```python
import torch

def _softmax(x, axis=-1):
    return torch.softmax(x, dim=axis)
def _gelu(x):
    return torch.nn.functional.gelu(x, approximate="tanh")
def _silu(x):
    return torch.nn.functional.silu(x)
def _sigmoid(x):
    return torch.sigmoid(x)
def _layernorm(x, axis=-1, eps=1e-5):
    m = x.mean(dim=axis, keepdim=True)
    v = x.var(dim=axis, keepdim=True, unbiased=False)
    return (x - m) / torch.sqrt(v + eps)
def _scatter_add(tgt, idx, src, axis=0):
    return tgt.clone().index_add_(axis, idx, src)
def _segment_sum(src, seg, n):
    out = torch.zeros((n,) + src.shape[1:], dtype=src.dtype)
    return out.index_add_(0, seg, src)
def _pad(x, pw):
    flat = tuple(v for pair in reversed(pw) for v in pair)
    return torch.nn.functional.pad(x, flat)

kernel_name = 'gated_mix__compressed_kv_cla__sliding_local_dilated__prompt'

def setup_inputs():

    _w = (lambda a: (lambda t: t.to(torch.bfloat16) if t.is_floating_point() else t)(torch.as_tensor(a)))
    def _A_setup():
        B, H, Sq, Sk, D, M = 1, 32, 2048, 2048, 128, 1024
        Dc = 4 * D
        return {
            "x": _w((lambda *s: torch.randn(*s, dtype=torch.bfloat16) * 0.05)(B, Sq, M)),
            "c_kv": _w((lambda *s: torch.randn(*s, dtype=torch.bfloat16) * 1.6)(B, Sk, Dc)),
            "w_q": _w((lambda *s: torch.randn(*s, dtype=torch.bfloat16) * 6.4)(M, H, D) * (M ** -0.5)),
            "w_uk": _w((lambda *s: torch.randn(*s, dtype=torch.bfloat16) * 6.4)(Dc, H, D) * (Dc ** -0.5)),
            "w_uv": _w((lambda *s: torch.randn(*s, dtype=torch.bfloat16) * 1.6)(Dc, H, D) * (Dc ** -0.5)),
            "w_o": _w((lambda *s: torch.randn(*s, dtype=torch.bfloat16) * 1.6)(H, D, M) * ((H * D) ** -0.5)),
        }
    _A_in = _A_setup()

    def _B_setup():
        B, S, D = 1, 2048, 1024
        return {
            "x": _w((lambda *s: torch.randn(*s, dtype=torch.bfloat16) * 0.05)(B, S, D)),
            "wqkv": _w((lambda *s: torch.randn(*s, dtype=torch.bfloat16) * 0.8)(D, 3 * D)),
            "wo": _w((lambda *s: torch.randn(*s, dtype=torch.bfloat16) * 0.05)(D, D)),
        }
    _B_in = _B_setup()

    return {
        "A_x": _A_in["x"],
        "A_c_kv": _A_in["c_kv"],
        "A_w_q": _A_in["w_q"],
        "A_w_uk": _A_in["w_uk"],
        "A_w_uv": _A_in["w_uv"],
        "A_w_o": _A_in["w_o"],
        "B_x": _B_in["x"],
        "B_wqkv": _B_in["wqkv"],
        "B_wo": _B_in["wo"],
        "gate_w": _w((lambda *s: torch.randn(*s, dtype=torch.bfloat16) * 0.05)(1024) * 16.0),
    }

def reference(A_x, A_c_kv, A_w_q, A_w_uk, A_w_uv, A_w_o, B_x, B_wqkv, B_wo, gate_w):
    def _A_ref(x, c_kv, w_q, w_uk, w_uv, w_o):
        B, Sq, M = x.shape[0], x.shape[1], x.shape[2]
        Sk = c_kv.shape[1]
        H, D = w_q.shape[1], w_q.shape[2]
        q = torch.einsum("bqm,mhd->bhqd", x, w_q)
        k = torch.einsum("bkc,chd->bhkd", c_kv, w_uk)
        v = torch.einsum("bkc,chd->bhkd", c_kv, w_uv)
        scores = torch.einsum("bhqd,bhkd->bhqk", q, k) * (D ** -0.5)
        off = Sk - Sq
        qi = torch.arange(Sq)[:, None]
        kj = torch.arange(Sk)[None, :]
        cmask = kj <= (qi + off)
        scores = torch.where(cmask[None, None], scores, -1e9)
        p = _softmax(scores, axis=-1)
        ctx = torch.einsum("bhqk,bhkd->bhqd", p, v)
        return torch.einsum("bhqd,hdm->bqm", ctx, w_o)

    def _B_ref(x, wqkv, wo):
        B, S, D = x.shape
        H = 32; Dh = D // H
        W, dil = 8, 2
        qkv = (lambda x, *d: x.permute(*d))((x @ wqkv).reshape(B, S, 3, H, Dh), 2, 0, 3, 1, 4)
        q, k, v = qkv[0], qkv[1], qkv[2]
        scale = Dh ** -0.5
        pos = torch.arange(S)
        off = torch.arange(W) * dil
        idx = pos[:, None] - off[None, :]
        mask = idx >= 0
        idx_c = torch.where(mask, idx, 0).reshape(-1)
        kg = k[:, :, idx_c, :].reshape(B, H, S, W, Dh)
        vg = v[:, :, idx_c, :].reshape(B, H, S, W, Dh)
        logits = torch.einsum("bhsd,bhswd->bhsw", q, kg) * scale
        logits = torch.where(mask[None, None, :, :], logits, -1e9)
        attn = _softmax(logits, axis=-1)
        o = torch.einsum("bhsw,bhswd->bhsd", attn, vg)
        return (lambda x, *d: x.permute(*d))(o, 0, 2, 1, 3).reshape(B, S, D) @ wo

    x = A_x
    g = _sigmoid((x * gate_w).sum(-1, keepdims=True))
    a = _A_ref(x, A_c_kv, A_w_q, A_w_uk, A_w_uv, A_w_o)
    b = _B_ref(x, B_wqkv, B_wo)
    return g * a + (1 - g) * b
```

```asm
; @launch kernel=k1_kernel grid=(256,1,1) block=(256,1,1) lds=155648
; @launch kernel=k2_kernel grid=(256,1,1) block=(256,1,1) lds=155648
; @launch kernel=k3_kernel grid=(256,1,1) block=(256,1,1) lds=155648
.amdgcn_target "amdgcn-amd-amdhsa--gfx950"
.text
.globl k1_kernel
.p2align 8
.type k1_kernel,@function
k1_kernel:
s_cmp_ge_u32 s2, 256
s_cbranch_scc1 L_end_1
s_load_dwordx16 s[4:19], s[0:1], 0
s_load_dwordx8 s[20:27], s[0:1], 64
s_load_dwordx2 s[28:29], s[0:1], 96
v_lshrrev_b32 v1, 6, v0
v_and_b32 v0, 63, v0
v_readfirstlane_b32 s30, v1
s_and_b32 s52, s2, 7
s_lshr_b32 s53, s2, 3
s_and_b32 s54, s53, 3
s_lshl2_add_u32 s31, s52, s54
s_lshr_b32 s3, s53, 2
s_waitcnt lgkmcnt(0)
s_mov_b32 s32, s6
s_mov_b32 s33, s7
s_mov_b32 s34, 2097152
s_mov_b32 s35, 0x20000
s_mov_b32 s36, s10
s_mov_b32 s37, s11
s_mov_b32 s38, 4194304
s_mov_b32 s39, 0x20000
s_mov_b32 s40, s12
s_mov_b32 s41, s13
s_mov_b32 s42, 4194304
s_mov_b32 s43, 0x20000
v_lshrrev_b32 v13, 3, v0
v_lshrrev_b32 v14, 4, v0
v_and_b32 v15, 7, v0
v_xor_b32 v15, v15, v14
v_lshlrev_b32 v15, 4, v15
v_lshl_add_u32 v8, v13, 10, v15
v_xor_b32 v9, 64, v8
v_bfe_u32 v15, v0, 1, 3
v_xor_b32 v15, v15, v14
v_lshlrev_b32 v15, 5, v15
v_and_b32 v13, 1, v0
v_lshl_add_u32 v15, v13, 4, v15
v_lshl_add_u32 v10, v14, 13, v15
v_xor_b32 v11, 128, v10
s_lshl_b32 s56, s3, 18
s_lshl_b32 s52, s30, 16
s_add_u32 s56, s56, s52
s_lshl_b32 s57, s30, 17
s_lshl_b32 s52, s31, 8
s_add_u32 s57, s57, s52
s_lshl_b32 s58, s30, 13
s_lshl_b32 s59, s30, 12
s_add_u32 s59, s59, 65536
s_add_u32 m0, s58, 0
s_add_u32 s60, s56, 0
buffer_load_dwordx4 v8, s[32:35], s60 offen lds
s_add_u32 m0, s58, 1024
s_add_u32 s60, s56, 8192
buffer_load_dwordx4 v9, s[32:35], s60 offen lds
s_add_u32 m0, s58, 2048
s_add_u32 s60, s56, 16384
buffer_load_dwordx4 v8, s[32:35], s60 offen lds
s_add_u32 m0, s58, 3072
s_add_u32 s60, s56, 24576
buffer_load_dwordx4 v9, s[32:35], s60 offen lds
s_add_u32 m0, s58, 4096
s_add_u32 s60, s56, 32768
buffer_load_dwordx4 v8, s[32:35], s60 offen lds
s_add_u32 m0, s58, 5120
s_add_u32 s60, s56, 40960
buffer_load_dwordx4 v9, s[32:35], s60 offen lds
s_add_u32 m0, s58, 6144
s_add_u32 s60, s56, 49152
buffer_load_dwordx4 v8, s[32:35], s60 offen lds
s_add_u32 m0, s58, 7168
s_add_u32 s60, s56, 57344
buffer_load_dwordx4 v9, s[32:35], s60 offen lds
s_add_u32 m0, s59, 0
s_add_u32 s60, s57, 0
buffer_load_dwordx4 v10, s[36:39], s60 offen lds
s_add_u32 m0, s59, 1024
s_add_u32 s60, s57, 32768
buffer_load_dwordx4 v10, s[36:39], s60 offen lds
s_add_u32 m0, s59, 2048
s_add_u32 s60, s57, 65536
buffer_load_dwordx4 v11, s[36:39], s60 offen lds
s_add_u32 m0, s59, 3072
s_add_u32 s60, s57, 98304
buffer_load_dwordx4 v11, s[36:39], s60 offen lds
s_add_u32 m0, s59, 16384
s_add_u32 s60, s57, 0
buffer_load_dwordx4 v10, s[40:43], s60 offen lds
s_add_u32 m0, s59, 17408
s_add_u32 s60, s57, 32768
buffer_load_dwordx4 v10, s[40:43], s60 offen lds
s_add_u32 m0, s59, 18432
s_add_u32 s60, s57, 65536
buffer_load_dwordx4 v11, s[40:43], s60 offen lds
s_add_u32 m0, s59, 19456
s_add_u32 s60, s57, 98304
buffer_load_dwordx4 v11, s[40:43], s60 offen lds
s_add_u32 s56, s56, 128
s_add_u32 s57, s57, 524288
s_add_u32 m0, s58, 32768
s_add_u32 s60, s56, 0
buffer_load_dwordx4 v8, s[32:35], s60 offen lds
s_add_u32 m0, s58, 33792
s_add_u32 s60, s56, 8192
buffer_load_dwordx4 v9, s[32:35], s60 offen lds
s_add_u32 m0, s58, 34816
s_add_u32 s60, s56, 16384
buffer_load_dwordx4 v8, s[32:35], s60 offen lds
s_add_u32 m0, s58, 35840
s_add_u32 s60, s56, 24576
buffer_load_dwordx4 v9, s[32:35], s60 offen lds
s_add_u32 m0, s58, 36864
s_add_u32 s60, s56, 32768
buffer_load_dwordx4 v8, s[32:35], s60 offen lds
s_add_u32 m0, s58, 37888
s_add_u32 s60, s56, 40960
buffer_load_dwordx4 v9, s[32:35], s60 offen lds
s_add_u32 m0, s58, 38912
s_add_u32 s60, s56, 49152
buffer_load_dwordx4 v8, s[32:35], s60 offen lds
s_add_u32 m0, s58, 39936
s_add_u32 s60, s56, 57344
buffer_load_dwordx4 v9, s[32:35], s60 offen lds
s_add_u32 m0, s59, 32768
s_add_u32 s60, s57, 0
buffer_load_dwordx4 v10, s[36:39], s60 offen lds
s_add_u32 m0, s59, 33792
s_add_u32 s60, s57, 32768
buffer_load_dwordx4 v10, s[36:39], s60 offen lds
s_add_u32 m0, s59, 34816
s_add_u32 s60, s57, 65536
buffer_load_dwordx4 v11, s[36:39], s60 offen lds
s_add_u32 m0, s59, 35840
s_add_u32 s60, s57, 98304
buffer_load_dwordx4 v11, s[36:39], s60 offen lds
s_add_u32 m0, s59, 49152
s_add_u32 s60, s57, 0
buffer_load_dwordx4 v10, s[40:43], s60 offen lds
s_add_u32 m0, s59, 50176
s_add_u32 s60, s57, 32768
buffer_load_dwordx4 v10, s[40:43], s60 offen lds
s_add_u32 m0, s59, 51200
s_add_u32 s60, s57, 65536
buffer_load_dwordx4 v11, s[40:43], s60 offen lds
s_add_u32 m0, s59, 52224
s_add_u32 s60, s57, 98304
buffer_load_dwordx4 v11, s[40:43], s60 offen lds
s_add_u32 s56, s56, 128
s_add_u32 s57, s57, 524288
s_lshl_b32 s52, s2, 3
s_lshl1_add_u32 s52, s30, s52
v_lshrrev_b32 v16, 5, v0
v_add_u32 v16, s52, v16
v_and_b32 v17, 31, v0
v_lshlrev_b32 v17, 4, v17
v_lshl_add_u32 v18, v16, 11, v17
global_load_dwordx4 v[20:23], v18, s[4:5] offset:0
global_load_dwordx4 v[24:27], v18, s[4:5] offset:512
global_load_dwordx4 v[28:31], v18, s[4:5] offset:1024
global_load_dwordx4 v[32:35], v18, s[4:5] offset:1536
global_load_dwordx4 v[36:39], v17, s[22:23] offset:0
global_load_dwordx4 v[40:43], v17, s[22:23] offset:512
global_load_dwordx4 v[44:47], v17, s[22:23] offset:1024
global_load_dwordx4 v[48:51], v17, s[22:23] offset:1536
v_and_b32 v13, 15, v0
v_lshrrev_b32 v15, 1, v13
v_xor_b32 v15, v15, v14
v_lshlrev_b32 v15, 4, v15
v_lshl_add_u32 v15, v13, 7, v15
s_lshr_b32 s52, s30, 1
s_lshl_b32 s52, s52, 14
v_add_u32 v2, s52, v15
v_xor_b32 v3, 64, v2
v_bfe_u32 v13, v0, 2, 2
v_lshl_add_u32 v15, v14, 3, v13
v_lshlrev_b32 v15, 8, v15
v_and_b32 v1, 3, v0
v_lshl_add_u32 v15, v1, 3, v15
v_add_u32 v15, 65536, v15
v_and_b32 v1, 1, v14
v_lshl_add_u32 v13, v1, 2, v13
s_and_b32 s52, s30, 1
s_lshl_b32 s52, s52, 2
v_xor_b32 v13, s52, v13
v_xor_b32 v1, 0, v13
v_lshl_add_u32 v4, v1, 5, v15
v_xor_b32 v1, 1, v13
v_lshl_add_u32 v5, v1, 5, v15
v_xor_b32 v1, 2, v13
v_lshl_add_u32 v6, v1, 5, v15
v_xor_b32 v1, 3, v13
v_lshl_add_u32 v7, v1, 5, v15
v_lshlrev_b32 v12, 4, v0
s_waitcnt vmcnt(0)
v_mov_b32 v19, 0
v_lshlrev_b32 v52, 16, v20
v_and_b32 v53, 0xffff0000, v20
v_lshlrev_b32 v54, 16, v36
v_and_b32 v55, 0xffff0000, v36
v_mul_f32 v52, v52, v54
v_mul_f32 v53, v53, v55
v_cvt_pk_bf16_f32 v52, v52, v53
v_lshlrev_b32 v53, 16, v52
v_and_b32 v52, 0xffff0000, v52
v_add_f32 v19, v19, v53
v_add_f32 v19, v19, v52
v_lshlrev_b32 v52, 16, v21
v_and_b32 v53, 0xffff0000, v21
v_lshlrev_b32 v54, 16, v37
v_and_b32 v55, 0xffff0000, v37
v_mul_f32 v52, v52, v54
v_mul_f32 v53, v53, v55
v_cvt_pk_bf16_f32 v52, v52, v53
v_lshlrev_b32 v53, 16, v52
v_and_b32 v52, 0xffff0000, v52
v_add_f32 v19, v19, v53
v_add_f32 v19, v19, v52
v_lshlrev_b32 v52, 16, v22
v_and_b32 v53, 0xffff0000, v22
v_lshlrev_b32 v54, 16, v38
v_and_b32 v55, 0xffff0000, v38
v_mul_f32 v52, v52, v54
v_mul_f32 v53, v53, v55
v_cvt_pk_bf16_f32 v52, v52, v53
v_lshlrev_b32 v53, 16, v52
v_and_b32 v52, 0xffff0000, v52
v_add_f32 v19, v19, v53
v_add_f32 v19, v19, v52
v_lshlrev_b32 v52, 16, v23
v_and_b32 v53, 0xffff0000, v23
v_lshlrev_b32 v54, 16, v39
v_and_b32 v55, 0xffff0000, v39
v_mul_f32 v52, v52, v54
v_mul_f32 v53, v53, v55
v_cvt_pk_bf16_f32 v52, v52, v53
v_lshlrev_b32 v53, 16, v52
v_and_b32 v52, 0xffff0000, v52
v_add_f32 v19, v19, v53
v_add_f32 v19, v19, v52
v_lshlrev_b32 v52, 16, v24
v_and_b32 v53, 0xffff0000, v24
v_lshlrev_b32 v54, 16, v40
v_and_b32 v55, 0xffff0000, v40
v_mul_f32 v52, v52, v54
v_mul_f32 v53, v53, v55
v_cvt_pk_bf16_f32 v52, v52, v53
v_lshlrev_b32 v53, 16, v52
v_and_b32 v52, 0xffff0000, v52
v_add_f32 v19, v19, v53
v_add_f32 v19, v19, v52
v_lshlrev_b32 v52, 16, v25
v_and_b32 v53, 0xffff0000, v25
v_lshlrev_b32 v54, 16, v41
v_and_b32 v55, 0xffff0000, v41
v_mul_f32 v52, v52, v54
v_mul_f32 v53, v53, v55
v_cvt_pk_bf16_f32 v52, v52, v53
v_lshlrev_b32 v53, 16, v52
v_and_b32 v52, 0xffff0000, v52
v_add_f32 v19, v19, v53
v_add_f32 v19, v19, v52
v_lshlrev_b32 v52, 16, v26
v_and_b32 v53, 0xffff0000, v26
v_lshlrev_b32 v54, 16, v42
v_and_b32 v55, 0xffff0000, v42
v_mul_f32 v52, v52, v54
v_mul_f32 v53, v53, v55
v_cvt_pk_bf16_f32 v52, v52, v53
v_lshlrev_b32 v53, 16, v52
v_and_b32 v52, 0xffff0000, v52
v_add_f32 v19, v19, v53
v_add_f32 v19, v19, v52
v_lshlrev_b32 v52, 16, v27
v_and_b32 v53, 0xffff0000, v27
v_lshlrev_b32 v54, 16, v43
v_and_b32 v55, 0xffff0000, v43
v_mul_f32 v52, v52, v54
v_mul_f32 v53, v53, v55
v_cvt_pk_bf16_f32 v52, v52, v53
v_lshlrev_b32 v53, 16, v52
v_and_b32 v52, 0xffff0000, v52
v_add_f32 v19, v19, v53
v_add_f32 v19, v19, v52
v_lshlrev_b32 v52, 16, v28
v_and_b32 v53, 0xffff0000, v28
v_lshlrev_b32 v54, 16, v44
v_and_b32 v55, 0xffff0000, v44
v_mul_f32 v52, v52, v54
v_mul_f32 v53, v53, v55
v_cvt_pk_bf16_f32 v52, v52, v53
v_lshlrev_b32 v53, 16, v52
v_and_b32 v52, 0xffff0000, v52
v_add_f32 v19, v19, v53
v_add_f32 v19, v19, v52
v_lshlrev_b32 v52, 16, v29
v_and_b32 v53, 0xffff0000, v29
v_lshlrev_b32 v54, 16, v45
v_and_b32 v55, 0xffff0000, v45
v_mul_f32 v52, v52, v54
v_mul_f32 v53, v53, v55
v_cvt_pk_bf16_f32 v52, v52, v53
v_lshlrev_b32 v53, 16, v52
v_and_b32 v52, 0xffff0000, v52
v_add_f32 v19, v19, v53
v_add_f32 v19, v19, v52
v_lshlrev_b32 v52, 16, v30
v_and_b32 v53, 0xffff0000, v30
v_lshlrev_b32 v54, 16, v46
v_and_b32 v55, 0xffff0000, v46
v_mul_f32 v52, v52, v54
v_mul_f32 v53, v53, v55
v_cvt_pk_bf16_f32 v52, v52, v53
v_lshlrev_b32 v53, 16, v52
v_and_b32 v52, 0xffff0000, v52
v_add_f32 v19, v19, v53
v_add_f32 v19, v19, v52
v_lshlrev_b32 v52, 16, v31
v_and_b32 v53, 0xffff0000, v31
v_lshlrev_b32 v54, 16, v47
v_and_b32 v55, 0xffff0000, v47
v_mul_f32 v52, v52, v54
v_mul_f32 v53, v53, v55
v_cvt_pk_bf16_f32 v52, v52, v53
v_lshlrev_b32 v53, 16, v52
v_and_b32 v52, 0xffff0000, v52
v_add_f32 v19, v19, v53
v_add_f32 v19, v19, v52
v_lshlrev_b32 v52, 16, v32
v_and_b32 v53, 0xffff0000, v32
v_lshlrev_b32 v54, 16, v48
v_and_b32 v55, 0xffff0000, v48
v_mul_f32 v52, v52, v54
v_mul_f32 v53, v53, v55
v_cvt_pk_bf16_f32 v52, v52, v53
v_lshlrev_b32 v53, 16, v52
v_and_b32 v52, 0xffff0000, v52
v_add_f32 v19, v19, v53
v_add_f32 v19, v19, v52
v_lshlrev_b32 v52, 16, v33
v_and_b32 v53, 0xffff0000, v33
v_lshlrev_b32 v54, 16, v49
v_and_b32 v55, 0xffff0000, v49
v_mul_f32 v52, v52, v54
v_mul_f32 v53, v53, v55
v_cvt_pk_bf16_f32 v52, v52, v53
v_lshlrev_b32 v53, 16, v52
v_and_b32 v52, 0xffff0000, v52
v_add_f32 v19, v19, v53
v_add_f32 v19, v19, v52
v_lshlrev_b32 v52, 16, v34
v_and_b32 v53, 0xffff0000, v34
v_lshlrev_b32 v54, 16, v50
v_and_b32 v55, 0xffff0000, v50
v_mul_f32 v52, v52, v54
v_mul_f32 v53, v53, v55
v_cvt_pk_bf16_f32 v52, v52, v53
v_lshlrev_b32 v53, 16, v52
v_and_b32 v52, 0xffff0000, v52
v_add_f32 v19, v19, v53
v_add_f32 v19, v19, v52
v_lshlrev_b32 v52, 16, v35
v_and_b32 v53, 0xffff0000, v35
v_lshlrev_b32 v54, 16, v51
v_and_b32 v55, 0xffff0000, v51
v_mul_f32 v52, v52, v54
v_mul_f32 v53, v53, v55
v_cvt_pk_bf16_f32 v52, v52, v53
v_lshlrev_b32 v53, 16, v52
v_and_b32 v52, 0xffff0000, v52
v_add_f32 v19, v19, v53
v_add_f32 v19, v19, v52
s_nop 1
v_add_f32_dpp v19, v19, v19 row_ror:8 row_mask:0xf bank_mask:0xf
s_nop 1
v_add_f32_dpp v19, v19, v19 row_ror:4 row_mask:0xf bank_mask:0xf
s_nop 1
v_add_f32_dpp v19, v19, v19 row_ror:2 row_mask:0xf bank_mask:0xf
s_nop 1
v_add_f32_dpp v19, v19, v19 row_ror:1 row_mask:0xf bank_mask:0xf
v_mov_b32 v52, v19
s_nop 1
v_permlane16_swap_b32 v52, v19
v_add_f32 v19, v19, v52
v_cvt_pk_bf16_f32 v19, v19, v19
v_and_b32 v19, 0xffff0000, v19
v_mul_f32 v19, 0xbfb8aa3b, v19
v_exp_f32 v19, v19
s_nop 0
v_add_f32 v19, 1.0, v19
v_rcp_f32 v19, v19
s_nop 0
v_cvt_pk_bf16_f32 v52, v19, v19
v_and_b32 v52, 0xffff0000, v52
v_sub_f32 v53, 1.0, v52
v_cvt_pk_bf16_f32 v53, v53, v53
v_and_b32 v53, 0xffff0000, v53
v_lshlrev_b32 v16, 3, v16
v_add_u32 v16, 58720256, v16
s_mov_b32 exec_lo, 1
s_mov_b32 exec_hi, 1
global_store_dwordx2 v16, v[52:53], s[28:29]
s_mov_b64 exec, -1
s_nop 1
v_mov_b32 v16, 0
v_mov_b32 v17, 0
v_mov_b32 v18, 0
v_mov_b32 v19, 0
v_mov_b32 v20, 0
v_mov_b32 v21, 0
v_mov_b32 v22, 0
v_mov_b32 v23, 0
v_mov_b32 v24, 0
v_mov_b32 v25, 0
v_mov_b32 v26, 0
v_mov_b32 v27, 0
v_mov_b32 v28, 0
v_mov_b32 v29, 0
v_mov_b32 v30, 0
v_mov_b32 v31, 0
v_mov_b32 v32, 0
v_mov_b32 v33, 0
v_mov_b32 v34, 0
v_mov_b32 v35, 0
v_mov_b32 v36, 0
v_mov_b32 v37, 0
v_mov_b32 v38, 0
v_mov_b32 v39, 0
v_mov_b32 v40, 0
v_mov_b32 v41, 0
v_mov_b32 v42, 0
v_mov_b32 v43, 0
v_mov_b32 v44, 0
v_mov_b32 v45, 0
v_mov_b32 v46, 0
v_mov_b32 v47, 0
v_mov_b32 v48, 0
v_mov_b32 v49, 0
v_mov_b32 v50, 0
v_mov_b32 v51, 0
v_mov_b32 v52, 0
v_mov_b32 v53, 0
v_mov_b32 v54, 0
v_mov_b32 v55, 0
v_mov_b32 v56, 0
v_mov_b32 v57, 0
v_mov_b32 v58, 0
v_mov_b32 v59, 0
v_mov_b32 v60, 0
v_mov_b32 v61, 0
v_mov_b32 v62, 0
v_mov_b32 v63, 0
v_mov_b32 v64, 0
v_mov_b32 v65, 0
v_mov_b32 v66, 0
v_mov_b32 v67, 0
v_mov_b32 v68, 0
v_mov_b32 v69, 0
v_mov_b32 v70, 0
v_mov_b32 v71, 0
v_mov_b32 v72, 0
v_mov_b32 v73, 0
v_mov_b32 v74, 0
v_mov_b32 v75, 0
v_mov_b32 v76, 0
v_mov_b32 v77, 0
v_mov_b32 v78, 0
v_mov_b32 v79, 0
v_mov_b32 v80, 0
v_mov_b32 v81, 0
v_mov_b32 v82, 0
v_mov_b32 v83, 0
v_mov_b32 v84, 0
v_mov_b32 v85, 0
v_mov_b32 v86, 0
v_mov_b32 v87, 0
v_mov_b32 v88, 0
v_mov_b32 v89, 0
v_mov_b32 v90, 0
v_mov_b32 v91, 0
v_mov_b32 v92, 0
v_mov_b32 v93, 0
v_mov_b32 v94, 0
v_mov_b32 v95, 0
v_mov_b32 v96, 0
v_mov_b32 v97, 0
v_mov_b32 v98, 0
v_mov_b32 v99, 0
v_mov_b32 v100, 0
v_mov_b32 v101, 0
v_mov_b32 v102, 0
v_mov_b32 v103, 0
v_mov_b32 v104, 0
v_mov_b32 v105, 0
v_mov_b32 v106, 0
v_mov_b32 v107, 0
v_mov_b32 v108, 0
v_mov_b32 v109, 0
v_mov_b32 v110, 0
v_mov_b32 v111, 0
v_mov_b32 v112, 0
v_mov_b32 v113, 0
v_mov_b32 v114, 0
v_mov_b32 v115, 0
v_mov_b32 v116, 0
v_mov_b32 v117, 0
v_mov_b32 v118, 0
v_mov_b32 v119, 0
v_mov_b32 v120, 0
v_mov_b32 v121, 0
v_mov_b32 v122, 0
v_mov_b32 v123, 0
v_mov_b32 v124, 0
v_mov_b32 v125, 0
v_mov_b32 v126, 0
v_mov_b32 v127, 0
v_mov_b32 v128, 0
v_mov_b32 v129, 0
v_mov_b32 v130, 0
v_mov_b32 v131, 0
v_mov_b32 v132, 0
v_mov_b32 v133, 0
v_mov_b32 v134, 0
v_mov_b32 v135, 0
v_mov_b32 v136, 0
v_mov_b32 v137, 0
v_mov_b32 v138, 0
v_mov_b32 v139, 0
v_mov_b32 v140, 0
v_mov_b32 v141, 0
v_mov_b32 v142, 0
v_mov_b32 v143, 0
v_mov_b32 v144, 0
v_mov_b32 v145, 0
v_mov_b32 v146, 0
v_mov_b32 v147, 0
v_mov_b32 v148, 0
v_mov_b32 v149, 0
v_mov_b32 v150, 0
v_mov_b32 v151, 0
v_mov_b32 v152, 0
v_mov_b32 v153, 0
v_mov_b32 v154, 0
v_mov_b32 v155, 0
v_mov_b32 v156, 0
v_mov_b32 v157, 0
v_mov_b32 v158, 0
v_mov_b32 v159, 0
v_mov_b32 v160, 0
v_mov_b32 v161, 0
v_mov_b32 v162, 0
v_mov_b32 v163, 0
v_mov_b32 v164, 0
v_mov_b32 v165, 0
v_mov_b32 v166, 0
v_mov_b32 v167, 0
v_mov_b32 v168, 0
v_mov_b32 v169, 0
v_mov_b32 v170, 0
v_mov_b32 v171, 0
v_mov_b32 v172, 0
v_mov_b32 v173, 0
v_mov_b32 v174, 0
v_mov_b32 v175, 0
v_mov_b32 v176, 0
v_mov_b32 v177, 0
v_mov_b32 v178, 0
v_mov_b32 v179, 0
v_mov_b32 v180, 0
v_mov_b32 v181, 0
v_mov_b32 v182, 0
v_mov_b32 v183, 0
v_mov_b32 v184, 0
v_mov_b32 v185, 0
v_mov_b32 v186, 0
v_mov_b32 v187, 0
v_mov_b32 v188, 0
v_mov_b32 v189, 0
v_mov_b32 v190, 0
v_mov_b32 v191, 0
v_mov_b32 v192, 0
v_mov_b32 v193, 0
v_mov_b32 v194, 0
v_mov_b32 v195, 0
v_mov_b32 v196, 0
v_mov_b32 v197, 0
v_mov_b32 v198, 0
v_mov_b32 v199, 0
v_mov_b32 v200, 0
v_mov_b32 v201, 0
v_mov_b32 v202, 0
v_mov_b32 v203, 0
v_mov_b32 v204, 0
v_mov_b32 v205, 0
v_mov_b32 v206, 0
v_mov_b32 v207, 0
v_mov_b32 v208, 0
v_mov_b32 v209, 0
v_mov_b32 v210, 0
v_mov_b32 v211, 0
v_mov_b32 v212, 0
v_mov_b32 v213, 0
v_mov_b32 v214, 0
v_mov_b32 v215, 0
v_mov_b32 v216, 0
v_mov_b32 v217, 0
v_mov_b32 v218, 0
v_mov_b32 v219, 0
v_mov_b32 v220, 0
v_mov_b32 v221, 0
v_mov_b32 v222, 0
v_mov_b32 v223, 0
v_mov_b32 v224, 0
v_mov_b32 v225, 0
v_mov_b32 v226, 0
v_mov_b32 v227, 0
v_mov_b32 v228, 0
v_mov_b32 v229, 0
v_mov_b32 v230, 0
v_mov_b32 v231, 0
v_mov_b32 v232, 0
v_mov_b32 v233, 0
v_mov_b32 v234, 0
v_mov_b32 v235, 0
v_mov_b32 v236, 0
v_mov_b32 v237, 0
v_mov_b32 v238, 0
v_mov_b32 v239, 0
v_mov_b32 v240, 0
v_mov_b32 v241, 0
v_mov_b32 v242, 0
v_mov_b32 v243, 0
v_mov_b32 v244, 0
v_mov_b32 v245, 0
v_mov_b32 v246, 0
v_mov_b32 v247, 0
v_mov_b32 v248, 0
v_mov_b32 v249, 0
v_mov_b32 v250, 0
v_mov_b32 v251, 0
v_mov_b32 v252, 0
v_mov_b32 v253, 0
v_mov_b32 v254, 0
v_mov_b32 v255, 0
v_accvgpr_write_b32 a128, 0
v_accvgpr_write_b32 a129, 0
v_accvgpr_write_b32 a130, 0
v_accvgpr_write_b32 a131, 0
v_accvgpr_write_b32 a132, 0
v_accvgpr_write_b32 a133, 0
v_accvgpr_write_b32 a134, 0
v_accvgpr_write_b32 a135, 0
v_accvgpr_write_b32 a136, 0
v_accvgpr_write_b32 a137, 0
v_accvgpr_write_b32 a138, 0
v_accvgpr_write_b32 a139, 0
v_accvgpr_write_b32 a140, 0
v_accvgpr_write_b32 a141, 0
v_accvgpr_write_b32 a142, 0
v_accvgpr_write_b32 a143, 0
s_waitcnt vmcnt(0)
s_barrier
ds_read_b128 a[0:3], v2 offset:0
ds_read_b64_tr_b16 a[32:33], v4 offset:0
ds_read_b64_tr_b16 a[34:35], v4 offset:1024
ds_read_b64_tr_b16 a[36:37], v5 offset:0
ds_read_b64_tr_b16 a[38:39], v5 offset:1024
ds_read_b64_tr_b16 a[40:41], v6 offset:0
ds_read_b64_tr_b16 a[42:43], v6 offset:1024
ds_read_b64_tr_b16 a[44:45], v7 offset:0
ds_read_b64_tr_b16 a[46:47], v7 offset:1024
ds_read_b64_tr_b16 a[48:49], v4 offset:16384
ds_read_b64_tr_b16 a[50:51], v4 offset:17408
ds_read_b64_tr_b16 a[52:53], v5 offset:16384
ds_read_b64_tr_b16 a[54:55], v5 offset:17408
ds_read_b64_tr_b16 a[56:57], v6 offset:16384
ds_read_b64_tr_b16 a[58:59], v6 offset:17408
ds_read_b64_tr_b16 a[60:61], v7 offset:16384
ds_read_b64_tr_b16 a[62:63], v7 offset:17408
ds_read_b128 a[4:7], v2 offset:2048
ds_read_b128 a[8:11], v2 offset:4096
ds_read_b128 a[12:15], v2 offset:6144
ds_read_b128 a[16:19], v2 offset:8192
ds_read_b128 a[20:23], v2 offset:10240
ds_read_b128 a[24:27], v2 offset:12288
ds_read_b128 a[28:31], v2 offset:14336
s_mov_b32 s61, 3
s_waitcnt lgkmcnt(0)
.p2align 3
L_p1_2:
s_waitcnt lgkmcnt(15)
v_mfma_f32_16x16x32_bf16 v[16:19], a[32:35], a[0:3], v[16:19]
s_waitcnt lgkmcnt(15)
ds_read_b128 a[64:67], v3 offset:0
v_mfma_f32_16x16x32_bf16 v[20:23], a[36:39], a[0:3], v[20:23]
s_waitcnt lgkmcnt(15)
ds_read_b64_tr_b16 a[96:97], v4 offset:8192
v_mfma_f32_16x16x32_bf16 v[24:27], a[40:43], a[0:3], v[24:27]
s_waitcnt lgkmcnt(15)
ds_read_b64_tr_b16 a[98:99], v4 offset:9216
v_mfma_f32_16x16x32_bf16 v[28:31], a[44:47], a[0:3], v[28:31]
s_waitcnt lgkmcnt(15)
ds_read_b64_tr_b16 a[100:101], v5 offset:8192
v_mfma_f32_16x16x32_bf16 v[32:35], a[0:3], a[48:51], v[32:35]
s_waitcnt lgkmcnt(15)
ds_read_b64_tr_b16 a[102:103], v5 offset:9216
v_mfma_f32_16x16x32_bf16 v[36:39], a[0:3], a[52:55], v[36:39]
s_waitcnt lgkmcnt(14)
ds_read_b64_tr_b16 a[104:105], v6 offset:8192
v_mfma_f32_16x16x32_bf16 v[40:43], a[0:3], a[56:59], v[40:43]
s_waitcnt lgkmcnt(13)
ds_read_b64_tr_b16 a[106:107], v6 offset:9216
v_mfma_f32_16x16x32_bf16 v[44:47], a[0:3], a[60:63], v[44:47]
s_waitcnt lgkmcnt(13)
ds_read_b64_tr_b16 a[108:109], v7 offset:8192
v_mfma_f32_16x16x32_bf16 v[48:51], a[32:35], a[4:7], v[48:51]
ds_read_b64_tr_b16 a[110:111], v7 offset:9216
v_mfma_f32_16x16x32_bf16 v[52:55], a[36:39], a[4:7], v[52:55]
ds_read_b64_tr_b16 a[112:113], v4 offset:24576
v_mfma_f32_16x16x32_bf16 v[56:59], a[40:43], a[4:7], v[56:59]
ds_read_b64_tr_b16 a[114:115], v4 offset:25600
v_mfma_f32_16x16x32_bf16 v[60:63], a[44:47], a[4:7], v[60:63]
ds_read_b64_tr_b16 a[116:117], v5 offset:24576
v_mfma_f32_16x16x32_bf16 v[64:67], a[4:7], a[48:51], v[64:67]
ds_read_b64_tr_b16 a[118:119], v5 offset:25600
v_mfma_f32_16x16x32_bf16 v[68:71], a[4:7], a[52:55], v[68:71]
ds_read_b64_tr_b16 a[120:121], v6 offset:24576
v_mfma_f32_16x16x32_bf16 v[72:75], a[4:7], a[56:59], v[72:75]
ds_read_b64_tr_b16 a[122:123], v6 offset:25600
v_mfma_f32_16x16x32_bf16 v[76:79], a[4:7], a[60:63], v[76:79]
s_waitcnt lgkmcnt(15)
ds_read_b64_tr_b16 a[124:125], v7 offset:24576
v_mfma_f32_16x16x32_bf16 v[80:83], a[32:35], a[8:11], v[80:83]
ds_read_b64_tr_b16 a[126:127], v7 offset:25600
v_mfma_f32_16x16x32_bf16 v[84:87], a[36:39], a[8:11], v[84:87]
ds_read_b128 a[68:71], v3 offset:2048
v_mfma_f32_16x16x32_bf16 v[88:91], a[40:43], a[8:11], v[88:91]
ds_read_b128 a[72:75], v3 offset:4096
v_mfma_f32_16x16x32_bf16 v[92:95], a[44:47], a[8:11], v[92:95]
ds_read_b128 a[76:79], v3 offset:6144
v_mfma_f32_16x16x32_bf16 v[96:99], a[8:11], a[48:51], v[96:99]
ds_read_b128 a[80:83], v3 offset:8192
v_mfma_f32_16x16x32_bf16 v[100:103], a[8:11], a[52:55], v[100:103]
ds_read_b128 a[84:87], v3 offset:10240
v_mfma_f32_16x16x32_bf16 v[104:107], a[8:11], a[56:59], v[104:107]
ds_read_b128 a[88:91], v3 offset:12288
v_mfma_f32_16x16x32_bf16 v[108:111], a[8:11], a[60:63], v[108:111]
s_waitcnt lgkmcnt(15)
ds_read_b128 a[92:95], v3 offset:14336
v_mfma_f32_16x16x32_bf16 v[112:115], a[32:35], a[12:15], v[112:115]
v_mfma_f32_16x16x32_bf16 v[116:119], a[36:39], a[12:15], v[116:119]
v_mfma_f32_16x16x32_bf16 v[120:123], a[40:43], a[12:15], v[120:123]
v_mfma_f32_16x16x32_bf16 v[124:127], a[44:47], a[12:15], v[124:127]
v_mfma_f32_16x16x32_bf16 v[128:131], a[12:15], a[48:51], v[128:131]
v_mfma_f32_16x16x32_bf16 v[132:135], a[12:15], a[52:55], v[132:135]
v_mfma_f32_16x16x32_bf16 v[136:139], a[12:15], a[56:59], v[136:139]
v_mfma_f32_16x16x32_bf16 v[140:143], a[12:15], a[60:63], v[140:143]
s_waitcnt lgkmcnt(15)
v_mfma_f32_16x16x32_bf16 v[144:147], a[32:35], a[16:19], v[144:147]
v_mfma_f32_16x16x32_bf16 v[148:151], a[36:39], a[16:19], v[148:151]
v_mfma_f32_16x16x32_bf16 v[152:155], a[40:43], a[16:19], v[152:155]
v_mfma_f32_16x16x32_bf16 v[156:159], a[44:47], a[16:19], v[156:159]
v_mfma_f32_16x16x32_bf16 v[160:163], a[16:19], a[48:51], v[160:163]
v_mfma_f32_16x16x32_bf16 v[164:167], a[16:19], a[52:55], v[164:167]
v_mfma_f32_16x16x32_bf16 v[168:171], a[16:19], a[56:59], v[168:171]
v_mfma_f32_16x16x32_bf16 v[172:175], a[16:19], a[60:63], v[172:175]
s_waitcnt lgkmcnt(15)
v_mfma_f32_16x16x32_bf16 v[176:179], a[32:35], a[20:23], v[176:179]
v_mfma_f32_16x16x32_bf16 v[180:183], a[36:39], a[20:23], v[180:183]
v_mfma_f32_16x16x32_bf16 v[184:187], a[40:43], a[20:23], v[184:187]
v_mfma_f32_16x16x32_bf16 v[188:191], a[44:47], a[20:23], v[188:191]
v_mfma_f32_16x16x32_bf16 v[192:195], a[20:23], a[48:51], v[192:195]
v_mfma_f32_16x16x32_bf16 v[196:199], a[20:23], a[52:55], v[196:199]
v_mfma_f32_16x16x32_bf16 v[200:203], a[20:23], a[56:59], v[200:203]
v_mfma_f32_16x16x32_bf16 v[204:207], a[20:23], a[60:63], v[204:207]
s_waitcnt lgkmcnt(15)
v_mfma_f32_16x16x32_bf16 v[208:211], a[32:35], a[24:27], v[208:211]
v_mfma_f32_16x16x32_bf16 v[212:215], a[36:39], a[24:27], v[212:215]
v_mfma_f32_16x16x32_bf16 v[216:219], a[40:43], a[24:27], v[216:219]
v_mfma_f32_16x16x32_bf16 v[220:223], a[44:47], a[24:27], v[220:223]
v_mfma_f32_16x16x32_bf16 v[224:227], a[24:27], a[48:51], v[224:227]
v_mfma_f32_16x16x32_bf16 v[228:231], a[24:27], a[52:55], v[228:231]
v_mfma_f32_16x16x32_bf16 v[232:235], a[24:27], a[56:59], v[232:235]
v_mfma_f32_16x16x32_bf16 v[236:239], a[24:27], a[60:63], v[236:239]
s_waitcnt lgkmcnt(15)
v_mfma_f32_16x16x32_bf16 v[240:243], a[32:35], a[28:31], v[240:243]
v_mfma_f32_16x16x32_bf16 v[244:247], a[36:39], a[28:31], v[244:247]
v_mfma_f32_16x16x32_bf16 v[248:251], a[40:43], a[28:31], v[248:251]
v_mfma_f32_16x16x32_bf16 v[252:255], a[44:47], a[28:31], v[252:255]
v_mfma_f32_16x16x32_bf16 a[128:131], a[28:31], a[48:51], a[128:131]
v_mfma_f32_16x16x32_bf16 a[132:135], a[28:31], a[52:55], a[132:135]
v_mfma_f32_16x16x32_bf16 a[136:139], a[28:31], a[56:59], a[136:139]
v_mfma_f32_16x16x32_bf16 a[140:143], a[28:31], a[60:63], a[140:143]
s_waitcnt vmcnt(0) lgkmcnt(0)
s_barrier
v_mfma_f32_16x16x32_bf16 v[16:19], a[96:99], a[64:67], v[16:19]
s_add_u32 m0, s58, 0
ds_read_b128 a[0:3], v2 offset:32768
v_mfma_f32_16x16x32_bf16 v[20:23], a[100:103], a[64:67], v[20:23]
s_add_u32 s60, s56, 0
ds_read_b64_tr_b16 a[32:33], v4 offset:32768
v_mfma_f32_16x16x32_bf16 v[24:27], a[104:107], a[64:67], v[24:27]
buffer_load_dwordx4 v8, s[32:35], s60 offen lds
v_mfma_f32_16x16x32_bf16 v[28:31], a[108:111], a[64:67], v[28:31]
ds_read_b64_tr_b16 a[34:35], v4 offset:33792
v_mfma_f32_16x16x32_bf16 v[32:35], a[64:67], a[112:115], v[32:35]
s_add_u32 m0, s58, 1024
ds_read_b64_tr_b16 a[36:37], v5 offset:32768
v_mfma_f32_16x16x32_bf16 v[36:39], a[64:67], a[116:119], v[36:39]
s_add_u32 s60, s56, 8192
ds_read_b64_tr_b16 a[38:39], v5 offset:33792
v_mfma_f32_16x16x32_bf16 v[40:43], a[64:67], a[120:123], v[40:43]
buffer_load_dwordx4 v9, s[32:35], s60 offen lds
v_mfma_f32_16x16x32_bf16 v[44:47], a[64:67], a[124:127], v[44:47]
ds_read_b64_tr_b16 a[40:41], v6 offset:32768
v_mfma_f32_16x16x32_bf16 v[48:51], a[96:99], a[68:71], v[48:51]
s_add_u32 m0, s58, 2048
ds_read_b64_tr_b16 a[42:43], v6 offset:33792
v_mfma_f32_16x16x32_bf16 v[52:55], a[100:103], a[68:71], v[52:55]
s_add_u32 s60, s56, 16384
ds_read_b64_tr_b16 a[44:45], v7 offset:32768
v_mfma_f32_16x16x32_bf16 v[56:59], a[104:107], a[68:71], v[56:59]
buffer_load_dwordx4 v8, s[32:35], s60 offen lds
v_mfma_f32_16x16x32_bf16 v[60:63], a[108:111], a[68:71], v[60:63]
ds_read_b64_tr_b16 a[46:47], v7 offset:33792
v_mfma_f32_16x16x32_bf16 v[64:67], a[68:71], a[112:115], v[64:67]
s_add_u32 m0, s58, 3072
ds_read_b64_tr_b16 a[48:49], v4 offset:49152
v_mfma_f32_16x16x32_bf16 v[68:71], a[68:71], a[116:119], v[68:71]
s_add_u32 s60, s56, 24576
ds_read_b64_tr_b16 a[50:51], v4 offset:50176
v_mfma_f32_16x16x32_bf16 v[72:75], a[68:71], a[120:123], v[72:75]
buffer_load_dwordx4 v9, s[32:35], s60 offen lds
v_mfma_f32_16x16x32_bf16 v[76:79], a[68:71], a[124:127], v[76:79]
ds_read_b64_tr_b16 a[52:53], v5 offset:49152
v_mfma_f32_16x16x32_bf16 v[80:83], a[96:99], a[72:75], v[80:83]
s_add_u32 m0, s58, 4096
ds_read_b64_tr_b16 a[54:55], v5 offset:50176
v_mfma_f32_16x16x32_bf16 v[84:87], a[100:103], a[72:75], v[84:87]
s_add_u32 s60, s56, 32768
ds_read_b64_tr_b16 a[56:57], v6 offset:49152
v_mfma_f32_16x16x32_bf16 v[88:91], a[104:107], a[72:75], v[88:91]
buffer_load_dwordx4 v8, s[32:35], s60 offen lds
v_mfma_f32_16x16x32_bf16 v[92:95], a[108:111], a[72:75], v[92:95]
ds_read_b64_tr_b16 a[58:59], v6 offset:50176
v_mfma_f32_16x16x32_bf16 v[96:99], a[72:75], a[112:115], v[96:99]
s_add_u32 m0, s58, 5120
ds_read_b64_tr_b16 a[60:61], v7 offset:49152
v_mfma_f32_16x16x32_bf16 v[100:103], a[72:75], a[116:119], v[100:103]
s_add_u32 s60, s56, 40960
ds_read_b64_tr_b16 a[62:63], v7 offset:50176
v_mfma_f32_16x16x32_bf16 v[104:107], a[72:75], a[120:123], v[104:107]
buffer_load_dwordx4 v9, s[32:35], s60 offen lds
v_mfma_f32_16x16x32_bf16 v[108:111], a[72:75], a[124:127], v[108:111]
ds_read_b128 a[4:7], v2 offset:34816
v_mfma_f32_16x16x32_bf16 v[112:115], a[96:99], a[76:79], v[112:115]
s_add_u32 m0, s58, 6144
ds_read_b128 a[8:11], v2 offset:36864
v_mfma_f32_16x16x32_bf16 v[116:119], a[100:103], a[76:79], v[116:119]
s_add_u32 s60, s56, 49152
ds_read_b128 a[12:15], v2 offset:38912
v_mfma_f32_16x16x32_bf16 v[120:123], a[104:107], a[76:79], v[120:123]
buffer_load_dwordx4 v8, s[32:35], s60 offen lds
v_mfma_f32_16x16x32_bf16 v[124:127], a[108:111], a[76:79], v[124:127]
ds_read_b128 a[16:19], v2 offset:40960
v_mfma_f32_16x16x32_bf16 v[128:131], a[76:79], a[112:115], v[128:131]
s_add_u32 m0, s58, 7168
ds_read_b128 a[20:23], v2 offset:43008
v_mfma_f32_16x16x32_bf16 v[132:135], a[76:79], a[116:119], v[132:135]
s_add_u32 s60, s56, 57344
ds_read_b128 a[24:27], v2 offset:45056
v_mfma_f32_16x16x32_bf16 v[136:139], a[76:79], a[120:123], v[136:139]
buffer_load_dwordx4 v9, s[32:35], s60 offen lds
v_mfma_f32_16x16x32_bf16 v[140:143], a[76:79], a[124:127], v[140:143]
ds_read_b128 a[28:31], v2 offset:47104
v_mfma_f32_16x16x32_bf16 v[144:147], a[96:99], a[80:83], v[144:147]
s_add_u32 m0, s59, 0
v_mfma_f32_16x16x32_bf16 v[148:151], a[100:103], a[80:83], v[148:151]
s_add_u32 s60, s57, 0
v_mfma_f32_16x16x32_bf16 v[152:155], a[104:107], a[80:83], v[152:155]
buffer_load_dwordx4 v10, s[36:39], s60 offen lds
v_mfma_f32_16x16x32_bf16 v[156:159], a[108:111], a[80:83], v[156:159]
v_mfma_f32_16x16x32_bf16 v[160:163], a[80:83], a[112:115], v[160:163]
s_add_u32 m0, s59, 1024
v_mfma_f32_16x16x32_bf16 v[164:167], a[80:83], a[116:119], v[164:167]
s_add_u32 s60, s57, 32768
v_mfma_f32_16x16x32_bf16 v[168:171], a[80:83], a[120:123], v[168:171]
buffer_load_dwordx4 v10, s[36:39], s60 offen lds
v_mfma_f32_16x16x32_bf16 v[172:175], a[80:83], a[124:127], v[172:175]
v_mfma_f32_16x16x32_bf16 v[176:179], a[96:99], a[84:87], v[176:179]
s_add_u32 m0, s59, 2048
v_mfma_f32_16x16x32_bf16 v[180:183], a[100:103], a[84:87], v[180:183]
s_add_u32 s60, s57, 65536
v_mfma_f32_16x16x32_bf16 v[184:187], a[104:107], a[84:87], v[184:187]
buffer_load_dwordx4 v11, s[36:39], s60 offen lds
v_mfma_f32_16x16x32_bf16 v[188:191], a[108:111], a[84:87], v[188:191]
v_mfma_f32_16x16x32_bf16 v[192:195], a[84:87], a[112:115], v[192:195]
s_add_u32 m0, s59, 3072
v_mfma_f32_16x16x32_bf16 v[196:199], a[84:87], a[116:119], v[196:199]
s_add_u32 s60, s57, 98304
v_mfma_f32_16x16x32_bf16 v[200:203], a[84:87], a[120:123], v[200:203]
buffer_load_dwordx4 v11, s[36:39], s60 offen lds
v_mfma_f32_16x16x32_bf16 v[204:207], a[84:87], a[124:127], v[204:207]
v_mfma_f32_16x16x32_bf16 v[208:211], a[96:99], a[88:91], v[208:211]
s_add_u32 m0, s59, 16384
v_mfma_f32_16x16x32_bf16 v[212:215], a[100:103], a[88:91], v[212:215]
s_add_u32 s60, s57, 0
v_mfma_f32_16x16x32_bf16 v[216:219], a[104:107], a[88:91], v[216:219]
buffer_load_dwordx4 v10, s[40:43], s60 offen lds
v_mfma_f32_16x16x32_bf16 v[220:223], a[108:111], a[88:91], v[220:223]
v_mfma_f32_16x16x32_bf16 v[224:227], a[88:91], a[112:115], v[224:227]
s_add_u32 m0, s59, 17408
v_mfma_f32_16x16x32_bf16 v[228:231], a[88:91], a[116:119], v[228:231]
s_add_u32 s60, s57, 32768
v_mfma_f32_16x16x32_bf16 v[232:235], a[88:91], a[120:123], v[232:235]
buffer_load_dwordx4 v10, s[40:43], s60 offen lds
v_mfma_f32_16x16x32_bf16 v[236:239], a[88:91], a[124:127], v[236:239]
v_mfma_f32_16x16x32_bf16 v[240:243], a[96:99], a[92:95], v[240:243]
s_add_u32 m0, s59, 18432
v_mfma_f32_16x16x32_bf16 v[244:247], a[100:103], a[92:95], v[244:247]
s_add_u32 s60, s57, 65536
v_mfma_f32_16x16x32_bf16 v[248:251], a[104:107], a[92:95], v[248:251]
buffer_load_dwordx4 v11, s[40:43], s60 offen lds
v_mfma_f32_16x16x32_bf16 v[252:255], a[108:111], a[92:95], v[252:255]
v_mfma_f32_16x16x32_bf16 a[128:131], a[92:95], a[112:115], a[128:131]
s_add_u32 m0, s59, 19456
v_mfma_f32_16x16x32_bf16 a[132:135], a[92:95], a[116:119], a[132:135]
s_add_u32 s60, s57, 98304
v_mfma_f32_16x16x32_bf16 a[136:139], a[92:95], a[120:123], a[136:139]
buffer_load_dwordx4 v11, s[40:43], s60 offen lds
v_mfma_f32_16x16x32_bf16 a[140:143], a[92:95], a[124:127], a[140:143]
s_waitcnt lgkmcnt(15)
s_add_u32 s56, s56, 128
s_add_u32 s57, s57, 524288
v_mfma_f32_16x16x32_bf16 v[16:19], a[32:35], a[0:3], v[16:19]
s_waitcnt lgkmcnt(15)
ds_read_b128 a[64:67], v3 offset:32768
v_mfma_f32_16x16x32_bf16 v[20:23], a[36:39], a[0:3], v[20:23]
s_waitcnt lgkmcnt(15)
ds_read_b64_tr_b16 a[96:97], v4 offset:40960
v_mfma_f32_16x16x32_bf16 v[24:27], a[40:43], a[0:3], v[24:27]
s_waitcnt lgkmcnt(15)
ds_read_b64_tr_b16 a[98:99], v4 offset:41984
v_mfma_f32_16x16x32_bf16 v[28:31], a[44:47], a[0:3], v[28:31]
s_waitcnt lgkmcnt(15)
ds_read_b64_tr_b16 a[100:101], v5 offset:40960
v_mfma_f32_16x16x32_bf16 v[32:35], a[0:3], a[48:51], v[32:35]
s_waitcnt lgkmcnt(15)
ds_read_b64_tr_b16 a[102:103], v5 offset:41984
v_mfma_f32_16x16x32_bf16 v[36:39], a[0:3], a[52:55], v[36:39]
s_waitcnt lgkmcnt(14)
ds_read_b64_tr_b16 a[104:105], v6 offset:40960
v_mfma_f32_16x16x32_bf16 v[40:43], a[0:3], a[56:59], v[40:43]
s_waitcnt lgkmcnt(13)
ds_read_b64_tr_b16 a[106:107], v6 offset:41984
v_mfma_f32_16x16x32_bf16 v[44:47], a[0:3], a[60:63], v[44:47]
s_waitcnt lgkmcnt(13)
ds_read_b64_tr_b16 a[108:109], v7 offset:40960
v_mfma_f32_16x16x32_bf16 v[48:51], a[32:35], a[4:7], v[48:51]
ds_read_b64_tr_b16 a[110:111], v7 offset:41984
v_mfma_f32_16x16x32_bf16 v[52:55], a[36:39], a[4:7], v[52:55]
ds_read_b64_tr_b16 a[112:113], v4 offset:57344
v_mfma_f32_16x16x32_bf16 v[56:59], a[40:43], a[4:7], v[56:59]
ds_read_b64_tr_b16 a[114:115], v4 offset:58368
v_mfma_f32_16x16x32_bf16 v[60:63], a[44:47], a[4:7], v[60:63]
ds_read_b64_tr_b16 a[116:117], v5 offset:57344
v_mfma_f32_16x16x32_bf16 v[64:67], a[4:7], a[48:51], v[64:67]
ds_read_b64_tr_b16 a[118:119], v5 offset:58368
v_mfma_f32_16x16x32_bf16 v[68:71], a[4:7], a[52:55], v[68:71]
ds_read_b64_tr_b16 a[120:121], v6 offset:57344
v_mfma_f32_16x16x32_bf16 v[72:75], a[4:7], a[56:59], v[72:75]
ds_read_b64_tr_b16 a[122:123], v6 offset:58368
v_mfma_f32_16x16x32_bf16 v[76:79], a[4:7], a[60:63], v[76:79]
s_waitcnt lgkmcnt(15)
ds_read_b64_tr_b16 a[124:125], v7 offset:57344
v_mfma_f32_16x16x32_bf16 v[80:83], a[32:35], a[8:11], v[80:83]
ds_read_b64_tr_b16 a[126:127], v7 offset:58368
v_mfma_f32_16x16x32_bf16 v[84:87], a[36:39], a[8:11], v[84:87]
ds_read_b128 a[68:71], v3 offset:34816
v_mfma_f32_16x16x32_bf16 v[88:91], a[40:43], a[8:11], v[88:91]
ds_read_b128 a[72:75], v3 offset:36864
v_mfma_f32_16x16x32_bf16 v[92:95], a[44:47], a[8:11], v[92:95]
ds_read_b128 a[76:79], v3 offset:38912
v_mfma_f32_16x16x32_bf16 v[96:99], a[8:11], a[48:51], v[96:99]
ds_read_b128 a[80:83], v3 offset:40960
v_mfma_f32_16x16x32_bf16 v[100:103], a[8:11], a[52:55], v[100:103]
ds_read_b128 a[84:87], v3 offset:43008
v_mfma_f32_16x16x32_bf16 v[104:107], a[8:11], a[56:59], v[104:107]
ds_read_b128 a[88:91], v3 offset:45056
v_mfma_f32_16x16x32_bf16 v[108:111], a[8:11], a[60:63], v[108:111]
s_waitcnt lgkmcnt(15)
ds_read_b128 a[92:95], v3 offset:47104
v_mfma_f32_16x16x32_bf16 v[112:115], a[32:35], a[12:15], v[112:115]
v_mfma_f32_16x16x32_bf16 v[116:119], a[36:39], a[12:15], v[116:119]
v_mfma_f32_16x16x32_bf16 v[120:123], a[40:43], a[12:15], v[120:123]
v_mfma_f32_16x16x32_bf16 v[124:127], a[44:47], a[12:15], v[124:127]
v_mfma_f32_16x16x32_bf16 v[128:131], a[12:15], a[48:51], v[128:131]
v_mfma_f32_16x16x32_bf16 v[132:135], a[12:15], a[52:55], v[132:135]
v_mfma_f32_16x16x32_bf16 v[136:139], a[12:15], a[56:59], v[136:139]
v_mfma_f32_16x16x32_bf16 v[140:143], a[12:15], a[60:63], v[140:143]
s_waitcnt lgkmcnt(15)
v_mfma_f32_16x16x32_bf16 v[144:147], a[32:35], a[16:19], v[144:147]
v_mfma_f32_16x16x32_bf16 v[148:151], a[36:39], a[16:19], v[148:151]
v_mfma_f32_16x16x32_bf16 v[152:155], a[40:43], a[16:19], v[152:155]
v_mfma_f32_16x16x32_bf16 v[156:159], a[44:47], a[16:19], v[156:159]
v_mfma_f32_16x16x32_bf16 v[160:163], a[16:19], a[48:51], v[160:163]
v_mfma_f32_16x16x32_bf16 v[164:167], a[16:19], a[52:55], v[164:167]
v_mfma_f32_16x16x32_bf16 v[168:171], a[16:19], a[56:59], v[168:171]
v_mfma_f32_16x16x32_bf16 v[172:175], a[16:19], a[60:63], v[172:175]
s_waitcnt lgkmcnt(15)
v_mfma_f32_16x16x32_bf16 v[176:179], a[32:35], a[20:23], v[176:179]
v_mfma_f32_16x16x32_bf16 v[180:183], a[36:39], a[20:23], v[180:183]
v_mfma_f32_16x16x32_bf16 v[184:187], a[40:43], a[20:23], v[184:187]
v_mfma_f32_16x16x32_bf16 v[188:191], a[44:47], a[20:23], v[188:191]
v_mfma_f32_16x16x32_bf16 v[192:195], a[20:23], a[48:51], v[192:195]
v_mfma_f32_16x16x32_bf16 v[196:199], a[20:23], a[52:55], v[196:199]
v_mfma_f32_16x16x32_bf16 v[200:203], a[20:23], a[56:59], v[200:203]
v_mfma_f32_16x16x32_bf16 v[204:207], a[20:23], a[60:63], v[204:207]
s_waitcnt lgkmcnt(15)
v_mfma_f32_16x16x32_bf16 v[208:211], a[32:35], a[24:27], v[208:211]
v_mfma_f32_16x16x32_bf16 v[212:215], a[36:39], a[24:27], v[212:215]
v_mfma_f32_16x16x32_bf16 v[216:219], a[40:43], a[24:27], v[216:219]
v_mfma_f32_16x16x32_bf16 v[220:223], a[44:47], a[24:27], v[220:223]
v_mfma_f32_16x16x32_bf16 v[224:227], a[24:27], a[48:51], v[224:227]
v_mfma_f32_16x16x32_bf16 v[228:231], a[24:27], a[52:55], v[228:231]
v_mfma_f32_16x16x32_bf16 v[232:235], a[24:27], a[56:59], v[232:235]
v_mfma_f32_16x16x32_bf16 v[236:239], a[24:27], a[60:63], v[236:239]
s_waitcnt lgkmcnt(15)
v_mfma_f32_16x16x32_bf16 v[240:243], a[32:35], a[28:31], v[240:243]
v_mfma_f32_16x16x32_bf16 v[244:247], a[36:39], a[28:31], v[244:247]
v_mfma_f32_16x16x32_bf16 v[248:251], a[40:43], a[28:31], v[248:251]
v_mfma_f32_16x16x32_bf16 v[252:255], a[44:47], a[28:31], v[252:255]
v_mfma_f32_16x16x32_bf16 a[128:131], a[28:31], a[48:51], a[128:131]
v_mfma_f32_16x16x32_bf16 a[132:135], a[28:31], a[52:55], a[132:135]
v_mfma_f32_16x16x32_bf16 a[136:139], a[28:31], a[56:59], a[136:139]
v_mfma_f32_16x16x32_bf16 a[140:143], a[28:31], a[60:63], a[140:143]
s_waitcnt vmcnt(0) lgkmcnt(0)
s_barrier
v_mfma_f32_16x16x32_bf16 v[16:19], a[96:99], a[64:67], v[16:19]
s_add_u32 m0, s58, 32768
ds_read_b128 a[0:3], v2 offset:0
v_mfma_f32_16x16x32_bf16 v[20:23], a[100:103], a[64:67], v[20:23]
s_add_u32 s60, s56, 0
ds_read_b64_tr_b16 a[32:33], v4 offset:0
v_mfma_f32_16x16x32_bf16 v[24:27], a[104:107], a[64:67], v[24:27]
buffer_load_dwordx4 v8, s[32:35], s60 offen lds
v_mfma_f32_16x16x32_bf16 v[28:31], a[108:111], a[64:67], v[28:31]
ds_read_b64_tr_b16 a[34:35], v4 offset:1024
v_mfma_f32_16x16x32_bf16 v[32:35], a[64:67], a[112:115], v[32:35]
s_add_u32 m0, s58, 33792
ds_read_b64_tr_b16 a[36:37], v5 offset:0
v_mfma_f32_16x16x32_bf16 v[36:39], a[64:67], a[116:119], v[36:39]
s_add_u32 s60, s56, 8192
ds_read_b64_tr_b16 a[38:39], v5 offset:1024
v_mfma_f32_16x16x32_bf16 v[40:43], a[64:67], a[120:123], v[40:43]
buffer_load_dwordx4 v9, s[32:35], s60 offen lds
v_mfma_f32_16x16x32_bf16 v[44:47], a[64:67], a[124:127], v[44:47]
ds_read_b64_tr_b16 a[40:41], v6 offset:0
v_mfma_f32_16x16x32_bf16 v[48:51], a[96:99], a[68:71], v[48:51]
s_add_u32 m0, s58, 34816
ds_read_b64_tr_b16 a[42:43], v6 offset:1024
v_mfma_f32_16x16x32_bf16 v[52:55], a[100:103], a[68:71], v[52:55]
s_add_u32 s60, s56, 16384
ds_read_b64_tr_b16 a[44:45], v7 offset:0
v_mfma_f32_16x16x32_bf16 v[56:59], a[104:107], a[68:71], v[56:59]
buffer_load_dwordx4 v8, s[32:35], s60 offen lds
v_mfma_f32_16x16x32_bf16 v[60:63], a[108:111], a[68:71], v[60:63]
ds_read_b64_tr_b16 a[46:47], v7 offset:1024
v_mfma_f32_16x16x32_bf16 v[64:67], a[68:71], a[112:115], v[64:67]
s_add_u32 m0, s58, 35840
ds_read_b64_tr_b16 a[48:49], v4 offset:16384
v_mfma_f32_16x16x32_bf16 v[68:71], a[68:71], a[116:119], v[68:71]
s_add_u32 s60, s56, 24576
ds_read_b64_tr_b16 a[50:51], v4 offset:17408
v_mfma_f32_16x16x32_bf16 v[72:75], a[68:71], a[120:123], v[72:75]
buffer_load_dwordx4 v9, s[32:35], s60 offen lds
v_mfma_f32_16x16x32_bf16 v[76:79], a[68:71], a[124:127], v[76:79]
ds_read_b64_tr_b16 a[52:53], v5 offset:16384
v_mfma_f32_16x16x32_bf16 v[80:83], a[96:99], a[72:75], v[80:83]
s_add_u32 m0, s58, 36864
ds_read_b64_tr_b16 a[54:55], v5 offset:17408
v_mfma_f32_16x16x32_bf16 v[84:87], a[100:103], a[72:75], v[84:87]
s_add_u32 s60, s56, 32768
ds_read_b64_tr_b16 a[56:57], v6 offset:16384
v_mfma_f32_16x16x32_bf16 v[88:91], a[104:107], a[72:75], v[88:91]
buffer_load_dwordx4 v8, s[32:35], s60 offen lds
v_mfma_f32_16x16x32_bf16 v[92:95], a[108:111], a[72:75], v[92:95]
ds_read_b64_tr_b16 a[58:59], v6 offset:17408
v_mfma_f32_16x16x32_bf16 v[96:99], a[72:75], a[112:115], v[96:99]
s_add_u32 m0, s58, 37888
ds_read_b64_tr_b16 a[60:61], v7 offset:16384
v_mfma_f32_16x16x32_bf16 v[100:103], a[72:75], a[116:119], v[100:103]
s_add_u32 s60, s56, 40960
ds_read_b64_tr_b16 a[62:63], v7 offset:17408
v_mfma_f32_16x16x32_bf16 v[104:107], a[72:75], a[120:123], v[104:107]
buffer_load_dwordx4 v9, s[32:35], s60 offen lds
v_mfma_f32_16x16x32_bf16 v[108:111], a[72:75], a[124:127], v[108:111]
ds_read_b128 a[4:7], v2 offset:2048
v_mfma_f32_16x16x32_bf16 v[112:115], a[96:99], a[76:79], v[112:115]
s_add_u32 m0, s58, 38912
ds_read_b128 a[8:11], v2 offset:4096
v_mfma_f32_16x16x32_bf16 v[116:119], a[100:103], a[76:79], v[116:119]
s_add_u32 s60, s56, 49152
ds_read_b128 a[12:15], v2 offset:6144
v_mfma_f32_16x16x32_bf16 v[120:123], a[104:107], a[76:79], v[120:123]
buffer_load_dwordx4 v8, s[32:35], s60 offen lds
v_mfma_f32_16x16x32_bf16 v[124:127], a[108:111], a[76:79], v[124:127]
ds_read_b128 a[16:19], v2 offset:8192
v_mfma_f32_16x16x32_bf16 v[128:131], a[76:79], a[112:115], v[128:131]
s_add_u32 m0, s58, 39936
ds_read_b128 a[20:23], v2 offset:10240
v_mfma_f32_16x16x32_bf16 v[132:135], a[76:79], a[116:119], v[132:135]
s_add_u32 s60, s56, 57344
ds_read_b128 a[24:27], v2 offset:12288
v_mfma_f32_16x16x32_bf16 v[136:139], a[76:79], a[120:123], v[136:139]
buffer_load_dwordx4 v9, s[32:35], s60 offen lds
v_mfma_f32_16x16x32_bf16 v[140:143], a[76:79], a[124:127], v[140:143]
ds_read_b128 a[28:31], v2 offset:14336
v_mfma_f32_16x16x32_bf16 v[144:147], a[96:99], a[80:83], v[144:147]
s_add_u32 m0, s59, 32768
v_mfma_f32_16x16x32_bf16 v[148:151], a[100:103], a[80:83], v[148:151]
s_add_u32 s60, s57, 0
v_mfma_f32_16x16x32_bf16 v[152:155], a[104:107], a[80:83], v[152:155]
buffer_load_dwordx4 v10, s[36:39], s60 offen lds
v_mfma_f32_16x16x32_bf16 v[156:159], a[108:111], a[80:83], v[156:159]
v_mfma_f32_16x16x32_bf16 v[160:163], a[80:83], a[112:115], v[160:163]
s_add_u32 m0, s59, 33792
v_mfma_f32_16x16x32_bf16 v[164:167], a[80:83], a[116:119], v[164:167]
s_add_u32 s60, s57, 32768
v_mfma_f32_16x16x32_bf16 v[168:171], a[80:83], a[120:123], v[168:171]
buffer_load_dwordx4 v10, s[36:39], s60 offen lds
v_mfma_f32_16x16x32_bf16 v[172:175], a[80:83], a[124:127], v[172:175]
v_mfma_f32_16x16x32_bf16 v[176:179], a[96:99], a[84:87], v[176:179]
s_add_u32 m0, s59, 34816
v_mfma_f32_16x16x32_bf16 v[180:183], a[100:103], a[84:87], v[180:183]
s_add_u32 s60, s57, 65536
v_mfma_f32_16x16x32_bf16 v[184:187], a[104:107], a[84:87], v[184:187]
buffer_load_dwordx4 v11, s[36:39], s60 offen lds
v_mfma_f32_16x16x32_bf16 v[188:191], a[108:111], a[84:87], v[188:191]
v_mfma_f32_16x16x32_bf16 v[192:195], a[84:87], a[112:115], v[192:195]
s_add_u32 m0, s59, 35840
v_mfma_f32_16x16x32_bf16 v[196:199], a[84:87], a[116:119], v[196:199]
s_add_u32 s60, s57, 98304
v_mfma_f32_16x16x32_bf16 v[200:203], a[84:87], a[120:123], v[200:203]
buffer_load_dwordx4 v11, s[36:39], s60 offen lds
v_mfma_f32_16x16x32_bf16 v[204:207], a[84:87], a[124:127], v[204:207]
v_mfma_f32_16x16x32_bf16 v[208:211], a[96:99], a[88:91], v[208:211]
s_add_u32 m0, s59, 49152
v_mfma_f32_16x16x32_bf16 v[212:215], a[100:103], a[88:91], v[212:215]
s_add_u32 s60, s57, 0
v_mfma_f32_16x16x32_bf16 v[216:219], a[104:107], a[88:91], v[216:219]
buffer_load_dwordx4 v10, s[40:43], s60 offen lds
v_mfma_f32_16x16x32_bf16 v[220:223], a[108:111], a[88:91], v[220:223]
v_mfma_f32_16x16x32_bf16 v[224:227], a[88:91], a[112:115], v[224:227]
s_add_u32 m0, s59, 50176
v_mfma_f32_16x16x32_bf16 v[228:231], a[88:91], a[116:119], v[228:231]
s_add_u32 s60, s57, 32768
v_mfma_f32_16x16x32_bf16 v[232:235], a[88:91], a[120:123], v[232:235]
buffer_load_dwordx4 v10, s[40:43], s60 offen lds
v_mfma_f32_16x16x32_bf16 v[236:239], a[88:91], a[124:127], v[236:239]
v_mfma_f32_16x16x32_bf16 v[240:243], a[96:99], a[92:95], v[240:243]
s_add_u32 m0, s59, 51200
v_mfma_f32_16x16x32_bf16 v[244:247], a[100:103], a[92:95], v[244:247]
s_add_u32 s60, s57, 65536
v_mfma_f32_16x16x32_bf16 v[248:251], a[104:107], a[92:95], v[248:251]
buffer_load_dwordx4 v11, s[40:43], s60 offen lds
v_mfma_f32_16x16x32_bf16 v[252:255], a[108:111], a[92:95], v[252:255]
v_mfma_f32_16x16x32_bf16 a[128:131], a[92:95], a[112:115], a[128:131]
s_add_u32 m0, s59, 52224
v_mfma_f32_16x16x32_bf16 a[132:135], a[92:95], a[116:119], a[132:135]
s_add_u32 s60, s57, 98304
v_mfma_f32_16x16x32_bf16 a[136:139], a[92:95], a[120:123], a[136:139]
buffer_load_dwordx4 v11, s[40:43], s60 offen lds
v_mfma_f32_16x16x32_bf16 a[140:143], a[92:95], a[124:127], a[140:143]
s_add_u32 s56, s56, 128
s_add_u32 s57, s57, 524288
s_sub_u32 s61, s61, 1
s_cmp_lg_u32 s61, 0
s_cbranch_scc1 L_p1_2
s_waitcnt lgkmcnt(15)
v_mfma_f32_16x16x32_bf16 v[16:19], a[32:35], a[0:3], v[16:19]
s_waitcnt lgkmcnt(15)
ds_read_b128 a[64:67], v3 offset:0
v_mfma_f32_16x16x32_bf16 v[20:23], a[36:39], a[0:3], v[20:23]
s_waitcnt lgkmcnt(15)
ds_read_b64_tr_b16 a[96:97], v4 offset:8192
v_mfma_f32_16x16x32_bf16 v[24:27], a[40:43], a[0:3], v[24:27]
s_waitcnt lgkmcnt(15)
ds_read_b64_tr_b16 a[98:99], v4 offset:9216
v_mfma_f32_16x16x32_bf16 v[28:31], a[44:47], a[0:3], v[28:31]
s_waitcnt lgkmcnt(15)
ds_read_b64_tr_b16 a[100:101], v5 offset:8192
v_mfma_f32_16x16x32_bf16 v[32:35], a[0:3], a[48:51], v[32:35]
s_waitcnt lgkmcnt(15)
ds_read_b64_tr_b16 a[102:103], v5 offset:9216
v_mfma_f32_16x16x32_bf16 v[36:39], a[0:3], a[52:55], v[36:39]
s_waitcnt lgkmcnt(14)
ds_read_b64_tr_b16 a[104:105], v6 offset:8192
v_mfma_f32_16x16x32_bf16 v[40:43], a[0:3], a[56:59], v[40:43]
s_waitcnt lgkmcnt(13)
ds_read_b64_tr_b16 a[106:107], v6 offset:9216
v_mfma_f32_16x16x32_bf16 v[44:47], a[0:3], a[60:63], v[44:47]
s_waitcnt lgkmcnt(13)
ds_read_b64_tr_b16 a[108:109], v7 offset:8192
v_mfma_f32_16x16x32_bf16 v[48:51], a[32:35], a[4:7], v[48:51]
ds_read_b64_tr_b16 a[110:111], v7 offset:9216
v_mfma_f32_16x16x32_bf16 v[52:55], a[36:39], a[4:7], v[52:55]
ds_read_b64_tr_b16 a[112:113], v4 offset:24576
v_mfma_f32_16x16x32_bf16 v[56:59], a[40:43], a[4:7], v[56:59]
ds_read_b64_tr_b16 a[114:115], v4 offset:25600
v_mfma_f32_16x16x32_bf16 v[60:63], a[44:47], a[4:7], v[60:63]
ds_read_b64_tr_b16 a[116:117], v5 offset:24576
v_mfma_f32_16x16x32_bf16 v[64:67], a[4:7], a[48:51], v[64:67]
ds_read_b64_tr_b16 a[118:119], v5 offset:25600
v_mfma_f32_16x16x32_bf16 v[68:71], a[4:7], a[52:55], v[68:71]
ds_read_b64_tr_b16 a[120:121], v6 offset:24576
v_mfma_f32_16x16x32_bf16 v[72:75], a[4:7], a[56:59], v[72:75]
ds_read_b64_tr_b16 a[122:123], v6 offset:25600
v_mfma_f32_16x16x32_bf16 v[76:79], a[4:7], a[60:63], v[76:79]
s_waitcnt lgkmcnt(15)
ds_read_b64_tr_b16 a[124:125], v7 offset:24576
v_mfma_f32_16x16x32_bf16 v[80:83], a[32:35], a[8:11], v[80:83]
ds_read_b64_tr_b16 a[126:127], v7 offset:25600
v_mfma_f32_16x16x32_bf16 v[84:87], a[36:39], a[8:11], v[84:87]
ds_read_b128 a[68:71], v3 offset:2048
v_mfma_f32_16x16x32_bf16 v[88:91], a[40:43], a[8:11], v[88:91]
ds_read_b128 a[72:75], v3 offset:4096
v_mfma_f32_16x16x32_bf16 v[92:95], a[44:47], a[8:11], v[92:95]
ds_read_b128 a[76:79], v3 offset:6144
v_mfma_f32_16x16x32_bf16 v[96:99], a[8:11], a[48:51], v[96:99]
ds_read_b128 a[80:83], v3 offset:8192
v_mfma_f32_16x16x32_bf16 v[100:103], a[8:11], a[52:55], v[100:103]
ds_read_b128 a[84:87], v3 offset:10240
v_mfma_f32_16x16x32_bf16 v[104:107], a[8:11], a[56:59], v[104:107]
ds_read_b128 a[88:91], v3 offset:12288
v_mfma_f32_16x16x32_bf16 v[108:111], a[8:11], a[60:63], v[108:111]
s_waitcnt lgkmcnt(15)
ds_read_b128 a[92:95], v3 offset:14336
v_mfma_f32_16x16x32_bf16 v[112:115], a[32:35], a[12:15], v[112:115]
v_mfma_f32_16x16x32_bf16 v[116:119], a[36:39], a[12:15], v[116:119]
v_mfma_f32_16x16x32_bf16 v[120:123], a[40:43], a[12:15], v[120:123]
v_mfma_f32_16x16x32_bf16 v[124:127], a[44:47], a[12:15], v[124:127]
v_mfma_f32_16x16x32_bf16 v[128:131], a[12:15], a[48:51], v[128:131]
v_mfma_f32_16x16x32_bf16 v[132:135], a[12:15], a[52:55], v[132:135]
v_mfma_f32_16x16x32_bf16 v[136:139], a[12:15], a[56:59], v[136:139]
v_mfma_f32_16x16x32_bf16 v[140:143], a[12:15], a[60:63], v[140:143]
s_waitcnt lgkmcnt(15)
v_mfma_f32_16x16x32_bf16 v[144:147], a[32:35], a[16:19], v[144:147]
v_mfma_f32_16x16x32_bf16 v[148:151], a[36:39], a[16:19], v[148:151]
v_mfma_f32_16x16x32_bf16 v[152:155], a[40:43], a[16:19], v[152:155]
v_mfma_f32_16x16x32_bf16 v[156:159], a[44:47], a[16:19], v[156:159]
v_mfma_f32_16x16x32_bf16 v[160:163], a[16:19], a[48:51], v[160:163]
v_mfma_f32_16x16x32_bf16 v[164:167], a[16:19], a[52:55], v[164:167]
v_mfma_f32_16x16x32_bf16 v[168:171], a[16:19], a[56:59], v[168:171]
v_mfma_f32_16x16x32_bf16 v[172:175], a[16:19], a[60:63], v[172:175]
s_waitcnt lgkmcnt(15)
v_mfma_f32_16x16x32_bf16 v[176:179], a[32:35], a[20:23], v[176:179]
v_mfma_f32_16x16x32_bf16 v[180:183], a[36:39], a[20:23], v[180:183]
v_mfma_f32_16x16x32_bf16 v[184:187], a[40:43], a[20:23], v[184:187]
v_mfma_f32_16x16x32_bf16 v[188:191], a[44:47], a[20:23], v[188:191]
v_mfma_f32_16x16x32_bf16 v[192:195], a[20:23], a[48:51], v[192:195]
v_mfma_f32_16x16x32_bf16 v[196:199], a[20:23], a[52:55], v[196:199]
v_mfma_f32_16x16x32_bf16 v[200:203], a[20:23], a[56:59], v[200:203]
v_mfma_f32_16x16x32_bf16 v[204:207], a[20:23], a[60:63], v[204:207]
s_waitcnt lgkmcnt(15)
v_mfma_f32_16x16x32_bf16 v[208:211], a[32:35], a[24:27], v[208:211]
v_mfma_f32_16x16x32_bf16 v[212:215], a[36:39], a[24:27], v[212:215]
v_mfma_f32_16x16x32_bf16 v[216:219], a[40:43], a[24:27], v[216:219]
v_mfma_f32_16x16x32_bf16 v[220:223], a[44:47], a[24:27], v[220:223]
v_mfma_f32_16x16x32_bf16 v[224:227], a[24:27], a[48:51], v[224:227]
v_mfma_f32_16x16x32_bf16 v[228:231], a[24:27], a[52:55], v[228:231]
v_mfma_f32_16x16x32_bf16 v[232:235], a[24:27], a[56:59], v[232:235]
v_mfma_f32_16x16x32_bf16 v[236:239], a[24:27], a[60:63], v[236:239]
s_waitcnt lgkmcnt(15)
v_mfma_f32_16x16x32_bf16 v[240:243], a[32:35], a[28:31], v[240:243]
v_mfma_f32_16x16x32_bf16 v[244:247], a[36:39], a[28:31], v[244:247]
v_mfma_f32_16x16x32_bf16 v[248:251], a[40:43], a[28:31], v[248:251]
v_mfma_f32_16x16x32_bf16 v[252:255], a[44:47], a[28:31], v[252:255]
v_mfma_f32_16x16x32_bf16 a[128:131], a[28:31], a[48:51], a[128:131]
v_mfma_f32_16x16x32_bf16 a[132:135], a[28:31], a[52:55], a[132:135]
v_mfma_f32_16x16x32_bf16 a[136:139], a[28:31], a[56:59], a[136:139]
v_mfma_f32_16x16x32_bf16 a[140:143], a[28:31], a[60:63], a[140:143]
s_waitcnt vmcnt(0) lgkmcnt(0)
s_barrier
v_mfma_f32_16x16x32_bf16 v[16:19], a[96:99], a[64:67], v[16:19]
ds_read_b128 a[0:3], v2 offset:32768
v_mfma_f32_16x16x32_bf16 v[20:23], a[100:103], a[64:67], v[20:23]
ds_read_b64_tr_b16 a[32:33], v4 offset:32768
v_mfma_f32_16x16x32_bf16 v[24:27], a[104:107], a[64:67], v[24:27]
ds_read_b64_tr_b16 a[34:35], v4 offset:33792
v_mfma_f32_16x16x32_bf16 v[28:31], a[108:111], a[64:67], v[28:31]
ds_read_b64_tr_b16 a[36:37], v5 offset:32768
v_mfma_f32_16x16x32_bf16 v[32:35], a[64:67], a[112:115], v[32:35]
ds_read_b64_tr_b16 a[38:39], v5 offset:33792
v_mfma_f32_16x16x32_bf16 v[36:39], a[64:67], a[116:119], v[36:39]
ds_read_b64_tr_b16 a[40:41], v6 offset:32768
v_mfma_f32_16x16x32_bf16 v[40:43], a[64:67], a[120:123], v[40:43]
ds_read_b64_tr_b16 a[42:43], v6 offset:33792
v_mfma_f32_16x16x32_bf16 v[44:47], a[64:67], a[124:127], v[44:47]
ds_read_b64_tr_b16 a[44:45], v7 offset:32768
v_mfma_f32_16x16x32_bf16 v[48:51], a[96:99], a[68:71], v[48:51]
ds_read_b64_tr_b16 a[46:47], v7 offset:33792
v_mfma_f32_16x16x32_bf16 v[52:55], a[100:103], a[68:71], v[52:55]
ds_read_b64_tr_b16 a[48:49], v4 offset:49152
v_mfma_f32_16x16x32_bf16 v[56:59], a[104:107], a[68:71], v[56:59]
ds_read_b64_tr_b16 a[50:51], v4 offset:50176
v_mfma_f32_16x16x32_bf16 v[60:63], a[108:111], a[68:71], v[60:63]
ds_read_b64_tr_b16 a[52:53], v5 offset:49152
v_mfma_f32_16x16x32_bf16 v[64:67], a[68:71], a[112:115], v[64:67]
ds_read_b64_tr_b16 a[54:55], v5 offset:50176
v_mfma_f32_16x16x32_bf16 v[68:71], a[68:71], a[116:119], v[68:71]
ds_read_b64_tr_b16 a[56:57], v6 offset:49152
v_mfma_f32_16x16x32_bf16 v[72:75], a[68:71], a[120:123], v[72:75]
ds_read_b64_tr_b16 a[58:59], v6 offset:50176
v_mfma_f32_16x16x32_bf16 v[76:79], a[68:71], a[124:127], v[76:79]
ds_read_b64_tr_b16 a[60:61], v7 offset:49152
v_mfma_f32_16x16x32_bf16 v[80:83], a[96:99], a[72:75], v[80:83]
ds_read_b64_tr_b16 a[62:63], v7 offset:50176
v_mfma_f32_16x16x32_bf16 v[84:87], a[100:103], a[72:75], v[84:87]
ds_read_b128 a[4:7], v2 offset:34816
v_mfma_f32_16x16x32_bf16 v[88:91], a[104:107], a[72:75], v[88:91]
ds_read_b128 a[8:11], v2 offset:36864
v_mfma_f32_16x16x32_bf16 v[92:95], a[108:111], a[72:75], v[92:95]
ds_read_b128 a[12:15], v2 offset:38912
v_mfma_f32_16x16x32_bf16 v[96:99], a[72:75], a[112:115], v[96:99]
ds_read_b128 a[16:19], v2 offset:40960
v_mfma_f32_16x16x32_bf16 v[100:103], a[72:75], a[116:119], v[100:103]
ds_read_b128 a[20:23], v2 offset:43008
v_mfma_f32_16x16x32_bf16 v[104:107], a[72:75], a[120:123], v[104:107]
ds_read_b128 a[24:27], v2 offset:45056
v_mfma_f32_16x16x32_bf16 v[108:111], a[72:75], a[124:127], v[108:111]
ds_read_b128 a[28:31], v2 offset:47104
v_mfma_f32_16x16x32_bf16 v[112:115], a[96:99], a[76:79], v[112:115]
v_mfma_f32_16x16x32_bf16 v[116:119], a[100:103], a[76:79], v[116:119]
v_mfma_f32_16x16x32_bf16 v[120:123], a[104:107], a[76:79], v[120:123]
v_mfma_f32_16x16x32_bf16 v[124:127], a[108:111], a[76:79], v[124:127]
v_mfma_f32_16x16x32_bf16 v[128:131], a[76:79], a[112:115], v[128:131]
v_mfma_f32_16x16x32_bf16 v[132:135], a[76:79], a[116:119], v[132:135]
v_mfma_f32_16x16x32_bf16 v[136:139], a[76:79], a[120:123], v[136:139]
v_mfma_f32_16x16x32_bf16 v[140:143], a[76:79], a[124:127], v[140:143]
v_mfma_f32_16x16x32_bf16 v[144:147], a[96:99], a[80:83], v[144:147]
v_mfma_f32_16x16x32_bf16 v[148:151], a[100:103], a[80:83], v[148:151]
v_mfma_f32_16x16x32_bf16 v[152:155], a[104:107], a[80:83], v[152:155]
v_mfma_f32_16x16x32_bf16 v[156:159], a[108:111], a[80:83], v[156:159]
v_mfma_f32_16x16x32_bf16 v[160:163], a[80:83], a[112:115], v[160:163]
v_mfma_f32_16x16x32_bf16 v[164:167], a[80:83], a[116:119], v[164:167]
v_mfma_f32_16x16x32_bf16 v[168:171], a[80:83], a[120:123], v[168:171]
v_mfma_f32_16x16x32_bf16 v[172:175], a[80:83], a[124:127], v[172:175]
v_mfma_f32_16x16x32_bf16 v[176:179], a[96:99], a[84:87], v[176:179]
v_mfma_f32_16x16x32_bf16 v[180:183], a[100:103], a[84:87], v[180:183]
v_mfma_f32_16x16x32_bf16 v[184:187], a[104:107], a[84:87], v[184:187]
v_mfma_f32_16x16x32_bf16 v[188:191], a[108:111], a[84:87], v[188:191]
v_mfma_f32_16x16x32_bf16 v[192:195], a[84:87], a[112:115], v[192:195]
v_mfma_f32_16x16x32_bf16 v[196:199], a[84:87], a[116:119], v[196:199]
v_mfma_f32_16x16x32_bf16 v[200:203], a[84:87], a[120:123], v[200:203]
v_mfma_f32_16x16x32_bf16 v[204:207], a[84:87], a[124:127], v[204:207]
v_mfma_f32_16x16x32_bf16 v[208:211], a[96:99], a[88:91], v[208:211]
v_mfma_f32_16x16x32_bf16 v[212:215], a[100:103], a[88:91], v[212:215]
v_mfma_f32_16x16x32_bf16 v[216:219], a[104:107], a[88:91], v[216:219]
v_mfma_f32_16x16x32_bf16 v[220:223], a[108:111], a[88:91], v[220:223]
v_mfma_f32_16x16x32_bf16 v[224:227], a[88:91], a[112:115], v[224:227]
v_mfma_f32_16x16x32_bf16 v[228:231], a[88:91], a[116:119], v[228:231]
v_mfma_f32_16x16x32_bf16 v[232:235], a[88:91], a[120:123], v[232:235]
v_mfma_f32_16x16x32_bf16 v[236:239], a[88:91], a[124:127], v[236:239]
v_mfma_f32_16x16x32_bf16 v[240:243], a[96:99], a[92:95], v[240:243]
v_mfma_f32_16x16x32_bf16 v[244:247], a[100:103], a[92:95], v[244:247]
v_mfma_f32_16x16x32_bf16 v[248:251], a[104:107], a[92:95], v[248:251]
v_mfma_f32_16x16x32_bf16 v[252:255], a[108:111], a[92:95], v[252:255]
v_mfma_f32_16x16x32_bf16 a[128:131], a[92:95], a[112:115], a[128:131]
v_mfma_f32_16x16x32_bf16 a[132:135], a[92:95], a[116:119], a[132:135]
v_mfma_f32_16x16x32_bf16 a[136:139], a[92:95], a[120:123], a[136:139]
v_mfma_f32_16x16x32_bf16 a[140:143], a[92:95], a[124:127], a[140:143]
s_waitcnt lgkmcnt(15)
v_mfma_f32_16x16x32_bf16 v[16:19], a[32:35], a[0:3], v[16:19]
s_waitcnt lgkmcnt(15)
ds_read_b128 a[64:67], v3 offset:32768
v_mfma_f32_16x16x32_bf16 v[20:23], a[36:39], a[0:3], v[20:23]
s_waitcnt lgkmcnt(15)
ds_read_b64_tr_b16 a[96:97], v4 offset:40960
v_mfma_f32_16x16x32_bf16 v[24:27], a[40:43], a[0:3], v[24:27]
s_waitcnt lgkmcnt(15)
ds_read_b64_tr_b16 a[98:99], v4 offset:41984
v_mfma_f32_16x16x32_bf16 v[28:31], a[44:47], a[0:3], v[28:31]
s_waitcnt lgkmcnt(15)
ds_read_b64_tr_b16 a[100:101], v5 offset:40960
v_mfma_f32_16x16x32_bf16 v[32:35], a[0:3], a[48:51], v[32:35]
s_waitcnt lgkmcnt(15)
ds_read_b64_tr_b16 a[102:103], v5 offset:41984
v_mfma_f32_16x16x32_bf16 v[36:39], a[0:3], a[52:55], v[36:39]
s_waitcnt lgkmcnt(14)
ds_read_b64_tr_b16 a[104:105], v6 offset:40960
v_mfma_f32_16x16x32_bf16 v[40:43], a[0:3], a[56:59], v[40:43]
s_waitcnt lgkmcnt(13)
ds_read_b64_tr_b16 a[106:107], v6 offset:41984
v_mfma_f32_16x16x32_bf16 v[44:47], a[0:3], a[60:63], v[44:47]
s_waitcnt lgkmcnt(13)
ds_read_b64_tr_b16 a[108:109], v7 offset:40960
v_mfma_f32_16x16x32_bf16 v[48:51], a[32:35], a[4:7], v[48:51]
ds_read_b64_tr_b16 a[110:111], v7 offset:41984
v_mfma_f32_16x16x32_bf16 v[52:55], a[36:39], a[4:7], v[52:55]
ds_read_b64_tr_b16 a[112:113], v4 offset:57344
v_mfma_f32_16x16x32_bf16 v[56:59], a[40:43], a[4:7], v[56:59]
ds_read_b64_tr_b16 a[114:115], v4 offset:58368
v_mfma_f32_16x16x32_bf16 v[60:63], a[44:47], a[4:7], v[60:63]
ds_read_b64_tr_b16 a[116:117], v5 offset:57344
v_mfma_f32_16x16x32_bf16 v[64:67], a[4:7], a[48:51], v[64:67]
ds_read_b64_tr_b16 a[118:119], v5 offset:58368
v_mfma_f32_16x16x32_bf16 v[68:71], a[4:7], a[52:55], v[68:71]
ds_read_b64_tr_b16 a[120:121], v6 offset:57344
v_mfma_f32_16x16x32_bf16 v[72:75], a[4:7], a[56:59], v[72:75]
ds_read_b64_tr_b16 a[122:123], v6 offset:58368
v_mfma_f32_16x16x32_bf16 v[76:79], a[4:7], a[60:63], v[76:79]
s_waitcnt lgkmcnt(15)
ds_read_b64_tr_b16 a[124:125], v7 offset:57344
v_mfma_f32_16x16x32_bf16 v[80:83], a[32:35], a[8:11], v[80:83]
ds_read_b64_tr_b16 a[126:127], v7 offset:58368
v_mfma_f32_16x16x32_bf16 v[84:87], a[36:39], a[8:11], v[84:87]
ds_read_b128 a[68:71], v3 offset:34816
v_mfma_f32_16x16x32_bf16 v[88:91], a[40:43], a[8:11], v[88:91]
ds_read_b128 a[72:75], v3 offset:36864
v_mfma_f32_16x16x32_bf16 v[92:95], a[44:47], a[8:11], v[92:95]
ds_read_b128 a[76:79], v3 offset:38912
v_mfma_f32_16x16x32_bf16 v[96:99], a[8:11], a[48:51], v[96:99]
ds_read_b128 a[80:83], v3 offset:40960
v_mfma_f32_16x16x32_bf16 v[100:103], a[8:11], a[52:55], v[100:103]
ds_read_b128 a[84:87], v3 offset:43008
v_mfma_f32_16x16x32_bf16 v[104:107], a[8:11], a[56:59], v[104:107]
ds_read_b128 a[88:91], v3 offset:45056
v_mfma_f32_16x16x32_bf16 v[108:111], a[8:11], a[60:63], v[108:111]
s_waitcnt lgkmcnt(15)
ds_read_b128 a[92:95], v3 offset:47104
v_mfma_f32_16x16x32_bf16 v[112:115], a[32:35], a[12:15], v[112:115]
v_mfma_f32_16x16x32_bf16 v[116:119], a[36:39], a[12:15], v[116:119]
v_mfma_f32_16x16x32_bf16 v[120:123], a[40:43], a[12:15], v[120:123]
v_mfma_f32_16x16x32_bf16 v[124:127], a[44:47], a[12:15], v[124:127]
v_mfma_f32_16x16x32_bf16 v[128:131], a[12:15], a[48:51], v[128:131]
v_mfma_f32_16x16x32_bf16 v[132:135], a[12:15], a[52:55], v[132:135]
v_mfma_f32_16x16x32_bf16 v[136:139], a[12:15], a[56:59], v[136:139]
v_mfma_f32_16x16x32_bf16 v[140:143], a[12:15], a[60:63], v[140:143]
s_waitcnt lgkmcnt(15)
v_mfma_f32_16x16x32_bf16 v[144:147], a[32:35], a[16:19], v[144:147]
v_mfma_f32_16x16x32_bf16 v[148:151], a[36:39], a[16:19], v[148:151]
v_mfma_f32_16x16x32_bf16 v[152:155], a[40:43], a[16:19], v[152:155]
v_mfma_f32_16x16x32_bf16 v[156:159], a[44:47], a[16:19], v[156:159]
v_mfma_f32_16x16x32_bf16 v[160:163], a[16:19], a[48:51], v[160:163]
v_mfma_f32_16x16x32_bf16 v[164:167], a[16:19], a[52:55], v[164:167]
v_mfma_f32_16x16x32_bf16 v[168:171], a[16:19], a[56:59], v[168:171]
v_mfma_f32_16x16x32_bf16 v[172:175], a[16:19], a[60:63], v[172:175]
s_waitcnt lgkmcnt(15)
v_mfma_f32_16x16x32_bf16 v[176:179], a[32:35], a[20:23], v[176:179]
v_mfma_f32_16x16x32_bf16 v[180:183], a[36:39], a[20:23], v[180:183]
v_mfma_f32_16x16x32_bf16 v[184:187], a[40:43], a[20:23], v[184:187]
v_mfma_f32_16x16x32_bf16 v[188:191], a[44:47], a[20:23], v[188:191]
v_mfma_f32_16x16x32_bf16 v[192:195], a[20:23], a[48:51], v[192:195]
v_mfma_f32_16x16x32_bf16 v[196:199], a[20:23], a[52:55], v[196:199]
v_mfma_f32_16x16x32_bf16 v[200:203], a[20:23], a[56:59], v[200:203]
v_mfma_f32_16x16x32_bf16 v[204:207], a[20:23], a[60:63], v[204:207]
s_waitcnt lgkmcnt(15)
v_mfma_f32_16x16x32_bf16 v[208:211], a[32:35], a[24:27], v[208:211]
v_mfma_f32_16x16x32_bf16 v[212:215], a[36:39], a[24:27], v[212:215]
v_mfma_f32_16x16x32_bf16 v[216:219], a[40:43], a[24:27], v[216:219]
v_mfma_f32_16x16x32_bf16 v[220:223], a[44:47], a[24:27], v[220:223]
v_mfma_f32_16x16x32_bf16 v[224:227], a[24:27], a[48:51], v[224:227]
v_mfma_f32_16x16x32_bf16 v[228:231], a[24:27], a[52:55], v[228:231]
v_mfma_f32_16x16x32_bf16 v[232:235], a[24:27], a[56:59], v[232:235]
v_mfma_f32_16x16x32_bf16 v[236:239], a[24:27], a[60:63], v[236:239]
s_waitcnt lgkmcnt(15)
v_mfma_f32_16x16x32_bf16 v[240:243], a[32:35], a[28:31], v[240:243]
v_mfma_f32_16x16x32_bf16 v[244:247], a[36:39], a[28:31], v[244:247]
v_mfma_f32_16x16x32_bf16 v[248:251], a[40:43], a[28:31], v[248:251]
v_mfma_f32_16x16x32_bf16 v[252:255], a[44:47], a[28:31], v[252:255]
v_mfma_f32_16x16x32_bf16 a[128:131], a[28:31], a[48:51], a[128:131]
v_mfma_f32_16x16x32_bf16 a[132:135], a[28:31], a[52:55], a[132:135]
v_mfma_f32_16x16x32_bf16 a[136:139], a[28:31], a[56:59], a[136:139]
v_mfma_f32_16x16x32_bf16 a[140:143], a[28:31], a[60:63], a[140:143]
s_waitcnt lgkmcnt(15)
v_mfma_f32_16x16x32_bf16 v[16:19], a[96:99], a[64:67], v[16:19]
s_waitcnt lgkmcnt(15)
v_mfma_f32_16x16x32_bf16 v[20:23], a[100:103], a[64:67], v[20:23]
s_waitcnt lgkmcnt(15)
v_mfma_f32_16x16x32_bf16 v[24:27], a[104:107], a[64:67], v[24:27]
s_waitcnt lgkmcnt(15)
v_mfma_f32_16x16x32_bf16 v[28:31], a[108:111], a[64:67], v[28:31]
s_waitcnt lgkmcnt(13)
v_mfma_f32_16x16x32_bf16 v[32:35], a[64:67], a[112:115], v[32:35]
s_waitcnt lgkmcnt(11)
v_mfma_f32_16x16x32_bf16 v[36:39], a[64:67], a[116:119], v[36:39]
s_waitcnt lgkmcnt(9)
v_mfma_f32_16x16x32_bf16 v[40:43], a[64:67], a[120:123], v[40:43]
s_waitcnt lgkmcnt(7)
v_mfma_f32_16x16x32_bf16 v[44:47], a[64:67], a[124:127], v[44:47]
s_waitcnt lgkmcnt(6)
v_mfma_f32_16x16x32_bf16 v[48:51], a[96:99], a[68:71], v[48:51]
v_mfma_f32_16x16x32_bf16 v[52:55], a[100:103], a[68:71], v[52:55]
v_mfma_f32_16x16x32_bf16 v[56:59], a[104:107], a[68:71], v[56:59]
v_mfma_f32_16x16x32_bf16 v[60:63], a[108:111], a[68:71], v[60:63]
v_mfma_f32_16x16x32_bf16 v[64:67], a[68:71], a[112:115], v[64:67]
v_mfma_f32_16x16x32_bf16 v[68:71], a[68:71], a[116:119], v[68:71]
v_mfma_f32_16x16x32_bf16 v[72:75], a[68:71], a[120:123], v[72:75]
v_mfma_f32_16x16x32_bf16 v[76:79], a[68:71], a[124:127], v[76:79]
s_waitcnt lgkmcnt(5)
v_mfma_f32_16x16x32_bf16 v[80:83], a[96:99], a[72:75], v[80:83]
v_mfma_f32_16x16x32_bf16 v[84:87], a[100:103], a[72:75], v[84:87]
v_mfma_f32_16x16x32_bf16 v[88:91], a[104:107], a[72:75], v[88:91]
v_mfma_f32_16x16x32_bf16 v[92:95], a[108:111], a[72:75], v[92:95]
v_mfma_f32_16x16x32_bf16 v[96:99], a[72:75], a[112:115], v[96:99]
v_mfma_f32_16x16x32_bf16 v[100:103], a[72:75], a[116:119], v[100:103]
v_mfma_f32_16x16x32_bf16 v[104:107], a[72:75], a[120:123], v[104:107]
v_mfma_f32_16x16x32_bf16 v[108:111], a[72:75], a[124:127], v[108:111]
s_waitcnt lgkmcnt(4)
v_mfma_f32_16x16x32_bf16 v[112:115], a[96:99], a[76:79], v[112:115]
v_mfma_f32_16x16x32_bf16 v[116:119], a[100:103], a[76:79], v[116:119]
v_mfma_f32_16x16x32_bf16 v[120:123], a[104:107], a[76:79], v[120:123]
v_mfma_f32_16x16x32_bf16 v[124:127], a[108:111], a[76:79], v[124:127]
v_mfma_f32_16x16x32_bf16 v[128:131], a[76:79], a[112:115], v[128:131]
v_mfma_f32_16x16x32_bf16 v[132:135], a[76:79], a[116:119], v[132:135]
v_mfma_f32_16x16x32_bf16 v[136:139], a[76:79], a[120:123], v[136:139]
v_mfma_f32_16x16x32_bf16 v[140:143], a[76:79], a[124:127], v[140:143]
s_waitcnt lgkmcnt(3)
v_mfma_f32_16x16x32_bf16 v[144:147], a[96:99], a[80:83], v[144:147]
v_mfma_f32_16x16x32_bf16 v[148:151], a[100:103], a[80:83], v[148:151]
v_mfma_f32_16x16x32_bf16 v[152:155], a[104:107], a[80:83], v[152:155]
v_mfma_f32_16x16x32_bf16 v[156:159], a[108:111], a[80:83], v[156:159]
v_mfma_f32_16x16x32_bf16 v[160:163], a[80:83], a[112:115], v[160:163]
v_mfma_f32_16x16x32_bf16 v[164:167], a[80:83], a[116:119], v[164:167]
v_mfma_f32_16x16x32_bf16 v[168:171], a[80:83], a[120:123], v[168:171]
v_mfma_f32_16x16x32_bf16 v[172:175], a[80:83], a[124:127], v[172:175]
s_waitcnt lgkmcnt(2)
v_mfma_f32_16x16x32_bf16 v[176:179], a[96:99], a[84:87], v[176:179]
v_mfma_f32_16x16x32_bf16 v[180:183], a[100:103], a[84:87], v[180:183]
v_mfma_f32_16x16x32_bf16 v[184:187], a[104:107], a[84:87], v[184:187]
v_mfma_f32_16x16x32_bf16 v[188:191], a[108:111], a[84:87], v[188:191]
v_mfma_f32_16x16x32_bf16 v[192:195], a[84:87], a[112:115], v[192:195]
v_mfma_f32_16x16x32_bf16 v[196:199], a[84:87], a[116:119], v[196:199]
v_mfma_f32_16x16x32_bf16 v[200:203], a[84:87], a[120:123], v[200:203]
v_mfma_f32_16x16x32_bf16 v[204:207], a[84:87], a[124:127], v[204:207]
s_waitcnt lgkmcnt(1)
v_mfma_f32_16x16x32_bf16 v[208:211], a[96:99], a[88:91], v[208:211]
v_mfma_f32_16x16x32_bf16 v[212:215], a[100:103], a[88:91], v[212:215]
v_mfma_f32_16x16x32_bf16 v[216:219], a[104:107], a[88:91], v[216:219]
v_mfma_f32_16x16x32_bf16 v[220:223], a[108:111], a[88:91], v[220:223]
v_mfma_f32_16x16x32_bf16 v[224:227], a[88:91], a[112:115], v[224:227]
v_mfma_f32_16x16x32_bf16 v[228:231], a[88:91], a[116:119], v[228:231]
v_mfma_f32_16x16x32_bf16 v[232:235], a[88:91], a[120:123], v[232:235]
v_mfma_f32_16x16x32_bf16 v[236:239], a[88:91], a[124:127], v[236:239]
s_waitcnt lgkmcnt(0)
v_mfma_f32_16x16x32_bf16 v[240:243], a[96:99], a[92:95], v[240:243]
v_mfma_f32_16x16x32_bf16 v[244:247], a[100:103], a[92:95], v[244:247]
v_mfma_f32_16x16x32_bf16 v[248:251], a[104:107], a[92:95], v[248:251]
v_mfma_f32_16x16x32_bf16 v[252:255], a[108:111], a[92:95], v[252:255]
v_mfma_f32_16x16x32_bf16 a[128:131], a[92:95], a[112:115], a[128:131]
v_mfma_f32_16x16x32_bf16 a[132:135], a[92:95], a[116:119], a[132:135]
v_mfma_f32_16x16x32_bf16 a[136:139], a[92:95], a[120:123], a[136:139]
v_mfma_f32_16x16x32_bf16 a[140:143], a[92:95], a[124:127], a[140:143]
s_add_u32 s44, s28, 0
s_addc_u32 s45, s29, 0
s_mov_b32 s46, 33554432
s_mov_b32 s47, 0x20000
s_lshl_b32 s56, s31, 20
s_lshl_b32 s52, s3, 17
s_add_u32 s56, s56, s52
s_lshr_b32 s52, s30, 1
s_lshl_b32 s52, s52, 16
s_add_u32 s56, s56, s52
s_and_b32 s52, s30, 1
s_lshl_b32 s53, s52, 11
s_add_u32 s57, s56, s53
s_lshl_b32 s53, s52, 12
s_add_u32 s58, s56, s53
s_add_u32 s60, s57, 0
v_cvt_pk_bf16_f32 v16, v16, v17
v_cvt_pk_bf16_f32 v17, v18, v19
v_cvt_pk_bf16_f32 v18, v20, v21
v_cvt_pk_bf16_f32 v19, v22, v23
buffer_store_dwordx4 v[16:19], v12, s[44:47], s60 offen offset:0
v_cvt_pk_bf16_f32 v24, v24, v25
v_cvt_pk_bf16_f32 v25, v26, v27
v_cvt_pk_bf16_f32 v26, v28, v29
v_cvt_pk_bf16_f32 v27, v30, v31
buffer_store_dwordx4 v[24:27], v12, s[44:47], s60 offen offset:1024
s_add_u32 s60, s57, 4096
v_cvt_pk_bf16_f32 v48, v48, v49
v_cvt_pk_bf16_f32 v49, v50, v51
v_cvt_pk_bf16_f32 v50, v52, v53
v_cvt_pk_bf16_f32 v51, v54, v55
buffer_store_dwordx4 v[48:51], v12, s[44:47], s60 offen offset:0
v_cvt_pk_bf16_f32 v56, v56, v57
v_cvt_pk_bf16_f32 v57, v58, v59
v_cvt_pk_bf16_f32 v58, v60, v61
v_cvt_pk_bf16_f32 v59, v62, v63
buffer_store_dwordx4 v[56:59], v12, s[44:47], s60 offen offset:1024
s_add_u32 s60, s58, 8192
v_cvt_pk_bf16_f32 v32, v32, v33
v_cvt_pk_bf16_f32 v33, v34, v35
v_cvt_pk_bf16_f32 v34, v64, v65
v_cvt_pk_bf16_f32 v35, v66, v67
buffer_store_dwordx4 v[32:35], v12, s[44:47], s60 offen offset:0
v_cvt_pk_bf16_f32 v36, v36, v37
v_cvt_pk_bf16_f32 v37, v38, v39
v_cvt_pk_bf16_f32 v38, v68, v69
v_cvt_pk_bf16_f32 v39, v70, v71
buffer_store_dwordx4 v[36:39], v12, s[44:47], s60 offen offset:1024
v_cvt_pk_bf16_f32 v40, v40, v41
v_cvt_pk_bf16_f32 v41, v42, v43
v_cvt_pk_bf16_f32 v42, v72, v73
v_cvt_pk_bf16_f32 v43, v74, v75
buffer_store_dwordx4 v[40:43], v12, s[44:47], s60 offen offset:2048
v_cvt_pk_bf16_f32 v44, v44, v45
v_cvt_pk_bf16_f32 v45, v46, v47
v_cvt_pk_bf16_f32 v46, v76, v77
v_cvt_pk_bf16_f32 v47, v78, v79
buffer_store_dwordx4 v[44:47], v12, s[44:47], s60 offen offset:3072
s_add_u32 s60, s57, 16384
v_cvt_pk_bf16_f32 v80, v80, v81
v_cvt_pk_bf16_f32 v81, v82, v83
v_cvt_pk_bf16_f32 v82, v84, v85
v_cvt_pk_bf16_f32 v83, v86, v87
buffer_store_dwordx4 v[80:83], v12, s[44:47], s60 offen offset:0
v_cvt_pk_bf16_f32 v88, v88, v89
v_cvt_pk_bf16_f32 v89, v90, v91
v_cvt_pk_bf16_f32 v90, v92, v93
v_cvt_pk_bf16_f32 v91, v94, v95
buffer_store_dwordx4 v[88:91], v12, s[44:47], s60 offen offset:1024
s_add_u32 s60, s57, 20480
v_cvt_pk_bf16_f32 v112, v112, v113
v_cvt_pk_bf16_f32 v113, v114, v115
v_cvt_pk_bf16_f32 v114, v116, v117
v_cvt_pk_bf16_f32 v115, v118, v119
buffer_store_dwordx4 v[112:115], v12, s[44:47], s60 offen offset:0
v_cvt_pk_bf16_f32 v120, v120, v121
v_cvt_pk_bf16_f32 v121, v122, v123
v_cvt_pk_bf16_f32 v122, v124, v125
v_cvt_pk_bf16_f32 v123, v126, v127
buffer_store_dwordx4 v[120:123], v12, s[44:47], s60 offen offset:1024
s_add_u32 s60, s58, 24576
v_cvt_pk_bf16_f32 v96, v96, v97
v_cvt_pk_bf16_f32 v97, v98, v99
v_cvt_pk_bf16_f32 v98, v128, v129
v_cvt_pk_bf16_f32 v99, v130, v131
buffer_store_dwordx4 v[96:99], v12, s[44:47], s60 offen offset:0
v_cvt_pk_bf16_f32 v100, v100, v101
v_cvt_pk_bf16_f32 v101, v102, v103
v_cvt_pk_bf16_f32 v102, v132, v133
v_cvt_pk_bf16_f32 v103, v134, v135
buffer_store_dwordx4 v[100:103], v12, s[44:47], s60 offen offset:1024
v_cvt_pk_bf16_f32 v104, v104, v105
v_cvt_pk_bf16_f32 v105, v106, v107
v_cvt_pk_bf16_f32 v106, v136, v137
v_cvt_pk_bf16_f32 v107, v138, v139
buffer_store_dwordx4 v[104:107], v12, s[44:47], s60 offen offset:2048
v_cvt_pk_bf16_f32 v108, v108, v109
v_cvt_pk_bf16_f32 v109, v110, v111
v_cvt_pk_bf16_f32 v110, v140, v141
v_cvt_pk_bf16_f32 v111, v142, v143
buffer_store_dwordx4 v[108:111], v12, s[44:47], s60 offen offset:3072
s_add_u32 s60, s57, 32768
v_cvt_pk_bf16_f32 v144, v144, v145
v_cvt_pk_bf16_f32 v145, v146, v147
v_cvt_pk_bf16_f32 v146, v148, v149
v_cvt_pk_bf16_f32 v147, v150, v151
buffer_store_dwordx4 v[144:147], v12, s[44:47], s60 offen offset:0
v_cvt_pk_bf16_f32 v152, v152, v153
v_cvt_pk_bf16_f32 v153, v154, v155
v_cvt_pk_bf16_f32 v154, v156, v157
v_cvt_pk_bf16_f32 v155, v158, v159
buffer_store_dwordx4 v[152:155], v12, s[44:47], s60 offen offset:1024
s_add_u32 s60, s57, 36864
v_cvt_pk_bf16_f32 v176, v176, v177
v_cvt_pk_bf16_f32 v177, v178, v179
v_cvt_pk_bf16_f32 v178, v180, v181
v_cvt_pk_bf16_f32 v179, v182, v183
buffer_store_dwordx4 v[176:179], v12, s[44:47], s60 offen offset:0
v_cvt_pk_bf16_f32 v184, v184, v185
v_cvt_pk_bf16_f32 v185, v186, v187
v_cvt_pk_bf16_f32 v186, v188, v189
v_cvt_pk_bf16_f32 v187, v190, v191
buffer_store_dwordx4 v[184:187], v12, s[44:47], s60 offen offset:1024
s_add_u32 s60, s58, 40960
v_cvt_pk_bf16_f32 v160, v160, v161
v_cvt_pk_bf16_f32 v161, v162, v163
v_cvt_pk_bf16_f32 v162, v192, v193
v_cvt_pk_bf16_f32 v163, v194, v195
buffer_store_dwordx4 v[160:163], v12, s[44:47], s60 offen offset:0
v_cvt_pk_bf16_f32 v164, v164, v165
v_cvt_pk_bf16_f32 v165, v166, v167
v_cvt_pk_bf16_f32 v166, v196, v197
v_cvt_pk_bf16_f32 v167, v198, v199
buffer_store_dwordx4 v[164:167], v12, s[44:47], s60 offen offset:1024
v_cvt_pk_bf16_f32 v168, v168, v169
v_cvt_pk_bf16_f32 v169, v170, v171
v_cvt_pk_bf16_f32 v170, v200, v201
v_cvt_pk_bf16_f32 v171, v202, v203
buffer_store_dwordx4 v[168:171], v12, s[44:47], s60 offen offset:2048
v_cvt_pk_bf16_f32 v172, v172, v173
v_cvt_pk_bf16_f32 v173, v174, v175
v_cvt_pk_bf16_f32 v174, v204, v205
v_cvt_pk_bf16_f32 v175, v206, v207
buffer_store_dwordx4 v[172:175], v12, s[44:47], s60 offen offset:3072
s_add_u32 s60, s57, 49152
v_cvt_pk_bf16_f32 v208, v208, v209
v_cvt_pk_bf16_f32 v209, v210, v211
v_cvt_pk_bf16_f32 v210, v212, v213
v_cvt_pk_bf16_f32 v211, v214, v215
buffer_store_dwordx4 v[208:211], v12, s[44:47], s60 offen offset:0
v_cvt_pk_bf16_f32 v216, v216, v217
v_cvt_pk_bf16_f32 v217, v218, v219
v_cvt_pk_bf16_f32 v218, v220, v221
v_cvt_pk_bf16_f32 v219, v222, v223
buffer_store_dwordx4 v[216:219], v12, s[44:47], s60 offen offset:1024
s_add_u32 s60, s57, 53248
v_cvt_pk_bf16_f32 v240, v240, v241
v_cvt_pk_bf16_f32 v241, v242, v243
v_cvt_pk_bf16_f32 v242, v244, v245
v_cvt_pk_bf16_f32 v243, v246, v247
buffer_store_dwordx4 v[240:243], v12, s[44:47], s60 offen offset:0
v_cvt_pk_bf16_f32 v248, v248, v249
v_cvt_pk_bf16_f32 v249, v250, v251
v_cvt_pk_bf16_f32 v250, v252, v253
v_cvt_pk_bf16_f32 v251, v254, v255
buffer_store_dwordx4 v[248:251], v12, s[44:47], s60 offen offset:1024
s_add_u32 s60, s58, 57344
v_accvgpr_read_b32 v20, a128
v_accvgpr_read_b32 v21, a129
v_accvgpr_read_b32 v22, a130
v_accvgpr_read_b32 v23, a131
v_cvt_pk_bf16_f32 v224, v224, v225
v_cvt_pk_bf16_f32 v225, v226, v227
v_cvt_pk_bf16_f32 v226, v20, v21
v_cvt_pk_bf16_f32 v227, v22, v23
buffer_store_dwordx4 v[224:227], v12, s[44:47], s60 offen offset:0
v_accvgpr_read_b32 v20, a132
v_accvgpr_read_b32 v21, a133
v_accvgpr_read_b32 v22, a134
v_accvgpr_read_b32 v23, a135
v_cvt_pk_bf16_f32 v228, v228, v229
v_cvt_pk_bf16_f32 v229, v230, v231
v_cvt_pk_bf16_f32 v230, v20, v21
v_cvt_pk_bf16_f32 v231, v22, v23
buffer_store_dwordx4 v[228:231], v12, s[44:47], s60 offen offset:1024
v_accvgpr_read_b32 v20, a136
v_accvgpr_read_b32 v21, a137
v_accvgpr_read_b32 v22, a138
v_accvgpr_read_b32 v23, a139
v_cvt_pk_bf16_f32 v232, v232, v233
v_cvt_pk_bf16_f32 v233, v234, v235
v_cvt_pk_bf16_f32 v234, v20, v21
v_cvt_pk_bf16_f32 v235, v22, v23
buffer_store_dwordx4 v[232:235], v12, s[44:47], s60 offen offset:2048
v_accvgpr_read_b32 v20, a140
v_accvgpr_read_b32 v21, a141
v_accvgpr_read_b32 v22, a142
v_accvgpr_read_b32 v23, a143
v_cvt_pk_bf16_f32 v236, v236, v237
v_cvt_pk_bf16_f32 v237, v238, v239
v_cvt_pk_bf16_f32 v238, v20, v21
v_cvt_pk_bf16_f32 v239, v22, v23
buffer_store_dwordx4 v[236:239], v12, s[44:47], s60 offen offset:3072
L_end_1:
s_endpgm
.globl k2_kernel
.p2align 8
.type k2_kernel,@function
k2_kernel:
s_cmp_ge_u32 s2, 256
s_cbranch_scc1 L_end_3
s_load_dwordx16 s[4:19], s[0:1], 0
s_load_dwordx8 s[20:27], s[0:1], 64
s_load_dwordx2 s[28:29], s[0:1], 96
v_lshrrev_b32 v1, 6, v0
v_and_b32 v0, 63, v0
v_readfirstlane_b32 s30, v1
s_and_b32 s52, s2, 7
s_lshr_b32 s53, s2, 3
s_and_b32 s54, s53, 3
s_lshl2_add_u32 s31, s52, s54
s_lshr_b32 s3, s53, 2
s_waitcnt lgkmcnt(0)
s_mov_b32 s32, s4
s_mov_b32 s33, s5
s_mov_b32 s34, 4194304
s_mov_b32 s35, 0x20000
s_mov_b32 s36, s8
s_mov_b32 s37, s9
s_mov_b32 s38, 8388608
s_mov_b32 s39, 0x20000
s_mov_b32 s40, s18
s_mov_b32 s41, s19
s_mov_b32 s42, 6291456
s_mov_b32 s43, 0x20000
s_mov_b32 s62, s3
s_sub_u32 s63, 15, s3
v_lshrrev_b32 v24, 3, v0
v_lshrrev_b32 v25, 4, v0
v_and_b32 v26, 7, v0
v_xor_b32 v26, v26, v25
v_lshlrev_b32 v26, 4, v26
v_lshl_add_u32 v17, v24, 11, v26
v_xor_b32 v18, 64, v17
s_and_b32 s52, s30, 1
s_lshl_b32 s53, s52, 6
v_xor_b32 v19, s53, v17
v_bfe_u32 v26, v0, 1, 3
v_xor_b32 v26, v26, v25
v_lshlrev_b32 v26, 5, v26
v_and_b32 v24, 1, v0
v_lshl_add_u32 v26, v24, 4, v26
v_lshl_add_u32 v20, v25, 13, v26
v_xor_b32 v21, 128, v20
v_bfe_u32 v26, v0, 1, 1
v_lshrrev_b32 v1, 5, v0
v_xor_b32 v26, v26, v1
v_lshlrev_b32 v26, 5, v26
v_lshl_add_u32 v26, v24, 4, v26
v_lshrrev_b32 v1, 2, v0
v_mul_u32_u24 v1, 6144, v1
v_add_u32 v22, v1, v26
s_lshl_b32 s53, s30, 16
s_lshl_b32 s64, s62, 18
s_lshl_b32 s65, s63, 18
s_cmp_lt_u32 s30, 2
s_cselect_b32 s66, s64, s65
s_max_u32 s66, s66, 32768
s_sub_u32 s66, s66, 32768
s_lshl_b32 s54, s52, 14
s_add_u32 s66, s66, s54
s_add_u32 s64, s64, s53
s_add_u32 s65, s65, s53
s_lshl_b32 s67, s30, 17
s_lshl_b32 s53, s31, 8
s_add_u32 s67, s67, s53
s_mul_i32 s68, s30, 98304
s_lshl_b32 s53, s31, 6
s_add_u32 s68, s68, s53
s_lshl_b32 s69, s30, 13
s_lshl_b32 s70, s30, 10
s_lshl_b32 s71, s30, 12
s_add_u32 m0, s71, 73728
s_add_u32 s73, s67, 0
buffer_load_dwordx4 v20, s[36:39], s73 offen lds
s_add_u32 m0, s71, 74752
s_add_u32 s73, s67, 32768
buffer_load_dwordx4 v20, s[36:39], s73 offen lds
s_add_u32 m0, s71, 75776
s_add_u32 s73, s67, 65536
buffer_load_dwordx4 v21, s[36:39], s73 offen lds
s_add_u32 m0, s71, 76800
s_add_u32 s73, s67, 98304
buffer_load_dwordx4 v21, s[36:39], s73 offen lds
s_add_u32 m0, s70, 106496
s_add_u32 s73, s68, 0
buffer_load_dwordx4 v22, s[40:43], s73 offen lds
s_add_u32 m0, s70, 110592
s_add_u32 s73, s68, 2048
buffer_load_dwordx4 v22, s[40:43], s73 offen lds
s_add_u32 m0, s70, 114688
s_add_u32 s73, s68, 4096
buffer_load_dwordx4 v22, s[40:43], s73 offen lds
s_add_u32 m0, s69, 0
s_add_u32 s73, s64, 0
buffer_load_dwordx4 v17, s[32:35], s73 offen lds
s_add_u32 m0, s69, 1024
s_add_u32 s73, s64, 16384
buffer_load_dwordx4 v18, s[32:35], s73 offen lds
s_add_u32 m0, s69, 2048
s_add_u32 s73, s64, 32768
buffer_load_dwordx4 v17, s[32:35], s73 offen lds
s_add_u32 m0, s69, 3072
s_add_u32 s73, s64, 49152
buffer_load_dwordx4 v18, s[32:35], s73 offen lds
s_add_u32 m0, s69, 4096
s_add_u32 s73, s65, 0
buffer_load_dwordx4 v17, s[32:35], s73 offen lds
s_add_u32 m0, s69, 5120
s_add_u32 s73, s65, 16384
buffer_load_dwordx4 v18, s[32:35], s73 offen lds
s_add_u32 m0, s69, 6144
s_add_u32 s73, s65, 32768
buffer_load_dwordx4 v17, s[32:35], s73 offen lds
s_add_u32 m0, s69, 7168
s_add_u32 s73, s65, 49152
buffer_load_dwordx4 v18, s[32:35], s73 offen lds
s_add_u32 m0, s70, 32768
s_nop 0
buffer_load_dwordx4 v19, s[32:35], s66 offen lds
s_add_u32 s64, s64, 128
s_add_u32 s65, s65, 128
s_add_u32 s66, s66, 128
s_add_u32 s67, s67, 524288
s_add_u32 s68, s68, 393216
s_add_u32 m0, s71, 90112
s_add_u32 s73, s67, 0
buffer_load_dwordx4 v20, s[36:39], s73 offen lds
s_add_u32 m0, s71, 91136
s_add_u32 s73, s67, 32768
buffer_load_dwordx4 v20, s[36:39], s73 offen lds
s_add_u32 m0, s71, 92160
s_add_u32 s73, s67, 65536
buffer_load_dwordx4 v21, s[36:39], s73 offen lds
s_add_u32 m0, s71, 93184
s_add_u32 s73, s67, 98304
buffer_load_dwordx4 v21, s[36:39], s73 offen lds
s_add_u32 m0, s70, 118784
s_add_u32 s73, s68, 0
buffer_load_dwordx4 v22, s[40:43], s73 offen lds
s_add_u32 m0, s70, 122880
s_add_u32 s73, s68, 2048
buffer_load_dwordx4 v22, s[40:43], s73 offen lds
s_add_u32 m0, s70, 126976
s_add_u32 s73, s68, 4096
buffer_load_dwordx4 v22, s[40:43], s73 offen lds
s_add_u32 m0, s69, 36864
s_add_u32 s73, s64, 0
buffer_load_dwordx4 v17, s[32:35], s73 offen lds
s_add_u32 m0, s69, 37888
s_add_u32 s73, s64, 16384
buffer_load_dwordx4 v18, s[32:35], s73 offen lds
s_add_u32 m0, s69, 38912
s_add_u32 s73, s64, 32768
buffer_load_dwordx4 v17, s[32:35], s73 offen lds
s_add_u32 m0, s69, 39936
s_add_u32 s73, s64, 49152
buffer_load_dwordx4 v18, s[32:35], s73 offen lds
s_add_u32 m0, s69, 40960
s_add_u32 s73, s65, 0
buffer_load_dwordx4 v17, s[32:35], s73 offen lds
s_add_u32 m0, s69, 41984
s_add_u32 s73, s65, 16384
buffer_load_dwordx4 v18, s[32:35], s73 offen lds
s_add_u32 m0, s69, 43008
s_add_u32 s73, s65, 32768
buffer_load_dwordx4 v17, s[32:35], s73 offen lds
s_add_u32 m0, s69, 44032
s_add_u32 s73, s65, 49152
buffer_load_dwordx4 v18, s[32:35], s73 offen lds
s_add_u32 m0, s70, 69632
s_nop 0
buffer_load_dwordx4 v19, s[32:35], s66 offen lds
s_add_u32 s64, s64, 128
s_add_u32 s65, s65, 128
s_add_u32 s66, s66, 128
s_add_u32 s67, s67, 524288
s_add_u32 s68, s68, 393216
v_and_b32 v24, 15, v0
v_lshrrev_b32 v26, 1, v24
v_xor_b32 v26, v26, v25
v_lshlrev_b32 v26, 4, v26
v_lshl_add_u32 v26, v24, 7, v26
v_add_u32 v2, s69, v26
v_xor_b32 v3, 64, v2
s_lshr_b32 s53, s30, 1
s_lshl_b32 s53, s53, 11
s_add_u32 s53, s53, 32768
v_add_u32 v4, s53, v26
v_xor_b32 v5, 64, v4
v_bfe_u32 v24, v0, 2, 2
v_lshl_add_u32 v27, v25, 3, v24
v_and_b32 v1, 3, v0
v_lshlrev_b32 v1, 3, v1
v_lshl_add_u32 v26, v27, 8, v1
v_add_u32 v26, 73728, v26
v_lshl_add_u32 v27, v27, 6, v1
v_add_u32 v27, 106496, v27
v_and_b32 v1, 1, v25
v_lshl_add_u32 v14, v1, 5, v27
v_xor_b32 v15, 32, v14
s_lshl_b32 s53, s52, 5
v_xor_b32 v16, s53, v14
v_lshl_add_u32 v24, v1, 2, v24
v_xor_b32 v1, 0, v24
v_lshl_add_u32 v6, v1, 5, v26
v_xor_b32 v1, 1, v24
v_lshl_add_u32 v7, v1, 5, v26
v_xor_b32 v1, 2, v24
v_lshl_add_u32 v8, v1, 5, v26
v_xor_b32 v1, 3, v24
v_lshl_add_u32 v9, v1, 5, v26
v_xor_b32 v1, 4, v24
v_lshl_add_u32 v10, v1, 5, v26
v_xor_b32 v1, 5, v24
v_lshl_add_u32 v11, v1, 5, v26
v_xor_b32 v1, 6, v24
v_lshl_add_u32 v12, v1, 5, v26
v_xor_b32 v1, 7, v24
v_lshl_add_u32 v13, v1, 5, v26
v_mov_b32 v24, 0
v_mov_b32 v25, 0
v_mov_b32 v26, 0
v_mov_b32 v27, 0
v_mov_b32 v28, 0
v_mov_b32 v29, 0
v_mov_b32 v30, 0
v_mov_b32 v31, 0
v_mov_b32 v32, 0
v_mov_b32 v33, 0
v_mov_b32 v34, 0
v_mov_b32 v35, 0
v_mov_b32 v36, 0
v_mov_b32 v37, 0
v_mov_b32 v38, 0
v_mov_b32 v39, 0
v_mov_b32 v40, 0
v_mov_b32 v41, 0
v_mov_b32 v42, 0
v_mov_b32 v43, 0
v_mov_b32 v44, 0
v_mov_b32 v45, 0
v_mov_b32 v46, 0
v_mov_b32 v47, 0
v_mov_b32 v48, 0
v_mov_b32 v49, 0
v_mov_b32 v50, 0
v_mov_b32 v51, 0
v_mov_b32 v52, 0
v_mov_b32 v53, 0
v_mov_b32 v54, 0
v_mov_b32 v55, 0
v_mov_b32 v56, 0
v_mov_b32 v57, 0
v_mov_b32 v58, 0
v_mov_b32 v59, 0
v_mov_b32 v60, 0
v_mov_b32 v61, 0
v_mov_b32 v62, 0
v_mov_b32 v63, 0
v_mov_b32 v64, 0
v_mov_b32 v65, 0
v_mov_b32 v66, 0
v_mov_b32 v67, 0
v_mov_b32 v68, 0
v_mov_b32 v69, 0
v_mov_b32 v70, 0
v_mov_b32 v71, 0
v_mov_b32 v72, 0
v_mov_b32 v73, 0
v_mov_b32 v74, 0
v_mov_b32 v75, 0
v_mov_b32 v76, 0
v_mov_b32 v77, 0
v_mov_b32 v78, 0
v_mov_b32 v79, 0
v_mov_b32 v80, 0
v_mov_b32 v81, 0
v_mov_b32 v82, 0
v_mov_b32 v83, 0
v_mov_b32 v84, 0
v_mov_b32 v85, 0
v_mov_b32 v86, 0
v_mov_b32 v87, 0
v_mov_b32 v88, 0
v_mov_b32 v89, 0
v_mov_b32 v90, 0
v_mov_b32 v91, 0
v_mov_b32 v92, 0
v_mov_b32 v93, 0
v_mov_b32 v94, 0
v_mov_b32 v95, 0
v_mov_b32 v96, 0
v_mov_b32 v97, 0
v_mov_b32 v98, 0
v_mov_b32 v99, 0
v_mov_b32 v100, 0
v_mov_b32 v101, 0
v_mov_b32 v102, 0
v_mov_b32 v103, 0
v_mov_b32 v104, 0
v_mov_b32 v105, 0
v_mov_b32 v106, 0
v_mov_b32 v107, 0
v_mov_b32 v108, 0
v_mov_b32 v109, 0
v_mov_b32 v110, 0
v_mov_b32 v111, 0
v_mov_b32 v112, 0
v_mov_b32 v113, 0
v_mov_b32 v114, 0
v_mov_b32 v115, 0
v_mov_b32 v116, 0
v_mov_b32 v117, 0
v_mov_b32 v118, 0
v_mov_b32 v119, 0
v_mov_b32 v120, 0
v_mov_b32 v121, 0
v_mov_b32 v122, 0
v_mov_b32 v123, 0
v_mov_b32 v124, 0
v_mov_b32 v125, 0
v_mov_b32 v126, 0
v_mov_b32 v127, 0
v_mov_b32 v128, 0
v_mov_b32 v129, 0
v_mov_b32 v130, 0
v_mov_b32 v131, 0
v_mov_b32 v132, 0
v_mov_b32 v133, 0
v_mov_b32 v134, 0
v_mov_b32 v135, 0
v_mov_b32 v136, 0
v_mov_b32 v137, 0
v_mov_b32 v138, 0
v_mov_b32 v139, 0
v_mov_b32 v140, 0
v_mov_b32 v141, 0
v_mov_b32 v142, 0
v_mov_b32 v143, 0
v_mov_b32 v144, 0
v_mov_b32 v145, 0
v_mov_b32 v146, 0
v_mov_b32 v147, 0
v_mov_b32 v148, 0
v_mov_b32 v149, 0
v_mov_b32 v150, 0
v_mov_b32 v151, 0
v_mov_b32 v152, 0
v_mov_b32 v153, 0
v_mov_b32 v154, 0
v_mov_b32 v155, 0
v_mov_b32 v156, 0
v_mov_b32 v157, 0
v_mov_b32 v158, 0
v_mov_b32 v159, 0
v_mov_b32 v160, 0
v_mov_b32 v161, 0
v_mov_b32 v162, 0
v_mov_b32 v163, 0
v_mov_b32 v164, 0
v_mov_b32 v165, 0
v_mov_b32 v166, 0
v_mov_b32 v167, 0
v_mov_b32 v168, 0
v_mov_b32 v169, 0
v_mov_b32 v170, 0
v_mov_b32 v171, 0
v_mov_b32 v172, 0
v_mov_b32 v173, 0
v_mov_b32 v174, 0
v_mov_b32 v175, 0
v_mov_b32 v176, 0
v_mov_b32 v177, 0
v_mov_b32 v178, 0
v_mov_b32 v179, 0
v_mov_b32 v180, 0
v_mov_b32 v181, 0
v_mov_b32 v182, 0
v_mov_b32 v183, 0
v_mov_b32 v184, 0
v_mov_b32 v185, 0
v_mov_b32 v186, 0
v_mov_b32 v187, 0
v_mov_b32 v188, 0
v_mov_b32 v189, 0
v_mov_b32 v190, 0
v_mov_b32 v191, 0
v_mov_b32 v192, 0
v_mov_b32 v193, 0
v_mov_b32 v194, 0
v_mov_b32 v195, 0
v_mov_b32 v196, 0
v_mov_b32 v197, 0
v_mov_b32 v198, 0
v_mov_b32 v199, 0
v_mov_b32 v200, 0
v_mov_b32 v201, 0
v_mov_b32 v202, 0
v_mov_b32 v203, 0
v_mov_b32 v204, 0
v_mov_b32 v205, 0
v_mov_b32 v206, 0
v_mov_b32 v207, 0
v_mov_b32 v208, 0
v_mov_b32 v209, 0
v_mov_b32 v210, 0
v_mov_b32 v211, 0
v_mov_b32 v212, 0
v_mov_b32 v213, 0
v_mov_b32 v214, 0
v_mov_b32 v215, 0
v_mov_b32 v216, 0
v_mov_b32 v217, 0
v_mov_b32 v218, 0
v_mov_b32 v219, 0
v_mov_b32 v220, 0
v_mov_b32 v221, 0
v_mov_b32 v222, 0
v_mov_b32 v223, 0
v_mov_b32 v224, 0
v_mov_b32 v225, 0
v_mov_b32 v226, 0
v_mov_b32 v227, 0
v_mov_b32 v228, 0
v_mov_b32 v229, 0
v_mov_b32 v230, 0
v_mov_b32 v231, 0
v_mov_b32 v232, 0
v_mov_b32 v233, 0
v_mov_b32 v234, 0
v_mov_b32 v235, 0
v_mov_b32 v236, 0
v_mov_b32 v237, 0
v_mov_b32 v238, 0
v_mov_b32 v239, 0
v_mov_b32 v240, 0
v_mov_b32 v241, 0
v_mov_b32 v242, 0
v_mov_b32 v243, 0
v_mov_b32 v244, 0
v_mov_b32 v245, 0
v_mov_b32 v246, 0
v_mov_b32 v247, 0
v_mov_b32 v248, 0
v_mov_b32 v249, 0
v_mov_b32 v250, 0
v_mov_b32 v251, 0
v_mov_b32 v252, 0
v_mov_b32 v253, 0
v_mov_b32 v254, 0
v_mov_b32 v255, 0
s_waitcnt vmcnt(16)
s_barrier
ds_read_b128 a[0:3], v2 offset:0
ds_read_b128 a[4:7], v2 offset:2048
ds_read_b128 a[8:11], v2 offset:4096
ds_read_b128 a[12:15], v2 offset:6144
ds_read_b64_tr_b16 a[20:21], v6 offset:0
ds_read_b64_tr_b16 a[22:23], v6 offset:1024
ds_read_b64_tr_b16 a[24:25], v7 offset:0
ds_read_b64_tr_b16 a[26:27], v7 offset:1024
ds_read_b64_tr_b16 a[28:29], v8 offset:0
ds_read_b64_tr_b16 a[30:31], v8 offset:1024
ds_read_b64_tr_b16 a[32:33], v9 offset:0
ds_read_b64_tr_b16 a[34:35], v9 offset:1024
ds_read_b64_tr_b16 a[36:37], v10 offset:0
ds_read_b64_tr_b16 a[38:39], v10 offset:1024
ds_read_b64_tr_b16 a[40:41], v11 offset:0
ds_read_b64_tr_b16 a[42:43], v11 offset:1024
ds_read_b64_tr_b16 a[44:45], v12 offset:0
ds_read_b64_tr_b16 a[46:47], v12 offset:1024
ds_read_b64_tr_b16 a[48:49], v13 offset:0
ds_read_b64_tr_b16 a[50:51], v13 offset:1024
ds_read_b64_tr_b16 a[52:53], v14 offset:0
ds_read_b64_tr_b16 a[54:55], v14 offset:256
ds_read_b64_tr_b16 a[56:57], v15 offset:0
ds_read_b64_tr_b16 a[58:59], v15 offset:256
ds_read_b64_tr_b16 a[60:61], v14 offset:4096
ds_read_b64_tr_b16 a[62:63], v14 offset:4352
ds_read_b64_tr_b16 a[64:65], v15 offset:4096
ds_read_b64_tr_b16 a[66:67], v15 offset:4352
ds_read_b64_tr_b16 a[68:69], v14 offset:8192
ds_read_b64_tr_b16 a[70:71], v14 offset:8448
ds_read_b64_tr_b16 a[72:73], v15 offset:8192
ds_read_b64_tr_b16 a[74:75], v15 offset:8448
ds_read_b128 a[16:19], v4 offset:0
ds_read_b64_tr_b16 a[76:77], v16 offset:4096
ds_read_b64_tr_b16 a[78:79], v16 offset:4352
ds_read_b64_tr_b16 a[80:81], v16 offset:8192
ds_read_b64_tr_b16 a[82:83], v16 offset:8448
s_sub_u32 s64, s64, 128
s_sub_u32 s65, s65, 128
s_sub_u32 s66, s66, 128
s_sub_u32 s67, s67, 524288
s_sub_u32 s68, s68, 393216
s_mov_b32 s74, 7
s_waitcnt lgkmcnt(0)
.p2align 3
L_p2_4:
s_waitcnt lgkmcnt(15)
v_mfma_f32_16x16x32_bf16 v[24:27], a[20:23], a[0:3], v[24:27]
ds_read_b128 a[84:87], v3 offset:0
v_mfma_f32_16x16x32_bf16 v[40:43], a[20:23], a[4:7], v[40:43]
ds_read_b128 a[88:91], v3 offset:2048
v_mfma_f32_16x16x32_bf16 v[56:59], a[20:23], a[8:11], v[56:59]
ds_read_b128 a[92:95], v3 offset:4096
v_mfma_f32_16x16x32_bf16 v[72:75], a[20:23], a[12:15], v[72:75]
s_waitcnt lgkmcnt(15)
ds_read_b128 a[96:99], v3 offset:6144
v_mfma_f32_16x16x32_bf16 v[88:91], a[24:27], a[0:3], v[88:91]
ds_read_b64_tr_b16 a[104:105], v6 offset:8192
v_mfma_f32_16x16x32_bf16 v[104:107], a[24:27], a[4:7], v[104:107]
ds_read_b64_tr_b16 a[106:107], v6 offset:9216
v_mfma_f32_16x16x32_bf16 v[120:123], a[24:27], a[8:11], v[120:123]
ds_read_b64_tr_b16 a[108:109], v7 offset:8192
v_mfma_f32_16x16x32_bf16 v[136:139], a[24:27], a[12:15], v[136:139]
s_waitcnt lgkmcnt(15)
ds_read_b64_tr_b16 a[110:111], v7 offset:9216
v_mfma_f32_16x16x32_bf16 v[28:31], a[28:31], a[0:3], v[28:31]
ds_read_b64_tr_b16 a[112:113], v8 offset:8192
v_mfma_f32_16x16x32_bf16 v[44:47], a[28:31], a[4:7], v[44:47]
ds_read_b64_tr_b16 a[114:115], v8 offset:9216
v_mfma_f32_16x16x32_bf16 v[60:63], a[28:31], a[8:11], v[60:63]
ds_read_b64_tr_b16 a[116:117], v9 offset:8192
v_mfma_f32_16x16x32_bf16 v[76:79], a[28:31], a[12:15], v[76:79]
s_waitcnt lgkmcnt(15)
ds_read_b64_tr_b16 a[118:119], v9 offset:9216
v_mfma_f32_16x16x32_bf16 v[92:95], a[32:35], a[0:3], v[92:95]
ds_read_b64_tr_b16 a[120:121], v10 offset:8192
v_mfma_f32_16x16x32_bf16 v[108:111], a[32:35], a[4:7], v[108:111]
ds_read_b64_tr_b16 a[122:123], v10 offset:9216
v_mfma_f32_16x16x32_bf16 v[124:127], a[32:35], a[8:11], v[124:127]
ds_read_b64_tr_b16 a[124:125], v11 offset:8192
v_mfma_f32_16x16x32_bf16 v[140:143], a[32:35], a[12:15], v[140:143]
s_waitcnt lgkmcnt(15)
ds_read_b64_tr_b16 a[126:127], v11 offset:9216
v_mfma_f32_16x16x32_bf16 v[32:35], a[36:39], a[0:3], v[32:35]
ds_read_b64_tr_b16 a[128:129], v12 offset:8192
v_mfma_f32_16x16x32_bf16 v[48:51], a[36:39], a[4:7], v[48:51]
ds_read_b64_tr_b16 a[130:131], v12 offset:9216
v_mfma_f32_16x16x32_bf16 v[64:67], a[36:39], a[8:11], v[64:67]
ds_read_b64_tr_b16 a[132:133], v13 offset:8192
v_mfma_f32_16x16x32_bf16 v[80:83], a[36:39], a[12:15], v[80:83]
s_waitcnt lgkmcnt(15)
ds_read_b64_tr_b16 a[134:135], v13 offset:9216
v_mfma_f32_16x16x32_bf16 v[96:99], a[40:43], a[0:3], v[96:99]
ds_read_b64_tr_b16 a[136:137], v14 offset:2048
v_mfma_f32_16x16x32_bf16 v[112:115], a[40:43], a[4:7], v[112:115]
ds_read_b64_tr_b16 a[138:139], v14 offset:2304
v_mfma_f32_16x16x32_bf16 v[128:131], a[40:43], a[8:11], v[128:131]
ds_read_b64_tr_b16 a[140:141], v15 offset:2048
v_mfma_f32_16x16x32_bf16 v[144:147], a[40:43], a[12:15], v[144:147]
s_waitcnt lgkmcnt(15)
ds_read_b64_tr_b16 a[142:143], v15 offset:2304
v_mfma_f32_16x16x32_bf16 v[36:39], a[44:47], a[0:3], v[36:39]
ds_read_b64_tr_b16 a[144:145], v14 offset:6144
v_mfma_f32_16x16x32_bf16 v[52:55], a[44:47], a[4:7], v[52:55]
ds_read_b64_tr_b16 a[146:147], v14 offset:6400
v_mfma_f32_16x16x32_bf16 v[68:71], a[44:47], a[8:11], v[68:71]
ds_read_b64_tr_b16 a[148:149], v15 offset:6144
v_mfma_f32_16x16x32_bf16 v[84:87], a[44:47], a[12:15], v[84:87]
s_waitcnt lgkmcnt(15)
ds_read_b64_tr_b16 a[150:151], v15 offset:6400
v_mfma_f32_16x16x32_bf16 v[100:103], a[48:51], a[0:3], v[100:103]
ds_read_b64_tr_b16 a[152:153], v14 offset:10240
v_mfma_f32_16x16x32_bf16 v[116:119], a[48:51], a[4:7], v[116:119]
ds_read_b64_tr_b16 a[154:155], v14 offset:10496
v_mfma_f32_16x16x32_bf16 v[132:135], a[48:51], a[8:11], v[132:135]
ds_read_b64_tr_b16 a[156:157], v15 offset:10240
v_mfma_f32_16x16x32_bf16 v[148:151], a[48:51], a[12:15], v[148:151]
s_waitcnt lgkmcnt(15)
ds_read_b64_tr_b16 a[158:159], v15 offset:10496
v_mfma_f32_16x16x32_bf16 v[152:155], a[52:55], a[0:3], v[152:155]
ds_read_b128 a[100:103], v5 offset:0
v_mfma_f32_16x16x32_bf16 v[160:163], a[52:55], a[4:7], v[160:163]
ds_read_b64_tr_b16 a[160:161], v16 offset:6144
v_mfma_f32_16x16x32_bf16 v[168:171], a[52:55], a[8:11], v[168:171]
ds_read_b64_tr_b16 a[162:163], v16 offset:6400
v_mfma_f32_16x16x32_bf16 v[176:179], a[52:55], a[12:15], v[176:179]
s_waitcnt lgkmcnt(15)
ds_read_b64_tr_b16 a[164:165], v16 offset:10240
v_mfma_f32_16x16x32_bf16 v[156:159], a[56:59], a[0:3], v[156:159]
ds_read_b64_tr_b16 a[166:167], v16 offset:10496
v_mfma_f32_16x16x32_bf16 v[164:167], a[56:59], a[4:7], v[164:167]
s_add_u32 s64, s64, 128
v_mfma_f32_16x16x32_bf16 v[172:175], a[56:59], a[8:11], v[172:175]
s_add_u32 s65, s65, 128
v_mfma_f32_16x16x32_bf16 v[180:183], a[56:59], a[12:15], v[180:183]
s_waitcnt lgkmcnt(15)
s_add_u32 s66, s66, 128
v_mfma_f32_16x16x32_bf16 v[184:187], a[60:63], a[0:3], v[184:187]
s_add_u32 s67, s67, 524288
v_mfma_f32_16x16x32_bf16 v[192:195], a[60:63], a[4:7], v[192:195]
s_add_u32 s68, s68, 393216
v_mfma_f32_16x16x32_bf16 v[200:203], a[60:63], a[8:11], v[200:203]
v_mfma_f32_16x16x32_bf16 v[208:211], a[60:63], a[12:15], v[208:211]
s_waitcnt lgkmcnt(15)
v_mfma_f32_16x16x32_bf16 v[188:191], a[64:67], a[0:3], v[188:191]
v_mfma_f32_16x16x32_bf16 v[196:199], a[64:67], a[4:7], v[196:199]
v_mfma_f32_16x16x32_bf16 v[204:207], a[64:67], a[8:11], v[204:207]
v_mfma_f32_16x16x32_bf16 v[212:215], a[64:67], a[12:15], v[212:215]
s_waitcnt lgkmcnt(15)
v_mfma_f32_16x16x32_bf16 v[216:219], a[0:3], a[68:71], v[216:219]
v_mfma_f32_16x16x32_bf16 v[224:227], a[4:7], a[68:71], v[224:227]
v_mfma_f32_16x16x32_bf16 v[232:235], a[8:11], a[68:71], v[232:235]
v_mfma_f32_16x16x32_bf16 v[240:243], a[12:15], a[68:71], v[240:243]
s_waitcnt lgkmcnt(15)
v_mfma_f32_16x16x32_bf16 v[220:223], a[0:3], a[72:75], v[220:223]
v_mfma_f32_16x16x32_bf16 v[228:231], a[4:7], a[72:75], v[228:231]
v_mfma_f32_16x16x32_bf16 v[236:239], a[8:11], a[72:75], v[236:239]
v_mfma_f32_16x16x32_bf16 v[244:247], a[12:15], a[72:75], v[244:247]
s_waitcnt lgkmcnt(15)
v_mfma_f32_16x16x32_bf16 v[248:251], a[76:79], a[16:19], v[248:251]
s_waitcnt lgkmcnt(15)
v_mfma_f32_16x16x32_bf16 v[252:255], a[16:19], a[80:83], v[252:255]
s_waitcnt vmcnt(0) lgkmcnt(0)
s_barrier
v_mfma_f32_16x16x32_bf16 v[24:27], a[104:107], a[84:87], v[24:27]
s_add_u32 m0, s71, 73728
ds_read_b128 a[0:3], v2 offset:36864
v_mfma_f32_16x16x32_bf16 v[40:43], a[104:107], a[88:91], v[40:43]
s_add_u32 s73, s67, 0
ds_read_b128 a[4:7], v2 offset:38912
v_mfma_f32_16x16x32_bf16 v[56:59], a[104:107], a[92:95], v[56:59]
buffer_load_dwordx4 v20, s[36:39], s73 offen lds
v_mfma_f32_16x16x32_bf16 v[72:75], a[104:107], a[96:99], v[72:75]
s_add_u32 m0, s71, 74752
ds_read_b128 a[8:11], v2 offset:40960
v_mfma_f32_16x16x32_bf16 v[88:91], a[108:111], a[84:87], v[88:91]
s_add_u32 s73, s67, 32768
ds_read_b128 a[12:15], v2 offset:43008
v_mfma_f32_16x16x32_bf16 v[104:107], a[108:111], a[88:91], v[104:107]
buffer_load_dwordx4 v20, s[36:39], s73 offen lds
v_mfma_f32_16x16x32_bf16 v[120:123], a[108:111], a[92:95], v[120:123]
ds_read_b64_tr_b16 a[20:21], v6 offset:16384
v_mfma_f32_16x16x32_bf16 v[136:139], a[108:111], a[96:99], v[136:139]
s_add_u32 m0, s71, 75776
ds_read_b64_tr_b16 a[22:23], v6 offset:17408
v_mfma_f32_16x16x32_bf16 v[28:31], a[112:115], a[84:87], v[28:31]
s_add_u32 s73, s67, 65536
ds_read_b64_tr_b16 a[24:25], v7 offset:16384
v_mfma_f32_16x16x32_bf16 v[44:47], a[112:115], a[88:91], v[44:47]
buffer_load_dwordx4 v21, s[36:39], s73 offen lds
v_mfma_f32_16x16x32_bf16 v[60:63], a[112:115], a[92:95], v[60:63]
s_add_u32 m0, s71, 76800
ds_read_b64_tr_b16 a[26:27], v7 offset:17408
v_mfma_f32_16x16x32_bf16 v[76:79], a[112:115], a[96:99], v[76:79]
s_add_u32 s73, s67, 98304
ds_read_b64_tr_b16 a[28:29], v8 offset:16384
v_mfma_f32_16x16x32_bf16 v[92:95], a[116:119], a[84:87], v[92:95]
buffer_load_dwordx4 v21, s[36:39], s73 offen lds
v_mfma_f32_16x16x32_bf16 v[108:111], a[116:119], a[88:91], v[108:111]
ds_read_b64_tr_b16 a[30:31], v8 offset:17408
v_mfma_f32_16x16x32_bf16 v[124:127], a[116:119], a[92:95], v[124:127]
s_add_u32 m0, s70, 106496
ds_read_b64_tr_b16 a[32:33], v9 offset:16384
v_mfma_f32_16x16x32_bf16 v[140:143], a[116:119], a[96:99], v[140:143]
s_add_u32 s73, s68, 0
ds_read_b64_tr_b16 a[34:35], v9 offset:17408
v_mfma_f32_16x16x32_bf16 v[32:35], a[120:123], a[84:87], v[32:35]
buffer_load_dwordx4 v22, s[40:43], s73 offen lds
v_mfma_f32_16x16x32_bf16 v[48:51], a[120:123], a[88:91], v[48:51]
ds_read_b64_tr_b16 a[36:37], v10 offset:16384
v_mfma_f32_16x16x32_bf16 v[64:67], a[120:123], a[92:95], v[64:67]
s_add_u32 m0, s70, 110592
ds_read_b64_tr_b16 a[38:39], v10 offset:17408
v_mfma_f32_16x16x32_bf16 v[80:83], a[120:123], a[96:99], v[80:83]
s_add_u32 s73, s68, 2048
ds_read_b64_tr_b16 a[40:41], v11 offset:16384
v_mfma_f32_16x16x32_bf16 v[96:99], a[124:127], a[84:87], v[96:99]
buffer_load_dwordx4 v22, s[40:43], s73 offen lds
v_mfma_f32_16x16x32_bf16 v[112:115], a[124:127], a[88:91], v[112:115]
s_add_u32 m0, s70, 114688
ds_read_b64_tr_b16 a[42:43], v11 offset:17408
v_mfma_f32_16x16x32_bf16 v[128:131], a[124:127], a[92:95], v[128:131]
s_add_u32 s73, s68, 4096
ds_read_b64_tr_b16 a[44:45], v12 offset:16384
v_mfma_f32_16x16x32_bf16 v[144:147], a[124:127], a[96:99], v[144:147]
buffer_load_dwordx4 v22, s[40:43], s73 offen lds
v_mfma_f32_16x16x32_bf16 v[36:39], a[128:131], a[84:87], v[36:39]
ds_read_b64_tr_b16 a[46:47], v12 offset:17408
v_mfma_f32_16x16x32_bf16 v[52:55], a[128:131], a[88:91], v[52:55]
s_add_u32 m0, s69, 0
ds_read_b64_tr_b16 a[48:49], v13 offset:16384
v_mfma_f32_16x16x32_bf16 v[68:71], a[128:131], a[92:95], v[68:71]
s_add_u32 s73, s64, 0
ds_read_b64_tr_b16 a[50:51], v13 offset:17408
v_mfma_f32_16x16x32_bf16 v[84:87], a[128:131], a[96:99], v[84:87]
buffer_load_dwordx4 v17, s[32:35], s73 offen lds
v_mfma_f32_16x16x32_bf16 v[100:103], a[132:135], a[84:87], v[100:103]
ds_read_b64_tr_b16 a[52:53], v14 offset:12288
v_mfma_f32_16x16x32_bf16 v[116:119], a[132:135], a[88:91], v[116:119]
s_add_u32 m0, s69, 1024
ds_read_b64_tr_b16 a[54:55], v14 offset:12544
v_mfma_f32_16x16x32_bf16 v[132:135], a[132:135], a[92:95], v[132:135]
s_add_u32 s73, s64, 16384
ds_read_b64_tr_b16 a[56:57], v15 offset:12288
v_mfma_f32_16x16x32_bf16 v[148:151], a[132:135], a[96:99], v[148:151]
buffer_load_dwordx4 v18, s[32:35], s73 offen lds
v_mfma_f32_16x16x32_bf16 v[152:155], a[136:139], a[84:87], v[152:155]
s_add_u32 m0, s69, 2048
ds_read_b64_tr_b16 a[58:59], v15 offset:12544
v_mfma_f32_16x16x32_bf16 v[160:163], a[136:139], a[88:91], v[160:163]
s_add_u32 s73, s64, 32768
ds_read_b64_tr_b16 a[60:61], v14 offset:16384
v_mfma_f32_16x16x32_bf16 v[168:171], a[136:139], a[92:95], v[168:171]
buffer_load_dwordx4 v17, s[32:35], s73 offen lds
v_mfma_f32_16x16x32_bf16 v[176:179], a[136:139], a[96:99], v[176:179]
ds_read_b64_tr_b16 a[62:63], v14 offset:16640
v_mfma_f32_16x16x32_bf16 v[156:159], a[140:143], a[84:87], v[156:159]
s_add_u32 m0, s69, 3072
ds_read_b64_tr_b16 a[64:65], v15 offset:16384
v_mfma_f32_16x16x32_bf16 v[164:167], a[140:143], a[88:91], v[164:167]
s_add_u32 s73, s64, 49152
ds_read_b64_tr_b16 a[66:67], v15 offset:16640
v_mfma_f32_16x16x32_bf16 v[172:175], a[140:143], a[92:95], v[172:175]
buffer_load_dwordx4 v18, s[32:35], s73 offen lds
v_mfma_f32_16x16x32_bf16 v[180:183], a[140:143], a[96:99], v[180:183]
s_add_u32 m0, s69, 4096
ds_read_b64_tr_b16 a[68:69], v14 offset:20480
v_mfma_f32_16x16x32_bf16 v[184:187], a[144:147], a[84:87], v[184:187]
s_add_u32 s73, s65, 0
ds_read_b64_tr_b16 a[70:71], v14 offset:20736
v_mfma_f32_16x16x32_bf16 v[192:195], a[144:147], a[88:91], v[192:195]
buffer_load_dwordx4 v17, s[32:35], s73 offen lds
v_mfma_f32_16x16x32_bf16 v[200:203], a[144:147], a[92:95], v[200:203]
ds_read_b64_tr_b16 a[72:73], v15 offset:20480
v_mfma_f32_16x16x32_bf16 v[208:211], a[144:147], a[96:99], v[208:211]
s_add_u32 m0, s69, 5120
ds_read_b64_tr_b16 a[74:75], v15 offset:20736
v_mfma_f32_16x16x32_bf16 v[188:191], a[148:151], a[84:87], v[188:191]
s_add_u32 s73, s65, 16384
ds_read_b128 a[16:19], v4 offset:36864
v_mfma_f32_16x16x32_bf16 v[196:199], a[148:151], a[88:91], v[196:199]
buffer_load_dwordx4 v18, s[32:35], s73 offen lds
v_mfma_f32_16x16x32_bf16 v[204:207], a[148:151], a[92:95], v[204:207]
ds_read_b64_tr_b16 a[76:77], v16 offset:16384
v_mfma_f32_16x16x32_bf16 v[212:215], a[148:151], a[96:99], v[212:215]
s_add_u32 m0, s69, 6144
ds_read_b64_tr_b16 a[78:79], v16 offset:16640
v_mfma_f32_16x16x32_bf16 v[216:219], a[84:87], a[152:155], v[216:219]
s_add_u32 s73, s65, 32768
ds_read_b64_tr_b16 a[80:81], v16 offset:20480
v_mfma_f32_16x16x32_bf16 v[224:227], a[88:91], a[152:155], v[224:227]
buffer_load_dwordx4 v17, s[32:35], s73 offen lds
v_mfma_f32_16x16x32_bf16 v[232:235], a[92:95], a[152:155], v[232:235]
s_add_u32 m0, s69, 7168
ds_read_b64_tr_b16 a[82:83], v16 offset:20736
v_mfma_f32_16x16x32_bf16 v[240:243], a[96:99], a[152:155], v[240:243]
s_add_u32 s73, s65, 49152
v_mfma_f32_16x16x32_bf16 v[220:223], a[84:87], a[156:159], v[220:223]
buffer_load_dwordx4 v18, s[32:35], s73 offen lds
v_mfma_f32_16x16x32_bf16 v[228:231], a[88:91], a[156:159], v[228:231]
v_mfma_f32_16x16x32_bf16 v[236:239], a[92:95], a[156:159], v[236:239]
s_add_u32 m0, s70, 32768
v_mfma_f32_16x16x32_bf16 v[244:247], a[96:99], a[156:159], v[244:247]
s_nop 0
v_mfma_f32_16x16x32_bf16 v[248:251], a[160:163], a[100:103], v[248:251]
buffer_load_dwordx4 v19, s[32:35], s66 offen lds
v_mfma_f32_16x16x32_bf16 v[252:255], a[100:103], a[164:167], v[252:255]
s_waitcnt lgkmcnt(15)
v_mfma_f32_16x16x32_bf16 v[24:27], a[20:23], a[0:3], v[24:27]
ds_read_b128 a[84:87], v3 offset:36864
v_mfma_f32_16x16x32_bf16 v[40:43], a[20:23], a[4:7], v[40:43]
ds_read_b128 a[88:91], v3 offset:38912
v_mfma_f32_16x16x32_bf16 v[56:59], a[20:23], a[8:11], v[56:59]
ds_read_b128 a[92:95], v3 offset:40960
v_mfma_f32_16x16x32_bf16 v[72:75], a[20:23], a[12:15], v[72:75]
s_waitcnt lgkmcnt(15)
ds_read_b128 a[96:99], v3 offset:43008
v_mfma_f32_16x16x32_bf16 v[88:91], a[24:27], a[0:3], v[88:91]
ds_read_b64_tr_b16 a[104:105], v6 offset:24576
v_mfma_f32_16x16x32_bf16 v[104:107], a[24:27], a[4:7], v[104:107]
ds_read_b64_tr_b16 a[106:107], v6 offset:25600
v_mfma_f32_16x16x32_bf16 v[120:123], a[24:27], a[8:11], v[120:123]
ds_read_b64_tr_b16 a[108:109], v7 offset:24576
v_mfma_f32_16x16x32_bf16 v[136:139], a[24:27], a[12:15], v[136:139]
s_waitcnt lgkmcnt(15)
ds_read_b64_tr_b16 a[110:111], v7 offset:25600
v_mfma_f32_16x16x32_bf16 v[28:31], a[28:31], a[0:3], v[28:31]
ds_read_b64_tr_b16 a[112:113], v8 offset:24576
v_mfma_f32_16x16x32_bf16 v[44:47], a[28:31], a[4:7], v[44:47]
ds_read_b64_tr_b16 a[114:115], v8 offset:25600
v_mfma_f32_16x16x32_bf16 v[60:63], a[28:31], a[8:11], v[60:63]
ds_read_b64_tr_b16 a[116:117], v9 offset:24576
v_mfma_f32_16x16x32_bf16 v[76:79], a[28:31], a[12:15], v[76:79]
s_waitcnt lgkmcnt(15)
ds_read_b64_tr_b16 a[118:119], v9 offset:25600
v_mfma_f32_16x16x32_bf16 v[92:95], a[32:35], a[0:3], v[92:95]
ds_read_b64_tr_b16 a[120:121], v10 offset:24576
v_mfma_f32_16x16x32_bf16 v[108:111], a[32:35], a[4:7], v[108:111]
ds_read_b64_tr_b16 a[122:123], v10 offset:25600
v_mfma_f32_16x16x32_bf16 v[124:127], a[32:35], a[8:11], v[124:127]
ds_read_b64_tr_b16 a[124:125], v11 offset:24576
v_mfma_f32_16x16x32_bf16 v[140:143], a[32:35], a[12:15], v[140:143]
s_waitcnt lgkmcnt(15)
ds_read_b64_tr_b16 a[126:127], v11 offset:25600
v_mfma_f32_16x16x32_bf16 v[32:35], a[36:39], a[0:3], v[32:35]
ds_read_b64_tr_b16 a[128:129], v12 offset:24576
v_mfma_f32_16x16x32_bf16 v[48:51], a[36:39], a[4:7], v[48:51]
ds_read_b64_tr_b16 a[130:131], v12 offset:25600
v_mfma_f32_16x16x32_bf16 v[64:67], a[36:39], a[8:11], v[64:67]
ds_read_b64_tr_b16 a[132:133], v13 offset:24576
v_mfma_f32_16x16x32_bf16 v[80:83], a[36:39], a[12:15], v[80:83]
s_waitcnt lgkmcnt(15)
ds_read_b64_tr_b16 a[134:135], v13 offset:25600
v_mfma_f32_16x16x32_bf16 v[96:99], a[40:43], a[0:3], v[96:99]
ds_read_b64_tr_b16 a[136:137], v14 offset:14336
v_mfma_f32_16x16x32_bf16 v[112:115], a[40:43], a[4:7], v[112:115]
ds_read_b64_tr_b16 a[138:139], v14 offset:14592
v_mfma_f32_16x16x32_bf16 v[128:131], a[40:43], a[8:11], v[128:131]
ds_read_b64_tr_b16 a[140:141], v15 offset:14336
v_mfma_f32_16x16x32_bf16 v[144:147], a[40:43], a[12:15], v[144:147]
s_waitcnt lgkmcnt(15)
ds_read_b64_tr_b16 a[142:143], v15 offset:14592
v_mfma_f32_16x16x32_bf16 v[36:39], a[44:47], a[0:3], v[36:39]
ds_read_b64_tr_b16 a[144:145], v14 offset:18432
v_mfma_f32_16x16x32_bf16 v[52:55], a[44:47], a[4:7], v[52:55]
ds_read_b64_tr_b16 a[146:147], v14 offset:18688
v_mfma_f32_16x16x32_bf16 v[68:71], a[44:47], a[8:11], v[68:71]
ds_read_b64_tr_b16 a[148:149], v15 offset:18432
v_mfma_f32_16x16x32_bf16 v[84:87], a[44:47], a[12:15], v[84:87]
s_waitcnt lgkmcnt(15)
ds_read_b64_tr_b16 a[150:151], v15 offset:18688
v_mfma_f32_16x16x32_bf16 v[100:103], a[48:51], a[0:3], v[100:103]
ds_read_b64_tr_b16 a[152:153], v14 offset:22528
v_mfma_f32_16x16x32_bf16 v[116:119], a[48:51], a[4:7], v[116:119]
ds_read_b64_tr_b16 a[154:155], v14 offset:22784
v_mfma_f32_16x16x32_bf16 v[132:135], a[48:51], a[8:11], v[132:135]
ds_read_b64_tr_b16 a[156:157], v15 offset:22528
v_mfma_f32_16x16x32_bf16 v[148:151], a[48:51], a[12:15], v[148:151]
s_waitcnt lgkmcnt(15)
ds_read_b64_tr_b16 a[158:159], v15 offset:22784
v_mfma_f32_16x16x32_bf16 v[152:155], a[52:55], a[0:3], v[152:155]
ds_read_b128 a[100:103], v5 offset:36864
v_mfma_f32_16x16x32_bf16 v[160:163], a[52:55], a[4:7], v[160:163]
ds_read_b64_tr_b16 a[160:161], v16 offset:18432
v_mfma_f32_16x16x32_bf16 v[168:171], a[52:55], a[8:11], v[168:171]
ds_read_b64_tr_b16 a[162:163], v16 offset:18688
v_mfma_f32_16x16x32_bf16 v[176:179], a[52:55], a[12:15], v[176:179]
s_waitcnt lgkmcnt(15)
ds_read_b64_tr_b16 a[164:165], v16 offset:22528
v_mfma_f32_16x16x32_bf16 v[156:159], a[56:59], a[0:3], v[156:159]
ds_read_b64_tr_b16 a[166:167], v16 offset:22784
v_mfma_f32_16x16x32_bf16 v[164:167], a[56:59], a[4:7], v[164:167]
s_add_u32 s64, s64, 128
v_mfma_f32_16x16x32_bf16 v[172:175], a[56:59], a[8:11], v[172:175]
s_add_u32 s65, s65, 128
v_mfma_f32_16x16x32_bf16 v[180:183], a[56:59], a[12:15], v[180:183]
s_waitcnt lgkmcnt(15)
s_add_u32 s66, s66, 128
v_mfma_f32_16x16x32_bf16 v[184:187], a[60:63], a[0:3], v[184:187]
s_add_u32 s67, s67, 524288
v_mfma_f32_16x16x32_bf16 v[192:195], a[60:63], a[4:7], v[192:195]
s_add_u32 s68, s68, 393216
v_mfma_f32_16x16x32_bf16 v[200:203], a[60:63], a[8:11], v[200:203]
v_mfma_f32_16x16x32_bf16 v[208:211], a[60:63], a[12:15], v[208:211]
s_waitcnt lgkmcnt(15)
v_mfma_f32_16x16x32_bf16 v[188:191], a[64:67], a[0:3], v[188:191]
v_mfma_f32_16x16x32_bf16 v[196:199], a[64:67], a[4:7], v[196:199]
v_mfma_f32_16x16x32_bf16 v[204:207], a[64:67], a[8:11], v[204:207]
v_mfma_f32_16x16x32_bf16 v[212:215], a[64:67], a[12:15], v[212:215]
s_waitcnt lgkmcnt(15)
v_mfma_f32_16x16x32_bf16 v[216:219], a[0:3], a[68:71], v[216:219]
v_mfma_f32_16x16x32_bf16 v[224:227], a[4:7], a[68:71], v[224:227]
v_mfma_f32_16x16x32_bf16 v[232:235], a[8:11], a[68:71], v[232:235]
v_mfma_f32_16x16x32_bf16 v[240:243], a[12:15], a[68:71], v[240:243]
s_waitcnt lgkmcnt(15)
v_mfma_f32_16x16x32_bf16 v[220:223], a[0:3], a[72:75], v[220:223]
v_mfma_f32_16x16x32_bf16 v[228:231], a[4:7], a[72:75], v[228:231]
v_mfma_f32_16x16x32_bf16 v[236:239], a[8:11], a[72:75], v[236:239]
v_mfma_f32_16x16x32_bf16 v[244:247], a[12:15], a[72:75], v[244:247]
s_waitcnt lgkmcnt(15)
v_mfma_f32_16x16x32_bf16 v[248:251], a[76:79], a[16:19], v[248:251]
s_waitcnt lgkmcnt(15)
v_mfma_f32_16x16x32_bf16 v[252:255], a[16:19], a[80:83], v[252:255]
s_waitcnt vmcnt(0) lgkmcnt(0)
s_barrier
v_mfma_f32_16x16x32_bf16 v[24:27], a[104:107], a[84:87], v[24:27]
s_add_u32 m0, s71, 90112
ds_read_b128 a[0:3], v2 offset:0
v_mfma_f32_16x16x32_bf16 v[40:43], a[104:107], a[88:91], v[40:43]
s_add_u32 s73, s67, 0
ds_read_b128 a[4:7], v2 offset:2048
v_mfma_f32_16x16x32_bf16 v[56:59], a[104:107], a[92:95], v[56:59]
buffer_load_dwordx4 v20, s[36:39], s73 offen lds
v_mfma_f32_16x16x32_bf16 v[72:75], a[104:107], a[96:99], v[72:75]
s_add_u32 m0, s71, 91136
ds_read_b128 a[8:11], v2 offset:4096
v_mfma_f32_16x16x32_bf16 v[88:91], a[108:111], a[84:87], v[88:91]
s_add_u32 s73, s67, 32768
ds_read_b128 a[12:15], v2 offset:6144
v_mfma_f32_16x16x32_bf16 v[104:107], a[108:111], a[88:91], v[104:107]
buffer_load_dwordx4 v20, s[36:39], s73 offen lds
v_mfma_f32_16x16x32_bf16 v[120:123], a[108:111], a[92:95], v[120:123]
ds_read_b64_tr_b16 a[20:21], v6 offset:0
v_mfma_f32_16x16x32_bf16 v[136:139], a[108:111], a[96:99], v[136:139]
s_add_u32 m0, s71, 92160
ds_read_b64_tr_b16 a[22:23], v6 offset:1024
v_mfma_f32_16x16x32_bf16 v[28:31], a[112:115], a[84:87], v[28:31]
s_add_u32 s73, s67, 65536
ds_read_b64_tr_b16 a[24:25], v7 offset:0
v_mfma_f32_16x16x32_bf16 v[44:47], a[112:115], a[88:91], v[44:47]
buffer_load_dwordx4 v21, s[36:39], s73 offen lds
v_mfma_f32_16x16x32_bf16 v[60:63], a[112:115], a[92:95], v[60:63]
s_add_u32 m0, s71, 93184
ds_read_b64_tr_b16 a[26:27], v7 offset:1024
v_mfma_f32_16x16x32_bf16 v[76:79], a[112:115], a[96:99], v[76:79]
s_add_u32 s73, s67, 98304
ds_read_b64_tr_b16 a[28:29], v8 offset:0
v_mfma_f32_16x16x32_bf16 v[92:95], a[116:119], a[84:87], v[92:95]
buffer_load_dwordx4 v21, s[36:39], s73 offen lds
v_mfma_f32_16x16x32_bf16 v[108:111], a[116:119], a[88:91], v[108:111]
ds_read_b64_tr_b16 a[30:31], v8 offset:1024
v_mfma_f32_16x16x32_bf16 v[124:127], a[116:119], a[92:95], v[124:127]
s_add_u32 m0, s70, 118784
ds_read_b64_tr_b16 a[32:33], v9 offset:0
v_mfma_f32_16x16x32_bf16 v[140:143], a[116:119], a[96:99], v[140:143]
s_add_u32 s73, s68, 0
ds_read_b64_tr_b16 a[34:35], v9 offset:1024
v_mfma_f32_16x16x32_bf16 v[32:35], a[120:123], a[84:87], v[32:35]
buffer_load_dwordx4 v22, s[40:43], s73 offen lds
v_mfma_f32_16x16x32_bf16 v[48:51], a[120:123], a[88:91], v[48:51]
ds_read_b64_tr_b16 a[36:37], v10 offset:0
v_mfma_f32_16x16x32_bf16 v[64:67], a[120:123], a[92:95], v[64:67]
s_add_u32 m0, s70, 122880
ds_read_b64_tr_b16 a[38:39], v10 offset:1024
v_mfma_f32_16x16x32_bf16 v[80:83], a[120:123], a[96:99], v[80:83]
s_add_u32 s73, s68, 2048
ds_read_b64_tr_b16 a[40:41], v11 offset:0
v_mfma_f32_16x16x32_bf16 v[96:99], a[124:127], a[84:87], v[96:99]
buffer_load_dwordx4 v22, s[40:43], s73 offen lds
v_mfma_f32_16x16x32_bf16 v[112:115], a[124:127], a[88:91], v[112:115]
s_add_u32 m0, s70, 126976
ds_read_b64_tr_b16 a[42:43], v11 offset:1024
v_mfma_f32_16x16x32_bf16 v[128:131], a[124:127], a[92:95], v[128:131]
s_add_u32 s73, s68, 4096
ds_read_b64_tr_b16 a[44:45], v12 offset:0
v_mfma_f32_16x16x32_bf16 v[144:147], a[124:127], a[96:99], v[144:147]
buffer_load_dwordx4 v22, s[40:43], s73 offen lds
v_mfma_f32_16x16x32_bf16 v[36:39], a[128:131], a[84:87], v[36:39]
ds_read_b64_tr_b16 a[46:47], v12 offset:1024
v_mfma_f32_16x16x32_bf16 v[52:55], a[128:131], a[88:91], v[52:55]
s_add_u32 m0, s69, 36864
ds_read_b64_tr_b16 a[48:49], v13 offset:0
v_mfma_f32_16x16x32_bf16 v[68:71], a[128:131], a[92:95], v[68:71]
s_add_u32 s73, s64, 0
ds_read_b64_tr_b16 a[50:51], v13 offset:1024
v_mfma_f32_16x16x32_bf16 v[84:87], a[128:131], a[96:99], v[84:87]
buffer_load_dwordx4 v17, s[32:35], s73 offen lds
v_mfma_f32_16x16x32_bf16 v[100:103], a[132:135], a[84:87], v[100:103]
ds_read_b64_tr_b16 a[52:53], v14 offset:0
v_mfma_f32_16x16x32_bf16 v[116:119], a[132:135], a[88:91], v[116:119]
s_add_u32 m0, s69, 37888
ds_read_b64_tr_b16 a[54:55], v14 offset:256
v_mfma_f32_16x16x32_bf16 v[132:135], a[132:135], a[92:95], v[132:135]
s_add_u32 s73, s64, 16384
ds_read_b64_tr_b16 a[56:57], v15 offset:0
v_mfma_f32_16x16x32_bf16 v[148:151], a[132:135], a[96:99], v[148:151]
buffer_load_dwordx4 v18, s[32:35], s73 offen lds
v_mfma_f32_16x16x32_bf16 v[152:155], a[136:139], a[84:87], v[152:155]
s_add_u32 m0, s69, 38912
ds_read_b64_tr_b16 a[58:59], v15 offset:256
v_mfma_f32_16x16x32_bf16 v[160:163], a[136:139], a[88:91], v[160:163]
s_add_u32 s73, s64, 32768
ds_read_b64_tr_b16 a[60:61], v14 offset:4096
v_mfma_f32_16x16x32_bf16 v[168:171], a[136:139], a[92:95], v[168:171]
buffer_load_dwordx4 v17, s[32:35], s73 offen lds
v_mfma_f32_16x16x32_bf16 v[176:179], a[136:139], a[96:99], v[176:179]
ds_read_b64_tr_b16 a[62:63], v14 offset:4352
v_mfma_f32_16x16x32_bf16 v[156:159], a[140:143], a[84:87], v[156:159]
s_add_u32 m0, s69, 39936
ds_read_b64_tr_b16 a[64:65], v15 offset:4096
v_mfma_f32_16x16x32_bf16 v[164:167], a[140:143], a[88:91], v[164:167]
s_add_u32 s73, s64, 49152
ds_read_b64_tr_b16 a[66:67], v15 offset:4352
v_mfma_f32_16x16x32_bf16 v[172:175], a[140:143], a[92:95], v[172:175]
buffer_load_dwordx4 v18, s[32:35], s73 offen lds
v_mfma_f32_16x16x32_bf16 v[180:183], a[140:143], a[96:99], v[180:183]
s_add_u32 m0, s69, 40960
ds_read_b64_tr_b16 a[68:69], v14 offset:8192
v_mfma_f32_16x16x32_bf16 v[184:187], a[144:147], a[84:87], v[184:187]
s_add_u32 s73, s65, 0
ds_read_b64_tr_b16 a[70:71], v14 offset:8448
v_mfma_f32_16x16x32_bf16 v[192:195], a[144:147], a[88:91], v[192:195]
buffer_load_dwordx4 v17, s[32:35], s73 offen lds
v_mfma_f32_16x16x32_bf16 v[200:203], a[144:147], a[92:95], v[200:203]
ds_read_b64_tr_b16 a[72:73], v15 offset:8192
v_mfma_f32_16x16x32_bf16 v[208:211], a[144:147], a[96:99], v[208:211]
s_add_u32 m0, s69, 41984
ds_read_b64_tr_b16 a[74:75], v15 offset:8448
v_mfma_f32_16x16x32_bf16 v[188:191], a[148:151], a[84:87], v[188:191]
s_add_u32 s73, s65, 16384
ds_read_b128 a[16:19], v4 offset:0
v_mfma_f32_16x16x32_bf16 v[196:199], a[148:151], a[88:91], v[196:199]
buffer_load_dwordx4 v18, s[32:35], s73 offen lds
v_mfma_f32_16x16x32_bf16 v[204:207], a[148:151], a[92:95], v[204:207]
ds_read_b64_tr_b16 a[76:77], v16 offset:4096
v_mfma_f32_16x16x32_bf16 v[212:215], a[148:151], a[96:99], v[212:215]
s_add_u32 m0, s69, 43008
ds_read_b64_tr_b16 a[78:79], v16 offset:4352
v_mfma_f32_16x16x32_bf16 v[216:219], a[84:87], a[152:155], v[216:219]
s_add_u32 s73, s65, 32768
ds_read_b64_tr_b16 a[80:81], v16 offset:8192
v_mfma_f32_16x16x32_bf16 v[224:227], a[88:91], a[152:155], v[224:227]
buffer_load_dwordx4 v17, s[32:35], s73 offen lds
v_mfma_f32_16x16x32_bf16 v[232:235], a[92:95], a[152:155], v[232:235]
s_add_u32 m0, s69, 44032
ds_read_b64_tr_b16 a[82:83], v16 offset:8448
v_mfma_f32_16x16x32_bf16 v[240:243], a[96:99], a[152:155], v[240:243]
s_add_u32 s73, s65, 49152
v_mfma_f32_16x16x32_bf16 v[220:223], a[84:87], a[156:159], v[220:223]
buffer_load_dwordx4 v18, s[32:35], s73 offen lds
v_mfma_f32_16x16x32_bf16 v[228:231], a[88:91], a[156:159], v[228:231]
v_mfma_f32_16x16x32_bf16 v[236:239], a[92:95], a[156:159], v[236:239]
s_add_u32 m0, s70, 69632
v_mfma_f32_16x16x32_bf16 v[244:247], a[96:99], a[156:159], v[244:247]
s_nop 0
v_mfma_f32_16x16x32_bf16 v[248:251], a[160:163], a[100:103], v[248:251]
buffer_load_dwordx4 v19, s[32:35], s66 offen lds
v_mfma_f32_16x16x32_bf16 v[252:255], a[100:103], a[164:167], v[252:255]
s_sub_u32 s74, s74, 1
s_cmp_lg_u32 s74, 0
s_cbranch_scc1 L_p2_4
s_waitcnt lgkmcnt(15)
v_mfma_f32_16x16x32_bf16 v[24:27], a[20:23], a[0:3], v[24:27]
ds_read_b128 a[84:87], v3 offset:0
v_mfma_f32_16x16x32_bf16 v[40:43], a[20:23], a[4:7], v[40:43]
ds_read_b128 a[88:91], v3 offset:2048
v_mfma_f32_16x16x32_bf16 v[56:59], a[20:23], a[8:11], v[56:59]
ds_read_b128 a[92:95], v3 offset:4096
v_mfma_f32_16x16x32_bf16 v[72:75], a[20:23], a[12:15], v[72:75]
s_waitcnt lgkmcnt(15)
ds_read_b128 a[96:99], v3 offset:6144
v_mfma_f32_16x16x32_bf16 v[88:91], a[24:27], a[0:3], v[88:91]
ds_read_b64_tr_b16 a[104:105], v6 offset:8192
v_mfma_f32_16x16x32_bf16 v[104:107], a[24:27], a[4:7], v[104:107]
ds_read_b64_tr_b16 a[106:107], v6 offset:9216
v_mfma_f32_16x16x32_bf16 v[120:123], a[24:27], a[8:11], v[120:123]
ds_read_b64_tr_b16 a[108:109], v7 offset:8192
v_mfma_f32_16x16x32_bf16 v[136:139], a[24:27], a[12:15], v[136:139]
s_waitcnt lgkmcnt(15)
ds_read_b64_tr_b16 a[110:111], v7 offset:9216
v_mfma_f32_16x16x32_bf16 v[28:31], a[28:31], a[0:3], v[28:31]
ds_read_b64_tr_b16 a[112:113], v8 offset:8192
v_mfma_f32_16x16x32_bf16 v[44:47], a[28:31], a[4:7], v[44:47]
ds_read_b64_tr_b16 a[114:115], v8 offset:9216
v_mfma_f32_16x16x32_bf16 v[60:63], a[28:31], a[8:11], v[60:63]
ds_read_b64_tr_b16 a[116:117], v9 offset:8192
v_mfma_f32_16x16x32_bf16 v[76:79], a[28:31], a[12:15], v[76:79]
s_waitcnt lgkmcnt(15)
ds_read_b64_tr_b16 a[118:119], v9 offset:9216
v_mfma_f32_16x16x32_bf16 v[92:95], a[32:35], a[0:3], v[92:95]
ds_read_b64_tr_b16 a[120:121], v10 offset:8192
v_mfma_f32_16x16x32_bf16 v[108:111], a[32:35], a[4:7], v[108:111]
ds_read_b64_tr_b16 a[122:123], v10 offset:9216
v_mfma_f32_16x16x32_bf16 v[124:127], a[32:35], a[8:11], v[124:127]
ds_read_b64_tr_b16 a[124:125], v11 offset:8192
v_mfma_f32_16x16x32_bf16 v[140:143], a[32:35], a[12:15], v[140:143]
s_waitcnt lgkmcnt(15)
ds_read_b64_tr_b16 a[126:127], v11 offset:9216
v_mfma_f32_16x16x32_bf16 v[32:35], a[36:39], a[0:3], v[32:35]
ds_read_b64_tr_b16 a[128:129], v12 offset:8192
v_mfma_f32_16x16x32_bf16 v[48:51], a[36:39], a[4:7], v[48:51]
ds_read_b64_tr_b16 a[130:131], v12 offset:9216
v_mfma_f32_16x16x32_bf16 v[64:67], a[36:39], a[8:11], v[64:67]
ds_read_b64_tr_b16 a[132:133], v13 offset:8192
v_mfma_f32_16x16x32_bf16 v[80:83], a[36:39], a[12:15], v[80:83]
s_waitcnt lgkmcnt(15)
ds_read_b64_tr_b16 a[134:135], v13 offset:9216
v_mfma_f32_16x16x32_bf16 v[96:99], a[40:43], a[0:3], v[96:99]
ds_read_b64_tr_b16 a[136:137], v14 offset:2048
v_mfma_f32_16x16x32_bf16 v[112:115], a[40:43], a[4:7], v[112:115]
ds_read_b64_tr_b16 a[138:139], v14 offset:2304
v_mfma_f32_16x16x32_bf16 v[128:131], a[40:43], a[8:11], v[128:131]
ds_read_b64_tr_b16 a[140:141], v15 offset:2048
v_mfma_f32_16x16x32_bf16 v[144:147], a[40:43], a[12:15], v[144:147]
s_waitcnt lgkmcnt(15)
ds_read_b64_tr_b16 a[142:143], v15 offset:2304
v_mfma_f32_16x16x32_bf16 v[36:39], a[44:47], a[0:3], v[36:39]
ds_read_b64_tr_b16 a[144:145], v14 offset:6144
v_mfma_f32_16x16x32_bf16 v[52:55], a[44:47], a[4:7], v[52:55]
ds_read_b64_tr_b16 a[146:147], v14 offset:6400
v_mfma_f32_16x16x32_bf16 v[68:71], a[44:47], a[8:11], v[68:71]
ds_read_b64_tr_b16 a[148:149], v15 offset:6144
v_mfma_f32_16x16x32_bf16 v[84:87], a[44:47], a[12:15], v[84:87]
s_waitcnt lgkmcnt(15)
ds_read_b64_tr_b16 a[150:151], v15 offset:6400
v_mfma_f32_16x16x32_bf16 v[100:103], a[48:51], a[0:3], v[100:103]
ds_read_b64_tr_b16 a[152:153], v14 offset:10240
v_mfma_f32_16x16x32_bf16 v[116:119], a[48:51], a[4:7], v[116:119]
ds_read_b64_tr_b16 a[154:155], v14 offset:10496
v_mfma_f32_16x16x32_bf16 v[132:135], a[48:51], a[8:11], v[132:135]
ds_read_b64_tr_b16 a[156:157], v15 offset:10240
v_mfma_f32_16x16x32_bf16 v[148:151], a[48:51], a[12:15], v[148:151]
s_waitcnt lgkmcnt(15)
ds_read_b64_tr_b16 a[158:159], v15 offset:10496
v_mfma_f32_16x16x32_bf16 v[152:155], a[52:55], a[0:3], v[152:155]
ds_read_b128 a[100:103], v5 offset:0
v_mfma_f32_16x16x32_bf16 v[160:163], a[52:55], a[4:7], v[160:163]
ds_read_b64_tr_b16 a[160:161], v16 offset:6144
v_mfma_f32_16x16x32_bf16 v[168:171], a[52:55], a[8:11], v[168:171]
ds_read_b64_tr_b16 a[162:163], v16 offset:6400
v_mfma_f32_16x16x32_bf16 v[176:179], a[52:55], a[12:15], v[176:179]
s_waitcnt lgkmcnt(15)
ds_read_b64_tr_b16 a[164:165], v16 offset:10240
v_mfma_f32_16x16x32_bf16 v[156:159], a[56:59], a[0:3], v[156:159]
ds_read_b64_tr_b16 a[166:167], v16 offset:10496
v_mfma_f32_16x16x32_bf16 v[164:167], a[56:59], a[4:7], v[164:167]
v_mfma_f32_16x16x32_bf16 v[172:175], a[56:59], a[8:11], v[172:175]
v_mfma_f32_16x16x32_bf16 v[180:183], a[56:59], a[12:15], v[180:183]
s_waitcnt lgkmcnt(15)
v_mfma_f32_16x16x32_bf16 v[184:187], a[60:63], a[0:3], v[184:187]
v_mfma_f32_16x16x32_bf16 v[192:195], a[60:63], a[4:7], v[192:195]
v_mfma_f32_16x16x32_bf16 v[200:203], a[60:63], a[8:11], v[200:203]
v_mfma_f32_16x16x32_bf16 v[208:211], a[60:63], a[12:15], v[208:211]
s_waitcnt lgkmcnt(15)
v_mfma_f32_16x16x32_bf16 v[188:191], a[64:67], a[0:3], v[188:191]
v_mfma_f32_16x16x32_bf16 v[196:199], a[64:67], a[4:7], v[196:199]
v_mfma_f32_16x16x32_bf16 v[204:207], a[64:67], a[8:11], v[204:207]
v_mfma_f32_16x16x32_bf16 v[212:215], a[64:67], a[12:15], v[212:215]
s_waitcnt lgkmcnt(15)
v_mfma_f32_16x16x32_bf16 v[216:219], a[0:3], a[68:71], v[216:219]
v_mfma_f32_16x16x32_bf16 v[224:227], a[4:7], a[68:71], v[224:227]
v_mfma_f32_16x16x32_bf16 v[232:235], a[8:11], a[68:71], v[232:235]
v_mfma_f32_16x16x32_bf16 v[240:243], a[12:15], a[68:71], v[240:243]
s_waitcnt lgkmcnt(15)
v_mfma_f32_16x16x32_bf16 v[220:223], a[0:3], a[72:75], v[220:223]
v_mfma_f32_16x16x32_bf16 v[228:231], a[4:7], a[72:75], v[228:231]
v_mfma_f32_16x16x32_bf16 v[236:239], a[8:11], a[72:75], v[236:239]
v_mfma_f32_16x16x32_bf16 v[244:247], a[12:15], a[72:75], v[244:247]
s_waitcnt lgkmcnt(15)
v_mfma_f32_16x16x32_bf16 v[248:251], a[76:79], a[16:19], v[248:251]
s_waitcnt lgkmcnt(15)
v_mfma_f32_16x16x32_bf16 v[252:255], a[16:19], a[80:83], v[252:255]
s_waitcnt vmcnt(0) lgkmcnt(0)
s_barrier
v_mfma_f32_16x16x32_bf16 v[24:27], a[104:107], a[84:87], v[24:27]
ds_read_b128 a[0:3], v2 offset:36864
v_mfma_f32_16x16x32_bf16 v[40:43], a[104:107], a[88:91], v[40:43]
ds_read_b128 a[4:7], v2 offset:38912
v_mfma_f32_16x16x32_bf16 v[56:59], a[104:107], a[92:95], v[56:59]
ds_read_b128 a[8:11], v2 offset:40960
v_mfma_f32_16x16x32_bf16 v[72:75], a[104:107], a[96:99], v[72:75]
ds_read_b128 a[12:15], v2 offset:43008
v_mfma_f32_16x16x32_bf16 v[88:91], a[108:111], a[84:87], v[88:91]
ds_read_b64_tr_b16 a[20:21], v6 offset:16384
v_mfma_f32_16x16x32_bf16 v[104:107], a[108:111], a[88:91], v[104:107]
ds_read_b64_tr_b16 a[22:23], v6 offset:17408
v_mfma_f32_16x16x32_bf16 v[120:123], a[108:111], a[92:95], v[120:123]
ds_read_b64_tr_b16 a[24:25], v7 offset:16384
v_mfma_f32_16x16x32_bf16 v[136:139], a[108:111], a[96:99], v[136:139]
ds_read_b64_tr_b16 a[26:27], v7 offset:17408
v_mfma_f32_16x16x32_bf16 v[28:31], a[112:115], a[84:87], v[28:31]
ds_read_b64_tr_b16 a[28:29], v8 offset:16384
v_mfma_f32_16x16x32_bf16 v[44:47], a[112:115], a[88:91], v[44:47]
ds_read_b64_tr_b16 a[30:31], v8 offset:17408
v_mfma_f32_16x16x32_bf16 v[60:63], a[112:115], a[92:95], v[60:63]
ds_read_b64_tr_b16 a[32:33], v9 offset:16384
v_mfma_f32_16x16x32_bf16 v[76:79], a[112:115], a[96:99], v[76:79]
ds_read_b64_tr_b16 a[34:35], v9 offset:17408
v_mfma_f32_16x16x32_bf16 v[92:95], a[116:119], a[84:87], v[92:95]
ds_read_b64_tr_b16 a[36:37], v10 offset:16384
v_mfma_f32_16x16x32_bf16 v[108:111], a[116:119], a[88:91], v[108:111]
ds_read_b64_tr_b16 a[38:39], v10 offset:17408
v_mfma_f32_16x16x32_bf16 v[124:127], a[116:119], a[92:95], v[124:127]
ds_read_b64_tr_b16 a[40:41], v11 offset:16384
v_mfma_f32_16x16x32_bf16 v[140:143], a[116:119], a[96:99], v[140:143]
ds_read_b64_tr_b16 a[42:43], v11 offset:17408
v_mfma_f32_16x16x32_bf16 v[32:35], a[120:123], a[84:87], v[32:35]
ds_read_b64_tr_b16 a[44:45], v12 offset:16384
v_mfma_f32_16x16x32_bf16 v[48:51], a[120:123], a[88:91], v[48:51]
ds_read_b64_tr_b16 a[46:47], v12 offset:17408
v_mfma_f32_16x16x32_bf16 v[64:67], a[120:123], a[92:95], v[64:67]
ds_read_b64_tr_b16 a[48:49], v13 offset:16384
v_mfma_f32_16x16x32_bf16 v[80:83], a[120:123], a[96:99], v[80:83]
ds_read_b64_tr_b16 a[50:51], v13 offset:17408
v_mfma_f32_16x16x32_bf16 v[96:99], a[124:127], a[84:87], v[96:99]
ds_read_b64_tr_b16 a[52:53], v14 offset:12288
v_mfma_f32_16x16x32_bf16 v[112:115], a[124:127], a[88:91], v[112:115]
ds_read_b64_tr_b16 a[54:55], v14 offset:12544
v_mfma_f32_16x16x32_bf16 v[128:131], a[124:127], a[92:95], v[128:131]
ds_read_b64_tr_b16 a[56:57], v15 offset:12288
v_mfma_f32_16x16x32_bf16 v[144:147], a[124:127], a[96:99], v[144:147]
ds_read_b64_tr_b16 a[58:59], v15 offset:12544
v_mfma_f32_16x16x32_bf16 v[36:39], a[128:131], a[84:87], v[36:39]
ds_read_b64_tr_b16 a[60:61], v14 offset:16384
v_mfma_f32_16x16x32_bf16 v[52:55], a[128:131], a[88:91], v[52:55]
ds_read_b64_tr_b16 a[62:63], v14 offset:16640
v_mfma_f32_16x16x32_bf16 v[68:71], a[128:131], a[92:95], v[68:71]
ds_read_b64_tr_b16 a[64:65], v15 offset:16384
v_mfma_f32_16x16x32_bf16 v[84:87], a[128:131], a[96:99], v[84:87]
ds_read_b64_tr_b16 a[66:67], v15 offset:16640
v_mfma_f32_16x16x32_bf16 v[100:103], a[132:135], a[84:87], v[100:103]
ds_read_b64_tr_b16 a[68:69], v14 offset:20480
v_mfma_f32_16x16x32_bf16 v[116:119], a[132:135], a[88:91], v[116:119]
ds_read_b64_tr_b16 a[70:71], v14 offset:20736
v_mfma_f32_16x16x32_bf16 v[132:135], a[132:135], a[92:95], v[132:135]
ds_read_b64_tr_b16 a[72:73], v15 offset:20480
v_mfma_f32_16x16x32_bf16 v[148:151], a[132:135], a[96:99], v[148:151]
ds_read_b64_tr_b16 a[74:75], v15 offset:20736
v_mfma_f32_16x16x32_bf16 v[152:155], a[136:139], a[84:87], v[152:155]
ds_read_b128 a[16:19], v4 offset:36864
v_mfma_f32_16x16x32_bf16 v[160:163], a[136:139], a[88:91], v[160:163]
ds_read_b64_tr_b16 a[76:77], v16 offset:16384
v_mfma_f32_16x16x32_bf16 v[168:171], a[136:139], a[92:95], v[168:171]
ds_read_b64_tr_b16 a[78:79], v16 offset:16640
v_mfma_f32_16x16x32_bf16 v[176:179], a[136:139], a[96:99], v[176:179]
ds_read_b64_tr_b16 a[80:81], v16 offset:20480
v_mfma_f32_16x16x32_bf16 v[156:159], a[140:143], a[84:87], v[156:159]
ds_read_b64_tr_b16 a[82:83], v16 offset:20736
v_mfma_f32_16x16x32_bf16 v[164:167], a[140:143], a[88:91], v[164:167]
v_mfma_f32_16x16x32_bf16 v[172:175], a[140:143], a[92:95], v[172:175]
v_mfma_f32_16x16x32_bf16 v[180:183], a[140:143], a[96:99], v[180:183]
v_mfma_f32_16x16x32_bf16 v[184:187], a[144:147], a[84:87], v[184:187]
v_mfma_f32_16x16x32_bf16 v[192:195], a[144:147], a[88:91], v[192:195]
v_mfma_f32_16x16x32_bf16 v[200:203], a[144:147], a[92:95], v[200:203]
v_mfma_f32_16x16x32_bf16 v[208:211], a[144:147], a[96:99], v[208:211]
v_mfma_f32_16x16x32_bf16 v[188:191], a[148:151], a[84:87], v[188:191]
v_mfma_f32_16x16x32_bf16 v[196:199], a[148:151], a[88:91], v[196:199]
v_mfma_f32_16x16x32_bf16 v[204:207], a[148:151], a[92:95], v[204:207]
v_mfma_f32_16x16x32_bf16 v[212:215], a[148:151], a[96:99], v[212:215]
v_mfma_f32_16x16x32_bf16 v[216:219], a[84:87], a[152:155], v[216:219]
v_mfma_f32_16x16x32_bf16 v[224:227], a[88:91], a[152:155], v[224:227]
v_mfma_f32_16x16x32_bf16 v[232:235], a[92:95], a[152:155], v[232:235]
v_mfma_f32_16x16x32_bf16 v[240:243], a[96:99], a[152:155], v[240:243]
v_mfma_f32_16x16x32_bf16 v[220:223], a[84:87], a[156:159], v[220:223]
v_mfma_f32_16x16x32_bf16 v[228:231], a[88:91], a[156:159], v[228:231]
v_mfma_f32_16x16x32_bf16 v[236:239], a[92:95], a[156:159], v[236:239]
v_mfma_f32_16x16x32_bf16 v[244:247], a[96:99], a[156:159], v[244:247]
v_mfma_f32_16x16x32_bf16 v[248:251], a[160:163], a[100:103], v[248:251]
v_mfma_f32_16x16x32_bf16 v[252:255], a[100:103], a[164:167], v[252:255]
s_waitcnt lgkmcnt(15)
v_mfma_f32_16x16x32_bf16 v[24:27], a[20:23], a[0:3], v[24:27]
ds_read_b128 a[84:87], v3 offset:36864
v_mfma_f32_16x16x32_bf16 v[40:43], a[20:23], a[4:7], v[40:43]
ds_read_b128 a[88:91], v3 offset:38912
v_mfma_f32_16x16x32_bf16 v[56:59], a[20:23], a[8:11], v[56:59]
ds_read_b128 a[92:95], v3 offset:40960
v_mfma_f32_16x16x32_bf16 v[72:75], a[20:23], a[12:15], v[72:75]
s_waitcnt lgkmcnt(15)
ds_read_b128 a[96:99], v3 offset:43008
v_mfma_f32_16x16x32_bf16 v[88:91], a[24:27], a[0:3], v[88:91]
ds_read_b64_tr_b16 a[104:105], v6 offset:24576
v_mfma_f32_16x16x32_bf16 v[104:107], a[24:27], a[4:7], v[104:107]
ds_read_b64_tr_b16 a[106:107], v6 offset:25600
v_mfma_f32_16x16x32_bf16 v[120:123], a[24:27], a[8:11], v[120:123]
ds_read_b64_tr_b16 a[108:109], v7 offset:24576
v_mfma_f32_16x16x32_bf16 v[136:139], a[24:27], a[12:15], v[136:139]
s_waitcnt lgkmcnt(15)
ds_read_b64_tr_b16 a[110:111], v7 offset:25600
v_mfma_f32_16x16x32_bf16 v[28:31], a[28:31], a[0:3], v[28:31]
ds_read_b64_tr_b16 a[112:113], v8 offset:24576
v_mfma_f32_16x16x32_bf16 v[44:47], a[28:31], a[4:7], v[44:47]
ds_read_b64_tr_b16 a[114:115], v8 offset:25600
v_mfma_f32_16x16x32_bf16 v[60:63], a[28:31], a[8:11], v[60:63]
ds_read_b64_tr_b16 a[116:117], v9 offset:24576
v_mfma_f32_16x16x32_bf16 v[76:79], a[28:31], a[12:15], v[76:79]
s_waitcnt lgkmcnt(15)
ds_read_b64_tr_b16 a[118:119], v9 offset:25600
v_mfma_f32_16x16x32_bf16 v[92:95], a[32:35], a[0:3], v[92:95]
ds_read_b64_tr_b16 a[120:121], v10 offset:24576
v_mfma_f32_16x16x32_bf16 v[108:111], a[32:35], a[4:7], v[108:111]
ds_read_b64_tr_b16 a[122:123], v10 offset:25600
v_mfma_f32_16x16x32_bf16 v[124:127], a[32:35], a[8:11], v[124:127]
ds_read_b64_tr_b16 a[124:125], v11 offset:24576
v_mfma_f32_16x16x32_bf16 v[140:143], a[32:35], a[12:15], v[140:143]
s_waitcnt lgkmcnt(15)
ds_read_b64_tr_b16 a[126:127], v11 offset:25600
v_mfma_f32_16x16x32_bf16 v[32:35], a[36:39], a[0:3], v[32:35]
ds_read_b64_tr_b16 a[128:129], v12 offset:24576
v_mfma_f32_16x16x32_bf16 v[48:51], a[36:39], a[4:7], v[48:51]
ds_read_b64_tr_b16 a[130:131], v12 offset:25600
v_mfma_f32_16x16x32_bf16 v[64:67], a[36:39], a[8:11], v[64:67]
ds_read_b64_tr_b16 a[132:133], v13 offset:24576
v_mfma_f32_16x16x32_bf16 v[80:83], a[36:39], a[12:15], v[80:83]
s_waitcnt lgkmcnt(15)
ds_read_b64_tr_b16 a[134:135], v13 offset:25600
v_mfma_f32_16x16x32_bf16 v[96:99], a[40:43], a[0:3], v[96:99]
ds_read_b64_tr_b16 a[136:137], v14 offset:14336
v_mfma_f32_16x16x32_bf16 v[112:115], a[40:43], a[4:7], v[112:115]
ds_read_b64_tr_b16 a[138:139], v14 offset:14592
v_mfma_f32_16x16x32_bf16 v[128:131], a[40:43], a[8:11], v[128:131]
ds_read_b64_tr_b16 a[140:141], v15 offset:14336
v_mfma_f32_16x16x32_bf16 v[144:147], a[40:43], a[12:15], v[144:147]
s_waitcnt lgkmcnt(15)
ds_read_b64_tr_b16 a[142:143], v15 offset:14592
v_mfma_f32_16x16x32_bf16 v[36:39], a[44:47], a[0:3], v[36:39]
ds_read_b64_tr_b16 a[144:145], v14 offset:18432
v_mfma_f32_16x16x32_bf16 v[52:55], a[44:47], a[4:7], v[52:55]
ds_read_b64_tr_b16 a[146:147], v14 offset:18688
v_mfma_f32_16x16x32_bf16 v[68:71], a[44:47], a[8:11], v[68:71]
ds_read_b64_tr_b16 a[148:149], v15 offset:18432
v_mfma_f32_16x16x32_bf16 v[84:87], a[44:47], a[12:15], v[84:87]
s_waitcnt lgkmcnt(15)
ds_read_b64_tr_b16 a[150:151], v15 offset:18688
v_mfma_f32_16x16x32_bf16 v[100:103], a[48:51], a[0:3], v[100:103]
ds_read_b64_tr_b16 a[152:153], v14 offset:22528
v_mfma_f32_16x16x32_bf16 v[116:119], a[48:51], a[4:7], v[116:119]
ds_read_b64_tr_b16 a[154:155], v14 offset:22784
v_mfma_f32_16x16x32_bf16 v[132:135], a[48:51], a[8:11], v[132:135]
ds_read_b64_tr_b16 a[156:157], v15 offset:22528
v_mfma_f32_16x16x32_bf16 v[148:151], a[48:51], a[12:15], v[148:151]
s_waitcnt lgkmcnt(15)
ds_read_b64_tr_b16 a[158:159], v15 offset:22784
v_mfma_f32_16x16x32_bf16 v[152:155], a[52:55], a[0:3], v[152:155]
ds_read_b128 a[100:103], v5 offset:36864
v_mfma_f32_16x16x32_bf16 v[160:163], a[52:55], a[4:7], v[160:163]
ds_read_b64_tr_b16 a[160:161], v16 offset:18432
v_mfma_f32_16x16x32_bf16 v[168:171], a[52:55], a[8:11], v[168:171]
ds_read_b64_tr_b16 a[162:163], v16 offset:18688
v_mfma_f32_16x16x32_bf16 v[176:179], a[52:55], a[12:15], v[176:179]
s_waitcnt lgkmcnt(15)
ds_read_b64_tr_b16 a[164:165], v16 offset:22528
v_mfma_f32_16x16x32_bf16 v[156:159], a[56:59], a[0:3], v[156:159]
ds_read_b64_tr_b16 a[166:167], v16 offset:22784
v_mfma_f32_16x16x32_bf16 v[164:167], a[56:59], a[4:7], v[164:167]
v_mfma_f32_16x16x32_bf16 v[172:175], a[56:59], a[8:11], v[172:175]
v_mfma_f32_16x16x32_bf16 v[180:183], a[56:59], a[12:15], v[180:183]
s_waitcnt lgkmcnt(15)
v_mfma_f32_16x16x32_bf16 v[184:187], a[60:63], a[0:3], v[184:187]
v_mfma_f32_16x16x32_bf16 v[192:195], a[60:63], a[4:7], v[192:195]
v_mfma_f32_16x16x32_bf16 v[200:203], a[60:63], a[8:11], v[200:203]
v_mfma_f32_16x16x32_bf16 v[208:211], a[60:63], a[12:15], v[208:211]
s_waitcnt lgkmcnt(15)
v_mfma_f32_16x16x32_bf16 v[188:191], a[64:67], a[0:3], v[188:191]
v_mfma_f32_16x16x32_bf16 v[196:199], a[64:67], a[4:7], v[196:199]
v_mfma_f32_16x16x32_bf16 v[204:207], a[64:67], a[8:11], v[204:207]
v_mfma_f32_16x16x32_bf16 v[212:215], a[64:67], a[12:15], v[212:215]
s_waitcnt lgkmcnt(15)
v_mfma_f32_16x16x32_bf16 v[216:219], a[0:3], a[68:71], v[216:219]
v_mfma_f32_16x16x32_bf16 v[224:227], a[4:7], a[68:71], v[224:227]
v_mfma_f32_16x16x32_bf16 v[232:235], a[8:11], a[68:71], v[232:235]
v_mfma_f32_16x16x32_bf16 v[240:243], a[12:15], a[68:71], v[240:243]
s_waitcnt lgkmcnt(15)
v_mfma_f32_16x16x32_bf16 v[220:223], a[0:3], a[72:75], v[220:223]
v_mfma_f32_16x16x32_bf16 v[228:231], a[4:7], a[72:75], v[228:231]
v_mfma_f32_16x16x32_bf16 v[236:239], a[8:11], a[72:75], v[236:239]
v_mfma_f32_16x16x32_bf16 v[244:247], a[12:15], a[72:75], v[244:247]
s_waitcnt lgkmcnt(15)
v_mfma_f32_16x16x32_bf16 v[248:251], a[76:79], a[16:19], v[248:251]
s_waitcnt lgkmcnt(15)
v_mfma_f32_16x16x32_bf16 v[252:255], a[16:19], a[80:83], v[252:255]
s_waitcnt lgkmcnt(15)
v_mfma_f32_16x16x32_bf16 v[24:27], a[104:107], a[84:87], v[24:27]
v_mfma_f32_16x16x32_bf16 v[40:43], a[104:107], a[88:91], v[40:43]
v_mfma_f32_16x16x32_bf16 v[56:59], a[104:107], a[92:95], v[56:59]
v_mfma_f32_16x16x32_bf16 v[72:75], a[104:107], a[96:99], v[72:75]
s_waitcnt lgkmcnt(15)
v_mfma_f32_16x16x32_bf16 v[88:91], a[108:111], a[84:87], v[88:91]
v_mfma_f32_16x16x32_bf16 v[104:107], a[108:111], a[88:91], v[104:107]
v_mfma_f32_16x16x32_bf16 v[120:123], a[108:111], a[92:95], v[120:123]
v_mfma_f32_16x16x32_bf16 v[136:139], a[108:111], a[96:99], v[136:139]
s_waitcnt lgkmcnt(15)
v_mfma_f32_16x16x32_bf16 v[28:31], a[112:115], a[84:87], v[28:31]
v_mfma_f32_16x16x32_bf16 v[44:47], a[112:115], a[88:91], v[44:47]
v_mfma_f32_16x16x32_bf16 v[60:63], a[112:115], a[92:95], v[60:63]
v_mfma_f32_16x16x32_bf16 v[76:79], a[112:115], a[96:99], v[76:79]
s_waitcnt lgkmcnt(15)
v_mfma_f32_16x16x32_bf16 v[92:95], a[116:119], a[84:87], v[92:95]
v_mfma_f32_16x16x32_bf16 v[108:111], a[116:119], a[88:91], v[108:111]
v_mfma_f32_16x16x32_bf16 v[124:127], a[116:119], a[92:95], v[124:127]
v_mfma_f32_16x16x32_bf16 v[140:143], a[116:119], a[96:99], v[140:143]
s_waitcnt lgkmcnt(15)
v_mfma_f32_16x16x32_bf16 v[32:35], a[120:123], a[84:87], v[32:35]
v_mfma_f32_16x16x32_bf16 v[48:51], a[120:123], a[88:91], v[48:51]
v_mfma_f32_16x16x32_bf16 v[64:67], a[120:123], a[92:95], v[64:67]
v_mfma_f32_16x16x32_bf16 v[80:83], a[120:123], a[96:99], v[80:83]
s_waitcnt lgkmcnt(15)
v_mfma_f32_16x16x32_bf16 v[96:99], a[124:127], a[84:87], v[96:99]
v_mfma_f32_16x16x32_bf16 v[112:115], a[124:127], a[88:91], v[112:115]
v_mfma_f32_16x16x32_bf16 v[128:131], a[124:127], a[92:95], v[128:131]
v_mfma_f32_16x16x32_bf16 v[144:147], a[124:127], a[96:99], v[144:147]
s_waitcnt lgkmcnt(15)
v_mfma_f32_16x16x32_bf16 v[36:39], a[128:131], a[84:87], v[36:39]
v_mfma_f32_16x16x32_bf16 v[52:55], a[128:131], a[88:91], v[52:55]
v_mfma_f32_16x16x32_bf16 v[68:71], a[128:131], a[92:95], v[68:71]
v_mfma_f32_16x16x32_bf16 v[84:87], a[128:131], a[96:99], v[84:87]
s_waitcnt lgkmcnt(15)
v_mfma_f32_16x16x32_bf16 v[100:103], a[132:135], a[84:87], v[100:103]
v_mfma_f32_16x16x32_bf16 v[116:119], a[132:135], a[88:91], v[116:119]
v_mfma_f32_16x16x32_bf16 v[132:135], a[132:135], a[92:95], v[132:135]
v_mfma_f32_16x16x32_bf16 v[148:151], a[132:135], a[96:99], v[148:151]
s_waitcnt lgkmcnt(15)
v_mfma_f32_16x16x32_bf16 v[152:155], a[136:139], a[84:87], v[152:155]
v_mfma_f32_16x16x32_bf16 v[160:163], a[136:139], a[88:91], v[160:163]
v_mfma_f32_16x16x32_bf16 v[168:171], a[136:139], a[92:95], v[168:171]
v_mfma_f32_16x16x32_bf16 v[176:179], a[136:139], a[96:99], v[176:179]
s_waitcnt lgkmcnt(13)
v_mfma_f32_16x16x32_bf16 v[156:159], a[140:143], a[84:87], v[156:159]
v_mfma_f32_16x16x32_bf16 v[164:167], a[140:143], a[88:91], v[164:167]
v_mfma_f32_16x16x32_bf16 v[172:175], a[140:143], a[92:95], v[172:175]
v_mfma_f32_16x16x32_bf16 v[180:183], a[140:143], a[96:99], v[180:183]
s_waitcnt lgkmcnt(11)
v_mfma_f32_16x16x32_bf16 v[184:187], a[144:147], a[84:87], v[184:187]
v_mfma_f32_16x16x32_bf16 v[192:195], a[144:147], a[88:91], v[192:195]
v_mfma_f32_16x16x32_bf16 v[200:203], a[144:147], a[92:95], v[200:203]
v_mfma_f32_16x16x32_bf16 v[208:211], a[144:147], a[96:99], v[208:211]
s_waitcnt lgkmcnt(9)
v_mfma_f32_16x16x32_bf16 v[188:191], a[148:151], a[84:87], v[188:191]
v_mfma_f32_16x16x32_bf16 v[196:199], a[148:151], a[88:91], v[196:199]
v_mfma_f32_16x16x32_bf16 v[204:207], a[148:151], a[92:95], v[204:207]
v_mfma_f32_16x16x32_bf16 v[212:215], a[148:151], a[96:99], v[212:215]
s_waitcnt lgkmcnt(7)
v_mfma_f32_16x16x32_bf16 v[216:219], a[84:87], a[152:155], v[216:219]
v_mfma_f32_16x16x32_bf16 v[224:227], a[88:91], a[152:155], v[224:227]
v_mfma_f32_16x16x32_bf16 v[232:235], a[92:95], a[152:155], v[232:235]
v_mfma_f32_16x16x32_bf16 v[240:243], a[96:99], a[152:155], v[240:243]
s_waitcnt lgkmcnt(5)
v_mfma_f32_16x16x32_bf16 v[220:223], a[84:87], a[156:159], v[220:223]
v_mfma_f32_16x16x32_bf16 v[228:231], a[88:91], a[156:159], v[228:231]
v_mfma_f32_16x16x32_bf16 v[236:239], a[92:95], a[156:159], v[236:239]
v_mfma_f32_16x16x32_bf16 v[244:247], a[96:99], a[156:159], v[244:247]
s_waitcnt lgkmcnt(2)
v_mfma_f32_16x16x32_bf16 v[248:251], a[160:163], a[100:103], v[248:251]
s_waitcnt lgkmcnt(0)
v_mfma_f32_16x16x32_bf16 v[252:255], a[100:103], a[164:167], v[252:255]
s_lshl_b32 s52, s30, 8
s_add_u32 s52, s52, 58720256
s_lshl_b32 s53, s62, 10
s_add_u32 s53, s53, s52
s_lshl_b32 s54, s63, 10
s_add_u32 s54, s54, s52
v_and_b32 v2, 15, v0
v_lshlrev_b32 v2, 3, v2
v_add_u32 v3, s54, v2
v_add_u32 v2, s53, v2
global_load_dwordx2 v[8:9], v2, s[28:29] offset:0
global_load_dwordx2 v[10:11], v2, s[28:29] offset:128
global_load_dwordx2 v[12:13], v3, s[28:29] offset:0
global_load_dwordx2 v[14:15], v3, s[28:29] offset:128
s_mov_b32 s52, 0x3e0293ee
s_mov_b32 s53, s52
v_pk_mul_f32 v[24:25], v[24:25], s[52:53]
v_pk_mul_f32 v[26:27], v[26:27], s[52:53]
v_pk_mul_f32 v[88:89], v[88:89], s[52:53]
v_pk_mul_f32 v[90:91], v[90:91], s[52:53]
v_cvt_pk_bf16_f32 v24, v24, v25
v_cvt_pk_bf16_f32 v25, v26, v27
v_cvt_pk_bf16_f32 v26, v88, v89
v_cvt_pk_bf16_f32 v27, v90, v91
v_pk_mul_f32 v[28:29], v[28:29], s[52:53]
v_pk_mul_f32 v[30:31], v[30:31], s[52:53]
v_pk_mul_f32 v[92:93], v[92:93], s[52:53]
v_pk_mul_f32 v[94:95], v[94:95], s[52:53]
v_cvt_pk_bf16_f32 v28, v28, v29
v_cvt_pk_bf16_f32 v29, v30, v31
v_cvt_pk_bf16_f32 v30, v92, v93
v_cvt_pk_bf16_f32 v31, v94, v95
v_pk_mul_f32 v[32:33], v[32:33], s[52:53]
v_pk_mul_f32 v[34:35], v[34:35], s[52:53]
v_pk_mul_f32 v[96:97], v[96:97], s[52:53]
v_pk_mul_f32 v[98:99], v[98:99], s[52:53]
v_cvt_pk_bf16_f32 v32, v32, v33
v_cvt_pk_bf16_f32 v33, v34, v35
v_cvt_pk_bf16_f32 v34, v96, v97
v_cvt_pk_bf16_f32 v35, v98, v99
v_pk_mul_f32 v[36:37], v[36:37], s[52:53]
v_pk_mul_f32 v[38:39], v[38:39], s[52:53]
v_pk_mul_f32 v[100:101], v[100:101], s[52:53]
v_pk_mul_f32 v[102:103], v[102:103], s[52:53]
v_cvt_pk_bf16_f32 v36, v36, v37
v_cvt_pk_bf16_f32 v37, v38, v39
v_cvt_pk_bf16_f32 v38, v100, v101
v_cvt_pk_bf16_f32 v39, v102, v103
v_pk_mul_f32 v[40:41], v[40:41], s[52:53]
v_pk_mul_f32 v[42:43], v[42:43], s[52:53]
v_pk_mul_f32 v[104:105], v[104:105], s[52:53]
v_pk_mul_f32 v[106:107], v[106:107], s[52:53]
v_cvt_pk_bf16_f32 v40, v40, v41
v_cvt_pk_bf16_f32 v41, v42, v43
v_cvt_pk_bf16_f32 v42, v104, v105
v_cvt_pk_bf16_f32 v43, v106, v107
v_pk_mul_f32 v[44:45], v[44:45], s[52:53]
v_pk_mul_f32 v[46:47], v[46:47], s[52:53]
v_pk_mul_f32 v[108:109], v[108:109], s[52:53]
v_pk_mul_f32 v[110:111], v[110:111], s[52:53]
v_cvt_pk_bf16_f32 v44, v44, v45
v_cvt_pk_bf16_f32 v45, v46, v47
v_cvt_pk_bf16_f32 v46, v108, v109
v_cvt_pk_bf16_f32 v47, v110, v111
v_pk_mul_f32 v[48:49], v[48:49], s[52:53]
v_pk_mul_f32 v[50:51], v[50:51], s[52:53]
v_pk_mul_f32 v[112:113], v[112:113], s[52:53]
v_pk_mul_f32 v[114:115], v[114:115], s[52:53]
v_cvt_pk_bf16_f32 v48, v48, v49
v_cvt_pk_bf16_f32 v49, v50, v51
v_cvt_pk_bf16_f32 v50, v112, v113
v_cvt_pk_bf16_f32 v51, v114, v115
v_pk_mul_f32 v[52:53], v[52:53], s[52:53]
v_pk_mul_f32 v[54:55], v[54:55], s[52:53]
v_pk_mul_f32 v[116:117], v[116:117], s[52:53]
v_pk_mul_f32 v[118:119], v[118:119], s[52:53]
v_cvt_pk_bf16_f32 v52, v52, v53
v_cvt_pk_bf16_f32 v53, v54, v55
v_cvt_pk_bf16_f32 v54, v116, v117
v_cvt_pk_bf16_f32 v55, v118, v119
v_pk_mul_f32 v[56:57], v[56:57], s[52:53]
v_pk_mul_f32 v[58:59], v[58:59], s[52:53]
v_pk_mul_f32 v[120:121], v[120:121], s[52:53]
v_pk_mul_f32 v[122:123], v[122:123], s[52:53]
v_cvt_pk_bf16_f32 v56, v56, v57
v_cvt_pk_bf16_f32 v57, v58, v59
v_cvt_pk_bf16_f32 v58, v120, v121
v_cvt_pk_bf16_f32 v59, v122, v123
v_pk_mul_f32 v[60:61], v[60:61], s[52:53]
v_pk_mul_f32 v[62:63], v[62:63], s[52:53]
v_pk_mul_f32 v[124:125], v[124:125], s[52:53]
v_pk_mul_f32 v[126:127], v[126:127], s[52:53]
v_cvt_pk_bf16_f32 v60, v60, v61
v_cvt_pk_bf16_f32 v61, v62, v63
v_cvt_pk_bf16_f32 v62, v124, v125
v_cvt_pk_bf16_f32 v63, v126, v127
v_pk_mul_f32 v[64:65], v[64:65], s[52:53]
v_pk_mul_f32 v[66:67], v[66:67], s[52:53]
v_pk_mul_f32 v[128:129], v[128:129], s[52:53]
v_pk_mul_f32 v[130:131], v[130:131], s[52:53]
v_cvt_pk_bf16_f32 v64, v64, v65
v_cvt_pk_bf16_f32 v65, v66, v67
v_cvt_pk_bf16_f32 v66, v128, v129
v_cvt_pk_bf16_f32 v67, v130, v131
v_pk_mul_f32 v[68:69], v[68:69], s[52:53]
v_pk_mul_f32 v[70:71], v[70:71], s[52:53]
v_pk_mul_f32 v[132:133], v[132:133], s[52:53]
v_pk_mul_f32 v[134:135], v[134:135], s[52:53]
v_cvt_pk_bf16_f32 v68, v68, v69
v_cvt_pk_bf16_f32 v69, v70, v71
v_cvt_pk_bf16_f32 v70, v132, v133
v_cvt_pk_bf16_f32 v71, v134, v135
v_pk_mul_f32 v[72:73], v[72:73], s[52:53]
v_pk_mul_f32 v[74:75], v[74:75], s[52:53]
v_pk_mul_f32 v[136:137], v[136:137], s[52:53]
v_pk_mul_f32 v[138:139], v[138:139], s[52:53]
v_cvt_pk_bf16_f32 v72, v72, v73
v_cvt_pk_bf16_f32 v73, v74, v75
v_cvt_pk_bf16_f32 v74, v136, v137
v_cvt_pk_bf16_f32 v75, v138, v139
v_pk_mul_f32 v[76:77], v[76:77], s[52:53]
v_pk_mul_f32 v[78:79], v[78:79], s[52:53]
v_pk_mul_f32 v[140:141], v[140:141], s[52:53]
v_pk_mul_f32 v[142:143], v[142:143], s[52:53]
v_cvt_pk_bf16_f32 v76, v76, v77
v_cvt_pk_bf16_f32 v77, v78, v79
v_cvt_pk_bf16_f32 v78, v140, v141
v_cvt_pk_bf16_f32 v79, v142, v143
v_pk_mul_f32 v[80:81], v[80:81], s[52:53]
v_pk_mul_f32 v[82:83], v[82:83], s[52:53]
v_pk_mul_f32 v[144:145], v[144:145], s[52:53]
v_pk_mul_f32 v[146:147], v[146:147], s[52:53]
v_cvt_pk_bf16_f32 v80, v80, v81
v_cvt_pk_bf16_f32 v81, v82, v83
v_cvt_pk_bf16_f32 v82, v144, v145
v_cvt_pk_bf16_f32 v83, v146, v147
v_pk_mul_f32 v[84:85], v[84:85], s[52:53]
v_pk_mul_f32 v[86:87], v[86:87], s[52:53]
v_pk_mul_f32 v[148:149], v[148:149], s[52:53]
v_pk_mul_f32 v[150:151], v[150:151], s[52:53]
v_cvt_pk_bf16_f32 v84, v84, v85
v_cvt_pk_bf16_f32 v85, v86, v87
v_cvt_pk_bf16_f32 v86, v148, v149
v_cvt_pk_bf16_f32 v87, v150, v151
v_cvt_pk_bf16_f32 v184, v184, v185
v_cvt_pk_bf16_f32 v185, v186, v187
v_cvt_pk_bf16_f32 v186, v188, v189
v_cvt_pk_bf16_f32 v187, v190, v191
v_cvt_pk_bf16_f32 v192, v192, v193
v_cvt_pk_bf16_f32 v193, v194, v195
v_cvt_pk_bf16_f32 v194, v196, v197
v_cvt_pk_bf16_f32 v195, v198, v199
v_cvt_pk_bf16_f32 v200, v200, v201
v_cvt_pk_bf16_f32 v201, v202, v203
v_cvt_pk_bf16_f32 v202, v204, v205
v_cvt_pk_bf16_f32 v203, v206, v207
v_cvt_pk_bf16_f32 v208, v208, v209
v_cvt_pk_bf16_f32 v209, v210, v211
v_cvt_pk_bf16_f32 v210, v212, v213
v_cvt_pk_bf16_f32 v211, v214, v215
v_cvt_pk_bf16_f32 v152, v152, v153
v_cvt_pk_bf16_f32 v153, v154, v155
v_cvt_pk_bf16_f32 v154, v156, v157
v_cvt_pk_bf16_f32 v155, v158, v159
v_cvt_pk_bf16_f32 v160, v160, v161
v_cvt_pk_bf16_f32 v161, v162, v163
v_cvt_pk_bf16_f32 v162, v164, v165
v_cvt_pk_bf16_f32 v163, v166, v167
v_cvt_pk_bf16_f32 v168, v168, v169
v_cvt_pk_bf16_f32 v169, v170, v171
v_cvt_pk_bf16_f32 v170, v172, v173
v_cvt_pk_bf16_f32 v171, v174, v175
v_cvt_pk_bf16_f32 v176, v176, v177
v_cvt_pk_bf16_f32 v177, v178, v179
v_cvt_pk_bf16_f32 v178, v180, v181
v_cvt_pk_bf16_f32 v179, v182, v183
v_cvt_pk_bf16_f32 v90, v216, v217
v_cvt_pk_bf16_f32 v91, v218, v219
v_cvt_pk_bf16_f32 v98, v220, v221
v_cvt_pk_bf16_f32 v99, v222, v223
v_cvt_pk_bf16_f32 v92, v224, v225
v_cvt_pk_bf16_f32 v93, v226, v227
v_cvt_pk_bf16_f32 v100, v228, v229
v_cvt_pk_bf16_f32 v101, v230, v231
v_cvt_pk_bf16_f32 v106, v232, v233
v_cvt_pk_bf16_f32 v107, v234, v235
v_cvt_pk_bf16_f32 v114, v236, v237
v_cvt_pk_bf16_f32 v115, v238, v239
v_cvt_pk_bf16_f32 v108, v240, v241
v_cvt_pk_bf16_f32 v109, v242, v243
v_cvt_pk_bf16_f32 v116, v244, v245
v_cvt_pk_bf16_f32 v117, v246, v247
v_cvt_pk_bf16_f32 v248, v248, v249
v_cvt_pk_bf16_f32 v249, v250, v251
v_cvt_pk_bf16_f32 v252, v252, v253
v_cvt_pk_bf16_f32 v253, v254, v255
v_lshlrev_b32 v4, 4, v0
s_lshl_b32 s52, s30, 11
s_add_u32 s52, s52, 131072
v_add_u32 v5, s52, v4
s_lshr_b32 s52, s30, 1
s_mul_i32 s52, s52, 10240
s_and_b32 s53, s30, 1
s_lshl3_add_u32 s52, s53, s52
s_add_u32 s52, s52, 131072
v_add_u32 v6, s52, v4
ds_write_b128 v5, v[192:195] offset:2048
ds_write_b64 v5, v[92:93] offset:3072
ds_write_b64 v5, v[100:101] offset:3080
ds_write_b128 v5, v[208:211] offset:12288
ds_write_b64 v5, v[108:109] offset:13312
ds_write_b64 v5, v[116:117] offset:13320
ds_write_b64 v6, v[248:249]
ds_write_b64 v6, v[252:253] offset:1024
v_and_b32 v20, 15, v0
v_lshrrev_b32 v21, 4, v0
v_lshlrev_b32 v21, 2, v21
v_sub_u32 v20, v20, v21
v_mov_b32 v21, 0xff800000
s_or_b32 s52, s3, s30
s_cmp_eq_u32 s52, 0
s_cselect_b32 s52, 0xff800000, 0
v_subrev_u32 v22, 0, v20
v_and_b32 v23, 0x80000001, v22
v_cmp_eq_u32 vcc, 0, v23
s_nop 1
v_cndmask_b32 v132, v21, v23, vcc
v_xor_b32 v23, 0x80000000, v23
v_cmp_eq_u32 vcc, 0, v23
s_nop 1
v_cndmask_b32 v128, v21, v23, vcc
v_or_b32 v136, s52, v128
v_subrev_u32 v22, 1, v20
v_and_b32 v23, 0x80000001, v22
v_cmp_eq_u32 vcc, 0, v23
s_nop 1
v_cndmask_b32 v133, v21, v23, vcc
v_xor_b32 v23, 0x80000000, v23
v_cmp_eq_u32 vcc, 0, v23
s_nop 1
v_cndmask_b32 v129, v21, v23, vcc
v_or_b32 v137, s52, v129
v_subrev_u32 v22, 2, v20
v_and_b32 v23, 0x80000001, v22
v_cmp_eq_u32 vcc, 0, v23
s_nop 1
v_cndmask_b32 v134, v21, v23, vcc
v_xor_b32 v23, 0x80000000, v23
v_cmp_eq_u32 vcc, 0, v23
s_nop 1
v_cndmask_b32 v130, v21, v23, vcc
v_or_b32 v138, s52, v130
v_subrev_u32 v22, 3, v20
v_and_b32 v23, 0x80000001, v22
v_cmp_eq_u32 vcc, 0, v23
s_nop 1
v_cndmask_b32 v135, v21, v23, vcc
v_xor_b32 v23, 0x80000000, v23
v_cmp_eq_u32 vcc, 0, v23
s_nop 1
v_cndmask_b32 v131, v21, v23, vcc
v_or_b32 v139, s52, v131
v_and_b32 v22, 3, v0
v_cmp_eq_u32 vcc, 0, v22
v_mov_b32 v23, 0x3f803f80
v_mov_b32 v22, 0
v_cndmask_b32 v16, v22, v23, vcc
v_mov_b32 v17, v16
v_mov_b32 v18, v16
v_mov_b32 v19, v16
s_waitcnt lgkmcnt(0)
s_barrier
ds_read_b128 v[120:123], v5 offset:0
ds_read_b64 v[88:89], v5 offset:1024
ds_read_b64 v[96:97], v5 offset:1032
ds_read_b128 v[124:127], v5 offset:10240
ds_read_b64 v[104:105], v5 offset:11264
ds_read_b64 v[112:113], v5 offset:11272
v_mfma_f32_16x16x32_bf16 v[220:223], v[184:187], v[152:155], v[132:135]
v_mfma_f32_16x16x32_bf16 v[228:231], v[192:195], v[160:163], v[132:135]
v_mfma_f32_16x16x32_bf16 v[236:239], v[200:203], v[168:171], v[132:135]
v_mfma_f32_16x16x32_bf16 v[244:247], v[208:211], v[176:179], v[132:135]
v_mfma_f32_16x16x32_bf16 v[224:227], v[184:187], v[160:163], v[128:131]
v_mfma_f32_16x16x32_bf16 v[240:243], v[200:203], v[176:179], v[128:131]
s_waitcnt lgkmcnt(0)
v_mfma_f32_16x16x32_bf16 v[216:219], v[120:123], v[152:155], v[136:139]
v_mfma_f32_16x16x32_bf16 v[232:235], v[124:127], v[168:171], v[128:131]
s_mov_b32 s52, 0x3e8293ee
s_nop 6
v_max3_f32 v141, v228, v229, v230
v_max3_f32 v141, v141, v231, v224
v_max3_f32 v141, v141, v225, v226
v_max_f32 v141, v141, v227
v_max3_f32 v143, v244, v245, v246
v_max3_f32 v143, v143, v247, v240
v_max3_f32 v143, v143, v241, v242
v_max_f32 v143, v143, v243
v_max3_f32 v140, v220, v221, v222
v_max3_f32 v140, v140, v223, v216
v_max3_f32 v140, v140, v217, v218
v_max_f32 v140, v140, v219
v_max3_f32 v142, v236, v237, v238
v_max3_f32 v142, v142, v239, v232
v_max3_f32 v142, v142, v233, v234
v_max_f32 v142, v142, v235
v_mov_b32 v145, v141
v_mov_b32 v147, v143
v_mov_b32 v144, v140
v_mov_b32 v146, v142
s_nop 0
v_permlane16_swap_b32 v145, v141
v_permlane16_swap_b32 v147, v143
v_permlane16_swap_b32 v144, v140
v_permlane16_swap_b32 v146, v142
v_max_f32 v141, v141, v145
v_max_f32 v143, v143, v147
v_max_f32 v140, v140, v144
v_max_f32 v142, v142, v146
v_mov_b32 v145, v141
v_mov_b32 v147, v143
v_mov_b32 v144, v140
v_mov_b32 v146, v142
s_nop 0
v_permlane32_swap_b32 v145, v141
v_permlane32_swap_b32 v147, v143
v_permlane32_swap_b32 v144, v140
v_permlane32_swap_b32 v146, v142
v_max_f32 v141, v141, v145
v_max_f32 v143, v143, v147
v_max_f32 v140, v140, v144
v_max_f32 v142, v142, v146
v_mul_f32 v141, s52, v141
v_mul_f32 v143, s52, v143
v_mul_f32 v140, s52, v140
v_mul_f32 v142, s52, v142
v_fma_f32 v224, v224, s52, -v141
v_fma_f32 v225, v225, s52, -v141
v_fma_f32 v226, v226, s52, -v141
v_fma_f32 v227, v227, s52, -v141
v_fma_f32 v228, v228, s52, -v141
v_fma_f32 v229, v229, s52, -v141
v_fma_f32 v230, v230, s52, -v141
v_fma_f32 v231, v231, s52, -v141
v_exp_f32 v224, v224
v_exp_f32 v225, v225
v_exp_f32 v226, v226
v_exp_f32 v227, v227
v_exp_f32 v228, v228
v_exp_f32 v229, v229
v_exp_f32 v230, v230
v_exp_f32 v231, v231
v_fma_f32 v240, v240, s52, -v143
v_fma_f32 v241, v241, s52, -v143
v_fma_f32 v242, v242, s52, -v143
v_fma_f32 v243, v243, s52, -v143
v_fma_f32 v244, v244, s52, -v143
v_fma_f32 v245, v245, s52, -v143
v_fma_f32 v246, v246, s52, -v143
v_fma_f32 v247, v247, s52, -v143
v_exp_f32 v240, v240
v_exp_f32 v241, v241
v_exp_f32 v242, v242
v_exp_f32 v243, v243
v_exp_f32 v244, v244
v_exp_f32 v245, v245
v_exp_f32 v246, v246
v_exp_f32 v247, v247
v_fma_f32 v216, v216, s52, -v140
v_fma_f32 v217, v217, s52, -v140
v_fma_f32 v218, v218, s52, -v140
v_fma_f32 v219, v219, s52, -v140
v_fma_f32 v220, v220, s52, -v140
v_fma_f32 v221, v221, s52, -v140
v_fma_f32 v222, v222, s52, -v140
v_fma_f32 v223, v223, s52, -v140
v_exp_f32 v216, v216
v_exp_f32 v217, v217
v_exp_f32 v218, v218
v_exp_f32 v219, v219
v_exp_f32 v220, v220
v_exp_f32 v221, v221
v_exp_f32 v222, v222
v_exp_f32 v223, v223
v_fma_f32 v232, v232, s52, -v142
v_fma_f32 v233, v233, s52, -v142
v_fma_f32 v234, v234, s52, -v142
v_fma_f32 v235, v235, s52, -v142
v_fma_f32 v236, v236, s52, -v142
v_fma_f32 v237, v237, s52, -v142
v_fma_f32 v238, v238, s52, -v142
v_fma_f32 v239, v239, s52, -v142
v_exp_f32 v232, v232
v_exp_f32 v233, v233
v_exp_f32 v234, v234
v_exp_f32 v235, v235
v_exp_f32 v236, v236
v_exp_f32 v237, v237
v_exp_f32 v238, v238
v_exp_f32 v239, v239
v_cvt_pk_bf16_f32 v224, v224, v225
v_cvt_pk_bf16_f32 v225, v226, v227
v_cvt_pk_bf16_f32 v226, v228, v229
v_cvt_pk_bf16_f32 v227, v230, v231
v_cvt_pk_bf16_f32 v240, v240, v241
v_cvt_pk_bf16_f32 v241, v242, v243
v_cvt_pk_bf16_f32 v242, v244, v245
v_cvt_pk_bf16_f32 v243, v246, v247
v_cvt_pk_bf16_f32 v216, v216, v217
v_cvt_pk_bf16_f32 v217, v218, v219
v_cvt_pk_bf16_f32 v218, v220, v221
v_cvt_pk_bf16_f32 v219, v222, v223
v_cvt_pk_bf16_f32 v232, v232, v233
v_cvt_pk_bf16_f32 v233, v234, v235
v_cvt_pk_bf16_f32 v234, v236, v237
v_cvt_pk_bf16_f32 v235, v238, v239
s_nop 1
v_mfma_f32_16x16x32_bf16 v[228:231], v[16:19], v[224:227], 0
v_mfma_f32_16x16x32_bf16 v[164:167], v[90:93], v[224:227], 0
v_mfma_f32_16x16x32_bf16 v[196:199], v[98:101], v[224:227], 0
v_mfma_f32_16x16x32_bf16 v[244:247], v[16:19], v[240:243], 0
v_mfma_f32_16x16x32_bf16 v[180:183], v[106:109], v[240:243], 0
v_mfma_f32_16x16x32_bf16 v[212:215], v[114:117], v[240:243], 0
v_mfma_f32_16x16x32_bf16 v[220:223], v[16:19], v[216:219], 0
v_mfma_f32_16x16x32_bf16 v[156:159], v[88:91], v[216:219], 0
v_mfma_f32_16x16x32_bf16 v[188:191], v[96:99], v[216:219], 0
v_mfma_f32_16x16x32_bf16 v[236:239], v[16:19], v[232:235], 0
v_mfma_f32_16x16x32_bf16 v[172:175], v[104:107], v[232:235], 0
v_mfma_f32_16x16x32_bf16 v[204:207], v[112:115], v[232:235], 0
s_add_u32 s44, s28, 33554432
s_addc_u32 s45, s29, 0
s_mov_b32 s46, 20971520
s_mov_b32 s47, 0x20000
s_add_u32 s52, s31, 128
s_lshl_b32 s52, s52, 13
s_lshl_b32 s53, s30, 11
s_add_u32 s52, s52, s53
s_mul_i32 s53, s62, 1310720
s_add_u32 s53, s53, s52
s_mul_i32 s54, s63, 1310720
s_add_u32 s54, s54, s52
s_waitcnt vmcnt(0)
v_rcp_f32 v141, v228
v_rcp_f32 v143, v244
v_rcp_f32 v140, v220
v_rcp_f32 v142, v236
v_mul_f32 v141, v141, v11
v_mul_f32 v143, v143, v15
v_mul_f32 v140, v140, v9
v_mul_f32 v142, v142, v13
v_mul_f32 v164, v164, v141
v_mul_f32 v165, v165, v141
v_mul_f32 v166, v166, v141
v_mul_f32 v167, v167, v141
v_mul_f32 v196, v196, v141
v_mul_f32 v197, v197, v141
v_mul_f32 v198, v198, v141
v_mul_f32 v199, v199, v141
v_cvt_pk_bf16_f32 v164, v164, v165
v_cvt_pk_bf16_f32 v165, v166, v167
v_cvt_pk_bf16_f32 v166, v196, v197
v_cvt_pk_bf16_f32 v167, v198, v199
buffer_store_dwordx4 v[164:167], v4, s[44:47], s53 offen offset:1024
v_mul_f32 v180, v180, v143
v_mul_f32 v181, v181, v143
v_mul_f32 v182, v182, v143
v_mul_f32 v183, v183, v143
v_mul_f32 v212, v212, v143
v_mul_f32 v213, v213, v143
v_mul_f32 v214, v214, v143
v_mul_f32 v215, v215, v143
v_cvt_pk_bf16_f32 v180, v180, v181
v_cvt_pk_bf16_f32 v181, v182, v183
v_cvt_pk_bf16_f32 v182, v212, v213
v_cvt_pk_bf16_f32 v183, v214, v215
buffer_store_dwordx4 v[180:183], v4, s[44:47], s54 offen offset:1024
v_mul_f32 v156, v156, v140
v_mul_f32 v157, v157, v140
v_mul_f32 v158, v158, v140
v_mul_f32 v159, v159, v140
v_mul_f32 v188, v188, v140
v_mul_f32 v189, v189, v140
v_mul_f32 v190, v190, v140
v_mul_f32 v191, v191, v140
v_cvt_pk_bf16_f32 v156, v156, v157
v_cvt_pk_bf16_f32 v157, v158, v159
v_cvt_pk_bf16_f32 v158, v188, v189
v_cvt_pk_bf16_f32 v159, v190, v191
buffer_store_dwordx4 v[156:159], v4, s[44:47], s53 offen offset:0
v_mul_f32 v172, v172, v142
v_mul_f32 v173, v173, v142
v_mul_f32 v174, v174, v142
v_mul_f32 v175, v175, v142
v_mul_f32 v204, v204, v142
v_mul_f32 v205, v205, v142
v_mul_f32 v206, v206, v142
v_mul_f32 v207, v207, v142
v_cvt_pk_bf16_f32 v172, v172, v173
v_cvt_pk_bf16_f32 v173, v174, v175
v_cvt_pk_bf16_f32 v174, v204, v205
v_cvt_pk_bf16_f32 v175, v206, v207
buffer_store_dwordx4 v[172:175], v4, s[44:47], s54 offen offset:0
s_lshl_b32 s52, s31, 20
s_add_u32 s52, s52, 0
s_add_u32 s32, s28, s52
s_addc_u32 s33, s29, 0
s_add_u32 s52, s63, 1
s_lshl_b32 s34, s52, 16
s_mov_b32 s35, 0x20000
s_mov_b32 s68, 0
v_lshlrev_b32 v4, 4, v0
v_mov_b32 v5, 0xff800000
v_and_b32 v6, 15, v0
v_lshrrev_b32 v7, 4, v0
v_lshlrev_b32 v7, 2, v7
v_sub_u32 v6, v6, v7
v_cmp_gt_i32 s[72:73], 0, v6
v_cmp_gt_i32 s[74:75], 1, v6
v_cmp_gt_i32 s[76:77], 2, v6
v_cmp_gt_i32 s[78:79], 3, v6
v_mov_b32 v184, 0
v_mov_b32 v185, 0
v_mov_b32 v186, 0
v_mov_b32 v187, 0
v_mov_b32 v188, 0
v_mov_b32 v189, 0
v_mov_b32 v190, 0
v_mov_b32 v191, 0
v_mov_b32 v192, 0
v_mov_b32 v193, 0
v_mov_b32 v194, 0
v_mov_b32 v195, 0
v_mov_b32 v196, 0
v_mov_b32 v197, 0
v_mov_b32 v198, 0
v_mov_b32 v199, 0
v_mov_b32 v200, 0
v_mov_b32 v201, 0
v_mov_b32 v202, 0
v_mov_b32 v203, 0
v_mov_b32 v204, 0
v_mov_b32 v205, 0
v_mov_b32 v206, 0
v_mov_b32 v207, 0
v_mov_b32 v208, 0
v_mov_b32 v209, 0
v_mov_b32 v210, 0
v_mov_b32 v211, 0
v_mov_b32 v212, 0
v_mov_b32 v213, 0
v_mov_b32 v214, 0
v_mov_b32 v215, 0
L_attstart_7:
s_waitcnt vmcnt(0) lgkmcnt(0)
s_barrier
v_mov_b32 v2, v4
v_mov_b32 v6, 151552
v_mov_b32 v7, 0
ds_write_b32 v6, v7
s_and_b32 s52, s30, 1
s_lshr_b32 s53, s30, 1
s_lshl_b32 s65, s52, 13
s_lshl_b32 s54, s53, 15
s_add_u32 s65, s65, s54
s_lshl_b32 s55, s52, 14
s_cmp_eq_u32 s53, 0
s_cselect_b32 s64, s55, 0x7000000
s_mov_b32 m0, s65
s_nop 0
buffer_load_dwordx4 v4, s[32:35], s64 offen offset:0 lds
buffer_load_dwordx4 v4, s[32:35], s64 offen offset:1024 lds
buffer_load_dwordx4 v4, s[32:35], s64 offen offset:2048 lds
buffer_load_dwordx4 v4, s[32:35], s64 offen offset:3072 lds
s_add_u32 m0, s65, 4096
s_add_u32 s69, s64, 4096
buffer_load_dwordx4 v4, s[32:35], s69 offen offset:0 lds
buffer_load_dwordx4 v4, s[32:35], s69 offen offset:1024 lds
buffer_load_dwordx4 v4, s[32:35], s69 offen offset:2048 lds
buffer_load_dwordx4 v4, s[32:35], s69 offen offset:3072 lds
s_xor_b32 s65, s65, 16384
s_cmp_eq_u32 s53, 0
s_cselect_b32 s54, 4, 1
s_lshl_b32 s54, s54, 13
s_add_u32 s64, s55, s54
s_mov_b32 m0, s65
s_nop 0
buffer_load_dwordx4 v4, s[32:35], s64 offen offset:0 lds
buffer_load_dwordx4 v4, s[32:35], s64 offen offset:1024 lds
buffer_load_dwordx4 v4, s[32:35], s64 offen offset:2048 lds
buffer_load_dwordx4 v4, s[32:35], s64 offen offset:3072 lds
s_add_u32 m0, s65, 4096
s_add_u32 s69, s64, 4096
buffer_load_dwordx4 v4, s[32:35], s69 offen offset:0 lds
buffer_load_dwordx4 v4, s[32:35], s69 offen offset:1024 lds
buffer_load_dwordx4 v4, s[32:35], s69 offen offset:2048 lds
buffer_load_dwordx4 v4, s[32:35], s69 offen offset:3072 lds
s_xor_b32 s65, s65, 81920
s_add_u32 s64, s64, 32768
s_lshl2_add_u32 s66, s62, s30
s_add_u32 s66, s66, 1
s_cmp_le_u32 s66, 1
s_cbranch_scc1 L_st_8
L_bk_9:
s_sub_u32 s66, s66, 1
s_waitcnt vmcnt(8) lgkmcnt(0)
s_barrier
ds_read_b128 a[144:147], v2 offset:0
ds_read_b128 a[148:151], v2 offset:1024
ds_read_b128 a[152:155], v2 offset:2048
ds_read_b128 a[156:159], v2 offset:3072
ds_read_b128 a[160:163], v2 offset:4096
ds_read_b128 a[164:167], v2 offset:5120
s_mov_b32 m0, s65
s_nop 0
buffer_load_dwordx4 v4, s[32:35], s64 offen offset:0 lds
buffer_load_dwordx4 v4, s[32:35], s64 offen offset:1024 lds
s_waitcnt lgkmcnt(5)
v_mfma_f32_16x16x32_bf16 v[88:91], a[144:147], v[24:27], v[184:187]
ds_read_b128 a[168:171], v2 offset:6144
v_mfma_f32_16x16x32_bf16 v[96:99], a[144:147], v[40:43], v[192:195]
v_mfma_f32_16x16x32_bf16 v[104:107], a[144:147], v[56:59], v[200:203]
v_mfma_f32_16x16x32_bf16 v[112:115], a[144:147], v[72:75], v[208:211]
s_waitcnt lgkmcnt(5)
v_mfma_f32_16x16x32_bf16 v[88:91], a[148:151], v[28:31], v[88:91]
ds_read_b128 a[172:175], v2 offset:7168
v_mfma_f32_16x16x32_bf16 v[96:99], a[148:151], v[44:47], v[96:99]
v_mfma_f32_16x16x32_bf16 v[104:107], a[148:151], v[60:63], v[104:107]
v_mfma_f32_16x16x32_bf16 v[112:115], a[148:151], v[76:79], v[112:115]
s_waitcnt lgkmcnt(5)
v_mfma_f32_16x16x32_bf16 v[88:91], a[152:155], v[32:35], v[88:91]
v_mfma_f32_16x16x32_bf16 v[96:99], a[152:155], v[48:51], v[96:99]
v_mfma_f32_16x16x32_bf16 v[104:107], a[152:155], v[64:67], v[104:107]
buffer_load_dwordx4 v4, s[32:35], s64 offen offset:2048 lds
v_mfma_f32_16x16x32_bf16 v[112:115], a[152:155], v[80:83], v[112:115]
s_waitcnt lgkmcnt(4)
v_mfma_f32_16x16x32_bf16 v[88:91], a[156:159], v[36:39], v[88:91]
v_mfma_f32_16x16x32_bf16 v[96:99], a[156:159], v[52:55], v[96:99]
v_mfma_f32_16x16x32_bf16 v[104:107], a[156:159], v[68:71], v[104:107]
v_mfma_f32_16x16x32_bf16 v[112:115], a[156:159], v[84:87], v[112:115]
s_waitcnt lgkmcnt(3)
v_mfma_f32_16x16x32_bf16 v[92:95], a[160:163], v[24:27], v[188:191]
v_mfma_f32_16x16x32_bf16 v[100:103], a[160:163], v[40:43], v[196:199]
v_mfma_f32_16x16x32_bf16 v[108:111], a[160:163], v[56:59], v[204:207]
v_mfma_f32_16x16x32_bf16 v[116:119], a[160:163], v[72:75], v[212:215]
s_waitcnt lgkmcnt(2)
v_mfma_f32_16x16x32_bf16 v[92:95], a[164:167], v[28:31], v[92:95]
buffer_load_dwordx4 v4, s[32:35], s64 offen offset:3072 lds
v_mfma_f32_16x16x32_bf16 v[100:103], a[164:167], v[44:47], v[100:103]
v_mfma_f32_16x16x32_bf16 v[108:111], a[164:167], v[60:63], v[108:111]
v_mfma_f32_16x16x32_bf16 v[116:119], a[164:167], v[76:79], v[116:119]
s_waitcnt lgkmcnt(1)
v_mfma_f32_16x16x32_bf16 v[92:95], a[168:171], v[32:35], v[92:95]
v_mfma_f32_16x16x32_bf16 v[100:103], a[168:171], v[48:51], v[100:103]
v_mfma_f32_16x16x32_bf16 v[108:111], a[168:171], v[64:67], v[108:111]
v_mfma_f32_16x16x32_bf16 v[116:119], a[168:171], v[80:83], v[116:119]
s_waitcnt lgkmcnt(0)
v_mfma_f32_16x16x32_bf16 v[92:95], a[172:175], v[36:39], v[92:95]
v_mfma_f32_16x16x32_bf16 v[100:103], a[172:175], v[52:55], v[100:103]
s_add_u32 m0, s65, 4096
s_add_u32 s69, s64, 4096
v_mfma_f32_16x16x32_bf16 v[108:111], a[172:175], v[68:71], v[108:111]
v_mfma_f32_16x16x32_bf16 v[116:119], a[172:175], v[84:87], v[116:119]
ds_read_b128 a[144:147], v2 offset:8192
ds_read_b128 a[148:151], v2 offset:9216
ds_read_b128 a[152:155], v2 offset:10240
ds_read_b128 a[156:159], v2 offset:11264
ds_read_b128 a[160:163], v2 offset:12288
ds_read_b128 a[164:167], v2 offset:13312
buffer_load_dwordx4 v4, s[32:35], s69 offen offset:0 lds
buffer_load_dwordx4 v4, s[32:35], s69 offen offset:1024 lds
s_nop 7
s_cmp_eq_u32 s68, 0
s_cselect_b32 s52, -1, 0
v_max3_f32 v216, v88, v89, v90
v_max3_f32 v216, v216, v91, v92
v_max3_f32 v216, v216, v93, v94
v_max_f32 v216, v216, v95
v_max3_f32 v217, v96, v97, v98
v_max3_f32 v217, v217, v99, v100
v_max3_f32 v217, v217, v101, v102
v_max_f32 v217, v217, v103
v_max3_f32 v218, v104, v105, v106
v_max3_f32 v218, v218, v107, v108
v_max3_f32 v218, v218, v109, v110
v_max_f32 v218, v218, v111
v_max3_f32 v219, v112, v113, v114
v_max3_f32 v219, v219, v115, v116
v_max3_f32 v219, v219, v117, v118
v_max_f32 v219, v219, v119
v_mov_b32 v220, v216
v_mov_b32 v221, v217
v_mov_b32 v222, v218
v_mov_b32 v223, v219
s_nop 0
v_permlane16_swap_b32 v220, v216
v_permlane16_swap_b32 v221, v217
v_permlane16_swap_b32 v222, v218
v_permlane16_swap_b32 v223, v219
v_max_f32 v216, v216, v220
v_max_f32 v217, v217, v221
v_max_f32 v218, v218, v222
v_max_f32 v219, v219, v223
v_mov_b32 v220, v216
v_mov_b32 v221, v217
v_mov_b32 v222, v218
v_mov_b32 v223, v219
s_nop 0
v_permlane32_swap_b32 v220, v216
v_permlane32_swap_b32 v221, v217
v_permlane32_swap_b32 v222, v218
v_permlane32_swap_b32 v223, v219
v_max_f32 v216, v216, v220
v_max_f32 v217, v217, v221
v_max_f32 v218, v218, v222
v_max_f32 v219, v219, v223
v_and_b32 v216, s52, v216
v_and_b32 v217, s52, v217
v_and_b32 v218, s52, v218
v_and_b32 v219, s52, v219
v_sub_f32 v184, v184, v216
v_sub_f32 v185, v185, v216
v_sub_f32 v186, v186, v216
v_sub_f32 v187, v187, v216
v_sub_f32 v188, v188, v216
v_sub_f32 v189, v189, v216
v_sub_f32 v190, v190, v216
v_sub_f32 v191, v191, v216
v_sub_f32 v192, v192, v217
v_sub_f32 v193, v193, v217
v_sub_f32 v194, v194, v217
v_sub_f32 v195, v195, v217
v_sub_f32 v196, v196, v217
v_sub_f32 v197, v197, v217
v_sub_f32 v198, v198, v217
v_sub_f32 v199, v199, v217
v_sub_f32 v200, v200, v218
v_sub_f32 v201, v201, v218
v_sub_f32 v202, v202, v218
v_sub_f32 v203, v203, v218
v_sub_f32 v204, v204, v218
v_sub_f32 v205, v205, v218
v_sub_f32 v206, v206, v218
v_sub_f32 v207, v207, v218
v_sub_f32 v208, v208, v219
v_sub_f32 v209, v209, v219
v_sub_f32 v210, v210, v219
v_sub_f32 v211, v211, v219
v_sub_f32 v212, v212, v219
v_sub_f32 v213, v213, v219
v_sub_f32 v214, v214, v219
v_sub_f32 v215, v215, v219
s_cmp_le_u32 s66, 1
s_cbranch_scc1 L_st_10
L_bk_11:
s_sub_u32 s66, s66, 1
v_sub_f32 v88, v88, v216
v_sub_f32 v89, v89, v216
v_sub_f32 v90, v90, v216
v_sub_f32 v91, v91, v216
v_sub_f32 v92, v92, v216
v_sub_f32 v93, v93, v216
v_sub_f32 v94, v94, v216
v_sub_f32 v95, v95, v216
v_sub_f32 v96, v96, v217
v_sub_f32 v97, v97, v217
v_sub_f32 v98, v98, v217
v_sub_f32 v99, v99, v217
v_sub_f32 v100, v100, v217
v_sub_f32 v101, v101, v217
v_sub_f32 v102, v102, v217
v_sub_f32 v103, v103, v217
v_sub_f32 v104, v104, v218
v_sub_f32 v105, v105, v218
v_sub_f32 v106, v106, v218
v_sub_f32 v107, v107, v218
v_sub_f32 v108, v108, v218
v_sub_f32 v109, v109, v218
v_sub_f32 v110, v110, v218
v_sub_f32 v111, v111, v218
v_sub_f32 v112, v112, v219
v_sub_f32 v113, v113, v219
v_sub_f32 v114, v114, v219
v_sub_f32 v115, v115, v219
v_sub_f32 v116, v116, v219
v_sub_f32 v117, v117, v219
v_sub_f32 v118, v118, v219
v_sub_f32 v119, v119, v219
s_waitcnt lgkmcnt(5)
v_mfma_f32_16x16x32_bf16 v[120:123], a[144:147], v[24:27], v[184:187]
ds_read_b128 a[168:171], v2 offset:14336
v_exp_f32 v88, v88
v_mfma_f32_16x16x32_bf16 v[128:131], a[144:147], v[40:43], v[192:195]
v_exp_f32 v89, v89
v_mfma_f32_16x16x32_bf16 v[136:139], a[144:147], v[56:59], v[200:203]
v_cvt_pk_bf16_f32 v152, v88, v89
v_exp_f32 v90, v90
v_mfma_f32_16x16x32_bf16 v[144:147], a[144:147], v[72:75], v[208:211]
s_waitcnt lgkmcnt(5)
v_exp_f32 v91, v91
v_mfma_f32_16x16x32_bf16 v[120:123], a[148:151], v[28:31], v[120:123]
ds_read_b128 a[172:175], v2 offset:15360
v_cvt_pk_bf16_f32 v153, v90, v91
v_exp_f32 v92, v92
v_mfma_f32_16x16x32_bf16 v[128:131], a[148:151], v[44:47], v[128:131]
v_exp_f32 v93, v93
v_mfma_f32_16x16x32_bf16 v[136:139], a[148:151], v[60:63], v[136:139]
v_cvt_pk_bf16_f32 v154, v92, v93
v_exp_f32 v94, v94
v_mfma_f32_16x16x32_bf16 v[144:147], a[148:151], v[76:79], v[144:147]
s_waitcnt lgkmcnt(5)
v_exp_f32 v95, v95
v_exp_f32 v96, v96
v_mfma_f32_16x16x32_bf16 v[120:123], a[152:155], v[32:35], v[120:123]
v_cvt_pk_bf16_f32 v155, v94, v95
v_exp_f32 v97, v97
v_mfma_f32_16x16x32_bf16 v[128:131], a[152:155], v[48:51], v[128:131]
v_cvt_pk_bf16_f32 v156, v96, v97
v_exp_f32 v98, v98
v_mfma_f32_16x16x32_bf16 v[136:139], a[152:155], v[64:67], v[136:139]
buffer_load_dwordx4 v4, s[32:35], s69 offen offset:2048 lds
v_exp_f32 v99, v99
v_mfma_f32_16x16x32_bf16 v[144:147], a[152:155], v[80:83], v[144:147]
s_waitcnt lgkmcnt(4)
v_cvt_pk_bf16_f32 v157, v98, v99
v_exp_f32 v100, v100
v_mfma_f32_16x16x32_bf16 v[120:123], a[156:159], v[36:39], v[120:123]
v_exp_f32 v101, v101
v_mfma_f32_16x16x32_bf16 v[128:131], a[156:159], v[52:55], v[128:131]
v_cvt_pk_bf16_f32 v158, v100, v101
v_exp_f32 v102, v102
v_mfma_f32_16x16x32_bf16 v[136:139], a[156:159], v[68:71], v[136:139]
v_exp_f32 v103, v103
v_mfma_f32_16x16x32_bf16 v[144:147], a[156:159], v[84:87], v[144:147]
s_waitcnt lgkmcnt(3)
v_cvt_pk_bf16_f32 v159, v102, v103
v_exp_f32 v104, v104
v_mfma_f32_16x16x32_bf16 v[124:127], a[160:163], v[24:27], v[188:191]
v_exp_f32 v105, v105
v_mfma_f32_16x16x32_bf16 v[132:135], a[160:163], v[40:43], v[196:199]
v_cvt_pk_bf16_f32 v160, v104, v105
v_exp_f32 v106, v106
v_mfma_f32_16x16x32_bf16 v[140:143], a[160:163], v[56:59], v[204:207]
v_exp_f32 v107, v107
v_mfma_f32_16x16x32_bf16 v[148:151], a[160:163], v[72:75], v[212:215]
s_waitcnt lgkmcnt(2)
v_cvt_pk_bf16_f32 v161, v106, v107
v_exp_f32 v108, v108
v_mfma_f32_16x16x32_bf16 v[124:127], a[164:167], v[28:31], v[124:127]
buffer_load_dwordx4 v4, s[32:35], s69 offen offset:3072 lds
v_exp_f32 v109, v109
v_mfma_f32_16x16x32_bf16 v[132:135], a[164:167], v[44:47], v[132:135]
v_cvt_pk_bf16_f32 v162, v108, v109
v_exp_f32 v110, v110
v_mfma_f32_16x16x32_bf16 v[140:143], a[164:167], v[60:63], v[140:143]
v_exp_f32 v111, v111
v_exp_f32 v112, v112
v_mfma_f32_16x16x32_bf16 v[148:151], a[164:167], v[76:79], v[148:151]
s_waitcnt lgkmcnt(1)
v_cvt_pk_bf16_f32 v163, v110, v111
v_exp_f32 v113, v113
v_mfma_f32_16x16x32_bf16 v[124:127], a[168:171], v[32:35], v[124:127]
v_cvt_pk_bf16_f32 v164, v112, v113
v_exp_f32 v114, v114
v_mfma_f32_16x16x32_bf16 v[132:135], a[168:171], v[48:51], v[132:135]
v_exp_f32 v115, v115
v_mfma_f32_16x16x32_bf16 v[140:143], a[168:171], v[64:67], v[140:143]
v_cvt_pk_bf16_f32 v165, v114, v115
v_exp_f32 v116, v116
v_mfma_f32_16x16x32_bf16 v[148:151], a[168:171], v[80:83], v[148:151]
s_waitcnt lgkmcnt(0)
v_exp_f32 v117, v117
v_mfma_f32_16x16x32_bf16 v[124:127], a[172:175], v[36:39], v[124:127]
v_cvt_pk_bf16_f32 v166, v116, v117
v_exp_f32 v118, v118
v_mfma_f32_16x16x32_bf16 v[132:135], a[172:175], v[52:55], v[132:135]
v_exp_f32 v119, v119
v_mfma_f32_16x16x32_bf16 v[140:143], a[172:175], v[68:71], v[140:143]
s_cmp_le_u32 s66, 1
s_cbranch_scc1 L_st_12
L_bk_13:
s_sub_u32 s66, s66, 1
v_cvt_pk_bf16_f32 v167, v118, v119
v_mfma_f32_16x16x32_bf16 v[148:151], a[172:175], v[84:87], v[148:151]
s_waitcnt vmcnt(8)
s_barrier
s_xor_b32 s65, s65, 16384
s_add_u32 s64, s64, 32768
s_mov_b32 m0, s65
ds_read_b128 a[144:147], v2 offset:16384
ds_read_b128 a[148:151], v2 offset:17408
ds_read_b128 a[152:155], v2 offset:18432
ds_read_b128 a[156:159], v2 offset:19456
ds_read_b128 a[160:163], v2 offset:20480
ds_read_b128 a[164:167], v2 offset:21504
buffer_load_dwordx4 v4, s[32:35], s64 offen offset:0 lds
buffer_load_dwordx4 v4, s[32:35], s64 offen offset:1024 lds
s_waitcnt lgkmcnt(5)
v_mfma_f32_16x16x32_bf16 v[88:91], a[144:147], v[24:27], v[184:187]
ds_read_b128 a[168:171], v2 offset:22528
v_mfma_f32_16x16x32_bf16 v[96:99], a[144:147], v[40:43], v[192:195]
v_exp_f32 v120, v120
v_mfma_f32_16x16x32_bf16 v[104:107], a[144:147], v[56:59], v[200:203]
v_mfma_f32_16x16x32_bf16 v[112:115], a[144:147], v[72:75], v[208:211]
s_waitcnt lgkmcnt(5)
v_exp_f32 v121, v121
v_mfma_f32_16x16x32_bf16 v[88:91], a[148:151], v[28:31], v[88:91]
ds_read_b128 a[172:175], v2 offset:23552
v_cvt_pk_bf16_f32 v168, v120, v121
v_mfma_f32_16x16x32_bf16 v[96:99], a[148:151], v[44:47], v[96:99]
v_exp_f32 v122, v122
v_mfma_f32_16x16x32_bf16 v[104:107], a[148:151], v[60:63], v[104:107]
v_mfma_f32_16x16x32_bf16 v[112:115], a[148:151], v[76:79], v[112:115]
s_waitcnt lgkmcnt(5)
v_exp_f32 v123, v123
v_mfma_f32_16x16x32_bf16 v[88:91], a[152:155], v[32:35], v[88:91]
ds_read_b128 a[176:179], v2 offset:49152
v_cvt_pk_bf16_f32 v169, v122, v123
v_mfma_f32_16x16x32_bf16 v[96:99], a[152:155], v[48:51], v[96:99]
v_exp_f32 v124, v124
v_mfma_f32_16x16x32_bf16 v[104:107], a[152:155], v[64:67], v[104:107]
buffer_load_dwordx4 v4, s[32:35], s64 offen offset:2048 lds
v_mfma_f32_16x16x32_bf16 v[112:115], a[152:155], v[80:83], v[112:115]
s_waitcnt lgkmcnt(5)
v_exp_f32 v125, v125
v_mfma_f32_16x16x32_bf16 v[88:91], a[156:159], v[36:39], v[88:91]
ds_read_b128 a[180:183], v2 offset:50176
v_cvt_pk_bf16_f32 v170, v124, v125
v_mfma_f32_16x16x32_bf16 v[96:99], a[156:159], v[52:55], v[96:99]
v_exp_f32 v126, v126
v_mfma_f32_16x16x32_bf16 v[104:107], a[156:159], v[68:71], v[104:107]
v_mfma_f32_16x16x32_bf16 v[112:115], a[156:159], v[84:87], v[112:115]
s_waitcnt lgkmcnt(5)
v_exp_f32 v127, v127
v_mfma_f32_16x16x32_bf16 v[92:95], a[160:163], v[24:27], v[188:191]
ds_read_b128 a[184:187], v2 offset:51200
v_cvt_pk_bf16_f32 v171, v126, v127
v_mfma_f32_16x16x32_bf16 v[100:103], a[160:163], v[40:43], v[196:199]
v_exp_f32 v128, v128
v_mfma_f32_16x16x32_bf16 v[108:111], a[160:163], v[56:59], v[204:207]
v_mfma_f32_16x16x32_bf16 v[116:119], a[160:163], v[72:75], v[212:215]
s_waitcnt lgkmcnt(5)
v_exp_f32 v129, v129
v_mfma_f32_16x16x32_bf16 v[92:95], a[164:167], v[28:31], v[92:95]
ds_read_b128 a[188:191], v2 offset:52224
v_cvt_pk_bf16_f32 v172, v128, v129
v_mfma_f32_16x16x32_bf16 v[100:103], a[164:167], v[44:47], v[100:103]
v_exp_f32 v130, v130
v_mfma_f32_16x16x32_bf16 v[108:111], a[164:167], v[60:63], v[108:111]
v_mfma_f32_16x16x32_bf16 v[116:119], a[164:167], v[76:79], v[116:119]
s_waitcnt lgkmcnt(5)
v_exp_f32 v131, v131
v_mfma_f32_16x16x32_bf16 v[92:95], a[168:171], v[32:35], v[92:95]
ds_read_b128 a[192:195], v2 offset:53248
v_cvt_pk_bf16_f32 v173, v130, v131
v_mfma_f32_16x16x32_bf16 v[100:103], a[168:171], v[48:51], v[100:103]
v_exp_f32 v132, v132
v_mfma_f32_16x16x32_bf16 v[108:111], a[168:171], v[64:67], v[108:111]
buffer_load_dwordx4 v4, s[32:35], s64 offen offset:3072 lds
v_mfma_f32_16x16x32_bf16 v[116:119], a[168:171], v[80:83], v[116:119]
s_waitcnt lgkmcnt(5)
v_exp_f32 v133, v133
v_mfma_f32_16x16x32_bf16 v[92:95], a[172:175], v[36:39], v[92:95]
ds_read_b128 a[196:199], v2 offset:54272
v_cvt_pk_bf16_f32 v174, v132, v133
v_mfma_f32_16x16x32_bf16 v[100:103], a[172:175], v[52:55], v[100:103]
v_exp_f32 v134, v134
v_mfma_f32_16x16x32_bf16 v[108:111], a[172:175], v[68:71], v[108:111]
v_mfma_f32_16x16x32_bf16 v[116:119], a[172:175], v[84:87], v[116:119]
s_waitcnt lgkmcnt(5)
v_exp_f32 v135, v135
v_mfma_f32_16x16x32_bf16 a[0:3], a[176:179], v[152:155], 0
ds_read_b128 a[200:203], v2 offset:55296
v_cvt_pk_bf16_f32 v175, v134, v135
v_mfma_f32_16x16x32_bf16 a[32:35], a[176:179], v[156:159], 0
v_exp_f32 v136, v136
v_mfma_f32_16x16x32_bf16 a[64:67], a[176:179], v[160:163], 0
v_mfma_f32_16x16x32_bf16 a[96:99], a[176:179], v[164:167], 0
s_waitcnt lgkmcnt(5)
v_exp_f32 v137, v137
v_mfma_f32_16x16x32_bf16 a[4:7], a[180:183], v[152:155], 0
ds_read_b128 a[204:207], v2 offset:56320
v_cvt_pk_bf16_f32 v176, v136, v137
v_mfma_f32_16x16x32_bf16 a[36:39], a[180:183], v[156:159], 0
v_exp_f32 v138, v138
v_mfma_f32_16x16x32_bf16 a[68:71], a[180:183], v[160:163], 0
v_mfma_f32_16x16x32_bf16 a[100:103], a[180:183], v[164:167], 0
s_waitcnt lgkmcnt(5)
v_exp_f32 v139, v139
v_mfma_f32_16x16x32_bf16 a[8:11], a[184:187], v[152:155], 0
ds_read_b128 a[144:147], v2 offset:24576
v_cvt_pk_bf16_f32 v177, v138, v139
v_mfma_f32_16x16x32_bf16 a[40:43], a[184:187], v[156:159], 0
v_exp_f32 v140, v140
v_mfma_f32_16x16x32_bf16 a[72:75], a[184:187], v[160:163], 0
v_mfma_f32_16x16x32_bf16 a[104:107], a[184:187], v[164:167], 0
s_waitcnt lgkmcnt(5)
v_exp_f32 v141, v141
v_mfma_f32_16x16x32_bf16 a[12:15], a[188:191], v[152:155], 0
s_add_u32 m0, s65, 4096
s_add_u32 s69, s64, 4096
ds_read_b128 a[148:151], v2 offset:25600
v_cvt_pk_bf16_f32 v178, v140, v141
v_mfma_f32_16x16x32_bf16 a[44:47], a[188:191], v[156:159], 0
v_exp_f32 v142, v142
v_mfma_f32_16x16x32_bf16 a[76:79], a[188:191], v[160:163], 0
buffer_load_dwordx4 v4, s[32:35], s69 offen offset:0 lds
v_mfma_f32_16x16x32_bf16 a[108:111], a[188:191], v[164:167], 0
s_waitcnt lgkmcnt(5)
v_exp_f32 v143, v143
v_mfma_f32_16x16x32_bf16 a[16:19], a[192:195], v[152:155], 0
ds_read_b128 a[152:155], v2 offset:26624
v_cvt_pk_bf16_f32 v179, v142, v143
v_mfma_f32_16x16x32_bf16 a[48:51], a[192:195], v[156:159], 0
v_exp_f32 v144, v144
v_mfma_f32_16x16x32_bf16 a[80:83], a[192:195], v[160:163], 0
v_mfma_f32_16x16x32_bf16 a[112:115], a[192:195], v[164:167], 0
s_waitcnt lgkmcnt(5)
v_exp_f32 v145, v145
v_mfma_f32_16x16x32_bf16 a[20:23], a[196:199], v[152:155], 0
ds_read_b128 a[156:159], v2 offset:27648
v_cvt_pk_bf16_f32 v180, v144, v145
v_mfma_f32_16x16x32_bf16 a[52:55], a[196:199], v[156:159], 0
v_exp_f32 v146, v146
v_mfma_f32_16x16x32_bf16 a[84:87], a[196:199], v[160:163], 0
v_mfma_f32_16x16x32_bf16 a[116:119], a[196:199], v[164:167], 0
s_waitcnt lgkmcnt(5)
v_exp_f32 v147, v147
v_mfma_f32_16x16x32_bf16 a[24:27], a[200:203], v[152:155], 0
ds_read_b128 a[160:163], v2 offset:28672
v_cvt_pk_bf16_f32 v181, v146, v147
v_mfma_f32_16x16x32_bf16 a[56:59], a[200:203], v[156:159], 0
v_exp_f32 v148, v148
v_mfma_f32_16x16x32_bf16 a[88:91], a[200:203], v[160:163], 0
buffer_load_dwordx4 v4, s[32:35], s69 offen offset:1024 lds
v_mfma_f32_16x16x32_bf16 a[120:123], a[200:203], v[164:167], 0
s_waitcnt lgkmcnt(5)
v_exp_f32 v149, v149
v_mfma_f32_16x16x32_bf16 a[28:31], a[204:207], v[152:155], 0
ds_read_b128 a[164:167], v2 offset:29696
v_cvt_pk_bf16_f32 v182, v148, v149
v_mfma_f32_16x16x32_bf16 a[60:63], a[204:207], v[156:159], 0
v_exp_f32 v150, v150
v_mfma_f32_16x16x32_bf16 a[92:95], a[204:207], v[160:163], 0
s_cmp_le_u32 s66, 1
s_cbranch_scc1 L_st_14
L_bk_15:
s_sub_u32 s66, s66, 1
v_mfma_f32_16x16x32_bf16 a[124:127], a[204:207], v[164:167], 0
v_exp_f32 v151, v151
v_mfma_f32_16x16x32_bf16 a[128:131], v[16:19], v[152:155], 0
v_cvt_pk_bf16_f32 v183, v150, v151
v_mfma_f32_16x16x32_bf16 a[132:135], v[16:19], v[156:159], 0
v_mfma_f32_16x16x32_bf16 a[136:139], v[16:19], v[160:163], 0
v_mfma_f32_16x16x32_bf16 a[140:143], v[16:19], v[164:167], 0
s_waitcnt lgkmcnt(5)
v_mfma_f32_16x16x32_bf16 v[120:123], a[144:147], v[24:27], v[184:187]
ds_read_b128 a[168:171], v2 offset:30720
v_mfma_f32_16x16x32_bf16 v[128:131], a[144:147], v[40:43], v[192:195]
v_exp_f32 v88, v88
v_mfma_f32_16x16x32_bf16 v[136:139], a[144:147], v[56:59], v[200:203]
v_mfma_f32_16x16x32_bf16 v[144:147], a[144:147], v[72:75], v[208:211]
s_waitcnt lgkmcnt(5)
v_exp_f32 v89, v89
v_mfma_f32_16x16x32_bf16 v[120:123], a[148:151], v[28:31], v[120:123]
ds_read_b128 a[172:175], v2 offset:31744
v_cvt_pk_bf16_f32 v152, v88, v89
v_mfma_f32_16x16x32_bf16 v[128:131], a[148:151], v[44:47], v[128:131]
v_exp_f32 v90, v90
v_mfma_f32_16x16x32_bf16 v[136:139], a[148:151], v[60:63], v[136:139]
v_mfma_f32_16x16x32_bf16 v[144:147], a[148:151], v[76:79], v[144:147]
s_waitcnt lgkmcnt(5)
v_exp_f32 v91, v91
v_mfma_f32_16x16x32_bf16 v[120:123], a[152:155], v[32:35], v[120:123]
ds_read_b128 a[176:179], v2 offset:57344
v_cvt_pk_bf16_f32 v153, v90, v91
v_mfma_f32_16x16x32_bf16 v[128:131], a[152:155], v[48:51], v[128:131]
v_exp_f32 v92, v92
v_mfma_f32_16x16x32_bf16 v[136:139], a[152:155], v[64:67], v[136:139]
buffer_load_dwordx4 v4, s[32:35], s69 offen offset:2048 lds
v_mfma_f32_16x16x32_bf16 v[144:147], a[152:155], v[80:83], v[144:147]
s_waitcnt lgkmcnt(5)
v_exp_f32 v93, v93
v_mfma_f32_16x16x32_bf16 v[120:123], a[156:159], v[36:39], v[120:123]
ds_read_b128 a[180:183], v2 offset:58368
v_cvt_pk_bf16_f32 v154, v92, v93
v_mfma_f32_16x16x32_bf16 v[128:131], a[156:159], v[52:55], v[128:131]
v_exp_f32 v94, v94
v_mfma_f32_16x16x32_bf16 v[136:139], a[156:159], v[68:71], v[136:139]
v_mfma_f32_16x16x32_bf16 v[144:147], a[156:159], v[84:87], v[144:147]
s_waitcnt lgkmcnt(5)
v_exp_f32 v95, v95
v_mfma_f32_16x16x32_bf16 v[124:127], a[160:163], v[24:27], v[188:191]
ds_read_b128 a[184:187], v2 offset:59392
v_cvt_pk_bf16_f32 v155, v94, v95
v_mfma_f32_16x16x32_bf16 v[132:135], a[160:163], v[40:43], v[196:199]
v_exp_f32 v96, v96
v_mfma_f32_16x16x32_bf16 v[140:143], a[160:163], v[56:59], v[204:207]
v_mfma_f32_16x16x32_bf16 v[148:151], a[160:163], v[72:75], v[212:215]
s_waitcnt lgkmcnt(5)
v_exp_f32 v97, v97
v_mfma_f32_16x16x32_bf16 v[124:127], a[164:167], v[28:31], v[124:127]
ds_read_b128 a[188:191], v2 offset:60416
v_cvt_pk_bf16_f32 v156, v96, v97
v_mfma_f32_16x16x32_bf16 v[132:135], a[164:167], v[44:47], v[132:135]
v_exp_f32 v98, v98
v_mfma_f32_16x16x32_bf16 v[140:143], a[164:167], v[60:63], v[140:143]
v_mfma_f32_16x16x32_bf16 v[148:151], a[164:167], v[76:79], v[148:151]
s_waitcnt lgkmcnt(5)
v_exp_f32 v99, v99
v_mfma_f32_16x16x32_bf16 v[124:127], a[168:171], v[32:35], v[124:127]
ds_read_b128 a[192:195], v2 offset:61440
v_cvt_pk_bf16_f32 v157, v98, v99
v_mfma_f32_16x16x32_bf16 v[132:135], a[168:171], v[48:51], v[132:135]
v_exp_f32 v100, v100
v_mfma_f32_16x16x32_bf16 v[140:143], a[168:171], v[64:67], v[140:143]
buffer_load_dwordx4 v4, s[32:35], s69 offen offset:3072 lds
v_mfma_f32_16x16x32_bf16 v[148:151], a[168:171], v[80:83], v[148:151]
s_waitcnt lgkmcnt(5)
v_exp_f32 v101, v101
v_mfma_f32_16x16x32_bf16 v[124:127], a[172:175], v[36:39], v[124:127]
ds_read_b128 a[196:199], v2 offset:62464
v_cvt_pk_bf16_f32 v158, v100, v101
v_mfma_f32_16x16x32_bf16 v[132:135], a[172:175], v[52:55], v[132:135]
v_exp_f32 v102, v102
v_mfma_f32_16x16x32_bf16 v[140:143], a[172:175], v[68:71], v[140:143]
v_mfma_f32_16x16x32_bf16 v[148:151], a[172:175], v[84:87], v[148:151]
s_waitcnt lgkmcnt(5)
v_exp_f32 v103, v103
v_mfma_f32_16x16x32_bf16 a[0:3], a[176:179], v[168:171], a[0:3]
ds_read_b128 a[200:203], v2 offset:63488
v_cvt_pk_bf16_f32 v159, v102, v103
v_mfma_f32_16x16x32_bf16 a[32:35], a[176:179], v[172:175], a[32:35]
v_exp_f32 v104, v104
v_mfma_f32_16x16x32_bf16 a[64:67], a[176:179], v[176:179], a[64:67]
v_mfma_f32_16x16x32_bf16 a[96:99], a[176:179], v[180:183], a[96:99]
s_waitcnt lgkmcnt(5)
v_exp_f32 v105, v105
v_mfma_f32_16x16x32_bf16 a[4:7], a[180:183], v[168:171], a[4:7]
ds_read_b128 a[204:207], v2 offset:64512
v_cvt_pk_bf16_f32 v160, v104, v105
v_mfma_f32_16x16x32_bf16 a[36:39], a[180:183], v[172:175], a[36:39]
v_exp_f32 v106, v106
v_mfma_f32_16x16x32_bf16 a[68:71], a[180:183], v[176:179], a[68:71]
v_mfma_f32_16x16x32_bf16 a[100:103], a[180:183], v[180:183], a[100:103]
s_waitcnt lgkmcnt(5)
v_exp_f32 v107, v107
v_mfma_f32_16x16x32_bf16 a[8:11], a[184:187], v[168:171], a[8:11]
v_xor_b32 v2, 0x10000, v2
s_waitcnt vmcnt(8)
s_barrier
s_xor_b32 s65, s65, 81920
s_add_u32 s64, s64, 32768
s_mov_b32 m0, s65
ds_read_b128 a[144:147], v2 offset:0
v_cvt_pk_bf16_f32 v161, v106, v107
v_mfma_f32_16x16x32_bf16 a[40:43], a[184:187], v[172:175], a[40:43]
v_exp_f32 v108, v108
v_mfma_f32_16x16x32_bf16 a[72:75], a[184:187], v[176:179], a[72:75]
v_mfma_f32_16x16x32_bf16 a[104:107], a[184:187], v[180:183], a[104:107]
s_waitcnt lgkmcnt(5)
v_exp_f32 v109, v109
v_mfma_f32_16x16x32_bf16 a[12:15], a[188:191], v[168:171], a[12:15]
ds_read_b128 a[148:151], v2 offset:1024
v_cvt_pk_bf16_f32 v162, v108, v109
v_mfma_f32_16x16x32_bf16 a[44:47], a[188:191], v[172:175], a[44:47]
v_exp_f32 v110, v110
v_mfma_f32_16x16x32_bf16 a[76:79], a[188:191], v[176:179], a[76:79]
buffer_load_dwordx4 v4, s[32:35], s64 offen offset:0 lds
v_mfma_f32_16x16x32_bf16 a[108:111], a[188:191], v[180:183], a[108:111]
s_waitcnt lgkmcnt(5)
v_exp_f32 v111, v111
v_mfma_f32_16x16x32_bf16 a[16:19], a[192:195], v[168:171], a[16:19]
ds_read_b128 a[152:155], v2 offset:2048
v_cvt_pk_bf16_f32 v163, v110, v111
v_mfma_f32_16x16x32_bf16 a[48:51], a[192:195], v[172:175], a[48:51]
v_exp_f32 v112, v112
v_mfma_f32_16x16x32_bf16 a[80:83], a[192:195], v[176:179], a[80:83]
v_mfma_f32_16x16x32_bf16 a[112:115], a[192:195], v[180:183], a[112:115]
s_waitcnt lgkmcnt(5)
v_exp_f32 v113, v113
v_mfma_f32_16x16x32_bf16 a[20:23], a[196:199], v[168:171], a[20:23]
ds_read_b128 a[156:159], v2 offset:3072
v_cvt_pk_bf16_f32 v164, v112, v113
v_mfma_f32_16x16x32_bf16 a[52:55], a[196:199], v[172:175], a[52:55]
v_exp_f32 v114, v114
v_mfma_f32_16x16x32_bf16 a[84:87], a[196:199], v[176:179], a[84:87]
v_mfma_f32_16x16x32_bf16 a[116:119], a[196:199], v[180:183], a[116:119]
s_waitcnt lgkmcnt(5)
v_exp_f32 v115, v115
v_mfma_f32_16x16x32_bf16 a[24:27], a[200:203], v[168:171], a[24:27]
ds_read_b128 a[160:163], v2 offset:4096
v_cvt_pk_bf16_f32 v165, v114, v115
v_mfma_f32_16x16x32_bf16 a[56:59], a[200:203], v[172:175], a[56:59]
v_exp_f32 v116, v116
v_mfma_f32_16x16x32_bf16 a[88:91], a[200:203], v[176:179], a[88:91]
buffer_load_dwordx4 v4, s[32:35], s64 offen offset:1024 lds
v_mfma_f32_16x16x32_bf16 a[120:123], a[200:203], v[180:183], a[120:123]
s_waitcnt lgkmcnt(5)
v_exp_f32 v117, v117
v_mfma_f32_16x16x32_bf16 a[28:31], a[204:207], v[168:171], a[28:31]
ds_read_b128 a[164:167], v2 offset:5120
v_cvt_pk_bf16_f32 v166, v116, v117
v_mfma_f32_16x16x32_bf16 a[60:63], a[204:207], v[172:175], a[60:63]
v_exp_f32 v118, v118
v_mfma_f32_16x16x32_bf16 a[92:95], a[204:207], v[176:179], a[92:95]
s_cmp_le_u32 s66, 1
s_cbranch_scc1 L_st_16
L_bk_17:
s_sub_u32 s66, s66, 1
v_mfma_f32_16x16x32_bf16 a[124:127], a[204:207], v[180:183], a[124:127]
v_exp_f32 v119, v119
v_mfma_f32_16x16x32_bf16 a[128:131], v[16:19], v[168:171], a[128:131]
v_cvt_pk_bf16_f32 v167, v118, v119
v_mfma_f32_16x16x32_bf16 a[132:135], v[16:19], v[172:175], a[132:135]
v_mfma_f32_16x16x32_bf16 a[136:139], v[16:19], v[176:179], a[136:139]
v_mfma_f32_16x16x32_bf16 a[140:143], v[16:19], v[180:183], a[140:143]
s_mov_b32 s67, s3
s_cmp_eq_u32 s67, 0
s_cbranch_scc1 L_trans_19
.p2align 3
L_dual_18:
s_waitcnt lgkmcnt(5)
v_mfma_f32_16x16x32_bf16 v[88:91], a[144:147], v[24:27], v[184:187]
ds_read_b128 a[168:171], v2 offset:6144
v_mfma_f32_16x16x32_bf16 v[96:99], a[144:147], v[40:43], v[192:195]
v_exp_f32 v120, v120
v_mfma_f32_16x16x32_bf16 v[104:107], a[144:147], v[56:59], v[200:203]
v_mfma_f32_16x16x32_bf16 v[112:115], a[144:147], v[72:75], v[208:211]
s_waitcnt lgkmcnt(5)
v_exp_f32 v121, v121
v_mfma_f32_16x16x32_bf16 v[88:91], a[148:151], v[28:31], v[88:91]
ds_read_b128 a[172:175], v2 offset:7168
v_cvt_pk_bf16_f32 v168, v120, v121
v_mfma_f32_16x16x32_bf16 v[96:99], a[148:151], v[44:47], v[96:99]
v_exp_f32 v122, v122
v_mfma_f32_16x16x32_bf16 v[104:107], a[148:151], v[60:63], v[104:107]
v_mfma_f32_16x16x32_bf16 v[112:115], a[148:151], v[76:79], v[112:115]
s_waitcnt lgkmcnt(5)
v_exp_f32 v123, v123
v_mfma_f32_16x16x32_bf16 v[88:91], a[152:155], v[32:35], v[88:91]
ds_read_b128 a[176:179], v2 offset:32768
v_cvt_pk_bf16_f32 v169, v122, v123
v_mfma_f32_16x16x32_bf16 v[96:99], a[152:155], v[48:51], v[96:99]
v_exp_f32 v124, v124
v_mfma_f32_16x16x32_bf16 v[104:107], a[152:155], v[64:67], v[104:107]
buffer_load_dwordx4 v4, s[32:35], s64 offen offset:2048 lds
v_mfma_f32_16x16x32_bf16 v[112:115], a[152:155], v[80:83], v[112:115]
s_waitcnt lgkmcnt(5)
v_exp_f32 v125, v125
v_mfma_f32_16x16x32_bf16 v[88:91], a[156:159], v[36:39], v[88:91]
ds_read_b128 a[180:183], v2 offset:33792
v_cvt_pk_bf16_f32 v170, v124, v125
v_mfma_f32_16x16x32_bf16 v[96:99], a[156:159], v[52:55], v[96:99]
v_exp_f32 v126, v126
v_mfma_f32_16x16x32_bf16 v[104:107], a[156:159], v[68:71], v[104:107]
v_mfma_f32_16x16x32_bf16 v[112:115], a[156:159], v[84:87], v[112:115]
s_waitcnt lgkmcnt(5)
v_exp_f32 v127, v127
v_mfma_f32_16x16x32_bf16 v[92:95], a[160:163], v[24:27], v[188:191]
ds_read_b128 a[184:187], v2 offset:34816
v_cvt_pk_bf16_f32 v171, v126, v127
v_mfma_f32_16x16x32_bf16 v[100:103], a[160:163], v[40:43], v[196:199]
v_exp_f32 v128, v128
v_mfma_f32_16x16x32_bf16 v[108:111], a[160:163], v[56:59], v[204:207]
v_mfma_f32_16x16x32_bf16 v[116:119], a[160:163], v[72:75], v[212:215]
s_waitcnt lgkmcnt(5)
v_exp_f32 v129, v129
v_mfma_f32_16x16x32_bf16 v[92:95], a[164:167], v[28:31], v[92:95]
ds_read_b128 a[188:191], v2 offset:35840
v_cvt_pk_bf16_f32 v172, v128, v129
v_mfma_f32_16x16x32_bf16 v[100:103], a[164:167], v[44:47], v[100:103]
v_exp_f32 v130, v130
v_mfma_f32_16x16x32_bf16 v[108:111], a[164:167], v[60:63], v[108:111]
v_mfma_f32_16x16x32_bf16 v[116:119], a[164:167], v[76:79], v[116:119]
s_waitcnt lgkmcnt(5)
v_exp_f32 v131, v131
v_mfma_f32_16x16x32_bf16 v[92:95], a[168:171], v[32:35], v[92:95]
ds_read_b128 a[192:195], v2 offset:36864
v_cvt_pk_bf16_f32 v173, v130, v131
v_mfma_f32_16x16x32_bf16 v[100:103], a[168:171], v[48:51], v[100:103]
v_exp_f32 v132, v132
v_mfma_f32_16x16x32_bf16 v[108:111], a[168:171], v[64:67], v[108:111]
buffer_load_dwordx4 v4, s[32:35], s64 offen offset:3072 lds
v_mfma_f32_16x16x32_bf16 v[116:119], a[168:171], v[80:83], v[116:119]
s_waitcnt lgkmcnt(5)
v_exp_f32 v133, v133
v_mfma_f32_16x16x32_bf16 v[92:95], a[172:175], v[36:39], v[92:95]
ds_read_b128 a[196:199], v2 offset:37888
v_cvt_pk_bf16_f32 v174, v132, v133
v_mfma_f32_16x16x32_bf16 v[100:103], a[172:175], v[52:55], v[100:103]
v_exp_f32 v134, v134
v_mfma_f32_16x16x32_bf16 v[108:111], a[172:175], v[68:71], v[108:111]
v_mfma_f32_16x16x32_bf16 v[116:119], a[172:175], v[84:87], v[116:119]
s_waitcnt lgkmcnt(5)
v_exp_f32 v135, v135
v_mfma_f32_16x16x32_bf16 a[0:3], a[176:179], v[152:155], a[0:3]
ds_read_b128 a[200:203], v2 offset:38912
v_cvt_pk_bf16_f32 v175, v134, v135
v_mfma_f32_16x16x32_bf16 a[32:35], a[176:179], v[156:159], a[32:35]
v_exp_f32 v136, v136
v_mfma_f32_16x16x32_bf16 a[64:67], a[176:179], v[160:163], a[64:67]
v_mfma_f32_16x16x32_bf16 a[96:99], a[176:179], v[164:167], a[96:99]
s_waitcnt lgkmcnt(5)
v_exp_f32 v137, v137
v_mfma_f32_16x16x32_bf16 a[4:7], a[180:183], v[152:155], a[4:7]
ds_read_b128 a[204:207], v2 offset:39936
v_cvt_pk_bf16_f32 v176, v136, v137
v_mfma_f32_16x16x32_bf16 a[36:39], a[180:183], v[156:159], a[36:39]
v_exp_f32 v138, v138
v_mfma_f32_16x16x32_bf16 a[68:71], a[180:183], v[160:163], a[68:71]
v_mfma_f32_16x16x32_bf16 a[100:103], a[180:183], v[164:167], a[100:103]
s_waitcnt lgkmcnt(5)
v_exp_f32 v139, v139
v_mfma_f32_16x16x32_bf16 a[8:11], a[184:187], v[152:155], a[8:11]
ds_read_b128 a[144:147], v2 offset:8192
v_cvt_pk_bf16_f32 v177, v138, v139
v_mfma_f32_16x16x32_bf16 a[40:43], a[184:187], v[156:159], a[40:43]
v_exp_f32 v140, v140
v_mfma_f32_16x16x32_bf16 a[72:75], a[184:187], v[160:163], a[72:75]
v_mfma_f32_16x16x32_bf16 a[104:107], a[184:187], v[164:167], a[104:107]
s_waitcnt lgkmcnt(5)
v_exp_f32 v141, v141
v_mfma_f32_16x16x32_bf16 a[12:15], a[188:191], v[152:155], a[12:15]
s_add_u32 m0, s65, 4096
s_add_u32 s69, s64, 4096
ds_read_b128 a[148:151], v2 offset:9216
v_cvt_pk_bf16_f32 v178, v140, v141
v_mfma_f32_16x16x32_bf16 a[44:47], a[188:191], v[156:159], a[44:47]
v_exp_f32 v142, v142
v_mfma_f32_16x16x32_bf16 a[76:79], a[188:191], v[160:163], a[76:79]
buffer_load_dwordx4 v4, s[32:35], s69 offen offset:0 lds
v_mfma_f32_16x16x32_bf16 a[108:111], a[188:191], v[164:167], a[108:111]
s_waitcnt lgkmcnt(5)
v_exp_f32 v143, v143
v_mfma_f32_16x16x32_bf16 a[16:19], a[192:195], v[152:155], a[16:19]
ds_read_b128 a[152:155], v2 offset:10240
v_cvt_pk_bf16_f32 v179, v142, v143
v_mfma_f32_16x16x32_bf16 a[48:51], a[192:195], v[156:159], a[48:51]
v_exp_f32 v144, v144
v_mfma_f32_16x16x32_bf16 a[80:83], a[192:195], v[160:163], a[80:83]
v_mfma_f32_16x16x32_bf16 a[112:115], a[192:195], v[164:167], a[112:115]
s_waitcnt lgkmcnt(5)
v_exp_f32 v145, v145
v_mfma_f32_16x16x32_bf16 a[20:23], a[196:199], v[152:155], a[20:23]
ds_read_b128 a[156:159], v2 offset:11264
v_cvt_pk_bf16_f32 v180, v144, v145
v_mfma_f32_16x16x32_bf16 a[52:55], a[196:199], v[156:159], a[52:55]
v_exp_f32 v146, v146
v_mfma_f32_16x16x32_bf16 a[84:87], a[196:199], v[160:163], a[84:87]
v_mfma_f32_16x16x32_bf16 a[116:119], a[196:199], v[164:167], a[116:119]
s_waitcnt lgkmcnt(5)
v_exp_f32 v147, v147
v_mfma_f32_16x16x32_bf16 a[24:27], a[200:203], v[152:155], a[24:27]
ds_read_b128 a[160:163], v2 offset:12288
v_cvt_pk_bf16_f32 v181, v146, v147
v_mfma_f32_16x16x32_bf16 a[56:59], a[200:203], v[156:159], a[56:59]
v_exp_f32 v148, v148
v_mfma_f32_16x16x32_bf16 a[88:91], a[200:203], v[160:163], a[88:91]
buffer_load_dwordx4 v4, s[32:35], s69 offen offset:1024 lds
v_mfma_f32_16x16x32_bf16 a[120:123], a[200:203], v[164:167], a[120:123]
s_waitcnt lgkmcnt(5)
v_exp_f32 v149, v149
v_mfma_f32_16x16x32_bf16 a[28:31], a[204:207], v[152:155], a[28:31]
ds_read_b128 a[164:167], v2 offset:13312
v_cvt_pk_bf16_f32 v182, v148, v149
v_mfma_f32_16x16x32_bf16 a[60:63], a[204:207], v[156:159], a[60:63]
v_exp_f32 v150, v150
v_mfma_f32_16x16x32_bf16 a[92:95], a[204:207], v[160:163], a[92:95]
s_cmp_le_u32 s66, 1
s_cbranch_scc1 L_st_22
L_bk_23:
s_sub_u32 s66, s66, 1
v_mfma_f32_16x16x32_bf16 a[124:127], a[204:207], v[164:167], a[124:127]
v_exp_f32 v151, v151
v_mfma_f32_16x16x32_bf16 a[128:131], v[16:19], v[152:155], a[128:131]
v_cvt_pk_bf16_f32 v183, v150, v151
v_mfma_f32_16x16x32_bf16 a[132:135], v[16:19], v[156:159], a[132:135]
v_mfma_f32_16x16x32_bf16 a[136:139], v[16:19], v[160:163], a[136:139]
v_mfma_f32_16x16x32_bf16 a[140:143], v[16:19], v[164:167], a[140:143]
s_waitcnt lgkmcnt(5)
v_mfma_f32_16x16x32_bf16 v[120:123], a[144:147], v[24:27], v[184:187]
ds_read_b128 a[168:171], v2 offset:14336
v_mfma_f32_16x16x32_bf16 v[128:131], a[144:147], v[40:43], v[192:195]
v_exp_f32 v88, v88
v_mfma_f32_16x16x32_bf16 v[136:139], a[144:147], v[56:59], v[200:203]
v_mfma_f32_16x16x32_bf16 v[144:147], a[144:147], v[72:75], v[208:211]
s_waitcnt lgkmcnt(5)
v_exp_f32 v89, v89
v_mfma_f32_16x16x32_bf16 v[120:123], a[148:151], v[28:31], v[120:123]
ds_read_b128 a[172:175], v2 offset:15360
v_cvt_pk_bf16_f32 v152, v88, v89
v_mfma_f32_16x16x32_bf16 v[128:131], a[148:151], v[44:47], v[128:131]
v_exp_f32 v90, v90
v_mfma_f32_16x16x32_bf16 v[136:139], a[148:151], v[60:63], v[136:139]
v_mfma_f32_16x16x32_bf16 v[144:147], a[148:151], v[76:79], v[144:147]
s_waitcnt lgkmcnt(5)
v_exp_f32 v91, v91
v_mfma_f32_16x16x32_bf16 v[120:123], a[152:155], v[32:35], v[120:123]
ds_read_b128 a[176:179], v2 offset:40960
v_cvt_pk_bf16_f32 v153, v90, v91
v_mfma_f32_16x16x32_bf16 v[128:131], a[152:155], v[48:51], v[128:131]
v_exp_f32 v92, v92
v_mfma_f32_16x16x32_bf16 v[136:139], a[152:155], v[64:67], v[136:139]
buffer_load_dwordx4 v4, s[32:35], s69 offen offset:2048 lds
v_mfma_f32_16x16x32_bf16 v[144:147], a[152:155], v[80:83], v[144:147]
s_waitcnt lgkmcnt(5)
v_exp_f32 v93, v93
v_mfma_f32_16x16x32_bf16 v[120:123], a[156:159], v[36:39], v[120:123]
ds_read_b128 a[180:183], v2 offset:41984
v_cvt_pk_bf16_f32 v154, v92, v93
v_mfma_f32_16x16x32_bf16 v[128:131], a[156:159], v[52:55], v[128:131]
v_exp_f32 v94, v94
v_mfma_f32_16x16x32_bf16 v[136:139], a[156:159], v[68:71], v[136:139]
v_mfma_f32_16x16x32_bf16 v[144:147], a[156:159], v[84:87], v[144:147]
s_waitcnt lgkmcnt(5)
v_exp_f32 v95, v95
v_mfma_f32_16x16x32_bf16 v[124:127], a[160:163], v[24:27], v[188:191]
ds_read_b128 a[184:187], v2 offset:43008
v_cvt_pk_bf16_f32 v155, v94, v95
v_mfma_f32_16x16x32_bf16 v[132:135], a[160:163], v[40:43], v[196:199]
v_exp_f32 v96, v96
v_mfma_f32_16x16x32_bf16 v[140:143], a[160:163], v[56:59], v[204:207]
v_mfma_f32_16x16x32_bf16 v[148:151], a[160:163], v[72:75], v[212:215]
s_waitcnt lgkmcnt(5)
v_exp_f32 v97, v97
v_mfma_f32_16x16x32_bf16 v[124:127], a[164:167], v[28:31], v[124:127]
ds_read_b128 a[188:191], v2 offset:44032
v_cvt_pk_bf16_f32 v156, v96, v97
v_mfma_f32_16x16x32_bf16 v[132:135], a[164:167], v[44:47], v[132:135]
v_exp_f32 v98, v98
v_mfma_f32_16x16x32_bf16 v[140:143], a[164:167], v[60:63], v[140:143]
v_mfma_f32_16x16x32_bf16 v[148:151], a[164:167], v[76:79], v[148:151]
s_waitcnt lgkmcnt(5)
v_exp_f32 v99, v99
v_mfma_f32_16x16x32_bf16 v[124:127], a[168:171], v[32:35], v[124:127]
ds_read_b128 a[192:195], v2 offset:45056
v_cvt_pk_bf16_f32 v157, v98, v99
v_mfma_f32_16x16x32_bf16 v[132:135], a[168:171], v[48:51], v[132:135]
v_exp_f32 v100, v100
v_mfma_f32_16x16x32_bf16 v[140:143], a[168:171], v[64:67], v[140:143]
buffer_load_dwordx4 v4, s[32:35], s69 offen offset:3072 lds
v_mfma_f32_16x16x32_bf16 v[148:151], a[168:171], v[80:83], v[148:151]
s_waitcnt lgkmcnt(5)
v_exp_f32 v101, v101
v_mfma_f32_16x16x32_bf16 v[124:127], a[172:175], v[36:39], v[124:127]
ds_read_b128 a[196:199], v2 offset:46080
v_cvt_pk_bf16_f32 v158, v100, v101
v_mfma_f32_16x16x32_bf16 v[132:135], a[172:175], v[52:55], v[132:135]
v_exp_f32 v102, v102
v_mfma_f32_16x16x32_bf16 v[140:143], a[172:175], v[68:71], v[140:143]
v_mfma_f32_16x16x32_bf16 v[148:151], a[172:175], v[84:87], v[148:151]
s_waitcnt lgkmcnt(5)
v_exp_f32 v103, v103
v_mfma_f32_16x16x32_bf16 a[0:3], a[176:179], v[168:171], a[0:3]
ds_read_b128 a[200:203], v2 offset:47104
v_cvt_pk_bf16_f32 v159, v102, v103
v_mfma_f32_16x16x32_bf16 a[32:35], a[176:179], v[172:175], a[32:35]
v_exp_f32 v104, v104
v_mfma_f32_16x16x32_bf16 a[64:67], a[176:179], v[176:179], a[64:67]
v_mfma_f32_16x16x32_bf16 a[96:99], a[176:179], v[180:183], a[96:99]
s_waitcnt lgkmcnt(5)
v_exp_f32 v105, v105
v_mfma_f32_16x16x32_bf16 a[4:7], a[180:183], v[168:171], a[4:7]
ds_read_b128 a[204:207], v2 offset:48128
v_cvt_pk_bf16_f32 v160, v104, v105
v_mfma_f32_16x16x32_bf16 a[36:39], a[180:183], v[172:175], a[36:39]
v_exp_f32 v106, v106
v_mfma_f32_16x16x32_bf16 a[68:71], a[180:183], v[176:179], a[68:71]
v_mfma_f32_16x16x32_bf16 a[100:103], a[180:183], v[180:183], a[100:103]
s_waitcnt lgkmcnt(5)
v_exp_f32 v107, v107
v_mfma_f32_16x16x32_bf16 a[8:11], a[184:187], v[168:171], a[8:11]
s_waitcnt vmcnt(8)
s_barrier
s_xor_b32 s65, s65, 16384
s_add_u32 s64, s64, 32768
s_mov_b32 m0, s65
ds_read_b128 a[144:147], v2 offset:16384
v_cvt_pk_bf16_f32 v161, v106, v107
v_mfma_f32_16x16x32_bf16 a[40:43], a[184:187], v[172:175], a[40:43]
v_exp_f32 v108, v108
v_mfma_f32_16x16x32_bf16 a[72:75], a[184:187], v[176:179], a[72:75]
v_mfma_f32_16x16x32_bf16 a[104:107], a[184:187], v[180:183], a[104:107]
s_waitcnt lgkmcnt(5)
v_exp_f32 v109, v109
v_mfma_f32_16x16x32_bf16 a[12:15], a[188:191], v[168:171], a[12:15]
ds_read_b128 a[148:151], v2 offset:17408
v_cvt_pk_bf16_f32 v162, v108, v109
v_mfma_f32_16x16x32_bf16 a[44:47], a[188:191], v[172:175], a[44:47]
v_exp_f32 v110, v110
v_mfma_f32_16x16x32_bf16 a[76:79], a[188:191], v[176:179], a[76:79]
buffer_load_dwordx4 v4, s[32:35], s64 offen offset:0 lds
v_mfma_f32_16x16x32_bf16 a[108:111], a[188:191], v[180:183], a[108:111]
s_waitcnt lgkmcnt(5)
v_exp_f32 v111, v111
v_mfma_f32_16x16x32_bf16 a[16:19], a[192:195], v[168:171], a[16:19]
ds_read_b128 a[152:155], v2 offset:18432
v_cvt_pk_bf16_f32 v163, v110, v111
v_mfma_f32_16x16x32_bf16 a[48:51], a[192:195], v[172:175], a[48:51]
v_exp_f32 v112, v112
v_mfma_f32_16x16x32_bf16 a[80:83], a[192:195], v[176:179], a[80:83]
v_mfma_f32_16x16x32_bf16 a[112:115], a[192:195], v[180:183], a[112:115]
s_waitcnt lgkmcnt(5)
v_exp_f32 v113, v113
v_mfma_f32_16x16x32_bf16 a[20:23], a[196:199], v[168:171], a[20:23]
ds_read_b128 a[156:159], v2 offset:19456
v_cvt_pk_bf16_f32 v164, v112, v113
v_mfma_f32_16x16x32_bf16 a[52:55], a[196:199], v[172:175], a[52:55]
v_exp_f32 v114, v114
v_mfma_f32_16x16x32_bf16 a[84:87], a[196:199], v[176:179], a[84:87]
v_mfma_f32_16x16x32_bf16 a[116:119], a[196:199], v[180:183], a[116:119]
s_waitcnt lgkmcnt(5)
v_exp_f32 v115, v115
v_mfma_f32_16x16x32_bf16 a[24:27], a[200:203], v[168:171], a[24:27]
ds_read_b128 a[160:163], v2 offset:20480
v_cvt_pk_bf16_f32 v165, v114, v115
v_mfma_f32_16x16x32_bf16 a[56:59], a[200:203], v[172:175], a[56:59]
v_exp_f32 v116, v116
v_mfma_f32_16x16x32_bf16 a[88:91], a[200:203], v[176:179], a[88:91]
buffer_load_dwordx4 v4, s[32:35], s64 offen offset:1024 lds
v_mfma_f32_16x16x32_bf16 a[120:123], a[200:203], v[180:183], a[120:123]
s_waitcnt lgkmcnt(5)
v_exp_f32 v117, v117
v_mfma_f32_16x16x32_bf16 a[28:31], a[204:207], v[168:171], a[28:31]
ds_read_b128 a[164:167], v2 offset:21504
v_cvt_pk_bf16_f32 v166, v116, v117
v_mfma_f32_16x16x32_bf16 a[60:63], a[204:207], v[172:175], a[60:63]
v_exp_f32 v118, v118
v_mfma_f32_16x16x32_bf16 a[92:95], a[204:207], v[176:179], a[92:95]
s_cmp_le_u32 s66, 1
s_cbranch_scc1 L_st_24
L_bk_25:
s_sub_u32 s66, s66, 1
v_mfma_f32_16x16x32_bf16 a[124:127], a[204:207], v[180:183], a[124:127]
v_exp_f32 v119, v119
v_mfma_f32_16x16x32_bf16 a[128:131], v[16:19], v[168:171], a[128:131]
v_cvt_pk_bf16_f32 v167, v118, v119
v_mfma_f32_16x16x32_bf16 a[132:135], v[16:19], v[172:175], a[132:135]
v_mfma_f32_16x16x32_bf16 a[136:139], v[16:19], v[176:179], a[136:139]
v_mfma_f32_16x16x32_bf16 a[140:143], v[16:19], v[180:183], a[140:143]
s_waitcnt lgkmcnt(5)
v_mfma_f32_16x16x32_bf16 v[88:91], a[144:147], v[24:27], v[184:187]
ds_read_b128 a[168:171], v2 offset:22528
v_mfma_f32_16x16x32_bf16 v[96:99], a[144:147], v[40:43], v[192:195]
v_exp_f32 v120, v120
v_mfma_f32_16x16x32_bf16 v[104:107], a[144:147], v[56:59], v[200:203]
v_mfma_f32_16x16x32_bf16 v[112:115], a[144:147], v[72:75], v[208:211]
s_waitcnt lgkmcnt(5)
v_exp_f32 v121, v121
v_mfma_f32_16x16x32_bf16 v[88:91], a[148:151], v[28:31], v[88:91]
ds_read_b128 a[172:175], v2 offset:23552
v_cvt_pk_bf16_f32 v168, v120, v121
v_mfma_f32_16x16x32_bf16 v[96:99], a[148:151], v[44:47], v[96:99]
v_exp_f32 v122, v122
v_mfma_f32_16x16x32_bf16 v[104:107], a[148:151], v[60:63], v[104:107]
v_mfma_f32_16x16x32_bf16 v[112:115], a[148:151], v[76:79], v[112:115]
s_waitcnt lgkmcnt(5)
v_exp_f32 v123, v123
v_mfma_f32_16x16x32_bf16 v[88:91], a[152:155], v[32:35], v[88:91]
ds_read_b128 a[176:179], v2 offset:49152
v_cvt_pk_bf16_f32 v169, v122, v123
v_mfma_f32_16x16x32_bf16 v[96:99], a[152:155], v[48:51], v[96:99]
v_exp_f32 v124, v124
v_mfma_f32_16x16x32_bf16 v[104:107], a[152:155], v[64:67], v[104:107]
buffer_load_dwordx4 v4, s[32:35], s64 offen offset:2048 lds
v_mfma_f32_16x16x32_bf16 v[112:115], a[152:155], v[80:83], v[112:115]
s_waitcnt lgkmcnt(5)
v_exp_f32 v125, v125
v_mfma_f32_16x16x32_bf16 v[88:91], a[156:159], v[36:39], v[88:91]
ds_read_b128 a[180:183], v2 offset:50176
v_cvt_pk_bf16_f32 v170, v124, v125
v_mfma_f32_16x16x32_bf16 v[96:99], a[156:159], v[52:55], v[96:99]
v_exp_f32 v126, v126
v_mfma_f32_16x16x32_bf16 v[104:107], a[156:159], v[68:71], v[104:107]
v_mfma_f32_16x16x32_bf16 v[112:115], a[156:159], v[84:87], v[112:115]
s_waitcnt lgkmcnt(5)
v_exp_f32 v127, v127
v_mfma_f32_16x16x32_bf16 v[92:95], a[160:163], v[24:27], v[188:191]
ds_read_b128 a[184:187], v2 offset:51200
v_cvt_pk_bf16_f32 v171, v126, v127
v_mfma_f32_16x16x32_bf16 v[100:103], a[160:163], v[40:43], v[196:199]
v_exp_f32 v128, v128
v_mfma_f32_16x16x32_bf16 v[108:111], a[160:163], v[56:59], v[204:207]
v_mfma_f32_16x16x32_bf16 v[116:119], a[160:163], v[72:75], v[212:215]
s_waitcnt lgkmcnt(5)
v_exp_f32 v129, v129
v_mfma_f32_16x16x32_bf16 v[92:95], a[164:167], v[28:31], v[92:95]
ds_read_b128 a[188:191], v2 offset:52224
v_cvt_pk_bf16_f32 v172, v128, v129
v_mfma_f32_16x16x32_bf16 v[100:103], a[164:167], v[44:47], v[100:103]
v_exp_f32 v130, v130
v_mfma_f32_16x16x32_bf16 v[108:111], a[164:167], v[60:63], v[108:111]
v_mfma_f32_16x16x32_bf16 v[116:119], a[164:167], v[76:79], v[116:119]
s_waitcnt lgkmcnt(5)
v_exp_f32 v131, v131
v_mfma_f32_16x16x32_bf16 v[92:95], a[168:171], v[32:35], v[92:95]
ds_read_b128 a[192:195], v2 offset:53248
v_cvt_pk_bf16_f32 v173, v130, v131
v_mfma_f32_16x16x32_bf16 v[100:103], a[168:171], v[48:51], v[100:103]
v_exp_f32 v132, v132
v_mfma_f32_16x16x32_bf16 v[108:111], a[168:171], v[64:67], v[108:111]
buffer_load_dwordx4 v4, s[32:35], s64 offen offset:3072 lds
v_mfma_f32_16x16x32_bf16 v[116:119], a[168:171], v[80:83], v[116:119]
s_waitcnt lgkmcnt(5)
v_exp_f32 v133, v133
v_mfma_f32_16x16x32_bf16 v[92:95], a[172:175], v[36:39], v[92:95]
ds_read_b128 a[196:199], v2 offset:54272
v_cvt_pk_bf16_f32 v174, v132, v133
v_mfma_f32_16x16x32_bf16 v[100:103], a[172:175], v[52:55], v[100:103]
v_exp_f32 v134, v134
v_mfma_f32_16x16x32_bf16 v[108:111], a[172:175], v[68:71], v[108:111]
v_mfma_f32_16x16x32_bf16 v[116:119], a[172:175], v[84:87], v[116:119]
s_waitcnt lgkmcnt(5)
v_exp_f32 v135, v135
v_mfma_f32_16x16x32_bf16 a[0:3], a[176:179], v[152:155], a[0:3]
ds_read_b128 a[200:203], v2 offset:55296
v_cvt_pk_bf16_f32 v175, v134, v135
v_mfma_f32_16x16x32_bf16 a[32:35], a[176:179], v[156:159], a[32:35]
v_exp_f32 v136, v136
v_mfma_f32_16x16x32_bf16 a[64:67], a[176:179], v[160:163], a[64:67]
v_mfma_f32_16x16x32_bf16 a[96:99], a[176:179], v[164:167], a[96:99]
s_waitcnt lgkmcnt(5)
v_exp_f32 v137, v137
v_mfma_f32_16x16x32_bf16 a[4:7], a[180:183], v[152:155], a[4:7]
ds_read_b128 a[204:207], v2 offset:56320
v_cvt_pk_bf16_f32 v176, v136, v137
v_mfma_f32_16x16x32_bf16 a[36:39], a[180:183], v[156:159], a[36:39]
v_exp_f32 v138, v138
v_mfma_f32_16x16x32_bf16 a[68:71], a[180:183], v[160:163], a[68:71]
v_mfma_f32_16x16x32_bf16 a[100:103], a[180:183], v[164:167], a[100:103]
s_waitcnt lgkmcnt(5)
v_exp_f32 v139, v139
v_mfma_f32_16x16x32_bf16 a[8:11], a[184:187], v[152:155], a[8:11]
ds_read_b128 a[144:147], v2 offset:24576
v_cvt_pk_bf16_f32 v177, v138, v139
v_mfma_f32_16x16x32_bf16 a[40:43], a[184:187], v[156:159], a[40:43]
v_exp_f32 v140, v140
v_mfma_f32_16x16x32_bf16 a[72:75], a[184:187], v[160:163], a[72:75]
v_mfma_f32_16x16x32_bf16 a[104:107], a[184:187], v[164:167], a[104:107]
s_waitcnt lgkmcnt(5)
v_exp_f32 v141, v141
v_mfma_f32_16x16x32_bf16 a[12:15], a[188:191], v[152:155], a[12:15]
s_add_u32 m0, s65, 4096
s_add_u32 s69, s64, 4096
ds_read_b128 a[148:151], v2 offset:25600
v_cvt_pk_bf16_f32 v178, v140, v141
v_mfma_f32_16x16x32_bf16 a[44:47], a[188:191], v[156:159], a[44:47]
v_exp_f32 v142, v142
v_mfma_f32_16x16x32_bf16 a[76:79], a[188:191], v[160:163], a[76:79]
buffer_load_dwordx4 v4, s[32:35], s69 offen offset:0 lds
v_mfma_f32_16x16x32_bf16 a[108:111], a[188:191], v[164:167], a[108:111]
s_waitcnt lgkmcnt(5)
v_exp_f32 v143, v143
v_mfma_f32_16x16x32_bf16 a[16:19], a[192:195], v[152:155], a[16:19]
ds_read_b128 a[152:155], v2 offset:26624
v_cvt_pk_bf16_f32 v179, v142, v143
v_mfma_f32_16x16x32_bf16 a[48:51], a[192:195], v[156:159], a[48:51]
v_exp_f32 v144, v144
v_mfma_f32_16x16x32_bf16 a[80:83], a[192:195], v[160:163], a[80:83]
v_mfma_f32_16x16x32_bf16 a[112:115], a[192:195], v[164:167], a[112:115]
s_waitcnt lgkmcnt(5)
v_exp_f32 v145, v145
v_mfma_f32_16x16x32_bf16 a[20:23], a[196:199], v[152:155], a[20:23]
ds_read_b128 a[156:159], v2 offset:27648
v_cvt_pk_bf16_f32 v180, v144, v145
v_mfma_f32_16x16x32_bf16 a[52:55], a[196:199], v[156:159], a[52:55]
v_exp_f32 v146, v146
v_mfma_f32_16x16x32_bf16 a[84:87], a[196:199], v[160:163], a[84:87]
v_mfma_f32_16x16x32_bf16 a[116:119], a[196:199], v[164:167], a[116:119]
s_waitcnt lgkmcnt(5)
v_exp_f32 v147, v147
v_mfma_f32_16x16x32_bf16 a[24:27], a[200:203], v[152:155], a[24:27]
ds_read_b128 a[160:163], v2 offset:28672
v_cvt_pk_bf16_f32 v181, v146, v147
v_mfma_f32_16x16x32_bf16 a[56:59], a[200:203], v[156:159], a[56:59]
v_exp_f32 v148, v148
v_mfma_f32_16x16x32_bf16 a[88:91], a[200:203], v[160:163], a[88:91]
buffer_load_dwordx4 v4, s[32:35], s69 offen offset:1024 lds
v_mfma_f32_16x16x32_bf16 a[120:123], a[200:203], v[164:167], a[120:123]
s_waitcnt lgkmcnt(5)
v_exp_f32 v149, v149
v_mfma_f32_16x16x32_bf16 a[28:31], a[204:207], v[152:155], a[28:31]
ds_read_b128 a[164:167], v2 offset:29696
v_cvt_pk_bf16_f32 v182, v148, v149
v_mfma_f32_16x16x32_bf16 a[60:63], a[204:207], v[156:159], a[60:63]
v_exp_f32 v150, v150
v_mfma_f32_16x16x32_bf16 a[92:95], a[204:207], v[160:163], a[92:95]
s_cmp_le_u32 s66, 1
s_cbranch_scc1 L_st_26
L_bk_27:
s_sub_u32 s66, s66, 1
v_mfma_f32_16x16x32_bf16 a[124:127], a[204:207], v[164:167], a[124:127]
v_exp_f32 v151, v151
v_mfma_f32_16x16x32_bf16 a[128:131], v[16:19], v[152:155], a[128:131]
v_cvt_pk_bf16_f32 v183, v150, v151
v_mfma_f32_16x16x32_bf16 a[132:135], v[16:19], v[156:159], a[132:135]
v_mfma_f32_16x16x32_bf16 a[136:139], v[16:19], v[160:163], a[136:139]
v_mfma_f32_16x16x32_bf16 a[140:143], v[16:19], v[164:167], a[140:143]
s_waitcnt lgkmcnt(5)
v_mfma_f32_16x16x32_bf16 v[120:123], a[144:147], v[24:27], v[184:187]
ds_read_b128 a[168:171], v2 offset:30720
v_mfma_f32_16x16x32_bf16 v[128:131], a[144:147], v[40:43], v[192:195]
v_exp_f32 v88, v88
v_mfma_f32_16x16x32_bf16 v[136:139], a[144:147], v[56:59], v[200:203]
v_mfma_f32_16x16x32_bf16 v[144:147], a[144:147], v[72:75], v[208:211]
s_waitcnt lgkmcnt(5)
v_exp_f32 v89, v89
v_mfma_f32_16x16x32_bf16 v[120:123], a[148:151], v[28:31], v[120:123]
ds_read_b128 a[172:175], v2 offset:31744
v_cvt_pk_bf16_f32 v152, v88, v89
v_mfma_f32_16x16x32_bf16 v[128:131], a[148:151], v[44:47], v[128:131]
v_exp_f32 v90, v90
v_mfma_f32_16x16x32_bf16 v[136:139], a[148:151], v[60:63], v[136:139]
v_mfma_f32_16x16x32_bf16 v[144:147], a[148:151], v[76:79], v[144:147]
s_waitcnt lgkmcnt(5)
v_exp_f32 v91, v91
v_mfma_f32_16x16x32_bf16 v[120:123], a[152:155], v[32:35], v[120:123]
ds_read_b128 a[176:179], v2 offset:57344
v_cvt_pk_bf16_f32 v153, v90, v91
v_mfma_f32_16x16x32_bf16 v[128:131], a[152:155], v[48:51], v[128:131]
v_exp_f32 v92, v92
v_mfma_f32_16x16x32_bf16 v[136:139], a[152:155], v[64:67], v[136:139]
buffer_load_dwordx4 v4, s[32:35], s69 offen offset:2048 lds
v_mfma_f32_16x16x32_bf16 v[144:147], a[152:155], v[80:83], v[144:147]
s_waitcnt lgkmcnt(5)
v_exp_f32 v93, v93
v_mfma_f32_16x16x32_bf16 v[120:123], a[156:159], v[36:39], v[120:123]
ds_read_b128 a[180:183], v2 offset:58368
v_cvt_pk_bf16_f32 v154, v92, v93
v_mfma_f32_16x16x32_bf16 v[128:131], a[156:159], v[52:55], v[128:131]
v_exp_f32 v94, v94
v_mfma_f32_16x16x32_bf16 v[136:139], a[156:159], v[68:71], v[136:139]
v_mfma_f32_16x16x32_bf16 v[144:147], a[156:159], v[84:87], v[144:147]
s_waitcnt lgkmcnt(5)
v_exp_f32 v95, v95
v_mfma_f32_16x16x32_bf16 v[124:127], a[160:163], v[24:27], v[188:191]
ds_read_b128 a[184:187], v2 offset:59392
v_cvt_pk_bf16_f32 v155, v94, v95
v_mfma_f32_16x16x32_bf16 v[132:135], a[160:163], v[40:43], v[196:199]
v_exp_f32 v96, v96
v_mfma_f32_16x16x32_bf16 v[140:143], a[160:163], v[56:59], v[204:207]
v_mfma_f32_16x16x32_bf16 v[148:151], a[160:163], v[72:75], v[212:215]
s_waitcnt lgkmcnt(5)
v_exp_f32 v97, v97
v_mfma_f32_16x16x32_bf16 v[124:127], a[164:167], v[28:31], v[124:127]
ds_read_b128 a[188:191], v2 offset:60416
v_cvt_pk_bf16_f32 v156, v96, v97
v_mfma_f32_16x16x32_bf16 v[132:135], a[164:167], v[44:47], v[132:135]
v_exp_f32 v98, v98
v_mfma_f32_16x16x32_bf16 v[140:143], a[164:167], v[60:63], v[140:143]
v_mfma_f32_16x16x32_bf16 v[148:151], a[164:167], v[76:79], v[148:151]
s_waitcnt lgkmcnt(5)
v_exp_f32 v99, v99
v_mfma_f32_16x16x32_bf16 v[124:127], a[168:171], v[32:35], v[124:127]
ds_read_b128 a[192:195], v2 offset:61440
v_cvt_pk_bf16_f32 v157, v98, v99
v_mfma_f32_16x16x32_bf16 v[132:135], a[168:171], v[48:51], v[132:135]
v_exp_f32 v100, v100
v_mfma_f32_16x16x32_bf16 v[140:143], a[168:171], v[64:67], v[140:143]
buffer_load_dwordx4 v4, s[32:35], s69 offen offset:3072 lds
v_mfma_f32_16x16x32_bf16 v[148:151], a[168:171], v[80:83], v[148:151]
s_waitcnt lgkmcnt(5)
v_exp_f32 v101, v101
v_mfma_f32_16x16x32_bf16 v[124:127], a[172:175], v[36:39], v[124:127]
ds_read_b128 a[196:199], v2 offset:62464
v_cvt_pk_bf16_f32 v158, v100, v101
v_mfma_f32_16x16x32_bf16 v[132:135], a[172:175], v[52:55], v[132:135]
v_exp_f32 v102, v102
v_mfma_f32_16x16x32_bf16 v[140:143], a[172:175], v[68:71], v[140:143]
v_mfma_f32_16x16x32_bf16 v[148:151], a[172:175], v[84:87], v[148:151]
s_waitcnt lgkmcnt(5)
v_exp_f32 v103, v103
v_mfma_f32_16x16x32_bf16 a[0:3], a[176:179], v[168:171], a[0:3]
ds_read_b128 a[200:203], v2 offset:63488
v_cvt_pk_bf16_f32 v159, v102, v103
v_mfma_f32_16x16x32_bf16 a[32:35], a[176:179], v[172:175], a[32:35]
v_exp_f32 v104, v104
v_mfma_f32_16x16x32_bf16 a[64:67], a[176:179], v[176:179], a[64:67]
v_mfma_f32_16x16x32_bf16 a[96:99], a[176:179], v[180:183], a[96:99]
s_waitcnt lgkmcnt(5)
v_exp_f32 v105, v105
v_mfma_f32_16x16x32_bf16 a[4:7], a[180:183], v[168:171], a[4:7]
ds_read_b128 a[204:207], v2 offset:64512
v_cvt_pk_bf16_f32 v160, v104, v105
v_mfma_f32_16x16x32_bf16 a[36:39], a[180:183], v[172:175], a[36:39]
v_exp_f32 v106, v106
v_mfma_f32_16x16x32_bf16 a[68:71], a[180:183], v[176:179], a[68:71]
v_mfma_f32_16x16x32_bf16 a[100:103], a[180:183], v[180:183], a[100:103]
s_waitcnt lgkmcnt(5)
v_exp_f32 v107, v107
v_mfma_f32_16x16x32_bf16 a[8:11], a[184:187], v[168:171], a[8:11]
v_xor_b32 v2, 0x10000, v2
s_waitcnt vmcnt(8)
s_barrier
s_xor_b32 s65, s65, 81920
s_add_u32 s64, s64, 32768
s_mov_b32 m0, s65
ds_read_b128 a[144:147], v2 offset:0
v_cvt_pk_bf16_f32 v161, v106, v107
v_mfma_f32_16x16x32_bf16 a[40:43], a[184:187], v[172:175], a[40:43]
v_exp_f32 v108, v108
v_mfma_f32_16x16x32_bf16 a[72:75], a[184:187], v[176:179], a[72:75]
v_mfma_f32_16x16x32_bf16 a[104:107], a[184:187], v[180:183], a[104:107]
s_waitcnt lgkmcnt(5)
v_exp_f32 v109, v109
v_mfma_f32_16x16x32_bf16 a[12:15], a[188:191], v[168:171], a[12:15]
ds_read_b128 a[148:151], v2 offset:1024
v_cvt_pk_bf16_f32 v162, v108, v109
v_mfma_f32_16x16x32_bf16 a[44:47], a[188:191], v[172:175], a[44:47]
v_exp_f32 v110, v110
v_mfma_f32_16x16x32_bf16 a[76:79], a[188:191], v[176:179], a[76:79]
buffer_load_dwordx4 v4, s[32:35], s64 offen offset:0 lds
v_mfma_f32_16x16x32_bf16 a[108:111], a[188:191], v[180:183], a[108:111]
s_waitcnt lgkmcnt(5)
v_exp_f32 v111, v111
v_mfma_f32_16x16x32_bf16 a[16:19], a[192:195], v[168:171], a[16:19]
ds_read_b128 a[152:155], v2 offset:2048
v_cvt_pk_bf16_f32 v163, v110, v111
v_mfma_f32_16x16x32_bf16 a[48:51], a[192:195], v[172:175], a[48:51]
v_exp_f32 v112, v112
v_mfma_f32_16x16x32_bf16 a[80:83], a[192:195], v[176:179], a[80:83]
v_mfma_f32_16x16x32_bf16 a[112:115], a[192:195], v[180:183], a[112:115]
s_waitcnt lgkmcnt(5)
v_exp_f32 v113, v113
v_mfma_f32_16x16x32_bf16 a[20:23], a[196:199], v[168:171], a[20:23]
ds_read_b128 a[156:159], v2 offset:3072
v_cvt_pk_bf16_f32 v164, v112, v113
v_mfma_f32_16x16x32_bf16 a[52:55], a[196:199], v[172:175], a[52:55]
v_exp_f32 v114, v114
v_mfma_f32_16x16x32_bf16 a[84:87], a[196:199], v[176:179], a[84:87]
v_mfma_f32_16x16x32_bf16 a[116:119], a[196:199], v[180:183], a[116:119]
s_waitcnt lgkmcnt(5)
v_exp_f32 v115, v115
v_mfma_f32_16x16x32_bf16 a[24:27], a[200:203], v[168:171], a[24:27]
ds_read_b128 a[160:163], v2 offset:4096
v_cvt_pk_bf16_f32 v165, v114, v115
v_mfma_f32_16x16x32_bf16 a[56:59], a[200:203], v[172:175], a[56:59]
v_exp_f32 v116, v116
v_mfma_f32_16x16x32_bf16 a[88:91], a[200:203], v[176:179], a[88:91]
buffer_load_dwordx4 v4, s[32:35], s64 offen offset:1024 lds
v_mfma_f32_16x16x32_bf16 a[120:123], a[200:203], v[180:183], a[120:123]
s_waitcnt lgkmcnt(5)
v_exp_f32 v117, v117
v_mfma_f32_16x16x32_bf16 a[28:31], a[204:207], v[168:171], a[28:31]
ds_read_b128 a[164:167], v2 offset:5120
v_cvt_pk_bf16_f32 v166, v116, v117
v_mfma_f32_16x16x32_bf16 a[60:63], a[204:207], v[172:175], a[60:63]
v_exp_f32 v118, v118
v_mfma_f32_16x16x32_bf16 a[92:95], a[204:207], v[176:179], a[92:95]
s_cmp_le_u32 s66, 1
s_cbranch_scc1 L_st_28
L_bk_29:
s_sub_u32 s66, s66, 1
v_mfma_f32_16x16x32_bf16 a[124:127], a[204:207], v[180:183], a[124:127]
v_exp_f32 v119, v119
v_mfma_f32_16x16x32_bf16 a[128:131], v[16:19], v[168:171], a[128:131]
v_cvt_pk_bf16_f32 v167, v118, v119
v_mfma_f32_16x16x32_bf16 a[132:135], v[16:19], v[172:175], a[132:135]
v_mfma_f32_16x16x32_bf16 a[136:139], v[16:19], v[176:179], a[136:139]
v_mfma_f32_16x16x32_bf16 a[140:143], v[16:19], v[180:183], a[140:143]
s_sub_u32 s67, s67, 1
s_cmp_lg_u32 s67, 0
s_cbranch_scc1 L_dual_18
L_trans_19:
s_sub_u32 s52, s63, s62
s_sub_u32 s52, s52, 1
s_sub_u32 s67, s52, 0
s_lshl2_add_u32 s66, s52, s30
s_add_u32 s66, s66, 1
s_cmp_le_u32 s66, 1
s_cbranch_scc1 L_st_30
L_bk_31:
s_sub_u32 s66, s66, 1
s_waitcnt lgkmcnt(5)
v_mfma_f32_16x16x32_bf16 v[104:107], a[144:147], v[56:59], v[200:203]
ds_read_b128 a[168:171], v2 offset:6144
v_exp_f32 v120, v120
v_mfma_f32_16x16x32_bf16 v[112:115], a[144:147], v[72:75], v[208:211]
s_waitcnt lgkmcnt(5)
v_mfma_f32_16x16x32_bf16 v[104:107], a[148:151], v[60:63], v[104:107]
ds_read_b128 a[172:175], v2 offset:7168
v_exp_f32 v121, v121
v_mfma_f32_16x16x32_bf16 v[112:115], a[148:151], v[76:79], v[112:115]
s_waitcnt lgkmcnt(5)
v_cvt_pk_bf16_f32 v168, v120, v121
v_exp_f32 v122, v122
v_mfma_f32_16x16x32_bf16 v[104:107], a[152:155], v[64:67], v[104:107]
ds_read_b128 a[176:179], v2 offset:32768
v_mfma_f32_16x16x32_bf16 v[112:115], a[152:155], v[80:83], v[112:115]
s_waitcnt lgkmcnt(5)
v_exp_f32 v123, v123
v_mfma_f32_16x16x32_bf16 v[104:107], a[156:159], v[68:71], v[104:107]
ds_read_b128 a[180:183], v2 offset:33792
v_cvt_pk_bf16_f32 v169, v122, v123
v_mfma_f32_16x16x32_bf16 v[112:115], a[156:159], v[84:87], v[112:115]
s_waitcnt lgkmcnt(5)
v_exp_f32 v124, v124
v_mfma_f32_16x16x32_bf16 v[108:111], a[160:163], v[56:59], v[204:207]
ds_read_b128 a[184:187], v2 offset:34816
buffer_load_dwordx4 v4, s[32:35], s64 offen offset:2048 lds
v_exp_f32 v125, v125
v_mfma_f32_16x16x32_bf16 v[116:119], a[160:163], v[72:75], v[212:215]
s_waitcnt lgkmcnt(5)
v_cvt_pk_bf16_f32 v170, v124, v125
v_mfma_f32_16x16x32_bf16 v[108:111], a[164:167], v[60:63], v[108:111]
ds_read_b128 a[188:191], v2 offset:35840
v_exp_f32 v126, v126
v_mfma_f32_16x16x32_bf16 v[116:119], a[164:167], v[76:79], v[116:119]
s_waitcnt lgkmcnt(5)
v_exp_f32 v127, v127
v_mfma_f32_16x16x32_bf16 v[108:111], a[168:171], v[64:67], v[108:111]
ds_read_b128 a[192:195], v2 offset:36864
v_cvt_pk_bf16_f32 v171, v126, v127
v_mfma_f32_16x16x32_bf16 v[116:119], a[168:171], v[80:83], v[116:119]
s_waitcnt lgkmcnt(5)
v_exp_f32 v128, v128
v_mfma_f32_16x16x32_bf16 v[108:111], a[172:175], v[68:71], v[108:111]
ds_read_b128 a[196:199], v2 offset:37888
v_exp_f32 v129, v129
v_mfma_f32_16x16x32_bf16 v[116:119], a[172:175], v[84:87], v[116:119]
s_waitcnt lgkmcnt(5)
v_cvt_pk_bf16_f32 v172, v128, v129
v_mfma_f32_16x16x32_bf16 a[0:3], a[176:179], v[152:155], a[0:3]
ds_read_b128 a[200:203], v2 offset:38912
buffer_load_dwordx4 v4, s[32:35], s64 offen offset:3072 lds
v_exp_f32 v130, v130
v_mfma_f32_16x16x32_bf16 a[32:35], a[176:179], v[156:159], a[32:35]
v_exp_f32 v131, v131
v_mfma_f32_16x16x32_bf16 a[64:67], a[176:179], v[160:163], a[64:67]
v_cvt_pk_bf16_f32 v173, v130, v131
v_mfma_f32_16x16x32_bf16 a[96:99], a[176:179], v[164:167], a[96:99]
s_waitcnt lgkmcnt(5)
v_exp_f32 v132, v132
v_mfma_f32_16x16x32_bf16 a[4:7], a[180:183], v[152:155], a[4:7]
ds_read_b128 a[204:207], v2 offset:39936
v_mfma_f32_16x16x32_bf16 a[36:39], a[180:183], v[156:159], a[36:39]
v_exp_f32 v133, v133
v_mfma_f32_16x16x32_bf16 a[68:71], a[180:183], v[160:163], a[68:71]
v_cvt_pk_bf16_f32 v174, v132, v133
v_exp_f32 v134, v134
v_mfma_f32_16x16x32_bf16 a[100:103], a[180:183], v[164:167], a[100:103]
s_waitcnt lgkmcnt(5)
v_mfma_f32_16x16x32_bf16 a[8:11], a[184:187], v[152:155], a[8:11]
ds_read_b128 a[144:147], v2 offset:8192
v_exp_f32 v135, v135
v_mfma_f32_16x16x32_bf16 a[40:43], a[184:187], v[156:159], a[40:43]
v_cvt_pk_bf16_f32 v175, v134, v135
v_exp_f32 v136, v136
v_mfma_f32_16x16x32_bf16 a[72:75], a[184:187], v[160:163], a[72:75]
v_mfma_f32_16x16x32_bf16 a[104:107], a[184:187], v[164:167], a[104:107]
s_waitcnt lgkmcnt(5)
v_exp_f32 v137, v137
v_mfma_f32_16x16x32_bf16 a[12:15], a[188:191], v[152:155], a[12:15]
ds_read_b128 a[148:151], v2 offset:9216
v_cvt_pk_bf16_f32 v176, v136, v137
v_exp_f32 v138, v138
v_mfma_f32_16x16x32_bf16 a[44:47], a[188:191], v[156:159], a[44:47]
v_mfma_f32_16x16x32_bf16 a[76:79], a[188:191], v[160:163], a[76:79]
v_exp_f32 v139, v139
v_mfma_f32_16x16x32_bf16 a[108:111], a[188:191], v[164:167], a[108:111]
s_waitcnt lgkmcnt(5)
s_add_u32 m0, s65, 4096
s_add_u32 s69, s64, 4096
v_cvt_pk_bf16_f32 v177, v138, v139
v_mfma_f32_16x16x32_bf16 a[16:19], a[192:195], v[152:155], a[16:19]
ds_read_b128 a[152:155], v2 offset:10240
v_exp_f32 v140, v140
v_mfma_f32_16x16x32_bf16 a[48:51], a[192:195], v[156:159], a[48:51]
buffer_load_dwordx4 v4, s[32:35], s69 offen offset:0 lds
v_exp_f32 v141, v141
v_mfma_f32_16x16x32_bf16 a[80:83], a[192:195], v[160:163], a[80:83]
v_cvt_pk_bf16_f32 v178, v140, v141
v_mfma_f32_16x16x32_bf16 a[112:115], a[192:195], v[164:167], a[112:115]
s_waitcnt lgkmcnt(5)
v_exp_f32 v142, v142
v_mfma_f32_16x16x32_bf16 a[20:23], a[196:199], v[152:155], a[20:23]
ds_read_b128 a[156:159], v2 offset:11264
v_exp_f32 v143, v143
v_mfma_f32_16x16x32_bf16 a[52:55], a[196:199], v[156:159], a[52:55]
v_cvt_pk_bf16_f32 v179, v142, v143
v_mfma_f32_16x16x32_bf16 a[84:87], a[196:199], v[160:163], a[84:87]
v_exp_f32 v144, v144
v_mfma_f32_16x16x32_bf16 a[116:119], a[196:199], v[164:167], a[116:119]
s_waitcnt lgkmcnt(5)
v_exp_f32 v145, v145
v_mfma_f32_16x16x32_bf16 a[24:27], a[200:203], v[152:155], a[24:27]
ds_read_b128 a[160:163], v2 offset:12288
v_cvt_pk_bf16_f32 v180, v144, v145
v_mfma_f32_16x16x32_bf16 a[56:59], a[200:203], v[156:159], a[56:59]
v_exp_f32 v146, v146
v_mfma_f32_16x16x32_bf16 a[88:91], a[200:203], v[160:163], a[88:91]
buffer_load_dwordx4 v4, s[32:35], s69 offen offset:1024 lds
v_exp_f32 v147, v147
v_mfma_f32_16x16x32_bf16 a[120:123], a[200:203], v[164:167], a[120:123]
s_waitcnt lgkmcnt(5)
v_cvt_pk_bf16_f32 v181, v146, v147
v_mfma_f32_16x16x32_bf16 a[28:31], a[204:207], v[152:155], a[28:31]
ds_read_b128 a[164:167], v2 offset:13312
v_exp_f32 v148, v148
v_mfma_f32_16x16x32_bf16 a[60:63], a[204:207], v[156:159], a[60:63]
v_mfma_f32_16x16x32_bf16 a[92:95], a[204:207], v[160:163], a[92:95]
v_exp_f32 v149, v149
v_mfma_f32_16x16x32_bf16 a[124:127], a[204:207], v[164:167], a[124:127]
v_cvt_pk_bf16_f32 v182, v148, v149
v_exp_f32 v150, v150
v_mfma_f32_16x16x32_bf16 a[128:131], v[16:19], v[152:155], a[128:131]
v_mfma_f32_16x16x32_bf16 a[132:135], v[16:19], v[156:159], a[132:135]
v_exp_f32 v151, v151
v_mfma_f32_16x16x32_bf16 a[136:139], v[16:19], v[160:163], a[136:139]
s_cmp_le_u32 s66, 1
s_cbranch_scc1 L_st_32
L_bk_33:
s_sub_u32 s66, s66, 1
v_cvt_pk_bf16_f32 v183, v150, v151
v_mfma_f32_16x16x32_bf16 a[140:143], v[16:19], v[164:167], a[140:143]
s_waitcnt lgkmcnt(5)
v_mfma_f32_16x16x32_bf16 v[136:139], a[144:147], v[56:59], v[200:203]
ds_read_b128 a[168:171], v2 offset:14336
v_mfma_f32_16x16x32_bf16 v[144:147], a[144:147], v[72:75], v[208:211]
s_waitcnt lgkmcnt(5)
v_exp_f32 v104, v104
v_mfma_f32_16x16x32_bf16 v[136:139], a[148:151], v[60:63], v[136:139]
ds_read_b128 a[172:175], v2 offset:15360
v_mfma_f32_16x16x32_bf16 v[144:147], a[148:151], v[76:79], v[144:147]
s_waitcnt lgkmcnt(5)
v_mfma_f32_16x16x32_bf16 v[136:139], a[152:155], v[64:67], v[136:139]
ds_read_b128 a[176:179], v2 offset:40960
v_exp_f32 v105, v105
v_mfma_f32_16x16x32_bf16 v[144:147], a[152:155], v[80:83], v[144:147]
s_waitcnt lgkmcnt(5)
v_cvt_pk_bf16_f32 v160, v104, v105
v_mfma_f32_16x16x32_bf16 v[136:139], a[156:159], v[68:71], v[136:139]
ds_read_b128 a[180:183], v2 offset:41984
v_mfma_f32_16x16x32_bf16 v[144:147], a[156:159], v[84:87], v[144:147]
s_waitcnt lgkmcnt(5)
v_exp_f32 v106, v106
v_mfma_f32_16x16x32_bf16 v[140:143], a[160:163], v[56:59], v[204:207]
ds_read_b128 a[184:187], v2 offset:43008
buffer_load_dwordx4 v4, s[32:35], s69 offen offset:2048 lds
v_mfma_f32_16x16x32_bf16 v[148:151], a[160:163], v[72:75], v[212:215]
s_waitcnt lgkmcnt(5)
v_mfma_f32_16x16x32_bf16 v[140:143], a[164:167], v[60:63], v[140:143]
ds_read_b128 a[188:191], v2 offset:44032
v_exp_f32 v107, v107
v_mfma_f32_16x16x32_bf16 v[148:151], a[164:167], v[76:79], v[148:151]
s_waitcnt lgkmcnt(5)
v_cvt_pk_bf16_f32 v161, v106, v107
v_mfma_f32_16x16x32_bf16 v[140:143], a[168:171], v[64:67], v[140:143]
ds_read_b128 a[192:195], v2 offset:45056
v_mfma_f32_16x16x32_bf16 v[148:151], a[168:171], v[80:83], v[148:151]
s_waitcnt lgkmcnt(5)
v_mfma_f32_16x16x32_bf16 v[140:143], a[172:175], v[68:71], v[140:143]
ds_read_b128 a[196:199], v2 offset:46080
v_exp_f32 v108, v108
v_mfma_f32_16x16x32_bf16 v[148:151], a[172:175], v[84:87], v[148:151]
s_waitcnt lgkmcnt(5)
v_mfma_f32_16x16x32_bf16 a[0:3], a[176:179], v[168:171], a[0:3]
ds_read_b128 a[200:203], v2 offset:47104
buffer_load_dwordx4 v4, s[32:35], s69 offen offset:3072 lds
v_mfma_f32_16x16x32_bf16 a[32:35], a[176:179], v[172:175], a[32:35]
v_exp_f32 v109, v109
v_mfma_f32_16x16x32_bf16 a[64:67], a[176:179], v[176:179], a[64:67]
v_cvt_pk_bf16_f32 v162, v108, v109
v_mfma_f32_16x16x32_bf16 a[96:99], a[176:179], v[180:183], a[96:99]
s_waitcnt lgkmcnt(5)
v_mfma_f32_16x16x32_bf16 a[4:7], a[180:183], v[168:171], a[4:7]
ds_read_b128 a[204:207], v2 offset:48128
v_exp_f32 v110, v110
v_mfma_f32_16x16x32_bf16 a[36:39], a[180:183], v[172:175], a[36:39]
v_mfma_f32_16x16x32_bf16 a[68:71], a[180:183], v[176:179], a[68:71]
v_mfma_f32_16x16x32_bf16 a[100:103], a[180:183], v[180:183], a[100:103]
s_waitcnt lgkmcnt(5)
v_exp_f32 v111, v111
v_mfma_f32_16x16x32_bf16 a[8:11], a[184:187], v[168:171], a[8:11]
s_waitcnt vmcnt(8)
s_barrier
s_xor_b32 s65, s65, 16384
s_add_u32 s64, s64, 32768
s_mov_b32 m0, s65
ds_read_b128 a[144:147], v2 offset:16384
v_cvt_pk_bf16_f32 v163, v110, v111
v_mfma_f32_16x16x32_bf16 a[40:43], a[184:187], v[172:175], a[40:43]
v_mfma_f32_16x16x32_bf16 a[72:75], a[184:187], v[176:179], a[72:75]
v_exp_f32 v112, v112
v_mfma_f32_16x16x32_bf16 a[104:107], a[184:187], v[180:183], a[104:107]
s_waitcnt lgkmcnt(5)
v_mfma_f32_16x16x32_bf16 a[12:15], a[188:191], v[168:171], a[12:15]
ds_read_b128 a[148:151], v2 offset:17408
v_mfma_f32_16x16x32_bf16 a[44:47], a[188:191], v[172:175], a[44:47]
v_exp_f32 v113, v113
v_mfma_f32_16x16x32_bf16 a[76:79], a[188:191], v[176:179], a[76:79]
v_cvt_pk_bf16_f32 v164, v112, v113
v_mfma_f32_16x16x32_bf16 a[108:111], a[188:191], v[180:183], a[108:111]
s_waitcnt lgkmcnt(5)
v_mfma_f32_16x16x32_bf16 a[16:19], a[192:195], v[168:171], a[16:19]
ds_read_b128 a[152:155], v2 offset:18432
v_exp_f32 v114, v114
v_mfma_f32_16x16x32_bf16 a[48:51], a[192:195], v[172:175], a[48:51]
buffer_load_dwordx4 v4, s[32:35], s64 offen offset:0 lds
v_mfma_f32_16x16x32_bf16 a[80:83], a[192:195], v[176:179], a[80:83]
v_mfma_f32_16x16x32_bf16 a[112:115], a[192:195], v[180:183], a[112:115]
s_waitcnt lgkmcnt(5)
v_exp_f32 v115, v115
v_mfma_f32_16x16x32_bf16 a[20:23], a[196:199], v[168:171], a[20:23]
ds_read_b128 a[156:159], v2 offset:19456
v_cvt_pk_bf16_f32 v165, v114, v115
v_mfma_f32_16x16x32_bf16 a[52:55], a[196:199], v[172:175], a[52:55]
v_mfma_f32_16x16x32_bf16 a[84:87], a[196:199], v[176:179], a[84:87]
v_mfma_f32_16x16x32_bf16 a[116:119], a[196:199], v[180:183], a[116:119]
s_waitcnt lgkmcnt(5)
v_exp_f32 v116, v116
v_mfma_f32_16x16x32_bf16 a[24:27], a[200:203], v[168:171], a[24:27]
ds_read_b128 a[160:163], v2 offset:20480
v_mfma_f32_16x16x32_bf16 a[56:59], a[200:203], v[172:175], a[56:59]
v_mfma_f32_16x16x32_bf16 a[88:91], a[200:203], v[176:179], a[88:91]
buffer_load_dwordx4 v4, s[32:35], s64 offen offset:1024 lds
v_exp_f32 v117, v117
v_mfma_f32_16x16x32_bf16 a[120:123], a[200:203], v[180:183], a[120:123]
s_waitcnt lgkmcnt(5)
v_cvt_pk_bf16_f32 v166, v116, v117
v_mfma_f32_16x16x32_bf16 a[28:31], a[204:207], v[168:171], a[28:31]
ds_read_b128 a[164:167], v2 offset:21504
v_mfma_f32_16x16x32_bf16 a[60:63], a[204:207], v[172:175], a[60:63]
v_exp_f32 v118, v118
v_mfma_f32_16x16x32_bf16 a[92:95], a[204:207], v[176:179], a[92:95]
v_mfma_f32_16x16x32_bf16 a[124:127], a[204:207], v[180:183], a[124:127]
v_mfma_f32_16x16x32_bf16 a[128:131], v[16:19], v[168:171], a[128:131]
v_exp_f32 v119, v119
v_mfma_f32_16x16x32_bf16 a[132:135], v[16:19], v[172:175], a[132:135]
v_cvt_pk_bf16_f32 v167, v118, v119
v_mfma_f32_16x16x32_bf16 a[136:139], v[16:19], v[176:179], a[136:139]
s_cmp_le_u32 s66, 1
s_cbranch_scc1 L_st_34
L_bk_35:
s_sub_u32 s66, s66, 1
v_mfma_f32_16x16x32_bf16 a[140:143], v[16:19], v[180:183], a[140:143]
s_waitcnt lgkmcnt(5)
v_mfma_f32_16x16x32_bf16 v[104:107], a[144:147], v[56:59], v[200:203]
ds_read_b128 a[168:171], v2 offset:22528
v_mfma_f32_16x16x32_bf16 v[112:115], a[144:147], v[72:75], v[208:211]
s_waitcnt lgkmcnt(5)
v_exp_f32 v136, v136
v_mfma_f32_16x16x32_bf16 v[104:107], a[148:151], v[60:63], v[104:107]
ds_read_b128 a[172:175], v2 offset:23552
ds_read_b128 a[176:179], v2 offset:49152
v_mfma_f32_16x16x32_bf16 v[112:115], a[148:151], v[76:79], v[112:115]
s_waitcnt lgkmcnt(6)
v_exp_f32 v137, v137
v_mfma_f32_16x16x32_bf16 v[104:107], a[152:155], v[64:67], v[104:107]
ds_read_b128 a[180:183], v2 offset:50176
v_cvt_pk_bf16_f32 v176, v136, v137
v_mfma_f32_16x16x32_bf16 v[112:115], a[152:155], v[80:83], v[112:115]
s_waitcnt lgkmcnt(6)
v_exp_f32 v138, v138
v_mfma_f32_16x16x32_bf16 v[104:107], a[156:159], v[68:71], v[104:107]
buffer_load_dwordx4 v4, s[32:35], s64 offen offset:2048 lds
v_mfma_f32_16x16x32_bf16 v[112:115], a[156:159], v[84:87], v[112:115]
s_waitcnt lgkmcnt(5)
v_exp_f32 v139, v139
v_mfma_f32_16x16x32_bf16 v[108:111], a[160:163], v[56:59], v[204:207]
ds_read_b128 a[184:187], v2 offset:51200
v_cvt_pk_bf16_f32 v177, v138, v139
v_mfma_f32_16x16x32_bf16 v[116:119], a[160:163], v[72:75], v[212:215]
s_waitcnt lgkmcnt(5)
v_exp_f32 v140, v140
v_mfma_f32_16x16x32_bf16 v[108:111], a[164:167], v[60:63], v[108:111]
ds_read_b128 a[188:191], v2 offset:52224
v_mfma_f32_16x16x32_bf16 v[116:119], a[164:167], v[76:79], v[116:119]
s_waitcnt lgkmcnt(5)
v_exp_f32 v141, v141
v_mfma_f32_16x16x32_bf16 v[108:111], a[168:171], v[64:67], v[108:111]
ds_read_b128 a[192:195], v2 offset:53248
v_cvt_pk_bf16_f32 v178, v140, v141
v_mfma_f32_16x16x32_bf16 v[116:119], a[168:171], v[80:83], v[116:119]
s_waitcnt lgkmcnt(5)
v_exp_f32 v142, v142
v_mfma_f32_16x16x32_bf16 v[108:111], a[172:175], v[68:71], v[108:111]
buffer_load_dwordx4 v4, s[32:35], s64 offen offset:3072 lds
v_mfma_f32_16x16x32_bf16 v[116:119], a[172:175], v[84:87], v[116:119]
s_waitcnt lgkmcnt(4)
v_exp_f32 v143, v143
v_mfma_f32_16x16x32_bf16 a[64:67], a[176:179], v[160:163], a[64:67]
ds_read_b128 a[196:199], v2 offset:54272
v_cvt_pk_bf16_f32 v179, v142, v143
v_mfma_f32_16x16x32_bf16 a[96:99], a[176:179], v[164:167], a[96:99]
s_waitcnt lgkmcnt(4)
v_exp_f32 v144, v144
v_mfma_f32_16x16x32_bf16 a[68:71], a[180:183], v[160:163], a[68:71]
ds_read_b128 a[200:203], v2 offset:55296
ds_read_b128 a[204:207], v2 offset:56320
v_mfma_f32_16x16x32_bf16 a[100:103], a[180:183], v[164:167], a[100:103]
s_waitcnt lgkmcnt(5)
v_exp_f32 v145, v145
v_mfma_f32_16x16x32_bf16 a[72:75], a[184:187], v[160:163], a[72:75]
s_add_u32 m0, s65, 4096
s_add_u32 s69, s64, 4096
ds_read_b128 a[144:147], v2 offset:24576
v_cvt_pk_bf16_f32 v180, v144, v145
v_mfma_f32_16x16x32_bf16 a[104:107], a[184:187], v[164:167], a[104:107]
s_waitcnt lgkmcnt(5)
v_exp_f32 v146, v146
v_mfma_f32_16x16x32_bf16 a[76:79], a[188:191], v[160:163], a[76:79]
buffer_load_dwordx4 v4, s[32:35], s69 offen offset:0 lds
v_mfma_f32_16x16x32_bf16 a[108:111], a[188:191], v[164:167], a[108:111]
s_waitcnt lgkmcnt(4)
v_exp_f32 v147, v147
v_mfma_f32_16x16x32_bf16 a[80:83], a[192:195], v[160:163], a[80:83]
ds_read_b128 a[148:151], v2 offset:25600
v_cvt_pk_bf16_f32 v181, v146, v147
v_mfma_f32_16x16x32_bf16 a[112:115], a[192:195], v[164:167], a[112:115]
s_waitcnt lgkmcnt(4)
v_exp_f32 v148, v148
v_mfma_f32_16x16x32_bf16 a[84:87], a[196:199], v[160:163], a[84:87]
s_cmp_le_u32 s66, 1
s_cbranch_scc1 L_st_36
L_bk_37:
s_sub_u32 s66, s66, 1
ds_read_b128 a[152:155], v2 offset:26624
v_mfma_f32_16x16x32_bf16 a[116:119], a[196:199], v[164:167], a[116:119]
s_waitcnt lgkmcnt(4)
v_exp_f32 v149, v149
v_mfma_f32_16x16x32_bf16 a[88:91], a[200:203], v[160:163], a[88:91]
ds_read_b128 a[156:159], v2 offset:27648
v_cvt_pk_bf16_f32 v182, v148, v149
v_mfma_f32_16x16x32_bf16 a[120:123], a[200:203], v[164:167], a[120:123]
s_waitcnt lgkmcnt(4)
v_exp_f32 v150, v150
v_mfma_f32_16x16x32_bf16 a[92:95], a[204:207], v[160:163], a[92:95]
buffer_load_dwordx4 v4, s[32:35], s69 offen offset:1024 lds
v_mfma_f32_16x16x32_bf16 a[124:127], a[204:207], v[164:167], a[124:127]
v_exp_f32 v151, v151
v_mfma_f32_16x16x32_bf16 a[136:139], v[16:19], v[160:163], a[136:139]
ds_read_b128 a[160:163], v2 offset:28672
v_cvt_pk_bf16_f32 v183, v150, v151
v_mfma_f32_16x16x32_bf16 a[140:143], v[16:19], v[164:167], a[140:143]
s_waitcnt lgkmcnt(4)
ds_read_b128 a[164:167], v2 offset:29696
v_mfma_f32_16x16x32_bf16 v[136:139], a[144:147], v[56:59], v[200:203]
ds_read_b128 a[168:171], v2 offset:30720
v_mfma_f32_16x16x32_bf16 v[144:147], a[144:147], v[72:75], v[208:211]
s_waitcnt lgkmcnt(5)
v_exp_f32 v104, v104
v_mfma_f32_16x16x32_bf16 v[136:139], a[148:151], v[60:63], v[136:139]
ds_read_b128 a[172:175], v2 offset:31744
ds_read_b128 a[176:179], v2 offset:57344
v_mfma_f32_16x16x32_bf16 v[144:147], a[148:151], v[76:79], v[144:147]
s_waitcnt lgkmcnt(6)
v_exp_f32 v105, v105
v_mfma_f32_16x16x32_bf16 v[136:139], a[152:155], v[64:67], v[136:139]
ds_read_b128 a[180:183], v2 offset:58368
v_cvt_pk_bf16_f32 v160, v104, v105
v_mfma_f32_16x16x32_bf16 v[144:147], a[152:155], v[80:83], v[144:147]
s_waitcnt lgkmcnt(6)
v_exp_f32 v106, v106
v_mfma_f32_16x16x32_bf16 v[136:139], a[156:159], v[68:71], v[136:139]
buffer_load_dwordx4 v4, s[32:35], s69 offen offset:2048 lds
v_mfma_f32_16x16x32_bf16 v[144:147], a[156:159], v[84:87], v[144:147]
s_waitcnt lgkmcnt(5)
v_exp_f32 v107, v107
v_mfma_f32_16x16x32_bf16 v[140:143], a[160:163], v[56:59], v[204:207]
ds_read_b128 a[184:187], v2 offset:59392
v_cvt_pk_bf16_f32 v161, v106, v107
v_mfma_f32_16x16x32_bf16 v[148:151], a[160:163], v[72:75], v[212:215]
s_waitcnt lgkmcnt(5)
v_exp_f32 v108, v108
v_mfma_f32_16x16x32_bf16 v[140:143], a[164:167], v[60:63], v[140:143]
ds_read_b128 a[188:191], v2 offset:60416
v_mfma_f32_16x16x32_bf16 v[148:151], a[164:167], v[76:79], v[148:151]
s_waitcnt lgkmcnt(5)
v_exp_f32 v109, v109
v_mfma_f32_16x16x32_bf16 v[140:143], a[168:171], v[64:67], v[140:143]
ds_read_b128 a[192:195], v2 offset:61440
v_cvt_pk_bf16_f32 v162, v108, v109
v_mfma_f32_16x16x32_bf16 v[148:151], a[168:171], v[80:83], v[148:151]
s_waitcnt lgkmcnt(5)
v_exp_f32 v110, v110
v_mfma_f32_16x16x32_bf16 v[140:143], a[172:175], v[68:71], v[140:143]
buffer_load_dwordx4 v4, s[32:35], s69 offen offset:3072 lds
v_mfma_f32_16x16x32_bf16 v[148:151], a[172:175], v[84:87], v[148:151]
s_waitcnt lgkmcnt(4)
v_exp_f32 v111, v111
v_mfma_f32_16x16x32_bf16 a[64:67], a[176:179], v[176:179], a[64:67]
ds_read_b128 a[196:199], v2 offset:62464
v_cvt_pk_bf16_f32 v163, v110, v111
v_mfma_f32_16x16x32_bf16 a[96:99], a[176:179], v[180:183], a[96:99]
s_waitcnt lgkmcnt(4)
v_exp_f32 v112, v112
v_mfma_f32_16x16x32_bf16 a[68:71], a[180:183], v[176:179], a[68:71]
ds_read_b128 a[200:203], v2 offset:63488
ds_read_b128 a[204:207], v2 offset:64512
v_mfma_f32_16x16x32_bf16 a[100:103], a[180:183], v[180:183], a[100:103]
s_waitcnt lgkmcnt(5)
v_exp_f32 v113, v113
v_mfma_f32_16x16x32_bf16 a[72:75], a[184:187], v[176:179], a[72:75]
v_xor_b32 v2, 0x10000, v2
s_waitcnt vmcnt(8)
s_barrier
s_xor_b32 s65, s65, 81920
s_add_u32 s64, s64, 32768
s_mov_b32 m0, s65
ds_read_b128 a[144:147], v2 offset:0
v_cvt_pk_bf16_f32 v164, v112, v113
v_mfma_f32_16x16x32_bf16 a[104:107], a[184:187], v[180:183], a[104:107]
s_waitcnt lgkmcnt(5)
v_exp_f32 v114, v114
v_mfma_f32_16x16x32_bf16 a[76:79], a[188:191], v[176:179], a[76:79]
buffer_load_dwordx4 v4, s[32:35], s64 offen offset:0 lds
v_mfma_f32_16x16x32_bf16 a[108:111], a[188:191], v[180:183], a[108:111]
s_waitcnt lgkmcnt(4)
v_exp_f32 v115, v115
v_mfma_f32_16x16x32_bf16 a[80:83], a[192:195], v[176:179], a[80:83]
ds_read_b128 a[148:151], v2 offset:1024
v_cvt_pk_bf16_f32 v165, v114, v115
v_mfma_f32_16x16x32_bf16 a[112:115], a[192:195], v[180:183], a[112:115]
s_waitcnt lgkmcnt(4)
v_exp_f32 v116, v116
v_mfma_f32_16x16x32_bf16 a[84:87], a[196:199], v[176:179], a[84:87]
s_cmp_le_u32 s66, 1
s_cbranch_scc1 L_st_38
L_bk_39:
s_sub_u32 s66, s66, 1
ds_read_b128 a[152:155], v2 offset:2048
v_mfma_f32_16x16x32_bf16 a[116:119], a[196:199], v[180:183], a[116:119]
s_waitcnt lgkmcnt(4)
v_exp_f32 v117, v117
v_mfma_f32_16x16x32_bf16 a[88:91], a[200:203], v[176:179], a[88:91]
ds_read_b128 a[156:159], v2 offset:3072
v_cvt_pk_bf16_f32 v166, v116, v117
v_mfma_f32_16x16x32_bf16 a[120:123], a[200:203], v[180:183], a[120:123]
s_waitcnt lgkmcnt(4)
v_exp_f32 v118, v118
v_mfma_f32_16x16x32_bf16 a[92:95], a[204:207], v[176:179], a[92:95]
buffer_load_dwordx4 v4, s[32:35], s64 offen offset:1024 lds
v_mfma_f32_16x16x32_bf16 a[124:127], a[204:207], v[180:183], a[124:127]
v_exp_f32 v119, v119
v_mfma_f32_16x16x32_bf16 a[136:139], v[16:19], v[176:179], a[136:139]
ds_read_b128 a[160:163], v2 offset:4096
v_cvt_pk_bf16_f32 v167, v118, v119
v_mfma_f32_16x16x32_bf16 a[140:143], v[16:19], v[180:183], a[140:143]
ds_read_b128 a[164:167], v2 offset:5120
s_cmp_eq_u32 s67, 0
s_cbranch_scc1 L_tail_21
.p2align 3
L_single_20:
s_waitcnt lgkmcnt(5)
v_mfma_f32_16x16x32_bf16 v[104:107], a[144:147], v[56:59], v[200:203]
ds_read_b128 a[168:171], v2 offset:6144
v_mfma_f32_16x16x32_bf16 v[112:115], a[144:147], v[72:75], v[208:211]
s_waitcnt lgkmcnt(5)
v_exp_f32 v136, v136
v_mfma_f32_16x16x32_bf16 v[104:107], a[148:151], v[60:63], v[104:107]
ds_read_b128 a[172:175], v2 offset:7168
ds_read_b128 a[176:179], v2 offset:32768
v_mfma_f32_16x16x32_bf16 v[112:115], a[148:151], v[76:79], v[112:115]
s_waitcnt lgkmcnt(6)
v_exp_f32 v137, v137
v_mfma_f32_16x16x32_bf16 v[104:107], a[152:155], v[64:67], v[104:107]
ds_read_b128 a[180:183], v2 offset:33792
v_cvt_pk_bf16_f32 v176, v136, v137
v_mfma_f32_16x16x32_bf16 v[112:115], a[152:155], v[80:83], v[112:115]
s_waitcnt lgkmcnt(6)
v_exp_f32 v138, v138
v_mfma_f32_16x16x32_bf16 v[104:107], a[156:159], v[68:71], v[104:107]
buffer_load_dwordx4 v4, s[32:35], s64 offen offset:2048 lds
v_mfma_f32_16x16x32_bf16 v[112:115], a[156:159], v[84:87], v[112:115]
s_waitcnt lgkmcnt(5)
v_exp_f32 v139, v139
v_mfma_f32_16x16x32_bf16 v[108:111], a[160:163], v[56:59], v[204:207]
ds_read_b128 a[184:187], v2 offset:34816
v_cvt_pk_bf16_f32 v177, v138, v139
v_mfma_f32_16x16x32_bf16 v[116:119], a[160:163], v[72:75], v[212:215]
s_waitcnt lgkmcnt(5)
v_exp_f32 v140, v140
v_mfma_f32_16x16x32_bf16 v[108:111], a[164:167], v[60:63], v[108:111]
ds_read_b128 a[188:191], v2 offset:35840
v_mfma_f32_16x16x32_bf16 v[116:119], a[164:167], v[76:79], v[116:119]
s_waitcnt lgkmcnt(5)
v_exp_f32 v141, v141
v_mfma_f32_16x16x32_bf16 v[108:111], a[168:171], v[64:67], v[108:111]
ds_read_b128 a[192:195], v2 offset:36864
v_cvt_pk_bf16_f32 v178, v140, v141
v_mfma_f32_16x16x32_bf16 v[116:119], a[168:171], v[80:83], v[116:119]
s_waitcnt lgkmcnt(5)
v_exp_f32 v142, v142
v_mfma_f32_16x16x32_bf16 v[108:111], a[172:175], v[68:71], v[108:111]
buffer_load_dwordx4 v4, s[32:35], s64 offen offset:3072 lds
v_mfma_f32_16x16x32_bf16 v[116:119], a[172:175], v[84:87], v[116:119]
s_waitcnt lgkmcnt(4)
v_exp_f32 v143, v143
v_mfma_f32_16x16x32_bf16 a[64:67], a[176:179], v[160:163], a[64:67]
ds_read_b128 a[196:199], v2 offset:37888
v_cvt_pk_bf16_f32 v179, v142, v143
v_mfma_f32_16x16x32_bf16 a[96:99], a[176:179], v[164:167], a[96:99]
s_waitcnt lgkmcnt(4)
v_exp_f32 v144, v144
v_mfma_f32_16x16x32_bf16 a[68:71], a[180:183], v[160:163], a[68:71]
ds_read_b128 a[200:203], v2 offset:38912
ds_read_b128 a[204:207], v2 offset:39936
v_mfma_f32_16x16x32_bf16 a[100:103], a[180:183], v[164:167], a[100:103]
s_waitcnt lgkmcnt(5)
v_exp_f32 v145, v145
v_mfma_f32_16x16x32_bf16 a[72:75], a[184:187], v[160:163], a[72:75]
s_add_u32 m0, s65, 4096
s_add_u32 s69, s64, 4096
ds_read_b128 a[144:147], v2 offset:8192
v_cvt_pk_bf16_f32 v180, v144, v145
v_mfma_f32_16x16x32_bf16 a[104:107], a[184:187], v[164:167], a[104:107]
s_waitcnt lgkmcnt(5)
v_exp_f32 v146, v146
v_mfma_f32_16x16x32_bf16 a[76:79], a[188:191], v[160:163], a[76:79]
buffer_load_dwordx4 v4, s[32:35], s69 offen offset:0 lds
v_mfma_f32_16x16x32_bf16 a[108:111], a[188:191], v[164:167], a[108:111]
s_waitcnt lgkmcnt(4)
v_exp_f32 v147, v147
v_mfma_f32_16x16x32_bf16 a[80:83], a[192:195], v[160:163], a[80:83]
ds_read_b128 a[148:151], v2 offset:9216
v_cvt_pk_bf16_f32 v181, v146, v147
v_mfma_f32_16x16x32_bf16 a[112:115], a[192:195], v[164:167], a[112:115]
s_waitcnt lgkmcnt(4)
v_exp_f32 v148, v148
v_mfma_f32_16x16x32_bf16 a[84:87], a[196:199], v[160:163], a[84:87]
s_cmp_le_u32 s66, 1
s_cbranch_scc1 L_st_40
L_bk_41:
s_sub_u32 s66, s66, 1
ds_read_b128 a[152:155], v2 offset:10240
v_mfma_f32_16x16x32_bf16 a[116:119], a[196:199], v[164:167], a[116:119]
s_waitcnt lgkmcnt(4)
v_exp_f32 v149, v149
v_mfma_f32_16x16x32_bf16 a[88:91], a[200:203], v[160:163], a[88:91]
ds_read_b128 a[156:159], v2 offset:11264
v_cvt_pk_bf16_f32 v182, v148, v149
v_mfma_f32_16x16x32_bf16 a[120:123], a[200:203], v[164:167], a[120:123]
s_waitcnt lgkmcnt(4)
v_exp_f32 v150, v150
v_mfma_f32_16x16x32_bf16 a[92:95], a[204:207], v[160:163], a[92:95]
buffer_load_dwordx4 v4, s[32:35], s69 offen offset:1024 lds
v_mfma_f32_16x16x32_bf16 a[124:127], a[204:207], v[164:167], a[124:127]
v_exp_f32 v151, v151
v_mfma_f32_16x16x32_bf16 a[136:139], v[16:19], v[160:163], a[136:139]
ds_read_b128 a[160:163], v2 offset:12288
v_cvt_pk_bf16_f32 v183, v150, v151
v_mfma_f32_16x16x32_bf16 a[140:143], v[16:19], v[164:167], a[140:143]
s_waitcnt lgkmcnt(4)
ds_read_b128 a[164:167], v2 offset:13312
v_mfma_f32_16x16x32_bf16 v[136:139], a[144:147], v[56:59], v[200:203]
ds_read_b128 a[168:171], v2 offset:14336
v_mfma_f32_16x16x32_bf16 v[144:147], a[144:147], v[72:75], v[208:211]
s_waitcnt lgkmcnt(5)
v_exp_f32 v104, v104
v_mfma_f32_16x16x32_bf16 v[136:139], a[148:151], v[60:63], v[136:139]
ds_read_b128 a[172:175], v2 offset:15360
ds_read_b128 a[176:179], v2 offset:40960
v_mfma_f32_16x16x32_bf16 v[144:147], a[148:151], v[76:79], v[144:147]
s_waitcnt lgkmcnt(6)
v_exp_f32 v105, v105
v_mfma_f32_16x16x32_bf16 v[136:139], a[152:155], v[64:67], v[136:139]
ds_read_b128 a[180:183], v2 offset:41984
v_cvt_pk_bf16_f32 v160, v104, v105
v_mfma_f32_16x16x32_bf16 v[144:147], a[152:155], v[80:83], v[144:147]
s_waitcnt lgkmcnt(6)
v_exp_f32 v106, v106
v_mfma_f32_16x16x32_bf16 v[136:139], a[156:159], v[68:71], v[136:139]
buffer_load_dwordx4 v4, s[32:35], s69 offen offset:2048 lds
v_mfma_f32_16x16x32_bf16 v[144:147], a[156:159], v[84:87], v[144:147]
s_waitcnt lgkmcnt(5)
v_exp_f32 v107, v107
v_mfma_f32_16x16x32_bf16 v[140:143], a[160:163], v[56:59], v[204:207]
ds_read_b128 a[184:187], v2 offset:43008
v_cvt_pk_bf16_f32 v161, v106, v107
v_mfma_f32_16x16x32_bf16 v[148:151], a[160:163], v[72:75], v[212:215]
s_waitcnt lgkmcnt(5)
v_exp_f32 v108, v108
v_mfma_f32_16x16x32_bf16 v[140:143], a[164:167], v[60:63], v[140:143]
ds_read_b128 a[188:191], v2 offset:44032
v_mfma_f32_16x16x32_bf16 v[148:151], a[164:167], v[76:79], v[148:151]
s_waitcnt lgkmcnt(5)
v_exp_f32 v109, v109
v_mfma_f32_16x16x32_bf16 v[140:143], a[168:171], v[64:67], v[140:143]
ds_read_b128 a[192:195], v2 offset:45056
v_cvt_pk_bf16_f32 v162, v108, v109
v_mfma_f32_16x16x32_bf16 v[148:151], a[168:171], v[80:83], v[148:151]
s_waitcnt lgkmcnt(5)
v_exp_f32 v110, v110
v_mfma_f32_16x16x32_bf16 v[140:143], a[172:175], v[68:71], v[140:143]
buffer_load_dwordx4 v4, s[32:35], s69 offen offset:3072 lds
v_mfma_f32_16x16x32_bf16 v[148:151], a[172:175], v[84:87], v[148:151]
s_waitcnt lgkmcnt(4)
v_exp_f32 v111, v111
v_mfma_f32_16x16x32_bf16 a[64:67], a[176:179], v[176:179], a[64:67]
ds_read_b128 a[196:199], v2 offset:46080
v_cvt_pk_bf16_f32 v163, v110, v111
v_mfma_f32_16x16x32_bf16 a[96:99], a[176:179], v[180:183], a[96:99]
s_waitcnt lgkmcnt(4)
v_exp_f32 v112, v112
v_mfma_f32_16x16x32_bf16 a[68:71], a[180:183], v[176:179], a[68:71]
ds_read_b128 a[200:203], v2 offset:47104
ds_read_b128 a[204:207], v2 offset:48128
v_mfma_f32_16x16x32_bf16 a[100:103], a[180:183], v[180:183], a[100:103]
s_waitcnt lgkmcnt(5)
v_exp_f32 v113, v113
v_mfma_f32_16x16x32_bf16 a[72:75], a[184:187], v[176:179], a[72:75]
s_waitcnt vmcnt(8)
s_barrier
s_xor_b32 s65, s65, 16384
s_add_u32 s64, s64, 32768
s_mov_b32 m0, s65
ds_read_b128 a[144:147], v2 offset:16384
v_cvt_pk_bf16_f32 v164, v112, v113
v_mfma_f32_16x16x32_bf16 a[104:107], a[184:187], v[180:183], a[104:107]
s_waitcnt lgkmcnt(5)
v_exp_f32 v114, v114
v_mfma_f32_16x16x32_bf16 a[76:79], a[188:191], v[176:179], a[76:79]
buffer_load_dwordx4 v4, s[32:35], s64 offen offset:0 lds
v_mfma_f32_16x16x32_bf16 a[108:111], a[188:191], v[180:183], a[108:111]
s_waitcnt lgkmcnt(4)
v_exp_f32 v115, v115
v_mfma_f32_16x16x32_bf16 a[80:83], a[192:195], v[176:179], a[80:83]
ds_read_b128 a[148:151], v2 offset:17408
v_cvt_pk_bf16_f32 v165, v114, v115
v_mfma_f32_16x16x32_bf16 a[112:115], a[192:195], v[180:183], a[112:115]
s_waitcnt lgkmcnt(4)
v_exp_f32 v116, v116
v_mfma_f32_16x16x32_bf16 a[84:87], a[196:199], v[176:179], a[84:87]
s_cmp_le_u32 s66, 1
s_cbranch_scc1 L_st_42
L_bk_43:
s_sub_u32 s66, s66, 1
ds_read_b128 a[152:155], v2 offset:18432
v_mfma_f32_16x16x32_bf16 a[116:119], a[196:199], v[180:183], a[116:119]
s_waitcnt lgkmcnt(4)
v_exp_f32 v117, v117
v_mfma_f32_16x16x32_bf16 a[88:91], a[200:203], v[176:179], a[88:91]
ds_read_b128 a[156:159], v2 offset:19456
v_cvt_pk_bf16_f32 v166, v116, v117
v_mfma_f32_16x16x32_bf16 a[120:123], a[200:203], v[180:183], a[120:123]
s_waitcnt lgkmcnt(4)
v_exp_f32 v118, v118
v_mfma_f32_16x16x32_bf16 a[92:95], a[204:207], v[176:179], a[92:95]
buffer_load_dwordx4 v4, s[32:35], s64 offen offset:1024 lds
v_mfma_f32_16x16x32_bf16 a[124:127], a[204:207], v[180:183], a[124:127]
v_exp_f32 v119, v119
v_mfma_f32_16x16x32_bf16 a[136:139], v[16:19], v[176:179], a[136:139]
ds_read_b128 a[160:163], v2 offset:20480
v_cvt_pk_bf16_f32 v167, v118, v119
v_mfma_f32_16x16x32_bf16 a[140:143], v[16:19], v[180:183], a[140:143]
s_waitcnt lgkmcnt(4)
ds_read_b128 a[164:167], v2 offset:21504
v_mfma_f32_16x16x32_bf16 v[104:107], a[144:147], v[56:59], v[200:203]
ds_read_b128 a[168:171], v2 offset:22528
v_mfma_f32_16x16x32_bf16 v[112:115], a[144:147], v[72:75], v[208:211]
s_waitcnt lgkmcnt(5)
v_exp_f32 v136, v136
v_mfma_f32_16x16x32_bf16 v[104:107], a[148:151], v[60:63], v[104:107]
ds_read_b128 a[172:175], v2 offset:23552
ds_read_b128 a[176:179], v2 offset:49152
v_mfma_f32_16x16x32_bf16 v[112:115], a[148:151], v[76:79], v[112:115]
s_waitcnt lgkmcnt(6)
v_exp_f32 v137, v137
v_mfma_f32_16x16x32_bf16 v[104:107], a[152:155], v[64:67], v[104:107]
ds_read_b128 a[180:183], v2 offset:50176
v_cvt_pk_bf16_f32 v176, v136, v137
v_mfma_f32_16x16x32_bf16 v[112:115], a[152:155], v[80:83], v[112:115]
s_waitcnt lgkmcnt(6)
v_exp_f32 v138, v138
v_mfma_f32_16x16x32_bf16 v[104:107], a[156:159], v[68:71], v[104:107]
buffer_load_dwordx4 v4, s[32:35], s64 offen offset:2048 lds
v_mfma_f32_16x16x32_bf16 v[112:115], a[156:159], v[84:87], v[112:115]
s_waitcnt lgkmcnt(5)
v_exp_f32 v139, v139
v_mfma_f32_16x16x32_bf16 v[108:111], a[160:163], v[56:59], v[204:207]
ds_read_b128 a[184:187], v2 offset:51200
v_cvt_pk_bf16_f32 v177, v138, v139
v_mfma_f32_16x16x32_bf16 v[116:119], a[160:163], v[72:75], v[212:215]
s_waitcnt lgkmcnt(5)
v_exp_f32 v140, v140
v_mfma_f32_16x16x32_bf16 v[108:111], a[164:167], v[60:63], v[108:111]
ds_read_b128 a[188:191], v2 offset:52224
v_mfma_f32_16x16x32_bf16 v[116:119], a[164:167], v[76:79], v[116:119]
s_waitcnt lgkmcnt(5)
v_exp_f32 v141, v141
v_mfma_f32_16x16x32_bf16 v[108:111], a[168:171], v[64:67], v[108:111]
ds_read_b128 a[192:195], v2 offset:53248
v_cvt_pk_bf16_f32 v178, v140, v141
v_mfma_f32_16x16x32_bf16 v[116:119], a[168:171], v[80:83], v[116:119]
s_waitcnt lgkmcnt(5)
v_exp_f32 v142, v142
v_mfma_f32_16x16x32_bf16 v[108:111], a[172:175], v[68:71], v[108:111]
buffer_load_dwordx4 v4, s[32:35], s64 offen offset:3072 lds
v_mfma_f32_16x16x32_bf16 v[116:119], a[172:175], v[84:87], v[116:119]
s_waitcnt lgkmcnt(4)
v_exp_f32 v143, v143
v_mfma_f32_16x16x32_bf16 a[64:67], a[176:179], v[160:163], a[64:67]
ds_read_b128 a[196:199], v2 offset:54272
v_cvt_pk_bf16_f32 v179, v142, v143
v_mfma_f32_16x16x32_bf16 a[96:99], a[176:179], v[164:167], a[96:99]
s_waitcnt lgkmcnt(4)
v_exp_f32 v144, v144
v_mfma_f32_16x16x32_bf16 a[68:71], a[180:183], v[160:163], a[68:71]
ds_read_b128 a[200:203], v2 offset:55296
ds_read_b128 a[204:207], v2 offset:56320
v_mfma_f32_16x16x32_bf16 a[100:103], a[180:183], v[164:167], a[100:103]
s_waitcnt lgkmcnt(5)
v_exp_f32 v145, v145
v_mfma_f32_16x16x32_bf16 a[72:75], a[184:187], v[160:163], a[72:75]
s_add_u32 m0, s65, 4096
s_add_u32 s69, s64, 4096
ds_read_b128 a[144:147], v2 offset:24576
v_cvt_pk_bf16_f32 v180, v144, v145
v_mfma_f32_16x16x32_bf16 a[104:107], a[184:187], v[164:167], a[104:107]
s_waitcnt lgkmcnt(5)
v_exp_f32 v146, v146
v_mfma_f32_16x16x32_bf16 a[76:79], a[188:191], v[160:163], a[76:79]
buffer_load_dwordx4 v4, s[32:35], s69 offen offset:0 lds
v_mfma_f32_16x16x32_bf16 a[108:111], a[188:191], v[164:167], a[108:111]
s_waitcnt lgkmcnt(4)
v_exp_f32 v147, v147
v_mfma_f32_16x16x32_bf16 a[80:83], a[192:195], v[160:163], a[80:83]
ds_read_b128 a[148:151], v2 offset:25600
v_cvt_pk_bf16_f32 v181, v146, v147
v_mfma_f32_16x16x32_bf16 a[112:115], a[192:195], v[164:167], a[112:115]
s_waitcnt lgkmcnt(4)
v_exp_f32 v148, v148
v_mfma_f32_16x16x32_bf16 a[84:87], a[196:199], v[160:163], a[84:87]
s_cmp_le_u32 s66, 1
s_cbranch_scc1 L_st_44
L_bk_45:
s_sub_u32 s66, s66, 1
ds_read_b128 a[152:155], v2 offset:26624
v_mfma_f32_16x16x32_bf16 a[116:119], a[196:199], v[164:167], a[116:119]
s_waitcnt lgkmcnt(4)
v_exp_f32 v149, v149
v_mfma_f32_16x16x32_bf16 a[88:91], a[200:203], v[160:163], a[88:91]
ds_read_b128 a[156:159], v2 offset:27648
v_cvt_pk_bf16_f32 v182, v148, v149
v_mfma_f32_16x16x32_bf16 a[120:123], a[200:203], v[164:167], a[120:123]
s_waitcnt lgkmcnt(4)
v_exp_f32 v150, v150
v_mfma_f32_16x16x32_bf16 a[92:95], a[204:207], v[160:163], a[92:95]
buffer_load_dwordx4 v4, s[32:35], s69 offen offset:1024 lds
v_mfma_f32_16x16x32_bf16 a[124:127], a[204:207], v[164:167], a[124:127]
v_exp_f32 v151, v151
v_mfma_f32_16x16x32_bf16 a[136:139], v[16:19], v[160:163], a[136:139]
ds_read_b128 a[160:163], v2 offset:28672
v_cvt_pk_bf16_f32 v183, v150, v151
v_mfma_f32_16x16x32_bf16 a[140:143], v[16:19], v[164:167], a[140:143]
s_waitcnt lgkmcnt(4)
ds_read_b128 a[164:167], v2 offset:29696
v_mfma_f32_16x16x32_bf16 v[136:139], a[144:147], v[56:59], v[200:203]
ds_read_b128 a[168:171], v2 offset:30720
v_mfma_f32_16x16x32_bf16 v[144:147], a[144:147], v[72:75], v[208:211]
s_waitcnt lgkmcnt(5)
v_exp_f32 v104, v104
v_mfma_f32_16x16x32_bf16 v[136:139], a[148:151], v[60:63], v[136:139]
ds_read_b128 a[172:175], v2 offset:31744
ds_read_b128 a[176:179], v2 offset:57344
v_mfma_f32_16x16x32_bf16 v[144:147], a[148:151], v[76:79], v[144:147]
s_waitcnt lgkmcnt(6)
v_exp_f32 v105, v105
v_mfma_f32_16x16x32_bf16 v[136:139], a[152:155], v[64:67], v[136:139]
ds_read_b128 a[180:183], v2 offset:58368
v_cvt_pk_bf16_f32 v160, v104, v105
v_mfma_f32_16x16x32_bf16 v[144:147], a[152:155], v[80:83], v[144:147]
s_waitcnt lgkmcnt(6)
v_exp_f32 v106, v106
v_mfma_f32_16x16x32_bf16 v[136:139], a[156:159], v[68:71], v[136:139]
buffer_load_dwordx4 v4, s[32:35], s69 offen offset:2048 lds
v_mfma_f32_16x16x32_bf16 v[144:147], a[156:159], v[84:87], v[144:147]
s_waitcnt lgkmcnt(5)
v_exp_f32 v107, v107
v_mfma_f32_16x16x32_bf16 v[140:143], a[160:163], v[56:59], v[204:207]
ds_read_b128 a[184:187], v2 offset:59392
v_cvt_pk_bf16_f32 v161, v106, v107
v_mfma_f32_16x16x32_bf16 v[148:151], a[160:163], v[72:75], v[212:215]
s_waitcnt lgkmcnt(5)
v_exp_f32 v108, v108
v_mfma_f32_16x16x32_bf16 v[140:143], a[164:167], v[60:63], v[140:143]
ds_read_b128 a[188:191], v2 offset:60416
v_mfma_f32_16x16x32_bf16 v[148:151], a[164:167], v[76:79], v[148:151]
s_waitcnt lgkmcnt(5)
v_exp_f32 v109, v109
v_mfma_f32_16x16x32_bf16 v[140:143], a[168:171], v[64:67], v[140:143]
ds_read_b128 a[192:195], v2 offset:61440
v_cvt_pk_bf16_f32 v162, v108, v109
v_mfma_f32_16x16x32_bf16 v[148:151], a[168:171], v[80:83], v[148:151]
s_waitcnt lgkmcnt(5)
v_exp_f32 v110, v110
v_mfma_f32_16x16x32_bf16 v[140:143], a[172:175], v[68:71], v[140:143]
buffer_load_dwordx4 v4, s[32:35], s69 offen offset:3072 lds
v_mfma_f32_16x16x32_bf16 v[148:151], a[172:175], v[84:87], v[148:151]
s_waitcnt lgkmcnt(4)
v_exp_f32 v111, v111
v_mfma_f32_16x16x32_bf16 a[64:67], a[176:179], v[176:179], a[64:67]
ds_read_b128 a[196:199], v2 offset:62464
v_cvt_pk_bf16_f32 v163, v110, v111
v_mfma_f32_16x16x32_bf16 a[96:99], a[176:179], v[180:183], a[96:99]
s_waitcnt lgkmcnt(4)
v_exp_f32 v112, v112
v_mfma_f32_16x16x32_bf16 a[68:71], a[180:183], v[176:179], a[68:71]
ds_read_b128 a[200:203], v2 offset:63488
ds_read_b128 a[204:207], v2 offset:64512
v_mfma_f32_16x16x32_bf16 a[100:103], a[180:183], v[180:183], a[100:103]
s_waitcnt lgkmcnt(5)
v_exp_f32 v113, v113
v_mfma_f32_16x16x32_bf16 a[72:75], a[184:187], v[176:179], a[72:75]
v_xor_b32 v2, 0x10000, v2
s_waitcnt vmcnt(8)
s_barrier
s_xor_b32 s65, s65, 81920
s_add_u32 s64, s64, 32768
s_mov_b32 m0, s65
ds_read_b128 a[144:147], v2 offset:0
v_cvt_pk_bf16_f32 v164, v112, v113
v_mfma_f32_16x16x32_bf16 a[104:107], a[184:187], v[180:183], a[104:107]
s_waitcnt lgkmcnt(5)
v_exp_f32 v114, v114
v_mfma_f32_16x16x32_bf16 a[76:79], a[188:191], v[176:179], a[76:79]
buffer_load_dwordx4 v4, s[32:35], s64 offen offset:0 lds
v_mfma_f32_16x16x32_bf16 a[108:111], a[188:191], v[180:183], a[108:111]
s_waitcnt lgkmcnt(4)
v_exp_f32 v115, v115
v_mfma_f32_16x16x32_bf16 a[80:83], a[192:195], v[176:179], a[80:83]
ds_read_b128 a[148:151], v2 offset:1024
v_cvt_pk_bf16_f32 v165, v114, v115
v_mfma_f32_16x16x32_bf16 a[112:115], a[192:195], v[180:183], a[112:115]
s_waitcnt lgkmcnt(4)
v_exp_f32 v116, v116
v_mfma_f32_16x16x32_bf16 a[84:87], a[196:199], v[176:179], a[84:87]
s_cmp_le_u32 s66, 1
s_cbranch_scc1 L_st_46
L_bk_47:
s_sub_u32 s66, s66, 1
ds_read_b128 a[152:155], v2 offset:2048
v_mfma_f32_16x16x32_bf16 a[116:119], a[196:199], v[180:183], a[116:119]
s_waitcnt lgkmcnt(4)
v_exp_f32 v117, v117
v_mfma_f32_16x16x32_bf16 a[88:91], a[200:203], v[176:179], a[88:91]
ds_read_b128 a[156:159], v2 offset:3072
v_cvt_pk_bf16_f32 v166, v116, v117
v_mfma_f32_16x16x32_bf16 a[120:123], a[200:203], v[180:183], a[120:123]
s_waitcnt lgkmcnt(4)
v_exp_f32 v118, v118
v_mfma_f32_16x16x32_bf16 a[92:95], a[204:207], v[176:179], a[92:95]
buffer_load_dwordx4 v4, s[32:35], s64 offen offset:1024 lds
v_mfma_f32_16x16x32_bf16 a[124:127], a[204:207], v[180:183], a[124:127]
v_exp_f32 v119, v119
v_mfma_f32_16x16x32_bf16 a[136:139], v[16:19], v[176:179], a[136:139]
ds_read_b128 a[160:163], v2 offset:4096
v_cvt_pk_bf16_f32 v167, v118, v119
v_mfma_f32_16x16x32_bf16 a[140:143], v[16:19], v[180:183], a[140:143]
ds_read_b128 a[164:167], v2 offset:5120
s_sub_u32 s67, s67, 1
s_cmp_lg_u32 s67, 0
s_cbranch_scc1 L_single_20
L_tail_21:
s_waitcnt lgkmcnt(0)
ds_read_b128 a[176:179], v2 offset:32768
ds_read_b128 a[180:183], v2 offset:33792
ds_read_b128 a[184:187], v2 offset:34816
ds_read_b128 a[188:191], v2 offset:35840
ds_read_b128 a[192:195], v2 offset:36864
ds_read_b128 a[196:199], v2 offset:37888
ds_read_b128 a[200:203], v2 offset:38912
ds_read_b128 a[204:207], v2 offset:39936
ds_read_b128 a[144:147], v2 offset:40960
ds_read_b128 a[148:151], v2 offset:41984
ds_read_b128 a[152:155], v2 offset:43008
ds_read_b128 a[156:159], v2 offset:44032
ds_read_b128 a[160:163], v2 offset:45056
ds_read_b128 a[164:167], v2 offset:46080
ds_read_b128 a[168:171], v2 offset:47104
ds_read_b128 a[172:175], v2 offset:48128
v_exp_f32 v136, v136
s_waitcnt lgkmcnt(15)
v_mfma_f32_16x16x32_bf16 a[64:67], a[176:179], v[160:163], a[64:67]
v_exp_f32 v137, v137
v_mfma_f32_16x16x32_bf16 a[96:99], a[176:179], v[164:167], a[96:99]
s_waitcnt lgkmcnt(14)
v_exp_f32 v138, v138
v_mfma_f32_16x16x32_bf16 a[68:71], a[180:183], v[160:163], a[68:71]
v_exp_f32 v139, v139
v_mfma_f32_16x16x32_bf16 a[100:103], a[180:183], v[164:167], a[100:103]
s_waitcnt lgkmcnt(13)
v_exp_f32 v140, v140
v_mfma_f32_16x16x32_bf16 a[72:75], a[184:187], v[160:163], a[72:75]
v_cvt_pk_bf16_f32 v176, v136, v137
v_cvt_pk_bf16_f32 v177, v138, v139
v_exp_f32 v141, v141
v_mfma_f32_16x16x32_bf16 a[104:107], a[184:187], v[164:167], a[104:107]
s_waitcnt lgkmcnt(12)
v_exp_f32 v142, v142
v_mfma_f32_16x16x32_bf16 a[76:79], a[188:191], v[160:163], a[76:79]
v_exp_f32 v143, v143
v_mfma_f32_16x16x32_bf16 a[108:111], a[188:191], v[164:167], a[108:111]
s_waitcnt lgkmcnt(11)
v_exp_f32 v144, v144
v_mfma_f32_16x16x32_bf16 a[80:83], a[192:195], v[160:163], a[80:83]
v_cvt_pk_bf16_f32 v178, v140, v141
v_cvt_pk_bf16_f32 v179, v142, v143
v_exp_f32 v145, v145
v_mfma_f32_16x16x32_bf16 a[112:115], a[192:195], v[164:167], a[112:115]
s_waitcnt lgkmcnt(10)
v_exp_f32 v146, v146
v_mfma_f32_16x16x32_bf16 a[84:87], a[196:199], v[160:163], a[84:87]
v_exp_f32 v147, v147
v_mfma_f32_16x16x32_bf16 a[116:119], a[196:199], v[164:167], a[116:119]
s_waitcnt lgkmcnt(9)
v_exp_f32 v148, v148
v_mfma_f32_16x16x32_bf16 a[88:91], a[200:203], v[160:163], a[88:91]
v_cvt_pk_bf16_f32 v180, v144, v145
v_cvt_pk_bf16_f32 v181, v146, v147
v_exp_f32 v149, v149
v_mfma_f32_16x16x32_bf16 a[120:123], a[200:203], v[164:167], a[120:123]
s_waitcnt lgkmcnt(8)
v_exp_f32 v150, v150
v_mfma_f32_16x16x32_bf16 a[92:95], a[204:207], v[160:163], a[92:95]
v_exp_f32 v151, v151
v_mfma_f32_16x16x32_bf16 a[124:127], a[204:207], v[164:167], a[124:127]
v_mfma_f32_16x16x32_bf16 a[136:139], v[16:19], v[160:163], a[136:139]
v_cvt_pk_bf16_f32 v182, v148, v149
v_cvt_pk_bf16_f32 v183, v150, v151
v_mfma_f32_16x16x32_bf16 a[140:143], v[16:19], v[164:167], a[140:143]
s_nop 0
v_mfma_f32_16x16x32_bf16 a[136:139], v[16:19], v[176:179], a[136:139]
v_mfma_f32_16x16x32_bf16 a[140:143], v[16:19], v[180:183], a[140:143]
s_waitcnt lgkmcnt(7)
v_mfma_f32_16x16x32_bf16 a[64:67], a[144:147], v[176:179], a[64:67]
v_mfma_f32_16x16x32_bf16 a[96:99], a[144:147], v[180:183], a[96:99]
s_waitcnt lgkmcnt(6)
v_mfma_f32_16x16x32_bf16 a[68:71], a[148:151], v[176:179], a[68:71]
v_mfma_f32_16x16x32_bf16 a[100:103], a[148:151], v[180:183], a[100:103]
s_waitcnt lgkmcnt(5)
v_mfma_f32_16x16x32_bf16 a[72:75], a[152:155], v[176:179], a[72:75]
v_mfma_f32_16x16x32_bf16 a[104:107], a[152:155], v[180:183], a[104:107]
s_waitcnt lgkmcnt(4)
v_mfma_f32_16x16x32_bf16 a[76:79], a[156:159], v[176:179], a[76:79]
v_mfma_f32_16x16x32_bf16 a[108:111], a[156:159], v[180:183], a[108:111]
s_waitcnt lgkmcnt(3)
v_mfma_f32_16x16x32_bf16 a[80:83], a[160:163], v[176:179], a[80:83]
v_mfma_f32_16x16x32_bf16 a[112:115], a[160:163], v[180:183], a[112:115]
s_waitcnt lgkmcnt(2)
v_mfma_f32_16x16x32_bf16 a[84:87], a[164:167], v[176:179], a[84:87]
v_mfma_f32_16x16x32_bf16 a[116:119], a[164:167], v[180:183], a[116:119]
s_waitcnt lgkmcnt(1)
v_mfma_f32_16x16x32_bf16 a[88:91], a[168:171], v[176:179], a[88:91]
v_mfma_f32_16x16x32_bf16 a[120:123], a[168:171], v[180:183], a[120:123]
s_waitcnt lgkmcnt(0)
v_mfma_f32_16x16x32_bf16 a[92:95], a[172:175], v[176:179], a[92:95]
v_mfma_f32_16x16x32_bf16 a[124:127], a[172:175], v[180:183], a[124:127]
s_lshl_b32 s52, s31, 15
s_lshl_b32 s53, s30, 11
s_add_u32 s52, s52, s53
s_mul_i32 s53, s62, 1310720
s_add_u32 s53, s53, s52
s_mul_i32 s54, s63, 1310720
s_add_u32 s54, s54, s52
s_mov_b32 s55, 0x5d800000
v_accvgpr_read_b32 v216, a128
v_accvgpr_read_b32 v217, a132
v_accvgpr_read_b32 v218, a136
v_accvgpr_read_b32 v219, a140
v_max3_f32 v220, v216, v217, v218
v_max_f32 v220, v220, v219
v_cmp_le_f32 vcc, s55, v220
v_rcp_f32 v216, v216
v_rcp_f32 v217, v217
v_rcp_f32 v218, v218
v_rcp_f32 v219, v219
s_cbranch_vccz L_noflag_48
v_mov_b32 v6, 151552
v_mov_b32 v7, 1
ds_write_b32 v6, v7
L_noflag_48:
v_mul_f32 v216, v216, v8
v_mul_f32 v217, v217, v10
v_mul_f32 v218, v218, v12
v_mul_f32 v219, v219, v14
v_accvgpr_read_b32 v88, a0
v_accvgpr_read_b32 v89, a1
v_accvgpr_read_b32 v90, a2
v_accvgpr_read_b32 v91, a3
v_accvgpr_read_b32 v92, a4
v_accvgpr_read_b32 v93, a5
v_accvgpr_read_b32 v94, a6
v_accvgpr_read_b32 v95, a7
v_mul_f32 v88, v88, v216
v_mul_f32 v89, v89, v216
v_mul_f32 v90, v90, v216
v_mul_f32 v91, v91, v216
v_mul_f32 v92, v92, v216
v_mul_f32 v93, v93, v216
v_mul_f32 v94, v94, v216
v_mul_f32 v95, v95, v216
v_cvt_pk_bf16_f32 v88, v88, v89
v_cvt_pk_bf16_f32 v89, v90, v91
v_cvt_pk_bf16_f32 v90, v92, v93
v_cvt_pk_bf16_f32 v91, v94, v95
s_add_u32 s69, s53, 0
buffer_store_dwordx4 v[88:91], v4, s[44:47], s69 offen offset:0
v_accvgpr_read_b32 v96, a8
v_accvgpr_read_b32 v97, a9
v_accvgpr_read_b32 v98, a10
v_accvgpr_read_b32 v99, a11
v_accvgpr_read_b32 v100, a12
v_accvgpr_read_b32 v101, a13
v_accvgpr_read_b32 v102, a14
v_accvgpr_read_b32 v103, a15
v_mul_f32 v96, v96, v216
v_mul_f32 v97, v97, v216
v_mul_f32 v98, v98, v216
v_mul_f32 v99, v99, v216
v_mul_f32 v100, v100, v216
v_mul_f32 v101, v101, v216
v_mul_f32 v102, v102, v216
v_mul_f32 v103, v103, v216
v_cvt_pk_bf16_f32 v96, v96, v97
v_cvt_pk_bf16_f32 v97, v98, v99
v_cvt_pk_bf16_f32 v98, v100, v101
v_cvt_pk_bf16_f32 v99, v102, v103
s_add_u32 s69, s53, 8192
buffer_store_dwordx4 v[96:99], v4, s[44:47], s69 offen offset:0
v_accvgpr_read_b32 v104, a16
v_accvgpr_read_b32 v105, a17
v_accvgpr_read_b32 v106, a18
v_accvgpr_read_b32 v107, a19
v_accvgpr_read_b32 v108, a20
v_accvgpr_read_b32 v109, a21
v_accvgpr_read_b32 v110, a22
v_accvgpr_read_b32 v111, a23
v_mul_f32 v104, v104, v216
v_mul_f32 v105, v105, v216
v_mul_f32 v106, v106, v216
v_mul_f32 v107, v107, v216
v_mul_f32 v108, v108, v216
v_mul_f32 v109, v109, v216
v_mul_f32 v110, v110, v216
v_mul_f32 v111, v111, v216
v_cvt_pk_bf16_f32 v104, v104, v105
v_cvt_pk_bf16_f32 v105, v106, v107
v_cvt_pk_bf16_f32 v106, v108, v109
v_cvt_pk_bf16_f32 v107, v110, v111
s_add_u32 s69, s53, 16384
buffer_store_dwordx4 v[104:107], v4, s[44:47], s69 offen offset:0
v_accvgpr_read_b32 v112, a24
v_accvgpr_read_b32 v113, a25
v_accvgpr_read_b32 v114, a26
v_accvgpr_read_b32 v115, a27
v_accvgpr_read_b32 v116, a28
v_accvgpr_read_b32 v117, a29
v_accvgpr_read_b32 v118, a30
v_accvgpr_read_b32 v119, a31
v_mul_f32 v112, v112, v216
v_mul_f32 v113, v113, v216
v_mul_f32 v114, v114, v216
v_mul_f32 v115, v115, v216
v_mul_f32 v116, v116, v216
v_mul_f32 v117, v117, v216
v_mul_f32 v118, v118, v216
v_mul_f32 v119, v119, v216
v_cvt_pk_bf16_f32 v112, v112, v113
v_cvt_pk_bf16_f32 v113, v114, v115
v_cvt_pk_bf16_f32 v114, v116, v117
v_cvt_pk_bf16_f32 v115, v118, v119
s_add_u32 s69, s53, 24576
buffer_store_dwordx4 v[112:115], v4, s[44:47], s69 offen offset:0
v_accvgpr_read_b32 v120, a32
v_accvgpr_read_b32 v121, a33
v_accvgpr_read_b32 v122, a34
v_accvgpr_read_b32 v123, a35
v_accvgpr_read_b32 v124, a36
v_accvgpr_read_b32 v125, a37
v_accvgpr_read_b32 v126, a38
v_accvgpr_read_b32 v127, a39
v_mul_f32 v120, v120, v217
v_mul_f32 v121, v121, v217
v_mul_f32 v122, v122, v217
v_mul_f32 v123, v123, v217
v_mul_f32 v124, v124, v217
v_mul_f32 v125, v125, v217
v_mul_f32 v126, v126, v217
v_mul_f32 v127, v127, v217
v_cvt_pk_bf16_f32 v120, v120, v121
v_cvt_pk_bf16_f32 v121, v122, v123
v_cvt_pk_bf16_f32 v122, v124, v125
v_cvt_pk_bf16_f32 v123, v126, v127
s_add_u32 s69, s53, 0
buffer_store_dwordx4 v[120:123], v4, s[44:47], s69 offen offset:1024
v_accvgpr_read_b32 v128, a40
v_accvgpr_read_b32 v129, a41
v_accvgpr_read_b32 v130, a42
v_accvgpr_read_b32 v131, a43
v_accvgpr_read_b32 v132, a44
v_accvgpr_read_b32 v133, a45
v_accvgpr_read_b32 v134, a46
v_accvgpr_read_b32 v135, a47
v_mul_f32 v128, v128, v217
v_mul_f32 v129, v129, v217
v_mul_f32 v130, v130, v217
v_mul_f32 v131, v131, v217
v_mul_f32 v132, v132, v217
v_mul_f32 v133, v133, v217
v_mul_f32 v134, v134, v217
v_mul_f32 v135, v135, v217
v_cvt_pk_bf16_f32 v128, v128, v129
v_cvt_pk_bf16_f32 v129, v130, v131
v_cvt_pk_bf16_f32 v130, v132, v133
v_cvt_pk_bf16_f32 v131, v134, v135
s_add_u32 s69, s53, 8192
buffer_store_dwordx4 v[128:131], v4, s[44:47], s69 offen offset:1024
v_accvgpr_read_b32 v136, a48
v_accvgpr_read_b32 v137, a49
v_accvgpr_read_b32 v138, a50
v_accvgpr_read_b32 v139, a51
v_accvgpr_read_b32 v140, a52
v_accvgpr_read_b32 v141, a53
v_accvgpr_read_b32 v142, a54
v_accvgpr_read_b32 v143, a55
v_mul_f32 v136, v136, v217
v_mul_f32 v137, v137, v217
v_mul_f32 v138, v138, v217
v_mul_f32 v139, v139, v217
v_mul_f32 v140, v140, v217
v_mul_f32 v141, v141, v217
v_mul_f32 v142, v142, v217
v_mul_f32 v143, v143, v217
v_cvt_pk_bf16_f32 v136, v136, v137
v_cvt_pk_bf16_f32 v137, v138, v139
v_cvt_pk_bf16_f32 v138, v140, v141
v_cvt_pk_bf16_f32 v139, v142, v143
s_add_u32 s69, s53, 16384
buffer_store_dwordx4 v[136:139], v4, s[44:47], s69 offen offset:1024
v_accvgpr_read_b32 v144, a56
v_accvgpr_read_b32 v145, a57
v_accvgpr_read_b32 v146, a58
v_accvgpr_read_b32 v147, a59
v_accvgpr_read_b32 v148, a60
v_accvgpr_read_b32 v149, a61
v_accvgpr_read_b32 v150, a62
v_accvgpr_read_b32 v151, a63
v_mul_f32 v144, v144, v217
v_mul_f32 v145, v145, v217
v_mul_f32 v146, v146, v217
v_mul_f32 v147, v147, v217
v_mul_f32 v148, v148, v217
v_mul_f32 v149, v149, v217
v_mul_f32 v150, v150, v217
v_mul_f32 v151, v151, v217
v_cvt_pk_bf16_f32 v144, v144, v145
v_cvt_pk_bf16_f32 v145, v146, v147
v_cvt_pk_bf16_f32 v146, v148, v149
v_cvt_pk_bf16_f32 v147, v150, v151
s_add_u32 s69, s53, 24576
buffer_store_dwordx4 v[144:147], v4, s[44:47], s69 offen offset:1024
v_accvgpr_read_b32 v88, a64
v_accvgpr_read_b32 v89, a65
v_accvgpr_read_b32 v90, a66
v_accvgpr_read_b32 v91, a67
v_accvgpr_read_b32 v92, a68
v_accvgpr_read_b32 v93, a69
v_accvgpr_read_b32 v94, a70
v_accvgpr_read_b32 v95, a71
v_mul_f32 v88, v88, v218
v_mul_f32 v89, v89, v218
v_mul_f32 v90, v90, v218
v_mul_f32 v91, v91, v218
v_mul_f32 v92, v92, v218
v_mul_f32 v93, v93, v218
v_mul_f32 v94, v94, v218
v_mul_f32 v95, v95, v218
v_cvt_pk_bf16_f32 v88, v88, v89
v_cvt_pk_bf16_f32 v89, v90, v91
v_cvt_pk_bf16_f32 v90, v92, v93
v_cvt_pk_bf16_f32 v91, v94, v95
s_add_u32 s69, s54, 0
buffer_store_dwordx4 v[88:91], v4, s[44:47], s69 offen offset:0
v_accvgpr_read_b32 v96, a72
v_accvgpr_read_b32 v97, a73
v_accvgpr_read_b32 v98, a74
v_accvgpr_read_b32 v99, a75
v_accvgpr_read_b32 v100, a76
v_accvgpr_read_b32 v101, a77
v_accvgpr_read_b32 v102, a78
v_accvgpr_read_b32 v103, a79
v_mul_f32 v96, v96, v218
v_mul_f32 v97, v97, v218
v_mul_f32 v98, v98, v218
v_mul_f32 v99, v99, v218
v_mul_f32 v100, v100, v218
v_mul_f32 v101, v101, v218
v_mul_f32 v102, v102, v218
v_mul_f32 v103, v103, v218
v_cvt_pk_bf16_f32 v96, v96, v97
v_cvt_pk_bf16_f32 v97, v98, v99
v_cvt_pk_bf16_f32 v98, v100, v101
v_cvt_pk_bf16_f32 v99, v102, v103
s_add_u32 s69, s54, 8192
buffer_store_dwordx4 v[96:99], v4, s[44:47], s69 offen offset:0
v_accvgpr_read_b32 v104, a80
v_accvgpr_read_b32 v105, a81
v_accvgpr_read_b32 v106, a82
v_accvgpr_read_b32 v107, a83
v_accvgpr_read_b32 v108, a84
v_accvgpr_read_b32 v109, a85
v_accvgpr_read_b32 v110, a86
v_accvgpr_read_b32 v111, a87
v_mul_f32 v104, v104, v218
v_mul_f32 v105, v105, v218
v_mul_f32 v106, v106, v218
v_mul_f32 v107, v107, v218
v_mul_f32 v108, v108, v218
v_mul_f32 v109, v109, v218
v_mul_f32 v110, v110, v218
v_mul_f32 v111, v111, v218
v_cvt_pk_bf16_f32 v104, v104, v105
v_cvt_pk_bf16_f32 v105, v106, v107
v_cvt_pk_bf16_f32 v106, v108, v109
v_cvt_pk_bf16_f32 v107, v110, v111
s_add_u32 s69, s54, 16384
buffer_store_dwordx4 v[104:107], v4, s[44:47], s69 offen offset:0
v_accvgpr_read_b32 v112, a88
v_accvgpr_read_b32 v113, a89
v_accvgpr_read_b32 v114, a90
v_accvgpr_read_b32 v115, a91
v_accvgpr_read_b32 v116, a92
v_accvgpr_read_b32 v117, a93
v_accvgpr_read_b32 v118, a94
v_accvgpr_read_b32 v119, a95
v_mul_f32 v112, v112, v218
v_mul_f32 v113, v113, v218
v_mul_f32 v114, v114, v218
v_mul_f32 v115, v115, v218
v_mul_f32 v116, v116, v218
v_mul_f32 v117, v117, v218
v_mul_f32 v118, v118, v218
v_mul_f32 v119, v119, v218
v_cvt_pk_bf16_f32 v112, v112, v113
v_cvt_pk_bf16_f32 v113, v114, v115
v_cvt_pk_bf16_f32 v114, v116, v117
v_cvt_pk_bf16_f32 v115, v118, v119
s_add_u32 s69, s54, 24576
buffer_store_dwordx4 v[112:115], v4, s[44:47], s69 offen offset:0
v_accvgpr_read_b32 v120, a96
v_accvgpr_read_b32 v121, a97
v_accvgpr_read_b32 v122, a98
v_accvgpr_read_b32 v123, a99
v_accvgpr_read_b32 v124, a100
v_accvgpr_read_b32 v125, a101
v_accvgpr_read_b32 v126, a102
v_accvgpr_read_b32 v127, a103
v_mul_f32 v120, v120, v219
v_mul_f32 v121, v121, v219
v_mul_f32 v122, v122, v219
v_mul_f32 v123, v123, v219
v_mul_f32 v124, v124, v219
v_mul_f32 v125, v125, v219
v_mul_f32 v126, v126, v219
v_mul_f32 v127, v127, v219
v_cvt_pk_bf16_f32 v120, v120, v121
v_cvt_pk_bf16_f32 v121, v122, v123
v_cvt_pk_bf16_f32 v122, v124, v125
v_cvt_pk_bf16_f32 v123, v126, v127
s_add_u32 s69, s54, 0
buffer_store_dwordx4 v[120:123], v4, s[44:47], s69 offen offset:1024
v_accvgpr_read_b32 v128, a104
v_accvgpr_read_b32 v129, a105
v_accvgpr_read_b32 v130, a106
v_accvgpr_read_b32 v131, a107
v_accvgpr_read_b32 v132, a108
v_accvgpr_read_b32 v133, a109
v_accvgpr_read_b32 v134, a110
v_accvgpr_read_b32 v135, a111
v_mul_f32 v128, v128, v219
v_mul_f32 v129, v129, v219
v_mul_f32 v130, v130, v219
v_mul_f32 v131, v131, v219
v_mul_f32 v132, v132, v219
v_mul_f32 v133, v133, v219
v_mul_f32 v134, v134, v219
v_mul_f32 v135, v135, v219
v_cvt_pk_bf16_f32 v128, v128, v129
v_cvt_pk_bf16_f32 v129, v130, v131
v_cvt_pk_bf16_f32 v130, v132, v133
v_cvt_pk_bf16_f32 v131, v134, v135
s_add_u32 s69, s54, 8192
buffer_store_dwordx4 v[128:131], v4, s[44:47], s69 offen offset:1024
v_accvgpr_read_b32 v136, a112
v_accvgpr_read_b32 v137, a113
v_accvgpr_read_b32 v138, a114
v_accvgpr_read_b32 v139, a115
v_accvgpr_read_b32 v140, a116
v_accvgpr_read_b32 v141, a117
v_accvgpr_read_b32 v142, a118
v_accvgpr_read_b32 v143, a119
v_mul_f32 v136, v136, v219
v_mul_f32 v137, v137, v219
v_mul_f32 v138, v138, v219
v_mul_f32 v139, v139, v219
v_mul_f32 v140, v140, v219
v_mul_f32 v141, v141, v219
v_mul_f32 v142, v142, v219
v_mul_f32 v143, v143, v219
v_cvt_pk_bf16_f32 v136, v136, v137
v_cvt_pk_bf16_f32 v137, v138, v139
v_cvt_pk_bf16_f32 v138, v140, v141
v_cvt_pk_bf16_f32 v139, v142, v143
s_add_u32 s69, s54, 16384
buffer_store_dwordx4 v[136:139], v4, s[44:47], s69 offen offset:1024
v_accvgpr_read_b32 v144, a120
v_accvgpr_read_b32 v145, a121
v_accvgpr_read_b32 v146, a122
v_accvgpr_read_b32 v147, a123
v_accvgpr_read_b32 v148, a124
v_accvgpr_read_b32 v149, a125
v_accvgpr_read_b32 v150, a126
v_accvgpr_read_b32 v151, a127
v_mul_f32 v144, v144, v219
v_mul_f32 v145, v145, v219
v_mul_f32 v146, v146, v219
v_mul_f32 v147, v147, v219
v_mul_f32 v148, v148, v219
v_mul_f32 v149, v149, v219
v_mul_f32 v150, v150, v219
v_mul_f32 v151, v151, v219
v_cvt_pk_bf16_f32 v144, v144, v145
v_cvt_pk_bf16_f32 v145, v146, v147
v_cvt_pk_bf16_f32 v146, v148, v149
v_cvt_pk_bf16_f32 v147, v150, v151
s_add_u32 s69, s54, 24576
buffer_store_dwordx4 v[144:147], v4, s[44:47], s69 offen offset:1024
s_waitcnt vmcnt(0) lgkmcnt(0)
s_barrier
v_mov_b32 v6, 151552
ds_read_b32 v7, v6
s_waitcnt lgkmcnt(0)
v_readfirstlane_b32 s52, v7
s_nop 0
s_cmp_gt_u32 s52, s68
s_cbranch_scc1 L_fallback_50
s_branch L_attdone_49
L_st_8:
s_call_b64 s[70:71], L_masklo_5
s_branch L_bk_9
L_st_10:
s_call_b64 s[70:71], L_masklo_5
s_branch L_bk_11
L_st_12:
s_call_b64 s[70:71], L_masklo_5
s_branch L_bk_13
L_st_14:
s_call_b64 s[70:71], L_masklo_5
s_branch L_bk_15
L_st_16:
s_call_b64 s[70:71], L_masklo_5
s_branch L_bk_17
L_st_22:
s_call_b64 s[70:71], L_masklo_5
s_branch L_bk_23
L_st_24:
s_call_b64 s[70:71], L_masklo_5
s_branch L_bk_25
L_st_26:
s_call_b64 s[70:71], L_masklo_5
s_branch L_bk_27
L_st_28:
s_call_b64 s[70:71], L_masklo_5
s_branch L_bk_29
L_st_30:
s_call_b64 s[70:71], L_maskhi_6
s_branch L_bk_31
L_st_32:
s_call_b64 s[70:71], L_maskhi_6
s_branch L_bk_33
L_st_34:
s_call_b64 s[70:71], L_maskhi_6
s_branch L_bk_35
L_st_36:
s_call_b64 s[70:71], L_maskhi_6
s_branch L_bk_37
L_st_38:
s_call_b64 s[70:71], L_maskhi_6
s_branch L_bk_39
L_st_40:
s_call_b64 s[70:71], L_maskhi_6
s_branch L_bk_41
L_st_42:
s_call_b64 s[70:71], L_maskhi_6
s_branch L_bk_43
L_st_44:
s_call_b64 s[70:71], L_maskhi_6
s_branch L_bk_45
L_st_46:
s_call_b64 s[70:71], L_maskhi_6
s_branch L_bk_47
L_masklo_5:
s_nop 2
s_cmp_eq_u32 s66, 0
s_cbranch_scc1 L_full_51
v_cndmask_b32 v184, v184, v5, s[72:73]
v_cndmask_b32 v196, v196, v5, s[72:73]
v_mov_b32 v188, v5
v_cndmask_b32 v185, v185, v5, s[74:75]
v_cndmask_b32 v197, v197, v5, s[74:75]
v_mov_b32 v189, v5
v_cndmask_b32 v186, v186, v5, s[76:77]
v_cndmask_b32 v198, v198, v5, s[76:77]
v_mov_b32 v190, v5
v_cndmask_b32 v187, v187, v5, s[78:79]
v_cndmask_b32 v199, v199, v5, s[78:79]
v_mov_b32 v191, v5
s_nop 1
s_setpc_b64 s[70:71]
L_full_51:
v_mov_b32 v184, v5
v_mov_b32 v196, v5
v_mov_b32 v192, v5
v_mov_b32 v185, v5
v_mov_b32 v197, v5
v_mov_b32 v193, v5
v_mov_b32 v186, v5
v_mov_b32 v198, v5
v_mov_b32 v194, v5
v_mov_b32 v187, v5
v_mov_b32 v199, v5
v_mov_b32 v195, v5
s_nop 1
s_setpc_b64 s[70:71]
L_maskhi_6:
s_nop 2
s_cmp_eq_u32 s66, 0
s_cbranch_scc1 L_full_52
v_cndmask_b32 v200, v200, v5, s[72:73]
v_cndmask_b32 v212, v212, v5, s[72:73]
v_mov_b32 v204, v5
v_cndmask_b32 v201, v201, v5, s[74:75]
v_cndmask_b32 v213, v213, v5, s[74:75]
v_mov_b32 v205, v5
v_cndmask_b32 v202, v202, v5, s[76:77]
v_cndmask_b32 v214, v214, v5, s[76:77]
v_mov_b32 v206, v5
v_cndmask_b32 v203, v203, v5, s[78:79]
v_cndmask_b32 v215, v215, v5, s[78:79]
v_mov_b32 v207, v5
s_nop 1
s_setpc_b64 s[70:71]
L_full_52:
v_mov_b32 v200, v5
v_mov_b32 v212, v5
v_mov_b32 v208, v5
v_mov_b32 v201, v5
v_mov_b32 v213, v5
v_mov_b32 v209, v5
v_mov_b32 v202, v5
v_mov_b32 v214, v5
v_mov_b32 v210, v5
v_mov_b32 v203, v5
v_mov_b32 v215, v5
v_mov_b32 v211, v5
s_nop 1
s_setpc_b64 s[70:71]
L_fallback_50:
v_mov_b32 v184, 0
v_mov_b32 v185, 0
v_mov_b32 v186, 0
v_mov_b32 v187, 0
v_mov_b32 v188, 0
v_mov_b32 v189, 0
v_mov_b32 v190, 0
v_mov_b32 v191, 0
v_mov_b32 v192, 0
v_mov_b32 v193, 0
v_mov_b32 v194, 0
v_mov_b32 v195, 0
v_mov_b32 v196, 0
v_mov_b32 v197, 0
v_mov_b32 v198, 0
v_mov_b32 v199, 0
v_mov_b32 v200, 0
v_mov_b32 v201, 0
v_mov_b32 v202, 0
v_mov_b32 v203, 0
v_mov_b32 v204, 0
v_mov_b32 v205, 0
v_mov_b32 v206, 0
v_mov_b32 v207, 0
v_mov_b32 v208, 0
v_mov_b32 v209, 0
v_mov_b32 v210, 0
v_mov_b32 v211, 0
v_mov_b32 v212, 0
v_mov_b32 v213, 0
v_mov_b32 v214, 0
v_mov_b32 v215, 0
v_mov_b32 v216, v5
v_mov_b32 v217, v5
v_mov_b32 v218, v5
v_mov_b32 v219, v5
s_mov_b32 s68, 1
s_lshl2_add_u32 s80, s62, s30
s_add_u32 s80, s80, 1
s_lshl2_add_u32 s81, s63, s30
s_add_u32 s81, s81, 1
s_mov_b32 s82, 0
L_fbl_53:
buffer_load_dwordx4 a[144:147], v4, s[32:35], s82 offen offset:0
buffer_load_dwordx4 a[148:151], v4, s[32:35], s82 offen offset:1024
buffer_load_dwordx4 a[152:155], v4, s[32:35], s82 offen offset:2048
buffer_load_dwordx4 a[156:159], v4, s[32:35], s82 offen offset:3072
s_add_u32 s69, s82, 4096
buffer_load_dwordx4 a[160:163], v4, s[32:35], s69 offen offset:0
buffer_load_dwordx4 a[164:167], v4, s[32:35], s69 offen offset:1024
buffer_load_dwordx4 a[168:171], v4, s[32:35], s69 offen offset:2048
buffer_load_dwordx4 a[172:175], v4, s[32:35], s69 offen offset:3072
s_mov_b32 s66, s80
s_cmp_le_u32 s66, 1
s_cbranch_scc0 L_sk_54
s_call_b64 s[70:71], L_masklo_5
L_sk_54:
s_sub_u32 s80, s80, 1
s_mov_b32 s66, s81
s_cmp_le_u32 s66, 1
s_cbranch_scc0 L_sk_55
s_call_b64 s[70:71], L_maskhi_6
L_sk_55:
s_sub_u32 s81, s81, 1
s_waitcnt vmcnt(0)
v_mfma_f32_16x16x32_bf16 v[88:91], a[144:147], v[24:27], v[184:187]
v_mfma_f32_16x16x32_bf16 v[96:99], a[144:147], v[40:43], v[192:195]
v_mfma_f32_16x16x32_bf16 v[104:107], a[144:147], v[56:59], v[200:203]
v_mfma_f32_16x16x32_bf16 v[112:115], a[144:147], v[72:75], v[208:211]
v_mfma_f32_16x16x32_bf16 v[88:91], a[148:151], v[28:31], v[88:91]
v_mfma_f32_16x16x32_bf16 v[96:99], a[148:151], v[44:47], v[96:99]
v_mfma_f32_16x16x32_bf16 v[104:107], a[148:151], v[60:63], v[104:107]
v_mfma_f32_16x16x32_bf16 v[112:115], a[148:151], v[76:79], v[112:115]
v_mfma_f32_16x16x32_bf16 v[88:91], a[152:155], v[32:35], v[88:91]
v_mfma_f32_16x16x32_bf16 v[96:99], a[152:155], v[48:51], v[96:99]
v_mfma_f32_16x16x32_bf16 v[104:107], a[152:155], v[64:67], v[104:107]
v_mfma_f32_16x16x32_bf16 v[112:115], a[152:155], v[80:83], v[112:115]
v_mfma_f32_16x16x32_bf16 v[88:91], a[156:159], v[36:39], v[88:91]
v_mfma_f32_16x16x32_bf16 v[96:99], a[156:159], v[52:55], v[96:99]
v_mfma_f32_16x16x32_bf16 v[104:107], a[156:159], v[68:71], v[104:107]
v_mfma_f32_16x16x32_bf16 v[112:115], a[156:159], v[84:87], v[112:115]
v_mfma_f32_16x16x32_bf16 v[92:95], a[160:163], v[24:27], v[188:191]
v_mfma_f32_16x16x32_bf16 v[100:103], a[160:163], v[40:43], v[196:199]
v_mfma_f32_16x16x32_bf16 v[108:111], a[160:163], v[56:59], v[204:207]
v_mfma_f32_16x16x32_bf16 v[116:119], a[160:163], v[72:75], v[212:215]
v_mfma_f32_16x16x32_bf16 v[92:95], a[164:167], v[28:31], v[92:95]
v_mfma_f32_16x16x32_bf16 v[100:103], a[164:167], v[44:47], v[100:103]
v_mfma_f32_16x16x32_bf16 v[108:111], a[164:167], v[60:63], v[108:111]
v_mfma_f32_16x16x32_bf16 v[116:119], a[164:167], v[76:79], v[116:119]
v_mfma_f32_16x16x32_bf16 v[92:95], a[168:171], v[32:35], v[92:95]
v_mfma_f32_16x16x32_bf16 v[100:103], a[168:171], v[48:51], v[100:103]
v_mfma_f32_16x16x32_bf16 v[108:111], a[168:171], v[64:67], v[108:111]
v_mfma_f32_16x16x32_bf16 v[116:119], a[168:171], v[80:83], v[116:119]
v_mfma_f32_16x16x32_bf16 v[92:95], a[172:175], v[36:39], v[92:95]
v_mfma_f32_16x16x32_bf16 v[100:103], a[172:175], v[52:55], v[100:103]
v_mfma_f32_16x16x32_bf16 v[108:111], a[172:175], v[68:71], v[108:111]
v_mfma_f32_16x16x32_bf16 v[116:119], a[172:175], v[84:87], v[116:119]
s_nop 7
v_max3_f32 v216, v216, v88, v89
v_max3_f32 v216, v216, v90, v91
v_max3_f32 v216, v216, v92, v93
v_max3_f32 v216, v216, v94, v95
v_max3_f32 v217, v217, v96, v97
v_max3_f32 v217, v217, v98, v99
v_max3_f32 v217, v217, v100, v101
v_max3_f32 v217, v217, v102, v103
v_max3_f32 v218, v218, v104, v105
v_max3_f32 v218, v218, v106, v107
v_max3_f32 v218, v218, v108, v109
v_max3_f32 v218, v218, v110, v111
v_max3_f32 v219, v219, v112, v113
v_max3_f32 v219, v219, v114, v115
v_max3_f32 v219, v219, v116, v117
v_max3_f32 v219, v219, v118, v119
s_add_u32 s82, s82, 16384
s_cmp_lt_u32 s82, s34
s_cbranch_scc1 L_fbl_53
v_mov_b32 v220, v216
v_mov_b32 v221, v217
v_mov_b32 v222, v218
v_mov_b32 v223, v219
s_nop 0
v_permlane16_swap_b32 v220, v216
v_permlane16_swap_b32 v221, v217
v_permlane16_swap_b32 v222, v218
v_permlane16_swap_b32 v223, v219
v_max_f32 v216, v216, v220
v_max_f32 v217, v217, v221
v_max_f32 v218, v218, v222
v_max_f32 v219, v219, v223
v_mov_b32 v220, v216
v_mov_b32 v221, v217
v_mov_b32 v222, v218
v_mov_b32 v223, v219
s_nop 0
v_permlane32_swap_b32 v220, v216
v_permlane32_swap_b32 v221, v217
v_permlane32_swap_b32 v222, v218
v_permlane32_swap_b32 v223, v219
v_max_f32 v216, v216, v220
v_max_f32 v217, v217, v221
v_max_f32 v218, v218, v222
v_max_f32 v219, v219, v223
v_sub_f32 v184, 0, v216
v_sub_f32 v185, 0, v216
v_sub_f32 v186, 0, v216
v_sub_f32 v187, 0, v216
v_sub_f32 v188, 0, v216
v_sub_f32 v189, 0, v216
v_sub_f32 v190, 0, v216
v_sub_f32 v191, 0, v216
v_sub_f32 v192, 0, v217
v_sub_f32 v193, 0, v217
v_sub_f32 v194, 0, v217
v_sub_f32 v195, 0, v217
v_sub_f32 v196, 0, v217
v_sub_f32 v197, 0, v217
v_sub_f32 v198, 0, v217
v_sub_f32 v199, 0, v217
v_sub_f32 v200, 0, v218
v_sub_f32 v201, 0, v218
v_sub_f32 v202, 0, v218
v_sub_f32 v203, 0, v218
v_sub_f32 v204, 0, v218
v_sub_f32 v205, 0, v218
v_sub_f32 v206, 0, v218
v_sub_f32 v207, 0, v218
v_sub_f32 v208, 0, v219
v_sub_f32 v209, 0, v219
v_sub_f32 v210, 0, v219
v_sub_f32 v211, 0, v219
v_sub_f32 v212, 0, v219
v_sub_f32 v213, 0, v219
v_sub_f32 v214, 0, v219
v_sub_f32 v215, 0, v219
s_branch L_attstart_7
L_attdone_49:
L_end_3:
s_endpgm
.globl k3_kernel
.p2align 8
.type k3_kernel,@function
k3_kernel:
s_cmp_ge_u32 s2, 256
s_cbranch_scc1 L_end_56
s_load_dwordx16 s[4:19], s[0:1], 0
s_load_dwordx8 s[20:27], s[0:1], 64
s_load_dwordx2 s[28:29], s[0:1], 96
v_lshrrev_b32 v1, 6, v0
v_and_b32 v0, 63, v0
v_readfirstlane_b32 s30, v1
s_and_b32 s52, s2, 7
s_lshr_b32 s53, s2, 3
s_and_b32 s54, s53, 3
s_lshl2_add_u32 s31, s52, s54
s_lshr_b32 s3, s53, 2
s_waitcnt lgkmcnt(0)
s_and_b32 s52, s2, 7
s_lshr_b32 s53, s2, 3
s_lshr_b32 s54, s52, 1
s_and_b32 s55, s53, 3
s_lshl2_add_u32 s64, s54, s55
s_and_b32 s54, s52, 1
s_lshr_b32 s55, s53, 2
s_lshl3_add_u32 s65, s54, s55
s_mul_i32 s52, s64, 1310720
s_add_u32 s52, s52, 33554432
s_add_u32 s32, s28, s52
s_addc_u32 s33, s29, 0
s_mov_b32 s34, 1310720
s_mov_b32 s35, 0x20000
s_mov_b32 s36, s20
s_mov_b32 s37, s21
s_mov_b32 s38, 2097152
s_mov_b32 s39, 0x20000
v_lshlrev_b32 v7, 4, v0
v_lshrrev_b32 v8, 3, v0
v_lshrrev_b32 v9, 4, v0
v_bfe_u32 v10, v0, 1, 2
v_xor_b32 v10, v10, v9
v_lshlrev_b32 v10, 5, v10
v_and_b32 v11, 1, v0
v_lshl_add_u32 v10, v11, 4, v10
v_lshl_add_u32 v6, v8, 11, v10
s_lshl_b32 s66, s30, 11
s_add_u32 s66, s66, 1048576
s_lshl_b32 s67, s30, 16
s_lshl_b32 s52, s65, 7
s_add_u32 s67, s67, s52
s_mov_b32 s72, s67
s_lshl_b32 s73, s30, 11
s_lshl_b32 s68, s30, 12
s_mov_b32 s70, 0
s_add_u32 m0, s68, 0
s_add_u32 s69, s67, 0
buffer_load_dwordx4 v6, s[36:39], s69 offen lds
s_add_u32 m0, s68, 1024
s_add_u32 s69, s67, 16384
buffer_load_dwordx4 v6, s[36:39], s69 offen lds
s_add_u32 m0, s68, 2048
s_add_u32 s69, s67, 32768
buffer_load_dwordx4 v6, s[36:39], s69 offen lds
s_add_u32 m0, s68, 3072
s_add_u32 s69, s67, 49152
buffer_load_dwordx4 v6, s[36:39], s69 offen lds
s_add_u32 s71, s66, 0
buffer_load_dwordx4 a[0:3], v7, s[32:35], s71 offen offset:0
buffer_load_dwordx4 a[4:7], v7, s[32:35], s71 offen offset:1024
s_add_u32 s71, s66, 8192
buffer_load_dwordx4 a[8:11], v7, s[32:35], s71 offen offset:0
buffer_load_dwordx4 a[12:15], v7, s[32:35], s71 offen offset:1024
s_add_u32 s71, s66, 16384
buffer_load_dwordx4 a[16:19], v7, s[32:35], s71 offen offset:0
buffer_load_dwordx4 a[20:23], v7, s[32:35], s71 offen offset:1024
s_add_u32 s71, s66, 24576
buffer_load_dwordx4 a[24:27], v7, s[32:35], s71 offen offset:0
buffer_load_dwordx4 a[28:31], v7, s[32:35], s71 offen offset:1024
s_add_u32 s70, s70, 1
s_add_u32 s66, s66, 32768
s_add_u32 s67, s67, 262144
s_cmp_eq_u32 s70, 8
s_cselect_b32 s66, s73, s66
s_cselect_b32 s67, s72, s67
s_cselect_b32 s36, s14, s36
s_cselect_b32 s37, s15, s37
s_cselect_b32 s38, 8388608, s38
s_cmp_eq_u32 s70, 40
s_cselect_b32 s34, 0, s34
s_add_u32 m0, s68, 16384
s_add_u32 s69, s67, 0
buffer_load_dwordx4 v6, s[36:39], s69 offen lds
s_add_u32 m0, s68, 17408
s_add_u32 s69, s67, 16384
buffer_load_dwordx4 v6, s[36:39], s69 offen lds
s_add_u32 m0, s68, 18432
s_add_u32 s69, s67, 32768
buffer_load_dwordx4 v6, s[36:39], s69 offen lds
s_add_u32 m0, s68, 19456
s_add_u32 s69, s67, 49152
buffer_load_dwordx4 v6, s[36:39], s69 offen lds
s_add_u32 s71, s66, 0
buffer_load_dwordx4 a[32:35], v7, s[32:35], s71 offen offset:0
buffer_load_dwordx4 a[36:39], v7, s[32:35], s71 offen offset:1024
s_add_u32 s71, s66, 8192
buffer_load_dwordx4 a[40:43], v7, s[32:35], s71 offen offset:0
buffer_load_dwordx4 a[44:47], v7, s[32:35], s71 offen offset:1024
s_add_u32 s71, s66, 16384
buffer_load_dwordx4 a[48:51], v7, s[32:35], s71 offen offset:0
buffer_load_dwordx4 a[52:55], v7, s[32:35], s71 offen offset:1024
s_add_u32 s71, s66, 24576
buffer_load_dwordx4 a[56:59], v7, s[32:35], s71 offen offset:0
buffer_load_dwordx4 a[60:63], v7, s[32:35], s71 offen offset:1024
s_add_u32 s70, s70, 1
s_add_u32 s66, s66, 32768
s_add_u32 s67, s67, 262144
s_cmp_eq_u32 s70, 8
s_cselect_b32 s66, s73, s66
s_cselect_b32 s67, s72, s67
s_cselect_b32 s36, s14, s36
s_cselect_b32 s37, s15, s37
s_cselect_b32 s38, 8388608, s38
s_cmp_eq_u32 s70, 40
s_cselect_b32 s34, 0, s34
s_add_u32 m0, s68, 32768
s_add_u32 s69, s67, 0
buffer_load_dwordx4 v6, s[36:39], s69 offen lds
s_add_u32 m0, s68, 33792
s_add_u32 s69, s67, 16384
buffer_load_dwordx4 v6, s[36:39], s69 offen lds
s_add_u32 m0, s68, 34816
s_add_u32 s69, s67, 32768
buffer_load_dwordx4 v6, s[36:39], s69 offen lds
s_add_u32 m0, s68, 35840
s_add_u32 s69, s67, 49152
buffer_load_dwordx4 v6, s[36:39], s69 offen lds
s_add_u32 s71, s66, 0
buffer_load_dwordx4 a[64:67], v7, s[32:35], s71 offen offset:0
buffer_load_dwordx4 a[68:71], v7, s[32:35], s71 offen offset:1024
s_add_u32 s71, s66, 8192
buffer_load_dwordx4 a[72:75], v7, s[32:35], s71 offen offset:0
buffer_load_dwordx4 a[76:79], v7, s[32:35], s71 offen offset:1024
s_add_u32 s71, s66, 16384
buffer_load_dwordx4 a[80:83], v7, s[32:35], s71 offen offset:0
buffer_load_dwordx4 a[84:87], v7, s[32:35], s71 offen offset:1024
s_add_u32 s71, s66, 24576
buffer_load_dwordx4 a[88:91], v7, s[32:35], s71 offen offset:0
buffer_load_dwordx4 a[92:95], v7, s[32:35], s71 offen offset:1024
s_add_u32 s70, s70, 1
s_add_u32 s66, s66, 32768
s_add_u32 s67, s67, 262144
s_cmp_eq_u32 s70, 8
s_cselect_b32 s66, s73, s66
s_cselect_b32 s67, s72, s67
s_cselect_b32 s36, s14, s36
s_cselect_b32 s37, s15, s37
s_cselect_b32 s38, 8388608, s38
s_cmp_eq_u32 s70, 40
s_cselect_b32 s34, 0, s34
v_bfe_u32 v8, v0, 2, 2
v_lshl_add_u32 v8, v9, 2, v8
v_and_b32 v10, 3, v0
v_lshlrev_b32 v10, 3, v10
v_lshl_add_u32 v10, v8, 7, v10
v_bfe_u32 v8, v8, 1, 2
v_xor_b32 v11, 0, v8
v_lshl_add_u32 v2, v11, 5, v10
v_xor_b32 v11, 1, v8
v_lshl_add_u32 v3, v11, 5, v10
v_xor_b32 v11, 2, v8
v_lshl_add_u32 v4, v11, 5, v10
v_xor_b32 v11, 3, v8
v_lshl_add_u32 v5, v11, 5, v10
v_mov_b32 v16, 0
v_mov_b32 v17, 0
v_mov_b32 v18, 0
v_mov_b32 v19, 0
v_mov_b32 v20, 0
v_mov_b32 v21, 0
v_mov_b32 v22, 0
v_mov_b32 v23, 0
v_mov_b32 v24, 0
v_mov_b32 v25, 0
v_mov_b32 v26, 0
v_mov_b32 v27, 0
v_mov_b32 v28, 0
v_mov_b32 v29, 0
v_mov_b32 v30, 0
v_mov_b32 v31, 0
v_mov_b32 v32, 0
v_mov_b32 v33, 0
v_mov_b32 v34, 0
v_mov_b32 v35, 0
v_mov_b32 v36, 0
v_mov_b32 v37, 0
v_mov_b32 v38, 0
v_mov_b32 v39, 0
v_mov_b32 v40, 0
v_mov_b32 v41, 0
v_mov_b32 v42, 0
v_mov_b32 v43, 0
v_mov_b32 v44, 0
v_mov_b32 v45, 0
v_mov_b32 v46, 0
v_mov_b32 v47, 0
s_waitcnt vmcnt(24)
s_barrier
ds_read_b64_tr_b16 a[128:129], v2 offset:0
ds_read_b64_tr_b16 a[130:131], v2 offset:2048
ds_read_b64_tr_b16 a[132:133], v3 offset:0
ds_read_b64_tr_b16 a[134:135], v3 offset:2048
ds_read_b64_tr_b16 a[136:137], v4 offset:0
ds_read_b64_tr_b16 a[138:139], v4 offset:2048
ds_read_b64_tr_b16 a[140:141], v5 offset:0
ds_read_b64_tr_b16 a[142:143], v5 offset:2048
.p2align 3
L_p5_57:
s_waitcnt lgkmcnt(6)
v_mfma_f32_16x16x32_bf16 v[16:19], a[128:131], a[0:3], v[16:19]
s_add_u32 m0, s68, 49152
s_add_u32 s69, s67, 0
ds_read_b64_tr_b16 a[144:145], v2 offset:4096
v_mfma_f32_16x16x32_bf16 v[32:35], a[128:131], a[4:7], v[32:35]
s_waitcnt lgkmcnt(5)
ds_read_b64_tr_b16 a[146:147], v2 offset:6144
buffer_load_dwordx4 v6, s[36:39], s69 offen lds
v_mfma_f32_16x16x32_bf16 v[20:23], a[132:135], a[0:3], v[20:23]
s_add_u32 m0, s68, 50176
s_add_u32 s69, s67, 16384
ds_read_b64_tr_b16 a[148:149], v3 offset:4096
v_mfma_f32_16x16x32_bf16 v[36:39], a[132:135], a[4:7], v[36:39]
s_waitcnt lgkmcnt(5)
ds_read_b64_tr_b16 a[150:151], v3 offset:6144
buffer_load_dwordx4 v6, s[36:39], s69 offen lds
v_mfma_f32_16x16x32_bf16 v[24:27], a[136:139], a[0:3], v[24:27]
s_add_u32 m0, s68, 51200
s_add_u32 s69, s67, 32768
ds_read_b64_tr_b16 a[152:153], v4 offset:4096
v_mfma_f32_16x16x32_bf16 v[40:43], a[136:139], a[4:7], v[40:43]
s_waitcnt lgkmcnt(5)
ds_read_b64_tr_b16 a[154:155], v4 offset:6144
buffer_load_dwordx4 v6, s[36:39], s69 offen lds
v_mfma_f32_16x16x32_bf16 v[28:31], a[140:143], a[0:3], v[28:31]
s_add_u32 m0, s68, 52224
s_add_u32 s69, s67, 49152
ds_read_b64_tr_b16 a[156:157], v5 offset:4096
v_mfma_f32_16x16x32_bf16 v[44:47], a[140:143], a[4:7], v[44:47]
s_waitcnt lgkmcnt(5)
ds_read_b64_tr_b16 a[158:159], v5 offset:6144
buffer_load_dwordx4 v6, s[36:39], s69 offen lds
v_mfma_f32_16x16x32_bf16 v[16:19], a[144:147], a[8:11], v[16:19]
s_add_u32 s71, s66, 0
ds_read_b64_tr_b16 a[128:129], v2 offset:8192
v_mfma_f32_16x16x32_bf16 v[32:35], a[144:147], a[12:15], v[32:35]
s_waitcnt lgkmcnt(5)
ds_read_b64_tr_b16 a[130:131], v2 offset:10240
buffer_load_dwordx4 a[96:99], v7, s[32:35], s71 offen offset:0
v_mfma_f32_16x16x32_bf16 v[20:23], a[148:151], a[8:11], v[20:23]
ds_read_b64_tr_b16 a[132:133], v3 offset:8192
v_mfma_f32_16x16x32_bf16 v[36:39], a[148:151], a[12:15], v[36:39]
s_waitcnt lgkmcnt(5)
ds_read_b64_tr_b16 a[134:135], v3 offset:10240
buffer_load_dwordx4 a[100:103], v7, s[32:35], s71 offen offset:1024
v_mfma_f32_16x16x32_bf16 v[24:27], a[152:155], a[8:11], v[24:27]
s_add_u32 s71, s66, 8192
ds_read_b64_tr_b16 a[136:137], v4 offset:8192
v_mfma_f32_16x16x32_bf16 v[40:43], a[152:155], a[12:15], v[40:43]
s_waitcnt lgkmcnt(5)
ds_read_b64_tr_b16 a[138:139], v4 offset:10240
buffer_load_dwordx4 a[104:107], v7, s[32:35], s71 offen offset:0
v_mfma_f32_16x16x32_bf16 v[28:31], a[156:159], a[8:11], v[28:31]
ds_read_b64_tr_b16 a[140:141], v5 offset:8192
v_mfma_f32_16x16x32_bf16 v[44:47], a[156:159], a[12:15], v[44:47]
s_waitcnt lgkmcnt(5)
ds_read_b64_tr_b16 a[142:143], v5 offset:10240
buffer_load_dwordx4 a[108:111], v7, s[32:35], s71 offen offset:1024
v_mfma_f32_16x16x32_bf16 v[16:19], a[128:131], a[16:19], v[16:19]
s_add_u32 s71, s66, 16384
ds_read_b64_tr_b16 a[144:145], v2 offset:12288
v_mfma_f32_16x16x32_bf16 v[32:35], a[128:131], a[20:23], v[32:35]
s_waitcnt lgkmcnt(5)
ds_read_b64_tr_b16 a[146:147], v2 offset:14336
buffer_load_dwordx4 a[112:115], v7, s[32:35], s71 offen offset:0
v_mfma_f32_16x16x32_bf16 v[20:23], a[132:135], a[16:19], v[20:23]
ds_read_b64_tr_b16 a[148:149], v3 offset:12288
v_mfma_f32_16x16x32_bf16 v[36:39], a[132:135], a[20:23], v[36:39]
s_waitcnt lgkmcnt(5)
ds_read_b64_tr_b16 a[150:151], v3 offset:14336
buffer_load_dwordx4 a[116:119], v7, s[32:35], s71 offen offset:1024
v_mfma_f32_16x16x32_bf16 v[24:27], a[136:139], a[16:19], v[24:27]
s_add_u32 s71, s66, 24576
ds_read_b64_tr_b16 a[152:153], v4 offset:12288
v_mfma_f32_16x16x32_bf16 v[40:43], a[136:139], a[20:23], v[40:43]
s_waitcnt lgkmcnt(5)
ds_read_b64_tr_b16 a[154:155], v4 offset:14336
buffer_load_dwordx4 a[120:123], v7, s[32:35], s71 offen offset:0
v_mfma_f32_16x16x32_bf16 v[28:31], a[140:143], a[16:19], v[28:31]
ds_read_b64_tr_b16 a[156:157], v5 offset:12288
v_mfma_f32_16x16x32_bf16 v[44:47], a[140:143], a[20:23], v[44:47]
ds_read_b64_tr_b16 a[158:159], v5 offset:14336
buffer_load_dwordx4 a[124:127], v7, s[32:35], s71 offen offset:1024
s_waitcnt vmcnt(24) lgkmcnt(0)
s_barrier
v_mfma_f32_16x16x32_bf16 v[16:19], a[144:147], a[24:27], v[16:19]
s_add_u32 s70, s70, 1
s_add_u32 s66, s66, 32768
ds_read_b64_tr_b16 a[128:129], v2 offset:16384
v_mfma_f32_16x16x32_bf16 v[32:35], a[144:147], a[28:31], v[32:35]
s_add_u32 s67, s67, 262144
ds_read_b64_tr_b16 a[130:131], v2 offset:18432
v_mfma_f32_16x16x32_bf16 v[20:23], a[148:151], a[24:27], v[20:23]
s_cmp_eq_u32 s70, 8
s_cselect_b32 s66, s73, s66
ds_read_b64_tr_b16 a[132:133], v3 offset:16384
v_mfma_f32_16x16x32_bf16 v[36:39], a[148:151], a[28:31], v[36:39]
s_cselect_b32 s67, s72, s67
ds_read_b64_tr_b16 a[134:135], v3 offset:18432
v_mfma_f32_16x16x32_bf16 v[24:27], a[152:155], a[24:27], v[24:27]
s_cselect_b32 s36, s14, s36
ds_read_b64_tr_b16 a[136:137], v4 offset:16384
v_mfma_f32_16x16x32_bf16 v[40:43], a[152:155], a[28:31], v[40:43]
s_cselect_b32 s37, s15, s37
s_cselect_b32 s38, 8388608, s38
ds_read_b64_tr_b16 a[138:139], v4 offset:18432
v_mfma_f32_16x16x32_bf16 v[28:31], a[156:159], a[24:27], v[28:31]
s_cmp_eq_u32 s70, 40
ds_read_b64_tr_b16 a[140:141], v5 offset:16384
v_mfma_f32_16x16x32_bf16 v[44:47], a[156:159], a[28:31], v[44:47]
s_waitcnt lgkmcnt(5)
s_cselect_b32 s34, 0, s34
ds_read_b64_tr_b16 a[142:143], v5 offset:18432
v_mfma_f32_16x16x32_bf16 v[16:19], a[128:131], a[32:35], v[16:19]
s_add_u32 m0, s68, 0
s_add_u32 s69, s67, 0
ds_read_b64_tr_b16 a[144:145], v2 offset:20480
v_mfma_f32_16x16x32_bf16 v[32:35], a[128:131], a[36:39], v[32:35]
s_waitcnt lgkmcnt(5)
ds_read_b64_tr_b16 a[146:147], v2 offset:22528
buffer_load_dwordx4 v6, s[36:39], s69 offen lds
v_mfma_f32_16x16x32_bf16 v[20:23], a[132:135], a[32:35], v[20:23]
s_add_u32 m0, s68, 1024
s_add_u32 s69, s67, 16384
ds_read_b64_tr_b16 a[148:149], v3 offset:20480
v_mfma_f32_16x16x32_bf16 v[36:39], a[132:135], a[36:39], v[36:39]
s_waitcnt lgkmcnt(5)
ds_read_b64_tr_b16 a[150:151], v3 offset:22528
buffer_load_dwordx4 v6, s[36:39], s69 offen lds
v_mfma_f32_16x16x32_bf16 v[24:27], a[136:139], a[32:35], v[24:27]
s_add_u32 m0, s68, 2048
s_add_u32 s69, s67, 32768
ds_read_b64_tr_b16 a[152:153], v4 offset:20480
v_mfma_f32_16x16x32_bf16 v[40:43], a[136:139], a[36:39], v[40:43]
s_waitcnt lgkmcnt(5)
ds_read_b64_tr_b16 a[154:155], v4 offset:22528
buffer_load_dwordx4 v6, s[36:39], s69 offen lds
v_mfma_f32_16x16x32_bf16 v[28:31], a[140:143], a[32:35], v[28:31]
s_add_u32 m0, s68, 3072
s_add_u32 s69, s67, 49152
ds_read_b64_tr_b16 a[156:157], v5 offset:20480
v_mfma_f32_16x16x32_bf16 v[44:47], a[140:143], a[36:39], v[44:47]
s_waitcnt lgkmcnt(5)
ds_read_b64_tr_b16 a[158:159], v5 offset:22528
buffer_load_dwordx4 v6, s[36:39], s69 offen lds
v_mfma_f32_16x16x32_bf16 v[16:19], a[144:147], a[40:43], v[16:19]
s_add_u32 s71, s66, 0
ds_read_b64_tr_b16 a[128:129], v2 offset:24576
v_mfma_f32_16x16x32_bf16 v[32:35], a[144:147], a[44:47], v[32:35]
s_waitcnt lgkmcnt(5)
ds_read_b64_tr_b16 a[130:131], v2 offset:26624
buffer_load_dwordx4 a[0:3], v7, s[32:35], s71 offen offset:0
v_mfma_f32_16x16x32_bf16 v[20:23], a[148:151], a[40:43], v[20:23]
ds_read_b64_tr_b16 a[132:133], v3 offset:24576
v_mfma_f32_16x16x32_bf16 v[36:39], a[148:151], a[44:47], v[36:39]
s_waitcnt lgkmcnt(5)
ds_read_b64_tr_b16 a[134:135], v3 offset:26624
buffer_load_dwordx4 a[4:7], v7, s[32:35], s71 offen offset:1024
v_mfma_f32_16x16x32_bf16 v[24:27], a[152:155], a[40:43], v[24:27]
s_add_u32 s71, s66, 8192
ds_read_b64_tr_b16 a[136:137], v4 offset:24576
v_mfma_f32_16x16x32_bf16 v[40:43], a[152:155], a[44:47], v[40:43]
s_waitcnt lgkmcnt(5)
ds_read_b64_tr_b16 a[138:139], v4 offset:26624
buffer_load_dwordx4 a[8:11], v7, s[32:35], s71 offen offset:0
v_mfma_f32_16x16x32_bf16 v[28:31], a[156:159], a[40:43], v[28:31]
ds_read_b64_tr_b16 a[140:141], v5 offset:24576
v_mfma_f32_16x16x32_bf16 v[44:47], a[156:159], a[44:47], v[44:47]
s_waitcnt lgkmcnt(5)
ds_read_b64_tr_b16 a[142:143], v5 offset:26624
buffer_load_dwordx4 a[12:15], v7, s[32:35], s71 offen offset:1024
v_mfma_f32_16x16x32_bf16 v[16:19], a[128:131], a[48:51], v[16:19]
s_add_u32 s71, s66, 16384
ds_read_b64_tr_b16 a[144:145], v2 offset:28672
v_mfma_f32_16x16x32_bf16 v[32:35], a[128:131], a[52:55], v[32:35]
s_waitcnt lgkmcnt(5)
ds_read_b64_tr_b16 a[146:147], v2 offset:30720
buffer_load_dwordx4 a[16:19], v7, s[32:35], s71 offen offset:0
v_mfma_f32_16x16x32_bf16 v[20:23], a[132:135], a[48:51], v[20:23]
ds_read_b64_tr_b16 a[148:149], v3 offset:28672
v_mfma_f32_16x16x32_bf16 v[36:39], a[132:135], a[52:55], v[36:39]
s_waitcnt lgkmcnt(5)
ds_read_b64_tr_b16 a[150:151], v3 offset:30720
buffer_load_dwordx4 a[20:23], v7, s[32:35], s71 offen offset:1024
v_mfma_f32_16x16x32_bf16 v[24:27], a[136:139], a[48:51], v[24:27]
s_add_u32 s71, s66, 24576
ds_read_b64_tr_b16 a[152:153], v4 offset:28672
v_mfma_f32_16x16x32_bf16 v[40:43], a[136:139], a[52:55], v[40:43]
s_waitcnt lgkmcnt(5)
ds_read_b64_tr_b16 a[154:155], v4 offset:30720
buffer_load_dwordx4 a[24:27], v7, s[32:35], s71 offen offset:0
v_mfma_f32_16x16x32_bf16 v[28:31], a[140:143], a[48:51], v[28:31]
ds_read_b64_tr_b16 a[156:157], v5 offset:28672
v_mfma_f32_16x16x32_bf16 v[44:47], a[140:143], a[52:55], v[44:47]
ds_read_b64_tr_b16 a[158:159], v5 offset:30720
buffer_load_dwordx4 a[28:31], v7, s[32:35], s71 offen offset:1024
s_waitcnt vmcnt(24) lgkmcnt(0)
s_barrier
v_mfma_f32_16x16x32_bf16 v[16:19], a[144:147], a[56:59], v[16:19]
s_add_u32 s70, s70, 1
s_add_u32 s66, s66, 32768
ds_read_b64_tr_b16 a[128:129], v2 offset:32768
v_mfma_f32_16x16x32_bf16 v[32:35], a[144:147], a[60:63], v[32:35]
s_add_u32 s67, s67, 262144
ds_read_b64_tr_b16 a[130:131], v2 offset:34816
v_mfma_f32_16x16x32_bf16 v[20:23], a[148:151], a[56:59], v[20:23]
s_cmp_eq_u32 s70, 8
s_cselect_b32 s66, s73, s66
ds_read_b64_tr_b16 a[132:133], v3 offset:32768
v_mfma_f32_16x16x32_bf16 v[36:39], a[148:151], a[60:63], v[36:39]
s_cselect_b32 s67, s72, s67
ds_read_b64_tr_b16 a[134:135], v3 offset:34816
v_mfma_f32_16x16x32_bf16 v[24:27], a[152:155], a[56:59], v[24:27]
s_cselect_b32 s36, s14, s36
ds_read_b64_tr_b16 a[136:137], v4 offset:32768
v_mfma_f32_16x16x32_bf16 v[40:43], a[152:155], a[60:63], v[40:43]
s_cselect_b32 s37, s15, s37
s_cselect_b32 s38, 8388608, s38
ds_read_b64_tr_b16 a[138:139], v4 offset:34816
v_mfma_f32_16x16x32_bf16 v[28:31], a[156:159], a[56:59], v[28:31]
s_cmp_eq_u32 s70, 40
ds_read_b64_tr_b16 a[140:141], v5 offset:32768
v_mfma_f32_16x16x32_bf16 v[44:47], a[156:159], a[60:63], v[44:47]
s_waitcnt lgkmcnt(5)
s_cselect_b32 s34, 0, s34
ds_read_b64_tr_b16 a[142:143], v5 offset:34816
v_mfma_f32_16x16x32_bf16 v[16:19], a[128:131], a[64:67], v[16:19]
s_add_u32 m0, s68, 16384
s_add_u32 s69, s67, 0
ds_read_b64_tr_b16 a[144:145], v2 offset:36864
v_mfma_f32_16x16x32_bf16 v[32:35], a[128:131], a[68:71], v[32:35]
s_waitcnt lgkmcnt(5)
ds_read_b64_tr_b16 a[146:147], v2 offset:38912
buffer_load_dwordx4 v6, s[36:39], s69 offen lds
v_mfma_f32_16x16x32_bf16 v[20:23], a[132:135], a[64:67], v[20:23]
s_add_u32 m0, s68, 17408
s_add_u32 s69, s67, 16384
ds_read_b64_tr_b16 a[148:149], v3 offset:36864
v_mfma_f32_16x16x32_bf16 v[36:39], a[132:135], a[68:71], v[36:39]
s_waitcnt lgkmcnt(5)
ds_read_b64_tr_b16 a[150:151], v3 offset:38912
buffer_load_dwordx4 v6, s[36:39], s69 offen lds
v_mfma_f32_16x16x32_bf16 v[24:27], a[136:139], a[64:67], v[24:27]
s_add_u32 m0, s68, 18432
s_add_u32 s69, s67, 32768
ds_read_b64_tr_b16 a[152:153], v4 offset:36864
v_mfma_f32_16x16x32_bf16 v[40:43], a[136:139], a[68:71], v[40:43]
s_waitcnt lgkmcnt(5)
ds_read_b64_tr_b16 a[154:155], v4 offset:38912
buffer_load_dwordx4 v6, s[36:39], s69 offen lds
v_mfma_f32_16x16x32_bf16 v[28:31], a[140:143], a[64:67], v[28:31]
s_add_u32 m0, s68, 19456
s_add_u32 s69, s67, 49152
ds_read_b64_tr_b16 a[156:157], v5 offset:36864
v_mfma_f32_16x16x32_bf16 v[44:47], a[140:143], a[68:71], v[44:47]
s_waitcnt lgkmcnt(5)
ds_read_b64_tr_b16 a[158:159], v5 offset:38912
buffer_load_dwordx4 v6, s[36:39], s69 offen lds
v_mfma_f32_16x16x32_bf16 v[16:19], a[144:147], a[72:75], v[16:19]
s_add_u32 s71, s66, 0
ds_read_b64_tr_b16 a[128:129], v2 offset:40960
v_mfma_f32_16x16x32_bf16 v[32:35], a[144:147], a[76:79], v[32:35]
s_waitcnt lgkmcnt(5)
ds_read_b64_tr_b16 a[130:131], v2 offset:43008
buffer_load_dwordx4 a[32:35], v7, s[32:35], s71 offen offset:0
v_mfma_f32_16x16x32_bf16 v[20:23], a[148:151], a[72:75], v[20:23]
ds_read_b64_tr_b16 a[132:133], v3 offset:40960
v_mfma_f32_16x16x32_bf16 v[36:39], a[148:151], a[76:79], v[36:39]
s_waitcnt lgkmcnt(5)
ds_read_b64_tr_b16 a[134:135], v3 offset:43008
buffer_load_dwordx4 a[36:39], v7, s[32:35], s71 offen offset:1024
v_mfma_f32_16x16x32_bf16 v[24:27], a[152:155], a[72:75], v[24:27]
s_add_u32 s71, s66, 8192
ds_read_b64_tr_b16 a[136:137], v4 offset:40960
v_mfma_f32_16x16x32_bf16 v[40:43], a[152:155], a[76:79], v[40:43]
s_waitcnt lgkmcnt(5)
ds_read_b64_tr_b16 a[138:139], v4 offset:43008
buffer_load_dwordx4 a[40:43], v7, s[32:35], s71 offen offset:0
v_mfma_f32_16x16x32_bf16 v[28:31], a[156:159], a[72:75], v[28:31]
ds_read_b64_tr_b16 a[140:141], v5 offset:40960
v_mfma_f32_16x16x32_bf16 v[44:47], a[156:159], a[76:79], v[44:47]
s_waitcnt lgkmcnt(5)
ds_read_b64_tr_b16 a[142:143], v5 offset:43008
buffer_load_dwordx4 a[44:47], v7, s[32:35], s71 offen offset:1024
v_mfma_f32_16x16x32_bf16 v[16:19], a[128:131], a[80:83], v[16:19]
s_add_u32 s71, s66, 16384
ds_read_b64_tr_b16 a[144:145], v2 offset:45056
v_mfma_f32_16x16x32_bf16 v[32:35], a[128:131], a[84:87], v[32:35]
s_waitcnt lgkmcnt(5)
ds_read_b64_tr_b16 a[146:147], v2 offset:47104
buffer_load_dwordx4 a[48:51], v7, s[32:35], s71 offen offset:0
v_mfma_f32_16x16x32_bf16 v[20:23], a[132:135], a[80:83], v[20:23]
ds_read_b64_tr_b16 a[148:149], v3 offset:45056
v_mfma_f32_16x16x32_bf16 v[36:39], a[132:135], a[84:87], v[36:39]
s_waitcnt lgkmcnt(5)
ds_read_b64_tr_b16 a[150:151], v3 offset:47104
buffer_load_dwordx4 a[52:55], v7, s[32:35], s71 offen offset:1024
v_mfma_f32_16x16x32_bf16 v[24:27], a[136:139], a[80:83], v[24:27]
s_add_u32 s71, s66, 24576
ds_read_b64_tr_b16 a[152:153], v4 offset:45056
v_mfma_f32_16x16x32_bf16 v[40:43], a[136:139], a[84:87], v[40:43]
s_waitcnt lgkmcnt(5)
ds_read_b64_tr_b16 a[154:155], v4 offset:47104
buffer_load_dwordx4 a[56:59], v7, s[32:35], s71 offen offset:0
v_mfma_f32_16x16x32_bf16 v[28:31], a[140:143], a[80:83], v[28:31]
ds_read_b64_tr_b16 a[156:157], v5 offset:45056
v_mfma_f32_16x16x32_bf16 v[44:47], a[140:143], a[84:87], v[44:47]
ds_read_b64_tr_b16 a[158:159], v5 offset:47104
buffer_load_dwordx4 a[60:63], v7, s[32:35], s71 offen offset:1024
s_waitcnt vmcnt(24) lgkmcnt(0)
s_barrier
v_mfma_f32_16x16x32_bf16 v[16:19], a[144:147], a[88:91], v[16:19]
s_add_u32 s70, s70, 1
s_add_u32 s66, s66, 32768
ds_read_b64_tr_b16 a[128:129], v2 offset:49152
v_mfma_f32_16x16x32_bf16 v[32:35], a[144:147], a[92:95], v[32:35]
s_add_u32 s67, s67, 262144
ds_read_b64_tr_b16 a[130:131], v2 offset:51200
v_mfma_f32_16x16x32_bf16 v[20:23], a[148:151], a[88:91], v[20:23]
s_cmp_eq_u32 s70, 8
s_cselect_b32 s66, s73, s66
ds_read_b64_tr_b16 a[132:133], v3 offset:49152
v_mfma_f32_16x16x32_bf16 v[36:39], a[148:151], a[92:95], v[36:39]
s_cselect_b32 s67, s72, s67
ds_read_b64_tr_b16 a[134:135], v3 offset:51200
v_mfma_f32_16x16x32_bf16 v[24:27], a[152:155], a[88:91], v[24:27]
s_cselect_b32 s36, s14, s36
ds_read_b64_tr_b16 a[136:137], v4 offset:49152
v_mfma_f32_16x16x32_bf16 v[40:43], a[152:155], a[92:95], v[40:43]
s_cselect_b32 s37, s15, s37
s_cselect_b32 s38, 8388608, s38
ds_read_b64_tr_b16 a[138:139], v4 offset:51200
v_mfma_f32_16x16x32_bf16 v[28:31], a[156:159], a[88:91], v[28:31]
s_cmp_eq_u32 s70, 40
ds_read_b64_tr_b16 a[140:141], v5 offset:49152
v_mfma_f32_16x16x32_bf16 v[44:47], a[156:159], a[92:95], v[44:47]
s_waitcnt lgkmcnt(5)
s_cselect_b32 s34, 0, s34
ds_read_b64_tr_b16 a[142:143], v5 offset:51200
v_mfma_f32_16x16x32_bf16 v[16:19], a[128:131], a[96:99], v[16:19]
s_add_u32 m0, s68, 32768
s_add_u32 s69, s67, 0
ds_read_b64_tr_b16 a[144:145], v2 offset:53248
v_mfma_f32_16x16x32_bf16 v[32:35], a[128:131], a[100:103], v[32:35]
s_waitcnt lgkmcnt(5)
ds_read_b64_tr_b16 a[146:147], v2 offset:55296
buffer_load_dwordx4 v6, s[36:39], s69 offen lds
v_mfma_f32_16x16x32_bf16 v[20:23], a[132:135], a[96:99], v[20:23]
s_add_u32 m0, s68, 33792
s_add_u32 s69, s67, 16384
ds_read_b64_tr_b16 a[148:149], v3 offset:53248
v_mfma_f32_16x16x32_bf16 v[36:39], a[132:135], a[100:103], v[36:39]
s_waitcnt lgkmcnt(5)
ds_read_b64_tr_b16 a[150:151], v3 offset:55296
buffer_load_dwordx4 v6, s[36:39], s69 offen lds
v_mfma_f32_16x16x32_bf16 v[24:27], a[136:139], a[96:99], v[24:27]
s_add_u32 m0, s68, 34816
s_add_u32 s69, s67, 32768
ds_read_b64_tr_b16 a[152:153], v4 offset:53248
v_mfma_f32_16x16x32_bf16 v[40:43], a[136:139], a[100:103], v[40:43]
s_waitcnt lgkmcnt(5)
ds_read_b64_tr_b16 a[154:155], v4 offset:55296
buffer_load_dwordx4 v6, s[36:39], s69 offen lds
v_mfma_f32_16x16x32_bf16 v[28:31], a[140:143], a[96:99], v[28:31]
s_add_u32 m0, s68, 35840
s_add_u32 s69, s67, 49152
ds_read_b64_tr_b16 a[156:157], v5 offset:53248
v_mfma_f32_16x16x32_bf16 v[44:47], a[140:143], a[100:103], v[44:47]
s_waitcnt lgkmcnt(5)
ds_read_b64_tr_b16 a[158:159], v5 offset:55296
buffer_load_dwordx4 v6, s[36:39], s69 offen lds
v_mfma_f32_16x16x32_bf16 v[16:19], a[144:147], a[104:107], v[16:19]
s_add_u32 s71, s66, 0
ds_read_b64_tr_b16 a[128:129], v2 offset:57344
v_mfma_f32_16x16x32_bf16 v[32:35], a[144:147], a[108:111], v[32:35]
s_waitcnt lgkmcnt(5)
ds_read_b64_tr_b16 a[130:131], v2 offset:59392
buffer_load_dwordx4 a[64:67], v7, s[32:35], s71 offen offset:0
v_mfma_f32_16x16x32_bf16 v[20:23], a[148:151], a[104:107], v[20:23]
ds_read_b64_tr_b16 a[132:133], v3 offset:57344
v_mfma_f32_16x16x32_bf16 v[36:39], a[148:151], a[108:111], v[36:39]
s_waitcnt lgkmcnt(5)
ds_read_b64_tr_b16 a[134:135], v3 offset:59392
buffer_load_dwordx4 a[68:71], v7, s[32:35], s71 offen offset:1024
v_mfma_f32_16x16x32_bf16 v[24:27], a[152:155], a[104:107], v[24:27]
s_add_u32 s71, s66, 8192
ds_read_b64_tr_b16 a[136:137], v4 offset:57344
v_mfma_f32_16x16x32_bf16 v[40:43], a[152:155], a[108:111], v[40:43]
s_waitcnt lgkmcnt(5)
ds_read_b64_tr_b16 a[138:139], v4 offset:59392
buffer_load_dwordx4 a[72:75], v7, s[32:35], s71 offen offset:0
v_mfma_f32_16x16x32_bf16 v[28:31], a[156:159], a[104:107], v[28:31]
ds_read_b64_tr_b16 a[140:141], v5 offset:57344
v_mfma_f32_16x16x32_bf16 v[44:47], a[156:159], a[108:111], v[44:47]
s_waitcnt lgkmcnt(5)
ds_read_b64_tr_b16 a[142:143], v5 offset:59392
buffer_load_dwordx4 a[76:79], v7, s[32:35], s71 offen offset:1024
v_mfma_f32_16x16x32_bf16 v[16:19], a[128:131], a[112:115], v[16:19]
s_add_u32 s71, s66, 16384
ds_read_b64_tr_b16 a[144:145], v2 offset:61440
v_mfma_f32_16x16x32_bf16 v[32:35], a[128:131], a[116:119], v[32:35]
s_waitcnt lgkmcnt(5)
ds_read_b64_tr_b16 a[146:147], v2 offset:63488
buffer_load_dwordx4 a[80:83], v7, s[32:35], s71 offen offset:0
v_mfma_f32_16x16x32_bf16 v[20:23], a[132:135], a[112:115], v[20:23]
ds_read_b64_tr_b16 a[148:149], v3 offset:61440
v_mfma_f32_16x16x32_bf16 v[36:39], a[132:135], a[116:119], v[36:39]
s_waitcnt lgkmcnt(5)
ds_read_b64_tr_b16 a[150:151], v3 offset:63488
buffer_load_dwordx4 a[84:87], v7, s[32:35], s71 offen offset:1024
v_mfma_f32_16x16x32_bf16 v[24:27], a[136:139], a[112:115], v[24:27]
s_add_u32 s71, s66, 24576
ds_read_b64_tr_b16 a[152:153], v4 offset:61440
v_mfma_f32_16x16x32_bf16 v[40:43], a[136:139], a[116:119], v[40:43]
s_waitcnt lgkmcnt(5)
ds_read_b64_tr_b16 a[154:155], v4 offset:63488
buffer_load_dwordx4 a[88:91], v7, s[32:35], s71 offen offset:0
v_mfma_f32_16x16x32_bf16 v[28:31], a[140:143], a[112:115], v[28:31]
ds_read_b64_tr_b16 a[156:157], v5 offset:61440
v_mfma_f32_16x16x32_bf16 v[44:47], a[140:143], a[116:119], v[44:47]
ds_read_b64_tr_b16 a[158:159], v5 offset:63488
buffer_load_dwordx4 a[92:95], v7, s[32:35], s71 offen offset:1024
s_waitcnt vmcnt(24) lgkmcnt(0)
s_barrier
v_mfma_f32_16x16x32_bf16 v[16:19], a[144:147], a[120:123], v[16:19]
s_add_u32 s70, s70, 1
s_add_u32 s66, s66, 32768
ds_read_b64_tr_b16 a[128:129], v2 offset:0
v_mfma_f32_16x16x32_bf16 v[32:35], a[144:147], a[124:127], v[32:35]
s_add_u32 s67, s67, 262144
ds_read_b64_tr_b16 a[130:131], v2 offset:2048
v_mfma_f32_16x16x32_bf16 v[20:23], a[148:151], a[120:123], v[20:23]
s_cmp_eq_u32 s70, 8
s_cselect_b32 s66, s73, s66
ds_read_b64_tr_b16 a[132:133], v3 offset:0
v_mfma_f32_16x16x32_bf16 v[36:39], a[148:151], a[124:127], v[36:39]
s_cselect_b32 s67, s72, s67
ds_read_b64_tr_b16 a[134:135], v3 offset:2048
v_mfma_f32_16x16x32_bf16 v[24:27], a[152:155], a[120:123], v[24:27]
s_cselect_b32 s36, s14, s36
ds_read_b64_tr_b16 a[136:137], v4 offset:0
v_mfma_f32_16x16x32_bf16 v[40:43], a[152:155], a[124:127], v[40:43]
s_cselect_b32 s37, s15, s37
s_cselect_b32 s38, 8388608, s38
ds_read_b64_tr_b16 a[138:139], v4 offset:2048
v_mfma_f32_16x16x32_bf16 v[28:31], a[156:159], a[120:123], v[28:31]
s_cmp_eq_u32 s70, 40
ds_read_b64_tr_b16 a[140:141], v5 offset:0
v_mfma_f32_16x16x32_bf16 v[44:47], a[156:159], a[124:127], v[44:47]
s_cselect_b32 s34, 0, s34
ds_read_b64_tr_b16 a[142:143], v5 offset:2048
s_cmp_lt_u32 s70, 43
s_cbranch_scc1 L_p5_57
s_mov_b32 s44, s24
s_mov_b32 s45, s25
s_mov_b32 s46, 4194304
s_mov_b32 s47, 0x20000
s_lshl_b32 s52, s64, 18
s_lshl_b32 s53, s30, 16
s_add_u32 s52, s52, s53
s_lshl_b32 s53, s65, 7
s_add_u32 s52, s52, s53
s_add_u32 s53, s52, 32768
v_and_b32 v8, 15, v0
v_lshlrev_b32 v8, 11, v8
v_bfe_u32 v10, v0, 4, 1
v_lshl_add_u32 v8, v10, 5, v8
v_lshrrev_b32 v10, 5, v0
v_lshl_add_u32 v8, v10, 4, v8
v_cvt_pk_bf16_f32 v16, v16, v17
v_cvt_pk_bf16_f32 v17, v18, v19
v_cvt_pk_bf16_f32 v18, v20, v21
v_cvt_pk_bf16_f32 v19, v22, v23
s_nop 1
v_permlane16_swap_b32 v16, v18
v_permlane16_swap_b32 v17, v19
buffer_store_dwordx4 v[16:19], v8, s[44:47], s52 offen offset:0
v_cvt_pk_bf16_f32 v24, v24, v25
v_cvt_pk_bf16_f32 v25, v26, v27
v_cvt_pk_bf16_f32 v26, v28, v29
v_cvt_pk_bf16_f32 v27, v30, v31
s_nop 1
v_permlane16_swap_b32 v24, v26
v_permlane16_swap_b32 v25, v27
buffer_store_dwordx4 v[24:27], v8, s[44:47], s52 offen offset:64
v_cvt_pk_bf16_f32 v32, v32, v33
v_cvt_pk_bf16_f32 v33, v34, v35
v_cvt_pk_bf16_f32 v34, v36, v37
v_cvt_pk_bf16_f32 v35, v38, v39
s_nop 1
v_permlane16_swap_b32 v32, v34
v_permlane16_swap_b32 v33, v35
buffer_store_dwordx4 v[32:35], v8, s[44:47], s53 offen offset:0
v_cvt_pk_bf16_f32 v40, v40, v41
v_cvt_pk_bf16_f32 v41, v42, v43
v_cvt_pk_bf16_f32 v42, v44, v45
v_cvt_pk_bf16_f32 v43, v46, v47
s_nop 1
v_permlane16_swap_b32 v40, v42
v_permlane16_swap_b32 v41, v43
buffer_store_dwordx4 v[40:43], v8, s[44:47], s53 offen offset:64
s_waitcnt vmcnt(0) lgkmcnt(0)
L_end_56:
s_endpgm
.section .rodata,"a"
.p2align 6
.amdhsa_kernel k1_kernel
  .amdhsa_next_free_vgpr 512
  .amdhsa_next_free_sgpr 102
  .amdhsa_accum_offset 256
  .amdhsa_group_segment_fixed_size 0
  .amdhsa_kernarg_size 104
  .amdhsa_user_sgpr_count 2
  .amdhsa_user_sgpr_kernarg_segment_ptr 1
  .amdhsa_system_sgpr_workgroup_id_x 1
.end_amdhsa_kernel
.p2align 6
.amdhsa_kernel k2_kernel
  .amdhsa_next_free_vgpr 512
  .amdhsa_next_free_sgpr 102
  .amdhsa_accum_offset 256
  .amdhsa_group_segment_fixed_size 0
  .amdhsa_kernarg_size 104
  .amdhsa_user_sgpr_count 2
  .amdhsa_user_sgpr_kernarg_segment_ptr 1
  .amdhsa_system_sgpr_workgroup_id_x 1
.end_amdhsa_kernel
.p2align 6
.amdhsa_kernel k3_kernel
  .amdhsa_next_free_vgpr 512
  .amdhsa_next_free_sgpr 102
  .amdhsa_accum_offset 256
  .amdhsa_group_segment_fixed_size 0
  .amdhsa_kernarg_size 104
  .amdhsa_user_sgpr_count 2
  .amdhsa_user_sgpr_kernarg_segment_ptr 1
  .amdhsa_system_sgpr_workgroup_id_x 1
.end_amdhsa_kernel
```

```asm
; @launch grid=(256,1,1) block=(256,1,1) lds=163840
.amdgcn_target "amdgcn-amd-amdhsa--gfx950"
.text
.globl gated_mix__compressed_kv_cla__sliding_local_dilated__prompt_kernel
.p2align 8
.type gated_mix__compressed_kv_cla__sliding_local_dilated__prompt_kernel,@function
gated_mix__compressed_kv_cla__sliding_local_dilated__prompt_kernel:
s_cmp_ge_u32 s2, 256
s_cbranch_scc1 L_end
s_load_dwordx16 s[4:19], s[0:1], 0
s_load_dwordx8 s[20:27], s[0:1], 64
s_load_dwordx2 s[28:29], s[0:1], 96
s_getpc_b64 s[90:91]
L_pc:
v_lshrrev_b32 v1, 6, v0
v_and_b32 v0, 63, v0
v_readfirstlane_b32 s30, v1
v_lshrrev_b32 v24, 3, v0
v_lshrrev_b32 v25, 4, v0
v_and_b32 v26, 7, v0
v_xor_b32 v26, v26, v25
v_lshlrev_b32 v26, 4, v26
v_lshl_add_u32 v12, v24, 10, v26
v_xor_b32 v13, 64, v12
v_bfe_u32 v26, v0, 1, 3
v_xor_b32 v26, v26, v25
v_lshlrev_b32 v26, 5, v26
v_and_b32 v24, 1, v0
v_lshl_add_u32 v26, v24, 4, v26
v_lshl_add_u32 v14, v25, 13, v26
v_xor_b32 v15, 128, v14
s_and_b32 s66, s2, 7
s_lshr_b32 s67, s2, 3
s_and_b32 s68, s67, 3
s_lshl2_add_u32 s31, s66, s68
s_lshr_b32 s3, s67, 2
s_lshl2_add_u32 s80, s67, s30
s_lshl_b32 s70, s3, 18
s_lshl_b32 s66, s30, 16
s_add_u32 s70, s70, s66
s_lshl_b32 s71, s30, 17
s_lshl_b32 s66, s31, 8
s_add_u32 s71, s71, s66
s_lshl_b32 s76, s30, 13
s_lshl_b32 s77, s30, 12
s_lshl_b32 s78, s30, 10
s_waitcnt lgkmcnt(0)
s_mov_b32 s32, s6
s_mov_b32 s33, s7
s_mov_b32 s34, 2097152
s_mov_b32 s35, 0x20000
s_mov_b32 s36, s10
s_mov_b32 s37, s11
s_mov_b32 s38, 4194304
s_mov_b32 s39, 0x20000
s_mov_b32 s40, s12
s_mov_b32 s41, s13
s_mov_b32 s42, 4194304
s_mov_b32 s43, 0x20000
s_add_u32 m0, s76, 0
s_add_u32 s64, s70, 0
buffer_load_dwordx4 v12, s[32:35], s64 offen lds
s_add_u32 m0, s76, 1024
s_add_u32 s64, s70, 8192
buffer_load_dwordx4 v13, s[32:35], s64 offen lds
s_add_u32 m0, s76, 2048
s_add_u32 s64, s70, 16384
buffer_load_dwordx4 v12, s[32:35], s64 offen lds
s_add_u32 m0, s76, 3072
s_add_u32 s64, s70, 24576
buffer_load_dwordx4 v13, s[32:35], s64 offen lds
s_add_u32 m0, s76, 4096
s_add_u32 s64, s70, 32768
buffer_load_dwordx4 v12, s[32:35], s64 offen lds
s_add_u32 m0, s76, 5120
s_add_u32 s64, s70, 40960
buffer_load_dwordx4 v13, s[32:35], s64 offen lds
s_add_u32 m0, s76, 6144
s_add_u32 s64, s70, 49152
buffer_load_dwordx4 v12, s[32:35], s64 offen lds
s_add_u32 m0, s76, 7168
s_add_u32 s64, s70, 57344
buffer_load_dwordx4 v13, s[32:35], s64 offen lds
s_add_u32 m0, s77, 65536
s_add_u32 s64, s71, 0
buffer_load_dwordx4 v14, s[36:39], s64 offen lds
s_add_u32 m0, s77, 66560
s_add_u32 s64, s71, 32768
buffer_load_dwordx4 v14, s[36:39], s64 offen lds
s_add_u32 m0, s77, 67584
s_add_u32 s64, s71, 65536
buffer_load_dwordx4 v15, s[36:39], s64 offen lds
s_add_u32 m0, s77, 68608
s_add_u32 s64, s71, 98304
buffer_load_dwordx4 v15, s[36:39], s64 offen lds
s_add_u32 m0, s77, 81920
s_add_u32 s64, s71, 0
buffer_load_dwordx4 v14, s[40:43], s64 offen lds
s_add_u32 m0, s77, 82944
s_add_u32 s64, s71, 32768
buffer_load_dwordx4 v14, s[40:43], s64 offen lds
s_add_u32 m0, s77, 83968
s_add_u32 s64, s71, 65536
buffer_load_dwordx4 v15, s[40:43], s64 offen lds
s_add_u32 m0, s77, 84992
s_add_u32 s64, s71, 98304
buffer_load_dwordx4 v15, s[40:43], s64 offen lds
v_lshlrev_b32 v27, 7, v0
s_and_b32 s66, s80, 15
s_min_u32 s66, s66, 13
s_lshl_b32 s66, s66, 13
v_add_u32 v28, s66, v27
global_load_dword a252, v28, s[90:91]
s_add_u32 m0, s76, 32768
s_add_u32 s64, s70, 128
buffer_load_dwordx4 v12, s[32:35], s64 offen lds
s_add_u32 m0, s76, 33792
s_add_u32 s64, s70, 8320
buffer_load_dwordx4 v13, s[32:35], s64 offen lds
s_add_u32 m0, s76, 34816
s_add_u32 s64, s70, 16512
buffer_load_dwordx4 v12, s[32:35], s64 offen lds
s_add_u32 m0, s76, 35840
s_add_u32 s64, s70, 24704
buffer_load_dwordx4 v13, s[32:35], s64 offen lds
s_add_u32 m0, s76, 36864
s_add_u32 s64, s70, 32896
buffer_load_dwordx4 v12, s[32:35], s64 offen lds
s_add_u32 m0, s76, 37888
s_add_u32 s64, s70, 41088
buffer_load_dwordx4 v13, s[32:35], s64 offen lds
s_add_u32 m0, s76, 38912
s_add_u32 s64, s70, 49280
buffer_load_dwordx4 v12, s[32:35], s64 offen lds
s_add_u32 m0, s76, 39936
s_add_u32 s64, s70, 57472
buffer_load_dwordx4 v13, s[32:35], s64 offen lds
s_add_u32 m0, s77, 98304
s_add_u32 s64, s71, 524288
buffer_load_dwordx4 v14, s[36:39], s64 offen lds
s_add_u32 m0, s77, 99328
s_add_u32 s64, s71, 557056
buffer_load_dwordx4 v14, s[36:39], s64 offen lds
s_add_u32 m0, s77, 100352
s_add_u32 s64, s71, 589824
buffer_load_dwordx4 v15, s[36:39], s64 offen lds
s_add_u32 m0, s77, 101376
s_add_u32 s64, s71, 622592
buffer_load_dwordx4 v15, s[36:39], s64 offen lds
s_add_u32 m0, s77, 114688
s_add_u32 s64, s71, 524288
buffer_load_dwordx4 v14, s[40:43], s64 offen lds
s_add_u32 m0, s77, 115712
s_add_u32 s64, s71, 557056
buffer_load_dwordx4 v14, s[40:43], s64 offen lds
s_add_u32 m0, s77, 116736
s_add_u32 s64, s71, 589824
buffer_load_dwordx4 v15, s[40:43], s64 offen lds
s_add_u32 m0, s77, 117760
s_add_u32 s64, s71, 622592
buffer_load_dwordx4 v15, s[40:43], s64 offen lds
s_mov_b32 s44, s28
s_mov_b32 s45, s29
s_mov_b32 s46, 134217728
s_mov_b32 s47, 0x20000
s_mov_b32 s48, s4
s_mov_b32 s49, s5
s_mov_b32 s50, 4194304
s_mov_b32 s51, 0x20000
s_mov_b32 s52, s26
s_mov_b32 s53, s27
s_mov_b32 s54, 256
s_mov_b32 s55, 0x20000
s_mov_b32 s56, s8
s_mov_b32 s57, s9
s_mov_b32 s58, 8388608
s_mov_b32 s59, 0x20000
s_mov_b32 s60, s18
s_mov_b32 s61, s19
s_mov_b32 s62, 6291456
s_mov_b32 s63, 0x20000
s_lshl_b32 s66, s80, 14
buffer_load_dword a252, v27, s[32:35], s66 offen
s_add_u32 s66, s66, 8192
buffer_load_dword a252, v27, s[32:35], s66 offen
v_and_b32 v28, 7, v0
v_lshlrev_b32 v28, 7, v28
v_lshrrev_b32 v29, 3, v0
v_lshl_add_u32 v28, v29, 13, v28
s_and_b32 s66, s80, 63
s_lshl_b32 s66, s66, 16
s_and_b32 s67, s2, 7
s_lshl_b32 s67, s67, 10
s_add_u32 s66, s66, s67
s_cmp_lt_u32 s80, 64
s_cselect_b32 s68, s66, 0x7000000
s_cselect_b32 s69, 0x7000000, s66
buffer_load_dword a252, v28, s[36:39], s68 offen
buffer_load_dword a252, v28, s[40:43], s69 offen
s_lshl_b32 s66, s2, 3
s_lshl1_add_u32 s66, s30, s66
v_lshrrev_b32 v29, 5, v0
v_add_u32 v29, s66, v29
v_and_b32 v30, 31, v0
v_lshlrev_b32 v30, 4, v30
v_lshl_add_u32 v29, v29, 11, v30
global_load_dwordx4 a[128:131], v29, s[4:5] offset:0
global_load_dwordx4 a[132:135], v29, s[4:5] offset:512
global_load_dwordx4 a[136:139], v29, s[4:5] offset:1024
global_load_dwordx4 a[140:143], v29, s[4:5] offset:1536
global_load_dwordx4 a[144:147], v30, s[22:23] offset:0
global_load_dwordx4 a[148:151], v30, s[22:23] offset:512
global_load_dwordx4 a[152:155], v30, s[22:23] offset:1024
global_load_dwordx4 a[156:159], v30, s[22:23] offset:1536
v_mov_b32 v30, 0
s_lshl_b32 s66, s2, 8
s_lshl_b32 s67, s30, 6
s_add_u32 s66, s66, s67
s_add_u32 s66, s66, 59834368
v_cmp_eq_u32 vcc, 0, v0
v_mov_b32 v29, 0x70000000
s_and_b32 s67, s2, 15
v_cndmask_b32 v29, v29, v30, vcc
s_lshl_b32 s67, s67, 8
s_add_u32 s67, s67, 59768832
buffer_store_dword v30, v29, s[44:47], s66 offen sc1
buffer_store_dword v30, v29, s[44:47], s67 offen sc1
v_accvgpr_write_b32 a251, 1
v_and_b32 v24, 15, v0
v_lshrrev_b32 v26, 1, v24
v_xor_b32 v26, v26, v25
v_lshlrev_b32 v26, 4, v26
v_lshl_add_u32 v26, v24, 7, v26
v_add_u32 v2, s76, v26
v_xor_b32 v3, 64, v2
v_bfe_u32 v24, v0, 2, 2
v_lshl_add_u32 v27, v25, 3, v24
v_and_b32 v1, 3, v0
v_lshlrev_b32 v1, 3, v1
v_lshl_add_u32 v26, v27, 8, v1
v_add_u32 v26, 65536, v26
v_and_b32 v1, 1, v25
v_lshl_add_u32 v24, v1, 2, v24
v_lshlrev_b32 v16, 4, v0
v_xor_b32 v1, 0, v24
v_lshl_add_u32 v4, v1, 5, v26
v_xor_b32 v1, 1, v24
v_lshl_add_u32 v5, v1, 5, v26
v_xor_b32 v1, 2, v24
v_lshl_add_u32 v6, v1, 5, v26
v_xor_b32 v1, 3, v24
v_lshl_add_u32 v7, v1, 5, v26
v_xor_b32 v1, 4, v24
v_lshl_add_u32 v8, v1, 5, v26
v_xor_b32 v1, 5, v24
v_lshl_add_u32 v9, v1, 5, v26
v_xor_b32 v1, 6, v24
v_lshl_add_u32 v10, v1, 5, v26
v_xor_b32 v1, 7, v24
v_lshl_add_u32 v11, v1, 5, v26
s_sub_u32 s16, 15, s3
s_lshl_b32 s72, s3, 18
s_lshl_b32 s73, s16, 18
s_cmp_lt_u32 s30, 2
s_cselect_b32 s74, s72, s73
s_max_u32 s74, s74, 32768
s_sub_u32 s74, s74, 32768
s_and_b32 s66, s30, 1
s_lshl_b32 s66, s66, 14
s_add_u32 s74, s74, s66
s_lshl_b32 s66, s30, 15
s_add_u32 s72, s72, s66
s_add_u32 s73, s73, s66
s_mul_i32 s75, s30, 98304
s_lshl_b32 s66, s31, 6
s_add_u32 s75, s75, s66
s_lshl_b32 s79, s31, 20
s_lshl_b32 s66, s3, 17
s_add_u32 s79, s79, s66
s_lshl_b32 s66, s30, 15
s_add_u32 s79, s79, s66
s_waitcnt vmcnt(31)
s_barrier
ds_read_b128 a[0:3], v2 offset:0
ds_read_b128 a[4:7], v2 offset:2048
ds_read_b128 a[8:11], v2 offset:4096
ds_read_b128 a[12:15], v2 offset:6144
ds_read_b64_tr_b16 a[40:41], v4 offset:0
ds_read_b64_tr_b16 a[42:43], v4 offset:1024
ds_read_b64_tr_b16 a[44:45], v5 offset:0
ds_read_b64_tr_b16 a[46:47], v5 offset:1024
ds_read_b64_tr_b16 a[48:49], v6 offset:0
ds_read_b64_tr_b16 a[50:51], v6 offset:1024
ds_read_b64_tr_b16 a[52:53], v7 offset:0
ds_read_b64_tr_b16 a[54:55], v7 offset:1024
ds_read_b64_tr_b16 a[56:57], v8 offset:0
ds_read_b64_tr_b16 a[58:59], v8 offset:1024
ds_read_b64_tr_b16 a[60:61], v9 offset:0
ds_read_b64_tr_b16 a[62:63], v9 offset:1024
ds_read_b64_tr_b16 a[64:65], v10 offset:0
ds_read_b64_tr_b16 a[66:67], v10 offset:1024
ds_read_b64_tr_b16 a[68:69], v11 offset:0
ds_read_b64_tr_b16 a[70:71], v11 offset:1024
ds_read_b64_tr_b16 a[72:73], v4 offset:16384
ds_read_b64_tr_b16 a[74:75], v4 offset:17408
ds_read_b64_tr_b16 a[76:77], v5 offset:16384
ds_read_b64_tr_b16 a[78:79], v5 offset:17408
ds_read_b64_tr_b16 a[80:81], v6 offset:16384
ds_read_b64_tr_b16 a[82:83], v6 offset:17408
ds_read_b64_tr_b16 a[84:85], v7 offset:16384
ds_read_b64_tr_b16 a[86:87], v7 offset:17408
ds_read_b64_tr_b16 a[88:89], v8 offset:16384
ds_read_b64_tr_b16 a[90:91], v8 offset:17408
ds_read_b64_tr_b16 a[92:93], v9 offset:16384
ds_read_b64_tr_b16 a[94:95], v9 offset:17408
ds_read_b64_tr_b16 a[96:97], v10 offset:16384
ds_read_b64_tr_b16 a[98:99], v10 offset:17408
ds_read_b64_tr_b16 a[100:101], v11 offset:16384
ds_read_b64_tr_b16 a[102:103], v11 offset:17408
s_waitcnt lgkmcnt(15)
v_mfma_f32_16x16x32_bf16 v[24:27], a[40:43], a[0:3], 0
ds_read_b128 a[20:23], v3 offset:0
v_mfma_f32_16x16x32_bf16 v[40:43], a[40:43], a[4:7], 0
ds_read_b128 a[24:27], v3 offset:2048
v_mfma_f32_16x16x32_bf16 v[56:59], a[40:43], a[8:11], 0
ds_read_b128 a[28:31], v3 offset:4096
v_lshlrev_b32 v22, 7, v0
v_mfma_f32_16x16x32_bf16 v[72:75], a[40:43], a[12:15], 0
s_waitcnt lgkmcnt(15)
s_lshl2_add_u32 s66, s2, s30
ds_read_b128 a[32:35], v3 offset:6144
v_mfma_f32_16x16x32_bf16 v[88:91], a[44:47], a[0:3], 0
s_lshl_b32 s66, s66, 13
ds_read_b64_tr_b16 a[40:41], v4 offset:8192
v_mfma_f32_16x16x32_bf16 v[104:107], a[44:47], a[4:7], 0
ds_read_b64_tr_b16 a[42:43], v4 offset:9216
v_mfma_f32_16x16x32_bf16 v[120:123], a[44:47], a[8:11], 0
buffer_load_dword a252, v22, s[48:51], s66 offen
v_mfma_f32_16x16x32_bf16 v[136:139], a[44:47], a[12:15], 0
s_waitcnt lgkmcnt(15)
ds_read_b64_tr_b16 a[44:45], v5 offset:8192
v_mfma_f32_16x16x32_bf16 v[28:31], a[48:51], a[0:3], 0
ds_read_b64_tr_b16 a[46:47], v5 offset:9216
v_mfma_f32_16x16x32_bf16 v[44:47], a[48:51], a[4:7], 0
v_mfma_f32_16x16x32_bf16 v[60:63], a[48:51], a[8:11], 0
v_mfma_f32_16x16x32_bf16 v[76:79], a[48:51], a[12:15], 0
s_waitcnt lgkmcnt(6)
ds_read_b64_tr_b16 a[48:49], v6 offset:8192
v_mfma_f32_16x16x32_bf16 v[92:95], a[52:55], a[0:3], 0
ds_read_b64_tr_b16 a[50:51], v6 offset:9216
v_mfma_f32_16x16x32_bf16 v[108:111], a[52:55], a[4:7], 0
s_waitcnt lgkmcnt(6)
v_mfma_f32_16x16x32_bf16 v[124:127], a[52:55], a[8:11], 0
s_add_u32 m0, s76, 0
v_mfma_f32_16x16x32_bf16 v[140:143], a[52:55], a[12:15], 0
s_add_u32 s64, s70, 256
ds_read_b64_tr_b16 a[52:53], v7 offset:8192
v_mfma_f32_16x16x32_bf16 v[32:35], a[56:59], a[0:3], 0
buffer_load_dwordx4 v12, s[32:35], s64 offen lds
v_mfma_f32_16x16x32_bf16 v[48:51], a[56:59], a[4:7], 0
ds_read_b64_tr_b16 a[54:55], v7 offset:9216
v_mfma_f32_16x16x32_bf16 v[64:67], a[56:59], a[8:11], 0
v_mfma_f32_16x16x32_bf16 v[80:83], a[56:59], a[12:15], 0
s_add_u32 m0, s76, 1024
ds_read_b64_tr_b16 a[56:57], v8 offset:8192
v_mfma_f32_16x16x32_bf16 v[96:99], a[60:63], a[0:3], 0
s_add_u32 s64, s70, 8448
ds_read_b64_tr_b16 a[58:59], v8 offset:9216
v_mfma_f32_16x16x32_bf16 v[112:115], a[60:63], a[4:7], 0
buffer_load_dwordx4 v13, s[32:35], s64 offen lds
v_mfma_f32_16x16x32_bf16 v[128:131], a[60:63], a[8:11], 0
v_mfma_f32_16x16x32_bf16 v[144:147], a[60:63], a[12:15], 0
ds_read_b64_tr_b16 a[60:61], v9 offset:8192
v_mfma_f32_16x16x32_bf16 v[36:39], a[64:67], a[0:3], 0
ds_read_b64_tr_b16 a[62:63], v9 offset:9216
v_mfma_f32_16x16x32_bf16 v[52:55], a[64:67], a[4:7], 0
v_mfma_f32_16x16x32_bf16 v[68:71], a[64:67], a[8:11], 0
s_add_u32 m0, s76, 2048
v_mfma_f32_16x16x32_bf16 v[84:87], a[64:67], a[12:15], 0
s_add_u32 s64, s70, 16640
ds_read_b64_tr_b16 a[64:65], v10 offset:8192
v_mfma_f32_16x16x32_bf16 v[100:103], a[68:71], a[0:3], 0
buffer_load_dwordx4 v12, s[32:35], s64 offen lds
v_mfma_f32_16x16x32_bf16 v[116:119], a[68:71], a[4:7], 0
ds_read_b64_tr_b16 a[66:67], v10 offset:9216
v_mfma_f32_16x16x32_bf16 v[132:135], a[68:71], a[8:11], 0
v_mfma_f32_16x16x32_bf16 v[148:151], a[68:71], a[12:15], 0
ds_read_b64_tr_b16 a[68:69], v11 offset:8192
v_mfma_f32_16x16x32_bf16 v[152:155], a[0:3], a[72:75], 0
ds_read_b64_tr_b16 a[70:71], v11 offset:9216
v_mfma_f32_16x16x32_bf16 v[160:163], a[4:7], a[72:75], 0
s_add_u32 m0, s76, 3072
v_mfma_f32_16x16x32_bf16 v[168:171], a[8:11], a[72:75], 0
s_add_u32 s64, s70, 24832
v_mfma_f32_16x16x32_bf16 v[176:179], a[12:15], a[72:75], 0
buffer_load_dwordx4 v13, s[32:35], s64 offen lds
v_mfma_f32_16x16x32_bf16 v[156:159], a[0:3], a[76:79], 0
ds_read_b64_tr_b16 a[72:73], v4 offset:24576
v_mfma_f32_16x16x32_bf16 v[164:167], a[4:7], a[76:79], 0
ds_read_b64_tr_b16 a[74:75], v4 offset:25600
v_mfma_f32_16x16x32_bf16 v[172:175], a[8:11], a[76:79], 0
v_mfma_f32_16x16x32_bf16 v[180:183], a[12:15], a[76:79], 0
ds_read_b64_tr_b16 a[76:77], v5 offset:24576
v_mfma_f32_16x16x32_bf16 v[184:187], a[0:3], a[80:83], 0
s_add_u32 m0, s76, 4096
ds_read_b64_tr_b16 a[78:79], v5 offset:25600
v_mfma_f32_16x16x32_bf16 v[192:195], a[4:7], a[80:83], 0
s_add_u32 s64, s70, 33024
v_mfma_f32_16x16x32_bf16 v[200:203], a[8:11], a[80:83], 0
buffer_load_dwordx4 v12, s[32:35], s64 offen lds
v_mfma_f32_16x16x32_bf16 v[208:211], a[12:15], a[80:83], 0
ds_read_b64_tr_b16 a[80:81], v6 offset:24576
v_mfma_f32_16x16x32_bf16 v[188:191], a[0:3], a[84:87], 0
ds_read_b64_tr_b16 a[82:83], v6 offset:25600
v_mfma_f32_16x16x32_bf16 v[196:199], a[4:7], a[84:87], 0
v_mfma_f32_16x16x32_bf16 v[204:207], a[8:11], a[84:87], 0
v_mfma_f32_16x16x32_bf16 v[212:215], a[12:15], a[84:87], 0
s_add_u32 m0, s76, 5120
ds_read_b64_tr_b16 a[84:85], v7 offset:24576
v_mfma_f32_16x16x32_bf16 v[216:219], a[0:3], a[88:91], 0
s_add_u32 s64, s70, 41216
ds_read_b64_tr_b16 a[86:87], v7 offset:25600
v_mfma_f32_16x16x32_bf16 v[224:227], a[4:7], a[88:91], 0
buffer_load_dwordx4 v13, s[32:35], s64 offen lds
v_mfma_f32_16x16x32_bf16 v[232:235], a[8:11], a[88:91], 0
v_mfma_f32_16x16x32_bf16 v[240:243], a[12:15], a[88:91], 0
ds_read_b64_tr_b16 a[88:89], v8 offset:24576
v_mfma_f32_16x16x32_bf16 v[220:223], a[0:3], a[92:95], 0
ds_read_b64_tr_b16 a[90:91], v8 offset:25600
v_mfma_f32_16x16x32_bf16 v[228:231], a[4:7], a[92:95], 0
v_mfma_f32_16x16x32_bf16 v[236:239], a[8:11], a[92:95], 0
s_add_u32 m0, s76, 6144
v_mfma_f32_16x16x32_bf16 v[244:247], a[12:15], a[92:95], 0
s_add_u32 s64, s70, 49408
ds_read_b64_tr_b16 a[92:93], v9 offset:24576
v_mfma_f32_16x16x32_bf16 v[248:251], a[0:3], a[96:99], 0
buffer_load_dwordx4 v12, s[32:35], s64 offen lds
v_mfma_f32_16x16x32_bf16 v[252:255], a[4:7], a[96:99], 0
ds_read_b64_tr_b16 a[94:95], v9 offset:25600
v_mfma_f32_16x16x32_bf16 a[104:107], a[8:11], a[96:99], 0
v_mfma_f32_16x16x32_bf16 a[108:111], a[12:15], a[96:99], 0
ds_read_b64_tr_b16 a[96:97], v10 offset:24576
v_mfma_f32_16x16x32_bf16 a[112:115], a[0:3], a[100:103], 0
ds_read_b64_tr_b16 a[98:99], v10 offset:25600
v_mfma_f32_16x16x32_bf16 a[116:119], a[4:7], a[100:103], 0
v_mfma_f32_16x16x32_bf16 a[120:123], a[8:11], a[100:103], 0
v_mfma_f32_16x16x32_bf16 a[124:127], a[12:15], a[100:103], 0
s_waitcnt lgkmcnt(4)
s_add_u32 m0, s76, 7168
ds_read_b64_tr_b16 a[100:101], v11 offset:24576
v_mfma_f32_16x16x32_bf16 v[24:27], a[40:43], a[20:23], v[24:27]
s_add_u32 s64, s70, 57600
ds_read_b64_tr_b16 a[102:103], v11 offset:25600
v_mfma_f32_16x16x32_bf16 v[40:43], a[40:43], a[24:27], v[40:43]
buffer_load_dwordx4 v13, s[32:35], s64 offen lds
v_mfma_f32_16x16x32_bf16 v[56:59], a[40:43], a[28:31], v[56:59]
v_mfma_f32_16x16x32_bf16 v[72:75], a[40:43], a[32:35], v[72:75]
v_mfma_f32_16x16x32_bf16 v[88:91], a[44:47], a[20:23], v[88:91]
v_mfma_f32_16x16x32_bf16 v[104:107], a[44:47], a[24:27], v[104:107]
v_mfma_f32_16x16x32_bf16 v[120:123], a[44:47], a[28:31], v[120:123]
v_mfma_f32_16x16x32_bf16 v[136:139], a[44:47], a[32:35], v[136:139]
v_mfma_f32_16x16x32_bf16 v[28:31], a[48:51], a[20:23], v[28:31]
s_waitcnt vmcnt(23) lgkmcnt(0)
s_barrier
v_mfma_f32_16x16x32_bf16 v[44:47], a[48:51], a[24:27], v[44:47]
s_add_u32 m0, s77, 65536
ds_read_b64_tr_b16 a[40:41], v4 offset:32768
v_mfma_f32_16x16x32_bf16 v[60:63], a[48:51], a[28:31], v[60:63]
s_add_u32 s64, s71, 1048576
ds_read_b64_tr_b16 a[42:43], v4 offset:33792
v_mfma_f32_16x16x32_bf16 v[76:79], a[48:51], a[32:35], v[76:79]
buffer_load_dwordx4 v14, s[36:39], s64 offen lds
v_mfma_f32_16x16x32_bf16 v[92:95], a[52:55], a[20:23], v[92:95]
ds_read_b64_tr_b16 a[44:45], v5 offset:32768
v_mfma_f32_16x16x32_bf16 v[108:111], a[52:55], a[24:27], v[108:111]
ds_read_b64_tr_b16 a[46:47], v5 offset:33792
v_mfma_f32_16x16x32_bf16 v[124:127], a[52:55], a[28:31], v[124:127]
ds_read_b64_tr_b16 a[48:49], v6 offset:32768
v_mfma_f32_16x16x32_bf16 v[140:143], a[52:55], a[32:35], v[140:143]
ds_read_b64_tr_b16 a[50:51], v6 offset:33792
v_mfma_f32_16x16x32_bf16 v[32:35], a[56:59], a[20:23], v[32:35]
s_add_u32 m0, s77, 66560
ds_read_b64_tr_b16 a[52:53], v7 offset:32768
v_mfma_f32_16x16x32_bf16 v[48:51], a[56:59], a[24:27], v[48:51]
s_add_u32 s64, s71, 1081344
ds_read_b64_tr_b16 a[54:55], v7 offset:33792
v_mfma_f32_16x16x32_bf16 v[64:67], a[56:59], a[28:31], v[64:67]
buffer_load_dwordx4 v14, s[36:39], s64 offen lds
v_mfma_f32_16x16x32_bf16 v[80:83], a[56:59], a[32:35], v[80:83]
ds_read_b64_tr_b16 a[56:57], v8 offset:32768
v_mfma_f32_16x16x32_bf16 v[96:99], a[60:63], a[20:23], v[96:99]
ds_read_b64_tr_b16 a[58:59], v8 offset:33792
v_mfma_f32_16x16x32_bf16 v[112:115], a[60:63], a[24:27], v[112:115]
ds_read_b128 a[0:3], v2 offset:32768
v_mfma_f32_16x16x32_bf16 v[128:131], a[60:63], a[28:31], v[128:131]
ds_read_b128 a[4:7], v2 offset:34816
v_mfma_f32_16x16x32_bf16 v[144:147], a[60:63], a[32:35], v[144:147]
ds_read_b64_tr_b16 a[60:61], v9 offset:32768
v_mfma_f32_16x16x32_bf16 v[36:39], a[64:67], a[20:23], v[36:39]
s_add_u32 m0, s77, 67584
ds_read_b64_tr_b16 a[62:63], v9 offset:33792
v_mfma_f32_16x16x32_bf16 v[52:55], a[64:67], a[24:27], v[52:55]
s_add_u32 s64, s71, 1114112
ds_read_b128 a[8:11], v2 offset:36864
v_mfma_f32_16x16x32_bf16 v[68:71], a[64:67], a[28:31], v[68:71]
buffer_load_dwordx4 v15, s[36:39], s64 offen lds
v_mfma_f32_16x16x32_bf16 v[84:87], a[64:67], a[32:35], v[84:87]
ds_read_b64_tr_b16 a[64:65], v10 offset:32768
v_mfma_f32_16x16x32_bf16 v[100:103], a[68:71], a[20:23], v[100:103]
ds_read_b64_tr_b16 a[66:67], v10 offset:33792
v_mfma_f32_16x16x32_bf16 v[116:119], a[68:71], a[24:27], v[116:119]
ds_read_b128 a[12:15], v2 offset:38912
v_mfma_f32_16x16x32_bf16 v[132:135], a[68:71], a[28:31], v[132:135]
v_mfma_f32_16x16x32_bf16 v[148:151], a[68:71], a[32:35], v[148:151]
s_add_u32 m0, s77, 68608
ds_read_b64_tr_b16 a[68:69], v11 offset:32768
v_mfma_f32_16x16x32_bf16 v[152:155], a[20:23], a[72:75], v[152:155]
s_add_u32 s64, s71, 1146880
ds_read_b64_tr_b16 a[70:71], v11 offset:33792
v_mfma_f32_16x16x32_bf16 v[160:163], a[24:27], a[72:75], v[160:163]
buffer_load_dwordx4 v15, s[36:39], s64 offen lds
v_mfma_f32_16x16x32_bf16 v[168:171], a[28:31], a[72:75], v[168:171]
v_mfma_f32_16x16x32_bf16 v[176:179], a[32:35], a[72:75], v[176:179]
ds_read_b64_tr_b16 a[72:73], v4 offset:49152
v_mfma_f32_16x16x32_bf16 v[156:159], a[20:23], a[76:79], v[156:159]
ds_read_b64_tr_b16 a[74:75], v4 offset:50176
v_mfma_f32_16x16x32_bf16 v[164:167], a[24:27], a[76:79], v[164:167]
v_mfma_f32_16x16x32_bf16 v[172:175], a[28:31], a[76:79], v[172:175]
v_mfma_f32_16x16x32_bf16 v[180:183], a[32:35], a[76:79], v[180:183]
s_add_u32 m0, s77, 81920
ds_read_b64_tr_b16 a[76:77], v5 offset:49152
v_mfma_f32_16x16x32_bf16 v[184:187], a[20:23], a[80:83], v[184:187]
s_add_u32 s64, s71, 1048576
ds_read_b64_tr_b16 a[78:79], v5 offset:50176
v_mfma_f32_16x16x32_bf16 v[192:195], a[24:27], a[80:83], v[192:195]
buffer_load_dwordx4 v14, s[40:43], s64 offen lds
v_mfma_f32_16x16x32_bf16 v[200:203], a[28:31], a[80:83], v[200:203]
v_mfma_f32_16x16x32_bf16 v[208:211], a[32:35], a[80:83], v[208:211]
ds_read_b64_tr_b16 a[80:81], v6 offset:49152
v_mfma_f32_16x16x32_bf16 v[188:191], a[20:23], a[84:87], v[188:191]
ds_read_b64_tr_b16 a[82:83], v6 offset:50176
v_mfma_f32_16x16x32_bf16 v[196:199], a[24:27], a[84:87], v[196:199]
v_mfma_f32_16x16x32_bf16 v[204:207], a[28:31], a[84:87], v[204:207]
v_mfma_f32_16x16x32_bf16 v[212:215], a[32:35], a[84:87], v[212:215]
s_add_u32 m0, s77, 82944
ds_read_b64_tr_b16 a[84:85], v7 offset:49152
v_mfma_f32_16x16x32_bf16 v[216:219], a[20:23], a[88:91], v[216:219]
s_add_u32 s64, s71, 1081344
ds_read_b64_tr_b16 a[86:87], v7 offset:50176
v_mfma_f32_16x16x32_bf16 v[224:227], a[24:27], a[88:91], v[224:227]
buffer_load_dwordx4 v14, s[40:43], s64 offen lds
v_mfma_f32_16x16x32_bf16 v[232:235], a[28:31], a[88:91], v[232:235]
v_mfma_f32_16x16x32_bf16 v[240:243], a[32:35], a[88:91], v[240:243]
ds_read_b64_tr_b16 a[88:89], v8 offset:49152
v_mfma_f32_16x16x32_bf16 v[220:223], a[20:23], a[92:95], v[220:223]
ds_read_b64_tr_b16 a[90:91], v8 offset:50176
v_mfma_f32_16x16x32_bf16 v[228:231], a[24:27], a[92:95], v[228:231]
v_mfma_f32_16x16x32_bf16 v[236:239], a[28:31], a[92:95], v[236:239]
s_add_u32 m0, s77, 83968
v_mfma_f32_16x16x32_bf16 v[244:247], a[32:35], a[92:95], v[244:247]
s_add_u32 s64, s71, 1114112
ds_read_b64_tr_b16 a[92:93], v9 offset:49152
v_mfma_f32_16x16x32_bf16 v[248:251], a[20:23], a[96:99], v[248:251]
buffer_load_dwordx4 v15, s[40:43], s64 offen lds
v_mfma_f32_16x16x32_bf16 v[252:255], a[24:27], a[96:99], v[252:255]
ds_read_b64_tr_b16 a[94:95], v9 offset:50176
v_mfma_f32_16x16x32_bf16 a[104:107], a[28:31], a[96:99], a[104:107]
v_mfma_f32_16x16x32_bf16 a[108:111], a[32:35], a[96:99], a[108:111]
ds_read_b64_tr_b16 a[96:97], v10 offset:49152
v_mfma_f32_16x16x32_bf16 a[112:115], a[20:23], a[100:103], a[112:115]
ds_read_b64_tr_b16 a[98:99], v10 offset:50176
v_mfma_f32_16x16x32_bf16 a[116:119], a[24:27], a[100:103], a[116:119]
v_mfma_f32_16x16x32_bf16 a[120:123], a[28:31], a[100:103], a[120:123]
s_add_u32 m0, s77, 84992
v_mfma_f32_16x16x32_bf16 a[124:127], a[32:35], a[100:103], a[124:127]
s_waitcnt lgkmcnt(4)
s_add_u32 s64, s71, 1146880
ds_read_b64_tr_b16 a[100:101], v11 offset:49152
v_mfma_f32_16x16x32_bf16 v[24:27], a[40:43], a[0:3], v[24:27]
buffer_load_dwordx4 v15, s[40:43], s64 offen lds
v_mfma_f32_16x16x32_bf16 v[40:43], a[40:43], a[4:7], v[40:43]
ds_read_b128 a[20:23], v3 offset:32768
v_mfma_f32_16x16x32_bf16 v[56:59], a[40:43], a[8:11], v[56:59]
ds_read_b128 a[24:27], v3 offset:34816
v_and_b32 v22, 7, v0
v_mfma_f32_16x16x32_bf16 v[72:75], a[40:43], a[12:15], v[72:75]
ds_read_b128 a[28:31], v3 offset:36864
v_lshlrev_b32 v22, 7, v22
v_mfma_f32_16x16x32_bf16 v[88:91], a[44:47], a[0:3], v[88:91]
ds_read_b128 a[32:35], v3 offset:38912
v_lshrrev_b32 v23, 3, v0
v_mfma_f32_16x16x32_bf16 v[104:107], a[44:47], a[4:7], v[104:107]
ds_read_b64_tr_b16 a[40:41], v4 offset:40960
v_lshl_add_u32 v22, v23, 13, v22
v_mfma_f32_16x16x32_bf16 v[120:123], a[44:47], a[8:11], v[120:123]
s_lshl_b32 s66, s80, 16
ds_read_b64_tr_b16 a[42:43], v4 offset:41984
v_mfma_f32_16x16x32_bf16 v[136:139], a[44:47], a[12:15], v[136:139]
s_and_b32 s67, s2, 7
ds_read_b64_tr_b16 a[44:45], v5 offset:40960
v_mfma_f32_16x16x32_bf16 v[28:31], a[48:51], a[0:3], v[28:31]
s_lshl_b32 s67, s67, 10
ds_read_b64_tr_b16 a[46:47], v5 offset:41984
v_mfma_f32_16x16x32_bf16 v[44:47], a[48:51], a[4:7], v[44:47]
s_add_u32 s66, s66, s67
ds_read_b64_tr_b16 a[102:103], v11 offset:50176
v_mfma_f32_16x16x32_bf16 v[60:63], a[48:51], a[8:11], v[60:63]
buffer_load_dword a252, v22, s[56:59], s66 offen
v_mfma_f32_16x16x32_bf16 v[76:79], a[48:51], a[12:15], v[76:79]
ds_read_b64_tr_b16 a[48:49], v6 offset:40960
v_mfma_f32_16x16x32_bf16 v[92:95], a[52:55], a[0:3], v[92:95]
ds_read_b64_tr_b16 a[50:51], v6 offset:41984
v_mfma_f32_16x16x32_bf16 v[108:111], a[52:55], a[4:7], v[108:111]
s_waitcnt lgkmcnt(7)
v_mfma_f32_16x16x32_bf16 v[124:127], a[52:55], a[8:11], v[124:127]
s_add_u32 m0, s76, 32768
v_mfma_f32_16x16x32_bf16 v[140:143], a[52:55], a[12:15], v[140:143]
s_add_u32 s64, s70, 384
ds_read_b64_tr_b16 a[52:53], v7 offset:40960
v_mfma_f32_16x16x32_bf16 v[32:35], a[56:59], a[0:3], v[32:35]
buffer_load_dwordx4 v12, s[32:35], s64 offen lds
v_mfma_f32_16x16x32_bf16 v[48:51], a[56:59], a[4:7], v[48:51]
ds_read_b64_tr_b16 a[54:55], v7 offset:41984
v_mfma_f32_16x16x32_bf16 v[64:67], a[56:59], a[8:11], v[64:67]
v_mfma_f32_16x16x32_bf16 v[80:83], a[56:59], a[12:15], v[80:83]
s_add_u32 m0, s76, 33792
ds_read_b64_tr_b16 a[56:57], v8 offset:40960
v_mfma_f32_16x16x32_bf16 v[96:99], a[60:63], a[0:3], v[96:99]
s_add_u32 s64, s70, 8576
ds_read_b64_tr_b16 a[58:59], v8 offset:41984
v_mfma_f32_16x16x32_bf16 v[112:115], a[60:63], a[4:7], v[112:115]
buffer_load_dwordx4 v13, s[32:35], s64 offen lds
v_mfma_f32_16x16x32_bf16 v[128:131], a[60:63], a[8:11], v[128:131]
v_mfma_f32_16x16x32_bf16 v[144:147], a[60:63], a[12:15], v[144:147]
ds_read_b64_tr_b16 a[60:61], v9 offset:40960
v_mfma_f32_16x16x32_bf16 v[36:39], a[64:67], a[0:3], v[36:39]
ds_read_b64_tr_b16 a[62:63], v9 offset:41984
v_mfma_f32_16x16x32_bf16 v[52:55], a[64:67], a[4:7], v[52:55]
v_mfma_f32_16x16x32_bf16 v[68:71], a[64:67], a[8:11], v[68:71]
s_add_u32 m0, s76, 34816
v_mfma_f32_16x16x32_bf16 v[84:87], a[64:67], a[12:15], v[84:87]
s_add_u32 s64, s70, 16768
ds_read_b64_tr_b16 a[64:65], v10 offset:40960
v_mfma_f32_16x16x32_bf16 v[100:103], a[68:71], a[0:3], v[100:103]
buffer_load_dwordx4 v12, s[32:35], s64 offen lds
v_mfma_f32_16x16x32_bf16 v[116:119], a[68:71], a[4:7], v[116:119]
ds_read_b64_tr_b16 a[66:67], v10 offset:41984
v_mfma_f32_16x16x32_bf16 v[132:135], a[68:71], a[8:11], v[132:135]
v_mfma_f32_16x16x32_bf16 v[148:151], a[68:71], a[12:15], v[148:151]
ds_read_b64_tr_b16 a[68:69], v11 offset:40960
v_mfma_f32_16x16x32_bf16 v[152:155], a[0:3], a[72:75], v[152:155]
ds_read_b64_tr_b16 a[70:71], v11 offset:41984
v_mfma_f32_16x16x32_bf16 v[160:163], a[4:7], a[72:75], v[160:163]
s_add_u32 m0, s76, 35840
v_mfma_f32_16x16x32_bf16 v[168:171], a[8:11], a[72:75], v[168:171]
s_add_u32 s64, s70, 24960
v_mfma_f32_16x16x32_bf16 v[176:179], a[12:15], a[72:75], v[176:179]
buffer_load_dwordx4 v13, s[32:35], s64 offen lds
v_mfma_f32_16x16x32_bf16 v[156:159], a[0:3], a[76:79], v[156:159]
ds_read_b64_tr_b16 a[72:73], v4 offset:57344
v_mfma_f32_16x16x32_bf16 v[164:167], a[4:7], a[76:79], v[164:167]
ds_read_b64_tr_b16 a[74:75], v4 offset:58368
v_mfma_f32_16x16x32_bf16 v[172:175], a[8:11], a[76:79], v[172:175]
v_mfma_f32_16x16x32_bf16 v[180:183], a[12:15], a[76:79], v[180:183]
ds_read_b64_tr_b16 a[76:77], v5 offset:57344
v_mfma_f32_16x16x32_bf16 v[184:187], a[0:3], a[80:83], v[184:187]
s_add_u32 m0, s76, 36864
ds_read_b64_tr_b16 a[78:79], v5 offset:58368
v_mfma_f32_16x16x32_bf16 v[192:195], a[4:7], a[80:83], v[192:195]
s_add_u32 s64, s70, 33152
v_mfma_f32_16x16x32_bf16 v[200:203], a[8:11], a[80:83], v[200:203]
buffer_load_dwordx4 v12, s[32:35], s64 offen lds
v_mfma_f32_16x16x32_bf16 v[208:211], a[12:15], a[80:83], v[208:211]
ds_read_b64_tr_b16 a[80:81], v6 offset:57344
v_mfma_f32_16x16x32_bf16 v[188:191], a[0:3], a[84:87], v[188:191]
ds_read_b64_tr_b16 a[82:83], v6 offset:58368
v_mfma_f32_16x16x32_bf16 v[196:199], a[4:7], a[84:87], v[196:199]
v_mfma_f32_16x16x32_bf16 v[204:207], a[8:11], a[84:87], v[204:207]
v_mfma_f32_16x16x32_bf16 v[212:215], a[12:15], a[84:87], v[212:215]
s_add_u32 m0, s76, 37888
ds_read_b64_tr_b16 a[84:85], v7 offset:57344
v_mfma_f32_16x16x32_bf16 v[216:219], a[0:3], a[88:91], v[216:219]
s_add_u32 s64, s70, 41344
ds_read_b64_tr_b16 a[86:87], v7 offset:58368
v_mfma_f32_16x16x32_bf16 v[224:227], a[4:7], a[88:91], v[224:227]
buffer_load_dwordx4 v13, s[32:35], s64 offen lds
v_mfma_f32_16x16x32_bf16 v[232:235], a[8:11], a[88:91], v[232:235]
v_mfma_f32_16x16x32_bf16 v[240:243], a[12:15], a[88:91], v[240:243]
ds_read_b64_tr_b16 a[88:89], v8 offset:57344
v_mfma_f32_16x16x32_bf16 v[220:223], a[0:3], a[92:95], v[220:223]
ds_read_b64_tr_b16 a[90:91], v8 offset:58368
v_mfma_f32_16x16x32_bf16 v[228:231], a[4:7], a[92:95], v[228:231]
v_mfma_f32_16x16x32_bf16 v[236:239], a[8:11], a[92:95], v[236:239]
s_add_u32 m0, s76, 38912
v_mfma_f32_16x16x32_bf16 v[244:247], a[12:15], a[92:95], v[244:247]
s_add_u32 s64, s70, 49536
ds_read_b64_tr_b16 a[92:93], v9 offset:57344
v_mfma_f32_16x16x32_bf16 v[248:251], a[0:3], a[96:99], v[248:251]
buffer_load_dwordx4 v12, s[32:35], s64 offen lds
v_mfma_f32_16x16x32_bf16 v[252:255], a[4:7], a[96:99], v[252:255]
ds_read_b64_tr_b16 a[94:95], v9 offset:58368
v_mfma_f32_16x16x32_bf16 a[104:107], a[8:11], a[96:99], a[104:107]
v_mfma_f32_16x16x32_bf16 a[108:111], a[12:15], a[96:99], a[108:111]
s_waitcnt lgkmcnt(4)
ds_read_b64_tr_b16 a[96:97], v10 offset:57344
v_mfma_f32_16x16x32_bf16 a[112:115], a[0:3], a[100:103], a[112:115]
ds_read_b64_tr_b16 a[98:99], v10 offset:58368
v_mfma_f32_16x16x32_bf16 a[116:119], a[4:7], a[100:103], a[116:119]
v_mfma_f32_16x16x32_bf16 a[120:123], a[8:11], a[100:103], a[120:123]
v_mfma_f32_16x16x32_bf16 a[124:127], a[12:15], a[100:103], a[124:127]
s_add_u32 m0, s76, 39936
ds_read_b64_tr_b16 a[100:101], v11 offset:57344
v_mfma_f32_16x16x32_bf16 v[24:27], a[40:43], a[20:23], v[24:27]
s_add_u32 s64, s70, 57728
ds_read_b64_tr_b16 a[102:103], v11 offset:58368
v_mfma_f32_16x16x32_bf16 v[40:43], a[40:43], a[24:27], v[40:43]
buffer_load_dwordx4 v13, s[32:35], s64 offen lds
v_mfma_f32_16x16x32_bf16 v[56:59], a[40:43], a[28:31], v[56:59]
v_mfma_f32_16x16x32_bf16 v[72:75], a[40:43], a[32:35], v[72:75]
v_mfma_f32_16x16x32_bf16 v[88:91], a[44:47], a[20:23], v[88:91]
v_mfma_f32_16x16x32_bf16 v[104:107], a[44:47], a[24:27], v[104:107]
v_mfma_f32_16x16x32_bf16 v[120:123], a[44:47], a[28:31], v[120:123]
v_mfma_f32_16x16x32_bf16 v[136:139], a[44:47], a[32:35], v[136:139]
v_mfma_f32_16x16x32_bf16 v[28:31], a[48:51], a[20:23], v[28:31]
s_waitcnt vmcnt(9) lgkmcnt(0)
s_barrier
v_mfma_f32_16x16x32_bf16 v[44:47], a[48:51], a[24:27], v[44:47]
s_add_u32 m0, s77, 98304
ds_read_b64_tr_b16 a[40:41], v4 offset:0
v_mfma_f32_16x16x32_bf16 v[60:63], a[48:51], a[28:31], v[60:63]
s_add_u32 s64, s71, 1572864
ds_read_b64_tr_b16 a[42:43], v4 offset:1024
v_mov_b32 v17, 0
v_mfma_f32_16x16x32_bf16 v[76:79], a[48:51], a[32:35], v[76:79]
buffer_load_dwordx4 v14, s[36:39], s64 offen lds
v_mfma_f32_16x16x32_bf16 v[92:95], a[52:55], a[20:23], v[92:95]
ds_read_b64_tr_b16 a[44:45], v5 offset:0
v_accvgpr_read_b32 v19, a128
v_mfma_f32_16x16x32_bf16 v[108:111], a[52:55], a[24:27], v[108:111]
ds_read_b64_tr_b16 a[46:47], v5 offset:1024
v_accvgpr_read_b32 v21, a144
v_mfma_f32_16x16x32_bf16 v[124:127], a[52:55], a[28:31], v[124:127]
ds_read_b64_tr_b16 a[48:49], v6 offset:0
v_lshlrev_b32 v18, 16, v19
v_mfma_f32_16x16x32_bf16 v[140:143], a[52:55], a[32:35], v[140:143]
ds_read_b64_tr_b16 a[50:51], v6 offset:1024
v_and_b32 v19, 0xffff0000, v19
v_mfma_f32_16x16x32_bf16 v[32:35], a[56:59], a[20:23], v[32:35]
s_add_u32 m0, s77, 99328
ds_read_b64_tr_b16 a[52:53], v7 offset:0
v_lshlrev_b32 v20, 16, v21
v_mfma_f32_16x16x32_bf16 v[48:51], a[56:59], a[24:27], v[48:51]
s_add_u32 s64, s71, 1605632
ds_read_b64_tr_b16 a[54:55], v7 offset:1024
v_and_b32 v21, 0xffff0000, v21
v_mfma_f32_16x16x32_bf16 v[64:67], a[56:59], a[28:31], v[64:67]
buffer_load_dwordx4 v14, s[36:39], s64 offen lds
v_mfma_f32_16x16x32_bf16 v[80:83], a[56:59], a[32:35], v[80:83]
ds_read_b64_tr_b16 a[56:57], v8 offset:0
v_mul_f32 v18, v18, v20
v_mfma_f32_16x16x32_bf16 v[96:99], a[60:63], a[20:23], v[96:99]
ds_read_b64_tr_b16 a[58:59], v8 offset:1024
v_mul_f32 v19, v19, v21
v_mfma_f32_16x16x32_bf16 v[112:115], a[60:63], a[24:27], v[112:115]
ds_read_b128 a[0:3], v2 offset:0
v_cvt_pk_bf16_f32 v18, v18, v19
v_mfma_f32_16x16x32_bf16 v[128:131], a[60:63], a[28:31], v[128:131]
ds_read_b128 a[4:7], v2 offset:2048
v_lshlrev_b32 v19, 16, v18
v_mfma_f32_16x16x32_bf16 v[144:147], a[60:63], a[32:35], v[144:147]
ds_read_b64_tr_b16 a[60:61], v9 offset:0
v_and_b32 v18, 0xffff0000, v18
v_mfma_f32_16x16x32_bf16 v[36:39], a[64:67], a[20:23], v[36:39]
s_add_u32 m0, s77, 100352
ds_read_b64_tr_b16 a[62:63], v9 offset:1024
v_add_f32 v17, v17, v19
v_mfma_f32_16x16x32_bf16 v[52:55], a[64:67], a[24:27], v[52:55]
s_add_u32 s64, s71, 1638400
ds_read_b128 a[8:11], v2 offset:4096
v_add_f32 v17, v17, v18
v_mfma_f32_16x16x32_bf16 v[68:71], a[64:67], a[28:31], v[68:71]
buffer_load_dwordx4 v15, s[36:39], s64 offen lds
v_mfma_f32_16x16x32_bf16 v[84:87], a[64:67], a[32:35], v[84:87]
ds_read_b64_tr_b16 a[64:65], v10 offset:0
v_accvgpr_read_b32 v19, a129
v_mfma_f32_16x16x32_bf16 v[100:103], a[68:71], a[20:23], v[100:103]
ds_read_b64_tr_b16 a[66:67], v10 offset:1024
v_accvgpr_read_b32 v21, a145
v_mfma_f32_16x16x32_bf16 v[116:119], a[68:71], a[24:27], v[116:119]
ds_read_b128 a[12:15], v2 offset:6144
v_lshlrev_b32 v18, 16, v19
v_mfma_f32_16x16x32_bf16 v[132:135], a[68:71], a[28:31], v[132:135]
v_and_b32 v19, 0xffff0000, v19
v_lshlrev_b32 v20, 16, v21
v_mfma_f32_16x16x32_bf16 v[148:151], a[68:71], a[32:35], v[148:151]
s_add_u32 m0, s77, 101376
ds_read_b64_tr_b16 a[68:69], v11 offset:0
v_and_b32 v21, 0xffff0000, v21
v_mfma_f32_16x16x32_bf16 v[152:155], a[20:23], a[72:75], v[152:155]
s_add_u32 s64, s71, 1671168
ds_read_b64_tr_b16 a[70:71], v11 offset:1024
v_mul_f32 v18, v18, v20
v_mfma_f32_16x16x32_bf16 v[160:163], a[24:27], a[72:75], v[160:163]
buffer_load_dwordx4 v15, s[36:39], s64 offen lds
v_mfma_f32_16x16x32_bf16 v[168:171], a[28:31], a[72:75], v[168:171]
v_mul_f32 v19, v19, v21
v_cvt_pk_bf16_f32 v18, v18, v19
v_mfma_f32_16x16x32_bf16 v[176:179], a[32:35], a[72:75], v[176:179]
ds_read_b64_tr_b16 a[72:73], v4 offset:16384
v_lshlrev_b32 v19, 16, v18
v_mfma_f32_16x16x32_bf16 v[156:159], a[20:23], a[76:79], v[156:159]
ds_read_b64_tr_b16 a[74:75], v4 offset:17408
v_and_b32 v18, 0xffff0000, v18
v_mfma_f32_16x16x32_bf16 v[164:167], a[24:27], a[76:79], v[164:167]
s_add_u32 m0, s77, 114688
v_add_f32 v17, v17, v19
v_add_f32 v17, v17, v18
v_mfma_f32_16x16x32_bf16 v[172:175], a[28:31], a[76:79], v[172:175]
s_add_u32 s64, s71, 1572864
v_accvgpr_read_b32 v19, a130
v_accvgpr_read_b32 v21, a146
v_mfma_f32_16x16x32_bf16 v[180:183], a[32:35], a[76:79], v[180:183]
ds_read_b64_tr_b16 a[76:77], v5 offset:16384
v_lshlrev_b32 v18, 16, v19
v_mfma_f32_16x16x32_bf16 v[184:187], a[20:23], a[80:83], v[184:187]
ds_read_b64_tr_b16 a[78:79], v5 offset:17408
v_and_b32 v19, 0xffff0000, v19
v_mfma_f32_16x16x32_bf16 v[192:195], a[24:27], a[80:83], v[192:195]
buffer_load_dwordx4 v14, s[40:43], s64 offen lds
v_mfma_f32_16x16x32_bf16 v[200:203], a[28:31], a[80:83], v[200:203]
v_lshlrev_b32 v20, 16, v21
v_and_b32 v21, 0xffff0000, v21
v_mfma_f32_16x16x32_bf16 v[208:211], a[32:35], a[80:83], v[208:211]
ds_read_b64_tr_b16 a[80:81], v6 offset:16384
v_mul_f32 v18, v18, v20
v_mfma_f32_16x16x32_bf16 v[188:191], a[20:23], a[84:87], v[188:191]
ds_read_b64_tr_b16 a[82:83], v6 offset:17408
v_mul_f32 v19, v19, v21
v_mfma_f32_16x16x32_bf16 v[196:199], a[24:27], a[84:87], v[196:199]
s_add_u32 m0, s77, 115712
v_cvt_pk_bf16_f32 v18, v18, v19
v_lshlrev_b32 v19, 16, v18
v_mfma_f32_16x16x32_bf16 v[204:207], a[28:31], a[84:87], v[204:207]
s_add_u32 s64, s71, 1605632
v_and_b32 v18, 0xffff0000, v18
v_add_f32 v17, v17, v19
v_mfma_f32_16x16x32_bf16 v[212:215], a[32:35], a[84:87], v[212:215]
ds_read_b64_tr_b16 a[84:85], v7 offset:16384
v_add_f32 v17, v17, v18
v_mfma_f32_16x16x32_bf16 v[216:219], a[20:23], a[88:91], v[216:219]
ds_read_b64_tr_b16 a[86:87], v7 offset:17408
v_accvgpr_read_b32 v19, a131
v_mfma_f32_16x16x32_bf16 v[224:227], a[24:27], a[88:91], v[224:227]
buffer_load_dwordx4 v14, s[40:43], s64 offen lds
v_mfma_f32_16x16x32_bf16 v[232:235], a[28:31], a[88:91], v[232:235]
v_accvgpr_read_b32 v21, a147
v_lshlrev_b32 v18, 16, v19
v_mfma_f32_16x16x32_bf16 v[240:243], a[32:35], a[88:91], v[240:243]
ds_read_b64_tr_b16 a[88:89], v8 offset:16384
v_and_b32 v19, 0xffff0000, v19
v_mfma_f32_16x16x32_bf16 v[220:223], a[20:23], a[92:95], v[220:223]
ds_read_b64_tr_b16 a[90:91], v8 offset:17408
v_lshlrev_b32 v20, 16, v21
v_mfma_f32_16x16x32_bf16 v[228:231], a[24:27], a[92:95], v[228:231]
s_add_u32 m0, s77, 116736
v_and_b32 v21, 0xffff0000, v21
v_mul_f32 v18, v18, v20
v_mfma_f32_16x16x32_bf16 v[236:239], a[28:31], a[92:95], v[236:239]
s_add_u32 s64, s71, 1638400
v_mul_f32 v19, v19, v21
v_cvt_pk_bf16_f32 v18, v18, v19
v_mfma_f32_16x16x32_bf16 v[244:247], a[32:35], a[92:95], v[244:247]
ds_read_b64_tr_b16 a[92:93], v9 offset:16384
v_lshlrev_b32 v19, 16, v18
v_mfma_f32_16x16x32_bf16 v[248:251], a[20:23], a[96:99], v[248:251]
buffer_load_dwordx4 v15, s[40:43], s64 offen lds
v_mfma_f32_16x16x32_bf16 v[252:255], a[24:27], a[96:99], v[252:255]
ds_read_b64_tr_b16 a[94:95], v9 offset:17408
v_and_b32 v18, 0xffff0000, v18
v_mfma_f32_16x16x32_bf16 a[104:107], a[28:31], a[96:99], a[104:107]
v_add_f32 v17, v17, v19
v_add_f32 v17, v17, v18
v_mfma_f32_16x16x32_bf16 a[108:111], a[32:35], a[96:99], a[108:111]
ds_read_b64_tr_b16 a[96:97], v10 offset:16384
v_accvgpr_read_b32 v19, a132
v_mfma_f32_16x16x32_bf16 a[112:115], a[20:23], a[100:103], a[112:115]
ds_read_b64_tr_b16 a[98:99], v10 offset:17408
v_accvgpr_read_b32 v21, a148
v_mfma_f32_16x16x32_bf16 a[116:119], a[24:27], a[100:103], a[116:119]
s_add_u32 m0, s77, 117760
v_lshlrev_b32 v18, 16, v19
v_and_b32 v19, 0xffff0000, v19
v_mfma_f32_16x16x32_bf16 a[120:123], a[28:31], a[100:103], a[120:123]
s_add_u32 s64, s71, 1671168
v_lshlrev_b32 v20, 16, v21
v_and_b32 v21, 0xffff0000, v21
v_mfma_f32_16x16x32_bf16 a[124:127], a[32:35], a[100:103], a[124:127]
s_waitcnt lgkmcnt(4)
ds_read_b64_tr_b16 a[100:101], v11 offset:16384
v_mul_f32 v18, v18, v20
v_mfma_f32_16x16x32_bf16 v[24:27], a[40:43], a[0:3], v[24:27]
buffer_load_dwordx4 v15, s[40:43], s64 offen lds
v_mfma_f32_16x16x32_bf16 v[40:43], a[40:43], a[4:7], v[40:43]
ds_read_b128 a[20:23], v3 offset:0
v_mul_f32 v19, v19, v21
v_mfma_f32_16x16x32_bf16 v[56:59], a[40:43], a[8:11], v[56:59]
ds_read_b128 a[24:27], v3 offset:2048
v_and_b32 v22, 1, v0
v_mfma_f32_16x16x32_bf16 v[72:75], a[40:43], a[12:15], v[72:75]
ds_read_b128 a[28:31], v3 offset:4096
v_lshlrev_b32 v22, 7, v22
v_mfma_f32_16x16x32_bf16 v[88:91], a[44:47], a[0:3], v[88:91]
ds_read_b128 a[32:35], v3 offset:6144
v_lshrrev_b32 v23, 1, v0
v_mfma_f32_16x16x32_bf16 v[104:107], a[44:47], a[4:7], v[104:107]
ds_read_b64_tr_b16 a[40:41], v4 offset:8192
v_lshl_add_u32 v22, v23, 11, v22
v_mfma_f32_16x16x32_bf16 v[120:123], a[44:47], a[8:11], v[120:123]
s_lshl_b32 s66, s80, 16
ds_read_b64_tr_b16 a[42:43], v4 offset:9216
v_cvt_pk_bf16_f32 v18, v18, v19
v_mfma_f32_16x16x32_bf16 v[136:139], a[44:47], a[12:15], v[136:139]
s_and_b32 s67, s2, 7
ds_read_b64_tr_b16 a[44:45], v5 offset:8192
v_lshlrev_b32 v19, 16, v18
v_mfma_f32_16x16x32_bf16 v[28:31], a[48:51], a[0:3], v[28:31]
s_lshl_b32 s67, s67, 8
ds_read_b64_tr_b16 a[46:47], v5 offset:9216
v_and_b32 v18, 0xffff0000, v18
v_mfma_f32_16x16x32_bf16 v[44:47], a[48:51], a[4:7], v[44:47]
s_add_u32 s66, s66, s67
ds_read_b64_tr_b16 a[102:103], v11 offset:17408
v_add_f32 v17, v17, v19
v_mfma_f32_16x16x32_bf16 v[60:63], a[48:51], a[8:11], v[60:63]
buffer_load_dword a252, v22, s[60:63], s66 offen
v_mfma_f32_16x16x32_bf16 v[76:79], a[48:51], a[12:15], v[76:79]
ds_read_b64_tr_b16 a[48:49], v6 offset:8192
v_add_f32 v17, v17, v18
v_mfma_f32_16x16x32_bf16 v[92:95], a[52:55], a[0:3], v[92:95]
ds_read_b64_tr_b16 a[50:51], v6 offset:9216
v_accvgpr_read_b32 v19, a133
v_mfma_f32_16x16x32_bf16 v[108:111], a[52:55], a[4:7], v[108:111]
s_waitcnt lgkmcnt(7)
v_accvgpr_read_b32 v21, a149
v_lshlrev_b32 v18, 16, v19
v_mfma_f32_16x16x32_bf16 v[124:127], a[52:55], a[8:11], v[124:127]
s_add_u32 m0, s76, 0
v_and_b32 v19, 0xffff0000, v19
v_lshlrev_b32 v20, 16, v21
v_mfma_f32_16x16x32_bf16 v[140:143], a[52:55], a[12:15], v[140:143]
s_add_u32 s64, s70, 512
ds_read_b64_tr_b16 a[52:53], v7 offset:8192
v_and_b32 v21, 0xffff0000, v21
v_mfma_f32_16x16x32_bf16 v[32:35], a[56:59], a[0:3], v[32:35]
buffer_load_dwordx4 v12, s[32:35], s64 offen lds
v_mfma_f32_16x16x32_bf16 v[48:51], a[56:59], a[4:7], v[48:51]
ds_read_b64_tr_b16 a[54:55], v7 offset:9216
v_mul_f32 v18, v18, v20
v_mfma_f32_16x16x32_bf16 v[64:67], a[56:59], a[8:11], v[64:67]
v_mul_f32 v19, v19, v21
v_cvt_pk_bf16_f32 v18, v18, v19
v_mfma_f32_16x16x32_bf16 v[80:83], a[56:59], a[12:15], v[80:83]
s_add_u32 m0, s76, 1024
ds_read_b64_tr_b16 a[56:57], v8 offset:8192
v_lshlrev_b32 v19, 16, v18
v_mfma_f32_16x16x32_bf16 v[96:99], a[60:63], a[0:3], v[96:99]
s_add_u32 s64, s70, 8704
ds_read_b64_tr_b16 a[58:59], v8 offset:9216
v_and_b32 v18, 0xffff0000, v18
v_mfma_f32_16x16x32_bf16 v[112:115], a[60:63], a[4:7], v[112:115]
buffer_load_dwordx4 v13, s[32:35], s64 offen lds
v_mfma_f32_16x16x32_bf16 v[128:131], a[60:63], a[8:11], v[128:131]
v_add_f32 v17, v17, v19
v_add_f32 v17, v17, v18
v_mfma_f32_16x16x32_bf16 v[144:147], a[60:63], a[12:15], v[144:147]
ds_read_b64_tr_b16 a[60:61], v9 offset:8192
v_accvgpr_read_b32 v19, a134
v_mfma_f32_16x16x32_bf16 v[36:39], a[64:67], a[0:3], v[36:39]
ds_read_b64_tr_b16 a[62:63], v9 offset:9216
v_accvgpr_read_b32 v21, a150
v_mfma_f32_16x16x32_bf16 v[52:55], a[64:67], a[4:7], v[52:55]
s_add_u32 m0, s76, 2048
v_lshlrev_b32 v18, 16, v19
v_and_b32 v19, 0xffff0000, v19
v_mfma_f32_16x16x32_bf16 v[68:71], a[64:67], a[8:11], v[68:71]
s_add_u32 s64, s70, 16896
v_lshlrev_b32 v20, 16, v21
v_and_b32 v21, 0xffff0000, v21
v_mfma_f32_16x16x32_bf16 v[84:87], a[64:67], a[12:15], v[84:87]
ds_read_b64_tr_b16 a[64:65], v10 offset:8192
v_mul_f32 v18, v18, v20
v_mfma_f32_16x16x32_bf16 v[100:103], a[68:71], a[0:3], v[100:103]
buffer_load_dwordx4 v12, s[32:35], s64 offen lds
v_mfma_f32_16x16x32_bf16 v[116:119], a[68:71], a[4:7], v[116:119]
ds_read_b64_tr_b16 a[66:67], v10 offset:9216
v_mul_f32 v19, v19, v21
v_mfma_f32_16x16x32_bf16 v[132:135], a[68:71], a[8:11], v[132:135]
v_cvt_pk_bf16_f32 v18, v18, v19
v_lshlrev_b32 v19, 16, v18
v_mfma_f32_16x16x32_bf16 v[148:151], a[68:71], a[12:15], v[148:151]
ds_read_b64_tr_b16 a[68:69], v11 offset:8192
v_and_b32 v18, 0xffff0000, v18
v_mfma_f32_16x16x32_bf16 v[152:155], a[0:3], a[72:75], v[152:155]
ds_read_b64_tr_b16 a[70:71], v11 offset:9216
v_add_f32 v17, v17, v19
v_mfma_f32_16x16x32_bf16 v[160:163], a[4:7], a[72:75], v[160:163]
s_add_u32 m0, s76, 3072
v_add_f32 v17, v17, v18
v_accvgpr_read_b32 v19, a135
v_mfma_f32_16x16x32_bf16 v[168:171], a[8:11], a[72:75], v[168:171]
s_add_u32 s64, s70, 25088
v_accvgpr_read_b32 v21, a151
v_lshlrev_b32 v18, 16, v19
v_mfma_f32_16x16x32_bf16 v[176:179], a[12:15], a[72:75], v[176:179]
buffer_load_dwordx4 v13, s[32:35], s64 offen lds
v_mfma_f32_16x16x32_bf16 v[156:159], a[0:3], a[76:79], v[156:159]
ds_read_b64_tr_b16 a[72:73], v4 offset:24576
v_and_b32 v19, 0xffff0000, v19
v_mfma_f32_16x16x32_bf16 v[164:167], a[4:7], a[76:79], v[164:167]
ds_read_b64_tr_b16 a[74:75], v4 offset:25600
v_lshlrev_b32 v20, 16, v21
v_mfma_f32_16x16x32_bf16 v[172:175], a[8:11], a[76:79], v[172:175]
s_add_u32 m0, s76, 4096
v_and_b32 v21, 0xffff0000, v21
v_mul_f32 v18, v18, v20
v_mfma_f32_16x16x32_bf16 v[180:183], a[12:15], a[76:79], v[180:183]
ds_read_b64_tr_b16 a[76:77], v5 offset:24576
v_mul_f32 v19, v19, v21
v_mfma_f32_16x16x32_bf16 v[184:187], a[0:3], a[80:83], v[184:187]
ds_read_b64_tr_b16 a[78:79], v5 offset:25600
v_cvt_pk_bf16_f32 v18, v18, v19
v_mfma_f32_16x16x32_bf16 v[192:195], a[4:7], a[80:83], v[192:195]
s_add_u32 s64, s70, 33280
v_lshlrev_b32 v19, 16, v18
v_and_b32 v18, 0xffff0000, v18
v_mfma_f32_16x16x32_bf16 v[200:203], a[8:11], a[80:83], v[200:203]
buffer_load_dwordx4 v12, s[32:35], s64 offen lds
v_mfma_f32_16x16x32_bf16 v[208:211], a[12:15], a[80:83], v[208:211]
ds_read_b64_tr_b16 a[80:81], v6 offset:24576
v_add_f32 v17, v17, v19
v_mfma_f32_16x16x32_bf16 v[188:191], a[0:3], a[84:87], v[188:191]
ds_read_b64_tr_b16 a[82:83], v6 offset:25600
v_add_f32 v17, v17, v18
v_mfma_f32_16x16x32_bf16 v[196:199], a[4:7], a[84:87], v[196:199]
s_add_u32 m0, s76, 5120
v_accvgpr_read_b32 v19, a136
v_accvgpr_read_b32 v21, a152
v_mfma_f32_16x16x32_bf16 v[204:207], a[8:11], a[84:87], v[204:207]
s_add_u32 s64, s70, 41472
v_lshlrev_b32 v18, 16, v19
v_and_b32 v19, 0xffff0000, v19
v_mfma_f32_16x16x32_bf16 v[212:215], a[12:15], a[84:87], v[212:215]
ds_read_b64_tr_b16 a[84:85], v7 offset:24576
v_lshlrev_b32 v20, 16, v21
v_mfma_f32_16x16x32_bf16 v[216:219], a[0:3], a[88:91], v[216:219]
ds_read_b64_tr_b16 a[86:87], v7 offset:25600
v_and_b32 v21, 0xffff0000, v21
v_mfma_f32_16x16x32_bf16 v[224:227], a[4:7], a[88:91], v[224:227]
buffer_load_dwordx4 v13, s[32:35], s64 offen lds
v_mfma_f32_16x16x32_bf16 v[232:235], a[8:11], a[88:91], v[232:235]
v_mul_f32 v18, v18, v20
v_mul_f32 v19, v19, v21
v_mfma_f32_16x16x32_bf16 v[240:243], a[12:15], a[88:91], v[240:243]
ds_read_b64_tr_b16 a[88:89], v8 offset:24576
v_cvt_pk_bf16_f32 v18, v18, v19
v_mfma_f32_16x16x32_bf16 v[220:223], a[0:3], a[92:95], v[220:223]
ds_read_b64_tr_b16 a[90:91], v8 offset:25600
v_lshlrev_b32 v19, 16, v18
v_mfma_f32_16x16x32_bf16 v[228:231], a[4:7], a[92:95], v[228:231]
s_add_u32 m0, s76, 6144
v_and_b32 v18, 0xffff0000, v18
v_add_f32 v17, v17, v19
v_mfma_f32_16x16x32_bf16 v[236:239], a[8:11], a[92:95], v[236:239]
s_add_u32 s64, s70, 49664
v_add_f32 v17, v17, v18
v_accvgpr_read_b32 v19, a137
v_mfma_f32_16x16x32_bf16 v[244:247], a[12:15], a[92:95], v[244:247]
ds_read_b64_tr_b16 a[92:93], v9 offset:24576
v_accvgpr_read_b32 v21, a153
v_mfma_f32_16x16x32_bf16 v[248:251], a[0:3], a[96:99], v[248:251]
buffer_load_dwordx4 v12, s[32:35], s64 offen lds
v_mfma_f32_16x16x32_bf16 v[252:255], a[4:7], a[96:99], v[252:255]
ds_read_b64_tr_b16 a[94:95], v9 offset:25600
v_lshlrev_b32 v18, 16, v19
v_mfma_f32_16x16x32_bf16 a[104:107], a[8:11], a[96:99], a[104:107]
v_and_b32 v19, 0xffff0000, v19
v_lshlrev_b32 v20, 16, v21
v_mfma_f32_16x16x32_bf16 a[108:111], a[12:15], a[96:99], a[108:111]
s_waitcnt lgkmcnt(4)
ds_read_b64_tr_b16 a[96:97], v10 offset:24576
v_and_b32 v21, 0xffff0000, v21
v_mfma_f32_16x16x32_bf16 a[112:115], a[0:3], a[100:103], a[112:115]
ds_read_b64_tr_b16 a[98:99], v10 offset:25600
v_mul_f32 v18, v18, v20
v_mfma_f32_16x16x32_bf16 a[116:119], a[4:7], a[100:103], a[116:119]
s_add_u32 m0, s76, 7168
v_mul_f32 v19, v19, v21
v_cvt_pk_bf16_f32 v18, v18, v19
v_mfma_f32_16x16x32_bf16 a[120:123], a[8:11], a[100:103], a[120:123]
s_add_u32 s64, s70, 57856
v_lshlrev_b32 v19, 16, v18
v_and_b32 v18, 0xffff0000, v18
v_mfma_f32_16x16x32_bf16 a[124:127], a[12:15], a[100:103], a[124:127]
ds_read_b64_tr_b16 a[100:101], v11 offset:24576
v_add_f32 v17, v17, v19
v_mfma_f32_16x16x32_bf16 v[24:27], a[40:43], a[20:23], v[24:27]
ds_read_b64_tr_b16 a[102:103], v11 offset:25600
v_add_f32 v17, v17, v18
v_mfma_f32_16x16x32_bf16 v[40:43], a[40:43], a[24:27], v[40:43]
buffer_load_dwordx4 v13, s[32:35], s64 offen lds
v_mfma_f32_16x16x32_bf16 v[56:59], a[40:43], a[28:31], v[56:59]
v_accvgpr_read_b32 v19, a138
v_accvgpr_read_b32 v21, a154
v_mfma_f32_16x16x32_bf16 v[72:75], a[40:43], a[32:35], v[72:75]
v_lshlrev_b32 v18, 16, v19
v_and_b32 v19, 0xffff0000, v19
v_mfma_f32_16x16x32_bf16 v[88:91], a[44:47], a[20:23], v[88:91]
v_lshlrev_b32 v20, 16, v21
v_and_b32 v21, 0xffff0000, v21
v_mfma_f32_16x16x32_bf16 v[104:107], a[44:47], a[24:27], v[104:107]
v_mul_f32 v18, v18, v20
v_mul_f32 v19, v19, v21
v_mfma_f32_16x16x32_bf16 v[120:123], a[44:47], a[28:31], v[120:123]
v_cvt_pk_bf16_f32 v18, v18, v19
v_lshlrev_b32 v19, 16, v18
v_mfma_f32_16x16x32_bf16 v[136:139], a[44:47], a[32:35], v[136:139]
v_and_b32 v18, 0xffff0000, v18
v_add_f32 v17, v17, v19
v_mfma_f32_16x16x32_bf16 v[28:31], a[48:51], a[20:23], v[28:31]
s_waitcnt vmcnt(9) lgkmcnt(0)
s_barrier
v_mfma_f32_16x16x32_bf16 v[44:47], a[48:51], a[24:27], v[44:47]
s_add_u32 m0, s77, 65536
ds_read_b64_tr_b16 a[40:41], v4 offset:32768
v_add_f32 v17, v17, v18
v_mfma_f32_16x16x32_bf16 v[60:63], a[48:51], a[28:31], v[60:63]
s_add_u32 s64, s71, 2097152
ds_read_b64_tr_b16 a[42:43], v4 offset:33792
v_accvgpr_read_b32 v19, a139
v_mfma_f32_16x16x32_bf16 v[76:79], a[48:51], a[32:35], v[76:79]
buffer_load_dwordx4 v14, s[36:39], s64 offen lds
v_mfma_f32_16x16x32_bf16 v[92:95], a[52:55], a[20:23], v[92:95]
ds_read_b64_tr_b16 a[44:45], v5 offset:32768
v_accvgpr_read_b32 v21, a155
v_mfma_f32_16x16x32_bf16 v[108:111], a[52:55], a[24:27], v[108:111]
ds_read_b64_tr_b16 a[46:47], v5 offset:33792
v_lshlrev_b32 v18, 16, v19
v_mfma_f32_16x16x32_bf16 v[124:127], a[52:55], a[28:31], v[124:127]
ds_read_b64_tr_b16 a[48:49], v6 offset:32768
v_and_b32 v19, 0xffff0000, v19
v_mfma_f32_16x16x32_bf16 v[140:143], a[52:55], a[32:35], v[140:143]
ds_read_b64_tr_b16 a[50:51], v6 offset:33792
v_lshlrev_b32 v20, 16, v21
v_mfma_f32_16x16x32_bf16 v[32:35], a[56:59], a[20:23], v[32:35]
s_add_u32 m0, s77, 66560
ds_read_b64_tr_b16 a[52:53], v7 offset:32768
v_and_b32 v21, 0xffff0000, v21
v_mfma_f32_16x16x32_bf16 v[48:51], a[56:59], a[24:27], v[48:51]
s_add_u32 s64, s71, 2129920
ds_read_b64_tr_b16 a[54:55], v7 offset:33792
v_mul_f32 v18, v18, v20
v_mfma_f32_16x16x32_bf16 v[64:67], a[56:59], a[28:31], v[64:67]
buffer_load_dwordx4 v14, s[36:39], s64 offen lds
v_mfma_f32_16x16x32_bf16 v[80:83], a[56:59], a[32:35], v[80:83]
ds_read_b64_tr_b16 a[56:57], v8 offset:32768
v_mul_f32 v19, v19, v21
v_mfma_f32_16x16x32_bf16 v[96:99], a[60:63], a[20:23], v[96:99]
ds_read_b64_tr_b16 a[58:59], v8 offset:33792
v_cvt_pk_bf16_f32 v18, v18, v19
v_mfma_f32_16x16x32_bf16 v[112:115], a[60:63], a[24:27], v[112:115]
ds_read_b128 a[0:3], v2 offset:32768
v_lshlrev_b32 v19, 16, v18
v_mfma_f32_16x16x32_bf16 v[128:131], a[60:63], a[28:31], v[128:131]
ds_read_b128 a[4:7], v2 offset:34816
v_and_b32 v18, 0xffff0000, v18
v_mfma_f32_16x16x32_bf16 v[144:147], a[60:63], a[32:35], v[144:147]
ds_read_b64_tr_b16 a[60:61], v9 offset:32768
v_add_f32 v17, v17, v19
v_mfma_f32_16x16x32_bf16 v[36:39], a[64:67], a[20:23], v[36:39]
s_add_u32 m0, s77, 67584
ds_read_b64_tr_b16 a[62:63], v9 offset:33792
v_add_f32 v17, v17, v18
v_mfma_f32_16x16x32_bf16 v[52:55], a[64:67], a[24:27], v[52:55]
s_add_u32 s64, s71, 2162688
ds_read_b128 a[8:11], v2 offset:36864
v_accvgpr_read_b32 v19, a140
v_mfma_f32_16x16x32_bf16 v[68:71], a[64:67], a[28:31], v[68:71]
buffer_load_dwordx4 v15, s[36:39], s64 offen lds
v_mfma_f32_16x16x32_bf16 v[84:87], a[64:67], a[32:35], v[84:87]
ds_read_b64_tr_b16 a[64:65], v10 offset:32768
v_accvgpr_read_b32 v21, a156
v_mfma_f32_16x16x32_bf16 v[100:103], a[68:71], a[20:23], v[100:103]
ds_read_b64_tr_b16 a[66:67], v10 offset:33792
v_lshlrev_b32 v18, 16, v19
v_mfma_f32_16x16x32_bf16 v[116:119], a[68:71], a[24:27], v[116:119]
ds_read_b128 a[12:15], v2 offset:38912
v_and_b32 v19, 0xffff0000, v19
v_mfma_f32_16x16x32_bf16 v[132:135], a[68:71], a[28:31], v[132:135]
v_lshlrev_b32 v20, 16, v21
v_and_b32 v21, 0xffff0000, v21
v_mfma_f32_16x16x32_bf16 v[148:151], a[68:71], a[32:35], v[148:151]
s_add_u32 m0, s77, 68608
ds_read_b64_tr_b16 a[68:69], v11 offset:32768
v_mul_f32 v18, v18, v20
v_mfma_f32_16x16x32_bf16 v[152:155], a[20:23], a[72:75], v[152:155]
s_add_u32 s64, s71, 2195456
ds_read_b64_tr_b16 a[70:71], v11 offset:33792
v_mul_f32 v19, v19, v21
v_mfma_f32_16x16x32_bf16 v[160:163], a[24:27], a[72:75], v[160:163]
buffer_load_dwordx4 v15, s[36:39], s64 offen lds
v_mfma_f32_16x16x32_bf16 v[168:171], a[28:31], a[72:75], v[168:171]
v_cvt_pk_bf16_f32 v18, v18, v19
v_lshlrev_b32 v19, 16, v18
v_mfma_f32_16x16x32_bf16 v[176:179], a[32:35], a[72:75], v[176:179]
ds_read_b64_tr_b16 a[72:73], v4 offset:49152
v_and_b32 v18, 0xffff0000, v18
v_mfma_f32_16x16x32_bf16 v[156:159], a[20:23], a[76:79], v[156:159]
ds_read_b64_tr_b16 a[74:75], v4 offset:50176
v_add_f32 v17, v17, v19
v_mfma_f32_16x16x32_bf16 v[164:167], a[24:27], a[76:79], v[164:167]
s_add_u32 m0, s77, 81920
v_add_f32 v17, v17, v18
v_accvgpr_read_b32 v19, a141
v_mfma_f32_16x16x32_bf16 v[172:175], a[28:31], a[76:79], v[172:175]
s_add_u32 s64, s71, 2097152
v_accvgpr_read_b32 v21, a157
v_lshlrev_b32 v18, 16, v19
v_mfma_f32_16x16x32_bf16 v[180:183], a[32:35], a[76:79], v[180:183]
ds_read_b64_tr_b16 a[76:77], v5 offset:49152
v_and_b32 v19, 0xffff0000, v19
v_mfma_f32_16x16x32_bf16 v[184:187], a[20:23], a[80:83], v[184:187]
ds_read_b64_tr_b16 a[78:79], v5 offset:50176
v_lshlrev_b32 v20, 16, v21
v_mfma_f32_16x16x32_bf16 v[192:195], a[24:27], a[80:83], v[192:195]
buffer_load_dwordx4 v14, s[40:43], s64 offen lds
v_mfma_f32_16x16x32_bf16 v[200:203], a[28:31], a[80:83], v[200:203]
v_and_b32 v21, 0xffff0000, v21
v_mul_f32 v18, v18, v20
v_mfma_f32_16x16x32_bf16 v[208:211], a[32:35], a[80:83], v[208:211]
ds_read_b64_tr_b16 a[80:81], v6 offset:49152
v_mul_f32 v19, v19, v21
v_mfma_f32_16x16x32_bf16 v[188:191], a[20:23], a[84:87], v[188:191]
ds_read_b64_tr_b16 a[82:83], v6 offset:50176
v_cvt_pk_bf16_f32 v18, v18, v19
v_mfma_f32_16x16x32_bf16 v[196:199], a[24:27], a[84:87], v[196:199]
s_add_u32 m0, s77, 82944
v_lshlrev_b32 v19, 16, v18
v_and_b32 v18, 0xffff0000, v18
v_mfma_f32_16x16x32_bf16 v[204:207], a[28:31], a[84:87], v[204:207]
s_add_u32 s64, s71, 2129920
v_add_f32 v17, v17, v19
v_add_f32 v17, v17, v18
v_mfma_f32_16x16x32_bf16 v[212:215], a[32:35], a[84:87], v[212:215]
ds_read_b64_tr_b16 a[84:85], v7 offset:49152
v_accvgpr_read_b32 v19, a142
v_mfma_f32_16x16x32_bf16 v[216:219], a[20:23], a[88:91], v[216:219]
ds_read_b64_tr_b16 a[86:87], v7 offset:50176
v_accvgpr_read_b32 v21, a158
v_mfma_f32_16x16x32_bf16 v[224:227], a[24:27], a[88:91], v[224:227]
buffer_load_dwordx4 v14, s[40:43], s64 offen lds
v_mfma_f32_16x16x32_bf16 v[232:235], a[28:31], a[88:91], v[232:235]
v_lshlrev_b32 v18, 16, v19
v_and_b32 v19, 0xffff0000, v19
v_mfma_f32_16x16x32_bf16 v[240:243], a[32:35], a[88:91], v[240:243]
ds_read_b64_tr_b16 a[88:89], v8 offset:49152
v_lshlrev_b32 v20, 16, v21
v_mfma_f32_16x16x32_bf16 v[220:223], a[20:23], a[92:95], v[220:223]
ds_read_b64_tr_b16 a[90:91], v8 offset:50176
v_and_b32 v21, 0xffff0000, v21
v_mfma_f32_16x16x32_bf16 v[228:231], a[24:27], a[92:95], v[228:231]
s_add_u32 m0, s77, 83968
v_mul_f32 v18, v18, v20
v_mul_f32 v19, v19, v21
v_mfma_f32_16x16x32_bf16 v[236:239], a[28:31], a[92:95], v[236:239]
s_add_u32 s64, s71, 2162688
v_cvt_pk_bf16_f32 v18, v18, v19
v_lshlrev_b32 v19, 16, v18
v_mfma_f32_16x16x32_bf16 v[244:247], a[32:35], a[92:95], v[244:247]
ds_read_b64_tr_b16 a[92:93], v9 offset:49152
v_and_b32 v18, 0xffff0000, v18
v_mfma_f32_16x16x32_bf16 v[248:251], a[20:23], a[96:99], v[248:251]
buffer_load_dwordx4 v15, s[40:43], s64 offen lds
v_mfma_f32_16x16x32_bf16 v[252:255], a[24:27], a[96:99], v[252:255]
ds_read_b64_tr_b16 a[94:95], v9 offset:50176
v_add_f32 v17, v17, v19
v_mfma_f32_16x16x32_bf16 a[104:107], a[28:31], a[96:99], a[104:107]
v_add_f32 v17, v17, v18
v_accvgpr_read_b32 v19, a143
v_mfma_f32_16x16x32_bf16 a[108:111], a[32:35], a[96:99], a[108:111]
ds_read_b64_tr_b16 a[96:97], v10 offset:49152
v_accvgpr_read_b32 v21, a159
v_mfma_f32_16x16x32_bf16 a[112:115], a[20:23], a[100:103], a[112:115]
ds_read_b64_tr_b16 a[98:99], v10 offset:50176
v_lshlrev_b32 v18, 16, v19
v_mfma_f32_16x16x32_bf16 a[116:119], a[24:27], a[100:103], a[116:119]
s_add_u32 m0, s77, 84992
v_and_b32 v19, 0xffff0000, v19
v_lshlrev_b32 v20, 16, v21
v_mfma_f32_16x16x32_bf16 a[120:123], a[28:31], a[100:103], a[120:123]
s_add_u32 s64, s71, 2195456
v_and_b32 v21, 0xffff0000, v21
v_mul_f32 v18, v18, v20
v_mfma_f32_16x16x32_bf16 a[124:127], a[32:35], a[100:103], a[124:127]
s_waitcnt lgkmcnt(4)
ds_read_b64_tr_b16 a[100:101], v11 offset:49152
v_mul_f32 v19, v19, v21
v_mfma_f32_16x16x32_bf16 v[24:27], a[40:43], a[0:3], v[24:27]
buffer_load_dwordx4 v15, s[40:43], s64 offen lds
v_mfma_f32_16x16x32_bf16 v[40:43], a[40:43], a[4:7], v[40:43]
ds_read_b128 a[20:23], v3 offset:32768
v_cvt_pk_bf16_f32 v18, v18, v19
v_mfma_f32_16x16x32_bf16 v[56:59], a[40:43], a[8:11], v[56:59]
ds_read_b128 a[24:27], v3 offset:34816
v_lshlrev_b32 v19, 16, v18
v_mfma_f32_16x16x32_bf16 v[72:75], a[40:43], a[12:15], v[72:75]
ds_read_b128 a[28:31], v3 offset:36864
v_and_b32 v18, 0xffff0000, v18
v_mfma_f32_16x16x32_bf16 v[88:91], a[44:47], a[0:3], v[88:91]
ds_read_b128 a[32:35], v3 offset:38912
v_add_f32 v17, v17, v19
v_mfma_f32_16x16x32_bf16 v[104:107], a[44:47], a[4:7], v[104:107]
ds_read_b64_tr_b16 a[40:41], v4 offset:40960
v_add_f32 v17, v17, v18
v_mfma_f32_16x16x32_bf16 v[120:123], a[44:47], a[8:11], v[120:123]
ds_read_b64_tr_b16 a[42:43], v4 offset:41984
v_mfma_f32_16x16x32_bf16 v[136:139], a[44:47], a[12:15], v[136:139]
ds_read_b64_tr_b16 a[44:45], v5 offset:40960
v_add_f32_dpp v17, v17, v17 row_ror:8 row_mask:0xf bank_mask:0xf
v_mfma_f32_16x16x32_bf16 v[28:31], a[48:51], a[0:3], v[28:31]
ds_read_b64_tr_b16 a[46:47], v5 offset:41984
v_mfma_f32_16x16x32_bf16 v[44:47], a[48:51], a[4:7], v[44:47]
ds_read_b64_tr_b16 a[102:103], v11 offset:50176
v_add_f32_dpp v17, v17, v17 row_ror:4 row_mask:0xf bank_mask:0xf
v_mfma_f32_16x16x32_bf16 v[60:63], a[48:51], a[8:11], v[60:63]
v_mfma_f32_16x16x32_bf16 v[76:79], a[48:51], a[12:15], v[76:79]
ds_read_b64_tr_b16 a[48:49], v6 offset:40960
v_add_f32_dpp v17, v17, v17 row_ror:2 row_mask:0xf bank_mask:0xf
v_mfma_f32_16x16x32_bf16 v[92:95], a[52:55], a[0:3], v[92:95]
ds_read_b64_tr_b16 a[50:51], v6 offset:41984
v_mfma_f32_16x16x32_bf16 v[108:111], a[52:55], a[4:7], v[108:111]
s_waitcnt lgkmcnt(7)
v_add_f32_dpp v17, v17, v17 row_ror:1 row_mask:0xf bank_mask:0xf
v_mov_b32 v18, v17
v_mfma_f32_16x16x32_bf16 v[124:127], a[52:55], a[8:11], v[124:127]
s_add_u32 m0, s76, 32768
v_mfma_f32_16x16x32_bf16 v[140:143], a[52:55], a[12:15], v[140:143]
s_add_u32 s64, s70, 640
ds_read_b64_tr_b16 a[52:53], v7 offset:40960
v_permlane16_swap_b32 v18, v17
v_mfma_f32_16x16x32_bf16 v[32:35], a[56:59], a[0:3], v[32:35]
buffer_load_dwordx4 v12, s[32:35], s64 offen lds
v_mfma_f32_16x16x32_bf16 v[48:51], a[56:59], a[4:7], v[48:51]
ds_read_b64_tr_b16 a[54:55], v7 offset:41984
v_add_f32 v17, v17, v18
v_mfma_f32_16x16x32_bf16 v[64:67], a[56:59], a[8:11], v[64:67]
v_cvt_pk_bf16_f32 v17, v17, v17
v_mfma_f32_16x16x32_bf16 v[80:83], a[56:59], a[12:15], v[80:83]
s_add_u32 m0, s76, 33792
ds_read_b64_tr_b16 a[56:57], v8 offset:40960
v_and_b32 v17, 0xffff0000, v17
v_mfma_f32_16x16x32_bf16 v[96:99], a[60:63], a[0:3], v[96:99]
s_add_u32 s64, s70, 8832
ds_read_b64_tr_b16 a[58:59], v8 offset:41984
v_mul_f32 v17, 0xbfb8aa3b, v17
v_mfma_f32_16x16x32_bf16 v[112:115], a[60:63], a[4:7], v[112:115]
buffer_load_dwordx4 v13, s[32:35], s64 offen lds
v_mfma_f32_16x16x32_bf16 v[128:131], a[60:63], a[8:11], v[128:131]
v_exp_f32 v17, v17
v_mfma_f32_16x16x32_bf16 v[144:147], a[60:63], a[12:15], v[144:147]
ds_read_b64_tr_b16 a[60:61], v9 offset:40960
v_add_f32 v17, 1.0, v17
v_mfma_f32_16x16x32_bf16 v[36:39], a[64:67], a[0:3], v[36:39]
ds_read_b64_tr_b16 a[62:63], v9 offset:41984
v_mfma_f32_16x16x32_bf16 v[52:55], a[64:67], a[4:7], v[52:55]
s_add_u32 m0, s76, 34816
v_rcp_f32 v17, v17
v_mfma_f32_16x16x32_bf16 v[68:71], a[64:67], a[8:11], v[68:71]
s_add_u32 s64, s70, 17024
v_cvt_pk_bf16_f32 v18, v17, v17
v_mfma_f32_16x16x32_bf16 v[84:87], a[64:67], a[12:15], v[84:87]
ds_read_b64_tr_b16 a[64:65], v10 offset:40960
v_and_b32 v18, 0xffff0000, v18
v_mfma_f32_16x16x32_bf16 v[100:103], a[68:71], a[0:3], v[100:103]
buffer_load_dwordx4 v12, s[32:35], s64 offen lds
v_mfma_f32_16x16x32_bf16 v[116:119], a[68:71], a[4:7], v[116:119]
ds_read_b64_tr_b16 a[66:67], v10 offset:41984
v_sub_f32 v19, 1.0, v18
v_mfma_f32_16x16x32_bf16 v[132:135], a[68:71], a[8:11], v[132:135]
v_cvt_pk_bf16_f32 v19, v19, v19
v_mfma_f32_16x16x32_bf16 v[148:151], a[68:71], a[12:15], v[148:151]
ds_read_b64_tr_b16 a[68:69], v11 offset:40960
v_and_b32 v19, 0xffff0000, v19
v_mfma_f32_16x16x32_bf16 v[152:155], a[0:3], a[72:75], v[152:155]
ds_read_b64_tr_b16 a[70:71], v11 offset:41984
v_and_b32 v20, 31, v0
v_mfma_f32_16x16x32_bf16 v[160:163], a[4:7], a[72:75], v[160:163]
s_add_u32 m0, s76, 35840
v_lshlrev_b32 v20, 27, v20
v_mfma_f32_16x16x32_bf16 v[168:171], a[8:11], a[72:75], v[168:171]
s_add_u32 s64, s70, 25216
v_lshrrev_b32 v21, 2, v0
v_mfma_f32_16x16x32_bf16 v[176:179], a[12:15], a[72:75], v[176:179]
buffer_load_dwordx4 v13, s[32:35], s64 offen lds
v_mfma_f32_16x16x32_bf16 v[156:159], a[0:3], a[76:79], v[156:159]
ds_read_b64_tr_b16 a[72:73], v4 offset:57344
v_add_u32 v20, v20, v21
v_mfma_f32_16x16x32_bf16 v[164:167], a[4:7], a[76:79], v[164:167]
s_lshl2_add_u32 s65, s2, s30
ds_read_b64_tr_b16 a[74:75], v4 offset:58368
v_mfma_f32_16x16x32_bf16 v[172:175], a[8:11], a[76:79], v[172:175]
s_lshl4_add_u32 s65, s65, 58720256
v_mfma_f32_16x16x32_bf16 v[180:183], a[12:15], a[76:79], v[180:183]
s_add_u32 m0, s76, 36864
ds_read_b64_tr_b16 a[76:77], v5 offset:57344
v_mfma_f32_16x16x32_bf16 v[184:187], a[0:3], a[80:83], v[184:187]
s_add_u32 s64, s70, 33408
ds_read_b64_tr_b16 a[78:79], v5 offset:58368
v_mfma_f32_16x16x32_bf16 v[192:195], a[4:7], a[80:83], v[192:195]
buffer_store_dwordx2 v[18:19], v20, s[44:47], s65 offen sc1
v_mfma_f32_16x16x32_bf16 v[200:203], a[8:11], a[80:83], v[200:203]
buffer_load_dwordx4 v12, s[32:35], s64 offen lds
v_mfma_f32_16x16x32_bf16 v[208:211], a[12:15], a[80:83], v[208:211]
ds_read_b64_tr_b16 a[80:81], v6 offset:57344
v_mfma_f32_16x16x32_bf16 v[188:191], a[0:3], a[84:87], v[188:191]
ds_read_b64_tr_b16 a[82:83], v6 offset:58368
v_mfma_f32_16x16x32_bf16 v[196:199], a[4:7], a[84:87], v[196:199]
v_mfma_f32_16x16x32_bf16 v[204:207], a[8:11], a[84:87], v[204:207]
v_mfma_f32_16x16x32_bf16 v[212:215], a[12:15], a[84:87], v[212:215]
s_add_u32 m0, s76, 37888
ds_read_b64_tr_b16 a[84:85], v7 offset:57344
v_mfma_f32_16x16x32_bf16 v[216:219], a[0:3], a[88:91], v[216:219]
s_add_u32 s64, s70, 41600
ds_read_b64_tr_b16 a[86:87], v7 offset:58368
v_mfma_f32_16x16x32_bf16 v[224:227], a[4:7], a[88:91], v[224:227]
buffer_load_dwordx4 v13, s[32:35], s64 offen lds
v_mfma_f32_16x16x32_bf16 v[232:235], a[8:11], a[88:91], v[232:235]
v_mfma_f32_16x16x32_bf16 v[240:243], a[12:15], a[88:91], v[240:243]
ds_read_b64_tr_b16 a[88:89], v8 offset:57344
v_mfma_f32_16x16x32_bf16 v[220:223], a[0:3], a[92:95], v[220:223]
ds_read_b64_tr_b16 a[90:91], v8 offset:58368
v_mfma_f32_16x16x32_bf16 v[228:231], a[4:7], a[92:95], v[228:231]
v_mfma_f32_16x16x32_bf16 v[236:239], a[8:11], a[92:95], v[236:239]
s_add_u32 m0, s76, 38912
v_mfma_f32_16x16x32_bf16 v[244:247], a[12:15], a[92:95], v[244:247]
s_add_u32 s64, s70, 49792
ds_read_b64_tr_b16 a[92:93], v9 offset:57344
v_mfma_f32_16x16x32_bf16 v[248:251], a[0:3], a[96:99], v[248:251]
buffer_load_dwordx4 v12, s[32:35], s64 offen lds
v_mfma_f32_16x16x32_bf16 v[252:255], a[4:7], a[96:99], v[252:255]
ds_read_b64_tr_b16 a[94:95], v9 offset:58368
v_mfma_f32_16x16x32_bf16 a[104:107], a[8:11], a[96:99], a[104:107]
v_mfma_f32_16x16x32_bf16 a[108:111], a[12:15], a[96:99], a[108:111]
s_waitcnt lgkmcnt(4)
ds_read_b64_tr_b16 a[96:97], v10 offset:57344
v_mfma_f32_16x16x32_bf16 a[112:115], a[0:3], a[100:103], a[112:115]
ds_read_b64_tr_b16 a[98:99], v10 offset:58368
v_mfma_f32_16x16x32_bf16 a[116:119], a[4:7], a[100:103], a[116:119]
v_mfma_f32_16x16x32_bf16 a[120:123], a[8:11], a[100:103], a[120:123]
v_mfma_f32_16x16x32_bf16 a[124:127], a[12:15], a[100:103], a[124:127]
s_add_u32 m0, s76, 39936
ds_read_b64_tr_b16 a[100:101], v11 offset:57344
v_mfma_f32_16x16x32_bf16 v[24:27], a[40:43], a[20:23], v[24:27]
s_add_u32 s64, s70, 57984
ds_read_b64_tr_b16 a[102:103], v11 offset:58368
v_mfma_f32_16x16x32_bf16 v[40:43], a[40:43], a[24:27], v[40:43]
buffer_load_dwordx4 v13, s[32:35], s64 offen lds
v_mfma_f32_16x16x32_bf16 v[56:59], a[40:43], a[28:31], v[56:59]
v_mfma_f32_16x16x32_bf16 v[72:75], a[40:43], a[32:35], v[72:75]
v_mfma_f32_16x16x32_bf16 v[88:91], a[44:47], a[20:23], v[88:91]
v_mfma_f32_16x16x32_bf16 v[104:107], a[44:47], a[24:27], v[104:107]
v_mfma_f32_16x16x32_bf16 v[120:123], a[44:47], a[28:31], v[120:123]
v_mfma_f32_16x16x32_bf16 v[136:139], a[44:47], a[32:35], v[136:139]
v_mfma_f32_16x16x32_bf16 v[28:31], a[48:51], a[20:23], v[28:31]
s_waitcnt vmcnt(9) lgkmcnt(0)
s_barrier
v_mfma_f32_16x16x32_bf16 v[44:47], a[48:51], a[24:27], v[44:47]
s_add_u32 m0, s77, 98304
ds_read_b64_tr_b16 a[40:41], v4 offset:0
v_mfma_f32_16x16x32_bf16 v[60:63], a[48:51], a[28:31], v[60:63]
s_add_u32 s64, s71, 2621440
ds_read_b64_tr_b16 a[42:43], v4 offset:1024
v_mfma_f32_16x16x32_bf16 v[76:79], a[48:51], a[32:35], v[76:79]
buffer_load_dwordx4 v14, s[36:39], s64 offen lds
v_mfma_f32_16x16x32_bf16 v[92:95], a[52:55], a[20:23], v[92:95]
ds_read_b64_tr_b16 a[44:45], v5 offset:0
v_mfma_f32_16x16x32_bf16 v[108:111], a[52:55], a[24:27], v[108:111]
ds_read_b64_tr_b16 a[46:47], v5 offset:1024
v_mfma_f32_16x16x32_bf16 v[124:127], a[52:55], a[28:31], v[124:127]
ds_read_b64_tr_b16 a[48:49], v6 offset:0
v_mfma_f32_16x16x32_bf16 v[140:143], a[52:55], a[32:35], v[140:143]
ds_read_b64_tr_b16 a[50:51], v6 offset:1024
v_mfma_f32_16x16x32_bf16 v[32:35], a[56:59], a[20:23], v[32:35]
s_add_u32 m0, s77, 99328
ds_read_b64_tr_b16 a[52:53], v7 offset:0
v_mfma_f32_16x16x32_bf16 v[48:51], a[56:59], a[24:27], v[48:51]
s_add_u32 s64, s71, 2654208
ds_read_b64_tr_b16 a[54:55], v7 offset:1024
v_mfma_f32_16x16x32_bf16 v[64:67], a[56:59], a[28:31], v[64:67]
buffer_load_dwordx4 v14, s[36:39], s64 offen lds
v_mfma_f32_16x16x32_bf16 v[80:83], a[56:59], a[32:35], v[80:83]
ds_read_b64_tr_b16 a[56:57], v8 offset:0
v_mfma_f32_16x16x32_bf16 v[96:99], a[60:63], a[20:23], v[96:99]
ds_read_b64_tr_b16 a[58:59], v8 offset:1024
v_mfma_f32_16x16x32_bf16 v[112:115], a[60:63], a[24:27], v[112:115]
ds_read_b128 a[0:3], v2 offset:0
v_mfma_f32_16x16x32_bf16 v[128:131], a[60:63], a[28:31], v[128:131]
ds_read_b128 a[4:7], v2 offset:2048
v_mfma_f32_16x16x32_bf16 v[144:147], a[60:63], a[32:35], v[144:147]
ds_read_b64_tr_b16 a[60:61], v9 offset:0
v_mfma_f32_16x16x32_bf16 v[36:39], a[64:67], a[20:23], v[36:39]
s_add_u32 m0, s77, 100352
ds_read_b64_tr_b16 a[62:63], v9 offset:1024
v_mfma_f32_16x16x32_bf16 v[52:55], a[64:67], a[24:27], v[52:55]
s_add_u32 s64, s71, 2686976
ds_read_b128 a[8:11], v2 offset:4096
v_mfma_f32_16x16x32_bf16 v[68:71], a[64:67], a[28:31], v[68:71]
buffer_load_dwordx4 v15, s[36:39], s64 offen lds
v_mfma_f32_16x16x32_bf16 v[84:87], a[64:67], a[32:35], v[84:87]
ds_read_b64_tr_b16 a[64:65], v10 offset:0
v_mfma_f32_16x16x32_bf16 v[100:103], a[68:71], a[20:23], v[100:103]
ds_read_b64_tr_b16 a[66:67], v10 offset:1024
v_mfma_f32_16x16x32_bf16 v[116:119], a[68:71], a[24:27], v[116:119]
ds_read_b128 a[12:15], v2 offset:6144
v_mfma_f32_16x16x32_bf16 v[132:135], a[68:71], a[28:31], v[132:135]
v_mfma_f32_16x16x32_bf16 v[148:151], a[68:71], a[32:35], v[148:151]
s_add_u32 m0, s77, 101376
ds_read_b64_tr_b16 a[68:69], v11 offset:0
v_mfma_f32_16x16x32_bf16 v[152:155], a[20:23], a[72:75], v[152:155]
s_add_u32 s64, s71, 2719744
ds_read_b64_tr_b16 a[70:71], v11 offset:1024
v_mfma_f32_16x16x32_bf16 v[160:163], a[24:27], a[72:75], v[160:163]
buffer_load_dwordx4 v15, s[36:39], s64 offen lds
v_mfma_f32_16x16x32_bf16 v[168:171], a[28:31], a[72:75], v[168:171]
v_mfma_f32_16x16x32_bf16 v[176:179], a[32:35], a[72:75], v[176:179]
ds_read_b64_tr_b16 a[72:73], v4 offset:16384
v_mfma_f32_16x16x32_bf16 v[156:159], a[20:23], a[76:79], v[156:159]
ds_read_b64_tr_b16 a[74:75], v4 offset:17408
v_mfma_f32_16x16x32_bf16 v[164:167], a[24:27], a[76:79], v[164:167]
v_mfma_f32_16x16x32_bf16 v[172:175], a[28:31], a[76:79], v[172:175]
v_mfma_f32_16x16x32_bf16 v[180:183], a[32:35], a[76:79], v[180:183]
s_add_u32 m0, s77, 114688
ds_read_b64_tr_b16 a[76:77], v5 offset:16384
v_mfma_f32_16x16x32_bf16 v[184:187], a[20:23], a[80:83], v[184:187]
s_add_u32 s64, s71, 2621440
ds_read_b64_tr_b16 a[78:79], v5 offset:17408
v_mfma_f32_16x16x32_bf16 v[192:195], a[24:27], a[80:83], v[192:195]
buffer_load_dwordx4 v14, s[40:43], s64 offen lds
v_mfma_f32_16x16x32_bf16 v[200:203], a[28:31], a[80:83], v[200:203]
v_mfma_f32_16x16x32_bf16 v[208:211], a[32:35], a[80:83], v[208:211]
ds_read_b64_tr_b16 a[80:81], v6 offset:16384
v_mfma_f32_16x16x32_bf16 v[188:191], a[20:23], a[84:87], v[188:191]
ds_read_b64_tr_b16 a[82:83], v6 offset:17408
v_mfma_f32_16x16x32_bf16 v[196:199], a[24:27], a[84:87], v[196:199]
v_mfma_f32_16x16x32_bf16 v[204:207], a[28:31], a[84:87], v[204:207]
v_mfma_f32_16x16x32_bf16 v[212:215], a[32:35], a[84:87], v[212:215]
s_add_u32 m0, s77, 115712
ds_read_b64_tr_b16 a[84:85], v7 offset:16384
v_mfma_f32_16x16x32_bf16 v[216:219], a[20:23], a[88:91], v[216:219]
s_add_u32 s64, s71, 2654208
ds_read_b64_tr_b16 a[86:87], v7 offset:17408
v_mfma_f32_16x16x32_bf16 v[224:227], a[24:27], a[88:91], v[224:227]
buffer_load_dwordx4 v14, s[40:43], s64 offen lds
v_mfma_f32_16x16x32_bf16 v[232:235], a[28:31], a[88:91], v[232:235]
v_mfma_f32_16x16x32_bf16 v[240:243], a[32:35], a[88:91], v[240:243]
ds_read_b64_tr_b16 a[88:89], v8 offset:16384
v_mfma_f32_16x16x32_bf16 v[220:223], a[20:23], a[92:95], v[220:223]
ds_read_b64_tr_b16 a[90:91], v8 offset:17408
v_mfma_f32_16x16x32_bf16 v[228:231], a[24:27], a[92:95], v[228:231]
v_mfma_f32_16x16x32_bf16 v[236:239], a[28:31], a[92:95], v[236:239]
s_add_u32 m0, s77, 116736
v_mfma_f32_16x16x32_bf16 v[244:247], a[32:35], a[92:95], v[244:247]
s_add_u32 s64, s71, 2686976
ds_read_b64_tr_b16 a[92:93], v9 offset:16384
v_mfma_f32_16x16x32_bf16 v[248:251], a[20:23], a[96:99], v[248:251]
buffer_load_dwordx4 v15, s[40:43], s64 offen lds
v_mfma_f32_16x16x32_bf16 v[252:255], a[24:27], a[96:99], v[252:255]
ds_read_b64_tr_b16 a[94:95], v9 offset:17408
v_mfma_f32_16x16x32_bf16 a[104:107], a[28:31], a[96:99], a[104:107]
v_mfma_f32_16x16x32_bf16 a[108:111], a[32:35], a[96:99], a[108:111]
ds_read_b64_tr_b16 a[96:97], v10 offset:16384
v_mfma_f32_16x16x32_bf16 a[112:115], a[20:23], a[100:103], a[112:115]
ds_read_b64_tr_b16 a[98:99], v10 offset:17408
v_mfma_f32_16x16x32_bf16 a[116:119], a[24:27], a[100:103], a[116:119]
v_mfma_f32_16x16x32_bf16 a[120:123], a[28:31], a[100:103], a[120:123]
s_add_u32 m0, s77, 117760
v_mfma_f32_16x16x32_bf16 a[124:127], a[32:35], a[100:103], a[124:127]
s_waitcnt lgkmcnt(4)
s_add_u32 s64, s71, 2719744
ds_read_b64_tr_b16 a[100:101], v11 offset:16384
v_mfma_f32_16x16x32_bf16 v[24:27], a[40:43], a[0:3], v[24:27]
buffer_load_dwordx4 v15, s[40:43], s64 offen lds
v_mfma_f32_16x16x32_bf16 v[40:43], a[40:43], a[4:7], v[40:43]
ds_read_b128 a[20:23], v3 offset:0
v_mfma_f32_16x16x32_bf16 v[56:59], a[40:43], a[8:11], v[56:59]
ds_read_b128 a[24:27], v3 offset:2048
v_mfma_f32_16x16x32_bf16 v[72:75], a[40:43], a[12:15], v[72:75]
ds_read_b128 a[28:31], v3 offset:4096
v_mfma_f32_16x16x32_bf16 v[88:91], a[44:47], a[0:3], v[88:91]
ds_read_b128 a[32:35], v3 offset:6144
v_mfma_f32_16x16x32_bf16 v[104:107], a[44:47], a[4:7], v[104:107]
ds_read_b64_tr_b16 a[40:41], v4 offset:8192
v_mfma_f32_16x16x32_bf16 v[120:123], a[44:47], a[8:11], v[120:123]
ds_read_b64_tr_b16 a[42:43], v4 offset:9216
v_mfma_f32_16x16x32_bf16 v[136:139], a[44:47], a[12:15], v[136:139]
ds_read_b64_tr_b16 a[44:45], v5 offset:8192
v_mfma_f32_16x16x32_bf16 v[28:31], a[48:51], a[0:3], v[28:31]
ds_read_b64_tr_b16 a[46:47], v5 offset:9216
v_mfma_f32_16x16x32_bf16 v[44:47], a[48:51], a[4:7], v[44:47]
ds_read_b64_tr_b16 a[102:103], v11 offset:17408
v_mfma_f32_16x16x32_bf16 v[60:63], a[48:51], a[8:11], v[60:63]
v_mfma_f32_16x16x32_bf16 v[76:79], a[48:51], a[12:15], v[76:79]
ds_read_b64_tr_b16 a[48:49], v6 offset:8192
v_mfma_f32_16x16x32_bf16 v[92:95], a[52:55], a[0:3], v[92:95]
ds_read_b64_tr_b16 a[50:51], v6 offset:9216
v_mfma_f32_16x16x32_bf16 v[108:111], a[52:55], a[4:7], v[108:111]
s_waitcnt lgkmcnt(7)
v_mfma_f32_16x16x32_bf16 v[124:127], a[52:55], a[8:11], v[124:127]
s_add_u32 m0, s76, 0
v_mfma_f32_16x16x32_bf16 v[140:143], a[52:55], a[12:15], v[140:143]
s_add_u32 s64, s70, 768
ds_read_b64_tr_b16 a[52:53], v7 offset:8192
v_mfma_f32_16x16x32_bf16 v[32:35], a[56:59], a[0:3], v[32:35]
buffer_load_dwordx4 v12, s[32:35], s64 offen lds
v_mfma_f32_16x16x32_bf16 v[48:51], a[56:59], a[4:7], v[48:51]
ds_read_b64_tr_b16 a[54:55], v7 offset:9216
v_mfma_f32_16x16x32_bf16 v[64:67], a[56:59], a[8:11], v[64:67]
v_mfma_f32_16x16x32_bf16 v[80:83], a[56:59], a[12:15], v[80:83]
s_add_u32 m0, s76, 1024
ds_read_b64_tr_b16 a[56:57], v8 offset:8192
v_mfma_f32_16x16x32_bf16 v[96:99], a[60:63], a[0:3], v[96:99]
s_add_u32 s64, s70, 8960
ds_read_b64_tr_b16 a[58:59], v8 offset:9216
v_mfma_f32_16x16x32_bf16 v[112:115], a[60:63], a[4:7], v[112:115]
buffer_load_dwordx4 v13, s[32:35], s64 offen lds
v_mfma_f32_16x16x32_bf16 v[128:131], a[60:63], a[8:11], v[128:131]
v_mfma_f32_16x16x32_bf16 v[144:147], a[60:63], a[12:15], v[144:147]
ds_read_b64_tr_b16 a[60:61], v9 offset:8192
v_mfma_f32_16x16x32_bf16 v[36:39], a[64:67], a[0:3], v[36:39]
ds_read_b64_tr_b16 a[62:63], v9 offset:9216
v_mfma_f32_16x16x32_bf16 v[52:55], a[64:67], a[4:7], v[52:55]
v_mfma_f32_16x16x32_bf16 v[68:71], a[64:67], a[8:11], v[68:71]
s_add_u32 m0, s76, 2048
v_mfma_f32_16x16x32_bf16 v[84:87], a[64:67], a[12:15], v[84:87]
s_add_u32 s64, s70, 17152
ds_read_b64_tr_b16 a[64:65], v10 offset:8192
v_mfma_f32_16x16x32_bf16 v[100:103], a[68:71], a[0:3], v[100:103]
buffer_load_dwordx4 v12, s[32:35], s64 offen lds
v_mfma_f32_16x16x32_bf16 v[116:119], a[68:71], a[4:7], v[116:119]
ds_read_b64_tr_b16 a[66:67], v10 offset:9216
v_mfma_f32_16x16x32_bf16 v[132:135], a[68:71], a[8:11], v[132:135]
v_mfma_f32_16x16x32_bf16 v[148:151], a[68:71], a[12:15], v[148:151]
ds_read_b64_tr_b16 a[68:69], v11 offset:8192
v_mfma_f32_16x16x32_bf16 v[152:155], a[0:3], a[72:75], v[152:155]
ds_read_b64_tr_b16 a[70:71], v11 offset:9216
v_mfma_f32_16x16x32_bf16 v[160:163], a[4:7], a[72:75], v[160:163]
s_add_u32 m0, s76, 3072
v_mfma_f32_16x16x32_bf16 v[168:171], a[8:11], a[72:75], v[168:171]
s_add_u32 s64, s70, 25344
v_mfma_f32_16x16x32_bf16 v[176:179], a[12:15], a[72:75], v[176:179]
buffer_load_dwordx4 v13, s[32:35], s64 offen lds
v_mfma_f32_16x16x32_bf16 v[156:159], a[0:3], a[76:79], v[156:159]
ds_read_b64_tr_b16 a[72:73], v4 offset:24576
v_mfma_f32_16x16x32_bf16 v[164:167], a[4:7], a[76:79], v[164:167]
ds_read_b64_tr_b16 a[74:75], v4 offset:25600
v_mfma_f32_16x16x32_bf16 v[172:175], a[8:11], a[76:79], v[172:175]
v_mfma_f32_16x16x32_bf16 v[180:183], a[12:15], a[76:79], v[180:183]
ds_read_b64_tr_b16 a[76:77], v5 offset:24576
v_mfma_f32_16x16x32_bf16 v[184:187], a[0:3], a[80:83], v[184:187]
s_add_u32 m0, s76, 4096
ds_read_b64_tr_b16 a[78:79], v5 offset:25600
v_mfma_f32_16x16x32_bf16 v[192:195], a[4:7], a[80:83], v[192:195]
s_add_u32 s64, s70, 33536
v_mfma_f32_16x16x32_bf16 v[200:203], a[8:11], a[80:83], v[200:203]
buffer_load_dwordx4 v12, s[32:35], s64 offen lds
v_mfma_f32_16x16x32_bf16 v[208:211], a[12:15], a[80:83], v[208:211]
ds_read_b64_tr_b16 a[80:81], v6 offset:24576
v_mfma_f32_16x16x32_bf16 v[188:191], a[0:3], a[84:87], v[188:191]
ds_read_b64_tr_b16 a[82:83], v6 offset:25600
v_mfma_f32_16x16x32_bf16 v[196:199], a[4:7], a[84:87], v[196:199]
v_mfma_f32_16x16x32_bf16 v[204:207], a[8:11], a[84:87], v[204:207]
v_mfma_f32_16x16x32_bf16 v[212:215], a[12:15], a[84:87], v[212:215]
s_add_u32 m0, s76, 5120
ds_read_b64_tr_b16 a[84:85], v7 offset:24576
v_mfma_f32_16x16x32_bf16 v[216:219], a[0:3], a[88:91], v[216:219]
s_add_u32 s64, s70, 41728
ds_read_b64_tr_b16 a[86:87], v7 offset:25600
v_mfma_f32_16x16x32_bf16 v[224:227], a[4:7], a[88:91], v[224:227]
buffer_load_dwordx4 v13, s[32:35], s64 offen lds
v_mfma_f32_16x16x32_bf16 v[232:235], a[8:11], a[88:91], v[232:235]
v_mfma_f32_16x16x32_bf16 v[240:243], a[12:15], a[88:91], v[240:243]
ds_read_b64_tr_b16 a[88:89], v8 offset:24576
v_mfma_f32_16x16x32_bf16 v[220:223], a[0:3], a[92:95], v[220:223]
ds_read_b64_tr_b16 a[90:91], v8 offset:25600
v_mfma_f32_16x16x32_bf16 v[228:231], a[4:7], a[92:95], v[228:231]
v_mfma_f32_16x16x32_bf16 v[236:239], a[8:11], a[92:95], v[236:239]
s_add_u32 m0, s76, 6144
v_mfma_f32_16x16x32_bf16 v[244:247], a[12:15], a[92:95], v[244:247]
s_add_u32 s64, s70, 49920
ds_read_b64_tr_b16 a[92:93], v9 offset:24576
v_mfma_f32_16x16x32_bf16 v[248:251], a[0:3], a[96:99], v[248:251]
buffer_load_dwordx4 v12, s[32:35], s64 offen lds
v_mfma_f32_16x16x32_bf16 v[252:255], a[4:7], a[96:99], v[252:255]
ds_read_b64_tr_b16 a[94:95], v9 offset:25600
v_mfma_f32_16x16x32_bf16 a[104:107], a[8:11], a[96:99], a[104:107]
v_mfma_f32_16x16x32_bf16 a[108:111], a[12:15], a[96:99], a[108:111]
s_waitcnt lgkmcnt(4)
ds_read_b64_tr_b16 a[96:97], v10 offset:24576
v_mfma_f32_16x16x32_bf16 a[112:115], a[0:3], a[100:103], a[112:115]
ds_read_b64_tr_b16 a[98:99], v10 offset:25600
v_mfma_f32_16x16x32_bf16 a[116:119], a[4:7], a[100:103], a[116:119]
v_mfma_f32_16x16x32_bf16 a[120:123], a[8:11], a[100:103], a[120:123]
v_mfma_f32_16x16x32_bf16 a[124:127], a[12:15], a[100:103], a[124:127]
s_add_u32 m0, s76, 7168
ds_read_b64_tr_b16 a[100:101], v11 offset:24576
v_mfma_f32_16x16x32_bf16 v[24:27], a[40:43], a[20:23], v[24:27]
s_add_u32 s64, s70, 58112
ds_read_b64_tr_b16 a[102:103], v11 offset:25600
v_mfma_f32_16x16x32_bf16 v[40:43], a[40:43], a[24:27], v[40:43]
buffer_load_dwordx4 v13, s[32:35], s64 offen lds
v_mfma_f32_16x16x32_bf16 v[56:59], a[40:43], a[28:31], v[56:59]
v_mfma_f32_16x16x32_bf16 v[72:75], a[40:43], a[32:35], v[72:75]
v_mfma_f32_16x16x32_bf16 v[88:91], a[44:47], a[20:23], v[88:91]
v_mfma_f32_16x16x32_bf16 v[104:107], a[44:47], a[24:27], v[104:107]
v_mfma_f32_16x16x32_bf16 v[120:123], a[44:47], a[28:31], v[120:123]
v_mfma_f32_16x16x32_bf16 v[136:139], a[44:47], a[32:35], v[136:139]
v_mfma_f32_16x16x32_bf16 v[28:31], a[48:51], a[20:23], v[28:31]
s_waitcnt vmcnt(8) lgkmcnt(0)
s_barrier
v_mfma_f32_16x16x32_bf16 v[44:47], a[48:51], a[24:27], v[44:47]
s_add_u32 m0, s77, 65536
ds_read_b64_tr_b16 a[40:41], v4 offset:32768
v_mfma_f32_16x16x32_bf16 v[60:63], a[48:51], a[28:31], v[60:63]
s_add_u32 s64, s71, 3145728
ds_read_b64_tr_b16 a[42:43], v4 offset:33792
v_mfma_f32_16x16x32_bf16 v[76:79], a[48:51], a[32:35], v[76:79]
buffer_load_dwordx4 v14, s[36:39], s64 offen lds
v_mfma_f32_16x16x32_bf16 v[92:95], a[52:55], a[20:23], v[92:95]
ds_read_b64_tr_b16 a[44:45], v5 offset:32768
v_mfma_f32_16x16x32_bf16 v[108:111], a[52:55], a[24:27], v[108:111]
ds_read_b64_tr_b16 a[46:47], v5 offset:33792
v_mfma_f32_16x16x32_bf16 v[124:127], a[52:55], a[28:31], v[124:127]
ds_read_b64_tr_b16 a[48:49], v6 offset:32768
v_mfma_f32_16x16x32_bf16 v[140:143], a[52:55], a[32:35], v[140:143]
ds_read_b64_tr_b16 a[50:51], v6 offset:33792
v_mfma_f32_16x16x32_bf16 v[32:35], a[56:59], a[20:23], v[32:35]
s_add_u32 m0, s77, 66560
ds_read_b64_tr_b16 a[52:53], v7 offset:32768
v_mfma_f32_16x16x32_bf16 v[48:51], a[56:59], a[24:27], v[48:51]
s_add_u32 s64, s71, 3178496
ds_read_b64_tr_b16 a[54:55], v7 offset:33792
v_mfma_f32_16x16x32_bf16 v[64:67], a[56:59], a[28:31], v[64:67]
buffer_load_dwordx4 v14, s[36:39], s64 offen lds
v_mfma_f32_16x16x32_bf16 v[80:83], a[56:59], a[32:35], v[80:83]
ds_read_b64_tr_b16 a[56:57], v8 offset:32768
v_mfma_f32_16x16x32_bf16 v[96:99], a[60:63], a[20:23], v[96:99]
ds_read_b64_tr_b16 a[58:59], v8 offset:33792
v_mfma_f32_16x16x32_bf16 v[112:115], a[60:63], a[24:27], v[112:115]
ds_read_b128 a[0:3], v2 offset:32768
v_mfma_f32_16x16x32_bf16 v[128:131], a[60:63], a[28:31], v[128:131]
ds_read_b128 a[4:7], v2 offset:34816
v_mfma_f32_16x16x32_bf16 v[144:147], a[60:63], a[32:35], v[144:147]
ds_read_b64_tr_b16 a[60:61], v9 offset:32768
v_mfma_f32_16x16x32_bf16 v[36:39], a[64:67], a[20:23], v[36:39]
s_add_u32 m0, s77, 67584
ds_read_b64_tr_b16 a[62:63], v9 offset:33792
v_mfma_f32_16x16x32_bf16 v[52:55], a[64:67], a[24:27], v[52:55]
s_add_u32 s64, s71, 3211264
ds_read_b128 a[8:11], v2 offset:36864
v_mfma_f32_16x16x32_bf16 v[68:71], a[64:67], a[28:31], v[68:71]
buffer_load_dwordx4 v15, s[36:39], s64 offen lds
v_mfma_f32_16x16x32_bf16 v[84:87], a[64:67], a[32:35], v[84:87]
ds_read_b64_tr_b16 a[64:65], v10 offset:32768
v_mfma_f32_16x16x32_bf16 v[100:103], a[68:71], a[20:23], v[100:103]
ds_read_b64_tr_b16 a[66:67], v10 offset:33792
v_mfma_f32_16x16x32_bf16 v[116:119], a[68:71], a[24:27], v[116:119]
ds_read_b128 a[12:15], v2 offset:38912
v_mfma_f32_16x16x32_bf16 v[132:135], a[68:71], a[28:31], v[132:135]
v_mfma_f32_16x16x32_bf16 v[148:151], a[68:71], a[32:35], v[148:151]
s_add_u32 m0, s77, 68608
ds_read_b64_tr_b16 a[68:69], v11 offset:32768
v_mfma_f32_16x16x32_bf16 v[152:155], a[20:23], a[72:75], v[152:155]
s_add_u32 s64, s71, 3244032
ds_read_b64_tr_b16 a[70:71], v11 offset:33792
v_mfma_f32_16x16x32_bf16 v[160:163], a[24:27], a[72:75], v[160:163]
buffer_load_dwordx4 v15, s[36:39], s64 offen lds
v_mfma_f32_16x16x32_bf16 v[168:171], a[28:31], a[72:75], v[168:171]
v_mfma_f32_16x16x32_bf16 v[176:179], a[32:35], a[72:75], v[176:179]
ds_read_b64_tr_b16 a[72:73], v4 offset:49152
v_mfma_f32_16x16x32_bf16 v[156:159], a[20:23], a[76:79], v[156:159]
ds_read_b64_tr_b16 a[74:75], v4 offset:50176
v_mfma_f32_16x16x32_bf16 v[164:167], a[24:27], a[76:79], v[164:167]
v_mfma_f32_16x16x32_bf16 v[172:175], a[28:31], a[76:79], v[172:175]
v_mfma_f32_16x16x32_bf16 v[180:183], a[32:35], a[76:79], v[180:183]
s_add_u32 m0, s77, 81920
ds_read_b64_tr_b16 a[76:77], v5 offset:49152
v_mfma_f32_16x16x32_bf16 v[184:187], a[20:23], a[80:83], v[184:187]
s_add_u32 s64, s71, 3145728
ds_read_b64_tr_b16 a[78:79], v5 offset:50176
v_mfma_f32_16x16x32_bf16 v[192:195], a[24:27], a[80:83], v[192:195]
buffer_load_dwordx4 v14, s[40:43], s64 offen lds
v_mfma_f32_16x16x32_bf16 v[200:203], a[28:31], a[80:83], v[200:203]
v_mfma_f32_16x16x32_bf16 v[208:211], a[32:35], a[80:83], v[208:211]
ds_read_b64_tr_b16 a[80:81], v6 offset:49152
v_mfma_f32_16x16x32_bf16 v[188:191], a[20:23], a[84:87], v[188:191]
ds_read_b64_tr_b16 a[82:83], v6 offset:50176
v_mfma_f32_16x16x32_bf16 v[196:199], a[24:27], a[84:87], v[196:199]
v_mfma_f32_16x16x32_bf16 v[204:207], a[28:31], a[84:87], v[204:207]
v_mfma_f32_16x16x32_bf16 v[212:215], a[32:35], a[84:87], v[212:215]
s_add_u32 m0, s77, 82944
ds_read_b64_tr_b16 a[84:85], v7 offset:49152
v_mfma_f32_16x16x32_bf16 v[216:219], a[20:23], a[88:91], v[216:219]
s_add_u32 s64, s71, 3178496
ds_read_b64_tr_b16 a[86:87], v7 offset:50176
v_mfma_f32_16x16x32_bf16 v[224:227], a[24:27], a[88:91], v[224:227]
buffer_load_dwordx4 v14, s[40:43], s64 offen lds
v_mfma_f32_16x16x32_bf16 v[232:235], a[28:31], a[88:91], v[232:235]
v_mfma_f32_16x16x32_bf16 v[240:243], a[32:35], a[88:91], v[240:243]
ds_read_b64_tr_b16 a[88:89], v8 offset:49152
v_mfma_f32_16x16x32_bf16 v[220:223], a[20:23], a[92:95], v[220:223]
ds_read_b64_tr_b16 a[90:91], v8 offset:50176
v_mfma_f32_16x16x32_bf16 v[228:231], a[24:27], a[92:95], v[228:231]
v_mfma_f32_16x16x32_bf16 v[236:239], a[28:31], a[92:95], v[236:239]
s_add_u32 m0, s77, 83968
v_mfma_f32_16x16x32_bf16 v[244:247], a[32:35], a[92:95], v[244:247]
s_add_u32 s64, s71, 3211264
ds_read_b64_tr_b16 a[92:93], v9 offset:49152
v_mfma_f32_16x16x32_bf16 v[248:251], a[20:23], a[96:99], v[248:251]
buffer_load_dwordx4 v15, s[40:43], s64 offen lds
v_mfma_f32_16x16x32_bf16 v[252:255], a[24:27], a[96:99], v[252:255]
ds_read_b64_tr_b16 a[94:95], v9 offset:50176
v_mfma_f32_16x16x32_bf16 a[104:107], a[28:31], a[96:99], a[104:107]
v_mfma_f32_16x16x32_bf16 a[108:111], a[32:35], a[96:99], a[108:111]
ds_read_b64_tr_b16 a[96:97], v10 offset:49152
v_mfma_f32_16x16x32_bf16 a[112:115], a[20:23], a[100:103], a[112:115]
ds_read_b64_tr_b16 a[98:99], v10 offset:50176
v_mfma_f32_16x16x32_bf16 a[116:119], a[24:27], a[100:103], a[116:119]
v_mfma_f32_16x16x32_bf16 a[120:123], a[28:31], a[100:103], a[120:123]
s_add_u32 m0, s77, 84992
v_mfma_f32_16x16x32_bf16 a[124:127], a[32:35], a[100:103], a[124:127]
s_waitcnt lgkmcnt(4)
s_add_u32 s64, s71, 3244032
ds_read_b64_tr_b16 a[100:101], v11 offset:49152
v_mfma_f32_16x16x32_bf16 v[24:27], a[40:43], a[0:3], v[24:27]
buffer_load_dwordx4 v15, s[40:43], s64 offen lds
v_mfma_f32_16x16x32_bf16 v[40:43], a[40:43], a[4:7], v[40:43]
ds_read_b128 a[20:23], v3 offset:32768
v_bfe_u32 v23, v0, 1, 1
v_mfma_f32_16x16x32_bf16 v[56:59], a[40:43], a[8:11], v[56:59]
ds_read_b128 a[24:27], v3 offset:34816
v_lshrrev_b32 v1, 5, v0
v_mfma_f32_16x16x32_bf16 v[72:75], a[40:43], a[12:15], v[72:75]
ds_read_b128 a[28:31], v3 offset:36864
v_xor_b32 v23, v23, v1
v_mfma_f32_16x16x32_bf16 v[88:91], a[44:47], a[0:3], v[88:91]
ds_read_b128 a[32:35], v3 offset:38912
v_lshlrev_b32 v23, 5, v23
v_mfma_f32_16x16x32_bf16 v[104:107], a[44:47], a[4:7], v[104:107]
ds_read_b64_tr_b16 a[40:41], v4 offset:40960
v_and_b32 v1, 1, v0
v_mfma_f32_16x16x32_bf16 v[120:123], a[44:47], a[8:11], v[120:123]
ds_read_b64_tr_b16 a[42:43], v4 offset:41984
v_lshl_add_u32 v23, v1, 4, v23
v_mfma_f32_16x16x32_bf16 v[136:139], a[44:47], a[12:15], v[136:139]
ds_read_b64_tr_b16 a[44:45], v5 offset:40960
v_lshrrev_b32 v1, 2, v0
v_mfma_f32_16x16x32_bf16 v[28:31], a[48:51], a[0:3], v[28:31]
ds_read_b64_tr_b16 a[46:47], v5 offset:41984
v_mul_u32_u24 v1, 6144, v1
v_mfma_f32_16x16x32_bf16 v[44:47], a[48:51], a[4:7], v[44:47]
ds_read_b64_tr_b16 a[102:103], v11 offset:50176
v_add_u32 v23, v1, v23
v_mfma_f32_16x16x32_bf16 v[60:63], a[48:51], a[8:11], v[60:63]
s_lshr_b32 s66, s30, 1
v_mfma_f32_16x16x32_bf16 v[76:79], a[48:51], a[12:15], v[76:79]
s_lshl_b32 s66, s66, 11
ds_read_b64_tr_b16 a[48:49], v6 offset:40960
v_mfma_f32_16x16x32_bf16 v[92:95], a[52:55], a[0:3], v[92:95]
s_add_u32 s66, s66, 94208
ds_read_b64_tr_b16 a[50:51], v6 offset:41984
v_mfma_f32_16x16x32_bf16 v[108:111], a[52:55], a[4:7], v[108:111]
s_waitcnt lgkmcnt(7)
s_sub_u32 s66, s66, s76
v_mfma_f32_16x16x32_bf16 v[124:127], a[52:55], a[8:11], v[124:127]
s_add_u32 m0, s76, 32768
v_add_u32 v17, s66, v2
v_mfma_f32_16x16x32_bf16 v[140:143], a[52:55], a[12:15], v[140:143]
s_add_u32 s64, s70, 896
ds_read_b64_tr_b16 a[52:53], v7 offset:40960
v_xor_b32 v18, 64, v17
v_mfma_f32_16x16x32_bf16 v[32:35], a[56:59], a[0:3], v[32:35]
buffer_load_dwordx4 v12, s[32:35], s64 offen lds
v_mfma_f32_16x16x32_bf16 v[48:51], a[56:59], a[4:7], v[48:51]
ds_read_b64_tr_b16 a[54:55], v7 offset:41984
v_lshrrev_b32 v1, 4, v0
v_mfma_f32_16x16x32_bf16 v[64:67], a[56:59], a[8:11], v[64:67]
v_bfe_u32 v19, v0, 2, 2
v_mfma_f32_16x16x32_bf16 v[80:83], a[56:59], a[12:15], v[80:83]
s_add_u32 m0, s76, 33792
ds_read_b64_tr_b16 a[56:57], v8 offset:40960
v_lshl_add_u32 v19, v1, 3, v19
v_mfma_f32_16x16x32_bf16 v[96:99], a[60:63], a[0:3], v[96:99]
s_add_u32 s64, s70, 9088
ds_read_b64_tr_b16 a[58:59], v8 offset:41984
v_lshlrev_b32 v19, 6, v19
v_mfma_f32_16x16x32_bf16 v[112:115], a[60:63], a[4:7], v[112:115]
buffer_load_dwordx4 v13, s[32:35], s64 offen lds
v_mfma_f32_16x16x32_bf16 v[128:131], a[60:63], a[8:11], v[128:131]
v_and_b32 v1, 1, v1
v_mfma_f32_16x16x32_bf16 v[144:147], a[60:63], a[12:15], v[144:147]
ds_read_b64_tr_b16 a[60:61], v9 offset:40960
v_lshl_add_u32 v19, v1, 5, v19
v_mfma_f32_16x16x32_bf16 v[36:39], a[64:67], a[0:3], v[36:39]
ds_read_b64_tr_b16 a[62:63], v9 offset:41984
v_and_b32 v1, 3, v0
v_mfma_f32_16x16x32_bf16 v[52:55], a[64:67], a[4:7], v[52:55]
s_add_u32 m0, s76, 34816
v_lshl_add_u32 v19, v1, 3, v19
v_mfma_f32_16x16x32_bf16 v[68:71], a[64:67], a[8:11], v[68:71]
s_add_u32 s64, s70, 17280
v_add_u32 v19, 81920, v19
v_mfma_f32_16x16x32_bf16 v[84:87], a[64:67], a[12:15], v[84:87]
ds_read_b64_tr_b16 a[64:65], v10 offset:40960
v_xor_b32 v20, 32, v19
v_mfma_f32_16x16x32_bf16 v[100:103], a[68:71], a[0:3], v[100:103]
s_and_b32 s66, s30, 1
buffer_load_dwordx4 v12, s[32:35], s64 offen lds
v_mfma_f32_16x16x32_bf16 v[116:119], a[68:71], a[4:7], v[116:119]
s_lshl_b32 s67, s66, 5
ds_read_b64_tr_b16 a[66:67], v10 offset:41984
v_mfma_f32_16x16x32_bf16 v[132:135], a[68:71], a[8:11], v[132:135]
v_xor_b32 v21, s67, v19
v_mfma_f32_16x16x32_bf16 v[148:151], a[68:71], a[12:15], v[148:151]
s_lshl_b32 s67, s66, 6
ds_read_b64_tr_b16 a[68:69], v11 offset:40960
v_mfma_f32_16x16x32_bf16 v[152:155], a[0:3], a[72:75], v[152:155]
ds_read_b64_tr_b16 a[70:71], v11 offset:41984
v_lshrrev_b32 v1, 3, v0
v_mfma_f32_16x16x32_bf16 v[160:163], a[4:7], a[72:75], v[160:163]
s_add_u32 m0, s76, 35840
v_mfma_f32_16x16x32_bf16 v[168:171], a[8:11], a[72:75], v[168:171]
s_add_u32 s64, s70, 25472
v_mfma_f32_16x16x32_bf16 v[176:179], a[12:15], a[72:75], v[176:179]
buffer_load_dwordx4 v13, s[32:35], s64 offen lds
v_mfma_f32_16x16x32_bf16 v[156:159], a[0:3], a[76:79], v[156:159]
ds_read_b64_tr_b16 a[72:73], v4 offset:57344
v_mfma_f32_16x16x32_bf16 v[164:167], a[4:7], a[76:79], v[164:167]
ds_read_b64_tr_b16 a[74:75], v4 offset:58368
v_mfma_f32_16x16x32_bf16 v[172:175], a[8:11], a[76:79], v[172:175]
v_mfma_f32_16x16x32_bf16 v[180:183], a[12:15], a[76:79], v[180:183]
ds_read_b64_tr_b16 a[76:77], v5 offset:57344
v_mfma_f32_16x16x32_bf16 v[184:187], a[0:3], a[80:83], v[184:187]
s_add_u32 m0, s76, 36864
ds_read_b64_tr_b16 a[78:79], v5 offset:58368
v_mfma_f32_16x16x32_bf16 v[192:195], a[4:7], a[80:83], v[192:195]
s_add_u32 s64, s70, 33664
v_mfma_f32_16x16x32_bf16 v[200:203], a[8:11], a[80:83], v[200:203]
buffer_load_dwordx4 v12, s[32:35], s64 offen lds
v_mfma_f32_16x16x32_bf16 v[208:211], a[12:15], a[80:83], v[208:211]
ds_read_b64_tr_b16 a[80:81], v6 offset:57344
v_mfma_f32_16x16x32_bf16 v[188:191], a[0:3], a[84:87], v[188:191]
ds_read_b64_tr_b16 a[82:83], v6 offset:58368
v_mfma_f32_16x16x32_bf16 v[196:199], a[4:7], a[84:87], v[196:199]
v_mfma_f32_16x16x32_bf16 v[204:207], a[8:11], a[84:87], v[204:207]
v_mfma_f32_16x16x32_bf16 v[212:215], a[12:15], a[84:87], v[212:215]
s_add_u32 m0, s76, 37888
ds_read_b64_tr_b16 a[84:85], v7 offset:57344
v_mfma_f32_16x16x32_bf16 v[216:219], a[0:3], a[88:91], v[216:219]
s_add_u32 s64, s70, 41856
ds_read_b64_tr_b16 a[86:87], v7 offset:58368
v_mfma_f32_16x16x32_bf16 v[224:227], a[4:7], a[88:91], v[224:227]
buffer_load_dwordx4 v13, s[32:35], s64 offen lds
v_mfma_f32_16x16x32_bf16 v[232:235], a[8:11], a[88:91], v[232:235]
v_mfma_f32_16x16x32_bf16 v[240:243], a[12:15], a[88:91], v[240:243]
ds_read_b64_tr_b16 a[88:89], v8 offset:57344
v_mfma_f32_16x16x32_bf16 v[220:223], a[0:3], a[92:95], v[220:223]
ds_read_b64_tr_b16 a[90:91], v8 offset:58368
v_mfma_f32_16x16x32_bf16 v[228:231], a[4:7], a[92:95], v[228:231]
v_mfma_f32_16x16x32_bf16 v[236:239], a[8:11], a[92:95], v[236:239]
s_add_u32 m0, s76, 38912
v_mfma_f32_16x16x32_bf16 v[244:247], a[12:15], a[92:95], v[244:247]
s_add_u32 s64, s70, 50048
ds_read_b64_tr_b16 a[92:93], v9 offset:57344
v_mfma_f32_16x16x32_bf16 v[248:251], a[0:3], a[96:99], v[248:251]
buffer_load_dwordx4 v12, s[32:35], s64 offen lds
v_mfma_f32_16x16x32_bf16 v[252:255], a[4:7], a[96:99], v[252:255]
ds_read_b64_tr_b16 a[94:95], v9 offset:58368
v_mfma_f32_16x16x32_bf16 a[104:107], a[8:11], a[96:99], a[104:107]
v_mfma_f32_16x16x32_bf16 a[108:111], a[12:15], a[96:99], a[108:111]
s_waitcnt lgkmcnt(4)
ds_read_b64_tr_b16 a[96:97], v10 offset:57344
v_mfma_f32_16x16x32_bf16 a[112:115], a[0:3], a[100:103], a[112:115]
ds_read_b64_tr_b16 a[98:99], v10 offset:58368
v_mfma_f32_16x16x32_bf16 a[116:119], a[4:7], a[100:103], a[116:119]
v_mfma_f32_16x16x32_bf16 a[120:123], a[8:11], a[100:103], a[120:123]
v_mfma_f32_16x16x32_bf16 a[124:127], a[12:15], a[100:103], a[124:127]
s_add_u32 m0, s76, 39936
ds_read_b64_tr_b16 a[100:101], v11 offset:57344
v_mfma_f32_16x16x32_bf16 v[24:27], a[40:43], a[20:23], v[24:27]
s_add_u32 s64, s70, 58240
ds_read_b64_tr_b16 a[102:103], v11 offset:58368
v_mfma_f32_16x16x32_bf16 v[40:43], a[40:43], a[24:27], v[40:43]
buffer_load_dwordx4 v13, s[32:35], s64 offen lds
v_mfma_f32_16x16x32_bf16 v[56:59], a[40:43], a[28:31], v[56:59]
v_mfma_f32_16x16x32_bf16 v[72:75], a[40:43], a[32:35], v[72:75]
v_mfma_f32_16x16x32_bf16 v[88:91], a[44:47], a[20:23], v[88:91]
v_mfma_f32_16x16x32_bf16 v[104:107], a[44:47], a[24:27], v[104:107]
v_mfma_f32_16x16x32_bf16 v[120:123], a[44:47], a[28:31], v[120:123]
v_mfma_f32_16x16x32_bf16 v[136:139], a[44:47], a[32:35], v[136:139]
v_mfma_f32_16x16x32_bf16 v[28:31], a[48:51], a[20:23], v[28:31]
s_waitcnt vmcnt(8) lgkmcnt(0)
s_barrier
v_mfma_f32_16x16x32_bf16 v[44:47], a[48:51], a[24:27], v[44:47]
s_add_u32 m0, s77, 98304
ds_read_b64_tr_b16 a[40:41], v4 offset:0
v_mfma_f32_16x16x32_bf16 v[60:63], a[48:51], a[28:31], v[60:63]
s_add_u32 s64, s71, 3670016
ds_read_b64_tr_b16 a[42:43], v4 offset:1024
v_mfma_f32_16x16x32_bf16 v[76:79], a[48:51], a[32:35], v[76:79]
buffer_load_dwordx4 v14, s[36:39], s64 offen lds
v_mfma_f32_16x16x32_bf16 v[92:95], a[52:55], a[20:23], v[92:95]
ds_read_b64_tr_b16 a[44:45], v5 offset:0
v_mfma_f32_16x16x32_bf16 v[108:111], a[52:55], a[24:27], v[108:111]
ds_read_b64_tr_b16 a[46:47], v5 offset:1024
v_mfma_f32_16x16x32_bf16 v[124:127], a[52:55], a[28:31], v[124:127]
ds_read_b64_tr_b16 a[48:49], v6 offset:0
v_lshl_add_u32 v12, v1, 10, v12
v_mfma_f32_16x16x32_bf16 v[140:143], a[52:55], a[32:35], v[140:143]
ds_read_b64_tr_b16 a[50:51], v6 offset:1024
v_xor_b32 v13, 64, v12
v_mfma_f32_16x16x32_bf16 v[32:35], a[56:59], a[20:23], v[32:35]
s_add_u32 m0, s77, 99328
ds_read_b64_tr_b16 a[52:53], v7 offset:0
v_xor_b32 v22, s67, v12
v_mfma_f32_16x16x32_bf16 v[48:51], a[56:59], a[24:27], v[48:51]
s_add_u32 s64, s71, 3702784
ds_read_b64_tr_b16 a[54:55], v7 offset:1024
v_mfma_f32_16x16x32_bf16 v[64:67], a[56:59], a[28:31], v[64:67]
buffer_load_dwordx4 v14, s[36:39], s64 offen lds
v_mfma_f32_16x16x32_bf16 v[80:83], a[56:59], a[32:35], v[80:83]
ds_read_b64_tr_b16 a[56:57], v8 offset:0
v_mfma_f32_16x16x32_bf16 v[96:99], a[60:63], a[20:23], v[96:99]
ds_read_b64_tr_b16 a[58:59], v8 offset:1024
v_mfma_f32_16x16x32_bf16 v[112:115], a[60:63], a[24:27], v[112:115]
ds_read_b128 a[0:3], v2 offset:0
v_mfma_f32_16x16x32_bf16 v[128:131], a[60:63], a[28:31], v[128:131]
ds_read_b128 a[4:7], v2 offset:2048
v_mfma_f32_16x16x32_bf16 v[144:147], a[60:63], a[32:35], v[144:147]
ds_read_b64_tr_b16 a[60:61], v9 offset:0
v_mfma_f32_16x16x32_bf16 v[36:39], a[64:67], a[20:23], v[36:39]
s_add_u32 m0, s77, 100352
ds_read_b64_tr_b16 a[62:63], v9 offset:1024
v_mfma_f32_16x16x32_bf16 v[52:55], a[64:67], a[24:27], v[52:55]
s_add_u32 s64, s71, 3735552
ds_read_b128 a[8:11], v2 offset:4096
v_mfma_f32_16x16x32_bf16 v[68:71], a[64:67], a[28:31], v[68:71]
buffer_load_dwordx4 v15, s[36:39], s64 offen lds
v_mfma_f32_16x16x32_bf16 v[84:87], a[64:67], a[32:35], v[84:87]
ds_read_b64_tr_b16 a[64:65], v10 offset:0
v_mfma_f32_16x16x32_bf16 v[100:103], a[68:71], a[20:23], v[100:103]
ds_read_b64_tr_b16 a[66:67], v10 offset:1024
v_mfma_f32_16x16x32_bf16 v[116:119], a[68:71], a[24:27], v[116:119]
ds_read_b128 a[12:15], v2 offset:6144
v_mfma_f32_16x16x32_bf16 v[132:135], a[68:71], a[28:31], v[132:135]
v_mfma_f32_16x16x32_bf16 v[148:151], a[68:71], a[32:35], v[148:151]
s_add_u32 m0, s77, 101376
ds_read_b64_tr_b16 a[68:69], v11 offset:0
v_mfma_f32_16x16x32_bf16 v[152:155], a[20:23], a[72:75], v[152:155]
s_add_u32 s64, s71, 3768320
ds_read_b64_tr_b16 a[70:71], v11 offset:1024
v_mfma_f32_16x16x32_bf16 v[160:163], a[24:27], a[72:75], v[160:163]
buffer_load_dwordx4 v15, s[36:39], s64 offen lds
v_mfma_f32_16x16x32_bf16 v[168:171], a[28:31], a[72:75], v[168:171]
v_mfma_f32_16x16x32_bf16 v[176:179], a[32:35], a[72:75], v[176:179]
ds_read_b64_tr_b16 a[72:73], v4 offset:16384
v_mfma_f32_16x16x32_bf16 v[156:159], a[20:23], a[76:79], v[156:159]
ds_read_b64_tr_b16 a[74:75], v4 offset:17408
v_mfma_f32_16x16x32_bf16 v[164:167], a[24:27], a[76:79], v[164:167]
v_mfma_f32_16x16x32_bf16 v[172:175], a[28:31], a[76:79], v[172:175]
v_mfma_f32_16x16x32_bf16 v[180:183], a[32:35], a[76:79], v[180:183]
s_add_u32 m0, s77, 114688
ds_read_b64_tr_b16 a[76:77], v5 offset:16384
v_mfma_f32_16x16x32_bf16 v[184:187], a[20:23], a[80:83], v[184:187]
s_add_u32 s64, s71, 3670016
ds_read_b64_tr_b16 a[78:79], v5 offset:17408
v_mfma_f32_16x16x32_bf16 v[192:195], a[24:27], a[80:83], v[192:195]
buffer_load_dwordx4 v14, s[40:43], s64 offen lds
v_mfma_f32_16x16x32_bf16 v[200:203], a[28:31], a[80:83], v[200:203]
v_mfma_f32_16x16x32_bf16 v[208:211], a[32:35], a[80:83], v[208:211]
ds_read_b64_tr_b16 a[80:81], v6 offset:16384
v_mfma_f32_16x16x32_bf16 v[188:191], a[20:23], a[84:87], v[188:191]
ds_read_b64_tr_b16 a[82:83], v6 offset:17408
v_mfma_f32_16x16x32_bf16 v[196:199], a[24:27], a[84:87], v[196:199]
v_mfma_f32_16x16x32_bf16 v[204:207], a[28:31], a[84:87], v[204:207]
v_mfma_f32_16x16x32_bf16 v[212:215], a[32:35], a[84:87], v[212:215]
s_add_u32 m0, s77, 115712
ds_read_b64_tr_b16 a[84:85], v7 offset:16384
v_mfma_f32_16x16x32_bf16 v[216:219], a[20:23], a[88:91], v[216:219]
s_add_u32 s64, s71, 3702784
ds_read_b64_tr_b16 a[86:87], v7 offset:17408
v_mfma_f32_16x16x32_bf16 v[224:227], a[24:27], a[88:91], v[224:227]
buffer_load_dwordx4 v14, s[40:43], s64 offen lds
v_mfma_f32_16x16x32_bf16 v[232:235], a[28:31], a[88:91], v[232:235]
v_mfma_f32_16x16x32_bf16 v[240:243], a[32:35], a[88:91], v[240:243]
ds_read_b64_tr_b16 a[88:89], v8 offset:16384
v_mfma_f32_16x16x32_bf16 v[220:223], a[20:23], a[92:95], v[220:223]
ds_read_b64_tr_b16 a[90:91], v8 offset:17408
v_mfma_f32_16x16x32_bf16 v[228:231], a[24:27], a[92:95], v[228:231]
v_mfma_f32_16x16x32_bf16 v[236:239], a[28:31], a[92:95], v[236:239]
s_add_u32 m0, s77, 116736
v_mfma_f32_16x16x32_bf16 v[244:247], a[32:35], a[92:95], v[244:247]
s_add_u32 s64, s71, 3735552
ds_read_b64_tr_b16 a[92:93], v9 offset:16384
v_mfma_f32_16x16x32_bf16 v[248:251], a[20:23], a[96:99], v[248:251]
buffer_load_dwordx4 v15, s[40:43], s64 offen lds
v_mfma_f32_16x16x32_bf16 v[252:255], a[24:27], a[96:99], v[252:255]
ds_read_b64_tr_b16 a[94:95], v9 offset:17408
v_mfma_f32_16x16x32_bf16 a[104:107], a[28:31], a[96:99], a[104:107]
v_mfma_f32_16x16x32_bf16 a[108:111], a[32:35], a[96:99], a[108:111]
ds_read_b64_tr_b16 a[96:97], v10 offset:16384
v_mfma_f32_16x16x32_bf16 a[112:115], a[20:23], a[100:103], a[112:115]
ds_read_b64_tr_b16 a[98:99], v10 offset:17408
v_mfma_f32_16x16x32_bf16 a[116:119], a[24:27], a[100:103], a[116:119]
v_mfma_f32_16x16x32_bf16 a[120:123], a[28:31], a[100:103], a[120:123]
s_add_u32 m0, s77, 117760
v_mfma_f32_16x16x32_bf16 a[124:127], a[32:35], a[100:103], a[124:127]
s_waitcnt lgkmcnt(4)
s_add_u32 s64, s71, 3768320
ds_read_b64_tr_b16 a[100:101], v11 offset:16384
v_mfma_f32_16x16x32_bf16 v[24:27], a[40:43], a[0:3], v[24:27]
buffer_load_dwordx4 v15, s[40:43], s64 offen lds
v_mfma_f32_16x16x32_bf16 v[40:43], a[40:43], a[4:7], v[40:43]
ds_read_b128 a[20:23], v3 offset:0
v_mfma_f32_16x16x32_bf16 v[56:59], a[40:43], a[8:11], v[56:59]
ds_read_b128 a[24:27], v3 offset:2048
v_mfma_f32_16x16x32_bf16 v[72:75], a[40:43], a[12:15], v[72:75]
ds_read_b128 a[28:31], v3 offset:4096
v_mfma_f32_16x16x32_bf16 v[88:91], a[44:47], a[0:3], v[88:91]
ds_read_b128 a[32:35], v3 offset:6144
v_mfma_f32_16x16x32_bf16 v[104:107], a[44:47], a[4:7], v[104:107]
ds_read_b64_tr_b16 a[40:41], v4 offset:8192
v_mfma_f32_16x16x32_bf16 v[120:123], a[44:47], a[8:11], v[120:123]
ds_read_b64_tr_b16 a[42:43], v4 offset:9216
v_mfma_f32_16x16x32_bf16 v[136:139], a[44:47], a[12:15], v[136:139]
ds_read_b64_tr_b16 a[44:45], v5 offset:8192
v_mfma_f32_16x16x32_bf16 v[28:31], a[48:51], a[0:3], v[28:31]
ds_read_b64_tr_b16 a[46:47], v5 offset:9216
v_mfma_f32_16x16x32_bf16 v[44:47], a[48:51], a[4:7], v[44:47]
ds_read_b64_tr_b16 a[102:103], v11 offset:17408
v_mfma_f32_16x16x32_bf16 v[60:63], a[48:51], a[8:11], v[60:63]
v_mfma_f32_16x16x32_bf16 v[76:79], a[48:51], a[12:15], v[76:79]
ds_read_b64_tr_b16 a[48:49], v6 offset:8192
v_mfma_f32_16x16x32_bf16 v[92:95], a[52:55], a[0:3], v[92:95]
ds_read_b64_tr_b16 a[50:51], v6 offset:9216
v_mfma_f32_16x16x32_bf16 v[108:111], a[52:55], a[4:7], v[108:111]
s_waitcnt lgkmcnt(7)
v_mfma_f32_16x16x32_bf16 v[124:127], a[52:55], a[8:11], v[124:127]
s_add_u32 m0, s76, 0
v_mfma_f32_16x16x32_bf16 v[140:143], a[52:55], a[12:15], v[140:143]
s_add_u32 s64, s72, 0
ds_read_b64_tr_b16 a[52:53], v7 offset:8192
v_mfma_f32_16x16x32_bf16 v[32:35], a[56:59], a[0:3], v[32:35]
buffer_load_dwordx4 v12, s[48:51], s64 offen lds
v_mfma_f32_16x16x32_bf16 v[48:51], a[56:59], a[4:7], v[48:51]
ds_read_b64_tr_b16 a[54:55], v7 offset:9216
v_mfma_f32_16x16x32_bf16 v[64:67], a[56:59], a[8:11], v[64:67]
v_mfma_f32_16x16x32_bf16 v[80:83], a[56:59], a[12:15], v[80:83]
s_add_u32 m0, s76, 1024
ds_read_b64_tr_b16 a[56:57], v8 offset:8192
v_mfma_f32_16x16x32_bf16 v[96:99], a[60:63], a[0:3], v[96:99]
s_add_u32 s64, s72, 16384
ds_read_b64_tr_b16 a[58:59], v8 offset:9216
v_mfma_f32_16x16x32_bf16 v[112:115], a[60:63], a[4:7], v[112:115]
buffer_load_dwordx4 v13, s[48:51], s64 offen lds
v_mfma_f32_16x16x32_bf16 v[128:131], a[60:63], a[8:11], v[128:131]
v_mfma_f32_16x16x32_bf16 v[144:147], a[60:63], a[12:15], v[144:147]
ds_read_b64_tr_b16 a[60:61], v9 offset:8192
v_mfma_f32_16x16x32_bf16 v[36:39], a[64:67], a[0:3], v[36:39]
ds_read_b64_tr_b16 a[62:63], v9 offset:9216
v_mfma_f32_16x16x32_bf16 v[52:55], a[64:67], a[4:7], v[52:55]
v_mfma_f32_16x16x32_bf16 v[68:71], a[64:67], a[8:11], v[68:71]
s_add_u32 m0, s76, 2048
v_mfma_f32_16x16x32_bf16 v[84:87], a[64:67], a[12:15], v[84:87]
s_add_u32 s64, s72, 131072
ds_read_b64_tr_b16 a[64:65], v10 offset:8192
v_mfma_f32_16x16x32_bf16 v[100:103], a[68:71], a[0:3], v[100:103]
buffer_load_dwordx4 v12, s[48:51], s64 offen lds
v_mfma_f32_16x16x32_bf16 v[116:119], a[68:71], a[4:7], v[116:119]
ds_read_b64_tr_b16 a[66:67], v10 offset:9216
v_mfma_f32_16x16x32_bf16 v[132:135], a[68:71], a[8:11], v[132:135]
v_mfma_f32_16x16x32_bf16 v[148:151], a[68:71], a[12:15], v[148:151]
ds_read_b64_tr_b16 a[68:69], v11 offset:8192
v_mfma_f32_16x16x32_bf16 v[152:155], a[0:3], a[72:75], v[152:155]
ds_read_b64_tr_b16 a[70:71], v11 offset:9216
v_mfma_f32_16x16x32_bf16 v[160:163], a[4:7], a[72:75], v[160:163]
s_add_u32 m0, s76, 3072
v_mfma_f32_16x16x32_bf16 v[168:171], a[8:11], a[72:75], v[168:171]
s_add_u32 s64, s72, 147456
v_mfma_f32_16x16x32_bf16 v[176:179], a[12:15], a[72:75], v[176:179]
buffer_load_dwordx4 v13, s[48:51], s64 offen lds
v_mfma_f32_16x16x32_bf16 v[156:159], a[0:3], a[76:79], v[156:159]
ds_read_b64_tr_b16 a[72:73], v4 offset:24576
v_mfma_f32_16x16x32_bf16 v[164:167], a[4:7], a[76:79], v[164:167]
ds_read_b64_tr_b16 a[74:75], v4 offset:25600
v_mfma_f32_16x16x32_bf16 v[172:175], a[8:11], a[76:79], v[172:175]
v_mfma_f32_16x16x32_bf16 v[180:183], a[12:15], a[76:79], v[180:183]
ds_read_b64_tr_b16 a[76:77], v5 offset:24576
v_mfma_f32_16x16x32_bf16 v[184:187], a[0:3], a[80:83], v[184:187]
s_add_u32 m0, s76, 4096
ds_read_b64_tr_b16 a[78:79], v5 offset:25600
v_mfma_f32_16x16x32_bf16 v[192:195], a[4:7], a[80:83], v[192:195]
s_add_u32 s64, s73, 0
v_mfma_f32_16x16x32_bf16 v[200:203], a[8:11], a[80:83], v[200:203]
buffer_load_dwordx4 v12, s[48:51], s64 offen lds
v_mfma_f32_16x16x32_bf16 v[208:211], a[12:15], a[80:83], v[208:211]
ds_read_b64_tr_b16 a[80:81], v6 offset:24576
v_mfma_f32_16x16x32_bf16 v[188:191], a[0:3], a[84:87], v[188:191]
ds_read_b64_tr_b16 a[82:83], v6 offset:25600
v_mfma_f32_16x16x32_bf16 v[196:199], a[4:7], a[84:87], v[196:199]
v_mfma_f32_16x16x32_bf16 v[204:207], a[8:11], a[84:87], v[204:207]
v_mfma_f32_16x16x32_bf16 v[212:215], a[12:15], a[84:87], v[212:215]
s_add_u32 m0, s76, 5120
ds_read_b64_tr_b16 a[84:85], v7 offset:24576
v_mfma_f32_16x16x32_bf16 v[216:219], a[0:3], a[88:91], v[216:219]
s_add_u32 s64, s73, 16384
ds_read_b64_tr_b16 a[86:87], v7 offset:25600
v_mfma_f32_16x16x32_bf16 v[224:227], a[4:7], a[88:91], v[224:227]
buffer_load_dwordx4 v13, s[48:51], s64 offen lds
v_mfma_f32_16x16x32_bf16 v[232:235], a[8:11], a[88:91], v[232:235]
v_mfma_f32_16x16x32_bf16 v[240:243], a[12:15], a[88:91], v[240:243]
ds_read_b64_tr_b16 a[88:89], v8 offset:24576
v_mfma_f32_16x16x32_bf16 v[220:223], a[0:3], a[92:95], v[220:223]
ds_read_b64_tr_b16 a[90:91], v8 offset:25600
v_mfma_f32_16x16x32_bf16 v[228:231], a[4:7], a[92:95], v[228:231]
v_mfma_f32_16x16x32_bf16 v[236:239], a[8:11], a[92:95], v[236:239]
s_add_u32 m0, s76, 6144
v_mfma_f32_16x16x32_bf16 v[244:247], a[12:15], a[92:95], v[244:247]
s_add_u32 s64, s73, 131072
ds_read_b64_tr_b16 a[92:93], v9 offset:24576
v_mfma_f32_16x16x32_bf16 v[248:251], a[0:3], a[96:99], v[248:251]
buffer_load_dwordx4 v12, s[48:51], s64 offen lds
v_mfma_f32_16x16x32_bf16 v[252:255], a[4:7], a[96:99], v[252:255]
ds_read_b64_tr_b16 a[94:95], v9 offset:25600
v_mfma_f32_16x16x32_bf16 a[104:107], a[8:11], a[96:99], a[104:107]
v_mfma_f32_16x16x32_bf16 a[108:111], a[12:15], a[96:99], a[108:111]
s_waitcnt lgkmcnt(4)
ds_read_b64_tr_b16 a[96:97], v10 offset:24576
v_mfma_f32_16x16x32_bf16 a[112:115], a[0:3], a[100:103], a[112:115]
ds_read_b64_tr_b16 a[98:99], v10 offset:25600
v_mfma_f32_16x16x32_bf16 a[116:119], a[4:7], a[100:103], a[116:119]
v_mfma_f32_16x16x32_bf16 a[120:123], a[8:11], a[100:103], a[120:123]
v_mfma_f32_16x16x32_bf16 a[124:127], a[12:15], a[100:103], a[124:127]
s_add_u32 m0, s76, 7168
ds_read_b64_tr_b16 a[100:101], v11 offset:24576
v_mfma_f32_16x16x32_bf16 v[24:27], a[40:43], a[20:23], v[24:27]
s_add_u32 s64, s73, 147456
ds_read_b64_tr_b16 a[102:103], v11 offset:25600
v_mfma_f32_16x16x32_bf16 v[40:43], a[40:43], a[24:27], v[40:43]
buffer_load_dwordx4 v13, s[48:51], s64 offen lds
v_mfma_f32_16x16x32_bf16 v[56:59], a[40:43], a[28:31], v[56:59]
v_mfma_f32_16x16x32_bf16 v[72:75], a[40:43], a[32:35], v[72:75]
v_mfma_f32_16x16x32_bf16 v[88:91], a[44:47], a[20:23], v[88:91]
v_mfma_f32_16x16x32_bf16 v[104:107], a[44:47], a[24:27], v[104:107]
v_mfma_f32_16x16x32_bf16 v[120:123], a[44:47], a[28:31], v[120:123]
v_mfma_f32_16x16x32_bf16 v[136:139], a[44:47], a[32:35], v[136:139]
v_mfma_f32_16x16x32_bf16 v[28:31], a[48:51], a[20:23], v[28:31]
s_waitcnt vmcnt(8) lgkmcnt(0)
s_barrier
v_mfma_f32_16x16x32_bf16 v[44:47], a[48:51], a[24:27], v[44:47]
s_add_u32 m0, s77, 65536
ds_read_b64_tr_b16 a[40:41], v4 offset:32768
v_mfma_f32_16x16x32_bf16 v[60:63], a[48:51], a[28:31], v[60:63]
s_add_u32 s64, s71, 0
ds_read_b64_tr_b16 a[42:43], v4 offset:33792
v_mfma_f32_16x16x32_bf16 v[76:79], a[48:51], a[32:35], v[76:79]
buffer_load_dwordx4 v14, s[56:59], s64 offen lds
v_mfma_f32_16x16x32_bf16 v[92:95], a[52:55], a[20:23], v[92:95]
ds_read_b64_tr_b16 a[44:45], v5 offset:32768
v_mfma_f32_16x16x32_bf16 v[108:111], a[52:55], a[24:27], v[108:111]
ds_read_b64_tr_b16 a[46:47], v5 offset:33792
v_mfma_f32_16x16x32_bf16 v[124:127], a[52:55], a[28:31], v[124:127]
ds_read_b64_tr_b16 a[48:49], v6 offset:32768
v_mfma_f32_16x16x32_bf16 v[140:143], a[52:55], a[32:35], v[140:143]
ds_read_b64_tr_b16 a[50:51], v6 offset:33792
v_mfma_f32_16x16x32_bf16 v[32:35], a[56:59], a[20:23], v[32:35]
s_add_u32 m0, s77, 66560
ds_read_b64_tr_b16 a[52:53], v7 offset:32768
v_mfma_f32_16x16x32_bf16 v[48:51], a[56:59], a[24:27], v[48:51]
s_add_u32 s64, s71, 32768
ds_read_b64_tr_b16 a[54:55], v7 offset:33792
v_mfma_f32_16x16x32_bf16 v[64:67], a[56:59], a[28:31], v[64:67]
buffer_load_dwordx4 v14, s[56:59], s64 offen lds
v_mfma_f32_16x16x32_bf16 v[80:83], a[56:59], a[32:35], v[80:83]
ds_read_b64_tr_b16 a[56:57], v8 offset:32768
v_mfma_f32_16x16x32_bf16 v[96:99], a[60:63], a[20:23], v[96:99]
ds_read_b64_tr_b16 a[58:59], v8 offset:33792
v_mfma_f32_16x16x32_bf16 v[112:115], a[60:63], a[24:27], v[112:115]
ds_read_b128 a[0:3], v2 offset:32768
v_mfma_f32_16x16x32_bf16 v[128:131], a[60:63], a[28:31], v[128:131]
ds_read_b128 a[4:7], v2 offset:34816
v_mfma_f32_16x16x32_bf16 v[144:147], a[60:63], a[32:35], v[144:147]
ds_read_b64_tr_b16 a[60:61], v9 offset:32768
v_mfma_f32_16x16x32_bf16 v[36:39], a[64:67], a[20:23], v[36:39]
s_add_u32 m0, s77, 67584
ds_read_b64_tr_b16 a[62:63], v9 offset:33792
v_mfma_f32_16x16x32_bf16 v[52:55], a[64:67], a[24:27], v[52:55]
s_add_u32 s64, s71, 65536
ds_read_b128 a[8:11], v2 offset:36864
v_mfma_f32_16x16x32_bf16 v[68:71], a[64:67], a[28:31], v[68:71]
buffer_load_dwordx4 v15, s[56:59], s64 offen lds
v_mfma_f32_16x16x32_bf16 v[84:87], a[64:67], a[32:35], v[84:87]
ds_read_b64_tr_b16 a[64:65], v10 offset:32768
v_mfma_f32_16x16x32_bf16 v[100:103], a[68:71], a[20:23], v[100:103]
ds_read_b64_tr_b16 a[66:67], v10 offset:33792
v_mfma_f32_16x16x32_bf16 v[116:119], a[68:71], a[24:27], v[116:119]
ds_read_b128 a[12:15], v2 offset:38912
v_mfma_f32_16x16x32_bf16 v[132:135], a[68:71], a[28:31], v[132:135]
v_mfma_f32_16x16x32_bf16 v[148:151], a[68:71], a[32:35], v[148:151]
s_add_u32 m0, s77, 68608
ds_read_b64_tr_b16 a[68:69], v11 offset:32768
v_mfma_f32_16x16x32_bf16 v[152:155], a[20:23], a[72:75], v[152:155]
s_add_u32 s64, s71, 98304
ds_read_b64_tr_b16 a[70:71], v11 offset:33792
v_mfma_f32_16x16x32_bf16 v[160:163], a[24:27], a[72:75], v[160:163]
buffer_load_dwordx4 v15, s[56:59], s64 offen lds
v_mfma_f32_16x16x32_bf16 v[168:171], a[28:31], a[72:75], v[168:171]
v_mfma_f32_16x16x32_bf16 v[176:179], a[32:35], a[72:75], v[176:179]
ds_read_b64_tr_b16 a[72:73], v4 offset:49152
v_mfma_f32_16x16x32_bf16 v[156:159], a[20:23], a[76:79], v[156:159]
ds_read_b64_tr_b16 a[74:75], v4 offset:50176
v_mfma_f32_16x16x32_bf16 v[164:167], a[24:27], a[76:79], v[164:167]
v_mfma_f32_16x16x32_bf16 v[172:175], a[28:31], a[76:79], v[172:175]
v_mfma_f32_16x16x32_bf16 v[180:183], a[32:35], a[76:79], v[180:183]
s_add_u32 m0, s78, 81920
ds_read_b64_tr_b16 a[76:77], v5 offset:49152
v_mfma_f32_16x16x32_bf16 v[184:187], a[20:23], a[80:83], v[184:187]
s_add_u32 s64, s75, 0
ds_read_b64_tr_b16 a[78:79], v5 offset:50176
v_mfma_f32_16x16x32_bf16 v[192:195], a[24:27], a[80:83], v[192:195]
buffer_load_dwordx4 v23, s[60:63], s64 offen lds
v_mfma_f32_16x16x32_bf16 v[200:203], a[28:31], a[80:83], v[200:203]
v_mfma_f32_16x16x32_bf16 v[208:211], a[32:35], a[80:83], v[208:211]
ds_read_b64_tr_b16 a[80:81], v6 offset:49152
v_mfma_f32_16x16x32_bf16 v[188:191], a[20:23], a[84:87], v[188:191]
ds_read_b64_tr_b16 a[82:83], v6 offset:50176
v_mfma_f32_16x16x32_bf16 v[196:199], a[24:27], a[84:87], v[196:199]
v_mfma_f32_16x16x32_bf16 v[204:207], a[28:31], a[84:87], v[204:207]
v_mfma_f32_16x16x32_bf16 v[212:215], a[32:35], a[84:87], v[212:215]
s_add_u32 m0, s78, 86016
ds_read_b64_tr_b16 a[84:85], v7 offset:49152
v_mfma_f32_16x16x32_bf16 v[216:219], a[20:23], a[88:91], v[216:219]
s_add_u32 s64, s75, 2048
ds_read_b64_tr_b16 a[86:87], v7 offset:50176
v_mfma_f32_16x16x32_bf16 v[224:227], a[24:27], a[88:91], v[224:227]
buffer_load_dwordx4 v23, s[60:63], s64 offen lds
v_mfma_f32_16x16x32_bf16 v[232:235], a[28:31], a[88:91], v[232:235]
v_mfma_f32_16x16x32_bf16 v[240:243], a[32:35], a[88:91], v[240:243]
ds_read_b64_tr_b16 a[88:89], v8 offset:49152
v_mfma_f32_16x16x32_bf16 v[220:223], a[20:23], a[92:95], v[220:223]
ds_read_b64_tr_b16 a[90:91], v8 offset:50176
v_mfma_f32_16x16x32_bf16 v[228:231], a[24:27], a[92:95], v[228:231]
v_mfma_f32_16x16x32_bf16 v[236:239], a[28:31], a[92:95], v[236:239]
s_add_u32 m0, s78, 90112
v_mfma_f32_16x16x32_bf16 v[244:247], a[32:35], a[92:95], v[244:247]
s_add_u32 s64, s75, 4096
ds_read_b64_tr_b16 a[92:93], v9 offset:49152
v_mfma_f32_16x16x32_bf16 v[248:251], a[20:23], a[96:99], v[248:251]
buffer_load_dwordx4 v23, s[60:63], s64 offen lds
v_mfma_f32_16x16x32_bf16 v[252:255], a[24:27], a[96:99], v[252:255]
ds_read_b64_tr_b16 a[94:95], v9 offset:50176
v_mfma_f32_16x16x32_bf16 a[104:107], a[28:31], a[96:99], a[104:107]
v_mfma_f32_16x16x32_bf16 a[108:111], a[32:35], a[96:99], a[108:111]
ds_read_b64_tr_b16 a[96:97], v10 offset:49152
v_mfma_f32_16x16x32_bf16 a[112:115], a[20:23], a[100:103], a[112:115]
ds_read_b64_tr_b16 a[98:99], v10 offset:50176
v_mfma_f32_16x16x32_bf16 a[116:119], a[24:27], a[100:103], a[116:119]
v_mfma_f32_16x16x32_bf16 a[120:123], a[28:31], a[100:103], a[120:123]
s_add_u32 m0, s78, 94208
v_mfma_f32_16x16x32_bf16 a[124:127], a[32:35], a[100:103], a[124:127]
s_waitcnt lgkmcnt(4)
s_add_u32 s64, s74, 0
ds_read_b64_tr_b16 a[100:101], v11 offset:49152
v_mfma_f32_16x16x32_bf16 v[24:27], a[40:43], a[0:3], v[24:27]
buffer_load_dwordx4 v22, s[48:51], s64 offen lds
v_mfma_f32_16x16x32_bf16 v[40:43], a[40:43], a[4:7], v[40:43]
ds_read_b128 a[20:23], v3 offset:32768
v_mfma_f32_16x16x32_bf16 v[56:59], a[40:43], a[8:11], v[56:59]
ds_read_b128 a[24:27], v3 offset:34816
v_mfma_f32_16x16x32_bf16 v[72:75], a[40:43], a[12:15], v[72:75]
ds_read_b128 a[28:31], v3 offset:36864
v_mfma_f32_16x16x32_bf16 v[88:91], a[44:47], a[0:3], v[88:91]
ds_read_b128 a[32:35], v3 offset:38912
v_mfma_f32_16x16x32_bf16 v[104:107], a[44:47], a[4:7], v[104:107]
ds_read_b64_tr_b16 a[40:41], v4 offset:40960
v_mfma_f32_16x16x32_bf16 v[120:123], a[44:47], a[8:11], v[120:123]
ds_read_b64_tr_b16 a[42:43], v4 offset:41984
v_mfma_f32_16x16x32_bf16 v[136:139], a[44:47], a[12:15], v[136:139]
ds_read_b64_tr_b16 a[44:45], v5 offset:40960
v_mfma_f32_16x16x32_bf16 v[28:31], a[48:51], a[0:3], v[28:31]
ds_read_b64_tr_b16 a[46:47], v5 offset:41984
v_mfma_f32_16x16x32_bf16 v[44:47], a[48:51], a[4:7], v[44:47]
ds_read_b64_tr_b16 a[102:103], v11 offset:50176
v_mfma_f32_16x16x32_bf16 v[60:63], a[48:51], a[8:11], v[60:63]
v_mfma_f32_16x16x32_bf16 v[76:79], a[48:51], a[12:15], v[76:79]
ds_read_b64_tr_b16 a[48:49], v6 offset:40960
v_mfma_f32_16x16x32_bf16 v[92:95], a[52:55], a[0:3], v[92:95]
ds_read_b64_tr_b16 a[50:51], v6 offset:41984
v_mfma_f32_16x16x32_bf16 v[108:111], a[52:55], a[4:7], v[108:111]
s_waitcnt lgkmcnt(7)
v_mfma_f32_16x16x32_bf16 v[124:127], a[52:55], a[8:11], v[124:127]
s_add_u32 m0, s76, 32768
v_mfma_f32_16x16x32_bf16 v[140:143], a[52:55], a[12:15], v[140:143]
s_add_u32 s64, s72, 128
ds_read_b64_tr_b16 a[52:53], v7 offset:40960
v_mfma_f32_16x16x32_bf16 v[32:35], a[56:59], a[0:3], v[32:35]
buffer_load_dwordx4 v12, s[48:51], s64 offen lds
v_mfma_f32_16x16x32_bf16 v[48:51], a[56:59], a[4:7], v[48:51]
ds_read_b64_tr_b16 a[54:55], v7 offset:41984
v_mfma_f32_16x16x32_bf16 v[64:67], a[56:59], a[8:11], v[64:67]
v_mfma_f32_16x16x32_bf16 v[80:83], a[56:59], a[12:15], v[80:83]
s_add_u32 m0, s76, 33792
ds_read_b64_tr_b16 a[56:57], v8 offset:40960
v_mfma_f32_16x16x32_bf16 v[96:99], a[60:63], a[0:3], v[96:99]
s_add_u32 s64, s72, 16512
ds_read_b64_tr_b16 a[58:59], v8 offset:41984
v_mfma_f32_16x16x32_bf16 v[112:115], a[60:63], a[4:7], v[112:115]
buffer_load_dwordx4 v13, s[48:51], s64 offen lds
v_mfma_f32_16x16x32_bf16 v[128:131], a[60:63], a[8:11], v[128:131]
v_mfma_f32_16x16x32_bf16 v[144:147], a[60:63], a[12:15], v[144:147]
ds_read_b64_tr_b16 a[60:61], v9 offset:40960
v_mfma_f32_16x16x32_bf16 v[36:39], a[64:67], a[0:3], v[36:39]
ds_read_b64_tr_b16 a[62:63], v9 offset:41984
v_mfma_f32_16x16x32_bf16 v[52:55], a[64:67], a[4:7], v[52:55]
v_mfma_f32_16x16x32_bf16 v[68:71], a[64:67], a[8:11], v[68:71]
s_add_u32 m0, s76, 34816
v_mfma_f32_16x16x32_bf16 v[84:87], a[64:67], a[12:15], v[84:87]
s_add_u32 s64, s72, 131200
ds_read_b64_tr_b16 a[64:65], v10 offset:40960
v_mfma_f32_16x16x32_bf16 v[100:103], a[68:71], a[0:3], v[100:103]
buffer_load_dwordx4 v12, s[48:51], s64 offen lds
v_mfma_f32_16x16x32_bf16 v[116:119], a[68:71], a[4:7], v[116:119]
ds_read_b64_tr_b16 a[66:67], v10 offset:41984
v_mfma_f32_16x16x32_bf16 v[132:135], a[68:71], a[8:11], v[132:135]
v_mfma_f32_16x16x32_bf16 v[148:151], a[68:71], a[12:15], v[148:151]
ds_read_b64_tr_b16 a[68:69], v11 offset:40960
v_mfma_f32_16x16x32_bf16 v[152:155], a[0:3], a[72:75], v[152:155]
ds_read_b64_tr_b16 a[70:71], v11 offset:41984
v_mfma_f32_16x16x32_bf16 v[160:163], a[4:7], a[72:75], v[160:163]
s_add_u32 m0, s76, 35840
v_mfma_f32_16x16x32_bf16 v[168:171], a[8:11], a[72:75], v[168:171]
s_add_u32 s64, s72, 147584
v_mfma_f32_16x16x32_bf16 v[176:179], a[12:15], a[72:75], v[176:179]
buffer_load_dwordx4 v13, s[48:51], s64 offen lds
v_mfma_f32_16x16x32_bf16 v[156:159], a[0:3], a[76:79], v[156:159]
ds_read_b64_tr_b16 a[72:73], v4 offset:57344
v_mfma_f32_16x16x32_bf16 v[164:167], a[4:7], a[76:79], v[164:167]
ds_read_b64_tr_b16 a[74:75], v4 offset:58368
v_mfma_f32_16x16x32_bf16 v[172:175], a[8:11], a[76:79], v[172:175]
v_mfma_f32_16x16x32_bf16 v[180:183], a[12:15], a[76:79], v[180:183]
ds_read_b64_tr_b16 a[76:77], v5 offset:57344
v_mfma_f32_16x16x32_bf16 v[184:187], a[0:3], a[80:83], v[184:187]
s_add_u32 m0, s76, 36864
ds_read_b64_tr_b16 a[78:79], v5 offset:58368
v_mfma_f32_16x16x32_bf16 v[192:195], a[4:7], a[80:83], v[192:195]
s_add_u32 s64, s73, 128
v_mfma_f32_16x16x32_bf16 v[200:203], a[8:11], a[80:83], v[200:203]
buffer_load_dwordx4 v12, s[48:51], s64 offen lds
v_mfma_f32_16x16x32_bf16 v[208:211], a[12:15], a[80:83], v[208:211]
ds_read_b64_tr_b16 a[80:81], v6 offset:57344
v_mfma_f32_16x16x32_bf16 v[188:191], a[0:3], a[84:87], v[188:191]
ds_read_b64_tr_b16 a[82:83], v6 offset:58368
v_mfma_f32_16x16x32_bf16 v[196:199], a[4:7], a[84:87], v[196:199]
v_mfma_f32_16x16x32_bf16 v[204:207], a[8:11], a[84:87], v[204:207]
v_mfma_f32_16x16x32_bf16 v[212:215], a[12:15], a[84:87], v[212:215]
s_add_u32 m0, s76, 37888
ds_read_b64_tr_b16 a[84:85], v7 offset:57344
v_mfma_f32_16x16x32_bf16 v[216:219], a[0:3], a[88:91], v[216:219]
s_add_u32 s64, s73, 16512
ds_read_b64_tr_b16 a[86:87], v7 offset:58368
v_mfma_f32_16x16x32_bf16 v[224:227], a[4:7], a[88:91], v[224:227]
buffer_load_dwordx4 v13, s[48:51], s64 offen lds
v_mfma_f32_16x16x32_bf16 v[232:235], a[8:11], a[88:91], v[232:235]
v_mfma_f32_16x16x32_bf16 v[240:243], a[12:15], a[88:91], v[240:243]
ds_read_b64_tr_b16 a[88:89], v8 offset:57344
v_mfma_f32_16x16x32_bf16 v[220:223], a[0:3], a[92:95], v[220:223]
ds_read_b64_tr_b16 a[90:91], v8 offset:58368
v_mfma_f32_16x16x32_bf16 v[228:231], a[4:7], a[92:95], v[228:231]
v_mfma_f32_16x16x32_bf16 v[236:239], a[8:11], a[92:95], v[236:239]
s_add_u32 m0, s76, 38912
v_mfma_f32_16x16x32_bf16 v[244:247], a[12:15], a[92:95], v[244:247]
s_add_u32 s64, s73, 131200
ds_read_b64_tr_b16 a[92:93], v9 offset:57344
v_mfma_f32_16x16x32_bf16 v[248:251], a[0:3], a[96:99], v[248:251]
buffer_load_dwordx4 v12, s[48:51], s64 offen lds
v_mfma_f32_16x16x32_bf16 v[252:255], a[4:7], a[96:99], v[252:255]
ds_read_b64_tr_b16 a[94:95], v9 offset:58368
v_mfma_f32_16x16x32_bf16 a[104:107], a[8:11], a[96:99], a[104:107]
v_mfma_f32_16x16x32_bf16 a[108:111], a[12:15], a[96:99], a[108:111]
s_waitcnt lgkmcnt(4)
ds_read_b64_tr_b16 a[96:97], v10 offset:57344
v_mfma_f32_16x16x32_bf16 a[112:115], a[0:3], a[100:103], a[112:115]
ds_read_b64_tr_b16 a[98:99], v10 offset:58368
v_mfma_f32_16x16x32_bf16 a[116:119], a[4:7], a[100:103], a[116:119]
v_mfma_f32_16x16x32_bf16 a[120:123], a[8:11], a[100:103], a[120:123]
v_mfma_f32_16x16x32_bf16 a[124:127], a[12:15], a[100:103], a[124:127]
s_add_u32 m0, s76, 39936
ds_read_b64_tr_b16 a[100:101], v11 offset:57344
v_mfma_f32_16x16x32_bf16 v[24:27], a[40:43], a[20:23], v[24:27]
s_add_u32 s64, s73, 147584
ds_read_b64_tr_b16 a[102:103], v11 offset:58368
v_mfma_f32_16x16x32_bf16 v[40:43], a[40:43], a[24:27], v[40:43]
buffer_load_dwordx4 v13, s[48:51], s64 offen lds
v_mfma_f32_16x16x32_bf16 v[56:59], a[40:43], a[28:31], v[56:59]
v_mfma_f32_16x16x32_bf16 v[72:75], a[40:43], a[32:35], v[72:75]
v_mfma_f32_16x16x32_bf16 v[88:91], a[44:47], a[20:23], v[88:91]
v_mfma_f32_16x16x32_bf16 v[104:107], a[44:47], a[24:27], v[104:107]
v_mfma_f32_16x16x32_bf16 v[120:123], a[44:47], a[28:31], v[120:123]
v_mfma_f32_16x16x32_bf16 v[136:139], a[44:47], a[32:35], v[136:139]
v_mfma_f32_16x16x32_bf16 v[28:31], a[48:51], a[20:23], v[28:31]
s_waitcnt vmcnt(8) lgkmcnt(0)
s_barrier
v_mfma_f32_16x16x32_bf16 v[44:47], a[48:51], a[24:27], v[44:47]
s_add_u32 m0, s77, 98304
ds_read_b64_tr_b16 a[40:41], v4 offset:0
v_mfma_f32_16x16x32_bf16 v[60:63], a[48:51], a[28:31], v[60:63]
s_add_u32 s65, s79, 0
s_add_u32 s64, s71, 524288
ds_read_b64_tr_b16 a[42:43], v4 offset:1024
v_mfma_f32_16x16x32_bf16 v[76:79], a[48:51], a[32:35], v[76:79]
buffer_load_dwordx4 v14, s[56:59], s64 offen lds
v_mfma_f32_16x16x32_bf16 v[92:95], a[52:55], a[20:23], v[92:95]
ds_read_b64_tr_b16 a[44:45], v5 offset:0
v_cvt_pk_bf16_f32 v91, v90, v91
v_mfma_f32_16x16x32_bf16 v[108:111], a[52:55], a[24:27], v[108:111]
ds_read_b64_tr_b16 a[46:47], v5 offset:1024
v_cvt_pk_bf16_f32 v90, v88, v89
v_mfma_f32_16x16x32_bf16 v[124:127], a[52:55], a[28:31], v[124:127]
ds_read_b64_tr_b16 a[48:49], v6 offset:0
v_cvt_pk_bf16_f32 v88, v24, v25
v_mfma_f32_16x16x32_bf16 v[140:143], a[52:55], a[32:35], v[140:143]
ds_read_b64_tr_b16 a[50:51], v6 offset:1024
v_cvt_pk_bf16_f32 v89, v26, v27
v_mfma_f32_16x16x32_bf16 v[32:35], a[56:59], a[20:23], v[32:35]
s_add_u32 m0, s77, 99328
ds_read_b64_tr_b16 a[52:53], v7 offset:0
v_mfma_f32_16x16x32_bf16 v[48:51], a[56:59], a[24:27], v[48:51]
s_add_u32 s64, s71, 557056
ds_read_b64_tr_b16 a[54:55], v7 offset:1024
v_mfma_f32_16x16x32_bf16 v[64:67], a[56:59], a[28:31], v[64:67]
buffer_load_dwordx4 v14, s[56:59], s64 offen lds
v_mfma_f32_16x16x32_bf16 v[80:83], a[56:59], a[32:35], v[80:83]
ds_read_b64_tr_b16 a[56:57], v8 offset:0
v_mfma_f32_16x16x32_bf16 v[96:99], a[60:63], a[20:23], v[96:99]
ds_read_b64_tr_b16 a[58:59], v8 offset:1024
v_mfma_f32_16x16x32_bf16 v[112:115], a[60:63], a[24:27], v[112:115]
ds_read_b128 a[0:3], v2 offset:0
v_mfma_f32_16x16x32_bf16 v[128:131], a[60:63], a[28:31], v[128:131]
ds_read_b128 a[4:7], v2 offset:2048
v_mfma_f32_16x16x32_bf16 v[144:147], a[60:63], a[32:35], v[144:147]
ds_read_b64_tr_b16 a[60:61], v9 offset:0
v_mfma_f32_16x16x32_bf16 v[36:39], a[64:67], a[20:23], v[36:39]
s_add_u32 m0, s77, 100352
ds_read_b64_tr_b16 a[62:63], v9 offset:1024
v_mfma_f32_16x16x32_bf16 v[52:55], a[64:67], a[24:27], v[52:55]
s_add_u32 s64, s71, 589824
ds_read_b128 a[8:11], v2 offset:4096
v_mfma_f32_16x16x32_bf16 v[68:71], a[64:67], a[28:31], v[68:71]
buffer_load_dwordx4 v15, s[56:59], s64 offen lds
v_mfma_f32_16x16x32_bf16 v[84:87], a[64:67], a[32:35], v[84:87]
ds_read_b64_tr_b16 a[64:65], v10 offset:0
v_mfma_f32_16x16x32_bf16 v[100:103], a[68:71], a[20:23], v[100:103]
ds_read_b64_tr_b16 a[66:67], v10 offset:1024
v_mfma_f32_16x16x32_bf16 v[116:119], a[68:71], a[24:27], v[116:119]
ds_read_b128 a[12:15], v2 offset:6144
v_mfma_f32_16x16x32_bf16 v[132:135], a[68:71], a[28:31], v[132:135]
buffer_store_dwordx4 v[88:91], v16, s[44:47], s65 offen sc1
v_mfma_f32_16x16x32_bf16 v[148:151], a[68:71], a[32:35], v[148:151]
s_add_u32 m0, s77, 101376
ds_read_b64_tr_b16 a[68:69], v11 offset:0
v_cvt_pk_bf16_f32 v107, v106, v107
v_mfma_f32_16x16x32_bf16 v[152:155], a[20:23], a[72:75], v[152:155]
s_add_u32 s64, s71, 622592
ds_read_b64_tr_b16 a[70:71], v11 offset:1024
v_cvt_pk_bf16_f32 v106, v104, v105
v_mfma_f32_16x16x32_bf16 v[160:163], a[24:27], a[72:75], v[160:163]
buffer_load_dwordx4 v15, s[56:59], s64 offen lds
v_mfma_f32_16x16x32_bf16 v[168:171], a[28:31], a[72:75], v[168:171]
v_cvt_pk_bf16_f32 v104, v40, v41
v_cvt_pk_bf16_f32 v105, v42, v43
v_mfma_f32_16x16x32_bf16 v[176:179], a[32:35], a[72:75], v[176:179]
ds_read_b64_tr_b16 a[72:73], v19 offset:0
v_accvgpr_write_b32 a128, v104
v_mfma_f32_16x16x32_bf16 v[156:159], a[20:23], a[76:79], v[156:159]
ds_read_b64_tr_b16 a[74:75], v19 offset:256
v_accvgpr_write_b32 a129, v105
v_mfma_f32_16x16x32_bf16 v[164:167], a[24:27], a[76:79], v[164:167]
s_add_u32 m0, s78, 114688
v_accvgpr_write_b32 a130, v106
v_accvgpr_write_b32 a131, v107
v_mfma_f32_16x16x32_bf16 v[172:175], a[28:31], a[76:79], v[172:175]
s_add_u32 s64, s75, 393216
v_cvt_pk_bf16_f32 v123, v122, v123
v_cvt_pk_bf16_f32 v122, v120, v121
v_mfma_f32_16x16x32_bf16 v[180:183], a[32:35], a[76:79], v[180:183]
ds_read_b64_tr_b16 a[76:77], v20 offset:0
v_cvt_pk_bf16_f32 v120, v56, v57
v_mfma_f32_16x16x32_bf16 v[184:187], a[20:23], a[80:83], v[184:187]
ds_read_b64_tr_b16 a[78:79], v20 offset:256
v_cvt_pk_bf16_f32 v121, v58, v59
v_mfma_f32_16x16x32_bf16 v[192:195], a[24:27], a[80:83], v[192:195]
buffer_load_dwordx4 v23, s[60:63], s64 offen lds
v_mfma_f32_16x16x32_bf16 v[200:203], a[28:31], a[80:83], v[200:203]
v_accvgpr_write_b32 a132, v120
v_accvgpr_write_b32 a133, v121
v_mfma_f32_16x16x32_bf16 v[208:211], a[32:35], a[80:83], v[208:211]
v_accvgpr_write_b32 a134, v122
v_accvgpr_write_b32 a135, v123
v_mfma_f32_16x16x32_bf16 v[188:191], a[20:23], a[84:87], v[188:191]
v_cvt_pk_bf16_f32 v139, v138, v139
v_cvt_pk_bf16_f32 v138, v136, v137
v_mfma_f32_16x16x32_bf16 v[196:199], a[24:27], a[84:87], v[196:199]
s_add_u32 m0, s78, 118784
v_cvt_pk_bf16_f32 v136, v72, v73
v_cvt_pk_bf16_f32 v137, v74, v75
v_mfma_f32_16x16x32_bf16 v[204:207], a[28:31], a[84:87], v[204:207]
ds_read_b64_tr_b16 a[80:81], v19 offset:4096
v_accvgpr_write_b32 a136, v136
v_mfma_f32_16x16x32_bf16 v[212:215], a[32:35], a[84:87], v[212:215]
ds_read_b64_tr_b16 a[82:83], v19 offset:4352
v_accvgpr_write_b32 a137, v137
v_mfma_f32_16x16x32_bf16 v[216:219], a[20:23], a[88:91], v[216:219]
s_add_u32 s64, s75, 395264
v_accvgpr_write_b32 a138, v138
v_accvgpr_write_b32 a139, v139
v_mfma_f32_16x16x32_bf16 v[224:227], a[24:27], a[88:91], v[224:227]
s_add_u32 s65, s79, 1024
buffer_load_dwordx4 v23, s[60:63], s64 offen lds
v_mfma_f32_16x16x32_bf16 v[232:235], a[28:31], a[88:91], v[232:235]
v_cvt_pk_bf16_f32 v95, v94, v95
v_cvt_pk_bf16_f32 v94, v92, v93
v_mfma_f32_16x16x32_bf16 v[240:243], a[32:35], a[88:91], v[240:243]
v_cvt_pk_bf16_f32 v92, v28, v29
v_cvt_pk_bf16_f32 v93, v30, v31
v_mfma_f32_16x16x32_bf16 v[220:223], a[20:23], a[92:95], v[220:223]
ds_read_b64_tr_b16 a[84:85], v20 offset:4096
v_mfma_f32_16x16x32_bf16 v[228:231], a[24:27], a[92:95], v[228:231]
s_add_u32 m0, s78, 122880
ds_read_b64_tr_b16 a[86:87], v20 offset:4352
v_mfma_f32_16x16x32_bf16 v[236:239], a[28:31], a[92:95], v[236:239]
buffer_store_dwordx4 v[92:95], v16, s[44:47], s65 offen sc1
v_mfma_f32_16x16x32_bf16 v[244:247], a[32:35], a[92:95], v[244:247]
s_add_u32 s64, s75, 397312
v_cvt_pk_bf16_f32 v111, v110, v111
v_cvt_pk_bf16_f32 v110, v108, v109
v_mfma_f32_16x16x32_bf16 v[248:251], a[20:23], a[96:99], v[248:251]
buffer_load_dwordx4 v23, s[60:63], s64 offen lds
v_mfma_f32_16x16x32_bf16 v[252:255], a[24:27], a[96:99], v[252:255]
v_cvt_pk_bf16_f32 v108, v44, v45
v_cvt_pk_bf16_f32 v109, v46, v47
v_mfma_f32_16x16x32_bf16 a[104:107], a[28:31], a[96:99], a[104:107]
v_accvgpr_write_b32 a140, v108
v_accvgpr_write_b32 a141, v109
v_mfma_f32_16x16x32_bf16 a[108:111], a[32:35], a[96:99], a[108:111]
v_accvgpr_write_b32 a142, v110
v_accvgpr_write_b32 a143, v111
v_mfma_f32_16x16x32_bf16 a[112:115], a[20:23], a[100:103], a[112:115]
v_cvt_pk_bf16_f32 v127, v126, v127
v_cvt_pk_bf16_f32 v126, v124, v125
v_mfma_f32_16x16x32_bf16 a[116:119], a[24:27], a[100:103], a[116:119]
v_cvt_pk_bf16_f32 v124, v60, v61
v_cvt_pk_bf16_f32 v125, v62, v63
v_mfma_f32_16x16x32_bf16 a[120:123], a[28:31], a[100:103], a[120:123]
s_add_u32 m0, s78, 126976
v_accvgpr_write_b32 a144, v124
v_accvgpr_write_b32 a145, v125
v_mfma_f32_16x16x32_bf16 a[124:127], a[32:35], a[100:103], a[124:127]
s_waitcnt lgkmcnt(0)
s_add_u32 s64, s74, 128
v_accvgpr_write_b32 a146, v126
v_accvgpr_write_b32 a147, v127
v_mfma_f32_16x16x32_bf16 v[24:27], a[40:43], a[0:3], 0
buffer_load_dwordx4 v22, s[48:51], s64 offen lds
v_mfma_f32_16x16x32_bf16 v[40:43], a[40:43], a[4:7], 0
ds_read_b128 a[20:23], v3 offset:0
v_cvt_pk_bf16_f32 v143, v142, v143
v_mfma_f32_16x16x32_bf16 v[56:59], a[40:43], a[8:11], 0
ds_read_b128 a[24:27], v3 offset:2048
v_cvt_pk_bf16_f32 v142, v140, v141
v_mfma_f32_16x16x32_bf16 v[72:75], a[40:43], a[12:15], 0
ds_read_b128 a[28:31], v3 offset:4096
v_cvt_pk_bf16_f32 v140, v76, v77
v_mfma_f32_16x16x32_bf16 v[88:91], a[44:47], a[0:3], 0
ds_read_b128 a[32:35], v3 offset:6144
v_cvt_pk_bf16_f32 v141, v78, v79
v_mfma_f32_16x16x32_bf16 v[104:107], a[44:47], a[4:7], 0
ds_read_b64_tr_b16 a[88:89], v19 offset:8192
v_accvgpr_write_b32 a148, v140
v_mfma_f32_16x16x32_bf16 v[120:123], a[44:47], a[8:11], 0
ds_read_b64_tr_b16 a[90:91], v19 offset:8448
v_accvgpr_write_b32 a149, v141
v_mfma_f32_16x16x32_bf16 v[136:139], a[44:47], a[12:15], 0
v_accvgpr_write_b32 a150, v142
v_accvgpr_write_b32 a151, v143
v_mfma_f32_16x16x32_bf16 v[28:31], a[48:51], a[0:3], 0
s_add_u32 s65, s79, 2048
v_cvt_pk_bf16_f32 v99, v98, v99
v_cvt_pk_bf16_f32 v98, v96, v97
v_mfma_f32_16x16x32_bf16 v[44:47], a[48:51], a[4:7], 0
v_cvt_pk_bf16_f32 v96, v32, v33
v_cvt_pk_bf16_f32 v97, v34, v35
v_mfma_f32_16x16x32_bf16 v[60:63], a[48:51], a[8:11], 0
ds_read_b64_tr_b16 a[92:93], v20 offset:8192
v_mfma_f32_16x16x32_bf16 v[76:79], a[48:51], a[12:15], 0
ds_read_b64_tr_b16 a[94:95], v20 offset:8448
v_mfma_f32_16x16x32_bf16 v[92:95], a[52:55], a[0:3], 0
buffer_store_dwordx4 v[96:99], v16, s[44:47], s65 offen sc1
v_mfma_f32_16x16x32_bf16 v[108:111], a[52:55], a[4:7], 0
s_waitcnt lgkmcnt(4)
v_cvt_pk_bf16_f32 v115, v114, v115
v_cvt_pk_bf16_f32 v114, v112, v113
v_mfma_f32_16x16x32_bf16 v[124:127], a[52:55], a[8:11], 0
v_cvt_pk_bf16_f32 v112, v48, v49
v_cvt_pk_bf16_f32 v113, v50, v51
v_mfma_f32_16x16x32_bf16 v[140:143], a[52:55], a[12:15], 0
v_accvgpr_write_b32 a152, v112
v_accvgpr_write_b32 a153, v113
v_mfma_f32_16x16x32_bf16 v[32:35], a[56:59], a[0:3], 0
v_accvgpr_write_b32 a154, v114
v_accvgpr_write_b32 a155, v115
v_mfma_f32_16x16x32_bf16 v[48:51], a[56:59], a[4:7], 0
ds_read_b64_tr_b16 a[40:41], v4 offset:8192
ds_read_b64_tr_b16 a[42:43], v4 offset:9216
v_cvt_pk_bf16_f32 v131, v130, v131
v_cvt_pk_bf16_f32 v130, v128, v129
v_cvt_pk_bf16_f32 v128, v64, v65
v_cvt_pk_bf16_f32 v129, v66, v67
v_mfma_f32_16x16x32_bf16 v[64:67], a[56:59], a[8:11], 0
v_accvgpr_write_b32 a156, v128
v_accvgpr_write_b32 a157, v129
v_accvgpr_write_b32 a158, v130
v_accvgpr_write_b32 a159, v131
v_cvt_pk_bf16_f32 v147, v146, v147
v_cvt_pk_bf16_f32 v146, v144, v145
v_cvt_pk_bf16_f32 v144, v80, v81
v_cvt_pk_bf16_f32 v145, v82, v83
v_mfma_f32_16x16x32_bf16 v[80:83], a[56:59], a[12:15], 0
s_add_u32 m0, s76, 0
ds_read_b64_tr_b16 a[96:97], v21 offset:4096
ds_read_b64_tr_b16 a[98:99], v21 offset:4352
v_accvgpr_write_b32 a160, v144
v_mfma_f32_16x16x32_bf16 v[96:99], a[60:63], a[0:3], 0
s_add_u32 s64, s72, 256
ds_read_b128 a[16:19], v17 offset:0
v_accvgpr_write_b32 a161, v145
v_accvgpr_write_b32 a162, v146
v_accvgpr_write_b32 a163, v147
v_mfma_f32_16x16x32_bf16 v[112:115], a[60:63], a[4:7], 0
s_add_u32 s65, s79, 3072
ds_read_b64_tr_b16 a[44:45], v5 offset:8192
ds_read_b64_tr_b16 a[46:47], v5 offset:9216
buffer_load_dwordx4 v12, s[48:51], s64 offen lds
v_mfma_f32_16x16x32_bf16 v[128:131], a[60:63], a[8:11], 0
v_cvt_pk_bf16_f32 v103, v102, v103
v_cvt_pk_bf16_f32 v102, v100, v101
v_mfma_f32_16x16x32_bf16 v[144:147], a[60:63], a[12:15], 0
ds_read_b64_tr_b16 a[100:101], v21 offset:8192
ds_read_b64_tr_b16 a[102:103], v21 offset:8448
v_cvt_pk_bf16_f32 v100, v36, v37
v_cvt_pk_bf16_f32 v101, v38, v39
v_mfma_f32_16x16x32_bf16 v[36:39], a[64:67], a[0:3], 0
buffer_store_dwordx4 v[100:103], v16, s[44:47], s65 offen sc1
v_cvt_pk_bf16_f32 v119, v118, v119
v_cvt_pk_bf16_f32 v118, v116, v117
v_cvt_pk_bf16_f32 v116, v52, v53
v_cvt_pk_bf16_f32 v117, v54, v55
v_mfma_f32_16x16x32_bf16 v[52:55], a[64:67], a[4:7], 0
s_add_u32 m0, s76, 1024
ds_read_b64_tr_b16 a[48:49], v6 offset:8192
ds_read_b64_tr_b16 a[50:51], v6 offset:9216
v_accvgpr_write_b32 a164, v116
v_accvgpr_write_b32 a165, v117
v_accvgpr_write_b32 a166, v118
v_accvgpr_write_b32 a167, v119
v_cvt_pk_bf16_f32 v135, v134, v135
v_cvt_pk_bf16_f32 v134, v132, v133
v_cvt_pk_bf16_f32 v132, v68, v69
v_cvt_pk_bf16_f32 v133, v70, v71
v_mfma_f32_16x16x32_bf16 v[68:71], a[64:67], a[8:11], 0
s_add_u32 s64, s72, 16640
v_accvgpr_write_b32 a168, v132
v_accvgpr_write_b32 a169, v133
v_accvgpr_write_b32 a170, v134
v_accvgpr_write_b32 a171, v135
v_cvt_pk_bf16_f32 v151, v150, v151
v_cvt_pk_bf16_f32 v150, v148, v149
v_cvt_pk_bf16_f32 v148, v84, v85
v_cvt_pk_bf16_f32 v149, v86, v87
v_mfma_f32_16x16x32_bf16 v[84:87], a[64:67], a[12:15], 0
buffer_load_dwordx4 v13, s[48:51], s64 offen lds
v_mfma_f32_16x16x32_bf16 v[100:103], a[68:71], a[0:3], 0
v_accvgpr_write_b32 a172, v148
v_accvgpr_write_b32 a173, v149
v_accvgpr_write_b32 a174, v150
v_accvgpr_write_b32 a175, v151
v_mfma_f32_16x16x32_bf16 v[116:119], a[68:71], a[4:7], 0
s_add_u32 s65, s79, 8192
ds_read_b64_tr_b16 a[52:53], v7 offset:8192
ds_read_b64_tr_b16 a[54:55], v7 offset:9216
v_cvt_pk_bf16_f32 v163, v162, v163
v_cvt_pk_bf16_f32 v162, v160, v161
v_cvt_pk_bf16_f32 v160, v152, v153
v_cvt_pk_bf16_f32 v161, v154, v155
v_mfma_f32_16x16x32_bf16 v[132:135], a[68:71], a[8:11], 0
buffer_store_dwordx4 v[160:163], v16, s[44:47], s65 offen sc1
v_mfma_f32_16x16x32_bf16 v[148:151], a[68:71], a[12:15], 0
s_add_u32 m0, s76, 2048
v_cvt_pk_bf16_f32 v179, v178, v179
v_cvt_pk_bf16_f32 v178, v176, v177
v_mfma_f32_16x16x32_bf16 v[152:155], a[72:75], a[0:3], 0
s_add_u32 s64, s72, 131328
v_cvt_pk_bf16_f32 v176, v168, v169
v_cvt_pk_bf16_f32 v177, v170, v171
v_accvgpr_write_b32 a176, v176
v_accvgpr_write_b32 a177, v177
v_accvgpr_write_b32 a178, v178
v_accvgpr_write_b32 a179, v179
v_mfma_f32_16x16x32_bf16 v[160:163], a[72:75], a[4:7], 0
ds_read_b64_tr_b16 a[56:57], v8 offset:8192
ds_read_b64_tr_b16 a[58:59], v8 offset:9216
buffer_load_dwordx4 v12, s[48:51], s64 offen lds
v_mfma_f32_16x16x32_bf16 v[168:171], a[72:75], a[8:11], 0
v_cvt_pk_bf16_f32 v167, v166, v167
v_cvt_pk_bf16_f32 v166, v164, v165
v_cvt_pk_bf16_f32 v164, v156, v157
v_cvt_pk_bf16_f32 v165, v158, v159
v_accvgpr_write_b32 a180, v164
v_accvgpr_write_b32 a181, v165
v_accvgpr_write_b32 a182, v166
v_accvgpr_write_b32 a183, v167
v_mfma_f32_16x16x32_bf16 v[176:179], a[72:75], a[12:15], 0
s_add_u32 m0, s76, 3072
v_cvt_pk_bf16_f32 v183, v182, v183
v_cvt_pk_bf16_f32 v182, v180, v181
v_mfma_f32_16x16x32_bf16 v[156:159], a[76:79], a[0:3], 0
s_add_u32 s64, s72, 147712
v_cvt_pk_bf16_f32 v180, v172, v173
v_cvt_pk_bf16_f32 v181, v174, v175
v_accvgpr_write_b32 a184, v180
v_accvgpr_write_b32 a185, v181
v_accvgpr_write_b32 a186, v182
v_accvgpr_write_b32 a187, v183
v_mfma_f32_16x16x32_bf16 v[164:167], a[76:79], a[4:7], 0
s_add_u32 s65, s79, 10240
ds_read_b64_tr_b16 a[60:61], v9 offset:8192
ds_read_b64_tr_b16 a[62:63], v9 offset:9216
v_cvt_pk_bf16_f32 v195, v194, v195
v_cvt_pk_bf16_f32 v194, v192, v193
v_cvt_pk_bf16_f32 v192, v184, v185
v_cvt_pk_bf16_f32 v193, v186, v187
v_mfma_f32_16x16x32_bf16 v[172:175], a[76:79], a[8:11], 0
buffer_store_dwordx4 v[192:195], v16, s[44:47], s65 offen sc1
v_mfma_f32_16x16x32_bf16 v[180:183], a[76:79], a[12:15], 0
buffer_load_dwordx4 v13, s[48:51], s64 offen lds
v_mfma_f32_16x16x32_bf16 v[184:187], a[80:83], a[0:3], 0
v_cvt_pk_bf16_f32 v211, v210, v211
v_cvt_pk_bf16_f32 v210, v208, v209
v_cvt_pk_bf16_f32 v208, v200, v201
v_cvt_pk_bf16_f32 v209, v202, v203
v_accvgpr_write_b32 a188, v208
v_accvgpr_write_b32 a189, v209
v_accvgpr_write_b32 a190, v210
v_accvgpr_write_b32 a191, v211
v_mfma_f32_16x16x32_bf16 v[192:195], a[80:83], a[4:7], 0
ds_read_b64_tr_b16 a[64:65], v10 offset:8192
ds_read_b64_tr_b16 a[66:67], v10 offset:9216
v_cvt_pk_bf16_f32 v199, v198, v199
v_mfma_f32_16x16x32_bf16 v[200:203], a[80:83], a[8:11], 0
v_cvt_pk_bf16_f32 v198, v196, v197
v_cvt_pk_bf16_f32 v196, v188, v189
v_cvt_pk_bf16_f32 v197, v190, v191
v_accvgpr_write_b32 a192, v196
v_accvgpr_write_b32 a193, v197
v_accvgpr_write_b32 a194, v198
v_accvgpr_write_b32 a195, v199
v_mfma_f32_16x16x32_bf16 v[208:211], a[80:83], a[12:15], 0
s_add_u32 m0, s76, 4096
v_cvt_pk_bf16_f32 v215, v214, v215
v_cvt_pk_bf16_f32 v214, v212, v213
v_mfma_f32_16x16x32_bf16 v[188:191], a[84:87], a[0:3], 0
s_add_u32 s64, s73, 256
v_cvt_pk_bf16_f32 v212, v204, v205
v_cvt_pk_bf16_f32 v213, v206, v207
v_accvgpr_write_b32 a196, v212
v_accvgpr_write_b32 a197, v213
v_accvgpr_write_b32 a198, v214
v_accvgpr_write_b32 a199, v215
v_mfma_f32_16x16x32_bf16 v[196:199], a[84:87], a[4:7], 0
s_add_u32 s65, s79, 12288
ds_read_b64_tr_b16 a[68:69], v11 offset:8192
ds_read_b64_tr_b16 a[70:71], v11 offset:9216
buffer_load_dwordx4 v12, s[48:51], s64 offen lds
v_cvt_pk_bf16_f32 v227, v226, v227
v_cvt_pk_bf16_f32 v226, v224, v225
v_cvt_pk_bf16_f32 v224, v216, v217
v_cvt_pk_bf16_f32 v225, v218, v219
v_mfma_f32_16x16x32_bf16 v[204:207], a[84:87], a[8:11], 0
buffer_store_dwordx4 v[224:227], v16, s[44:47], s65 offen sc1
v_mfma_f32_16x16x32_bf16 v[212:215], a[84:87], a[12:15], 0
s_waitcnt lgkmcnt(4)
v_cvt_pk_bf16_f32 v243, v242, v243
v_cvt_pk_bf16_f32 v242, v240, v241
v_mfma_f32_16x16x32_bf16 v[216:219], a[0:3], a[88:91], 0
s_add_u32 m0, s76, 5120
v_cvt_pk_bf16_f32 v240, v232, v233
v_cvt_pk_bf16_f32 v241, v234, v235
v_accvgpr_write_b32 a200, v240
v_accvgpr_write_b32 a201, v241
v_accvgpr_write_b32 a202, v242
v_accvgpr_write_b32 a203, v243
v_mfma_f32_16x16x32_bf16 v[224:227], a[4:7], a[88:91], 0
ds_read_b64_tr_b16 a[72:73], v19 offset:2048
ds_read_b64_tr_b16 a[74:75], v19 offset:2304
v_cvt_pk_bf16_f32 v231, v230, v231
v_mfma_f32_16x16x32_bf16 v[232:235], a[8:11], a[88:91], 0
s_add_u32 s64, s73, 16640
v_cvt_pk_bf16_f32 v230, v228, v229
v_cvt_pk_bf16_f32 v228, v220, v221
v_cvt_pk_bf16_f32 v229, v222, v223
v_accvgpr_write_b32 a204, v228
v_accvgpr_write_b32 a205, v229
v_accvgpr_write_b32 a206, v230
v_accvgpr_write_b32 a207, v231
v_mfma_f32_16x16x32_bf16 v[240:243], a[12:15], a[88:91], 0
buffer_load_dwordx4 v13, s[48:51], s64 offen lds
v_cvt_pk_bf16_f32 v247, v246, v247
v_cvt_pk_bf16_f32 v246, v244, v245
v_cvt_pk_bf16_f32 v244, v236, v237
v_cvt_pk_bf16_f32 v245, v238, v239
v_accvgpr_write_b32 a208, v244
v_accvgpr_write_b32 a209, v245
v_accvgpr_write_b32 a210, v246
v_accvgpr_write_b32 a211, v247
s_add_u32 s65, s79, 14336
v_cvt_pk_bf16_f32 v255, v254, v255
v_cvt_pk_bf16_f32 v254, v252, v253
v_cvt_pk_bf16_f32 v252, v248, v249
v_cvt_pk_bf16_f32 v253, v250, v251
v_mfma_f32_16x16x32_bf16 v[220:223], a[0:3], a[92:95], 0
ds_read_b128 a[36:39], v18 offset:0
buffer_store_dwordx4 v[252:255], v16, s[44:47], s65 offen sc1
v_accvgpr_read_b32 v236, a104
v_accvgpr_read_b32 v237, a105
v_accvgpr_read_b32 v238, a106
v_accvgpr_read_b32 v239, a107
v_accvgpr_read_b32 v248, a108
v_accvgpr_read_b32 v249, a109
v_accvgpr_read_b32 v250, a110
v_accvgpr_read_b32 v251, a111
v_cvt_pk_bf16_f32 v251, v250, v251
v_cvt_pk_bf16_f32 v250, v248, v249
v_cvt_pk_bf16_f32 v248, v236, v237
v_cvt_pk_bf16_f32 v249, v238, v239
v_accvgpr_write_b32 a212, v248
v_accvgpr_write_b32 a213, v249
v_accvgpr_write_b32 a214, v250
v_accvgpr_write_b32 a215, v251
v_accvgpr_read_b32 v236, a112
v_accvgpr_read_b32 v237, a113
v_accvgpr_read_b32 v238, a114
v_accvgpr_read_b32 v239, a115
v_accvgpr_read_b32 v248, a116
v_accvgpr_read_b32 v249, a117
v_accvgpr_read_b32 v250, a118
v_accvgpr_read_b32 v251, a119
v_cvt_pk_bf16_f32 v251, v250, v251
v_cvt_pk_bf16_f32 v250, v248, v249
v_cvt_pk_bf16_f32 v248, v236, v237
v_cvt_pk_bf16_f32 v249, v238, v239
v_accvgpr_write_b32 a216, v248
v_accvgpr_write_b32 a217, v249
v_accvgpr_write_b32 a218, v250
v_accvgpr_write_b32 a219, v251
v_accvgpr_read_b32 v236, a120
v_accvgpr_read_b32 v237, a121
v_accvgpr_read_b32 v238, a122
v_accvgpr_read_b32 v239, a123
v_accvgpr_read_b32 v248, a124
v_accvgpr_read_b32 v249, a125
v_accvgpr_read_b32 v250, a126
v_accvgpr_read_b32 v251, a127
v_cvt_pk_bf16_f32 v251, v250, v251
v_cvt_pk_bf16_f32 v250, v248, v249
v_cvt_pk_bf16_f32 v248, v236, v237
v_cvt_pk_bf16_f32 v249, v238, v239
v_accvgpr_write_b32 a220, v248
v_accvgpr_write_b32 a221, v249
v_accvgpr_write_b32 a222, v250
v_accvgpr_write_b32 a223, v251
v_mfma_f32_16x16x32_bf16 v[228:231], a[4:7], a[92:95], 0
ds_read_b64_tr_b16 a[76:77], v20 offset:2048
ds_read_b64_tr_b16 a[78:79], v20 offset:2304
v_mfma_f32_16x16x32_bf16 v[236:239], a[8:11], a[92:95], 0
s_add_u32 m0, s76, 6144
ds_read_b64_tr_b16 a[80:81], v19 offset:6144
v_mfma_f32_16x16x32_bf16 v[244:247], a[12:15], a[92:95], 0
s_add_u32 s64, s73, 131328
ds_read_b64_tr_b16 a[82:83], v19 offset:6400
v_mfma_f32_16x16x32_bf16 v[248:251], a[96:99], a[16:19], 0
buffer_load_dwordx4 v12, s[48:51], s64 offen lds
v_mfma_f32_16x16x32_bf16 v[252:255], a[16:19], a[100:103], 0
ds_read_b64_tr_b16 a[84:85], v20 offset:6144
v_mfma_f32_16x16x32_bf16 v[24:27], a[40:43], a[20:23], v[24:27]
ds_read_b64_tr_b16 a[86:87], v20 offset:6400
v_mfma_f32_16x16x32_bf16 v[40:43], a[40:43], a[24:27], v[40:43]
ds_read_b64_tr_b16 a[88:89], v19 offset:10240
v_mfma_f32_16x16x32_bf16 v[56:59], a[40:43], a[28:31], v[56:59]
s_add_u32 m0, s76, 7168
ds_read_b64_tr_b16 a[90:91], v19 offset:10496
v_mfma_f32_16x16x32_bf16 v[72:75], a[40:43], a[32:35], v[72:75]
s_add_u32 s64, s73, 147712
ds_read_b64_tr_b16 a[92:93], v20 offset:10240
ds_read_b64_tr_b16 a[94:95], v20 offset:10496
ds_read_b64_tr_b16 a[96:97], v21 offset:6144
ds_read_b64_tr_b16 a[98:99], v21 offset:6400
ds_read_b64_tr_b16 a[100:101], v21 offset:10240
ds_read_b64_tr_b16 a[102:103], v21 offset:10496
v_mfma_f32_16x16x32_bf16 v[88:91], a[44:47], a[20:23], v[88:91]
buffer_load_dwordx4 v13, s[48:51], s64 offen lds
v_mfma_f32_16x16x32_bf16 v[104:107], a[44:47], a[24:27], v[104:107]
v_mfma_f32_16x16x32_bf16 v[120:123], a[44:47], a[28:31], v[120:123]
v_mfma_f32_16x16x32_bf16 v[136:139], a[44:47], a[32:35], v[136:139]
v_mfma_f32_16x16x32_bf16 v[28:31], a[48:51], a[20:23], v[28:31]
s_waitcnt vmcnt(14) lgkmcnt(0)
s_barrier
v_mfma_f32_16x16x32_bf16 v[44:47], a[48:51], a[24:27], v[44:47]
s_add_u32 m0, s77, 65536
ds_read_b64_tr_b16 a[40:41], v4 offset:32768
v_mfma_f32_16x16x32_bf16 v[60:63], a[48:51], a[28:31], v[60:63]
s_add_u32 s64, s71, 1048576
ds_read_b64_tr_b16 a[42:43], v4 offset:33792
v_mfma_f32_16x16x32_bf16 v[76:79], a[48:51], a[32:35], v[76:79]
buffer_load_dwordx4 v14, s[56:59], s64 offen lds
v_mfma_f32_16x16x32_bf16 v[92:95], a[52:55], a[20:23], v[92:95]
ds_read_b64_tr_b16 a[44:45], v5 offset:32768
v_mfma_f32_16x16x32_bf16 v[108:111], a[52:55], a[24:27], v[108:111]
ds_read_b64_tr_b16 a[46:47], v5 offset:33792
v_mfma_f32_16x16x32_bf16 v[124:127], a[52:55], a[28:31], v[124:127]
ds_read_b64_tr_b16 a[48:49], v6 offset:32768
v_mfma_f32_16x16x32_bf16 v[140:143], a[52:55], a[32:35], v[140:143]
s_add_u32 m0, s77, 66560
ds_read_b64_tr_b16 a[50:51], v6 offset:33792
v_mfma_f32_16x16x32_bf16 v[32:35], a[56:59], a[20:23], v[32:35]
s_add_u32 s64, s71, 1081344
ds_read_b64_tr_b16 a[52:53], v7 offset:32768
v_mfma_f32_16x16x32_bf16 v[48:51], a[56:59], a[24:27], v[48:51]
buffer_load_dwordx4 v14, s[56:59], s64 offen lds
v_mfma_f32_16x16x32_bf16 v[64:67], a[56:59], a[28:31], v[64:67]
ds_read_b64_tr_b16 a[54:55], v7 offset:33792
v_mfma_f32_16x16x32_bf16 v[80:83], a[56:59], a[32:35], v[80:83]
ds_read_b64_tr_b16 a[56:57], v8 offset:32768
v_mfma_f32_16x16x32_bf16 v[96:99], a[60:63], a[20:23], v[96:99]
ds_read_b64_tr_b16 a[58:59], v8 offset:33792
v_mfma_f32_16x16x32_bf16 v[112:115], a[60:63], a[24:27], v[112:115]
ds_read_b128 a[0:3], v2 offset:32768
v_mfma_f32_16x16x32_bf16 v[128:131], a[60:63], a[28:31], v[128:131]
s_add_u32 m0, s77, 67584
ds_read_b128 a[4:7], v2 offset:34816
v_mfma_f32_16x16x32_bf16 v[144:147], a[60:63], a[32:35], v[144:147]
s_add_u32 s64, s71, 1114112
ds_read_b64_tr_b16 a[60:61], v9 offset:32768
v_mfma_f32_16x16x32_bf16 v[36:39], a[64:67], a[20:23], v[36:39]
buffer_load_dwordx4 v15, s[56:59], s64 offen lds
v_mfma_f32_16x16x32_bf16 v[52:55], a[64:67], a[24:27], v[52:55]
ds_read_b64_tr_b16 a[62:63], v9 offset:33792
v_mfma_f32_16x16x32_bf16 v[68:71], a[64:67], a[28:31], v[68:71]
ds_read_b128 a[8:11], v2 offset:36864
v_mfma_f32_16x16x32_bf16 v[84:87], a[64:67], a[32:35], v[84:87]
ds_read_b128 a[12:15], v2 offset:38912
v_mfma_f32_16x16x32_bf16 v[100:103], a[68:71], a[20:23], v[100:103]
ds_read_b64_tr_b16 a[64:65], v10 offset:32768
v_mfma_f32_16x16x32_bf16 v[116:119], a[68:71], a[24:27], v[116:119]
s_add_u32 m0, s77, 68608
ds_read_b64_tr_b16 a[66:67], v10 offset:33792
v_mfma_f32_16x16x32_bf16 v[132:135], a[68:71], a[28:31], v[132:135]
s_add_u32 s64, s71, 1146880
ds_read_b128 a[16:19], v17 offset:32768
v_mfma_f32_16x16x32_bf16 v[148:151], a[68:71], a[32:35], v[148:151]
buffer_load_dwordx4 v15, s[56:59], s64 offen lds
v_mfma_f32_16x16x32_bf16 v[152:155], a[72:75], a[20:23], v[152:155]
ds_read_b64_tr_b16 a[68:69], v11 offset:32768
v_mfma_f32_16x16x32_bf16 v[160:163], a[72:75], a[24:27], v[160:163]
ds_read_b64_tr_b16 a[70:71], v11 offset:33792
v_mfma_f32_16x16x32_bf16 v[168:171], a[72:75], a[28:31], v[168:171]
v_mfma_f32_16x16x32_bf16 v[176:179], a[72:75], a[32:35], v[176:179]
ds_read_b64_tr_b16 a[72:73], v19 offset:32768
v_mfma_f32_16x16x32_bf16 v[156:159], a[76:79], a[20:23], v[156:159]
s_add_u32 m0, s78, 81920
ds_read_b64_tr_b16 a[74:75], v19 offset:33024
v_mfma_f32_16x16x32_bf16 v[164:167], a[76:79], a[24:27], v[164:167]
s_add_u32 s64, s75, 786432
v_mfma_f32_16x16x32_bf16 v[172:175], a[76:79], a[28:31], v[172:175]
buffer_load_dwordx4 v23, s[60:63], s64 offen lds
v_mfma_f32_16x16x32_bf16 v[180:183], a[76:79], a[32:35], v[180:183]
ds_read_b64_tr_b16 a[76:77], v20 offset:32768
v_mfma_f32_16x16x32_bf16 v[184:187], a[80:83], a[20:23], v[184:187]
ds_read_b64_tr_b16 a[78:79], v20 offset:33024
v_mfma_f32_16x16x32_bf16 v[192:195], a[80:83], a[24:27], v[192:195]
v_mfma_f32_16x16x32_bf16 v[200:203], a[80:83], a[28:31], v[200:203]
v_mfma_f32_16x16x32_bf16 v[208:211], a[80:83], a[32:35], v[208:211]
s_add_u32 m0, s78, 86016
ds_read_b64_tr_b16 a[80:81], v19 offset:36864
v_mfma_f32_16x16x32_bf16 v[188:191], a[84:87], a[20:23], v[188:191]
s_add_u32 s64, s75, 788480
ds_read_b64_tr_b16 a[82:83], v19 offset:37120
v_mfma_f32_16x16x32_bf16 v[196:199], a[84:87], a[24:27], v[196:199]
buffer_load_dwordx4 v23, s[60:63], s64 offen lds
v_mfma_f32_16x16x32_bf16 v[204:207], a[84:87], a[28:31], v[204:207]
v_mfma_f32_16x16x32_bf16 v[212:215], a[84:87], a[32:35], v[212:215]
ds_read_b64_tr_b16 a[84:85], v20 offset:36864
v_mfma_f32_16x16x32_bf16 v[216:219], a[20:23], a[88:91], v[216:219]
ds_read_b64_tr_b16 a[86:87], v20 offset:37120
v_mfma_f32_16x16x32_bf16 v[224:227], a[24:27], a[88:91], v[224:227]
v_mfma_f32_16x16x32_bf16 v[232:235], a[28:31], a[88:91], v[232:235]
s_add_u32 m0, s78, 90112
v_mfma_f32_16x16x32_bf16 v[240:243], a[32:35], a[88:91], v[240:243]
s_add_u32 s64, s75, 790528
ds_read_b64_tr_b16 a[88:89], v19 offset:40960
v_mfma_f32_16x16x32_bf16 v[220:223], a[20:23], a[92:95], v[220:223]
buffer_load_dwordx4 v23, s[60:63], s64 offen lds
v_mfma_f32_16x16x32_bf16 v[228:231], a[24:27], a[92:95], v[228:231]
ds_read_b64_tr_b16 a[90:91], v19 offset:41216
v_mfma_f32_16x16x32_bf16 v[236:239], a[28:31], a[92:95], v[236:239]
v_mfma_f32_16x16x32_bf16 v[244:247], a[32:35], a[92:95], v[244:247]
ds_read_b64_tr_b16 a[92:93], v20 offset:40960
v_mfma_f32_16x16x32_bf16 v[248:251], a[96:99], a[36:39], v[248:251]
ds_read_b64_tr_b16 a[94:95], v20 offset:41216
v_mfma_f32_16x16x32_bf16 v[252:255], a[36:39], a[100:103], v[252:255]
s_waitcnt lgkmcnt(5)
s_add_u32 m0, s78, 94208
ds_read_b64_tr_b16 a[96:97], v21 offset:36864
v_mfma_f32_16x16x32_bf16 v[24:27], a[40:43], a[0:3], v[24:27]
s_add_u32 s64, s74, 256
ds_read_b128 a[20:23], v3 offset:32768
v_mfma_f32_16x16x32_bf16 v[40:43], a[40:43], a[4:7], v[40:43]
buffer_load_dwordx4 v22, s[48:51], s64 offen lds
v_mfma_f32_16x16x32_bf16 v[56:59], a[40:43], a[8:11], v[56:59]
ds_read_b128 a[24:27], v3 offset:34816
v_mfma_f32_16x16x32_bf16 v[72:75], a[40:43], a[12:15], v[72:75]
ds_read_b128 a[28:31], v3 offset:36864
v_mfma_f32_16x16x32_bf16 v[88:91], a[44:47], a[0:3], v[88:91]
s_add_u32 s65, s79, 4096
ds_read_b128 a[32:35], v3 offset:38912
v_mfma_f32_16x16x32_bf16 v[104:107], a[44:47], a[4:7], v[104:107]
buffer_store_dwordx4 a[128:131], v16, s[44:47], s65 offen sc1
v_mfma_f32_16x16x32_bf16 v[120:123], a[44:47], a[8:11], v[120:123]
ds_read_b64_tr_b16 a[40:41], v4 offset:40960
v_mfma_f32_16x16x32_bf16 v[136:139], a[44:47], a[12:15], v[136:139]
ds_read_b64_tr_b16 a[42:43], v4 offset:41984
v_mfma_f32_16x16x32_bf16 v[28:31], a[48:51], a[0:3], v[28:31]
ds_read_b64_tr_b16 a[44:45], v5 offset:40960
v_mfma_f32_16x16x32_bf16 v[44:47], a[48:51], a[4:7], v[44:47]
ds_read_b64_tr_b16 a[46:47], v5 offset:41984
v_mfma_f32_16x16x32_bf16 v[60:63], a[48:51], a[8:11], v[60:63]
ds_read_b64_tr_b16 a[98:99], v21 offset:37120
v_mfma_f32_16x16x32_bf16 v[76:79], a[48:51], a[12:15], v[76:79]
ds_read_b64_tr_b16 a[100:101], v21 offset:40960
v_mfma_f32_16x16x32_bf16 v[92:95], a[52:55], a[0:3], v[92:95]
ds_read_b64_tr_b16 a[102:103], v21 offset:41216
v_mfma_f32_16x16x32_bf16 v[108:111], a[52:55], a[4:7], v[108:111]
s_waitcnt lgkmcnt(7)
ds_read_b64_tr_b16 a[48:49], v6 offset:40960
v_mfma_f32_16x16x32_bf16 v[124:127], a[52:55], a[8:11], v[124:127]
s_add_u32 m0, s76, 32768
ds_read_b64_tr_b16 a[50:51], v6 offset:41984
v_mfma_f32_16x16x32_bf16 v[140:143], a[52:55], a[12:15], v[140:143]
s_add_u32 s64, s72, 384
ds_read_b64_tr_b16 a[52:53], v7 offset:40960
v_mfma_f32_16x16x32_bf16 v[32:35], a[56:59], a[0:3], v[32:35]
buffer_load_dwordx4 v12, s[48:51], s64 offen lds
v_mfma_f32_16x16x32_bf16 v[48:51], a[56:59], a[4:7], v[48:51]
ds_read_b64_tr_b16 a[54:55], v7 offset:41984
v_mfma_f32_16x16x32_bf16 v[64:67], a[56:59], a[8:11], v[64:67]
ds_read_b128 a[36:39], v18 offset:32768
v_mfma_f32_16x16x32_bf16 v[80:83], a[56:59], a[12:15], v[80:83]
s_add_u32 m0, s76, 33792
ds_read_b64_tr_b16 a[56:57], v8 offset:40960
v_mfma_f32_16x16x32_bf16 v[96:99], a[60:63], a[0:3], v[96:99]
s_add_u32 s64, s72, 16768
ds_read_b64_tr_b16 a[58:59], v8 offset:41984
v_mfma_f32_16x16x32_bf16 v[112:115], a[60:63], a[4:7], v[112:115]
buffer_load_dwordx4 v13, s[48:51], s64 offen lds
v_mfma_f32_16x16x32_bf16 v[128:131], a[60:63], a[8:11], v[128:131]
v_mfma_f32_16x16x32_bf16 v[144:147], a[60:63], a[12:15], v[144:147]
s_add_u32 s65, s79, 16384
ds_read_b64_tr_b16 a[60:61], v9 offset:40960
v_mfma_f32_16x16x32_bf16 v[36:39], a[64:67], a[0:3], v[36:39]
buffer_store_dwordx4 a[132:135], v16, s[44:47], s65 offen sc1
v_mfma_f32_16x16x32_bf16 v[52:55], a[64:67], a[4:7], v[52:55]
s_add_u32 m0, s76, 34816
ds_read_b64_tr_b16 a[62:63], v9 offset:41984
v_mfma_f32_16x16x32_bf16 v[68:71], a[64:67], a[8:11], v[68:71]
s_add_u32 s64, s72, 131456
v_mfma_f32_16x16x32_bf16 v[84:87], a[64:67], a[12:15], v[84:87]
buffer_load_dwordx4 v12, s[48:51], s64 offen lds
v_mfma_f32_16x16x32_bf16 v[100:103], a[68:71], a[0:3], v[100:103]
ds_read_b64_tr_b16 a[64:65], v10 offset:40960
v_mfma_f32_16x16x32_bf16 v[116:119], a[68:71], a[4:7], v[116:119]
ds_read_b64_tr_b16 a[66:67], v10 offset:41984
v_mfma_f32_16x16x32_bf16 v[132:135], a[68:71], a[8:11], v[132:135]
v_mfma_f32_16x16x32_bf16 v[148:151], a[68:71], a[12:15], v[148:151]
s_add_u32 m0, s76, 35840
ds_read_b64_tr_b16 a[68:69], v11 offset:40960
v_mfma_f32_16x16x32_bf16 v[152:155], a[72:75], a[0:3], v[152:155]
s_add_u32 s64, s72, 147840
ds_read_b64_tr_b16 a[70:71], v11 offset:41984
v_mfma_f32_16x16x32_bf16 v[160:163], a[72:75], a[4:7], v[160:163]
buffer_load_dwordx4 v13, s[48:51], s64 offen lds
v_mfma_f32_16x16x32_bf16 v[168:171], a[72:75], a[8:11], v[168:171]
v_mfma_f32_16x16x32_bf16 v[176:179], a[72:75], a[12:15], v[176:179]
ds_read_b64_tr_b16 a[72:73], v19 offset:34816
v_mfma_f32_16x16x32_bf16 v[156:159], a[76:79], a[0:3], v[156:159]
ds_read_b64_tr_b16 a[74:75], v19 offset:35072
v_mfma_f32_16x16x32_bf16 v[164:167], a[76:79], a[4:7], v[164:167]
s_add_u32 m0, s76, 36864
v_mfma_f32_16x16x32_bf16 v[172:175], a[76:79], a[8:11], v[172:175]
s_add_u32 s64, s73, 384
v_mfma_f32_16x16x32_bf16 v[180:183], a[76:79], a[12:15], v[180:183]
buffer_load_dwordx4 v12, s[48:51], s64 offen lds
v_mfma_f32_16x16x32_bf16 v[184:187], a[80:83], a[0:3], v[184:187]
ds_read_b64_tr_b16 a[76:77], v20 offset:34816
v_mfma_f32_16x16x32_bf16 v[192:195], a[80:83], a[4:7], v[192:195]
s_add_u32 s65, s79, 20480
ds_read_b64_tr_b16 a[78:79], v20 offset:35072
v_mfma_f32_16x16x32_bf16 v[200:203], a[80:83], a[8:11], v[200:203]
s_add_u32 m0, s76, 37888
v_mfma_f32_16x16x32_bf16 v[208:211], a[80:83], a[12:15], v[208:211]
s_add_u32 s64, s73, 16768
ds_read_b64_tr_b16 a[80:81], v19 offset:38912
v_mfma_f32_16x16x32_bf16 v[188:191], a[84:87], a[0:3], v[188:191]
buffer_store_dwordx4 a[136:139], v16, s[44:47], s65 offen sc1
v_mfma_f32_16x16x32_bf16 v[196:199], a[84:87], a[4:7], v[196:199]
buffer_load_dwordx4 v13, s[48:51], s64 offen lds
v_mfma_f32_16x16x32_bf16 v[204:207], a[84:87], a[8:11], v[204:207]
ds_read_b64_tr_b16 a[82:83], v19 offset:39168
v_mfma_f32_16x16x32_bf16 v[212:215], a[84:87], a[12:15], v[212:215]
ds_read_b64_tr_b16 a[84:85], v20 offset:38912
v_mfma_f32_16x16x32_bf16 v[216:219], a[0:3], a[88:91], v[216:219]
ds_read_b64_tr_b16 a[86:87], v20 offset:39168
v_mfma_f32_16x16x32_bf16 v[224:227], a[4:7], a[88:91], v[224:227]
s_add_u32 m0, s76, 38912
v_mfma_f32_16x16x32_bf16 v[232:235], a[8:11], a[88:91], v[232:235]
s_add_u32 s64, s73, 131456
v_mfma_f32_16x16x32_bf16 v[240:243], a[12:15], a[88:91], v[240:243]
buffer_load_dwordx4 v12, s[48:51], s64 offen lds
v_mfma_f32_16x16x32_bf16 v[220:223], a[0:3], a[92:95], v[220:223]
ds_read_b64_tr_b16 a[88:89], v19 offset:43008
v_mfma_f32_16x16x32_bf16 v[228:231], a[4:7], a[92:95], v[228:231]
ds_read_b64_tr_b16 a[90:91], v19 offset:43264
v_mfma_f32_16x16x32_bf16 v[236:239], a[8:11], a[92:95], v[236:239]
v_mfma_f32_16x16x32_bf16 v[244:247], a[12:15], a[92:95], v[244:247]
s_waitcnt lgkmcnt(5)
ds_read_b64_tr_b16 a[92:93], v20 offset:43008
v_mfma_f32_16x16x32_bf16 v[248:251], a[96:99], a[16:19], v[248:251]
ds_read_b64_tr_b16 a[94:95], v20 offset:43264
v_mfma_f32_16x16x32_bf16 v[252:255], a[16:19], a[100:103], v[252:255]
ds_read_b64_tr_b16 a[96:97], v21 offset:38912
v_mfma_f32_16x16x32_bf16 v[24:27], a[40:43], a[20:23], v[24:27]
ds_read_b64_tr_b16 a[98:99], v21 offset:39168
v_mfma_f32_16x16x32_bf16 v[40:43], a[40:43], a[24:27], v[40:43]
s_add_u32 m0, s76, 39936
ds_read_b64_tr_b16 a[100:101], v21 offset:43008
v_mfma_f32_16x16x32_bf16 v[56:59], a[40:43], a[28:31], v[56:59]
s_add_u32 s64, s73, 147840
ds_read_b64_tr_b16 a[102:103], v21 offset:43264
v_mfma_f32_16x16x32_bf16 v[72:75], a[40:43], a[32:35], v[72:75]
buffer_load_dwordx4 v13, s[48:51], s64 offen lds
v_mfma_f32_16x16x32_bf16 v[88:91], a[44:47], a[20:23], v[88:91]
v_mfma_f32_16x16x32_bf16 v[104:107], a[44:47], a[24:27], v[104:107]
v_mfma_f32_16x16x32_bf16 v[120:123], a[44:47], a[28:31], v[120:123]
v_mfma_f32_16x16x32_bf16 v[136:139], a[44:47], a[32:35], v[136:139]
v_mfma_f32_16x16x32_bf16 v[28:31], a[48:51], a[20:23], v[28:31]
s_waitcnt vmcnt(11) lgkmcnt(0)
s_barrier
v_mfma_f32_16x16x32_bf16 v[44:47], a[48:51], a[24:27], v[44:47]
s_add_u32 m0, s77, 98304
ds_read_b64_tr_b16 a[40:41], v4 offset:0
v_mfma_f32_16x16x32_bf16 v[60:63], a[48:51], a[28:31], v[60:63]
s_add_u32 s64, s71, 1572864
ds_read_b64_tr_b16 a[42:43], v4 offset:1024
v_mfma_f32_16x16x32_bf16 v[76:79], a[48:51], a[32:35], v[76:79]
buffer_load_dwordx4 v14, s[56:59], s64 offen lds
v_mfma_f32_16x16x32_bf16 v[92:95], a[52:55], a[20:23], v[92:95]
ds_read_b64_tr_b16 a[44:45], v5 offset:0
v_mfma_f32_16x16x32_bf16 v[108:111], a[52:55], a[24:27], v[108:111]
ds_read_b64_tr_b16 a[46:47], v5 offset:1024
v_mfma_f32_16x16x32_bf16 v[124:127], a[52:55], a[28:31], v[124:127]
ds_read_b64_tr_b16 a[48:49], v6 offset:0
v_mfma_f32_16x16x32_bf16 v[140:143], a[52:55], a[32:35], v[140:143]
s_add_u32 m0, s77, 99328
ds_read_b64_tr_b16 a[50:51], v6 offset:1024
v_mfma_f32_16x16x32_bf16 v[32:35], a[56:59], a[20:23], v[32:35]
s_add_u32 s64, s71, 1605632
ds_read_b64_tr_b16 a[52:53], v7 offset:0
v_mfma_f32_16x16x32_bf16 v[48:51], a[56:59], a[24:27], v[48:51]
buffer_load_dwordx4 v14, s[56:59], s64 offen lds
v_mfma_f32_16x16x32_bf16 v[64:67], a[56:59], a[28:31], v[64:67]
ds_read_b64_tr_b16 a[54:55], v7 offset:1024
v_mfma_f32_16x16x32_bf16 v[80:83], a[56:59], a[32:35], v[80:83]
ds_read_b64_tr_b16 a[56:57], v8 offset:0
v_mfma_f32_16x16x32_bf16 v[96:99], a[60:63], a[20:23], v[96:99]
ds_read_b64_tr_b16 a[58:59], v8 offset:1024
v_mfma_f32_16x16x32_bf16 v[112:115], a[60:63], a[24:27], v[112:115]
ds_read_b128 a[0:3], v2 offset:0
v_mfma_f32_16x16x32_bf16 v[128:131], a[60:63], a[28:31], v[128:131]
s_add_u32 m0, s77, 100352
ds_read_b128 a[4:7], v2 offset:2048
v_mfma_f32_16x16x32_bf16 v[144:147], a[60:63], a[32:35], v[144:147]
s_add_u32 s64, s71, 1638400
ds_read_b64_tr_b16 a[60:61], v9 offset:0
v_mfma_f32_16x16x32_bf16 v[36:39], a[64:67], a[20:23], v[36:39]
buffer_load_dwordx4 v15, s[56:59], s64 offen lds
v_mfma_f32_16x16x32_bf16 v[52:55], a[64:67], a[24:27], v[52:55]
ds_read_b64_tr_b16 a[62:63], v9 offset:1024
v_mfma_f32_16x16x32_bf16 v[68:71], a[64:67], a[28:31], v[68:71]
ds_read_b128 a[8:11], v2 offset:4096
v_mfma_f32_16x16x32_bf16 v[84:87], a[64:67], a[32:35], v[84:87]
ds_read_b128 a[12:15], v2 offset:6144
v_mfma_f32_16x16x32_bf16 v[100:103], a[68:71], a[20:23], v[100:103]
ds_read_b64_tr_b16 a[64:65], v10 offset:0
v_mfma_f32_16x16x32_bf16 v[116:119], a[68:71], a[24:27], v[116:119]
s_add_u32 m0, s77, 101376
ds_read_b64_tr_b16 a[66:67], v10 offset:1024
v_mfma_f32_16x16x32_bf16 v[132:135], a[68:71], a[28:31], v[132:135]
s_add_u32 s64, s71, 1671168
ds_read_b128 a[16:19], v17 offset:0
v_mfma_f32_16x16x32_bf16 v[148:151], a[68:71], a[32:35], v[148:151]
buffer_load_dwordx4 v15, s[56:59], s64 offen lds
v_mfma_f32_16x16x32_bf16 v[152:155], a[72:75], a[20:23], v[152:155]
ds_read_b64_tr_b16 a[68:69], v11 offset:0
v_mfma_f32_16x16x32_bf16 v[160:163], a[72:75], a[24:27], v[160:163]
ds_read_b64_tr_b16 a[70:71], v11 offset:1024
v_mfma_f32_16x16x32_bf16 v[168:171], a[72:75], a[28:31], v[168:171]
v_mfma_f32_16x16x32_bf16 v[176:179], a[72:75], a[32:35], v[176:179]
ds_read_b64_tr_b16 a[72:73], v19 offset:0
v_mfma_f32_16x16x32_bf16 v[156:159], a[76:79], a[20:23], v[156:159]
s_add_u32 m0, s78, 114688
ds_read_b64_tr_b16 a[74:75], v19 offset:256
v_mfma_f32_16x16x32_bf16 v[164:167], a[76:79], a[24:27], v[164:167]
s_add_u32 s64, s75, 1179648
v_mfma_f32_16x16x32_bf16 v[172:175], a[76:79], a[28:31], v[172:175]
buffer_load_dwordx4 v23, s[60:63], s64 offen lds
v_mfma_f32_16x16x32_bf16 v[180:183], a[76:79], a[32:35], v[180:183]
ds_read_b64_tr_b16 a[76:77], v20 offset:0
v_mfma_f32_16x16x32_bf16 v[184:187], a[80:83], a[20:23], v[184:187]
ds_read_b64_tr_b16 a[78:79], v20 offset:256
v_mfma_f32_16x16x32_bf16 v[192:195], a[80:83], a[24:27], v[192:195]
v_mfma_f32_16x16x32_bf16 v[200:203], a[80:83], a[28:31], v[200:203]
v_mfma_f32_16x16x32_bf16 v[208:211], a[80:83], a[32:35], v[208:211]
s_add_u32 m0, s78, 118784
ds_read_b64_tr_b16 a[80:81], v19 offset:4096
v_mfma_f32_16x16x32_bf16 v[188:191], a[84:87], a[20:23], v[188:191]
s_add_u32 s64, s75, 1181696
ds_read_b64_tr_b16 a[82:83], v19 offset:4352
v_mfma_f32_16x16x32_bf16 v[196:199], a[84:87], a[24:27], v[196:199]
buffer_load_dwordx4 v23, s[60:63], s64 offen lds
v_mfma_f32_16x16x32_bf16 v[204:207], a[84:87], a[28:31], v[204:207]
v_mfma_f32_16x16x32_bf16 v[212:215], a[84:87], a[32:35], v[212:215]
ds_read_b64_tr_b16 a[84:85], v20 offset:4096
v_mfma_f32_16x16x32_bf16 v[216:219], a[20:23], a[88:91], v[216:219]
ds_read_b64_tr_b16 a[86:87], v20 offset:4352
v_mfma_f32_16x16x32_bf16 v[224:227], a[24:27], a[88:91], v[224:227]
v_mfma_f32_16x16x32_bf16 v[232:235], a[28:31], a[88:91], v[232:235]
s_add_u32 m0, s78, 122880
v_mfma_f32_16x16x32_bf16 v[240:243], a[32:35], a[88:91], v[240:243]
s_add_u32 s64, s75, 1183744
ds_read_b64_tr_b16 a[88:89], v19 offset:8192
v_mfma_f32_16x16x32_bf16 v[220:223], a[20:23], a[92:95], v[220:223]
buffer_load_dwordx4 v23, s[60:63], s64 offen lds
v_mfma_f32_16x16x32_bf16 v[228:231], a[24:27], a[92:95], v[228:231]
ds_read_b64_tr_b16 a[90:91], v19 offset:8448
v_mfma_f32_16x16x32_bf16 v[236:239], a[28:31], a[92:95], v[236:239]
v_mfma_f32_16x16x32_bf16 v[244:247], a[32:35], a[92:95], v[244:247]
ds_read_b64_tr_b16 a[92:93], v20 offset:8192
v_mfma_f32_16x16x32_bf16 v[248:251], a[96:99], a[36:39], v[248:251]
ds_read_b64_tr_b16 a[94:95], v20 offset:8448
v_mfma_f32_16x16x32_bf16 v[252:255], a[36:39], a[100:103], v[252:255]
s_waitcnt lgkmcnt(5)
s_add_u32 m0, s78, 126976
ds_read_b64_tr_b16 a[96:97], v21 offset:4096
v_mfma_f32_16x16x32_bf16 v[24:27], a[40:43], a[0:3], v[24:27]
s_add_u32 s64, s74, 384
ds_read_b128 a[20:23], v3 offset:0
v_mfma_f32_16x16x32_bf16 v[40:43], a[40:43], a[4:7], v[40:43]
buffer_load_dwordx4 v22, s[48:51], s64 offen lds
v_mfma_f32_16x16x32_bf16 v[56:59], a[40:43], a[8:11], v[56:59]
ds_read_b128 a[24:27], v3 offset:2048
v_mfma_f32_16x16x32_bf16 v[72:75], a[40:43], a[12:15], v[72:75]
ds_read_b128 a[28:31], v3 offset:4096
v_mfma_f32_16x16x32_bf16 v[88:91], a[44:47], a[0:3], v[88:91]
s_add_u32 s65, s79, 5120
ds_read_b128 a[32:35], v3 offset:6144
v_mfma_f32_16x16x32_bf16 v[104:107], a[44:47], a[4:7], v[104:107]
buffer_store_dwordx4 a[140:143], v16, s[44:47], s65 offen sc1
v_mfma_f32_16x16x32_bf16 v[120:123], a[44:47], a[8:11], v[120:123]
ds_read_b64_tr_b16 a[40:41], v4 offset:8192
v_mfma_f32_16x16x32_bf16 v[136:139], a[44:47], a[12:15], v[136:139]
ds_read_b64_tr_b16 a[42:43], v4 offset:9216
v_mfma_f32_16x16x32_bf16 v[28:31], a[48:51], a[0:3], v[28:31]
ds_read_b64_tr_b16 a[44:45], v5 offset:8192
v_mfma_f32_16x16x32_bf16 v[44:47], a[48:51], a[4:7], v[44:47]
ds_read_b64_tr_b16 a[46:47], v5 offset:9216
v_mfma_f32_16x16x32_bf16 v[60:63], a[48:51], a[8:11], v[60:63]
ds_read_b64_tr_b16 a[98:99], v21 offset:4352
v_mfma_f32_16x16x32_bf16 v[76:79], a[48:51], a[12:15], v[76:79]
ds_read_b64_tr_b16 a[100:101], v21 offset:8192
v_mfma_f32_16x16x32_bf16 v[92:95], a[52:55], a[0:3], v[92:95]
ds_read_b64_tr_b16 a[102:103], v21 offset:8448
v_mfma_f32_16x16x32_bf16 v[108:111], a[52:55], a[4:7], v[108:111]
s_waitcnt lgkmcnt(7)
ds_read_b64_tr_b16 a[48:49], v6 offset:8192
v_mfma_f32_16x16x32_bf16 v[124:127], a[52:55], a[8:11], v[124:127]
s_add_u32 m0, s76, 0
ds_read_b64_tr_b16 a[50:51], v6 offset:9216
v_mfma_f32_16x16x32_bf16 v[140:143], a[52:55], a[12:15], v[140:143]
s_add_u32 s64, s72, 512
ds_read_b64_tr_b16 a[52:53], v7 offset:8192
v_mfma_f32_16x16x32_bf16 v[32:35], a[56:59], a[0:3], v[32:35]
buffer_load_dwordx4 v12, s[48:51], s64 offen lds
v_mfma_f32_16x16x32_bf16 v[48:51], a[56:59], a[4:7], v[48:51]
ds_read_b64_tr_b16 a[54:55], v7 offset:9216
v_mfma_f32_16x16x32_bf16 v[64:67], a[56:59], a[8:11], v[64:67]
ds_read_b128 a[36:39], v18 offset:0
v_mfma_f32_16x16x32_bf16 v[80:83], a[56:59], a[12:15], v[80:83]
s_add_u32 m0, s76, 1024
ds_read_b64_tr_b16 a[56:57], v8 offset:8192
v_mfma_f32_16x16x32_bf16 v[96:99], a[60:63], a[0:3], v[96:99]
s_add_u32 s64, s72, 16896
ds_read_b64_tr_b16 a[58:59], v8 offset:9216
v_mfma_f32_16x16x32_bf16 v[112:115], a[60:63], a[4:7], v[112:115]
buffer_load_dwordx4 v13, s[48:51], s64 offen lds
v_mfma_f32_16x16x32_bf16 v[128:131], a[60:63], a[8:11], v[128:131]
v_mfma_f32_16x16x32_bf16 v[144:147], a[60:63], a[12:15], v[144:147]
s_add_u32 s65, s79, 17408
ds_read_b64_tr_b16 a[60:61], v9 offset:8192
v_mfma_f32_16x16x32_bf16 v[36:39], a[64:67], a[0:3], v[36:39]
buffer_store_dwordx4 a[144:147], v16, s[44:47], s65 offen sc1
v_mfma_f32_16x16x32_bf16 v[52:55], a[64:67], a[4:7], v[52:55]
s_add_u32 m0, s76, 2048
ds_read_b64_tr_b16 a[62:63], v9 offset:9216
v_mfma_f32_16x16x32_bf16 v[68:71], a[64:67], a[8:11], v[68:71]
s_add_u32 s64, s72, 131584
v_mfma_f32_16x16x32_bf16 v[84:87], a[64:67], a[12:15], v[84:87]
buffer_load_dwordx4 v12, s[48:51], s64 offen lds
v_mfma_f32_16x16x32_bf16 v[100:103], a[68:71], a[0:3], v[100:103]
ds_read_b64_tr_b16 a[64:65], v10 offset:8192
v_mfma_f32_16x16x32_bf16 v[116:119], a[68:71], a[4:7], v[116:119]
ds_read_b64_tr_b16 a[66:67], v10 offset:9216
v_mfma_f32_16x16x32_bf16 v[132:135], a[68:71], a[8:11], v[132:135]
v_mfma_f32_16x16x32_bf16 v[148:151], a[68:71], a[12:15], v[148:151]
s_add_u32 m0, s76, 3072
ds_read_b64_tr_b16 a[68:69], v11 offset:8192
v_mfma_f32_16x16x32_bf16 v[152:155], a[72:75], a[0:3], v[152:155]
s_add_u32 s64, s72, 147968
ds_read_b64_tr_b16 a[70:71], v11 offset:9216
v_mfma_f32_16x16x32_bf16 v[160:163], a[72:75], a[4:7], v[160:163]
buffer_load_dwordx4 v13, s[48:51], s64 offen lds
v_mfma_f32_16x16x32_bf16 v[168:171], a[72:75], a[8:11], v[168:171]
v_mfma_f32_16x16x32_bf16 v[176:179], a[72:75], a[12:15], v[176:179]
ds_read_b64_tr_b16 a[72:73], v19 offset:2048
v_mfma_f32_16x16x32_bf16 v[156:159], a[76:79], a[0:3], v[156:159]
ds_read_b64_tr_b16 a[74:75], v19 offset:2304
v_mfma_f32_16x16x32_bf16 v[164:167], a[76:79], a[4:7], v[164:167]
s_add_u32 m0, s76, 4096
v_mfma_f32_16x16x32_bf16 v[172:175], a[76:79], a[8:11], v[172:175]
s_add_u32 s64, s73, 512
v_mfma_f32_16x16x32_bf16 v[180:183], a[76:79], a[12:15], v[180:183]
buffer_load_dwordx4 v12, s[48:51], s64 offen lds
v_mfma_f32_16x16x32_bf16 v[184:187], a[80:83], a[0:3], v[184:187]
ds_read_b64_tr_b16 a[76:77], v20 offset:2048
v_mfma_f32_16x16x32_bf16 v[192:195], a[80:83], a[4:7], v[192:195]
s_add_u32 s65, s79, 21504
ds_read_b64_tr_b16 a[78:79], v20 offset:2304
v_mfma_f32_16x16x32_bf16 v[200:203], a[80:83], a[8:11], v[200:203]
s_add_u32 m0, s76, 5120
v_mfma_f32_16x16x32_bf16 v[208:211], a[80:83], a[12:15], v[208:211]
s_add_u32 s64, s73, 16896
ds_read_b64_tr_b16 a[80:81], v19 offset:6144
v_mfma_f32_16x16x32_bf16 v[188:191], a[84:87], a[0:3], v[188:191]
buffer_store_dwordx4 a[148:151], v16, s[44:47], s65 offen sc1
v_mfma_f32_16x16x32_bf16 v[196:199], a[84:87], a[4:7], v[196:199]
buffer_load_dwordx4 v13, s[48:51], s64 offen lds
v_mfma_f32_16x16x32_bf16 v[204:207], a[84:87], a[8:11], v[204:207]
ds_read_b64_tr_b16 a[82:83], v19 offset:6400
v_mfma_f32_16x16x32_bf16 v[212:215], a[84:87], a[12:15], v[212:215]
ds_read_b64_tr_b16 a[84:85], v20 offset:6144
v_mfma_f32_16x16x32_bf16 v[216:219], a[0:3], a[88:91], v[216:219]
ds_read_b64_tr_b16 a[86:87], v20 offset:6400
v_mfma_f32_16x16x32_bf16 v[224:227], a[4:7], a[88:91], v[224:227]
s_add_u32 m0, s76, 6144
v_mfma_f32_16x16x32_bf16 v[232:235], a[8:11], a[88:91], v[232:235]
s_add_u32 s64, s73, 131584
v_mfma_f32_16x16x32_bf16 v[240:243], a[12:15], a[88:91], v[240:243]
buffer_load_dwordx4 v12, s[48:51], s64 offen lds
v_mfma_f32_16x16x32_bf16 v[220:223], a[0:3], a[92:95], v[220:223]
ds_read_b64_tr_b16 a[88:89], v19 offset:10240
v_mfma_f32_16x16x32_bf16 v[228:231], a[4:7], a[92:95], v[228:231]
ds_read_b64_tr_b16 a[90:91], v19 offset:10496
v_mfma_f32_16x16x32_bf16 v[236:239], a[8:11], a[92:95], v[236:239]
v_mfma_f32_16x16x32_bf16 v[244:247], a[12:15], a[92:95], v[244:247]
s_waitcnt lgkmcnt(5)
ds_read_b64_tr_b16 a[92:93], v20 offset:10240
v_mfma_f32_16x16x32_bf16 v[248:251], a[96:99], a[16:19], v[248:251]
ds_read_b64_tr_b16 a[94:95], v20 offset:10496
v_mfma_f32_16x16x32_bf16 v[252:255], a[16:19], a[100:103], v[252:255]
ds_read_b64_tr_b16 a[96:97], v21 offset:6144
v_mfma_f32_16x16x32_bf16 v[24:27], a[40:43], a[20:23], v[24:27]
ds_read_b64_tr_b16 a[98:99], v21 offset:6400
v_mfma_f32_16x16x32_bf16 v[40:43], a[40:43], a[24:27], v[40:43]
s_add_u32 m0, s76, 7168
ds_read_b64_tr_b16 a[100:101], v21 offset:10240
v_mfma_f32_16x16x32_bf16 v[56:59], a[40:43], a[28:31], v[56:59]
s_add_u32 s64, s73, 147968
ds_read_b64_tr_b16 a[102:103], v21 offset:10496
v_mfma_f32_16x16x32_bf16 v[72:75], a[40:43], a[32:35], v[72:75]
buffer_load_dwordx4 v13, s[48:51], s64 offen lds
v_mfma_f32_16x16x32_bf16 v[88:91], a[44:47], a[20:23], v[88:91]
v_mfma_f32_16x16x32_bf16 v[104:107], a[44:47], a[24:27], v[104:107]
v_mfma_f32_16x16x32_bf16 v[120:123], a[44:47], a[28:31], v[120:123]
v_mfma_f32_16x16x32_bf16 v[136:139], a[44:47], a[32:35], v[136:139]
v_mfma_f32_16x16x32_bf16 v[28:31], a[48:51], a[20:23], v[28:31]
s_waitcnt vmcnt(11) lgkmcnt(0)
s_barrier
v_mfma_f32_16x16x32_bf16 v[44:47], a[48:51], a[24:27], v[44:47]
s_add_u32 m0, s77, 65536
ds_read_b64_tr_b16 a[40:41], v4 offset:32768
v_mfma_f32_16x16x32_bf16 v[60:63], a[48:51], a[28:31], v[60:63]
s_add_u32 s64, s71, 2097152
ds_read_b64_tr_b16 a[42:43], v4 offset:33792
v_mfma_f32_16x16x32_bf16 v[76:79], a[48:51], a[32:35], v[76:79]
buffer_load_dwordx4 v14, s[56:59], s64 offen lds
v_mfma_f32_16x16x32_bf16 v[92:95], a[52:55], a[20:23], v[92:95]
ds_read_b64_tr_b16 a[44:45], v5 offset:32768
v_mfma_f32_16x16x32_bf16 v[108:111], a[52:55], a[24:27], v[108:111]
ds_read_b64_tr_b16 a[46:47], v5 offset:33792
v_mfma_f32_16x16x32_bf16 v[124:127], a[52:55], a[28:31], v[124:127]
ds_read_b64_tr_b16 a[48:49], v6 offset:32768
v_mfma_f32_16x16x32_bf16 v[140:143], a[52:55], a[32:35], v[140:143]
s_add_u32 m0, s77, 66560
ds_read_b64_tr_b16 a[50:51], v6 offset:33792
v_mfma_f32_16x16x32_bf16 v[32:35], a[56:59], a[20:23], v[32:35]
s_add_u32 s64, s71, 2129920
ds_read_b64_tr_b16 a[52:53], v7 offset:32768
v_mfma_f32_16x16x32_bf16 v[48:51], a[56:59], a[24:27], v[48:51]
buffer_load_dwordx4 v14, s[56:59], s64 offen lds
v_mfma_f32_16x16x32_bf16 v[64:67], a[56:59], a[28:31], v[64:67]
ds_read_b64_tr_b16 a[54:55], v7 offset:33792
v_mfma_f32_16x16x32_bf16 v[80:83], a[56:59], a[32:35], v[80:83]
ds_read_b64_tr_b16 a[56:57], v8 offset:32768
v_mfma_f32_16x16x32_bf16 v[96:99], a[60:63], a[20:23], v[96:99]
ds_read_b64_tr_b16 a[58:59], v8 offset:33792
v_mfma_f32_16x16x32_bf16 v[112:115], a[60:63], a[24:27], v[112:115]
ds_read_b128 a[0:3], v2 offset:32768
v_mfma_f32_16x16x32_bf16 v[128:131], a[60:63], a[28:31], v[128:131]
s_add_u32 m0, s77, 67584
ds_read_b128 a[4:7], v2 offset:34816
v_mfma_f32_16x16x32_bf16 v[144:147], a[60:63], a[32:35], v[144:147]
s_add_u32 s64, s71, 2162688
ds_read_b64_tr_b16 a[60:61], v9 offset:32768
v_mfma_f32_16x16x32_bf16 v[36:39], a[64:67], a[20:23], v[36:39]
buffer_load_dwordx4 v15, s[56:59], s64 offen lds
v_mfma_f32_16x16x32_bf16 v[52:55], a[64:67], a[24:27], v[52:55]
ds_read_b64_tr_b16 a[62:63], v9 offset:33792
v_mfma_f32_16x16x32_bf16 v[68:71], a[64:67], a[28:31], v[68:71]
ds_read_b128 a[8:11], v2 offset:36864
v_mfma_f32_16x16x32_bf16 v[84:87], a[64:67], a[32:35], v[84:87]
ds_read_b128 a[12:15], v2 offset:38912
v_mfma_f32_16x16x32_bf16 v[100:103], a[68:71], a[20:23], v[100:103]
ds_read_b64_tr_b16 a[64:65], v10 offset:32768
v_mfma_f32_16x16x32_bf16 v[116:119], a[68:71], a[24:27], v[116:119]
s_add_u32 m0, s77, 68608
ds_read_b64_tr_b16 a[66:67], v10 offset:33792
v_mfma_f32_16x16x32_bf16 v[132:135], a[68:71], a[28:31], v[132:135]
s_add_u32 s64, s71, 2195456
ds_read_b128 a[16:19], v17 offset:32768
v_mfma_f32_16x16x32_bf16 v[148:151], a[68:71], a[32:35], v[148:151]
buffer_load_dwordx4 v15, s[56:59], s64 offen lds
v_mfma_f32_16x16x32_bf16 v[152:155], a[72:75], a[20:23], v[152:155]
ds_read_b64_tr_b16 a[68:69], v11 offset:32768
v_mfma_f32_16x16x32_bf16 v[160:163], a[72:75], a[24:27], v[160:163]
ds_read_b64_tr_b16 a[70:71], v11 offset:33792
v_mfma_f32_16x16x32_bf16 v[168:171], a[72:75], a[28:31], v[168:171]
v_mfma_f32_16x16x32_bf16 v[176:179], a[72:75], a[32:35], v[176:179]
ds_read_b64_tr_b16 a[72:73], v19 offset:32768
v_mfma_f32_16x16x32_bf16 v[156:159], a[76:79], a[20:23], v[156:159]
s_add_u32 m0, s78, 81920
ds_read_b64_tr_b16 a[74:75], v19 offset:33024
v_mfma_f32_16x16x32_bf16 v[164:167], a[76:79], a[24:27], v[164:167]
s_add_u32 s64, s75, 1572864
v_mfma_f32_16x16x32_bf16 v[172:175], a[76:79], a[28:31], v[172:175]
buffer_load_dwordx4 v23, s[60:63], s64 offen lds
v_mfma_f32_16x16x32_bf16 v[180:183], a[76:79], a[32:35], v[180:183]
ds_read_b64_tr_b16 a[76:77], v20 offset:32768
v_mfma_f32_16x16x32_bf16 v[184:187], a[80:83], a[20:23], v[184:187]
ds_read_b64_tr_b16 a[78:79], v20 offset:33024
v_mfma_f32_16x16x32_bf16 v[192:195], a[80:83], a[24:27], v[192:195]
v_mfma_f32_16x16x32_bf16 v[200:203], a[80:83], a[28:31], v[200:203]
v_mfma_f32_16x16x32_bf16 v[208:211], a[80:83], a[32:35], v[208:211]
s_add_u32 m0, s78, 86016
ds_read_b64_tr_b16 a[80:81], v19 offset:36864
v_mfma_f32_16x16x32_bf16 v[188:191], a[84:87], a[20:23], v[188:191]
s_add_u32 s64, s75, 1574912
ds_read_b64_tr_b16 a[82:83], v19 offset:37120
v_mfma_f32_16x16x32_bf16 v[196:199], a[84:87], a[24:27], v[196:199]
buffer_load_dwordx4 v23, s[60:63], s64 offen lds
v_mfma_f32_16x16x32_bf16 v[204:207], a[84:87], a[28:31], v[204:207]
v_mfma_f32_16x16x32_bf16 v[212:215], a[84:87], a[32:35], v[212:215]
ds_read_b64_tr_b16 a[84:85], v20 offset:36864
v_mfma_f32_16x16x32_bf16 v[216:219], a[20:23], a[88:91], v[216:219]
ds_read_b64_tr_b16 a[86:87], v20 offset:37120
v_mfma_f32_16x16x32_bf16 v[224:227], a[24:27], a[88:91], v[224:227]
v_mfma_f32_16x16x32_bf16 v[232:235], a[28:31], a[88:91], v[232:235]
s_add_u32 m0, s78, 90112
v_mfma_f32_16x16x32_bf16 v[240:243], a[32:35], a[88:91], v[240:243]
s_add_u32 s64, s75, 1576960
ds_read_b64_tr_b16 a[88:89], v19 offset:40960
v_mfma_f32_16x16x32_bf16 v[220:223], a[20:23], a[92:95], v[220:223]
buffer_load_dwordx4 v23, s[60:63], s64 offen lds
v_mfma_f32_16x16x32_bf16 v[228:231], a[24:27], a[92:95], v[228:231]
ds_read_b64_tr_b16 a[90:91], v19 offset:41216
v_mfma_f32_16x16x32_bf16 v[236:239], a[28:31], a[92:95], v[236:239]
v_mfma_f32_16x16x32_bf16 v[244:247], a[32:35], a[92:95], v[244:247]
ds_read_b64_tr_b16 a[92:93], v20 offset:40960
v_mfma_f32_16x16x32_bf16 v[248:251], a[96:99], a[36:39], v[248:251]
ds_read_b64_tr_b16 a[94:95], v20 offset:41216
v_mfma_f32_16x16x32_bf16 v[252:255], a[36:39], a[100:103], v[252:255]
s_waitcnt lgkmcnt(5)
s_add_u32 m0, s78, 94208
ds_read_b64_tr_b16 a[96:97], v21 offset:36864
v_mfma_f32_16x16x32_bf16 v[24:27], a[40:43], a[0:3], v[24:27]
s_add_u32 s64, s74, 512
ds_read_b128 a[20:23], v3 offset:32768
v_mfma_f32_16x16x32_bf16 v[40:43], a[40:43], a[4:7], v[40:43]
buffer_load_dwordx4 v22, s[48:51], s64 offen lds
v_mfma_f32_16x16x32_bf16 v[56:59], a[40:43], a[8:11], v[56:59]
ds_read_b128 a[24:27], v3 offset:34816
v_mfma_f32_16x16x32_bf16 v[72:75], a[40:43], a[12:15], v[72:75]
ds_read_b128 a[28:31], v3 offset:36864
v_mfma_f32_16x16x32_bf16 v[88:91], a[44:47], a[0:3], v[88:91]
s_add_u32 s65, s79, 6144
ds_read_b128 a[32:35], v3 offset:38912
v_mfma_f32_16x16x32_bf16 v[104:107], a[44:47], a[4:7], v[104:107]
buffer_store_dwordx4 a[152:155], v16, s[44:47], s65 offen sc1
v_mfma_f32_16x16x32_bf16 v[120:123], a[44:47], a[8:11], v[120:123]
ds_read_b64_tr_b16 a[40:41], v4 offset:40960
v_mfma_f32_16x16x32_bf16 v[136:139], a[44:47], a[12:15], v[136:139]
ds_read_b64_tr_b16 a[42:43], v4 offset:41984
v_mfma_f32_16x16x32_bf16 v[28:31], a[48:51], a[0:3], v[28:31]
ds_read_b64_tr_b16 a[44:45], v5 offset:40960
v_mfma_f32_16x16x32_bf16 v[44:47], a[48:51], a[4:7], v[44:47]
ds_read_b64_tr_b16 a[46:47], v5 offset:41984
v_mfma_f32_16x16x32_bf16 v[60:63], a[48:51], a[8:11], v[60:63]
ds_read_b64_tr_b16 a[98:99], v21 offset:37120
v_mfma_f32_16x16x32_bf16 v[76:79], a[48:51], a[12:15], v[76:79]
ds_read_b64_tr_b16 a[100:101], v21 offset:40960
v_mfma_f32_16x16x32_bf16 v[92:95], a[52:55], a[0:3], v[92:95]
ds_read_b64_tr_b16 a[102:103], v21 offset:41216
v_mfma_f32_16x16x32_bf16 v[108:111], a[52:55], a[4:7], v[108:111]
s_waitcnt lgkmcnt(7)
ds_read_b64_tr_b16 a[48:49], v6 offset:40960
v_mfma_f32_16x16x32_bf16 v[124:127], a[52:55], a[8:11], v[124:127]
s_add_u32 m0, s76, 32768
ds_read_b64_tr_b16 a[50:51], v6 offset:41984
v_mfma_f32_16x16x32_bf16 v[140:143], a[52:55], a[12:15], v[140:143]
s_add_u32 s64, s72, 640
ds_read_b64_tr_b16 a[52:53], v7 offset:40960
v_mfma_f32_16x16x32_bf16 v[32:35], a[56:59], a[0:3], v[32:35]
buffer_load_dwordx4 v12, s[48:51], s64 offen lds
v_mfma_f32_16x16x32_bf16 v[48:51], a[56:59], a[4:7], v[48:51]
ds_read_b64_tr_b16 a[54:55], v7 offset:41984
v_mfma_f32_16x16x32_bf16 v[64:67], a[56:59], a[8:11], v[64:67]
ds_read_b128 a[36:39], v18 offset:32768
v_mfma_f32_16x16x32_bf16 v[80:83], a[56:59], a[12:15], v[80:83]
s_add_u32 m0, s76, 33792
ds_read_b64_tr_b16 a[56:57], v8 offset:40960
v_mfma_f32_16x16x32_bf16 v[96:99], a[60:63], a[0:3], v[96:99]
s_add_u32 s64, s72, 17024
ds_read_b64_tr_b16 a[58:59], v8 offset:41984
v_mfma_f32_16x16x32_bf16 v[112:115], a[60:63], a[4:7], v[112:115]
buffer_load_dwordx4 v13, s[48:51], s64 offen lds
v_mfma_f32_16x16x32_bf16 v[128:131], a[60:63], a[8:11], v[128:131]
v_mfma_f32_16x16x32_bf16 v[144:147], a[60:63], a[12:15], v[144:147]
s_add_u32 s65, s79, 18432
ds_read_b64_tr_b16 a[60:61], v9 offset:40960
v_mfma_f32_16x16x32_bf16 v[36:39], a[64:67], a[0:3], v[36:39]
buffer_store_dwordx4 a[156:159], v16, s[44:47], s65 offen sc1
v_mfma_f32_16x16x32_bf16 v[52:55], a[64:67], a[4:7], v[52:55]
s_add_u32 m0, s76, 34816
ds_read_b64_tr_b16 a[62:63], v9 offset:41984
v_mfma_f32_16x16x32_bf16 v[68:71], a[64:67], a[8:11], v[68:71]
s_add_u32 s64, s72, 131712
v_mfma_f32_16x16x32_bf16 v[84:87], a[64:67], a[12:15], v[84:87]
buffer_load_dwordx4 v12, s[48:51], s64 offen lds
v_mfma_f32_16x16x32_bf16 v[100:103], a[68:71], a[0:3], v[100:103]
ds_read_b64_tr_b16 a[64:65], v10 offset:40960
v_mfma_f32_16x16x32_bf16 v[116:119], a[68:71], a[4:7], v[116:119]
ds_read_b64_tr_b16 a[66:67], v10 offset:41984
v_mfma_f32_16x16x32_bf16 v[132:135], a[68:71], a[8:11], v[132:135]
v_mfma_f32_16x16x32_bf16 v[148:151], a[68:71], a[12:15], v[148:151]
s_add_u32 m0, s76, 35840
ds_read_b64_tr_b16 a[68:69], v11 offset:40960
v_mfma_f32_16x16x32_bf16 v[152:155], a[72:75], a[0:3], v[152:155]
s_add_u32 s64, s72, 148096
ds_read_b64_tr_b16 a[70:71], v11 offset:41984
v_mfma_f32_16x16x32_bf16 v[160:163], a[72:75], a[4:7], v[160:163]
buffer_load_dwordx4 v13, s[48:51], s64 offen lds
v_mfma_f32_16x16x32_bf16 v[168:171], a[72:75], a[8:11], v[168:171]
v_mfma_f32_16x16x32_bf16 v[176:179], a[72:75], a[12:15], v[176:179]
ds_read_b64_tr_b16 a[72:73], v19 offset:34816
v_mfma_f32_16x16x32_bf16 v[156:159], a[76:79], a[0:3], v[156:159]
ds_read_b64_tr_b16 a[74:75], v19 offset:35072
v_mfma_f32_16x16x32_bf16 v[164:167], a[76:79], a[4:7], v[164:167]
s_add_u32 m0, s76, 36864
v_mfma_f32_16x16x32_bf16 v[172:175], a[76:79], a[8:11], v[172:175]
s_add_u32 s64, s73, 640
v_mfma_f32_16x16x32_bf16 v[180:183], a[76:79], a[12:15], v[180:183]
buffer_load_dwordx4 v12, s[48:51], s64 offen lds
v_mfma_f32_16x16x32_bf16 v[184:187], a[80:83], a[0:3], v[184:187]
ds_read_b64_tr_b16 a[76:77], v20 offset:34816
v_mfma_f32_16x16x32_bf16 v[192:195], a[80:83], a[4:7], v[192:195]
s_add_u32 s65, s79, 22528
ds_read_b64_tr_b16 a[78:79], v20 offset:35072
v_mfma_f32_16x16x32_bf16 v[200:203], a[80:83], a[8:11], v[200:203]
s_add_u32 m0, s76, 37888
v_mfma_f32_16x16x32_bf16 v[208:211], a[80:83], a[12:15], v[208:211]
s_add_u32 s64, s73, 17024
ds_read_b64_tr_b16 a[80:81], v19 offset:38912
v_mfma_f32_16x16x32_bf16 v[188:191], a[84:87], a[0:3], v[188:191]
buffer_store_dwordx4 a[160:163], v16, s[44:47], s65 offen sc1
v_mfma_f32_16x16x32_bf16 v[196:199], a[84:87], a[4:7], v[196:199]
buffer_load_dwordx4 v13, s[48:51], s64 offen lds
v_mfma_f32_16x16x32_bf16 v[204:207], a[84:87], a[8:11], v[204:207]
ds_read_b64_tr_b16 a[82:83], v19 offset:39168
v_mfma_f32_16x16x32_bf16 v[212:215], a[84:87], a[12:15], v[212:215]
ds_read_b64_tr_b16 a[84:85], v20 offset:38912
v_mfma_f32_16x16x32_bf16 v[216:219], a[0:3], a[88:91], v[216:219]
ds_read_b64_tr_b16 a[86:87], v20 offset:39168
v_mfma_f32_16x16x32_bf16 v[224:227], a[4:7], a[88:91], v[224:227]
s_add_u32 m0, s76, 38912
v_mfma_f32_16x16x32_bf16 v[232:235], a[8:11], a[88:91], v[232:235]
s_add_u32 s64, s73, 131712
v_mfma_f32_16x16x32_bf16 v[240:243], a[12:15], a[88:91], v[240:243]
buffer_load_dwordx4 v12, s[48:51], s64 offen lds
v_mfma_f32_16x16x32_bf16 v[220:223], a[0:3], a[92:95], v[220:223]
ds_read_b64_tr_b16 a[88:89], v19 offset:43008
v_mfma_f32_16x16x32_bf16 v[228:231], a[4:7], a[92:95], v[228:231]
ds_read_b64_tr_b16 a[90:91], v19 offset:43264
v_mfma_f32_16x16x32_bf16 v[236:239], a[8:11], a[92:95], v[236:239]
v_mfma_f32_16x16x32_bf16 v[244:247], a[12:15], a[92:95], v[244:247]
s_waitcnt lgkmcnt(5)
ds_read_b64_tr_b16 a[92:93], v20 offset:43008
v_mfma_f32_16x16x32_bf16 v[248:251], a[96:99], a[16:19], v[248:251]
ds_read_b64_tr_b16 a[94:95], v20 offset:43264
v_mfma_f32_16x16x32_bf16 v[252:255], a[16:19], a[100:103], v[252:255]
ds_read_b64_tr_b16 a[96:97], v21 offset:38912
v_mfma_f32_16x16x32_bf16 v[24:27], a[40:43], a[20:23], v[24:27]
ds_read_b64_tr_b16 a[98:99], v21 offset:39168
v_mfma_f32_16x16x32_bf16 v[40:43], a[40:43], a[24:27], v[40:43]
s_add_u32 m0, s76, 39936
ds_read_b64_tr_b16 a[100:101], v21 offset:43008
v_mfma_f32_16x16x32_bf16 v[56:59], a[40:43], a[28:31], v[56:59]
s_add_u32 s64, s73, 148096
ds_read_b64_tr_b16 a[102:103], v21 offset:43264
v_mfma_f32_16x16x32_bf16 v[72:75], a[40:43], a[32:35], v[72:75]
buffer_load_dwordx4 v13, s[48:51], s64 offen lds
v_mfma_f32_16x16x32_bf16 v[88:91], a[44:47], a[20:23], v[88:91]
v_mfma_f32_16x16x32_bf16 v[104:107], a[44:47], a[24:27], v[104:107]
v_mfma_f32_16x16x32_bf16 v[120:123], a[44:47], a[28:31], v[120:123]
v_mfma_f32_16x16x32_bf16 v[136:139], a[44:47], a[32:35], v[136:139]
v_mfma_f32_16x16x32_bf16 v[28:31], a[48:51], a[20:23], v[28:31]
s_waitcnt vmcnt(11) lgkmcnt(0)
s_barrier
v_mfma_f32_16x16x32_bf16 v[44:47], a[48:51], a[24:27], v[44:47]
s_add_u32 m0, s77, 98304
ds_read_b64_tr_b16 a[40:41], v4 offset:0
v_mfma_f32_16x16x32_bf16 v[60:63], a[48:51], a[28:31], v[60:63]
s_add_u32 s64, s71, 2621440
ds_read_b64_tr_b16 a[42:43], v4 offset:1024
v_mfma_f32_16x16x32_bf16 v[76:79], a[48:51], a[32:35], v[76:79]
buffer_load_dwordx4 v14, s[56:59], s64 offen lds
v_mfma_f32_16x16x32_bf16 v[92:95], a[52:55], a[20:23], v[92:95]
ds_read_b64_tr_b16 a[44:45], v5 offset:0
v_mfma_f32_16x16x32_bf16 v[108:111], a[52:55], a[24:27], v[108:111]
ds_read_b64_tr_b16 a[46:47], v5 offset:1024
v_mfma_f32_16x16x32_bf16 v[124:127], a[52:55], a[28:31], v[124:127]
ds_read_b64_tr_b16 a[48:49], v6 offset:0
v_mfma_f32_16x16x32_bf16 v[140:143], a[52:55], a[32:35], v[140:143]
s_add_u32 m0, s77, 99328
ds_read_b64_tr_b16 a[50:51], v6 offset:1024
v_mfma_f32_16x16x32_bf16 v[32:35], a[56:59], a[20:23], v[32:35]
s_add_u32 s64, s71, 2654208
ds_read_b64_tr_b16 a[52:53], v7 offset:0
v_mfma_f32_16x16x32_bf16 v[48:51], a[56:59], a[24:27], v[48:51]
buffer_load_dwordx4 v14, s[56:59], s64 offen lds
v_mfma_f32_16x16x32_bf16 v[64:67], a[56:59], a[28:31], v[64:67]
ds_read_b64_tr_b16 a[54:55], v7 offset:1024
v_mfma_f32_16x16x32_bf16 v[80:83], a[56:59], a[32:35], v[80:83]
ds_read_b64_tr_b16 a[56:57], v8 offset:0
v_mfma_f32_16x16x32_bf16 v[96:99], a[60:63], a[20:23], v[96:99]
ds_read_b64_tr_b16 a[58:59], v8 offset:1024
v_mfma_f32_16x16x32_bf16 v[112:115], a[60:63], a[24:27], v[112:115]
ds_read_b128 a[0:3], v2 offset:0
v_mfma_f32_16x16x32_bf16 v[128:131], a[60:63], a[28:31], v[128:131]
s_add_u32 m0, s77, 100352
ds_read_b128 a[4:7], v2 offset:2048
v_mfma_f32_16x16x32_bf16 v[144:147], a[60:63], a[32:35], v[144:147]
s_add_u32 s64, s71, 2686976
ds_read_b64_tr_b16 a[60:61], v9 offset:0
v_mfma_f32_16x16x32_bf16 v[36:39], a[64:67], a[20:23], v[36:39]
buffer_load_dwordx4 v15, s[56:59], s64 offen lds
v_mfma_f32_16x16x32_bf16 v[52:55], a[64:67], a[24:27], v[52:55]
ds_read_b64_tr_b16 a[62:63], v9 offset:1024
v_mfma_f32_16x16x32_bf16 v[68:71], a[64:67], a[28:31], v[68:71]
ds_read_b128 a[8:11], v2 offset:4096
v_mfma_f32_16x16x32_bf16 v[84:87], a[64:67], a[32:35], v[84:87]
ds_read_b128 a[12:15], v2 offset:6144
v_mfma_f32_16x16x32_bf16 v[100:103], a[68:71], a[20:23], v[100:103]
ds_read_b64_tr_b16 a[64:65], v10 offset:0
v_mfma_f32_16x16x32_bf16 v[116:119], a[68:71], a[24:27], v[116:119]
s_add_u32 m0, s77, 101376
ds_read_b64_tr_b16 a[66:67], v10 offset:1024
v_mfma_f32_16x16x32_bf16 v[132:135], a[68:71], a[28:31], v[132:135]
s_add_u32 s64, s71, 2719744
ds_read_b128 a[16:19], v17 offset:0
v_mfma_f32_16x16x32_bf16 v[148:151], a[68:71], a[32:35], v[148:151]
buffer_load_dwordx4 v15, s[56:59], s64 offen lds
v_mfma_f32_16x16x32_bf16 v[152:155], a[72:75], a[20:23], v[152:155]
ds_read_b64_tr_b16 a[68:69], v11 offset:0
v_mfma_f32_16x16x32_bf16 v[160:163], a[72:75], a[24:27], v[160:163]
ds_read_b64_tr_b16 a[70:71], v11 offset:1024
v_mfma_f32_16x16x32_bf16 v[168:171], a[72:75], a[28:31], v[168:171]
v_mfma_f32_16x16x32_bf16 v[176:179], a[72:75], a[32:35], v[176:179]
ds_read_b64_tr_b16 a[72:73], v19 offset:0
v_mfma_f32_16x16x32_bf16 v[156:159], a[76:79], a[20:23], v[156:159]
s_add_u32 m0, s78, 114688
ds_read_b64_tr_b16 a[74:75], v19 offset:256
v_mfma_f32_16x16x32_bf16 v[164:167], a[76:79], a[24:27], v[164:167]
s_add_u32 s64, s75, 1966080
v_mfma_f32_16x16x32_bf16 v[172:175], a[76:79], a[28:31], v[172:175]
buffer_load_dwordx4 v23, s[60:63], s64 offen lds
v_mfma_f32_16x16x32_bf16 v[180:183], a[76:79], a[32:35], v[180:183]
ds_read_b64_tr_b16 a[76:77], v20 offset:0
v_mfma_f32_16x16x32_bf16 v[184:187], a[80:83], a[20:23], v[184:187]
ds_read_b64_tr_b16 a[78:79], v20 offset:256
v_mfma_f32_16x16x32_bf16 v[192:195], a[80:83], a[24:27], v[192:195]
v_mfma_f32_16x16x32_bf16 v[200:203], a[80:83], a[28:31], v[200:203]
v_mfma_f32_16x16x32_bf16 v[208:211], a[80:83], a[32:35], v[208:211]
s_add_u32 m0, s78, 118784
ds_read_b64_tr_b16 a[80:81], v19 offset:4096
v_mfma_f32_16x16x32_bf16 v[188:191], a[84:87], a[20:23], v[188:191]
s_add_u32 s64, s75, 1968128
ds_read_b64_tr_b16 a[82:83], v19 offset:4352
v_mfma_f32_16x16x32_bf16 v[196:199], a[84:87], a[24:27], v[196:199]
buffer_load_dwordx4 v23, s[60:63], s64 offen lds
v_mfma_f32_16x16x32_bf16 v[204:207], a[84:87], a[28:31], v[204:207]
v_mfma_f32_16x16x32_bf16 v[212:215], a[84:87], a[32:35], v[212:215]
ds_read_b64_tr_b16 a[84:85], v20 offset:4096
v_mfma_f32_16x16x32_bf16 v[216:219], a[20:23], a[88:91], v[216:219]
ds_read_b64_tr_b16 a[86:87], v20 offset:4352
v_mfma_f32_16x16x32_bf16 v[224:227], a[24:27], a[88:91], v[224:227]
v_mfma_f32_16x16x32_bf16 v[232:235], a[28:31], a[88:91], v[232:235]
s_add_u32 m0, s78, 122880
v_mfma_f32_16x16x32_bf16 v[240:243], a[32:35], a[88:91], v[240:243]
s_add_u32 s64, s75, 1970176
ds_read_b64_tr_b16 a[88:89], v19 offset:8192
v_mfma_f32_16x16x32_bf16 v[220:223], a[20:23], a[92:95], v[220:223]
buffer_load_dwordx4 v23, s[60:63], s64 offen lds
v_mfma_f32_16x16x32_bf16 v[228:231], a[24:27], a[92:95], v[228:231]
ds_read_b64_tr_b16 a[90:91], v19 offset:8448
v_mfma_f32_16x16x32_bf16 v[236:239], a[28:31], a[92:95], v[236:239]
v_mfma_f32_16x16x32_bf16 v[244:247], a[32:35], a[92:95], v[244:247]
ds_read_b64_tr_b16 a[92:93], v20 offset:8192
v_mfma_f32_16x16x32_bf16 v[248:251], a[96:99], a[36:39], v[248:251]
ds_read_b64_tr_b16 a[94:95], v20 offset:8448
v_mfma_f32_16x16x32_bf16 v[252:255], a[36:39], a[100:103], v[252:255]
s_waitcnt lgkmcnt(5)
s_add_u32 m0, s78, 126976
ds_read_b64_tr_b16 a[96:97], v21 offset:4096
v_mfma_f32_16x16x32_bf16 v[24:27], a[40:43], a[0:3], v[24:27]
s_add_u32 s64, s74, 640
ds_read_b128 a[20:23], v3 offset:0
v_mfma_f32_16x16x32_bf16 v[40:43], a[40:43], a[4:7], v[40:43]
buffer_load_dwordx4 v22, s[48:51], s64 offen lds
v_mfma_f32_16x16x32_bf16 v[56:59], a[40:43], a[8:11], v[56:59]
ds_read_b128 a[24:27], v3 offset:2048
v_mfma_f32_16x16x32_bf16 v[72:75], a[40:43], a[12:15], v[72:75]
ds_read_b128 a[28:31], v3 offset:4096
v_mfma_f32_16x16x32_bf16 v[88:91], a[44:47], a[0:3], v[88:91]
s_add_u32 s65, s79, 7168
ds_read_b128 a[32:35], v3 offset:6144
v_mfma_f32_16x16x32_bf16 v[104:107], a[44:47], a[4:7], v[104:107]
buffer_store_dwordx4 a[164:167], v16, s[44:47], s65 offen sc1
v_mfma_f32_16x16x32_bf16 v[120:123], a[44:47], a[8:11], v[120:123]
ds_read_b64_tr_b16 a[40:41], v4 offset:8192
v_mfma_f32_16x16x32_bf16 v[136:139], a[44:47], a[12:15], v[136:139]
ds_read_b64_tr_b16 a[42:43], v4 offset:9216
v_mfma_f32_16x16x32_bf16 v[28:31], a[48:51], a[0:3], v[28:31]
ds_read_b64_tr_b16 a[44:45], v5 offset:8192
v_mfma_f32_16x16x32_bf16 v[44:47], a[48:51], a[4:7], v[44:47]
ds_read_b64_tr_b16 a[46:47], v5 offset:9216
v_mfma_f32_16x16x32_bf16 v[60:63], a[48:51], a[8:11], v[60:63]
ds_read_b64_tr_b16 a[98:99], v21 offset:4352
v_mfma_f32_16x16x32_bf16 v[76:79], a[48:51], a[12:15], v[76:79]
ds_read_b64_tr_b16 a[100:101], v21 offset:8192
v_mfma_f32_16x16x32_bf16 v[92:95], a[52:55], a[0:3], v[92:95]
ds_read_b64_tr_b16 a[102:103], v21 offset:8448
v_mfma_f32_16x16x32_bf16 v[108:111], a[52:55], a[4:7], v[108:111]
s_waitcnt lgkmcnt(7)
ds_read_b64_tr_b16 a[48:49], v6 offset:8192
v_mfma_f32_16x16x32_bf16 v[124:127], a[52:55], a[8:11], v[124:127]
s_add_u32 m0, s76, 0
ds_read_b64_tr_b16 a[50:51], v6 offset:9216
v_mfma_f32_16x16x32_bf16 v[140:143], a[52:55], a[12:15], v[140:143]
s_add_u32 s64, s72, 768
ds_read_b64_tr_b16 a[52:53], v7 offset:8192
v_mfma_f32_16x16x32_bf16 v[32:35], a[56:59], a[0:3], v[32:35]
buffer_load_dwordx4 v12, s[48:51], s64 offen lds
v_mfma_f32_16x16x32_bf16 v[48:51], a[56:59], a[4:7], v[48:51]
ds_read_b64_tr_b16 a[54:55], v7 offset:9216
v_mfma_f32_16x16x32_bf16 v[64:67], a[56:59], a[8:11], v[64:67]
ds_read_b128 a[36:39], v18 offset:0
v_mfma_f32_16x16x32_bf16 v[80:83], a[56:59], a[12:15], v[80:83]
s_add_u32 m0, s76, 1024
ds_read_b64_tr_b16 a[56:57], v8 offset:8192
v_mfma_f32_16x16x32_bf16 v[96:99], a[60:63], a[0:3], v[96:99]
s_add_u32 s64, s72, 17152
ds_read_b64_tr_b16 a[58:59], v8 offset:9216
v_mfma_f32_16x16x32_bf16 v[112:115], a[60:63], a[4:7], v[112:115]
buffer_load_dwordx4 v13, s[48:51], s64 offen lds
v_mfma_f32_16x16x32_bf16 v[128:131], a[60:63], a[8:11], v[128:131]
v_mfma_f32_16x16x32_bf16 v[144:147], a[60:63], a[12:15], v[144:147]
s_add_u32 s65, s79, 19456
ds_read_b64_tr_b16 a[60:61], v9 offset:8192
v_mfma_f32_16x16x32_bf16 v[36:39], a[64:67], a[0:3], v[36:39]
buffer_store_dwordx4 a[168:171], v16, s[44:47], s65 offen sc1
v_mfma_f32_16x16x32_bf16 v[52:55], a[64:67], a[4:7], v[52:55]
s_add_u32 m0, s76, 2048
ds_read_b64_tr_b16 a[62:63], v9 offset:9216
v_mfma_f32_16x16x32_bf16 v[68:71], a[64:67], a[8:11], v[68:71]
s_add_u32 s64, s72, 131840
v_mfma_f32_16x16x32_bf16 v[84:87], a[64:67], a[12:15], v[84:87]
buffer_load_dwordx4 v12, s[48:51], s64 offen lds
v_mfma_f32_16x16x32_bf16 v[100:103], a[68:71], a[0:3], v[100:103]
ds_read_b64_tr_b16 a[64:65], v10 offset:8192
v_mfma_f32_16x16x32_bf16 v[116:119], a[68:71], a[4:7], v[116:119]
ds_read_b64_tr_b16 a[66:67], v10 offset:9216
v_mfma_f32_16x16x32_bf16 v[132:135], a[68:71], a[8:11], v[132:135]
v_mfma_f32_16x16x32_bf16 v[148:151], a[68:71], a[12:15], v[148:151]
s_add_u32 m0, s76, 3072
ds_read_b64_tr_b16 a[68:69], v11 offset:8192
v_mfma_f32_16x16x32_bf16 v[152:155], a[72:75], a[0:3], v[152:155]
s_add_u32 s64, s72, 148224
ds_read_b64_tr_b16 a[70:71], v11 offset:9216
v_mfma_f32_16x16x32_bf16 v[160:163], a[72:75], a[4:7], v[160:163]
buffer_load_dwordx4 v13, s[48:51], s64 offen lds
v_mfma_f32_16x16x32_bf16 v[168:171], a[72:75], a[8:11], v[168:171]
v_mfma_f32_16x16x32_bf16 v[176:179], a[72:75], a[12:15], v[176:179]
ds_read_b64_tr_b16 a[72:73], v19 offset:2048
v_mfma_f32_16x16x32_bf16 v[156:159], a[76:79], a[0:3], v[156:159]
ds_read_b64_tr_b16 a[74:75], v19 offset:2304
v_mfma_f32_16x16x32_bf16 v[164:167], a[76:79], a[4:7], v[164:167]
s_add_u32 m0, s76, 4096
v_mfma_f32_16x16x32_bf16 v[172:175], a[76:79], a[8:11], v[172:175]
s_add_u32 s64, s73, 768
v_mfma_f32_16x16x32_bf16 v[180:183], a[76:79], a[12:15], v[180:183]
buffer_load_dwordx4 v12, s[48:51], s64 offen lds
v_mfma_f32_16x16x32_bf16 v[184:187], a[80:83], a[0:3], v[184:187]
ds_read_b64_tr_b16 a[76:77], v20 offset:2048
v_mfma_f32_16x16x32_bf16 v[192:195], a[80:83], a[4:7], v[192:195]
s_add_u32 s65, s79, 23552
ds_read_b64_tr_b16 a[78:79], v20 offset:2304
v_mfma_f32_16x16x32_bf16 v[200:203], a[80:83], a[8:11], v[200:203]
s_add_u32 m0, s76, 5120
v_mfma_f32_16x16x32_bf16 v[208:211], a[80:83], a[12:15], v[208:211]
s_add_u32 s64, s73, 17152
ds_read_b64_tr_b16 a[80:81], v19 offset:6144
v_mfma_f32_16x16x32_bf16 v[188:191], a[84:87], a[0:3], v[188:191]
buffer_store_dwordx4 a[172:175], v16, s[44:47], s65 offen sc1
v_mfma_f32_16x16x32_bf16 v[196:199], a[84:87], a[4:7], v[196:199]
buffer_load_dwordx4 v13, s[48:51], s64 offen lds
v_mfma_f32_16x16x32_bf16 v[204:207], a[84:87], a[8:11], v[204:207]
ds_read_b64_tr_b16 a[82:83], v19 offset:6400
v_mfma_f32_16x16x32_bf16 v[212:215], a[84:87], a[12:15], v[212:215]
ds_read_b64_tr_b16 a[84:85], v20 offset:6144
v_mfma_f32_16x16x32_bf16 v[216:219], a[0:3], a[88:91], v[216:219]
ds_read_b64_tr_b16 a[86:87], v20 offset:6400
v_mfma_f32_16x16x32_bf16 v[224:227], a[4:7], a[88:91], v[224:227]
s_add_u32 m0, s76, 6144
v_mfma_f32_16x16x32_bf16 v[232:235], a[8:11], a[88:91], v[232:235]
s_add_u32 s64, s73, 131840
v_mfma_f32_16x16x32_bf16 v[240:243], a[12:15], a[88:91], v[240:243]
buffer_load_dwordx4 v12, s[48:51], s64 offen lds
v_mfma_f32_16x16x32_bf16 v[220:223], a[0:3], a[92:95], v[220:223]
ds_read_b64_tr_b16 a[88:89], v19 offset:10240
v_mfma_f32_16x16x32_bf16 v[228:231], a[4:7], a[92:95], v[228:231]
ds_read_b64_tr_b16 a[90:91], v19 offset:10496
v_mfma_f32_16x16x32_bf16 v[236:239], a[8:11], a[92:95], v[236:239]
v_mfma_f32_16x16x32_bf16 v[244:247], a[12:15], a[92:95], v[244:247]
s_waitcnt lgkmcnt(5)
ds_read_b64_tr_b16 a[92:93], v20 offset:10240
v_mfma_f32_16x16x32_bf16 v[248:251], a[96:99], a[16:19], v[248:251]
ds_read_b64_tr_b16 a[94:95], v20 offset:10496
v_mfma_f32_16x16x32_bf16 v[252:255], a[16:19], a[100:103], v[252:255]
ds_read_b64_tr_b16 a[96:97], v21 offset:6144
v_mfma_f32_16x16x32_bf16 v[24:27], a[40:43], a[20:23], v[24:27]
ds_read_b64_tr_b16 a[98:99], v21 offset:6400
v_mfma_f32_16x16x32_bf16 v[40:43], a[40:43], a[24:27], v[40:43]
s_add_u32 m0, s76, 7168
ds_read_b64_tr_b16 a[100:101], v21 offset:10240
v_mfma_f32_16x16x32_bf16 v[56:59], a[40:43], a[28:31], v[56:59]
s_add_u32 s64, s73, 148224
ds_read_b64_tr_b16 a[102:103], v21 offset:10496
v_mfma_f32_16x16x32_bf16 v[72:75], a[40:43], a[32:35], v[72:75]
buffer_load_dwordx4 v13, s[48:51], s64 offen lds
v_mfma_f32_16x16x32_bf16 v[88:91], a[44:47], a[20:23], v[88:91]
v_mfma_f32_16x16x32_bf16 v[104:107], a[44:47], a[24:27], v[104:107]
v_mfma_f32_16x16x32_bf16 v[120:123], a[44:47], a[28:31], v[120:123]
v_mfma_f32_16x16x32_bf16 v[136:139], a[44:47], a[32:35], v[136:139]
v_mfma_f32_16x16x32_bf16 v[28:31], a[48:51], a[20:23], v[28:31]
s_waitcnt vmcnt(11) lgkmcnt(0)
s_barrier
v_mfma_f32_16x16x32_bf16 v[44:47], a[48:51], a[24:27], v[44:47]
s_add_u32 m0, s77, 65536
ds_read_b64_tr_b16 a[40:41], v4 offset:32768
v_mfma_f32_16x16x32_bf16 v[60:63], a[48:51], a[28:31], v[60:63]
s_add_u32 s64, s71, 3145728
ds_read_b64_tr_b16 a[42:43], v4 offset:33792
v_mfma_f32_16x16x32_bf16 v[76:79], a[48:51], a[32:35], v[76:79]
buffer_load_dwordx4 v14, s[56:59], s64 offen lds
v_mfma_f32_16x16x32_bf16 v[92:95], a[52:55], a[20:23], v[92:95]
ds_read_b64_tr_b16 a[44:45], v5 offset:32768
v_mfma_f32_16x16x32_bf16 v[108:111], a[52:55], a[24:27], v[108:111]
ds_read_b64_tr_b16 a[46:47], v5 offset:33792
v_mfma_f32_16x16x32_bf16 v[124:127], a[52:55], a[28:31], v[124:127]
ds_read_b64_tr_b16 a[48:49], v6 offset:32768
v_mfma_f32_16x16x32_bf16 v[140:143], a[52:55], a[32:35], v[140:143]
s_add_u32 m0, s77, 66560
ds_read_b64_tr_b16 a[50:51], v6 offset:33792
v_mfma_f32_16x16x32_bf16 v[32:35], a[56:59], a[20:23], v[32:35]
s_add_u32 s64, s71, 3178496
ds_read_b64_tr_b16 a[52:53], v7 offset:32768
v_mfma_f32_16x16x32_bf16 v[48:51], a[56:59], a[24:27], v[48:51]
buffer_load_dwordx4 v14, s[56:59], s64 offen lds
v_mfma_f32_16x16x32_bf16 v[64:67], a[56:59], a[28:31], v[64:67]
ds_read_b64_tr_b16 a[54:55], v7 offset:33792
v_mfma_f32_16x16x32_bf16 v[80:83], a[56:59], a[32:35], v[80:83]
ds_read_b64_tr_b16 a[56:57], v8 offset:32768
v_mfma_f32_16x16x32_bf16 v[96:99], a[60:63], a[20:23], v[96:99]
ds_read_b64_tr_b16 a[58:59], v8 offset:33792
v_mfma_f32_16x16x32_bf16 v[112:115], a[60:63], a[24:27], v[112:115]
ds_read_b128 a[0:3], v2 offset:32768
v_mfma_f32_16x16x32_bf16 v[128:131], a[60:63], a[28:31], v[128:131]
s_add_u32 m0, s77, 67584
ds_read_b128 a[4:7], v2 offset:34816
v_mfma_f32_16x16x32_bf16 v[144:147], a[60:63], a[32:35], v[144:147]
s_add_u32 s64, s71, 3211264
ds_read_b64_tr_b16 a[60:61], v9 offset:32768
v_mfma_f32_16x16x32_bf16 v[36:39], a[64:67], a[20:23], v[36:39]
buffer_load_dwordx4 v15, s[56:59], s64 offen lds
v_mfma_f32_16x16x32_bf16 v[52:55], a[64:67], a[24:27], v[52:55]
ds_read_b64_tr_b16 a[62:63], v9 offset:33792
v_mfma_f32_16x16x32_bf16 v[68:71], a[64:67], a[28:31], v[68:71]
ds_read_b128 a[8:11], v2 offset:36864
v_mfma_f32_16x16x32_bf16 v[84:87], a[64:67], a[32:35], v[84:87]
ds_read_b128 a[12:15], v2 offset:38912
v_mfma_f32_16x16x32_bf16 v[100:103], a[68:71], a[20:23], v[100:103]
ds_read_b64_tr_b16 a[64:65], v10 offset:32768
v_mfma_f32_16x16x32_bf16 v[116:119], a[68:71], a[24:27], v[116:119]
s_add_u32 m0, s77, 68608
ds_read_b64_tr_b16 a[66:67], v10 offset:33792
v_mfma_f32_16x16x32_bf16 v[132:135], a[68:71], a[28:31], v[132:135]
s_add_u32 s64, s71, 3244032
ds_read_b128 a[16:19], v17 offset:32768
v_mfma_f32_16x16x32_bf16 v[148:151], a[68:71], a[32:35], v[148:151]
buffer_load_dwordx4 v15, s[56:59], s64 offen lds
v_mfma_f32_16x16x32_bf16 v[152:155], a[72:75], a[20:23], v[152:155]
ds_read_b64_tr_b16 a[68:69], v11 offset:32768
v_mfma_f32_16x16x32_bf16 v[160:163], a[72:75], a[24:27], v[160:163]
ds_read_b64_tr_b16 a[70:71], v11 offset:33792
v_mfma_f32_16x16x32_bf16 v[168:171], a[72:75], a[28:31], v[168:171]
v_mfma_f32_16x16x32_bf16 v[176:179], a[72:75], a[32:35], v[176:179]
ds_read_b64_tr_b16 a[72:73], v19 offset:32768
v_mfma_f32_16x16x32_bf16 v[156:159], a[76:79], a[20:23], v[156:159]
s_add_u32 m0, s78, 81920
ds_read_b64_tr_b16 a[74:75], v19 offset:33024
v_mfma_f32_16x16x32_bf16 v[164:167], a[76:79], a[24:27], v[164:167]
s_add_u32 s64, s75, 2359296
v_mfma_f32_16x16x32_bf16 v[172:175], a[76:79], a[28:31], v[172:175]
buffer_load_dwordx4 v23, s[60:63], s64 offen lds
v_mfma_f32_16x16x32_bf16 v[180:183], a[76:79], a[32:35], v[180:183]
ds_read_b64_tr_b16 a[76:77], v20 offset:32768
v_mfma_f32_16x16x32_bf16 v[184:187], a[80:83], a[20:23], v[184:187]
ds_read_b64_tr_b16 a[78:79], v20 offset:33024
v_mfma_f32_16x16x32_bf16 v[192:195], a[80:83], a[24:27], v[192:195]
v_mfma_f32_16x16x32_bf16 v[200:203], a[80:83], a[28:31], v[200:203]
v_mfma_f32_16x16x32_bf16 v[208:211], a[80:83], a[32:35], v[208:211]
s_add_u32 m0, s78, 86016
ds_read_b64_tr_b16 a[80:81], v19 offset:36864
v_mfma_f32_16x16x32_bf16 v[188:191], a[84:87], a[20:23], v[188:191]
s_add_u32 s64, s75, 2361344
ds_read_b64_tr_b16 a[82:83], v19 offset:37120
v_mfma_f32_16x16x32_bf16 v[196:199], a[84:87], a[24:27], v[196:199]
buffer_load_dwordx4 v23, s[60:63], s64 offen lds
v_mfma_f32_16x16x32_bf16 v[204:207], a[84:87], a[28:31], v[204:207]
v_mfma_f32_16x16x32_bf16 v[212:215], a[84:87], a[32:35], v[212:215]
ds_read_b64_tr_b16 a[84:85], v20 offset:36864
v_mfma_f32_16x16x32_bf16 v[216:219], a[20:23], a[88:91], v[216:219]
ds_read_b64_tr_b16 a[86:87], v20 offset:37120
v_mfma_f32_16x16x32_bf16 v[224:227], a[24:27], a[88:91], v[224:227]
v_mfma_f32_16x16x32_bf16 v[232:235], a[28:31], a[88:91], v[232:235]
s_add_u32 m0, s78, 90112
v_mfma_f32_16x16x32_bf16 v[240:243], a[32:35], a[88:91], v[240:243]
s_add_u32 s64, s75, 2363392
ds_read_b64_tr_b16 a[88:89], v19 offset:40960
v_mfma_f32_16x16x32_bf16 v[220:223], a[20:23], a[92:95], v[220:223]
buffer_load_dwordx4 v23, s[60:63], s64 offen lds
v_mfma_f32_16x16x32_bf16 v[228:231], a[24:27], a[92:95], v[228:231]
ds_read_b64_tr_b16 a[90:91], v19 offset:41216
v_mfma_f32_16x16x32_bf16 v[236:239], a[28:31], a[92:95], v[236:239]
v_mfma_f32_16x16x32_bf16 v[244:247], a[32:35], a[92:95], v[244:247]
ds_read_b64_tr_b16 a[92:93], v20 offset:40960
v_mfma_f32_16x16x32_bf16 v[248:251], a[96:99], a[36:39], v[248:251]
ds_read_b64_tr_b16 a[94:95], v20 offset:41216
v_mfma_f32_16x16x32_bf16 v[252:255], a[36:39], a[100:103], v[252:255]
s_waitcnt lgkmcnt(5)
s_add_u32 m0, s78, 94208
ds_read_b64_tr_b16 a[96:97], v21 offset:36864
v_mfma_f32_16x16x32_bf16 v[24:27], a[40:43], a[0:3], v[24:27]
s_add_u32 s64, s74, 768
ds_read_b128 a[20:23], v3 offset:32768
v_mfma_f32_16x16x32_bf16 v[40:43], a[40:43], a[4:7], v[40:43]
buffer_load_dwordx4 v22, s[48:51], s64 offen lds
v_mfma_f32_16x16x32_bf16 v[56:59], a[40:43], a[8:11], v[56:59]
ds_read_b128 a[24:27], v3 offset:34816
v_mfma_f32_16x16x32_bf16 v[72:75], a[40:43], a[12:15], v[72:75]
ds_read_b128 a[28:31], v3 offset:36864
v_mfma_f32_16x16x32_bf16 v[88:91], a[44:47], a[0:3], v[88:91]
s_add_u32 s65, s79, 24576
ds_read_b128 a[32:35], v3 offset:38912
v_mfma_f32_16x16x32_bf16 v[104:107], a[44:47], a[4:7], v[104:107]
buffer_store_dwordx4 a[176:179], v16, s[44:47], s65 offen sc1
v_mfma_f32_16x16x32_bf16 v[120:123], a[44:47], a[8:11], v[120:123]
ds_read_b64_tr_b16 a[40:41], v4 offset:40960
v_mfma_f32_16x16x32_bf16 v[136:139], a[44:47], a[12:15], v[136:139]
ds_read_b64_tr_b16 a[42:43], v4 offset:41984
v_mfma_f32_16x16x32_bf16 v[28:31], a[48:51], a[0:3], v[28:31]
ds_read_b64_tr_b16 a[44:45], v5 offset:40960
v_mfma_f32_16x16x32_bf16 v[44:47], a[48:51], a[4:7], v[44:47]
ds_read_b64_tr_b16 a[46:47], v5 offset:41984
v_mfma_f32_16x16x32_bf16 v[60:63], a[48:51], a[8:11], v[60:63]
ds_read_b64_tr_b16 a[98:99], v21 offset:37120
v_mfma_f32_16x16x32_bf16 v[76:79], a[48:51], a[12:15], v[76:79]
ds_read_b64_tr_b16 a[100:101], v21 offset:40960
v_mfma_f32_16x16x32_bf16 v[92:95], a[52:55], a[0:3], v[92:95]
ds_read_b64_tr_b16 a[102:103], v21 offset:41216
v_mfma_f32_16x16x32_bf16 v[108:111], a[52:55], a[4:7], v[108:111]
s_waitcnt lgkmcnt(7)
ds_read_b64_tr_b16 a[48:49], v6 offset:40960
v_mfma_f32_16x16x32_bf16 v[124:127], a[52:55], a[8:11], v[124:127]
s_add_u32 m0, s76, 32768
ds_read_b64_tr_b16 a[50:51], v6 offset:41984
v_mfma_f32_16x16x32_bf16 v[140:143], a[52:55], a[12:15], v[140:143]
s_add_u32 s64, s72, 896
ds_read_b64_tr_b16 a[52:53], v7 offset:40960
v_mfma_f32_16x16x32_bf16 v[32:35], a[56:59], a[0:3], v[32:35]
buffer_load_dwordx4 v12, s[48:51], s64 offen lds
v_mfma_f32_16x16x32_bf16 v[48:51], a[56:59], a[4:7], v[48:51]
ds_read_b64_tr_b16 a[54:55], v7 offset:41984
v_mfma_f32_16x16x32_bf16 v[64:67], a[56:59], a[8:11], v[64:67]
ds_read_b128 a[36:39], v18 offset:32768
v_mfma_f32_16x16x32_bf16 v[80:83], a[56:59], a[12:15], v[80:83]
s_add_u32 m0, s76, 33792
ds_read_b64_tr_b16 a[56:57], v8 offset:40960
v_mfma_f32_16x16x32_bf16 v[96:99], a[60:63], a[0:3], v[96:99]
s_add_u32 s64, s72, 17280
ds_read_b64_tr_b16 a[58:59], v8 offset:41984
v_mfma_f32_16x16x32_bf16 v[112:115], a[60:63], a[4:7], v[112:115]
buffer_load_dwordx4 v13, s[48:51], s64 offen lds
v_mfma_f32_16x16x32_bf16 v[128:131], a[60:63], a[8:11], v[128:131]
v_mfma_f32_16x16x32_bf16 v[144:147], a[60:63], a[12:15], v[144:147]
s_add_u32 s65, s79, 9216
ds_read_b64_tr_b16 a[60:61], v9 offset:40960
v_mfma_f32_16x16x32_bf16 v[36:39], a[64:67], a[0:3], v[36:39]
buffer_store_dwordx4 a[180:183], v16, s[44:47], s65 offen sc1
v_mfma_f32_16x16x32_bf16 v[52:55], a[64:67], a[4:7], v[52:55]
s_add_u32 m0, s76, 34816
ds_read_b64_tr_b16 a[62:63], v9 offset:41984
v_mfma_f32_16x16x32_bf16 v[68:71], a[64:67], a[8:11], v[68:71]
s_add_u32 s64, s72, 131968
v_mfma_f32_16x16x32_bf16 v[84:87], a[64:67], a[12:15], v[84:87]
buffer_load_dwordx4 v12, s[48:51], s64 offen lds
v_mfma_f32_16x16x32_bf16 v[100:103], a[68:71], a[0:3], v[100:103]
ds_read_b64_tr_b16 a[64:65], v10 offset:40960
v_mfma_f32_16x16x32_bf16 v[116:119], a[68:71], a[4:7], v[116:119]
ds_read_b64_tr_b16 a[66:67], v10 offset:41984
v_mfma_f32_16x16x32_bf16 v[132:135], a[68:71], a[8:11], v[132:135]
v_mfma_f32_16x16x32_bf16 v[148:151], a[68:71], a[12:15], v[148:151]
s_add_u32 m0, s76, 35840
ds_read_b64_tr_b16 a[68:69], v11 offset:40960
v_mfma_f32_16x16x32_bf16 v[152:155], a[72:75], a[0:3], v[152:155]
s_add_u32 s64, s72, 148352
ds_read_b64_tr_b16 a[70:71], v11 offset:41984
v_mfma_f32_16x16x32_bf16 v[160:163], a[72:75], a[4:7], v[160:163]
buffer_load_dwordx4 v13, s[48:51], s64 offen lds
v_mfma_f32_16x16x32_bf16 v[168:171], a[72:75], a[8:11], v[168:171]
v_mfma_f32_16x16x32_bf16 v[176:179], a[72:75], a[12:15], v[176:179]
ds_read_b64_tr_b16 a[72:73], v19 offset:34816
v_mfma_f32_16x16x32_bf16 v[156:159], a[76:79], a[0:3], v[156:159]
ds_read_b64_tr_b16 a[74:75], v19 offset:35072
v_mfma_f32_16x16x32_bf16 v[164:167], a[76:79], a[4:7], v[164:167]
s_add_u32 m0, s76, 36864
v_mfma_f32_16x16x32_bf16 v[172:175], a[76:79], a[8:11], v[172:175]
s_add_u32 s64, s73, 896
v_mfma_f32_16x16x32_bf16 v[180:183], a[76:79], a[12:15], v[180:183]
buffer_load_dwordx4 v12, s[48:51], s64 offen lds
v_mfma_f32_16x16x32_bf16 v[184:187], a[80:83], a[0:3], v[184:187]
ds_read_b64_tr_b16 a[76:77], v20 offset:34816
v_mfma_f32_16x16x32_bf16 v[192:195], a[80:83], a[4:7], v[192:195]
s_add_u32 s65, s79, 25600
ds_read_b64_tr_b16 a[78:79], v20 offset:35072
v_mfma_f32_16x16x32_bf16 v[200:203], a[80:83], a[8:11], v[200:203]
s_add_u32 m0, s76, 37888
v_mfma_f32_16x16x32_bf16 v[208:211], a[80:83], a[12:15], v[208:211]
s_add_u32 s64, s73, 17280
ds_read_b64_tr_b16 a[80:81], v19 offset:38912
v_mfma_f32_16x16x32_bf16 v[188:191], a[84:87], a[0:3], v[188:191]
buffer_store_dwordx4 a[184:187], v16, s[44:47], s65 offen sc1
v_mfma_f32_16x16x32_bf16 v[196:199], a[84:87], a[4:7], v[196:199]
buffer_load_dwordx4 v13, s[48:51], s64 offen lds
v_mfma_f32_16x16x32_bf16 v[204:207], a[84:87], a[8:11], v[204:207]
ds_read_b64_tr_b16 a[82:83], v19 offset:39168
v_mfma_f32_16x16x32_bf16 v[212:215], a[84:87], a[12:15], v[212:215]
ds_read_b64_tr_b16 a[84:85], v20 offset:38912
v_mfma_f32_16x16x32_bf16 v[216:219], a[0:3], a[88:91], v[216:219]
ds_read_b64_tr_b16 a[86:87], v20 offset:39168
v_mfma_f32_16x16x32_bf16 v[224:227], a[4:7], a[88:91], v[224:227]
s_add_u32 m0, s76, 38912
v_mfma_f32_16x16x32_bf16 v[232:235], a[8:11], a[88:91], v[232:235]
s_add_u32 s64, s73, 131968
v_mfma_f32_16x16x32_bf16 v[240:243], a[12:15], a[88:91], v[240:243]
buffer_load_dwordx4 v12, s[48:51], s64 offen lds
v_mfma_f32_16x16x32_bf16 v[220:223], a[0:3], a[92:95], v[220:223]
ds_read_b64_tr_b16 a[88:89], v19 offset:43008
v_mfma_f32_16x16x32_bf16 v[228:231], a[4:7], a[92:95], v[228:231]
ds_read_b64_tr_b16 a[90:91], v19 offset:43264
v_mfma_f32_16x16x32_bf16 v[236:239], a[8:11], a[92:95], v[236:239]
v_mfma_f32_16x16x32_bf16 v[244:247], a[12:15], a[92:95], v[244:247]
s_waitcnt lgkmcnt(5)
ds_read_b64_tr_b16 a[92:93], v20 offset:43008
v_mfma_f32_16x16x32_bf16 v[248:251], a[96:99], a[16:19], v[248:251]
ds_read_b64_tr_b16 a[94:95], v20 offset:43264
v_mfma_f32_16x16x32_bf16 v[252:255], a[16:19], a[100:103], v[252:255]
ds_read_b64_tr_b16 a[96:97], v21 offset:38912
v_mfma_f32_16x16x32_bf16 v[24:27], a[40:43], a[20:23], v[24:27]
ds_read_b64_tr_b16 a[98:99], v21 offset:39168
v_mfma_f32_16x16x32_bf16 v[40:43], a[40:43], a[24:27], v[40:43]
s_add_u32 m0, s76, 39936
ds_read_b64_tr_b16 a[100:101], v21 offset:43008
v_mfma_f32_16x16x32_bf16 v[56:59], a[40:43], a[28:31], v[56:59]
s_add_u32 s64, s73, 148352
ds_read_b64_tr_b16 a[102:103], v21 offset:43264
v_mfma_f32_16x16x32_bf16 v[72:75], a[40:43], a[32:35], v[72:75]
buffer_load_dwordx4 v13, s[48:51], s64 offen lds
v_mfma_f32_16x16x32_bf16 v[88:91], a[44:47], a[20:23], v[88:91]
v_mfma_f32_16x16x32_bf16 v[104:107], a[44:47], a[24:27], v[104:107]
v_mfma_f32_16x16x32_bf16 v[120:123], a[44:47], a[28:31], v[120:123]
v_mfma_f32_16x16x32_bf16 v[136:139], a[44:47], a[32:35], v[136:139]
v_mfma_f32_16x16x32_bf16 v[28:31], a[48:51], a[20:23], v[28:31]
s_waitcnt vmcnt(11) lgkmcnt(0)
s_barrier
v_mfma_f32_16x16x32_bf16 v[44:47], a[48:51], a[24:27], v[44:47]
s_add_u32 m0, s77, 98304
ds_read_b64_tr_b16 a[40:41], v4 offset:0
v_mfma_f32_16x16x32_bf16 v[60:63], a[48:51], a[28:31], v[60:63]
s_add_u32 s64, s71, 3670016
ds_read_b64_tr_b16 a[42:43], v4 offset:1024
v_mfma_f32_16x16x32_bf16 v[76:79], a[48:51], a[32:35], v[76:79]
buffer_load_dwordx4 v14, s[56:59], s64 offen lds
v_mfma_f32_16x16x32_bf16 v[92:95], a[52:55], a[20:23], v[92:95]
ds_read_b64_tr_b16 a[44:45], v5 offset:0
v_mfma_f32_16x16x32_bf16 v[108:111], a[52:55], a[24:27], v[108:111]
ds_read_b64_tr_b16 a[46:47], v5 offset:1024
v_mfma_f32_16x16x32_bf16 v[124:127], a[52:55], a[28:31], v[124:127]
ds_read_b64_tr_b16 a[48:49], v6 offset:0
v_mfma_f32_16x16x32_bf16 v[140:143], a[52:55], a[32:35], v[140:143]
s_add_u32 m0, s77, 99328
ds_read_b64_tr_b16 a[50:51], v6 offset:1024
v_mfma_f32_16x16x32_bf16 v[32:35], a[56:59], a[20:23], v[32:35]
s_add_u32 s64, s71, 3702784
ds_read_b64_tr_b16 a[52:53], v7 offset:0
v_mfma_f32_16x16x32_bf16 v[48:51], a[56:59], a[24:27], v[48:51]
buffer_load_dwordx4 v14, s[56:59], s64 offen lds
v_mfma_f32_16x16x32_bf16 v[64:67], a[56:59], a[28:31], v[64:67]
ds_read_b64_tr_b16 a[54:55], v7 offset:1024
v_mfma_f32_16x16x32_bf16 v[80:83], a[56:59], a[32:35], v[80:83]
ds_read_b64_tr_b16 a[56:57], v8 offset:0
v_mfma_f32_16x16x32_bf16 v[96:99], a[60:63], a[20:23], v[96:99]
ds_read_b64_tr_b16 a[58:59], v8 offset:1024
v_mfma_f32_16x16x32_bf16 v[112:115], a[60:63], a[24:27], v[112:115]
ds_read_b128 a[0:3], v2 offset:0
v_mfma_f32_16x16x32_bf16 v[128:131], a[60:63], a[28:31], v[128:131]
s_add_u32 m0, s77, 100352
ds_read_b128 a[4:7], v2 offset:2048
v_mfma_f32_16x16x32_bf16 v[144:147], a[60:63], a[32:35], v[144:147]
s_add_u32 s64, s71, 3735552
ds_read_b64_tr_b16 a[60:61], v9 offset:0
v_mfma_f32_16x16x32_bf16 v[36:39], a[64:67], a[20:23], v[36:39]
buffer_load_dwordx4 v15, s[56:59], s64 offen lds
v_mfma_f32_16x16x32_bf16 v[52:55], a[64:67], a[24:27], v[52:55]
ds_read_b64_tr_b16 a[62:63], v9 offset:1024
v_mfma_f32_16x16x32_bf16 v[68:71], a[64:67], a[28:31], v[68:71]
ds_read_b128 a[8:11], v2 offset:4096
v_mfma_f32_16x16x32_bf16 v[84:87], a[64:67], a[32:35], v[84:87]
ds_read_b128 a[12:15], v2 offset:6144
v_mfma_f32_16x16x32_bf16 v[100:103], a[68:71], a[20:23], v[100:103]
ds_read_b64_tr_b16 a[64:65], v10 offset:0
v_mfma_f32_16x16x32_bf16 v[116:119], a[68:71], a[24:27], v[116:119]
s_add_u32 m0, s77, 101376
ds_read_b64_tr_b16 a[66:67], v10 offset:1024
v_mfma_f32_16x16x32_bf16 v[132:135], a[68:71], a[28:31], v[132:135]
s_add_u32 s64, s71, 3768320
ds_read_b128 a[16:19], v17 offset:0
v_mfma_f32_16x16x32_bf16 v[148:151], a[68:71], a[32:35], v[148:151]
buffer_load_dwordx4 v15, s[56:59], s64 offen lds
v_mfma_f32_16x16x32_bf16 v[152:155], a[72:75], a[20:23], v[152:155]
ds_read_b64_tr_b16 a[68:69], v11 offset:0
v_mfma_f32_16x16x32_bf16 v[160:163], a[72:75], a[24:27], v[160:163]
ds_read_b64_tr_b16 a[70:71], v11 offset:1024
v_mfma_f32_16x16x32_bf16 v[168:171], a[72:75], a[28:31], v[168:171]
v_mfma_f32_16x16x32_bf16 v[176:179], a[72:75], a[32:35], v[176:179]
ds_read_b64_tr_b16 a[72:73], v19 offset:0
v_mfma_f32_16x16x32_bf16 v[156:159], a[76:79], a[20:23], v[156:159]
s_add_u32 m0, s78, 114688
ds_read_b64_tr_b16 a[74:75], v19 offset:256
v_mfma_f32_16x16x32_bf16 v[164:167], a[76:79], a[24:27], v[164:167]
s_add_u32 s64, s75, 2752512
v_mfma_f32_16x16x32_bf16 v[172:175], a[76:79], a[28:31], v[172:175]
buffer_load_dwordx4 v23, s[60:63], s64 offen lds
v_mfma_f32_16x16x32_bf16 v[180:183], a[76:79], a[32:35], v[180:183]
ds_read_b64_tr_b16 a[76:77], v20 offset:0
v_mfma_f32_16x16x32_bf16 v[184:187], a[80:83], a[20:23], v[184:187]
ds_read_b64_tr_b16 a[78:79], v20 offset:256
v_mfma_f32_16x16x32_bf16 v[192:195], a[80:83], a[24:27], v[192:195]
v_mfma_f32_16x16x32_bf16 v[200:203], a[80:83], a[28:31], v[200:203]
v_mfma_f32_16x16x32_bf16 v[208:211], a[80:83], a[32:35], v[208:211]
s_add_u32 m0, s78, 118784
ds_read_b64_tr_b16 a[80:81], v19 offset:4096
v_mfma_f32_16x16x32_bf16 v[188:191], a[84:87], a[20:23], v[188:191]
s_add_u32 s64, s75, 2754560
ds_read_b64_tr_b16 a[82:83], v19 offset:4352
v_mfma_f32_16x16x32_bf16 v[196:199], a[84:87], a[24:27], v[196:199]
buffer_load_dwordx4 v23, s[60:63], s64 offen lds
v_mfma_f32_16x16x32_bf16 v[204:207], a[84:87], a[28:31], v[204:207]
v_mfma_f32_16x16x32_bf16 v[212:215], a[84:87], a[32:35], v[212:215]
ds_read_b64_tr_b16 a[84:85], v20 offset:4096
v_mfma_f32_16x16x32_bf16 v[216:219], a[20:23], a[88:91], v[216:219]
ds_read_b64_tr_b16 a[86:87], v20 offset:4352
v_mfma_f32_16x16x32_bf16 v[224:227], a[24:27], a[88:91], v[224:227]
v_mfma_f32_16x16x32_bf16 v[232:235], a[28:31], a[88:91], v[232:235]
s_add_u32 m0, s78, 122880
v_mfma_f32_16x16x32_bf16 v[240:243], a[32:35], a[88:91], v[240:243]
s_add_u32 s64, s75, 2756608
ds_read_b64_tr_b16 a[88:89], v19 offset:8192
v_mfma_f32_16x16x32_bf16 v[220:223], a[20:23], a[92:95], v[220:223]
buffer_load_dwordx4 v23, s[60:63], s64 offen lds
v_mfma_f32_16x16x32_bf16 v[228:231], a[24:27], a[92:95], v[228:231]
ds_read_b64_tr_b16 a[90:91], v19 offset:8448
v_mfma_f32_16x16x32_bf16 v[236:239], a[28:31], a[92:95], v[236:239]
v_mfma_f32_16x16x32_bf16 v[244:247], a[32:35], a[92:95], v[244:247]
ds_read_b64_tr_b16 a[92:93], v20 offset:8192
v_mfma_f32_16x16x32_bf16 v[248:251], a[96:99], a[36:39], v[248:251]
ds_read_b64_tr_b16 a[94:95], v20 offset:8448
v_mfma_f32_16x16x32_bf16 v[252:255], a[36:39], a[100:103], v[252:255]
s_waitcnt lgkmcnt(5)
s_add_u32 m0, s78, 126976
ds_read_b64_tr_b16 a[96:97], v21 offset:4096
v_mfma_f32_16x16x32_bf16 v[24:27], a[40:43], a[0:3], v[24:27]
s_add_u32 s64, s74, 896
ds_read_b128 a[20:23], v3 offset:0
v_mfma_f32_16x16x32_bf16 v[40:43], a[40:43], a[4:7], v[40:43]
buffer_load_dwordx4 v22, s[48:51], s64 offen lds
v_mfma_f32_16x16x32_bf16 v[56:59], a[40:43], a[8:11], v[56:59]
ds_read_b128 a[24:27], v3 offset:2048
v_mfma_f32_16x16x32_bf16 v[72:75], a[40:43], a[12:15], v[72:75]
ds_read_b128 a[28:31], v3 offset:4096
v_mfma_f32_16x16x32_bf16 v[88:91], a[44:47], a[0:3], v[88:91]
s_add_u32 s65, s79, 26624
ds_read_b128 a[32:35], v3 offset:6144
v_mfma_f32_16x16x32_bf16 v[104:107], a[44:47], a[4:7], v[104:107]
buffer_store_dwordx4 a[188:191], v16, s[44:47], s65 offen sc1
v_mfma_f32_16x16x32_bf16 v[120:123], a[44:47], a[8:11], v[120:123]
ds_read_b64_tr_b16 a[40:41], v4 offset:8192
v_mfma_f32_16x16x32_bf16 v[136:139], a[44:47], a[12:15], v[136:139]
ds_read_b64_tr_b16 a[42:43], v4 offset:9216
v_mfma_f32_16x16x32_bf16 v[28:31], a[48:51], a[0:3], v[28:31]
ds_read_b64_tr_b16 a[44:45], v5 offset:8192
v_mfma_f32_16x16x32_bf16 v[44:47], a[48:51], a[4:7], v[44:47]
ds_read_b64_tr_b16 a[46:47], v5 offset:9216
v_mfma_f32_16x16x32_bf16 v[60:63], a[48:51], a[8:11], v[60:63]
ds_read_b64_tr_b16 a[98:99], v21 offset:4352
v_mfma_f32_16x16x32_bf16 v[76:79], a[48:51], a[12:15], v[76:79]
ds_read_b64_tr_b16 a[100:101], v21 offset:8192
v_mfma_f32_16x16x32_bf16 v[92:95], a[52:55], a[0:3], v[92:95]
ds_read_b64_tr_b16 a[102:103], v21 offset:8448
v_mfma_f32_16x16x32_bf16 v[108:111], a[52:55], a[4:7], v[108:111]
s_waitcnt lgkmcnt(7)
ds_read_b64_tr_b16 a[48:49], v6 offset:8192
v_mfma_f32_16x16x32_bf16 v[124:127], a[52:55], a[8:11], v[124:127]
s_add_u32 m0, s76, 0
ds_read_b64_tr_b16 a[50:51], v6 offset:9216
v_mfma_f32_16x16x32_bf16 v[140:143], a[52:55], a[12:15], v[140:143]
s_add_u32 s64, s72, 1024
ds_read_b64_tr_b16 a[52:53], v7 offset:8192
v_mfma_f32_16x16x32_bf16 v[32:35], a[56:59], a[0:3], v[32:35]
buffer_load_dwordx4 v12, s[48:51], s64 offen lds
v_mfma_f32_16x16x32_bf16 v[48:51], a[56:59], a[4:7], v[48:51]
ds_read_b64_tr_b16 a[54:55], v7 offset:9216
v_mfma_f32_16x16x32_bf16 v[64:67], a[56:59], a[8:11], v[64:67]
ds_read_b128 a[36:39], v18 offset:0
v_mfma_f32_16x16x32_bf16 v[80:83], a[56:59], a[12:15], v[80:83]
s_add_u32 m0, s76, 1024
ds_read_b64_tr_b16 a[56:57], v8 offset:8192
v_mfma_f32_16x16x32_bf16 v[96:99], a[60:63], a[0:3], v[96:99]
s_add_u32 s64, s72, 17408
ds_read_b64_tr_b16 a[58:59], v8 offset:9216
v_mfma_f32_16x16x32_bf16 v[112:115], a[60:63], a[4:7], v[112:115]
buffer_load_dwordx4 v13, s[48:51], s64 offen lds
v_mfma_f32_16x16x32_bf16 v[128:131], a[60:63], a[8:11], v[128:131]
v_mfma_f32_16x16x32_bf16 v[144:147], a[60:63], a[12:15], v[144:147]
s_add_u32 s65, s79, 11264
ds_read_b64_tr_b16 a[60:61], v9 offset:8192
v_mfma_f32_16x16x32_bf16 v[36:39], a[64:67], a[0:3], v[36:39]
buffer_store_dwordx4 a[192:195], v16, s[44:47], s65 offen sc1
v_mfma_f32_16x16x32_bf16 v[52:55], a[64:67], a[4:7], v[52:55]
s_add_u32 m0, s76, 2048
ds_read_b64_tr_b16 a[62:63], v9 offset:9216
v_mfma_f32_16x16x32_bf16 v[68:71], a[64:67], a[8:11], v[68:71]
s_add_u32 s64, s72, 132096
v_mfma_f32_16x16x32_bf16 v[84:87], a[64:67], a[12:15], v[84:87]
buffer_load_dwordx4 v12, s[48:51], s64 offen lds
v_mfma_f32_16x16x32_bf16 v[100:103], a[68:71], a[0:3], v[100:103]
ds_read_b64_tr_b16 a[64:65], v10 offset:8192
v_mfma_f32_16x16x32_bf16 v[116:119], a[68:71], a[4:7], v[116:119]
ds_read_b64_tr_b16 a[66:67], v10 offset:9216
v_mfma_f32_16x16x32_bf16 v[132:135], a[68:71], a[8:11], v[132:135]
v_mfma_f32_16x16x32_bf16 v[148:151], a[68:71], a[12:15], v[148:151]
s_add_u32 m0, s76, 3072
ds_read_b64_tr_b16 a[68:69], v11 offset:8192
v_mfma_f32_16x16x32_bf16 v[152:155], a[72:75], a[0:3], v[152:155]
s_add_u32 s64, s72, 148480
ds_read_b64_tr_b16 a[70:71], v11 offset:9216
v_mfma_f32_16x16x32_bf16 v[160:163], a[72:75], a[4:7], v[160:163]
buffer_load_dwordx4 v13, s[48:51], s64 offen lds
v_mfma_f32_16x16x32_bf16 v[168:171], a[72:75], a[8:11], v[168:171]
v_mfma_f32_16x16x32_bf16 v[176:179], a[72:75], a[12:15], v[176:179]
ds_read_b64_tr_b16 a[72:73], v19 offset:2048
v_mfma_f32_16x16x32_bf16 v[156:159], a[76:79], a[0:3], v[156:159]
ds_read_b64_tr_b16 a[74:75], v19 offset:2304
v_mfma_f32_16x16x32_bf16 v[164:167], a[76:79], a[4:7], v[164:167]
s_add_u32 m0, s76, 4096
v_mfma_f32_16x16x32_bf16 v[172:175], a[76:79], a[8:11], v[172:175]
s_add_u32 s64, s73, 1024
v_mfma_f32_16x16x32_bf16 v[180:183], a[76:79], a[12:15], v[180:183]
buffer_load_dwordx4 v12, s[48:51], s64 offen lds
v_mfma_f32_16x16x32_bf16 v[184:187], a[80:83], a[0:3], v[184:187]
ds_read_b64_tr_b16 a[76:77], v20 offset:2048
v_mfma_f32_16x16x32_bf16 v[192:195], a[80:83], a[4:7], v[192:195]
s_add_u32 s65, s79, 27648
ds_read_b64_tr_b16 a[78:79], v20 offset:2304
v_mfma_f32_16x16x32_bf16 v[200:203], a[80:83], a[8:11], v[200:203]
s_add_u32 m0, s76, 5120
v_mfma_f32_16x16x32_bf16 v[208:211], a[80:83], a[12:15], v[208:211]
s_add_u32 s64, s73, 17408
ds_read_b64_tr_b16 a[80:81], v19 offset:6144
v_mfma_f32_16x16x32_bf16 v[188:191], a[84:87], a[0:3], v[188:191]
buffer_store_dwordx4 a[196:199], v16, s[44:47], s65 offen sc1
v_mfma_f32_16x16x32_bf16 v[196:199], a[84:87], a[4:7], v[196:199]
buffer_load_dwordx4 v13, s[48:51], s64 offen lds
v_mfma_f32_16x16x32_bf16 v[204:207], a[84:87], a[8:11], v[204:207]
ds_read_b64_tr_b16 a[82:83], v19 offset:6400
v_mfma_f32_16x16x32_bf16 v[212:215], a[84:87], a[12:15], v[212:215]
ds_read_b64_tr_b16 a[84:85], v20 offset:6144
v_mfma_f32_16x16x32_bf16 v[216:219], a[0:3], a[88:91], v[216:219]
ds_read_b64_tr_b16 a[86:87], v20 offset:6400
v_mfma_f32_16x16x32_bf16 v[224:227], a[4:7], a[88:91], v[224:227]
s_add_u32 m0, s76, 6144
v_mfma_f32_16x16x32_bf16 v[232:235], a[8:11], a[88:91], v[232:235]
s_add_u32 s64, s73, 132096
v_mfma_f32_16x16x32_bf16 v[240:243], a[12:15], a[88:91], v[240:243]
buffer_load_dwordx4 v12, s[48:51], s64 offen lds
v_mfma_f32_16x16x32_bf16 v[220:223], a[0:3], a[92:95], v[220:223]
ds_read_b64_tr_b16 a[88:89], v19 offset:10240
v_mfma_f32_16x16x32_bf16 v[228:231], a[4:7], a[92:95], v[228:231]
ds_read_b64_tr_b16 a[90:91], v19 offset:10496
v_mfma_f32_16x16x32_bf16 v[236:239], a[8:11], a[92:95], v[236:239]
v_mfma_f32_16x16x32_bf16 v[244:247], a[12:15], a[92:95], v[244:247]
s_waitcnt lgkmcnt(5)
ds_read_b64_tr_b16 a[92:93], v20 offset:10240
v_mfma_f32_16x16x32_bf16 v[248:251], a[96:99], a[16:19], v[248:251]
ds_read_b64_tr_b16 a[94:95], v20 offset:10496
v_mfma_f32_16x16x32_bf16 v[252:255], a[16:19], a[100:103], v[252:255]
ds_read_b64_tr_b16 a[96:97], v21 offset:6144
v_mfma_f32_16x16x32_bf16 v[24:27], a[40:43], a[20:23], v[24:27]
ds_read_b64_tr_b16 a[98:99], v21 offset:6400
v_mfma_f32_16x16x32_bf16 v[40:43], a[40:43], a[24:27], v[40:43]
s_add_u32 m0, s76, 7168
ds_read_b64_tr_b16 a[100:101], v21 offset:10240
v_mfma_f32_16x16x32_bf16 v[56:59], a[40:43], a[28:31], v[56:59]
s_add_u32 s64, s73, 148480
ds_read_b64_tr_b16 a[102:103], v21 offset:10496
v_mfma_f32_16x16x32_bf16 v[72:75], a[40:43], a[32:35], v[72:75]
buffer_load_dwordx4 v13, s[48:51], s64 offen lds
v_mfma_f32_16x16x32_bf16 v[88:91], a[44:47], a[20:23], v[88:91]
v_mfma_f32_16x16x32_bf16 v[104:107], a[44:47], a[24:27], v[104:107]
v_mfma_f32_16x16x32_bf16 v[120:123], a[44:47], a[28:31], v[120:123]
v_mfma_f32_16x16x32_bf16 v[136:139], a[44:47], a[32:35], v[136:139]
v_mfma_f32_16x16x32_bf16 v[28:31], a[48:51], a[20:23], v[28:31]
s_waitcnt vmcnt(11) lgkmcnt(0)
s_barrier
v_mfma_f32_16x16x32_bf16 v[44:47], a[48:51], a[24:27], v[44:47]
s_add_u32 m0, s77, 65536
ds_read_b64_tr_b16 a[40:41], v4 offset:32768
v_mfma_f32_16x16x32_bf16 v[60:63], a[48:51], a[28:31], v[60:63]
s_add_u32 s64, s71, 4194304
ds_read_b64_tr_b16 a[42:43], v4 offset:33792
v_mfma_f32_16x16x32_bf16 v[76:79], a[48:51], a[32:35], v[76:79]
buffer_load_dwordx4 v14, s[56:59], s64 offen lds
v_mfma_f32_16x16x32_bf16 v[92:95], a[52:55], a[20:23], v[92:95]
ds_read_b64_tr_b16 a[44:45], v5 offset:32768
v_mfma_f32_16x16x32_bf16 v[108:111], a[52:55], a[24:27], v[108:111]
ds_read_b64_tr_b16 a[46:47], v5 offset:33792
v_mfma_f32_16x16x32_bf16 v[124:127], a[52:55], a[28:31], v[124:127]
ds_read_b64_tr_b16 a[48:49], v6 offset:32768
v_mfma_f32_16x16x32_bf16 v[140:143], a[52:55], a[32:35], v[140:143]
s_add_u32 m0, s77, 66560
ds_read_b64_tr_b16 a[50:51], v6 offset:33792
v_mfma_f32_16x16x32_bf16 v[32:35], a[56:59], a[20:23], v[32:35]
s_add_u32 s64, s71, 4227072
ds_read_b64_tr_b16 a[52:53], v7 offset:32768
v_mfma_f32_16x16x32_bf16 v[48:51], a[56:59], a[24:27], v[48:51]
buffer_load_dwordx4 v14, s[56:59], s64 offen lds
v_mfma_f32_16x16x32_bf16 v[64:67], a[56:59], a[28:31], v[64:67]
ds_read_b64_tr_b16 a[54:55], v7 offset:33792
v_mfma_f32_16x16x32_bf16 v[80:83], a[56:59], a[32:35], v[80:83]
ds_read_b64_tr_b16 a[56:57], v8 offset:32768
v_mfma_f32_16x16x32_bf16 v[96:99], a[60:63], a[20:23], v[96:99]
ds_read_b64_tr_b16 a[58:59], v8 offset:33792
v_mfma_f32_16x16x32_bf16 v[112:115], a[60:63], a[24:27], v[112:115]
ds_read_b128 a[0:3], v2 offset:32768
v_mfma_f32_16x16x32_bf16 v[128:131], a[60:63], a[28:31], v[128:131]
s_add_u32 m0, s77, 67584
ds_read_b128 a[4:7], v2 offset:34816
v_mfma_f32_16x16x32_bf16 v[144:147], a[60:63], a[32:35], v[144:147]
s_add_u32 s64, s71, 4259840
ds_read_b64_tr_b16 a[60:61], v9 offset:32768
v_mfma_f32_16x16x32_bf16 v[36:39], a[64:67], a[20:23], v[36:39]
buffer_load_dwordx4 v15, s[56:59], s64 offen lds
v_mfma_f32_16x16x32_bf16 v[52:55], a[64:67], a[24:27], v[52:55]
ds_read_b64_tr_b16 a[62:63], v9 offset:33792
v_mfma_f32_16x16x32_bf16 v[68:71], a[64:67], a[28:31], v[68:71]
ds_read_b128 a[8:11], v2 offset:36864
v_mfma_f32_16x16x32_bf16 v[84:87], a[64:67], a[32:35], v[84:87]
ds_read_b128 a[12:15], v2 offset:38912
v_mfma_f32_16x16x32_bf16 v[100:103], a[68:71], a[20:23], v[100:103]
ds_read_b64_tr_b16 a[64:65], v10 offset:32768
v_mfma_f32_16x16x32_bf16 v[116:119], a[68:71], a[24:27], v[116:119]
s_add_u32 m0, s77, 68608
ds_read_b64_tr_b16 a[66:67], v10 offset:33792
v_mfma_f32_16x16x32_bf16 v[132:135], a[68:71], a[28:31], v[132:135]
s_add_u32 s64, s71, 4292608
ds_read_b128 a[16:19], v17 offset:32768
v_mfma_f32_16x16x32_bf16 v[148:151], a[68:71], a[32:35], v[148:151]
buffer_load_dwordx4 v15, s[56:59], s64 offen lds
v_mfma_f32_16x16x32_bf16 v[152:155], a[72:75], a[20:23], v[152:155]
ds_read_b64_tr_b16 a[68:69], v11 offset:32768
v_mfma_f32_16x16x32_bf16 v[160:163], a[72:75], a[24:27], v[160:163]
ds_read_b64_tr_b16 a[70:71], v11 offset:33792
v_mfma_f32_16x16x32_bf16 v[168:171], a[72:75], a[28:31], v[168:171]
v_mfma_f32_16x16x32_bf16 v[176:179], a[72:75], a[32:35], v[176:179]
ds_read_b64_tr_b16 a[72:73], v19 offset:32768
v_mfma_f32_16x16x32_bf16 v[156:159], a[76:79], a[20:23], v[156:159]
s_add_u32 m0, s78, 81920
ds_read_b64_tr_b16 a[74:75], v19 offset:33024
v_mfma_f32_16x16x32_bf16 v[164:167], a[76:79], a[24:27], v[164:167]
s_add_u32 s64, s75, 3145728
v_mfma_f32_16x16x32_bf16 v[172:175], a[76:79], a[28:31], v[172:175]
buffer_load_dwordx4 v23, s[60:63], s64 offen lds
v_mfma_f32_16x16x32_bf16 v[180:183], a[76:79], a[32:35], v[180:183]
ds_read_b64_tr_b16 a[76:77], v20 offset:32768
v_mfma_f32_16x16x32_bf16 v[184:187], a[80:83], a[20:23], v[184:187]
ds_read_b64_tr_b16 a[78:79], v20 offset:33024
v_mfma_f32_16x16x32_bf16 v[192:195], a[80:83], a[24:27], v[192:195]
v_mfma_f32_16x16x32_bf16 v[200:203], a[80:83], a[28:31], v[200:203]
v_mfma_f32_16x16x32_bf16 v[208:211], a[80:83], a[32:35], v[208:211]
s_add_u32 m0, s78, 86016
ds_read_b64_tr_b16 a[80:81], v19 offset:36864
v_mfma_f32_16x16x32_bf16 v[188:191], a[84:87], a[20:23], v[188:191]
s_add_u32 s64, s75, 3147776
ds_read_b64_tr_b16 a[82:83], v19 offset:37120
v_mfma_f32_16x16x32_bf16 v[196:199], a[84:87], a[24:27], v[196:199]
buffer_load_dwordx4 v23, s[60:63], s64 offen lds
v_mfma_f32_16x16x32_bf16 v[204:207], a[84:87], a[28:31], v[204:207]
v_mfma_f32_16x16x32_bf16 v[212:215], a[84:87], a[32:35], v[212:215]
ds_read_b64_tr_b16 a[84:85], v20 offset:36864
v_mfma_f32_16x16x32_bf16 v[216:219], a[20:23], a[88:91], v[216:219]
ds_read_b64_tr_b16 a[86:87], v20 offset:37120
v_mfma_f32_16x16x32_bf16 v[224:227], a[24:27], a[88:91], v[224:227]
v_mfma_f32_16x16x32_bf16 v[232:235], a[28:31], a[88:91], v[232:235]
s_add_u32 m0, s78, 90112
v_mfma_f32_16x16x32_bf16 v[240:243], a[32:35], a[88:91], v[240:243]
s_add_u32 s64, s75, 3149824
ds_read_b64_tr_b16 a[88:89], v19 offset:40960
v_mfma_f32_16x16x32_bf16 v[220:223], a[20:23], a[92:95], v[220:223]
buffer_load_dwordx4 v23, s[60:63], s64 offen lds
v_mfma_f32_16x16x32_bf16 v[228:231], a[24:27], a[92:95], v[228:231]
ds_read_b64_tr_b16 a[90:91], v19 offset:41216
v_mfma_f32_16x16x32_bf16 v[236:239], a[28:31], a[92:95], v[236:239]
v_mfma_f32_16x16x32_bf16 v[244:247], a[32:35], a[92:95], v[244:247]
ds_read_b64_tr_b16 a[92:93], v20 offset:40960
v_mfma_f32_16x16x32_bf16 v[248:251], a[96:99], a[36:39], v[248:251]
ds_read_b64_tr_b16 a[94:95], v20 offset:41216
v_mfma_f32_16x16x32_bf16 v[252:255], a[36:39], a[100:103], v[252:255]
s_waitcnt lgkmcnt(5)
s_add_u32 m0, s78, 94208
ds_read_b64_tr_b16 a[96:97], v21 offset:36864
v_mfma_f32_16x16x32_bf16 v[24:27], a[40:43], a[0:3], v[24:27]
s_add_u32 s64, s74, 1024
ds_read_b128 a[20:23], v3 offset:32768
v_mfma_f32_16x16x32_bf16 v[40:43], a[40:43], a[4:7], v[40:43]
buffer_load_dwordx4 v22, s[48:51], s64 offen lds
v_mfma_f32_16x16x32_bf16 v[56:59], a[40:43], a[8:11], v[56:59]
ds_read_b128 a[24:27], v3 offset:34816
v_mfma_f32_16x16x32_bf16 v[72:75], a[40:43], a[12:15], v[72:75]
ds_read_b128 a[28:31], v3 offset:36864
v_mfma_f32_16x16x32_bf16 v[88:91], a[44:47], a[0:3], v[88:91]
s_add_u32 s65, s79, 28672
ds_read_b128 a[32:35], v3 offset:38912
v_mfma_f32_16x16x32_bf16 v[104:107], a[44:47], a[4:7], v[104:107]
buffer_store_dwordx4 a[200:203], v16, s[44:47], s65 offen sc1
v_mfma_f32_16x16x32_bf16 v[120:123], a[44:47], a[8:11], v[120:123]
ds_read_b64_tr_b16 a[40:41], v4 offset:40960
v_mfma_f32_16x16x32_bf16 v[136:139], a[44:47], a[12:15], v[136:139]
ds_read_b64_tr_b16 a[42:43], v4 offset:41984
v_mfma_f32_16x16x32_bf16 v[28:31], a[48:51], a[0:3], v[28:31]
ds_read_b64_tr_b16 a[44:45], v5 offset:40960
v_mfma_f32_16x16x32_bf16 v[44:47], a[48:51], a[4:7], v[44:47]
ds_read_b64_tr_b16 a[46:47], v5 offset:41984
v_mfma_f32_16x16x32_bf16 v[60:63], a[48:51], a[8:11], v[60:63]
ds_read_b64_tr_b16 a[98:99], v21 offset:37120
v_mfma_f32_16x16x32_bf16 v[76:79], a[48:51], a[12:15], v[76:79]
ds_read_b64_tr_b16 a[100:101], v21 offset:40960
v_mfma_f32_16x16x32_bf16 v[92:95], a[52:55], a[0:3], v[92:95]
ds_read_b64_tr_b16 a[102:103], v21 offset:41216
v_mfma_f32_16x16x32_bf16 v[108:111], a[52:55], a[4:7], v[108:111]
s_waitcnt lgkmcnt(7)
ds_read_b64_tr_b16 a[48:49], v6 offset:40960
v_mfma_f32_16x16x32_bf16 v[124:127], a[52:55], a[8:11], v[124:127]
s_add_u32 m0, s76, 32768
ds_read_b64_tr_b16 a[50:51], v6 offset:41984
v_mfma_f32_16x16x32_bf16 v[140:143], a[52:55], a[12:15], v[140:143]
s_add_u32 s64, s72, 1152
ds_read_b64_tr_b16 a[52:53], v7 offset:40960
v_mfma_f32_16x16x32_bf16 v[32:35], a[56:59], a[0:3], v[32:35]
buffer_load_dwordx4 v12, s[48:51], s64 offen lds
v_mfma_f32_16x16x32_bf16 v[48:51], a[56:59], a[4:7], v[48:51]
ds_read_b64_tr_b16 a[54:55], v7 offset:41984
v_mfma_f32_16x16x32_bf16 v[64:67], a[56:59], a[8:11], v[64:67]
ds_read_b128 a[36:39], v18 offset:32768
v_mfma_f32_16x16x32_bf16 v[80:83], a[56:59], a[12:15], v[80:83]
s_add_u32 m0, s76, 33792
ds_read_b64_tr_b16 a[56:57], v8 offset:40960
v_mfma_f32_16x16x32_bf16 v[96:99], a[60:63], a[0:3], v[96:99]
s_add_u32 s64, s72, 17536
ds_read_b64_tr_b16 a[58:59], v8 offset:41984
v_mfma_f32_16x16x32_bf16 v[112:115], a[60:63], a[4:7], v[112:115]
buffer_load_dwordx4 v13, s[48:51], s64 offen lds
v_mfma_f32_16x16x32_bf16 v[128:131], a[60:63], a[8:11], v[128:131]
v_mfma_f32_16x16x32_bf16 v[144:147], a[60:63], a[12:15], v[144:147]
s_add_u32 s65, s79, 13312
ds_read_b64_tr_b16 a[60:61], v9 offset:40960
v_mfma_f32_16x16x32_bf16 v[36:39], a[64:67], a[0:3], v[36:39]
buffer_store_dwordx4 a[204:207], v16, s[44:47], s65 offen sc1
v_mfma_f32_16x16x32_bf16 v[52:55], a[64:67], a[4:7], v[52:55]
s_add_u32 m0, s76, 34816
ds_read_b64_tr_b16 a[62:63], v9 offset:41984
v_mfma_f32_16x16x32_bf16 v[68:71], a[64:67], a[8:11], v[68:71]
s_add_u32 s64, s72, 132224
v_mfma_f32_16x16x32_bf16 v[84:87], a[64:67], a[12:15], v[84:87]
buffer_load_dwordx4 v12, s[48:51], s64 offen lds
v_mfma_f32_16x16x32_bf16 v[100:103], a[68:71], a[0:3], v[100:103]
ds_read_b64_tr_b16 a[64:65], v10 offset:40960
v_mfma_f32_16x16x32_bf16 v[116:119], a[68:71], a[4:7], v[116:119]
ds_read_b64_tr_b16 a[66:67], v10 offset:41984
v_mfma_f32_16x16x32_bf16 v[132:135], a[68:71], a[8:11], v[132:135]
v_mfma_f32_16x16x32_bf16 v[148:151], a[68:71], a[12:15], v[148:151]
s_add_u32 m0, s76, 35840
ds_read_b64_tr_b16 a[68:69], v11 offset:40960
v_mfma_f32_16x16x32_bf16 v[152:155], a[72:75], a[0:3], v[152:155]
s_add_u32 s64, s72, 148608
ds_read_b64_tr_b16 a[70:71], v11 offset:41984
v_mfma_f32_16x16x32_bf16 v[160:163], a[72:75], a[4:7], v[160:163]
buffer_load_dwordx4 v13, s[48:51], s64 offen lds
v_mfma_f32_16x16x32_bf16 v[168:171], a[72:75], a[8:11], v[168:171]
v_mfma_f32_16x16x32_bf16 v[176:179], a[72:75], a[12:15], v[176:179]
ds_read_b64_tr_b16 a[72:73], v19 offset:34816
v_mfma_f32_16x16x32_bf16 v[156:159], a[76:79], a[0:3], v[156:159]
ds_read_b64_tr_b16 a[74:75], v19 offset:35072
v_mfma_f32_16x16x32_bf16 v[164:167], a[76:79], a[4:7], v[164:167]
s_add_u32 m0, s76, 36864
v_mfma_f32_16x16x32_bf16 v[172:175], a[76:79], a[8:11], v[172:175]
s_add_u32 s64, s73, 1152
v_mfma_f32_16x16x32_bf16 v[180:183], a[76:79], a[12:15], v[180:183]
buffer_load_dwordx4 v12, s[48:51], s64 offen lds
v_mfma_f32_16x16x32_bf16 v[184:187], a[80:83], a[0:3], v[184:187]
ds_read_b64_tr_b16 a[76:77], v20 offset:34816
v_mfma_f32_16x16x32_bf16 v[192:195], a[80:83], a[4:7], v[192:195]
s_add_u32 s65, s79, 29696
ds_read_b64_tr_b16 a[78:79], v20 offset:35072
v_mfma_f32_16x16x32_bf16 v[200:203], a[80:83], a[8:11], v[200:203]
s_add_u32 m0, s76, 37888
v_mfma_f32_16x16x32_bf16 v[208:211], a[80:83], a[12:15], v[208:211]
s_add_u32 s64, s73, 17536
ds_read_b64_tr_b16 a[80:81], v19 offset:38912
v_mfma_f32_16x16x32_bf16 v[188:191], a[84:87], a[0:3], v[188:191]
buffer_store_dwordx4 a[208:211], v16, s[44:47], s65 offen sc1
v_mfma_f32_16x16x32_bf16 v[196:199], a[84:87], a[4:7], v[196:199]
buffer_load_dwordx4 v13, s[48:51], s64 offen lds
v_mfma_f32_16x16x32_bf16 v[204:207], a[84:87], a[8:11], v[204:207]
ds_read_b64_tr_b16 a[82:83], v19 offset:39168
v_mfma_f32_16x16x32_bf16 v[212:215], a[84:87], a[12:15], v[212:215]
ds_read_b64_tr_b16 a[84:85], v20 offset:38912
v_mfma_f32_16x16x32_bf16 v[216:219], a[0:3], a[88:91], v[216:219]
ds_read_b64_tr_b16 a[86:87], v20 offset:39168
v_mfma_f32_16x16x32_bf16 v[224:227], a[4:7], a[88:91], v[224:227]
s_add_u32 m0, s76, 38912
v_mfma_f32_16x16x32_bf16 v[232:235], a[8:11], a[88:91], v[232:235]
s_add_u32 s64, s73, 132224
v_mfma_f32_16x16x32_bf16 v[240:243], a[12:15], a[88:91], v[240:243]
buffer_load_dwordx4 v12, s[48:51], s64 offen lds
v_mfma_f32_16x16x32_bf16 v[220:223], a[0:3], a[92:95], v[220:223]
ds_read_b64_tr_b16 a[88:89], v19 offset:43008
v_mfma_f32_16x16x32_bf16 v[228:231], a[4:7], a[92:95], v[228:231]
ds_read_b64_tr_b16 a[90:91], v19 offset:43264
v_mfma_f32_16x16x32_bf16 v[236:239], a[8:11], a[92:95], v[236:239]
v_mfma_f32_16x16x32_bf16 v[244:247], a[12:15], a[92:95], v[244:247]
s_waitcnt lgkmcnt(5)
ds_read_b64_tr_b16 a[92:93], v20 offset:43008
v_mfma_f32_16x16x32_bf16 v[248:251], a[96:99], a[16:19], v[248:251]
ds_read_b64_tr_b16 a[94:95], v20 offset:43264
v_mfma_f32_16x16x32_bf16 v[252:255], a[16:19], a[100:103], v[252:255]
ds_read_b64_tr_b16 a[96:97], v21 offset:38912
v_mfma_f32_16x16x32_bf16 v[24:27], a[40:43], a[20:23], v[24:27]
ds_read_b64_tr_b16 a[98:99], v21 offset:39168
v_mfma_f32_16x16x32_bf16 v[40:43], a[40:43], a[24:27], v[40:43]
s_add_u32 m0, s76, 39936
ds_read_b64_tr_b16 a[100:101], v21 offset:43008
v_mfma_f32_16x16x32_bf16 v[56:59], a[40:43], a[28:31], v[56:59]
s_add_u32 s64, s73, 148608
ds_read_b64_tr_b16 a[102:103], v21 offset:43264
v_mfma_f32_16x16x32_bf16 v[72:75], a[40:43], a[32:35], v[72:75]
buffer_load_dwordx4 v13, s[48:51], s64 offen lds
v_mfma_f32_16x16x32_bf16 v[88:91], a[44:47], a[20:23], v[88:91]
v_mfma_f32_16x16x32_bf16 v[104:107], a[44:47], a[24:27], v[104:107]
v_mfma_f32_16x16x32_bf16 v[120:123], a[44:47], a[28:31], v[120:123]
v_mfma_f32_16x16x32_bf16 v[136:139], a[44:47], a[32:35], v[136:139]
v_mfma_f32_16x16x32_bf16 v[28:31], a[48:51], a[20:23], v[28:31]
s_waitcnt vmcnt(11) lgkmcnt(0)
s_barrier
v_mfma_f32_16x16x32_bf16 v[44:47], a[48:51], a[24:27], v[44:47]
s_add_u32 m0, s77, 98304
ds_read_b64_tr_b16 a[40:41], v4 offset:0
v_mfma_f32_16x16x32_bf16 v[60:63], a[48:51], a[28:31], v[60:63]
s_add_u32 s64, s71, 4718592
ds_read_b64_tr_b16 a[42:43], v4 offset:1024
v_mfma_f32_16x16x32_bf16 v[76:79], a[48:51], a[32:35], v[76:79]
buffer_load_dwordx4 v14, s[56:59], s64 offen lds
v_mfma_f32_16x16x32_bf16 v[92:95], a[52:55], a[20:23], v[92:95]
ds_read_b64_tr_b16 a[44:45], v5 offset:0
v_mfma_f32_16x16x32_bf16 v[108:111], a[52:55], a[24:27], v[108:111]
ds_read_b64_tr_b16 a[46:47], v5 offset:1024
v_mfma_f32_16x16x32_bf16 v[124:127], a[52:55], a[28:31], v[124:127]
ds_read_b64_tr_b16 a[48:49], v6 offset:0
v_mfma_f32_16x16x32_bf16 v[140:143], a[52:55], a[32:35], v[140:143]
s_add_u32 m0, s77, 99328
ds_read_b64_tr_b16 a[50:51], v6 offset:1024
v_mfma_f32_16x16x32_bf16 v[32:35], a[56:59], a[20:23], v[32:35]
s_add_u32 s64, s71, 4751360
ds_read_b64_tr_b16 a[52:53], v7 offset:0
v_mfma_f32_16x16x32_bf16 v[48:51], a[56:59], a[24:27], v[48:51]
buffer_load_dwordx4 v14, s[56:59], s64 offen lds
v_mfma_f32_16x16x32_bf16 v[64:67], a[56:59], a[28:31], v[64:67]
ds_read_b64_tr_b16 a[54:55], v7 offset:1024
v_mfma_f32_16x16x32_bf16 v[80:83], a[56:59], a[32:35], v[80:83]
ds_read_b64_tr_b16 a[56:57], v8 offset:0
v_mfma_f32_16x16x32_bf16 v[96:99], a[60:63], a[20:23], v[96:99]
ds_read_b64_tr_b16 a[58:59], v8 offset:1024
v_mfma_f32_16x16x32_bf16 v[112:115], a[60:63], a[24:27], v[112:115]
ds_read_b128 a[0:3], v2 offset:0
v_mfma_f32_16x16x32_bf16 v[128:131], a[60:63], a[28:31], v[128:131]
s_add_u32 m0, s77, 100352
ds_read_b128 a[4:7], v2 offset:2048
v_mfma_f32_16x16x32_bf16 v[144:147], a[60:63], a[32:35], v[144:147]
s_add_u32 s64, s71, 4784128
ds_read_b64_tr_b16 a[60:61], v9 offset:0
v_mfma_f32_16x16x32_bf16 v[36:39], a[64:67], a[20:23], v[36:39]
buffer_load_dwordx4 v15, s[56:59], s64 offen lds
v_mfma_f32_16x16x32_bf16 v[52:55], a[64:67], a[24:27], v[52:55]
ds_read_b64_tr_b16 a[62:63], v9 offset:1024
v_mfma_f32_16x16x32_bf16 v[68:71], a[64:67], a[28:31], v[68:71]
ds_read_b128 a[8:11], v2 offset:4096
v_mfma_f32_16x16x32_bf16 v[84:87], a[64:67], a[32:35], v[84:87]
ds_read_b128 a[12:15], v2 offset:6144
v_mfma_f32_16x16x32_bf16 v[100:103], a[68:71], a[20:23], v[100:103]
ds_read_b64_tr_b16 a[64:65], v10 offset:0
v_mfma_f32_16x16x32_bf16 v[116:119], a[68:71], a[24:27], v[116:119]
s_add_u32 m0, s77, 101376
ds_read_b64_tr_b16 a[66:67], v10 offset:1024
v_mfma_f32_16x16x32_bf16 v[132:135], a[68:71], a[28:31], v[132:135]
s_add_u32 s64, s71, 4816896
ds_read_b128 a[16:19], v17 offset:0
v_mfma_f32_16x16x32_bf16 v[148:151], a[68:71], a[32:35], v[148:151]
buffer_load_dwordx4 v15, s[56:59], s64 offen lds
v_mfma_f32_16x16x32_bf16 v[152:155], a[72:75], a[20:23], v[152:155]
ds_read_b64_tr_b16 a[68:69], v11 offset:0
v_mfma_f32_16x16x32_bf16 v[160:163], a[72:75], a[24:27], v[160:163]
ds_read_b64_tr_b16 a[70:71], v11 offset:1024
v_mfma_f32_16x16x32_bf16 v[168:171], a[72:75], a[28:31], v[168:171]
v_mfma_f32_16x16x32_bf16 v[176:179], a[72:75], a[32:35], v[176:179]
ds_read_b64_tr_b16 a[72:73], v19 offset:0
v_mfma_f32_16x16x32_bf16 v[156:159], a[76:79], a[20:23], v[156:159]
s_add_u32 m0, s78, 114688
ds_read_b64_tr_b16 a[74:75], v19 offset:256
v_mfma_f32_16x16x32_bf16 v[164:167], a[76:79], a[24:27], v[164:167]
s_add_u32 s64, s75, 3538944
v_mfma_f32_16x16x32_bf16 v[172:175], a[76:79], a[28:31], v[172:175]
buffer_load_dwordx4 v23, s[60:63], s64 offen lds
v_mfma_f32_16x16x32_bf16 v[180:183], a[76:79], a[32:35], v[180:183]
ds_read_b64_tr_b16 a[76:77], v20 offset:0
v_mfma_f32_16x16x32_bf16 v[184:187], a[80:83], a[20:23], v[184:187]
ds_read_b64_tr_b16 a[78:79], v20 offset:256
v_mfma_f32_16x16x32_bf16 v[192:195], a[80:83], a[24:27], v[192:195]
v_mfma_f32_16x16x32_bf16 v[200:203], a[80:83], a[28:31], v[200:203]
v_mfma_f32_16x16x32_bf16 v[208:211], a[80:83], a[32:35], v[208:211]
s_add_u32 m0, s78, 118784
ds_read_b64_tr_b16 a[80:81], v19 offset:4096
v_mfma_f32_16x16x32_bf16 v[188:191], a[84:87], a[20:23], v[188:191]
s_add_u32 s64, s75, 3540992
ds_read_b64_tr_b16 a[82:83], v19 offset:4352
v_mfma_f32_16x16x32_bf16 v[196:199], a[84:87], a[24:27], v[196:199]
buffer_load_dwordx4 v23, s[60:63], s64 offen lds
v_mfma_f32_16x16x32_bf16 v[204:207], a[84:87], a[28:31], v[204:207]
v_mfma_f32_16x16x32_bf16 v[212:215], a[84:87], a[32:35], v[212:215]
ds_read_b64_tr_b16 a[84:85], v20 offset:4096
v_mfma_f32_16x16x32_bf16 v[216:219], a[20:23], a[88:91], v[216:219]
ds_read_b64_tr_b16 a[86:87], v20 offset:4352
v_mfma_f32_16x16x32_bf16 v[224:227], a[24:27], a[88:91], v[224:227]
v_mfma_f32_16x16x32_bf16 v[232:235], a[28:31], a[88:91], v[232:235]
s_add_u32 m0, s78, 122880
v_mfma_f32_16x16x32_bf16 v[240:243], a[32:35], a[88:91], v[240:243]
s_add_u32 s64, s75, 3543040
ds_read_b64_tr_b16 a[88:89], v19 offset:8192
v_mfma_f32_16x16x32_bf16 v[220:223], a[20:23], a[92:95], v[220:223]
buffer_load_dwordx4 v23, s[60:63], s64 offen lds
v_mfma_f32_16x16x32_bf16 v[228:231], a[24:27], a[92:95], v[228:231]
ds_read_b64_tr_b16 a[90:91], v19 offset:8448
v_mfma_f32_16x16x32_bf16 v[236:239], a[28:31], a[92:95], v[236:239]
v_mfma_f32_16x16x32_bf16 v[244:247], a[32:35], a[92:95], v[244:247]
ds_read_b64_tr_b16 a[92:93], v20 offset:8192
v_mfma_f32_16x16x32_bf16 v[248:251], a[96:99], a[36:39], v[248:251]
ds_read_b64_tr_b16 a[94:95], v20 offset:8448
v_mfma_f32_16x16x32_bf16 v[252:255], a[36:39], a[100:103], v[252:255]
s_waitcnt lgkmcnt(5)
s_add_u32 m0, s78, 126976
ds_read_b64_tr_b16 a[96:97], v21 offset:4096
v_mfma_f32_16x16x32_bf16 v[24:27], a[40:43], a[0:3], v[24:27]
s_add_u32 s64, s74, 1152
ds_read_b128 a[20:23], v3 offset:0
v_mfma_f32_16x16x32_bf16 v[40:43], a[40:43], a[4:7], v[40:43]
buffer_load_dwordx4 v22, s[48:51], s64 offen lds
v_mfma_f32_16x16x32_bf16 v[56:59], a[40:43], a[8:11], v[56:59]
ds_read_b128 a[24:27], v3 offset:2048
v_mfma_f32_16x16x32_bf16 v[72:75], a[40:43], a[12:15], v[72:75]
ds_read_b128 a[28:31], v3 offset:4096
v_mfma_f32_16x16x32_bf16 v[88:91], a[44:47], a[0:3], v[88:91]
s_add_u32 s65, s79, 30720
ds_read_b128 a[32:35], v3 offset:6144
v_mfma_f32_16x16x32_bf16 v[104:107], a[44:47], a[4:7], v[104:107]
buffer_store_dwordx4 a[212:215], v16, s[44:47], s65 offen sc1
v_mfma_f32_16x16x32_bf16 v[120:123], a[44:47], a[8:11], v[120:123]
ds_read_b64_tr_b16 a[40:41], v4 offset:8192
v_mfma_f32_16x16x32_bf16 v[136:139], a[44:47], a[12:15], v[136:139]
ds_read_b64_tr_b16 a[42:43], v4 offset:9216
v_mfma_f32_16x16x32_bf16 v[28:31], a[48:51], a[0:3], v[28:31]
ds_read_b64_tr_b16 a[44:45], v5 offset:8192
v_mfma_f32_16x16x32_bf16 v[44:47], a[48:51], a[4:7], v[44:47]
ds_read_b64_tr_b16 a[46:47], v5 offset:9216
v_mfma_f32_16x16x32_bf16 v[60:63], a[48:51], a[8:11], v[60:63]
ds_read_b64_tr_b16 a[98:99], v21 offset:4352
v_mfma_f32_16x16x32_bf16 v[76:79], a[48:51], a[12:15], v[76:79]
ds_read_b64_tr_b16 a[100:101], v21 offset:8192
v_mfma_f32_16x16x32_bf16 v[92:95], a[52:55], a[0:3], v[92:95]
ds_read_b64_tr_b16 a[102:103], v21 offset:8448
v_mfma_f32_16x16x32_bf16 v[108:111], a[52:55], a[4:7], v[108:111]
s_waitcnt lgkmcnt(7)
ds_read_b64_tr_b16 a[48:49], v6 offset:8192
v_mfma_f32_16x16x32_bf16 v[124:127], a[52:55], a[8:11], v[124:127]
s_add_u32 m0, s76, 0
ds_read_b64_tr_b16 a[50:51], v6 offset:9216
v_mfma_f32_16x16x32_bf16 v[140:143], a[52:55], a[12:15], v[140:143]
s_add_u32 s64, s72, 1280
ds_read_b64_tr_b16 a[52:53], v7 offset:8192
v_mfma_f32_16x16x32_bf16 v[32:35], a[56:59], a[0:3], v[32:35]
buffer_load_dwordx4 v12, s[48:51], s64 offen lds
v_mfma_f32_16x16x32_bf16 v[48:51], a[56:59], a[4:7], v[48:51]
ds_read_b64_tr_b16 a[54:55], v7 offset:9216
v_mfma_f32_16x16x32_bf16 v[64:67], a[56:59], a[8:11], v[64:67]
ds_read_b128 a[36:39], v18 offset:0
v_mfma_f32_16x16x32_bf16 v[80:83], a[56:59], a[12:15], v[80:83]
s_add_u32 m0, s76, 1024
ds_read_b64_tr_b16 a[56:57], v8 offset:8192
v_mfma_f32_16x16x32_bf16 v[96:99], a[60:63], a[0:3], v[96:99]
s_add_u32 s64, s72, 17664
ds_read_b64_tr_b16 a[58:59], v8 offset:9216
v_mfma_f32_16x16x32_bf16 v[112:115], a[60:63], a[4:7], v[112:115]
buffer_load_dwordx4 v13, s[48:51], s64 offen lds
v_mfma_f32_16x16x32_bf16 v[128:131], a[60:63], a[8:11], v[128:131]
v_mfma_f32_16x16x32_bf16 v[144:147], a[60:63], a[12:15], v[144:147]
s_add_u32 s65, s79, 15360
ds_read_b64_tr_b16 a[60:61], v9 offset:8192
v_mfma_f32_16x16x32_bf16 v[36:39], a[64:67], a[0:3], v[36:39]
buffer_store_dwordx4 a[216:219], v16, s[44:47], s65 offen sc1
v_mfma_f32_16x16x32_bf16 v[52:55], a[64:67], a[4:7], v[52:55]
s_add_u32 m0, s76, 2048
ds_read_b64_tr_b16 a[62:63], v9 offset:9216
v_mfma_f32_16x16x32_bf16 v[68:71], a[64:67], a[8:11], v[68:71]
s_add_u32 s64, s72, 132352
v_mfma_f32_16x16x32_bf16 v[84:87], a[64:67], a[12:15], v[84:87]
buffer_load_dwordx4 v12, s[48:51], s64 offen lds
v_mfma_f32_16x16x32_bf16 v[100:103], a[68:71], a[0:3], v[100:103]
ds_read_b64_tr_b16 a[64:65], v10 offset:8192
v_mfma_f32_16x16x32_bf16 v[116:119], a[68:71], a[4:7], v[116:119]
ds_read_b64_tr_b16 a[66:67], v10 offset:9216
v_mfma_f32_16x16x32_bf16 v[132:135], a[68:71], a[8:11], v[132:135]
v_mfma_f32_16x16x32_bf16 v[148:151], a[68:71], a[12:15], v[148:151]
s_add_u32 m0, s76, 3072
ds_read_b64_tr_b16 a[68:69], v11 offset:8192
v_mfma_f32_16x16x32_bf16 v[152:155], a[72:75], a[0:3], v[152:155]
s_add_u32 s64, s72, 148736
ds_read_b64_tr_b16 a[70:71], v11 offset:9216
v_mfma_f32_16x16x32_bf16 v[160:163], a[72:75], a[4:7], v[160:163]
buffer_load_dwordx4 v13, s[48:51], s64 offen lds
v_mfma_f32_16x16x32_bf16 v[168:171], a[72:75], a[8:11], v[168:171]
v_mfma_f32_16x16x32_bf16 v[176:179], a[72:75], a[12:15], v[176:179]
ds_read_b64_tr_b16 a[72:73], v19 offset:2048
v_mfma_f32_16x16x32_bf16 v[156:159], a[76:79], a[0:3], v[156:159]
ds_read_b64_tr_b16 a[74:75], v19 offset:2304
v_mfma_f32_16x16x32_bf16 v[164:167], a[76:79], a[4:7], v[164:167]
s_add_u32 m0, s76, 4096
v_mfma_f32_16x16x32_bf16 v[172:175], a[76:79], a[8:11], v[172:175]
s_add_u32 s64, s73, 1280
v_mfma_f32_16x16x32_bf16 v[180:183], a[76:79], a[12:15], v[180:183]
buffer_load_dwordx4 v12, s[48:51], s64 offen lds
v_mfma_f32_16x16x32_bf16 v[184:187], a[80:83], a[0:3], v[184:187]
ds_read_b64_tr_b16 a[76:77], v20 offset:2048
v_mfma_f32_16x16x32_bf16 v[192:195], a[80:83], a[4:7], v[192:195]
s_add_u32 s65, s79, 31744
ds_read_b64_tr_b16 a[78:79], v20 offset:2304
v_mfma_f32_16x16x32_bf16 v[200:203], a[80:83], a[8:11], v[200:203]
s_add_u32 m0, s76, 5120
v_mfma_f32_16x16x32_bf16 v[208:211], a[80:83], a[12:15], v[208:211]
s_add_u32 s64, s73, 17664
ds_read_b64_tr_b16 a[80:81], v19 offset:6144
v_mfma_f32_16x16x32_bf16 v[188:191], a[84:87], a[0:3], v[188:191]
buffer_store_dwordx4 a[220:223], v16, s[44:47], s65 offen sc1
v_mfma_f32_16x16x32_bf16 v[196:199], a[84:87], a[4:7], v[196:199]
buffer_load_dwordx4 v13, s[48:51], s64 offen lds
v_mfma_f32_16x16x32_bf16 v[204:207], a[84:87], a[8:11], v[204:207]
ds_read_b64_tr_b16 a[82:83], v19 offset:6400
v_mfma_f32_16x16x32_bf16 v[212:215], a[84:87], a[12:15], v[212:215]
ds_read_b64_tr_b16 a[84:85], v20 offset:6144
v_mfma_f32_16x16x32_bf16 v[216:219], a[0:3], a[88:91], v[216:219]
ds_read_b64_tr_b16 a[86:87], v20 offset:6400
v_mfma_f32_16x16x32_bf16 v[224:227], a[4:7], a[88:91], v[224:227]
s_add_u32 m0, s76, 6144
v_mfma_f32_16x16x32_bf16 v[232:235], a[8:11], a[88:91], v[232:235]
s_add_u32 s64, s73, 132352
v_mfma_f32_16x16x32_bf16 v[240:243], a[12:15], a[88:91], v[240:243]
buffer_load_dwordx4 v12, s[48:51], s64 offen lds
v_mfma_f32_16x16x32_bf16 v[220:223], a[0:3], a[92:95], v[220:223]
ds_read_b64_tr_b16 a[88:89], v19 offset:10240
v_mfma_f32_16x16x32_bf16 v[228:231], a[4:7], a[92:95], v[228:231]
ds_read_b64_tr_b16 a[90:91], v19 offset:10496
v_mfma_f32_16x16x32_bf16 v[236:239], a[8:11], a[92:95], v[236:239]
v_mfma_f32_16x16x32_bf16 v[244:247], a[12:15], a[92:95], v[244:247]
s_waitcnt lgkmcnt(5)
ds_read_b64_tr_b16 a[92:93], v20 offset:10240
v_mfma_f32_16x16x32_bf16 v[248:251], a[96:99], a[16:19], v[248:251]
ds_read_b64_tr_b16 a[94:95], v20 offset:10496
v_mfma_f32_16x16x32_bf16 v[252:255], a[16:19], a[100:103], v[252:255]
ds_read_b64_tr_b16 a[96:97], v21 offset:6144
v_mfma_f32_16x16x32_bf16 v[24:27], a[40:43], a[20:23], v[24:27]
ds_read_b64_tr_b16 a[98:99], v21 offset:6400
v_mfma_f32_16x16x32_bf16 v[40:43], a[40:43], a[24:27], v[40:43]
s_add_u32 m0, s76, 7168
ds_read_b64_tr_b16 a[100:101], v21 offset:10240
v_mfma_f32_16x16x32_bf16 v[56:59], a[40:43], a[28:31], v[56:59]
s_add_u32 s64, s73, 148736
ds_read_b64_tr_b16 a[102:103], v21 offset:10496
v_mfma_f32_16x16x32_bf16 v[72:75], a[40:43], a[32:35], v[72:75]
buffer_load_dwordx4 v13, s[48:51], s64 offen lds
v_mfma_f32_16x16x32_bf16 v[88:91], a[44:47], a[20:23], v[88:91]
v_mfma_f32_16x16x32_bf16 v[104:107], a[44:47], a[24:27], v[104:107]
v_mfma_f32_16x16x32_bf16 v[120:123], a[44:47], a[28:31], v[120:123]
v_mfma_f32_16x16x32_bf16 v[136:139], a[44:47], a[32:35], v[136:139]
v_mfma_f32_16x16x32_bf16 v[28:31], a[48:51], a[20:23], v[28:31]
s_waitcnt vmcnt(11) lgkmcnt(0)
s_barrier
v_mfma_f32_16x16x32_bf16 v[44:47], a[48:51], a[24:27], v[44:47]
s_add_u32 m0, s77, 65536
ds_read_b64_tr_b16 a[40:41], v4 offset:32768
v_mfma_f32_16x16x32_bf16 v[60:63], a[48:51], a[28:31], v[60:63]
s_add_u32 s64, s71, 5242880
ds_read_b64_tr_b16 a[42:43], v4 offset:33792
v_mfma_f32_16x16x32_bf16 v[76:79], a[48:51], a[32:35], v[76:79]
buffer_load_dwordx4 v14, s[56:59], s64 offen lds
v_mfma_f32_16x16x32_bf16 v[92:95], a[52:55], a[20:23], v[92:95]
ds_read_b64_tr_b16 a[44:45], v5 offset:32768
v_mfma_f32_16x16x32_bf16 v[108:111], a[52:55], a[24:27], v[108:111]
ds_read_b64_tr_b16 a[46:47], v5 offset:33792
v_mfma_f32_16x16x32_bf16 v[124:127], a[52:55], a[28:31], v[124:127]
ds_read_b64_tr_b16 a[48:49], v6 offset:32768
v_mfma_f32_16x16x32_bf16 v[140:143], a[52:55], a[32:35], v[140:143]
s_add_u32 m0, s77, 66560
ds_read_b64_tr_b16 a[50:51], v6 offset:33792
v_mfma_f32_16x16x32_bf16 v[32:35], a[56:59], a[20:23], v[32:35]
s_add_u32 s64, s71, 5275648
ds_read_b64_tr_b16 a[52:53], v7 offset:32768
v_mfma_f32_16x16x32_bf16 v[48:51], a[56:59], a[24:27], v[48:51]
buffer_load_dwordx4 v14, s[56:59], s64 offen lds
v_mfma_f32_16x16x32_bf16 v[64:67], a[56:59], a[28:31], v[64:67]
ds_read_b64_tr_b16 a[54:55], v7 offset:33792
v_mfma_f32_16x16x32_bf16 v[80:83], a[56:59], a[32:35], v[80:83]
ds_read_b64_tr_b16 a[56:57], v8 offset:32768
v_mfma_f32_16x16x32_bf16 v[96:99], a[60:63], a[20:23], v[96:99]
ds_read_b64_tr_b16 a[58:59], v8 offset:33792
v_mfma_f32_16x16x32_bf16 v[112:115], a[60:63], a[24:27], v[112:115]
ds_read_b128 a[0:3], v2 offset:32768
v_mfma_f32_16x16x32_bf16 v[128:131], a[60:63], a[28:31], v[128:131]
s_add_u32 m0, s77, 67584
ds_read_b128 a[4:7], v2 offset:34816
v_mfma_f32_16x16x32_bf16 v[144:147], a[60:63], a[32:35], v[144:147]
s_add_u32 s64, s71, 5308416
ds_read_b64_tr_b16 a[60:61], v9 offset:32768
v_mfma_f32_16x16x32_bf16 v[36:39], a[64:67], a[20:23], v[36:39]
buffer_load_dwordx4 v15, s[56:59], s64 offen lds
v_mfma_f32_16x16x32_bf16 v[52:55], a[64:67], a[24:27], v[52:55]
ds_read_b64_tr_b16 a[62:63], v9 offset:33792
v_mfma_f32_16x16x32_bf16 v[68:71], a[64:67], a[28:31], v[68:71]
ds_read_b128 a[8:11], v2 offset:36864
v_mfma_f32_16x16x32_bf16 v[84:87], a[64:67], a[32:35], v[84:87]
ds_read_b128 a[12:15], v2 offset:38912
v_mfma_f32_16x16x32_bf16 v[100:103], a[68:71], a[20:23], v[100:103]
ds_read_b64_tr_b16 a[64:65], v10 offset:32768
v_mfma_f32_16x16x32_bf16 v[116:119], a[68:71], a[24:27], v[116:119]
s_add_u32 m0, s77, 68608
ds_read_b64_tr_b16 a[66:67], v10 offset:33792
v_mfma_f32_16x16x32_bf16 v[132:135], a[68:71], a[28:31], v[132:135]
s_add_u32 s64, s71, 5341184
ds_read_b128 a[16:19], v17 offset:32768
v_mfma_f32_16x16x32_bf16 v[148:151], a[68:71], a[32:35], v[148:151]
buffer_load_dwordx4 v15, s[56:59], s64 offen lds
v_mfma_f32_16x16x32_bf16 v[152:155], a[72:75], a[20:23], v[152:155]
ds_read_b64_tr_b16 a[68:69], v11 offset:32768
v_mfma_f32_16x16x32_bf16 v[160:163], a[72:75], a[24:27], v[160:163]
ds_read_b64_tr_b16 a[70:71], v11 offset:33792
v_mfma_f32_16x16x32_bf16 v[168:171], a[72:75], a[28:31], v[168:171]
v_mfma_f32_16x16x32_bf16 v[176:179], a[72:75], a[32:35], v[176:179]
ds_read_b64_tr_b16 a[72:73], v19 offset:32768
v_mfma_f32_16x16x32_bf16 v[156:159], a[76:79], a[20:23], v[156:159]
s_add_u32 m0, s78, 81920
ds_read_b64_tr_b16 a[74:75], v19 offset:33024
v_mfma_f32_16x16x32_bf16 v[164:167], a[76:79], a[24:27], v[164:167]
s_add_u32 s64, s75, 3932160
v_mfma_f32_16x16x32_bf16 v[172:175], a[76:79], a[28:31], v[172:175]
buffer_load_dwordx4 v23, s[60:63], s64 offen lds
v_mfma_f32_16x16x32_bf16 v[180:183], a[76:79], a[32:35], v[180:183]
ds_read_b64_tr_b16 a[76:77], v20 offset:32768
v_mfma_f32_16x16x32_bf16 v[184:187], a[80:83], a[20:23], v[184:187]
ds_read_b64_tr_b16 a[78:79], v20 offset:33024
v_mfma_f32_16x16x32_bf16 v[192:195], a[80:83], a[24:27], v[192:195]
v_mfma_f32_16x16x32_bf16 v[200:203], a[80:83], a[28:31], v[200:203]
v_mfma_f32_16x16x32_bf16 v[208:211], a[80:83], a[32:35], v[208:211]
s_add_u32 m0, s78, 86016
ds_read_b64_tr_b16 a[80:81], v19 offset:36864
v_mfma_f32_16x16x32_bf16 v[188:191], a[84:87], a[20:23], v[188:191]
s_add_u32 s64, s75, 3934208
ds_read_b64_tr_b16 a[82:83], v19 offset:37120
v_mfma_f32_16x16x32_bf16 v[196:199], a[84:87], a[24:27], v[196:199]
buffer_load_dwordx4 v23, s[60:63], s64 offen lds
v_mfma_f32_16x16x32_bf16 v[204:207], a[84:87], a[28:31], v[204:207]
v_mfma_f32_16x16x32_bf16 v[212:215], a[84:87], a[32:35], v[212:215]
ds_read_b64_tr_b16 a[84:85], v20 offset:36864
v_mfma_f32_16x16x32_bf16 v[216:219], a[20:23], a[88:91], v[216:219]
ds_read_b64_tr_b16 a[86:87], v20 offset:37120
v_mfma_f32_16x16x32_bf16 v[224:227], a[24:27], a[88:91], v[224:227]
v_mfma_f32_16x16x32_bf16 v[232:235], a[28:31], a[88:91], v[232:235]
s_add_u32 m0, s78, 90112
v_mfma_f32_16x16x32_bf16 v[240:243], a[32:35], a[88:91], v[240:243]
s_add_u32 s64, s75, 3936256
ds_read_b64_tr_b16 a[88:89], v19 offset:40960
v_mfma_f32_16x16x32_bf16 v[220:223], a[20:23], a[92:95], v[220:223]
buffer_load_dwordx4 v23, s[60:63], s64 offen lds
v_mfma_f32_16x16x32_bf16 v[228:231], a[24:27], a[92:95], v[228:231]
ds_read_b64_tr_b16 a[90:91], v19 offset:41216
v_mfma_f32_16x16x32_bf16 v[236:239], a[28:31], a[92:95], v[236:239]
v_mfma_f32_16x16x32_bf16 v[244:247], a[32:35], a[92:95], v[244:247]
ds_read_b64_tr_b16 a[92:93], v20 offset:40960
v_mfma_f32_16x16x32_bf16 v[248:251], a[96:99], a[36:39], v[248:251]
ds_read_b64_tr_b16 a[94:95], v20 offset:41216
v_mfma_f32_16x16x32_bf16 v[252:255], a[36:39], a[100:103], v[252:255]
s_waitcnt lgkmcnt(5)
s_add_u32 m0, s78, 94208
ds_read_b64_tr_b16 a[96:97], v21 offset:36864
v_mfma_f32_16x16x32_bf16 v[24:27], a[40:43], a[0:3], v[24:27]
s_add_u32 s64, s74, 1280
ds_read_b128 a[20:23], v3 offset:32768
v_mfma_f32_16x16x32_bf16 v[40:43], a[40:43], a[4:7], v[40:43]
buffer_load_dwordx4 v22, s[48:51], s64 offen lds
v_mfma_f32_16x16x32_bf16 v[56:59], a[40:43], a[8:11], v[56:59]
ds_read_b128 a[24:27], v3 offset:34816
v_mfma_f32_16x16x32_bf16 v[72:75], a[40:43], a[12:15], v[72:75]
ds_read_b128 a[28:31], v3 offset:36864
v_mfma_f32_16x16x32_bf16 v[88:91], a[44:47], a[0:3], v[88:91]
ds_read_b128 a[32:35], v3 offset:38912
v_mfma_f32_16x16x32_bf16 v[104:107], a[44:47], a[4:7], v[104:107]
ds_read_b64_tr_b16 a[40:41], v4 offset:40960
v_mfma_f32_16x16x32_bf16 v[120:123], a[44:47], a[8:11], v[120:123]
ds_read_b64_tr_b16 a[42:43], v4 offset:41984
v_mfma_f32_16x16x32_bf16 v[136:139], a[44:47], a[12:15], v[136:139]
ds_read_b64_tr_b16 a[44:45], v5 offset:40960
v_mfma_f32_16x16x32_bf16 v[28:31], a[48:51], a[0:3], v[28:31]
ds_read_b64_tr_b16 a[46:47], v5 offset:41984
v_mfma_f32_16x16x32_bf16 v[44:47], a[48:51], a[4:7], v[44:47]
ds_read_b64_tr_b16 a[98:99], v21 offset:37120
v_mfma_f32_16x16x32_bf16 v[60:63], a[48:51], a[8:11], v[60:63]
ds_read_b64_tr_b16 a[100:101], v21 offset:40960
v_mfma_f32_16x16x32_bf16 v[76:79], a[48:51], a[12:15], v[76:79]
ds_read_b64_tr_b16 a[102:103], v21 offset:41216
v_mfma_f32_16x16x32_bf16 v[92:95], a[52:55], a[0:3], v[92:95]
ds_read_b64_tr_b16 a[48:49], v6 offset:40960
v_mfma_f32_16x16x32_bf16 v[108:111], a[52:55], a[4:7], v[108:111]
s_waitcnt lgkmcnt(8)
ds_read_b64_tr_b16 a[50:51], v6 offset:41984
v_mfma_f32_16x16x32_bf16 v[124:127], a[52:55], a[8:11], v[124:127]
s_add_u32 m0, s76, 32768
ds_read_b128 a[36:39], v18 offset:32768
v_mfma_f32_16x16x32_bf16 v[140:143], a[52:55], a[12:15], v[140:143]
s_add_u32 s64, s72, 1408
ds_read_b64_tr_b16 a[52:53], v7 offset:40960
v_mfma_f32_16x16x32_bf16 v[32:35], a[56:59], a[0:3], v[32:35]
buffer_load_dwordx4 v12, s[48:51], s64 offen lds
v_mfma_f32_16x16x32_bf16 v[48:51], a[56:59], a[4:7], v[48:51]
ds_read_b64_tr_b16 a[54:55], v7 offset:41984
v_mfma_f32_16x16x32_bf16 v[64:67], a[56:59], a[8:11], v[64:67]
v_mfma_f32_16x16x32_bf16 v[80:83], a[56:59], a[12:15], v[80:83]
s_add_u32 m0, s76, 33792
ds_read_b64_tr_b16 a[56:57], v8 offset:40960
v_mfma_f32_16x16x32_bf16 v[96:99], a[60:63], a[0:3], v[96:99]
s_add_u32 s64, s72, 17792
ds_read_b64_tr_b16 a[58:59], v8 offset:41984
v_mfma_f32_16x16x32_bf16 v[112:115], a[60:63], a[4:7], v[112:115]
buffer_load_dwordx4 v13, s[48:51], s64 offen lds
v_mfma_f32_16x16x32_bf16 v[128:131], a[60:63], a[8:11], v[128:131]
v_mfma_f32_16x16x32_bf16 v[144:147], a[60:63], a[12:15], v[144:147]
ds_read_b64_tr_b16 a[60:61], v9 offset:40960
v_mfma_f32_16x16x32_bf16 v[36:39], a[64:67], a[0:3], v[36:39]
ds_read_b64_tr_b16 a[62:63], v9 offset:41984
v_mfma_f32_16x16x32_bf16 v[52:55], a[64:67], a[4:7], v[52:55]
s_add_u32 m0, s76, 34816
v_mfma_f32_16x16x32_bf16 v[68:71], a[64:67], a[8:11], v[68:71]
s_add_u32 s64, s72, 132480
v_mfma_f32_16x16x32_bf16 v[84:87], a[64:67], a[12:15], v[84:87]
buffer_load_dwordx4 v12, s[48:51], s64 offen lds
v_mfma_f32_16x16x32_bf16 v[100:103], a[68:71], a[0:3], v[100:103]
ds_read_b64_tr_b16 a[64:65], v10 offset:40960
v_mfma_f32_16x16x32_bf16 v[116:119], a[68:71], a[4:7], v[116:119]
ds_read_b64_tr_b16 a[66:67], v10 offset:41984
v_mfma_f32_16x16x32_bf16 v[132:135], a[68:71], a[8:11], v[132:135]
v_mfma_f32_16x16x32_bf16 v[148:151], a[68:71], a[12:15], v[148:151]
s_add_u32 m0, s76, 35840
ds_read_b64_tr_b16 a[68:69], v11 offset:40960
v_mfma_f32_16x16x32_bf16 v[152:155], a[72:75], a[0:3], v[152:155]
s_add_u32 s64, s72, 148864
ds_read_b64_tr_b16 a[70:71], v11 offset:41984
v_mfma_f32_16x16x32_bf16 v[160:163], a[72:75], a[4:7], v[160:163]
buffer_load_dwordx4 v13, s[48:51], s64 offen lds
v_mfma_f32_16x16x32_bf16 v[168:171], a[72:75], a[8:11], v[168:171]
v_mfma_f32_16x16x32_bf16 v[176:179], a[72:75], a[12:15], v[176:179]
ds_read_b64_tr_b16 a[72:73], v19 offset:34816
v_mfma_f32_16x16x32_bf16 v[156:159], a[76:79], a[0:3], v[156:159]
ds_read_b64_tr_b16 a[74:75], v19 offset:35072
v_mfma_f32_16x16x32_bf16 v[164:167], a[76:79], a[4:7], v[164:167]
s_add_u32 m0, s76, 36864
v_mfma_f32_16x16x32_bf16 v[172:175], a[76:79], a[8:11], v[172:175]
s_add_u32 s64, s73, 1408
v_mfma_f32_16x16x32_bf16 v[180:183], a[76:79], a[12:15], v[180:183]
buffer_load_dwordx4 v12, s[48:51], s64 offen lds
v_mfma_f32_16x16x32_bf16 v[184:187], a[80:83], a[0:3], v[184:187]
ds_read_b64_tr_b16 a[76:77], v20 offset:34816
v_mfma_f32_16x16x32_bf16 v[192:195], a[80:83], a[4:7], v[192:195]
ds_read_b64_tr_b16 a[78:79], v20 offset:35072
v_mfma_f32_16x16x32_bf16 v[200:203], a[80:83], a[8:11], v[200:203]
v_mfma_f32_16x16x32_bf16 v[208:211], a[80:83], a[12:15], v[208:211]
s_add_u32 m0, s76, 37888
ds_read_b64_tr_b16 a[80:81], v19 offset:38912
v_mfma_f32_16x16x32_bf16 v[188:191], a[84:87], a[0:3], v[188:191]
s_add_u32 s64, s73, 17792
ds_read_b64_tr_b16 a[82:83], v19 offset:39168
v_mfma_f32_16x16x32_bf16 v[196:199], a[84:87], a[4:7], v[196:199]
buffer_load_dwordx4 v13, s[48:51], s64 offen lds
v_mfma_f32_16x16x32_bf16 v[204:207], a[84:87], a[8:11], v[204:207]
v_mfma_f32_16x16x32_bf16 v[212:215], a[84:87], a[12:15], v[212:215]
ds_read_b64_tr_b16 a[84:85], v20 offset:38912
v_mfma_f32_16x16x32_bf16 v[216:219], a[0:3], a[88:91], v[216:219]
ds_read_b64_tr_b16 a[86:87], v20 offset:39168
v_mfma_f32_16x16x32_bf16 v[224:227], a[4:7], a[88:91], v[224:227]
s_add_u32 m0, s76, 38912
v_mfma_f32_16x16x32_bf16 v[232:235], a[8:11], a[88:91], v[232:235]
s_add_u32 s64, s73, 132480
v_mfma_f32_16x16x32_bf16 v[240:243], a[12:15], a[88:91], v[240:243]
buffer_load_dwordx4 v12, s[48:51], s64 offen lds
v_mfma_f32_16x16x32_bf16 v[220:223], a[0:3], a[92:95], v[220:223]
ds_read_b64_tr_b16 a[88:89], v19 offset:43008
v_mfma_f32_16x16x32_bf16 v[228:231], a[4:7], a[92:95], v[228:231]
ds_read_b64_tr_b16 a[90:91], v19 offset:43264
v_mfma_f32_16x16x32_bf16 v[236:239], a[8:11], a[92:95], v[236:239]
v_mfma_f32_16x16x32_bf16 v[244:247], a[12:15], a[92:95], v[244:247]
s_waitcnt lgkmcnt(4)
ds_read_b64_tr_b16 a[92:93], v20 offset:43008
v_mfma_f32_16x16x32_bf16 v[248:251], a[96:99], a[16:19], v[248:251]
ds_read_b64_tr_b16 a[94:95], v20 offset:43264
v_mfma_f32_16x16x32_bf16 v[252:255], a[16:19], a[100:103], v[252:255]
ds_read_b64_tr_b16 a[96:97], v21 offset:38912
v_mfma_f32_16x16x32_bf16 v[24:27], a[40:43], a[20:23], v[24:27]
ds_read_b64_tr_b16 a[98:99], v21 offset:39168
v_mfma_f32_16x16x32_bf16 v[40:43], a[40:43], a[24:27], v[40:43]
s_add_u32 m0, s76, 39936
ds_read_b64_tr_b16 a[100:101], v21 offset:43008
v_mfma_f32_16x16x32_bf16 v[56:59], a[40:43], a[28:31], v[56:59]
s_add_u32 s64, s73, 148864
ds_read_b64_tr_b16 a[102:103], v21 offset:43264
v_mfma_f32_16x16x32_bf16 v[72:75], a[40:43], a[32:35], v[72:75]
buffer_load_dwordx4 v13, s[48:51], s64 offen lds
v_mfma_f32_16x16x32_bf16 v[88:91], a[44:47], a[20:23], v[88:91]
v_mfma_f32_16x16x32_bf16 v[104:107], a[44:47], a[24:27], v[104:107]
v_mfma_f32_16x16x32_bf16 v[120:123], a[44:47], a[28:31], v[120:123]
v_mfma_f32_16x16x32_bf16 v[136:139], a[44:47], a[32:35], v[136:139]
v_mfma_f32_16x16x32_bf16 v[28:31], a[48:51], a[20:23], v[28:31]
s_waitcnt vmcnt(8) lgkmcnt(0)
s_barrier
v_mfma_f32_16x16x32_bf16 v[44:47], a[48:51], a[24:27], v[44:47]
s_lshl_b32 s66, s30, 30
s_add_u32 m0, s77, 98304
ds_read_b64_tr_b16 a[40:41], v4 offset:0
v_mfma_f32_16x16x32_bf16 v[60:63], a[48:51], a[28:31], v[60:63]
s_add_u32 s64, s71, 5767168
ds_read_b64_tr_b16 a[42:43], v4 offset:1024
v_lshl_add_u32 v1, v0, 24, s66
v_mfma_f32_16x16x32_bf16 v[76:79], a[48:51], a[32:35], v[76:79]
buffer_load_dwordx4 v14, s[56:59], s64 offen lds
v_mfma_f32_16x16x32_bf16 v[92:95], a[52:55], a[20:23], v[92:95]
buffer_atomic_add a251, v1, s[52:55], 0 offen offset:0 sc1
v_mfma_f32_16x16x32_bf16 v[108:111], a[52:55], a[24:27], v[108:111]
ds_read_b64_tr_b16 a[44:45], v5 offset:0
v_mfma_f32_16x16x32_bf16 v[124:127], a[52:55], a[28:31], v[124:127]
ds_read_b64_tr_b16 a[46:47], v5 offset:1024
v_mfma_f32_16x16x32_bf16 v[140:143], a[52:55], a[32:35], v[140:143]
s_add_u32 m0, s77, 99328
ds_read_b64_tr_b16 a[48:49], v6 offset:0
v_mfma_f32_16x16x32_bf16 v[32:35], a[56:59], a[20:23], v[32:35]
s_add_u32 s64, s71, 5799936
ds_read_b64_tr_b16 a[50:51], v6 offset:1024
v_mfma_f32_16x16x32_bf16 v[48:51], a[56:59], a[24:27], v[48:51]
buffer_load_dwordx4 v14, s[56:59], s64 offen lds
v_mfma_f32_16x16x32_bf16 v[64:67], a[56:59], a[28:31], v[64:67]
ds_read_b64_tr_b16 a[52:53], v7 offset:0
v_mfma_f32_16x16x32_bf16 v[80:83], a[56:59], a[32:35], v[80:83]
ds_read_b64_tr_b16 a[54:55], v7 offset:1024
v_mfma_f32_16x16x32_bf16 v[96:99], a[60:63], a[20:23], v[96:99]
ds_read_b64_tr_b16 a[56:57], v8 offset:0
v_mfma_f32_16x16x32_bf16 v[112:115], a[60:63], a[24:27], v[112:115]
ds_read_b64_tr_b16 a[58:59], v8 offset:1024
v_mfma_f32_16x16x32_bf16 v[128:131], a[60:63], a[28:31], v[128:131]
s_add_u32 m0, s77, 100352
ds_read_b128 a[0:3], v2 offset:0
v_mfma_f32_16x16x32_bf16 v[144:147], a[60:63], a[32:35], v[144:147]
s_add_u32 s64, s71, 5832704
ds_read_b64_tr_b16 a[60:61], v9 offset:0
v_mfma_f32_16x16x32_bf16 v[36:39], a[64:67], a[20:23], v[36:39]
buffer_load_dwordx4 v15, s[56:59], s64 offen lds
v_mfma_f32_16x16x32_bf16 v[52:55], a[64:67], a[24:27], v[52:55]
ds_read_b64_tr_b16 a[62:63], v9 offset:1024
v_mfma_f32_16x16x32_bf16 v[68:71], a[64:67], a[28:31], v[68:71]
ds_read_b128 a[4:7], v2 offset:2048
v_mfma_f32_16x16x32_bf16 v[84:87], a[64:67], a[32:35], v[84:87]
ds_read_b128 a[8:11], v2 offset:4096
v_mfma_f32_16x16x32_bf16 v[100:103], a[68:71], a[20:23], v[100:103]
ds_read_b128 a[12:15], v2 offset:6144
v_mfma_f32_16x16x32_bf16 v[116:119], a[68:71], a[24:27], v[116:119]
s_add_u32 m0, s77, 101376
ds_read_b64_tr_b16 a[64:65], v10 offset:0
v_mfma_f32_16x16x32_bf16 v[132:135], a[68:71], a[28:31], v[132:135]
s_add_u32 s64, s71, 5865472
ds_read_b64_tr_b16 a[66:67], v10 offset:1024
v_mfma_f32_16x16x32_bf16 v[148:151], a[68:71], a[32:35], v[148:151]
buffer_load_dwordx4 v15, s[56:59], s64 offen lds
v_mfma_f32_16x16x32_bf16 v[152:155], a[72:75], a[20:23], v[152:155]
ds_read_b64_tr_b16 a[68:69], v11 offset:0
v_mfma_f32_16x16x32_bf16 v[160:163], a[72:75], a[24:27], v[160:163]
ds_read_b64_tr_b16 a[70:71], v11 offset:1024
v_mfma_f32_16x16x32_bf16 v[168:171], a[72:75], a[28:31], v[168:171]
ds_read_b128 a[16:19], v17 offset:0
v_mfma_f32_16x16x32_bf16 v[176:179], a[72:75], a[32:35], v[176:179]
ds_read_b64_tr_b16 a[72:73], v19 offset:0
v_mfma_f32_16x16x32_bf16 v[156:159], a[76:79], a[20:23], v[156:159]
s_add_u32 m0, s78, 114688
ds_read_b64_tr_b16 a[74:75], v19 offset:256
v_mfma_f32_16x16x32_bf16 v[164:167], a[76:79], a[24:27], v[164:167]
s_add_u32 s64, s75, 4325376
v_mfma_f32_16x16x32_bf16 v[172:175], a[76:79], a[28:31], v[172:175]
buffer_load_dwordx4 v23, s[60:63], s64 offen lds
v_mfma_f32_16x16x32_bf16 v[180:183], a[76:79], a[32:35], v[180:183]
ds_read_b64_tr_b16 a[76:77], v20 offset:0
v_mfma_f32_16x16x32_bf16 v[184:187], a[80:83], a[20:23], v[184:187]
ds_read_b64_tr_b16 a[78:79], v20 offset:256
v_mfma_f32_16x16x32_bf16 v[192:195], a[80:83], a[24:27], v[192:195]
v_mfma_f32_16x16x32_bf16 v[200:203], a[80:83], a[28:31], v[200:203]
v_mfma_f32_16x16x32_bf16 v[208:211], a[80:83], a[32:35], v[208:211]
s_add_u32 m0, s78, 118784
ds_read_b64_tr_b16 a[80:81], v19 offset:4096
v_mfma_f32_16x16x32_bf16 v[188:191], a[84:87], a[20:23], v[188:191]
s_add_u32 s64, s75, 4327424
ds_read_b64_tr_b16 a[82:83], v19 offset:4352
v_mfma_f32_16x16x32_bf16 v[196:199], a[84:87], a[24:27], v[196:199]
buffer_load_dwordx4 v23, s[60:63], s64 offen lds
v_mfma_f32_16x16x32_bf16 v[204:207], a[84:87], a[28:31], v[204:207]
v_mfma_f32_16x16x32_bf16 v[212:215], a[84:87], a[32:35], v[212:215]
ds_read_b64_tr_b16 a[84:85], v20 offset:4096
v_mfma_f32_16x16x32_bf16 v[216:219], a[20:23], a[88:91], v[216:219]
ds_read_b64_tr_b16 a[86:87], v20 offset:4352
v_mfma_f32_16x16x32_bf16 v[224:227], a[24:27], a[88:91], v[224:227]
v_mfma_f32_16x16x32_bf16 v[232:235], a[28:31], a[88:91], v[232:235]
s_add_u32 m0, s78, 122880
v_mfma_f32_16x16x32_bf16 v[240:243], a[32:35], a[88:91], v[240:243]
s_add_u32 s64, s75, 4329472
ds_read_b64_tr_b16 a[88:89], v19 offset:8192
v_mfma_f32_16x16x32_bf16 v[220:223], a[20:23], a[92:95], v[220:223]
buffer_load_dwordx4 v23, s[60:63], s64 offen lds
v_mfma_f32_16x16x32_bf16 v[228:231], a[24:27], a[92:95], v[228:231]
ds_read_b64_tr_b16 a[90:91], v19 offset:8448
v_mfma_f32_16x16x32_bf16 v[236:239], a[28:31], a[92:95], v[236:239]
v_mfma_f32_16x16x32_bf16 v[244:247], a[32:35], a[92:95], v[244:247]
ds_read_b64_tr_b16 a[92:93], v20 offset:8192
v_mfma_f32_16x16x32_bf16 v[248:251], a[96:99], a[36:39], v[248:251]
ds_read_b64_tr_b16 a[94:95], v20 offset:8448
v_mfma_f32_16x16x32_bf16 v[252:255], a[36:39], a[100:103], v[252:255]
s_waitcnt lgkmcnt(5)
s_add_u32 m0, s78, 126976
ds_read_b64_tr_b16 a[96:97], v21 offset:4096
v_mfma_f32_16x16x32_bf16 v[24:27], a[40:43], a[0:3], v[24:27]
s_add_u32 s64, s74, 1408
ds_read_b128 a[20:23], v3 offset:0
v_mfma_f32_16x16x32_bf16 v[40:43], a[40:43], a[4:7], v[40:43]
buffer_load_dwordx4 v22, s[48:51], s64 offen lds
v_mfma_f32_16x16x32_bf16 v[56:59], a[40:43], a[8:11], v[56:59]
ds_read_b128 a[24:27], v3 offset:2048
v_mfma_f32_16x16x32_bf16 v[72:75], a[40:43], a[12:15], v[72:75]
ds_read_b128 a[28:31], v3 offset:4096
v_mfma_f32_16x16x32_bf16 v[88:91], a[44:47], a[0:3], v[88:91]
ds_read_b128 a[32:35], v3 offset:6144
v_mfma_f32_16x16x32_bf16 v[104:107], a[44:47], a[4:7], v[104:107]
ds_read_b64_tr_b16 a[40:41], v4 offset:8192
v_mfma_f32_16x16x32_bf16 v[120:123], a[44:47], a[8:11], v[120:123]
ds_read_b64_tr_b16 a[42:43], v4 offset:9216
v_mfma_f32_16x16x32_bf16 v[136:139], a[44:47], a[12:15], v[136:139]
ds_read_b64_tr_b16 a[44:45], v5 offset:8192
v_mfma_f32_16x16x32_bf16 v[28:31], a[48:51], a[0:3], v[28:31]
ds_read_b64_tr_b16 a[46:47], v5 offset:9216
v_mfma_f32_16x16x32_bf16 v[44:47], a[48:51], a[4:7], v[44:47]
ds_read_b64_tr_b16 a[98:99], v21 offset:4352
v_mfma_f32_16x16x32_bf16 v[60:63], a[48:51], a[8:11], v[60:63]
ds_read_b64_tr_b16 a[100:101], v21 offset:8192
v_mfma_f32_16x16x32_bf16 v[76:79], a[48:51], a[12:15], v[76:79]
ds_read_b64_tr_b16 a[102:103], v21 offset:8448
v_mfma_f32_16x16x32_bf16 v[92:95], a[52:55], a[0:3], v[92:95]
ds_read_b64_tr_b16 a[48:49], v6 offset:8192
v_mfma_f32_16x16x32_bf16 v[108:111], a[52:55], a[4:7], v[108:111]
s_waitcnt lgkmcnt(8)
ds_read_b64_tr_b16 a[50:51], v6 offset:9216
v_mfma_f32_16x16x32_bf16 v[124:127], a[52:55], a[8:11], v[124:127]
s_add_u32 m0, s76, 0
ds_read_b128 a[36:39], v18 offset:0
v_mfma_f32_16x16x32_bf16 v[140:143], a[52:55], a[12:15], v[140:143]
s_add_u32 s64, s72, 1536
ds_read_b64_tr_b16 a[52:53], v7 offset:8192
v_mfma_f32_16x16x32_bf16 v[32:35], a[56:59], a[0:3], v[32:35]
buffer_load_dwordx4 v12, s[48:51], s64 offen lds
v_mfma_f32_16x16x32_bf16 v[48:51], a[56:59], a[4:7], v[48:51]
ds_read_b64_tr_b16 a[54:55], v7 offset:9216
v_mfma_f32_16x16x32_bf16 v[64:67], a[56:59], a[8:11], v[64:67]
v_mfma_f32_16x16x32_bf16 v[80:83], a[56:59], a[12:15], v[80:83]
s_add_u32 m0, s76, 1024
ds_read_b64_tr_b16 a[56:57], v8 offset:8192
v_mfma_f32_16x16x32_bf16 v[96:99], a[60:63], a[0:3], v[96:99]
s_add_u32 s64, s72, 17920
ds_read_b64_tr_b16 a[58:59], v8 offset:9216
v_mfma_f32_16x16x32_bf16 v[112:115], a[60:63], a[4:7], v[112:115]
buffer_load_dwordx4 v13, s[48:51], s64 offen lds
v_mfma_f32_16x16x32_bf16 v[128:131], a[60:63], a[8:11], v[128:131]
v_mfma_f32_16x16x32_bf16 v[144:147], a[60:63], a[12:15], v[144:147]
ds_read_b64_tr_b16 a[60:61], v9 offset:8192
v_mfma_f32_16x16x32_bf16 v[36:39], a[64:67], a[0:3], v[36:39]
ds_read_b64_tr_b16 a[62:63], v9 offset:9216
v_mfma_f32_16x16x32_bf16 v[52:55], a[64:67], a[4:7], v[52:55]
s_add_u32 m0, s76, 2048
v_mfma_f32_16x16x32_bf16 v[68:71], a[64:67], a[8:11], v[68:71]
s_add_u32 s64, s72, 132608
v_mfma_f32_16x16x32_bf16 v[84:87], a[64:67], a[12:15], v[84:87]
buffer_load_dwordx4 v12, s[48:51], s64 offen lds
v_mfma_f32_16x16x32_bf16 v[100:103], a[68:71], a[0:3], v[100:103]
ds_read_b64_tr_b16 a[64:65], v10 offset:8192
v_mfma_f32_16x16x32_bf16 v[116:119], a[68:71], a[4:7], v[116:119]
ds_read_b64_tr_b16 a[66:67], v10 offset:9216
v_mfma_f32_16x16x32_bf16 v[132:135], a[68:71], a[8:11], v[132:135]
v_mfma_f32_16x16x32_bf16 v[148:151], a[68:71], a[12:15], v[148:151]
s_add_u32 m0, s76, 3072
ds_read_b64_tr_b16 a[68:69], v11 offset:8192
v_mfma_f32_16x16x32_bf16 v[152:155], a[72:75], a[0:3], v[152:155]
s_add_u32 s64, s72, 148992
ds_read_b64_tr_b16 a[70:71], v11 offset:9216
v_mfma_f32_16x16x32_bf16 v[160:163], a[72:75], a[4:7], v[160:163]
buffer_load_dwordx4 v13, s[48:51], s64 offen lds
v_mfma_f32_16x16x32_bf16 v[168:171], a[72:75], a[8:11], v[168:171]
v_mfma_f32_16x16x32_bf16 v[176:179], a[72:75], a[12:15], v[176:179]
ds_read_b64_tr_b16 a[72:73], v19 offset:2048
v_mfma_f32_16x16x32_bf16 v[156:159], a[76:79], a[0:3], v[156:159]
ds_read_b64_tr_b16 a[74:75], v19 offset:2304
v_mfma_f32_16x16x32_bf16 v[164:167], a[76:79], a[4:7], v[164:167]
s_add_u32 m0, s76, 4096
v_mfma_f32_16x16x32_bf16 v[172:175], a[76:79], a[8:11], v[172:175]
s_add_u32 s64, s73, 1536
v_mfma_f32_16x16x32_bf16 v[180:183], a[76:79], a[12:15], v[180:183]
buffer_load_dwordx4 v12, s[48:51], s64 offen lds
v_mfma_f32_16x16x32_bf16 v[184:187], a[80:83], a[0:3], v[184:187]
ds_read_b64_tr_b16 a[76:77], v20 offset:2048
v_mfma_f32_16x16x32_bf16 v[192:195], a[80:83], a[4:7], v[192:195]
ds_read_b64_tr_b16 a[78:79], v20 offset:2304
v_mfma_f32_16x16x32_bf16 v[200:203], a[80:83], a[8:11], v[200:203]
v_mfma_f32_16x16x32_bf16 v[208:211], a[80:83], a[12:15], v[208:211]
s_add_u32 m0, s76, 5120
ds_read_b64_tr_b16 a[80:81], v19 offset:6144
v_mfma_f32_16x16x32_bf16 v[188:191], a[84:87], a[0:3], v[188:191]
s_add_u32 s64, s73, 17920
ds_read_b64_tr_b16 a[82:83], v19 offset:6400
v_mfma_f32_16x16x32_bf16 v[196:199], a[84:87], a[4:7], v[196:199]
buffer_load_dwordx4 v13, s[48:51], s64 offen lds
v_mfma_f32_16x16x32_bf16 v[204:207], a[84:87], a[8:11], v[204:207]
v_mfma_f32_16x16x32_bf16 v[212:215], a[84:87], a[12:15], v[212:215]
ds_read_b64_tr_b16 a[84:85], v20 offset:6144
v_mfma_f32_16x16x32_bf16 v[216:219], a[0:3], a[88:91], v[216:219]
ds_read_b64_tr_b16 a[86:87], v20 offset:6400
v_mfma_f32_16x16x32_bf16 v[224:227], a[4:7], a[88:91], v[224:227]
s_add_u32 m0, s76, 6144
v_mfma_f32_16x16x32_bf16 v[232:235], a[8:11], a[88:91], v[232:235]
s_add_u32 s64, s73, 132608
v_mfma_f32_16x16x32_bf16 v[240:243], a[12:15], a[88:91], v[240:243]
buffer_load_dwordx4 v12, s[48:51], s64 offen lds
v_mfma_f32_16x16x32_bf16 v[220:223], a[0:3], a[92:95], v[220:223]
ds_read_b64_tr_b16 a[88:89], v19 offset:10240
v_mfma_f32_16x16x32_bf16 v[228:231], a[4:7], a[92:95], v[228:231]
ds_read_b64_tr_b16 a[90:91], v19 offset:10496
v_mfma_f32_16x16x32_bf16 v[236:239], a[8:11], a[92:95], v[236:239]
v_mfma_f32_16x16x32_bf16 v[244:247], a[12:15], a[92:95], v[244:247]
s_waitcnt lgkmcnt(4)
ds_read_b64_tr_b16 a[92:93], v20 offset:10240
v_mfma_f32_16x16x32_bf16 v[248:251], a[96:99], a[16:19], v[248:251]
ds_read_b64_tr_b16 a[94:95], v20 offset:10496
v_mfma_f32_16x16x32_bf16 v[252:255], a[16:19], a[100:103], v[252:255]
ds_read_b64_tr_b16 a[96:97], v21 offset:6144
v_mfma_f32_16x16x32_bf16 v[24:27], a[40:43], a[20:23], v[24:27]
ds_read_b64_tr_b16 a[98:99], v21 offset:6400
v_mfma_f32_16x16x32_bf16 v[40:43], a[40:43], a[24:27], v[40:43]
s_add_u32 m0, s76, 7168
ds_read_b64_tr_b16 a[100:101], v21 offset:10240
v_mfma_f32_16x16x32_bf16 v[56:59], a[40:43], a[28:31], v[56:59]
s_add_u32 s64, s73, 148992
ds_read_b64_tr_b16 a[102:103], v21 offset:10496
v_mfma_f32_16x16x32_bf16 v[72:75], a[40:43], a[32:35], v[72:75]
buffer_load_dwordx4 v13, s[48:51], s64 offen lds
v_mfma_f32_16x16x32_bf16 v[88:91], a[44:47], a[20:23], v[88:91]
v_mfma_f32_16x16x32_bf16 v[104:107], a[44:47], a[24:27], v[104:107]
v_mfma_f32_16x16x32_bf16 v[120:123], a[44:47], a[28:31], v[120:123]
v_mfma_f32_16x16x32_bf16 v[136:139], a[44:47], a[32:35], v[136:139]
v_mfma_f32_16x16x32_bf16 v[28:31], a[48:51], a[20:23], v[28:31]
s_waitcnt vmcnt(8) lgkmcnt(0)
s_barrier
v_mfma_f32_16x16x32_bf16 v[44:47], a[48:51], a[24:27], v[44:47]
s_add_u32 m0, s77, 65536
ds_read_b64_tr_b16 a[40:41], v4 offset:32768
v_mfma_f32_16x16x32_bf16 v[60:63], a[48:51], a[28:31], v[60:63]
s_add_u32 s64, s71, 6291456
ds_read_b64_tr_b16 a[42:43], v4 offset:33792
v_mfma_f32_16x16x32_bf16 v[76:79], a[48:51], a[32:35], v[76:79]
buffer_load_dwordx4 v14, s[56:59], s64 offen lds
v_mfma_f32_16x16x32_bf16 v[92:95], a[52:55], a[20:23], v[92:95]
ds_read_b64_tr_b16 a[44:45], v5 offset:32768
v_mfma_f32_16x16x32_bf16 v[108:111], a[52:55], a[24:27], v[108:111]
ds_read_b64_tr_b16 a[46:47], v5 offset:33792
v_mfma_f32_16x16x32_bf16 v[124:127], a[52:55], a[28:31], v[124:127]
ds_read_b64_tr_b16 a[48:49], v6 offset:32768
v_mfma_f32_16x16x32_bf16 v[140:143], a[52:55], a[32:35], v[140:143]
s_add_u32 m0, s77, 66560
ds_read_b64_tr_b16 a[50:51], v6 offset:33792
v_mfma_f32_16x16x32_bf16 v[32:35], a[56:59], a[20:23], v[32:35]
s_add_u32 s64, s71, 6324224
ds_read_b64_tr_b16 a[52:53], v7 offset:32768
v_mfma_f32_16x16x32_bf16 v[48:51], a[56:59], a[24:27], v[48:51]
buffer_load_dwordx4 v14, s[56:59], s64 offen lds
v_mfma_f32_16x16x32_bf16 v[64:67], a[56:59], a[28:31], v[64:67]
ds_read_b64_tr_b16 a[54:55], v7 offset:33792
v_mfma_f32_16x16x32_bf16 v[80:83], a[56:59], a[32:35], v[80:83]
ds_read_b64_tr_b16 a[56:57], v8 offset:32768
v_mfma_f32_16x16x32_bf16 v[96:99], a[60:63], a[20:23], v[96:99]
ds_read_b64_tr_b16 a[58:59], v8 offset:33792
v_mfma_f32_16x16x32_bf16 v[112:115], a[60:63], a[24:27], v[112:115]
ds_read_b128 a[0:3], v2 offset:32768
v_mfma_f32_16x16x32_bf16 v[128:131], a[60:63], a[28:31], v[128:131]
s_add_u32 m0, s77, 67584
ds_read_b128 a[4:7], v2 offset:34816
v_mfma_f32_16x16x32_bf16 v[144:147], a[60:63], a[32:35], v[144:147]
s_add_u32 s64, s71, 6356992
ds_read_b64_tr_b16 a[60:61], v9 offset:32768
v_mfma_f32_16x16x32_bf16 v[36:39], a[64:67], a[20:23], v[36:39]
buffer_load_dwordx4 v15, s[56:59], s64 offen lds
v_mfma_f32_16x16x32_bf16 v[52:55], a[64:67], a[24:27], v[52:55]
ds_read_b64_tr_b16 a[62:63], v9 offset:33792
v_mfma_f32_16x16x32_bf16 v[68:71], a[64:67], a[28:31], v[68:71]
ds_read_b128 a[8:11], v2 offset:36864
v_mfma_f32_16x16x32_bf16 v[84:87], a[64:67], a[32:35], v[84:87]
ds_read_b128 a[12:15], v2 offset:38912
v_mfma_f32_16x16x32_bf16 v[100:103], a[68:71], a[20:23], v[100:103]
ds_read_b64_tr_b16 a[64:65], v10 offset:32768
v_mfma_f32_16x16x32_bf16 v[116:119], a[68:71], a[24:27], v[116:119]
s_add_u32 m0, s77, 68608
ds_read_b64_tr_b16 a[66:67], v10 offset:33792
v_mfma_f32_16x16x32_bf16 v[132:135], a[68:71], a[28:31], v[132:135]
s_add_u32 s64, s71, 6389760
ds_read_b128 a[16:19], v17 offset:32768
v_mfma_f32_16x16x32_bf16 v[148:151], a[68:71], a[32:35], v[148:151]
buffer_load_dwordx4 v15, s[56:59], s64 offen lds
v_mfma_f32_16x16x32_bf16 v[152:155], a[72:75], a[20:23], v[152:155]
ds_read_b64_tr_b16 a[68:69], v11 offset:32768
v_mfma_f32_16x16x32_bf16 v[160:163], a[72:75], a[24:27], v[160:163]
ds_read_b64_tr_b16 a[70:71], v11 offset:33792
v_mfma_f32_16x16x32_bf16 v[168:171], a[72:75], a[28:31], v[168:171]
v_mfma_f32_16x16x32_bf16 v[176:179], a[72:75], a[32:35], v[176:179]
ds_read_b64_tr_b16 a[72:73], v19 offset:32768
v_mfma_f32_16x16x32_bf16 v[156:159], a[76:79], a[20:23], v[156:159]
s_add_u32 m0, s78, 81920
ds_read_b64_tr_b16 a[74:75], v19 offset:33024
v_mfma_f32_16x16x32_bf16 v[164:167], a[76:79], a[24:27], v[164:167]
s_add_u32 s64, s75, 4718592
v_mfma_f32_16x16x32_bf16 v[172:175], a[76:79], a[28:31], v[172:175]
buffer_load_dwordx4 v23, s[60:63], s64 offen lds
v_mfma_f32_16x16x32_bf16 v[180:183], a[76:79], a[32:35], v[180:183]
ds_read_b64_tr_b16 a[76:77], v20 offset:32768
v_mfma_f32_16x16x32_bf16 v[184:187], a[80:83], a[20:23], v[184:187]
ds_read_b64_tr_b16 a[78:79], v20 offset:33024
v_mfma_f32_16x16x32_bf16 v[192:195], a[80:83], a[24:27], v[192:195]
v_mfma_f32_16x16x32_bf16 v[200:203], a[80:83], a[28:31], v[200:203]
v_mfma_f32_16x16x32_bf16 v[208:211], a[80:83], a[32:35], v[208:211]
s_add_u32 m0, s78, 86016
ds_read_b64_tr_b16 a[80:81], v19 offset:36864
v_mfma_f32_16x16x32_bf16 v[188:191], a[84:87], a[20:23], v[188:191]
s_add_u32 s64, s75, 4720640
ds_read_b64_tr_b16 a[82:83], v19 offset:37120
v_mfma_f32_16x16x32_bf16 v[196:199], a[84:87], a[24:27], v[196:199]
buffer_load_dwordx4 v23, s[60:63], s64 offen lds
v_mfma_f32_16x16x32_bf16 v[204:207], a[84:87], a[28:31], v[204:207]
v_mfma_f32_16x16x32_bf16 v[212:215], a[84:87], a[32:35], v[212:215]
ds_read_b64_tr_b16 a[84:85], v20 offset:36864
v_mfma_f32_16x16x32_bf16 v[216:219], a[20:23], a[88:91], v[216:219]
ds_read_b64_tr_b16 a[86:87], v20 offset:37120
v_mfma_f32_16x16x32_bf16 v[224:227], a[24:27], a[88:91], v[224:227]
v_mfma_f32_16x16x32_bf16 v[232:235], a[28:31], a[88:91], v[232:235]
s_add_u32 m0, s78, 90112
v_mfma_f32_16x16x32_bf16 v[240:243], a[32:35], a[88:91], v[240:243]
s_add_u32 s64, s75, 4722688
ds_read_b64_tr_b16 a[88:89], v19 offset:40960
v_mfma_f32_16x16x32_bf16 v[220:223], a[20:23], a[92:95], v[220:223]
buffer_load_dwordx4 v23, s[60:63], s64 offen lds
v_mfma_f32_16x16x32_bf16 v[228:231], a[24:27], a[92:95], v[228:231]
ds_read_b64_tr_b16 a[90:91], v19 offset:41216
v_mfma_f32_16x16x32_bf16 v[236:239], a[28:31], a[92:95], v[236:239]
v_mfma_f32_16x16x32_bf16 v[244:247], a[32:35], a[92:95], v[244:247]
ds_read_b64_tr_b16 a[92:93], v20 offset:40960
v_mfma_f32_16x16x32_bf16 v[248:251], a[96:99], a[36:39], v[248:251]
ds_read_b64_tr_b16 a[94:95], v20 offset:41216
v_mfma_f32_16x16x32_bf16 v[252:255], a[36:39], a[100:103], v[252:255]
s_waitcnt lgkmcnt(5)
s_add_u32 m0, s78, 94208
ds_read_b64_tr_b16 a[96:97], v21 offset:36864
v_mfma_f32_16x16x32_bf16 v[24:27], a[40:43], a[0:3], v[24:27]
s_add_u32 s64, s74, 1536
ds_read_b128 a[20:23], v3 offset:32768
v_mfma_f32_16x16x32_bf16 v[40:43], a[40:43], a[4:7], v[40:43]
buffer_load_dwordx4 v22, s[48:51], s64 offen lds
v_mfma_f32_16x16x32_bf16 v[56:59], a[40:43], a[8:11], v[56:59]
ds_read_b128 a[24:27], v3 offset:34816
v_mfma_f32_16x16x32_bf16 v[72:75], a[40:43], a[12:15], v[72:75]
ds_read_b128 a[28:31], v3 offset:36864
v_mfma_f32_16x16x32_bf16 v[88:91], a[44:47], a[0:3], v[88:91]
ds_read_b128 a[32:35], v3 offset:38912
v_mfma_f32_16x16x32_bf16 v[104:107], a[44:47], a[4:7], v[104:107]
ds_read_b64_tr_b16 a[40:41], v4 offset:40960
v_mfma_f32_16x16x32_bf16 v[120:123], a[44:47], a[8:11], v[120:123]
ds_read_b64_tr_b16 a[42:43], v4 offset:41984
v_mfma_f32_16x16x32_bf16 v[136:139], a[44:47], a[12:15], v[136:139]
ds_read_b64_tr_b16 a[44:45], v5 offset:40960
v_mfma_f32_16x16x32_bf16 v[28:31], a[48:51], a[0:3], v[28:31]
ds_read_b64_tr_b16 a[46:47], v5 offset:41984
v_mfma_f32_16x16x32_bf16 v[44:47], a[48:51], a[4:7], v[44:47]
ds_read_b64_tr_b16 a[98:99], v21 offset:37120
v_mfma_f32_16x16x32_bf16 v[60:63], a[48:51], a[8:11], v[60:63]
ds_read_b64_tr_b16 a[100:101], v21 offset:40960
v_mfma_f32_16x16x32_bf16 v[76:79], a[48:51], a[12:15], v[76:79]
ds_read_b64_tr_b16 a[102:103], v21 offset:41216
v_mfma_f32_16x16x32_bf16 v[92:95], a[52:55], a[0:3], v[92:95]
ds_read_b64_tr_b16 a[48:49], v6 offset:40960
v_mfma_f32_16x16x32_bf16 v[108:111], a[52:55], a[4:7], v[108:111]
s_waitcnt lgkmcnt(8)
ds_read_b64_tr_b16 a[50:51], v6 offset:41984
v_mfma_f32_16x16x32_bf16 v[124:127], a[52:55], a[8:11], v[124:127]
s_add_u32 m0, s76, 32768
ds_read_b128 a[36:39], v18 offset:32768
v_mfma_f32_16x16x32_bf16 v[140:143], a[52:55], a[12:15], v[140:143]
s_add_u32 s64, s72, 1664
ds_read_b64_tr_b16 a[52:53], v7 offset:40960
v_mfma_f32_16x16x32_bf16 v[32:35], a[56:59], a[0:3], v[32:35]
buffer_load_dwordx4 v12, s[48:51], s64 offen lds
v_mfma_f32_16x16x32_bf16 v[48:51], a[56:59], a[4:7], v[48:51]
ds_read_b64_tr_b16 a[54:55], v7 offset:41984
v_mfma_f32_16x16x32_bf16 v[64:67], a[56:59], a[8:11], v[64:67]
v_mfma_f32_16x16x32_bf16 v[80:83], a[56:59], a[12:15], v[80:83]
s_add_u32 m0, s76, 33792
ds_read_b64_tr_b16 a[56:57], v8 offset:40960
v_mfma_f32_16x16x32_bf16 v[96:99], a[60:63], a[0:3], v[96:99]
s_add_u32 s64, s72, 18048
ds_read_b64_tr_b16 a[58:59], v8 offset:41984
v_mfma_f32_16x16x32_bf16 v[112:115], a[60:63], a[4:7], v[112:115]
buffer_load_dwordx4 v13, s[48:51], s64 offen lds
v_mfma_f32_16x16x32_bf16 v[128:131], a[60:63], a[8:11], v[128:131]
v_mfma_f32_16x16x32_bf16 v[144:147], a[60:63], a[12:15], v[144:147]
ds_read_b64_tr_b16 a[60:61], v9 offset:40960
v_mfma_f32_16x16x32_bf16 v[36:39], a[64:67], a[0:3], v[36:39]
ds_read_b64_tr_b16 a[62:63], v9 offset:41984
v_mfma_f32_16x16x32_bf16 v[52:55], a[64:67], a[4:7], v[52:55]
s_add_u32 m0, s76, 34816
v_mfma_f32_16x16x32_bf16 v[68:71], a[64:67], a[8:11], v[68:71]
s_add_u32 s64, s72, 132736
v_mfma_f32_16x16x32_bf16 v[84:87], a[64:67], a[12:15], v[84:87]
buffer_load_dwordx4 v12, s[48:51], s64 offen lds
v_mfma_f32_16x16x32_bf16 v[100:103], a[68:71], a[0:3], v[100:103]
ds_read_b64_tr_b16 a[64:65], v10 offset:40960
v_mfma_f32_16x16x32_bf16 v[116:119], a[68:71], a[4:7], v[116:119]
ds_read_b64_tr_b16 a[66:67], v10 offset:41984
v_mfma_f32_16x16x32_bf16 v[132:135], a[68:71], a[8:11], v[132:135]
v_mfma_f32_16x16x32_bf16 v[148:151], a[68:71], a[12:15], v[148:151]
s_add_u32 m0, s76, 35840
ds_read_b64_tr_b16 a[68:69], v11 offset:40960
v_mfma_f32_16x16x32_bf16 v[152:155], a[72:75], a[0:3], v[152:155]
s_add_u32 s64, s72, 149120
ds_read_b64_tr_b16 a[70:71], v11 offset:41984
v_mfma_f32_16x16x32_bf16 v[160:163], a[72:75], a[4:7], v[160:163]
buffer_load_dwordx4 v13, s[48:51], s64 offen lds
v_mfma_f32_16x16x32_bf16 v[168:171], a[72:75], a[8:11], v[168:171]
v_mfma_f32_16x16x32_bf16 v[176:179], a[72:75], a[12:15], v[176:179]
ds_read_b64_tr_b16 a[72:73], v19 offset:34816
v_mfma_f32_16x16x32_bf16 v[156:159], a[76:79], a[0:3], v[156:159]
ds_read_b64_tr_b16 a[74:75], v19 offset:35072
v_mfma_f32_16x16x32_bf16 v[164:167], a[76:79], a[4:7], v[164:167]
s_add_u32 m0, s76, 36864
v_mfma_f32_16x16x32_bf16 v[172:175], a[76:79], a[8:11], v[172:175]
s_add_u32 s64, s73, 1664
v_mfma_f32_16x16x32_bf16 v[180:183], a[76:79], a[12:15], v[180:183]
buffer_load_dwordx4 v12, s[48:51], s64 offen lds
v_mfma_f32_16x16x32_bf16 v[184:187], a[80:83], a[0:3], v[184:187]
ds_read_b64_tr_b16 a[76:77], v20 offset:34816
v_mfma_f32_16x16x32_bf16 v[192:195], a[80:83], a[4:7], v[192:195]
ds_read_b64_tr_b16 a[78:79], v20 offset:35072
v_mfma_f32_16x16x32_bf16 v[200:203], a[80:83], a[8:11], v[200:203]
v_mfma_f32_16x16x32_bf16 v[208:211], a[80:83], a[12:15], v[208:211]
s_add_u32 m0, s76, 37888
ds_read_b64_tr_b16 a[80:81], v19 offset:38912
v_mfma_f32_16x16x32_bf16 v[188:191], a[84:87], a[0:3], v[188:191]
s_add_u32 s64, s73, 18048
ds_read_b64_tr_b16 a[82:83], v19 offset:39168
v_mfma_f32_16x16x32_bf16 v[196:199], a[84:87], a[4:7], v[196:199]
buffer_load_dwordx4 v13, s[48:51], s64 offen lds
v_mfma_f32_16x16x32_bf16 v[204:207], a[84:87], a[8:11], v[204:207]
v_mfma_f32_16x16x32_bf16 v[212:215], a[84:87], a[12:15], v[212:215]
ds_read_b64_tr_b16 a[84:85], v20 offset:38912
v_mfma_f32_16x16x32_bf16 v[216:219], a[0:3], a[88:91], v[216:219]
ds_read_b64_tr_b16 a[86:87], v20 offset:39168
v_mfma_f32_16x16x32_bf16 v[224:227], a[4:7], a[88:91], v[224:227]
s_add_u32 m0, s76, 38912
v_mfma_f32_16x16x32_bf16 v[232:235], a[8:11], a[88:91], v[232:235]
s_add_u32 s64, s73, 132736
v_mfma_f32_16x16x32_bf16 v[240:243], a[12:15], a[88:91], v[240:243]
buffer_load_dwordx4 v12, s[48:51], s64 offen lds
v_mfma_f32_16x16x32_bf16 v[220:223], a[0:3], a[92:95], v[220:223]
ds_read_b64_tr_b16 a[88:89], v19 offset:43008
v_mfma_f32_16x16x32_bf16 v[228:231], a[4:7], a[92:95], v[228:231]
ds_read_b64_tr_b16 a[90:91], v19 offset:43264
v_mfma_f32_16x16x32_bf16 v[236:239], a[8:11], a[92:95], v[236:239]
v_mfma_f32_16x16x32_bf16 v[244:247], a[12:15], a[92:95], v[244:247]
s_waitcnt lgkmcnt(4)
ds_read_b64_tr_b16 a[92:93], v20 offset:43008
v_mfma_f32_16x16x32_bf16 v[248:251], a[96:99], a[16:19], v[248:251]
ds_read_b64_tr_b16 a[94:95], v20 offset:43264
v_mfma_f32_16x16x32_bf16 v[252:255], a[16:19], a[100:103], v[252:255]
ds_read_b64_tr_b16 a[96:97], v21 offset:38912
v_mfma_f32_16x16x32_bf16 v[24:27], a[40:43], a[20:23], v[24:27]
ds_read_b64_tr_b16 a[98:99], v21 offset:39168
v_mfma_f32_16x16x32_bf16 v[40:43], a[40:43], a[24:27], v[40:43]
s_add_u32 m0, s76, 39936
ds_read_b64_tr_b16 a[100:101], v21 offset:43008
v_mfma_f32_16x16x32_bf16 v[56:59], a[40:43], a[28:31], v[56:59]
s_add_u32 s64, s73, 149120
ds_read_b64_tr_b16 a[102:103], v21 offset:43264
v_mfma_f32_16x16x32_bf16 v[72:75], a[40:43], a[32:35], v[72:75]
buffer_load_dwordx4 v13, s[48:51], s64 offen lds
v_mfma_f32_16x16x32_bf16 v[88:91], a[44:47], a[20:23], v[88:91]
v_mfma_f32_16x16x32_bf16 v[104:107], a[44:47], a[24:27], v[104:107]
v_mfma_f32_16x16x32_bf16 v[120:123], a[44:47], a[28:31], v[120:123]
v_mfma_f32_16x16x32_bf16 v[136:139], a[44:47], a[32:35], v[136:139]
v_mfma_f32_16x16x32_bf16 v[28:31], a[48:51], a[20:23], v[28:31]
s_waitcnt vmcnt(8) lgkmcnt(0)
s_barrier
v_mfma_f32_16x16x32_bf16 v[44:47], a[48:51], a[24:27], v[44:47]
s_add_u32 m0, s77, 98304
ds_read_b64_tr_b16 a[40:41], v4 offset:0
v_mfma_f32_16x16x32_bf16 v[60:63], a[48:51], a[28:31], v[60:63]
s_add_u32 s64, s71, 6815744
ds_read_b64_tr_b16 a[42:43], v4 offset:1024
v_mfma_f32_16x16x32_bf16 v[76:79], a[48:51], a[32:35], v[76:79]
buffer_load_dwordx4 v14, s[56:59], s64 offen lds
v_mfma_f32_16x16x32_bf16 v[92:95], a[52:55], a[20:23], v[92:95]
ds_read_b64_tr_b16 a[44:45], v5 offset:0
v_mfma_f32_16x16x32_bf16 v[108:111], a[52:55], a[24:27], v[108:111]
ds_read_b64_tr_b16 a[46:47], v5 offset:1024
v_mfma_f32_16x16x32_bf16 v[124:127], a[52:55], a[28:31], v[124:127]
ds_read_b64_tr_b16 a[48:49], v6 offset:0
v_mfma_f32_16x16x32_bf16 v[140:143], a[52:55], a[32:35], v[140:143]
s_add_u32 m0, s77, 99328
ds_read_b64_tr_b16 a[50:51], v6 offset:1024
v_mfma_f32_16x16x32_bf16 v[32:35], a[56:59], a[20:23], v[32:35]
s_add_u32 s64, s71, 6848512
ds_read_b64_tr_b16 a[52:53], v7 offset:0
v_mfma_f32_16x16x32_bf16 v[48:51], a[56:59], a[24:27], v[48:51]
buffer_load_dwordx4 v14, s[56:59], s64 offen lds
v_mfma_f32_16x16x32_bf16 v[64:67], a[56:59], a[28:31], v[64:67]
ds_read_b64_tr_b16 a[54:55], v7 offset:1024
v_mfma_f32_16x16x32_bf16 v[80:83], a[56:59], a[32:35], v[80:83]
ds_read_b64_tr_b16 a[56:57], v8 offset:0
v_mfma_f32_16x16x32_bf16 v[96:99], a[60:63], a[20:23], v[96:99]
ds_read_b64_tr_b16 a[58:59], v8 offset:1024
v_mfma_f32_16x16x32_bf16 v[112:115], a[60:63], a[24:27], v[112:115]
ds_read_b128 a[0:3], v2 offset:0
v_mfma_f32_16x16x32_bf16 v[128:131], a[60:63], a[28:31], v[128:131]
s_add_u32 m0, s77, 100352
ds_read_b128 a[4:7], v2 offset:2048
v_mfma_f32_16x16x32_bf16 v[144:147], a[60:63], a[32:35], v[144:147]
s_add_u32 s64, s71, 6881280
ds_read_b64_tr_b16 a[60:61], v9 offset:0
v_mfma_f32_16x16x32_bf16 v[36:39], a[64:67], a[20:23], v[36:39]
buffer_load_dwordx4 v15, s[56:59], s64 offen lds
v_mfma_f32_16x16x32_bf16 v[52:55], a[64:67], a[24:27], v[52:55]
ds_read_b64_tr_b16 a[62:63], v9 offset:1024
v_mfma_f32_16x16x32_bf16 v[68:71], a[64:67], a[28:31], v[68:71]
ds_read_b128 a[8:11], v2 offset:4096
v_mfma_f32_16x16x32_bf16 v[84:87], a[64:67], a[32:35], v[84:87]
ds_read_b128 a[12:15], v2 offset:6144
v_mfma_f32_16x16x32_bf16 v[100:103], a[68:71], a[20:23], v[100:103]
ds_read_b64_tr_b16 a[64:65], v10 offset:0
v_mfma_f32_16x16x32_bf16 v[116:119], a[68:71], a[24:27], v[116:119]
s_add_u32 m0, s77, 101376
ds_read_b64_tr_b16 a[66:67], v10 offset:1024
v_mfma_f32_16x16x32_bf16 v[132:135], a[68:71], a[28:31], v[132:135]
s_add_u32 s64, s71, 6914048
ds_read_b128 a[16:19], v17 offset:0
v_mfma_f32_16x16x32_bf16 v[148:151], a[68:71], a[32:35], v[148:151]
buffer_load_dwordx4 v15, s[56:59], s64 offen lds
v_mfma_f32_16x16x32_bf16 v[152:155], a[72:75], a[20:23], v[152:155]
ds_read_b64_tr_b16 a[68:69], v11 offset:0
v_mfma_f32_16x16x32_bf16 v[160:163], a[72:75], a[24:27], v[160:163]
ds_read_b64_tr_b16 a[70:71], v11 offset:1024
v_mfma_f32_16x16x32_bf16 v[168:171], a[72:75], a[28:31], v[168:171]
v_mfma_f32_16x16x32_bf16 v[176:179], a[72:75], a[32:35], v[176:179]
ds_read_b64_tr_b16 a[72:73], v19 offset:0
v_mfma_f32_16x16x32_bf16 v[156:159], a[76:79], a[20:23], v[156:159]
s_add_u32 m0, s78, 114688
ds_read_b64_tr_b16 a[74:75], v19 offset:256
v_mfma_f32_16x16x32_bf16 v[164:167], a[76:79], a[24:27], v[164:167]
s_add_u32 s64, s75, 5111808
v_mfma_f32_16x16x32_bf16 v[172:175], a[76:79], a[28:31], v[172:175]
buffer_load_dwordx4 v23, s[60:63], s64 offen lds
v_mfma_f32_16x16x32_bf16 v[180:183], a[76:79], a[32:35], v[180:183]
ds_read_b64_tr_b16 a[76:77], v20 offset:0
v_mfma_f32_16x16x32_bf16 v[184:187], a[80:83], a[20:23], v[184:187]
ds_read_b64_tr_b16 a[78:79], v20 offset:256
v_mfma_f32_16x16x32_bf16 v[192:195], a[80:83], a[24:27], v[192:195]
v_mfma_f32_16x16x32_bf16 v[200:203], a[80:83], a[28:31], v[200:203]
v_mfma_f32_16x16x32_bf16 v[208:211], a[80:83], a[32:35], v[208:211]
s_add_u32 m0, s78, 118784
ds_read_b64_tr_b16 a[80:81], v19 offset:4096
v_mfma_f32_16x16x32_bf16 v[188:191], a[84:87], a[20:23], v[188:191]
s_add_u32 s64, s75, 5113856
ds_read_b64_tr_b16 a[82:83], v19 offset:4352
v_mfma_f32_16x16x32_bf16 v[196:199], a[84:87], a[24:27], v[196:199]
buffer_load_dwordx4 v23, s[60:63], s64 offen lds
v_mfma_f32_16x16x32_bf16 v[204:207], a[84:87], a[28:31], v[204:207]
v_mfma_f32_16x16x32_bf16 v[212:215], a[84:87], a[32:35], v[212:215]
ds_read_b64_tr_b16 a[84:85], v20 offset:4096
v_mfma_f32_16x16x32_bf16 v[216:219], a[20:23], a[88:91], v[216:219]
ds_read_b64_tr_b16 a[86:87], v20 offset:4352
v_mfma_f32_16x16x32_bf16 v[224:227], a[24:27], a[88:91], v[224:227]
v_mfma_f32_16x16x32_bf16 v[232:235], a[28:31], a[88:91], v[232:235]
s_add_u32 m0, s78, 122880
v_mfma_f32_16x16x32_bf16 v[240:243], a[32:35], a[88:91], v[240:243]
s_add_u32 s64, s75, 5115904
ds_read_b64_tr_b16 a[88:89], v19 offset:8192
v_mfma_f32_16x16x32_bf16 v[220:223], a[20:23], a[92:95], v[220:223]
buffer_load_dwordx4 v23, s[60:63], s64 offen lds
v_mfma_f32_16x16x32_bf16 v[228:231], a[24:27], a[92:95], v[228:231]
ds_read_b64_tr_b16 a[90:91], v19 offset:8448
v_mfma_f32_16x16x32_bf16 v[236:239], a[28:31], a[92:95], v[236:239]
v_mfma_f32_16x16x32_bf16 v[244:247], a[32:35], a[92:95], v[244:247]
ds_read_b64_tr_b16 a[92:93], v20 offset:8192
v_mfma_f32_16x16x32_bf16 v[248:251], a[96:99], a[36:39], v[248:251]
ds_read_b64_tr_b16 a[94:95], v20 offset:8448
v_mfma_f32_16x16x32_bf16 v[252:255], a[36:39], a[100:103], v[252:255]
s_waitcnt lgkmcnt(5)
s_add_u32 m0, s78, 126976
ds_read_b64_tr_b16 a[96:97], v21 offset:4096
v_mfma_f32_16x16x32_bf16 v[24:27], a[40:43], a[0:3], v[24:27]
s_add_u32 s64, s74, 1664
ds_read_b128 a[20:23], v3 offset:0
v_mfma_f32_16x16x32_bf16 v[40:43], a[40:43], a[4:7], v[40:43]
buffer_load_dwordx4 v22, s[48:51], s64 offen lds
v_mfma_f32_16x16x32_bf16 v[56:59], a[40:43], a[8:11], v[56:59]
ds_read_b128 a[24:27], v3 offset:2048
v_mfma_f32_16x16x32_bf16 v[72:75], a[40:43], a[12:15], v[72:75]
ds_read_b128 a[28:31], v3 offset:4096
v_mfma_f32_16x16x32_bf16 v[88:91], a[44:47], a[0:3], v[88:91]
ds_read_b128 a[32:35], v3 offset:6144
v_mfma_f32_16x16x32_bf16 v[104:107], a[44:47], a[4:7], v[104:107]
ds_read_b64_tr_b16 a[40:41], v4 offset:8192
v_mfma_f32_16x16x32_bf16 v[120:123], a[44:47], a[8:11], v[120:123]
ds_read_b64_tr_b16 a[42:43], v4 offset:9216
v_mfma_f32_16x16x32_bf16 v[136:139], a[44:47], a[12:15], v[136:139]
ds_read_b64_tr_b16 a[44:45], v5 offset:8192
v_mfma_f32_16x16x32_bf16 v[28:31], a[48:51], a[0:3], v[28:31]
ds_read_b64_tr_b16 a[46:47], v5 offset:9216
v_mfma_f32_16x16x32_bf16 v[44:47], a[48:51], a[4:7], v[44:47]
ds_read_b64_tr_b16 a[98:99], v21 offset:4352
v_mfma_f32_16x16x32_bf16 v[60:63], a[48:51], a[8:11], v[60:63]
ds_read_b64_tr_b16 a[100:101], v21 offset:8192
v_mfma_f32_16x16x32_bf16 v[76:79], a[48:51], a[12:15], v[76:79]
ds_read_b64_tr_b16 a[102:103], v21 offset:8448
v_mfma_f32_16x16x32_bf16 v[92:95], a[52:55], a[0:3], v[92:95]
ds_read_b64_tr_b16 a[48:49], v6 offset:8192
v_mfma_f32_16x16x32_bf16 v[108:111], a[52:55], a[4:7], v[108:111]
s_waitcnt lgkmcnt(8)
ds_read_b64_tr_b16 a[50:51], v6 offset:9216
v_mfma_f32_16x16x32_bf16 v[124:127], a[52:55], a[8:11], v[124:127]
s_add_u32 m0, s76, 0
ds_read_b128 a[36:39], v18 offset:0
v_mfma_f32_16x16x32_bf16 v[140:143], a[52:55], a[12:15], v[140:143]
s_add_u32 s64, s72, 1792
ds_read_b64_tr_b16 a[52:53], v7 offset:8192
v_mfma_f32_16x16x32_bf16 v[32:35], a[56:59], a[0:3], v[32:35]
buffer_load_dwordx4 v12, s[48:51], s64 offen lds
v_mfma_f32_16x16x32_bf16 v[48:51], a[56:59], a[4:7], v[48:51]
ds_read_b64_tr_b16 a[54:55], v7 offset:9216
v_mfma_f32_16x16x32_bf16 v[64:67], a[56:59], a[8:11], v[64:67]
v_mfma_f32_16x16x32_bf16 v[80:83], a[56:59], a[12:15], v[80:83]
s_add_u32 m0, s76, 1024
ds_read_b64_tr_b16 a[56:57], v8 offset:8192
v_mfma_f32_16x16x32_bf16 v[96:99], a[60:63], a[0:3], v[96:99]
s_add_u32 s64, s72, 18176
ds_read_b64_tr_b16 a[58:59], v8 offset:9216
v_mfma_f32_16x16x32_bf16 v[112:115], a[60:63], a[4:7], v[112:115]
buffer_load_dwordx4 v13, s[48:51], s64 offen lds
v_mfma_f32_16x16x32_bf16 v[128:131], a[60:63], a[8:11], v[128:131]
v_mfma_f32_16x16x32_bf16 v[144:147], a[60:63], a[12:15], v[144:147]
ds_read_b64_tr_b16 a[60:61], v9 offset:8192
v_mfma_f32_16x16x32_bf16 v[36:39], a[64:67], a[0:3], v[36:39]
ds_read_b64_tr_b16 a[62:63], v9 offset:9216
v_mfma_f32_16x16x32_bf16 v[52:55], a[64:67], a[4:7], v[52:55]
s_add_u32 m0, s76, 2048
v_mfma_f32_16x16x32_bf16 v[68:71], a[64:67], a[8:11], v[68:71]
s_add_u32 s64, s72, 132864
v_mfma_f32_16x16x32_bf16 v[84:87], a[64:67], a[12:15], v[84:87]
buffer_load_dwordx4 v12, s[48:51], s64 offen lds
v_mfma_f32_16x16x32_bf16 v[100:103], a[68:71], a[0:3], v[100:103]
ds_read_b64_tr_b16 a[64:65], v10 offset:8192
v_mfma_f32_16x16x32_bf16 v[116:119], a[68:71], a[4:7], v[116:119]
ds_read_b64_tr_b16 a[66:67], v10 offset:9216
v_mfma_f32_16x16x32_bf16 v[132:135], a[68:71], a[8:11], v[132:135]
v_mfma_f32_16x16x32_bf16 v[148:151], a[68:71], a[12:15], v[148:151]
s_add_u32 m0, s76, 3072
ds_read_b64_tr_b16 a[68:69], v11 offset:8192
v_mfma_f32_16x16x32_bf16 v[152:155], a[72:75], a[0:3], v[152:155]
s_add_u32 s64, s72, 149248
ds_read_b64_tr_b16 a[70:71], v11 offset:9216
v_mfma_f32_16x16x32_bf16 v[160:163], a[72:75], a[4:7], v[160:163]
buffer_load_dwordx4 v13, s[48:51], s64 offen lds
v_mfma_f32_16x16x32_bf16 v[168:171], a[72:75], a[8:11], v[168:171]
v_mfma_f32_16x16x32_bf16 v[176:179], a[72:75], a[12:15], v[176:179]
ds_read_b64_tr_b16 a[72:73], v19 offset:2048
v_mfma_f32_16x16x32_bf16 v[156:159], a[76:79], a[0:3], v[156:159]
ds_read_b64_tr_b16 a[74:75], v19 offset:2304
v_mfma_f32_16x16x32_bf16 v[164:167], a[76:79], a[4:7], v[164:167]
s_add_u32 m0, s76, 4096
v_mfma_f32_16x16x32_bf16 v[172:175], a[76:79], a[8:11], v[172:175]
s_add_u32 s64, s73, 1792
v_mfma_f32_16x16x32_bf16 v[180:183], a[76:79], a[12:15], v[180:183]
buffer_load_dwordx4 v12, s[48:51], s64 offen lds
v_mfma_f32_16x16x32_bf16 v[184:187], a[80:83], a[0:3], v[184:187]
ds_read_b64_tr_b16 a[76:77], v20 offset:2048
v_mfma_f32_16x16x32_bf16 v[192:195], a[80:83], a[4:7], v[192:195]
ds_read_b64_tr_b16 a[78:79], v20 offset:2304
v_mfma_f32_16x16x32_bf16 v[200:203], a[80:83], a[8:11], v[200:203]
v_mfma_f32_16x16x32_bf16 v[208:211], a[80:83], a[12:15], v[208:211]
s_add_u32 m0, s76, 5120
ds_read_b64_tr_b16 a[80:81], v19 offset:6144
v_mfma_f32_16x16x32_bf16 v[188:191], a[84:87], a[0:3], v[188:191]
s_add_u32 s64, s73, 18176
ds_read_b64_tr_b16 a[82:83], v19 offset:6400
v_mfma_f32_16x16x32_bf16 v[196:199], a[84:87], a[4:7], v[196:199]
buffer_load_dwordx4 v13, s[48:51], s64 offen lds
v_mfma_f32_16x16x32_bf16 v[204:207], a[84:87], a[8:11], v[204:207]
v_mfma_f32_16x16x32_bf16 v[212:215], a[84:87], a[12:15], v[212:215]
ds_read_b64_tr_b16 a[84:85], v20 offset:6144
v_mfma_f32_16x16x32_bf16 v[216:219], a[0:3], a[88:91], v[216:219]
ds_read_b64_tr_b16 a[86:87], v20 offset:6400
v_mfma_f32_16x16x32_bf16 v[224:227], a[4:7], a[88:91], v[224:227]
s_add_u32 m0, s76, 6144
v_mfma_f32_16x16x32_bf16 v[232:235], a[8:11], a[88:91], v[232:235]
s_add_u32 s64, s73, 132864
v_mfma_f32_16x16x32_bf16 v[240:243], a[12:15], a[88:91], v[240:243]
buffer_load_dwordx4 v12, s[48:51], s64 offen lds
v_mfma_f32_16x16x32_bf16 v[220:223], a[0:3], a[92:95], v[220:223]
ds_read_b64_tr_b16 a[88:89], v19 offset:10240
v_mfma_f32_16x16x32_bf16 v[228:231], a[4:7], a[92:95], v[228:231]
ds_read_b64_tr_b16 a[90:91], v19 offset:10496
v_mfma_f32_16x16x32_bf16 v[236:239], a[8:11], a[92:95], v[236:239]
v_mfma_f32_16x16x32_bf16 v[244:247], a[12:15], a[92:95], v[244:247]
s_waitcnt lgkmcnt(4)
ds_read_b64_tr_b16 a[92:93], v20 offset:10240
v_mfma_f32_16x16x32_bf16 v[248:251], a[96:99], a[16:19], v[248:251]
ds_read_b64_tr_b16 a[94:95], v20 offset:10496
v_mfma_f32_16x16x32_bf16 v[252:255], a[16:19], a[100:103], v[252:255]
ds_read_b64_tr_b16 a[96:97], v21 offset:6144
v_mfma_f32_16x16x32_bf16 v[24:27], a[40:43], a[20:23], v[24:27]
ds_read_b64_tr_b16 a[98:99], v21 offset:6400
v_mfma_f32_16x16x32_bf16 v[40:43], a[40:43], a[24:27], v[40:43]
s_add_u32 m0, s76, 7168
ds_read_b64_tr_b16 a[100:101], v21 offset:10240
v_mfma_f32_16x16x32_bf16 v[56:59], a[40:43], a[28:31], v[56:59]
s_add_u32 s64, s73, 149248
ds_read_b64_tr_b16 a[102:103], v21 offset:10496
v_mfma_f32_16x16x32_bf16 v[72:75], a[40:43], a[32:35], v[72:75]
buffer_load_dwordx4 v13, s[48:51], s64 offen lds
v_mfma_f32_16x16x32_bf16 v[88:91], a[44:47], a[20:23], v[88:91]
v_mfma_f32_16x16x32_bf16 v[104:107], a[44:47], a[24:27], v[104:107]
v_mfma_f32_16x16x32_bf16 v[120:123], a[44:47], a[28:31], v[120:123]
v_mfma_f32_16x16x32_bf16 v[136:139], a[44:47], a[32:35], v[136:139]
v_mfma_f32_16x16x32_bf16 v[28:31], a[48:51], a[20:23], v[28:31]
s_waitcnt vmcnt(8) lgkmcnt(0)
s_barrier
v_mfma_f32_16x16x32_bf16 v[44:47], a[48:51], a[24:27], v[44:47]
s_add_u32 m0, s77, 65536
ds_read_b64_tr_b16 a[40:41], v4 offset:32768
v_mfma_f32_16x16x32_bf16 v[60:63], a[48:51], a[28:31], v[60:63]
s_add_u32 s64, s71, 7340032
ds_read_b64_tr_b16 a[42:43], v4 offset:33792
v_mfma_f32_16x16x32_bf16 v[76:79], a[48:51], a[32:35], v[76:79]
buffer_load_dwordx4 v14, s[56:59], s64 offen lds
v_mfma_f32_16x16x32_bf16 v[92:95], a[52:55], a[20:23], v[92:95]
ds_read_b64_tr_b16 a[44:45], v5 offset:32768
v_mfma_f32_16x16x32_bf16 v[108:111], a[52:55], a[24:27], v[108:111]
ds_read_b64_tr_b16 a[46:47], v5 offset:33792
v_mfma_f32_16x16x32_bf16 v[124:127], a[52:55], a[28:31], v[124:127]
ds_read_b64_tr_b16 a[48:49], v6 offset:32768
v_mfma_f32_16x16x32_bf16 v[140:143], a[52:55], a[32:35], v[140:143]
s_add_u32 m0, s77, 66560
ds_read_b64_tr_b16 a[50:51], v6 offset:33792
v_mfma_f32_16x16x32_bf16 v[32:35], a[56:59], a[20:23], v[32:35]
s_add_u32 s64, s71, 7372800
ds_read_b64_tr_b16 a[52:53], v7 offset:32768
v_mfma_f32_16x16x32_bf16 v[48:51], a[56:59], a[24:27], v[48:51]
buffer_load_dwordx4 v14, s[56:59], s64 offen lds
v_mfma_f32_16x16x32_bf16 v[64:67], a[56:59], a[28:31], v[64:67]
ds_read_b64_tr_b16 a[54:55], v7 offset:33792
v_mfma_f32_16x16x32_bf16 v[80:83], a[56:59], a[32:35], v[80:83]
ds_read_b64_tr_b16 a[56:57], v8 offset:32768
v_mfma_f32_16x16x32_bf16 v[96:99], a[60:63], a[20:23], v[96:99]
ds_read_b64_tr_b16 a[58:59], v8 offset:33792
v_mfma_f32_16x16x32_bf16 v[112:115], a[60:63], a[24:27], v[112:115]
ds_read_b128 a[0:3], v2 offset:32768
v_mfma_f32_16x16x32_bf16 v[128:131], a[60:63], a[28:31], v[128:131]
s_add_u32 m0, s77, 67584
ds_read_b128 a[4:7], v2 offset:34816
v_mfma_f32_16x16x32_bf16 v[144:147], a[60:63], a[32:35], v[144:147]
s_add_u32 s64, s71, 7405568
ds_read_b64_tr_b16 a[60:61], v9 offset:32768
v_mfma_f32_16x16x32_bf16 v[36:39], a[64:67], a[20:23], v[36:39]
buffer_load_dwordx4 v15, s[56:59], s64 offen lds
v_mfma_f32_16x16x32_bf16 v[52:55], a[64:67], a[24:27], v[52:55]
ds_read_b64_tr_b16 a[62:63], v9 offset:33792
v_mfma_f32_16x16x32_bf16 v[68:71], a[64:67], a[28:31], v[68:71]
ds_read_b128 a[8:11], v2 offset:36864
v_mfma_f32_16x16x32_bf16 v[84:87], a[64:67], a[32:35], v[84:87]
ds_read_b128 a[12:15], v2 offset:38912
v_mfma_f32_16x16x32_bf16 v[100:103], a[68:71], a[20:23], v[100:103]
ds_read_b64_tr_b16 a[64:65], v10 offset:32768
v_mfma_f32_16x16x32_bf16 v[116:119], a[68:71], a[24:27], v[116:119]
s_add_u32 m0, s77, 68608
ds_read_b64_tr_b16 a[66:67], v10 offset:33792
v_mfma_f32_16x16x32_bf16 v[132:135], a[68:71], a[28:31], v[132:135]
s_add_u32 s64, s71, 7438336
ds_read_b128 a[16:19], v17 offset:32768
v_mfma_f32_16x16x32_bf16 v[148:151], a[68:71], a[32:35], v[148:151]
buffer_load_dwordx4 v15, s[56:59], s64 offen lds
v_mfma_f32_16x16x32_bf16 v[152:155], a[72:75], a[20:23], v[152:155]
ds_read_b64_tr_b16 a[68:69], v11 offset:32768
v_mfma_f32_16x16x32_bf16 v[160:163], a[72:75], a[24:27], v[160:163]
ds_read_b64_tr_b16 a[70:71], v11 offset:33792
v_mfma_f32_16x16x32_bf16 v[168:171], a[72:75], a[28:31], v[168:171]
v_mfma_f32_16x16x32_bf16 v[176:179], a[72:75], a[32:35], v[176:179]
ds_read_b64_tr_b16 a[72:73], v19 offset:32768
v_mfma_f32_16x16x32_bf16 v[156:159], a[76:79], a[20:23], v[156:159]
s_add_u32 m0, s78, 81920
ds_read_b64_tr_b16 a[74:75], v19 offset:33024
v_mfma_f32_16x16x32_bf16 v[164:167], a[76:79], a[24:27], v[164:167]
s_add_u32 s64, s75, 5505024
v_mfma_f32_16x16x32_bf16 v[172:175], a[76:79], a[28:31], v[172:175]
buffer_load_dwordx4 v23, s[60:63], s64 offen lds
v_mfma_f32_16x16x32_bf16 v[180:183], a[76:79], a[32:35], v[180:183]
ds_read_b64_tr_b16 a[76:77], v20 offset:32768
v_mfma_f32_16x16x32_bf16 v[184:187], a[80:83], a[20:23], v[184:187]
ds_read_b64_tr_b16 a[78:79], v20 offset:33024
v_mfma_f32_16x16x32_bf16 v[192:195], a[80:83], a[24:27], v[192:195]
v_mfma_f32_16x16x32_bf16 v[200:203], a[80:83], a[28:31], v[200:203]
v_mfma_f32_16x16x32_bf16 v[208:211], a[80:83], a[32:35], v[208:211]
s_add_u32 m0, s78, 86016
ds_read_b64_tr_b16 a[80:81], v19 offset:36864
v_mfma_f32_16x16x32_bf16 v[188:191], a[84:87], a[20:23], v[188:191]
s_add_u32 s64, s75, 5507072
ds_read_b64_tr_b16 a[82:83], v19 offset:37120
v_mfma_f32_16x16x32_bf16 v[196:199], a[84:87], a[24:27], v[196:199]
buffer_load_dwordx4 v23, s[60:63], s64 offen lds
v_mfma_f32_16x16x32_bf16 v[204:207], a[84:87], a[28:31], v[204:207]
v_mfma_f32_16x16x32_bf16 v[212:215], a[84:87], a[32:35], v[212:215]
ds_read_b64_tr_b16 a[84:85], v20 offset:36864
v_mfma_f32_16x16x32_bf16 v[216:219], a[20:23], a[88:91], v[216:219]
ds_read_b64_tr_b16 a[86:87], v20 offset:37120
v_mfma_f32_16x16x32_bf16 v[224:227], a[24:27], a[88:91], v[224:227]
v_mfma_f32_16x16x32_bf16 v[232:235], a[28:31], a[88:91], v[232:235]
s_add_u32 m0, s78, 90112
v_mfma_f32_16x16x32_bf16 v[240:243], a[32:35], a[88:91], v[240:243]
s_add_u32 s64, s75, 5509120
ds_read_b64_tr_b16 a[88:89], v19 offset:40960
v_mfma_f32_16x16x32_bf16 v[220:223], a[20:23], a[92:95], v[220:223]
buffer_load_dwordx4 v23, s[60:63], s64 offen lds
v_mfma_f32_16x16x32_bf16 v[228:231], a[24:27], a[92:95], v[228:231]
ds_read_b64_tr_b16 a[90:91], v19 offset:41216
v_mfma_f32_16x16x32_bf16 v[236:239], a[28:31], a[92:95], v[236:239]
v_mfma_f32_16x16x32_bf16 v[244:247], a[32:35], a[92:95], v[244:247]
ds_read_b64_tr_b16 a[92:93], v20 offset:40960
v_mfma_f32_16x16x32_bf16 v[248:251], a[96:99], a[36:39], v[248:251]
ds_read_b64_tr_b16 a[94:95], v20 offset:41216
v_mfma_f32_16x16x32_bf16 v[252:255], a[36:39], a[100:103], v[252:255]
s_waitcnt lgkmcnt(5)
s_add_u32 m0, s78, 94208
ds_read_b64_tr_b16 a[96:97], v21 offset:36864
v_mfma_f32_16x16x32_bf16 v[24:27], a[40:43], a[0:3], v[24:27]
s_add_u32 s64, s74, 1792
ds_read_b128 a[20:23], v3 offset:32768
v_mfma_f32_16x16x32_bf16 v[40:43], a[40:43], a[4:7], v[40:43]
buffer_load_dwordx4 v22, s[48:51], s64 offen lds
v_mfma_f32_16x16x32_bf16 v[56:59], a[40:43], a[8:11], v[56:59]
ds_read_b128 a[24:27], v3 offset:34816
v_mfma_f32_16x16x32_bf16 v[72:75], a[40:43], a[12:15], v[72:75]
ds_read_b128 a[28:31], v3 offset:36864
v_mfma_f32_16x16x32_bf16 v[88:91], a[44:47], a[0:3], v[88:91]
ds_read_b128 a[32:35], v3 offset:38912
v_mfma_f32_16x16x32_bf16 v[104:107], a[44:47], a[4:7], v[104:107]
ds_read_b64_tr_b16 a[40:41], v4 offset:40960
v_mfma_f32_16x16x32_bf16 v[120:123], a[44:47], a[8:11], v[120:123]
ds_read_b64_tr_b16 a[42:43], v4 offset:41984
v_mfma_f32_16x16x32_bf16 v[136:139], a[44:47], a[12:15], v[136:139]
ds_read_b64_tr_b16 a[44:45], v5 offset:40960
v_mfma_f32_16x16x32_bf16 v[28:31], a[48:51], a[0:3], v[28:31]
ds_read_b64_tr_b16 a[46:47], v5 offset:41984
v_mfma_f32_16x16x32_bf16 v[44:47], a[48:51], a[4:7], v[44:47]
ds_read_b64_tr_b16 a[98:99], v21 offset:37120
v_mfma_f32_16x16x32_bf16 v[60:63], a[48:51], a[8:11], v[60:63]
ds_read_b64_tr_b16 a[100:101], v21 offset:40960
v_mfma_f32_16x16x32_bf16 v[76:79], a[48:51], a[12:15], v[76:79]
ds_read_b64_tr_b16 a[102:103], v21 offset:41216
v_mfma_f32_16x16x32_bf16 v[92:95], a[52:55], a[0:3], v[92:95]
ds_read_b64_tr_b16 a[48:49], v6 offset:40960
v_mfma_f32_16x16x32_bf16 v[108:111], a[52:55], a[4:7], v[108:111]
s_waitcnt lgkmcnt(8)
ds_read_b64_tr_b16 a[50:51], v6 offset:41984
v_mfma_f32_16x16x32_bf16 v[124:127], a[52:55], a[8:11], v[124:127]
s_add_u32 m0, s76, 32768
ds_read_b128 a[36:39], v18 offset:32768
v_mfma_f32_16x16x32_bf16 v[140:143], a[52:55], a[12:15], v[140:143]
s_add_u32 s64, s72, 1920
ds_read_b64_tr_b16 a[52:53], v7 offset:40960
v_mfma_f32_16x16x32_bf16 v[32:35], a[56:59], a[0:3], v[32:35]
buffer_load_dwordx4 v12, s[48:51], s64 offen lds
v_mfma_f32_16x16x32_bf16 v[48:51], a[56:59], a[4:7], v[48:51]
ds_read_b64_tr_b16 a[54:55], v7 offset:41984
v_mfma_f32_16x16x32_bf16 v[64:67], a[56:59], a[8:11], v[64:67]
v_mfma_f32_16x16x32_bf16 v[80:83], a[56:59], a[12:15], v[80:83]
s_add_u32 m0, s76, 33792
ds_read_b64_tr_b16 a[56:57], v8 offset:40960
v_mfma_f32_16x16x32_bf16 v[96:99], a[60:63], a[0:3], v[96:99]
s_add_u32 s64, s72, 18304
ds_read_b64_tr_b16 a[58:59], v8 offset:41984
v_mfma_f32_16x16x32_bf16 v[112:115], a[60:63], a[4:7], v[112:115]
buffer_load_dwordx4 v13, s[48:51], s64 offen lds
v_mfma_f32_16x16x32_bf16 v[128:131], a[60:63], a[8:11], v[128:131]
v_mfma_f32_16x16x32_bf16 v[144:147], a[60:63], a[12:15], v[144:147]
ds_read_b64_tr_b16 a[60:61], v9 offset:40960
v_mfma_f32_16x16x32_bf16 v[36:39], a[64:67], a[0:3], v[36:39]
ds_read_b64_tr_b16 a[62:63], v9 offset:41984
v_mfma_f32_16x16x32_bf16 v[52:55], a[64:67], a[4:7], v[52:55]
s_add_u32 m0, s76, 34816
v_mfma_f32_16x16x32_bf16 v[68:71], a[64:67], a[8:11], v[68:71]
s_add_u32 s64, s72, 132992
v_mfma_f32_16x16x32_bf16 v[84:87], a[64:67], a[12:15], v[84:87]
buffer_load_dwordx4 v12, s[48:51], s64 offen lds
v_mfma_f32_16x16x32_bf16 v[100:103], a[68:71], a[0:3], v[100:103]
ds_read_b64_tr_b16 a[64:65], v10 offset:40960
v_mfma_f32_16x16x32_bf16 v[116:119], a[68:71], a[4:7], v[116:119]
ds_read_b64_tr_b16 a[66:67], v10 offset:41984
v_mfma_f32_16x16x32_bf16 v[132:135], a[68:71], a[8:11], v[132:135]
v_mfma_f32_16x16x32_bf16 v[148:151], a[68:71], a[12:15], v[148:151]
s_add_u32 m0, s76, 35840
ds_read_b64_tr_b16 a[68:69], v11 offset:40960
v_mfma_f32_16x16x32_bf16 v[152:155], a[72:75], a[0:3], v[152:155]
s_add_u32 s64, s72, 149376
ds_read_b64_tr_b16 a[70:71], v11 offset:41984
v_mfma_f32_16x16x32_bf16 v[160:163], a[72:75], a[4:7], v[160:163]
buffer_load_dwordx4 v13, s[48:51], s64 offen lds
v_mfma_f32_16x16x32_bf16 v[168:171], a[72:75], a[8:11], v[168:171]
v_mfma_f32_16x16x32_bf16 v[176:179], a[72:75], a[12:15], v[176:179]
ds_read_b64_tr_b16 a[72:73], v19 offset:34816
v_mfma_f32_16x16x32_bf16 v[156:159], a[76:79], a[0:3], v[156:159]
ds_read_b64_tr_b16 a[74:75], v19 offset:35072
v_mfma_f32_16x16x32_bf16 v[164:167], a[76:79], a[4:7], v[164:167]
s_add_u32 m0, s76, 36864
v_mfma_f32_16x16x32_bf16 v[172:175], a[76:79], a[8:11], v[172:175]
s_add_u32 s64, s73, 1920
v_mfma_f32_16x16x32_bf16 v[180:183], a[76:79], a[12:15], v[180:183]
buffer_load_dwordx4 v12, s[48:51], s64 offen lds
v_mfma_f32_16x16x32_bf16 v[184:187], a[80:83], a[0:3], v[184:187]
ds_read_b64_tr_b16 a[76:77], v20 offset:34816
v_mfma_f32_16x16x32_bf16 v[192:195], a[80:83], a[4:7], v[192:195]
ds_read_b64_tr_b16 a[78:79], v20 offset:35072
v_mfma_f32_16x16x32_bf16 v[200:203], a[80:83], a[8:11], v[200:203]
v_mfma_f32_16x16x32_bf16 v[208:211], a[80:83], a[12:15], v[208:211]
s_add_u32 m0, s76, 37888
ds_read_b64_tr_b16 a[80:81], v19 offset:38912
v_mfma_f32_16x16x32_bf16 v[188:191], a[84:87], a[0:3], v[188:191]
s_add_u32 s64, s73, 18304
ds_read_b64_tr_b16 a[82:83], v19 offset:39168
v_mfma_f32_16x16x32_bf16 v[196:199], a[84:87], a[4:7], v[196:199]
buffer_load_dwordx4 v13, s[48:51], s64 offen lds
v_mfma_f32_16x16x32_bf16 v[204:207], a[84:87], a[8:11], v[204:207]
v_mfma_f32_16x16x32_bf16 v[212:215], a[84:87], a[12:15], v[212:215]
ds_read_b64_tr_b16 a[84:85], v20 offset:38912
v_mfma_f32_16x16x32_bf16 v[216:219], a[0:3], a[88:91], v[216:219]
ds_read_b64_tr_b16 a[86:87], v20 offset:39168
v_mfma_f32_16x16x32_bf16 v[224:227], a[4:7], a[88:91], v[224:227]
s_add_u32 m0, s76, 38912
v_mfma_f32_16x16x32_bf16 v[232:235], a[8:11], a[88:91], v[232:235]
s_add_u32 s64, s73, 132992
v_mfma_f32_16x16x32_bf16 v[240:243], a[12:15], a[88:91], v[240:243]
buffer_load_dwordx4 v12, s[48:51], s64 offen lds
v_mfma_f32_16x16x32_bf16 v[220:223], a[0:3], a[92:95], v[220:223]
ds_read_b64_tr_b16 a[88:89], v19 offset:43008
v_mfma_f32_16x16x32_bf16 v[228:231], a[4:7], a[92:95], v[228:231]
ds_read_b64_tr_b16 a[90:91], v19 offset:43264
v_mfma_f32_16x16x32_bf16 v[236:239], a[8:11], a[92:95], v[236:239]
buffer_load_dword v1, off, s[52:55], 0 sc1
v_mfma_f32_16x16x32_bf16 v[244:247], a[12:15], a[92:95], v[244:247]
s_waitcnt lgkmcnt(4)
ds_read_b64_tr_b16 a[92:93], v20 offset:43008
v_mfma_f32_16x16x32_bf16 v[248:251], a[96:99], a[16:19], v[248:251]
ds_read_b64_tr_b16 a[94:95], v20 offset:43264
v_mfma_f32_16x16x32_bf16 v[252:255], a[16:19], a[100:103], v[252:255]
ds_read_b64_tr_b16 a[96:97], v21 offset:38912
v_mfma_f32_16x16x32_bf16 v[24:27], a[40:43], a[20:23], v[24:27]
ds_read_b64_tr_b16 a[98:99], v21 offset:39168
v_mfma_f32_16x16x32_bf16 v[40:43], a[40:43], a[24:27], v[40:43]
s_add_u32 m0, s76, 39936
ds_read_b64_tr_b16 a[100:101], v21 offset:43008
v_mfma_f32_16x16x32_bf16 v[56:59], a[40:43], a[28:31], v[56:59]
s_add_u32 s64, s73, 149376
ds_read_b64_tr_b16 a[102:103], v21 offset:43264
v_mfma_f32_16x16x32_bf16 v[72:75], a[40:43], a[32:35], v[72:75]
buffer_load_dwordx4 v13, s[48:51], s64 offen lds
v_mfma_f32_16x16x32_bf16 v[88:91], a[44:47], a[20:23], v[88:91]
v_mfma_f32_16x16x32_bf16 v[104:107], a[44:47], a[24:27], v[104:107]
v_mfma_f32_16x16x32_bf16 v[120:123], a[44:47], a[28:31], v[120:123]
v_mfma_f32_16x16x32_bf16 v[136:139], a[44:47], a[32:35], v[136:139]
v_mfma_f32_16x16x32_bf16 v[28:31], a[48:51], a[20:23], v[28:31]
s_waitcnt vmcnt(9) lgkmcnt(0)
s_barrier
v_mfma_f32_16x16x32_bf16 v[44:47], a[48:51], a[24:27], v[44:47]
s_add_u32 m0, s77, 98304
ds_read_b64_tr_b16 a[40:41], v4 offset:0
v_mfma_f32_16x16x32_bf16 v[60:63], a[48:51], a[28:31], v[60:63]
s_add_u32 s64, s71, 7864320
ds_read_b64_tr_b16 a[42:43], v4 offset:1024
v_mfma_f32_16x16x32_bf16 v[76:79], a[48:51], a[32:35], v[76:79]
buffer_load_dwordx4 v14, s[56:59], s64 offen lds
v_mfma_f32_16x16x32_bf16 v[92:95], a[52:55], a[20:23], v[92:95]
ds_read_b64_tr_b16 a[44:45], v5 offset:0
v_mfma_f32_16x16x32_bf16 v[108:111], a[52:55], a[24:27], v[108:111]
ds_read_b64_tr_b16 a[46:47], v5 offset:1024
v_mfma_f32_16x16x32_bf16 v[124:127], a[52:55], a[28:31], v[124:127]
ds_read_b64_tr_b16 a[48:49], v6 offset:0
v_mfma_f32_16x16x32_bf16 v[140:143], a[52:55], a[32:35], v[140:143]
s_add_u32 m0, s77, 99328
ds_read_b64_tr_b16 a[50:51], v6 offset:1024
v_mfma_f32_16x16x32_bf16 v[32:35], a[56:59], a[20:23], v[32:35]
s_add_u32 s64, s71, 7897088
ds_read_b64_tr_b16 a[52:53], v7 offset:0
v_mfma_f32_16x16x32_bf16 v[48:51], a[56:59], a[24:27], v[48:51]
buffer_load_dwordx4 v14, s[56:59], s64 offen lds
v_mfma_f32_16x16x32_bf16 v[64:67], a[56:59], a[28:31], v[64:67]
ds_read_b64_tr_b16 a[54:55], v7 offset:1024
v_mfma_f32_16x16x32_bf16 v[80:83], a[56:59], a[32:35], v[80:83]
ds_read_b64_tr_b16 a[56:57], v8 offset:0
v_mfma_f32_16x16x32_bf16 v[96:99], a[60:63], a[20:23], v[96:99]
ds_read_b64_tr_b16 a[58:59], v8 offset:1024
v_mfma_f32_16x16x32_bf16 v[112:115], a[60:63], a[24:27], v[112:115]
ds_read_b128 a[0:3], v2 offset:0
v_mfma_f32_16x16x32_bf16 v[128:131], a[60:63], a[28:31], v[128:131]
s_add_u32 m0, s77, 100352
ds_read_b128 a[4:7], v2 offset:2048
v_mfma_f32_16x16x32_bf16 v[144:147], a[60:63], a[32:35], v[144:147]
s_add_u32 s64, s71, 7929856
ds_read_b64_tr_b16 a[60:61], v9 offset:0
v_mfma_f32_16x16x32_bf16 v[36:39], a[64:67], a[20:23], v[36:39]
buffer_load_dwordx4 v15, s[56:59], s64 offen lds
v_mfma_f32_16x16x32_bf16 v[52:55], a[64:67], a[24:27], v[52:55]
ds_read_b64_tr_b16 a[62:63], v9 offset:1024
v_mfma_f32_16x16x32_bf16 v[68:71], a[64:67], a[28:31], v[68:71]
ds_read_b128 a[8:11], v2 offset:4096
v_mfma_f32_16x16x32_bf16 v[84:87], a[64:67], a[32:35], v[84:87]
ds_read_b128 a[12:15], v2 offset:6144
v_mfma_f32_16x16x32_bf16 v[100:103], a[68:71], a[20:23], v[100:103]
ds_read_b64_tr_b16 a[64:65], v10 offset:0
v_mfma_f32_16x16x32_bf16 v[116:119], a[68:71], a[24:27], v[116:119]
s_add_u32 m0, s77, 101376
ds_read_b64_tr_b16 a[66:67], v10 offset:1024
v_mfma_f32_16x16x32_bf16 v[132:135], a[68:71], a[28:31], v[132:135]
s_add_u32 s64, s71, 7962624
ds_read_b128 a[16:19], v17 offset:0
v_mfma_f32_16x16x32_bf16 v[148:151], a[68:71], a[32:35], v[148:151]
buffer_load_dwordx4 v15, s[56:59], s64 offen lds
v_mfma_f32_16x16x32_bf16 v[152:155], a[72:75], a[20:23], v[152:155]
ds_read_b64_tr_b16 a[68:69], v11 offset:0
v_mfma_f32_16x16x32_bf16 v[160:163], a[72:75], a[24:27], v[160:163]
ds_read_b64_tr_b16 a[70:71], v11 offset:1024
v_mfma_f32_16x16x32_bf16 v[168:171], a[72:75], a[28:31], v[168:171]
v_mfma_f32_16x16x32_bf16 v[176:179], a[72:75], a[32:35], v[176:179]
ds_read_b64_tr_b16 a[72:73], v19 offset:0
v_mfma_f32_16x16x32_bf16 v[156:159], a[76:79], a[20:23], v[156:159]
s_add_u32 m0, s78, 114688
ds_read_b64_tr_b16 a[74:75], v19 offset:256
v_mfma_f32_16x16x32_bf16 v[164:167], a[76:79], a[24:27], v[164:167]
s_add_u32 s64, s75, 5898240
v_mfma_f32_16x16x32_bf16 v[172:175], a[76:79], a[28:31], v[172:175]
buffer_load_dwordx4 v23, s[60:63], s64 offen lds
v_mfma_f32_16x16x32_bf16 v[180:183], a[76:79], a[32:35], v[180:183]
ds_read_b64_tr_b16 a[76:77], v20 offset:0
v_mfma_f32_16x16x32_bf16 v[184:187], a[80:83], a[20:23], v[184:187]
ds_read_b64_tr_b16 a[78:79], v20 offset:256
v_mfma_f32_16x16x32_bf16 v[192:195], a[80:83], a[24:27], v[192:195]
v_mfma_f32_16x16x32_bf16 v[200:203], a[80:83], a[28:31], v[200:203]
v_mfma_f32_16x16x32_bf16 v[208:211], a[80:83], a[32:35], v[208:211]
s_add_u32 m0, s78, 118784
ds_read_b64_tr_b16 a[80:81], v19 offset:4096
v_mfma_f32_16x16x32_bf16 v[188:191], a[84:87], a[20:23], v[188:191]
s_add_u32 s64, s75, 5900288
ds_read_b64_tr_b16 a[82:83], v19 offset:4352
v_mfma_f32_16x16x32_bf16 v[196:199], a[84:87], a[24:27], v[196:199]
buffer_load_dwordx4 v23, s[60:63], s64 offen lds
v_mfma_f32_16x16x32_bf16 v[204:207], a[84:87], a[28:31], v[204:207]
v_mfma_f32_16x16x32_bf16 v[212:215], a[84:87], a[32:35], v[212:215]
ds_read_b64_tr_b16 a[84:85], v20 offset:4096
v_mfma_f32_16x16x32_bf16 v[216:219], a[20:23], a[88:91], v[216:219]
ds_read_b64_tr_b16 a[86:87], v20 offset:4352
v_mfma_f32_16x16x32_bf16 v[224:227], a[24:27], a[88:91], v[224:227]
v_mfma_f32_16x16x32_bf16 v[232:235], a[28:31], a[88:91], v[232:235]
s_add_u32 m0, s78, 122880
v_mfma_f32_16x16x32_bf16 v[240:243], a[32:35], a[88:91], v[240:243]
s_add_u32 s64, s75, 5902336
ds_read_b64_tr_b16 a[88:89], v19 offset:8192
v_mfma_f32_16x16x32_bf16 v[220:223], a[20:23], a[92:95], v[220:223]
buffer_load_dwordx4 v23, s[60:63], s64 offen lds
v_mfma_f32_16x16x32_bf16 v[228:231], a[24:27], a[92:95], v[228:231]
ds_read_b64_tr_b16 a[90:91], v19 offset:8448
v_mfma_f32_16x16x32_bf16 v[236:239], a[28:31], a[92:95], v[236:239]
v_mfma_f32_16x16x32_bf16 v[244:247], a[32:35], a[92:95], v[244:247]
ds_read_b64_tr_b16 a[92:93], v20 offset:8192
v_mfma_f32_16x16x32_bf16 v[248:251], a[96:99], a[36:39], v[248:251]
ds_read_b64_tr_b16 a[94:95], v20 offset:8448
v_mfma_f32_16x16x32_bf16 v[252:255], a[36:39], a[100:103], v[252:255]
s_waitcnt lgkmcnt(5)
s_add_u32 m0, s78, 126976
ds_read_b64_tr_b16 a[96:97], v21 offset:4096
v_mfma_f32_16x16x32_bf16 v[24:27], a[40:43], a[0:3], v[24:27]
s_add_u32 s64, s74, 1920
ds_read_b128 a[20:23], v3 offset:0
v_mfma_f32_16x16x32_bf16 v[40:43], a[40:43], a[4:7], v[40:43]
buffer_load_dwordx4 v22, s[48:51], s64 offen lds
v_mfma_f32_16x16x32_bf16 v[56:59], a[40:43], a[8:11], v[56:59]
ds_read_b128 a[24:27], v3 offset:2048
v_mfma_f32_16x16x32_bf16 v[72:75], a[40:43], a[12:15], v[72:75]
ds_read_b128 a[28:31], v3 offset:4096
v_mfma_f32_16x16x32_bf16 v[88:91], a[44:47], a[0:3], v[88:91]
ds_read_b128 a[32:35], v3 offset:6144
v_mfma_f32_16x16x32_bf16 v[104:107], a[44:47], a[4:7], v[104:107]
ds_read_b64_tr_b16 a[40:41], v4 offset:8192
v_mfma_f32_16x16x32_bf16 v[120:123], a[44:47], a[8:11], v[120:123]
ds_read_b64_tr_b16 a[42:43], v4 offset:9216
v_mfma_f32_16x16x32_bf16 v[136:139], a[44:47], a[12:15], v[136:139]
ds_read_b64_tr_b16 a[44:45], v5 offset:8192
v_mfma_f32_16x16x32_bf16 v[28:31], a[48:51], a[0:3], v[28:31]
ds_read_b64_tr_b16 a[46:47], v5 offset:9216
v_mfma_f32_16x16x32_bf16 v[44:47], a[48:51], a[4:7], v[44:47]
ds_read_b64_tr_b16 a[98:99], v21 offset:4352
v_mfma_f32_16x16x32_bf16 v[60:63], a[48:51], a[8:11], v[60:63]
ds_read_b64_tr_b16 a[100:101], v21 offset:8192
v_mfma_f32_16x16x32_bf16 v[76:79], a[48:51], a[12:15], v[76:79]
ds_read_b64_tr_b16 a[102:103], v21 offset:8448
v_mfma_f32_16x16x32_bf16 v[92:95], a[52:55], a[0:3], v[92:95]
ds_read_b64_tr_b16 a[48:49], v6 offset:8192
v_mfma_f32_16x16x32_bf16 v[108:111], a[52:55], a[4:7], v[108:111]
ds_read_b64_tr_b16 a[50:51], v6 offset:9216
v_mfma_f32_16x16x32_bf16 v[124:127], a[52:55], a[8:11], v[124:127]
s_lshl_b32 s68, s31, 20
s_add_u32 s32, s28, s68
s_addc_u32 s33, s29, 0
v_mfma_f32_16x16x32_bf16 v[140:143], a[52:55], a[12:15], v[140:143]
ds_read_b64_tr_b16 a[52:53], v7 offset:8192
v_mfma_f32_16x16x32_bf16 v[32:35], a[56:59], a[0:3], v[32:35]
ds_read_b64_tr_b16 a[54:55], v7 offset:9216
v_mfma_f32_16x16x32_bf16 v[48:51], a[56:59], a[4:7], v[48:51]
s_add_u32 s68, s16, 1
s_lshl_b32 s34, s68, 16
v_mfma_f32_16x16x32_bf16 v[64:67], a[56:59], a[8:11], v[64:67]
ds_read_b128 a[36:39], v18 offset:0
v_mfma_f32_16x16x32_bf16 v[80:83], a[56:59], a[12:15], v[80:83]
ds_read_b64_tr_b16 a[56:57], v8 offset:8192
v_mfma_f32_16x16x32_bf16 v[96:99], a[60:63], a[0:3], v[96:99]
ds_read_b64_tr_b16 a[58:59], v8 offset:9216
v_mfma_f32_16x16x32_bf16 v[112:115], a[60:63], a[4:7], v[112:115]
v_mfma_f32_16x16x32_bf16 v[128:131], a[60:63], a[8:11], v[128:131]
v_mfma_f32_16x16x32_bf16 v[144:147], a[60:63], a[12:15], v[144:147]
ds_read_b64_tr_b16 a[60:61], v9 offset:8192
v_mfma_f32_16x16x32_bf16 v[36:39], a[64:67], a[0:3], v[36:39]
ds_read_b64_tr_b16 a[62:63], v9 offset:9216
v_mfma_f32_16x16x32_bf16 v[52:55], a[64:67], a[4:7], v[52:55]
v_mfma_f32_16x16x32_bf16 v[68:71], a[64:67], a[8:11], v[68:71]
v_mfma_f32_16x16x32_bf16 v[84:87], a[64:67], a[12:15], v[84:87]
ds_read_b64_tr_b16 a[64:65], v10 offset:8192
v_mfma_f32_16x16x32_bf16 v[100:103], a[68:71], a[0:3], v[100:103]
ds_read_b64_tr_b16 a[66:67], v10 offset:9216
v_mfma_f32_16x16x32_bf16 v[116:119], a[68:71], a[4:7], v[116:119]
v_mfma_f32_16x16x32_bf16 v[132:135], a[68:71], a[8:11], v[132:135]
v_mfma_f32_16x16x32_bf16 v[148:151], a[68:71], a[12:15], v[148:151]
ds_read_b64_tr_b16 a[68:69], v11 offset:8192
v_mfma_f32_16x16x32_bf16 v[152:155], a[72:75], a[0:3], v[152:155]
ds_read_b64_tr_b16 a[70:71], v11 offset:9216
v_mfma_f32_16x16x32_bf16 v[160:163], a[72:75], a[4:7], v[160:163]
v_mfma_f32_16x16x32_bf16 v[168:171], a[72:75], a[8:11], v[168:171]
v_mfma_f32_16x16x32_bf16 v[176:179], a[72:75], a[12:15], v[176:179]
ds_read_b64_tr_b16 a[72:73], v19 offset:2048
v_mfma_f32_16x16x32_bf16 v[156:159], a[76:79], a[0:3], v[156:159]
ds_read_b64_tr_b16 a[74:75], v19 offset:2304
v_mfma_f32_16x16x32_bf16 v[164:167], a[76:79], a[4:7], v[164:167]
v_mfma_f32_16x16x32_bf16 v[172:175], a[76:79], a[8:11], v[172:175]
v_mfma_f32_16x16x32_bf16 v[180:183], a[76:79], a[12:15], v[180:183]
ds_read_b64_tr_b16 a[76:77], v20 offset:2048
v_mfma_f32_16x16x32_bf16 v[184:187], a[80:83], a[0:3], v[184:187]
ds_read_b64_tr_b16 a[78:79], v20 offset:2304
v_mfma_f32_16x16x32_bf16 v[192:195], a[80:83], a[4:7], v[192:195]
v_mfma_f32_16x16x32_bf16 v[200:203], a[80:83], a[8:11], v[200:203]
v_mfma_f32_16x16x32_bf16 v[208:211], a[80:83], a[12:15], v[208:211]
s_waitcnt lgkmcnt(4)
ds_read_b64_tr_b16 a[80:81], v19 offset:6144
v_mfma_f32_16x16x32_bf16 v[188:191], a[84:87], a[0:3], v[188:191]
ds_read_b64_tr_b16 a[82:83], v19 offset:6400
v_mfma_f32_16x16x32_bf16 v[196:199], a[84:87], a[4:7], v[196:199]
v_mfma_f32_16x16x32_bf16 v[204:207], a[84:87], a[8:11], v[204:207]
v_mfma_f32_16x16x32_bf16 v[212:215], a[84:87], a[12:15], v[212:215]
ds_read_b64_tr_b16 a[84:85], v20 offset:6144
v_mfma_f32_16x16x32_bf16 v[216:219], a[0:3], a[88:91], v[216:219]
ds_read_b64_tr_b16 a[86:87], v20 offset:6400
v_mfma_f32_16x16x32_bf16 v[224:227], a[4:7], a[88:91], v[224:227]
v_mfma_f32_16x16x32_bf16 v[232:235], a[8:11], a[88:91], v[232:235]
v_mfma_f32_16x16x32_bf16 v[240:243], a[12:15], a[88:91], v[240:243]
ds_read_b64_tr_b16 a[88:89], v19 offset:10240
v_mfma_f32_16x16x32_bf16 v[220:223], a[0:3], a[92:95], v[220:223]
ds_read_b64_tr_b16 a[90:91], v19 offset:10496
v_mfma_f32_16x16x32_bf16 v[228:231], a[4:7], a[92:95], v[228:231]
v_mfma_f32_16x16x32_bf16 v[236:239], a[8:11], a[92:95], v[236:239]
v_mfma_f32_16x16x32_bf16 v[244:247], a[12:15], a[92:95], v[244:247]
ds_read_b64_tr_b16 a[92:93], v20 offset:10240
v_mfma_f32_16x16x32_bf16 v[248:251], a[96:99], a[16:19], v[248:251]
ds_read_b64_tr_b16 a[94:95], v20 offset:10496
v_mfma_f32_16x16x32_bf16 v[252:255], a[16:19], a[100:103], v[252:255]
ds_read_b64_tr_b16 a[96:97], v21 offset:6144
v_mfma_f32_16x16x32_bf16 v[24:27], a[40:43], a[20:23], v[24:27]
ds_read_b64_tr_b16 a[98:99], v21 offset:6400
v_mfma_f32_16x16x32_bf16 v[40:43], a[40:43], a[24:27], v[40:43]
ds_read_b64_tr_b16 a[100:101], v21 offset:10240
v_mfma_f32_16x16x32_bf16 v[56:59], a[40:43], a[28:31], v[56:59]
ds_read_b64_tr_b16 a[102:103], v21 offset:10496
v_mfma_f32_16x16x32_bf16 v[72:75], a[40:43], a[32:35], v[72:75]
v_mfma_f32_16x16x32_bf16 v[88:91], a[44:47], a[20:23], v[88:91]
v_mfma_f32_16x16x32_bf16 v[104:107], a[44:47], a[24:27], v[104:107]
v_mfma_f32_16x16x32_bf16 v[120:123], a[44:47], a[28:31], v[120:123]
v_mfma_f32_16x16x32_bf16 v[136:139], a[44:47], a[32:35], v[136:139]
v_mfma_f32_16x16x32_bf16 v[28:31], a[48:51], a[20:23], v[28:31]
s_waitcnt vmcnt(0) lgkmcnt(0)
s_barrier
v_mfma_f32_16x16x32_bf16 v[44:47], a[48:51], a[24:27], v[44:47]
v_readfirstlane_b32 s66, v1
s_nop 0
s_cmp_lt_u32 s66, 256
s_cbranch_scc1 L_spin_1
L_spinbk_2:
v_mfma_f32_16x16x32_bf16 v[60:63], a[48:51], a[28:31], v[60:63]
ds_read_b64_tr_b16 a[40:41], v4 offset:32768
v_mfma_f32_16x16x32_bf16 v[76:79], a[48:51], a[32:35], v[76:79]
s_mov_b32 m0, s76
ds_read_b64_tr_b16 a[42:43], v4 offset:33792
v_mfma_f32_16x16x32_bf16 v[92:95], a[52:55], a[20:23], v[92:95]
s_lshl_b32 s64, s30, 14
ds_read_b64_tr_b16 a[44:45], v5 offset:32768
v_mfma_f32_16x16x32_bf16 v[108:111], a[52:55], a[24:27], v[108:111]
buffer_load_dwordx4 v16, s[32:35], s64 offen offset:0 sc1 lds
v_mfma_f32_16x16x32_bf16 v[124:127], a[52:55], a[28:31], v[124:127]
ds_read_b64_tr_b16 a[46:47], v5 offset:33792
v_mfma_f32_16x16x32_bf16 v[140:143], a[52:55], a[32:35], v[140:143]
ds_read_b64_tr_b16 a[48:49], v6 offset:32768
v_mfma_f32_16x16x32_bf16 v[32:35], a[56:59], a[20:23], v[32:35]
ds_read_b64_tr_b16 a[50:51], v6 offset:33792
v_mfma_f32_16x16x32_bf16 v[48:51], a[56:59], a[24:27], v[48:51]
ds_read_b64_tr_b16 a[52:53], v7 offset:32768
v_mfma_f32_16x16x32_bf16 v[64:67], a[56:59], a[28:31], v[64:67]
ds_read_b64_tr_b16 a[54:55], v7 offset:33792
v_mfma_f32_16x16x32_bf16 v[80:83], a[56:59], a[32:35], v[80:83]
buffer_load_dwordx4 v16, s[32:35], s64 offen offset:1024 sc1 lds
v_mfma_f32_16x16x32_bf16 v[96:99], a[60:63], a[20:23], v[96:99]
ds_read_b64_tr_b16 a[56:57], v8 offset:32768
v_mfma_f32_16x16x32_bf16 v[112:115], a[60:63], a[24:27], v[112:115]
ds_read_b64_tr_b16 a[58:59], v8 offset:33792
v_mfma_f32_16x16x32_bf16 v[128:131], a[60:63], a[28:31], v[128:131]
ds_read_b128 a[0:3], v2 offset:32768
v_mfma_f32_16x16x32_bf16 v[144:147], a[60:63], a[32:35], v[144:147]
ds_read_b64_tr_b16 a[60:61], v9 offset:32768
v_mfma_f32_16x16x32_bf16 v[36:39], a[64:67], a[20:23], v[36:39]
ds_read_b64_tr_b16 a[62:63], v9 offset:33792
v_mfma_f32_16x16x32_bf16 v[52:55], a[64:67], a[24:27], v[52:55]
buffer_load_dwordx4 v16, s[32:35], s64 offen offset:2048 sc1 lds
v_mfma_f32_16x16x32_bf16 v[68:71], a[64:67], a[28:31], v[68:71]
ds_read_b128 a[4:7], v2 offset:34816
v_mfma_f32_16x16x32_bf16 v[84:87], a[64:67], a[32:35], v[84:87]
ds_read_b128 a[8:11], v2 offset:36864
v_mfma_f32_16x16x32_bf16 v[100:103], a[68:71], a[20:23], v[100:103]
ds_read_b128 a[12:15], v2 offset:38912
v_mfma_f32_16x16x32_bf16 v[116:119], a[68:71], a[24:27], v[116:119]
ds_read_b64_tr_b16 a[64:65], v10 offset:32768
v_mfma_f32_16x16x32_bf16 v[132:135], a[68:71], a[28:31], v[132:135]
ds_read_b64_tr_b16 a[66:67], v10 offset:33792
v_mfma_f32_16x16x32_bf16 v[148:151], a[68:71], a[32:35], v[148:151]
buffer_load_dwordx4 v16, s[32:35], s64 offen offset:3072 sc1 lds
v_mfma_f32_16x16x32_bf16 v[152:155], a[72:75], a[20:23], v[152:155]
ds_read_b64_tr_b16 a[68:69], v11 offset:32768
v_mfma_f32_16x16x32_bf16 v[160:163], a[72:75], a[24:27], v[160:163]
ds_read_b64_tr_b16 a[70:71], v11 offset:33792
v_mfma_f32_16x16x32_bf16 v[168:171], a[72:75], a[28:31], v[168:171]
ds_read_b128 a[16:19], v17 offset:32768
v_mfma_f32_16x16x32_bf16 v[176:179], a[72:75], a[32:35], v[176:179]
s_add_u32 m0, s76, 4096
ds_read_b64_tr_b16 a[72:73], v19 offset:32768
v_mfma_f32_16x16x32_bf16 v[156:159], a[76:79], a[20:23], v[156:159]
s_add_u32 s64, s64, 4096
ds_read_b64_tr_b16 a[74:75], v19 offset:33024
v_mfma_f32_16x16x32_bf16 v[164:167], a[76:79], a[24:27], v[164:167]
buffer_load_dwordx4 v16, s[32:35], s64 offen offset:0 sc1 lds
v_mfma_f32_16x16x32_bf16 v[172:175], a[76:79], a[28:31], v[172:175]
v_mfma_f32_16x16x32_bf16 v[180:183], a[76:79], a[32:35], v[180:183]
ds_read_b64_tr_b16 a[76:77], v20 offset:32768
v_mfma_f32_16x16x32_bf16 v[184:187], a[80:83], a[20:23], v[184:187]
ds_read_b64_tr_b16 a[78:79], v20 offset:33024
v_mfma_f32_16x16x32_bf16 v[192:195], a[80:83], a[24:27], v[192:195]
v_mfma_f32_16x16x32_bf16 v[200:203], a[80:83], a[28:31], v[200:203]
v_mfma_f32_16x16x32_bf16 v[208:211], a[80:83], a[32:35], v[208:211]
buffer_load_dwordx4 v16, s[32:35], s64 offen offset:1024 sc1 lds
v_mfma_f32_16x16x32_bf16 v[188:191], a[84:87], a[20:23], v[188:191]
ds_read_b64_tr_b16 a[80:81], v19 offset:36864
v_mfma_f32_16x16x32_bf16 v[196:199], a[84:87], a[24:27], v[196:199]
ds_read_b64_tr_b16 a[82:83], v19 offset:37120
v_mfma_f32_16x16x32_bf16 v[204:207], a[84:87], a[28:31], v[204:207]
v_mfma_f32_16x16x32_bf16 v[212:215], a[84:87], a[32:35], v[212:215]
ds_read_b64_tr_b16 a[84:85], v20 offset:36864
v_mfma_f32_16x16x32_bf16 v[216:219], a[20:23], a[88:91], v[216:219]
ds_read_b64_tr_b16 a[86:87], v20 offset:37120
v_mfma_f32_16x16x32_bf16 v[224:227], a[24:27], a[88:91], v[224:227]
buffer_load_dwordx4 v16, s[32:35], s64 offen offset:2048 sc1 lds
v_mfma_f32_16x16x32_bf16 v[232:235], a[28:31], a[88:91], v[232:235]
v_mfma_f32_16x16x32_bf16 v[240:243], a[32:35], a[88:91], v[240:243]
ds_read_b64_tr_b16 a[88:89], v19 offset:40960
v_mfma_f32_16x16x32_bf16 v[220:223], a[20:23], a[92:95], v[220:223]
ds_read_b64_tr_b16 a[90:91], v19 offset:41216
v_mfma_f32_16x16x32_bf16 v[228:231], a[24:27], a[92:95], v[228:231]
v_mfma_f32_16x16x32_bf16 v[236:239], a[28:31], a[92:95], v[236:239]
v_mfma_f32_16x16x32_bf16 v[244:247], a[32:35], a[92:95], v[244:247]
buffer_load_dwordx4 v16, s[32:35], s64 offen offset:3072 sc1 lds
v_mfma_f32_16x16x32_bf16 v[248:251], a[96:99], a[36:39], v[248:251]
ds_read_b64_tr_b16 a[92:93], v20 offset:40960
v_mfma_f32_16x16x32_bf16 v[252:255], a[36:39], a[100:103], v[252:255]
s_waitcnt lgkmcnt(4)
ds_read_b64_tr_b16 a[94:95], v20 offset:41216
v_mfma_f32_16x16x32_bf16 v[24:27], a[40:43], a[0:3], v[24:27]
ds_read_b128 a[20:23], v3 offset:32768
v_mfma_f32_16x16x32_bf16 v[40:43], a[40:43], a[4:7], v[40:43]
ds_read_b128 a[24:27], v3 offset:34816
v_mfma_f32_16x16x32_bf16 v[56:59], a[40:43], a[8:11], v[56:59]
ds_read_b128 a[28:31], v3 offset:36864
v_mfma_f32_16x16x32_bf16 v[72:75], a[40:43], a[12:15], v[72:75]
s_lshr_b32 s64, s76, 1
s_add_u32 m0, s64, 81920
s_and_b32 s69, s64, 8192
s_add_u32 s64, s64, s69
s_add_u32 s64, s64, 8192
ds_read_b128 a[32:35], v3 offset:38912
v_mfma_f32_16x16x32_bf16 v[88:91], a[44:47], a[0:3], v[88:91]
buffer_load_dwordx4 v16, s[32:35], s64 offen offset:0 sc1 lds
v_mfma_f32_16x16x32_bf16 v[104:107], a[44:47], a[4:7], v[104:107]
ds_read_b64_tr_b16 a[40:41], v4 offset:40960
v_mfma_f32_16x16x32_bf16 v[120:123], a[44:47], a[8:11], v[120:123]
ds_read_b64_tr_b16 a[42:43], v4 offset:41984
v_mfma_f32_16x16x32_bf16 v[136:139], a[44:47], a[12:15], v[136:139]
ds_read_b64_tr_b16 a[44:45], v5 offset:40960
v_mfma_f32_16x16x32_bf16 v[28:31], a[48:51], a[0:3], v[28:31]
ds_read_b64_tr_b16 a[46:47], v5 offset:41984
v_mfma_f32_16x16x32_bf16 v[44:47], a[48:51], a[4:7], v[44:47]
buffer_load_dwordx4 v16, s[32:35], s64 offen offset:1024 sc1 lds
v_mfma_f32_16x16x32_bf16 v[60:63], a[48:51], a[8:11], v[60:63]
ds_read_b64_tr_b16 a[96:97], v21 offset:36864
v_mfma_f32_16x16x32_bf16 v[76:79], a[48:51], a[12:15], v[76:79]
ds_read_b64_tr_b16 a[98:99], v21 offset:37120
v_mfma_f32_16x16x32_bf16 v[92:95], a[52:55], a[0:3], v[92:95]
ds_read_b64_tr_b16 a[100:101], v21 offset:40960
v_mfma_f32_16x16x32_bf16 v[108:111], a[52:55], a[4:7], v[108:111]
ds_read_b64_tr_b16 a[102:103], v21 offset:41216
v_mfma_f32_16x16x32_bf16 v[124:127], a[52:55], a[8:11], v[124:127]
ds_read_b64_tr_b16 a[48:49], v6 offset:40960
v_mfma_f32_16x16x32_bf16 v[140:143], a[52:55], a[12:15], v[140:143]
buffer_load_dwordx4 v16, s[32:35], s64 offen offset:2048 sc1 lds
v_mfma_f32_16x16x32_bf16 v[32:35], a[56:59], a[0:3], v[32:35]
ds_read_b64_tr_b16 a[50:51], v6 offset:41984
v_mfma_f32_16x16x32_bf16 v[48:51], a[56:59], a[4:7], v[48:51]
ds_read_b64_tr_b16 a[52:53], v7 offset:40960
v_mfma_f32_16x16x32_bf16 v[64:67], a[56:59], a[8:11], v[64:67]
ds_read_b64_tr_b16 a[54:55], v7 offset:41984
v_mfma_f32_16x16x32_bf16 v[80:83], a[56:59], a[12:15], v[80:83]
ds_read_b64_tr_b16 a[56:57], v8 offset:40960
v_mfma_f32_16x16x32_bf16 v[96:99], a[60:63], a[0:3], v[96:99]
ds_read_b64_tr_b16 a[58:59], v8 offset:41984
v_mfma_f32_16x16x32_bf16 v[112:115], a[60:63], a[4:7], v[112:115]
buffer_load_dwordx4 v16, s[32:35], s64 offen offset:3072 sc1 lds
v_mfma_f32_16x16x32_bf16 v[128:131], a[60:63], a[8:11], v[128:131]
ds_read_b128 a[36:39], v18 offset:32768
v_mfma_f32_16x16x32_bf16 v[144:147], a[60:63], a[12:15], v[144:147]
ds_read_b64_tr_b16 a[60:61], v9 offset:40960
v_mfma_f32_16x16x32_bf16 v[36:39], a[64:67], a[0:3], v[36:39]
ds_read_b64_tr_b16 a[62:63], v9 offset:41984
v_mfma_f32_16x16x32_bf16 v[52:55], a[64:67], a[4:7], v[52:55]
v_mfma_f32_16x16x32_bf16 v[68:71], a[64:67], a[8:11], v[68:71]
v_mfma_f32_16x16x32_bf16 v[84:87], a[64:67], a[12:15], v[84:87]
ds_read_b64_tr_b16 a[64:65], v10 offset:40960
v_mfma_f32_16x16x32_bf16 v[100:103], a[68:71], a[0:3], v[100:103]
ds_read_b64_tr_b16 a[66:67], v10 offset:41984
v_mfma_f32_16x16x32_bf16 v[116:119], a[68:71], a[4:7], v[116:119]
v_mfma_f32_16x16x32_bf16 v[132:135], a[68:71], a[8:11], v[132:135]
v_mfma_f32_16x16x32_bf16 v[148:151], a[68:71], a[12:15], v[148:151]
ds_read_b64_tr_b16 a[68:69], v11 offset:40960
v_mfma_f32_16x16x32_bf16 v[152:155], a[72:75], a[0:3], v[152:155]
ds_read_b64_tr_b16 a[70:71], v11 offset:41984
v_mfma_f32_16x16x32_bf16 v[160:163], a[72:75], a[4:7], v[160:163]
v_mfma_f32_16x16x32_bf16 v[168:171], a[72:75], a[8:11], v[168:171]
v_mfma_f32_16x16x32_bf16 v[176:179], a[72:75], a[12:15], v[176:179]
ds_read_b64_tr_b16 a[72:73], v19 offset:34816
v_mfma_f32_16x16x32_bf16 v[156:159], a[76:79], a[0:3], v[156:159]
ds_read_b64_tr_b16 a[74:75], v19 offset:35072
v_mfma_f32_16x16x32_bf16 v[164:167], a[76:79], a[4:7], v[164:167]
v_mfma_f32_16x16x32_bf16 v[172:175], a[76:79], a[8:11], v[172:175]
v_mfma_f32_16x16x32_bf16 v[180:183], a[76:79], a[12:15], v[180:183]
ds_read_b64_tr_b16 a[76:77], v20 offset:34816
v_mfma_f32_16x16x32_bf16 v[184:187], a[80:83], a[0:3], v[184:187]
ds_read_b64_tr_b16 a[78:79], v20 offset:35072
v_mfma_f32_16x16x32_bf16 v[192:195], a[80:83], a[4:7], v[192:195]
v_mfma_f32_16x16x32_bf16 v[200:203], a[80:83], a[8:11], v[200:203]
v_mfma_f32_16x16x32_bf16 v[208:211], a[80:83], a[12:15], v[208:211]
s_waitcnt lgkmcnt(4)
ds_read_b64_tr_b16 a[80:81], v19 offset:38912
v_mfma_f32_16x16x32_bf16 v[188:191], a[84:87], a[0:3], v[188:191]
ds_read_b64_tr_b16 a[82:83], v19 offset:39168
v_mfma_f32_16x16x32_bf16 v[196:199], a[84:87], a[4:7], v[196:199]
v_mfma_f32_16x16x32_bf16 v[204:207], a[84:87], a[8:11], v[204:207]
v_mfma_f32_16x16x32_bf16 v[212:215], a[84:87], a[12:15], v[212:215]
ds_read_b64_tr_b16 a[84:85], v20 offset:38912
v_mfma_f32_16x16x32_bf16 v[216:219], a[0:3], a[88:91], v[216:219]
ds_read_b64_tr_b16 a[86:87], v20 offset:39168
v_mfma_f32_16x16x32_bf16 v[224:227], a[4:7], a[88:91], v[224:227]
v_mfma_f32_16x16x32_bf16 v[232:235], a[8:11], a[88:91], v[232:235]
v_mfma_f32_16x16x32_bf16 v[240:243], a[12:15], a[88:91], v[240:243]
ds_read_b64_tr_b16 a[88:89], v19 offset:43008
v_mfma_f32_16x16x32_bf16 v[220:223], a[0:3], a[92:95], v[220:223]
ds_read_b64_tr_b16 a[90:91], v19 offset:43264
v_mfma_f32_16x16x32_bf16 v[228:231], a[4:7], a[92:95], v[228:231]
v_mfma_f32_16x16x32_bf16 v[236:239], a[8:11], a[92:95], v[236:239]
v_mfma_f32_16x16x32_bf16 v[244:247], a[12:15], a[92:95], v[244:247]
ds_read_b64_tr_b16 a[92:93], v20 offset:43008
v_mfma_f32_16x16x32_bf16 v[248:251], a[96:99], a[16:19], v[248:251]
ds_read_b64_tr_b16 a[94:95], v20 offset:43264
v_mfma_f32_16x16x32_bf16 v[252:255], a[16:19], a[100:103], v[252:255]
ds_read_b64_tr_b16 a[96:97], v21 offset:38912
v_mfma_f32_16x16x32_bf16 v[24:27], a[40:43], a[20:23], v[24:27]
ds_read_b64_tr_b16 a[98:99], v21 offset:39168
v_mfma_f32_16x16x32_bf16 v[40:43], a[40:43], a[24:27], v[40:43]
ds_read_b64_tr_b16 a[100:101], v21 offset:43008
v_mfma_f32_16x16x32_bf16 v[56:59], a[40:43], a[28:31], v[56:59]
ds_read_b64_tr_b16 a[102:103], v21 offset:43264
v_mfma_f32_16x16x32_bf16 v[72:75], a[40:43], a[32:35], v[72:75]
v_mfma_f32_16x16x32_bf16 v[88:91], a[44:47], a[20:23], v[88:91]
v_mfma_f32_16x16x32_bf16 v[104:107], a[44:47], a[24:27], v[104:107]
v_mfma_f32_16x16x32_bf16 v[120:123], a[44:47], a[28:31], v[120:123]
v_mfma_f32_16x16x32_bf16 v[136:139], a[44:47], a[32:35], v[136:139]
v_mfma_f32_16x16x32_bf16 v[28:31], a[48:51], a[20:23], v[28:31]
s_waitcnt lgkmcnt(0)
s_barrier
v_mfma_f32_16x16x32_bf16 v[44:47], a[48:51], a[24:27], v[44:47]
v_and_b32 v12, 15, v0
v_mfma_f32_16x16x32_bf16 v[60:63], a[48:51], a[28:31], v[60:63]
v_lshlrev_b32 v12, 3, v12
v_mfma_f32_16x16x32_bf16 v[76:79], a[48:51], a[32:35], v[76:79]
s_lshl_b32 s66, s30, 7
v_mfma_f32_16x16x32_bf16 v[92:95], a[52:55], a[20:23], v[92:95]
s_add_u32 s66, s66, 58720256
v_mfma_f32_16x16x32_bf16 v[108:111], a[52:55], a[24:27], v[108:111]
s_lshl_b32 s67, s3, 10
v_mfma_f32_16x16x32_bf16 v[124:127], a[52:55], a[28:31], v[124:127]
s_add_u32 s67, s67, s66
v_mfma_f32_16x16x32_bf16 v[140:143], a[52:55], a[32:35], v[140:143]
s_lshl_b32 s68, s16, 10
v_mfma_f32_16x16x32_bf16 v[32:35], a[56:59], a[20:23], v[32:35]
s_add_u32 s68, s68, s66
v_mfma_f32_16x16x32_bf16 v[48:51], a[56:59], a[24:27], v[48:51]
buffer_load_dwordx2 v[4:5], v12, s[44:47], s67 offen offset:0 sc1
v_mfma_f32_16x16x32_bf16 v[64:67], a[56:59], a[28:31], v[64:67]
buffer_load_dwordx2 v[6:7], v12, s[44:47], s67 offen offset:512 sc1
v_mfma_f32_16x16x32_bf16 v[80:83], a[56:59], a[32:35], v[80:83]
buffer_load_dwordx2 v[8:9], v12, s[44:47], s68 offen offset:0 sc1
v_mfma_f32_16x16x32_bf16 v[96:99], a[60:63], a[20:23], v[96:99]
buffer_load_dwordx2 v[10:11], v12, s[44:47], s68 offen offset:512 sc1
v_mfma_f32_16x16x32_bf16 v[112:115], a[60:63], a[24:27], v[112:115]
v_mfma_f32_16x16x32_bf16 v[128:131], a[60:63], a[28:31], v[128:131]
v_mfma_f32_16x16x32_bf16 v[144:147], a[60:63], a[32:35], v[144:147]
v_mfma_f32_16x16x32_bf16 v[36:39], a[64:67], a[20:23], v[36:39]
v_mfma_f32_16x16x32_bf16 v[52:55], a[64:67], a[24:27], v[52:55]
v_mfma_f32_16x16x32_bf16 v[68:71], a[64:67], a[28:31], v[68:71]
v_mfma_f32_16x16x32_bf16 v[84:87], a[64:67], a[32:35], v[84:87]
v_mfma_f32_16x16x32_bf16 v[100:103], a[68:71], a[20:23], v[100:103]
v_mfma_f32_16x16x32_bf16 v[116:119], a[68:71], a[24:27], v[116:119]
v_mfma_f32_16x16x32_bf16 v[132:135], a[68:71], a[28:31], v[132:135]
v_mfma_f32_16x16x32_bf16 v[148:151], a[68:71], a[32:35], v[148:151]
v_mfma_f32_16x16x32_bf16 v[152:155], a[72:75], a[20:23], v[152:155]
v_mfma_f32_16x16x32_bf16 v[160:163], a[72:75], a[24:27], v[160:163]
v_mfma_f32_16x16x32_bf16 v[168:171], a[72:75], a[28:31], v[168:171]
v_mfma_f32_16x16x32_bf16 v[176:179], a[72:75], a[32:35], v[176:179]
v_mfma_f32_16x16x32_bf16 v[156:159], a[76:79], a[20:23], v[156:159]
v_mfma_f32_16x16x32_bf16 v[164:167], a[76:79], a[24:27], v[164:167]
v_mfma_f32_16x16x32_bf16 v[172:175], a[76:79], a[28:31], v[172:175]
v_mfma_f32_16x16x32_bf16 v[180:183], a[76:79], a[32:35], v[180:183]
v_mfma_f32_16x16x32_bf16 v[184:187], a[80:83], a[20:23], v[184:187]
v_mfma_f32_16x16x32_bf16 v[192:195], a[80:83], a[24:27], v[192:195]
v_mfma_f32_16x16x32_bf16 v[200:203], a[80:83], a[28:31], v[200:203]
v_mfma_f32_16x16x32_bf16 v[208:211], a[80:83], a[32:35], v[208:211]
v_mfma_f32_16x16x32_bf16 v[188:191], a[84:87], a[20:23], v[188:191]
v_mfma_f32_16x16x32_bf16 v[196:199], a[84:87], a[24:27], v[196:199]
v_mfma_f32_16x16x32_bf16 v[204:207], a[84:87], a[28:31], v[204:207]
v_mfma_f32_16x16x32_bf16 v[212:215], a[84:87], a[32:35], v[212:215]
v_mfma_f32_16x16x32_bf16 v[216:219], a[20:23], a[88:91], v[216:219]
v_mfma_f32_16x16x32_bf16 v[224:227], a[24:27], a[88:91], v[224:227]
v_mfma_f32_16x16x32_bf16 v[232:235], a[28:31], a[88:91], v[232:235]
v_mfma_f32_16x16x32_bf16 v[240:243], a[32:35], a[88:91], v[240:243]
v_mfma_f32_16x16x32_bf16 v[220:223], a[20:23], a[92:95], v[220:223]
v_mfma_f32_16x16x32_bf16 v[228:231], a[24:27], a[92:95], v[228:231]
v_mfma_f32_16x16x32_bf16 v[236:239], a[28:31], a[92:95], v[236:239]
v_mfma_f32_16x16x32_bf16 v[244:247], a[32:35], a[92:95], v[244:247]
v_mfma_f32_16x16x32_bf16 v[248:251], a[96:99], a[36:39], v[248:251]
v_mfma_f32_16x16x32_bf16 v[252:255], a[36:39], a[100:103], v[252:255]
s_mov_b32 s66, 0x3e0293ee
s_mov_b32 s67, s66
v_pk_mul_f32 v[24:25], v[24:25], s[66:67]
v_pk_mul_f32 v[26:27], v[26:27], s[66:67]
v_pk_mul_f32 v[88:89], v[88:89], s[66:67]
v_pk_mul_f32 v[90:91], v[90:91], s[66:67]
v_cvt_pk_bf16_f32 v24, v24, v25
v_cvt_pk_bf16_f32 v25, v26, v27
v_cvt_pk_bf16_f32 v26, v88, v89
v_cvt_pk_bf16_f32 v27, v90, v91
v_pk_mul_f32 v[28:29], v[28:29], s[66:67]
v_pk_mul_f32 v[30:31], v[30:31], s[66:67]
v_pk_mul_f32 v[92:93], v[92:93], s[66:67]
v_pk_mul_f32 v[94:95], v[94:95], s[66:67]
v_cvt_pk_bf16_f32 v28, v28, v29
v_cvt_pk_bf16_f32 v29, v30, v31
v_cvt_pk_bf16_f32 v30, v92, v93
v_cvt_pk_bf16_f32 v31, v94, v95
v_pk_mul_f32 v[32:33], v[32:33], s[66:67]
v_pk_mul_f32 v[34:35], v[34:35], s[66:67]
v_pk_mul_f32 v[96:97], v[96:97], s[66:67]
v_pk_mul_f32 v[98:99], v[98:99], s[66:67]
v_cvt_pk_bf16_f32 v32, v32, v33
v_cvt_pk_bf16_f32 v33, v34, v35
v_cvt_pk_bf16_f32 v34, v96, v97
v_cvt_pk_bf16_f32 v35, v98, v99
v_pk_mul_f32 v[36:37], v[36:37], s[66:67]
v_pk_mul_f32 v[38:39], v[38:39], s[66:67]
v_pk_mul_f32 v[100:101], v[100:101], s[66:67]
v_pk_mul_f32 v[102:103], v[102:103], s[66:67]
v_cvt_pk_bf16_f32 v36, v36, v37
v_cvt_pk_bf16_f32 v37, v38, v39
v_cvt_pk_bf16_f32 v38, v100, v101
v_cvt_pk_bf16_f32 v39, v102, v103
v_pk_mul_f32 v[40:41], v[40:41], s[66:67]
v_pk_mul_f32 v[42:43], v[42:43], s[66:67]
v_pk_mul_f32 v[104:105], v[104:105], s[66:67]
v_pk_mul_f32 v[106:107], v[106:107], s[66:67]
v_cvt_pk_bf16_f32 v40, v40, v41
v_cvt_pk_bf16_f32 v41, v42, v43
v_cvt_pk_bf16_f32 v42, v104, v105
v_cvt_pk_bf16_f32 v43, v106, v107
v_pk_mul_f32 v[44:45], v[44:45], s[66:67]
v_pk_mul_f32 v[46:47], v[46:47], s[66:67]
v_pk_mul_f32 v[108:109], v[108:109], s[66:67]
v_pk_mul_f32 v[110:111], v[110:111], s[66:67]
v_cvt_pk_bf16_f32 v44, v44, v45
v_cvt_pk_bf16_f32 v45, v46, v47
v_cvt_pk_bf16_f32 v46, v108, v109
v_cvt_pk_bf16_f32 v47, v110, v111
v_pk_mul_f32 v[48:49], v[48:49], s[66:67]
v_pk_mul_f32 v[50:51], v[50:51], s[66:67]
v_pk_mul_f32 v[112:113], v[112:113], s[66:67]
v_pk_mul_f32 v[114:115], v[114:115], s[66:67]
v_cvt_pk_bf16_f32 v48, v48, v49
v_cvt_pk_bf16_f32 v49, v50, v51
v_cvt_pk_bf16_f32 v50, v112, v113
v_cvt_pk_bf16_f32 v51, v114, v115
v_pk_mul_f32 v[52:53], v[52:53], s[66:67]
v_pk_mul_f32 v[54:55], v[54:55], s[66:67]
v_pk_mul_f32 v[116:117], v[116:117], s[66:67]
v_pk_mul_f32 v[118:119], v[118:119], s[66:67]
v_cvt_pk_bf16_f32 v52, v52, v53
v_cvt_pk_bf16_f32 v53, v54, v55
v_cvt_pk_bf16_f32 v54, v116, v117
v_cvt_pk_bf16_f32 v55, v118, v119
v_pk_mul_f32 v[56:57], v[56:57], s[66:67]
v_pk_mul_f32 v[58:59], v[58:59], s[66:67]
v_pk_mul_f32 v[120:121], v[120:121], s[66:67]
v_pk_mul_f32 v[122:123], v[122:123], s[66:67]
v_cvt_pk_bf16_f32 v56, v56, v57
v_cvt_pk_bf16_f32 v57, v58, v59
v_cvt_pk_bf16_f32 v58, v120, v121
v_cvt_pk_bf16_f32 v59, v122, v123
v_pk_mul_f32 v[60:61], v[60:61], s[66:67]
v_pk_mul_f32 v[62:63], v[62:63], s[66:67]
v_pk_mul_f32 v[124:125], v[124:125], s[66:67]
v_pk_mul_f32 v[126:127], v[126:127], s[66:67]
v_cvt_pk_bf16_f32 v60, v60, v61
v_cvt_pk_bf16_f32 v61, v62, v63
v_cvt_pk_bf16_f32 v62, v124, v125
v_cvt_pk_bf16_f32 v63, v126, v127
v_pk_mul_f32 v[64:65], v[64:65], s[66:67]
v_pk_mul_f32 v[66:67], v[66:67], s[66:67]
v_pk_mul_f32 v[128:129], v[128:129], s[66:67]
v_pk_mul_f32 v[130:131], v[130:131], s[66:67]
v_cvt_pk_bf16_f32 v64, v64, v65
v_cvt_pk_bf16_f32 v65, v66, v67
v_cvt_pk_bf16_f32 v66, v128, v129
v_cvt_pk_bf16_f32 v67, v130, v131
v_pk_mul_f32 v[68:69], v[68:69], s[66:67]
v_pk_mul_f32 v[70:71], v[70:71], s[66:67]
v_pk_mul_f32 v[132:133], v[132:133], s[66:67]
v_pk_mul_f32 v[134:135], v[134:135], s[66:67]
v_cvt_pk_bf16_f32 v68, v68, v69
v_cvt_pk_bf16_f32 v69, v70, v71
v_cvt_pk_bf16_f32 v70, v132, v133
v_cvt_pk_bf16_f32 v71, v134, v135
v_pk_mul_f32 v[72:73], v[72:73], s[66:67]
v_pk_mul_f32 v[74:75], v[74:75], s[66:67]
v_pk_mul_f32 v[136:137], v[136:137], s[66:67]
v_pk_mul_f32 v[138:139], v[138:139], s[66:67]
v_cvt_pk_bf16_f32 v72, v72, v73
v_cvt_pk_bf16_f32 v73, v74, v75
v_cvt_pk_bf16_f32 v74, v136, v137
v_cvt_pk_bf16_f32 v75, v138, v139
v_pk_mul_f32 v[76:77], v[76:77], s[66:67]
v_pk_mul_f32 v[78:79], v[78:79], s[66:67]
v_pk_mul_f32 v[140:141], v[140:141], s[66:67]
v_pk_mul_f32 v[142:143], v[142:143], s[66:67]
v_cvt_pk_bf16_f32 v76, v76, v77
v_cvt_pk_bf16_f32 v77, v78, v79
v_cvt_pk_bf16_f32 v78, v140, v141
v_cvt_pk_bf16_f32 v79, v142, v143
v_pk_mul_f32 v[80:81], v[80:81], s[66:67]
v_pk_mul_f32 v[82:83], v[82:83], s[66:67]
v_pk_mul_f32 v[144:145], v[144:145], s[66:67]
v_pk_mul_f32 v[146:147], v[146:147], s[66:67]
v_cvt_pk_bf16_f32 v80, v80, v81
v_cvt_pk_bf16_f32 v81, v82, v83
v_cvt_pk_bf16_f32 v82, v144, v145
v_cvt_pk_bf16_f32 v83, v146, v147
v_pk_mul_f32 v[84:85], v[84:85], s[66:67]
v_pk_mul_f32 v[86:87], v[86:87], s[66:67]
v_pk_mul_f32 v[148:149], v[148:149], s[66:67]
v_pk_mul_f32 v[150:151], v[150:151], s[66:67]
v_cvt_pk_bf16_f32 v84, v84, v85
v_cvt_pk_bf16_f32 v85, v86, v87
v_cvt_pk_bf16_f32 v86, v148, v149
v_cvt_pk_bf16_f32 v87, v150, v151
s_lshl_b32 s66, s30, 11
s_add_u32 s66, s66, 32768
v_add_u32 v17, s66, v16
v_add_u32 v18, 0x10000, v17
s_lshr_b32 s66, s30, 1
s_lshl_b32 s66, s66, 16
s_and_b32 s67, s30, 1
s_lshl3_add_u32 s66, s67, s66
s_add_u32 s66, s66, 32768
v_add_u32 v19, s66, v16
v_cvt_pk_bf16_f32 v184, v184, v185
v_cvt_pk_bf16_f32 v185, v186, v187
v_cvt_pk_bf16_f32 v186, v188, v189
v_cvt_pk_bf16_f32 v187, v190, v191
ds_write_b128 v17, v[184:187] offset:2048
v_cvt_pk_bf16_f32 v90, v216, v217
v_cvt_pk_bf16_f32 v91, v218, v219
ds_write_b64 v17, v[90:91] offset:3072
v_cvt_pk_bf16_f32 v94, v220, v221
v_cvt_pk_bf16_f32 v95, v222, v223
ds_write_b64 v17, v[94:95] offset:3080
v_cvt_pk_bf16_f32 v192, v192, v193
v_cvt_pk_bf16_f32 v193, v194, v195
v_cvt_pk_bf16_f32 v194, v196, v197
v_cvt_pk_bf16_f32 v195, v198, v199
ds_write_b128 v17, v[192:195] offset:10240
v_cvt_pk_bf16_f32 v98, v224, v225
v_cvt_pk_bf16_f32 v99, v226, v227
ds_write_b64 v17, v[98:99] offset:11264
v_cvt_pk_bf16_f32 v102, v228, v229
v_cvt_pk_bf16_f32 v103, v230, v231
ds_write_b64 v17, v[102:103] offset:11272
v_cvt_pk_bf16_f32 v200, v200, v201
v_cvt_pk_bf16_f32 v201, v202, v203
v_cvt_pk_bf16_f32 v202, v204, v205
v_cvt_pk_bf16_f32 v203, v206, v207
ds_write_b128 v18, v[200:203] offset:2048
v_cvt_pk_bf16_f32 v106, v232, v233
v_cvt_pk_bf16_f32 v107, v234, v235
ds_write_b64 v18, v[106:107] offset:3072
v_cvt_pk_bf16_f32 v110, v236, v237
v_cvt_pk_bf16_f32 v111, v238, v239
ds_write_b64 v18, v[110:111] offset:3080
v_cvt_pk_bf16_f32 v208, v208, v209
v_cvt_pk_bf16_f32 v209, v210, v211
v_cvt_pk_bf16_f32 v210, v212, v213
v_cvt_pk_bf16_f32 v211, v214, v215
ds_write_b128 v18, v[208:211] offset:10240
v_cvt_pk_bf16_f32 v114, v240, v241
v_cvt_pk_bf16_f32 v115, v242, v243
ds_write_b64 v18, v[114:115] offset:11264
v_cvt_pk_bf16_f32 v118, v244, v245
v_cvt_pk_bf16_f32 v119, v246, v247
ds_write_b64 v18, v[118:119] offset:11272
v_cvt_pk_bf16_f32 v248, v248, v249
v_cvt_pk_bf16_f32 v249, v250, v251
v_cvt_pk_bf16_f32 v252, v252, v253
v_cvt_pk_bf16_f32 v253, v254, v255
ds_write_b64 v19, v[248:249]
ds_write_b64 v19, v[252:253] offset:1024
v_cvt_pk_bf16_f32 v152, v152, v153
v_cvt_pk_bf16_f32 v153, v154, v155
v_cvt_pk_bf16_f32 v154, v156, v157
v_cvt_pk_bf16_f32 v155, v158, v159
v_cvt_pk_bf16_f32 v160, v160, v161
v_cvt_pk_bf16_f32 v161, v162, v163
v_cvt_pk_bf16_f32 v162, v164, v165
v_cvt_pk_bf16_f32 v163, v166, v167
v_cvt_pk_bf16_f32 v168, v168, v169
v_cvt_pk_bf16_f32 v169, v170, v171
v_cvt_pk_bf16_f32 v170, v172, v173
v_cvt_pk_bf16_f32 v171, v174, v175
v_cvt_pk_bf16_f32 v176, v176, v177
v_cvt_pk_bf16_f32 v177, v178, v179
v_cvt_pk_bf16_f32 v178, v180, v181
v_cvt_pk_bf16_f32 v179, v182, v183
v_and_b32 v20, 15, v0
v_lshrrev_b32 v21, 4, v0
v_lshlrev_b32 v21, 2, v21
v_sub_u32 v20, v20, v21
v_mov_b32 v21, 0xff800000
s_or_b32 s66, s3, s30
s_cmp_eq_u32 s66, 0
s_cselect_b32 s66, 0xff800000, 0
v_subrev_u32 v22, 0, v20
v_and_b32 v23, 0x80000001, v22
v_cmp_eq_u32 vcc, 0, v23
v_xor_b32 v22, 0x80000000, v23
v_cmp_eq_u32 s[68:69], 0, v22
v_cndmask_b32 v140, v21, v23, vcc
s_nop 0
v_cndmask_b32 v136, v21, v22, s[68:69]
v_or_b32 v144, s66, v136
v_subrev_u32 v22, 1, v20
v_and_b32 v23, 0x80000001, v22
v_cmp_eq_u32 vcc, 0, v23
v_xor_b32 v22, 0x80000000, v23
v_cmp_eq_u32 s[68:69], 0, v22
v_cndmask_b32 v141, v21, v23, vcc
s_nop 0
v_cndmask_b32 v137, v21, v22, s[68:69]
v_or_b32 v145, s66, v137
v_subrev_u32 v22, 2, v20
v_and_b32 v23, 0x80000001, v22
v_cmp_eq_u32 vcc, 0, v23
v_xor_b32 v22, 0x80000000, v23
v_cmp_eq_u32 s[68:69], 0, v22
v_cndmask_b32 v142, v21, v23, vcc
s_nop 0
v_cndmask_b32 v138, v21, v22, s[68:69]
v_or_b32 v146, s66, v138
v_subrev_u32 v22, 3, v20
v_and_b32 v23, 0x80000001, v22
v_cmp_eq_u32 vcc, 0, v23
v_xor_b32 v22, 0x80000000, v23
v_cmp_eq_u32 s[68:69], 0, v22
v_cndmask_b32 v143, v21, v23, vcc
s_nop 0
v_cndmask_b32 v139, v21, v22, s[68:69]
v_or_b32 v147, s66, v139
v_and_b32 v22, 3, v0
v_cmp_eq_u32 vcc, 0, v22
v_mov_b32 v23, 0x3f803f80
v_mov_b32 v22, 0
v_cndmask_b32 v12, v22, v23, vcc
v_mov_b32 v13, v12
v_mov_b32 v14, v12
v_mov_b32 v15, v12
s_waitcnt lgkmcnt(0)
s_barrier
ds_read_b128 v[120:123], v17 offset:0
ds_read_b128 v[124:127], v17 offset:8192
ds_read_b128 v[128:131], v18 offset:0
ds_read_b128 v[132:135], v18 offset:8192
ds_read_b64 v[88:89], v17 offset:1024
ds_read_b64 v[92:93], v17 offset:1032
ds_read_b64 v[96:97], v17 offset:9216
ds_read_b64 v[100:101], v17 offset:9224
ds_read_b64 v[104:105], v18 offset:1024
ds_read_b64 v[108:109], v18 offset:1032
ds_read_b64 v[112:113], v18 offset:9216
ds_read_b64 v[116:117], v18 offset:9224
v_mfma_f32_16x16x32_bf16 v[220:223], v[184:187], v[152:155], v[140:143]
v_mfma_f32_16x16x32_bf16 v[228:231], v[192:195], v[160:163], v[140:143]
v_mfma_f32_16x16x32_bf16 v[236:239], v[200:203], v[168:171], v[140:143]
v_mfma_f32_16x16x32_bf16 v[244:247], v[208:211], v[176:179], v[140:143]
s_waitcnt lgkmcnt(11)
v_mfma_f32_16x16x32_bf16 v[216:219], v[120:123], v[152:155], v[144:147]
s_waitcnt lgkmcnt(10)
v_mfma_f32_16x16x32_bf16 v[224:227], v[124:127], v[160:163], v[136:139]
s_waitcnt lgkmcnt(9)
v_mfma_f32_16x16x32_bf16 v[232:235], v[128:131], v[168:171], v[136:139]
s_waitcnt lgkmcnt(8)
v_mfma_f32_16x16x32_bf16 v[240:243], v[132:135], v[176:179], v[136:139]
s_mov_b32 s66, 0x3e8293ee
s_nop 1
v_max3_f32 v148, v220, v221, v222
v_max3_f32 v149, v228, v229, v230
v_max3_f32 v150, v236, v237, v238
v_max3_f32 v151, v244, v245, v246
v_max3_f32 v148, v148, v223, v216
v_max3_f32 v148, v148, v217, v218
v_max_f32 v148, v148, v219
v_max3_f32 v149, v149, v231, v224
v_max3_f32 v149, v149, v225, v226
v_max_f32 v149, v149, v227
v_max3_f32 v150, v150, v239, v232
v_max3_f32 v150, v150, v233, v234
v_max_f32 v150, v150, v235
v_max3_f32 v151, v151, v247, v240
v_max3_f32 v151, v151, v241, v242
v_max_f32 v151, v151, v243
v_mov_b32 v20, v148
v_mov_b32 v21, v149
v_mov_b32 v22, v150
v_mov_b32 v23, v151
v_permlane16_swap_b32 v20, v148
v_permlane16_swap_b32 v21, v149
v_permlane16_swap_b32 v22, v150
v_permlane16_swap_b32 v23, v151
v_max_f32 v148, v148, v20
v_max_f32 v149, v149, v21
v_max_f32 v150, v150, v22
v_max_f32 v151, v151, v23
v_mov_b32 v20, v148
v_mov_b32 v21, v149
v_mov_b32 v22, v150
v_mov_b32 v23, v151
v_permlane32_swap_b32 v20, v148
v_permlane32_swap_b32 v21, v149
v_permlane32_swap_b32 v22, v150
v_permlane32_swap_b32 v23, v151
v_max_f32 v148, v148, v20
v_max_f32 v149, v149, v21
v_max_f32 v150, v150, v22
v_max_f32 v151, v151, v23
v_mul_f32 v148, s66, v148
v_mul_f32 v149, s66, v149
v_mul_f32 v150, s66, v150
v_mul_f32 v151, s66, v151
v_fma_f32 v216, v216, s66, -v148
v_fma_f32 v217, v217, s66, -v148
v_fma_f32 v218, v218, s66, -v148
v_fma_f32 v219, v219, s66, -v148
v_fma_f32 v220, v220, s66, -v148
v_fma_f32 v221, v221, s66, -v148
v_fma_f32 v222, v222, s66, -v148
v_fma_f32 v223, v223, s66, -v148
v_exp_f32 v216, v216
v_exp_f32 v217, v217
v_exp_f32 v218, v218
v_exp_f32 v219, v219
v_exp_f32 v220, v220
v_exp_f32 v221, v221
v_exp_f32 v222, v222
v_exp_f32 v223, v223
v_fma_f32 v224, v224, s66, -v149
v_fma_f32 v225, v225, s66, -v149
v_fma_f32 v226, v226, s66, -v149
v_fma_f32 v227, v227, s66, -v149
v_fma_f32 v228, v228, s66, -v149
v_fma_f32 v229, v229, s66, -v149
v_fma_f32 v230, v230, s66, -v149
v_fma_f32 v231, v231, s66, -v149
v_exp_f32 v224, v224
v_exp_f32 v225, v225
v_exp_f32 v226, v226
v_exp_f32 v227, v227
v_exp_f32 v228, v228
v_exp_f32 v229, v229
v_exp_f32 v230, v230
v_exp_f32 v231, v231
v_fma_f32 v232, v232, s66, -v150
v_fma_f32 v233, v233, s66, -v150
v_fma_f32 v234, v234, s66, -v150
v_fma_f32 v235, v235, s66, -v150
v_fma_f32 v236, v236, s66, -v150
v_fma_f32 v237, v237, s66, -v150
v_fma_f32 v238, v238, s66, -v150
v_fma_f32 v239, v239, s66, -v150
v_exp_f32 v232, v232
v_exp_f32 v233, v233
v_exp_f32 v234, v234
v_exp_f32 v235, v235
v_exp_f32 v236, v236
v_exp_f32 v237, v237
v_exp_f32 v238, v238
v_exp_f32 v239, v239
v_fma_f32 v240, v240, s66, -v151
v_fma_f32 v241, v241, s66, -v151
v_fma_f32 v242, v242, s66, -v151
v_fma_f32 v243, v243, s66, -v151
v_fma_f32 v244, v244, s66, -v151
v_fma_f32 v245, v245, s66, -v151
v_fma_f32 v246, v246, s66, -v151
v_fma_f32 v247, v247, s66, -v151
v_exp_f32 v240, v240
v_exp_f32 v241, v241
v_exp_f32 v242, v242
v_exp_f32 v243, v243
v_exp_f32 v244, v244
v_exp_f32 v245, v245
v_exp_f32 v246, v246
v_exp_f32 v247, v247
v_cvt_pk_bf16_f32 v216, v216, v217
v_cvt_pk_bf16_f32 v217, v218, v219
v_cvt_pk_bf16_f32 v218, v220, v221
v_cvt_pk_bf16_f32 v219, v222, v223
v_cvt_pk_bf16_f32 v224, v224, v225
v_cvt_pk_bf16_f32 v225, v226, v227
v_cvt_pk_bf16_f32 v226, v228, v229
v_cvt_pk_bf16_f32 v227, v230, v231
v_cvt_pk_bf16_f32 v232, v232, v233
v_cvt_pk_bf16_f32 v233, v234, v235
v_cvt_pk_bf16_f32 v234, v236, v237
v_cvt_pk_bf16_f32 v235, v238, v239
v_cvt_pk_bf16_f32 v240, v240, v241
v_cvt_pk_bf16_f32 v241, v242, v243
v_cvt_pk_bf16_f32 v242, v244, v245
v_cvt_pk_bf16_f32 v243, v246, v247
v_mfma_f32_16x16x32_bf16 v[220:223], v[12:15], v[216:219], 0
s_waitcnt lgkmcnt(7)
v_mfma_f32_16x16x32_bf16 v[156:159], v[88:91], v[216:219], 0
s_waitcnt lgkmcnt(6)
v_mfma_f32_16x16x32_bf16 v[188:191], v[92:95], v[216:219], 0
v_mfma_f32_16x16x32_bf16 v[228:231], v[12:15], v[224:227], 0
s_waitcnt lgkmcnt(5)
v_mfma_f32_16x16x32_bf16 v[164:167], v[96:99], v[224:227], 0
s_waitcnt lgkmcnt(4)
v_mfma_f32_16x16x32_bf16 v[196:199], v[100:103], v[224:227], 0
v_mfma_f32_16x16x32_bf16 v[236:239], v[12:15], v[232:235], 0
s_waitcnt lgkmcnt(3)
v_mfma_f32_16x16x32_bf16 v[172:175], v[104:107], v[232:235], 0
s_waitcnt lgkmcnt(2)
v_mfma_f32_16x16x32_bf16 v[204:207], v[108:111], v[232:235], 0
v_mfma_f32_16x16x32_bf16 v[244:247], v[12:15], v[240:243], 0
s_waitcnt lgkmcnt(1)
v_mfma_f32_16x16x32_bf16 v[180:183], v[112:115], v[240:243], 0
s_waitcnt lgkmcnt(0)
v_mfma_f32_16x16x32_bf16 v[212:215], v[116:119], v[240:243], 0
s_waitcnt vmcnt(0)
s_waitcnt vmcnt(1)
s_waitcnt vmcnt(2)
s_waitcnt vmcnt(3)
s_add_u32 s66, s31, 128
s_lshl_b32 s66, s66, 13
s_lshl_b32 s67, s30, 10
s_add_u32 s66, s66, s67
s_add_u32 s66, s66, 33554432
s_mul_i32 s67, s3, 1310720
s_add_u32 s67, s67, s66
s_mul_i32 s68, s16, 1310720
s_add_u32 s68, s68, s66
v_rcp_f32 v148, v220
v_rcp_f32 v149, v228
v_rcp_f32 v150, v236
v_rcp_f32 v151, v244
v_mul_f32 v148, v148, v5
v_mul_f32 v149, v149, v7
v_mul_f32 v150, v150, v9
v_mul_f32 v151, v151, v11
v_mul_f32 v156, v156, v148
v_mul_f32 v157, v157, v148
v_mul_f32 v158, v158, v148
v_mul_f32 v159, v159, v148
v_mul_f32 v188, v188, v148
v_mul_f32 v189, v189, v148
v_mul_f32 v190, v190, v148
v_mul_f32 v191, v191, v148
v_cvt_pk_bf16_f32 v156, v156, v157
v_cvt_pk_bf16_f32 v157, v158, v159
v_cvt_pk_bf16_f32 v158, v188, v189
v_cvt_pk_bf16_f32 v159, v190, v191
buffer_store_dwordx4 v[156:159], v16, s[44:47], s67 offen sc1
v_mul_f32 v164, v164, v149
v_mul_f32 v165, v165, v149
v_mul_f32 v166, v166, v149
v_mul_f32 v167, v167, v149
v_mul_f32 v196, v196, v149
v_mul_f32 v197, v197, v149
v_mul_f32 v198, v198, v149
v_mul_f32 v199, v199, v149
v_cvt_pk_bf16_f32 v164, v164, v165
v_cvt_pk_bf16_f32 v165, v166, v167
v_cvt_pk_bf16_f32 v166, v196, v197
v_cvt_pk_bf16_f32 v167, v198, v199
s_add_u32 s67, s67, 4096
buffer_store_dwordx4 v[164:167], v16, s[44:47], s67 offen sc1
v_mul_f32 v172, v172, v150
v_mul_f32 v173, v173, v150
v_mul_f32 v174, v174, v150
v_mul_f32 v175, v175, v150
v_mul_f32 v204, v204, v150
v_mul_f32 v205, v205, v150
v_mul_f32 v206, v206, v150
v_mul_f32 v207, v207, v150
v_cvt_pk_bf16_f32 v172, v172, v173
v_cvt_pk_bf16_f32 v173, v174, v175
v_cvt_pk_bf16_f32 v174, v204, v205
v_cvt_pk_bf16_f32 v175, v206, v207
buffer_store_dwordx4 v[172:175], v16, s[44:47], s68 offen sc1
v_mul_f32 v180, v180, v151
v_mul_f32 v181, v181, v151
v_mul_f32 v182, v182, v151
v_mul_f32 v183, v183, v151
v_mul_f32 v212, v212, v151
v_mul_f32 v213, v213, v151
v_mul_f32 v214, v214, v151
v_mul_f32 v215, v215, v151
v_cvt_pk_bf16_f32 v180, v180, v181
v_cvt_pk_bf16_f32 v181, v182, v183
v_cvt_pk_bf16_f32 v182, v212, v213
v_cvt_pk_bf16_f32 v183, v214, v215
s_add_u32 s68, s68, 4096
buffer_store_dwordx4 v[180:183], v16, s[44:47], s68 offen sc1
s_mov_b32 s73, 0
v_and_b32 v20, 15, v0
v_lshrrev_b32 v21, 4, v0
v_lshlrev_b32 v21, 2, v21
v_sub_u32 v20, v20, v21
s_lshl_b32 s66, s30, 4
v_add_u32 v20, s66, v20
v_subrev_u32 v21, 0, v20
v_ashrrev_i32 v21, 31, v21
v_and_b32 v200, 0xff800000, v21
v_subrev_u32 v21, 1, v20
v_ashrrev_i32 v21, 31, v21
v_and_b32 v201, 0xff800000, v21
v_subrev_u32 v21, 2, v20
v_ashrrev_i32 v21, 31, v21
v_and_b32 v202, 0xff800000, v21
v_subrev_u32 v21, 3, v20
v_ashrrev_i32 v21, 31, v21
v_and_b32 v203, 0xff800000, v21
v_subrev_u32 v21, 16, v20
v_ashrrev_i32 v21, 31, v21
v_and_b32 v204, 0xff800000, v21
v_subrev_u32 v21, 17, v20
v_ashrrev_i32 v21, 31, v21
v_and_b32 v205, 0xff800000, v21
v_subrev_u32 v21, 18, v20
v_ashrrev_i32 v21, 31, v21
v_and_b32 v206, 0xff800000, v21
v_subrev_u32 v21, 19, v20
v_ashrrev_i32 v21, 31, v21
v_and_b32 v207, 0xff800000, v21
v_subrev_u32 v21, 32, v20
v_ashrrev_i32 v21, 31, v21
v_and_b32 v208, 0xff800000, v21
v_subrev_u32 v21, 33, v20
v_ashrrev_i32 v21, 31, v21
v_and_b32 v209, 0xff800000, v21
v_subrev_u32 v21, 34, v20
v_ashrrev_i32 v21, 31, v21
v_and_b32 v210, 0xff800000, v21
v_subrev_u32 v21, 35, v20
v_ashrrev_i32 v21, 31, v21
v_and_b32 v211, 0xff800000, v21
v_subrev_u32 v21, 48, v20
v_ashrrev_i32 v21, 31, v21
v_and_b32 v212, 0xff800000, v21
v_subrev_u32 v21, 49, v20
v_ashrrev_i32 v21, 31, v21
v_and_b32 v213, 0xff800000, v21
v_subrev_u32 v21, 50, v20
v_ashrrev_i32 v21, 31, v21
v_and_b32 v214, 0xff800000, v21
v_subrev_u32 v21, 51, v20
v_ashrrev_i32 v21, 31, v21
v_and_b32 v215, 0xff800000, v21
v_mov_b32 v184, 0
v_mov_b32 v185, 0
v_mov_b32 v186, 0
v_mov_b32 v187, 0
v_mov_b32 v188, 0
v_mov_b32 v189, 0
v_mov_b32 v190, 0
v_mov_b32 v191, 0
v_mov_b32 v192, 0
v_mov_b32 v193, 0
v_mov_b32 v194, 0
v_mov_b32 v195, 0
v_mov_b32 v196, 0
v_mov_b32 v197, 0
v_mov_b32 v198, 0
v_mov_b32 v199, 0
s_lshl_b32 s66, s31, 15
s_lshl_b32 s67, s30, 10
s_add_u32 s66, s66, s67
s_add_u32 s66, s66, 33554432
s_mul_i32 s74, s3, 1310720
s_add_u32 s74, s74, s66
s_mul_i32 s75, s16, 1310720
s_add_u32 s75, s75, s66
L_attstart_4:
v_mov_b32 v2, v16
v_add_u32 v3, 0x10000, v16
v_mov_b32 v1, 0
s_and_b32 s66, s30, 1
s_lshr_b32 s67, s30, 1
s_lshl_b32 s71, s66, 13
s_lshl_b32 s68, s67, 16
s_add_u32 s71, s71, s68
s_add_u32 s71, s71, 32768
s_lshl_b32 s70, s66, 14
s_mul_i32 s67, s67, 24576
s_sub_u32 s70, s70, s67
s_add_u32 s70, s70, 65536
s_waitcnt lgkmcnt(0)
s_barrier
s_cmp_eq_u32 s3, 0
s_cbranch_scc1 L_F1_5
ds_read_b128 a[144:147], v2 offset:0
ds_read_b128 a[148:151], v2 offset:1024
ds_read_b128 a[152:155], v2 offset:2048
ds_read_b128 a[156:159], v2 offset:3072
ds_read_b128 a[160:163], v2 offset:4096
ds_read_b128 a[164:167], v2 offset:5120
s_mov_b32 m0, s71
s_nop 0
buffer_load_dwordx4 v16, s[32:35], s70 offen offset:0 sc1 lds
buffer_load_dwordx4 v16, s[32:35], s70 offen offset:1024 sc1 lds
s_waitcnt lgkmcnt(5)
v_mfma_f32_16x16x32_bf16 v[88:91], a[144:147], v[24:27], v[184:187]
ds_read_b128 a[168:171], v2 offset:6144
v_mfma_f32_16x16x32_bf16 v[96:99], a[144:147], v[40:43], v[188:191]
buffer_load_dwordx4 v16, s[32:35], s70 offen offset:2048 sc1 lds
v_mfma_f32_16x16x32_bf16 v[104:107], a[144:147], v[56:59], v[192:195]
v_mfma_f32_16x16x32_bf16 v[112:115], a[144:147], v[72:75], v[196:199]
s_waitcnt lgkmcnt(5)
v_mfma_f32_16x16x32_bf16 v[88:91], a[148:151], v[28:31], v[88:91]
ds_read_b128 a[172:175], v2 offset:7168
v_mfma_f32_16x16x32_bf16 v[96:99], a[148:151], v[44:47], v[96:99]
v_mfma_f32_16x16x32_bf16 v[104:107], a[148:151], v[60:63], v[104:107]
v_mfma_f32_16x16x32_bf16 v[112:115], a[148:151], v[76:79], v[112:115]
s_waitcnt lgkmcnt(5)
buffer_load_dwordx4 v16, s[32:35], s70 offen offset:3072 sc1 lds
v_mfma_f32_16x16x32_bf16 v[88:91], a[152:155], v[32:35], v[88:91]
v_mfma_f32_16x16x32_bf16 v[96:99], a[152:155], v[48:51], v[96:99]
v_mfma_f32_16x16x32_bf16 v[104:107], a[152:155], v[64:67], v[104:107]
v_mfma_f32_16x16x32_bf16 v[112:115], a[152:155], v[80:83], v[112:115]
s_waitcnt lgkmcnt(4)
s_add_u32 m0, s71, 4096
v_mfma_f32_16x16x32_bf16 v[88:91], a[156:159], v[36:39], v[88:91]
s_add_u32 s64, s70, 4096
v_mfma_f32_16x16x32_bf16 v[96:99], a[156:159], v[52:55], v[96:99]
buffer_load_dwordx4 v16, s[32:35], s64 offen offset:0 sc1 lds
v_mfma_f32_16x16x32_bf16 v[104:107], a[156:159], v[68:71], v[104:107]
v_mfma_f32_16x16x32_bf16 v[112:115], a[156:159], v[84:87], v[112:115]
s_waitcnt lgkmcnt(3)
v_mfma_f32_16x16x32_bf16 v[92:95], a[160:163], v[24:27], v[184:187]
v_mfma_f32_16x16x32_bf16 v[100:103], a[160:163], v[40:43], v[188:191]
v_mfma_f32_16x16x32_bf16 v[108:111], a[160:163], v[56:59], v[192:195]
v_mfma_f32_16x16x32_bf16 v[116:119], a[160:163], v[72:75], v[196:199]
s_waitcnt lgkmcnt(2)
v_mfma_f32_16x16x32_bf16 v[92:95], a[164:167], v[28:31], v[92:95]
buffer_load_dwordx4 v16, s[32:35], s64 offen offset:1024 sc1 lds
v_mfma_f32_16x16x32_bf16 v[100:103], a[164:167], v[44:47], v[100:103]
v_mfma_f32_16x16x32_bf16 v[108:111], a[164:167], v[60:63], v[108:111]
v_mfma_f32_16x16x32_bf16 v[116:119], a[164:167], v[76:79], v[116:119]
s_waitcnt lgkmcnt(1)
v_mfma_f32_16x16x32_bf16 v[92:95], a[168:171], v[32:35], v[92:95]
v_mfma_f32_16x16x32_bf16 v[100:103], a[168:171], v[48:51], v[100:103]
v_mfma_f32_16x16x32_bf16 v[108:111], a[168:171], v[64:67], v[108:111]
buffer_load_dwordx4 v16, s[32:35], s64 offen offset:2048 sc1 lds
v_mfma_f32_16x16x32_bf16 v[116:119], a[168:171], v[80:83], v[116:119]
s_waitcnt lgkmcnt(0)
v_mfma_f32_16x16x32_bf16 v[92:95], a[172:175], v[36:39], v[92:95]
v_mfma_f32_16x16x32_bf16 v[100:103], a[172:175], v[52:55], v[100:103]
v_mfma_f32_16x16x32_bf16 v[108:111], a[172:175], v[68:71], v[108:111]
v_mfma_f32_16x16x32_bf16 v[116:119], a[172:175], v[84:87], v[116:119]
ds_read_b128 a[144:147], v2 offset:8192
ds_read_b128 a[148:151], v2 offset:9216
ds_read_b128 a[152:155], v2 offset:10240
ds_read_b128 a[156:159], v2 offset:11264
ds_read_b128 a[160:163], v2 offset:12288
ds_read_b128 a[164:167], v2 offset:13312
s_nop 3
s_cmp_eq_u32 s73, 0
s_cselect_b32 s66, -1, 0
v_max3_f32 v20, v88, v89, v90
v_max3_f32 v21, v96, v97, v98
v_max3_f32 v22, v104, v105, v106
v_max3_f32 v23, v112, v113, v114
v_max3_f32 v20, v20, v91, v92
v_max3_f32 v20, v20, v93, v94
v_max_f32 v20, v20, v95
v_max3_f32 v21, v21, v99, v100
v_max3_f32 v21, v21, v101, v102
v_max_f32 v21, v21, v103
v_max3_f32 v22, v22, v107, v108
v_max3_f32 v22, v22, v109, v110
v_max_f32 v22, v22, v111
v_max3_f32 v23, v23, v115, v116
v_max3_f32 v23, v23, v117, v118
v_max_f32 v23, v23, v119
v_mov_b32 v224, v20
v_mov_b32 v225, v21
v_mov_b32 v226, v22
v_mov_b32 v227, v23
v_permlane16_swap_b32 v224, v20
v_permlane16_swap_b32 v225, v21
v_permlane16_swap_b32 v226, v22
v_permlane16_swap_b32 v227, v23
v_max_f32 v20, v20, v224
v_max_f32 v21, v21, v225
v_max_f32 v22, v22, v226
v_max_f32 v23, v23, v227
v_mov_b32 v224, v20
v_mov_b32 v225, v21
v_mov_b32 v226, v22
v_mov_b32 v227, v23
v_permlane32_swap_b32 v224, v20
v_permlane32_swap_b32 v225, v21
v_permlane32_swap_b32 v226, v22
v_permlane32_swap_b32 v227, v23
v_max_f32 v20, v20, v224
v_max_f32 v21, v21, v225
v_max_f32 v22, v22, v226
v_max_f32 v23, v23, v227
v_and_b32 v20, s66, v20
v_and_b32 v21, s66, v21
v_and_b32 v22, s66, v22
v_and_b32 v23, s66, v23
v_sub_f32 v184, v184, v20
v_sub_f32 v185, v185, v20
v_sub_f32 v186, v186, v20
v_sub_f32 v187, v187, v20
v_sub_f32 v188, v188, v21
v_sub_f32 v189, v189, v21
v_sub_f32 v190, v190, v21
v_sub_f32 v191, v191, v21
v_sub_f32 v192, v192, v22
v_sub_f32 v193, v193, v22
v_sub_f32 v194, v194, v22
v_sub_f32 v195, v195, v22
v_sub_f32 v196, v196, v23
v_sub_f32 v197, v197, v23
v_sub_f32 v198, v198, v23
v_sub_f32 v199, v199, v23
v_sub_f32 v88, v88, v20
v_sub_f32 v89, v89, v20
v_sub_f32 v90, v90, v20
v_sub_f32 v91, v91, v20
v_sub_f32 v92, v92, v20
v_sub_f32 v93, v93, v20
v_sub_f32 v94, v94, v20
v_sub_f32 v95, v95, v20
v_sub_f32 v96, v96, v21
v_sub_f32 v97, v97, v21
v_sub_f32 v98, v98, v21
v_sub_f32 v99, v99, v21
v_sub_f32 v100, v100, v21
v_sub_f32 v101, v101, v21
v_sub_f32 v102, v102, v21
v_sub_f32 v103, v103, v21
v_sub_f32 v104, v104, v22
v_sub_f32 v105, v105, v22
v_sub_f32 v106, v106, v22
v_sub_f32 v107, v107, v22
v_sub_f32 v108, v108, v22
v_sub_f32 v109, v109, v22
v_sub_f32 v110, v110, v22
v_sub_f32 v111, v111, v22
v_sub_f32 v112, v112, v23
v_sub_f32 v113, v113, v23
v_sub_f32 v114, v114, v23
v_sub_f32 v115, v115, v23
v_sub_f32 v116, v116, v23
v_sub_f32 v117, v117, v23
v_sub_f32 v118, v118, v23
v_sub_f32 v119, v119, v23
s_waitcnt lgkmcnt(5)
v_mfma_f32_16x16x32_bf16 v[120:123], a[144:147], v[24:27], v[184:187]
v_exp_f32 v88, v88
v_mfma_f32_16x16x32_bf16 v[128:131], a[144:147], v[40:43], v[188:191]
v_exp_f32 v89, v89
v_mfma_f32_16x16x32_bf16 v[136:139], a[144:147], v[56:59], v[192:195]
v_exp_f32 v90, v90
v_mfma_f32_16x16x32_bf16 v[144:147], a[144:147], v[72:75], v[196:199]
s_waitcnt lgkmcnt(4)
ds_read_b128 a[168:171], v2 offset:14336
v_exp_f32 v91, v91
v_mfma_f32_16x16x32_bf16 v[120:123], a[148:151], v[28:31], v[120:123]
v_exp_f32 v92, v92
v_mfma_f32_16x16x32_bf16 v[128:131], a[148:151], v[44:47], v[128:131]
v_exp_f32 v93, v93
v_mfma_f32_16x16x32_bf16 v[136:139], a[148:151], v[60:63], v[136:139]
v_exp_f32 v94, v94
v_mfma_f32_16x16x32_bf16 v[144:147], a[148:151], v[76:79], v[144:147]
s_waitcnt lgkmcnt(4)
ds_read_b128 a[172:175], v2 offset:15360
v_exp_f32 v95, v95
v_mfma_f32_16x16x32_bf16 v[120:123], a[152:155], v[32:35], v[120:123]
v_exp_f32 v96, v96
v_mfma_f32_16x16x32_bf16 v[128:131], a[152:155], v[48:51], v[128:131]
v_exp_f32 v97, v97
v_mfma_f32_16x16x32_bf16 v[136:139], a[152:155], v[64:67], v[136:139]
v_exp_f32 v98, v98
v_mfma_f32_16x16x32_bf16 v[144:147], a[152:155], v[80:83], v[144:147]
s_waitcnt lgkmcnt(4)
v_exp_f32 v99, v99
v_mfma_f32_16x16x32_bf16 v[120:123], a[156:159], v[36:39], v[120:123]
v_exp_f32 v100, v100
v_mfma_f32_16x16x32_bf16 v[128:131], a[156:159], v[52:55], v[128:131]
v_exp_f32 v101, v101
v_mfma_f32_16x16x32_bf16 v[136:139], a[156:159], v[68:71], v[136:139]
v_exp_f32 v102, v102
v_mfma_f32_16x16x32_bf16 v[144:147], a[156:159], v[84:87], v[144:147]
s_waitcnt lgkmcnt(3)
v_exp_f32 v103, v103
v_exp_f32 v104, v104
v_mfma_f32_16x16x32_bf16 v[124:127], a[160:163], v[24:27], v[184:187]
v_exp_f32 v105, v105
v_mfma_f32_16x16x32_bf16 v[132:135], a[160:163], v[40:43], v[188:191]
v_exp_f32 v106, v106
v_mfma_f32_16x16x32_bf16 v[140:143], a[160:163], v[56:59], v[192:195]
buffer_load_dwordx4 v16, s[32:35], s64 offen offset:3072 sc1 lds
v_exp_f32 v107, v107
v_mfma_f32_16x16x32_bf16 v[148:151], a[160:163], v[72:75], v[196:199]
s_waitcnt lgkmcnt(2)
v_exp_f32 v108, v108
v_mfma_f32_16x16x32_bf16 v[124:127], a[164:167], v[28:31], v[124:127]
v_exp_f32 v109, v109
v_mfma_f32_16x16x32_bf16 v[132:135], a[164:167], v[44:47], v[132:135]
v_exp_f32 v110, v110
v_mfma_f32_16x16x32_bf16 v[140:143], a[164:167], v[60:63], v[140:143]
v_exp_f32 v111, v111
v_mfma_f32_16x16x32_bf16 v[148:151], a[164:167], v[76:79], v[148:151]
s_waitcnt lgkmcnt(1)
v_exp_f32 v112, v112
v_mfma_f32_16x16x32_bf16 v[124:127], a[168:171], v[32:35], v[124:127]
v_exp_f32 v113, v113
v_mfma_f32_16x16x32_bf16 v[132:135], a[168:171], v[48:51], v[132:135]
v_exp_f32 v114, v114
v_mfma_f32_16x16x32_bf16 v[140:143], a[168:171], v[64:67], v[140:143]
v_exp_f32 v115, v115
v_mfma_f32_16x16x32_bf16 v[148:151], a[168:171], v[80:83], v[148:151]
s_waitcnt lgkmcnt(0)
v_exp_f32 v116, v116
v_mfma_f32_16x16x32_bf16 v[124:127], a[172:175], v[36:39], v[124:127]
s_xor_b32 s71, s71, 16384
v_exp_f32 v117, v117
v_mfma_f32_16x16x32_bf16 v[132:135], a[172:175], v[52:55], v[132:135]
s_add_u32 s70, s70, 32768
v_exp_f32 v118, v118
v_mfma_f32_16x16x32_bf16 v[140:143], a[172:175], v[68:71], v[140:143]
s_mov_b32 m0, s71
v_exp_f32 v119, v119
v_mfma_f32_16x16x32_bf16 v[148:151], a[172:175], v[84:87], v[148:151]
s_waitcnt vmcnt(8)
s_barrier
buffer_load_dwordx4 v16, s[32:35], s70 offen offset:0 sc1 lds
ds_read_b128 a[144:147], v2 offset:16384
ds_read_b128 a[148:151], v2 offset:17408
ds_read_b128 a[152:155], v2 offset:18432
ds_read_b128 a[156:159], v2 offset:19456
ds_read_b128 a[160:163], v2 offset:20480
ds_read_b128 a[164:167], v2 offset:21504
v_cvt_pk_bf16_f32 v152, v88, v89
v_cvt_pk_bf16_f32 v153, v90, v91
v_cvt_pk_bf16_f32 v154, v92, v93
v_cvt_pk_bf16_f32 v155, v94, v95
v_cvt_pk_bf16_f32 v156, v96, v97
v_cvt_pk_bf16_f32 v157, v98, v99
v_cvt_pk_bf16_f32 v158, v100, v101
v_cvt_pk_bf16_f32 v159, v102, v103
v_cvt_pk_bf16_f32 v160, v104, v105
v_cvt_pk_bf16_f32 v161, v106, v107
v_cvt_pk_bf16_f32 v162, v108, v109
v_cvt_pk_bf16_f32 v163, v110, v111
v_cvt_pk_bf16_f32 v164, v112, v113
v_cvt_pk_bf16_f32 v165, v114, v115
v_cvt_pk_bf16_f32 v166, v116, v117
v_cvt_pk_bf16_f32 v167, v118, v119
buffer_load_dwordx4 v16, s[32:35], s70 offen offset:1024 sc1 lds
s_waitcnt lgkmcnt(5)
v_mfma_f32_16x16x32_bf16 v[88:91], a[144:147], v[24:27], v[184:187]
s_lshl_b32 s66, s30, 30
ds_read_b128 a[168:171], v2 offset:22528
v_mfma_f32_16x16x32_bf16 v[96:99], a[144:147], v[40:43], v[188:191]
v_exp_f32 v120, v120
v_mfma_f32_16x16x32_bf16 v[104:107], a[144:147], v[56:59], v[192:195]
v_lshl_add_u32 v19, v0, 24, s66
v_mfma_f32_16x16x32_bf16 v[112:115], a[144:147], v[72:75], v[196:199]
s_waitcnt lgkmcnt(5)
v_exp_f32 v121, v121
v_mfma_f32_16x16x32_bf16 v[88:91], a[148:151], v[28:31], v[88:91]
ds_read_b128 a[172:175], v2 offset:23552
v_cvt_pk_bf16_f32 v168, v120, v121
v_mfma_f32_16x16x32_bf16 v[96:99], a[148:151], v[44:47], v[96:99]
v_exp_f32 v122, v122
v_mfma_f32_16x16x32_bf16 v[104:107], a[148:151], v[60:63], v[104:107]
buffer_load_dwordx4 v16, s[32:35], s70 offen offset:2048 sc1 lds
v_mfma_f32_16x16x32_bf16 v[112:115], a[148:151], v[76:79], v[112:115]
s_waitcnt lgkmcnt(5)
v_exp_f32 v123, v123
v_mfma_f32_16x16x32_bf16 v[88:91], a[152:155], v[32:35], v[88:91]
ds_read_b128 a[176:179], v3 offset:16384
v_cvt_pk_bf16_f32 v169, v122, v123
v_mfma_f32_16x16x32_bf16 v[96:99], a[152:155], v[48:51], v[96:99]
v_exp_f32 v124, v124
v_mfma_f32_16x16x32_bf16 v[104:107], a[152:155], v[64:67], v[104:107]
s_cmp_eq_u32 s73, 0
s_cselect_b32 s67, 0, 0x1000
v_mfma_f32_16x16x32_bf16 v[112:115], a[152:155], v[80:83], v[112:115]
s_waitcnt lgkmcnt(5)
v_exp_f32 v125, v125
v_mfma_f32_16x16x32_bf16 v[88:91], a[156:159], v[36:39], v[88:91]
ds_read_b128 a[180:183], v3 offset:17408
v_cvt_pk_bf16_f32 v170, v124, v125
v_mfma_f32_16x16x32_bf16 v[96:99], a[156:159], v[52:55], v[96:99]
v_exp_f32 v126, v126
v_mfma_f32_16x16x32_bf16 v[104:107], a[156:159], v[68:71], v[104:107]
buffer_atomic_add a251, v19, s[52:55], s67 offen offset:128 sc1
v_mfma_f32_16x16x32_bf16 v[112:115], a[156:159], v[84:87], v[112:115]
s_waitcnt lgkmcnt(5)
v_exp_f32 v127, v127
v_mfma_f32_16x16x32_bf16 v[92:95], a[160:163], v[24:27], v[184:187]
ds_read_b128 a[184:187], v3 offset:18432
v_cvt_pk_bf16_f32 v171, v126, v127
v_mfma_f32_16x16x32_bf16 v[100:103], a[160:163], v[40:43], v[188:191]
v_exp_f32 v128, v128
v_mfma_f32_16x16x32_bf16 v[108:111], a[160:163], v[56:59], v[192:195]
buffer_load_dwordx4 v16, s[32:35], s70 offen offset:3072 sc1 lds
v_mfma_f32_16x16x32_bf16 v[116:119], a[160:163], v[72:75], v[196:199]
s_waitcnt lgkmcnt(5)
v_exp_f32 v129, v129
v_mfma_f32_16x16x32_bf16 v[92:95], a[164:167], v[28:31], v[92:95]
ds_read_b128 a[188:191], v3 offset:19456
v_cvt_pk_bf16_f32 v172, v128, v129
v_mfma_f32_16x16x32_bf16 v[100:103], a[164:167], v[44:47], v[100:103]
v_exp_f32 v130, v130
v_mfma_f32_16x16x32_bf16 v[108:111], a[164:167], v[60:63], v[108:111]
v_mfma_f32_16x16x32_bf16 v[116:119], a[164:167], v[76:79], v[116:119]
s_waitcnt lgkmcnt(5)
v_exp_f32 v131, v131
v_mfma_f32_16x16x32_bf16 v[92:95], a[168:171], v[32:35], v[92:95]
s_add_u32 m0, s71, 4096
ds_read_b128 a[192:195], v3 offset:20480
v_cvt_pk_bf16_f32 v173, v130, v131
v_mfma_f32_16x16x32_bf16 v[100:103], a[168:171], v[48:51], v[100:103]
v_exp_f32 v132, v132
v_mfma_f32_16x16x32_bf16 v[108:111], a[168:171], v[64:67], v[108:111]
s_add_u32 s64, s70, 4096
v_mfma_f32_16x16x32_bf16 v[116:119], a[168:171], v[80:83], v[116:119]
s_waitcnt lgkmcnt(5)
v_exp_f32 v133, v133
v_mfma_f32_16x16x32_bf16 v[92:95], a[172:175], v[36:39], v[92:95]
ds_read_b128 a[196:199], v3 offset:21504
v_cvt_pk_bf16_f32 v174, v132, v133
v_mfma_f32_16x16x32_bf16 v[100:103], a[172:175], v[52:55], v[100:103]
v_exp_f32 v134, v134
v_mfma_f32_16x16x32_bf16 v[108:111], a[172:175], v[68:71], v[108:111]
buffer_load_dwordx4 v16, s[32:35], s64 offen offset:0 sc1 lds
v_mfma_f32_16x16x32_bf16 v[116:119], a[172:175], v[84:87], v[116:119]
s_waitcnt lgkmcnt(5)
v_exp_f32 v135, v135
v_mfma_f32_16x16x32_bf16 a[0:3], a[176:179], v[152:155], 0
ds_read_b128 a[200:203], v3 offset:22528
v_cvt_pk_bf16_f32 v175, v134, v135
v_mfma_f32_16x16x32_bf16 a[32:35], a[176:179], v[156:159], 0
v_exp_f32 v136, v136
v_mfma_f32_16x16x32_bf16 a[64:67], a[176:179], v[160:163], 0
v_mfma_f32_16x16x32_bf16 a[96:99], a[176:179], v[164:167], 0
s_waitcnt lgkmcnt(5)
v_exp_f32 v137, v137
v_mfma_f32_16x16x32_bf16 a[4:7], a[180:183], v[152:155], 0
ds_read_b128 a[204:207], v3 offset:23552
v_cvt_pk_bf16_f32 v176, v136, v137
v_mfma_f32_16x16x32_bf16 a[36:39], a[180:183], v[156:159], 0
v_exp_f32 v138, v138
v_mfma_f32_16x16x32_bf16 a[68:71], a[180:183], v[160:163], 0
v_mfma_f32_16x16x32_bf16 a[100:103], a[180:183], v[164:167], 0
s_waitcnt lgkmcnt(5)
v_exp_f32 v139, v139
v_mfma_f32_16x16x32_bf16 a[8:11], a[184:187], v[152:155], 0
ds_read_b128 a[144:147], v2 offset:24576
v_cvt_pk_bf16_f32 v177, v138, v139
v_mfma_f32_16x16x32_bf16 a[40:43], a[184:187], v[156:159], 0
v_exp_f32 v140, v140
v_mfma_f32_16x16x32_bf16 a[72:75], a[184:187], v[160:163], 0
buffer_load_dwordx4 v16, s[32:35], s64 offen offset:1024 sc1 lds
v_mfma_f32_16x16x32_bf16 a[104:107], a[184:187], v[164:167], 0
s_waitcnt lgkmcnt(5)
v_exp_f32 v141, v141
v_mfma_f32_16x16x32_bf16 a[12:15], a[188:191], v[152:155], 0
ds_read_b128 a[148:151], v2 offset:25600
v_cvt_pk_bf16_f32 v178, v140, v141
v_mfma_f32_16x16x32_bf16 a[44:47], a[188:191], v[156:159], 0
v_exp_f32 v142, v142
v_mfma_f32_16x16x32_bf16 a[76:79], a[188:191], v[160:163], 0
v_mfma_f32_16x16x32_bf16 a[108:111], a[188:191], v[164:167], 0
s_waitcnt lgkmcnt(5)
v_exp_f32 v143, v143
v_mfma_f32_16x16x32_bf16 a[16:19], a[192:195], v[152:155], 0
ds_read_b128 a[152:155], v2 offset:26624
v_cvt_pk_bf16_f32 v179, v142, v143
v_mfma_f32_16x16x32_bf16 a[48:51], a[192:195], v[156:159], 0
v_exp_f32 v144, v144
v_mfma_f32_16x16x32_bf16 a[80:83], a[192:195], v[160:163], 0
v_mfma_f32_16x16x32_bf16 a[112:115], a[192:195], v[164:167], 0
s_waitcnt lgkmcnt(5)
v_exp_f32 v145, v145
v_mfma_f32_16x16x32_bf16 a[20:23], a[196:199], v[152:155], 0
ds_read_b128 a[156:159], v2 offset:27648
v_cvt_pk_bf16_f32 v180, v144, v145
v_mfma_f32_16x16x32_bf16 a[52:55], a[196:199], v[156:159], 0
v_exp_f32 v146, v146
v_mfma_f32_16x16x32_bf16 a[84:87], a[196:199], v[160:163], 0
v_mfma_f32_16x16x32_bf16 a[116:119], a[196:199], v[164:167], 0
s_waitcnt lgkmcnt(5)
v_exp_f32 v147, v147
v_mfma_f32_16x16x32_bf16 a[24:27], a[200:203], v[152:155], 0
ds_read_b128 a[160:163], v2 offset:28672
v_cvt_pk_bf16_f32 v181, v146, v147
v_mfma_f32_16x16x32_bf16 a[56:59], a[200:203], v[156:159], 0
v_exp_f32 v148, v148
v_mfma_f32_16x16x32_bf16 a[88:91], a[200:203], v[160:163], 0
buffer_load_dwordx4 v16, s[32:35], s64 offen offset:2048 sc1 lds
v_mfma_f32_16x16x32_bf16 a[120:123], a[200:203], v[164:167], 0
s_waitcnt lgkmcnt(5)
v_exp_f32 v149, v149
v_mfma_f32_16x16x32_bf16 a[28:31], a[204:207], v[152:155], 0
ds_read_b128 a[164:167], v2 offset:29696
v_cvt_pk_bf16_f32 v182, v148, v149
v_mfma_f32_16x16x32_bf16 a[60:63], a[204:207], v[156:159], 0
v_exp_f32 v150, v150
v_mfma_f32_16x16x32_bf16 a[92:95], a[204:207], v[160:163], 0
v_mfma_f32_16x16x32_bf16 a[124:127], a[204:207], v[164:167], 0
v_exp_f32 v151, v151
v_mfma_f32_16x16x32_bf16 a[128:131], v[12:15], v[152:155], 0
v_cvt_pk_bf16_f32 v183, v150, v151
v_mfma_f32_16x16x32_bf16 a[132:135], v[12:15], v[156:159], 0
v_mfma_f32_16x16x32_bf16 a[136:139], v[12:15], v[160:163], 0
v_mfma_f32_16x16x32_bf16 a[140:143], v[12:15], v[164:167], 0
s_waitcnt lgkmcnt(5)
v_mfma_f32_16x16x32_bf16 v[120:123], a[144:147], v[24:27], v[184:187]
ds_read_b128 a[168:171], v2 offset:30720
v_lshlrev_b32 v19, 7, v0
v_mfma_f32_16x16x32_bf16 v[128:131], a[144:147], v[40:43], v[188:191]
s_lshl2_add_u32 s66, s2, s30
v_exp_f32 v88, v88
v_mfma_f32_16x16x32_bf16 v[136:139], a[144:147], v[56:59], v[192:195]
s_lshl_b32 s66, s66, 13
v_mfma_f32_16x16x32_bf16 v[144:147], a[144:147], v[72:75], v[196:199]
s_waitcnt lgkmcnt(5)
v_exp_f32 v89, v89
v_mfma_f32_16x16x32_bf16 v[120:123], a[148:151], v[28:31], v[120:123]
ds_read_b128 a[172:175], v2 offset:31744
v_cvt_pk_bf16_f32 v152, v88, v89
v_mfma_f32_16x16x32_bf16 v[128:131], a[148:151], v[44:47], v[128:131]
v_exp_f32 v90, v90
v_mfma_f32_16x16x32_bf16 v[136:139], a[148:151], v[60:63], v[136:139]
v_xor_b32 v2, 0x8000, v2
v_add_u32 v19, s66, v19
v_mfma_f32_16x16x32_bf16 v[144:147], a[148:151], v[76:79], v[144:147]
s_waitcnt lgkmcnt(5)
v_exp_f32 v91, v91
v_mfma_f32_16x16x32_bf16 v[120:123], a[152:155], v[32:35], v[120:123]
ds_read_b128 a[176:179], v3 offset:24576
v_cvt_pk_bf16_f32 v153, v90, v91
v_mfma_f32_16x16x32_bf16 v[128:131], a[152:155], v[48:51], v[128:131]
v_exp_f32 v92, v92
v_mfma_f32_16x16x32_bf16 v[136:139], a[152:155], v[64:67], v[136:139]
v_mfma_f32_16x16x32_bf16 v[144:147], a[152:155], v[80:83], v[144:147]
s_waitcnt lgkmcnt(5)
v_exp_f32 v93, v93
v_mfma_f32_16x16x32_bf16 v[120:123], a[156:159], v[36:39], v[120:123]
ds_read_b128 a[180:183], v3 offset:25600
v_cvt_pk_bf16_f32 v154, v92, v93
v_mfma_f32_16x16x32_bf16 v[128:131], a[156:159], v[52:55], v[128:131]
v_exp_f32 v94, v94
v_mfma_f32_16x16x32_bf16 v[136:139], a[156:159], v[68:71], v[136:139]
buffer_load_dwordx4 v16, s[32:35], s64 offen offset:3072 sc1 lds
v_mfma_f32_16x16x32_bf16 v[144:147], a[156:159], v[84:87], v[144:147]
s_waitcnt lgkmcnt(5)
v_exp_f32 v95, v95
v_mfma_f32_16x16x32_bf16 v[124:127], a[160:163], v[24:27], v[184:187]
ds_read_b128 a[184:187], v3 offset:26624
v_cvt_pk_bf16_f32 v155, v94, v95
v_mfma_f32_16x16x32_bf16 v[132:135], a[160:163], v[40:43], v[188:191]
v_exp_f32 v96, v96
v_mfma_f32_16x16x32_bf16 v[140:143], a[160:163], v[56:59], v[192:195]
v_mfma_f32_16x16x32_bf16 v[148:151], a[160:163], v[72:75], v[196:199]
s_waitcnt lgkmcnt(5)
v_exp_f32 v97, v97
v_mfma_f32_16x16x32_bf16 v[124:127], a[164:167], v[28:31], v[124:127]
ds_read_b128 a[188:191], v3 offset:27648
v_cvt_pk_bf16_f32 v156, v96, v97
v_mfma_f32_16x16x32_bf16 v[132:135], a[164:167], v[44:47], v[132:135]
v_exp_f32 v98, v98
v_mfma_f32_16x16x32_bf16 v[140:143], a[164:167], v[60:63], v[140:143]
v_mfma_f32_16x16x32_bf16 v[148:151], a[164:167], v[76:79], v[148:151]
s_waitcnt lgkmcnt(5)
v_exp_f32 v99, v99
v_mfma_f32_16x16x32_bf16 v[124:127], a[168:171], v[32:35], v[124:127]
s_xor_b32 s71, s71, 49152
ds_read_b128 a[192:195], v3 offset:28672
v_cvt_pk_bf16_f32 v157, v98, v99
v_mfma_f32_16x16x32_bf16 v[132:135], a[168:171], v[48:51], v[132:135]
v_exp_f32 v100, v100
v_mfma_f32_16x16x32_bf16 v[140:143], a[168:171], v[64:67], v[140:143]
v_mfma_f32_16x16x32_bf16 v[148:151], a[168:171], v[80:83], v[148:151]
s_waitcnt lgkmcnt(5)
v_exp_f32 v101, v101
v_mfma_f32_16x16x32_bf16 v[124:127], a[172:175], v[36:39], v[124:127]
ds_read_b128 a[196:199], v3 offset:29696
v_cvt_pk_bf16_f32 v158, v100, v101
v_mfma_f32_16x16x32_bf16 v[132:135], a[172:175], v[52:55], v[132:135]
v_exp_f32 v102, v102
v_mfma_f32_16x16x32_bf16 v[140:143], a[172:175], v[68:71], v[140:143]
v_mfma_f32_16x16x32_bf16 v[148:151], a[172:175], v[84:87], v[148:151]
s_waitcnt lgkmcnt(5)
v_exp_f32 v103, v103
v_mfma_f32_16x16x32_bf16 a[0:3], a[176:179], v[168:171], a[0:3]
s_add_u32 s70, s70, 32768
ds_read_b128 a[200:203], v3 offset:30720
v_cvt_pk_bf16_f32 v159, v102, v103
v_mfma_f32_16x16x32_bf16 a[32:35], a[176:179], v[172:175], a[32:35]
v_exp_f32 v104, v104
v_mfma_f32_16x16x32_bf16 a[64:67], a[176:179], v[176:179], a[64:67]
v_mfma_f32_16x16x32_bf16 a[96:99], a[176:179], v[180:183], a[96:99]
s_waitcnt lgkmcnt(5)
v_exp_f32 v105, v105
v_mfma_f32_16x16x32_bf16 a[4:7], a[180:183], v[168:171], a[4:7]
ds_read_b128 a[204:207], v3 offset:31744
v_cvt_pk_bf16_f32 v160, v104, v105
v_mfma_f32_16x16x32_bf16 a[36:39], a[180:183], v[172:175], a[36:39]
v_exp_f32 v106, v106
v_mfma_f32_16x16x32_bf16 a[68:71], a[180:183], v[176:179], a[68:71]
s_waitcnt vmcnt(9)
s_barrier
v_mfma_f32_16x16x32_bf16 a[100:103], a[180:183], v[180:183], a[100:103]
s_waitcnt lgkmcnt(5)
v_exp_f32 v107, v107
v_mfma_f32_16x16x32_bf16 a[8:11], a[184:187], v[168:171], a[8:11]
s_mov_b32 m0, s71
ds_read_b128 a[144:147], v2 offset:0
v_cvt_pk_bf16_f32 v161, v106, v107
v_mfma_f32_16x16x32_bf16 a[40:43], a[184:187], v[172:175], a[40:43]
v_exp_f32 v108, v108
v_mfma_f32_16x16x32_bf16 a[72:75], a[184:187], v[176:179], a[72:75]
global_load_dword a252, v19, s[14:15]
v_mfma_f32_16x16x32_bf16 a[104:107], a[184:187], v[180:183], a[104:107]
s_waitcnt lgkmcnt(5)
v_exp_f32 v109, v109
v_mfma_f32_16x16x32_bf16 a[12:15], a[188:191], v[168:171], a[12:15]
ds_read_b128 a[148:151], v2 offset:1024
v_cvt_pk_bf16_f32 v162, v108, v109
v_mfma_f32_16x16x32_bf16 a[44:47], a[188:191], v[172:175], a[44:47]
v_exp_f32 v110, v110
v_mfma_f32_16x16x32_bf16 a[76:79], a[188:191], v[176:179], a[76:79]
buffer_load_dwordx4 v16, s[32:35], s70 offen offset:0 sc1 lds
v_mfma_f32_16x16x32_bf16 a[108:111], a[188:191], v[180:183], a[108:111]
s_waitcnt lgkmcnt(5)
v_exp_f32 v111, v111
v_mfma_f32_16x16x32_bf16 a[16:19], a[192:195], v[168:171], a[16:19]
ds_read_b128 a[152:155], v2 offset:2048
v_cvt_pk_bf16_f32 v163, v110, v111
v_mfma_f32_16x16x32_bf16 a[48:51], a[192:195], v[172:175], a[48:51]
v_exp_f32 v112, v112
v_mfma_f32_16x16x32_bf16 a[80:83], a[192:195], v[176:179], a[80:83]
v_and_b32 v19, 2097151, v19
v_xor_b32 v3, 0x8000, v3
v_mfma_f32_16x16x32_bf16 a[112:115], a[192:195], v[180:183], a[112:115]
s_waitcnt lgkmcnt(5)
v_exp_f32 v113, v113
v_mfma_f32_16x16x32_bf16 a[20:23], a[196:199], v[168:171], a[20:23]
ds_read_b128 a[156:159], v2 offset:3072
v_cvt_pk_bf16_f32 v164, v112, v113
v_mfma_f32_16x16x32_bf16 a[52:55], a[196:199], v[172:175], a[52:55]
v_exp_f32 v114, v114
v_mfma_f32_16x16x32_bf16 a[84:87], a[196:199], v[176:179], a[84:87]
global_load_dword a252, v19, s[20:21]
v_mfma_f32_16x16x32_bf16 a[116:119], a[196:199], v[180:183], a[116:119]
s_waitcnt lgkmcnt(5)
v_exp_f32 v115, v115
v_mfma_f32_16x16x32_bf16 a[24:27], a[200:203], v[168:171], a[24:27]
ds_read_b128 a[160:163], v2 offset:4096
v_cvt_pk_bf16_f32 v165, v114, v115
v_mfma_f32_16x16x32_bf16 a[56:59], a[200:203], v[172:175], a[56:59]
v_exp_f32 v116, v116
v_mfma_f32_16x16x32_bf16 a[88:91], a[200:203], v[176:179], a[88:91]
buffer_load_dwordx4 v16, s[32:35], s70 offen offset:1024 sc1 lds
v_mfma_f32_16x16x32_bf16 a[120:123], a[200:203], v[180:183], a[120:123]
s_waitcnt lgkmcnt(5)
v_exp_f32 v117, v117
v_mfma_f32_16x16x32_bf16 a[28:31], a[204:207], v[168:171], a[28:31]
ds_read_b128 a[164:167], v2 offset:5120
v_cvt_pk_bf16_f32 v166, v116, v117
v_mfma_f32_16x16x32_bf16 a[60:63], a[204:207], v[172:175], a[60:63]
v_exp_f32 v118, v118
v_mfma_f32_16x16x32_bf16 a[92:95], a[204:207], v[176:179], a[92:95]
v_mfma_f32_16x16x32_bf16 a[124:127], a[204:207], v[180:183], a[124:127]
v_exp_f32 v119, v119
v_mfma_f32_16x16x32_bf16 a[128:131], v[12:15], v[168:171], a[128:131]
v_cvt_pk_bf16_f32 v167, v118, v119
v_mfma_f32_16x16x32_bf16 a[132:135], v[12:15], v[172:175], a[132:135]
v_mfma_f32_16x16x32_bf16 a[136:139], v[12:15], v[176:179], a[136:139]
v_mfma_f32_16x16x32_bf16 a[140:143], v[12:15], v[180:183], a[140:143]
s_sub_u32 s72, s3, 1
s_cmp_eq_u32 s72, 0
s_cbranch_scc1 L_DD_7
.p2align 3
L_D_6:
s_waitcnt lgkmcnt(5)
v_mfma_f32_16x16x32_bf16 v[88:91], a[144:147], v[24:27], v[184:187]
ds_read_b128 a[168:171], v2 offset:6144
v_mfma_f32_16x16x32_bf16 v[96:99], a[144:147], v[40:43], v[188:191]
v_exp_f32 v120, v120
v_mfma_f32_16x16x32_bf16 v[104:107], a[144:147], v[56:59], v[192:195]
v_mfma_f32_16x16x32_bf16 v[112:115], a[144:147], v[72:75], v[196:199]
s_waitcnt lgkmcnt(5)
v_exp_f32 v121, v121
v_mfma_f32_16x16x32_bf16 v[88:91], a[148:151], v[28:31], v[88:91]
ds_read_b128 a[172:175], v2 offset:7168
v_cvt_pk_bf16_f32 v168, v120, v121
v_mfma_f32_16x16x32_bf16 v[96:99], a[148:151], v[44:47], v[96:99]
v_exp_f32 v122, v122
v_mfma_f32_16x16x32_bf16 v[104:107], a[148:151], v[60:63], v[104:107]
buffer_load_dwordx4 v16, s[32:35], s70 offen offset:2048 sc1 lds
v_mfma_f32_16x16x32_bf16 v[112:115], a[148:151], v[76:79], v[112:115]
s_waitcnt lgkmcnt(5)
v_exp_f32 v123, v123
v_mfma_f32_16x16x32_bf16 v[88:91], a[152:155], v[32:35], v[88:91]
ds_read_b128 a[176:179], v3 offset:0
v_cvt_pk_bf16_f32 v169, v122, v123
v_mfma_f32_16x16x32_bf16 v[96:99], a[152:155], v[48:51], v[96:99]
v_exp_f32 v124, v124
v_mfma_f32_16x16x32_bf16 v[104:107], a[152:155], v[64:67], v[104:107]
v_mfma_f32_16x16x32_bf16 v[112:115], a[152:155], v[80:83], v[112:115]
s_waitcnt lgkmcnt(5)
v_exp_f32 v125, v125
v_mfma_f32_16x16x32_bf16 v[88:91], a[156:159], v[36:39], v[88:91]
ds_read_b128 a[180:183], v3 offset:1024
v_cvt_pk_bf16_f32 v170, v124, v125
v_mfma_f32_16x16x32_bf16 v[96:99], a[156:159], v[52:55], v[96:99]
v_exp_f32 v126, v126
v_mfma_f32_16x16x32_bf16 v[104:107], a[156:159], v[68:71], v[104:107]
v_mfma_f32_16x16x32_bf16 v[112:115], a[156:159], v[84:87], v[112:115]
s_waitcnt lgkmcnt(5)
v_exp_f32 v127, v127
v_mfma_f32_16x16x32_bf16 v[92:95], a[160:163], v[24:27], v[184:187]
ds_read_b128 a[184:187], v3 offset:2048
v_cvt_pk_bf16_f32 v171, v126, v127
v_mfma_f32_16x16x32_bf16 v[100:103], a[160:163], v[40:43], v[188:191]
v_exp_f32 v128, v128
v_mfma_f32_16x16x32_bf16 v[108:111], a[160:163], v[56:59], v[192:195]
buffer_load_dwordx4 v16, s[32:35], s70 offen offset:3072 sc1 lds
v_mfma_f32_16x16x32_bf16 v[116:119], a[160:163], v[72:75], v[196:199]
s_waitcnt lgkmcnt(5)
v_exp_f32 v129, v129
v_mfma_f32_16x16x32_bf16 v[92:95], a[164:167], v[28:31], v[92:95]
ds_read_b128 a[188:191], v3 offset:3072
v_cvt_pk_bf16_f32 v172, v128, v129
v_mfma_f32_16x16x32_bf16 v[100:103], a[164:167], v[44:47], v[100:103]
v_exp_f32 v130, v130
v_mfma_f32_16x16x32_bf16 v[108:111], a[164:167], v[60:63], v[108:111]
v_mfma_f32_16x16x32_bf16 v[116:119], a[164:167], v[76:79], v[116:119]
s_waitcnt lgkmcnt(5)
v_exp_f32 v131, v131
v_mfma_f32_16x16x32_bf16 v[92:95], a[168:171], v[32:35], v[92:95]
s_add_u32 m0, s71, 4096
ds_read_b128 a[192:195], v3 offset:4096
v_cvt_pk_bf16_f32 v173, v130, v131
v_mfma_f32_16x16x32_bf16 v[100:103], a[168:171], v[48:51], v[100:103]
v_exp_f32 v132, v132
v_mfma_f32_16x16x32_bf16 v[108:111], a[168:171], v[64:67], v[108:111]
s_add_u32 s64, s70, 4096
v_mfma_f32_16x16x32_bf16 v[116:119], a[168:171], v[80:83], v[116:119]
s_waitcnt lgkmcnt(5)
v_exp_f32 v133, v133
v_mfma_f32_16x16x32_bf16 v[92:95], a[172:175], v[36:39], v[92:95]
ds_read_b128 a[196:199], v3 offset:5120
v_cvt_pk_bf16_f32 v174, v132, v133
v_mfma_f32_16x16x32_bf16 v[100:103], a[172:175], v[52:55], v[100:103]
v_exp_f32 v134, v134
v_mfma_f32_16x16x32_bf16 v[108:111], a[172:175], v[68:71], v[108:111]
buffer_load_dwordx4 v16, s[32:35], s64 offen offset:0 sc1 lds
v_mfma_f32_16x16x32_bf16 v[116:119], a[172:175], v[84:87], v[116:119]
s_waitcnt lgkmcnt(5)
v_exp_f32 v135, v135
v_mfma_f32_16x16x32_bf16 a[0:3], a[176:179], v[152:155], a[0:3]
ds_read_b128 a[200:203], v3 offset:6144
v_cvt_pk_bf16_f32 v175, v134, v135
v_mfma_f32_16x16x32_bf16 a[32:35], a[176:179], v[156:159], a[32:35]
v_exp_f32 v136, v136
v_mfma_f32_16x16x32_bf16 a[64:67], a[176:179], v[160:163], a[64:67]
v_mfma_f32_16x16x32_bf16 a[96:99], a[176:179], v[164:167], a[96:99]
s_waitcnt lgkmcnt(5)
v_exp_f32 v137, v137
v_mfma_f32_16x16x32_bf16 a[4:7], a[180:183], v[152:155], a[4:7]
ds_read_b128 a[204:207], v3 offset:7168
v_cvt_pk_bf16_f32 v176, v136, v137
v_mfma_f32_16x16x32_bf16 a[36:39], a[180:183], v[156:159], a[36:39]
v_exp_f32 v138, v138
v_mfma_f32_16x16x32_bf16 a[68:71], a[180:183], v[160:163], a[68:71]
v_mfma_f32_16x16x32_bf16 a[100:103], a[180:183], v[164:167], a[100:103]
s_waitcnt lgkmcnt(5)
v_exp_f32 v139, v139
v_mfma_f32_16x16x32_bf16 a[8:11], a[184:187], v[152:155], a[8:11]
ds_read_b128 a[144:147], v2 offset:8192
v_cvt_pk_bf16_f32 v177, v138, v139
v_mfma_f32_16x16x32_bf16 a[40:43], a[184:187], v[156:159], a[40:43]
v_exp_f32 v140, v140
v_mfma_f32_16x16x32_bf16 a[72:75], a[184:187], v[160:163], a[72:75]
buffer_load_dwordx4 v16, s[32:35], s64 offen offset:1024 sc1 lds
v_mfma_f32_16x16x32_bf16 a[104:107], a[184:187], v[164:167], a[104:107]
s_waitcnt lgkmcnt(5)
v_exp_f32 v141, v141
v_mfma_f32_16x16x32_bf16 a[12:15], a[188:191], v[152:155], a[12:15]
ds_read_b128 a[148:151], v2 offset:9216
v_cvt_pk_bf16_f32 v178, v140, v141
v_mfma_f32_16x16x32_bf16 a[44:47], a[188:191], v[156:159], a[44:47]
v_exp_f32 v142, v142
v_mfma_f32_16x16x32_bf16 a[76:79], a[188:191], v[160:163], a[76:79]
v_mfma_f32_16x16x32_bf16 a[108:111], a[188:191], v[164:167], a[108:111]
s_waitcnt lgkmcnt(5)
v_exp_f32 v143, v143
v_mfma_f32_16x16x32_bf16 a[16:19], a[192:195], v[152:155], a[16:19]
ds_read_b128 a[152:155], v2 offset:10240
v_cvt_pk_bf16_f32 v179, v142, v143
v_mfma_f32_16x16x32_bf16 a[48:51], a[192:195], v[156:159], a[48:51]
v_exp_f32 v144, v144
v_mfma_f32_16x16x32_bf16 a[80:83], a[192:195], v[160:163], a[80:83]
v_mfma_f32_16x16x32_bf16 a[112:115], a[192:195], v[164:167], a[112:115]
s_waitcnt lgkmcnt(5)
v_exp_f32 v145, v145
v_mfma_f32_16x16x32_bf16 a[20:23], a[196:199], v[152:155], a[20:23]
ds_read_b128 a[156:159], v2 offset:11264
v_cvt_pk_bf16_f32 v180, v144, v145
v_mfma_f32_16x16x32_bf16 a[52:55], a[196:199], v[156:159], a[52:55]
v_exp_f32 v146, v146
v_mfma_f32_16x16x32_bf16 a[84:87], a[196:199], v[160:163], a[84:87]
v_mfma_f32_16x16x32_bf16 a[116:119], a[196:199], v[164:167], a[116:119]
s_waitcnt lgkmcnt(5)
v_exp_f32 v147, v147
v_mfma_f32_16x16x32_bf16 a[24:27], a[200:203], v[152:155], a[24:27]
ds_read_b128 a[160:163], v2 offset:12288
v_cvt_pk_bf16_f32 v181, v146, v147
v_mfma_f32_16x16x32_bf16 a[56:59], a[200:203], v[156:159], a[56:59]
v_exp_f32 v148, v148
v_mfma_f32_16x16x32_bf16 a[88:91], a[200:203], v[160:163], a[88:91]
buffer_load_dwordx4 v16, s[32:35], s64 offen offset:2048 sc1 lds
v_mfma_f32_16x16x32_bf16 a[120:123], a[200:203], v[164:167], a[120:123]
s_waitcnt lgkmcnt(5)
v_exp_f32 v149, v149
v_mfma_f32_16x16x32_bf16 a[28:31], a[204:207], v[152:155], a[28:31]
ds_read_b128 a[164:167], v2 offset:13312
v_cvt_pk_bf16_f32 v182, v148, v149
v_mfma_f32_16x16x32_bf16 a[60:63], a[204:207], v[156:159], a[60:63]
v_exp_f32 v150, v150
v_mfma_f32_16x16x32_bf16 a[92:95], a[204:207], v[160:163], a[92:95]
v_mfma_f32_16x16x32_bf16 a[124:127], a[204:207], v[164:167], a[124:127]
v_exp_f32 v151, v151
v_mfma_f32_16x16x32_bf16 a[128:131], v[12:15], v[152:155], a[128:131]
v_cvt_pk_bf16_f32 v183, v150, v151
v_mfma_f32_16x16x32_bf16 a[132:135], v[12:15], v[156:159], a[132:135]
v_mfma_f32_16x16x32_bf16 a[136:139], v[12:15], v[160:163], a[136:139]
v_mfma_f32_16x16x32_bf16 a[140:143], v[12:15], v[164:167], a[140:143]
s_waitcnt lgkmcnt(5)
v_mfma_f32_16x16x32_bf16 v[120:123], a[144:147], v[24:27], v[184:187]
ds_read_b128 a[168:171], v2 offset:14336
v_mfma_f32_16x16x32_bf16 v[128:131], a[144:147], v[40:43], v[188:191]
v_exp_f32 v88, v88
v_mfma_f32_16x16x32_bf16 v[136:139], a[144:147], v[56:59], v[192:195]
v_mfma_f32_16x16x32_bf16 v[144:147], a[144:147], v[72:75], v[196:199]
s_waitcnt lgkmcnt(5)
v_exp_f32 v89, v89
v_mfma_f32_16x16x32_bf16 v[120:123], a[148:151], v[28:31], v[120:123]
ds_read_b128 a[172:175], v2 offset:15360
v_cvt_pk_bf16_f32 v152, v88, v89
v_mfma_f32_16x16x32_bf16 v[128:131], a[148:151], v[44:47], v[128:131]
v_exp_f32 v90, v90
v_mfma_f32_16x16x32_bf16 v[136:139], a[148:151], v[60:63], v[136:139]
v_mfma_f32_16x16x32_bf16 v[144:147], a[148:151], v[76:79], v[144:147]
s_waitcnt lgkmcnt(5)
v_exp_f32 v91, v91
v_mfma_f32_16x16x32_bf16 v[120:123], a[152:155], v[32:35], v[120:123]
ds_read_b128 a[176:179], v3 offset:8192
v_cvt_pk_bf16_f32 v153, v90, v91
v_mfma_f32_16x16x32_bf16 v[128:131], a[152:155], v[48:51], v[128:131]
v_exp_f32 v92, v92
v_mfma_f32_16x16x32_bf16 v[136:139], a[152:155], v[64:67], v[136:139]
v_mfma_f32_16x16x32_bf16 v[144:147], a[152:155], v[80:83], v[144:147]
s_waitcnt lgkmcnt(5)
v_exp_f32 v93, v93
v_mfma_f32_16x16x32_bf16 v[120:123], a[156:159], v[36:39], v[120:123]
ds_read_b128 a[180:183], v3 offset:9216
v_cvt_pk_bf16_f32 v154, v92, v93
v_mfma_f32_16x16x32_bf16 v[128:131], a[156:159], v[52:55], v[128:131]
v_exp_f32 v94, v94
v_mfma_f32_16x16x32_bf16 v[136:139], a[156:159], v[68:71], v[136:139]
buffer_load_dwordx4 v16, s[32:35], s64 offen offset:3072 sc1 lds
v_mfma_f32_16x16x32_bf16 v[144:147], a[156:159], v[84:87], v[144:147]
s_waitcnt lgkmcnt(5)
v_exp_f32 v95, v95
v_mfma_f32_16x16x32_bf16 v[124:127], a[160:163], v[24:27], v[184:187]
ds_read_b128 a[184:187], v3 offset:10240
v_cvt_pk_bf16_f32 v155, v94, v95
v_mfma_f32_16x16x32_bf16 v[132:135], a[160:163], v[40:43], v[188:191]
v_exp_f32 v96, v96
v_mfma_f32_16x16x32_bf16 v[140:143], a[160:163], v[56:59], v[192:195]
v_mfma_f32_16x16x32_bf16 v[148:151], a[160:163], v[72:75], v[196:199]
s_waitcnt lgkmcnt(5)
v_exp_f32 v97, v97
v_mfma_f32_16x16x32_bf16 v[124:127], a[164:167], v[28:31], v[124:127]
ds_read_b128 a[188:191], v3 offset:11264
v_cvt_pk_bf16_f32 v156, v96, v97
v_mfma_f32_16x16x32_bf16 v[132:135], a[164:167], v[44:47], v[132:135]
v_exp_f32 v98, v98
v_mfma_f32_16x16x32_bf16 v[140:143], a[164:167], v[60:63], v[140:143]
v_mfma_f32_16x16x32_bf16 v[148:151], a[164:167], v[76:79], v[148:151]
s_waitcnt lgkmcnt(5)
v_exp_f32 v99, v99
v_mfma_f32_16x16x32_bf16 v[124:127], a[168:171], v[32:35], v[124:127]
s_xor_b32 s71, s71, 16384
ds_read_b128 a[192:195], v3 offset:12288
v_cvt_pk_bf16_f32 v157, v98, v99
v_mfma_f32_16x16x32_bf16 v[132:135], a[168:171], v[48:51], v[132:135]
v_exp_f32 v100, v100
v_mfma_f32_16x16x32_bf16 v[140:143], a[168:171], v[64:67], v[140:143]
v_mfma_f32_16x16x32_bf16 v[148:151], a[168:171], v[80:83], v[148:151]
s_waitcnt lgkmcnt(5)
v_exp_f32 v101, v101
v_mfma_f32_16x16x32_bf16 v[124:127], a[172:175], v[36:39], v[124:127]
ds_read_b128 a[196:199], v3 offset:13312
v_cvt_pk_bf16_f32 v158, v100, v101
v_mfma_f32_16x16x32_bf16 v[132:135], a[172:175], v[52:55], v[132:135]
v_exp_f32 v102, v102
v_mfma_f32_16x16x32_bf16 v[140:143], a[172:175], v[68:71], v[140:143]
v_mfma_f32_16x16x32_bf16 v[148:151], a[172:175], v[84:87], v[148:151]
s_waitcnt lgkmcnt(5)
v_exp_f32 v103, v103
v_mfma_f32_16x16x32_bf16 a[0:3], a[176:179], v[168:171], a[0:3]
s_add_u32 s70, s70, 32768
ds_read_b128 a[200:203], v3 offset:14336
v_cvt_pk_bf16_f32 v159, v102, v103
v_mfma_f32_16x16x32_bf16 a[32:35], a[176:179], v[172:175], a[32:35]
v_exp_f32 v104, v104
v_mfma_f32_16x16x32_bf16 a[64:67], a[176:179], v[176:179], a[64:67]
v_mfma_f32_16x16x32_bf16 a[96:99], a[176:179], v[180:183], a[96:99]
s_waitcnt lgkmcnt(5)
v_exp_f32 v105, v105
v_mfma_f32_16x16x32_bf16 a[4:7], a[180:183], v[168:171], a[4:7]
ds_read_b128 a[204:207], v3 offset:15360
v_cvt_pk_bf16_f32 v160, v104, v105
v_mfma_f32_16x16x32_bf16 a[36:39], a[180:183], v[172:175], a[36:39]
v_exp_f32 v106, v106
v_mfma_f32_16x16x32_bf16 a[68:71], a[180:183], v[176:179], a[68:71]
s_waitcnt vmcnt(8)
s_barrier
v_mfma_f32_16x16x32_bf16 a[100:103], a[180:183], v[180:183], a[100:103]
s_waitcnt lgkmcnt(5)
v_exp_f32 v107, v107
v_mfma_f32_16x16x32_bf16 a[8:11], a[184:187], v[168:171], a[8:11]
s_mov_b32 m0, s71
ds_read_b128 a[144:147], v2 offset:16384
v_cvt_pk_bf16_f32 v161, v106, v107
v_mfma_f32_16x16x32_bf16 a[40:43], a[184:187], v[172:175], a[40:43]
v_exp_f32 v108, v108
v_mfma_f32_16x16x32_bf16 a[72:75], a[184:187], v[176:179], a[72:75]
v_mfma_f32_16x16x32_bf16 a[104:107], a[184:187], v[180:183], a[104:107]
s_waitcnt lgkmcnt(5)
v_exp_f32 v109, v109
v_mfma_f32_16x16x32_bf16 a[12:15], a[188:191], v[168:171], a[12:15]
ds_read_b128 a[148:151], v2 offset:17408
v_cvt_pk_bf16_f32 v162, v108, v109
v_mfma_f32_16x16x32_bf16 a[44:47], a[188:191], v[172:175], a[44:47]
v_exp_f32 v110, v110
v_mfma_f32_16x16x32_bf16 a[76:79], a[188:191], v[176:179], a[76:79]
buffer_load_dwordx4 v16, s[32:35], s70 offen offset:0 sc1 lds
v_mfma_f32_16x16x32_bf16 a[108:111], a[188:191], v[180:183], a[108:111]
s_waitcnt lgkmcnt(5)
v_exp_f32 v111, v111
v_mfma_f32_16x16x32_bf16 a[16:19], a[192:195], v[168:171], a[16:19]
ds_read_b128 a[152:155], v2 offset:18432
v_cvt_pk_bf16_f32 v163, v110, v111
v_mfma_f32_16x16x32_bf16 a[48:51], a[192:195], v[172:175], a[48:51]
v_exp_f32 v112, v112
v_mfma_f32_16x16x32_bf16 a[80:83], a[192:195], v[176:179], a[80:83]
v_mfma_f32_16x16x32_bf16 a[112:115], a[192:195], v[180:183], a[112:115]
s_waitcnt lgkmcnt(5)
v_exp_f32 v113, v113
v_mfma_f32_16x16x32_bf16 a[20:23], a[196:199], v[168:171], a[20:23]
ds_read_b128 a[156:159], v2 offset:19456
v_cvt_pk_bf16_f32 v164, v112, v113
v_mfma_f32_16x16x32_bf16 a[52:55], a[196:199], v[172:175], a[52:55]
v_exp_f32 v114, v114
v_mfma_f32_16x16x32_bf16 a[84:87], a[196:199], v[176:179], a[84:87]
v_mfma_f32_16x16x32_bf16 a[116:119], a[196:199], v[180:183], a[116:119]
s_waitcnt lgkmcnt(5)
v_exp_f32 v115, v115
v_mfma_f32_16x16x32_bf16 a[24:27], a[200:203], v[168:171], a[24:27]
ds_read_b128 a[160:163], v2 offset:20480
v_cvt_pk_bf16_f32 v165, v114, v115
v_mfma_f32_16x16x32_bf16 a[56:59], a[200:203], v[172:175], a[56:59]
v_exp_f32 v116, v116
v_mfma_f32_16x16x32_bf16 a[88:91], a[200:203], v[176:179], a[88:91]
buffer_load_dwordx4 v16, s[32:35], s70 offen offset:1024 sc1 lds
v_mfma_f32_16x16x32_bf16 a[120:123], a[200:203], v[180:183], a[120:123]
s_waitcnt lgkmcnt(5)
v_exp_f32 v117, v117
v_mfma_f32_16x16x32_bf16 a[28:31], a[204:207], v[168:171], a[28:31]
ds_read_b128 a[164:167], v2 offset:21504
v_cvt_pk_bf16_f32 v166, v116, v117
v_mfma_f32_16x16x32_bf16 a[60:63], a[204:207], v[172:175], a[60:63]
v_exp_f32 v118, v118
v_mfma_f32_16x16x32_bf16 a[92:95], a[204:207], v[176:179], a[92:95]
v_mfma_f32_16x16x32_bf16 a[124:127], a[204:207], v[180:183], a[124:127]
v_exp_f32 v119, v119
v_mfma_f32_16x16x32_bf16 a[128:131], v[12:15], v[168:171], a[128:131]
v_cvt_pk_bf16_f32 v167, v118, v119
v_mfma_f32_16x16x32_bf16 a[132:135], v[12:15], v[172:175], a[132:135]
v_mfma_f32_16x16x32_bf16 a[136:139], v[12:15], v[176:179], a[136:139]
v_mfma_f32_16x16x32_bf16 a[140:143], v[12:15], v[180:183], a[140:143]
s_waitcnt lgkmcnt(5)
v_mfma_f32_16x16x32_bf16 v[88:91], a[144:147], v[24:27], v[184:187]
ds_read_b128 a[168:171], v2 offset:22528
v_mfma_f32_16x16x32_bf16 v[96:99], a[144:147], v[40:43], v[188:191]
v_exp_f32 v120, v120
v_mfma_f32_16x16x32_bf16 v[104:107], a[144:147], v[56:59], v[192:195]
v_mfma_f32_16x16x32_bf16 v[112:115], a[144:147], v[72:75], v[196:199]
s_waitcnt lgkmcnt(5)
v_exp_f32 v121, v121
v_mfma_f32_16x16x32_bf16 v[88:91], a[148:151], v[28:31], v[88:91]
ds_read_b128 a[172:175], v2 offset:23552
v_cvt_pk_bf16_f32 v168, v120, v121
v_mfma_f32_16x16x32_bf16 v[96:99], a[148:151], v[44:47], v[96:99]
v_exp_f32 v122, v122
v_mfma_f32_16x16x32_bf16 v[104:107], a[148:151], v[60:63], v[104:107]
buffer_load_dwordx4 v16, s[32:35], s70 offen offset:2048 sc1 lds
v_mfma_f32_16x16x32_bf16 v[112:115], a[148:151], v[76:79], v[112:115]
s_waitcnt lgkmcnt(5)
v_exp_f32 v123, v123
v_mfma_f32_16x16x32_bf16 v[88:91], a[152:155], v[32:35], v[88:91]
ds_read_b128 a[176:179], v3 offset:16384
v_cvt_pk_bf16_f32 v169, v122, v123
v_mfma_f32_16x16x32_bf16 v[96:99], a[152:155], v[48:51], v[96:99]
v_exp_f32 v124, v124
v_mfma_f32_16x16x32_bf16 v[104:107], a[152:155], v[64:67], v[104:107]
v_mfma_f32_16x16x32_bf16 v[112:115], a[152:155], v[80:83], v[112:115]
s_waitcnt lgkmcnt(5)
v_exp_f32 v125, v125
v_mfma_f32_16x16x32_bf16 v[88:91], a[156:159], v[36:39], v[88:91]
ds_read_b128 a[180:183], v3 offset:17408
v_cvt_pk_bf16_f32 v170, v124, v125
v_mfma_f32_16x16x32_bf16 v[96:99], a[156:159], v[52:55], v[96:99]
v_exp_f32 v126, v126
v_mfma_f32_16x16x32_bf16 v[104:107], a[156:159], v[68:71], v[104:107]
v_mfma_f32_16x16x32_bf16 v[112:115], a[156:159], v[84:87], v[112:115]
s_waitcnt lgkmcnt(5)
v_exp_f32 v127, v127
v_mfma_f32_16x16x32_bf16 v[92:95], a[160:163], v[24:27], v[184:187]
ds_read_b128 a[184:187], v3 offset:18432
v_cvt_pk_bf16_f32 v171, v126, v127
v_mfma_f32_16x16x32_bf16 v[100:103], a[160:163], v[40:43], v[188:191]
v_exp_f32 v128, v128
v_mfma_f32_16x16x32_bf16 v[108:111], a[160:163], v[56:59], v[192:195]
buffer_load_dwordx4 v16, s[32:35], s70 offen offset:3072 sc1 lds
v_mfma_f32_16x16x32_bf16 v[116:119], a[160:163], v[72:75], v[196:199]
s_waitcnt lgkmcnt(5)
v_exp_f32 v129, v129
v_mfma_f32_16x16x32_bf16 v[92:95], a[164:167], v[28:31], v[92:95]
ds_read_b128 a[188:191], v3 offset:19456
v_cvt_pk_bf16_f32 v172, v128, v129
v_mfma_f32_16x16x32_bf16 v[100:103], a[164:167], v[44:47], v[100:103]
v_exp_f32 v130, v130
v_mfma_f32_16x16x32_bf16 v[108:111], a[164:167], v[60:63], v[108:111]
v_mfma_f32_16x16x32_bf16 v[116:119], a[164:167], v[76:79], v[116:119]
s_waitcnt lgkmcnt(5)
v_exp_f32 v131, v131
v_mfma_f32_16x16x32_bf16 v[92:95], a[168:171], v[32:35], v[92:95]
s_add_u32 m0, s71, 4096
ds_read_b128 a[192:195], v3 offset:20480
v_cvt_pk_bf16_f32 v173, v130, v131
v_mfma_f32_16x16x32_bf16 v[100:103], a[168:171], v[48:51], v[100:103]
v_exp_f32 v132, v132
v_mfma_f32_16x16x32_bf16 v[108:111], a[168:171], v[64:67], v[108:111]
s_add_u32 s64, s70, 4096
v_mfma_f32_16x16x32_bf16 v[116:119], a[168:171], v[80:83], v[116:119]
s_waitcnt lgkmcnt(5)
v_exp_f32 v133, v133
v_mfma_f32_16x16x32_bf16 v[92:95], a[172:175], v[36:39], v[92:95]
ds_read_b128 a[196:199], v3 offset:21504
v_cvt_pk_bf16_f32 v174, v132, v133
v_mfma_f32_16x16x32_bf16 v[100:103], a[172:175], v[52:55], v[100:103]
v_exp_f32 v134, v134
v_mfma_f32_16x16x32_bf16 v[108:111], a[172:175], v[68:71], v[108:111]
buffer_load_dwordx4 v16, s[32:35], s64 offen offset:0 sc1 lds
v_mfma_f32_16x16x32_bf16 v[116:119], a[172:175], v[84:87], v[116:119]
s_waitcnt lgkmcnt(5)
v_exp_f32 v135, v135
v_mfma_f32_16x16x32_bf16 a[0:3], a[176:179], v[152:155], a[0:3]
ds_read_b128 a[200:203], v3 offset:22528
v_cvt_pk_bf16_f32 v175, v134, v135
v_mfma_f32_16x16x32_bf16 a[32:35], a[176:179], v[156:159], a[32:35]
v_exp_f32 v136, v136
v_mfma_f32_16x16x32_bf16 a[64:67], a[176:179], v[160:163], a[64:67]
v_mfma_f32_16x16x32_bf16 a[96:99], a[176:179], v[164:167], a[96:99]
s_waitcnt lgkmcnt(5)
v_exp_f32 v137, v137
v_mfma_f32_16x16x32_bf16 a[4:7], a[180:183], v[152:155], a[4:7]
ds_read_b128 a[204:207], v3 offset:23552
v_cvt_pk_bf16_f32 v176, v136, v137
v_mfma_f32_16x16x32_bf16 a[36:39], a[180:183], v[156:159], a[36:39]
v_exp_f32 v138, v138
v_mfma_f32_16x16x32_bf16 a[68:71], a[180:183], v[160:163], a[68:71]
v_mfma_f32_16x16x32_bf16 a[100:103], a[180:183], v[164:167], a[100:103]
s_waitcnt lgkmcnt(5)
v_exp_f32 v139, v139
v_mfma_f32_16x16x32_bf16 a[8:11], a[184:187], v[152:155], a[8:11]
ds_read_b128 a[144:147], v2 offset:24576
v_cvt_pk_bf16_f32 v177, v138, v139
v_mfma_f32_16x16x32_bf16 a[40:43], a[184:187], v[156:159], a[40:43]
v_exp_f32 v140, v140
v_mfma_f32_16x16x32_bf16 a[72:75], a[184:187], v[160:163], a[72:75]
buffer_load_dwordx4 v16, s[32:35], s64 offen offset:1024 sc1 lds
v_mfma_f32_16x16x32_bf16 a[104:107], a[184:187], v[164:167], a[104:107]
s_waitcnt lgkmcnt(5)
v_exp_f32 v141, v141
v_mfma_f32_16x16x32_bf16 a[12:15], a[188:191], v[152:155], a[12:15]
ds_read_b128 a[148:151], v2 offset:25600
v_cvt_pk_bf16_f32 v178, v140, v141
v_mfma_f32_16x16x32_bf16 a[44:47], a[188:191], v[156:159], a[44:47]
v_exp_f32 v142, v142
v_mfma_f32_16x16x32_bf16 a[76:79], a[188:191], v[160:163], a[76:79]
v_mfma_f32_16x16x32_bf16 a[108:111], a[188:191], v[164:167], a[108:111]
s_waitcnt lgkmcnt(5)
v_exp_f32 v143, v143
v_mfma_f32_16x16x32_bf16 a[16:19], a[192:195], v[152:155], a[16:19]
ds_read_b128 a[152:155], v2 offset:26624
v_cvt_pk_bf16_f32 v179, v142, v143
v_mfma_f32_16x16x32_bf16 a[48:51], a[192:195], v[156:159], a[48:51]
v_exp_f32 v144, v144
v_mfma_f32_16x16x32_bf16 a[80:83], a[192:195], v[160:163], a[80:83]
v_mfma_f32_16x16x32_bf16 a[112:115], a[192:195], v[164:167], a[112:115]
s_waitcnt lgkmcnt(5)
v_exp_f32 v145, v145
v_mfma_f32_16x16x32_bf16 a[20:23], a[196:199], v[152:155], a[20:23]
ds_read_b128 a[156:159], v2 offset:27648
v_cvt_pk_bf16_f32 v180, v144, v145
v_mfma_f32_16x16x32_bf16 a[52:55], a[196:199], v[156:159], a[52:55]
v_exp_f32 v146, v146
v_mfma_f32_16x16x32_bf16 a[84:87], a[196:199], v[160:163], a[84:87]
v_mfma_f32_16x16x32_bf16 a[116:119], a[196:199], v[164:167], a[116:119]
s_waitcnt lgkmcnt(5)
v_exp_f32 v147, v147
v_mfma_f32_16x16x32_bf16 a[24:27], a[200:203], v[152:155], a[24:27]
ds_read_b128 a[160:163], v2 offset:28672
v_cvt_pk_bf16_f32 v181, v146, v147
v_mfma_f32_16x16x32_bf16 a[56:59], a[200:203], v[156:159], a[56:59]
v_exp_f32 v148, v148
v_mfma_f32_16x16x32_bf16 a[88:91], a[200:203], v[160:163], a[88:91]
buffer_load_dwordx4 v16, s[32:35], s64 offen offset:2048 sc1 lds
v_mfma_f32_16x16x32_bf16 a[120:123], a[200:203], v[164:167], a[120:123]
s_waitcnt lgkmcnt(5)
v_exp_f32 v149, v149
v_mfma_f32_16x16x32_bf16 a[28:31], a[204:207], v[152:155], a[28:31]
ds_read_b128 a[164:167], v2 offset:29696
v_cvt_pk_bf16_f32 v182, v148, v149
v_mfma_f32_16x16x32_bf16 a[60:63], a[204:207], v[156:159], a[60:63]
v_exp_f32 v150, v150
v_mfma_f32_16x16x32_bf16 a[92:95], a[204:207], v[160:163], a[92:95]
v_mfma_f32_16x16x32_bf16 a[124:127], a[204:207], v[164:167], a[124:127]
v_exp_f32 v151, v151
v_mfma_f32_16x16x32_bf16 a[128:131], v[12:15], v[152:155], a[128:131]
v_cvt_pk_bf16_f32 v183, v150, v151
v_mfma_f32_16x16x32_bf16 a[132:135], v[12:15], v[156:159], a[132:135]
v_mfma_f32_16x16x32_bf16 a[136:139], v[12:15], v[160:163], a[136:139]
v_mfma_f32_16x16x32_bf16 a[140:143], v[12:15], v[164:167], a[140:143]
s_waitcnt lgkmcnt(5)
v_mfma_f32_16x16x32_bf16 v[120:123], a[144:147], v[24:27], v[184:187]
ds_read_b128 a[168:171], v2 offset:30720
v_mfma_f32_16x16x32_bf16 v[128:131], a[144:147], v[40:43], v[188:191]
v_exp_f32 v88, v88
v_mfma_f32_16x16x32_bf16 v[136:139], a[144:147], v[56:59], v[192:195]
v_mfma_f32_16x16x32_bf16 v[144:147], a[144:147], v[72:75], v[196:199]
s_waitcnt lgkmcnt(5)
v_exp_f32 v89, v89
v_mfma_f32_16x16x32_bf16 v[120:123], a[148:151], v[28:31], v[120:123]
ds_read_b128 a[172:175], v2 offset:31744
v_cvt_pk_bf16_f32 v152, v88, v89
v_mfma_f32_16x16x32_bf16 v[128:131], a[148:151], v[44:47], v[128:131]
v_exp_f32 v90, v90
v_mfma_f32_16x16x32_bf16 v[136:139], a[148:151], v[60:63], v[136:139]
v_xor_b32 v2, 0x8000, v2
v_mfma_f32_16x16x32_bf16 v[144:147], a[148:151], v[76:79], v[144:147]
s_waitcnt lgkmcnt(5)
v_exp_f32 v91, v91
v_mfma_f32_16x16x32_bf16 v[120:123], a[152:155], v[32:35], v[120:123]
ds_read_b128 a[176:179], v3 offset:24576
v_cvt_pk_bf16_f32 v153, v90, v91
v_mfma_f32_16x16x32_bf16 v[128:131], a[152:155], v[48:51], v[128:131]
v_exp_f32 v92, v92
v_mfma_f32_16x16x32_bf16 v[136:139], a[152:155], v[64:67], v[136:139]
v_mfma_f32_16x16x32_bf16 v[144:147], a[152:155], v[80:83], v[144:147]
s_waitcnt lgkmcnt(5)
v_exp_f32 v93, v93
v_mfma_f32_16x16x32_bf16 v[120:123], a[156:159], v[36:39], v[120:123]
ds_read_b128 a[180:183], v3 offset:25600
v_cvt_pk_bf16_f32 v154, v92, v93
v_mfma_f32_16x16x32_bf16 v[128:131], a[156:159], v[52:55], v[128:131]
v_exp_f32 v94, v94
v_mfma_f32_16x16x32_bf16 v[136:139], a[156:159], v[68:71], v[136:139]
buffer_load_dwordx4 v16, s[32:35], s64 offen offset:3072 sc1 lds
v_mfma_f32_16x16x32_bf16 v[144:147], a[156:159], v[84:87], v[144:147]
s_waitcnt lgkmcnt(5)
v_exp_f32 v95, v95
v_mfma_f32_16x16x32_bf16 v[124:127], a[160:163], v[24:27], v[184:187]
ds_read_b128 a[184:187], v3 offset:26624
v_cvt_pk_bf16_f32 v155, v94, v95
v_mfma_f32_16x16x32_bf16 v[132:135], a[160:163], v[40:43], v[188:191]
v_exp_f32 v96, v96
v_mfma_f32_16x16x32_bf16 v[140:143], a[160:163], v[56:59], v[192:195]
v_mfma_f32_16x16x32_bf16 v[148:151], a[160:163], v[72:75], v[196:199]
s_waitcnt lgkmcnt(5)
v_exp_f32 v97, v97
v_mfma_f32_16x16x32_bf16 v[124:127], a[164:167], v[28:31], v[124:127]
ds_read_b128 a[188:191], v3 offset:27648
v_cvt_pk_bf16_f32 v156, v96, v97
v_mfma_f32_16x16x32_bf16 v[132:135], a[164:167], v[44:47], v[132:135]
v_exp_f32 v98, v98
v_mfma_f32_16x16x32_bf16 v[140:143], a[164:167], v[60:63], v[140:143]
v_mfma_f32_16x16x32_bf16 v[148:151], a[164:167], v[76:79], v[148:151]
s_waitcnt lgkmcnt(5)
v_exp_f32 v99, v99
v_mfma_f32_16x16x32_bf16 v[124:127], a[168:171], v[32:35], v[124:127]
s_xor_b32 s71, s71, 49152
ds_read_b128 a[192:195], v3 offset:28672
v_cvt_pk_bf16_f32 v157, v98, v99
v_mfma_f32_16x16x32_bf16 v[132:135], a[168:171], v[48:51], v[132:135]
v_exp_f32 v100, v100
v_mfma_f32_16x16x32_bf16 v[140:143], a[168:171], v[64:67], v[140:143]
v_mfma_f32_16x16x32_bf16 v[148:151], a[168:171], v[80:83], v[148:151]
s_waitcnt lgkmcnt(5)
v_exp_f32 v101, v101
v_mfma_f32_16x16x32_bf16 v[124:127], a[172:175], v[36:39], v[124:127]
ds_read_b128 a[196:199], v3 offset:29696
v_cvt_pk_bf16_f32 v158, v100, v101
v_mfma_f32_16x16x32_bf16 v[132:135], a[172:175], v[52:55], v[132:135]
v_exp_f32 v102, v102
v_mfma_f32_16x16x32_bf16 v[140:143], a[172:175], v[68:71], v[140:143]
v_mfma_f32_16x16x32_bf16 v[148:151], a[172:175], v[84:87], v[148:151]
s_waitcnt lgkmcnt(5)
v_exp_f32 v103, v103
v_mfma_f32_16x16x32_bf16 a[0:3], a[176:179], v[168:171], a[0:3]
s_add_u32 s70, s70, 32768
ds_read_b128 a[200:203], v3 offset:30720
v_cvt_pk_bf16_f32 v159, v102, v103
v_mfma_f32_16x16x32_bf16 a[32:35], a[176:179], v[172:175], a[32:35]
v_exp_f32 v104, v104
v_mfma_f32_16x16x32_bf16 a[64:67], a[176:179], v[176:179], a[64:67]
v_mfma_f32_16x16x32_bf16 a[96:99], a[176:179], v[180:183], a[96:99]
s_waitcnt lgkmcnt(5)
v_exp_f32 v105, v105
v_mfma_f32_16x16x32_bf16 a[4:7], a[180:183], v[168:171], a[4:7]
ds_read_b128 a[204:207], v3 offset:31744
v_cvt_pk_bf16_f32 v160, v104, v105
v_mfma_f32_16x16x32_bf16 a[36:39], a[180:183], v[172:175], a[36:39]
v_exp_f32 v106, v106
v_mfma_f32_16x16x32_bf16 a[68:71], a[180:183], v[176:179], a[68:71]
s_waitcnt vmcnt(8)
s_barrier
v_mfma_f32_16x16x32_bf16 a[100:103], a[180:183], v[180:183], a[100:103]
s_waitcnt lgkmcnt(5)
v_exp_f32 v107, v107
v_mfma_f32_16x16x32_bf16 a[8:11], a[184:187], v[168:171], a[8:11]
s_mov_b32 m0, s71
ds_read_b128 a[144:147], v2 offset:0
v_cvt_pk_bf16_f32 v161, v106, v107
v_mfma_f32_16x16x32_bf16 a[40:43], a[184:187], v[172:175], a[40:43]
v_exp_f32 v108, v108
v_mfma_f32_16x16x32_bf16 a[72:75], a[184:187], v[176:179], a[72:75]
v_xor_b32 v3, 0x8000, v3
v_mfma_f32_16x16x32_bf16 a[104:107], a[184:187], v[180:183], a[104:107]
s_waitcnt lgkmcnt(5)
v_exp_f32 v109, v109
v_mfma_f32_16x16x32_bf16 a[12:15], a[188:191], v[168:171], a[12:15]
ds_read_b128 a[148:151], v2 offset:1024
v_cvt_pk_bf16_f32 v162, v108, v109
v_mfma_f32_16x16x32_bf16 a[44:47], a[188:191], v[172:175], a[44:47]
v_exp_f32 v110, v110
v_mfma_f32_16x16x32_bf16 a[76:79], a[188:191], v[176:179], a[76:79]
buffer_load_dwordx4 v16, s[32:35], s70 offen offset:0 sc1 lds
v_mfma_f32_16x16x32_bf16 a[108:111], a[188:191], v[180:183], a[108:111]
s_waitcnt lgkmcnt(5)
v_exp_f32 v111, v111
v_mfma_f32_16x16x32_bf16 a[16:19], a[192:195], v[168:171], a[16:19]
ds_read_b128 a[152:155], v2 offset:2048
v_cvt_pk_bf16_f32 v163, v110, v111
v_mfma_f32_16x16x32_bf16 a[48:51], a[192:195], v[172:175], a[48:51]
v_exp_f32 v112, v112
v_mfma_f32_16x16x32_bf16 a[80:83], a[192:195], v[176:179], a[80:83]
v_mfma_f32_16x16x32_bf16 a[112:115], a[192:195], v[180:183], a[112:115]
s_waitcnt lgkmcnt(5)
v_exp_f32 v113, v113
v_mfma_f32_16x16x32_bf16 a[20:23], a[196:199], v[168:171], a[20:23]
ds_read_b128 a[156:159], v2 offset:3072
v_cvt_pk_bf16_f32 v164, v112, v113
v_mfma_f32_16x16x32_bf16 a[52:55], a[196:199], v[172:175], a[52:55]
v_exp_f32 v114, v114
v_mfma_f32_16x16x32_bf16 a[84:87], a[196:199], v[176:179], a[84:87]
v_mfma_f32_16x16x32_bf16 a[116:119], a[196:199], v[180:183], a[116:119]
s_waitcnt lgkmcnt(5)
v_exp_f32 v115, v115
v_mfma_f32_16x16x32_bf16 a[24:27], a[200:203], v[168:171], a[24:27]
ds_read_b128 a[160:163], v2 offset:4096
v_cvt_pk_bf16_f32 v165, v114, v115
v_mfma_f32_16x16x32_bf16 a[56:59], a[200:203], v[172:175], a[56:59]
v_exp_f32 v116, v116
v_mfma_f32_16x16x32_bf16 a[88:91], a[200:203], v[176:179], a[88:91]
buffer_load_dwordx4 v16, s[32:35], s70 offen offset:1024 sc1 lds
v_mfma_f32_16x16x32_bf16 a[120:123], a[200:203], v[180:183], a[120:123]
s_waitcnt lgkmcnt(5)
v_exp_f32 v117, v117
v_mfma_f32_16x16x32_bf16 a[28:31], a[204:207], v[168:171], a[28:31]
ds_read_b128 a[164:167], v2 offset:5120
v_cvt_pk_bf16_f32 v166, v116, v117
v_mfma_f32_16x16x32_bf16 a[60:63], a[204:207], v[172:175], a[60:63]
v_exp_f32 v118, v118
v_mfma_f32_16x16x32_bf16 a[92:95], a[204:207], v[176:179], a[92:95]
v_mfma_f32_16x16x32_bf16 a[124:127], a[204:207], v[180:183], a[124:127]
v_exp_f32 v119, v119
v_mfma_f32_16x16x32_bf16 a[128:131], v[12:15], v[168:171], a[128:131]
v_cvt_pk_bf16_f32 v167, v118, v119
v_mfma_f32_16x16x32_bf16 a[132:135], v[12:15], v[172:175], a[132:135]
v_mfma_f32_16x16x32_bf16 a[136:139], v[12:15], v[176:179], a[136:139]
v_mfma_f32_16x16x32_bf16 a[140:143], v[12:15], v[180:183], a[140:143]
s_sub_u32 s72, s72, 1
s_cmp_lg_u32 s72, 0
s_cbranch_scc1 L_D_6
L_DD_7:
v_add_f32 v216, v184, v200
v_add_f32 v217, v184, v201
v_add_f32 v218, v184, v202
v_add_f32 v219, v184, v203
v_add_f32 v220, v184, v204
v_add_f32 v221, v184, v205
v_add_f32 v222, v184, v206
v_add_f32 v223, v184, v207
s_nop 0
s_waitcnt lgkmcnt(5)
v_mfma_f32_16x16x32_bf16 v[88:91], a[144:147], v[24:27], v[216:219]
ds_read_b128 a[168:171], v2 offset:6144
v_mfma_f32_16x16x32_bf16 v[96:99], a[144:147], v[40:43], v[188:191]
v_exp_f32 v120, v120
v_mfma_f32_16x16x32_bf16 v[104:107], a[144:147], v[56:59], v[192:195]
v_mfma_f32_16x16x32_bf16 v[112:115], a[144:147], v[72:75], v[196:199]
s_waitcnt lgkmcnt(5)
v_exp_f32 v121, v121
v_mfma_f32_16x16x32_bf16 v[88:91], a[148:151], v[28:31], v[88:91]
ds_read_b128 a[172:175], v2 offset:7168
v_cvt_pk_bf16_f32 v168, v120, v121
v_mfma_f32_16x16x32_bf16 v[96:99], a[148:151], v[44:47], v[96:99]
v_exp_f32 v122, v122
v_mfma_f32_16x16x32_bf16 v[104:107], a[148:151], v[60:63], v[104:107]
buffer_load_dwordx4 v16, s[32:35], s70 offen offset:2048 sc1 lds
v_mfma_f32_16x16x32_bf16 v[112:115], a[148:151], v[76:79], v[112:115]
s_waitcnt lgkmcnt(5)
v_exp_f32 v123, v123
v_mfma_f32_16x16x32_bf16 v[88:91], a[152:155], v[32:35], v[88:91]
ds_read_b128 a[176:179], v3 offset:0
v_cvt_pk_bf16_f32 v169, v122, v123
v_mfma_f32_16x16x32_bf16 v[96:99], a[152:155], v[48:51], v[96:99]
v_exp_f32 v124, v124
v_mfma_f32_16x16x32_bf16 v[104:107], a[152:155], v[64:67], v[104:107]
v_mfma_f32_16x16x32_bf16 v[112:115], a[152:155], v[80:83], v[112:115]
s_waitcnt lgkmcnt(5)
v_exp_f32 v125, v125
v_mfma_f32_16x16x32_bf16 v[88:91], a[156:159], v[36:39], v[88:91]
ds_read_b128 a[180:183], v3 offset:1024
v_cvt_pk_bf16_f32 v170, v124, v125
v_mfma_f32_16x16x32_bf16 v[96:99], a[156:159], v[52:55], v[96:99]
v_exp_f32 v126, v126
v_mfma_f32_16x16x32_bf16 v[104:107], a[156:159], v[68:71], v[104:107]
v_mfma_f32_16x16x32_bf16 v[112:115], a[156:159], v[84:87], v[112:115]
s_waitcnt lgkmcnt(5)
v_exp_f32 v127, v127
v_mfma_f32_16x16x32_bf16 v[92:95], a[160:163], v[24:27], v[220:223]
ds_read_b128 a[184:187], v3 offset:2048
v_cvt_pk_bf16_f32 v171, v126, v127
v_mfma_f32_16x16x32_bf16 v[100:103], a[160:163], v[40:43], v[188:191]
v_exp_f32 v128, v128
v_mfma_f32_16x16x32_bf16 v[108:111], a[160:163], v[56:59], v[192:195]
buffer_load_dwordx4 v16, s[32:35], s70 offen offset:3072 sc1 lds
v_mfma_f32_16x16x32_bf16 v[116:119], a[160:163], v[72:75], v[196:199]
s_waitcnt lgkmcnt(5)
v_exp_f32 v129, v129
v_mfma_f32_16x16x32_bf16 v[92:95], a[164:167], v[28:31], v[92:95]
ds_read_b128 a[188:191], v3 offset:3072
v_cvt_pk_bf16_f32 v172, v128, v129
v_mfma_f32_16x16x32_bf16 v[100:103], a[164:167], v[44:47], v[100:103]
v_exp_f32 v130, v130
v_mfma_f32_16x16x32_bf16 v[108:111], a[164:167], v[60:63], v[108:111]
v_mfma_f32_16x16x32_bf16 v[116:119], a[164:167], v[76:79], v[116:119]
s_waitcnt lgkmcnt(5)
v_exp_f32 v131, v131
v_mfma_f32_16x16x32_bf16 v[92:95], a[168:171], v[32:35], v[92:95]
s_add_u32 m0, s71, 4096
ds_read_b128 a[192:195], v3 offset:4096
v_cvt_pk_bf16_f32 v173, v130, v131
v_mfma_f32_16x16x32_bf16 v[100:103], a[168:171], v[48:51], v[100:103]
v_exp_f32 v132, v132
v_mfma_f32_16x16x32_bf16 v[108:111], a[168:171], v[64:67], v[108:111]
s_add_u32 s64, s70, 4096
v_add_f32 v216, v184, v208
v_add_f32 v217, v184, v209
v_mfma_f32_16x16x32_bf16 v[116:119], a[168:171], v[80:83], v[116:119]
s_waitcnt lgkmcnt(5)
v_exp_f32 v133, v133
v_mfma_f32_16x16x32_bf16 v[92:95], a[172:175], v[36:39], v[92:95]
ds_read_b128 a[196:199], v3 offset:5120
v_cvt_pk_bf16_f32 v174, v132, v133
v_mfma_f32_16x16x32_bf16 v[100:103], a[172:175], v[52:55], v[100:103]
v_exp_f32 v134, v134
v_mfma_f32_16x16x32_bf16 v[108:111], a[172:175], v[68:71], v[108:111]
buffer_load_dwordx4 v16, s[32:35], s64 offen offset:0 sc1 lds
v_mfma_f32_16x16x32_bf16 v[116:119], a[172:175], v[84:87], v[116:119]
s_waitcnt lgkmcnt(5)
v_exp_f32 v135, v135
v_mfma_f32_16x16x32_bf16 a[0:3], a[176:179], v[152:155], a[0:3]
ds_read_b128 a[200:203], v3 offset:6144
v_cvt_pk_bf16_f32 v175, v134, v135
v_mfma_f32_16x16x32_bf16 a[32:35], a[176:179], v[156:159], a[32:35]
v_exp_f32 v136, v136
v_mfma_f32_16x16x32_bf16 a[64:67], a[176:179], v[160:163], a[64:67]
v_add_f32 v218, v184, v210
v_add_f32 v219, v184, v211
v_mfma_f32_16x16x32_bf16 a[96:99], a[176:179], v[164:167], a[96:99]
s_waitcnt lgkmcnt(5)
v_exp_f32 v137, v137
v_mfma_f32_16x16x32_bf16 a[4:7], a[180:183], v[152:155], a[4:7]
ds_read_b128 a[204:207], v3 offset:7168
v_cvt_pk_bf16_f32 v176, v136, v137
v_mfma_f32_16x16x32_bf16 a[36:39], a[180:183], v[156:159], a[36:39]
v_exp_f32 v138, v138
v_mfma_f32_16x16x32_bf16 a[68:71], a[180:183], v[160:163], a[68:71]
v_add_f32 v220, v184, v212
v_add_f32 v221, v184, v213
v_mfma_f32_16x16x32_bf16 a[100:103], a[180:183], v[164:167], a[100:103]
s_waitcnt lgkmcnt(5)
v_exp_f32 v139, v139
v_mfma_f32_16x16x32_bf16 a[8:11], a[184:187], v[152:155], a[8:11]
ds_read_b128 a[144:147], v2 offset:8192
v_cvt_pk_bf16_f32 v177, v138, v139
v_mfma_f32_16x16x32_bf16 a[40:43], a[184:187], v[156:159], a[40:43]
v_exp_f32 v140, v140
v_mfma_f32_16x16x32_bf16 a[72:75], a[184:187], v[160:163], a[72:75]
buffer_load_dwordx4 v16, s[32:35], s64 offen offset:1024 sc1 lds
v_mfma_f32_16x16x32_bf16 a[104:107], a[184:187], v[164:167], a[104:107]
s_waitcnt lgkmcnt(5)
v_exp_f32 v141, v141
v_mfma_f32_16x16x32_bf16 a[12:15], a[188:191], v[152:155], a[12:15]
ds_read_b128 a[148:151], v2 offset:9216
v_cvt_pk_bf16_f32 v178, v140, v141
v_mfma_f32_16x16x32_bf16 a[44:47], a[188:191], v[156:159], a[44:47]
v_exp_f32 v142, v142
v_mfma_f32_16x16x32_bf16 a[76:79], a[188:191], v[160:163], a[76:79]
v_add_f32 v222, v184, v214
v_add_f32 v223, v184, v215
v_mfma_f32_16x16x32_bf16 a[108:111], a[188:191], v[164:167], a[108:111]
s_waitcnt lgkmcnt(5)
v_exp_f32 v143, v143
v_mfma_f32_16x16x32_bf16 a[16:19], a[192:195], v[152:155], a[16:19]
ds_read_b128 a[152:155], v2 offset:10240
v_cvt_pk_bf16_f32 v179, v142, v143
v_mfma_f32_16x16x32_bf16 a[48:51], a[192:195], v[156:159], a[48:51]
v_exp_f32 v144, v144
v_mfma_f32_16x16x32_bf16 a[80:83], a[192:195], v[160:163], a[80:83]
v_mfma_f32_16x16x32_bf16 a[112:115], a[192:195], v[164:167], a[112:115]
s_waitcnt lgkmcnt(5)
v_exp_f32 v145, v145
v_mfma_f32_16x16x32_bf16 a[20:23], a[196:199], v[152:155], a[20:23]
ds_read_b128 a[156:159], v2 offset:11264
v_cvt_pk_bf16_f32 v180, v144, v145
v_mfma_f32_16x16x32_bf16 a[52:55], a[196:199], v[156:159], a[52:55]
v_exp_f32 v146, v146
v_mfma_f32_16x16x32_bf16 a[84:87], a[196:199], v[160:163], a[84:87]
v_mfma_f32_16x16x32_bf16 a[116:119], a[196:199], v[164:167], a[116:119]
s_waitcnt lgkmcnt(5)
v_exp_f32 v147, v147
v_mfma_f32_16x16x32_bf16 a[24:27], a[200:203], v[152:155], a[24:27]
ds_read_b128 a[160:163], v2 offset:12288
v_cvt_pk_bf16_f32 v181, v146, v147
v_mfma_f32_16x16x32_bf16 a[56:59], a[200:203], v[156:159], a[56:59]
v_exp_f32 v148, v148
v_mfma_f32_16x16x32_bf16 a[88:91], a[200:203], v[160:163], a[88:91]
buffer_load_dwordx4 v16, s[32:35], s64 offen offset:2048 sc1 lds
v_mfma_f32_16x16x32_bf16 a[120:123], a[200:203], v[164:167], a[120:123]
s_waitcnt lgkmcnt(5)
v_exp_f32 v149, v149
v_mfma_f32_16x16x32_bf16 a[28:31], a[204:207], v[152:155], a[28:31]
ds_read_b128 a[164:167], v2 offset:13312
v_cvt_pk_bf16_f32 v182, v148, v149
v_mfma_f32_16x16x32_bf16 a[60:63], a[204:207], v[156:159], a[60:63]
v_exp_f32 v150, v150
v_mfma_f32_16x16x32_bf16 a[92:95], a[204:207], v[160:163], a[92:95]
v_mfma_f32_16x16x32_bf16 a[124:127], a[204:207], v[164:167], a[124:127]
v_exp_f32 v151, v151
v_mfma_f32_16x16x32_bf16 a[128:131], v[12:15], v[152:155], a[128:131]
v_cvt_pk_bf16_f32 v183, v150, v151
v_mfma_f32_16x16x32_bf16 a[132:135], v[12:15], v[156:159], a[132:135]
v_mfma_f32_16x16x32_bf16 a[136:139], v[12:15], v[160:163], a[136:139]
v_mfma_f32_16x16x32_bf16 a[140:143], v[12:15], v[164:167], a[140:143]
s_waitcnt lgkmcnt(5)
v_mfma_f32_16x16x32_bf16 v[120:123], a[144:147], v[24:27], v[216:219]
ds_read_b128 a[168:171], v2 offset:14336
v_mfma_f32_16x16x32_bf16 v[128:131], a[144:147], v[40:43], v[188:191]
v_exp_f32 v88, v88
v_mfma_f32_16x16x32_bf16 v[136:139], a[144:147], v[56:59], v[192:195]
v_mfma_f32_16x16x32_bf16 v[144:147], a[144:147], v[72:75], v[196:199]
s_waitcnt lgkmcnt(5)
v_exp_f32 v89, v89
v_mfma_f32_16x16x32_bf16 v[120:123], a[148:151], v[28:31], v[120:123]
ds_read_b128 a[172:175], v2 offset:15360
v_cvt_pk_bf16_f32 v152, v88, v89
v_mfma_f32_16x16x32_bf16 v[128:131], a[148:151], v[44:47], v[128:131]
v_exp_f32 v90, v90
v_mfma_f32_16x16x32_bf16 v[136:139], a[148:151], v[60:63], v[136:139]
v_mfma_f32_16x16x32_bf16 v[144:147], a[148:151], v[76:79], v[144:147]
s_waitcnt lgkmcnt(5)
v_exp_f32 v91, v91
v_mfma_f32_16x16x32_bf16 v[120:123], a[152:155], v[32:35], v[120:123]
ds_read_b128 a[176:179], v3 offset:8192
v_cvt_pk_bf16_f32 v153, v90, v91
v_mfma_f32_16x16x32_bf16 v[128:131], a[152:155], v[48:51], v[128:131]
v_exp_f32 v92, v92
v_mfma_f32_16x16x32_bf16 v[136:139], a[152:155], v[64:67], v[136:139]
v_mfma_f32_16x16x32_bf16 v[144:147], a[152:155], v[80:83], v[144:147]
s_waitcnt lgkmcnt(5)
v_exp_f32 v93, v93
v_mfma_f32_16x16x32_bf16 v[120:123], a[156:159], v[36:39], v[120:123]
ds_read_b128 a[180:183], v3 offset:9216
v_cvt_pk_bf16_f32 v154, v92, v93
v_mfma_f32_16x16x32_bf16 v[128:131], a[156:159], v[52:55], v[128:131]
v_exp_f32 v94, v94
v_mfma_f32_16x16x32_bf16 v[136:139], a[156:159], v[68:71], v[136:139]
buffer_load_dwordx4 v16, s[32:35], s64 offen offset:3072 sc1 lds
v_mfma_f32_16x16x32_bf16 v[144:147], a[156:159], v[84:87], v[144:147]
s_waitcnt lgkmcnt(5)
v_exp_f32 v95, v95
v_mfma_f32_16x16x32_bf16 v[124:127], a[160:163], v[24:27], v[220:223]
ds_read_b128 a[184:187], v3 offset:10240
v_cvt_pk_bf16_f32 v155, v94, v95
v_mfma_f32_16x16x32_bf16 v[132:135], a[160:163], v[40:43], v[188:191]
v_exp_f32 v96, v96
v_mfma_f32_16x16x32_bf16 v[140:143], a[160:163], v[56:59], v[192:195]
v_mfma_f32_16x16x32_bf16 v[148:151], a[160:163], v[72:75], v[196:199]
s_waitcnt lgkmcnt(5)
v_exp_f32 v97, v97
v_mfma_f32_16x16x32_bf16 v[124:127], a[164:167], v[28:31], v[124:127]
ds_read_b128 a[188:191], v3 offset:11264
v_cvt_pk_bf16_f32 v156, v96, v97
v_mfma_f32_16x16x32_bf16 v[132:135], a[164:167], v[44:47], v[132:135]
v_exp_f32 v98, v98
v_mfma_f32_16x16x32_bf16 v[140:143], a[164:167], v[60:63], v[140:143]
v_mfma_f32_16x16x32_bf16 v[148:151], a[164:167], v[76:79], v[148:151]
s_waitcnt lgkmcnt(5)
v_exp_f32 v99, v99
v_mfma_f32_16x16x32_bf16 v[124:127], a[168:171], v[32:35], v[124:127]
s_xor_b32 s71, s71, 16384
ds_read_b128 a[192:195], v3 offset:12288
v_cvt_pk_bf16_f32 v157, v98, v99
v_mfma_f32_16x16x32_bf16 v[132:135], a[168:171], v[48:51], v[132:135]
v_exp_f32 v100, v100
v_mfma_f32_16x16x32_bf16 v[140:143], a[168:171], v[64:67], v[140:143]
v_add_f32 v216, v188, v200
v_add_f32 v217, v188, v201
v_mfma_f32_16x16x32_bf16 v[148:151], a[168:171], v[80:83], v[148:151]
s_waitcnt lgkmcnt(5)
v_exp_f32 v101, v101
v_mfma_f32_16x16x32_bf16 v[124:127], a[172:175], v[36:39], v[124:127]
ds_read_b128 a[196:199], v3 offset:13312
v_cvt_pk_bf16_f32 v158, v100, v101
v_mfma_f32_16x16x32_bf16 v[132:135], a[172:175], v[52:55], v[132:135]
v_exp_f32 v102, v102
v_mfma_f32_16x16x32_bf16 v[140:143], a[172:175], v[68:71], v[140:143]
v_add_f32 v218, v188, v202
v_add_f32 v219, v188, v203
v_mfma_f32_16x16x32_bf16 v[148:151], a[172:175], v[84:87], v[148:151]
s_waitcnt lgkmcnt(5)
v_exp_f32 v103, v103
v_mfma_f32_16x16x32_bf16 a[0:3], a[176:179], v[168:171], a[0:3]
s_add_u32 s70, s70, 32768
ds_read_b128 a[200:203], v3 offset:14336
v_cvt_pk_bf16_f32 v159, v102, v103
v_mfma_f32_16x16x32_bf16 a[32:35], a[176:179], v[172:175], a[32:35]
v_exp_f32 v104, v104
v_mfma_f32_16x16x32_bf16 a[64:67], a[176:179], v[176:179], a[64:67]
v_add_f32 v220, v188, v204
v_add_f32 v221, v188, v205
v_mfma_f32_16x16x32_bf16 a[96:99], a[176:179], v[180:183], a[96:99]
s_waitcnt lgkmcnt(5)
v_exp_f32 v105, v105
v_mfma_f32_16x16x32_bf16 a[4:7], a[180:183], v[168:171], a[4:7]
ds_read_b128 a[204:207], v3 offset:15360
v_cvt_pk_bf16_f32 v160, v104, v105
v_mfma_f32_16x16x32_bf16 a[36:39], a[180:183], v[172:175], a[36:39]
v_exp_f32 v106, v106
v_mfma_f32_16x16x32_bf16 a[68:71], a[180:183], v[176:179], a[68:71]
s_waitcnt vmcnt(8)
s_barrier
v_mfma_f32_16x16x32_bf16 a[100:103], a[180:183], v[180:183], a[100:103]
s_waitcnt lgkmcnt(5)
v_exp_f32 v107, v107
v_mfma_f32_16x16x32_bf16 a[8:11], a[184:187], v[168:171], a[8:11]
s_mov_b32 m0, s71
ds_read_b128 a[144:147], v2 offset:16384
v_cvt_pk_bf16_f32 v161, v106, v107
v_mfma_f32_16x16x32_bf16 a[40:43], a[184:187], v[172:175], a[40:43]
v_exp_f32 v108, v108
v_mfma_f32_16x16x32_bf16 a[72:75], a[184:187], v[176:179], a[72:75]
v_add_f32 v222, v188, v206
v_add_f32 v223, v188, v207
v_mfma_f32_16x16x32_bf16 a[104:107], a[184:187], v[180:183], a[104:107]
s_waitcnt lgkmcnt(5)
v_exp_f32 v109, v109
v_mfma_f32_16x16x32_bf16 a[12:15], a[188:191], v[168:171], a[12:15]
ds_read_b128 a[148:151], v2 offset:17408
v_cvt_pk_bf16_f32 v162, v108, v109
v_mfma_f32_16x16x32_bf16 a[44:47], a[188:191], v[172:175], a[44:47]
v_exp_f32 v110, v110
v_mfma_f32_16x16x32_bf16 a[76:79], a[188:191], v[176:179], a[76:79]
buffer_load_dwordx4 v16, s[32:35], s70 offen offset:0 sc1 lds
v_mfma_f32_16x16x32_bf16 a[108:111], a[188:191], v[180:183], a[108:111]
s_waitcnt lgkmcnt(5)
v_exp_f32 v111, v111
v_mfma_f32_16x16x32_bf16 a[16:19], a[192:195], v[168:171], a[16:19]
ds_read_b128 a[152:155], v2 offset:18432
v_cvt_pk_bf16_f32 v163, v110, v111
v_mfma_f32_16x16x32_bf16 a[48:51], a[192:195], v[172:175], a[48:51]
v_exp_f32 v112, v112
v_mfma_f32_16x16x32_bf16 a[80:83], a[192:195], v[176:179], a[80:83]
v_mfma_f32_16x16x32_bf16 a[112:115], a[192:195], v[180:183], a[112:115]
s_waitcnt lgkmcnt(5)
v_exp_f32 v113, v113
v_mfma_f32_16x16x32_bf16 a[20:23], a[196:199], v[168:171], a[20:23]
ds_read_b128 a[156:159], v2 offset:19456
v_cvt_pk_bf16_f32 v164, v112, v113
v_mfma_f32_16x16x32_bf16 a[52:55], a[196:199], v[172:175], a[52:55]
v_exp_f32 v114, v114
v_mfma_f32_16x16x32_bf16 a[84:87], a[196:199], v[176:179], a[84:87]
v_mfma_f32_16x16x32_bf16 a[116:119], a[196:199], v[180:183], a[116:119]
s_waitcnt lgkmcnt(5)
v_exp_f32 v115, v115
v_mfma_f32_16x16x32_bf16 a[24:27], a[200:203], v[168:171], a[24:27]
ds_read_b128 a[160:163], v2 offset:20480
v_cvt_pk_bf16_f32 v165, v114, v115
v_mfma_f32_16x16x32_bf16 a[56:59], a[200:203], v[172:175], a[56:59]
v_exp_f32 v116, v116
v_mfma_f32_16x16x32_bf16 a[88:91], a[200:203], v[176:179], a[88:91]
buffer_load_dwordx4 v16, s[32:35], s70 offen offset:1024 sc1 lds
v_mfma_f32_16x16x32_bf16 a[120:123], a[200:203], v[180:183], a[120:123]
s_waitcnt lgkmcnt(5)
v_exp_f32 v117, v117
v_mfma_f32_16x16x32_bf16 a[28:31], a[204:207], v[168:171], a[28:31]
ds_read_b128 a[164:167], v2 offset:21504
v_cvt_pk_bf16_f32 v166, v116, v117
v_mfma_f32_16x16x32_bf16 a[60:63], a[204:207], v[172:175], a[60:63]
v_exp_f32 v118, v118
v_mfma_f32_16x16x32_bf16 a[92:95], a[204:207], v[176:179], a[92:95]
v_mfma_f32_16x16x32_bf16 a[124:127], a[204:207], v[180:183], a[124:127]
v_exp_f32 v119, v119
v_mfma_f32_16x16x32_bf16 a[128:131], v[12:15], v[168:171], a[128:131]
v_cvt_pk_bf16_f32 v167, v118, v119
v_mfma_f32_16x16x32_bf16 a[132:135], v[12:15], v[172:175], a[132:135]
v_mfma_f32_16x16x32_bf16 a[136:139], v[12:15], v[176:179], a[136:139]
v_mfma_f32_16x16x32_bf16 a[140:143], v[12:15], v[180:183], a[140:143]
s_waitcnt lgkmcnt(5)
v_mfma_f32_16x16x32_bf16 v[96:99], a[144:147], v[40:43], v[216:219]
v_exp_f32 v120, v120
v_mfma_f32_16x16x32_bf16 v[104:107], a[144:147], v[56:59], v[192:195]
ds_read_b128 a[168:171], v2 offset:22528
v_mfma_f32_16x16x32_bf16 v[112:115], a[144:147], v[72:75], v[196:199]
s_waitcnt lgkmcnt(5)
v_exp_f32 v121, v121
v_mfma_f32_16x16x32_bf16 v[96:99], a[148:151], v[44:47], v[96:99]
buffer_load_dwordx4 v16, s[32:35], s70 offen offset:2048 sc1 lds
v_mfma_f32_16x16x32_bf16 v[104:107], a[148:151], v[60:63], v[104:107]
v_exp_f32 v122, v122
v_mfma_f32_16x16x32_bf16 v[112:115], a[148:151], v[76:79], v[112:115]
s_waitcnt lgkmcnt(4)
ds_read_b128 a[172:175], v2 offset:23552
v_cvt_pk_bf16_f32 v168, v120, v121
v_mfma_f32_16x16x32_bf16 v[96:99], a[152:155], v[48:51], v[96:99]
v_exp_f32 v123, v123
v_mfma_f32_16x16x32_bf16 v[104:107], a[152:155], v[64:67], v[104:107]
v_exp_f32 v124, v124
v_mfma_f32_16x16x32_bf16 v[112:115], a[152:155], v[80:83], v[112:115]
s_waitcnt lgkmcnt(4)
ds_read_b128 a[176:179], v3 offset:16384
v_cvt_pk_bf16_f32 v169, v122, v123
v_mfma_f32_16x16x32_bf16 v[96:99], a[156:159], v[52:55], v[96:99]
v_exp_f32 v125, v125
v_mfma_f32_16x16x32_bf16 v[104:107], a[156:159], v[68:71], v[104:107]
v_exp_f32 v126, v126
v_mfma_f32_16x16x32_bf16 v[112:115], a[156:159], v[84:87], v[112:115]
s_waitcnt lgkmcnt(4)
ds_read_b128 a[180:183], v3 offset:17408
v_cvt_pk_bf16_f32 v170, v124, v125
v_mfma_f32_16x16x32_bf16 v[100:103], a[160:163], v[40:43], v[220:223]
v_exp_f32 v127, v127
v_mfma_f32_16x16x32_bf16 v[108:111], a[160:163], v[56:59], v[192:195]
ds_read_b128 a[184:187], v3 offset:18432
v_cvt_pk_bf16_f32 v171, v126, v127
v_mfma_f32_16x16x32_bf16 v[116:119], a[160:163], v[72:75], v[196:199]
s_waitcnt lgkmcnt(5)
v_exp_f32 v128, v128
v_mfma_f32_16x16x32_bf16 v[100:103], a[164:167], v[44:47], v[100:103]
buffer_load_dwordx4 v16, s[32:35], s70 offen offset:3072 sc1 lds
v_mfma_f32_16x16x32_bf16 v[108:111], a[164:167], v[60:63], v[108:111]
v_exp_f32 v129, v129
v_mfma_f32_16x16x32_bf16 v[116:119], a[164:167], v[76:79], v[116:119]
s_waitcnt lgkmcnt(4)
ds_read_b128 a[188:191], v3 offset:19456
v_cvt_pk_bf16_f32 v172, v128, v129
v_mfma_f32_16x16x32_bf16 v[100:103], a[168:171], v[48:51], v[100:103]
v_exp_f32 v130, v130
v_mfma_f32_16x16x32_bf16 v[108:111], a[168:171], v[64:67], v[108:111]
v_exp_f32 v131, v131
v_mfma_f32_16x16x32_bf16 v[116:119], a[168:171], v[80:83], v[116:119]
s_waitcnt lgkmcnt(4)
ds_read_b128 a[192:195], v3 offset:20480
v_add_f32 v216, v188, v208
v_mfma_f32_16x16x32_bf16 v[100:103], a[172:175], v[52:55], v[100:103]
v_exp_f32 v132, v132
v_mfma_f32_16x16x32_bf16 v[108:111], a[172:175], v[68:71], v[108:111]
ds_read_b128 a[196:199], v3 offset:21504
v_add_f32 v217, v188, v209
v_mfma_f32_16x16x32_bf16 v[116:119], a[172:175], v[84:87], v[116:119]
s_waitcnt lgkmcnt(5)
s_add_u32 m0, s71, 4096
v_exp_f32 v133, v133
v_mfma_f32_16x16x32_bf16 a[0:3], a[176:179], v[152:155], a[0:3]
s_add_u32 s64, s70, 4096
v_exp_f32 v134, v134
v_mfma_f32_16x16x32_bf16 a[32:35], a[176:179], v[156:159], a[32:35]
ds_read_b128 a[200:203], v3 offset:22528
v_add_f32 v218, v188, v210
v_mfma_f32_16x16x32_bf16 a[64:67], a[176:179], v[160:163], a[64:67]
buffer_load_dwordx4 v16, s[32:35], s64 offen offset:0 sc1 lds
v_mfma_f32_16x16x32_bf16 a[96:99], a[176:179], v[164:167], a[96:99]
s_waitcnt lgkmcnt(5)
v_exp_f32 v135, v135
v_mfma_f32_16x16x32_bf16 a[4:7], a[180:183], v[152:155], a[4:7]
v_exp_f32 v136, v136
v_mfma_f32_16x16x32_bf16 a[36:39], a[180:183], v[156:159], a[36:39]
ds_read_b128 a[204:207], v3 offset:23552
v_add_f32 v219, v188, v211
v_mfma_f32_16x16x32_bf16 a[68:71], a[180:183], v[160:163], a[68:71]
v_exp_f32 v137, v137
v_mfma_f32_16x16x32_bf16 a[100:103], a[180:183], v[164:167], a[100:103]
s_waitcnt lgkmcnt(5)
v_exp_f32 v138, v138
v_mfma_f32_16x16x32_bf16 a[8:11], a[184:187], v[152:155], a[8:11]
ds_read_b128 a[144:147], v2 offset:24576
v_add_f32 v220, v188, v212
v_mfma_f32_16x16x32_bf16 a[40:43], a[184:187], v[156:159], a[40:43]
v_exp_f32 v139, v139
v_mfma_f32_16x16x32_bf16 a[72:75], a[184:187], v[160:163], a[72:75]
v_exp_f32 v140, v140
v_mfma_f32_16x16x32_bf16 a[104:107], a[184:187], v[164:167], a[104:107]
s_waitcnt lgkmcnt(5)
v_exp_f32 v141, v141
v_mfma_f32_16x16x32_bf16 a[12:15], a[188:191], v[152:155], a[12:15]
ds_read_b128 a[148:151], v2 offset:25600
v_add_f32 v221, v188, v213
v_mfma_f32_16x16x32_bf16 a[44:47], a[188:191], v[156:159], a[44:47]
buffer_load_dwordx4 v16, s[32:35], s64 offen offset:1024 sc1 lds
v_mfma_f32_16x16x32_bf16 a[76:79], a[188:191], v[160:163], a[76:79]
v_exp_f32 v142, v142
v_mfma_f32_16x16x32_bf16 a[108:111], a[188:191], v[164:167], a[108:111]
s_waitcnt lgkmcnt(5)
v_exp_f32 v143, v143
v_mfma_f32_16x16x32_bf16 a[16:19], a[192:195], v[152:155], a[16:19]
ds_read_b128 a[152:155], v2 offset:26624
v_add_f32 v222, v188, v214
v_mfma_f32_16x16x32_bf16 a[48:51], a[192:195], v[156:159], a[48:51]
v_exp_f32 v144, v144
v_mfma_f32_16x16x32_bf16 a[80:83], a[192:195], v[160:163], a[80:83]
v_exp_f32 v145, v145
v_mfma_f32_16x16x32_bf16 a[112:115], a[192:195], v[164:167], a[112:115]
s_waitcnt lgkmcnt(5)
v_exp_f32 v146, v146
v_mfma_f32_16x16x32_bf16 a[20:23], a[196:199], v[152:155], a[20:23]
ds_read_b128 a[156:159], v2 offset:27648
v_add_f32 v223, v188, v215
v_mfma_f32_16x16x32_bf16 a[52:55], a[196:199], v[156:159], a[52:55]
v_exp_f32 v147, v147
v_mfma_f32_16x16x32_bf16 a[84:87], a[196:199], v[160:163], a[84:87]
v_exp_f32 v148, v148
v_mfma_f32_16x16x32_bf16 a[116:119], a[196:199], v[164:167], a[116:119]
s_waitcnt lgkmcnt(5)
v_exp_f32 v149, v149
v_mfma_f32_16x16x32_bf16 a[24:27], a[200:203], v[152:155], a[24:27]
ds_read_b128 a[160:163], v2 offset:28672
v_cvt_pk_bf16_f32 v173, v130, v131
v_mfma_f32_16x16x32_bf16 a[56:59], a[200:203], v[156:159], a[56:59]
buffer_load_dwordx4 v16, s[32:35], s64 offen offset:2048 sc1 lds
v_mfma_f32_16x16x32_bf16 a[88:91], a[200:203], v[160:163], a[88:91]
v_exp_f32 v150, v150
v_mfma_f32_16x16x32_bf16 a[120:123], a[200:203], v[164:167], a[120:123]
s_waitcnt lgkmcnt(5)
v_exp_f32 v151, v151
v_mfma_f32_16x16x32_bf16 a[28:31], a[204:207], v[152:155], a[28:31]
ds_read_b128 a[164:167], v2 offset:29696
v_cvt_pk_bf16_f32 v174, v132, v133
v_mfma_f32_16x16x32_bf16 a[60:63], a[204:207], v[156:159], a[60:63]
v_cvt_pk_bf16_f32 v175, v134, v135
v_cvt_pk_bf16_f32 v176, v136, v137
v_mfma_f32_16x16x32_bf16 a[92:95], a[204:207], v[160:163], a[92:95]
v_cvt_pk_bf16_f32 v177, v138, v139
v_cvt_pk_bf16_f32 v178, v140, v141
v_mfma_f32_16x16x32_bf16 a[124:127], a[204:207], v[164:167], a[124:127]
v_cvt_pk_bf16_f32 v179, v142, v143
v_cvt_pk_bf16_f32 v180, v144, v145
v_mfma_f32_16x16x32_bf16 a[128:131], v[12:15], v[152:155], a[128:131]
v_cvt_pk_bf16_f32 v181, v146, v147
v_cvt_pk_bf16_f32 v182, v148, v149
v_mfma_f32_16x16x32_bf16 a[132:135], v[12:15], v[156:159], a[132:135]
v_cvt_pk_bf16_f32 v183, v150, v151
v_mfma_f32_16x16x32_bf16 a[136:139], v[12:15], v[160:163], a[136:139]
v_mfma_f32_16x16x32_bf16 a[140:143], v[12:15], v[164:167], a[140:143]
s_waitcnt lgkmcnt(5)
v_mfma_f32_16x16x32_bf16 v[128:131], a[144:147], v[40:43], v[216:219]
v_exp_f32 v96, v96
v_mfma_f32_16x16x32_bf16 v[136:139], a[144:147], v[56:59], v[192:195]
ds_read_b128 a[168:171], v2 offset:30720
v_mfma_f32_16x16x32_bf16 v[144:147], a[144:147], v[72:75], v[196:199]
s_waitcnt lgkmcnt(5)
v_exp_f32 v97, v97
v_mfma_f32_16x16x32_bf16 v[128:131], a[148:151], v[44:47], v[128:131]
ds_read_b128 a[172:175], v2 offset:31744
v_cvt_pk_bf16_f32 v156, v96, v97
v_mfma_f32_16x16x32_bf16 v[136:139], a[148:151], v[60:63], v[136:139]
v_exp_f32 v98, v98
v_mfma_f32_16x16x32_bf16 v[144:147], a[148:151], v[76:79], v[144:147]
s_waitcnt lgkmcnt(5)
v_exp_f32 v99, v99
v_mfma_f32_16x16x32_bf16 v[128:131], a[152:155], v[48:51], v[128:131]
ds_read_b128 a[176:179], v3 offset:24576
v_cvt_pk_bf16_f32 v157, v98, v99
v_mfma_f32_16x16x32_bf16 v[136:139], a[152:155], v[64:67], v[136:139]
v_exp_f32 v100, v100
v_mfma_f32_16x16x32_bf16 v[144:147], a[152:155], v[80:83], v[144:147]
s_waitcnt lgkmcnt(5)
v_exp_f32 v101, v101
v_mfma_f32_16x16x32_bf16 v[128:131], a[156:159], v[52:55], v[128:131]
ds_read_b128 a[180:183], v3 offset:25600
v_xor_b32 v2, 0x8000, v2
v_mfma_f32_16x16x32_bf16 v[136:139], a[156:159], v[68:71], v[136:139]
v_exp_f32 v102, v102
v_mfma_f32_16x16x32_bf16 v[144:147], a[156:159], v[84:87], v[144:147]
s_waitcnt lgkmcnt(5)
v_exp_f32 v103, v103
v_mfma_f32_16x16x32_bf16 v[132:135], a[160:163], v[40:43], v[220:223]
ds_read_b128 a[184:187], v3 offset:26624
v_cvt_pk_bf16_f32 v158, v100, v101
v_mfma_f32_16x16x32_bf16 v[140:143], a[160:163], v[56:59], v[192:195]
v_exp_f32 v104, v104
v_mfma_f32_16x16x32_bf16 v[148:151], a[160:163], v[72:75], v[196:199]
s_waitcnt lgkmcnt(5)
v_exp_f32 v105, v105
v_mfma_f32_16x16x32_bf16 v[132:135], a[164:167], v[44:47], v[132:135]
ds_read_b128 a[188:191], v3 offset:27648
v_cvt_pk_bf16_f32 v159, v102, v103
v_mfma_f32_16x16x32_bf16 v[140:143], a[164:167], v[60:63], v[140:143]
buffer_load_dwordx4 v16, s[32:35], s64 offen offset:3072 sc1 lds
v_mfma_f32_16x16x32_bf16 v[148:151], a[164:167], v[76:79], v[148:151]
s_waitcnt lgkmcnt(5)
v_exp_f32 v106, v106
v_mfma_f32_16x16x32_bf16 v[132:135], a[168:171], v[48:51], v[132:135]
ds_read_b128 a[192:195], v3 offset:28672
v_cvt_pk_bf16_f32 v160, v104, v105
v_mfma_f32_16x16x32_bf16 v[140:143], a[168:171], v[64:67], v[140:143]
v_exp_f32 v107, v107
v_mfma_f32_16x16x32_bf16 v[148:151], a[168:171], v[80:83], v[148:151]
s_waitcnt lgkmcnt(5)
v_exp_f32 v108, v108
v_mfma_f32_16x16x32_bf16 v[132:135], a[172:175], v[52:55], v[132:135]
ds_read_b128 a[196:199], v3 offset:29696
v_cvt_pk_bf16_f32 v161, v106, v107
v_mfma_f32_16x16x32_bf16 v[140:143], a[172:175], v[68:71], v[140:143]
v_exp_f32 v109, v109
v_mfma_f32_16x16x32_bf16 v[148:151], a[172:175], v[84:87], v[148:151]
s_waitcnt lgkmcnt(5)
v_exp_f32 v110, v110
v_mfma_f32_16x16x32_bf16 a[0:3], a[176:179], v[168:171], a[0:3]
ds_read_b128 a[200:203], v3 offset:30720
v_cvt_pk_bf16_f32 v162, v108, v109
v_mfma_f32_16x16x32_bf16 a[32:35], a[176:179], v[172:175], a[32:35]
v_exp_f32 v111, v111
v_mfma_f32_16x16x32_bf16 a[64:67], a[176:179], v[176:179], a[64:67]
v_exp_f32 v112, v112
v_mfma_f32_16x16x32_bf16 a[96:99], a[176:179], v[180:183], a[96:99]
s_waitcnt lgkmcnt(5)
v_exp_f32 v113, v113
v_mfma_f32_16x16x32_bf16 a[4:7], a[180:183], v[168:171], a[4:7]
ds_read_b128 a[204:207], v3 offset:31744
v_cvt_pk_bf16_f32 v163, v110, v111
v_mfma_f32_16x16x32_bf16 a[36:39], a[180:183], v[172:175], a[36:39]
v_exp_f32 v114, v114
v_mfma_f32_16x16x32_bf16 a[68:71], a[180:183], v[176:179], a[68:71]
v_exp_f32 v115, v115
v_mfma_f32_16x16x32_bf16 a[100:103], a[180:183], v[180:183], a[100:103]
s_waitcnt vmcnt(8)
s_barrier
s_waitcnt lgkmcnt(5)
v_mfma_f32_16x16x32_bf16 a[8:11], a[184:187], v[168:171], a[8:11]
ds_read_b128 a[144:147], v2 offset:0
v_cvt_pk_bf16_f32 v164, v112, v113
v_mfma_f32_16x16x32_bf16 a[40:43], a[184:187], v[172:175], a[40:43]
v_exp_f32 v116, v116
v_mfma_f32_16x16x32_bf16 a[72:75], a[184:187], v[176:179], a[72:75]
v_exp_f32 v117, v117
v_mfma_f32_16x16x32_bf16 a[104:107], a[184:187], v[180:183], a[104:107]
s_waitcnt lgkmcnt(5)
v_exp_f32 v118, v118
v_mfma_f32_16x16x32_bf16 a[12:15], a[188:191], v[168:171], a[12:15]
ds_read_b128 a[148:151], v2 offset:1024
v_cvt_pk_bf16_f32 v165, v114, v115
v_mfma_f32_16x16x32_bf16 a[44:47], a[188:191], v[172:175], a[44:47]
v_exp_f32 v119, v119
v_mfma_f32_16x16x32_bf16 a[76:79], a[188:191], v[176:179], a[76:79]
s_xor_b32 s71, s71, 49152
v_cvt_pk_bf16_f32 v166, v116, v117
v_cvt_pk_bf16_f32 v167, v118, v119
v_mfma_f32_16x16x32_bf16 a[108:111], a[188:191], v[180:183], a[108:111]
s_waitcnt lgkmcnt(5)
s_add_u32 s70, s70, 32768
v_xor_b32 v3, 0x8000, v3
v_mfma_f32_16x16x32_bf16 a[16:19], a[192:195], v[168:171], a[16:19]
s_mov_b32 m0, s71
ds_read_b128 a[152:155], v2 offset:2048
v_mfma_f32_16x16x32_bf16 a[48:51], a[192:195], v[172:175], a[48:51]
buffer_load_dwordx4 v16, s[32:35], s70 offen offset:0 sc1 lds
v_mfma_f32_16x16x32_bf16 a[80:83], a[192:195], v[176:179], a[80:83]
v_mfma_f32_16x16x32_bf16 a[112:115], a[192:195], v[180:183], a[112:115]
s_waitcnt lgkmcnt(5)
v_mfma_f32_16x16x32_bf16 a[20:23], a[196:199], v[168:171], a[20:23]
ds_read_b128 a[156:159], v2 offset:3072
v_mfma_f32_16x16x32_bf16 a[52:55], a[196:199], v[172:175], a[52:55]
v_mfma_f32_16x16x32_bf16 a[84:87], a[196:199], v[176:179], a[84:87]
v_mfma_f32_16x16x32_bf16 a[116:119], a[196:199], v[180:183], a[116:119]
s_waitcnt lgkmcnt(5)
v_mfma_f32_16x16x32_bf16 a[24:27], a[200:203], v[168:171], a[24:27]
ds_read_b128 a[160:163], v2 offset:4096
v_mfma_f32_16x16x32_bf16 a[56:59], a[200:203], v[172:175], a[56:59]
v_mfma_f32_16x16x32_bf16 a[88:91], a[200:203], v[176:179], a[88:91]
buffer_load_dwordx4 v16, s[32:35], s70 offen offset:1024 sc1 lds
v_mfma_f32_16x16x32_bf16 a[120:123], a[200:203], v[180:183], a[120:123]
s_waitcnt lgkmcnt(5)
v_mfma_f32_16x16x32_bf16 a[28:31], a[204:207], v[168:171], a[28:31]
ds_read_b128 a[164:167], v2 offset:5120
v_mfma_f32_16x16x32_bf16 a[60:63], a[204:207], v[172:175], a[60:63]
v_mfma_f32_16x16x32_bf16 a[92:95], a[204:207], v[176:179], a[92:95]
v_mfma_f32_16x16x32_bf16 a[124:127], a[204:207], v[180:183], a[124:127]
v_mfma_f32_16x16x32_bf16 a[128:131], v[12:15], v[168:171], a[128:131]
v_mfma_f32_16x16x32_bf16 a[132:135], v[12:15], v[172:175], a[132:135]
v_mfma_f32_16x16x32_bf16 a[136:139], v[12:15], v[176:179], a[136:139]
v_mfma_f32_16x16x32_bf16 a[140:143], v[12:15], v[180:183], a[140:143]
s_cmp_eq_u32 s3, 7
s_cbranch_scc1 L_T1_9
L_T_8:
s_waitcnt lgkmcnt(5)
v_mfma_f32_16x16x32_bf16 v[104:107], a[144:147], v[56:59], v[192:195]
v_exp_f32 v128, v128
v_mfma_f32_16x16x32_bf16 v[112:115], a[144:147], v[72:75], v[196:199]
s_waitcnt lgkmcnt(4)
ds_read_b128 a[168:171], v2 offset:6144
v_mfma_f32_16x16x32_bf16 v[104:107], a[148:151], v[60:63], v[104:107]
v_exp_f32 v129, v129
v_mfma_f32_16x16x32_bf16 v[112:115], a[148:151], v[76:79], v[112:115]
s_waitcnt lgkmcnt(4)
buffer_load_dwordx4 v16, s[32:35], s70 offen offset:2048 sc1 lds
v_mfma_f32_16x16x32_bf16 v[104:107], a[152:155], v[64:67], v[104:107]
v_exp_f32 v130, v130
v_mfma_f32_16x16x32_bf16 v[112:115], a[152:155], v[80:83], v[112:115]
s_waitcnt lgkmcnt(3)
ds_read_b128 a[172:175], v2 offset:7168
v_cvt_pk_bf16_f32 v172, v128, v129
v_mfma_f32_16x16x32_bf16 v[104:107], a[156:159], v[68:71], v[104:107]
v_exp_f32 v131, v131
v_mfma_f32_16x16x32_bf16 v[112:115], a[156:159], v[84:87], v[112:115]
s_waitcnt lgkmcnt(3)
ds_read_b128 a[176:179], v3 offset:0
v_cvt_pk_bf16_f32 v173, v130, v131
v_mfma_f32_16x16x32_bf16 v[108:111], a[160:163], v[56:59], v[192:195]
v_exp_f32 v132, v132
v_mfma_f32_16x16x32_bf16 v[116:119], a[160:163], v[72:75], v[196:199]
s_waitcnt lgkmcnt(3)
ds_read_b128 a[180:183], v3 offset:1024
v_mfma_f32_16x16x32_bf16 v[108:111], a[164:167], v[60:63], v[108:111]
v_exp_f32 v133, v133
v_mfma_f32_16x16x32_bf16 v[116:119], a[164:167], v[76:79], v[116:119]
s_waitcnt lgkmcnt(3)
ds_read_b128 a[184:187], v3 offset:2048
v_exp_f32 v134, v134
v_mfma_f32_16x16x32_bf16 v[108:111], a[168:171], v[64:67], v[108:111]
buffer_load_dwordx4 v16, s[32:35], s70 offen offset:3072 sc1 lds
v_mfma_f32_16x16x32_bf16 v[116:119], a[168:171], v[80:83], v[116:119]
s_waitcnt lgkmcnt(3)
ds_read_b128 a[188:191], v3 offset:3072
v_exp_f32 v135, v135
v_mfma_f32_16x16x32_bf16 v[108:111], a[172:175], v[68:71], v[108:111]
v_exp_f32 v136, v136
v_mfma_f32_16x16x32_bf16 v[116:119], a[172:175], v[84:87], v[116:119]
s_waitcnt lgkmcnt(3)
ds_read_b128 a[192:195], v3 offset:4096
v_cvt_pk_bf16_f32 v174, v132, v133
v_mfma_f32_16x16x32_bf16 a[32:35], a[176:179], v[156:159], a[32:35]
v_exp_f32 v137, v137
v_mfma_f32_16x16x32_bf16 a[64:67], a[176:179], v[160:163], a[64:67]
ds_read_b128 a[196:199], v3 offset:5120
v_cvt_pk_bf16_f32 v175, v134, v135
v_mfma_f32_16x16x32_bf16 a[96:99], a[176:179], v[164:167], a[96:99]
s_waitcnt lgkmcnt(4)
s_add_u32 m0, s71, 4096
v_exp_f32 v138, v138
v_mfma_f32_16x16x32_bf16 a[36:39], a[180:183], v[156:159], a[36:39]
ds_read_b128 a[200:203], v3 offset:6144
v_cvt_pk_bf16_f32 v176, v136, v137
v_mfma_f32_16x16x32_bf16 a[68:71], a[180:183], v[160:163], a[68:71]
s_add_u32 s64, s70, 4096
v_exp_f32 v139, v139
v_mfma_f32_16x16x32_bf16 a[100:103], a[180:183], v[164:167], a[100:103]
s_waitcnt lgkmcnt(4)
buffer_load_dwordx4 v16, s[32:35], s64 offen offset:0 sc1 lds
v_mfma_f32_16x16x32_bf16 a[40:43], a[184:187], v[156:159], a[40:43]
ds_read_b128 a[204:207], v3 offset:7168
v_exp_f32 v140, v140
v_mfma_f32_16x16x32_bf16 a[72:75], a[184:187], v[160:163], a[72:75]
v_exp_f32 v141, v141
v_mfma_f32_16x16x32_bf16 a[104:107], a[184:187], v[164:167], a[104:107]
s_waitcnt lgkmcnt(4)
v_exp_f32 v142, v142
v_mfma_f32_16x16x32_bf16 a[44:47], a[188:191], v[156:159], a[44:47]
ds_read_b128 a[144:147], v2 offset:8192
v_cvt_pk_bf16_f32 v177, v138, v139
v_mfma_f32_16x16x32_bf16 a[76:79], a[188:191], v[160:163], a[76:79]
v_exp_f32 v143, v143
v_mfma_f32_16x16x32_bf16 a[108:111], a[188:191], v[164:167], a[108:111]
s_waitcnt lgkmcnt(4)
ds_read_b128 a[148:151], v2 offset:9216
v_cvt_pk_bf16_f32 v178, v140, v141
v_mfma_f32_16x16x32_bf16 a[48:51], a[192:195], v[156:159], a[48:51]
v_exp_f32 v144, v144
v_mfma_f32_16x16x32_bf16 a[80:83], a[192:195], v[160:163], a[80:83]
buffer_load_dwordx4 v16, s[32:35], s64 offen offset:1024 sc1 lds
v_mfma_f32_16x16x32_bf16 a[112:115], a[192:195], v[164:167], a[112:115]
s_waitcnt lgkmcnt(4)
v_exp_f32 v145, v145
v_mfma_f32_16x16x32_bf16 a[52:55], a[196:199], v[156:159], a[52:55]
ds_read_b128 a[152:155], v2 offset:10240
v_cvt_pk_bf16_f32 v179, v142, v143
v_mfma_f32_16x16x32_bf16 a[84:87], a[196:199], v[160:163], a[84:87]
v_exp_f32 v146, v146
v_mfma_f32_16x16x32_bf16 a[116:119], a[196:199], v[164:167], a[116:119]
s_waitcnt lgkmcnt(4)
v_exp_f32 v147, v147
v_mfma_f32_16x16x32_bf16 a[56:59], a[200:203], v[156:159], a[56:59]
ds_read_b128 a[156:159], v2 offset:11264
v_cvt_pk_bf16_f32 v180, v144, v145
v_mfma_f32_16x16x32_bf16 a[88:91], a[200:203], v[160:163], a[88:91]
v_exp_f32 v148, v148
v_mfma_f32_16x16x32_bf16 a[120:123], a[200:203], v[164:167], a[120:123]
s_waitcnt lgkmcnt(4)
v_exp_f32 v149, v149
v_mfma_f32_16x16x32_bf16 a[60:63], a[204:207], v[156:159], a[60:63]
ds_read_b128 a[160:163], v2 offset:12288
v_cvt_pk_bf16_f32 v181, v146, v147
v_mfma_f32_16x16x32_bf16 a[92:95], a[204:207], v[160:163], a[92:95]
buffer_load_dwordx4 v16, s[32:35], s64 offen offset:2048 sc1 lds
v_mfma_f32_16x16x32_bf16 a[124:127], a[204:207], v[164:167], a[124:127]
v_exp_f32 v150, v150
v_mfma_f32_16x16x32_bf16 a[132:135], v[12:15], v[156:159], a[132:135]
ds_read_b128 a[164:167], v2 offset:13312
v_cvt_pk_bf16_f32 v182, v148, v149
v_mfma_f32_16x16x32_bf16 a[136:139], v[12:15], v[160:163], a[136:139]
v_exp_f32 v151, v151
v_mfma_f32_16x16x32_bf16 a[140:143], v[12:15], v[164:167], a[140:143]
s_waitcnt lgkmcnt(5)
v_cvt_pk_bf16_f32 v183, v150, v151
v_mfma_f32_16x16x32_bf16 v[136:139], a[144:147], v[56:59], v[192:195]
v_exp_f32 v104, v104
v_mfma_f32_16x16x32_bf16 v[144:147], a[144:147], v[72:75], v[196:199]
s_waitcnt lgkmcnt(4)
ds_read_b128 a[168:171], v2 offset:14336
v_mfma_f32_16x16x32_bf16 v[136:139], a[148:151], v[60:63], v[136:139]
v_exp_f32 v105, v105
v_mfma_f32_16x16x32_bf16 v[144:147], a[148:151], v[76:79], v[144:147]
s_waitcnt lgkmcnt(4)
ds_read_b128 a[172:175], v2 offset:15360
v_cvt_pk_bf16_f32 v160, v104, v105
v_mfma_f32_16x16x32_bf16 v[136:139], a[152:155], v[64:67], v[136:139]
v_exp_f32 v106, v106
v_mfma_f32_16x16x32_bf16 v[144:147], a[152:155], v[80:83], v[144:147]
s_waitcnt lgkmcnt(4)
ds_read_b128 a[176:179], v3 offset:8192
v_mfma_f32_16x16x32_bf16 v[136:139], a[156:159], v[68:71], v[136:139]
ds_read_b128 a[180:183], v3 offset:9216
v_mfma_f32_16x16x32_bf16 v[144:147], a[156:159], v[84:87], v[144:147]
s_waitcnt lgkmcnt(5)
v_exp_f32 v107, v107
v_mfma_f32_16x16x32_bf16 v[140:143], a[160:163], v[56:59], v[192:195]
ds_read_b128 a[184:187], v3 offset:10240
v_cvt_pk_bf16_f32 v161, v106, v107
v_mfma_f32_16x16x32_bf16 v[148:151], a[160:163], v[72:75], v[196:199]
s_waitcnt lgkmcnt(5)
v_exp_f32 v108, v108
v_mfma_f32_16x16x32_bf16 v[140:143], a[164:167], v[60:63], v[140:143]
ds_read_b128 a[188:191], v3 offset:11264
v_mfma_f32_16x16x32_bf16 v[148:151], a[164:167], v[76:79], v[148:151]
s_waitcnt lgkmcnt(5)
buffer_load_dwordx4 v16, s[32:35], s64 offen offset:3072 sc1 lds
v_mfma_f32_16x16x32_bf16 v[140:143], a[168:171], v[64:67], v[140:143]
v_exp_f32 v109, v109
v_mfma_f32_16x16x32_bf16 v[148:151], a[168:171], v[80:83], v[148:151]
s_waitcnt lgkmcnt(4)
ds_read_b128 a[192:195], v3 offset:12288
v_cvt_pk_bf16_f32 v162, v108, v109
v_mfma_f32_16x16x32_bf16 v[140:143], a[172:175], v[68:71], v[140:143]
v_exp_f32 v110, v110
v_mfma_f32_16x16x32_bf16 v[148:151], a[172:175], v[84:87], v[148:151]
s_waitcnt lgkmcnt(4)
ds_read_b128 a[196:199], v3 offset:13312
v_mfma_f32_16x16x32_bf16 a[32:35], a[176:179], v[172:175], a[32:35]
ds_read_b128 a[200:203], v3 offset:14336
v_mfma_f32_16x16x32_bf16 a[64:67], a[176:179], v[176:179], a[64:67]
v_exp_f32 v111, v111
v_mfma_f32_16x16x32_bf16 a[96:99], a[176:179], v[180:183], a[96:99]
s_waitcnt lgkmcnt(5)
v_exp_f32 v112, v112
v_mfma_f32_16x16x32_bf16 a[36:39], a[180:183], v[172:175], a[36:39]
ds_read_b128 a[204:207], v3 offset:15360
v_cvt_pk_bf16_f32 v163, v110, v111
v_mfma_f32_16x16x32_bf16 a[68:71], a[180:183], v[176:179], a[68:71]
v_exp_f32 v113, v113
v_mfma_f32_16x16x32_bf16 a[100:103], a[180:183], v[180:183], a[100:103]
s_waitcnt vmcnt(8)
s_barrier
s_waitcnt lgkmcnt(5)
v_mfma_f32_16x16x32_bf16 a[40:43], a[184:187], v[172:175], a[40:43]
ds_read_b128 a[144:147], v2 offset:16384
v_cvt_pk_bf16_f32 v164, v112, v113
v_mfma_f32_16x16x32_bf16 a[72:75], a[184:187], v[176:179], a[72:75]
v_exp_f32 v114, v114
v_mfma_f32_16x16x32_bf16 a[104:107], a[184:187], v[180:183], a[104:107]
s_waitcnt lgkmcnt(5)
v_exp_f32 v115, v115
v_mfma_f32_16x16x32_bf16 a[44:47], a[188:191], v[172:175], a[44:47]
ds_read_b128 a[148:151], v2 offset:17408
v_cvt_pk_bf16_f32 v165, v114, v115
v_mfma_f32_16x16x32_bf16 a[76:79], a[188:191], v[176:179], a[76:79]
s_xor_b32 s71, s71, 16384
v_exp_f32 v116, v116
v_mfma_f32_16x16x32_bf16 a[108:111], a[188:191], v[180:183], a[108:111]
s_waitcnt lgkmcnt(5)
s_add_u32 s70, s70, 32768
v_exp_f32 v117, v117
v_mfma_f32_16x16x32_bf16 a[48:51], a[192:195], v[172:175], a[48:51]
s_mov_b32 m0, s71
ds_read_b128 a[152:155], v2 offset:18432
v_cvt_pk_bf16_f32 v166, v116, v117
v_mfma_f32_16x16x32_bf16 a[80:83], a[192:195], v[176:179], a[80:83]
buffer_load_dwordx4 v16, s[32:35], s70 offen offset:0 sc1 lds
v_mfma_f32_16x16x32_bf16 a[112:115], a[192:195], v[180:183], a[112:115]
s_waitcnt lgkmcnt(5)
v_exp_f32 v118, v118
v_mfma_f32_16x16x32_bf16 a[52:55], a[196:199], v[172:175], a[52:55]
ds_read_b128 a[156:159], v2 offset:19456
v_mfma_f32_16x16x32_bf16 a[84:87], a[196:199], v[176:179], a[84:87]
v_exp_f32 v119, v119
v_mfma_f32_16x16x32_bf16 a[116:119], a[196:199], v[180:183], a[116:119]
s_waitcnt lgkmcnt(5)
v_cvt_pk_bf16_f32 v167, v118, v119
v_mfma_f32_16x16x32_bf16 a[56:59], a[200:203], v[172:175], a[56:59]
ds_read_b128 a[160:163], v2 offset:20480
v_mfma_f32_16x16x32_bf16 a[88:91], a[200:203], v[176:179], a[88:91]
buffer_load_dwordx4 v16, s[32:35], s70 offen offset:1024 sc1 lds
v_mfma_f32_16x16x32_bf16 a[120:123], a[200:203], v[180:183], a[120:123]
s_waitcnt lgkmcnt(5)
v_mfma_f32_16x16x32_bf16 a[60:63], a[204:207], v[172:175], a[60:63]
ds_read_b128 a[164:167], v2 offset:21504
v_mfma_f32_16x16x32_bf16 a[92:95], a[204:207], v[176:179], a[92:95]
v_mfma_f32_16x16x32_bf16 a[124:127], a[204:207], v[180:183], a[124:127]
v_mfma_f32_16x16x32_bf16 a[132:135], v[12:15], v[172:175], a[132:135]
v_mfma_f32_16x16x32_bf16 a[136:139], v[12:15], v[176:179], a[136:139]
v_mfma_f32_16x16x32_bf16 a[140:143], v[12:15], v[180:183], a[140:143]
s_waitcnt lgkmcnt(5)
s_nop 7
v_accvgpr_read_b32 v20, a128
v_accvgpr_read_b32 v21, a132
v_max3_f32 v1, v1, v20, v21
v_rcp_f32 v20, v20
v_rcp_f32 v21, v21
s_nop 0
v_mul_f32 v20, v20, v4
v_mul_f32 v21, v21, v6
v_accvgpr_read_b32 v88, a0
v_accvgpr_read_b32 v89, a1
v_accvgpr_read_b32 v90, a2
v_accvgpr_read_b32 v91, a3
v_accvgpr_read_b32 v92, a4
v_accvgpr_read_b32 v93, a5
v_accvgpr_read_b32 v94, a6
v_accvgpr_read_b32 v95, a7
s_add_u32 s65, s74, 0
v_mul_f32 v88, v88, v20
v_mul_f32 v89, v89, v20
v_mul_f32 v90, v90, v20
v_mul_f32 v91, v91, v20
v_mul_f32 v92, v92, v20
v_mul_f32 v93, v93, v20
v_mul_f32 v94, v94, v20
v_mul_f32 v95, v95, v20
v_cvt_pk_bf16_f32 v88, v88, v89
v_cvt_pk_bf16_f32 v89, v90, v91
v_cvt_pk_bf16_f32 v90, v92, v93
v_cvt_pk_bf16_f32 v91, v94, v95
buffer_store_dwordx4 v[88:91], v16, s[44:47], s65 offen sc1
v_accvgpr_read_b32 v120, a8
v_accvgpr_read_b32 v121, a9
v_accvgpr_read_b32 v122, a10
v_accvgpr_read_b32 v123, a11
v_accvgpr_read_b32 v124, a12
v_accvgpr_read_b32 v125, a13
v_accvgpr_read_b32 v126, a14
v_accvgpr_read_b32 v127, a15
s_add_u32 s65, s74, 8192
v_mul_f32 v120, v120, v20
v_mul_f32 v121, v121, v20
v_mul_f32 v122, v122, v20
v_mul_f32 v123, v123, v20
v_mul_f32 v124, v124, v20
v_mul_f32 v125, v125, v20
v_mul_f32 v126, v126, v20
v_mul_f32 v127, v127, v20
v_cvt_pk_bf16_f32 v120, v120, v121
v_cvt_pk_bf16_f32 v121, v122, v123
v_cvt_pk_bf16_f32 v122, v124, v125
v_cvt_pk_bf16_f32 v123, v126, v127
buffer_store_dwordx4 v[120:123], v16, s[44:47], s65 offen sc1
v_accvgpr_read_b32 v88, a16
v_accvgpr_read_b32 v89, a17
v_accvgpr_read_b32 v90, a18
v_accvgpr_read_b32 v91, a19
v_accvgpr_read_b32 v92, a20
v_accvgpr_read_b32 v93, a21
v_accvgpr_read_b32 v94, a22
v_accvgpr_read_b32 v95, a23
s_add_u32 s65, s74, 16384
v_mul_f32 v88, v88, v20
v_mul_f32 v89, v89, v20
v_mul_f32 v90, v90, v20
v_mul_f32 v91, v91, v20
v_mul_f32 v92, v92, v20
v_mul_f32 v93, v93, v20
v_mul_f32 v94, v94, v20
v_mul_f32 v95, v95, v20
v_cvt_pk_bf16_f32 v88, v88, v89
v_cvt_pk_bf16_f32 v89, v90, v91
v_cvt_pk_bf16_f32 v90, v92, v93
v_cvt_pk_bf16_f32 v91, v94, v95
buffer_store_dwordx4 v[88:91], v16, s[44:47], s65 offen sc1
v_accvgpr_read_b32 v120, a24
v_accvgpr_read_b32 v121, a25
v_accvgpr_read_b32 v122, a26
v_accvgpr_read_b32 v123, a27
v_accvgpr_read_b32 v124, a28
v_accvgpr_read_b32 v125, a29
v_accvgpr_read_b32 v126, a30
v_accvgpr_read_b32 v127, a31
s_add_u32 s65, s74, 24576
v_mul_f32 v120, v120, v20
v_mul_f32 v121, v121, v20
v_mul_f32 v122, v122, v20
v_mul_f32 v123, v123, v20
v_mul_f32 v124, v124, v20
v_mul_f32 v125, v125, v20
v_mul_f32 v126, v126, v20
v_mul_f32 v127, v127, v20
v_cvt_pk_bf16_f32 v120, v120, v121
v_cvt_pk_bf16_f32 v121, v122, v123
v_cvt_pk_bf16_f32 v122, v124, v125
v_cvt_pk_bf16_f32 v123, v126, v127
buffer_store_dwordx4 v[120:123], v16, s[44:47], s65 offen sc1
v_accvgpr_read_b32 v88, a32
v_accvgpr_read_b32 v89, a33
v_accvgpr_read_b32 v90, a34
v_accvgpr_read_b32 v91, a35
v_accvgpr_read_b32 v92, a36
v_accvgpr_read_b32 v93, a37
v_accvgpr_read_b32 v94, a38
v_accvgpr_read_b32 v95, a39
s_add_u32 s65, s74, 4096
v_mul_f32 v88, v88, v21
v_mul_f32 v89, v89, v21
v_mul_f32 v90, v90, v21
v_mul_f32 v91, v91, v21
v_mul_f32 v92, v92, v21
v_mul_f32 v93, v93, v21
v_mul_f32 v94, v94, v21
v_mul_f32 v95, v95, v21
v_cvt_pk_bf16_f32 v88, v88, v89
v_cvt_pk_bf16_f32 v89, v90, v91
v_cvt_pk_bf16_f32 v90, v92, v93
v_cvt_pk_bf16_f32 v91, v94, v95
buffer_store_dwordx4 v[88:91], v16, s[44:47], s65 offen sc1
v_accvgpr_read_b32 v120, a40
v_accvgpr_read_b32 v121, a41
v_accvgpr_read_b32 v122, a42
v_accvgpr_read_b32 v123, a43
v_accvgpr_read_b32 v124, a44
v_accvgpr_read_b32 v125, a45
v_accvgpr_read_b32 v126, a46
v_accvgpr_read_b32 v127, a47
s_add_u32 s65, s74, 12288
v_mul_f32 v120, v120, v21
v_mul_f32 v121, v121, v21
v_mul_f32 v122, v122, v21
v_mul_f32 v123, v123, v21
v_mul_f32 v124, v124, v21
v_mul_f32 v125, v125, v21
v_mul_f32 v126, v126, v21
v_mul_f32 v127, v127, v21
v_cvt_pk_bf16_f32 v120, v120, v121
v_cvt_pk_bf16_f32 v121, v122, v123
v_cvt_pk_bf16_f32 v122, v124, v125
v_cvt_pk_bf16_f32 v123, v126, v127
buffer_store_dwordx4 v[120:123], v16, s[44:47], s65 offen sc1
v_accvgpr_read_b32 v88, a48
v_accvgpr_read_b32 v89, a49
v_accvgpr_read_b32 v90, a50
v_accvgpr_read_b32 v91, a51
v_accvgpr_read_b32 v92, a52
v_accvgpr_read_b32 v93, a53
v_accvgpr_read_b32 v94, a54
v_accvgpr_read_b32 v95, a55
s_add_u32 s65, s74, 20480
v_mul_f32 v88, v88, v21
v_mul_f32 v89, v89, v21
v_mul_f32 v90, v90, v21
v_mul_f32 v91, v91, v21
v_mul_f32 v92, v92, v21
v_mul_f32 v93, v93, v21
v_mul_f32 v94, v94, v21
v_mul_f32 v95, v95, v21
v_cvt_pk_bf16_f32 v88, v88, v89
v_cvt_pk_bf16_f32 v89, v90, v91
v_cvt_pk_bf16_f32 v90, v92, v93
v_cvt_pk_bf16_f32 v91, v94, v95
buffer_store_dwordx4 v[88:91], v16, s[44:47], s65 offen sc1
v_accvgpr_read_b32 v120, a56
v_accvgpr_read_b32 v121, a57
v_accvgpr_read_b32 v122, a58
v_accvgpr_read_b32 v123, a59
v_accvgpr_read_b32 v124, a60
v_accvgpr_read_b32 v125, a61
v_accvgpr_read_b32 v126, a62
v_accvgpr_read_b32 v127, a63
s_add_u32 s65, s74, 28672
v_mul_f32 v120, v120, v21
v_mul_f32 v121, v121, v21
v_mul_f32 v122, v122, v21
v_mul_f32 v123, v123, v21
v_mul_f32 v124, v124, v21
v_mul_f32 v125, v125, v21
v_mul_f32 v126, v126, v21
v_mul_f32 v127, v127, v21
v_cvt_pk_bf16_f32 v120, v120, v121
v_cvt_pk_bf16_f32 v121, v122, v123
v_cvt_pk_bf16_f32 v122, v124, v125
v_cvt_pk_bf16_f32 v123, v126, v127
buffer_store_dwordx4 v[120:123], v16, s[44:47], s65 offen sc1
v_mfma_f32_16x16x32_bf16 v[104:107], a[144:147], v[56:59], v[192:195]
ds_read_b128 a[168:171], v2 offset:22528
v_mfma_f32_16x16x32_bf16 v[112:115], a[144:147], v[72:75], v[196:199]
s_waitcnt lgkmcnt(5)
v_exp_f32 v136, v136
v_mfma_f32_16x16x32_bf16 v[104:107], a[148:151], v[60:63], v[104:107]
ds_read_b128 a[172:175], v2 offset:23552
ds_read_b128 a[176:179], v3 offset:16384
v_mfma_f32_16x16x32_bf16 v[112:115], a[148:151], v[76:79], v[112:115]
s_waitcnt lgkmcnt(6)
v_exp_f32 v137, v137
v_mfma_f32_16x16x32_bf16 v[104:107], a[152:155], v[64:67], v[104:107]
ds_read_b128 a[180:183], v3 offset:17408
v_cvt_pk_bf16_f32 v176, v136, v137
v_mfma_f32_16x16x32_bf16 v[112:115], a[152:155], v[80:83], v[112:115]
s_waitcnt lgkmcnt(6)
v_exp_f32 v138, v138
v_mfma_f32_16x16x32_bf16 v[104:107], a[156:159], v[68:71], v[104:107]
buffer_load_dwordx4 v16, s[32:35], s70 offen offset:2048 sc1 lds
v_mfma_f32_16x16x32_bf16 v[112:115], a[156:159], v[84:87], v[112:115]
s_waitcnt lgkmcnt(5)
v_exp_f32 v139, v139
v_mfma_f32_16x16x32_bf16 v[108:111], a[160:163], v[56:59], v[192:195]
ds_read_b128 a[184:187], v3 offset:18432
v_cvt_pk_bf16_f32 v177, v138, v139
v_mfma_f32_16x16x32_bf16 v[116:119], a[160:163], v[72:75], v[196:199]
s_waitcnt lgkmcnt(5)
v_exp_f32 v140, v140
v_mfma_f32_16x16x32_bf16 v[108:111], a[164:167], v[60:63], v[108:111]
buffer_load_dwordx4 v16, s[32:35], s70 offen offset:3072 sc1 lds
v_mfma_f32_16x16x32_bf16 v[116:119], a[164:167], v[76:79], v[116:119]
s_waitcnt lgkmcnt(4)
v_exp_f32 v141, v141
v_mfma_f32_16x16x32_bf16 v[108:111], a[168:171], v[64:67], v[108:111]
s_add_u32 m0, s71, 4096
ds_read_b128 a[188:191], v3 offset:19456
v_cvt_pk_bf16_f32 v178, v140, v141
v_mfma_f32_16x16x32_bf16 v[116:119], a[168:171], v[80:83], v[116:119]
s_waitcnt lgkmcnt(4)
v_exp_f32 v142, v142
v_mfma_f32_16x16x32_bf16 v[108:111], a[172:175], v[68:71], v[108:111]
ds_read_b128 a[192:195], v3 offset:20480
ds_read_b128 a[196:199], v3 offset:21504
v_mfma_f32_16x16x32_bf16 v[116:119], a[172:175], v[84:87], v[116:119]
s_waitcnt lgkmcnt(5)
v_exp_f32 v143, v143
v_mfma_f32_16x16x32_bf16 a[64:67], a[176:179], v[160:163], a[64:67]
s_add_u32 s64, s70, 4096
ds_read_b128 a[200:203], v3 offset:22528
v_cvt_pk_bf16_f32 v179, v142, v143
v_mfma_f32_16x16x32_bf16 a[96:99], a[176:179], v[164:167], a[96:99]
s_waitcnt lgkmcnt(5)
v_exp_f32 v144, v144
v_mfma_f32_16x16x32_bf16 a[68:71], a[180:183], v[160:163], a[68:71]
buffer_load_dwordx4 v16, s[32:35], s64 offen offset:0 sc1 lds
v_mfma_f32_16x16x32_bf16 a[100:103], a[180:183], v[164:167], a[100:103]
s_waitcnt lgkmcnt(4)
v_exp_f32 v145, v145
v_mfma_f32_16x16x32_bf16 a[72:75], a[184:187], v[160:163], a[72:75]
ds_read_b128 a[204:207], v3 offset:23552
v_cvt_pk_bf16_f32 v180, v144, v145
v_mfma_f32_16x16x32_bf16 a[104:107], a[184:187], v[164:167], a[104:107]
s_waitcnt lgkmcnt(4)
v_exp_f32 v146, v146
v_mfma_f32_16x16x32_bf16 a[76:79], a[188:191], v[160:163], a[76:79]
buffer_load_dwordx4 v16, s[32:35], s64 offen offset:1024 sc1 lds
v_mfma_f32_16x16x32_bf16 a[108:111], a[188:191], v[164:167], a[108:111]
s_waitcnt lgkmcnt(3)
v_exp_f32 v147, v147
v_mfma_f32_16x16x32_bf16 a[80:83], a[192:195], v[160:163], a[80:83]
ds_read_b128 a[144:147], v2 offset:24576
v_cvt_pk_bf16_f32 v181, v146, v147
v_mfma_f32_16x16x32_bf16 a[112:115], a[192:195], v[164:167], a[112:115]
s_waitcnt lgkmcnt(3)
v_exp_f32 v148, v148
v_mfma_f32_16x16x32_bf16 a[84:87], a[196:199], v[160:163], a[84:87]
ds_read_b128 a[148:151], v2 offset:25600
ds_read_b128 a[152:155], v2 offset:26624
v_mfma_f32_16x16x32_bf16 a[116:119], a[196:199], v[164:167], a[116:119]
s_waitcnt lgkmcnt(4)
v_exp_f32 v149, v149
v_mfma_f32_16x16x32_bf16 a[88:91], a[200:203], v[160:163], a[88:91]
ds_read_b128 a[156:159], v2 offset:27648
v_cvt_pk_bf16_f32 v182, v148, v149
v_mfma_f32_16x16x32_bf16 a[120:123], a[200:203], v[164:167], a[120:123]
s_waitcnt lgkmcnt(4)
v_exp_f32 v150, v150
v_mfma_f32_16x16x32_bf16 a[92:95], a[204:207], v[160:163], a[92:95]
buffer_load_dwordx4 v16, s[32:35], s64 offen offset:2048 sc1 lds
v_mfma_f32_16x16x32_bf16 a[124:127], a[204:207], v[164:167], a[124:127]
v_exp_f32 v151, v151
v_mfma_f32_16x16x32_bf16 a[136:139], v[12:15], v[160:163], a[136:139]
ds_read_b128 a[160:163], v2 offset:28672
v_cvt_pk_bf16_f32 v183, v150, v151
v_mfma_f32_16x16x32_bf16 a[140:143], v[12:15], v[164:167], a[140:143]
s_waitcnt lgkmcnt(4)
ds_read_b128 a[164:167], v2 offset:29696
v_mfma_f32_16x16x32_bf16 v[136:139], a[144:147], v[56:59], v[192:195]
ds_read_b128 a[168:171], v2 offset:30720
v_mfma_f32_16x16x32_bf16 v[144:147], a[144:147], v[72:75], v[196:199]
s_waitcnt lgkmcnt(5)
v_exp_f32 v104, v104
v_mfma_f32_16x16x32_bf16 v[136:139], a[148:151], v[60:63], v[136:139]
ds_read_b128 a[172:175], v2 offset:31744
ds_read_b128 a[176:179], v3 offset:24576
v_mfma_f32_16x16x32_bf16 v[144:147], a[148:151], v[76:79], v[144:147]
s_waitcnt lgkmcnt(6)
v_exp_f32 v105, v105
v_mfma_f32_16x16x32_bf16 v[136:139], a[152:155], v[64:67], v[136:139]
ds_read_b128 a[180:183], v3 offset:25600
v_cvt_pk_bf16_f32 v160, v104, v105
v_mfma_f32_16x16x32_bf16 v[144:147], a[152:155], v[80:83], v[144:147]
s_waitcnt lgkmcnt(6)
v_exp_f32 v106, v106
v_mfma_f32_16x16x32_bf16 v[136:139], a[156:159], v[68:71], v[136:139]
ds_read_b128 a[184:187], v3 offset:26624
v_xor_b32 v2, 0x8000, v2
v_mfma_f32_16x16x32_bf16 v[144:147], a[156:159], v[84:87], v[144:147]
s_waitcnt lgkmcnt(6)
v_exp_f32 v107, v107
v_mfma_f32_16x16x32_bf16 v[140:143], a[160:163], v[56:59], v[192:195]
ds_read_b128 a[188:191], v3 offset:27648
v_cvt_pk_bf16_f32 v161, v106, v107
v_mfma_f32_16x16x32_bf16 v[148:151], a[160:163], v[72:75], v[196:199]
s_waitcnt lgkmcnt(6)
v_exp_f32 v108, v108
v_mfma_f32_16x16x32_bf16 v[140:143], a[164:167], v[60:63], v[140:143]
buffer_load_dwordx4 v16, s[32:35], s64 offen offset:3072 sc1 lds
v_mfma_f32_16x16x32_bf16 v[148:151], a[164:167], v[76:79], v[148:151]
s_waitcnt lgkmcnt(5)
v_exp_f32 v109, v109
v_mfma_f32_16x16x32_bf16 v[140:143], a[168:171], v[64:67], v[140:143]
s_xor_b32 s71, s71, 49152
ds_read_b128 a[192:195], v3 offset:28672
v_cvt_pk_bf16_f32 v162, v108, v109
v_mfma_f32_16x16x32_bf16 v[148:151], a[168:171], v[80:83], v[148:151]
s_waitcnt lgkmcnt(5)
v_exp_f32 v110, v110
v_mfma_f32_16x16x32_bf16 v[140:143], a[172:175], v[68:71], v[140:143]
ds_read_b128 a[196:199], v3 offset:29696
ds_read_b128 a[200:203], v3 offset:30720
v_mfma_f32_16x16x32_bf16 v[148:151], a[172:175], v[84:87], v[148:151]
s_waitcnt lgkmcnt(6)
v_exp_f32 v111, v111
v_mfma_f32_16x16x32_bf16 a[64:67], a[176:179], v[176:179], a[64:67]
s_add_u32 s70, s70, 32768
ds_read_b128 a[204:207], v3 offset:31744
v_cvt_pk_bf16_f32 v163, v110, v111
v_mfma_f32_16x16x32_bf16 a[96:99], a[176:179], v[180:183], a[96:99]
s_waitcnt lgkmcnt(6)
v_exp_f32 v112, v112
v_mfma_f32_16x16x32_bf16 a[68:71], a[180:183], v[176:179], a[68:71]
s_waitcnt vmcnt(16)
s_barrier
v_mfma_f32_16x16x32_bf16 a[100:103], a[180:183], v[180:183], a[100:103]
s_waitcnt lgkmcnt(5)
v_exp_f32 v113, v113
v_mfma_f32_16x16x32_bf16 a[72:75], a[184:187], v[176:179], a[72:75]
s_mov_b32 m0, s71
ds_read_b128 a[144:147], v2 offset:0
v_cvt_pk_bf16_f32 v164, v112, v113
v_mfma_f32_16x16x32_bf16 a[104:107], a[184:187], v[180:183], a[104:107]
s_waitcnt lgkmcnt(5)
v_exp_f32 v114, v114
v_mfma_f32_16x16x32_bf16 a[76:79], a[188:191], v[176:179], a[76:79]
buffer_load_dwordx4 v16, s[32:35], s70 offen offset:0 sc1 lds
v_mfma_f32_16x16x32_bf16 a[108:111], a[188:191], v[180:183], a[108:111]
s_waitcnt lgkmcnt(4)
v_exp_f32 v115, v115
v_mfma_f32_16x16x32_bf16 a[80:83], a[192:195], v[176:179], a[80:83]
ds_read_b128 a[148:151], v2 offset:1024
v_cvt_pk_bf16_f32 v165, v114, v115
v_mfma_f32_16x16x32_bf16 a[112:115], a[192:195], v[180:183], a[112:115]
s_waitcnt lgkmcnt(4)
v_exp_f32 v116, v116
v_mfma_f32_16x16x32_bf16 a[84:87], a[196:199], v[176:179], a[84:87]
ds_read_b128 a[152:155], v2 offset:2048
v_xor_b32 v3, 0x8000, v3
v_mfma_f32_16x16x32_bf16 a[116:119], a[196:199], v[180:183], a[116:119]
s_waitcnt lgkmcnt(4)
v_exp_f32 v117, v117
v_mfma_f32_16x16x32_bf16 a[88:91], a[200:203], v[176:179], a[88:91]
ds_read_b128 a[156:159], v2 offset:3072
v_cvt_pk_bf16_f32 v166, v116, v117
v_mfma_f32_16x16x32_bf16 a[120:123], a[200:203], v[180:183], a[120:123]
s_waitcnt lgkmcnt(4)
v_exp_f32 v118, v118
v_mfma_f32_16x16x32_bf16 a[92:95], a[204:207], v[176:179], a[92:95]
buffer_load_dwordx4 v16, s[32:35], s70 offen offset:1024 sc1 lds
v_mfma_f32_16x16x32_bf16 a[124:127], a[204:207], v[180:183], a[124:127]
v_exp_f32 v119, v119
v_mfma_f32_16x16x32_bf16 a[136:139], v[12:15], v[176:179], a[136:139]
ds_read_b128 a[160:163], v2 offset:4096
v_cvt_pk_bf16_f32 v167, v118, v119
v_mfma_f32_16x16x32_bf16 a[140:143], v[12:15], v[180:183], a[140:143]
ds_read_b128 a[164:167], v2 offset:5120
s_lshl_b32 s72, s3, 1
s_sub_u32 s72, 13, s72
.p2align 3
L_S_10:
s_waitcnt lgkmcnt(5)
v_mfma_f32_16x16x32_bf16 v[104:107], a[144:147], v[56:59], v[192:195]
ds_read_b128 a[168:171], v2 offset:6144
v_mfma_f32_16x16x32_bf16 v[112:115], a[144:147], v[72:75], v[196:199]
s_waitcnt lgkmcnt(5)
v_exp_f32 v136, v136
v_mfma_f32_16x16x32_bf16 v[104:107], a[148:151], v[60:63], v[104:107]
ds_read_b128 a[172:175], v2 offset:7168
ds_read_b128 a[176:179], v3 offset:0
v_mfma_f32_16x16x32_bf16 v[112:115], a[148:151], v[76:79], v[112:115]
s_waitcnt lgkmcnt(6)
v_exp_f32 v137, v137
v_mfma_f32_16x16x32_bf16 v[104:107], a[152:155], v[64:67], v[104:107]
ds_read_b128 a[180:183], v3 offset:1024
v_cvt_pk_bf16_f32 v176, v136, v137
v_mfma_f32_16x16x32_bf16 v[112:115], a[152:155], v[80:83], v[112:115]
s_waitcnt lgkmcnt(6)
v_exp_f32 v138, v138
v_mfma_f32_16x16x32_bf16 v[104:107], a[156:159], v[68:71], v[104:107]
buffer_load_dwordx4 v16, s[32:35], s70 offen offset:2048 sc1 lds
v_mfma_f32_16x16x32_bf16 v[112:115], a[156:159], v[84:87], v[112:115]
s_waitcnt lgkmcnt(5)
v_exp_f32 v139, v139
v_mfma_f32_16x16x32_bf16 v[108:111], a[160:163], v[56:59], v[192:195]
ds_read_b128 a[184:187], v3 offset:2048
v_cvt_pk_bf16_f32 v177, v138, v139
v_mfma_f32_16x16x32_bf16 v[116:119], a[160:163], v[72:75], v[196:199]
s_waitcnt lgkmcnt(5)
v_exp_f32 v140, v140
v_mfma_f32_16x16x32_bf16 v[108:111], a[164:167], v[60:63], v[108:111]
buffer_load_dwordx4 v16, s[32:35], s70 offen offset:3072 sc1 lds
v_mfma_f32_16x16x32_bf16 v[116:119], a[164:167], v[76:79], v[116:119]
s_waitcnt lgkmcnt(4)
v_exp_f32 v141, v141
v_mfma_f32_16x16x32_bf16 v[108:111], a[168:171], v[64:67], v[108:111]
s_add_u32 m0, s71, 4096
ds_read_b128 a[188:191], v3 offset:3072
v_cvt_pk_bf16_f32 v178, v140, v141
v_mfma_f32_16x16x32_bf16 v[116:119], a[168:171], v[80:83], v[116:119]
s_waitcnt lgkmcnt(4)
v_exp_f32 v142, v142
v_mfma_f32_16x16x32_bf16 v[108:111], a[172:175], v[68:71], v[108:111]
ds_read_b128 a[192:195], v3 offset:4096
ds_read_b128 a[196:199], v3 offset:5120
v_mfma_f32_16x16x32_bf16 v[116:119], a[172:175], v[84:87], v[116:119]
s_waitcnt lgkmcnt(5)
v_exp_f32 v143, v143
v_mfma_f32_16x16x32_bf16 a[64:67], a[176:179], v[160:163], a[64:67]
s_add_u32 s64, s70, 4096
ds_read_b128 a[200:203], v3 offset:6144
v_cvt_pk_bf16_f32 v179, v142, v143
v_mfma_f32_16x16x32_bf16 a[96:99], a[176:179], v[164:167], a[96:99]
s_waitcnt lgkmcnt(5)
v_exp_f32 v144, v144
v_mfma_f32_16x16x32_bf16 a[68:71], a[180:183], v[160:163], a[68:71]
buffer_load_dwordx4 v16, s[32:35], s64 offen offset:0 sc1 lds
v_mfma_f32_16x16x32_bf16 a[100:103], a[180:183], v[164:167], a[100:103]
s_waitcnt lgkmcnt(4)
v_exp_f32 v145, v145
v_mfma_f32_16x16x32_bf16 a[72:75], a[184:187], v[160:163], a[72:75]
ds_read_b128 a[204:207], v3 offset:7168
v_cvt_pk_bf16_f32 v180, v144, v145
v_mfma_f32_16x16x32_bf16 a[104:107], a[184:187], v[164:167], a[104:107]
s_waitcnt lgkmcnt(4)
v_exp_f32 v146, v146
v_mfma_f32_16x16x32_bf16 a[76:79], a[188:191], v[160:163], a[76:79]
buffer_load_dwordx4 v16, s[32:35], s64 offen offset:1024 sc1 lds
v_mfma_f32_16x16x32_bf16 a[108:111], a[188:191], v[164:167], a[108:111]
s_waitcnt lgkmcnt(3)
v_exp_f32 v147, v147
v_mfma_f32_16x16x32_bf16 a[80:83], a[192:195], v[160:163], a[80:83]
ds_read_b128 a[144:147], v2 offset:8192
v_cvt_pk_bf16_f32 v181, v146, v147
v_mfma_f32_16x16x32_bf16 a[112:115], a[192:195], v[164:167], a[112:115]
s_waitcnt lgkmcnt(3)
v_exp_f32 v148, v148
v_mfma_f32_16x16x32_bf16 a[84:87], a[196:199], v[160:163], a[84:87]
ds_read_b128 a[148:151], v2 offset:9216
ds_read_b128 a[152:155], v2 offset:10240
v_mfma_f32_16x16x32_bf16 a[116:119], a[196:199], v[164:167], a[116:119]
s_waitcnt lgkmcnt(4)
v_exp_f32 v149, v149
v_mfma_f32_16x16x32_bf16 a[88:91], a[200:203], v[160:163], a[88:91]
ds_read_b128 a[156:159], v2 offset:11264
v_cvt_pk_bf16_f32 v182, v148, v149
v_mfma_f32_16x16x32_bf16 a[120:123], a[200:203], v[164:167], a[120:123]
s_waitcnt lgkmcnt(4)
v_exp_f32 v150, v150
v_mfma_f32_16x16x32_bf16 a[92:95], a[204:207], v[160:163], a[92:95]
buffer_load_dwordx4 v16, s[32:35], s64 offen offset:2048 sc1 lds
v_mfma_f32_16x16x32_bf16 a[124:127], a[204:207], v[164:167], a[124:127]
v_exp_f32 v151, v151
v_mfma_f32_16x16x32_bf16 a[136:139], v[12:15], v[160:163], a[136:139]
ds_read_b128 a[160:163], v2 offset:12288
v_cvt_pk_bf16_f32 v183, v150, v151
v_mfma_f32_16x16x32_bf16 a[140:143], v[12:15], v[164:167], a[140:143]
s_waitcnt lgkmcnt(4)
ds_read_b128 a[164:167], v2 offset:13312
v_mfma_f32_16x16x32_bf16 v[136:139], a[144:147], v[56:59], v[192:195]
ds_read_b128 a[168:171], v2 offset:14336
v_mfma_f32_16x16x32_bf16 v[144:147], a[144:147], v[72:75], v[196:199]
s_waitcnt lgkmcnt(5)
v_exp_f32 v104, v104
v_mfma_f32_16x16x32_bf16 v[136:139], a[148:151], v[60:63], v[136:139]
ds_read_b128 a[172:175], v2 offset:15360
ds_read_b128 a[176:179], v3 offset:8192
v_mfma_f32_16x16x32_bf16 v[144:147], a[148:151], v[76:79], v[144:147]
s_waitcnt lgkmcnt(6)
v_exp_f32 v105, v105
v_mfma_f32_16x16x32_bf16 v[136:139], a[152:155], v[64:67], v[136:139]
ds_read_b128 a[180:183], v3 offset:9216
v_cvt_pk_bf16_f32 v160, v104, v105
v_mfma_f32_16x16x32_bf16 v[144:147], a[152:155], v[80:83], v[144:147]
s_waitcnt lgkmcnt(6)
v_exp_f32 v106, v106
v_mfma_f32_16x16x32_bf16 v[136:139], a[156:159], v[68:71], v[136:139]
ds_read_b128 a[184:187], v3 offset:10240
v_mfma_f32_16x16x32_bf16 v[144:147], a[156:159], v[84:87], v[144:147]
s_waitcnt lgkmcnt(6)
v_exp_f32 v107, v107
v_mfma_f32_16x16x32_bf16 v[140:143], a[160:163], v[56:59], v[192:195]
ds_read_b128 a[188:191], v3 offset:11264
v_cvt_pk_bf16_f32 v161, v106, v107
v_mfma_f32_16x16x32_bf16 v[148:151], a[160:163], v[72:75], v[196:199]
s_waitcnt lgkmcnt(6)
v_exp_f32 v108, v108
v_mfma_f32_16x16x32_bf16 v[140:143], a[164:167], v[60:63], v[140:143]
buffer_load_dwordx4 v16, s[32:35], s64 offen offset:3072 sc1 lds
v_mfma_f32_16x16x32_bf16 v[148:151], a[164:167], v[76:79], v[148:151]
s_waitcnt lgkmcnt(5)
v_exp_f32 v109, v109
v_mfma_f32_16x16x32_bf16 v[140:143], a[168:171], v[64:67], v[140:143]
s_xor_b32 s71, s71, 16384
ds_read_b128 a[192:195], v3 offset:12288
v_cvt_pk_bf16_f32 v162, v108, v109
v_mfma_f32_16x16x32_bf16 v[148:151], a[168:171], v[80:83], v[148:151]
s_waitcnt lgkmcnt(5)
v_exp_f32 v110, v110
v_mfma_f32_16x16x32_bf16 v[140:143], a[172:175], v[68:71], v[140:143]
ds_read_b128 a[196:199], v3 offset:13312
ds_read_b128 a[200:203], v3 offset:14336
v_mfma_f32_16x16x32_bf16 v[148:151], a[172:175], v[84:87], v[148:151]
s_waitcnt lgkmcnt(6)
v_exp_f32 v111, v111
v_mfma_f32_16x16x32_bf16 a[64:67], a[176:179], v[176:179], a[64:67]
s_add_u32 s70, s70, 32768
ds_read_b128 a[204:207], v3 offset:15360
v_cvt_pk_bf16_f32 v163, v110, v111
v_mfma_f32_16x16x32_bf16 a[96:99], a[176:179], v[180:183], a[96:99]
s_waitcnt lgkmcnt(6)
v_exp_f32 v112, v112
v_mfma_f32_16x16x32_bf16 a[68:71], a[180:183], v[176:179], a[68:71]
s_waitcnt vmcnt(8)
s_barrier
v_mfma_f32_16x16x32_bf16 a[100:103], a[180:183], v[180:183], a[100:103]
s_waitcnt lgkmcnt(5)
v_exp_f32 v113, v113
v_mfma_f32_16x16x32_bf16 a[72:75], a[184:187], v[176:179], a[72:75]
s_mov_b32 m0, s71
ds_read_b128 a[144:147], v2 offset:16384
v_cvt_pk_bf16_f32 v164, v112, v113
v_mfma_f32_16x16x32_bf16 a[104:107], a[184:187], v[180:183], a[104:107]
s_waitcnt lgkmcnt(5)
v_exp_f32 v114, v114
v_mfma_f32_16x16x32_bf16 a[76:79], a[188:191], v[176:179], a[76:79]
buffer_load_dwordx4 v16, s[32:35], s70 offen offset:0 sc1 lds
v_mfma_f32_16x16x32_bf16 a[108:111], a[188:191], v[180:183], a[108:111]
s_waitcnt lgkmcnt(4)
v_exp_f32 v115, v115
v_mfma_f32_16x16x32_bf16 a[80:83], a[192:195], v[176:179], a[80:83]
ds_read_b128 a[148:151], v2 offset:17408
v_cvt_pk_bf16_f32 v165, v114, v115
v_mfma_f32_16x16x32_bf16 a[112:115], a[192:195], v[180:183], a[112:115]
s_waitcnt lgkmcnt(4)
v_exp_f32 v116, v116
v_mfma_f32_16x16x32_bf16 a[84:87], a[196:199], v[176:179], a[84:87]
ds_read_b128 a[152:155], v2 offset:18432
v_mfma_f32_16x16x32_bf16 a[116:119], a[196:199], v[180:183], a[116:119]
s_waitcnt lgkmcnt(4)
v_exp_f32 v117, v117
v_mfma_f32_16x16x32_bf16 a[88:91], a[200:203], v[176:179], a[88:91]
ds_read_b128 a[156:159], v2 offset:19456
v_cvt_pk_bf16_f32 v166, v116, v117
v_mfma_f32_16x16x32_bf16 a[120:123], a[200:203], v[180:183], a[120:123]
s_waitcnt lgkmcnt(4)
v_exp_f32 v118, v118
v_mfma_f32_16x16x32_bf16 a[92:95], a[204:207], v[176:179], a[92:95]
buffer_load_dwordx4 v16, s[32:35], s70 offen offset:1024 sc1 lds
v_mfma_f32_16x16x32_bf16 a[124:127], a[204:207], v[180:183], a[124:127]
v_exp_f32 v119, v119
v_mfma_f32_16x16x32_bf16 a[136:139], v[12:15], v[176:179], a[136:139]
ds_read_b128 a[160:163], v2 offset:20480
v_cvt_pk_bf16_f32 v167, v118, v119
v_mfma_f32_16x16x32_bf16 a[140:143], v[12:15], v[180:183], a[140:143]
s_waitcnt lgkmcnt(4)
ds_read_b128 a[164:167], v2 offset:21504
v_mfma_f32_16x16x32_bf16 v[104:107], a[144:147], v[56:59], v[192:195]
ds_read_b128 a[168:171], v2 offset:22528
v_mfma_f32_16x16x32_bf16 v[112:115], a[144:147], v[72:75], v[196:199]
s_waitcnt lgkmcnt(5)
v_exp_f32 v136, v136
v_mfma_f32_16x16x32_bf16 v[104:107], a[148:151], v[60:63], v[104:107]
ds_read_b128 a[172:175], v2 offset:23552
ds_read_b128 a[176:179], v3 offset:16384
v_mfma_f32_16x16x32_bf16 v[112:115], a[148:151], v[76:79], v[112:115]
s_waitcnt lgkmcnt(6)
v_exp_f32 v137, v137
v_mfma_f32_16x16x32_bf16 v[104:107], a[152:155], v[64:67], v[104:107]
ds_read_b128 a[180:183], v3 offset:17408
v_cvt_pk_bf16_f32 v176, v136, v137
v_mfma_f32_16x16x32_bf16 v[112:115], a[152:155], v[80:83], v[112:115]
s_waitcnt lgkmcnt(6)
v_exp_f32 v138, v138
v_mfma_f32_16x16x32_bf16 v[104:107], a[156:159], v[68:71], v[104:107]
buffer_load_dwordx4 v16, s[32:35], s70 offen offset:2048 sc1 lds
v_mfma_f32_16x16x32_bf16 v[112:115], a[156:159], v[84:87], v[112:115]
s_waitcnt lgkmcnt(5)
v_exp_f32 v139, v139
v_mfma_f32_16x16x32_bf16 v[108:111], a[160:163], v[56:59], v[192:195]
ds_read_b128 a[184:187], v3 offset:18432
v_cvt_pk_bf16_f32 v177, v138, v139
v_mfma_f32_16x16x32_bf16 v[116:119], a[160:163], v[72:75], v[196:199]
s_waitcnt lgkmcnt(5)
v_exp_f32 v140, v140
v_mfma_f32_16x16x32_bf16 v[108:111], a[164:167], v[60:63], v[108:111]
buffer_load_dwordx4 v16, s[32:35], s70 offen offset:3072 sc1 lds
v_mfma_f32_16x16x32_bf16 v[116:119], a[164:167], v[76:79], v[116:119]
s_waitcnt lgkmcnt(4)
v_exp_f32 v141, v141
v_mfma_f32_16x16x32_bf16 v[108:111], a[168:171], v[64:67], v[108:111]
s_add_u32 m0, s71, 4096
ds_read_b128 a[188:191], v3 offset:19456
v_cvt_pk_bf16_f32 v178, v140, v141
v_mfma_f32_16x16x32_bf16 v[116:119], a[168:171], v[80:83], v[116:119]
s_waitcnt lgkmcnt(4)
v_exp_f32 v142, v142
v_mfma_f32_16x16x32_bf16 v[108:111], a[172:175], v[68:71], v[108:111]
ds_read_b128 a[192:195], v3 offset:20480
ds_read_b128 a[196:199], v3 offset:21504
v_mfma_f32_16x16x32_bf16 v[116:119], a[172:175], v[84:87], v[116:119]
s_waitcnt lgkmcnt(5)
v_exp_f32 v143, v143
v_mfma_f32_16x16x32_bf16 a[64:67], a[176:179], v[160:163], a[64:67]
s_add_u32 s64, s70, 4096
ds_read_b128 a[200:203], v3 offset:22528
v_cvt_pk_bf16_f32 v179, v142, v143
v_mfma_f32_16x16x32_bf16 a[96:99], a[176:179], v[164:167], a[96:99]
s_waitcnt lgkmcnt(5)
v_exp_f32 v144, v144
v_mfma_f32_16x16x32_bf16 a[68:71], a[180:183], v[160:163], a[68:71]
buffer_load_dwordx4 v16, s[32:35], s64 offen offset:0 sc1 lds
v_mfma_f32_16x16x32_bf16 a[100:103], a[180:183], v[164:167], a[100:103]
s_waitcnt lgkmcnt(4)
v_exp_f32 v145, v145
v_mfma_f32_16x16x32_bf16 a[72:75], a[184:187], v[160:163], a[72:75]
ds_read_b128 a[204:207], v3 offset:23552
v_cvt_pk_bf16_f32 v180, v144, v145
v_mfma_f32_16x16x32_bf16 a[104:107], a[184:187], v[164:167], a[104:107]
s_waitcnt lgkmcnt(4)
v_exp_f32 v146, v146
v_mfma_f32_16x16x32_bf16 a[76:79], a[188:191], v[160:163], a[76:79]
buffer_load_dwordx4 v16, s[32:35], s64 offen offset:1024 sc1 lds
v_mfma_f32_16x16x32_bf16 a[108:111], a[188:191], v[164:167], a[108:111]
s_waitcnt lgkmcnt(3)
v_exp_f32 v147, v147
v_mfma_f32_16x16x32_bf16 a[80:83], a[192:195], v[160:163], a[80:83]
ds_read_b128 a[144:147], v2 offset:24576
v_cvt_pk_bf16_f32 v181, v146, v147
v_mfma_f32_16x16x32_bf16 a[112:115], a[192:195], v[164:167], a[112:115]
s_waitcnt lgkmcnt(3)
v_exp_f32 v148, v148
v_mfma_f32_16x16x32_bf16 a[84:87], a[196:199], v[160:163], a[84:87]
ds_read_b128 a[148:151], v2 offset:25600
ds_read_b128 a[152:155], v2 offset:26624
v_mfma_f32_16x16x32_bf16 a[116:119], a[196:199], v[164:167], a[116:119]
s_waitcnt lgkmcnt(4)
v_exp_f32 v149, v149
v_mfma_f32_16x16x32_bf16 a[88:91], a[200:203], v[160:163], a[88:91]
ds_read_b128 a[156:159], v2 offset:27648
v_cvt_pk_bf16_f32 v182, v148, v149
v_mfma_f32_16x16x32_bf16 a[120:123], a[200:203], v[164:167], a[120:123]
s_waitcnt lgkmcnt(4)
v_exp_f32 v150, v150
v_mfma_f32_16x16x32_bf16 a[92:95], a[204:207], v[160:163], a[92:95]
buffer_load_dwordx4 v16, s[32:35], s64 offen offset:2048 sc1 lds
v_mfma_f32_16x16x32_bf16 a[124:127], a[204:207], v[164:167], a[124:127]
v_exp_f32 v151, v151
v_mfma_f32_16x16x32_bf16 a[136:139], v[12:15], v[160:163], a[136:139]
ds_read_b128 a[160:163], v2 offset:28672
v_cvt_pk_bf16_f32 v183, v150, v151
v_mfma_f32_16x16x32_bf16 a[140:143], v[12:15], v[164:167], a[140:143]
s_waitcnt lgkmcnt(4)
ds_read_b128 a[164:167], v2 offset:29696
v_mfma_f32_16x16x32_bf16 v[136:139], a[144:147], v[56:59], v[192:195]
ds_read_b128 a[168:171], v2 offset:30720
v_mfma_f32_16x16x32_bf16 v[144:147], a[144:147], v[72:75], v[196:199]
s_waitcnt lgkmcnt(5)
v_exp_f32 v104, v104
v_mfma_f32_16x16x32_bf16 v[136:139], a[148:151], v[60:63], v[136:139]
ds_read_b128 a[172:175], v2 offset:31744
ds_read_b128 a[176:179], v3 offset:24576
v_mfma_f32_16x16x32_bf16 v[144:147], a[148:151], v[76:79], v[144:147]
s_waitcnt lgkmcnt(6)
v_exp_f32 v105, v105
v_mfma_f32_16x16x32_bf16 v[136:139], a[152:155], v[64:67], v[136:139]
ds_read_b128 a[180:183], v3 offset:25600
v_cvt_pk_bf16_f32 v160, v104, v105
v_mfma_f32_16x16x32_bf16 v[144:147], a[152:155], v[80:83], v[144:147]
s_waitcnt lgkmcnt(6)
v_exp_f32 v106, v106
v_mfma_f32_16x16x32_bf16 v[136:139], a[156:159], v[68:71], v[136:139]
ds_read_b128 a[184:187], v3 offset:26624
v_xor_b32 v2, 0x8000, v2
v_mfma_f32_16x16x32_bf16 v[144:147], a[156:159], v[84:87], v[144:147]
s_waitcnt lgkmcnt(6)
v_exp_f32 v107, v107
v_mfma_f32_16x16x32_bf16 v[140:143], a[160:163], v[56:59], v[192:195]
ds_read_b128 a[188:191], v3 offset:27648
v_cvt_pk_bf16_f32 v161, v106, v107
v_mfma_f32_16x16x32_bf16 v[148:151], a[160:163], v[72:75], v[196:199]
s_waitcnt lgkmcnt(6)
v_exp_f32 v108, v108
v_mfma_f32_16x16x32_bf16 v[140:143], a[164:167], v[60:63], v[140:143]
buffer_load_dwordx4 v16, s[32:35], s64 offen offset:3072 sc1 lds
v_mfma_f32_16x16x32_bf16 v[148:151], a[164:167], v[76:79], v[148:151]
s_waitcnt lgkmcnt(5)
v_exp_f32 v109, v109
v_mfma_f32_16x16x32_bf16 v[140:143], a[168:171], v[64:67], v[140:143]
s_xor_b32 s71, s71, 49152
ds_read_b128 a[192:195], v3 offset:28672
v_cvt_pk_bf16_f32 v162, v108, v109
v_mfma_f32_16x16x32_bf16 v[148:151], a[168:171], v[80:83], v[148:151]
s_waitcnt lgkmcnt(5)
v_exp_f32 v110, v110
v_mfma_f32_16x16x32_bf16 v[140:143], a[172:175], v[68:71], v[140:143]
ds_read_b128 a[196:199], v3 offset:29696
ds_read_b128 a[200:203], v3 offset:30720
v_mfma_f32_16x16x32_bf16 v[148:151], a[172:175], v[84:87], v[148:151]
s_waitcnt lgkmcnt(6)
v_exp_f32 v111, v111
v_mfma_f32_16x16x32_bf16 a[64:67], a[176:179], v[176:179], a[64:67]
s_add_u32 s70, s70, 32768
ds_read_b128 a[204:207], v3 offset:31744
v_cvt_pk_bf16_f32 v163, v110, v111
v_mfma_f32_16x16x32_bf16 a[96:99], a[176:179], v[180:183], a[96:99]
s_waitcnt lgkmcnt(6)
v_exp_f32 v112, v112
v_mfma_f32_16x16x32_bf16 a[68:71], a[180:183], v[176:179], a[68:71]
s_waitcnt vmcnt(8)
s_barrier
v_mfma_f32_16x16x32_bf16 a[100:103], a[180:183], v[180:183], a[100:103]
s_waitcnt lgkmcnt(5)
v_exp_f32 v113, v113
v_mfma_f32_16x16x32_bf16 a[72:75], a[184:187], v[176:179], a[72:75]
s_mov_b32 m0, s71
ds_read_b128 a[144:147], v2 offset:0
v_cvt_pk_bf16_f32 v164, v112, v113
v_mfma_f32_16x16x32_bf16 a[104:107], a[184:187], v[180:183], a[104:107]
s_waitcnt lgkmcnt(5)
v_exp_f32 v114, v114
v_mfma_f32_16x16x32_bf16 a[76:79], a[188:191], v[176:179], a[76:79]
buffer_load_dwordx4 v16, s[32:35], s70 offen offset:0 sc1 lds
v_mfma_f32_16x16x32_bf16 a[108:111], a[188:191], v[180:183], a[108:111]
s_waitcnt lgkmcnt(4)
v_exp_f32 v115, v115
v_mfma_f32_16x16x32_bf16 a[80:83], a[192:195], v[176:179], a[80:83]
ds_read_b128 a[148:151], v2 offset:1024
v_cvt_pk_bf16_f32 v165, v114, v115
v_mfma_f32_16x16x32_bf16 a[112:115], a[192:195], v[180:183], a[112:115]
s_waitcnt lgkmcnt(4)
v_exp_f32 v116, v116
v_mfma_f32_16x16x32_bf16 a[84:87], a[196:199], v[176:179], a[84:87]
ds_read_b128 a[152:155], v2 offset:2048
v_xor_b32 v3, 0x8000, v3
v_mfma_f32_16x16x32_bf16 a[116:119], a[196:199], v[180:183], a[116:119]
s_waitcnt lgkmcnt(4)
v_exp_f32 v117, v117
v_mfma_f32_16x16x32_bf16 a[88:91], a[200:203], v[176:179], a[88:91]
ds_read_b128 a[156:159], v2 offset:3072
v_cvt_pk_bf16_f32 v166, v116, v117
v_mfma_f32_16x16x32_bf16 a[120:123], a[200:203], v[180:183], a[120:123]
s_waitcnt lgkmcnt(4)
v_exp_f32 v118, v118
v_mfma_f32_16x16x32_bf16 a[92:95], a[204:207], v[176:179], a[92:95]
buffer_load_dwordx4 v16, s[32:35], s70 offen offset:1024 sc1 lds
v_mfma_f32_16x16x32_bf16 a[124:127], a[204:207], v[180:183], a[124:127]
v_exp_f32 v119, v119
v_mfma_f32_16x16x32_bf16 a[136:139], v[12:15], v[176:179], a[136:139]
ds_read_b128 a[160:163], v2 offset:4096
v_cvt_pk_bf16_f32 v167, v118, v119
v_mfma_f32_16x16x32_bf16 a[140:143], v[12:15], v[180:183], a[140:143]
ds_read_b128 a[164:167], v2 offset:5120
s_sub_u32 s72, s72, 1
s_cmp_lg_u32 s72, 0
s_cbranch_scc1 L_S_10
v_add_f32 v216, v192, v200
v_add_f32 v217, v192, v201
v_add_f32 v218, v192, v202
v_add_f32 v219, v192, v203
v_add_f32 v220, v192, v204
v_add_f32 v221, v192, v205
v_add_f32 v222, v192, v206
v_add_f32 v223, v192, v207
s_nop 0
s_waitcnt lgkmcnt(5)
v_mfma_f32_16x16x32_bf16 v[104:107], a[144:147], v[56:59], v[216:219]
s_and_b32 s66, s2, 7
ds_read_b128 a[168:171], v2 offset:6144
v_mfma_f32_16x16x32_bf16 v[112:115], a[144:147], v[72:75], v[196:199]
s_waitcnt lgkmcnt(5)
s_lshr_b32 s67, s2, 3
v_exp_f32 v136, v136
v_mfma_f32_16x16x32_bf16 v[104:107], a[148:151], v[60:63], v[104:107]
s_lshr_b32 s83, s66, 2
ds_read_b128 a[172:175], v2 offset:7168
ds_read_b128 a[176:179], v3 offset:0
v_mfma_f32_16x16x32_bf16 v[112:115], a[148:151], v[76:79], v[112:115]
s_waitcnt lgkmcnt(6)
s_and_b32 s68, s66, 1
v_exp_f32 v137, v137
v_mfma_f32_16x16x32_bf16 v[104:107], a[152:155], v[64:67], v[104:107]
s_and_b32 s69, s67, 7
ds_read_b128 a[180:183], v3 offset:1024
v_cvt_pk_bf16_f32 v176, v136, v137
v_mfma_f32_16x16x32_bf16 v[112:115], a[152:155], v[80:83], v[112:115]
s_waitcnt lgkmcnt(6)
s_lshl3_add_u32 s82, s68, s69
v_exp_f32 v138, v138
v_mfma_f32_16x16x32_bf16 v[104:107], a[156:159], v[68:71], v[104:107]
s_and_b32 s68, s66, 2
buffer_load_dwordx4 v16, s[32:35], s70 offen offset:2048 sc1 lds
v_mfma_f32_16x16x32_bf16 v[112:115], a[156:159], v[84:87], v[112:115]
s_waitcnt lgkmcnt(5)
s_lshr_b32 s69, s67, 3
v_exp_f32 v139, v139
v_mfma_f32_16x16x32_bf16 v[108:111], a[160:163], v[56:59], v[220:223]
s_lshl1_add_u32 s87, s68, s69
ds_read_b128 a[184:187], v3 offset:2048
v_cvt_pk_bf16_f32 v177, v138, v139
v_mfma_f32_16x16x32_bf16 v[116:119], a[160:163], v[72:75], v[196:199]
s_waitcnt lgkmcnt(5)
s_lshl_b32 s87, s87, 8
v_exp_f32 v140, v140
v_mfma_f32_16x16x32_bf16 v[108:111], a[164:167], v[60:63], v[108:111]
s_lshl_b32 s86, s30, 12
buffer_load_dwordx4 v16, s[32:35], s70 offen offset:3072 sc1 lds
v_mfma_f32_16x16x32_bf16 v[116:119], a[164:167], v[76:79], v[116:119]
s_waitcnt lgkmcnt(4)
s_lshl_b32 s85, s30, 15
v_exp_f32 v141, v141
v_mfma_f32_16x16x32_bf16 v[108:111], a[168:171], v[64:67], v[108:111]
s_add_u32 m0, s71, 4096
ds_read_b128 a[188:191], v3 offset:3072
v_cvt_pk_bf16_f32 v178, v140, v141
v_mfma_f32_16x16x32_bf16 v[116:119], a[168:171], v[80:83], v[116:119]
s_waitcnt lgkmcnt(4)
s_add_u32 s85, s85, s87
v_exp_f32 v142, v142
v_mfma_f32_16x16x32_bf16 v[108:111], a[172:175], v[68:71], v[108:111]
s_lshl_b32 s66, s83, 20
ds_read_b128 a[192:195], v3 offset:4096
ds_read_b128 a[196:199], v3 offset:5120
v_add_f32 v216, v192, v208
v_mfma_f32_16x16x32_bf16 v[116:119], a[172:175], v[84:87], v[116:119]
s_waitcnt lgkmcnt(5)
s_add_u32 s85, s85, s66
v_exp_f32 v143, v143
v_mfma_f32_16x16x32_bf16 a[64:67], a[176:179], v[160:163], a[64:67]
s_add_u32 s64, s70, 4096
ds_read_b128 a[200:203], v3 offset:6144
v_cvt_pk_bf16_f32 v179, v142, v143
v_mfma_f32_16x16x32_bf16 a[96:99], a[176:179], v[164:167], a[96:99]
s_waitcnt lgkmcnt(5)
s_mul_i32 s84, s82, 1310720
v_exp_f32 v144, v144
v_mfma_f32_16x16x32_bf16 a[68:71], a[180:183], v[160:163], a[68:71]
s_lshl_b32 s66, s30, 11
buffer_load_dwordx4 v16, s[32:35], s64 offen offset:0 sc1 lds
v_mfma_f32_16x16x32_bf16 a[100:103], a[180:183], v[164:167], a[100:103]
s_waitcnt lgkmcnt(4)
s_add_u32 s84, s84, s66
v_exp_f32 v145, v145
v_mfma_f32_16x16x32_bf16 a[72:75], a[184:187], v[160:163], a[72:75]
s_lshl_b32 s66, s83, 17
ds_read_b128 a[204:207], v3 offset:7168
v_cvt_pk_bf16_f32 v180, v144, v145
v_mfma_f32_16x16x32_bf16 a[104:107], a[184:187], v[164:167], a[104:107]
s_waitcnt lgkmcnt(4)
s_add_u32 s84, s84, s66
v_exp_f32 v146, v146
v_mfma_f32_16x16x32_bf16 a[76:79], a[188:191], v[160:163], a[76:79]
s_add_u32 s84, s84, 34603008
buffer_load_dwordx4 v16, s[32:35], s64 offen offset:1024 sc1 lds
v_mfma_f32_16x16x32_bf16 a[108:111], a[188:191], v[164:167], a[108:111]
s_waitcnt lgkmcnt(3)
s_mov_b32 s36, s20
v_exp_f32 v147, v147
v_mfma_f32_16x16x32_bf16 a[80:83], a[192:195], v[160:163], a[80:83]
s_mov_b32 s37, s21
ds_read_b128 a[144:147], v2 offset:8192
v_cvt_pk_bf16_f32 v181, v146, v147
v_mfma_f32_16x16x32_bf16 a[112:115], a[192:195], v[164:167], a[112:115]
s_waitcnt lgkmcnt(3)
s_mov_b32 s38, 2097152
v_exp_f32 v148, v148
v_mfma_f32_16x16x32_bf16 a[84:87], a[196:199], v[160:163], a[84:87]
s_mov_b32 s40, s14
ds_read_b128 a[148:151], v2 offset:9216
ds_read_b128 a[152:155], v2 offset:10240
v_add_f32 v217, v192, v209
v_mfma_f32_16x16x32_bf16 a[116:119], a[196:199], v[164:167], a[116:119]
s_waitcnt lgkmcnt(4)
s_mov_b32 s41, s15
v_exp_f32 v149, v149
v_mfma_f32_16x16x32_bf16 a[88:91], a[200:203], v[160:163], a[88:91]
s_mov_b32 s42, 8388608
ds_read_b128 a[156:159], v2 offset:11264
v_cvt_pk_bf16_f32 v182, v148, v149
v_mfma_f32_16x16x32_bf16 a[120:123], a[200:203], v[164:167], a[120:123]
s_waitcnt lgkmcnt(4)
v_exp_f32 v150, v150
v_mfma_f32_16x16x32_bf16 a[92:95], a[204:207], v[160:163], a[92:95]
buffer_load_dwordx4 v16, s[32:35], s64 offen offset:2048 sc1 lds
v_mfma_f32_16x16x32_bf16 a[124:127], a[204:207], v[164:167], a[124:127]
v_add_f32 v218, v192, v210
v_add_f32 v219, v192, v211
v_add_f32 v220, v192, v212
v_add_f32 v221, v192, v213
v_add_f32 v222, v192, v214
v_add_f32 v223, v192, v215
v_exp_f32 v151, v151
v_mfma_f32_16x16x32_bf16 a[136:139], v[12:15], v[160:163], a[136:139]
ds_read_b128 a[160:163], v2 offset:12288
v_cvt_pk_bf16_f32 v183, v150, v151
v_mfma_f32_16x16x32_bf16 a[140:143], v[12:15], v[164:167], a[140:143]
s_waitcnt lgkmcnt(4)
ds_read_b128 a[164:167], v2 offset:13312
v_lshrrev_b32 v19, 4, v0
v_bfe_u32 v17, v0, 1, 3
v_xor_b32 v17, v17, v19
v_lshlrev_b32 v17, 5, v17
v_lshl_add_u32 v17, v19, 11, v17
v_and_b32 v19, 1, v0
v_lshl_add_u32 v17, v19, 4, v17
v_xor_b32 v18, 128, v17
buffer_load_dword v19, off, s[52:55], 0 offset:128 sc1
v_mfma_f32_16x16x32_bf16 v[136:139], a[144:147], v[56:59], v[216:219]
ds_read_b128 a[168:171], v2 offset:14336
v_mfma_f32_16x16x32_bf16 v[144:147], a[144:147], v[72:75], v[196:199]
s_waitcnt lgkmcnt(5)
v_exp_f32 v104, v104
v_mfma_f32_16x16x32_bf16 v[136:139], a[148:151], v[60:63], v[136:139]
ds_read_b128 a[172:175], v2 offset:15360
ds_read_b128 a[176:179], v3 offset:8192
v_mfma_f32_16x16x32_bf16 v[144:147], a[148:151], v[76:79], v[144:147]
s_waitcnt lgkmcnt(6)
v_exp_f32 v105, v105
v_mfma_f32_16x16x32_bf16 v[136:139], a[152:155], v[64:67], v[136:139]
ds_read_b128 a[180:183], v3 offset:9216
v_cvt_pk_bf16_f32 v160, v104, v105
v_mfma_f32_16x16x32_bf16 v[144:147], a[152:155], v[80:83], v[144:147]
s_waitcnt lgkmcnt(6)
v_exp_f32 v106, v106
v_mfma_f32_16x16x32_bf16 v[136:139], a[156:159], v[68:71], v[136:139]
ds_read_b128 a[184:187], v3 offset:10240
v_mfma_f32_16x16x32_bf16 v[144:147], a[156:159], v[84:87], v[144:147]
s_waitcnt lgkmcnt(6)
v_exp_f32 v107, v107
v_mfma_f32_16x16x32_bf16 v[140:143], a[160:163], v[56:59], v[220:223]
ds_read_b128 a[188:191], v3 offset:11264
v_cvt_pk_bf16_f32 v161, v106, v107
v_mfma_f32_16x16x32_bf16 v[148:151], a[160:163], v[72:75], v[196:199]
s_waitcnt lgkmcnt(6)
v_exp_f32 v108, v108
v_mfma_f32_16x16x32_bf16 v[140:143], a[164:167], v[60:63], v[140:143]
buffer_load_dwordx4 v16, s[32:35], s64 offen offset:3072 sc1 lds
v_mfma_f32_16x16x32_bf16 v[148:151], a[164:167], v[76:79], v[148:151]
s_waitcnt lgkmcnt(5)
v_exp_f32 v109, v109
v_mfma_f32_16x16x32_bf16 v[140:143], a[168:171], v[64:67], v[140:143]
ds_read_b128 a[192:195], v3 offset:12288
v_cvt_pk_bf16_f32 v162, v108, v109
v_mfma_f32_16x16x32_bf16 v[148:151], a[168:171], v[80:83], v[148:151]
s_waitcnt lgkmcnt(5)
v_exp_f32 v110, v110
v_mfma_f32_16x16x32_bf16 v[140:143], a[172:175], v[68:71], v[140:143]
ds_read_b128 a[196:199], v3 offset:13312
ds_read_b128 a[200:203], v3 offset:14336
v_add_f32 v216, v196, v200
v_mfma_f32_16x16x32_bf16 v[148:151], a[172:175], v[84:87], v[148:151]
s_waitcnt lgkmcnt(6)
v_exp_f32 v111, v111
v_mfma_f32_16x16x32_bf16 a[64:67], a[176:179], v[176:179], a[64:67]
ds_read_b128 a[204:207], v3 offset:15360
v_cvt_pk_bf16_f32 v163, v110, v111
v_mfma_f32_16x16x32_bf16 a[96:99], a[176:179], v[180:183], a[96:99]
s_waitcnt lgkmcnt(6)
v_exp_f32 v112, v112
v_mfma_f32_16x16x32_bf16 a[68:71], a[180:183], v[176:179], a[68:71]
s_waitcnt vmcnt(9)
s_barrier
v_mfma_f32_16x16x32_bf16 a[100:103], a[180:183], v[180:183], a[100:103]
s_waitcnt lgkmcnt(5)
v_exp_f32 v113, v113
v_mfma_f32_16x16x32_bf16 a[72:75], a[184:187], v[176:179], a[72:75]
ds_read_b128 a[144:147], v2 offset:16384
v_cvt_pk_bf16_f32 v164, v112, v113
v_mfma_f32_16x16x32_bf16 a[104:107], a[184:187], v[180:183], a[104:107]
s_waitcnt lgkmcnt(5)
v_exp_f32 v114, v114
v_mfma_f32_16x16x32_bf16 a[76:79], a[188:191], v[176:179], a[76:79]
v_add_f32 v217, v196, v201
v_add_f32 v218, v196, v202
v_mfma_f32_16x16x32_bf16 a[108:111], a[188:191], v[180:183], a[108:111]
s_waitcnt lgkmcnt(4)
v_exp_f32 v115, v115
v_mfma_f32_16x16x32_bf16 a[80:83], a[192:195], v[176:179], a[80:83]
ds_read_b128 a[148:151], v2 offset:17408
v_cvt_pk_bf16_f32 v165, v114, v115
v_mfma_f32_16x16x32_bf16 a[112:115], a[192:195], v[180:183], a[112:115]
s_waitcnt lgkmcnt(4)
v_exp_f32 v116, v116
v_mfma_f32_16x16x32_bf16 a[84:87], a[196:199], v[176:179], a[84:87]
ds_read_b128 a[152:155], v2 offset:18432
v_add_f32 v219, v196, v203
v_mfma_f32_16x16x32_bf16 a[116:119], a[196:199], v[180:183], a[116:119]
s_waitcnt lgkmcnt(4)
v_exp_f32 v117, v117
v_mfma_f32_16x16x32_bf16 a[88:91], a[200:203], v[176:179], a[88:91]
ds_read_b128 a[156:159], v2 offset:19456
v_cvt_pk_bf16_f32 v166, v116, v117
v_mfma_f32_16x16x32_bf16 a[120:123], a[200:203], v[180:183], a[120:123]
s_waitcnt lgkmcnt(4)
v_exp_f32 v118, v118
v_mfma_f32_16x16x32_bf16 a[92:95], a[204:207], v[176:179], a[92:95]
v_add_f32 v220, v196, v204
v_add_f32 v221, v196, v205
v_mfma_f32_16x16x32_bf16 a[124:127], a[204:207], v[180:183], a[124:127]
v_add_f32 v222, v196, v206
v_add_f32 v223, v196, v207
v_exp_f32 v119, v119
v_mfma_f32_16x16x32_bf16 a[136:139], v[12:15], v[176:179], a[136:139]
ds_read_b128 a[160:163], v2 offset:20480
v_cvt_pk_bf16_f32 v167, v118, v119
v_mfma_f32_16x16x32_bf16 a[140:143], v[12:15], v[180:183], a[140:143]
s_waitcnt lgkmcnt(4)
ds_read_b128 a[164:167], v2 offset:21504
v_mfma_f32_16x16x32_bf16 v[112:115], a[144:147], v[72:75], v[216:219]
s_waitcnt vmcnt(1)
v_readfirstlane_b32 s66, v19
s_nop 0
s_cmp_lt_u32 s66, 256
s_cbranch_scc1 L_spin_13
L_spinbk_14:
s_waitcnt lgkmcnt(4)
v_mfma_f32_16x16x32_bf16 v[112:115], a[148:151], v[76:79], v[112:115]
s_waitcnt lgkmcnt(3)
v_exp_f32 v136, v136
v_mfma_f32_16x16x32_bf16 v[112:115], a[152:155], v[80:83], v[112:115]
s_waitcnt lgkmcnt(2)
s_add_u32 m0, s86, 131072
ds_read_b128 a[168:171], v2 offset:22528
v_mfma_f32_16x16x32_bf16 v[112:115], a[156:159], v[84:87], v[112:115]
s_waitcnt lgkmcnt(2)
s_add_u32 s64, s85, 0
v_exp_f32 v137, v137
v_mfma_f32_16x16x32_bf16 v[116:119], a[160:163], v[72:75], v[220:223]
s_waitcnt lgkmcnt(1)
ds_read_b128 a[172:175], v2 offset:23552
buffer_load_dwordx4 v17, s[36:39], s64 offen lds
v_exp_f32 v138, v138
v_mfma_f32_16x16x32_bf16 v[116:119], a[164:167], v[76:79], v[116:119]
s_waitcnt lgkmcnt(1)
s_add_u32 m0, s86, 132096
ds_read_b128 a[176:179], v3 offset:16384
v_cvt_pk_bf16_f32 v176, v136, v137
v_mfma_f32_16x16x32_bf16 v[116:119], a[168:171], v[80:83], v[116:119]
s_waitcnt lgkmcnt(1)
s_add_u32 s64, s85, 8192
ds_read_b128 a[180:183], v3 offset:17408
v_exp_f32 v139, v139
v_mfma_f32_16x16x32_bf16 v[116:119], a[172:175], v[84:87], v[116:119]
s_waitcnt lgkmcnt(1)
buffer_load_dwordx4 v18, s[36:39], s64 offen lds
ds_read_b128 a[184:187], v3 offset:18432
v_exp_f32 v140, v140
v_mfma_f32_16x16x32_bf16 a[64:67], a[176:179], v[160:163], a[64:67]
s_add_u32 m0, s86, 133120
ds_read_b128 a[188:191], v3 offset:19456
v_add_f32 v216, v196, v208
v_mfma_f32_16x16x32_bf16 a[96:99], a[176:179], v[164:167], a[96:99]
s_waitcnt lgkmcnt(2)
s_add_u32 s64, s85, 16384
ds_read_b128 a[192:195], v3 offset:20480
v_exp_f32 v141, v141
v_mfma_f32_16x16x32_bf16 a[68:71], a[180:183], v[160:163], a[68:71]
buffer_load_dwordx4 v17, s[36:39], s64 offen lds
ds_read_b128 a[196:199], v3 offset:21504
v_exp_f32 v142, v142
v_mfma_f32_16x16x32_bf16 a[100:103], a[180:183], v[164:167], a[100:103]
s_waitcnt lgkmcnt(3)
s_add_u32 m0, s86, 134144
ds_read_b128 a[200:203], v3 offset:22528
v_add_f32 v217, v196, v209
v_mfma_f32_16x16x32_bf16 a[72:75], a[184:187], v[160:163], a[72:75]
s_add_u32 s64, s85, 24576
v_exp_f32 v143, v143
v_mfma_f32_16x16x32_bf16 a[104:107], a[184:187], v[164:167], a[104:107]
s_waitcnt lgkmcnt(3)
buffer_load_dwordx4 v18, s[36:39], s64 offen lds
ds_read_b128 a[204:207], v3 offset:23552
v_exp_f32 v144, v144
v_mfma_f32_16x16x32_bf16 a[76:79], a[188:191], v[160:163], a[76:79]
s_add_u32 s65, s84, 0
v_exp_f32 v145, v145
v_mfma_f32_16x16x32_bf16 a[108:111], a[188:191], v[164:167], a[108:111]
s_waitcnt lgkmcnt(3)
ds_read_b128 a[144:147], v2 offset:24576
v_add_f32 v218, v196, v210
v_mfma_f32_16x16x32_bf16 a[80:83], a[192:195], v[160:163], a[80:83]
buffer_load_dwordx4 v[224:227], v16, s[44:47], s65 offen offset:0 sc1
v_exp_f32 v146, v146
v_mfma_f32_16x16x32_bf16 a[112:115], a[192:195], v[164:167], a[112:115]
s_waitcnt lgkmcnt(3)
ds_read_b128 a[148:151], v2 offset:25600
v_add_f32 v219, v196, v211
v_mfma_f32_16x16x32_bf16 a[84:87], a[196:199], v[160:163], a[84:87]
v_exp_f32 v147, v147
v_mfma_f32_16x16x32_bf16 a[116:119], a[196:199], v[164:167], a[116:119]
s_waitcnt lgkmcnt(3)
buffer_load_dwordx4 v[228:231], v16, s[44:47], s65 offen offset:1024 sc1
ds_read_b128 a[152:155], v2 offset:26624
v_exp_f32 v148, v148
v_mfma_f32_16x16x32_bf16 a[88:91], a[200:203], v[160:163], a[88:91]
s_add_u32 s65, s84, 8192
v_exp_f32 v149, v149
v_mfma_f32_16x16x32_bf16 a[120:123], a[200:203], v[164:167], a[120:123]
s_waitcnt lgkmcnt(3)
ds_read_b128 a[156:159], v2 offset:27648
v_add_f32 v220, v196, v212
v_mfma_f32_16x16x32_bf16 a[92:95], a[204:207], v[160:163], a[92:95]
buffer_load_dwordx4 v[232:235], v16, s[44:47], s65 offen offset:0 sc1
v_exp_f32 v150, v150
v_mfma_f32_16x16x32_bf16 a[124:127], a[204:207], v[164:167], a[124:127]
ds_read_b128 a[160:163], v2 offset:28672
v_add_f32 v221, v196, v213
v_add_f32 v222, v196, v214
v_add_f32 v223, v196, v215
v_mfma_f32_16x16x32_bf16 a[136:139], v[12:15], v[160:163], a[136:139]
v_exp_f32 v151, v151
v_mfma_f32_16x16x32_bf16 a[140:143], v[12:15], v[164:167], a[140:143]
s_waitcnt lgkmcnt(4)
buffer_load_dwordx4 v[236:239], v16, s[44:47], s65 offen offset:1024 sc1
ds_read_b128 a[164:167], v2 offset:29696
v_cvt_pk_bf16_f32 v177, v138, v139
v_cvt_pk_bf16_f32 v178, v140, v141
v_cvt_pk_bf16_f32 v179, v142, v143
v_cvt_pk_bf16_f32 v180, v144, v145
v_cvt_pk_bf16_f32 v181, v146, v147
v_cvt_pk_bf16_f32 v182, v148, v149
v_cvt_pk_bf16_f32 v183, v150, v151
v_mfma_f32_16x16x32_bf16 v[144:147], a[144:147], v[72:75], v[216:219]
s_waitcnt lgkmcnt(4)
ds_read_b128 a[168:171], v2 offset:30720
v_mfma_f32_16x16x32_bf16 v[144:147], a[148:151], v[76:79], v[144:147]
s_waitcnt lgkmcnt(4)
v_exp_f32 v112, v112
v_mfma_f32_16x16x32_bf16 v[144:147], a[152:155], v[80:83], v[144:147]
s_waitcnt lgkmcnt(3)
ds_read_b128 a[172:175], v2 offset:31744
v_mfma_f32_16x16x32_bf16 v[144:147], a[156:159], v[84:87], v[144:147]
s_waitcnt lgkmcnt(3)
ds_read_b128 a[176:179], v3 offset:24576
v_mfma_f32_16x16x32_bf16 v[148:151], a[160:163], v[72:75], v[220:223]
s_waitcnt lgkmcnt(3)
v_exp_f32 v113, v113
v_mfma_f32_16x16x32_bf16 v[148:151], a[164:167], v[76:79], v[148:151]
s_waitcnt lgkmcnt(2)
ds_read_b128 a[180:183], v3 offset:25600
v_xor_b32 v2, 0x8000, v2
v_mfma_f32_16x16x32_bf16 v[148:151], a[168:171], v[80:83], v[148:151]
s_waitcnt lgkmcnt(2)
ds_read_b128 a[184:187], v3 offset:26624
v_cvt_pk_bf16_f32 v164, v112, v113
v_mfma_f32_16x16x32_bf16 v[148:151], a[172:175], v[84:87], v[148:151]
s_waitcnt lgkmcnt(2)
ds_read_b128 a[188:191], v3 offset:27648
v_mfma_f32_16x16x32_bf16 a[64:67], a[176:179], v[176:179], a[64:67]
v_exp_f32 v114, v114
v_mfma_f32_16x16x32_bf16 a[96:99], a[176:179], v[180:183], a[96:99]
s_waitcnt lgkmcnt(2)
s_add_u32 m0, s86, 147456
ds_read_b128 a[192:195], v3 offset:28672
v_mfma_f32_16x16x32_bf16 a[68:71], a[180:183], v[176:179], a[68:71]
s_add_u32 s64, s85, 131072
ds_read_b128 a[196:199], v3 offset:29696
v_mfma_f32_16x16x32_bf16 a[100:103], a[180:183], v[180:183], a[100:103]
s_waitcnt lgkmcnt(3)
buffer_load_dwordx4 v17, s[36:39], s64 offen lds
ds_read_b128 a[200:203], v3 offset:30720
v_mfma_f32_16x16x32_bf16 a[72:75], a[184:187], v[176:179], a[72:75]
s_add_u32 m0, s86, 148480
s_add_u32 s64, s85, 139264
v_exp_f32 v115, v115
v_mfma_f32_16x16x32_bf16 a[104:107], a[184:187], v[180:183], a[104:107]
buffer_load_dwordx4 v18, s[36:39], s64 offen lds
ds_read_b128 a[204:207], v3 offset:31744
s_waitcnt vmcnt(10)
s_barrier
s_waitcnt lgkmcnt(4)
v_mfma_f32_16x16x32_bf16 a[76:79], a[188:191], v[176:179], a[76:79]
s_add_u32 m0, s86, 149504
s_add_u32 s64, s85, 147456
v_exp_f32 v116, v116
v_mfma_f32_16x16x32_bf16 a[108:111], a[188:191], v[180:183], a[108:111]
s_waitcnt lgkmcnt(3)
buffer_load_dwordx4 v17, s[36:39], s64 offen lds
v_mfma_f32_16x16x32_bf16 a[80:83], a[192:195], v[176:179], a[80:83]
s_add_u32 m0, s86, 150528
s_add_u32 s64, s85, 155648
v_exp_f32 v117, v117
v_mfma_f32_16x16x32_bf16 a[112:115], a[192:195], v[180:183], a[112:115]
s_waitcnt lgkmcnt(2)
buffer_load_dwordx4 v18, s[36:39], s64 offen lds
v_mfma_f32_16x16x32_bf16 a[84:87], a[196:199], v[176:179], a[84:87]
s_add_u32 s65, s84, 16384
v_exp_f32 v118, v118
v_mfma_f32_16x16x32_bf16 a[116:119], a[196:199], v[180:183], a[116:119]
s_waitcnt lgkmcnt(1)
buffer_load_dwordx4 v[240:243], v16, s[44:47], s65 offen offset:0 sc1
v_mfma_f32_16x16x32_bf16 a[88:91], a[200:203], v[176:179], a[88:91]
v_exp_f32 v119, v119
v_mfma_f32_16x16x32_bf16 a[120:123], a[200:203], v[180:183], a[120:123]
s_waitcnt lgkmcnt(0)
buffer_load_dwordx4 v[244:247], v16, s[44:47], s65 offen offset:1024 sc1
v_mfma_f32_16x16x32_bf16 a[92:95], a[204:207], v[176:179], a[92:95]
s_add_u32 s65, s84, 24576
v_cvt_pk_bf16_f32 v165, v114, v115
v_cvt_pk_bf16_f32 v166, v116, v117
v_mfma_f32_16x16x32_bf16 a[124:127], a[204:207], v[180:183], a[124:127]
buffer_load_dwordx4 v[248:251], v16, s[44:47], s65 offen offset:0 sc1
v_mfma_f32_16x16x32_bf16 a[136:139], v[12:15], v[176:179], a[136:139]
v_cvt_pk_bf16_f32 v167, v118, v119
v_xor_b32 v3, 0x8000, v3
v_mfma_f32_16x16x32_bf16 a[140:143], v[12:15], v[180:183], a[140:143]
buffer_load_dwordx4 v[252:255], v16, s[44:47], s65 offen offset:1024 sc1
L_TAIL_12:
ds_read_b128 a[176:179], v3 offset:0
ds_read_b128 a[180:183], v3 offset:1024
ds_read_b128 a[184:187], v3 offset:2048
ds_read_b128 a[188:191], v3 offset:3072
ds_read_b128 a[192:195], v3 offset:4096
ds_read_b128 a[196:199], v3 offset:5120
ds_read_b128 a[200:203], v3 offset:6144
ds_read_b128 a[204:207], v3 offset:7168
ds_read_b128 a[144:147], v3 offset:8192
ds_read_b128 a[148:151], v3 offset:9216
ds_read_b128 a[152:155], v3 offset:10240
ds_read_b128 a[156:159], v3 offset:11264
ds_read_b128 a[160:163], v3 offset:12288
ds_read_b128 a[164:167], v3 offset:13312
ds_read_b128 a[168:171], v3 offset:14336
ds_read_b128 a[172:175], v3 offset:15360
v_exp_f32 v144, v144
v_exp_f32 v145, v145
v_exp_f32 v146, v146
v_exp_f32 v147, v147
v_exp_f32 v148, v148
v_exp_f32 v149, v149
v_exp_f32 v150, v150
v_exp_f32 v151, v151
v_cvt_pk_bf16_f32 v180, v144, v145
v_cvt_pk_bf16_f32 v181, v146, v147
v_cvt_pk_bf16_f32 v182, v148, v149
v_cvt_pk_bf16_f32 v183, v150, v151
v_mfma_f32_16x16x32_bf16 a[140:143], v[12:15], v[164:167], a[140:143]
s_waitcnt lgkmcnt(15)
v_mfma_f32_16x16x32_bf16 a[96:99], a[176:179], v[164:167], a[96:99]
s_waitcnt lgkmcnt(14)
v_mfma_f32_16x16x32_bf16 a[100:103], a[180:183], v[164:167], a[100:103]
s_waitcnt lgkmcnt(13)
v_mfma_f32_16x16x32_bf16 a[104:107], a[184:187], v[164:167], a[104:107]
s_waitcnt lgkmcnt(12)
v_mfma_f32_16x16x32_bf16 a[108:111], a[188:191], v[164:167], a[108:111]
s_waitcnt lgkmcnt(11)
v_mfma_f32_16x16x32_bf16 a[112:115], a[192:195], v[164:167], a[112:115]
s_waitcnt lgkmcnt(10)
v_mfma_f32_16x16x32_bf16 a[116:119], a[196:199], v[164:167], a[116:119]
s_waitcnt lgkmcnt(9)
v_mfma_f32_16x16x32_bf16 a[120:123], a[200:203], v[164:167], a[120:123]
s_waitcnt lgkmcnt(8)
v_mfma_f32_16x16x32_bf16 a[124:127], a[204:207], v[164:167], a[124:127]
v_mfma_f32_16x16x32_bf16 a[140:143], v[12:15], v[180:183], a[140:143]
s_waitcnt lgkmcnt(7)
v_mfma_f32_16x16x32_bf16 a[96:99], a[144:147], v[180:183], a[96:99]
s_waitcnt lgkmcnt(6)
v_mfma_f32_16x16x32_bf16 a[100:103], a[148:151], v[180:183], a[100:103]
s_waitcnt lgkmcnt(5)
v_mfma_f32_16x16x32_bf16 a[104:107], a[152:155], v[180:183], a[104:107]
s_waitcnt lgkmcnt(4)
v_mfma_f32_16x16x32_bf16 a[108:111], a[156:159], v[180:183], a[108:111]
s_waitcnt lgkmcnt(3)
v_mfma_f32_16x16x32_bf16 a[112:115], a[160:163], v[180:183], a[112:115]
s_waitcnt lgkmcnt(2)
v_mfma_f32_16x16x32_bf16 a[116:119], a[164:167], v[180:183], a[116:119]
s_waitcnt lgkmcnt(1)
v_mfma_f32_16x16x32_bf16 a[120:123], a[168:171], v[180:183], a[120:123]
s_waitcnt lgkmcnt(0)
v_mfma_f32_16x16x32_bf16 a[124:127], a[172:175], v[180:183], a[124:127]
v_accvgpr_read_b32 v22, a136
v_accvgpr_read_b32 v23, a140
v_max3_f32 v1, v1, v22, v23
v_rcp_f32 v22, v22
v_rcp_f32 v23, v23
s_mov_b32 s66, 0x5d800000
v_cmp_le_f32 vcc, s66, v1
s_lshl_b32 s67, s30, 2
s_cmp_lg_u64 vcc, 0
s_cselect_b32 s66, 1, 0
v_mov_b32 v96, s67
v_mov_b32 v97, s66
ds_write_b32 v96, v97
v_mul_f32 v22, v22, v8
v_mul_f32 v23, v23, v10
v_accvgpr_read_b32 v88, a64
v_accvgpr_read_b32 v89, a65
v_accvgpr_read_b32 v90, a66
v_accvgpr_read_b32 v91, a67
v_accvgpr_read_b32 v92, a68
v_accvgpr_read_b32 v93, a69
v_accvgpr_read_b32 v94, a70
v_accvgpr_read_b32 v95, a71
s_add_u32 s65, s75, 0
v_mul_f32 v88, v88, v22
v_mul_f32 v89, v89, v22
v_mul_f32 v90, v90, v22
v_mul_f32 v91, v91, v22
v_mul_f32 v92, v92, v22
v_mul_f32 v93, v93, v22
v_mul_f32 v94, v94, v22
v_mul_f32 v95, v95, v22
v_cvt_pk_bf16_f32 v88, v88, v89
v_cvt_pk_bf16_f32 v89, v90, v91
v_cvt_pk_bf16_f32 v90, v92, v93
v_cvt_pk_bf16_f32 v91, v94, v95
buffer_store_dwordx4 v[88:91], v16, s[44:47], s65 offen sc1
v_accvgpr_read_b32 v120, a72
v_accvgpr_read_b32 v121, a73
v_accvgpr_read_b32 v122, a74
v_accvgpr_read_b32 v123, a75
v_accvgpr_read_b32 v124, a76
v_accvgpr_read_b32 v125, a77
v_accvgpr_read_b32 v126, a78
v_accvgpr_read_b32 v127, a79
s_add_u32 s65, s75, 8192
v_mul_f32 v120, v120, v22
v_mul_f32 v121, v121, v22
v_mul_f32 v122, v122, v22
v_mul_f32 v123, v123, v22
v_mul_f32 v124, v124, v22
v_mul_f32 v125, v125, v22
v_mul_f32 v126, v126, v22
v_mul_f32 v127, v127, v22
v_cvt_pk_bf16_f32 v120, v120, v121
v_cvt_pk_bf16_f32 v121, v122, v123
v_cvt_pk_bf16_f32 v122, v124, v125
v_cvt_pk_bf16_f32 v123, v126, v127
buffer_store_dwordx4 v[120:123], v16, s[44:47], s65 offen sc1
v_accvgpr_read_b32 v88, a80
v_accvgpr_read_b32 v89, a81
v_accvgpr_read_b32 v90, a82
v_accvgpr_read_b32 v91, a83
v_accvgpr_read_b32 v92, a84
v_accvgpr_read_b32 v93, a85
v_accvgpr_read_b32 v94, a86
v_accvgpr_read_b32 v95, a87
s_add_u32 s65, s75, 16384
v_mul_f32 v88, v88, v22
v_mul_f32 v89, v89, v22
v_mul_f32 v90, v90, v22
v_mul_f32 v91, v91, v22
v_mul_f32 v92, v92, v22
v_mul_f32 v93, v93, v22
v_mul_f32 v94, v94, v22
v_mul_f32 v95, v95, v22
v_cvt_pk_bf16_f32 v88, v88, v89
v_cvt_pk_bf16_f32 v89, v90, v91
v_cvt_pk_bf16_f32 v90, v92, v93
v_cvt_pk_bf16_f32 v91, v94, v95
buffer_store_dwordx4 v[88:91], v16, s[44:47], s65 offen sc1
v_accvgpr_read_b32 v120, a88
v_accvgpr_read_b32 v121, a89
v_accvgpr_read_b32 v122, a90
v_accvgpr_read_b32 v123, a91
v_accvgpr_read_b32 v124, a92
v_accvgpr_read_b32 v125, a93
v_accvgpr_read_b32 v126, a94
v_accvgpr_read_b32 v127, a95
s_add_u32 s65, s75, 24576
v_mul_f32 v120, v120, v22
v_mul_f32 v121, v121, v22
v_mul_f32 v122, v122, v22
v_mul_f32 v123, v123, v22
v_mul_f32 v124, v124, v22
v_mul_f32 v125, v125, v22
v_mul_f32 v126, v126, v22
v_mul_f32 v127, v127, v22
v_cvt_pk_bf16_f32 v120, v120, v121
v_cvt_pk_bf16_f32 v121, v122, v123
v_cvt_pk_bf16_f32 v122, v124, v125
v_cvt_pk_bf16_f32 v123, v126, v127
buffer_store_dwordx4 v[120:123], v16, s[44:47], s65 offen sc1
v_accvgpr_read_b32 v88, a96
v_accvgpr_read_b32 v89, a97
v_accvgpr_read_b32 v90, a98
v_accvgpr_read_b32 v91, a99
v_accvgpr_read_b32 v92, a100
v_accvgpr_read_b32 v93, a101
v_accvgpr_read_b32 v94, a102
v_accvgpr_read_b32 v95, a103
s_add_u32 s65, s75, 4096
v_mul_f32 v88, v88, v23
v_mul_f32 v89, v89, v23
v_mul_f32 v90, v90, v23
v_mul_f32 v91, v91, v23
v_mul_f32 v92, v92, v23
v_mul_f32 v93, v93, v23
v_mul_f32 v94, v94, v23
v_mul_f32 v95, v95, v23
v_cvt_pk_bf16_f32 v88, v88, v89
v_cvt_pk_bf16_f32 v89, v90, v91
v_cvt_pk_bf16_f32 v90, v92, v93
v_cvt_pk_bf16_f32 v91, v94, v95
buffer_store_dwordx4 v[88:91], v16, s[44:47], s65 offen sc1
v_accvgpr_read_b32 v120, a104
v_accvgpr_read_b32 v121, a105
v_accvgpr_read_b32 v122, a106
v_accvgpr_read_b32 v123, a107
v_accvgpr_read_b32 v124, a108
v_accvgpr_read_b32 v125, a109
v_accvgpr_read_b32 v126, a110
v_accvgpr_read_b32 v127, a111
s_add_u32 s65, s75, 12288
v_mul_f32 v120, v120, v23
v_mul_f32 v121, v121, v23
v_mul_f32 v122, v122, v23
v_mul_f32 v123, v123, v23
v_mul_f32 v124, v124, v23
v_mul_f32 v125, v125, v23
v_mul_f32 v126, v126, v23
v_mul_f32 v127, v127, v23
v_cvt_pk_bf16_f32 v120, v120, v121
v_cvt_pk_bf16_f32 v121, v122, v123
v_cvt_pk_bf16_f32 v122, v124, v125
v_cvt_pk_bf16_f32 v123, v126, v127
buffer_store_dwordx4 v[120:123], v16, s[44:47], s65 offen sc1
v_accvgpr_read_b32 v88, a112
v_accvgpr_read_b32 v89, a113
v_accvgpr_read_b32 v90, a114
v_accvgpr_read_b32 v91, a115
v_accvgpr_read_b32 v92, a116
v_accvgpr_read_b32 v93, a117
v_accvgpr_read_b32 v94, a118
v_accvgpr_read_b32 v95, a119
s_add_u32 s65, s75, 20480
v_mul_f32 v88, v88, v23
v_mul_f32 v89, v89, v23
v_mul_f32 v90, v90, v23
v_mul_f32 v91, v91, v23
v_mul_f32 v92, v92, v23
v_mul_f32 v93, v93, v23
v_mul_f32 v94, v94, v23
v_mul_f32 v95, v95, v23
v_cvt_pk_bf16_f32 v88, v88, v89
v_cvt_pk_bf16_f32 v89, v90, v91
v_cvt_pk_bf16_f32 v90, v92, v93
v_cvt_pk_bf16_f32 v91, v94, v95
buffer_store_dwordx4 v[88:91], v16, s[44:47], s65 offen sc1
v_accvgpr_read_b32 v120, a120
v_accvgpr_read_b32 v121, a121
v_accvgpr_read_b32 v122, a122
v_accvgpr_read_b32 v123, a123
v_accvgpr_read_b32 v124, a124
v_accvgpr_read_b32 v125, a125
v_accvgpr_read_b32 v126, a126
v_accvgpr_read_b32 v127, a127
s_add_u32 s65, s75, 28672
v_mul_f32 v120, v120, v23
v_mul_f32 v121, v121, v23
v_mul_f32 v122, v122, v23
v_mul_f32 v123, v123, v23
v_mul_f32 v124, v124, v23
v_mul_f32 v125, v125, v23
v_mul_f32 v126, v126, v23
v_mul_f32 v127, v127, v23
v_cvt_pk_bf16_f32 v120, v120, v121
v_cvt_pk_bf16_f32 v121, v122, v123
v_cvt_pk_bf16_f32 v122, v124, v125
v_cvt_pk_bf16_f32 v123, v126, v127
buffer_store_dwordx4 v[120:123], v16, s[44:47], s65 offen sc1
v_mov_b32 v96, 0
s_waitcnt vmcnt(20) lgkmcnt(0)
s_barrier
ds_read_b128 v[100:103], v96
v_lshrrev_b32 v112, 4, v0
v_bfe_u32 v113, v0, 2, 2
v_lshl_add_u32 v114, v112, 2, v113
v_and_b32 v115, 3, v0
v_lshlrev_b32 v115, 3, v115
v_lshl_add_u32 v115, v114, 8, v115
v_add_u32 v115, 98304, v115
v_and_b32 v114, 7, v114
s_lshl_b32 s66, s83, 2
v_xor_b32 v114, s66, v114
v_xor_b32 v112, 0, v114
v_lshl_add_u32 v88, v112, 5, v115
v_xor_b32 v104, 0x10000, v88
v_xor_b32 v112, 1, v114
v_lshl_add_u32 v89, v112, 5, v115
v_xor_b32 v105, 0x10000, v89
v_xor_b32 v112, 2, v114
v_lshl_add_u32 v90, v112, 5, v115
v_xor_b32 v106, 0x10000, v90
v_xor_b32 v112, 3, v114
v_lshl_add_u32 v91, v112, 5, v115
v_xor_b32 v107, 0x10000, v91
v_xor_b32 v112, 4, v114
v_lshl_add_u32 v92, v112, 5, v115
v_xor_b32 v108, 0x10000, v92
v_xor_b32 v112, 5, v114
v_lshl_add_u32 v93, v112, 5, v115
v_xor_b32 v109, 0x10000, v93
v_xor_b32 v112, 6, v114
v_lshl_add_u32 v94, v112, 5, v115
v_xor_b32 v110, 0x10000, v94
v_xor_b32 v112, 7, v114
v_lshl_add_u32 v95, v112, 5, v115
v_xor_b32 v111, 0x10000, v95
s_waitcnt lgkmcnt(0)
v_or3_b32 v100, v100, v101, v102
v_or_b32 v100, v100, v103
s_nop 0
v_readfirstlane_b32 s66, v100
s_nop 0
s_cmp_gt_u32 s66, s73
s_cbranch_scc1 L_fallback_16
ds_read_b64_tr_b16 a[0:1], v88 offset:32768
ds_read_b64_tr_b16 a[2:3], v88 offset:36864
ds_read_b64_tr_b16 a[4:5], v89 offset:32768
ds_read_b64_tr_b16 a[6:7], v89 offset:36864
ds_read_b64_tr_b16 a[8:9], v90 offset:32768
ds_read_b64_tr_b16 a[10:11], v90 offset:36864
ds_read_b64_tr_b16 a[12:13], v91 offset:32768
ds_read_b64_tr_b16 a[14:15], v91 offset:36864
ds_read_b64_tr_b16 a[16:17], v92 offset:32768
ds_read_b64_tr_b16 a[18:19], v92 offset:36864
ds_read_b64_tr_b16 a[20:21], v93 offset:32768
ds_read_b64_tr_b16 a[22:23], v93 offset:36864
ds_read_b64_tr_b16 a[24:25], v94 offset:32768
ds_read_b64_tr_b16 a[26:27], v94 offset:36864
ds_read_b64_tr_b16 a[28:29], v95 offset:32768
ds_read_b64_tr_b16 a[30:31], v95 offset:36864
s_lshr_b32 s66, s31, 4
s_lshl1_add_u32 s66, s3, s66
s_lshl_b32 s71, s66, 8
s_sub_u32 s66, 15, s82
s_min_u32 s66, s66, s82
s_lshl1_add_u32 s66, s66, s83
s_lshl_b32 s72, s66, 8
s_add_u32 s52, s28, 59768832
s_addc_u32 s53, s29, 0
s_mov_b32 s54, 4096
s_mov_b32 s55, 0x20000
s_waitcnt lgkmcnt(14)
s_waitcnt vmcnt(19)
v_mfma_f32_16x16x32_bf16 v[24:27], a[0:3], v[224:227], 0
s_waitcnt vmcnt(18)
ds_read_b64_tr_b16 a[32:33], v88 offset:40960
v_mfma_f32_16x16x32_bf16 v[56:59], a[0:3], v[228:231], 0
s_waitcnt lgkmcnt(13)
ds_read_b64_tr_b16 a[34:35], v88 offset:45056
v_mfma_f32_16x16x32_bf16 v[28:31], a[4:7], v[224:227], 0
s_add_u32 s65, s84, 32768
ds_read_b64_tr_b16 a[36:37], v89 offset:40960
v_mfma_f32_16x16x32_bf16 v[60:63], a[4:7], v[228:231], 0
s_waitcnt lgkmcnt(13)
buffer_load_dwordx4 v[192:195], v16, s[44:47], s65 offen offset:0 sc1
v_mfma_f32_16x16x32_bf16 v[32:35], a[8:11], v[224:227], 0
ds_read_b64_tr_b16 a[38:39], v89 offset:45056
buffer_load_dwordx4 v[196:199], v16, s[44:47], s65 offen offset:1024 sc1
v_mfma_f32_16x16x32_bf16 v[64:67], a[8:11], v[228:231], 0
s_waitcnt lgkmcnt(12)
s_add_u32 s65, s84, 40960
ds_read_b64_tr_b16 a[40:41], v90 offset:40960
v_mfma_f32_16x16x32_bf16 v[36:39], a[12:15], v[224:227], 0
ds_read_b64_tr_b16 a[42:43], v90 offset:45056
ds_read_b64_tr_b16 a[44:45], v91 offset:40960
buffer_load_dwordx4 v[200:203], v16, s[44:47], s65 offen offset:0 sc1
v_mfma_f32_16x16x32_bf16 v[68:71], a[12:15], v[228:231], 0
s_waitcnt lgkmcnt(13)
ds_read_b64_tr_b16 a[46:47], v91 offset:45056
v_mfma_f32_16x16x32_bf16 v[40:43], a[16:19], v[224:227], 0
ds_read_b64_tr_b16 a[48:49], v92 offset:40960
buffer_load_dwordx4 v[204:207], v16, s[44:47], s65 offen offset:1024 sc1
v_mfma_f32_16x16x32_bf16 v[72:75], a[16:19], v[228:231], 0
s_waitcnt lgkmcnt(13)
s_add_u32 s65, s84, 49152
ds_read_b64_tr_b16 a[50:51], v92 offset:45056
v_mfma_f32_16x16x32_bf16 v[44:47], a[20:23], v[224:227], 0
ds_read_b64_tr_b16 a[52:53], v93 offset:40960
ds_read_b64_tr_b16 a[54:55], v93 offset:45056
buffer_load_dwordx4 v[208:211], v16, s[44:47], s65 offen offset:0 sc1
v_mfma_f32_16x16x32_bf16 v[76:79], a[20:23], v[228:231], 0
s_waitcnt lgkmcnt(14)
ds_read_b64_tr_b16 a[56:57], v94 offset:40960
v_mfma_f32_16x16x32_bf16 v[48:51], a[24:27], v[224:227], 0
ds_read_b64_tr_b16 a[58:59], v94 offset:45056
buffer_load_dwordx4 v[212:215], v16, s[44:47], s65 offen offset:1024 sc1
v_mfma_f32_16x16x32_bf16 v[80:83], a[24:27], v[228:231], 0
s_waitcnt lgkmcnt(14)
s_add_u32 s65, s84, 57344
ds_read_b64_tr_b16 a[60:61], v95 offset:40960
v_mfma_f32_16x16x32_bf16 v[52:55], a[28:31], v[224:227], 0
ds_read_b64_tr_b16 a[62:63], v95 offset:45056
buffer_load_dwordx4 v[216:219], v16, s[44:47], s65 offen offset:0 sc1
v_mfma_f32_16x16x32_bf16 v[84:87], a[28:31], v[228:231], 0
s_waitcnt vmcnt(19)
s_barrier
s_waitcnt lgkmcnt(14)
v_mfma_f32_16x16x32_bf16 v[24:27], a[32:35], v[232:235], v[24:27]
buffer_load_dwordx4 v[220:223], v16, s[44:47], s65 offen offset:1024 sc1
v_mfma_f32_16x16x32_bf16 v[56:59], a[32:35], v[236:239], v[56:59]
s_waitcnt lgkmcnt(12)
s_add_u32 m0, s86, 98304
s_add_u32 s64, s85, 262144
ds_read_b64_tr_b16 a[0:1], v88 offset:49152
v_mfma_f32_16x16x32_bf16 v[28:31], a[36:39], v[232:235], v[28:31]
ds_read_b64_tr_b16 a[2:3], v88 offset:53248
buffer_load_dwordx4 v17, s[36:39], s64 offen lds
v_mfma_f32_16x16x32_bf16 v[60:63], a[36:39], v[236:239], v[60:63]
s_waitcnt lgkmcnt(12)
ds_read_b64_tr_b16 a[4:5], v89 offset:49152
s_add_u32 m0, s86, 99328
s_add_u32 s64, s85, 270336
s_nop 0
buffer_load_dwordx4 v18, s[36:39], s64 offen lds
v_mfma_f32_16x16x32_bf16 v[32:35], a[40:43], v[232:235], v[32:35]
s_add_u32 m0, s86, 100352
s_add_u32 s64, s85, 278528
ds_read_b64_tr_b16 a[6:7], v89 offset:53248
v_mfma_f32_16x16x32_bf16 v[64:67], a[40:43], v[236:239], v[64:67]
s_waitcnt lgkmcnt(12)
ds_read_b64_tr_b16 a[8:9], v90 offset:49152
buffer_load_dwordx4 v17, s[36:39], s64 offen lds
v_mfma_f32_16x16x32_bf16 v[36:39], a[44:47], v[232:235], v[36:39]
s_add_u32 m0, s86, 101376
s_add_u32 s64, s85, 286720
ds_read_b64_tr_b16 a[10:11], v90 offset:53248
ds_read_b64_tr_b16 a[12:13], v91 offset:49152
v_mfma_f32_16x16x32_bf16 v[68:71], a[44:47], v[236:239], v[68:71]
s_waitcnt lgkmcnt(13)
ds_read_b64_tr_b16 a[14:15], v91 offset:53248
buffer_load_dwordx4 v18, s[36:39], s64 offen lds
v_mfma_f32_16x16x32_bf16 v[40:43], a[48:51], v[232:235], v[40:43]
s_add_u32 m0, s86, 114688
s_add_u32 s64, s85, 393216
ds_read_b64_tr_b16 a[16:17], v92 offset:49152
v_mfma_f32_16x16x32_bf16 v[72:75], a[48:51], v[236:239], v[72:75]
s_waitcnt lgkmcnt(13)
ds_read_b64_tr_b16 a[18:19], v92 offset:53248
buffer_load_dwordx4 v17, s[36:39], s64 offen lds
v_mfma_f32_16x16x32_bf16 v[44:47], a[52:55], v[232:235], v[44:47]
s_add_u32 m0, s86, 115712
s_add_u32 s64, s85, 401408
ds_read_b64_tr_b16 a[20:21], v93 offset:49152
ds_read_b64_tr_b16 a[22:23], v93 offset:53248
v_mfma_f32_16x16x32_bf16 v[76:79], a[52:55], v[236:239], v[76:79]
s_waitcnt lgkmcnt(14)
ds_read_b64_tr_b16 a[24:25], v94 offset:49152
buffer_load_dwordx4 v18, s[36:39], s64 offen lds
v_mfma_f32_16x16x32_bf16 v[48:51], a[56:59], v[232:235], v[48:51]
s_add_u32 m0, s86, 116736
s_add_u32 s64, s85, 409600
ds_read_b64_tr_b16 a[26:27], v94 offset:53248
v_mfma_f32_16x16x32_bf16 v[80:83], a[56:59], v[236:239], v[80:83]
s_waitcnt lgkmcnt(14)
ds_read_b64_tr_b16 a[28:29], v95 offset:49152
buffer_load_dwordx4 v17, s[36:39], s64 offen lds
v_mfma_f32_16x16x32_bf16 v[52:55], a[60:63], v[232:235], v[52:55]
s_add_u32 m0, s86, 117760
s_add_u32 s64, s85, 417792
ds_read_b64_tr_b16 a[30:31], v95 offset:53248
v_mfma_f32_16x16x32_bf16 v[84:87], a[60:63], v[236:239], v[84:87]
s_waitcnt vmcnt(26)
s_waitcnt lgkmcnt(14)
buffer_load_dwordx4 v18, s[36:39], s64 offen lds
v_mfma_f32_16x16x32_bf16 v[24:27], a[0:3], v[240:243], v[24:27]
s_waitcnt vmcnt(26)
ds_read_b64_tr_b16 a[32:33], v88 offset:57344
v_mfma_f32_16x16x32_bf16 v[56:59], a[0:3], v[244:247], v[56:59]
s_waitcnt lgkmcnt(13)
ds_read_b64_tr_b16 a[34:35], v88 offset:61440
v_mfma_f32_16x16x32_bf16 v[28:31], a[4:7], v[240:243], v[28:31]
s_add_u32 s65, s84, 65536
ds_read_b64_tr_b16 a[36:37], v89 offset:57344
v_mfma_f32_16x16x32_bf16 v[60:63], a[4:7], v[244:247], v[60:63]
s_waitcnt lgkmcnt(13)
buffer_load_dwordx4 v[224:227], v16, s[44:47], s65 offen offset:0 sc1
v_mfma_f32_16x16x32_bf16 v[32:35], a[8:11], v[240:243], v[32:35]
ds_read_b64_tr_b16 a[38:39], v89 offset:61440
v_mfma_f32_16x16x32_bf16 v[64:67], a[8:11], v[244:247], v[64:67]
s_waitcnt lgkmcnt(12)
ds_read_b64_tr_b16 a[40:41], v90 offset:57344
buffer_load_dwordx4 v[228:231], v16, s[44:47], s65 offen offset:1024 sc1
v_mfma_f32_16x16x32_bf16 v[36:39], a[12:15], v[240:243], v[36:39]
ds_read_b64_tr_b16 a[42:43], v90 offset:61440
ds_read_b64_tr_b16 a[44:45], v91 offset:57344
v_mfma_f32_16x16x32_bf16 v[68:71], a[12:15], v[244:247], v[68:71]
s_waitcnt lgkmcnt(13)
s_add_u32 s65, s84, 73728
ds_read_b64_tr_b16 a[46:47], v91 offset:61440
v_mfma_f32_16x16x32_bf16 v[40:43], a[16:19], v[240:243], v[40:43]
ds_read_b64_tr_b16 a[48:49], v92 offset:57344
buffer_load_dwordx4 v[232:235], v16, s[44:47], s65 offen offset:0 sc1
v_mfma_f32_16x16x32_bf16 v[72:75], a[16:19], v[244:247], v[72:75]
s_waitcnt lgkmcnt(13)
ds_read_b64_tr_b16 a[50:51], v92 offset:61440
v_mfma_f32_16x16x32_bf16 v[44:47], a[20:23], v[240:243], v[44:47]
ds_read_b64_tr_b16 a[52:53], v93 offset:57344
ds_read_b64_tr_b16 a[54:55], v93 offset:61440
buffer_load_dwordx4 v[236:239], v16, s[44:47], s65 offen offset:1024 sc1
v_mfma_f32_16x16x32_bf16 v[76:79], a[20:23], v[244:247], v[76:79]
s_waitcnt lgkmcnt(14)
s_lshl_b32 s66, s30, 30
s_add_u32 m0, s86, 65536
ds_read_b64_tr_b16 a[56:57], v94 offset:57344
v_mfma_f32_16x16x32_bf16 v[48:51], a[24:27], v[240:243], v[48:51]
s_add_u32 s64, s85, 524288
ds_read_b64_tr_b16 a[58:59], v94 offset:61440
v_lshl_add_u32 v1, v0, 24, s66
v_mfma_f32_16x16x32_bf16 v[80:83], a[24:27], v[244:247], v[80:83]
s_waitcnt lgkmcnt(14)
ds_read_b64_tr_b16 a[60:61], v95 offset:57344
buffer_load_dwordx4 v17, s[36:39], s64 offen lds
v_mfma_f32_16x16x32_bf16 v[52:55], a[28:31], v[240:243], v[52:55]
s_add_u32 m0, s86, 66560
s_add_u32 s64, s85, 532480
ds_read_b64_tr_b16 a[62:63], v95 offset:61440
v_mfma_f32_16x16x32_bf16 v[84:87], a[28:31], v[244:247], v[84:87]
s_waitcnt vmcnt(30)
s_waitcnt lgkmcnt(14)
buffer_load_dwordx4 v18, s[36:39], s64 offen lds
v_mfma_f32_16x16x32_bf16 v[24:27], a[32:35], v[248:251], v[24:27]
s_waitcnt vmcnt(10)
s_barrier
s_add_u32 m0, s86, 67584
v_mfma_f32_16x16x32_bf16 v[56:59], a[32:35], v[252:255], v[56:59]
s_waitcnt lgkmcnt(12)
s_add_u32 s64, s85, 540672
buffer_atomic_add a251, v1, s[52:55], s71 offen offset:0 sc1
v_mfma_f32_16x16x32_bf16 v[28:31], a[36:39], v[248:251], v[28:31]
ds_read_b64_tr_b16 a[0:1], v88 offset:0
ds_read_b64_tr_b16 a[2:3], v88 offset:4096
buffer_load_dwordx4 v17, s[36:39], s64 offen lds
v_mfma_f32_16x16x32_bf16 v[60:63], a[36:39], v[252:255], v[60:63]
s_waitcnt lgkmcnt(12)
s_add_u32 m0, s86, 68608
s_add_u32 s64, s85, 548864
ds_read_b64_tr_b16 a[4:5], v89 offset:0
v_mfma_f32_16x16x32_bf16 v[32:35], a[40:43], v[248:251], v[32:35]
ds_read_b64_tr_b16 a[6:7], v89 offset:4096
buffer_load_dwordx4 v18, s[36:39], s64 offen lds
v_mfma_f32_16x16x32_bf16 v[64:67], a[40:43], v[252:255], v[64:67]
s_waitcnt lgkmcnt(12)
s_add_u32 m0, s86, 81920
ds_read_b64_tr_b16 a[8:9], v90 offset:0
v_mfma_f32_16x16x32_bf16 v[36:39], a[44:47], v[248:251], v[36:39]
s_add_u32 s64, s85, 655360
ds_read_b64_tr_b16 a[10:11], v90 offset:4096
ds_read_b64_tr_b16 a[12:13], v91 offset:0
v_mfma_f32_16x16x32_bf16 v[68:71], a[44:47], v[252:255], v[68:71]
s_waitcnt lgkmcnt(13)
ds_read_b64_tr_b16 a[14:15], v91 offset:4096
buffer_load_dwordx4 v17, s[36:39], s64 offen lds
v_mfma_f32_16x16x32_bf16 v[40:43], a[48:51], v[248:251], v[40:43]
s_add_u32 m0, s86, 82944
s_add_u32 s64, s85, 663552
ds_read_b64_tr_b16 a[16:17], v92 offset:0
v_mfma_f32_16x16x32_bf16 v[72:75], a[48:51], v[252:255], v[72:75]
s_waitcnt lgkmcnt(13)
ds_read_b64_tr_b16 a[18:19], v92 offset:4096
buffer_load_dwordx4 v18, s[36:39], s64 offen lds
v_mfma_f32_16x16x32_bf16 v[44:47], a[52:55], v[248:251], v[44:47]
s_add_u32 m0, s86, 83968
ds_read_b64_tr_b16 a[20:21], v93 offset:0
ds_read_b64_tr_b16 a[22:23], v93 offset:4096
v_mfma_f32_16x16x32_bf16 v[76:79], a[52:55], v[252:255], v[76:79]
s_waitcnt lgkmcnt(14)
s_add_u32 s64, s85, 671744
ds_read_b64_tr_b16 a[24:25], v94 offset:0
v_mfma_f32_16x16x32_bf16 v[48:51], a[56:59], v[248:251], v[48:51]
ds_read_b64_tr_b16 a[26:27], v94 offset:4096
buffer_load_dwordx4 v17, s[36:39], s64 offen lds
v_mfma_f32_16x16x32_bf16 v[80:83], a[56:59], v[252:255], v[80:83]
s_waitcnt lgkmcnt(14)
s_add_u32 m0, s86, 84992
s_add_u32 s64, s85, 679936
ds_read_b64_tr_b16 a[28:29], v95 offset:0
v_mfma_f32_16x16x32_bf16 v[52:55], a[60:63], v[248:251], v[52:55]
ds_read_b64_tr_b16 a[30:31], v95 offset:4096
buffer_load_dwordx4 v18, s[36:39], s64 offen lds
v_mfma_f32_16x16x32_bf16 v[84:87], a[60:63], v[252:255], v[84:87]
s_waitcnt lgkmcnt(14)
v_mfma_f32_16x16x32_bf16 v[24:27], a[0:3], v[192:195], v[24:27]
ds_read_b64_tr_b16 a[32:33], v88 offset:8192
v_mfma_f32_16x16x32_bf16 v[56:59], a[0:3], v[196:199], v[56:59]
s_waitcnt lgkmcnt(13)
ds_read_b64_tr_b16 a[34:35], v88 offset:12288
v_mfma_f32_16x16x32_bf16 v[28:31], a[4:7], v[192:195], v[28:31]
s_add_u32 s65, s84, 81920
ds_read_b64_tr_b16 a[36:37], v89 offset:8192
v_mfma_f32_16x16x32_bf16 v[60:63], a[4:7], v[196:199], v[60:63]
s_waitcnt lgkmcnt(13)
buffer_load_dwordx4 v[240:243], v16, s[44:47], s65 offen offset:0 sc1
v_mfma_f32_16x16x32_bf16 v[32:35], a[8:11], v[192:195], v[32:35]
ds_read_b64_tr_b16 a[38:39], v89 offset:12288
v_mfma_f32_16x16x32_bf16 v[64:67], a[8:11], v[196:199], v[64:67]
s_waitcnt lgkmcnt(12)
ds_read_b64_tr_b16 a[40:41], v90 offset:8192
v_mfma_f32_16x16x32_bf16 v[36:39], a[12:15], v[192:195], v[36:39]
ds_read_b64_tr_b16 a[42:43], v90 offset:12288
ds_read_b64_tr_b16 a[44:45], v91 offset:8192
buffer_load_dwordx4 v[244:247], v16, s[44:47], s65 offen offset:1024 sc1
v_mfma_f32_16x16x32_bf16 v[68:71], a[12:15], v[196:199], v[68:71]
s_waitcnt lgkmcnt(13)
ds_read_b64_tr_b16 a[46:47], v91 offset:12288
v_mfma_f32_16x16x32_bf16 v[40:43], a[16:19], v[192:195], v[40:43]
ds_read_b64_tr_b16 a[48:49], v92 offset:8192
v_mfma_f32_16x16x32_bf16 v[72:75], a[16:19], v[196:199], v[72:75]
s_waitcnt lgkmcnt(13)
s_add_u32 s65, s84, 90112
ds_read_b64_tr_b16 a[50:51], v92 offset:12288
v_mfma_f32_16x16x32_bf16 v[44:47], a[20:23], v[192:195], v[44:47]
ds_read_b64_tr_b16 a[52:53], v93 offset:8192
ds_read_b64_tr_b16 a[54:55], v93 offset:12288
buffer_load_dwordx4 v[248:251], v16, s[44:47], s65 offen offset:0 sc1
v_mfma_f32_16x16x32_bf16 v[76:79], a[20:23], v[196:199], v[76:79]
s_waitcnt lgkmcnt(14)
ds_read_b64_tr_b16 a[56:57], v94 offset:8192
v_mfma_f32_16x16x32_bf16 v[48:51], a[24:27], v[192:195], v[48:51]
ds_read_b64_tr_b16 a[58:59], v94 offset:12288
v_mfma_f32_16x16x32_bf16 v[80:83], a[24:27], v[196:199], v[80:83]
s_waitcnt lgkmcnt(14)
ds_read_b64_tr_b16 a[60:61], v95 offset:8192
v_mfma_f32_16x16x32_bf16 v[52:55], a[28:31], v[192:195], v[52:55]
ds_read_b64_tr_b16 a[62:63], v95 offset:12288
buffer_load_dwordx4 v[252:255], v16, s[44:47], s65 offen offset:1024 sc1
v_mfma_f32_16x16x32_bf16 v[84:87], a[28:31], v[196:199], v[84:87]
s_waitcnt vmcnt(17)
s_barrier
s_waitcnt lgkmcnt(14)
v_mfma_f32_16x16x32_bf16 v[24:27], a[32:35], v[200:203], v[24:27]
s_add_u32 m0, s86, 32768
ds_read_b64_tr_b16 a[0:1], v88 offset:16384
v_mfma_f32_16x16x32_bf16 v[56:59], a[32:35], v[204:207], v[56:59]
s_waitcnt lgkmcnt(13)
s_add_u32 s64, s85, 786432
ds_read_b64_tr_b16 a[2:3], v88 offset:20480
v_mfma_f32_16x16x32_bf16 v[28:31], a[36:39], v[200:203], v[28:31]
buffer_load_dwordx4 v17, s[36:39], s64 offen lds
v_mfma_f32_16x16x32_bf16 v[60:63], a[36:39], v[204:207], v[60:63]
s_waitcnt lgkmcnt(12)
s_add_u32 m0, s86, 33792
ds_read_b64_tr_b16 a[4:5], v89 offset:16384
v_mfma_f32_16x16x32_bf16 v[32:35], a[40:43], v[200:203], v[32:35]
s_add_u32 s64, s85, 794624
ds_read_b64_tr_b16 a[6:7], v89 offset:20480
v_mfma_f32_16x16x32_bf16 v[64:67], a[40:43], v[204:207], v[64:67]
s_waitcnt lgkmcnt(12)
ds_read_b64_tr_b16 a[8:9], v90 offset:16384
buffer_load_dwordx4 v18, s[36:39], s64 offen lds
v_mfma_f32_16x16x32_bf16 v[36:39], a[44:47], v[200:203], v[36:39]
ds_read_b64_tr_b16 a[10:11], v90 offset:20480
ds_read_b64_tr_b16 a[12:13], v91 offset:16384
v_mfma_f32_16x16x32_bf16 v[68:71], a[44:47], v[204:207], v[68:71]
s_waitcnt lgkmcnt(13)
s_add_u32 m0, s86, 34816
ds_read_b64_tr_b16 a[14:15], v91 offset:20480
v_mfma_f32_16x16x32_bf16 v[40:43], a[48:51], v[200:203], v[40:43]
s_add_u32 s64, s85, 802816
ds_read_b64_tr_b16 a[16:17], v92 offset:16384
v_mfma_f32_16x16x32_bf16 v[72:75], a[48:51], v[204:207], v[72:75]
s_waitcnt lgkmcnt(13)
ds_read_b64_tr_b16 a[18:19], v92 offset:20480
buffer_load_dwordx4 v17, s[36:39], s64 offen lds
v_mfma_f32_16x16x32_bf16 v[44:47], a[52:55], v[200:203], v[44:47]
ds_read_b64_tr_b16 a[20:21], v93 offset:16384
ds_read_b64_tr_b16 a[22:23], v93 offset:20480
v_mfma_f32_16x16x32_bf16 v[76:79], a[52:55], v[204:207], v[76:79]
s_waitcnt lgkmcnt(14)
s_add_u32 m0, s86, 35840
ds_read_b64_tr_b16 a[24:25], v94 offset:16384
v_mfma_f32_16x16x32_bf16 v[48:51], a[56:59], v[200:203], v[48:51]
s_add_u32 s64, s85, 811008
ds_read_b64_tr_b16 a[26:27], v94 offset:20480
v_mfma_f32_16x16x32_bf16 v[80:83], a[56:59], v[204:207], v[80:83]
s_waitcnt lgkmcnt(14)
ds_read_b64_tr_b16 a[28:29], v95 offset:16384
buffer_load_dwordx4 v18, s[36:39], s64 offen lds
v_mfma_f32_16x16x32_bf16 v[52:55], a[60:63], v[200:203], v[52:55]
ds_read_b64_tr_b16 a[30:31], v95 offset:20480
v_mfma_f32_16x16x32_bf16 v[84:87], a[60:63], v[204:207], v[84:87]
s_waitcnt lgkmcnt(14)
v_mfma_f32_16x16x32_bf16 v[24:27], a[0:3], v[208:211], v[24:27]
ds_read_b64_tr_b16 a[32:33], v88 offset:24576
v_mfma_f32_16x16x32_bf16 v[56:59], a[0:3], v[212:215], v[56:59]
s_waitcnt lgkmcnt(13)
ds_read_b64_tr_b16 a[34:35], v88 offset:28672
v_mfma_f32_16x16x32_bf16 v[28:31], a[4:7], v[208:211], v[28:31]
s_add_u32 s65, s84, 98304
ds_read_b64_tr_b16 a[36:37], v89 offset:24576
v_mfma_f32_16x16x32_bf16 v[60:63], a[4:7], v[212:215], v[60:63]
s_waitcnt lgkmcnt(13)
buffer_load_dwordx4 v[192:195], v16, s[44:47], s65 offen offset:0 sc1
v_mfma_f32_16x16x32_bf16 v[32:35], a[8:11], v[208:211], v[32:35]
ds_read_b64_tr_b16 a[38:39], v89 offset:28672
v_mfma_f32_16x16x32_bf16 v[64:67], a[8:11], v[212:215], v[64:67]
s_waitcnt lgkmcnt(12)
ds_read_b64_tr_b16 a[40:41], v90 offset:24576
v_mfma_f32_16x16x32_bf16 v[36:39], a[12:15], v[208:211], v[36:39]
ds_read_b64_tr_b16 a[42:43], v90 offset:28672
ds_read_b64_tr_b16 a[44:45], v91 offset:24576
buffer_load_dwordx4 v[196:199], v16, s[44:47], s65 offen offset:1024 sc1
v_mfma_f32_16x16x32_bf16 v[68:71], a[12:15], v[212:215], v[68:71]
s_waitcnt lgkmcnt(13)
ds_read_b64_tr_b16 a[46:47], v91 offset:28672
v_mfma_f32_16x16x32_bf16 v[40:43], a[16:19], v[208:211], v[40:43]
ds_read_b64_tr_b16 a[48:49], v92 offset:24576
v_mfma_f32_16x16x32_bf16 v[72:75], a[16:19], v[212:215], v[72:75]
s_waitcnt lgkmcnt(13)
s_add_u32 s65, s84, 106496
ds_read_b64_tr_b16 a[50:51], v92 offset:28672
v_mfma_f32_16x16x32_bf16 v[44:47], a[20:23], v[208:211], v[44:47]
ds_read_b64_tr_b16 a[52:53], v93 offset:24576
ds_read_b64_tr_b16 a[54:55], v93 offset:28672
buffer_load_dwordx4 v[200:203], v16, s[44:47], s65 offen offset:0 sc1
v_mfma_f32_16x16x32_bf16 v[76:79], a[20:23], v[212:215], v[76:79]
s_waitcnt lgkmcnt(14)
ds_read_b64_tr_b16 a[56:57], v94 offset:24576
v_mfma_f32_16x16x32_bf16 v[48:51], a[24:27], v[208:211], v[48:51]
ds_read_b64_tr_b16 a[58:59], v94 offset:28672
v_mfma_f32_16x16x32_bf16 v[80:83], a[24:27], v[212:215], v[80:83]
s_waitcnt lgkmcnt(14)
ds_read_b64_tr_b16 a[60:61], v95 offset:24576
v_mfma_f32_16x16x32_bf16 v[52:55], a[28:31], v[208:211], v[52:55]
ds_read_b64_tr_b16 a[62:63], v95 offset:28672
buffer_load_dwordx4 v[204:207], v16, s[44:47], s65 offen offset:1024 sc1
v_mfma_f32_16x16x32_bf16 v[84:87], a[28:31], v[212:215], v[84:87]
s_waitcnt vmcnt(16)
s_barrier
s_waitcnt lgkmcnt(14)
v_mfma_f32_16x16x32_bf16 v[24:27], a[32:35], v[216:219], v[24:27]
s_add_u32 m0, s86, 49152
ds_read_b64_tr_b16 a[0:1], v104 offset:32768
v_mfma_f32_16x16x32_bf16 v[56:59], a[32:35], v[220:223], v[56:59]
s_waitcnt lgkmcnt(13)
s_add_u32 s64, s85, 917504
ds_read_b64_tr_b16 a[2:3], v104 offset:36864
v_mfma_f32_16x16x32_bf16 v[28:31], a[36:39], v[216:219], v[28:31]
buffer_load_dwordx4 v17, s[36:39], s64 offen lds
v_mfma_f32_16x16x32_bf16 v[60:63], a[36:39], v[220:223], v[60:63]
s_waitcnt lgkmcnt(12)
s_add_u32 m0, s86, 50176
ds_read_b64_tr_b16 a[4:5], v105 offset:32768
v_mfma_f32_16x16x32_bf16 v[32:35], a[40:43], v[216:219], v[32:35]
s_add_u32 s64, s85, 925696
ds_read_b64_tr_b16 a[6:7], v105 offset:36864
v_mfma_f32_16x16x32_bf16 v[64:67], a[40:43], v[220:223], v[64:67]
s_waitcnt lgkmcnt(12)
ds_read_b64_tr_b16 a[8:9], v106 offset:32768
buffer_load_dwordx4 v18, s[36:39], s64 offen lds
v_mfma_f32_16x16x32_bf16 v[36:39], a[44:47], v[216:219], v[36:39]
ds_read_b64_tr_b16 a[10:11], v106 offset:36864
ds_read_b64_tr_b16 a[12:13], v107 offset:32768
v_mfma_f32_16x16x32_bf16 v[68:71], a[44:47], v[220:223], v[68:71]
s_waitcnt lgkmcnt(13)
s_add_u32 m0, s86, 51200
ds_read_b64_tr_b16 a[14:15], v107 offset:36864
v_mfma_f32_16x16x32_bf16 v[40:43], a[48:51], v[216:219], v[40:43]
s_add_u32 s64, s85, 933888
ds_read_b64_tr_b16 a[16:17], v108 offset:32768
v_mfma_f32_16x16x32_bf16 v[72:75], a[48:51], v[220:223], v[72:75]
s_waitcnt lgkmcnt(13)
ds_read_b64_tr_b16 a[18:19], v108 offset:36864
buffer_load_dwordx4 v17, s[36:39], s64 offen lds
v_mfma_f32_16x16x32_bf16 v[44:47], a[52:55], v[216:219], v[44:47]
ds_read_b64_tr_b16 a[20:21], v109 offset:32768
ds_read_b64_tr_b16 a[22:23], v109 offset:36864
v_mfma_f32_16x16x32_bf16 v[76:79], a[52:55], v[220:223], v[76:79]
s_waitcnt lgkmcnt(14)
s_add_u32 m0, s86, 52224
ds_read_b64_tr_b16 a[24:25], v110 offset:32768
v_mfma_f32_16x16x32_bf16 v[48:51], a[56:59], v[216:219], v[48:51]
s_add_u32 s64, s85, 942080
ds_read_b64_tr_b16 a[26:27], v110 offset:36864
v_mfma_f32_16x16x32_bf16 v[80:83], a[56:59], v[220:223], v[80:83]
s_waitcnt lgkmcnt(14)
ds_read_b64_tr_b16 a[28:29], v111 offset:32768
buffer_load_dwordx4 v18, s[36:39], s64 offen lds
v_mfma_f32_16x16x32_bf16 v[52:55], a[60:63], v[216:219], v[52:55]
ds_read_b64_tr_b16 a[30:31], v111 offset:36864
v_mfma_f32_16x16x32_bf16 v[84:87], a[60:63], v[220:223], v[84:87]
s_waitcnt lgkmcnt(14)
v_mfma_f32_16x16x32_bf16 v[24:27], a[0:3], v[224:227], v[24:27]
s_mul_i32 s66, s83, 3145728
s_add_u32 s85, s85, s66
v_mfma_f32_16x16x32_bf16 v[56:59], a[0:3], v[228:231], v[56:59]
s_waitcnt lgkmcnt(12)
ds_read_b64_tr_b16 a[32:33], v104 offset:40960
v_mfma_f32_16x16x32_bf16 v[28:31], a[4:7], v[224:227], v[28:31]
ds_read_b64_tr_b16 a[34:35], v104 offset:45056
buffer_load_dword v19, off, s[52:55], s72 sc1
v_mfma_f32_16x16x32_bf16 v[60:63], a[4:7], v[228:231], v[60:63]
s_waitcnt lgkmcnt(12)
ds_read_b64_tr_b16 a[36:37], v105 offset:40960
s_add_u32 s65, s84, 114688
s_nop 0
buffer_load_dwordx4 v[208:211], v16, s[44:47], s65 offen offset:0 sc1
v_mfma_f32_16x16x32_bf16 v[32:35], a[8:11], v[224:227], v[32:35]
ds_read_b64_tr_b16 a[38:39], v105 offset:45056
v_mfma_f32_16x16x32_bf16 v[64:67], a[8:11], v[228:231], v[64:67]
s_waitcnt lgkmcnt(12)
ds_read_b64_tr_b16 a[40:41], v106 offset:40960
v_mfma_f32_16x16x32_bf16 v[36:39], a[12:15], v[224:227], v[36:39]
ds_read_b64_tr_b16 a[42:43], v106 offset:45056
ds_read_b64_tr_b16 a[44:45], v107 offset:40960
buffer_load_dwordx4 v[212:215], v16, s[44:47], s65 offen offset:1024 sc1
v_mfma_f32_16x16x32_bf16 v[68:71], a[12:15], v[228:231], v[68:71]
s_waitcnt lgkmcnt(13)
ds_read_b64_tr_b16 a[46:47], v107 offset:45056
v_mfma_f32_16x16x32_bf16 v[40:43], a[16:19], v[224:227], v[40:43]
ds_read_b64_tr_b16 a[48:49], v108 offset:40960
v_mfma_f32_16x16x32_bf16 v[72:75], a[16:19], v[228:231], v[72:75]
s_waitcnt lgkmcnt(13)
s_add_u32 s65, s84, 122880
ds_read_b64_tr_b16 a[50:51], v108 offset:45056
v_mfma_f32_16x16x32_bf16 v[44:47], a[20:23], v[224:227], v[44:47]
ds_read_b64_tr_b16 a[52:53], v109 offset:40960
ds_read_b64_tr_b16 a[54:55], v109 offset:45056
buffer_load_dwordx4 v[216:219], v16, s[44:47], s65 offen offset:0 sc1
v_mfma_f32_16x16x32_bf16 v[76:79], a[20:23], v[228:231], v[76:79]
s_waitcnt lgkmcnt(14)
ds_read_b64_tr_b16 a[56:57], v110 offset:40960
v_mfma_f32_16x16x32_bf16 v[48:51], a[24:27], v[224:227], v[48:51]
ds_read_b64_tr_b16 a[58:59], v110 offset:45056
v_mfma_f32_16x16x32_bf16 v[80:83], a[24:27], v[228:231], v[80:83]
s_waitcnt lgkmcnt(14)
ds_read_b64_tr_b16 a[60:61], v111 offset:40960
v_mfma_f32_16x16x32_bf16 v[52:55], a[28:31], v[224:227], v[52:55]
ds_read_b64_tr_b16 a[62:63], v111 offset:45056
buffer_load_dwordx4 v[220:223], v16, s[44:47], s65 offen offset:1024 sc1
v_mfma_f32_16x16x32_bf16 v[84:87], a[28:31], v[228:231], v[84:87]
s_waitcnt vmcnt(21)
s_barrier
s_waitcnt lgkmcnt(14)
v_mfma_f32_16x16x32_bf16 v[24:27], a[32:35], v[232:235], v[24:27]
s_add_u32 m0, s86, 131072
ds_read_b64_tr_b16 a[0:1], v104 offset:49152
v_mfma_f32_16x16x32_bf16 v[56:59], a[32:35], v[236:239], v[56:59]
s_waitcnt lgkmcnt(13)
s_add_u32 s64, s85, 0
ds_read_b64_tr_b16 a[2:3], v104 offset:53248
v_mfma_f32_16x16x32_bf16 v[28:31], a[36:39], v[232:235], v[28:31]
buffer_load_dwordx4 v17, s[40:43], s64 offen lds
v_mfma_f32_16x16x32_bf16 v[60:63], a[36:39], v[236:239], v[60:63]
s_waitcnt lgkmcnt(12)
s_add_u32 m0, s86, 132096
ds_read_b64_tr_b16 a[4:5], v105 offset:49152
v_mfma_f32_16x16x32_bf16 v[32:35], a[40:43], v[232:235], v[32:35]
s_add_u32 s64, s85, 8192
ds_read_b64_tr_b16 a[6:7], v105 offset:53248
v_mfma_f32_16x16x32_bf16 v[64:67], a[40:43], v[236:239], v[64:67]
s_waitcnt lgkmcnt(12)
ds_read_b64_tr_b16 a[8:9], v106 offset:49152
buffer_load_dwordx4 v18, s[40:43], s64 offen lds
v_mfma_f32_16x16x32_bf16 v[36:39], a[44:47], v[232:235], v[36:39]
ds_read_b64_tr_b16 a[10:11], v106 offset:53248
ds_read_b64_tr_b16 a[12:13], v107 offset:49152
v_mfma_f32_16x16x32_bf16 v[68:71], a[44:47], v[236:239], v[68:71]
s_waitcnt lgkmcnt(13)
s_add_u32 m0, s86, 133120
ds_read_b64_tr_b16 a[14:15], v107 offset:53248
v_mfma_f32_16x16x32_bf16 v[40:43], a[48:51], v[232:235], v[40:43]
s_add_u32 s64, s85, 16384
ds_read_b64_tr_b16 a[16:17], v108 offset:49152
v_mfma_f32_16x16x32_bf16 v[72:75], a[48:51], v[236:239], v[72:75]
s_waitcnt lgkmcnt(13)
ds_read_b64_tr_b16 a[18:19], v108 offset:53248
buffer_load_dwordx4 v17, s[40:43], s64 offen lds
v_mfma_f32_16x16x32_bf16 v[44:47], a[52:55], v[232:235], v[44:47]
ds_read_b64_tr_b16 a[20:21], v109 offset:49152
ds_read_b64_tr_b16 a[22:23], v109 offset:53248
v_mfma_f32_16x16x32_bf16 v[76:79], a[52:55], v[236:239], v[76:79]
s_waitcnt lgkmcnt(14)
s_add_u32 m0, s86, 134144
ds_read_b64_tr_b16 a[24:25], v110 offset:49152
v_mfma_f32_16x16x32_bf16 v[48:51], a[56:59], v[232:235], v[48:51]
s_add_u32 s64, s85, 24576
ds_read_b64_tr_b16 a[26:27], v110 offset:53248
v_mfma_f32_16x16x32_bf16 v[80:83], a[56:59], v[236:239], v[80:83]
s_waitcnt lgkmcnt(14)
ds_read_b64_tr_b16 a[28:29], v111 offset:49152
buffer_load_dwordx4 v18, s[40:43], s64 offen lds
v_mfma_f32_16x16x32_bf16 v[52:55], a[60:63], v[232:235], v[52:55]
ds_read_b64_tr_b16 a[30:31], v111 offset:53248
v_mfma_f32_16x16x32_bf16 v[84:87], a[60:63], v[236:239], v[84:87]
s_waitcnt vmcnt(24)
s_waitcnt lgkmcnt(14)
v_mfma_f32_16x16x32_bf16 v[24:27], a[0:3], v[240:243], v[24:27]
s_waitcnt vmcnt(8)
v_readfirstlane_b32 s66, v19
s_nop 0
s_cmp_lt_u32 s66, 16
s_cbranch_scc1 L_spin_2021
L_spinbk_2022:
s_mul_i32 s66, s83, 393216
s_add_u32 s84, s84, s66
s_sub_u32 s84, s84, 1048576
v_mfma_f32_16x16x32_bf16 v[56:59], a[0:3], v[244:247], v[56:59]
s_waitcnt lgkmcnt(12)
ds_read_b64_tr_b16 a[32:33], v104 offset:57344
v_mfma_f32_16x16x32_bf16 v[28:31], a[4:7], v[240:243], v[28:31]
s_add_u32 s65, s84, 0
ds_read_b64_tr_b16 a[34:35], v104 offset:61440
v_mfma_f32_16x16x32_bf16 v[60:63], a[4:7], v[244:247], v[60:63]
s_waitcnt lgkmcnt(12)
ds_read_b64_tr_b16 a[36:37], v105 offset:57344
buffer_load_dwordx4 v[224:227], v16, s[44:47], s65 offen offset:0 sc1
v_mfma_f32_16x16x32_bf16 v[32:35], a[8:11], v[240:243], v[32:35]
ds_read_b64_tr_b16 a[38:39], v105 offset:61440
v_mfma_f32_16x16x32_bf16 v[64:67], a[8:11], v[244:247], v[64:67]
s_waitcnt lgkmcnt(12)
ds_read_b64_tr_b16 a[40:41], v106 offset:57344
v_mfma_f32_16x16x32_bf16 v[36:39], a[12:15], v[240:243], v[36:39]
ds_read_b64_tr_b16 a[42:43], v106 offset:61440
ds_read_b64_tr_b16 a[44:45], v107 offset:57344
buffer_load_dwordx4 v[228:231], v16, s[44:47], s65 offen offset:1024 sc1
v_mfma_f32_16x16x32_bf16 v[68:71], a[12:15], v[244:247], v[68:71]
s_waitcnt lgkmcnt(13)
ds_read_b64_tr_b16 a[46:47], v107 offset:61440
v_mfma_f32_16x16x32_bf16 v[40:43], a[16:19], v[240:243], v[40:43]
ds_read_b64_tr_b16 a[48:49], v108 offset:57344
v_mfma_f32_16x16x32_bf16 v[72:75], a[16:19], v[244:247], v[72:75]
s_waitcnt lgkmcnt(13)
s_add_u32 s65, s84, 8192
ds_read_b64_tr_b16 a[50:51], v108 offset:61440
v_mfma_f32_16x16x32_bf16 v[44:47], a[20:23], v[240:243], v[44:47]
ds_read_b64_tr_b16 a[52:53], v109 offset:57344
ds_read_b64_tr_b16 a[54:55], v109 offset:61440
buffer_load_dwordx4 v[232:235], v16, s[44:47], s65 offen offset:0 sc1
v_mfma_f32_16x16x32_bf16 v[76:79], a[20:23], v[244:247], v[76:79]
s_waitcnt lgkmcnt(14)
ds_read_b64_tr_b16 a[56:57], v110 offset:57344
v_mfma_f32_16x16x32_bf16 v[48:51], a[24:27], v[240:243], v[48:51]
ds_read_b64_tr_b16 a[58:59], v110 offset:61440
v_mfma_f32_16x16x32_bf16 v[80:83], a[24:27], v[244:247], v[80:83]
s_waitcnt lgkmcnt(14)
ds_read_b64_tr_b16 a[60:61], v111 offset:57344
v_mfma_f32_16x16x32_bf16 v[52:55], a[28:31], v[240:243], v[52:55]
ds_read_b64_tr_b16 a[62:63], v111 offset:61440
buffer_load_dwordx4 v[236:239], v16, s[44:47], s65 offen offset:1024 sc1
v_mfma_f32_16x16x32_bf16 v[84:87], a[28:31], v[244:247], v[84:87]
s_barrier
s_waitcnt lgkmcnt(14)
v_mfma_f32_16x16x32_bf16 v[24:27], a[32:35], v[248:251], v[24:27]
s_add_u32 m0, s86, 147456
ds_read_b64_tr_b16 a[0:1], v104 offset:0
v_mfma_f32_16x16x32_bf16 v[56:59], a[32:35], v[252:255], v[56:59]
s_waitcnt lgkmcnt(13)
s_add_u32 s64, s85, 131072
ds_read_b64_tr_b16 a[2:3], v104 offset:4096
v_mfma_f32_16x16x32_bf16 v[28:31], a[36:39], v[248:251], v[28:31]
buffer_load_dwordx4 v17, s[40:43], s64 offen lds
v_mfma_f32_16x16x32_bf16 v[60:63], a[36:39], v[252:255], v[60:63]
s_waitcnt lgkmcnt(12)
s_add_u32 m0, s86, 148480
ds_read_b64_tr_b16 a[4:5], v105 offset:0
v_mfma_f32_16x16x32_bf16 v[32:35], a[40:43], v[248:251], v[32:35]
s_add_u32 s64, s85, 139264
ds_read_b64_tr_b16 a[6:7], v105 offset:4096
v_mfma_f32_16x16x32_bf16 v[64:67], a[40:43], v[252:255], v[64:67]
s_waitcnt lgkmcnt(12)
ds_read_b64_tr_b16 a[8:9], v106 offset:0
buffer_load_dwordx4 v18, s[40:43], s64 offen lds
v_mfma_f32_16x16x32_bf16 v[36:39], a[44:47], v[248:251], v[36:39]
ds_read_b64_tr_b16 a[10:11], v106 offset:4096
ds_read_b64_tr_b16 a[12:13], v107 offset:0
v_mfma_f32_16x16x32_bf16 v[68:71], a[44:47], v[252:255], v[68:71]
s_waitcnt lgkmcnt(13)
s_add_u32 m0, s86, 149504
ds_read_b64_tr_b16 a[14:15], v107 offset:4096
v_mfma_f32_16x16x32_bf16 v[40:43], a[48:51], v[248:251], v[40:43]
s_add_u32 s64, s85, 147456
ds_read_b64_tr_b16 a[16:17], v108 offset:0
v_mfma_f32_16x16x32_bf16 v[72:75], a[48:51], v[252:255], v[72:75]
s_waitcnt lgkmcnt(13)
ds_read_b64_tr_b16 a[18:19], v108 offset:4096
buffer_load_dwordx4 v17, s[40:43], s64 offen lds
v_mfma_f32_16x16x32_bf16 v[44:47], a[52:55], v[248:251], v[44:47]
ds_read_b64_tr_b16 a[20:21], v109 offset:0
ds_read_b64_tr_b16 a[22:23], v109 offset:4096
v_mfma_f32_16x16x32_bf16 v[76:79], a[52:55], v[252:255], v[76:79]
s_waitcnt lgkmcnt(14)
s_add_u32 m0, s86, 150528
ds_read_b64_tr_b16 a[24:25], v110 offset:0
v_mfma_f32_16x16x32_bf16 v[48:51], a[56:59], v[248:251], v[48:51]
s_add_u32 s64, s85, 155648
ds_read_b64_tr_b16 a[26:27], v110 offset:4096
v_mfma_f32_16x16x32_bf16 v[80:83], a[56:59], v[252:255], v[80:83]
s_waitcnt lgkmcnt(14)
ds_read_b64_tr_b16 a[28:29], v111 offset:0
buffer_load_dwordx4 v18, s[40:43], s64 offen lds
v_mfma_f32_16x16x32_bf16 v[52:55], a[60:63], v[248:251], v[52:55]
ds_read_b64_tr_b16 a[30:31], v111 offset:4096
v_mfma_f32_16x16x32_bf16 v[84:87], a[60:63], v[252:255], v[84:87]
s_waitcnt lgkmcnt(14)
v_mfma_f32_16x16x32_bf16 v[24:27], a[0:3], v[192:195], v[24:27]
ds_read_b64_tr_b16 a[32:33], v104 offset:8192
v_mfma_f32_16x16x32_bf16 v[56:59], a[0:3], v[196:199], v[56:59]
s_waitcnt lgkmcnt(13)
ds_read_b64_tr_b16 a[34:35], v104 offset:12288
v_mfma_f32_16x16x32_bf16 v[28:31], a[4:7], v[192:195], v[28:31]
s_add_u32 s65, s84, 16384
ds_read_b64_tr_b16 a[36:37], v105 offset:8192
v_mfma_f32_16x16x32_bf16 v[60:63], a[4:7], v[196:199], v[60:63]
s_waitcnt lgkmcnt(13)
buffer_load_dwordx4 v[240:243], v16, s[44:47], s65 offen offset:0 sc1
v_mfma_f32_16x16x32_bf16 v[32:35], a[8:11], v[192:195], v[32:35]
ds_read_b64_tr_b16 a[38:39], v105 offset:12288
v_mfma_f32_16x16x32_bf16 v[64:67], a[8:11], v[196:199], v[64:67]
s_waitcnt lgkmcnt(12)
ds_read_b64_tr_b16 a[40:41], v106 offset:8192
v_mfma_f32_16x16x32_bf16 v[36:39], a[12:15], v[192:195], v[36:39]
ds_read_b64_tr_b16 a[42:43], v106 offset:12288
ds_read_b64_tr_b16 a[44:45], v107 offset:8192
buffer_load_dwordx4 v[244:247], v16, s[44:47], s65 offen offset:1024 sc1
v_mfma_f32_16x16x32_bf16 v[68:71], a[12:15], v[196:199], v[68:71]
s_waitcnt lgkmcnt(13)
ds_read_b64_tr_b16 a[46:47], v107 offset:12288
v_mfma_f32_16x16x32_bf16 v[40:43], a[16:19], v[192:195], v[40:43]
ds_read_b64_tr_b16 a[48:49], v108 offset:8192
v_mfma_f32_16x16x32_bf16 v[72:75], a[16:19], v[196:199], v[72:75]
s_waitcnt lgkmcnt(13)
s_add_u32 s65, s84, 24576
ds_read_b64_tr_b16 a[50:51], v108 offset:12288
v_mfma_f32_16x16x32_bf16 v[44:47], a[20:23], v[192:195], v[44:47]
ds_read_b64_tr_b16 a[52:53], v109 offset:8192
ds_read_b64_tr_b16 a[54:55], v109 offset:12288
buffer_load_dwordx4 v[248:251], v16, s[44:47], s65 offen offset:0 sc1
v_mfma_f32_16x16x32_bf16 v[76:79], a[20:23], v[196:199], v[76:79]
s_waitcnt lgkmcnt(14)
ds_read_b64_tr_b16 a[56:57], v110 offset:8192
v_mfma_f32_16x16x32_bf16 v[48:51], a[24:27], v[192:195], v[48:51]
ds_read_b64_tr_b16 a[58:59], v110 offset:12288
v_mfma_f32_16x16x32_bf16 v[80:83], a[24:27], v[196:199], v[80:83]
s_waitcnt lgkmcnt(14)
ds_read_b64_tr_b16 a[60:61], v111 offset:8192
v_mfma_f32_16x16x32_bf16 v[52:55], a[28:31], v[192:195], v[52:55]
ds_read_b64_tr_b16 a[62:63], v111 offset:12288
buffer_load_dwordx4 v[252:255], v16, s[44:47], s65 offen offset:1024 sc1
v_mfma_f32_16x16x32_bf16 v[84:87], a[28:31], v[196:199], v[84:87]
s_barrier
s_waitcnt lgkmcnt(14)
v_mfma_f32_16x16x32_bf16 v[24:27], a[32:35], v[200:203], v[24:27]
s_add_u32 m0, s86, 98304
ds_read_b64_tr_b16 a[0:1], v104 offset:16384
v_mfma_f32_16x16x32_bf16 v[56:59], a[32:35], v[204:207], v[56:59]
s_waitcnt lgkmcnt(13)
s_add_u32 s64, s85, 262144
ds_read_b64_tr_b16 a[2:3], v104 offset:20480
v_mfma_f32_16x16x32_bf16 v[28:31], a[36:39], v[200:203], v[28:31]
buffer_load_dwordx4 v17, s[40:43], s64 offen lds
v_mfma_f32_16x16x32_bf16 v[60:63], a[36:39], v[204:207], v[60:63]
s_waitcnt lgkmcnt(12)
s_add_u32 m0, s86, 99328
ds_read_b64_tr_b16 a[4:5], v105 offset:16384
v_mfma_f32_16x16x32_bf16 v[32:35], a[40:43], v[200:203], v[32:35]
s_add_u32 s64, s85, 270336
ds_read_b64_tr_b16 a[6:7], v105 offset:20480
v_mfma_f32_16x16x32_bf16 v[64:67], a[40:43], v[204:207], v[64:67]
s_waitcnt lgkmcnt(12)
ds_read_b64_tr_b16 a[8:9], v106 offset:16384
buffer_load_dwordx4 v18, s[40:43], s64 offen lds
v_mfma_f32_16x16x32_bf16 v[36:39], a[44:47], v[200:203], v[36:39]
ds_read_b64_tr_b16 a[10:11], v106 offset:20480
ds_read_b64_tr_b16 a[12:13], v107 offset:16384
v_mfma_f32_16x16x32_bf16 v[68:71], a[44:47], v[204:207], v[68:71]
s_waitcnt lgkmcnt(13)
s_add_u32 m0, s86, 100352
ds_read_b64_tr_b16 a[14:15], v107 offset:20480
v_mfma_f32_16x16x32_bf16 v[40:43], a[48:51], v[200:203], v[40:43]
s_add_u32 s64, s85, 278528
ds_read_b64_tr_b16 a[16:17], v108 offset:16384
v_mfma_f32_16x16x32_bf16 v[72:75], a[48:51], v[204:207], v[72:75]
s_waitcnt lgkmcnt(13)
ds_read_b64_tr_b16 a[18:19], v108 offset:20480
buffer_load_dwordx4 v17, s[40:43], s64 offen lds
v_mfma_f32_16x16x32_bf16 v[44:47], a[52:55], v[200:203], v[44:47]
ds_read_b64_tr_b16 a[20:21], v109 offset:16384
ds_read_b64_tr_b16 a[22:23], v109 offset:20480
v_mfma_f32_16x16x32_bf16 v[76:79], a[52:55], v[204:207], v[76:79]
s_waitcnt lgkmcnt(14)
s_add_u32 m0, s86, 101376
ds_read_b64_tr_b16 a[24:25], v110 offset:16384
v_mfma_f32_16x16x32_bf16 v[48:51], a[56:59], v[200:203], v[48:51]
s_add_u32 s64, s85, 286720
ds_read_b64_tr_b16 a[26:27], v110 offset:20480
v_mfma_f32_16x16x32_bf16 v[80:83], a[56:59], v[204:207], v[80:83]
s_waitcnt lgkmcnt(14)
ds_read_b64_tr_b16 a[28:29], v111 offset:16384
buffer_load_dwordx4 v18, s[40:43], s64 offen lds
v_mfma_f32_16x16x32_bf16 v[52:55], a[60:63], v[200:203], v[52:55]
ds_read_b64_tr_b16 a[30:31], v111 offset:20480
v_mfma_f32_16x16x32_bf16 v[84:87], a[60:63], v[204:207], v[84:87]
s_waitcnt vmcnt(23)
s_waitcnt lgkmcnt(14)
v_mfma_f32_16x16x32_bf16 v[24:27], a[0:3], v[208:211], v[24:27]
s_waitcnt vmcnt(22)
ds_read_b64_tr_b16 a[32:33], v104 offset:24576
v_mfma_f32_16x16x32_bf16 v[56:59], a[0:3], v[212:215], v[56:59]
s_waitcnt lgkmcnt(13)
ds_read_b64_tr_b16 a[34:35], v104 offset:28672
v_mfma_f32_16x16x32_bf16 v[28:31], a[4:7], v[208:211], v[28:31]
s_add_u32 s65, s84, 32768
ds_read_b64_tr_b16 a[36:37], v105 offset:24576
v_mfma_f32_16x16x32_bf16 v[60:63], a[4:7], v[212:215], v[60:63]
s_waitcnt lgkmcnt(13)
buffer_load_dwordx4 v[192:195], v16, s[44:47], s65 offen offset:0 sc1
v_mfma_f32_16x16x32_bf16 v[32:35], a[8:11], v[208:211], v[32:35]
ds_read_b64_tr_b16 a[38:39], v105 offset:28672
v_mfma_f32_16x16x32_bf16 v[64:67], a[8:11], v[212:215], v[64:67]
s_waitcnt lgkmcnt(12)
ds_read_b64_tr_b16 a[40:41], v106 offset:24576
v_mfma_f32_16x16x32_bf16 v[36:39], a[12:15], v[208:211], v[36:39]
ds_read_b64_tr_b16 a[42:43], v106 offset:28672
ds_read_b64_tr_b16 a[44:45], v107 offset:24576
buffer_load_dwordx4 v[196:199], v16, s[44:47], s65 offen offset:1024 sc1
v_mfma_f32_16x16x32_bf16 v[68:71], a[12:15], v[212:215], v[68:71]
s_waitcnt lgkmcnt(13)
ds_read_b64_tr_b16 a[46:47], v107 offset:28672
v_mfma_f32_16x16x32_bf16 v[40:43], a[16:19], v[208:211], v[40:43]
ds_read_b64_tr_b16 a[48:49], v108 offset:24576
v_mfma_f32_16x16x32_bf16 v[72:75], a[16:19], v[212:215], v[72:75]
s_waitcnt lgkmcnt(13)
s_add_u32 s65, s84, 40960
ds_read_b64_tr_b16 a[50:51], v108 offset:28672
v_mfma_f32_16x16x32_bf16 v[44:47], a[20:23], v[208:211], v[44:47]
ds_read_b64_tr_b16 a[52:53], v109 offset:24576
ds_read_b64_tr_b16 a[54:55], v109 offset:28672
buffer_load_dwordx4 v[200:203], v16, s[44:47], s65 offen offset:0 sc1
v_mfma_f32_16x16x32_bf16 v[76:79], a[20:23], v[212:215], v[76:79]
s_waitcnt lgkmcnt(14)
ds_read_b64_tr_b16 a[56:57], v110 offset:24576
v_mfma_f32_16x16x32_bf16 v[48:51], a[24:27], v[208:211], v[48:51]
ds_read_b64_tr_b16 a[58:59], v110 offset:28672
v_mfma_f32_16x16x32_bf16 v[80:83], a[24:27], v[212:215], v[80:83]
s_waitcnt lgkmcnt(14)
ds_read_b64_tr_b16 a[60:61], v111 offset:24576
v_mfma_f32_16x16x32_bf16 v[52:55], a[28:31], v[208:211], v[52:55]
ds_read_b64_tr_b16 a[62:63], v111 offset:28672
buffer_load_dwordx4 v[204:207], v16, s[44:47], s65 offen offset:1024 sc1
v_mfma_f32_16x16x32_bf16 v[84:87], a[28:31], v[212:215], v[84:87]
s_waitcnt vmcnt(20)
s_barrier
s_waitcnt lgkmcnt(14)
v_mfma_f32_16x16x32_bf16 v[24:27], a[32:35], v[216:219], v[24:27]
s_add_u32 m0, s86, 114688
ds_read_b64_tr_b16 a[0:1], v88 offset:32768
v_mfma_f32_16x16x32_bf16 v[56:59], a[32:35], v[220:223], v[56:59]
s_waitcnt lgkmcnt(13)
s_add_u32 s64, s85, 393216
ds_read_b64_tr_b16 a[2:3], v88 offset:36864
v_mfma_f32_16x16x32_bf16 v[28:31], a[36:39], v[216:219], v[28:31]
buffer_load_dwordx4 v17, s[40:43], s64 offen lds
v_mfma_f32_16x16x32_bf16 v[60:63], a[36:39], v[220:223], v[60:63]
s_waitcnt lgkmcnt(12)
s_add_u32 m0, s86, 115712
ds_read_b64_tr_b16 a[4:5], v89 offset:32768
v_mfma_f32_16x16x32_bf16 v[32:35], a[40:43], v[216:219], v[32:35]
s_add_u32 s64, s85, 401408
ds_read_b64_tr_b16 a[6:7], v89 offset:36864
v_mfma_f32_16x16x32_bf16 v[64:67], a[40:43], v[220:223], v[64:67]
s_waitcnt lgkmcnt(12)
ds_read_b64_tr_b16 a[8:9], v90 offset:32768
buffer_load_dwordx4 v18, s[40:43], s64 offen lds
v_mfma_f32_16x16x32_bf16 v[36:39], a[44:47], v[216:219], v[36:39]
ds_read_b64_tr_b16 a[10:11], v90 offset:36864
ds_read_b64_tr_b16 a[12:13], v91 offset:32768
v_mfma_f32_16x16x32_bf16 v[68:71], a[44:47], v[220:223], v[68:71]
s_waitcnt lgkmcnt(13)
s_add_u32 m0, s86, 116736
ds_read_b64_tr_b16 a[14:15], v91 offset:36864
v_mfma_f32_16x16x32_bf16 v[40:43], a[48:51], v[216:219], v[40:43]
s_add_u32 s64, s85, 409600
ds_read_b64_tr_b16 a[16:17], v92 offset:32768
v_mfma_f32_16x16x32_bf16 v[72:75], a[48:51], v[220:223], v[72:75]
s_waitcnt lgkmcnt(13)
ds_read_b64_tr_b16 a[18:19], v92 offset:36864
buffer_load_dwordx4 v17, s[40:43], s64 offen lds
v_mfma_f32_16x16x32_bf16 v[44:47], a[52:55], v[216:219], v[44:47]
ds_read_b64_tr_b16 a[20:21], v93 offset:32768
ds_read_b64_tr_b16 a[22:23], v93 offset:36864
v_mfma_f32_16x16x32_bf16 v[76:79], a[52:55], v[220:223], v[76:79]
s_waitcnt lgkmcnt(14)
s_add_u32 m0, s86, 117760
ds_read_b64_tr_b16 a[24:25], v94 offset:32768
v_mfma_f32_16x16x32_bf16 v[48:51], a[56:59], v[216:219], v[48:51]
s_add_u32 s64, s85, 417792
ds_read_b64_tr_b16 a[26:27], v94 offset:36864
v_mfma_f32_16x16x32_bf16 v[80:83], a[56:59], v[220:223], v[80:83]
s_waitcnt lgkmcnt(14)
ds_read_b64_tr_b16 a[28:29], v95 offset:32768
buffer_load_dwordx4 v18, s[40:43], s64 offen lds
v_mfma_f32_16x16x32_bf16 v[52:55], a[60:63], v[216:219], v[52:55]
ds_read_b64_tr_b16 a[30:31], v95 offset:36864
v_mfma_f32_16x16x32_bf16 v[84:87], a[60:63], v[220:223], v[84:87]
s_mov_b32 s70, 3
.p2align 3
L_p5_2024:
s_waitcnt lgkmcnt(14)
s_waitcnt vmcnt(23)
v_mfma_f32_16x16x32_bf16 v[24:27], a[0:3], v[224:227], v[24:27]
s_waitcnt vmcnt(22)
ds_read_b64_tr_b16 a[32:33], v88 offset:40960
v_mfma_f32_16x16x32_bf16 v[56:59], a[0:3], v[228:231], v[56:59]
s_waitcnt lgkmcnt(13)
ds_read_b64_tr_b16 a[34:35], v88 offset:45056
v_mfma_f32_16x16x32_bf16 v[28:31], a[4:7], v[224:227], v[28:31]
s_add_u32 s65, s84, 49152
ds_read_b64_tr_b16 a[36:37], v89 offset:40960
v_mfma_f32_16x16x32_bf16 v[60:63], a[4:7], v[228:231], v[60:63]
s_waitcnt lgkmcnt(13)
buffer_load_dwordx4 v[208:211], v16, s[44:47], s65 offen offset:0 sc1
v_mfma_f32_16x16x32_bf16 v[32:35], a[8:11], v[224:227], v[32:35]
ds_read_b64_tr_b16 a[38:39], v89 offset:45056
v_mfma_f32_16x16x32_bf16 v[64:67], a[8:11], v[228:231], v[64:67]
s_waitcnt lgkmcnt(12)
ds_read_b64_tr_b16 a[40:41], v90 offset:40960
v_mfma_f32_16x16x32_bf16 v[36:39], a[12:15], v[224:227], v[36:39]
ds_read_b64_tr_b16 a[42:43], v90 offset:45056
ds_read_b64_tr_b16 a[44:45], v91 offset:40960
buffer_load_dwordx4 v[212:215], v16, s[44:47], s65 offen offset:1024 sc1
v_mfma_f32_16x16x32_bf16 v[68:71], a[12:15], v[228:231], v[68:71]
s_waitcnt lgkmcnt(13)
ds_read_b64_tr_b16 a[46:47], v91 offset:45056
v_mfma_f32_16x16x32_bf16 v[40:43], a[16:19], v[224:227], v[40:43]
ds_read_b64_tr_b16 a[48:49], v92 offset:40960
v_mfma_f32_16x16x32_bf16 v[72:75], a[16:19], v[228:231], v[72:75]
s_waitcnt lgkmcnt(13)
s_add_u32 s65, s84, 57344
ds_read_b64_tr_b16 a[50:51], v92 offset:45056
v_mfma_f32_16x16x32_bf16 v[44:47], a[20:23], v[224:227], v[44:47]
ds_read_b64_tr_b16 a[52:53], v93 offset:40960
ds_read_b64_tr_b16 a[54:55], v93 offset:45056
buffer_load_dwordx4 v[216:219], v16, s[44:47], s65 offen offset:0 sc1
v_mfma_f32_16x16x32_bf16 v[76:79], a[20:23], v[228:231], v[76:79]
s_waitcnt lgkmcnt(14)
ds_read_b64_tr_b16 a[56:57], v94 offset:40960
v_mfma_f32_16x16x32_bf16 v[48:51], a[24:27], v[224:227], v[48:51]
ds_read_b64_tr_b16 a[58:59], v94 offset:45056
v_mfma_f32_16x16x32_bf16 v[80:83], a[24:27], v[228:231], v[80:83]
s_waitcnt lgkmcnt(14)
ds_read_b64_tr_b16 a[60:61], v95 offset:40960
v_mfma_f32_16x16x32_bf16 v[52:55], a[28:31], v[224:227], v[52:55]
ds_read_b64_tr_b16 a[62:63], v95 offset:45056
buffer_load_dwordx4 v[220:223], v16, s[44:47], s65 offen offset:1024 sc1
v_mfma_f32_16x16x32_bf16 v[84:87], a[28:31], v[228:231], v[84:87]
s_waitcnt vmcnt(20)
s_barrier
s_waitcnt lgkmcnt(14)
v_mfma_f32_16x16x32_bf16 v[24:27], a[32:35], v[232:235], v[24:27]
s_add_u32 m0, s86, 65536
ds_read_b64_tr_b16 a[0:1], v88 offset:49152
v_mfma_f32_16x16x32_bf16 v[56:59], a[32:35], v[236:239], v[56:59]
s_waitcnt lgkmcnt(13)
s_add_u32 s64, s85, 524288
ds_read_b64_tr_b16 a[2:3], v88 offset:53248
v_mfma_f32_16x16x32_bf16 v[28:31], a[36:39], v[232:235], v[28:31]
buffer_load_dwordx4 v17, s[40:43], s64 offen lds
v_mfma_f32_16x16x32_bf16 v[60:63], a[36:39], v[236:239], v[60:63]
s_waitcnt lgkmcnt(12)
s_add_u32 m0, s86, 66560
ds_read_b64_tr_b16 a[4:5], v89 offset:49152
v_mfma_f32_16x16x32_bf16 v[32:35], a[40:43], v[232:235], v[32:35]
s_add_u32 s64, s85, 532480
ds_read_b64_tr_b16 a[6:7], v89 offset:53248
v_mfma_f32_16x16x32_bf16 v[64:67], a[40:43], v[236:239], v[64:67]
s_waitcnt lgkmcnt(12)
ds_read_b64_tr_b16 a[8:9], v90 offset:49152
buffer_load_dwordx4 v18, s[40:43], s64 offen lds
v_mfma_f32_16x16x32_bf16 v[36:39], a[44:47], v[232:235], v[36:39]
ds_read_b64_tr_b16 a[10:11], v90 offset:53248
ds_read_b64_tr_b16 a[12:13], v91 offset:49152
v_mfma_f32_16x16x32_bf16 v[68:71], a[44:47], v[236:239], v[68:71]
s_waitcnt lgkmcnt(13)
s_add_u32 m0, s86, 67584
ds_read_b64_tr_b16 a[14:15], v91 offset:53248
v_mfma_f32_16x16x32_bf16 v[40:43], a[48:51], v[232:235], v[40:43]
s_add_u32 s64, s85, 540672
ds_read_b64_tr_b16 a[16:17], v92 offset:49152
v_mfma_f32_16x16x32_bf16 v[72:75], a[48:51], v[236:239], v[72:75]
s_waitcnt lgkmcnt(13)
ds_read_b64_tr_b16 a[18:19], v92 offset:53248
buffer_load_dwordx4 v17, s[40:43], s64 offen lds
v_mfma_f32_16x16x32_bf16 v[44:47], a[52:55], v[232:235], v[44:47]
ds_read_b64_tr_b16 a[20:21], v93 offset:49152
ds_read_b64_tr_b16 a[22:23], v93 offset:53248
v_mfma_f32_16x16x32_bf16 v[76:79], a[52:55], v[236:239], v[76:79]
s_waitcnt lgkmcnt(14)
s_add_u32 m0, s86, 68608
ds_read_b64_tr_b16 a[24:25], v94 offset:49152
v_mfma_f32_16x16x32_bf16 v[48:51], a[56:59], v[232:235], v[48:51]
s_add_u32 s64, s85, 548864
ds_read_b64_tr_b16 a[26:27], v94 offset:53248
v_mfma_f32_16x16x32_bf16 v[80:83], a[56:59], v[236:239], v[80:83]
s_waitcnt lgkmcnt(14)
ds_read_b64_tr_b16 a[28:29], v95 offset:49152
buffer_load_dwordx4 v18, s[40:43], s64 offen lds
v_mfma_f32_16x16x32_bf16 v[52:55], a[60:63], v[232:235], v[52:55]
ds_read_b64_tr_b16 a[30:31], v95 offset:53248
v_mfma_f32_16x16x32_bf16 v[84:87], a[60:63], v[236:239], v[84:87]
s_waitcnt vmcnt(23)
s_waitcnt lgkmcnt(14)
v_mfma_f32_16x16x32_bf16 v[24:27], a[0:3], v[240:243], v[24:27]
s_waitcnt vmcnt(22)
ds_read_b64_tr_b16 a[32:33], v88 offset:57344
v_mfma_f32_16x16x32_bf16 v[56:59], a[0:3], v[244:247], v[56:59]
s_waitcnt lgkmcnt(13)
ds_read_b64_tr_b16 a[34:35], v88 offset:61440
v_mfma_f32_16x16x32_bf16 v[28:31], a[4:7], v[240:243], v[28:31]
s_add_u32 s65, s84, 65536
ds_read_b64_tr_b16 a[36:37], v89 offset:57344
v_mfma_f32_16x16x32_bf16 v[60:63], a[4:7], v[244:247], v[60:63]
s_waitcnt lgkmcnt(13)
buffer_load_dwordx4 v[224:227], v16, s[44:47], s65 offen offset:0 sc1
v_mfma_f32_16x16x32_bf16 v[32:35], a[8:11], v[240:243], v[32:35]
ds_read_b64_tr_b16 a[38:39], v89 offset:61440
v_mfma_f32_16x16x32_bf16 v[64:67], a[8:11], v[244:247], v[64:67]
s_waitcnt lgkmcnt(12)
ds_read_b64_tr_b16 a[40:41], v90 offset:57344
v_mfma_f32_16x16x32_bf16 v[36:39], a[12:15], v[240:243], v[36:39]
ds_read_b64_tr_b16 a[42:43], v90 offset:61440
ds_read_b64_tr_b16 a[44:45], v91 offset:57344
buffer_load_dwordx4 v[228:231], v16, s[44:47], s65 offen offset:1024 sc1
v_mfma_f32_16x16x32_bf16 v[68:71], a[12:15], v[244:247], v[68:71]
s_waitcnt lgkmcnt(13)
ds_read_b64_tr_b16 a[46:47], v91 offset:61440
v_mfma_f32_16x16x32_bf16 v[40:43], a[16:19], v[240:243], v[40:43]
ds_read_b64_tr_b16 a[48:49], v92 offset:57344
v_mfma_f32_16x16x32_bf16 v[72:75], a[16:19], v[244:247], v[72:75]
s_waitcnt lgkmcnt(13)
s_add_u32 s65, s84, 73728
ds_read_b64_tr_b16 a[50:51], v92 offset:61440
v_mfma_f32_16x16x32_bf16 v[44:47], a[20:23], v[240:243], v[44:47]
ds_read_b64_tr_b16 a[52:53], v93 offset:57344
ds_read_b64_tr_b16 a[54:55], v93 offset:61440
buffer_load_dwordx4 v[232:235], v16, s[44:47], s65 offen offset:0 sc1
v_mfma_f32_16x16x32_bf16 v[76:79], a[20:23], v[244:247], v[76:79]
s_waitcnt lgkmcnt(14)
ds_read_b64_tr_b16 a[56:57], v94 offset:57344
v_mfma_f32_16x16x32_bf16 v[48:51], a[24:27], v[240:243], v[48:51]
ds_read_b64_tr_b16 a[58:59], v94 offset:61440
v_mfma_f32_16x16x32_bf16 v[80:83], a[24:27], v[244:247], v[80:83]
s_waitcnt lgkmcnt(14)
ds_read_b64_tr_b16 a[60:61], v95 offset:57344
v_mfma_f32_16x16x32_bf16 v[52:55], a[28:31], v[240:243], v[52:55]
ds_read_b64_tr_b16 a[62:63], v95 offset:61440
buffer_load_dwordx4 v[236:239], v16, s[44:47], s65 offen offset:1024 sc1
v_mfma_f32_16x16x32_bf16 v[84:87], a[28:31], v[244:247], v[84:87]
s_waitcnt vmcnt(20)
s_barrier
s_waitcnt lgkmcnt(14)
v_mfma_f32_16x16x32_bf16 v[24:27], a[32:35], v[248:251], v[24:27]
s_add_u32 m0, s86, 81920
ds_read_b64_tr_b16 a[0:1], v88 offset:0
v_mfma_f32_16x16x32_bf16 v[56:59], a[32:35], v[252:255], v[56:59]
s_waitcnt lgkmcnt(13)
s_add_u32 s64, s85, 655360
ds_read_b64_tr_b16 a[2:3], v88 offset:4096
v_mfma_f32_16x16x32_bf16 v[28:31], a[36:39], v[248:251], v[28:31]
buffer_load_dwordx4 v17, s[40:43], s64 offen lds
v_mfma_f32_16x16x32_bf16 v[60:63], a[36:39], v[252:255], v[60:63]
s_waitcnt lgkmcnt(12)
s_add_u32 m0, s86, 82944
ds_read_b64_tr_b16 a[4:5], v89 offset:0
v_mfma_f32_16x16x32_bf16 v[32:35], a[40:43], v[248:251], v[32:35]
s_add_u32 s64, s85, 663552
ds_read_b64_tr_b16 a[6:7], v89 offset:4096
v_mfma_f32_16x16x32_bf16 v[64:67], a[40:43], v[252:255], v[64:67]
s_waitcnt lgkmcnt(12)
ds_read_b64_tr_b16 a[8:9], v90 offset:0
buffer_load_dwordx4 v18, s[40:43], s64 offen lds
v_mfma_f32_16x16x32_bf16 v[36:39], a[44:47], v[248:251], v[36:39]
ds_read_b64_tr_b16 a[10:11], v90 offset:4096
ds_read_b64_tr_b16 a[12:13], v91 offset:0
v_mfma_f32_16x16x32_bf16 v[68:71], a[44:47], v[252:255], v[68:71]
s_waitcnt lgkmcnt(13)
s_add_u32 m0, s86, 83968
ds_read_b64_tr_b16 a[14:15], v91 offset:4096
v_mfma_f32_16x16x32_bf16 v[40:43], a[48:51], v[248:251], v[40:43]
s_add_u32 s64, s85, 671744
ds_read_b64_tr_b16 a[16:17], v92 offset:0
v_mfma_f32_16x16x32_bf16 v[72:75], a[48:51], v[252:255], v[72:75]
s_waitcnt lgkmcnt(13)
ds_read_b64_tr_b16 a[18:19], v92 offset:4096
buffer_load_dwordx4 v17, s[40:43], s64 offen lds
v_mfma_f32_16x16x32_bf16 v[44:47], a[52:55], v[248:251], v[44:47]
ds_read_b64_tr_b16 a[20:21], v93 offset:0
ds_read_b64_tr_b16 a[22:23], v93 offset:4096
v_mfma_f32_16x16x32_bf16 v[76:79], a[52:55], v[252:255], v[76:79]
s_waitcnt lgkmcnt(14)
s_add_u32 m0, s86, 84992
ds_read_b64_tr_b16 a[24:25], v94 offset:0
v_mfma_f32_16x16x32_bf16 v[48:51], a[56:59], v[248:251], v[48:51]
s_add_u32 s64, s85, 679936
ds_read_b64_tr_b16 a[26:27], v94 offset:4096
v_mfma_f32_16x16x32_bf16 v[80:83], a[56:59], v[252:255], v[80:83]
s_waitcnt lgkmcnt(14)
ds_read_b64_tr_b16 a[28:29], v95 offset:0
buffer_load_dwordx4 v18, s[40:43], s64 offen lds
v_mfma_f32_16x16x32_bf16 v[52:55], a[60:63], v[248:251], v[52:55]
ds_read_b64_tr_b16 a[30:31], v95 offset:4096
v_mfma_f32_16x16x32_bf16 v[84:87], a[60:63], v[252:255], v[84:87]
s_waitcnt vmcnt(23)
s_waitcnt lgkmcnt(14)
v_mfma_f32_16x16x32_bf16 v[24:27], a[0:3], v[192:195], v[24:27]
s_waitcnt vmcnt(22)
ds_read_b64_tr_b16 a[32:33], v88 offset:8192
v_mfma_f32_16x16x32_bf16 v[56:59], a[0:3], v[196:199], v[56:59]
s_waitcnt lgkmcnt(13)
ds_read_b64_tr_b16 a[34:35], v88 offset:12288
v_mfma_f32_16x16x32_bf16 v[28:31], a[4:7], v[192:195], v[28:31]
s_add_u32 s65, s84, 81920
ds_read_b64_tr_b16 a[36:37], v89 offset:8192
v_mfma_f32_16x16x32_bf16 v[60:63], a[4:7], v[196:199], v[60:63]
s_waitcnt lgkmcnt(13)
buffer_load_dwordx4 v[240:243], v16, s[44:47], s65 offen offset:0 sc1
v_mfma_f32_16x16x32_bf16 v[32:35], a[8:11], v[192:195], v[32:35]
ds_read_b64_tr_b16 a[38:39], v89 offset:12288
v_mfma_f32_16x16x32_bf16 v[64:67], a[8:11], v[196:199], v[64:67]
s_waitcnt lgkmcnt(12)
ds_read_b64_tr_b16 a[40:41], v90 offset:8192
v_mfma_f32_16x16x32_bf16 v[36:39], a[12:15], v[192:195], v[36:39]
ds_read_b64_tr_b16 a[42:43], v90 offset:12288
ds_read_b64_tr_b16 a[44:45], v91 offset:8192
buffer_load_dwordx4 v[244:247], v16, s[44:47], s65 offen offset:1024 sc1
v_mfma_f32_16x16x32_bf16 v[68:71], a[12:15], v[196:199], v[68:71]
s_waitcnt lgkmcnt(13)
ds_read_b64_tr_b16 a[46:47], v91 offset:12288
v_mfma_f32_16x16x32_bf16 v[40:43], a[16:19], v[192:195], v[40:43]
ds_read_b64_tr_b16 a[48:49], v92 offset:8192
v_mfma_f32_16x16x32_bf16 v[72:75], a[16:19], v[196:199], v[72:75]
s_waitcnt lgkmcnt(13)
s_add_u32 s65, s84, 90112
ds_read_b64_tr_b16 a[50:51], v92 offset:12288
v_mfma_f32_16x16x32_bf16 v[44:47], a[20:23], v[192:195], v[44:47]
ds_read_b64_tr_b16 a[52:53], v93 offset:8192
ds_read_b64_tr_b16 a[54:55], v93 offset:12288
buffer_load_dwordx4 v[248:251], v16, s[44:47], s65 offen offset:0 sc1
v_mfma_f32_16x16x32_bf16 v[76:79], a[20:23], v[196:199], v[76:79]
s_waitcnt lgkmcnt(14)
ds_read_b64_tr_b16 a[56:57], v94 offset:8192
v_mfma_f32_16x16x32_bf16 v[48:51], a[24:27], v[192:195], v[48:51]
ds_read_b64_tr_b16 a[58:59], v94 offset:12288
v_mfma_f32_16x16x32_bf16 v[80:83], a[24:27], v[196:199], v[80:83]
s_waitcnt lgkmcnt(14)
ds_read_b64_tr_b16 a[60:61], v95 offset:8192
v_mfma_f32_16x16x32_bf16 v[52:55], a[28:31], v[192:195], v[52:55]
ds_read_b64_tr_b16 a[62:63], v95 offset:12288
buffer_load_dwordx4 v[252:255], v16, s[44:47], s65 offen offset:1024 sc1
v_mfma_f32_16x16x32_bf16 v[84:87], a[28:31], v[196:199], v[84:87]
s_waitcnt vmcnt(20)
s_barrier
s_waitcnt lgkmcnt(14)
v_mfma_f32_16x16x32_bf16 v[24:27], a[32:35], v[200:203], v[24:27]
s_add_u32 m0, s86, 32768
ds_read_b64_tr_b16 a[0:1], v88 offset:16384
v_mfma_f32_16x16x32_bf16 v[56:59], a[32:35], v[204:207], v[56:59]
s_waitcnt lgkmcnt(13)
s_add_u32 s64, s85, 786432
ds_read_b64_tr_b16 a[2:3], v88 offset:20480
v_mfma_f32_16x16x32_bf16 v[28:31], a[36:39], v[200:203], v[28:31]
buffer_load_dwordx4 v17, s[40:43], s64 offen lds
v_mfma_f32_16x16x32_bf16 v[60:63], a[36:39], v[204:207], v[60:63]
s_waitcnt lgkmcnt(12)
s_add_u32 m0, s86, 33792
ds_read_b64_tr_b16 a[4:5], v89 offset:16384
v_mfma_f32_16x16x32_bf16 v[32:35], a[40:43], v[200:203], v[32:35]
s_add_u32 s64, s85, 794624
ds_read_b64_tr_b16 a[6:7], v89 offset:20480
v_mfma_f32_16x16x32_bf16 v[64:67], a[40:43], v[204:207], v[64:67]
s_waitcnt lgkmcnt(12)
ds_read_b64_tr_b16 a[8:9], v90 offset:16384
buffer_load_dwordx4 v18, s[40:43], s64 offen lds
v_mfma_f32_16x16x32_bf16 v[36:39], a[44:47], v[200:203], v[36:39]
ds_read_b64_tr_b16 a[10:11], v90 offset:20480
ds_read_b64_tr_b16 a[12:13], v91 offset:16384
v_mfma_f32_16x16x32_bf16 v[68:71], a[44:47], v[204:207], v[68:71]
s_waitcnt lgkmcnt(13)
s_add_u32 m0, s86, 34816
ds_read_b64_tr_b16 a[14:15], v91 offset:20480
v_mfma_f32_16x16x32_bf16 v[40:43], a[48:51], v[200:203], v[40:43]
s_add_u32 s64, s85, 802816
ds_read_b64_tr_b16 a[16:17], v92 offset:16384
v_mfma_f32_16x16x32_bf16 v[72:75], a[48:51], v[204:207], v[72:75]
s_waitcnt lgkmcnt(13)
ds_read_b64_tr_b16 a[18:19], v92 offset:20480
buffer_load_dwordx4 v17, s[40:43], s64 offen lds
v_mfma_f32_16x16x32_bf16 v[44:47], a[52:55], v[200:203], v[44:47]
ds_read_b64_tr_b16 a[20:21], v93 offset:16384
ds_read_b64_tr_b16 a[22:23], v93 offset:20480
v_mfma_f32_16x16x32_bf16 v[76:79], a[52:55], v[204:207], v[76:79]
s_waitcnt lgkmcnt(14)
s_add_u32 m0, s86, 35840
ds_read_b64_tr_b16 a[24:25], v94 offset:16384
v_mfma_f32_16x16x32_bf16 v[48:51], a[56:59], v[200:203], v[48:51]
s_add_u32 s64, s85, 811008
ds_read_b64_tr_b16 a[26:27], v94 offset:20480
v_mfma_f32_16x16x32_bf16 v[80:83], a[56:59], v[204:207], v[80:83]
s_waitcnt lgkmcnt(14)
ds_read_b64_tr_b16 a[28:29], v95 offset:16384
buffer_load_dwordx4 v18, s[40:43], s64 offen lds
v_mfma_f32_16x16x32_bf16 v[52:55], a[60:63], v[200:203], v[52:55]
ds_read_b64_tr_b16 a[30:31], v95 offset:20480
v_mfma_f32_16x16x32_bf16 v[84:87], a[60:63], v[204:207], v[84:87]
s_waitcnt vmcnt(23)
s_waitcnt lgkmcnt(14)
v_mfma_f32_16x16x32_bf16 v[24:27], a[0:3], v[208:211], v[24:27]
s_waitcnt vmcnt(22)
ds_read_b64_tr_b16 a[32:33], v88 offset:24576
v_mfma_f32_16x16x32_bf16 v[56:59], a[0:3], v[212:215], v[56:59]
s_waitcnt lgkmcnt(13)
ds_read_b64_tr_b16 a[34:35], v88 offset:28672
v_mfma_f32_16x16x32_bf16 v[28:31], a[4:7], v[208:211], v[28:31]
s_add_u32 s65, s84, 98304
ds_read_b64_tr_b16 a[36:37], v89 offset:24576
v_mfma_f32_16x16x32_bf16 v[60:63], a[4:7], v[212:215], v[60:63]
s_waitcnt lgkmcnt(13)
buffer_load_dwordx4 v[192:195], v16, s[44:47], s65 offen offset:0 sc1
v_mfma_f32_16x16x32_bf16 v[32:35], a[8:11], v[208:211], v[32:35]
ds_read_b64_tr_b16 a[38:39], v89 offset:28672
v_mfma_f32_16x16x32_bf16 v[64:67], a[8:11], v[212:215], v[64:67]
s_waitcnt lgkmcnt(12)
ds_read_b64_tr_b16 a[40:41], v90 offset:24576
v_mfma_f32_16x16x32_bf16 v[36:39], a[12:15], v[208:211], v[36:39]
ds_read_b64_tr_b16 a[42:43], v90 offset:28672
ds_read_b64_tr_b16 a[44:45], v91 offset:24576
buffer_load_dwordx4 v[196:199], v16, s[44:47], s65 offen offset:1024 sc1
v_mfma_f32_16x16x32_bf16 v[68:71], a[12:15], v[212:215], v[68:71]
s_waitcnt lgkmcnt(13)
ds_read_b64_tr_b16 a[46:47], v91 offset:28672
v_mfma_f32_16x16x32_bf16 v[40:43], a[16:19], v[208:211], v[40:43]
ds_read_b64_tr_b16 a[48:49], v92 offset:24576
v_mfma_f32_16x16x32_bf16 v[72:75], a[16:19], v[212:215], v[72:75]
s_waitcnt lgkmcnt(13)
s_add_u32 s65, s84, 106496
ds_read_b64_tr_b16 a[50:51], v92 offset:28672
v_mfma_f32_16x16x32_bf16 v[44:47], a[20:23], v[208:211], v[44:47]
ds_read_b64_tr_b16 a[52:53], v93 offset:24576
ds_read_b64_tr_b16 a[54:55], v93 offset:28672
buffer_load_dwordx4 v[200:203], v16, s[44:47], s65 offen offset:0 sc1
v_mfma_f32_16x16x32_bf16 v[76:79], a[20:23], v[212:215], v[76:79]
s_waitcnt lgkmcnt(14)
ds_read_b64_tr_b16 a[56:57], v94 offset:24576
v_mfma_f32_16x16x32_bf16 v[48:51], a[24:27], v[208:211], v[48:51]
ds_read_b64_tr_b16 a[58:59], v94 offset:28672
v_mfma_f32_16x16x32_bf16 v[80:83], a[24:27], v[212:215], v[80:83]
s_waitcnt lgkmcnt(14)
ds_read_b64_tr_b16 a[60:61], v95 offset:24576
v_mfma_f32_16x16x32_bf16 v[52:55], a[28:31], v[208:211], v[52:55]
ds_read_b64_tr_b16 a[62:63], v95 offset:28672
buffer_load_dwordx4 v[204:207], v16, s[44:47], s65 offen offset:1024 sc1
v_mfma_f32_16x16x32_bf16 v[84:87], a[28:31], v[212:215], v[84:87]
s_waitcnt vmcnt(20)
s_barrier
s_waitcnt lgkmcnt(14)
v_mfma_f32_16x16x32_bf16 v[24:27], a[32:35], v[216:219], v[24:27]
s_add_u32 m0, s86, 49152
ds_read_b64_tr_b16 a[0:1], v104 offset:32768
v_mfma_f32_16x16x32_bf16 v[56:59], a[32:35], v[220:223], v[56:59]
s_waitcnt lgkmcnt(13)
s_add_u32 s64, s85, 917504
ds_read_b64_tr_b16 a[2:3], v104 offset:36864
v_mfma_f32_16x16x32_bf16 v[28:31], a[36:39], v[216:219], v[28:31]
buffer_load_dwordx4 v17, s[40:43], s64 offen lds
v_mfma_f32_16x16x32_bf16 v[60:63], a[36:39], v[220:223], v[60:63]
s_waitcnt lgkmcnt(12)
s_add_u32 m0, s86, 50176
ds_read_b64_tr_b16 a[4:5], v105 offset:32768
v_mfma_f32_16x16x32_bf16 v[32:35], a[40:43], v[216:219], v[32:35]
s_add_u32 s64, s85, 925696
ds_read_b64_tr_b16 a[6:7], v105 offset:36864
v_mfma_f32_16x16x32_bf16 v[64:67], a[40:43], v[220:223], v[64:67]
s_waitcnt lgkmcnt(12)
ds_read_b64_tr_b16 a[8:9], v106 offset:32768
buffer_load_dwordx4 v18, s[40:43], s64 offen lds
v_mfma_f32_16x16x32_bf16 v[36:39], a[44:47], v[216:219], v[36:39]
ds_read_b64_tr_b16 a[10:11], v106 offset:36864
ds_read_b64_tr_b16 a[12:13], v107 offset:32768
v_mfma_f32_16x16x32_bf16 v[68:71], a[44:47], v[220:223], v[68:71]
s_waitcnt lgkmcnt(13)
s_add_u32 m0, s86, 51200
ds_read_b64_tr_b16 a[14:15], v107 offset:36864
v_mfma_f32_16x16x32_bf16 v[40:43], a[48:51], v[216:219], v[40:43]
s_add_u32 s64, s85, 933888
ds_read_b64_tr_b16 a[16:17], v108 offset:32768
v_mfma_f32_16x16x32_bf16 v[72:75], a[48:51], v[220:223], v[72:75]
s_waitcnt lgkmcnt(13)
ds_read_b64_tr_b16 a[18:19], v108 offset:36864
buffer_load_dwordx4 v17, s[40:43], s64 offen lds
v_mfma_f32_16x16x32_bf16 v[44:47], a[52:55], v[216:219], v[44:47]
ds_read_b64_tr_b16 a[20:21], v109 offset:32768
ds_read_b64_tr_b16 a[22:23], v109 offset:36864
v_mfma_f32_16x16x32_bf16 v[76:79], a[52:55], v[220:223], v[76:79]
s_waitcnt lgkmcnt(14)
s_add_u32 m0, s86, 52224
ds_read_b64_tr_b16 a[24:25], v110 offset:32768
v_mfma_f32_16x16x32_bf16 v[48:51], a[56:59], v[216:219], v[48:51]
s_add_u32 s64, s85, 942080
ds_read_b64_tr_b16 a[26:27], v110 offset:36864
v_mfma_f32_16x16x32_bf16 v[80:83], a[56:59], v[220:223], v[80:83]
s_waitcnt lgkmcnt(14)
ds_read_b64_tr_b16 a[28:29], v111 offset:32768
buffer_load_dwordx4 v18, s[40:43], s64 offen lds
v_mfma_f32_16x16x32_bf16 v[52:55], a[60:63], v[216:219], v[52:55]
ds_read_b64_tr_b16 a[30:31], v111 offset:36864
v_mfma_f32_16x16x32_bf16 v[84:87], a[60:63], v[220:223], v[84:87]
s_waitcnt vmcnt(23)
s_waitcnt lgkmcnt(14)
v_mfma_f32_16x16x32_bf16 v[24:27], a[0:3], v[224:227], v[24:27]
s_waitcnt vmcnt(22)
ds_read_b64_tr_b16 a[32:33], v104 offset:40960
v_mfma_f32_16x16x32_bf16 v[56:59], a[0:3], v[228:231], v[56:59]
s_waitcnt lgkmcnt(13)
ds_read_b64_tr_b16 a[34:35], v104 offset:45056
v_mfma_f32_16x16x32_bf16 v[28:31], a[4:7], v[224:227], v[28:31]
s_add_u32 s65, s84, 114688
ds_read_b64_tr_b16 a[36:37], v105 offset:40960
v_mfma_f32_16x16x32_bf16 v[60:63], a[4:7], v[228:231], v[60:63]
s_waitcnt lgkmcnt(13)
buffer_load_dwordx4 v[208:211], v16, s[44:47], s65 offen offset:0 sc1
v_mfma_f32_16x16x32_bf16 v[32:35], a[8:11], v[224:227], v[32:35]
ds_read_b64_tr_b16 a[38:39], v105 offset:45056
v_mfma_f32_16x16x32_bf16 v[64:67], a[8:11], v[228:231], v[64:67]
s_waitcnt lgkmcnt(12)
ds_read_b64_tr_b16 a[40:41], v106 offset:40960
v_mfma_f32_16x16x32_bf16 v[36:39], a[12:15], v[224:227], v[36:39]
ds_read_b64_tr_b16 a[42:43], v106 offset:45056
ds_read_b64_tr_b16 a[44:45], v107 offset:40960
buffer_load_dwordx4 v[212:215], v16, s[44:47], s65 offen offset:1024 sc1
v_mfma_f32_16x16x32_bf16 v[68:71], a[12:15], v[228:231], v[68:71]
s_waitcnt lgkmcnt(13)
ds_read_b64_tr_b16 a[46:47], v107 offset:45056
v_mfma_f32_16x16x32_bf16 v[40:43], a[16:19], v[224:227], v[40:43]
ds_read_b64_tr_b16 a[48:49], v108 offset:40960
v_mfma_f32_16x16x32_bf16 v[72:75], a[16:19], v[228:231], v[72:75]
s_waitcnt lgkmcnt(13)
s_add_u32 s65, s84, 122880
ds_read_b64_tr_b16 a[50:51], v108 offset:45056
v_mfma_f32_16x16x32_bf16 v[44:47], a[20:23], v[224:227], v[44:47]
ds_read_b64_tr_b16 a[52:53], v109 offset:40960
ds_read_b64_tr_b16 a[54:55], v109 offset:45056
buffer_load_dwordx4 v[216:219], v16, s[44:47], s65 offen offset:0 sc1
v_mfma_f32_16x16x32_bf16 v[76:79], a[20:23], v[228:231], v[76:79]
s_waitcnt lgkmcnt(14)
ds_read_b64_tr_b16 a[56:57], v110 offset:40960
v_mfma_f32_16x16x32_bf16 v[48:51], a[24:27], v[224:227], v[48:51]
ds_read_b64_tr_b16 a[58:59], v110 offset:45056
v_mfma_f32_16x16x32_bf16 v[80:83], a[24:27], v[228:231], v[80:83]
s_waitcnt lgkmcnt(14)
ds_read_b64_tr_b16 a[60:61], v111 offset:40960
v_mfma_f32_16x16x32_bf16 v[52:55], a[28:31], v[224:227], v[52:55]
ds_read_b64_tr_b16 a[62:63], v111 offset:45056
buffer_load_dwordx4 v[220:223], v16, s[44:47], s65 offen offset:1024 sc1
v_mfma_f32_16x16x32_bf16 v[84:87], a[28:31], v[228:231], v[84:87]
s_waitcnt vmcnt(20)
s_barrier
s_waitcnt lgkmcnt(14)
v_mfma_f32_16x16x32_bf16 v[24:27], a[32:35], v[232:235], v[24:27]
s_add_u32 m0, s86, 131072
ds_read_b64_tr_b16 a[0:1], v104 offset:49152
v_mfma_f32_16x16x32_bf16 v[56:59], a[32:35], v[236:239], v[56:59]
s_waitcnt lgkmcnt(13)
s_add_u32 s64, s85, 1048576
ds_read_b64_tr_b16 a[2:3], v104 offset:53248
v_mfma_f32_16x16x32_bf16 v[28:31], a[36:39], v[232:235], v[28:31]
buffer_load_dwordx4 v17, s[40:43], s64 offen lds
v_mfma_f32_16x16x32_bf16 v[60:63], a[36:39], v[236:239], v[60:63]
s_waitcnt lgkmcnt(12)
s_add_u32 m0, s86, 132096
ds_read_b64_tr_b16 a[4:5], v105 offset:49152
v_mfma_f32_16x16x32_bf16 v[32:35], a[40:43], v[232:235], v[32:35]
s_add_u32 s64, s85, 1056768
ds_read_b64_tr_b16 a[6:7], v105 offset:53248
v_mfma_f32_16x16x32_bf16 v[64:67], a[40:43], v[236:239], v[64:67]
s_waitcnt lgkmcnt(12)
ds_read_b64_tr_b16 a[8:9], v106 offset:49152
buffer_load_dwordx4 v18, s[40:43], s64 offen lds
v_mfma_f32_16x16x32_bf16 v[36:39], a[44:47], v[232:235], v[36:39]
ds_read_b64_tr_b16 a[10:11], v106 offset:53248
ds_read_b64_tr_b16 a[12:13], v107 offset:49152
v_mfma_f32_16x16x32_bf16 v[68:71], a[44:47], v[236:239], v[68:71]
s_waitcnt lgkmcnt(13)
s_add_u32 m0, s86, 133120
ds_read_b64_tr_b16 a[14:15], v107 offset:53248
v_mfma_f32_16x16x32_bf16 v[40:43], a[48:51], v[232:235], v[40:43]
s_add_u32 s64, s85, 1064960
ds_read_b64_tr_b16 a[16:17], v108 offset:49152
v_mfma_f32_16x16x32_bf16 v[72:75], a[48:51], v[236:239], v[72:75]
s_waitcnt lgkmcnt(13)
ds_read_b64_tr_b16 a[18:19], v108 offset:53248
buffer_load_dwordx4 v17, s[40:43], s64 offen lds
v_mfma_f32_16x16x32_bf16 v[44:47], a[52:55], v[232:235], v[44:47]
ds_read_b64_tr_b16 a[20:21], v109 offset:49152
ds_read_b64_tr_b16 a[22:23], v109 offset:53248
v_mfma_f32_16x16x32_bf16 v[76:79], a[52:55], v[236:239], v[76:79]
s_waitcnt lgkmcnt(14)
s_add_u32 m0, s86, 134144
ds_read_b64_tr_b16 a[24:25], v110 offset:49152
v_mfma_f32_16x16x32_bf16 v[48:51], a[56:59], v[232:235], v[48:51]
s_add_u32 s64, s85, 1073152
ds_read_b64_tr_b16 a[26:27], v110 offset:53248
v_mfma_f32_16x16x32_bf16 v[80:83], a[56:59], v[236:239], v[80:83]
s_waitcnt lgkmcnt(14)
ds_read_b64_tr_b16 a[28:29], v111 offset:49152
buffer_load_dwordx4 v18, s[40:43], s64 offen lds
v_mfma_f32_16x16x32_bf16 v[52:55], a[60:63], v[232:235], v[52:55]
ds_read_b64_tr_b16 a[30:31], v111 offset:53248
v_mfma_f32_16x16x32_bf16 v[84:87], a[60:63], v[236:239], v[84:87]
s_waitcnt vmcnt(23)
s_waitcnt lgkmcnt(14)
v_mfma_f32_16x16x32_bf16 v[24:27], a[0:3], v[240:243], v[24:27]
s_waitcnt vmcnt(22)
ds_read_b64_tr_b16 a[32:33], v104 offset:57344
v_mfma_f32_16x16x32_bf16 v[56:59], a[0:3], v[244:247], v[56:59]
s_waitcnt lgkmcnt(13)
ds_read_b64_tr_b16 a[34:35], v104 offset:61440
v_mfma_f32_16x16x32_bf16 v[28:31], a[4:7], v[240:243], v[28:31]
s_add_u32 s65, s84, 131072
ds_read_b64_tr_b16 a[36:37], v105 offset:57344
v_mfma_f32_16x16x32_bf16 v[60:63], a[4:7], v[244:247], v[60:63]
s_waitcnt lgkmcnt(13)
buffer_load_dwordx4 v[224:227], v16, s[44:47], s65 offen offset:0 sc1
v_mfma_f32_16x16x32_bf16 v[32:35], a[8:11], v[240:243], v[32:35]
ds_read_b64_tr_b16 a[38:39], v105 offset:61440
v_mfma_f32_16x16x32_bf16 v[64:67], a[8:11], v[244:247], v[64:67]
s_waitcnt lgkmcnt(12)
ds_read_b64_tr_b16 a[40:41], v106 offset:57344
v_mfma_f32_16x16x32_bf16 v[36:39], a[12:15], v[240:243], v[36:39]
ds_read_b64_tr_b16 a[42:43], v106 offset:61440
ds_read_b64_tr_b16 a[44:45], v107 offset:57344
buffer_load_dwordx4 v[228:231], v16, s[44:47], s65 offen offset:1024 sc1
v_mfma_f32_16x16x32_bf16 v[68:71], a[12:15], v[244:247], v[68:71]
s_waitcnt lgkmcnt(13)
ds_read_b64_tr_b16 a[46:47], v107 offset:61440
v_mfma_f32_16x16x32_bf16 v[40:43], a[16:19], v[240:243], v[40:43]
ds_read_b64_tr_b16 a[48:49], v108 offset:57344
v_mfma_f32_16x16x32_bf16 v[72:75], a[16:19], v[244:247], v[72:75]
s_waitcnt lgkmcnt(13)
s_add_u32 s65, s84, 139264
ds_read_b64_tr_b16 a[50:51], v108 offset:61440
v_mfma_f32_16x16x32_bf16 v[44:47], a[20:23], v[240:243], v[44:47]
ds_read_b64_tr_b16 a[52:53], v109 offset:57344
ds_read_b64_tr_b16 a[54:55], v109 offset:61440
buffer_load_dwordx4 v[232:235], v16, s[44:47], s65 offen offset:0 sc1
v_mfma_f32_16x16x32_bf16 v[76:79], a[20:23], v[244:247], v[76:79]
s_waitcnt lgkmcnt(14)
ds_read_b64_tr_b16 a[56:57], v110 offset:57344
v_mfma_f32_16x16x32_bf16 v[48:51], a[24:27], v[240:243], v[48:51]
ds_read_b64_tr_b16 a[58:59], v110 offset:61440
v_mfma_f32_16x16x32_bf16 v[80:83], a[24:27], v[244:247], v[80:83]
s_waitcnt lgkmcnt(14)
ds_read_b64_tr_b16 a[60:61], v111 offset:57344
v_mfma_f32_16x16x32_bf16 v[52:55], a[28:31], v[240:243], v[52:55]
ds_read_b64_tr_b16 a[62:63], v111 offset:61440
buffer_load_dwordx4 v[236:239], v16, s[44:47], s65 offen offset:1024 sc1
v_mfma_f32_16x16x32_bf16 v[84:87], a[28:31], v[244:247], v[84:87]
s_waitcnt vmcnt(20)
s_barrier
s_waitcnt lgkmcnt(14)
v_mfma_f32_16x16x32_bf16 v[24:27], a[32:35], v[248:251], v[24:27]
s_add_u32 m0, s86, 147456
ds_read_b64_tr_b16 a[0:1], v104 offset:0
v_mfma_f32_16x16x32_bf16 v[56:59], a[32:35], v[252:255], v[56:59]
s_waitcnt lgkmcnt(13)
s_add_u32 s64, s85, 1179648
ds_read_b64_tr_b16 a[2:3], v104 offset:4096
v_mfma_f32_16x16x32_bf16 v[28:31], a[36:39], v[248:251], v[28:31]
buffer_load_dwordx4 v17, s[40:43], s64 offen lds
v_mfma_f32_16x16x32_bf16 v[60:63], a[36:39], v[252:255], v[60:63]
s_waitcnt lgkmcnt(12)
s_add_u32 m0, s86, 148480
ds_read_b64_tr_b16 a[4:5], v105 offset:0
v_mfma_f32_16x16x32_bf16 v[32:35], a[40:43], v[248:251], v[32:35]
s_add_u32 s64, s85, 1187840
ds_read_b64_tr_b16 a[6:7], v105 offset:4096
v_mfma_f32_16x16x32_bf16 v[64:67], a[40:43], v[252:255], v[64:67]
s_waitcnt lgkmcnt(12)
ds_read_b64_tr_b16 a[8:9], v106 offset:0
buffer_load_dwordx4 v18, s[40:43], s64 offen lds
v_mfma_f32_16x16x32_bf16 v[36:39], a[44:47], v[248:251], v[36:39]
ds_read_b64_tr_b16 a[10:11], v106 offset:4096
ds_read_b64_tr_b16 a[12:13], v107 offset:0
v_mfma_f32_16x16x32_bf16 v[68:71], a[44:47], v[252:255], v[68:71]
s_waitcnt lgkmcnt(13)
s_add_u32 m0, s86, 149504
ds_read_b64_tr_b16 a[14:15], v107 offset:4096
v_mfma_f32_16x16x32_bf16 v[40:43], a[48:51], v[248:251], v[40:43]
s_add_u32 s64, s85, 1196032
ds_read_b64_tr_b16 a[16:17], v108 offset:0
v_mfma_f32_16x16x32_bf16 v[72:75], a[48:51], v[252:255], v[72:75]
s_waitcnt lgkmcnt(13)
ds_read_b64_tr_b16 a[18:19], v108 offset:4096
buffer_load_dwordx4 v17, s[40:43], s64 offen lds
v_mfma_f32_16x16x32_bf16 v[44:47], a[52:55], v[248:251], v[44:47]
ds_read_b64_tr_b16 a[20:21], v109 offset:0
ds_read_b64_tr_b16 a[22:23], v109 offset:4096
v_mfma_f32_16x16x32_bf16 v[76:79], a[52:55], v[252:255], v[76:79]
s_waitcnt lgkmcnt(14)
s_add_u32 m0, s86, 150528
ds_read_b64_tr_b16 a[24:25], v110 offset:0
v_mfma_f32_16x16x32_bf16 v[48:51], a[56:59], v[248:251], v[48:51]
s_add_u32 s64, s85, 1204224
ds_read_b64_tr_b16 a[26:27], v110 offset:4096
v_mfma_f32_16x16x32_bf16 v[80:83], a[56:59], v[252:255], v[80:83]
s_waitcnt lgkmcnt(14)
ds_read_b64_tr_b16 a[28:29], v111 offset:0
buffer_load_dwordx4 v18, s[40:43], s64 offen lds
v_mfma_f32_16x16x32_bf16 v[52:55], a[60:63], v[248:251], v[52:55]
ds_read_b64_tr_b16 a[30:31], v111 offset:4096
v_mfma_f32_16x16x32_bf16 v[84:87], a[60:63], v[252:255], v[84:87]
s_waitcnt vmcnt(23)
s_waitcnt lgkmcnt(14)
v_mfma_f32_16x16x32_bf16 v[24:27], a[0:3], v[192:195], v[24:27]
s_waitcnt vmcnt(22)
ds_read_b64_tr_b16 a[32:33], v104 offset:8192
v_mfma_f32_16x16x32_bf16 v[56:59], a[0:3], v[196:199], v[56:59]
s_waitcnt lgkmcnt(13)
ds_read_b64_tr_b16 a[34:35], v104 offset:12288
v_mfma_f32_16x16x32_bf16 v[28:31], a[4:7], v[192:195], v[28:31]
s_add_u32 s65, s84, 147456
ds_read_b64_tr_b16 a[36:37], v105 offset:8192
v_mfma_f32_16x16x32_bf16 v[60:63], a[4:7], v[196:199], v[60:63]
s_waitcnt lgkmcnt(13)
buffer_load_dwordx4 v[240:243], v16, s[44:47], s65 offen offset:0 sc1
v_mfma_f32_16x16x32_bf16 v[32:35], a[8:11], v[192:195], v[32:35]
ds_read_b64_tr_b16 a[38:39], v105 offset:12288
v_mfma_f32_16x16x32_bf16 v[64:67], a[8:11], v[196:199], v[64:67]
s_waitcnt lgkmcnt(12)
ds_read_b64_tr_b16 a[40:41], v106 offset:8192
v_mfma_f32_16x16x32_bf16 v[36:39], a[12:15], v[192:195], v[36:39]
ds_read_b64_tr_b16 a[42:43], v106 offset:12288
ds_read_b64_tr_b16 a[44:45], v107 offset:8192
buffer_load_dwordx4 v[244:247], v16, s[44:47], s65 offen offset:1024 sc1
v_mfma_f32_16x16x32_bf16 v[68:71], a[12:15], v[196:199], v[68:71]
s_waitcnt lgkmcnt(13)
ds_read_b64_tr_b16 a[46:47], v107 offset:12288
v_mfma_f32_16x16x32_bf16 v[40:43], a[16:19], v[192:195], v[40:43]
ds_read_b64_tr_b16 a[48:49], v108 offset:8192
v_mfma_f32_16x16x32_bf16 v[72:75], a[16:19], v[196:199], v[72:75]
s_waitcnt lgkmcnt(13)
s_add_u32 s65, s84, 155648
ds_read_b64_tr_b16 a[50:51], v108 offset:12288
v_mfma_f32_16x16x32_bf16 v[44:47], a[20:23], v[192:195], v[44:47]
ds_read_b64_tr_b16 a[52:53], v109 offset:8192
ds_read_b64_tr_b16 a[54:55], v109 offset:12288
buffer_load_dwordx4 v[248:251], v16, s[44:47], s65 offen offset:0 sc1
v_mfma_f32_16x16x32_bf16 v[76:79], a[20:23], v[196:199], v[76:79]
s_waitcnt lgkmcnt(14)
ds_read_b64_tr_b16 a[56:57], v110 offset:8192
v_mfma_f32_16x16x32_bf16 v[48:51], a[24:27], v[192:195], v[48:51]
ds_read_b64_tr_b16 a[58:59], v110 offset:12288
v_mfma_f32_16x16x32_bf16 v[80:83], a[24:27], v[196:199], v[80:83]
s_waitcnt lgkmcnt(14)
ds_read_b64_tr_b16 a[60:61], v111 offset:8192
v_mfma_f32_16x16x32_bf16 v[52:55], a[28:31], v[192:195], v[52:55]
ds_read_b64_tr_b16 a[62:63], v111 offset:12288
buffer_load_dwordx4 v[252:255], v16, s[44:47], s65 offen offset:1024 sc1
v_mfma_f32_16x16x32_bf16 v[84:87], a[28:31], v[196:199], v[84:87]
s_waitcnt vmcnt(20)
s_barrier
s_waitcnt lgkmcnt(14)
v_mfma_f32_16x16x32_bf16 v[24:27], a[32:35], v[200:203], v[24:27]
s_add_u32 m0, s86, 98304
ds_read_b64_tr_b16 a[0:1], v104 offset:16384
v_mfma_f32_16x16x32_bf16 v[56:59], a[32:35], v[204:207], v[56:59]
s_waitcnt lgkmcnt(13)
s_add_u32 s64, s85, 1310720
ds_read_b64_tr_b16 a[2:3], v104 offset:20480
v_mfma_f32_16x16x32_bf16 v[28:31], a[36:39], v[200:203], v[28:31]
buffer_load_dwordx4 v17, s[40:43], s64 offen lds
v_mfma_f32_16x16x32_bf16 v[60:63], a[36:39], v[204:207], v[60:63]
s_waitcnt lgkmcnt(12)
s_add_u32 m0, s86, 99328
ds_read_b64_tr_b16 a[4:5], v105 offset:16384
v_mfma_f32_16x16x32_bf16 v[32:35], a[40:43], v[200:203], v[32:35]
s_add_u32 s64, s85, 1318912
ds_read_b64_tr_b16 a[6:7], v105 offset:20480
v_mfma_f32_16x16x32_bf16 v[64:67], a[40:43], v[204:207], v[64:67]
s_waitcnt lgkmcnt(12)
ds_read_b64_tr_b16 a[8:9], v106 offset:16384
buffer_load_dwordx4 v18, s[40:43], s64 offen lds
v_mfma_f32_16x16x32_bf16 v[36:39], a[44:47], v[200:203], v[36:39]
ds_read_b64_tr_b16 a[10:11], v106 offset:20480
ds_read_b64_tr_b16 a[12:13], v107 offset:16384
v_mfma_f32_16x16x32_bf16 v[68:71], a[44:47], v[204:207], v[68:71]
s_waitcnt lgkmcnt(13)
s_add_u32 m0, s86, 100352
ds_read_b64_tr_b16 a[14:15], v107 offset:20480
v_mfma_f32_16x16x32_bf16 v[40:43], a[48:51], v[200:203], v[40:43]
s_add_u32 s64, s85, 1327104
ds_read_b64_tr_b16 a[16:17], v108 offset:16384
v_mfma_f32_16x16x32_bf16 v[72:75], a[48:51], v[204:207], v[72:75]
s_waitcnt lgkmcnt(13)
ds_read_b64_tr_b16 a[18:19], v108 offset:20480
buffer_load_dwordx4 v17, s[40:43], s64 offen lds
v_mfma_f32_16x16x32_bf16 v[44:47], a[52:55], v[200:203], v[44:47]
ds_read_b64_tr_b16 a[20:21], v109 offset:16384
ds_read_b64_tr_b16 a[22:23], v109 offset:20480
v_mfma_f32_16x16x32_bf16 v[76:79], a[52:55], v[204:207], v[76:79]
s_waitcnt lgkmcnt(14)
s_add_u32 m0, s86, 101376
ds_read_b64_tr_b16 a[24:25], v110 offset:16384
v_mfma_f32_16x16x32_bf16 v[48:51], a[56:59], v[200:203], v[48:51]
s_add_u32 s64, s85, 1335296
ds_read_b64_tr_b16 a[26:27], v110 offset:20480
v_mfma_f32_16x16x32_bf16 v[80:83], a[56:59], v[204:207], v[80:83]
s_waitcnt lgkmcnt(14)
ds_read_b64_tr_b16 a[28:29], v111 offset:16384
buffer_load_dwordx4 v18, s[40:43], s64 offen lds
v_mfma_f32_16x16x32_bf16 v[52:55], a[60:63], v[200:203], v[52:55]
ds_read_b64_tr_b16 a[30:31], v111 offset:20480
v_mfma_f32_16x16x32_bf16 v[84:87], a[60:63], v[204:207], v[84:87]
s_waitcnt vmcnt(23)
s_waitcnt lgkmcnt(14)
v_mfma_f32_16x16x32_bf16 v[24:27], a[0:3], v[208:211], v[24:27]
s_waitcnt vmcnt(22)
ds_read_b64_tr_b16 a[32:33], v104 offset:24576
v_mfma_f32_16x16x32_bf16 v[56:59], a[0:3], v[212:215], v[56:59]
s_waitcnt lgkmcnt(13)
ds_read_b64_tr_b16 a[34:35], v104 offset:28672
v_mfma_f32_16x16x32_bf16 v[28:31], a[4:7], v[208:211], v[28:31]
s_add_u32 s65, s84, 163840
ds_read_b64_tr_b16 a[36:37], v105 offset:24576
v_mfma_f32_16x16x32_bf16 v[60:63], a[4:7], v[212:215], v[60:63]
s_waitcnt lgkmcnt(13)
buffer_load_dwordx4 v[192:195], v16, s[44:47], s65 offen offset:0 sc1
v_mfma_f32_16x16x32_bf16 v[32:35], a[8:11], v[208:211], v[32:35]
ds_read_b64_tr_b16 a[38:39], v105 offset:28672
v_mfma_f32_16x16x32_bf16 v[64:67], a[8:11], v[212:215], v[64:67]
s_waitcnt lgkmcnt(12)
ds_read_b64_tr_b16 a[40:41], v106 offset:24576
v_mfma_f32_16x16x32_bf16 v[36:39], a[12:15], v[208:211], v[36:39]
ds_read_b64_tr_b16 a[42:43], v106 offset:28672
ds_read_b64_tr_b16 a[44:45], v107 offset:24576
buffer_load_dwordx4 v[196:199], v16, s[44:47], s65 offen offset:1024 sc1
v_mfma_f32_16x16x32_bf16 v[68:71], a[12:15], v[212:215], v[68:71]
s_waitcnt lgkmcnt(13)
ds_read_b64_tr_b16 a[46:47], v107 offset:28672
v_mfma_f32_16x16x32_bf16 v[40:43], a[16:19], v[208:211], v[40:43]
ds_read_b64_tr_b16 a[48:49], v108 offset:24576
v_mfma_f32_16x16x32_bf16 v[72:75], a[16:19], v[212:215], v[72:75]
s_waitcnt lgkmcnt(13)
s_add_u32 s65, s84, 172032
ds_read_b64_tr_b16 a[50:51], v108 offset:28672
v_mfma_f32_16x16x32_bf16 v[44:47], a[20:23], v[208:211], v[44:47]
ds_read_b64_tr_b16 a[52:53], v109 offset:24576
ds_read_b64_tr_b16 a[54:55], v109 offset:28672
buffer_load_dwordx4 v[200:203], v16, s[44:47], s65 offen offset:0 sc1
v_mfma_f32_16x16x32_bf16 v[76:79], a[20:23], v[212:215], v[76:79]
s_waitcnt lgkmcnt(14)
ds_read_b64_tr_b16 a[56:57], v110 offset:24576
v_mfma_f32_16x16x32_bf16 v[48:51], a[24:27], v[208:211], v[48:51]
ds_read_b64_tr_b16 a[58:59], v110 offset:28672
v_mfma_f32_16x16x32_bf16 v[80:83], a[24:27], v[212:215], v[80:83]
s_waitcnt lgkmcnt(14)
ds_read_b64_tr_b16 a[60:61], v111 offset:24576
v_mfma_f32_16x16x32_bf16 v[52:55], a[28:31], v[208:211], v[52:55]
ds_read_b64_tr_b16 a[62:63], v111 offset:28672
buffer_load_dwordx4 v[204:207], v16, s[44:47], s65 offen offset:1024 sc1
v_mfma_f32_16x16x32_bf16 v[84:87], a[28:31], v[212:215], v[84:87]
s_waitcnt vmcnt(20)
s_barrier
s_waitcnt lgkmcnt(14)
v_mfma_f32_16x16x32_bf16 v[24:27], a[32:35], v[216:219], v[24:27]
s_add_u32 m0, s86, 114688
ds_read_b64_tr_b16 a[0:1], v88 offset:32768
v_mfma_f32_16x16x32_bf16 v[56:59], a[32:35], v[220:223], v[56:59]
s_waitcnt lgkmcnt(13)
s_add_u32 s64, s85, 1441792
ds_read_b64_tr_b16 a[2:3], v88 offset:36864
v_mfma_f32_16x16x32_bf16 v[28:31], a[36:39], v[216:219], v[28:31]
buffer_load_dwordx4 v17, s[40:43], s64 offen lds
v_mfma_f32_16x16x32_bf16 v[60:63], a[36:39], v[220:223], v[60:63]
s_waitcnt lgkmcnt(12)
s_add_u32 m0, s86, 115712
ds_read_b64_tr_b16 a[4:5], v89 offset:32768
v_mfma_f32_16x16x32_bf16 v[32:35], a[40:43], v[216:219], v[32:35]
s_add_u32 s64, s85, 1449984
ds_read_b64_tr_b16 a[6:7], v89 offset:36864
v_mfma_f32_16x16x32_bf16 v[64:67], a[40:43], v[220:223], v[64:67]
s_waitcnt lgkmcnt(12)
ds_read_b64_tr_b16 a[8:9], v90 offset:32768
buffer_load_dwordx4 v18, s[40:43], s64 offen lds
v_mfma_f32_16x16x32_bf16 v[36:39], a[44:47], v[216:219], v[36:39]
ds_read_b64_tr_b16 a[10:11], v90 offset:36864
ds_read_b64_tr_b16 a[12:13], v91 offset:32768
v_mfma_f32_16x16x32_bf16 v[68:71], a[44:47], v[220:223], v[68:71]
s_waitcnt lgkmcnt(13)
s_add_u32 m0, s86, 116736
ds_read_b64_tr_b16 a[14:15], v91 offset:36864
v_mfma_f32_16x16x32_bf16 v[40:43], a[48:51], v[216:219], v[40:43]
s_add_u32 s64, s85, 1458176
ds_read_b64_tr_b16 a[16:17], v92 offset:32768
v_mfma_f32_16x16x32_bf16 v[72:75], a[48:51], v[220:223], v[72:75]
s_waitcnt lgkmcnt(13)
ds_read_b64_tr_b16 a[18:19], v92 offset:36864
buffer_load_dwordx4 v17, s[40:43], s64 offen lds
v_mfma_f32_16x16x32_bf16 v[44:47], a[52:55], v[216:219], v[44:47]
ds_read_b64_tr_b16 a[20:21], v93 offset:32768
ds_read_b64_tr_b16 a[22:23], v93 offset:36864
v_mfma_f32_16x16x32_bf16 v[76:79], a[52:55], v[220:223], v[76:79]
s_waitcnt lgkmcnt(14)
s_add_u32 m0, s86, 117760
ds_read_b64_tr_b16 a[24:25], v94 offset:32768
v_mfma_f32_16x16x32_bf16 v[48:51], a[56:59], v[216:219], v[48:51]
s_add_u32 s64, s85, 1466368
ds_read_b64_tr_b16 a[26:27], v94 offset:36864
v_mfma_f32_16x16x32_bf16 v[80:83], a[56:59], v[220:223], v[80:83]
s_waitcnt lgkmcnt(14)
ds_read_b64_tr_b16 a[28:29], v95 offset:32768
buffer_load_dwordx4 v18, s[40:43], s64 offen lds
v_mfma_f32_16x16x32_bf16 v[52:55], a[60:63], v[216:219], v[52:55]
ds_read_b64_tr_b16 a[30:31], v95 offset:36864
v_mfma_f32_16x16x32_bf16 v[84:87], a[60:63], v[220:223], v[84:87]
s_add_u32 s85, s85, 1048576
s_add_u32 s84, s84, 131072
s_sub_u32 s70, s70, 1
s_cmp_lg_u32 s70, 0
s_cbranch_scc1 L_p5_2024
s_waitcnt lgkmcnt(14)
s_waitcnt vmcnt(23)
v_mfma_f32_16x16x32_bf16 v[24:27], a[0:3], v[224:227], v[24:27]
s_waitcnt vmcnt(22)
ds_read_b64_tr_b16 a[32:33], v88 offset:40960
v_mfma_f32_16x16x32_bf16 v[56:59], a[0:3], v[228:231], v[56:59]
s_waitcnt lgkmcnt(13)
ds_read_b64_tr_b16 a[34:35], v88 offset:45056
v_mfma_f32_16x16x32_bf16 v[28:31], a[4:7], v[224:227], v[28:31]
s_add_u32 s65, s84, 49152
ds_read_b64_tr_b16 a[36:37], v89 offset:40960
v_mfma_f32_16x16x32_bf16 v[60:63], a[4:7], v[228:231], v[60:63]
s_waitcnt lgkmcnt(13)
buffer_load_dwordx4 v[208:211], v16, s[44:47], s65 offen offset:0 sc1
v_mfma_f32_16x16x32_bf16 v[32:35], a[8:11], v[224:227], v[32:35]
ds_read_b64_tr_b16 a[38:39], v89 offset:45056
v_mfma_f32_16x16x32_bf16 v[64:67], a[8:11], v[228:231], v[64:67]
s_waitcnt lgkmcnt(12)
ds_read_b64_tr_b16 a[40:41], v90 offset:40960
v_mfma_f32_16x16x32_bf16 v[36:39], a[12:15], v[224:227], v[36:39]
ds_read_b64_tr_b16 a[42:43], v90 offset:45056
ds_read_b64_tr_b16 a[44:45], v91 offset:40960
buffer_load_dwordx4 v[212:215], v16, s[44:47], s65 offen offset:1024 sc1
v_mfma_f32_16x16x32_bf16 v[68:71], a[12:15], v[228:231], v[68:71]
s_waitcnt lgkmcnt(13)
ds_read_b64_tr_b16 a[46:47], v91 offset:45056
v_mfma_f32_16x16x32_bf16 v[40:43], a[16:19], v[224:227], v[40:43]
ds_read_b64_tr_b16 a[48:49], v92 offset:40960
v_mfma_f32_16x16x32_bf16 v[72:75], a[16:19], v[228:231], v[72:75]
s_waitcnt lgkmcnt(13)
s_add_u32 s65, s84, 57344
ds_read_b64_tr_b16 a[50:51], v92 offset:45056
v_mfma_f32_16x16x32_bf16 v[44:47], a[20:23], v[224:227], v[44:47]
ds_read_b64_tr_b16 a[52:53], v93 offset:40960
ds_read_b64_tr_b16 a[54:55], v93 offset:45056
buffer_load_dwordx4 v[216:219], v16, s[44:47], s65 offen offset:0 sc1
v_mfma_f32_16x16x32_bf16 v[76:79], a[20:23], v[228:231], v[76:79]
s_waitcnt lgkmcnt(14)
ds_read_b64_tr_b16 a[56:57], v94 offset:40960
v_mfma_f32_16x16x32_bf16 v[48:51], a[24:27], v[224:227], v[48:51]
ds_read_b64_tr_b16 a[58:59], v94 offset:45056
v_mfma_f32_16x16x32_bf16 v[80:83], a[24:27], v[228:231], v[80:83]
s_waitcnt lgkmcnt(14)
ds_read_b64_tr_b16 a[60:61], v95 offset:40960
v_mfma_f32_16x16x32_bf16 v[52:55], a[28:31], v[224:227], v[52:55]
ds_read_b64_tr_b16 a[62:63], v95 offset:45056
buffer_load_dwordx4 v[220:223], v16, s[44:47], s65 offen offset:1024 sc1
v_mfma_f32_16x16x32_bf16 v[84:87], a[28:31], v[228:231], v[84:87]
s_waitcnt vmcnt(20)
s_barrier
s_waitcnt lgkmcnt(14)
v_mfma_f32_16x16x32_bf16 v[24:27], a[32:35], v[232:235], v[24:27]
s_add_u32 m0, s86, 65536
ds_read_b64_tr_b16 a[0:1], v88 offset:49152
v_mfma_f32_16x16x32_bf16 v[56:59], a[32:35], v[236:239], v[56:59]
s_waitcnt lgkmcnt(13)
s_add_u32 s64, s85, 524288
ds_read_b64_tr_b16 a[2:3], v88 offset:53248
v_mfma_f32_16x16x32_bf16 v[28:31], a[36:39], v[232:235], v[28:31]
buffer_load_dwordx4 v17, s[40:43], s64 offen lds
v_mfma_f32_16x16x32_bf16 v[60:63], a[36:39], v[236:239], v[60:63]
s_waitcnt lgkmcnt(12)
s_add_u32 m0, s86, 66560
ds_read_b64_tr_b16 a[4:5], v89 offset:49152
v_mfma_f32_16x16x32_bf16 v[32:35], a[40:43], v[232:235], v[32:35]
s_add_u32 s64, s85, 532480
ds_read_b64_tr_b16 a[6:7], v89 offset:53248
v_mfma_f32_16x16x32_bf16 v[64:67], a[40:43], v[236:239], v[64:67]
s_waitcnt lgkmcnt(12)
ds_read_b64_tr_b16 a[8:9], v90 offset:49152
buffer_load_dwordx4 v18, s[40:43], s64 offen lds
v_mfma_f32_16x16x32_bf16 v[36:39], a[44:47], v[232:235], v[36:39]
ds_read_b64_tr_b16 a[10:11], v90 offset:53248
ds_read_b64_tr_b16 a[12:13], v91 offset:49152
v_mfma_f32_16x16x32_bf16 v[68:71], a[44:47], v[236:239], v[68:71]
s_waitcnt lgkmcnt(13)
s_add_u32 m0, s86, 67584
ds_read_b64_tr_b16 a[14:15], v91 offset:53248
v_mfma_f32_16x16x32_bf16 v[40:43], a[48:51], v[232:235], v[40:43]
s_add_u32 s64, s85, 540672
ds_read_b64_tr_b16 a[16:17], v92 offset:49152
v_mfma_f32_16x16x32_bf16 v[72:75], a[48:51], v[236:239], v[72:75]
s_waitcnt lgkmcnt(13)
ds_read_b64_tr_b16 a[18:19], v92 offset:53248
buffer_load_dwordx4 v17, s[40:43], s64 offen lds
v_mfma_f32_16x16x32_bf16 v[44:47], a[52:55], v[232:235], v[44:47]
ds_read_b64_tr_b16 a[20:21], v93 offset:49152
ds_read_b64_tr_b16 a[22:23], v93 offset:53248
v_mfma_f32_16x16x32_bf16 v[76:79], a[52:55], v[236:239], v[76:79]
s_waitcnt lgkmcnt(14)
s_add_u32 m0, s86, 68608
ds_read_b64_tr_b16 a[24:25], v94 offset:49152
v_mfma_f32_16x16x32_bf16 v[48:51], a[56:59], v[232:235], v[48:51]
s_add_u32 s64, s85, 548864
ds_read_b64_tr_b16 a[26:27], v94 offset:53248
v_mfma_f32_16x16x32_bf16 v[80:83], a[56:59], v[236:239], v[80:83]
s_waitcnt lgkmcnt(14)
ds_read_b64_tr_b16 a[28:29], v95 offset:49152
buffer_load_dwordx4 v18, s[40:43], s64 offen lds
v_mfma_f32_16x16x32_bf16 v[52:55], a[60:63], v[232:235], v[52:55]
ds_read_b64_tr_b16 a[30:31], v95 offset:53248
v_mfma_f32_16x16x32_bf16 v[84:87], a[60:63], v[236:239], v[84:87]
s_waitcnt vmcnt(23)
s_waitcnt lgkmcnt(14)
v_mfma_f32_16x16x32_bf16 v[24:27], a[0:3], v[240:243], v[24:27]
s_waitcnt vmcnt(22)
ds_read_b64_tr_b16 a[32:33], v88 offset:57344
v_mfma_f32_16x16x32_bf16 v[56:59], a[0:3], v[244:247], v[56:59]
s_waitcnt lgkmcnt(13)
ds_read_b64_tr_b16 a[34:35], v88 offset:61440
v_mfma_f32_16x16x32_bf16 v[28:31], a[4:7], v[240:243], v[28:31]
s_add_u32 s65, s84, 65536
ds_read_b64_tr_b16 a[36:37], v89 offset:57344
v_mfma_f32_16x16x32_bf16 v[60:63], a[4:7], v[244:247], v[60:63]
s_waitcnt lgkmcnt(13)
buffer_load_dwordx4 v[224:227], v16, s[44:47], s65 offen offset:0 sc1
v_mfma_f32_16x16x32_bf16 v[32:35], a[8:11], v[240:243], v[32:35]
ds_read_b64_tr_b16 a[38:39], v89 offset:61440
v_mfma_f32_16x16x32_bf16 v[64:67], a[8:11], v[244:247], v[64:67]
s_waitcnt lgkmcnt(12)
ds_read_b64_tr_b16 a[40:41], v90 offset:57344
v_mfma_f32_16x16x32_bf16 v[36:39], a[12:15], v[240:243], v[36:39]
ds_read_b64_tr_b16 a[42:43], v90 offset:61440
ds_read_b64_tr_b16 a[44:45], v91 offset:57344
buffer_load_dwordx4 v[228:231], v16, s[44:47], s65 offen offset:1024 sc1
v_mfma_f32_16x16x32_bf16 v[68:71], a[12:15], v[244:247], v[68:71]
s_waitcnt lgkmcnt(13)
ds_read_b64_tr_b16 a[46:47], v91 offset:61440
v_mfma_f32_16x16x32_bf16 v[40:43], a[16:19], v[240:243], v[40:43]
ds_read_b64_tr_b16 a[48:49], v92 offset:57344
v_mfma_f32_16x16x32_bf16 v[72:75], a[16:19], v[244:247], v[72:75]
s_waitcnt lgkmcnt(13)
s_add_u32 s65, s84, 73728
ds_read_b64_tr_b16 a[50:51], v92 offset:61440
v_mfma_f32_16x16x32_bf16 v[44:47], a[20:23], v[240:243], v[44:47]
ds_read_b64_tr_b16 a[52:53], v93 offset:57344
ds_read_b64_tr_b16 a[54:55], v93 offset:61440
buffer_load_dwordx4 v[232:235], v16, s[44:47], s65 offen offset:0 sc1
v_mfma_f32_16x16x32_bf16 v[76:79], a[20:23], v[244:247], v[76:79]
s_waitcnt lgkmcnt(14)
ds_read_b64_tr_b16 a[56:57], v94 offset:57344
v_mfma_f32_16x16x32_bf16 v[48:51], a[24:27], v[240:243], v[48:51]
ds_read_b64_tr_b16 a[58:59], v94 offset:61440
v_mfma_f32_16x16x32_bf16 v[80:83], a[24:27], v[244:247], v[80:83]
s_waitcnt lgkmcnt(14)
ds_read_b64_tr_b16 a[60:61], v95 offset:57344
v_mfma_f32_16x16x32_bf16 v[52:55], a[28:31], v[240:243], v[52:55]
ds_read_b64_tr_b16 a[62:63], v95 offset:61440
buffer_load_dwordx4 v[236:239], v16, s[44:47], s65 offen offset:1024 sc1
v_mfma_f32_16x16x32_bf16 v[84:87], a[28:31], v[244:247], v[84:87]
s_waitcnt vmcnt(20)
s_barrier
s_waitcnt lgkmcnt(14)
v_mfma_f32_16x16x32_bf16 v[24:27], a[32:35], v[248:251], v[24:27]
s_add_u32 m0, s86, 81920
ds_read_b64_tr_b16 a[0:1], v88 offset:0
v_mfma_f32_16x16x32_bf16 v[56:59], a[32:35], v[252:255], v[56:59]
s_waitcnt lgkmcnt(13)
s_add_u32 s64, s85, 655360
ds_read_b64_tr_b16 a[2:3], v88 offset:4096
v_mfma_f32_16x16x32_bf16 v[28:31], a[36:39], v[248:251], v[28:31]
buffer_load_dwordx4 v17, s[40:43], s64 offen lds
v_mfma_f32_16x16x32_bf16 v[60:63], a[36:39], v[252:255], v[60:63]
s_waitcnt lgkmcnt(12)
s_add_u32 m0, s86, 82944
ds_read_b64_tr_b16 a[4:5], v89 offset:0
v_mfma_f32_16x16x32_bf16 v[32:35], a[40:43], v[248:251], v[32:35]
s_add_u32 s64, s85, 663552
ds_read_b64_tr_b16 a[6:7], v89 offset:4096
v_mfma_f32_16x16x32_bf16 v[64:67], a[40:43], v[252:255], v[64:67]
s_waitcnt lgkmcnt(12)
ds_read_b64_tr_b16 a[8:9], v90 offset:0
buffer_load_dwordx4 v18, s[40:43], s64 offen lds
v_mfma_f32_16x16x32_bf16 v[36:39], a[44:47], v[248:251], v[36:39]
ds_read_b64_tr_b16 a[10:11], v90 offset:4096
ds_read_b64_tr_b16 a[12:13], v91 offset:0
v_mfma_f32_16x16x32_bf16 v[68:71], a[44:47], v[252:255], v[68:71]
s_waitcnt lgkmcnt(13)
s_add_u32 m0, s86, 83968
ds_read_b64_tr_b16 a[14:15], v91 offset:4096
v_mfma_f32_16x16x32_bf16 v[40:43], a[48:51], v[248:251], v[40:43]
s_add_u32 s64, s85, 671744
ds_read_b64_tr_b16 a[16:17], v92 offset:0
v_mfma_f32_16x16x32_bf16 v[72:75], a[48:51], v[252:255], v[72:75]
s_waitcnt lgkmcnt(13)
ds_read_b64_tr_b16 a[18:19], v92 offset:4096
buffer_load_dwordx4 v17, s[40:43], s64 offen lds
v_mfma_f32_16x16x32_bf16 v[44:47], a[52:55], v[248:251], v[44:47]
ds_read_b64_tr_b16 a[20:21], v93 offset:0
ds_read_b64_tr_b16 a[22:23], v93 offset:4096
v_mfma_f32_16x16x32_bf16 v[76:79], a[52:55], v[252:255], v[76:79]
s_waitcnt lgkmcnt(14)
s_add_u32 m0, s86, 84992
ds_read_b64_tr_b16 a[24:25], v94 offset:0
v_mfma_f32_16x16x32_bf16 v[48:51], a[56:59], v[248:251], v[48:51]
s_add_u32 s64, s85, 679936
ds_read_b64_tr_b16 a[26:27], v94 offset:4096
v_mfma_f32_16x16x32_bf16 v[80:83], a[56:59], v[252:255], v[80:83]
s_waitcnt lgkmcnt(14)
ds_read_b64_tr_b16 a[28:29], v95 offset:0
buffer_load_dwordx4 v18, s[40:43], s64 offen lds
v_mfma_f32_16x16x32_bf16 v[52:55], a[60:63], v[248:251], v[52:55]
ds_read_b64_tr_b16 a[30:31], v95 offset:4096
v_mfma_f32_16x16x32_bf16 v[84:87], a[60:63], v[252:255], v[84:87]
s_waitcnt vmcnt(23)
s_waitcnt lgkmcnt(14)
v_mfma_f32_16x16x32_bf16 v[24:27], a[0:3], v[192:195], v[24:27]
s_waitcnt vmcnt(22)
ds_read_b64_tr_b16 a[32:33], v88 offset:8192
v_mfma_f32_16x16x32_bf16 v[56:59], a[0:3], v[196:199], v[56:59]
s_waitcnt lgkmcnt(13)
ds_read_b64_tr_b16 a[34:35], v88 offset:12288
v_mfma_f32_16x16x32_bf16 v[28:31], a[4:7], v[192:195], v[28:31]
s_add_u32 s65, s84, 81920
ds_read_b64_tr_b16 a[36:37], v89 offset:8192
v_mfma_f32_16x16x32_bf16 v[60:63], a[4:7], v[196:199], v[60:63]
s_waitcnt lgkmcnt(13)
buffer_load_dwordx4 v[240:243], v16, s[44:47], s65 offen offset:0 sc1
v_mfma_f32_16x16x32_bf16 v[32:35], a[8:11], v[192:195], v[32:35]
ds_read_b64_tr_b16 a[38:39], v89 offset:12288
v_mfma_f32_16x16x32_bf16 v[64:67], a[8:11], v[196:199], v[64:67]
s_waitcnt lgkmcnt(12)
ds_read_b64_tr_b16 a[40:41], v90 offset:8192
v_mfma_f32_16x16x32_bf16 v[36:39], a[12:15], v[192:195], v[36:39]
ds_read_b64_tr_b16 a[42:43], v90 offset:12288
ds_read_b64_tr_b16 a[44:45], v91 offset:8192
buffer_load_dwordx4 v[244:247], v16, s[44:47], s65 offen offset:1024 sc1
v_mfma_f32_16x16x32_bf16 v[68:71], a[12:15], v[196:199], v[68:71]
s_waitcnt lgkmcnt(13)
ds_read_b64_tr_b16 a[46:47], v91 offset:12288
v_mfma_f32_16x16x32_bf16 v[40:43], a[16:19], v[192:195], v[40:43]
ds_read_b64_tr_b16 a[48:49], v92 offset:8192
v_mfma_f32_16x16x32_bf16 v[72:75], a[16:19], v[196:199], v[72:75]
s_waitcnt lgkmcnt(13)
s_add_u32 s65, s84, 90112
ds_read_b64_tr_b16 a[50:51], v92 offset:12288
v_mfma_f32_16x16x32_bf16 v[44:47], a[20:23], v[192:195], v[44:47]
ds_read_b64_tr_b16 a[52:53], v93 offset:8192
ds_read_b64_tr_b16 a[54:55], v93 offset:12288
buffer_load_dwordx4 v[248:251], v16, s[44:47], s65 offen offset:0 sc1
v_mfma_f32_16x16x32_bf16 v[76:79], a[20:23], v[196:199], v[76:79]
s_waitcnt lgkmcnt(14)
ds_read_b64_tr_b16 a[56:57], v94 offset:8192
v_mfma_f32_16x16x32_bf16 v[48:51], a[24:27], v[192:195], v[48:51]
ds_read_b64_tr_b16 a[58:59], v94 offset:12288
v_mfma_f32_16x16x32_bf16 v[80:83], a[24:27], v[196:199], v[80:83]
s_waitcnt lgkmcnt(14)
ds_read_b64_tr_b16 a[60:61], v95 offset:8192
v_mfma_f32_16x16x32_bf16 v[52:55], a[28:31], v[192:195], v[52:55]
ds_read_b64_tr_b16 a[62:63], v95 offset:12288
buffer_load_dwordx4 v[252:255], v16, s[44:47], s65 offen offset:1024 sc1
v_mfma_f32_16x16x32_bf16 v[84:87], a[28:31], v[196:199], v[84:87]
s_waitcnt vmcnt(20)
s_barrier
s_waitcnt lgkmcnt(14)
v_mfma_f32_16x16x32_bf16 v[24:27], a[32:35], v[200:203], v[24:27]
s_add_u32 m0, s86, 32768
ds_read_b64_tr_b16 a[0:1], v88 offset:16384
v_mfma_f32_16x16x32_bf16 v[56:59], a[32:35], v[204:207], v[56:59]
s_waitcnt lgkmcnt(13)
s_add_u32 s64, s85, 786432
ds_read_b64_tr_b16 a[2:3], v88 offset:20480
v_mfma_f32_16x16x32_bf16 v[28:31], a[36:39], v[200:203], v[28:31]
buffer_load_dwordx4 v17, s[40:43], s64 offen lds
v_mfma_f32_16x16x32_bf16 v[60:63], a[36:39], v[204:207], v[60:63]
s_waitcnt lgkmcnt(12)
s_add_u32 m0, s86, 33792
ds_read_b64_tr_b16 a[4:5], v89 offset:16384
v_mfma_f32_16x16x32_bf16 v[32:35], a[40:43], v[200:203], v[32:35]
s_add_u32 s64, s85, 794624
ds_read_b64_tr_b16 a[6:7], v89 offset:20480
v_mfma_f32_16x16x32_bf16 v[64:67], a[40:43], v[204:207], v[64:67]
s_waitcnt lgkmcnt(12)
ds_read_b64_tr_b16 a[8:9], v90 offset:16384
buffer_load_dwordx4 v18, s[40:43], s64 offen lds
v_mfma_f32_16x16x32_bf16 v[36:39], a[44:47], v[200:203], v[36:39]
ds_read_b64_tr_b16 a[10:11], v90 offset:20480
ds_read_b64_tr_b16 a[12:13], v91 offset:16384
v_mfma_f32_16x16x32_bf16 v[68:71], a[44:47], v[204:207], v[68:71]
s_waitcnt lgkmcnt(13)
s_add_u32 m0, s86, 34816
ds_read_b64_tr_b16 a[14:15], v91 offset:20480
v_mfma_f32_16x16x32_bf16 v[40:43], a[48:51], v[200:203], v[40:43]
s_add_u32 s64, s85, 802816
ds_read_b64_tr_b16 a[16:17], v92 offset:16384
v_mfma_f32_16x16x32_bf16 v[72:75], a[48:51], v[204:207], v[72:75]
s_waitcnt lgkmcnt(13)
ds_read_b64_tr_b16 a[18:19], v92 offset:20480
buffer_load_dwordx4 v17, s[40:43], s64 offen lds
v_mfma_f32_16x16x32_bf16 v[44:47], a[52:55], v[200:203], v[44:47]
ds_read_b64_tr_b16 a[20:21], v93 offset:16384
ds_read_b64_tr_b16 a[22:23], v93 offset:20480
v_mfma_f32_16x16x32_bf16 v[76:79], a[52:55], v[204:207], v[76:79]
s_waitcnt lgkmcnt(14)
s_add_u32 m0, s86, 35840
ds_read_b64_tr_b16 a[24:25], v94 offset:16384
v_mfma_f32_16x16x32_bf16 v[48:51], a[56:59], v[200:203], v[48:51]
s_add_u32 s64, s85, 811008
ds_read_b64_tr_b16 a[26:27], v94 offset:20480
v_mfma_f32_16x16x32_bf16 v[80:83], a[56:59], v[204:207], v[80:83]
s_waitcnt lgkmcnt(14)
ds_read_b64_tr_b16 a[28:29], v95 offset:16384
buffer_load_dwordx4 v18, s[40:43], s64 offen lds
v_mfma_f32_16x16x32_bf16 v[52:55], a[60:63], v[200:203], v[52:55]
ds_read_b64_tr_b16 a[30:31], v95 offset:20480
v_mfma_f32_16x16x32_bf16 v[84:87], a[60:63], v[204:207], v[84:87]
s_waitcnt vmcnt(23)
s_waitcnt lgkmcnt(14)
v_mfma_f32_16x16x32_bf16 v[24:27], a[0:3], v[208:211], v[24:27]
s_waitcnt vmcnt(22)
ds_read_b64_tr_b16 a[32:33], v88 offset:24576
v_mfma_f32_16x16x32_bf16 v[56:59], a[0:3], v[212:215], v[56:59]
s_waitcnt lgkmcnt(13)
ds_read_b64_tr_b16 a[34:35], v88 offset:28672
v_mfma_f32_16x16x32_bf16 v[28:31], a[4:7], v[208:211], v[28:31]
s_add_u32 s65, s84, 98304
ds_read_b64_tr_b16 a[36:37], v89 offset:24576
v_mfma_f32_16x16x32_bf16 v[60:63], a[4:7], v[212:215], v[60:63]
s_waitcnt lgkmcnt(13)
buffer_load_dwordx4 v[192:195], v16, s[44:47], s65 offen offset:0 sc1
v_mfma_f32_16x16x32_bf16 v[32:35], a[8:11], v[208:211], v[32:35]
ds_read_b64_tr_b16 a[38:39], v89 offset:28672
v_mfma_f32_16x16x32_bf16 v[64:67], a[8:11], v[212:215], v[64:67]
s_waitcnt lgkmcnt(12)
ds_read_b64_tr_b16 a[40:41], v90 offset:24576
v_mfma_f32_16x16x32_bf16 v[36:39], a[12:15], v[208:211], v[36:39]
ds_read_b64_tr_b16 a[42:43], v90 offset:28672
ds_read_b64_tr_b16 a[44:45], v91 offset:24576
buffer_load_dwordx4 v[196:199], v16, s[44:47], s65 offen offset:1024 sc1
v_mfma_f32_16x16x32_bf16 v[68:71], a[12:15], v[212:215], v[68:71]
s_waitcnt lgkmcnt(13)
ds_read_b64_tr_b16 a[46:47], v91 offset:28672
v_mfma_f32_16x16x32_bf16 v[40:43], a[16:19], v[208:211], v[40:43]
ds_read_b64_tr_b16 a[48:49], v92 offset:24576
v_mfma_f32_16x16x32_bf16 v[72:75], a[16:19], v[212:215], v[72:75]
s_waitcnt lgkmcnt(13)
s_add_u32 s65, s84, 106496
ds_read_b64_tr_b16 a[50:51], v92 offset:28672
v_mfma_f32_16x16x32_bf16 v[44:47], a[20:23], v[208:211], v[44:47]
ds_read_b64_tr_b16 a[52:53], v93 offset:24576
ds_read_b64_tr_b16 a[54:55], v93 offset:28672
buffer_load_dwordx4 v[200:203], v16, s[44:47], s65 offen offset:0 sc1
v_mfma_f32_16x16x32_bf16 v[76:79], a[20:23], v[212:215], v[76:79]
s_waitcnt lgkmcnt(14)
ds_read_b64_tr_b16 a[56:57], v94 offset:24576
v_mfma_f32_16x16x32_bf16 v[48:51], a[24:27], v[208:211], v[48:51]
ds_read_b64_tr_b16 a[58:59], v94 offset:28672
v_mfma_f32_16x16x32_bf16 v[80:83], a[24:27], v[212:215], v[80:83]
s_waitcnt lgkmcnt(14)
ds_read_b64_tr_b16 a[60:61], v95 offset:24576
v_mfma_f32_16x16x32_bf16 v[52:55], a[28:31], v[208:211], v[52:55]
ds_read_b64_tr_b16 a[62:63], v95 offset:28672
buffer_load_dwordx4 v[204:207], v16, s[44:47], s65 offen offset:1024 sc1
v_mfma_f32_16x16x32_bf16 v[84:87], a[28:31], v[212:215], v[84:87]
s_waitcnt vmcnt(20)
s_barrier
s_waitcnt lgkmcnt(14)
v_mfma_f32_16x16x32_bf16 v[24:27], a[32:35], v[216:219], v[24:27]
s_add_u32 m0, s86, 49152
ds_read_b64_tr_b16 a[0:1], v104 offset:32768
v_mfma_f32_16x16x32_bf16 v[56:59], a[32:35], v[220:223], v[56:59]
s_waitcnt lgkmcnt(13)
s_add_u32 s64, s85, 917504
ds_read_b64_tr_b16 a[2:3], v104 offset:36864
v_mfma_f32_16x16x32_bf16 v[28:31], a[36:39], v[216:219], v[28:31]
buffer_load_dwordx4 v17, s[40:43], s64 offen lds
v_mfma_f32_16x16x32_bf16 v[60:63], a[36:39], v[220:223], v[60:63]
s_waitcnt lgkmcnt(12)
s_add_u32 m0, s86, 50176
ds_read_b64_tr_b16 a[4:5], v105 offset:32768
v_mfma_f32_16x16x32_bf16 v[32:35], a[40:43], v[216:219], v[32:35]
s_add_u32 s64, s85, 925696
ds_read_b64_tr_b16 a[6:7], v105 offset:36864
v_mfma_f32_16x16x32_bf16 v[64:67], a[40:43], v[220:223], v[64:67]
s_waitcnt lgkmcnt(12)
ds_read_b64_tr_b16 a[8:9], v106 offset:32768
buffer_load_dwordx4 v18, s[40:43], s64 offen lds
v_mfma_f32_16x16x32_bf16 v[36:39], a[44:47], v[216:219], v[36:39]
ds_read_b64_tr_b16 a[10:11], v106 offset:36864
ds_read_b64_tr_b16 a[12:13], v107 offset:32768
v_mfma_f32_16x16x32_bf16 v[68:71], a[44:47], v[220:223], v[68:71]
s_waitcnt lgkmcnt(13)
s_add_u32 m0, s86, 51200
ds_read_b64_tr_b16 a[14:15], v107 offset:36864
v_mfma_f32_16x16x32_bf16 v[40:43], a[48:51], v[216:219], v[40:43]
s_add_u32 s64, s85, 933888
ds_read_b64_tr_b16 a[16:17], v108 offset:32768
v_mfma_f32_16x16x32_bf16 v[72:75], a[48:51], v[220:223], v[72:75]
s_waitcnt lgkmcnt(13)
ds_read_b64_tr_b16 a[18:19], v108 offset:36864
buffer_load_dwordx4 v17, s[40:43], s64 offen lds
v_mfma_f32_16x16x32_bf16 v[44:47], a[52:55], v[216:219], v[44:47]
ds_read_b64_tr_b16 a[20:21], v109 offset:32768
ds_read_b64_tr_b16 a[22:23], v109 offset:36864
v_mfma_f32_16x16x32_bf16 v[76:79], a[52:55], v[220:223], v[76:79]
s_waitcnt lgkmcnt(14)
s_add_u32 m0, s86, 52224
ds_read_b64_tr_b16 a[24:25], v110 offset:32768
v_mfma_f32_16x16x32_bf16 v[48:51], a[56:59], v[216:219], v[48:51]
s_add_u32 s64, s85, 942080
ds_read_b64_tr_b16 a[26:27], v110 offset:36864
v_mfma_f32_16x16x32_bf16 v[80:83], a[56:59], v[220:223], v[80:83]
s_waitcnt lgkmcnt(14)
ds_read_b64_tr_b16 a[28:29], v111 offset:32768
buffer_load_dwordx4 v18, s[40:43], s64 offen lds
v_mfma_f32_16x16x32_bf16 v[52:55], a[60:63], v[216:219], v[52:55]
ds_read_b64_tr_b16 a[30:31], v111 offset:36864
v_mfma_f32_16x16x32_bf16 v[84:87], a[60:63], v[220:223], v[84:87]
s_waitcnt vmcnt(23)
s_waitcnt lgkmcnt(14)
v_mfma_f32_16x16x32_bf16 v[24:27], a[0:3], v[224:227], v[24:27]
s_waitcnt vmcnt(22)
ds_read_b64_tr_b16 a[32:33], v104 offset:40960
v_mfma_f32_16x16x32_bf16 v[56:59], a[0:3], v[228:231], v[56:59]
s_waitcnt lgkmcnt(13)
ds_read_b64_tr_b16 a[34:35], v104 offset:45056
v_mfma_f32_16x16x32_bf16 v[28:31], a[4:7], v[224:227], v[28:31]
s_add_u32 s65, s84, 114688
ds_read_b64_tr_b16 a[36:37], v105 offset:40960
v_mfma_f32_16x16x32_bf16 v[60:63], a[4:7], v[228:231], v[60:63]
s_waitcnt lgkmcnt(13)
buffer_load_dwordx4 v[208:211], v16, s[44:47], s65 offen offset:0 sc1
v_mfma_f32_16x16x32_bf16 v[32:35], a[8:11], v[224:227], v[32:35]
ds_read_b64_tr_b16 a[38:39], v105 offset:45056
v_mfma_f32_16x16x32_bf16 v[64:67], a[8:11], v[228:231], v[64:67]
s_waitcnt lgkmcnt(12)
ds_read_b64_tr_b16 a[40:41], v106 offset:40960
v_mfma_f32_16x16x32_bf16 v[36:39], a[12:15], v[224:227], v[36:39]
ds_read_b64_tr_b16 a[42:43], v106 offset:45056
ds_read_b64_tr_b16 a[44:45], v107 offset:40960
v_mfma_f32_16x16x32_bf16 v[68:71], a[12:15], v[228:231], v[68:71]
s_waitcnt lgkmcnt(13)
ds_read_b64_tr_b16 a[46:47], v107 offset:45056
v_mfma_f32_16x16x32_bf16 v[40:43], a[16:19], v[224:227], v[40:43]
ds_read_b64_tr_b16 a[48:49], v108 offset:40960
v_mfma_f32_16x16x32_bf16 v[72:75], a[16:19], v[228:231], v[72:75]
s_waitcnt lgkmcnt(13)
ds_read_b64_tr_b16 a[50:51], v108 offset:45056
v_mfma_f32_16x16x32_bf16 v[44:47], a[20:23], v[224:227], v[44:47]
ds_read_b64_tr_b16 a[52:53], v109 offset:40960
ds_read_b64_tr_b16 a[54:55], v109 offset:45056
buffer_load_dwordx4 v[212:215], v16, s[44:47], s65 offen offset:1024 sc1
v_mfma_f32_16x16x32_bf16 v[76:79], a[20:23], v[228:231], v[76:79]
s_waitcnt lgkmcnt(14)
ds_read_b64_tr_b16 a[56:57], v110 offset:40960
v_mfma_f32_16x16x32_bf16 v[48:51], a[24:27], v[224:227], v[48:51]
ds_read_b64_tr_b16 a[58:59], v110 offset:45056
v_mfma_f32_16x16x32_bf16 v[80:83], a[24:27], v[228:231], v[80:83]
s_waitcnt lgkmcnt(14)
ds_read_b64_tr_b16 a[60:61], v111 offset:40960
v_mfma_f32_16x16x32_bf16 v[52:55], a[28:31], v[224:227], v[52:55]
ds_read_b64_tr_b16 a[62:63], v111 offset:45056
v_mfma_f32_16x16x32_bf16 v[84:87], a[28:31], v[228:231], v[84:87]
s_waitcnt vmcnt(18)
s_barrier
s_waitcnt lgkmcnt(14)
v_mfma_f32_16x16x32_bf16 v[24:27], a[32:35], v[232:235], v[24:27]
ds_read_b64_tr_b16 a[0:1], v104 offset:49152
v_mfma_f32_16x16x32_bf16 v[56:59], a[32:35], v[236:239], v[56:59]
s_waitcnt lgkmcnt(13)
s_add_u32 s65, s84, 122880
ds_read_b64_tr_b16 a[2:3], v104 offset:53248
v_mfma_f32_16x16x32_bf16 v[28:31], a[36:39], v[232:235], v[28:31]
buffer_load_dwordx4 v[216:219], v16, s[44:47], s65 offen offset:0 sc1
v_mfma_f32_16x16x32_bf16 v[60:63], a[36:39], v[236:239], v[60:63]
s_waitcnt lgkmcnt(12)
ds_read_b64_tr_b16 a[4:5], v105 offset:49152
v_mfma_f32_16x16x32_bf16 v[32:35], a[40:43], v[232:235], v[32:35]
ds_read_b64_tr_b16 a[6:7], v105 offset:53248
v_mfma_f32_16x16x32_bf16 v[64:67], a[40:43], v[236:239], v[64:67]
s_waitcnt lgkmcnt(12)
ds_read_b64_tr_b16 a[8:9], v106 offset:49152
v_mfma_f32_16x16x32_bf16 v[36:39], a[44:47], v[232:235], v[36:39]
ds_read_b64_tr_b16 a[10:11], v106 offset:53248
ds_read_b64_tr_b16 a[12:13], v107 offset:49152
v_mfma_f32_16x16x32_bf16 v[68:71], a[44:47], v[236:239], v[68:71]
s_waitcnt lgkmcnt(13)
ds_read_b64_tr_b16 a[14:15], v107 offset:53248
v_mfma_f32_16x16x32_bf16 v[40:43], a[48:51], v[232:235], v[40:43]
ds_read_b64_tr_b16 a[16:17], v108 offset:49152
v_mfma_f32_16x16x32_bf16 v[72:75], a[48:51], v[236:239], v[72:75]
s_waitcnt lgkmcnt(13)
ds_read_b64_tr_b16 a[18:19], v108 offset:53248
buffer_load_dwordx4 v[220:223], v16, s[44:47], s65 offen offset:1024 sc1
v_mfma_f32_16x16x32_bf16 v[44:47], a[52:55], v[232:235], v[44:47]
ds_read_b64_tr_b16 a[20:21], v109 offset:49152
ds_read_b64_tr_b16 a[22:23], v109 offset:53248
v_mfma_f32_16x16x32_bf16 v[76:79], a[52:55], v[236:239], v[76:79]
s_waitcnt lgkmcnt(14)
ds_read_b64_tr_b16 a[24:25], v110 offset:49152
v_mfma_f32_16x16x32_bf16 v[48:51], a[56:59], v[232:235], v[48:51]
ds_read_b64_tr_b16 a[26:27], v110 offset:53248
v_mfma_f32_16x16x32_bf16 v[80:83], a[56:59], v[236:239], v[80:83]
s_waitcnt lgkmcnt(14)
ds_read_b64_tr_b16 a[28:29], v111 offset:49152
v_mfma_f32_16x16x32_bf16 v[52:55], a[60:63], v[232:235], v[52:55]
ds_read_b64_tr_b16 a[30:31], v111 offset:53248
v_mfma_f32_16x16x32_bf16 v[84:87], a[60:63], v[236:239], v[84:87]
s_waitcnt vmcnt(19)
s_waitcnt lgkmcnt(14)
v_mfma_f32_16x16x32_bf16 v[24:27], a[0:3], v[240:243], v[24:27]
s_waitcnt vmcnt(18)
ds_read_b64_tr_b16 a[32:33], v104 offset:57344
v_mfma_f32_16x16x32_bf16 v[56:59], a[0:3], v[244:247], v[56:59]
s_waitcnt lgkmcnt(13)
ds_read_b64_tr_b16 a[34:35], v104 offset:61440
v_mfma_f32_16x16x32_bf16 v[28:31], a[4:7], v[240:243], v[28:31]
ds_read_b64_tr_b16 a[36:37], v105 offset:57344
v_mfma_f32_16x16x32_bf16 v[60:63], a[4:7], v[244:247], v[60:63]
s_waitcnt lgkmcnt(13)
ds_read_b64_tr_b16 a[38:39], v105 offset:61440
v_mfma_f32_16x16x32_bf16 v[32:35], a[8:11], v[240:243], v[32:35]
ds_read_b64_tr_b16 a[40:41], v106 offset:57344
v_mfma_f32_16x16x32_bf16 v[64:67], a[8:11], v[244:247], v[64:67]
s_waitcnt lgkmcnt(13)
ds_read_b64_tr_b16 a[42:43], v106 offset:61440
v_mfma_f32_16x16x32_bf16 v[36:39], a[12:15], v[240:243], v[36:39]
ds_read_b64_tr_b16 a[44:45], v107 offset:57344
v_mfma_f32_16x16x32_bf16 v[68:71], a[12:15], v[244:247], v[68:71]
s_waitcnt lgkmcnt(13)
ds_read_b64_tr_b16 a[46:47], v107 offset:61440
v_mfma_f32_16x16x32_bf16 v[40:43], a[16:19], v[240:243], v[40:43]
ds_read_b64_tr_b16 a[48:49], v108 offset:57344
v_mfma_f32_16x16x32_bf16 v[72:75], a[16:19], v[244:247], v[72:75]
s_waitcnt lgkmcnt(13)
ds_read_b64_tr_b16 a[50:51], v108 offset:61440
v_mfma_f32_16x16x32_bf16 v[44:47], a[20:23], v[240:243], v[44:47]
ds_read_b64_tr_b16 a[52:53], v109 offset:57344
ds_read_b64_tr_b16 a[54:55], v109 offset:61440
v_mfma_f32_16x16x32_bf16 v[76:79], a[20:23], v[244:247], v[76:79]
s_waitcnt lgkmcnt(14)
ds_read_b64_tr_b16 a[56:57], v110 offset:57344
v_mfma_f32_16x16x32_bf16 v[48:51], a[24:27], v[240:243], v[48:51]
ds_read_b64_tr_b16 a[58:59], v110 offset:61440
v_mfma_f32_16x16x32_bf16 v[80:83], a[24:27], v[244:247], v[80:83]
s_waitcnt lgkmcnt(14)
ds_read_b64_tr_b16 a[60:61], v111 offset:57344
v_mfma_f32_16x16x32_bf16 v[52:55], a[28:31], v[240:243], v[52:55]
ds_read_b64_tr_b16 a[62:63], v111 offset:61440
v_mfma_f32_16x16x32_bf16 v[84:87], a[28:31], v[244:247], v[84:87]
s_waitcnt vmcnt(12)
s_barrier
s_waitcnt lgkmcnt(14)
v_mfma_f32_16x16x32_bf16 v[24:27], a[32:35], v[248:251], v[24:27]
ds_read_b64_tr_b16 a[0:1], v104 offset:0
v_mfma_f32_16x16x32_bf16 v[56:59], a[32:35], v[252:255], v[56:59]
s_waitcnt lgkmcnt(13)
ds_read_b64_tr_b16 a[2:3], v104 offset:4096
v_mfma_f32_16x16x32_bf16 v[28:31], a[36:39], v[248:251], v[28:31]
ds_read_b64_tr_b16 a[4:5], v105 offset:0
v_mfma_f32_16x16x32_bf16 v[60:63], a[36:39], v[252:255], v[60:63]
s_waitcnt lgkmcnt(13)
ds_read_b64_tr_b16 a[6:7], v105 offset:4096
v_mfma_f32_16x16x32_bf16 v[32:35], a[40:43], v[248:251], v[32:35]
ds_read_b64_tr_b16 a[8:9], v106 offset:0
v_mfma_f32_16x16x32_bf16 v[64:67], a[40:43], v[252:255], v[64:67]
s_waitcnt lgkmcnt(13)
ds_read_b64_tr_b16 a[10:11], v106 offset:4096
v_mfma_f32_16x16x32_bf16 v[36:39], a[44:47], v[248:251], v[36:39]
ds_read_b64_tr_b16 a[12:13], v107 offset:0
v_mfma_f32_16x16x32_bf16 v[68:71], a[44:47], v[252:255], v[68:71]
s_waitcnt lgkmcnt(13)
ds_read_b64_tr_b16 a[14:15], v107 offset:4096
v_mfma_f32_16x16x32_bf16 v[40:43], a[48:51], v[248:251], v[40:43]
ds_read_b64_tr_b16 a[16:17], v108 offset:0
v_mfma_f32_16x16x32_bf16 v[72:75], a[48:51], v[252:255], v[72:75]
s_waitcnt lgkmcnt(13)
ds_read_b64_tr_b16 a[18:19], v108 offset:4096
v_mfma_f32_16x16x32_bf16 v[44:47], a[52:55], v[248:251], v[44:47]
ds_read_b64_tr_b16 a[20:21], v109 offset:0
ds_read_b64_tr_b16 a[22:23], v109 offset:4096
v_mfma_f32_16x16x32_bf16 v[76:79], a[52:55], v[252:255], v[76:79]
s_waitcnt lgkmcnt(14)
ds_read_b64_tr_b16 a[24:25], v110 offset:0
v_mfma_f32_16x16x32_bf16 v[48:51], a[56:59], v[248:251], v[48:51]
ds_read_b64_tr_b16 a[26:27], v110 offset:4096
v_mfma_f32_16x16x32_bf16 v[80:83], a[56:59], v[252:255], v[80:83]
s_waitcnt lgkmcnt(14)
ds_read_b64_tr_b16 a[28:29], v111 offset:0
v_mfma_f32_16x16x32_bf16 v[52:55], a[60:63], v[248:251], v[52:55]
ds_read_b64_tr_b16 a[30:31], v111 offset:4096
v_mfma_f32_16x16x32_bf16 v[84:87], a[60:63], v[252:255], v[84:87]
s_waitcnt vmcnt(11)
s_waitcnt lgkmcnt(14)
v_mfma_f32_16x16x32_bf16 v[24:27], a[0:3], v[192:195], v[24:27]
s_waitcnt vmcnt(10)
ds_read_b64_tr_b16 a[32:33], v104 offset:8192
v_mfma_f32_16x16x32_bf16 v[56:59], a[0:3], v[196:199], v[56:59]
s_waitcnt lgkmcnt(13)
ds_read_b64_tr_b16 a[34:35], v104 offset:12288
v_mfma_f32_16x16x32_bf16 v[28:31], a[4:7], v[192:195], v[28:31]
ds_read_b64_tr_b16 a[36:37], v105 offset:8192
v_mfma_f32_16x16x32_bf16 v[60:63], a[4:7], v[196:199], v[60:63]
s_waitcnt lgkmcnt(13)
ds_read_b64_tr_b16 a[38:39], v105 offset:12288
v_mfma_f32_16x16x32_bf16 v[32:35], a[8:11], v[192:195], v[32:35]
ds_read_b64_tr_b16 a[40:41], v106 offset:8192
v_mfma_f32_16x16x32_bf16 v[64:67], a[8:11], v[196:199], v[64:67]
s_waitcnt lgkmcnt(13)
ds_read_b64_tr_b16 a[42:43], v106 offset:12288
v_mfma_f32_16x16x32_bf16 v[36:39], a[12:15], v[192:195], v[36:39]
ds_read_b64_tr_b16 a[44:45], v107 offset:8192
v_mfma_f32_16x16x32_bf16 v[68:71], a[12:15], v[196:199], v[68:71]
s_waitcnt lgkmcnt(13)
ds_read_b64_tr_b16 a[46:47], v107 offset:12288
v_mfma_f32_16x16x32_bf16 v[40:43], a[16:19], v[192:195], v[40:43]
ds_read_b64_tr_b16 a[48:49], v108 offset:8192
v_mfma_f32_16x16x32_bf16 v[72:75], a[16:19], v[196:199], v[72:75]
s_waitcnt lgkmcnt(13)
ds_read_b64_tr_b16 a[50:51], v108 offset:12288
v_mfma_f32_16x16x32_bf16 v[44:47], a[20:23], v[192:195], v[44:47]
ds_read_b64_tr_b16 a[52:53], v109 offset:8192
ds_read_b64_tr_b16 a[54:55], v109 offset:12288
v_mfma_f32_16x16x32_bf16 v[76:79], a[20:23], v[196:199], v[76:79]
s_waitcnt lgkmcnt(14)
ds_read_b64_tr_b16 a[56:57], v110 offset:8192
v_mfma_f32_16x16x32_bf16 v[48:51], a[24:27], v[192:195], v[48:51]
ds_read_b64_tr_b16 a[58:59], v110 offset:12288
v_mfma_f32_16x16x32_bf16 v[80:83], a[24:27], v[196:199], v[80:83]
s_waitcnt lgkmcnt(14)
ds_read_b64_tr_b16 a[60:61], v111 offset:8192
v_mfma_f32_16x16x32_bf16 v[52:55], a[28:31], v[192:195], v[52:55]
ds_read_b64_tr_b16 a[62:63], v111 offset:12288
v_mfma_f32_16x16x32_bf16 v[84:87], a[28:31], v[196:199], v[84:87]
s_waitcnt vmcnt(4)
s_barrier
s_waitcnt lgkmcnt(14)
v_mfma_f32_16x16x32_bf16 v[24:27], a[32:35], v[200:203], v[24:27]
ds_read_b64_tr_b16 a[0:1], v104 offset:16384
v_mfma_f32_16x16x32_bf16 v[56:59], a[32:35], v[204:207], v[56:59]
s_waitcnt lgkmcnt(13)
ds_read_b64_tr_b16 a[2:3], v104 offset:20480
v_mfma_f32_16x16x32_bf16 v[28:31], a[36:39], v[200:203], v[28:31]
ds_read_b64_tr_b16 a[4:5], v105 offset:16384
v_mfma_f32_16x16x32_bf16 v[60:63], a[36:39], v[204:207], v[60:63]
s_waitcnt lgkmcnt(13)
ds_read_b64_tr_b16 a[6:7], v105 offset:20480
v_mfma_f32_16x16x32_bf16 v[32:35], a[40:43], v[200:203], v[32:35]
ds_read_b64_tr_b16 a[8:9], v106 offset:16384
v_mfma_f32_16x16x32_bf16 v[64:67], a[40:43], v[204:207], v[64:67]
s_waitcnt lgkmcnt(13)
ds_read_b64_tr_b16 a[10:11], v106 offset:20480
v_mfma_f32_16x16x32_bf16 v[36:39], a[44:47], v[200:203], v[36:39]
ds_read_b64_tr_b16 a[12:13], v107 offset:16384
v_mfma_f32_16x16x32_bf16 v[68:71], a[44:47], v[204:207], v[68:71]
s_waitcnt lgkmcnt(13)
ds_read_b64_tr_b16 a[14:15], v107 offset:20480
v_mfma_f32_16x16x32_bf16 v[40:43], a[48:51], v[200:203], v[40:43]
ds_read_b64_tr_b16 a[16:17], v108 offset:16384
v_mfma_f32_16x16x32_bf16 v[72:75], a[48:51], v[204:207], v[72:75]
s_waitcnt lgkmcnt(13)
ds_read_b64_tr_b16 a[18:19], v108 offset:20480
v_mfma_f32_16x16x32_bf16 v[44:47], a[52:55], v[200:203], v[44:47]
ds_read_b64_tr_b16 a[20:21], v109 offset:16384
ds_read_b64_tr_b16 a[22:23], v109 offset:20480
v_mfma_f32_16x16x32_bf16 v[76:79], a[52:55], v[204:207], v[76:79]
s_waitcnt lgkmcnt(14)
ds_read_b64_tr_b16 a[24:25], v110 offset:16384
v_mfma_f32_16x16x32_bf16 v[48:51], a[56:59], v[200:203], v[48:51]
ds_read_b64_tr_b16 a[26:27], v110 offset:20480
v_mfma_f32_16x16x32_bf16 v[80:83], a[56:59], v[204:207], v[80:83]
s_waitcnt lgkmcnt(14)
ds_read_b64_tr_b16 a[28:29], v111 offset:16384
v_mfma_f32_16x16x32_bf16 v[52:55], a[60:63], v[200:203], v[52:55]
ds_read_b64_tr_b16 a[30:31], v111 offset:20480
v_mfma_f32_16x16x32_bf16 v[84:87], a[60:63], v[204:207], v[84:87]
s_waitcnt vmcnt(3)
s_waitcnt lgkmcnt(14)
v_mfma_f32_16x16x32_bf16 v[24:27], a[0:3], v[208:211], v[24:27]
s_waitcnt vmcnt(2)
ds_read_b64_tr_b16 a[32:33], v104 offset:24576
v_mfma_f32_16x16x32_bf16 v[56:59], a[0:3], v[212:215], v[56:59]
s_waitcnt lgkmcnt(13)
ds_read_b64_tr_b16 a[34:35], v104 offset:28672
v_mfma_f32_16x16x32_bf16 v[28:31], a[4:7], v[208:211], v[28:31]
ds_read_b64_tr_b16 a[36:37], v105 offset:24576
v_mfma_f32_16x16x32_bf16 v[60:63], a[4:7], v[212:215], v[60:63]
s_waitcnt lgkmcnt(13)
ds_read_b64_tr_b16 a[38:39], v105 offset:28672
v_mfma_f32_16x16x32_bf16 v[32:35], a[8:11], v[208:211], v[32:35]
ds_read_b64_tr_b16 a[40:41], v106 offset:24576
v_mfma_f32_16x16x32_bf16 v[64:67], a[8:11], v[212:215], v[64:67]
s_waitcnt lgkmcnt(13)
ds_read_b64_tr_b16 a[42:43], v106 offset:28672
v_mfma_f32_16x16x32_bf16 v[36:39], a[12:15], v[208:211], v[36:39]
ds_read_b64_tr_b16 a[44:45], v107 offset:24576
v_mfma_f32_16x16x32_bf16 v[68:71], a[12:15], v[212:215], v[68:71]
s_waitcnt lgkmcnt(13)
ds_read_b64_tr_b16 a[46:47], v107 offset:28672
v_mfma_f32_16x16x32_bf16 v[40:43], a[16:19], v[208:211], v[40:43]
ds_read_b64_tr_b16 a[48:49], v108 offset:24576
v_mfma_f32_16x16x32_bf16 v[72:75], a[16:19], v[212:215], v[72:75]
s_waitcnt lgkmcnt(13)
ds_read_b64_tr_b16 a[50:51], v108 offset:28672
v_mfma_f32_16x16x32_bf16 v[44:47], a[20:23], v[208:211], v[44:47]
ds_read_b64_tr_b16 a[52:53], v109 offset:24576
ds_read_b64_tr_b16 a[54:55], v109 offset:28672
v_mfma_f32_16x16x32_bf16 v[76:79], a[20:23], v[212:215], v[76:79]
s_waitcnt lgkmcnt(14)
ds_read_b64_tr_b16 a[56:57], v110 offset:24576
v_mfma_f32_16x16x32_bf16 v[48:51], a[24:27], v[208:211], v[48:51]
ds_read_b64_tr_b16 a[58:59], v110 offset:28672
v_mfma_f32_16x16x32_bf16 v[80:83], a[24:27], v[212:215], v[80:83]
s_waitcnt lgkmcnt(14)
ds_read_b64_tr_b16 a[60:61], v111 offset:24576
v_mfma_f32_16x16x32_bf16 v[52:55], a[28:31], v[208:211], v[52:55]
ds_read_b64_tr_b16 a[62:63], v111 offset:28672
v_mfma_f32_16x16x32_bf16 v[84:87], a[28:31], v[212:215], v[84:87]
s_waitcnt vmcnt(1)
s_waitcnt lgkmcnt(14)
v_mfma_f32_16x16x32_bf16 v[24:27], a[32:35], v[216:219], v[24:27]
s_waitcnt vmcnt(0)
v_mfma_f32_16x16x32_bf16 v[56:59], a[32:35], v[220:223], v[56:59]
s_waitcnt lgkmcnt(12)
v_mfma_f32_16x16x32_bf16 v[28:31], a[36:39], v[216:219], v[28:31]
v_mfma_f32_16x16x32_bf16 v[60:63], a[36:39], v[220:223], v[60:63]
s_waitcnt lgkmcnt(10)
v_mfma_f32_16x16x32_bf16 v[32:35], a[40:43], v[216:219], v[32:35]
v_mfma_f32_16x16x32_bf16 v[64:67], a[40:43], v[220:223], v[64:67]
s_waitcnt lgkmcnt(8)
v_mfma_f32_16x16x32_bf16 v[36:39], a[44:47], v[216:219], v[36:39]
v_mfma_f32_16x16x32_bf16 v[68:71], a[44:47], v[220:223], v[68:71]
s_waitcnt lgkmcnt(6)
v_mfma_f32_16x16x32_bf16 v[40:43], a[48:51], v[216:219], v[40:43]
v_mfma_f32_16x16x32_bf16 v[72:75], a[48:51], v[220:223], v[72:75]
s_waitcnt lgkmcnt(4)
v_mfma_f32_16x16x32_bf16 v[44:47], a[52:55], v[216:219], v[44:47]
v_mfma_f32_16x16x32_bf16 v[76:79], a[52:55], v[220:223], v[76:79]
s_waitcnt lgkmcnt(2)
v_mfma_f32_16x16x32_bf16 v[48:51], a[56:59], v[216:219], v[48:51]
v_mfma_f32_16x16x32_bf16 v[80:83], a[56:59], v[220:223], v[80:83]
s_waitcnt lgkmcnt(0)
v_mfma_f32_16x16x32_bf16 v[52:55], a[60:63], v[216:219], v[52:55]
v_mfma_f32_16x16x32_bf16 v[84:87], a[60:63], v[220:223], v[84:87]
s_xor_b32 s66, s2, 4
s_lshl2_add_u32 s66, s66, s30
s_lshl_b32 s67, s66, 13
s_add_u32 s67, s67, 67108864
s_add_u32 s68, s67, 4096
s_lshl_b32 s71, s66, 6
s_lshl2_add_u32 s66, s2, s30
s_lshl_b32 s72, s66, 6
s_lshl_b32 s73, s66, 13
s_add_u32 s73, s73, 67108864
s_add_u32 s74, s73, 4096
s_add_u32 s52, s28, 59834368
s_addc_u32 s53, s29, 0
s_mov_b32 s54, 65536
s_mov_b32 s55, 0x20000
buffer_store_dwordx4 v[40:43], v16, s[44:47], s67 offen offset:0 sc1
buffer_store_dwordx4 v[44:47], v16, s[44:47], s67 offen offset:1024 sc1
buffer_store_dwordx4 v[48:51], v16, s[44:47], s67 offen offset:2048 sc1
buffer_store_dwordx4 v[52:55], v16, s[44:47], s67 offen offset:3072 sc1
buffer_store_dwordx4 v[72:75], v16, s[44:47], s68 offen offset:0 sc1
buffer_store_dwordx4 v[76:79], v16, s[44:47], s68 offen offset:1024 sc1
buffer_store_dwordx4 v[80:83], v16, s[44:47], s68 offen offset:2048 sc1
buffer_store_dwordx4 v[84:87], v16, s[44:47], s68 offen offset:3072 sc1
s_mov_b32 s48, s24
s_mov_b32 s49, s25
s_mov_b32 s50, 4194304
s_mov_b32 s51, 0x20000
v_lshlrev_b32 v1, 24, v0
s_lshl_b32 s75, s82, 18
s_lshl_b32 s66, s30, 16
s_add_u32 s75, s75, s66
s_add_u32 s75, s75, s87
s_lshl_b32 s66, s83, 7
s_add_u32 s75, s75, s66
s_add_u32 s76, s75, 32768
v_and_b32 v8, 15, v0
v_lshlrev_b32 v8, 11, v8
v_bfe_u32 v10, v0, 4, 1
v_lshl_add_u32 v8, v10, 5, v8
v_lshrrev_b32 v10, 5, v0
v_lshl_add_u32 v8, v10, 4, v8
s_waitcnt vmcnt(0)
buffer_store_dword a251, v1, s[52:55], s71 offen sc1
buffer_load_dword v19, off, s[52:55], s72 sc1
s_waitcnt vmcnt(0)
v_readfirstlane_b32 s66, v19
s_nop 0
s_cmp_lt_u32 s66, 1
s_cbranch_scc1 L_spin_2025
L_spinbk_2026:
buffer_load_dwordx4 v[40:43], v16, s[44:47], s73 offen offset:0 sc1
buffer_load_dwordx4 v[44:47], v16, s[44:47], s73 offen offset:1024 sc1
buffer_load_dwordx4 v[48:51], v16, s[44:47], s73 offen offset:2048 sc1
buffer_load_dwordx4 v[52:55], v16, s[44:47], s73 offen offset:3072 sc1
buffer_load_dwordx4 v[72:75], v16, s[44:47], s74 offen offset:0 sc1
buffer_load_dwordx4 v[76:79], v16, s[44:47], s74 offen offset:1024 sc1
buffer_load_dwordx4 v[80:83], v16, s[44:47], s74 offen offset:2048 sc1
buffer_load_dwordx4 v[84:87], v16, s[44:47], s74 offen offset:3072 sc1
s_waitcnt vmcnt(7)
v_add_f32 v24, v24, v40
v_add_f32 v25, v25, v41
v_add_f32 v26, v26, v42
v_add_f32 v27, v27, v43
s_waitcnt vmcnt(6)
v_add_f32 v28, v28, v44
v_add_f32 v29, v29, v45
v_add_f32 v30, v30, v46
v_add_f32 v31, v31, v47
v_cvt_pk_bf16_f32 v24, v24, v25
v_cvt_pk_bf16_f32 v25, v26, v27
v_cvt_pk_bf16_f32 v26, v28, v29
v_cvt_pk_bf16_f32 v27, v30, v31
s_nop 1
v_permlane16_swap_b32 v24, v26
v_permlane16_swap_b32 v25, v27
buffer_store_dwordx4 v[24:27], v8, s[48:51], s75 offen offset:0
s_waitcnt vmcnt(6)
v_add_f32 v32, v32, v48
v_add_f32 v33, v33, v49
v_add_f32 v34, v34, v50
v_add_f32 v35, v35, v51
s_waitcnt vmcnt(5)
v_add_f32 v36, v36, v52
v_add_f32 v37, v37, v53
v_add_f32 v38, v38, v54
v_add_f32 v39, v39, v55
v_cvt_pk_bf16_f32 v32, v32, v33
v_cvt_pk_bf16_f32 v33, v34, v35
v_cvt_pk_bf16_f32 v34, v36, v37
v_cvt_pk_bf16_f32 v35, v38, v39
s_nop 1
v_permlane16_swap_b32 v32, v34
v_permlane16_swap_b32 v33, v35
buffer_store_dwordx4 v[32:35], v8, s[48:51], s75 offen offset:64
s_waitcnt vmcnt(5)
v_add_f32 v56, v56, v72
v_add_f32 v57, v57, v73
v_add_f32 v58, v58, v74
v_add_f32 v59, v59, v75
s_waitcnt vmcnt(4)
v_add_f32 v60, v60, v76
v_add_f32 v61, v61, v77
v_add_f32 v62, v62, v78
v_add_f32 v63, v63, v79
v_cvt_pk_bf16_f32 v56, v56, v57
v_cvt_pk_bf16_f32 v57, v58, v59
v_cvt_pk_bf16_f32 v58, v60, v61
v_cvt_pk_bf16_f32 v59, v62, v63
s_nop 1
v_permlane16_swap_b32 v56, v58
v_permlane16_swap_b32 v57, v59
buffer_store_dwordx4 v[56:59], v8, s[48:51], s76 offen offset:0
s_waitcnt vmcnt(4)
v_add_f32 v64, v64, v80
v_add_f32 v65, v65, v81
v_add_f32 v66, v66, v82
v_add_f32 v67, v67, v83
s_waitcnt vmcnt(3)
v_add_f32 v68, v68, v84
v_add_f32 v69, v69, v85
v_add_f32 v70, v70, v86
v_add_f32 v71, v71, v87
v_cvt_pk_bf16_f32 v64, v64, v65
v_cvt_pk_bf16_f32 v65, v66, v67
v_cvt_pk_bf16_f32 v66, v68, v69
v_cvt_pk_bf16_f32 v67, v70, v71
s_nop 1
v_permlane16_swap_b32 v64, v66
v_permlane16_swap_b32 v65, v67
buffer_store_dwordx4 v[64:67], v8, s[48:51], s76 offen offset:64
L_end:
s_endpgm
L_spin_1:
s_mov_b32 s67, 0x8000
L_spinlp_3:
s_sleep 1
buffer_load_dword v1, off, s[52:55], 0 offset:0 sc1
s_waitcnt vmcnt(0)
v_readfirstlane_b32 s66, v1
s_sub_u32 s67, s67, 1
s_cbranch_scc1 L_spinbk_2
s_cmp_lt_u32 s66, 256
s_cbranch_scc1 L_spinlp_3
s_branch L_spinbk_2
L_spin_13:
s_mov_b32 s67, 0x8000
L_spinlp_15:
s_sleep 1
buffer_load_dword v19, off, s[52:55], 0 offset:128 sc1
s_waitcnt vmcnt(0)
v_readfirstlane_b32 s66, v19
s_sub_u32 s67, s67, 1
s_cbranch_scc1 L_spinbk_14
s_cmp_lt_u32 s66, 256
s_cbranch_scc1 L_spinlp_15
s_branch L_spinbk_14
L_spin_1017:
s_mov_b32 s67, 0x8000
L_spinlp_1019:
s_sleep 1
buffer_load_dword v19, off, s[52:55], 0 offset:128 sc1
s_waitcnt vmcnt(0)
v_readfirstlane_b32 s66, v19
s_sub_u32 s67, s67, 1
s_cbranch_scc1 L_spinbk_1018
s_cmp_lt_u32 s66, 256
s_cbranch_scc1 L_spinlp_1019
s_branch L_spinbk_1018
L_F1_5:
v_add_f32 v216, v184, v200
v_add_f32 v217, v184, v201
v_add_f32 v218, v184, v202
v_add_f32 v219, v184, v203
v_add_f32 v220, v184, v204
v_add_f32 v221, v184, v205
v_add_f32 v222, v184, v206
v_add_f32 v223, v184, v207
ds_read_b128 a[144:147], v2 offset:0
ds_read_b128 a[148:151], v2 offset:1024
ds_read_b128 a[152:155], v2 offset:2048
ds_read_b128 a[156:159], v2 offset:3072
ds_read_b128 a[160:163], v2 offset:4096
ds_read_b128 a[164:167], v2 offset:5120
s_mov_b32 m0, s71
s_nop 0
buffer_load_dwordx4 v16, s[32:35], s70 offen offset:0 sc1 lds
buffer_load_dwordx4 v16, s[32:35], s70 offen offset:1024 sc1 lds
s_waitcnt lgkmcnt(5)
v_mfma_f32_16x16x32_bf16 v[88:91], a[144:147], v[24:27], v[216:219]
ds_read_b128 a[168:171], v2 offset:6144
v_mfma_f32_16x16x32_bf16 v[96:99], a[144:147], v[40:43], v[188:191]
buffer_load_dwordx4 v16, s[32:35], s70 offen offset:2048 sc1 lds
v_mfma_f32_16x16x32_bf16 v[104:107], a[144:147], v[56:59], v[192:195]
v_mfma_f32_16x16x32_bf16 v[112:115], a[144:147], v[72:75], v[196:199]
s_waitcnt lgkmcnt(5)
v_mfma_f32_16x16x32_bf16 v[88:91], a[148:151], v[28:31], v[88:91]
ds_read_b128 a[172:175], v2 offset:7168
v_mfma_f32_16x16x32_bf16 v[96:99], a[148:151], v[44:47], v[96:99]
v_mfma_f32_16x16x32_bf16 v[104:107], a[148:151], v[60:63], v[104:107]
v_mfma_f32_16x16x32_bf16 v[112:115], a[148:151], v[76:79], v[112:115]
s_waitcnt lgkmcnt(5)
buffer_load_dwordx4 v16, s[32:35], s70 offen offset:3072 sc1 lds
v_mfma_f32_16x16x32_bf16 v[88:91], a[152:155], v[32:35], v[88:91]
v_mfma_f32_16x16x32_bf16 v[96:99], a[152:155], v[48:51], v[96:99]
v_mfma_f32_16x16x32_bf16 v[104:107], a[152:155], v[64:67], v[104:107]
v_mfma_f32_16x16x32_bf16 v[112:115], a[152:155], v[80:83], v[112:115]
s_waitcnt lgkmcnt(4)
s_add_u32 m0, s71, 4096
v_mfma_f32_16x16x32_bf16 v[88:91], a[156:159], v[36:39], v[88:91]
s_add_u32 s64, s70, 4096
v_mfma_f32_16x16x32_bf16 v[96:99], a[156:159], v[52:55], v[96:99]
buffer_load_dwordx4 v16, s[32:35], s64 offen offset:0 sc1 lds
v_mfma_f32_16x16x32_bf16 v[104:107], a[156:159], v[68:71], v[104:107]
v_mfma_f32_16x16x32_bf16 v[112:115], a[156:159], v[84:87], v[112:115]
s_waitcnt lgkmcnt(3)
v_mfma_f32_16x16x32_bf16 v[92:95], a[160:163], v[24:27], v[220:223]
v_mfma_f32_16x16x32_bf16 v[100:103], a[160:163], v[40:43], v[188:191]
v_mfma_f32_16x16x32_bf16 v[108:111], a[160:163], v[56:59], v[192:195]
v_mfma_f32_16x16x32_bf16 v[116:119], a[160:163], v[72:75], v[196:199]
s_waitcnt lgkmcnt(2)
v_mfma_f32_16x16x32_bf16 v[92:95], a[164:167], v[28:31], v[92:95]
buffer_load_dwordx4 v16, s[32:35], s64 offen offset:1024 sc1 lds
v_mfma_f32_16x16x32_bf16 v[100:103], a[164:167], v[44:47], v[100:103]
v_mfma_f32_16x16x32_bf16 v[108:111], a[164:167], v[60:63], v[108:111]
v_mfma_f32_16x16x32_bf16 v[116:119], a[164:167], v[76:79], v[116:119]
s_waitcnt lgkmcnt(1)
v_mfma_f32_16x16x32_bf16 v[92:95], a[168:171], v[32:35], v[92:95]
v_mfma_f32_16x16x32_bf16 v[100:103], a[168:171], v[48:51], v[100:103]
v_mfma_f32_16x16x32_bf16 v[108:111], a[168:171], v[64:67], v[108:111]
buffer_load_dwordx4 v16, s[32:35], s64 offen offset:2048 sc1 lds
v_mfma_f32_16x16x32_bf16 v[116:119], a[168:171], v[80:83], v[116:119]
s_waitcnt lgkmcnt(0)
v_mfma_f32_16x16x32_bf16 v[92:95], a[172:175], v[36:39], v[92:95]
v_mfma_f32_16x16x32_bf16 v[100:103], a[172:175], v[52:55], v[100:103]
v_mfma_f32_16x16x32_bf16 v[108:111], a[172:175], v[68:71], v[108:111]
v_mfma_f32_16x16x32_bf16 v[116:119], a[172:175], v[84:87], v[116:119]
ds_read_b128 a[144:147], v2 offset:8192
ds_read_b128 a[148:151], v2 offset:9216
ds_read_b128 a[152:155], v2 offset:10240
ds_read_b128 a[156:159], v2 offset:11264
ds_read_b128 a[160:163], v2 offset:12288
ds_read_b128 a[164:167], v2 offset:13312
s_nop 3
s_cmp_eq_u32 s73, 0
s_cselect_b32 s66, -1, 0
v_max3_f32 v20, v88, v89, v90
v_max3_f32 v21, v96, v97, v98
v_max3_f32 v22, v104, v105, v106
v_max3_f32 v23, v112, v113, v114
v_max3_f32 v20, v20, v91, v92
v_max3_f32 v20, v20, v93, v94
v_max_f32 v20, v20, v95
v_max3_f32 v21, v21, v99, v100
v_max3_f32 v21, v21, v101, v102
v_max_f32 v21, v21, v103
v_max3_f32 v22, v22, v107, v108
v_max3_f32 v22, v22, v109, v110
v_max_f32 v22, v22, v111
v_max3_f32 v23, v23, v115, v116
v_max3_f32 v23, v23, v117, v118
v_max_f32 v23, v23, v119
v_mov_b32 v224, v20
v_mov_b32 v225, v21
v_mov_b32 v226, v22
v_mov_b32 v227, v23
v_permlane16_swap_b32 v224, v20
v_permlane16_swap_b32 v225, v21
v_permlane16_swap_b32 v226, v22
v_permlane16_swap_b32 v227, v23
v_max_f32 v20, v20, v224
v_max_f32 v21, v21, v225
v_max_f32 v22, v22, v226
v_max_f32 v23, v23, v227
v_mov_b32 v224, v20
v_mov_b32 v225, v21
v_mov_b32 v226, v22
v_mov_b32 v227, v23
v_permlane32_swap_b32 v224, v20
v_permlane32_swap_b32 v225, v21
v_permlane32_swap_b32 v226, v22
v_permlane32_swap_b32 v227, v23
v_max_f32 v20, v20, v224
v_max_f32 v21, v21, v225
v_max_f32 v22, v22, v226
v_max_f32 v23, v23, v227
v_and_b32 v20, s66, v20
v_and_b32 v21, s66, v21
v_and_b32 v22, s66, v22
v_and_b32 v23, s66, v23
v_sub_f32 v184, v184, v20
v_sub_f32 v185, v185, v20
v_sub_f32 v186, v186, v20
v_sub_f32 v187, v187, v20
v_sub_f32 v188, v188, v21
v_sub_f32 v189, v189, v21
v_sub_f32 v190, v190, v21
v_sub_f32 v191, v191, v21
v_sub_f32 v192, v192, v22
v_sub_f32 v193, v193, v22
v_sub_f32 v194, v194, v22
v_sub_f32 v195, v195, v22
v_sub_f32 v196, v196, v23
v_sub_f32 v197, v197, v23
v_sub_f32 v198, v198, v23
v_sub_f32 v199, v199, v23
v_add_f32 v216, v184, v208
v_add_f32 v217, v184, v209
v_add_f32 v218, v184, v210
v_add_f32 v219, v184, v211
v_add_f32 v220, v184, v212
v_add_f32 v221, v184, v213
v_add_f32 v222, v184, v214
v_add_f32 v223, v184, v215
v_sub_f32 v88, v88, v20
v_sub_f32 v89, v89, v20
v_sub_f32 v90, v90, v20
v_sub_f32 v91, v91, v20
v_sub_f32 v92, v92, v20
v_sub_f32 v93, v93, v20
v_sub_f32 v94, v94, v20
v_sub_f32 v95, v95, v20
v_sub_f32 v96, v96, v21
v_sub_f32 v97, v97, v21
v_sub_f32 v98, v98, v21
v_sub_f32 v99, v99, v21
v_sub_f32 v100, v100, v21
v_sub_f32 v101, v101, v21
v_sub_f32 v102, v102, v21
v_sub_f32 v103, v103, v21
v_sub_f32 v104, v104, v22
v_sub_f32 v105, v105, v22
v_sub_f32 v106, v106, v22
v_sub_f32 v107, v107, v22
v_sub_f32 v108, v108, v22
v_sub_f32 v109, v109, v22
v_sub_f32 v110, v110, v22
v_sub_f32 v111, v111, v22
v_sub_f32 v112, v112, v23
v_sub_f32 v113, v113, v23
v_sub_f32 v114, v114, v23
v_sub_f32 v115, v115, v23
v_sub_f32 v116, v116, v23
v_sub_f32 v117, v117, v23
v_sub_f32 v118, v118, v23
v_sub_f32 v119, v119, v23
s_waitcnt lgkmcnt(5)
v_mfma_f32_16x16x32_bf16 v[120:123], a[144:147], v[24:27], v[216:219]
v_exp_f32 v88, v88
v_mfma_f32_16x16x32_bf16 v[128:131], a[144:147], v[40:43], v[188:191]
v_exp_f32 v89, v89
v_mfma_f32_16x16x32_bf16 v[136:139], a[144:147], v[56:59], v[192:195]
v_exp_f32 v90, v90
v_mfma_f32_16x16x32_bf16 v[144:147], a[144:147], v[72:75], v[196:199]
s_waitcnt lgkmcnt(4)
ds_read_b128 a[168:171], v2 offset:14336
v_exp_f32 v91, v91
v_mfma_f32_16x16x32_bf16 v[120:123], a[148:151], v[28:31], v[120:123]
v_exp_f32 v92, v92
v_mfma_f32_16x16x32_bf16 v[128:131], a[148:151], v[44:47], v[128:131]
v_exp_f32 v93, v93
v_mfma_f32_16x16x32_bf16 v[136:139], a[148:151], v[60:63], v[136:139]
v_exp_f32 v94, v94
v_mfma_f32_16x16x32_bf16 v[144:147], a[148:151], v[76:79], v[144:147]
s_waitcnt lgkmcnt(4)
ds_read_b128 a[172:175], v2 offset:15360
v_exp_f32 v95, v95
v_mfma_f32_16x16x32_bf16 v[120:123], a[152:155], v[32:35], v[120:123]
v_exp_f32 v96, v96
v_mfma_f32_16x16x32_bf16 v[128:131], a[152:155], v[48:51], v[128:131]
v_exp_f32 v97, v97
v_mfma_f32_16x16x32_bf16 v[136:139], a[152:155], v[64:67], v[136:139]
v_exp_f32 v98, v98
v_mfma_f32_16x16x32_bf16 v[144:147], a[152:155], v[80:83], v[144:147]
s_waitcnt lgkmcnt(4)
v_exp_f32 v99, v99
v_mfma_f32_16x16x32_bf16 v[120:123], a[156:159], v[36:39], v[120:123]
v_exp_f32 v100, v100
v_mfma_f32_16x16x32_bf16 v[128:131], a[156:159], v[52:55], v[128:131]
v_exp_f32 v101, v101
v_mfma_f32_16x16x32_bf16 v[136:139], a[156:159], v[68:71], v[136:139]
v_exp_f32 v102, v102
v_mfma_f32_16x16x32_bf16 v[144:147], a[156:159], v[84:87], v[144:147]
s_waitcnt lgkmcnt(3)
v_exp_f32 v103, v103
v_exp_f32 v104, v104
v_mfma_f32_16x16x32_bf16 v[124:127], a[160:163], v[24:27], v[220:223]
v_exp_f32 v105, v105
v_mfma_f32_16x16x32_bf16 v[132:135], a[160:163], v[40:43], v[188:191]
v_exp_f32 v106, v106
v_mfma_f32_16x16x32_bf16 v[140:143], a[160:163], v[56:59], v[192:195]
buffer_load_dwordx4 v16, s[32:35], s64 offen offset:3072 sc1 lds
v_exp_f32 v107, v107
v_mfma_f32_16x16x32_bf16 v[148:151], a[160:163], v[72:75], v[196:199]
s_waitcnt lgkmcnt(2)
v_exp_f32 v108, v108
v_mfma_f32_16x16x32_bf16 v[124:127], a[164:167], v[28:31], v[124:127]
v_exp_f32 v109, v109
v_mfma_f32_16x16x32_bf16 v[132:135], a[164:167], v[44:47], v[132:135]
v_exp_f32 v110, v110
v_mfma_f32_16x16x32_bf16 v[140:143], a[164:167], v[60:63], v[140:143]
v_exp_f32 v111, v111
v_mfma_f32_16x16x32_bf16 v[148:151], a[164:167], v[76:79], v[148:151]
s_waitcnt lgkmcnt(1)
v_exp_f32 v112, v112
v_mfma_f32_16x16x32_bf16 v[124:127], a[168:171], v[32:35], v[124:127]
v_exp_f32 v113, v113
v_mfma_f32_16x16x32_bf16 v[132:135], a[168:171], v[48:51], v[132:135]
v_exp_f32 v114, v114
v_mfma_f32_16x16x32_bf16 v[140:143], a[168:171], v[64:67], v[140:143]
v_exp_f32 v115, v115
v_mfma_f32_16x16x32_bf16 v[148:151], a[168:171], v[80:83], v[148:151]
s_waitcnt lgkmcnt(0)
v_exp_f32 v116, v116
v_mfma_f32_16x16x32_bf16 v[124:127], a[172:175], v[36:39], v[124:127]
s_xor_b32 s71, s71, 16384
v_exp_f32 v117, v117
v_mfma_f32_16x16x32_bf16 v[132:135], a[172:175], v[52:55], v[132:135]
s_add_u32 s70, s70, 32768
v_exp_f32 v118, v118
v_add_f32 v216, v188, v200
v_add_f32 v217, v188, v201
v_add_f32 v218, v188, v202
v_add_f32 v219, v188, v203
v_add_f32 v220, v188, v204
v_add_f32 v221, v188, v205
v_add_f32 v222, v188, v206
v_add_f32 v223, v188, v207
v_mfma_f32_16x16x32_bf16 v[140:143], a[172:175], v[68:71], v[140:143]
s_mov_b32 m0, s71
v_exp_f32 v119, v119
v_mfma_f32_16x16x32_bf16 v[148:151], a[172:175], v[84:87], v[148:151]
s_waitcnt vmcnt(8)
s_barrier
buffer_load_dwordx4 v16, s[32:35], s70 offen offset:0 sc1 lds
ds_read_b128 a[144:147], v2 offset:16384
ds_read_b128 a[148:151], v2 offset:17408
ds_read_b128 a[152:155], v2 offset:18432
ds_read_b128 a[156:159], v2 offset:19456
ds_read_b128 a[160:163], v2 offset:20480
ds_read_b128 a[164:167], v2 offset:21504
v_cvt_pk_bf16_f32 v152, v88, v89
v_cvt_pk_bf16_f32 v153, v90, v91
v_cvt_pk_bf16_f32 v154, v92, v93
v_cvt_pk_bf16_f32 v155, v94, v95
v_cvt_pk_bf16_f32 v156, v96, v97
v_cvt_pk_bf16_f32 v157, v98, v99
v_cvt_pk_bf16_f32 v158, v100, v101
v_cvt_pk_bf16_f32 v159, v102, v103
v_cvt_pk_bf16_f32 v160, v104, v105
v_cvt_pk_bf16_f32 v161, v106, v107
v_cvt_pk_bf16_f32 v162, v108, v109
v_cvt_pk_bf16_f32 v163, v110, v111
v_cvt_pk_bf16_f32 v164, v112, v113
v_cvt_pk_bf16_f32 v165, v114, v115
v_cvt_pk_bf16_f32 v166, v116, v117
v_cvt_pk_bf16_f32 v167, v118, v119
buffer_load_dwordx4 v16, s[32:35], s70 offen offset:1024 sc1 lds
s_waitcnt lgkmcnt(5)
v_mfma_f32_16x16x32_bf16 v[96:99], a[144:147], v[40:43], v[216:219]
s_lshl_b32 s66, s30, 30
v_exp_f32 v120, v120
v_mfma_f32_16x16x32_bf16 v[104:107], a[144:147], v[56:59], v[192:195]
ds_read_b128 a[168:171], v2 offset:22528
v_lshl_add_u32 v19, v0, 24, s66
v_mfma_f32_16x16x32_bf16 v[112:115], a[144:147], v[72:75], v[196:199]
s_waitcnt lgkmcnt(5)
v_exp_f32 v121, v121
v_mfma_f32_16x16x32_bf16 v[96:99], a[148:151], v[44:47], v[96:99]
buffer_load_dwordx4 v16, s[32:35], s70 offen offset:2048 sc1 lds
v_mfma_f32_16x16x32_bf16 v[104:107], a[148:151], v[60:63], v[104:107]
v_exp_f32 v122, v122
v_mfma_f32_16x16x32_bf16 v[112:115], a[148:151], v[76:79], v[112:115]
s_waitcnt lgkmcnt(4)
ds_read_b128 a[172:175], v2 offset:23552
v_cvt_pk_bf16_f32 v168, v120, v121
v_mfma_f32_16x16x32_bf16 v[96:99], a[152:155], v[48:51], v[96:99]
v_exp_f32 v123, v123
v_mfma_f32_16x16x32_bf16 v[104:107], a[152:155], v[64:67], v[104:107]
v_exp_f32 v124, v124
v_mfma_f32_16x16x32_bf16 v[112:115], a[152:155], v[80:83], v[112:115]
s_waitcnt lgkmcnt(4)
ds_read_b128 a[176:179], v3 offset:16384
v_cvt_pk_bf16_f32 v169, v122, v123
v_mfma_f32_16x16x32_bf16 v[96:99], a[156:159], v[52:55], v[96:99]
v_exp_f32 v125, v125
v_mfma_f32_16x16x32_bf16 v[104:107], a[156:159], v[68:71], v[104:107]
v_exp_f32 v126, v126
v_mfma_f32_16x16x32_bf16 v[112:115], a[156:159], v[84:87], v[112:115]
s_waitcnt lgkmcnt(4)
ds_read_b128 a[180:183], v3 offset:17408
v_cvt_pk_bf16_f32 v170, v124, v125
v_mfma_f32_16x16x32_bf16 v[100:103], a[160:163], v[40:43], v[220:223]
v_exp_f32 v127, v127
v_mfma_f32_16x16x32_bf16 v[108:111], a[160:163], v[56:59], v[192:195]
ds_read_b128 a[184:187], v3 offset:18432
v_cvt_pk_bf16_f32 v171, v126, v127
v_mfma_f32_16x16x32_bf16 v[116:119], a[160:163], v[72:75], v[196:199]
s_waitcnt lgkmcnt(5)
v_exp_f32 v128, v128
v_mfma_f32_16x16x32_bf16 v[100:103], a[164:167], v[44:47], v[100:103]
buffer_load_dwordx4 v16, s[32:35], s70 offen offset:3072 sc1 lds
v_mfma_f32_16x16x32_bf16 v[108:111], a[164:167], v[60:63], v[108:111]
v_exp_f32 v129, v129
v_mfma_f32_16x16x32_bf16 v[116:119], a[164:167], v[76:79], v[116:119]
s_waitcnt lgkmcnt(4)
ds_read_b128 a[188:191], v3 offset:19456
v_cvt_pk_bf16_f32 v172, v128, v129
v_mfma_f32_16x16x32_bf16 v[100:103], a[168:171], v[48:51], v[100:103]
v_exp_f32 v130, v130
v_mfma_f32_16x16x32_bf16 v[108:111], a[168:171], v[64:67], v[108:111]
v_exp_f32 v131, v131
v_mfma_f32_16x16x32_bf16 v[116:119], a[168:171], v[80:83], v[116:119]
s_waitcnt lgkmcnt(4)
ds_read_b128 a[192:195], v3 offset:20480
v_add_f32 v216, v188, v208
v_mfma_f32_16x16x32_bf16 v[100:103], a[172:175], v[52:55], v[100:103]
v_exp_f32 v132, v132
v_mfma_f32_16x16x32_bf16 v[108:111], a[172:175], v[68:71], v[108:111]
ds_read_b128 a[196:199], v3 offset:21504
v_add_f32 v217, v188, v209
v_mfma_f32_16x16x32_bf16 v[116:119], a[172:175], v[84:87], v[116:119]
s_waitcnt lgkmcnt(5)
s_add_u32 m0, s71, 4096
v_exp_f32 v133, v133
v_mfma_f32_16x16x32_bf16 a[0:3], a[176:179], v[152:155], 0
s_add_u32 s64, s70, 4096
v_exp_f32 v134, v134
v_mfma_f32_16x16x32_bf16 a[32:35], a[176:179], v[156:159], 0
ds_read_b128 a[200:203], v3 offset:22528
v_add_f32 v218, v188, v210
v_mfma_f32_16x16x32_bf16 a[64:67], a[176:179], v[160:163], 0
buffer_load_dwordx4 v16, s[32:35], s64 offen offset:0 sc1 lds
v_mfma_f32_16x16x32_bf16 a[96:99], a[176:179], v[164:167], 0
s_waitcnt lgkmcnt(5)
v_exp_f32 v135, v135
v_mfma_f32_16x16x32_bf16 a[4:7], a[180:183], v[152:155], 0
v_exp_f32 v136, v136
v_mfma_f32_16x16x32_bf16 a[36:39], a[180:183], v[156:159], 0
ds_read_b128 a[204:207], v3 offset:23552
v_add_f32 v219, v188, v211
v_mfma_f32_16x16x32_bf16 a[68:71], a[180:183], v[160:163], 0
v_exp_f32 v137, v137
v_mfma_f32_16x16x32_bf16 a[100:103], a[180:183], v[164:167], 0
s_waitcnt lgkmcnt(5)
v_exp_f32 v138, v138
v_mfma_f32_16x16x32_bf16 a[8:11], a[184:187], v[152:155], 0
ds_read_b128 a[144:147], v2 offset:24576
v_add_f32 v220, v188, v212
v_mfma_f32_16x16x32_bf16 a[40:43], a[184:187], v[156:159], 0
v_exp_f32 v139, v139
v_mfma_f32_16x16x32_bf16 a[72:75], a[184:187], v[160:163], 0
v_exp_f32 v140, v140
v_mfma_f32_16x16x32_bf16 a[104:107], a[184:187], v[164:167], 0
s_waitcnt lgkmcnt(5)
v_exp_f32 v141, v141
v_mfma_f32_16x16x32_bf16 a[12:15], a[188:191], v[152:155], 0
ds_read_b128 a[148:151], v2 offset:25600
v_add_f32 v221, v188, v213
v_mfma_f32_16x16x32_bf16 a[44:47], a[188:191], v[156:159], 0
buffer_load_dwordx4 v16, s[32:35], s64 offen offset:1024 sc1 lds
v_mfma_f32_16x16x32_bf16 a[76:79], a[188:191], v[160:163], 0
v_exp_f32 v142, v142
v_mfma_f32_16x16x32_bf16 a[108:111], a[188:191], v[164:167], 0
s_waitcnt lgkmcnt(5)
v_exp_f32 v143, v143
v_mfma_f32_16x16x32_bf16 a[16:19], a[192:195], v[152:155], 0
ds_read_b128 a[152:155], v2 offset:26624
v_add_f32 v222, v188, v214
v_mfma_f32_16x16x32_bf16 a[48:51], a[192:195], v[156:159], 0
v_exp_f32 v144, v144
v_mfma_f32_16x16x32_bf16 a[80:83], a[192:195], v[160:163], 0
v_exp_f32 v145, v145
v_mfma_f32_16x16x32_bf16 a[112:115], a[192:195], v[164:167], 0
s_waitcnt lgkmcnt(5)
v_exp_f32 v146, v146
v_mfma_f32_16x16x32_bf16 a[20:23], a[196:199], v[152:155], 0
ds_read_b128 a[156:159], v2 offset:27648
v_add_f32 v223, v188, v215
v_mfma_f32_16x16x32_bf16 a[52:55], a[196:199], v[156:159], 0
v_exp_f32 v147, v147
v_mfma_f32_16x16x32_bf16 a[84:87], a[196:199], v[160:163], 0
v_exp_f32 v148, v148
v_mfma_f32_16x16x32_bf16 a[116:119], a[196:199], v[164:167], 0
s_waitcnt lgkmcnt(5)
v_exp_f32 v149, v149
v_mfma_f32_16x16x32_bf16 a[24:27], a[200:203], v[152:155], 0
ds_read_b128 a[160:163], v2 offset:28672
v_cvt_pk_bf16_f32 v173, v130, v131
v_mfma_f32_16x16x32_bf16 a[56:59], a[200:203], v[156:159], 0
buffer_load_dwordx4 v16, s[32:35], s64 offen offset:2048 sc1 lds
v_mfma_f32_16x16x32_bf16 a[88:91], a[200:203], v[160:163], 0
v_exp_f32 v150, v150
v_mfma_f32_16x16x32_bf16 a[120:123], a[200:203], v[164:167], 0
s_waitcnt lgkmcnt(5)
v_exp_f32 v151, v151
v_mfma_f32_16x16x32_bf16 a[28:31], a[204:207], v[152:155], 0
ds_read_b128 a[164:167], v2 offset:29696
v_cvt_pk_bf16_f32 v174, v132, v133
v_mfma_f32_16x16x32_bf16 a[60:63], a[204:207], v[156:159], 0
s_cmp_eq_u32 s73, 0
s_cselect_b32 s67, 0, 0x1000
v_mfma_f32_16x16x32_bf16 a[92:95], a[204:207], v[160:163], 0
v_cvt_pk_bf16_f32 v175, v134, v135
v_cvt_pk_bf16_f32 v176, v136, v137
v_mfma_f32_16x16x32_bf16 a[124:127], a[204:207], v[164:167], 0
v_cvt_pk_bf16_f32 v177, v138, v139
v_cvt_pk_bf16_f32 v178, v140, v141
v_mfma_f32_16x16x32_bf16 a[128:131], v[12:15], v[152:155], 0
v_cvt_pk_bf16_f32 v179, v142, v143
v_cvt_pk_bf16_f32 v180, v144, v145
v_mfma_f32_16x16x32_bf16 a[132:135], v[12:15], v[156:159], 0
v_cvt_pk_bf16_f32 v181, v146, v147
v_cvt_pk_bf16_f32 v182, v148, v149
v_mfma_f32_16x16x32_bf16 a[136:139], v[12:15], v[160:163], 0
v_cvt_pk_bf16_f32 v183, v150, v151
v_mfma_f32_16x16x32_bf16 a[140:143], v[12:15], v[164:167], 0
s_waitcnt lgkmcnt(5)
buffer_atomic_add a251, v19, s[52:55], s67 offen offset:128 sc1
v_mfma_f32_16x16x32_bf16 v[128:131], a[144:147], v[40:43], v[216:219]
v_exp_f32 v96, v96
v_mfma_f32_16x16x32_bf16 v[136:139], a[144:147], v[56:59], v[192:195]
ds_read_b128 a[168:171], v2 offset:30720
v_lshlrev_b32 v19, 7, v0
v_mfma_f32_16x16x32_bf16 v[144:147], a[144:147], v[72:75], v[196:199]
s_waitcnt lgkmcnt(5)
s_lshl2_add_u32 s66, s2, s30
v_exp_f32 v97, v97
v_mfma_f32_16x16x32_bf16 v[128:131], a[148:151], v[44:47], v[128:131]
s_lshl_b32 s66, s66, 13
ds_read_b128 a[172:175], v2 offset:31744
v_cvt_pk_bf16_f32 v156, v96, v97
v_mfma_f32_16x16x32_bf16 v[136:139], a[148:151], v[60:63], v[136:139]
v_exp_f32 v98, v98
v_mfma_f32_16x16x32_bf16 v[144:147], a[148:151], v[76:79], v[144:147]
s_waitcnt lgkmcnt(5)
v_exp_f32 v99, v99
v_mfma_f32_16x16x32_bf16 v[128:131], a[152:155], v[48:51], v[128:131]
ds_read_b128 a[176:179], v3 offset:24576
v_add_u32 v19, s66, v19
v_mfma_f32_16x16x32_bf16 v[136:139], a[152:155], v[64:67], v[136:139]
v_exp_f32 v100, v100
v_mfma_f32_16x16x32_bf16 v[144:147], a[152:155], v[80:83], v[144:147]
s_waitcnt lgkmcnt(5)
v_exp_f32 v101, v101
v_mfma_f32_16x16x32_bf16 v[128:131], a[156:159], v[52:55], v[128:131]
ds_read_b128 a[180:183], v3 offset:25600
v_xor_b32 v2, 0x8000, v2
v_mfma_f32_16x16x32_bf16 v[136:139], a[156:159], v[68:71], v[136:139]
v_exp_f32 v102, v102
v_mfma_f32_16x16x32_bf16 v[144:147], a[156:159], v[84:87], v[144:147]
s_waitcnt lgkmcnt(5)
v_exp_f32 v103, v103
v_mfma_f32_16x16x32_bf16 v[132:135], a[160:163], v[40:43], v[220:223]
ds_read_b128 a[184:187], v3 offset:26624
v_cvt_pk_bf16_f32 v157, v98, v99
v_mfma_f32_16x16x32_bf16 v[140:143], a[160:163], v[56:59], v[192:195]
v_exp_f32 v104, v104
v_mfma_f32_16x16x32_bf16 v[148:151], a[160:163], v[72:75], v[196:199]
s_waitcnt lgkmcnt(5)
v_exp_f32 v105, v105
v_mfma_f32_16x16x32_bf16 v[132:135], a[164:167], v[44:47], v[132:135]
ds_read_b128 a[188:191], v3 offset:27648
v_cvt_pk_bf16_f32 v158, v100, v101
v_mfma_f32_16x16x32_bf16 v[140:143], a[164:167], v[60:63], v[140:143]
buffer_load_dwordx4 v16, s[32:35], s64 offen offset:3072 sc1 lds
v_mfma_f32_16x16x32_bf16 v[148:151], a[164:167], v[76:79], v[148:151]
s_waitcnt lgkmcnt(5)
v_exp_f32 v106, v106
v_mfma_f32_16x16x32_bf16 v[132:135], a[168:171], v[48:51], v[132:135]
ds_read_b128 a[192:195], v3 offset:28672
v_cvt_pk_bf16_f32 v159, v102, v103
v_mfma_f32_16x16x32_bf16 v[140:143], a[168:171], v[64:67], v[140:143]
v_exp_f32 v107, v107
v_mfma_f32_16x16x32_bf16 v[148:151], a[168:171], v[80:83], v[148:151]
s_waitcnt lgkmcnt(5)
v_exp_f32 v108, v108
v_mfma_f32_16x16x32_bf16 v[132:135], a[172:175], v[52:55], v[132:135]
ds_read_b128 a[196:199], v3 offset:29696
v_cvt_pk_bf16_f32 v160, v104, v105
v_mfma_f32_16x16x32_bf16 v[140:143], a[172:175], v[68:71], v[140:143]
v_exp_f32 v109, v109
v_mfma_f32_16x16x32_bf16 v[148:151], a[172:175], v[84:87], v[148:151]
s_waitcnt lgkmcnt(5)
v_exp_f32 v110, v110
v_mfma_f32_16x16x32_bf16 a[0:3], a[176:179], v[168:171], a[0:3]
ds_read_b128 a[200:203], v3 offset:30720
v_cvt_pk_bf16_f32 v161, v106, v107
v_mfma_f32_16x16x32_bf16 a[32:35], a[176:179], v[172:175], a[32:35]
v_exp_f32 v111, v111
v_mfma_f32_16x16x32_bf16 a[64:67], a[176:179], v[176:179], a[64:67]
v_exp_f32 v112, v112
v_mfma_f32_16x16x32_bf16 a[96:99], a[176:179], v[180:183], a[96:99]
s_waitcnt lgkmcnt(5)
v_exp_f32 v113, v113
v_mfma_f32_16x16x32_bf16 a[4:7], a[180:183], v[168:171], a[4:7]
ds_read_b128 a[204:207], v3 offset:31744
v_cvt_pk_bf16_f32 v162, v108, v109
v_mfma_f32_16x16x32_bf16 a[36:39], a[180:183], v[172:175], a[36:39]
v_exp_f32 v114, v114
v_mfma_f32_16x16x32_bf16 a[68:71], a[180:183], v[176:179], a[68:71]
v_exp_f32 v115, v115
v_mfma_f32_16x16x32_bf16 a[100:103], a[180:183], v[180:183], a[100:103]
s_waitcnt vmcnt(9)
s_barrier
s_waitcnt lgkmcnt(5)
v_mfma_f32_16x16x32_bf16 a[8:11], a[184:187], v[168:171], a[8:11]
ds_read_b128 a[144:147], v2 offset:0
v_cvt_pk_bf16_f32 v163, v110, v111
v_mfma_f32_16x16x32_bf16 a[40:43], a[184:187], v[172:175], a[40:43]
v_exp_f32 v116, v116
v_mfma_f32_16x16x32_bf16 a[72:75], a[184:187], v[176:179], a[72:75]
v_exp_f32 v117, v117
v_mfma_f32_16x16x32_bf16 a[104:107], a[184:187], v[180:183], a[104:107]
s_waitcnt lgkmcnt(5)
v_exp_f32 v118, v118
v_mfma_f32_16x16x32_bf16 a[12:15], a[188:191], v[168:171], a[12:15]
ds_read_b128 a[148:151], v2 offset:1024
v_cvt_pk_bf16_f32 v164, v112, v113
v_mfma_f32_16x16x32_bf16 a[44:47], a[188:191], v[172:175], a[44:47]
global_load_dword a252, v19, s[14:15]
v_mfma_f32_16x16x32_bf16 a[76:79], a[188:191], v[176:179], a[76:79]
s_xor_b32 s71, s71, 49152
v_exp_f32 v119, v119
v_mfma_f32_16x16x32_bf16 a[108:111], a[188:191], v[180:183], a[108:111]
s_waitcnt lgkmcnt(5)
s_add_u32 s70, s70, 32768
v_and_b32 v19, 2097151, v19
v_cvt_pk_bf16_f32 v165, v114, v115
v_mfma_f32_16x16x32_bf16 a[16:19], a[192:195], v[168:171], a[16:19]
s_mov_b32 m0, s71
ds_read_b128 a[152:155], v2 offset:2048
v_cvt_pk_bf16_f32 v166, v116, v117
v_mfma_f32_16x16x32_bf16 a[48:51], a[192:195], v[172:175], a[48:51]
buffer_load_dwordx4 v16, s[32:35], s70 offen offset:0 sc1 lds
v_mfma_f32_16x16x32_bf16 a[80:83], a[192:195], v[176:179], a[80:83]
v_cvt_pk_bf16_f32 v167, v118, v119
v_xor_b32 v3, 0x8000, v3
v_mfma_f32_16x16x32_bf16 a[112:115], a[192:195], v[180:183], a[112:115]
s_waitcnt lgkmcnt(5)
global_load_dword a252, v19, s[20:21]
v_mfma_f32_16x16x32_bf16 a[20:23], a[196:199], v[168:171], a[20:23]
ds_read_b128 a[156:159], v2 offset:3072
v_mfma_f32_16x16x32_bf16 a[52:55], a[196:199], v[172:175], a[52:55]
v_mfma_f32_16x16x32_bf16 a[84:87], a[196:199], v[176:179], a[84:87]
v_mfma_f32_16x16x32_bf16 a[116:119], a[196:199], v[180:183], a[116:119]
s_waitcnt lgkmcnt(5)
v_mfma_f32_16x16x32_bf16 a[24:27], a[200:203], v[168:171], a[24:27]
ds_read_b128 a[160:163], v2 offset:4096
v_mfma_f32_16x16x32_bf16 a[56:59], a[200:203], v[172:175], a[56:59]
v_mfma_f32_16x16x32_bf16 a[88:91], a[200:203], v[176:179], a[88:91]
buffer_load_dwordx4 v16, s[32:35], s70 offen offset:1024 sc1 lds
v_mfma_f32_16x16x32_bf16 a[120:123], a[200:203], v[180:183], a[120:123]
s_waitcnt lgkmcnt(5)
v_mfma_f32_16x16x32_bf16 a[28:31], a[204:207], v[168:171], a[28:31]
ds_read_b128 a[164:167], v2 offset:5120
v_mfma_f32_16x16x32_bf16 a[60:63], a[204:207], v[172:175], a[60:63]
v_mfma_f32_16x16x32_bf16 a[92:95], a[204:207], v[176:179], a[92:95]
v_mfma_f32_16x16x32_bf16 a[124:127], a[204:207], v[180:183], a[124:127]
v_mfma_f32_16x16x32_bf16 a[128:131], v[12:15], v[168:171], a[128:131]
v_mfma_f32_16x16x32_bf16 a[132:135], v[12:15], v[172:175], a[132:135]
v_mfma_f32_16x16x32_bf16 a[136:139], v[12:15], v[176:179], a[136:139]
v_mfma_f32_16x16x32_bf16 a[140:143], v[12:15], v[180:183], a[140:143]
s_branch L_T_8
L_T1_9:
v_add_f32 v216, v192, v200
v_add_f32 v217, v192, v201
v_add_f32 v218, v192, v202
v_add_f32 v219, v192, v203
v_add_f32 v220, v192, v204
v_add_f32 v221, v192, v205
v_add_f32 v222, v192, v206
v_add_f32 v223, v192, v207
s_nop 0
s_waitcnt lgkmcnt(5)
v_mfma_f32_16x16x32_bf16 v[104:107], a[144:147], v[56:59], v[216:219]
s_and_b32 s66, s2, 7
v_exp_f32 v128, v128
v_mfma_f32_16x16x32_bf16 v[112:115], a[144:147], v[72:75], v[196:199]
s_waitcnt lgkmcnt(4)
s_lshr_b32 s67, s2, 3
ds_read_b128 a[168:171], v2 offset:6144
v_mfma_f32_16x16x32_bf16 v[104:107], a[148:151], v[60:63], v[104:107]
s_lshr_b32 s83, s66, 2
v_exp_f32 v129, v129
v_mfma_f32_16x16x32_bf16 v[112:115], a[148:151], v[76:79], v[112:115]
s_waitcnt lgkmcnt(4)
s_and_b32 s68, s66, 1
buffer_load_dwordx4 v16, s[32:35], s70 offen offset:2048 sc1 lds
v_mfma_f32_16x16x32_bf16 v[104:107], a[152:155], v[64:67], v[104:107]
s_and_b32 s69, s67, 7
v_exp_f32 v130, v130
v_mfma_f32_16x16x32_bf16 v[112:115], a[152:155], v[80:83], v[112:115]
s_waitcnt lgkmcnt(3)
s_lshl3_add_u32 s82, s68, s69
ds_read_b128 a[172:175], v2 offset:7168
v_cvt_pk_bf16_f32 v172, v128, v129
v_mfma_f32_16x16x32_bf16 v[104:107], a[156:159], v[68:71], v[104:107]
s_and_b32 s68, s66, 2
v_exp_f32 v131, v131
v_mfma_f32_16x16x32_bf16 v[112:115], a[156:159], v[84:87], v[112:115]
s_waitcnt lgkmcnt(3)
s_lshr_b32 s69, s67, 3
ds_read_b128 a[176:179], v3 offset:0
v_cvt_pk_bf16_f32 v173, v130, v131
v_mfma_f32_16x16x32_bf16 v[108:111], a[160:163], v[56:59], v[220:223]
s_lshl1_add_u32 s87, s68, s69
v_exp_f32 v132, v132
v_mfma_f32_16x16x32_bf16 v[116:119], a[160:163], v[72:75], v[196:199]
s_waitcnt lgkmcnt(3)
s_lshl_b32 s87, s87, 8
ds_read_b128 a[180:183], v3 offset:1024
v_mfma_f32_16x16x32_bf16 v[108:111], a[164:167], v[60:63], v[108:111]
s_lshl_b32 s86, s30, 12
v_exp_f32 v133, v133
v_mfma_f32_16x16x32_bf16 v[116:119], a[164:167], v[76:79], v[116:119]
s_waitcnt lgkmcnt(3)
s_lshl_b32 s85, s30, 15
ds_read_b128 a[184:187], v3 offset:2048
v_exp_f32 v134, v134
v_mfma_f32_16x16x32_bf16 v[108:111], a[168:171], v[64:67], v[108:111]
s_add_u32 s85, s85, s87
buffer_load_dwordx4 v16, s[32:35], s70 offen offset:3072 sc1 lds
v_mfma_f32_16x16x32_bf16 v[116:119], a[168:171], v[80:83], v[116:119]
s_waitcnt lgkmcnt(3)
s_lshl_b32 s66, s83, 20
ds_read_b128 a[188:191], v3 offset:3072
v_exp_f32 v135, v135
v_mfma_f32_16x16x32_bf16 v[108:111], a[172:175], v[68:71], v[108:111]
s_add_u32 s85, s85, s66
v_exp_f32 v136, v136
v_mfma_f32_16x16x32_bf16 v[116:119], a[172:175], v[84:87], v[116:119]
s_waitcnt lgkmcnt(3)
s_mul_i32 s84, s82, 1310720
ds_read_b128 a[192:195], v3 offset:4096
v_add_f32 v216, v192, v208
v_mfma_f32_16x16x32_bf16 a[32:35], a[176:179], v[156:159], a[32:35]
s_lshl_b32 s66, s30, 11
v_exp_f32 v137, v137
v_mfma_f32_16x16x32_bf16 a[64:67], a[176:179], v[160:163], a[64:67]
s_add_u32 s84, s84, s66
ds_read_b128 a[196:199], v3 offset:5120
v_add_f32 v217, v192, v209
v_mfma_f32_16x16x32_bf16 a[96:99], a[176:179], v[164:167], a[96:99]
s_waitcnt lgkmcnt(4)
s_lshl_b32 s66, s83, 17
v_exp_f32 v138, v138
v_mfma_f32_16x16x32_bf16 a[36:39], a[180:183], v[156:159], a[36:39]
s_add_u32 s84, s84, s66
s_add_u32 m0, s71, 4096
ds_read_b128 a[200:203], v3 offset:6144
v_add_f32 v218, v192, v210
v_mfma_f32_16x16x32_bf16 a[68:71], a[180:183], v[160:163], a[68:71]
s_add_u32 s84, s84, 34603008
s_add_u32 s64, s70, 4096
v_exp_f32 v139, v139
v_mfma_f32_16x16x32_bf16 a[100:103], a[180:183], v[164:167], a[100:103]
s_waitcnt lgkmcnt(4)
s_mov_b32 s36, s20
buffer_load_dwordx4 v16, s[32:35], s64 offen offset:0 sc1 lds
v_mfma_f32_16x16x32_bf16 a[40:43], a[184:187], v[156:159], a[40:43]
s_mov_b32 s37, s21
ds_read_b128 a[204:207], v3 offset:7168
v_exp_f32 v140, v140
v_mfma_f32_16x16x32_bf16 a[72:75], a[184:187], v[160:163], a[72:75]
s_mov_b32 s38, 2097152
v_exp_f32 v141, v141
v_mfma_f32_16x16x32_bf16 a[104:107], a[184:187], v[164:167], a[104:107]
s_waitcnt lgkmcnt(4)
s_mov_b32 s40, s14
v_exp_f32 v142, v142
v_mfma_f32_16x16x32_bf16 a[44:47], a[188:191], v[156:159], a[44:47]
s_mov_b32 s41, s15
ds_read_b128 a[144:147], v2 offset:8192
v_add_f32 v219, v192, v211
v_mfma_f32_16x16x32_bf16 a[76:79], a[188:191], v[160:163], a[76:79]
s_mov_b32 s42, 8388608
v_exp_f32 v143, v143
v_mfma_f32_16x16x32_bf16 a[108:111], a[188:191], v[164:167], a[108:111]
s_waitcnt lgkmcnt(4)
ds_read_b128 a[148:151], v2 offset:9216
v_add_f32 v220, v192, v212
v_mfma_f32_16x16x32_bf16 a[48:51], a[192:195], v[156:159], a[48:51]
v_exp_f32 v144, v144
v_mfma_f32_16x16x32_bf16 a[80:83], a[192:195], v[160:163], a[80:83]
buffer_load_dwordx4 v16, s[32:35], s64 offen offset:1024 sc1 lds
v_mfma_f32_16x16x32_bf16 a[112:115], a[192:195], v[164:167], a[112:115]
s_waitcnt lgkmcnt(4)
v_exp_f32 v145, v145
v_mfma_f32_16x16x32_bf16 a[52:55], a[196:199], v[156:159], a[52:55]
ds_read_b128 a[152:155], v2 offset:10240
v_add_f32 v221, v192, v213
v_mfma_f32_16x16x32_bf16 a[84:87], a[196:199], v[160:163], a[84:87]
v_exp_f32 v146, v146
v_mfma_f32_16x16x32_bf16 a[116:119], a[196:199], v[164:167], a[116:119]
s_waitcnt lgkmcnt(4)
v_exp_f32 v147, v147
v_mfma_f32_16x16x32_bf16 a[56:59], a[200:203], v[156:159], a[56:59]
ds_read_b128 a[156:159], v2 offset:11264
v_add_f32 v222, v192, v214
v_mfma_f32_16x16x32_bf16 a[88:91], a[200:203], v[160:163], a[88:91]
v_exp_f32 v148, v148
v_mfma_f32_16x16x32_bf16 a[120:123], a[200:203], v[164:167], a[120:123]
s_waitcnt lgkmcnt(4)
v_exp_f32 v149, v149
v_mfma_f32_16x16x32_bf16 a[60:63], a[204:207], v[156:159], a[60:63]
ds_read_b128 a[160:163], v2 offset:12288
v_add_f32 v223, v192, v215
v_mfma_f32_16x16x32_bf16 a[92:95], a[204:207], v[160:163], a[92:95]
buffer_load_dwordx4 v16, s[32:35], s64 offen offset:2048 sc1 lds
v_mfma_f32_16x16x32_bf16 a[124:127], a[204:207], v[164:167], a[124:127]
v_exp_f32 v150, v150
v_mfma_f32_16x16x32_bf16 a[132:135], v[12:15], v[156:159], a[132:135]
ds_read_b128 a[164:167], v2 offset:13312
v_cvt_pk_bf16_f32 v174, v132, v133
v_mfma_f32_16x16x32_bf16 a[136:139], v[12:15], v[160:163], a[136:139]
v_exp_f32 v151, v151
v_mfma_f32_16x16x32_bf16 a[140:143], v[12:15], v[164:167], a[140:143]
s_waitcnt lgkmcnt(5)
v_cvt_pk_bf16_f32 v175, v134, v135
v_cvt_pk_bf16_f32 v176, v136, v137
v_cvt_pk_bf16_f32 v177, v138, v139
v_cvt_pk_bf16_f32 v178, v140, v141
v_cvt_pk_bf16_f32 v179, v142, v143
v_cvt_pk_bf16_f32 v180, v144, v145
v_cvt_pk_bf16_f32 v181, v146, v147
v_cvt_pk_bf16_f32 v182, v148, v149
v_cvt_pk_bf16_f32 v183, v150, v151
v_lshrrev_b32 v19, 4, v0
v_bfe_u32 v17, v0, 1, 3
v_xor_b32 v17, v17, v19
v_lshlrev_b32 v17, 5, v17
v_lshl_add_u32 v17, v19, 11, v17
v_and_b32 v19, 1, v0
v_lshl_add_u32 v17, v19, 4, v17
v_xor_b32 v18, 128, v17
buffer_load_dword v19, off, s[52:55], 0 offset:128 sc1
v_mfma_f32_16x16x32_bf16 v[136:139], a[144:147], v[56:59], v[216:219]
v_exp_f32 v104, v104
v_mfma_f32_16x16x32_bf16 v[144:147], a[144:147], v[72:75], v[196:199]
s_waitcnt lgkmcnt(4)
ds_read_b128 a[168:171], v2 offset:14336
v_mfma_f32_16x16x32_bf16 v[136:139], a[148:151], v[60:63], v[136:139]
v_exp_f32 v105, v105
v_mfma_f32_16x16x32_bf16 v[144:147], a[148:151], v[76:79], v[144:147]
s_waitcnt lgkmcnt(4)
ds_read_b128 a[172:175], v2 offset:15360
v_cvt_pk_bf16_f32 v160, v104, v105
v_mfma_f32_16x16x32_bf16 v[136:139], a[152:155], v[64:67], v[136:139]
v_exp_f32 v106, v106
v_mfma_f32_16x16x32_bf16 v[144:147], a[152:155], v[80:83], v[144:147]
s_waitcnt lgkmcnt(4)
ds_read_b128 a[176:179], v3 offset:8192
v_mfma_f32_16x16x32_bf16 v[136:139], a[156:159], v[68:71], v[136:139]
ds_read_b128 a[180:183], v3 offset:9216
v_mfma_f32_16x16x32_bf16 v[144:147], a[156:159], v[84:87], v[144:147]
s_waitcnt lgkmcnt(5)
v_exp_f32 v107, v107
v_mfma_f32_16x16x32_bf16 v[140:143], a[160:163], v[56:59], v[220:223]
ds_read_b128 a[184:187], v3 offset:10240
v_cvt_pk_bf16_f32 v161, v106, v107
v_mfma_f32_16x16x32_bf16 v[148:151], a[160:163], v[72:75], v[196:199]
s_waitcnt lgkmcnt(5)
v_exp_f32 v108, v108
v_mfma_f32_16x16x32_bf16 v[140:143], a[164:167], v[60:63], v[140:143]
ds_read_b128 a[188:191], v3 offset:11264
v_mfma_f32_16x16x32_bf16 v[148:151], a[164:167], v[76:79], v[148:151]
s_waitcnt lgkmcnt(5)
buffer_load_dwordx4 v16, s[32:35], s64 offen offset:3072 sc1 lds
v_mfma_f32_16x16x32_bf16 v[140:143], a[168:171], v[64:67], v[140:143]
v_exp_f32 v109, v109
v_mfma_f32_16x16x32_bf16 v[148:151], a[168:171], v[80:83], v[148:151]
s_waitcnt lgkmcnt(4)
ds_read_b128 a[192:195], v3 offset:12288
v_add_f32 v216, v196, v200
v_mfma_f32_16x16x32_bf16 v[140:143], a[172:175], v[68:71], v[140:143]
v_exp_f32 v110, v110
v_mfma_f32_16x16x32_bf16 v[148:151], a[172:175], v[84:87], v[148:151]
s_waitcnt lgkmcnt(4)
ds_read_b128 a[196:199], v3 offset:13312
v_add_f32 v217, v196, v201
v_mfma_f32_16x16x32_bf16 a[32:35], a[176:179], v[172:175], a[32:35]
ds_read_b128 a[200:203], v3 offset:14336
v_add_f32 v218, v196, v202
v_mfma_f32_16x16x32_bf16 a[64:67], a[176:179], v[176:179], a[64:67]
v_exp_f32 v111, v111
v_mfma_f32_16x16x32_bf16 a[96:99], a[176:179], v[180:183], a[96:99]
s_waitcnt lgkmcnt(5)
v_exp_f32 v112, v112
v_mfma_f32_16x16x32_bf16 a[36:39], a[180:183], v[172:175], a[36:39]
ds_read_b128 a[204:207], v3 offset:15360
v_add_f32 v219, v196, v203
v_mfma_f32_16x16x32_bf16 a[68:71], a[180:183], v[176:179], a[68:71]
v_exp_f32 v113, v113
v_mfma_f32_16x16x32_bf16 a[100:103], a[180:183], v[180:183], a[100:103]
s_waitcnt vmcnt(9)
s_barrier
s_waitcnt lgkmcnt(5)
v_mfma_f32_16x16x32_bf16 a[40:43], a[184:187], v[172:175], a[40:43]
ds_read_b128 a[144:147], v2 offset:16384
v_add_f32 v220, v196, v204
v_mfma_f32_16x16x32_bf16 a[72:75], a[184:187], v[176:179], a[72:75]
v_exp_f32 v114, v114
v_mfma_f32_16x16x32_bf16 a[104:107], a[184:187], v[180:183], a[104:107]
s_waitcnt lgkmcnt(5)
v_exp_f32 v115, v115
v_mfma_f32_16x16x32_bf16 a[44:47], a[188:191], v[172:175], a[44:47]
ds_read_b128 a[148:151], v2 offset:17408
v_add_f32 v221, v196, v205
v_mfma_f32_16x16x32_bf16 a[76:79], a[188:191], v[176:179], a[76:79]
v_exp_f32 v116, v116
v_mfma_f32_16x16x32_bf16 a[108:111], a[188:191], v[180:183], a[108:111]
s_waitcnt lgkmcnt(5)
v_exp_f32 v117, v117
v_mfma_f32_16x16x32_bf16 a[48:51], a[192:195], v[172:175], a[48:51]
ds_read_b128 a[152:155], v2 offset:18432
v_add_f32 v222, v196, v206
v_mfma_f32_16x16x32_bf16 a[80:83], a[192:195], v[176:179], a[80:83]
v_exp_f32 v118, v118
v_mfma_f32_16x16x32_bf16 a[112:115], a[192:195], v[180:183], a[112:115]
s_waitcnt lgkmcnt(5)
v_add_f32 v223, v196, v207
v_cvt_pk_bf16_f32 v162, v108, v109
v_mfma_f32_16x16x32_bf16 a[52:55], a[196:199], v[172:175], a[52:55]
ds_read_b128 a[156:159], v2 offset:19456
v_cvt_pk_bf16_f32 v163, v110, v111
v_mfma_f32_16x16x32_bf16 a[84:87], a[196:199], v[176:179], a[84:87]
v_exp_f32 v119, v119
v_mfma_f32_16x16x32_bf16 a[116:119], a[196:199], v[180:183], a[116:119]
s_waitcnt lgkmcnt(5)
v_cvt_pk_bf16_f32 v164, v112, v113
v_cvt_pk_bf16_f32 v165, v114, v115
v_mfma_f32_16x16x32_bf16 a[56:59], a[200:203], v[172:175], a[56:59]
ds_read_b128 a[160:163], v2 offset:20480
v_cvt_pk_bf16_f32 v166, v116, v117
v_mfma_f32_16x16x32_bf16 a[88:91], a[200:203], v[176:179], a[88:91]
v_cvt_pk_bf16_f32 v167, v118, v119
v_mfma_f32_16x16x32_bf16 a[120:123], a[200:203], v[180:183], a[120:123]
s_waitcnt lgkmcnt(5)
v_mfma_f32_16x16x32_bf16 a[60:63], a[204:207], v[172:175], a[60:63]
ds_read_b128 a[164:167], v2 offset:21504
v_mfma_f32_16x16x32_bf16 a[92:95], a[204:207], v[176:179], a[92:95]
v_mfma_f32_16x16x32_bf16 a[124:127], a[204:207], v[180:183], a[124:127]
v_mfma_f32_16x16x32_bf16 a[132:135], v[12:15], v[172:175], a[132:135]
v_mfma_f32_16x16x32_bf16 a[136:139], v[12:15], v[176:179], a[136:139]
v_mfma_f32_16x16x32_bf16 a[140:143], v[12:15], v[180:183], a[140:143]
s_waitcnt lgkmcnt(5)
s_nop 7
v_accvgpr_read_b32 v20, a128
v_accvgpr_read_b32 v21, a132
v_max3_f32 v1, v1, v20, v21
v_rcp_f32 v20, v20
v_rcp_f32 v21, v21
s_nop 0
v_mul_f32 v20, v20, v4
v_mul_f32 v21, v21, v6
v_accvgpr_read_b32 v88, a0
v_accvgpr_read_b32 v89, a1
v_accvgpr_read_b32 v90, a2
v_accvgpr_read_b32 v91, a3
v_accvgpr_read_b32 v92, a4
v_accvgpr_read_b32 v93, a5
v_accvgpr_read_b32 v94, a6
v_accvgpr_read_b32 v95, a7
s_add_u32 s65, s74, 0
v_mul_f32 v88, v88, v20
v_mul_f32 v89, v89, v20
v_mul_f32 v90, v90, v20
v_mul_f32 v91, v91, v20
v_mul_f32 v92, v92, v20
v_mul_f32 v93, v93, v20
v_mul_f32 v94, v94, v20
v_mul_f32 v95, v95, v20
v_cvt_pk_bf16_f32 v88, v88, v89
v_cvt_pk_bf16_f32 v89, v90, v91
v_cvt_pk_bf16_f32 v90, v92, v93
v_cvt_pk_bf16_f32 v91, v94, v95
buffer_store_dwordx4 v[88:91], v16, s[44:47], s65 offen sc1
v_accvgpr_read_b32 v120, a8
v_accvgpr_read_b32 v121, a9
v_accvgpr_read_b32 v122, a10
v_accvgpr_read_b32 v123, a11
v_accvgpr_read_b32 v124, a12
v_accvgpr_read_b32 v125, a13
v_accvgpr_read_b32 v126, a14
v_accvgpr_read_b32 v127, a15
s_add_u32 s65, s74, 8192
v_mul_f32 v120, v120, v20
v_mul_f32 v121, v121, v20
v_mul_f32 v122, v122, v20
v_mul_f32 v123, v123, v20
v_mul_f32 v124, v124, v20
v_mul_f32 v125, v125, v20
v_mul_f32 v126, v126, v20
v_mul_f32 v127, v127, v20
v_cvt_pk_bf16_f32 v120, v120, v121
v_cvt_pk_bf16_f32 v121, v122, v123
v_cvt_pk_bf16_f32 v122, v124, v125
v_cvt_pk_bf16_f32 v123, v126, v127
buffer_store_dwordx4 v[120:123], v16, s[44:47], s65 offen sc1
v_accvgpr_read_b32 v88, a16
v_accvgpr_read_b32 v89, a17
v_accvgpr_read_b32 v90, a18
v_accvgpr_read_b32 v91, a19
v_accvgpr_read_b32 v92, a20
v_accvgpr_read_b32 v93, a21
v_accvgpr_read_b32 v94, a22
v_accvgpr_read_b32 v95, a23
s_add_u32 s65, s74, 16384
v_mul_f32 v88, v88, v20
v_mul_f32 v89, v89, v20
v_mul_f32 v90, v90, v20
v_mul_f32 v91, v91, v20
v_mul_f32 v92, v92, v20
v_mul_f32 v93, v93, v20
v_mul_f32 v94, v94, v20
v_mul_f32 v95, v95, v20
v_cvt_pk_bf16_f32 v88, v88, v89
v_cvt_pk_bf16_f32 v89, v90, v91
v_cvt_pk_bf16_f32 v90, v92, v93
v_cvt_pk_bf16_f32 v91, v94, v95
buffer_store_dwordx4 v[88:91], v16, s[44:47], s65 offen sc1
v_accvgpr_read_b32 v120, a24
v_accvgpr_read_b32 v121, a25
v_accvgpr_read_b32 v122, a26
v_accvgpr_read_b32 v123, a27
v_accvgpr_read_b32 v124, a28
v_accvgpr_read_b32 v125, a29
v_accvgpr_read_b32 v126, a30
v_accvgpr_read_b32 v127, a31
s_add_u32 s65, s74, 24576
v_mul_f32 v120, v120, v20
v_mul_f32 v121, v121, v20
v_mul_f32 v122, v122, v20
v_mul_f32 v123, v123, v20
v_mul_f32 v124, v124, v20
v_mul_f32 v125, v125, v20
v_mul_f32 v126, v126, v20
v_mul_f32 v127, v127, v20
v_cvt_pk_bf16_f32 v120, v120, v121
v_cvt_pk_bf16_f32 v121, v122, v123
v_cvt_pk_bf16_f32 v122, v124, v125
v_cvt_pk_bf16_f32 v123, v126, v127
buffer_store_dwordx4 v[120:123], v16, s[44:47], s65 offen sc1
v_accvgpr_read_b32 v88, a32
v_accvgpr_read_b32 v89, a33
v_accvgpr_read_b32 v90, a34
v_accvgpr_read_b32 v91, a35
v_accvgpr_read_b32 v92, a36
v_accvgpr_read_b32 v93, a37
v_accvgpr_read_b32 v94, a38
v_accvgpr_read_b32 v95, a39
s_add_u32 s65, s74, 4096
v_mul_f32 v88, v88, v21
v_mul_f32 v89, v89, v21
v_mul_f32 v90, v90, v21
v_mul_f32 v91, v91, v21
v_mul_f32 v92, v92, v21
v_mul_f32 v93, v93, v21
v_mul_f32 v94, v94, v21
v_mul_f32 v95, v95, v21
v_cvt_pk_bf16_f32 v88, v88, v89
v_cvt_pk_bf16_f32 v89, v90, v91
v_cvt_pk_bf16_f32 v90, v92, v93
v_cvt_pk_bf16_f32 v91, v94, v95
buffer_store_dwordx4 v[88:91], v16, s[44:47], s65 offen sc1
v_accvgpr_read_b32 v120, a40
v_accvgpr_read_b32 v121, a41
v_accvgpr_read_b32 v122, a42
v_accvgpr_read_b32 v123, a43
v_accvgpr_read_b32 v124, a44
v_accvgpr_read_b32 v125, a45
v_accvgpr_read_b32 v126, a46
v_accvgpr_read_b32 v127, a47
s_add_u32 s65, s74, 12288
v_mul_f32 v120, v120, v21
v_mul_f32 v121, v121, v21
v_mul_f32 v122, v122, v21
v_mul_f32 v123, v123, v21
v_mul_f32 v124, v124, v21
v_mul_f32 v125, v125, v21
v_mul_f32 v126, v126, v21
v_mul_f32 v127, v127, v21
v_cvt_pk_bf16_f32 v120, v120, v121
v_cvt_pk_bf16_f32 v121, v122, v123
v_cvt_pk_bf16_f32 v122, v124, v125
v_cvt_pk_bf16_f32 v123, v126, v127
buffer_store_dwordx4 v[120:123], v16, s[44:47], s65 offen sc1
v_accvgpr_read_b32 v88, a48
v_accvgpr_read_b32 v89, a49
v_accvgpr_read_b32 v90, a50
v_accvgpr_read_b32 v91, a51
v_accvgpr_read_b32 v92, a52
v_accvgpr_read_b32 v93, a53
v_accvgpr_read_b32 v94, a54
v_accvgpr_read_b32 v95, a55
s_add_u32 s65, s74, 20480
v_mul_f32 v88, v88, v21
v_mul_f32 v89, v89, v21
v_mul_f32 v90, v90, v21
v_mul_f32 v91, v91, v21
v_mul_f32 v92, v92, v21
v_mul_f32 v93, v93, v21
v_mul_f32 v94, v94, v21
v_mul_f32 v95, v95, v21
v_cvt_pk_bf16_f32 v88, v88, v89
v_cvt_pk_bf16_f32 v89, v90, v91
v_cvt_pk_bf16_f32 v90, v92, v93
v_cvt_pk_bf16_f32 v91, v94, v95
buffer_store_dwordx4 v[88:91], v16, s[44:47], s65 offen sc1
v_accvgpr_read_b32 v120, a56
v_accvgpr_read_b32 v121, a57
v_accvgpr_read_b32 v122, a58
v_accvgpr_read_b32 v123, a59
v_accvgpr_read_b32 v124, a60
v_accvgpr_read_b32 v125, a61
v_accvgpr_read_b32 v126, a62
v_accvgpr_read_b32 v127, a63
s_add_u32 s65, s74, 28672
v_mul_f32 v120, v120, v21
v_mul_f32 v121, v121, v21
v_mul_f32 v122, v122, v21
v_mul_f32 v123, v123, v21
v_mul_f32 v124, v124, v21
v_mul_f32 v125, v125, v21
v_mul_f32 v126, v126, v21
v_mul_f32 v127, v127, v21
v_cvt_pk_bf16_f32 v120, v120, v121
v_cvt_pk_bf16_f32 v121, v122, v123
v_cvt_pk_bf16_f32 v122, v124, v125
v_cvt_pk_bf16_f32 v123, v126, v127
buffer_store_dwordx4 v[120:123], v16, s[44:47], s65 offen sc1
v_mfma_f32_16x16x32_bf16 v[112:115], a[144:147], v[72:75], v[216:219]
s_waitcnt vmcnt(9)
v_readfirstlane_b32 s66, v19
s_nop 0
s_cmp_lt_u32 s66, 256
s_cbranch_scc1 L_spin_1017
L_spinbk_1018:
s_waitcnt lgkmcnt(4)
v_mfma_f32_16x16x32_bf16 v[112:115], a[148:151], v[76:79], v[112:115]
s_waitcnt lgkmcnt(3)
v_exp_f32 v136, v136
v_mfma_f32_16x16x32_bf16 v[112:115], a[152:155], v[80:83], v[112:115]
s_waitcnt lgkmcnt(2)
s_add_u32 m0, s86, 131072
ds_read_b128 a[168:171], v2 offset:22528
v_mfma_f32_16x16x32_bf16 v[112:115], a[156:159], v[84:87], v[112:115]
s_waitcnt lgkmcnt(2)
s_add_u32 s64, s85, 0
v_exp_f32 v137, v137
v_mfma_f32_16x16x32_bf16 v[116:119], a[160:163], v[72:75], v[220:223]
s_waitcnt lgkmcnt(1)
ds_read_b128 a[172:175], v2 offset:23552
buffer_load_dwordx4 v17, s[36:39], s64 offen lds
v_exp_f32 v138, v138
v_mfma_f32_16x16x32_bf16 v[116:119], a[164:167], v[76:79], v[116:119]
s_waitcnt lgkmcnt(1)
s_add_u32 m0, s86, 132096
ds_read_b128 a[176:179], v3 offset:16384
v_cvt_pk_bf16_f32 v176, v136, v137
v_mfma_f32_16x16x32_bf16 v[116:119], a[168:171], v[80:83], v[116:119]
s_waitcnt lgkmcnt(1)
s_add_u32 s64, s85, 8192
ds_read_b128 a[180:183], v3 offset:17408
v_exp_f32 v139, v139
v_mfma_f32_16x16x32_bf16 v[116:119], a[172:175], v[84:87], v[116:119]
s_waitcnt lgkmcnt(1)
buffer_load_dwordx4 v18, s[36:39], s64 offen lds
ds_read_b128 a[184:187], v3 offset:18432
v_exp_f32 v140, v140
v_mfma_f32_16x16x32_bf16 a[64:67], a[176:179], v[160:163], a[64:67]
s_add_u32 m0, s86, 133120
ds_read_b128 a[188:191], v3 offset:19456
v_add_f32 v216, v196, v208
v_mfma_f32_16x16x32_bf16 a[96:99], a[176:179], v[164:167], a[96:99]
s_waitcnt lgkmcnt(2)
s_add_u32 s64, s85, 16384
ds_read_b128 a[192:195], v3 offset:20480
v_exp_f32 v141, v141
v_mfma_f32_16x16x32_bf16 a[68:71], a[180:183], v[160:163], a[68:71]
buffer_load_dwordx4 v17, s[36:39], s64 offen lds
ds_read_b128 a[196:199], v3 offset:21504
v_exp_f32 v142, v142
v_mfma_f32_16x16x32_bf16 a[100:103], a[180:183], v[164:167], a[100:103]
s_waitcnt lgkmcnt(3)
s_add_u32 m0, s86, 134144
ds_read_b128 a[200:203], v3 offset:22528
v_add_f32 v217, v196, v209
v_mfma_f32_16x16x32_bf16 a[72:75], a[184:187], v[160:163], a[72:75]
s_add_u32 s64, s85, 24576
v_exp_f32 v143, v143
v_mfma_f32_16x16x32_bf16 a[104:107], a[184:187], v[164:167], a[104:107]
s_waitcnt lgkmcnt(3)
buffer_load_dwordx4 v18, s[36:39], s64 offen lds
ds_read_b128 a[204:207], v3 offset:23552
v_exp_f32 v144, v144
v_mfma_f32_16x16x32_bf16 a[76:79], a[188:191], v[160:163], a[76:79]
s_add_u32 s65, s84, 0
v_exp_f32 v145, v145
v_mfma_f32_16x16x32_bf16 a[108:111], a[188:191], v[164:167], a[108:111]
s_waitcnt lgkmcnt(3)
ds_read_b128 a[144:147], v2 offset:24576
v_add_f32 v218, v196, v210
v_mfma_f32_16x16x32_bf16 a[80:83], a[192:195], v[160:163], a[80:83]
buffer_load_dwordx4 v[224:227], v16, s[44:47], s65 offen offset:0 sc1
v_exp_f32 v146, v146
v_mfma_f32_16x16x32_bf16 a[112:115], a[192:195], v[164:167], a[112:115]
s_waitcnt lgkmcnt(3)
ds_read_b128 a[148:151], v2 offset:25600
v_add_f32 v219, v196, v211
v_mfma_f32_16x16x32_bf16 a[84:87], a[196:199], v[160:163], a[84:87]
v_exp_f32 v147, v147
v_mfma_f32_16x16x32_bf16 a[116:119], a[196:199], v[164:167], a[116:119]
s_waitcnt lgkmcnt(3)
buffer_load_dwordx4 v[228:231], v16, s[44:47], s65 offen offset:1024 sc1
ds_read_b128 a[152:155], v2 offset:26624
v_exp_f32 v148, v148
v_mfma_f32_16x16x32_bf16 a[88:91], a[200:203], v[160:163], a[88:91]
s_add_u32 s65, s84, 8192
v_exp_f32 v149, v149
v_mfma_f32_16x16x32_bf16 a[120:123], a[200:203], v[164:167], a[120:123]
s_waitcnt lgkmcnt(3)
ds_read_b128 a[156:159], v2 offset:27648
v_add_f32 v220, v196, v212
v_mfma_f32_16x16x32_bf16 a[92:95], a[204:207], v[160:163], a[92:95]
buffer_load_dwordx4 v[232:235], v16, s[44:47], s65 offen offset:0 sc1
v_exp_f32 v150, v150
v_mfma_f32_16x16x32_bf16 a[124:127], a[204:207], v[164:167], a[124:127]
ds_read_b128 a[160:163], v2 offset:28672
v_add_f32 v221, v196, v213
v_add_f32 v222, v196, v214
v_add_f32 v223, v196, v215
v_mfma_f32_16x16x32_bf16 a[136:139], v[12:15], v[160:163], a[136:139]
v_exp_f32 v151, v151
v_mfma_f32_16x16x32_bf16 a[140:143], v[12:15], v[164:167], a[140:143]
s_waitcnt lgkmcnt(4)
buffer_load_dwordx4 v[236:239], v16, s[44:47], s65 offen offset:1024 sc1
ds_read_b128 a[164:167], v2 offset:29696
v_cvt_pk_bf16_f32 v177, v138, v139
v_cvt_pk_bf16_f32 v178, v140, v141
v_cvt_pk_bf16_f32 v179, v142, v143
v_cvt_pk_bf16_f32 v180, v144, v145
v_cvt_pk_bf16_f32 v181, v146, v147
v_cvt_pk_bf16_f32 v182, v148, v149
v_cvt_pk_bf16_f32 v183, v150, v151
v_mfma_f32_16x16x32_bf16 v[144:147], a[144:147], v[72:75], v[216:219]
s_waitcnt lgkmcnt(4)
ds_read_b128 a[168:171], v2 offset:30720
v_mfma_f32_16x16x32_bf16 v[144:147], a[148:151], v[76:79], v[144:147]
s_waitcnt lgkmcnt(4)
v_exp_f32 v112, v112
v_mfma_f32_16x16x32_bf16 v[144:147], a[152:155], v[80:83], v[144:147]
s_waitcnt lgkmcnt(3)
ds_read_b128 a[172:175], v2 offset:31744
v_mfma_f32_16x16x32_bf16 v[144:147], a[156:159], v[84:87], v[144:147]
s_waitcnt lgkmcnt(3)
ds_read_b128 a[176:179], v3 offset:24576
v_mfma_f32_16x16x32_bf16 v[148:151], a[160:163], v[72:75], v[220:223]
s_waitcnt lgkmcnt(3)
v_exp_f32 v113, v113
v_mfma_f32_16x16x32_bf16 v[148:151], a[164:167], v[76:79], v[148:151]
s_waitcnt lgkmcnt(2)
ds_read_b128 a[180:183], v3 offset:25600
v_xor_b32 v2, 0x8000, v2
v_mfma_f32_16x16x32_bf16 v[148:151], a[168:171], v[80:83], v[148:151]
s_waitcnt lgkmcnt(2)
ds_read_b128 a[184:187], v3 offset:26624
v_cvt_pk_bf16_f32 v164, v112, v113
v_mfma_f32_16x16x32_bf16 v[148:151], a[172:175], v[84:87], v[148:151]
s_waitcnt lgkmcnt(2)
ds_read_b128 a[188:191], v3 offset:27648
v_mfma_f32_16x16x32_bf16 a[64:67], a[176:179], v[176:179], a[64:67]
v_exp_f32 v114, v114
v_mfma_f32_16x16x32_bf16 a[96:99], a[176:179], v[180:183], a[96:99]
s_waitcnt lgkmcnt(2)
s_add_u32 m0, s86, 147456
ds_read_b128 a[192:195], v3 offset:28672
v_mfma_f32_16x16x32_bf16 a[68:71], a[180:183], v[176:179], a[68:71]
s_add_u32 s64, s85, 131072
ds_read_b128 a[196:199], v3 offset:29696
v_mfma_f32_16x16x32_bf16 a[100:103], a[180:183], v[180:183], a[100:103]
s_waitcnt lgkmcnt(3)
buffer_load_dwordx4 v17, s[36:39], s64 offen lds
ds_read_b128 a[200:203], v3 offset:30720
v_mfma_f32_16x16x32_bf16 a[72:75], a[184:187], v[176:179], a[72:75]
s_add_u32 m0, s86, 148480
s_add_u32 s64, s85, 139264
v_exp_f32 v115, v115
v_mfma_f32_16x16x32_bf16 a[104:107], a[184:187], v[180:183], a[104:107]
buffer_load_dwordx4 v18, s[36:39], s64 offen lds
ds_read_b128 a[204:207], v3 offset:31744
s_waitcnt vmcnt(18)
s_barrier
s_waitcnt lgkmcnt(4)
v_mfma_f32_16x16x32_bf16 a[76:79], a[188:191], v[176:179], a[76:79]
s_add_u32 m0, s86, 149504
s_add_u32 s64, s85, 147456
v_exp_f32 v116, v116
v_mfma_f32_16x16x32_bf16 a[108:111], a[188:191], v[180:183], a[108:111]
s_waitcnt lgkmcnt(3)
buffer_load_dwordx4 v17, s[36:39], s64 offen lds
v_mfma_f32_16x16x32_bf16 a[80:83], a[192:195], v[176:179], a[80:83]
s_add_u32 m0, s86, 150528
s_add_u32 s64, s85, 155648
v_exp_f32 v117, v117
v_mfma_f32_16x16x32_bf16 a[112:115], a[192:195], v[180:183], a[112:115]
s_waitcnt lgkmcnt(2)
buffer_load_dwordx4 v18, s[36:39], s64 offen lds
v_mfma_f32_16x16x32_bf16 a[84:87], a[196:199], v[176:179], a[84:87]
s_add_u32 s65, s84, 16384
v_exp_f32 v118, v118
v_mfma_f32_16x16x32_bf16 a[116:119], a[196:199], v[180:183], a[116:119]
s_waitcnt lgkmcnt(1)
buffer_load_dwordx4 v[240:243], v16, s[44:47], s65 offen offset:0 sc1
v_mfma_f32_16x16x32_bf16 a[88:91], a[200:203], v[176:179], a[88:91]
v_exp_f32 v119, v119
v_mfma_f32_16x16x32_bf16 a[120:123], a[200:203], v[180:183], a[120:123]
s_waitcnt lgkmcnt(0)
buffer_load_dwordx4 v[244:247], v16, s[44:47], s65 offen offset:1024 sc1
v_mfma_f32_16x16x32_bf16 a[92:95], a[204:207], v[176:179], a[92:95]
s_add_u32 s65, s84, 24576
v_cvt_pk_bf16_f32 v165, v114, v115
v_cvt_pk_bf16_f32 v166, v116, v117
v_mfma_f32_16x16x32_bf16 a[124:127], a[204:207], v[180:183], a[124:127]
buffer_load_dwordx4 v[248:251], v16, s[44:47], s65 offen offset:0 sc1
v_mfma_f32_16x16x32_bf16 a[136:139], v[12:15], v[176:179], a[136:139]
v_cvt_pk_bf16_f32 v167, v118, v119
v_xor_b32 v3, 0x8000, v3
v_mfma_f32_16x16x32_bf16 a[140:143], v[12:15], v[180:183], a[140:143]
buffer_load_dwordx4 v[252:255], v16, s[44:47], s65 offen offset:1024 sc1
s_branch L_TAIL_12
L_fallback_16:
s_waitcnt vmcnt(0) lgkmcnt(0)
s_barrier
s_mov_b32 s73, 1
s_mov_b32 s88, 0
v_and_b32 v228, 15, v0
v_lshrrev_b32 v229, 4, v0
v_lshlrev_b32 v229, 2, v229
v_sub_u32 v228, v228, v229
s_lshl_b32 s66, s30, 4
v_add_u32 v228, s66, v228
s_lshl_b32 s66, s16, 7
v_add_u32 v230, s66, v228
s_lshl_b32 s66, s3, 7
v_add_u32 v228, s66, v228
v_add_u32 v229, 64, v228
v_add_u32 v231, 64, v230
s_mov_b32 m0, s76
s_lshl_b32 s64, s30, 14
s_nop 0
buffer_load_dwordx4 v16, s[32:35], s64 offen offset:0 sc1 lds
s_nop 0
buffer_load_dwordx4 v16, s[32:35], s64 offen offset:1024 sc1 lds
s_nop 0
buffer_load_dwordx4 v16, s[32:35], s64 offen offset:2048 sc1 lds
s_nop 0
buffer_load_dwordx4 v16, s[32:35], s64 offen offset:3072 sc1 lds
s_add_u32 m0, s76, 4096
s_add_u32 s64, s64, 4096
s_nop 0
buffer_load_dwordx4 v16, s[32:35], s64 offen offset:0 sc1 lds
s_nop 0
buffer_load_dwordx4 v16, s[32:35], s64 offen offset:1024 sc1 lds
s_nop 0
buffer_load_dwordx4 v16, s[32:35], s64 offen offset:2048 sc1 lds
s_nop 0
buffer_load_dwordx4 v16, s[32:35], s64 offen offset:3072 sc1 lds
s_lshr_b32 s64, s76, 1
s_add_u32 m0, s64, 81920
s_and_b32 s69, s64, 8192
s_add_u32 s64, s64, s69
s_add_u32 s64, s64, 8192
s_nop 0
buffer_load_dwordx4 v16, s[32:35], s64 offen offset:0 sc1 lds
s_nop 0
buffer_load_dwordx4 v16, s[32:35], s64 offen offset:1024 sc1 lds
s_nop 0
buffer_load_dwordx4 v16, s[32:35], s64 offen offset:2048 sc1 lds
s_nop 0
buffer_load_dwordx4 v16, s[32:35], s64 offen offset:3072 sc1 lds
v_mov_b32 v20, 0xff800000
v_mov_b32 v21, 0xff800000
v_mov_b32 v22, 0xff800000
v_mov_b32 v23, 0xff800000
L_fbl_1020:
buffer_load_dwordx4 a[144:147], v16, s[32:35], s88 offen offset:0 sc1
buffer_load_dwordx4 a[148:151], v16, s[32:35], s88 offen offset:1024 sc1
buffer_load_dwordx4 a[152:155], v16, s[32:35], s88 offen offset:2048 sc1
buffer_load_dwordx4 a[156:159], v16, s[32:35], s88 offen offset:3072 sc1
s_add_u32 s64, s88, 4096
buffer_load_dwordx4 a[160:163], v16, s[32:35], s64 offen offset:0 sc1
buffer_load_dwordx4 a[164:167], v16, s[32:35], s64 offen offset:1024 sc1
buffer_load_dwordx4 a[168:171], v16, s[32:35], s64 offen offset:2048 sc1
buffer_load_dwordx4 a[172:175], v16, s[32:35], s64 offen offset:3072 sc1
v_subrev_u32 v88, 0, v228
v_ashrrev_i32 v88, 31, v88
v_and_b32 v88, 0xff800000, v88
v_subrev_u32 v89, 1, v228
v_ashrrev_i32 v89, 31, v89
v_and_b32 v89, 0xff800000, v89
v_subrev_u32 v90, 2, v228
v_ashrrev_i32 v90, 31, v90
v_and_b32 v90, 0xff800000, v90
v_subrev_u32 v91, 3, v228
v_ashrrev_i32 v91, 31, v91
v_and_b32 v91, 0xff800000, v91
v_subrev_u32 v92, 16, v228
v_ashrrev_i32 v92, 31, v92
v_and_b32 v92, 0xff800000, v92
v_subrev_u32 v93, 17, v228
v_ashrrev_i32 v93, 31, v93
v_and_b32 v93, 0xff800000, v93
v_subrev_u32 v94, 18, v228
v_ashrrev_i32 v94, 31, v94
v_and_b32 v94, 0xff800000, v94
v_subrev_u32 v95, 19, v228
v_ashrrev_i32 v95, 31, v95
v_and_b32 v95, 0xff800000, v95
v_subrev_u32 v228, 32, v228
v_subrev_u32 v96, 0, v229
v_ashrrev_i32 v96, 31, v96
v_and_b32 v96, 0xff800000, v96
v_subrev_u32 v97, 1, v229
v_ashrrev_i32 v97, 31, v97
v_and_b32 v97, 0xff800000, v97
v_subrev_u32 v98, 2, v229
v_ashrrev_i32 v98, 31, v98
v_and_b32 v98, 0xff800000, v98
v_subrev_u32 v99, 3, v229
v_ashrrev_i32 v99, 31, v99
v_and_b32 v99, 0xff800000, v99
v_subrev_u32 v100, 16, v229
v_ashrrev_i32 v100, 31, v100
v_and_b32 v100, 0xff800000, v100
v_subrev_u32 v101, 17, v229
v_ashrrev_i32 v101, 31, v101
v_and_b32 v101, 0xff800000, v101
v_subrev_u32 v102, 18, v229
v_ashrrev_i32 v102, 31, v102
v_and_b32 v102, 0xff800000, v102
v_subrev_u32 v103, 19, v229
v_ashrrev_i32 v103, 31, v103
v_and_b32 v103, 0xff800000, v103
v_subrev_u32 v229, 32, v229
v_subrev_u32 v104, 0, v230
v_ashrrev_i32 v104, 31, v104
v_and_b32 v104, 0xff800000, v104
v_subrev_u32 v105, 1, v230
v_ashrrev_i32 v105, 31, v105
v_and_b32 v105, 0xff800000, v105
v_subrev_u32 v106, 2, v230
v_ashrrev_i32 v106, 31, v106
v_and_b32 v106, 0xff800000, v106
v_subrev_u32 v107, 3, v230
v_ashrrev_i32 v107, 31, v107
v_and_b32 v107, 0xff800000, v107
v_subrev_u32 v108, 16, v230
v_ashrrev_i32 v108, 31, v108
v_and_b32 v108, 0xff800000, v108
v_subrev_u32 v109, 17, v230
v_ashrrev_i32 v109, 31, v109
v_and_b32 v109, 0xff800000, v109
v_subrev_u32 v110, 18, v230
v_ashrrev_i32 v110, 31, v110
v_and_b32 v110, 0xff800000, v110
v_subrev_u32 v111, 19, v230
v_ashrrev_i32 v111, 31, v111
v_and_b32 v111, 0xff800000, v111
v_subrev_u32 v230, 32, v230
v_subrev_u32 v112, 0, v231
v_ashrrev_i32 v112, 31, v112
v_and_b32 v112, 0xff800000, v112
v_subrev_u32 v113, 1, v231
v_ashrrev_i32 v113, 31, v113
v_and_b32 v113, 0xff800000, v113
v_subrev_u32 v114, 2, v231
v_ashrrev_i32 v114, 31, v114
v_and_b32 v114, 0xff800000, v114
v_subrev_u32 v115, 3, v231
v_ashrrev_i32 v115, 31, v115
v_and_b32 v115, 0xff800000, v115
v_subrev_u32 v116, 16, v231
v_ashrrev_i32 v116, 31, v116
v_and_b32 v116, 0xff800000, v116
v_subrev_u32 v117, 17, v231
v_ashrrev_i32 v117, 31, v117
v_and_b32 v117, 0xff800000, v117
v_subrev_u32 v118, 18, v231
v_ashrrev_i32 v118, 31, v118
v_and_b32 v118, 0xff800000, v118
v_subrev_u32 v119, 19, v231
v_ashrrev_i32 v119, 31, v119
v_and_b32 v119, 0xff800000, v119
v_subrev_u32 v231, 32, v231
s_waitcnt vmcnt(0)
v_mfma_f32_16x16x32_bf16 v[88:91], a[144:147], v[24:27], v[88:91]
v_mfma_f32_16x16x32_bf16 v[96:99], a[144:147], v[40:43], v[96:99]
v_mfma_f32_16x16x32_bf16 v[104:107], a[144:147], v[56:59], v[104:107]
v_mfma_f32_16x16x32_bf16 v[112:115], a[144:147], v[72:75], v[112:115]
v_mfma_f32_16x16x32_bf16 v[88:91], a[148:151], v[28:31], v[88:91]
v_mfma_f32_16x16x32_bf16 v[96:99], a[148:151], v[44:47], v[96:99]
v_mfma_f32_16x16x32_bf16 v[104:107], a[148:151], v[60:63], v[104:107]
v_mfma_f32_16x16x32_bf16 v[112:115], a[148:151], v[76:79], v[112:115]
v_mfma_f32_16x16x32_bf16 v[88:91], a[152:155], v[32:35], v[88:91]
v_mfma_f32_16x16x32_bf16 v[96:99], a[152:155], v[48:51], v[96:99]
v_mfma_f32_16x16x32_bf16 v[104:107], a[152:155], v[64:67], v[104:107]
v_mfma_f32_16x16x32_bf16 v[112:115], a[152:155], v[80:83], v[112:115]
v_mfma_f32_16x16x32_bf16 v[88:91], a[156:159], v[36:39], v[88:91]
v_mfma_f32_16x16x32_bf16 v[96:99], a[156:159], v[52:55], v[96:99]
v_mfma_f32_16x16x32_bf16 v[104:107], a[156:159], v[68:71], v[104:107]
v_mfma_f32_16x16x32_bf16 v[112:115], a[156:159], v[84:87], v[112:115]
v_mfma_f32_16x16x32_bf16 v[92:95], a[160:163], v[24:27], v[92:95]
v_mfma_f32_16x16x32_bf16 v[100:103], a[160:163], v[40:43], v[100:103]
v_mfma_f32_16x16x32_bf16 v[108:111], a[160:163], v[56:59], v[108:111]
v_mfma_f32_16x16x32_bf16 v[116:119], a[160:163], v[72:75], v[116:119]
v_mfma_f32_16x16x32_bf16 v[92:95], a[164:167], v[28:31], v[92:95]
v_mfma_f32_16x16x32_bf16 v[100:103], a[164:167], v[44:47], v[100:103]
v_mfma_f32_16x16x32_bf16 v[108:111], a[164:167], v[60:63], v[108:111]
v_mfma_f32_16x16x32_bf16 v[116:119], a[164:167], v[76:79], v[116:119]
v_mfma_f32_16x16x32_bf16 v[92:95], a[168:171], v[32:35], v[92:95]
v_mfma_f32_16x16x32_bf16 v[100:103], a[168:171], v[48:51], v[100:103]
v_mfma_f32_16x16x32_bf16 v[108:111], a[168:171], v[64:67], v[108:111]
v_mfma_f32_16x16x32_bf16 v[116:119], a[168:171], v[80:83], v[116:119]
v_mfma_f32_16x16x32_bf16 v[92:95], a[172:175], v[36:39], v[92:95]
v_mfma_f32_16x16x32_bf16 v[100:103], a[172:175], v[52:55], v[100:103]
v_mfma_f32_16x16x32_bf16 v[108:111], a[172:175], v[68:71], v[108:111]
v_mfma_f32_16x16x32_bf16 v[116:119], a[172:175], v[84:87], v[116:119]
s_nop 7
v_max3_f32 v20, v20, v88, v89
v_max3_f32 v20, v20, v90, v91
v_max3_f32 v20, v20, v92, v93
v_max3_f32 v20, v20, v94, v95
v_max3_f32 v21, v21, v96, v97
v_max3_f32 v21, v21, v98, v99
v_max3_f32 v21, v21, v100, v101
v_max3_f32 v21, v21, v102, v103
v_max3_f32 v22, v22, v104, v105
v_max3_f32 v22, v22, v106, v107
v_max3_f32 v22, v22, v108, v109
v_max3_f32 v22, v22, v110, v111
v_max3_f32 v23, v23, v112, v113
v_max3_f32 v23, v23, v114, v115
v_max3_f32 v23, v23, v116, v117
v_max3_f32 v23, v23, v118, v119
s_add_u32 s88, s88, 16384
s_cmp_lt_u32 s88, s34
s_cbranch_scc1 L_fbl_1020
v_mov_b32 v224, v20
v_mov_b32 v225, v21
v_mov_b32 v226, v22
v_mov_b32 v227, v23
v_permlane16_swap_b32 v224, v20
v_permlane16_swap_b32 v225, v21
v_permlane16_swap_b32 v226, v22
v_permlane16_swap_b32 v227, v23
v_max_f32 v20, v20, v224
v_max_f32 v21, v21, v225
v_max_f32 v22, v22, v226
v_max_f32 v23, v23, v227
v_mov_b32 v224, v20
v_mov_b32 v225, v21
v_mov_b32 v226, v22
v_mov_b32 v227, v23
v_permlane32_swap_b32 v224, v20
v_permlane32_swap_b32 v225, v21
v_permlane32_swap_b32 v226, v22
v_permlane32_swap_b32 v227, v23
v_max_f32 v20, v20, v224
v_max_f32 v21, v21, v225
v_max_f32 v22, v22, v226
v_max_f32 v23, v23, v227
v_sub_f32 v184, 0, v20
v_sub_f32 v185, 0, v20
v_sub_f32 v186, 0, v20
v_sub_f32 v187, 0, v20
v_sub_f32 v188, 0, v21
v_sub_f32 v189, 0, v21
v_sub_f32 v190, 0, v21
v_sub_f32 v191, 0, v21
v_sub_f32 v192, 0, v22
v_sub_f32 v193, 0, v22
v_sub_f32 v194, 0, v22
v_sub_f32 v195, 0, v22
v_sub_f32 v196, 0, v23
v_sub_f32 v197, 0, v23
v_sub_f32 v198, 0, v23
v_sub_f32 v199, 0, v23
s_branch L_attstart_4
L_spin_2021:
s_mov_b32 s67, 0x8000
L_spinlp_2023:
s_sleep 1
buffer_load_dword v19, off, s[52:55], s72 offset:0 sc1
s_waitcnt vmcnt(0)
v_readfirstlane_b32 s66, v19
s_sub_u32 s67, s67, 1
s_cbranch_scc1 L_spinbk_2022
s_cmp_lt_u32 s66, 16
s_cbranch_scc1 L_spinlp_2023
s_branch L_spinbk_2022
L_spin_2025:
s_mov_b32 s67, 0x8000
L_spinlp_2027:
s_sleep 1
buffer_load_dword v19, off, s[52:55], s72 offset:0 sc1
s_waitcnt vmcnt(0)
v_readfirstlane_b32 s66, v19
s_sub_u32 s67, s67, 1
s_cbranch_scc1 L_spinbk_2026
s_cmp_lt_u32 s66, 1
s_cbranch_scc1 L_spinlp_2027
s_branch L_spinbk_2026
L_codeend:
.fill 2048, 4, 0xbf810000
.section .rodata,"a"
.p2align 6
.amdhsa_kernel gated_mix__compressed_kv_cla__sliding_local_dilated__prompt_kernel
  .amdhsa_next_free_vgpr 512
  .amdhsa_next_free_sgpr 102
  .amdhsa_accum_offset 256
  .amdhsa_group_segment_fixed_size 0
  .amdhsa_kernarg_size 104
  .amdhsa_user_sgpr_count 2
  .amdhsa_user_sgpr_kernarg_segment_ptr 1
  .amdhsa_system_sgpr_workgroup_id_x 1
.end_amdhsa_kernel
```

```asm
; @launch grid=(256,1,1) block=(256,1,1) lds=163840
.amdgcn_target "amdgcn-amd-amdhsa--gfx950"
.text
.globl gated_mix__compressed_kv_cla__sliding_local_dilated__prompt_kernel
.p2align 8
.type gated_mix__compressed_kv_cla__sliding_local_dilated__prompt_kernel,@function
gated_mix__compressed_kv_cla__sliding_local_dilated__prompt_kernel:
s_cmp_ge_u32 s2, 256
s_cbranch_scc1 L_end
s_load_dwordx16 s[4:19], s[0:1], 0
s_load_dwordx8 s[20:27], s[0:1], 64
s_load_dwordx2 s[28:29], s[0:1], 96
s_getpc_b64 s[88:89]
L_pc:
v_lshrrev_b32 v1, 6, v0
s_lshr_b32 s67, s2, 3
v_lshl_add_u32 v24, s67, 2, v1
s_mov_b32 s90, L_codeend-L_pc
s_mov_b32 s91, 0x20000
v_and_b32 v25, 7, v0
v_lshlrev_b32 v25, 7, v25
v_lshl_add_u32 v24, v24, 10, v25
buffer_load_dword a252, v24, s[88:91], 0 offen
v_and_b32 v0, 63, v0
v_readfirstlane_b32 s30, v1
v_lshrrev_b32 v24, 3, v0
v_lshrrev_b32 v25, 4, v0
v_and_b32 v26, 7, v0
v_xor_b32 v26, v26, v25
v_lshlrev_b32 v26, 4, v26
v_lshl_add_u32 v12, v24, 10, v26
v_xor_b32 v13, 64, v12
v_bfe_u32 v26, v0, 1, 3
v_xor_b32 v26, v26, v25
v_lshlrev_b32 v26, 5, v26
v_and_b32 v24, 1, v0
v_lshl_add_u32 v26, v24, 4, v26
v_lshl_add_u32 v14, v25, 13, v26
v_xor_b32 v15, 128, v14
s_and_b32 s66, s2, 7
s_and_b32 s68, s67, 3
s_lshl2_add_u32 s31, s66, s68
s_lshr_b32 s3, s67, 2
s_lshl2_add_u32 s80, s67, s30
s_lshl_b32 s70, s3, 18
s_lshl_b32 s66, s30, 16
s_add_u32 s70, s70, s66
s_lshl_b32 s71, s30, 17
s_lshl_b32 s66, s31, 8
s_add_u32 s71, s71, s66
s_lshl_b32 s76, s30, 13
s_lshl_b32 s77, s30, 12
s_lshl_b32 s78, s30, 10
s_waitcnt lgkmcnt(0)
s_mov_b32 s32, s6
s_mov_b32 s33, s7
s_mov_b32 s34, 2097152
s_mov_b32 s35, 0x20000
s_mov_b32 s36, s10
s_mov_b32 s37, s11
s_mov_b32 s38, 4194304
s_mov_b32 s39, 0x20000
s_mov_b32 s40, s12
s_mov_b32 s41, s13
s_mov_b32 s42, 4194304
s_mov_b32 s43, 0x20000
s_add_u32 m0, s76, 0
s_add_u32 s64, s70, 0
buffer_load_dwordx4 v12, s[32:35], s64 offen lds
s_add_u32 m0, s76, 1024
s_add_u32 s64, s70, 8192
buffer_load_dwordx4 v13, s[32:35], s64 offen lds
s_add_u32 m0, s76, 2048
s_add_u32 s64, s70, 16384
buffer_load_dwordx4 v12, s[32:35], s64 offen lds
s_add_u32 m0, s76, 3072
s_add_u32 s64, s70, 24576
buffer_load_dwordx4 v13, s[32:35], s64 offen lds
s_add_u32 m0, s76, 4096
s_add_u32 s64, s70, 32768
buffer_load_dwordx4 v12, s[32:35], s64 offen lds
s_add_u32 m0, s76, 5120
s_add_u32 s64, s70, 40960
buffer_load_dwordx4 v13, s[32:35], s64 offen lds
s_add_u32 m0, s76, 6144
s_add_u32 s64, s70, 49152
buffer_load_dwordx4 v12, s[32:35], s64 offen lds
s_add_u32 m0, s76, 7168
s_add_u32 s64, s70, 57344
buffer_load_dwordx4 v13, s[32:35], s64 offen lds
s_add_u32 m0, s77, 65536
s_add_u32 s64, s71, 0
buffer_load_dwordx4 v14, s[36:39], s64 offen lds
s_add_u32 m0, s77, 66560
s_add_u32 s64, s71, 32768
buffer_load_dwordx4 v14, s[36:39], s64 offen lds
s_add_u32 m0, s77, 67584
s_add_u32 s64, s71, 65536
buffer_load_dwordx4 v15, s[36:39], s64 offen lds
s_add_u32 m0, s77, 68608
s_add_u32 s64, s71, 98304
buffer_load_dwordx4 v15, s[36:39], s64 offen lds
s_add_u32 m0, s77, 81920
s_add_u32 s64, s71, 0
buffer_load_dwordx4 v14, s[40:43], s64 offen lds
s_add_u32 m0, s77, 82944
s_add_u32 s64, s71, 32768
buffer_load_dwordx4 v14, s[40:43], s64 offen lds
s_add_u32 m0, s77, 83968
s_add_u32 s64, s71, 65536
buffer_load_dwordx4 v15, s[40:43], s64 offen lds
s_add_u32 m0, s77, 84992
s_add_u32 s64, s71, 98304
buffer_load_dwordx4 v15, s[40:43], s64 offen lds
s_mov_b32 s44, s28
s_mov_b32 s45, s29
s_mov_b32 s46, 134217728
s_mov_b32 s47, 0x20000
s_mov_b32 s48, s4
s_mov_b32 s49, s5
s_mov_b32 s50, 4194304
s_mov_b32 s51, 0x20000
s_mov_b32 s52, s26
s_mov_b32 s53, s27
s_mov_b32 s54, 256
s_mov_b32 s55, 0x20000
s_mov_b32 s56, s8
s_mov_b32 s57, s9
s_mov_b32 s58, 8388608
s_mov_b32 s59, 0x20000
s_mov_b32 s60, s18
s_mov_b32 s61, s19
s_mov_b32 s62, 6291456
s_mov_b32 s63, 0x20000
v_accvgpr_write_b32 a251, 1
v_and_b32 v24, 15, v0
v_lshrrev_b32 v26, 1, v24
v_xor_b32 v26, v26, v25
v_lshlrev_b32 v26, 4, v26
v_lshl_add_u32 v26, v24, 7, v26
v_add_u32 v2, s76, v26
v_xor_b32 v3, 64, v2
v_bfe_u32 v24, v0, 2, 2
v_lshl_add_u32 v27, v25, 3, v24
v_and_b32 v1, 3, v0
v_cmp_eq_u32 vcc, 0, v1
v_lshlrev_b32 v1, 3, v1
v_lshl_add_u32 v26, v27, 8, v1
v_add_u32 v26, 65536, v26
v_and_b32 v1, 1, v25
v_lshl_add_u32 v24, v1, 2, v24
v_lshlrev_b32 v16, 4, v0
v_mov_b32 v28, 0x3f803f80
v_cndmask_b32 v28, 0, v28, vcc
v_accvgpr_write_b32 a244, v28
v_accvgpr_write_b32 a245, v28
v_accvgpr_write_b32 a246, v28
v_accvgpr_write_b32 a247, v28
v_xor_b32 v1, 0, v24
v_lshl_add_u32 v4, v1, 5, v26
v_xor_b32 v1, 1, v24
v_lshl_add_u32 v5, v1, 5, v26
v_xor_b32 v1, 2, v24
v_lshl_add_u32 v6, v1, 5, v26
v_xor_b32 v1, 3, v24
v_lshl_add_u32 v7, v1, 5, v26
v_xor_b32 v1, 4, v24
v_lshl_add_u32 v8, v1, 5, v26
v_xor_b32 v1, 5, v24
v_lshl_add_u32 v9, v1, 5, v26
v_xor_b32 v1, 6, v24
v_lshl_add_u32 v10, v1, 5, v26
v_xor_b32 v1, 7, v24
v_lshl_add_u32 v11, v1, 5, v26
s_sub_u32 s16, 15, s3
s_lshl_b32 s72, s3, 18
s_lshl_b32 s73, s16, 18
s_cmp_lt_u32 s30, 2
s_cselect_b32 s74, s72, s73
s_max_u32 s74, s74, 32768
s_sub_u32 s74, s74, 32768
s_and_b32 s66, s30, 1
s_lshl_b32 s66, s66, 14
s_add_u32 s74, s74, s66
s_lshl_b32 s66, s30, 15
s_add_u32 s72, s72, s66
s_add_u32 s73, s73, s66
s_mul_i32 s75, s30, 98304
s_lshl_b32 s66, s31, 6
s_add_u32 s75, s75, s66
s_lshl_b32 s79, s31, 20
s_lshl_b32 s66, s3, 17
s_add_u32 s79, s79, s66
s_lshl_b32 s66, s30, 15
s_add_u32 s79, s79, s66
v_bfe_u32 v23, v0, 1, 1
v_lshrrev_b32 v1, 5, v0
v_xor_b32 v23, v23, v1
v_lshlrev_b32 v23, 5, v23
v_and_b32 v1, 1, v0
v_lshl_add_u32 v23, v1, 4, v23
v_lshrrev_b32 v1, 2, v0
v_mul_u32_u24 v1, 6144, v1
v_add_u32 v23, v1, v23
s_and_b32 s68, s30, 1
s_lshl_b32 s68, s68, 6
v_lshrrev_b32 v1, 3, v0
v_lshl_add_u32 v22, v1, 10, v12
v_xor_b32 v22, s68, v22
s_lshl_b32 s81, s80, 13
s_and_b32 s67, s2, 7
s_lshl_b32 s82, s67, 8
s_add_u32 s82, s82, s81
s_lshl_b32 s67, s67, 10
s_add_u32 s81, s81, s67
v_mul_u32_u24 v1, 1792, v25
v_add_u32 v1, v1, v16
s_lshl_b32 s68, s2, 3
s_lshl1_add_u32 s68, s30, s68
v_lshrrev_b32 v18, 5, v0
v_add_u32 v18, s68, v18
v_and_b32 v19, 31, v0
v_lshlrev_b32 v19, 4, v19
v_lshl_add_u32 v18, v18, 11, v19
v_mov_b32 v21, 0
v_min_u32 v20, 1, v0
v_lshlrev_b32 v20, 30, v20
s_lshl2_add_u32 s68, s2, s30
s_lshl_b32 s68, s68, 6
s_add_u32 s68, s68, 59834368
s_lshr_b32 s69, s2, 6
s_or_b32 s69, s69, s30
s_lshl_b32 s69, s69, 20
s_add_u32 s69, s69, s2
s_lshl_b32 s69, s69, 8
s_add_u32 s69, s69, 59768832
s_add_u32 m0, s76, 32768
s_add_u32 s64, s70, 128
buffer_load_dwordx4 v12, s[32:35], s64 offen lds
s_add_u32 m0, s76, 33792
s_add_u32 s64, s70, 8320
buffer_load_dwordx4 v13, s[32:35], s64 offen lds
s_add_u32 m0, s76, 34816
s_add_u32 s64, s70, 16512
buffer_load_dwordx4 v12, s[32:35], s64 offen lds
s_add_u32 m0, s76, 35840
s_add_u32 s64, s70, 24704
buffer_load_dwordx4 v13, s[32:35], s64 offen lds
s_add_u32 m0, s76, 36864
s_add_u32 s64, s70, 32896
buffer_load_dwordx4 v12, s[32:35], s64 offen lds
s_add_u32 m0, s76, 37888
s_add_u32 s64, s70, 41088
buffer_load_dwordx4 v13, s[32:35], s64 offen lds
s_add_u32 m0, s76, 38912
s_add_u32 s64, s70, 49280
buffer_load_dwordx4 v12, s[32:35], s64 offen lds
s_add_u32 m0, s76, 39936
s_add_u32 s64, s70, 57472
buffer_load_dwordx4 v13, s[32:35], s64 offen lds
s_add_u32 m0, s77, 98304
s_add_u32 s64, s71, 524288
buffer_load_dwordx4 v14, s[36:39], s64 offen lds
s_add_u32 m0, s77, 99328
s_add_u32 s64, s71, 557056
buffer_load_dwordx4 v14, s[36:39], s64 offen lds
s_add_u32 m0, s77, 100352
s_add_u32 s64, s71, 589824
buffer_load_dwordx4 v15, s[36:39], s64 offen lds
s_add_u32 m0, s77, 101376
s_add_u32 s64, s71, 622592
buffer_load_dwordx4 v15, s[36:39], s64 offen lds
s_add_u32 m0, s77, 114688
s_add_u32 s64, s71, 524288
buffer_load_dwordx4 v14, s[40:43], s64 offen lds
s_add_u32 m0, s77, 115712
s_add_u32 s64, s71, 557056
buffer_load_dwordx4 v14, s[40:43], s64 offen lds
s_add_u32 m0, s77, 116736
s_add_u32 s64, s71, 589824
buffer_load_dwordx4 v15, s[40:43], s64 offen lds
s_add_u32 m0, s77, 117760
s_add_u32 s64, s71, 622592
buffer_load_dwordx4 v15, s[40:43], s64 offen lds
s_waitcnt vmcnt(16)
s_barrier
ds_read_b128 a[0:3], v2 offset:0
ds_read_b128 a[4:7], v3 offset:0
ds_read_b64_tr_b16 a[72:73], v4 offset:0
ds_read_b64_tr_b16 a[74:75], v4 offset:1024
ds_read_b64_tr_b16 a[76:77], v4 offset:8192
ds_read_b64_tr_b16 a[78:79], v4 offset:9216
ds_read_b128 a[8:11], v2 offset:2048
ds_read_b128 a[12:15], v3 offset:2048
ds_read_b128 a[16:19], v2 offset:4096
ds_read_b128 a[20:23], v3 offset:4096
ds_read_b128 a[24:27], v2 offset:6144
ds_read_b128 a[28:31], v3 offset:6144
ds_read_b64_tr_b16 a[80:81], v5 offset:0
ds_read_b64_tr_b16 a[82:83], v5 offset:1024
ds_read_b64_tr_b16 a[84:85], v5 offset:8192
ds_read_b64_tr_b16 a[86:87], v5 offset:9216
ds_read_b64_tr_b16 a[88:89], v6 offset:0
ds_read_b64_tr_b16 a[90:91], v6 offset:1024
ds_read_b64_tr_b16 a[92:93], v6 offset:8192
ds_read_b64_tr_b16 a[94:95], v6 offset:9216
s_waitcnt lgkmcnt(15)
v_mfma_f32_16x16x32_bf16 v[184:187], a[72:75], a[0:3], 0
s_waitcnt lgkmcnt(14)
s_add_u32 m0, s77, 131072
ds_read_b64_tr_b16 a[96:97], v7 offset:0
v_mfma_f32_16x16x32_bf16 v[184:187], a[76:79], a[4:7], v[184:187]
s_waitcnt lgkmcnt(13)
s_add_u32 s64, s71, 1048576
ds_read_b64_tr_b16 a[98:99], v7 offset:1024
v_mfma_f32_16x16x32_bf16 v[192:195], a[76:79], a[12:15], 0
buffer_load_dwordx4 v14, s[36:39], s64 offen lds
v_mfma_f32_16x16x32_bf16 v[192:195], a[72:75], a[8:11], v[192:195]
s_waitcnt lgkmcnt(13)
ds_read_b64_tr_b16 a[100:101], v7 offset:8192
v_mfma_f32_16x16x32_bf16 v[200:203], a[72:75], a[16:19], 0
s_waitcnt lgkmcnt(13)
s_add_u32 m0, s77, 132096
ds_read_b64_tr_b16 a[102:103], v7 offset:9216
v_mfma_f32_16x16x32_bf16 v[200:203], a[76:79], a[20:23], v[200:203]
s_waitcnt lgkmcnt(12)
s_add_u32 s64, s71, 1081344
ds_read_b64_tr_b16 a[104:105], v8 offset:0
v_mfma_f32_16x16x32_bf16 v[208:211], a[76:79], a[28:31], 0
buffer_load_dwordx4 v14, s[36:39], s64 offen lds
v_mfma_f32_16x16x32_bf16 v[208:211], a[72:75], a[24:27], v[208:211]
s_waitcnt lgkmcnt(11)
s_add_u32 s17, s78, .-L_pc+6144
ds_read_b64_tr_b16 a[106:107], v8 offset:1024
v_mfma_f32_16x16x32_bf16 v[248:251], a[80:83], a[24:27], 0
s_waitcnt lgkmcnt(10)
s_add_u32 m0, s77, 133120
ds_read_b64_tr_b16 a[108:109], v8 offset:8192
v_mfma_f32_16x16x32_bf16 v[248:251], a[84:87], a[28:31], v[248:251]
s_add_u32 s64, s71, 1114112
ds_read_b64_tr_b16 a[110:111], v8 offset:9216
v_mfma_f32_16x16x32_bf16 v[212:215], a[84:87], a[20:23], 0
buffer_load_dword a252, v16, s[88:91], s17 offen
v_mfma_f32_16x16x32_bf16 v[212:215], a[80:83], a[16:19], v[212:215]
buffer_load_dwordx4 v15, s[36:39], s64 offen lds
v_mfma_f32_16x16x32_bf16 v[204:207], a[80:83], a[8:11], 0
ds_read_b64_tr_b16 a[112:113], v9 offset:0
v_mfma_f32_16x16x32_bf16 v[204:207], a[84:87], a[12:15], v[204:207]
s_add_u32 m0, s77, 134144
ds_read_b64_tr_b16 a[114:115], v9 offset:1024
v_mfma_f32_16x16x32_bf16 v[196:199], a[84:87], a[4:7], 0
s_add_u32 s64, s71, 1146880
ds_read_b64_tr_b16 a[116:117], v9 offset:8192
v_mfma_f32_16x16x32_bf16 v[196:199], a[80:83], a[0:3], v[196:199]
s_waitcnt lgkmcnt(6)
buffer_load_dwordx4 v15, s[36:39], s64 offen lds
v_mfma_f32_16x16x32_bf16 v[188:191], a[88:91], a[0:3], 0
ds_read_b64_tr_b16 a[118:119], v9 offset:9216
v_mfma_f32_16x16x32_bf16 v[188:191], a[92:95], a[4:7], v[188:191]
ds_read_b64_tr_b16 a[72:73], v10 offset:0
v_mfma_f32_16x16x32_bf16 v[216:219], a[92:95], a[12:15], 0
s_add_u32 m0, s77, 147456
ds_read_b64_tr_b16 a[74:75], v10 offset:1024
v_mfma_f32_16x16x32_bf16 v[216:219], a[88:91], a[8:11], v[216:219]
s_add_u32 s64, s71, 1048576
ds_read_b64_tr_b16 a[76:77], v10 offset:8192
v_mfma_f32_16x16x32_bf16 v[224:227], a[88:91], a[16:19], 0
buffer_load_dwordx4 v14, s[40:43], s64 offen lds
v_mfma_f32_16x16x32_bf16 v[224:227], a[92:95], a[20:23], v[224:227]
ds_read_b64_tr_b16 a[78:79], v10 offset:9216
v_mfma_f32_16x16x32_bf16 v[232:235], a[92:95], a[28:31], 0
s_add_u32 m0, s77, 148480
ds_read_b64_tr_b16 a[80:81], v11 offset:0
v_mfma_f32_16x16x32_bf16 v[232:235], a[88:91], a[24:27], v[232:235]
s_add_u32 s64, s71, 1081344
ds_read_b64_tr_b16 a[82:83], v11 offset:1024
v_mfma_f32_16x16x32_bf16 v[240:243], a[96:99], a[24:27], 0
buffer_load_dwordx4 v14, s[40:43], s64 offen lds
v_mfma_f32_16x16x32_bf16 v[240:243], a[100:103], a[28:31], v[240:243]
ds_read_b64_tr_b16 a[84:85], v11 offset:8192
v_mfma_f32_16x16x32_bf16 v[252:255], a[100:103], a[20:23], 0
ds_read_b64_tr_b16 a[86:87], v11 offset:9216
v_mfma_f32_16x16x32_bf16 v[252:255], a[96:99], a[16:19], v[252:255]
s_add_u32 m0, s77, 149504
ds_read_b64_tr_b16 a[88:89], v4 offset:16384
v_mfma_f32_16x16x32_bf16 v[244:247], a[96:99], a[8:11], 0
s_add_u32 s64, s71, 1114112
ds_read_b64_tr_b16 a[90:91], v4 offset:17408
v_mfma_f32_16x16x32_bf16 v[244:247], a[100:103], a[12:15], v[244:247]
buffer_load_dwordx4 v15, s[40:43], s64 offen lds
v_mfma_f32_16x16x32_bf16 v[236:239], a[100:103], a[4:7], 0
ds_read_b64_tr_b16 a[92:93], v4 offset:24576
v_mfma_f32_16x16x32_bf16 v[236:239], a[96:99], a[0:3], v[236:239]
s_waitcnt lgkmcnt(7)
s_add_u32 m0, s77, 150528
ds_read_b64_tr_b16 a[94:95], v4 offset:25600
v_mfma_f32_16x16x32_bf16 v[228:231], a[104:107], a[0:3], 0
s_add_u32 s64, s71, 1146880
ds_read_b64_tr_b16 a[96:97], v5 offset:16384
v_mfma_f32_16x16x32_bf16 v[228:231], a[108:111], a[4:7], v[228:231]
buffer_load_dwordx4 v15, s[40:43], s64 offen lds
v_mfma_f32_16x16x32_bf16 v[220:223], a[108:111], a[12:15], 0
ds_read_b64_tr_b16 a[98:99], v5 offset:17408
v_mfma_f32_16x16x32_bf16 v[220:223], a[104:107], a[8:11], v[220:223]
ds_read_b64_tr_b16 a[100:101], v5 offset:24576
v_mfma_f32_16x16x32_bf16 v[152:155], a[104:107], a[16:19], 0
ds_read_b64_tr_b16 a[102:103], v5 offset:25600
v_mfma_f32_16x16x32_bf16 v[152:155], a[108:111], a[20:23], v[152:155]
v_mfma_f32_16x16x32_bf16 v[160:163], a[108:111], a[28:31], 0
s_add_u32 m0, s76, 0
v_mfma_f32_16x16x32_bf16 v[160:163], a[104:107], a[24:27], v[160:163]
s_add_u32 s64, s70, 256
ds_read_b64_tr_b16 a[104:105], v6 offset:16384
v_mfma_f32_16x16x32_bf16 v[168:171], a[112:115], a[24:27], 0
buffer_load_dwordx4 v12, s[32:35], s64 offen lds
v_mfma_f32_16x16x32_bf16 v[168:171], a[116:119], a[28:31], v[168:171]
global_load_dwordx4 a[144:147], v18, s[4:5] offset:0
v_mfma_f32_16x16x32_bf16 v[176:179], a[116:119], a[20:23], 0
ds_read_b64_tr_b16 a[106:107], v6 offset:17408
v_mfma_f32_16x16x32_bf16 v[176:179], a[112:115], a[16:19], v[176:179]
ds_read_b64_tr_b16 a[108:109], v6 offset:24576
v_mfma_f32_16x16x32_bf16 v[180:183], a[112:115], a[8:11], 0
ds_read_b64_tr_b16 a[110:111], v6 offset:25600
v_mfma_f32_16x16x32_bf16 v[180:183], a[116:119], a[12:15], v[180:183]
s_add_u32 m0, s76, 1024
v_mfma_f32_16x16x32_bf16 v[172:175], a[116:119], a[4:7], 0
s_add_u32 s64, s70, 8448
v_mfma_f32_16x16x32_bf16 v[172:175], a[112:115], a[0:3], v[172:175]
buffer_load_dwordx4 v13, s[32:35], s64 offen lds
v_mfma_f32_16x16x32_bf16 v[164:167], a[72:75], a[0:3], 0
ds_read_b64_tr_b16 a[112:113], v7 offset:16384
v_mfma_f32_16x16x32_bf16 v[164:167], a[76:79], a[4:7], v[164:167]
ds_read_b64_tr_b16 a[114:115], v7 offset:17408
v_mfma_f32_16x16x32_bf16 v[156:159], a[76:79], a[12:15], 0
ds_read_b64_tr_b16 a[116:117], v7 offset:24576
v_mfma_f32_16x16x32_bf16 v[156:159], a[72:75], a[8:11], v[156:159]
ds_read_b64_tr_b16 a[118:119], v7 offset:25600
v_mfma_f32_16x16x32_bf16 v[24:27], a[72:75], a[16:19], 0
s_add_u32 m0, s76, 2048
v_mfma_f32_16x16x32_bf16 v[24:27], a[76:79], a[20:23], v[24:27]
s_add_u32 s64, s70, 16640
v_mfma_f32_16x16x32_bf16 v[40:43], a[76:79], a[28:31], 0
s_waitcnt vmcnt(20)
buffer_load_dwordx4 v12, s[32:35], s64 offen lds
v_mfma_f32_16x16x32_bf16 v[40:43], a[72:75], a[24:27], v[40:43]
s_waitcnt lgkmcnt(4)
ds_read_b64_tr_b16 a[72:73], v8 offset:16384
v_mfma_f32_16x16x32_bf16 v[56:59], a[80:83], a[24:27], 0
ds_read_b64_tr_b16 a[74:75], v8 offset:17408
v_mfma_f32_16x16x32_bf16 v[56:59], a[84:87], a[28:31], v[56:59]
ds_read_b64_tr_b16 a[76:77], v8 offset:24576
v_mfma_f32_16x16x32_bf16 v[72:75], a[84:87], a[20:23], 0
ds_read_b64_tr_b16 a[78:79], v8 offset:25600
v_mfma_f32_16x16x32_bf16 v[72:75], a[80:83], a[16:19], v[72:75]
s_add_u32 m0, s76, 3072
ds_read_b128 a[32:35], v2 offset:32768
v_mfma_f32_16x16x32_bf16 v[136:139], a[80:83], a[8:11], 0
s_add_u32 s64, s70, 24832
ds_read_b128 a[36:39], v3 offset:32768
v_mfma_f32_16x16x32_bf16 v[136:139], a[84:87], a[12:15], v[136:139]
buffer_load_dwordx4 v13, s[32:35], s64 offen lds
v_mfma_f32_16x16x32_bf16 v[120:123], a[84:87], a[4:7], 0
ds_read_b128 a[40:43], v2 offset:34816
v_mfma_f32_16x16x32_bf16 v[120:123], a[80:83], a[0:3], v[120:123]
ds_read_b128 a[44:47], v3 offset:34816
v_mfma_f32_16x16x32_bf16 v[104:107], a[0:3], a[88:91], 0
ds_read_b128 a[48:51], v2 offset:36864
v_mfma_f32_16x16x32_bf16 v[104:107], a[4:7], a[92:95], v[104:107]
ds_read_b128 a[52:55], v3 offset:36864
v_mfma_f32_16x16x32_bf16 v[88:91], a[12:15], a[92:95], 0
s_add_u32 m0, s76, 4096
ds_read_b128 a[56:59], v2 offset:38912
v_mfma_f32_16x16x32_bf16 v[88:91], a[8:11], a[88:91], v[88:91]
s_add_u32 s64, s70, 33024
ds_read_b128 a[60:63], v3 offset:38912
v_mfma_f32_16x16x32_bf16 v[28:31], a[16:19], a[88:91], 0
buffer_load_dwordx4 v12, s[32:35], s64 offen lds
v_mfma_f32_16x16x32_bf16 v[28:31], a[20:23], a[92:95], v[28:31]
global_load_dwordx4 a[160:163], v19, s[22:23] offset:0
v_mfma_f32_16x16x32_bf16 v[44:47], a[28:31], a[92:95], 0
ds_read_b64_tr_b16 a[80:81], v9 offset:16384
v_mfma_f32_16x16x32_bf16 v[44:47], a[24:27], a[88:91], v[44:47]
ds_read_b64_tr_b16 a[82:83], v9 offset:17408
v_mfma_f32_16x16x32_bf16 v[60:63], a[24:27], a[96:99], 0
ds_read_b64_tr_b16 a[84:85], v9 offset:24576
v_mfma_f32_16x16x32_bf16 v[60:63], a[28:31], a[100:103], v[60:63]
s_add_u32 m0, s76, 5120
ds_read_b64_tr_b16 a[86:87], v9 offset:25600
v_mfma_f32_16x16x32_bf16 v[76:79], a[20:23], a[100:103], 0
s_add_u32 s64, s70, 41216
ds_read_b64_tr_b16 a[88:89], v10 offset:16384
v_mfma_f32_16x16x32_bf16 v[76:79], a[16:19], a[96:99], v[76:79]
buffer_load_dwordx4 v13, s[32:35], s64 offen lds
v_mfma_f32_16x16x32_bf16 v[140:143], a[8:11], a[96:99], 0
ds_read_b64_tr_b16 a[90:91], v10 offset:17408
v_mfma_f32_16x16x32_bf16 v[140:143], a[12:15], a[100:103], v[140:143]
ds_read_b64_tr_b16 a[92:93], v10 offset:24576
v_mfma_f32_16x16x32_bf16 v[124:127], a[4:7], a[100:103], 0
ds_read_b64_tr_b16 a[94:95], v10 offset:25600
v_mfma_f32_16x16x32_bf16 v[124:127], a[0:3], a[96:99], v[124:127]
ds_read_b64_tr_b16 a[96:97], v11 offset:16384
v_mfma_f32_16x16x32_bf16 v[108:111], a[0:3], a[104:107], 0
s_add_u32 m0, s76, 6144
ds_read_b64_tr_b16 a[98:99], v11 offset:17408
v_mfma_f32_16x16x32_bf16 v[108:111], a[4:7], a[108:111], v[108:111]
s_add_u32 s64, s70, 49408
ds_read_b64_tr_b16 a[100:101], v11 offset:24576
v_mfma_f32_16x16x32_bf16 v[92:95], a[12:15], a[108:111], 0
buffer_load_dwordx4 v12, s[32:35], s64 offen lds
v_mfma_f32_16x16x32_bf16 v[92:95], a[8:11], a[104:107], v[92:95]
ds_read_b64_tr_b16 a[102:103], v11 offset:25600
v_mfma_f32_16x16x32_bf16 v[32:35], a[16:19], a[104:107], 0
v_mfma_f32_16x16x32_bf16 v[32:35], a[20:23], a[108:111], v[32:35]
v_mfma_f32_16x16x32_bf16 v[48:51], a[28:31], a[108:111], 0
v_mfma_f32_16x16x32_bf16 v[48:51], a[24:27], a[104:107], v[48:51]
s_waitcnt lgkmcnt(5)
s_add_u32 m0, s76, 7168
v_mfma_f32_16x16x32_bf16 v[64:67], a[24:27], a[112:115], 0
s_add_u32 s64, s70, 57600
v_mfma_f32_16x16x32_bf16 v[64:67], a[28:31], a[116:119], v[64:67]
buffer_load_dwordx4 v13, s[32:35], s64 offen lds
v_mfma_f32_16x16x32_bf16 v[80:83], a[20:23], a[116:119], 0
v_mfma_f32_16x16x32_bf16 v[80:83], a[16:19], a[112:115], v[80:83]
v_mfma_f32_16x16x32_bf16 v[144:147], a[8:11], a[112:115], 0
v_mfma_f32_16x16x32_bf16 v[144:147], a[12:15], a[116:119], v[144:147]
v_mfma_f32_16x16x32_bf16 v[128:131], a[4:7], a[116:119], 0
v_mfma_f32_16x16x32_bf16 v[128:131], a[0:3], a[112:115], v[128:131]
v_mfma_f32_16x16x32_bf16 v[112:115], a[0:3], a[72:75], 0
global_load_dwordx4 a[148:151], v18, s[4:5] offset:512
v_mfma_f32_16x16x32_bf16 v[112:115], a[4:7], a[76:79], v[112:115]
v_mfma_f32_16x16x32_bf16 v[96:99], a[12:15], a[76:79], 0
s_waitcnt vmcnt(20) lgkmcnt(0)
s_barrier
v_mfma_f32_16x16x32_bf16 v[96:99], a[8:11], a[72:75], v[96:99]
s_add_u32 m0, s77, 65536
ds_read_b64_tr_b16 a[104:105], v4 offset:32768
v_mfma_f32_16x16x32_bf16 v[36:39], a[16:19], a[72:75], 0
s_add_u32 s64, s71, 1572864
ds_read_b64_tr_b16 a[106:107], v4 offset:33792
v_mfma_f32_16x16x32_bf16 v[36:39], a[20:23], a[76:79], v[36:39]
buffer_load_dwordx4 v14, s[36:39], s64 offen lds
v_mfma_f32_16x16x32_bf16 v[52:55], a[28:31], a[76:79], 0
ds_read_b64_tr_b16 a[108:109], v4 offset:40960
v_mfma_f32_16x16x32_bf16 v[52:55], a[24:27], a[72:75], v[52:55]
ds_read_b64_tr_b16 a[110:111], v4 offset:41984
v_mfma_f32_16x16x32_bf16 v[68:71], a[24:27], a[80:83], 0
ds_read_b64_tr_b16 a[112:113], v5 offset:32768
v_mfma_f32_16x16x32_bf16 v[68:71], a[28:31], a[84:87], v[68:71]
ds_read_b64_tr_b16 a[114:115], v5 offset:33792
v_mfma_f32_16x16x32_bf16 v[84:87], a[20:23], a[84:87], 0
ds_read_b64_tr_b16 a[116:117], v5 offset:40960
v_mfma_f32_16x16x32_bf16 v[84:87], a[16:19], a[80:83], v[84:87]
s_add_u32 m0, s77, 66560
ds_read_b64_tr_b16 a[118:119], v5 offset:41984
v_mfma_f32_16x16x32_bf16 v[148:151], a[8:11], a[80:83], 0
s_add_u32 s64, s71, 1605632
ds_read_b64_tr_b16 a[72:73], v6 offset:32768
v_mfma_f32_16x16x32_bf16 v[148:151], a[12:15], a[84:87], v[148:151]
buffer_load_dwordx4 v14, s[36:39], s64 offen lds
v_mfma_f32_16x16x32_bf16 v[132:135], a[4:7], a[84:87], 0
ds_read_b64_tr_b16 a[74:75], v6 offset:33792
v_mfma_f32_16x16x32_bf16 v[132:135], a[0:3], a[80:83], v[132:135]
ds_read_b64_tr_b16 a[76:77], v6 offset:40960
v_mfma_f32_16x16x32_bf16 v[116:119], a[0:3], a[88:91], 0
ds_read_b64_tr_b16 a[78:79], v6 offset:41984
v_mfma_f32_16x16x32_bf16 v[116:119], a[4:7], a[92:95], v[116:119]
ds_read_b64_tr_b16 a[80:81], v7 offset:32768
v_mfma_f32_16x16x32_bf16 v[100:103], a[12:15], a[92:95], 0
ds_read_b64_tr_b16 a[82:83], v7 offset:33792
v_mfma_f32_16x16x32_bf16 v[100:103], a[8:11], a[88:91], v[100:103]
s_add_u32 m0, s77, 67584
ds_read_b64_tr_b16 a[84:85], v7 offset:40960
v_mfma_f32_16x16x32_bf16 a[120:123], a[16:19], a[88:91], 0
s_add_u32 s64, s71, 1638400
ds_read_b64_tr_b16 a[86:87], v7 offset:41984
v_mfma_f32_16x16x32_bf16 a[120:123], a[20:23], a[92:95], a[120:123]
buffer_load_dwordx4 v15, s[36:39], s64 offen lds
v_mfma_f32_16x16x32_bf16 a[124:127], a[28:31], a[92:95], 0
v_mfma_f32_16x16x32_bf16 a[124:127], a[24:27], a[88:91], a[124:127]
ds_read_b64_tr_b16 a[88:89], v8 offset:32768
v_mfma_f32_16x16x32_bf16 a[128:131], a[24:27], a[96:99], 0
ds_read_b64_tr_b16 a[90:91], v8 offset:33792
v_mfma_f32_16x16x32_bf16 a[128:131], a[28:31], a[100:103], a[128:131]
ds_read_b64_tr_b16 a[92:93], v8 offset:40960
v_mfma_f32_16x16x32_bf16 a[132:135], a[20:23], a[100:103], 0
s_add_u32 m0, s77, 68608
ds_read_b64_tr_b16 a[94:95], v8 offset:41984
v_mfma_f32_16x16x32_bf16 a[132:135], a[16:19], a[96:99], a[132:135]
s_add_u32 s64, s71, 1671168
v_mfma_f32_16x16x32_bf16 a[136:139], a[8:11], a[96:99], 0
global_load_dwordx4 a[164:167], v19, s[22:23] offset:512
v_mfma_f32_16x16x32_bf16 a[136:139], a[12:15], a[100:103], a[136:139]
buffer_load_dwordx4 v15, s[36:39], s64 offen lds
v_mfma_f32_16x16x32_bf16 a[140:143], a[4:7], a[100:103], 0
v_mfma_f32_16x16x32_bf16 a[140:143], a[0:3], a[96:99], a[140:143]
s_waitcnt lgkmcnt(4)
ds_read_b64_tr_b16 a[96:97], v9 offset:32768
v_mfma_f32_16x16x32_bf16 v[184:187], a[104:107], a[32:35], v[184:187]
ds_read_b64_tr_b16 a[98:99], v9 offset:33792
v_mfma_f32_16x16x32_bf16 v[184:187], a[108:111], a[36:39], v[184:187]
s_add_u32 s17, s78, .-L_pc+6144
ds_read_b64_tr_b16 a[100:101], v9 offset:40960
v_mfma_f32_16x16x32_bf16 v[192:195], a[108:111], a[44:47], v[192:195]
s_add_u32 m0, s77, 81920
ds_read_b64_tr_b16 a[102:103], v9 offset:41984
v_mfma_f32_16x16x32_bf16 v[192:195], a[104:107], a[40:43], v[192:195]
s_add_u32 s64, s71, 1572864
v_mfma_f32_16x16x32_bf16 v[200:203], a[104:107], a[48:51], v[200:203]
buffer_load_dword a252, v16, s[88:91], s17 offen
v_mfma_f32_16x16x32_bf16 v[200:203], a[108:111], a[52:55], v[200:203]
buffer_load_dwordx4 v14, s[40:43], s64 offen lds
v_mfma_f32_16x16x32_bf16 v[208:211], a[108:111], a[60:63], v[208:211]
v_mfma_f32_16x16x32_bf16 v[208:211], a[104:107], a[56:59], v[208:211]
ds_read_b64_tr_b16 a[104:105], v10 offset:32768
v_mfma_f32_16x16x32_bf16 v[248:251], a[112:115], a[56:59], v[248:251]
ds_read_b64_tr_b16 a[106:107], v10 offset:33792
v_mfma_f32_16x16x32_bf16 v[248:251], a[116:119], a[60:63], v[248:251]
ds_read_b64_tr_b16 a[108:109], v10 offset:40960
v_mfma_f32_16x16x32_bf16 v[212:215], a[116:119], a[52:55], v[212:215]
ds_read_b64_tr_b16 a[110:111], v10 offset:41984
v_mfma_f32_16x16x32_bf16 v[212:215], a[112:115], a[48:51], v[212:215]
s_add_u32 m0, s77, 82944
v_mfma_f32_16x16x32_bf16 v[204:207], a[112:115], a[40:43], v[204:207]
s_add_u32 s64, s71, 1605632
v_mfma_f32_16x16x32_bf16 v[204:207], a[116:119], a[44:47], v[204:207]
buffer_load_dwordx4 v14, s[40:43], s64 offen lds
v_mfma_f32_16x16x32_bf16 v[196:199], a[116:119], a[36:39], v[196:199]
v_mfma_f32_16x16x32_bf16 v[196:199], a[112:115], a[32:35], v[196:199]
ds_read_b64_tr_b16 a[112:113], v11 offset:32768
v_mfma_f32_16x16x32_bf16 v[188:191], a[72:75], a[32:35], v[188:191]
ds_read_b64_tr_b16 a[114:115], v11 offset:33792
v_mfma_f32_16x16x32_bf16 v[188:191], a[76:79], a[36:39], v[188:191]
ds_read_b64_tr_b16 a[116:117], v11 offset:40960
v_mfma_f32_16x16x32_bf16 v[216:219], a[76:79], a[44:47], v[216:219]
ds_read_b64_tr_b16 a[118:119], v11 offset:41984
v_mfma_f32_16x16x32_bf16 v[216:219], a[72:75], a[40:43], v[216:219]
s_add_u32 m0, s77, 83968
v_mfma_f32_16x16x32_bf16 v[224:227], a[72:75], a[48:51], v[224:227]
s_add_u32 s64, s71, 1638400
v_mfma_f32_16x16x32_bf16 v[224:227], a[76:79], a[52:55], v[224:227]
buffer_load_dwordx4 v15, s[40:43], s64 offen lds
v_mfma_f32_16x16x32_bf16 v[232:235], a[76:79], a[60:63], v[232:235]
v_mfma_f32_16x16x32_bf16 v[232:235], a[72:75], a[56:59], v[232:235]
ds_read_b64_tr_b16 a[72:73], v4 offset:49152
v_mfma_f32_16x16x32_bf16 v[240:243], a[80:83], a[56:59], v[240:243]
global_load_dwordx4 a[152:155], v18, s[4:5] offset:1024
v_mfma_f32_16x16x32_bf16 v[240:243], a[84:87], a[60:63], v[240:243]
ds_read_b64_tr_b16 a[74:75], v4 offset:50176
v_mfma_f32_16x16x32_bf16 v[252:255], a[84:87], a[52:55], v[252:255]
ds_read_b64_tr_b16 a[76:77], v4 offset:57344
v_mfma_f32_16x16x32_bf16 v[252:255], a[80:83], a[48:51], v[252:255]
s_add_u32 m0, s77, 84992
ds_read_b64_tr_b16 a[78:79], v4 offset:58368
v_mfma_f32_16x16x32_bf16 v[244:247], a[80:83], a[40:43], v[244:247]
s_add_u32 s64, s71, 1671168
v_mfma_f32_16x16x32_bf16 v[244:247], a[84:87], a[44:47], v[244:247]
buffer_load_dwordx4 v15, s[40:43], s64 offen lds
v_mfma_f32_16x16x32_bf16 v[236:239], a[84:87], a[36:39], v[236:239]
v_mfma_f32_16x16x32_bf16 v[236:239], a[80:83], a[32:35], v[236:239]
s_waitcnt lgkmcnt(4)
ds_read_b64_tr_b16 a[80:81], v5 offset:49152
v_mfma_f32_16x16x32_bf16 v[228:231], a[88:91], a[32:35], v[228:231]
ds_read_b64_tr_b16 a[82:83], v5 offset:50176
v_mfma_f32_16x16x32_bf16 v[228:231], a[92:95], a[36:39], v[228:231]
ds_read_b64_tr_b16 a[84:85], v5 offset:57344
v_mfma_f32_16x16x32_bf16 v[220:223], a[92:95], a[44:47], v[220:223]
ds_read_b64_tr_b16 a[86:87], v5 offset:58368
v_mfma_f32_16x16x32_bf16 v[220:223], a[88:91], a[40:43], v[220:223]
v_mfma_f32_16x16x32_bf16 v[152:155], a[88:91], a[48:51], v[152:155]
v_mfma_f32_16x16x32_bf16 v[152:155], a[92:95], a[52:55], v[152:155]
v_mfma_f32_16x16x32_bf16 v[160:163], a[92:95], a[60:63], v[160:163]
s_add_u32 m0, s76, 32768
v_mfma_f32_16x16x32_bf16 v[160:163], a[88:91], a[56:59], v[160:163]
s_add_u32 s64, s70, 384
ds_read_b64_tr_b16 a[88:89], v6 offset:49152
v_mfma_f32_16x16x32_bf16 v[168:171], a[96:99], a[56:59], v[168:171]
buffer_load_dwordx4 v12, s[32:35], s64 offen lds
v_mfma_f32_16x16x32_bf16 v[168:171], a[100:103], a[60:63], v[168:171]
ds_read_b64_tr_b16 a[90:91], v6 offset:50176
v_mfma_f32_16x16x32_bf16 v[176:179], a[100:103], a[52:55], v[176:179]
ds_read_b64_tr_b16 a[92:93], v6 offset:57344
v_mfma_f32_16x16x32_bf16 v[176:179], a[96:99], a[48:51], v[176:179]
ds_read_b64_tr_b16 a[94:95], v6 offset:58368
v_mfma_f32_16x16x32_bf16 v[180:183], a[96:99], a[40:43], v[180:183]
v_mfma_f32_16x16x32_bf16 v[180:183], a[100:103], a[44:47], v[180:183]
s_add_u32 m0, s76, 33792
v_mfma_f32_16x16x32_bf16 v[172:175], a[100:103], a[36:39], v[172:175]
s_add_u32 s64, s70, 8576
v_mfma_f32_16x16x32_bf16 v[172:175], a[96:99], a[32:35], v[172:175]
buffer_load_dwordx4 v13, s[32:35], s64 offen lds
v_mfma_f32_16x16x32_bf16 v[164:167], a[104:107], a[32:35], v[164:167]
ds_read_b64_tr_b16 a[96:97], v7 offset:49152
v_mfma_f32_16x16x32_bf16 v[164:167], a[108:111], a[36:39], v[164:167]
ds_read_b64_tr_b16 a[98:99], v7 offset:50176
v_mfma_f32_16x16x32_bf16 v[156:159], a[108:111], a[44:47], v[156:159]
ds_read_b64_tr_b16 a[100:101], v7 offset:57344
v_mfma_f32_16x16x32_bf16 v[156:159], a[104:107], a[40:43], v[156:159]
s_add_u32 m0, s76, 34816
ds_read_b64_tr_b16 a[102:103], v7 offset:58368
v_mfma_f32_16x16x32_bf16 v[24:27], a[104:107], a[48:51], v[24:27]
global_load_dwordx4 a[168:171], v19, s[22:23] offset:1024
v_mfma_f32_16x16x32_bf16 v[24:27], a[108:111], a[52:55], v[24:27]
s_add_u32 s64, s70, 16768
v_mfma_f32_16x16x32_bf16 v[40:43], a[108:111], a[60:63], v[40:43]
s_waitcnt vmcnt(15)
buffer_load_dwordx4 v12, s[32:35], s64 offen lds
v_mfma_f32_16x16x32_bf16 v[40:43], a[104:107], a[56:59], v[40:43]
ds_read_b64_tr_b16 a[104:105], v8 offset:49152
v_mfma_f32_16x16x32_bf16 v[56:59], a[112:115], a[56:59], v[56:59]
ds_read_b64_tr_b16 a[106:107], v8 offset:50176
v_mfma_f32_16x16x32_bf16 v[56:59], a[116:119], a[60:63], v[56:59]
ds_read_b64_tr_b16 a[108:109], v8 offset:57344
v_add_u32 v4, 0x8000, v4
v_mfma_f32_16x16x32_bf16 v[72:75], a[116:119], a[52:55], v[72:75]
ds_read_b64_tr_b16 a[110:111], v8 offset:58368
v_mfma_f32_16x16x32_bf16 v[72:75], a[112:115], a[48:51], v[72:75]
s_add_u32 m0, s76, 35840
ds_read_b128 a[0:3], v2 offset:0
v_mfma_f32_16x16x32_bf16 v[136:139], a[112:115], a[40:43], v[136:139]
s_add_u32 s64, s70, 24960
ds_read_b128 a[4:7], v3 offset:0
v_mfma_f32_16x16x32_bf16 v[136:139], a[116:119], a[44:47], v[136:139]
buffer_load_dwordx4 v13, s[32:35], s64 offen lds
v_mfma_f32_16x16x32_bf16 v[120:123], a[116:119], a[36:39], v[120:123]
ds_read_b128 a[8:11], v2 offset:2048
v_mfma_f32_16x16x32_bf16 v[120:123], a[112:115], a[32:35], v[120:123]
s_waitcnt lgkmcnt(7)
ds_read_b128 a[12:15], v3 offset:2048
v_mfma_f32_16x16x32_bf16 v[104:107], a[32:35], a[72:75], v[104:107]
ds_read_b128 a[16:19], v2 offset:4096
v_mfma_f32_16x16x32_bf16 v[104:107], a[36:39], a[76:79], v[104:107]
ds_read_b128 a[20:23], v3 offset:4096
v_add_u32 v5, 0x8000, v5
v_mfma_f32_16x16x32_bf16 v[88:91], a[44:47], a[76:79], v[88:91]
s_add_u32 m0, s76, 36864
ds_read_b128 a[24:27], v2 offset:6144
v_mfma_f32_16x16x32_bf16 v[88:91], a[40:43], a[72:75], v[88:91]
s_add_u32 s64, s70, 33152
ds_read_b128 a[28:31], v3 offset:6144
v_mfma_f32_16x16x32_bf16 v[28:31], a[48:51], a[72:75], v[28:31]
buffer_load_dwordx4 v12, s[32:35], s64 offen lds
v_mfma_f32_16x16x32_bf16 v[28:31], a[52:55], a[76:79], v[28:31]
ds_read_b64_tr_b16 a[112:113], v9 offset:49152
v_mfma_f32_16x16x32_bf16 v[44:47], a[60:63], a[76:79], v[44:47]
ds_read_b64_tr_b16 a[114:115], v9 offset:50176
v_mfma_f32_16x16x32_bf16 v[44:47], a[56:59], a[72:75], v[44:47]
ds_read_b64_tr_b16 a[116:117], v9 offset:57344
v_mfma_f32_16x16x32_bf16 v[60:63], a[56:59], a[80:83], v[60:63]
s_add_u32 m0, s76, 37888
ds_read_b64_tr_b16 a[118:119], v9 offset:58368
v_mfma_f32_16x16x32_bf16 v[60:63], a[60:63], a[84:87], v[60:63]
ds_read_b64_tr_b16 a[72:73], v10 offset:49152
v_add_u32 v6, 0x8000, v6
v_mfma_f32_16x16x32_bf16 v[76:79], a[52:55], a[84:87], v[76:79]
s_add_u32 s64, s70, 41344
ds_read_b64_tr_b16 a[74:75], v10 offset:50176
v_mfma_f32_16x16x32_bf16 v[76:79], a[48:51], a[80:83], v[76:79]
buffer_load_dwordx4 v13, s[32:35], s64 offen lds
v_mfma_f32_16x16x32_bf16 v[140:143], a[40:43], a[80:83], v[140:143]
ds_read_b64_tr_b16 a[76:77], v10 offset:57344
v_mfma_f32_16x16x32_bf16 v[140:143], a[44:47], a[84:87], v[140:143]
ds_read_b64_tr_b16 a[78:79], v10 offset:58368
v_mfma_f32_16x16x32_bf16 v[124:127], a[36:39], a[84:87], v[124:127]
s_add_u32 m0, s76, 38912
v_mfma_f32_16x16x32_bf16 v[124:127], a[32:35], a[80:83], v[124:127]
s_add_u32 s64, s70, 49536
ds_read_b64_tr_b16 a[80:81], v11 offset:49152
v_mfma_f32_16x16x32_bf16 v[108:111], a[32:35], a[88:91], v[108:111]
global_load_dwordx4 a[156:159], v18, s[4:5] offset:1536
v_mfma_f32_16x16x32_bf16 v[108:111], a[36:39], a[92:95], v[108:111]
ds_read_b64_tr_b16 a[82:83], v11 offset:50176
v_add_u32 v7, 0x8000, v7
v_mfma_f32_16x16x32_bf16 v[92:95], a[44:47], a[92:95], v[92:95]
buffer_load_dwordx4 v12, s[32:35], s64 offen lds
v_mfma_f32_16x16x32_bf16 v[92:95], a[40:43], a[88:91], v[92:95]
ds_read_b64_tr_b16 a[84:85], v11 offset:57344
v_mfma_f32_16x16x32_bf16 v[32:35], a[48:51], a[88:91], v[32:35]
ds_read_b64_tr_b16 a[86:87], v11 offset:58368
v_mfma_f32_16x16x32_bf16 v[32:35], a[52:55], a[92:95], v[32:35]
v_mfma_f32_16x16x32_bf16 v[48:51], a[60:63], a[92:95], v[48:51]
v_mfma_f32_16x16x32_bf16 v[48:51], a[56:59], a[88:91], v[48:51]
s_add_u32 m0, s76, 39936
v_mfma_f32_16x16x32_bf16 v[64:67], a[56:59], a[96:99], v[64:67]
s_add_u32 s64, s70, 57728
v_mfma_f32_16x16x32_bf16 v[64:67], a[60:63], a[100:103], v[64:67]
buffer_load_dwordx4 v13, s[32:35], s64 offen lds
v_mfma_f32_16x16x32_bf16 v[80:83], a[52:55], a[100:103], v[80:83]
v_add_u32 v8, 0x8000, v8
v_mfma_f32_16x16x32_bf16 v[80:83], a[48:51], a[96:99], v[80:83]
v_mfma_f32_16x16x32_bf16 v[144:147], a[40:43], a[96:99], v[144:147]
v_mfma_f32_16x16x32_bf16 v[144:147], a[44:47], a[100:103], v[144:147]
v_mfma_f32_16x16x32_bf16 v[128:131], a[36:39], a[100:103], v[128:131]
v_add_u32 v9, 0x8000, v9
v_add_u32 v10, 0x8000, v10
v_mfma_f32_16x16x32_bf16 v[128:131], a[32:35], a[96:99], v[128:131]
s_waitcnt lgkmcnt(0)
v_add_u32 v11, 0x8000, v11
v_mfma_f32_16x16x32_bf16 v[112:115], a[32:35], a[104:107], v[112:115]
v_mfma_f32_16x16x32_bf16 v[112:115], a[36:39], a[108:111], v[112:115]
v_mfma_f32_16x16x32_bf16 v[96:99], a[44:47], a[108:111], v[96:99]
s_waitcnt lgkmcnt(0)
s_barrier
v_mfma_f32_16x16x32_bf16 v[96:99], a[40:43], a[104:107], v[96:99]
s_add_u32 m0, s77, 98304
ds_read_b64_tr_b16 a[88:89], v4 offset:32768
v_mfma_f32_16x16x32_bf16 v[36:39], a[48:51], a[104:107], v[36:39]
s_add_u32 s64, s71, 2097152
ds_read_b64_tr_b16 a[90:91], v4 offset:33792
v_mfma_f32_16x16x32_bf16 v[36:39], a[52:55], a[108:111], v[36:39]
buffer_load_dwordx4 v14, s[36:39], s64 offen lds
v_mfma_f32_16x16x32_bf16 v[52:55], a[60:63], a[108:111], v[52:55]
ds_read_b64_tr_b16 a[92:93], v4 offset:40960
v_mfma_f32_16x16x32_bf16 v[52:55], a[56:59], a[104:107], v[52:55]
ds_read_b64_tr_b16 a[94:95], v4 offset:41984
v_mfma_f32_16x16x32_bf16 v[68:71], a[56:59], a[112:115], v[68:71]
ds_read_b64_tr_b16 a[96:97], v5 offset:32768
v_mfma_f32_16x16x32_bf16 v[68:71], a[60:63], a[116:119], v[68:71]
ds_read_b64_tr_b16 a[98:99], v5 offset:33792
v_mfma_f32_16x16x32_bf16 v[84:87], a[52:55], a[116:119], v[84:87]
s_add_u32 m0, s77, 99328
ds_read_b64_tr_b16 a[100:101], v5 offset:40960
v_mfma_f32_16x16x32_bf16 v[84:87], a[48:51], a[112:115], v[84:87]
s_add_u32 s64, s71, 2129920
ds_read_b64_tr_b16 a[102:103], v5 offset:41984
v_mfma_f32_16x16x32_bf16 v[148:151], a[40:43], a[112:115], v[148:151]
global_load_dwordx4 a[172:175], v19, s[22:23] offset:1536
v_mfma_f32_16x16x32_bf16 v[148:151], a[44:47], a[116:119], v[148:151]
buffer_load_dwordx4 v14, s[36:39], s64 offen lds
v_mfma_f32_16x16x32_bf16 v[132:135], a[36:39], a[116:119], v[132:135]
ds_read_b64_tr_b16 a[104:105], v6 offset:32768
v_mfma_f32_16x16x32_bf16 v[132:135], a[32:35], a[112:115], v[132:135]
ds_read_b64_tr_b16 a[106:107], v6 offset:33792
v_mfma_f32_16x16x32_bf16 v[116:119], a[32:35], a[72:75], v[116:119]
ds_read_b64_tr_b16 a[108:109], v6 offset:40960
v_mfma_f32_16x16x32_bf16 v[116:119], a[36:39], a[76:79], v[116:119]
ds_read_b64_tr_b16 a[110:111], v6 offset:41984
v_mfma_f32_16x16x32_bf16 v[100:103], a[44:47], a[76:79], v[100:103]
ds_read_b64_tr_b16 a[112:113], v7 offset:32768
v_mfma_f32_16x16x32_bf16 v[100:103], a[40:43], a[72:75], v[100:103]
s_add_u32 m0, s77, 100352
ds_read_b64_tr_b16 a[114:115], v7 offset:33792
v_mfma_f32_16x16x32_bf16 a[120:123], a[48:51], a[72:75], a[120:123]
s_add_u32 s64, s71, 2162688
ds_read_b64_tr_b16 a[116:117], v7 offset:40960
v_mfma_f32_16x16x32_bf16 a[120:123], a[52:55], a[76:79], a[120:123]
buffer_load_dwordx4 v15, s[36:39], s64 offen lds
v_mfma_f32_16x16x32_bf16 a[124:127], a[60:63], a[76:79], a[124:127]
ds_read_b64_tr_b16 a[118:119], v7 offset:41984
v_mfma_f32_16x16x32_bf16 a[124:127], a[56:59], a[72:75], a[124:127]
ds_read_b64_tr_b16 a[72:73], v8 offset:32768
v_mfma_f32_16x16x32_bf16 a[128:131], a[56:59], a[80:83], a[128:131]
ds_read_b64_tr_b16 a[74:75], v8 offset:33792
v_mfma_f32_16x16x32_bf16 a[128:131], a[60:63], a[84:87], a[128:131]
ds_read_b64_tr_b16 a[76:77], v8 offset:40960
v_mfma_f32_16x16x32_bf16 a[132:135], a[52:55], a[84:87], a[132:135]
ds_read_b64_tr_b16 a[78:79], v8 offset:41984
v_mfma_f32_16x16x32_bf16 a[132:135], a[48:51], a[80:83], a[132:135]
s_add_u32 m0, s77, 101376
v_mfma_f32_16x16x32_bf16 a[136:139], a[40:43], a[80:83], a[136:139]
s_add_u32 s64, s71, 2195456
v_mfma_f32_16x16x32_bf16 a[136:139], a[44:47], a[84:87], a[136:139]
buffer_load_dwordx4 v15, s[36:39], s64 offen lds
v_mfma_f32_16x16x32_bf16 a[140:143], a[36:39], a[84:87], a[140:143]
v_mfma_f32_16x16x32_bf16 a[140:143], a[32:35], a[80:83], a[140:143]
s_waitcnt lgkmcnt(5)
ds_read_b64_tr_b16 a[80:81], v9 offset:32768
v_mfma_f32_16x16x32_bf16 v[184:187], a[88:91], a[0:3], v[184:187]
buffer_load_dword a252, v16, s[56:59], s81 offen
v_mfma_f32_16x16x32_bf16 v[184:187], a[92:95], a[4:7], v[184:187]
s_add_u32 s17, s78, .-L_pc+6144
ds_read_b64_tr_b16 a[82:83], v9 offset:33792
v_mfma_f32_16x16x32_bf16 v[192:195], a[92:95], a[12:15], v[192:195]
s_add_u32 m0, s77, 114688
ds_read_b64_tr_b16 a[84:85], v9 offset:40960
v_mfma_f32_16x16x32_bf16 v[192:195], a[88:91], a[8:11], v[192:195]
s_add_u32 s64, s71, 2097152
ds_read_b64_tr_b16 a[86:87], v9 offset:41984
v_mfma_f32_16x16x32_bf16 v[200:203], a[88:91], a[16:19], v[200:203]
buffer_load_dword a252, v16, s[88:91], s17 offen
v_mfma_f32_16x16x32_bf16 v[200:203], a[92:95], a[20:23], v[200:203]
buffer_load_dwordx4 v14, s[40:43], s64 offen lds
v_mfma_f32_16x16x32_bf16 v[208:211], a[92:95], a[28:31], v[208:211]
v_mfma_f32_16x16x32_bf16 v[208:211], a[88:91], a[24:27], v[208:211]
ds_read_b64_tr_b16 a[88:89], v10 offset:32768
v_mfma_f32_16x16x32_bf16 v[248:251], a[96:99], a[24:27], v[248:251]
ds_read_b64_tr_b16 a[90:91], v10 offset:33792
v_mfma_f32_16x16x32_bf16 v[248:251], a[100:103], a[28:31], v[248:251]
ds_read_b64_tr_b16 a[92:93], v10 offset:40960
v_mfma_f32_16x16x32_bf16 v[212:215], a[100:103], a[20:23], v[212:215]
buffer_store_dword v21, v20, s[44:47], s68 offen sc1
v_mfma_f32_16x16x32_bf16 v[212:215], a[96:99], a[16:19], v[212:215]
s_add_u32 m0, s77, 115712
ds_read_b64_tr_b16 a[94:95], v10 offset:41984
v_mfma_f32_16x16x32_bf16 v[204:207], a[96:99], a[8:11], v[204:207]
s_add_u32 s64, s71, 2129920
v_mfma_f32_16x16x32_bf16 v[204:207], a[100:103], a[12:15], v[204:207]
buffer_load_dwordx4 v14, s[40:43], s64 offen lds
v_mfma_f32_16x16x32_bf16 v[196:199], a[100:103], a[4:7], v[196:199]
v_mfma_f32_16x16x32_bf16 v[196:199], a[96:99], a[0:3], v[196:199]
ds_read_b64_tr_b16 a[96:97], v11 offset:32768
v_mfma_f32_16x16x32_bf16 v[188:191], a[104:107], a[0:3], v[188:191]
ds_read_b64_tr_b16 a[98:99], v11 offset:33792
v_mfma_f32_16x16x32_bf16 v[188:191], a[108:111], a[4:7], v[188:191]
ds_read_b64_tr_b16 a[100:101], v11 offset:40960
v_mfma_f32_16x16x32_bf16 v[216:219], a[108:111], a[12:15], v[216:219]
s_add_u32 m0, s77, 116736
ds_read_b64_tr_b16 a[102:103], v11 offset:41984
v_mfma_f32_16x16x32_bf16 v[216:219], a[104:107], a[8:11], v[216:219]
s_add_u32 s64, s71, 2162688
v_mfma_f32_16x16x32_bf16 v[224:227], a[104:107], a[16:19], v[224:227]
buffer_store_dword v21, v20, s[44:47], s69 offen sc1
v_mfma_f32_16x16x32_bf16 v[224:227], a[108:111], a[20:23], v[224:227]
buffer_load_dwordx4 v15, s[40:43], s64 offen lds
v_mfma_f32_16x16x32_bf16 v[232:235], a[108:111], a[28:31], v[232:235]
v_mfma_f32_16x16x32_bf16 v[232:235], a[104:107], a[24:27], v[232:235]
ds_read_b64_tr_b16 a[104:105], v4 offset:49152
v_mfma_f32_16x16x32_bf16 v[240:243], a[112:115], a[24:27], v[240:243]
s_waitcnt lgkmcnt(5)
ds_read_b64_tr_b16 a[106:107], v4 offset:50176
v_mfma_f32_16x16x32_bf16 v[240:243], a[116:119], a[28:31], v[240:243]
ds_read_b64_tr_b16 a[108:109], v4 offset:57344
v_mfma_f32_16x16x32_bf16 v[252:255], a[116:119], a[20:23], v[252:255]
ds_read_b64_tr_b16 a[110:111], v4 offset:58368
v_mfma_f32_16x16x32_bf16 v[252:255], a[112:115], a[16:19], v[252:255]
s_add_u32 m0, s77, 117760
v_mfma_f32_16x16x32_bf16 v[244:247], a[112:115], a[8:11], v[244:247]
s_add_u32 s64, s71, 2195456
v_mfma_f32_16x16x32_bf16 v[244:247], a[116:119], a[12:15], v[244:247]
buffer_load_dwordx4 v15, s[40:43], s64 offen lds
v_mfma_f32_16x16x32_bf16 v[236:239], a[116:119], a[4:7], v[236:239]
v_mfma_f32_16x16x32_bf16 v[236:239], a[112:115], a[0:3], v[236:239]
ds_read_b64_tr_b16 a[112:113], v5 offset:49152
v_mfma_f32_16x16x32_bf16 v[228:231], a[72:75], a[0:3], v[228:231]
ds_read_b64_tr_b16 a[114:115], v5 offset:50176
v_mfma_f32_16x16x32_bf16 v[228:231], a[76:79], a[4:7], v[228:231]
ds_read_b64_tr_b16 a[116:117], v5 offset:57344
v_mfma_f32_16x16x32_bf16 v[220:223], a[76:79], a[12:15], v[220:223]
ds_read_b64_tr_b16 a[118:119], v5 offset:58368
v_mfma_f32_16x16x32_bf16 v[220:223], a[72:75], a[8:11], v[220:223]
v_mfma_f32_16x16x32_bf16 v[152:155], a[72:75], a[16:19], v[152:155]
v_mfma_f32_16x16x32_bf16 v[152:155], a[76:79], a[20:23], v[152:155]
v_mfma_f32_16x16x32_bf16 v[160:163], a[76:79], a[28:31], v[160:163]
s_add_u32 m0, s76, 0
v_mfma_f32_16x16x32_bf16 v[160:163], a[72:75], a[24:27], v[160:163]
s_add_u32 s64, s70, 512
ds_read_b64_tr_b16 a[72:73], v6 offset:49152
v_mfma_f32_16x16x32_bf16 v[168:171], a[80:83], a[24:27], v[168:171]
buffer_load_dwordx4 v12, s[32:35], s64 offen lds
v_mfma_f32_16x16x32_bf16 v[168:171], a[84:87], a[28:31], v[168:171]
ds_read_b64_tr_b16 a[74:75], v6 offset:50176
v_mfma_f32_16x16x32_bf16 v[176:179], a[84:87], a[20:23], v[176:179]
ds_read_b64_tr_b16 a[76:77], v6 offset:57344
v_mfma_f32_16x16x32_bf16 v[176:179], a[80:83], a[16:19], v[176:179]
ds_read_b64_tr_b16 a[78:79], v6 offset:58368
v_mfma_f32_16x16x32_bf16 v[180:183], a[80:83], a[8:11], v[180:183]
buffer_load_dword a252, v1, s[60:63], s82 offen
v_mfma_f32_16x16x32_bf16 v[180:183], a[84:87], a[12:15], v[180:183]
s_add_u32 m0, s76, 1024
v_mfma_f32_16x16x32_bf16 v[172:175], a[84:87], a[4:7], v[172:175]
s_add_u32 s64, s70, 8704
v_mfma_f32_16x16x32_bf16 v[172:175], a[80:83], a[0:3], v[172:175]
buffer_load_dwordx4 v13, s[32:35], s64 offen lds
v_mfma_f32_16x16x32_bf16 v[164:167], a[88:91], a[0:3], v[164:167]
ds_read_b64_tr_b16 a[80:81], v7 offset:49152
v_mfma_f32_16x16x32_bf16 v[164:167], a[92:95], a[4:7], v[164:167]
ds_read_b64_tr_b16 a[82:83], v7 offset:50176
v_mfma_f32_16x16x32_bf16 v[156:159], a[92:95], a[12:15], v[156:159]
ds_read_b64_tr_b16 a[84:85], v7 offset:57344
v_mfma_f32_16x16x32_bf16 v[156:159], a[88:91], a[8:11], v[156:159]
ds_read_b64_tr_b16 a[86:87], v7 offset:58368
v_mfma_f32_16x16x32_bf16 v[24:27], a[88:91], a[16:19], v[24:27]
s_add_u32 m0, s76, 2048
v_mfma_f32_16x16x32_bf16 v[24:27], a[92:95], a[20:23], v[24:27]
s_add_u32 s64, s70, 16896
v_mfma_f32_16x16x32_bf16 v[40:43], a[92:95], a[28:31], v[40:43]
s_waitcnt vmcnt(16)
buffer_load_dwordx4 v12, s[32:35], s64 offen lds
v_mfma_f32_16x16x32_bf16 v[40:43], a[88:91], a[24:27], v[40:43]
s_waitcnt lgkmcnt(4)
ds_read_b64_tr_b16 a[88:89], v8 offset:49152
v_mfma_f32_16x16x32_bf16 v[56:59], a[96:99], a[24:27], v[56:59]
ds_read_b64_tr_b16 a[90:91], v8 offset:50176
v_mfma_f32_16x16x32_bf16 v[56:59], a[100:103], a[28:31], v[56:59]
ds_read_b64_tr_b16 a[92:93], v8 offset:57344
v_subrev_u32 v4, 0x8000, v4
v_mfma_f32_16x16x32_bf16 v[72:75], a[100:103], a[20:23], v[72:75]
ds_read_b64_tr_b16 a[94:95], v8 offset:58368
v_mfma_f32_16x16x32_bf16 v[72:75], a[96:99], a[16:19], v[72:75]
s_add_u32 m0, s76, 3072
ds_read_b128 a[32:35], v2 offset:32768
v_mfma_f32_16x16x32_bf16 v[136:139], a[96:99], a[8:11], v[136:139]
s_add_u32 s64, s70, 25088
ds_read_b128 a[36:39], v3 offset:32768
v_mfma_f32_16x16x32_bf16 v[136:139], a[100:103], a[12:15], v[136:139]
buffer_load_dwordx4 v13, s[32:35], s64 offen lds
v_mfma_f32_16x16x32_bf16 v[120:123], a[100:103], a[4:7], v[120:123]
ds_read_b128 a[40:43], v2 offset:34816
v_mfma_f32_16x16x32_bf16 v[120:123], a[96:99], a[0:3], v[120:123]
ds_read_b128 a[44:47], v3 offset:34816
v_mfma_f32_16x16x32_bf16 v[104:107], a[0:3], a[104:107], v[104:107]
ds_read_b128 a[48:51], v2 offset:36864
v_mfma_f32_16x16x32_bf16 v[104:107], a[4:7], a[108:111], v[104:107]
ds_read_b128 a[52:55], v3 offset:36864
v_subrev_u32 v5, 0x8000, v5
v_mfma_f32_16x16x32_bf16 v[88:91], a[12:15], a[108:111], v[88:91]
s_add_u32 m0, s76, 4096
ds_read_b128 a[56:59], v2 offset:38912
v_mfma_f32_16x16x32_bf16 v[88:91], a[8:11], a[104:107], v[88:91]
s_add_u32 s64, s70, 33280
ds_read_b128 a[60:63], v3 offset:38912
v_mfma_f32_16x16x32_bf16 v[28:31], a[16:19], a[104:107], v[28:31]
buffer_load_dwordx4 v12, s[32:35], s64 offen lds
v_mfma_f32_16x16x32_bf16 v[28:31], a[20:23], a[108:111], v[28:31]
ds_read_b64_tr_b16 a[96:97], v9 offset:49152
v_mfma_f32_16x16x32_bf16 v[44:47], a[28:31], a[108:111], v[44:47]
ds_read_b64_tr_b16 a[98:99], v9 offset:50176
v_mfma_f32_16x16x32_bf16 v[44:47], a[24:27], a[104:107], v[44:47]
ds_read_b64_tr_b16 a[100:101], v9 offset:57344
v_mfma_f32_16x16x32_bf16 v[60:63], a[24:27], a[112:115], v[60:63]
s_add_u32 m0, s76, 5120
ds_read_b64_tr_b16 a[102:103], v9 offset:58368
v_mfma_f32_16x16x32_bf16 v[60:63], a[28:31], a[116:119], v[60:63]
ds_read_b64_tr_b16 a[104:105], v10 offset:49152
v_subrev_u32 v6, 0x8000, v6
v_mfma_f32_16x16x32_bf16 v[76:79], a[20:23], a[116:119], v[76:79]
s_add_u32 s64, s70, 41472
ds_read_b64_tr_b16 a[106:107], v10 offset:50176
v_mfma_f32_16x16x32_bf16 v[76:79], a[16:19], a[112:115], v[76:79]
buffer_load_dwordx4 v13, s[32:35], s64 offen lds
v_mfma_f32_16x16x32_bf16 v[140:143], a[8:11], a[112:115], v[140:143]
ds_read_b64_tr_b16 a[108:109], v10 offset:57344
v_mfma_f32_16x16x32_bf16 v[140:143], a[12:15], a[116:119], v[140:143]
ds_read_b64_tr_b16 a[110:111], v10 offset:58368
v_mfma_f32_16x16x32_bf16 v[124:127], a[4:7], a[116:119], v[124:127]
v_mfma_f32_16x16x32_bf16 v[124:127], a[0:3], a[112:115], v[124:127]
s_add_u32 m0, s76, 6144
ds_read_b64_tr_b16 a[112:113], v11 offset:49152
v_mfma_f32_16x16x32_bf16 v[108:111], a[0:3], a[72:75], v[108:111]
s_add_u32 s64, s70, 49664
ds_read_b64_tr_b16 a[114:115], v11 offset:50176
v_mfma_f32_16x16x32_bf16 v[108:111], a[4:7], a[76:79], v[108:111]
ds_read_b64_tr_b16 a[116:117], v11 offset:57344
v_subrev_u32 v7, 0x8000, v7
v_mfma_f32_16x16x32_bf16 v[92:95], a[12:15], a[76:79], v[92:95]
buffer_load_dwordx4 v12, s[32:35], s64 offen lds
v_mfma_f32_16x16x32_bf16 v[92:95], a[8:11], a[72:75], v[92:95]
ds_read_b64_tr_b16 a[118:119], v11 offset:58368
v_mfma_f32_16x16x32_bf16 v[32:35], a[16:19], a[72:75], v[32:35]
v_mfma_f32_16x16x32_bf16 v[32:35], a[20:23], a[76:79], v[32:35]
s_add_u32 s81, s81, 1048576
v_mfma_f32_16x16x32_bf16 v[48:51], a[28:31], a[76:79], v[48:51]
s_add_u32 m0, s76, 7168
v_mfma_f32_16x16x32_bf16 v[48:51], a[24:27], a[72:75], v[48:51]
s_waitcnt lgkmcnt(4)
s_add_u32 s64, s70, 57856
v_mfma_f32_16x16x32_bf16 v[64:67], a[24:27], a[80:83], v[64:67]
buffer_load_dword a252, v16, s[56:59], s81 offen
v_mfma_f32_16x16x32_bf16 v[64:67], a[28:31], a[84:87], v[64:67]
buffer_load_dwordx4 v13, s[32:35], s64 offen lds
v_mfma_f32_16x16x32_bf16 v[80:83], a[20:23], a[84:87], v[80:83]
v_subrev_u32 v8, 0x8000, v8
v_mfma_f32_16x16x32_bf16 v[80:83], a[16:19], a[80:83], v[80:83]
v_mfma_f32_16x16x32_bf16 v[144:147], a[8:11], a[80:83], v[144:147]
v_mfma_f32_16x16x32_bf16 v[144:147], a[12:15], a[84:87], v[144:147]
v_mfma_f32_16x16x32_bf16 v[128:131], a[4:7], a[84:87], v[128:131]
v_subrev_u32 v9, 0x8000, v9
v_subrev_u32 v10, 0x8000, v10
v_mfma_f32_16x16x32_bf16 v[128:131], a[0:3], a[80:83], v[128:131]
v_subrev_u32 v11, 0x8000, v11
v_mfma_f32_16x16x32_bf16 v[112:115], a[0:3], a[88:91], v[112:115]
v_mfma_f32_16x16x32_bf16 v[112:115], a[4:7], a[92:95], v[112:115]
v_mfma_f32_16x16x32_bf16 v[96:99], a[12:15], a[92:95], v[96:99]
s_waitcnt lgkmcnt(0)
s_barrier
v_mfma_f32_16x16x32_bf16 v[96:99], a[8:11], a[88:91], v[96:99]
s_add_u32 m0, s77, 131072
ds_read_b64_tr_b16 a[72:73], v4 offset:0
v_mfma_f32_16x16x32_bf16 v[36:39], a[16:19], a[88:91], v[36:39]
s_add_u32 s64, s71, 2621440
ds_read_b64_tr_b16 a[74:75], v4 offset:1024
v_mfma_f32_16x16x32_bf16 v[36:39], a[20:23], a[92:95], v[36:39]
buffer_load_dwordx4 v14, s[36:39], s64 offen lds
v_mfma_f32_16x16x32_bf16 v[52:55], a[28:31], a[92:95], v[52:55]
ds_read_b64_tr_b16 a[76:77], v4 offset:8192
v_mfma_f32_16x16x32_bf16 v[52:55], a[24:27], a[88:91], v[52:55]
ds_read_b64_tr_b16 a[78:79], v4 offset:9216
v_mfma_f32_16x16x32_bf16 v[68:71], a[24:27], a[96:99], v[68:71]
ds_read_b64_tr_b16 a[80:81], v5 offset:0
v_mfma_f32_16x16x32_bf16 v[68:71], a[28:31], a[100:103], v[68:71]
ds_read_b64_tr_b16 a[82:83], v5 offset:1024
v_mfma_f32_16x16x32_bf16 v[84:87], a[20:23], a[100:103], v[84:87]
ds_read_b64_tr_b16 a[84:85], v5 offset:8192
v_mfma_f32_16x16x32_bf16 v[84:87], a[16:19], a[96:99], v[84:87]
s_add_u32 m0, s77, 132096
ds_read_b64_tr_b16 a[86:87], v5 offset:9216
v_mfma_f32_16x16x32_bf16 v[148:151], a[8:11], a[96:99], v[148:151]
s_add_u32 s64, s71, 2654208
ds_read_b64_tr_b16 a[88:89], v6 offset:0
v_mfma_f32_16x16x32_bf16 v[148:151], a[12:15], a[100:103], v[148:151]
buffer_load_dwordx4 v14, s[36:39], s64 offen lds
v_mfma_f32_16x16x32_bf16 v[132:135], a[4:7], a[100:103], v[132:135]
ds_read_b64_tr_b16 a[90:91], v6 offset:1024
v_mfma_f32_16x16x32_bf16 v[132:135], a[0:3], a[96:99], v[132:135]
ds_read_b64_tr_b16 a[92:93], v6 offset:8192
v_mfma_f32_16x16x32_bf16 v[116:119], a[0:3], a[104:107], v[116:119]
ds_read_b64_tr_b16 a[94:95], v6 offset:9216
v_mfma_f32_16x16x32_bf16 v[116:119], a[4:7], a[108:111], v[116:119]
ds_read_b64_tr_b16 a[96:97], v7 offset:0
v_mfma_f32_16x16x32_bf16 v[100:103], a[12:15], a[108:111], v[100:103]
ds_read_b64_tr_b16 a[98:99], v7 offset:1024
v_mfma_f32_16x16x32_bf16 v[100:103], a[8:11], a[104:107], v[100:103]
s_add_u32 m0, s77, 133120
ds_read_b64_tr_b16 a[100:101], v7 offset:8192
v_mfma_f32_16x16x32_bf16 a[120:123], a[16:19], a[104:107], a[120:123]
s_add_u32 s64, s71, 2686976
ds_read_b64_tr_b16 a[102:103], v7 offset:9216
v_mfma_f32_16x16x32_bf16 a[120:123], a[20:23], a[108:111], a[120:123]
buffer_load_dwordx4 v15, s[36:39], s64 offen lds
v_mfma_f32_16x16x32_bf16 a[124:127], a[28:31], a[108:111], a[124:127]
v_mfma_f32_16x16x32_bf16 a[124:127], a[24:27], a[104:107], a[124:127]
ds_read_b64_tr_b16 a[104:105], v8 offset:0
v_mfma_f32_16x16x32_bf16 a[128:131], a[24:27], a[112:115], a[128:131]
ds_read_b64_tr_b16 a[106:107], v8 offset:1024
v_mfma_f32_16x16x32_bf16 a[128:131], a[28:31], a[116:119], a[128:131]
ds_read_b64_tr_b16 a[108:109], v8 offset:8192
v_mfma_f32_16x16x32_bf16 a[132:135], a[20:23], a[116:119], a[132:135]
ds_read_b64_tr_b16 a[110:111], v8 offset:9216
v_mfma_f32_16x16x32_bf16 a[132:135], a[16:19], a[112:115], a[132:135]
s_add_u32 m0, s77, 134144
v_mfma_f32_16x16x32_bf16 a[136:139], a[8:11], a[112:115], a[136:139]
s_add_u32 s64, s71, 2719744
v_mfma_f32_16x16x32_bf16 a[136:139], a[12:15], a[116:119], a[136:139]
buffer_load_dwordx4 v15, s[36:39], s64 offen lds
v_mfma_f32_16x16x32_bf16 a[140:143], a[4:7], a[116:119], a[140:143]
v_mfma_f32_16x16x32_bf16 a[140:143], a[0:3], a[112:115], a[140:143]
s_waitcnt lgkmcnt(4)
ds_read_b64_tr_b16 a[112:113], v9 offset:0
v_mfma_f32_16x16x32_bf16 v[184:187], a[72:75], a[32:35], v[184:187]
ds_read_b64_tr_b16 a[114:115], v9 offset:1024
v_mov_b32 v17, 0
v_mfma_f32_16x16x32_bf16 v[184:187], a[76:79], a[36:39], v[184:187]
ds_read_b64_tr_b16 a[116:117], v9 offset:8192
v_accvgpr_read_b32 v19, a144
v_mfma_f32_16x16x32_bf16 v[192:195], a[76:79], a[44:47], v[192:195]
ds_read_b64_tr_b16 a[118:119], v9 offset:9216
v_accvgpr_read_b32 v21, a160
v_mfma_f32_16x16x32_bf16 v[192:195], a[72:75], a[40:43], v[192:195]
s_add_u32 m0, s77, 147456
s_add_u32 s82, s82, 1048576
v_lshlrev_b32 v18, 16, v19
v_and_b32 v19, 0xffff0000, v19
v_mfma_f32_16x16x32_bf16 v[200:203], a[72:75], a[48:51], v[200:203]
s_add_u32 s64, s71, 2621440
buffer_load_dword a252, v1, s[60:63], s82 offen
v_mfma_f32_16x16x32_bf16 v[200:203], a[76:79], a[52:55], v[200:203]
s_add_u32 s17, s78, .-L_pc+6144
buffer_load_dwordx4 v14, s[40:43], s64 offen lds
v_mfma_f32_16x16x32_bf16 v[208:211], a[76:79], a[60:63], v[208:211]
buffer_load_dword a252, v16, s[88:91], s17 offen
v_mfma_f32_16x16x32_bf16 v[208:211], a[72:75], a[56:59], v[208:211]
ds_read_b64_tr_b16 a[72:73], v10 offset:0
v_lshlrev_b32 v20, 16, v21
v_mfma_f32_16x16x32_bf16 v[248:251], a[80:83], a[56:59], v[248:251]
ds_read_b64_tr_b16 a[74:75], v10 offset:1024
v_and_b32 v21, 0xffff0000, v21
v_mfma_f32_16x16x32_bf16 v[248:251], a[84:87], a[60:63], v[248:251]
ds_read_b64_tr_b16 a[76:77], v10 offset:8192
v_mul_f32 v18, v18, v20
v_mfma_f32_16x16x32_bf16 v[212:215], a[84:87], a[52:55], v[212:215]
ds_read_b64_tr_b16 a[78:79], v10 offset:9216
v_mul_f32 v19, v19, v21
v_mfma_f32_16x16x32_bf16 v[212:215], a[80:83], a[48:51], v[212:215]
s_add_u32 m0, s77, 148480
v_cvt_pk_bf16_f32 v18, v18, v19
v_lshlrev_b32 v19, 16, v18
v_mfma_f32_16x16x32_bf16 v[204:207], a[80:83], a[40:43], v[204:207]
s_add_u32 s64, s71, 2654208
v_and_b32 v18, 0xffff0000, v18
v_add_f32 v17, v17, v19
v_mfma_f32_16x16x32_bf16 v[204:207], a[84:87], a[44:47], v[204:207]
buffer_load_dwordx4 v14, s[40:43], s64 offen lds
v_mfma_f32_16x16x32_bf16 v[196:199], a[84:87], a[36:39], v[196:199]
v_add_f32 v17, v17, v18
v_accvgpr_read_b32 v19, a145
v_mfma_f32_16x16x32_bf16 v[196:199], a[80:83], a[32:35], v[196:199]
ds_read_b64_tr_b16 a[80:81], v11 offset:0
v_accvgpr_read_b32 v21, a161
v_mfma_f32_16x16x32_bf16 v[188:191], a[88:91], a[32:35], v[188:191]
ds_read_b64_tr_b16 a[82:83], v11 offset:1024
v_lshlrev_b32 v18, 16, v19
v_mfma_f32_16x16x32_bf16 v[188:191], a[92:95], a[36:39], v[188:191]
ds_read_b64_tr_b16 a[84:85], v11 offset:8192
v_and_b32 v19, 0xffff0000, v19
v_mfma_f32_16x16x32_bf16 v[216:219], a[92:95], a[44:47], v[216:219]
ds_read_b64_tr_b16 a[86:87], v11 offset:9216
v_lshlrev_b32 v20, 16, v21
v_mfma_f32_16x16x32_bf16 v[216:219], a[88:91], a[40:43], v[216:219]
s_add_u32 m0, s77, 149504
v_and_b32 v21, 0xffff0000, v21
v_mul_f32 v18, v18, v20
v_mfma_f32_16x16x32_bf16 v[224:227], a[88:91], a[48:51], v[224:227]
s_add_u32 s64, s71, 2686976
v_mul_f32 v19, v19, v21
v_cvt_pk_bf16_f32 v18, v18, v19
v_mfma_f32_16x16x32_bf16 v[224:227], a[92:95], a[52:55], v[224:227]
buffer_load_dwordx4 v15, s[40:43], s64 offen lds
v_mfma_f32_16x16x32_bf16 v[232:235], a[92:95], a[60:63], v[232:235]
v_lshlrev_b32 v19, 16, v18
v_and_b32 v18, 0xffff0000, v18
v_mfma_f32_16x16x32_bf16 v[232:235], a[88:91], a[56:59], v[232:235]
ds_read_b64_tr_b16 a[88:89], v4 offset:16384
v_add_f32 v17, v17, v19
v_mfma_f32_16x16x32_bf16 v[240:243], a[96:99], a[56:59], v[240:243]
ds_read_b64_tr_b16 a[90:91], v4 offset:17408
v_add_f32 v17, v17, v18
v_mfma_f32_16x16x32_bf16 v[240:243], a[100:103], a[60:63], v[240:243]
ds_read_b64_tr_b16 a[92:93], v4 offset:24576
v_accvgpr_read_b32 v19, a146
v_mfma_f32_16x16x32_bf16 v[252:255], a[100:103], a[52:55], v[252:255]
ds_read_b64_tr_b16 a[94:95], v4 offset:25600
v_accvgpr_read_b32 v21, a162
v_mfma_f32_16x16x32_bf16 v[252:255], a[96:99], a[48:51], v[252:255]
s_add_u32 m0, s77, 150528
v_lshlrev_b32 v18, 16, v19
v_and_b32 v19, 0xffff0000, v19
v_mfma_f32_16x16x32_bf16 v[244:247], a[96:99], a[40:43], v[244:247]
s_add_u32 s64, s71, 2719744
v_lshlrev_b32 v20, 16, v21
v_and_b32 v21, 0xffff0000, v21
v_mfma_f32_16x16x32_bf16 v[244:247], a[100:103], a[44:47], v[244:247]
buffer_load_dwordx4 v15, s[40:43], s64 offen lds
v_mfma_f32_16x16x32_bf16 v[236:239], a[100:103], a[36:39], v[236:239]
v_mul_f32 v18, v18, v20
v_mul_f32 v19, v19, v21
v_mfma_f32_16x16x32_bf16 v[236:239], a[96:99], a[32:35], v[236:239]
s_waitcnt lgkmcnt(4)
ds_read_b64_tr_b16 a[96:97], v5 offset:16384
v_cvt_pk_bf16_f32 v18, v18, v19
v_mfma_f32_16x16x32_bf16 v[228:231], a[104:107], a[32:35], v[228:231]
ds_read_b64_tr_b16 a[98:99], v5 offset:17408
v_lshlrev_b32 v19, 16, v18
v_mfma_f32_16x16x32_bf16 v[228:231], a[108:111], a[36:39], v[228:231]
ds_read_b64_tr_b16 a[100:101], v5 offset:24576
v_and_b32 v18, 0xffff0000, v18
v_mfma_f32_16x16x32_bf16 v[220:223], a[108:111], a[44:47], v[220:223]
ds_read_b64_tr_b16 a[102:103], v5 offset:25600
v_add_f32 v17, v17, v19
v_mfma_f32_16x16x32_bf16 v[220:223], a[104:107], a[40:43], v[220:223]
v_add_f32 v17, v17, v18
v_accvgpr_read_b32 v19, a147
v_mfma_f32_16x16x32_bf16 v[152:155], a[104:107], a[48:51], v[152:155]
v_accvgpr_read_b32 v21, a163
v_lshlrev_b32 v18, 16, v19
v_mfma_f32_16x16x32_bf16 v[152:155], a[108:111], a[52:55], v[152:155]
v_and_b32 v19, 0xffff0000, v19
v_lshlrev_b32 v20, 16, v21
v_mfma_f32_16x16x32_bf16 v[160:163], a[108:111], a[60:63], v[160:163]
s_add_u32 m0, s76, 32768
v_and_b32 v21, 0xffff0000, v21
v_mul_f32 v18, v18, v20
v_mfma_f32_16x16x32_bf16 v[160:163], a[104:107], a[56:59], v[160:163]
s_add_u32 s64, s70, 640
ds_read_b64_tr_b16 a[104:105], v6 offset:16384
v_mul_f32 v19, v19, v21
v_mfma_f32_16x16x32_bf16 v[168:171], a[112:115], a[56:59], v[168:171]
buffer_load_dwordx4 v12, s[32:35], s64 offen lds
v_mfma_f32_16x16x32_bf16 v[168:171], a[116:119], a[60:63], v[168:171]
ds_read_b64_tr_b16 a[106:107], v6 offset:17408
v_cvt_pk_bf16_f32 v18, v18, v19
v_mfma_f32_16x16x32_bf16 v[176:179], a[116:119], a[52:55], v[176:179]
ds_read_b64_tr_b16 a[108:109], v6 offset:24576
v_lshlrev_b32 v19, 16, v18
v_mfma_f32_16x16x32_bf16 v[176:179], a[112:115], a[48:51], v[176:179]
ds_read_b64_tr_b16 a[110:111], v6 offset:25600
v_and_b32 v18, 0xffff0000, v18
v_mfma_f32_16x16x32_bf16 v[180:183], a[112:115], a[40:43], v[180:183]
s_add_u32 s81, s81, 1048576
v_add_f32 v17, v17, v19
v_add_f32 v17, v17, v18
v_mfma_f32_16x16x32_bf16 v[180:183], a[116:119], a[44:47], v[180:183]
s_add_u32 m0, s76, 33792
v_accvgpr_read_b32 v19, a148
v_accvgpr_read_b32 v21, a164
v_mfma_f32_16x16x32_bf16 v[172:175], a[116:119], a[36:39], v[172:175]
s_add_u32 s64, s70, 8832
v_lshlrev_b32 v18, 16, v19
v_and_b32 v19, 0xffff0000, v19
v_mfma_f32_16x16x32_bf16 v[172:175], a[112:115], a[32:35], v[172:175]
buffer_load_dwordx4 v13, s[32:35], s64 offen lds
v_mfma_f32_16x16x32_bf16 v[164:167], a[72:75], a[32:35], v[164:167]
buffer_load_dword a252, v16, s[56:59], s81 offen
v_mfma_f32_16x16x32_bf16 v[164:167], a[76:79], a[36:39], v[164:167]
ds_read_b64_tr_b16 a[112:113], v7 offset:16384
v_lshlrev_b32 v20, 16, v21
v_mfma_f32_16x16x32_bf16 v[156:159], a[76:79], a[44:47], v[156:159]
ds_read_b64_tr_b16 a[114:115], v7 offset:17408
v_and_b32 v21, 0xffff0000, v21
v_mfma_f32_16x16x32_bf16 v[156:159], a[72:75], a[40:43], v[156:159]
ds_read_b64_tr_b16 a[116:117], v7 offset:24576
v_mul_f32 v18, v18, v20
v_mfma_f32_16x16x32_bf16 v[24:27], a[72:75], a[48:51], v[24:27]
s_add_u32 m0, s76, 34816
ds_read_b64_tr_b16 a[118:119], v7 offset:25600
v_mul_f32 v19, v19, v21
v_mfma_f32_16x16x32_bf16 v[24:27], a[76:79], a[52:55], v[24:27]
s_add_u32 s64, s70, 17024
v_cvt_pk_bf16_f32 v18, v18, v19
v_lshlrev_b32 v19, 16, v18
v_mfma_f32_16x16x32_bf16 v[40:43], a[76:79], a[60:63], v[40:43]
s_waitcnt vmcnt(13)
buffer_load_dwordx4 v12, s[32:35], s64 offen lds
v_mfma_f32_16x16x32_bf16 v[40:43], a[72:75], a[56:59], v[40:43]
ds_read_b64_tr_b16 a[72:73], v8 offset:16384
v_and_b32 v18, 0xffff0000, v18
v_mfma_f32_16x16x32_bf16 v[56:59], a[80:83], a[56:59], v[56:59]
ds_read_b64_tr_b16 a[74:75], v8 offset:17408
v_add_f32 v17, v17, v19
v_mfma_f32_16x16x32_bf16 v[56:59], a[84:87], a[60:63], v[56:59]
ds_read_b64_tr_b16 a[76:77], v8 offset:24576
v_add_f32 v17, v17, v18
v_mfma_f32_16x16x32_bf16 v[72:75], a[84:87], a[52:55], v[72:75]
ds_read_b64_tr_b16 a[78:79], v8 offset:25600
v_accvgpr_read_b32 v19, a149
v_mfma_f32_16x16x32_bf16 v[72:75], a[80:83], a[48:51], v[72:75]
s_add_u32 m0, s76, 35840
ds_read_b128 a[0:3], v2 offset:0
v_accvgpr_read_b32 v21, a165
v_mfma_f32_16x16x32_bf16 v[136:139], a[80:83], a[40:43], v[136:139]
s_add_u32 s64, s70, 25216
ds_read_b128 a[4:7], v3 offset:0
v_lshlrev_b32 v18, 16, v19
v_mfma_f32_16x16x32_bf16 v[136:139], a[84:87], a[44:47], v[136:139]
buffer_load_dwordx4 v13, s[32:35], s64 offen lds
v_mfma_f32_16x16x32_bf16 v[120:123], a[84:87], a[36:39], v[120:123]
ds_read_b128 a[8:11], v2 offset:2048
v_and_b32 v19, 0xffff0000, v19
v_mfma_f32_16x16x32_bf16 v[120:123], a[80:83], a[32:35], v[120:123]
s_waitcnt lgkmcnt(7)
ds_read_b128 a[12:15], v3 offset:2048
v_lshlrev_b32 v20, 16, v21
v_mfma_f32_16x16x32_bf16 v[104:107], a[32:35], a[88:91], v[104:107]
ds_read_b128 a[16:19], v2 offset:4096
v_and_b32 v21, 0xffff0000, v21
v_mfma_f32_16x16x32_bf16 v[104:107], a[36:39], a[92:95], v[104:107]
ds_read_b128 a[20:23], v3 offset:4096
v_mul_f32 v18, v18, v20
v_mfma_f32_16x16x32_bf16 v[88:91], a[44:47], a[92:95], v[88:91]
s_add_u32 m0, s76, 36864
ds_read_b128 a[24:27], v2 offset:6144
v_mul_f32 v19, v19, v21
v_mfma_f32_16x16x32_bf16 v[88:91], a[40:43], a[88:91], v[88:91]
s_add_u32 s64, s70, 33408
ds_read_b128 a[28:31], v3 offset:6144
v_cvt_pk_bf16_f32 v18, v18, v19
v_mfma_f32_16x16x32_bf16 v[28:31], a[48:51], a[88:91], v[28:31]
buffer_load_dwordx4 v12, s[32:35], s64 offen lds
v_mfma_f32_16x16x32_bf16 v[28:31], a[52:55], a[92:95], v[28:31]
ds_read_b64_tr_b16 a[80:81], v9 offset:16384
v_lshlrev_b32 v19, 16, v18
v_mfma_f32_16x16x32_bf16 v[44:47], a[60:63], a[92:95], v[44:47]
ds_read_b64_tr_b16 a[82:83], v9 offset:17408
v_and_b32 v18, 0xffff0000, v18
v_mfma_f32_16x16x32_bf16 v[44:47], a[56:59], a[88:91], v[44:47]
ds_read_b64_tr_b16 a[84:85], v9 offset:24576
v_add_f32 v17, v17, v19
v_mfma_f32_16x16x32_bf16 v[60:63], a[56:59], a[96:99], v[60:63]
ds_read_b64_tr_b16 a[86:87], v9 offset:25600
v_add_f32 v17, v17, v18
v_mfma_f32_16x16x32_bf16 v[60:63], a[60:63], a[100:103], v[60:63]
s_add_u32 m0, s76, 37888
ds_read_b64_tr_b16 a[88:89], v10 offset:16384
v_accvgpr_read_b32 v19, a150
v_mfma_f32_16x16x32_bf16 v[76:79], a[52:55], a[100:103], v[76:79]
s_add_u32 s64, s70, 41600
ds_read_b64_tr_b16 a[90:91], v10 offset:17408
v_accvgpr_read_b32 v21, a166
v_mfma_f32_16x16x32_bf16 v[76:79], a[48:51], a[96:99], v[76:79]
buffer_load_dwordx4 v13, s[32:35], s64 offen lds
v_mfma_f32_16x16x32_bf16 v[140:143], a[40:43], a[96:99], v[140:143]
ds_read_b64_tr_b16 a[92:93], v10 offset:24576
v_lshlrev_b32 v18, 16, v19
v_mfma_f32_16x16x32_bf16 v[140:143], a[44:47], a[100:103], v[140:143]
ds_read_b64_tr_b16 a[94:95], v10 offset:25600
v_and_b32 v19, 0xffff0000, v19
v_mfma_f32_16x16x32_bf16 v[124:127], a[36:39], a[100:103], v[124:127]
v_lshlrev_b32 v20, 16, v21
v_and_b32 v21, 0xffff0000, v21
v_mfma_f32_16x16x32_bf16 v[124:127], a[32:35], a[96:99], v[124:127]
ds_read_b64_tr_b16 a[96:97], v11 offset:16384
v_mul_f32 v18, v18, v20
v_mfma_f32_16x16x32_bf16 v[108:111], a[32:35], a[104:107], v[108:111]
s_add_u32 m0, s76, 38912
ds_read_b64_tr_b16 a[98:99], v11 offset:17408
v_mul_f32 v19, v19, v21
v_mfma_f32_16x16x32_bf16 v[108:111], a[36:39], a[108:111], v[108:111]
s_add_u32 s64, s70, 49792
ds_read_b64_tr_b16 a[100:101], v11 offset:24576
v_cvt_pk_bf16_f32 v18, v18, v19
v_mfma_f32_16x16x32_bf16 v[92:95], a[44:47], a[108:111], v[92:95]
buffer_load_dwordx4 v12, s[32:35], s64 offen lds
v_mfma_f32_16x16x32_bf16 v[92:95], a[40:43], a[104:107], v[92:95]
ds_read_b64_tr_b16 a[102:103], v11 offset:25600
v_lshlrev_b32 v19, 16, v18
v_mfma_f32_16x16x32_bf16 v[32:35], a[48:51], a[104:107], v[32:35]
v_and_b32 v18, 0xffff0000, v18
v_add_f32 v17, v17, v19
v_mfma_f32_16x16x32_bf16 v[32:35], a[52:55], a[108:111], v[32:35]
v_add_f32 v17, v17, v18
v_accvgpr_read_b32 v19, a151
v_mfma_f32_16x16x32_bf16 v[48:51], a[60:63], a[108:111], v[48:51]
v_accvgpr_read_b32 v21, a167
v_lshlrev_b32 v18, 16, v19
v_mfma_f32_16x16x32_bf16 v[48:51], a[56:59], a[104:107], v[48:51]
s_add_u32 m0, s76, 39936
v_and_b32 v19, 0xffff0000, v19
v_lshlrev_b32 v20, 16, v21
v_mfma_f32_16x16x32_bf16 v[64:67], a[56:59], a[112:115], v[64:67]
s_add_u32 s64, s70, 57984
v_and_b32 v21, 0xffff0000, v21
v_mul_f32 v18, v18, v20
v_mfma_f32_16x16x32_bf16 v[64:67], a[60:63], a[116:119], v[64:67]
buffer_load_dwordx4 v13, s[32:35], s64 offen lds
v_mfma_f32_16x16x32_bf16 v[80:83], a[52:55], a[116:119], v[80:83]
v_mul_f32 v19, v19, v21
v_cvt_pk_bf16_f32 v18, v18, v19
v_mfma_f32_16x16x32_bf16 v[80:83], a[48:51], a[112:115], v[80:83]
s_add_u32 s81, s81, 1048576
v_lshlrev_b32 v19, 16, v18
v_and_b32 v18, 0xffff0000, v18
v_mfma_f32_16x16x32_bf16 v[144:147], a[40:43], a[112:115], v[144:147]
buffer_load_dword a252, v16, s[56:59], s81 offen
v_mfma_f32_16x16x32_bf16 v[144:147], a[44:47], a[116:119], v[144:147]
v_add_f32 v17, v17, v19
v_add_f32 v17, v17, v18
v_mfma_f32_16x16x32_bf16 v[128:131], a[36:39], a[116:119], v[128:131]
v_accvgpr_read_b32 v19, a152
v_accvgpr_read_b32 v21, a168
v_mfma_f32_16x16x32_bf16 v[128:131], a[32:35], a[112:115], v[128:131]
s_waitcnt lgkmcnt(0)
v_lshlrev_b32 v18, 16, v19
v_and_b32 v19, 0xffff0000, v19
v_mfma_f32_16x16x32_bf16 v[112:115], a[32:35], a[72:75], v[112:115]
v_lshlrev_b32 v20, 16, v21
v_and_b32 v21, 0xffff0000, v21
v_mfma_f32_16x16x32_bf16 v[112:115], a[36:39], a[76:79], v[112:115]
v_mul_f32 v18, v18, v20
v_mul_f32 v19, v19, v21
v_mfma_f32_16x16x32_bf16 v[96:99], a[44:47], a[76:79], v[96:99]
s_waitcnt lgkmcnt(0)
s_barrier
v_mfma_f32_16x16x32_bf16 v[96:99], a[40:43], a[72:75], v[96:99]
s_add_u32 m0, s77, 65536
ds_read_b64_tr_b16 a[104:105], v4 offset:32768
v_cvt_pk_bf16_f32 v18, v18, v19
v_mfma_f32_16x16x32_bf16 v[36:39], a[48:51], a[72:75], v[36:39]
s_add_u32 s64, s71, 3145728
ds_read_b64_tr_b16 a[106:107], v4 offset:33792
v_lshlrev_b32 v19, 16, v18
v_mfma_f32_16x16x32_bf16 v[36:39], a[52:55], a[76:79], v[36:39]
buffer_load_dwordx4 v14, s[36:39], s64 offen lds
v_mfma_f32_16x16x32_bf16 v[52:55], a[60:63], a[76:79], v[52:55]
ds_read_b64_tr_b16 a[108:109], v4 offset:40960
v_and_b32 v18, 0xffff0000, v18
v_mfma_f32_16x16x32_bf16 v[52:55], a[56:59], a[72:75], v[52:55]
ds_read_b64_tr_b16 a[110:111], v4 offset:41984
v_add_f32 v17, v17, v19
v_mfma_f32_16x16x32_bf16 v[68:71], a[56:59], a[80:83], v[68:71]
ds_read_b64_tr_b16 a[112:113], v5 offset:32768
v_add_f32 v17, v17, v18
v_mfma_f32_16x16x32_bf16 v[68:71], a[60:63], a[84:87], v[68:71]
ds_read_b64_tr_b16 a[114:115], v5 offset:33792
v_accvgpr_read_b32 v19, a153
v_mfma_f32_16x16x32_bf16 v[84:87], a[52:55], a[84:87], v[84:87]
ds_read_b64_tr_b16 a[116:117], v5 offset:40960
v_accvgpr_read_b32 v21, a169
v_mfma_f32_16x16x32_bf16 v[84:87], a[48:51], a[80:83], v[84:87]
s_add_u32 m0, s77, 66560
ds_read_b64_tr_b16 a[118:119], v5 offset:41984
v_lshlrev_b32 v18, 16, v19
v_mfma_f32_16x16x32_bf16 v[148:151], a[40:43], a[80:83], v[148:151]
s_add_u32 s64, s71, 3178496
ds_read_b64_tr_b16 a[72:73], v6 offset:32768
v_and_b32 v19, 0xffff0000, v19
v_mfma_f32_16x16x32_bf16 v[148:151], a[44:47], a[84:87], v[148:151]
buffer_load_dwordx4 v14, s[36:39], s64 offen lds
v_mfma_f32_16x16x32_bf16 v[132:135], a[36:39], a[84:87], v[132:135]
ds_read_b64_tr_b16 a[74:75], v6 offset:33792
v_lshlrev_b32 v20, 16, v21
v_mfma_f32_16x16x32_bf16 v[132:135], a[32:35], a[80:83], v[132:135]
ds_read_b64_tr_b16 a[76:77], v6 offset:40960
v_and_b32 v21, 0xffff0000, v21
v_mfma_f32_16x16x32_bf16 v[116:119], a[32:35], a[88:91], v[116:119]
ds_read_b64_tr_b16 a[78:79], v6 offset:41984
v_mul_f32 v18, v18, v20
v_mfma_f32_16x16x32_bf16 v[116:119], a[36:39], a[92:95], v[116:119]
ds_read_b64_tr_b16 a[80:81], v7 offset:32768
v_mul_f32 v19, v19, v21
v_mfma_f32_16x16x32_bf16 v[100:103], a[44:47], a[92:95], v[100:103]
ds_read_b64_tr_b16 a[82:83], v7 offset:33792
v_cvt_pk_bf16_f32 v18, v18, v19
v_mfma_f32_16x16x32_bf16 v[100:103], a[40:43], a[88:91], v[100:103]
s_add_u32 m0, s77, 67584
ds_read_b64_tr_b16 a[84:85], v7 offset:40960
v_lshlrev_b32 v19, 16, v18
v_mfma_f32_16x16x32_bf16 a[120:123], a[48:51], a[88:91], a[120:123]
s_add_u32 s64, s71, 3211264
ds_read_b64_tr_b16 a[86:87], v7 offset:41984
v_and_b32 v18, 0xffff0000, v18
v_mfma_f32_16x16x32_bf16 a[120:123], a[52:55], a[92:95], a[120:123]
buffer_load_dwordx4 v15, s[36:39], s64 offen lds
v_mfma_f32_16x16x32_bf16 a[124:127], a[60:63], a[92:95], a[124:127]
v_add_f32 v17, v17, v19
v_add_f32 v17, v17, v18
v_mfma_f32_16x16x32_bf16 a[124:127], a[56:59], a[88:91], a[124:127]
ds_read_b64_tr_b16 a[88:89], v8 offset:32768
v_accvgpr_read_b32 v19, a154
v_mfma_f32_16x16x32_bf16 a[128:131], a[56:59], a[96:99], a[128:131]
ds_read_b64_tr_b16 a[90:91], v8 offset:33792
v_accvgpr_read_b32 v21, a170
v_mfma_f32_16x16x32_bf16 a[128:131], a[60:63], a[100:103], a[128:131]
ds_read_b64_tr_b16 a[92:93], v8 offset:40960
v_lshlrev_b32 v18, 16, v19
v_mfma_f32_16x16x32_bf16 a[132:135], a[52:55], a[100:103], a[132:135]
ds_read_b64_tr_b16 a[94:95], v8 offset:41984
v_and_b32 v19, 0xffff0000, v19
v_mfma_f32_16x16x32_bf16 a[132:135], a[48:51], a[96:99], a[132:135]
s_add_u32 m0, s77, 68608
v_lshlrev_b32 v20, 16, v21
v_and_b32 v21, 0xffff0000, v21
v_mfma_f32_16x16x32_bf16 a[136:139], a[40:43], a[96:99], a[136:139]
s_add_u32 s64, s71, 3244032
v_mul_f32 v18, v18, v20
v_mul_f32 v19, v19, v21
v_mfma_f32_16x16x32_bf16 a[136:139], a[44:47], a[100:103], a[136:139]
buffer_load_dwordx4 v15, s[36:39], s64 offen lds
v_mfma_f32_16x16x32_bf16 a[140:143], a[36:39], a[100:103], a[140:143]
v_cvt_pk_bf16_f32 v18, v18, v19
v_lshlrev_b32 v19, 16, v18
v_mfma_f32_16x16x32_bf16 a[140:143], a[32:35], a[96:99], a[140:143]
s_waitcnt lgkmcnt(4)
ds_read_b64_tr_b16 a[96:97], v9 offset:32768
v_and_b32 v18, 0xffff0000, v18
v_mfma_f32_16x16x32_bf16 v[184:187], a[104:107], a[0:3], v[184:187]
ds_read_b64_tr_b16 a[98:99], v9 offset:33792
v_add_f32 v17, v17, v19
v_mfma_f32_16x16x32_bf16 v[184:187], a[108:111], a[4:7], v[184:187]
ds_read_b64_tr_b16 a[100:101], v9 offset:40960
v_add_f32 v17, v17, v18
v_mfma_f32_16x16x32_bf16 v[192:195], a[108:111], a[12:15], v[192:195]
ds_read_b64_tr_b16 a[102:103], v9 offset:41984
v_accvgpr_read_b32 v19, a155
v_mfma_f32_16x16x32_bf16 v[192:195], a[104:107], a[8:11], v[192:195]
s_add_u32 m0, s77, 81920
s_add_u32 s17, s78, .-L_pc+6144
v_accvgpr_read_b32 v21, a171
v_lshlrev_b32 v18, 16, v19
v_mfma_f32_16x16x32_bf16 v[200:203], a[104:107], a[16:19], v[200:203]
s_add_u32 s64, s71, 3145728
buffer_load_dword a252, v16, s[88:91], s17 offen
v_mfma_f32_16x16x32_bf16 v[200:203], a[108:111], a[20:23], v[200:203]
buffer_load_dwordx4 v14, s[40:43], s64 offen lds
v_mfma_f32_16x16x32_bf16 v[208:211], a[108:111], a[28:31], v[208:211]
s_add_u32 s82, s82, 1048576
v_and_b32 v19, 0xffff0000, v19
v_lshlrev_b32 v20, 16, v21
v_mfma_f32_16x16x32_bf16 v[208:211], a[104:107], a[24:27], v[208:211]
ds_read_b64_tr_b16 a[104:105], v10 offset:32768
v_and_b32 v21, 0xffff0000, v21
v_mfma_f32_16x16x32_bf16 v[248:251], a[112:115], a[24:27], v[248:251]
buffer_load_dword a252, v1, s[60:63], s82 offen
v_mfma_f32_16x16x32_bf16 v[248:251], a[116:119], a[28:31], v[248:251]
ds_read_b64_tr_b16 a[106:107], v10 offset:33792
v_mul_f32 v18, v18, v20
v_mfma_f32_16x16x32_bf16 v[212:215], a[116:119], a[20:23], v[212:215]
ds_read_b64_tr_b16 a[108:109], v10 offset:40960
v_mul_f32 v19, v19, v21
v_mfma_f32_16x16x32_bf16 v[212:215], a[112:115], a[16:19], v[212:215]
s_add_u32 m0, s77, 82944
ds_read_b64_tr_b16 a[110:111], v10 offset:41984
v_cvt_pk_bf16_f32 v18, v18, v19
v_mfma_f32_16x16x32_bf16 v[204:207], a[112:115], a[8:11], v[204:207]
s_add_u32 s64, s71, 3178496
v_lshlrev_b32 v19, 16, v18
v_and_b32 v18, 0xffff0000, v18
v_mfma_f32_16x16x32_bf16 v[204:207], a[116:119], a[12:15], v[204:207]
buffer_load_dwordx4 v14, s[40:43], s64 offen lds
v_mfma_f32_16x16x32_bf16 v[196:199], a[116:119], a[4:7], v[196:199]
v_add_f32 v17, v17, v19
v_add_f32 v17, v17, v18
v_mfma_f32_16x16x32_bf16 v[196:199], a[112:115], a[0:3], v[196:199]
ds_read_b64_tr_b16 a[112:113], v11 offset:32768
v_accvgpr_read_b32 v19, a156
v_mfma_f32_16x16x32_bf16 v[188:191], a[72:75], a[0:3], v[188:191]
ds_read_b64_tr_b16 a[114:115], v11 offset:33792
v_accvgpr_read_b32 v21, a172
v_mfma_f32_16x16x32_bf16 v[188:191], a[76:79], a[4:7], v[188:191]
ds_read_b64_tr_b16 a[116:117], v11 offset:40960
v_lshlrev_b32 v18, 16, v19
v_mfma_f32_16x16x32_bf16 v[216:219], a[76:79], a[12:15], v[216:219]
ds_read_b64_tr_b16 a[118:119], v11 offset:41984
v_and_b32 v19, 0xffff0000, v19
v_mfma_f32_16x16x32_bf16 v[216:219], a[72:75], a[8:11], v[216:219]
s_add_u32 m0, s77, 83968
v_lshlrev_b32 v20, 16, v21
v_and_b32 v21, 0xffff0000, v21
v_mfma_f32_16x16x32_bf16 v[224:227], a[72:75], a[16:19], v[224:227]
s_add_u32 s64, s71, 3211264
v_mul_f32 v18, v18, v20
v_mul_f32 v19, v19, v21
v_mfma_f32_16x16x32_bf16 v[224:227], a[76:79], a[20:23], v[224:227]
buffer_load_dwordx4 v15, s[40:43], s64 offen lds
v_mfma_f32_16x16x32_bf16 v[232:235], a[76:79], a[28:31], v[232:235]
v_cvt_pk_bf16_f32 v18, v18, v19
v_lshlrev_b32 v19, 16, v18
v_mfma_f32_16x16x32_bf16 v[232:235], a[72:75], a[24:27], v[232:235]
ds_read_b64_tr_b16 a[72:73], v4 offset:49152
v_and_b32 v18, 0xffff0000, v18
v_mfma_f32_16x16x32_bf16 v[240:243], a[80:83], a[24:27], v[240:243]
ds_read_b64_tr_b16 a[74:75], v4 offset:50176
v_add_f32 v17, v17, v19
v_mfma_f32_16x16x32_bf16 v[240:243], a[84:87], a[28:31], v[240:243]
ds_read_b64_tr_b16 a[76:77], v4 offset:57344
v_add_f32 v17, v17, v18
v_mfma_f32_16x16x32_bf16 v[252:255], a[84:87], a[20:23], v[252:255]
ds_read_b64_tr_b16 a[78:79], v4 offset:58368
v_accvgpr_read_b32 v19, a157
v_mfma_f32_16x16x32_bf16 v[252:255], a[80:83], a[16:19], v[252:255]
s_add_u32 m0, s77, 84992
v_accvgpr_read_b32 v21, a173
v_lshlrev_b32 v18, 16, v19
v_mfma_f32_16x16x32_bf16 v[244:247], a[80:83], a[8:11], v[244:247]
s_add_u32 s64, s71, 3244032
v_and_b32 v19, 0xffff0000, v19
v_lshlrev_b32 v20, 16, v21
v_mfma_f32_16x16x32_bf16 v[244:247], a[84:87], a[12:15], v[244:247]
buffer_load_dwordx4 v15, s[40:43], s64 offen lds
v_mfma_f32_16x16x32_bf16 v[236:239], a[84:87], a[4:7], v[236:239]
v_and_b32 v21, 0xffff0000, v21
v_mul_f32 v18, v18, v20
v_mfma_f32_16x16x32_bf16 v[236:239], a[80:83], a[0:3], v[236:239]
s_waitcnt lgkmcnt(4)
ds_read_b64_tr_b16 a[80:81], v5 offset:49152
v_mul_f32 v19, v19, v21
v_mfma_f32_16x16x32_bf16 v[228:231], a[88:91], a[0:3], v[228:231]
ds_read_b64_tr_b16 a[82:83], v5 offset:50176
v_cvt_pk_bf16_f32 v18, v18, v19
v_mfma_f32_16x16x32_bf16 v[228:231], a[92:95], a[4:7], v[228:231]
ds_read_b64_tr_b16 a[84:85], v5 offset:57344
v_lshlrev_b32 v19, 16, v18
v_mfma_f32_16x16x32_bf16 v[220:223], a[92:95], a[12:15], v[220:223]
ds_read_b64_tr_b16 a[86:87], v5 offset:58368
v_and_b32 v18, 0xffff0000, v18
v_mfma_f32_16x16x32_bf16 v[220:223], a[88:91], a[8:11], v[220:223]
v_add_f32 v17, v17, v19
v_add_f32 v17, v17, v18
v_mfma_f32_16x16x32_bf16 v[152:155], a[88:91], a[16:19], v[152:155]
v_accvgpr_read_b32 v19, a158
v_accvgpr_read_b32 v21, a174
v_mfma_f32_16x16x32_bf16 v[152:155], a[92:95], a[20:23], v[152:155]
v_lshlrev_b32 v18, 16, v19
v_and_b32 v19, 0xffff0000, v19
v_mfma_f32_16x16x32_bf16 v[160:163], a[92:95], a[28:31], v[160:163]
s_add_u32 m0, s76, 0
v_lshlrev_b32 v20, 16, v21
v_and_b32 v21, 0xffff0000, v21
v_mfma_f32_16x16x32_bf16 v[160:163], a[88:91], a[24:27], v[160:163]
s_add_u32 s64, s70, 768
ds_read_b64_tr_b16 a[88:89], v6 offset:49152
v_mul_f32 v18, v18, v20
v_mfma_f32_16x16x32_bf16 v[168:171], a[96:99], a[24:27], v[168:171]
buffer_load_dwordx4 v12, s[32:35], s64 offen lds
v_mfma_f32_16x16x32_bf16 v[168:171], a[100:103], a[28:31], v[168:171]
ds_read_b64_tr_b16 a[90:91], v6 offset:50176
v_mul_f32 v19, v19, v21
v_mfma_f32_16x16x32_bf16 v[176:179], a[100:103], a[20:23], v[176:179]
ds_read_b64_tr_b16 a[92:93], v6 offset:57344
v_cvt_pk_bf16_f32 v18, v18, v19
v_mfma_f32_16x16x32_bf16 v[176:179], a[96:99], a[16:19], v[176:179]
ds_read_b64_tr_b16 a[94:95], v6 offset:58368
v_lshlrev_b32 v19, 16, v18
v_mfma_f32_16x16x32_bf16 v[180:183], a[96:99], a[8:11], v[180:183]
v_and_b32 v18, 0xffff0000, v18
v_add_f32 v17, v17, v19
v_mfma_f32_16x16x32_bf16 v[180:183], a[100:103], a[12:15], v[180:183]
s_add_u32 m0, s76, 1024
v_add_f32 v17, v17, v18
v_accvgpr_read_b32 v19, a159
v_mfma_f32_16x16x32_bf16 v[172:175], a[100:103], a[4:7], v[172:175]
s_add_u32 s64, s70, 8960
v_accvgpr_read_b32 v21, a175
v_lshlrev_b32 v18, 16, v19
v_mfma_f32_16x16x32_bf16 v[172:175], a[96:99], a[0:3], v[172:175]
buffer_load_dwordx4 v13, s[32:35], s64 offen lds
v_mfma_f32_16x16x32_bf16 v[164:167], a[104:107], a[0:3], v[164:167]
ds_read_b64_tr_b16 a[96:97], v7 offset:49152
v_and_b32 v19, 0xffff0000, v19
v_mfma_f32_16x16x32_bf16 v[164:167], a[108:111], a[4:7], v[164:167]
ds_read_b64_tr_b16 a[98:99], v7 offset:50176
v_lshlrev_b32 v20, 16, v21
v_mfma_f32_16x16x32_bf16 v[156:159], a[108:111], a[12:15], v[156:159]
ds_read_b64_tr_b16 a[100:101], v7 offset:57344
v_and_b32 v21, 0xffff0000, v21
v_mfma_f32_16x16x32_bf16 v[156:159], a[104:107], a[8:11], v[156:159]
s_add_u32 s81, s81, 1048576
ds_read_b64_tr_b16 a[102:103], v7 offset:58368
v_mul_f32 v18, v18, v20
v_mfma_f32_16x16x32_bf16 v[24:27], a[104:107], a[16:19], v[24:27]
s_add_u32 m0, s76, 2048
buffer_load_dword a252, v16, s[56:59], s81 offen
v_mfma_f32_16x16x32_bf16 v[24:27], a[108:111], a[20:23], v[24:27]
s_add_u32 s64, s70, 17152
v_mul_f32 v19, v19, v21
v_cvt_pk_bf16_f32 v18, v18, v19
v_mfma_f32_16x16x32_bf16 v[40:43], a[108:111], a[28:31], v[40:43]
s_waitcnt vmcnt(14)
buffer_load_dwordx4 v12, s[32:35], s64 offen lds
v_mfma_f32_16x16x32_bf16 v[40:43], a[104:107], a[24:27], v[40:43]
ds_read_b64_tr_b16 a[104:105], v8 offset:49152
v_lshlrev_b32 v19, 16, v18
v_mfma_f32_16x16x32_bf16 v[56:59], a[112:115], a[24:27], v[56:59]
ds_read_b64_tr_b16 a[106:107], v8 offset:50176
v_and_b32 v18, 0xffff0000, v18
v_mfma_f32_16x16x32_bf16 v[56:59], a[116:119], a[28:31], v[56:59]
ds_read_b64_tr_b16 a[108:109], v8 offset:57344
v_add_u32 v4, 0x8000, v4
v_mfma_f32_16x16x32_bf16 v[72:75], a[116:119], a[20:23], v[72:75]
ds_read_b64_tr_b16 a[110:111], v8 offset:58368
v_add_f32 v17, v17, v19
v_mfma_f32_16x16x32_bf16 v[72:75], a[112:115], a[16:19], v[72:75]
s_add_u32 m0, s76, 3072
ds_read_b128 a[32:35], v2 offset:32768
v_add_f32 v17, v17, v18
v_mfma_f32_16x16x32_bf16 v[136:139], a[112:115], a[8:11], v[136:139]
s_add_u32 s64, s70, 25344
ds_read_b128 a[36:39], v3 offset:32768
v_mfma_f32_16x16x32_bf16 v[136:139], a[116:119], a[12:15], v[136:139]
buffer_load_dwordx4 v13, s[32:35], s64 offen lds
v_mfma_f32_16x16x32_bf16 v[120:123], a[116:119], a[4:7], v[120:123]
ds_read_b128 a[40:43], v2 offset:34816
v_add_f32_dpp v17, v17, v17 row_ror:8 row_mask:0xf bank_mask:0xf
v_mfma_f32_16x16x32_bf16 v[120:123], a[112:115], a[0:3], v[120:123]
s_waitcnt lgkmcnt(7)
ds_read_b128 a[44:47], v3 offset:34816
v_mfma_f32_16x16x32_bf16 v[104:107], a[0:3], a[72:75], v[104:107]
ds_read_b128 a[48:51], v2 offset:36864
v_add_f32_dpp v17, v17, v17 row_ror:4 row_mask:0xf bank_mask:0xf
v_mfma_f32_16x16x32_bf16 v[104:107], a[4:7], a[76:79], v[104:107]
ds_read_b128 a[52:55], v3 offset:36864
v_add_u32 v5, 0x8000, v5
v_mfma_f32_16x16x32_bf16 v[88:91], a[12:15], a[76:79], v[88:91]
s_add_u32 m0, s76, 4096
ds_read_b128 a[56:59], v2 offset:38912
v_add_f32_dpp v17, v17, v17 row_ror:2 row_mask:0xf bank_mask:0xf
v_mfma_f32_16x16x32_bf16 v[88:91], a[8:11], a[72:75], v[88:91]
s_add_u32 s64, s70, 33536
ds_read_b128 a[60:63], v3 offset:38912
v_mfma_f32_16x16x32_bf16 v[28:31], a[16:19], a[72:75], v[28:31]
buffer_load_dwordx4 v12, s[32:35], s64 offen lds
v_mfma_f32_16x16x32_bf16 v[28:31], a[20:23], a[76:79], v[28:31]
ds_read_b64_tr_b16 a[112:113], v9 offset:49152
v_add_f32_dpp v17, v17, v17 row_ror:1 row_mask:0xf bank_mask:0xf
v_mfma_f32_16x16x32_bf16 v[44:47], a[28:31], a[76:79], v[44:47]
ds_read_b64_tr_b16 a[114:115], v9 offset:50176
v_mov_b32 v18, v17
v_mfma_f32_16x16x32_bf16 v[44:47], a[24:27], a[72:75], v[44:47]
ds_read_b64_tr_b16 a[116:117], v9 offset:57344
v_mfma_f32_16x16x32_bf16 v[60:63], a[24:27], a[80:83], v[60:63]
ds_read_b64_tr_b16 a[118:119], v9 offset:58368
v_permlane16_swap_b32 v18, v17
v_mfma_f32_16x16x32_bf16 v[60:63], a[28:31], a[84:87], v[60:63]
s_add_u32 m0, s76, 5120
ds_read_b64_tr_b16 a[72:73], v10 offset:49152
v_add_u32 v6, 0x8000, v6
v_mfma_f32_16x16x32_bf16 v[76:79], a[20:23], a[84:87], v[76:79]
s_add_u32 s64, s70, 41728
ds_read_b64_tr_b16 a[74:75], v10 offset:50176
v_add_f32 v17, v17, v18
v_mfma_f32_16x16x32_bf16 v[76:79], a[16:19], a[80:83], v[76:79]
buffer_load_dwordx4 v13, s[32:35], s64 offen lds
v_mfma_f32_16x16x32_bf16 v[140:143], a[8:11], a[80:83], v[140:143]
ds_read_b64_tr_b16 a[76:77], v10 offset:57344
v_cvt_pk_bf16_f32 v17, v17, v17
v_mfma_f32_16x16x32_bf16 v[140:143], a[12:15], a[84:87], v[140:143]
ds_read_b64_tr_b16 a[78:79], v10 offset:58368
v_and_b32 v17, 0xffff0000, v17
v_mfma_f32_16x16x32_bf16 v[124:127], a[4:7], a[84:87], v[124:127]
v_mul_f32 v17, 0xbfb8aa3b, v17
v_mfma_f32_16x16x32_bf16 v[124:127], a[0:3], a[80:83], v[124:127]
s_add_u32 m0, s76, 6144
ds_read_b64_tr_b16 a[80:81], v11 offset:49152
v_mfma_f32_16x16x32_bf16 v[108:111], a[0:3], a[88:91], v[108:111]
s_add_u32 s64, s70, 49920
ds_read_b64_tr_b16 a[82:83], v11 offset:50176
v_mfma_f32_16x16x32_bf16 v[108:111], a[4:7], a[92:95], v[108:111]
ds_read_b64_tr_b16 a[84:85], v11 offset:57344
v_add_u32 v7, 0x8000, v7
v_mfma_f32_16x16x32_bf16 v[92:95], a[12:15], a[92:95], v[92:95]
buffer_load_dwordx4 v12, s[32:35], s64 offen lds
v_mfma_f32_16x16x32_bf16 v[92:95], a[8:11], a[88:91], v[92:95]
ds_read_b64_tr_b16 a[86:87], v11 offset:58368
v_mfma_f32_16x16x32_bf16 v[32:35], a[16:19], a[88:91], v[32:35]
v_exp_f32 v17, v17
v_mfma_f32_16x16x32_bf16 v[32:35], a[20:23], a[92:95], v[32:35]
v_add_f32 v17, 1.0, v17
v_mfma_f32_16x16x32_bf16 v[48:51], a[28:31], a[92:95], v[48:51]
v_rcp_f32 v17, v17
v_mfma_f32_16x16x32_bf16 v[48:51], a[24:27], a[88:91], v[48:51]
s_add_u32 m0, s76, 7168
v_cvt_pk_bf16_f32 v18, v17, v17
v_mfma_f32_16x16x32_bf16 v[64:67], a[24:27], a[96:99], v[64:67]
s_add_u32 s64, s70, 58112
v_and_b32 v18, 0xffff0000, v18
v_mfma_f32_16x16x32_bf16 v[64:67], a[28:31], a[100:103], v[64:67]
buffer_load_dwordx4 v13, s[32:35], s64 offen lds
v_mfma_f32_16x16x32_bf16 v[80:83], a[20:23], a[100:103], v[80:83]
v_add_u32 v8, 0x8000, v8
v_sub_f32 v19, 1.0, v18
v_mfma_f32_16x16x32_bf16 v[80:83], a[16:19], a[96:99], v[80:83]
v_cvt_pk_bf16_f32 v19, v19, v19
v_mfma_f32_16x16x32_bf16 v[144:147], a[8:11], a[96:99], v[144:147]
v_and_b32 v19, 0xffff0000, v19
v_mfma_f32_16x16x32_bf16 v[144:147], a[12:15], a[100:103], v[144:147]
v_and_b32 v20, 31, v0
v_mfma_f32_16x16x32_bf16 v[128:131], a[4:7], a[100:103], v[128:131]
v_add_u32 v9, 0x8000, v9
v_add_u32 v10, 0x8000, v10
v_mfma_f32_16x16x32_bf16 v[128:131], a[0:3], a[96:99], v[128:131]
s_waitcnt lgkmcnt(0)
s_add_u32 s82, s82, 1048576
v_add_u32 v11, 0x8000, v11
v_lshlrev_b32 v20, 27, v20
v_mfma_f32_16x16x32_bf16 v[112:115], a[0:3], a[104:107], v[112:115]
buffer_load_dword a252, v1, s[60:63], s82 offen
v_mfma_f32_16x16x32_bf16 v[112:115], a[4:7], a[108:111], v[112:115]
v_lshrrev_b32 v21, 2, v0
v_mfma_f32_16x16x32_bf16 v[96:99], a[12:15], a[108:111], v[96:99]
s_waitcnt lgkmcnt(0)
s_barrier
v_mfma_f32_16x16x32_bf16 v[96:99], a[8:11], a[104:107], v[96:99]
s_add_u32 m0, s77, 98304
ds_read_b64_tr_b16 a[88:89], v4 offset:32768
v_add_u32 v20, v20, v21
v_mfma_f32_16x16x32_bf16 v[36:39], a[16:19], a[104:107], v[36:39]
s_add_u32 s64, s71, 3670016
ds_read_b64_tr_b16 a[90:91], v4 offset:33792
v_mfma_f32_16x16x32_bf16 v[36:39], a[20:23], a[108:111], v[36:39]
buffer_load_dwordx4 v14, s[36:39], s64 offen lds
v_mfma_f32_16x16x32_bf16 v[52:55], a[28:31], a[108:111], v[52:55]
ds_read_b64_tr_b16 a[92:93], v4 offset:40960
v_mfma_f32_16x16x32_bf16 v[52:55], a[24:27], a[104:107], v[52:55]
ds_read_b64_tr_b16 a[94:95], v4 offset:41984
v_mfma_f32_16x16x32_bf16 v[68:71], a[24:27], a[112:115], v[68:71]
ds_read_b64_tr_b16 a[96:97], v5 offset:32768
v_mfma_f32_16x16x32_bf16 v[68:71], a[28:31], a[116:119], v[68:71]
ds_read_b64_tr_b16 a[98:99], v5 offset:33792
v_mfma_f32_16x16x32_bf16 v[84:87], a[20:23], a[116:119], v[84:87]
ds_read_b64_tr_b16 a[100:101], v5 offset:40960
v_mfma_f32_16x16x32_bf16 v[84:87], a[16:19], a[112:115], v[84:87]
s_add_u32 m0, s77, 99328
ds_read_b64_tr_b16 a[102:103], v5 offset:41984
v_mfma_f32_16x16x32_bf16 v[148:151], a[8:11], a[112:115], v[148:151]
s_add_u32 s64, s71, 3702784
ds_read_b64_tr_b16 a[104:105], v6 offset:32768
v_mfma_f32_16x16x32_bf16 v[148:151], a[12:15], a[116:119], v[148:151]
buffer_load_dwordx4 v14, s[36:39], s64 offen lds
v_mfma_f32_16x16x32_bf16 v[132:135], a[4:7], a[116:119], v[132:135]
ds_read_b64_tr_b16 a[106:107], v6 offset:33792
v_mfma_f32_16x16x32_bf16 v[132:135], a[0:3], a[112:115], v[132:135]
ds_read_b64_tr_b16 a[108:109], v6 offset:40960
v_mfma_f32_16x16x32_bf16 v[116:119], a[0:3], a[72:75], v[116:119]
ds_read_b64_tr_b16 a[110:111], v6 offset:41984
v_mfma_f32_16x16x32_bf16 v[116:119], a[4:7], a[76:79], v[116:119]
ds_read_b64_tr_b16 a[112:113], v7 offset:32768
v_mfma_f32_16x16x32_bf16 v[100:103], a[12:15], a[76:79], v[100:103]
ds_read_b64_tr_b16 a[114:115], v7 offset:33792
v_mfma_f32_16x16x32_bf16 v[100:103], a[8:11], a[72:75], v[100:103]
s_add_u32 m0, s77, 100352
ds_read_b64_tr_b16 a[116:117], v7 offset:40960
v_mfma_f32_16x16x32_bf16 a[120:123], a[16:19], a[72:75], a[120:123]
s_add_u32 s64, s71, 3735552
s_lshl2_add_u32 s65, s2, s30
ds_read_b64_tr_b16 a[118:119], v7 offset:41984
v_mfma_f32_16x16x32_bf16 a[120:123], a[20:23], a[76:79], a[120:123]
s_lshl4_add_u32 s65, s65, 58720256
buffer_load_dwordx4 v15, s[36:39], s64 offen lds
v_mfma_f32_16x16x32_bf16 a[124:127], a[28:31], a[76:79], a[124:127]
buffer_store_dwordx2 v[18:19], v20, s[44:47], s65 offen sc1
v_mfma_f32_16x16x32_bf16 a[124:127], a[24:27], a[72:75], a[124:127]
s_lshr_b32 s66, s30, 1
ds_read_b64_tr_b16 a[72:73], v8 offset:32768
v_mfma_f32_16x16x32_bf16 a[128:131], a[24:27], a[80:83], a[128:131]
s_lshl_b32 s66, s66, 11
ds_read_b64_tr_b16 a[74:75], v8 offset:33792
v_mfma_f32_16x16x32_bf16 a[128:131], a[28:31], a[84:87], a[128:131]
s_add_u32 s66, s66, 126976
ds_read_b64_tr_b16 a[76:77], v8 offset:40960
v_mfma_f32_16x16x32_bf16 a[132:135], a[20:23], a[84:87], a[132:135]
s_sub_u32 s66, s66, s76
ds_read_b64_tr_b16 a[78:79], v8 offset:41984
v_mfma_f32_16x16x32_bf16 a[132:135], a[16:19], a[80:83], a[132:135]
s_add_u32 m0, s77, 101376
v_add_u32 v17, s66, v2
v_mfma_f32_16x16x32_bf16 a[136:139], a[8:11], a[80:83], a[136:139]
s_add_u32 s64, s71, 3768320
v_xor_b32 v18, 64, v17
v_mfma_f32_16x16x32_bf16 a[136:139], a[12:15], a[84:87], a[136:139]
buffer_load_dwordx4 v15, s[36:39], s64 offen lds
v_mfma_f32_16x16x32_bf16 a[140:143], a[4:7], a[84:87], a[140:143]
v_lshrrev_b32 v21, 4, v0
v_mfma_f32_16x16x32_bf16 a[140:143], a[0:3], a[80:83], a[140:143]
s_waitcnt lgkmcnt(4)
ds_read_b64_tr_b16 a[80:81], v9 offset:32768
v_bfe_u32 v19, v0, 2, 2
v_mfma_f32_16x16x32_bf16 v[184:187], a[88:91], a[32:35], v[184:187]
ds_read_b64_tr_b16 a[82:83], v9 offset:33792
v_lshl_add_u32 v19, v21, 3, v19
v_mfma_f32_16x16x32_bf16 v[184:187], a[92:95], a[36:39], v[184:187]
ds_read_b64_tr_b16 a[84:85], v9 offset:40960
v_lshlrev_b32 v19, 6, v19
v_mfma_f32_16x16x32_bf16 v[192:195], a[92:95], a[44:47], v[192:195]
ds_read_b64_tr_b16 a[86:87], v9 offset:41984
v_and_b32 v21, 1, v21
v_mfma_f32_16x16x32_bf16 v[192:195], a[88:91], a[40:43], v[192:195]
s_add_u32 m0, s77, 114688
s_add_u32 s17, s78, .-L_pc+6144
v_lshl_add_u32 v19, v21, 5, v19
v_mfma_f32_16x16x32_bf16 v[200:203], a[88:91], a[48:51], v[200:203]
s_add_u32 s64, s71, 3670016
buffer_load_dword a252, v16, s[88:91], s17 offen
v_mfma_f32_16x16x32_bf16 v[200:203], a[92:95], a[52:55], v[200:203]
buffer_load_dwordx4 v14, s[40:43], s64 offen lds
v_mfma_f32_16x16x32_bf16 v[208:211], a[92:95], a[60:63], v[208:211]
v_and_b32 v21, 3, v0
v_mfma_f32_16x16x32_bf16 v[208:211], a[88:91], a[56:59], v[208:211]
ds_read_b64_tr_b16 a[88:89], v10 offset:32768
v_lshl_add_u32 v19, v21, 3, v19
v_mfma_f32_16x16x32_bf16 v[248:251], a[96:99], a[56:59], v[248:251]
ds_read_b64_tr_b16 a[90:91], v10 offset:33792
v_add_u32 v19, 114688, v19
v_mfma_f32_16x16x32_bf16 v[248:251], a[100:103], a[60:63], v[248:251]
ds_read_b64_tr_b16 a[92:93], v10 offset:40960
v_xor_b32 v20, 32, v19
v_mfma_f32_16x16x32_bf16 v[212:215], a[100:103], a[52:55], v[212:215]
s_and_b32 s66, s30, 1
ds_read_b64_tr_b16 a[94:95], v10 offset:41984
v_mfma_f32_16x16x32_bf16 v[212:215], a[96:99], a[48:51], v[212:215]
s_lshl_b32 s67, s66, 5
s_add_u32 m0, s77, 115712
s_add_u32 s81, s81, 1048576
v_mfma_f32_16x16x32_bf16 v[204:207], a[96:99], a[40:43], v[204:207]
s_add_u32 s64, s71, 3702784
buffer_load_dword a252, v16, s[56:59], s81 offen
v_mfma_f32_16x16x32_bf16 v[204:207], a[100:103], a[44:47], v[204:207]
buffer_load_dwordx4 v14, s[40:43], s64 offen lds
v_mfma_f32_16x16x32_bf16 v[196:199], a[100:103], a[36:39], v[196:199]
v_xor_b32 v21, s67, v19
v_mfma_f32_16x16x32_bf16 v[196:199], a[96:99], a[32:35], v[196:199]
ds_read_b64_tr_b16 a[96:97], v11 offset:32768
v_mfma_f32_16x16x32_bf16 v[188:191], a[104:107], a[32:35], v[188:191]
ds_read_b64_tr_b16 a[98:99], v11 offset:33792
v_mfma_f32_16x16x32_bf16 v[188:191], a[108:111], a[36:39], v[188:191]
ds_read_b64_tr_b16 a[100:101], v11 offset:40960
v_mfma_f32_16x16x32_bf16 v[216:219], a[108:111], a[44:47], v[216:219]
ds_read_b64_tr_b16 a[102:103], v11 offset:41984
v_mfma_f32_16x16x32_bf16 v[216:219], a[104:107], a[40:43], v[216:219]
s_add_u32 m0, s77, 116736
v_mfma_f32_16x16x32_bf16 v[224:227], a[104:107], a[48:51], v[224:227]
s_add_u32 s64, s71, 3735552
v_mfma_f32_16x16x32_bf16 v[224:227], a[108:111], a[52:55], v[224:227]
buffer_load_dwordx4 v15, s[40:43], s64 offen lds
v_mfma_f32_16x16x32_bf16 v[232:235], a[108:111], a[60:63], v[232:235]
v_mfma_f32_16x16x32_bf16 v[232:235], a[104:107], a[56:59], v[232:235]
ds_read_b64_tr_b16 a[104:105], v4 offset:49152
v_mfma_f32_16x16x32_bf16 v[240:243], a[112:115], a[56:59], v[240:243]
ds_read_b64_tr_b16 a[106:107], v4 offset:50176
v_mfma_f32_16x16x32_bf16 v[240:243], a[116:119], a[60:63], v[240:243]
ds_read_b64_tr_b16 a[108:109], v4 offset:57344
v_mfma_f32_16x16x32_bf16 v[252:255], a[116:119], a[52:55], v[252:255]
ds_read_b64_tr_b16 a[110:111], v4 offset:58368
v_mfma_f32_16x16x32_bf16 v[252:255], a[112:115], a[48:51], v[252:255]
s_add_u32 m0, s77, 117760
v_mfma_f32_16x16x32_bf16 v[244:247], a[112:115], a[40:43], v[244:247]
s_add_u32 s64, s71, 3768320
v_mfma_f32_16x16x32_bf16 v[244:247], a[116:119], a[44:47], v[244:247]
buffer_load_dwordx4 v15, s[40:43], s64 offen lds
v_mfma_f32_16x16x32_bf16 v[236:239], a[116:119], a[36:39], v[236:239]
v_mfma_f32_16x16x32_bf16 v[236:239], a[112:115], a[32:35], v[236:239]
s_waitcnt lgkmcnt(4)
ds_read_b64_tr_b16 a[112:113], v5 offset:49152
v_mfma_f32_16x16x32_bf16 v[228:231], a[72:75], a[32:35], v[228:231]
ds_read_b64_tr_b16 a[114:115], v5 offset:50176
v_mfma_f32_16x16x32_bf16 v[228:231], a[76:79], a[36:39], v[228:231]
ds_read_b64_tr_b16 a[116:117], v5 offset:57344
v_mfma_f32_16x16x32_bf16 v[220:223], a[76:79], a[44:47], v[220:223]
ds_read_b64_tr_b16 a[118:119], v5 offset:58368
v_mfma_f32_16x16x32_bf16 v[220:223], a[72:75], a[40:43], v[220:223]
v_mfma_f32_16x16x32_bf16 v[152:155], a[72:75], a[48:51], v[152:155]
v_mfma_f32_16x16x32_bf16 v[152:155], a[76:79], a[52:55], v[152:155]
v_mfma_f32_16x16x32_bf16 v[160:163], a[76:79], a[60:63], v[160:163]
s_add_u32 m0, s76, 32768
v_mfma_f32_16x16x32_bf16 v[160:163], a[72:75], a[56:59], v[160:163]
s_add_u32 s64, s70, 896
ds_read_b64_tr_b16 a[72:73], v6 offset:49152
v_mfma_f32_16x16x32_bf16 v[168:171], a[80:83], a[56:59], v[168:171]
buffer_load_dwordx4 v12, s[32:35], s64 offen lds
v_mfma_f32_16x16x32_bf16 v[168:171], a[84:87], a[60:63], v[168:171]
ds_read_b64_tr_b16 a[74:75], v6 offset:50176
v_mfma_f32_16x16x32_bf16 v[176:179], a[84:87], a[52:55], v[176:179]
ds_read_b64_tr_b16 a[76:77], v6 offset:57344
v_mfma_f32_16x16x32_bf16 v[176:179], a[80:83], a[48:51], v[176:179]
ds_read_b64_tr_b16 a[78:79], v6 offset:58368
v_mfma_f32_16x16x32_bf16 v[180:183], a[80:83], a[40:43], v[180:183]
v_mfma_f32_16x16x32_bf16 v[180:183], a[84:87], a[44:47], v[180:183]
s_add_u32 m0, s76, 33792
v_mfma_f32_16x16x32_bf16 v[172:175], a[84:87], a[36:39], v[172:175]
s_add_u32 s64, s70, 9088
v_mfma_f32_16x16x32_bf16 v[172:175], a[80:83], a[32:35], v[172:175]
buffer_load_dwordx4 v13, s[32:35], s64 offen lds
v_mfma_f32_16x16x32_bf16 v[164:167], a[88:91], a[32:35], v[164:167]
ds_read_b64_tr_b16 a[80:81], v7 offset:49152
v_mfma_f32_16x16x32_bf16 v[164:167], a[92:95], a[36:39], v[164:167]
ds_read_b64_tr_b16 a[82:83], v7 offset:50176
v_mfma_f32_16x16x32_bf16 v[156:159], a[92:95], a[44:47], v[156:159]
ds_read_b64_tr_b16 a[84:85], v7 offset:57344
v_mfma_f32_16x16x32_bf16 v[156:159], a[88:91], a[40:43], v[156:159]
ds_read_b64_tr_b16 a[86:87], v7 offset:58368
v_mfma_f32_16x16x32_bf16 v[24:27], a[88:91], a[48:51], v[24:27]
s_add_u32 m0, s76, 34816
v_mfma_f32_16x16x32_bf16 v[24:27], a[92:95], a[52:55], v[24:27]
s_add_u32 s64, s70, 17280
v_mfma_f32_16x16x32_bf16 v[40:43], a[92:95], a[60:63], v[40:43]
s_waitcnt vmcnt(14)
buffer_load_dwordx4 v12, s[32:35], s64 offen lds
v_mfma_f32_16x16x32_bf16 v[40:43], a[88:91], a[56:59], v[40:43]
s_add_u32 s81, s81, 1048576
ds_read_b64_tr_b16 a[88:89], v8 offset:49152
v_mfma_f32_16x16x32_bf16 v[56:59], a[96:99], a[56:59], v[56:59]
buffer_load_dword a252, v16, s[56:59], s81 offen
v_mfma_f32_16x16x32_bf16 v[56:59], a[100:103], a[60:63], v[56:59]
ds_read_b64_tr_b16 a[90:91], v8 offset:50176
v_subrev_u32 v4, 0x8000, v4
v_mfma_f32_16x16x32_bf16 v[72:75], a[100:103], a[52:55], v[72:75]
ds_read_b64_tr_b16 a[92:93], v8 offset:57344
v_mfma_f32_16x16x32_bf16 v[72:75], a[96:99], a[48:51], v[72:75]
s_add_u32 m0, s76, 35840
ds_read_b64_tr_b16 a[94:95], v8 offset:58368
v_mfma_f32_16x16x32_bf16 v[136:139], a[96:99], a[40:43], v[136:139]
s_add_u32 s64, s70, 25472
ds_read_b128 a[0:3], v2 offset:0
v_mfma_f32_16x16x32_bf16 v[136:139], a[100:103], a[44:47], v[136:139]
buffer_load_dwordx4 v13, s[32:35], s64 offen lds
v_mfma_f32_16x16x32_bf16 v[120:123], a[100:103], a[36:39], v[120:123]
ds_read_b128 a[4:7], v3 offset:0
v_mfma_f32_16x16x32_bf16 v[120:123], a[96:99], a[32:35], v[120:123]
s_waitcnt lgkmcnt(6)
ds_read_b128 a[8:11], v2 offset:2048
v_mfma_f32_16x16x32_bf16 v[104:107], a[32:35], a[104:107], v[104:107]
ds_read_b128 a[12:15], v3 offset:2048
v_mfma_f32_16x16x32_bf16 v[104:107], a[36:39], a[108:111], v[104:107]
ds_read_b128 a[16:19], v2 offset:4096
v_subrev_u32 v5, 0x8000, v5
v_mfma_f32_16x16x32_bf16 v[88:91], a[44:47], a[108:111], v[88:91]
s_add_u32 m0, s76, 36864
ds_read_b128 a[20:23], v3 offset:4096
v_mfma_f32_16x16x32_bf16 v[88:91], a[40:43], a[104:107], v[88:91]
s_add_u32 s64, s70, 33664
ds_read_b128 a[24:27], v2 offset:6144
v_mfma_f32_16x16x32_bf16 v[28:31], a[48:51], a[104:107], v[28:31]
buffer_load_dwordx4 v12, s[32:35], s64 offen lds
v_mfma_f32_16x16x32_bf16 v[28:31], a[52:55], a[108:111], v[28:31]
ds_read_b128 a[28:31], v3 offset:6144
v_mfma_f32_16x16x32_bf16 v[44:47], a[60:63], a[108:111], v[44:47]
ds_read_b64_tr_b16 a[96:97], v9 offset:49152
v_mfma_f32_16x16x32_bf16 v[44:47], a[56:59], a[104:107], v[44:47]
ds_read_b64_tr_b16 a[98:99], v9 offset:50176
v_mfma_f32_16x16x32_bf16 v[60:63], a[56:59], a[112:115], v[60:63]
s_add_u32 m0, s76, 37888
ds_read_b64_tr_b16 a[100:101], v9 offset:57344
v_mfma_f32_16x16x32_bf16 v[60:63], a[60:63], a[116:119], v[60:63]
ds_read_b64_tr_b16 a[102:103], v9 offset:58368
v_subrev_u32 v6, 0x8000, v6
v_mfma_f32_16x16x32_bf16 v[76:79], a[52:55], a[116:119], v[76:79]
s_add_u32 s64, s70, 41856
ds_read_b64_tr_b16 a[104:105], v10 offset:49152
v_mfma_f32_16x16x32_bf16 v[76:79], a[48:51], a[112:115], v[76:79]
buffer_load_dwordx4 v13, s[32:35], s64 offen lds
v_mfma_f32_16x16x32_bf16 v[140:143], a[40:43], a[112:115], v[140:143]
ds_read_b64_tr_b16 a[106:107], v10 offset:50176
v_mfma_f32_16x16x32_bf16 v[140:143], a[44:47], a[116:119], v[140:143]
ds_read_b64_tr_b16 a[108:109], v10 offset:57344
v_mfma_f32_16x16x32_bf16 v[124:127], a[36:39], a[116:119], v[124:127]
ds_read_b64_tr_b16 a[110:111], v10 offset:58368
v_mfma_f32_16x16x32_bf16 v[124:127], a[32:35], a[112:115], v[124:127]
s_add_u32 m0, s76, 38912
ds_read_b64_tr_b16 a[112:113], v11 offset:49152
v_mfma_f32_16x16x32_bf16 v[108:111], a[32:35], a[72:75], v[108:111]
s_add_u32 s64, s70, 50048
ds_read_b64_tr_b16 a[114:115], v11 offset:50176
v_mfma_f32_16x16x32_bf16 v[108:111], a[36:39], a[76:79], v[108:111]
ds_read_b64_tr_b16 a[116:117], v11 offset:57344
v_subrev_u32 v7, 0x8000, v7
v_mfma_f32_16x16x32_bf16 v[92:95], a[44:47], a[76:79], v[92:95]
buffer_load_dwordx4 v12, s[32:35], s64 offen lds
v_mfma_f32_16x16x32_bf16 v[92:95], a[40:43], a[72:75], v[92:95]
ds_read_b64_tr_b16 a[118:119], v11 offset:58368
v_mfma_f32_16x16x32_bf16 v[32:35], a[48:51], a[72:75], v[32:35]
v_mfma_f32_16x16x32_bf16 v[32:35], a[52:55], a[76:79], v[32:35]
v_mfma_f32_16x16x32_bf16 v[48:51], a[60:63], a[76:79], v[48:51]
v_mfma_f32_16x16x32_bf16 v[48:51], a[56:59], a[72:75], v[48:51]
s_add_u32 m0, s76, 39936
v_mfma_f32_16x16x32_bf16 v[64:67], a[56:59], a[80:83], v[64:67]
s_add_u32 s64, s70, 58240
v_mfma_f32_16x16x32_bf16 v[64:67], a[60:63], a[84:87], v[64:67]
buffer_load_dwordx4 v13, s[32:35], s64 offen lds
v_mfma_f32_16x16x32_bf16 v[80:83], a[52:55], a[84:87], v[80:83]
v_subrev_u32 v8, 0x8000, v8
v_mfma_f32_16x16x32_bf16 v[80:83], a[48:51], a[80:83], v[80:83]
v_mfma_f32_16x16x32_bf16 v[144:147], a[40:43], a[80:83], v[144:147]
v_mfma_f32_16x16x32_bf16 v[144:147], a[44:47], a[84:87], v[144:147]
v_mfma_f32_16x16x32_bf16 v[128:131], a[36:39], a[84:87], v[128:131]
v_subrev_u32 v9, 0x8000, v9
v_subrev_u32 v10, 0x8000, v10
v_mfma_f32_16x16x32_bf16 v[128:131], a[32:35], a[80:83], v[128:131]
s_waitcnt lgkmcnt(0)
v_subrev_u32 v11, 0x8000, v11
v_mfma_f32_16x16x32_bf16 v[112:115], a[32:35], a[88:91], v[112:115]
v_mfma_f32_16x16x32_bf16 v[112:115], a[36:39], a[92:95], v[112:115]
s_add_u32 s82, s82, 1048576
v_mfma_f32_16x16x32_bf16 v[96:99], a[44:47], a[92:95], v[96:99]
s_waitcnt lgkmcnt(0)
s_barrier
v_mfma_f32_16x16x32_bf16 v[96:99], a[40:43], a[88:91], v[96:99]
s_add_u32 m0, s77, 131072
ds_read_b64_tr_b16 a[72:73], v4 offset:0
v_mfma_f32_16x16x32_bf16 v[36:39], a[48:51], a[88:91], v[36:39]
s_add_u32 s64, s71, 0
buffer_load_dword a252, v1, s[60:63], s82 offen
v_mfma_f32_16x16x32_bf16 v[36:39], a[52:55], a[92:95], v[36:39]
buffer_load_dwordx4 v14, s[56:59], s64 offen lds
v_mfma_f32_16x16x32_bf16 v[52:55], a[60:63], a[92:95], v[52:55]
ds_read_b64_tr_b16 a[74:75], v4 offset:1024
v_mfma_f32_16x16x32_bf16 v[52:55], a[56:59], a[88:91], v[52:55]
ds_read_b64_tr_b16 a[76:77], v4 offset:8192
v_mfma_f32_16x16x32_bf16 v[68:71], a[56:59], a[96:99], v[68:71]
ds_read_b64_tr_b16 a[78:79], v4 offset:9216
v_lshrrev_b32 v13, 3, v0
v_mfma_f32_16x16x32_bf16 v[68:71], a[60:63], a[100:103], v[68:71]
ds_read_b64_tr_b16 a[80:81], v5 offset:0
v_lshl_add_u32 v12, v13, 10, v12
v_mfma_f32_16x16x32_bf16 v[84:87], a[52:55], a[100:103], v[84:87]
ds_read_b64_tr_b16 a[82:83], v5 offset:1024
v_xor_b32 v13, 64, v12
v_mfma_f32_16x16x32_bf16 v[84:87], a[48:51], a[96:99], v[84:87]
s_add_u32 m0, s78, 147456
ds_read_b64_tr_b16 a[84:85], v5 offset:8192
v_mfma_f32_16x16x32_bf16 v[148:151], a[40:43], a[96:99], v[148:151]
s_add_u32 s64, s75, 0
ds_read_b64_tr_b16 a[86:87], v5 offset:9216
v_mfma_f32_16x16x32_bf16 v[148:151], a[44:47], a[100:103], v[148:151]
buffer_load_dwordx4 v23, s[60:63], s64 offen lds
v_mfma_f32_16x16x32_bf16 v[132:135], a[36:39], a[100:103], v[132:135]
ds_read_b64_tr_b16 a[88:89], v6 offset:0
v_mfma_f32_16x16x32_bf16 v[132:135], a[32:35], a[96:99], v[132:135]
ds_read_b64_tr_b16 a[90:91], v6 offset:1024
v_mfma_f32_16x16x32_bf16 v[116:119], a[32:35], a[104:107], v[116:119]
ds_read_b64_tr_b16 a[92:93], v6 offset:8192
v_mfma_f32_16x16x32_bf16 v[116:119], a[36:39], a[108:111], v[116:119]
ds_read_b64_tr_b16 a[94:95], v6 offset:9216
v_mfma_f32_16x16x32_bf16 v[100:103], a[44:47], a[108:111], v[100:103]
ds_read_b64_tr_b16 a[96:97], v7 offset:0
v_mfma_f32_16x16x32_bf16 v[100:103], a[40:43], a[104:107], v[100:103]
s_add_u32 m0, s77, 132096
ds_read_b64_tr_b16 a[98:99], v7 offset:1024
v_mfma_f32_16x16x32_bf16 a[120:123], a[48:51], a[104:107], a[120:123]
s_add_u32 s64, s71, 32768
ds_read_b64_tr_b16 a[100:101], v7 offset:8192
v_mfma_f32_16x16x32_bf16 a[120:123], a[52:55], a[108:111], a[120:123]
buffer_load_dwordx4 v14, s[56:59], s64 offen lds
v_mfma_f32_16x16x32_bf16 a[124:127], a[60:63], a[108:111], a[124:127]
ds_read_b64_tr_b16 a[102:103], v7 offset:9216
v_mfma_f32_16x16x32_bf16 a[124:127], a[56:59], a[104:107], a[124:127]
ds_read_b64_tr_b16 a[104:105], v8 offset:0
v_mfma_f32_16x16x32_bf16 a[128:131], a[56:59], a[112:115], a[128:131]
ds_read_b64_tr_b16 a[106:107], v8 offset:1024
v_mfma_f32_16x16x32_bf16 a[128:131], a[60:63], a[116:119], a[128:131]
ds_read_b64_tr_b16 a[108:109], v8 offset:8192
v_mfma_f32_16x16x32_bf16 a[132:135], a[52:55], a[116:119], a[132:135]
ds_read_b64_tr_b16 a[110:111], v8 offset:9216
v_mfma_f32_16x16x32_bf16 a[132:135], a[48:51], a[112:115], a[132:135]
s_add_u32 m0, s78, 151552
v_mfma_f32_16x16x32_bf16 a[136:139], a[40:43], a[112:115], a[136:139]
s_add_u32 s64, s75, 2048
v_mfma_f32_16x16x32_bf16 a[136:139], a[44:47], a[116:119], a[136:139]
buffer_load_dwordx4 v23, s[60:63], s64 offen lds
v_mfma_f32_16x16x32_bf16 a[140:143], a[36:39], a[116:119], a[140:143]
v_mfma_f32_16x16x32_bf16 a[140:143], a[32:35], a[112:115], a[140:143]
s_waitcnt lgkmcnt(5)
ds_read_b64_tr_b16 a[112:113], v9 offset:0
v_mfma_f32_16x16x32_bf16 v[184:187], a[72:75], a[0:3], v[184:187]
ds_read_b64_tr_b16 a[114:115], v9 offset:1024
v_mfma_f32_16x16x32_bf16 v[184:187], a[76:79], a[4:7], v[184:187]
s_add_u32 s17, s78, .-L_pc+6144
ds_read_b64_tr_b16 a[116:117], v9 offset:8192
v_mfma_f32_16x16x32_bf16 v[192:195], a[76:79], a[12:15], v[192:195]
s_add_u32 m0, s77, 133120
ds_read_b64_tr_b16 a[118:119], v9 offset:9216
v_mfma_f32_16x16x32_bf16 v[192:195], a[72:75], a[8:11], v[192:195]
s_add_u32 s64, s71, 65536
v_mfma_f32_16x16x32_bf16 v[200:203], a[72:75], a[16:19], v[200:203]
buffer_load_dword a252, v16, s[88:91], s17 offen
v_mfma_f32_16x16x32_bf16 v[200:203], a[76:79], a[20:23], v[200:203]
buffer_load_dwordx4 v15, s[56:59], s64 offen lds
v_mfma_f32_16x16x32_bf16 v[208:211], a[76:79], a[28:31], v[208:211]
v_mfma_f32_16x16x32_bf16 v[208:211], a[72:75], a[24:27], v[208:211]
ds_read_b64_tr_b16 a[72:73], v10 offset:0
v_mfma_f32_16x16x32_bf16 v[248:251], a[80:83], a[24:27], v[248:251]
ds_read_b64_tr_b16 a[74:75], v10 offset:1024
v_mfma_f32_16x16x32_bf16 v[248:251], a[84:87], a[28:31], v[248:251]
ds_read_b64_tr_b16 a[76:77], v10 offset:8192
v_mfma_f32_16x16x32_bf16 v[212:215], a[84:87], a[20:23], v[212:215]
ds_read_b64_tr_b16 a[78:79], v10 offset:9216
v_mfma_f32_16x16x32_bf16 v[212:215], a[80:83], a[16:19], v[212:215]
s_add_u32 m0, s78, 155648
v_mfma_f32_16x16x32_bf16 v[204:207], a[80:83], a[8:11], v[204:207]
s_add_u32 s64, s75, 4096
v_mfma_f32_16x16x32_bf16 v[204:207], a[84:87], a[12:15], v[204:207]
buffer_load_dwordx4 v23, s[60:63], s64 offen lds
v_mfma_f32_16x16x32_bf16 v[196:199], a[84:87], a[4:7], v[196:199]
v_mfma_f32_16x16x32_bf16 v[196:199], a[80:83], a[0:3], v[196:199]
s_add_u32 s81, s81, 1048576
ds_read_b64_tr_b16 a[80:81], v11 offset:0
v_mfma_f32_16x16x32_bf16 v[188:191], a[88:91], a[0:3], v[188:191]
buffer_load_dword a252, v16, s[56:59], s81 offen
v_mfma_f32_16x16x32_bf16 v[188:191], a[92:95], a[4:7], v[188:191]
ds_read_b64_tr_b16 a[82:83], v11 offset:1024
v_mfma_f32_16x16x32_bf16 v[216:219], a[92:95], a[12:15], v[216:219]
ds_read_b64_tr_b16 a[84:85], v11 offset:8192
v_mfma_f32_16x16x32_bf16 v[216:219], a[88:91], a[8:11], v[216:219]
s_add_u32 m0, s77, 134144
ds_read_b64_tr_b16 a[86:87], v11 offset:9216
v_mfma_f32_16x16x32_bf16 v[224:227], a[88:91], a[16:19], v[224:227]
s_add_u32 s64, s71, 98304
v_mfma_f32_16x16x32_bf16 v[224:227], a[92:95], a[20:23], v[224:227]
buffer_load_dwordx4 v15, s[56:59], s64 offen lds
v_mfma_f32_16x16x32_bf16 v[232:235], a[92:95], a[28:31], v[232:235]
v_mfma_f32_16x16x32_bf16 v[232:235], a[88:91], a[24:27], v[232:235]
ds_read_b64_tr_b16 a[88:89], v4 offset:16384
v_mfma_f32_16x16x32_bf16 v[240:243], a[96:99], a[24:27], v[240:243]
s_waitcnt lgkmcnt(5)
ds_read_b64_tr_b16 a[90:91], v4 offset:17408
v_mfma_f32_16x16x32_bf16 v[240:243], a[100:103], a[28:31], v[240:243]
ds_read_b64_tr_b16 a[92:93], v4 offset:24576
v_mfma_f32_16x16x32_bf16 v[252:255], a[100:103], a[20:23], v[252:255]
ds_read_b64_tr_b16 a[94:95], v4 offset:25600
v_mfma_f32_16x16x32_bf16 v[252:255], a[96:99], a[16:19], v[252:255]
s_add_u32 m0, s78, 159744
v_mfma_f32_16x16x32_bf16 v[244:247], a[96:99], a[8:11], v[244:247]
s_add_u32 s64, s74, 0
v_mfma_f32_16x16x32_bf16 v[244:247], a[100:103], a[12:15], v[244:247]
buffer_load_dwordx4 v22, s[48:51], s64 offen lds
v_mfma_f32_16x16x32_bf16 v[236:239], a[100:103], a[4:7], v[236:239]
v_mfma_f32_16x16x32_bf16 v[236:239], a[96:99], a[0:3], v[236:239]
ds_read_b64_tr_b16 a[96:97], v5 offset:16384
v_mfma_f32_16x16x32_bf16 v[228:231], a[104:107], a[0:3], v[228:231]
ds_read_b64_tr_b16 a[98:99], v5 offset:17408
v_mfma_f32_16x16x32_bf16 v[228:231], a[108:111], a[4:7], v[228:231]
ds_read_b64_tr_b16 a[100:101], v5 offset:24576
v_mfma_f32_16x16x32_bf16 v[220:223], a[108:111], a[12:15], v[220:223]
ds_read_b64_tr_b16 a[102:103], v5 offset:25600
v_mfma_f32_16x16x32_bf16 v[220:223], a[104:107], a[8:11], v[220:223]
v_mfma_f32_16x16x32_bf16 v[152:155], a[104:107], a[16:19], v[152:155]
v_mfma_f32_16x16x32_bf16 v[152:155], a[108:111], a[20:23], v[152:155]
v_mfma_f32_16x16x32_bf16 v[160:163], a[108:111], a[28:31], v[160:163]
s_add_u32 m0, s76, 0
v_mfma_f32_16x16x32_bf16 v[160:163], a[104:107], a[24:27], v[160:163]
s_add_u32 s64, s72, 0
ds_read_b64_tr_b16 a[104:105], v6 offset:16384
v_mfma_f32_16x16x32_bf16 v[168:171], a[112:115], a[24:27], v[168:171]
buffer_load_dwordx4 v12, s[48:51], s64 offen lds
v_mfma_f32_16x16x32_bf16 v[168:171], a[116:119], a[28:31], v[168:171]
ds_read_b64_tr_b16 a[106:107], v6 offset:17408
v_mfma_f32_16x16x32_bf16 v[176:179], a[116:119], a[20:23], v[176:179]
ds_read_b64_tr_b16 a[108:109], v6 offset:24576
v_mfma_f32_16x16x32_bf16 v[176:179], a[112:115], a[16:19], v[176:179]
ds_read_b64_tr_b16 a[110:111], v6 offset:25600
v_mfma_f32_16x16x32_bf16 v[180:183], a[112:115], a[8:11], v[180:183]
v_mfma_f32_16x16x32_bf16 v[180:183], a[116:119], a[12:15], v[180:183]
s_add_u32 m0, s76, 1024
v_mfma_f32_16x16x32_bf16 v[172:175], a[116:119], a[4:7], v[172:175]
s_add_u32 s64, s72, 16384
v_mfma_f32_16x16x32_bf16 v[172:175], a[112:115], a[0:3], v[172:175]
buffer_load_dwordx4 v13, s[48:51], s64 offen lds
v_mfma_f32_16x16x32_bf16 v[164:167], a[72:75], a[0:3], v[164:167]
ds_read_b64_tr_b16 a[112:113], v7 offset:16384
v_mfma_f32_16x16x32_bf16 v[164:167], a[76:79], a[4:7], v[164:167]
ds_read_b64_tr_b16 a[114:115], v7 offset:17408
v_mfma_f32_16x16x32_bf16 v[156:159], a[76:79], a[12:15], v[156:159]
ds_read_b64_tr_b16 a[116:117], v7 offset:24576
v_mfma_f32_16x16x32_bf16 v[156:159], a[72:75], a[8:11], v[156:159]
ds_read_b64_tr_b16 a[118:119], v7 offset:25600
v_mfma_f32_16x16x32_bf16 v[24:27], a[72:75], a[16:19], v[24:27]
s_add_u32 m0, s76, 2048
v_mfma_f32_16x16x32_bf16 v[24:27], a[76:79], a[20:23], v[24:27]
s_add_u32 s64, s72, 131072
v_mfma_f32_16x16x32_bf16 v[40:43], a[76:79], a[28:31], v[40:43]
s_waitcnt vmcnt(13)
buffer_load_dwordx4 v12, s[48:51], s64 offen lds
v_mfma_f32_16x16x32_bf16 v[40:43], a[72:75], a[24:27], v[40:43]
s_waitcnt lgkmcnt(4)
ds_read_b64_tr_b16 a[72:73], v8 offset:16384
v_mfma_f32_16x16x32_bf16 v[56:59], a[80:83], a[24:27], v[56:59]
ds_read_b64_tr_b16 a[74:75], v8 offset:17408
v_mfma_f32_16x16x32_bf16 v[56:59], a[84:87], a[28:31], v[56:59]
s_add_u32 s82, s82, 1048576
ds_read_b64_tr_b16 a[76:77], v8 offset:24576
v_mfma_f32_16x16x32_bf16 v[72:75], a[84:87], a[20:23], v[72:75]
s_add_u32 m0, s76, 3072
ds_read_b64_tr_b16 a[78:79], v8 offset:25600
v_mfma_f32_16x16x32_bf16 v[72:75], a[80:83], a[16:19], v[72:75]
s_add_u32 s64, s72, 147456
ds_read_b128 a[32:35], v2 offset:32768
v_mfma_f32_16x16x32_bf16 v[136:139], a[80:83], a[8:11], v[136:139]
buffer_load_dword a252, v1, s[60:63], s82 offen
v_mfma_f32_16x16x32_bf16 v[136:139], a[84:87], a[12:15], v[136:139]
buffer_load_dwordx4 v13, s[48:51], s64 offen lds
v_mfma_f32_16x16x32_bf16 v[120:123], a[84:87], a[4:7], v[120:123]
ds_read_b128 a[36:39], v3 offset:32768
v_mfma_f32_16x16x32_bf16 v[120:123], a[80:83], a[0:3], v[120:123]
ds_read_b128 a[40:43], v2 offset:34816
v_mfma_f32_16x16x32_bf16 v[104:107], a[0:3], a[88:91], v[104:107]
ds_read_b128 a[44:47], v3 offset:34816
v_mfma_f32_16x16x32_bf16 v[104:107], a[4:7], a[92:95], v[104:107]
ds_read_b128 a[48:51], v2 offset:36864
v_mfma_f32_16x16x32_bf16 v[88:91], a[12:15], a[92:95], v[88:91]
s_add_u32 m0, s76, 4096
ds_read_b128 a[52:55], v3 offset:36864
v_mfma_f32_16x16x32_bf16 v[88:91], a[8:11], a[88:91], v[88:91]
s_add_u32 s64, s73, 0
ds_read_b128 a[56:59], v2 offset:38912
v_mfma_f32_16x16x32_bf16 v[28:31], a[16:19], a[88:91], v[28:31]
buffer_load_dwordx4 v12, s[48:51], s64 offen lds
v_mfma_f32_16x16x32_bf16 v[28:31], a[20:23], a[92:95], v[28:31]
ds_read_b128 a[60:63], v3 offset:38912
v_mfma_f32_16x16x32_bf16 v[44:47], a[28:31], a[92:95], v[44:47]
ds_read_b64_tr_b16 a[80:81], v9 offset:16384
v_mfma_f32_16x16x32_bf16 v[44:47], a[24:27], a[88:91], v[44:47]
ds_read_b64_tr_b16 a[82:83], v9 offset:17408
v_mfma_f32_16x16x32_bf16 v[60:63], a[24:27], a[96:99], v[60:63]
ds_read_b64_tr_b16 a[84:85], v9 offset:24576
v_mfma_f32_16x16x32_bf16 v[60:63], a[28:31], a[100:103], v[60:63]
s_add_u32 m0, s76, 5120
ds_read_b64_tr_b16 a[86:87], v9 offset:25600
v_mfma_f32_16x16x32_bf16 v[76:79], a[20:23], a[100:103], v[76:79]
s_add_u32 s64, s73, 16384
ds_read_b64_tr_b16 a[88:89], v10 offset:16384
v_mfma_f32_16x16x32_bf16 v[76:79], a[16:19], a[96:99], v[76:79]
buffer_load_dwordx4 v13, s[48:51], s64 offen lds
v_mfma_f32_16x16x32_bf16 v[140:143], a[8:11], a[96:99], v[140:143]
ds_read_b64_tr_b16 a[90:91], v10 offset:17408
v_mfma_f32_16x16x32_bf16 v[140:143], a[12:15], a[100:103], v[140:143]
ds_read_b64_tr_b16 a[92:93], v10 offset:24576
v_mfma_f32_16x16x32_bf16 v[124:127], a[4:7], a[100:103], v[124:127]
ds_read_b64_tr_b16 a[94:95], v10 offset:25600
v_mfma_f32_16x16x32_bf16 v[124:127], a[0:3], a[96:99], v[124:127]
ds_read_b64_tr_b16 a[96:97], v11 offset:16384
v_mfma_f32_16x16x32_bf16 v[108:111], a[0:3], a[104:107], v[108:111]
s_add_u32 m0, s76, 6144
ds_read_b64_tr_b16 a[98:99], v11 offset:17408
v_mfma_f32_16x16x32_bf16 v[108:111], a[4:7], a[108:111], v[108:111]
s_add_u32 s64, s73, 131072
ds_read_b64_tr_b16 a[100:101], v11 offset:24576
v_mfma_f32_16x16x32_bf16 v[92:95], a[12:15], a[108:111], v[92:95]
buffer_load_dwordx4 v12, s[48:51], s64 offen lds
v_mfma_f32_16x16x32_bf16 v[92:95], a[8:11], a[104:107], v[92:95]
ds_read_b64_tr_b16 a[102:103], v11 offset:25600
v_mfma_f32_16x16x32_bf16 v[32:35], a[16:19], a[104:107], v[32:35]
v_mfma_f32_16x16x32_bf16 v[32:35], a[20:23], a[108:111], v[32:35]
v_mfma_f32_16x16x32_bf16 v[48:51], a[28:31], a[108:111], v[48:51]
v_mfma_f32_16x16x32_bf16 v[48:51], a[24:27], a[104:107], v[48:51]
s_waitcnt lgkmcnt(5)
s_add_u32 m0, s76, 7168
v_mfma_f32_16x16x32_bf16 v[64:67], a[24:27], a[112:115], v[64:67]
s_add_u32 s64, s73, 147456
v_mfma_f32_16x16x32_bf16 v[64:67], a[28:31], a[116:119], v[64:67]
buffer_load_dwordx4 v13, s[48:51], s64 offen lds
v_mfma_f32_16x16x32_bf16 v[80:83], a[20:23], a[116:119], v[80:83]
v_mfma_f32_16x16x32_bf16 v[80:83], a[16:19], a[112:115], v[80:83]
v_mfma_f32_16x16x32_bf16 v[144:147], a[8:11], a[112:115], v[144:147]
v_mfma_f32_16x16x32_bf16 v[144:147], a[12:15], a[116:119], v[144:147]
v_mfma_f32_16x16x32_bf16 v[128:131], a[4:7], a[116:119], v[128:131]
v_mfma_f32_16x16x32_bf16 v[128:131], a[0:3], a[112:115], v[128:131]
v_mfma_f32_16x16x32_bf16 v[112:115], a[0:3], a[72:75], v[112:115]
v_mfma_f32_16x16x32_bf16 v[112:115], a[4:7], a[76:79], v[112:115]
v_mfma_f32_16x16x32_bf16 v[96:99], a[12:15], a[76:79], v[96:99]
s_waitcnt lgkmcnt(0)
s_barrier
v_mfma_f32_16x16x32_bf16 v[96:99], a[8:11], a[72:75], v[96:99]
s_add_u32 m0, s77, 65536
ds_read_b64_tr_b16 a[104:105], v4 offset:32768
v_mfma_f32_16x16x32_bf16 v[36:39], a[16:19], a[72:75], v[36:39]
s_add_u32 s64, s71, 524288
ds_read_b64_tr_b16 a[106:107], v4 offset:33792
v_mfma_f32_16x16x32_bf16 v[36:39], a[20:23], a[76:79], v[36:39]
buffer_load_dwordx4 v14, s[56:59], s64 offen lds
v_mfma_f32_16x16x32_bf16 v[52:55], a[28:31], a[76:79], v[52:55]
ds_read_b64_tr_b16 a[108:109], v4 offset:40960
v_mfma_f32_16x16x32_bf16 v[52:55], a[24:27], a[72:75], v[52:55]
ds_read_b64_tr_b16 a[110:111], v4 offset:41984
v_mfma_f32_16x16x32_bf16 v[68:71], a[24:27], a[80:83], v[68:71]
ds_read_b64_tr_b16 a[112:113], v5 offset:32768
v_mfma_f32_16x16x32_bf16 v[68:71], a[28:31], a[84:87], v[68:71]
ds_read_b64_tr_b16 a[114:115], v5 offset:33792
v_mfma_f32_16x16x32_bf16 v[84:87], a[20:23], a[84:87], v[84:87]
ds_read_b64_tr_b16 a[116:117], v5 offset:40960
v_mfma_f32_16x16x32_bf16 v[84:87], a[16:19], a[80:83], v[84:87]
s_add_u32 m0, s78, 81920
ds_read_b64_tr_b16 a[118:119], v5 offset:41984
v_mfma_f32_16x16x32_bf16 v[148:151], a[8:11], a[80:83], v[148:151]
s_add_u32 s64, s75, 393216
ds_read_b64_tr_b16 a[72:73], v6 offset:32768
v_mfma_f32_16x16x32_bf16 v[148:151], a[12:15], a[84:87], v[148:151]
buffer_load_dwordx4 v23, s[60:63], s64 offen lds
v_mfma_f32_16x16x32_bf16 v[132:135], a[4:7], a[84:87], v[132:135]
ds_read_b64_tr_b16 a[74:75], v6 offset:33792
v_mfma_f32_16x16x32_bf16 v[132:135], a[0:3], a[80:83], v[132:135]
ds_read_b64_tr_b16 a[76:77], v6 offset:40960
v_mfma_f32_16x16x32_bf16 v[116:119], a[0:3], a[88:91], v[116:119]
ds_read_b64_tr_b16 a[78:79], v6 offset:41984
v_mfma_f32_16x16x32_bf16 v[116:119], a[4:7], a[92:95], v[116:119]
ds_read_b64_tr_b16 a[80:81], v7 offset:32768
v_mfma_f32_16x16x32_bf16 v[100:103], a[12:15], a[92:95], v[100:103]
ds_read_b64_tr_b16 a[82:83], v7 offset:33792
v_mfma_f32_16x16x32_bf16 v[100:103], a[8:11], a[88:91], v[100:103]
s_add_u32 m0, s77, 66560
ds_read_b64_tr_b16 a[84:85], v7 offset:40960
v_mfma_f32_16x16x32_bf16 a[120:123], a[16:19], a[88:91], a[120:123]
s_add_u32 s64, s71, 557056
ds_read_b64_tr_b16 a[86:87], v7 offset:41984
v_mfma_f32_16x16x32_bf16 a[120:123], a[20:23], a[92:95], a[120:123]
buffer_load_dwordx4 v14, s[56:59], s64 offen lds
v_mfma_f32_16x16x32_bf16 a[124:127], a[28:31], a[92:95], a[124:127]
v_mfma_f32_16x16x32_bf16 a[124:127], a[24:27], a[88:91], a[124:127]
ds_read_b64_tr_b16 a[88:89], v8 offset:32768
v_mfma_f32_16x16x32_bf16 a[128:131], a[24:27], a[96:99], a[128:131]
ds_read_b64_tr_b16 a[90:91], v8 offset:33792
v_mfma_f32_16x16x32_bf16 a[128:131], a[28:31], a[100:103], a[128:131]
ds_read_b64_tr_b16 a[92:93], v8 offset:40960
v_mfma_f32_16x16x32_bf16 a[132:135], a[20:23], a[100:103], a[132:135]
ds_read_b64_tr_b16 a[94:95], v8 offset:41984
v_mfma_f32_16x16x32_bf16 a[132:135], a[16:19], a[96:99], a[132:135]
s_add_u32 m0, s78, 86016
v_mfma_f32_16x16x32_bf16 a[136:139], a[8:11], a[96:99], a[136:139]
s_add_u32 s64, s75, 395264
v_mfma_f32_16x16x32_bf16 a[136:139], a[12:15], a[100:103], a[136:139]
buffer_load_dwordx4 v23, s[60:63], s64 offen lds
v_mfma_f32_16x16x32_bf16 a[140:143], a[4:7], a[100:103], a[140:143]
v_mfma_f32_16x16x32_bf16 a[140:143], a[0:3], a[96:99], a[140:143]
s_waitcnt lgkmcnt(4)
ds_read_b64_tr_b16 a[96:97], v9 offset:32768
v_mfma_f32_16x16x32_bf16 v[184:187], a[104:107], a[32:35], v[184:187]
s_lshl_b32 s66, s30, 30
ds_read_b64_tr_b16 a[98:99], v9 offset:33792
v_mfma_f32_16x16x32_bf16 v[184:187], a[108:111], a[36:39], v[184:187]
ds_read_b64_tr_b16 a[100:101], v9 offset:40960
v_lshl_add_u32 v1, v0, 24, s66
v_mfma_f32_16x16x32_bf16 v[192:195], a[108:111], a[44:47], v[192:195]
s_lshl_b32 s66, s3, 12
ds_read_b64_tr_b16 a[102:103], v9 offset:41984
v_mfma_f32_16x16x32_bf16 v[192:195], a[104:107], a[40:43], v[192:195]
s_add_u32 m0, s77, 67584
s_add_u32 s17, s78, .-L_pc+6144
v_mfma_f32_16x16x32_bf16 v[200:203], a[104:107], a[48:51], v[200:203]
s_add_u32 s64, s71, 589824
buffer_load_dword a252, v16, s[88:91], s17 offen
v_mfma_f32_16x16x32_bf16 v[200:203], a[108:111], a[52:55], v[200:203]
buffer_load_dwordx4 v15, s[56:59], s64 offen lds
v_mfma_f32_16x16x32_bf16 v[208:211], a[108:111], a[60:63], v[208:211]
v_mfma_f32_16x16x32_bf16 v[208:211], a[104:107], a[56:59], v[208:211]
ds_read_b64_tr_b16 a[104:105], v10 offset:32768
v_mfma_f32_16x16x32_bf16 v[248:251], a[112:115], a[56:59], v[248:251]
ds_read_b64_tr_b16 a[106:107], v10 offset:33792
v_mfma_f32_16x16x32_bf16 v[248:251], a[116:119], a[60:63], v[248:251]
ds_read_b64_tr_b16 a[108:109], v10 offset:40960
v_mfma_f32_16x16x32_bf16 v[212:215], a[116:119], a[52:55], v[212:215]
ds_read_b64_tr_b16 a[110:111], v10 offset:41984
v_mfma_f32_16x16x32_bf16 v[212:215], a[112:115], a[48:51], v[212:215]
s_add_u32 m0, s78, 90112
v_mfma_f32_16x16x32_bf16 v[204:207], a[112:115], a[40:43], v[204:207]
s_add_u32 s64, s75, 397312
v_mfma_f32_16x16x32_bf16 v[204:207], a[116:119], a[44:47], v[204:207]
buffer_load_dwordx4 v23, s[60:63], s64 offen lds
v_mfma_f32_16x16x32_bf16 v[196:199], a[116:119], a[36:39], v[196:199]
v_mfma_f32_16x16x32_bf16 v[196:199], a[112:115], a[32:35], v[196:199]
s_add_u32 s65, s79, 20480
ds_read_b64_tr_b16 a[112:113], v11 offset:32768
v_mfma_f32_16x16x32_bf16 v[188:191], a[72:75], a[32:35], v[188:191]
ds_read_b64_tr_b16 a[114:115], v11 offset:33792
v_mfma_f32_16x16x32_bf16 v[188:191], a[76:79], a[36:39], v[188:191]
ds_read_b64_tr_b16 a[116:117], v11 offset:40960
v_cvt_pk_bf16_f32 v251, v250, v251
v_mfma_f32_16x16x32_bf16 v[216:219], a[76:79], a[44:47], v[216:219]
ds_read_b64_tr_b16 a[118:119], v11 offset:41984
v_cvt_pk_bf16_f32 v250, v248, v249
v_mfma_f32_16x16x32_bf16 v[216:219], a[72:75], a[40:43], v[216:219]
s_add_u32 m0, s77, 68608
v_cvt_pk_bf16_f32 v248, v208, v209
v_cvt_pk_bf16_f32 v249, v210, v211
v_mfma_f32_16x16x32_bf16 v[224:227], a[72:75], a[48:51], v[224:227]
s_add_u32 s64, s71, 622592
buffer_store_dwordx4 v[248:251], v16, s[44:47], s65 offen sc1
v_mfma_f32_16x16x32_bf16 v[224:227], a[76:79], a[52:55], v[224:227]
buffer_load_dwordx4 v15, s[56:59], s64 offen lds
v_mfma_f32_16x16x32_bf16 v[232:235], a[76:79], a[60:63], v[232:235]
v_cvt_pk_bf16_f32 v215, v214, v215
v_cvt_pk_bf16_f32 v214, v212, v213
v_mfma_f32_16x16x32_bf16 v[232:235], a[72:75], a[56:59], v[232:235]
ds_read_b64_tr_b16 a[72:73], v4 offset:49152
v_cvt_pk_bf16_f32 v212, v200, v201
v_mfma_f32_16x16x32_bf16 v[240:243], a[80:83], a[56:59], v[240:243]
ds_read_b64_tr_b16 a[74:75], v4 offset:50176
v_cvt_pk_bf16_f32 v213, v202, v203
v_mfma_f32_16x16x32_bf16 v[240:243], a[84:87], a[60:63], v[240:243]
ds_read_b64_tr_b16 a[76:77], v4 offset:57344
v_accvgpr_write_b32 a144, v212
v_mfma_f32_16x16x32_bf16 v[252:255], a[84:87], a[52:55], v[252:255]
ds_read_b64_tr_b16 a[78:79], v4 offset:58368
v_accvgpr_write_b32 a145, v213
v_mfma_f32_16x16x32_bf16 v[252:255], a[80:83], a[48:51], v[252:255]
s_add_u32 m0, s78, 94208
v_accvgpr_write_b32 a146, v214
v_accvgpr_write_b32 a147, v215
v_mfma_f32_16x16x32_bf16 v[244:247], a[80:83], a[40:43], v[244:247]
s_add_u32 s64, s74, 128
v_cvt_pk_bf16_f32 v207, v206, v207
v_cvt_pk_bf16_f32 v206, v204, v205
v_mfma_f32_16x16x32_bf16 v[244:247], a[84:87], a[44:47], v[244:247]
buffer_load_dwordx4 v22, s[48:51], s64 offen lds
v_mfma_f32_16x16x32_bf16 v[236:239], a[84:87], a[36:39], v[236:239]
v_cvt_pk_bf16_f32 v204, v192, v193
v_cvt_pk_bf16_f32 v205, v194, v195
v_mfma_f32_16x16x32_bf16 v[236:239], a[80:83], a[32:35], v[236:239]
s_waitcnt lgkmcnt(4)
ds_read_b64_tr_b16 a[80:81], v5 offset:49152
v_accvgpr_write_b32 a148, v204
v_mfma_f32_16x16x32_bf16 v[228:231], a[88:91], a[32:35], v[228:231]
ds_read_b64_tr_b16 a[82:83], v5 offset:50176
v_accvgpr_write_b32 a149, v205
v_mfma_f32_16x16x32_bf16 v[228:231], a[92:95], a[36:39], v[228:231]
ds_read_b64_tr_b16 a[84:85], v5 offset:57344
v_accvgpr_write_b32 a150, v206
v_mfma_f32_16x16x32_bf16 v[220:223], a[92:95], a[44:47], v[220:223]
ds_read_b64_tr_b16 a[86:87], v5 offset:58368
v_accvgpr_write_b32 a151, v207
v_mfma_f32_16x16x32_bf16 v[220:223], a[88:91], a[40:43], v[220:223]
v_cvt_pk_bf16_f32 v199, v198, v199
v_cvt_pk_bf16_f32 v198, v196, v197
v_mfma_f32_16x16x32_bf16 v[152:155], a[88:91], a[48:51], v[152:155]
v_cvt_pk_bf16_f32 v196, v184, v185
v_cvt_pk_bf16_f32 v197, v186, v187
v_mfma_f32_16x16x32_bf16 v[152:155], a[92:95], a[52:55], v[152:155]
v_accvgpr_write_b32 a152, v196
v_accvgpr_write_b32 a153, v197
v_mfma_f32_16x16x32_bf16 v[160:163], a[92:95], a[60:63], v[160:163]
s_add_u32 m0, s76, 32768
v_accvgpr_write_b32 a154, v198
v_accvgpr_write_b32 a155, v199
v_mfma_f32_16x16x32_bf16 v[160:163], a[88:91], a[56:59], v[160:163]
s_add_u32 s65, s79, 21504
s_add_u32 s64, s72, 128
ds_read_b64_tr_b16 a[88:89], v6 offset:49152
v_cvt_pk_bf16_f32 v243, v242, v243
v_mfma_f32_16x16x32_bf16 v[168:171], a[96:99], a[56:59], v[168:171]
buffer_load_dwordx4 v12, s[48:51], s64 offen lds
v_mfma_f32_16x16x32_bf16 v[168:171], a[100:103], a[60:63], v[168:171]
ds_read_b64_tr_b16 a[90:91], v6 offset:50176
v_cvt_pk_bf16_f32 v242, v240, v241
v_mfma_f32_16x16x32_bf16 v[176:179], a[100:103], a[52:55], v[176:179]
ds_read_b64_tr_b16 a[92:93], v6 offset:57344
v_cvt_pk_bf16_f32 v240, v232, v233
v_mfma_f32_16x16x32_bf16 v[176:179], a[96:99], a[48:51], v[176:179]
ds_read_b64_tr_b16 a[94:95], v6 offset:58368
v_cvt_pk_bf16_f32 v241, v234, v235
v_mfma_f32_16x16x32_bf16 v[180:183], a[96:99], a[40:43], v[180:183]
buffer_store_dwordx4 v[240:243], v16, s[44:47], s65 offen sc1
v_mfma_f32_16x16x32_bf16 v[180:183], a[100:103], a[44:47], v[180:183]
s_add_u32 m0, s76, 33792
v_cvt_pk_bf16_f32 v255, v254, v255
v_cvt_pk_bf16_f32 v254, v252, v253
v_mfma_f32_16x16x32_bf16 v[172:175], a[100:103], a[36:39], v[172:175]
s_add_u32 s64, s72, 16512
v_cvt_pk_bf16_f32 v252, v224, v225
v_cvt_pk_bf16_f32 v253, v226, v227
v_mfma_f32_16x16x32_bf16 v[172:175], a[96:99], a[32:35], v[172:175]
buffer_load_dwordx4 v13, s[48:51], s64 offen lds
v_mfma_f32_16x16x32_bf16 v[164:167], a[104:107], a[32:35], v[164:167]
ds_read_b64_tr_b16 a[96:97], v7 offset:49152
v_accvgpr_write_b32 a156, v252
v_mfma_f32_16x16x32_bf16 v[164:167], a[108:111], a[36:39], v[164:167]
ds_read_b64_tr_b16 a[98:99], v7 offset:50176
v_accvgpr_write_b32 a157, v253
v_mfma_f32_16x16x32_bf16 v[156:159], a[108:111], a[44:47], v[156:159]
ds_read_b64_tr_b16 a[100:101], v7 offset:57344
v_accvgpr_write_b32 a158, v254
v_mfma_f32_16x16x32_bf16 v[156:159], a[104:107], a[40:43], v[156:159]
ds_read_b64_tr_b16 a[102:103], v7 offset:58368
v_accvgpr_write_b32 a159, v255
v_mfma_f32_16x16x32_bf16 v[24:27], a[104:107], a[48:51], v[24:27]
s_add_u32 m0, s76, 34816
v_cvt_pk_bf16_f32 v247, v246, v247
v_cvt_pk_bf16_f32 v246, v244, v245
v_mfma_f32_16x16x32_bf16 v[24:27], a[108:111], a[52:55], v[24:27]
s_add_u32 s64, s72, 131200
v_cvt_pk_bf16_f32 v244, v216, v217
v_cvt_pk_bf16_f32 v245, v218, v219
v_mfma_f32_16x16x32_bf16 v[40:43], a[108:111], a[60:63], v[40:43]
s_waitcnt vmcnt(13)
buffer_load_dwordx4 v12, s[48:51], s64 offen lds
v_mfma_f32_16x16x32_bf16 v[40:43], a[104:107], a[56:59], v[40:43]
ds_read_b64_tr_b16 a[104:105], v8 offset:49152
v_accvgpr_write_b32 a160, v244
v_mfma_f32_16x16x32_bf16 v[56:59], a[112:115], a[56:59], v[56:59]
ds_read_b64_tr_b16 a[106:107], v8 offset:50176
v_accvgpr_write_b32 a161, v245
v_mfma_f32_16x16x32_bf16 v[56:59], a[116:119], a[60:63], v[56:59]
ds_read_b64_tr_b16 a[108:109], v8 offset:57344
v_add_u32 v4, 0x8000, v4
v_mfma_f32_16x16x32_bf16 v[72:75], a[116:119], a[52:55], v[72:75]
ds_read_b64_tr_b16 a[110:111], v8 offset:58368
v_accvgpr_write_b32 a162, v246
v_mfma_f32_16x16x32_bf16 v[72:75], a[112:115], a[48:51], v[72:75]
s_add_u32 m0, s76, 35840
ds_read_b128 a[0:3], v2 offset:0
v_accvgpr_write_b32 a163, v247
v_mfma_f32_16x16x32_bf16 v[136:139], a[112:115], a[40:43], v[136:139]
s_add_u32 s64, s72, 147584
ds_read_b128 a[4:7], v3 offset:0
v_cvt_pk_bf16_f32 v239, v238, v239
v_mfma_f32_16x16x32_bf16 v[136:139], a[116:119], a[44:47], v[136:139]
buffer_load_dwordx4 v13, s[48:51], s64 offen lds
v_mfma_f32_16x16x32_bf16 v[120:123], a[116:119], a[36:39], v[120:123]
ds_read_b128 a[8:11], v2 offset:2048
v_cvt_pk_bf16_f32 v238, v236, v237
v_mfma_f32_16x16x32_bf16 v[120:123], a[112:115], a[32:35], v[120:123]
s_waitcnt lgkmcnt(7)
ds_read_b128 a[12:15], v3 offset:2048
v_cvt_pk_bf16_f32 v236, v188, v189
v_mfma_f32_16x16x32_bf16 v[104:107], a[32:35], a[72:75], v[104:107]
ds_read_b128 a[16:19], v2 offset:4096
v_cvt_pk_bf16_f32 v237, v190, v191
v_mfma_f32_16x16x32_bf16 v[104:107], a[36:39], a[76:79], v[104:107]
ds_read_b128 a[20:23], v3 offset:4096
v_add_u32 v5, 0x8000, v5
v_mfma_f32_16x16x32_bf16 v[88:91], a[44:47], a[76:79], v[88:91]
s_add_u32 m0, s76, 36864
ds_read_b128 a[24:27], v2 offset:6144
v_accvgpr_write_b32 a164, v236
v_mfma_f32_16x16x32_bf16 v[88:91], a[40:43], a[72:75], v[88:91]
s_add_u32 s64, s73, 128
ds_read_b128 a[28:31], v3 offset:6144
v_accvgpr_write_b32 a165, v237
v_mfma_f32_16x16x32_bf16 v[28:31], a[48:51], a[72:75], v[28:31]
buffer_load_dwordx4 v12, s[48:51], s64 offen lds
v_mfma_f32_16x16x32_bf16 v[28:31], a[52:55], a[76:79], v[28:31]
ds_read_b64_tr_b16 a[112:113], v9 offset:49152
v_accvgpr_write_b32 a166, v238
v_mfma_f32_16x16x32_bf16 v[44:47], a[60:63], a[76:79], v[44:47]
ds_read_b64_tr_b16 a[114:115], v9 offset:50176
v_accvgpr_write_b32 a167, v239
v_mfma_f32_16x16x32_bf16 v[44:47], a[56:59], a[72:75], v[44:47]
s_add_u32 s65, s79, 22528
ds_read_b64_tr_b16 a[116:117], v9 offset:57344
v_cvt_pk_bf16_f32 v171, v170, v171
v_mfma_f32_16x16x32_bf16 v[60:63], a[56:59], a[80:83], v[60:63]
ds_read_b64_tr_b16 a[118:119], v9 offset:58368
v_cvt_pk_bf16_f32 v170, v168, v169
v_mfma_f32_16x16x32_bf16 v[60:63], a[60:63], a[84:87], v[60:63]
s_add_u32 m0, s76, 37888
ds_read_b64_tr_b16 a[72:73], v10 offset:49152
v_add_u32 v6, 0x8000, v6
v_mfma_f32_16x16x32_bf16 v[76:79], a[52:55], a[84:87], v[76:79]
s_add_u32 s64, s73, 16512
ds_read_b64_tr_b16 a[74:75], v10 offset:50176
v_cvt_pk_bf16_f32 v168, v160, v161
v_mfma_f32_16x16x32_bf16 v[76:79], a[48:51], a[80:83], v[76:79]
buffer_load_dwordx4 v13, s[48:51], s64 offen lds
v_mfma_f32_16x16x32_bf16 v[140:143], a[40:43], a[80:83], v[140:143]
ds_read_b64_tr_b16 a[76:77], v10 offset:57344
v_cvt_pk_bf16_f32 v169, v162, v163
v_mfma_f32_16x16x32_bf16 v[140:143], a[44:47], a[84:87], v[140:143]
ds_read_b64_tr_b16 a[78:79], v10 offset:58368
v_mfma_f32_16x16x32_bf16 v[124:127], a[36:39], a[84:87], v[124:127]
buffer_store_dwordx4 v[168:171], v16, s[44:47], s65 offen sc1
v_mfma_f32_16x16x32_bf16 v[124:127], a[32:35], a[80:83], v[124:127]
ds_read_b64_tr_b16 a[80:81], v11 offset:49152
v_cvt_pk_bf16_f32 v179, v178, v179
v_mfma_f32_16x16x32_bf16 v[108:111], a[32:35], a[88:91], v[108:111]
s_add_u32 m0, s76, 38912
ds_read_b64_tr_b16 a[82:83], v11 offset:50176
v_cvt_pk_bf16_f32 v178, v176, v177
v_mfma_f32_16x16x32_bf16 v[108:111], a[36:39], a[92:95], v[108:111]
s_add_u32 s64, s73, 131200
ds_read_b64_tr_b16 a[84:85], v11 offset:57344
v_add_u32 v7, 0x8000, v7
v_mfma_f32_16x16x32_bf16 v[92:95], a[44:47], a[92:95], v[92:95]
buffer_load_dwordx4 v12, s[48:51], s64 offen lds
v_mfma_f32_16x16x32_bf16 v[92:95], a[40:43], a[88:91], v[92:95]
ds_read_b64_tr_b16 a[86:87], v11 offset:58368
v_cvt_pk_bf16_f32 v176, v152, v153
v_mfma_f32_16x16x32_bf16 v[32:35], a[48:51], a[88:91], v[32:35]
v_cvt_pk_bf16_f32 v177, v154, v155
v_accvgpr_write_b32 a168, v176
v_mfma_f32_16x16x32_bf16 v[32:35], a[52:55], a[92:95], v[32:35]
v_accvgpr_write_b32 a169, v177
v_accvgpr_write_b32 a170, v178
v_mfma_f32_16x16x32_bf16 v[48:51], a[60:63], a[92:95], v[48:51]
v_accvgpr_write_b32 a171, v179
v_cvt_pk_bf16_f32 v183, v182, v183
v_mfma_f32_16x16x32_bf16 v[48:51], a[56:59], a[88:91], v[48:51]
s_add_u32 m0, s76, 39936
v_cvt_pk_bf16_f32 v182, v180, v181
v_cvt_pk_bf16_f32 v180, v220, v221
v_mfma_f32_16x16x32_bf16 v[64:67], a[56:59], a[96:99], v[64:67]
s_add_u32 s64, s73, 147584
v_cvt_pk_bf16_f32 v181, v222, v223
v_accvgpr_write_b32 a172, v180
v_mfma_f32_16x16x32_bf16 v[64:67], a[60:63], a[100:103], v[64:67]
buffer_load_dwordx4 v13, s[48:51], s64 offen lds
v_mfma_f32_16x16x32_bf16 v[80:83], a[52:55], a[100:103], v[80:83]
v_add_u32 v8, 0x8000, v8
v_accvgpr_write_b32 a173, v181
v_mfma_f32_16x16x32_bf16 v[80:83], a[48:51], a[96:99], v[80:83]
v_accvgpr_write_b32 a174, v182
v_accvgpr_write_b32 a175, v183
v_mfma_f32_16x16x32_bf16 v[144:147], a[40:43], a[96:99], v[144:147]
v_cvt_pk_bf16_f32 v175, v174, v175
v_cvt_pk_bf16_f32 v174, v172, v173
v_mfma_f32_16x16x32_bf16 v[144:147], a[44:47], a[100:103], v[144:147]
v_cvt_pk_bf16_f32 v172, v228, v229
v_cvt_pk_bf16_f32 v173, v230, v231
v_mfma_f32_16x16x32_bf16 v[128:131], a[36:39], a[100:103], v[128:131]
v_add_u32 v9, 0x8000, v9
v_add_u32 v10, 0x8000, v10
v_mfma_f32_16x16x32_bf16 v[128:131], a[32:35], a[96:99], v[128:131]
s_waitcnt lgkmcnt(0)
v_add_u32 v11, 0x8000, v11
v_accvgpr_write_b32 a176, v172
v_mfma_f32_16x16x32_bf16 v[112:115], a[32:35], a[104:107], v[112:115]
v_accvgpr_write_b32 a177, v173
v_accvgpr_write_b32 a178, v174
v_mfma_f32_16x16x32_bf16 v[112:115], a[36:39], a[108:111], v[112:115]
v_accvgpr_write_b32 a179, v175
v_mfma_f32_16x16x32_bf16 v[96:99], a[44:47], a[108:111], v[96:99]
s_add_u32 s65, s79, 23552
s_waitcnt lgkmcnt(0)
s_barrier
v_mfma_f32_16x16x32_bf16 v[96:99], a[40:43], a[104:107], v[96:99]
s_add_u32 m0, s77, 98304
ds_read_b64_tr_b16 a[88:89], v19 offset:36864
v_cvt_pk_bf16_f32 v59, v58, v59
v_mfma_f32_16x16x32_bf16 v[36:39], a[48:51], a[104:107], v[36:39]
s_add_u32 s64, s71, 1048576
ds_read_b64_tr_b16 a[90:91], v19 offset:37120
v_cvt_pk_bf16_f32 v58, v56, v57
v_mfma_f32_16x16x32_bf16 v[36:39], a[52:55], a[108:111], v[36:39]
buffer_load_dwordx4 v14, s[56:59], s64 offen lds
v_mfma_f32_16x16x32_bf16 v[52:55], a[60:63], a[108:111], v[52:55]
ds_read_b64_tr_b16 a[92:93], v19 offset:38912
v_cvt_pk_bf16_f32 v56, v40, v41
v_mfma_f32_16x16x32_bf16 v[52:55], a[56:59], a[104:107], v[52:55]
ds_read_b64_tr_b16 a[94:95], v19 offset:39168
v_cvt_pk_bf16_f32 v57, v42, v43
v_mfma_f32_16x16x32_bf16 v[68:71], a[56:59], a[112:115], v[68:71]
ds_read_b128 a[64:67], v17 offset:32768
v_mfma_f32_16x16x32_bf16 v[68:71], a[60:63], a[116:119], v[68:71]
ds_read_b128 a[68:71], v18 offset:32768
v_mfma_f32_16x16x32_bf16 v[84:87], a[52:55], a[116:119], v[84:87]
ds_read_b64_tr_b16 a[96:97], v21 offset:36864
v_mfma_f32_16x16x32_bf16 v[84:87], a[48:51], a[112:115], v[84:87]
s_add_u32 m0, s78, 114688
ds_read_b64_tr_b16 a[98:99], v21 offset:37120
v_mfma_f32_16x16x32_bf16 v[148:151], a[40:43], a[112:115], v[148:151]
s_add_u32 s64, s75, 786432
ds_read_b64_tr_b16 a[100:101], v21 offset:38912
v_mfma_f32_16x16x32_bf16 v[148:151], a[44:47], a[116:119], v[148:151]
buffer_load_dwordx4 v23, s[60:63], s64 offen lds
v_mfma_f32_16x16x32_bf16 v[132:135], a[36:39], a[116:119], v[132:135]
ds_read_b64_tr_b16 a[102:103], v21 offset:39168
v_mfma_f32_16x16x32_bf16 v[132:135], a[32:35], a[112:115], v[132:135]
ds_read_b64_tr_b16 a[104:105], v20 offset:36864
v_mfma_f32_16x16x32_bf16 v[116:119], a[32:35], a[72:75], v[116:119]
ds_read_b64_tr_b16 a[106:107], v20 offset:37120
v_mfma_f32_16x16x32_bf16 v[116:119], a[36:39], a[76:79], v[116:119]
ds_read_b64_tr_b16 a[108:109], v20 offset:38912
v_mfma_f32_16x16x32_bf16 v[100:103], a[44:47], a[76:79], v[100:103]
ds_read_b64_tr_b16 a[110:111], v20 offset:39168
v_mfma_f32_16x16x32_bf16 v[100:103], a[40:43], a[72:75], v[100:103]
s_add_u32 m0, s77, 99328
ds_read_b64_tr_b16 a[112:113], v19 offset:40960
v_mfma_f32_16x16x32_bf16 a[120:123], a[48:51], a[72:75], a[120:123]
s_add_u32 s64, s71, 1081344
ds_read_b64_tr_b16 a[114:115], v19 offset:41216
v_mfma_f32_16x16x32_bf16 a[120:123], a[52:55], a[76:79], a[120:123]
buffer_load_dwordx4 v14, s[56:59], s64 offen lds
v_mfma_f32_16x16x32_bf16 a[124:127], a[60:63], a[76:79], a[124:127]
ds_read_b64_tr_b16 a[116:117], v19 offset:43008
v_mfma_f32_16x16x32_bf16 a[124:127], a[56:59], a[72:75], a[124:127]
ds_read_b64_tr_b16 a[118:119], v19 offset:43264
v_mfma_f32_16x16x32_bf16 a[128:131], a[56:59], a[80:83], a[128:131]
ds_read_b64_tr_b16 a[72:73], v21 offset:40960
v_mfma_f32_16x16x32_bf16 a[128:131], a[60:63], a[84:87], a[128:131]
ds_read_b64_tr_b16 a[74:75], v21 offset:41216
v_mfma_f32_16x16x32_bf16 a[132:135], a[52:55], a[84:87], a[132:135]
s_add_u32 m0, s78, 118784
ds_read_b64_tr_b16 a[76:77], v21 offset:43008
v_mfma_f32_16x16x32_bf16 a[132:135], a[48:51], a[80:83], a[132:135]
s_add_u32 s64, s75, 788480
ds_read_b64_tr_b16 a[78:79], v21 offset:43264
v_mfma_f32_16x16x32_bf16 a[136:139], a[40:43], a[80:83], a[136:139]
buffer_store_dwordx4 v[56:59], v16, s[44:47], s65 offen sc1
v_mfma_f32_16x16x32_bf16 a[136:139], a[44:47], a[84:87], a[136:139]
buffer_load_dwordx4 v23, s[60:63], s64 offen lds
v_mfma_f32_16x16x32_bf16 a[140:143], a[36:39], a[84:87], a[140:143]
v_cvt_pk_bf16_f32 v75, v74, v75
v_cvt_pk_bf16_f32 v74, v72, v73
v_mfma_f32_16x16x32_bf16 a[140:143], a[32:35], a[80:83], a[140:143]
s_waitcnt lgkmcnt(6)
ds_read_b64_tr_b16 a[80:81], v20 offset:40960
v_cvt_pk_bf16_f32 v72, v24, v25
v_mfma_f32_16x16x32_bf16 v[184:187], a[88:91], a[0:3], 0
ds_read_b64_tr_b16 a[82:83], v20 offset:41216
v_cvt_pk_bf16_f32 v73, v26, v27
v_mfma_f32_16x16x32_bf16 v[184:187], a[92:95], a[4:7], v[184:187]
ds_read_b64_tr_b16 a[84:85], v20 offset:43008
v_accvgpr_write_b32 a180, v72
v_mfma_f32_16x16x32_bf16 v[192:195], a[92:95], a[12:15], 0
ds_read_b64_tr_b16 a[86:87], v20 offset:43264
v_accvgpr_write_b32 a181, v73
v_mfma_f32_16x16x32_bf16 v[192:195], a[88:91], a[8:11], v[192:195]
s_add_u32 m0, s77, 100352
s_add_u32 s17, s78, .-L_pc+6144
v_accvgpr_write_b32 a182, v74
v_accvgpr_write_b32 a183, v75
v_mfma_f32_16x16x32_bf16 v[200:203], a[88:91], a[16:19], 0
s_add_u32 s64, s71, 1114112
buffer_load_dword a252, v16, s[88:91], s17 offen
v_mfma_f32_16x16x32_bf16 v[200:203], a[92:95], a[20:23], v[200:203]
buffer_load_dwordx4 v15, s[56:59], s64 offen lds
v_mfma_f32_16x16x32_bf16 v[208:211], a[92:95], a[28:31], 0
v_cvt_pk_bf16_f32 v139, v138, v139
v_cvt_pk_bf16_f32 v138, v136, v137
v_mfma_f32_16x16x32_bf16 v[208:211], a[88:91], a[24:27], v[208:211]
ds_read_b64_tr_b16 a[88:89], v19 offset:32768
v_cvt_pk_bf16_f32 v136, v156, v157
v_mfma_f32_16x16x32_bf16 v[248:251], a[96:99], a[64:67], 0
ds_read_b64_tr_b16 a[90:91], v19 offset:33024
v_cvt_pk_bf16_f32 v137, v158, v159
v_mfma_f32_16x16x32_bf16 v[248:251], a[100:103], a[68:71], v[248:251]
ds_read_b64_tr_b16 a[92:93], v19 offset:34816
v_accvgpr_write_b32 a184, v136
v_mfma_f32_16x16x32_bf16 v[212:215], a[108:111], a[28:31], 0
ds_read_b64_tr_b16 a[94:95], v19 offset:35072
v_accvgpr_write_b32 a185, v137
v_mfma_f32_16x16x32_bf16 v[212:215], a[104:107], a[24:27], v[212:215]
s_add_u32 m0, s78, 122880
ds_read_b64_tr_b16 a[96:97], v20 offset:32768
v_accvgpr_write_b32 a186, v138
v_mfma_f32_16x16x32_bf16 v[204:207], a[104:107], a[16:19], 0
s_add_u32 s64, s75, 790528
ds_read_b64_tr_b16 a[98:99], v20 offset:33024
v_accvgpr_write_b32 a187, v139
v_mfma_f32_16x16x32_bf16 v[204:207], a[108:111], a[20:23], v[204:207]
buffer_load_dwordx4 v23, s[60:63], s64 offen lds
v_mfma_f32_16x16x32_bf16 v[196:199], a[108:111], a[12:15], 0
ds_read_b64_tr_b16 a[100:101], v20 offset:34816
v_cvt_pk_bf16_f32 v123, v122, v123
v_mfma_f32_16x16x32_bf16 v[196:199], a[104:107], a[8:11], v[196:199]
ds_read_b64_tr_b16 a[102:103], v20 offset:35072
v_cvt_pk_bf16_f32 v122, v120, v121
v_mfma_f32_16x16x32_bf16 v[188:191], a[104:107], a[0:3], 0
v_cvt_pk_bf16_f32 v120, v164, v165
v_cvt_pk_bf16_f32 v121, v166, v167
v_mfma_f32_16x16x32_bf16 v[188:191], a[108:111], a[4:7], v[188:191]
s_waitcnt lgkmcnt(7)
ds_read_b64_tr_b16 a[104:105], v4 offset:32768
v_accvgpr_write_b32 a188, v120
v_mfma_f32_16x16x32_bf16 v[216:219], a[4:7], a[116:119], 0
ds_read_b64_tr_b16 a[106:107], v4 offset:33792
v_accvgpr_write_b32 a189, v121
v_mfma_f32_16x16x32_bf16 v[216:219], a[0:3], a[112:115], v[216:219]
s_add_u32 m0, s77, 101376
ds_read_b64_tr_b16 a[108:109], v4 offset:40960
v_accvgpr_write_b32 a190, v122
v_mfma_f32_16x16x32_bf16 v[224:227], a[8:11], a[112:115], 0
s_add_u32 s64, s71, 1146880
ds_read_b64_tr_b16 a[110:111], v4 offset:41984
v_accvgpr_write_b32 a191, v123
v_mfma_f32_16x16x32_bf16 v[224:227], a[12:15], a[116:119], v[224:227]
s_add_u32 s65, s79, 8192
buffer_load_dwordx4 v15, s[56:59], s64 offen lds
v_mfma_f32_16x16x32_bf16 v[232:235], a[20:23], a[116:119], 0
v_cvt_pk_bf16_f32 v91, v90, v91
v_cvt_pk_bf16_f32 v90, v88, v89
v_mfma_f32_16x16x32_bf16 v[232:235], a[16:19], a[112:115], v[232:235]
v_cvt_pk_bf16_f32 v88, v104, v105
v_cvt_pk_bf16_f32 v89, v106, v107
v_mfma_f32_16x16x32_bf16 v[240:243], a[24:27], a[112:115], 0
buffer_store_dwordx4 v[88:91], v16, s[44:47], s65 offen sc1
v_mfma_f32_16x16x32_bf16 v[240:243], a[28:31], a[116:119], v[240:243]
ds_read_b64_tr_b16 a[112:113], v5 offset:32768
v_cvt_pk_bf16_f32 v47, v46, v47
v_mfma_f32_16x16x32_bf16 v[252:255], a[68:71], a[76:79], 0
ds_read_b64_tr_b16 a[114:115], v5 offset:33792
v_cvt_pk_bf16_f32 v46, v44, v45
v_mfma_f32_16x16x32_bf16 v[252:255], a[64:67], a[72:75], v[252:255]
s_add_u32 m0, s78, 126976
ds_read_b64_tr_b16 a[116:117], v5 offset:40960
v_cvt_pk_bf16_f32 v44, v28, v29
v_mfma_f32_16x16x32_bf16 v[244:247], a[24:27], a[80:83], 0
s_add_u32 s64, s74, 256
ds_read_b64_tr_b16 a[118:119], v5 offset:41984
v_cvt_pk_bf16_f32 v45, v30, v31
v_mfma_f32_16x16x32_bf16 v[244:247], a[28:31], a[84:87], v[244:247]
buffer_load_dwordx4 v22, s[48:51], s64 offen lds
v_mfma_f32_16x16x32_bf16 v[236:239], a[20:23], a[84:87], 0
ds_read_b64_tr_b16 a[72:73], v6 offset:32768
v_accvgpr_write_b32 a192, v44
v_mfma_f32_16x16x32_bf16 v[236:239], a[16:19], a[80:83], v[236:239]
ds_read_b64_tr_b16 a[74:75], v6 offset:33792
v_accvgpr_write_b32 a193, v45
v_mfma_f32_16x16x32_bf16 v[228:231], a[8:11], a[80:83], 0
ds_read_b64_tr_b16 a[76:77], v6 offset:40960
v_accvgpr_write_b32 a194, v46
v_mfma_f32_16x16x32_bf16 v[228:231], a[12:15], a[84:87], v[228:231]
ds_read_b64_tr_b16 a[78:79], v6 offset:41984
v_accvgpr_write_b32 a195, v47
v_mfma_f32_16x16x32_bf16 v[220:223], a[4:7], a[84:87], 0
v_cvt_pk_bf16_f32 v76, v76, v77
v_cvt_pk_bf16_f32 v77, v78, v79
v_mfma_f32_16x16x32_bf16 v[220:223], a[0:3], a[80:83], v[220:223]
s_waitcnt lgkmcnt(7)
ds_read_b64_tr_b16 a[80:81], v7 offset:32768
v_cvt_pk_bf16_f32 v78, v60, v61
v_mfma_f32_16x16x32_bf16 v[152:155], a[88:91], a[0:3], 0
ds_read_b64_tr_b16 a[82:83], v7 offset:33792
v_cvt_pk_bf16_f32 v79, v62, v63
v_mfma_f32_16x16x32_bf16 v[152:155], a[92:95], a[4:7], v[152:155]
ds_read_b64_tr_b16 a[84:85], v7 offset:40960
v_accvgpr_write_b32 a196, v76
v_mfma_f32_16x16x32_bf16 v[160:163], a[92:95], a[12:15], 0
s_add_u32 m0, s76, 0
ds_read_b64_tr_b16 a[86:87], v7 offset:41984
v_accvgpr_write_b32 a197, v77
v_mfma_f32_16x16x32_bf16 v[160:163], a[88:91], a[8:11], v[160:163]
s_add_u32 s64, s72, 256
v_accvgpr_write_b32 a198, v78
v_accvgpr_write_b32 a199, v79
v_mfma_f32_16x16x32_bf16 v[168:171], a[88:91], a[16:19], 0
buffer_load_dwordx4 v12, s[48:51], s64 offen lds
v_mfma_f32_16x16x32_bf16 v[168:171], a[92:95], a[20:23], v[168:171]
v_cvt_pk_bf16_f32 v124, v124, v125
v_cvt_pk_bf16_f32 v125, v126, v127
v_mfma_f32_16x16x32_bf16 v[176:179], a[92:95], a[28:31], 0
v_cvt_pk_bf16_f32 v126, v140, v141
v_cvt_pk_bf16_f32 v127, v142, v143
v_mfma_f32_16x16x32_bf16 v[176:179], a[88:91], a[24:27], v[176:179]
s_add_u32 m0, s76, 1024
v_accvgpr_write_b32 a200, v124
v_accvgpr_write_b32 a201, v125
v_mfma_f32_16x16x32_bf16 v[180:183], a[96:99], a[24:27], 0
s_add_u32 s64, s72, 16640
v_accvgpr_write_b32 a202, v126
v_accvgpr_write_b32 a203, v127
v_mfma_f32_16x16x32_bf16 v[180:183], a[100:103], a[28:31], v[180:183]
s_add_u32 s65, s79, 10240
buffer_load_dwordx4 v13, s[48:51], s64 offen lds
v_mfma_f32_16x16x32_bf16 v[172:175], a[100:103], a[20:23], 0
ds_read_b64_tr_b16 a[88:89], v8 offset:32768
v_cvt_pk_bf16_f32 v95, v94, v95
v_mfma_f32_16x16x32_bf16 v[172:175], a[96:99], a[16:19], v[172:175]
ds_read_b64_tr_b16 a[90:91], v8 offset:33792
v_cvt_pk_bf16_f32 v94, v92, v93
v_mfma_f32_16x16x32_bf16 v[164:167], a[96:99], a[8:11], 0
ds_read_b64_tr_b16 a[92:93], v8 offset:40960
v_cvt_pk_bf16_f32 v92, v108, v109
v_mfma_f32_16x16x32_bf16 v[164:167], a[100:103], a[12:15], v[164:167]
s_add_u32 m0, s76, 2048
ds_read_b64_tr_b16 a[94:95], v8 offset:41984
v_cvt_pk_bf16_f32 v93, v110, v111
v_mfma_f32_16x16x32_bf16 v[156:159], a[100:103], a[4:7], 0
s_add_u32 s64, s72, 131328
buffer_store_dwordx4 v[92:95], v16, s[44:47], s65 offen sc1
v_mfma_f32_16x16x32_bf16 v[156:159], a[96:99], a[0:3], v[156:159]
buffer_load_dwordx4 v12, s[48:51], s64 offen lds
v_mfma_f32_16x16x32_bf16 v[24:27], a[104:107], a[0:3], 0
ds_read_b64_tr_b16 a[96:97], v9 offset:32768
v_cvt_pk_bf16_f32 v51, v50, v51
v_mfma_f32_16x16x32_bf16 v[24:27], a[108:111], a[4:7], v[24:27]
ds_read_b64_tr_b16 a[98:99], v9 offset:33792
v_cvt_pk_bf16_f32 v50, v48, v49
v_mfma_f32_16x16x32_bf16 v[40:43], a[108:111], a[12:15], 0
s_waitcnt vmcnt(15)
s_add_u32 m0, s76, 3072
ds_read_b64_tr_b16 a[100:101], v9 offset:40960
v_cvt_pk_bf16_f32 v48, v32, v33
v_mfma_f32_16x16x32_bf16 v[40:43], a[104:107], a[8:11], v[40:43]
s_add_u32 s64, s72, 147712
ds_read_b64_tr_b16 a[102:103], v9 offset:41984
v_cvt_pk_bf16_f32 v49, v34, v35
v_mfma_f32_16x16x32_bf16 v[56:59], a[104:107], a[16:19], 0
buffer_load_dwordx4 v13, s[48:51], s64 offen lds
v_mfma_f32_16x16x32_bf16 v[56:59], a[108:111], a[20:23], v[56:59]
ds_read_b128 a[32:35], v2 offset:32768
v_accvgpr_write_b32 a204, v48
v_mfma_f32_16x16x32_bf16 v[72:75], a[108:111], a[28:31], 0
ds_read_b128 a[36:39], v3 offset:32768
v_accvgpr_write_b32 a205, v49
v_mfma_f32_16x16x32_bf16 v[72:75], a[104:107], a[24:27], v[72:75]
s_waitcnt lgkmcnt(6)
ds_read_b128 a[40:43], v2 offset:34816
v_accvgpr_write_b32 a206, v50
v_mfma_f32_16x16x32_bf16 v[136:139], a[112:115], a[24:27], 0
s_add_u32 m0, s76, 4096
ds_read_b128 a[44:47], v3 offset:34816
v_accvgpr_write_b32 a207, v51
v_mfma_f32_16x16x32_bf16 v[136:139], a[116:119], a[28:31], v[136:139]
s_add_u32 s64, s73, 256
ds_read_b128 a[48:51], v2 offset:36864
v_subrev_u32 v17, 0x8000, v17
v_mfma_f32_16x16x32_bf16 v[120:123], a[116:119], a[20:23], 0
buffer_load_dwordx4 v12, s[48:51], s64 offen lds
v_mfma_f32_16x16x32_bf16 v[120:123], a[112:115], a[16:19], v[120:123]
ds_read_b128 a[52:55], v3 offset:36864
v_subrev_u32 v18, 0x8000, v18
v_mfma_f32_16x16x32_bf16 v[104:107], a[112:115], a[8:11], 0
ds_read_b128 a[56:59], v2 offset:38912
v_subrev_u32 v21, 0x8000, v21
v_mfma_f32_16x16x32_bf16 v[104:107], a[116:119], a[12:15], v[104:107]
s_add_u32 m0, s76, 5120
ds_read_b128 a[60:63], v3 offset:38912
v_subrev_u32 v19, 0x8000, v19
v_mfma_f32_16x16x32_bf16 v[88:91], a[116:119], a[4:7], 0
s_add_u32 s64, s73, 16640
ds_read_b64_tr_b16 a[104:105], v10 offset:32768
v_subrev_u32 v20, 0x8000, v20
v_mfma_f32_16x16x32_bf16 v[88:91], a[112:115], a[0:3], v[88:91]
buffer_load_dwordx4 v13, s[48:51], s64 offen lds
v_mfma_f32_16x16x32_bf16 v[28:31], a[72:75], a[0:3], 0
ds_read_b64_tr_b16 a[106:107], v10 offset:33792
v_subrev_u32 v4, 0x8000, v4
v_mfma_f32_16x16x32_bf16 v[28:31], a[76:79], a[4:7], v[28:31]
ds_read_b64_tr_b16 a[108:109], v10 offset:40960
v_subrev_u32 v5, 0x8000, v5
v_mfma_f32_16x16x32_bf16 v[44:47], a[76:79], a[12:15], 0
ds_read_b64_tr_b16 a[110:111], v10 offset:41984
v_subrev_u32 v6, 0x8000, v6
v_mfma_f32_16x16x32_bf16 v[44:47], a[72:75], a[8:11], v[44:47]
s_add_u32 m0, s76, 6144
ds_read_b64_tr_b16 a[112:113], v11 offset:32768
v_subrev_u32 v7, 0x8000, v7
v_mfma_f32_16x16x32_bf16 v[60:63], a[72:75], a[16:19], 0
s_add_u32 s64, s73, 131328
ds_read_b64_tr_b16 a[114:115], v11 offset:33792
v_cvt_pk_bf16_f32 v80, v80, v81
v_mfma_f32_16x16x32_bf16 v[60:63], a[76:79], a[20:23], v[60:63]
buffer_load_dwordx4 v12, s[48:51], s64 offen lds
v_mfma_f32_16x16x32_bf16 v[76:79], a[76:79], a[28:31], 0
ds_read_b64_tr_b16 a[116:117], v11 offset:40960
v_cvt_pk_bf16_f32 v81, v82, v83
v_mfma_f32_16x16x32_bf16 v[76:79], a[72:75], a[24:27], v[76:79]
ds_read_b64_tr_b16 a[118:119], v11 offset:41984
v_cvt_pk_bf16_f32 v82, v64, v65
v_mfma_f32_16x16x32_bf16 v[140:143], a[80:83], a[24:27], 0
s_add_u32 m0, s76, 7168
v_cvt_pk_bf16_f32 v83, v66, v67
v_accvgpr_write_b32 a208, v80
v_mfma_f32_16x16x32_bf16 v[140:143], a[84:87], a[28:31], v[140:143]
s_add_u32 s64, s73, 147712
v_subrev_u32 v8, 0x8000, v8
v_accvgpr_write_b32 a209, v81
v_mfma_f32_16x16x32_bf16 v[124:127], a[84:87], a[20:23], 0
buffer_load_dwordx4 v13, s[48:51], s64 offen lds
v_mfma_f32_16x16x32_bf16 v[124:127], a[80:83], a[16:19], v[124:127]
v_accvgpr_write_b32 a210, v82
v_accvgpr_write_b32 a211, v83
v_mfma_f32_16x16x32_bf16 v[108:111], a[80:83], a[8:11], 0
v_cvt_pk_bf16_f32 v128, v128, v129
v_cvt_pk_bf16_f32 v129, v130, v131
v_mfma_f32_16x16x32_bf16 v[108:111], a[84:87], a[12:15], v[108:111]
v_cvt_pk_bf16_f32 v130, v144, v145
v_cvt_pk_bf16_f32 v131, v146, v147
v_mfma_f32_16x16x32_bf16 v[92:95], a[84:87], a[4:7], 0
v_subrev_u32 v9, 0x8000, v9
v_subrev_u32 v10, 0x8000, v10
v_mfma_f32_16x16x32_bf16 v[92:95], a[80:83], a[0:3], v[92:95]
v_subrev_u32 v11, 0x8000, v11
v_accvgpr_write_b32 a212, v128
v_mfma_f32_16x16x32_bf16 v[32:35], a[88:91], a[0:3], 0
v_accvgpr_write_b32 a213, v129
v_accvgpr_write_b32 a214, v130
v_mfma_f32_16x16x32_bf16 v[32:35], a[92:95], a[4:7], v[32:35]
v_accvgpr_write_b32 a215, v131
v_mfma_f32_16x16x32_bf16 v[48:51], a[92:95], a[12:15], 0
s_add_u32 s65, s79, 12288
s_waitcnt lgkmcnt(0)
s_barrier
v_mfma_f32_16x16x32_bf16 v[48:51], a[88:91], a[8:11], v[48:51]
s_add_u32 m0, s77, 131072
v_cvt_pk_bf16_f32 v99, v98, v99
v_cvt_pk_bf16_f32 v98, v96, v97
v_mfma_f32_16x16x32_bf16 v[64:67], a[88:91], a[16:19], 0
s_add_u32 s64, s71, 1572864
v_cvt_pk_bf16_f32 v96, v112, v113
v_cvt_pk_bf16_f32 v97, v114, v115
v_mfma_f32_16x16x32_bf16 v[64:67], a[92:95], a[20:23], v[64:67]
buffer_load_dwordx4 v14, s[56:59], s64 offen lds
v_mfma_f32_16x16x32_bf16 v[80:83], a[92:95], a[28:31], 0
buffer_store_dwordx4 v[96:99], v16, s[44:47], s65 offen sc1
v_mfma_f32_16x16x32_bf16 v[80:83], a[88:91], a[24:27], v[80:83]
v_cvt_pk_bf16_f32 v55, v54, v55
v_cvt_pk_bf16_f32 v54, v52, v53
v_mfma_f32_16x16x32_bf16 v[144:147], a[96:99], a[24:27], 0
v_cvt_pk_bf16_f32 v52, v36, v37
v_cvt_pk_bf16_f32 v53, v38, v39
v_mfma_f32_16x16x32_bf16 v[144:147], a[100:103], a[28:31], v[144:147]
v_accvgpr_write_b32 a216, v52
v_accvgpr_write_b32 a217, v53
v_mfma_f32_16x16x32_bf16 v[128:131], a[100:103], a[20:23], 0
v_accvgpr_write_b32 a218, v54
v_accvgpr_write_b32 a219, v55
v_mfma_f32_16x16x32_bf16 v[128:131], a[96:99], a[16:19], v[128:131]
s_add_u32 m0, s78, 147456
v_cvt_pk_bf16_f32 v84, v84, v85
v_cvt_pk_bf16_f32 v85, v86, v87
v_mfma_f32_16x16x32_bf16 v[112:115], a[96:99], a[8:11], 0
s_add_u32 s64, s75, 1179648
v_cvt_pk_bf16_f32 v86, v68, v69
v_cvt_pk_bf16_f32 v87, v70, v71
v_mfma_f32_16x16x32_bf16 v[112:115], a[100:103], a[12:15], v[112:115]
buffer_load_dwordx4 v23, s[60:63], s64 offen lds
v_mfma_f32_16x16x32_bf16 v[96:99], a[100:103], a[4:7], 0
v_accvgpr_write_b32 a220, v84
v_accvgpr_write_b32 a221, v85
v_mfma_f32_16x16x32_bf16 v[96:99], a[96:99], a[0:3], v[96:99]
v_accvgpr_write_b32 a222, v86
v_accvgpr_write_b32 a223, v87
v_mfma_f32_16x16x32_bf16 v[36:39], a[104:107], a[0:3], 0
v_cvt_pk_bf16_f32 v132, v132, v133
v_cvt_pk_bf16_f32 v133, v134, v135
v_mfma_f32_16x16x32_bf16 v[36:39], a[108:111], a[4:7], v[36:39]
v_cvt_pk_bf16_f32 v134, v148, v149
v_cvt_pk_bf16_f32 v135, v150, v151
v_mfma_f32_16x16x32_bf16 v[52:55], a[108:111], a[12:15], 0
v_accvgpr_write_b32 a224, v132
v_accvgpr_write_b32 a225, v133
v_mfma_f32_16x16x32_bf16 v[52:55], a[104:107], a[8:11], v[52:55]
v_accvgpr_write_b32 a226, v134
v_accvgpr_write_b32 a227, v135
s_add_u32 s65, s79, 14336
v_cvt_pk_bf16_f32 v103, v102, v103
v_cvt_pk_bf16_f32 v102, v100, v101
v_cvt_pk_bf16_f32 v100, v116, v117
v_cvt_pk_bf16_f32 v101, v118, v119
v_mfma_f32_16x16x32_bf16 v[68:71], a[104:107], a[16:19], 0
buffer_store_dwordx4 v[100:103], v16, s[44:47], s65 offen sc1
v_accvgpr_read_b32 v148, a120
v_accvgpr_read_b32 v149, a121
v_accvgpr_read_b32 v150, a122
v_accvgpr_read_b32 v151, a123
v_accvgpr_read_b32 v116, a124
v_accvgpr_read_b32 v117, a125
v_accvgpr_read_b32 v118, a126
v_accvgpr_read_b32 v119, a127
v_cvt_pk_bf16_f32 v119, v118, v119
v_cvt_pk_bf16_f32 v118, v116, v117
v_cvt_pk_bf16_f32 v116, v148, v149
v_cvt_pk_bf16_f32 v117, v150, v151
v_accvgpr_write_b32 a228, v116
v_accvgpr_write_b32 a229, v117
v_accvgpr_write_b32 a230, v118
v_accvgpr_write_b32 a231, v119
v_accvgpr_read_b32 v148, a132
v_accvgpr_read_b32 v149, a133
v_accvgpr_read_b32 v150, a134
v_accvgpr_read_b32 v151, a135
v_accvgpr_read_b32 v116, a128
v_accvgpr_read_b32 v117, a129
v_accvgpr_read_b32 v118, a130
v_accvgpr_read_b32 v119, a131
v_cvt_pk_bf16_f32 v119, v118, v119
v_cvt_pk_bf16_f32 v118, v116, v117
v_cvt_pk_bf16_f32 v116, v148, v149
v_cvt_pk_bf16_f32 v117, v150, v151
v_accvgpr_write_b32 a232, v116
v_accvgpr_write_b32 a233, v117
v_accvgpr_write_b32 a234, v118
v_accvgpr_write_b32 a235, v119
v_accvgpr_read_b32 v148, a140
v_accvgpr_read_b32 v149, a141
v_accvgpr_read_b32 v150, a142
v_accvgpr_read_b32 v151, a143
v_accvgpr_read_b32 v116, a136
v_accvgpr_read_b32 v117, a137
v_accvgpr_read_b32 v118, a138
v_accvgpr_read_b32 v119, a139
v_cvt_pk_bf16_f32 v119, v118, v119
v_cvt_pk_bf16_f32 v118, v116, v117
v_cvt_pk_bf16_f32 v116, v148, v149
v_cvt_pk_bf16_f32 v117, v150, v151
v_accvgpr_write_b32 a236, v116
v_accvgpr_write_b32 a237, v117
v_accvgpr_write_b32 a238, v118
v_accvgpr_write_b32 a239, v119
v_mfma_f32_16x16x32_bf16 v[68:71], a[108:111], a[20:23], v[68:71]
ds_read_b64_tr_b16 a[72:73], v19 offset:4096
v_mfma_f32_16x16x32_bf16 v[84:87], a[108:111], a[28:31], 0
ds_read_b64_tr_b16 a[74:75], v19 offset:4352
v_mfma_f32_16x16x32_bf16 v[84:87], a[104:107], a[24:27], v[84:87]
s_add_u32 m0, s77, 132096
ds_read_b64_tr_b16 a[76:77], v19 offset:6144
v_mfma_f32_16x16x32_bf16 v[148:151], a[112:115], a[24:27], 0
s_add_u32 s64, s71, 1605632
ds_read_b64_tr_b16 a[78:79], v19 offset:6400
v_mfma_f32_16x16x32_bf16 v[148:151], a[116:119], a[28:31], v[148:151]
buffer_load_dwordx4 v14, s[56:59], s64 offen lds
v_mfma_f32_16x16x32_bf16 v[132:135], a[116:119], a[20:23], 0
ds_read_b128 a[64:67], v17 offset:0
v_mfma_f32_16x16x32_bf16 v[132:135], a[112:115], a[16:19], v[132:135]
ds_read_b128 a[68:71], v18 offset:0
v_mfma_f32_16x16x32_bf16 v[116:119], a[112:115], a[8:11], 0
ds_read_b64_tr_b16 a[80:81], v21 offset:4096
v_mfma_f32_16x16x32_bf16 v[116:119], a[116:119], a[12:15], v[116:119]
ds_read_b64_tr_b16 a[82:83], v21 offset:4352
v_mfma_f32_16x16x32_bf16 v[100:103], a[116:119], a[4:7], 0
ds_read_b64_tr_b16 a[84:85], v21 offset:6144
v_mfma_f32_16x16x32_bf16 v[100:103], a[112:115], a[0:3], v[100:103]
s_waitcnt lgkmcnt(7)
s_xor_b32 s68, s66, 0
ds_read_b64_tr_b16 a[86:87], v21 offset:6400
v_mfma_f32_16x16x32_bf16 v[184:187], a[72:75], a[32:35], v[184:187]
s_waitcnt lgkmcnt(6)
s_add_u32 m0, s78, 151552
ds_read_b64_tr_b16 a[88:89], v20 offset:4096
v_mfma_f32_16x16x32_bf16 v[184:187], a[76:79], a[36:39], v[184:187]
s_add_u32 s64, s75, 1181696
ds_read_b64_tr_b16 a[90:91], v20 offset:4352
v_mfma_f32_16x16x32_bf16 v[192:195], a[76:79], a[44:47], v[192:195]
ds_read_b64_tr_b16 a[92:93], v20 offset:6144
ds_read_b64_tr_b16 a[94:95], v20 offset:6400
buffer_load_dwordx4 v23, s[60:63], s64 offen lds
v_mfma_f32_16x16x32_bf16 v[192:195], a[72:75], a[40:43], v[192:195]
buffer_atomic_add a251, v1, s[52:55], s68 offen offset:0 sc1
v_mfma_f32_16x16x32_bf16 v[200:203], a[72:75], a[48:51], v[200:203]
ds_read_b64_tr_b16 a[96:97], v19 offset:8192
v_mfma_f32_16x16x32_bf16 v[200:203], a[76:79], a[52:55], v[200:203]
s_add_u32 s65, s79, 16384
ds_read_b64_tr_b16 a[98:99], v19 offset:8448
v_mfma_f32_16x16x32_bf16 v[208:211], a[76:79], a[60:63], v[208:211]
s_add_u32 m0, s77, 133120
ds_read_b64_tr_b16 a[100:101], v19 offset:10240
v_mfma_f32_16x16x32_bf16 v[208:211], a[72:75], a[56:59], v[208:211]
s_waitcnt lgkmcnt(9)
s_add_u32 s64, s71, 1638400
ds_read_b64_tr_b16 a[102:103], v19 offset:10496
v_mfma_f32_16x16x32_bf16 v[248:251], a[80:83], a[64:67], v[248:251]
s_waitcnt lgkmcnt(8)
buffer_load_dwordx4 v15, s[56:59], s64 offen lds
v_mfma_f32_16x16x32_bf16 v[248:251], a[84:87], a[68:71], v[248:251]
s_waitcnt lgkmcnt(4)
buffer_store_dwordx4 a[144:147], v16, s[44:47], s65 offen sc1
v_mfma_f32_16x16x32_bf16 v[212:215], a[92:95], a[60:63], v[212:215]
ds_read_b64_tr_b16 a[104:105], v21 offset:8192
v_mfma_f32_16x16x32_bf16 v[212:215], a[88:91], a[56:59], v[212:215]
ds_read_b64_tr_b16 a[106:107], v21 offset:8448
v_mfma_f32_16x16x32_bf16 v[204:207], a[88:91], a[48:51], v[204:207]
s_add_u32 m0, s78, 155648
ds_read_b64_tr_b16 a[108:109], v21 offset:10240
v_mfma_f32_16x16x32_bf16 v[204:207], a[92:95], a[52:55], v[204:207]
s_add_u32 s64, s75, 1183744
ds_read_b64_tr_b16 a[110:111], v21 offset:10496
v_mfma_f32_16x16x32_bf16 v[196:199], a[92:95], a[44:47], v[196:199]
buffer_load_dwordx4 v23, s[60:63], s64 offen lds
v_mfma_f32_16x16x32_bf16 v[196:199], a[88:91], a[40:43], v[196:199]
ds_read_b64_tr_b16 a[112:113], v20 offset:8192
v_mfma_f32_16x16x32_bf16 v[188:191], a[88:91], a[32:35], v[188:191]
ds_read_b64_tr_b16 a[114:115], v20 offset:8448
v_mfma_f32_16x16x32_bf16 v[188:191], a[92:95], a[36:39], v[188:191]
s_waitcnt lgkmcnt(6)
ds_read_b64_tr_b16 a[116:117], v20 offset:10240
v_mfma_f32_16x16x32_bf16 v[216:219], a[36:39], a[100:103], v[216:219]
ds_read_b64_tr_b16 a[118:119], v20 offset:10496
v_mfma_f32_16x16x32_bf16 v[216:219], a[32:35], a[96:99], v[216:219]
s_add_u32 m0, s77, 134144
ds_read_b64_tr_b16 a[72:73], v19 offset:0
v_mfma_f32_16x16x32_bf16 v[224:227], a[40:43], a[96:99], v[224:227]
s_add_u32 s64, s71, 1671168
ds_read_b64_tr_b16 a[74:75], v19 offset:256
v_mfma_f32_16x16x32_bf16 v[224:227], a[44:47], a[100:103], v[224:227]
buffer_load_dwordx4 v15, s[56:59], s64 offen lds
v_mfma_f32_16x16x32_bf16 v[232:235], a[52:55], a[100:103], v[232:235]
s_add_u32 s17, s78, .-L_pc+6144
ds_read_b64_tr_b16 a[76:77], v19 offset:2048
v_mfma_f32_16x16x32_bf16 v[232:235], a[48:51], a[96:99], v[232:235]
s_xor_b32 s68, s66, 4096
ds_read_b64_tr_b16 a[78:79], v19 offset:2304
v_mfma_f32_16x16x32_bf16 v[240:243], a[56:59], a[96:99], v[240:243]
buffer_load_dword a252, v16, s[88:91], s17 offen
v_mfma_f32_16x16x32_bf16 v[240:243], a[60:63], a[100:103], v[240:243]
s_waitcnt lgkmcnt(7)
buffer_atomic_add a251, v1, s[52:55], s68 offen offset:0 sc1
v_mfma_f32_16x16x32_bf16 v[252:255], a[68:71], a[108:111], v[252:255]
ds_read_b64_tr_b16 a[80:81], v20 offset:0
v_mfma_f32_16x16x32_bf16 v[252:255], a[64:67], a[104:107], v[252:255]
s_waitcnt lgkmcnt(6)
s_add_u32 m0, s78, 159744
ds_read_b64_tr_b16 a[82:83], v20 offset:256
v_mfma_f32_16x16x32_bf16 v[244:247], a[56:59], a[112:115], v[244:247]
s_waitcnt lgkmcnt(6)
s_add_u32 s64, s74, 384
ds_read_b64_tr_b16 a[84:85], v20 offset:2048
v_mfma_f32_16x16x32_bf16 v[244:247], a[60:63], a[116:119], v[244:247]
buffer_load_dwordx4 v22, s[48:51], s64 offen lds
v_mfma_f32_16x16x32_bf16 v[236:239], a[52:55], a[116:119], v[236:239]
s_add_u32 s65, s79, 4096
ds_read_b64_tr_b16 a[86:87], v20 offset:2304
v_mfma_f32_16x16x32_bf16 v[236:239], a[48:51], a[112:115], v[236:239]
buffer_store_dwordx4 a[148:151], v16, s[44:47], s65 offen sc1
v_mfma_f32_16x16x32_bf16 v[228:231], a[40:43], a[112:115], v[228:231]
ds_read_b64_tr_b16 a[88:89], v4 offset:0
v_mfma_f32_16x16x32_bf16 v[228:231], a[44:47], a[116:119], v[228:231]
ds_read_b64_tr_b16 a[90:91], v4 offset:1024
v_mfma_f32_16x16x32_bf16 v[220:223], a[36:39], a[116:119], v[220:223]
ds_read_b64_tr_b16 a[92:93], v4 offset:8192
v_mfma_f32_16x16x32_bf16 v[220:223], a[32:35], a[112:115], v[220:223]
s_waitcnt lgkmcnt(7)
ds_read_b64_tr_b16 a[94:95], v4 offset:9216
v_mfma_f32_16x16x32_bf16 v[152:155], a[72:75], a[32:35], v[152:155]
ds_read_b64_tr_b16 a[96:97], v5 offset:0
v_mfma_f32_16x16x32_bf16 v[152:155], a[76:79], a[36:39], v[152:155]
ds_read_b64_tr_b16 a[98:99], v5 offset:1024
v_mfma_f32_16x16x32_bf16 v[160:163], a[76:79], a[44:47], v[160:163]
s_add_u32 m0, s76, 32768
ds_read_b64_tr_b16 a[100:101], v5 offset:8192
v_mfma_f32_16x16x32_bf16 v[160:163], a[72:75], a[40:43], v[160:163]
s_add_u32 s64, s72, 384
ds_read_b64_tr_b16 a[102:103], v5 offset:9216
v_mfma_f32_16x16x32_bf16 v[168:171], a[72:75], a[48:51], v[168:171]
buffer_load_dwordx4 v12, s[48:51], s64 offen lds
v_mfma_f32_16x16x32_bf16 v[168:171], a[76:79], a[52:55], v[168:171]
ds_read_b64_tr_b16 a[104:105], v6 offset:0
v_mfma_f32_16x16x32_bf16 v[176:179], a[76:79], a[60:63], v[176:179]
s_add_u32 s65, s79, 0
ds_read_b64_tr_b16 a[106:107], v6 offset:1024
v_mfma_f32_16x16x32_bf16 v[176:179], a[72:75], a[56:59], v[176:179]
s_waitcnt lgkmcnt(8)
s_add_u32 m0, s76, 33792
ds_read_b64_tr_b16 a[108:109], v6 offset:8192
v_mfma_f32_16x16x32_bf16 v[180:183], a[80:83], a[56:59], v[180:183]
s_add_u32 s64, s72, 16768
ds_read_b64_tr_b16 a[110:111], v6 offset:9216
v_mfma_f32_16x16x32_bf16 v[180:183], a[84:87], a[60:63], v[180:183]
buffer_load_dwordx4 v13, s[48:51], s64 offen lds
v_mfma_f32_16x16x32_bf16 v[172:175], a[84:87], a[52:55], v[172:175]
buffer_store_dwordx4 a[152:155], v16, s[44:47], s65 offen sc1
v_mfma_f32_16x16x32_bf16 v[172:175], a[80:83], a[48:51], v[172:175]
ds_read_b64_tr_b16 a[112:113], v7 offset:0
v_mfma_f32_16x16x32_bf16 v[164:167], a[80:83], a[40:43], v[164:167]
ds_read_b64_tr_b16 a[114:115], v7 offset:1024
v_mfma_f32_16x16x32_bf16 v[164:167], a[84:87], a[44:47], v[164:167]
s_add_u32 m0, s76, 34816
ds_read_b64_tr_b16 a[116:117], v7 offset:8192
v_mfma_f32_16x16x32_bf16 v[156:159], a[84:87], a[36:39], v[156:159]
s_add_u32 s64, s72, 131456
ds_read_b64_tr_b16 a[118:119], v7 offset:9216
v_mfma_f32_16x16x32_bf16 v[156:159], a[80:83], a[32:35], v[156:159]
buffer_load_dwordx4 v12, s[48:51], s64 offen lds
v_mfma_f32_16x16x32_bf16 v[24:27], a[88:91], a[32:35], v[24:27]
s_waitcnt lgkmcnt(6)
ds_read_b64_tr_b16 a[72:73], v8 offset:0
v_mfma_f32_16x16x32_bf16 v[24:27], a[92:95], a[36:39], v[24:27]
s_add_u32 m0, s76, 35840
ds_read_b64_tr_b16 a[74:75], v8 offset:1024
v_mfma_f32_16x16x32_bf16 v[40:43], a[92:95], a[44:47], v[40:43]
s_waitcnt vmcnt(19)
ds_read_b64_tr_b16 a[76:77], v8 offset:8192
v_mfma_f32_16x16x32_bf16 v[40:43], a[88:91], a[40:43], v[40:43]
s_add_u32 s64, s72, 147840
ds_read_b64_tr_b16 a[78:79], v8 offset:9216
v_mfma_f32_16x16x32_bf16 v[56:59], a[88:91], a[48:51], v[56:59]
buffer_load_dwordx4 v13, s[48:51], s64 offen lds
v_mfma_f32_16x16x32_bf16 v[56:59], a[92:95], a[52:55], v[56:59]
ds_read_b64_tr_b16 a[80:81], v9 offset:0
v_mfma_f32_16x16x32_bf16 v[72:75], a[92:95], a[60:63], v[72:75]
ds_read_b64_tr_b16 a[82:83], v9 offset:1024
v_mfma_f32_16x16x32_bf16 v[72:75], a[88:91], a[56:59], v[72:75]
ds_read_b64_tr_b16 a[84:85], v9 offset:8192
v_mfma_f32_16x16x32_bf16 v[136:139], a[96:99], a[56:59], v[136:139]
s_add_u32 m0, s76, 36864
ds_read_b64_tr_b16 a[86:87], v9 offset:9216
v_mfma_f32_16x16x32_bf16 v[136:139], a[100:103], a[60:63], v[136:139]
s_add_u32 s64, s73, 384
ds_read_b128 a[0:3], v2 offset:0
v_mfma_f32_16x16x32_bf16 v[120:123], a[100:103], a[52:55], v[120:123]
buffer_load_dwordx4 v12, s[48:51], s64 offen lds
v_mfma_f32_16x16x32_bf16 v[120:123], a[96:99], a[48:51], v[120:123]
ds_read_b128 a[4:7], v3 offset:0
v_mfma_f32_16x16x32_bf16 v[104:107], a[96:99], a[40:43], v[104:107]
ds_read_b128 a[8:11], v2 offset:2048
v_mfma_f32_16x16x32_bf16 v[104:107], a[100:103], a[44:47], v[104:107]
s_add_u32 m0, s76, 37888
ds_read_b128 a[12:15], v3 offset:2048
v_mfma_f32_16x16x32_bf16 v[88:91], a[100:103], a[36:39], v[88:91]
s_add_u32 s64, s73, 16768
ds_read_b128 a[16:19], v2 offset:4096
v_mfma_f32_16x16x32_bf16 v[88:91], a[96:99], a[32:35], v[88:91]
buffer_load_dwordx4 v13, s[48:51], s64 offen lds
v_mfma_f32_16x16x32_bf16 v[28:31], a[104:107], a[32:35], v[28:31]
s_waitcnt lgkmcnt(7)
ds_read_b128 a[20:23], v3 offset:4096
v_mfma_f32_16x16x32_bf16 v[28:31], a[108:111], a[36:39], v[28:31]
ds_read_b128 a[24:27], v2 offset:6144
v_mfma_f32_16x16x32_bf16 v[44:47], a[108:111], a[44:47], v[44:47]
ds_read_b128 a[28:31], v3 offset:6144
v_mfma_f32_16x16x32_bf16 v[44:47], a[104:107], a[40:43], v[44:47]
s_add_u32 m0, s76, 38912
ds_read_b64_tr_b16 a[88:89], v10 offset:0
v_mfma_f32_16x16x32_bf16 v[60:63], a[104:107], a[48:51], v[60:63]
s_add_u32 s64, s73, 131456
ds_read_b64_tr_b16 a[90:91], v10 offset:1024
v_mfma_f32_16x16x32_bf16 v[60:63], a[108:111], a[52:55], v[60:63]
buffer_load_dwordx4 v12, s[48:51], s64 offen lds
v_mfma_f32_16x16x32_bf16 v[76:79], a[108:111], a[60:63], v[76:79]
ds_read_b64_tr_b16 a[92:93], v10 offset:8192
v_mfma_f32_16x16x32_bf16 v[76:79], a[104:107], a[56:59], v[76:79]
ds_read_b64_tr_b16 a[94:95], v10 offset:9216
v_mfma_f32_16x16x32_bf16 v[140:143], a[112:115], a[56:59], v[140:143]
ds_read_b64_tr_b16 a[96:97], v11 offset:0
v_mfma_f32_16x16x32_bf16 v[140:143], a[116:119], a[60:63], v[140:143]
ds_read_b64_tr_b16 a[98:99], v11 offset:1024
v_mfma_f32_16x16x32_bf16 v[124:127], a[116:119], a[52:55], v[124:127]
s_add_u32 m0, s76, 39936
ds_read_b64_tr_b16 a[100:101], v11 offset:8192
v_mfma_f32_16x16x32_bf16 v[124:127], a[112:115], a[48:51], v[124:127]
s_add_u32 s64, s73, 147840
ds_read_b64_tr_b16 a[102:103], v11 offset:9216
v_mfma_f32_16x16x32_bf16 v[108:111], a[112:115], a[40:43], v[108:111]
buffer_load_dwordx4 v13, s[48:51], s64 offen lds
v_mfma_f32_16x16x32_bf16 v[108:111], a[116:119], a[44:47], v[108:111]
v_mfma_f32_16x16x32_bf16 v[92:95], a[116:119], a[36:39], v[92:95]
v_mfma_f32_16x16x32_bf16 v[92:95], a[112:115], a[32:35], v[92:95]
v_mfma_f32_16x16x32_bf16 v[32:35], a[72:75], a[32:35], v[32:35]
v_mfma_f32_16x16x32_bf16 v[32:35], a[76:79], a[36:39], v[32:35]
v_mfma_f32_16x16x32_bf16 v[48:51], a[76:79], a[44:47], v[48:51]
s_waitcnt lgkmcnt(0)
s_barrier
v_mfma_f32_16x16x32_bf16 v[48:51], a[72:75], a[40:43], v[48:51]
s_add_u32 m0, s77, 65536
ds_read_b64_tr_b16 a[104:105], v19 offset:36864
v_mfma_f32_16x16x32_bf16 v[64:67], a[72:75], a[48:51], v[64:67]
s_add_u32 s64, s71, 2097152
ds_read_b64_tr_b16 a[106:107], v19 offset:37120
v_mfma_f32_16x16x32_bf16 v[64:67], a[76:79], a[52:55], v[64:67]
buffer_load_dwordx4 v14, s[56:59], s64 offen lds
v_mfma_f32_16x16x32_bf16 v[80:83], a[76:79], a[60:63], v[80:83]
ds_read_b64_tr_b16 a[108:109], v19 offset:38912
v_mfma_f32_16x16x32_bf16 v[80:83], a[72:75], a[56:59], v[80:83]
ds_read_b64_tr_b16 a[110:111], v19 offset:39168
v_mfma_f32_16x16x32_bf16 v[144:147], a[80:83], a[56:59], v[144:147]
ds_read_b128 a[64:67], v17 offset:32768
v_mfma_f32_16x16x32_bf16 v[144:147], a[84:87], a[60:63], v[144:147]
s_add_u32 s65, s79, 17408
ds_read_b128 a[68:71], v18 offset:32768
v_mfma_f32_16x16x32_bf16 v[128:131], a[84:87], a[52:55], v[128:131]
buffer_store_dwordx4 a[156:159], v16, s[44:47], s65 offen sc1
v_mfma_f32_16x16x32_bf16 v[128:131], a[80:83], a[48:51], v[128:131]
s_add_u32 m0, s78, 81920
ds_read_b64_tr_b16 a[112:113], v21 offset:36864
v_mfma_f32_16x16x32_bf16 v[112:115], a[80:83], a[40:43], v[112:115]
s_add_u32 s64, s75, 1572864
ds_read_b64_tr_b16 a[114:115], v21 offset:37120
v_mfma_f32_16x16x32_bf16 v[112:115], a[84:87], a[44:47], v[112:115]
buffer_load_dwordx4 v23, s[60:63], s64 offen lds
v_mfma_f32_16x16x32_bf16 v[96:99], a[84:87], a[36:39], v[96:99]
ds_read_b64_tr_b16 a[116:117], v21 offset:38912
v_mfma_f32_16x16x32_bf16 v[96:99], a[80:83], a[32:35], v[96:99]
ds_read_b64_tr_b16 a[118:119], v21 offset:39168
v_mfma_f32_16x16x32_bf16 v[36:39], a[88:91], a[32:35], v[36:39]
ds_read_b64_tr_b16 a[72:73], v20 offset:36864
v_mfma_f32_16x16x32_bf16 v[36:39], a[92:95], a[36:39], v[36:39]
ds_read_b64_tr_b16 a[74:75], v20 offset:37120
v_mfma_f32_16x16x32_bf16 v[52:55], a[92:95], a[44:47], v[52:55]
s_xor_b32 s68, s66, 8192
ds_read_b64_tr_b16 a[76:77], v20 offset:38912
v_mfma_f32_16x16x32_bf16 v[52:55], a[88:91], a[40:43], v[52:55]
s_add_u32 m0, s77, 66560
ds_read_b64_tr_b16 a[78:79], v20 offset:39168
v_mfma_f32_16x16x32_bf16 v[68:71], a[88:91], a[48:51], v[68:71]
s_add_u32 s64, s71, 2129920
ds_read_b64_tr_b16 a[80:81], v19 offset:40960
v_mfma_f32_16x16x32_bf16 v[68:71], a[92:95], a[52:55], v[68:71]
buffer_load_dwordx4 v14, s[56:59], s64 offen lds
v_mfma_f32_16x16x32_bf16 v[84:87], a[92:95], a[60:63], v[84:87]
buffer_atomic_add a251, v1, s[52:55], s68 offen offset:0 sc1
v_mfma_f32_16x16x32_bf16 v[84:87], a[88:91], a[56:59], v[84:87]
ds_read_b64_tr_b16 a[82:83], v19 offset:41216
v_mfma_f32_16x16x32_bf16 v[148:151], a[96:99], a[56:59], v[148:151]
ds_read_b64_tr_b16 a[84:85], v19 offset:43008
v_mfma_f32_16x16x32_bf16 v[148:151], a[100:103], a[60:63], v[148:151]
ds_read_b64_tr_b16 a[86:87], v19 offset:43264
v_mfma_f32_16x16x32_bf16 v[132:135], a[100:103], a[52:55], v[132:135]
ds_read_b64_tr_b16 a[88:89], v21 offset:40960
v_mfma_f32_16x16x32_bf16 v[132:135], a[96:99], a[48:51], v[132:135]
s_add_u32 m0, s78, 86016
ds_read_b64_tr_b16 a[90:91], v21 offset:41216
v_mfma_f32_16x16x32_bf16 v[116:119], a[96:99], a[40:43], v[116:119]
s_add_u32 s64, s75, 1574912
ds_read_b64_tr_b16 a[92:93], v21 offset:43008
v_mfma_f32_16x16x32_bf16 v[116:119], a[100:103], a[44:47], v[116:119]
buffer_load_dwordx4 v23, s[60:63], s64 offen lds
v_mfma_f32_16x16x32_bf16 v[100:103], a[100:103], a[36:39], v[100:103]
ds_read_b64_tr_b16 a[94:95], v21 offset:43264
v_mfma_f32_16x16x32_bf16 v[100:103], a[96:99], a[32:35], v[100:103]
s_waitcnt lgkmcnt(7)
ds_read_b64_tr_b16 a[96:97], v20 offset:40960
v_mfma_f32_16x16x32_bf16 v[184:187], a[104:107], a[0:3], v[184:187]
s_add_u32 s17, s78, .-L_pc+6144
ds_read_b64_tr_b16 a[98:99], v20 offset:41216
v_mfma_f32_16x16x32_bf16 v[184:187], a[108:111], a[4:7], v[184:187]
ds_read_b64_tr_b16 a[100:101], v20 offset:43008
v_add_u32 v17, 0x8000, v17
v_mfma_f32_16x16x32_bf16 v[192:195], a[108:111], a[12:15], v[192:195]
ds_read_b64_tr_b16 a[102:103], v20 offset:43264
v_add_u32 v18, 0x8000, v18
v_mfma_f32_16x16x32_bf16 v[192:195], a[104:107], a[8:11], v[192:195]
s_add_u32 m0, s77, 67584
v_mfma_f32_16x16x32_bf16 v[200:203], a[104:107], a[16:19], v[200:203]
s_add_u32 s64, s71, 2162688
buffer_load_dword a252, v16, s[88:91], s17 offen
v_mfma_f32_16x16x32_bf16 v[200:203], a[108:111], a[20:23], v[200:203]
s_add_u32 s65, s79, 5120
buffer_load_dwordx4 v15, s[56:59], s64 offen lds
v_mfma_f32_16x16x32_bf16 v[208:211], a[108:111], a[28:31], v[208:211]
buffer_store_dwordx4 a[160:163], v16, s[44:47], s65 offen sc1
v_mfma_f32_16x16x32_bf16 v[208:211], a[104:107], a[24:27], v[208:211]
ds_read_b64_tr_b16 a[104:105], v19 offset:32768
v_mfma_f32_16x16x32_bf16 v[248:251], a[112:115], a[64:67], v[248:251]
ds_read_b64_tr_b16 a[106:107], v19 offset:33024
v_mfma_f32_16x16x32_bf16 v[248:251], a[116:119], a[68:71], v[248:251]
ds_read_b64_tr_b16 a[108:109], v19 offset:34816
v_mfma_f32_16x16x32_bf16 v[212:215], a[76:79], a[28:31], v[212:215]
ds_read_b64_tr_b16 a[110:111], v19 offset:35072
v_mfma_f32_16x16x32_bf16 v[212:215], a[72:75], a[24:27], v[212:215]
s_add_u32 m0, s78, 90112
ds_read_b64_tr_b16 a[112:113], v20 offset:32768
v_mfma_f32_16x16x32_bf16 v[204:207], a[72:75], a[16:19], v[204:207]
s_add_u32 s64, s75, 1576960
ds_read_b64_tr_b16 a[114:115], v20 offset:33024
v_mfma_f32_16x16x32_bf16 v[204:207], a[76:79], a[20:23], v[204:207]
buffer_load_dwordx4 v23, s[60:63], s64 offen lds
v_mfma_f32_16x16x32_bf16 v[196:199], a[76:79], a[12:15], v[196:199]
ds_read_b64_tr_b16 a[116:117], v20 offset:34816
v_mfma_f32_16x16x32_bf16 v[196:199], a[72:75], a[8:11], v[196:199]
ds_read_b64_tr_b16 a[118:119], v20 offset:35072
v_mfma_f32_16x16x32_bf16 v[188:191], a[72:75], a[0:3], v[188:191]
s_xor_b32 s68, s66, 12288
v_mfma_f32_16x16x32_bf16 v[188:191], a[76:79], a[4:7], v[188:191]
s_waitcnt lgkmcnt(7)
s_add_u32 m0, s77, 68608
ds_read_b64_tr_b16 a[72:73], v4 offset:32768
v_mfma_f32_16x16x32_bf16 v[216:219], a[4:7], a[84:87], v[216:219]
buffer_atomic_add a251, v1, s[52:55], s68 offen offset:0 sc1
v_mfma_f32_16x16x32_bf16 v[216:219], a[0:3], a[80:83], v[216:219]
ds_read_b64_tr_b16 a[74:75], v4 offset:33792
v_add_u32 v21, 0x8000, v21
v_mfma_f32_16x16x32_bf16 v[224:227], a[8:11], a[80:83], v[224:227]
s_add_u32 s64, s71, 2195456
ds_read_b64_tr_b16 a[76:77], v4 offset:40960
v_mfma_f32_16x16x32_bf16 v[224:227], a[12:15], a[84:87], v[224:227]
buffer_load_dwordx4 v15, s[56:59], s64 offen lds
v_mfma_f32_16x16x32_bf16 v[232:235], a[20:23], a[84:87], v[232:235]
ds_read_b64_tr_b16 a[78:79], v4 offset:41984
v_mfma_f32_16x16x32_bf16 v[232:235], a[16:19], a[80:83], v[232:235]
v_mfma_f32_16x16x32_bf16 v[240:243], a[24:27], a[80:83], v[240:243]
v_mfma_f32_16x16x32_bf16 v[240:243], a[28:31], a[84:87], v[240:243]
ds_read_b64_tr_b16 a[80:81], v5 offset:32768
v_mfma_f32_16x16x32_bf16 v[252:255], a[68:71], a[92:95], v[252:255]
ds_read_b64_tr_b16 a[82:83], v5 offset:33792
v_mfma_f32_16x16x32_bf16 v[252:255], a[64:67], a[88:91], v[252:255]
s_add_u32 m0, s78, 94208
ds_read_b64_tr_b16 a[84:85], v5 offset:40960
v_mfma_f32_16x16x32_bf16 v[244:247], a[24:27], a[96:99], v[244:247]
s_add_u32 s64, s74, 512
ds_read_b64_tr_b16 a[86:87], v5 offset:41984
v_mfma_f32_16x16x32_bf16 v[244:247], a[28:31], a[100:103], v[244:247]
buffer_load_dwordx4 v22, s[48:51], s64 offen lds
v_mfma_f32_16x16x32_bf16 v[236:239], a[20:23], a[100:103], v[236:239]
ds_read_b64_tr_b16 a[88:89], v6 offset:32768
v_add_u32 v19, 0x8000, v19
v_mfma_f32_16x16x32_bf16 v[236:239], a[16:19], a[96:99], v[236:239]
ds_read_b64_tr_b16 a[90:91], v6 offset:33792
v_mfma_f32_16x16x32_bf16 v[228:231], a[8:11], a[96:99], v[228:231]
ds_read_b64_tr_b16 a[92:93], v6 offset:40960
v_mfma_f32_16x16x32_bf16 v[228:231], a[12:15], a[100:103], v[228:231]
s_add_u32 s65, s79, 1024
ds_read_b64_tr_b16 a[94:95], v6 offset:41984
v_mfma_f32_16x16x32_bf16 v[220:223], a[4:7], a[100:103], v[220:223]
buffer_store_dwordx4 a[164:167], v16, s[44:47], s65 offen sc1
v_mfma_f32_16x16x32_bf16 v[220:223], a[0:3], a[96:99], v[220:223]
s_waitcnt lgkmcnt(7)
ds_read_b64_tr_b16 a[96:97], v7 offset:32768
v_mfma_f32_16x16x32_bf16 v[152:155], a[104:107], a[0:3], v[152:155]
ds_read_b64_tr_b16 a[98:99], v7 offset:33792
v_mfma_f32_16x16x32_bf16 v[152:155], a[108:111], a[4:7], v[152:155]
ds_read_b64_tr_b16 a[100:101], v7 offset:40960
v_add_u32 v20, 0x8000, v20
v_mfma_f32_16x16x32_bf16 v[160:163], a[108:111], a[12:15], v[160:163]
s_add_u32 m0, s76, 0
ds_read_b64_tr_b16 a[102:103], v7 offset:41984
v_mfma_f32_16x16x32_bf16 v[160:163], a[104:107], a[8:11], v[160:163]
s_add_u32 s64, s72, 512
v_mfma_f32_16x16x32_bf16 v[168:171], a[104:107], a[16:19], v[168:171]
buffer_load_dwordx4 v12, s[48:51], s64 offen lds
v_mfma_f32_16x16x32_bf16 v[168:171], a[108:111], a[20:23], v[168:171]
v_mfma_f32_16x16x32_bf16 v[176:179], a[108:111], a[28:31], v[176:179]
v_mfma_f32_16x16x32_bf16 v[176:179], a[104:107], a[24:27], v[176:179]
s_add_u32 m0, s76, 1024
ds_read_b64_tr_b16 a[104:105], v8 offset:32768
v_mfma_f32_16x16x32_bf16 v[180:183], a[112:115], a[24:27], v[180:183]
s_add_u32 s64, s72, 16896
ds_read_b64_tr_b16 a[106:107], v8 offset:33792
v_mfma_f32_16x16x32_bf16 v[180:183], a[116:119], a[28:31], v[180:183]
buffer_load_dwordx4 v13, s[48:51], s64 offen lds
v_mfma_f32_16x16x32_bf16 v[172:175], a[116:119], a[20:23], v[172:175]
ds_read_b64_tr_b16 a[108:109], v8 offset:40960
v_add_u32 v4, 0x8000, v4
v_mfma_f32_16x16x32_bf16 v[172:175], a[112:115], a[16:19], v[172:175]
ds_read_b64_tr_b16 a[110:111], v8 offset:41984
v_mfma_f32_16x16x32_bf16 v[164:167], a[112:115], a[8:11], v[164:167]
v_mfma_f32_16x16x32_bf16 v[164:167], a[116:119], a[12:15], v[164:167]
s_add_u32 m0, s76, 2048
v_mfma_f32_16x16x32_bf16 v[156:159], a[116:119], a[4:7], v[156:159]
s_add_u32 s64, s72, 131584
v_mfma_f32_16x16x32_bf16 v[156:159], a[112:115], a[0:3], v[156:159]
buffer_load_dwordx4 v12, s[48:51], s64 offen lds
v_mfma_f32_16x16x32_bf16 v[24:27], a[72:75], a[0:3], v[24:27]
s_add_u32 m0, s76, 3072
ds_read_b64_tr_b16 a[112:113], v9 offset:32768
v_mfma_f32_16x16x32_bf16 v[24:27], a[76:79], a[4:7], v[24:27]
ds_read_b64_tr_b16 a[114:115], v9 offset:33792
v_add_u32 v5, 0x8000, v5
v_mfma_f32_16x16x32_bf16 v[40:43], a[76:79], a[12:15], v[40:43]
s_waitcnt vmcnt(17)
ds_read_b64_tr_b16 a[116:117], v9 offset:40960
v_mfma_f32_16x16x32_bf16 v[40:43], a[72:75], a[8:11], v[40:43]
s_add_u32 s64, s72, 147968
ds_read_b64_tr_b16 a[118:119], v9 offset:41984
v_mfma_f32_16x16x32_bf16 v[56:59], a[72:75], a[16:19], v[56:59]
buffer_load_dwordx4 v13, s[48:51], s64 offen lds
v_mfma_f32_16x16x32_bf16 v[56:59], a[76:79], a[20:23], v[56:59]
ds_read_b128 a[32:35], v2 offset:32768
v_mfma_f32_16x16x32_bf16 v[72:75], a[76:79], a[28:31], v[72:75]
ds_read_b128 a[36:39], v3 offset:32768
v_mfma_f32_16x16x32_bf16 v[72:75], a[72:75], a[24:27], v[72:75]
s_waitcnt lgkmcnt(6)
s_add_u32 m0, s76, 4096
ds_read_b128 a[40:43], v2 offset:34816
v_mfma_f32_16x16x32_bf16 v[136:139], a[80:83], a[24:27], v[136:139]
s_add_u32 s64, s73, 512
ds_read_b128 a[44:47], v3 offset:34816
v_mfma_f32_16x16x32_bf16 v[136:139], a[84:87], a[28:31], v[136:139]
ds_read_b128 a[48:51], v2 offset:36864
v_add_u32 v6, 0x8000, v6
v_mfma_f32_16x16x32_bf16 v[120:123], a[84:87], a[20:23], v[120:123]
buffer_load_dwordx4 v12, s[48:51], s64 offen lds
v_mfma_f32_16x16x32_bf16 v[120:123], a[80:83], a[16:19], v[120:123]
ds_read_b128 a[52:55], v3 offset:36864
v_mfma_f32_16x16x32_bf16 v[104:107], a[80:83], a[8:11], v[104:107]
ds_read_b128 a[56:59], v2 offset:38912
v_mfma_f32_16x16x32_bf16 v[104:107], a[84:87], a[12:15], v[104:107]
s_add_u32 m0, s76, 5120
ds_read_b128 a[60:63], v3 offset:38912
v_mfma_f32_16x16x32_bf16 v[88:91], a[84:87], a[4:7], v[88:91]
s_add_u32 s64, s73, 16896
ds_read_b64_tr_b16 a[72:73], v10 offset:32768
v_mfma_f32_16x16x32_bf16 v[88:91], a[80:83], a[0:3], v[88:91]
buffer_load_dwordx4 v13, s[48:51], s64 offen lds
v_mfma_f32_16x16x32_bf16 v[28:31], a[88:91], a[0:3], v[28:31]
ds_read_b64_tr_b16 a[74:75], v10 offset:33792
v_mfma_f32_16x16x32_bf16 v[28:31], a[92:95], a[4:7], v[28:31]
ds_read_b64_tr_b16 a[76:77], v10 offset:40960
v_add_u32 v7, 0x8000, v7
v_mfma_f32_16x16x32_bf16 v[44:47], a[92:95], a[12:15], v[44:47]
ds_read_b64_tr_b16 a[78:79], v10 offset:41984
v_mfma_f32_16x16x32_bf16 v[44:47], a[88:91], a[8:11], v[44:47]
s_add_u32 m0, s76, 6144
ds_read_b64_tr_b16 a[80:81], v11 offset:32768
v_mfma_f32_16x16x32_bf16 v[60:63], a[88:91], a[16:19], v[60:63]
s_add_u32 s64, s73, 131584
ds_read_b64_tr_b16 a[82:83], v11 offset:33792
v_mfma_f32_16x16x32_bf16 v[60:63], a[92:95], a[20:23], v[60:63]
buffer_load_dwordx4 v12, s[48:51], s64 offen lds
v_mfma_f32_16x16x32_bf16 v[76:79], a[92:95], a[28:31], v[76:79]
ds_read_b64_tr_b16 a[84:85], v11 offset:40960
v_mfma_f32_16x16x32_bf16 v[76:79], a[88:91], a[24:27], v[76:79]
ds_read_b64_tr_b16 a[86:87], v11 offset:41984
v_mfma_f32_16x16x32_bf16 v[140:143], a[96:99], a[24:27], v[140:143]
s_add_u32 m0, s76, 7168
v_mfma_f32_16x16x32_bf16 v[140:143], a[100:103], a[28:31], v[140:143]
s_add_u32 s64, s73, 147968
v_add_u32 v8, 0x8000, v8
v_mfma_f32_16x16x32_bf16 v[124:127], a[100:103], a[20:23], v[124:127]
buffer_load_dwordx4 v13, s[48:51], s64 offen lds
v_mfma_f32_16x16x32_bf16 v[124:127], a[96:99], a[16:19], v[124:127]
v_mfma_f32_16x16x32_bf16 v[108:111], a[96:99], a[8:11], v[108:111]
v_mfma_f32_16x16x32_bf16 v[108:111], a[100:103], a[12:15], v[108:111]
v_mfma_f32_16x16x32_bf16 v[92:95], a[100:103], a[4:7], v[92:95]
v_add_u32 v9, 0x8000, v9
v_add_u32 v10, 0x8000, v10
v_mfma_f32_16x16x32_bf16 v[92:95], a[96:99], a[0:3], v[92:95]
v_add_u32 v11, 0x8000, v11
v_mfma_f32_16x16x32_bf16 v[32:35], a[104:107], a[0:3], v[32:35]
v_mfma_f32_16x16x32_bf16 v[32:35], a[108:111], a[4:7], v[32:35]
v_mfma_f32_16x16x32_bf16 v[48:51], a[108:111], a[12:15], v[48:51]
s_waitcnt lgkmcnt(0)
s_barrier
v_mfma_f32_16x16x32_bf16 v[48:51], a[104:107], a[8:11], v[48:51]
s_add_u32 m0, s77, 98304
ds_read_b64_tr_b16 a[88:89], v19 offset:36864
v_mfma_f32_16x16x32_bf16 v[64:67], a[104:107], a[16:19], v[64:67]
s_add_u32 s64, s71, 2621440
ds_read_b64_tr_b16 a[90:91], v19 offset:37120
v_mfma_f32_16x16x32_bf16 v[64:67], a[108:111], a[20:23], v[64:67]
buffer_load_dwordx4 v14, s[56:59], s64 offen lds
v_mfma_f32_16x16x32_bf16 v[80:83], a[108:111], a[28:31], v[80:83]
ds_read_b64_tr_b16 a[92:93], v19 offset:38912
v_mfma_f32_16x16x32_bf16 v[80:83], a[104:107], a[24:27], v[80:83]
ds_read_b64_tr_b16 a[94:95], v19 offset:39168
v_mfma_f32_16x16x32_bf16 v[144:147], a[112:115], a[24:27], v[144:147]
ds_read_b128 a[64:67], v17 offset:32768
v_mfma_f32_16x16x32_bf16 v[144:147], a[116:119], a[28:31], v[144:147]
s_add_u32 s65, s79, 18432
ds_read_b128 a[68:71], v18 offset:32768
v_mfma_f32_16x16x32_bf16 v[128:131], a[116:119], a[20:23], v[128:131]
buffer_store_dwordx4 a[168:171], v16, s[44:47], s65 offen sc1
v_mfma_f32_16x16x32_bf16 v[128:131], a[112:115], a[16:19], v[128:131]
s_add_u32 m0, s78, 114688
ds_read_b64_tr_b16 a[96:97], v21 offset:36864
v_mfma_f32_16x16x32_bf16 v[112:115], a[112:115], a[8:11], v[112:115]
s_add_u32 s64, s75, 1966080
ds_read_b64_tr_b16 a[98:99], v21 offset:37120
v_mfma_f32_16x16x32_bf16 v[112:115], a[116:119], a[12:15], v[112:115]
buffer_load_dwordx4 v23, s[60:63], s64 offen lds
v_mfma_f32_16x16x32_bf16 v[96:99], a[116:119], a[4:7], v[96:99]
ds_read_b64_tr_b16 a[100:101], v21 offset:38912
v_mfma_f32_16x16x32_bf16 v[96:99], a[112:115], a[0:3], v[96:99]
ds_read_b64_tr_b16 a[102:103], v21 offset:39168
v_mfma_f32_16x16x32_bf16 v[36:39], a[72:75], a[0:3], v[36:39]
ds_read_b64_tr_b16 a[104:105], v20 offset:36864
v_mfma_f32_16x16x32_bf16 v[36:39], a[76:79], a[4:7], v[36:39]
ds_read_b64_tr_b16 a[106:107], v20 offset:37120
v_mfma_f32_16x16x32_bf16 v[52:55], a[76:79], a[12:15], v[52:55]
s_xor_b32 s68, s66, 16384
ds_read_b64_tr_b16 a[108:109], v20 offset:38912
v_mfma_f32_16x16x32_bf16 v[52:55], a[72:75], a[8:11], v[52:55]
s_add_u32 m0, s77, 99328
ds_read_b64_tr_b16 a[110:111], v20 offset:39168
v_mfma_f32_16x16x32_bf16 v[68:71], a[72:75], a[16:19], v[68:71]
s_add_u32 s64, s71, 2654208
ds_read_b64_tr_b16 a[112:113], v19 offset:40960
v_mfma_f32_16x16x32_bf16 v[68:71], a[76:79], a[20:23], v[68:71]
buffer_load_dwordx4 v14, s[56:59], s64 offen lds
v_mfma_f32_16x16x32_bf16 v[84:87], a[76:79], a[28:31], v[84:87]
buffer_atomic_add a251, v1, s[52:55], s68 offen offset:0 sc1
v_mfma_f32_16x16x32_bf16 v[84:87], a[72:75], a[24:27], v[84:87]
ds_read_b64_tr_b16 a[114:115], v19 offset:41216
v_mfma_f32_16x16x32_bf16 v[148:151], a[80:83], a[24:27], v[148:151]
ds_read_b64_tr_b16 a[116:117], v19 offset:43008
v_mfma_f32_16x16x32_bf16 v[148:151], a[84:87], a[28:31], v[148:151]
ds_read_b64_tr_b16 a[118:119], v19 offset:43264
v_mfma_f32_16x16x32_bf16 v[132:135], a[84:87], a[20:23], v[132:135]
ds_read_b64_tr_b16 a[72:73], v21 offset:40960
v_mfma_f32_16x16x32_bf16 v[132:135], a[80:83], a[16:19], v[132:135]
s_add_u32 m0, s78, 118784
ds_read_b64_tr_b16 a[74:75], v21 offset:41216
v_mfma_f32_16x16x32_bf16 v[116:119], a[80:83], a[8:11], v[116:119]
s_add_u32 s64, s75, 1968128
ds_read_b64_tr_b16 a[76:77], v21 offset:43008
v_mfma_f32_16x16x32_bf16 v[116:119], a[84:87], a[12:15], v[116:119]
buffer_load_dwordx4 v23, s[60:63], s64 offen lds
v_mfma_f32_16x16x32_bf16 v[100:103], a[84:87], a[4:7], v[100:103]
ds_read_b64_tr_b16 a[78:79], v21 offset:43264
v_mfma_f32_16x16x32_bf16 v[100:103], a[80:83], a[0:3], v[100:103]
s_waitcnt lgkmcnt(7)
ds_read_b64_tr_b16 a[80:81], v20 offset:40960
v_mfma_f32_16x16x32_bf16 v[184:187], a[88:91], a[32:35], v[184:187]
s_add_u32 s17, s78, .-L_pc+6144
ds_read_b64_tr_b16 a[82:83], v20 offset:41216
v_mfma_f32_16x16x32_bf16 v[184:187], a[92:95], a[36:39], v[184:187]
ds_read_b64_tr_b16 a[84:85], v20 offset:43008
v_subrev_u32 v17, 0x8000, v17
v_mfma_f32_16x16x32_bf16 v[192:195], a[92:95], a[44:47], v[192:195]
ds_read_b64_tr_b16 a[86:87], v20 offset:43264
v_subrev_u32 v18, 0x8000, v18
v_mfma_f32_16x16x32_bf16 v[192:195], a[88:91], a[40:43], v[192:195]
s_add_u32 m0, s77, 100352
v_mfma_f32_16x16x32_bf16 v[200:203], a[88:91], a[48:51], v[200:203]
s_add_u32 s64, s71, 2686976
buffer_load_dword a252, v16, s[88:91], s17 offen
v_mfma_f32_16x16x32_bf16 v[200:203], a[92:95], a[52:55], v[200:203]
s_add_u32 s65, s79, 6144
buffer_load_dwordx4 v15, s[56:59], s64 offen lds
v_mfma_f32_16x16x32_bf16 v[208:211], a[92:95], a[60:63], v[208:211]
buffer_store_dwordx4 a[172:175], v16, s[44:47], s65 offen sc1
v_mfma_f32_16x16x32_bf16 v[208:211], a[88:91], a[56:59], v[208:211]
ds_read_b64_tr_b16 a[88:89], v19 offset:32768
v_mfma_f32_16x16x32_bf16 v[248:251], a[96:99], a[64:67], v[248:251]
ds_read_b64_tr_b16 a[90:91], v19 offset:33024
v_mfma_f32_16x16x32_bf16 v[248:251], a[100:103], a[68:71], v[248:251]
ds_read_b64_tr_b16 a[92:93], v19 offset:34816
v_mfma_f32_16x16x32_bf16 v[212:215], a[108:111], a[60:63], v[212:215]
ds_read_b64_tr_b16 a[94:95], v19 offset:35072
v_mfma_f32_16x16x32_bf16 v[212:215], a[104:107], a[56:59], v[212:215]
s_add_u32 m0, s78, 122880
ds_read_b64_tr_b16 a[96:97], v20 offset:32768
v_mfma_f32_16x16x32_bf16 v[204:207], a[104:107], a[48:51], v[204:207]
s_add_u32 s64, s75, 1970176
ds_read_b64_tr_b16 a[98:99], v20 offset:33024
v_mfma_f32_16x16x32_bf16 v[204:207], a[108:111], a[52:55], v[204:207]
buffer_load_dwordx4 v23, s[60:63], s64 offen lds
v_mfma_f32_16x16x32_bf16 v[196:199], a[108:111], a[44:47], v[196:199]
ds_read_b64_tr_b16 a[100:101], v20 offset:34816
v_mfma_f32_16x16x32_bf16 v[196:199], a[104:107], a[40:43], v[196:199]
ds_read_b64_tr_b16 a[102:103], v20 offset:35072
v_mfma_f32_16x16x32_bf16 v[188:191], a[104:107], a[32:35], v[188:191]
s_xor_b32 s68, s66, 20480
v_mfma_f32_16x16x32_bf16 v[188:191], a[108:111], a[36:39], v[188:191]
s_waitcnt lgkmcnt(7)
s_add_u32 m0, s77, 101376
ds_read_b64_tr_b16 a[104:105], v4 offset:32768
v_mfma_f32_16x16x32_bf16 v[216:219], a[36:39], a[116:119], v[216:219]
buffer_atomic_add a251, v1, s[52:55], s68 offen offset:0 sc1
v_mfma_f32_16x16x32_bf16 v[216:219], a[32:35], a[112:115], v[216:219]
ds_read_b64_tr_b16 a[106:107], v4 offset:33792
v_subrev_u32 v21, 0x8000, v21
v_mfma_f32_16x16x32_bf16 v[224:227], a[40:43], a[112:115], v[224:227]
s_add_u32 s64, s71, 2719744
ds_read_b64_tr_b16 a[108:109], v4 offset:40960
v_mfma_f32_16x16x32_bf16 v[224:227], a[44:47], a[116:119], v[224:227]
buffer_load_dwordx4 v15, s[56:59], s64 offen lds
v_mfma_f32_16x16x32_bf16 v[232:235], a[52:55], a[116:119], v[232:235]
ds_read_b64_tr_b16 a[110:111], v4 offset:41984
v_mfma_f32_16x16x32_bf16 v[232:235], a[48:51], a[112:115], v[232:235]
v_mfma_f32_16x16x32_bf16 v[240:243], a[56:59], a[112:115], v[240:243]
v_mfma_f32_16x16x32_bf16 v[240:243], a[60:63], a[116:119], v[240:243]
ds_read_b64_tr_b16 a[112:113], v5 offset:32768
v_mfma_f32_16x16x32_bf16 v[252:255], a[68:71], a[76:79], v[252:255]
ds_read_b64_tr_b16 a[114:115], v5 offset:33792
v_mfma_f32_16x16x32_bf16 v[252:255], a[64:67], a[72:75], v[252:255]
s_add_u32 m0, s78, 126976
ds_read_b64_tr_b16 a[116:117], v5 offset:40960
v_mfma_f32_16x16x32_bf16 v[244:247], a[56:59], a[80:83], v[244:247]
s_add_u32 s64, s74, 640
ds_read_b64_tr_b16 a[118:119], v5 offset:41984
v_mfma_f32_16x16x32_bf16 v[244:247], a[60:63], a[84:87], v[244:247]
buffer_load_dwordx4 v22, s[48:51], s64 offen lds
v_mfma_f32_16x16x32_bf16 v[236:239], a[52:55], a[84:87], v[236:239]
ds_read_b64_tr_b16 a[72:73], v6 offset:32768
v_subrev_u32 v19, 0x8000, v19
v_mfma_f32_16x16x32_bf16 v[236:239], a[48:51], a[80:83], v[236:239]
ds_read_b64_tr_b16 a[74:75], v6 offset:33792
v_mfma_f32_16x16x32_bf16 v[228:231], a[40:43], a[80:83], v[228:231]
ds_read_b64_tr_b16 a[76:77], v6 offset:40960
v_mfma_f32_16x16x32_bf16 v[228:231], a[44:47], a[84:87], v[228:231]
s_add_u32 s65, s79, 2048
ds_read_b64_tr_b16 a[78:79], v6 offset:41984
v_mfma_f32_16x16x32_bf16 v[220:223], a[36:39], a[84:87], v[220:223]
buffer_store_dwordx4 a[176:179], v16, s[44:47], s65 offen sc1
v_mfma_f32_16x16x32_bf16 v[220:223], a[32:35], a[80:83], v[220:223]
s_waitcnt lgkmcnt(7)
ds_read_b64_tr_b16 a[80:81], v7 offset:32768
v_mfma_f32_16x16x32_bf16 v[152:155], a[88:91], a[32:35], v[152:155]
ds_read_b64_tr_b16 a[82:83], v7 offset:33792
v_mfma_f32_16x16x32_bf16 v[152:155], a[92:95], a[36:39], v[152:155]
ds_read_b64_tr_b16 a[84:85], v7 offset:40960
v_subrev_u32 v20, 0x8000, v20
v_mfma_f32_16x16x32_bf16 v[160:163], a[92:95], a[44:47], v[160:163]
s_add_u32 m0, s76, 32768
ds_read_b64_tr_b16 a[86:87], v7 offset:41984
v_mfma_f32_16x16x32_bf16 v[160:163], a[88:91], a[40:43], v[160:163]
s_add_u32 s64, s72, 640
v_mfma_f32_16x16x32_bf16 v[168:171], a[88:91], a[48:51], v[168:171]
buffer_load_dwordx4 v12, s[48:51], s64 offen lds
v_mfma_f32_16x16x32_bf16 v[168:171], a[92:95], a[52:55], v[168:171]
v_mfma_f32_16x16x32_bf16 v[176:179], a[92:95], a[60:63], v[176:179]
v_mfma_f32_16x16x32_bf16 v[176:179], a[88:91], a[56:59], v[176:179]
s_add_u32 m0, s76, 33792
ds_read_b64_tr_b16 a[88:89], v8 offset:32768
v_mfma_f32_16x16x32_bf16 v[180:183], a[96:99], a[56:59], v[180:183]
s_add_u32 s64, s72, 17024
ds_read_b64_tr_b16 a[90:91], v8 offset:33792
v_mfma_f32_16x16x32_bf16 v[180:183], a[100:103], a[60:63], v[180:183]
buffer_load_dwordx4 v13, s[48:51], s64 offen lds
v_mfma_f32_16x16x32_bf16 v[172:175], a[100:103], a[52:55], v[172:175]
ds_read_b64_tr_b16 a[92:93], v8 offset:40960
v_subrev_u32 v4, 0x8000, v4
v_mfma_f32_16x16x32_bf16 v[172:175], a[96:99], a[48:51], v[172:175]
ds_read_b64_tr_b16 a[94:95], v8 offset:41984
v_mfma_f32_16x16x32_bf16 v[164:167], a[96:99], a[40:43], v[164:167]
v_mfma_f32_16x16x32_bf16 v[164:167], a[100:103], a[44:47], v[164:167]
s_add_u32 m0, s76, 34816
v_mfma_f32_16x16x32_bf16 v[156:159], a[100:103], a[36:39], v[156:159]
s_add_u32 s64, s72, 131712
v_mfma_f32_16x16x32_bf16 v[156:159], a[96:99], a[32:35], v[156:159]
buffer_load_dwordx4 v12, s[48:51], s64 offen lds
v_mfma_f32_16x16x32_bf16 v[24:27], a[104:107], a[32:35], v[24:27]
s_add_u32 m0, s76, 35840
ds_read_b64_tr_b16 a[96:97], v9 offset:32768
v_mfma_f32_16x16x32_bf16 v[24:27], a[108:111], a[36:39], v[24:27]
ds_read_b64_tr_b16 a[98:99], v9 offset:33792
v_subrev_u32 v5, 0x8000, v5
v_mfma_f32_16x16x32_bf16 v[40:43], a[108:111], a[44:47], v[40:43]
s_waitcnt vmcnt(17)
ds_read_b64_tr_b16 a[100:101], v9 offset:40960
v_mfma_f32_16x16x32_bf16 v[40:43], a[104:107], a[40:43], v[40:43]
s_add_u32 s64, s72, 148096
ds_read_b64_tr_b16 a[102:103], v9 offset:41984
v_mfma_f32_16x16x32_bf16 v[56:59], a[104:107], a[48:51], v[56:59]
buffer_load_dwordx4 v13, s[48:51], s64 offen lds
v_mfma_f32_16x16x32_bf16 v[56:59], a[108:111], a[52:55], v[56:59]
ds_read_b128 a[0:3], v2 offset:0
v_mfma_f32_16x16x32_bf16 v[72:75], a[108:111], a[60:63], v[72:75]
ds_read_b128 a[4:7], v3 offset:0
v_mfma_f32_16x16x32_bf16 v[72:75], a[104:107], a[56:59], v[72:75]
s_waitcnt lgkmcnt(6)
s_add_u32 m0, s76, 36864
ds_read_b128 a[8:11], v2 offset:2048
v_mfma_f32_16x16x32_bf16 v[136:139], a[112:115], a[56:59], v[136:139]
s_add_u32 s64, s73, 640
ds_read_b128 a[12:15], v3 offset:2048
v_mfma_f32_16x16x32_bf16 v[136:139], a[116:119], a[60:63], v[136:139]
ds_read_b128 a[16:19], v2 offset:4096
v_subrev_u32 v6, 0x8000, v6
v_mfma_f32_16x16x32_bf16 v[120:123], a[116:119], a[52:55], v[120:123]
buffer_load_dwordx4 v12, s[48:51], s64 offen lds
v_mfma_f32_16x16x32_bf16 v[120:123], a[112:115], a[48:51], v[120:123]
ds_read_b128 a[20:23], v3 offset:4096
v_mfma_f32_16x16x32_bf16 v[104:107], a[112:115], a[40:43], v[104:107]
ds_read_b128 a[24:27], v2 offset:6144
v_mfma_f32_16x16x32_bf16 v[104:107], a[116:119], a[44:47], v[104:107]
s_add_u32 m0, s76, 37888
ds_read_b128 a[28:31], v3 offset:6144
v_mfma_f32_16x16x32_bf16 v[88:91], a[116:119], a[36:39], v[88:91]
s_add_u32 s64, s73, 17024
ds_read_b64_tr_b16 a[104:105], v10 offset:32768
v_mfma_f32_16x16x32_bf16 v[88:91], a[112:115], a[32:35], v[88:91]
buffer_load_dwordx4 v13, s[48:51], s64 offen lds
v_mfma_f32_16x16x32_bf16 v[28:31], a[72:75], a[32:35], v[28:31]
ds_read_b64_tr_b16 a[106:107], v10 offset:33792
v_mfma_f32_16x16x32_bf16 v[28:31], a[76:79], a[36:39], v[28:31]
ds_read_b64_tr_b16 a[108:109], v10 offset:40960
v_subrev_u32 v7, 0x8000, v7
v_mfma_f32_16x16x32_bf16 v[44:47], a[76:79], a[44:47], v[44:47]
ds_read_b64_tr_b16 a[110:111], v10 offset:41984
v_mfma_f32_16x16x32_bf16 v[44:47], a[72:75], a[40:43], v[44:47]
s_add_u32 m0, s76, 38912
ds_read_b64_tr_b16 a[112:113], v11 offset:32768
v_mfma_f32_16x16x32_bf16 v[60:63], a[72:75], a[48:51], v[60:63]
s_add_u32 s64, s73, 131712
ds_read_b64_tr_b16 a[114:115], v11 offset:33792
v_mfma_f32_16x16x32_bf16 v[60:63], a[76:79], a[52:55], v[60:63]
buffer_load_dwordx4 v12, s[48:51], s64 offen lds
v_mfma_f32_16x16x32_bf16 v[76:79], a[76:79], a[60:63], v[76:79]
ds_read_b64_tr_b16 a[116:117], v11 offset:40960
v_mfma_f32_16x16x32_bf16 v[76:79], a[72:75], a[56:59], v[76:79]
ds_read_b64_tr_b16 a[118:119], v11 offset:41984
v_mfma_f32_16x16x32_bf16 v[140:143], a[80:83], a[56:59], v[140:143]
s_add_u32 m0, s76, 39936
v_mfma_f32_16x16x32_bf16 v[140:143], a[84:87], a[60:63], v[140:143]
s_add_u32 s64, s73, 148096
v_subrev_u32 v8, 0x8000, v8
v_mfma_f32_16x16x32_bf16 v[124:127], a[84:87], a[52:55], v[124:127]
buffer_load_dwordx4 v13, s[48:51], s64 offen lds
v_mfma_f32_16x16x32_bf16 v[124:127], a[80:83], a[48:51], v[124:127]
v_mfma_f32_16x16x32_bf16 v[108:111], a[80:83], a[40:43], v[108:111]
v_mfma_f32_16x16x32_bf16 v[108:111], a[84:87], a[44:47], v[108:111]
v_mfma_f32_16x16x32_bf16 v[92:95], a[84:87], a[36:39], v[92:95]
v_subrev_u32 v9, 0x8000, v9
v_subrev_u32 v10, 0x8000, v10
v_mfma_f32_16x16x32_bf16 v[92:95], a[80:83], a[32:35], v[92:95]
v_subrev_u32 v11, 0x8000, v11
v_mfma_f32_16x16x32_bf16 v[32:35], a[88:91], a[32:35], v[32:35]
v_mfma_f32_16x16x32_bf16 v[32:35], a[92:95], a[36:39], v[32:35]
v_mfma_f32_16x16x32_bf16 v[48:51], a[92:95], a[44:47], v[48:51]
s_waitcnt lgkmcnt(0)
s_barrier
v_mfma_f32_16x16x32_bf16 v[48:51], a[88:91], a[40:43], v[48:51]
s_add_u32 m0, s77, 131072
ds_read_b64_tr_b16 a[72:73], v19 offset:4096
v_mfma_f32_16x16x32_bf16 v[64:67], a[88:91], a[48:51], v[64:67]
s_add_u32 s64, s71, 3145728
ds_read_b64_tr_b16 a[74:75], v19 offset:4352
v_mfma_f32_16x16x32_bf16 v[64:67], a[92:95], a[52:55], v[64:67]
buffer_load_dwordx4 v14, s[56:59], s64 offen lds
v_mfma_f32_16x16x32_bf16 v[80:83], a[92:95], a[60:63], v[80:83]
ds_read_b64_tr_b16 a[76:77], v19 offset:6144
v_mfma_f32_16x16x32_bf16 v[80:83], a[88:91], a[56:59], v[80:83]
ds_read_b64_tr_b16 a[78:79], v19 offset:6400
v_mfma_f32_16x16x32_bf16 v[144:147], a[96:99], a[56:59], v[144:147]
ds_read_b128 a[64:67], v17 offset:0
v_mfma_f32_16x16x32_bf16 v[144:147], a[100:103], a[60:63], v[144:147]
s_add_u32 s65, s79, 19456
ds_read_b128 a[68:71], v18 offset:0
v_mfma_f32_16x16x32_bf16 v[128:131], a[100:103], a[52:55], v[128:131]
buffer_store_dwordx4 a[180:183], v16, s[44:47], s65 offen sc1
v_mfma_f32_16x16x32_bf16 v[128:131], a[96:99], a[48:51], v[128:131]
s_add_u32 m0, s78, 147456
ds_read_b64_tr_b16 a[80:81], v21 offset:4096
v_mfma_f32_16x16x32_bf16 v[112:115], a[96:99], a[40:43], v[112:115]
s_add_u32 s64, s75, 2359296
ds_read_b64_tr_b16 a[82:83], v21 offset:4352
v_mfma_f32_16x16x32_bf16 v[112:115], a[100:103], a[44:47], v[112:115]
buffer_load_dwordx4 v23, s[60:63], s64 offen lds
v_mfma_f32_16x16x32_bf16 v[96:99], a[100:103], a[36:39], v[96:99]
ds_read_b64_tr_b16 a[84:85], v21 offset:6144
v_mfma_f32_16x16x32_bf16 v[96:99], a[96:99], a[32:35], v[96:99]
ds_read_b64_tr_b16 a[86:87], v21 offset:6400
v_mfma_f32_16x16x32_bf16 v[36:39], a[104:107], a[32:35], v[36:39]
ds_read_b64_tr_b16 a[88:89], v20 offset:4096
v_mfma_f32_16x16x32_bf16 v[36:39], a[108:111], a[36:39], v[36:39]
ds_read_b64_tr_b16 a[90:91], v20 offset:4352
v_mfma_f32_16x16x32_bf16 v[52:55], a[108:111], a[44:47], v[52:55]
s_xor_b32 s68, s66, 24576
ds_read_b64_tr_b16 a[92:93], v20 offset:6144
v_mfma_f32_16x16x32_bf16 v[52:55], a[104:107], a[40:43], v[52:55]
s_add_u32 m0, s77, 132096
ds_read_b64_tr_b16 a[94:95], v20 offset:6400
v_mfma_f32_16x16x32_bf16 v[68:71], a[104:107], a[48:51], v[68:71]
s_add_u32 s64, s71, 3178496
ds_read_b64_tr_b16 a[96:97], v19 offset:8192
v_mfma_f32_16x16x32_bf16 v[68:71], a[108:111], a[52:55], v[68:71]
buffer_load_dwordx4 v14, s[56:59], s64 offen lds
v_mfma_f32_16x16x32_bf16 v[84:87], a[108:111], a[60:63], v[84:87]
buffer_atomic_add a251, v1, s[52:55], s68 offen offset:0 sc1
v_mfma_f32_16x16x32_bf16 v[84:87], a[104:107], a[56:59], v[84:87]
ds_read_b64_tr_b16 a[98:99], v19 offset:8448
v_mfma_f32_16x16x32_bf16 v[148:151], a[112:115], a[56:59], v[148:151]
ds_read_b64_tr_b16 a[100:101], v19 offset:10240
v_mfma_f32_16x16x32_bf16 v[148:151], a[116:119], a[60:63], v[148:151]
ds_read_b64_tr_b16 a[102:103], v19 offset:10496
v_mfma_f32_16x16x32_bf16 v[132:135], a[116:119], a[52:55], v[132:135]
ds_read_b64_tr_b16 a[104:105], v21 offset:8192
v_mfma_f32_16x16x32_bf16 v[132:135], a[112:115], a[48:51], v[132:135]
s_add_u32 m0, s78, 151552
ds_read_b64_tr_b16 a[106:107], v21 offset:8448
v_mfma_f32_16x16x32_bf16 v[116:119], a[112:115], a[40:43], v[116:119]
s_add_u32 s64, s75, 2361344
ds_read_b64_tr_b16 a[108:109], v21 offset:10240
v_mfma_f32_16x16x32_bf16 v[116:119], a[116:119], a[44:47], v[116:119]
buffer_load_dwordx4 v23, s[60:63], s64 offen lds
v_mfma_f32_16x16x32_bf16 v[100:103], a[116:119], a[36:39], v[100:103]
ds_read_b64_tr_b16 a[110:111], v21 offset:10496
v_mfma_f32_16x16x32_bf16 v[100:103], a[112:115], a[32:35], v[100:103]
s_waitcnt lgkmcnt(7)
ds_read_b64_tr_b16 a[112:113], v20 offset:8192
v_mfma_f32_16x16x32_bf16 v[184:187], a[72:75], a[0:3], v[184:187]
ds_read_b64_tr_b16 a[114:115], v20 offset:8448
v_mfma_f32_16x16x32_bf16 v[184:187], a[76:79], a[4:7], v[184:187]
s_add_u32 s17, s78, .-L_pc+6144
ds_read_b64_tr_b16 a[116:117], v20 offset:10240
v_mfma_f32_16x16x32_bf16 v[192:195], a[76:79], a[12:15], v[192:195]
s_add_u32 m0, s77, 133120
ds_read_b64_tr_b16 a[118:119], v20 offset:10496
v_mfma_f32_16x16x32_bf16 v[192:195], a[72:75], a[8:11], v[192:195]
s_add_u32 s64, s71, 3211264
v_mfma_f32_16x16x32_bf16 v[200:203], a[72:75], a[16:19], v[200:203]
buffer_load_dword a252, v16, s[88:91], s17 offen
v_mfma_f32_16x16x32_bf16 v[200:203], a[76:79], a[20:23], v[200:203]
s_add_u32 s65, s79, 7168
buffer_load_dwordx4 v15, s[56:59], s64 offen lds
v_mfma_f32_16x16x32_bf16 v[208:211], a[76:79], a[28:31], v[208:211]
buffer_store_dwordx4 a[184:187], v16, s[44:47], s65 offen sc1
v_mfma_f32_16x16x32_bf16 v[208:211], a[72:75], a[24:27], v[208:211]
ds_read_b64_tr_b16 a[72:73], v19 offset:0
v_mfma_f32_16x16x32_bf16 v[248:251], a[80:83], a[64:67], v[248:251]
ds_read_b64_tr_b16 a[74:75], v19 offset:256
v_mfma_f32_16x16x32_bf16 v[248:251], a[84:87], a[68:71], v[248:251]
ds_read_b64_tr_b16 a[76:77], v19 offset:2048
v_mfma_f32_16x16x32_bf16 v[212:215], a[92:95], a[28:31], v[212:215]
ds_read_b64_tr_b16 a[78:79], v19 offset:2304
v_mfma_f32_16x16x32_bf16 v[212:215], a[88:91], a[24:27], v[212:215]
s_add_u32 m0, s78, 155648
ds_read_b64_tr_b16 a[80:81], v20 offset:0
v_mfma_f32_16x16x32_bf16 v[204:207], a[88:91], a[16:19], v[204:207]
s_add_u32 s64, s75, 2363392
ds_read_b64_tr_b16 a[82:83], v20 offset:256
v_mfma_f32_16x16x32_bf16 v[204:207], a[92:95], a[20:23], v[204:207]
buffer_load_dwordx4 v23, s[60:63], s64 offen lds
v_mfma_f32_16x16x32_bf16 v[196:199], a[92:95], a[12:15], v[196:199]
ds_read_b64_tr_b16 a[84:85], v20 offset:2048
v_mfma_f32_16x16x32_bf16 v[196:199], a[88:91], a[8:11], v[196:199]
ds_read_b64_tr_b16 a[86:87], v20 offset:2304
v_mfma_f32_16x16x32_bf16 v[188:191], a[88:91], a[0:3], v[188:191]
v_mfma_f32_16x16x32_bf16 v[188:191], a[92:95], a[4:7], v[188:191]
s_waitcnt lgkmcnt(7)
s_xor_b32 s68, s66, 28672
ds_read_b64_tr_b16 a[88:89], v4 offset:0
v_mfma_f32_16x16x32_bf16 v[216:219], a[4:7], a[100:103], v[216:219]
buffer_atomic_add a251, v1, s[52:55], s68 offen offset:0 sc1
v_mfma_f32_16x16x32_bf16 v[216:219], a[0:3], a[96:99], v[216:219]
s_add_u32 m0, s77, 134144
ds_read_b64_tr_b16 a[90:91], v4 offset:1024
v_mfma_f32_16x16x32_bf16 v[224:227], a[8:11], a[96:99], v[224:227]
s_add_u32 s64, s71, 3244032
ds_read_b64_tr_b16 a[92:93], v4 offset:8192
v_mfma_f32_16x16x32_bf16 v[224:227], a[12:15], a[100:103], v[224:227]
buffer_load_dwordx4 v15, s[56:59], s64 offen lds
v_mfma_f32_16x16x32_bf16 v[232:235], a[20:23], a[100:103], v[232:235]
ds_read_b64_tr_b16 a[94:95], v4 offset:9216
v_mfma_f32_16x16x32_bf16 v[232:235], a[16:19], a[96:99], v[232:235]
v_mfma_f32_16x16x32_bf16 v[240:243], a[24:27], a[96:99], v[240:243]
v_mfma_f32_16x16x32_bf16 v[240:243], a[28:31], a[100:103], v[240:243]
ds_read_b64_tr_b16 a[96:97], v5 offset:0
v_mfma_f32_16x16x32_bf16 v[252:255], a[68:71], a[108:111], v[252:255]
ds_read_b64_tr_b16 a[98:99], v5 offset:1024
v_mfma_f32_16x16x32_bf16 v[252:255], a[64:67], a[104:107], v[252:255]
s_add_u32 m0, s78, 159744
ds_read_b64_tr_b16 a[100:101], v5 offset:8192
v_mfma_f32_16x16x32_bf16 v[244:247], a[24:27], a[112:115], v[244:247]
s_add_u32 s64, s74, 768
ds_read_b64_tr_b16 a[102:103], v5 offset:9216
v_mfma_f32_16x16x32_bf16 v[244:247], a[28:31], a[116:119], v[244:247]
buffer_load_dwordx4 v22, s[48:51], s64 offen lds
v_mfma_f32_16x16x32_bf16 v[236:239], a[20:23], a[116:119], v[236:239]
ds_read_b64_tr_b16 a[104:105], v6 offset:0
v_mfma_f32_16x16x32_bf16 v[236:239], a[16:19], a[112:115], v[236:239]
ds_read_b64_tr_b16 a[106:107], v6 offset:1024
v_mfma_f32_16x16x32_bf16 v[228:231], a[8:11], a[112:115], v[228:231]
ds_read_b64_tr_b16 a[108:109], v6 offset:8192
v_mfma_f32_16x16x32_bf16 v[228:231], a[12:15], a[116:119], v[228:231]
s_add_u32 s65, s79, 3072
ds_read_b64_tr_b16 a[110:111], v6 offset:9216
v_mfma_f32_16x16x32_bf16 v[220:223], a[4:7], a[116:119], v[220:223]
buffer_store_dwordx4 a[188:191], v16, s[44:47], s65 offen sc1
v_mfma_f32_16x16x32_bf16 v[220:223], a[0:3], a[112:115], v[220:223]
s_waitcnt lgkmcnt(7)
ds_read_b64_tr_b16 a[112:113], v7 offset:0
v_mfma_f32_16x16x32_bf16 v[152:155], a[72:75], a[0:3], v[152:155]
ds_read_b64_tr_b16 a[114:115], v7 offset:1024
v_mfma_f32_16x16x32_bf16 v[152:155], a[76:79], a[4:7], v[152:155]
ds_read_b64_tr_b16 a[116:117], v7 offset:8192
v_mfma_f32_16x16x32_bf16 v[160:163], a[76:79], a[12:15], v[160:163]
s_add_u32 m0, s76, 0
ds_read_b64_tr_b16 a[118:119], v7 offset:9216
v_mfma_f32_16x16x32_bf16 v[160:163], a[72:75], a[8:11], v[160:163]
s_add_u32 s64, s72, 768
v_mfma_f32_16x16x32_bf16 v[168:171], a[72:75], a[16:19], v[168:171]
buffer_load_dwordx4 v12, s[48:51], s64 offen lds
v_mfma_f32_16x16x32_bf16 v[168:171], a[76:79], a[20:23], v[168:171]
v_mfma_f32_16x16x32_bf16 v[176:179], a[76:79], a[28:31], v[176:179]
v_mfma_f32_16x16x32_bf16 v[176:179], a[72:75], a[24:27], v[176:179]
s_add_u32 m0, s76, 1024
ds_read_b64_tr_b16 a[72:73], v8 offset:0
v_mfma_f32_16x16x32_bf16 v[180:183], a[80:83], a[24:27], v[180:183]
s_add_u32 s64, s72, 17152
ds_read_b64_tr_b16 a[74:75], v8 offset:1024
v_mfma_f32_16x16x32_bf16 v[180:183], a[84:87], a[28:31], v[180:183]
buffer_load_dwordx4 v13, s[48:51], s64 offen lds
v_mfma_f32_16x16x32_bf16 v[172:175], a[84:87], a[20:23], v[172:175]
ds_read_b64_tr_b16 a[76:77], v8 offset:8192
v_mfma_f32_16x16x32_bf16 v[172:175], a[80:83], a[16:19], v[172:175]
ds_read_b64_tr_b16 a[78:79], v8 offset:9216
v_mfma_f32_16x16x32_bf16 v[164:167], a[80:83], a[8:11], v[164:167]
v_mfma_f32_16x16x32_bf16 v[164:167], a[84:87], a[12:15], v[164:167]
s_add_u32 m0, s76, 2048
v_mfma_f32_16x16x32_bf16 v[156:159], a[84:87], a[4:7], v[156:159]
s_add_u32 s64, s72, 131840
v_mfma_f32_16x16x32_bf16 v[156:159], a[80:83], a[0:3], v[156:159]
buffer_load_dwordx4 v12, s[48:51], s64 offen lds
v_mfma_f32_16x16x32_bf16 v[24:27], a[88:91], a[0:3], v[24:27]
ds_read_b64_tr_b16 a[80:81], v9 offset:0
v_mfma_f32_16x16x32_bf16 v[24:27], a[92:95], a[4:7], v[24:27]
s_add_u32 m0, s76, 3072
ds_read_b64_tr_b16 a[82:83], v9 offset:1024
v_mfma_f32_16x16x32_bf16 v[40:43], a[92:95], a[12:15], v[40:43]
s_waitcnt vmcnt(17)
ds_read_b64_tr_b16 a[84:85], v9 offset:8192
v_mfma_f32_16x16x32_bf16 v[40:43], a[88:91], a[8:11], v[40:43]
s_add_u32 s64, s72, 148224
ds_read_b64_tr_b16 a[86:87], v9 offset:9216
v_mfma_f32_16x16x32_bf16 v[56:59], a[88:91], a[16:19], v[56:59]
buffer_load_dwordx4 v13, s[48:51], s64 offen lds
v_mfma_f32_16x16x32_bf16 v[56:59], a[92:95], a[20:23], v[56:59]
ds_read_b128 a[32:35], v2 offset:32768
v_mfma_f32_16x16x32_bf16 v[72:75], a[92:95], a[28:31], v[72:75]
ds_read_b128 a[36:39], v3 offset:32768
v_mfma_f32_16x16x32_bf16 v[72:75], a[88:91], a[24:27], v[72:75]
s_waitcnt lgkmcnt(6)
ds_read_b128 a[40:43], v2 offset:34816
v_mfma_f32_16x16x32_bf16 v[136:139], a[96:99], a[24:27], v[136:139]
s_add_u32 m0, s76, 4096
ds_read_b128 a[44:47], v3 offset:34816
v_mfma_f32_16x16x32_bf16 v[136:139], a[100:103], a[28:31], v[136:139]
s_add_u32 s64, s73, 768
ds_read_b128 a[48:51], v2 offset:36864
v_mfma_f32_16x16x32_bf16 v[120:123], a[100:103], a[20:23], v[120:123]
buffer_load_dwordx4 v12, s[48:51], s64 offen lds
v_mfma_f32_16x16x32_bf16 v[120:123], a[96:99], a[16:19], v[120:123]
ds_read_b128 a[52:55], v3 offset:36864
v_mfma_f32_16x16x32_bf16 v[104:107], a[96:99], a[8:11], v[104:107]
ds_read_b128 a[56:59], v2 offset:38912
v_mfma_f32_16x16x32_bf16 v[104:107], a[100:103], a[12:15], v[104:107]
s_add_u32 m0, s76, 5120
ds_read_b128 a[60:63], v3 offset:38912
v_mfma_f32_16x16x32_bf16 v[88:91], a[100:103], a[4:7], v[88:91]
s_add_u32 s64, s73, 17152
ds_read_b64_tr_b16 a[88:89], v10 offset:0
v_mfma_f32_16x16x32_bf16 v[88:91], a[96:99], a[0:3], v[88:91]
buffer_load_dwordx4 v13, s[48:51], s64 offen lds
v_mfma_f32_16x16x32_bf16 v[28:31], a[104:107], a[0:3], v[28:31]
ds_read_b64_tr_b16 a[90:91], v10 offset:1024
v_mfma_f32_16x16x32_bf16 v[28:31], a[108:111], a[4:7], v[28:31]
ds_read_b64_tr_b16 a[92:93], v10 offset:8192
v_mfma_f32_16x16x32_bf16 v[44:47], a[108:111], a[12:15], v[44:47]
ds_read_b64_tr_b16 a[94:95], v10 offset:9216
v_mfma_f32_16x16x32_bf16 v[44:47], a[104:107], a[8:11], v[44:47]
s_add_u32 m0, s76, 6144
ds_read_b64_tr_b16 a[96:97], v11 offset:0
v_mfma_f32_16x16x32_bf16 v[60:63], a[104:107], a[16:19], v[60:63]
s_add_u32 s64, s73, 131840
ds_read_b64_tr_b16 a[98:99], v11 offset:1024
v_mfma_f32_16x16x32_bf16 v[60:63], a[108:111], a[20:23], v[60:63]
buffer_load_dwordx4 v12, s[48:51], s64 offen lds
v_mfma_f32_16x16x32_bf16 v[76:79], a[108:111], a[28:31], v[76:79]
ds_read_b64_tr_b16 a[100:101], v11 offset:8192
v_mfma_f32_16x16x32_bf16 v[76:79], a[104:107], a[24:27], v[76:79]
ds_read_b64_tr_b16 a[102:103], v11 offset:9216
v_mfma_f32_16x16x32_bf16 v[140:143], a[112:115], a[24:27], v[140:143]
s_add_u32 m0, s76, 7168
v_mfma_f32_16x16x32_bf16 v[140:143], a[116:119], a[28:31], v[140:143]
s_add_u32 s64, s73, 148224
v_mfma_f32_16x16x32_bf16 v[124:127], a[116:119], a[20:23], v[124:127]
buffer_load_dwordx4 v13, s[48:51], s64 offen lds
v_mfma_f32_16x16x32_bf16 v[124:127], a[112:115], a[16:19], v[124:127]
v_mfma_f32_16x16x32_bf16 v[108:111], a[112:115], a[8:11], v[108:111]
v_mfma_f32_16x16x32_bf16 v[108:111], a[116:119], a[12:15], v[108:111]
v_mfma_f32_16x16x32_bf16 v[92:95], a[116:119], a[4:7], v[92:95]
v_mfma_f32_16x16x32_bf16 v[92:95], a[112:115], a[0:3], v[92:95]
v_mfma_f32_16x16x32_bf16 v[32:35], a[72:75], a[0:3], v[32:35]
v_mfma_f32_16x16x32_bf16 v[32:35], a[76:79], a[4:7], v[32:35]
v_mfma_f32_16x16x32_bf16 v[48:51], a[76:79], a[12:15], v[48:51]
s_waitcnt lgkmcnt(0)
s_barrier
v_mfma_f32_16x16x32_bf16 v[48:51], a[72:75], a[8:11], v[48:51]
s_add_u32 m0, s77, 65536
ds_read_b64_tr_b16 a[104:105], v19 offset:36864
v_mfma_f32_16x16x32_bf16 v[64:67], a[72:75], a[16:19], v[64:67]
s_add_u32 s64, s71, 3670016
ds_read_b64_tr_b16 a[106:107], v19 offset:37120
v_mfma_f32_16x16x32_bf16 v[64:67], a[76:79], a[20:23], v[64:67]
buffer_load_dwordx4 v14, s[56:59], s64 offen lds
v_mfma_f32_16x16x32_bf16 v[80:83], a[76:79], a[28:31], v[80:83]
ds_read_b64_tr_b16 a[108:109], v19 offset:38912
v_mfma_f32_16x16x32_bf16 v[80:83], a[72:75], a[24:27], v[80:83]
ds_read_b64_tr_b16 a[110:111], v19 offset:39168
v_mfma_f32_16x16x32_bf16 v[144:147], a[80:83], a[24:27], v[144:147]
ds_read_b128 a[64:67], v17 offset:32768
v_mfma_f32_16x16x32_bf16 v[144:147], a[84:87], a[28:31], v[144:147]
s_add_u32 s65, s79, 24576
ds_read_b128 a[68:71], v18 offset:32768
v_mfma_f32_16x16x32_bf16 v[128:131], a[84:87], a[20:23], v[128:131]
buffer_store_dwordx4 a[192:195], v16, s[44:47], s65 offen sc1
v_mfma_f32_16x16x32_bf16 v[128:131], a[80:83], a[16:19], v[128:131]
s_add_u32 m0, s78, 81920
ds_read_b64_tr_b16 a[112:113], v21 offset:36864
v_mfma_f32_16x16x32_bf16 v[112:115], a[80:83], a[8:11], v[112:115]
s_add_u32 s64, s75, 2752512
ds_read_b64_tr_b16 a[114:115], v21 offset:37120
v_mfma_f32_16x16x32_bf16 v[112:115], a[84:87], a[12:15], v[112:115]
buffer_load_dwordx4 v23, s[60:63], s64 offen lds
v_mfma_f32_16x16x32_bf16 v[96:99], a[84:87], a[4:7], v[96:99]
ds_read_b64_tr_b16 a[116:117], v21 offset:38912
v_mfma_f32_16x16x32_bf16 v[96:99], a[80:83], a[0:3], v[96:99]
ds_read_b64_tr_b16 a[118:119], v21 offset:39168
v_mfma_f32_16x16x32_bf16 v[36:39], a[88:91], a[0:3], v[36:39]
ds_read_b64_tr_b16 a[72:73], v20 offset:36864
v_mfma_f32_16x16x32_bf16 v[36:39], a[92:95], a[4:7], v[36:39]
ds_read_b64_tr_b16 a[74:75], v20 offset:37120
v_mfma_f32_16x16x32_bf16 v[52:55], a[92:95], a[12:15], v[52:55]
ds_read_b64_tr_b16 a[76:77], v20 offset:38912
v_mfma_f32_16x16x32_bf16 v[52:55], a[88:91], a[8:11], v[52:55]
s_add_u32 m0, s77, 66560
ds_read_b64_tr_b16 a[78:79], v20 offset:39168
v_mfma_f32_16x16x32_bf16 v[68:71], a[88:91], a[16:19], v[68:71]
s_add_u32 s64, s71, 3702784
ds_read_b64_tr_b16 a[80:81], v19 offset:40960
v_mfma_f32_16x16x32_bf16 v[68:71], a[92:95], a[20:23], v[68:71]
buffer_load_dwordx4 v14, s[56:59], s64 offen lds
v_mfma_f32_16x16x32_bf16 v[84:87], a[92:95], a[28:31], v[84:87]
ds_read_b64_tr_b16 a[82:83], v19 offset:41216
v_mfma_f32_16x16x32_bf16 v[84:87], a[88:91], a[24:27], v[84:87]
ds_read_b64_tr_b16 a[84:85], v19 offset:43008
v_mfma_f32_16x16x32_bf16 v[148:151], a[96:99], a[24:27], v[148:151]
ds_read_b64_tr_b16 a[86:87], v19 offset:43264
v_mfma_f32_16x16x32_bf16 v[148:151], a[100:103], a[28:31], v[148:151]
ds_read_b64_tr_b16 a[88:89], v21 offset:40960
v_mfma_f32_16x16x32_bf16 v[132:135], a[100:103], a[20:23], v[132:135]
ds_read_b64_tr_b16 a[90:91], v21 offset:41216
v_mfma_f32_16x16x32_bf16 v[132:135], a[96:99], a[16:19], v[132:135]
s_add_u32 m0, s78, 86016
ds_read_b64_tr_b16 a[92:93], v21 offset:43008
v_mfma_f32_16x16x32_bf16 v[116:119], a[96:99], a[8:11], v[116:119]
s_add_u32 s64, s75, 2754560
ds_read_b64_tr_b16 a[94:95], v21 offset:43264
v_mfma_f32_16x16x32_bf16 v[116:119], a[100:103], a[12:15], v[116:119]
buffer_load_dwordx4 v23, s[60:63], s64 offen lds
v_mfma_f32_16x16x32_bf16 v[100:103], a[100:103], a[4:7], v[100:103]
v_mfma_f32_16x16x32_bf16 v[100:103], a[96:99], a[0:3], v[100:103]
s_waitcnt lgkmcnt(7)
ds_read_b64_tr_b16 a[96:97], v20 offset:40960
v_mfma_f32_16x16x32_bf16 v[184:187], a[104:107], a[32:35], v[184:187]
s_add_u32 s17, s78, .-L_pc+6144
ds_read_b64_tr_b16 a[98:99], v20 offset:41216
v_mfma_f32_16x16x32_bf16 v[184:187], a[108:111], a[36:39], v[184:187]
ds_read_b64_tr_b16 a[100:101], v20 offset:43008
v_add_u32 v17, 0x8000, v17
v_mfma_f32_16x16x32_bf16 v[192:195], a[108:111], a[44:47], v[192:195]
ds_read_b64_tr_b16 a[102:103], v20 offset:43264
v_add_u32 v18, 0x8000, v18
v_mfma_f32_16x16x32_bf16 v[192:195], a[104:107], a[40:43], v[192:195]
s_add_u32 m0, s77, 67584
v_mfma_f32_16x16x32_bf16 v[200:203], a[104:107], a[48:51], v[200:203]
s_add_u32 s64, s71, 3735552
buffer_load_dword a252, v16, s[88:91], s17 offen
v_mfma_f32_16x16x32_bf16 v[200:203], a[108:111], a[52:55], v[200:203]
s_add_u32 s65, s79, 25600
buffer_load_dwordx4 v15, s[56:59], s64 offen lds
v_mfma_f32_16x16x32_bf16 v[208:211], a[108:111], a[60:63], v[208:211]
buffer_store_dwordx4 a[196:199], v16, s[44:47], s65 offen sc1
v_mfma_f32_16x16x32_bf16 v[208:211], a[104:107], a[56:59], v[208:211]
ds_read_b64_tr_b16 a[104:105], v19 offset:32768
v_mfma_f32_16x16x32_bf16 v[248:251], a[112:115], a[64:67], v[248:251]
ds_read_b64_tr_b16 a[106:107], v19 offset:33024
v_mfma_f32_16x16x32_bf16 v[248:251], a[116:119], a[68:71], v[248:251]
ds_read_b64_tr_b16 a[108:109], v19 offset:34816
v_mfma_f32_16x16x32_bf16 v[212:215], a[76:79], a[60:63], v[212:215]
ds_read_b64_tr_b16 a[110:111], v19 offset:35072
v_mfma_f32_16x16x32_bf16 v[212:215], a[72:75], a[56:59], v[212:215]
s_add_u32 m0, s78, 90112
ds_read_b64_tr_b16 a[112:113], v20 offset:32768
v_mfma_f32_16x16x32_bf16 v[204:207], a[72:75], a[48:51], v[204:207]
s_add_u32 s64, s75, 2756608
ds_read_b64_tr_b16 a[114:115], v20 offset:33024
v_mfma_f32_16x16x32_bf16 v[204:207], a[76:79], a[52:55], v[204:207]
buffer_load_dwordx4 v23, s[60:63], s64 offen lds
v_mfma_f32_16x16x32_bf16 v[196:199], a[76:79], a[44:47], v[196:199]
ds_read_b64_tr_b16 a[116:117], v20 offset:34816
v_mfma_f32_16x16x32_bf16 v[196:199], a[72:75], a[40:43], v[196:199]
ds_read_b64_tr_b16 a[118:119], v20 offset:35072
v_mfma_f32_16x16x32_bf16 v[188:191], a[72:75], a[32:35], v[188:191]
v_mfma_f32_16x16x32_bf16 v[188:191], a[76:79], a[36:39], v[188:191]
s_waitcnt lgkmcnt(7)
ds_read_b64_tr_b16 a[72:73], v4 offset:32768
v_mfma_f32_16x16x32_bf16 v[216:219], a[36:39], a[84:87], v[216:219]
s_add_u32 m0, s77, 68608
ds_read_b64_tr_b16 a[74:75], v4 offset:33792
v_mfma_f32_16x16x32_bf16 v[216:219], a[32:35], a[80:83], v[216:219]
ds_read_b64_tr_b16 a[76:77], v4 offset:40960
v_add_u32 v21, 0x8000, v21
v_mfma_f32_16x16x32_bf16 v[224:227], a[40:43], a[80:83], v[224:227]
s_add_u32 s64, s71, 3768320
ds_read_b64_tr_b16 a[78:79], v4 offset:41984
v_mfma_f32_16x16x32_bf16 v[224:227], a[44:47], a[84:87], v[224:227]
buffer_load_dwordx4 v15, s[56:59], s64 offen lds
v_mfma_f32_16x16x32_bf16 v[232:235], a[52:55], a[84:87], v[232:235]
v_mfma_f32_16x16x32_bf16 v[232:235], a[48:51], a[80:83], v[232:235]
v_mfma_f32_16x16x32_bf16 v[240:243], a[56:59], a[80:83], v[240:243]
v_mfma_f32_16x16x32_bf16 v[240:243], a[60:63], a[84:87], v[240:243]
ds_read_b64_tr_b16 a[80:81], v5 offset:32768
v_mfma_f32_16x16x32_bf16 v[252:255], a[68:71], a[92:95], v[252:255]
ds_read_b64_tr_b16 a[82:83], v5 offset:33792
v_mfma_f32_16x16x32_bf16 v[252:255], a[64:67], a[88:91], v[252:255]
s_add_u32 m0, s78, 94208
ds_read_b64_tr_b16 a[84:85], v5 offset:40960
v_mfma_f32_16x16x32_bf16 v[244:247], a[56:59], a[96:99], v[244:247]
s_add_u32 s64, s74, 896
ds_read_b64_tr_b16 a[86:87], v5 offset:41984
v_mfma_f32_16x16x32_bf16 v[244:247], a[60:63], a[100:103], v[244:247]
buffer_load_dwordx4 v22, s[48:51], s64 offen lds
v_mfma_f32_16x16x32_bf16 v[236:239], a[52:55], a[100:103], v[236:239]
ds_read_b64_tr_b16 a[88:89], v6 offset:32768
v_add_u32 v19, 0x8000, v19
v_mfma_f32_16x16x32_bf16 v[236:239], a[48:51], a[96:99], v[236:239]
ds_read_b64_tr_b16 a[90:91], v6 offset:33792
v_mfma_f32_16x16x32_bf16 v[228:231], a[40:43], a[96:99], v[228:231]
ds_read_b64_tr_b16 a[92:93], v6 offset:40960
v_mfma_f32_16x16x32_bf16 v[228:231], a[44:47], a[100:103], v[228:231]
s_add_u32 s65, s79, 9216
ds_read_b64_tr_b16 a[94:95], v6 offset:41984
v_mfma_f32_16x16x32_bf16 v[220:223], a[36:39], a[100:103], v[220:223]
buffer_store_dwordx4 a[200:203], v16, s[44:47], s65 offen sc1
v_mfma_f32_16x16x32_bf16 v[220:223], a[32:35], a[96:99], v[220:223]
s_waitcnt lgkmcnt(7)
ds_read_b64_tr_b16 a[96:97], v7 offset:32768
v_mfma_f32_16x16x32_bf16 v[152:155], a[104:107], a[32:35], v[152:155]
ds_read_b64_tr_b16 a[98:99], v7 offset:33792
v_mfma_f32_16x16x32_bf16 v[152:155], a[108:111], a[36:39], v[152:155]
ds_read_b64_tr_b16 a[100:101], v7 offset:40960
v_add_u32 v20, 0x8000, v20
v_mfma_f32_16x16x32_bf16 v[160:163], a[108:111], a[44:47], v[160:163]
s_add_u32 m0, s76, 32768
ds_read_b64_tr_b16 a[102:103], v7 offset:41984
v_mfma_f32_16x16x32_bf16 v[160:163], a[104:107], a[40:43], v[160:163]
s_add_u32 s64, s72, 896
v_mfma_f32_16x16x32_bf16 v[168:171], a[104:107], a[48:51], v[168:171]
buffer_load_dwordx4 v12, s[48:51], s64 offen lds
v_mfma_f32_16x16x32_bf16 v[168:171], a[108:111], a[52:55], v[168:171]
v_mfma_f32_16x16x32_bf16 v[176:179], a[108:111], a[60:63], v[176:179]
v_mfma_f32_16x16x32_bf16 v[176:179], a[104:107], a[56:59], v[176:179]
s_add_u32 m0, s76, 33792
ds_read_b64_tr_b16 a[104:105], v8 offset:32768
v_mfma_f32_16x16x32_bf16 v[180:183], a[112:115], a[56:59], v[180:183]
s_add_u32 s64, s72, 17280
ds_read_b64_tr_b16 a[106:107], v8 offset:33792
v_mfma_f32_16x16x32_bf16 v[180:183], a[116:119], a[60:63], v[180:183]
buffer_load_dwordx4 v13, s[48:51], s64 offen lds
v_mfma_f32_16x16x32_bf16 v[172:175], a[116:119], a[52:55], v[172:175]
ds_read_b64_tr_b16 a[108:109], v8 offset:40960
v_add_u32 v4, 0x8000, v4
v_mfma_f32_16x16x32_bf16 v[172:175], a[112:115], a[48:51], v[172:175]
ds_read_b64_tr_b16 a[110:111], v8 offset:41984
v_mfma_f32_16x16x32_bf16 v[164:167], a[112:115], a[40:43], v[164:167]
v_mfma_f32_16x16x32_bf16 v[164:167], a[116:119], a[44:47], v[164:167]
s_add_u32 m0, s76, 34816
v_mfma_f32_16x16x32_bf16 v[156:159], a[116:119], a[36:39], v[156:159]
s_add_u32 s64, s72, 131968
v_mfma_f32_16x16x32_bf16 v[156:159], a[112:115], a[32:35], v[156:159]
buffer_load_dwordx4 v12, s[48:51], s64 offen lds
v_mfma_f32_16x16x32_bf16 v[24:27], a[72:75], a[32:35], v[24:27]
s_add_u32 m0, s76, 35840
ds_read_b64_tr_b16 a[112:113], v9 offset:32768
v_mfma_f32_16x16x32_bf16 v[24:27], a[76:79], a[36:39], v[24:27]
ds_read_b64_tr_b16 a[114:115], v9 offset:33792
v_add_u32 v5, 0x8000, v5
v_mfma_f32_16x16x32_bf16 v[40:43], a[76:79], a[44:47], v[40:43]
s_waitcnt vmcnt(15)
ds_read_b64_tr_b16 a[116:117], v9 offset:40960
v_mfma_f32_16x16x32_bf16 v[40:43], a[72:75], a[40:43], v[40:43]
s_add_u32 s64, s72, 148352
ds_read_b64_tr_b16 a[118:119], v9 offset:41984
v_mfma_f32_16x16x32_bf16 v[56:59], a[72:75], a[48:51], v[56:59]
buffer_load_dwordx4 v13, s[48:51], s64 offen lds
v_mfma_f32_16x16x32_bf16 v[56:59], a[76:79], a[52:55], v[56:59]
ds_read_b128 a[0:3], v2 offset:0
v_mfma_f32_16x16x32_bf16 v[72:75], a[76:79], a[60:63], v[72:75]
ds_read_b128 a[4:7], v3 offset:0
v_mfma_f32_16x16x32_bf16 v[72:75], a[72:75], a[56:59], v[72:75]
s_waitcnt lgkmcnt(6)
s_add_u32 m0, s76, 36864
ds_read_b128 a[8:11], v2 offset:2048
v_mfma_f32_16x16x32_bf16 v[136:139], a[80:83], a[56:59], v[136:139]
s_add_u32 s64, s73, 896
ds_read_b128 a[12:15], v3 offset:2048
v_mfma_f32_16x16x32_bf16 v[136:139], a[84:87], a[60:63], v[136:139]
ds_read_b128 a[16:19], v2 offset:4096
v_add_u32 v6, 0x8000, v6
v_mfma_f32_16x16x32_bf16 v[120:123], a[84:87], a[52:55], v[120:123]
buffer_load_dwordx4 v12, s[48:51], s64 offen lds
v_mfma_f32_16x16x32_bf16 v[120:123], a[80:83], a[48:51], v[120:123]
ds_read_b128 a[20:23], v3 offset:4096
v_mfma_f32_16x16x32_bf16 v[104:107], a[80:83], a[40:43], v[104:107]
ds_read_b128 a[24:27], v2 offset:6144
v_mfma_f32_16x16x32_bf16 v[104:107], a[84:87], a[44:47], v[104:107]
s_add_u32 m0, s76, 37888
ds_read_b128 a[28:31], v3 offset:6144
v_mfma_f32_16x16x32_bf16 v[88:91], a[84:87], a[36:39], v[88:91]
s_add_u32 s64, s73, 17280
ds_read_b64_tr_b16 a[72:73], v10 offset:32768
v_mfma_f32_16x16x32_bf16 v[88:91], a[80:83], a[32:35], v[88:91]
buffer_load_dwordx4 v13, s[48:51], s64 offen lds
v_mfma_f32_16x16x32_bf16 v[28:31], a[88:91], a[32:35], v[28:31]
ds_read_b64_tr_b16 a[74:75], v10 offset:33792
v_mfma_f32_16x16x32_bf16 v[28:31], a[92:95], a[36:39], v[28:31]
ds_read_b64_tr_b16 a[76:77], v10 offset:40960
v_add_u32 v7, 0x8000, v7
v_mfma_f32_16x16x32_bf16 v[44:47], a[92:95], a[44:47], v[44:47]
ds_read_b64_tr_b16 a[78:79], v10 offset:41984
v_mfma_f32_16x16x32_bf16 v[44:47], a[88:91], a[40:43], v[44:47]
s_add_u32 m0, s76, 38912
ds_read_b64_tr_b16 a[80:81], v11 offset:32768
v_mfma_f32_16x16x32_bf16 v[60:63], a[88:91], a[48:51], v[60:63]
s_add_u32 s64, s73, 131968
ds_read_b64_tr_b16 a[82:83], v11 offset:33792
v_mfma_f32_16x16x32_bf16 v[60:63], a[92:95], a[52:55], v[60:63]
buffer_load_dwordx4 v12, s[48:51], s64 offen lds
v_mfma_f32_16x16x32_bf16 v[76:79], a[92:95], a[60:63], v[76:79]
ds_read_b64_tr_b16 a[84:85], v11 offset:40960
v_mfma_f32_16x16x32_bf16 v[76:79], a[88:91], a[56:59], v[76:79]
ds_read_b64_tr_b16 a[86:87], v11 offset:41984
v_mfma_f32_16x16x32_bf16 v[140:143], a[96:99], a[56:59], v[140:143]
s_add_u32 m0, s76, 39936
v_mfma_f32_16x16x32_bf16 v[140:143], a[100:103], a[60:63], v[140:143]
s_add_u32 s64, s73, 148352
v_add_u32 v8, 0x8000, v8
v_mfma_f32_16x16x32_bf16 v[124:127], a[100:103], a[52:55], v[124:127]
buffer_load_dwordx4 v13, s[48:51], s64 offen lds
v_mfma_f32_16x16x32_bf16 v[124:127], a[96:99], a[48:51], v[124:127]
v_mfma_f32_16x16x32_bf16 v[108:111], a[96:99], a[40:43], v[108:111]
v_mfma_f32_16x16x32_bf16 v[108:111], a[100:103], a[44:47], v[108:111]
v_mfma_f32_16x16x32_bf16 v[92:95], a[100:103], a[36:39], v[92:95]
v_add_u32 v9, 0x8000, v9
v_add_u32 v10, 0x8000, v10
v_mfma_f32_16x16x32_bf16 v[92:95], a[96:99], a[32:35], v[92:95]
v_add_u32 v11, 0x8000, v11
v_mfma_f32_16x16x32_bf16 v[32:35], a[104:107], a[32:35], v[32:35]
v_mfma_f32_16x16x32_bf16 v[32:35], a[108:111], a[36:39], v[32:35]
v_mfma_f32_16x16x32_bf16 v[48:51], a[108:111], a[44:47], v[48:51]
s_waitcnt lgkmcnt(0)
s_barrier
v_mfma_f32_16x16x32_bf16 v[48:51], a[104:107], a[40:43], v[48:51]
s_add_u32 m0, s77, 98304
ds_read_b64_tr_b16 a[88:89], v19 offset:36864
v_mfma_f32_16x16x32_bf16 v[64:67], a[104:107], a[48:51], v[64:67]
s_add_u32 s64, s71, 4194304
ds_read_b64_tr_b16 a[90:91], v19 offset:37120
v_mfma_f32_16x16x32_bf16 v[64:67], a[108:111], a[52:55], v[64:67]
buffer_load_dwordx4 v14, s[56:59], s64 offen lds
v_mfma_f32_16x16x32_bf16 v[80:83], a[108:111], a[60:63], v[80:83]
ds_read_b64_tr_b16 a[92:93], v19 offset:38912
v_mfma_f32_16x16x32_bf16 v[80:83], a[104:107], a[56:59], v[80:83]
ds_read_b64_tr_b16 a[94:95], v19 offset:39168
v_mfma_f32_16x16x32_bf16 v[144:147], a[112:115], a[56:59], v[144:147]
ds_read_b128 a[64:67], v17 offset:32768
v_mfma_f32_16x16x32_bf16 v[144:147], a[116:119], a[60:63], v[144:147]
s_add_u32 s65, s79, 26624
ds_read_b128 a[68:71], v18 offset:32768
v_mfma_f32_16x16x32_bf16 v[128:131], a[116:119], a[52:55], v[128:131]
buffer_store_dwordx4 a[204:207], v16, s[44:47], s65 offen sc1
v_mfma_f32_16x16x32_bf16 v[128:131], a[112:115], a[48:51], v[128:131]
s_add_u32 m0, s78, 114688
ds_read_b64_tr_b16 a[96:97], v21 offset:36864
v_mfma_f32_16x16x32_bf16 v[112:115], a[112:115], a[40:43], v[112:115]
s_add_u32 s64, s75, 3145728
ds_read_b64_tr_b16 a[98:99], v21 offset:37120
v_mfma_f32_16x16x32_bf16 v[112:115], a[116:119], a[44:47], v[112:115]
buffer_load_dwordx4 v23, s[60:63], s64 offen lds
v_mfma_f32_16x16x32_bf16 v[96:99], a[116:119], a[36:39], v[96:99]
ds_read_b64_tr_b16 a[100:101], v21 offset:38912
v_mfma_f32_16x16x32_bf16 v[96:99], a[112:115], a[32:35], v[96:99]
ds_read_b64_tr_b16 a[102:103], v21 offset:39168
v_mfma_f32_16x16x32_bf16 v[36:39], a[72:75], a[32:35], v[36:39]
ds_read_b64_tr_b16 a[104:105], v20 offset:36864
v_mfma_f32_16x16x32_bf16 v[36:39], a[76:79], a[36:39], v[36:39]
ds_read_b64_tr_b16 a[106:107], v20 offset:37120
v_mfma_f32_16x16x32_bf16 v[52:55], a[76:79], a[44:47], v[52:55]
ds_read_b64_tr_b16 a[108:109], v20 offset:38912
v_mfma_f32_16x16x32_bf16 v[52:55], a[72:75], a[40:43], v[52:55]
s_add_u32 m0, s77, 99328
ds_read_b64_tr_b16 a[110:111], v20 offset:39168
v_mfma_f32_16x16x32_bf16 v[68:71], a[72:75], a[48:51], v[68:71]
s_add_u32 s64, s71, 4227072
ds_read_b64_tr_b16 a[112:113], v19 offset:40960
v_mfma_f32_16x16x32_bf16 v[68:71], a[76:79], a[52:55], v[68:71]
buffer_load_dwordx4 v14, s[56:59], s64 offen lds
v_mfma_f32_16x16x32_bf16 v[84:87], a[76:79], a[60:63], v[84:87]
ds_read_b64_tr_b16 a[114:115], v19 offset:41216
v_mfma_f32_16x16x32_bf16 v[84:87], a[72:75], a[56:59], v[84:87]
ds_read_b64_tr_b16 a[116:117], v19 offset:43008
v_mfma_f32_16x16x32_bf16 v[148:151], a[80:83], a[56:59], v[148:151]
ds_read_b64_tr_b16 a[118:119], v19 offset:43264
v_mfma_f32_16x16x32_bf16 v[148:151], a[84:87], a[60:63], v[148:151]
ds_read_b64_tr_b16 a[72:73], v21 offset:40960
v_mfma_f32_16x16x32_bf16 v[132:135], a[84:87], a[52:55], v[132:135]
ds_read_b64_tr_b16 a[74:75], v21 offset:41216
v_mfma_f32_16x16x32_bf16 v[132:135], a[80:83], a[48:51], v[132:135]
s_add_u32 m0, s78, 118784
ds_read_b64_tr_b16 a[76:77], v21 offset:43008
v_mfma_f32_16x16x32_bf16 v[116:119], a[80:83], a[40:43], v[116:119]
s_add_u32 s64, s75, 3147776
ds_read_b64_tr_b16 a[78:79], v21 offset:43264
v_mfma_f32_16x16x32_bf16 v[116:119], a[84:87], a[44:47], v[116:119]
buffer_load_dwordx4 v23, s[60:63], s64 offen lds
v_mfma_f32_16x16x32_bf16 v[100:103], a[84:87], a[36:39], v[100:103]
v_mfma_f32_16x16x32_bf16 v[100:103], a[80:83], a[32:35], v[100:103]
s_waitcnt lgkmcnt(7)
ds_read_b64_tr_b16 a[80:81], v20 offset:40960
v_mfma_f32_16x16x32_bf16 v[184:187], a[88:91], a[0:3], v[184:187]
s_add_u32 s17, s78, .-L_pc+6144
ds_read_b64_tr_b16 a[82:83], v20 offset:41216
v_mfma_f32_16x16x32_bf16 v[184:187], a[92:95], a[4:7], v[184:187]
ds_read_b64_tr_b16 a[84:85], v20 offset:43008
v_subrev_u32 v17, 0x8000, v17
v_mfma_f32_16x16x32_bf16 v[192:195], a[92:95], a[12:15], v[192:195]
ds_read_b64_tr_b16 a[86:87], v20 offset:43264
v_subrev_u32 v18, 0x8000, v18
v_mfma_f32_16x16x32_bf16 v[192:195], a[88:91], a[8:11], v[192:195]
s_add_u32 m0, s77, 100352
v_mfma_f32_16x16x32_bf16 v[200:203], a[88:91], a[16:19], v[200:203]
s_add_u32 s64, s71, 4259840
buffer_load_dword a252, v16, s[88:91], s17 offen
v_mfma_f32_16x16x32_bf16 v[200:203], a[92:95], a[20:23], v[200:203]
s_add_u32 s65, s79, 27648
buffer_load_dwordx4 v15, s[56:59], s64 offen lds
v_mfma_f32_16x16x32_bf16 v[208:211], a[92:95], a[28:31], v[208:211]
buffer_store_dwordx4 a[208:211], v16, s[44:47], s65 offen sc1
v_mfma_f32_16x16x32_bf16 v[208:211], a[88:91], a[24:27], v[208:211]
ds_read_b64_tr_b16 a[88:89], v19 offset:32768
v_mfma_f32_16x16x32_bf16 v[248:251], a[96:99], a[64:67], v[248:251]
ds_read_b64_tr_b16 a[90:91], v19 offset:33024
v_mfma_f32_16x16x32_bf16 v[248:251], a[100:103], a[68:71], v[248:251]
ds_read_b64_tr_b16 a[92:93], v19 offset:34816
v_mfma_f32_16x16x32_bf16 v[212:215], a[108:111], a[28:31], v[212:215]
ds_read_b64_tr_b16 a[94:95], v19 offset:35072
v_mfma_f32_16x16x32_bf16 v[212:215], a[104:107], a[24:27], v[212:215]
s_add_u32 m0, s78, 122880
ds_read_b64_tr_b16 a[96:97], v20 offset:32768
v_mfma_f32_16x16x32_bf16 v[204:207], a[104:107], a[16:19], v[204:207]
s_add_u32 s64, s75, 3149824
ds_read_b64_tr_b16 a[98:99], v20 offset:33024
v_mfma_f32_16x16x32_bf16 v[204:207], a[108:111], a[20:23], v[204:207]
buffer_load_dwordx4 v23, s[60:63], s64 offen lds
v_mfma_f32_16x16x32_bf16 v[196:199], a[108:111], a[12:15], v[196:199]
ds_read_b64_tr_b16 a[100:101], v20 offset:34816
v_mfma_f32_16x16x32_bf16 v[196:199], a[104:107], a[8:11], v[196:199]
ds_read_b64_tr_b16 a[102:103], v20 offset:35072
v_mfma_f32_16x16x32_bf16 v[188:191], a[104:107], a[0:3], v[188:191]
v_mfma_f32_16x16x32_bf16 v[188:191], a[108:111], a[4:7], v[188:191]
s_waitcnt lgkmcnt(7)
ds_read_b64_tr_b16 a[104:105], v4 offset:32768
v_mfma_f32_16x16x32_bf16 v[216:219], a[4:7], a[116:119], v[216:219]
s_add_u32 m0, s77, 101376
ds_read_b64_tr_b16 a[106:107], v4 offset:33792
v_mfma_f32_16x16x32_bf16 v[216:219], a[0:3], a[112:115], v[216:219]
ds_read_b64_tr_b16 a[108:109], v4 offset:40960
v_subrev_u32 v21, 0x8000, v21
v_mfma_f32_16x16x32_bf16 v[224:227], a[8:11], a[112:115], v[224:227]
s_add_u32 s64, s71, 4292608
ds_read_b64_tr_b16 a[110:111], v4 offset:41984
v_mfma_f32_16x16x32_bf16 v[224:227], a[12:15], a[116:119], v[224:227]
buffer_load_dwordx4 v15, s[56:59], s64 offen lds
v_mfma_f32_16x16x32_bf16 v[232:235], a[20:23], a[116:119], v[232:235]
v_mfma_f32_16x16x32_bf16 v[232:235], a[16:19], a[112:115], v[232:235]
v_mfma_f32_16x16x32_bf16 v[240:243], a[24:27], a[112:115], v[240:243]
v_mfma_f32_16x16x32_bf16 v[240:243], a[28:31], a[116:119], v[240:243]
ds_read_b64_tr_b16 a[112:113], v5 offset:32768
v_mfma_f32_16x16x32_bf16 v[252:255], a[68:71], a[76:79], v[252:255]
ds_read_b64_tr_b16 a[114:115], v5 offset:33792
v_mfma_f32_16x16x32_bf16 v[252:255], a[64:67], a[72:75], v[252:255]
s_add_u32 m0, s78, 126976
ds_read_b64_tr_b16 a[116:117], v5 offset:40960
v_mfma_f32_16x16x32_bf16 v[244:247], a[24:27], a[80:83], v[244:247]
s_add_u32 s64, s74, 1024
ds_read_b64_tr_b16 a[118:119], v5 offset:41984
v_mfma_f32_16x16x32_bf16 v[244:247], a[28:31], a[84:87], v[244:247]
buffer_load_dwordx4 v22, s[48:51], s64 offen lds
v_mfma_f32_16x16x32_bf16 v[236:239], a[20:23], a[84:87], v[236:239]
ds_read_b64_tr_b16 a[72:73], v6 offset:32768
v_subrev_u32 v19, 0x8000, v19
v_mfma_f32_16x16x32_bf16 v[236:239], a[16:19], a[80:83], v[236:239]
ds_read_b64_tr_b16 a[74:75], v6 offset:33792
v_mfma_f32_16x16x32_bf16 v[228:231], a[8:11], a[80:83], v[228:231]
ds_read_b64_tr_b16 a[76:77], v6 offset:40960
v_mfma_f32_16x16x32_bf16 v[228:231], a[12:15], a[84:87], v[228:231]
s_add_u32 s65, s79, 11264
ds_read_b64_tr_b16 a[78:79], v6 offset:41984
v_mfma_f32_16x16x32_bf16 v[220:223], a[4:7], a[84:87], v[220:223]
buffer_store_dwordx4 a[212:215], v16, s[44:47], s65 offen sc1
v_mfma_f32_16x16x32_bf16 v[220:223], a[0:3], a[80:83], v[220:223]
s_waitcnt lgkmcnt(7)
ds_read_b64_tr_b16 a[80:81], v7 offset:32768
v_mfma_f32_16x16x32_bf16 v[152:155], a[88:91], a[0:3], v[152:155]
ds_read_b64_tr_b16 a[82:83], v7 offset:33792
v_mfma_f32_16x16x32_bf16 v[152:155], a[92:95], a[4:7], v[152:155]
ds_read_b64_tr_b16 a[84:85], v7 offset:40960
v_subrev_u32 v20, 0x8000, v20
v_mfma_f32_16x16x32_bf16 v[160:163], a[92:95], a[12:15], v[160:163]
s_add_u32 m0, s76, 0
ds_read_b64_tr_b16 a[86:87], v7 offset:41984
v_mfma_f32_16x16x32_bf16 v[160:163], a[88:91], a[8:11], v[160:163]
s_add_u32 s64, s72, 1024
v_mfma_f32_16x16x32_bf16 v[168:171], a[88:91], a[16:19], v[168:171]
buffer_load_dwordx4 v12, s[48:51], s64 offen lds
v_mfma_f32_16x16x32_bf16 v[168:171], a[92:95], a[20:23], v[168:171]
v_mfma_f32_16x16x32_bf16 v[176:179], a[92:95], a[28:31], v[176:179]
v_mfma_f32_16x16x32_bf16 v[176:179], a[88:91], a[24:27], v[176:179]
s_add_u32 m0, s76, 1024
ds_read_b64_tr_b16 a[88:89], v8 offset:32768
v_mfma_f32_16x16x32_bf16 v[180:183], a[96:99], a[24:27], v[180:183]
s_add_u32 s64, s72, 17408
ds_read_b64_tr_b16 a[90:91], v8 offset:33792
v_mfma_f32_16x16x32_bf16 v[180:183], a[100:103], a[28:31], v[180:183]
buffer_load_dwordx4 v13, s[48:51], s64 offen lds
v_mfma_f32_16x16x32_bf16 v[172:175], a[100:103], a[20:23], v[172:175]
ds_read_b64_tr_b16 a[92:93], v8 offset:40960
v_subrev_u32 v4, 0x8000, v4
v_mfma_f32_16x16x32_bf16 v[172:175], a[96:99], a[16:19], v[172:175]
ds_read_b64_tr_b16 a[94:95], v8 offset:41984
v_mfma_f32_16x16x32_bf16 v[164:167], a[96:99], a[8:11], v[164:167]
v_mfma_f32_16x16x32_bf16 v[164:167], a[100:103], a[12:15], v[164:167]
s_add_u32 m0, s76, 2048
v_mfma_f32_16x16x32_bf16 v[156:159], a[100:103], a[4:7], v[156:159]
s_add_u32 s64, s72, 132096
v_mfma_f32_16x16x32_bf16 v[156:159], a[96:99], a[0:3], v[156:159]
buffer_load_dwordx4 v12, s[48:51], s64 offen lds
v_mfma_f32_16x16x32_bf16 v[24:27], a[104:107], a[0:3], v[24:27]
s_add_u32 m0, s76, 3072
ds_read_b64_tr_b16 a[96:97], v9 offset:32768
v_mfma_f32_16x16x32_bf16 v[24:27], a[108:111], a[4:7], v[24:27]
ds_read_b64_tr_b16 a[98:99], v9 offset:33792
v_subrev_u32 v5, 0x8000, v5
v_mfma_f32_16x16x32_bf16 v[40:43], a[108:111], a[12:15], v[40:43]
s_waitcnt vmcnt(15)
ds_read_b64_tr_b16 a[100:101], v9 offset:40960
v_mfma_f32_16x16x32_bf16 v[40:43], a[104:107], a[8:11], v[40:43]
s_add_u32 s64, s72, 148480
ds_read_b64_tr_b16 a[102:103], v9 offset:41984
v_mfma_f32_16x16x32_bf16 v[56:59], a[104:107], a[16:19], v[56:59]
buffer_load_dwordx4 v13, s[48:51], s64 offen lds
v_mfma_f32_16x16x32_bf16 v[56:59], a[108:111], a[20:23], v[56:59]
ds_read_b128 a[32:35], v2 offset:32768
v_mfma_f32_16x16x32_bf16 v[72:75], a[108:111], a[28:31], v[72:75]
ds_read_b128 a[36:39], v3 offset:32768
v_mfma_f32_16x16x32_bf16 v[72:75], a[104:107], a[24:27], v[72:75]
s_waitcnt lgkmcnt(6)
s_add_u32 m0, s76, 4096
ds_read_b128 a[40:43], v2 offset:34816
v_mfma_f32_16x16x32_bf16 v[136:139], a[112:115], a[24:27], v[136:139]
s_add_u32 s64, s73, 1024
ds_read_b128 a[44:47], v3 offset:34816
v_mfma_f32_16x16x32_bf16 v[136:139], a[116:119], a[28:31], v[136:139]
ds_read_b128 a[48:51], v2 offset:36864
v_subrev_u32 v6, 0x8000, v6
v_mfma_f32_16x16x32_bf16 v[120:123], a[116:119], a[20:23], v[120:123]
buffer_load_dwordx4 v12, s[48:51], s64 offen lds
v_mfma_f32_16x16x32_bf16 v[120:123], a[112:115], a[16:19], v[120:123]
ds_read_b128 a[52:55], v3 offset:36864
v_mfma_f32_16x16x32_bf16 v[104:107], a[112:115], a[8:11], v[104:107]
ds_read_b128 a[56:59], v2 offset:38912
v_mfma_f32_16x16x32_bf16 v[104:107], a[116:119], a[12:15], v[104:107]
s_add_u32 m0, s76, 5120
ds_read_b128 a[60:63], v3 offset:38912
v_mfma_f32_16x16x32_bf16 v[88:91], a[116:119], a[4:7], v[88:91]
s_add_u32 s64, s73, 17408
ds_read_b64_tr_b16 a[104:105], v10 offset:32768
v_mfma_f32_16x16x32_bf16 v[88:91], a[112:115], a[0:3], v[88:91]
buffer_load_dwordx4 v13, s[48:51], s64 offen lds
v_mfma_f32_16x16x32_bf16 v[28:31], a[72:75], a[0:3], v[28:31]
ds_read_b64_tr_b16 a[106:107], v10 offset:33792
v_mfma_f32_16x16x32_bf16 v[28:31], a[76:79], a[4:7], v[28:31]
ds_read_b64_tr_b16 a[108:109], v10 offset:40960
v_subrev_u32 v7, 0x8000, v7
v_mfma_f32_16x16x32_bf16 v[44:47], a[76:79], a[12:15], v[44:47]
ds_read_b64_tr_b16 a[110:111], v10 offset:41984
v_mfma_f32_16x16x32_bf16 v[44:47], a[72:75], a[8:11], v[44:47]
s_add_u32 m0, s76, 6144
ds_read_b64_tr_b16 a[112:113], v11 offset:32768
v_mfma_f32_16x16x32_bf16 v[60:63], a[72:75], a[16:19], v[60:63]
s_add_u32 s64, s73, 132096
ds_read_b64_tr_b16 a[114:115], v11 offset:33792
v_mfma_f32_16x16x32_bf16 v[60:63], a[76:79], a[20:23], v[60:63]
buffer_load_dwordx4 v12, s[48:51], s64 offen lds
v_mfma_f32_16x16x32_bf16 v[76:79], a[76:79], a[28:31], v[76:79]
ds_read_b64_tr_b16 a[116:117], v11 offset:40960
v_mfma_f32_16x16x32_bf16 v[76:79], a[72:75], a[24:27], v[76:79]
ds_read_b64_tr_b16 a[118:119], v11 offset:41984
v_mfma_f32_16x16x32_bf16 v[140:143], a[80:83], a[24:27], v[140:143]
s_add_u32 m0, s76, 7168
v_mfma_f32_16x16x32_bf16 v[140:143], a[84:87], a[28:31], v[140:143]
s_add_u32 s64, s73, 148480
v_subrev_u32 v8, 0x8000, v8
v_mfma_f32_16x16x32_bf16 v[124:127], a[84:87], a[20:23], v[124:127]
buffer_load_dwordx4 v13, s[48:51], s64 offen lds
v_mfma_f32_16x16x32_bf16 v[124:127], a[80:83], a[16:19], v[124:127]
v_mfma_f32_16x16x32_bf16 v[108:111], a[80:83], a[8:11], v[108:111]
v_mfma_f32_16x16x32_bf16 v[108:111], a[84:87], a[12:15], v[108:111]
v_mfma_f32_16x16x32_bf16 v[92:95], a[84:87], a[4:7], v[92:95]
v_subrev_u32 v9, 0x8000, v9
v_subrev_u32 v10, 0x8000, v10
v_mfma_f32_16x16x32_bf16 v[92:95], a[80:83], a[0:3], v[92:95]
v_subrev_u32 v11, 0x8000, v11
v_mfma_f32_16x16x32_bf16 v[32:35], a[88:91], a[0:3], v[32:35]
v_mfma_f32_16x16x32_bf16 v[32:35], a[92:95], a[4:7], v[32:35]
v_mfma_f32_16x16x32_bf16 v[48:51], a[92:95], a[12:15], v[48:51]
s_waitcnt lgkmcnt(0)
s_barrier
v_mfma_f32_16x16x32_bf16 v[48:51], a[88:91], a[8:11], v[48:51]
s_add_u32 m0, s77, 131072
ds_read_b64_tr_b16 a[72:73], v19 offset:4096
v_mfma_f32_16x16x32_bf16 v[64:67], a[88:91], a[16:19], v[64:67]
s_add_u32 s64, s71, 4718592
ds_read_b64_tr_b16 a[74:75], v19 offset:4352
v_mfma_f32_16x16x32_bf16 v[64:67], a[92:95], a[20:23], v[64:67]
buffer_load_dwordx4 v14, s[56:59], s64 offen lds
v_mfma_f32_16x16x32_bf16 v[80:83], a[92:95], a[28:31], v[80:83]
ds_read_b64_tr_b16 a[76:77], v19 offset:6144
v_mfma_f32_16x16x32_bf16 v[80:83], a[88:91], a[24:27], v[80:83]
ds_read_b64_tr_b16 a[78:79], v19 offset:6400
v_mfma_f32_16x16x32_bf16 v[144:147], a[96:99], a[24:27], v[144:147]
ds_read_b128 a[64:67], v17 offset:0
v_mfma_f32_16x16x32_bf16 v[144:147], a[100:103], a[28:31], v[144:147]
s_add_u32 s65, s79, 28672
ds_read_b128 a[68:71], v18 offset:0
v_mfma_f32_16x16x32_bf16 v[128:131], a[100:103], a[20:23], v[128:131]
buffer_store_dwordx4 a[216:219], v16, s[44:47], s65 offen sc1
v_mfma_f32_16x16x32_bf16 v[128:131], a[96:99], a[16:19], v[128:131]
s_add_u32 m0, s78, 147456
ds_read_b64_tr_b16 a[80:81], v21 offset:4096
v_mfma_f32_16x16x32_bf16 v[112:115], a[96:99], a[8:11], v[112:115]
s_add_u32 s64, s75, 3538944
ds_read_b64_tr_b16 a[82:83], v21 offset:4352
v_mfma_f32_16x16x32_bf16 v[112:115], a[100:103], a[12:15], v[112:115]
buffer_load_dwordx4 v23, s[60:63], s64 offen lds
v_mfma_f32_16x16x32_bf16 v[96:99], a[100:103], a[4:7], v[96:99]
ds_read_b64_tr_b16 a[84:85], v21 offset:6144
v_mfma_f32_16x16x32_bf16 v[96:99], a[96:99], a[0:3], v[96:99]
ds_read_b64_tr_b16 a[86:87], v21 offset:6400
v_mfma_f32_16x16x32_bf16 v[36:39], a[104:107], a[0:3], v[36:39]
ds_read_b64_tr_b16 a[88:89], v20 offset:4096
v_mfma_f32_16x16x32_bf16 v[36:39], a[108:111], a[4:7], v[36:39]
ds_read_b64_tr_b16 a[90:91], v20 offset:4352
v_mfma_f32_16x16x32_bf16 v[52:55], a[108:111], a[12:15], v[52:55]
ds_read_b64_tr_b16 a[92:93], v20 offset:6144
v_mfma_f32_16x16x32_bf16 v[52:55], a[104:107], a[8:11], v[52:55]
s_add_u32 m0, s77, 132096
ds_read_b64_tr_b16 a[94:95], v20 offset:6400
v_mfma_f32_16x16x32_bf16 v[68:71], a[104:107], a[16:19], v[68:71]
s_add_u32 s64, s71, 4751360
ds_read_b64_tr_b16 a[96:97], v19 offset:8192
v_mfma_f32_16x16x32_bf16 v[68:71], a[108:111], a[20:23], v[68:71]
buffer_load_dwordx4 v14, s[56:59], s64 offen lds
v_mfma_f32_16x16x32_bf16 v[84:87], a[108:111], a[28:31], v[84:87]
ds_read_b64_tr_b16 a[98:99], v19 offset:8448
v_mfma_f32_16x16x32_bf16 v[84:87], a[104:107], a[24:27], v[84:87]
ds_read_b64_tr_b16 a[100:101], v19 offset:10240
v_mfma_f32_16x16x32_bf16 v[148:151], a[112:115], a[24:27], v[148:151]
ds_read_b64_tr_b16 a[102:103], v19 offset:10496
v_mfma_f32_16x16x32_bf16 v[148:151], a[116:119], a[28:31], v[148:151]
ds_read_b64_tr_b16 a[104:105], v21 offset:8192
v_mfma_f32_16x16x32_bf16 v[132:135], a[116:119], a[20:23], v[132:135]
ds_read_b64_tr_b16 a[106:107], v21 offset:8448
v_mfma_f32_16x16x32_bf16 v[132:135], a[112:115], a[16:19], v[132:135]
s_add_u32 m0, s78, 151552
ds_read_b64_tr_b16 a[108:109], v21 offset:10240
v_mfma_f32_16x16x32_bf16 v[116:119], a[112:115], a[8:11], v[116:119]
s_add_u32 s64, s75, 3540992
ds_read_b64_tr_b16 a[110:111], v21 offset:10496
v_mfma_f32_16x16x32_bf16 v[116:119], a[116:119], a[12:15], v[116:119]
buffer_load_dwordx4 v23, s[60:63], s64 offen lds
v_mfma_f32_16x16x32_bf16 v[100:103], a[116:119], a[4:7], v[100:103]
v_mfma_f32_16x16x32_bf16 v[100:103], a[112:115], a[0:3], v[100:103]
s_waitcnt lgkmcnt(7)
ds_read_b64_tr_b16 a[112:113], v20 offset:8192
v_mfma_f32_16x16x32_bf16 v[184:187], a[72:75], a[32:35], v[184:187]
ds_read_b64_tr_b16 a[114:115], v20 offset:8448
v_mfma_f32_16x16x32_bf16 v[184:187], a[76:79], a[36:39], v[184:187]
s_add_u32 s17, s78, .-L_pc+6144
ds_read_b64_tr_b16 a[116:117], v20 offset:10240
v_mfma_f32_16x16x32_bf16 v[192:195], a[76:79], a[44:47], v[192:195]
s_add_u32 m0, s77, 133120
ds_read_b64_tr_b16 a[118:119], v20 offset:10496
v_mfma_f32_16x16x32_bf16 v[192:195], a[72:75], a[40:43], v[192:195]
s_add_u32 s64, s71, 4784128
v_mfma_f32_16x16x32_bf16 v[200:203], a[72:75], a[48:51], v[200:203]
buffer_load_dword a252, v16, s[88:91], s17 offen
v_mfma_f32_16x16x32_bf16 v[200:203], a[76:79], a[52:55], v[200:203]
s_add_u32 s65, s79, 29696
buffer_load_dwordx4 v15, s[56:59], s64 offen lds
v_mfma_f32_16x16x32_bf16 v[208:211], a[76:79], a[60:63], v[208:211]
buffer_store_dwordx4 a[220:223], v16, s[44:47], s65 offen sc1
v_mfma_f32_16x16x32_bf16 v[208:211], a[72:75], a[56:59], v[208:211]
ds_read_b64_tr_b16 a[72:73], v19 offset:0
v_mfma_f32_16x16x32_bf16 v[248:251], a[80:83], a[64:67], v[248:251]
ds_read_b64_tr_b16 a[74:75], v19 offset:256
v_mfma_f32_16x16x32_bf16 v[248:251], a[84:87], a[68:71], v[248:251]
ds_read_b64_tr_b16 a[76:77], v19 offset:2048
v_mfma_f32_16x16x32_bf16 v[212:215], a[92:95], a[60:63], v[212:215]
ds_read_b64_tr_b16 a[78:79], v19 offset:2304
v_mfma_f32_16x16x32_bf16 v[212:215], a[88:91], a[56:59], v[212:215]
s_add_u32 m0, s78, 155648
ds_read_b64_tr_b16 a[80:81], v20 offset:0
v_mfma_f32_16x16x32_bf16 v[204:207], a[88:91], a[48:51], v[204:207]
s_add_u32 s64, s75, 3543040
ds_read_b64_tr_b16 a[82:83], v20 offset:256
v_mfma_f32_16x16x32_bf16 v[204:207], a[92:95], a[52:55], v[204:207]
buffer_load_dwordx4 v23, s[60:63], s64 offen lds
v_mfma_f32_16x16x32_bf16 v[196:199], a[92:95], a[44:47], v[196:199]
ds_read_b64_tr_b16 a[84:85], v20 offset:2048
v_mfma_f32_16x16x32_bf16 v[196:199], a[88:91], a[40:43], v[196:199]
ds_read_b64_tr_b16 a[86:87], v20 offset:2304
v_mfma_f32_16x16x32_bf16 v[188:191], a[88:91], a[32:35], v[188:191]
v_mfma_f32_16x16x32_bf16 v[188:191], a[92:95], a[36:39], v[188:191]
s_waitcnt lgkmcnt(7)
ds_read_b64_tr_b16 a[88:89], v4 offset:0
v_mfma_f32_16x16x32_bf16 v[216:219], a[36:39], a[100:103], v[216:219]
ds_read_b64_tr_b16 a[90:91], v4 offset:1024
v_mfma_f32_16x16x32_bf16 v[216:219], a[32:35], a[96:99], v[216:219]
s_add_u32 m0, s77, 134144
ds_read_b64_tr_b16 a[92:93], v4 offset:8192
v_mfma_f32_16x16x32_bf16 v[224:227], a[40:43], a[96:99], v[224:227]
s_add_u32 s64, s71, 4816896
ds_read_b64_tr_b16 a[94:95], v4 offset:9216
v_mfma_f32_16x16x32_bf16 v[224:227], a[44:47], a[100:103], v[224:227]
buffer_load_dwordx4 v15, s[56:59], s64 offen lds
v_mfma_f32_16x16x32_bf16 v[232:235], a[52:55], a[100:103], v[232:235]
v_mfma_f32_16x16x32_bf16 v[232:235], a[48:51], a[96:99], v[232:235]
v_mfma_f32_16x16x32_bf16 v[240:243], a[56:59], a[96:99], v[240:243]
v_mfma_f32_16x16x32_bf16 v[240:243], a[60:63], a[100:103], v[240:243]
ds_read_b64_tr_b16 a[96:97], v5 offset:0
v_mfma_f32_16x16x32_bf16 v[252:255], a[68:71], a[108:111], v[252:255]
ds_read_b64_tr_b16 a[98:99], v5 offset:1024
v_mfma_f32_16x16x32_bf16 v[252:255], a[64:67], a[104:107], v[252:255]
s_add_u32 m0, s78, 159744
ds_read_b64_tr_b16 a[100:101], v5 offset:8192
v_mfma_f32_16x16x32_bf16 v[244:247], a[56:59], a[112:115], v[244:247]
s_add_u32 s64, s74, 1152
ds_read_b64_tr_b16 a[102:103], v5 offset:9216
v_mfma_f32_16x16x32_bf16 v[244:247], a[60:63], a[116:119], v[244:247]
buffer_load_dwordx4 v22, s[48:51], s64 offen lds
v_mfma_f32_16x16x32_bf16 v[236:239], a[52:55], a[116:119], v[236:239]
ds_read_b64_tr_b16 a[104:105], v6 offset:0
v_mfma_f32_16x16x32_bf16 v[236:239], a[48:51], a[112:115], v[236:239]
ds_read_b64_tr_b16 a[106:107], v6 offset:1024
v_mfma_f32_16x16x32_bf16 v[228:231], a[40:43], a[112:115], v[228:231]
ds_read_b64_tr_b16 a[108:109], v6 offset:8192
v_mfma_f32_16x16x32_bf16 v[228:231], a[44:47], a[116:119], v[228:231]
s_add_u32 s65, s79, 13312
ds_read_b64_tr_b16 a[110:111], v6 offset:9216
v_mfma_f32_16x16x32_bf16 v[220:223], a[36:39], a[116:119], v[220:223]
buffer_store_dwordx4 a[224:227], v16, s[44:47], s65 offen sc1
v_mfma_f32_16x16x32_bf16 v[220:223], a[32:35], a[112:115], v[220:223]
s_waitcnt lgkmcnt(7)
ds_read_b64_tr_b16 a[112:113], v7 offset:0
v_mfma_f32_16x16x32_bf16 v[152:155], a[72:75], a[32:35], v[152:155]
ds_read_b64_tr_b16 a[114:115], v7 offset:1024
v_mfma_f32_16x16x32_bf16 v[152:155], a[76:79], a[36:39], v[152:155]
ds_read_b64_tr_b16 a[116:117], v7 offset:8192
v_mfma_f32_16x16x32_bf16 v[160:163], a[76:79], a[44:47], v[160:163]
s_add_u32 m0, s76, 32768
ds_read_b64_tr_b16 a[118:119], v7 offset:9216
v_mfma_f32_16x16x32_bf16 v[160:163], a[72:75], a[40:43], v[160:163]
s_add_u32 s64, s72, 1152
v_mfma_f32_16x16x32_bf16 v[168:171], a[72:75], a[48:51], v[168:171]
buffer_load_dwordx4 v12, s[48:51], s64 offen lds
v_mfma_f32_16x16x32_bf16 v[168:171], a[76:79], a[52:55], v[168:171]
v_mfma_f32_16x16x32_bf16 v[176:179], a[76:79], a[60:63], v[176:179]
v_mfma_f32_16x16x32_bf16 v[176:179], a[72:75], a[56:59], v[176:179]
s_add_u32 m0, s76, 33792
ds_read_b64_tr_b16 a[72:73], v8 offset:0
v_mfma_f32_16x16x32_bf16 v[180:183], a[80:83], a[56:59], v[180:183]
s_add_u32 s64, s72, 17536
ds_read_b64_tr_b16 a[74:75], v8 offset:1024
v_mfma_f32_16x16x32_bf16 v[180:183], a[84:87], a[60:63], v[180:183]
buffer_load_dwordx4 v13, s[48:51], s64 offen lds
v_mfma_f32_16x16x32_bf16 v[172:175], a[84:87], a[52:55], v[172:175]
ds_read_b64_tr_b16 a[76:77], v8 offset:8192
v_mfma_f32_16x16x32_bf16 v[172:175], a[80:83], a[48:51], v[172:175]
ds_read_b64_tr_b16 a[78:79], v8 offset:9216
v_mfma_f32_16x16x32_bf16 v[164:167], a[80:83], a[40:43], v[164:167]
v_mfma_f32_16x16x32_bf16 v[164:167], a[84:87], a[44:47], v[164:167]
s_add_u32 m0, s76, 34816
v_mfma_f32_16x16x32_bf16 v[156:159], a[84:87], a[36:39], v[156:159]
s_add_u32 s64, s72, 132224
v_mfma_f32_16x16x32_bf16 v[156:159], a[80:83], a[32:35], v[156:159]
buffer_load_dwordx4 v12, s[48:51], s64 offen lds
v_mfma_f32_16x16x32_bf16 v[24:27], a[88:91], a[32:35], v[24:27]
ds_read_b64_tr_b16 a[80:81], v9 offset:0
v_mfma_f32_16x16x32_bf16 v[24:27], a[92:95], a[36:39], v[24:27]
s_add_u32 m0, s76, 35840
ds_read_b64_tr_b16 a[82:83], v9 offset:1024
v_mfma_f32_16x16x32_bf16 v[40:43], a[92:95], a[44:47], v[40:43]
s_waitcnt vmcnt(15)
ds_read_b64_tr_b16 a[84:85], v9 offset:8192
v_mfma_f32_16x16x32_bf16 v[40:43], a[88:91], a[40:43], v[40:43]
s_add_u32 s64, s72, 148608
ds_read_b64_tr_b16 a[86:87], v9 offset:9216
v_mfma_f32_16x16x32_bf16 v[56:59], a[88:91], a[48:51], v[56:59]
buffer_load_dwordx4 v13, s[48:51], s64 offen lds
v_mfma_f32_16x16x32_bf16 v[56:59], a[92:95], a[52:55], v[56:59]
ds_read_b128 a[0:3], v2 offset:0
v_mfma_f32_16x16x32_bf16 v[72:75], a[92:95], a[60:63], v[72:75]
ds_read_b128 a[4:7], v3 offset:0
v_mfma_f32_16x16x32_bf16 v[72:75], a[88:91], a[56:59], v[72:75]
s_waitcnt lgkmcnt(6)
ds_read_b128 a[8:11], v2 offset:2048
v_mfma_f32_16x16x32_bf16 v[136:139], a[96:99], a[56:59], v[136:139]
s_add_u32 m0, s76, 36864
ds_read_b128 a[12:15], v3 offset:2048
v_mfma_f32_16x16x32_bf16 v[136:139], a[100:103], a[60:63], v[136:139]
s_add_u32 s64, s73, 1152
ds_read_b128 a[16:19], v2 offset:4096
v_mfma_f32_16x16x32_bf16 v[120:123], a[100:103], a[52:55], v[120:123]
buffer_load_dwordx4 v12, s[48:51], s64 offen lds
v_mfma_f32_16x16x32_bf16 v[120:123], a[96:99], a[48:51], v[120:123]
ds_read_b128 a[20:23], v3 offset:4096
v_mfma_f32_16x16x32_bf16 v[104:107], a[96:99], a[40:43], v[104:107]
ds_read_b128 a[24:27], v2 offset:6144
v_mfma_f32_16x16x32_bf16 v[104:107], a[100:103], a[44:47], v[104:107]
s_add_u32 m0, s76, 37888
ds_read_b128 a[28:31], v3 offset:6144
v_mfma_f32_16x16x32_bf16 v[88:91], a[100:103], a[36:39], v[88:91]
s_add_u32 s64, s73, 17536
ds_read_b64_tr_b16 a[88:89], v10 offset:0
v_mfma_f32_16x16x32_bf16 v[88:91], a[96:99], a[32:35], v[88:91]
buffer_load_dwordx4 v13, s[48:51], s64 offen lds
v_mfma_f32_16x16x32_bf16 v[28:31], a[104:107], a[32:35], v[28:31]
ds_read_b64_tr_b16 a[90:91], v10 offset:1024
v_mfma_f32_16x16x32_bf16 v[28:31], a[108:111], a[36:39], v[28:31]
ds_read_b64_tr_b16 a[92:93], v10 offset:8192
v_mfma_f32_16x16x32_bf16 v[44:47], a[108:111], a[44:47], v[44:47]
s_add_u32 m0, s76, 38912
ds_read_b64_tr_b16 a[94:95], v10 offset:9216
v_mfma_f32_16x16x32_bf16 v[44:47], a[104:107], a[40:43], v[44:47]
s_add_u32 s64, s73, 132224
ds_read_b64_tr_b16 a[96:97], v11 offset:0
v_mfma_f32_16x16x32_bf16 v[60:63], a[104:107], a[48:51], v[60:63]
buffer_load_dword v1, off, s[52:55], 0 sc1
v_mfma_f32_16x16x32_bf16 v[60:63], a[108:111], a[52:55], v[60:63]
buffer_load_dwordx4 v12, s[48:51], s64 offen lds
v_mfma_f32_16x16x32_bf16 v[76:79], a[108:111], a[60:63], v[76:79]
ds_read_b64_tr_b16 a[98:99], v11 offset:1024
v_mfma_f32_16x16x32_bf16 v[76:79], a[104:107], a[56:59], v[76:79]
ds_read_b64_tr_b16 a[100:101], v11 offset:8192
v_mfma_f32_16x16x32_bf16 v[140:143], a[112:115], a[56:59], v[140:143]
s_add_u32 m0, s76, 39936
ds_read_b64_tr_b16 a[102:103], v11 offset:9216
v_mfma_f32_16x16x32_bf16 v[140:143], a[116:119], a[60:63], v[140:143]
s_add_u32 s64, s73, 148608
v_mfma_f32_16x16x32_bf16 v[124:127], a[116:119], a[52:55], v[124:127]
buffer_load_dwordx4 v13, s[48:51], s64 offen lds
v_mfma_f32_16x16x32_bf16 v[124:127], a[112:115], a[48:51], v[124:127]
v_mfma_f32_16x16x32_bf16 v[108:111], a[112:115], a[40:43], v[108:111]
v_mfma_f32_16x16x32_bf16 v[108:111], a[116:119], a[44:47], v[108:111]
v_mfma_f32_16x16x32_bf16 v[92:95], a[116:119], a[36:39], v[92:95]
v_mfma_f32_16x16x32_bf16 v[92:95], a[112:115], a[32:35], v[92:95]
v_mfma_f32_16x16x32_bf16 v[32:35], a[72:75], a[32:35], v[32:35]
v_mfma_f32_16x16x32_bf16 v[32:35], a[76:79], a[36:39], v[32:35]
v_mfma_f32_16x16x32_bf16 v[48:51], a[76:79], a[44:47], v[48:51]
s_waitcnt lgkmcnt(0)
s_barrier
v_mfma_f32_16x16x32_bf16 v[48:51], a[72:75], a[40:43], v[48:51]
s_add_u32 m0, s77, 65536
ds_read_b64_tr_b16 a[104:105], v19 offset:36864
v_mfma_f32_16x16x32_bf16 v[64:67], a[72:75], a[48:51], v[64:67]
s_add_u32 s64, s71, 5242880
ds_read_b64_tr_b16 a[106:107], v19 offset:37120
v_mfma_f32_16x16x32_bf16 v[64:67], a[76:79], a[52:55], v[64:67]
buffer_load_dwordx4 v14, s[56:59], s64 offen lds
v_mfma_f32_16x16x32_bf16 v[80:83], a[76:79], a[60:63], v[80:83]
ds_read_b64_tr_b16 a[108:109], v19 offset:38912
v_mfma_f32_16x16x32_bf16 v[80:83], a[72:75], a[56:59], v[80:83]
ds_read_b64_tr_b16 a[110:111], v19 offset:39168
v_mfma_f32_16x16x32_bf16 v[144:147], a[80:83], a[56:59], v[144:147]
ds_read_b128 a[64:67], v17 offset:32768
v_mfma_f32_16x16x32_bf16 v[144:147], a[84:87], a[60:63], v[144:147]
s_add_u32 s65, s79, 30720
ds_read_b128 a[68:71], v18 offset:32768
v_mfma_f32_16x16x32_bf16 v[128:131], a[84:87], a[52:55], v[128:131]
buffer_store_dwordx4 a[228:231], v16, s[44:47], s65 offen sc1
v_mfma_f32_16x16x32_bf16 v[128:131], a[80:83], a[48:51], v[128:131]
s_add_u32 m0, s78, 81920
ds_read_b64_tr_b16 a[112:113], v21 offset:36864
v_mfma_f32_16x16x32_bf16 v[112:115], a[80:83], a[40:43], v[112:115]
s_add_u32 s64, s75, 3932160
ds_read_b64_tr_b16 a[114:115], v21 offset:37120
v_mfma_f32_16x16x32_bf16 v[112:115], a[84:87], a[44:47], v[112:115]
buffer_load_dwordx4 v23, s[60:63], s64 offen lds
v_mfma_f32_16x16x32_bf16 v[96:99], a[84:87], a[36:39], v[96:99]
ds_read_b64_tr_b16 a[116:117], v21 offset:38912
v_mfma_f32_16x16x32_bf16 v[96:99], a[80:83], a[32:35], v[96:99]
ds_read_b64_tr_b16 a[118:119], v21 offset:39168
v_mfma_f32_16x16x32_bf16 v[36:39], a[88:91], a[32:35], v[36:39]
ds_read_b64_tr_b16 a[72:73], v20 offset:36864
v_mfma_f32_16x16x32_bf16 v[36:39], a[92:95], a[36:39], v[36:39]
ds_read_b64_tr_b16 a[74:75], v20 offset:37120
v_mfma_f32_16x16x32_bf16 v[52:55], a[92:95], a[44:47], v[52:55]
ds_read_b64_tr_b16 a[76:77], v20 offset:38912
v_mfma_f32_16x16x32_bf16 v[52:55], a[88:91], a[40:43], v[52:55]
s_add_u32 m0, s77, 66560
ds_read_b64_tr_b16 a[78:79], v20 offset:39168
v_mfma_f32_16x16x32_bf16 v[68:71], a[88:91], a[48:51], v[68:71]
s_add_u32 s64, s71, 5275648
ds_read_b64_tr_b16 a[80:81], v19 offset:40960
v_mfma_f32_16x16x32_bf16 v[68:71], a[92:95], a[52:55], v[68:71]
buffer_load_dwordx4 v14, s[56:59], s64 offen lds
v_mfma_f32_16x16x32_bf16 v[84:87], a[92:95], a[60:63], v[84:87]
ds_read_b64_tr_b16 a[82:83], v19 offset:41216
v_mfma_f32_16x16x32_bf16 v[84:87], a[88:91], a[56:59], v[84:87]
ds_read_b64_tr_b16 a[84:85], v19 offset:43008
v_mfma_f32_16x16x32_bf16 v[148:151], a[96:99], a[56:59], v[148:151]
ds_read_b64_tr_b16 a[86:87], v19 offset:43264
v_mfma_f32_16x16x32_bf16 v[148:151], a[100:103], a[60:63], v[148:151]
ds_read_b64_tr_b16 a[88:89], v21 offset:40960
v_mfma_f32_16x16x32_bf16 v[132:135], a[100:103], a[52:55], v[132:135]
ds_read_b64_tr_b16 a[90:91], v21 offset:41216
v_mfma_f32_16x16x32_bf16 v[132:135], a[96:99], a[48:51], v[132:135]
s_add_u32 m0, s78, 86016
ds_read_b64_tr_b16 a[92:93], v21 offset:43008
v_mfma_f32_16x16x32_bf16 v[116:119], a[96:99], a[40:43], v[116:119]
s_add_u32 s64, s75, 3934208
ds_read_b64_tr_b16 a[94:95], v21 offset:43264
v_mfma_f32_16x16x32_bf16 v[116:119], a[100:103], a[44:47], v[116:119]
buffer_load_dwordx4 v23, s[60:63], s64 offen lds
v_mfma_f32_16x16x32_bf16 v[100:103], a[100:103], a[36:39], v[100:103]
v_mfma_f32_16x16x32_bf16 v[100:103], a[96:99], a[32:35], v[100:103]
s_waitcnt lgkmcnt(7)
ds_read_b64_tr_b16 a[96:97], v20 offset:40960
v_mfma_f32_16x16x32_bf16 v[184:187], a[104:107], a[0:3], v[184:187]
s_add_u32 s17, s78, .-L_pc+6144
ds_read_b64_tr_b16 a[98:99], v20 offset:41216
v_mfma_f32_16x16x32_bf16 v[184:187], a[108:111], a[4:7], v[184:187]
ds_read_b64_tr_b16 a[100:101], v20 offset:43008
v_add_u32 v17, 0x8000, v17
v_mfma_f32_16x16x32_bf16 v[192:195], a[108:111], a[12:15], v[192:195]
ds_read_b64_tr_b16 a[102:103], v20 offset:43264
v_add_u32 v18, 0x8000, v18
v_mfma_f32_16x16x32_bf16 v[192:195], a[104:107], a[8:11], v[192:195]
s_add_u32 m0, s77, 67584
v_mfma_f32_16x16x32_bf16 v[200:203], a[104:107], a[16:19], v[200:203]
s_add_u32 s64, s71, 5308416
buffer_load_dword a252, v16, s[88:91], s17 offen
v_mfma_f32_16x16x32_bf16 v[200:203], a[108:111], a[20:23], v[200:203]
s_add_u32 s65, s79, 31744
buffer_load_dwordx4 v15, s[56:59], s64 offen lds
v_mfma_f32_16x16x32_bf16 v[208:211], a[108:111], a[28:31], v[208:211]
buffer_store_dwordx4 a[232:235], v16, s[44:47], s65 offen sc1
v_mfma_f32_16x16x32_bf16 v[208:211], a[104:107], a[24:27], v[208:211]
ds_read_b64_tr_b16 a[104:105], v19 offset:32768
v_mfma_f32_16x16x32_bf16 v[248:251], a[112:115], a[64:67], v[248:251]
ds_read_b64_tr_b16 a[106:107], v19 offset:33024
v_mfma_f32_16x16x32_bf16 v[248:251], a[116:119], a[68:71], v[248:251]
ds_read_b64_tr_b16 a[108:109], v19 offset:34816
v_mfma_f32_16x16x32_bf16 v[212:215], a[76:79], a[28:31], v[212:215]
ds_read_b64_tr_b16 a[110:111], v19 offset:35072
v_mfma_f32_16x16x32_bf16 v[212:215], a[72:75], a[24:27], v[212:215]
s_add_u32 m0, s78, 90112
ds_read_b64_tr_b16 a[112:113], v20 offset:32768
v_mfma_f32_16x16x32_bf16 v[204:207], a[72:75], a[16:19], v[204:207]
s_add_u32 s64, s75, 3936256
ds_read_b64_tr_b16 a[114:115], v20 offset:33024
v_mfma_f32_16x16x32_bf16 v[204:207], a[76:79], a[20:23], v[204:207]
buffer_load_dwordx4 v23, s[60:63], s64 offen lds
v_mfma_f32_16x16x32_bf16 v[196:199], a[76:79], a[12:15], v[196:199]
ds_read_b64_tr_b16 a[116:117], v20 offset:34816
v_mfma_f32_16x16x32_bf16 v[196:199], a[72:75], a[8:11], v[196:199]
ds_read_b64_tr_b16 a[118:119], v20 offset:35072
v_mfma_f32_16x16x32_bf16 v[188:191], a[72:75], a[0:3], v[188:191]
v_mfma_f32_16x16x32_bf16 v[188:191], a[76:79], a[4:7], v[188:191]
s_waitcnt lgkmcnt(7)
ds_read_b64_tr_b16 a[72:73], v4 offset:32768
v_mfma_f32_16x16x32_bf16 v[216:219], a[4:7], a[84:87], v[216:219]
s_add_u32 m0, s77, 68608
ds_read_b64_tr_b16 a[74:75], v4 offset:33792
v_mfma_f32_16x16x32_bf16 v[216:219], a[0:3], a[80:83], v[216:219]
ds_read_b64_tr_b16 a[76:77], v4 offset:40960
v_add_u32 v21, 0x8000, v21
v_mfma_f32_16x16x32_bf16 v[224:227], a[8:11], a[80:83], v[224:227]
s_add_u32 s64, s71, 5341184
ds_read_b64_tr_b16 a[78:79], v4 offset:41984
v_mfma_f32_16x16x32_bf16 v[224:227], a[12:15], a[84:87], v[224:227]
buffer_load_dwordx4 v15, s[56:59], s64 offen lds
v_mfma_f32_16x16x32_bf16 v[232:235], a[20:23], a[84:87], v[232:235]
v_mfma_f32_16x16x32_bf16 v[232:235], a[16:19], a[80:83], v[232:235]
v_mfma_f32_16x16x32_bf16 v[240:243], a[24:27], a[80:83], v[240:243]
v_mfma_f32_16x16x32_bf16 v[240:243], a[28:31], a[84:87], v[240:243]
ds_read_b64_tr_b16 a[80:81], v5 offset:32768
v_mfma_f32_16x16x32_bf16 v[252:255], a[68:71], a[92:95], v[252:255]
ds_read_b64_tr_b16 a[82:83], v5 offset:33792
v_mfma_f32_16x16x32_bf16 v[252:255], a[64:67], a[88:91], v[252:255]
s_add_u32 m0, s78, 94208
ds_read_b64_tr_b16 a[84:85], v5 offset:40960
v_mfma_f32_16x16x32_bf16 v[244:247], a[24:27], a[96:99], v[244:247]
s_add_u32 s64, s74, 1280
ds_read_b64_tr_b16 a[86:87], v5 offset:41984
v_mfma_f32_16x16x32_bf16 v[244:247], a[28:31], a[100:103], v[244:247]
buffer_load_dwordx4 v22, s[48:51], s64 offen lds
v_mfma_f32_16x16x32_bf16 v[236:239], a[20:23], a[100:103], v[236:239]
ds_read_b64_tr_b16 a[88:89], v6 offset:32768
v_add_u32 v19, 0x8000, v19
v_mfma_f32_16x16x32_bf16 v[236:239], a[16:19], a[96:99], v[236:239]
ds_read_b64_tr_b16 a[90:91], v6 offset:33792
v_mfma_f32_16x16x32_bf16 v[228:231], a[8:11], a[96:99], v[228:231]
ds_read_b64_tr_b16 a[92:93], v6 offset:40960
v_mfma_f32_16x16x32_bf16 v[228:231], a[12:15], a[100:103], v[228:231]
s_add_u32 s65, s79, 15360
ds_read_b64_tr_b16 a[94:95], v6 offset:41984
v_mfma_f32_16x16x32_bf16 v[220:223], a[4:7], a[100:103], v[220:223]
buffer_store_dwordx4 a[236:239], v16, s[44:47], s65 offen sc1
v_mfma_f32_16x16x32_bf16 v[220:223], a[0:3], a[96:99], v[220:223]
s_waitcnt lgkmcnt(7)
ds_read_b64_tr_b16 a[96:97], v7 offset:32768
v_mfma_f32_16x16x32_bf16 v[152:155], a[104:107], a[0:3], v[152:155]
ds_read_b64_tr_b16 a[98:99], v7 offset:33792
v_mfma_f32_16x16x32_bf16 v[152:155], a[108:111], a[4:7], v[152:155]
ds_read_b64_tr_b16 a[100:101], v7 offset:40960
v_add_u32 v20, 0x8000, v20
v_mfma_f32_16x16x32_bf16 v[160:163], a[108:111], a[12:15], v[160:163]
s_add_u32 m0, s76, 0
ds_read_b64_tr_b16 a[102:103], v7 offset:41984
v_mfma_f32_16x16x32_bf16 v[160:163], a[104:107], a[8:11], v[160:163]
s_add_u32 s64, s72, 1280
v_mfma_f32_16x16x32_bf16 v[168:171], a[104:107], a[16:19], v[168:171]
buffer_load_dwordx4 v12, s[48:51], s64 offen lds
v_mfma_f32_16x16x32_bf16 v[168:171], a[108:111], a[20:23], v[168:171]
v_mfma_f32_16x16x32_bf16 v[176:179], a[108:111], a[28:31], v[176:179]
v_mfma_f32_16x16x32_bf16 v[176:179], a[104:107], a[24:27], v[176:179]
s_add_u32 m0, s76, 1024
ds_read_b64_tr_b16 a[104:105], v8 offset:32768
v_mfma_f32_16x16x32_bf16 v[180:183], a[112:115], a[24:27], v[180:183]
s_add_u32 s64, s72, 17664
ds_read_b64_tr_b16 a[106:107], v8 offset:33792
v_mfma_f32_16x16x32_bf16 v[180:183], a[116:119], a[28:31], v[180:183]
buffer_load_dwordx4 v13, s[48:51], s64 offen lds
v_mfma_f32_16x16x32_bf16 v[172:175], a[116:119], a[20:23], v[172:175]
ds_read_b64_tr_b16 a[108:109], v8 offset:40960
v_add_u32 v4, 0x8000, v4
v_mfma_f32_16x16x32_bf16 v[172:175], a[112:115], a[16:19], v[172:175]
ds_read_b64_tr_b16 a[110:111], v8 offset:41984
v_mfma_f32_16x16x32_bf16 v[164:167], a[112:115], a[8:11], v[164:167]
v_mfma_f32_16x16x32_bf16 v[164:167], a[116:119], a[12:15], v[164:167]
s_add_u32 m0, s76, 2048
v_mfma_f32_16x16x32_bf16 v[156:159], a[116:119], a[4:7], v[156:159]
s_add_u32 s64, s72, 132352
v_mfma_f32_16x16x32_bf16 v[156:159], a[112:115], a[0:3], v[156:159]
buffer_load_dwordx4 v12, s[48:51], s64 offen lds
v_mfma_f32_16x16x32_bf16 v[24:27], a[72:75], a[0:3], v[24:27]
s_add_u32 m0, s76, 3072
ds_read_b64_tr_b16 a[112:113], v9 offset:32768
v_mfma_f32_16x16x32_bf16 v[24:27], a[76:79], a[4:7], v[24:27]
ds_read_b64_tr_b16 a[114:115], v9 offset:33792
v_add_u32 v5, 0x8000, v5
v_mfma_f32_16x16x32_bf16 v[40:43], a[76:79], a[12:15], v[40:43]
s_waitcnt vmcnt(15)
ds_read_b64_tr_b16 a[116:117], v9 offset:40960
v_mfma_f32_16x16x32_bf16 v[40:43], a[72:75], a[8:11], v[40:43]
s_add_u32 s64, s72, 148736
ds_read_b64_tr_b16 a[118:119], v9 offset:41984
v_mfma_f32_16x16x32_bf16 v[56:59], a[72:75], a[16:19], v[56:59]
buffer_load_dwordx4 v13, s[48:51], s64 offen lds
v_mfma_f32_16x16x32_bf16 v[56:59], a[76:79], a[20:23], v[56:59]
ds_read_b128 a[32:35], v2 offset:32768
v_mfma_f32_16x16x32_bf16 v[72:75], a[76:79], a[28:31], v[72:75]
ds_read_b128 a[36:39], v3 offset:32768
v_mfma_f32_16x16x32_bf16 v[72:75], a[72:75], a[24:27], v[72:75]
s_waitcnt lgkmcnt(6)
s_add_u32 m0, s76, 4096
ds_read_b128 a[40:43], v2 offset:34816
v_mfma_f32_16x16x32_bf16 v[136:139], a[80:83], a[24:27], v[136:139]
s_add_u32 s64, s73, 1280
ds_read_b128 a[44:47], v3 offset:34816
v_mfma_f32_16x16x32_bf16 v[136:139], a[84:87], a[28:31], v[136:139]
ds_read_b128 a[48:51], v2 offset:36864
v_add_u32 v6, 0x8000, v6
v_mfma_f32_16x16x32_bf16 v[120:123], a[84:87], a[20:23], v[120:123]
buffer_load_dwordx4 v12, s[48:51], s64 offen lds
v_mfma_f32_16x16x32_bf16 v[120:123], a[80:83], a[16:19], v[120:123]
ds_read_b128 a[52:55], v3 offset:36864
v_mfma_f32_16x16x32_bf16 v[104:107], a[80:83], a[8:11], v[104:107]
s_add_u32 m0, s76, 5120
ds_read_b128 a[56:59], v2 offset:38912
v_mfma_f32_16x16x32_bf16 v[104:107], a[84:87], a[12:15], v[104:107]
s_add_u32 s64, s73, 17664
ds_read_b128 a[60:63], v3 offset:38912
v_mfma_f32_16x16x32_bf16 v[88:91], a[84:87], a[4:7], v[88:91]
v_readfirstlane_b32 s66, v1
s_nop 0
s_cmp_lt_u32 s66, 256
s_cbranch_scc1 L_spin_1
L_spinbk_2:
v_mfma_f32_16x16x32_bf16 v[88:91], a[80:83], a[0:3], v[88:91]
buffer_load_dwordx4 v13, s[48:51], s64 offen lds
v_mfma_f32_16x16x32_bf16 v[28:31], a[88:91], a[0:3], v[28:31]
ds_read_b64_tr_b16 a[72:73], v10 offset:32768
v_mfma_f32_16x16x32_bf16 v[28:31], a[92:95], a[4:7], v[28:31]
ds_read_b64_tr_b16 a[74:75], v10 offset:33792
v_add_u32 v7, 0x8000, v7
v_mfma_f32_16x16x32_bf16 v[44:47], a[92:95], a[12:15], v[44:47]
ds_read_b64_tr_b16 a[76:77], v10 offset:40960
v_mfma_f32_16x16x32_bf16 v[44:47], a[88:91], a[8:11], v[44:47]
s_add_u32 m0, s76, 6144
ds_read_b64_tr_b16 a[78:79], v10 offset:41984
v_mfma_f32_16x16x32_bf16 v[60:63], a[88:91], a[16:19], v[60:63]
s_add_u32 s64, s73, 132352
ds_read_b64_tr_b16 a[80:81], v11 offset:32768
v_mfma_f32_16x16x32_bf16 v[60:63], a[92:95], a[20:23], v[60:63]
buffer_load_dwordx4 v12, s[48:51], s64 offen lds
v_mfma_f32_16x16x32_bf16 v[76:79], a[92:95], a[28:31], v[76:79]
ds_read_b64_tr_b16 a[82:83], v11 offset:33792
v_mfma_f32_16x16x32_bf16 v[76:79], a[88:91], a[24:27], v[76:79]
ds_read_b64_tr_b16 a[84:85], v11 offset:40960
v_mfma_f32_16x16x32_bf16 v[140:143], a[96:99], a[24:27], v[140:143]
s_add_u32 m0, s76, 7168
ds_read_b64_tr_b16 a[86:87], v11 offset:41984
v_mfma_f32_16x16x32_bf16 v[140:143], a[100:103], a[28:31], v[140:143]
s_add_u32 s64, s73, 148736
v_add_u32 v8, 0x8000, v8
v_mfma_f32_16x16x32_bf16 v[124:127], a[100:103], a[20:23], v[124:127]
buffer_load_dwordx4 v13, s[48:51], s64 offen lds
v_mfma_f32_16x16x32_bf16 v[124:127], a[96:99], a[16:19], v[124:127]
v_mfma_f32_16x16x32_bf16 v[108:111], a[96:99], a[8:11], v[108:111]
v_mfma_f32_16x16x32_bf16 v[108:111], a[100:103], a[12:15], v[108:111]
v_mfma_f32_16x16x32_bf16 v[92:95], a[100:103], a[4:7], v[92:95]
v_add_u32 v9, 0x8000, v9
v_add_u32 v10, 0x8000, v10
v_mfma_f32_16x16x32_bf16 v[92:95], a[96:99], a[0:3], v[92:95]
v_add_u32 v11, 0x8000, v11
v_mfma_f32_16x16x32_bf16 v[32:35], a[104:107], a[0:3], v[32:35]
s_add_u32 s52, s28, 59768832
s_addc_u32 s53, s29, 0
s_mov_b32 s54, 16384
v_mfma_f32_16x16x32_bf16 v[32:35], a[108:111], a[4:7], v[32:35]
v_mfma_f32_16x16x32_bf16 v[48:51], a[108:111], a[12:15], v[48:51]
s_waitcnt lgkmcnt(0)
s_barrier
v_mfma_f32_16x16x32_bf16 v[48:51], a[104:107], a[8:11], v[48:51]
s_add_u32 m0, s77, 98304
ds_read_b64_tr_b16 a[88:89], v19 offset:36864
v_mfma_f32_16x16x32_bf16 v[64:67], a[104:107], a[16:19], v[64:67]
s_add_u32 s64, s71, 5767168
ds_read_b64_tr_b16 a[90:91], v19 offset:37120
v_mfma_f32_16x16x32_bf16 v[64:67], a[108:111], a[20:23], v[64:67]
buffer_load_dwordx4 v14, s[56:59], s64 offen lds
v_mfma_f32_16x16x32_bf16 v[80:83], a[108:111], a[28:31], v[80:83]
ds_read_b64_tr_b16 a[92:93], v19 offset:38912
v_mfma_f32_16x16x32_bf16 v[80:83], a[104:107], a[24:27], v[80:83]
ds_read_b64_tr_b16 a[94:95], v19 offset:39168
v_mfma_f32_16x16x32_bf16 v[144:147], a[112:115], a[24:27], v[144:147]
ds_read_b128 a[64:67], v17 offset:32768
v_mfma_f32_16x16x32_bf16 v[144:147], a[116:119], a[28:31], v[144:147]
ds_read_b128 a[68:71], v18 offset:32768
v_mfma_f32_16x16x32_bf16 v[128:131], a[116:119], a[20:23], v[128:131]
ds_read_b64_tr_b16 a[96:97], v21 offset:36864
v_mfma_f32_16x16x32_bf16 v[128:131], a[112:115], a[16:19], v[128:131]
s_add_u32 m0, s78, 114688
ds_read_b64_tr_b16 a[98:99], v21 offset:37120
v_mfma_f32_16x16x32_bf16 v[112:115], a[112:115], a[8:11], v[112:115]
s_add_u32 s64, s75, 4325376
ds_read_b64_tr_b16 a[100:101], v21 offset:38912
v_mfma_f32_16x16x32_bf16 v[112:115], a[116:119], a[12:15], v[112:115]
buffer_load_dwordx4 v23, s[60:63], s64 offen lds
v_mfma_f32_16x16x32_bf16 v[96:99], a[116:119], a[4:7], v[96:99]
ds_read_b64_tr_b16 a[102:103], v21 offset:39168
v_mfma_f32_16x16x32_bf16 v[96:99], a[112:115], a[0:3], v[96:99]
ds_read_b64_tr_b16 a[104:105], v20 offset:36864
v_mfma_f32_16x16x32_bf16 v[36:39], a[72:75], a[0:3], v[36:39]
ds_read_b64_tr_b16 a[106:107], v20 offset:37120
v_mfma_f32_16x16x32_bf16 v[36:39], a[76:79], a[4:7], v[36:39]
ds_read_b64_tr_b16 a[108:109], v20 offset:38912
v_mfma_f32_16x16x32_bf16 v[52:55], a[76:79], a[12:15], v[52:55]
ds_read_b64_tr_b16 a[110:111], v20 offset:39168
v_mfma_f32_16x16x32_bf16 v[52:55], a[72:75], a[8:11], v[52:55]
s_add_u32 m0, s77, 99328
ds_read_b64_tr_b16 a[112:113], v19 offset:40960
v_mfma_f32_16x16x32_bf16 v[68:71], a[72:75], a[16:19], v[68:71]
s_add_u32 s64, s71, 5799936
ds_read_b64_tr_b16 a[114:115], v19 offset:41216
v_mfma_f32_16x16x32_bf16 v[68:71], a[76:79], a[20:23], v[68:71]
buffer_load_dwordx4 v14, s[56:59], s64 offen lds
v_mfma_f32_16x16x32_bf16 v[84:87], a[76:79], a[28:31], v[84:87]
ds_read_b64_tr_b16 a[116:117], v19 offset:43008
v_mfma_f32_16x16x32_bf16 v[84:87], a[72:75], a[24:27], v[84:87]
ds_read_b64_tr_b16 a[118:119], v19 offset:43264
v_mfma_f32_16x16x32_bf16 v[148:151], a[80:83], a[24:27], v[148:151]
ds_read_b64_tr_b16 a[72:73], v21 offset:40960
v_mfma_f32_16x16x32_bf16 v[148:151], a[84:87], a[28:31], v[148:151]
ds_read_b64_tr_b16 a[74:75], v21 offset:41216
v_mfma_f32_16x16x32_bf16 v[132:135], a[84:87], a[20:23], v[132:135]
ds_read_b64_tr_b16 a[76:77], v21 offset:43008
v_mfma_f32_16x16x32_bf16 v[132:135], a[80:83], a[16:19], v[132:135]
s_add_u32 m0, s78, 118784
ds_read_b64_tr_b16 a[78:79], v21 offset:43264
v_mfma_f32_16x16x32_bf16 v[116:119], a[80:83], a[8:11], v[116:119]
s_add_u32 s64, s75, 4327424
v_mfma_f32_16x16x32_bf16 v[116:119], a[84:87], a[12:15], v[116:119]
buffer_load_dwordx4 v23, s[60:63], s64 offen lds
v_mfma_f32_16x16x32_bf16 v[100:103], a[84:87], a[4:7], v[100:103]
v_mfma_f32_16x16x32_bf16 v[100:103], a[80:83], a[0:3], v[100:103]
s_waitcnt lgkmcnt(6)
ds_read_b64_tr_b16 a[80:81], v20 offset:40960
v_mfma_f32_16x16x32_bf16 v[184:187], a[88:91], a[32:35], v[184:187]
s_lshl_b32 s66, s30, 30
ds_read_b64_tr_b16 a[82:83], v20 offset:41216
v_mfma_f32_16x16x32_bf16 v[184:187], a[92:95], a[36:39], v[184:187]
ds_read_b64_tr_b16 a[84:85], v20 offset:43008
v_lshl_add_u32 v1, v0, 24, s66
v_mfma_f32_16x16x32_bf16 v[192:195], a[92:95], a[44:47], v[192:195]
s_lshl_b32 s80, s31, 8
ds_read_b64_tr_b16 a[86:87], v20 offset:43264
v_subrev_u32 v17, 0x8000, v17
v_mfma_f32_16x16x32_bf16 v[192:195], a[88:91], a[40:43], v[192:195]
s_add_u32 m0, s77, 100352
s_add_u32 s17, s78, .-L_pc+6144
v_subrev_u32 v18, 0x8000, v18
v_mfma_f32_16x16x32_bf16 v[200:203], a[88:91], a[48:51], v[200:203]
s_add_u32 s64, s71, 5832704
buffer_load_dword a252, v16, s[88:91], s17 offen
v_mfma_f32_16x16x32_bf16 v[200:203], a[92:95], a[52:55], v[200:203]
buffer_load_dwordx4 v15, s[56:59], s64 offen lds
v_mfma_f32_16x16x32_bf16 v[208:211], a[92:95], a[60:63], v[208:211]
v_mfma_f32_16x16x32_bf16 v[208:211], a[88:91], a[56:59], v[208:211]
ds_read_b64_tr_b16 a[88:89], v19 offset:32768
v_mfma_f32_16x16x32_bf16 v[248:251], a[96:99], a[64:67], v[248:251]
ds_read_b64_tr_b16 a[90:91], v19 offset:33024
v_mfma_f32_16x16x32_bf16 v[248:251], a[100:103], a[68:71], v[248:251]
ds_read_b64_tr_b16 a[92:93], v19 offset:34816
v_mfma_f32_16x16x32_bf16 v[212:215], a[108:111], a[60:63], v[212:215]
ds_read_b64_tr_b16 a[94:95], v19 offset:35072
v_mfma_f32_16x16x32_bf16 v[212:215], a[104:107], a[56:59], v[212:215]
s_add_u32 m0, s78, 122880
ds_read_b64_tr_b16 a[96:97], v20 offset:32768
v_mfma_f32_16x16x32_bf16 v[204:207], a[104:107], a[48:51], v[204:207]
s_add_u32 s64, s75, 4329472
ds_read_b64_tr_b16 a[98:99], v20 offset:33024
v_mfma_f32_16x16x32_bf16 v[204:207], a[108:111], a[52:55], v[204:207]
buffer_load_dwordx4 v23, s[60:63], s64 offen lds
v_mfma_f32_16x16x32_bf16 v[196:199], a[108:111], a[44:47], v[196:199]
ds_read_b64_tr_b16 a[100:101], v20 offset:34816
v_mfma_f32_16x16x32_bf16 v[196:199], a[104:107], a[40:43], v[196:199]
ds_read_b64_tr_b16 a[102:103], v20 offset:35072
v_mfma_f32_16x16x32_bf16 v[188:191], a[104:107], a[32:35], v[188:191]
v_mfma_f32_16x16x32_bf16 v[188:191], a[108:111], a[36:39], v[188:191]
s_waitcnt lgkmcnt(7)
ds_read_b64_tr_b16 a[104:105], v4 offset:32768
v_mfma_f32_16x16x32_bf16 v[216:219], a[36:39], a[116:119], v[216:219]
s_add_u32 m0, s77, 101376
ds_read_b64_tr_b16 a[106:107], v4 offset:33792
v_mfma_f32_16x16x32_bf16 v[216:219], a[32:35], a[112:115], v[216:219]
ds_read_b64_tr_b16 a[108:109], v4 offset:40960
v_subrev_u32 v21, 0x8000, v21
v_mfma_f32_16x16x32_bf16 v[224:227], a[40:43], a[112:115], v[224:227]
s_add_u32 s64, s71, 5865472
ds_read_b64_tr_b16 a[110:111], v4 offset:41984
v_mfma_f32_16x16x32_bf16 v[224:227], a[44:47], a[116:119], v[224:227]
buffer_load_dwordx4 v15, s[56:59], s64 offen lds
v_mfma_f32_16x16x32_bf16 v[232:235], a[52:55], a[116:119], v[232:235]
v_mfma_f32_16x16x32_bf16 v[232:235], a[48:51], a[112:115], v[232:235]
v_mfma_f32_16x16x32_bf16 v[240:243], a[56:59], a[112:115], v[240:243]
v_mfma_f32_16x16x32_bf16 v[240:243], a[60:63], a[116:119], v[240:243]
ds_read_b64_tr_b16 a[112:113], v5 offset:32768
v_mfma_f32_16x16x32_bf16 v[252:255], a[68:71], a[76:79], v[252:255]
ds_read_b64_tr_b16 a[114:115], v5 offset:33792
v_mfma_f32_16x16x32_bf16 v[252:255], a[64:67], a[72:75], v[252:255]
s_add_u32 m0, s78, 126976
ds_read_b64_tr_b16 a[116:117], v5 offset:40960
v_mfma_f32_16x16x32_bf16 v[244:247], a[56:59], a[80:83], v[244:247]
s_add_u32 s64, s74, 1408
ds_read_b64_tr_b16 a[118:119], v5 offset:41984
v_mfma_f32_16x16x32_bf16 v[244:247], a[60:63], a[84:87], v[244:247]
buffer_load_dwordx4 v22, s[48:51], s64 offen lds
v_mfma_f32_16x16x32_bf16 v[236:239], a[52:55], a[84:87], v[236:239]
ds_read_b64_tr_b16 a[72:73], v6 offset:32768
v_subrev_u32 v19, 0x8000, v19
v_mfma_f32_16x16x32_bf16 v[236:239], a[48:51], a[80:83], v[236:239]
ds_read_b64_tr_b16 a[74:75], v6 offset:33792
v_mfma_f32_16x16x32_bf16 v[228:231], a[40:43], a[80:83], v[228:231]
ds_read_b64_tr_b16 a[76:77], v6 offset:40960
v_mfma_f32_16x16x32_bf16 v[228:231], a[44:47], a[84:87], v[228:231]
ds_read_b64_tr_b16 a[78:79], v6 offset:41984
v_mfma_f32_16x16x32_bf16 v[220:223], a[36:39], a[84:87], v[220:223]
v_mfma_f32_16x16x32_bf16 v[220:223], a[32:35], a[80:83], v[220:223]
s_waitcnt lgkmcnt(7)
ds_read_b64_tr_b16 a[80:81], v7 offset:32768
v_mfma_f32_16x16x32_bf16 v[152:155], a[88:91], a[32:35], v[152:155]
ds_read_b64_tr_b16 a[82:83], v7 offset:33792
v_mfma_f32_16x16x32_bf16 v[152:155], a[92:95], a[36:39], v[152:155]
ds_read_b64_tr_b16 a[84:85], v7 offset:40960
v_subrev_u32 v20, 0x8000, v20
v_mfma_f32_16x16x32_bf16 v[160:163], a[92:95], a[44:47], v[160:163]
s_add_u32 m0, s76, 32768
ds_read_b64_tr_b16 a[86:87], v7 offset:41984
v_mfma_f32_16x16x32_bf16 v[160:163], a[88:91], a[40:43], v[160:163]
s_add_u32 s64, s72, 1408
v_mfma_f32_16x16x32_bf16 v[168:171], a[88:91], a[48:51], v[168:171]
buffer_load_dwordx4 v12, s[48:51], s64 offen lds
v_mfma_f32_16x16x32_bf16 v[168:171], a[92:95], a[52:55], v[168:171]
v_mfma_f32_16x16x32_bf16 v[176:179], a[92:95], a[60:63], v[176:179]
v_mfma_f32_16x16x32_bf16 v[176:179], a[88:91], a[56:59], v[176:179]
s_add_u32 m0, s76, 33792
ds_read_b64_tr_b16 a[88:89], v8 offset:32768
v_mfma_f32_16x16x32_bf16 v[180:183], a[96:99], a[56:59], v[180:183]
s_add_u32 s64, s72, 17792
ds_read_b64_tr_b16 a[90:91], v8 offset:33792
v_mfma_f32_16x16x32_bf16 v[180:183], a[100:103], a[60:63], v[180:183]
buffer_load_dwordx4 v13, s[48:51], s64 offen lds
v_mfma_f32_16x16x32_bf16 v[172:175], a[100:103], a[52:55], v[172:175]
ds_read_b64_tr_b16 a[92:93], v8 offset:40960
v_subrev_u32 v4, 0x8000, v4
v_mfma_f32_16x16x32_bf16 v[172:175], a[96:99], a[48:51], v[172:175]
ds_read_b64_tr_b16 a[94:95], v8 offset:41984
v_mfma_f32_16x16x32_bf16 v[164:167], a[96:99], a[40:43], v[164:167]
v_mfma_f32_16x16x32_bf16 v[164:167], a[100:103], a[44:47], v[164:167]
s_add_u32 m0, s76, 34816
v_mfma_f32_16x16x32_bf16 v[156:159], a[100:103], a[36:39], v[156:159]
s_add_u32 s64, s72, 132480
v_mfma_f32_16x16x32_bf16 v[156:159], a[96:99], a[32:35], v[156:159]
buffer_load_dwordx4 v12, s[48:51], s64 offen lds
v_mfma_f32_16x16x32_bf16 v[24:27], a[104:107], a[32:35], v[24:27]
s_add_u32 m0, s76, 35840
ds_read_b64_tr_b16 a[96:97], v9 offset:32768
v_mfma_f32_16x16x32_bf16 v[24:27], a[108:111], a[36:39], v[24:27]
ds_read_b64_tr_b16 a[98:99], v9 offset:33792
v_subrev_u32 v5, 0x8000, v5
v_mfma_f32_16x16x32_bf16 v[40:43], a[108:111], a[44:47], v[40:43]
s_waitcnt vmcnt(12)
ds_read_b64_tr_b16 a[100:101], v9 offset:40960
v_mfma_f32_16x16x32_bf16 v[40:43], a[104:107], a[40:43], v[40:43]
s_add_u32 s64, s72, 148864
ds_read_b64_tr_b16 a[102:103], v9 offset:41984
v_mfma_f32_16x16x32_bf16 v[56:59], a[104:107], a[48:51], v[56:59]
buffer_load_dwordx4 v13, s[48:51], s64 offen lds
v_mfma_f32_16x16x32_bf16 v[56:59], a[108:111], a[52:55], v[56:59]
ds_read_b128 a[0:3], v2 offset:0
v_mfma_f32_16x16x32_bf16 v[72:75], a[108:111], a[60:63], v[72:75]
ds_read_b128 a[4:7], v3 offset:0
v_mfma_f32_16x16x32_bf16 v[72:75], a[104:107], a[56:59], v[72:75]
s_waitcnt lgkmcnt(6)
s_add_u32 m0, s76, 36864
ds_read_b128 a[8:11], v2 offset:2048
v_mfma_f32_16x16x32_bf16 v[136:139], a[112:115], a[56:59], v[136:139]
s_add_u32 s64, s73, 1408
ds_read_b128 a[12:15], v3 offset:2048
v_mfma_f32_16x16x32_bf16 v[136:139], a[116:119], a[60:63], v[136:139]
ds_read_b128 a[16:19], v2 offset:4096
v_subrev_u32 v6, 0x8000, v6
v_mfma_f32_16x16x32_bf16 v[120:123], a[116:119], a[52:55], v[120:123]
buffer_load_dwordx4 v12, s[48:51], s64 offen lds
v_mfma_f32_16x16x32_bf16 v[120:123], a[112:115], a[48:51], v[120:123]
ds_read_b128 a[20:23], v3 offset:4096
v_mfma_f32_16x16x32_bf16 v[104:107], a[112:115], a[40:43], v[104:107]
ds_read_b128 a[24:27], v2 offset:6144
v_mfma_f32_16x16x32_bf16 v[104:107], a[116:119], a[44:47], v[104:107]
s_add_u32 m0, s76, 37888
ds_read_b128 a[28:31], v3 offset:6144
v_mfma_f32_16x16x32_bf16 v[88:91], a[116:119], a[36:39], v[88:91]
s_add_u32 s64, s73, 17792
ds_read_b64_tr_b16 a[104:105], v10 offset:32768
v_mfma_f32_16x16x32_bf16 v[88:91], a[112:115], a[32:35], v[88:91]
buffer_load_dwordx4 v13, s[48:51], s64 offen lds
v_mfma_f32_16x16x32_bf16 v[28:31], a[72:75], a[32:35], v[28:31]
ds_read_b64_tr_b16 a[106:107], v10 offset:33792
v_mfma_f32_16x16x32_bf16 v[28:31], a[76:79], a[36:39], v[28:31]
ds_read_b64_tr_b16 a[108:109], v10 offset:40960
v_subrev_u32 v7, 0x8000, v7
v_mfma_f32_16x16x32_bf16 v[44:47], a[76:79], a[44:47], v[44:47]
ds_read_b64_tr_b16 a[110:111], v10 offset:41984
v_mfma_f32_16x16x32_bf16 v[44:47], a[72:75], a[40:43], v[44:47]
s_add_u32 m0, s76, 38912
ds_read_b64_tr_b16 a[112:113], v11 offset:32768
v_mfma_f32_16x16x32_bf16 v[60:63], a[72:75], a[48:51], v[60:63]
s_add_u32 s64, s73, 132480
ds_read_b64_tr_b16 a[114:115], v11 offset:33792
v_mfma_f32_16x16x32_bf16 v[60:63], a[76:79], a[52:55], v[60:63]
buffer_load_dwordx4 v12, s[48:51], s64 offen lds
v_mfma_f32_16x16x32_bf16 v[76:79], a[76:79], a[60:63], v[76:79]
ds_read_b64_tr_b16 a[116:117], v11 offset:40960
v_mfma_f32_16x16x32_bf16 v[76:79], a[72:75], a[56:59], v[76:79]
ds_read_b64_tr_b16 a[118:119], v11 offset:41984
v_mfma_f32_16x16x32_bf16 v[140:143], a[80:83], a[56:59], v[140:143]
s_add_u32 m0, s76, 39936
v_mfma_f32_16x16x32_bf16 v[140:143], a[84:87], a[60:63], v[140:143]
s_add_u32 s64, s73, 148864
v_subrev_u32 v8, 0x8000, v8
v_mfma_f32_16x16x32_bf16 v[124:127], a[84:87], a[52:55], v[124:127]
buffer_load_dwordx4 v13, s[48:51], s64 offen lds
v_mfma_f32_16x16x32_bf16 v[124:127], a[80:83], a[48:51], v[124:127]
v_mfma_f32_16x16x32_bf16 v[108:111], a[80:83], a[40:43], v[108:111]
v_mfma_f32_16x16x32_bf16 v[108:111], a[84:87], a[44:47], v[108:111]
v_mfma_f32_16x16x32_bf16 v[92:95], a[84:87], a[36:39], v[92:95]
v_subrev_u32 v9, 0x8000, v9
v_subrev_u32 v10, 0x8000, v10
v_mfma_f32_16x16x32_bf16 v[92:95], a[80:83], a[32:35], v[92:95]
v_subrev_u32 v11, 0x8000, v11
v_mfma_f32_16x16x32_bf16 v[32:35], a[88:91], a[32:35], v[32:35]
v_mfma_f32_16x16x32_bf16 v[32:35], a[92:95], a[36:39], v[32:35]
v_mfma_f32_16x16x32_bf16 v[48:51], a[92:95], a[44:47], v[48:51]
s_waitcnt lgkmcnt(0)
s_barrier
v_mfma_f32_16x16x32_bf16 v[48:51], a[88:91], a[40:43], v[48:51]
s_add_u32 m0, s77, 131072
buffer_atomic_add a251, v1, s[52:55], s80 offen offset:0 sc1
v_mfma_f32_16x16x32_bf16 v[64:67], a[88:91], a[48:51], v[64:67]
s_add_u32 s64, s71, 6291456
ds_read_b64_tr_b16 a[72:73], v19 offset:4096
v_mfma_f32_16x16x32_bf16 v[64:67], a[92:95], a[52:55], v[64:67]
buffer_load_dwordx4 v14, s[56:59], s64 offen lds
v_mfma_f32_16x16x32_bf16 v[80:83], a[92:95], a[60:63], v[80:83]
ds_read_b64_tr_b16 a[74:75], v19 offset:4352
v_mfma_f32_16x16x32_bf16 v[80:83], a[88:91], a[56:59], v[80:83]
ds_read_b64_tr_b16 a[76:77], v19 offset:6144
v_mfma_f32_16x16x32_bf16 v[144:147], a[96:99], a[56:59], v[144:147]
ds_read_b64_tr_b16 a[78:79], v19 offset:6400
v_mfma_f32_16x16x32_bf16 v[144:147], a[100:103], a[60:63], v[144:147]
ds_read_b128 a[64:67], v17 offset:0
v_mfma_f32_16x16x32_bf16 v[128:131], a[100:103], a[52:55], v[128:131]
ds_read_b128 a[68:71], v18 offset:0
v_mfma_f32_16x16x32_bf16 v[128:131], a[96:99], a[48:51], v[128:131]
s_add_u32 m0, s78, 147456
ds_read_b64_tr_b16 a[80:81], v21 offset:4096
v_mfma_f32_16x16x32_bf16 v[112:115], a[96:99], a[40:43], v[112:115]
s_add_u32 s64, s75, 4718592
ds_read_b64_tr_b16 a[82:83], v21 offset:4352
v_mfma_f32_16x16x32_bf16 v[112:115], a[100:103], a[44:47], v[112:115]
buffer_load_dwordx4 v23, s[60:63], s64 offen lds
v_mfma_f32_16x16x32_bf16 v[96:99], a[100:103], a[36:39], v[96:99]
ds_read_b64_tr_b16 a[84:85], v21 offset:6144
v_mfma_f32_16x16x32_bf16 v[96:99], a[96:99], a[32:35], v[96:99]
ds_read_b64_tr_b16 a[86:87], v21 offset:6400
v_mfma_f32_16x16x32_bf16 v[36:39], a[104:107], a[32:35], v[36:39]
ds_read_b64_tr_b16 a[88:89], v20 offset:4096
v_mfma_f32_16x16x32_bf16 v[36:39], a[108:111], a[36:39], v[36:39]
ds_read_b64_tr_b16 a[90:91], v20 offset:4352
v_mfma_f32_16x16x32_bf16 v[52:55], a[108:111], a[44:47], v[52:55]
ds_read_b64_tr_b16 a[92:93], v20 offset:6144
v_mfma_f32_16x16x32_bf16 v[52:55], a[104:107], a[40:43], v[52:55]
s_add_u32 m0, s77, 132096
ds_read_b64_tr_b16 a[94:95], v20 offset:6400
v_mfma_f32_16x16x32_bf16 v[68:71], a[104:107], a[48:51], v[68:71]
s_add_u32 s64, s71, 6324224
ds_read_b64_tr_b16 a[96:97], v19 offset:8192
v_mfma_f32_16x16x32_bf16 v[68:71], a[108:111], a[52:55], v[68:71]
buffer_load_dwordx4 v14, s[56:59], s64 offen lds
v_mfma_f32_16x16x32_bf16 v[84:87], a[108:111], a[60:63], v[84:87]
ds_read_b64_tr_b16 a[98:99], v19 offset:8448
v_mfma_f32_16x16x32_bf16 v[84:87], a[104:107], a[56:59], v[84:87]
ds_read_b64_tr_b16 a[100:101], v19 offset:10240
v_mfma_f32_16x16x32_bf16 v[148:151], a[112:115], a[56:59], v[148:151]
ds_read_b64_tr_b16 a[102:103], v19 offset:10496
v_mfma_f32_16x16x32_bf16 v[148:151], a[116:119], a[60:63], v[148:151]
ds_read_b64_tr_b16 a[104:105], v21 offset:8192
v_mfma_f32_16x16x32_bf16 v[132:135], a[116:119], a[52:55], v[132:135]
ds_read_b64_tr_b16 a[106:107], v21 offset:8448
v_mfma_f32_16x16x32_bf16 v[132:135], a[112:115], a[48:51], v[132:135]
s_add_u32 m0, s78, 151552
ds_read_b64_tr_b16 a[108:109], v21 offset:10240
v_mfma_f32_16x16x32_bf16 v[116:119], a[112:115], a[40:43], v[116:119]
s_add_u32 s64, s75, 4720640
ds_read_b64_tr_b16 a[110:111], v21 offset:10496
v_mfma_f32_16x16x32_bf16 v[116:119], a[116:119], a[44:47], v[116:119]
buffer_load_dwordx4 v23, s[60:63], s64 offen lds
v_mfma_f32_16x16x32_bf16 v[100:103], a[116:119], a[36:39], v[100:103]
v_mfma_f32_16x16x32_bf16 v[100:103], a[112:115], a[32:35], v[100:103]
s_waitcnt lgkmcnt(7)
ds_read_b64_tr_b16 a[112:113], v20 offset:8192
v_mfma_f32_16x16x32_bf16 v[184:187], a[72:75], a[0:3], v[184:187]
ds_read_b64_tr_b16 a[114:115], v20 offset:8448
v_mfma_f32_16x16x32_bf16 v[184:187], a[76:79], a[4:7], v[184:187]
s_add_u32 s17, s78, .-L_pc+6144
ds_read_b64_tr_b16 a[116:117], v20 offset:10240
v_mfma_f32_16x16x32_bf16 v[192:195], a[76:79], a[12:15], v[192:195]
s_add_u32 m0, s77, 133120
ds_read_b64_tr_b16 a[118:119], v20 offset:10496
v_mfma_f32_16x16x32_bf16 v[192:195], a[72:75], a[8:11], v[192:195]
s_add_u32 s64, s71, 6356992
v_mfma_f32_16x16x32_bf16 v[200:203], a[72:75], a[16:19], v[200:203]
buffer_load_dword a252, v16, s[88:91], s17 offen
v_mfma_f32_16x16x32_bf16 v[200:203], a[76:79], a[20:23], v[200:203]
buffer_load_dwordx4 v15, s[56:59], s64 offen lds
v_mfma_f32_16x16x32_bf16 v[208:211], a[76:79], a[28:31], v[208:211]
v_mfma_f32_16x16x32_bf16 v[208:211], a[72:75], a[24:27], v[208:211]
ds_read_b64_tr_b16 a[72:73], v19 offset:0
v_mfma_f32_16x16x32_bf16 v[248:251], a[80:83], a[64:67], v[248:251]
ds_read_b64_tr_b16 a[74:75], v19 offset:256
v_mfma_f32_16x16x32_bf16 v[248:251], a[84:87], a[68:71], v[248:251]
ds_read_b64_tr_b16 a[76:77], v19 offset:2048
v_mfma_f32_16x16x32_bf16 v[212:215], a[92:95], a[28:31], v[212:215]
ds_read_b64_tr_b16 a[78:79], v19 offset:2304
v_mfma_f32_16x16x32_bf16 v[212:215], a[88:91], a[24:27], v[212:215]
s_add_u32 m0, s78, 155648
ds_read_b64_tr_b16 a[80:81], v20 offset:0
v_mfma_f32_16x16x32_bf16 v[204:207], a[88:91], a[16:19], v[204:207]
s_add_u32 s64, s75, 4722688
ds_read_b64_tr_b16 a[82:83], v20 offset:256
v_mfma_f32_16x16x32_bf16 v[204:207], a[92:95], a[20:23], v[204:207]
buffer_load_dwordx4 v23, s[60:63], s64 offen lds
v_mfma_f32_16x16x32_bf16 v[196:199], a[92:95], a[12:15], v[196:199]
ds_read_b64_tr_b16 a[84:85], v20 offset:2048
v_mfma_f32_16x16x32_bf16 v[196:199], a[88:91], a[8:11], v[196:199]
ds_read_b64_tr_b16 a[86:87], v20 offset:2304
v_mfma_f32_16x16x32_bf16 v[188:191], a[88:91], a[0:3], v[188:191]
v_mfma_f32_16x16x32_bf16 v[188:191], a[92:95], a[4:7], v[188:191]
s_waitcnt lgkmcnt(7)
ds_read_b64_tr_b16 a[88:89], v4 offset:0
v_mfma_f32_16x16x32_bf16 v[216:219], a[4:7], a[100:103], v[216:219]
ds_read_b64_tr_b16 a[90:91], v4 offset:1024
v_mfma_f32_16x16x32_bf16 v[216:219], a[0:3], a[96:99], v[216:219]
s_add_u32 m0, s77, 134144
ds_read_b64_tr_b16 a[92:93], v4 offset:8192
v_mfma_f32_16x16x32_bf16 v[224:227], a[8:11], a[96:99], v[224:227]
s_add_u32 s64, s71, 6389760
ds_read_b64_tr_b16 a[94:95], v4 offset:9216
v_mfma_f32_16x16x32_bf16 v[224:227], a[12:15], a[100:103], v[224:227]
buffer_load_dwordx4 v15, s[56:59], s64 offen lds
v_mfma_f32_16x16x32_bf16 v[232:235], a[20:23], a[100:103], v[232:235]
v_mfma_f32_16x16x32_bf16 v[232:235], a[16:19], a[96:99], v[232:235]
v_mfma_f32_16x16x32_bf16 v[240:243], a[24:27], a[96:99], v[240:243]
v_mfma_f32_16x16x32_bf16 v[240:243], a[28:31], a[100:103], v[240:243]
ds_read_b64_tr_b16 a[96:97], v5 offset:0
v_mfma_f32_16x16x32_bf16 v[252:255], a[68:71], a[108:111], v[252:255]
ds_read_b64_tr_b16 a[98:99], v5 offset:1024
v_mfma_f32_16x16x32_bf16 v[252:255], a[64:67], a[104:107], v[252:255]
s_add_u32 m0, s78, 159744
ds_read_b64_tr_b16 a[100:101], v5 offset:8192
v_mfma_f32_16x16x32_bf16 v[244:247], a[24:27], a[112:115], v[244:247]
s_add_u32 s64, s74, 1536
ds_read_b64_tr_b16 a[102:103], v5 offset:9216
v_mfma_f32_16x16x32_bf16 v[244:247], a[28:31], a[116:119], v[244:247]
buffer_load_dwordx4 v22, s[48:51], s64 offen lds
v_mfma_f32_16x16x32_bf16 v[236:239], a[20:23], a[116:119], v[236:239]
ds_read_b64_tr_b16 a[104:105], v6 offset:0
v_mfma_f32_16x16x32_bf16 v[236:239], a[16:19], a[112:115], v[236:239]
ds_read_b64_tr_b16 a[106:107], v6 offset:1024
v_mfma_f32_16x16x32_bf16 v[228:231], a[8:11], a[112:115], v[228:231]
ds_read_b64_tr_b16 a[108:109], v6 offset:8192
v_mfma_f32_16x16x32_bf16 v[228:231], a[12:15], a[116:119], v[228:231]
ds_read_b64_tr_b16 a[110:111], v6 offset:9216
v_mfma_f32_16x16x32_bf16 v[220:223], a[4:7], a[116:119], v[220:223]
v_mfma_f32_16x16x32_bf16 v[220:223], a[0:3], a[112:115], v[220:223]
s_waitcnt lgkmcnt(7)
ds_read_b64_tr_b16 a[112:113], v7 offset:0
v_mfma_f32_16x16x32_bf16 v[152:155], a[72:75], a[0:3], v[152:155]
ds_read_b64_tr_b16 a[114:115], v7 offset:1024
v_mfma_f32_16x16x32_bf16 v[152:155], a[76:79], a[4:7], v[152:155]
ds_read_b64_tr_b16 a[116:117], v7 offset:8192
v_mfma_f32_16x16x32_bf16 v[160:163], a[76:79], a[12:15], v[160:163]
s_add_u32 m0, s76, 0
ds_read_b64_tr_b16 a[118:119], v7 offset:9216
v_mfma_f32_16x16x32_bf16 v[160:163], a[72:75], a[8:11], v[160:163]
s_add_u32 s64, s72, 1536
v_mfma_f32_16x16x32_bf16 v[168:171], a[72:75], a[16:19], v[168:171]
buffer_load_dwordx4 v12, s[48:51], s64 offen lds
v_mfma_f32_16x16x32_bf16 v[168:171], a[76:79], a[20:23], v[168:171]
v_mfma_f32_16x16x32_bf16 v[176:179], a[76:79], a[28:31], v[176:179]
v_mfma_f32_16x16x32_bf16 v[176:179], a[72:75], a[24:27], v[176:179]
s_add_u32 m0, s76, 1024
ds_read_b64_tr_b16 a[72:73], v8 offset:0
v_mfma_f32_16x16x32_bf16 v[180:183], a[80:83], a[24:27], v[180:183]
s_add_u32 s64, s72, 17920
ds_read_b64_tr_b16 a[74:75], v8 offset:1024
v_mfma_f32_16x16x32_bf16 v[180:183], a[84:87], a[28:31], v[180:183]
buffer_load_dwordx4 v13, s[48:51], s64 offen lds
v_mfma_f32_16x16x32_bf16 v[172:175], a[84:87], a[20:23], v[172:175]
ds_read_b64_tr_b16 a[76:77], v8 offset:8192
v_mfma_f32_16x16x32_bf16 v[172:175], a[80:83], a[16:19], v[172:175]
ds_read_b64_tr_b16 a[78:79], v8 offset:9216
v_mfma_f32_16x16x32_bf16 v[164:167], a[80:83], a[8:11], v[164:167]
v_mfma_f32_16x16x32_bf16 v[164:167], a[84:87], a[12:15], v[164:167]
s_add_u32 m0, s76, 2048
v_mfma_f32_16x16x32_bf16 v[156:159], a[84:87], a[4:7], v[156:159]
s_add_u32 s64, s72, 132608
v_mfma_f32_16x16x32_bf16 v[156:159], a[80:83], a[0:3], v[156:159]
buffer_load_dwordx4 v12, s[48:51], s64 offen lds
v_mfma_f32_16x16x32_bf16 v[24:27], a[88:91], a[0:3], v[24:27]
ds_read_b64_tr_b16 a[80:81], v9 offset:0
v_mfma_f32_16x16x32_bf16 v[24:27], a[92:95], a[4:7], v[24:27]
s_add_u32 m0, s76, 3072
ds_read_b64_tr_b16 a[82:83], v9 offset:1024
v_mfma_f32_16x16x32_bf16 v[40:43], a[92:95], a[12:15], v[40:43]
s_waitcnt vmcnt(13)
ds_read_b64_tr_b16 a[84:85], v9 offset:8192
v_mfma_f32_16x16x32_bf16 v[40:43], a[88:91], a[8:11], v[40:43]
s_add_u32 s64, s72, 148992
ds_read_b64_tr_b16 a[86:87], v9 offset:9216
v_mfma_f32_16x16x32_bf16 v[56:59], a[88:91], a[16:19], v[56:59]
buffer_load_dwordx4 v13, s[48:51], s64 offen lds
v_mfma_f32_16x16x32_bf16 v[56:59], a[92:95], a[20:23], v[56:59]
ds_read_b128 a[32:35], v2 offset:32768
v_mfma_f32_16x16x32_bf16 v[72:75], a[92:95], a[28:31], v[72:75]
ds_read_b128 a[36:39], v3 offset:32768
v_mfma_f32_16x16x32_bf16 v[72:75], a[88:91], a[24:27], v[72:75]
s_waitcnt lgkmcnt(6)
ds_read_b128 a[40:43], v2 offset:34816
v_mfma_f32_16x16x32_bf16 v[136:139], a[96:99], a[24:27], v[136:139]
s_add_u32 m0, s76, 4096
ds_read_b128 a[44:47], v3 offset:34816
v_mfma_f32_16x16x32_bf16 v[136:139], a[100:103], a[28:31], v[136:139]
s_add_u32 s64, s73, 1536
ds_read_b128 a[48:51], v2 offset:36864
v_mfma_f32_16x16x32_bf16 v[120:123], a[100:103], a[20:23], v[120:123]
buffer_load_dwordx4 v12, s[48:51], s64 offen lds
v_mfma_f32_16x16x32_bf16 v[120:123], a[96:99], a[16:19], v[120:123]
ds_read_b128 a[52:55], v3 offset:36864
v_mfma_f32_16x16x32_bf16 v[104:107], a[96:99], a[8:11], v[104:107]
ds_read_b128 a[56:59], v2 offset:38912
v_mfma_f32_16x16x32_bf16 v[104:107], a[100:103], a[12:15], v[104:107]
s_add_u32 m0, s76, 5120
ds_read_b128 a[60:63], v3 offset:38912
v_mfma_f32_16x16x32_bf16 v[88:91], a[100:103], a[4:7], v[88:91]
s_add_u32 s64, s73, 17920
ds_read_b64_tr_b16 a[88:89], v10 offset:0
v_mfma_f32_16x16x32_bf16 v[88:91], a[96:99], a[0:3], v[88:91]
buffer_load_dwordx4 v13, s[48:51], s64 offen lds
v_mfma_f32_16x16x32_bf16 v[28:31], a[104:107], a[0:3], v[28:31]
ds_read_b64_tr_b16 a[90:91], v10 offset:1024
v_mfma_f32_16x16x32_bf16 v[28:31], a[108:111], a[4:7], v[28:31]
ds_read_b64_tr_b16 a[92:93], v10 offset:8192
v_mfma_f32_16x16x32_bf16 v[44:47], a[108:111], a[12:15], v[44:47]
ds_read_b64_tr_b16 a[94:95], v10 offset:9216
v_mfma_f32_16x16x32_bf16 v[44:47], a[104:107], a[8:11], v[44:47]
s_add_u32 m0, s76, 6144
ds_read_b64_tr_b16 a[96:97], v11 offset:0
v_mfma_f32_16x16x32_bf16 v[60:63], a[104:107], a[16:19], v[60:63]
s_add_u32 s64, s73, 132608
ds_read_b64_tr_b16 a[98:99], v11 offset:1024
v_mfma_f32_16x16x32_bf16 v[60:63], a[108:111], a[20:23], v[60:63]
buffer_load_dwordx4 v12, s[48:51], s64 offen lds
v_mfma_f32_16x16x32_bf16 v[76:79], a[108:111], a[28:31], v[76:79]
ds_read_b64_tr_b16 a[100:101], v11 offset:8192
v_mfma_f32_16x16x32_bf16 v[76:79], a[104:107], a[24:27], v[76:79]
ds_read_b64_tr_b16 a[102:103], v11 offset:9216
v_mfma_f32_16x16x32_bf16 v[140:143], a[112:115], a[24:27], v[140:143]
s_add_u32 m0, s76, 7168
v_mfma_f32_16x16x32_bf16 v[140:143], a[116:119], a[28:31], v[140:143]
s_add_u32 s64, s73, 148992
v_mfma_f32_16x16x32_bf16 v[124:127], a[116:119], a[20:23], v[124:127]
buffer_load_dwordx4 v13, s[48:51], s64 offen lds
v_mfma_f32_16x16x32_bf16 v[124:127], a[112:115], a[16:19], v[124:127]
v_mfma_f32_16x16x32_bf16 v[108:111], a[112:115], a[8:11], v[108:111]
v_mfma_f32_16x16x32_bf16 v[108:111], a[116:119], a[12:15], v[108:111]
v_mfma_f32_16x16x32_bf16 v[92:95], a[116:119], a[4:7], v[92:95]
v_mfma_f32_16x16x32_bf16 v[92:95], a[112:115], a[0:3], v[92:95]
v_mfma_f32_16x16x32_bf16 v[32:35], a[72:75], a[0:3], v[32:35]
v_mfma_f32_16x16x32_bf16 v[32:35], a[76:79], a[4:7], v[32:35]
v_mfma_f32_16x16x32_bf16 v[48:51], a[76:79], a[12:15], v[48:51]
s_waitcnt lgkmcnt(0)
s_barrier
v_mfma_f32_16x16x32_bf16 v[48:51], a[72:75], a[8:11], v[48:51]
s_add_u32 m0, s77, 65536
ds_read_b64_tr_b16 a[104:105], v19 offset:36864
v_mfma_f32_16x16x32_bf16 v[64:67], a[72:75], a[16:19], v[64:67]
s_add_u32 s64, s71, 6815744
ds_read_b64_tr_b16 a[106:107], v19 offset:37120
v_mfma_f32_16x16x32_bf16 v[64:67], a[76:79], a[20:23], v[64:67]
buffer_load_dwordx4 v14, s[56:59], s64 offen lds
v_mfma_f32_16x16x32_bf16 v[80:83], a[76:79], a[28:31], v[80:83]
ds_read_b64_tr_b16 a[108:109], v19 offset:38912
v_mfma_f32_16x16x32_bf16 v[80:83], a[72:75], a[24:27], v[80:83]
ds_read_b64_tr_b16 a[110:111], v19 offset:39168
v_mfma_f32_16x16x32_bf16 v[144:147], a[80:83], a[24:27], v[144:147]
ds_read_b128 a[64:67], v17 offset:32768
v_mfma_f32_16x16x32_bf16 v[144:147], a[84:87], a[28:31], v[144:147]
ds_read_b128 a[68:71], v18 offset:32768
v_mfma_f32_16x16x32_bf16 v[128:131], a[84:87], a[20:23], v[128:131]
ds_read_b64_tr_b16 a[112:113], v21 offset:36864
v_mfma_f32_16x16x32_bf16 v[128:131], a[80:83], a[16:19], v[128:131]
s_add_u32 m0, s78, 81920
ds_read_b64_tr_b16 a[114:115], v21 offset:37120
v_mfma_f32_16x16x32_bf16 v[112:115], a[80:83], a[8:11], v[112:115]
s_add_u32 s64, s75, 5111808
ds_read_b64_tr_b16 a[116:117], v21 offset:38912
v_mfma_f32_16x16x32_bf16 v[112:115], a[84:87], a[12:15], v[112:115]
buffer_load_dwordx4 v23, s[60:63], s64 offen lds
v_mfma_f32_16x16x32_bf16 v[96:99], a[84:87], a[4:7], v[96:99]
ds_read_b64_tr_b16 a[118:119], v21 offset:39168
v_mfma_f32_16x16x32_bf16 v[96:99], a[80:83], a[0:3], v[96:99]
ds_read_b64_tr_b16 a[72:73], v20 offset:36864
v_mfma_f32_16x16x32_bf16 v[36:39], a[88:91], a[0:3], v[36:39]
ds_read_b64_tr_b16 a[74:75], v20 offset:37120
v_mfma_f32_16x16x32_bf16 v[36:39], a[92:95], a[4:7], v[36:39]
ds_read_b64_tr_b16 a[76:77], v20 offset:38912
v_mfma_f32_16x16x32_bf16 v[52:55], a[92:95], a[12:15], v[52:55]
ds_read_b64_tr_b16 a[78:79], v20 offset:39168
v_mfma_f32_16x16x32_bf16 v[52:55], a[88:91], a[8:11], v[52:55]
s_add_u32 m0, s77, 66560
ds_read_b64_tr_b16 a[80:81], v19 offset:40960
v_mfma_f32_16x16x32_bf16 v[68:71], a[88:91], a[16:19], v[68:71]
s_add_u32 s64, s71, 6848512
ds_read_b64_tr_b16 a[82:83], v19 offset:41216
v_mfma_f32_16x16x32_bf16 v[68:71], a[92:95], a[20:23], v[68:71]
buffer_load_dwordx4 v14, s[56:59], s64 offen lds
v_mfma_f32_16x16x32_bf16 v[84:87], a[92:95], a[28:31], v[84:87]
ds_read_b64_tr_b16 a[84:85], v19 offset:43008
v_mfma_f32_16x16x32_bf16 v[84:87], a[88:91], a[24:27], v[84:87]
ds_read_b64_tr_b16 a[86:87], v19 offset:43264
v_mfma_f32_16x16x32_bf16 v[148:151], a[96:99], a[24:27], v[148:151]
ds_read_b64_tr_b16 a[88:89], v21 offset:40960
v_mfma_f32_16x16x32_bf16 v[148:151], a[100:103], a[28:31], v[148:151]
ds_read_b64_tr_b16 a[90:91], v21 offset:41216
v_mfma_f32_16x16x32_bf16 v[132:135], a[100:103], a[20:23], v[132:135]
ds_read_b64_tr_b16 a[92:93], v21 offset:43008
v_mfma_f32_16x16x32_bf16 v[132:135], a[96:99], a[16:19], v[132:135]
s_add_u32 m0, s78, 86016
ds_read_b64_tr_b16 a[94:95], v21 offset:43264
v_mfma_f32_16x16x32_bf16 v[116:119], a[96:99], a[8:11], v[116:119]
s_add_u32 s64, s75, 5113856
v_mfma_f32_16x16x32_bf16 v[116:119], a[100:103], a[12:15], v[116:119]
buffer_load_dwordx4 v23, s[60:63], s64 offen lds
v_mfma_f32_16x16x32_bf16 v[100:103], a[100:103], a[4:7], v[100:103]
v_mfma_f32_16x16x32_bf16 v[100:103], a[96:99], a[0:3], v[100:103]
s_waitcnt lgkmcnt(6)
ds_read_b64_tr_b16 a[96:97], v20 offset:40960
v_mfma_f32_16x16x32_bf16 v[184:187], a[104:107], a[32:35], v[184:187]
s_add_u32 s17, s78, .-L_pc+6144
ds_read_b64_tr_b16 a[98:99], v20 offset:41216
v_mfma_f32_16x16x32_bf16 v[184:187], a[108:111], a[36:39], v[184:187]
ds_read_b64_tr_b16 a[100:101], v20 offset:43008
v_add_u32 v17, 0x8000, v17
v_mfma_f32_16x16x32_bf16 v[192:195], a[108:111], a[44:47], v[192:195]
ds_read_b64_tr_b16 a[102:103], v20 offset:43264
v_add_u32 v18, 0x8000, v18
v_mfma_f32_16x16x32_bf16 v[192:195], a[104:107], a[40:43], v[192:195]
s_add_u32 m0, s77, 67584
v_mfma_f32_16x16x32_bf16 v[200:203], a[104:107], a[48:51], v[200:203]
s_add_u32 s64, s71, 6881280
buffer_load_dword a252, v16, s[88:91], s17 offen
v_mfma_f32_16x16x32_bf16 v[200:203], a[108:111], a[52:55], v[200:203]
buffer_load_dwordx4 v15, s[56:59], s64 offen lds
v_mfma_f32_16x16x32_bf16 v[208:211], a[108:111], a[60:63], v[208:211]
v_mfma_f32_16x16x32_bf16 v[208:211], a[104:107], a[56:59], v[208:211]
ds_read_b64_tr_b16 a[104:105], v19 offset:32768
v_mfma_f32_16x16x32_bf16 v[248:251], a[112:115], a[64:67], v[248:251]
ds_read_b64_tr_b16 a[106:107], v19 offset:33024
v_mfma_f32_16x16x32_bf16 v[248:251], a[116:119], a[68:71], v[248:251]
ds_read_b64_tr_b16 a[108:109], v19 offset:34816
v_mfma_f32_16x16x32_bf16 v[212:215], a[76:79], a[60:63], v[212:215]
ds_read_b64_tr_b16 a[110:111], v19 offset:35072
v_mfma_f32_16x16x32_bf16 v[212:215], a[72:75], a[56:59], v[212:215]
s_add_u32 m0, s78, 90112
ds_read_b64_tr_b16 a[112:113], v20 offset:32768
v_mfma_f32_16x16x32_bf16 v[204:207], a[72:75], a[48:51], v[204:207]
s_add_u32 s64, s75, 5115904
ds_read_b64_tr_b16 a[114:115], v20 offset:33024
v_mfma_f32_16x16x32_bf16 v[204:207], a[76:79], a[52:55], v[204:207]
buffer_load_dwordx4 v23, s[60:63], s64 offen lds
v_mfma_f32_16x16x32_bf16 v[196:199], a[76:79], a[44:47], v[196:199]
ds_read_b64_tr_b16 a[116:117], v20 offset:34816
v_mfma_f32_16x16x32_bf16 v[196:199], a[72:75], a[40:43], v[196:199]
ds_read_b64_tr_b16 a[118:119], v20 offset:35072
v_mfma_f32_16x16x32_bf16 v[188:191], a[72:75], a[32:35], v[188:191]
v_mfma_f32_16x16x32_bf16 v[188:191], a[76:79], a[36:39], v[188:191]
s_waitcnt lgkmcnt(7)
ds_read_b64_tr_b16 a[72:73], v4 offset:32768
v_mfma_f32_16x16x32_bf16 v[216:219], a[36:39], a[84:87], v[216:219]
s_add_u32 m0, s77, 68608
ds_read_b64_tr_b16 a[74:75], v4 offset:33792
v_mfma_f32_16x16x32_bf16 v[216:219], a[32:35], a[80:83], v[216:219]
ds_read_b64_tr_b16 a[76:77], v4 offset:40960
v_add_u32 v21, 0x8000, v21
v_mfma_f32_16x16x32_bf16 v[224:227], a[40:43], a[80:83], v[224:227]
s_add_u32 s64, s71, 6914048
ds_read_b64_tr_b16 a[78:79], v4 offset:41984
v_mfma_f32_16x16x32_bf16 v[224:227], a[44:47], a[84:87], v[224:227]
buffer_load_dwordx4 v15, s[56:59], s64 offen lds
v_mfma_f32_16x16x32_bf16 v[232:235], a[52:55], a[84:87], v[232:235]
v_mfma_f32_16x16x32_bf16 v[232:235], a[48:51], a[80:83], v[232:235]
v_mfma_f32_16x16x32_bf16 v[240:243], a[56:59], a[80:83], v[240:243]
v_mfma_f32_16x16x32_bf16 v[240:243], a[60:63], a[84:87], v[240:243]
ds_read_b64_tr_b16 a[80:81], v5 offset:32768
v_mfma_f32_16x16x32_bf16 v[252:255], a[68:71], a[92:95], v[252:255]
ds_read_b64_tr_b16 a[82:83], v5 offset:33792
v_mfma_f32_16x16x32_bf16 v[252:255], a[64:67], a[88:91], v[252:255]
s_add_u32 m0, s78, 94208
ds_read_b64_tr_b16 a[84:85], v5 offset:40960
v_mfma_f32_16x16x32_bf16 v[244:247], a[56:59], a[96:99], v[244:247]
s_add_u32 s64, s74, 1664
ds_read_b64_tr_b16 a[86:87], v5 offset:41984
v_mfma_f32_16x16x32_bf16 v[244:247], a[60:63], a[100:103], v[244:247]
buffer_load_dwordx4 v22, s[48:51], s64 offen lds
v_mfma_f32_16x16x32_bf16 v[236:239], a[52:55], a[100:103], v[236:239]
ds_read_b64_tr_b16 a[88:89], v6 offset:32768
v_add_u32 v19, 0x8000, v19
v_mfma_f32_16x16x32_bf16 v[236:239], a[48:51], a[96:99], v[236:239]
ds_read_b64_tr_b16 a[90:91], v6 offset:33792
v_mfma_f32_16x16x32_bf16 v[228:231], a[40:43], a[96:99], v[228:231]
ds_read_b64_tr_b16 a[92:93], v6 offset:40960
v_mfma_f32_16x16x32_bf16 v[228:231], a[44:47], a[100:103], v[228:231]
ds_read_b64_tr_b16 a[94:95], v6 offset:41984
v_mfma_f32_16x16x32_bf16 v[220:223], a[36:39], a[100:103], v[220:223]
v_mfma_f32_16x16x32_bf16 v[220:223], a[32:35], a[96:99], v[220:223]
s_waitcnt lgkmcnt(7)
ds_read_b64_tr_b16 a[96:97], v7 offset:32768
v_mfma_f32_16x16x32_bf16 v[152:155], a[104:107], a[32:35], v[152:155]
ds_read_b64_tr_b16 a[98:99], v7 offset:33792
v_mfma_f32_16x16x32_bf16 v[152:155], a[108:111], a[36:39], v[152:155]
ds_read_b64_tr_b16 a[100:101], v7 offset:40960
v_add_u32 v20, 0x8000, v20
v_mfma_f32_16x16x32_bf16 v[160:163], a[108:111], a[44:47], v[160:163]
s_add_u32 m0, s76, 32768
ds_read_b64_tr_b16 a[102:103], v7 offset:41984
v_mfma_f32_16x16x32_bf16 v[160:163], a[104:107], a[40:43], v[160:163]
s_add_u32 s64, s72, 1664
v_mfma_f32_16x16x32_bf16 v[168:171], a[104:107], a[48:51], v[168:171]
buffer_load_dwordx4 v12, s[48:51], s64 offen lds
v_mfma_f32_16x16x32_bf16 v[168:171], a[108:111], a[52:55], v[168:171]
v_mfma_f32_16x16x32_bf16 v[176:179], a[108:111], a[60:63], v[176:179]
v_mfma_f32_16x16x32_bf16 v[176:179], a[104:107], a[56:59], v[176:179]
s_add_u32 m0, s76, 33792
ds_read_b64_tr_b16 a[104:105], v8 offset:32768
v_mfma_f32_16x16x32_bf16 v[180:183], a[112:115], a[56:59], v[180:183]
s_add_u32 s64, s72, 18048
ds_read_b64_tr_b16 a[106:107], v8 offset:33792
v_mfma_f32_16x16x32_bf16 v[180:183], a[116:119], a[60:63], v[180:183]
buffer_load_dwordx4 v13, s[48:51], s64 offen lds
v_mfma_f32_16x16x32_bf16 v[172:175], a[116:119], a[52:55], v[172:175]
ds_read_b64_tr_b16 a[108:109], v8 offset:40960
v_add_u32 v4, 0x8000, v4
v_mfma_f32_16x16x32_bf16 v[172:175], a[112:115], a[48:51], v[172:175]
ds_read_b64_tr_b16 a[110:111], v8 offset:41984
v_mfma_f32_16x16x32_bf16 v[164:167], a[112:115], a[40:43], v[164:167]
v_mfma_f32_16x16x32_bf16 v[164:167], a[116:119], a[44:47], v[164:167]
s_add_u32 m0, s76, 34816
v_mfma_f32_16x16x32_bf16 v[156:159], a[116:119], a[36:39], v[156:159]
s_add_u32 s64, s72, 132736
v_mfma_f32_16x16x32_bf16 v[156:159], a[112:115], a[32:35], v[156:159]
buffer_load_dwordx4 v12, s[48:51], s64 offen lds
v_mfma_f32_16x16x32_bf16 v[24:27], a[72:75], a[32:35], v[24:27]
s_add_u32 m0, s76, 35840
ds_read_b64_tr_b16 a[112:113], v9 offset:32768
v_mfma_f32_16x16x32_bf16 v[24:27], a[76:79], a[36:39], v[24:27]
ds_read_b64_tr_b16 a[114:115], v9 offset:33792
v_add_u32 v5, 0x8000, v5
v_mfma_f32_16x16x32_bf16 v[40:43], a[76:79], a[44:47], v[40:43]
s_waitcnt vmcnt(12)
ds_read_b64_tr_b16 a[116:117], v9 offset:40960
v_mfma_f32_16x16x32_bf16 v[40:43], a[72:75], a[40:43], v[40:43]
s_add_u32 s64, s72, 149120
ds_read_b64_tr_b16 a[118:119], v9 offset:41984
v_mfma_f32_16x16x32_bf16 v[56:59], a[72:75], a[48:51], v[56:59]
buffer_load_dwordx4 v13, s[48:51], s64 offen lds
v_mfma_f32_16x16x32_bf16 v[56:59], a[76:79], a[52:55], v[56:59]
ds_read_b128 a[0:3], v2 offset:0
v_mfma_f32_16x16x32_bf16 v[72:75], a[76:79], a[60:63], v[72:75]
ds_read_b128 a[4:7], v3 offset:0
v_mfma_f32_16x16x32_bf16 v[72:75], a[72:75], a[56:59], v[72:75]
s_waitcnt lgkmcnt(6)
s_add_u32 m0, s76, 36864
ds_read_b128 a[8:11], v2 offset:2048
v_mfma_f32_16x16x32_bf16 v[136:139], a[80:83], a[56:59], v[136:139]
s_add_u32 s64, s73, 1664
ds_read_b128 a[12:15], v3 offset:2048
v_mfma_f32_16x16x32_bf16 v[136:139], a[84:87], a[60:63], v[136:139]
ds_read_b128 a[16:19], v2 offset:4096
v_add_u32 v6, 0x8000, v6
v_mfma_f32_16x16x32_bf16 v[120:123], a[84:87], a[52:55], v[120:123]
buffer_load_dwordx4 v12, s[48:51], s64 offen lds
v_mfma_f32_16x16x32_bf16 v[120:123], a[80:83], a[48:51], v[120:123]
ds_read_b128 a[20:23], v3 offset:4096
v_mfma_f32_16x16x32_bf16 v[104:107], a[80:83], a[40:43], v[104:107]
ds_read_b128 a[24:27], v2 offset:6144
v_mfma_f32_16x16x32_bf16 v[104:107], a[84:87], a[44:47], v[104:107]
s_add_u32 m0, s76, 37888
ds_read_b128 a[28:31], v3 offset:6144
v_mfma_f32_16x16x32_bf16 v[88:91], a[84:87], a[36:39], v[88:91]
s_add_u32 s64, s73, 18048
ds_read_b64_tr_b16 a[72:73], v10 offset:32768
v_mfma_f32_16x16x32_bf16 v[88:91], a[80:83], a[32:35], v[88:91]
buffer_load_dwordx4 v13, s[48:51], s64 offen lds
v_mfma_f32_16x16x32_bf16 v[28:31], a[88:91], a[32:35], v[28:31]
ds_read_b64_tr_b16 a[74:75], v10 offset:33792
v_mfma_f32_16x16x32_bf16 v[28:31], a[92:95], a[36:39], v[28:31]
ds_read_b64_tr_b16 a[76:77], v10 offset:40960
v_add_u32 v7, 0x8000, v7
v_mfma_f32_16x16x32_bf16 v[44:47], a[92:95], a[44:47], v[44:47]
ds_read_b64_tr_b16 a[78:79], v10 offset:41984
v_mfma_f32_16x16x32_bf16 v[44:47], a[88:91], a[40:43], v[44:47]
s_add_u32 m0, s76, 38912
ds_read_b64_tr_b16 a[80:81], v11 offset:32768
v_mfma_f32_16x16x32_bf16 v[60:63], a[88:91], a[48:51], v[60:63]
s_add_u32 s64, s73, 132736
ds_read_b64_tr_b16 a[82:83], v11 offset:33792
v_mfma_f32_16x16x32_bf16 v[60:63], a[92:95], a[52:55], v[60:63]
buffer_load_dwordx4 v12, s[48:51], s64 offen lds
v_mfma_f32_16x16x32_bf16 v[76:79], a[92:95], a[60:63], v[76:79]
ds_read_b64_tr_b16 a[84:85], v11 offset:40960
v_mfma_f32_16x16x32_bf16 v[76:79], a[88:91], a[56:59], v[76:79]
ds_read_b64_tr_b16 a[86:87], v11 offset:41984
v_mfma_f32_16x16x32_bf16 v[140:143], a[96:99], a[56:59], v[140:143]
s_add_u32 m0, s76, 39936
v_mfma_f32_16x16x32_bf16 v[140:143], a[100:103], a[60:63], v[140:143]
s_add_u32 s64, s73, 149120
v_add_u32 v8, 0x8000, v8
v_mfma_f32_16x16x32_bf16 v[124:127], a[100:103], a[52:55], v[124:127]
buffer_load_dwordx4 v13, s[48:51], s64 offen lds
v_mfma_f32_16x16x32_bf16 v[124:127], a[96:99], a[48:51], v[124:127]
v_mfma_f32_16x16x32_bf16 v[108:111], a[96:99], a[40:43], v[108:111]
v_mfma_f32_16x16x32_bf16 v[108:111], a[100:103], a[44:47], v[108:111]
v_mfma_f32_16x16x32_bf16 v[92:95], a[100:103], a[36:39], v[92:95]
v_add_u32 v9, 0x8000, v9
v_add_u32 v10, 0x8000, v10
v_mfma_f32_16x16x32_bf16 v[92:95], a[96:99], a[32:35], v[92:95]
v_add_u32 v11, 0x8000, v11
v_mfma_f32_16x16x32_bf16 v[32:35], a[104:107], a[32:35], v[32:35]
v_mfma_f32_16x16x32_bf16 v[32:35], a[108:111], a[36:39], v[32:35]
v_mfma_f32_16x16x32_bf16 v[48:51], a[108:111], a[44:47], v[48:51]
s_waitcnt lgkmcnt(0)
s_barrier
v_mfma_f32_16x16x32_bf16 v[48:51], a[104:107], a[40:43], v[48:51]
s_add_u32 m0, s77, 98304
ds_read_b64_tr_b16 a[88:89], v19 offset:36864
v_mfma_f32_16x16x32_bf16 v[64:67], a[104:107], a[48:51], v[64:67]
s_add_u32 s64, s71, 7340032
ds_read_b64_tr_b16 a[90:91], v19 offset:37120
v_mfma_f32_16x16x32_bf16 v[64:67], a[108:111], a[52:55], v[64:67]
buffer_load_dwordx4 v14, s[56:59], s64 offen lds
v_mfma_f32_16x16x32_bf16 v[80:83], a[108:111], a[60:63], v[80:83]
ds_read_b64_tr_b16 a[92:93], v19 offset:38912
v_mfma_f32_16x16x32_bf16 v[80:83], a[104:107], a[56:59], v[80:83]
ds_read_b64_tr_b16 a[94:95], v19 offset:39168
v_mfma_f32_16x16x32_bf16 v[144:147], a[112:115], a[56:59], v[144:147]
ds_read_b128 a[64:67], v17 offset:32768
v_mfma_f32_16x16x32_bf16 v[144:147], a[116:119], a[60:63], v[144:147]
ds_read_b128 a[68:71], v18 offset:32768
v_mfma_f32_16x16x32_bf16 v[128:131], a[116:119], a[52:55], v[128:131]
ds_read_b64_tr_b16 a[96:97], v21 offset:36864
v_mfma_f32_16x16x32_bf16 v[128:131], a[112:115], a[48:51], v[128:131]
s_add_u32 m0, s78, 114688
ds_read_b64_tr_b16 a[98:99], v21 offset:37120
v_mfma_f32_16x16x32_bf16 v[112:115], a[112:115], a[40:43], v[112:115]
s_add_u32 s64, s75, 5505024
ds_read_b64_tr_b16 a[100:101], v21 offset:38912
v_mfma_f32_16x16x32_bf16 v[112:115], a[116:119], a[44:47], v[112:115]
buffer_load_dwordx4 v23, s[60:63], s64 offen lds
v_mfma_f32_16x16x32_bf16 v[96:99], a[116:119], a[36:39], v[96:99]
ds_read_b64_tr_b16 a[102:103], v21 offset:39168
v_mfma_f32_16x16x32_bf16 v[96:99], a[112:115], a[32:35], v[96:99]
ds_read_b64_tr_b16 a[104:105], v20 offset:36864
v_mfma_f32_16x16x32_bf16 v[36:39], a[72:75], a[32:35], v[36:39]
ds_read_b64_tr_b16 a[106:107], v20 offset:37120
v_mfma_f32_16x16x32_bf16 v[36:39], a[76:79], a[36:39], v[36:39]
ds_read_b64_tr_b16 a[108:109], v20 offset:38912
v_mfma_f32_16x16x32_bf16 v[52:55], a[76:79], a[44:47], v[52:55]
ds_read_b64_tr_b16 a[110:111], v20 offset:39168
v_mfma_f32_16x16x32_bf16 v[52:55], a[72:75], a[40:43], v[52:55]
s_add_u32 m0, s77, 99328
ds_read_b64_tr_b16 a[112:113], v19 offset:40960
v_mfma_f32_16x16x32_bf16 v[68:71], a[72:75], a[48:51], v[68:71]
s_add_u32 s64, s71, 7372800
ds_read_b64_tr_b16 a[114:115], v19 offset:41216
v_mfma_f32_16x16x32_bf16 v[68:71], a[76:79], a[52:55], v[68:71]
buffer_load_dwordx4 v14, s[56:59], s64 offen lds
v_mfma_f32_16x16x32_bf16 v[84:87], a[76:79], a[60:63], v[84:87]
ds_read_b64_tr_b16 a[116:117], v19 offset:43008
v_mfma_f32_16x16x32_bf16 v[84:87], a[72:75], a[56:59], v[84:87]
ds_read_b64_tr_b16 a[118:119], v19 offset:43264
v_mfma_f32_16x16x32_bf16 v[148:151], a[80:83], a[56:59], v[148:151]
ds_read_b64_tr_b16 a[72:73], v21 offset:40960
v_mfma_f32_16x16x32_bf16 v[148:151], a[84:87], a[60:63], v[148:151]
ds_read_b64_tr_b16 a[74:75], v21 offset:41216
v_mfma_f32_16x16x32_bf16 v[132:135], a[84:87], a[52:55], v[132:135]
ds_read_b64_tr_b16 a[76:77], v21 offset:43008
v_mfma_f32_16x16x32_bf16 v[132:135], a[80:83], a[48:51], v[132:135]
s_add_u32 m0, s78, 118784
ds_read_b64_tr_b16 a[78:79], v21 offset:43264
v_mfma_f32_16x16x32_bf16 v[116:119], a[80:83], a[40:43], v[116:119]
s_add_u32 s64, s75, 5507072
v_mfma_f32_16x16x32_bf16 v[116:119], a[84:87], a[44:47], v[116:119]
buffer_load_dwordx4 v23, s[60:63], s64 offen lds
v_mfma_f32_16x16x32_bf16 v[100:103], a[84:87], a[36:39], v[100:103]
v_mfma_f32_16x16x32_bf16 v[100:103], a[80:83], a[32:35], v[100:103]
s_waitcnt lgkmcnt(6)
ds_read_b64_tr_b16 a[80:81], v20 offset:40960
v_mfma_f32_16x16x32_bf16 v[184:187], a[88:91], a[0:3], v[184:187]
s_add_u32 s17, s78, .-L_pc+6144
ds_read_b64_tr_b16 a[82:83], v20 offset:41216
v_mfma_f32_16x16x32_bf16 v[184:187], a[92:95], a[4:7], v[184:187]
ds_read_b64_tr_b16 a[84:85], v20 offset:43008
v_subrev_u32 v17, 0x8000, v17
v_mfma_f32_16x16x32_bf16 v[192:195], a[92:95], a[12:15], v[192:195]
ds_read_b64_tr_b16 a[86:87], v20 offset:43264
v_subrev_u32 v18, 0x8000, v18
v_mfma_f32_16x16x32_bf16 v[192:195], a[88:91], a[8:11], v[192:195]
s_add_u32 m0, s77, 100352
v_mfma_f32_16x16x32_bf16 v[200:203], a[88:91], a[16:19], v[200:203]
s_add_u32 s64, s71, 7405568
buffer_load_dword a252, v16, s[88:91], s17 offen
v_mfma_f32_16x16x32_bf16 v[200:203], a[92:95], a[20:23], v[200:203]
buffer_load_dwordx4 v15, s[56:59], s64 offen lds
v_mfma_f32_16x16x32_bf16 v[208:211], a[92:95], a[28:31], v[208:211]
v_mfma_f32_16x16x32_bf16 v[208:211], a[88:91], a[24:27], v[208:211]
ds_read_b64_tr_b16 a[88:89], v19 offset:32768
v_mfma_f32_16x16x32_bf16 v[248:251], a[96:99], a[64:67], v[248:251]
ds_read_b64_tr_b16 a[90:91], v19 offset:33024
v_mfma_f32_16x16x32_bf16 v[248:251], a[100:103], a[68:71], v[248:251]
ds_read_b64_tr_b16 a[92:93], v19 offset:34816
v_mfma_f32_16x16x32_bf16 v[212:215], a[108:111], a[28:31], v[212:215]
ds_read_b64_tr_b16 a[94:95], v19 offset:35072
v_mfma_f32_16x16x32_bf16 v[212:215], a[104:107], a[24:27], v[212:215]
s_add_u32 m0, s78, 122880
ds_read_b64_tr_b16 a[96:97], v20 offset:32768
v_mfma_f32_16x16x32_bf16 v[204:207], a[104:107], a[16:19], v[204:207]
s_add_u32 s64, s75, 5509120
ds_read_b64_tr_b16 a[98:99], v20 offset:33024
v_mfma_f32_16x16x32_bf16 v[204:207], a[108:111], a[20:23], v[204:207]
buffer_load_dwordx4 v23, s[60:63], s64 offen lds
v_mfma_f32_16x16x32_bf16 v[196:199], a[108:111], a[12:15], v[196:199]
ds_read_b64_tr_b16 a[100:101], v20 offset:34816
v_mfma_f32_16x16x32_bf16 v[196:199], a[104:107], a[8:11], v[196:199]
ds_read_b64_tr_b16 a[102:103], v20 offset:35072
v_mfma_f32_16x16x32_bf16 v[188:191], a[104:107], a[0:3], v[188:191]
v_mfma_f32_16x16x32_bf16 v[188:191], a[108:111], a[4:7], v[188:191]
s_waitcnt lgkmcnt(7)
ds_read_b64_tr_b16 a[104:105], v4 offset:32768
v_mfma_f32_16x16x32_bf16 v[216:219], a[4:7], a[116:119], v[216:219]
s_add_u32 m0, s77, 101376
ds_read_b64_tr_b16 a[106:107], v4 offset:33792
v_mfma_f32_16x16x32_bf16 v[216:219], a[0:3], a[112:115], v[216:219]
ds_read_b64_tr_b16 a[108:109], v4 offset:40960
v_subrev_u32 v21, 0x8000, v21
v_mfma_f32_16x16x32_bf16 v[224:227], a[8:11], a[112:115], v[224:227]
s_add_u32 s64, s71, 7438336
ds_read_b64_tr_b16 a[110:111], v4 offset:41984
v_mfma_f32_16x16x32_bf16 v[224:227], a[12:15], a[116:119], v[224:227]
buffer_load_dwordx4 v15, s[56:59], s64 offen lds
v_mfma_f32_16x16x32_bf16 v[232:235], a[20:23], a[116:119], v[232:235]
v_mfma_f32_16x16x32_bf16 v[232:235], a[16:19], a[112:115], v[232:235]
v_mfma_f32_16x16x32_bf16 v[240:243], a[24:27], a[112:115], v[240:243]
v_mfma_f32_16x16x32_bf16 v[240:243], a[28:31], a[116:119], v[240:243]
ds_read_b64_tr_b16 a[112:113], v5 offset:32768
v_mfma_f32_16x16x32_bf16 v[252:255], a[68:71], a[76:79], v[252:255]
ds_read_b64_tr_b16 a[114:115], v5 offset:33792
v_mfma_f32_16x16x32_bf16 v[252:255], a[64:67], a[72:75], v[252:255]
s_add_u32 m0, s78, 126976
ds_read_b64_tr_b16 a[116:117], v5 offset:40960
v_mfma_f32_16x16x32_bf16 v[244:247], a[24:27], a[80:83], v[244:247]
s_add_u32 s64, s74, 1792
ds_read_b64_tr_b16 a[118:119], v5 offset:41984
v_mfma_f32_16x16x32_bf16 v[244:247], a[28:31], a[84:87], v[244:247]
buffer_load_dwordx4 v22, s[48:51], s64 offen lds
v_mfma_f32_16x16x32_bf16 v[236:239], a[20:23], a[84:87], v[236:239]
ds_read_b64_tr_b16 a[72:73], v6 offset:32768
v_subrev_u32 v19, 0x8000, v19
v_mfma_f32_16x16x32_bf16 v[236:239], a[16:19], a[80:83], v[236:239]
ds_read_b64_tr_b16 a[74:75], v6 offset:33792
v_mfma_f32_16x16x32_bf16 v[228:231], a[8:11], a[80:83], v[228:231]
ds_read_b64_tr_b16 a[76:77], v6 offset:40960
v_mfma_f32_16x16x32_bf16 v[228:231], a[12:15], a[84:87], v[228:231]
ds_read_b64_tr_b16 a[78:79], v6 offset:41984
v_mfma_f32_16x16x32_bf16 v[220:223], a[4:7], a[84:87], v[220:223]
v_mfma_f32_16x16x32_bf16 v[220:223], a[0:3], a[80:83], v[220:223]
s_waitcnt lgkmcnt(7)
ds_read_b64_tr_b16 a[80:81], v7 offset:32768
v_mfma_f32_16x16x32_bf16 v[152:155], a[88:91], a[0:3], v[152:155]
ds_read_b64_tr_b16 a[82:83], v7 offset:33792
v_mfma_f32_16x16x32_bf16 v[152:155], a[92:95], a[4:7], v[152:155]
ds_read_b64_tr_b16 a[84:85], v7 offset:40960
v_subrev_u32 v20, 0x8000, v20
v_mfma_f32_16x16x32_bf16 v[160:163], a[92:95], a[12:15], v[160:163]
s_add_u32 m0, s76, 0
ds_read_b64_tr_b16 a[86:87], v7 offset:41984
v_mfma_f32_16x16x32_bf16 v[160:163], a[88:91], a[8:11], v[160:163]
s_add_u32 s64, s72, 1792
v_mfma_f32_16x16x32_bf16 v[168:171], a[88:91], a[16:19], v[168:171]
buffer_load_dwordx4 v12, s[48:51], s64 offen lds
v_mfma_f32_16x16x32_bf16 v[168:171], a[92:95], a[20:23], v[168:171]
v_mfma_f32_16x16x32_bf16 v[176:179], a[92:95], a[28:31], v[176:179]
v_mfma_f32_16x16x32_bf16 v[176:179], a[88:91], a[24:27], v[176:179]
s_add_u32 m0, s76, 1024
ds_read_b64_tr_b16 a[88:89], v8 offset:32768
v_mfma_f32_16x16x32_bf16 v[180:183], a[96:99], a[24:27], v[180:183]
s_add_u32 s64, s72, 18176
ds_read_b64_tr_b16 a[90:91], v8 offset:33792
v_mfma_f32_16x16x32_bf16 v[180:183], a[100:103], a[28:31], v[180:183]
buffer_load_dwordx4 v13, s[48:51], s64 offen lds
v_mfma_f32_16x16x32_bf16 v[172:175], a[100:103], a[20:23], v[172:175]
ds_read_b64_tr_b16 a[92:93], v8 offset:40960
v_subrev_u32 v4, 0x8000, v4
v_mfma_f32_16x16x32_bf16 v[172:175], a[96:99], a[16:19], v[172:175]
ds_read_b64_tr_b16 a[94:95], v8 offset:41984
v_mfma_f32_16x16x32_bf16 v[164:167], a[96:99], a[8:11], v[164:167]
v_mfma_f32_16x16x32_bf16 v[164:167], a[100:103], a[12:15], v[164:167]
s_add_u32 m0, s76, 2048
v_mfma_f32_16x16x32_bf16 v[156:159], a[100:103], a[4:7], v[156:159]
s_add_u32 s64, s72, 132864
v_mfma_f32_16x16x32_bf16 v[156:159], a[96:99], a[0:3], v[156:159]
buffer_load_dwordx4 v12, s[48:51], s64 offen lds
v_mfma_f32_16x16x32_bf16 v[24:27], a[104:107], a[0:3], v[24:27]
s_add_u32 m0, s76, 3072
ds_read_b64_tr_b16 a[96:97], v9 offset:32768
v_mfma_f32_16x16x32_bf16 v[24:27], a[108:111], a[4:7], v[24:27]
ds_read_b64_tr_b16 a[98:99], v9 offset:33792
v_subrev_u32 v5, 0x8000, v5
v_mfma_f32_16x16x32_bf16 v[40:43], a[108:111], a[12:15], v[40:43]
s_waitcnt vmcnt(12)
ds_read_b64_tr_b16 a[100:101], v9 offset:40960
v_mfma_f32_16x16x32_bf16 v[40:43], a[104:107], a[8:11], v[40:43]
s_add_u32 s64, s72, 149248
ds_read_b64_tr_b16 a[102:103], v9 offset:41984
v_mfma_f32_16x16x32_bf16 v[56:59], a[104:107], a[16:19], v[56:59]
buffer_load_dwordx4 v13, s[48:51], s64 offen lds
v_mfma_f32_16x16x32_bf16 v[56:59], a[108:111], a[20:23], v[56:59]
ds_read_b128 a[32:35], v2 offset:32768
v_mfma_f32_16x16x32_bf16 v[72:75], a[108:111], a[28:31], v[72:75]
ds_read_b128 a[36:39], v3 offset:32768
v_mfma_f32_16x16x32_bf16 v[72:75], a[104:107], a[24:27], v[72:75]
s_waitcnt lgkmcnt(6)
s_add_u32 m0, s76, 4096
ds_read_b128 a[40:43], v2 offset:34816
v_mfma_f32_16x16x32_bf16 v[136:139], a[112:115], a[24:27], v[136:139]
s_add_u32 s64, s73, 1792
ds_read_b128 a[44:47], v3 offset:34816
v_mfma_f32_16x16x32_bf16 v[136:139], a[116:119], a[28:31], v[136:139]
ds_read_b128 a[48:51], v2 offset:36864
v_subrev_u32 v6, 0x8000, v6
v_mfma_f32_16x16x32_bf16 v[120:123], a[116:119], a[20:23], v[120:123]
buffer_load_dwordx4 v12, s[48:51], s64 offen lds
v_mfma_f32_16x16x32_bf16 v[120:123], a[112:115], a[16:19], v[120:123]
ds_read_b128 a[52:55], v3 offset:36864
v_mfma_f32_16x16x32_bf16 v[104:107], a[112:115], a[8:11], v[104:107]
ds_read_b128 a[56:59], v2 offset:38912
v_mfma_f32_16x16x32_bf16 v[104:107], a[116:119], a[12:15], v[104:107]
s_add_u32 m0, s76, 5120
ds_read_b128 a[60:63], v3 offset:38912
v_mfma_f32_16x16x32_bf16 v[88:91], a[116:119], a[4:7], v[88:91]
s_add_u32 s64, s73, 18176
ds_read_b64_tr_b16 a[104:105], v10 offset:32768
v_mfma_f32_16x16x32_bf16 v[88:91], a[112:115], a[0:3], v[88:91]
buffer_load_dwordx4 v13, s[48:51], s64 offen lds
v_mfma_f32_16x16x32_bf16 v[28:31], a[72:75], a[0:3], v[28:31]
ds_read_b64_tr_b16 a[106:107], v10 offset:33792
v_mfma_f32_16x16x32_bf16 v[28:31], a[76:79], a[4:7], v[28:31]
ds_read_b64_tr_b16 a[108:109], v10 offset:40960
v_subrev_u32 v7, 0x8000, v7
v_mfma_f32_16x16x32_bf16 v[44:47], a[76:79], a[12:15], v[44:47]
s_add_u32 m0, s76, 6144
ds_read_b64_tr_b16 a[110:111], v10 offset:41984
v_mfma_f32_16x16x32_bf16 v[44:47], a[72:75], a[8:11], v[44:47]
s_add_u32 s64, s73, 132864
ds_read_b64_tr_b16 a[112:113], v11 offset:32768
v_mfma_f32_16x16x32_bf16 v[60:63], a[72:75], a[16:19], v[60:63]
buffer_load_dword v1, off, s[52:55], s80 sc1
v_mfma_f32_16x16x32_bf16 v[60:63], a[76:79], a[20:23], v[60:63]
buffer_load_dwordx4 v12, s[48:51], s64 offen lds
v_mfma_f32_16x16x32_bf16 v[76:79], a[76:79], a[28:31], v[76:79]
ds_read_b64_tr_b16 a[114:115], v11 offset:33792
v_mfma_f32_16x16x32_bf16 v[76:79], a[72:75], a[24:27], v[76:79]
ds_read_b64_tr_b16 a[116:117], v11 offset:40960
v_mfma_f32_16x16x32_bf16 v[140:143], a[80:83], a[24:27], v[140:143]
s_add_u32 m0, s76, 7168
ds_read_b64_tr_b16 a[118:119], v11 offset:41984
v_mfma_f32_16x16x32_bf16 v[140:143], a[84:87], a[28:31], v[140:143]
s_add_u32 s64, s73, 149248
v_subrev_u32 v8, 0x8000, v8
v_mfma_f32_16x16x32_bf16 v[124:127], a[84:87], a[20:23], v[124:127]
buffer_load_dwordx4 v13, s[48:51], s64 offen lds
v_mfma_f32_16x16x32_bf16 v[124:127], a[80:83], a[16:19], v[124:127]
v_mfma_f32_16x16x32_bf16 v[108:111], a[80:83], a[8:11], v[108:111]
v_mfma_f32_16x16x32_bf16 v[108:111], a[84:87], a[12:15], v[108:111]
v_mfma_f32_16x16x32_bf16 v[92:95], a[84:87], a[4:7], v[92:95]
v_subrev_u32 v9, 0x8000, v9
v_subrev_u32 v10, 0x8000, v10
v_mfma_f32_16x16x32_bf16 v[92:95], a[80:83], a[0:3], v[92:95]
v_subrev_u32 v11, 0x8000, v11
v_mfma_f32_16x16x32_bf16 v[32:35], a[88:91], a[0:3], v[32:35]
v_mfma_f32_16x16x32_bf16 v[32:35], a[92:95], a[4:7], v[32:35]
v_mfma_f32_16x16x32_bf16 v[48:51], a[92:95], a[12:15], v[48:51]
s_waitcnt lgkmcnt(0)
s_barrier
v_mfma_f32_16x16x32_bf16 v[48:51], a[88:91], a[8:11], v[48:51]
s_add_u32 m0, s77, 131072
ds_read_b64_tr_b16 a[72:73], v19 offset:4096
v_mfma_f32_16x16x32_bf16 v[64:67], a[88:91], a[16:19], v[64:67]
s_add_u32 s64, s71, 7864320
ds_read_b64_tr_b16 a[74:75], v19 offset:4352
v_mfma_f32_16x16x32_bf16 v[64:67], a[92:95], a[20:23], v[64:67]
buffer_load_dwordx4 v14, s[56:59], s64 offen lds
v_mfma_f32_16x16x32_bf16 v[80:83], a[92:95], a[28:31], v[80:83]
ds_read_b64_tr_b16 a[76:77], v19 offset:6144
v_mfma_f32_16x16x32_bf16 v[80:83], a[88:91], a[24:27], v[80:83]
ds_read_b64_tr_b16 a[78:79], v19 offset:6400
v_mfma_f32_16x16x32_bf16 v[144:147], a[96:99], a[24:27], v[144:147]
ds_read_b128 a[64:67], v17 offset:0
v_mfma_f32_16x16x32_bf16 v[144:147], a[100:103], a[28:31], v[144:147]
ds_read_b128 a[68:71], v18 offset:0
v_mfma_f32_16x16x32_bf16 v[128:131], a[100:103], a[20:23], v[128:131]
ds_read_b64_tr_b16 a[80:81], v21 offset:4096
v_mfma_f32_16x16x32_bf16 v[128:131], a[96:99], a[16:19], v[128:131]
s_add_u32 m0, s78, 147456
ds_read_b64_tr_b16 a[82:83], v21 offset:4352
v_mfma_f32_16x16x32_bf16 v[112:115], a[96:99], a[8:11], v[112:115]
s_add_u32 s64, s75, 5898240
ds_read_b64_tr_b16 a[84:85], v21 offset:6144
v_mfma_f32_16x16x32_bf16 v[112:115], a[100:103], a[12:15], v[112:115]
buffer_load_dwordx4 v23, s[60:63], s64 offen lds
v_mfma_f32_16x16x32_bf16 v[96:99], a[100:103], a[4:7], v[96:99]
ds_read_b64_tr_b16 a[86:87], v21 offset:6400
v_mfma_f32_16x16x32_bf16 v[96:99], a[96:99], a[0:3], v[96:99]
ds_read_b64_tr_b16 a[88:89], v20 offset:4096
v_mfma_f32_16x16x32_bf16 v[36:39], a[104:107], a[0:3], v[36:39]
ds_read_b64_tr_b16 a[90:91], v20 offset:4352
v_mfma_f32_16x16x32_bf16 v[36:39], a[108:111], a[4:7], v[36:39]
ds_read_b64_tr_b16 a[92:93], v20 offset:6144
v_mfma_f32_16x16x32_bf16 v[52:55], a[108:111], a[12:15], v[52:55]
ds_read_b64_tr_b16 a[94:95], v20 offset:6400
v_mfma_f32_16x16x32_bf16 v[52:55], a[104:107], a[8:11], v[52:55]
s_add_u32 m0, s77, 132096
ds_read_b64_tr_b16 a[96:97], v19 offset:8192
v_mfma_f32_16x16x32_bf16 v[68:71], a[104:107], a[16:19], v[68:71]
s_add_u32 s64, s71, 7897088
ds_read_b64_tr_b16 a[98:99], v19 offset:8448
v_mfma_f32_16x16x32_bf16 v[68:71], a[108:111], a[20:23], v[68:71]
buffer_load_dwordx4 v14, s[56:59], s64 offen lds
v_mfma_f32_16x16x32_bf16 v[84:87], a[108:111], a[28:31], v[84:87]
ds_read_b64_tr_b16 a[100:101], v19 offset:10240
v_mfma_f32_16x16x32_bf16 v[84:87], a[104:107], a[24:27], v[84:87]
ds_read_b64_tr_b16 a[102:103], v19 offset:10496
v_mfma_f32_16x16x32_bf16 v[148:151], a[112:115], a[24:27], v[148:151]
ds_read_b64_tr_b16 a[104:105], v21 offset:8192
v_mfma_f32_16x16x32_bf16 v[148:151], a[116:119], a[28:31], v[148:151]
ds_read_b64_tr_b16 a[106:107], v21 offset:8448
v_mfma_f32_16x16x32_bf16 v[132:135], a[116:119], a[20:23], v[132:135]
ds_read_b64_tr_b16 a[108:109], v21 offset:10240
v_mfma_f32_16x16x32_bf16 v[132:135], a[112:115], a[16:19], v[132:135]
s_add_u32 m0, s78, 151552
ds_read_b64_tr_b16 a[110:111], v21 offset:10496
v_mfma_f32_16x16x32_bf16 v[116:119], a[112:115], a[8:11], v[116:119]
s_add_u32 s64, s75, 5900288
v_mfma_f32_16x16x32_bf16 v[116:119], a[116:119], a[12:15], v[116:119]
buffer_load_dwordx4 v23, s[60:63], s64 offen lds
v_mfma_f32_16x16x32_bf16 v[100:103], a[116:119], a[4:7], v[100:103]
v_mfma_f32_16x16x32_bf16 v[100:103], a[112:115], a[0:3], v[100:103]
s_waitcnt lgkmcnt(6)
ds_read_b64_tr_b16 a[112:113], v20 offset:8192
v_mfma_f32_16x16x32_bf16 v[184:187], a[72:75], a[32:35], v[184:187]
s_add_u32 s17, s78, .-L_pc+6144
ds_read_b64_tr_b16 a[114:115], v20 offset:8448
v_mfma_f32_16x16x32_bf16 v[184:187], a[76:79], a[36:39], v[184:187]
s_add_u32 m0, s77, 133120
ds_read_b64_tr_b16 a[116:117], v20 offset:10240
v_mfma_f32_16x16x32_bf16 v[192:195], a[76:79], a[44:47], v[192:195]
s_add_u32 s64, s71, 7929856
ds_read_b64_tr_b16 a[118:119], v20 offset:10496
v_mfma_f32_16x16x32_bf16 v[192:195], a[72:75], a[40:43], v[192:195]
s_lshl_b32 s68, s31, 20
s_add_u32 s32, s28, s68
s_addc_u32 s33, s29, 0
v_mfma_f32_16x16x32_bf16 v[200:203], a[72:75], a[48:51], v[200:203]
buffer_load_dword a252, v16, s[88:91], s17 offen
v_mfma_f32_16x16x32_bf16 v[200:203], a[76:79], a[52:55], v[200:203]
buffer_load_dwordx4 v15, s[56:59], s64 offen lds
v_mfma_f32_16x16x32_bf16 v[208:211], a[76:79], a[60:63], v[208:211]
s_add_u32 s68, s16, 1
s_lshl_b32 s34, s68, 16
v_mfma_f32_16x16x32_bf16 v[208:211], a[72:75], a[56:59], v[208:211]
ds_read_b64_tr_b16 a[72:73], v19 offset:0
v_mfma_f32_16x16x32_bf16 v[248:251], a[80:83], a[64:67], v[248:251]
ds_read_b64_tr_b16 a[74:75], v19 offset:256
v_mfma_f32_16x16x32_bf16 v[248:251], a[84:87], a[68:71], v[248:251]
ds_read_b64_tr_b16 a[76:77], v19 offset:2048
v_mfma_f32_16x16x32_bf16 v[212:215], a[92:95], a[60:63], v[212:215]
ds_read_b64_tr_b16 a[78:79], v19 offset:2304
v_mfma_f32_16x16x32_bf16 v[212:215], a[88:91], a[56:59], v[212:215]
s_add_u32 m0, s78, 155648
ds_read_b64_tr_b16 a[80:81], v20 offset:0
v_mfma_f32_16x16x32_bf16 v[204:207], a[88:91], a[48:51], v[204:207]
s_add_u32 s64, s75, 5902336
ds_read_b64_tr_b16 a[82:83], v20 offset:256
v_mfma_f32_16x16x32_bf16 v[204:207], a[92:95], a[52:55], v[204:207]
buffer_load_dwordx4 v23, s[60:63], s64 offen lds
v_mfma_f32_16x16x32_bf16 v[196:199], a[92:95], a[44:47], v[196:199]
ds_read_b64_tr_b16 a[84:85], v20 offset:2048
v_mfma_f32_16x16x32_bf16 v[196:199], a[88:91], a[40:43], v[196:199]
ds_read_b64_tr_b16 a[86:87], v20 offset:2304
v_mfma_f32_16x16x32_bf16 v[188:191], a[88:91], a[32:35], v[188:191]
v_mfma_f32_16x16x32_bf16 v[188:191], a[92:95], a[36:39], v[188:191]
s_waitcnt lgkmcnt(7)
ds_read_b64_tr_b16 a[88:89], v4 offset:0
v_mfma_f32_16x16x32_bf16 v[216:219], a[36:39], a[100:103], v[216:219]
ds_read_b64_tr_b16 a[90:91], v4 offset:1024
v_mfma_f32_16x16x32_bf16 v[216:219], a[32:35], a[96:99], v[216:219]
s_add_u32 m0, s77, 134144
ds_read_b64_tr_b16 a[92:93], v4 offset:8192
v_mfma_f32_16x16x32_bf16 v[224:227], a[40:43], a[96:99], v[224:227]
s_add_u32 s64, s71, 7962624
ds_read_b64_tr_b16 a[94:95], v4 offset:9216
v_mfma_f32_16x16x32_bf16 v[224:227], a[44:47], a[100:103], v[224:227]
buffer_load_dwordx4 v15, s[56:59], s64 offen lds
v_mfma_f32_16x16x32_bf16 v[232:235], a[52:55], a[100:103], v[232:235]
v_mfma_f32_16x16x32_bf16 v[232:235], a[48:51], a[96:99], v[232:235]
v_mfma_f32_16x16x32_bf16 v[240:243], a[56:59], a[96:99], v[240:243]
v_mfma_f32_16x16x32_bf16 v[240:243], a[60:63], a[100:103], v[240:243]
ds_read_b64_tr_b16 a[96:97], v5 offset:0
v_mfma_f32_16x16x32_bf16 v[252:255], a[68:71], a[108:111], v[252:255]
ds_read_b64_tr_b16 a[98:99], v5 offset:1024
v_mfma_f32_16x16x32_bf16 v[252:255], a[64:67], a[104:107], v[252:255]
s_add_u32 m0, s78, 159744
ds_read_b64_tr_b16 a[100:101], v5 offset:8192
v_mfma_f32_16x16x32_bf16 v[244:247], a[56:59], a[112:115], v[244:247]
s_add_u32 s64, s74, 1920
ds_read_b64_tr_b16 a[102:103], v5 offset:9216
v_mfma_f32_16x16x32_bf16 v[244:247], a[60:63], a[116:119], v[244:247]
buffer_load_dwordx4 v22, s[48:51], s64 offen lds
v_mfma_f32_16x16x32_bf16 v[236:239], a[52:55], a[116:119], v[236:239]
ds_read_b64_tr_b16 a[104:105], v6 offset:0
v_mfma_f32_16x16x32_bf16 v[236:239], a[48:51], a[112:115], v[236:239]
ds_read_b64_tr_b16 a[106:107], v6 offset:1024
v_mfma_f32_16x16x32_bf16 v[228:231], a[40:43], a[112:115], v[228:231]
ds_read_b64_tr_b16 a[108:109], v6 offset:8192
v_mfma_f32_16x16x32_bf16 v[228:231], a[44:47], a[116:119], v[228:231]
ds_read_b64_tr_b16 a[110:111], v6 offset:9216
v_mfma_f32_16x16x32_bf16 v[220:223], a[36:39], a[116:119], v[220:223]
v_mfma_f32_16x16x32_bf16 v[220:223], a[32:35], a[112:115], v[220:223]
s_waitcnt lgkmcnt(7)
ds_read_b64_tr_b16 a[112:113], v7 offset:0
v_mfma_f32_16x16x32_bf16 v[152:155], a[72:75], a[32:35], v[152:155]
ds_read_b64_tr_b16 a[114:115], v7 offset:1024
v_mfma_f32_16x16x32_bf16 v[152:155], a[76:79], a[36:39], v[152:155]
ds_read_b64_tr_b16 a[116:117], v7 offset:8192
v_mfma_f32_16x16x32_bf16 v[160:163], a[76:79], a[44:47], v[160:163]
s_add_u32 m0, s76, 32768
ds_read_b64_tr_b16 a[118:119], v7 offset:9216
v_mfma_f32_16x16x32_bf16 v[160:163], a[72:75], a[40:43], v[160:163]
s_add_u32 s64, s72, 1920
v_mfma_f32_16x16x32_bf16 v[168:171], a[72:75], a[48:51], v[168:171]
buffer_load_dwordx4 v12, s[48:51], s64 offen lds
v_mfma_f32_16x16x32_bf16 v[168:171], a[76:79], a[52:55], v[168:171]
v_mfma_f32_16x16x32_bf16 v[176:179], a[76:79], a[60:63], v[176:179]
v_mfma_f32_16x16x32_bf16 v[176:179], a[72:75], a[56:59], v[176:179]
s_add_u32 m0, s76, 33792
ds_read_b64_tr_b16 a[72:73], v8 offset:0
v_mfma_f32_16x16x32_bf16 v[180:183], a[80:83], a[56:59], v[180:183]
s_add_u32 s64, s72, 18304
ds_read_b64_tr_b16 a[74:75], v8 offset:1024
v_mfma_f32_16x16x32_bf16 v[180:183], a[84:87], a[60:63], v[180:183]
buffer_load_dwordx4 v13, s[48:51], s64 offen lds
v_mfma_f32_16x16x32_bf16 v[172:175], a[84:87], a[52:55], v[172:175]
ds_read_b64_tr_b16 a[76:77], v8 offset:8192
v_mfma_f32_16x16x32_bf16 v[172:175], a[80:83], a[48:51], v[172:175]
ds_read_b64_tr_b16 a[78:79], v8 offset:9216
v_mfma_f32_16x16x32_bf16 v[164:167], a[80:83], a[40:43], v[164:167]
v_mfma_f32_16x16x32_bf16 v[164:167], a[84:87], a[44:47], v[164:167]
s_add_u32 m0, s76, 34816
v_mfma_f32_16x16x32_bf16 v[156:159], a[84:87], a[36:39], v[156:159]
s_add_u32 s64, s72, 132992
v_mfma_f32_16x16x32_bf16 v[156:159], a[80:83], a[32:35], v[156:159]
buffer_load_dwordx4 v12, s[48:51], s64 offen lds
v_mfma_f32_16x16x32_bf16 v[24:27], a[88:91], a[32:35], v[24:27]
ds_read_b64_tr_b16 a[80:81], v9 offset:0
v_mfma_f32_16x16x32_bf16 v[24:27], a[92:95], a[36:39], v[24:27]
s_add_u32 m0, s76, 35840
ds_read_b64_tr_b16 a[82:83], v9 offset:1024
v_mfma_f32_16x16x32_bf16 v[40:43], a[92:95], a[44:47], v[40:43]
s_waitcnt vmcnt(12)
ds_read_b64_tr_b16 a[84:85], v9 offset:8192
v_mfma_f32_16x16x32_bf16 v[40:43], a[88:91], a[40:43], v[40:43]
s_add_u32 s64, s72, 149376
ds_read_b64_tr_b16 a[86:87], v9 offset:9216
v_mfma_f32_16x16x32_bf16 v[56:59], a[88:91], a[48:51], v[56:59]
buffer_load_dwordx4 v13, s[48:51], s64 offen lds
v_mfma_f32_16x16x32_bf16 v[56:59], a[92:95], a[52:55], v[56:59]
ds_read_b128 a[0:3], v2 offset:0
v_mfma_f32_16x16x32_bf16 v[72:75], a[92:95], a[60:63], v[72:75]
ds_read_b128 a[4:7], v3 offset:0
v_mfma_f32_16x16x32_bf16 v[72:75], a[88:91], a[56:59], v[72:75]
s_waitcnt lgkmcnt(6)
ds_read_b128 a[8:11], v2 offset:2048
v_mfma_f32_16x16x32_bf16 v[136:139], a[96:99], a[56:59], v[136:139]
s_add_u32 m0, s76, 36864
ds_read_b128 a[12:15], v3 offset:2048
v_mfma_f32_16x16x32_bf16 v[136:139], a[100:103], a[60:63], v[136:139]
s_add_u32 s64, s73, 1920
ds_read_b128 a[16:19], v2 offset:4096
v_mfma_f32_16x16x32_bf16 v[120:123], a[100:103], a[52:55], v[120:123]
buffer_load_dwordx4 v12, s[48:51], s64 offen lds
v_mfma_f32_16x16x32_bf16 v[120:123], a[96:99], a[48:51], v[120:123]
ds_read_b128 a[20:23], v3 offset:4096
v_mfma_f32_16x16x32_bf16 v[104:107], a[96:99], a[40:43], v[104:107]
ds_read_b128 a[24:27], v2 offset:6144
v_mfma_f32_16x16x32_bf16 v[104:107], a[100:103], a[44:47], v[104:107]
s_add_u32 m0, s76, 37888
ds_read_b128 a[28:31], v3 offset:6144
v_mfma_f32_16x16x32_bf16 v[88:91], a[100:103], a[36:39], v[88:91]
s_add_u32 s64, s73, 18304
ds_read_b64_tr_b16 a[88:89], v10 offset:0
v_mfma_f32_16x16x32_bf16 v[88:91], a[96:99], a[32:35], v[88:91]
buffer_load_dwordx4 v13, s[48:51], s64 offen lds
v_mfma_f32_16x16x32_bf16 v[28:31], a[104:107], a[32:35], v[28:31]
ds_read_b64_tr_b16 a[90:91], v10 offset:1024
v_mfma_f32_16x16x32_bf16 v[28:31], a[108:111], a[36:39], v[28:31]
ds_read_b64_tr_b16 a[92:93], v10 offset:8192
v_mfma_f32_16x16x32_bf16 v[44:47], a[108:111], a[44:47], v[44:47]
ds_read_b64_tr_b16 a[94:95], v10 offset:9216
v_mfma_f32_16x16x32_bf16 v[44:47], a[104:107], a[40:43], v[44:47]
s_add_u32 m0, s76, 38912
ds_read_b64_tr_b16 a[96:97], v11 offset:0
v_mfma_f32_16x16x32_bf16 v[60:63], a[104:107], a[48:51], v[60:63]
s_add_u32 s64, s73, 132992
ds_read_b64_tr_b16 a[98:99], v11 offset:1024
v_mfma_f32_16x16x32_bf16 v[60:63], a[108:111], a[52:55], v[60:63]
buffer_load_dwordx4 v12, s[48:51], s64 offen lds
v_mfma_f32_16x16x32_bf16 v[76:79], a[108:111], a[60:63], v[76:79]
ds_read_b64_tr_b16 a[100:101], v11 offset:8192
v_mfma_f32_16x16x32_bf16 v[76:79], a[104:107], a[56:59], v[76:79]
s_add_u32 m0, s76, 39936
ds_read_b64_tr_b16 a[102:103], v11 offset:9216
v_mfma_f32_16x16x32_bf16 v[140:143], a[112:115], a[56:59], v[140:143]
v_readfirstlane_b32 s66, v1
s_nop 0
s_cmp_lt_u32 s66, 8
s_cbranch_scc1 L_spin_4
L_spinbk_5:
v_mfma_f32_16x16x32_bf16 v[140:143], a[116:119], a[60:63], v[140:143]
s_add_u32 s64, s73, 149376
v_mfma_f32_16x16x32_bf16 v[124:127], a[116:119], a[52:55], v[124:127]
buffer_load_dwordx4 v13, s[48:51], s64 offen lds
v_mfma_f32_16x16x32_bf16 v[124:127], a[112:115], a[48:51], v[124:127]
v_mfma_f32_16x16x32_bf16 v[108:111], a[112:115], a[40:43], v[108:111]
v_mfma_f32_16x16x32_bf16 v[108:111], a[116:119], a[44:47], v[108:111]
v_mfma_f32_16x16x32_bf16 v[92:95], a[116:119], a[36:39], v[92:95]
v_mfma_f32_16x16x32_bf16 v[92:95], a[112:115], a[32:35], v[92:95]
v_mfma_f32_16x16x32_bf16 v[32:35], a[72:75], a[32:35], v[32:35]
v_mfma_f32_16x16x32_bf16 v[32:35], a[76:79], a[36:39], v[32:35]
v_mfma_f32_16x16x32_bf16 v[48:51], a[76:79], a[44:47], v[48:51]
s_waitcnt lgkmcnt(0)
s_barrier
v_mfma_f32_16x16x32_bf16 v[48:51], a[72:75], a[40:43], v[48:51]
ds_read_b64_tr_b16 a[104:105], v19 offset:36864
v_mfma_f32_16x16x32_bf16 v[64:67], a[72:75], a[48:51], v[64:67]
ds_read_b64_tr_b16 a[106:107], v19 offset:37120
v_mfma_f32_16x16x32_bf16 v[64:67], a[76:79], a[52:55], v[64:67]
s_mov_b32 m0, s76
ds_read_b64_tr_b16 a[108:109], v19 offset:38912
v_mfma_f32_16x16x32_bf16 v[80:83], a[76:79], a[60:63], v[80:83]
s_lshl_b32 s64, s30, 14
ds_read_b64_tr_b16 a[110:111], v19 offset:39168
v_mfma_f32_16x16x32_bf16 v[80:83], a[72:75], a[56:59], v[80:83]
buffer_load_dwordx4 v16, s[32:35], s64 offen offset:0 sc1 lds
v_mfma_f32_16x16x32_bf16 v[144:147], a[80:83], a[56:59], v[144:147]
ds_read_b128 a[64:67], v17 offset:32768
v_mfma_f32_16x16x32_bf16 v[144:147], a[84:87], a[60:63], v[144:147]
ds_read_b128 a[68:71], v18 offset:32768
v_mfma_f32_16x16x32_bf16 v[128:131], a[84:87], a[52:55], v[128:131]
ds_read_b64_tr_b16 a[112:113], v21 offset:36864
v_mfma_f32_16x16x32_bf16 v[128:131], a[80:83], a[48:51], v[128:131]
ds_read_b64_tr_b16 a[114:115], v21 offset:37120
v_mfma_f32_16x16x32_bf16 v[112:115], a[80:83], a[40:43], v[112:115]
ds_read_b64_tr_b16 a[116:117], v21 offset:38912
v_mfma_f32_16x16x32_bf16 v[112:115], a[84:87], a[44:47], v[112:115]
buffer_load_dwordx4 v16, s[32:35], s64 offen offset:1024 sc1 lds
v_mfma_f32_16x16x32_bf16 v[96:99], a[84:87], a[36:39], v[96:99]
ds_read_b64_tr_b16 a[118:119], v21 offset:39168
v_mfma_f32_16x16x32_bf16 v[96:99], a[80:83], a[32:35], v[96:99]
ds_read_b64_tr_b16 a[72:73], v20 offset:36864
v_mfma_f32_16x16x32_bf16 v[36:39], a[88:91], a[32:35], v[36:39]
ds_read_b64_tr_b16 a[74:75], v20 offset:37120
v_mfma_f32_16x16x32_bf16 v[36:39], a[92:95], a[36:39], v[36:39]
ds_read_b64_tr_b16 a[76:77], v20 offset:38912
v_mfma_f32_16x16x32_bf16 v[52:55], a[92:95], a[44:47], v[52:55]
ds_read_b64_tr_b16 a[78:79], v20 offset:39168
v_mfma_f32_16x16x32_bf16 v[52:55], a[88:91], a[40:43], v[52:55]
buffer_load_dwordx4 v16, s[32:35], s64 offen offset:2048 sc1 lds
v_mfma_f32_16x16x32_bf16 v[68:71], a[88:91], a[48:51], v[68:71]
ds_read_b64_tr_b16 a[80:81], v19 offset:40960
v_mfma_f32_16x16x32_bf16 v[68:71], a[92:95], a[52:55], v[68:71]
ds_read_b64_tr_b16 a[82:83], v19 offset:41216
v_mfma_f32_16x16x32_bf16 v[84:87], a[92:95], a[60:63], v[84:87]
ds_read_b64_tr_b16 a[84:85], v19 offset:43008
v_mfma_f32_16x16x32_bf16 v[84:87], a[88:91], a[56:59], v[84:87]
ds_read_b64_tr_b16 a[86:87], v19 offset:43264
v_mfma_f32_16x16x32_bf16 v[148:151], a[96:99], a[56:59], v[148:151]
ds_read_b64_tr_b16 a[88:89], v21 offset:40960
v_mfma_f32_16x16x32_bf16 v[148:151], a[100:103], a[60:63], v[148:151]
buffer_load_dwordx4 v16, s[32:35], s64 offen offset:3072 sc1 lds
v_mfma_f32_16x16x32_bf16 v[132:135], a[100:103], a[52:55], v[132:135]
ds_read_b64_tr_b16 a[90:91], v21 offset:41216
v_mfma_f32_16x16x32_bf16 v[132:135], a[96:99], a[48:51], v[132:135]
ds_read_b64_tr_b16 a[92:93], v21 offset:43008
v_mfma_f32_16x16x32_bf16 v[116:119], a[96:99], a[40:43], v[116:119]
ds_read_b64_tr_b16 a[94:95], v21 offset:43264
v_mfma_f32_16x16x32_bf16 v[116:119], a[100:103], a[44:47], v[116:119]
s_add_u32 m0, s76, 4096
v_mfma_f32_16x16x32_bf16 v[100:103], a[100:103], a[36:39], v[100:103]
s_add_u32 s64, s64, 4096
v_mfma_f32_16x16x32_bf16 v[100:103], a[96:99], a[32:35], v[100:103]
s_waitcnt lgkmcnt(6)
buffer_load_dwordx4 v16, s[32:35], s64 offen offset:0 sc1 lds
v_mfma_f32_16x16x32_bf16 v[184:187], a[104:107], a[0:3], v[184:187]
ds_read_b64_tr_b16 a[96:97], v20 offset:40960
v_and_b32 v12, 15, v0
v_mfma_f32_16x16x32_bf16 v[184:187], a[108:111], a[4:7], v[184:187]
ds_read_b64_tr_b16 a[98:99], v20 offset:41216
v_lshrrev_b32 v13, 4, v0
v_mfma_f32_16x16x32_bf16 v[192:195], a[108:111], a[12:15], v[192:195]
ds_read_b64_tr_b16 a[100:101], v20 offset:43008
v_lshlrev_b32 v13, 2, v13
v_mfma_f32_16x16x32_bf16 v[192:195], a[104:107], a[8:11], v[192:195]
ds_read_b64_tr_b16 a[102:103], v20 offset:43264
v_sub_u32 v12, v12, v13
v_mfma_f32_16x16x32_bf16 v[200:203], a[104:107], a[16:19], v[200:203]
s_lshl_b32 s66, s30, 4
v_add_u32 v17, 0x8000, v17
v_add_u32 v18, 0x8000, v18
v_mfma_f32_16x16x32_bf16 v[200:203], a[108:111], a[20:23], v[200:203]
buffer_load_dwordx4 v16, s[32:35], s64 offen offset:1024 sc1 lds
v_mfma_f32_16x16x32_bf16 v[208:211], a[108:111], a[28:31], v[208:211]
v_add_u32 v13, s66, v12
v_cmp_gt_i32 s[0:1], 0, v13
v_mfma_f32_16x16x32_bf16 v[208:211], a[104:107], a[24:27], v[208:211]
ds_read_b64_tr_b16 a[104:105], v19 offset:32768
v_cmp_gt_i32 s[4:5], 1, v13
v_mfma_f32_16x16x32_bf16 v[248:251], a[112:115], a[64:67], v[248:251]
ds_read_b64_tr_b16 a[106:107], v19 offset:33024
v_cmp_gt_i32 s[6:7], 2, v13
v_mfma_f32_16x16x32_bf16 v[248:251], a[116:119], a[68:71], v[248:251]
ds_read_b64_tr_b16 a[108:109], v19 offset:34816
v_cmp_gt_i32 s[8:9], 3, v13
v_mfma_f32_16x16x32_bf16 v[212:215], a[76:79], a[28:31], v[212:215]
ds_read_b64_tr_b16 a[110:111], v19 offset:35072
v_cmp_gt_i32 s[10:11], 16, v13
v_mfma_f32_16x16x32_bf16 v[212:215], a[72:75], a[24:27], v[212:215]
buffer_load_dwordx4 v16, s[32:35], s64 offen offset:2048 sc1 lds
v_mfma_f32_16x16x32_bf16 v[204:207], a[72:75], a[16:19], v[204:207]
ds_read_b64_tr_b16 a[112:113], v20 offset:32768
v_cmp_gt_i32 s[12:13], 17, v13
v_mfma_f32_16x16x32_bf16 v[204:207], a[76:79], a[20:23], v[204:207]
ds_read_b64_tr_b16 a[114:115], v20 offset:33024
v_cmp_gt_i32 s[18:19], 18, v13
v_mfma_f32_16x16x32_bf16 v[196:199], a[76:79], a[12:15], v[196:199]
ds_read_b64_tr_b16 a[116:117], v20 offset:34816
v_cmp_gt_i32 s[22:23], 19, v13
v_mfma_f32_16x16x32_bf16 v[196:199], a[72:75], a[8:11], v[196:199]
ds_read_b64_tr_b16 a[118:119], v20 offset:35072
v_cmp_gt_i32 s[26:27], 32, v13
v_mfma_f32_16x16x32_bf16 v[188:191], a[72:75], a[0:3], v[188:191]
v_cmp_gt_i32 s[56:57], 33, v13
v_cmp_gt_i32 s[58:59], 34, v13
v_mfma_f32_16x16x32_bf16 v[188:191], a[76:79], a[4:7], v[188:191]
s_waitcnt lgkmcnt(7)
buffer_load_dwordx4 v16, s[32:35], s64 offen offset:3072 sc1 lds
v_mfma_f32_16x16x32_bf16 v[216:219], a[4:7], a[84:87], v[216:219]
ds_read_b64_tr_b16 a[72:73], v4 offset:32768
v_cmp_gt_i32 s[60:61], 35, v13
v_mfma_f32_16x16x32_bf16 v[216:219], a[0:3], a[80:83], v[216:219]
ds_read_b64_tr_b16 a[74:75], v4 offset:33792
v_add_u32 v21, 0x8000, v21
v_mfma_f32_16x16x32_bf16 v[224:227], a[8:11], a[80:83], v[224:227]
ds_read_b64_tr_b16 a[76:77], v4 offset:40960
v_cmp_gt_i32 s[62:63], 48, v13
v_mfma_f32_16x16x32_bf16 v[224:227], a[12:15], a[84:87], v[224:227]
ds_read_b64_tr_b16 a[78:79], v4 offset:41984
v_cmp_gt_i32 s[48:49], 49, v13
v_mfma_f32_16x16x32_bf16 v[232:235], a[20:23], a[84:87], v[232:235]
s_lshr_b32 s64, s76, 1
s_add_u32 m0, s64, 81920
s_and_b32 s69, s64, 8192
s_add_u32 s64, s64, s69
s_add_u32 s64, s64, 8192
v_cmp_gt_i32 s[50:51], 50, v13
v_cmp_gt_i32 s[100:101], 51, v13
v_mfma_f32_16x16x32_bf16 v[232:235], a[16:19], a[80:83], v[232:235]
buffer_load_dwordx4 v16, s[32:35], s64 offen offset:0 sc1 lds
v_mfma_f32_16x16x32_bf16 v[240:243], a[24:27], a[80:83], v[240:243]
v_lshlrev_b32 v14, 7, v0
v_mfma_f32_16x16x32_bf16 v[240:243], a[28:31], a[84:87], v[240:243]
s_lshl2_add_u32 s66, s2, s30
ds_read_b64_tr_b16 a[80:81], v5 offset:32768
v_mfma_f32_16x16x32_bf16 v[252:255], a[68:71], a[92:95], v[252:255]
s_lshl_b32 s67, s66, 13
ds_read_b64_tr_b16 a[82:83], v5 offset:33792
v_mfma_f32_16x16x32_bf16 v[252:255], a[64:67], a[88:91], v[252:255]
ds_read_b64_tr_b16 a[84:85], v5 offset:40960
v_add_u32 v13, s67, v14
v_mfma_f32_16x16x32_bf16 v[244:247], a[24:27], a[96:99], v[244:247]
ds_read_b64_tr_b16 a[86:87], v5 offset:41984
v_and_b32 v14, 0x7ff, v14
v_mfma_f32_16x16x32_bf16 v[244:247], a[28:31], a[100:103], v[244:247]
s_lshl_b32 s67, s66, 11
buffer_load_dwordx4 v16, s[32:35], s64 offen offset:1024 sc1 lds
v_mfma_f32_16x16x32_bf16 v[236:239], a[20:23], a[100:103], v[236:239]
ds_read_b64_tr_b16 a[88:89], v6 offset:32768
v_add_u32 v19, 0x8000, v19
v_mfma_f32_16x16x32_bf16 v[236:239], a[16:19], a[96:99], v[236:239]
ds_read_b64_tr_b16 a[90:91], v6 offset:33792
v_add_u32 v14, s67, v14
v_mfma_f32_16x16x32_bf16 v[228:231], a[8:11], a[96:99], v[228:231]
s_lshl_b32 s66, s30, 11
ds_read_b64_tr_b16 a[92:93], v6 offset:40960
v_mfma_f32_16x16x32_bf16 v[228:231], a[12:15], a[100:103], v[228:231]
s_add_u32 s66, s66, 32768
ds_read_b64_tr_b16 a[94:95], v6 offset:41984
v_mfma_f32_16x16x32_bf16 v[220:223], a[4:7], a[100:103], v[220:223]
v_add_u32 v22, s66, v16
v_mfma_f32_16x16x32_bf16 v[220:223], a[0:3], a[96:99], v[220:223]
s_waitcnt lgkmcnt(7)
buffer_load_dwordx4 v16, s[32:35], s64 offen offset:2048 sc1 lds
v_mfma_f32_16x16x32_bf16 v[152:155], a[104:107], a[0:3], v[152:155]
ds_read_b64_tr_b16 a[96:97], v7 offset:32768
v_add_u32 v23, 0x10000, v22
v_mfma_f32_16x16x32_bf16 v[152:155], a[108:111], a[4:7], v[152:155]
s_lshr_b32 s66, s30, 1
ds_read_b64_tr_b16 a[98:99], v7 offset:33792
v_add_u32 v20, 0x8000, v20
v_mfma_f32_16x16x32_bf16 v[160:163], a[108:111], a[12:15], v[160:163]
s_lshl_b32 s66, s66, 16
ds_read_b64_tr_b16 a[100:101], v7 offset:40960
v_mfma_f32_16x16x32_bf16 v[160:163], a[104:107], a[8:11], v[160:163]
s_and_b32 s67, s30, 1
ds_read_b64_tr_b16 a[102:103], v7 offset:41984
v_mfma_f32_16x16x32_bf16 v[168:171], a[104:107], a[16:19], v[168:171]
s_lshl3_add_u32 s66, s67, s66
v_mfma_f32_16x16x32_bf16 v[168:171], a[108:111], a[20:23], v[168:171]
s_add_u32 s66, s66, 32768
buffer_load_dwordx4 v16, s[32:35], s64 offen offset:3072 sc1 lds
v_mfma_f32_16x16x32_bf16 v[176:179], a[108:111], a[28:31], v[176:179]
v_add_u32 v15, s66, v16
v_mfma_f32_16x16x32_bf16 v[176:179], a[104:107], a[24:27], v[176:179]
ds_read_b64_tr_b16 a[104:105], v8 offset:32768
v_and_b32 v1, 15, v0
v_mfma_f32_16x16x32_bf16 v[180:183], a[112:115], a[24:27], v[180:183]
ds_read_b64_tr_b16 a[106:107], v8 offset:33792
v_lshlrev_b32 v1, 3, v1
v_mfma_f32_16x16x32_bf16 v[180:183], a[116:119], a[28:31], v[180:183]
s_lshl_b32 s66, s30, 7
ds_read_b64_tr_b16 a[108:109], v8 offset:40960
v_add_u32 v4, 0x8000, v4
v_mfma_f32_16x16x32_bf16 v[172:175], a[116:119], a[20:23], v[172:175]
s_add_u32 s66, s66, 58720256
ds_read_b64_tr_b16 a[110:111], v8 offset:41984
v_mfma_f32_16x16x32_bf16 v[172:175], a[112:115], a[16:19], v[172:175]
s_lshl_b32 s67, s3, 10
v_mfma_f32_16x16x32_bf16 v[164:167], a[112:115], a[8:11], v[164:167]
s_add_u32 s67, s67, s66
v_mfma_f32_16x16x32_bf16 v[164:167], a[116:119], a[12:15], v[164:167]
s_lshl_b32 s68, s16, 10
s_add_u32 s17, s78, .-L_pc+6144
v_mfma_f32_16x16x32_bf16 v[156:159], a[116:119], a[4:7], v[156:159]
s_add_u32 s68, s68, s66
buffer_load_dword a252, v16, s[88:91], s17 offen
v_mfma_f32_16x16x32_bf16 v[156:159], a[112:115], a[0:3], v[156:159]
ds_read_b64_tr_b16 a[112:113], v9 offset:32768
v_mfma_f32_16x16x32_bf16 v[24:27], a[72:75], a[0:3], v[24:27]
ds_read_b64_tr_b16 a[114:115], v9 offset:33792
v_mfma_f32_16x16x32_bf16 v[24:27], a[76:79], a[4:7], v[24:27]
ds_read_b64_tr_b16 a[116:117], v9 offset:40960
v_add_u32 v5, 0x8000, v5
v_mfma_f32_16x16x32_bf16 v[40:43], a[76:79], a[12:15], v[40:43]
s_waitcnt vmcnt(13)
ds_read_b64_tr_b16 a[118:119], v9 offset:41984
v_mfma_f32_16x16x32_bf16 v[40:43], a[72:75], a[8:11], v[40:43]
ds_read_b128 a[32:35], v2 offset:32768
v_mfma_f32_16x16x32_bf16 v[56:59], a[72:75], a[16:19], v[56:59]
ds_read_b128 a[36:39], v3 offset:32768
v_mfma_f32_16x16x32_bf16 v[56:59], a[76:79], a[20:23], v[56:59]
s_add_u32 s17, s78, .-L_pc+9728
ds_read_b128 a[40:43], v2 offset:34816
v_mfma_f32_16x16x32_bf16 v[72:75], a[76:79], a[28:31], v[72:75]
buffer_load_dword a252, v16, s[88:91], s17 offen
v_mfma_f32_16x16x32_bf16 v[72:75], a[72:75], a[24:27], v[72:75]
s_waitcnt lgkmcnt(7)
ds_read_b128 a[44:47], v3 offset:34816
v_mfma_f32_16x16x32_bf16 v[136:139], a[80:83], a[24:27], v[136:139]
ds_read_b128 a[48:51], v2 offset:36864
v_mfma_f32_16x16x32_bf16 v[136:139], a[84:87], a[28:31], v[136:139]
ds_read_b128 a[52:55], v3 offset:36864
v_add_u32 v6, 0x8000, v6
v_mfma_f32_16x16x32_bf16 v[120:123], a[84:87], a[20:23], v[120:123]
ds_read_b128 a[56:59], v2 offset:38912
v_mfma_f32_16x16x32_bf16 v[120:123], a[80:83], a[16:19], v[120:123]
ds_read_b128 a[60:63], v3 offset:38912
v_mfma_f32_16x16x32_bf16 v[104:107], a[80:83], a[8:11], v[104:107]
ds_read_b64_tr_b16 a[72:73], v10 offset:32768
v_mfma_f32_16x16x32_bf16 v[104:107], a[84:87], a[12:15], v[104:107]
s_add_u32 s17, s78, .-L_pc+13312
ds_read_b64_tr_b16 a[74:75], v10 offset:33792
v_mfma_f32_16x16x32_bf16 v[88:91], a[84:87], a[4:7], v[88:91]
buffer_load_dword a252, v16, s[88:91], s17 offen
v_mfma_f32_16x16x32_bf16 v[88:91], a[80:83], a[0:3], v[88:91]
ds_read_b64_tr_b16 a[76:77], v10 offset:40960
v_mfma_f32_16x16x32_bf16 v[28:31], a[88:91], a[0:3], v[28:31]
ds_read_b64_tr_b16 a[78:79], v10 offset:41984
v_mfma_f32_16x16x32_bf16 v[28:31], a[92:95], a[4:7], v[28:31]
ds_read_b64_tr_b16 a[80:81], v11 offset:32768
v_add_u32 v7, 0x8000, v7
v_mfma_f32_16x16x32_bf16 v[44:47], a[92:95], a[12:15], v[44:47]
ds_read_b64_tr_b16 a[82:83], v11 offset:33792
v_mfma_f32_16x16x32_bf16 v[44:47], a[88:91], a[8:11], v[44:47]
ds_read_b64_tr_b16 a[84:85], v11 offset:40960
v_mfma_f32_16x16x32_bf16 v[60:63], a[88:91], a[16:19], v[60:63]
ds_read_b64_tr_b16 a[86:87], v11 offset:41984
v_mfma_f32_16x16x32_bf16 v[60:63], a[92:95], a[20:23], v[60:63]
v_mfma_f32_16x16x32_bf16 v[76:79], a[92:95], a[28:31], v[76:79]
v_mfma_f32_16x16x32_bf16 v[76:79], a[88:91], a[24:27], v[76:79]
v_mfma_f32_16x16x32_bf16 v[140:143], a[96:99], a[24:27], v[140:143]
v_mfma_f32_16x16x32_bf16 v[140:143], a[100:103], a[28:31], v[140:143]
v_add_u32 v8, 0x8000, v8
v_mfma_f32_16x16x32_bf16 v[124:127], a[100:103], a[20:23], v[124:127]
v_mfma_f32_16x16x32_bf16 v[124:127], a[96:99], a[16:19], v[124:127]
v_mfma_f32_16x16x32_bf16 v[108:111], a[96:99], a[8:11], v[108:111]
v_mfma_f32_16x16x32_bf16 v[108:111], a[100:103], a[12:15], v[108:111]
v_mfma_f32_16x16x32_bf16 v[92:95], a[100:103], a[4:7], v[92:95]
v_add_u32 v9, 0x8000, v9
v_add_u32 v10, 0x8000, v10
v_mfma_f32_16x16x32_bf16 v[92:95], a[96:99], a[0:3], v[92:95]
v_add_u32 v11, 0x8000, v11
v_mfma_f32_16x16x32_bf16 v[32:35], a[104:107], a[0:3], v[32:35]
v_mfma_f32_16x16x32_bf16 v[32:35], a[108:111], a[4:7], v[32:35]
v_mfma_f32_16x16x32_bf16 v[48:51], a[108:111], a[12:15], v[48:51]
s_waitcnt lgkmcnt(0)
s_barrier
v_mfma_f32_16x16x32_bf16 v[48:51], a[104:107], a[8:11], v[48:51]
ds_read_b64_tr_b16 a[88:89], v19 offset:36864
v_mfma_f32_16x16x32_bf16 v[64:67], a[104:107], a[16:19], v[64:67]
ds_read_b64_tr_b16 a[90:91], v19 offset:37120
v_mfma_f32_16x16x32_bf16 v[64:67], a[108:111], a[20:23], v[64:67]
ds_read_b64_tr_b16 a[92:93], v19 offset:38912
v_mfma_f32_16x16x32_bf16 v[80:83], a[108:111], a[28:31], v[80:83]
ds_read_b64_tr_b16 a[94:95], v19 offset:39168
v_mfma_f32_16x16x32_bf16 v[80:83], a[104:107], a[24:27], v[80:83]
ds_read_b128 a[64:67], v17 offset:32768
v_mfma_f32_16x16x32_bf16 v[144:147], a[112:115], a[24:27], v[144:147]
ds_read_b128 a[68:71], v18 offset:32768
v_mfma_f32_16x16x32_bf16 v[144:147], a[116:119], a[28:31], v[144:147]
ds_read_b64_tr_b16 a[96:97], v21 offset:36864
v_mfma_f32_16x16x32_bf16 v[128:131], a[116:119], a[20:23], v[128:131]
ds_read_b64_tr_b16 a[98:99], v21 offset:37120
v_mfma_f32_16x16x32_bf16 v[128:131], a[112:115], a[16:19], v[128:131]
ds_read_b64_tr_b16 a[100:101], v21 offset:38912
v_mfma_f32_16x16x32_bf16 v[112:115], a[112:115], a[8:11], v[112:115]
ds_read_b64_tr_b16 a[102:103], v21 offset:39168
v_mfma_f32_16x16x32_bf16 v[112:115], a[116:119], a[12:15], v[112:115]
ds_read_b64_tr_b16 a[104:105], v20 offset:36864
v_mfma_f32_16x16x32_bf16 v[96:99], a[116:119], a[4:7], v[96:99]
ds_read_b64_tr_b16 a[106:107], v20 offset:37120
v_mfma_f32_16x16x32_bf16 v[96:99], a[112:115], a[0:3], v[96:99]
ds_read_b64_tr_b16 a[108:109], v20 offset:38912
v_mfma_f32_16x16x32_bf16 v[36:39], a[72:75], a[0:3], v[36:39]
ds_read_b64_tr_b16 a[110:111], v20 offset:39168
v_mfma_f32_16x16x32_bf16 v[36:39], a[76:79], a[4:7], v[36:39]
buffer_load_dwordx2 a[232:233], v1, s[44:47], s67 offen offset:0 sc1
v_mfma_f32_16x16x32_bf16 v[52:55], a[76:79], a[12:15], v[52:55]
ds_read_b64_tr_b16 a[112:113], v19 offset:40960
v_mfma_f32_16x16x32_bf16 v[52:55], a[72:75], a[8:11], v[52:55]
buffer_load_dwordx2 a[234:235], v1, s[44:47], s67 offen offset:512 sc1
v_mfma_f32_16x16x32_bf16 v[68:71], a[72:75], a[16:19], v[68:71]
ds_read_b64_tr_b16 a[114:115], v19 offset:41216
v_mfma_f32_16x16x32_bf16 v[68:71], a[76:79], a[20:23], v[68:71]
buffer_load_dwordx2 a[236:237], v1, s[44:47], s68 offen offset:0 sc1
v_mfma_f32_16x16x32_bf16 v[84:87], a[76:79], a[28:31], v[84:87]
ds_read_b64_tr_b16 a[116:117], v19 offset:43008
v_mfma_f32_16x16x32_bf16 v[84:87], a[72:75], a[24:27], v[84:87]
buffer_load_dwordx2 a[238:239], v1, s[44:47], s68 offen offset:512 sc1
v_mfma_f32_16x16x32_bf16 v[148:151], a[80:83], a[24:27], v[148:151]
ds_read_b64_tr_b16 a[118:119], v19 offset:43264
v_mfma_f32_16x16x32_bf16 v[148:151], a[84:87], a[28:31], v[148:151]
ds_read_b64_tr_b16 a[72:73], v21 offset:40960
v_mfma_f32_16x16x32_bf16 v[132:135], a[84:87], a[20:23], v[132:135]
ds_read_b64_tr_b16 a[74:75], v21 offset:41216
v_mfma_f32_16x16x32_bf16 v[132:135], a[80:83], a[16:19], v[132:135]
ds_read_b64_tr_b16 a[76:77], v21 offset:43008
v_mfma_f32_16x16x32_bf16 v[116:119], a[80:83], a[8:11], v[116:119]
ds_read_b64_tr_b16 a[78:79], v21 offset:43264
v_mfma_f32_16x16x32_bf16 v[116:119], a[84:87], a[12:15], v[116:119]
v_mfma_f32_16x16x32_bf16 v[100:103], a[84:87], a[4:7], v[100:103]
v_mfma_f32_16x16x32_bf16 v[100:103], a[80:83], a[0:3], v[100:103]
s_waitcnt lgkmcnt(6)
ds_read_b64_tr_b16 a[80:81], v20 offset:40960
v_mfma_f32_16x16x32_bf16 v[184:187], a[88:91], a[32:35], v[184:187]
global_load_dword a252, v13, s[14:15]
v_mfma_f32_16x16x32_bf16 v[184:187], a[92:95], a[36:39], v[184:187]
ds_read_b64_tr_b16 a[82:83], v20 offset:41216
v_mfma_f32_16x16x32_bf16 v[192:195], a[92:95], a[44:47], v[192:195]
ds_read_b64_tr_b16 a[84:85], v20 offset:43008
v_mfma_f32_16x16x32_bf16 v[192:195], a[88:91], a[40:43], v[192:195]
ds_read_b64_tr_b16 a[86:87], v20 offset:43264
v_mfma_f32_16x16x32_bf16 v[200:203], a[88:91], a[48:51], v[200:203]
global_load_dword a252, v14, s[20:21]
v_mfma_f32_16x16x32_bf16 v[200:203], a[92:95], a[52:55], v[200:203]
v_mfma_f32_16x16x32_bf16 v[208:211], a[92:95], a[60:63], v[208:211]
v_mfma_f32_16x16x32_bf16 v[208:211], a[88:91], a[56:59], v[208:211]
ds_read_b64_tr_b16 a[88:89], v19 offset:32768
v_mfma_f32_16x16x32_bf16 v[248:251], a[96:99], a[64:67], v[248:251]
ds_read_b64_tr_b16 a[90:91], v19 offset:33024
v_mfma_f32_16x16x32_bf16 v[248:251], a[100:103], a[68:71], v[248:251]
ds_read_b64_tr_b16 a[92:93], v19 offset:34816
v_mfma_f32_16x16x32_bf16 v[212:215], a[108:111], a[60:63], v[212:215]
ds_read_b64_tr_b16 a[94:95], v19 offset:35072
v_mfma_f32_16x16x32_bf16 v[212:215], a[104:107], a[56:59], v[212:215]
ds_read_b64_tr_b16 a[96:97], v20 offset:32768
v_mfma_f32_16x16x32_bf16 v[204:207], a[104:107], a[48:51], v[204:207]
ds_read_b64_tr_b16 a[98:99], v20 offset:33024
v_mfma_f32_16x16x32_bf16 v[204:207], a[108:111], a[52:55], v[204:207]
ds_read_b64_tr_b16 a[100:101], v20 offset:34816
v_mfma_f32_16x16x32_bf16 v[196:199], a[108:111], a[44:47], v[196:199]
ds_read_b64_tr_b16 a[102:103], v20 offset:35072
v_mfma_f32_16x16x32_bf16 v[196:199], a[104:107], a[40:43], v[196:199]
s_or_b32 s66, s3, s30
s_cmp_eq_u32 s66, 0
s_cselect_b32 s66, 0xff800000, 0
v_mfma_f32_16x16x32_bf16 v[188:191], a[104:107], a[32:35], v[188:191]
v_mfma_f32_16x16x32_bf16 v[188:191], a[108:111], a[36:39], v[188:191]
s_waitcnt lgkmcnt(7)
ds_read_b64_tr_b16 a[104:105], v4 offset:32768
v_cvt_pk_bf16_f32 v248, v248, v249
v_mfma_f32_16x16x32_bf16 v[216:219], a[36:39], a[116:119], v[216:219]
ds_read_b64_tr_b16 a[106:107], v4 offset:33792
v_cvt_pk_bf16_f32 v249, v250, v251
v_mfma_f32_16x16x32_bf16 v[216:219], a[32:35], a[112:115], v[216:219]
ds_read_b64_tr_b16 a[108:109], v4 offset:40960
v_mfma_f32_16x16x32_bf16 v[224:227], a[40:43], a[112:115], v[224:227]
ds_read_b64_tr_b16 a[110:111], v4 offset:41984
v_mfma_f32_16x16x32_bf16 v[224:227], a[44:47], a[116:119], v[224:227]
ds_write_b64 v15, v[248:249]
v_mfma_f32_16x16x32_bf16 v[232:235], a[52:55], a[116:119], v[232:235]
v_cvt_pk_bf16_f32 v208, v208, v209
v_cvt_pk_bf16_f32 v209, v210, v211
v_mfma_f32_16x16x32_bf16 v[232:235], a[48:51], a[112:115], v[232:235]
v_cvt_pk_bf16_f32 v210, v212, v213
v_cvt_pk_bf16_f32 v211, v214, v215
v_mfma_f32_16x16x32_bf16 v[240:243], a[56:59], a[112:115], v[240:243]
ds_write_b128 v23, v[208:211] offset:10240
v_mfma_f32_16x16x32_bf16 v[240:243], a[60:63], a[116:119], v[240:243]
ds_read_b64_tr_b16 a[112:113], v5 offset:32768
v_cvt_pk_bf16_f32 v200, v200, v201
v_mfma_f32_16x16x32_bf16 v[252:255], a[68:71], a[76:79], v[252:255]
ds_read_b64_tr_b16 a[114:115], v5 offset:33792
v_cvt_pk_bf16_f32 v201, v202, v203
v_mfma_f32_16x16x32_bf16 v[252:255], a[64:67], a[72:75], v[252:255]
ds_read_b64_tr_b16 a[116:117], v5 offset:40960
v_cvt_pk_bf16_f32 v202, v204, v205
v_mfma_f32_16x16x32_bf16 v[244:247], a[56:59], a[80:83], v[244:247]
ds_read_b64_tr_b16 a[118:119], v5 offset:41984
v_cvt_pk_bf16_f32 v203, v206, v207
v_mfma_f32_16x16x32_bf16 v[244:247], a[60:63], a[84:87], v[244:247]
ds_read_b64_tr_b16 a[72:73], v6 offset:32768
v_mfma_f32_16x16x32_bf16 v[236:239], a[52:55], a[84:87], v[236:239]
ds_read_b64_tr_b16 a[74:75], v6 offset:33792
v_mfma_f32_16x16x32_bf16 v[236:239], a[48:51], a[80:83], v[236:239]
ds_read_b64_tr_b16 a[76:77], v6 offset:40960
v_mfma_f32_16x16x32_bf16 v[228:231], a[40:43], a[80:83], v[228:231]
ds_read_b64_tr_b16 a[78:79], v6 offset:41984
v_mfma_f32_16x16x32_bf16 v[228:231], a[44:47], a[84:87], v[228:231]
ds_write_b128 v23, v[200:203] offset:2048
v_mfma_f32_16x16x32_bf16 v[220:223], a[36:39], a[84:87], v[220:223]
v_cvt_pk_bf16_f32 v192, v192, v193
v_cvt_pk_bf16_f32 v193, v194, v195
v_mfma_f32_16x16x32_bf16 v[220:223], a[32:35], a[80:83], v[220:223]
s_waitcnt lgkmcnt(8)
ds_read_b64_tr_b16 a[80:81], v7 offset:32768
v_cvt_pk_bf16_f32 v194, v196, v197
v_mfma_f32_16x16x32_bf16 v[152:155], a[88:91], a[32:35], v[152:155]
ds_read_b64_tr_b16 a[82:83], v7 offset:33792
v_cvt_pk_bf16_f32 v195, v198, v199
v_mfma_f32_16x16x32_bf16 v[152:155], a[92:95], a[36:39], v[152:155]
ds_read_b64_tr_b16 a[84:85], v7 offset:40960
v_mfma_f32_16x16x32_bf16 v[160:163], a[92:95], a[44:47], v[160:163]
ds_read_b64_tr_b16 a[86:87], v7 offset:41984
v_mfma_f32_16x16x32_bf16 v[160:163], a[88:91], a[40:43], v[160:163]
ds_write_b128 v22, v[192:195] offset:10240
v_mfma_f32_16x16x32_bf16 v[168:171], a[88:91], a[48:51], v[168:171]
v_cvt_pk_bf16_f32 v184, v184, v185
v_cvt_pk_bf16_f32 v185, v186, v187
v_mfma_f32_16x16x32_bf16 v[168:171], a[92:95], a[52:55], v[168:171]
v_cvt_pk_bf16_f32 v186, v188, v189
v_cvt_pk_bf16_f32 v187, v190, v191
v_mfma_f32_16x16x32_bf16 v[176:179], a[92:95], a[60:63], v[176:179]
ds_write_b128 v22, v[184:187] offset:2048
v_mfma_f32_16x16x32_bf16 v[176:179], a[88:91], a[56:59], v[176:179]
ds_read_b64_tr_b16 a[88:89], v8 offset:32768
v_cvt_pk_bf16_f32 v252, v252, v253
v_mfma_f32_16x16x32_bf16 v[180:183], a[96:99], a[56:59], v[180:183]
ds_read_b64_tr_b16 a[90:91], v8 offset:33792
v_cvt_pk_bf16_f32 v253, v254, v255
v_mfma_f32_16x16x32_bf16 v[180:183], a[100:103], a[60:63], v[180:183]
ds_read_b64_tr_b16 a[92:93], v8 offset:40960
v_mfma_f32_16x16x32_bf16 v[172:175], a[100:103], a[52:55], v[172:175]
ds_read_b64_tr_b16 a[94:95], v8 offset:41984
v_mfma_f32_16x16x32_bf16 v[172:175], a[96:99], a[48:51], v[172:175]
ds_write_b64 v15, v[252:253] offset:1024
v_mfma_f32_16x16x32_bf16 v[164:167], a[96:99], a[40:43], v[164:167]
v_cvt_pk_bf16_f32 v243, v242, v243
v_cvt_pk_bf16_f32 v242, v240, v241
v_mfma_f32_16x16x32_bf16 v[164:167], a[100:103], a[44:47], v[164:167]
v_cvt_pk_bf16_f32 v247, v246, v247
v_cvt_pk_bf16_f32 v246, v244, v245
v_mfma_f32_16x16x32_bf16 v[156:159], a[100:103], a[36:39], v[156:159]
ds_write_b64 v23, v[242:243] offset:11264
v_mfma_f32_16x16x32_bf16 v[156:159], a[96:99], a[32:35], v[156:159]
ds_read_b64_tr_b16 a[96:97], v9 offset:32768
v_mfma_f32_16x16x32_bf16 v[24:27], a[104:107], a[32:35], v[24:27]
ds_read_b64_tr_b16 a[98:99], v9 offset:33792
v_mfma_f32_16x16x32_bf16 v[24:27], a[108:111], a[36:39], v[24:27]
ds_read_b64_tr_b16 a[100:101], v9 offset:40960
v_mfma_f32_16x16x32_bf16 v[40:43], a[108:111], a[44:47], v[40:43]
ds_read_b64_tr_b16 a[102:103], v9 offset:41984
v_mfma_f32_16x16x32_bf16 v[40:43], a[104:107], a[40:43], v[40:43]
ds_write_b64 v23, v[246:247] offset:11272
v_mfma_f32_16x16x32_bf16 v[56:59], a[104:107], a[48:51], v[56:59]
v_cvt_pk_bf16_f32 v235, v234, v235
v_cvt_pk_bf16_f32 v234, v232, v233
v_mfma_f32_16x16x32_bf16 v[56:59], a[108:111], a[52:55], v[56:59]
v_cvt_pk_bf16_f32 v239, v238, v239
v_cvt_pk_bf16_f32 v238, v236, v237
v_mfma_f32_16x16x32_bf16 v[72:75], a[108:111], a[60:63], v[72:75]
ds_write_b64 v23, v[234:235] offset:3072
v_mfma_f32_16x16x32_bf16 v[72:75], a[104:107], a[56:59], v[72:75]
s_waitcnt lgkmcnt(7)
ds_read_b64_tr_b16 a[104:105], v10 offset:32768
v_mfma_f32_16x16x32_bf16 v[136:139], a[112:115], a[56:59], v[136:139]
ds_read_b64_tr_b16 a[106:107], v10 offset:33792
v_mfma_f32_16x16x32_bf16 v[136:139], a[116:119], a[60:63], v[136:139]
ds_read_b64_tr_b16 a[108:109], v10 offset:40960
v_mfma_f32_16x16x32_bf16 v[120:123], a[116:119], a[52:55], v[120:123]
ds_read_b64_tr_b16 a[110:111], v10 offset:41984
v_mfma_f32_16x16x32_bf16 v[120:123], a[112:115], a[48:51], v[120:123]
ds_write_b64 v23, v[238:239] offset:3080
v_mfma_f32_16x16x32_bf16 v[104:107], a[112:115], a[40:43], v[104:107]
v_cvt_pk_bf16_f32 v227, v226, v227
v_cvt_pk_bf16_f32 v226, v224, v225
v_mfma_f32_16x16x32_bf16 v[104:107], a[116:119], a[44:47], v[104:107]
v_cvt_pk_bf16_f32 v231, v230, v231
v_cvt_pk_bf16_f32 v230, v228, v229
v_mfma_f32_16x16x32_bf16 v[88:91], a[116:119], a[36:39], v[88:91]
ds_write_b64 v22, v[226:227] offset:11264
v_mfma_f32_16x16x32_bf16 v[88:91], a[112:115], a[32:35], v[88:91]
ds_read_b64_tr_b16 a[112:113], v11 offset:32768
v_mfma_f32_16x16x32_bf16 v[28:31], a[72:75], a[32:35], v[28:31]
ds_read_b64_tr_b16 a[114:115], v11 offset:33792
v_mfma_f32_16x16x32_bf16 v[28:31], a[76:79], a[36:39], v[28:31]
ds_read_b64_tr_b16 a[116:117], v11 offset:40960
v_mfma_f32_16x16x32_bf16 v[44:47], a[76:79], a[44:47], v[44:47]
ds_read_b64_tr_b16 a[118:119], v11 offset:41984
v_mfma_f32_16x16x32_bf16 v[44:47], a[72:75], a[40:43], v[44:47]
ds_write_b64 v22, v[230:231] offset:11272
v_mfma_f32_16x16x32_bf16 v[60:63], a[72:75], a[48:51], v[60:63]
v_cvt_pk_bf16_f32 v219, v218, v219
v_cvt_pk_bf16_f32 v218, v216, v217
v_mfma_f32_16x16x32_bf16 v[60:63], a[76:79], a[52:55], v[60:63]
v_cvt_pk_bf16_f32 v223, v222, v223
v_cvt_pk_bf16_f32 v222, v220, v221
v_mfma_f32_16x16x32_bf16 v[76:79], a[76:79], a[60:63], v[76:79]
ds_write_b64 v22, v[218:219] offset:3072
v_mfma_f32_16x16x32_bf16 v[76:79], a[72:75], a[56:59], v[76:79]
ds_write_b64 v22, v[222:223] offset:3080
v_mfma_f32_16x16x32_bf16 v[140:143], a[80:83], a[56:59], v[140:143]
v_cvt_pk_bf16_f32 v176, v176, v177
v_cvt_pk_bf16_f32 v177, v178, v179
v_mfma_f32_16x16x32_bf16 v[140:143], a[84:87], a[60:63], v[140:143]
v_cvt_pk_bf16_f32 v178, v180, v181
v_cvt_pk_bf16_f32 v179, v182, v183
v_mfma_f32_16x16x32_bf16 v[124:127], a[84:87], a[52:55], v[124:127]
v_cvt_pk_bf16_f32 v168, v168, v169
v_cvt_pk_bf16_f32 v169, v170, v171
v_mfma_f32_16x16x32_bf16 v[124:127], a[80:83], a[48:51], v[124:127]
v_cvt_pk_bf16_f32 v170, v172, v173
v_cvt_pk_bf16_f32 v171, v174, v175
v_mfma_f32_16x16x32_bf16 v[108:111], a[80:83], a[40:43], v[108:111]
s_waitcnt lgkmcnt(0)
s_barrier
v_mfma_f32_16x16x32_bf16 v[108:111], a[84:87], a[44:47], v[108:111]
v_cvt_pk_bf16_f32 v160, v160, v161
v_cvt_pk_bf16_f32 v161, v162, v163
v_mfma_f32_16x16x32_bf16 v[92:95], a[84:87], a[36:39], v[92:95]
v_cvt_pk_bf16_f32 v162, v164, v165
v_cvt_pk_bf16_f32 v163, v166, v167
v_mfma_f32_16x16x32_bf16 v[92:95], a[80:83], a[32:35], v[92:95]
v_cvt_pk_bf16_f32 v152, v152, v153
v_cvt_pk_bf16_f32 v153, v154, v155
v_mfma_f32_16x16x32_bf16 v[32:35], a[88:91], a[32:35], v[32:35]
v_cvt_pk_bf16_f32 v154, v156, v157
v_cvt_pk_bf16_f32 v155, v158, v159
v_mfma_f32_16x16x32_bf16 v[32:35], a[92:95], a[36:39], v[32:35]
ds_read_b128 a[0:3], v22 offset:0
v_subrev_u32 v13, 0, v12
v_mfma_f32_16x16x32_bf16 v[48:51], a[92:95], a[44:47], v[48:51]
v_lshlrev_b32 v14, 31, v13
v_mfma_f32_16x16x32_bf16 v[48:51], a[88:91], a[40:43], v[48:51]
ds_read_b128 a[4:7], v22 offset:8192
v_or_b32 v17, v13, v14
v_mfma_f32_16x16x32_bf16 v[64:67], a[88:91], a[48:51], v[64:67]
v_ashrrev_i32 v17, 31, v17
v_mfma_f32_16x16x32_bf16 v[64:67], a[92:95], a[52:55], v[64:67]
ds_read_b128 a[8:11], v23 offset:0
v_and_b32 v248, 0xff800000, v17
v_mfma_f32_16x16x32_bf16 v[80:83], a[92:95], a[60:63], v[80:83]
v_not_b32 v13, v13
v_mfma_f32_16x16x32_bf16 v[80:83], a[88:91], a[56:59], v[80:83]
ds_read_b128 a[12:15], v23 offset:8192
v_or_b32 v17, v13, v14
v_mfma_f32_16x16x32_bf16 v[144:147], a[96:99], a[56:59], v[144:147]
v_ashrrev_i32 v17, 31, v17
v_mfma_f32_16x16x32_bf16 v[144:147], a[100:103], a[60:63], v[144:147]
ds_read_b64 v[216:217], v22 offset:1024
v_and_b32 v252, 0xff800000, v17
v_mfma_f32_16x16x32_bf16 v[128:131], a[100:103], a[52:55], v[128:131]
v_or_b32 v18, s66, v252
v_mfma_f32_16x16x32_bf16 v[128:131], a[96:99], a[48:51], v[128:131]
ds_read_b64 v[220:221], v22 offset:1032
v_subrev_u32 v13, 1, v12
v_mfma_f32_16x16x32_bf16 v[112:115], a[96:99], a[40:43], v[112:115]
v_lshlrev_b32 v14, 31, v13
v_mfma_f32_16x16x32_bf16 v[112:115], a[100:103], a[44:47], v[112:115]
ds_read_b64 v[224:225], v22 offset:9216
v_or_b32 v17, v13, v14
v_mfma_f32_16x16x32_bf16 v[96:99], a[100:103], a[36:39], v[96:99]
v_ashrrev_i32 v17, 31, v17
v_mfma_f32_16x16x32_bf16 v[96:99], a[96:99], a[32:35], v[96:99]
ds_read_b64 v[228:229], v22 offset:9224
v_and_b32 v249, 0xff800000, v17
v_mfma_f32_16x16x32_bf16 v[36:39], a[104:107], a[32:35], v[36:39]
v_not_b32 v13, v13
v_mfma_f32_16x16x32_bf16 v[36:39], a[108:111], a[36:39], v[36:39]
ds_read_b64 v[232:233], v23 offset:1024
v_or_b32 v17, v13, v14
v_mfma_f32_16x16x32_bf16 v[52:55], a[108:111], a[44:47], v[52:55]
v_ashrrev_i32 v17, 31, v17
v_mfma_f32_16x16x32_bf16 v[52:55], a[104:107], a[40:43], v[52:55]
ds_read_b64 v[236:237], v23 offset:1032
v_and_b32 v253, 0xff800000, v17
v_mfma_f32_16x16x32_bf16 v[68:71], a[104:107], a[48:51], v[68:71]
v_or_b32 v19, s66, v253
v_mfma_f32_16x16x32_bf16 v[68:71], a[108:111], a[52:55], v[68:71]
ds_read_b64 v[240:241], v23 offset:9216
v_subrev_u32 v13, 2, v12
v_mfma_f32_16x16x32_bf16 v[84:87], a[108:111], a[60:63], v[84:87]
v_lshlrev_b32 v14, 31, v13
v_mfma_f32_16x16x32_bf16 v[84:87], a[104:107], a[56:59], v[84:87]
ds_read_b64 v[244:245], v23 offset:9224
v_or_b32 v17, v13, v14
v_mfma_f32_16x16x32_bf16 v[148:151], a[112:115], a[56:59], v[148:151]
v_ashrrev_i32 v17, 31, v17
v_and_b32 v250, 0xff800000, v17
v_mfma_f32_16x16x32_bf16 v[148:151], a[116:119], a[60:63], v[148:151]
v_not_b32 v13, v13
v_or_b32 v17, v13, v14
v_mfma_f32_16x16x32_bf16 v[132:135], a[116:119], a[52:55], v[132:135]
v_ashrrev_i32 v17, 31, v17
v_and_b32 v254, 0xff800000, v17
v_mfma_f32_16x16x32_bf16 v[132:135], a[112:115], a[48:51], v[132:135]
v_or_b32 v20, s66, v254
v_subrev_u32 v13, 3, v12
v_mfma_f32_16x16x32_bf16 v[116:119], a[112:115], a[40:43], v[116:119]
v_lshlrev_b32 v14, 31, v13
v_or_b32 v17, v13, v14
v_mfma_f32_16x16x32_bf16 v[116:119], a[116:119], a[44:47], v[116:119]
v_ashrrev_i32 v17, 31, v17
v_and_b32 v251, 0xff800000, v17
v_mfma_f32_16x16x32_bf16 v[100:103], a[116:119], a[36:39], v[100:103]
v_not_b32 v13, v13
v_or_b32 v17, v13, v14
v_mfma_f32_16x16x32_bf16 v[100:103], a[112:115], a[32:35], v[100:103]
v_ashrrev_i32 v17, 31, v17
v_and_b32 v255, 0xff800000, v17
v_or_b32 v21, s66, v255
s_mov_b32 s68, 0x3e0293ee
s_mov_b32 s69, s68
s_mov_b32 s66, 0x3e8293ee
v_mfma_f32_16x16x32_bf16 v[188:191], v[184:187], v[152:155], v[248:251]
v_mfma_f32_16x16x32_bf16 v[196:199], v[192:195], v[160:163], v[248:251]
v_mfma_f32_16x16x32_bf16 v[204:207], v[200:203], v[168:171], v[248:251]
v_mfma_f32_16x16x32_bf16 v[212:215], v[208:211], v[176:179], v[248:251]
s_waitcnt lgkmcnt(11)
v_mfma_f32_16x16x32_bf16 v[156:159], a[0:3], v[152:155], v[18:21]
s_waitcnt lgkmcnt(10)
v_mfma_f32_16x16x32_bf16 v[164:167], a[4:7], v[160:163], v[252:255]
s_waitcnt lgkmcnt(9)
v_mfma_f32_16x16x32_bf16 v[172:175], a[8:11], v[168:171], v[252:255]
s_waitcnt lgkmcnt(8)
v_mfma_f32_16x16x32_bf16 v[180:183], a[12:15], v[176:179], v[252:255]
s_waitcnt vmcnt(2)
s_waitcnt vmcnt(3)
s_waitcnt vmcnt(4)
s_waitcnt vmcnt(5)
v_accvgpr_read_b32 v4, a232
v_accvgpr_read_b32 v5, a233
v_accvgpr_read_b32 v6, a234
v_accvgpr_read_b32 v7, a235
v_accvgpr_read_b32 v8, a236
v_accvgpr_read_b32 v9, a237
v_accvgpr_read_b32 v10, a238
v_accvgpr_read_b32 v11, a239
v_pk_mul_f32 v[24:25], v[24:25], s[68:69]
v_pk_mul_f32 v[26:27], v[26:27], s[68:69]
v_pk_mul_f32 v[88:89], v[88:89], s[68:69]
v_pk_mul_f32 v[90:91], v[90:91], s[68:69]
v_cvt_pk_bf16_f32 v24, v24, v25
v_cvt_pk_bf16_f32 v25, v26, v27
v_cvt_pk_bf16_f32 v26, v88, v89
v_cvt_pk_bf16_f32 v27, v90, v91
v_pk_mul_f32 v[40:41], v[40:41], s[68:69]
v_pk_mul_f32 v[42:43], v[42:43], s[68:69]
v_pk_mul_f32 v[104:105], v[104:105], s[68:69]
v_pk_mul_f32 v[106:107], v[106:107], s[68:69]
v_cvt_pk_bf16_f32 v40, v40, v41
v_cvt_pk_bf16_f32 v41, v42, v43
v_cvt_pk_bf16_f32 v42, v104, v105
v_cvt_pk_bf16_f32 v43, v106, v107
v_max3_f32 v12, v188, v189, v190
v_max3_f32 v12, v12, v191, v156
v_max3_f32 v12, v12, v157, v158
v_max_f32 v12, v12, v159
v_max3_f32 v13, v196, v197, v198
v_max3_f32 v13, v13, v199, v164
v_max3_f32 v13, v13, v165, v166
v_max_f32 v13, v13, v167
v_max3_f32 v14, v204, v205, v206
v_max3_f32 v14, v14, v207, v172
v_max3_f32 v14, v14, v173, v174
v_max_f32 v14, v14, v175
v_max3_f32 v15, v212, v213, v214
v_max3_f32 v15, v15, v215, v180
v_max3_f32 v15, v15, v181, v182
v_max_f32 v15, v15, v183
v_mov_b32 v20, v12
v_mov_b32 v21, v13
v_mov_b32 v22, v14
v_mov_b32 v23, v15
v_permlane16_swap_b32 v20, v12
v_permlane16_swap_b32 v21, v13
v_permlane16_swap_b32 v22, v14
v_permlane16_swap_b32 v23, v15
v_max_f32 v12, v12, v20
v_max_f32 v13, v13, v21
v_max_f32 v14, v14, v22
v_max_f32 v15, v15, v23
v_mov_b32 v20, v12
v_mov_b32 v21, v13
v_mov_b32 v22, v14
v_mov_b32 v23, v15
v_permlane32_swap_b32 v20, v12
v_permlane32_swap_b32 v21, v13
v_permlane32_swap_b32 v22, v14
v_permlane32_swap_b32 v23, v15
v_max_f32 v12, v12, v20
v_max_f32 v13, v13, v21
v_max_f32 v14, v14, v22
v_max_f32 v15, v15, v23
v_mul_f32 v12, s66, v12
v_mul_f32 v13, s66, v13
v_mul_f32 v14, s66, v14
v_mul_f32 v15, s66, v15
v_fma_f32 v156, v156, s66, -v12
v_fma_f32 v157, v157, s66, -v12
v_fma_f32 v158, v158, s66, -v12
v_fma_f32 v159, v159, s66, -v12
v_fma_f32 v188, v188, s66, -v12
v_fma_f32 v189, v189, s66, -v12
v_fma_f32 v190, v190, s66, -v12
v_fma_f32 v191, v191, s66, -v12
v_exp_f32 v156, v156
v_exp_f32 v157, v157
v_exp_f32 v158, v158
v_exp_f32 v159, v159
v_exp_f32 v188, v188
v_exp_f32 v189, v189
v_exp_f32 v190, v190
v_exp_f32 v191, v191
v_cvt_pk_bf16_f32 v156, v156, v157
v_cvt_pk_bf16_f32 v157, v158, v159
v_cvt_pk_bf16_f32 v158, v188, v189
v_cvt_pk_bf16_f32 v159, v190, v191
v_pk_mul_f32 v[56:57], v[56:57], s[68:69]
v_pk_mul_f32 v[58:59], v[58:59], s[68:69]
v_mfma_f32_16x16x32_bf16 v[188:191], a[244:247], v[156:159], 0
s_waitcnt lgkmcnt(7)
v_mfma_f32_16x16x32_bf16 v[152:155], v[216:219], v[156:159], 0
s_waitcnt lgkmcnt(6)
v_mfma_f32_16x16x32_bf16 v[184:187], v[220:223], v[156:159], 0
v_fma_f32 v164, v164, s66, -v13
v_fma_f32 v165, v165, s66, -v13
v_fma_f32 v166, v166, s66, -v13
v_fma_f32 v167, v167, s66, -v13
v_fma_f32 v196, v196, s66, -v13
v_fma_f32 v197, v197, s66, -v13
v_fma_f32 v198, v198, s66, -v13
v_fma_f32 v199, v199, s66, -v13
v_exp_f32 v164, v164
v_exp_f32 v165, v165
v_exp_f32 v166, v166
v_exp_f32 v167, v167
v_exp_f32 v196, v196
v_exp_f32 v197, v197
v_exp_f32 v198, v198
v_exp_f32 v199, v199
v_cvt_pk_bf16_f32 v164, v164, v165
v_cvt_pk_bf16_f32 v165, v166, v167
v_cvt_pk_bf16_f32 v166, v196, v197
v_cvt_pk_bf16_f32 v167, v198, v199
v_pk_mul_f32 v[120:121], v[120:121], s[68:69]
v_pk_mul_f32 v[122:123], v[122:123], s[68:69]
v_mfma_f32_16x16x32_bf16 v[196:199], a[244:247], v[164:167], 0
s_waitcnt lgkmcnt(5)
v_mfma_f32_16x16x32_bf16 v[160:163], v[224:227], v[164:167], 0
s_waitcnt lgkmcnt(4)
v_mfma_f32_16x16x32_bf16 v[192:195], v[228:231], v[164:167], 0
v_fma_f32 v172, v172, s66, -v14
v_fma_f32 v173, v173, s66, -v14
v_fma_f32 v174, v174, s66, -v14
v_fma_f32 v175, v175, s66, -v14
v_fma_f32 v204, v204, s66, -v14
v_fma_f32 v205, v205, s66, -v14
v_fma_f32 v206, v206, s66, -v14
v_fma_f32 v207, v207, s66, -v14
v_exp_f32 v172, v172
v_exp_f32 v173, v173
v_exp_f32 v174, v174
v_exp_f32 v175, v175
v_exp_f32 v204, v204
v_exp_f32 v205, v205
v_exp_f32 v206, v206
v_exp_f32 v207, v207
v_cvt_pk_bf16_f32 v172, v172, v173
v_cvt_pk_bf16_f32 v173, v174, v175
v_cvt_pk_bf16_f32 v174, v204, v205
v_cvt_pk_bf16_f32 v175, v206, v207
v_cvt_pk_bf16_f32 v56, v56, v57
v_cvt_pk_bf16_f32 v57, v58, v59
v_mfma_f32_16x16x32_bf16 v[204:207], a[244:247], v[172:175], 0
s_waitcnt lgkmcnt(3)
v_mfma_f32_16x16x32_bf16 v[168:171], v[232:235], v[172:175], 0
s_waitcnt lgkmcnt(2)
v_mfma_f32_16x16x32_bf16 v[200:203], v[236:239], v[172:175], 0
v_fma_f32 v180, v180, s66, -v15
v_fma_f32 v181, v181, s66, -v15
v_fma_f32 v182, v182, s66, -v15
v_fma_f32 v183, v183, s66, -v15
v_fma_f32 v212, v212, s66, -v15
v_fma_f32 v213, v213, s66, -v15
v_fma_f32 v214, v214, s66, -v15
v_fma_f32 v215, v215, s66, -v15
v_exp_f32 v180, v180
v_exp_f32 v181, v181
v_exp_f32 v182, v182
v_exp_f32 v183, v183
v_exp_f32 v212, v212
v_exp_f32 v213, v213
v_exp_f32 v214, v214
v_exp_f32 v215, v215
v_cvt_pk_bf16_f32 v180, v180, v181
v_cvt_pk_bf16_f32 v181, v182, v183
v_cvt_pk_bf16_f32 v182, v212, v213
v_cvt_pk_bf16_f32 v183, v214, v215
v_cvt_pk_bf16_f32 v58, v120, v121
v_cvt_pk_bf16_f32 v59, v122, v123
v_mfma_f32_16x16x32_bf16 v[212:215], a[244:247], v[180:183], 0
s_waitcnt lgkmcnt(1)
v_mfma_f32_16x16x32_bf16 v[176:179], v[240:243], v[180:183], 0
s_waitcnt lgkmcnt(0)
v_mfma_f32_16x16x32_bf16 v[208:211], v[244:247], v[180:183], 0
v_pk_mul_f32 v[72:73], v[72:73], s[68:69]
v_pk_mul_f32 v[74:75], v[74:75], s[68:69]
v_pk_mul_f32 v[136:137], v[136:137], s[68:69]
v_pk_mul_f32 v[138:139], v[138:139], s[68:69]
v_cvt_pk_bf16_f32 v72, v72, v73
v_cvt_pk_bf16_f32 v73, v74, v75
v_cvt_pk_bf16_f32 v74, v136, v137
v_cvt_pk_bf16_f32 v75, v138, v139
v_pk_mul_f32 v[28:29], v[28:29], s[68:69]
v_pk_mul_f32 v[30:31], v[30:31], s[68:69]
v_pk_mul_f32 v[92:93], v[92:93], s[68:69]
v_pk_mul_f32 v[94:95], v[94:95], s[68:69]
v_cvt_pk_bf16_f32 v28, v28, v29
v_cvt_pk_bf16_f32 v29, v30, v31
v_cvt_pk_bf16_f32 v30, v92, v93
v_cvt_pk_bf16_f32 v31, v94, v95
v_pk_mul_f32 v[44:45], v[44:45], s[68:69]
v_pk_mul_f32 v[46:47], v[46:47], s[68:69]
v_pk_mul_f32 v[108:109], v[108:109], s[68:69]
v_pk_mul_f32 v[110:111], v[110:111], s[68:69]
v_cvt_pk_bf16_f32 v44, v44, v45
v_cvt_pk_bf16_f32 v45, v46, v47
v_cvt_pk_bf16_f32 v46, v108, v109
v_cvt_pk_bf16_f32 v47, v110, v111
s_add_u32 s66, s31, 128
s_lshl_b32 s66, s66, 13
s_add_u32 s66, s66, s78
s_add_u32 s66, s66, 33554432
s_mul_i32 s64, s3, 1310720
s_add_u32 s64, s64, s66
s_mul_i32 s65, s16, 1310720
s_add_u32 s65, s65, s66
v_rcp_f32 v12, v188
v_rcp_f32 v13, v196
v_rcp_f32 v14, v204
v_rcp_f32 v15, v212
v_mul_f32 v12, v12, v5
v_mul_f32 v13, v13, v7
v_mul_f32 v14, v14, v9
v_mul_f32 v15, v15, v11
v_mul_f32 v152, v152, v12
v_mul_f32 v153, v153, v12
v_mul_f32 v154, v154, v12
v_mul_f32 v155, v155, v12
v_mul_f32 v184, v184, v12
v_mul_f32 v185, v185, v12
v_mul_f32 v186, v186, v12
v_mul_f32 v187, v187, v12
v_cvt_pk_bf16_f32 v152, v152, v153
v_cvt_pk_bf16_f32 v153, v154, v155
v_cvt_pk_bf16_f32 v154, v184, v185
v_cvt_pk_bf16_f32 v155, v186, v187
buffer_store_dwordx4 v[152:155], v16, s[44:47], s64 offen sc1
v_mul_f32 v160, v160, v13
v_mul_f32 v161, v161, v13
v_mul_f32 v162, v162, v13
v_mul_f32 v163, v163, v13
v_mul_f32 v192, v192, v13
v_mul_f32 v193, v193, v13
v_mul_f32 v194, v194, v13
v_mul_f32 v195, v195, v13
v_cvt_pk_bf16_f32 v160, v160, v161
v_cvt_pk_bf16_f32 v161, v162, v163
v_cvt_pk_bf16_f32 v162, v192, v193
v_cvt_pk_bf16_f32 v163, v194, v195
s_add_u32 s64, s64, 4096
buffer_store_dwordx4 v[160:163], v16, s[44:47], s64 offen sc1
v_mul_f32 v168, v168, v14
v_mul_f32 v169, v169, v14
v_mul_f32 v170, v170, v14
v_mul_f32 v171, v171, v14
v_mul_f32 v200, v200, v14
v_mul_f32 v201, v201, v14
v_mul_f32 v202, v202, v14
v_mul_f32 v203, v203, v14
v_cvt_pk_bf16_f32 v168, v168, v169
v_cvt_pk_bf16_f32 v169, v170, v171
v_cvt_pk_bf16_f32 v170, v200, v201
v_cvt_pk_bf16_f32 v171, v202, v203
buffer_store_dwordx4 v[168:171], v16, s[44:47], s65 offen sc1
v_mul_f32 v176, v176, v15
v_mul_f32 v177, v177, v15
v_mul_f32 v178, v178, v15
v_mul_f32 v179, v179, v15
v_mul_f32 v208, v208, v15
v_mul_f32 v209, v209, v15
v_mul_f32 v210, v210, v15
v_mul_f32 v211, v211, v15
v_cvt_pk_bf16_f32 v176, v176, v177
v_cvt_pk_bf16_f32 v177, v178, v179
v_cvt_pk_bf16_f32 v178, v208, v209
v_cvt_pk_bf16_f32 v179, v210, v211
s_add_u32 s65, s65, 4096
buffer_store_dwordx4 v[176:179], v16, s[44:47], s65 offen sc1
v_pk_mul_f32 v[60:61], v[60:61], s[68:69]
v_pk_mul_f32 v[62:63], v[62:63], s[68:69]
v_pk_mul_f32 v[124:125], v[124:125], s[68:69]
v_pk_mul_f32 v[126:127], v[126:127], s[68:69]
v_cvt_pk_bf16_f32 v60, v60, v61
v_cvt_pk_bf16_f32 v61, v62, v63
v_cvt_pk_bf16_f32 v62, v124, v125
v_cvt_pk_bf16_f32 v63, v126, v127
v_pk_mul_f32 v[76:77], v[76:77], s[68:69]
v_pk_mul_f32 v[78:79], v[78:79], s[68:69]
v_pk_mul_f32 v[140:141], v[140:141], s[68:69]
v_pk_mul_f32 v[142:143], v[142:143], s[68:69]
v_cvt_pk_bf16_f32 v76, v76, v77
v_cvt_pk_bf16_f32 v77, v78, v79
v_cvt_pk_bf16_f32 v78, v140, v141
v_cvt_pk_bf16_f32 v79, v142, v143
v_pk_mul_f32 v[32:33], v[32:33], s[68:69]
v_pk_mul_f32 v[34:35], v[34:35], s[68:69]
v_pk_mul_f32 v[96:97], v[96:97], s[68:69]
v_pk_mul_f32 v[98:99], v[98:99], s[68:69]
v_cvt_pk_bf16_f32 v32, v32, v33
v_cvt_pk_bf16_f32 v33, v34, v35
v_cvt_pk_bf16_f32 v34, v96, v97
v_cvt_pk_bf16_f32 v35, v98, v99
v_pk_mul_f32 v[48:49], v[48:49], s[68:69]
v_pk_mul_f32 v[50:51], v[50:51], s[68:69]
v_pk_mul_f32 v[112:113], v[112:113], s[68:69]
v_pk_mul_f32 v[114:115], v[114:115], s[68:69]
v_cvt_pk_bf16_f32 v48, v48, v49
v_cvt_pk_bf16_f32 v49, v50, v51
v_cvt_pk_bf16_f32 v50, v112, v113
v_cvt_pk_bf16_f32 v51, v114, v115
v_pk_mul_f32 v[64:65], v[64:65], s[68:69]
v_pk_mul_f32 v[66:67], v[66:67], s[68:69]
v_pk_mul_f32 v[128:129], v[128:129], s[68:69]
v_pk_mul_f32 v[130:131], v[130:131], s[68:69]
v_cvt_pk_bf16_f32 v64, v64, v65
v_cvt_pk_bf16_f32 v65, v66, v67
v_cvt_pk_bf16_f32 v66, v128, v129
v_cvt_pk_bf16_f32 v67, v130, v131
v_pk_mul_f32 v[80:81], v[80:81], s[68:69]
v_pk_mul_f32 v[82:83], v[82:83], s[68:69]
v_pk_mul_f32 v[144:145], v[144:145], s[68:69]
v_pk_mul_f32 v[146:147], v[146:147], s[68:69]
v_cvt_pk_bf16_f32 v80, v80, v81
v_cvt_pk_bf16_f32 v81, v82, v83
v_cvt_pk_bf16_f32 v82, v144, v145
v_cvt_pk_bf16_f32 v83, v146, v147
v_pk_mul_f32 v[36:37], v[36:37], s[68:69]
v_pk_mul_f32 v[38:39], v[38:39], s[68:69]
v_pk_mul_f32 v[100:101], v[100:101], s[68:69]
v_pk_mul_f32 v[102:103], v[102:103], s[68:69]
v_cvt_pk_bf16_f32 v36, v36, v37
v_cvt_pk_bf16_f32 v37, v38, v39
v_cvt_pk_bf16_f32 v38, v100, v101
v_cvt_pk_bf16_f32 v39, v102, v103
v_pk_mul_f32 v[52:53], v[52:53], s[68:69]
v_pk_mul_f32 v[54:55], v[54:55], s[68:69]
v_pk_mul_f32 v[116:117], v[116:117], s[68:69]
v_pk_mul_f32 v[118:119], v[118:119], s[68:69]
v_cvt_pk_bf16_f32 v52, v52, v53
v_cvt_pk_bf16_f32 v53, v54, v55
v_cvt_pk_bf16_f32 v54, v116, v117
v_cvt_pk_bf16_f32 v55, v118, v119
v_pk_mul_f32 v[68:69], v[68:69], s[68:69]
v_pk_mul_f32 v[70:71], v[70:71], s[68:69]
v_pk_mul_f32 v[132:133], v[132:133], s[68:69]
v_pk_mul_f32 v[134:135], v[134:135], s[68:69]
v_cvt_pk_bf16_f32 v68, v68, v69
v_cvt_pk_bf16_f32 v69, v70, v71
v_cvt_pk_bf16_f32 v70, v132, v133
v_cvt_pk_bf16_f32 v71, v134, v135
v_pk_mul_f32 v[84:85], v[84:85], s[68:69]
v_pk_mul_f32 v[86:87], v[86:87], s[68:69]
v_pk_mul_f32 v[148:149], v[148:149], s[68:69]
v_pk_mul_f32 v[150:151], v[150:151], s[68:69]
v_cvt_pk_bf16_f32 v84, v84, v85
v_cvt_pk_bf16_f32 v85, v86, v87
v_cvt_pk_bf16_f32 v86, v148, v149
v_cvt_pk_bf16_f32 v87, v150, v151
s_mov_b32 s73, 0
v_mov_b32 v17, 0xff800000
s_lshl_b32 s66, s31, 15
s_add_u32 s66, s66, s78
s_add_u32 s66, s66, 33554432
s_mul_i32 s74, s3, 1310720
s_add_u32 s74, s74, s66
s_mul_i32 s75, s16, 1310720
s_add_u32 s75, s75, s66
L_attstart_15:
v_mov_b32 v2, v16
v_add_u32 v3, 0x10000, v16
v_mov_b32 v1, 0
s_and_b32 s66, s30, 1
s_lshr_b32 s67, s30, 1
s_lshl_b32 s71, s66, 13
s_lshl_b32 s68, s67, 16
s_add_u32 s71, s71, s68
s_add_u32 s71, s71, 32768
s_lshl_b32 s70, s66, 14
s_mul_i32 s67, s67, 24576
s_sub_u32 s70, s70, s67
s_add_u32 s70, s70, 65536
s_waitcnt lgkmcnt(0)
s_barrier
s_cmp_eq_u32 s3, 0
s_cbranch_scc1 L_F1_7
ds_read_b128 a[144:147], v2 offset:0
ds_read_b128 a[148:151], v2 offset:1024
ds_read_b128 a[152:155], v2 offset:2048
ds_read_b128 a[156:159], v2 offset:3072
ds_read_b128 a[160:163], v2 offset:4096
ds_read_b128 a[164:167], v2 offset:5120
ds_read_b128 a[168:171], v2 offset:6144
ds_read_b128 a[172:175], v2 offset:7168
s_mov_b32 m0, s71
s_nop 0
buffer_load_dwordx4 v16, s[32:35], s70 offen offset:0 sc1 lds
buffer_load_dwordx4 v16, s[32:35], s70 offen offset:1024 sc1 lds
s_waitcnt lgkmcnt(7)
v_mfma_f32_16x16x32_bf16 v[88:91], a[144:147], v[24:27], 0
s_waitcnt lgkmcnt(6)
ds_read_b128 a[176:179], v2 offset:8192
v_mfma_f32_16x16x32_bf16 v[88:91], a[148:151], v[28:31], v[88:91]
s_waitcnt lgkmcnt(6)
ds_read_b128 a[180:183], v2 offset:9216
v_mfma_f32_16x16x32_bf16 v[88:91], a[152:155], v[32:35], v[88:91]
s_waitcnt lgkmcnt(6)
buffer_load_dwordx4 v16, s[32:35], s70 offen offset:2048 sc1 lds
v_mfma_f32_16x16x32_bf16 v[88:91], a[156:159], v[36:39], v[88:91]
ds_read_b128 a[184:187], v2 offset:10240
v_mfma_f32_16x16x32_bf16 v[104:107], a[156:159], v[52:55], 0
ds_read_b128 a[188:191], v2 offset:11264
v_mfma_f32_16x16x32_bf16 v[104:107], a[152:155], v[48:51], v[104:107]
ds_read_b128 a[192:195], v2 offset:12288
v_mfma_f32_16x16x32_bf16 v[104:107], a[148:151], v[44:47], v[104:107]
ds_read_b128 a[196:199], v2 offset:13312
v_mfma_f32_16x16x32_bf16 v[104:107], a[144:147], v[40:43], v[104:107]
ds_read_b128 a[200:203], v2 offset:14336
v_mfma_f32_16x16x32_bf16 v[120:123], a[144:147], v[56:59], 0
ds_read_b128 a[204:207], v2 offset:15360
v_mfma_f32_16x16x32_bf16 v[120:123], a[148:151], v[60:63], v[120:123]
buffer_load_dwordx4 v16, s[32:35], s70 offen offset:3072 sc1 lds
v_mfma_f32_16x16x32_bf16 v[120:123], a[152:155], v[64:67], v[120:123]
v_mfma_f32_16x16x32_bf16 v[120:123], a[156:159], v[68:71], v[120:123]
v_mfma_f32_16x16x32_bf16 v[136:139], a[156:159], v[84:87], 0
v_mfma_f32_16x16x32_bf16 v[136:139], a[152:155], v[80:83], v[136:139]
v_mfma_f32_16x16x32_bf16 v[136:139], a[148:151], v[76:79], v[136:139]
v_mfma_f32_16x16x32_bf16 v[136:139], a[144:147], v[72:75], v[136:139]
s_waitcnt lgkmcnt(0)
s_nop 1
v_max3_f32 v20, v88, v89, v90
v_max_f32 v20, v20, v91
v_max3_f32 v21, v104, v105, v106
v_max_f32 v21, v21, v107
v_max3_f32 v22, v120, v121, v122
v_max_f32 v22, v22, v123
v_max3_f32 v23, v136, v137, v138
v_max_f32 v23, v23, v139
v_mov_b32 v248, v20
v_mov_b32 v249, v21
v_mov_b32 v250, v22
v_mov_b32 v251, v23
v_permlane16_swap_b32 v248, v20
v_permlane16_swap_b32 v249, v21
v_permlane16_swap_b32 v250, v22
v_permlane16_swap_b32 v251, v23
v_max_f32 v20, v20, v248
v_max_f32 v21, v21, v249
v_max_f32 v22, v22, v250
v_max_f32 v23, v23, v251
v_mov_b32 v248, v20
v_mov_b32 v249, v21
v_mov_b32 v250, v22
v_mov_b32 v251, v23
v_permlane32_swap_b32 v248, v20
v_permlane32_swap_b32 v249, v21
v_permlane32_swap_b32 v250, v22
v_permlane32_swap_b32 v251, v23
v_max_f32 v20, v20, v248
v_max_f32 v21, v21, v249
v_max_f32 v22, v22, v250
v_max_f32 v23, v23, v251
s_cmp_eq_u32 s73, 0
s_cselect_b64 vcc, 0, -1
v_cndmask_b32 v20, v20, v252, vcc
v_cndmask_b32 v21, v21, v253, vcc
v_cndmask_b32 v22, v22, v254, vcc
v_cndmask_b32 v23, v23, v255, vcc
v_sub_f32 v228, 0, v23
v_sub_f32 v229, 0, v23
v_sub_f32 v230, 0, v23
v_sub_f32 v231, 0, v23
v_sub_f32 v224, 0, v22
v_sub_f32 v225, 0, v22
v_sub_f32 v226, 0, v22
v_sub_f32 v227, 0, v22
v_sub_f32 v220, 0, v21
v_sub_f32 v221, 0, v21
v_sub_f32 v222, 0, v21
v_sub_f32 v223, 0, v21
v_sub_f32 v216, 0, v20
v_sub_f32 v217, 0, v20
v_sub_f32 v218, 0, v20
v_sub_f32 v219, 0, v20
v_mfma_f32_16x16x32_bf16 v[140:143], a[160:163], v[72:75], v[228:231]
v_add_f32 v88, v88, v216
v_add_f32 v89, v89, v216
v_mfma_f32_16x16x32_bf16 v[140:143], a[164:167], v[76:79], v[140:143]
s_add_u32 m0, s71, 4096
v_add_f32 v90, v90, v216
v_add_f32 v91, v91, v216
v_exp_f32 v88, v88
v_mfma_f32_16x16x32_bf16 v[140:143], a[168:171], v[80:83], v[140:143]
s_add_u32 s64, s70, 4096
v_exp_f32 v89, v89
v_mfma_f32_16x16x32_bf16 v[140:143], a[172:175], v[84:87], v[140:143]
buffer_load_dwordx4 v16, s[32:35], s64 offen offset:0 sc1 lds
v_mfma_f32_16x16x32_bf16 v[124:127], a[172:175], v[68:71], v[224:227]
v_exp_f32 v90, v90
v_mfma_f32_16x16x32_bf16 v[124:127], a[168:171], v[64:67], v[124:127]
v_exp_f32 v91, v91
v_mfma_f32_16x16x32_bf16 v[124:127], a[164:167], v[60:63], v[124:127]
v_add_f32 v104, v104, v220
v_add_f32 v105, v105, v220
v_add_f32 v106, v106, v220
v_add_f32 v107, v107, v220
v_exp_f32 v104, v104
v_mfma_f32_16x16x32_bf16 v[124:127], a[160:163], v[56:59], v[124:127]
v_exp_f32 v105, v105
v_mfma_f32_16x16x32_bf16 v[108:111], a[160:163], v[40:43], v[220:223]
v_exp_f32 v106, v106
v_mfma_f32_16x16x32_bf16 v[108:111], a[164:167], v[44:47], v[108:111]
buffer_load_dwordx4 v16, s[32:35], s64 offen offset:1024 sc1 lds
v_mfma_f32_16x16x32_bf16 v[108:111], a[168:171], v[48:51], v[108:111]
v_cvt_pk_bf16_f32 v152, v88, v89
v_add_f32 v120, v120, v224
v_mfma_f32_16x16x32_bf16 v[108:111], a[172:175], v[52:55], v[108:111]
v_exp_f32 v107, v107
v_mfma_f32_16x16x32_bf16 v[92:95], a[172:175], v[36:39], v[216:219]
v_add_f32 v121, v121, v224
v_add_f32 v122, v122, v224
v_add_f32 v123, v123, v224
v_exp_f32 v120, v120
v_mfma_f32_16x16x32_bf16 v[92:95], a[168:171], v[32:35], v[92:95]
v_cvt_pk_bf16_f32 v153, v90, v91
v_exp_f32 v121, v121
v_mfma_f32_16x16x32_bf16 v[92:95], a[164:167], v[28:31], v[92:95]
v_exp_f32 v122, v122
v_mfma_f32_16x16x32_bf16 v[92:95], a[160:163], v[24:27], v[92:95]
v_exp_f32 v123, v123
v_mfma_f32_16x16x32_bf16 v[96:99], a[176:179], v[24:27], v[216:219]
v_cvt_pk_bf16_f32 v160, v104, v105
v_add_f32 v136, v136, v228
v_mfma_f32_16x16x32_bf16 v[96:99], a[180:183], v[28:31], v[96:99]
buffer_load_dwordx4 v16, s[32:35], s64 offen offset:2048 sc1 lds
v_add_f32 v137, v137, v228
v_add_f32 v138, v138, v228
v_add_f32 v139, v139, v228
v_exp_f32 v136, v136
v_mfma_f32_16x16x32_bf16 v[96:99], a[184:187], v[32:35], v[96:99]
v_exp_f32 v137, v137
v_mfma_f32_16x16x32_bf16 v[96:99], a[188:191], v[36:39], v[96:99]
v_cvt_pk_bf16_f32 v161, v106, v107
v_cvt_pk_bf16_f32 v184, v120, v121
v_mfma_f32_16x16x32_bf16 v[112:115], a[188:191], v[52:55], v[220:223]
v_exp_f32 v138, v138
v_mfma_f32_16x16x32_bf16 v[112:115], a[184:187], v[48:51], v[112:115]
v_exp_f32 v139, v139
v_mfma_f32_16x16x32_bf16 v[112:115], a[180:183], v[44:47], v[112:115]
v_exp_f32 v140, v140
v_mfma_f32_16x16x32_bf16 v[112:115], a[176:179], v[40:43], v[112:115]
v_exp_f32 v141, v141
v_mfma_f32_16x16x32_bf16 v[128:131], a[176:179], v[56:59], v[224:227]
buffer_load_dwordx4 v16, s[32:35], s64 offen offset:3072 sc1 lds
v_cvt_pk_bf16_f32 v185, v122, v123
v_mfma_f32_16x16x32_bf16 v[128:131], a[180:183], v[60:63], v[128:131]
v_exp_f32 v142, v142
v_mfma_f32_16x16x32_bf16 v[128:131], a[184:187], v[64:67], v[128:131]
v_exp_f32 v143, v143
v_mfma_f32_16x16x32_bf16 v[128:131], a[188:191], v[68:71], v[128:131]
v_cvt_pk_bf16_f32 v192, v136, v137
v_cvt_pk_bf16_f32 v193, v138, v139
v_mfma_f32_16x16x32_bf16 v[144:147], a[188:191], v[84:87], v[228:231]
v_exp_f32 v124, v124
v_mfma_f32_16x16x32_bf16 v[144:147], a[184:187], v[80:83], v[144:147]
v_exp_f32 v125, v125
v_mfma_f32_16x16x32_bf16 v[144:147], a[180:183], v[76:79], v[144:147]
s_waitcnt vmcnt(8)
s_barrier
v_mfma_f32_16x16x32_bf16 v[144:147], a[176:179], v[72:75], v[144:147]
v_exp_f32 v126, v126
v_mfma_f32_16x16x32_bf16 v[148:151], a[192:195], v[72:75], v[228:231]
v_cvt_pk_bf16_f32 v194, v140, v141
v_cvt_pk_bf16_f32 v195, v142, v143
v_mfma_f32_16x16x32_bf16 v[148:151], a[196:199], v[76:79], v[148:151]
v_exp_f32 v127, v127
v_mfma_f32_16x16x32_bf16 v[148:151], a[200:203], v[80:83], v[148:151]
s_xor_b32 s71, s71, 16384
v_exp_f32 v108, v108
v_mfma_f32_16x16x32_bf16 v[148:151], a[204:207], v[84:87], v[148:151]
s_add_u32 s70, s70, 32768
v_exp_f32 v109, v109
v_mfma_f32_16x16x32_bf16 v[132:135], a[204:207], v[68:71], v[224:227]
s_mov_b32 m0, s71
v_exp_f32 v110, v110
v_mfma_f32_16x16x32_bf16 v[132:135], a[200:203], v[64:67], v[132:135]
buffer_load_dwordx4 v16, s[32:35], s70 offen offset:0 sc1 lds
v_mfma_f32_16x16x32_bf16 v[132:135], a[196:199], v[60:63], v[132:135]
v_cvt_pk_bf16_f32 v186, v124, v125
v_exp_f32 v111, v111
v_mfma_f32_16x16x32_bf16 v[132:135], a[192:195], v[56:59], v[132:135]
v_exp_f32 v92, v92
v_mfma_f32_16x16x32_bf16 v[116:119], a[192:195], v[40:43], v[220:223]
v_exp_f32 v93, v93
v_mfma_f32_16x16x32_bf16 v[116:119], a[196:199], v[44:47], v[116:119]
ds_read_b128 a[144:147], v2 offset:16384
v_cvt_pk_bf16_f32 v187, v126, v127
v_mfma_f32_16x16x32_bf16 v[116:119], a[200:203], v[48:51], v[116:119]
v_exp_f32 v94, v94
v_mfma_f32_16x16x32_bf16 v[116:119], a[204:207], v[52:55], v[116:119]
ds_read_b128 a[148:151], v2 offset:17408
v_cvt_pk_bf16_f32 v162, v108, v109
v_mfma_f32_16x16x32_bf16 v[100:103], a[204:207], v[36:39], v[216:219]
ds_read_b128 a[152:155], v2 offset:18432
buffer_load_dwordx4 v16, s[32:35], s70 offen offset:1024 sc1 lds
v_exp_f32 v95, v95
v_mfma_f32_16x16x32_bf16 v[100:103], a[200:203], v[32:35], v[100:103]
ds_read_b128 a[156:159], v2 offset:19456
v_exp_f32 v96, v96
v_mfma_f32_16x16x32_bf16 v[100:103], a[196:199], v[28:31], v[100:103]
v_cvt_pk_bf16_f32 v163, v110, v111
v_exp_f32 v97, v97
v_mfma_f32_16x16x32_bf16 v[100:103], a[192:195], v[24:27], v[100:103]
s_waitcnt lgkmcnt(3)
ds_read_b128 a[160:163], v2 offset:20480
ds_read_b128 a[164:167], v2 offset:21504
ds_read_b128 a[168:171], v2 offset:22528
ds_read_b128 a[172:175], v2 offset:23552
v_cvt_pk_bf16_f32 v154, v92, v93
v_mfma_f32_16x16x32_bf16 v[88:91], a[144:147], v[24:27], v[216:219]
s_waitcnt lgkmcnt(6)
v_exp_f32 v98, v98
v_mfma_f32_16x16x32_bf16 v[88:91], a[148:151], v[28:31], v[88:91]
s_waitcnt lgkmcnt(5)
v_exp_f32 v99, v99
v_mfma_f32_16x16x32_bf16 v[88:91], a[152:155], v[32:35], v[88:91]
s_waitcnt lgkmcnt(4)
v_exp_f32 v112, v112
v_mfma_f32_16x16x32_bf16 v[88:91], a[156:159], v[36:39], v[88:91]
v_exp_f32 v113, v113
v_mfma_f32_16x16x32_bf16 v[104:107], a[156:159], v[52:55], v[220:223]
v_cvt_pk_bf16_f32 v155, v94, v95
v_cvt_pk_bf16_f32 v156, v96, v97
v_mfma_f32_16x16x32_bf16 v[104:107], a[152:155], v[48:51], v[104:107]
buffer_load_dwordx4 v16, s[32:35], s70 offen offset:2048 sc1 lds
v_exp_f32 v114, v114
v_mfma_f32_16x16x32_bf16 v[104:107], a[148:151], v[44:47], v[104:107]
v_exp_f32 v115, v115
v_mfma_f32_16x16x32_bf16 v[104:107], a[144:147], v[40:43], v[104:107]
v_exp_f32 v128, v128
v_mfma_f32_16x16x32_bf16 v[120:123], a[144:147], v[56:59], v[224:227]
v_exp_f32 v129, v129
v_mfma_f32_16x16x32_bf16 v[120:123], a[148:151], v[60:63], v[120:123]
v_cvt_pk_bf16_f32 v157, v98, v99
v_cvt_pk_bf16_f32 v164, v112, v113
v_mfma_f32_16x16x32_bf16 v[120:123], a[152:155], v[64:67], v[120:123]
v_exp_f32 v130, v130
v_mfma_f32_16x16x32_bf16 v[120:123], a[156:159], v[68:71], v[120:123]
v_exp_f32 v131, v131
v_mfma_f32_16x16x32_bf16 v[136:139], a[156:159], v[84:87], v[228:231]
v_exp_f32 v144, v144
v_mfma_f32_16x16x32_bf16 v[136:139], a[152:155], v[80:83], v[136:139]
v_exp_f32 v145, v145
v_mfma_f32_16x16x32_bf16 v[136:139], a[148:151], v[76:79], v[136:139]
v_exp_f32 v146, v146
v_mfma_f32_16x16x32_bf16 v[136:139], a[144:147], v[72:75], v[136:139]
s_waitcnt lgkmcnt(0)
v_cvt_pk_bf16_f32 v165, v114, v115
v_cvt_pk_bf16_f32 v188, v128, v129
v_mfma_f32_16x16x32_bf16 v[140:143], a[160:163], v[72:75], v[228:231]
v_exp_f32 v147, v147
v_mfma_f32_16x16x32_bf16 v[140:143], a[164:167], v[76:79], v[140:143]
v_exp_f32 v148, v148
v_mfma_f32_16x16x32_bf16 v[140:143], a[168:171], v[80:83], v[140:143]
v_exp_f32 v149, v149
v_mfma_f32_16x16x32_bf16 v[140:143], a[172:175], v[84:87], v[140:143]
buffer_load_dwordx4 v16, s[32:35], s70 offen offset:3072 sc1 lds
v_mfma_f32_16x16x32_bf16 v[124:127], a[172:175], v[68:71], v[224:227]
v_cvt_pk_bf16_f32 v189, v130, v131
v_cvt_pk_bf16_f32 v196, v144, v145
v_mfma_f32_16x16x32_bf16 v[124:127], a[168:171], v[64:67], v[124:127]
v_exp_f32 v150, v150
v_mfma_f32_16x16x32_bf16 v[124:127], a[164:167], v[60:63], v[124:127]
v_exp_f32 v151, v151
v_mfma_f32_16x16x32_bf16 v[124:127], a[160:163], v[56:59], v[124:127]
v_exp_f32 v132, v132
v_mfma_f32_16x16x32_bf16 v[108:111], a[160:163], v[40:43], v[220:223]
ds_read_b128 a[176:179], v2 offset:24576
v_cvt_pk_bf16_f32 v197, v146, v147
v_mfma_f32_16x16x32_bf16 v[108:111], a[164:167], v[44:47], v[108:111]
ds_read_b128 a[180:183], v2 offset:25600
v_cvt_pk_bf16_f32 v198, v148, v149
v_mfma_f32_16x16x32_bf16 v[108:111], a[168:171], v[48:51], v[108:111]
ds_read_b128 a[184:187], v2 offset:26624
v_exp_f32 v133, v133
v_mfma_f32_16x16x32_bf16 v[108:111], a[172:175], v[52:55], v[108:111]
ds_read_b128 a[188:191], v2 offset:27648
v_exp_f32 v134, v134
v_mfma_f32_16x16x32_bf16 v[92:95], a[172:175], v[36:39], v[216:219]
v_exp_f32 v135, v135
v_mfma_f32_16x16x32_bf16 v[92:95], a[168:171], v[32:35], v[92:95]
v_exp_f32 v116, v116
v_mfma_f32_16x16x32_bf16 v[92:95], a[164:167], v[28:31], v[92:95]
v_exp_f32 v117, v117
v_mfma_f32_16x16x32_bf16 v[92:95], a[160:163], v[24:27], v[92:95]
s_waitcnt lgkmcnt(2)
v_cvt_pk_bf16_f32 v199, v150, v151
v_cvt_pk_bf16_f32 v190, v132, v133
v_mfma_f32_16x16x32_bf16 v[96:99], a[176:179], v[24:27], v[216:219]
v_exp_f32 v118, v118
v_mfma_f32_16x16x32_bf16 v[96:99], a[180:183], v[28:31], v[96:99]
s_waitcnt lgkmcnt(0)
v_exp_f32 v119, v119
v_mfma_f32_16x16x32_bf16 v[96:99], a[184:187], v[32:35], v[96:99]
s_add_u32 m0, s71, 4096
v_exp_f32 v100, v100
v_mfma_f32_16x16x32_bf16 v[96:99], a[188:191], v[36:39], v[96:99]
s_add_u32 s64, s70, 4096
v_exp_f32 v101, v101
v_mfma_f32_16x16x32_bf16 v[112:115], a[188:191], v[52:55], v[220:223]
buffer_load_dwordx4 v16, s[32:35], s64 offen offset:0 sc1 lds
v_mfma_f32_16x16x32_bf16 v[112:115], a[184:187], v[48:51], v[112:115]
v_cvt_pk_bf16_f32 v191, v134, v135
v_cvt_pk_bf16_f32 v166, v116, v117
v_mfma_f32_16x16x32_bf16 v[112:115], a[180:183], v[44:47], v[112:115]
v_exp_f32 v102, v102
v_mfma_f32_16x16x32_bf16 v[112:115], a[176:179], v[40:43], v[112:115]
v_exp_f32 v103, v103
v_mfma_f32_16x16x32_bf16 v[128:131], a[176:179], v[56:59], v[224:227]
s_lshl_b32 s66, s30, 30
ds_read_b128 a[192:195], v2 offset:28672
v_cvt_pk_bf16_f32 v167, v118, v119
v_mfma_f32_16x16x32_bf16 v[128:131], a[180:183], v[60:63], v[128:131]
ds_read_b128 a[196:199], v2 offset:29696
v_exp_f32 v88, v88
v_mfma_f32_16x16x32_bf16 v[128:131], a[184:187], v[64:67], v[128:131]
ds_read_b128 a[200:203], v2 offset:30720
v_exp_f32 v89, v89
v_mfma_f32_16x16x32_bf16 v[128:131], a[188:191], v[68:71], v[128:131]
ds_read_b128 a[204:207], v2 offset:31744
v_cvt_pk_bf16_f32 v158, v100, v101
v_mfma_f32_16x16x32_bf16 v[144:147], a[188:191], v[84:87], v[228:231]
v_exp_f32 v90, v90
v_mfma_f32_16x16x32_bf16 v[144:147], a[184:187], v[80:83], v[144:147]
v_exp_f32 v91, v91
v_mfma_f32_16x16x32_bf16 v[144:147], a[180:183], v[76:79], v[144:147]
v_exp_f32 v104, v104
v_mfma_f32_16x16x32_bf16 v[144:147], a[176:179], v[72:75], v[144:147]
s_waitcnt lgkmcnt(2)
v_exp_f32 v105, v105
v_mfma_f32_16x16x32_bf16 v[148:151], a[192:195], v[72:75], v[228:231]
v_cvt_pk_bf16_f32 v159, v102, v103
v_cvt_pk_bf16_f32 v168, v88, v89
v_mfma_f32_16x16x32_bf16 v[148:151], a[196:199], v[76:79], v[148:151]
s_waitcnt lgkmcnt(0)
v_exp_f32 v106, v106
v_mfma_f32_16x16x32_bf16 v[148:151], a[200:203], v[80:83], v[148:151]
v_exp_f32 v107, v107
v_mfma_f32_16x16x32_bf16 v[148:151], a[204:207], v[84:87], v[148:151]
v_exp_f32 v120, v120
v_mfma_f32_16x16x32_bf16 v[132:135], a[204:207], v[68:71], v[224:227]
buffer_load_dwordx4 v16, s[32:35], s64 offen offset:1024 sc1 lds
v_mfma_f32_16x16x32_bf16 v[132:135], a[200:203], v[64:67], v[132:135]
v_cvt_pk_bf16_f32 v169, v90, v91
v_cvt_pk_bf16_f32 v176, v104, v105
v_mfma_f32_16x16x32_bf16 v[132:135], a[196:199], v[60:63], v[132:135]
v_exp_f32 v121, v121
v_mfma_f32_16x16x32_bf16 v[132:135], a[192:195], v[56:59], v[132:135]
v_exp_f32 v122, v122
v_mfma_f32_16x16x32_bf16 v[116:119], a[192:195], v[40:43], v[220:223]
ds_read_b128 a[144:147], v3 offset:16384
v_cvt_pk_bf16_f32 v177, v106, v107
v_mfma_f32_16x16x32_bf16 v[116:119], a[196:199], v[44:47], v[116:119]
ds_read_b128 a[148:151], v3 offset:24576
v_exp_f32 v123, v123
v_mfma_f32_16x16x32_bf16 v[116:119], a[200:203], v[48:51], v[116:119]
v_exp_f32 v136, v136
v_mfma_f32_16x16x32_bf16 v[116:119], a[204:207], v[52:55], v[116:119]
v_exp_f32 v137, v137
v_mfma_f32_16x16x32_bf16 v[100:103], a[204:207], v[36:39], v[216:219]
v_exp_f32 v138, v138
v_mfma_f32_16x16x32_bf16 v[100:103], a[200:203], v[32:35], v[100:103]
v_exp_f32 v139, v139
v_mfma_f32_16x16x32_bf16 v[100:103], a[196:199], v[28:31], v[100:103]
ds_read_b128 a[152:155], v3 offset:17408
v_cvt_pk_bf16_f32 v200, v120, v121
v_mfma_f32_16x16x32_bf16 v[100:103], a[192:195], v[24:27], v[100:103]
s_waitcnt lgkmcnt(1)
v_exp_f32 v140, v140
v_mfma_f32_16x16x32_bf16 a[0:3], a[144:147], v[152:155], 0
ds_read_b128 a[156:159], v3 offset:25600
v_cvt_pk_bf16_f32 v201, v122, v123
v_mfma_f32_16x16x32_bf16 a[0:3], a[148:151], v[156:159], a[0:3]
v_exp_f32 v141, v141
v_mfma_f32_16x16x32_bf16 a[32:35], a[148:151], v[164:167], 0
v_exp_f32 v142, v142
v_mfma_f32_16x16x32_bf16 a[32:35], a[144:147], v[160:163], a[32:35]
v_exp_f32 v143, v143
v_mfma_f32_16x16x32_bf16 a[64:67], a[144:147], v[184:187], 0
v_cvt_pk_bf16_f32 v208, v136, v137
v_cvt_pk_bf16_f32 v209, v138, v139
v_mfma_f32_16x16x32_bf16 a[64:67], a[148:151], v[188:191], a[64:67]
buffer_load_dwordx4 v16, s[32:35], s64 offen offset:2048 sc1 lds
v_mfma_f32_16x16x32_bf16 a[96:99], a[148:151], v[196:199], 0
v_exp_f32 v124, v124
v_mfma_f32_16x16x32_bf16 a[96:99], a[144:147], v[192:195], a[96:99]
s_waitcnt lgkmcnt(0)
v_exp_f32 v125, v125
v_mfma_f32_16x16x32_bf16 a[100:103], a[152:155], v[192:195], 0
ds_read_b128 a[160:163], v3 offset:18432
v_cvt_pk_bf16_f32 v210, v140, v141
v_mfma_f32_16x16x32_bf16 a[100:103], a[156:159], v[196:199], a[100:103]
ds_read_b128 a[164:167], v3 offset:26624
v_exp_f32 v126, v126
v_mfma_f32_16x16x32_bf16 a[68:71], a[156:159], v[188:191], 0
v_exp_f32 v127, v127
v_mfma_f32_16x16x32_bf16 a[68:71], a[152:155], v[184:187], a[68:71]
v_exp_f32 v108, v108
v_mfma_f32_16x16x32_bf16 a[36:39], a[152:155], v[160:163], 0
v_exp_f32 v109, v109
v_mfma_f32_16x16x32_bf16 a[36:39], a[156:159], v[164:167], a[36:39]
v_cvt_pk_bf16_f32 v211, v142, v143
v_cvt_pk_bf16_f32 v202, v124, v125
v_mfma_f32_16x16x32_bf16 a[4:7], a[156:159], v[156:159], 0
v_exp_f32 v110, v110
v_mfma_f32_16x16x32_bf16 a[4:7], a[152:155], v[152:155], a[4:7]
s_waitcnt lgkmcnt(0)
ds_read_b128 a[168:171], v3 offset:19456
v_cvt_pk_bf16_f32 v203, v126, v127
v_mfma_f32_16x16x32_bf16 a[8:11], a[160:163], v[152:155], 0
v_exp_f32 v111, v111
v_mfma_f32_16x16x32_bf16 a[8:11], a[164:167], v[156:159], a[8:11]
ds_read_b128 a[172:175], v3 offset:27648
v_cvt_pk_bf16_f32 v178, v108, v109
v_mfma_f32_16x16x32_bf16 a[40:43], a[164:167], v[164:167], 0
v_exp_f32 v92, v92
v_mfma_f32_16x16x32_bf16 a[40:43], a[160:163], v[160:163], a[40:43]
v_exp_f32 v93, v93
v_mfma_f32_16x16x32_bf16 a[72:75], a[160:163], v[184:187], 0
v_exp_f32 v94, v94
v_mfma_f32_16x16x32_bf16 a[72:75], a[164:167], v[188:191], a[72:75]
buffer_load_dwordx4 v16, s[32:35], s64 offen offset:3072 sc1 lds
v_mfma_f32_16x16x32_bf16 a[104:107], a[164:167], v[196:199], 0
v_exp_f32 v95, v95
v_mfma_f32_16x16x32_bf16 a[104:107], a[160:163], v[192:195], a[104:107]
s_waitcnt lgkmcnt(0)
v_exp_f32 v96, v96
v_mfma_f32_16x16x32_bf16 a[108:111], a[168:171], v[192:195], 0
ds_read_b128 a[176:179], v3 offset:20480
v_cvt_pk_bf16_f32 v179, v110, v111
v_mfma_f32_16x16x32_bf16 a[108:111], a[172:175], v[196:199], a[108:111]
ds_read_b128 a[180:183], v3 offset:28672
v_exp_f32 v97, v97
v_mfma_f32_16x16x32_bf16 a[76:79], a[172:175], v[188:191], 0
v_exp_f32 v98, v98
v_mfma_f32_16x16x32_bf16 a[76:79], a[168:171], v[184:187], a[76:79]
v_exp_f32 v99, v99
v_mfma_f32_16x16x32_bf16 a[44:47], a[168:171], v[160:163], 0
v_cvt_pk_bf16_f32 v170, v92, v93
v_cvt_pk_bf16_f32 v171, v94, v95
v_mfma_f32_16x16x32_bf16 a[44:47], a[172:175], v[164:167], a[44:47]
v_exp_f32 v112, v112
v_mfma_f32_16x16x32_bf16 a[12:15], a[172:175], v[156:159], 0
v_exp_f32 v113, v113
v_mfma_f32_16x16x32_bf16 a[12:15], a[168:171], v[152:155], a[12:15]
s_waitcnt lgkmcnt(0)
ds_read_b128 a[184:187], v3 offset:21504
v_cvt_pk_bf16_f32 v172, v96, v97
v_mfma_f32_16x16x32_bf16 a[16:19], a[176:179], v[152:155], 0
v_exp_f32 v114, v114
v_mfma_f32_16x16x32_bf16 a[16:19], a[180:183], v[156:159], a[16:19]
ds_read_b128 a[188:191], v3 offset:29696
v_xor_b32 v2, 0x8000, v2
v_mfma_f32_16x16x32_bf16 a[48:51], a[180:183], v[164:167], 0
v_exp_f32 v115, v115
v_mfma_f32_16x16x32_bf16 a[48:51], a[176:179], v[160:163], a[48:51]
ds_read_b128 a[192:195], v3 offset:22528
ds_read_b128 a[196:199], v3 offset:30720
ds_read_b128 a[200:203], v3 offset:23552
ds_read_b128 a[204:207], v3 offset:31744
v_cvt_pk_bf16_f32 v173, v98, v99
v_mfma_f32_16x16x32_bf16 a[80:83], a[176:179], v[184:187], 0
s_waitcnt vmcnt(8)
s_barrier
v_exp_f32 v128, v128
v_mfma_f32_16x16x32_bf16 a[80:83], a[180:183], v[188:191], a[80:83]
v_exp_f32 v129, v129
v_mfma_f32_16x16x32_bf16 a[112:115], a[180:183], v[196:199], 0
v_exp_f32 v130, v130
v_mfma_f32_16x16x32_bf16 a[112:115], a[176:179], v[192:195], a[112:115]
s_waitcnt lgkmcnt(4)
v_cvt_pk_bf16_f32 v180, v112, v113
v_cvt_pk_bf16_f32 v181, v114, v115
v_mfma_f32_16x16x32_bf16 a[116:119], a[184:187], v[192:195], 0
s_xor_b32 s71, s71, 49152
v_exp_f32 v131, v131
v_mfma_f32_16x16x32_bf16 a[116:119], a[188:191], v[196:199], a[116:119]
s_add_u32 s70, s70, 32768
v_exp_f32 v144, v144
v_mfma_f32_16x16x32_bf16 a[84:87], a[188:191], v[188:191], 0
s_mov_b32 m0, s71
v_exp_f32 v145, v145
v_mfma_f32_16x16x32_bf16 a[84:87], a[184:187], v[184:187], a[84:87]
buffer_load_dwordx4 v16, s[32:35], s70 offen offset:0 sc1 lds
v_mfma_f32_16x16x32_bf16 a[52:55], a[184:187], v[160:163], 0
v_exp_f32 v146, v146
v_mfma_f32_16x16x32_bf16 a[52:55], a[188:191], v[164:167], a[52:55]
v_cvt_pk_bf16_f32 v204, v128, v129
v_cvt_pk_bf16_f32 v205, v130, v131
v_mfma_f32_16x16x32_bf16 a[20:23], a[188:191], v[156:159], 0
v_exp_f32 v147, v147
v_mfma_f32_16x16x32_bf16 a[20:23], a[184:187], v[152:155], a[20:23]
s_waitcnt lgkmcnt(0)
v_exp_f32 v148, v148
v_mfma_f32_16x16x32_bf16 a[24:27], a[192:195], v[152:155], 0
v_exp_f32 v149, v149
v_mfma_f32_16x16x32_bf16 a[24:27], a[196:199], v[156:159], a[24:27]
v_exp_f32 v150, v150
v_mfma_f32_16x16x32_bf16 a[56:59], a[196:199], v[164:167], 0
v_exp_f32 v151, v151
v_mfma_f32_16x16x32_bf16 a[56:59], a[192:195], v[160:163], a[56:59]
v_cvt_pk_bf16_f32 v212, v144, v145
v_cvt_pk_bf16_f32 v213, v146, v147
v_mfma_f32_16x16x32_bf16 a[88:91], a[192:195], v[184:187], 0
v_exp_f32 v132, v132
v_mfma_f32_16x16x32_bf16 a[88:91], a[196:199], v[188:191], a[88:91]
v_exp_f32 v133, v133
v_mfma_f32_16x16x32_bf16 a[120:123], a[196:199], v[196:199], 0
v_exp_f32 v134, v134
v_mfma_f32_16x16x32_bf16 a[120:123], a[192:195], v[192:195], a[120:123]
v_exp_f32 v135, v135
v_mfma_f32_16x16x32_bf16 a[124:127], a[200:203], v[192:195], 0
v_exp_f32 v116, v116
v_mfma_f32_16x16x32_bf16 a[124:127], a[204:207], v[196:199], a[124:127]
v_cvt_pk_bf16_f32 v214, v148, v149
v_cvt_pk_bf16_f32 v215, v150, v151
v_mfma_f32_16x16x32_bf16 a[92:95], a[204:207], v[188:191], 0
buffer_load_dwordx4 v16, s[32:35], s70 offen offset:1024 sc1 lds
v_mfma_f32_16x16x32_bf16 a[92:95], a[200:203], v[184:187], a[92:95]
s_add_u32 s17, s78, L_D_8-L_pc+0
v_exp_f32 v117, v117
v_mfma_f32_16x16x32_bf16 a[60:63], a[200:203], v[160:163], 0
buffer_load_dword a252, v16, s[88:91], s17 offen
v_mfma_f32_16x16x32_bf16 a[60:63], a[204:207], v[164:167], a[60:63]
v_exp_f32 v118, v118
v_mfma_f32_16x16x32_bf16 a[28:31], a[204:207], v[156:159], 0
s_add_u32 s17, s78, L_D_8-L_pc+4096
v_lshl_add_u32 v19, v0, 24, s66
v_cvt_pk_bf16_f32 v206, v132, v133
v_mfma_f32_16x16x32_bf16 a[28:31], a[200:203], v[152:155], a[28:31]
s_lshr_b32 s67, s31, 4
v_exp_f32 v119, v119
v_mfma_f32_16x16x32_bf16 a[128:131], a[244:247], v[152:155], 0
s_lshl1_add_u32 s67, s3, s67
buffer_load_dword a252, v16, s[88:91], s17 offen
v_mfma_f32_16x16x32_bf16 a[128:131], a[244:247], v[156:159], a[128:131]
s_lshl_b32 s79, s67, 8
v_exp_f32 v100, v100
v_mfma_f32_16x16x32_bf16 a[132:135], a[244:247], v[160:163], 0
s_add_u32 s79, s79, 8192
ds_read_b128 a[144:147], v2 offset:0
v_cvt_pk_bf16_f32 v207, v134, v135
v_mfma_f32_16x16x32_bf16 a[132:135], a[244:247], v[164:167], a[132:135]
s_lshl_b32 s67, s73, 16
s_add_u32 s17, s78, L_D_8-L_pc+8192
ds_read_b128 a[148:151], v2 offset:1024
v_exp_f32 v101, v101
v_mfma_f32_16x16x32_bf16 a[136:139], a[244:247], v[184:187], 0
s_add_u32 s67, s67, s79
buffer_load_dword a252, v16, s[88:91], s17 offen
ds_read_b128 a[152:155], v2 offset:2048
v_exp_f32 v102, v102
v_mfma_f32_16x16x32_bf16 a[136:139], a[244:247], v[188:191], a[136:139]
ds_read_b128 a[156:159], v2 offset:3072
v_cvt_pk_bf16_f32 v182, v116, v117
v_mfma_f32_16x16x32_bf16 a[140:143], a[244:247], v[192:195], 0
s_add_u32 s17, s78, L_D_8-L_pc+12288
v_exp_f32 v103, v103
v_mfma_f32_16x16x32_bf16 a[140:143], a[244:247], v[196:199], a[140:143]
buffer_atomic_add a251, v19, s[52:55], s67 offen offset:0 sc1
buffer_load_dword a252, v16, s[88:91], s17 offen
ds_read_b128 a[160:163], v2 offset:4096
ds_read_b128 a[164:167], v2 offset:5120
ds_read_b128 a[168:171], v2 offset:6144
ds_read_b128 a[172:175], v2 offset:7168
v_cvt_pk_bf16_f32 v183, v118, v119
v_cvt_pk_bf16_f32 v174, v100, v101
v_cvt_pk_bf16_f32 v175, v102, v103
v_xor_b32 v3, 0x8000, v3
s_sub_u32 s72, s3, 1
s_cmp_eq_u32 s72, 0
s_cbranch_scc1 L_DD_9
.p2align 3
L_D_8:
s_waitcnt lgkmcnt(7)
v_mfma_f32_16x16x32_bf16 v[88:91], a[144:147], v[24:27], v[216:219]
s_waitcnt lgkmcnt(6)
ds_read_b128 a[176:179], v2 offset:8192
v_mfma_f32_16x16x32_bf16 v[88:91], a[148:151], v[28:31], v[88:91]
s_waitcnt lgkmcnt(6)
ds_read_b128 a[180:183], v2 offset:9216
v_mfma_f32_16x16x32_bf16 v[88:91], a[152:155], v[32:35], v[88:91]
s_waitcnt lgkmcnt(6)
buffer_load_dwordx4 v16, s[32:35], s70 offen offset:2048 sc1 lds
v_mfma_f32_16x16x32_bf16 v[88:91], a[156:159], v[36:39], v[88:91]
ds_read_b128 a[184:187], v2 offset:10240
v_mfma_f32_16x16x32_bf16 v[104:107], a[156:159], v[52:55], v[220:223]
v_mfma_f32_16x16x32_bf16 v[104:107], a[152:155], v[48:51], v[104:107]
v_mfma_f32_16x16x32_bf16 v[104:107], a[148:151], v[44:47], v[104:107]
ds_read_b128 a[188:191], v2 offset:11264
v_mfma_f32_16x16x32_bf16 v[104:107], a[144:147], v[40:43], v[104:107]
v_mfma_f32_16x16x32_bf16 v[120:123], a[144:147], v[56:59], v[224:227]
v_mfma_f32_16x16x32_bf16 v[120:123], a[148:151], v[60:63], v[120:123]
v_mfma_f32_16x16x32_bf16 v[120:123], a[152:155], v[64:67], v[120:123]
v_exp_f32 v88, v88
v_mfma_f32_16x16x32_bf16 v[120:123], a[156:159], v[68:71], v[120:123]
v_exp_f32 v89, v89
v_mfma_f32_16x16x32_bf16 v[136:139], a[156:159], v[84:87], v[228:231]
v_exp_f32 v90, v90
v_mfma_f32_16x16x32_bf16 v[136:139], a[152:155], v[80:83], v[136:139]
v_exp_f32 v91, v91
v_mfma_f32_16x16x32_bf16 v[136:139], a[148:151], v[76:79], v[136:139]
v_exp_f32 v104, v104
v_mfma_f32_16x16x32_bf16 v[136:139], a[144:147], v[72:75], v[136:139]
s_waitcnt lgkmcnt(0)
v_exp_f32 v105, v105
v_mfma_f32_16x16x32_bf16 v[140:143], a[160:163], v[72:75], v[228:231]
v_exp_f32 v106, v106
v_mfma_f32_16x16x32_bf16 v[140:143], a[164:167], v[76:79], v[140:143]
v_exp_f32 v107, v107
v_mfma_f32_16x16x32_bf16 v[140:143], a[168:171], v[80:83], v[140:143]
buffer_load_dwordx4 v16, s[32:35], s70 offen offset:3072 sc1 lds
v_mfma_f32_16x16x32_bf16 v[140:143], a[172:175], v[84:87], v[140:143]
v_cvt_pk_bf16_f32 v152, v88, v89
v_cvt_pk_bf16_f32 v153, v90, v91
v_mfma_f32_16x16x32_bf16 v[124:127], a[172:175], v[68:71], v[224:227]
v_exp_f32 v120, v120
v_mfma_f32_16x16x32_bf16 v[124:127], a[168:171], v[64:67], v[124:127]
v_exp_f32 v121, v121
v_mfma_f32_16x16x32_bf16 v[124:127], a[164:167], v[60:63], v[124:127]
v_exp_f32 v122, v122
v_mfma_f32_16x16x32_bf16 v[124:127], a[160:163], v[56:59], v[124:127]
v_exp_f32 v123, v123
v_mfma_f32_16x16x32_bf16 v[108:111], a[160:163], v[40:43], v[220:223]
v_exp_f32 v136, v136
v_mfma_f32_16x16x32_bf16 v[108:111], a[164:167], v[44:47], v[108:111]
v_exp_f32 v137, v137
v_mfma_f32_16x16x32_bf16 v[108:111], a[168:171], v[48:51], v[108:111]
v_exp_f32 v138, v138
v_mfma_f32_16x16x32_bf16 v[108:111], a[172:175], v[52:55], v[108:111]
v_cvt_pk_bf16_f32 v160, v104, v105
v_cvt_pk_bf16_f32 v161, v106, v107
v_mfma_f32_16x16x32_bf16 v[92:95], a[172:175], v[36:39], v[216:219]
v_exp_f32 v139, v139
v_mfma_f32_16x16x32_bf16 v[92:95], a[168:171], v[32:35], v[92:95]
ds_read_b128 a[192:195], v2 offset:12288
v_cvt_pk_bf16_f32 v184, v120, v121
v_mfma_f32_16x16x32_bf16 v[92:95], a[164:167], v[28:31], v[92:95]
ds_read_b128 a[196:199], v2 offset:13312
v_cvt_pk_bf16_f32 v185, v122, v123
v_mfma_f32_16x16x32_bf16 v[92:95], a[160:163], v[24:27], v[92:95]
v_exp_f32 v140, v140
v_mfma_f32_16x16x32_bf16 v[96:99], a[176:179], v[24:27], v[216:219]
s_add_u32 m0, s71, 4096
ds_read_b128 a[200:203], v2 offset:14336
v_cvt_pk_bf16_f32 v192, v136, v137
v_mfma_f32_16x16x32_bf16 v[96:99], a[180:183], v[28:31], v[96:99]
s_add_u32 s64, s70, 4096
ds_read_b128 a[204:207], v2 offset:15360
v_cvt_pk_bf16_f32 v193, v138, v139
v_mfma_f32_16x16x32_bf16 v[96:99], a[184:187], v[32:35], v[96:99]
buffer_load_dwordx4 v16, s[32:35], s64 offen offset:0 sc1 lds
v_mfma_f32_16x16x32_bf16 v[96:99], a[188:191], v[36:39], v[96:99]
v_exp_f32 v141, v141
v_mfma_f32_16x16x32_bf16 v[112:115], a[188:191], v[52:55], v[220:223]
v_exp_f32 v142, v142
v_mfma_f32_16x16x32_bf16 v[112:115], a[184:187], v[48:51], v[112:115]
v_exp_f32 v143, v143
v_mfma_f32_16x16x32_bf16 v[112:115], a[180:183], v[44:47], v[112:115]
v_exp_f32 v124, v124
v_mfma_f32_16x16x32_bf16 v[112:115], a[176:179], v[40:43], v[112:115]
v_exp_f32 v125, v125
v_mfma_f32_16x16x32_bf16 v[128:131], a[176:179], v[56:59], v[224:227]
v_exp_f32 v126, v126
v_mfma_f32_16x16x32_bf16 v[128:131], a[180:183], v[60:63], v[128:131]
v_exp_f32 v127, v127
v_mfma_f32_16x16x32_bf16 v[128:131], a[184:187], v[64:67], v[128:131]
ds_read_b128 a[144:147], v3 offset:0
v_cvt_pk_bf16_f32 v194, v140, v141
v_mfma_f32_16x16x32_bf16 v[128:131], a[188:191], v[68:71], v[128:131]
ds_read_b128 a[148:151], v3 offset:8192
v_cvt_pk_bf16_f32 v195, v142, v143
v_mfma_f32_16x16x32_bf16 v[144:147], a[188:191], v[84:87], v[228:231]
v_exp_f32 v108, v108
v_mfma_f32_16x16x32_bf16 v[144:147], a[184:187], v[80:83], v[144:147]
v_exp_f32 v109, v109
v_mfma_f32_16x16x32_bf16 v[144:147], a[180:183], v[76:79], v[144:147]
v_exp_f32 v110, v110
v_mfma_f32_16x16x32_bf16 v[144:147], a[176:179], v[72:75], v[144:147]
s_waitcnt lgkmcnt(2)
v_exp_f32 v111, v111
v_mfma_f32_16x16x32_bf16 v[148:151], a[192:195], v[72:75], v[228:231]
ds_read_b128 a[152:155], v3 offset:1024
v_cvt_pk_bf16_f32 v186, v124, v125
v_mfma_f32_16x16x32_bf16 v[148:151], a[196:199], v[76:79], v[148:151]
v_exp_f32 v92, v92
v_mfma_f32_16x16x32_bf16 v[148:151], a[200:203], v[80:83], v[148:151]
buffer_load_dwordx4 v16, s[32:35], s64 offen offset:1024 sc1 lds
v_mfma_f32_16x16x32_bf16 v[148:151], a[204:207], v[84:87], v[148:151]
ds_read_b128 a[156:159], v3 offset:9216
v_cvt_pk_bf16_f32 v187, v126, v127
v_mfma_f32_16x16x32_bf16 v[132:135], a[204:207], v[68:71], v[224:227]
v_exp_f32 v93, v93
v_mfma_f32_16x16x32_bf16 v[132:135], a[200:203], v[64:67], v[132:135]
v_exp_f32 v94, v94
v_mfma_f32_16x16x32_bf16 v[132:135], a[196:199], v[60:63], v[132:135]
v_exp_f32 v95, v95
v_mfma_f32_16x16x32_bf16 v[132:135], a[192:195], v[56:59], v[132:135]
v_exp_f32 v96, v96
v_mfma_f32_16x16x32_bf16 v[116:119], a[192:195], v[40:43], v[220:223]
ds_read_b128 a[160:163], v3 offset:2048
v_cvt_pk_bf16_f32 v162, v108, v109
v_mfma_f32_16x16x32_bf16 v[116:119], a[196:199], v[44:47], v[116:119]
ds_read_b128 a[164:167], v3 offset:10240
v_cvt_pk_bf16_f32 v163, v110, v111
v_mfma_f32_16x16x32_bf16 v[116:119], a[200:203], v[48:51], v[116:119]
v_exp_f32 v97, v97
v_mfma_f32_16x16x32_bf16 v[116:119], a[204:207], v[52:55], v[116:119]
v_exp_f32 v98, v98
v_mfma_f32_16x16x32_bf16 v[100:103], a[204:207], v[36:39], v[216:219]
v_exp_f32 v99, v99
v_mfma_f32_16x16x32_bf16 v[100:103], a[200:203], v[32:35], v[100:103]
v_exp_f32 v112, v112
v_mfma_f32_16x16x32_bf16 v[100:103], a[196:199], v[28:31], v[100:103]
ds_read_b128 a[168:171], v3 offset:3072
v_cvt_pk_bf16_f32 v154, v92, v93
v_mfma_f32_16x16x32_bf16 v[100:103], a[192:195], v[24:27], v[100:103]
s_waitcnt lgkmcnt(1)
ds_read_b128 a[172:175], v3 offset:11264
v_cvt_pk_bf16_f32 v155, v94, v95
v_mfma_f32_16x16x32_bf16 a[0:3], a[144:147], v[168:171], a[0:3]
v_exp_f32 v113, v113
v_mfma_f32_16x16x32_bf16 a[0:3], a[148:151], v[172:175], a[0:3]
v_exp_f32 v114, v114
v_mfma_f32_16x16x32_bf16 a[32:35], a[148:151], v[180:183], a[32:35]
buffer_load_dwordx4 v16, s[32:35], s64 offen offset:2048 sc1 lds
v_mfma_f32_16x16x32_bf16 a[32:35], a[144:147], v[176:179], a[32:35]
v_exp_f32 v115, v115
v_mfma_f32_16x16x32_bf16 a[64:67], a[144:147], v[200:203], a[64:67]
v_exp_f32 v128, v128
v_mfma_f32_16x16x32_bf16 a[64:67], a[148:151], v[204:207], a[64:67]
ds_read_b128 a[176:179], v3 offset:4096
v_cvt_pk_bf16_f32 v156, v96, v97
v_mfma_f32_16x16x32_bf16 a[96:99], a[148:151], v[212:215], a[96:99]
ds_read_b128 a[180:183], v3 offset:12288
v_cvt_pk_bf16_f32 v157, v98, v99
v_mfma_f32_16x16x32_bf16 a[96:99], a[144:147], v[208:211], a[96:99]
v_exp_f32 v129, v129
v_mfma_f32_16x16x32_bf16 a[100:103], a[152:155], v[208:211], a[100:103]
v_exp_f32 v130, v130
v_mfma_f32_16x16x32_bf16 a[100:103], a[156:159], v[212:215], a[100:103]
v_exp_f32 v131, v131
v_mfma_f32_16x16x32_bf16 a[68:71], a[156:159], v[204:207], a[68:71]
v_exp_f32 v144, v144
v_mfma_f32_16x16x32_bf16 a[68:71], a[152:155], v[200:203], a[68:71]
ds_read_b128 a[184:187], v3 offset:5120
v_cvt_pk_bf16_f32 v164, v112, v113
v_mfma_f32_16x16x32_bf16 a[36:39], a[152:155], v[176:179], a[36:39]
ds_read_b128 a[188:191], v3 offset:13312
v_cvt_pk_bf16_f32 v165, v114, v115
v_mfma_f32_16x16x32_bf16 a[36:39], a[156:159], v[180:183], a[36:39]
v_exp_f32 v145, v145
v_mfma_f32_16x16x32_bf16 a[4:7], a[156:159], v[172:175], a[4:7]
ds_read_b128 a[192:195], v3 offset:6144
v_cvt_pk_bf16_f32 v188, v128, v129
v_mfma_f32_16x16x32_bf16 a[4:7], a[152:155], v[168:171], a[4:7]
v_exp_f32 v146, v146
v_mfma_f32_16x16x32_bf16 a[8:11], a[160:163], v[168:171], a[8:11]
v_exp_f32 v147, v147
v_mfma_f32_16x16x32_bf16 a[8:11], a[164:167], v[172:175], a[8:11]
ds_read_b128 a[196:199], v3 offset:14336
v_cvt_pk_bf16_f32 v189, v130, v131
v_mfma_f32_16x16x32_bf16 a[40:43], a[164:167], v[180:183], a[40:43]
buffer_load_dwordx4 v16, s[32:35], s64 offen offset:3072 sc1 lds
v_mfma_f32_16x16x32_bf16 a[40:43], a[160:163], v[176:179], a[40:43]
v_exp_f32 v148, v148
v_mfma_f32_16x16x32_bf16 a[72:75], a[160:163], v[200:203], a[72:75]
v_exp_f32 v149, v149
v_mfma_f32_16x16x32_bf16 a[72:75], a[164:167], v[204:207], a[72:75]
ds_read_b128 a[200:203], v3 offset:7168
v_cvt_pk_bf16_f32 v196, v144, v145
v_mfma_f32_16x16x32_bf16 a[104:107], a[164:167], v[212:215], a[104:107]
v_exp_f32 v150, v150
v_mfma_f32_16x16x32_bf16 a[104:107], a[160:163], v[208:211], a[104:107]
s_waitcnt lgkmcnt(1)
v_exp_f32 v151, v151
v_mfma_f32_16x16x32_bf16 a[108:111], a[168:171], v[208:211], a[108:111]
v_exp_f32 v132, v132
v_mfma_f32_16x16x32_bf16 a[108:111], a[172:175], v[212:215], a[108:111]
ds_read_b128 a[204:207], v3 offset:15360
v_cvt_pk_bf16_f32 v197, v146, v147
v_mfma_f32_16x16x32_bf16 a[76:79], a[172:175], v[204:207], a[76:79]
v_exp_f32 v133, v133
v_mfma_f32_16x16x32_bf16 a[76:79], a[168:171], v[200:203], a[76:79]
v_exp_f32 v134, v134
v_mfma_f32_16x16x32_bf16 a[44:47], a[168:171], v[176:179], a[44:47]
v_exp_f32 v135, v135
v_mfma_f32_16x16x32_bf16 a[44:47], a[172:175], v[180:183], a[44:47]
v_exp_f32 v116, v116
v_mfma_f32_16x16x32_bf16 a[12:15], a[172:175], v[172:175], a[12:15]
v_exp_f32 v117, v117
v_mfma_f32_16x16x32_bf16 a[12:15], a[168:171], v[168:171], a[12:15]
v_exp_f32 v118, v118
v_mfma_f32_16x16x32_bf16 a[16:19], a[176:179], v[168:171], a[16:19]
v_exp_f32 v119, v119
v_mfma_f32_16x16x32_bf16 a[16:19], a[180:183], v[172:175], a[16:19]
v_exp_f32 v100, v100
v_mfma_f32_16x16x32_bf16 a[48:51], a[180:183], v[180:183], a[48:51]
v_exp_f32 v101, v101
v_mfma_f32_16x16x32_bf16 a[48:51], a[176:179], v[176:179], a[48:51]
v_exp_f32 v102, v102
v_mfma_f32_16x16x32_bf16 a[80:83], a[176:179], v[200:203], a[80:83]
s_waitcnt vmcnt(8)
s_barrier
v_mfma_f32_16x16x32_bf16 a[80:83], a[180:183], v[204:207], a[80:83]
s_xor_b32 s71, s71, 16384
ds_read_b128 a[144:147], v2 offset:16384
v_cvt_pk_bf16_f32 v198, v148, v149
v_mfma_f32_16x16x32_bf16 a[112:115], a[180:183], v[212:215], a[112:115]
s_add_u32 s70, s70, 32768
ds_read_b128 a[148:151], v2 offset:17408
v_cvt_pk_bf16_f32 v199, v150, v151
v_mfma_f32_16x16x32_bf16 a[112:115], a[176:179], v[208:211], a[112:115]
s_mov_b32 m0, s71
ds_read_b128 a[152:155], v2 offset:18432
v_cvt_pk_bf16_f32 v190, v132, v133
v_mfma_f32_16x16x32_bf16 a[116:119], a[184:187], v[208:211], a[116:119]
buffer_load_dwordx4 v16, s[32:35], s70 offen offset:0 sc1 lds
v_mfma_f32_16x16x32_bf16 a[116:119], a[188:191], v[212:215], a[116:119]
ds_read_b128 a[156:159], v2 offset:19456
v_cvt_pk_bf16_f32 v191, v134, v135
v_mfma_f32_16x16x32_bf16 a[84:87], a[188:191], v[204:207], a[84:87]
v_exp_f32 v103, v103
v_mfma_f32_16x16x32_bf16 a[84:87], a[184:187], v[200:203], a[84:87]
ds_read_b128 a[160:163], v2 offset:20480
v_cvt_pk_bf16_f32 v166, v116, v117
v_mfma_f32_16x16x32_bf16 a[52:55], a[184:187], v[176:179], a[52:55]
ds_read_b128 a[164:167], v2 offset:21504
v_cvt_pk_bf16_f32 v167, v118, v119
v_mfma_f32_16x16x32_bf16 a[52:55], a[188:191], v[180:183], a[52:55]
ds_read_b128 a[168:171], v2 offset:22528
v_cvt_pk_bf16_f32 v158, v100, v101
v_mfma_f32_16x16x32_bf16 a[20:23], a[188:191], v[172:175], a[20:23]
ds_read_b128 a[172:175], v2 offset:23552
v_cvt_pk_bf16_f32 v159, v102, v103
v_mfma_f32_16x16x32_bf16 a[20:23], a[184:187], v[168:171], a[20:23]
v_mfma_f32_16x16x32_bf16 a[24:27], a[192:195], v[168:171], a[24:27]
v_mfma_f32_16x16x32_bf16 a[24:27], a[196:199], v[172:175], a[24:27]
v_mfma_f32_16x16x32_bf16 a[56:59], a[196:199], v[180:183], a[56:59]
v_mfma_f32_16x16x32_bf16 a[56:59], a[192:195], v[176:179], a[56:59]
v_mfma_f32_16x16x32_bf16 a[88:91], a[192:195], v[200:203], a[88:91]
v_mfma_f32_16x16x32_bf16 a[88:91], a[196:199], v[204:207], a[88:91]
v_mfma_f32_16x16x32_bf16 a[120:123], a[196:199], v[212:215], a[120:123]
v_mfma_f32_16x16x32_bf16 a[120:123], a[192:195], v[208:211], a[120:123]
s_waitcnt lgkmcnt(0)
v_mfma_f32_16x16x32_bf16 a[124:127], a[200:203], v[208:211], a[124:127]
buffer_load_dwordx4 v16, s[32:35], s70 offen offset:1024 sc1 lds
v_mfma_f32_16x16x32_bf16 a[124:127], a[204:207], v[212:215], a[124:127]
v_mfma_f32_16x16x32_bf16 a[92:95], a[204:207], v[204:207], a[92:95]
v_mfma_f32_16x16x32_bf16 a[92:95], a[200:203], v[200:203], a[92:95]
v_mfma_f32_16x16x32_bf16 a[60:63], a[200:203], v[176:179], a[60:63]
v_mfma_f32_16x16x32_bf16 a[60:63], a[204:207], v[180:183], a[60:63]
v_mfma_f32_16x16x32_bf16 a[28:31], a[204:207], v[172:175], a[28:31]
v_mfma_f32_16x16x32_bf16 a[28:31], a[200:203], v[168:171], a[28:31]
v_mfma_f32_16x16x32_bf16 a[128:131], a[244:247], v[168:171], a[128:131]
v_mfma_f32_16x16x32_bf16 a[128:131], a[244:247], v[172:175], a[128:131]
v_mfma_f32_16x16x32_bf16 a[132:135], a[244:247], v[176:179], a[132:135]
v_mfma_f32_16x16x32_bf16 a[132:135], a[244:247], v[180:183], a[132:135]
v_mfma_f32_16x16x32_bf16 a[136:139], a[244:247], v[200:203], a[136:139]
v_mfma_f32_16x16x32_bf16 a[136:139], a[244:247], v[204:207], a[136:139]
v_mfma_f32_16x16x32_bf16 a[140:143], a[244:247], v[208:211], a[140:143]
v_mfma_f32_16x16x32_bf16 a[140:143], a[244:247], v[212:215], a[140:143]
v_mfma_f32_16x16x32_bf16 v[88:91], a[144:147], v[24:27], v[216:219]
ds_read_b128 a[176:179], v2 offset:24576
v_mfma_f32_16x16x32_bf16 v[88:91], a[148:151], v[28:31], v[88:91]
ds_read_b128 a[180:183], v2 offset:25600
v_mfma_f32_16x16x32_bf16 v[88:91], a[152:155], v[32:35], v[88:91]
buffer_load_dwordx4 v16, s[32:35], s70 offen offset:2048 sc1 lds
v_mfma_f32_16x16x32_bf16 v[88:91], a[156:159], v[36:39], v[88:91]
ds_read_b128 a[184:187], v2 offset:26624
v_mfma_f32_16x16x32_bf16 v[104:107], a[156:159], v[52:55], v[220:223]
v_mfma_f32_16x16x32_bf16 v[104:107], a[152:155], v[48:51], v[104:107]
v_mfma_f32_16x16x32_bf16 v[104:107], a[148:151], v[44:47], v[104:107]
ds_read_b128 a[188:191], v2 offset:27648
v_mfma_f32_16x16x32_bf16 v[104:107], a[144:147], v[40:43], v[104:107]
v_mfma_f32_16x16x32_bf16 v[120:123], a[144:147], v[56:59], v[224:227]
v_mfma_f32_16x16x32_bf16 v[120:123], a[148:151], v[60:63], v[120:123]
v_mfma_f32_16x16x32_bf16 v[120:123], a[152:155], v[64:67], v[120:123]
v_exp_f32 v88, v88
v_mfma_f32_16x16x32_bf16 v[120:123], a[156:159], v[68:71], v[120:123]
v_exp_f32 v89, v89
v_mfma_f32_16x16x32_bf16 v[136:139], a[156:159], v[84:87], v[228:231]
v_exp_f32 v90, v90
v_mfma_f32_16x16x32_bf16 v[136:139], a[152:155], v[80:83], v[136:139]
v_exp_f32 v91, v91
v_mfma_f32_16x16x32_bf16 v[136:139], a[148:151], v[76:79], v[136:139]
v_exp_f32 v104, v104
v_mfma_f32_16x16x32_bf16 v[136:139], a[144:147], v[72:75], v[136:139]
v_exp_f32 v105, v105
v_mfma_f32_16x16x32_bf16 v[140:143], a[160:163], v[72:75], v[228:231]
v_exp_f32 v106, v106
v_mfma_f32_16x16x32_bf16 v[140:143], a[164:167], v[76:79], v[140:143]
v_exp_f32 v107, v107
v_mfma_f32_16x16x32_bf16 v[140:143], a[168:171], v[80:83], v[140:143]
buffer_load_dwordx4 v16, s[32:35], s70 offen offset:3072 sc1 lds
v_mfma_f32_16x16x32_bf16 v[140:143], a[172:175], v[84:87], v[140:143]
v_cvt_pk_bf16_f32 v168, v88, v89
v_cvt_pk_bf16_f32 v169, v90, v91
v_mfma_f32_16x16x32_bf16 v[124:127], a[172:175], v[68:71], v[224:227]
v_exp_f32 v120, v120
v_mfma_f32_16x16x32_bf16 v[124:127], a[168:171], v[64:67], v[124:127]
v_exp_f32 v121, v121
v_mfma_f32_16x16x32_bf16 v[124:127], a[164:167], v[60:63], v[124:127]
v_exp_f32 v122, v122
v_mfma_f32_16x16x32_bf16 v[124:127], a[160:163], v[56:59], v[124:127]
v_exp_f32 v123, v123
v_mfma_f32_16x16x32_bf16 v[108:111], a[160:163], v[40:43], v[220:223]
v_exp_f32 v136, v136
v_mfma_f32_16x16x32_bf16 v[108:111], a[164:167], v[44:47], v[108:111]
v_exp_f32 v137, v137
v_mfma_f32_16x16x32_bf16 v[108:111], a[168:171], v[48:51], v[108:111]
v_exp_f32 v138, v138
v_mfma_f32_16x16x32_bf16 v[108:111], a[172:175], v[52:55], v[108:111]
v_cvt_pk_bf16_f32 v176, v104, v105
v_cvt_pk_bf16_f32 v177, v106, v107
v_mfma_f32_16x16x32_bf16 v[92:95], a[172:175], v[36:39], v[216:219]
v_exp_f32 v139, v139
v_mfma_f32_16x16x32_bf16 v[92:95], a[168:171], v[32:35], v[92:95]
ds_read_b128 a[192:195], v2 offset:28672
v_cvt_pk_bf16_f32 v200, v120, v121
v_mfma_f32_16x16x32_bf16 v[92:95], a[164:167], v[28:31], v[92:95]
ds_read_b128 a[196:199], v2 offset:29696
v_cvt_pk_bf16_f32 v201, v122, v123
v_mfma_f32_16x16x32_bf16 v[92:95], a[160:163], v[24:27], v[92:95]
s_waitcnt lgkmcnt(2)
v_exp_f32 v140, v140
v_mfma_f32_16x16x32_bf16 v[96:99], a[176:179], v[24:27], v[216:219]
s_add_u32 m0, s71, 4096
ds_read_b128 a[200:203], v2 offset:30720
v_cvt_pk_bf16_f32 v208, v136, v137
v_mfma_f32_16x16x32_bf16 v[96:99], a[180:183], v[28:31], v[96:99]
s_add_u32 s64, s70, 4096
ds_read_b128 a[204:207], v2 offset:31744
v_cvt_pk_bf16_f32 v209, v138, v139
v_mfma_f32_16x16x32_bf16 v[96:99], a[184:187], v[32:35], v[96:99]
buffer_load_dwordx4 v16, s[32:35], s64 offen offset:0 sc1 lds
v_mfma_f32_16x16x32_bf16 v[96:99], a[188:191], v[36:39], v[96:99]
v_exp_f32 v141, v141
v_mfma_f32_16x16x32_bf16 v[112:115], a[188:191], v[52:55], v[220:223]
v_exp_f32 v142, v142
v_mfma_f32_16x16x32_bf16 v[112:115], a[184:187], v[48:51], v[112:115]
v_exp_f32 v143, v143
v_mfma_f32_16x16x32_bf16 v[112:115], a[180:183], v[44:47], v[112:115]
v_exp_f32 v124, v124
v_mfma_f32_16x16x32_bf16 v[112:115], a[176:179], v[40:43], v[112:115]
v_exp_f32 v125, v125
v_mfma_f32_16x16x32_bf16 v[128:131], a[176:179], v[56:59], v[224:227]
v_exp_f32 v126, v126
v_mfma_f32_16x16x32_bf16 v[128:131], a[180:183], v[60:63], v[128:131]
v_exp_f32 v127, v127
v_mfma_f32_16x16x32_bf16 v[128:131], a[184:187], v[64:67], v[128:131]
ds_read_b128 a[144:147], v3 offset:16384
v_cvt_pk_bf16_f32 v210, v140, v141
v_mfma_f32_16x16x32_bf16 v[128:131], a[188:191], v[68:71], v[128:131]
ds_read_b128 a[148:151], v3 offset:24576
v_cvt_pk_bf16_f32 v211, v142, v143
v_mfma_f32_16x16x32_bf16 v[144:147], a[188:191], v[84:87], v[228:231]
v_exp_f32 v108, v108
v_mfma_f32_16x16x32_bf16 v[144:147], a[184:187], v[80:83], v[144:147]
v_exp_f32 v109, v109
v_mfma_f32_16x16x32_bf16 v[144:147], a[180:183], v[76:79], v[144:147]
v_exp_f32 v110, v110
v_mfma_f32_16x16x32_bf16 v[144:147], a[176:179], v[72:75], v[144:147]
s_waitcnt lgkmcnt(2)
v_exp_f32 v111, v111
v_mfma_f32_16x16x32_bf16 v[148:151], a[192:195], v[72:75], v[228:231]
ds_read_b128 a[152:155], v3 offset:17408
v_cvt_pk_bf16_f32 v202, v124, v125
v_mfma_f32_16x16x32_bf16 v[148:151], a[196:199], v[76:79], v[148:151]
v_exp_f32 v92, v92
v_mfma_f32_16x16x32_bf16 v[148:151], a[200:203], v[80:83], v[148:151]
buffer_load_dwordx4 v16, s[32:35], s64 offen offset:1024 sc1 lds
v_mfma_f32_16x16x32_bf16 v[148:151], a[204:207], v[84:87], v[148:151]
ds_read_b128 a[156:159], v3 offset:25600
v_cvt_pk_bf16_f32 v203, v126, v127
v_mfma_f32_16x16x32_bf16 v[132:135], a[204:207], v[68:71], v[224:227]
v_exp_f32 v93, v93
v_mfma_f32_16x16x32_bf16 v[132:135], a[200:203], v[64:67], v[132:135]
v_exp_f32 v94, v94
v_mfma_f32_16x16x32_bf16 v[132:135], a[196:199], v[60:63], v[132:135]
v_exp_f32 v95, v95
v_mfma_f32_16x16x32_bf16 v[132:135], a[192:195], v[56:59], v[132:135]
v_exp_f32 v96, v96
v_mfma_f32_16x16x32_bf16 v[116:119], a[192:195], v[40:43], v[220:223]
ds_read_b128 a[160:163], v3 offset:18432
v_cvt_pk_bf16_f32 v178, v108, v109
v_mfma_f32_16x16x32_bf16 v[116:119], a[196:199], v[44:47], v[116:119]
ds_read_b128 a[164:167], v3 offset:26624
v_cvt_pk_bf16_f32 v179, v110, v111
v_mfma_f32_16x16x32_bf16 v[116:119], a[200:203], v[48:51], v[116:119]
v_exp_f32 v97, v97
v_mfma_f32_16x16x32_bf16 v[116:119], a[204:207], v[52:55], v[116:119]
v_exp_f32 v98, v98
v_mfma_f32_16x16x32_bf16 v[100:103], a[204:207], v[36:39], v[216:219]
v_exp_f32 v99, v99
v_mfma_f32_16x16x32_bf16 v[100:103], a[200:203], v[32:35], v[100:103]
v_exp_f32 v112, v112
v_mfma_f32_16x16x32_bf16 v[100:103], a[196:199], v[28:31], v[100:103]
ds_read_b128 a[168:171], v3 offset:19456
v_cvt_pk_bf16_f32 v170, v92, v93
v_mfma_f32_16x16x32_bf16 v[100:103], a[192:195], v[24:27], v[100:103]
s_waitcnt lgkmcnt(1)
ds_read_b128 a[172:175], v3 offset:27648
v_cvt_pk_bf16_f32 v171, v94, v95
v_mfma_f32_16x16x32_bf16 a[0:3], a[144:147], v[152:155], a[0:3]
v_exp_f32 v113, v113
v_mfma_f32_16x16x32_bf16 a[0:3], a[148:151], v[156:159], a[0:3]
v_exp_f32 v114, v114
v_mfma_f32_16x16x32_bf16 a[32:35], a[148:151], v[164:167], a[32:35]
buffer_load_dwordx4 v16, s[32:35], s64 offen offset:2048 sc1 lds
v_mfma_f32_16x16x32_bf16 a[32:35], a[144:147], v[160:163], a[32:35]
v_exp_f32 v115, v115
v_mfma_f32_16x16x32_bf16 a[64:67], a[144:147], v[184:187], a[64:67]
v_exp_f32 v128, v128
v_mfma_f32_16x16x32_bf16 a[64:67], a[148:151], v[188:191], a[64:67]
ds_read_b128 a[176:179], v3 offset:20480
v_cvt_pk_bf16_f32 v172, v96, v97
v_mfma_f32_16x16x32_bf16 a[96:99], a[148:151], v[196:199], a[96:99]
ds_read_b128 a[180:183], v3 offset:28672
v_cvt_pk_bf16_f32 v173, v98, v99
v_mfma_f32_16x16x32_bf16 a[96:99], a[144:147], v[192:195], a[96:99]
v_exp_f32 v129, v129
v_mfma_f32_16x16x32_bf16 a[100:103], a[152:155], v[192:195], a[100:103]
v_exp_f32 v130, v130
v_mfma_f32_16x16x32_bf16 a[100:103], a[156:159], v[196:199], a[100:103]
v_exp_f32 v131, v131
v_mfma_f32_16x16x32_bf16 a[68:71], a[156:159], v[188:191], a[68:71]
v_exp_f32 v144, v144
v_mfma_f32_16x16x32_bf16 a[68:71], a[152:155], v[184:187], a[68:71]
ds_read_b128 a[184:187], v3 offset:21504
v_cvt_pk_bf16_f32 v180, v112, v113
v_mfma_f32_16x16x32_bf16 a[36:39], a[152:155], v[160:163], a[36:39]
ds_read_b128 a[188:191], v3 offset:29696
v_cvt_pk_bf16_f32 v181, v114, v115
v_mfma_f32_16x16x32_bf16 a[36:39], a[156:159], v[164:167], a[36:39]
v_exp_f32 v145, v145
v_mfma_f32_16x16x32_bf16 a[4:7], a[156:159], v[156:159], a[4:7]
v_xor_b32 v2, 0x8000, v2
v_cvt_pk_bf16_f32 v204, v128, v129
v_mfma_f32_16x16x32_bf16 a[4:7], a[152:155], v[152:155], a[4:7]
ds_read_b128 a[192:195], v3 offset:22528
v_cvt_pk_bf16_f32 v205, v130, v131
v_mfma_f32_16x16x32_bf16 a[8:11], a[160:163], v[152:155], a[8:11]
v_exp_f32 v146, v146
v_mfma_f32_16x16x32_bf16 a[8:11], a[164:167], v[156:159], a[8:11]
ds_read_b128 a[196:199], v3 offset:30720
v_cvt_pk_bf16_f32 v212, v144, v145
v_mfma_f32_16x16x32_bf16 a[40:43], a[164:167], v[164:167], a[40:43]
buffer_load_dwordx4 v16, s[32:35], s64 offen offset:3072 sc1 lds
v_mfma_f32_16x16x32_bf16 a[40:43], a[160:163], v[160:163], a[40:43]
v_exp_f32 v147, v147
v_mfma_f32_16x16x32_bf16 a[72:75], a[160:163], v[184:187], a[72:75]
v_exp_f32 v148, v148
v_mfma_f32_16x16x32_bf16 a[72:75], a[164:167], v[188:191], a[72:75]
ds_read_b128 a[200:203], v3 offset:23552
v_cvt_pk_bf16_f32 v213, v146, v147
v_mfma_f32_16x16x32_bf16 a[104:107], a[164:167], v[196:199], a[104:107]
v_exp_f32 v149, v149
v_mfma_f32_16x16x32_bf16 a[104:107], a[160:163], v[192:195], a[104:107]
s_waitcnt lgkmcnt(1)
v_exp_f32 v150, v150
v_mfma_f32_16x16x32_bf16 a[108:111], a[168:171], v[192:195], a[108:111]
v_exp_f32 v151, v151
v_mfma_f32_16x16x32_bf16 a[108:111], a[172:175], v[196:199], a[108:111]
ds_read_b128 a[204:207], v3 offset:31744
v_cvt_pk_bf16_f32 v214, v148, v149
v_mfma_f32_16x16x32_bf16 a[76:79], a[172:175], v[188:191], a[76:79]
v_exp_f32 v132, v132
v_mfma_f32_16x16x32_bf16 a[76:79], a[168:171], v[184:187], a[76:79]
v_exp_f32 v133, v133
v_mfma_f32_16x16x32_bf16 a[44:47], a[168:171], v[160:163], a[44:47]
v_exp_f32 v134, v134
v_mfma_f32_16x16x32_bf16 a[44:47], a[172:175], v[164:167], a[44:47]
v_exp_f32 v135, v135
v_mfma_f32_16x16x32_bf16 a[12:15], a[172:175], v[156:159], a[12:15]
v_exp_f32 v116, v116
v_mfma_f32_16x16x32_bf16 a[12:15], a[168:171], v[152:155], a[12:15]
v_exp_f32 v117, v117
v_mfma_f32_16x16x32_bf16 a[16:19], a[176:179], v[152:155], a[16:19]
v_exp_f32 v118, v118
v_mfma_f32_16x16x32_bf16 a[16:19], a[180:183], v[156:159], a[16:19]
v_exp_f32 v119, v119
v_mfma_f32_16x16x32_bf16 a[48:51], a[180:183], v[164:167], a[48:51]
v_exp_f32 v100, v100
v_mfma_f32_16x16x32_bf16 a[48:51], a[176:179], v[160:163], a[48:51]
v_exp_f32 v101, v101
v_mfma_f32_16x16x32_bf16 a[80:83], a[176:179], v[184:187], a[80:83]
s_waitcnt vmcnt(8)
s_barrier
v_mfma_f32_16x16x32_bf16 a[80:83], a[180:183], v[188:191], a[80:83]
s_xor_b32 s71, s71, 49152
ds_read_b128 a[144:147], v2 offset:0
v_cvt_pk_bf16_f32 v215, v150, v151
v_mfma_f32_16x16x32_bf16 a[112:115], a[180:183], v[196:199], a[112:115]
s_add_u32 s70, s70, 32768
ds_read_b128 a[148:151], v2 offset:1024
v_cvt_pk_bf16_f32 v206, v132, v133
v_mfma_f32_16x16x32_bf16 a[112:115], a[176:179], v[192:195], a[112:115]
s_mov_b32 m0, s71
v_exp_f32 v102, v102
v_mfma_f32_16x16x32_bf16 a[116:119], a[184:187], v[192:195], a[116:119]
buffer_load_dwordx4 v16, s[32:35], s70 offen offset:0 sc1 lds
v_mfma_f32_16x16x32_bf16 a[116:119], a[188:191], v[196:199], a[116:119]
ds_read_b128 a[152:155], v2 offset:2048
v_cvt_pk_bf16_f32 v207, v134, v135
v_mfma_f32_16x16x32_bf16 a[84:87], a[188:191], v[188:191], a[84:87]
ds_read_b128 a[156:159], v2 offset:3072
v_cvt_pk_bf16_f32 v182, v116, v117
v_mfma_f32_16x16x32_bf16 a[84:87], a[184:187], v[184:187], a[84:87]
v_exp_f32 v103, v103
v_mfma_f32_16x16x32_bf16 a[52:55], a[184:187], v[160:163], a[52:55]
ds_read_b128 a[160:163], v2 offset:4096
v_cvt_pk_bf16_f32 v183, v118, v119
v_mfma_f32_16x16x32_bf16 a[52:55], a[188:191], v[164:167], a[52:55]
ds_read_b128 a[164:167], v2 offset:5120
v_cvt_pk_bf16_f32 v174, v100, v101
v_mfma_f32_16x16x32_bf16 a[20:23], a[188:191], v[156:159], a[20:23]
ds_read_b128 a[168:171], v2 offset:6144
v_cvt_pk_bf16_f32 v175, v102, v103
v_mfma_f32_16x16x32_bf16 a[20:23], a[184:187], v[152:155], a[20:23]
ds_read_b128 a[172:175], v2 offset:7168
v_xor_b32 v3, 0x8000, v3
v_mfma_f32_16x16x32_bf16 a[24:27], a[192:195], v[152:155], a[24:27]
v_mfma_f32_16x16x32_bf16 a[24:27], a[196:199], v[156:159], a[24:27]
v_mfma_f32_16x16x32_bf16 a[56:59], a[196:199], v[164:167], a[56:59]
v_mfma_f32_16x16x32_bf16 a[56:59], a[192:195], v[160:163], a[56:59]
v_mfma_f32_16x16x32_bf16 a[88:91], a[192:195], v[184:187], a[88:91]
v_mfma_f32_16x16x32_bf16 a[88:91], a[196:199], v[188:191], a[88:91]
v_mfma_f32_16x16x32_bf16 a[120:123], a[196:199], v[196:199], a[120:123]
v_mfma_f32_16x16x32_bf16 a[120:123], a[192:195], v[192:195], a[120:123]
s_waitcnt lgkmcnt(0)
v_mfma_f32_16x16x32_bf16 a[124:127], a[200:203], v[192:195], a[124:127]
buffer_load_dwordx4 v16, s[32:35], s70 offen offset:1024 sc1 lds
v_mfma_f32_16x16x32_bf16 a[124:127], a[204:207], v[196:199], a[124:127]
v_mfma_f32_16x16x32_bf16 a[92:95], a[204:207], v[188:191], a[92:95]
v_mfma_f32_16x16x32_bf16 a[92:95], a[200:203], v[184:187], a[92:95]
v_mfma_f32_16x16x32_bf16 a[60:63], a[200:203], v[160:163], a[60:63]
v_mfma_f32_16x16x32_bf16 a[60:63], a[204:207], v[164:167], a[60:63]
s_sub_u32 s72, s72, 1
v_mfma_f32_16x16x32_bf16 a[28:31], a[204:207], v[156:159], a[28:31]
v_mfma_f32_16x16x32_bf16 a[28:31], a[200:203], v[152:155], a[28:31]
v_mfma_f32_16x16x32_bf16 a[128:131], a[244:247], v[152:155], a[128:131]
v_mfma_f32_16x16x32_bf16 a[128:131], a[244:247], v[156:159], a[128:131]
s_cmp_lg_u32 s72, 0
v_mfma_f32_16x16x32_bf16 a[132:135], a[244:247], v[160:163], a[132:135]
v_mfma_f32_16x16x32_bf16 a[132:135], a[244:247], v[164:167], a[132:135]
v_mfma_f32_16x16x32_bf16 a[136:139], a[244:247], v[184:187], a[136:139]
v_mfma_f32_16x16x32_bf16 a[136:139], a[244:247], v[188:191], a[136:139]
v_mfma_f32_16x16x32_bf16 a[140:143], a[244:247], v[192:195], a[140:143]
v_mfma_f32_16x16x32_bf16 a[140:143], a[244:247], v[196:199], a[140:143]
s_cbranch_scc1 L_D_8
L_DD_9:
s_waitcnt lgkmcnt(7)
v_mfma_f32_16x16x32_bf16 v[104:107], a[144:147], v[40:43], v[220:223]
s_waitcnt lgkmcnt(6)
v_cndmask_b32 v88, v216, v17, s[0:1]
v_cndmask_b32 v89, v216, v17, s[4:5]
v_mfma_f32_16x16x32_bf16 v[104:107], a[148:151], v[44:47], v[104:107]
s_waitcnt lgkmcnt(5)
v_cndmask_b32 v90, v216, v17, s[6:7]
v_cndmask_b32 v91, v216, v17, s[8:9]
v_mfma_f32_16x16x32_bf16 v[104:107], a[152:155], v[48:51], v[104:107]
s_waitcnt lgkmcnt(4)
buffer_load_dwordx4 v16, s[32:35], s70 offen offset:2048 sc1 lds
v_mfma_f32_16x16x32_bf16 v[104:107], a[156:159], v[52:55], v[104:107]
ds_read_b128 a[176:179], v2 offset:8192
v_cndmask_b32 v92, v216, v17, s[10:11]
v_mfma_f32_16x16x32_bf16 v[120:123], a[156:159], v[68:71], v[224:227]
ds_read_b128 a[180:183], v2 offset:9216
v_cndmask_b32 v93, v216, v17, s[12:13]
v_mfma_f32_16x16x32_bf16 v[120:123], a[152:155], v[64:67], v[120:123]
v_cndmask_b32 v94, v216, v17, s[18:19]
v_cndmask_b32 v95, v216, v17, s[22:23]
v_mfma_f32_16x16x32_bf16 v[120:123], a[148:151], v[60:63], v[120:123]
ds_read_b128 a[184:187], v2 offset:10240
v_cndmask_b32 v96, v216, v17, s[26:27]
v_mfma_f32_16x16x32_bf16 v[120:123], a[144:147], v[56:59], v[120:123]
ds_read_b128 a[188:191], v2 offset:11264
v_cndmask_b32 v97, v216, v17, s[56:57]
v_mfma_f32_16x16x32_bf16 v[136:139], a[144:147], v[72:75], v[228:231]
v_cndmask_b32 v98, v216, v17, s[58:59]
v_cndmask_b32 v99, v216, v17, s[60:61]
v_mfma_f32_16x16x32_bf16 v[136:139], a[148:151], v[76:79], v[136:139]
v_cndmask_b32 v100, v216, v17, s[62:63]
v_cndmask_b32 v101, v216, v17, s[48:49]
v_mfma_f32_16x16x32_bf16 v[136:139], a[152:155], v[80:83], v[136:139]
v_exp_f32 v104, v104
v_mfma_f32_16x16x32_bf16 v[136:139], a[156:159], v[84:87], v[136:139]
v_exp_f32 v105, v105
v_mfma_f32_16x16x32_bf16 v[88:91], a[156:159], v[36:39], v[88:91]
v_exp_f32 v106, v106
v_mfma_f32_16x16x32_bf16 v[88:91], a[152:155], v[32:35], v[88:91]
v_exp_f32 v107, v107
v_mfma_f32_16x16x32_bf16 v[88:91], a[148:151], v[28:31], v[88:91]
v_exp_f32 v120, v120
v_mfma_f32_16x16x32_bf16 v[88:91], a[144:147], v[24:27], v[88:91]
s_waitcnt lgkmcnt(0)
v_exp_f32 v121, v121
v_mfma_f32_16x16x32_bf16 v[140:143], a[160:163], v[72:75], v[228:231]
v_exp_f32 v122, v122
v_mfma_f32_16x16x32_bf16 v[140:143], a[164:167], v[76:79], v[140:143]
v_exp_f32 v123, v123
v_mfma_f32_16x16x32_bf16 v[140:143], a[168:171], v[80:83], v[140:143]
buffer_load_dwordx4 v16, s[32:35], s70 offen offset:3072 sc1 lds
v_mfma_f32_16x16x32_bf16 v[140:143], a[172:175], v[84:87], v[140:143]
v_cvt_pk_bf16_f32 v160, v104, v105
v_cvt_pk_bf16_f32 v161, v106, v107
v_mfma_f32_16x16x32_bf16 v[124:127], a[172:175], v[68:71], v[224:227]
v_exp_f32 v136, v136
v_mfma_f32_16x16x32_bf16 v[124:127], a[168:171], v[64:67], v[124:127]
v_exp_f32 v137, v137
v_mfma_f32_16x16x32_bf16 v[124:127], a[164:167], v[60:63], v[124:127]
v_exp_f32 v138, v138
v_mfma_f32_16x16x32_bf16 v[124:127], a[160:163], v[56:59], v[124:127]
v_exp_f32 v139, v139
v_mfma_f32_16x16x32_bf16 v[108:111], a[160:163], v[40:43], v[220:223]
v_exp_f32 v88, v88
v_mfma_f32_16x16x32_bf16 v[108:111], a[164:167], v[44:47], v[108:111]
v_exp_f32 v89, v89
v_mfma_f32_16x16x32_bf16 v[108:111], a[168:171], v[48:51], v[108:111]
v_exp_f32 v90, v90
v_mfma_f32_16x16x32_bf16 v[108:111], a[172:175], v[52:55], v[108:111]
v_cvt_pk_bf16_f32 v184, v120, v121
v_cvt_pk_bf16_f32 v185, v122, v123
v_mfma_f32_16x16x32_bf16 v[92:95], a[172:175], v[36:39], v[92:95]
v_exp_f32 v91, v91
v_mfma_f32_16x16x32_bf16 v[92:95], a[168:171], v[32:35], v[92:95]
ds_read_b128 a[192:195], v2 offset:12288
v_cvt_pk_bf16_f32 v192, v136, v137
v_mfma_f32_16x16x32_bf16 v[92:95], a[164:167], v[28:31], v[92:95]
ds_read_b128 a[196:199], v2 offset:13312
v_cvt_pk_bf16_f32 v193, v138, v139
v_mfma_f32_16x16x32_bf16 v[92:95], a[160:163], v[24:27], v[92:95]
v_exp_f32 v140, v140
v_mfma_f32_16x16x32_bf16 v[96:99], a[176:179], v[24:27], v[96:99]
s_add_u32 m0, s71, 4096
ds_read_b128 a[200:203], v2 offset:14336
v_cvt_pk_bf16_f32 v152, v88, v89
v_mfma_f32_16x16x32_bf16 v[96:99], a[180:183], v[28:31], v[96:99]
s_add_u32 s64, s70, 4096
ds_read_b128 a[204:207], v2 offset:15360
v_cvt_pk_bf16_f32 v153, v90, v91
v_mfma_f32_16x16x32_bf16 v[96:99], a[184:187], v[32:35], v[96:99]
buffer_load_dwordx4 v16, s[32:35], s64 offen offset:0 sc1 lds
v_mfma_f32_16x16x32_bf16 v[96:99], a[188:191], v[36:39], v[96:99]
v_exp_f32 v141, v141
v_mfma_f32_16x16x32_bf16 v[112:115], a[188:191], v[52:55], v[220:223]
v_exp_f32 v142, v142
v_mfma_f32_16x16x32_bf16 v[112:115], a[184:187], v[48:51], v[112:115]
v_exp_f32 v143, v143
v_mfma_f32_16x16x32_bf16 v[112:115], a[180:183], v[44:47], v[112:115]
v_exp_f32 v124, v124
v_mfma_f32_16x16x32_bf16 v[112:115], a[176:179], v[40:43], v[112:115]
v_exp_f32 v125, v125
v_mfma_f32_16x16x32_bf16 v[128:131], a[176:179], v[56:59], v[224:227]
v_exp_f32 v126, v126
v_mfma_f32_16x16x32_bf16 v[128:131], a[180:183], v[60:63], v[128:131]
v_exp_f32 v127, v127
v_mfma_f32_16x16x32_bf16 v[128:131], a[184:187], v[64:67], v[128:131]
ds_read_b128 a[144:147], v3 offset:0
v_cvt_pk_bf16_f32 v194, v140, v141
v_mfma_f32_16x16x32_bf16 v[128:131], a[188:191], v[68:71], v[128:131]
v_cndmask_b32 v102, v216, v17, s[50:51]
v_cvt_pk_bf16_f32 v195, v142, v143
v_mfma_f32_16x16x32_bf16 v[144:147], a[188:191], v[84:87], v[228:231]
ds_read_b128 a[148:151], v3 offset:8192
v_cndmask_b32 v103, v216, v17, s[100:101]
v_mfma_f32_16x16x32_bf16 v[144:147], a[184:187], v[80:83], v[144:147]
v_exp_f32 v108, v108
v_mfma_f32_16x16x32_bf16 v[144:147], a[180:183], v[76:79], v[144:147]
v_exp_f32 v109, v109
v_mfma_f32_16x16x32_bf16 v[144:147], a[176:179], v[72:75], v[144:147]
s_waitcnt lgkmcnt(2)
v_exp_f32 v110, v110
v_mfma_f32_16x16x32_bf16 v[148:151], a[192:195], v[72:75], v[228:231]
v_exp_f32 v111, v111
v_mfma_f32_16x16x32_bf16 v[148:151], a[196:199], v[76:79], v[148:151]
ds_read_b128 a[152:155], v3 offset:1024
v_cvt_pk_bf16_f32 v186, v124, v125
v_mfma_f32_16x16x32_bf16 v[148:151], a[200:203], v[80:83], v[148:151]
buffer_load_dwordx4 v16, s[32:35], s64 offen offset:1024 sc1 lds
v_mfma_f32_16x16x32_bf16 v[148:151], a[204:207], v[84:87], v[148:151]
v_exp_f32 v92, v92
v_mfma_f32_16x16x32_bf16 v[132:135], a[204:207], v[68:71], v[224:227]
ds_read_b128 a[156:159], v3 offset:9216
v_cvt_pk_bf16_f32 v187, v126, v127
v_mfma_f32_16x16x32_bf16 v[132:135], a[200:203], v[64:67], v[132:135]
v_exp_f32 v93, v93
v_mfma_f32_16x16x32_bf16 v[132:135], a[196:199], v[60:63], v[132:135]
v_exp_f32 v94, v94
v_mfma_f32_16x16x32_bf16 v[132:135], a[192:195], v[56:59], v[132:135]
v_exp_f32 v95, v95
v_mfma_f32_16x16x32_bf16 v[116:119], a[192:195], v[40:43], v[220:223]
v_exp_f32 v96, v96
v_mfma_f32_16x16x32_bf16 v[116:119], a[196:199], v[44:47], v[116:119]
ds_read_b128 a[160:163], v3 offset:2048
v_cvt_pk_bf16_f32 v162, v108, v109
v_mfma_f32_16x16x32_bf16 v[116:119], a[200:203], v[48:51], v[116:119]
ds_read_b128 a[164:167], v3 offset:10240
v_cvt_pk_bf16_f32 v163, v110, v111
v_mfma_f32_16x16x32_bf16 v[116:119], a[204:207], v[52:55], v[116:119]
v_exp_f32 v97, v97
v_mfma_f32_16x16x32_bf16 v[100:103], a[204:207], v[36:39], v[100:103]
v_exp_f32 v98, v98
v_mfma_f32_16x16x32_bf16 v[100:103], a[200:203], v[32:35], v[100:103]
v_exp_f32 v99, v99
v_mfma_f32_16x16x32_bf16 v[100:103], a[196:199], v[28:31], v[100:103]
v_exp_f32 v112, v112
v_mfma_f32_16x16x32_bf16 v[100:103], a[192:195], v[24:27], v[100:103]
s_waitcnt lgkmcnt(1)
ds_read_b128 a[168:171], v3 offset:3072
v_cvt_pk_bf16_f32 v154, v92, v93
v_mfma_f32_16x16x32_bf16 a[0:3], a[144:147], v[168:171], a[0:3]
ds_read_b128 a[172:175], v3 offset:11264
v_cvt_pk_bf16_f32 v155, v94, v95
v_mfma_f32_16x16x32_bf16 a[0:3], a[148:151], v[172:175], a[0:3]
v_exp_f32 v113, v113
v_mfma_f32_16x16x32_bf16 a[32:35], a[148:151], v[180:183], a[32:35]
buffer_load_dwordx4 v16, s[32:35], s64 offen offset:2048 sc1 lds
v_mfma_f32_16x16x32_bf16 a[32:35], a[144:147], v[176:179], a[32:35]
v_exp_f32 v114, v114
v_mfma_f32_16x16x32_bf16 a[64:67], a[144:147], v[200:203], a[64:67]
v_exp_f32 v115, v115
v_mfma_f32_16x16x32_bf16 a[64:67], a[148:151], v[204:207], a[64:67]
v_exp_f32 v128, v128
v_mfma_f32_16x16x32_bf16 a[96:99], a[148:151], v[212:215], a[96:99]
ds_read_b128 a[176:179], v3 offset:4096
v_cvt_pk_bf16_f32 v156, v96, v97
v_mfma_f32_16x16x32_bf16 a[96:99], a[144:147], v[208:211], a[96:99]
ds_read_b128 a[180:183], v3 offset:12288
v_cvt_pk_bf16_f32 v157, v98, v99
v_mfma_f32_16x16x32_bf16 a[100:103], a[152:155], v[208:211], a[100:103]
v_exp_f32 v129, v129
v_mfma_f32_16x16x32_bf16 a[100:103], a[156:159], v[212:215], a[100:103]
v_exp_f32 v130, v130
v_mfma_f32_16x16x32_bf16 a[68:71], a[156:159], v[204:207], a[68:71]
v_exp_f32 v131, v131
v_mfma_f32_16x16x32_bf16 a[68:71], a[152:155], v[200:203], a[68:71]
v_exp_f32 v144, v144
v_mfma_f32_16x16x32_bf16 a[36:39], a[152:155], v[176:179], a[36:39]
ds_read_b128 a[184:187], v3 offset:5120
v_cvt_pk_bf16_f32 v164, v112, v113
v_mfma_f32_16x16x32_bf16 a[36:39], a[156:159], v[180:183], a[36:39]
ds_read_b128 a[188:191], v3 offset:13312
v_cvt_pk_bf16_f32 v165, v114, v115
v_mfma_f32_16x16x32_bf16 a[4:7], a[156:159], v[172:175], a[4:7]
v_exp_f32 v145, v145
v_mfma_f32_16x16x32_bf16 a[4:7], a[152:155], v[168:171], a[4:7]
ds_read_b128 a[192:195], v3 offset:6144
v_cvt_pk_bf16_f32 v188, v128, v129
v_mfma_f32_16x16x32_bf16 a[8:11], a[160:163], v[168:171], a[8:11]
s_waitcnt lgkmcnt(3)
v_exp_f32 v146, v146
v_mfma_f32_16x16x32_bf16 a[8:11], a[164:167], v[172:175], a[8:11]
ds_read_b128 a[196:199], v3 offset:14336
v_cvt_pk_bf16_f32 v189, v130, v131
v_mfma_f32_16x16x32_bf16 a[40:43], a[164:167], v[180:183], a[40:43]
buffer_load_dwordx4 v16, s[32:35], s64 offen offset:3072 sc1 lds
v_mfma_f32_16x16x32_bf16 a[40:43], a[160:163], v[176:179], a[40:43]
v_exp_f32 v147, v147
v_mfma_f32_16x16x32_bf16 a[72:75], a[160:163], v[200:203], a[72:75]
v_exp_f32 v148, v148
v_mfma_f32_16x16x32_bf16 a[72:75], a[164:167], v[204:207], a[72:75]
ds_read_b128 a[200:203], v3 offset:7168
v_cvt_pk_bf16_f32 v196, v144, v145
v_mfma_f32_16x16x32_bf16 a[104:107], a[164:167], v[212:215], a[104:107]
v_exp_f32 v149, v149
v_mfma_f32_16x16x32_bf16 a[104:107], a[160:163], v[208:211], a[104:107]
v_exp_f32 v150, v150
v_mfma_f32_16x16x32_bf16 a[108:111], a[168:171], v[208:211], a[108:111]
v_exp_f32 v151, v151
v_mfma_f32_16x16x32_bf16 a[108:111], a[172:175], v[212:215], a[108:111]
ds_read_b128 a[204:207], v3 offset:15360
v_cvt_pk_bf16_f32 v197, v146, v147
v_mfma_f32_16x16x32_bf16 a[76:79], a[172:175], v[204:207], a[76:79]
v_exp_f32 v132, v132
v_mfma_f32_16x16x32_bf16 a[76:79], a[168:171], v[200:203], a[76:79]
v_exp_f32 v133, v133
v_mfma_f32_16x16x32_bf16 a[44:47], a[168:171], v[176:179], a[44:47]
v_exp_f32 v134, v134
v_mfma_f32_16x16x32_bf16 a[44:47], a[172:175], v[180:183], a[44:47]
v_exp_f32 v135, v135
v_mfma_f32_16x16x32_bf16 a[12:15], a[172:175], v[172:175], a[12:15]
v_exp_f32 v116, v116
v_mfma_f32_16x16x32_bf16 a[12:15], a[168:171], v[168:171], a[12:15]
v_exp_f32 v117, v117
v_mfma_f32_16x16x32_bf16 a[16:19], a[176:179], v[168:171], a[16:19]
v_exp_f32 v118, v118
v_mfma_f32_16x16x32_bf16 a[16:19], a[180:183], v[172:175], a[16:19]
v_exp_f32 v119, v119
v_mfma_f32_16x16x32_bf16 a[48:51], a[180:183], v[180:183], a[48:51]
v_exp_f32 v100, v100
v_mfma_f32_16x16x32_bf16 a[48:51], a[176:179], v[176:179], a[48:51]
v_exp_f32 v101, v101
v_mfma_f32_16x16x32_bf16 a[80:83], a[176:179], v[200:203], a[80:83]
s_waitcnt vmcnt(8)
s_barrier
v_mfma_f32_16x16x32_bf16 a[80:83], a[180:183], v[204:207], a[80:83]
s_xor_b32 s71, s71, 16384
ds_read_b128 a[144:147], v2 offset:16384
v_cvt_pk_bf16_f32 v198, v148, v149
v_mfma_f32_16x16x32_bf16 a[112:115], a[180:183], v[212:215], a[112:115]
s_add_u32 s70, s70, 32768
ds_read_b128 a[148:151], v2 offset:17408
v_cvt_pk_bf16_f32 v199, v150, v151
v_mfma_f32_16x16x32_bf16 a[112:115], a[176:179], v[208:211], a[112:115]
s_waitcnt lgkmcnt(2)
s_mov_b32 m0, s71
v_exp_f32 v102, v102
v_mfma_f32_16x16x32_bf16 a[116:119], a[184:187], v[208:211], a[116:119]
buffer_load_dwordx4 v16, s[32:35], s70 offen offset:0 sc1 lds
v_mfma_f32_16x16x32_bf16 a[116:119], a[188:191], v[212:215], a[116:119]
ds_read_b128 a[152:155], v2 offset:18432
v_cvt_pk_bf16_f32 v190, v132, v133
v_mfma_f32_16x16x32_bf16 a[84:87], a[188:191], v[204:207], a[84:87]
ds_read_b128 a[156:159], v2 offset:19456
v_cvt_pk_bf16_f32 v191, v134, v135
v_mfma_f32_16x16x32_bf16 a[84:87], a[184:187], v[200:203], a[84:87]
v_exp_f32 v103, v103
v_mfma_f32_16x16x32_bf16 a[52:55], a[184:187], v[176:179], a[52:55]
ds_read_b128 a[160:163], v2 offset:20480
v_cvt_pk_bf16_f32 v166, v116, v117
v_mfma_f32_16x16x32_bf16 a[52:55], a[188:191], v[180:183], a[52:55]
ds_read_b128 a[164:167], v2 offset:21504
v_cvt_pk_bf16_f32 v167, v118, v119
v_mfma_f32_16x16x32_bf16 a[20:23], a[188:191], v[172:175], a[20:23]
ds_read_b128 a[168:171], v2 offset:22528
v_cvt_pk_bf16_f32 v158, v100, v101
v_mfma_f32_16x16x32_bf16 a[20:23], a[184:187], v[168:171], a[20:23]
s_add_u32 s17, s78, L_T_10-L_pc
ds_read_b128 a[172:175], v2 offset:23552
v_cvt_pk_bf16_f32 v159, v102, v103
v_mfma_f32_16x16x32_bf16 a[24:27], a[192:195], v[168:171], a[24:27]
buffer_load_dword a252, v16, s[88:91], s17 offen
v_mfma_f32_16x16x32_bf16 a[24:27], a[196:199], v[172:175], a[24:27]
v_mfma_f32_16x16x32_bf16 a[56:59], a[196:199], v[180:183], a[56:59]
s_add_u32 s17, s78, L_T_10-L_pc+4096
v_mfma_f32_16x16x32_bf16 a[56:59], a[192:195], v[176:179], a[56:59]
buffer_load_dword a252, v16, s[88:91], s17 offen
v_mfma_f32_16x16x32_bf16 a[88:91], a[192:195], v[200:203], a[88:91]
v_cndmask_b32 v104, v220, v17, s[0:1]
v_cndmask_b32 v105, v220, v17, s[4:5]
v_mfma_f32_16x16x32_bf16 a[88:91], a[196:199], v[204:207], a[88:91]
v_cndmask_b32 v106, v220, v17, s[6:7]
v_cndmask_b32 v107, v220, v17, s[8:9]
v_mfma_f32_16x16x32_bf16 a[120:123], a[196:199], v[212:215], a[120:123]
v_cndmask_b32 v108, v220, v17, s[10:11]
v_cndmask_b32 v109, v220, v17, s[12:13]
v_mfma_f32_16x16x32_bf16 a[120:123], a[192:195], v[208:211], a[120:123]
v_cndmask_b32 v110, v220, v17, s[18:19]
v_cndmask_b32 v111, v220, v17, s[22:23]
v_mfma_f32_16x16x32_bf16 a[124:127], a[200:203], v[208:211], a[124:127]
buffer_load_dwordx4 v16, s[32:35], s70 offen offset:1024 sc1 lds
v_mfma_f32_16x16x32_bf16 a[124:127], a[204:207], v[212:215], a[124:127]
v_cndmask_b32 v112, v220, v17, s[26:27]
v_cndmask_b32 v113, v220, v17, s[56:57]
v_mfma_f32_16x16x32_bf16 a[92:95], a[204:207], v[204:207], a[92:95]
v_cndmask_b32 v114, v220, v17, s[58:59]
v_cndmask_b32 v115, v220, v17, s[60:61]
v_mfma_f32_16x16x32_bf16 a[92:95], a[200:203], v[200:203], a[92:95]
v_cndmask_b32 v116, v220, v17, s[62:63]
v_cndmask_b32 v117, v220, v17, s[48:49]
v_mfma_f32_16x16x32_bf16 a[60:63], a[200:203], v[176:179], a[60:63]
s_add_u32 s17, s78, L_T1_11-L_pc
v_cndmask_b32 v118, v220, v17, s[50:51]
v_cndmask_b32 v119, v220, v17, s[100:101]
v_mfma_f32_16x16x32_bf16 a[60:63], a[204:207], v[180:183], a[60:63]
buffer_load_dword a252, v16, s[88:91], s17 offen
v_mfma_f32_16x16x32_bf16 a[28:31], a[204:207], v[172:175], a[28:31]
v_mfma_f32_16x16x32_bf16 a[28:31], a[200:203], v[168:171], a[28:31]
s_add_u32 s17, s78, L_T1_11-L_pc+4096
v_mfma_f32_16x16x32_bf16 a[128:131], a[244:247], v[168:171], a[128:131]
buffer_load_dword a252, v16, s[88:91], s17 offen
v_mfma_f32_16x16x32_bf16 a[128:131], a[244:247], v[172:175], a[128:131]
v_mfma_f32_16x16x32_bf16 a[132:135], a[244:247], v[176:179], a[132:135]
v_mfma_f32_16x16x32_bf16 a[132:135], a[244:247], v[180:183], a[132:135]
v_mfma_f32_16x16x32_bf16 a[136:139], a[244:247], v[200:203], a[136:139]
v_mfma_f32_16x16x32_bf16 a[136:139], a[244:247], v[204:207], a[136:139]
v_mfma_f32_16x16x32_bf16 a[140:143], a[244:247], v[208:211], a[140:143]
v_mfma_f32_16x16x32_bf16 a[140:143], a[244:247], v[212:215], a[140:143]
s_waitcnt lgkmcnt(0)
v_mfma_f32_16x16x32_bf16 v[120:123], a[144:147], v[56:59], v[224:227]
ds_read_b128 a[176:179], v2 offset:24576
v_mfma_f32_16x16x32_bf16 v[120:123], a[148:151], v[60:63], v[120:123]
ds_read_b128 a[180:183], v2 offset:25600
v_mfma_f32_16x16x32_bf16 v[120:123], a[152:155], v[64:67], v[120:123]
buffer_load_dwordx4 v16, s[32:35], s70 offen offset:2048 sc1 lds
v_mfma_f32_16x16x32_bf16 v[120:123], a[156:159], v[68:71], v[120:123]
ds_read_b128 a[184:187], v2 offset:26624
v_mfma_f32_16x16x32_bf16 v[136:139], a[156:159], v[84:87], v[228:231]
v_mfma_f32_16x16x32_bf16 v[136:139], a[152:155], v[80:83], v[136:139]
ds_read_b128 a[188:191], v2 offset:27648
v_mfma_f32_16x16x32_bf16 v[136:139], a[148:151], v[76:79], v[136:139]
v_mfma_f32_16x16x32_bf16 v[136:139], a[144:147], v[72:75], v[136:139]
v_mfma_f32_16x16x32_bf16 v[104:107], a[144:147], v[40:43], v[104:107]
ds_read_b128 a[192:195], v2 offset:28672
v_mfma_f32_16x16x32_bf16 v[104:107], a[148:151], v[44:47], v[104:107]
v_mfma_f32_16x16x32_bf16 v[104:107], a[152:155], v[48:51], v[104:107]
v_exp_f32 v120, v120
v_mfma_f32_16x16x32_bf16 v[104:107], a[156:159], v[52:55], v[104:107]
v_exp_f32 v121, v121
v_mfma_f32_16x16x32_bf16 v[140:143], a[172:175], v[84:87], v[228:231]
v_exp_f32 v122, v122
v_mfma_f32_16x16x32_bf16 v[140:143], a[168:171], v[80:83], v[140:143]
v_exp_f32 v123, v123
v_mfma_f32_16x16x32_bf16 v[140:143], a[164:167], v[76:79], v[140:143]
v_exp_f32 v136, v136
v_mfma_f32_16x16x32_bf16 v[140:143], a[160:163], v[72:75], v[140:143]
v_exp_f32 v137, v137
v_mfma_f32_16x16x32_bf16 v[124:127], a[160:163], v[56:59], v[224:227]
buffer_load_dwordx4 v16, s[32:35], s70 offen offset:3072 sc1 lds
v_mfma_f32_16x16x32_bf16 v[124:127], a[164:167], v[60:63], v[124:127]
v_exp_f32 v138, v138
v_mfma_f32_16x16x32_bf16 v[124:127], a[168:171], v[64:67], v[124:127]
v_exp_f32 v139, v139
v_mfma_f32_16x16x32_bf16 v[124:127], a[172:175], v[68:71], v[124:127]
ds_read_b128 a[196:199], v2 offset:29696
v_cvt_pk_bf16_f32 v200, v120, v121
v_mfma_f32_16x16x32_bf16 v[108:111], a[172:175], v[52:55], v[108:111]
ds_read_b128 a[200:203], v2 offset:30720
v_cvt_pk_bf16_f32 v201, v122, v123
v_mfma_f32_16x16x32_bf16 v[108:111], a[168:171], v[48:51], v[108:111]
v_exp_f32 v104, v104
v_mfma_f32_16x16x32_bf16 v[108:111], a[164:167], v[44:47], v[108:111]
ds_read_b128 a[204:207], v2 offset:31744
v_cvt_pk_bf16_f32 v208, v136, v137
v_mfma_f32_16x16x32_bf16 v[108:111], a[160:163], v[40:43], v[108:111]
s_waitcnt lgkmcnt(3)
v_exp_f32 v105, v105
v_mfma_f32_16x16x32_bf16 v[112:115], a[176:179], v[40:43], v[112:115]
v_exp_f32 v106, v106
v_mfma_f32_16x16x32_bf16 v[112:115], a[180:183], v[44:47], v[112:115]
v_exp_f32 v107, v107
v_mfma_f32_16x16x32_bf16 v[112:115], a[184:187], v[48:51], v[112:115]
s_add_u32 m0, s71, 4096
v_exp_f32 v140, v140
v_mfma_f32_16x16x32_bf16 v[112:115], a[188:191], v[52:55], v[112:115]
s_add_u32 s64, s70, 4096
v_exp_f32 v141, v141
v_mfma_f32_16x16x32_bf16 v[128:131], a[188:191], v[68:71], v[224:227]
ds_read_b128 a[144:147], v3 offset:16384
v_cvt_pk_bf16_f32 v209, v138, v139
v_mfma_f32_16x16x32_bf16 v[128:131], a[184:187], v[64:67], v[128:131]
ds_read_b128 a[148:151], v3 offset:24576
v_cvt_pk_bf16_f32 v176, v104, v105
v_mfma_f32_16x16x32_bf16 v[128:131], a[180:183], v[60:63], v[128:131]
buffer_load_dwordx4 v16, s[32:35], s64 offen offset:0 sc1 lds
v_mfma_f32_16x16x32_bf16 v[128:131], a[176:179], v[56:59], v[128:131]
v_exp_f32 v142, v142
v_mfma_f32_16x16x32_bf16 v[144:147], a[176:179], v[72:75], v[228:231]
v_exp_f32 v143, v143
v_mfma_f32_16x16x32_bf16 v[144:147], a[180:183], v[76:79], v[144:147]
v_exp_f32 v124, v124
v_mfma_f32_16x16x32_bf16 v[144:147], a[184:187], v[80:83], v[144:147]
ds_read_b128 a[152:155], v3 offset:17408
v_cvt_pk_bf16_f32 v177, v106, v107
v_mfma_f32_16x16x32_bf16 v[144:147], a[188:191], v[84:87], v[144:147]
s_waitcnt lgkmcnt(1)
v_exp_f32 v125, v125
v_mfma_f32_16x16x32_bf16 v[148:151], a[204:207], v[84:87], v[228:231]
ds_read_b128 a[156:159], v3 offset:25600
v_cvt_pk_bf16_f32 v210, v140, v141
v_mfma_f32_16x16x32_bf16 v[148:151], a[200:203], v[80:83], v[148:151]
v_exp_f32 v126, v126
v_mfma_f32_16x16x32_bf16 v[148:151], a[196:199], v[76:79], v[148:151]
v_exp_f32 v127, v127
v_mfma_f32_16x16x32_bf16 v[148:151], a[192:195], v[72:75], v[148:151]
v_exp_f32 v108, v108
v_mfma_f32_16x16x32_bf16 v[132:135], a[192:195], v[56:59], v[224:227]
ds_read_b128 a[160:163], v3 offset:18432
v_cvt_pk_bf16_f32 v211, v142, v143
v_mfma_f32_16x16x32_bf16 v[132:135], a[196:199], v[60:63], v[132:135]
ds_read_b128 a[164:167], v3 offset:26624
v_cvt_pk_bf16_f32 v202, v124, v125
v_mfma_f32_16x16x32_bf16 v[132:135], a[200:203], v[64:67], v[132:135]
v_exp_f32 v109, v109
v_mfma_f32_16x16x32_bf16 v[132:135], a[204:207], v[68:71], v[132:135]
v_exp_f32 v110, v110
v_mfma_f32_16x16x32_bf16 v[116:119], a[204:207], v[52:55], v[116:119]
buffer_load_dwordx4 v16, s[32:35], s64 offen offset:1024 sc1 lds
v_mfma_f32_16x16x32_bf16 v[116:119], a[200:203], v[48:51], v[116:119]
v_exp_f32 v111, v111
v_mfma_f32_16x16x32_bf16 v[116:119], a[196:199], v[44:47], v[116:119]
ds_read_b128 a[168:171], v3 offset:19456
v_cvt_pk_bf16_f32 v203, v126, v127
v_mfma_f32_16x16x32_bf16 v[116:119], a[192:195], v[40:43], v[116:119]
v_exp_f32 v112, v112
v_mfma_f32_16x16x32_bf16 a[0:3], a[144:147], v[152:155], a[0:3]
v_exp_f32 v113, v113
v_mfma_f32_16x16x32_bf16 a[0:3], a[148:151], v[156:159], a[0:3]
ds_read_b128 a[172:175], v3 offset:27648
v_cvt_pk_bf16_f32 v178, v108, v109
v_mfma_f32_16x16x32_bf16 a[32:35], a[148:151], v[164:167], a[32:35]
v_exp_f32 v114, v114
v_mfma_f32_16x16x32_bf16 a[32:35], a[144:147], v[160:163], a[32:35]
v_exp_f32 v115, v115
v_mfma_f32_16x16x32_bf16 a[64:67], a[144:147], v[184:187], a[64:67]
ds_read_b128 a[176:179], v3 offset:20480
v_cvt_pk_bf16_f32 v179, v110, v111
v_mfma_f32_16x16x32_bf16 a[64:67], a[148:151], v[188:191], a[64:67]
v_exp_f32 v128, v128
v_mfma_f32_16x16x32_bf16 a[96:99], a[148:151], v[196:199], a[96:99]
v_exp_f32 v129, v129
v_mfma_f32_16x16x32_bf16 a[96:99], a[144:147], v[192:195], a[96:99]
s_waitcnt lgkmcnt(1)
v_exp_f32 v130, v130
v_mfma_f32_16x16x32_bf16 a[100:103], a[152:155], v[192:195], a[100:103]
ds_read_b128 a[180:183], v3 offset:28672
v_cvt_pk_bf16_f32 v180, v112, v113
v_mfma_f32_16x16x32_bf16 a[100:103], a[156:159], v[196:199], a[100:103]
v_exp_f32 v131, v131
v_mfma_f32_16x16x32_bf16 a[68:71], a[156:159], v[188:191], a[68:71]
buffer_load_dwordx4 v16, s[32:35], s64 offen offset:2048 sc1 lds
v_mfma_f32_16x16x32_bf16 a[68:71], a[152:155], v[184:187], a[68:71]
v_exp_f32 v144, v144
v_mfma_f32_16x16x32_bf16 a[36:39], a[152:155], v[160:163], a[36:39]
ds_read_b128 a[184:187], v3 offset:21504
v_cvt_pk_bf16_f32 v181, v114, v115
v_mfma_f32_16x16x32_bf16 a[36:39], a[156:159], v[164:167], a[36:39]
v_exp_f32 v145, v145
v_mfma_f32_16x16x32_bf16 a[4:7], a[156:159], v[156:159], a[4:7]
v_xor_b32 v2, 0x8000, v2
v_cvt_pk_bf16_f32 v204, v128, v129
v_mfma_f32_16x16x32_bf16 a[4:7], a[152:155], v[152:155], a[4:7]
ds_read_b128 a[188:191], v3 offset:29696
v_cvt_pk_bf16_f32 v205, v130, v131
v_mfma_f32_16x16x32_bf16 a[8:11], a[160:163], v[152:155], a[8:11]
v_exp_f32 v146, v146
v_mfma_f32_16x16x32_bf16 a[8:11], a[164:167], v[156:159], a[8:11]
v_exp_f32 v147, v147
v_mfma_f32_16x16x32_bf16 a[40:43], a[164:167], v[164:167], a[40:43]
v_exp_f32 v148, v148
v_mfma_f32_16x16x32_bf16 a[40:43], a[160:163], v[160:163], a[40:43]
ds_read_b128 a[192:195], v3 offset:22528
v_cvt_pk_bf16_f32 v212, v144, v145
v_mfma_f32_16x16x32_bf16 a[72:75], a[160:163], v[184:187], a[72:75]
v_exp_f32 v149, v149
v_mfma_f32_16x16x32_bf16 a[72:75], a[164:167], v[188:191], a[72:75]
v_exp_f32 v150, v150
v_mfma_f32_16x16x32_bf16 a[104:107], a[164:167], v[196:199], a[104:107]
v_exp_f32 v151, v151
v_mfma_f32_16x16x32_bf16 a[104:107], a[160:163], v[192:195], a[104:107]
ds_read_b128 a[196:199], v3 offset:30720
v_cvt_pk_bf16_f32 v213, v146, v147
v_mfma_f32_16x16x32_bf16 a[108:111], a[168:171], v[192:195], a[108:111]
buffer_load_dwordx4 v16, s[32:35], s64 offen offset:3072 sc1 lds
v_mfma_f32_16x16x32_bf16 a[108:111], a[172:175], v[196:199], a[108:111]
v_exp_f32 v132, v132
v_mfma_f32_16x16x32_bf16 a[76:79], a[172:175], v[188:191], a[76:79]
ds_read_b128 a[200:203], v3 offset:23552
v_cvt_pk_bf16_f32 v214, v148, v149
v_mfma_f32_16x16x32_bf16 a[76:79], a[168:171], v[184:187], a[76:79]
v_exp_f32 v133, v133
v_mfma_f32_16x16x32_bf16 a[44:47], a[168:171], v[160:163], a[44:47]
v_exp_f32 v134, v134
v_mfma_f32_16x16x32_bf16 a[44:47], a[172:175], v[164:167], a[44:47]
v_exp_f32 v135, v135
v_mfma_f32_16x16x32_bf16 a[12:15], a[172:175], v[156:159], a[12:15]
ds_read_b128 a[204:207], v3 offset:31744
v_cvt_pk_bf16_f32 v215, v150, v151
v_mfma_f32_16x16x32_bf16 a[12:15], a[168:171], v[152:155], a[12:15]
s_waitcnt lgkmcnt(2)
v_exp_f32 v116, v116
v_mfma_f32_16x16x32_bf16 a[16:19], a[176:179], v[152:155], a[16:19]
v_exp_f32 v117, v117
v_mfma_f32_16x16x32_bf16 a[16:19], a[180:183], v[156:159], a[16:19]
v_exp_f32 v118, v118
v_mfma_f32_16x16x32_bf16 a[48:51], a[180:183], v[164:167], a[48:51]
v_exp_f32 v119, v119
v_mfma_f32_16x16x32_bf16 a[48:51], a[176:179], v[160:163], a[48:51]
v_cvt_pk_bf16_f32 v206, v132, v133
v_cvt_pk_bf16_f32 v207, v134, v135
v_mfma_f32_16x16x32_bf16 a[80:83], a[176:179], v[184:187], a[80:83]
v_cvt_pk_bf16_f32 v182, v116, v117
v_cvt_pk_bf16_f32 v183, v118, v119
v_mfma_f32_16x16x32_bf16 a[80:83], a[180:183], v[188:191], a[80:83]
v_mfma_f32_16x16x32_bf16 a[112:115], a[180:183], v[196:199], a[112:115]
v_mfma_f32_16x16x32_bf16 a[112:115], a[176:179], v[192:195], a[112:115]
v_mfma_f32_16x16x32_bf16 a[116:119], a[184:187], v[192:195], a[116:119]
s_waitcnt vmcnt(12)
s_barrier
v_mfma_f32_16x16x32_bf16 a[116:119], a[188:191], v[196:199], a[116:119]
s_xor_b32 s71, s71, 49152
ds_read_b128 a[144:147], v2 offset:0
v_xor_b32 v3, 0x8000, v3
v_mfma_f32_16x16x32_bf16 a[84:87], a[188:191], v[188:191], a[84:87]
s_add_u32 s70, s70, 32768
ds_read_b128 a[148:151], v2 offset:1024
v_mfma_f32_16x16x32_bf16 a[84:87], a[184:187], v[184:187], a[84:87]
s_mov_b32 m0, s71
ds_read_b128 a[152:155], v2 offset:2048
v_mfma_f32_16x16x32_bf16 a[52:55], a[184:187], v[160:163], a[52:55]
buffer_load_dwordx4 v16, s[32:35], s70 offen offset:0 sc1 lds
v_mfma_f32_16x16x32_bf16 a[52:55], a[188:191], v[164:167], a[52:55]
ds_read_b128 a[156:159], v2 offset:3072
v_mfma_f32_16x16x32_bf16 a[20:23], a[188:191], v[156:159], a[20:23]
ds_read_b128 a[160:163], v2 offset:4096
v_mfma_f32_16x16x32_bf16 a[20:23], a[184:187], v[152:155], a[20:23]
ds_read_b128 a[164:167], v2 offset:5120
v_mfma_f32_16x16x32_bf16 a[24:27], a[192:195], v[152:155], a[24:27]
ds_read_b128 a[168:171], v2 offset:6144
v_mfma_f32_16x16x32_bf16 a[24:27], a[196:199], v[156:159], a[24:27]
ds_read_b128 a[172:175], v2 offset:7168
v_mfma_f32_16x16x32_bf16 a[56:59], a[196:199], v[164:167], a[56:59]
v_mfma_f32_16x16x32_bf16 a[56:59], a[192:195], v[160:163], a[56:59]
v_mfma_f32_16x16x32_bf16 a[88:91], a[192:195], v[184:187], a[88:91]
v_mfma_f32_16x16x32_bf16 a[88:91], a[196:199], v[188:191], a[88:91]
v_mfma_f32_16x16x32_bf16 a[120:123], a[196:199], v[196:199], a[120:123]
v_mfma_f32_16x16x32_bf16 a[120:123], a[192:195], v[192:195], a[120:123]
s_waitcnt lgkmcnt(0)
v_mfma_f32_16x16x32_bf16 a[124:127], a[200:203], v[192:195], a[124:127]
v_mfma_f32_16x16x32_bf16 a[124:127], a[204:207], v[196:199], a[124:127]
v_mfma_f32_16x16x32_bf16 a[92:95], a[204:207], v[188:191], a[92:95]
buffer_load_dwordx4 v16, s[32:35], s70 offen offset:1024 sc1 lds
v_mfma_f32_16x16x32_bf16 a[92:95], a[200:203], v[184:187], a[92:95]
v_mfma_f32_16x16x32_bf16 a[60:63], a[200:203], v[160:163], a[60:63]
v_mfma_f32_16x16x32_bf16 a[60:63], a[204:207], v[164:167], a[60:63]
v_mfma_f32_16x16x32_bf16 a[28:31], a[204:207], v[156:159], a[28:31]
v_mfma_f32_16x16x32_bf16 a[28:31], a[200:203], v[152:155], a[28:31]
v_mfma_f32_16x16x32_bf16 a[128:131], a[244:247], v[152:155], a[128:131]
v_mfma_f32_16x16x32_bf16 a[128:131], a[244:247], v[156:159], a[128:131]
v_mfma_f32_16x16x32_bf16 a[132:135], a[244:247], v[160:163], a[132:135]
v_mfma_f32_16x16x32_bf16 a[132:135], a[244:247], v[164:167], a[132:135]
v_mfma_f32_16x16x32_bf16 a[136:139], a[244:247], v[184:187], a[136:139]
v_mfma_f32_16x16x32_bf16 a[136:139], a[244:247], v[188:191], a[136:139]
v_mfma_f32_16x16x32_bf16 a[140:143], a[244:247], v[192:195], a[140:143]
v_mfma_f32_16x16x32_bf16 a[140:143], a[244:247], v[196:199], a[140:143]
s_cmp_eq_u32 s3, 7
s_cbranch_scc1 L_T1_11
L_T_10:
s_waitcnt lgkmcnt(7)
v_mfma_f32_16x16x32_bf16 v[120:123], a[144:147], v[56:59], v[224:227]
s_waitcnt lgkmcnt(6)
ds_read_b128 a[176:179], v2 offset:8192
v_mfma_f32_16x16x32_bf16 v[120:123], a[148:151], v[60:63], v[120:123]
s_waitcnt lgkmcnt(6)
ds_read_b128 a[180:183], v2 offset:9216
v_mfma_f32_16x16x32_bf16 v[120:123], a[152:155], v[64:67], v[120:123]
s_waitcnt lgkmcnt(6)
buffer_load_dwordx4 v16, s[32:35], s70 offen offset:2048 sc1 lds
v_mfma_f32_16x16x32_bf16 v[120:123], a[156:159], v[68:71], v[120:123]
ds_read_b128 a[184:187], v2 offset:10240
v_mfma_f32_16x16x32_bf16 v[136:139], a[156:159], v[84:87], v[228:231]
ds_read_b128 a[188:191], v2 offset:11264
v_mfma_f32_16x16x32_bf16 v[136:139], a[152:155], v[80:83], v[136:139]
ds_read_b128 a[192:195], v2 offset:12288
v_mfma_f32_16x16x32_bf16 v[136:139], a[148:151], v[76:79], v[136:139]
v_mfma_f32_16x16x32_bf16 v[136:139], a[144:147], v[72:75], v[136:139]
s_waitcnt lgkmcnt(3)
ds_read_b128 a[196:199], v2 offset:13312
v_mfma_f32_16x16x32_bf16 v[140:143], a[160:163], v[72:75], v[228:231]
v_accvgpr_read_b32 v20, a128
v_max_f32 v1, v1, v20
v_mfma_f32_16x16x32_bf16 v[140:143], a[164:167], v[76:79], v[140:143]
ds_read_b128 a[200:203], v2 offset:14336
v_mfma_f32_16x16x32_bf16 v[140:143], a[168:171], v[80:83], v[140:143]
v_exp_f32 v120, v120
v_mfma_f32_16x16x32_bf16 v[140:143], a[172:175], v[84:87], v[140:143]
v_exp_f32 v121, v121
v_mfma_f32_16x16x32_bf16 v[124:127], a[172:175], v[68:71], v[224:227]
buffer_load_dwordx4 v16, s[32:35], s70 offen offset:3072 sc1 lds
v_mfma_f32_16x16x32_bf16 v[124:127], a[168:171], v[64:67], v[124:127]
v_exp_f32 v122, v122
v_mfma_f32_16x16x32_bf16 v[124:127], a[164:167], v[60:63], v[124:127]
v_exp_f32 v123, v123
v_mfma_f32_16x16x32_bf16 v[124:127], a[160:163], v[56:59], v[124:127]
ds_read_b128 a[204:207], v2 offset:15360
v_cvt_pk_bf16_f32 v184, v120, v121
v_mfma_f32_16x16x32_bf16 v[128:131], a[176:179], v[56:59], v[224:227]
v_exp_f32 v136, v136
v_mfma_f32_16x16x32_bf16 v[128:131], a[180:183], v[60:63], v[128:131]
s_waitcnt lgkmcnt(1)
s_add_u32 m0, s71, 4096
v_exp_f32 v137, v137
v_mfma_f32_16x16x32_bf16 v[128:131], a[184:187], v[64:67], v[128:131]
s_add_u32 s64, s70, 4096
v_exp_f32 v138, v138
v_mfma_f32_16x16x32_bf16 v[128:131], a[188:191], v[68:71], v[128:131]
ds_read_b128 a[144:147], v3 offset:0
v_cvt_pk_bf16_f32 v185, v122, v123
v_mfma_f32_16x16x32_bf16 v[144:147], a[188:191], v[84:87], v[228:231]
ds_read_b128 a[148:151], v3 offset:8192
v_cvt_pk_bf16_f32 v192, v136, v137
v_mfma_f32_16x16x32_bf16 v[144:147], a[184:187], v[80:83], v[144:147]
buffer_load_dwordx4 v16, s[32:35], s64 offen offset:0 sc1 lds
v_mfma_f32_16x16x32_bf16 v[144:147], a[180:183], v[76:79], v[144:147]
v_exp_f32 v139, v139
v_mfma_f32_16x16x32_bf16 v[144:147], a[176:179], v[72:75], v[144:147]
v_exp_f32 v140, v140
v_mfma_f32_16x16x32_bf16 v[148:151], a[192:195], v[72:75], v[228:231]
ds_read_b128 a[152:155], v3 offset:1024
v_cvt_pk_bf16_f32 v193, v138, v139
v_mfma_f32_16x16x32_bf16 v[148:151], a[196:199], v[76:79], v[148:151]
ds_read_b128 a[156:159], v3 offset:9216
v_mfma_f32_16x16x32_bf16 v[148:151], a[200:203], v[80:83], v[148:151]
s_waitcnt lgkmcnt(2)
v_exp_f32 v141, v141
v_mfma_f32_16x16x32_bf16 v[148:151], a[204:207], v[84:87], v[148:151]
v_exp_f32 v142, v142
v_mfma_f32_16x16x32_bf16 v[132:135], a[204:207], v[68:71], v[224:227]
v_exp_f32 v143, v143
v_mfma_f32_16x16x32_bf16 v[132:135], a[200:203], v[64:67], v[132:135]
ds_read_b128 a[160:163], v3 offset:2048
v_cvt_pk_bf16_f32 v194, v140, v141
v_mfma_f32_16x16x32_bf16 v[132:135], a[196:199], v[60:63], v[132:135]
ds_read_b128 a[164:167], v3 offset:10240
v_cvt_pk_bf16_f32 v195, v142, v143
v_mfma_f32_16x16x32_bf16 v[132:135], a[192:195], v[56:59], v[132:135]
buffer_load_dwordx4 v16, s[32:35], s64 offen offset:1024 sc1 lds
v_mfma_f32_16x16x32_bf16 a[32:35], a[144:147], v[176:179], a[32:35]
v_exp_f32 v124, v124
v_mfma_f32_16x16x32_bf16 a[32:35], a[148:151], v[180:183], a[32:35]
v_exp_f32 v125, v125
v_mfma_f32_16x16x32_bf16 a[64:67], a[148:151], v[204:207], a[64:67]
ds_read_b128 a[168:171], v3 offset:3072
v_cvt_pk_bf16_f32 v186, v124, v125
v_mfma_f32_16x16x32_bf16 a[64:67], a[144:147], v[200:203], a[64:67]
ds_read_b128 a[172:175], v3 offset:11264
v_mfma_f32_16x16x32_bf16 a[96:99], a[144:147], v[208:211], a[96:99]
v_exp_f32 v126, v126
v_mfma_f32_16x16x32_bf16 a[96:99], a[148:151], v[212:215], a[96:99]
s_waitcnt lgkmcnt(2)
v_exp_f32 v127, v127
v_mfma_f32_16x16x32_bf16 a[100:103], a[156:159], v[212:215], a[100:103]
v_exp_f32 v128, v128
v_mfma_f32_16x16x32_bf16 a[100:103], a[152:155], v[208:211], a[100:103]
ds_read_b128 a[176:179], v3 offset:4096
v_cvt_pk_bf16_f32 v187, v126, v127
v_mfma_f32_16x16x32_bf16 a[68:71], a[152:155], v[200:203], a[68:71]
ds_read_b128 a[180:183], v3 offset:12288
v_mfma_f32_16x16x32_bf16 a[68:71], a[156:159], v[204:207], a[68:71]
buffer_load_dwordx4 v16, s[32:35], s64 offen offset:2048 sc1 lds
v_mfma_f32_16x16x32_bf16 a[36:39], a[156:159], v[180:183], a[36:39]
v_exp_f32 v129, v129
v_mfma_f32_16x16x32_bf16 a[36:39], a[152:155], v[176:179], a[36:39]
v_exp_f32 v130, v130
v_mfma_f32_16x16x32_bf16 a[40:43], a[160:163], v[176:179], a[40:43]
ds_read_b128 a[184:187], v3 offset:5120
v_cvt_pk_bf16_f32 v188, v128, v129
v_mfma_f32_16x16x32_bf16 a[40:43], a[164:167], v[180:183], a[40:43]
ds_read_b128 a[188:191], v3 offset:13312
v_mfma_f32_16x16x32_bf16 a[72:75], a[164:167], v[204:207], a[72:75]
v_exp_f32 v131, v131
v_mfma_f32_16x16x32_bf16 a[72:75], a[160:163], v[200:203], a[72:75]
v_exp_f32 v144, v144
v_mfma_f32_16x16x32_bf16 a[104:107], a[160:163], v[208:211], a[104:107]
v_exp_f32 v145, v145
v_mfma_f32_16x16x32_bf16 a[104:107], a[164:167], v[212:215], a[104:107]
s_waitcnt lgkmcnt(2)
ds_read_b128 a[192:195], v3 offset:6144
v_cvt_pk_bf16_f32 v189, v130, v131
v_mfma_f32_16x16x32_bf16 a[108:111], a[172:175], v[212:215], a[108:111]
ds_read_b128 a[196:199], v3 offset:14336
v_cvt_pk_bf16_f32 v196, v144, v145
v_mfma_f32_16x16x32_bf16 a[108:111], a[168:171], v[208:211], a[108:111]
buffer_load_dwordx4 v16, s[32:35], s64 offen offset:3072 sc1 lds
v_mfma_f32_16x16x32_bf16 a[76:79], a[168:171], v[200:203], a[76:79]
v_exp_f32 v146, v146
v_mfma_f32_16x16x32_bf16 a[76:79], a[172:175], v[204:207], a[76:79]
ds_read_b128 a[200:203], v3 offset:7168
v_mfma_f32_16x16x32_bf16 a[44:47], a[172:175], v[180:183], a[44:47]
ds_read_b128 a[204:207], v3 offset:15360
v_mfma_f32_16x16x32_bf16 a[44:47], a[168:171], v[176:179], a[44:47]
v_exp_f32 v147, v147
v_mfma_f32_16x16x32_bf16 a[48:51], a[176:179], v[176:179], a[48:51]
v_exp_f32 v148, v148
v_mfma_f32_16x16x32_bf16 a[48:51], a[180:183], v[180:183], a[48:51]
v_exp_f32 v149, v149
v_mfma_f32_16x16x32_bf16 a[80:83], a[180:183], v[204:207], a[80:83]
v_exp_f32 v150, v150
v_mfma_f32_16x16x32_bf16 a[80:83], a[176:179], v[200:203], a[80:83]
v_exp_f32 v151, v151
v_mfma_f32_16x16x32_bf16 a[112:115], a[176:179], v[208:211], a[112:115]
v_exp_f32 v132, v132
v_mfma_f32_16x16x32_bf16 a[112:115], a[180:183], v[212:215], a[112:115]
s_waitcnt lgkmcnt(0)
v_exp_f32 v133, v133
v_mfma_f32_16x16x32_bf16 a[116:119], a[188:191], v[212:215], a[116:119]
v_exp_f32 v134, v134
v_mfma_f32_16x16x32_bf16 a[116:119], a[184:187], v[208:211], a[116:119]
s_waitcnt vmcnt(8)
s_barrier
v_mfma_f32_16x16x32_bf16 a[84:87], a[184:187], v[200:203], a[84:87]
s_xor_b32 s71, s71, 16384
ds_read_b128 a[144:147], v2 offset:16384
v_cvt_pk_bf16_f32 v197, v146, v147
v_mfma_f32_16x16x32_bf16 a[84:87], a[188:191], v[204:207], a[84:87]
s_add_u32 s70, s70, 32768
ds_read_b128 a[148:151], v2 offset:17408
v_cvt_pk_bf16_f32 v198, v148, v149
v_mfma_f32_16x16x32_bf16 a[52:55], a[188:191], v[180:183], a[52:55]
s_mov_b32 m0, s71
ds_read_b128 a[152:155], v2 offset:18432
v_cvt_pk_bf16_f32 v199, v150, v151
v_mfma_f32_16x16x32_bf16 a[52:55], a[184:187], v[176:179], a[52:55]
buffer_load_dwordx4 v16, s[32:35], s70 offen offset:0 sc1 lds
v_mfma_f32_16x16x32_bf16 a[56:59], a[192:195], v[176:179], a[56:59]
ds_read_b128 a[156:159], v2 offset:19456
v_cvt_pk_bf16_f32 v190, v132, v133
v_mfma_f32_16x16x32_bf16 a[56:59], a[196:199], v[180:183], a[56:59]
v_exp_f32 v135, v135
v_mfma_f32_16x16x32_bf16 a[88:91], a[196:199], v[204:207], a[88:91]
ds_read_b128 a[160:163], v2 offset:20480
v_cvt_pk_bf16_f32 v191, v134, v135
v_mfma_f32_16x16x32_bf16 a[88:91], a[192:195], v[200:203], a[88:91]
ds_read_b128 a[164:167], v2 offset:21504
v_mfma_f32_16x16x32_bf16 a[120:123], a[192:195], v[208:211], a[120:123]
ds_read_b128 a[168:171], v2 offset:22528
v_mfma_f32_16x16x32_bf16 a[120:123], a[196:199], v[212:215], a[120:123]
ds_read_b128 a[172:175], v2 offset:23552
v_mfma_f32_16x16x32_bf16 a[124:127], a[204:207], v[212:215], a[124:127]
v_rcp_f32 v20, v20
v_mfma_f32_16x16x32_bf16 a[124:127], a[200:203], v[208:211], a[124:127]
v_accvgpr_read_b32 v232, a0
v_accvgpr_read_b32 v233, a1
v_mfma_f32_16x16x32_bf16 a[92:95], a[200:203], v[200:203], a[92:95]
buffer_load_dwordx4 v16, s[32:35], s70 offen offset:1024 sc1 lds
v_mfma_f32_16x16x32_bf16 a[92:95], a[204:207], v[204:207], a[92:95]
v_accvgpr_read_b32 v234, a2
v_accvgpr_read_b32 v235, a3
v_mfma_f32_16x16x32_bf16 a[60:63], a[204:207], v[180:183], a[60:63]
v_accvgpr_read_b32 v236, a4
v_accvgpr_read_b32 v237, a5
v_mfma_f32_16x16x32_bf16 a[60:63], a[200:203], v[176:179], a[60:63]
v_accvgpr_read_b32 v238, a6
v_accvgpr_read_b32 v239, a7
v_mfma_f32_16x16x32_bf16 a[132:135], a[244:247], v[176:179], a[132:135]
v_mul_f32 v20, v20, v4
v_mfma_f32_16x16x32_bf16 a[132:135], a[244:247], v[180:183], a[132:135]
s_add_u32 s77, s74, 0
v_mul_f32 v232, v232, v20
v_mul_f32 v233, v233, v20
v_mfma_f32_16x16x32_bf16 a[136:139], a[244:247], v[200:203], a[136:139]
v_mul_f32 v234, v234, v20
v_mul_f32 v235, v235, v20
v_mfma_f32_16x16x32_bf16 a[136:139], a[244:247], v[204:207], a[136:139]
v_mul_f32 v236, v236, v20
v_mul_f32 v237, v237, v20
v_mfma_f32_16x16x32_bf16 a[140:143], a[244:247], v[208:211], a[140:143]
v_mul_f32 v238, v238, v20
v_mul_f32 v239, v239, v20
v_mfma_f32_16x16x32_bf16 a[140:143], a[244:247], v[212:215], a[140:143]
s_waitcnt lgkmcnt(0)
v_cvt_pk_bf16_f32 v232, v232, v233
v_cvt_pk_bf16_f32 v233, v234, v235
v_mfma_f32_16x16x32_bf16 v[120:123], a[144:147], v[56:59], v[224:227]
ds_read_b128 a[176:179], v2 offset:24576
ds_read_b128 a[180:183], v2 offset:25600
v_cvt_pk_bf16_f32 v234, v236, v237
v_mfma_f32_16x16x32_bf16 v[120:123], a[148:151], v[60:63], v[120:123]
ds_read_b128 a[184:187], v2 offset:26624
v_cvt_pk_bf16_f32 v235, v238, v239
v_mfma_f32_16x16x32_bf16 v[120:123], a[152:155], v[64:67], v[120:123]
buffer_load_dwordx4 v16, s[32:35], s70 offen offset:2048 sc1 lds
v_mfma_f32_16x16x32_bf16 v[120:123], a[156:159], v[68:71], v[120:123]
ds_read_b128 a[188:191], v2 offset:27648
ds_read_b128 a[192:195], v2 offset:28672
v_mfma_f32_16x16x32_bf16 v[136:139], a[156:159], v[84:87], v[228:231]
ds_read_b128 a[196:199], v2 offset:29696
v_mfma_f32_16x16x32_bf16 v[136:139], a[152:155], v[80:83], v[136:139]
buffer_load_dwordx4 v16, s[32:35], s70 offen offset:3072 sc1 lds
v_mfma_f32_16x16x32_bf16 v[136:139], a[148:151], v[76:79], v[136:139]
ds_read_b128 a[200:203], v2 offset:30720
ds_read_b128 a[204:207], v2 offset:31744
v_mfma_f32_16x16x32_bf16 v[136:139], a[144:147], v[72:75], v[136:139]
v_exp_f32 v120, v120
v_mfma_f32_16x16x32_bf16 v[140:143], a[160:163], v[72:75], v[228:231]
v_exp_f32 v121, v121
v_mfma_f32_16x16x32_bf16 v[140:143], a[164:167], v[76:79], v[140:143]
s_add_u32 m0, s71, 4096
v_exp_f32 v122, v122
v_mfma_f32_16x16x32_bf16 v[140:143], a[168:171], v[80:83], v[140:143]
v_exp_f32 v123, v123
v_mfma_f32_16x16x32_bf16 v[140:143], a[172:175], v[84:87], v[140:143]
v_exp_f32 v136, v136
v_mfma_f32_16x16x32_bf16 v[124:127], a[172:175], v[68:71], v[224:227]
ds_read_b128 a[144:147], v3 offset:16384
v_cvt_pk_bf16_f32 v200, v120, v121
v_mfma_f32_16x16x32_bf16 v[124:127], a[168:171], v[64:67], v[124:127]
s_add_u32 s64, s70, 4096
v_exp_f32 v137, v137
v_mfma_f32_16x16x32_bf16 v[124:127], a[164:167], v[60:63], v[124:127]
ds_read_b128 a[148:151], v3 offset:24576
v_cvt_pk_bf16_f32 v201, v122, v123
v_mfma_f32_16x16x32_bf16 v[124:127], a[160:163], v[56:59], v[124:127]
s_waitcnt lgkmcnt(2)
v_exp_f32 v138, v138
v_mfma_f32_16x16x32_bf16 v[128:131], a[176:179], v[56:59], v[224:227]
ds_read_b128 a[152:155], v3 offset:17408
v_cvt_pk_bf16_f32 v208, v136, v137
v_mfma_f32_16x16x32_bf16 v[128:131], a[180:183], v[60:63], v[128:131]
v_exp_f32 v139, v139
v_mfma_f32_16x16x32_bf16 v[128:131], a[184:187], v[64:67], v[128:131]
ds_read_b128 a[156:159], v3 offset:25600
v_cvt_pk_bf16_f32 v209, v138, v139
v_mfma_f32_16x16x32_bf16 v[128:131], a[188:191], v[68:71], v[128:131]
v_exp_f32 v140, v140
v_mfma_f32_16x16x32_bf16 v[144:147], a[188:191], v[84:87], v[228:231]
buffer_store_dwordx4 v[232:235], v16, s[44:47], s77 offen sc1
buffer_load_dwordx4 v16, s[32:35], s64 offen offset:0 sc1 lds
v_accvgpr_read_b32 v240, a8
v_accvgpr_read_b32 v241, a9
v_accvgpr_read_b32 v242, a10
v_accvgpr_read_b32 v243, a11
v_accvgpr_read_b32 v244, a12
v_accvgpr_read_b32 v245, a13
v_accvgpr_read_b32 v246, a14
v_accvgpr_read_b32 v247, a15
s_add_u32 s77, s74, 8192
v_mul_f32 v240, v240, v20
v_mul_f32 v241, v241, v20
v_mul_f32 v242, v242, v20
v_mul_f32 v243, v243, v20
v_mul_f32 v244, v244, v20
v_mul_f32 v245, v245, v20
v_mul_f32 v246, v246, v20
v_mul_f32 v247, v247, v20
v_cvt_pk_bf16_f32 v240, v240, v241
v_cvt_pk_bf16_f32 v241, v242, v243
v_cvt_pk_bf16_f32 v242, v244, v245
v_cvt_pk_bf16_f32 v243, v246, v247
buffer_store_dwordx4 v[240:243], v16, s[44:47], s77 offen sc1
v_accvgpr_read_b32 v232, a16
v_accvgpr_read_b32 v233, a17
v_accvgpr_read_b32 v234, a18
v_accvgpr_read_b32 v235, a19
v_accvgpr_read_b32 v236, a20
v_accvgpr_read_b32 v237, a21
v_accvgpr_read_b32 v238, a22
v_accvgpr_read_b32 v239, a23
s_add_u32 s77, s74, 16384
v_mul_f32 v232, v232, v20
v_mul_f32 v233, v233, v20
v_mul_f32 v234, v234, v20
v_mul_f32 v235, v235, v20
v_mul_f32 v236, v236, v20
v_mul_f32 v237, v237, v20
v_mul_f32 v238, v238, v20
v_mul_f32 v239, v239, v20
v_cvt_pk_bf16_f32 v232, v232, v233
v_cvt_pk_bf16_f32 v233, v234, v235
v_cvt_pk_bf16_f32 v234, v236, v237
v_cvt_pk_bf16_f32 v235, v238, v239
buffer_store_dwordx4 v[232:235], v16, s[44:47], s77 offen sc1
v_accvgpr_read_b32 v240, a24
v_accvgpr_read_b32 v241, a25
v_accvgpr_read_b32 v242, a26
v_accvgpr_read_b32 v243, a27
v_accvgpr_read_b32 v244, a28
v_accvgpr_read_b32 v245, a29
v_accvgpr_read_b32 v246, a30
v_accvgpr_read_b32 v247, a31
s_add_u32 s77, s74, 24576
v_mul_f32 v240, v240, v20
v_mul_f32 v241, v241, v20
v_mul_f32 v242, v242, v20
v_mul_f32 v243, v243, v20
v_mul_f32 v244, v244, v20
v_mul_f32 v245, v245, v20
v_mul_f32 v246, v246, v20
v_mul_f32 v247, v247, v20
v_cvt_pk_bf16_f32 v240, v240, v241
v_cvt_pk_bf16_f32 v241, v242, v243
v_cvt_pk_bf16_f32 v242, v244, v245
v_cvt_pk_bf16_f32 v243, v246, v247
buffer_store_dwordx4 v[240:243], v16, s[44:47], s77 offen sc1
v_mfma_f32_16x16x32_bf16 v[144:147], a[184:187], v[80:83], v[144:147]
v_exp_f32 v141, v141
v_mfma_f32_16x16x32_bf16 v[144:147], a[180:183], v[76:79], v[144:147]
ds_read_b128 a[160:163], v3 offset:18432
v_cvt_pk_bf16_f32 v210, v140, v141
v_mfma_f32_16x16x32_bf16 v[144:147], a[176:179], v[72:75], v[144:147]
v_exp_f32 v142, v142
v_mfma_f32_16x16x32_bf16 v[148:151], a[192:195], v[72:75], v[228:231]
ds_read_b128 a[164:167], v3 offset:26624
ds_read_b128 a[168:171], v3 offset:19456
v_accvgpr_read_b32 v21, a132
v_mfma_f32_16x16x32_bf16 v[148:151], a[196:199], v[76:79], v[148:151]
v_exp_f32 v143, v143
v_mfma_f32_16x16x32_bf16 v[148:151], a[200:203], v[80:83], v[148:151]
ds_read_b128 a[172:175], v3 offset:27648
v_cvt_pk_bf16_f32 v211, v142, v143
v_mfma_f32_16x16x32_bf16 v[148:151], a[204:207], v[84:87], v[148:151]
v_exp_f32 v124, v124
v_mfma_f32_16x16x32_bf16 v[132:135], a[204:207], v[68:71], v[224:227]
buffer_load_dwordx4 v16, s[32:35], s64 offen offset:1024 sc1 lds
v_mfma_f32_16x16x32_bf16 v[132:135], a[200:203], v[64:67], v[132:135]
v_exp_f32 v125, v125
v_mfma_f32_16x16x32_bf16 v[132:135], a[196:199], v[60:63], v[132:135]
ds_read_b128 a[176:179], v3 offset:20480
v_max_f32 v1, v1, v21
v_rcp_f32 v21, v21
v_accvgpr_read_b32 v232, a32
v_accvgpr_read_b32 v233, a33
v_accvgpr_read_b32 v234, a34
v_accvgpr_read_b32 v235, a35
v_accvgpr_read_b32 v236, a36
v_accvgpr_read_b32 v237, a37
v_accvgpr_read_b32 v238, a38
v_accvgpr_read_b32 v239, a39
v_mul_f32 v21, v21, v6
s_add_u32 s77, s74, 4096
v_mul_f32 v232, v232, v21
v_mul_f32 v233, v233, v21
v_mul_f32 v234, v234, v21
v_mul_f32 v235, v235, v21
v_mul_f32 v236, v236, v21
v_mul_f32 v237, v237, v21
v_mul_f32 v238, v238, v21
v_mul_f32 v239, v239, v21
v_cvt_pk_bf16_f32 v232, v232, v233
v_cvt_pk_bf16_f32 v233, v234, v235
v_cvt_pk_bf16_f32 v234, v236, v237
v_cvt_pk_bf16_f32 v235, v238, v239
buffer_store_dwordx4 v[232:235], v16, s[44:47], s77 offen sc1
v_accvgpr_read_b32 v240, a40
v_accvgpr_read_b32 v241, a41
v_accvgpr_read_b32 v242, a42
v_accvgpr_read_b32 v243, a43
v_accvgpr_read_b32 v244, a44
v_accvgpr_read_b32 v245, a45
v_accvgpr_read_b32 v246, a46
v_accvgpr_read_b32 v247, a47
s_add_u32 s77, s74, 12288
v_mul_f32 v240, v240, v21
v_mul_f32 v241, v241, v21
v_mul_f32 v242, v242, v21
v_mul_f32 v243, v243, v21
v_mul_f32 v244, v244, v21
v_mul_f32 v245, v245, v21
v_mul_f32 v246, v246, v21
v_mul_f32 v247, v247, v21
v_cvt_pk_bf16_f32 v240, v240, v241
v_cvt_pk_bf16_f32 v241, v242, v243
v_cvt_pk_bf16_f32 v242, v244, v245
v_cvt_pk_bf16_f32 v243, v246, v247
buffer_store_dwordx4 v[240:243], v16, s[44:47], s77 offen sc1
v_accvgpr_read_b32 v232, a48
v_accvgpr_read_b32 v233, a49
v_accvgpr_read_b32 v234, a50
v_accvgpr_read_b32 v235, a51
v_accvgpr_read_b32 v236, a52
v_accvgpr_read_b32 v237, a53
v_accvgpr_read_b32 v238, a54
v_accvgpr_read_b32 v239, a55
s_add_u32 s77, s74, 20480
v_mul_f32 v232, v232, v21
v_mul_f32 v233, v233, v21
v_mul_f32 v234, v234, v21
v_mul_f32 v235, v235, v21
v_mul_f32 v236, v236, v21
v_mul_f32 v237, v237, v21
v_mul_f32 v238, v238, v21
v_mul_f32 v239, v239, v21
v_cvt_pk_bf16_f32 v232, v232, v233
v_cvt_pk_bf16_f32 v233, v234, v235
v_cvt_pk_bf16_f32 v234, v236, v237
v_cvt_pk_bf16_f32 v235, v238, v239
buffer_store_dwordx4 v[232:235], v16, s[44:47], s77 offen sc1
v_accvgpr_read_b32 v240, a56
v_accvgpr_read_b32 v241, a57
v_accvgpr_read_b32 v242, a58
v_accvgpr_read_b32 v243, a59
v_accvgpr_read_b32 v244, a60
v_accvgpr_read_b32 v245, a61
v_accvgpr_read_b32 v246, a62
v_accvgpr_read_b32 v247, a63
s_add_u32 s77, s74, 28672
v_mul_f32 v240, v240, v21
v_mul_f32 v241, v241, v21
v_mul_f32 v242, v242, v21
v_mul_f32 v243, v243, v21
v_mul_f32 v244, v244, v21
v_mul_f32 v245, v245, v21
v_mul_f32 v246, v246, v21
v_mul_f32 v247, v247, v21
v_cvt_pk_bf16_f32 v240, v240, v241
v_cvt_pk_bf16_f32 v241, v242, v243
v_cvt_pk_bf16_f32 v242, v244, v245
v_cvt_pk_bf16_f32 v243, v246, v247
buffer_store_dwordx4 v[240:243], v16, s[44:47], s77 offen sc1
v_cvt_pk_bf16_f32 v202, v124, v125
v_mfma_f32_16x16x32_bf16 v[132:135], a[192:195], v[56:59], v[132:135]
s_waitcnt lgkmcnt(2)
v_exp_f32 v126, v126
v_mfma_f32_16x16x32_bf16 a[64:67], a[144:147], v[184:187], a[64:67]
ds_read_b128 a[180:183], v3 offset:28672
ds_read_b128 a[184:187], v3 offset:21504
v_xor_b32 v2, 0x8000, v2
v_mfma_f32_16x16x32_bf16 a[64:67], a[148:151], v[188:191], a[64:67]
v_exp_f32 v127, v127
v_mfma_f32_16x16x32_bf16 a[96:99], a[148:151], v[196:199], a[96:99]
ds_read_b128 a[188:191], v3 offset:29696
v_cvt_pk_bf16_f32 v203, v126, v127
v_mfma_f32_16x16x32_bf16 a[96:99], a[144:147], v[192:195], a[96:99]
v_exp_f32 v128, v128
v_mfma_f32_16x16x32_bf16 a[100:103], a[152:155], v[192:195], a[100:103]
buffer_load_dwordx4 v16, s[32:35], s64 offen offset:2048 sc1 lds
v_mfma_f32_16x16x32_bf16 a[100:103], a[156:159], v[196:199], a[100:103]
v_exp_f32 v129, v129
v_mfma_f32_16x16x32_bf16 a[68:71], a[156:159], v[188:191], a[68:71]
ds_read_b128 a[192:195], v3 offset:22528
v_cvt_pk_bf16_f32 v204, v128, v129
v_mfma_f32_16x16x32_bf16 a[68:71], a[152:155], v[184:187], a[68:71]
v_exp_f32 v130, v130
v_mfma_f32_16x16x32_bf16 a[72:75], a[160:163], v[184:187], a[72:75]
ds_read_b128 a[196:199], v3 offset:30720
v_mfma_f32_16x16x32_bf16 a[72:75], a[164:167], v[188:191], a[72:75]
v_exp_f32 v131, v131
v_mfma_f32_16x16x32_bf16 a[104:107], a[164:167], v[196:199], a[104:107]
ds_read_b128 a[200:203], v3 offset:23552
v_cvt_pk_bf16_f32 v205, v130, v131
v_mfma_f32_16x16x32_bf16 a[104:107], a[160:163], v[192:195], a[104:107]
v_exp_f32 v144, v144
v_mfma_f32_16x16x32_bf16 a[108:111], a[168:171], v[192:195], a[108:111]
s_waitcnt lgkmcnt(2)
buffer_load_dwordx4 v16, s[32:35], s64 offen offset:3072 sc1 lds
v_mfma_f32_16x16x32_bf16 a[108:111], a[172:175], v[196:199], a[108:111]
s_xor_b32 s71, s71, 49152
v_exp_f32 v145, v145
v_mfma_f32_16x16x32_bf16 a[76:79], a[172:175], v[188:191], a[76:79]
ds_read_b128 a[204:207], v3 offset:31744
v_cvt_pk_bf16_f32 v212, v144, v145
v_mfma_f32_16x16x32_bf16 a[76:79], a[168:171], v[184:187], a[76:79]
v_exp_f32 v146, v146
v_mfma_f32_16x16x32_bf16 a[80:83], a[176:179], v[184:187], a[80:83]
s_waitcnt vmcnt(16)
s_barrier
v_mfma_f32_16x16x32_bf16 a[80:83], a[180:183], v[188:191], a[80:83]
s_add_u32 s70, s70, 32768
v_exp_f32 v147, v147
v_mfma_f32_16x16x32_bf16 a[112:115], a[180:183], v[196:199], a[112:115]
ds_read_b128 a[144:147], v2 offset:0
v_cvt_pk_bf16_f32 v213, v146, v147
v_mfma_f32_16x16x32_bf16 a[112:115], a[176:179], v[192:195], a[112:115]
v_exp_f32 v148, v148
v_mfma_f32_16x16x32_bf16 a[116:119], a[184:187], v[192:195], a[116:119]
ds_read_b128 a[148:151], v2 offset:1024
v_xor_b32 v3, 0x8000, v3
v_mfma_f32_16x16x32_bf16 a[116:119], a[188:191], v[196:199], a[116:119]
s_mov_b32 m0, s71
v_exp_f32 v149, v149
v_mfma_f32_16x16x32_bf16 a[84:87], a[188:191], v[188:191], a[84:87]
ds_read_b128 a[152:155], v2 offset:2048
v_cvt_pk_bf16_f32 v214, v148, v149
v_mfma_f32_16x16x32_bf16 a[84:87], a[184:187], v[184:187], a[84:87]
v_exp_f32 v150, v150
v_mfma_f32_16x16x32_bf16 a[88:91], a[192:195], v[184:187], a[88:91]
s_waitcnt lgkmcnt(2)
buffer_load_dwordx4 v16, s[32:35], s70 offen offset:0 sc1 lds
v_mfma_f32_16x16x32_bf16 a[88:91], a[196:199], v[188:191], a[88:91]
v_exp_f32 v151, v151
v_mfma_f32_16x16x32_bf16 a[120:123], a[196:199], v[196:199], a[120:123]
ds_read_b128 a[156:159], v2 offset:3072
v_cvt_pk_bf16_f32 v215, v150, v151
v_mfma_f32_16x16x32_bf16 a[120:123], a[192:195], v[192:195], a[120:123]
v_exp_f32 v132, v132
v_mfma_f32_16x16x32_bf16 a[124:127], a[200:203], v[192:195], a[124:127]
ds_read_b128 a[160:163], v2 offset:4096
v_mfma_f32_16x16x32_bf16 a[124:127], a[204:207], v[196:199], a[124:127]
v_exp_f32 v133, v133
v_mfma_f32_16x16x32_bf16 a[92:95], a[204:207], v[188:191], a[92:95]
ds_read_b128 a[164:167], v2 offset:5120
v_cvt_pk_bf16_f32 v206, v132, v133
v_mfma_f32_16x16x32_bf16 a[92:95], a[200:203], v[184:187], a[92:95]
v_exp_f32 v134, v134
v_mfma_f32_16x16x32_bf16 a[136:139], a[244:247], v[184:187], a[136:139]
buffer_load_dwordx4 v16, s[32:35], s70 offen offset:1024 sc1 lds
v_mfma_f32_16x16x32_bf16 a[136:139], a[244:247], v[188:191], a[136:139]
v_exp_f32 v135, v135
v_mfma_f32_16x16x32_bf16 a[140:143], a[244:247], v[192:195], a[140:143]
ds_read_b128 a[168:171], v2 offset:6144
v_cvt_pk_bf16_f32 v207, v134, v135
v_mfma_f32_16x16x32_bf16 a[140:143], a[244:247], v[196:199], a[140:143]
ds_read_b128 a[172:175], v2 offset:7168
s_lshl_b32 s72, s3, 1
s_sub_u32 s72, 13, s72
.p2align 3
L_S_12:
s_waitcnt lgkmcnt(7)
v_mfma_f32_16x16x32_bf16 v[120:123], a[144:147], v[56:59], v[224:227]
s_waitcnt lgkmcnt(6)
ds_read_b128 a[176:179], v2 offset:8192
ds_read_b128 a[180:183], v2 offset:9216
v_mfma_f32_16x16x32_bf16 v[120:123], a[148:151], v[60:63], v[120:123]
s_waitcnt lgkmcnt(7)
ds_read_b128 a[184:187], v2 offset:10240
v_mfma_f32_16x16x32_bf16 v[120:123], a[152:155], v[64:67], v[120:123]
s_waitcnt lgkmcnt(7)
buffer_load_dwordx4 v16, s[32:35], s70 offen offset:2048 sc1 lds
v_mfma_f32_16x16x32_bf16 v[120:123], a[156:159], v[68:71], v[120:123]
ds_read_b128 a[188:191], v2 offset:11264
ds_read_b128 a[192:195], v2 offset:12288
v_mfma_f32_16x16x32_bf16 v[136:139], a[156:159], v[84:87], v[228:231]
ds_read_b128 a[196:199], v2 offset:13312
v_mfma_f32_16x16x32_bf16 v[136:139], a[152:155], v[80:83], v[136:139]
buffer_load_dwordx4 v16, s[32:35], s70 offen offset:3072 sc1 lds
v_mfma_f32_16x16x32_bf16 v[136:139], a[148:151], v[76:79], v[136:139]
ds_read_b128 a[200:203], v2 offset:14336
ds_read_b128 a[204:207], v2 offset:15360
v_mfma_f32_16x16x32_bf16 v[136:139], a[144:147], v[72:75], v[136:139]
s_waitcnt lgkmcnt(5)
v_exp_f32 v120, v120
v_mfma_f32_16x16x32_bf16 v[140:143], a[160:163], v[72:75], v[228:231]
v_exp_f32 v121, v121
v_mfma_f32_16x16x32_bf16 v[140:143], a[164:167], v[76:79], v[140:143]
s_add_u32 m0, s71, 4096
v_exp_f32 v122, v122
v_mfma_f32_16x16x32_bf16 v[140:143], a[168:171], v[80:83], v[140:143]
v_exp_f32 v123, v123
v_mfma_f32_16x16x32_bf16 v[140:143], a[172:175], v[84:87], v[140:143]
v_exp_f32 v136, v136
v_mfma_f32_16x16x32_bf16 v[124:127], a[172:175], v[68:71], v[224:227]
ds_read_b128 a[144:147], v3 offset:0
v_cvt_pk_bf16_f32 v184, v120, v121
v_mfma_f32_16x16x32_bf16 v[124:127], a[168:171], v[64:67], v[124:127]
s_add_u32 s64, s70, 4096
v_exp_f32 v137, v137
v_mfma_f32_16x16x32_bf16 v[124:127], a[164:167], v[60:63], v[124:127]
ds_read_b128 a[148:151], v3 offset:8192
v_cvt_pk_bf16_f32 v185, v122, v123
v_mfma_f32_16x16x32_bf16 v[124:127], a[160:163], v[56:59], v[124:127]
v_exp_f32 v138, v138
v_mfma_f32_16x16x32_bf16 v[128:131], a[176:179], v[56:59], v[224:227]
ds_read_b128 a[152:155], v3 offset:1024
v_cvt_pk_bf16_f32 v192, v136, v137
v_mfma_f32_16x16x32_bf16 v[128:131], a[180:183], v[60:63], v[128:131]
v_exp_f32 v139, v139
v_mfma_f32_16x16x32_bf16 v[128:131], a[184:187], v[64:67], v[128:131]
s_waitcnt lgkmcnt(2)
ds_read_b128 a[156:159], v3 offset:9216
v_cvt_pk_bf16_f32 v193, v138, v139
v_mfma_f32_16x16x32_bf16 v[128:131], a[188:191], v[68:71], v[128:131]
v_exp_f32 v140, v140
v_mfma_f32_16x16x32_bf16 v[144:147], a[188:191], v[84:87], v[228:231]
buffer_load_dwordx4 v16, s[32:35], s64 offen offset:0 sc1 lds
v_mfma_f32_16x16x32_bf16 v[144:147], a[184:187], v[80:83], v[144:147]
v_exp_f32 v141, v141
v_mfma_f32_16x16x32_bf16 v[144:147], a[180:183], v[76:79], v[144:147]
ds_read_b128 a[160:163], v3 offset:2048
v_cvt_pk_bf16_f32 v194, v140, v141
v_mfma_f32_16x16x32_bf16 v[144:147], a[176:179], v[72:75], v[144:147]
v_exp_f32 v142, v142
v_mfma_f32_16x16x32_bf16 v[148:151], a[192:195], v[72:75], v[228:231]
ds_read_b128 a[164:167], v3 offset:10240
ds_read_b128 a[168:171], v3 offset:3072
v_mfma_f32_16x16x32_bf16 v[148:151], a[196:199], v[76:79], v[148:151]
v_exp_f32 v143, v143
v_mfma_f32_16x16x32_bf16 v[148:151], a[200:203], v[80:83], v[148:151]
ds_read_b128 a[172:175], v3 offset:11264
v_cvt_pk_bf16_f32 v195, v142, v143
v_mfma_f32_16x16x32_bf16 v[148:151], a[204:207], v[84:87], v[148:151]
v_exp_f32 v124, v124
v_mfma_f32_16x16x32_bf16 v[132:135], a[204:207], v[68:71], v[224:227]
buffer_load_dwordx4 v16, s[32:35], s64 offen offset:1024 sc1 lds
v_mfma_f32_16x16x32_bf16 v[132:135], a[200:203], v[64:67], v[132:135]
v_exp_f32 v125, v125
v_mfma_f32_16x16x32_bf16 v[132:135], a[196:199], v[60:63], v[132:135]
ds_read_b128 a[176:179], v3 offset:4096
v_cvt_pk_bf16_f32 v186, v124, v125
v_mfma_f32_16x16x32_bf16 v[132:135], a[192:195], v[56:59], v[132:135]
v_exp_f32 v126, v126
v_mfma_f32_16x16x32_bf16 a[64:67], a[144:147], v[200:203], a[64:67]
s_waitcnt lgkmcnt(1)
ds_read_b128 a[180:183], v3 offset:12288
ds_read_b128 a[184:187], v3 offset:5120
v_mfma_f32_16x16x32_bf16 a[64:67], a[148:151], v[204:207], a[64:67]
v_exp_f32 v127, v127
v_mfma_f32_16x16x32_bf16 a[96:99], a[148:151], v[212:215], a[96:99]
ds_read_b128 a[188:191], v3 offset:13312
v_cvt_pk_bf16_f32 v187, v126, v127
v_mfma_f32_16x16x32_bf16 a[96:99], a[144:147], v[208:211], a[96:99]
v_exp_f32 v128, v128
v_mfma_f32_16x16x32_bf16 a[100:103], a[152:155], v[208:211], a[100:103]
buffer_load_dwordx4 v16, s[32:35], s64 offen offset:2048 sc1 lds
v_mfma_f32_16x16x32_bf16 a[100:103], a[156:159], v[212:215], a[100:103]
v_exp_f32 v129, v129
v_mfma_f32_16x16x32_bf16 a[68:71], a[156:159], v[204:207], a[68:71]
ds_read_b128 a[192:195], v3 offset:6144
v_cvt_pk_bf16_f32 v188, v128, v129
v_mfma_f32_16x16x32_bf16 a[68:71], a[152:155], v[200:203], a[68:71]
v_exp_f32 v130, v130
v_mfma_f32_16x16x32_bf16 a[72:75], a[160:163], v[200:203], a[72:75]
ds_read_b128 a[196:199], v3 offset:14336
v_mfma_f32_16x16x32_bf16 a[72:75], a[164:167], v[204:207], a[72:75]
v_exp_f32 v131, v131
v_mfma_f32_16x16x32_bf16 a[104:107], a[164:167], v[212:215], a[104:107]
ds_read_b128 a[200:203], v3 offset:7168
v_cvt_pk_bf16_f32 v189, v130, v131
v_mfma_f32_16x16x32_bf16 a[104:107], a[160:163], v[208:211], a[104:107]
v_exp_f32 v144, v144
v_mfma_f32_16x16x32_bf16 a[108:111], a[168:171], v[208:211], a[108:111]
buffer_load_dwordx4 v16, s[32:35], s64 offen offset:3072 sc1 lds
v_mfma_f32_16x16x32_bf16 a[108:111], a[172:175], v[212:215], a[108:111]
s_xor_b32 s71, s71, 16384
v_exp_f32 v145, v145
v_mfma_f32_16x16x32_bf16 a[76:79], a[172:175], v[204:207], a[76:79]
ds_read_b128 a[204:207], v3 offset:15360
v_cvt_pk_bf16_f32 v196, v144, v145
v_mfma_f32_16x16x32_bf16 a[76:79], a[168:171], v[200:203], a[76:79]
s_waitcnt lgkmcnt(2)
v_exp_f32 v146, v146
v_mfma_f32_16x16x32_bf16 a[80:83], a[176:179], v[200:203], a[80:83]
s_waitcnt vmcnt(8)
s_barrier
v_mfma_f32_16x16x32_bf16 a[80:83], a[180:183], v[204:207], a[80:83]
s_add_u32 s70, s70, 32768
v_exp_f32 v147, v147
v_mfma_f32_16x16x32_bf16 a[112:115], a[180:183], v[212:215], a[112:115]
ds_read_b128 a[144:147], v2 offset:16384
v_cvt_pk_bf16_f32 v197, v146, v147
v_mfma_f32_16x16x32_bf16 a[112:115], a[176:179], v[208:211], a[112:115]
v_exp_f32 v148, v148
v_mfma_f32_16x16x32_bf16 a[116:119], a[184:187], v[208:211], a[116:119]
ds_read_b128 a[148:151], v2 offset:17408
v_mfma_f32_16x16x32_bf16 a[116:119], a[188:191], v[212:215], a[116:119]
s_mov_b32 m0, s71
v_exp_f32 v149, v149
v_mfma_f32_16x16x32_bf16 a[84:87], a[188:191], v[204:207], a[84:87]
ds_read_b128 a[152:155], v2 offset:18432
v_cvt_pk_bf16_f32 v198, v148, v149
v_mfma_f32_16x16x32_bf16 a[84:87], a[184:187], v[200:203], a[84:87]
v_exp_f32 v150, v150
v_mfma_f32_16x16x32_bf16 a[88:91], a[192:195], v[200:203], a[88:91]
buffer_load_dwordx4 v16, s[32:35], s70 offen offset:0 sc1 lds
v_mfma_f32_16x16x32_bf16 a[88:91], a[196:199], v[204:207], a[88:91]
v_exp_f32 v151, v151
v_mfma_f32_16x16x32_bf16 a[120:123], a[196:199], v[212:215], a[120:123]
ds_read_b128 a[156:159], v2 offset:19456
v_cvt_pk_bf16_f32 v199, v150, v151
v_mfma_f32_16x16x32_bf16 a[120:123], a[192:195], v[208:211], a[120:123]
s_waitcnt lgkmcnt(2)
v_exp_f32 v132, v132
v_mfma_f32_16x16x32_bf16 a[124:127], a[200:203], v[208:211], a[124:127]
ds_read_b128 a[160:163], v2 offset:20480
v_mfma_f32_16x16x32_bf16 a[124:127], a[204:207], v[212:215], a[124:127]
v_exp_f32 v133, v133
v_mfma_f32_16x16x32_bf16 a[92:95], a[204:207], v[204:207], a[92:95]
ds_read_b128 a[164:167], v2 offset:21504
v_cvt_pk_bf16_f32 v190, v132, v133
v_mfma_f32_16x16x32_bf16 a[92:95], a[200:203], v[200:203], a[92:95]
v_exp_f32 v134, v134
v_mfma_f32_16x16x32_bf16 a[136:139], a[244:247], v[200:203], a[136:139]
buffer_load_dwordx4 v16, s[32:35], s70 offen offset:1024 sc1 lds
v_mfma_f32_16x16x32_bf16 a[136:139], a[244:247], v[204:207], a[136:139]
v_exp_f32 v135, v135
v_mfma_f32_16x16x32_bf16 a[140:143], a[244:247], v[208:211], a[140:143]
ds_read_b128 a[168:171], v2 offset:22528
v_cvt_pk_bf16_f32 v191, v134, v135
v_mfma_f32_16x16x32_bf16 a[140:143], a[244:247], v[212:215], a[140:143]
ds_read_b128 a[172:175], v2 offset:23552
v_mfma_f32_16x16x32_bf16 v[120:123], a[144:147], v[56:59], v[224:227]
ds_read_b128 a[176:179], v2 offset:24576
ds_read_b128 a[180:183], v2 offset:25600
v_mfma_f32_16x16x32_bf16 v[120:123], a[148:151], v[60:63], v[120:123]
s_waitcnt lgkmcnt(4)
ds_read_b128 a[184:187], v2 offset:26624
v_mfma_f32_16x16x32_bf16 v[120:123], a[152:155], v[64:67], v[120:123]
buffer_load_dwordx4 v16, s[32:35], s70 offen offset:2048 sc1 lds
v_mfma_f32_16x16x32_bf16 v[120:123], a[156:159], v[68:71], v[120:123]
ds_read_b128 a[188:191], v2 offset:27648
ds_read_b128 a[192:195], v2 offset:28672
v_mfma_f32_16x16x32_bf16 v[136:139], a[156:159], v[84:87], v[228:231]
ds_read_b128 a[196:199], v2 offset:29696
v_mfma_f32_16x16x32_bf16 v[136:139], a[152:155], v[80:83], v[136:139]
buffer_load_dwordx4 v16, s[32:35], s70 offen offset:3072 sc1 lds
v_mfma_f32_16x16x32_bf16 v[136:139], a[148:151], v[76:79], v[136:139]
ds_read_b128 a[200:203], v2 offset:30720
ds_read_b128 a[204:207], v2 offset:31744
v_mfma_f32_16x16x32_bf16 v[136:139], a[144:147], v[72:75], v[136:139]
v_exp_f32 v120, v120
v_mfma_f32_16x16x32_bf16 v[140:143], a[160:163], v[72:75], v[228:231]
v_exp_f32 v121, v121
v_mfma_f32_16x16x32_bf16 v[140:143], a[164:167], v[76:79], v[140:143]
s_waitcnt lgkmcnt(3)
s_add_u32 m0, s71, 4096
v_exp_f32 v122, v122
v_mfma_f32_16x16x32_bf16 v[140:143], a[168:171], v[80:83], v[140:143]
v_exp_f32 v123, v123
v_mfma_f32_16x16x32_bf16 v[140:143], a[172:175], v[84:87], v[140:143]
v_exp_f32 v136, v136
v_mfma_f32_16x16x32_bf16 v[124:127], a[172:175], v[68:71], v[224:227]
ds_read_b128 a[144:147], v3 offset:16384
v_cvt_pk_bf16_f32 v200, v120, v121
v_mfma_f32_16x16x32_bf16 v[124:127], a[168:171], v[64:67], v[124:127]
s_add_u32 s64, s70, 4096
v_exp_f32 v137, v137
v_mfma_f32_16x16x32_bf16 v[124:127], a[164:167], v[60:63], v[124:127]
ds_read_b128 a[148:151], v3 offset:24576
v_cvt_pk_bf16_f32 v201, v122, v123
v_mfma_f32_16x16x32_bf16 v[124:127], a[160:163], v[56:59], v[124:127]
v_exp_f32 v138, v138
v_mfma_f32_16x16x32_bf16 v[128:131], a[176:179], v[56:59], v[224:227]
ds_read_b128 a[152:155], v3 offset:17408
v_cvt_pk_bf16_f32 v208, v136, v137
v_mfma_f32_16x16x32_bf16 v[128:131], a[180:183], v[60:63], v[128:131]
v_exp_f32 v139, v139
v_mfma_f32_16x16x32_bf16 v[128:131], a[184:187], v[64:67], v[128:131]
ds_read_b128 a[156:159], v3 offset:25600
v_cvt_pk_bf16_f32 v209, v138, v139
v_mfma_f32_16x16x32_bf16 v[128:131], a[188:191], v[68:71], v[128:131]
v_exp_f32 v140, v140
v_mfma_f32_16x16x32_bf16 v[144:147], a[188:191], v[84:87], v[228:231]
buffer_load_dwordx4 v16, s[32:35], s64 offen offset:0 sc1 lds
v_mfma_f32_16x16x32_bf16 v[144:147], a[184:187], v[80:83], v[144:147]
v_exp_f32 v141, v141
v_mfma_f32_16x16x32_bf16 v[144:147], a[180:183], v[76:79], v[144:147]
ds_read_b128 a[160:163], v3 offset:18432
v_cvt_pk_bf16_f32 v210, v140, v141
v_mfma_f32_16x16x32_bf16 v[144:147], a[176:179], v[72:75], v[144:147]
v_exp_f32 v142, v142
v_mfma_f32_16x16x32_bf16 v[148:151], a[192:195], v[72:75], v[228:231]
s_waitcnt lgkmcnt(1)
ds_read_b128 a[164:167], v3 offset:26624
ds_read_b128 a[168:171], v3 offset:19456
v_xor_b32 v2, 0x8000, v2
v_mfma_f32_16x16x32_bf16 v[148:151], a[196:199], v[76:79], v[148:151]
v_exp_f32 v143, v143
v_mfma_f32_16x16x32_bf16 v[148:151], a[200:203], v[80:83], v[148:151]
ds_read_b128 a[172:175], v3 offset:27648
v_cvt_pk_bf16_f32 v211, v142, v143
v_mfma_f32_16x16x32_bf16 v[148:151], a[204:207], v[84:87], v[148:151]
v_exp_f32 v124, v124
v_mfma_f32_16x16x32_bf16 v[132:135], a[204:207], v[68:71], v[224:227]
buffer_load_dwordx4 v16, s[32:35], s64 offen offset:1024 sc1 lds
v_mfma_f32_16x16x32_bf16 v[132:135], a[200:203], v[64:67], v[132:135]
v_exp_f32 v125, v125
v_mfma_f32_16x16x32_bf16 v[132:135], a[196:199], v[60:63], v[132:135]
ds_read_b128 a[176:179], v3 offset:20480
v_cvt_pk_bf16_f32 v202, v124, v125
v_mfma_f32_16x16x32_bf16 v[132:135], a[192:195], v[56:59], v[132:135]
v_exp_f32 v126, v126
v_mfma_f32_16x16x32_bf16 a[64:67], a[144:147], v[184:187], a[64:67]
ds_read_b128 a[180:183], v3 offset:28672
ds_read_b128 a[184:187], v3 offset:21504
v_mfma_f32_16x16x32_bf16 a[64:67], a[148:151], v[188:191], a[64:67]
v_exp_f32 v127, v127
v_mfma_f32_16x16x32_bf16 a[96:99], a[148:151], v[196:199], a[96:99]
ds_read_b128 a[188:191], v3 offset:29696
v_cvt_pk_bf16_f32 v203, v126, v127
v_mfma_f32_16x16x32_bf16 a[96:99], a[144:147], v[192:195], a[96:99]
v_exp_f32 v128, v128
v_mfma_f32_16x16x32_bf16 a[100:103], a[152:155], v[192:195], a[100:103]
buffer_load_dwordx4 v16, s[32:35], s64 offen offset:2048 sc1 lds
v_mfma_f32_16x16x32_bf16 a[100:103], a[156:159], v[196:199], a[100:103]
v_exp_f32 v129, v129
v_mfma_f32_16x16x32_bf16 a[68:71], a[156:159], v[188:191], a[68:71]
ds_read_b128 a[192:195], v3 offset:22528
v_cvt_pk_bf16_f32 v204, v128, v129
v_mfma_f32_16x16x32_bf16 a[68:71], a[152:155], v[184:187], a[68:71]
s_waitcnt lgkmcnt(2)
v_exp_f32 v130, v130
v_mfma_f32_16x16x32_bf16 a[72:75], a[160:163], v[184:187], a[72:75]
ds_read_b128 a[196:199], v3 offset:30720
v_mfma_f32_16x16x32_bf16 a[72:75], a[164:167], v[188:191], a[72:75]
v_exp_f32 v131, v131
v_mfma_f32_16x16x32_bf16 a[104:107], a[164:167], v[196:199], a[104:107]
ds_read_b128 a[200:203], v3 offset:23552
v_cvt_pk_bf16_f32 v205, v130, v131
v_mfma_f32_16x16x32_bf16 a[104:107], a[160:163], v[192:195], a[104:107]
v_exp_f32 v144, v144
v_mfma_f32_16x16x32_bf16 a[108:111], a[168:171], v[192:195], a[108:111]
buffer_load_dwordx4 v16, s[32:35], s64 offen offset:3072 sc1 lds
v_mfma_f32_16x16x32_bf16 a[108:111], a[172:175], v[196:199], a[108:111]
s_xor_b32 s71, s71, 49152
v_exp_f32 v145, v145
v_mfma_f32_16x16x32_bf16 a[76:79], a[172:175], v[188:191], a[76:79]
ds_read_b128 a[204:207], v3 offset:31744
v_cvt_pk_bf16_f32 v212, v144, v145
v_mfma_f32_16x16x32_bf16 a[76:79], a[168:171], v[184:187], a[76:79]
v_exp_f32 v146, v146
v_mfma_f32_16x16x32_bf16 a[80:83], a[176:179], v[184:187], a[80:83]
s_waitcnt vmcnt(8)
s_barrier
v_mfma_f32_16x16x32_bf16 a[80:83], a[180:183], v[188:191], a[80:83]
s_add_u32 s70, s70, 32768
v_exp_f32 v147, v147
v_mfma_f32_16x16x32_bf16 a[112:115], a[180:183], v[196:199], a[112:115]
ds_read_b128 a[144:147], v2 offset:0
v_cvt_pk_bf16_f32 v213, v146, v147
v_mfma_f32_16x16x32_bf16 a[112:115], a[176:179], v[192:195], a[112:115]
v_exp_f32 v148, v148
v_mfma_f32_16x16x32_bf16 a[116:119], a[184:187], v[192:195], a[116:119]
s_waitcnt lgkmcnt(1)
ds_read_b128 a[148:151], v2 offset:1024
v_xor_b32 v3, 0x8000, v3
v_mfma_f32_16x16x32_bf16 a[116:119], a[188:191], v[196:199], a[116:119]
s_mov_b32 m0, s71
v_exp_f32 v149, v149
v_mfma_f32_16x16x32_bf16 a[84:87], a[188:191], v[188:191], a[84:87]
ds_read_b128 a[152:155], v2 offset:2048
v_cvt_pk_bf16_f32 v214, v148, v149
v_mfma_f32_16x16x32_bf16 a[84:87], a[184:187], v[184:187], a[84:87]
v_exp_f32 v150, v150
v_mfma_f32_16x16x32_bf16 a[88:91], a[192:195], v[184:187], a[88:91]
buffer_load_dwordx4 v16, s[32:35], s70 offen offset:0 sc1 lds
v_mfma_f32_16x16x32_bf16 a[88:91], a[196:199], v[188:191], a[88:91]
s_sub_u32 s72, s72, 1
v_exp_f32 v151, v151
v_mfma_f32_16x16x32_bf16 a[120:123], a[196:199], v[196:199], a[120:123]
ds_read_b128 a[156:159], v2 offset:3072
v_cvt_pk_bf16_f32 v215, v150, v151
v_mfma_f32_16x16x32_bf16 a[120:123], a[192:195], v[192:195], a[120:123]
v_exp_f32 v132, v132
v_mfma_f32_16x16x32_bf16 a[124:127], a[200:203], v[192:195], a[124:127]
ds_read_b128 a[160:163], v2 offset:4096
v_mfma_f32_16x16x32_bf16 a[124:127], a[204:207], v[196:199], a[124:127]
s_cmp_lg_u32 s72, 0
v_exp_f32 v133, v133
v_mfma_f32_16x16x32_bf16 a[92:95], a[204:207], v[188:191], a[92:95]
ds_read_b128 a[164:167], v2 offset:5120
v_cvt_pk_bf16_f32 v206, v132, v133
v_mfma_f32_16x16x32_bf16 a[92:95], a[200:203], v[184:187], a[92:95]
v_exp_f32 v134, v134
v_mfma_f32_16x16x32_bf16 a[136:139], a[244:247], v[184:187], a[136:139]
buffer_load_dwordx4 v16, s[32:35], s70 offen offset:1024 sc1 lds
v_mfma_f32_16x16x32_bf16 a[136:139], a[244:247], v[188:191], a[136:139]
v_exp_f32 v135, v135
v_mfma_f32_16x16x32_bf16 a[140:143], a[244:247], v[192:195], a[140:143]
ds_read_b128 a[168:171], v2 offset:6144
v_cvt_pk_bf16_f32 v207, v134, v135
v_mfma_f32_16x16x32_bf16 a[140:143], a[244:247], v[196:199], a[140:143]
ds_read_b128 a[172:175], v2 offset:7168
s_cbranch_scc1 L_S_12
s_waitcnt lgkmcnt(7)
v_mfma_f32_16x16x32_bf16 v[136:139], a[144:147], v[72:75], v[228:231]
s_waitcnt lgkmcnt(6)
s_and_b32 s66, s2, 7
ds_read_b128 a[176:179], v2 offset:8192
ds_read_b128 a[180:183], v2 offset:9216
v_cndmask_b32 v120, v224, v17, s[0:1]
v_mfma_f32_16x16x32_bf16 v[136:139], a[148:151], v[76:79], v[136:139]
s_waitcnt lgkmcnt(7)
s_lshr_b32 s67, s2, 3
ds_read_b128 a[184:187], v2 offset:10240
v_cndmask_b32 v121, v224, v17, s[4:5]
v_cndmask_b32 v122, v224, v17, s[6:7]
v_cndmask_b32 v123, v224, v17, s[8:9]
v_mfma_f32_16x16x32_bf16 v[136:139], a[152:155], v[80:83], v[136:139]
s_waitcnt lgkmcnt(7)
s_lshr_b32 s83, s66, 2
buffer_load_dwordx4 v16, s[32:35], s70 offen offset:2048 sc1 lds
v_mfma_f32_16x16x32_bf16 v[136:139], a[156:159], v[84:87], v[136:139]
s_and_b32 s68, s66, 1
ds_read_b128 a[188:191], v2 offset:11264
ds_read_b128 a[192:195], v2 offset:12288
v_cndmask_b32 v124, v224, v17, s[10:11]
v_mfma_f32_16x16x32_bf16 v[120:123], a[156:159], v[68:71], v[120:123]
s_and_b32 s69, s67, 7
ds_read_b128 a[196:199], v2 offset:13312
v_cndmask_b32 v125, v224, v17, s[12:13]
v_mfma_f32_16x16x32_bf16 v[120:123], a[152:155], v[64:67], v[120:123]
s_lshl3_add_u32 s82, s68, s69
buffer_load_dwordx4 v16, s[32:35], s70 offen offset:3072 sc1 lds
v_mfma_f32_16x16x32_bf16 v[120:123], a[148:151], v[60:63], v[120:123]
s_and_b32 s68, s66, 2
ds_read_b128 a[200:203], v2 offset:14336
ds_read_b128 a[204:207], v2 offset:15360
v_cndmask_b32 v126, v224, v17, s[18:19]
v_mfma_f32_16x16x32_bf16 v[120:123], a[144:147], v[56:59], v[120:123]
s_waitcnt lgkmcnt(5)
s_lshr_b32 s69, s67, 3
v_exp_f32 v136, v136
v_mfma_f32_16x16x32_bf16 v[140:143], a[160:163], v[72:75], v[228:231]
s_lshl1_add_u32 s87, s68, s69
v_exp_f32 v137, v137
v_mfma_f32_16x16x32_bf16 v[140:143], a[164:167], v[76:79], v[140:143]
s_add_u32 m0, s71, 4096
v_cndmask_b32 v127, v224, v17, s[22:23]
v_exp_f32 v138, v138
v_mfma_f32_16x16x32_bf16 v[140:143], a[168:171], v[80:83], v[140:143]
s_lshl_b32 s87, s87, 8
v_exp_f32 v139, v139
v_mfma_f32_16x16x32_bf16 v[140:143], a[172:175], v[84:87], v[140:143]
s_lshl_b32 s86, s30, 13
v_exp_f32 v120, v120
v_mfma_f32_16x16x32_bf16 v[124:127], a[172:175], v[68:71], v[124:127]
s_lshl_b32 s85, s30, 16
ds_read_b128 a[144:147], v3 offset:0
v_cvt_pk_bf16_f32 v192, v136, v137
v_mfma_f32_16x16x32_bf16 v[124:127], a[168:171], v[64:67], v[124:127]
s_add_u32 s64, s70, 4096
v_cndmask_b32 v128, v224, v17, s[26:27]
v_cndmask_b32 v129, v224, v17, s[56:57]
v_cndmask_b32 v130, v224, v17, s[58:59]
v_cndmask_b32 v131, v224, v17, s[60:61]
v_exp_f32 v121, v121
v_mfma_f32_16x16x32_bf16 v[124:127], a[164:167], v[60:63], v[124:127]
s_add_u32 s85, s85, s87
ds_read_b128 a[148:151], v3 offset:8192
v_cvt_pk_bf16_f32 v193, v138, v139
v_mfma_f32_16x16x32_bf16 v[124:127], a[160:163], v[56:59], v[124:127]
s_lshl_b32 s66, s83, 20
v_exp_f32 v122, v122
v_mfma_f32_16x16x32_bf16 v[128:131], a[176:179], v[56:59], v[128:131]
s_add_u32 s85, s85, s66
ds_read_b128 a[152:155], v3 offset:1024
v_cvt_pk_bf16_f32 v184, v120, v121
v_mfma_f32_16x16x32_bf16 v[128:131], a[180:183], v[60:63], v[128:131]
s_mul_i32 s84, s82, 1310720
v_exp_f32 v123, v123
v_mfma_f32_16x16x32_bf16 v[128:131], a[184:187], v[64:67], v[128:131]
s_waitcnt lgkmcnt(2)
s_and_b32 s66, s30, 1
ds_read_b128 a[156:159], v3 offset:9216
v_cvt_pk_bf16_f32 v185, v122, v123
v_mfma_f32_16x16x32_bf16 v[128:131], a[188:191], v[68:71], v[128:131]
s_lshl_b32 s66, s66, 14
v_exp_f32 v140, v140
v_mfma_f32_16x16x32_bf16 v[144:147], a[188:191], v[84:87], v[228:231]
s_add_u32 s84, s84, s66
buffer_load_dwordx4 v16, s[32:35], s64 offen offset:0 sc1 lds
v_mfma_f32_16x16x32_bf16 v[144:147], a[184:187], v[80:83], v[144:147]
s_lshl_b32 s66, s83, 17
v_exp_f32 v141, v141
v_mfma_f32_16x16x32_bf16 v[144:147], a[180:183], v[76:79], v[144:147]
s_add_u32 s84, s84, s66
ds_read_b128 a[160:163], v3 offset:2048
v_cvt_pk_bf16_f32 v194, v140, v141
v_mfma_f32_16x16x32_bf16 v[144:147], a[176:179], v[72:75], v[144:147]
s_add_u32 s84, s84, 34603008
v_exp_f32 v142, v142
v_mfma_f32_16x16x32_bf16 v[148:151], a[192:195], v[72:75], v[228:231]
s_sub_u32 s66, 15, s82
ds_read_b128 a[164:167], v3 offset:10240
ds_read_b128 a[168:171], v3 offset:3072
v_cndmask_b32 v132, v224, v17, s[62:63]
v_mfma_f32_16x16x32_bf16 v[148:151], a[196:199], v[76:79], v[148:151]
s_min_u32 s66, s66, s82
v_cndmask_b32 v133, v224, v17, s[48:49]
v_cndmask_b32 v134, v224, v17, s[50:51]
v_cndmask_b32 v135, v224, v17, s[100:101]
v_exp_f32 v143, v143
v_mfma_f32_16x16x32_bf16 v[148:151], a[200:203], v[80:83], v[148:151]
s_lshl1_add_u32 s66, s66, s83
ds_read_b128 a[172:175], v3 offset:11264
v_cvt_pk_bf16_f32 v195, v142, v143
v_mfma_f32_16x16x32_bf16 v[148:151], a[204:207], v[84:87], v[148:151]
s_lshl_b32 s80, s66, 8
v_exp_f32 v124, v124
v_mfma_f32_16x16x32_bf16 v[132:135], a[204:207], v[68:71], v[132:135]
s_add_u32 s80, s80, 8192
buffer_load_dwordx4 v16, s[32:35], s64 offen offset:1024 sc1 lds
v_mfma_f32_16x16x32_bf16 v[132:135], a[200:203], v[64:67], v[132:135]
s_mov_b32 s36, s20
v_exp_f32 v125, v125
v_mfma_f32_16x16x32_bf16 v[132:135], a[196:199], v[60:63], v[132:135]
s_mov_b32 s37, s21
ds_read_b128 a[176:179], v3 offset:4096
v_cvt_pk_bf16_f32 v186, v124, v125
v_mfma_f32_16x16x32_bf16 v[132:135], a[192:195], v[56:59], v[132:135]
s_mov_b32 s38, 2097152
v_exp_f32 v126, v126
v_mfma_f32_16x16x32_bf16 a[64:67], a[144:147], v[200:203], a[64:67]
s_waitcnt lgkmcnt(1)
s_mov_b32 s40, s14
ds_read_b128 a[180:183], v3 offset:12288
ds_read_b128 a[184:187], v3 offset:5120
v_mfma_f32_16x16x32_bf16 a[64:67], a[148:151], v[204:207], a[64:67]
s_mov_b32 s41, s15
v_exp_f32 v127, v127
v_mfma_f32_16x16x32_bf16 a[96:99], a[148:151], v[212:215], a[96:99]
s_mov_b32 s42, 8388608
s_lshl_b32 s66, s30, 11
ds_read_b128 a[188:191], v3 offset:13312
v_lshrrev_b32 v14, 4, v0
v_bfe_u32 v12, v0, 1, 3
v_xor_b32 v12, v12, v14
v_lshlrev_b32 v12, 5, v12
v_lshl_add_u32 v12, v14, 11, v12
v_and_b32 v14, 1, v0
v_lshl_add_u32 v12, v14, 4, v12
v_xor_b32 v13, 128, v12
v_add_u32 v14, s66, v16
v_xor_b32 v15, 0x800, v14
v_cvt_pk_bf16_f32 v187, v126, v127
v_mfma_f32_16x16x32_bf16 a[96:99], a[144:147], v[208:211], a[96:99]
buffer_load_dword v19, off, s[52:55], s80 sc1
v_exp_f32 v128, v128
v_mfma_f32_16x16x32_bf16 a[100:103], a[152:155], v[208:211], a[100:103]
buffer_load_dwordx4 v16, s[32:35], s64 offen offset:2048 sc1 lds
v_mfma_f32_16x16x32_bf16 a[100:103], a[156:159], v[212:215], a[100:103]
v_exp_f32 v129, v129
v_mfma_f32_16x16x32_bf16 a[68:71], a[156:159], v[204:207], a[68:71]
ds_read_b128 a[192:195], v3 offset:6144
v_cvt_pk_bf16_f32 v188, v128, v129
v_mfma_f32_16x16x32_bf16 a[68:71], a[152:155], v[200:203], a[68:71]
v_exp_f32 v130, v130
v_mfma_f32_16x16x32_bf16 a[72:75], a[160:163], v[200:203], a[72:75]
ds_read_b128 a[196:199], v3 offset:14336
v_mfma_f32_16x16x32_bf16 a[72:75], a[164:167], v[204:207], a[72:75]
v_exp_f32 v131, v131
v_mfma_f32_16x16x32_bf16 a[104:107], a[164:167], v[212:215], a[104:107]
ds_read_b128 a[200:203], v3 offset:7168
v_cvt_pk_bf16_f32 v189, v130, v131
v_mfma_f32_16x16x32_bf16 a[104:107], a[160:163], v[208:211], a[104:107]
v_exp_f32 v144, v144
v_mfma_f32_16x16x32_bf16 a[108:111], a[168:171], v[208:211], a[108:111]
buffer_load_dwordx4 v16, s[32:35], s64 offen offset:3072 sc1 lds
v_mfma_f32_16x16x32_bf16 a[108:111], a[172:175], v[212:215], a[108:111]
v_exp_f32 v145, v145
v_mfma_f32_16x16x32_bf16 a[76:79], a[172:175], v[204:207], a[76:79]
ds_read_b128 a[204:207], v3 offset:15360
v_cvt_pk_bf16_f32 v196, v144, v145
v_mfma_f32_16x16x32_bf16 a[76:79], a[168:171], v[200:203], a[76:79]
s_waitcnt lgkmcnt(2)
v_exp_f32 v146, v146
v_mfma_f32_16x16x32_bf16 a[80:83], a[176:179], v[200:203], a[80:83]
s_waitcnt vmcnt(9)
s_barrier
v_mfma_f32_16x16x32_bf16 a[80:83], a[180:183], v[204:207], a[80:83]
v_exp_f32 v147, v147
v_mfma_f32_16x16x32_bf16 a[112:115], a[180:183], v[212:215], a[112:115]
ds_read_b128 a[144:147], v2 offset:16384
v_cvt_pk_bf16_f32 v197, v146, v147
v_mfma_f32_16x16x32_bf16 a[112:115], a[176:179], v[208:211], a[112:115]
v_exp_f32 v148, v148
v_mfma_f32_16x16x32_bf16 a[116:119], a[184:187], v[208:211], a[116:119]
ds_read_b128 a[148:151], v2 offset:17408
v_cndmask_b32 v136, v228, v17, s[0:1]
v_mfma_f32_16x16x32_bf16 a[116:119], a[188:191], v[212:215], a[116:119]
v_exp_f32 v149, v149
v_mfma_f32_16x16x32_bf16 a[84:87], a[188:191], v[204:207], a[84:87]
ds_read_b128 a[152:155], v2 offset:18432
v_cvt_pk_bf16_f32 v198, v148, v149
v_mfma_f32_16x16x32_bf16 a[84:87], a[184:187], v[200:203], a[84:87]
s_add_u32 s17, s78, L_TAIL_14-L_pc+0
v_exp_f32 v150, v150
v_mfma_f32_16x16x32_bf16 a[88:91], a[192:195], v[200:203], a[88:91]
buffer_load_dword a252, v16, s[88:91], s17 offen
v_mfma_f32_16x16x32_bf16 a[88:91], a[196:199], v[204:207], a[88:91]
v_exp_f32 v151, v151
v_mfma_f32_16x16x32_bf16 a[120:123], a[196:199], v[212:215], a[120:123]
ds_read_b128 a[156:159], v2 offset:19456
v_cvt_pk_bf16_f32 v199, v150, v151
v_mfma_f32_16x16x32_bf16 a[120:123], a[192:195], v[208:211], a[120:123]
s_waitcnt lgkmcnt(2)
v_exp_f32 v132, v132
v_mfma_f32_16x16x32_bf16 a[124:127], a[200:203], v[208:211], a[124:127]
ds_read_b128 a[160:163], v2 offset:20480
v_cndmask_b32 v137, v228, v17, s[4:5]
v_mfma_f32_16x16x32_bf16 a[124:127], a[204:207], v[212:215], a[124:127]
s_add_u32 m0, s86, 131072
v_exp_f32 v133, v133
v_mfma_f32_16x16x32_bf16 a[92:95], a[204:207], v[204:207], a[92:95]
ds_read_b128 a[164:167], v2 offset:21504
v_cvt_pk_bf16_f32 v190, v132, v133
v_mfma_f32_16x16x32_bf16 a[92:95], a[200:203], v[200:203], a[92:95]
s_add_u32 s64, s85, 0
v_exp_f32 v134, v134
v_mfma_f32_16x16x32_bf16 a[136:139], a[244:247], v[200:203], a[136:139]
s_add_u32 s17, s78, L_TAIL_14-L_pc+4096
buffer_load_dwordx4 v12, s[36:39], s64 offen lds
v_mfma_f32_16x16x32_bf16 a[136:139], a[244:247], v[204:207], a[136:139]
s_add_u32 m0, s86, 132096
buffer_load_dword a252, v16, s[88:91], s17 offen
v_cndmask_b32 v138, v228, v17, s[6:7]
v_cndmask_b32 v139, v228, v17, s[8:9]
v_exp_f32 v135, v135
v_mfma_f32_16x16x32_bf16 a[140:143], a[244:247], v[208:211], a[140:143]
s_add_u32 s64, s85, 8192
ds_read_b128 a[168:171], v2 offset:22528
v_cvt_pk_bf16_f32 v191, v134, v135
v_mfma_f32_16x16x32_bf16 a[140:143], a[244:247], v[212:215], a[140:143]
s_add_u32 s17, s78, L_TAIL_14-L_pc+8192
buffer_load_dwordx4 v13, s[36:39], s64 offen lds
ds_read_b128 a[172:175], v2 offset:23552
v_mfma_f32_16x16x32_bf16 v[136:139], a[144:147], v[72:75], v[136:139]
buffer_load_dword a252, v16, s[88:91], s17 offen
ds_read_b128 a[176:179], v2 offset:24576
v_mfma_f32_16x16x32_bf16 v[136:139], a[148:151], v[76:79], v[136:139]
s_waitcnt lgkmcnt(3)
ds_read_b128 a[180:183], v2 offset:25600
v_cndmask_b32 v140, v228, v17, s[10:11]
v_cndmask_b32 v141, v228, v17, s[12:13]
v_cndmask_b32 v142, v228, v17, s[18:19]
v_cndmask_b32 v143, v228, v17, s[22:23]
v_mfma_f32_16x16x32_bf16 v[136:139], a[152:155], v[80:83], v[136:139]
s_waitcnt vmcnt(7)
v_readfirstlane_b32 s66, v19
s_nop 0
s_cmp_lt_u32 s66, 16
s_cbranch_scc1 L_spin_16
L_spinbk_17:
ds_read_b128 a[184:187], v2 offset:26624
v_mfma_f32_16x16x32_bf16 v[136:139], a[156:159], v[84:87], v[136:139]
s_waitcnt lgkmcnt(3)
ds_read_b128 a[188:191], v2 offset:27648
v_cndmask_b32 v144, v228, v17, s[26:27]
v_mfma_f32_16x16x32_bf16 v[140:143], a[172:175], v[84:87], v[140:143]
ds_read_b128 a[192:195], v2 offset:28672
ds_read_b128 a[196:199], v2 offset:29696
ds_read_b128 a[200:203], v2 offset:30720
ds_read_b128 a[204:207], v2 offset:31744
v_cndmask_b32 v145, v228, v17, s[56:57]
v_mfma_f32_16x16x32_bf16 v[140:143], a[168:171], v[80:83], v[140:143]
v_cndmask_b32 v146, v228, v17, s[58:59]
v_cndmask_b32 v147, v228, v17, s[60:61]
v_mfma_f32_16x16x32_bf16 v[140:143], a[164:167], v[76:79], v[140:143]
ds_read_b128 a[144:147], v3 offset:16384
v_cndmask_b32 v148, v228, v17, s[62:63]
v_mfma_f32_16x16x32_bf16 v[140:143], a[160:163], v[72:75], v[140:143]
s_waitcnt lgkmcnt(7)
v_cndmask_b32 v149, v228, v17, s[48:49]
v_cndmask_b32 v150, v228, v17, s[50:51]
v_mfma_f32_16x16x32_bf16 v[144:147], a[176:179], v[72:75], v[144:147]
ds_read_b128 a[148:151], v3 offset:24576
v_cndmask_b32 v151, v228, v17, s[100:101]
v_mfma_f32_16x16x32_bf16 v[144:147], a[180:183], v[76:79], v[144:147]
s_waitcnt lgkmcnt(6)
ds_read_b128 a[152:155], v3 offset:17408
v_xor_b32 v2, 0x8000, v2
v_mfma_f32_16x16x32_bf16 v[144:147], a[184:187], v[80:83], v[144:147]
v_exp_f32 v136, v136
v_mfma_f32_16x16x32_bf16 v[144:147], a[188:191], v[84:87], v[144:147]
s_waitcnt lgkmcnt(3)
v_exp_f32 v137, v137
v_mfma_f32_16x16x32_bf16 v[148:151], a[204:207], v[84:87], v[148:151]
ds_read_b128 a[156:159], v3 offset:25600
v_cvt_pk_bf16_f32 v208, v136, v137
v_mfma_f32_16x16x32_bf16 v[148:151], a[200:203], v[80:83], v[148:151]
v_exp_f32 v138, v138
v_mfma_f32_16x16x32_bf16 v[148:151], a[196:199], v[76:79], v[148:151]
ds_read_b128 a[160:163], v3 offset:18432
v_mfma_f32_16x16x32_bf16 v[148:151], a[192:195], v[72:75], v[148:151]
s_waitcnt lgkmcnt(2)
ds_read_b128 a[164:167], v3 offset:26624
v_mfma_f32_16x16x32_bf16 a[64:67], a[144:147], v[184:187], a[64:67]
v_exp_f32 v139, v139
v_mfma_f32_16x16x32_bf16 a[64:67], a[148:151], v[188:191], a[64:67]
ds_read_b128 a[168:171], v3 offset:19456
v_cvt_pk_bf16_f32 v209, v138, v139
v_mfma_f32_16x16x32_bf16 a[96:99], a[148:151], v[196:199], a[96:99]
v_exp_f32 v140, v140
v_mfma_f32_16x16x32_bf16 a[96:99], a[144:147], v[192:195], a[96:99]
s_add_u32 m0, s86, 133120
ds_read_b128 a[172:175], v3 offset:27648
v_mfma_f32_16x16x32_bf16 a[100:103], a[152:155], v[192:195], a[100:103]
s_waitcnt lgkmcnt(3)
s_add_u32 s64, s85, 16384
v_exp_f32 v141, v141
v_mfma_f32_16x16x32_bf16 a[100:103], a[156:159], v[196:199], a[100:103]
ds_read_b128 a[176:179], v3 offset:20480
v_cvt_pk_bf16_f32 v210, v140, v141
v_mfma_f32_16x16x32_bf16 a[68:71], a[156:159], v[188:191], a[68:71]
buffer_load_dwordx4 v12, s[36:39], s64 offen lds
v_mfma_f32_16x16x32_bf16 a[68:71], a[152:155], v[184:187], a[68:71]
s_add_u32 m0, s86, 134144
ds_read_b128 a[180:183], v3 offset:28672
v_mfma_f32_16x16x32_bf16 a[72:75], a[160:163], v[184:187], a[72:75]
s_waitcnt lgkmcnt(3)
s_add_u32 s64, s85, 24576
v_exp_f32 v142, v142
v_mfma_f32_16x16x32_bf16 a[72:75], a[164:167], v[188:191], a[72:75]
buffer_load_dwordx4 v13, s[36:39], s64 offen lds
v_mfma_f32_16x16x32_bf16 a[104:107], a[164:167], v[196:199], a[104:107]
s_add_u32 m0, s86, 135168
s_add_u32 s64, s85, 32768
ds_read_b128 a[184:187], v3 offset:21504
v_mfma_f32_16x16x32_bf16 a[104:107], a[160:163], v[192:195], a[104:107]
buffer_load_dwordx4 v12, s[36:39], s64 offen lds
v_mfma_f32_16x16x32_bf16 a[108:111], a[168:171], v[192:195], a[108:111]
s_waitcnt lgkmcnt(2)
s_add_u32 m0, s86, 136192
v_exp_f32 v143, v143
v_mfma_f32_16x16x32_bf16 a[108:111], a[172:175], v[196:199], a[108:111]
s_add_u32 s64, s85, 40960
ds_read_b128 a[188:191], v3 offset:29696
v_cvt_pk_bf16_f32 v211, v142, v143
v_mfma_f32_16x16x32_bf16 a[76:79], a[172:175], v[188:191], a[76:79]
buffer_load_dwordx4 v13, s[36:39], s64 offen lds
v_mfma_f32_16x16x32_bf16 a[76:79], a[168:171], v[184:187], a[76:79]
s_add_u32 m0, s86, 137216
v_exp_f32 v144, v144
v_mfma_f32_16x16x32_bf16 a[80:83], a[176:179], v[184:187], a[80:83]
s_waitcnt lgkmcnt(1)
s_add_u32 s64, s85, 49152
ds_read_b128 a[192:195], v3 offset:22528
v_mfma_f32_16x16x32_bf16 a[80:83], a[180:183], v[188:191], a[80:83]
buffer_load_dwordx4 v12, s[36:39], s64 offen lds
ds_read_b128 a[196:199], v3 offset:30720
v_mfma_f32_16x16x32_bf16 a[112:115], a[180:183], v[196:199], a[112:115]
s_add_u32 m0, s86, 138240
s_add_u32 s64, s85, 57344
v_exp_f32 v145, v145
v_mfma_f32_16x16x32_bf16 a[112:115], a[176:179], v[192:195], a[112:115]
buffer_load_dwordx4 v13, s[36:39], s64 offen lds
v_mfma_f32_16x16x32_bf16 a[116:119], a[184:187], v[192:195], a[116:119]
s_waitcnt lgkmcnt(2)
s_add_u32 s65, s84, 0
ds_read_b128 a[200:203], v3 offset:23552
v_exp_f32 v146, v146
v_mfma_f32_16x16x32_bf16 a[116:119], a[188:191], v[196:199], a[116:119]
buffer_load_dwordx4 a[208:211], v14, s[44:47], s65 offen offset:0 sc1
ds_read_b128 a[204:207], v3 offset:31744
v_mfma_f32_16x16x32_bf16 a[84:87], a[188:191], v[188:191], a[84:87]
s_waitcnt vmcnt(12)
s_barrier
v_xor_b32 v3, 0x8000, v3
v_mfma_f32_16x16x32_bf16 a[84:87], a[184:187], v[184:187], a[84:87]
s_waitcnt lgkmcnt(2)
buffer_load_dwordx4 a[216:219], v14, s[44:47], s65 offen offset:1024 sc1
v_exp_f32 v147, v147
v_mfma_f32_16x16x32_bf16 a[88:91], a[192:195], v[184:187], a[88:91]
v_exp_f32 v148, v148
v_mfma_f32_16x16x32_bf16 a[88:91], a[196:199], v[188:191], a[88:91]
buffer_load_dwordx4 a[224:227], v15, s[44:47], s65 offen offset:0 sc1
v_mfma_f32_16x16x32_bf16 a[120:123], a[196:199], v[196:199], a[120:123]
ds_read_b128 a[144:147], v3 offset:0
v_cvt_pk_bf16_f32 v212, v144, v145
v_mfma_f32_16x16x32_bf16 a[120:123], a[192:195], v[192:195], a[120:123]
s_waitcnt lgkmcnt(1)
buffer_load_dwordx4 a[232:235], v15, s[44:47], s65 offen offset:1024 sc1
v_mfma_f32_16x16x32_bf16 a[124:127], a[200:203], v[192:195], a[124:127]
s_add_u32 s65, s84, 8192
v_exp_f32 v149, v149
v_mfma_f32_16x16x32_bf16 a[124:127], a[204:207], v[196:199], a[124:127]
buffer_load_dwordx4 a[212:215], v14, s[44:47], s65 offen offset:0 sc1
v_mfma_f32_16x16x32_bf16 a[92:95], a[204:207], v[188:191], a[92:95]
v_exp_f32 v150, v150
v_mfma_f32_16x16x32_bf16 a[92:95], a[200:203], v[184:187], a[92:95]
buffer_load_dwordx4 a[220:223], v14, s[44:47], s65 offen offset:1024 sc1
ds_read_b128 a[148:151], v3 offset:8192
v_cvt_pk_bf16_f32 v213, v146, v147
v_mfma_f32_16x16x32_bf16 a[136:139], a[244:247], v[184:187], a[136:139]
ds_read_b128 a[152:155], v3 offset:1024
v_cvt_pk_bf16_f32 v214, v148, v149
v_mfma_f32_16x16x32_bf16 a[136:139], a[244:247], v[188:191], a[136:139]
buffer_load_dwordx4 a[228:231], v15, s[44:47], s65 offen offset:0 sc1
ds_read_b128 a[156:159], v3 offset:9216
v_mfma_f32_16x16x32_bf16 a[140:143], a[244:247], v[192:195], a[140:143]
v_exp_f32 v151, v151
v_mfma_f32_16x16x32_bf16 a[140:143], a[244:247], v[196:199], a[140:143]
buffer_load_dwordx4 a[236:239], v15, s[44:47], s65 offen offset:1024 sc1
ds_read_b128 a[160:163], v3 offset:2048
ds_read_b128 a[164:167], v3 offset:10240
ds_read_b128 a[168:171], v3 offset:3072
ds_read_b128 a[172:175], v3 offset:11264
v_cvt_pk_bf16_f32 v215, v150, v151
L_TAIL_14:
ds_read_b128 a[176:179], v3 offset:4096
ds_read_b128 a[180:183], v3 offset:12288
ds_read_b128 a[184:187], v3 offset:5120
ds_read_b128 a[188:191], v3 offset:13312
ds_read_b128 a[192:195], v3 offset:6144
ds_read_b128 a[196:199], v3 offset:14336
ds_read_b128 a[200:203], v3 offset:7168
ds_read_b128 a[204:207], v3 offset:15360
v_mfma_f32_16x16x32_bf16 a[140:143], a[244:247], v[208:211], a[140:143]
s_add_u32 m0, s86, 32768
s_add_u32 s64, s85, 262144
buffer_load_dwordx4 v12, s[36:39], s64 offen lds
v_mfma_f32_16x16x32_bf16 a[140:143], a[244:247], v[212:215], a[140:143]
s_waitcnt lgkmcnt(15)
s_add_u32 m0, s86, 33792
s_add_u32 s64, s85, 270336
buffer_load_dwordx4 v13, s[36:39], s64 offen lds
v_mfma_f32_16x16x32_bf16 a[96:99], a[144:147], v[208:211], a[96:99]
s_waitcnt lgkmcnt(14)
s_add_u32 m0, s86, 34816
s_add_u32 s64, s85, 278528
buffer_load_dwordx4 v12, s[36:39], s64 offen lds
v_mfma_f32_16x16x32_bf16 a[96:99], a[148:151], v[212:215], a[96:99]
s_waitcnt lgkmcnt(12)
s_add_u32 m0, s86, 35840
s_add_u32 s64, s85, 286720
buffer_load_dwordx4 v13, s[36:39], s64 offen lds
v_mfma_f32_16x16x32_bf16 a[100:103], a[156:159], v[212:215], a[100:103]
s_add_u32 m0, s86, 36864
s_add_u32 s64, s85, 294912
buffer_load_dwordx4 v12, s[36:39], s64 offen lds
v_mfma_f32_16x16x32_bf16 a[100:103], a[152:155], v[208:211], a[100:103]
s_waitcnt lgkmcnt(11)
s_add_u32 m0, s86, 37888
s_add_u32 s64, s85, 303104
buffer_load_dwordx4 v13, s[36:39], s64 offen lds
v_mfma_f32_16x16x32_bf16 a[104:107], a[160:163], v[208:211], a[104:107]
s_waitcnt lgkmcnt(10)
s_add_u32 m0, s86, 38912
s_add_u32 s64, s85, 311296
buffer_load_dwordx4 v12, s[36:39], s64 offen lds
v_mfma_f32_16x16x32_bf16 a[104:107], a[164:167], v[212:215], a[104:107]
s_waitcnt lgkmcnt(8)
s_add_u32 m0, s86, 39936
s_add_u32 s64, s85, 319488
buffer_load_dwordx4 v13, s[36:39], s64 offen lds
v_mfma_f32_16x16x32_bf16 a[108:111], a[172:175], v[212:215], a[108:111]
s_add_u32 s65, s84, 32768
buffer_load_dwordx4 v[152:155], v14, s[44:47], s65 offen offset:0 sc1
v_mfma_f32_16x16x32_bf16 a[108:111], a[168:171], v[208:211], a[108:111]
s_waitcnt lgkmcnt(7)
buffer_load_dwordx4 v[160:163], v14, s[44:47], s65 offen offset:1024 sc1
v_mfma_f32_16x16x32_bf16 a[112:115], a[176:179], v[208:211], a[112:115]
s_waitcnt lgkmcnt(6)
buffer_load_dwordx4 v[168:171], v15, s[44:47], s65 offen offset:0 sc1
v_mfma_f32_16x16x32_bf16 a[112:115], a[180:183], v[212:215], a[112:115]
s_waitcnt lgkmcnt(4)
buffer_load_dwordx4 v[176:179], v15, s[44:47], s65 offen offset:1024 sc1
v_mfma_f32_16x16x32_bf16 a[116:119], a[188:191], v[212:215], a[116:119]
s_add_u32 s65, s84, 40960
buffer_load_dwordx4 v[156:159], v14, s[44:47], s65 offen offset:0 sc1
v_mfma_f32_16x16x32_bf16 a[116:119], a[184:187], v[208:211], a[116:119]
s_waitcnt lgkmcnt(3)
buffer_load_dwordx4 v[164:167], v14, s[44:47], s65 offen offset:1024 sc1
v_mfma_f32_16x16x32_bf16 a[120:123], a[192:195], v[208:211], a[120:123]
s_waitcnt lgkmcnt(2)
buffer_load_dwordx4 v[172:175], v15, s[44:47], s65 offen offset:0 sc1
v_mfma_f32_16x16x32_bf16 a[120:123], a[196:199], v[212:215], a[120:123]
s_waitcnt lgkmcnt(0)
buffer_load_dwordx4 v[180:183], v15, s[44:47], s65 offen offset:1024 sc1
v_mfma_f32_16x16x32_bf16 a[124:127], a[204:207], v[212:215], a[124:127]
v_mfma_f32_16x16x32_bf16 a[124:127], a[200:203], v[208:211], a[124:127]
v_accvgpr_read_b32 v22, a136
v_max_f32 v1, v1, v22
v_rcp_f32 v22, v22
v_accvgpr_read_b32 v23, a140
v_max_f32 v1, v1, v23
v_rcp_f32 v23, v23
s_mov_b32 s66, 0x5d800000
v_cmp_le_f32 vcc, s66, v1
s_lshl_b32 s67, s30, 2
s_cmp_lg_u64 vcc, 0
s_cselect_b32 s66, 1, 0
v_mov_b32 v248, s67
v_mov_b32 v249, s66
ds_write_b32 v248, v249
v_accvgpr_read_b32 v232, a64
v_accvgpr_read_b32 v233, a65
v_accvgpr_read_b32 v234, a66
v_accvgpr_read_b32 v235, a67
v_accvgpr_read_b32 v236, a68
v_accvgpr_read_b32 v237, a69
v_accvgpr_read_b32 v238, a70
v_accvgpr_read_b32 v239, a71
v_mul_f32 v22, v22, v8
s_add_u32 s77, s75, 0
v_mul_f32 v232, v232, v22
v_mul_f32 v233, v233, v22
v_mul_f32 v234, v234, v22
v_mul_f32 v235, v235, v22
v_mul_f32 v236, v236, v22
v_mul_f32 v237, v237, v22
v_mul_f32 v238, v238, v22
v_mul_f32 v239, v239, v22
v_cvt_pk_bf16_f32 v232, v232, v233
v_cvt_pk_bf16_f32 v233, v234, v235
v_cvt_pk_bf16_f32 v234, v236, v237
v_cvt_pk_bf16_f32 v235, v238, v239
buffer_store_dwordx4 v[232:235], v16, s[44:47], s77 offen sc1
v_accvgpr_read_b32 v240, a72
v_accvgpr_read_b32 v241, a73
v_accvgpr_read_b32 v242, a74
v_accvgpr_read_b32 v243, a75
v_accvgpr_read_b32 v244, a76
v_accvgpr_read_b32 v245, a77
v_accvgpr_read_b32 v246, a78
v_accvgpr_read_b32 v247, a79
s_add_u32 s77, s75, 8192
v_mul_f32 v240, v240, v22
v_mul_f32 v241, v241, v22
v_mul_f32 v242, v242, v22
v_mul_f32 v243, v243, v22
v_mul_f32 v244, v244, v22
v_mul_f32 v245, v245, v22
v_mul_f32 v246, v246, v22
v_mul_f32 v247, v247, v22
v_cvt_pk_bf16_f32 v240, v240, v241
v_cvt_pk_bf16_f32 v241, v242, v243
v_cvt_pk_bf16_f32 v242, v244, v245
v_cvt_pk_bf16_f32 v243, v246, v247
buffer_store_dwordx4 v[240:243], v16, s[44:47], s77 offen sc1
v_accvgpr_read_b32 v232, a80
v_accvgpr_read_b32 v233, a81
v_accvgpr_read_b32 v234, a82
v_accvgpr_read_b32 v235, a83
v_accvgpr_read_b32 v236, a84
v_accvgpr_read_b32 v237, a85
v_accvgpr_read_b32 v238, a86
v_accvgpr_read_b32 v239, a87
s_add_u32 s77, s75, 16384
v_mul_f32 v232, v232, v22
v_mul_f32 v233, v233, v22
v_mul_f32 v234, v234, v22
v_mul_f32 v235, v235, v22
v_mul_f32 v236, v236, v22
v_mul_f32 v237, v237, v22
v_mul_f32 v238, v238, v22
v_mul_f32 v239, v239, v22
v_cvt_pk_bf16_f32 v232, v232, v233
v_cvt_pk_bf16_f32 v233, v234, v235
v_cvt_pk_bf16_f32 v234, v236, v237
v_cvt_pk_bf16_f32 v235, v238, v239
buffer_store_dwordx4 v[232:235], v16, s[44:47], s77 offen sc1
v_accvgpr_read_b32 v240, a88
v_accvgpr_read_b32 v241, a89
v_accvgpr_read_b32 v242, a90
v_accvgpr_read_b32 v243, a91
v_accvgpr_read_b32 v244, a92
v_accvgpr_read_b32 v245, a93
v_accvgpr_read_b32 v246, a94
v_accvgpr_read_b32 v247, a95
s_add_u32 s77, s75, 24576
v_mul_f32 v240, v240, v22
v_mul_f32 v241, v241, v22
v_mul_f32 v242, v242, v22
v_mul_f32 v243, v243, v22
v_mul_f32 v244, v244, v22
v_mul_f32 v245, v245, v22
v_mul_f32 v246, v246, v22
v_mul_f32 v247, v247, v22
v_cvt_pk_bf16_f32 v240, v240, v241
v_cvt_pk_bf16_f32 v241, v242, v243
v_cvt_pk_bf16_f32 v242, v244, v245
v_cvt_pk_bf16_f32 v243, v246, v247
buffer_store_dwordx4 v[240:243], v16, s[44:47], s77 offen sc1
v_accvgpr_read_b32 v232, a96
v_accvgpr_read_b32 v233, a97
v_accvgpr_read_b32 v234, a98
v_accvgpr_read_b32 v235, a99
v_accvgpr_read_b32 v236, a100
v_accvgpr_read_b32 v237, a101
v_accvgpr_read_b32 v238, a102
v_accvgpr_read_b32 v239, a103
v_mul_f32 v23, v23, v10
s_add_u32 s77, s75, 4096
v_mul_f32 v232, v232, v23
v_mul_f32 v233, v233, v23
v_mul_f32 v234, v234, v23
v_mul_f32 v235, v235, v23
v_mul_f32 v236, v236, v23
v_mul_f32 v237, v237, v23
v_mul_f32 v238, v238, v23
v_mul_f32 v239, v239, v23
v_cvt_pk_bf16_f32 v232, v232, v233
v_cvt_pk_bf16_f32 v233, v234, v235
v_cvt_pk_bf16_f32 v234, v236, v237
v_cvt_pk_bf16_f32 v235, v238, v239
buffer_store_dwordx4 v[232:235], v16, s[44:47], s77 offen sc1
v_accvgpr_read_b32 v240, a104
v_accvgpr_read_b32 v241, a105
v_accvgpr_read_b32 v242, a106
v_accvgpr_read_b32 v243, a107
v_accvgpr_read_b32 v244, a108
v_accvgpr_read_b32 v245, a109
v_accvgpr_read_b32 v246, a110
v_accvgpr_read_b32 v247, a111
s_add_u32 s77, s75, 12288
v_mul_f32 v240, v240, v23
v_mul_f32 v241, v241, v23
v_mul_f32 v242, v242, v23
v_mul_f32 v243, v243, v23
v_mul_f32 v244, v244, v23
v_mul_f32 v245, v245, v23
v_mul_f32 v246, v246, v23
v_mul_f32 v247, v247, v23
v_cvt_pk_bf16_f32 v240, v240, v241
v_cvt_pk_bf16_f32 v241, v242, v243
v_cvt_pk_bf16_f32 v242, v244, v245
v_cvt_pk_bf16_f32 v243, v246, v247
buffer_store_dwordx4 v[240:243], v16, s[44:47], s77 offen sc1
v_accvgpr_read_b32 v232, a112
v_accvgpr_read_b32 v233, a113
v_accvgpr_read_b32 v234, a114
v_accvgpr_read_b32 v235, a115
v_accvgpr_read_b32 v236, a116
v_accvgpr_read_b32 v237, a117
v_accvgpr_read_b32 v238, a118
v_accvgpr_read_b32 v239, a119
s_add_u32 s77, s75, 20480
v_mul_f32 v232, v232, v23
v_mul_f32 v233, v233, v23
v_mul_f32 v234, v234, v23
v_mul_f32 v235, v235, v23
v_mul_f32 v236, v236, v23
v_mul_f32 v237, v237, v23
v_mul_f32 v238, v238, v23
v_mul_f32 v239, v239, v23
v_cvt_pk_bf16_f32 v232, v232, v233
v_cvt_pk_bf16_f32 v233, v234, v235
v_cvt_pk_bf16_f32 v234, v236, v237
v_cvt_pk_bf16_f32 v235, v238, v239
buffer_store_dwordx4 v[232:235], v16, s[44:47], s77 offen sc1
v_accvgpr_read_b32 v240, a120
v_accvgpr_read_b32 v241, a121
v_accvgpr_read_b32 v242, a122
v_accvgpr_read_b32 v243, a123
v_accvgpr_read_b32 v244, a124
v_accvgpr_read_b32 v245, a125
v_accvgpr_read_b32 v246, a126
v_accvgpr_read_b32 v247, a127
s_add_u32 s77, s75, 28672
v_mul_f32 v240, v240, v23
v_mul_f32 v241, v241, v23
v_mul_f32 v242, v242, v23
v_mul_f32 v243, v243, v23
v_mul_f32 v244, v244, v23
v_mul_f32 v245, v245, v23
v_mul_f32 v246, v246, v23
v_mul_f32 v247, v247, v23
v_cvt_pk_bf16_f32 v240, v240, v241
v_cvt_pk_bf16_f32 v241, v242, v243
v_cvt_pk_bf16_f32 v242, v244, v245
v_cvt_pk_bf16_f32 v243, v246, v247
buffer_store_dwordx4 v[240:243], v16, s[44:47], s77 offen sc1
v_mov_b32 v248, 0
s_waitcnt vmcnt(32) lgkmcnt(0)
s_barrier
ds_read_b128 v[248:251], v248
v_lshrrev_b32 v200, 4, v0
v_bfe_u32 v201, v0, 2, 2
v_lshl_add_u32 v202, v200, 2, v201
v_and_b32 v203, 3, v0
v_lshlrev_b32 v203, 3, v203
v_lshl_add_u32 v203, v202, 8, v203
s_and_b32 s66, s30, 1
s_lshl_b32 s66, s66, 14
s_add_u32 s66, s66, 98304
v_add_u32 v203, s66, v203
v_and_b32 v202, 7, v202
s_lshl_b32 s66, s83, 2
v_xor_b32 v202, s66, v202
v_xor_b32 v200, 4, v202
v_lshl_add_u32 v188, v200, 5, v203
v_xor_b32 v200, 5, v202
v_lshl_add_u32 v189, v200, 5, v203
v_xor_b32 v200, 6, v202
v_lshl_add_u32 v190, v200, 5, v203
v_xor_b32 v200, 7, v202
v_lshl_add_u32 v191, v200, 5, v203
v_xor_b32 v200, 0, v202
v_lshl_add_u32 v184, v200, 5, v203
v_xor_b32 v200, 1, v202
v_lshl_add_u32 v185, v200, 5, v203
v_xor_b32 v200, 2, v202
v_lshl_add_u32 v186, v200, 5, v203
v_xor_b32 v200, 3, v202
v_lshl_add_u32 v187, v200, 5, v203
s_waitcnt lgkmcnt(0)
v_or3_b32 v248, v248, v249, v250
v_or_b32 v248, v248, v251
s_nop 0
v_readfirstlane_b32 s66, v248
s_nop 0
s_cmp_gt_u32 s66, s73
s_cbranch_scc1 L_fallback_19
ds_read_b64_tr_b16 a[64:65], v188 offset:32768
ds_read_b64_tr_b16 a[66:67], v188 offset:36864
ds_read_b64_tr_b16 a[68:69], v188 offset:40960
ds_read_b64_tr_b16 a[70:71], v188 offset:45056
ds_read_b64_tr_b16 a[72:73], v189 offset:32768
ds_read_b64_tr_b16 a[74:75], v189 offset:36864
ds_read_b64_tr_b16 a[76:77], v189 offset:40960
ds_read_b64_tr_b16 a[78:79], v189 offset:45056
ds_read_b64_tr_b16 a[80:81], v190 offset:32768
ds_read_b64_tr_b16 a[82:83], v190 offset:36864
ds_read_b64_tr_b16 a[84:85], v190 offset:40960
ds_read_b64_tr_b16 a[86:87], v190 offset:45056
v_xor_b32 v192, 0x10000, v184
v_xor_b32 v193, 0x10000, v185
v_xor_b32 v194, 0x10000, v186
v_xor_b32 v195, 0x10000, v187
v_xor_b32 v196, 0x10000, v188
v_xor_b32 v197, 0x10000, v189
v_xor_b32 v198, 0x10000, v190
v_xor_b32 v199, 0x10000, v191
s_add_u32 s71, s79, 4096
s_add_u32 s72, s80, 4096
s_waitcnt lgkmcnt(10)
s_waitcnt vmcnt(28)
v_mfma_f32_16x16x32_bf16 v[136:139], a[64:67], a[232:235], 0
s_waitcnt vmcnt(24)
s_waitcnt lgkmcnt(8)
s_add_u32 m0, s86, 65536
ds_read_b64_tr_b16 a[88:89], v191 offset:32768
v_mfma_f32_16x16x32_bf16 v[136:139], a[68:71], a[236:239], v[136:139]
s_add_u32 s64, s85, 524288
ds_read_b64_tr_b16 a[90:91], v191 offset:36864
v_mfma_f32_16x16x32_bf16 v[104:107], a[68:71], a[228:231], 0
buffer_load_dwordx4 v12, s[36:39], s64 offen lds
v_mfma_f32_16x16x32_bf16 v[104:107], a[64:67], a[224:227], v[104:107]
s_add_u32 m0, s86, 66560
s_add_u32 s64, s85, 532480
ds_read_b64_tr_b16 a[92:93], v191 offset:40960
v_mfma_f32_16x16x32_bf16 v[72:75], a[64:67], a[216:219], 0
buffer_load_dwordx4 v13, s[36:39], s64 offen lds
v_mfma_f32_16x16x32_bf16 v[72:75], a[68:71], a[220:223], v[72:75]
s_add_u32 m0, s86, 67584
s_add_u32 s64, s85, 540672
ds_read_b64_tr_b16 a[94:95], v191 offset:45056
v_mfma_f32_16x16x32_bf16 v[40:43], a[68:71], a[212:215], 0
buffer_load_dwordx4 v12, s[36:39], s64 offen lds
v_mfma_f32_16x16x32_bf16 v[40:43], a[64:67], a[208:211], v[40:43]
s_waitcnt lgkmcnt(4)
s_add_u32 m0, s86, 68608
s_add_u32 s64, s85, 548864
ds_read_b64_tr_b16 a[96:97], v184 offset:32768
v_mfma_f32_16x16x32_bf16 v[44:47], a[72:75], a[208:211], 0
buffer_load_dwordx4 v13, s[36:39], s64 offen lds
v_mfma_f32_16x16x32_bf16 v[44:47], a[76:79], a[212:215], v[44:47]
s_add_u32 m0, s86, 69632
ds_read_b64_tr_b16 a[98:99], v184 offset:36864
v_mfma_f32_16x16x32_bf16 v[76:79], a[76:79], a[220:223], 0
s_add_u32 s64, s85, 557056
ds_read_b64_tr_b16 a[100:101], v184 offset:40960
v_mfma_f32_16x16x32_bf16 v[76:79], a[72:75], a[216:219], v[76:79]
buffer_load_dwordx4 v12, s[36:39], s64 offen lds
v_mfma_f32_16x16x32_bf16 v[108:111], a[72:75], a[224:227], 0
s_add_u32 m0, s86, 70656
s_add_u32 s64, s85, 565248
ds_read_b64_tr_b16 a[102:103], v184 offset:45056
v_mfma_f32_16x16x32_bf16 v[108:111], a[76:79], a[228:231], v[108:111]
buffer_load_dwordx4 v13, s[36:39], s64 offen lds
v_mfma_f32_16x16x32_bf16 v[140:143], a[76:79], a[236:239], 0
s_add_u32 m0, s86, 71680
s_add_u32 s64, s85, 573440
ds_read_b64_tr_b16 a[104:105], v185 offset:32768
v_mfma_f32_16x16x32_bf16 v[140:143], a[72:75], a[232:235], v[140:143]
buffer_load_dwordx4 v12, s[36:39], s64 offen lds
v_mfma_f32_16x16x32_bf16 v[144:147], a[80:83], a[232:235], 0
s_add_u32 m0, s86, 72704
ds_read_b64_tr_b16 a[106:107], v185 offset:36864
v_mfma_f32_16x16x32_bf16 v[144:147], a[84:87], a[236:239], v[144:147]
s_add_u32 s64, s85, 581632
ds_read_b64_tr_b16 a[108:109], v185 offset:40960
v_mfma_f32_16x16x32_bf16 v[112:115], a[84:87], a[228:231], 0
buffer_load_dwordx4 v13, s[36:39], s64 offen lds
v_mfma_f32_16x16x32_bf16 v[112:115], a[80:83], a[224:227], v[112:115]
s_add_u32 s65, s84, 65536
ds_read_b64_tr_b16 a[110:111], v185 offset:45056
v_mfma_f32_16x16x32_bf16 v[80:83], a[80:83], a[216:219], 0
buffer_load_dwordx4 a[0:3], v14, s[44:47], s65 offen offset:0 sc1
v_mfma_f32_16x16x32_bf16 v[80:83], a[84:87], a[220:223], v[80:83]
ds_read_b64_tr_b16 a[112:113], v186 offset:32768
v_mfma_f32_16x16x32_bf16 v[48:51], a[84:87], a[212:215], 0
buffer_load_dwordx4 a[8:11], v14, s[44:47], s65 offen offset:1024 sc1
v_mfma_f32_16x16x32_bf16 v[48:51], a[80:83], a[208:211], v[48:51]
s_waitcnt lgkmcnt(4)
ds_read_b64_tr_b16 a[114:115], v186 offset:36864
v_mfma_f32_16x16x32_bf16 v[52:55], a[88:91], a[208:211], 0
ds_read_b64_tr_b16 a[116:117], v186 offset:40960
v_mfma_f32_16x16x32_bf16 v[52:55], a[92:95], a[212:215], v[52:55]
buffer_load_dwordx4 a[16:19], v15, s[44:47], s65 offen offset:0 sc1
v_mfma_f32_16x16x32_bf16 v[84:87], a[92:95], a[220:223], 0
ds_read_b64_tr_b16 a[118:119], v186 offset:45056
v_mfma_f32_16x16x32_bf16 v[84:87], a[88:91], a[216:219], v[84:87]
buffer_load_dwordx4 a[24:27], v15, s[44:47], s65 offen offset:1024 sc1
v_mfma_f32_16x16x32_bf16 v[116:119], a[88:91], a[224:227], 0
s_add_u32 s65, s84, 73728
ds_read_b64_tr_b16 a[120:121], v187 offset:32768
v_mfma_f32_16x16x32_bf16 v[116:119], a[92:95], a[228:231], v[116:119]
buffer_load_dwordx4 a[4:7], v14, s[44:47], s65 offen offset:0 sc1
v_mfma_f32_16x16x32_bf16 v[148:151], a[92:95], a[236:239], 0
ds_read_b64_tr_b16 a[122:123], v187 offset:36864
v_mfma_f32_16x16x32_bf16 v[148:151], a[88:91], a[232:235], v[148:151]
ds_read_b64_tr_b16 a[124:125], v187 offset:40960
v_mfma_f32_16x16x32_bf16 v[120:123], a[96:99], a[232:235], 0
buffer_load_dwordx4 a[12:15], v14, s[44:47], s65 offen offset:1024 sc1
v_mfma_f32_16x16x32_bf16 v[120:123], a[100:103], a[236:239], v[120:123]
ds_read_b64_tr_b16 a[126:127], v187 offset:45056
v_mfma_f32_16x16x32_bf16 v[88:91], a[100:103], a[228:231], 0
buffer_load_dwordx4 a[20:23], v15, s[44:47], s65 offen offset:0 sc1
v_mfma_f32_16x16x32_bf16 v[88:91], a[96:99], a[224:227], v[88:91]
v_mfma_f32_16x16x32_bf16 v[56:59], a[96:99], a[216:219], 0
buffer_load_dwordx4 a[28:31], v15, s[44:47], s65 offen offset:1024 sc1
v_mfma_f32_16x16x32_bf16 v[56:59], a[100:103], a[220:223], v[56:59]
v_mfma_f32_16x16x32_bf16 v[24:27], a[100:103], a[212:215], 0
v_mfma_f32_16x16x32_bf16 v[24:27], a[96:99], a[208:211], v[24:27]
s_waitcnt lgkmcnt(1)
v_mfma_f32_16x16x32_bf16 v[28:31], a[104:107], a[208:211], 0
s_waitcnt vmcnt(32)
s_barrier
v_mfma_f32_16x16x32_bf16 v[28:31], a[108:111], a[212:215], v[28:31]
ds_read_b64_tr_b16 a[64:65], v196 offset:0
v_mfma_f32_16x16x32_bf16 v[60:63], a[108:111], a[220:223], 0
s_add_u32 m0, s86, 98304
ds_read_b64_tr_b16 a[66:67], v196 offset:4096
v_mfma_f32_16x16x32_bf16 v[60:63], a[104:107], a[216:219], v[60:63]
s_add_u32 s64, s85, 786432
ds_read_b64_tr_b16 a[68:69], v196 offset:8192
v_mfma_f32_16x16x32_bf16 v[92:95], a[104:107], a[224:227], 0
buffer_load_dwordx4 v12, s[36:39], s64 offen lds
v_mfma_f32_16x16x32_bf16 v[92:95], a[108:111], a[228:231], v[92:95]
ds_read_b64_tr_b16 a[70:71], v196 offset:12288
v_mfma_f32_16x16x32_bf16 v[124:127], a[108:111], a[236:239], 0
s_add_u32 m0, s86, 99328
ds_read_b64_tr_b16 a[72:73], v197 offset:0
v_mfma_f32_16x16x32_bf16 v[124:127], a[104:107], a[232:235], v[124:127]
s_add_u32 s64, s85, 794624
ds_read_b64_tr_b16 a[74:75], v197 offset:4096
v_mfma_f32_16x16x32_bf16 v[128:131], a[112:115], a[232:235], 0
buffer_load_dwordx4 v13, s[36:39], s64 offen lds
v_mfma_f32_16x16x32_bf16 v[128:131], a[116:119], a[236:239], v[128:131]
ds_read_b64_tr_b16 a[76:77], v197 offset:8192
v_mfma_f32_16x16x32_bf16 v[96:99], a[116:119], a[228:231], 0
s_add_u32 m0, s86, 100352
ds_read_b64_tr_b16 a[78:79], v197 offset:12288
v_mfma_f32_16x16x32_bf16 v[96:99], a[112:115], a[224:227], v[96:99]
s_add_u32 s64, s85, 802816
ds_read_b64_tr_b16 a[80:81], v198 offset:0
v_mfma_f32_16x16x32_bf16 v[64:67], a[112:115], a[216:219], 0
buffer_load_dwordx4 v12, s[36:39], s64 offen lds
v_mfma_f32_16x16x32_bf16 v[64:67], a[116:119], a[220:223], v[64:67]
ds_read_b64_tr_b16 a[82:83], v198 offset:4096
v_mfma_f32_16x16x32_bf16 v[32:35], a[116:119], a[212:215], 0
s_add_u32 m0, s86, 101376
ds_read_b64_tr_b16 a[84:85], v198 offset:8192
v_mfma_f32_16x16x32_bf16 v[32:35], a[112:115], a[208:211], v[32:35]
s_add_u32 s64, s85, 811008
ds_read_b64_tr_b16 a[86:87], v198 offset:12288
v_mfma_f32_16x16x32_bf16 v[36:39], a[120:123], a[208:211], 0
s_waitcnt lgkmcnt(6)
buffer_load_dwordx4 v13, s[36:39], s64 offen lds
v_mfma_f32_16x16x32_bf16 v[36:39], a[124:127], a[212:215], v[36:39]
v_mfma_f32_16x16x32_bf16 v[68:71], a[124:127], a[220:223], 0
s_add_u32 m0, s86, 102400
v_mfma_f32_16x16x32_bf16 v[68:71], a[120:123], a[216:219], v[68:71]
s_add_u32 s64, s85, 819200
v_mfma_f32_16x16x32_bf16 v[100:103], a[120:123], a[224:227], 0
buffer_load_dwordx4 v12, s[36:39], s64 offen lds
v_mfma_f32_16x16x32_bf16 v[100:103], a[124:127], a[228:231], v[100:103]
v_mfma_f32_16x16x32_bf16 v[132:135], a[124:127], a[236:239], 0
v_mfma_f32_16x16x32_bf16 v[132:135], a[120:123], a[232:235], v[132:135]
s_waitcnt vmcnt(33)
v_mfma_f32_16x16x32_bf16 v[136:139], a[64:67], v[176:179], v[136:139]
s_waitcnt vmcnt(29)
s_add_u32 m0, s86, 103424
ds_read_b64_tr_b16 a[88:89], v199 offset:0
v_mfma_f32_16x16x32_bf16 v[136:139], a[68:71], v[180:183], v[136:139]
s_add_u32 s64, s85, 827392
ds_read_b64_tr_b16 a[90:91], v199 offset:4096
v_mfma_f32_16x16x32_bf16 v[104:107], a[68:71], v[172:175], v[104:107]
buffer_load_dwordx4 v13, s[36:39], s64 offen lds
v_mfma_f32_16x16x32_bf16 v[104:107], a[64:67], v[168:171], v[104:107]
s_add_u32 m0, s86, 104448
ds_read_b64_tr_b16 a[92:93], v199 offset:8192
v_mfma_f32_16x16x32_bf16 v[72:75], a[64:67], v[160:163], v[72:75]
s_add_u32 s64, s85, 835584
ds_read_b64_tr_b16 a[94:95], v199 offset:12288
v_mfma_f32_16x16x32_bf16 v[72:75], a[68:71], v[164:167], v[72:75]
buffer_load_dwordx4 v12, s[36:39], s64 offen lds
v_mfma_f32_16x16x32_bf16 v[40:43], a[68:71], v[156:159], v[40:43]
s_add_u32 m0, s86, 105472
ds_read_b64_tr_b16 a[96:97], v192 offset:0
v_mfma_f32_16x16x32_bf16 v[40:43], a[64:67], v[152:155], v[40:43]
s_add_u32 s64, s85, 843776
ds_read_b64_tr_b16 a[98:99], v192 offset:4096
v_mfma_f32_16x16x32_bf16 v[44:47], a[72:75], v[152:155], v[44:47]
s_waitcnt lgkmcnt(5)
buffer_load_dwordx4 v13, s[36:39], s64 offen lds
v_mfma_f32_16x16x32_bf16 v[44:47], a[76:79], v[156:159], v[44:47]
ds_read_b64_tr_b16 a[100:101], v192 offset:8192
v_mfma_f32_16x16x32_bf16 v[76:79], a[76:79], v[164:167], v[76:79]
ds_read_b64_tr_b16 a[102:103], v192 offset:12288
v_mfma_f32_16x16x32_bf16 v[76:79], a[72:75], v[160:163], v[76:79]
s_add_u32 s65, s84, 98304
ds_read_b64_tr_b16 a[104:105], v193 offset:0
v_mfma_f32_16x16x32_bf16 v[108:111], a[72:75], v[168:171], v[108:111]
buffer_load_dwordx4 a[32:35], v14, s[44:47], s65 offen offset:0 sc1
v_mfma_f32_16x16x32_bf16 v[108:111], a[76:79], v[172:175], v[108:111]
ds_read_b64_tr_b16 a[106:107], v193 offset:4096
v_mfma_f32_16x16x32_bf16 v[140:143], a[76:79], v[180:183], v[140:143]
ds_read_b64_tr_b16 a[108:109], v193 offset:8192
v_mfma_f32_16x16x32_bf16 v[140:143], a[72:75], v[176:179], v[140:143]
buffer_load_dwordx4 a[40:43], v14, s[44:47], s65 offen offset:1024 sc1
v_mfma_f32_16x16x32_bf16 v[144:147], a[80:83], v[176:179], v[144:147]
ds_read_b64_tr_b16 a[110:111], v193 offset:12288
v_mfma_f32_16x16x32_bf16 v[144:147], a[84:87], v[180:183], v[144:147]
v_mfma_f32_16x16x32_bf16 v[112:115], a[84:87], v[172:175], v[112:115]
buffer_load_dwordx4 a[48:51], v15, s[44:47], s65 offen offset:0 sc1
v_mfma_f32_16x16x32_bf16 v[112:115], a[80:83], v[168:171], v[112:115]
ds_read_b64_tr_b16 a[112:113], v194 offset:0
v_mfma_f32_16x16x32_bf16 v[80:83], a[80:83], v[160:163], v[80:83]
ds_read_b64_tr_b16 a[114:115], v194 offset:4096
v_mfma_f32_16x16x32_bf16 v[80:83], a[84:87], v[164:167], v[80:83]
ds_read_b64_tr_b16 a[116:117], v194 offset:8192
v_mfma_f32_16x16x32_bf16 v[48:51], a[84:87], v[156:159], v[48:51]
buffer_load_dwordx4 a[56:59], v15, s[44:47], s65 offen offset:1024 sc1
v_mfma_f32_16x16x32_bf16 v[48:51], a[80:83], v[152:155], v[48:51]
s_waitcnt lgkmcnt(4)
ds_read_b64_tr_b16 a[118:119], v194 offset:12288
v_mfma_f32_16x16x32_bf16 v[52:55], a[88:91], v[152:155], v[52:55]
s_add_u32 s65, s84, 106496
v_mfma_f32_16x16x32_bf16 v[52:55], a[92:95], v[156:159], v[52:55]
buffer_load_dwordx4 a[36:39], v14, s[44:47], s65 offen offset:0 sc1
v_mfma_f32_16x16x32_bf16 v[84:87], a[92:95], v[164:167], v[84:87]
ds_read_b64_tr_b16 a[120:121], v195 offset:0
v_mfma_f32_16x16x32_bf16 v[84:87], a[88:91], v[160:163], v[84:87]
ds_read_b64_tr_b16 a[122:123], v195 offset:4096
v_mfma_f32_16x16x32_bf16 v[116:119], a[88:91], v[168:171], v[116:119]
s_lshl_b32 s66, s30, 30
buffer_load_dwordx4 a[44:47], v14, s[44:47], s65 offen offset:1024 sc1
v_mfma_f32_16x16x32_bf16 v[116:119], a[92:95], v[172:175], v[116:119]
ds_read_b64_tr_b16 a[124:125], v195 offset:8192
v_lshl_add_u32 v1, v0, 24, s66
v_mfma_f32_16x16x32_bf16 v[148:151], a[92:95], v[180:183], v[148:151]
ds_read_b64_tr_b16 a[126:127], v195 offset:12288
v_mfma_f32_16x16x32_bf16 v[148:151], a[88:91], v[176:179], v[148:151]
v_mfma_f32_16x16x32_bf16 v[120:123], a[96:99], v[176:179], v[120:123]
buffer_load_dwordx4 a[52:55], v15, s[44:47], s65 offen offset:0 sc1
v_mfma_f32_16x16x32_bf16 v[120:123], a[100:103], v[180:183], v[120:123]
v_mfma_f32_16x16x32_bf16 v[88:91], a[100:103], v[172:175], v[88:91]
v_mfma_f32_16x16x32_bf16 v[88:91], a[96:99], v[168:171], v[88:91]
buffer_load_dwordx4 a[60:63], v15, s[44:47], s65 offen offset:1024 sc1
v_mfma_f32_16x16x32_bf16 v[56:59], a[96:99], v[160:163], v[56:59]
v_mfma_f32_16x16x32_bf16 v[56:59], a[100:103], v[164:167], v[56:59]
v_mfma_f32_16x16x32_bf16 v[24:27], a[100:103], v[156:159], v[24:27]
v_mfma_f32_16x16x32_bf16 v[24:27], a[96:99], v[152:155], v[24:27]
v_mfma_f32_16x16x32_bf16 v[28:31], a[104:107], v[152:155], v[28:31]
s_waitcnt vmcnt(24)
s_barrier
s_waitcnt lgkmcnt(0)
v_mfma_f32_16x16x32_bf16 v[28:31], a[108:111], v[156:159], v[28:31]
s_mul_i32 s66, s83, 3145728
s_add_u32 s85, s85, s66
v_mfma_f32_16x16x32_bf16 v[60:63], a[108:111], v[164:167], v[60:63]
s_add_u32 m0, s86, 131072
buffer_atomic_add a251, v1, s[52:55], s71 offen offset:0 sc1
v_mfma_f32_16x16x32_bf16 v[60:63], a[104:107], v[160:163], v[60:63]
s_add_u32 s64, s85, 0
ds_read_b64_tr_b16 a[64:65], v196 offset:32768
v_mfma_f32_16x16x32_bf16 v[92:95], a[104:107], v[168:171], v[92:95]
buffer_load_dwordx4 v12, s[40:43], s64 offen lds
v_mfma_f32_16x16x32_bf16 v[92:95], a[108:111], v[172:175], v[92:95]
ds_read_b64_tr_b16 a[66:67], v196 offset:36864
v_mfma_f32_16x16x32_bf16 v[124:127], a[108:111], v[180:183], v[124:127]
s_add_u32 m0, s86, 132096
ds_read_b64_tr_b16 a[68:69], v196 offset:40960
v_mfma_f32_16x16x32_bf16 v[124:127], a[104:107], v[176:179], v[124:127]
s_add_u32 s64, s85, 8192
ds_read_b64_tr_b16 a[70:71], v196 offset:45056
v_mfma_f32_16x16x32_bf16 v[128:131], a[112:115], v[176:179], v[128:131]
buffer_load_dwordx4 v13, s[40:43], s64 offen lds
v_mfma_f32_16x16x32_bf16 v[128:131], a[116:119], v[180:183], v[128:131]
ds_read_b64_tr_b16 a[72:73], v197 offset:32768
v_mfma_f32_16x16x32_bf16 v[96:99], a[116:119], v[172:175], v[96:99]
s_add_u32 m0, s86, 133120
ds_read_b64_tr_b16 a[74:75], v197 offset:36864
v_mfma_f32_16x16x32_bf16 v[96:99], a[112:115], v[168:171], v[96:99]
s_add_u32 s64, s85, 16384
ds_read_b64_tr_b16 a[76:77], v197 offset:40960
v_mfma_f32_16x16x32_bf16 v[64:67], a[112:115], v[160:163], v[64:67]
buffer_load_dwordx4 v12, s[40:43], s64 offen lds
v_mfma_f32_16x16x32_bf16 v[64:67], a[116:119], v[164:167], v[64:67]
ds_read_b64_tr_b16 a[78:79], v197 offset:45056
v_mfma_f32_16x16x32_bf16 v[32:35], a[116:119], v[156:159], v[32:35]
s_add_u32 m0, s86, 134144
ds_read_b64_tr_b16 a[80:81], v198 offset:32768
v_mfma_f32_16x16x32_bf16 v[32:35], a[112:115], v[152:155], v[32:35]
s_add_u32 s64, s85, 24576
ds_read_b64_tr_b16 a[82:83], v198 offset:36864
v_mfma_f32_16x16x32_bf16 v[36:39], a[120:123], v[152:155], v[36:39]
buffer_load_dwordx4 v13, s[40:43], s64 offen lds
v_mfma_f32_16x16x32_bf16 v[36:39], a[124:127], v[156:159], v[36:39]
ds_read_b64_tr_b16 a[84:85], v198 offset:40960
v_mfma_f32_16x16x32_bf16 v[68:71], a[124:127], v[164:167], v[68:71]
s_add_u32 m0, s86, 135168
ds_read_b64_tr_b16 a[86:87], v198 offset:45056
v_mfma_f32_16x16x32_bf16 v[68:71], a[120:123], v[160:163], v[68:71]
s_add_u32 s64, s85, 32768
v_mfma_f32_16x16x32_bf16 v[100:103], a[120:123], v[168:171], v[100:103]
buffer_load_dwordx4 v12, s[40:43], s64 offen lds
v_mfma_f32_16x16x32_bf16 v[100:103], a[124:127], v[172:175], v[100:103]
v_mfma_f32_16x16x32_bf16 v[132:135], a[124:127], v[180:183], v[132:135]
v_mfma_f32_16x16x32_bf16 v[132:135], a[120:123], v[176:179], v[132:135]
s_waitcnt vmcnt(26)
s_waitcnt lgkmcnt(2)
v_mfma_f32_16x16x32_bf16 v[136:139], a[64:67], a[24:27], v[136:139]
s_waitcnt vmcnt(22)
s_add_u32 m0, s86, 136192
ds_read_b64_tr_b16 a[88:89], v199 offset:32768
v_mfma_f32_16x16x32_bf16 v[136:139], a[68:71], a[28:31], v[136:139]
s_add_u32 s64, s85, 40960
ds_read_b64_tr_b16 a[90:91], v199 offset:36864
v_mfma_f32_16x16x32_bf16 v[104:107], a[68:71], a[20:23], v[104:107]
buffer_load_dwordx4 v13, s[40:43], s64 offen lds
v_mfma_f32_16x16x32_bf16 v[104:107], a[64:67], a[16:19], v[104:107]
s_add_u32 m0, s86, 137216
ds_read_b64_tr_b16 a[92:93], v199 offset:40960
v_mfma_f32_16x16x32_bf16 v[72:75], a[64:67], a[8:11], v[72:75]
s_add_u32 s64, s85, 49152
ds_read_b64_tr_b16 a[94:95], v199 offset:45056
v_mfma_f32_16x16x32_bf16 v[72:75], a[68:71], a[12:15], v[72:75]
buffer_load_dwordx4 v12, s[40:43], s64 offen lds
v_mfma_f32_16x16x32_bf16 v[40:43], a[68:71], a[4:7], v[40:43]
s_add_u32 m0, s86, 138240
ds_read_b64_tr_b16 a[96:97], v192 offset:32768
v_mfma_f32_16x16x32_bf16 v[40:43], a[64:67], a[0:3], v[40:43]
s_add_u32 s64, s85, 57344
ds_read_b64_tr_b16 a[98:99], v192 offset:36864
v_mfma_f32_16x16x32_bf16 v[44:47], a[72:75], a[0:3], v[44:47]
buffer_load_dwordx4 v13, s[40:43], s64 offen lds
v_mfma_f32_16x16x32_bf16 v[44:47], a[76:79], a[4:7], v[44:47]
ds_read_b64_tr_b16 a[100:101], v192 offset:40960
v_mfma_f32_16x16x32_bf16 v[76:79], a[76:79], a[12:15], v[76:79]
ds_read_b64_tr_b16 a[102:103], v192 offset:45056
v_mfma_f32_16x16x32_bf16 v[76:79], a[72:75], a[8:11], v[76:79]
ds_read_b64_tr_b16 a[104:105], v193 offset:32768
v_mfma_f32_16x16x32_bf16 v[108:111], a[72:75], a[16:19], v[108:111]
ds_read_b64_tr_b16 a[106:107], v193 offset:36864
v_mfma_f32_16x16x32_bf16 v[108:111], a[76:79], a[20:23], v[108:111]
ds_read_b64_tr_b16 a[108:109], v193 offset:40960
v_mfma_f32_16x16x32_bf16 v[140:143], a[76:79], a[28:31], v[140:143]
s_add_u32 s17, s78, .-L_pc+2048
ds_read_b64_tr_b16 a[110:111], v193 offset:45056
v_mfma_f32_16x16x32_bf16 v[140:143], a[72:75], a[24:27], v[140:143]
buffer_load_dword a252, v16, s[88:91], s17 offen
v_mfma_f32_16x16x32_bf16 v[144:147], a[80:83], a[24:27], v[144:147]
s_waitcnt lgkmcnt(6)
v_mfma_f32_16x16x32_bf16 v[144:147], a[84:87], a[28:31], v[144:147]
s_add_u32 s17, s78, .-L_pc+6144
v_mfma_f32_16x16x32_bf16 v[112:115], a[84:87], a[20:23], v[112:115]
buffer_load_dword a252, v16, s[88:91], s17 offen
v_mfma_f32_16x16x32_bf16 v[112:115], a[80:83], a[16:19], v[112:115]
ds_read_b64_tr_b16 a[112:113], v194 offset:32768
v_mfma_f32_16x16x32_bf16 v[80:83], a[80:83], a[8:11], v[80:83]
s_add_u32 s17, s78, .-L_pc+10240
ds_read_b64_tr_b16 a[114:115], v194 offset:36864
v_mfma_f32_16x16x32_bf16 v[80:83], a[84:87], a[12:15], v[80:83]
buffer_load_dword a252, v16, s[88:91], s17 offen
v_mfma_f32_16x16x32_bf16 v[48:51], a[84:87], a[4:7], v[48:51]
ds_read_b64_tr_b16 a[116:117], v194 offset:40960
v_mfma_f32_16x16x32_bf16 v[48:51], a[80:83], a[0:3], v[48:51]
ds_read_b64_tr_b16 a[118:119], v194 offset:45056
v_mfma_f32_16x16x32_bf16 v[52:55], a[88:91], a[0:3], v[52:55]
buffer_load_dword v19, off, s[52:55], s72 sc1
v_mfma_f32_16x16x32_bf16 v[52:55], a[92:95], a[4:7], v[52:55]
v_mfma_f32_16x16x32_bf16 v[84:87], a[92:95], a[12:15], v[84:87]
ds_read_b64_tr_b16 a[120:121], v195 offset:32768
v_mfma_f32_16x16x32_bf16 v[84:87], a[88:91], a[8:11], v[84:87]
ds_read_b64_tr_b16 a[122:123], v195 offset:36864
v_mfma_f32_16x16x32_bf16 v[116:119], a[88:91], a[16:19], v[116:119]
ds_read_b64_tr_b16 a[124:125], v195 offset:40960
v_mfma_f32_16x16x32_bf16 v[116:119], a[92:95], a[20:23], v[116:119]
ds_read_b64_tr_b16 a[126:127], v195 offset:45056
v_mfma_f32_16x16x32_bf16 v[148:151], a[92:95], a[28:31], v[148:151]
v_mfma_f32_16x16x32_bf16 v[148:151], a[88:91], a[24:27], v[148:151]
v_mfma_f32_16x16x32_bf16 v[120:123], a[96:99], a[24:27], v[120:123]
s_waitcnt lgkmcnt(4)
v_mfma_f32_16x16x32_bf16 v[120:123], a[100:103], a[28:31], v[120:123]
v_mfma_f32_16x16x32_bf16 v[88:91], a[100:103], a[20:23], v[88:91]
v_mfma_f32_16x16x32_bf16 v[88:91], a[96:99], a[16:19], v[88:91]
v_mfma_f32_16x16x32_bf16 v[56:59], a[96:99], a[8:11], v[56:59]
v_mfma_f32_16x16x32_bf16 v[56:59], a[100:103], a[12:15], v[56:59]
v_mfma_f32_16x16x32_bf16 v[24:27], a[100:103], a[4:7], v[24:27]
v_mfma_f32_16x16x32_bf16 v[24:27], a[96:99], a[0:3], v[24:27]
v_mfma_f32_16x16x32_bf16 v[28:31], a[104:107], a[0:3], v[28:31]
s_waitcnt vmcnt(21)
s_barrier
v_mfma_f32_16x16x32_bf16 v[28:31], a[108:111], a[4:7], v[28:31]
ds_read_b64_tr_b16 a[64:65], v188 offset:0
v_mfma_f32_16x16x32_bf16 v[60:63], a[108:111], a[12:15], v[60:63]
s_add_u32 m0, s86, 32768
ds_read_b64_tr_b16 a[66:67], v188 offset:4096
v_mfma_f32_16x16x32_bf16 v[60:63], a[104:107], a[8:11], v[60:63]
s_add_u32 s64, s85, 262144
ds_read_b64_tr_b16 a[68:69], v188 offset:8192
v_mfma_f32_16x16x32_bf16 v[92:95], a[104:107], a[16:19], v[92:95]
buffer_load_dwordx4 v12, s[40:43], s64 offen lds
v_mfma_f32_16x16x32_bf16 v[92:95], a[108:111], a[20:23], v[92:95]
ds_read_b64_tr_b16 a[70:71], v188 offset:12288
v_mfma_f32_16x16x32_bf16 v[124:127], a[108:111], a[28:31], v[124:127]
s_add_u32 m0, s86, 33792
ds_read_b64_tr_b16 a[72:73], v189 offset:0
v_mfma_f32_16x16x32_bf16 v[124:127], a[104:107], a[24:27], v[124:127]
s_add_u32 s64, s85, 270336
ds_read_b64_tr_b16 a[74:75], v189 offset:4096
v_mfma_f32_16x16x32_bf16 v[128:131], a[112:115], a[24:27], v[128:131]
buffer_load_dwordx4 v13, s[40:43], s64 offen lds
v_mfma_f32_16x16x32_bf16 v[128:131], a[116:119], a[28:31], v[128:131]
ds_read_b64_tr_b16 a[76:77], v189 offset:8192
v_mfma_f32_16x16x32_bf16 v[96:99], a[116:119], a[20:23], v[96:99]
s_add_u32 m0, s86, 34816
ds_read_b64_tr_b16 a[78:79], v189 offset:12288
v_mfma_f32_16x16x32_bf16 v[96:99], a[112:115], a[16:19], v[96:99]
s_add_u32 s64, s85, 278528
ds_read_b64_tr_b16 a[80:81], v190 offset:0
v_mfma_f32_16x16x32_bf16 v[64:67], a[112:115], a[8:11], v[64:67]
buffer_load_dwordx4 v12, s[40:43], s64 offen lds
v_mfma_f32_16x16x32_bf16 v[64:67], a[116:119], a[12:15], v[64:67]
ds_read_b64_tr_b16 a[82:83], v190 offset:4096
v_mfma_f32_16x16x32_bf16 v[32:35], a[116:119], a[4:7], v[32:35]
s_add_u32 m0, s86, 35840
ds_read_b64_tr_b16 a[84:85], v190 offset:8192
v_mfma_f32_16x16x32_bf16 v[32:35], a[112:115], a[0:3], v[32:35]
s_waitcnt lgkmcnt(5)
s_add_u32 s64, s85, 286720
ds_read_b64_tr_b16 a[86:87], v190 offset:12288
v_mfma_f32_16x16x32_bf16 v[36:39], a[120:123], a[0:3], v[36:39]
buffer_load_dwordx4 v13, s[40:43], s64 offen lds
v_mfma_f32_16x16x32_bf16 v[36:39], a[124:127], a[4:7], v[36:39]
v_mfma_f32_16x16x32_bf16 v[68:71], a[124:127], a[12:15], v[68:71]
s_add_u32 m0, s86, 36864
v_mfma_f32_16x16x32_bf16 v[68:71], a[120:123], a[8:11], v[68:71]
s_add_u32 s64, s85, 294912
v_mfma_f32_16x16x32_bf16 v[100:103], a[120:123], a[16:19], v[100:103]
buffer_load_dwordx4 v12, s[40:43], s64 offen lds
v_mfma_f32_16x16x32_bf16 v[100:103], a[124:127], a[20:23], v[100:103]
v_mfma_f32_16x16x32_bf16 v[132:135], a[124:127], a[28:31], v[132:135]
v_mfma_f32_16x16x32_bf16 v[132:135], a[120:123], a[24:27], v[132:135]
s_waitcnt vmcnt(22)
v_mfma_f32_16x16x32_bf16 v[136:139], a[64:67], a[56:59], v[136:139]
s_waitcnt vmcnt(5)
v_readfirstlane_b32 s66, v19
s_nop 0
s_cmp_lt_u32 s66, 16
s_cbranch_scc1 L_spin_2024
L_spinbk_2025:
s_mul_i32 s66, s83, 393216
s_add_u32 s84, s84, s66
s_sub_u32 s84, s84, 1048576
v_mfma_f32_16x16x32_bf16 v[136:139], a[68:71], a[60:63], v[136:139]
s_add_u32 s65, s84, 0
ds_read_b64_tr_b16 a[88:89], v191 offset:0
v_mfma_f32_16x16x32_bf16 v[104:107], a[68:71], a[52:55], v[104:107]
buffer_load_dwordx4 a[208:211], v14, s[44:47], s65 offen offset:0 sc1
v_mfma_f32_16x16x32_bf16 v[104:107], a[64:67], a[48:51], v[104:107]
ds_read_b64_tr_b16 a[90:91], v191 offset:4096
v_mfma_f32_16x16x32_bf16 v[72:75], a[64:67], a[40:43], v[72:75]
buffer_load_dwordx4 a[216:219], v14, s[44:47], s65 offen offset:1024 sc1
v_mfma_f32_16x16x32_bf16 v[72:75], a[68:71], a[44:47], v[72:75]
ds_read_b64_tr_b16 a[92:93], v191 offset:8192
v_mfma_f32_16x16x32_bf16 v[40:43], a[68:71], a[36:39], v[40:43]
buffer_load_dwordx4 a[224:227], v15, s[44:47], s65 offen offset:0 sc1
v_mfma_f32_16x16x32_bf16 v[40:43], a[64:67], a[32:35], v[40:43]
ds_read_b64_tr_b16 a[94:95], v191 offset:12288
v_mfma_f32_16x16x32_bf16 v[44:47], a[72:75], a[32:35], v[44:47]
s_waitcnt lgkmcnt(4)
buffer_load_dwordx4 a[232:235], v15, s[44:47], s65 offen offset:1024 sc1
v_mfma_f32_16x16x32_bf16 v[44:47], a[76:79], a[36:39], v[44:47]
s_add_u32 s65, s84, 8192
ds_read_b64_tr_b16 a[96:97], v184 offset:0
v_mfma_f32_16x16x32_bf16 v[76:79], a[76:79], a[44:47], v[76:79]
buffer_load_dwordx4 a[212:215], v14, s[44:47], s65 offen offset:0 sc1
v_mfma_f32_16x16x32_bf16 v[76:79], a[72:75], a[40:43], v[76:79]
ds_read_b64_tr_b16 a[98:99], v184 offset:4096
v_mfma_f32_16x16x32_bf16 v[108:111], a[72:75], a[48:51], v[108:111]
buffer_load_dwordx4 a[220:223], v14, s[44:47], s65 offen offset:1024 sc1
v_mfma_f32_16x16x32_bf16 v[108:111], a[76:79], a[52:55], v[108:111]
ds_read_b64_tr_b16 a[100:101], v184 offset:8192
v_mfma_f32_16x16x32_bf16 v[140:143], a[76:79], a[60:63], v[140:143]
buffer_load_dwordx4 a[228:231], v15, s[44:47], s65 offen offset:0 sc1
v_mfma_f32_16x16x32_bf16 v[140:143], a[72:75], a[56:59], v[140:143]
ds_read_b64_tr_b16 a[102:103], v184 offset:12288
v_mfma_f32_16x16x32_bf16 v[144:147], a[80:83], a[56:59], v[144:147]
buffer_load_dwordx4 a[236:239], v15, s[44:47], s65 offen offset:1024 sc1
v_mfma_f32_16x16x32_bf16 v[144:147], a[84:87], a[60:63], v[144:147]
s_add_u32 m0, s86, 37888
s_add_u32 s64, s85, 303104
ds_read_b64_tr_b16 a[104:105], v185 offset:0
v_mfma_f32_16x16x32_bf16 v[112:115], a[84:87], a[52:55], v[112:115]
buffer_load_dwordx4 v13, s[40:43], s64 offen lds
v_mfma_f32_16x16x32_bf16 v[112:115], a[80:83], a[48:51], v[112:115]
s_add_u32 m0, s86, 38912
s_add_u32 s64, s85, 311296
ds_read_b64_tr_b16 a[106:107], v185 offset:4096
v_mfma_f32_16x16x32_bf16 v[80:83], a[80:83], a[40:43], v[80:83]
buffer_load_dwordx4 v12, s[40:43], s64 offen lds
v_mfma_f32_16x16x32_bf16 v[80:83], a[84:87], a[44:47], v[80:83]
s_add_u32 m0, s86, 39936
s_add_u32 s64, s85, 319488
ds_read_b64_tr_b16 a[108:109], v185 offset:8192
v_mfma_f32_16x16x32_bf16 v[48:51], a[84:87], a[36:39], v[48:51]
buffer_load_dwordx4 v13, s[40:43], s64 offen lds
v_mfma_f32_16x16x32_bf16 v[48:51], a[80:83], a[32:35], v[48:51]
s_waitcnt lgkmcnt(3)
s_add_u32 s65, s84, 32768
ds_read_b64_tr_b16 a[110:111], v185 offset:12288
v_mfma_f32_16x16x32_bf16 v[52:55], a[88:91], a[32:35], v[52:55]
buffer_load_dwordx4 v[152:155], v14, s[44:47], s65 offen offset:0 sc1
v_mfma_f32_16x16x32_bf16 v[52:55], a[92:95], a[36:39], v[52:55]
ds_read_b64_tr_b16 a[112:113], v186 offset:0
v_mfma_f32_16x16x32_bf16 v[84:87], a[92:95], a[44:47], v[84:87]
buffer_load_dwordx4 v[160:163], v14, s[44:47], s65 offen offset:1024 sc1
v_mfma_f32_16x16x32_bf16 v[84:87], a[88:91], a[40:43], v[84:87]
ds_read_b64_tr_b16 a[114:115], v186 offset:4096
v_mfma_f32_16x16x32_bf16 v[116:119], a[88:91], a[48:51], v[116:119]
buffer_load_dwordx4 v[168:171], v15, s[44:47], s65 offen offset:0 sc1
v_mfma_f32_16x16x32_bf16 v[116:119], a[92:95], a[52:55], v[116:119]
ds_read_b64_tr_b16 a[116:117], v186 offset:8192
v_mfma_f32_16x16x32_bf16 v[148:151], a[92:95], a[60:63], v[148:151]
buffer_load_dwordx4 v[176:179], v15, s[44:47], s65 offen offset:1024 sc1
v_mfma_f32_16x16x32_bf16 v[148:151], a[88:91], a[56:59], v[148:151]
s_add_u32 s65, s84, 40960
ds_read_b64_tr_b16 a[118:119], v186 offset:12288
v_mfma_f32_16x16x32_bf16 v[120:123], a[96:99], a[56:59], v[120:123]
buffer_load_dwordx4 v[156:159], v14, s[44:47], s65 offen offset:0 sc1
v_mfma_f32_16x16x32_bf16 v[120:123], a[100:103], a[60:63], v[120:123]
ds_read_b64_tr_b16 a[120:121], v187 offset:0
v_mfma_f32_16x16x32_bf16 v[88:91], a[100:103], a[52:55], v[88:91]
buffer_load_dwordx4 v[164:167], v14, s[44:47], s65 offen offset:1024 sc1
v_mfma_f32_16x16x32_bf16 v[88:91], a[96:99], a[48:51], v[88:91]
ds_read_b64_tr_b16 a[122:123], v187 offset:4096
v_mfma_f32_16x16x32_bf16 v[56:59], a[96:99], a[40:43], v[56:59]
buffer_load_dwordx4 v[172:175], v15, s[44:47], s65 offen offset:0 sc1
v_mfma_f32_16x16x32_bf16 v[56:59], a[100:103], a[44:47], v[56:59]
ds_read_b64_tr_b16 a[124:125], v187 offset:8192
v_mfma_f32_16x16x32_bf16 v[24:27], a[100:103], a[36:39], v[24:27]
ds_read_b64_tr_b16 a[126:127], v187 offset:12288
v_mfma_f32_16x16x32_bf16 v[24:27], a[96:99], a[32:35], v[24:27]
s_waitcnt lgkmcnt(4)
buffer_load_dwordx4 v[180:183], v15, s[44:47], s65 offen offset:1024 sc1
v_mfma_f32_16x16x32_bf16 v[28:31], a[104:107], a[32:35], v[28:31]
s_barrier
v_mfma_f32_16x16x32_bf16 v[28:31], a[108:111], a[36:39], v[28:31]
ds_read_b64_tr_b16 a[64:65], v188 offset:32768
v_mfma_f32_16x16x32_bf16 v[60:63], a[108:111], a[44:47], v[60:63]
s_add_u32 m0, s86, 65536
ds_read_b64_tr_b16 a[66:67], v188 offset:36864
v_mfma_f32_16x16x32_bf16 v[60:63], a[104:107], a[40:43], v[60:63]
s_add_u32 s64, s85, 524288
ds_read_b64_tr_b16 a[68:69], v188 offset:40960
v_mfma_f32_16x16x32_bf16 v[92:95], a[104:107], a[48:51], v[92:95]
buffer_load_dwordx4 v12, s[40:43], s64 offen lds
v_mfma_f32_16x16x32_bf16 v[92:95], a[108:111], a[52:55], v[92:95]
ds_read_b64_tr_b16 a[70:71], v188 offset:45056
v_mfma_f32_16x16x32_bf16 v[124:127], a[108:111], a[60:63], v[124:127]
s_add_u32 m0, s86, 66560
ds_read_b64_tr_b16 a[72:73], v189 offset:32768
v_mfma_f32_16x16x32_bf16 v[124:127], a[104:107], a[56:59], v[124:127]
s_add_u32 s64, s85, 532480
ds_read_b64_tr_b16 a[74:75], v189 offset:36864
v_mfma_f32_16x16x32_bf16 v[128:131], a[112:115], a[56:59], v[128:131]
buffer_load_dwordx4 v13, s[40:43], s64 offen lds
v_mfma_f32_16x16x32_bf16 v[128:131], a[116:119], a[60:63], v[128:131]
ds_read_b64_tr_b16 a[76:77], v189 offset:40960
v_mfma_f32_16x16x32_bf16 v[96:99], a[116:119], a[52:55], v[96:99]
s_add_u32 m0, s86, 67584
ds_read_b64_tr_b16 a[78:79], v189 offset:45056
v_mfma_f32_16x16x32_bf16 v[96:99], a[112:115], a[48:51], v[96:99]
s_add_u32 s64, s85, 540672
ds_read_b64_tr_b16 a[80:81], v190 offset:32768
v_mfma_f32_16x16x32_bf16 v[64:67], a[112:115], a[40:43], v[64:67]
buffer_load_dwordx4 v12, s[40:43], s64 offen lds
v_mfma_f32_16x16x32_bf16 v[64:67], a[116:119], a[44:47], v[64:67]
ds_read_b64_tr_b16 a[82:83], v190 offset:36864
v_mfma_f32_16x16x32_bf16 v[32:35], a[116:119], a[36:39], v[32:35]
s_add_u32 m0, s86, 68608
ds_read_b64_tr_b16 a[84:85], v190 offset:40960
v_mfma_f32_16x16x32_bf16 v[32:35], a[112:115], a[32:35], v[32:35]
s_waitcnt lgkmcnt(5)
s_add_u32 s64, s85, 548864
ds_read_b64_tr_b16 a[86:87], v190 offset:45056
v_mfma_f32_16x16x32_bf16 v[36:39], a[120:123], a[32:35], v[36:39]
buffer_load_dwordx4 v13, s[40:43], s64 offen lds
v_mfma_f32_16x16x32_bf16 v[36:39], a[124:127], a[36:39], v[36:39]
v_mfma_f32_16x16x32_bf16 v[68:71], a[124:127], a[44:47], v[68:71]
s_add_u32 m0, s86, 69632
v_mfma_f32_16x16x32_bf16 v[68:71], a[120:123], a[40:43], v[68:71]
s_add_u32 s64, s85, 557056
v_mfma_f32_16x16x32_bf16 v[100:103], a[120:123], a[48:51], v[100:103]
buffer_load_dwordx4 v12, s[40:43], s64 offen lds
v_mfma_f32_16x16x32_bf16 v[100:103], a[124:127], a[52:55], v[100:103]
v_mfma_f32_16x16x32_bf16 v[132:135], a[124:127], a[60:63], v[132:135]
v_mfma_f32_16x16x32_bf16 v[132:135], a[120:123], a[56:59], v[132:135]
s_mov_b32 s70, 3
.p2align 3
L_p5_2027:
s_waitcnt lgkmcnt(10)
s_waitcnt vmcnt(20)
v_mfma_f32_16x16x32_bf16 v[136:139], a[64:67], a[232:235], v[136:139]
s_waitcnt vmcnt(16)
s_waitcnt lgkmcnt(8)
s_add_u32 m0, s86, 70656
ds_read_b64_tr_b16 a[88:89], v191 offset:32768
v_mfma_f32_16x16x32_bf16 v[136:139], a[68:71], a[236:239], v[136:139]
s_add_u32 s64, s85, 565248
ds_read_b64_tr_b16 a[90:91], v191 offset:36864
v_mfma_f32_16x16x32_bf16 v[104:107], a[68:71], a[228:231], v[104:107]
buffer_load_dwordx4 v13, s[40:43], s64 offen lds
v_mfma_f32_16x16x32_bf16 v[104:107], a[64:67], a[224:227], v[104:107]
s_add_u32 m0, s86, 71680
ds_read_b64_tr_b16 a[92:93], v191 offset:40960
v_mfma_f32_16x16x32_bf16 v[72:75], a[64:67], a[216:219], v[72:75]
s_add_u32 s64, s85, 573440
ds_read_b64_tr_b16 a[94:95], v191 offset:45056
v_mfma_f32_16x16x32_bf16 v[72:75], a[68:71], a[220:223], v[72:75]
buffer_load_dwordx4 v12, s[40:43], s64 offen lds
v_mfma_f32_16x16x32_bf16 v[40:43], a[68:71], a[212:215], v[40:43]
s_add_u32 m0, s86, 72704
ds_read_b64_tr_b16 a[96:97], v184 offset:32768
v_mfma_f32_16x16x32_bf16 v[40:43], a[64:67], a[208:211], v[40:43]
s_waitcnt lgkmcnt(5)
s_add_u32 s64, s85, 581632
ds_read_b64_tr_b16 a[98:99], v184 offset:36864
v_mfma_f32_16x16x32_bf16 v[44:47], a[72:75], a[208:211], v[44:47]
buffer_load_dwordx4 v13, s[40:43], s64 offen lds
v_mfma_f32_16x16x32_bf16 v[44:47], a[76:79], a[212:215], v[44:47]
ds_read_b64_tr_b16 a[100:101], v184 offset:40960
v_mfma_f32_16x16x32_bf16 v[76:79], a[76:79], a[220:223], v[76:79]
ds_read_b64_tr_b16 a[102:103], v184 offset:45056
v_mfma_f32_16x16x32_bf16 v[76:79], a[72:75], a[216:219], v[76:79]
s_add_u32 s65, s84, 65536
ds_read_b64_tr_b16 a[104:105], v185 offset:32768
v_mfma_f32_16x16x32_bf16 v[108:111], a[72:75], a[224:227], v[108:111]
buffer_load_dwordx4 a[0:3], v14, s[44:47], s65 offen offset:0 sc1
v_mfma_f32_16x16x32_bf16 v[108:111], a[76:79], a[228:231], v[108:111]
ds_read_b64_tr_b16 a[106:107], v185 offset:36864
v_mfma_f32_16x16x32_bf16 v[140:143], a[76:79], a[236:239], v[140:143]
ds_read_b64_tr_b16 a[108:109], v185 offset:40960
v_mfma_f32_16x16x32_bf16 v[140:143], a[72:75], a[232:235], v[140:143]
buffer_load_dwordx4 a[8:11], v14, s[44:47], s65 offen offset:1024 sc1
v_mfma_f32_16x16x32_bf16 v[144:147], a[80:83], a[232:235], v[144:147]
ds_read_b64_tr_b16 a[110:111], v185 offset:45056
v_mfma_f32_16x16x32_bf16 v[144:147], a[84:87], a[236:239], v[144:147]
v_mfma_f32_16x16x32_bf16 v[112:115], a[84:87], a[228:231], v[112:115]
buffer_load_dwordx4 a[16:19], v15, s[44:47], s65 offen offset:0 sc1
v_mfma_f32_16x16x32_bf16 v[112:115], a[80:83], a[224:227], v[112:115]
ds_read_b64_tr_b16 a[112:113], v186 offset:32768
v_mfma_f32_16x16x32_bf16 v[80:83], a[80:83], a[216:219], v[80:83]
ds_read_b64_tr_b16 a[114:115], v186 offset:36864
v_mfma_f32_16x16x32_bf16 v[80:83], a[84:87], a[220:223], v[80:83]
ds_read_b64_tr_b16 a[116:117], v186 offset:40960
v_mfma_f32_16x16x32_bf16 v[48:51], a[84:87], a[212:215], v[48:51]
buffer_load_dwordx4 a[24:27], v15, s[44:47], s65 offen offset:1024 sc1
v_mfma_f32_16x16x32_bf16 v[48:51], a[80:83], a[208:211], v[48:51]
s_waitcnt lgkmcnt(4)
ds_read_b64_tr_b16 a[118:119], v186 offset:45056
v_mfma_f32_16x16x32_bf16 v[52:55], a[88:91], a[208:211], v[52:55]
s_add_u32 s65, s84, 73728
v_mfma_f32_16x16x32_bf16 v[52:55], a[92:95], a[212:215], v[52:55]
buffer_load_dwordx4 a[4:7], v14, s[44:47], s65 offen offset:0 sc1
v_mfma_f32_16x16x32_bf16 v[84:87], a[92:95], a[220:223], v[84:87]
ds_read_b64_tr_b16 a[120:121], v187 offset:32768
v_mfma_f32_16x16x32_bf16 v[84:87], a[88:91], a[216:219], v[84:87]
ds_read_b64_tr_b16 a[122:123], v187 offset:36864
v_mfma_f32_16x16x32_bf16 v[116:119], a[88:91], a[224:227], v[116:119]
buffer_load_dwordx4 a[12:15], v14, s[44:47], s65 offen offset:1024 sc1
v_mfma_f32_16x16x32_bf16 v[116:119], a[92:95], a[228:231], v[116:119]
ds_read_b64_tr_b16 a[124:125], v187 offset:40960
v_mfma_f32_16x16x32_bf16 v[148:151], a[92:95], a[236:239], v[148:151]
ds_read_b64_tr_b16 a[126:127], v187 offset:45056
v_mfma_f32_16x16x32_bf16 v[148:151], a[88:91], a[232:235], v[148:151]
v_mfma_f32_16x16x32_bf16 v[120:123], a[96:99], a[232:235], v[120:123]
buffer_load_dwordx4 a[20:23], v15, s[44:47], s65 offen offset:0 sc1
v_mfma_f32_16x16x32_bf16 v[120:123], a[100:103], a[236:239], v[120:123]
v_mfma_f32_16x16x32_bf16 v[88:91], a[100:103], a[228:231], v[88:91]
v_mfma_f32_16x16x32_bf16 v[88:91], a[96:99], a[224:227], v[88:91]
buffer_load_dwordx4 a[28:31], v15, s[44:47], s65 offen offset:1024 sc1
v_mfma_f32_16x16x32_bf16 v[56:59], a[96:99], a[216:219], v[56:59]
v_mfma_f32_16x16x32_bf16 v[56:59], a[100:103], a[220:223], v[56:59]
v_mfma_f32_16x16x32_bf16 v[24:27], a[100:103], a[212:215], v[24:27]
v_mfma_f32_16x16x32_bf16 v[24:27], a[96:99], a[208:211], v[24:27]
v_mfma_f32_16x16x32_bf16 v[28:31], a[104:107], a[208:211], v[28:31]
s_waitcnt vmcnt(24)
s_barrier
s_waitcnt lgkmcnt(0)
v_mfma_f32_16x16x32_bf16 v[28:31], a[108:111], a[212:215], v[28:31]
ds_read_b64_tr_b16 a[64:65], v196 offset:0
v_mfma_f32_16x16x32_bf16 v[60:63], a[108:111], a[220:223], v[60:63]
s_add_u32 m0, s86, 98304
ds_read_b64_tr_b16 a[66:67], v196 offset:4096
v_mfma_f32_16x16x32_bf16 v[60:63], a[104:107], a[216:219], v[60:63]
s_add_u32 s64, s85, 786432
ds_read_b64_tr_b16 a[68:69], v196 offset:8192
v_mfma_f32_16x16x32_bf16 v[92:95], a[104:107], a[224:227], v[92:95]
buffer_load_dwordx4 v12, s[40:43], s64 offen lds
v_mfma_f32_16x16x32_bf16 v[92:95], a[108:111], a[228:231], v[92:95]
ds_read_b64_tr_b16 a[70:71], v196 offset:12288
v_mfma_f32_16x16x32_bf16 v[124:127], a[108:111], a[236:239], v[124:127]
s_add_u32 m0, s86, 99328
ds_read_b64_tr_b16 a[72:73], v197 offset:0
v_mfma_f32_16x16x32_bf16 v[124:127], a[104:107], a[232:235], v[124:127]
s_add_u32 s64, s85, 794624
ds_read_b64_tr_b16 a[74:75], v197 offset:4096
v_mfma_f32_16x16x32_bf16 v[128:131], a[112:115], a[232:235], v[128:131]
buffer_load_dwordx4 v13, s[40:43], s64 offen lds
v_mfma_f32_16x16x32_bf16 v[128:131], a[116:119], a[236:239], v[128:131]
ds_read_b64_tr_b16 a[76:77], v197 offset:8192
v_mfma_f32_16x16x32_bf16 v[96:99], a[116:119], a[228:231], v[96:99]
s_add_u32 m0, s86, 100352
ds_read_b64_tr_b16 a[78:79], v197 offset:12288
v_mfma_f32_16x16x32_bf16 v[96:99], a[112:115], a[224:227], v[96:99]
s_add_u32 s64, s85, 802816
ds_read_b64_tr_b16 a[80:81], v198 offset:0
v_mfma_f32_16x16x32_bf16 v[64:67], a[112:115], a[216:219], v[64:67]
buffer_load_dwordx4 v12, s[40:43], s64 offen lds
v_mfma_f32_16x16x32_bf16 v[64:67], a[116:119], a[220:223], v[64:67]
ds_read_b64_tr_b16 a[82:83], v198 offset:4096
v_mfma_f32_16x16x32_bf16 v[32:35], a[116:119], a[212:215], v[32:35]
s_add_u32 m0, s86, 101376
ds_read_b64_tr_b16 a[84:85], v198 offset:8192
v_mfma_f32_16x16x32_bf16 v[32:35], a[112:115], a[208:211], v[32:35]
s_add_u32 s64, s85, 811008
ds_read_b64_tr_b16 a[86:87], v198 offset:12288
v_mfma_f32_16x16x32_bf16 v[36:39], a[120:123], a[208:211], v[36:39]
buffer_load_dwordx4 v13, s[40:43], s64 offen lds
v_mfma_f32_16x16x32_bf16 v[36:39], a[124:127], a[212:215], v[36:39]
v_mfma_f32_16x16x32_bf16 v[68:71], a[124:127], a[220:223], v[68:71]
s_add_u32 m0, s86, 102400
v_mfma_f32_16x16x32_bf16 v[68:71], a[120:123], a[216:219], v[68:71]
s_add_u32 s64, s85, 819200
v_mfma_f32_16x16x32_bf16 v[100:103], a[120:123], a[224:227], v[100:103]
buffer_load_dwordx4 v12, s[40:43], s64 offen lds
v_mfma_f32_16x16x32_bf16 v[100:103], a[124:127], a[228:231], v[100:103]
v_mfma_f32_16x16x32_bf16 v[132:135], a[124:127], a[236:239], v[132:135]
v_mfma_f32_16x16x32_bf16 v[132:135], a[120:123], a[232:235], v[132:135]
s_waitcnt vmcnt(25)
s_waitcnt lgkmcnt(0)
v_mfma_f32_16x16x32_bf16 v[136:139], a[64:67], v[176:179], v[136:139]
s_waitcnt vmcnt(21)
s_add_u32 m0, s86, 103424
ds_read_b64_tr_b16 a[88:89], v199 offset:0
v_mfma_f32_16x16x32_bf16 v[136:139], a[68:71], v[180:183], v[136:139]
s_add_u32 s64, s85, 827392
ds_read_b64_tr_b16 a[90:91], v199 offset:4096
v_mfma_f32_16x16x32_bf16 v[104:107], a[68:71], v[172:175], v[104:107]
buffer_load_dwordx4 v13, s[40:43], s64 offen lds
v_mfma_f32_16x16x32_bf16 v[104:107], a[64:67], v[168:171], v[104:107]
s_add_u32 m0, s86, 104448
ds_read_b64_tr_b16 a[92:93], v199 offset:8192
v_mfma_f32_16x16x32_bf16 v[72:75], a[64:67], v[160:163], v[72:75]
s_add_u32 s64, s85, 835584
ds_read_b64_tr_b16 a[94:95], v199 offset:12288
v_mfma_f32_16x16x32_bf16 v[72:75], a[68:71], v[164:167], v[72:75]
buffer_load_dwordx4 v12, s[40:43], s64 offen lds
v_mfma_f32_16x16x32_bf16 v[40:43], a[68:71], v[156:159], v[40:43]
s_add_u32 m0, s86, 105472
ds_read_b64_tr_b16 a[96:97], v192 offset:0
v_mfma_f32_16x16x32_bf16 v[40:43], a[64:67], v[152:155], v[40:43]
s_add_u32 s64, s85, 843776
ds_read_b64_tr_b16 a[98:99], v192 offset:4096
v_mfma_f32_16x16x32_bf16 v[44:47], a[72:75], v[152:155], v[44:47]
buffer_load_dwordx4 v13, s[40:43], s64 offen lds
v_mfma_f32_16x16x32_bf16 v[44:47], a[76:79], v[156:159], v[44:47]
ds_read_b64_tr_b16 a[100:101], v192 offset:8192
v_mfma_f32_16x16x32_bf16 v[76:79], a[76:79], v[164:167], v[76:79]
ds_read_b64_tr_b16 a[102:103], v192 offset:12288
v_mfma_f32_16x16x32_bf16 v[76:79], a[72:75], v[160:163], v[76:79]
s_add_u32 s65, s84, 98304
ds_read_b64_tr_b16 a[104:105], v193 offset:0
v_mfma_f32_16x16x32_bf16 v[108:111], a[72:75], v[168:171], v[108:111]
buffer_load_dwordx4 a[32:35], v14, s[44:47], s65 offen offset:0 sc1
v_mfma_f32_16x16x32_bf16 v[108:111], a[76:79], v[172:175], v[108:111]
ds_read_b64_tr_b16 a[106:107], v193 offset:4096
v_mfma_f32_16x16x32_bf16 v[140:143], a[76:79], v[180:183], v[140:143]
ds_read_b64_tr_b16 a[108:109], v193 offset:8192
v_mfma_f32_16x16x32_bf16 v[140:143], a[72:75], v[176:179], v[140:143]
buffer_load_dwordx4 a[40:43], v14, s[44:47], s65 offen offset:1024 sc1
v_mfma_f32_16x16x32_bf16 v[144:147], a[80:83], v[176:179], v[144:147]
ds_read_b64_tr_b16 a[110:111], v193 offset:12288
v_mfma_f32_16x16x32_bf16 v[144:147], a[84:87], v[180:183], v[144:147]
v_mfma_f32_16x16x32_bf16 v[112:115], a[84:87], v[172:175], v[112:115]
buffer_load_dwordx4 a[48:51], v15, s[44:47], s65 offen offset:0 sc1
v_mfma_f32_16x16x32_bf16 v[112:115], a[80:83], v[168:171], v[112:115]
ds_read_b64_tr_b16 a[112:113], v194 offset:0
v_mfma_f32_16x16x32_bf16 v[80:83], a[80:83], v[160:163], v[80:83]
ds_read_b64_tr_b16 a[114:115], v194 offset:4096
v_mfma_f32_16x16x32_bf16 v[80:83], a[84:87], v[164:167], v[80:83]
ds_read_b64_tr_b16 a[116:117], v194 offset:8192
v_mfma_f32_16x16x32_bf16 v[48:51], a[84:87], v[156:159], v[48:51]
buffer_load_dwordx4 a[56:59], v15, s[44:47], s65 offen offset:1024 sc1
v_mfma_f32_16x16x32_bf16 v[48:51], a[80:83], v[152:155], v[48:51]
s_waitcnt lgkmcnt(4)
ds_read_b64_tr_b16 a[118:119], v194 offset:12288
v_mfma_f32_16x16x32_bf16 v[52:55], a[88:91], v[152:155], v[52:55]
s_add_u32 s65, s84, 106496
v_mfma_f32_16x16x32_bf16 v[52:55], a[92:95], v[156:159], v[52:55]
buffer_load_dwordx4 a[36:39], v14, s[44:47], s65 offen offset:0 sc1
v_mfma_f32_16x16x32_bf16 v[84:87], a[92:95], v[164:167], v[84:87]
ds_read_b64_tr_b16 a[120:121], v195 offset:0
v_mfma_f32_16x16x32_bf16 v[84:87], a[88:91], v[160:163], v[84:87]
ds_read_b64_tr_b16 a[122:123], v195 offset:4096
v_mfma_f32_16x16x32_bf16 v[116:119], a[88:91], v[168:171], v[116:119]
buffer_load_dwordx4 a[44:47], v14, s[44:47], s65 offen offset:1024 sc1
v_mfma_f32_16x16x32_bf16 v[116:119], a[92:95], v[172:175], v[116:119]
ds_read_b64_tr_b16 a[124:125], v195 offset:8192
v_mfma_f32_16x16x32_bf16 v[148:151], a[92:95], v[180:183], v[148:151]
ds_read_b64_tr_b16 a[126:127], v195 offset:12288
v_mfma_f32_16x16x32_bf16 v[148:151], a[88:91], v[176:179], v[148:151]
v_mfma_f32_16x16x32_bf16 v[120:123], a[96:99], v[176:179], v[120:123]
buffer_load_dwordx4 a[52:55], v15, s[44:47], s65 offen offset:0 sc1
v_mfma_f32_16x16x32_bf16 v[120:123], a[100:103], v[180:183], v[120:123]
v_mfma_f32_16x16x32_bf16 v[88:91], a[100:103], v[172:175], v[88:91]
v_mfma_f32_16x16x32_bf16 v[88:91], a[96:99], v[168:171], v[88:91]
buffer_load_dwordx4 a[60:63], v15, s[44:47], s65 offen offset:1024 sc1
v_mfma_f32_16x16x32_bf16 v[56:59], a[96:99], v[160:163], v[56:59]
v_mfma_f32_16x16x32_bf16 v[56:59], a[100:103], v[164:167], v[56:59]
v_mfma_f32_16x16x32_bf16 v[24:27], a[100:103], v[156:159], v[24:27]
v_mfma_f32_16x16x32_bf16 v[24:27], a[96:99], v[152:155], v[24:27]
v_mfma_f32_16x16x32_bf16 v[28:31], a[104:107], v[152:155], v[28:31]
s_waitcnt vmcnt(24)
s_barrier
s_waitcnt lgkmcnt(0)
v_mfma_f32_16x16x32_bf16 v[28:31], a[108:111], v[156:159], v[28:31]
ds_read_b64_tr_b16 a[64:65], v196 offset:32768
v_mfma_f32_16x16x32_bf16 v[60:63], a[108:111], v[164:167], v[60:63]
s_add_u32 m0, s86, 131072
ds_read_b64_tr_b16 a[66:67], v196 offset:36864
v_mfma_f32_16x16x32_bf16 v[60:63], a[104:107], v[160:163], v[60:63]
s_add_u32 s64, s85, 1048576
ds_read_b64_tr_b16 a[68:69], v196 offset:40960
v_mfma_f32_16x16x32_bf16 v[92:95], a[104:107], v[168:171], v[92:95]
buffer_load_dwordx4 v12, s[40:43], s64 offen lds
v_mfma_f32_16x16x32_bf16 v[92:95], a[108:111], v[172:175], v[92:95]
ds_read_b64_tr_b16 a[70:71], v196 offset:45056
v_mfma_f32_16x16x32_bf16 v[124:127], a[108:111], v[180:183], v[124:127]
s_add_u32 m0, s86, 132096
ds_read_b64_tr_b16 a[72:73], v197 offset:32768
v_mfma_f32_16x16x32_bf16 v[124:127], a[104:107], v[176:179], v[124:127]
s_add_u32 s64, s85, 1056768
ds_read_b64_tr_b16 a[74:75], v197 offset:36864
v_mfma_f32_16x16x32_bf16 v[128:131], a[112:115], v[176:179], v[128:131]
buffer_load_dwordx4 v13, s[40:43], s64 offen lds
v_mfma_f32_16x16x32_bf16 v[128:131], a[116:119], v[180:183], v[128:131]
ds_read_b64_tr_b16 a[76:77], v197 offset:40960
v_mfma_f32_16x16x32_bf16 v[96:99], a[116:119], v[172:175], v[96:99]
s_add_u32 m0, s86, 133120
ds_read_b64_tr_b16 a[78:79], v197 offset:45056
v_mfma_f32_16x16x32_bf16 v[96:99], a[112:115], v[168:171], v[96:99]
s_add_u32 s64, s85, 1064960
ds_read_b64_tr_b16 a[80:81], v198 offset:32768
v_mfma_f32_16x16x32_bf16 v[64:67], a[112:115], v[160:163], v[64:67]
buffer_load_dwordx4 v12, s[40:43], s64 offen lds
v_mfma_f32_16x16x32_bf16 v[64:67], a[116:119], v[164:167], v[64:67]
ds_read_b64_tr_b16 a[82:83], v198 offset:36864
v_mfma_f32_16x16x32_bf16 v[32:35], a[116:119], v[156:159], v[32:35]
s_add_u32 m0, s86, 134144
ds_read_b64_tr_b16 a[84:85], v198 offset:40960
v_mfma_f32_16x16x32_bf16 v[32:35], a[112:115], v[152:155], v[32:35]
s_add_u32 s64, s85, 1073152
ds_read_b64_tr_b16 a[86:87], v198 offset:45056
v_mfma_f32_16x16x32_bf16 v[36:39], a[120:123], v[152:155], v[36:39]
buffer_load_dwordx4 v13, s[40:43], s64 offen lds
v_mfma_f32_16x16x32_bf16 v[36:39], a[124:127], v[156:159], v[36:39]
v_mfma_f32_16x16x32_bf16 v[68:71], a[124:127], v[164:167], v[68:71]
s_add_u32 m0, s86, 135168
v_mfma_f32_16x16x32_bf16 v[68:71], a[120:123], v[160:163], v[68:71]
s_add_u32 s64, s85, 1081344
v_mfma_f32_16x16x32_bf16 v[100:103], a[120:123], v[168:171], v[100:103]
buffer_load_dwordx4 v12, s[40:43], s64 offen lds
v_mfma_f32_16x16x32_bf16 v[100:103], a[124:127], v[172:175], v[100:103]
v_mfma_f32_16x16x32_bf16 v[132:135], a[124:127], v[180:183], v[132:135]
v_mfma_f32_16x16x32_bf16 v[132:135], a[120:123], v[176:179], v[132:135]
s_waitcnt vmcnt(25)
s_waitcnt lgkmcnt(0)
v_mfma_f32_16x16x32_bf16 v[136:139], a[64:67], a[24:27], v[136:139]
s_waitcnt vmcnt(21)
s_add_u32 m0, s86, 136192
ds_read_b64_tr_b16 a[88:89], v199 offset:32768
v_mfma_f32_16x16x32_bf16 v[136:139], a[68:71], a[28:31], v[136:139]
s_add_u32 s64, s85, 1089536
ds_read_b64_tr_b16 a[90:91], v199 offset:36864
v_mfma_f32_16x16x32_bf16 v[104:107], a[68:71], a[20:23], v[104:107]
buffer_load_dwordx4 v13, s[40:43], s64 offen lds
v_mfma_f32_16x16x32_bf16 v[104:107], a[64:67], a[16:19], v[104:107]
s_add_u32 m0, s86, 137216
ds_read_b64_tr_b16 a[92:93], v199 offset:40960
v_mfma_f32_16x16x32_bf16 v[72:75], a[64:67], a[8:11], v[72:75]
s_add_u32 s64, s85, 1097728
ds_read_b64_tr_b16 a[94:95], v199 offset:45056
v_mfma_f32_16x16x32_bf16 v[72:75], a[68:71], a[12:15], v[72:75]
buffer_load_dwordx4 v12, s[40:43], s64 offen lds
v_mfma_f32_16x16x32_bf16 v[40:43], a[68:71], a[4:7], v[40:43]
s_add_u32 m0, s86, 138240
ds_read_b64_tr_b16 a[96:97], v192 offset:32768
v_mfma_f32_16x16x32_bf16 v[40:43], a[64:67], a[0:3], v[40:43]
s_add_u32 s64, s85, 1105920
ds_read_b64_tr_b16 a[98:99], v192 offset:36864
v_mfma_f32_16x16x32_bf16 v[44:47], a[72:75], a[0:3], v[44:47]
buffer_load_dwordx4 v13, s[40:43], s64 offen lds
v_mfma_f32_16x16x32_bf16 v[44:47], a[76:79], a[4:7], v[44:47]
ds_read_b64_tr_b16 a[100:101], v192 offset:40960
v_mfma_f32_16x16x32_bf16 v[76:79], a[76:79], a[12:15], v[76:79]
ds_read_b64_tr_b16 a[102:103], v192 offset:45056
v_mfma_f32_16x16x32_bf16 v[76:79], a[72:75], a[8:11], v[76:79]
s_add_u32 s65, s84, 131072
ds_read_b64_tr_b16 a[104:105], v193 offset:32768
v_mfma_f32_16x16x32_bf16 v[108:111], a[72:75], a[16:19], v[108:111]
buffer_load_dwordx4 a[208:211], v14, s[44:47], s65 offen offset:0 sc1
v_mfma_f32_16x16x32_bf16 v[108:111], a[76:79], a[20:23], v[108:111]
ds_read_b64_tr_b16 a[106:107], v193 offset:36864
v_mfma_f32_16x16x32_bf16 v[140:143], a[76:79], a[28:31], v[140:143]
ds_read_b64_tr_b16 a[108:109], v193 offset:40960
v_mfma_f32_16x16x32_bf16 v[140:143], a[72:75], a[24:27], v[140:143]
buffer_load_dwordx4 a[216:219], v14, s[44:47], s65 offen offset:1024 sc1
v_mfma_f32_16x16x32_bf16 v[144:147], a[80:83], a[24:27], v[144:147]
ds_read_b64_tr_b16 a[110:111], v193 offset:45056
v_mfma_f32_16x16x32_bf16 v[144:147], a[84:87], a[28:31], v[144:147]
v_mfma_f32_16x16x32_bf16 v[112:115], a[84:87], a[20:23], v[112:115]
buffer_load_dwordx4 a[224:227], v15, s[44:47], s65 offen offset:0 sc1
v_mfma_f32_16x16x32_bf16 v[112:115], a[80:83], a[16:19], v[112:115]
ds_read_b64_tr_b16 a[112:113], v194 offset:32768
v_mfma_f32_16x16x32_bf16 v[80:83], a[80:83], a[8:11], v[80:83]
ds_read_b64_tr_b16 a[114:115], v194 offset:36864
v_mfma_f32_16x16x32_bf16 v[80:83], a[84:87], a[12:15], v[80:83]
ds_read_b64_tr_b16 a[116:117], v194 offset:40960
v_mfma_f32_16x16x32_bf16 v[48:51], a[84:87], a[4:7], v[48:51]
buffer_load_dwordx4 a[232:235], v15, s[44:47], s65 offen offset:1024 sc1
v_mfma_f32_16x16x32_bf16 v[48:51], a[80:83], a[0:3], v[48:51]
s_waitcnt lgkmcnt(4)
ds_read_b64_tr_b16 a[118:119], v194 offset:45056
v_mfma_f32_16x16x32_bf16 v[52:55], a[88:91], a[0:3], v[52:55]
s_add_u32 s65, s84, 139264
v_mfma_f32_16x16x32_bf16 v[52:55], a[92:95], a[4:7], v[52:55]
buffer_load_dwordx4 a[212:215], v14, s[44:47], s65 offen offset:0 sc1
v_mfma_f32_16x16x32_bf16 v[84:87], a[92:95], a[12:15], v[84:87]
ds_read_b64_tr_b16 a[120:121], v195 offset:32768
v_mfma_f32_16x16x32_bf16 v[84:87], a[88:91], a[8:11], v[84:87]
ds_read_b64_tr_b16 a[122:123], v195 offset:36864
v_mfma_f32_16x16x32_bf16 v[116:119], a[88:91], a[16:19], v[116:119]
buffer_load_dwordx4 a[220:223], v14, s[44:47], s65 offen offset:1024 sc1
v_mfma_f32_16x16x32_bf16 v[116:119], a[92:95], a[20:23], v[116:119]
ds_read_b64_tr_b16 a[124:125], v195 offset:40960
v_mfma_f32_16x16x32_bf16 v[148:151], a[92:95], a[28:31], v[148:151]
ds_read_b64_tr_b16 a[126:127], v195 offset:45056
v_mfma_f32_16x16x32_bf16 v[148:151], a[88:91], a[24:27], v[148:151]
v_mfma_f32_16x16x32_bf16 v[120:123], a[96:99], a[24:27], v[120:123]
buffer_load_dwordx4 a[228:231], v15, s[44:47], s65 offen offset:0 sc1
v_mfma_f32_16x16x32_bf16 v[120:123], a[100:103], a[28:31], v[120:123]
v_mfma_f32_16x16x32_bf16 v[88:91], a[100:103], a[20:23], v[88:91]
v_mfma_f32_16x16x32_bf16 v[88:91], a[96:99], a[16:19], v[88:91]
buffer_load_dwordx4 a[236:239], v15, s[44:47], s65 offen offset:1024 sc1
v_mfma_f32_16x16x32_bf16 v[56:59], a[96:99], a[8:11], v[56:59]
v_mfma_f32_16x16x32_bf16 v[56:59], a[100:103], a[12:15], v[56:59]
v_mfma_f32_16x16x32_bf16 v[24:27], a[100:103], a[4:7], v[24:27]
v_mfma_f32_16x16x32_bf16 v[24:27], a[96:99], a[0:3], v[24:27]
v_mfma_f32_16x16x32_bf16 v[28:31], a[104:107], a[0:3], v[28:31]
s_waitcnt vmcnt(24)
s_barrier
s_waitcnt lgkmcnt(0)
v_mfma_f32_16x16x32_bf16 v[28:31], a[108:111], a[4:7], v[28:31]
ds_read_b64_tr_b16 a[64:65], v188 offset:0
v_mfma_f32_16x16x32_bf16 v[60:63], a[108:111], a[12:15], v[60:63]
s_add_u32 m0, s86, 32768
ds_read_b64_tr_b16 a[66:67], v188 offset:4096
v_mfma_f32_16x16x32_bf16 v[60:63], a[104:107], a[8:11], v[60:63]
s_add_u32 s64, s85, 1310720
ds_read_b64_tr_b16 a[68:69], v188 offset:8192
v_mfma_f32_16x16x32_bf16 v[92:95], a[104:107], a[16:19], v[92:95]
buffer_load_dwordx4 v12, s[40:43], s64 offen lds
v_mfma_f32_16x16x32_bf16 v[92:95], a[108:111], a[20:23], v[92:95]
ds_read_b64_tr_b16 a[70:71], v188 offset:12288
v_mfma_f32_16x16x32_bf16 v[124:127], a[108:111], a[28:31], v[124:127]
s_add_u32 m0, s86, 33792
ds_read_b64_tr_b16 a[72:73], v189 offset:0
v_mfma_f32_16x16x32_bf16 v[124:127], a[104:107], a[24:27], v[124:127]
s_add_u32 s64, s85, 1318912
ds_read_b64_tr_b16 a[74:75], v189 offset:4096
v_mfma_f32_16x16x32_bf16 v[128:131], a[112:115], a[24:27], v[128:131]
buffer_load_dwordx4 v13, s[40:43], s64 offen lds
v_mfma_f32_16x16x32_bf16 v[128:131], a[116:119], a[28:31], v[128:131]
ds_read_b64_tr_b16 a[76:77], v189 offset:8192
v_mfma_f32_16x16x32_bf16 v[96:99], a[116:119], a[20:23], v[96:99]
s_add_u32 m0, s86, 34816
ds_read_b64_tr_b16 a[78:79], v189 offset:12288
v_mfma_f32_16x16x32_bf16 v[96:99], a[112:115], a[16:19], v[96:99]
s_add_u32 s64, s85, 1327104
ds_read_b64_tr_b16 a[80:81], v190 offset:0
v_mfma_f32_16x16x32_bf16 v[64:67], a[112:115], a[8:11], v[64:67]
buffer_load_dwordx4 v12, s[40:43], s64 offen lds
v_mfma_f32_16x16x32_bf16 v[64:67], a[116:119], a[12:15], v[64:67]
ds_read_b64_tr_b16 a[82:83], v190 offset:4096
v_mfma_f32_16x16x32_bf16 v[32:35], a[116:119], a[4:7], v[32:35]
s_add_u32 m0, s86, 35840
ds_read_b64_tr_b16 a[84:85], v190 offset:8192
v_mfma_f32_16x16x32_bf16 v[32:35], a[112:115], a[0:3], v[32:35]
s_add_u32 s64, s85, 1335296
ds_read_b64_tr_b16 a[86:87], v190 offset:12288
v_mfma_f32_16x16x32_bf16 v[36:39], a[120:123], a[0:3], v[36:39]
buffer_load_dwordx4 v13, s[40:43], s64 offen lds
v_mfma_f32_16x16x32_bf16 v[36:39], a[124:127], a[4:7], v[36:39]
v_mfma_f32_16x16x32_bf16 v[68:71], a[124:127], a[12:15], v[68:71]
s_add_u32 m0, s86, 36864
v_mfma_f32_16x16x32_bf16 v[68:71], a[120:123], a[8:11], v[68:71]
s_add_u32 s64, s85, 1343488
v_mfma_f32_16x16x32_bf16 v[100:103], a[120:123], a[16:19], v[100:103]
buffer_load_dwordx4 v12, s[40:43], s64 offen lds
v_mfma_f32_16x16x32_bf16 v[100:103], a[124:127], a[20:23], v[100:103]
v_mfma_f32_16x16x32_bf16 v[132:135], a[124:127], a[28:31], v[132:135]
v_mfma_f32_16x16x32_bf16 v[132:135], a[120:123], a[24:27], v[132:135]
s_waitcnt vmcnt(25)
s_waitcnt lgkmcnt(0)
v_mfma_f32_16x16x32_bf16 v[136:139], a[64:67], a[56:59], v[136:139]
s_waitcnt vmcnt(21)
s_add_u32 m0, s86, 37888
ds_read_b64_tr_b16 a[88:89], v191 offset:0
v_mfma_f32_16x16x32_bf16 v[136:139], a[68:71], a[60:63], v[136:139]
s_add_u32 s64, s85, 1351680
ds_read_b64_tr_b16 a[90:91], v191 offset:4096
v_mfma_f32_16x16x32_bf16 v[104:107], a[68:71], a[52:55], v[104:107]
buffer_load_dwordx4 v13, s[40:43], s64 offen lds
v_mfma_f32_16x16x32_bf16 v[104:107], a[64:67], a[48:51], v[104:107]
s_add_u32 m0, s86, 38912
ds_read_b64_tr_b16 a[92:93], v191 offset:8192
v_mfma_f32_16x16x32_bf16 v[72:75], a[64:67], a[40:43], v[72:75]
s_add_u32 s64, s85, 1359872
ds_read_b64_tr_b16 a[94:95], v191 offset:12288
v_mfma_f32_16x16x32_bf16 v[72:75], a[68:71], a[44:47], v[72:75]
buffer_load_dwordx4 v12, s[40:43], s64 offen lds
v_mfma_f32_16x16x32_bf16 v[40:43], a[68:71], a[36:39], v[40:43]
s_add_u32 m0, s86, 39936
ds_read_b64_tr_b16 a[96:97], v184 offset:0
v_mfma_f32_16x16x32_bf16 v[40:43], a[64:67], a[32:35], v[40:43]
s_add_u32 s64, s85, 1368064
ds_read_b64_tr_b16 a[98:99], v184 offset:4096
v_mfma_f32_16x16x32_bf16 v[44:47], a[72:75], a[32:35], v[44:47]
buffer_load_dwordx4 v13, s[40:43], s64 offen lds
v_mfma_f32_16x16x32_bf16 v[44:47], a[76:79], a[36:39], v[44:47]
ds_read_b64_tr_b16 a[100:101], v184 offset:8192
v_mfma_f32_16x16x32_bf16 v[76:79], a[76:79], a[44:47], v[76:79]
ds_read_b64_tr_b16 a[102:103], v184 offset:12288
v_mfma_f32_16x16x32_bf16 v[76:79], a[72:75], a[40:43], v[76:79]
s_add_u32 s65, s84, 163840
ds_read_b64_tr_b16 a[104:105], v185 offset:0
v_mfma_f32_16x16x32_bf16 v[108:111], a[72:75], a[48:51], v[108:111]
buffer_load_dwordx4 v[152:155], v14, s[44:47], s65 offen offset:0 sc1
v_mfma_f32_16x16x32_bf16 v[108:111], a[76:79], a[52:55], v[108:111]
ds_read_b64_tr_b16 a[106:107], v185 offset:4096
v_mfma_f32_16x16x32_bf16 v[140:143], a[76:79], a[60:63], v[140:143]
ds_read_b64_tr_b16 a[108:109], v185 offset:8192
v_mfma_f32_16x16x32_bf16 v[140:143], a[72:75], a[56:59], v[140:143]
buffer_load_dwordx4 v[160:163], v14, s[44:47], s65 offen offset:1024 sc1
v_mfma_f32_16x16x32_bf16 v[144:147], a[80:83], a[56:59], v[144:147]
ds_read_b64_tr_b16 a[110:111], v185 offset:12288
v_mfma_f32_16x16x32_bf16 v[144:147], a[84:87], a[60:63], v[144:147]
v_mfma_f32_16x16x32_bf16 v[112:115], a[84:87], a[52:55], v[112:115]
buffer_load_dwordx4 v[168:171], v15, s[44:47], s65 offen offset:0 sc1
v_mfma_f32_16x16x32_bf16 v[112:115], a[80:83], a[48:51], v[112:115]
ds_read_b64_tr_b16 a[112:113], v186 offset:0
v_mfma_f32_16x16x32_bf16 v[80:83], a[80:83], a[40:43], v[80:83]
ds_read_b64_tr_b16 a[114:115], v186 offset:4096
v_mfma_f32_16x16x32_bf16 v[80:83], a[84:87], a[44:47], v[80:83]
ds_read_b64_tr_b16 a[116:117], v186 offset:8192
v_mfma_f32_16x16x32_bf16 v[48:51], a[84:87], a[36:39], v[48:51]
buffer_load_dwordx4 v[176:179], v15, s[44:47], s65 offen offset:1024 sc1
v_mfma_f32_16x16x32_bf16 v[48:51], a[80:83], a[32:35], v[48:51]
s_waitcnt lgkmcnt(4)
ds_read_b64_tr_b16 a[118:119], v186 offset:12288
v_mfma_f32_16x16x32_bf16 v[52:55], a[88:91], a[32:35], v[52:55]
s_add_u32 s65, s84, 172032
v_mfma_f32_16x16x32_bf16 v[52:55], a[92:95], a[36:39], v[52:55]
buffer_load_dwordx4 v[156:159], v14, s[44:47], s65 offen offset:0 sc1
v_mfma_f32_16x16x32_bf16 v[84:87], a[92:95], a[44:47], v[84:87]
ds_read_b64_tr_b16 a[120:121], v187 offset:0
v_mfma_f32_16x16x32_bf16 v[84:87], a[88:91], a[40:43], v[84:87]
ds_read_b64_tr_b16 a[122:123], v187 offset:4096
v_mfma_f32_16x16x32_bf16 v[116:119], a[88:91], a[48:51], v[116:119]
buffer_load_dwordx4 v[164:167], v14, s[44:47], s65 offen offset:1024 sc1
v_mfma_f32_16x16x32_bf16 v[116:119], a[92:95], a[52:55], v[116:119]
ds_read_b64_tr_b16 a[124:125], v187 offset:8192
v_mfma_f32_16x16x32_bf16 v[148:151], a[92:95], a[60:63], v[148:151]
ds_read_b64_tr_b16 a[126:127], v187 offset:12288
v_mfma_f32_16x16x32_bf16 v[148:151], a[88:91], a[56:59], v[148:151]
v_mfma_f32_16x16x32_bf16 v[120:123], a[96:99], a[56:59], v[120:123]
buffer_load_dwordx4 v[172:175], v15, s[44:47], s65 offen offset:0 sc1
v_mfma_f32_16x16x32_bf16 v[120:123], a[100:103], a[60:63], v[120:123]
v_mfma_f32_16x16x32_bf16 v[88:91], a[100:103], a[52:55], v[88:91]
v_mfma_f32_16x16x32_bf16 v[88:91], a[96:99], a[48:51], v[88:91]
buffer_load_dwordx4 v[180:183], v15, s[44:47], s65 offen offset:1024 sc1
v_mfma_f32_16x16x32_bf16 v[56:59], a[96:99], a[40:43], v[56:59]
v_mfma_f32_16x16x32_bf16 v[56:59], a[100:103], a[44:47], v[56:59]
v_mfma_f32_16x16x32_bf16 v[24:27], a[100:103], a[36:39], v[24:27]
v_mfma_f32_16x16x32_bf16 v[24:27], a[96:99], a[32:35], v[24:27]
v_mfma_f32_16x16x32_bf16 v[28:31], a[104:107], a[32:35], v[28:31]
s_waitcnt vmcnt(24)
s_barrier
s_waitcnt lgkmcnt(0)
v_mfma_f32_16x16x32_bf16 v[28:31], a[108:111], a[36:39], v[28:31]
ds_read_b64_tr_b16 a[64:65], v188 offset:32768
v_mfma_f32_16x16x32_bf16 v[60:63], a[108:111], a[44:47], v[60:63]
s_add_u32 m0, s86, 65536
ds_read_b64_tr_b16 a[66:67], v188 offset:36864
v_mfma_f32_16x16x32_bf16 v[60:63], a[104:107], a[40:43], v[60:63]
s_add_u32 s64, s85, 1572864
ds_read_b64_tr_b16 a[68:69], v188 offset:40960
v_mfma_f32_16x16x32_bf16 v[92:95], a[104:107], a[48:51], v[92:95]
buffer_load_dwordx4 v12, s[40:43], s64 offen lds
v_mfma_f32_16x16x32_bf16 v[92:95], a[108:111], a[52:55], v[92:95]
ds_read_b64_tr_b16 a[70:71], v188 offset:45056
v_mfma_f32_16x16x32_bf16 v[124:127], a[108:111], a[60:63], v[124:127]
s_add_u32 m0, s86, 66560
ds_read_b64_tr_b16 a[72:73], v189 offset:32768
v_mfma_f32_16x16x32_bf16 v[124:127], a[104:107], a[56:59], v[124:127]
s_add_u32 s64, s85, 1581056
ds_read_b64_tr_b16 a[74:75], v189 offset:36864
v_mfma_f32_16x16x32_bf16 v[128:131], a[112:115], a[56:59], v[128:131]
buffer_load_dwordx4 v13, s[40:43], s64 offen lds
v_mfma_f32_16x16x32_bf16 v[128:131], a[116:119], a[60:63], v[128:131]
ds_read_b64_tr_b16 a[76:77], v189 offset:40960
v_mfma_f32_16x16x32_bf16 v[96:99], a[116:119], a[52:55], v[96:99]
s_add_u32 m0, s86, 67584
ds_read_b64_tr_b16 a[78:79], v189 offset:45056
v_mfma_f32_16x16x32_bf16 v[96:99], a[112:115], a[48:51], v[96:99]
s_add_u32 s64, s85, 1589248
ds_read_b64_tr_b16 a[80:81], v190 offset:32768
v_mfma_f32_16x16x32_bf16 v[64:67], a[112:115], a[40:43], v[64:67]
buffer_load_dwordx4 v12, s[40:43], s64 offen lds
v_mfma_f32_16x16x32_bf16 v[64:67], a[116:119], a[44:47], v[64:67]
ds_read_b64_tr_b16 a[82:83], v190 offset:36864
v_mfma_f32_16x16x32_bf16 v[32:35], a[116:119], a[36:39], v[32:35]
s_add_u32 m0, s86, 68608
ds_read_b64_tr_b16 a[84:85], v190 offset:40960
v_mfma_f32_16x16x32_bf16 v[32:35], a[112:115], a[32:35], v[32:35]
s_add_u32 s64, s85, 1597440
ds_read_b64_tr_b16 a[86:87], v190 offset:45056
v_mfma_f32_16x16x32_bf16 v[36:39], a[120:123], a[32:35], v[36:39]
buffer_load_dwordx4 v13, s[40:43], s64 offen lds
v_mfma_f32_16x16x32_bf16 v[36:39], a[124:127], a[36:39], v[36:39]
v_mfma_f32_16x16x32_bf16 v[68:71], a[124:127], a[44:47], v[68:71]
s_add_u32 m0, s86, 69632
v_mfma_f32_16x16x32_bf16 v[68:71], a[120:123], a[40:43], v[68:71]
s_add_u32 s64, s85, 1605632
v_mfma_f32_16x16x32_bf16 v[100:103], a[120:123], a[48:51], v[100:103]
buffer_load_dwordx4 v12, s[40:43], s64 offen lds
v_mfma_f32_16x16x32_bf16 v[100:103], a[124:127], a[52:55], v[100:103]
s_sub_u32 s70, s70, 1
s_add_u32 s84, s84, 131072
s_add_u32 s85, s85, 1048576
v_mfma_f32_16x16x32_bf16 v[132:135], a[124:127], a[60:63], v[132:135]
s_cmp_lg_u32 s70, 0
v_mfma_f32_16x16x32_bf16 v[132:135], a[120:123], a[56:59], v[132:135]
s_cbranch_scc1 L_p5_2027
s_waitcnt lgkmcnt(10)
s_waitcnt vmcnt(25)
v_mfma_f32_16x16x32_bf16 v[136:139], a[64:67], a[232:235], v[136:139]
s_waitcnt vmcnt(21)
s_waitcnt lgkmcnt(8)
s_add_u32 m0, s86, 70656
ds_read_b64_tr_b16 a[88:89], v191 offset:32768
v_mfma_f32_16x16x32_bf16 v[136:139], a[68:71], a[236:239], v[136:139]
s_add_u32 s64, s85, 565248
ds_read_b64_tr_b16 a[90:91], v191 offset:36864
v_mfma_f32_16x16x32_bf16 v[104:107], a[68:71], a[228:231], v[104:107]
buffer_load_dwordx4 v13, s[40:43], s64 offen lds
v_mfma_f32_16x16x32_bf16 v[104:107], a[64:67], a[224:227], v[104:107]
s_add_u32 m0, s86, 71680
ds_read_b64_tr_b16 a[92:93], v191 offset:40960
v_mfma_f32_16x16x32_bf16 v[72:75], a[64:67], a[216:219], v[72:75]
s_add_u32 s64, s85, 573440
ds_read_b64_tr_b16 a[94:95], v191 offset:45056
v_mfma_f32_16x16x32_bf16 v[72:75], a[68:71], a[220:223], v[72:75]
buffer_load_dwordx4 v12, s[40:43], s64 offen lds
v_mfma_f32_16x16x32_bf16 v[40:43], a[68:71], a[212:215], v[40:43]
s_add_u32 m0, s86, 72704
ds_read_b64_tr_b16 a[96:97], v184 offset:32768
v_mfma_f32_16x16x32_bf16 v[40:43], a[64:67], a[208:211], v[40:43]
s_waitcnt lgkmcnt(5)
s_add_u32 s64, s85, 581632
ds_read_b64_tr_b16 a[98:99], v184 offset:36864
v_mfma_f32_16x16x32_bf16 v[44:47], a[72:75], a[208:211], v[44:47]
buffer_load_dwordx4 v13, s[40:43], s64 offen lds
v_mfma_f32_16x16x32_bf16 v[44:47], a[76:79], a[212:215], v[44:47]
ds_read_b64_tr_b16 a[100:101], v184 offset:40960
v_mfma_f32_16x16x32_bf16 v[76:79], a[76:79], a[220:223], v[76:79]
ds_read_b64_tr_b16 a[102:103], v184 offset:45056
v_mfma_f32_16x16x32_bf16 v[76:79], a[72:75], a[216:219], v[76:79]
s_add_u32 s65, s84, 65536
ds_read_b64_tr_b16 a[104:105], v185 offset:32768
v_mfma_f32_16x16x32_bf16 v[108:111], a[72:75], a[224:227], v[108:111]
buffer_load_dwordx4 a[0:3], v14, s[44:47], s65 offen offset:0 sc1
v_mfma_f32_16x16x32_bf16 v[108:111], a[76:79], a[228:231], v[108:111]
ds_read_b64_tr_b16 a[106:107], v185 offset:36864
v_mfma_f32_16x16x32_bf16 v[140:143], a[76:79], a[236:239], v[140:143]
ds_read_b64_tr_b16 a[108:109], v185 offset:40960
v_mfma_f32_16x16x32_bf16 v[140:143], a[72:75], a[232:235], v[140:143]
buffer_load_dwordx4 a[8:11], v14, s[44:47], s65 offen offset:1024 sc1
v_mfma_f32_16x16x32_bf16 v[144:147], a[80:83], a[232:235], v[144:147]
ds_read_b64_tr_b16 a[110:111], v185 offset:45056
v_mfma_f32_16x16x32_bf16 v[144:147], a[84:87], a[236:239], v[144:147]
v_mfma_f32_16x16x32_bf16 v[112:115], a[84:87], a[228:231], v[112:115]
buffer_load_dwordx4 a[16:19], v15, s[44:47], s65 offen offset:0 sc1
v_mfma_f32_16x16x32_bf16 v[112:115], a[80:83], a[224:227], v[112:115]
ds_read_b64_tr_b16 a[112:113], v186 offset:32768
v_mfma_f32_16x16x32_bf16 v[80:83], a[80:83], a[216:219], v[80:83]
ds_read_b64_tr_b16 a[114:115], v186 offset:36864
v_mfma_f32_16x16x32_bf16 v[80:83], a[84:87], a[220:223], v[80:83]
ds_read_b64_tr_b16 a[116:117], v186 offset:40960
v_mfma_f32_16x16x32_bf16 v[48:51], a[84:87], a[212:215], v[48:51]
buffer_load_dwordx4 a[24:27], v15, s[44:47], s65 offen offset:1024 sc1
v_mfma_f32_16x16x32_bf16 v[48:51], a[80:83], a[208:211], v[48:51]
s_waitcnt lgkmcnt(4)
ds_read_b64_tr_b16 a[118:119], v186 offset:45056
v_mfma_f32_16x16x32_bf16 v[52:55], a[88:91], a[208:211], v[52:55]
s_add_u32 s65, s84, 73728
v_mfma_f32_16x16x32_bf16 v[52:55], a[92:95], a[212:215], v[52:55]
buffer_load_dwordx4 a[4:7], v14, s[44:47], s65 offen offset:0 sc1
v_mfma_f32_16x16x32_bf16 v[84:87], a[92:95], a[220:223], v[84:87]
ds_read_b64_tr_b16 a[120:121], v187 offset:32768
v_mfma_f32_16x16x32_bf16 v[84:87], a[88:91], a[216:219], v[84:87]
ds_read_b64_tr_b16 a[122:123], v187 offset:36864
v_mfma_f32_16x16x32_bf16 v[116:119], a[88:91], a[224:227], v[116:119]
buffer_load_dwordx4 a[12:15], v14, s[44:47], s65 offen offset:1024 sc1
v_mfma_f32_16x16x32_bf16 v[116:119], a[92:95], a[228:231], v[116:119]
ds_read_b64_tr_b16 a[124:125], v187 offset:40960
v_mfma_f32_16x16x32_bf16 v[148:151], a[92:95], a[236:239], v[148:151]
ds_read_b64_tr_b16 a[126:127], v187 offset:45056
v_mfma_f32_16x16x32_bf16 v[148:151], a[88:91], a[232:235], v[148:151]
v_mfma_f32_16x16x32_bf16 v[120:123], a[96:99], a[232:235], v[120:123]
buffer_load_dwordx4 a[20:23], v15, s[44:47], s65 offen offset:0 sc1
v_mfma_f32_16x16x32_bf16 v[120:123], a[100:103], a[236:239], v[120:123]
v_mfma_f32_16x16x32_bf16 v[88:91], a[100:103], a[228:231], v[88:91]
v_mfma_f32_16x16x32_bf16 v[88:91], a[96:99], a[224:227], v[88:91]
buffer_load_dwordx4 a[28:31], v15, s[44:47], s65 offen offset:1024 sc1
v_mfma_f32_16x16x32_bf16 v[56:59], a[96:99], a[216:219], v[56:59]
v_mfma_f32_16x16x32_bf16 v[56:59], a[100:103], a[220:223], v[56:59]
v_mfma_f32_16x16x32_bf16 v[24:27], a[100:103], a[212:215], v[24:27]
v_mfma_f32_16x16x32_bf16 v[24:27], a[96:99], a[208:211], v[24:27]
v_mfma_f32_16x16x32_bf16 v[28:31], a[104:107], a[208:211], v[28:31]
s_waitcnt vmcnt(24)
s_barrier
s_waitcnt lgkmcnt(0)
v_mfma_f32_16x16x32_bf16 v[28:31], a[108:111], a[212:215], v[28:31]
ds_read_b64_tr_b16 a[64:65], v196 offset:0
v_mfma_f32_16x16x32_bf16 v[60:63], a[108:111], a[220:223], v[60:63]
s_add_u32 m0, s86, 98304
ds_read_b64_tr_b16 a[66:67], v196 offset:4096
v_mfma_f32_16x16x32_bf16 v[60:63], a[104:107], a[216:219], v[60:63]
s_add_u32 s64, s85, 786432
ds_read_b64_tr_b16 a[68:69], v196 offset:8192
v_mfma_f32_16x16x32_bf16 v[92:95], a[104:107], a[224:227], v[92:95]
buffer_load_dwordx4 v12, s[40:43], s64 offen lds
v_mfma_f32_16x16x32_bf16 v[92:95], a[108:111], a[228:231], v[92:95]
ds_read_b64_tr_b16 a[70:71], v196 offset:12288
v_mfma_f32_16x16x32_bf16 v[124:127], a[108:111], a[236:239], v[124:127]
s_add_u32 m0, s86, 99328
ds_read_b64_tr_b16 a[72:73], v197 offset:0
v_mfma_f32_16x16x32_bf16 v[124:127], a[104:107], a[232:235], v[124:127]
s_add_u32 s64, s85, 794624
ds_read_b64_tr_b16 a[74:75], v197 offset:4096
v_mfma_f32_16x16x32_bf16 v[128:131], a[112:115], a[232:235], v[128:131]
buffer_load_dwordx4 v13, s[40:43], s64 offen lds
v_mfma_f32_16x16x32_bf16 v[128:131], a[116:119], a[236:239], v[128:131]
ds_read_b64_tr_b16 a[76:77], v197 offset:8192
v_mfma_f32_16x16x32_bf16 v[96:99], a[116:119], a[228:231], v[96:99]
s_add_u32 m0, s86, 100352
ds_read_b64_tr_b16 a[78:79], v197 offset:12288
v_mfma_f32_16x16x32_bf16 v[96:99], a[112:115], a[224:227], v[96:99]
s_add_u32 s64, s85, 802816
ds_read_b64_tr_b16 a[80:81], v198 offset:0
v_mfma_f32_16x16x32_bf16 v[64:67], a[112:115], a[216:219], v[64:67]
buffer_load_dwordx4 v12, s[40:43], s64 offen lds
v_mfma_f32_16x16x32_bf16 v[64:67], a[116:119], a[220:223], v[64:67]
ds_read_b64_tr_b16 a[82:83], v198 offset:4096
v_mfma_f32_16x16x32_bf16 v[32:35], a[116:119], a[212:215], v[32:35]
s_add_u32 m0, s86, 101376
ds_read_b64_tr_b16 a[84:85], v198 offset:8192
v_mfma_f32_16x16x32_bf16 v[32:35], a[112:115], a[208:211], v[32:35]
s_add_u32 s64, s85, 811008
ds_read_b64_tr_b16 a[86:87], v198 offset:12288
v_mfma_f32_16x16x32_bf16 v[36:39], a[120:123], a[208:211], v[36:39]
buffer_load_dwordx4 v13, s[40:43], s64 offen lds
v_mfma_f32_16x16x32_bf16 v[36:39], a[124:127], a[212:215], v[36:39]
v_mfma_f32_16x16x32_bf16 v[68:71], a[124:127], a[220:223], v[68:71]
s_add_u32 m0, s86, 102400
v_mfma_f32_16x16x32_bf16 v[68:71], a[120:123], a[216:219], v[68:71]
s_add_u32 s64, s85, 819200
v_mfma_f32_16x16x32_bf16 v[100:103], a[120:123], a[224:227], v[100:103]
buffer_load_dwordx4 v12, s[40:43], s64 offen lds
v_mfma_f32_16x16x32_bf16 v[100:103], a[124:127], a[228:231], v[100:103]
v_mfma_f32_16x16x32_bf16 v[132:135], a[124:127], a[236:239], v[132:135]
v_mfma_f32_16x16x32_bf16 v[132:135], a[120:123], a[232:235], v[132:135]
s_waitcnt vmcnt(25)
s_waitcnt lgkmcnt(0)
v_mfma_f32_16x16x32_bf16 v[136:139], a[64:67], v[176:179], v[136:139]
s_waitcnt vmcnt(21)
s_add_u32 m0, s86, 103424
ds_read_b64_tr_b16 a[88:89], v199 offset:0
v_mfma_f32_16x16x32_bf16 v[136:139], a[68:71], v[180:183], v[136:139]
s_add_u32 s64, s85, 827392
ds_read_b64_tr_b16 a[90:91], v199 offset:4096
v_mfma_f32_16x16x32_bf16 v[104:107], a[68:71], v[172:175], v[104:107]
buffer_load_dwordx4 v13, s[40:43], s64 offen lds
v_mfma_f32_16x16x32_bf16 v[104:107], a[64:67], v[168:171], v[104:107]
s_add_u32 m0, s86, 104448
ds_read_b64_tr_b16 a[92:93], v199 offset:8192
v_mfma_f32_16x16x32_bf16 v[72:75], a[64:67], v[160:163], v[72:75]
s_add_u32 s64, s85, 835584
ds_read_b64_tr_b16 a[94:95], v199 offset:12288
v_mfma_f32_16x16x32_bf16 v[72:75], a[68:71], v[164:167], v[72:75]
buffer_load_dwordx4 v12, s[40:43], s64 offen lds
v_mfma_f32_16x16x32_bf16 v[40:43], a[68:71], v[156:159], v[40:43]
s_add_u32 m0, s86, 105472
ds_read_b64_tr_b16 a[96:97], v192 offset:0
v_mfma_f32_16x16x32_bf16 v[40:43], a[64:67], v[152:155], v[40:43]
s_add_u32 s64, s85, 843776
ds_read_b64_tr_b16 a[98:99], v192 offset:4096
v_mfma_f32_16x16x32_bf16 v[44:47], a[72:75], v[152:155], v[44:47]
buffer_load_dwordx4 v13, s[40:43], s64 offen lds
v_mfma_f32_16x16x32_bf16 v[44:47], a[76:79], v[156:159], v[44:47]
ds_read_b64_tr_b16 a[100:101], v192 offset:8192
v_mfma_f32_16x16x32_bf16 v[76:79], a[76:79], v[164:167], v[76:79]
ds_read_b64_tr_b16 a[102:103], v192 offset:12288
v_mfma_f32_16x16x32_bf16 v[76:79], a[72:75], v[160:163], v[76:79]
s_add_u32 s65, s84, 98304
ds_read_b64_tr_b16 a[104:105], v193 offset:0
v_mfma_f32_16x16x32_bf16 v[108:111], a[72:75], v[168:171], v[108:111]
buffer_load_dwordx4 a[32:35], v14, s[44:47], s65 offen offset:0 sc1
v_mfma_f32_16x16x32_bf16 v[108:111], a[76:79], v[172:175], v[108:111]
ds_read_b64_tr_b16 a[106:107], v193 offset:4096
v_mfma_f32_16x16x32_bf16 v[140:143], a[76:79], v[180:183], v[140:143]
ds_read_b64_tr_b16 a[108:109], v193 offset:8192
v_mfma_f32_16x16x32_bf16 v[140:143], a[72:75], v[176:179], v[140:143]
buffer_load_dwordx4 a[40:43], v14, s[44:47], s65 offen offset:1024 sc1
v_mfma_f32_16x16x32_bf16 v[144:147], a[80:83], v[176:179], v[144:147]
ds_read_b64_tr_b16 a[110:111], v193 offset:12288
v_mfma_f32_16x16x32_bf16 v[144:147], a[84:87], v[180:183], v[144:147]
v_mfma_f32_16x16x32_bf16 v[112:115], a[84:87], v[172:175], v[112:115]
buffer_load_dwordx4 a[48:51], v15, s[44:47], s65 offen offset:0 sc1
v_mfma_f32_16x16x32_bf16 v[112:115], a[80:83], v[168:171], v[112:115]
ds_read_b64_tr_b16 a[112:113], v194 offset:0
v_mfma_f32_16x16x32_bf16 v[80:83], a[80:83], v[160:163], v[80:83]
ds_read_b64_tr_b16 a[114:115], v194 offset:4096
v_mfma_f32_16x16x32_bf16 v[80:83], a[84:87], v[164:167], v[80:83]
ds_read_b64_tr_b16 a[116:117], v194 offset:8192
v_mfma_f32_16x16x32_bf16 v[48:51], a[84:87], v[156:159], v[48:51]
buffer_load_dwordx4 a[56:59], v15, s[44:47], s65 offen offset:1024 sc1
v_mfma_f32_16x16x32_bf16 v[48:51], a[80:83], v[152:155], v[48:51]
s_waitcnt lgkmcnt(4)
ds_read_b64_tr_b16 a[118:119], v194 offset:12288
v_mfma_f32_16x16x32_bf16 v[52:55], a[88:91], v[152:155], v[52:55]
s_add_u32 s65, s84, 106496
v_mfma_f32_16x16x32_bf16 v[52:55], a[92:95], v[156:159], v[52:55]
buffer_load_dwordx4 a[36:39], v14, s[44:47], s65 offen offset:0 sc1
v_mfma_f32_16x16x32_bf16 v[84:87], a[92:95], v[164:167], v[84:87]
ds_read_b64_tr_b16 a[120:121], v195 offset:0
v_mfma_f32_16x16x32_bf16 v[84:87], a[88:91], v[160:163], v[84:87]
ds_read_b64_tr_b16 a[122:123], v195 offset:4096
v_mfma_f32_16x16x32_bf16 v[116:119], a[88:91], v[168:171], v[116:119]
buffer_load_dwordx4 a[44:47], v14, s[44:47], s65 offen offset:1024 sc1
v_mfma_f32_16x16x32_bf16 v[116:119], a[92:95], v[172:175], v[116:119]
ds_read_b64_tr_b16 a[124:125], v195 offset:8192
v_mfma_f32_16x16x32_bf16 v[148:151], a[92:95], v[180:183], v[148:151]
ds_read_b64_tr_b16 a[126:127], v195 offset:12288
v_mfma_f32_16x16x32_bf16 v[148:151], a[88:91], v[176:179], v[148:151]
v_mfma_f32_16x16x32_bf16 v[120:123], a[96:99], v[176:179], v[120:123]
buffer_load_dwordx4 a[52:55], v15, s[44:47], s65 offen offset:0 sc1
v_mfma_f32_16x16x32_bf16 v[120:123], a[100:103], v[180:183], v[120:123]
v_mfma_f32_16x16x32_bf16 v[88:91], a[100:103], v[172:175], v[88:91]
v_mfma_f32_16x16x32_bf16 v[88:91], a[96:99], v[168:171], v[88:91]
buffer_load_dwordx4 a[60:63], v15, s[44:47], s65 offen offset:1024 sc1
v_mfma_f32_16x16x32_bf16 v[56:59], a[96:99], v[160:163], v[56:59]
v_mfma_f32_16x16x32_bf16 v[56:59], a[100:103], v[164:167], v[56:59]
v_mfma_f32_16x16x32_bf16 v[24:27], a[100:103], v[156:159], v[24:27]
v_mfma_f32_16x16x32_bf16 v[24:27], a[96:99], v[152:155], v[24:27]
v_mfma_f32_16x16x32_bf16 v[28:31], a[104:107], v[152:155], v[28:31]
s_waitcnt vmcnt(24)
s_barrier
s_waitcnt lgkmcnt(0)
v_mfma_f32_16x16x32_bf16 v[28:31], a[108:111], v[156:159], v[28:31]
ds_read_b64_tr_b16 a[64:65], v196 offset:32768
v_mfma_f32_16x16x32_bf16 v[60:63], a[108:111], v[164:167], v[60:63]
ds_read_b64_tr_b16 a[66:67], v196 offset:36864
v_mfma_f32_16x16x32_bf16 v[60:63], a[104:107], v[160:163], v[60:63]
ds_read_b64_tr_b16 a[68:69], v196 offset:40960
v_mfma_f32_16x16x32_bf16 v[92:95], a[104:107], v[168:171], v[92:95]
ds_read_b64_tr_b16 a[70:71], v196 offset:45056
v_mfma_f32_16x16x32_bf16 v[92:95], a[108:111], v[172:175], v[92:95]
ds_read_b64_tr_b16 a[72:73], v197 offset:32768
v_mfma_f32_16x16x32_bf16 v[124:127], a[108:111], v[180:183], v[124:127]
ds_read_b64_tr_b16 a[74:75], v197 offset:36864
v_mfma_f32_16x16x32_bf16 v[124:127], a[104:107], v[176:179], v[124:127]
ds_read_b64_tr_b16 a[76:77], v197 offset:40960
v_mfma_f32_16x16x32_bf16 v[128:131], a[112:115], v[176:179], v[128:131]
ds_read_b64_tr_b16 a[78:79], v197 offset:45056
v_mfma_f32_16x16x32_bf16 v[128:131], a[116:119], v[180:183], v[128:131]
ds_read_b64_tr_b16 a[80:81], v198 offset:32768
v_mfma_f32_16x16x32_bf16 v[96:99], a[116:119], v[172:175], v[96:99]
ds_read_b64_tr_b16 a[82:83], v198 offset:36864
v_mfma_f32_16x16x32_bf16 v[96:99], a[112:115], v[168:171], v[96:99]
ds_read_b64_tr_b16 a[84:85], v198 offset:40960
v_mfma_f32_16x16x32_bf16 v[64:67], a[112:115], v[160:163], v[64:67]
ds_read_b64_tr_b16 a[86:87], v198 offset:45056
v_mfma_f32_16x16x32_bf16 v[64:67], a[116:119], v[164:167], v[64:67]
v_mfma_f32_16x16x32_bf16 v[32:35], a[116:119], v[156:159], v[32:35]
v_mfma_f32_16x16x32_bf16 v[32:35], a[112:115], v[152:155], v[32:35]
v_mfma_f32_16x16x32_bf16 v[36:39], a[120:123], v[152:155], v[36:39]
v_mfma_f32_16x16x32_bf16 v[36:39], a[124:127], v[156:159], v[36:39]
v_mfma_f32_16x16x32_bf16 v[68:71], a[124:127], v[164:167], v[68:71]
v_mfma_f32_16x16x32_bf16 v[68:71], a[120:123], v[160:163], v[68:71]
v_mfma_f32_16x16x32_bf16 v[100:103], a[120:123], v[168:171], v[100:103]
v_mfma_f32_16x16x32_bf16 v[100:103], a[124:127], v[172:175], v[100:103]
v_mfma_f32_16x16x32_bf16 v[132:135], a[124:127], v[180:183], v[132:135]
v_mfma_f32_16x16x32_bf16 v[132:135], a[120:123], v[176:179], v[132:135]
s_waitcnt vmcnt(20)
s_waitcnt lgkmcnt(0)
v_mfma_f32_16x16x32_bf16 v[136:139], a[64:67], a[24:27], v[136:139]
s_waitcnt vmcnt(16)
ds_read_b64_tr_b16 a[88:89], v199 offset:32768
v_mfma_f32_16x16x32_bf16 v[136:139], a[68:71], a[28:31], v[136:139]
ds_read_b64_tr_b16 a[90:91], v199 offset:36864
v_mfma_f32_16x16x32_bf16 v[104:107], a[68:71], a[20:23], v[104:107]
s_xor_b32 s66, s2, 4
ds_read_b64_tr_b16 a[92:93], v199 offset:40960
v_mfma_f32_16x16x32_bf16 v[104:107], a[64:67], a[16:19], v[104:107]
s_lshl2_add_u32 s66, s66, s30
ds_read_b64_tr_b16 a[94:95], v199 offset:45056
v_mfma_f32_16x16x32_bf16 v[72:75], a[64:67], a[8:11], v[72:75]
s_lshl_b32 s73, s66, 13
ds_read_b64_tr_b16 a[96:97], v192 offset:32768
v_mfma_f32_16x16x32_bf16 v[72:75], a[68:71], a[12:15], v[72:75]
s_add_u32 s73, s73, 67108864
ds_read_b64_tr_b16 a[98:99], v192 offset:36864
v_mfma_f32_16x16x32_bf16 v[40:43], a[68:71], a[4:7], v[40:43]
s_add_u32 s74, s73, 4096
ds_read_b64_tr_b16 a[100:101], v192 offset:40960
v_mfma_f32_16x16x32_bf16 v[40:43], a[64:67], a[0:3], v[40:43]
s_lshl_b32 s71, s66, 6
ds_read_b64_tr_b16 a[102:103], v192 offset:45056
v_mfma_f32_16x16x32_bf16 v[44:47], a[72:75], a[0:3], v[44:47]
s_lshl2_add_u32 s66, s2, s30
s_lshl_b32 s72, s66, 6
s_lshl_b32 s75, s66, 13
v_mfma_f32_16x16x32_bf16 v[44:47], a[76:79], a[4:7], v[44:47]
s_add_u32 s75, s75, 67108864
s_add_u32 s76, s75, 4096
s_lshl_b32 s77, s82, 18
v_mfma_f32_16x16x32_bf16 v[76:79], a[76:79], a[12:15], v[76:79]
s_lshl_b32 s66, s30, 16
ds_read_b64_tr_b16 a[104:105], v193 offset:32768
v_mfma_f32_16x16x32_bf16 v[76:79], a[72:75], a[8:11], v[76:79]
s_add_u32 s77, s77, s66
ds_read_b64_tr_b16 a[106:107], v193 offset:36864
v_mfma_f32_16x16x32_bf16 v[108:111], a[72:75], a[16:19], v[108:111]
s_add_u32 s77, s77, s87
ds_read_b64_tr_b16 a[108:109], v193 offset:40960
v_mfma_f32_16x16x32_bf16 v[108:111], a[76:79], a[20:23], v[108:111]
s_lshl_b32 s66, s83, 7
ds_read_b64_tr_b16 a[110:111], v193 offset:45056
v_mfma_f32_16x16x32_bf16 v[140:143], a[76:79], a[28:31], v[140:143]
s_add_u32 s77, s77, s66
s_add_u32 s78, s77, 32768
v_mfma_f32_16x16x32_bf16 v[140:143], a[72:75], a[24:27], v[140:143]
v_lshlrev_b32 v1, 24, v0
v_and_b32 v8, 15, v0
v_mfma_f32_16x16x32_bf16 v[144:147], a[80:83], a[24:27], v[144:147]
v_lshlrev_b32 v8, 11, v8
v_bfe_u32 v10, v0, 4, 1
v_mfma_f32_16x16x32_bf16 v[144:147], a[84:87], a[28:31], v[144:147]
v_lshl_add_u32 v8, v10, 5, v8
v_lshrrev_b32 v10, 5, v0
v_mfma_f32_16x16x32_bf16 v[112:115], a[84:87], a[20:23], v[112:115]
ds_read_b64_tr_b16 a[112:113], v194 offset:32768
v_lshl_add_u32 v8, v10, 4, v8
v_mfma_f32_16x16x32_bf16 v[112:115], a[80:83], a[16:19], v[112:115]
ds_read_b64_tr_b16 a[114:115], v194 offset:36864
v_add_u32 v2, s86, v16
v_mfma_f32_16x16x32_bf16 v[80:83], a[80:83], a[8:11], v[80:83]
ds_read_b64_tr_b16 a[116:117], v194 offset:40960
v_xor_b32 v3, 0x2000, v2
v_mfma_f32_16x16x32_bf16 v[80:83], a[84:87], a[12:15], v[80:83]
ds_read_b64_tr_b16 a[118:119], v194 offset:45056
v_mfma_f32_16x16x32_bf16 v[48:51], a[84:87], a[4:7], v[48:51]
s_add_u32 s52, s28, 59834368
s_addc_u32 s53, s29, 0
s_mov_b32 s54, 65536
v_mfma_f32_16x16x32_bf16 v[48:51], a[80:83], a[0:3], v[48:51]
s_waitcnt lgkmcnt(4)
s_mov_b32 s48, s24
s_mov_b32 s49, s25
s_mov_b32 s50, 4194304
v_mfma_f32_16x16x32_bf16 v[52:55], a[88:91], a[0:3], v[52:55]
s_mov_b32 s51, 0x20000
v_mfma_f32_16x16x32_bf16 v[52:55], a[92:95], a[4:7], v[52:55]
v_mfma_f32_16x16x32_bf16 v[84:87], a[92:95], a[12:15], v[84:87]
ds_read_b64_tr_b16 a[120:121], v195 offset:32768
v_mfma_f32_16x16x32_bf16 v[84:87], a[88:91], a[8:11], v[84:87]
ds_read_b64_tr_b16 a[122:123], v195 offset:36864
v_mfma_f32_16x16x32_bf16 v[116:119], a[88:91], a[16:19], v[116:119]
ds_read_b64_tr_b16 a[124:125], v195 offset:40960
v_mfma_f32_16x16x32_bf16 v[116:119], a[92:95], a[20:23], v[116:119]
ds_read_b64_tr_b16 a[126:127], v195 offset:45056
v_mfma_f32_16x16x32_bf16 v[148:151], a[92:95], a[28:31], v[148:151]
v_mfma_f32_16x16x32_bf16 v[148:151], a[88:91], a[24:27], v[148:151]
v_mfma_f32_16x16x32_bf16 v[120:123], a[96:99], a[24:27], v[120:123]
v_mfma_f32_16x16x32_bf16 v[120:123], a[100:103], a[28:31], v[120:123]
v_mfma_f32_16x16x32_bf16 v[88:91], a[100:103], a[20:23], v[88:91]
v_mfma_f32_16x16x32_bf16 v[88:91], a[96:99], a[16:19], v[88:91]
v_mfma_f32_16x16x32_bf16 v[56:59], a[96:99], a[8:11], v[56:59]
v_mfma_f32_16x16x32_bf16 v[56:59], a[100:103], a[12:15], v[56:59]
v_mfma_f32_16x16x32_bf16 v[24:27], a[100:103], a[4:7], v[24:27]
v_mfma_f32_16x16x32_bf16 v[24:27], a[96:99], a[0:3], v[24:27]
v_mfma_f32_16x16x32_bf16 v[28:31], a[104:107], a[0:3], v[28:31]
s_waitcnt vmcnt(8)
s_barrier
v_mfma_f32_16x16x32_bf16 v[28:31], a[108:111], a[4:7], v[28:31]
ds_read_b64_tr_b16 a[64:65], v188 offset:0
v_mfma_f32_16x16x32_bf16 v[60:63], a[108:111], a[12:15], v[60:63]
ds_read_b64_tr_b16 a[66:67], v188 offset:4096
v_mfma_f32_16x16x32_bf16 v[60:63], a[104:107], a[8:11], v[60:63]
ds_read_b64_tr_b16 a[68:69], v188 offset:8192
v_mfma_f32_16x16x32_bf16 v[92:95], a[104:107], a[16:19], v[92:95]
ds_read_b64_tr_b16 a[70:71], v188 offset:12288
v_mfma_f32_16x16x32_bf16 v[92:95], a[108:111], a[20:23], v[92:95]
ds_read_b64_tr_b16 a[72:73], v189 offset:0
v_mfma_f32_16x16x32_bf16 v[124:127], a[108:111], a[28:31], v[124:127]
ds_read_b64_tr_b16 a[74:75], v189 offset:4096
v_mfma_f32_16x16x32_bf16 v[124:127], a[104:107], a[24:27], v[124:127]
s_waitcnt lgkmcnt(6)
ds_read_b64_tr_b16 a[76:77], v189 offset:8192
v_mfma_f32_16x16x32_bf16 v[128:131], a[112:115], a[24:27], v[128:131]
ds_read_b64_tr_b16 a[78:79], v189 offset:12288
v_mfma_f32_16x16x32_bf16 v[128:131], a[116:119], a[28:31], v[128:131]
ds_read_b64_tr_b16 a[80:81], v190 offset:0
v_mfma_f32_16x16x32_bf16 v[96:99], a[116:119], a[20:23], v[96:99]
ds_read_b64_tr_b16 a[82:83], v190 offset:4096
v_mfma_f32_16x16x32_bf16 v[96:99], a[112:115], a[16:19], v[96:99]
ds_read_b64_tr_b16 a[84:85], v190 offset:8192
v_mfma_f32_16x16x32_bf16 v[64:67], a[112:115], a[8:11], v[64:67]
ds_read_b64_tr_b16 a[86:87], v190 offset:12288
v_mfma_f32_16x16x32_bf16 v[64:67], a[116:119], a[12:15], v[64:67]
v_mfma_f32_16x16x32_bf16 v[32:35], a[116:119], a[4:7], v[32:35]
v_mfma_f32_16x16x32_bf16 v[32:35], a[112:115], a[0:3], v[32:35]
v_mfma_f32_16x16x32_bf16 v[36:39], a[120:123], a[0:3], v[36:39]
v_mfma_f32_16x16x32_bf16 v[36:39], a[124:127], a[4:7], v[36:39]
v_mfma_f32_16x16x32_bf16 v[68:71], a[124:127], a[12:15], v[68:71]
v_mfma_f32_16x16x32_bf16 v[68:71], a[120:123], a[8:11], v[68:71]
v_mfma_f32_16x16x32_bf16 v[100:103], a[120:123], a[16:19], v[100:103]
v_mfma_f32_16x16x32_bf16 v[100:103], a[124:127], a[20:23], v[100:103]
v_mfma_f32_16x16x32_bf16 v[132:135], a[124:127], a[28:31], v[132:135]
v_mfma_f32_16x16x32_bf16 v[132:135], a[120:123], a[24:27], v[132:135]
s_waitcnt vmcnt(4)
s_waitcnt lgkmcnt(0)
v_mfma_f32_16x16x32_bf16 v[136:139], a[64:67], a[56:59], v[136:139]
s_waitcnt vmcnt(0)
ds_read_b64_tr_b16 a[88:89], v191 offset:0
v_mfma_f32_16x16x32_bf16 v[136:139], a[68:71], a[60:63], v[136:139]
ds_read_b64_tr_b16 a[90:91], v191 offset:4096
v_mfma_f32_16x16x32_bf16 v[104:107], a[68:71], a[52:55], v[104:107]
ds_read_b64_tr_b16 a[92:93], v191 offset:8192
v_mfma_f32_16x16x32_bf16 v[104:107], a[64:67], a[48:51], v[104:107]
ds_read_b64_tr_b16 a[94:95], v191 offset:12288
v_mfma_f32_16x16x32_bf16 v[72:75], a[64:67], a[40:43], v[72:75]
ds_read_b64_tr_b16 a[96:97], v184 offset:0
v_mfma_f32_16x16x32_bf16 v[72:75], a[68:71], a[44:47], v[72:75]
ds_read_b64_tr_b16 a[98:99], v184 offset:4096
v_mfma_f32_16x16x32_bf16 v[40:43], a[68:71], a[36:39], v[40:43]
ds_read_b64_tr_b16 a[100:101], v184 offset:8192
v_mfma_f32_16x16x32_bf16 v[40:43], a[64:67], a[32:35], v[40:43]
ds_read_b64_tr_b16 a[102:103], v184 offset:12288
v_mfma_f32_16x16x32_bf16 v[44:47], a[72:75], a[32:35], v[44:47]
v_mfma_f32_16x16x32_bf16 v[44:47], a[76:79], a[36:39], v[44:47]
v_mfma_f32_16x16x32_bf16 v[76:79], a[76:79], a[44:47], v[76:79]
ds_read_b64_tr_b16 a[104:105], v185 offset:0
v_mfma_f32_16x16x32_bf16 v[76:79], a[72:75], a[40:43], v[76:79]
ds_read_b64_tr_b16 a[106:107], v185 offset:4096
v_mfma_f32_16x16x32_bf16 v[108:111], a[72:75], a[48:51], v[108:111]
ds_read_b64_tr_b16 a[108:109], v185 offset:8192
v_mfma_f32_16x16x32_bf16 v[108:111], a[76:79], a[52:55], v[108:111]
ds_read_b64_tr_b16 a[110:111], v185 offset:12288
v_mfma_f32_16x16x32_bf16 v[140:143], a[76:79], a[60:63], v[140:143]
ds_write_b128 v3, v[104:107] offset:0
v_mfma_f32_16x16x32_bf16 v[140:143], a[72:75], a[56:59], v[140:143]
ds_write_b128 v3, v[136:139] offset:4096
v_mfma_f32_16x16x32_bf16 v[144:147], a[80:83], a[56:59], v[144:147]
v_mfma_f32_16x16x32_bf16 v[144:147], a[84:87], a[60:63], v[144:147]
v_mfma_f32_16x16x32_bf16 v[112:115], a[84:87], a[52:55], v[112:115]
ds_read_b64_tr_b16 a[112:113], v186 offset:0
v_mfma_f32_16x16x32_bf16 v[112:115], a[80:83], a[48:51], v[112:115]
ds_read_b64_tr_b16 a[114:115], v186 offset:4096
v_mfma_f32_16x16x32_bf16 v[80:83], a[80:83], a[40:43], v[80:83]
ds_read_b64_tr_b16 a[116:117], v186 offset:8192
v_mfma_f32_16x16x32_bf16 v[80:83], a[84:87], a[44:47], v[80:83]
ds_read_b64_tr_b16 a[118:119], v186 offset:12288
v_mfma_f32_16x16x32_bf16 v[48:51], a[84:87], a[36:39], v[48:51]
ds_write_b128 v3, v[108:111] offset:1024
v_mfma_f32_16x16x32_bf16 v[48:51], a[80:83], a[32:35], v[48:51]
s_waitcnt lgkmcnt(5)
ds_write_b128 v3, v[140:143] offset:5120
v_mfma_f32_16x16x32_bf16 v[52:55], a[88:91], a[32:35], v[52:55]
v_mfma_f32_16x16x32_bf16 v[52:55], a[92:95], a[36:39], v[52:55]
v_mfma_f32_16x16x32_bf16 v[84:87], a[92:95], a[44:47], v[84:87]
ds_read_b64_tr_b16 a[120:121], v187 offset:0
v_mfma_f32_16x16x32_bf16 v[84:87], a[88:91], a[40:43], v[84:87]
ds_read_b64_tr_b16 a[122:123], v187 offset:4096
v_mfma_f32_16x16x32_bf16 v[116:119], a[88:91], a[48:51], v[116:119]
ds_read_b64_tr_b16 a[124:125], v187 offset:8192
v_mfma_f32_16x16x32_bf16 v[116:119], a[92:95], a[52:55], v[116:119]
ds_read_b64_tr_b16 a[126:127], v187 offset:12288
v_mfma_f32_16x16x32_bf16 v[148:151], a[92:95], a[60:63], v[148:151]
ds_write_b128 v3, v[112:115] offset:2048
v_mfma_f32_16x16x32_bf16 v[148:151], a[88:91], a[56:59], v[148:151]
ds_write_b128 v3, v[144:147] offset:6144
v_mfma_f32_16x16x32_bf16 v[120:123], a[96:99], a[56:59], v[120:123]
v_mfma_f32_16x16x32_bf16 v[120:123], a[100:103], a[60:63], v[120:123]
v_mfma_f32_16x16x32_bf16 v[88:91], a[100:103], a[52:55], v[88:91]
v_mfma_f32_16x16x32_bf16 v[88:91], a[96:99], a[48:51], v[88:91]
v_mfma_f32_16x16x32_bf16 v[56:59], a[96:99], a[40:43], v[56:59]
v_mfma_f32_16x16x32_bf16 v[56:59], a[100:103], a[44:47], v[56:59]
ds_write_b128 v3, v[116:119] offset:3072
v_mfma_f32_16x16x32_bf16 v[24:27], a[100:103], a[36:39], v[24:27]
v_mfma_f32_16x16x32_bf16 v[24:27], a[96:99], a[32:35], v[24:27]
ds_write_b128 v3, v[148:151] offset:7168
v_mfma_f32_16x16x32_bf16 v[28:31], a[104:107], a[32:35], v[28:31]
v_mfma_f32_16x16x32_bf16 v[28:31], a[108:111], a[36:39], v[28:31]
v_mfma_f32_16x16x32_bf16 v[60:63], a[108:111], a[44:47], v[60:63]
s_waitcnt lgkmcnt(0)
s_barrier
v_mfma_f32_16x16x32_bf16 v[60:63], a[104:107], a[40:43], v[60:63]
ds_read_b128 v[200:203], v2 offset:0
v_mfma_f32_16x16x32_bf16 v[92:95], a[104:107], a[48:51], v[92:95]
ds_read_b128 v[204:207], v2 offset:1024
v_mfma_f32_16x16x32_bf16 v[92:95], a[108:111], a[52:55], v[92:95]
ds_read_b128 v[208:211], v2 offset:2048
v_mfma_f32_16x16x32_bf16 v[124:127], a[108:111], a[60:63], v[124:127]
ds_read_b128 v[212:215], v2 offset:3072
v_mfma_f32_16x16x32_bf16 v[124:127], a[104:107], a[56:59], v[124:127]
ds_read_b128 v[216:219], v2 offset:4096
v_mfma_f32_16x16x32_bf16 v[128:131], a[112:115], a[56:59], v[128:131]
ds_read_b128 v[220:223], v2 offset:5120
v_mfma_f32_16x16x32_bf16 v[128:131], a[116:119], a[60:63], v[128:131]
ds_read_b128 v[224:227], v2 offset:6144
v_mfma_f32_16x16x32_bf16 v[96:99], a[116:119], a[52:55], v[96:99]
s_waitcnt lgkmcnt(6)
ds_read_b128 v[228:231], v2 offset:7168
v_add_f32 v200, v200, v40
v_mfma_f32_16x16x32_bf16 v[96:99], a[112:115], a[48:51], v[96:99]
v_add_f32 v201, v201, v41
v_add_f32 v202, v202, v42
v_mfma_f32_16x16x32_bf16 v[64:67], a[112:115], a[40:43], v[64:67]
v_add_f32 v203, v203, v43
v_mfma_f32_16x16x32_bf16 v[64:67], a[116:119], a[44:47], v[64:67]
buffer_store_dwordx4 v[200:203], v16, s[44:47], s73 offen offset:0 sc1
v_mfma_f32_16x16x32_bf16 v[32:35], a[116:119], a[36:39], v[32:35]
s_waitcnt lgkmcnt(4)
v_add_f32 v204, v204, v44
v_add_f32 v205, v205, v45
v_mfma_f32_16x16x32_bf16 v[32:35], a[112:115], a[32:35], v[32:35]
v_add_f32 v206, v206, v46
v_add_f32 v207, v207, v47
v_mfma_f32_16x16x32_bf16 v[36:39], a[120:123], a[32:35], v[36:39]
buffer_store_dwordx4 v[204:207], v16, s[44:47], s73 offen offset:1024 sc1
v_mfma_f32_16x16x32_bf16 v[36:39], a[124:127], a[36:39], v[36:39]
v_add_f32 v208, v208, v48
v_add_f32 v209, v209, v49
v_mfma_f32_16x16x32_bf16 v[68:71], a[124:127], a[44:47], v[68:71]
v_add_f32 v210, v210, v50
v_add_f32 v211, v211, v51
v_mfma_f32_16x16x32_bf16 v[68:71], a[120:123], a[40:43], v[68:71]
buffer_store_dwordx4 v[208:211], v16, s[44:47], s73 offen offset:2048 sc1
v_mfma_f32_16x16x32_bf16 v[100:103], a[120:123], a[48:51], v[100:103]
v_add_f32 v212, v212, v52
v_add_f32 v213, v213, v53
v_mfma_f32_16x16x32_bf16 v[100:103], a[124:127], a[52:55], v[100:103]
v_add_f32 v214, v214, v54
v_add_f32 v215, v215, v55
v_mfma_f32_16x16x32_bf16 v[132:135], a[124:127], a[60:63], v[132:135]
buffer_store_dwordx4 v[212:215], v16, s[44:47], s73 offen offset:3072 sc1
v_mfma_f32_16x16x32_bf16 v[132:135], a[120:123], a[56:59], v[132:135]
s_waitcnt lgkmcnt(0)
v_add_f32 v216, v216, v72
v_add_f32 v217, v217, v73
v_add_f32 v218, v218, v74
v_add_f32 v219, v219, v75
buffer_store_dwordx4 v[216:219], v16, s[44:47], s74 offen offset:0 sc1
v_add_f32 v220, v220, v76
v_add_f32 v221, v221, v77
v_add_f32 v222, v222, v78
v_add_f32 v223, v223, v79
buffer_store_dwordx4 v[220:223], v16, s[44:47], s74 offen offset:1024 sc1
v_add_f32 v224, v224, v80
v_add_f32 v225, v225, v81
v_add_f32 v226, v226, v82
v_add_f32 v227, v227, v83
buffer_store_dwordx4 v[224:227], v16, s[44:47], s74 offen offset:2048 sc1
v_add_f32 v228, v228, v84
v_add_f32 v229, v229, v85
v_add_f32 v230, v230, v86
v_add_f32 v231, v231, v87
buffer_store_dwordx4 v[228:231], v16, s[44:47], s74 offen offset:3072 sc1
s_nop 4
ds_write_b128 v3, v[88:91] offset:32768
ds_write_b128 v3, v[120:123] offset:36864
ds_write_b128 v3, v[92:95] offset:33792
ds_write_b128 v3, v[124:127] offset:37888
ds_write_b128 v3, v[96:99] offset:34816
ds_write_b128 v3, v[128:131] offset:38912
ds_write_b128 v3, v[100:103] offset:35840
ds_write_b128 v3, v[132:135] offset:39936
s_waitcnt lgkmcnt(0)
s_barrier
ds_read_b128 v[88:91], v2 offset:32768
ds_read_b128 v[92:95], v2 offset:33792
ds_read_b128 v[96:99], v2 offset:34816
ds_read_b128 v[100:103], v2 offset:35840
ds_read_b128 v[120:123], v2 offset:36864
ds_read_b128 v[124:127], v2 offset:37888
ds_read_b128 v[128:131], v2 offset:38912
ds_read_b128 v[132:135], v2 offset:39936
s_waitcnt vmcnt(0)
buffer_store_dword a251, v1, s[52:55], s71 offen sc1
buffer_load_dword v19, off, s[52:55], s72 sc1
s_waitcnt lgkmcnt(7)
v_add_f32 v24, v24, v88
v_add_f32 v25, v25, v89
v_add_f32 v26, v26, v90
v_add_f32 v27, v27, v91
s_waitcnt lgkmcnt(6)
v_add_f32 v28, v28, v92
v_add_f32 v29, v29, v93
v_add_f32 v30, v30, v94
v_add_f32 v31, v31, v95
s_waitcnt lgkmcnt(5)
v_add_f32 v32, v32, v96
v_add_f32 v33, v33, v97
v_add_f32 v34, v34, v98
v_add_f32 v35, v35, v99
s_waitcnt lgkmcnt(4)
v_add_f32 v36, v36, v100
v_add_f32 v37, v37, v101
v_add_f32 v38, v38, v102
v_add_f32 v39, v39, v103
s_waitcnt lgkmcnt(3)
v_add_f32 v56, v56, v120
v_add_f32 v57, v57, v121
v_add_f32 v58, v58, v122
v_add_f32 v59, v59, v123
s_waitcnt lgkmcnt(2)
v_add_f32 v60, v60, v124
v_add_f32 v61, v61, v125
v_add_f32 v62, v62, v126
v_add_f32 v63, v63, v127
s_waitcnt lgkmcnt(1)
v_add_f32 v64, v64, v128
v_add_f32 v65, v65, v129
v_add_f32 v66, v66, v130
v_add_f32 v67, v67, v131
s_waitcnt lgkmcnt(0)
v_add_f32 v68, v68, v132
v_add_f32 v69, v69, v133
v_add_f32 v70, v70, v134
v_add_f32 v71, v71, v135
s_waitcnt vmcnt(0)
v_readfirstlane_b32 s66, v19
s_nop 0
s_cmp_lt_u32 s66, 1
s_cbranch_scc1 L_spin_2028
L_spinbk_2029:
buffer_load_dwordx4 v[40:43], v16, s[44:47], s75 offen offset:0 sc1
buffer_load_dwordx4 v[44:47], v16, s[44:47], s75 offen offset:1024 sc1
buffer_load_dwordx4 v[48:51], v16, s[44:47], s75 offen offset:2048 sc1
buffer_load_dwordx4 v[52:55], v16, s[44:47], s75 offen offset:3072 sc1
buffer_load_dwordx4 v[72:75], v16, s[44:47], s76 offen offset:0 sc1
buffer_load_dwordx4 v[76:79], v16, s[44:47], s76 offen offset:1024 sc1
buffer_load_dwordx4 v[80:83], v16, s[44:47], s76 offen offset:2048 sc1
buffer_load_dwordx4 v[84:87], v16, s[44:47], s76 offen offset:3072 sc1
s_waitcnt vmcnt(7)
v_add_f32 v24, v24, v40
v_add_f32 v25, v25, v41
v_add_f32 v26, v26, v42
v_add_f32 v27, v27, v43
s_waitcnt vmcnt(6)
v_add_f32 v28, v28, v44
v_add_f32 v29, v29, v45
v_add_f32 v30, v30, v46
v_add_f32 v31, v31, v47
v_cvt_pk_bf16_f32 v24, v24, v25
v_cvt_pk_bf16_f32 v25, v26, v27
v_cvt_pk_bf16_f32 v26, v28, v29
v_cvt_pk_bf16_f32 v27, v30, v31
s_nop 1
v_permlane16_swap_b32 v24, v26
v_permlane16_swap_b32 v25, v27
buffer_store_dwordx4 v[24:27], v8, s[48:51], s77 offen offset:0
s_waitcnt vmcnt(6)
v_add_f32 v32, v32, v48
v_add_f32 v33, v33, v49
v_add_f32 v34, v34, v50
v_add_f32 v35, v35, v51
s_waitcnt vmcnt(5)
v_add_f32 v36, v36, v52
v_add_f32 v37, v37, v53
v_add_f32 v38, v38, v54
v_add_f32 v39, v39, v55
v_cvt_pk_bf16_f32 v32, v32, v33
v_cvt_pk_bf16_f32 v33, v34, v35
v_cvt_pk_bf16_f32 v34, v36, v37
v_cvt_pk_bf16_f32 v35, v38, v39
s_nop 1
v_permlane16_swap_b32 v32, v34
v_permlane16_swap_b32 v33, v35
buffer_store_dwordx4 v[32:35], v8, s[48:51], s77 offen offset:64
s_waitcnt vmcnt(5)
v_add_f32 v56, v56, v72
v_add_f32 v57, v57, v73
v_add_f32 v58, v58, v74
v_add_f32 v59, v59, v75
s_waitcnt vmcnt(4)
v_add_f32 v60, v60, v76
v_add_f32 v61, v61, v77
v_add_f32 v62, v62, v78
v_add_f32 v63, v63, v79
v_cvt_pk_bf16_f32 v56, v56, v57
v_cvt_pk_bf16_f32 v57, v58, v59
v_cvt_pk_bf16_f32 v58, v60, v61
v_cvt_pk_bf16_f32 v59, v62, v63
s_nop 1
v_permlane16_swap_b32 v56, v58
v_permlane16_swap_b32 v57, v59
buffer_store_dwordx4 v[56:59], v8, s[48:51], s78 offen offset:0
s_waitcnt vmcnt(4)
v_add_f32 v64, v64, v80
v_add_f32 v65, v65, v81
v_add_f32 v66, v66, v82
v_add_f32 v67, v67, v83
s_waitcnt vmcnt(3)
v_add_f32 v68, v68, v84
v_add_f32 v69, v69, v85
v_add_f32 v70, v70, v86
v_add_f32 v71, v71, v87
v_cvt_pk_bf16_f32 v64, v64, v65
v_cvt_pk_bf16_f32 v65, v66, v67
v_cvt_pk_bf16_f32 v66, v68, v69
v_cvt_pk_bf16_f32 v67, v70, v71
s_nop 1
v_permlane16_swap_b32 v64, v66
v_permlane16_swap_b32 v65, v67
buffer_store_dwordx4 v[64:67], v8, s[48:51], s78 offen offset:64
L_end:
s_endpgm
L_spin_1:
s_mov_b32 s67, 0x8000
L_spinlp_3:
s_sleep 1
buffer_load_dword v1, off, s[52:55], 0 offset:0 sc1
s_waitcnt vmcnt(0)
v_readfirstlane_b32 s66, v1
s_sub_u32 s67, s67, 1
s_cbranch_scc1 L_spinbk_2
s_cmp_lt_u32 s66, 256
s_cbranch_scc1 L_spinlp_3
s_branch L_spinbk_2
L_spin_4:
s_mov_b32 s67, 0x8000
L_spinlp_6:
s_sleep 1
buffer_load_dword v1, off, s[52:55], s80 offset:0 sc1
s_waitcnt vmcnt(0)
v_readfirstlane_b32 s66, v1
s_sub_u32 s67, s67, 1
s_cbranch_scc1 L_spinbk_5
s_cmp_lt_u32 s66, 8
s_cbranch_scc1 L_spinlp_6
s_branch L_spinbk_5
L_spin_16:
s_mov_b32 s67, 0x8000
L_spinlp_18:
s_sleep 1
buffer_load_dword v19, off, s[52:55], s80 offset:0 sc1
s_waitcnt vmcnt(0)
v_readfirstlane_b32 s66, v19
s_sub_u32 s67, s67, 1
s_cbranch_scc1 L_spinbk_17
s_cmp_lt_u32 s66, 16
s_cbranch_scc1 L_spinlp_18
s_branch L_spinbk_17
L_spin_1020:
s_mov_b32 s67, 0x8000
L_spinlp_1022:
s_sleep 1
buffer_load_dword v19, off, s[52:55], s80 offset:0 sc1
s_waitcnt vmcnt(0)
v_readfirstlane_b32 s66, v19
s_sub_u32 s67, s67, 1
s_cbranch_scc1 L_spinbk_1021
s_cmp_lt_u32 s66, 16
s_cbranch_scc1 L_spinlp_1022
s_branch L_spinbk_1021
L_F1_7:
ds_read_b128 a[144:147], v2 offset:0
ds_read_b128 a[148:151], v2 offset:1024
ds_read_b128 a[152:155], v2 offset:2048
ds_read_b128 a[156:159], v2 offset:3072
ds_read_b128 a[160:163], v2 offset:4096
ds_read_b128 a[164:167], v2 offset:5120
ds_read_b128 a[168:171], v2 offset:6144
ds_read_b128 a[172:175], v2 offset:7168
s_mov_b32 m0, s71
s_nop 0
buffer_load_dwordx4 v16, s[32:35], s70 offen offset:0 sc1 lds
buffer_load_dwordx4 v16, s[32:35], s70 offen offset:1024 sc1 lds
s_waitcnt lgkmcnt(7)
v_mfma_f32_16x16x32_bf16 v[104:107], a[144:147], v[40:43], 0
s_waitcnt lgkmcnt(6)
v_cndmask_b32 v88, 0, v17, s[0:1]
v_cndmask_b32 v89, 0, v17, s[4:5]
v_mfma_f32_16x16x32_bf16 v[104:107], a[148:151], v[44:47], v[104:107]
s_waitcnt lgkmcnt(5)
v_cndmask_b32 v90, 0, v17, s[6:7]
v_cndmask_b32 v91, 0, v17, s[8:9]
v_mfma_f32_16x16x32_bf16 v[104:107], a[152:155], v[48:51], v[104:107]
s_waitcnt lgkmcnt(4)
buffer_load_dwordx4 v16, s[32:35], s70 offen offset:2048 sc1 lds
v_mfma_f32_16x16x32_bf16 v[104:107], a[156:159], v[52:55], v[104:107]
ds_read_b128 a[176:179], v2 offset:8192
v_mfma_f32_16x16x32_bf16 v[120:123], a[156:159], v[68:71], 0
ds_read_b128 a[180:183], v2 offset:9216
v_mfma_f32_16x16x32_bf16 v[120:123], a[152:155], v[64:67], v[120:123]
ds_read_b128 a[184:187], v2 offset:10240
v_mfma_f32_16x16x32_bf16 v[120:123], a[148:151], v[60:63], v[120:123]
ds_read_b128 a[188:191], v2 offset:11264
v_mfma_f32_16x16x32_bf16 v[120:123], a[144:147], v[56:59], v[120:123]
ds_read_b128 a[192:195], v2 offset:12288
v_mfma_f32_16x16x32_bf16 v[136:139], a[144:147], v[72:75], 0
ds_read_b128 a[196:199], v2 offset:13312
v_mfma_f32_16x16x32_bf16 v[136:139], a[148:151], v[76:79], v[136:139]
buffer_load_dwordx4 v16, s[32:35], s70 offen offset:3072 sc1 lds
v_mfma_f32_16x16x32_bf16 v[136:139], a[152:155], v[80:83], v[136:139]
ds_read_b128 a[200:203], v2 offset:14336
v_mfma_f32_16x16x32_bf16 v[136:139], a[156:159], v[84:87], v[136:139]
ds_read_b128 a[204:207], v2 offset:15360
v_mfma_f32_16x16x32_bf16 v[88:91], a[156:159], v[36:39], v[88:91]
v_mfma_f32_16x16x32_bf16 v[88:91], a[152:155], v[32:35], v[88:91]
v_mfma_f32_16x16x32_bf16 v[88:91], a[148:151], v[28:31], v[88:91]
v_mfma_f32_16x16x32_bf16 v[88:91], a[144:147], v[24:27], v[88:91]
s_waitcnt lgkmcnt(2)
s_nop 1
v_max3_f32 v21, v104, v105, v106
v_max_f32 v21, v21, v107
v_max3_f32 v22, v120, v121, v122
v_max_f32 v22, v22, v123
v_max3_f32 v23, v136, v137, v138
v_max_f32 v23, v23, v139
v_max3_f32 v20, v88, v89, v90
v_max_f32 v20, v20, v91
v_mov_b32 v248, v20
v_mov_b32 v249, v21
v_mov_b32 v250, v22
v_mov_b32 v251, v23
v_permlane16_swap_b32 v248, v20
v_permlane16_swap_b32 v249, v21
v_permlane16_swap_b32 v250, v22
v_permlane16_swap_b32 v251, v23
v_max_f32 v20, v20, v248
v_max_f32 v21, v21, v249
v_max_f32 v22, v22, v250
v_max_f32 v23, v23, v251
v_mov_b32 v248, v20
v_mov_b32 v249, v21
v_mov_b32 v250, v22
v_mov_b32 v251, v23
v_permlane32_swap_b32 v248, v20
v_permlane32_swap_b32 v249, v21
v_permlane32_swap_b32 v250, v22
v_permlane32_swap_b32 v251, v23
v_max_f32 v20, v20, v248
v_max_f32 v21, v21, v249
v_max_f32 v22, v22, v250
v_max_f32 v23, v23, v251
s_cmp_eq_u32 s73, 0
s_cselect_b64 vcc, 0, -1
v_cndmask_b32 v20, v20, v252, vcc
v_cndmask_b32 v21, v21, v253, vcc
v_cndmask_b32 v22, v22, v254, vcc
v_cndmask_b32 v23, v23, v255, vcc
v_sub_f32 v228, 0, v23
v_sub_f32 v229, 0, v23
v_sub_f32 v230, 0, v23
v_sub_f32 v231, 0, v23
v_sub_f32 v224, 0, v22
v_sub_f32 v225, 0, v22
v_sub_f32 v226, 0, v22
v_sub_f32 v227, 0, v22
v_sub_f32 v220, 0, v21
v_sub_f32 v221, 0, v21
v_sub_f32 v222, 0, v21
v_sub_f32 v223, 0, v21
v_sub_f32 v216, 0, v20
v_sub_f32 v217, 0, v20
v_sub_f32 v218, 0, v20
v_sub_f32 v219, 0, v20
v_mfma_f32_16x16x32_bf16 v[140:143], a[160:163], v[72:75], v[228:231]
v_add_f32 v104, v104, v220
v_add_f32 v105, v105, v220
v_mfma_f32_16x16x32_bf16 v[140:143], a[164:167], v[76:79], v[140:143]
s_add_u32 m0, s71, 4096
v_add_f32 v106, v106, v220
v_add_f32 v107, v107, v220
v_exp_f32 v104, v104
v_mfma_f32_16x16x32_bf16 v[140:143], a[168:171], v[80:83], v[140:143]
s_add_u32 s64, s70, 4096
v_exp_f32 v105, v105
v_mfma_f32_16x16x32_bf16 v[140:143], a[172:175], v[84:87], v[140:143]
buffer_load_dwordx4 v16, s[32:35], s64 offen offset:0 sc1 lds
v_mfma_f32_16x16x32_bf16 v[124:127], a[172:175], v[68:71], v[224:227]
v_exp_f32 v106, v106
v_mfma_f32_16x16x32_bf16 v[124:127], a[168:171], v[64:67], v[124:127]
v_exp_f32 v107, v107
v_mfma_f32_16x16x32_bf16 v[124:127], a[164:167], v[60:63], v[124:127]
v_add_f32 v120, v120, v224
v_add_f32 v121, v121, v224
v_add_f32 v122, v122, v224
v_add_f32 v123, v123, v224
v_exp_f32 v120, v120
v_mfma_f32_16x16x32_bf16 v[124:127], a[160:163], v[56:59], v[124:127]
v_exp_f32 v121, v121
v_mfma_f32_16x16x32_bf16 v[108:111], a[160:163], v[40:43], v[220:223]
v_exp_f32 v122, v122
v_mfma_f32_16x16x32_bf16 v[108:111], a[164:167], v[44:47], v[108:111]
v_cndmask_b32 v92, v216, v17, s[10:11]
v_cndmask_b32 v93, v216, v17, s[12:13]
v_cndmask_b32 v94, v216, v17, s[18:19]
v_cndmask_b32 v95, v216, v17, s[22:23]
v_mfma_f32_16x16x32_bf16 v[108:111], a[168:171], v[48:51], v[108:111]
buffer_load_dwordx4 v16, s[32:35], s64 offen offset:1024 sc1 lds
v_cvt_pk_bf16_f32 v160, v104, v105
v_mfma_f32_16x16x32_bf16 v[108:111], a[172:175], v[52:55], v[108:111]
v_exp_f32 v123, v123
v_mfma_f32_16x16x32_bf16 v[92:95], a[172:175], v[36:39], v[92:95]
v_add_f32 v136, v136, v228
v_add_f32 v137, v137, v228
v_add_f32 v138, v138, v228
v_add_f32 v139, v139, v228
v_exp_f32 v136, v136
v_mfma_f32_16x16x32_bf16 v[92:95], a[168:171], v[32:35], v[92:95]
v_cvt_pk_bf16_f32 v161, v106, v107
v_exp_f32 v137, v137
v_cndmask_b32 v96, v216, v17, s[26:27]
v_cndmask_b32 v97, v216, v17, s[56:57]
v_cndmask_b32 v98, v216, v17, s[58:59]
v_cndmask_b32 v99, v216, v17, s[60:61]
v_mfma_f32_16x16x32_bf16 v[92:95], a[164:167], v[28:31], v[92:95]
v_exp_f32 v138, v138
v_mfma_f32_16x16x32_bf16 v[92:95], a[160:163], v[24:27], v[92:95]
v_exp_f32 v139, v139
v_mfma_f32_16x16x32_bf16 v[96:99], a[176:179], v[24:27], v[96:99]
v_cvt_pk_bf16_f32 v184, v120, v121
v_add_f32 v88, v88, v216
v_mfma_f32_16x16x32_bf16 v[96:99], a[180:183], v[28:31], v[96:99]
buffer_load_dwordx4 v16, s[32:35], s64 offen offset:2048 sc1 lds
v_add_f32 v89, v89, v216
v_add_f32 v90, v90, v216
v_add_f32 v91, v91, v216
v_exp_f32 v88, v88
v_mfma_f32_16x16x32_bf16 v[96:99], a[184:187], v[32:35], v[96:99]
v_exp_f32 v89, v89
v_mfma_f32_16x16x32_bf16 v[96:99], a[188:191], v[36:39], v[96:99]
v_cvt_pk_bf16_f32 v185, v122, v123
v_cvt_pk_bf16_f32 v192, v136, v137
v_mfma_f32_16x16x32_bf16 v[112:115], a[188:191], v[52:55], v[220:223]
v_exp_f32 v90, v90
v_mfma_f32_16x16x32_bf16 v[112:115], a[184:187], v[48:51], v[112:115]
v_exp_f32 v91, v91
v_mfma_f32_16x16x32_bf16 v[112:115], a[180:183], v[44:47], v[112:115]
v_exp_f32 v140, v140
v_mfma_f32_16x16x32_bf16 v[112:115], a[176:179], v[40:43], v[112:115]
v_exp_f32 v141, v141
v_mfma_f32_16x16x32_bf16 v[128:131], a[176:179], v[56:59], v[224:227]
buffer_load_dwordx4 v16, s[32:35], s64 offen offset:3072 sc1 lds
v_cvt_pk_bf16_f32 v193, v138, v139
v_mfma_f32_16x16x32_bf16 v[128:131], a[180:183], v[60:63], v[128:131]
v_exp_f32 v142, v142
v_mfma_f32_16x16x32_bf16 v[128:131], a[184:187], v[64:67], v[128:131]
v_exp_f32 v143, v143
v_mfma_f32_16x16x32_bf16 v[128:131], a[188:191], v[68:71], v[128:131]
v_cvt_pk_bf16_f32 v152, v88, v89
v_cvt_pk_bf16_f32 v153, v90, v91
v_mfma_f32_16x16x32_bf16 v[144:147], a[188:191], v[84:87], v[228:231]
v_exp_f32 v124, v124
v_mfma_f32_16x16x32_bf16 v[144:147], a[184:187], v[80:83], v[144:147]
v_exp_f32 v125, v125
v_mfma_f32_16x16x32_bf16 v[144:147], a[180:183], v[76:79], v[144:147]
s_waitcnt vmcnt(8)
s_barrier
v_mfma_f32_16x16x32_bf16 v[144:147], a[176:179], v[72:75], v[144:147]
v_exp_f32 v126, v126
v_mfma_f32_16x16x32_bf16 v[148:151], a[192:195], v[72:75], v[228:231]
v_cvt_pk_bf16_f32 v194, v140, v141
v_cvt_pk_bf16_f32 v195, v142, v143
v_mfma_f32_16x16x32_bf16 v[148:151], a[196:199], v[76:79], v[148:151]
s_waitcnt lgkmcnt(0)
v_exp_f32 v127, v127
v_mfma_f32_16x16x32_bf16 v[148:151], a[200:203], v[80:83], v[148:151]
s_xor_b32 s71, s71, 16384
v_exp_f32 v108, v108
v_mfma_f32_16x16x32_bf16 v[148:151], a[204:207], v[84:87], v[148:151]
s_add_u32 s70, s70, 32768
v_exp_f32 v109, v109
v_mfma_f32_16x16x32_bf16 v[132:135], a[204:207], v[68:71], v[224:227]
s_mov_b32 m0, s71
v_exp_f32 v110, v110
v_mfma_f32_16x16x32_bf16 v[132:135], a[200:203], v[64:67], v[132:135]
buffer_load_dwordx4 v16, s[32:35], s70 offen offset:0 sc1 lds
v_mfma_f32_16x16x32_bf16 v[132:135], a[196:199], v[60:63], v[132:135]
v_cvt_pk_bf16_f32 v186, v124, v125
v_exp_f32 v111, v111
v_mfma_f32_16x16x32_bf16 v[132:135], a[192:195], v[56:59], v[132:135]
v_exp_f32 v92, v92
v_mfma_f32_16x16x32_bf16 v[116:119], a[192:195], v[40:43], v[220:223]
v_cndmask_b32 v100, v216, v17, s[62:63]
v_cndmask_b32 v101, v216, v17, s[48:49]
v_mfma_f32_16x16x32_bf16 v[116:119], a[196:199], v[44:47], v[116:119]
v_cndmask_b32 v102, v216, v17, s[50:51]
v_cndmask_b32 v103, v216, v17, s[100:101]
v_cvt_pk_bf16_f32 v187, v126, v127
v_exp_f32 v93, v93
v_mfma_f32_16x16x32_bf16 v[116:119], a[200:203], v[48:51], v[116:119]
ds_read_b128 a[144:147], v2 offset:16384
v_exp_f32 v94, v94
v_mfma_f32_16x16x32_bf16 v[116:119], a[204:207], v[52:55], v[116:119]
ds_read_b128 a[148:151], v2 offset:17408
v_cvt_pk_bf16_f32 v162, v108, v109
v_mfma_f32_16x16x32_bf16 v[100:103], a[204:207], v[36:39], v[100:103]
ds_read_b128 a[152:155], v2 offset:18432
buffer_load_dwordx4 v16, s[32:35], s70 offen offset:1024 sc1 lds
v_exp_f32 v95, v95
v_mfma_f32_16x16x32_bf16 v[100:103], a[200:203], v[32:35], v[100:103]
ds_read_b128 a[156:159], v2 offset:19456
v_exp_f32 v96, v96
v_mfma_f32_16x16x32_bf16 v[100:103], a[196:199], v[28:31], v[100:103]
v_cvt_pk_bf16_f32 v163, v110, v111
v_exp_f32 v97, v97
v_mfma_f32_16x16x32_bf16 v[100:103], a[192:195], v[24:27], v[100:103]
s_waitcnt lgkmcnt(3)
ds_read_b128 a[160:163], v2 offset:20480
ds_read_b128 a[164:167], v2 offset:21504
ds_read_b128 a[168:171], v2 offset:22528
ds_read_b128 a[172:175], v2 offset:23552
v_cvt_pk_bf16_f32 v154, v92, v93
v_mfma_f32_16x16x32_bf16 v[120:123], a[144:147], v[56:59], v[224:227]
s_waitcnt lgkmcnt(6)
v_exp_f32 v98, v98
v_mfma_f32_16x16x32_bf16 v[120:123], a[148:151], v[60:63], v[120:123]
s_waitcnt lgkmcnt(5)
v_exp_f32 v99, v99
v_mfma_f32_16x16x32_bf16 v[120:123], a[152:155], v[64:67], v[120:123]
s_waitcnt lgkmcnt(4)
v_exp_f32 v112, v112
v_mfma_f32_16x16x32_bf16 v[120:123], a[156:159], v[68:71], v[120:123]
v_exp_f32 v113, v113
v_mfma_f32_16x16x32_bf16 v[136:139], a[156:159], v[84:87], v[228:231]
v_cvt_pk_bf16_f32 v155, v94, v95
v_cndmask_b32 v104, v220, v17, s[0:1]
v_mfma_f32_16x16x32_bf16 v[136:139], a[152:155], v[80:83], v[136:139]
buffer_load_dwordx4 v16, s[32:35], s70 offen offset:2048 sc1 lds
v_cndmask_b32 v105, v220, v17, s[4:5]
v_cndmask_b32 v106, v220, v17, s[6:7]
v_cndmask_b32 v107, v220, v17, s[8:9]
v_exp_f32 v114, v114
v_mfma_f32_16x16x32_bf16 v[136:139], a[148:151], v[76:79], v[136:139]
v_cvt_pk_bf16_f32 v156, v96, v97
v_cvt_pk_bf16_f32 v157, v98, v99
v_mfma_f32_16x16x32_bf16 v[136:139], a[144:147], v[72:75], v[136:139]
v_exp_f32 v115, v115
v_mfma_f32_16x16x32_bf16 v[104:107], a[144:147], v[40:43], v[104:107]
v_exp_f32 v128, v128
v_mfma_f32_16x16x32_bf16 v[104:107], a[148:151], v[44:47], v[104:107]
v_exp_f32 v129, v129
v_mfma_f32_16x16x32_bf16 v[104:107], a[152:155], v[48:51], v[104:107]
v_exp_f32 v130, v130
v_mfma_f32_16x16x32_bf16 v[104:107], a[156:159], v[52:55], v[104:107]
s_waitcnt lgkmcnt(0)
v_exp_f32 v131, v131
v_mfma_f32_16x16x32_bf16 v[140:143], a[172:175], v[84:87], v[228:231]
v_cvt_pk_bf16_f32 v164, v112, v113
v_cvt_pk_bf16_f32 v165, v114, v115
v_mfma_f32_16x16x32_bf16 v[140:143], a[168:171], v[80:83], v[140:143]
v_exp_f32 v144, v144
v_mfma_f32_16x16x32_bf16 v[140:143], a[164:167], v[76:79], v[140:143]
v_exp_f32 v145, v145
v_mfma_f32_16x16x32_bf16 v[140:143], a[160:163], v[72:75], v[140:143]
v_exp_f32 v146, v146
v_mfma_f32_16x16x32_bf16 v[124:127], a[160:163], v[56:59], v[224:227]
ds_read_b128 a[176:179], v2 offset:24576
v_cndmask_b32 v108, v220, v17, s[10:11]
v_mfma_f32_16x16x32_bf16 v[124:127], a[164:167], v[60:63], v[124:127]
ds_read_b128 a[180:183], v2 offset:25600
v_cndmask_b32 v109, v220, v17, s[12:13]
v_cndmask_b32 v110, v220, v17, s[18:19]
v_cndmask_b32 v111, v220, v17, s[22:23]
v_cvt_pk_bf16_f32 v188, v128, v129
v_mfma_f32_16x16x32_bf16 v[124:127], a[168:171], v[64:67], v[124:127]
ds_read_b128 a[184:187], v2 offset:26624
v_exp_f32 v147, v147
v_mfma_f32_16x16x32_bf16 v[124:127], a[172:175], v[68:71], v[124:127]
ds_read_b128 a[188:191], v2 offset:27648
buffer_load_dwordx4 v16, s[32:35], s70 offen offset:3072 sc1 lds
v_exp_f32 v148, v148
v_mfma_f32_16x16x32_bf16 v[108:111], a[172:175], v[52:55], v[108:111]
v_cvt_pk_bf16_f32 v189, v130, v131
v_exp_f32 v149, v149
v_mfma_f32_16x16x32_bf16 v[108:111], a[168:171], v[48:51], v[108:111]
v_cndmask_b32 v112, v220, v17, s[26:27]
v_cndmask_b32 v113, v220, v17, s[56:57]
v_cndmask_b32 v114, v220, v17, s[58:59]
v_cndmask_b32 v115, v220, v17, s[60:61]
v_mfma_f32_16x16x32_bf16 v[108:111], a[164:167], v[44:47], v[108:111]
v_exp_f32 v150, v150
v_mfma_f32_16x16x32_bf16 v[108:111], a[160:163], v[40:43], v[108:111]
s_waitcnt lgkmcnt(2)
v_cvt_pk_bf16_f32 v196, v144, v145
v_exp_f32 v151, v151
v_mfma_f32_16x16x32_bf16 v[112:115], a[176:179], v[40:43], v[112:115]
v_exp_f32 v132, v132
v_mfma_f32_16x16x32_bf16 v[112:115], a[180:183], v[44:47], v[112:115]
s_waitcnt lgkmcnt(0)
v_exp_f32 v133, v133
v_mfma_f32_16x16x32_bf16 v[112:115], a[184:187], v[48:51], v[112:115]
v_cvt_pk_bf16_f32 v197, v146, v147
v_cvt_pk_bf16_f32 v198, v148, v149
v_mfma_f32_16x16x32_bf16 v[112:115], a[188:191], v[52:55], v[112:115]
v_exp_f32 v134, v134
v_mfma_f32_16x16x32_bf16 v[128:131], a[188:191], v[68:71], v[224:227]
ds_read_b128 a[192:195], v2 offset:28672
ds_read_b128 a[196:199], v2 offset:29696
ds_read_b128 a[200:203], v2 offset:30720
ds_read_b128 a[204:207], v2 offset:31744
v_cvt_pk_bf16_f32 v199, v150, v151
v_mfma_f32_16x16x32_bf16 v[128:131], a[184:187], v[64:67], v[128:131]
v_exp_f32 v135, v135
v_mfma_f32_16x16x32_bf16 v[128:131], a[180:183], v[60:63], v[128:131]
v_exp_f32 v116, v116
v_mfma_f32_16x16x32_bf16 v[128:131], a[176:179], v[56:59], v[128:131]
s_add_u32 m0, s71, 4096
v_exp_f32 v117, v117
v_mfma_f32_16x16x32_bf16 v[144:147], a[176:179], v[72:75], v[228:231]
s_add_u32 s64, s70, 4096
v_exp_f32 v118, v118
v_mfma_f32_16x16x32_bf16 v[144:147], a[180:183], v[76:79], v[144:147]
buffer_load_dwordx4 v16, s[32:35], s64 offen offset:0 sc1 lds
v_mfma_f32_16x16x32_bf16 v[144:147], a[184:187], v[80:83], v[144:147]
v_cvt_pk_bf16_f32 v190, v132, v133
v_exp_f32 v119, v119
v_mfma_f32_16x16x32_bf16 v[144:147], a[188:191], v[84:87], v[144:147]
s_waitcnt lgkmcnt(0)
v_exp_f32 v100, v100
v_mfma_f32_16x16x32_bf16 v[148:151], a[204:207], v[84:87], v[228:231]
v_exp_f32 v101, v101
v_mfma_f32_16x16x32_bf16 v[148:151], a[200:203], v[80:83], v[148:151]
v_cvt_pk_bf16_f32 v191, v134, v135
v_cvt_pk_bf16_f32 v166, v116, v117
v_cvt_pk_bf16_f32 v167, v118, v119
v_mfma_f32_16x16x32_bf16 v[148:151], a[196:199], v[76:79], v[148:151]
v_exp_f32 v102, v102
v_mfma_f32_16x16x32_bf16 v[148:151], a[192:195], v[72:75], v[148:151]
v_exp_f32 v103, v103
v_mfma_f32_16x16x32_bf16 v[132:135], a[192:195], v[56:59], v[224:227]
s_lshl_b32 s66, s30, 30
ds_read_b128 a[144:147], v3 offset:16384
v_cndmask_b32 v116, v220, v17, s[62:63]
v_mfma_f32_16x16x32_bf16 v[132:135], a[196:199], v[60:63], v[132:135]
ds_read_b128 a[148:151], v3 offset:24576
v_cndmask_b32 v117, v220, v17, s[48:49]
v_cndmask_b32 v118, v220, v17, s[50:51]
v_cndmask_b32 v119, v220, v17, s[100:101]
v_exp_f32 v120, v120
v_mfma_f32_16x16x32_bf16 v[132:135], a[200:203], v[64:67], v[132:135]
v_exp_f32 v121, v121
v_mfma_f32_16x16x32_bf16 v[132:135], a[204:207], v[68:71], v[132:135]
v_exp_f32 v122, v122
v_mfma_f32_16x16x32_bf16 v[116:119], a[204:207], v[52:55], v[116:119]
v_exp_f32 v123, v123
v_mfma_f32_16x16x32_bf16 v[116:119], a[200:203], v[48:51], v[116:119]
v_cvt_pk_bf16_f32 v158, v100, v101
v_cvt_pk_bf16_f32 v159, v102, v103
v_mfma_f32_16x16x32_bf16 v[116:119], a[196:199], v[44:47], v[116:119]
buffer_load_dwordx4 v16, s[32:35], s64 offen offset:1024 sc1 lds
v_mfma_f32_16x16x32_bf16 v[116:119], a[192:195], v[40:43], v[116:119]
s_waitcnt lgkmcnt(0)
v_exp_f32 v136, v136
v_mfma_f32_16x16x32_bf16 a[0:3], a[144:147], v[152:155], 0
ds_read_b128 a[152:155], v3 offset:17408
v_cvt_pk_bf16_f32 v200, v120, v121
v_mfma_f32_16x16x32_bf16 a[0:3], a[148:151], v[156:159], a[0:3]
ds_read_b128 a[156:159], v3 offset:25600
v_exp_f32 v137, v137
v_mfma_f32_16x16x32_bf16 a[32:35], a[148:151], v[164:167], 0
v_exp_f32 v138, v138
v_mfma_f32_16x16x32_bf16 a[32:35], a[144:147], v[160:163], a[32:35]
v_exp_f32 v139, v139
v_mfma_f32_16x16x32_bf16 a[64:67], a[144:147], v[184:187], 0
v_exp_f32 v104, v104
v_mfma_f32_16x16x32_bf16 a[64:67], a[148:151], v[188:191], a[64:67]
v_exp_f32 v105, v105
v_mfma_f32_16x16x32_bf16 a[96:99], a[148:151], v[196:199], 0
ds_read_b128 a[160:163], v3 offset:18432
v_cvt_pk_bf16_f32 v201, v122, v123
v_mfma_f32_16x16x32_bf16 a[96:99], a[144:147], v[192:195], a[96:99]
s_waitcnt lgkmcnt(1)
v_exp_f32 v106, v106
v_mfma_f32_16x16x32_bf16 a[100:103], a[152:155], v[192:195], 0
ds_read_b128 a[164:167], v3 offset:26624
v_cvt_pk_bf16_f32 v208, v136, v137
v_mfma_f32_16x16x32_bf16 a[100:103], a[156:159], v[196:199], a[100:103]
v_exp_f32 v107, v107
v_mfma_f32_16x16x32_bf16 a[68:71], a[156:159], v[188:191], 0
v_exp_f32 v140, v140
v_mfma_f32_16x16x32_bf16 a[68:71], a[152:155], v[184:187], a[68:71]
buffer_load_dwordx4 v16, s[32:35], s64 offen offset:2048 sc1 lds
v_mfma_f32_16x16x32_bf16 a[36:39], a[152:155], v[160:163], 0
v_exp_f32 v141, v141
v_mfma_f32_16x16x32_bf16 a[36:39], a[156:159], v[164:167], a[36:39]
v_cvt_pk_bf16_f32 v209, v138, v139
v_cvt_pk_bf16_f32 v176, v104, v105
v_mfma_f32_16x16x32_bf16 a[4:7], a[156:159], v[156:159], 0
v_exp_f32 v142, v142
v_mfma_f32_16x16x32_bf16 a[4:7], a[152:155], v[152:155], a[4:7]
s_waitcnt lgkmcnt(0)
ds_read_b128 a[168:171], v3 offset:19456
v_cvt_pk_bf16_f32 v177, v106, v107
v_mfma_f32_16x16x32_bf16 a[8:11], a[160:163], v[152:155], 0
ds_read_b128 a[172:175], v3 offset:27648
v_cvt_pk_bf16_f32 v210, v140, v141
v_mfma_f32_16x16x32_bf16 a[8:11], a[164:167], v[156:159], a[8:11]
v_exp_f32 v143, v143
v_mfma_f32_16x16x32_bf16 a[40:43], a[164:167], v[164:167], 0
v_exp_f32 v124, v124
v_mfma_f32_16x16x32_bf16 a[40:43], a[160:163], v[160:163], a[40:43]
v_exp_f32 v125, v125
v_mfma_f32_16x16x32_bf16 a[72:75], a[160:163], v[184:187], 0
v_exp_f32 v126, v126
v_mfma_f32_16x16x32_bf16 a[72:75], a[164:167], v[188:191], a[72:75]
v_exp_f32 v127, v127
v_mfma_f32_16x16x32_bf16 a[104:107], a[164:167], v[196:199], 0
ds_read_b128 a[176:179], v3 offset:20480
v_cvt_pk_bf16_f32 v211, v142, v143
v_mfma_f32_16x16x32_bf16 a[104:107], a[160:163], v[192:195], a[104:107]
s_waitcnt lgkmcnt(1)
ds_read_b128 a[180:183], v3 offset:28672
v_cvt_pk_bf16_f32 v202, v124, v125
v_mfma_f32_16x16x32_bf16 a[108:111], a[168:171], v[192:195], 0
v_exp_f32 v108, v108
v_mfma_f32_16x16x32_bf16 a[108:111], a[172:175], v[196:199], a[108:111]
v_exp_f32 v109, v109
v_mfma_f32_16x16x32_bf16 a[76:79], a[172:175], v[188:191], 0
buffer_load_dwordx4 v16, s[32:35], s64 offen offset:3072 sc1 lds
v_mfma_f32_16x16x32_bf16 a[76:79], a[168:171], v[184:187], a[76:79]
v_exp_f32 v110, v110
v_mfma_f32_16x16x32_bf16 a[44:47], a[168:171], v[160:163], 0
v_exp_f32 v111, v111
v_mfma_f32_16x16x32_bf16 a[44:47], a[172:175], v[164:167], a[44:47]
v_exp_f32 v112, v112
v_mfma_f32_16x16x32_bf16 a[12:15], a[172:175], v[156:159], 0
ds_read_b128 a[184:187], v3 offset:21504
v_cvt_pk_bf16_f32 v203, v126, v127
v_mfma_f32_16x16x32_bf16 a[12:15], a[168:171], v[152:155], a[12:15]
s_waitcnt lgkmcnt(1)
ds_read_b128 a[188:191], v3 offset:29696
v_cvt_pk_bf16_f32 v178, v108, v109
v_mfma_f32_16x16x32_bf16 a[16:19], a[176:179], v[152:155], 0
v_exp_f32 v113, v113
v_mfma_f32_16x16x32_bf16 a[16:19], a[180:183], v[156:159], a[16:19]
v_exp_f32 v114, v114
v_mfma_f32_16x16x32_bf16 a[48:51], a[180:183], v[164:167], 0
v_exp_f32 v115, v115
v_mfma_f32_16x16x32_bf16 a[48:51], a[176:179], v[160:163], a[48:51]
v_xor_b32 v2, 0x8000, v2
v_cvt_pk_bf16_f32 v179, v110, v111
v_mfma_f32_16x16x32_bf16 a[80:83], a[176:179], v[184:187], 0
v_exp_f32 v128, v128
v_mfma_f32_16x16x32_bf16 a[80:83], a[180:183], v[188:191], a[80:83]
ds_read_b128 a[192:195], v3 offset:22528
v_cvt_pk_bf16_f32 v180, v112, v113
v_mfma_f32_16x16x32_bf16 a[112:115], a[180:183], v[196:199], 0
ds_read_b128 a[196:199], v3 offset:30720
v_cvt_pk_bf16_f32 v181, v114, v115
v_mfma_f32_16x16x32_bf16 a[112:115], a[176:179], v[192:195], a[112:115]
s_waitcnt lgkmcnt(2)
ds_read_b128 a[200:203], v3 offset:23552
ds_read_b128 a[204:207], v3 offset:31744
v_lshl_add_u32 v19, v0, 24, s66
v_mfma_f32_16x16x32_bf16 a[116:119], a[184:187], v[192:195], 0
s_lshr_b32 s67, s31, 4
s_waitcnt vmcnt(8)
s_barrier
v_exp_f32 v129, v129
v_mfma_f32_16x16x32_bf16 a[116:119], a[188:191], v[196:199], a[116:119]
s_lshl1_add_u32 s67, s3, s67
v_exp_f32 v130, v130
v_mfma_f32_16x16x32_bf16 a[84:87], a[188:191], v[188:191], 0
s_lshl_b32 s79, s67, 8
s_xor_b32 s71, s71, 49152
v_exp_f32 v131, v131
v_mfma_f32_16x16x32_bf16 a[84:87], a[184:187], v[184:187], a[84:87]
s_add_u32 s79, s79, 8192
s_add_u32 s70, s70, 32768
v_exp_f32 v144, v144
v_mfma_f32_16x16x32_bf16 a[52:55], a[184:187], v[160:163], 0
s_lshl_b32 s67, s73, 16
s_mov_b32 m0, s71
v_exp_f32 v145, v145
v_mfma_f32_16x16x32_bf16 a[52:55], a[188:191], v[164:167], a[52:55]
s_add_u32 s67, s67, s79
buffer_load_dwordx4 v16, s[32:35], s70 offen offset:0 sc1 lds
v_mfma_f32_16x16x32_bf16 a[20:23], a[188:191], v[156:159], 0
v_exp_f32 v146, v146
v_mfma_f32_16x16x32_bf16 a[20:23], a[184:187], v[152:155], a[20:23]
s_waitcnt lgkmcnt(0)
v_exp_f32 v147, v147
v_mfma_f32_16x16x32_bf16 a[24:27], a[192:195], v[152:155], 0
v_cvt_pk_bf16_f32 v204, v128, v129
v_cvt_pk_bf16_f32 v205, v130, v131
v_mfma_f32_16x16x32_bf16 a[24:27], a[196:199], v[156:159], a[24:27]
v_exp_f32 v148, v148
v_mfma_f32_16x16x32_bf16 a[56:59], a[196:199], v[164:167], 0
v_exp_f32 v149, v149
v_mfma_f32_16x16x32_bf16 a[56:59], a[192:195], v[160:163], a[56:59]
v_exp_f32 v150, v150
v_mfma_f32_16x16x32_bf16 a[88:91], a[192:195], v[184:187], 0
v_exp_f32 v151, v151
v_mfma_f32_16x16x32_bf16 a[88:91], a[196:199], v[188:191], a[88:91]
v_exp_f32 v132, v132
v_mfma_f32_16x16x32_bf16 a[120:123], a[196:199], v[196:199], 0
v_exp_f32 v133, v133
v_mfma_f32_16x16x32_bf16 a[120:123], a[192:195], v[192:195], a[120:123]
v_cvt_pk_bf16_f32 v212, v144, v145
v_cvt_pk_bf16_f32 v213, v146, v147
v_mfma_f32_16x16x32_bf16 a[124:127], a[200:203], v[192:195], 0
s_add_u32 s17, s78, L_D_8-L_pc+0
v_exp_f32 v134, v134
v_mfma_f32_16x16x32_bf16 a[124:127], a[204:207], v[196:199], a[124:127]
buffer_load_dword a252, v16, s[88:91], s17 offen
v_mfma_f32_16x16x32_bf16 a[92:95], a[204:207], v[188:191], 0
buffer_load_dwordx4 v16, s[32:35], s70 offen offset:1024 sc1 lds
v_mfma_f32_16x16x32_bf16 a[92:95], a[200:203], v[184:187], a[92:95]
s_add_u32 s17, s78, L_D_8-L_pc+4096
v_exp_f32 v135, v135
v_mfma_f32_16x16x32_bf16 a[60:63], a[200:203], v[160:163], 0
buffer_load_dword a252, v16, s[88:91], s17 offen
v_mfma_f32_16x16x32_bf16 a[60:63], a[204:207], v[164:167], a[60:63]
v_cvt_pk_bf16_f32 v214, v148, v149
v_cvt_pk_bf16_f32 v215, v150, v151
v_mfma_f32_16x16x32_bf16 a[28:31], a[204:207], v[156:159], 0
v_exp_f32 v116, v116
v_mfma_f32_16x16x32_bf16 a[28:31], a[200:203], v[152:155], a[28:31]
s_add_u32 s17, s78, L_D_8-L_pc+8192
v_exp_f32 v117, v117
v_mfma_f32_16x16x32_bf16 a[128:131], a[244:247], v[152:155], 0
ds_read_b128 a[144:147], v2 offset:0
v_cvt_pk_bf16_f32 v206, v132, v133
v_mfma_f32_16x16x32_bf16 a[128:131], a[244:247], v[156:159], a[128:131]
ds_read_b128 a[148:151], v2 offset:1024
v_cvt_pk_bf16_f32 v207, v134, v135
v_mfma_f32_16x16x32_bf16 a[132:135], a[244:247], v[160:163], 0
buffer_load_dword a252, v16, s[88:91], s17 offen
v_mfma_f32_16x16x32_bf16 a[132:135], a[244:247], v[164:167], a[132:135]
v_exp_f32 v118, v118
v_mfma_f32_16x16x32_bf16 a[136:139], a[244:247], v[184:187], 0
ds_read_b128 a[152:155], v2 offset:2048
v_cvt_pk_bf16_f32 v182, v116, v117
v_mfma_f32_16x16x32_bf16 a[136:139], a[244:247], v[188:191], a[136:139]
ds_read_b128 a[156:159], v2 offset:3072
v_xor_b32 v3, 0x8000, v3
v_mfma_f32_16x16x32_bf16 a[140:143], a[244:247], v[192:195], 0
s_add_u32 s17, s78, L_D_8-L_pc+12288
v_exp_f32 v119, v119
v_mfma_f32_16x16x32_bf16 a[140:143], a[244:247], v[196:199], a[140:143]
buffer_atomic_add a251, v19, s[52:55], s67 offen offset:0 sc1
buffer_load_dword a252, v16, s[88:91], s17 offen
ds_read_b128 a[160:163], v2 offset:4096
ds_read_b128 a[164:167], v2 offset:5120
ds_read_b128 a[168:171], v2 offset:6144
ds_read_b128 a[172:175], v2 offset:7168
v_cvt_pk_bf16_f32 v183, v118, v119
s_branch L_T_10
L_T1_11:
s_waitcnt lgkmcnt(7)
v_mfma_f32_16x16x32_bf16 v[136:139], a[144:147], v[72:75], v[228:231]
s_waitcnt lgkmcnt(6)
s_and_b32 s66, s2, 7
v_cndmask_b32 v120, v224, v17, s[0:1]
v_cndmask_b32 v121, v224, v17, s[4:5]
v_mfma_f32_16x16x32_bf16 v[136:139], a[148:151], v[76:79], v[136:139]
s_waitcnt lgkmcnt(5)
s_lshr_b32 s67, s2, 3
v_cndmask_b32 v122, v224, v17, s[6:7]
v_cndmask_b32 v123, v224, v17, s[8:9]
v_mfma_f32_16x16x32_bf16 v[136:139], a[152:155], v[80:83], v[136:139]
s_waitcnt lgkmcnt(4)
s_lshr_b32 s83, s66, 2
buffer_load_dwordx4 v16, s[32:35], s70 offen offset:2048 sc1 lds
v_mfma_f32_16x16x32_bf16 v[136:139], a[156:159], v[84:87], v[136:139]
s_and_b32 s68, s66, 1
ds_read_b128 a[176:179], v2 offset:8192
v_cndmask_b32 v124, v224, v17, s[10:11]
v_mfma_f32_16x16x32_bf16 v[120:123], a[156:159], v[68:71], v[120:123]
s_and_b32 s69, s67, 7
ds_read_b128 a[180:183], v2 offset:9216
v_cndmask_b32 v125, v224, v17, s[12:13]
v_mfma_f32_16x16x32_bf16 v[120:123], a[152:155], v[64:67], v[120:123]
s_lshl3_add_u32 s82, s68, s69
v_cndmask_b32 v126, v224, v17, s[18:19]
v_cndmask_b32 v127, v224, v17, s[22:23]
v_mfma_f32_16x16x32_bf16 v[120:123], a[148:151], v[60:63], v[120:123]
s_and_b32 s68, s66, 2
ds_read_b128 a[184:187], v2 offset:10240
v_cndmask_b32 v128, v224, v17, s[26:27]
v_mfma_f32_16x16x32_bf16 v[120:123], a[144:147], v[56:59], v[120:123]
s_waitcnt lgkmcnt(3)
s_lshr_b32 s69, s67, 3
ds_read_b128 a[188:191], v2 offset:11264
v_cndmask_b32 v129, v224, v17, s[56:57]
v_mfma_f32_16x16x32_bf16 v[140:143], a[160:163], v[72:75], v[228:231]
s_lshl1_add_u32 s87, s68, s69
v_cndmask_b32 v130, v224, v17, s[58:59]
v_cndmask_b32 v131, v224, v17, s[60:61]
v_mfma_f32_16x16x32_bf16 v[140:143], a[164:167], v[76:79], v[140:143]
s_lshl_b32 s87, s87, 8
ds_read_b128 a[192:195], v2 offset:12288
v_cndmask_b32 v132, v224, v17, s[62:63]
v_mfma_f32_16x16x32_bf16 v[140:143], a[168:171], v[80:83], v[140:143]
s_lshl_b32 s86, s30, 13
v_exp_f32 v136, v136
v_mfma_f32_16x16x32_bf16 v[140:143], a[172:175], v[84:87], v[140:143]
s_lshl_b32 s85, s30, 16
v_exp_f32 v137, v137
v_mfma_f32_16x16x32_bf16 v[124:127], a[172:175], v[68:71], v[124:127]
s_add_u32 s85, s85, s87
buffer_load_dwordx4 v16, s[32:35], s70 offen offset:3072 sc1 lds
v_mfma_f32_16x16x32_bf16 v[124:127], a[168:171], v[64:67], v[124:127]
s_lshl_b32 s66, s83, 20
v_exp_f32 v138, v138
v_mfma_f32_16x16x32_bf16 v[124:127], a[164:167], v[60:63], v[124:127]
s_add_u32 s85, s85, s66
ds_read_b128 a[196:199], v2 offset:13312
v_cvt_pk_bf16_f32 v192, v136, v137
v_mfma_f32_16x16x32_bf16 v[124:127], a[160:163], v[56:59], v[124:127]
s_waitcnt lgkmcnt(1)
s_mul_i32 s84, s82, 1310720
v_exp_f32 v139, v139
v_mfma_f32_16x16x32_bf16 v[128:131], a[176:179], v[56:59], v[128:131]
s_and_b32 s66, s30, 1
ds_read_b128 a[200:203], v2 offset:14336
v_cndmask_b32 v133, v224, v17, s[48:49]
v_mfma_f32_16x16x32_bf16 v[128:131], a[180:183], v[60:63], v[128:131]
s_lshl_b32 s66, s66, 14
ds_read_b128 a[204:207], v2 offset:15360
v_cndmask_b32 v134, v224, v17, s[50:51]
v_mfma_f32_16x16x32_bf16 v[128:131], a[184:187], v[64:67], v[128:131]
s_add_u32 s84, s84, s66
v_exp_f32 v120, v120
v_mfma_f32_16x16x32_bf16 v[128:131], a[188:191], v[68:71], v[128:131]
s_lshl_b32 s66, s83, 17
v_exp_f32 v121, v121
v_mfma_f32_16x16x32_bf16 v[144:147], a[188:191], v[84:87], v[228:231]
s_add_u32 s84, s84, s66
s_add_u32 m0, s71, 4096
v_exp_f32 v122, v122
v_mfma_f32_16x16x32_bf16 v[144:147], a[184:187], v[80:83], v[144:147]
s_add_u32 s84, s84, 34603008
s_add_u32 s64, s70, 4096
ds_read_b128 a[144:147], v3 offset:0
v_cndmask_b32 v135, v224, v17, s[100:101]
v_mfma_f32_16x16x32_bf16 v[144:147], a[180:183], v[76:79], v[144:147]
s_sub_u32 s66, 15, s82
buffer_load_dwordx4 v16, s[32:35], s64 offen offset:0 sc1 lds
v_mfma_f32_16x16x32_bf16 v[144:147], a[176:179], v[72:75], v[144:147]
s_min_u32 s66, s66, s82
ds_read_b128 a[148:151], v3 offset:8192
v_cvt_pk_bf16_f32 v193, v138, v139
v_mfma_f32_16x16x32_bf16 v[148:151], a[192:195], v[72:75], v[228:231]
s_waitcnt lgkmcnt(2)
s_lshl1_add_u32 s66, s66, s83
v_exp_f32 v123, v123
v_mfma_f32_16x16x32_bf16 v[148:151], a[196:199], v[76:79], v[148:151]
s_lshl_b32 s80, s66, 8
v_exp_f32 v140, v140
v_mfma_f32_16x16x32_bf16 v[148:151], a[200:203], v[80:83], v[148:151]
s_add_u32 s80, s80, 8192
ds_read_b128 a[152:155], v3 offset:1024
v_cvt_pk_bf16_f32 v184, v120, v121
v_mfma_f32_16x16x32_bf16 v[148:151], a[204:207], v[84:87], v[148:151]
s_mov_b32 s36, s20
ds_read_b128 a[156:159], v3 offset:9216
v_cvt_pk_bf16_f32 v185, v122, v123
v_mfma_f32_16x16x32_bf16 v[132:135], a[204:207], v[68:71], v[132:135]
s_mov_b32 s37, s21
v_exp_f32 v141, v141
v_mfma_f32_16x16x32_bf16 v[132:135], a[200:203], v[64:67], v[132:135]
s_mov_b32 s38, 2097152
v_exp_f32 v142, v142
v_mfma_f32_16x16x32_bf16 v[132:135], a[196:199], v[60:63], v[132:135]
s_mov_b32 s40, s14
v_exp_f32 v143, v143
v_mfma_f32_16x16x32_bf16 v[132:135], a[192:195], v[56:59], v[132:135]
s_waitcnt lgkmcnt(2)
s_mov_b32 s41, s15
buffer_load_dwordx4 v16, s[32:35], s64 offen offset:1024 sc1 lds
v_mfma_f32_16x16x32_bf16 a[32:35], a[144:147], v[176:179], a[32:35]
s_mov_b32 s42, 8388608
ds_read_b128 a[160:163], v3 offset:2048
v_cvt_pk_bf16_f32 v194, v140, v141
v_mfma_f32_16x16x32_bf16 a[32:35], a[148:151], v[180:183], a[32:35]
s_lshl_b32 s66, s30, 11
ds_read_b128 a[164:167], v3 offset:10240
v_lshrrev_b32 v14, 4, v0
v_mfma_f32_16x16x32_bf16 a[64:67], a[148:151], v[204:207], a[64:67]
v_exp_f32 v124, v124
v_mfma_f32_16x16x32_bf16 a[64:67], a[144:147], v[200:203], a[64:67]
v_exp_f32 v125, v125
v_mfma_f32_16x16x32_bf16 a[96:99], a[144:147], v[208:211], a[96:99]
ds_read_b128 a[168:171], v3 offset:3072
v_bfe_u32 v12, v0, 1, 3
v_mfma_f32_16x16x32_bf16 a[96:99], a[148:151], v[212:215], a[96:99]
s_waitcnt lgkmcnt(3)
ds_read_b128 a[172:175], v3 offset:11264
v_xor_b32 v12, v12, v14
v_mfma_f32_16x16x32_bf16 a[100:103], a[156:159], v[212:215], a[100:103]
v_lshlrev_b32 v12, 5, v12
v_lshl_add_u32 v12, v14, 11, v12
v_mfma_f32_16x16x32_bf16 a[100:103], a[152:155], v[208:211], a[100:103]
v_and_b32 v14, 1, v0
v_lshl_add_u32 v12, v14, 4, v12
v_mfma_f32_16x16x32_bf16 a[68:71], a[152:155], v[200:203], a[68:71]
v_xor_b32 v13, 128, v12
v_add_u32 v14, s66, v16
v_mfma_f32_16x16x32_bf16 a[68:71], a[156:159], v[204:207], a[68:71]
v_xor_b32 v15, 0x800, v14
v_cvt_pk_bf16_f32 v195, v142, v143
v_mfma_f32_16x16x32_bf16 a[36:39], a[156:159], v[180:183], a[36:39]
v_exp_f32 v126, v126
v_mfma_f32_16x16x32_bf16 a[36:39], a[152:155], v[176:179], a[36:39]
s_waitcnt lgkmcnt(0)
buffer_load_dword v19, off, s[52:55], s80 sc1
v_mfma_f32_16x16x32_bf16 a[40:43], a[160:163], v[176:179], a[40:43]
buffer_load_dwordx4 v16, s[32:35], s64 offen offset:2048 sc1 lds
v_mfma_f32_16x16x32_bf16 a[40:43], a[164:167], v[180:183], a[40:43]
v_exp_f32 v127, v127
v_mfma_f32_16x16x32_bf16 a[72:75], a[164:167], v[204:207], a[72:75]
v_exp_f32 v128, v128
v_mfma_f32_16x16x32_bf16 a[72:75], a[160:163], v[200:203], a[72:75]
ds_read_b128 a[176:179], v3 offset:4096
v_cvt_pk_bf16_f32 v186, v124, v125
v_mfma_f32_16x16x32_bf16 a[104:107], a[160:163], v[208:211], a[104:107]
ds_read_b128 a[180:183], v3 offset:12288
v_cvt_pk_bf16_f32 v187, v126, v127
v_mfma_f32_16x16x32_bf16 a[104:107], a[164:167], v[212:215], a[104:107]
v_exp_f32 v129, v129
v_mfma_f32_16x16x32_bf16 a[108:111], a[172:175], v[212:215], a[108:111]
v_exp_f32 v130, v130
v_mfma_f32_16x16x32_bf16 a[108:111], a[168:171], v[208:211], a[108:111]
ds_read_b128 a[184:187], v3 offset:5120
v_cvt_pk_bf16_f32 v188, v128, v129
v_mfma_f32_16x16x32_bf16 a[76:79], a[168:171], v[200:203], a[76:79]
ds_read_b128 a[188:191], v3 offset:13312
v_accvgpr_read_b32 v20, a128
v_mfma_f32_16x16x32_bf16 a[76:79], a[172:175], v[204:207], a[76:79]
buffer_load_dwordx4 v16, s[32:35], s64 offen offset:3072 sc1 lds
v_mfma_f32_16x16x32_bf16 a[44:47], a[172:175], v[180:183], a[44:47]
v_exp_f32 v131, v131
v_mfma_f32_16x16x32_bf16 a[44:47], a[168:171], v[176:179], a[44:47]
s_waitcnt lgkmcnt(2)
v_exp_f32 v144, v144
v_mfma_f32_16x16x32_bf16 a[48:51], a[176:179], v[176:179], a[48:51]
v_exp_f32 v145, v145
v_mfma_f32_16x16x32_bf16 a[48:51], a[180:183], v[180:183], a[48:51]
ds_read_b128 a[192:195], v3 offset:6144
v_cvt_pk_bf16_f32 v189, v130, v131
v_mfma_f32_16x16x32_bf16 a[80:83], a[180:183], v[204:207], a[80:83]
ds_read_b128 a[196:199], v3 offset:14336
v_cvt_pk_bf16_f32 v196, v144, v145
v_mfma_f32_16x16x32_bf16 a[80:83], a[176:179], v[200:203], a[80:83]
v_exp_f32 v146, v146
v_mfma_f32_16x16x32_bf16 a[112:115], a[176:179], v[208:211], a[112:115]
ds_read_b128 a[200:203], v3 offset:7168
v_max_f32 v1, v1, v20
v_mfma_f32_16x16x32_bf16 a[112:115], a[180:183], v[212:215], a[112:115]
s_waitcnt lgkmcnt(3)
ds_read_b128 a[204:207], v3 offset:15360
v_mfma_f32_16x16x32_bf16 a[116:119], a[188:191], v[212:215], a[116:119]
v_exp_f32 v147, v147
v_mfma_f32_16x16x32_bf16 a[116:119], a[184:187], v[208:211], a[116:119]
s_waitcnt vmcnt(9)
s_barrier
v_mfma_f32_16x16x32_bf16 a[84:87], a[184:187], v[200:203], a[84:87]
v_exp_f32 v148, v148
v_mfma_f32_16x16x32_bf16 a[84:87], a[188:191], v[204:207], a[84:87]
v_exp_f32 v149, v149
v_mfma_f32_16x16x32_bf16 a[52:55], a[188:191], v[180:183], a[52:55]
v_exp_f32 v150, v150
v_mfma_f32_16x16x32_bf16 a[52:55], a[184:187], v[176:179], a[52:55]
s_waitcnt lgkmcnt(0)
v_exp_f32 v151, v151
v_mfma_f32_16x16x32_bf16 a[56:59], a[192:195], v[176:179], a[56:59]
v_exp_f32 v132, v132
v_mfma_f32_16x16x32_bf16 a[56:59], a[196:199], v[180:183], a[56:59]
s_add_u32 s17, s78, L_TAIL_14-L_pc+0
v_exp_f32 v133, v133
v_mfma_f32_16x16x32_bf16 a[88:91], a[196:199], v[204:207], a[88:91]
buffer_load_dword a252, v16, s[88:91], s17 offen
v_mfma_f32_16x16x32_bf16 a[88:91], a[192:195], v[200:203], a[88:91]
ds_read_b128 a[144:147], v2 offset:16384
v_cvt_pk_bf16_f32 v197, v146, v147
v_mfma_f32_16x16x32_bf16 a[120:123], a[192:195], v[208:211], a[120:123]
s_add_u32 s17, s78, L_TAIL_14-L_pc+4096
v_exp_f32 v134, v134
v_mfma_f32_16x16x32_bf16 a[120:123], a[196:199], v[212:215], a[120:123]
s_add_u32 m0, s86, 131072
ds_read_b128 a[148:151], v2 offset:17408
v_cvt_pk_bf16_f32 v198, v148, v149
v_mfma_f32_16x16x32_bf16 a[124:127], a[204:207], v[212:215], a[124:127]
s_add_u32 s64, s85, 0
ds_read_b128 a[152:155], v2 offset:18432
v_cvt_pk_bf16_f32 v199, v150, v151
v_mfma_f32_16x16x32_bf16 a[124:127], a[200:203], v[208:211], a[124:127]
buffer_load_dwordx4 v12, s[36:39], s64 offen lds
v_mfma_f32_16x16x32_bf16 a[92:95], a[200:203], v[200:203], a[92:95]
buffer_load_dword a252, v16, s[88:91], s17 offen
v_mfma_f32_16x16x32_bf16 a[92:95], a[204:207], v[204:207], a[92:95]
ds_read_b128 a[156:159], v2 offset:19456
v_cndmask_b32 v136, v228, v17, s[0:1]
v_mfma_f32_16x16x32_bf16 a[60:63], a[204:207], v[180:183], a[60:63]
v_cndmask_b32 v137, v228, v17, s[4:5]
v_cndmask_b32 v138, v228, v17, s[6:7]
v_mfma_f32_16x16x32_bf16 a[60:63], a[200:203], v[176:179], a[60:63]
v_cndmask_b32 v139, v228, v17, s[8:9]
v_cvt_pk_bf16_f32 v190, v132, v133
v_mfma_f32_16x16x32_bf16 a[132:135], a[244:247], v[176:179], a[132:135]
v_exp_f32 v135, v135
v_mfma_f32_16x16x32_bf16 a[132:135], a[244:247], v[180:183], a[132:135]
ds_read_b128 a[160:163], v2 offset:20480
v_cvt_pk_bf16_f32 v191, v134, v135
v_mfma_f32_16x16x32_bf16 a[136:139], a[244:247], v[200:203], a[136:139]
ds_read_b128 a[164:167], v2 offset:21504
v_cndmask_b32 v140, v228, v17, s[10:11]
v_mfma_f32_16x16x32_bf16 a[136:139], a[244:247], v[204:207], a[136:139]
s_add_u32 m0, s86, 132096
ds_read_b128 a[168:171], v2 offset:22528
v_cndmask_b32 v141, v228, v17, s[12:13]
v_mfma_f32_16x16x32_bf16 a[140:143], a[244:247], v[208:211], a[140:143]
s_add_u32 s64, s85, 8192
ds_read_b128 a[172:175], v2 offset:23552
v_cndmask_b32 v142, v228, v17, s[18:19]
v_mfma_f32_16x16x32_bf16 a[140:143], a[244:247], v[212:215], a[140:143]
s_waitcnt lgkmcnt(4)
s_add_u32 s17, s78, L_TAIL_14-L_pc+8192
buffer_load_dwordx4 v13, s[36:39], s64 offen lds
v_mfma_f32_16x16x32_bf16 v[136:139], a[144:147], v[72:75], v[136:139]
buffer_load_dword a252, v16, s[88:91], s17 offen
ds_read_b128 a[176:179], v2 offset:24576
v_mfma_f32_16x16x32_bf16 v[136:139], a[148:151], v[76:79], v[136:139]
ds_read_b128 a[180:183], v2 offset:25600
v_cndmask_b32 v143, v228, v17, s[22:23]
v_mfma_f32_16x16x32_bf16 v[136:139], a[152:155], v[80:83], v[136:139]
s_waitcnt vmcnt(7)
v_readfirstlane_b32 s66, v19
s_nop 0
s_cmp_lt_u32 s66, 16
s_cbranch_scc1 L_spin_1020
L_spinbk_1021:
ds_read_b128 a[184:187], v2 offset:26624
v_mfma_f32_16x16x32_bf16 v[136:139], a[156:159], v[84:87], v[136:139]
s_waitcnt lgkmcnt(3)
ds_read_b128 a[188:191], v2 offset:27648
v_cndmask_b32 v144, v228, v17, s[26:27]
v_mfma_f32_16x16x32_bf16 v[140:143], a[172:175], v[84:87], v[140:143]
ds_read_b128 a[192:195], v2 offset:28672
ds_read_b128 a[196:199], v2 offset:29696
ds_read_b128 a[200:203], v2 offset:30720
ds_read_b128 a[204:207], v2 offset:31744
v_cndmask_b32 v145, v228, v17, s[56:57]
v_mfma_f32_16x16x32_bf16 v[140:143], a[168:171], v[80:83], v[140:143]
v_cndmask_b32 v146, v228, v17, s[58:59]
v_cndmask_b32 v147, v228, v17, s[60:61]
v_mfma_f32_16x16x32_bf16 v[140:143], a[164:167], v[76:79], v[140:143]
ds_read_b128 a[144:147], v3 offset:16384
v_cndmask_b32 v148, v228, v17, s[62:63]
v_mfma_f32_16x16x32_bf16 v[140:143], a[160:163], v[72:75], v[140:143]
s_waitcnt lgkmcnt(7)
v_cndmask_b32 v149, v228, v17, s[48:49]
v_cndmask_b32 v150, v228, v17, s[50:51]
v_mfma_f32_16x16x32_bf16 v[144:147], a[176:179], v[72:75], v[144:147]
ds_read_b128 a[148:151], v3 offset:24576
v_cndmask_b32 v151, v228, v17, s[100:101]
v_mfma_f32_16x16x32_bf16 v[144:147], a[180:183], v[76:79], v[144:147]
s_waitcnt lgkmcnt(6)
ds_read_b128 a[152:155], v3 offset:17408
v_xor_b32 v2, 0x8000, v2
v_mfma_f32_16x16x32_bf16 v[144:147], a[184:187], v[80:83], v[144:147]
v_exp_f32 v136, v136
v_mfma_f32_16x16x32_bf16 v[144:147], a[188:191], v[84:87], v[144:147]
s_waitcnt lgkmcnt(3)
v_exp_f32 v137, v137
v_mfma_f32_16x16x32_bf16 v[148:151], a[204:207], v[84:87], v[148:151]
ds_read_b128 a[156:159], v3 offset:25600
v_cvt_pk_bf16_f32 v208, v136, v137
v_mfma_f32_16x16x32_bf16 v[148:151], a[200:203], v[80:83], v[148:151]
v_exp_f32 v138, v138
v_mfma_f32_16x16x32_bf16 v[148:151], a[196:199], v[76:79], v[148:151]
ds_read_b128 a[160:163], v3 offset:18432
v_mfma_f32_16x16x32_bf16 v[148:151], a[192:195], v[72:75], v[148:151]
s_waitcnt lgkmcnt(2)
ds_read_b128 a[164:167], v3 offset:26624
v_mfma_f32_16x16x32_bf16 a[64:67], a[144:147], v[184:187], a[64:67]
v_exp_f32 v139, v139
v_mfma_f32_16x16x32_bf16 a[64:67], a[148:151], v[188:191], a[64:67]
v_rcp_f32 v20, v20
v_mfma_f32_16x16x32_bf16 a[96:99], a[148:151], v[196:199], a[96:99]
v_accvgpr_read_b32 v232, a0
v_accvgpr_read_b32 v233, a1
v_mfma_f32_16x16x32_bf16 a[96:99], a[144:147], v[192:195], a[96:99]
v_accvgpr_read_b32 v234, a2
v_accvgpr_read_b32 v235, a3
v_mfma_f32_16x16x32_bf16 a[100:103], a[152:155], v[192:195], a[100:103]
s_waitcnt lgkmcnt(1)
ds_read_b128 a[168:171], v3 offset:19456
v_accvgpr_read_b32 v236, a4
v_accvgpr_read_b32 v237, a5
v_accvgpr_read_b32 v238, a6
v_accvgpr_read_b32 v239, a7
v_mul_f32 v20, v20, v4
s_add_u32 s77, s74, 0
v_mul_f32 v232, v232, v20
v_mul_f32 v233, v233, v20
v_mul_f32 v234, v234, v20
v_mul_f32 v235, v235, v20
v_mul_f32 v236, v236, v20
v_mul_f32 v237, v237, v20
v_mul_f32 v238, v238, v20
v_mul_f32 v239, v239, v20
v_cvt_pk_bf16_f32 v232, v232, v233
v_cvt_pk_bf16_f32 v233, v234, v235
v_cvt_pk_bf16_f32 v234, v236, v237
v_cvt_pk_bf16_f32 v235, v238, v239
buffer_store_dwordx4 v[232:235], v16, s[44:47], s77 offen sc1
v_accvgpr_read_b32 v240, a8
v_accvgpr_read_b32 v241, a9
v_accvgpr_read_b32 v242, a10
v_accvgpr_read_b32 v243, a11
v_accvgpr_read_b32 v244, a12
v_accvgpr_read_b32 v245, a13
v_accvgpr_read_b32 v246, a14
v_accvgpr_read_b32 v247, a15
s_add_u32 s77, s74, 8192
v_mul_f32 v240, v240, v20
v_mul_f32 v241, v241, v20
v_mul_f32 v242, v242, v20
v_mul_f32 v243, v243, v20
v_mul_f32 v244, v244, v20
v_mul_f32 v245, v245, v20
v_mul_f32 v246, v246, v20
v_mul_f32 v247, v247, v20
v_cvt_pk_bf16_f32 v240, v240, v241
v_cvt_pk_bf16_f32 v241, v242, v243
v_cvt_pk_bf16_f32 v242, v244, v245
v_cvt_pk_bf16_f32 v243, v246, v247
buffer_store_dwordx4 v[240:243], v16, s[44:47], s77 offen sc1
v_accvgpr_read_b32 v232, a16
v_accvgpr_read_b32 v233, a17
v_accvgpr_read_b32 v234, a18
v_accvgpr_read_b32 v235, a19
v_accvgpr_read_b32 v236, a20
v_accvgpr_read_b32 v237, a21
v_accvgpr_read_b32 v238, a22
v_accvgpr_read_b32 v239, a23
s_add_u32 s77, s74, 16384
v_mul_f32 v232, v232, v20
v_mul_f32 v233, v233, v20
v_mul_f32 v234, v234, v20
v_mul_f32 v235, v235, v20
v_mul_f32 v236, v236, v20
v_mul_f32 v237, v237, v20
v_mul_f32 v238, v238, v20
v_mul_f32 v239, v239, v20
v_cvt_pk_bf16_f32 v232, v232, v233
v_cvt_pk_bf16_f32 v233, v234, v235
v_cvt_pk_bf16_f32 v234, v236, v237
v_cvt_pk_bf16_f32 v235, v238, v239
buffer_store_dwordx4 v[232:235], v16, s[44:47], s77 offen sc1
v_accvgpr_read_b32 v240, a24
v_accvgpr_read_b32 v241, a25
v_accvgpr_read_b32 v242, a26
v_accvgpr_read_b32 v243, a27
v_accvgpr_read_b32 v244, a28
v_accvgpr_read_b32 v245, a29
v_accvgpr_read_b32 v246, a30
v_accvgpr_read_b32 v247, a31
s_add_u32 s77, s74, 24576
v_mul_f32 v240, v240, v20
v_mul_f32 v241, v241, v20
v_mul_f32 v242, v242, v20
v_mul_f32 v243, v243, v20
v_mul_f32 v244, v244, v20
v_mul_f32 v245, v245, v20
v_mul_f32 v246, v246, v20
v_mul_f32 v247, v247, v20
v_cvt_pk_bf16_f32 v240, v240, v241
v_cvt_pk_bf16_f32 v241, v242, v243
v_cvt_pk_bf16_f32 v242, v244, v245
v_cvt_pk_bf16_f32 v243, v246, v247
buffer_store_dwordx4 v[240:243], v16, s[44:47], s77 offen sc1
v_mfma_f32_16x16x32_bf16 a[100:103], a[156:159], v[196:199], a[100:103]
ds_read_b128 a[172:175], v3 offset:27648
v_exp_f32 v140, v140
v_mfma_f32_16x16x32_bf16 a[68:71], a[156:159], v[188:191], a[68:71]
s_add_u32 m0, s86, 133120
v_exp_f32 v141, v141
v_mfma_f32_16x16x32_bf16 a[68:71], a[152:155], v[184:187], a[68:71]
s_add_u32 s64, s85, 16384
ds_read_b128 a[176:179], v3 offset:20480
v_cvt_pk_bf16_f32 v209, v138, v139
v_mfma_f32_16x16x32_bf16 a[72:75], a[160:163], v[184:187], a[72:75]
s_waitcnt lgkmcnt(3)
buffer_load_dwordx4 v12, s[36:39], s64 offen lds
v_mfma_f32_16x16x32_bf16 a[72:75], a[164:167], v[188:191], a[72:75]
s_add_u32 m0, s86, 134144
ds_read_b128 a[180:183], v3 offset:28672
v_accvgpr_read_b32 v21, a132
v_mfma_f32_16x16x32_bf16 a[104:107], a[164:167], v[196:199], a[104:107]
s_add_u32 s64, s85, 24576
v_exp_f32 v142, v142
v_mfma_f32_16x16x32_bf16 a[104:107], a[160:163], v[192:195], a[104:107]
s_waitcnt lgkmcnt(2)
buffer_load_dwordx4 v13, s[36:39], s64 offen lds
v_mfma_f32_16x16x32_bf16 a[108:111], a[168:171], v[192:195], a[108:111]
s_add_u32 m0, s86, 135168
s_add_u32 s64, s85, 32768
ds_read_b128 a[184:187], v3 offset:21504
v_max_f32 v1, v1, v21
v_mfma_f32_16x16x32_bf16 a[108:111], a[172:175], v[196:199], a[108:111]
buffer_load_dwordx4 v12, s[36:39], s64 offen lds
ds_read_b128 a[188:191], v3 offset:29696
v_exp_f32 v143, v143
v_mfma_f32_16x16x32_bf16 a[76:79], a[172:175], v[188:191], a[76:79]
s_add_u32 m0, s86, 136192
s_add_u32 s64, s85, 40960
v_rcp_f32 v21, v21
v_accvgpr_read_b32 v232, a32
v_accvgpr_read_b32 v233, a33
v_accvgpr_read_b32 v234, a34
v_accvgpr_read_b32 v235, a35
v_accvgpr_read_b32 v236, a36
v_accvgpr_read_b32 v237, a37
v_accvgpr_read_b32 v238, a38
v_accvgpr_read_b32 v239, a39
v_mul_f32 v21, v21, v6
s_add_u32 s77, s74, 4096
v_mul_f32 v232, v232, v21
v_mul_f32 v233, v233, v21
v_mul_f32 v234, v234, v21
v_mul_f32 v235, v235, v21
v_mul_f32 v236, v236, v21
v_mul_f32 v237, v237, v21
v_mul_f32 v238, v238, v21
v_mul_f32 v239, v239, v21
v_cvt_pk_bf16_f32 v232, v232, v233
v_cvt_pk_bf16_f32 v233, v234, v235
v_cvt_pk_bf16_f32 v234, v236, v237
v_cvt_pk_bf16_f32 v235, v238, v239
buffer_store_dwordx4 v[232:235], v16, s[44:47], s77 offen sc1
v_accvgpr_read_b32 v240, a40
v_accvgpr_read_b32 v241, a41
v_accvgpr_read_b32 v242, a42
v_accvgpr_read_b32 v243, a43
v_accvgpr_read_b32 v244, a44
v_accvgpr_read_b32 v245, a45
v_accvgpr_read_b32 v246, a46
v_accvgpr_read_b32 v247, a47
s_add_u32 s77, s74, 12288
v_mul_f32 v240, v240, v21
v_mul_f32 v241, v241, v21
v_mul_f32 v242, v242, v21
v_mul_f32 v243, v243, v21
v_mul_f32 v244, v244, v21
v_mul_f32 v245, v245, v21
v_mul_f32 v246, v246, v21
v_mul_f32 v247, v247, v21
v_cvt_pk_bf16_f32 v240, v240, v241
v_cvt_pk_bf16_f32 v241, v242, v243
v_cvt_pk_bf16_f32 v242, v244, v245
v_cvt_pk_bf16_f32 v243, v246, v247
buffer_store_dwordx4 v[240:243], v16, s[44:47], s77 offen sc1
v_accvgpr_read_b32 v232, a48
v_accvgpr_read_b32 v233, a49
v_accvgpr_read_b32 v234, a50
v_accvgpr_read_b32 v235, a51
v_accvgpr_read_b32 v236, a52
v_accvgpr_read_b32 v237, a53
v_accvgpr_read_b32 v238, a54
v_accvgpr_read_b32 v239, a55
s_add_u32 s77, s74, 20480
v_mul_f32 v232, v232, v21
v_mul_f32 v233, v233, v21
v_mul_f32 v234, v234, v21
v_mul_f32 v235, v235, v21
v_mul_f32 v236, v236, v21
v_mul_f32 v237, v237, v21
v_mul_f32 v238, v238, v21
v_mul_f32 v239, v239, v21
v_cvt_pk_bf16_f32 v232, v232, v233
v_cvt_pk_bf16_f32 v233, v234, v235
v_cvt_pk_bf16_f32 v234, v236, v237
v_cvt_pk_bf16_f32 v235, v238, v239
buffer_store_dwordx4 v[232:235], v16, s[44:47], s77 offen sc1
v_accvgpr_read_b32 v240, a56
v_accvgpr_read_b32 v241, a57
v_accvgpr_read_b32 v242, a58
v_accvgpr_read_b32 v243, a59
v_accvgpr_read_b32 v244, a60
v_accvgpr_read_b32 v245, a61
v_accvgpr_read_b32 v246, a62
v_accvgpr_read_b32 v247, a63
s_add_u32 s77, s74, 28672
v_mul_f32 v240, v240, v21
v_mul_f32 v241, v241, v21
v_mul_f32 v242, v242, v21
v_mul_f32 v243, v243, v21
v_mul_f32 v244, v244, v21
v_mul_f32 v245, v245, v21
v_mul_f32 v246, v246, v21
v_mul_f32 v247, v247, v21
v_cvt_pk_bf16_f32 v240, v240, v241
v_cvt_pk_bf16_f32 v241, v242, v243
v_cvt_pk_bf16_f32 v242, v244, v245
v_cvt_pk_bf16_f32 v243, v246, v247
buffer_store_dwordx4 v[240:243], v16, s[44:47], s77 offen sc1
v_mfma_f32_16x16x32_bf16 a[76:79], a[168:171], v[184:187], a[76:79]
s_waitcnt lgkmcnt(2)
buffer_load_dwordx4 v13, s[36:39], s64 offen lds
v_cvt_pk_bf16_f32 v210, v140, v141
v_exp_f32 v144, v144
v_mfma_f32_16x16x32_bf16 a[80:83], a[176:179], v[184:187], a[80:83]
s_add_u32 m0, s86, 137216
s_add_u32 s64, s85, 49152
ds_read_b128 a[192:195], v3 offset:22528
v_cvt_pk_bf16_f32 v211, v142, v143
v_mfma_f32_16x16x32_bf16 a[80:83], a[180:183], v[188:191], a[80:83]
buffer_load_dwordx4 v12, s[36:39], s64 offen lds
ds_read_b128 a[196:199], v3 offset:30720
v_mfma_f32_16x16x32_bf16 a[112:115], a[180:183], v[196:199], a[112:115]
s_add_u32 m0, s86, 138240
s_add_u32 s64, s85, 57344
v_exp_f32 v145, v145
v_mfma_f32_16x16x32_bf16 a[112:115], a[176:179], v[192:195], a[112:115]
s_waitcnt lgkmcnt(2)
buffer_load_dwordx4 v13, s[36:39], s64 offen lds
v_mfma_f32_16x16x32_bf16 a[116:119], a[184:187], v[192:195], a[116:119]
s_add_u32 s65, s84, 0
ds_read_b128 a[200:203], v3 offset:23552
v_exp_f32 v146, v146
v_mfma_f32_16x16x32_bf16 a[116:119], a[188:191], v[196:199], a[116:119]
buffer_load_dwordx4 a[208:211], v14, s[44:47], s65 offen offset:0 sc1
ds_read_b128 a[204:207], v3 offset:31744
v_mfma_f32_16x16x32_bf16 a[84:87], a[188:191], v[188:191], a[84:87]
s_waitcnt vmcnt(20)
s_barrier
v_xor_b32 v3, 0x8000, v3
v_mfma_f32_16x16x32_bf16 a[84:87], a[184:187], v[184:187], a[84:87]
s_waitcnt lgkmcnt(2)
buffer_load_dwordx4 a[216:219], v14, s[44:47], s65 offen offset:1024 sc1
v_exp_f32 v147, v147
v_mfma_f32_16x16x32_bf16 a[88:91], a[192:195], v[184:187], a[88:91]
v_exp_f32 v148, v148
v_mfma_f32_16x16x32_bf16 a[88:91], a[196:199], v[188:191], a[88:91]
buffer_load_dwordx4 a[224:227], v15, s[44:47], s65 offen offset:0 sc1
v_mfma_f32_16x16x32_bf16 a[120:123], a[196:199], v[196:199], a[120:123]
ds_read_b128 a[144:147], v3 offset:0
v_cvt_pk_bf16_f32 v212, v144, v145
v_mfma_f32_16x16x32_bf16 a[120:123], a[192:195], v[192:195], a[120:123]
s_waitcnt lgkmcnt(1)
buffer_load_dwordx4 a[232:235], v15, s[44:47], s65 offen offset:1024 sc1
v_mfma_f32_16x16x32_bf16 a[124:127], a[200:203], v[192:195], a[124:127]
s_add_u32 s65, s84, 8192
v_exp_f32 v149, v149
v_mfma_f32_16x16x32_bf16 a[124:127], a[204:207], v[196:199], a[124:127]
buffer_load_dwordx4 a[212:215], v14, s[44:47], s65 offen offset:0 sc1
v_mfma_f32_16x16x32_bf16 a[92:95], a[204:207], v[188:191], a[92:95]
v_exp_f32 v150, v150
v_mfma_f32_16x16x32_bf16 a[92:95], a[200:203], v[184:187], a[92:95]
buffer_load_dwordx4 a[220:223], v14, s[44:47], s65 offen offset:1024 sc1
ds_read_b128 a[148:151], v3 offset:8192
v_cvt_pk_bf16_f32 v213, v146, v147
v_mfma_f32_16x16x32_bf16 a[136:139], a[244:247], v[184:187], a[136:139]
ds_read_b128 a[152:155], v3 offset:1024
v_cvt_pk_bf16_f32 v214, v148, v149
v_mfma_f32_16x16x32_bf16 a[136:139], a[244:247], v[188:191], a[136:139]
buffer_load_dwordx4 a[228:231], v15, s[44:47], s65 offen offset:0 sc1
ds_read_b128 a[156:159], v3 offset:9216
v_mfma_f32_16x16x32_bf16 a[140:143], a[244:247], v[192:195], a[140:143]
v_exp_f32 v151, v151
v_mfma_f32_16x16x32_bf16 a[140:143], a[244:247], v[196:199], a[140:143]
buffer_load_dwordx4 a[236:239], v15, s[44:47], s65 offen offset:1024 sc1
ds_read_b128 a[160:163], v3 offset:2048
ds_read_b128 a[164:167], v3 offset:10240
ds_read_b128 a[168:171], v3 offset:3072
ds_read_b128 a[172:175], v3 offset:11264
v_cvt_pk_bf16_f32 v215, v150, v151
s_branch L_TAIL_14
L_fallback_19:
s_waitcnt vmcnt(0) lgkmcnt(0)
s_barrier
s_mov_b32 s73, 1
s_mov_b32 s81, 0
v_and_b32 v232, 15, v0
v_lshrrev_b32 v233, 4, v0
v_lshlrev_b32 v233, 2, v233
v_sub_u32 v232, v232, v233
s_lshl_b32 s66, s30, 4
v_add_u32 v232, s66, v232
s_lshl_b32 s66, s16, 7
v_add_u32 v234, s66, v232
s_lshl_b32 s66, s3, 7
v_add_u32 v232, s66, v232
v_add_u32 v233, 64, v232
v_add_u32 v235, 64, v234
s_mov_b32 m0, s76
s_lshl_b32 s64, s30, 14
s_nop 0
buffer_load_dwordx4 v16, s[32:35], s64 offen offset:0 sc1 lds
s_nop 0
buffer_load_dwordx4 v16, s[32:35], s64 offen offset:1024 sc1 lds
s_nop 0
buffer_load_dwordx4 v16, s[32:35], s64 offen offset:2048 sc1 lds
s_nop 0
buffer_load_dwordx4 v16, s[32:35], s64 offen offset:3072 sc1 lds
s_add_u32 m0, s76, 4096
s_add_u32 s64, s64, 4096
s_nop 0
buffer_load_dwordx4 v16, s[32:35], s64 offen offset:0 sc1 lds
s_nop 0
buffer_load_dwordx4 v16, s[32:35], s64 offen offset:1024 sc1 lds
s_nop 0
buffer_load_dwordx4 v16, s[32:35], s64 offen offset:2048 sc1 lds
s_nop 0
buffer_load_dwordx4 v16, s[32:35], s64 offen offset:3072 sc1 lds
s_lshr_b32 s64, s76, 1
s_add_u32 m0, s64, 81920
s_and_b32 s69, s64, 8192
s_add_u32 s64, s64, s69
s_add_u32 s64, s64, 8192
s_nop 0
buffer_load_dwordx4 v16, s[32:35], s64 offen offset:0 sc1 lds
s_nop 0
buffer_load_dwordx4 v16, s[32:35], s64 offen offset:1024 sc1 lds
s_nop 0
buffer_load_dwordx4 v16, s[32:35], s64 offen offset:2048 sc1 lds
s_nop 0
buffer_load_dwordx4 v16, s[32:35], s64 offen offset:3072 sc1 lds
v_mov_b32 v20, 0xff800000
v_mov_b32 v21, 0xff800000
v_mov_b32 v22, 0xff800000
v_mov_b32 v23, 0xff800000
L_fbl_1023:
buffer_load_dwordx4 a[144:147], v16, s[32:35], s81 offen offset:0 sc1
buffer_load_dwordx4 a[148:151], v16, s[32:35], s81 offen offset:1024 sc1
buffer_load_dwordx4 a[152:155], v16, s[32:35], s81 offen offset:2048 sc1
buffer_load_dwordx4 a[156:159], v16, s[32:35], s81 offen offset:3072 sc1
s_add_u32 s64, s81, 4096
buffer_load_dwordx4 a[160:163], v16, s[32:35], s64 offen offset:0 sc1
buffer_load_dwordx4 a[164:167], v16, s[32:35], s64 offen offset:1024 sc1
buffer_load_dwordx4 a[168:171], v16, s[32:35], s64 offen offset:2048 sc1
buffer_load_dwordx4 a[172:175], v16, s[32:35], s64 offen offset:3072 sc1
v_subrev_u32 v88, 0, v232
v_ashrrev_i32 v88, 31, v88
v_and_b32 v88, 0xff800000, v88
v_subrev_u32 v89, 1, v232
v_ashrrev_i32 v89, 31, v89
v_and_b32 v89, 0xff800000, v89
v_subrev_u32 v90, 2, v232
v_ashrrev_i32 v90, 31, v90
v_and_b32 v90, 0xff800000, v90
v_subrev_u32 v91, 3, v232
v_ashrrev_i32 v91, 31, v91
v_and_b32 v91, 0xff800000, v91
v_subrev_u32 v92, 16, v232
v_ashrrev_i32 v92, 31, v92
v_and_b32 v92, 0xff800000, v92
v_subrev_u32 v93, 17, v232
v_ashrrev_i32 v93, 31, v93
v_and_b32 v93, 0xff800000, v93
v_subrev_u32 v94, 18, v232
v_ashrrev_i32 v94, 31, v94
v_and_b32 v94, 0xff800000, v94
v_subrev_u32 v95, 19, v232
v_ashrrev_i32 v95, 31, v95
v_and_b32 v95, 0xff800000, v95
v_subrev_u32 v232, 32, v232
v_subrev_u32 v104, 0, v233
v_ashrrev_i32 v104, 31, v104
v_and_b32 v104, 0xff800000, v104
v_subrev_u32 v105, 1, v233
v_ashrrev_i32 v105, 31, v105
v_and_b32 v105, 0xff800000, v105
v_subrev_u32 v106, 2, v233
v_ashrrev_i32 v106, 31, v106
v_and_b32 v106, 0xff800000, v106
v_subrev_u32 v107, 3, v233
v_ashrrev_i32 v107, 31, v107
v_and_b32 v107, 0xff800000, v107
v_subrev_u32 v108, 16, v233
v_ashrrev_i32 v108, 31, v108
v_and_b32 v108, 0xff800000, v108
v_subrev_u32 v109, 17, v233
v_ashrrev_i32 v109, 31, v109
v_and_b32 v109, 0xff800000, v109
v_subrev_u32 v110, 18, v233
v_ashrrev_i32 v110, 31, v110
v_and_b32 v110, 0xff800000, v110
v_subrev_u32 v111, 19, v233
v_ashrrev_i32 v111, 31, v111
v_and_b32 v111, 0xff800000, v111
v_subrev_u32 v233, 32, v233
v_subrev_u32 v120, 0, v234
v_ashrrev_i32 v120, 31, v120
v_and_b32 v120, 0xff800000, v120
v_subrev_u32 v121, 1, v234
v_ashrrev_i32 v121, 31, v121
v_and_b32 v121, 0xff800000, v121
v_subrev_u32 v122, 2, v234
v_ashrrev_i32 v122, 31, v122
v_and_b32 v122, 0xff800000, v122
v_subrev_u32 v123, 3, v234
v_ashrrev_i32 v123, 31, v123
v_and_b32 v123, 0xff800000, v123
v_subrev_u32 v124, 16, v234
v_ashrrev_i32 v124, 31, v124
v_and_b32 v124, 0xff800000, v124
v_subrev_u32 v125, 17, v234
v_ashrrev_i32 v125, 31, v125
v_and_b32 v125, 0xff800000, v125
v_subrev_u32 v126, 18, v234
v_ashrrev_i32 v126, 31, v126
v_and_b32 v126, 0xff800000, v126
v_subrev_u32 v127, 19, v234
v_ashrrev_i32 v127, 31, v127
v_and_b32 v127, 0xff800000, v127
v_subrev_u32 v234, 32, v234
v_subrev_u32 v136, 0, v235
v_ashrrev_i32 v136, 31, v136
v_and_b32 v136, 0xff800000, v136
v_subrev_u32 v137, 1, v235
v_ashrrev_i32 v137, 31, v137
v_and_b32 v137, 0xff800000, v137
v_subrev_u32 v138, 2, v235
v_ashrrev_i32 v138, 31, v138
v_and_b32 v138, 0xff800000, v138
v_subrev_u32 v139, 3, v235
v_ashrrev_i32 v139, 31, v139
v_and_b32 v139, 0xff800000, v139
v_subrev_u32 v140, 16, v235
v_ashrrev_i32 v140, 31, v140
v_and_b32 v140, 0xff800000, v140
v_subrev_u32 v141, 17, v235
v_ashrrev_i32 v141, 31, v141
v_and_b32 v141, 0xff800000, v141
v_subrev_u32 v142, 18, v235
v_ashrrev_i32 v142, 31, v142
v_and_b32 v142, 0xff800000, v142
v_subrev_u32 v143, 19, v235
v_ashrrev_i32 v143, 31, v143
v_and_b32 v143, 0xff800000, v143
v_subrev_u32 v235, 32, v235
s_waitcnt vmcnt(0)
v_mfma_f32_16x16x32_bf16 v[88:91], a[144:147], v[24:27], v[88:91]
v_mfma_f32_16x16x32_bf16 v[104:107], a[144:147], v[40:43], v[104:107]
v_mfma_f32_16x16x32_bf16 v[120:123], a[144:147], v[56:59], v[120:123]
v_mfma_f32_16x16x32_bf16 v[136:139], a[144:147], v[72:75], v[136:139]
v_mfma_f32_16x16x32_bf16 v[88:91], a[148:151], v[28:31], v[88:91]
v_mfma_f32_16x16x32_bf16 v[104:107], a[148:151], v[44:47], v[104:107]
v_mfma_f32_16x16x32_bf16 v[120:123], a[148:151], v[60:63], v[120:123]
v_mfma_f32_16x16x32_bf16 v[136:139], a[148:151], v[76:79], v[136:139]
v_mfma_f32_16x16x32_bf16 v[88:91], a[152:155], v[32:35], v[88:91]
v_mfma_f32_16x16x32_bf16 v[104:107], a[152:155], v[48:51], v[104:107]
v_mfma_f32_16x16x32_bf16 v[120:123], a[152:155], v[64:67], v[120:123]
v_mfma_f32_16x16x32_bf16 v[136:139], a[152:155], v[80:83], v[136:139]
v_mfma_f32_16x16x32_bf16 v[88:91], a[156:159], v[36:39], v[88:91]
v_mfma_f32_16x16x32_bf16 v[104:107], a[156:159], v[52:55], v[104:107]
v_mfma_f32_16x16x32_bf16 v[120:123], a[156:159], v[68:71], v[120:123]
v_mfma_f32_16x16x32_bf16 v[136:139], a[156:159], v[84:87], v[136:139]
v_mfma_f32_16x16x32_bf16 v[92:95], a[160:163], v[24:27], v[92:95]
v_mfma_f32_16x16x32_bf16 v[108:111], a[160:163], v[40:43], v[108:111]
v_mfma_f32_16x16x32_bf16 v[124:127], a[160:163], v[56:59], v[124:127]
v_mfma_f32_16x16x32_bf16 v[140:143], a[160:163], v[72:75], v[140:143]
v_mfma_f32_16x16x32_bf16 v[92:95], a[164:167], v[28:31], v[92:95]
v_mfma_f32_16x16x32_bf16 v[108:111], a[164:167], v[44:47], v[108:111]
v_mfma_f32_16x16x32_bf16 v[124:127], a[164:167], v[60:63], v[124:127]
v_mfma_f32_16x16x32_bf16 v[140:143], a[164:167], v[76:79], v[140:143]
v_mfma_f32_16x16x32_bf16 v[92:95], a[168:171], v[32:35], v[92:95]
v_mfma_f32_16x16x32_bf16 v[108:111], a[168:171], v[48:51], v[108:111]
v_mfma_f32_16x16x32_bf16 v[124:127], a[168:171], v[64:67], v[124:127]
v_mfma_f32_16x16x32_bf16 v[140:143], a[168:171], v[80:83], v[140:143]
v_mfma_f32_16x16x32_bf16 v[92:95], a[172:175], v[36:39], v[92:95]
v_mfma_f32_16x16x32_bf16 v[108:111], a[172:175], v[52:55], v[108:111]
v_mfma_f32_16x16x32_bf16 v[124:127], a[172:175], v[68:71], v[124:127]
v_mfma_f32_16x16x32_bf16 v[140:143], a[172:175], v[84:87], v[140:143]
s_nop 7
v_max3_f32 v20, v20, v88, v89
v_max3_f32 v20, v20, v90, v91
v_max3_f32 v20, v20, v92, v93
v_max3_f32 v20, v20, v94, v95
v_max3_f32 v21, v21, v104, v105
v_max3_f32 v21, v21, v106, v107
v_max3_f32 v21, v21, v108, v109
v_max3_f32 v21, v21, v110, v111
v_max3_f32 v22, v22, v120, v121
v_max3_f32 v22, v22, v122, v123
v_max3_f32 v22, v22, v124, v125
v_max3_f32 v22, v22, v126, v127
v_max3_f32 v23, v23, v136, v137
v_max3_f32 v23, v23, v138, v139
v_max3_f32 v23, v23, v140, v141
v_max3_f32 v23, v23, v142, v143
s_add_u32 s81, s81, 16384
s_cmp_lt_u32 s81, s34
s_cbranch_scc1 L_fbl_1023
v_mov_b32 v248, v20
v_mov_b32 v249, v21
v_mov_b32 v250, v22
v_mov_b32 v251, v23
v_permlane16_swap_b32 v248, v20
v_permlane16_swap_b32 v249, v21
v_permlane16_swap_b32 v250, v22
v_permlane16_swap_b32 v251, v23
v_max_f32 v20, v20, v248
v_max_f32 v21, v21, v249
v_max_f32 v22, v22, v250
v_max_f32 v23, v23, v251
v_mov_b32 v248, v20
v_mov_b32 v249, v21
v_mov_b32 v250, v22
v_mov_b32 v251, v23
v_permlane32_swap_b32 v248, v20
v_permlane32_swap_b32 v249, v21
v_permlane32_swap_b32 v250, v22
v_permlane32_swap_b32 v251, v23
v_max_f32 v20, v20, v248
v_max_f32 v21, v21, v249
v_max_f32 v22, v22, v250
v_max_f32 v23, v23, v251
v_mov_b32 v252, v20
v_mov_b32 v253, v21
v_mov_b32 v254, v22
v_mov_b32 v255, v23
s_branch L_attstart_15
L_spin_2024:
s_mov_b32 s67, 0x8000
L_spinlp_2026:
s_sleep 1
buffer_load_dword v19, off, s[52:55], s72 offset:0 sc1
s_waitcnt vmcnt(0)
v_readfirstlane_b32 s66, v19
s_sub_u32 s67, s67, 1
s_cbranch_scc1 L_spinbk_2025
s_cmp_lt_u32 s66, 16
s_cbranch_scc1 L_spinlp_2026
s_branch L_spinbk_2025
L_spin_2028:
s_mov_b32 s67, 0x8000
L_spinlp_2030:
s_sleep 1
buffer_load_dword v19, off, s[52:55], s72 offset:0 sc1
s_waitcnt vmcnt(0)
v_readfirstlane_b32 s66, v19
s_sub_u32 s67, s67, 1
s_cbranch_scc1 L_spinbk_2029
s_cmp_lt_u32 s66, 1
s_cbranch_scc1 L_spinlp_2030
s_branch L_spinbk_2029
L_codeend:
.section .rodata,"a"
.p2align 6
.amdhsa_kernel gated_mix__compressed_kv_cla__sliding_local_dilated__prompt_kernel
  .amdhsa_next_free_vgpr 512
  .amdhsa_next_free_sgpr 102
  .amdhsa_accum_offset 256
  .amdhsa_group_segment_fixed_size 0
  .amdhsa_kernarg_size 104
  .amdhsa_user_sgpr_count 2
  .amdhsa_user_sgpr_kernarg_segment_ptr 1
  .amdhsa_system_sgpr_workgroup_id_x 1
.end_amdhsa_kernel
```

```asm
; @launch grid=(256,1,1) block=(256,1,1) lds=163840
.amdgcn_target "amdgcn-amd-amdhsa--gfx950"
.text
.globl gated_mix__compressed_kv_cla__sliding_local_dilated__prompt_kernel
.p2align 8
.type gated_mix__compressed_kv_cla__sliding_local_dilated__prompt_kernel,@function
gated_mix__compressed_kv_cla__sliding_local_dilated__prompt_kernel:
s_cmp_ge_u32 s2, 256
s_cbranch_scc1 L_end
s_load_dwordx16 s[4:19], s[0:1], 0
s_load_dwordx8 s[20:27], s[0:1], 64
s_load_dwordx2 s[28:29], s[0:1], 96
s_getpc_b64 s[88:89]
L_pc:
v_lshrrev_b32 v1, 6, v0
s_lshr_b32 s67, s2, 3
v_lshl_add_u32 v24, s67, 2, v1
s_mov_b32 s90, L_codeend-L_pc
s_mov_b32 s91, 0x20000
v_and_b32 v25, 7, v0
v_lshlrev_b32 v25, 7, v25
v_lshl_add_u32 v24, v24, 10, v25
buffer_load_dword a252, v24, s[88:91], 0 offen
v_and_b32 v0, 63, v0
v_readfirstlane_b32 s30, v1
v_lshrrev_b32 v24, 3, v0
v_lshrrev_b32 v25, 4, v0
v_and_b32 v26, 7, v0
v_xor_b32 v26, v26, v25
v_lshlrev_b32 v26, 4, v26
v_lshl_add_u32 v12, v24, 10, v26
v_xor_b32 v13, 64, v12
v_bfe_u32 v26, v0, 1, 3
v_xor_b32 v26, v26, v25
v_lshlrev_b32 v26, 5, v26
v_and_b32 v24, 1, v0
v_lshl_add_u32 v26, v24, 4, v26
v_lshl_add_u32 v14, v25, 13, v26
v_xor_b32 v15, 128, v14
s_and_b32 s66, s2, 7
s_and_b32 s68, s67, 3
s_lshl2_add_u32 s31, s66, s68
s_lshr_b32 s3, s67, 2
s_lshl2_add_u32 s80, s67, s30
s_lshl_b32 s70, s3, 18
s_lshl_b32 s66, s30, 16
s_add_u32 s70, s70, s66
s_lshl_b32 s71, s30, 17
s_lshl_b32 s66, s31, 8
s_add_u32 s71, s71, s66
s_lshl_b32 s76, s30, 13
s_lshl_b32 s77, s30, 12
s_lshl_b32 s78, s30, 10
s_waitcnt lgkmcnt(0)
s_mov_b32 s32, s6
s_mov_b32 s33, s7
s_mov_b32 s34, 2097152
s_mov_b32 s35, 0x20000
s_mov_b32 s36, s10
s_mov_b32 s37, s11
s_mov_b32 s38, 4194304
s_mov_b32 s39, 0x20000
s_mov_b32 s40, s12
s_mov_b32 s41, s13
s_mov_b32 s42, 4194304
s_mov_b32 s43, 0x20000
s_add_u32 m0, s76, 0
s_add_u32 s64, s70, 0
buffer_load_dwordx4 v12, s[32:35], s64 offen lds
s_add_u32 m0, s76, 1024
s_add_u32 s64, s70, 8192
buffer_load_dwordx4 v13, s[32:35], s64 offen lds
s_add_u32 m0, s76, 2048
s_add_u32 s64, s70, 16384
buffer_load_dwordx4 v12, s[32:35], s64 offen lds
s_add_u32 m0, s76, 3072
s_add_u32 s64, s70, 24576
buffer_load_dwordx4 v13, s[32:35], s64 offen lds
s_add_u32 m0, s76, 4096
s_add_u32 s64, s70, 32768
buffer_load_dwordx4 v12, s[32:35], s64 offen lds
s_add_u32 m0, s76, 5120
s_add_u32 s64, s70, 40960
buffer_load_dwordx4 v13, s[32:35], s64 offen lds
s_add_u32 m0, s76, 6144
s_add_u32 s64, s70, 49152
buffer_load_dwordx4 v12, s[32:35], s64 offen lds
s_add_u32 m0, s76, 7168
s_add_u32 s64, s70, 57344
buffer_load_dwordx4 v13, s[32:35], s64 offen lds
s_add_u32 m0, s77, 65536
s_add_u32 s64, s71, 0
buffer_load_dwordx4 v14, s[36:39], s64 offen lds
s_add_u32 m0, s77, 66560
s_add_u32 s64, s71, 32768
buffer_load_dwordx4 v14, s[36:39], s64 offen lds
s_add_u32 m0, s77, 67584
s_add_u32 s64, s71, 65536
buffer_load_dwordx4 v15, s[36:39], s64 offen lds
s_add_u32 m0, s77, 68608
s_add_u32 s64, s71, 98304
buffer_load_dwordx4 v15, s[36:39], s64 offen lds
s_add_u32 m0, s77, 81920
s_add_u32 s64, s71, 0
buffer_load_dwordx4 v14, s[40:43], s64 offen lds
s_add_u32 m0, s77, 82944
s_add_u32 s64, s71, 32768
buffer_load_dwordx4 v14, s[40:43], s64 offen lds
s_add_u32 m0, s77, 83968
s_add_u32 s64, s71, 65536
buffer_load_dwordx4 v15, s[40:43], s64 offen lds
s_add_u32 m0, s77, 84992
s_add_u32 s64, s71, 98304
buffer_load_dwordx4 v15, s[40:43], s64 offen lds
s_mov_b32 s44, s28
s_mov_b32 s45, s29
s_mov_b32 s46, 134217728
s_mov_b32 s47, 0x20000
s_mov_b32 s48, s4
s_mov_b32 s49, s5
s_mov_b32 s50, 4194304
s_mov_b32 s51, 0x20000
s_mov_b32 s52, s26
s_mov_b32 s53, s27
s_mov_b32 s54, 256
s_mov_b32 s55, 0x20000
s_mov_b32 s56, s8
s_mov_b32 s57, s9
s_mov_b32 s58, 8388608
s_mov_b32 s59, 0x20000
s_mov_b32 s60, s18
s_mov_b32 s61, s19
s_mov_b32 s62, 6291456
s_mov_b32 s63, 0x20000
v_accvgpr_write_b32 a251, 1
v_and_b32 v24, 15, v0
v_lshrrev_b32 v26, 1, v24
v_xor_b32 v26, v26, v25
v_lshlrev_b32 v26, 4, v26
v_lshl_add_u32 v26, v24, 7, v26
v_add_u32 v2, s76, v26
v_xor_b32 v3, 64, v2
v_bfe_u32 v24, v0, 2, 2
v_lshl_add_u32 v27, v25, 3, v24
v_and_b32 v1, 3, v0
v_cmp_eq_u32 vcc, 0, v1
v_lshlrev_b32 v1, 3, v1
v_lshl_add_u32 v26, v27, 8, v1
v_add_u32 v26, 65536, v26
v_and_b32 v1, 1, v25
v_lshl_add_u32 v24, v1, 2, v24
v_lshlrev_b32 v16, 4, v0
v_mov_b32 v28, 0x3f803f80
v_cndmask_b32 v28, 0, v28, vcc
v_accvgpr_write_b32 a244, v28
v_accvgpr_write_b32 a245, v28
v_accvgpr_write_b32 a246, v28
v_accvgpr_write_b32 a247, v28
v_xor_b32 v1, 0, v24
v_lshl_add_u32 v4, v1, 5, v26
v_xor_b32 v1, 1, v24
v_lshl_add_u32 v5, v1, 5, v26
v_xor_b32 v1, 2, v24
v_lshl_add_u32 v6, v1, 5, v26
v_xor_b32 v1, 3, v24
v_lshl_add_u32 v7, v1, 5, v26
v_xor_b32 v1, 4, v24
v_lshl_add_u32 v8, v1, 5, v26
v_xor_b32 v1, 5, v24
v_lshl_add_u32 v9, v1, 5, v26
v_xor_b32 v1, 6, v24
v_lshl_add_u32 v10, v1, 5, v26
v_xor_b32 v1, 7, v24
v_lshl_add_u32 v11, v1, 5, v26
s_sub_u32 s16, 15, s3
s_lshl_b32 s72, s3, 18
s_lshl_b32 s73, s16, 18
s_cmp_lt_u32 s30, 2
s_cselect_b32 s74, s72, s73
s_max_u32 s74, s74, 32768
s_sub_u32 s74, s74, 32768
s_and_b32 s66, s30, 1
s_lshl_b32 s66, s66, 14
s_add_u32 s74, s74, s66
s_lshl_b32 s66, s30, 15
s_add_u32 s72, s72, s66
s_add_u32 s73, s73, s66
s_mul_i32 s75, s30, 98304
s_lshl_b32 s66, s31, 6
s_add_u32 s75, s75, s66
s_lshl_b32 s79, s31, 20
s_lshl_b32 s66, s3, 17
s_add_u32 s79, s79, s66
s_lshl_b32 s66, s30, 15
s_add_u32 s79, s79, s66
v_bfe_u32 v23, v0, 1, 1
v_lshrrev_b32 v1, 5, v0
v_xor_b32 v23, v23, v1
v_lshlrev_b32 v23, 5, v23
v_and_b32 v1, 1, v0
v_lshl_add_u32 v23, v1, 4, v23
v_lshrrev_b32 v1, 2, v0
v_mul_u32_u24 v1, 6144, v1
v_add_u32 v23, v1, v23
s_and_b32 s68, s30, 1
s_lshl_b32 s68, s68, 6
v_lshrrev_b32 v1, 3, v0
v_lshl_add_u32 v22, v1, 10, v12
v_xor_b32 v22, s68, v22
s_lshl_b32 s81, s80, 13
s_and_b32 s67, s2, 7
s_lshl_b32 s82, s67, 8
s_add_u32 s82, s82, s81
s_lshl_b32 s67, s67, 10
s_add_u32 s81, s81, s67
v_mul_u32_u24 v1, 1792, v25
v_add_u32 v1, v1, v16
s_lshl_b32 s68, s2, 3
s_lshl1_add_u32 s68, s30, s68
v_lshrrev_b32 v18, 5, v0
v_add_u32 v18, s68, v18
v_and_b32 v19, 31, v0
v_lshlrev_b32 v19, 4, v19
v_lshl_add_u32 v18, v18, 11, v19
v_mov_b32 v21, 0
v_min_u32 v20, 1, v0
v_lshlrev_b32 v20, 30, v20
s_lshl2_add_u32 s68, s2, s30
s_lshl_b32 s68, s68, 6
s_add_u32 s68, s68, 59834368
s_lshr_b32 s69, s2, 6
s_or_b32 s69, s69, s30
s_lshl_b32 s69, s69, 20
s_add_u32 s69, s69, s2
s_lshl_b32 s69, s69, 8
s_add_u32 s69, s69, 59768832
s_add_u32 m0, s76, 32768
s_add_u32 s64, s70, 128
buffer_load_dwordx4 v12, s[32:35], s64 offen lds
s_add_u32 m0, s76, 33792
s_add_u32 s64, s70, 8320
buffer_load_dwordx4 v13, s[32:35], s64 offen lds
s_add_u32 m0, s76, 34816
s_add_u32 s64, s70, 16512
buffer_load_dwordx4 v12, s[32:35], s64 offen lds
s_add_u32 m0, s76, 35840
s_add_u32 s64, s70, 24704
buffer_load_dwordx4 v13, s[32:35], s64 offen lds
s_add_u32 m0, s76, 36864
s_add_u32 s64, s70, 32896
buffer_load_dwordx4 v12, s[32:35], s64 offen lds
s_add_u32 m0, s76, 37888
s_add_u32 s64, s70, 41088
buffer_load_dwordx4 v13, s[32:35], s64 offen lds
s_add_u32 m0, s76, 38912
s_add_u32 s64, s70, 49280
buffer_load_dwordx4 v12, s[32:35], s64 offen lds
s_add_u32 m0, s76, 39936
s_add_u32 s64, s70, 57472
buffer_load_dwordx4 v13, s[32:35], s64 offen lds
s_add_u32 m0, s77, 98304
s_add_u32 s64, s71, 524288
buffer_load_dwordx4 v14, s[36:39], s64 offen lds
s_add_u32 m0, s77, 99328
s_add_u32 s64, s71, 557056
buffer_load_dwordx4 v14, s[36:39], s64 offen lds
s_add_u32 m0, s77, 100352
s_add_u32 s64, s71, 589824
buffer_load_dwordx4 v15, s[36:39], s64 offen lds
s_add_u32 m0, s77, 101376
s_add_u32 s64, s71, 622592
buffer_load_dwordx4 v15, s[36:39], s64 offen lds
s_add_u32 m0, s77, 114688
s_add_u32 s64, s71, 524288
buffer_load_dwordx4 v14, s[40:43], s64 offen lds
s_add_u32 m0, s77, 115712
s_add_u32 s64, s71, 557056
buffer_load_dwordx4 v14, s[40:43], s64 offen lds
s_add_u32 m0, s77, 116736
s_add_u32 s64, s71, 589824
buffer_load_dwordx4 v15, s[40:43], s64 offen lds
s_add_u32 m0, s77, 117760
s_add_u32 s64, s71, 622592
buffer_load_dwordx4 v15, s[40:43], s64 offen lds
s_waitcnt vmcnt(16)
s_barrier
ds_read_b128 a[0:3], v2 offset:0
ds_read_b128 a[4:7], v3 offset:0
ds_read_b64_tr_b16 a[72:73], v4 offset:0
ds_read_b64_tr_b16 a[74:75], v4 offset:1024
ds_read_b64_tr_b16 a[76:77], v4 offset:8192
ds_read_b64_tr_b16 a[78:79], v4 offset:9216
ds_read_b128 a[8:11], v2 offset:2048
ds_read_b128 a[12:15], v3 offset:2048
ds_read_b128 a[16:19], v2 offset:4096
ds_read_b128 a[20:23], v3 offset:4096
ds_read_b128 a[24:27], v2 offset:6144
ds_read_b128 a[28:31], v3 offset:6144
ds_read_b64_tr_b16 a[80:81], v5 offset:0
ds_read_b64_tr_b16 a[82:83], v5 offset:1024
ds_read_b64_tr_b16 a[84:85], v5 offset:8192
ds_read_b64_tr_b16 a[86:87], v5 offset:9216
ds_read_b64_tr_b16 a[88:89], v6 offset:0
ds_read_b64_tr_b16 a[90:91], v6 offset:1024
ds_read_b64_tr_b16 a[92:93], v6 offset:8192
ds_read_b64_tr_b16 a[94:95], v6 offset:9216
s_waitcnt lgkmcnt(15)
v_mfma_f32_16x16x32_bf16 v[184:187], a[72:75], a[0:3], 0
s_waitcnt lgkmcnt(14)
s_add_u32 m0, s77, 131072
ds_read_b64_tr_b16 a[96:97], v7 offset:0
v_mfma_f32_16x16x32_bf16 v[184:187], a[76:79], a[4:7], v[184:187]
s_waitcnt lgkmcnt(13)
s_add_u32 s64, s71, 1048576
ds_read_b64_tr_b16 a[98:99], v7 offset:1024
v_mfma_f32_16x16x32_bf16 v[192:195], a[76:79], a[12:15], 0
buffer_load_dwordx4 v14, s[36:39], s64 offen lds
v_mfma_f32_16x16x32_bf16 v[192:195], a[72:75], a[8:11], v[192:195]
s_waitcnt lgkmcnt(13)
ds_read_b64_tr_b16 a[100:101], v7 offset:8192
v_mfma_f32_16x16x32_bf16 v[200:203], a[72:75], a[16:19], 0
s_waitcnt lgkmcnt(13)
s_add_u32 m0, s77, 132096
ds_read_b64_tr_b16 a[102:103], v7 offset:9216
v_mfma_f32_16x16x32_bf16 v[200:203], a[76:79], a[20:23], v[200:203]
s_waitcnt lgkmcnt(12)
s_add_u32 s64, s71, 1081344
ds_read_b64_tr_b16 a[104:105], v8 offset:0
v_mfma_f32_16x16x32_bf16 v[208:211], a[76:79], a[28:31], 0
buffer_load_dwordx4 v14, s[36:39], s64 offen lds
v_mfma_f32_16x16x32_bf16 v[208:211], a[72:75], a[24:27], v[208:211]
s_waitcnt lgkmcnt(11)
ds_read_b64_tr_b16 a[106:107], v8 offset:1024
v_mfma_f32_16x16x32_bf16 v[248:251], a[80:83], a[24:27], 0
s_waitcnt lgkmcnt(10)
ds_read_b64_tr_b16 a[108:109], v8 offset:8192
v_mfma_f32_16x16x32_bf16 v[248:251], a[84:87], a[28:31], v[248:251]
s_add_u32 m0, s77, 133120
s_add_u32 s17, s78, .-L_pc+6144
ds_read_b64_tr_b16 a[110:111], v8 offset:9216
v_mfma_f32_16x16x32_bf16 v[212:215], a[84:87], a[20:23], 0
s_add_u32 s64, s71, 1114112
buffer_load_dword a252, v16, s[88:91], s17 offen
v_mfma_f32_16x16x32_bf16 v[212:215], a[80:83], a[16:19], v[212:215]
buffer_load_dwordx4 v15, s[36:39], s64 offen lds
v_mfma_f32_16x16x32_bf16 v[204:207], a[80:83], a[8:11], 0
ds_read_b64_tr_b16 a[112:113], v9 offset:0
v_mfma_f32_16x16x32_bf16 v[204:207], a[84:87], a[12:15], v[204:207]
s_add_u32 m0, s77, 134144
ds_read_b64_tr_b16 a[114:115], v9 offset:1024
v_mfma_f32_16x16x32_bf16 v[196:199], a[84:87], a[4:7], 0
s_add_u32 s64, s71, 1146880
ds_read_b64_tr_b16 a[116:117], v9 offset:8192
v_mfma_f32_16x16x32_bf16 v[196:199], a[80:83], a[0:3], v[196:199]
s_waitcnt lgkmcnt(6)
buffer_load_dwordx4 v15, s[36:39], s64 offen lds
v_mfma_f32_16x16x32_bf16 v[188:191], a[88:91], a[0:3], 0
ds_read_b64_tr_b16 a[118:119], v9 offset:9216
v_mfma_f32_16x16x32_bf16 v[188:191], a[92:95], a[4:7], v[188:191]
ds_read_b64_tr_b16 a[72:73], v10 offset:0
v_mfma_f32_16x16x32_bf16 v[216:219], a[92:95], a[12:15], 0
s_add_u32 m0, s77, 147456
ds_read_b64_tr_b16 a[74:75], v10 offset:1024
v_mfma_f32_16x16x32_bf16 v[216:219], a[88:91], a[8:11], v[216:219]
s_add_u32 s64, s71, 1048576
ds_read_b64_tr_b16 a[76:77], v10 offset:8192
v_mfma_f32_16x16x32_bf16 v[224:227], a[88:91], a[16:19], 0
buffer_load_dwordx4 v14, s[40:43], s64 offen lds
v_mfma_f32_16x16x32_bf16 v[224:227], a[92:95], a[20:23], v[224:227]
ds_read_b64_tr_b16 a[78:79], v10 offset:9216
v_mfma_f32_16x16x32_bf16 v[232:235], a[92:95], a[28:31], 0
s_add_u32 m0, s77, 148480
ds_read_b64_tr_b16 a[80:81], v11 offset:0
v_mfma_f32_16x16x32_bf16 v[232:235], a[88:91], a[24:27], v[232:235]
s_add_u32 s64, s71, 1081344
ds_read_b64_tr_b16 a[82:83], v11 offset:1024
v_mfma_f32_16x16x32_bf16 v[240:243], a[96:99], a[24:27], 0
buffer_load_dwordx4 v14, s[40:43], s64 offen lds
v_mfma_f32_16x16x32_bf16 v[240:243], a[100:103], a[28:31], v[240:243]
ds_read_b64_tr_b16 a[84:85], v11 offset:8192
v_mfma_f32_16x16x32_bf16 v[252:255], a[100:103], a[20:23], 0
ds_read_b64_tr_b16 a[86:87], v11 offset:9216
v_mfma_f32_16x16x32_bf16 v[252:255], a[96:99], a[16:19], v[252:255]
s_add_u32 m0, s77, 149504
ds_read_b64_tr_b16 a[88:89], v4 offset:16384
v_mfma_f32_16x16x32_bf16 v[244:247], a[96:99], a[8:11], 0
s_add_u32 s64, s71, 1114112
ds_read_b64_tr_b16 a[90:91], v4 offset:17408
v_mfma_f32_16x16x32_bf16 v[244:247], a[100:103], a[12:15], v[244:247]
buffer_load_dwordx4 v15, s[40:43], s64 offen lds
v_mfma_f32_16x16x32_bf16 v[236:239], a[100:103], a[4:7], 0
ds_read_b64_tr_b16 a[92:93], v4 offset:24576
v_mfma_f32_16x16x32_bf16 v[236:239], a[96:99], a[0:3], v[236:239]
s_waitcnt lgkmcnt(7)
s_add_u32 m0, s77, 150528
ds_read_b64_tr_b16 a[94:95], v4 offset:25600
v_mfma_f32_16x16x32_bf16 v[228:231], a[104:107], a[0:3], 0
s_add_u32 s64, s71, 1146880
ds_read_b64_tr_b16 a[96:97], v5 offset:16384
v_mfma_f32_16x16x32_bf16 v[228:231], a[108:111], a[4:7], v[228:231]
buffer_load_dwordx4 v15, s[40:43], s64 offen lds
v_mfma_f32_16x16x32_bf16 v[220:223], a[108:111], a[12:15], 0
ds_read_b64_tr_b16 a[98:99], v5 offset:17408
v_mfma_f32_16x16x32_bf16 v[220:223], a[104:107], a[8:11], v[220:223]
ds_read_b64_tr_b16 a[100:101], v5 offset:24576
v_mfma_f32_16x16x32_bf16 v[152:155], a[104:107], a[16:19], 0
ds_read_b64_tr_b16 a[102:103], v5 offset:25600
v_mfma_f32_16x16x32_bf16 v[152:155], a[108:111], a[20:23], v[152:155]
v_mfma_f32_16x16x32_bf16 v[160:163], a[108:111], a[28:31], 0
s_add_u32 m0, s76, 0
v_mfma_f32_16x16x32_bf16 v[160:163], a[104:107], a[24:27], v[160:163]
s_add_u32 s64, s70, 256
ds_read_b64_tr_b16 a[104:105], v6 offset:16384
v_mfma_f32_16x16x32_bf16 v[168:171], a[112:115], a[24:27], 0
buffer_load_dwordx4 v12, s[32:35], s64 offen lds
v_mfma_f32_16x16x32_bf16 v[168:171], a[116:119], a[28:31], v[168:171]
global_load_dwordx4 a[144:147], v18, s[4:5] offset:0
v_mfma_f32_16x16x32_bf16 v[176:179], a[116:119], a[20:23], 0
ds_read_b64_tr_b16 a[106:107], v6 offset:17408
v_mfma_f32_16x16x32_bf16 v[176:179], a[112:115], a[16:19], v[176:179]
ds_read_b64_tr_b16 a[108:109], v6 offset:24576
v_mfma_f32_16x16x32_bf16 v[180:183], a[112:115], a[8:11], 0
ds_read_b64_tr_b16 a[110:111], v6 offset:25600
v_mfma_f32_16x16x32_bf16 v[180:183], a[116:119], a[12:15], v[180:183]
s_add_u32 m0, s76, 1024
v_mfma_f32_16x16x32_bf16 v[172:175], a[116:119], a[4:7], 0
s_add_u32 s64, s70, 8448
v_mfma_f32_16x16x32_bf16 v[172:175], a[112:115], a[0:3], v[172:175]
buffer_load_dwordx4 v13, s[32:35], s64 offen lds
v_mfma_f32_16x16x32_bf16 v[164:167], a[72:75], a[0:3], 0
ds_read_b64_tr_b16 a[112:113], v7 offset:16384
v_mfma_f32_16x16x32_bf16 v[164:167], a[76:79], a[4:7], v[164:167]
ds_read_b64_tr_b16 a[114:115], v7 offset:17408
v_mfma_f32_16x16x32_bf16 v[156:159], a[76:79], a[12:15], 0
ds_read_b64_tr_b16 a[116:117], v7 offset:24576
v_mfma_f32_16x16x32_bf16 v[156:159], a[72:75], a[8:11], v[156:159]
ds_read_b64_tr_b16 a[118:119], v7 offset:25600
v_mfma_f32_16x16x32_bf16 v[24:27], a[72:75], a[16:19], 0
s_add_u32 m0, s76, 2048
v_mfma_f32_16x16x32_bf16 v[24:27], a[76:79], a[20:23], v[24:27]
s_add_u32 s64, s70, 16640
v_mfma_f32_16x16x32_bf16 v[40:43], a[76:79], a[28:31], 0
s_waitcnt vmcnt(20)
buffer_load_dwordx4 v12, s[32:35], s64 offen lds
v_mfma_f32_16x16x32_bf16 v[40:43], a[72:75], a[24:27], v[40:43]
s_waitcnt lgkmcnt(4)
ds_read_b64_tr_b16 a[72:73], v8 offset:16384
v_mfma_f32_16x16x32_bf16 v[56:59], a[80:83], a[24:27], 0
ds_read_b64_tr_b16 a[74:75], v8 offset:17408
v_mfma_f32_16x16x32_bf16 v[56:59], a[84:87], a[28:31], v[56:59]
ds_read_b64_tr_b16 a[76:77], v8 offset:24576
v_mfma_f32_16x16x32_bf16 v[72:75], a[84:87], a[20:23], 0
ds_read_b64_tr_b16 a[78:79], v8 offset:25600
v_mfma_f32_16x16x32_bf16 v[72:75], a[80:83], a[16:19], v[72:75]
s_add_u32 m0, s76, 3072
ds_read_b128 a[32:35], v2 offset:32768
v_mfma_f32_16x16x32_bf16 v[136:139], a[80:83], a[8:11], 0
s_add_u32 s64, s70, 24832
ds_read_b128 a[36:39], v3 offset:32768
v_mfma_f32_16x16x32_bf16 v[136:139], a[84:87], a[12:15], v[136:139]
buffer_load_dwordx4 v13, s[32:35], s64 offen lds
v_mfma_f32_16x16x32_bf16 v[120:123], a[84:87], a[4:7], 0
ds_read_b128 a[40:43], v2 offset:34816
v_mfma_f32_16x16x32_bf16 v[120:123], a[80:83], a[0:3], v[120:123]
ds_read_b128 a[44:47], v3 offset:34816
v_mfma_f32_16x16x32_bf16 v[104:107], a[0:3], a[88:91], 0
ds_read_b128 a[48:51], v2 offset:36864
v_mfma_f32_16x16x32_bf16 v[104:107], a[4:7], a[92:95], v[104:107]
ds_read_b128 a[52:55], v3 offset:36864
v_mfma_f32_16x16x32_bf16 v[88:91], a[12:15], a[92:95], 0
s_add_u32 m0, s76, 4096
ds_read_b128 a[56:59], v2 offset:38912
v_mfma_f32_16x16x32_bf16 v[88:91], a[8:11], a[88:91], v[88:91]
s_add_u32 s64, s70, 33024
ds_read_b128 a[60:63], v3 offset:38912
v_mfma_f32_16x16x32_bf16 v[28:31], a[16:19], a[88:91], 0
buffer_load_dwordx4 v12, s[32:35], s64 offen lds
v_mfma_f32_16x16x32_bf16 v[28:31], a[20:23], a[92:95], v[28:31]
global_load_dwordx4 a[160:163], v19, s[22:23] offset:0
v_mfma_f32_16x16x32_bf16 v[44:47], a[28:31], a[92:95], 0
ds_read_b64_tr_b16 a[80:81], v9 offset:16384
v_mfma_f32_16x16x32_bf16 v[44:47], a[24:27], a[88:91], v[44:47]
ds_read_b64_tr_b16 a[82:83], v9 offset:17408
v_mfma_f32_16x16x32_bf16 v[60:63], a[24:27], a[96:99], 0
ds_read_b64_tr_b16 a[84:85], v9 offset:24576
v_mfma_f32_16x16x32_bf16 v[60:63], a[28:31], a[100:103], v[60:63]
s_add_u32 m0, s76, 5120
ds_read_b64_tr_b16 a[86:87], v9 offset:25600
v_mfma_f32_16x16x32_bf16 v[76:79], a[20:23], a[100:103], 0
s_add_u32 s64, s70, 41216
ds_read_b64_tr_b16 a[88:89], v10 offset:16384
v_mfma_f32_16x16x32_bf16 v[76:79], a[16:19], a[96:99], v[76:79]
buffer_load_dwordx4 v13, s[32:35], s64 offen lds
v_mfma_f32_16x16x32_bf16 v[140:143], a[8:11], a[96:99], 0
ds_read_b64_tr_b16 a[90:91], v10 offset:17408
v_mfma_f32_16x16x32_bf16 v[140:143], a[12:15], a[100:103], v[140:143]
ds_read_b64_tr_b16 a[92:93], v10 offset:24576
v_mfma_f32_16x16x32_bf16 v[124:127], a[4:7], a[100:103], 0
ds_read_b64_tr_b16 a[94:95], v10 offset:25600
v_mfma_f32_16x16x32_bf16 v[124:127], a[0:3], a[96:99], v[124:127]
ds_read_b64_tr_b16 a[96:97], v11 offset:16384
v_mfma_f32_16x16x32_bf16 v[108:111], a[0:3], a[104:107], 0
s_add_u32 m0, s76, 6144
ds_read_b64_tr_b16 a[98:99], v11 offset:17408
v_mfma_f32_16x16x32_bf16 v[108:111], a[4:7], a[108:111], v[108:111]
s_add_u32 s64, s70, 49408
ds_read_b64_tr_b16 a[100:101], v11 offset:24576
v_mfma_f32_16x16x32_bf16 v[92:95], a[12:15], a[108:111], 0
buffer_load_dwordx4 v12, s[32:35], s64 offen lds
v_mfma_f32_16x16x32_bf16 v[92:95], a[8:11], a[104:107], v[92:95]
ds_read_b64_tr_b16 a[102:103], v11 offset:25600
v_mfma_f32_16x16x32_bf16 v[32:35], a[16:19], a[104:107], 0
v_mfma_f32_16x16x32_bf16 v[32:35], a[20:23], a[108:111], v[32:35]
v_mfma_f32_16x16x32_bf16 v[48:51], a[28:31], a[108:111], 0
v_mfma_f32_16x16x32_bf16 v[48:51], a[24:27], a[104:107], v[48:51]
s_waitcnt lgkmcnt(5)
s_add_u32 m0, s76, 7168
v_mfma_f32_16x16x32_bf16 v[64:67], a[24:27], a[112:115], 0
s_add_u32 s64, s70, 57600
v_mfma_f32_16x16x32_bf16 v[64:67], a[28:31], a[116:119], v[64:67]
buffer_load_dwordx4 v13, s[32:35], s64 offen lds
v_mfma_f32_16x16x32_bf16 v[80:83], a[20:23], a[116:119], 0
v_mfma_f32_16x16x32_bf16 v[80:83], a[16:19], a[112:115], v[80:83]
v_mfma_f32_16x16x32_bf16 v[144:147], a[8:11], a[112:115], 0
v_mfma_f32_16x16x32_bf16 v[144:147], a[12:15], a[116:119], v[144:147]
v_mfma_f32_16x16x32_bf16 v[128:131], a[4:7], a[116:119], 0
v_mfma_f32_16x16x32_bf16 v[128:131], a[0:3], a[112:115], v[128:131]
v_mfma_f32_16x16x32_bf16 v[112:115], a[0:3], a[72:75], 0
global_load_dwordx4 a[148:151], v18, s[4:5] offset:512
v_mfma_f32_16x16x32_bf16 v[112:115], a[4:7], a[76:79], v[112:115]
v_mfma_f32_16x16x32_bf16 v[96:99], a[12:15], a[76:79], 0
s_waitcnt vmcnt(20) lgkmcnt(0)
s_barrier
v_mfma_f32_16x16x32_bf16 v[96:99], a[8:11], a[72:75], v[96:99]
s_add_u32 m0, s77, 65536
ds_read_b64_tr_b16 a[104:105], v4 offset:32768
v_mfma_f32_16x16x32_bf16 v[36:39], a[16:19], a[72:75], 0
s_add_u32 s64, s71, 1572864
ds_read_b64_tr_b16 a[106:107], v4 offset:33792
v_mfma_f32_16x16x32_bf16 v[36:39], a[20:23], a[76:79], v[36:39]
buffer_load_dwordx4 v14, s[36:39], s64 offen lds
v_mfma_f32_16x16x32_bf16 v[52:55], a[28:31], a[76:79], 0
ds_read_b64_tr_b16 a[108:109], v4 offset:40960
v_mfma_f32_16x16x32_bf16 v[52:55], a[24:27], a[72:75], v[52:55]
ds_read_b64_tr_b16 a[110:111], v4 offset:41984
v_mfma_f32_16x16x32_bf16 v[68:71], a[24:27], a[80:83], 0
ds_read_b64_tr_b16 a[112:113], v5 offset:32768
v_mfma_f32_16x16x32_bf16 v[68:71], a[28:31], a[84:87], v[68:71]
ds_read_b64_tr_b16 a[114:115], v5 offset:33792
v_mfma_f32_16x16x32_bf16 v[84:87], a[20:23], a[84:87], 0
ds_read_b64_tr_b16 a[116:117], v5 offset:40960
v_mfma_f32_16x16x32_bf16 v[84:87], a[16:19], a[80:83], v[84:87]
s_add_u32 m0, s77, 66560
ds_read_b64_tr_b16 a[118:119], v5 offset:41984
v_mfma_f32_16x16x32_bf16 v[148:151], a[8:11], a[80:83], 0
s_add_u32 s64, s71, 1605632
ds_read_b64_tr_b16 a[72:73], v6 offset:32768
v_mfma_f32_16x16x32_bf16 v[148:151], a[12:15], a[84:87], v[148:151]
buffer_load_dwordx4 v14, s[36:39], s64 offen lds
v_mfma_f32_16x16x32_bf16 v[132:135], a[4:7], a[84:87], 0
ds_read_b64_tr_b16 a[74:75], v6 offset:33792
v_mfma_f32_16x16x32_bf16 v[132:135], a[0:3], a[80:83], v[132:135]
ds_read_b64_tr_b16 a[76:77], v6 offset:40960
v_mfma_f32_16x16x32_bf16 v[116:119], a[0:3], a[88:91], 0
ds_read_b64_tr_b16 a[78:79], v6 offset:41984
v_mfma_f32_16x16x32_bf16 v[116:119], a[4:7], a[92:95], v[116:119]
ds_read_b64_tr_b16 a[80:81], v7 offset:32768
v_mfma_f32_16x16x32_bf16 v[100:103], a[12:15], a[92:95], 0
ds_read_b64_tr_b16 a[82:83], v7 offset:33792
v_mfma_f32_16x16x32_bf16 v[100:103], a[8:11], a[88:91], v[100:103]
s_add_u32 m0, s77, 67584
ds_read_b64_tr_b16 a[84:85], v7 offset:40960
v_mfma_f32_16x16x32_bf16 a[120:123], a[16:19], a[88:91], 0
s_add_u32 s64, s71, 1638400
ds_read_b64_tr_b16 a[86:87], v7 offset:41984
v_mfma_f32_16x16x32_bf16 a[120:123], a[20:23], a[92:95], a[120:123]
buffer_load_dwordx4 v15, s[36:39], s64 offen lds
v_mfma_f32_16x16x32_bf16 a[124:127], a[28:31], a[92:95], 0
v_mfma_f32_16x16x32_bf16 a[124:127], a[24:27], a[88:91], a[124:127]
ds_read_b64_tr_b16 a[88:89], v8 offset:32768
v_mfma_f32_16x16x32_bf16 a[128:131], a[24:27], a[96:99], 0
ds_read_b64_tr_b16 a[90:91], v8 offset:33792
v_mfma_f32_16x16x32_bf16 a[128:131], a[28:31], a[100:103], a[128:131]
ds_read_b64_tr_b16 a[92:93], v8 offset:40960
v_mfma_f32_16x16x32_bf16 a[132:135], a[20:23], a[100:103], 0
ds_read_b64_tr_b16 a[94:95], v8 offset:41984
v_mfma_f32_16x16x32_bf16 a[132:135], a[16:19], a[96:99], a[132:135]
s_add_u32 m0, s77, 68608
v_mfma_f32_16x16x32_bf16 a[136:139], a[8:11], a[96:99], 0
s_add_u32 s64, s71, 1671168
global_load_dwordx4 a[164:167], v19, s[22:23] offset:512
v_mfma_f32_16x16x32_bf16 a[136:139], a[12:15], a[100:103], a[136:139]
buffer_load_dwordx4 v15, s[36:39], s64 offen lds
v_mfma_f32_16x16x32_bf16 a[140:143], a[4:7], a[100:103], 0
v_mfma_f32_16x16x32_bf16 a[140:143], a[0:3], a[96:99], a[140:143]
s_waitcnt lgkmcnt(4)
ds_read_b64_tr_b16 a[96:97], v9 offset:32768
v_mfma_f32_16x16x32_bf16 v[184:187], a[104:107], a[32:35], v[184:187]
ds_read_b64_tr_b16 a[98:99], v9 offset:33792
v_mfma_f32_16x16x32_bf16 v[184:187], a[108:111], a[36:39], v[184:187]
ds_read_b64_tr_b16 a[100:101], v9 offset:40960
v_mfma_f32_16x16x32_bf16 v[192:195], a[108:111], a[44:47], v[192:195]
ds_read_b64_tr_b16 a[102:103], v9 offset:41984
v_mfma_f32_16x16x32_bf16 v[192:195], a[104:107], a[40:43], v[192:195]
s_add_u32 m0, s77, 81920
v_mfma_f32_16x16x32_bf16 v[200:203], a[104:107], a[48:51], v[200:203]
s_add_u32 s64, s71, 1572864
v_mfma_f32_16x16x32_bf16 v[200:203], a[108:111], a[52:55], v[200:203]
buffer_load_dwordx4 v14, s[40:43], s64 offen lds
v_mfma_f32_16x16x32_bf16 v[208:211], a[108:111], a[60:63], v[208:211]
v_mfma_f32_16x16x32_bf16 v[208:211], a[104:107], a[56:59], v[208:211]
ds_read_b64_tr_b16 a[104:105], v10 offset:32768
v_mfma_f32_16x16x32_bf16 v[248:251], a[112:115], a[56:59], v[248:251]
ds_read_b64_tr_b16 a[106:107], v10 offset:33792
v_mfma_f32_16x16x32_bf16 v[248:251], a[116:119], a[60:63], v[248:251]
ds_read_b64_tr_b16 a[108:109], v10 offset:40960
v_mfma_f32_16x16x32_bf16 v[212:215], a[116:119], a[52:55], v[212:215]
ds_read_b64_tr_b16 a[110:111], v10 offset:41984
v_mfma_f32_16x16x32_bf16 v[212:215], a[112:115], a[48:51], v[212:215]
s_add_u32 m0, s77, 82944
v_mfma_f32_16x16x32_bf16 v[204:207], a[112:115], a[40:43], v[204:207]
s_add_u32 s64, s71, 1605632
v_mfma_f32_16x16x32_bf16 v[204:207], a[116:119], a[44:47], v[204:207]
buffer_load_dwordx4 v14, s[40:43], s64 offen lds
v_mfma_f32_16x16x32_bf16 v[196:199], a[116:119], a[36:39], v[196:199]
v_mfma_f32_16x16x32_bf16 v[196:199], a[112:115], a[32:35], v[196:199]
ds_read_b64_tr_b16 a[112:113], v11 offset:32768
v_mfma_f32_16x16x32_bf16 v[188:191], a[72:75], a[32:35], v[188:191]
ds_read_b64_tr_b16 a[114:115], v11 offset:33792
v_mfma_f32_16x16x32_bf16 v[188:191], a[76:79], a[36:39], v[188:191]
ds_read_b64_tr_b16 a[116:117], v11 offset:40960
v_mfma_f32_16x16x32_bf16 v[216:219], a[76:79], a[44:47], v[216:219]
ds_read_b64_tr_b16 a[118:119], v11 offset:41984
v_mfma_f32_16x16x32_bf16 v[216:219], a[72:75], a[40:43], v[216:219]
s_add_u32 m0, s77, 83968
v_mfma_f32_16x16x32_bf16 v[224:227], a[72:75], a[48:51], v[224:227]
s_add_u32 s64, s71, 1638400
v_mfma_f32_16x16x32_bf16 v[224:227], a[76:79], a[52:55], v[224:227]
buffer_load_dwordx4 v15, s[40:43], s64 offen lds
v_mfma_f32_16x16x32_bf16 v[232:235], a[76:79], a[60:63], v[232:235]
v_mfma_f32_16x16x32_bf16 v[232:235], a[72:75], a[56:59], v[232:235]
ds_read_b64_tr_b16 a[72:73], v4 offset:49152
v_mfma_f32_16x16x32_bf16 v[240:243], a[80:83], a[56:59], v[240:243]
global_load_dwordx4 a[152:155], v18, s[4:5] offset:1024
v_mfma_f32_16x16x32_bf16 v[240:243], a[84:87], a[60:63], v[240:243]
ds_read_b64_tr_b16 a[74:75], v4 offset:50176
v_mfma_f32_16x16x32_bf16 v[252:255], a[84:87], a[52:55], v[252:255]
ds_read_b64_tr_b16 a[76:77], v4 offset:57344
v_mfma_f32_16x16x32_bf16 v[252:255], a[80:83], a[48:51], v[252:255]
s_add_u32 m0, s77, 84992
ds_read_b64_tr_b16 a[78:79], v4 offset:58368
v_mfma_f32_16x16x32_bf16 v[244:247], a[80:83], a[40:43], v[244:247]
s_add_u32 s64, s71, 1671168
v_mfma_f32_16x16x32_bf16 v[244:247], a[84:87], a[44:47], v[244:247]
buffer_load_dwordx4 v15, s[40:43], s64 offen lds
v_mfma_f32_16x16x32_bf16 v[236:239], a[84:87], a[36:39], v[236:239]
v_mfma_f32_16x16x32_bf16 v[236:239], a[80:83], a[32:35], v[236:239]
s_waitcnt lgkmcnt(4)
ds_read_b64_tr_b16 a[80:81], v5 offset:49152
v_mfma_f32_16x16x32_bf16 v[228:231], a[88:91], a[32:35], v[228:231]
ds_read_b64_tr_b16 a[82:83], v5 offset:50176
v_mfma_f32_16x16x32_bf16 v[228:231], a[92:95], a[36:39], v[228:231]
ds_read_b64_tr_b16 a[84:85], v5 offset:57344
v_mfma_f32_16x16x32_bf16 v[220:223], a[92:95], a[44:47], v[220:223]
ds_read_b64_tr_b16 a[86:87], v5 offset:58368
v_mfma_f32_16x16x32_bf16 v[220:223], a[88:91], a[40:43], v[220:223]
v_mfma_f32_16x16x32_bf16 v[152:155], a[88:91], a[48:51], v[152:155]
v_mfma_f32_16x16x32_bf16 v[152:155], a[92:95], a[52:55], v[152:155]
v_mfma_f32_16x16x32_bf16 v[160:163], a[92:95], a[60:63], v[160:163]
s_add_u32 m0, s76, 32768
v_mfma_f32_16x16x32_bf16 v[160:163], a[88:91], a[56:59], v[160:163]
s_add_u32 s64, s70, 384
ds_read_b64_tr_b16 a[88:89], v6 offset:49152
v_mfma_f32_16x16x32_bf16 v[168:171], a[96:99], a[56:59], v[168:171]
buffer_load_dwordx4 v12, s[32:35], s64 offen lds
v_mfma_f32_16x16x32_bf16 v[168:171], a[100:103], a[60:63], v[168:171]
ds_read_b64_tr_b16 a[90:91], v6 offset:50176
v_mfma_f32_16x16x32_bf16 v[176:179], a[100:103], a[52:55], v[176:179]
ds_read_b64_tr_b16 a[92:93], v6 offset:57344
v_mfma_f32_16x16x32_bf16 v[176:179], a[96:99], a[48:51], v[176:179]
ds_read_b64_tr_b16 a[94:95], v6 offset:58368
v_mfma_f32_16x16x32_bf16 v[180:183], a[96:99], a[40:43], v[180:183]
v_mfma_f32_16x16x32_bf16 v[180:183], a[100:103], a[44:47], v[180:183]
s_add_u32 m0, s76, 33792
v_mfma_f32_16x16x32_bf16 v[172:175], a[100:103], a[36:39], v[172:175]
s_add_u32 s64, s70, 8576
v_mfma_f32_16x16x32_bf16 v[172:175], a[96:99], a[32:35], v[172:175]
buffer_load_dwordx4 v13, s[32:35], s64 offen lds
v_mfma_f32_16x16x32_bf16 v[164:167], a[104:107], a[32:35], v[164:167]
ds_read_b64_tr_b16 a[96:97], v7 offset:49152
v_mfma_f32_16x16x32_bf16 v[164:167], a[108:111], a[36:39], v[164:167]
ds_read_b64_tr_b16 a[98:99], v7 offset:50176
v_mfma_f32_16x16x32_bf16 v[156:159], a[108:111], a[44:47], v[156:159]
ds_read_b64_tr_b16 a[100:101], v7 offset:57344
v_mfma_f32_16x16x32_bf16 v[156:159], a[104:107], a[40:43], v[156:159]
ds_read_b64_tr_b16 a[102:103], v7 offset:58368
v_mfma_f32_16x16x32_bf16 v[24:27], a[104:107], a[48:51], v[24:27]
s_add_u32 m0, s76, 34816
global_load_dwordx4 a[168:171], v19, s[22:23] offset:1024
v_mfma_f32_16x16x32_bf16 v[24:27], a[108:111], a[52:55], v[24:27]
s_add_u32 s64, s70, 16768
v_mfma_f32_16x16x32_bf16 v[40:43], a[108:111], a[60:63], v[40:43]
s_waitcnt vmcnt(14)
buffer_load_dwordx4 v12, s[32:35], s64 offen lds
v_mfma_f32_16x16x32_bf16 v[40:43], a[104:107], a[56:59], v[40:43]
ds_read_b64_tr_b16 a[104:105], v8 offset:49152
v_mfma_f32_16x16x32_bf16 v[56:59], a[112:115], a[56:59], v[56:59]
ds_read_b64_tr_b16 a[106:107], v8 offset:50176
v_mfma_f32_16x16x32_bf16 v[56:59], a[116:119], a[60:63], v[56:59]
ds_read_b64_tr_b16 a[108:109], v8 offset:57344
v_add_u32 v4, 0x8000, v4
v_mfma_f32_16x16x32_bf16 v[72:75], a[116:119], a[52:55], v[72:75]
ds_read_b64_tr_b16 a[110:111], v8 offset:58368
v_mfma_f32_16x16x32_bf16 v[72:75], a[112:115], a[48:51], v[72:75]
s_add_u32 m0, s76, 35840
ds_read_b128 a[0:3], v2 offset:0
v_mfma_f32_16x16x32_bf16 v[136:139], a[112:115], a[40:43], v[136:139]
s_add_u32 s64, s70, 24960
ds_read_b128 a[4:7], v3 offset:0
v_mfma_f32_16x16x32_bf16 v[136:139], a[116:119], a[44:47], v[136:139]
buffer_load_dwordx4 v13, s[32:35], s64 offen lds
v_mfma_f32_16x16x32_bf16 v[120:123], a[116:119], a[36:39], v[120:123]
ds_read_b128 a[8:11], v2 offset:2048
v_mfma_f32_16x16x32_bf16 v[120:123], a[112:115], a[32:35], v[120:123]
s_waitcnt lgkmcnt(7)
ds_read_b128 a[12:15], v3 offset:2048
v_mfma_f32_16x16x32_bf16 v[104:107], a[32:35], a[72:75], v[104:107]
ds_read_b128 a[16:19], v2 offset:4096
v_mfma_f32_16x16x32_bf16 v[104:107], a[36:39], a[76:79], v[104:107]
ds_read_b128 a[20:23], v3 offset:4096
v_add_u32 v5, 0x8000, v5
v_mfma_f32_16x16x32_bf16 v[88:91], a[44:47], a[76:79], v[88:91]
s_add_u32 m0, s76, 36864
ds_read_b128 a[24:27], v2 offset:6144
v_mfma_f32_16x16x32_bf16 v[88:91], a[40:43], a[72:75], v[88:91]
s_add_u32 s64, s70, 33152
ds_read_b128 a[28:31], v3 offset:6144
v_mfma_f32_16x16x32_bf16 v[28:31], a[48:51], a[72:75], v[28:31]
buffer_load_dwordx4 v12, s[32:35], s64 offen lds
v_mfma_f32_16x16x32_bf16 v[28:31], a[52:55], a[76:79], v[28:31]
ds_read_b64_tr_b16 a[112:113], v9 offset:49152
v_mfma_f32_16x16x32_bf16 v[44:47], a[60:63], a[76:79], v[44:47]
ds_read_b64_tr_b16 a[114:115], v9 offset:50176
v_mfma_f32_16x16x32_bf16 v[44:47], a[56:59], a[72:75], v[44:47]
ds_read_b64_tr_b16 a[116:117], v9 offset:57344
v_mfma_f32_16x16x32_bf16 v[60:63], a[56:59], a[80:83], v[60:63]
ds_read_b64_tr_b16 a[118:119], v9 offset:58368
v_mfma_f32_16x16x32_bf16 v[60:63], a[60:63], a[84:87], v[60:63]
s_add_u32 m0, s76, 37888
ds_read_b64_tr_b16 a[72:73], v10 offset:49152
v_add_u32 v6, 0x8000, v6
v_mfma_f32_16x16x32_bf16 v[76:79], a[52:55], a[84:87], v[76:79]
s_add_u32 s64, s70, 41344
ds_read_b64_tr_b16 a[74:75], v10 offset:50176
v_mfma_f32_16x16x32_bf16 v[76:79], a[48:51], a[80:83], v[76:79]
buffer_load_dwordx4 v13, s[32:35], s64 offen lds
v_mfma_f32_16x16x32_bf16 v[140:143], a[40:43], a[80:83], v[140:143]
ds_read_b64_tr_b16 a[76:77], v10 offset:57344
v_mfma_f32_16x16x32_bf16 v[140:143], a[44:47], a[84:87], v[140:143]
ds_read_b64_tr_b16 a[78:79], v10 offset:58368
v_mfma_f32_16x16x32_bf16 v[124:127], a[36:39], a[84:87], v[124:127]
v_mfma_f32_16x16x32_bf16 v[124:127], a[32:35], a[80:83], v[124:127]
ds_read_b64_tr_b16 a[80:81], v11 offset:49152
v_mfma_f32_16x16x32_bf16 v[108:111], a[32:35], a[88:91], v[108:111]
s_add_u32 m0, s76, 38912
global_load_dwordx4 a[156:159], v18, s[4:5] offset:1536
v_mfma_f32_16x16x32_bf16 v[108:111], a[36:39], a[92:95], v[108:111]
s_add_u32 s64, s70, 49536
ds_read_b64_tr_b16 a[82:83], v11 offset:50176
v_add_u32 v7, 0x8000, v7
v_mfma_f32_16x16x32_bf16 v[92:95], a[44:47], a[92:95], v[92:95]
buffer_load_dwordx4 v12, s[32:35], s64 offen lds
v_mfma_f32_16x16x32_bf16 v[92:95], a[40:43], a[88:91], v[92:95]
ds_read_b64_tr_b16 a[84:85], v11 offset:57344
v_mfma_f32_16x16x32_bf16 v[32:35], a[48:51], a[88:91], v[32:35]
ds_read_b64_tr_b16 a[86:87], v11 offset:58368
v_mfma_f32_16x16x32_bf16 v[32:35], a[52:55], a[92:95], v[32:35]
v_mfma_f32_16x16x32_bf16 v[48:51], a[60:63], a[92:95], v[48:51]
v_mfma_f32_16x16x32_bf16 v[48:51], a[56:59], a[88:91], v[48:51]
s_add_u32 m0, s76, 39936
v_mfma_f32_16x16x32_bf16 v[64:67], a[56:59], a[96:99], v[64:67]
s_add_u32 s64, s70, 57728
v_mfma_f32_16x16x32_bf16 v[64:67], a[60:63], a[100:103], v[64:67]
buffer_load_dwordx4 v13, s[32:35], s64 offen lds
v_mfma_f32_16x16x32_bf16 v[80:83], a[52:55], a[100:103], v[80:83]
v_add_u32 v8, 0x8000, v8
v_mfma_f32_16x16x32_bf16 v[80:83], a[48:51], a[96:99], v[80:83]
v_mfma_f32_16x16x32_bf16 v[144:147], a[40:43], a[96:99], v[144:147]
v_mfma_f32_16x16x32_bf16 v[144:147], a[44:47], a[100:103], v[144:147]
v_mfma_f32_16x16x32_bf16 v[128:131], a[36:39], a[100:103], v[128:131]
v_add_u32 v9, 0x8000, v9
v_add_u32 v10, 0x8000, v10
v_mfma_f32_16x16x32_bf16 v[128:131], a[32:35], a[96:99], v[128:131]
s_waitcnt lgkmcnt(0)
v_add_u32 v11, 0x8000, v11
v_mfma_f32_16x16x32_bf16 v[112:115], a[32:35], a[104:107], v[112:115]
v_mfma_f32_16x16x32_bf16 v[112:115], a[36:39], a[108:111], v[112:115]
v_mfma_f32_16x16x32_bf16 v[96:99], a[44:47], a[108:111], v[96:99]
s_waitcnt lgkmcnt(0)
s_barrier
v_mfma_f32_16x16x32_bf16 v[96:99], a[40:43], a[104:107], v[96:99]
s_add_u32 m0, s77, 98304
ds_read_b64_tr_b16 a[88:89], v4 offset:32768
v_mfma_f32_16x16x32_bf16 v[36:39], a[48:51], a[104:107], v[36:39]
s_add_u32 s64, s71, 2097152
ds_read_b64_tr_b16 a[90:91], v4 offset:33792
v_mfma_f32_16x16x32_bf16 v[36:39], a[52:55], a[108:111], v[36:39]
buffer_load_dwordx4 v14, s[36:39], s64 offen lds
v_mfma_f32_16x16x32_bf16 v[52:55], a[60:63], a[108:111], v[52:55]
ds_read_b64_tr_b16 a[92:93], v4 offset:40960
v_mfma_f32_16x16x32_bf16 v[52:55], a[56:59], a[104:107], v[52:55]
ds_read_b64_tr_b16 a[94:95], v4 offset:41984
v_mfma_f32_16x16x32_bf16 v[68:71], a[56:59], a[112:115], v[68:71]
ds_read_b64_tr_b16 a[96:97], v5 offset:32768
v_mfma_f32_16x16x32_bf16 v[68:71], a[60:63], a[116:119], v[68:71]
ds_read_b64_tr_b16 a[98:99], v5 offset:33792
v_mfma_f32_16x16x32_bf16 v[84:87], a[52:55], a[116:119], v[84:87]
ds_read_b64_tr_b16 a[100:101], v5 offset:40960
v_mfma_f32_16x16x32_bf16 v[84:87], a[48:51], a[112:115], v[84:87]
s_add_u32 m0, s77, 99328
ds_read_b64_tr_b16 a[102:103], v5 offset:41984
v_mfma_f32_16x16x32_bf16 v[148:151], a[40:43], a[112:115], v[148:151]
s_add_u32 s64, s71, 2129920
global_load_dwordx4 a[172:175], v19, s[22:23] offset:1536
v_mfma_f32_16x16x32_bf16 v[148:151], a[44:47], a[116:119], v[148:151]
buffer_load_dwordx4 v14, s[36:39], s64 offen lds
v_mfma_f32_16x16x32_bf16 v[132:135], a[36:39], a[116:119], v[132:135]
ds_read_b64_tr_b16 a[104:105], v6 offset:32768
v_mfma_f32_16x16x32_bf16 v[132:135], a[32:35], a[112:115], v[132:135]
ds_read_b64_tr_b16 a[106:107], v6 offset:33792
v_mfma_f32_16x16x32_bf16 v[116:119], a[32:35], a[72:75], v[116:119]
ds_read_b64_tr_b16 a[108:109], v6 offset:40960
v_mfma_f32_16x16x32_bf16 v[116:119], a[36:39], a[76:79], v[116:119]
ds_read_b64_tr_b16 a[110:111], v6 offset:41984
v_mfma_f32_16x16x32_bf16 v[100:103], a[44:47], a[76:79], v[100:103]
ds_read_b64_tr_b16 a[112:113], v7 offset:32768
v_mfma_f32_16x16x32_bf16 v[100:103], a[40:43], a[72:75], v[100:103]
s_add_u32 m0, s77, 100352
ds_read_b64_tr_b16 a[114:115], v7 offset:33792
v_mfma_f32_16x16x32_bf16 a[120:123], a[48:51], a[72:75], a[120:123]
s_add_u32 s64, s71, 2162688
ds_read_b64_tr_b16 a[116:117], v7 offset:40960
v_mfma_f32_16x16x32_bf16 a[120:123], a[52:55], a[76:79], a[120:123]
buffer_load_dwordx4 v15, s[36:39], s64 offen lds
v_mfma_f32_16x16x32_bf16 a[124:127], a[60:63], a[76:79], a[124:127]
ds_read_b64_tr_b16 a[118:119], v7 offset:41984
v_mfma_f32_16x16x32_bf16 a[124:127], a[56:59], a[72:75], a[124:127]
ds_read_b64_tr_b16 a[72:73], v8 offset:32768
v_mfma_f32_16x16x32_bf16 a[128:131], a[56:59], a[80:83], a[128:131]
ds_read_b64_tr_b16 a[74:75], v8 offset:33792
v_mfma_f32_16x16x32_bf16 a[128:131], a[60:63], a[84:87], a[128:131]
ds_read_b64_tr_b16 a[76:77], v8 offset:40960
v_mfma_f32_16x16x32_bf16 a[132:135], a[52:55], a[84:87], a[132:135]
ds_read_b64_tr_b16 a[78:79], v8 offset:41984
v_mfma_f32_16x16x32_bf16 a[132:135], a[48:51], a[80:83], a[132:135]
s_add_u32 m0, s77, 101376
v_mfma_f32_16x16x32_bf16 a[136:139], a[40:43], a[80:83], a[136:139]
s_add_u32 s64, s71, 2195456
v_mfma_f32_16x16x32_bf16 a[136:139], a[44:47], a[84:87], a[136:139]
buffer_load_dwordx4 v15, s[36:39], s64 offen lds
v_mfma_f32_16x16x32_bf16 a[140:143], a[36:39], a[84:87], a[140:143]
v_mfma_f32_16x16x32_bf16 a[140:143], a[32:35], a[80:83], a[140:143]
s_waitcnt lgkmcnt(5)
ds_read_b64_tr_b16 a[80:81], v9 offset:32768
v_mfma_f32_16x16x32_bf16 v[184:187], a[88:91], a[0:3], v[184:187]
buffer_load_dword a252, v16, s[56:59], s81 offen
v_mfma_f32_16x16x32_bf16 v[184:187], a[92:95], a[4:7], v[184:187]
ds_read_b64_tr_b16 a[82:83], v9 offset:33792
v_mfma_f32_16x16x32_bf16 v[192:195], a[92:95], a[12:15], v[192:195]
ds_read_b64_tr_b16 a[84:85], v9 offset:40960
v_mfma_f32_16x16x32_bf16 v[192:195], a[88:91], a[8:11], v[192:195]
s_add_u32 m0, s77, 114688
s_add_u32 s17, s78, .-L_pc+6144
ds_read_b64_tr_b16 a[86:87], v9 offset:41984
v_mfma_f32_16x16x32_bf16 v[200:203], a[88:91], a[16:19], v[200:203]
s_add_u32 s64, s71, 2097152
buffer_load_dword a252, v16, s[88:91], s17 offen
v_mfma_f32_16x16x32_bf16 v[200:203], a[92:95], a[20:23], v[200:203]
buffer_load_dwordx4 v14, s[40:43], s64 offen lds
v_mfma_f32_16x16x32_bf16 v[208:211], a[92:95], a[28:31], v[208:211]
v_mfma_f32_16x16x32_bf16 v[208:211], a[88:91], a[24:27], v[208:211]
ds_read_b64_tr_b16 a[88:89], v10 offset:32768
v_mfma_f32_16x16x32_bf16 v[248:251], a[96:99], a[24:27], v[248:251]
ds_read_b64_tr_b16 a[90:91], v10 offset:33792
v_mfma_f32_16x16x32_bf16 v[248:251], a[100:103], a[28:31], v[248:251]
ds_read_b64_tr_b16 a[92:93], v10 offset:40960
v_mfma_f32_16x16x32_bf16 v[212:215], a[100:103], a[20:23], v[212:215]
buffer_store_dword v21, v20, s[44:47], s68 offen sc1
v_mfma_f32_16x16x32_bf16 v[212:215], a[96:99], a[16:19], v[212:215]
s_add_u32 m0, s77, 115712
ds_read_b64_tr_b16 a[94:95], v10 offset:41984
v_mfma_f32_16x16x32_bf16 v[204:207], a[96:99], a[8:11], v[204:207]
s_add_u32 s64, s71, 2129920
v_mfma_f32_16x16x32_bf16 v[204:207], a[100:103], a[12:15], v[204:207]
buffer_load_dwordx4 v14, s[40:43], s64 offen lds
v_mfma_f32_16x16x32_bf16 v[196:199], a[100:103], a[4:7], v[196:199]
v_mfma_f32_16x16x32_bf16 v[196:199], a[96:99], a[0:3], v[196:199]
ds_read_b64_tr_b16 a[96:97], v11 offset:32768
v_mfma_f32_16x16x32_bf16 v[188:191], a[104:107], a[0:3], v[188:191]
ds_read_b64_tr_b16 a[98:99], v11 offset:33792
v_mfma_f32_16x16x32_bf16 v[188:191], a[108:111], a[4:7], v[188:191]
ds_read_b64_tr_b16 a[100:101], v11 offset:40960
v_mfma_f32_16x16x32_bf16 v[216:219], a[108:111], a[12:15], v[216:219]
ds_read_b64_tr_b16 a[102:103], v11 offset:41984
v_mfma_f32_16x16x32_bf16 v[216:219], a[104:107], a[8:11], v[216:219]
s_add_u32 m0, s77, 116736
v_mfma_f32_16x16x32_bf16 v[224:227], a[104:107], a[16:19], v[224:227]
s_add_u32 s64, s71, 2162688
buffer_store_dword v21, v20, s[44:47], s69 offen sc1
v_mfma_f32_16x16x32_bf16 v[224:227], a[108:111], a[20:23], v[224:227]
buffer_load_dwordx4 v15, s[40:43], s64 offen lds
v_mfma_f32_16x16x32_bf16 v[232:235], a[108:111], a[28:31], v[232:235]
v_mfma_f32_16x16x32_bf16 v[232:235], a[104:107], a[24:27], v[232:235]
ds_read_b64_tr_b16 a[104:105], v4 offset:49152
v_mfma_f32_16x16x32_bf16 v[240:243], a[112:115], a[24:27], v[240:243]
s_waitcnt lgkmcnt(5)
ds_read_b64_tr_b16 a[106:107], v4 offset:50176
v_mfma_f32_16x16x32_bf16 v[240:243], a[116:119], a[28:31], v[240:243]
ds_read_b64_tr_b16 a[108:109], v4 offset:57344
v_mfma_f32_16x16x32_bf16 v[252:255], a[116:119], a[20:23], v[252:255]
ds_read_b64_tr_b16 a[110:111], v4 offset:58368
v_mfma_f32_16x16x32_bf16 v[252:255], a[112:115], a[16:19], v[252:255]
s_add_u32 m0, s77, 117760
v_mfma_f32_16x16x32_bf16 v[244:247], a[112:115], a[8:11], v[244:247]
s_add_u32 s64, s71, 2195456
v_mfma_f32_16x16x32_bf16 v[244:247], a[116:119], a[12:15], v[244:247]
buffer_load_dwordx4 v15, s[40:43], s64 offen lds
v_mfma_f32_16x16x32_bf16 v[236:239], a[116:119], a[4:7], v[236:239]
v_mfma_f32_16x16x32_bf16 v[236:239], a[112:115], a[0:3], v[236:239]
ds_read_b64_tr_b16 a[112:113], v5 offset:49152
v_mfma_f32_16x16x32_bf16 v[228:231], a[72:75], a[0:3], v[228:231]
ds_read_b64_tr_b16 a[114:115], v5 offset:50176
v_mfma_f32_16x16x32_bf16 v[228:231], a[76:79], a[4:7], v[228:231]
ds_read_b64_tr_b16 a[116:117], v5 offset:57344
v_mfma_f32_16x16x32_bf16 v[220:223], a[76:79], a[12:15], v[220:223]
ds_read_b64_tr_b16 a[118:119], v5 offset:58368
v_mfma_f32_16x16x32_bf16 v[220:223], a[72:75], a[8:11], v[220:223]
v_mfma_f32_16x16x32_bf16 v[152:155], a[72:75], a[16:19], v[152:155]
v_mfma_f32_16x16x32_bf16 v[152:155], a[76:79], a[20:23], v[152:155]
v_mfma_f32_16x16x32_bf16 v[160:163], a[76:79], a[28:31], v[160:163]
s_add_u32 m0, s76, 0
v_mfma_f32_16x16x32_bf16 v[160:163], a[72:75], a[24:27], v[160:163]
s_add_u32 s64, s70, 512
ds_read_b64_tr_b16 a[72:73], v6 offset:49152
v_mfma_f32_16x16x32_bf16 v[168:171], a[80:83], a[24:27], v[168:171]
buffer_load_dwordx4 v12, s[32:35], s64 offen lds
v_mfma_f32_16x16x32_bf16 v[168:171], a[84:87], a[28:31], v[168:171]
ds_read_b64_tr_b16 a[74:75], v6 offset:50176
v_mfma_f32_16x16x32_bf16 v[176:179], a[84:87], a[20:23], v[176:179]
ds_read_b64_tr_b16 a[76:77], v6 offset:57344
v_mfma_f32_16x16x32_bf16 v[176:179], a[80:83], a[16:19], v[176:179]
ds_read_b64_tr_b16 a[78:79], v6 offset:58368
v_mfma_f32_16x16x32_bf16 v[180:183], a[80:83], a[8:11], v[180:183]
buffer_load_dword a252, v1, s[60:63], s82 offen
v_mfma_f32_16x16x32_bf16 v[180:183], a[84:87], a[12:15], v[180:183]
s_add_u32 m0, s76, 1024
v_mfma_f32_16x16x32_bf16 v[172:175], a[84:87], a[4:7], v[172:175]
s_add_u32 s64, s70, 8704
v_mfma_f32_16x16x32_bf16 v[172:175], a[80:83], a[0:3], v[172:175]
buffer_load_dwordx4 v13, s[32:35], s64 offen lds
v_mfma_f32_16x16x32_bf16 v[164:167], a[88:91], a[0:3], v[164:167]
ds_read_b64_tr_b16 a[80:81], v7 offset:49152
v_mfma_f32_16x16x32_bf16 v[164:167], a[92:95], a[4:7], v[164:167]
ds_read_b64_tr_b16 a[82:83], v7 offset:50176
v_mfma_f32_16x16x32_bf16 v[156:159], a[92:95], a[12:15], v[156:159]
ds_read_b64_tr_b16 a[84:85], v7 offset:57344
v_mfma_f32_16x16x32_bf16 v[156:159], a[88:91], a[8:11], v[156:159]
ds_read_b64_tr_b16 a[86:87], v7 offset:58368
v_mfma_f32_16x16x32_bf16 v[24:27], a[88:91], a[16:19], v[24:27]
s_add_u32 m0, s76, 2048
v_mfma_f32_16x16x32_bf16 v[24:27], a[92:95], a[20:23], v[24:27]
s_add_u32 s64, s70, 16896
v_mfma_f32_16x16x32_bf16 v[40:43], a[92:95], a[28:31], v[40:43]
s_waitcnt vmcnt(16)
buffer_load_dwordx4 v12, s[32:35], s64 offen lds
v_mfma_f32_16x16x32_bf16 v[40:43], a[88:91], a[24:27], v[40:43]
s_waitcnt lgkmcnt(4)
ds_read_b64_tr_b16 a[88:89], v8 offset:49152
v_mfma_f32_16x16x32_bf16 v[56:59], a[96:99], a[24:27], v[56:59]
ds_read_b64_tr_b16 a[90:91], v8 offset:50176
v_mfma_f32_16x16x32_bf16 v[56:59], a[100:103], a[28:31], v[56:59]
ds_read_b64_tr_b16 a[92:93], v8 offset:57344
v_subrev_u32 v4, 0x8000, v4
v_mfma_f32_16x16x32_bf16 v[72:75], a[100:103], a[20:23], v[72:75]
ds_read_b64_tr_b16 a[94:95], v8 offset:58368
v_mfma_f32_16x16x32_bf16 v[72:75], a[96:99], a[16:19], v[72:75]
s_add_u32 m0, s76, 3072
ds_read_b128 a[32:35], v2 offset:32768
v_mfma_f32_16x16x32_bf16 v[136:139], a[96:99], a[8:11], v[136:139]
s_add_u32 s64, s70, 25088
ds_read_b128 a[36:39], v3 offset:32768
v_mfma_f32_16x16x32_bf16 v[136:139], a[100:103], a[12:15], v[136:139]
buffer_load_dwordx4 v13, s[32:35], s64 offen lds
v_mfma_f32_16x16x32_bf16 v[120:123], a[100:103], a[4:7], v[120:123]
ds_read_b128 a[40:43], v2 offset:34816
v_mfma_f32_16x16x32_bf16 v[120:123], a[96:99], a[0:3], v[120:123]
ds_read_b128 a[44:47], v3 offset:34816
v_mfma_f32_16x16x32_bf16 v[104:107], a[0:3], a[104:107], v[104:107]
ds_read_b128 a[48:51], v2 offset:36864
v_mfma_f32_16x16x32_bf16 v[104:107], a[4:7], a[108:111], v[104:107]
ds_read_b128 a[52:55], v3 offset:36864
v_subrev_u32 v5, 0x8000, v5
v_mfma_f32_16x16x32_bf16 v[88:91], a[12:15], a[108:111], v[88:91]
s_add_u32 m0, s76, 4096
ds_read_b128 a[56:59], v2 offset:38912
v_mfma_f32_16x16x32_bf16 v[88:91], a[8:11], a[104:107], v[88:91]
s_add_u32 s64, s70, 33280
ds_read_b128 a[60:63], v3 offset:38912
v_mfma_f32_16x16x32_bf16 v[28:31], a[16:19], a[104:107], v[28:31]
buffer_load_dwordx4 v12, s[32:35], s64 offen lds
v_mfma_f32_16x16x32_bf16 v[28:31], a[20:23], a[108:111], v[28:31]
ds_read_b64_tr_b16 a[96:97], v9 offset:49152
v_mfma_f32_16x16x32_bf16 v[44:47], a[28:31], a[108:111], v[44:47]
ds_read_b64_tr_b16 a[98:99], v9 offset:50176
v_mfma_f32_16x16x32_bf16 v[44:47], a[24:27], a[104:107], v[44:47]
ds_read_b64_tr_b16 a[100:101], v9 offset:57344
v_mfma_f32_16x16x32_bf16 v[60:63], a[24:27], a[112:115], v[60:63]
ds_read_b64_tr_b16 a[102:103], v9 offset:58368
v_mfma_f32_16x16x32_bf16 v[60:63], a[28:31], a[116:119], v[60:63]
s_add_u32 m0, s76, 5120
ds_read_b64_tr_b16 a[104:105], v10 offset:49152
v_subrev_u32 v6, 0x8000, v6
v_mfma_f32_16x16x32_bf16 v[76:79], a[20:23], a[116:119], v[76:79]
s_add_u32 s64, s70, 41472
ds_read_b64_tr_b16 a[106:107], v10 offset:50176
v_mfma_f32_16x16x32_bf16 v[76:79], a[16:19], a[112:115], v[76:79]
buffer_load_dwordx4 v13, s[32:35], s64 offen lds
v_mfma_f32_16x16x32_bf16 v[140:143], a[8:11], a[112:115], v[140:143]
ds_read_b64_tr_b16 a[108:109], v10 offset:57344
v_mfma_f32_16x16x32_bf16 v[140:143], a[12:15], a[116:119], v[140:143]
ds_read_b64_tr_b16 a[110:111], v10 offset:58368
v_mfma_f32_16x16x32_bf16 v[124:127], a[4:7], a[116:119], v[124:127]
v_mfma_f32_16x16x32_bf16 v[124:127], a[0:3], a[112:115], v[124:127]
ds_read_b64_tr_b16 a[112:113], v11 offset:49152
v_mfma_f32_16x16x32_bf16 v[108:111], a[0:3], a[72:75], v[108:111]
s_add_u32 m0, s76, 6144
ds_read_b64_tr_b16 a[114:115], v11 offset:50176
v_mfma_f32_16x16x32_bf16 v[108:111], a[4:7], a[76:79], v[108:111]
s_add_u32 s64, s70, 49664
ds_read_b64_tr_b16 a[116:117], v11 offset:57344
v_subrev_u32 v7, 0x8000, v7
v_mfma_f32_16x16x32_bf16 v[92:95], a[12:15], a[76:79], v[92:95]
buffer_load_dwordx4 v12, s[32:35], s64 offen lds
v_mfma_f32_16x16x32_bf16 v[92:95], a[8:11], a[72:75], v[92:95]
ds_read_b64_tr_b16 a[118:119], v11 offset:58368
v_mfma_f32_16x16x32_bf16 v[32:35], a[16:19], a[72:75], v[32:35]
v_mfma_f32_16x16x32_bf16 v[32:35], a[20:23], a[76:79], v[32:35]
v_mfma_f32_16x16x32_bf16 v[48:51], a[28:31], a[76:79], v[48:51]
v_mfma_f32_16x16x32_bf16 v[48:51], a[24:27], a[72:75], v[48:51]
s_waitcnt lgkmcnt(4)
s_add_u32 m0, s76, 7168
s_add_u32 s81, s81, 1048576
v_mfma_f32_16x16x32_bf16 v[64:67], a[24:27], a[80:83], v[64:67]
s_add_u32 s64, s70, 57856
buffer_load_dword a252, v16, s[56:59], s81 offen
v_mfma_f32_16x16x32_bf16 v[64:67], a[28:31], a[84:87], v[64:67]
buffer_load_dwordx4 v13, s[32:35], s64 offen lds
v_mfma_f32_16x16x32_bf16 v[80:83], a[20:23], a[84:87], v[80:83]
v_subrev_u32 v8, 0x8000, v8
v_mfma_f32_16x16x32_bf16 v[80:83], a[16:19], a[80:83], v[80:83]
v_mfma_f32_16x16x32_bf16 v[144:147], a[8:11], a[80:83], v[144:147]
v_mfma_f32_16x16x32_bf16 v[144:147], a[12:15], a[84:87], v[144:147]
v_mfma_f32_16x16x32_bf16 v[128:131], a[4:7], a[84:87], v[128:131]
v_subrev_u32 v9, 0x8000, v9
v_subrev_u32 v10, 0x8000, v10
v_mfma_f32_16x16x32_bf16 v[128:131], a[0:3], a[80:83], v[128:131]
v_subrev_u32 v11, 0x8000, v11
v_mfma_f32_16x16x32_bf16 v[112:115], a[0:3], a[88:91], v[112:115]
v_mfma_f32_16x16x32_bf16 v[112:115], a[4:7], a[92:95], v[112:115]
v_mfma_f32_16x16x32_bf16 v[96:99], a[12:15], a[92:95], v[96:99]
s_waitcnt lgkmcnt(0)
s_barrier
v_mfma_f32_16x16x32_bf16 v[96:99], a[8:11], a[88:91], v[96:99]
s_add_u32 m0, s77, 131072
ds_read_b64_tr_b16 a[72:73], v4 offset:0
v_mfma_f32_16x16x32_bf16 v[36:39], a[16:19], a[88:91], v[36:39]
s_add_u32 s64, s71, 2621440
ds_read_b64_tr_b16 a[74:75], v4 offset:1024
v_mfma_f32_16x16x32_bf16 v[36:39], a[20:23], a[92:95], v[36:39]
buffer_load_dwordx4 v14, s[36:39], s64 offen lds
v_mfma_f32_16x16x32_bf16 v[52:55], a[28:31], a[92:95], v[52:55]
ds_read_b64_tr_b16 a[76:77], v4 offset:8192
v_mfma_f32_16x16x32_bf16 v[52:55], a[24:27], a[88:91], v[52:55]
ds_read_b64_tr_b16 a[78:79], v4 offset:9216
v_mfma_f32_16x16x32_bf16 v[68:71], a[24:27], a[96:99], v[68:71]
ds_read_b64_tr_b16 a[80:81], v5 offset:0
v_mfma_f32_16x16x32_bf16 v[68:71], a[28:31], a[100:103], v[68:71]
ds_read_b64_tr_b16 a[82:83], v5 offset:1024
v_mfma_f32_16x16x32_bf16 v[84:87], a[20:23], a[100:103], v[84:87]
ds_read_b64_tr_b16 a[84:85], v5 offset:8192
v_mfma_f32_16x16x32_bf16 v[84:87], a[16:19], a[96:99], v[84:87]
s_add_u32 m0, s77, 132096
ds_read_b64_tr_b16 a[86:87], v5 offset:9216
v_mfma_f32_16x16x32_bf16 v[148:151], a[8:11], a[96:99], v[148:151]
s_add_u32 s64, s71, 2654208
ds_read_b64_tr_b16 a[88:89], v6 offset:0
v_mfma_f32_16x16x32_bf16 v[148:151], a[12:15], a[100:103], v[148:151]
buffer_load_dwordx4 v14, s[36:39], s64 offen lds
v_mfma_f32_16x16x32_bf16 v[132:135], a[4:7], a[100:103], v[132:135]
ds_read_b64_tr_b16 a[90:91], v6 offset:1024
v_mfma_f32_16x16x32_bf16 v[132:135], a[0:3], a[96:99], v[132:135]
ds_read_b64_tr_b16 a[92:93], v6 offset:8192
v_mfma_f32_16x16x32_bf16 v[116:119], a[0:3], a[104:107], v[116:119]
ds_read_b64_tr_b16 a[94:95], v6 offset:9216
v_mfma_f32_16x16x32_bf16 v[116:119], a[4:7], a[108:111], v[116:119]
ds_read_b64_tr_b16 a[96:97], v7 offset:0
v_mfma_f32_16x16x32_bf16 v[100:103], a[12:15], a[108:111], v[100:103]
ds_read_b64_tr_b16 a[98:99], v7 offset:1024
v_mfma_f32_16x16x32_bf16 v[100:103], a[8:11], a[104:107], v[100:103]
s_add_u32 m0, s77, 133120
ds_read_b64_tr_b16 a[100:101], v7 offset:8192
v_mfma_f32_16x16x32_bf16 a[120:123], a[16:19], a[104:107], a[120:123]
s_add_u32 s64, s71, 2686976
ds_read_b64_tr_b16 a[102:103], v7 offset:9216
v_mfma_f32_16x16x32_bf16 a[120:123], a[20:23], a[108:111], a[120:123]
buffer_load_dwordx4 v15, s[36:39], s64 offen lds
v_mfma_f32_16x16x32_bf16 a[124:127], a[28:31], a[108:111], a[124:127]
v_mfma_f32_16x16x32_bf16 a[124:127], a[24:27], a[104:107], a[124:127]
ds_read_b64_tr_b16 a[104:105], v8 offset:0
v_mfma_f32_16x16x32_bf16 a[128:131], a[24:27], a[112:115], a[128:131]
ds_read_b64_tr_b16 a[106:107], v8 offset:1024
v_mfma_f32_16x16x32_bf16 a[128:131], a[28:31], a[116:119], a[128:131]
ds_read_b64_tr_b16 a[108:109], v8 offset:8192
v_mfma_f32_16x16x32_bf16 a[132:135], a[20:23], a[116:119], a[132:135]
ds_read_b64_tr_b16 a[110:111], v8 offset:9216
v_mfma_f32_16x16x32_bf16 a[132:135], a[16:19], a[112:115], a[132:135]
s_add_u32 m0, s77, 134144
v_mfma_f32_16x16x32_bf16 a[136:139], a[8:11], a[112:115], a[136:139]
s_add_u32 s64, s71, 2719744
v_mfma_f32_16x16x32_bf16 a[136:139], a[12:15], a[116:119], a[136:139]
buffer_load_dwordx4 v15, s[36:39], s64 offen lds
v_mfma_f32_16x16x32_bf16 a[140:143], a[4:7], a[116:119], a[140:143]
v_mfma_f32_16x16x32_bf16 a[140:143], a[0:3], a[112:115], a[140:143]
s_waitcnt lgkmcnt(4)
ds_read_b64_tr_b16 a[112:113], v9 offset:0
v_mfma_f32_16x16x32_bf16 v[184:187], a[72:75], a[32:35], v[184:187]
ds_read_b64_tr_b16 a[114:115], v9 offset:1024
v_mov_b32 v17, 0
v_mfma_f32_16x16x32_bf16 v[184:187], a[76:79], a[36:39], v[184:187]
ds_read_b64_tr_b16 a[116:117], v9 offset:8192
v_accvgpr_read_b32 v19, a144
v_mfma_f32_16x16x32_bf16 v[192:195], a[76:79], a[44:47], v[192:195]
s_add_u32 s82, s82, 1048576
ds_read_b64_tr_b16 a[118:119], v9 offset:9216
v_accvgpr_read_b32 v21, a160
v_mfma_f32_16x16x32_bf16 v[192:195], a[72:75], a[40:43], v[192:195]
s_add_u32 m0, s77, 147456
v_lshlrev_b32 v18, 16, v19
v_and_b32 v19, 0xffff0000, v19
v_mfma_f32_16x16x32_bf16 v[200:203], a[72:75], a[48:51], v[200:203]
s_add_u32 s64, s71, 2621440
buffer_load_dword a252, v1, s[60:63], s82 offen
v_mfma_f32_16x16x32_bf16 v[200:203], a[76:79], a[52:55], v[200:203]
buffer_load_dwordx4 v14, s[40:43], s64 offen lds
v_mfma_f32_16x16x32_bf16 v[208:211], a[76:79], a[60:63], v[208:211]
v_lshlrev_b32 v20, 16, v21
v_and_b32 v21, 0xffff0000, v21
v_mfma_f32_16x16x32_bf16 v[208:211], a[72:75], a[56:59], v[208:211]
ds_read_b64_tr_b16 a[72:73], v10 offset:0
v_mul_f32 v18, v18, v20
v_mfma_f32_16x16x32_bf16 v[248:251], a[80:83], a[56:59], v[248:251]
ds_read_b64_tr_b16 a[74:75], v10 offset:1024
v_mul_f32 v19, v19, v21
v_mfma_f32_16x16x32_bf16 v[248:251], a[84:87], a[60:63], v[248:251]
ds_read_b64_tr_b16 a[76:77], v10 offset:8192
v_cvt_pk_bf16_f32 v18, v18, v19
v_mfma_f32_16x16x32_bf16 v[212:215], a[84:87], a[52:55], v[212:215]
ds_read_b64_tr_b16 a[78:79], v10 offset:9216
v_lshlrev_b32 v19, 16, v18
v_mfma_f32_16x16x32_bf16 v[212:215], a[80:83], a[48:51], v[212:215]
s_add_u32 m0, s77, 148480
v_and_b32 v18, 0xffff0000, v18
v_add_f32 v17, v17, v19
v_mfma_f32_16x16x32_bf16 v[204:207], a[80:83], a[40:43], v[204:207]
s_add_u32 s64, s71, 2654208
v_add_f32 v17, v17, v18
v_accvgpr_read_b32 v19, a145
v_mfma_f32_16x16x32_bf16 v[204:207], a[84:87], a[44:47], v[204:207]
buffer_load_dwordx4 v14, s[40:43], s64 offen lds
v_mfma_f32_16x16x32_bf16 v[196:199], a[84:87], a[36:39], v[196:199]
v_accvgpr_read_b32 v21, a161
v_lshlrev_b32 v18, 16, v19
v_mfma_f32_16x16x32_bf16 v[196:199], a[80:83], a[32:35], v[196:199]
ds_read_b64_tr_b16 a[80:81], v11 offset:0
v_and_b32 v19, 0xffff0000, v19
v_mfma_f32_16x16x32_bf16 v[188:191], a[88:91], a[32:35], v[188:191]
ds_read_b64_tr_b16 a[82:83], v11 offset:1024
v_lshlrev_b32 v20, 16, v21
v_mfma_f32_16x16x32_bf16 v[188:191], a[92:95], a[36:39], v[188:191]
ds_read_b64_tr_b16 a[84:85], v11 offset:8192
v_and_b32 v21, 0xffff0000, v21
v_mfma_f32_16x16x32_bf16 v[216:219], a[92:95], a[44:47], v[216:219]
ds_read_b64_tr_b16 a[86:87], v11 offset:9216
v_mul_f32 v18, v18, v20
v_mfma_f32_16x16x32_bf16 v[216:219], a[88:91], a[40:43], v[216:219]
s_add_u32 m0, s77, 149504
v_mul_f32 v19, v19, v21
v_cvt_pk_bf16_f32 v18, v18, v19
v_mfma_f32_16x16x32_bf16 v[224:227], a[88:91], a[48:51], v[224:227]
s_add_u32 s64, s71, 2686976
v_lshlrev_b32 v19, 16, v18
v_and_b32 v18, 0xffff0000, v18
v_mfma_f32_16x16x32_bf16 v[224:227], a[92:95], a[52:55], v[224:227]
buffer_load_dwordx4 v15, s[40:43], s64 offen lds
v_mfma_f32_16x16x32_bf16 v[232:235], a[92:95], a[60:63], v[232:235]
v_add_f32 v17, v17, v19
v_add_f32 v17, v17, v18
v_mfma_f32_16x16x32_bf16 v[232:235], a[88:91], a[56:59], v[232:235]
ds_read_b64_tr_b16 a[88:89], v4 offset:16384
v_accvgpr_read_b32 v19, a146
v_mfma_f32_16x16x32_bf16 v[240:243], a[96:99], a[56:59], v[240:243]
ds_read_b64_tr_b16 a[90:91], v4 offset:17408
v_accvgpr_read_b32 v21, a162
v_mfma_f32_16x16x32_bf16 v[240:243], a[100:103], a[60:63], v[240:243]
ds_read_b64_tr_b16 a[92:93], v4 offset:24576
v_lshlrev_b32 v18, 16, v19
v_mfma_f32_16x16x32_bf16 v[252:255], a[100:103], a[52:55], v[252:255]
ds_read_b64_tr_b16 a[94:95], v4 offset:25600
v_and_b32 v19, 0xffff0000, v19
v_mfma_f32_16x16x32_bf16 v[252:255], a[96:99], a[48:51], v[252:255]
s_add_u32 m0, s77, 150528
v_lshlrev_b32 v20, 16, v21
v_and_b32 v21, 0xffff0000, v21
v_mfma_f32_16x16x32_bf16 v[244:247], a[96:99], a[40:43], v[244:247]
s_add_u32 s64, s71, 2719744
v_mul_f32 v18, v18, v20
v_mul_f32 v19, v19, v21
v_mfma_f32_16x16x32_bf16 v[244:247], a[100:103], a[44:47], v[244:247]
buffer_load_dwordx4 v15, s[40:43], s64 offen lds
v_mfma_f32_16x16x32_bf16 v[236:239], a[100:103], a[36:39], v[236:239]
v_cvt_pk_bf16_f32 v18, v18, v19
v_lshlrev_b32 v19, 16, v18
v_mfma_f32_16x16x32_bf16 v[236:239], a[96:99], a[32:35], v[236:239]
s_waitcnt lgkmcnt(4)
ds_read_b64_tr_b16 a[96:97], v5 offset:16384
v_and_b32 v18, 0xffff0000, v18
v_mfma_f32_16x16x32_bf16 v[228:231], a[104:107], a[32:35], v[228:231]
ds_read_b64_tr_b16 a[98:99], v5 offset:17408
v_add_f32 v17, v17, v19
v_mfma_f32_16x16x32_bf16 v[228:231], a[108:111], a[36:39], v[228:231]
ds_read_b64_tr_b16 a[100:101], v5 offset:24576
v_add_f32 v17, v17, v18
v_mfma_f32_16x16x32_bf16 v[220:223], a[108:111], a[44:47], v[220:223]
ds_read_b64_tr_b16 a[102:103], v5 offset:25600
v_accvgpr_read_b32 v19, a147
v_mfma_f32_16x16x32_bf16 v[220:223], a[104:107], a[40:43], v[220:223]
v_accvgpr_read_b32 v21, a163
v_lshlrev_b32 v18, 16, v19
v_mfma_f32_16x16x32_bf16 v[152:155], a[104:107], a[48:51], v[152:155]
v_and_b32 v19, 0xffff0000, v19
v_lshlrev_b32 v20, 16, v21
v_mfma_f32_16x16x32_bf16 v[152:155], a[108:111], a[52:55], v[152:155]
v_and_b32 v21, 0xffff0000, v21
v_mul_f32 v18, v18, v20
v_mfma_f32_16x16x32_bf16 v[160:163], a[108:111], a[60:63], v[160:163]
s_add_u32 m0, s76, 32768
v_mul_f32 v19, v19, v21
v_cvt_pk_bf16_f32 v18, v18, v19
v_mfma_f32_16x16x32_bf16 v[160:163], a[104:107], a[56:59], v[160:163]
s_add_u32 s64, s70, 640
ds_read_b64_tr_b16 a[104:105], v6 offset:16384
v_lshlrev_b32 v19, 16, v18
v_mfma_f32_16x16x32_bf16 v[168:171], a[112:115], a[56:59], v[168:171]
buffer_load_dwordx4 v12, s[32:35], s64 offen lds
v_mfma_f32_16x16x32_bf16 v[168:171], a[116:119], a[60:63], v[168:171]
ds_read_b64_tr_b16 a[106:107], v6 offset:17408
v_and_b32 v18, 0xffff0000, v18
v_mfma_f32_16x16x32_bf16 v[176:179], a[116:119], a[52:55], v[176:179]
ds_read_b64_tr_b16 a[108:109], v6 offset:24576
v_add_f32 v17, v17, v19
v_mfma_f32_16x16x32_bf16 v[176:179], a[112:115], a[48:51], v[176:179]
ds_read_b64_tr_b16 a[110:111], v6 offset:25600
v_add_f32 v17, v17, v18
v_mfma_f32_16x16x32_bf16 v[180:183], a[112:115], a[40:43], v[180:183]
v_accvgpr_read_b32 v19, a148
v_accvgpr_read_b32 v21, a164
v_mfma_f32_16x16x32_bf16 v[180:183], a[116:119], a[44:47], v[180:183]
s_add_u32 m0, s76, 33792
v_lshlrev_b32 v18, 16, v19
v_and_b32 v19, 0xffff0000, v19
v_mfma_f32_16x16x32_bf16 v[172:175], a[116:119], a[36:39], v[172:175]
s_add_u32 s64, s70, 8832
v_lshlrev_b32 v20, 16, v21
v_and_b32 v21, 0xffff0000, v21
v_mfma_f32_16x16x32_bf16 v[172:175], a[112:115], a[32:35], v[172:175]
s_add_u32 s81, s81, 1048576
buffer_load_dwordx4 v13, s[32:35], s64 offen lds
v_mfma_f32_16x16x32_bf16 v[164:167], a[72:75], a[32:35], v[164:167]
buffer_load_dword a252, v16, s[56:59], s81 offen
v_mfma_f32_16x16x32_bf16 v[164:167], a[76:79], a[36:39], v[164:167]
ds_read_b64_tr_b16 a[112:113], v7 offset:16384
v_mul_f32 v18, v18, v20
v_mfma_f32_16x16x32_bf16 v[156:159], a[76:79], a[44:47], v[156:159]
ds_read_b64_tr_b16 a[114:115], v7 offset:17408
v_mul_f32 v19, v19, v21
v_mfma_f32_16x16x32_bf16 v[156:159], a[72:75], a[40:43], v[156:159]
ds_read_b64_tr_b16 a[116:117], v7 offset:24576
v_cvt_pk_bf16_f32 v18, v18, v19
v_mfma_f32_16x16x32_bf16 v[24:27], a[72:75], a[48:51], v[24:27]
s_add_u32 m0, s76, 34816
ds_read_b64_tr_b16 a[118:119], v7 offset:25600
v_lshlrev_b32 v19, 16, v18
v_mfma_f32_16x16x32_bf16 v[24:27], a[76:79], a[52:55], v[24:27]
s_add_u32 s64, s70, 17024
v_and_b32 v18, 0xffff0000, v18
v_add_f32 v17, v17, v19
v_mfma_f32_16x16x32_bf16 v[40:43], a[76:79], a[60:63], v[40:43]
s_waitcnt vmcnt(12)
buffer_load_dwordx4 v12, s[32:35], s64 offen lds
v_mfma_f32_16x16x32_bf16 v[40:43], a[72:75], a[56:59], v[40:43]
ds_read_b64_tr_b16 a[72:73], v8 offset:16384
v_add_f32 v17, v17, v18
v_mfma_f32_16x16x32_bf16 v[56:59], a[80:83], a[56:59], v[56:59]
ds_read_b64_tr_b16 a[74:75], v8 offset:17408
v_accvgpr_read_b32 v19, a149
v_mfma_f32_16x16x32_bf16 v[56:59], a[84:87], a[60:63], v[56:59]
ds_read_b64_tr_b16 a[76:77], v8 offset:24576
v_accvgpr_read_b32 v21, a165
v_mfma_f32_16x16x32_bf16 v[72:75], a[84:87], a[52:55], v[72:75]
ds_read_b64_tr_b16 a[78:79], v8 offset:25600
v_lshlrev_b32 v18, 16, v19
v_mfma_f32_16x16x32_bf16 v[72:75], a[80:83], a[48:51], v[72:75]
s_add_u32 m0, s76, 35840
ds_read_b128 a[0:3], v2 offset:0
v_and_b32 v19, 0xffff0000, v19
v_mfma_f32_16x16x32_bf16 v[136:139], a[80:83], a[40:43], v[136:139]
s_add_u32 s64, s70, 25216
ds_read_b128 a[4:7], v3 offset:0
v_lshlrev_b32 v20, 16, v21
v_mfma_f32_16x16x32_bf16 v[136:139], a[84:87], a[44:47], v[136:139]
buffer_load_dwordx4 v13, s[32:35], s64 offen lds
v_mfma_f32_16x16x32_bf16 v[120:123], a[84:87], a[36:39], v[120:123]
ds_read_b128 a[8:11], v2 offset:2048
v_and_b32 v21, 0xffff0000, v21
v_mfma_f32_16x16x32_bf16 v[120:123], a[80:83], a[32:35], v[120:123]
s_waitcnt lgkmcnt(7)
ds_read_b128 a[12:15], v3 offset:2048
v_mul_f32 v18, v18, v20
v_mfma_f32_16x16x32_bf16 v[104:107], a[32:35], a[88:91], v[104:107]
ds_read_b128 a[16:19], v2 offset:4096
v_mul_f32 v19, v19, v21
v_mfma_f32_16x16x32_bf16 v[104:107], a[36:39], a[92:95], v[104:107]
ds_read_b128 a[20:23], v3 offset:4096
v_cvt_pk_bf16_f32 v18, v18, v19
v_mfma_f32_16x16x32_bf16 v[88:91], a[44:47], a[92:95], v[88:91]
s_add_u32 m0, s76, 36864
ds_read_b128 a[24:27], v2 offset:6144
v_lshlrev_b32 v19, 16, v18
v_mfma_f32_16x16x32_bf16 v[88:91], a[40:43], a[88:91], v[88:91]
s_add_u32 s64, s70, 33408
ds_read_b128 a[28:31], v3 offset:6144
v_and_b32 v18, 0xffff0000, v18
v_mfma_f32_16x16x32_bf16 v[28:31], a[48:51], a[88:91], v[28:31]
buffer_load_dwordx4 v12, s[32:35], s64 offen lds
v_mfma_f32_16x16x32_bf16 v[28:31], a[52:55], a[92:95], v[28:31]
ds_read_b64_tr_b16 a[80:81], v9 offset:16384
v_add_f32 v17, v17, v19
v_mfma_f32_16x16x32_bf16 v[44:47], a[60:63], a[92:95], v[44:47]
ds_read_b64_tr_b16 a[82:83], v9 offset:17408
v_add_f32 v17, v17, v18
v_mfma_f32_16x16x32_bf16 v[44:47], a[56:59], a[88:91], v[44:47]
ds_read_b64_tr_b16 a[84:85], v9 offset:24576
v_accvgpr_read_b32 v19, a150
v_mfma_f32_16x16x32_bf16 v[60:63], a[56:59], a[96:99], v[60:63]
ds_read_b64_tr_b16 a[86:87], v9 offset:25600
v_accvgpr_read_b32 v21, a166
v_mfma_f32_16x16x32_bf16 v[60:63], a[60:63], a[100:103], v[60:63]
s_add_u32 m0, s76, 37888
ds_read_b64_tr_b16 a[88:89], v10 offset:16384
v_lshlrev_b32 v18, 16, v19
v_mfma_f32_16x16x32_bf16 v[76:79], a[52:55], a[100:103], v[76:79]
s_add_u32 s64, s70, 41600
ds_read_b64_tr_b16 a[90:91], v10 offset:17408
v_and_b32 v19, 0xffff0000, v19
v_mfma_f32_16x16x32_bf16 v[76:79], a[48:51], a[96:99], v[76:79]
buffer_load_dwordx4 v13, s[32:35], s64 offen lds
v_mfma_f32_16x16x32_bf16 v[140:143], a[40:43], a[96:99], v[140:143]
ds_read_b64_tr_b16 a[92:93], v10 offset:24576
v_lshlrev_b32 v20, 16, v21
v_mfma_f32_16x16x32_bf16 v[140:143], a[44:47], a[100:103], v[140:143]
ds_read_b64_tr_b16 a[94:95], v10 offset:25600
v_and_b32 v21, 0xffff0000, v21
v_mfma_f32_16x16x32_bf16 v[124:127], a[36:39], a[100:103], v[124:127]
v_mul_f32 v18, v18, v20
v_mul_f32 v19, v19, v21
v_mfma_f32_16x16x32_bf16 v[124:127], a[32:35], a[96:99], v[124:127]
ds_read_b64_tr_b16 a[96:97], v11 offset:16384
v_cvt_pk_bf16_f32 v18, v18, v19
v_mfma_f32_16x16x32_bf16 v[108:111], a[32:35], a[104:107], v[108:111]
s_add_u32 m0, s76, 38912
ds_read_b64_tr_b16 a[98:99], v11 offset:17408
v_lshlrev_b32 v19, 16, v18
v_mfma_f32_16x16x32_bf16 v[108:111], a[36:39], a[108:111], v[108:111]
s_add_u32 s64, s70, 49792
ds_read_b64_tr_b16 a[100:101], v11 offset:24576
v_and_b32 v18, 0xffff0000, v18
v_mfma_f32_16x16x32_bf16 v[92:95], a[44:47], a[108:111], v[92:95]
buffer_load_dwordx4 v12, s[32:35], s64 offen lds
v_mfma_f32_16x16x32_bf16 v[92:95], a[40:43], a[104:107], v[92:95]
ds_read_b64_tr_b16 a[102:103], v11 offset:25600
v_add_f32 v17, v17, v19
v_mfma_f32_16x16x32_bf16 v[32:35], a[48:51], a[104:107], v[32:35]
v_add_f32 v17, v17, v18
v_accvgpr_read_b32 v19, a151
v_mfma_f32_16x16x32_bf16 v[32:35], a[52:55], a[108:111], v[32:35]
v_accvgpr_read_b32 v21, a167
v_lshlrev_b32 v18, 16, v19
v_mfma_f32_16x16x32_bf16 v[48:51], a[60:63], a[108:111], v[48:51]
v_and_b32 v19, 0xffff0000, v19
v_lshlrev_b32 v20, 16, v21
v_mfma_f32_16x16x32_bf16 v[48:51], a[56:59], a[104:107], v[48:51]
s_add_u32 m0, s76, 39936
v_and_b32 v21, 0xffff0000, v21
v_mul_f32 v18, v18, v20
v_mfma_f32_16x16x32_bf16 v[64:67], a[56:59], a[112:115], v[64:67]
s_add_u32 s64, s70, 57984
v_mul_f32 v19, v19, v21
v_cvt_pk_bf16_f32 v18, v18, v19
v_mfma_f32_16x16x32_bf16 v[64:67], a[60:63], a[116:119], v[64:67]
buffer_load_dwordx4 v13, s[32:35], s64 offen lds
v_mfma_f32_16x16x32_bf16 v[80:83], a[52:55], a[116:119], v[80:83]
v_lshlrev_b32 v19, 16, v18
v_and_b32 v18, 0xffff0000, v18
v_mfma_f32_16x16x32_bf16 v[80:83], a[48:51], a[112:115], v[80:83]
s_add_u32 s81, s81, 1048576
v_add_f32 v17, v17, v19
v_add_f32 v17, v17, v18
v_mfma_f32_16x16x32_bf16 v[144:147], a[40:43], a[112:115], v[144:147]
buffer_load_dword a252, v16, s[56:59], s81 offen
v_mfma_f32_16x16x32_bf16 v[144:147], a[44:47], a[116:119], v[144:147]
v_accvgpr_read_b32 v19, a152
v_accvgpr_read_b32 v21, a168
v_mfma_f32_16x16x32_bf16 v[128:131], a[36:39], a[116:119], v[128:131]
v_lshlrev_b32 v18, 16, v19
v_and_b32 v19, 0xffff0000, v19
v_mfma_f32_16x16x32_bf16 v[128:131], a[32:35], a[112:115], v[128:131]
s_waitcnt lgkmcnt(0)
v_lshlrev_b32 v20, 16, v21
v_and_b32 v21, 0xffff0000, v21
v_mfma_f32_16x16x32_bf16 v[112:115], a[32:35], a[72:75], v[112:115]
v_mul_f32 v18, v18, v20
v_mul_f32 v19, v19, v21
v_mfma_f32_16x16x32_bf16 v[112:115], a[36:39], a[76:79], v[112:115]
v_cvt_pk_bf16_f32 v18, v18, v19
v_lshlrev_b32 v19, 16, v18
v_mfma_f32_16x16x32_bf16 v[96:99], a[44:47], a[76:79], v[96:99]
s_waitcnt lgkmcnt(0)
s_barrier
v_mfma_f32_16x16x32_bf16 v[96:99], a[40:43], a[72:75], v[96:99]
s_add_u32 m0, s77, 65536
ds_read_b64_tr_b16 a[104:105], v4 offset:32768
v_and_b32 v18, 0xffff0000, v18
v_mfma_f32_16x16x32_bf16 v[36:39], a[48:51], a[72:75], v[36:39]
s_add_u32 s64, s71, 3145728
ds_read_b64_tr_b16 a[106:107], v4 offset:33792
v_add_f32 v17, v17, v19
v_mfma_f32_16x16x32_bf16 v[36:39], a[52:55], a[76:79], v[36:39]
buffer_load_dwordx4 v14, s[36:39], s64 offen lds
v_mfma_f32_16x16x32_bf16 v[52:55], a[60:63], a[76:79], v[52:55]
ds_read_b64_tr_b16 a[108:109], v4 offset:40960
v_add_f32 v17, v17, v18
v_mfma_f32_16x16x32_bf16 v[52:55], a[56:59], a[72:75], v[52:55]
ds_read_b64_tr_b16 a[110:111], v4 offset:41984
v_accvgpr_read_b32 v19, a153
v_mfma_f32_16x16x32_bf16 v[68:71], a[56:59], a[80:83], v[68:71]
ds_read_b64_tr_b16 a[112:113], v5 offset:32768
v_accvgpr_read_b32 v21, a169
v_mfma_f32_16x16x32_bf16 v[68:71], a[60:63], a[84:87], v[68:71]
ds_read_b64_tr_b16 a[114:115], v5 offset:33792
v_lshlrev_b32 v18, 16, v19
v_mfma_f32_16x16x32_bf16 v[84:87], a[52:55], a[84:87], v[84:87]
ds_read_b64_tr_b16 a[116:117], v5 offset:40960
v_and_b32 v19, 0xffff0000, v19
v_mfma_f32_16x16x32_bf16 v[84:87], a[48:51], a[80:83], v[84:87]
s_add_u32 m0, s77, 66560
ds_read_b64_tr_b16 a[118:119], v5 offset:41984
v_lshlrev_b32 v20, 16, v21
v_mfma_f32_16x16x32_bf16 v[148:151], a[40:43], a[80:83], v[148:151]
s_add_u32 s64, s71, 3178496
ds_read_b64_tr_b16 a[72:73], v6 offset:32768
v_and_b32 v21, 0xffff0000, v21
v_mfma_f32_16x16x32_bf16 v[148:151], a[44:47], a[84:87], v[148:151]
buffer_load_dwordx4 v14, s[36:39], s64 offen lds
v_mfma_f32_16x16x32_bf16 v[132:135], a[36:39], a[84:87], v[132:135]
ds_read_b64_tr_b16 a[74:75], v6 offset:33792
v_mul_f32 v18, v18, v20
v_mfma_f32_16x16x32_bf16 v[132:135], a[32:35], a[80:83], v[132:135]
ds_read_b64_tr_b16 a[76:77], v6 offset:40960
v_mul_f32 v19, v19, v21
v_mfma_f32_16x16x32_bf16 v[116:119], a[32:35], a[88:91], v[116:119]
ds_read_b64_tr_b16 a[78:79], v6 offset:41984
v_cvt_pk_bf16_f32 v18, v18, v19
v_mfma_f32_16x16x32_bf16 v[116:119], a[36:39], a[92:95], v[116:119]
ds_read_b64_tr_b16 a[80:81], v7 offset:32768
v_lshlrev_b32 v19, 16, v18
v_mfma_f32_16x16x32_bf16 v[100:103], a[44:47], a[92:95], v[100:103]
ds_read_b64_tr_b16 a[82:83], v7 offset:33792
v_and_b32 v18, 0xffff0000, v18
v_mfma_f32_16x16x32_bf16 v[100:103], a[40:43], a[88:91], v[100:103]
s_add_u32 m0, s77, 67584
ds_read_b64_tr_b16 a[84:85], v7 offset:40960
v_add_f32 v17, v17, v19
v_mfma_f32_16x16x32_bf16 a[120:123], a[48:51], a[88:91], a[120:123]
s_add_u32 s64, s71, 3211264
ds_read_b64_tr_b16 a[86:87], v7 offset:41984
v_add_f32 v17, v17, v18
v_mfma_f32_16x16x32_bf16 a[120:123], a[52:55], a[92:95], a[120:123]
buffer_load_dwordx4 v15, s[36:39], s64 offen lds
v_mfma_f32_16x16x32_bf16 a[124:127], a[60:63], a[92:95], a[124:127]
v_accvgpr_read_b32 v19, a154
v_accvgpr_read_b32 v21, a170
v_mfma_f32_16x16x32_bf16 a[124:127], a[56:59], a[88:91], a[124:127]
ds_read_b64_tr_b16 a[88:89], v8 offset:32768
v_lshlrev_b32 v18, 16, v19
v_mfma_f32_16x16x32_bf16 a[128:131], a[56:59], a[96:99], a[128:131]
ds_read_b64_tr_b16 a[90:91], v8 offset:33792
v_and_b32 v19, 0xffff0000, v19
v_mfma_f32_16x16x32_bf16 a[128:131], a[60:63], a[100:103], a[128:131]
ds_read_b64_tr_b16 a[92:93], v8 offset:40960
v_lshlrev_b32 v20, 16, v21
v_mfma_f32_16x16x32_bf16 a[132:135], a[52:55], a[100:103], a[132:135]
ds_read_b64_tr_b16 a[94:95], v8 offset:41984
v_and_b32 v21, 0xffff0000, v21
v_mfma_f32_16x16x32_bf16 a[132:135], a[48:51], a[96:99], a[132:135]
s_add_u32 m0, s77, 68608
v_mul_f32 v18, v18, v20
v_mul_f32 v19, v19, v21
v_mfma_f32_16x16x32_bf16 a[136:139], a[40:43], a[96:99], a[136:139]
s_add_u32 s64, s71, 3244032
v_cvt_pk_bf16_f32 v18, v18, v19
v_lshlrev_b32 v19, 16, v18
v_mfma_f32_16x16x32_bf16 a[136:139], a[44:47], a[100:103], a[136:139]
buffer_load_dwordx4 v15, s[36:39], s64 offen lds
v_mfma_f32_16x16x32_bf16 a[140:143], a[36:39], a[100:103], a[140:143]
v_and_b32 v18, 0xffff0000, v18
v_add_f32 v17, v17, v19
v_mfma_f32_16x16x32_bf16 a[140:143], a[32:35], a[96:99], a[140:143]
s_waitcnt lgkmcnt(4)
ds_read_b64_tr_b16 a[96:97], v9 offset:32768
v_add_f32 v17, v17, v18
v_mfma_f32_16x16x32_bf16 v[184:187], a[104:107], a[0:3], v[184:187]
ds_read_b64_tr_b16 a[98:99], v9 offset:33792
v_accvgpr_read_b32 v19, a155
v_mfma_f32_16x16x32_bf16 v[184:187], a[108:111], a[4:7], v[184:187]
ds_read_b64_tr_b16 a[100:101], v9 offset:40960
v_accvgpr_read_b32 v21, a171
v_mfma_f32_16x16x32_bf16 v[192:195], a[108:111], a[12:15], v[192:195]
s_add_u32 s17, s78, .-L_pc+6144
ds_read_b64_tr_b16 a[102:103], v9 offset:41984
v_lshlrev_b32 v18, 16, v19
v_mfma_f32_16x16x32_bf16 v[192:195], a[104:107], a[8:11], v[192:195]
s_add_u32 m0, s77, 81920
v_and_b32 v19, 0xffff0000, v19
v_lshlrev_b32 v20, 16, v21
v_mfma_f32_16x16x32_bf16 v[200:203], a[104:107], a[16:19], v[200:203]
s_add_u32 s64, s71, 3145728
buffer_load_dword a252, v16, s[88:91], s17 offen
v_mfma_f32_16x16x32_bf16 v[200:203], a[108:111], a[20:23], v[200:203]
buffer_load_dwordx4 v14, s[40:43], s64 offen lds
v_mfma_f32_16x16x32_bf16 v[208:211], a[108:111], a[28:31], v[208:211]
v_and_b32 v21, 0xffff0000, v21
v_mul_f32 v18, v18, v20
v_mfma_f32_16x16x32_bf16 v[208:211], a[104:107], a[24:27], v[208:211]
s_add_u32 s82, s82, 1048576
ds_read_b64_tr_b16 a[104:105], v10 offset:32768
v_mul_f32 v19, v19, v21
v_mfma_f32_16x16x32_bf16 v[248:251], a[112:115], a[24:27], v[248:251]
buffer_load_dword a252, v1, s[60:63], s82 offen
v_mfma_f32_16x16x32_bf16 v[248:251], a[116:119], a[28:31], v[248:251]
ds_read_b64_tr_b16 a[106:107], v10 offset:33792
v_cvt_pk_bf16_f32 v18, v18, v19
v_mfma_f32_16x16x32_bf16 v[212:215], a[116:119], a[20:23], v[212:215]
ds_read_b64_tr_b16 a[108:109], v10 offset:40960
v_lshlrev_b32 v19, 16, v18
v_mfma_f32_16x16x32_bf16 v[212:215], a[112:115], a[16:19], v[212:215]
s_add_u32 m0, s77, 82944
ds_read_b64_tr_b16 a[110:111], v10 offset:41984
v_and_b32 v18, 0xffff0000, v18
v_mfma_f32_16x16x32_bf16 v[204:207], a[112:115], a[8:11], v[204:207]
s_add_u32 s64, s71, 3178496
v_add_f32 v17, v17, v19
v_add_f32 v17, v17, v18
v_mfma_f32_16x16x32_bf16 v[204:207], a[116:119], a[12:15], v[204:207]
buffer_load_dwordx4 v14, s[40:43], s64 offen lds
v_mfma_f32_16x16x32_bf16 v[196:199], a[116:119], a[4:7], v[196:199]
v_accvgpr_read_b32 v19, a156
v_accvgpr_read_b32 v21, a172
v_mfma_f32_16x16x32_bf16 v[196:199], a[112:115], a[0:3], v[196:199]
ds_read_b64_tr_b16 a[112:113], v11 offset:32768
v_lshlrev_b32 v18, 16, v19
v_mfma_f32_16x16x32_bf16 v[188:191], a[72:75], a[0:3], v[188:191]
ds_read_b64_tr_b16 a[114:115], v11 offset:33792
v_and_b32 v19, 0xffff0000, v19
v_mfma_f32_16x16x32_bf16 v[188:191], a[76:79], a[4:7], v[188:191]
ds_read_b64_tr_b16 a[116:117], v11 offset:40960
v_lshlrev_b32 v20, 16, v21
v_mfma_f32_16x16x32_bf16 v[216:219], a[76:79], a[12:15], v[216:219]
ds_read_b64_tr_b16 a[118:119], v11 offset:41984
v_and_b32 v21, 0xffff0000, v21
v_mfma_f32_16x16x32_bf16 v[216:219], a[72:75], a[8:11], v[216:219]
s_add_u32 m0, s77, 83968
v_mul_f32 v18, v18, v20
v_mul_f32 v19, v19, v21
v_mfma_f32_16x16x32_bf16 v[224:227], a[72:75], a[16:19], v[224:227]
s_add_u32 s64, s71, 3211264
v_cvt_pk_bf16_f32 v18, v18, v19
v_lshlrev_b32 v19, 16, v18
v_mfma_f32_16x16x32_bf16 v[224:227], a[76:79], a[20:23], v[224:227]
buffer_load_dwordx4 v15, s[40:43], s64 offen lds
v_mfma_f32_16x16x32_bf16 v[232:235], a[76:79], a[28:31], v[232:235]
v_and_b32 v18, 0xffff0000, v18
v_add_f32 v17, v17, v19
v_mfma_f32_16x16x32_bf16 v[232:235], a[72:75], a[24:27], v[232:235]
ds_read_b64_tr_b16 a[72:73], v4 offset:49152
v_add_f32 v17, v17, v18
v_mfma_f32_16x16x32_bf16 v[240:243], a[80:83], a[24:27], v[240:243]
ds_read_b64_tr_b16 a[74:75], v4 offset:50176
v_accvgpr_read_b32 v19, a157
v_mfma_f32_16x16x32_bf16 v[240:243], a[84:87], a[28:31], v[240:243]
ds_read_b64_tr_b16 a[76:77], v4 offset:57344
v_accvgpr_read_b32 v21, a173
v_mfma_f32_16x16x32_bf16 v[252:255], a[84:87], a[20:23], v[252:255]
ds_read_b64_tr_b16 a[78:79], v4 offset:58368
v_lshlrev_b32 v18, 16, v19
v_mfma_f32_16x16x32_bf16 v[252:255], a[80:83], a[16:19], v[252:255]
s_add_u32 m0, s77, 84992
v_and_b32 v19, 0xffff0000, v19
v_lshlrev_b32 v20, 16, v21
v_mfma_f32_16x16x32_bf16 v[244:247], a[80:83], a[8:11], v[244:247]
s_add_u32 s64, s71, 3244032
v_and_b32 v21, 0xffff0000, v21
v_mul_f32 v18, v18, v20
v_mfma_f32_16x16x32_bf16 v[244:247], a[84:87], a[12:15], v[244:247]
buffer_load_dwordx4 v15, s[40:43], s64 offen lds
v_mfma_f32_16x16x32_bf16 v[236:239], a[84:87], a[4:7], v[236:239]
v_mul_f32 v19, v19, v21
v_cvt_pk_bf16_f32 v18, v18, v19
v_mfma_f32_16x16x32_bf16 v[236:239], a[80:83], a[0:3], v[236:239]
s_waitcnt lgkmcnt(4)
ds_read_b64_tr_b16 a[80:81], v5 offset:49152
v_lshlrev_b32 v19, 16, v18
v_mfma_f32_16x16x32_bf16 v[228:231], a[88:91], a[0:3], v[228:231]
ds_read_b64_tr_b16 a[82:83], v5 offset:50176
v_and_b32 v18, 0xffff0000, v18
v_mfma_f32_16x16x32_bf16 v[228:231], a[92:95], a[4:7], v[228:231]
ds_read_b64_tr_b16 a[84:85], v5 offset:57344
v_add_f32 v17, v17, v19
v_mfma_f32_16x16x32_bf16 v[220:223], a[92:95], a[12:15], v[220:223]
ds_read_b64_tr_b16 a[86:87], v5 offset:58368
v_add_f32 v17, v17, v18
v_mfma_f32_16x16x32_bf16 v[220:223], a[88:91], a[8:11], v[220:223]
v_accvgpr_read_b32 v19, a158
v_accvgpr_read_b32 v21, a174
v_mfma_f32_16x16x32_bf16 v[152:155], a[88:91], a[16:19], v[152:155]
v_lshlrev_b32 v18, 16, v19
v_and_b32 v19, 0xffff0000, v19
v_mfma_f32_16x16x32_bf16 v[152:155], a[92:95], a[20:23], v[152:155]
v_lshlrev_b32 v20, 16, v21
v_and_b32 v21, 0xffff0000, v21
v_mfma_f32_16x16x32_bf16 v[160:163], a[92:95], a[28:31], v[160:163]
s_add_u32 m0, s76, 0
v_mul_f32 v18, v18, v20
v_mul_f32 v19, v19, v21
v_mfma_f32_16x16x32_bf16 v[160:163], a[88:91], a[24:27], v[160:163]
s_add_u32 s64, s70, 768
ds_read_b64_tr_b16 a[88:89], v6 offset:49152
v_cvt_pk_bf16_f32 v18, v18, v19
v_mfma_f32_16x16x32_bf16 v[168:171], a[96:99], a[24:27], v[168:171]
buffer_load_dwordx4 v12, s[32:35], s64 offen lds
v_mfma_f32_16x16x32_bf16 v[168:171], a[100:103], a[28:31], v[168:171]
ds_read_b64_tr_b16 a[90:91], v6 offset:50176
v_lshlrev_b32 v19, 16, v18
v_mfma_f32_16x16x32_bf16 v[176:179], a[100:103], a[20:23], v[176:179]
ds_read_b64_tr_b16 a[92:93], v6 offset:57344
v_and_b32 v18, 0xffff0000, v18
v_mfma_f32_16x16x32_bf16 v[176:179], a[96:99], a[16:19], v[176:179]
ds_read_b64_tr_b16 a[94:95], v6 offset:58368
v_add_f32 v17, v17, v19
v_mfma_f32_16x16x32_bf16 v[180:183], a[96:99], a[8:11], v[180:183]
v_add_f32 v17, v17, v18
v_accvgpr_read_b32 v19, a159
v_mfma_f32_16x16x32_bf16 v[180:183], a[100:103], a[12:15], v[180:183]
s_add_u32 m0, s76, 1024
v_accvgpr_read_b32 v21, a175
v_lshlrev_b32 v18, 16, v19
v_mfma_f32_16x16x32_bf16 v[172:175], a[100:103], a[4:7], v[172:175]
s_add_u32 s64, s70, 8960
v_and_b32 v19, 0xffff0000, v19
v_lshlrev_b32 v20, 16, v21
v_mfma_f32_16x16x32_bf16 v[172:175], a[96:99], a[0:3], v[172:175]
buffer_load_dwordx4 v13, s[32:35], s64 offen lds
v_mfma_f32_16x16x32_bf16 v[164:167], a[104:107], a[0:3], v[164:167]
ds_read_b64_tr_b16 a[96:97], v7 offset:49152
v_and_b32 v21, 0xffff0000, v21
v_mfma_f32_16x16x32_bf16 v[164:167], a[108:111], a[4:7], v[164:167]
ds_read_b64_tr_b16 a[98:99], v7 offset:50176
v_mul_f32 v18, v18, v20
v_mfma_f32_16x16x32_bf16 v[156:159], a[108:111], a[12:15], v[156:159]
ds_read_b64_tr_b16 a[100:101], v7 offset:57344
v_mul_f32 v19, v19, v21
v_mfma_f32_16x16x32_bf16 v[156:159], a[104:107], a[8:11], v[156:159]
s_add_u32 s81, s81, 1048576
ds_read_b64_tr_b16 a[102:103], v7 offset:58368
v_cvt_pk_bf16_f32 v18, v18, v19
v_mfma_f32_16x16x32_bf16 v[24:27], a[104:107], a[16:19], v[24:27]
s_add_u32 m0, s76, 2048
buffer_load_dword a252, v16, s[56:59], s81 offen
v_mfma_f32_16x16x32_bf16 v[24:27], a[108:111], a[20:23], v[24:27]
s_add_u32 s64, s70, 17152
v_lshlrev_b32 v19, 16, v18
v_and_b32 v18, 0xffff0000, v18
v_mfma_f32_16x16x32_bf16 v[40:43], a[108:111], a[28:31], v[40:43]
s_waitcnt vmcnt(14)
buffer_load_dwordx4 v12, s[32:35], s64 offen lds
v_mfma_f32_16x16x32_bf16 v[40:43], a[104:107], a[24:27], v[40:43]
ds_read_b64_tr_b16 a[104:105], v8 offset:49152
v_add_f32 v17, v17, v19
v_mfma_f32_16x16x32_bf16 v[56:59], a[112:115], a[24:27], v[56:59]
ds_read_b64_tr_b16 a[106:107], v8 offset:50176
v_add_f32 v17, v17, v18
v_mfma_f32_16x16x32_bf16 v[56:59], a[116:119], a[28:31], v[56:59]
ds_read_b64_tr_b16 a[108:109], v8 offset:57344
v_add_u32 v4, 0x8000, v4
v_mfma_f32_16x16x32_bf16 v[72:75], a[116:119], a[20:23], v[72:75]
ds_read_b64_tr_b16 a[110:111], v8 offset:58368
v_add_f32_dpp v17, v17, v17 row_ror:8 row_mask:0xf bank_mask:0xf
v_mfma_f32_16x16x32_bf16 v[72:75], a[112:115], a[16:19], v[72:75]
s_add_u32 m0, s76, 3072
ds_read_b128 a[32:35], v2 offset:32768
v_mfma_f32_16x16x32_bf16 v[136:139], a[112:115], a[8:11], v[136:139]
s_add_u32 s64, s70, 25344
ds_read_b128 a[36:39], v3 offset:32768
v_add_f32_dpp v17, v17, v17 row_ror:4 row_mask:0xf bank_mask:0xf
v_mfma_f32_16x16x32_bf16 v[136:139], a[116:119], a[12:15], v[136:139]
buffer_load_dwordx4 v13, s[32:35], s64 offen lds
v_mfma_f32_16x16x32_bf16 v[120:123], a[116:119], a[4:7], v[120:123]
ds_read_b128 a[40:43], v2 offset:34816
v_add_f32_dpp v17, v17, v17 row_ror:2 row_mask:0xf bank_mask:0xf
v_mfma_f32_16x16x32_bf16 v[120:123], a[112:115], a[0:3], v[120:123]
s_waitcnt lgkmcnt(7)
ds_read_b128 a[44:47], v3 offset:34816
v_mfma_f32_16x16x32_bf16 v[104:107], a[0:3], a[72:75], v[104:107]
ds_read_b128 a[48:51], v2 offset:36864
v_add_f32_dpp v17, v17, v17 row_ror:1 row_mask:0xf bank_mask:0xf
v_mfma_f32_16x16x32_bf16 v[104:107], a[4:7], a[76:79], v[104:107]
ds_read_b128 a[52:55], v3 offset:36864
v_add_u32 v5, 0x8000, v5
v_mfma_f32_16x16x32_bf16 v[88:91], a[12:15], a[76:79], v[88:91]
s_add_u32 m0, s76, 4096
ds_read_b128 a[56:59], v2 offset:38912
v_mov_b32 v18, v17
v_mfma_f32_16x16x32_bf16 v[88:91], a[8:11], a[72:75], v[88:91]
s_add_u32 s64, s70, 33536
ds_read_b128 a[60:63], v3 offset:38912
v_mfma_f32_16x16x32_bf16 v[28:31], a[16:19], a[72:75], v[28:31]
buffer_load_dwordx4 v12, s[32:35], s64 offen lds
v_mfma_f32_16x16x32_bf16 v[28:31], a[20:23], a[76:79], v[28:31]
ds_read_b64_tr_b16 a[112:113], v9 offset:49152
v_permlane16_swap_b32 v18, v17
v_mfma_f32_16x16x32_bf16 v[44:47], a[28:31], a[76:79], v[44:47]
ds_read_b64_tr_b16 a[114:115], v9 offset:50176
v_add_f32 v17, v17, v18
v_mfma_f32_16x16x32_bf16 v[44:47], a[24:27], a[72:75], v[44:47]
ds_read_b64_tr_b16 a[116:117], v9 offset:57344
v_cvt_pk_bf16_f32 v17, v17, v17
v_mfma_f32_16x16x32_bf16 v[60:63], a[24:27], a[80:83], v[60:63]
ds_read_b64_tr_b16 a[118:119], v9 offset:58368
v_and_b32 v17, 0xffff0000, v17
v_mfma_f32_16x16x32_bf16 v[60:63], a[28:31], a[84:87], v[60:63]
s_add_u32 m0, s76, 5120
ds_read_b64_tr_b16 a[72:73], v10 offset:49152
v_add_u32 v6, 0x8000, v6
v_mfma_f32_16x16x32_bf16 v[76:79], a[20:23], a[84:87], v[76:79]
s_add_u32 s64, s70, 41728
ds_read_b64_tr_b16 a[74:75], v10 offset:50176
v_mul_f32 v17, 0xbfb8aa3b, v17
v_mfma_f32_16x16x32_bf16 v[76:79], a[16:19], a[80:83], v[76:79]
buffer_load_dwordx4 v13, s[32:35], s64 offen lds
v_mfma_f32_16x16x32_bf16 v[140:143], a[8:11], a[80:83], v[140:143]
ds_read_b64_tr_b16 a[76:77], v10 offset:57344
v_mfma_f32_16x16x32_bf16 v[140:143], a[12:15], a[84:87], v[140:143]
ds_read_b64_tr_b16 a[78:79], v10 offset:58368
v_mfma_f32_16x16x32_bf16 v[124:127], a[4:7], a[84:87], v[124:127]
v_exp_f32 v17, v17
v_mfma_f32_16x16x32_bf16 v[124:127], a[0:3], a[80:83], v[124:127]
ds_read_b64_tr_b16 a[80:81], v11 offset:49152
v_add_f32 v17, 1.0, v17
v_mfma_f32_16x16x32_bf16 v[108:111], a[0:3], a[88:91], v[108:111]
s_add_u32 m0, s76, 6144
ds_read_b64_tr_b16 a[82:83], v11 offset:50176
v_mfma_f32_16x16x32_bf16 v[108:111], a[4:7], a[92:95], v[108:111]
s_add_u32 s64, s70, 49920
ds_read_b64_tr_b16 a[84:85], v11 offset:57344
v_add_u32 v7, 0x8000, v7
v_mfma_f32_16x16x32_bf16 v[92:95], a[12:15], a[92:95], v[92:95]
buffer_load_dwordx4 v12, s[32:35], s64 offen lds
v_mfma_f32_16x16x32_bf16 v[92:95], a[8:11], a[88:91], v[92:95]
ds_read_b64_tr_b16 a[86:87], v11 offset:58368
v_mfma_f32_16x16x32_bf16 v[32:35], a[16:19], a[88:91], v[32:35]
v_rcp_f32 v17, v17
v_mfma_f32_16x16x32_bf16 v[32:35], a[20:23], a[92:95], v[32:35]
v_cvt_pk_bf16_f32 v18, v17, v17
v_mfma_f32_16x16x32_bf16 v[48:51], a[28:31], a[92:95], v[48:51]
v_and_b32 v18, 0xffff0000, v18
v_mfma_f32_16x16x32_bf16 v[48:51], a[24:27], a[88:91], v[48:51]
s_add_u32 m0, s76, 7168
v_sub_f32 v19, 1.0, v18
v_mfma_f32_16x16x32_bf16 v[64:67], a[24:27], a[96:99], v[64:67]
s_add_u32 s64, s70, 58112
v_cvt_pk_bf16_f32 v19, v19, v19
v_mfma_f32_16x16x32_bf16 v[64:67], a[28:31], a[100:103], v[64:67]
buffer_load_dwordx4 v13, s[32:35], s64 offen lds
v_mfma_f32_16x16x32_bf16 v[80:83], a[20:23], a[100:103], v[80:83]
v_add_u32 v8, 0x8000, v8
v_and_b32 v19, 0xffff0000, v19
v_mfma_f32_16x16x32_bf16 v[80:83], a[16:19], a[96:99], v[80:83]
v_and_b32 v20, 31, v0
v_mfma_f32_16x16x32_bf16 v[144:147], a[8:11], a[96:99], v[144:147]
v_lshlrev_b32 v20, 27, v20
v_mfma_f32_16x16x32_bf16 v[144:147], a[12:15], a[100:103], v[144:147]
v_lshrrev_b32 v21, 2, v0
v_mfma_f32_16x16x32_bf16 v[128:131], a[4:7], a[100:103], v[128:131]
v_add_u32 v9, 0x8000, v9
v_add_u32 v10, 0x8000, v10
v_mfma_f32_16x16x32_bf16 v[128:131], a[0:3], a[96:99], v[128:131]
s_waitcnt lgkmcnt(0)
s_add_u32 s82, s82, 1048576
v_add_u32 v11, 0x8000, v11
v_add_u32 v20, v20, v21
v_mfma_f32_16x16x32_bf16 v[112:115], a[0:3], a[104:107], v[112:115]
buffer_load_dword a252, v1, s[60:63], s82 offen
v_mfma_f32_16x16x32_bf16 v[112:115], a[4:7], a[108:111], v[112:115]
v_mfma_f32_16x16x32_bf16 v[96:99], a[12:15], a[108:111], v[96:99]
s_waitcnt lgkmcnt(0)
s_barrier
v_mfma_f32_16x16x32_bf16 v[96:99], a[8:11], a[104:107], v[96:99]
s_add_u32 m0, s77, 98304
ds_read_b64_tr_b16 a[88:89], v4 offset:32768
v_mfma_f32_16x16x32_bf16 v[36:39], a[16:19], a[104:107], v[36:39]
s_add_u32 s64, s71, 3670016
ds_read_b64_tr_b16 a[90:91], v4 offset:33792
v_mfma_f32_16x16x32_bf16 v[36:39], a[20:23], a[108:111], v[36:39]
buffer_load_dwordx4 v14, s[36:39], s64 offen lds
v_mfma_f32_16x16x32_bf16 v[52:55], a[28:31], a[108:111], v[52:55]
ds_read_b64_tr_b16 a[92:93], v4 offset:40960
v_mfma_f32_16x16x32_bf16 v[52:55], a[24:27], a[104:107], v[52:55]
ds_read_b64_tr_b16 a[94:95], v4 offset:41984
v_mfma_f32_16x16x32_bf16 v[68:71], a[24:27], a[112:115], v[68:71]
ds_read_b64_tr_b16 a[96:97], v5 offset:32768
v_mfma_f32_16x16x32_bf16 v[68:71], a[28:31], a[116:119], v[68:71]
ds_read_b64_tr_b16 a[98:99], v5 offset:33792
v_mfma_f32_16x16x32_bf16 v[84:87], a[20:23], a[116:119], v[84:87]
ds_read_b64_tr_b16 a[100:101], v5 offset:40960
v_mfma_f32_16x16x32_bf16 v[84:87], a[16:19], a[112:115], v[84:87]
s_add_u32 m0, s77, 99328
ds_read_b64_tr_b16 a[102:103], v5 offset:41984
v_mfma_f32_16x16x32_bf16 v[148:151], a[8:11], a[112:115], v[148:151]
s_add_u32 s64, s71, 3702784
ds_read_b64_tr_b16 a[104:105], v6 offset:32768
v_mfma_f32_16x16x32_bf16 v[148:151], a[12:15], a[116:119], v[148:151]
buffer_load_dwordx4 v14, s[36:39], s64 offen lds
v_mfma_f32_16x16x32_bf16 v[132:135], a[4:7], a[116:119], v[132:135]
ds_read_b64_tr_b16 a[106:107], v6 offset:33792
v_mfma_f32_16x16x32_bf16 v[132:135], a[0:3], a[112:115], v[132:135]
ds_read_b64_tr_b16 a[108:109], v6 offset:40960
v_mfma_f32_16x16x32_bf16 v[116:119], a[0:3], a[72:75], v[116:119]
ds_read_b64_tr_b16 a[110:111], v6 offset:41984
v_mfma_f32_16x16x32_bf16 v[116:119], a[4:7], a[76:79], v[116:119]
ds_read_b64_tr_b16 a[112:113], v7 offset:32768
v_mfma_f32_16x16x32_bf16 v[100:103], a[12:15], a[76:79], v[100:103]
ds_read_b64_tr_b16 a[114:115], v7 offset:33792
v_mfma_f32_16x16x32_bf16 v[100:103], a[8:11], a[72:75], v[100:103]
s_add_u32 m0, s77, 100352
ds_read_b64_tr_b16 a[116:117], v7 offset:40960
v_mfma_f32_16x16x32_bf16 a[120:123], a[16:19], a[72:75], a[120:123]
s_add_u32 s64, s71, 3735552
s_lshl2_add_u32 s65, s2, s30
ds_read_b64_tr_b16 a[118:119], v7 offset:41984
v_mfma_f32_16x16x32_bf16 a[120:123], a[20:23], a[76:79], a[120:123]
s_lshl4_add_u32 s65, s65, 58720256
buffer_load_dwordx4 v15, s[36:39], s64 offen lds
v_mfma_f32_16x16x32_bf16 a[124:127], a[28:31], a[76:79], a[124:127]
buffer_store_dwordx2 v[18:19], v20, s[44:47], s65 offen sc1
v_mfma_f32_16x16x32_bf16 a[124:127], a[24:27], a[72:75], a[124:127]
s_lshr_b32 s66, s30, 1
ds_read_b64_tr_b16 a[72:73], v8 offset:32768
v_mfma_f32_16x16x32_bf16 a[128:131], a[24:27], a[80:83], a[128:131]
s_lshl_b32 s66, s66, 11
ds_read_b64_tr_b16 a[74:75], v8 offset:33792
v_mfma_f32_16x16x32_bf16 a[128:131], a[28:31], a[84:87], a[128:131]
s_add_u32 s66, s66, 126976
ds_read_b64_tr_b16 a[76:77], v8 offset:40960
v_mfma_f32_16x16x32_bf16 a[132:135], a[20:23], a[84:87], a[132:135]
s_sub_u32 s66, s66, s76
ds_read_b64_tr_b16 a[78:79], v8 offset:41984
v_mfma_f32_16x16x32_bf16 a[132:135], a[16:19], a[80:83], a[132:135]
s_add_u32 m0, s77, 101376
v_add_u32 v17, s66, v2
v_mfma_f32_16x16x32_bf16 a[136:139], a[8:11], a[80:83], a[136:139]
s_add_u32 s64, s71, 3768320
v_xor_b32 v18, 64, v17
v_mfma_f32_16x16x32_bf16 a[136:139], a[12:15], a[84:87], a[136:139]
buffer_load_dwordx4 v15, s[36:39], s64 offen lds
v_mfma_f32_16x16x32_bf16 a[140:143], a[4:7], a[84:87], a[140:143]
v_lshrrev_b32 v21, 4, v0
v_mfma_f32_16x16x32_bf16 a[140:143], a[0:3], a[80:83], a[140:143]
s_waitcnt lgkmcnt(4)
ds_read_b64_tr_b16 a[80:81], v9 offset:32768
v_bfe_u32 v19, v0, 2, 2
v_mfma_f32_16x16x32_bf16 v[184:187], a[88:91], a[32:35], v[184:187]
ds_read_b64_tr_b16 a[82:83], v9 offset:33792
v_lshl_add_u32 v19, v21, 3, v19
v_mfma_f32_16x16x32_bf16 v[184:187], a[92:95], a[36:39], v[184:187]
ds_read_b64_tr_b16 a[84:85], v9 offset:40960
v_lshlrev_b32 v19, 6, v19
v_mfma_f32_16x16x32_bf16 v[192:195], a[92:95], a[44:47], v[192:195]
ds_read_b64_tr_b16 a[86:87], v9 offset:41984
v_and_b32 v21, 1, v21
v_mfma_f32_16x16x32_bf16 v[192:195], a[88:91], a[40:43], v[192:195]
s_add_u32 m0, s77, 114688
v_lshl_add_u32 v19, v21, 5, v19
v_mfma_f32_16x16x32_bf16 v[200:203], a[88:91], a[48:51], v[200:203]
s_add_u32 s64, s71, 3670016
v_and_b32 v21, 3, v0
v_mfma_f32_16x16x32_bf16 v[200:203], a[92:95], a[52:55], v[200:203]
buffer_load_dwordx4 v14, s[40:43], s64 offen lds
v_mfma_f32_16x16x32_bf16 v[208:211], a[92:95], a[60:63], v[208:211]
v_lshl_add_u32 v19, v21, 3, v19
v_mfma_f32_16x16x32_bf16 v[208:211], a[88:91], a[56:59], v[208:211]
ds_read_b64_tr_b16 a[88:89], v10 offset:32768
v_add_u32 v19, 114688, v19
v_mfma_f32_16x16x32_bf16 v[248:251], a[96:99], a[56:59], v[248:251]
ds_read_b64_tr_b16 a[90:91], v10 offset:33792
v_xor_b32 v20, 32, v19
v_mfma_f32_16x16x32_bf16 v[248:251], a[100:103], a[60:63], v[248:251]
s_and_b32 s66, s30, 1
ds_read_b64_tr_b16 a[92:93], v10 offset:40960
v_mfma_f32_16x16x32_bf16 v[212:215], a[100:103], a[52:55], v[212:215]
s_lshl_b32 s67, s66, 5
ds_read_b64_tr_b16 a[94:95], v10 offset:41984
v_mfma_f32_16x16x32_bf16 v[212:215], a[96:99], a[48:51], v[212:215]
s_add_u32 m0, s77, 115712
s_add_u32 s81, s81, 1048576
v_xor_b32 v21, s67, v19
v_mfma_f32_16x16x32_bf16 v[204:207], a[96:99], a[40:43], v[204:207]
s_add_u32 s64, s71, 3702784
buffer_load_dword a252, v16, s[56:59], s81 offen
v_mfma_f32_16x16x32_bf16 v[204:207], a[100:103], a[44:47], v[204:207]
buffer_load_dwordx4 v14, s[40:43], s64 offen lds
v_mfma_f32_16x16x32_bf16 v[196:199], a[100:103], a[36:39], v[196:199]
v_mfma_f32_16x16x32_bf16 v[196:199], a[96:99], a[32:35], v[196:199]
ds_read_b64_tr_b16 a[96:97], v11 offset:32768
v_mfma_f32_16x16x32_bf16 v[188:191], a[104:107], a[32:35], v[188:191]
ds_read_b64_tr_b16 a[98:99], v11 offset:33792
v_mfma_f32_16x16x32_bf16 v[188:191], a[108:111], a[36:39], v[188:191]
ds_read_b64_tr_b16 a[100:101], v11 offset:40960
v_mfma_f32_16x16x32_bf16 v[216:219], a[108:111], a[44:47], v[216:219]
ds_read_b64_tr_b16 a[102:103], v11 offset:41984
v_mfma_f32_16x16x32_bf16 v[216:219], a[104:107], a[40:43], v[216:219]
s_add_u32 m0, s77, 116736
v_mfma_f32_16x16x32_bf16 v[224:227], a[104:107], a[48:51], v[224:227]
s_add_u32 s64, s71, 3735552
v_mfma_f32_16x16x32_bf16 v[224:227], a[108:111], a[52:55], v[224:227]
buffer_load_dwordx4 v15, s[40:43], s64 offen lds
v_mfma_f32_16x16x32_bf16 v[232:235], a[108:111], a[60:63], v[232:235]
v_mfma_f32_16x16x32_bf16 v[232:235], a[104:107], a[56:59], v[232:235]
ds_read_b64_tr_b16 a[104:105], v4 offset:49152
v_mfma_f32_16x16x32_bf16 v[240:243], a[112:115], a[56:59], v[240:243]
ds_read_b64_tr_b16 a[106:107], v4 offset:50176
v_mfma_f32_16x16x32_bf16 v[240:243], a[116:119], a[60:63], v[240:243]
ds_read_b64_tr_b16 a[108:109], v4 offset:57344
v_mfma_f32_16x16x32_bf16 v[252:255], a[116:119], a[52:55], v[252:255]
ds_read_b64_tr_b16 a[110:111], v4 offset:58368
v_mfma_f32_16x16x32_bf16 v[252:255], a[112:115], a[48:51], v[252:255]
s_add_u32 m0, s77, 117760
v_mfma_f32_16x16x32_bf16 v[244:247], a[112:115], a[40:43], v[244:247]
s_add_u32 s64, s71, 3768320
v_mfma_f32_16x16x32_bf16 v[244:247], a[116:119], a[44:47], v[244:247]
buffer_load_dwordx4 v15, s[40:43], s64 offen lds
v_mfma_f32_16x16x32_bf16 v[236:239], a[116:119], a[36:39], v[236:239]
v_mfma_f32_16x16x32_bf16 v[236:239], a[112:115], a[32:35], v[236:239]
s_waitcnt lgkmcnt(4)
ds_read_b64_tr_b16 a[112:113], v5 offset:49152
v_mfma_f32_16x16x32_bf16 v[228:231], a[72:75], a[32:35], v[228:231]
ds_read_b64_tr_b16 a[114:115], v5 offset:50176
v_mfma_f32_16x16x32_bf16 v[228:231], a[76:79], a[36:39], v[228:231]
ds_read_b64_tr_b16 a[116:117], v5 offset:57344
v_mfma_f32_16x16x32_bf16 v[220:223], a[76:79], a[44:47], v[220:223]
ds_read_b64_tr_b16 a[118:119], v5 offset:58368
v_mfma_f32_16x16x32_bf16 v[220:223], a[72:75], a[40:43], v[220:223]
v_mfma_f32_16x16x32_bf16 v[152:155], a[72:75], a[48:51], v[152:155]
v_mfma_f32_16x16x32_bf16 v[152:155], a[76:79], a[52:55], v[152:155]
v_mfma_f32_16x16x32_bf16 v[160:163], a[76:79], a[60:63], v[160:163]
s_add_u32 m0, s76, 32768
v_mfma_f32_16x16x32_bf16 v[160:163], a[72:75], a[56:59], v[160:163]
s_add_u32 s64, s70, 896
ds_read_b64_tr_b16 a[72:73], v6 offset:49152
v_mfma_f32_16x16x32_bf16 v[168:171], a[80:83], a[56:59], v[168:171]
buffer_load_dwordx4 v12, s[32:35], s64 offen lds
v_mfma_f32_16x16x32_bf16 v[168:171], a[84:87], a[60:63], v[168:171]
ds_read_b64_tr_b16 a[74:75], v6 offset:50176
v_mfma_f32_16x16x32_bf16 v[176:179], a[84:87], a[52:55], v[176:179]
ds_read_b64_tr_b16 a[76:77], v6 offset:57344
v_mfma_f32_16x16x32_bf16 v[176:179], a[80:83], a[48:51], v[176:179]
ds_read_b64_tr_b16 a[78:79], v6 offset:58368
v_mfma_f32_16x16x32_bf16 v[180:183], a[80:83], a[40:43], v[180:183]
v_mfma_f32_16x16x32_bf16 v[180:183], a[84:87], a[44:47], v[180:183]
s_add_u32 m0, s76, 33792
v_mfma_f32_16x16x32_bf16 v[172:175], a[84:87], a[36:39], v[172:175]
s_add_u32 s64, s70, 9088
v_mfma_f32_16x16x32_bf16 v[172:175], a[80:83], a[32:35], v[172:175]
buffer_load_dwordx4 v13, s[32:35], s64 offen lds
v_mfma_f32_16x16x32_bf16 v[164:167], a[88:91], a[32:35], v[164:167]
ds_read_b64_tr_b16 a[80:81], v7 offset:49152
v_mfma_f32_16x16x32_bf16 v[164:167], a[92:95], a[36:39], v[164:167]
ds_read_b64_tr_b16 a[82:83], v7 offset:50176
v_mfma_f32_16x16x32_bf16 v[156:159], a[92:95], a[44:47], v[156:159]
ds_read_b64_tr_b16 a[84:85], v7 offset:57344
v_mfma_f32_16x16x32_bf16 v[156:159], a[88:91], a[40:43], v[156:159]
ds_read_b64_tr_b16 a[86:87], v7 offset:58368
v_mfma_f32_16x16x32_bf16 v[24:27], a[88:91], a[48:51], v[24:27]
s_add_u32 m0, s76, 34816
v_mfma_f32_16x16x32_bf16 v[24:27], a[92:95], a[52:55], v[24:27]
s_add_u32 s64, s70, 17280
v_mfma_f32_16x16x32_bf16 v[40:43], a[92:95], a[60:63], v[40:43]
s_waitcnt vmcnt(13)
buffer_load_dwordx4 v12, s[32:35], s64 offen lds
v_mfma_f32_16x16x32_bf16 v[40:43], a[88:91], a[56:59], v[40:43]
s_add_u32 s81, s81, 1048576
ds_read_b64_tr_b16 a[88:89], v8 offset:49152
v_mfma_f32_16x16x32_bf16 v[56:59], a[96:99], a[56:59], v[56:59]
buffer_load_dword a252, v16, s[56:59], s81 offen
v_mfma_f32_16x16x32_bf16 v[56:59], a[100:103], a[60:63], v[56:59]
ds_read_b64_tr_b16 a[90:91], v8 offset:50176
v_subrev_u32 v4, 0x8000, v4
v_mfma_f32_16x16x32_bf16 v[72:75], a[100:103], a[52:55], v[72:75]
ds_read_b64_tr_b16 a[92:93], v8 offset:57344
v_mfma_f32_16x16x32_bf16 v[72:75], a[96:99], a[48:51], v[72:75]
s_add_u32 m0, s76, 35840
ds_read_b64_tr_b16 a[94:95], v8 offset:58368
v_mfma_f32_16x16x32_bf16 v[136:139], a[96:99], a[40:43], v[136:139]
s_add_u32 s64, s70, 25472
ds_read_b128 a[0:3], v2 offset:0
v_mfma_f32_16x16x32_bf16 v[136:139], a[100:103], a[44:47], v[136:139]
buffer_load_dwordx4 v13, s[32:35], s64 offen lds
v_mfma_f32_16x16x32_bf16 v[120:123], a[100:103], a[36:39], v[120:123]
ds_read_b128 a[4:7], v3 offset:0
v_mfma_f32_16x16x32_bf16 v[120:123], a[96:99], a[32:35], v[120:123]
s_waitcnt lgkmcnt(6)
ds_read_b128 a[8:11], v2 offset:2048
v_mfma_f32_16x16x32_bf16 v[104:107], a[32:35], a[104:107], v[104:107]
ds_read_b128 a[12:15], v3 offset:2048
v_mfma_f32_16x16x32_bf16 v[104:107], a[36:39], a[108:111], v[104:107]
ds_read_b128 a[16:19], v2 offset:4096
v_subrev_u32 v5, 0x8000, v5
v_mfma_f32_16x16x32_bf16 v[88:91], a[44:47], a[108:111], v[88:91]
s_add_u32 m0, s76, 36864
ds_read_b128 a[20:23], v3 offset:4096
v_mfma_f32_16x16x32_bf16 v[88:91], a[40:43], a[104:107], v[88:91]
s_add_u32 s64, s70, 33664
ds_read_b128 a[24:27], v2 offset:6144
v_mfma_f32_16x16x32_bf16 v[28:31], a[48:51], a[104:107], v[28:31]
buffer_load_dwordx4 v12, s[32:35], s64 offen lds
v_mfma_f32_16x16x32_bf16 v[28:31], a[52:55], a[108:111], v[28:31]
ds_read_b128 a[28:31], v3 offset:6144
v_mfma_f32_16x16x32_bf16 v[44:47], a[60:63], a[108:111], v[44:47]
ds_read_b64_tr_b16 a[96:97], v9 offset:49152
v_mfma_f32_16x16x32_bf16 v[44:47], a[56:59], a[104:107], v[44:47]
ds_read_b64_tr_b16 a[98:99], v9 offset:50176
v_mfma_f32_16x16x32_bf16 v[60:63], a[56:59], a[112:115], v[60:63]
ds_read_b64_tr_b16 a[100:101], v9 offset:57344
v_mfma_f32_16x16x32_bf16 v[60:63], a[60:63], a[116:119], v[60:63]
s_add_u32 m0, s76, 37888
ds_read_b64_tr_b16 a[102:103], v9 offset:58368
v_subrev_u32 v6, 0x8000, v6
v_mfma_f32_16x16x32_bf16 v[76:79], a[52:55], a[116:119], v[76:79]
s_add_u32 s64, s70, 41856
ds_read_b64_tr_b16 a[104:105], v10 offset:49152
v_mfma_f32_16x16x32_bf16 v[76:79], a[48:51], a[112:115], v[76:79]
buffer_load_dwordx4 v13, s[32:35], s64 offen lds
v_mfma_f32_16x16x32_bf16 v[140:143], a[40:43], a[112:115], v[140:143]
ds_read_b64_tr_b16 a[106:107], v10 offset:50176
v_mfma_f32_16x16x32_bf16 v[140:143], a[44:47], a[116:119], v[140:143]
ds_read_b64_tr_b16 a[108:109], v10 offset:57344
v_mfma_f32_16x16x32_bf16 v[124:127], a[36:39], a[116:119], v[124:127]
ds_read_b64_tr_b16 a[110:111], v10 offset:58368
v_mfma_f32_16x16x32_bf16 v[124:127], a[32:35], a[112:115], v[124:127]
ds_read_b64_tr_b16 a[112:113], v11 offset:49152
v_mfma_f32_16x16x32_bf16 v[108:111], a[32:35], a[72:75], v[108:111]
s_add_u32 m0, s76, 38912
ds_read_b64_tr_b16 a[114:115], v11 offset:50176
v_mfma_f32_16x16x32_bf16 v[108:111], a[36:39], a[76:79], v[108:111]
s_add_u32 s64, s70, 50048
ds_read_b64_tr_b16 a[116:117], v11 offset:57344
v_subrev_u32 v7, 0x8000, v7
v_mfma_f32_16x16x32_bf16 v[92:95], a[44:47], a[76:79], v[92:95]
buffer_load_dwordx4 v12, s[32:35], s64 offen lds
v_mfma_f32_16x16x32_bf16 v[92:95], a[40:43], a[72:75], v[92:95]
ds_read_b64_tr_b16 a[118:119], v11 offset:58368
v_mfma_f32_16x16x32_bf16 v[32:35], a[48:51], a[72:75], v[32:35]
v_mfma_f32_16x16x32_bf16 v[32:35], a[52:55], a[76:79], v[32:35]
v_mfma_f32_16x16x32_bf16 v[48:51], a[60:63], a[76:79], v[48:51]
v_mfma_f32_16x16x32_bf16 v[48:51], a[56:59], a[72:75], v[48:51]
s_add_u32 m0, s76, 39936
v_mfma_f32_16x16x32_bf16 v[64:67], a[56:59], a[80:83], v[64:67]
s_add_u32 s64, s70, 58240
v_mfma_f32_16x16x32_bf16 v[64:67], a[60:63], a[84:87], v[64:67]
buffer_load_dwordx4 v13, s[32:35], s64 offen lds
v_mfma_f32_16x16x32_bf16 v[80:83], a[52:55], a[84:87], v[80:83]
v_subrev_u32 v8, 0x8000, v8
v_mfma_f32_16x16x32_bf16 v[80:83], a[48:51], a[80:83], v[80:83]
v_mfma_f32_16x16x32_bf16 v[144:147], a[40:43], a[80:83], v[144:147]
v_mfma_f32_16x16x32_bf16 v[144:147], a[44:47], a[84:87], v[144:147]
v_mfma_f32_16x16x32_bf16 v[128:131], a[36:39], a[84:87], v[128:131]
v_subrev_u32 v9, 0x8000, v9
v_subrev_u32 v10, 0x8000, v10
v_mfma_f32_16x16x32_bf16 v[128:131], a[32:35], a[80:83], v[128:131]
s_waitcnt lgkmcnt(0)
v_subrev_u32 v11, 0x8000, v11
v_mfma_f32_16x16x32_bf16 v[112:115], a[32:35], a[88:91], v[112:115]
v_mfma_f32_16x16x32_bf16 v[112:115], a[36:39], a[92:95], v[112:115]
v_mfma_f32_16x16x32_bf16 v[96:99], a[44:47], a[92:95], v[96:99]
s_waitcnt lgkmcnt(0)
s_barrier
v_mfma_f32_16x16x32_bf16 v[96:99], a[40:43], a[88:91], v[96:99]
s_add_u32 m0, s77, 131072
s_add_u32 s82, s82, 1048576
ds_read_b64_tr_b16 a[72:73], v4 offset:0
v_mfma_f32_16x16x32_bf16 v[36:39], a[48:51], a[88:91], v[36:39]
s_add_u32 s64, s71, 0
buffer_load_dword a252, v1, s[60:63], s82 offen
v_mfma_f32_16x16x32_bf16 v[36:39], a[52:55], a[92:95], v[36:39]
buffer_load_dwordx4 v14, s[56:59], s64 offen lds
v_mfma_f32_16x16x32_bf16 v[52:55], a[60:63], a[92:95], v[52:55]
ds_read_b64_tr_b16 a[74:75], v4 offset:1024
v_mfma_f32_16x16x32_bf16 v[52:55], a[56:59], a[88:91], v[52:55]
ds_read_b64_tr_b16 a[76:77], v4 offset:8192
v_mfma_f32_16x16x32_bf16 v[68:71], a[56:59], a[96:99], v[68:71]
ds_read_b64_tr_b16 a[78:79], v4 offset:9216
v_lshrrev_b32 v13, 3, v0
v_mfma_f32_16x16x32_bf16 v[68:71], a[60:63], a[100:103], v[68:71]
ds_read_b64_tr_b16 a[80:81], v5 offset:0
v_lshl_add_u32 v12, v13, 10, v12
v_mfma_f32_16x16x32_bf16 v[84:87], a[52:55], a[100:103], v[84:87]
ds_read_b64_tr_b16 a[82:83], v5 offset:1024
v_xor_b32 v13, 64, v12
v_mfma_f32_16x16x32_bf16 v[84:87], a[48:51], a[96:99], v[84:87]
s_add_u32 m0, s78, 147456
ds_read_b64_tr_b16 a[84:85], v5 offset:8192
v_mfma_f32_16x16x32_bf16 v[148:151], a[40:43], a[96:99], v[148:151]
s_add_u32 s64, s75, 0
ds_read_b64_tr_b16 a[86:87], v5 offset:9216
v_mfma_f32_16x16x32_bf16 v[148:151], a[44:47], a[100:103], v[148:151]
buffer_load_dwordx4 v23, s[60:63], s64 offen lds
v_mfma_f32_16x16x32_bf16 v[132:135], a[36:39], a[100:103], v[132:135]
ds_read_b64_tr_b16 a[88:89], v6 offset:0
v_mfma_f32_16x16x32_bf16 v[132:135], a[32:35], a[96:99], v[132:135]
ds_read_b64_tr_b16 a[90:91], v6 offset:1024
v_mfma_f32_16x16x32_bf16 v[116:119], a[32:35], a[104:107], v[116:119]
ds_read_b64_tr_b16 a[92:93], v6 offset:8192
v_mfma_f32_16x16x32_bf16 v[116:119], a[36:39], a[108:111], v[116:119]
ds_read_b64_tr_b16 a[94:95], v6 offset:9216
v_mfma_f32_16x16x32_bf16 v[100:103], a[44:47], a[108:111], v[100:103]
ds_read_b64_tr_b16 a[96:97], v7 offset:0
v_mfma_f32_16x16x32_bf16 v[100:103], a[40:43], a[104:107], v[100:103]
s_add_u32 m0, s77, 132096
ds_read_b64_tr_b16 a[98:99], v7 offset:1024
v_mfma_f32_16x16x32_bf16 a[120:123], a[48:51], a[104:107], a[120:123]
s_add_u32 s64, s71, 32768
ds_read_b64_tr_b16 a[100:101], v7 offset:8192
v_mfma_f32_16x16x32_bf16 a[120:123], a[52:55], a[108:111], a[120:123]
buffer_load_dwordx4 v14, s[56:59], s64 offen lds
v_mfma_f32_16x16x32_bf16 a[124:127], a[60:63], a[108:111], a[124:127]
ds_read_b64_tr_b16 a[102:103], v7 offset:9216
v_mfma_f32_16x16x32_bf16 a[124:127], a[56:59], a[104:107], a[124:127]
ds_read_b64_tr_b16 a[104:105], v8 offset:0
v_mfma_f32_16x16x32_bf16 a[128:131], a[56:59], a[112:115], a[128:131]
ds_read_b64_tr_b16 a[106:107], v8 offset:1024
v_mfma_f32_16x16x32_bf16 a[128:131], a[60:63], a[116:119], a[128:131]
ds_read_b64_tr_b16 a[108:109], v8 offset:8192
v_mfma_f32_16x16x32_bf16 a[132:135], a[52:55], a[116:119], a[132:135]
ds_read_b64_tr_b16 a[110:111], v8 offset:9216
v_mfma_f32_16x16x32_bf16 a[132:135], a[48:51], a[112:115], a[132:135]
s_add_u32 m0, s78, 151552
v_mfma_f32_16x16x32_bf16 a[136:139], a[40:43], a[112:115], a[136:139]
s_add_u32 s64, s75, 2048
v_mfma_f32_16x16x32_bf16 a[136:139], a[44:47], a[116:119], a[136:139]
buffer_load_dwordx4 v23, s[60:63], s64 offen lds
v_mfma_f32_16x16x32_bf16 a[140:143], a[36:39], a[116:119], a[140:143]
v_mfma_f32_16x16x32_bf16 a[140:143], a[32:35], a[112:115], a[140:143]
s_waitcnt lgkmcnt(5)
ds_read_b64_tr_b16 a[112:113], v9 offset:0
v_mfma_f32_16x16x32_bf16 v[184:187], a[72:75], a[0:3], v[184:187]
ds_read_b64_tr_b16 a[114:115], v9 offset:1024
v_mfma_f32_16x16x32_bf16 v[184:187], a[76:79], a[4:7], v[184:187]
ds_read_b64_tr_b16 a[116:117], v9 offset:8192
v_mfma_f32_16x16x32_bf16 v[192:195], a[76:79], a[12:15], v[192:195]
ds_read_b64_tr_b16 a[118:119], v9 offset:9216
v_mfma_f32_16x16x32_bf16 v[192:195], a[72:75], a[8:11], v[192:195]
s_add_u32 m0, s77, 133120
s_add_u32 s17, s78, .-L_pc+6144
v_mfma_f32_16x16x32_bf16 v[200:203], a[72:75], a[16:19], v[200:203]
s_add_u32 s64, s71, 65536
buffer_load_dword a252, v16, s[88:91], s17 offen
v_mfma_f32_16x16x32_bf16 v[200:203], a[76:79], a[20:23], v[200:203]
buffer_load_dwordx4 v15, s[56:59], s64 offen lds
v_mfma_f32_16x16x32_bf16 v[208:211], a[76:79], a[28:31], v[208:211]
v_mfma_f32_16x16x32_bf16 v[208:211], a[72:75], a[24:27], v[208:211]
ds_read_b64_tr_b16 a[72:73], v10 offset:0
v_mfma_f32_16x16x32_bf16 v[248:251], a[80:83], a[24:27], v[248:251]
ds_read_b64_tr_b16 a[74:75], v10 offset:1024
v_mfma_f32_16x16x32_bf16 v[248:251], a[84:87], a[28:31], v[248:251]
ds_read_b64_tr_b16 a[76:77], v10 offset:8192
v_mfma_f32_16x16x32_bf16 v[212:215], a[84:87], a[20:23], v[212:215]
ds_read_b64_tr_b16 a[78:79], v10 offset:9216
v_mfma_f32_16x16x32_bf16 v[212:215], a[80:83], a[16:19], v[212:215]
s_add_u32 m0, s78, 155648
v_mfma_f32_16x16x32_bf16 v[204:207], a[80:83], a[8:11], v[204:207]
s_add_u32 s64, s75, 4096
v_mfma_f32_16x16x32_bf16 v[204:207], a[84:87], a[12:15], v[204:207]
buffer_load_dwordx4 v23, s[60:63], s64 offen lds
v_mfma_f32_16x16x32_bf16 v[196:199], a[84:87], a[4:7], v[196:199]
v_mfma_f32_16x16x32_bf16 v[196:199], a[80:83], a[0:3], v[196:199]
s_add_u32 s81, s81, 1048576
ds_read_b64_tr_b16 a[80:81], v11 offset:0
v_mfma_f32_16x16x32_bf16 v[188:191], a[88:91], a[0:3], v[188:191]
buffer_load_dword a252, v16, s[56:59], s81 offen
v_mfma_f32_16x16x32_bf16 v[188:191], a[92:95], a[4:7], v[188:191]
ds_read_b64_tr_b16 a[82:83], v11 offset:1024
v_mfma_f32_16x16x32_bf16 v[216:219], a[92:95], a[12:15], v[216:219]
ds_read_b64_tr_b16 a[84:85], v11 offset:8192
v_mfma_f32_16x16x32_bf16 v[216:219], a[88:91], a[8:11], v[216:219]
s_add_u32 m0, s77, 134144
ds_read_b64_tr_b16 a[86:87], v11 offset:9216
v_mfma_f32_16x16x32_bf16 v[224:227], a[88:91], a[16:19], v[224:227]
s_add_u32 s64, s71, 98304
v_mfma_f32_16x16x32_bf16 v[224:227], a[92:95], a[20:23], v[224:227]
buffer_load_dwordx4 v15, s[56:59], s64 offen lds
v_mfma_f32_16x16x32_bf16 v[232:235], a[92:95], a[28:31], v[232:235]
v_mfma_f32_16x16x32_bf16 v[232:235], a[88:91], a[24:27], v[232:235]
ds_read_b64_tr_b16 a[88:89], v4 offset:16384
v_mfma_f32_16x16x32_bf16 v[240:243], a[96:99], a[24:27], v[240:243]
s_waitcnt lgkmcnt(5)
ds_read_b64_tr_b16 a[90:91], v4 offset:17408
v_mfma_f32_16x16x32_bf16 v[240:243], a[100:103], a[28:31], v[240:243]
ds_read_b64_tr_b16 a[92:93], v4 offset:24576
v_mfma_f32_16x16x32_bf16 v[252:255], a[100:103], a[20:23], v[252:255]
ds_read_b64_tr_b16 a[94:95], v4 offset:25600
v_mfma_f32_16x16x32_bf16 v[252:255], a[96:99], a[16:19], v[252:255]
s_add_u32 m0, s78, 159744
v_mfma_f32_16x16x32_bf16 v[244:247], a[96:99], a[8:11], v[244:247]
s_add_u32 s64, s74, 0
v_mfma_f32_16x16x32_bf16 v[244:247], a[100:103], a[12:15], v[244:247]
buffer_load_dwordx4 v22, s[48:51], s64 offen lds
v_mfma_f32_16x16x32_bf16 v[236:239], a[100:103], a[4:7], v[236:239]
v_mfma_f32_16x16x32_bf16 v[236:239], a[96:99], a[0:3], v[236:239]
ds_read_b64_tr_b16 a[96:97], v5 offset:16384
v_mfma_f32_16x16x32_bf16 v[228:231], a[104:107], a[0:3], v[228:231]
ds_read_b64_tr_b16 a[98:99], v5 offset:17408
v_mfma_f32_16x16x32_bf16 v[228:231], a[108:111], a[4:7], v[228:231]
ds_read_b64_tr_b16 a[100:101], v5 offset:24576
v_mfma_f32_16x16x32_bf16 v[220:223], a[108:111], a[12:15], v[220:223]
ds_read_b64_tr_b16 a[102:103], v5 offset:25600
v_mfma_f32_16x16x32_bf16 v[220:223], a[104:107], a[8:11], v[220:223]
v_mfma_f32_16x16x32_bf16 v[152:155], a[104:107], a[16:19], v[152:155]
v_mfma_f32_16x16x32_bf16 v[152:155], a[108:111], a[20:23], v[152:155]
v_mfma_f32_16x16x32_bf16 v[160:163], a[108:111], a[28:31], v[160:163]
s_add_u32 m0, s76, 0
v_mfma_f32_16x16x32_bf16 v[160:163], a[104:107], a[24:27], v[160:163]
s_add_u32 s64, s72, 0
ds_read_b64_tr_b16 a[104:105], v6 offset:16384
v_mfma_f32_16x16x32_bf16 v[168:171], a[112:115], a[24:27], v[168:171]
buffer_load_dwordx4 v12, s[48:51], s64 offen lds
v_mfma_f32_16x16x32_bf16 v[168:171], a[116:119], a[28:31], v[168:171]
ds_read_b64_tr_b16 a[106:107], v6 offset:17408
v_mfma_f32_16x16x32_bf16 v[176:179], a[116:119], a[20:23], v[176:179]
ds_read_b64_tr_b16 a[108:109], v6 offset:24576
v_mfma_f32_16x16x32_bf16 v[176:179], a[112:115], a[16:19], v[176:179]
ds_read_b64_tr_b16 a[110:111], v6 offset:25600
v_mfma_f32_16x16x32_bf16 v[180:183], a[112:115], a[8:11], v[180:183]
v_mfma_f32_16x16x32_bf16 v[180:183], a[116:119], a[12:15], v[180:183]
s_add_u32 m0, s76, 1024
v_mfma_f32_16x16x32_bf16 v[172:175], a[116:119], a[4:7], v[172:175]
s_add_u32 s64, s72, 16384
v_mfma_f32_16x16x32_bf16 v[172:175], a[112:115], a[0:3], v[172:175]
buffer_load_dwordx4 v13, s[48:51], s64 offen lds
v_mfma_f32_16x16x32_bf16 v[164:167], a[72:75], a[0:3], v[164:167]
ds_read_b64_tr_b16 a[112:113], v7 offset:16384
v_mfma_f32_16x16x32_bf16 v[164:167], a[76:79], a[4:7], v[164:167]
ds_read_b64_tr_b16 a[114:115], v7 offset:17408
v_mfma_f32_16x16x32_bf16 v[156:159], a[76:79], a[12:15], v[156:159]
ds_read_b64_tr_b16 a[116:117], v7 offset:24576
v_mfma_f32_16x16x32_bf16 v[156:159], a[72:75], a[8:11], v[156:159]
ds_read_b64_tr_b16 a[118:119], v7 offset:25600
v_mfma_f32_16x16x32_bf16 v[24:27], a[72:75], a[16:19], v[24:27]
s_add_u32 m0, s76, 2048
v_mfma_f32_16x16x32_bf16 v[24:27], a[76:79], a[20:23], v[24:27]
s_add_u32 s64, s72, 131072
v_mfma_f32_16x16x32_bf16 v[40:43], a[76:79], a[28:31], v[40:43]
s_waitcnt vmcnt(13)
buffer_load_dwordx4 v12, s[48:51], s64 offen lds
v_mfma_f32_16x16x32_bf16 v[40:43], a[72:75], a[24:27], v[40:43]
s_waitcnt lgkmcnt(4)
ds_read_b64_tr_b16 a[72:73], v8 offset:16384
v_mfma_f32_16x16x32_bf16 v[56:59], a[80:83], a[24:27], v[56:59]
ds_read_b64_tr_b16 a[74:75], v8 offset:17408
v_mfma_f32_16x16x32_bf16 v[56:59], a[84:87], a[28:31], v[56:59]
ds_read_b64_tr_b16 a[76:77], v8 offset:24576
v_mfma_f32_16x16x32_bf16 v[72:75], a[84:87], a[20:23], v[72:75]
ds_read_b64_tr_b16 a[78:79], v8 offset:25600
v_mfma_f32_16x16x32_bf16 v[72:75], a[80:83], a[16:19], v[72:75]
s_add_u32 m0, s76, 3072
s_add_u32 s82, s82, 1048576
ds_read_b128 a[32:35], v2 offset:32768
v_mfma_f32_16x16x32_bf16 v[136:139], a[80:83], a[8:11], v[136:139]
s_add_u32 s64, s72, 147456
buffer_load_dword a252, v1, s[60:63], s82 offen
v_mfma_f32_16x16x32_bf16 v[136:139], a[84:87], a[12:15], v[136:139]
buffer_load_dwordx4 v13, s[48:51], s64 offen lds
v_mfma_f32_16x16x32_bf16 v[120:123], a[84:87], a[4:7], v[120:123]
ds_read_b128 a[36:39], v3 offset:32768
v_mfma_f32_16x16x32_bf16 v[120:123], a[80:83], a[0:3], v[120:123]
ds_read_b128 a[40:43], v2 offset:34816
v_mfma_f32_16x16x32_bf16 v[104:107], a[0:3], a[88:91], v[104:107]
ds_read_b128 a[44:47], v3 offset:34816
v_mfma_f32_16x16x32_bf16 v[104:107], a[4:7], a[92:95], v[104:107]
ds_read_b128 a[48:51], v2 offset:36864
v_mfma_f32_16x16x32_bf16 v[88:91], a[12:15], a[92:95], v[88:91]
s_add_u32 m0, s76, 4096
ds_read_b128 a[52:55], v3 offset:36864
v_mfma_f32_16x16x32_bf16 v[88:91], a[8:11], a[88:91], v[88:91]
s_add_u32 s64, s73, 0
ds_read_b128 a[56:59], v2 offset:38912
v_mfma_f32_16x16x32_bf16 v[28:31], a[16:19], a[88:91], v[28:31]
buffer_load_dwordx4 v12, s[48:51], s64 offen lds
v_mfma_f32_16x16x32_bf16 v[28:31], a[20:23], a[92:95], v[28:31]
ds_read_b128 a[60:63], v3 offset:38912
v_mfma_f32_16x16x32_bf16 v[44:47], a[28:31], a[92:95], v[44:47]
ds_read_b64_tr_b16 a[80:81], v9 offset:16384
v_mfma_f32_16x16x32_bf16 v[44:47], a[24:27], a[88:91], v[44:47]
ds_read_b64_tr_b16 a[82:83], v9 offset:17408
v_mfma_f32_16x16x32_bf16 v[60:63], a[24:27], a[96:99], v[60:63]
ds_read_b64_tr_b16 a[84:85], v9 offset:24576
v_mfma_f32_16x16x32_bf16 v[60:63], a[28:31], a[100:103], v[60:63]
s_add_u32 m0, s76, 5120
ds_read_b64_tr_b16 a[86:87], v9 offset:25600
v_mfma_f32_16x16x32_bf16 v[76:79], a[20:23], a[100:103], v[76:79]
s_add_u32 s64, s73, 16384
ds_read_b64_tr_b16 a[88:89], v10 offset:16384
v_mfma_f32_16x16x32_bf16 v[76:79], a[16:19], a[96:99], v[76:79]
buffer_load_dwordx4 v13, s[48:51], s64 offen lds
v_mfma_f32_16x16x32_bf16 v[140:143], a[8:11], a[96:99], v[140:143]
ds_read_b64_tr_b16 a[90:91], v10 offset:17408
v_mfma_f32_16x16x32_bf16 v[140:143], a[12:15], a[100:103], v[140:143]
ds_read_b64_tr_b16 a[92:93], v10 offset:24576
v_mfma_f32_16x16x32_bf16 v[124:127], a[4:7], a[100:103], v[124:127]
ds_read_b64_tr_b16 a[94:95], v10 offset:25600
v_mfma_f32_16x16x32_bf16 v[124:127], a[0:3], a[96:99], v[124:127]
ds_read_b64_tr_b16 a[96:97], v11 offset:16384
v_mfma_f32_16x16x32_bf16 v[108:111], a[0:3], a[104:107], v[108:111]
s_add_u32 m0, s76, 6144
ds_read_b64_tr_b16 a[98:99], v11 offset:17408
v_mfma_f32_16x16x32_bf16 v[108:111], a[4:7], a[108:111], v[108:111]
s_add_u32 s64, s73, 131072
ds_read_b64_tr_b16 a[100:101], v11 offset:24576
v_mfma_f32_16x16x32_bf16 v[92:95], a[12:15], a[108:111], v[92:95]
buffer_load_dwordx4 v12, s[48:51], s64 offen lds
v_mfma_f32_16x16x32_bf16 v[92:95], a[8:11], a[104:107], v[92:95]
ds_read_b64_tr_b16 a[102:103], v11 offset:25600
v_mfma_f32_16x16x32_bf16 v[32:35], a[16:19], a[104:107], v[32:35]
v_mfma_f32_16x16x32_bf16 v[32:35], a[20:23], a[108:111], v[32:35]
v_mfma_f32_16x16x32_bf16 v[48:51], a[28:31], a[108:111], v[48:51]
v_mfma_f32_16x16x32_bf16 v[48:51], a[24:27], a[104:107], v[48:51]
s_waitcnt lgkmcnt(5)
s_add_u32 m0, s76, 7168
v_mfma_f32_16x16x32_bf16 v[64:67], a[24:27], a[112:115], v[64:67]
s_add_u32 s64, s73, 147456
v_mfma_f32_16x16x32_bf16 v[64:67], a[28:31], a[116:119], v[64:67]
buffer_load_dwordx4 v13, s[48:51], s64 offen lds
v_mfma_f32_16x16x32_bf16 v[80:83], a[20:23], a[116:119], v[80:83]
v_mfma_f32_16x16x32_bf16 v[80:83], a[16:19], a[112:115], v[80:83]
v_mfma_f32_16x16x32_bf16 v[144:147], a[8:11], a[112:115], v[144:147]
v_mfma_f32_16x16x32_bf16 v[144:147], a[12:15], a[116:119], v[144:147]
v_mfma_f32_16x16x32_bf16 v[128:131], a[4:7], a[116:119], v[128:131]
v_mfma_f32_16x16x32_bf16 v[128:131], a[0:3], a[112:115], v[128:131]
v_mfma_f32_16x16x32_bf16 v[112:115], a[0:3], a[72:75], v[112:115]
v_mfma_f32_16x16x32_bf16 v[112:115], a[4:7], a[76:79], v[112:115]
v_mfma_f32_16x16x32_bf16 v[96:99], a[12:15], a[76:79], v[96:99]
s_waitcnt lgkmcnt(0)
s_barrier
v_mfma_f32_16x16x32_bf16 v[96:99], a[8:11], a[72:75], v[96:99]
s_add_u32 m0, s77, 65536
ds_read_b64_tr_b16 a[104:105], v4 offset:32768
v_mfma_f32_16x16x32_bf16 v[36:39], a[16:19], a[72:75], v[36:39]
s_add_u32 s64, s71, 524288
ds_read_b64_tr_b16 a[106:107], v4 offset:33792
v_mfma_f32_16x16x32_bf16 v[36:39], a[20:23], a[76:79], v[36:39]
buffer_load_dwordx4 v14, s[56:59], s64 offen lds
v_mfma_f32_16x16x32_bf16 v[52:55], a[28:31], a[76:79], v[52:55]
ds_read_b64_tr_b16 a[108:109], v4 offset:40960
v_mfma_f32_16x16x32_bf16 v[52:55], a[24:27], a[72:75], v[52:55]
ds_read_b64_tr_b16 a[110:111], v4 offset:41984
v_mfma_f32_16x16x32_bf16 v[68:71], a[24:27], a[80:83], v[68:71]
ds_read_b64_tr_b16 a[112:113], v5 offset:32768
v_mfma_f32_16x16x32_bf16 v[68:71], a[28:31], a[84:87], v[68:71]
ds_read_b64_tr_b16 a[114:115], v5 offset:33792
v_mfma_f32_16x16x32_bf16 v[84:87], a[20:23], a[84:87], v[84:87]
ds_read_b64_tr_b16 a[116:117], v5 offset:40960
v_mfma_f32_16x16x32_bf16 v[84:87], a[16:19], a[80:83], v[84:87]
s_add_u32 m0, s78, 81920
ds_read_b64_tr_b16 a[118:119], v5 offset:41984
v_mfma_f32_16x16x32_bf16 v[148:151], a[8:11], a[80:83], v[148:151]
s_add_u32 s64, s75, 393216
ds_read_b64_tr_b16 a[72:73], v6 offset:32768
v_mfma_f32_16x16x32_bf16 v[148:151], a[12:15], a[84:87], v[148:151]
buffer_load_dwordx4 v23, s[60:63], s64 offen lds
v_mfma_f32_16x16x32_bf16 v[132:135], a[4:7], a[84:87], v[132:135]
ds_read_b64_tr_b16 a[74:75], v6 offset:33792
v_mfma_f32_16x16x32_bf16 v[132:135], a[0:3], a[80:83], v[132:135]
ds_read_b64_tr_b16 a[76:77], v6 offset:40960
v_mfma_f32_16x16x32_bf16 v[116:119], a[0:3], a[88:91], v[116:119]
ds_read_b64_tr_b16 a[78:79], v6 offset:41984
v_mfma_f32_16x16x32_bf16 v[116:119], a[4:7], a[92:95], v[116:119]
ds_read_b64_tr_b16 a[80:81], v7 offset:32768
v_mfma_f32_16x16x32_bf16 v[100:103], a[12:15], a[92:95], v[100:103]
ds_read_b64_tr_b16 a[82:83], v7 offset:33792
v_mfma_f32_16x16x32_bf16 v[100:103], a[8:11], a[88:91], v[100:103]
s_add_u32 m0, s77, 66560
ds_read_b64_tr_b16 a[84:85], v7 offset:40960
v_mfma_f32_16x16x32_bf16 a[120:123], a[16:19], a[88:91], a[120:123]
s_add_u32 s64, s71, 557056
ds_read_b64_tr_b16 a[86:87], v7 offset:41984
v_mfma_f32_16x16x32_bf16 a[120:123], a[20:23], a[92:95], a[120:123]
buffer_load_dwordx4 v14, s[56:59], s64 offen lds
v_mfma_f32_16x16x32_bf16 a[124:127], a[28:31], a[92:95], a[124:127]
v_mfma_f32_16x16x32_bf16 a[124:127], a[24:27], a[88:91], a[124:127]
ds_read_b64_tr_b16 a[88:89], v8 offset:32768
v_mfma_f32_16x16x32_bf16 a[128:131], a[24:27], a[96:99], a[128:131]
ds_read_b64_tr_b16 a[90:91], v8 offset:33792
v_mfma_f32_16x16x32_bf16 a[128:131], a[28:31], a[100:103], a[128:131]
ds_read_b64_tr_b16 a[92:93], v8 offset:40960
v_mfma_f32_16x16x32_bf16 a[132:135], a[20:23], a[100:103], a[132:135]
ds_read_b64_tr_b16 a[94:95], v8 offset:41984
v_mfma_f32_16x16x32_bf16 a[132:135], a[16:19], a[96:99], a[132:135]
s_add_u32 m0, s78, 86016
v_mfma_f32_16x16x32_bf16 a[136:139], a[8:11], a[96:99], a[136:139]
s_add_u32 s64, s75, 395264
v_mfma_f32_16x16x32_bf16 a[136:139], a[12:15], a[100:103], a[136:139]
buffer_load_dwordx4 v23, s[60:63], s64 offen lds
v_mfma_f32_16x16x32_bf16 a[140:143], a[4:7], a[100:103], a[140:143]
v_mfma_f32_16x16x32_bf16 a[140:143], a[0:3], a[96:99], a[140:143]
s_waitcnt lgkmcnt(4)
ds_read_b64_tr_b16 a[96:97], v9 offset:32768
v_mfma_f32_16x16x32_bf16 v[184:187], a[104:107], a[32:35], v[184:187]
s_lshl_b32 s66, s30, 30
ds_read_b64_tr_b16 a[98:99], v9 offset:33792
v_mfma_f32_16x16x32_bf16 v[184:187], a[108:111], a[36:39], v[184:187]
ds_read_b64_tr_b16 a[100:101], v9 offset:40960
v_lshl_add_u32 v1, v0, 24, s66
v_mfma_f32_16x16x32_bf16 v[192:195], a[108:111], a[44:47], v[192:195]
s_lshr_b32 s66, s3, 1
ds_read_b64_tr_b16 a[102:103], v9 offset:41984
v_mfma_f32_16x16x32_bf16 v[192:195], a[104:107], a[40:43], v[192:195]
s_lshl_b32 s66, s66, 12
s_add_u32 m0, s77, 67584
v_mfma_f32_16x16x32_bf16 v[200:203], a[104:107], a[48:51], v[200:203]
s_add_u32 s64, s71, 589824
v_mfma_f32_16x16x32_bf16 v[200:203], a[108:111], a[52:55], v[200:203]
buffer_load_dwordx4 v15, s[56:59], s64 offen lds
v_mfma_f32_16x16x32_bf16 v[208:211], a[108:111], a[60:63], v[208:211]
v_mfma_f32_16x16x32_bf16 v[208:211], a[104:107], a[56:59], v[208:211]
ds_read_b64_tr_b16 a[104:105], v10 offset:32768
v_mfma_f32_16x16x32_bf16 v[248:251], a[112:115], a[56:59], v[248:251]
ds_read_b64_tr_b16 a[106:107], v10 offset:33792
v_mfma_f32_16x16x32_bf16 v[248:251], a[116:119], a[60:63], v[248:251]
ds_read_b64_tr_b16 a[108:109], v10 offset:40960
v_mfma_f32_16x16x32_bf16 v[212:215], a[116:119], a[52:55], v[212:215]
ds_read_b64_tr_b16 a[110:111], v10 offset:41984
v_mfma_f32_16x16x32_bf16 v[212:215], a[112:115], a[48:51], v[212:215]
s_add_u32 m0, s78, 90112
v_mfma_f32_16x16x32_bf16 v[204:207], a[112:115], a[40:43], v[204:207]
s_add_u32 s64, s75, 397312
v_mfma_f32_16x16x32_bf16 v[204:207], a[116:119], a[44:47], v[204:207]
buffer_load_dwordx4 v23, s[60:63], s64 offen lds
v_mfma_f32_16x16x32_bf16 v[196:199], a[116:119], a[36:39], v[196:199]
v_mfma_f32_16x16x32_bf16 v[196:199], a[112:115], a[32:35], v[196:199]
s_add_u32 s65, s79, 20480
ds_read_b64_tr_b16 a[112:113], v11 offset:32768
v_mfma_f32_16x16x32_bf16 v[188:191], a[72:75], a[32:35], v[188:191]
ds_read_b64_tr_b16 a[114:115], v11 offset:33792
v_mfma_f32_16x16x32_bf16 v[188:191], a[76:79], a[36:39], v[188:191]
ds_read_b64_tr_b16 a[116:117], v11 offset:40960
v_cvt_pk_bf16_f32 v251, v250, v251
v_mfma_f32_16x16x32_bf16 v[216:219], a[76:79], a[44:47], v[216:219]
ds_read_b64_tr_b16 a[118:119], v11 offset:41984
v_cvt_pk_bf16_f32 v250, v248, v249
v_mfma_f32_16x16x32_bf16 v[216:219], a[72:75], a[40:43], v[216:219]
s_add_u32 m0, s77, 68608
v_cvt_pk_bf16_f32 v248, v208, v209
v_cvt_pk_bf16_f32 v249, v210, v211
v_mfma_f32_16x16x32_bf16 v[224:227], a[72:75], a[48:51], v[224:227]
s_add_u32 s64, s71, 622592
buffer_store_dwordx4 v[248:251], v16, s[44:47], s65 offen sc1
v_mfma_f32_16x16x32_bf16 v[224:227], a[76:79], a[52:55], v[224:227]
buffer_load_dwordx4 v15, s[56:59], s64 offen lds
v_mfma_f32_16x16x32_bf16 v[232:235], a[76:79], a[60:63], v[232:235]
v_cvt_pk_bf16_f32 v215, v214, v215
v_cvt_pk_bf16_f32 v214, v212, v213
v_mfma_f32_16x16x32_bf16 v[232:235], a[72:75], a[56:59], v[232:235]
ds_read_b64_tr_b16 a[72:73], v4 offset:49152
v_cvt_pk_bf16_f32 v212, v200, v201
v_mfma_f32_16x16x32_bf16 v[240:243], a[80:83], a[56:59], v[240:243]
ds_read_b64_tr_b16 a[74:75], v4 offset:50176
v_cvt_pk_bf16_f32 v213, v202, v203
v_mfma_f32_16x16x32_bf16 v[240:243], a[84:87], a[60:63], v[240:243]
ds_read_b64_tr_b16 a[76:77], v4 offset:57344
v_accvgpr_write_b32 a144, v212
v_mfma_f32_16x16x32_bf16 v[252:255], a[84:87], a[52:55], v[252:255]
ds_read_b64_tr_b16 a[78:79], v4 offset:58368
v_accvgpr_write_b32 a145, v213
v_mfma_f32_16x16x32_bf16 v[252:255], a[80:83], a[48:51], v[252:255]
s_add_u32 m0, s78, 94208
v_accvgpr_write_b32 a146, v214
v_accvgpr_write_b32 a147, v215
v_mfma_f32_16x16x32_bf16 v[244:247], a[80:83], a[40:43], v[244:247]
s_add_u32 s64, s74, 128
v_cvt_pk_bf16_f32 v207, v206, v207
v_cvt_pk_bf16_f32 v206, v204, v205
v_mfma_f32_16x16x32_bf16 v[244:247], a[84:87], a[44:47], v[244:247]
buffer_load_dwordx4 v22, s[48:51], s64 offen lds
v_mfma_f32_16x16x32_bf16 v[236:239], a[84:87], a[36:39], v[236:239]
v_cvt_pk_bf16_f32 v204, v192, v193
v_cvt_pk_bf16_f32 v205, v194, v195
v_mfma_f32_16x16x32_bf16 v[236:239], a[80:83], a[32:35], v[236:239]
s_waitcnt lgkmcnt(4)
ds_read_b64_tr_b16 a[80:81], v5 offset:49152
v_accvgpr_write_b32 a148, v204
v_mfma_f32_16x16x32_bf16 v[228:231], a[88:91], a[32:35], v[228:231]
ds_read_b64_tr_b16 a[82:83], v5 offset:50176
v_accvgpr_write_b32 a149, v205
v_mfma_f32_16x16x32_bf16 v[228:231], a[92:95], a[36:39], v[228:231]
ds_read_b64_tr_b16 a[84:85], v5 offset:57344
v_accvgpr_write_b32 a150, v206
v_mfma_f32_16x16x32_bf16 v[220:223], a[92:95], a[44:47], v[220:223]
ds_read_b64_tr_b16 a[86:87], v5 offset:58368
v_accvgpr_write_b32 a151, v207
v_mfma_f32_16x16x32_bf16 v[220:223], a[88:91], a[40:43], v[220:223]
v_cvt_pk_bf16_f32 v199, v198, v199
v_cvt_pk_bf16_f32 v198, v196, v197
v_mfma_f32_16x16x32_bf16 v[152:155], a[88:91], a[48:51], v[152:155]
v_cvt_pk_bf16_f32 v196, v184, v185
v_cvt_pk_bf16_f32 v197, v186, v187
v_mfma_f32_16x16x32_bf16 v[152:155], a[92:95], a[52:55], v[152:155]
v_accvgpr_write_b32 a152, v196
v_accvgpr_write_b32 a153, v197
v_mfma_f32_16x16x32_bf16 v[160:163], a[92:95], a[60:63], v[160:163]
s_add_u32 m0, s76, 32768
v_accvgpr_write_b32 a154, v198
v_accvgpr_write_b32 a155, v199
v_mfma_f32_16x16x32_bf16 v[160:163], a[88:91], a[56:59], v[160:163]
s_add_u32 s65, s79, 21504
s_add_u32 s64, s72, 128
ds_read_b64_tr_b16 a[88:89], v6 offset:49152
v_cvt_pk_bf16_f32 v243, v242, v243
v_mfma_f32_16x16x32_bf16 v[168:171], a[96:99], a[56:59], v[168:171]
buffer_load_dwordx4 v12, s[48:51], s64 offen lds
v_mfma_f32_16x16x32_bf16 v[168:171], a[100:103], a[60:63], v[168:171]
ds_read_b64_tr_b16 a[90:91], v6 offset:50176
v_cvt_pk_bf16_f32 v242, v240, v241
v_mfma_f32_16x16x32_bf16 v[176:179], a[100:103], a[52:55], v[176:179]
ds_read_b64_tr_b16 a[92:93], v6 offset:57344
v_cvt_pk_bf16_f32 v240, v232, v233
v_mfma_f32_16x16x32_bf16 v[176:179], a[96:99], a[48:51], v[176:179]
ds_read_b64_tr_b16 a[94:95], v6 offset:58368
v_cvt_pk_bf16_f32 v241, v234, v235
v_mfma_f32_16x16x32_bf16 v[180:183], a[96:99], a[40:43], v[180:183]
buffer_store_dwordx4 v[240:243], v16, s[44:47], s65 offen sc1
v_mfma_f32_16x16x32_bf16 v[180:183], a[100:103], a[44:47], v[180:183]
s_add_u32 m0, s76, 33792
v_cvt_pk_bf16_f32 v255, v254, v255
v_cvt_pk_bf16_f32 v254, v252, v253
v_mfma_f32_16x16x32_bf16 v[172:175], a[100:103], a[36:39], v[172:175]
s_add_u32 s64, s72, 16512
v_cvt_pk_bf16_f32 v252, v224, v225
v_cvt_pk_bf16_f32 v253, v226, v227
v_mfma_f32_16x16x32_bf16 v[172:175], a[96:99], a[32:35], v[172:175]
buffer_load_dwordx4 v13, s[48:51], s64 offen lds
v_mfma_f32_16x16x32_bf16 v[164:167], a[104:107], a[32:35], v[164:167]
ds_read_b64_tr_b16 a[96:97], v7 offset:49152
v_accvgpr_write_b32 a156, v252
v_mfma_f32_16x16x32_bf16 v[164:167], a[108:111], a[36:39], v[164:167]
ds_read_b64_tr_b16 a[98:99], v7 offset:50176
v_accvgpr_write_b32 a157, v253
v_mfma_f32_16x16x32_bf16 v[156:159], a[108:111], a[44:47], v[156:159]
ds_read_b64_tr_b16 a[100:101], v7 offset:57344
v_accvgpr_write_b32 a158, v254
v_mfma_f32_16x16x32_bf16 v[156:159], a[104:107], a[40:43], v[156:159]
ds_read_b64_tr_b16 a[102:103], v7 offset:58368
v_accvgpr_write_b32 a159, v255
v_mfma_f32_16x16x32_bf16 v[24:27], a[104:107], a[48:51], v[24:27]
s_add_u32 m0, s76, 34816
v_cvt_pk_bf16_f32 v247, v246, v247
v_cvt_pk_bf16_f32 v246, v244, v245
v_mfma_f32_16x16x32_bf16 v[24:27], a[108:111], a[52:55], v[24:27]
s_add_u32 s64, s72, 131200
v_cvt_pk_bf16_f32 v244, v216, v217
v_cvt_pk_bf16_f32 v245, v218, v219
v_mfma_f32_16x16x32_bf16 v[40:43], a[108:111], a[60:63], v[40:43]
s_waitcnt vmcnt(12)
buffer_load_dwordx4 v12, s[48:51], s64 offen lds
v_mfma_f32_16x16x32_bf16 v[40:43], a[104:107], a[56:59], v[40:43]
ds_read_b64_tr_b16 a[104:105], v8 offset:49152
v_accvgpr_write_b32 a160, v244
v_mfma_f32_16x16x32_bf16 v[56:59], a[112:115], a[56:59], v[56:59]
ds_read_b64_tr_b16 a[106:107], v8 offset:50176
v_accvgpr_write_b32 a161, v245
v_mfma_f32_16x16x32_bf16 v[56:59], a[116:119], a[60:63], v[56:59]
ds_read_b64_tr_b16 a[108:109], v8 offset:57344
v_add_u32 v4, 0x8000, v4
v_mfma_f32_16x16x32_bf16 v[72:75], a[116:119], a[52:55], v[72:75]
ds_read_b64_tr_b16 a[110:111], v8 offset:58368
v_accvgpr_write_b32 a162, v246
v_mfma_f32_16x16x32_bf16 v[72:75], a[112:115], a[48:51], v[72:75]
s_add_u32 m0, s76, 35840
ds_read_b128 a[0:3], v2 offset:0
v_accvgpr_write_b32 a163, v247
v_mfma_f32_16x16x32_bf16 v[136:139], a[112:115], a[40:43], v[136:139]
s_add_u32 s64, s72, 147584
ds_read_b128 a[4:7], v3 offset:0
v_cvt_pk_bf16_f32 v239, v238, v239
v_mfma_f32_16x16x32_bf16 v[136:139], a[116:119], a[44:47], v[136:139]
buffer_load_dwordx4 v13, s[48:51], s64 offen lds
v_mfma_f32_16x16x32_bf16 v[120:123], a[116:119], a[36:39], v[120:123]
ds_read_b128 a[8:11], v2 offset:2048
v_cvt_pk_bf16_f32 v238, v236, v237
v_mfma_f32_16x16x32_bf16 v[120:123], a[112:115], a[32:35], v[120:123]
s_waitcnt lgkmcnt(7)
ds_read_b128 a[12:15], v3 offset:2048
v_cvt_pk_bf16_f32 v236, v188, v189
v_mfma_f32_16x16x32_bf16 v[104:107], a[32:35], a[72:75], v[104:107]
ds_read_b128 a[16:19], v2 offset:4096
v_cvt_pk_bf16_f32 v237, v190, v191
v_mfma_f32_16x16x32_bf16 v[104:107], a[36:39], a[76:79], v[104:107]
ds_read_b128 a[20:23], v3 offset:4096
v_add_u32 v5, 0x8000, v5
v_mfma_f32_16x16x32_bf16 v[88:91], a[44:47], a[76:79], v[88:91]
s_add_u32 m0, s76, 36864
ds_read_b128 a[24:27], v2 offset:6144
v_accvgpr_write_b32 a164, v236
v_mfma_f32_16x16x32_bf16 v[88:91], a[40:43], a[72:75], v[88:91]
s_add_u32 s64, s73, 128
ds_read_b128 a[28:31], v3 offset:6144
v_accvgpr_write_b32 a165, v237
v_mfma_f32_16x16x32_bf16 v[28:31], a[48:51], a[72:75], v[28:31]
buffer_load_dwordx4 v12, s[48:51], s64 offen lds
v_mfma_f32_16x16x32_bf16 v[28:31], a[52:55], a[76:79], v[28:31]
ds_read_b64_tr_b16 a[112:113], v9 offset:49152
v_accvgpr_write_b32 a166, v238
v_mfma_f32_16x16x32_bf16 v[44:47], a[60:63], a[76:79], v[44:47]
ds_read_b64_tr_b16 a[114:115], v9 offset:50176
v_accvgpr_write_b32 a167, v239
v_mfma_f32_16x16x32_bf16 v[44:47], a[56:59], a[72:75], v[44:47]
s_add_u32 s65, s79, 22528
ds_read_b64_tr_b16 a[116:117], v9 offset:57344
v_cvt_pk_bf16_f32 v171, v170, v171
v_mfma_f32_16x16x32_bf16 v[60:63], a[56:59], a[80:83], v[60:63]
ds_read_b64_tr_b16 a[118:119], v9 offset:58368
v_cvt_pk_bf16_f32 v170, v168, v169
v_mfma_f32_16x16x32_bf16 v[60:63], a[60:63], a[84:87], v[60:63]
s_add_u32 m0, s76, 37888
ds_read_b64_tr_b16 a[72:73], v10 offset:49152
v_add_u32 v6, 0x8000, v6
v_mfma_f32_16x16x32_bf16 v[76:79], a[52:55], a[84:87], v[76:79]
s_add_u32 s64, s73, 16512
ds_read_b64_tr_b16 a[74:75], v10 offset:50176
v_cvt_pk_bf16_f32 v168, v160, v161
v_mfma_f32_16x16x32_bf16 v[76:79], a[48:51], a[80:83], v[76:79]
buffer_load_dwordx4 v13, s[48:51], s64 offen lds
v_mfma_f32_16x16x32_bf16 v[140:143], a[40:43], a[80:83], v[140:143]
ds_read_b64_tr_b16 a[76:77], v10 offset:57344
v_cvt_pk_bf16_f32 v169, v162, v163
v_mfma_f32_16x16x32_bf16 v[140:143], a[44:47], a[84:87], v[140:143]
ds_read_b64_tr_b16 a[78:79], v10 offset:58368
v_mfma_f32_16x16x32_bf16 v[124:127], a[36:39], a[84:87], v[124:127]
buffer_store_dwordx4 v[168:171], v16, s[44:47], s65 offen sc1
v_mfma_f32_16x16x32_bf16 v[124:127], a[32:35], a[80:83], v[124:127]
ds_read_b64_tr_b16 a[80:81], v11 offset:49152
v_cvt_pk_bf16_f32 v179, v178, v179
v_mfma_f32_16x16x32_bf16 v[108:111], a[32:35], a[88:91], v[108:111]
s_add_u32 m0, s76, 38912
ds_read_b64_tr_b16 a[82:83], v11 offset:50176
v_cvt_pk_bf16_f32 v178, v176, v177
v_mfma_f32_16x16x32_bf16 v[108:111], a[36:39], a[92:95], v[108:111]
s_add_u32 s64, s73, 131200
ds_read_b64_tr_b16 a[84:85], v11 offset:57344
v_add_u32 v7, 0x8000, v7
v_mfma_f32_16x16x32_bf16 v[92:95], a[44:47], a[92:95], v[92:95]
buffer_load_dwordx4 v12, s[48:51], s64 offen lds
v_mfma_f32_16x16x32_bf16 v[92:95], a[40:43], a[88:91], v[92:95]
ds_read_b64_tr_b16 a[86:87], v11 offset:58368
v_cvt_pk_bf16_f32 v176, v152, v153
v_mfma_f32_16x16x32_bf16 v[32:35], a[48:51], a[88:91], v[32:35]
v_cvt_pk_bf16_f32 v177, v154, v155
v_accvgpr_write_b32 a168, v176
v_mfma_f32_16x16x32_bf16 v[32:35], a[52:55], a[92:95], v[32:35]
v_accvgpr_write_b32 a169, v177
v_accvgpr_write_b32 a170, v178
v_mfma_f32_16x16x32_bf16 v[48:51], a[60:63], a[92:95], v[48:51]
v_accvgpr_write_b32 a171, v179
v_cvt_pk_bf16_f32 v183, v182, v183
v_mfma_f32_16x16x32_bf16 v[48:51], a[56:59], a[88:91], v[48:51]
s_add_u32 m0, s76, 39936
v_cvt_pk_bf16_f32 v182, v180, v181
v_cvt_pk_bf16_f32 v180, v220, v221
v_mfma_f32_16x16x32_bf16 v[64:67], a[56:59], a[96:99], v[64:67]
s_add_u32 s64, s73, 147584
v_cvt_pk_bf16_f32 v181, v222, v223
v_accvgpr_write_b32 a172, v180
v_mfma_f32_16x16x32_bf16 v[64:67], a[60:63], a[100:103], v[64:67]
buffer_load_dwordx4 v13, s[48:51], s64 offen lds
v_mfma_f32_16x16x32_bf16 v[80:83], a[52:55], a[100:103], v[80:83]
v_add_u32 v8, 0x8000, v8
v_accvgpr_write_b32 a173, v181
v_mfma_f32_16x16x32_bf16 v[80:83], a[48:51], a[96:99], v[80:83]
v_accvgpr_write_b32 a174, v182
v_accvgpr_write_b32 a175, v183
v_mfma_f32_16x16x32_bf16 v[144:147], a[40:43], a[96:99], v[144:147]
v_cvt_pk_bf16_f32 v175, v174, v175
v_cvt_pk_bf16_f32 v174, v172, v173
v_mfma_f32_16x16x32_bf16 v[144:147], a[44:47], a[100:103], v[144:147]
v_cvt_pk_bf16_f32 v172, v228, v229
v_cvt_pk_bf16_f32 v173, v230, v231
v_mfma_f32_16x16x32_bf16 v[128:131], a[36:39], a[100:103], v[128:131]
v_add_u32 v9, 0x8000, v9
v_add_u32 v10, 0x8000, v10
v_mfma_f32_16x16x32_bf16 v[128:131], a[32:35], a[96:99], v[128:131]
s_waitcnt lgkmcnt(0)
v_add_u32 v11, 0x8000, v11
v_accvgpr_write_b32 a176, v172
v_mfma_f32_16x16x32_bf16 v[112:115], a[32:35], a[104:107], v[112:115]
v_accvgpr_write_b32 a177, v173
v_accvgpr_write_b32 a178, v174
v_mfma_f32_16x16x32_bf16 v[112:115], a[36:39], a[108:111], v[112:115]
v_accvgpr_write_b32 a179, v175
v_mfma_f32_16x16x32_bf16 v[96:99], a[44:47], a[108:111], v[96:99]
s_add_u32 s65, s79, 23552
s_waitcnt lgkmcnt(0)
s_barrier
v_mfma_f32_16x16x32_bf16 v[96:99], a[40:43], a[104:107], v[96:99]
s_add_u32 m0, s77, 98304
ds_read_b64_tr_b16 a[88:89], v19 offset:36864
v_cvt_pk_bf16_f32 v59, v58, v59
v_mfma_f32_16x16x32_bf16 v[36:39], a[48:51], a[104:107], v[36:39]
s_add_u32 s64, s71, 1048576
ds_read_b64_tr_b16 a[90:91], v19 offset:37120
v_cvt_pk_bf16_f32 v58, v56, v57
v_mfma_f32_16x16x32_bf16 v[36:39], a[52:55], a[108:111], v[36:39]
buffer_load_dwordx4 v14, s[56:59], s64 offen lds
v_mfma_f32_16x16x32_bf16 v[52:55], a[60:63], a[108:111], v[52:55]
ds_read_b64_tr_b16 a[92:93], v19 offset:38912
v_cvt_pk_bf16_f32 v56, v40, v41
v_mfma_f32_16x16x32_bf16 v[52:55], a[56:59], a[104:107], v[52:55]
ds_read_b64_tr_b16 a[94:95], v19 offset:39168
v_cvt_pk_bf16_f32 v57, v42, v43
v_mfma_f32_16x16x32_bf16 v[68:71], a[56:59], a[112:115], v[68:71]
ds_read_b128 a[64:67], v17 offset:32768
v_mfma_f32_16x16x32_bf16 v[68:71], a[60:63], a[116:119], v[68:71]
ds_read_b128 a[68:71], v18 offset:32768
v_mfma_f32_16x16x32_bf16 v[84:87], a[52:55], a[116:119], v[84:87]
ds_read_b64_tr_b16 a[96:97], v21 offset:36864
v_mfma_f32_16x16x32_bf16 v[84:87], a[48:51], a[112:115], v[84:87]
s_add_u32 m0, s78, 114688
ds_read_b64_tr_b16 a[98:99], v21 offset:37120
v_mfma_f32_16x16x32_bf16 v[148:151], a[40:43], a[112:115], v[148:151]
s_add_u32 s64, s75, 786432
ds_read_b64_tr_b16 a[100:101], v21 offset:38912
v_mfma_f32_16x16x32_bf16 v[148:151], a[44:47], a[116:119], v[148:151]
buffer_load_dwordx4 v23, s[60:63], s64 offen lds
v_mfma_f32_16x16x32_bf16 v[132:135], a[36:39], a[116:119], v[132:135]
ds_read_b64_tr_b16 a[102:103], v21 offset:39168
v_mfma_f32_16x16x32_bf16 v[132:135], a[32:35], a[112:115], v[132:135]
ds_read_b64_tr_b16 a[104:105], v20 offset:36864
v_mfma_f32_16x16x32_bf16 v[116:119], a[32:35], a[72:75], v[116:119]
ds_read_b64_tr_b16 a[106:107], v20 offset:37120
v_mfma_f32_16x16x32_bf16 v[116:119], a[36:39], a[76:79], v[116:119]
ds_read_b64_tr_b16 a[108:109], v20 offset:38912
v_mfma_f32_16x16x32_bf16 v[100:103], a[44:47], a[76:79], v[100:103]
ds_read_b64_tr_b16 a[110:111], v20 offset:39168
v_mfma_f32_16x16x32_bf16 v[100:103], a[40:43], a[72:75], v[100:103]
s_add_u32 m0, s77, 99328
ds_read_b64_tr_b16 a[112:113], v19 offset:40960
v_mfma_f32_16x16x32_bf16 a[120:123], a[48:51], a[72:75], a[120:123]
s_add_u32 s64, s71, 1081344
ds_read_b64_tr_b16 a[114:115], v19 offset:41216
v_mfma_f32_16x16x32_bf16 a[120:123], a[52:55], a[76:79], a[120:123]
buffer_load_dwordx4 v14, s[56:59], s64 offen lds
v_mfma_f32_16x16x32_bf16 a[124:127], a[60:63], a[76:79], a[124:127]
ds_read_b64_tr_b16 a[116:117], v19 offset:43008
v_mfma_f32_16x16x32_bf16 a[124:127], a[56:59], a[72:75], a[124:127]
ds_read_b64_tr_b16 a[118:119], v19 offset:43264
v_mfma_f32_16x16x32_bf16 a[128:131], a[56:59], a[80:83], a[128:131]
ds_read_b64_tr_b16 a[72:73], v21 offset:40960
v_mfma_f32_16x16x32_bf16 a[128:131], a[60:63], a[84:87], a[128:131]
ds_read_b64_tr_b16 a[74:75], v21 offset:41216
v_mfma_f32_16x16x32_bf16 a[132:135], a[52:55], a[84:87], a[132:135]
ds_read_b64_tr_b16 a[76:77], v21 offset:43008
v_mfma_f32_16x16x32_bf16 a[132:135], a[48:51], a[80:83], a[132:135]
s_add_u32 m0, s78, 118784
ds_read_b64_tr_b16 a[78:79], v21 offset:43264
v_mfma_f32_16x16x32_bf16 a[136:139], a[40:43], a[80:83], a[136:139]
s_add_u32 s64, s75, 788480
buffer_store_dwordx4 v[56:59], v16, s[44:47], s65 offen sc1
v_mfma_f32_16x16x32_bf16 a[136:139], a[44:47], a[84:87], a[136:139]
buffer_load_dwordx4 v23, s[60:63], s64 offen lds
v_mfma_f32_16x16x32_bf16 a[140:143], a[36:39], a[84:87], a[140:143]
v_cvt_pk_bf16_f32 v75, v74, v75
v_cvt_pk_bf16_f32 v74, v72, v73
v_mfma_f32_16x16x32_bf16 a[140:143], a[32:35], a[80:83], a[140:143]
s_waitcnt lgkmcnt(6)
ds_read_b64_tr_b16 a[80:81], v20 offset:40960
v_cvt_pk_bf16_f32 v72, v24, v25
v_mfma_f32_16x16x32_bf16 v[184:187], a[88:91], a[0:3], 0
ds_read_b64_tr_b16 a[82:83], v20 offset:41216
v_cvt_pk_bf16_f32 v73, v26, v27
v_mfma_f32_16x16x32_bf16 v[184:187], a[92:95], a[4:7], v[184:187]
ds_read_b64_tr_b16 a[84:85], v20 offset:43008
v_accvgpr_write_b32 a180, v72
v_mfma_f32_16x16x32_bf16 v[192:195], a[92:95], a[12:15], 0
s_add_u32 s17, s78, .-L_pc+6144
ds_read_b64_tr_b16 a[86:87], v20 offset:43264
v_accvgpr_write_b32 a181, v73
v_mfma_f32_16x16x32_bf16 v[192:195], a[88:91], a[8:11], v[192:195]
s_add_u32 m0, s77, 100352
v_accvgpr_write_b32 a182, v74
v_accvgpr_write_b32 a183, v75
v_mfma_f32_16x16x32_bf16 v[200:203], a[88:91], a[16:19], 0
s_add_u32 s64, s71, 1114112
buffer_load_dword a252, v16, s[88:91], s17 offen
v_mfma_f32_16x16x32_bf16 v[200:203], a[92:95], a[20:23], v[200:203]
buffer_load_dwordx4 v15, s[56:59], s64 offen lds
v_mfma_f32_16x16x32_bf16 v[208:211], a[92:95], a[28:31], 0
v_cvt_pk_bf16_f32 v139, v138, v139
v_cvt_pk_bf16_f32 v138, v136, v137
v_mfma_f32_16x16x32_bf16 v[208:211], a[88:91], a[24:27], v[208:211]
ds_read_b64_tr_b16 a[88:89], v19 offset:32768
v_cvt_pk_bf16_f32 v136, v156, v157
v_mfma_f32_16x16x32_bf16 v[248:251], a[96:99], a[64:67], 0
ds_read_b64_tr_b16 a[90:91], v19 offset:33024
v_cvt_pk_bf16_f32 v137, v158, v159
v_mfma_f32_16x16x32_bf16 v[248:251], a[100:103], a[68:71], v[248:251]
ds_read_b64_tr_b16 a[92:93], v19 offset:34816
v_accvgpr_write_b32 a184, v136
v_mfma_f32_16x16x32_bf16 v[212:215], a[108:111], a[28:31], 0
ds_read_b64_tr_b16 a[94:95], v19 offset:35072
v_accvgpr_write_b32 a185, v137
v_mfma_f32_16x16x32_bf16 v[212:215], a[104:107], a[24:27], v[212:215]
s_add_u32 m0, s78, 122880
ds_read_b64_tr_b16 a[96:97], v20 offset:32768
v_accvgpr_write_b32 a186, v138
v_mfma_f32_16x16x32_bf16 v[204:207], a[104:107], a[16:19], 0
s_add_u32 s64, s75, 790528
ds_read_b64_tr_b16 a[98:99], v20 offset:33024
v_accvgpr_write_b32 a187, v139
v_mfma_f32_16x16x32_bf16 v[204:207], a[108:111], a[20:23], v[204:207]
buffer_load_dwordx4 v23, s[60:63], s64 offen lds
v_mfma_f32_16x16x32_bf16 v[196:199], a[108:111], a[12:15], 0
ds_read_b64_tr_b16 a[100:101], v20 offset:34816
v_cvt_pk_bf16_f32 v123, v122, v123
v_mfma_f32_16x16x32_bf16 v[196:199], a[104:107], a[8:11], v[196:199]
ds_read_b64_tr_b16 a[102:103], v20 offset:35072
v_cvt_pk_bf16_f32 v122, v120, v121
v_mfma_f32_16x16x32_bf16 v[188:191], a[104:107], a[0:3], 0
v_cvt_pk_bf16_f32 v120, v164, v165
v_cvt_pk_bf16_f32 v121, v166, v167
v_mfma_f32_16x16x32_bf16 v[188:191], a[108:111], a[4:7], v[188:191]
s_waitcnt lgkmcnt(7)
ds_read_b64_tr_b16 a[104:105], v4 offset:32768
v_accvgpr_write_b32 a188, v120
v_mfma_f32_16x16x32_bf16 v[216:219], a[4:7], a[116:119], 0
ds_read_b64_tr_b16 a[106:107], v4 offset:33792
v_accvgpr_write_b32 a189, v121
v_mfma_f32_16x16x32_bf16 v[216:219], a[0:3], a[112:115], v[216:219]
s_add_u32 m0, s77, 101376
ds_read_b64_tr_b16 a[108:109], v4 offset:40960
v_accvgpr_write_b32 a190, v122
v_mfma_f32_16x16x32_bf16 v[224:227], a[8:11], a[112:115], 0
s_add_u32 s64, s71, 1146880
ds_read_b64_tr_b16 a[110:111], v4 offset:41984
v_accvgpr_write_b32 a191, v123
v_mfma_f32_16x16x32_bf16 v[224:227], a[12:15], a[116:119], v[224:227]
s_add_u32 s65, s79, 8192
buffer_load_dwordx4 v15, s[56:59], s64 offen lds
v_mfma_f32_16x16x32_bf16 v[232:235], a[20:23], a[116:119], 0
v_cvt_pk_bf16_f32 v91, v90, v91
v_cvt_pk_bf16_f32 v90, v88, v89
v_mfma_f32_16x16x32_bf16 v[232:235], a[16:19], a[112:115], v[232:235]
v_cvt_pk_bf16_f32 v88, v104, v105
v_cvt_pk_bf16_f32 v89, v106, v107
v_mfma_f32_16x16x32_bf16 v[240:243], a[24:27], a[112:115], 0
buffer_store_dwordx4 v[88:91], v16, s[44:47], s65 offen sc1
v_mfma_f32_16x16x32_bf16 v[240:243], a[28:31], a[116:119], v[240:243]
ds_read_b64_tr_b16 a[112:113], v5 offset:32768
v_cvt_pk_bf16_f32 v47, v46, v47
v_mfma_f32_16x16x32_bf16 v[252:255], a[68:71], a[76:79], 0
ds_read_b64_tr_b16 a[114:115], v5 offset:33792
v_cvt_pk_bf16_f32 v46, v44, v45
v_mfma_f32_16x16x32_bf16 v[252:255], a[64:67], a[72:75], v[252:255]
s_add_u32 m0, s78, 126976
ds_read_b64_tr_b16 a[116:117], v5 offset:40960
v_cvt_pk_bf16_f32 v44, v28, v29
v_mfma_f32_16x16x32_bf16 v[244:247], a[24:27], a[80:83], 0
s_add_u32 s64, s74, 256
ds_read_b64_tr_b16 a[118:119], v5 offset:41984
v_cvt_pk_bf16_f32 v45, v30, v31
v_mfma_f32_16x16x32_bf16 v[244:247], a[28:31], a[84:87], v[244:247]
buffer_load_dwordx4 v22, s[48:51], s64 offen lds
v_mfma_f32_16x16x32_bf16 v[236:239], a[20:23], a[84:87], 0
ds_read_b64_tr_b16 a[72:73], v6 offset:32768
v_accvgpr_write_b32 a192, v44
v_mfma_f32_16x16x32_bf16 v[236:239], a[16:19], a[80:83], v[236:239]
ds_read_b64_tr_b16 a[74:75], v6 offset:33792
v_accvgpr_write_b32 a193, v45
v_mfma_f32_16x16x32_bf16 v[228:231], a[8:11], a[80:83], 0
ds_read_b64_tr_b16 a[76:77], v6 offset:40960
v_accvgpr_write_b32 a194, v46
v_mfma_f32_16x16x32_bf16 v[228:231], a[12:15], a[84:87], v[228:231]
ds_read_b64_tr_b16 a[78:79], v6 offset:41984
v_accvgpr_write_b32 a195, v47
v_mfma_f32_16x16x32_bf16 v[220:223], a[4:7], a[84:87], 0
v_cvt_pk_bf16_f32 v76, v76, v77
v_cvt_pk_bf16_f32 v77, v78, v79
v_mfma_f32_16x16x32_bf16 v[220:223], a[0:3], a[80:83], v[220:223]
s_waitcnt lgkmcnt(7)
ds_read_b64_tr_b16 a[80:81], v7 offset:32768
v_cvt_pk_bf16_f32 v78, v60, v61
v_mfma_f32_16x16x32_bf16 v[152:155], a[88:91], a[0:3], 0
ds_read_b64_tr_b16 a[82:83], v7 offset:33792
v_cvt_pk_bf16_f32 v79, v62, v63
v_mfma_f32_16x16x32_bf16 v[152:155], a[92:95], a[4:7], v[152:155]
ds_read_b64_tr_b16 a[84:85], v7 offset:40960
v_accvgpr_write_b32 a196, v76
v_mfma_f32_16x16x32_bf16 v[160:163], a[92:95], a[12:15], 0
s_add_u32 m0, s76, 0
ds_read_b64_tr_b16 a[86:87], v7 offset:41984
v_accvgpr_write_b32 a197, v77
v_mfma_f32_16x16x32_bf16 v[160:163], a[88:91], a[8:11], v[160:163]
s_add_u32 s64, s72, 256
v_accvgpr_write_b32 a198, v78
v_accvgpr_write_b32 a199, v79
v_mfma_f32_16x16x32_bf16 v[168:171], a[88:91], a[16:19], 0
buffer_load_dwordx4 v12, s[48:51], s64 offen lds
v_mfma_f32_16x16x32_bf16 v[168:171], a[92:95], a[20:23], v[168:171]
v_cvt_pk_bf16_f32 v124, v124, v125
v_cvt_pk_bf16_f32 v125, v126, v127
v_mfma_f32_16x16x32_bf16 v[176:179], a[92:95], a[28:31], 0
v_cvt_pk_bf16_f32 v126, v140, v141
v_cvt_pk_bf16_f32 v127, v142, v143
v_mfma_f32_16x16x32_bf16 v[176:179], a[88:91], a[24:27], v[176:179]
s_add_u32 m0, s76, 1024
ds_read_b64_tr_b16 a[88:89], v8 offset:32768
v_accvgpr_write_b32 a200, v124
v_mfma_f32_16x16x32_bf16 v[180:183], a[96:99], a[24:27], 0
s_add_u32 s64, s72, 16640
ds_read_b64_tr_b16 a[90:91], v8 offset:33792
v_accvgpr_write_b32 a201, v125
v_mfma_f32_16x16x32_bf16 v[180:183], a[100:103], a[28:31], v[180:183]
buffer_load_dwordx4 v13, s[48:51], s64 offen lds
v_mfma_f32_16x16x32_bf16 v[172:175], a[100:103], a[20:23], 0
ds_read_b64_tr_b16 a[92:93], v8 offset:40960
v_accvgpr_write_b32 a202, v126
v_mfma_f32_16x16x32_bf16 v[172:175], a[96:99], a[16:19], v[172:175]
ds_read_b64_tr_b16 a[94:95], v8 offset:41984
v_accvgpr_write_b32 a203, v127
v_mfma_f32_16x16x32_bf16 v[164:167], a[96:99], a[8:11], 0
s_add_u32 s65, s79, 10240
v_cvt_pk_bf16_f32 v95, v94, v95
v_cvt_pk_bf16_f32 v94, v92, v93
v_mfma_f32_16x16x32_bf16 v[164:167], a[100:103], a[12:15], v[164:167]
s_add_u32 m0, s76, 2048
v_cvt_pk_bf16_f32 v92, v108, v109
v_cvt_pk_bf16_f32 v93, v110, v111
v_mfma_f32_16x16x32_bf16 v[156:159], a[100:103], a[4:7], 0
s_add_u32 s64, s72, 131328
buffer_store_dwordx4 v[92:95], v16, s[44:47], s65 offen sc1
v_mfma_f32_16x16x32_bf16 v[156:159], a[96:99], a[0:3], v[156:159]
buffer_load_dwordx4 v12, s[48:51], s64 offen lds
v_mfma_f32_16x16x32_bf16 v[24:27], a[104:107], a[0:3], 0
ds_read_b64_tr_b16 a[96:97], v9 offset:32768
v_cvt_pk_bf16_f32 v51, v50, v51
v_mfma_f32_16x16x32_bf16 v[24:27], a[108:111], a[4:7], v[24:27]
s_add_u32 m0, s76, 3072
ds_read_b64_tr_b16 a[98:99], v9 offset:33792
v_cvt_pk_bf16_f32 v50, v48, v49
v_mfma_f32_16x16x32_bf16 v[40:43], a[108:111], a[12:15], 0
s_waitcnt vmcnt(15)
ds_read_b64_tr_b16 a[100:101], v9 offset:40960
v_cvt_pk_bf16_f32 v48, v32, v33
v_mfma_f32_16x16x32_bf16 v[40:43], a[104:107], a[8:11], v[40:43]
s_add_u32 s64, s72, 147712
ds_read_b64_tr_b16 a[102:103], v9 offset:41984
v_cvt_pk_bf16_f32 v49, v34, v35
v_mfma_f32_16x16x32_bf16 v[56:59], a[104:107], a[16:19], 0
buffer_load_dwordx4 v13, s[48:51], s64 offen lds
v_mfma_f32_16x16x32_bf16 v[56:59], a[108:111], a[20:23], v[56:59]
ds_read_b128 a[32:35], v2 offset:32768
v_accvgpr_write_b32 a204, v48
v_mfma_f32_16x16x32_bf16 v[72:75], a[108:111], a[28:31], 0
ds_read_b128 a[36:39], v3 offset:32768
v_accvgpr_write_b32 a205, v49
v_mfma_f32_16x16x32_bf16 v[72:75], a[104:107], a[24:27], v[72:75]
s_waitcnt lgkmcnt(6)
ds_read_b128 a[40:43], v2 offset:34816
v_accvgpr_write_b32 a206, v50
v_mfma_f32_16x16x32_bf16 v[136:139], a[112:115], a[24:27], 0
s_add_u32 m0, s76, 4096
ds_read_b128 a[44:47], v3 offset:34816
v_accvgpr_write_b32 a207, v51
v_mfma_f32_16x16x32_bf16 v[136:139], a[116:119], a[28:31], v[136:139]
s_add_u32 s64, s73, 256
ds_read_b128 a[48:51], v2 offset:36864
v_subrev_u32 v17, 0x8000, v17
v_mfma_f32_16x16x32_bf16 v[120:123], a[116:119], a[20:23], 0
buffer_load_dwordx4 v12, s[48:51], s64 offen lds
v_mfma_f32_16x16x32_bf16 v[120:123], a[112:115], a[16:19], v[120:123]
ds_read_b128 a[52:55], v3 offset:36864
v_subrev_u32 v18, 0x8000, v18
v_mfma_f32_16x16x32_bf16 v[104:107], a[112:115], a[8:11], 0
ds_read_b128 a[56:59], v2 offset:38912
v_subrev_u32 v21, 0x8000, v21
v_mfma_f32_16x16x32_bf16 v[104:107], a[116:119], a[12:15], v[104:107]
s_add_u32 m0, s76, 5120
ds_read_b128 a[60:63], v3 offset:38912
v_subrev_u32 v19, 0x8000, v19
v_mfma_f32_16x16x32_bf16 v[88:91], a[116:119], a[4:7], 0
s_add_u32 s64, s73, 16640
ds_read_b64_tr_b16 a[104:105], v10 offset:32768
v_subrev_u32 v20, 0x8000, v20
v_mfma_f32_16x16x32_bf16 v[88:91], a[112:115], a[0:3], v[88:91]
buffer_load_dwordx4 v13, s[48:51], s64 offen lds
v_mfma_f32_16x16x32_bf16 v[28:31], a[72:75], a[0:3], 0
ds_read_b64_tr_b16 a[106:107], v10 offset:33792
v_subrev_u32 v4, 0x8000, v4
v_mfma_f32_16x16x32_bf16 v[28:31], a[76:79], a[4:7], v[28:31]
ds_read_b64_tr_b16 a[108:109], v10 offset:40960
v_subrev_u32 v5, 0x8000, v5
v_mfma_f32_16x16x32_bf16 v[44:47], a[76:79], a[12:15], 0
ds_read_b64_tr_b16 a[110:111], v10 offset:41984
v_subrev_u32 v6, 0x8000, v6
v_mfma_f32_16x16x32_bf16 v[44:47], a[72:75], a[8:11], v[44:47]
s_add_u32 m0, s76, 6144
ds_read_b64_tr_b16 a[112:113], v11 offset:32768
v_subrev_u32 v7, 0x8000, v7
v_mfma_f32_16x16x32_bf16 v[60:63], a[72:75], a[16:19], 0
s_add_u32 s64, s73, 131328
ds_read_b64_tr_b16 a[114:115], v11 offset:33792
v_cvt_pk_bf16_f32 v80, v80, v81
v_mfma_f32_16x16x32_bf16 v[60:63], a[76:79], a[20:23], v[60:63]
buffer_load_dwordx4 v12, s[48:51], s64 offen lds
v_mfma_f32_16x16x32_bf16 v[76:79], a[76:79], a[28:31], 0
ds_read_b64_tr_b16 a[116:117], v11 offset:40960
v_cvt_pk_bf16_f32 v81, v82, v83
v_mfma_f32_16x16x32_bf16 v[76:79], a[72:75], a[24:27], v[76:79]
ds_read_b64_tr_b16 a[118:119], v11 offset:41984
v_cvt_pk_bf16_f32 v82, v64, v65
v_mfma_f32_16x16x32_bf16 v[140:143], a[80:83], a[24:27], 0
s_add_u32 m0, s76, 7168
v_cvt_pk_bf16_f32 v83, v66, v67
v_accvgpr_write_b32 a208, v80
v_mfma_f32_16x16x32_bf16 v[140:143], a[84:87], a[28:31], v[140:143]
s_add_u32 s64, s73, 147712
v_subrev_u32 v8, 0x8000, v8
v_accvgpr_write_b32 a209, v81
v_mfma_f32_16x16x32_bf16 v[124:127], a[84:87], a[20:23], 0
buffer_load_dwordx4 v13, s[48:51], s64 offen lds
v_mfma_f32_16x16x32_bf16 v[124:127], a[80:83], a[16:19], v[124:127]
v_accvgpr_write_b32 a210, v82
v_accvgpr_write_b32 a211, v83
v_mfma_f32_16x16x32_bf16 v[108:111], a[80:83], a[8:11], 0
v_cvt_pk_bf16_f32 v128, v128, v129
v_cvt_pk_bf16_f32 v129, v130, v131
v_mfma_f32_16x16x32_bf16 v[108:111], a[84:87], a[12:15], v[108:111]
v_cvt_pk_bf16_f32 v130, v144, v145
v_cvt_pk_bf16_f32 v131, v146, v147
v_mfma_f32_16x16x32_bf16 v[92:95], a[84:87], a[4:7], 0
v_subrev_u32 v9, 0x8000, v9
v_subrev_u32 v10, 0x8000, v10
v_mfma_f32_16x16x32_bf16 v[92:95], a[80:83], a[0:3], v[92:95]
v_subrev_u32 v11, 0x8000, v11
v_accvgpr_write_b32 a212, v128
v_mfma_f32_16x16x32_bf16 v[32:35], a[88:91], a[0:3], 0
v_accvgpr_write_b32 a213, v129
v_accvgpr_write_b32 a214, v130
v_mfma_f32_16x16x32_bf16 v[32:35], a[92:95], a[4:7], v[32:35]
v_accvgpr_write_b32 a215, v131
v_mfma_f32_16x16x32_bf16 v[48:51], a[92:95], a[12:15], 0
s_add_u32 s65, s79, 12288
s_waitcnt lgkmcnt(0)
s_barrier
v_mfma_f32_16x16x32_bf16 v[48:51], a[88:91], a[8:11], v[48:51]
ds_read_b64_tr_b16 a[72:73], v19 offset:4096
v_cvt_pk_bf16_f32 v99, v98, v99
v_mfma_f32_16x16x32_bf16 v[64:67], a[88:91], a[16:19], 0
ds_read_b64_tr_b16 a[74:75], v19 offset:4352
v_cvt_pk_bf16_f32 v98, v96, v97
v_mfma_f32_16x16x32_bf16 v[64:67], a[92:95], a[20:23], v[64:67]
s_add_u32 m0, s77, 131072
ds_read_b64_tr_b16 a[76:77], v19 offset:6144
v_cvt_pk_bf16_f32 v96, v112, v113
v_mfma_f32_16x16x32_bf16 v[80:83], a[92:95], a[28:31], 0
s_add_u32 s64, s71, 1572864
ds_read_b64_tr_b16 a[78:79], v19 offset:6400
v_cvt_pk_bf16_f32 v97, v114, v115
v_mfma_f32_16x16x32_bf16 v[80:83], a[88:91], a[24:27], v[80:83]
buffer_load_dwordx4 v14, s[56:59], s64 offen lds
v_mfma_f32_16x16x32_bf16 v[144:147], a[96:99], a[24:27], 0
buffer_store_dwordx4 v[96:99], v16, s[44:47], s65 offen sc1
v_mfma_f32_16x16x32_bf16 v[144:147], a[100:103], a[28:31], v[144:147]
ds_read_b128 a[64:67], v17 offset:0
v_cvt_pk_bf16_f32 v55, v54, v55
v_mfma_f32_16x16x32_bf16 v[128:131], a[100:103], a[20:23], 0
ds_read_b128 a[68:71], v18 offset:0
v_cvt_pk_bf16_f32 v54, v52, v53
v_mfma_f32_16x16x32_bf16 v[128:131], a[96:99], a[16:19], v[128:131]
ds_read_b64_tr_b16 a[80:81], v21 offset:4096
v_cvt_pk_bf16_f32 v52, v36, v37
v_mfma_f32_16x16x32_bf16 v[112:115], a[96:99], a[8:11], 0
ds_read_b64_tr_b16 a[82:83], v21 offset:4352
v_cvt_pk_bf16_f32 v53, v38, v39
v_mfma_f32_16x16x32_bf16 v[112:115], a[100:103], a[12:15], v[112:115]
s_add_u32 m0, s78, 147456
ds_read_b64_tr_b16 a[84:85], v21 offset:6144
v_accvgpr_write_b32 a216, v52
v_mfma_f32_16x16x32_bf16 v[96:99], a[100:103], a[4:7], 0
s_add_u32 s64, s75, 1179648
ds_read_b64_tr_b16 a[86:87], v21 offset:6400
v_accvgpr_write_b32 a217, v53
v_mfma_f32_16x16x32_bf16 v[96:99], a[96:99], a[0:3], v[96:99]
ds_read_b64_tr_b16 a[88:89], v20 offset:4096
v_accvgpr_write_b32 a218, v54
v_accvgpr_write_b32 a219, v55
v_mfma_f32_16x16x32_bf16 v[36:39], a[104:107], a[0:3], 0
buffer_load_dwordx4 v23, s[60:63], s64 offen lds
v_mfma_f32_16x16x32_bf16 v[36:39], a[108:111], a[4:7], v[36:39]
s_add_u32 m0, s77, 132096
ds_read_b64_tr_b16 a[90:91], v20 offset:4352
v_cvt_pk_bf16_f32 v84, v84, v85
v_mfma_f32_16x16x32_bf16 v[52:55], a[108:111], a[12:15], 0
s_add_u32 s64, s71, 1605632
ds_read_b64_tr_b16 a[92:93], v20 offset:6144
v_cvt_pk_bf16_f32 v85, v86, v87
v_mfma_f32_16x16x32_bf16 v[52:55], a[104:107], a[8:11], v[52:55]
ds_read_b64_tr_b16 a[94:95], v20 offset:6400
v_cvt_pk_bf16_f32 v86, v68, v69
v_cvt_pk_bf16_f32 v87, v70, v71
v_accvgpr_write_b32 a220, v84
v_accvgpr_write_b32 a221, v85
v_accvgpr_write_b32 a222, v86
v_accvgpr_write_b32 a223, v87
v_cvt_pk_bf16_f32 v132, v132, v133
v_cvt_pk_bf16_f32 v133, v134, v135
v_cvt_pk_bf16_f32 v134, v148, v149
v_cvt_pk_bf16_f32 v135, v150, v151
v_accvgpr_write_b32 a224, v132
v_accvgpr_write_b32 a225, v133
v_accvgpr_write_b32 a226, v134
v_accvgpr_write_b32 a227, v135
s_add_u32 s65, s79, 14336
v_cvt_pk_bf16_f32 v103, v102, v103
v_cvt_pk_bf16_f32 v102, v100, v101
v_cvt_pk_bf16_f32 v100, v116, v117
v_cvt_pk_bf16_f32 v101, v118, v119
v_mfma_f32_16x16x32_bf16 v[68:71], a[104:107], a[16:19], 0
buffer_store_dwordx4 v[100:103], v16, s[44:47], s65 offen sc1
v_accvgpr_read_b32 v148, a120
v_accvgpr_read_b32 v149, a121
v_accvgpr_read_b32 v150, a122
v_accvgpr_read_b32 v151, a123
v_accvgpr_read_b32 v116, a124
v_accvgpr_read_b32 v117, a125
v_accvgpr_read_b32 v118, a126
v_accvgpr_read_b32 v119, a127
v_cvt_pk_bf16_f32 v119, v118, v119
v_cvt_pk_bf16_f32 v118, v116, v117
v_cvt_pk_bf16_f32 v116, v148, v149
v_cvt_pk_bf16_f32 v117, v150, v151
v_accvgpr_write_b32 a228, v116
v_accvgpr_write_b32 a229, v117
v_accvgpr_write_b32 a230, v118
v_accvgpr_write_b32 a231, v119
v_accvgpr_read_b32 v148, a132
v_accvgpr_read_b32 v149, a133
v_accvgpr_read_b32 v150, a134
v_accvgpr_read_b32 v151, a135
v_accvgpr_read_b32 v116, a128
v_accvgpr_read_b32 v117, a129
v_accvgpr_read_b32 v118, a130
v_accvgpr_read_b32 v119, a131
v_cvt_pk_bf16_f32 v119, v118, v119
v_cvt_pk_bf16_f32 v118, v116, v117
v_cvt_pk_bf16_f32 v116, v148, v149
v_cvt_pk_bf16_f32 v117, v150, v151
v_accvgpr_write_b32 a232, v116
v_accvgpr_write_b32 a233, v117
v_accvgpr_write_b32 a234, v118
v_accvgpr_write_b32 a235, v119
v_accvgpr_read_b32 v148, a140
v_accvgpr_read_b32 v149, a141
v_accvgpr_read_b32 v150, a142
v_accvgpr_read_b32 v151, a143
v_accvgpr_read_b32 v116, a136
v_accvgpr_read_b32 v117, a137
v_accvgpr_read_b32 v118, a138
v_accvgpr_read_b32 v119, a139
v_cvt_pk_bf16_f32 v119, v118, v119
v_cvt_pk_bf16_f32 v118, v116, v117
v_cvt_pk_bf16_f32 v116, v148, v149
v_cvt_pk_bf16_f32 v117, v150, v151
v_accvgpr_write_b32 a236, v116
v_accvgpr_write_b32 a237, v117
v_accvgpr_write_b32 a238, v118
v_accvgpr_write_b32 a239, v119
v_mfma_f32_16x16x32_bf16 v[68:71], a[108:111], a[20:23], v[68:71]
s_xor_b32 s68, s66, 0
buffer_load_dwordx4 v14, s[56:59], s64 offen lds
v_mfma_f32_16x16x32_bf16 v[84:87], a[108:111], a[28:31], 0
s_mov_b64 exec, 1
buffer_atomic_add a251, v1, s[52:55], s68 offen offset:0 sc1
s_mov_b64 exec, -1
v_mfma_f32_16x16x32_bf16 v[84:87], a[104:107], a[24:27], v[84:87]
ds_read_b64_tr_b16 a[96:97], v19 offset:8192
v_mfma_f32_16x16x32_bf16 v[148:151], a[112:115], a[24:27], 0
ds_read_b64_tr_b16 a[98:99], v19 offset:8448
v_mfma_f32_16x16x32_bf16 v[148:151], a[116:119], a[28:31], v[148:151]
ds_read_b64_tr_b16 a[100:101], v19 offset:10240
v_mfma_f32_16x16x32_bf16 v[132:135], a[116:119], a[20:23], 0
ds_read_b64_tr_b16 a[102:103], v19 offset:10496
v_mfma_f32_16x16x32_bf16 v[132:135], a[112:115], a[16:19], v[132:135]
s_add_u32 m0, s78, 151552
s_add_u32 s65, s79, 16384
ds_read_b64_tr_b16 a[104:105], v21 offset:8192
v_mfma_f32_16x16x32_bf16 v[116:119], a[112:115], a[8:11], 0
s_add_u32 s64, s75, 1181696
buffer_store_dwordx4 a[144:147], v16, s[44:47], s65 offen sc1
v_mfma_f32_16x16x32_bf16 v[116:119], a[116:119], a[12:15], v[116:119]
buffer_load_dwordx4 v23, s[60:63], s64 offen lds
v_mfma_f32_16x16x32_bf16 v[100:103], a[116:119], a[4:7], 0
ds_read_b64_tr_b16 a[106:107], v21 offset:8448
v_mfma_f32_16x16x32_bf16 v[100:103], a[112:115], a[0:3], v[100:103]
s_waitcnt lgkmcnt(6)
ds_read_b64_tr_b16 a[108:109], v21 offset:10240
v_mfma_f32_16x16x32_bf16 v[184:187], a[72:75], a[32:35], v[184:187]
ds_read_b64_tr_b16 a[110:111], v21 offset:10496
v_mfma_f32_16x16x32_bf16 v[184:187], a[76:79], a[36:39], v[184:187]
ds_read_b64_tr_b16 a[112:113], v20 offset:8192
v_mfma_f32_16x16x32_bf16 v[192:195], a[76:79], a[44:47], v[192:195]
ds_read_b64_tr_b16 a[114:115], v20 offset:8448
v_mfma_f32_16x16x32_bf16 v[192:195], a[72:75], a[40:43], v[192:195]
s_add_u32 m0, s77, 133120
ds_read_b64_tr_b16 a[116:117], v20 offset:10240
v_mfma_f32_16x16x32_bf16 v[200:203], a[72:75], a[48:51], v[200:203]
s_add_u32 s64, s71, 1638400
ds_read_b64_tr_b16 a[118:119], v20 offset:10496
v_mfma_f32_16x16x32_bf16 v[200:203], a[76:79], a[52:55], v[200:203]
buffer_load_dwordx4 v15, s[56:59], s64 offen lds
v_mfma_f32_16x16x32_bf16 v[208:211], a[76:79], a[60:63], v[208:211]
v_mfma_f32_16x16x32_bf16 v[208:211], a[72:75], a[56:59], v[208:211]
ds_read_b64_tr_b16 a[72:73], v19 offset:0
v_mfma_f32_16x16x32_bf16 v[248:251], a[80:83], a[64:67], v[248:251]
ds_read_b64_tr_b16 a[74:75], v19 offset:256
v_mfma_f32_16x16x32_bf16 v[248:251], a[84:87], a[68:71], v[248:251]
ds_read_b64_tr_b16 a[76:77], v19 offset:2048
v_mfma_f32_16x16x32_bf16 v[212:215], a[92:95], a[60:63], v[212:215]
ds_read_b64_tr_b16 a[78:79], v19 offset:2304
v_mfma_f32_16x16x32_bf16 v[212:215], a[88:91], a[56:59], v[212:215]
s_add_u32 m0, s78, 155648
ds_read_b64_tr_b16 a[80:81], v20 offset:0
v_mfma_f32_16x16x32_bf16 v[204:207], a[88:91], a[48:51], v[204:207]
s_add_u32 s64, s75, 1183744
ds_read_b64_tr_b16 a[82:83], v20 offset:256
v_mfma_f32_16x16x32_bf16 v[204:207], a[92:95], a[52:55], v[204:207]
buffer_load_dwordx4 v23, s[60:63], s64 offen lds
v_mfma_f32_16x16x32_bf16 v[196:199], a[92:95], a[44:47], v[196:199]
ds_read_b64_tr_b16 a[84:85], v20 offset:2048
v_mfma_f32_16x16x32_bf16 v[196:199], a[88:91], a[40:43], v[196:199]
ds_read_b64_tr_b16 a[86:87], v20 offset:2304
v_mfma_f32_16x16x32_bf16 v[188:191], a[88:91], a[32:35], v[188:191]
v_mfma_f32_16x16x32_bf16 v[188:191], a[92:95], a[36:39], v[188:191]
s_waitcnt lgkmcnt(7)
ds_read_b64_tr_b16 a[88:89], v4 offset:0
v_mfma_f32_16x16x32_bf16 v[216:219], a[36:39], a[100:103], v[216:219]
ds_read_b64_tr_b16 a[90:91], v4 offset:1024
v_mfma_f32_16x16x32_bf16 v[216:219], a[32:35], a[96:99], v[216:219]
s_add_u32 m0, s77, 134144
ds_read_b64_tr_b16 a[92:93], v4 offset:8192
v_mfma_f32_16x16x32_bf16 v[224:227], a[40:43], a[96:99], v[224:227]
s_add_u32 s64, s71, 1671168
ds_read_b64_tr_b16 a[94:95], v4 offset:9216
v_mfma_f32_16x16x32_bf16 v[224:227], a[44:47], a[100:103], v[224:227]
buffer_load_dwordx4 v15, s[56:59], s64 offen lds
v_mfma_f32_16x16x32_bf16 v[232:235], a[52:55], a[100:103], v[232:235]
v_mfma_f32_16x16x32_bf16 v[232:235], a[48:51], a[96:99], v[232:235]
v_mfma_f32_16x16x32_bf16 v[240:243], a[56:59], a[96:99], v[240:243]
v_mfma_f32_16x16x32_bf16 v[240:243], a[60:63], a[100:103], v[240:243]
ds_read_b64_tr_b16 a[96:97], v5 offset:0
v_mfma_f32_16x16x32_bf16 v[252:255], a[68:71], a[108:111], v[252:255]
ds_read_b64_tr_b16 a[98:99], v5 offset:1024
v_mfma_f32_16x16x32_bf16 v[252:255], a[64:67], a[104:107], v[252:255]
s_add_u32 m0, s78, 159744
ds_read_b64_tr_b16 a[100:101], v5 offset:8192
v_mfma_f32_16x16x32_bf16 v[244:247], a[56:59], a[112:115], v[244:247]
s_add_u32 s64, s74, 384
ds_read_b64_tr_b16 a[102:103], v5 offset:9216
v_mfma_f32_16x16x32_bf16 v[244:247], a[60:63], a[116:119], v[244:247]
buffer_load_dwordx4 v22, s[48:51], s64 offen lds
v_mfma_f32_16x16x32_bf16 v[236:239], a[52:55], a[116:119], v[236:239]
ds_read_b64_tr_b16 a[104:105], v6 offset:0
v_mfma_f32_16x16x32_bf16 v[236:239], a[48:51], a[112:115], v[236:239]
ds_read_b64_tr_b16 a[106:107], v6 offset:1024
v_mfma_f32_16x16x32_bf16 v[228:231], a[40:43], a[112:115], v[228:231]
ds_read_b64_tr_b16 a[108:109], v6 offset:8192
v_mfma_f32_16x16x32_bf16 v[228:231], a[44:47], a[116:119], v[228:231]
s_add_u32 s65, s79, 4096
ds_read_b64_tr_b16 a[110:111], v6 offset:9216
v_mfma_f32_16x16x32_bf16 v[220:223], a[36:39], a[116:119], v[220:223]
buffer_store_dwordx4 a[148:151], v16, s[44:47], s65 offen sc1
v_mfma_f32_16x16x32_bf16 v[220:223], a[32:35], a[112:115], v[220:223]
s_waitcnt lgkmcnt(7)
ds_read_b64_tr_b16 a[112:113], v7 offset:0
v_mfma_f32_16x16x32_bf16 v[152:155], a[72:75], a[32:35], v[152:155]
ds_read_b64_tr_b16 a[114:115], v7 offset:1024
v_mfma_f32_16x16x32_bf16 v[152:155], a[76:79], a[36:39], v[152:155]
ds_read_b64_tr_b16 a[116:117], v7 offset:8192
v_mfma_f32_16x16x32_bf16 v[160:163], a[76:79], a[44:47], v[160:163]
s_add_u32 m0, s76, 32768
ds_read_b64_tr_b16 a[118:119], v7 offset:9216
v_mfma_f32_16x16x32_bf16 v[160:163], a[72:75], a[40:43], v[160:163]
s_add_u32 s64, s72, 384
v_mfma_f32_16x16x32_bf16 v[168:171], a[72:75], a[48:51], v[168:171]
buffer_load_dwordx4 v12, s[48:51], s64 offen lds
v_mfma_f32_16x16x32_bf16 v[168:171], a[76:79], a[52:55], v[168:171]
v_mfma_f32_16x16x32_bf16 v[176:179], a[76:79], a[60:63], v[176:179]
v_mfma_f32_16x16x32_bf16 v[176:179], a[72:75], a[56:59], v[176:179]
s_add_u32 m0, s76, 33792
ds_read_b64_tr_b16 a[72:73], v8 offset:0
v_mfma_f32_16x16x32_bf16 v[180:183], a[80:83], a[56:59], v[180:183]
s_add_u32 s64, s72, 16768
ds_read_b64_tr_b16 a[74:75], v8 offset:1024
v_mfma_f32_16x16x32_bf16 v[180:183], a[84:87], a[60:63], v[180:183]
buffer_load_dwordx4 v13, s[48:51], s64 offen lds
v_mfma_f32_16x16x32_bf16 v[172:175], a[84:87], a[52:55], v[172:175]
ds_read_b64_tr_b16 a[76:77], v8 offset:8192
v_mfma_f32_16x16x32_bf16 v[172:175], a[80:83], a[48:51], v[172:175]
ds_read_b64_tr_b16 a[78:79], v8 offset:9216
v_mfma_f32_16x16x32_bf16 v[164:167], a[80:83], a[40:43], v[164:167]
v_mfma_f32_16x16x32_bf16 v[164:167], a[84:87], a[44:47], v[164:167]
s_add_u32 m0, s76, 34816
v_mfma_f32_16x16x32_bf16 v[156:159], a[84:87], a[36:39], v[156:159]
s_add_u32 s64, s72, 131456
v_mfma_f32_16x16x32_bf16 v[156:159], a[80:83], a[32:35], v[156:159]
buffer_load_dwordx4 v12, s[48:51], s64 offen lds
v_mfma_f32_16x16x32_bf16 v[24:27], a[88:91], a[32:35], v[24:27]
ds_read_b64_tr_b16 a[80:81], v9 offset:0
v_mfma_f32_16x16x32_bf16 v[24:27], a[92:95], a[36:39], v[24:27]
ds_read_b64_tr_b16 a[82:83], v9 offset:1024
v_mfma_f32_16x16x32_bf16 v[40:43], a[92:95], a[44:47], v[40:43]
s_waitcnt vmcnt(16)
s_add_u32 m0, s76, 35840
ds_read_b64_tr_b16 a[84:85], v9 offset:8192
v_mfma_f32_16x16x32_bf16 v[40:43], a[88:91], a[40:43], v[40:43]
s_add_u32 s64, s72, 147840
ds_read_b64_tr_b16 a[86:87], v9 offset:9216
v_mfma_f32_16x16x32_bf16 v[56:59], a[88:91], a[48:51], v[56:59]
buffer_load_dwordx4 v13, s[48:51], s64 offen lds
v_mfma_f32_16x16x32_bf16 v[56:59], a[92:95], a[52:55], v[56:59]
ds_read_b128 a[0:3], v2 offset:0
v_mfma_f32_16x16x32_bf16 v[72:75], a[92:95], a[60:63], v[72:75]
ds_read_b128 a[4:7], v3 offset:0
v_mfma_f32_16x16x32_bf16 v[72:75], a[88:91], a[56:59], v[72:75]
s_waitcnt lgkmcnt(6)
ds_read_b128 a[8:11], v2 offset:2048
v_mfma_f32_16x16x32_bf16 v[136:139], a[96:99], a[56:59], v[136:139]
s_add_u32 m0, s76, 36864
ds_read_b128 a[12:15], v3 offset:2048
v_mfma_f32_16x16x32_bf16 v[136:139], a[100:103], a[60:63], v[136:139]
s_add_u32 s64, s73, 384
ds_read_b128 a[16:19], v2 offset:4096
v_mfma_f32_16x16x32_bf16 v[120:123], a[100:103], a[52:55], v[120:123]
buffer_load_dwordx4 v12, s[48:51], s64 offen lds
v_mfma_f32_16x16x32_bf16 v[120:123], a[96:99], a[48:51], v[120:123]
ds_read_b128 a[20:23], v3 offset:4096
v_mfma_f32_16x16x32_bf16 v[104:107], a[96:99], a[40:43], v[104:107]
ds_read_b128 a[24:27], v2 offset:6144
v_mfma_f32_16x16x32_bf16 v[104:107], a[100:103], a[44:47], v[104:107]
s_add_u32 m0, s76, 37888
ds_read_b128 a[28:31], v3 offset:6144
v_mfma_f32_16x16x32_bf16 v[88:91], a[100:103], a[36:39], v[88:91]
s_add_u32 s64, s73, 16768
ds_read_b64_tr_b16 a[88:89], v10 offset:0
v_mfma_f32_16x16x32_bf16 v[88:91], a[96:99], a[32:35], v[88:91]
buffer_load_dwordx4 v13, s[48:51], s64 offen lds
v_mfma_f32_16x16x32_bf16 v[28:31], a[104:107], a[32:35], v[28:31]
ds_read_b64_tr_b16 a[90:91], v10 offset:1024
v_mfma_f32_16x16x32_bf16 v[28:31], a[108:111], a[36:39], v[28:31]
ds_read_b64_tr_b16 a[92:93], v10 offset:8192
v_mfma_f32_16x16x32_bf16 v[44:47], a[108:111], a[44:47], v[44:47]
ds_read_b64_tr_b16 a[94:95], v10 offset:9216
v_mfma_f32_16x16x32_bf16 v[44:47], a[104:107], a[40:43], v[44:47]
s_add_u32 m0, s76, 38912
s_add_u32 s65, s79, 0
ds_read_b64_tr_b16 a[96:97], v11 offset:0
v_mfma_f32_16x16x32_bf16 v[60:63], a[104:107], a[48:51], v[60:63]
s_add_u32 s64, s73, 131456
buffer_store_dwordx4 a[152:155], v16, s[44:47], s65 offen sc1
v_mfma_f32_16x16x32_bf16 v[60:63], a[108:111], a[52:55], v[60:63]
buffer_load_dwordx4 v12, s[48:51], s64 offen lds
v_mfma_f32_16x16x32_bf16 v[76:79], a[108:111], a[60:63], v[76:79]
ds_read_b64_tr_b16 a[98:99], v11 offset:1024
v_mfma_f32_16x16x32_bf16 v[76:79], a[104:107], a[56:59], v[76:79]
ds_read_b64_tr_b16 a[100:101], v11 offset:8192
v_mfma_f32_16x16x32_bf16 v[140:143], a[112:115], a[56:59], v[140:143]
s_add_u32 m0, s76, 39936
ds_read_b64_tr_b16 a[102:103], v11 offset:9216
v_mfma_f32_16x16x32_bf16 v[140:143], a[116:119], a[60:63], v[140:143]
s_add_u32 s64, s73, 147840
v_mfma_f32_16x16x32_bf16 v[124:127], a[116:119], a[52:55], v[124:127]
buffer_load_dwordx4 v13, s[48:51], s64 offen lds
v_mfma_f32_16x16x32_bf16 v[124:127], a[112:115], a[48:51], v[124:127]
v_mfma_f32_16x16x32_bf16 v[108:111], a[112:115], a[40:43], v[108:111]
v_mfma_f32_16x16x32_bf16 v[108:111], a[116:119], a[44:47], v[108:111]
v_mfma_f32_16x16x32_bf16 v[92:95], a[116:119], a[36:39], v[92:95]
v_mfma_f32_16x16x32_bf16 v[92:95], a[112:115], a[32:35], v[92:95]
v_mfma_f32_16x16x32_bf16 v[32:35], a[72:75], a[32:35], v[32:35]
v_mfma_f32_16x16x32_bf16 v[32:35], a[76:79], a[36:39], v[32:35]
v_mfma_f32_16x16x32_bf16 v[48:51], a[76:79], a[44:47], v[48:51]
s_waitcnt lgkmcnt(0)
s_barrier
v_mfma_f32_16x16x32_bf16 v[48:51], a[72:75], a[40:43], v[48:51]
s_add_u32 m0, s77, 65536
ds_read_b64_tr_b16 a[104:105], v19 offset:36864
v_mfma_f32_16x16x32_bf16 v[64:67], a[72:75], a[48:51], v[64:67]
s_add_u32 s64, s71, 2097152
ds_read_b64_tr_b16 a[106:107], v19 offset:37120
v_mfma_f32_16x16x32_bf16 v[64:67], a[76:79], a[52:55], v[64:67]
buffer_load_dwordx4 v14, s[56:59], s64 offen lds
v_mfma_f32_16x16x32_bf16 v[80:83], a[76:79], a[60:63], v[80:83]
ds_read_b64_tr_b16 a[108:109], v19 offset:38912
v_mfma_f32_16x16x32_bf16 v[80:83], a[72:75], a[56:59], v[80:83]
ds_read_b64_tr_b16 a[110:111], v19 offset:39168
v_mfma_f32_16x16x32_bf16 v[144:147], a[80:83], a[56:59], v[144:147]
ds_read_b128 a[64:67], v17 offset:32768
v_mfma_f32_16x16x32_bf16 v[144:147], a[84:87], a[60:63], v[144:147]
ds_read_b128 a[68:71], v18 offset:32768
v_mfma_f32_16x16x32_bf16 v[128:131], a[84:87], a[52:55], v[128:131]
ds_read_b64_tr_b16 a[112:113], v21 offset:36864
v_mfma_f32_16x16x32_bf16 v[128:131], a[80:83], a[48:51], v[128:131]
s_add_u32 m0, s78, 81920
ds_read_b64_tr_b16 a[114:115], v21 offset:37120
v_mfma_f32_16x16x32_bf16 v[112:115], a[80:83], a[40:43], v[112:115]
s_add_u32 s64, s75, 1572864
ds_read_b64_tr_b16 a[116:117], v21 offset:38912
v_mfma_f32_16x16x32_bf16 v[112:115], a[84:87], a[44:47], v[112:115]
buffer_load_dwordx4 v23, s[60:63], s64 offen lds
v_mfma_f32_16x16x32_bf16 v[96:99], a[84:87], a[36:39], v[96:99]
ds_read_b64_tr_b16 a[118:119], v21 offset:39168
v_mfma_f32_16x16x32_bf16 v[96:99], a[80:83], a[32:35], v[96:99]
ds_read_b64_tr_b16 a[72:73], v20 offset:36864
v_mfma_f32_16x16x32_bf16 v[36:39], a[88:91], a[32:35], v[36:39]
ds_read_b64_tr_b16 a[74:75], v20 offset:37120
v_mfma_f32_16x16x32_bf16 v[36:39], a[92:95], a[36:39], v[36:39]
ds_read_b64_tr_b16 a[76:77], v20 offset:38912
v_mfma_f32_16x16x32_bf16 v[52:55], a[92:95], a[44:47], v[52:55]
ds_read_b64_tr_b16 a[78:79], v20 offset:39168
v_mfma_f32_16x16x32_bf16 v[52:55], a[88:91], a[40:43], v[52:55]
s_add_u32 m0, s77, 66560
ds_read_b64_tr_b16 a[80:81], v19 offset:40960
v_mfma_f32_16x16x32_bf16 v[68:71], a[88:91], a[48:51], v[68:71]
s_add_u32 s64, s71, 2129920
ds_read_b64_tr_b16 a[82:83], v19 offset:41216
v_mfma_f32_16x16x32_bf16 v[68:71], a[92:95], a[52:55], v[68:71]
s_xor_b32 s68, s66, 4096
buffer_load_dwordx4 v14, s[56:59], s64 offen lds
v_mfma_f32_16x16x32_bf16 v[84:87], a[92:95], a[60:63], v[84:87]
s_mov_b64 exec, 1
buffer_atomic_add a251, v1, s[52:55], s68 offen offset:0 sc1
s_mov_b64 exec, -1
v_mfma_f32_16x16x32_bf16 v[84:87], a[88:91], a[56:59], v[84:87]
ds_read_b64_tr_b16 a[84:85], v19 offset:43008
v_mfma_f32_16x16x32_bf16 v[148:151], a[96:99], a[56:59], v[148:151]
ds_read_b64_tr_b16 a[86:87], v19 offset:43264
v_mfma_f32_16x16x32_bf16 v[148:151], a[100:103], a[60:63], v[148:151]
ds_read_b64_tr_b16 a[88:89], v21 offset:40960
v_mfma_f32_16x16x32_bf16 v[132:135], a[100:103], a[52:55], v[132:135]
s_add_u32 s65, s79, 17408
ds_read_b64_tr_b16 a[90:91], v21 offset:41216
v_mfma_f32_16x16x32_bf16 v[132:135], a[96:99], a[48:51], v[132:135]
s_add_u32 m0, s78, 86016
buffer_store_dwordx4 a[156:159], v16, s[44:47], s65 offen sc1
v_mfma_f32_16x16x32_bf16 v[116:119], a[96:99], a[40:43], v[116:119]
s_add_u32 s64, s75, 1574912
ds_read_b64_tr_b16 a[92:93], v21 offset:43008
v_mfma_f32_16x16x32_bf16 v[116:119], a[100:103], a[44:47], v[116:119]
buffer_load_dwordx4 v23, s[60:63], s64 offen lds
v_mfma_f32_16x16x32_bf16 v[100:103], a[100:103], a[36:39], v[100:103]
ds_read_b64_tr_b16 a[94:95], v21 offset:43264
v_mfma_f32_16x16x32_bf16 v[100:103], a[96:99], a[32:35], v[100:103]
s_waitcnt lgkmcnt(6)
ds_read_b64_tr_b16 a[96:97], v20 offset:40960
v_mfma_f32_16x16x32_bf16 v[184:187], a[104:107], a[0:3], v[184:187]
ds_read_b64_tr_b16 a[98:99], v20 offset:41216
v_mfma_f32_16x16x32_bf16 v[184:187], a[108:111], a[4:7], v[184:187]
ds_read_b64_tr_b16 a[100:101], v20 offset:43008
v_add_u32 v17, 0x8000, v17
v_mfma_f32_16x16x32_bf16 v[192:195], a[108:111], a[12:15], v[192:195]
ds_read_b64_tr_b16 a[102:103], v20 offset:43264
v_add_u32 v18, 0x8000, v18
v_mfma_f32_16x16x32_bf16 v[192:195], a[104:107], a[8:11], v[192:195]
s_add_u32 m0, s77, 67584
s_add_u32 s17, s78, .-L_pc+6144
v_mfma_f32_16x16x32_bf16 v[200:203], a[104:107], a[16:19], v[200:203]
s_add_u32 s64, s71, 2162688
buffer_load_dword a252, v16, s[88:91], s17 offen
v_mfma_f32_16x16x32_bf16 v[200:203], a[108:111], a[20:23], v[200:203]
buffer_load_dwordx4 v15, s[56:59], s64 offen lds
v_mfma_f32_16x16x32_bf16 v[208:211], a[108:111], a[28:31], v[208:211]
v_mfma_f32_16x16x32_bf16 v[208:211], a[104:107], a[24:27], v[208:211]
ds_read_b64_tr_b16 a[104:105], v19 offset:32768
v_mfma_f32_16x16x32_bf16 v[248:251], a[112:115], a[64:67], v[248:251]
ds_read_b64_tr_b16 a[106:107], v19 offset:33024
v_mfma_f32_16x16x32_bf16 v[248:251], a[116:119], a[68:71], v[248:251]
ds_read_b64_tr_b16 a[108:109], v19 offset:34816
v_mfma_f32_16x16x32_bf16 v[212:215], a[76:79], a[28:31], v[212:215]
ds_read_b64_tr_b16 a[110:111], v19 offset:35072
v_mfma_f32_16x16x32_bf16 v[212:215], a[72:75], a[24:27], v[212:215]
s_add_u32 m0, s78, 90112
ds_read_b64_tr_b16 a[112:113], v20 offset:32768
v_mfma_f32_16x16x32_bf16 v[204:207], a[72:75], a[16:19], v[204:207]
s_add_u32 s64, s75, 1576960
ds_read_b64_tr_b16 a[114:115], v20 offset:33024
v_mfma_f32_16x16x32_bf16 v[204:207], a[76:79], a[20:23], v[204:207]
buffer_load_dwordx4 v23, s[60:63], s64 offen lds
v_mfma_f32_16x16x32_bf16 v[196:199], a[76:79], a[12:15], v[196:199]
ds_read_b64_tr_b16 a[116:117], v20 offset:34816
v_mfma_f32_16x16x32_bf16 v[196:199], a[72:75], a[8:11], v[196:199]
ds_read_b64_tr_b16 a[118:119], v20 offset:35072
v_mfma_f32_16x16x32_bf16 v[188:191], a[72:75], a[0:3], v[188:191]
v_mfma_f32_16x16x32_bf16 v[188:191], a[76:79], a[4:7], v[188:191]
s_waitcnt lgkmcnt(7)
ds_read_b64_tr_b16 a[72:73], v4 offset:32768
v_mfma_f32_16x16x32_bf16 v[216:219], a[4:7], a[84:87], v[216:219]
ds_read_b64_tr_b16 a[74:75], v4 offset:33792
v_mfma_f32_16x16x32_bf16 v[216:219], a[0:3], a[80:83], v[216:219]
s_add_u32 m0, s77, 68608
ds_read_b64_tr_b16 a[76:77], v4 offset:40960
v_add_u32 v21, 0x8000, v21
v_mfma_f32_16x16x32_bf16 v[224:227], a[8:11], a[80:83], v[224:227]
s_add_u32 s64, s71, 2195456
ds_read_b64_tr_b16 a[78:79], v4 offset:41984
v_mfma_f32_16x16x32_bf16 v[224:227], a[12:15], a[84:87], v[224:227]
buffer_load_dwordx4 v15, s[56:59], s64 offen lds
v_mfma_f32_16x16x32_bf16 v[232:235], a[20:23], a[84:87], v[232:235]
v_mfma_f32_16x16x32_bf16 v[232:235], a[16:19], a[80:83], v[232:235]
v_mfma_f32_16x16x32_bf16 v[240:243], a[24:27], a[80:83], v[240:243]
v_mfma_f32_16x16x32_bf16 v[240:243], a[28:31], a[84:87], v[240:243]
ds_read_b64_tr_b16 a[80:81], v5 offset:32768
v_mfma_f32_16x16x32_bf16 v[252:255], a[68:71], a[92:95], v[252:255]
ds_read_b64_tr_b16 a[82:83], v5 offset:33792
v_mfma_f32_16x16x32_bf16 v[252:255], a[64:67], a[88:91], v[252:255]
s_add_u32 m0, s78, 94208
ds_read_b64_tr_b16 a[84:85], v5 offset:40960
v_mfma_f32_16x16x32_bf16 v[244:247], a[24:27], a[96:99], v[244:247]
s_add_u32 s64, s74, 512
ds_read_b64_tr_b16 a[86:87], v5 offset:41984
v_mfma_f32_16x16x32_bf16 v[244:247], a[28:31], a[100:103], v[244:247]
buffer_load_dwordx4 v22, s[48:51], s64 offen lds
v_mfma_f32_16x16x32_bf16 v[236:239], a[20:23], a[100:103], v[236:239]
ds_read_b64_tr_b16 a[88:89], v6 offset:32768
v_add_u32 v19, 0x8000, v19
v_mfma_f32_16x16x32_bf16 v[236:239], a[16:19], a[96:99], v[236:239]
ds_read_b64_tr_b16 a[90:91], v6 offset:33792
v_mfma_f32_16x16x32_bf16 v[228:231], a[8:11], a[96:99], v[228:231]
s_add_u32 s65, s79, 5120
ds_read_b64_tr_b16 a[92:93], v6 offset:40960
v_mfma_f32_16x16x32_bf16 v[228:231], a[12:15], a[100:103], v[228:231]
buffer_store_dwordx4 a[160:163], v16, s[44:47], s65 offen sc1
v_mfma_f32_16x16x32_bf16 v[220:223], a[4:7], a[100:103], v[220:223]
ds_read_b64_tr_b16 a[94:95], v6 offset:41984
v_mfma_f32_16x16x32_bf16 v[220:223], a[0:3], a[96:99], v[220:223]
s_waitcnt lgkmcnt(7)
ds_read_b64_tr_b16 a[96:97], v7 offset:32768
v_mfma_f32_16x16x32_bf16 v[152:155], a[104:107], a[0:3], v[152:155]
ds_read_b64_tr_b16 a[98:99], v7 offset:33792
v_mfma_f32_16x16x32_bf16 v[152:155], a[108:111], a[4:7], v[152:155]
ds_read_b64_tr_b16 a[100:101], v7 offset:40960
v_add_u32 v20, 0x8000, v20
v_mfma_f32_16x16x32_bf16 v[160:163], a[108:111], a[12:15], v[160:163]
s_add_u32 m0, s76, 0
ds_read_b64_tr_b16 a[102:103], v7 offset:41984
v_mfma_f32_16x16x32_bf16 v[160:163], a[104:107], a[8:11], v[160:163]
s_add_u32 s64, s72, 512
v_mfma_f32_16x16x32_bf16 v[168:171], a[104:107], a[16:19], v[168:171]
buffer_load_dwordx4 v12, s[48:51], s64 offen lds
v_mfma_f32_16x16x32_bf16 v[168:171], a[108:111], a[20:23], v[168:171]
v_mfma_f32_16x16x32_bf16 v[176:179], a[108:111], a[28:31], v[176:179]
v_mfma_f32_16x16x32_bf16 v[176:179], a[104:107], a[24:27], v[176:179]
s_add_u32 m0, s76, 1024
ds_read_b64_tr_b16 a[104:105], v8 offset:32768
v_mfma_f32_16x16x32_bf16 v[180:183], a[112:115], a[24:27], v[180:183]
s_add_u32 s64, s72, 16896
ds_read_b64_tr_b16 a[106:107], v8 offset:33792
v_mfma_f32_16x16x32_bf16 v[180:183], a[116:119], a[28:31], v[180:183]
buffer_load_dwordx4 v13, s[48:51], s64 offen lds
v_mfma_f32_16x16x32_bf16 v[172:175], a[116:119], a[20:23], v[172:175]
ds_read_b64_tr_b16 a[108:109], v8 offset:40960
v_add_u32 v4, 0x8000, v4
v_mfma_f32_16x16x32_bf16 v[172:175], a[112:115], a[16:19], v[172:175]
ds_read_b64_tr_b16 a[110:111], v8 offset:41984
v_mfma_f32_16x16x32_bf16 v[164:167], a[112:115], a[8:11], v[164:167]
v_mfma_f32_16x16x32_bf16 v[164:167], a[116:119], a[12:15], v[164:167]
s_add_u32 m0, s76, 2048
v_mfma_f32_16x16x32_bf16 v[156:159], a[116:119], a[4:7], v[156:159]
s_add_u32 s64, s72, 131584
v_mfma_f32_16x16x32_bf16 v[156:159], a[112:115], a[0:3], v[156:159]
buffer_load_dwordx4 v12, s[48:51], s64 offen lds
v_mfma_f32_16x16x32_bf16 v[24:27], a[72:75], a[0:3], v[24:27]
ds_read_b64_tr_b16 a[112:113], v9 offset:32768
v_mfma_f32_16x16x32_bf16 v[24:27], a[76:79], a[4:7], v[24:27]
ds_read_b64_tr_b16 a[114:115], v9 offset:33792
v_add_u32 v5, 0x8000, v5
v_mfma_f32_16x16x32_bf16 v[40:43], a[76:79], a[12:15], v[40:43]
s_waitcnt vmcnt(15)
s_add_u32 m0, s76, 3072
ds_read_b64_tr_b16 a[116:117], v9 offset:40960
v_mfma_f32_16x16x32_bf16 v[40:43], a[72:75], a[8:11], v[40:43]
s_add_u32 s64, s72, 147968
ds_read_b64_tr_b16 a[118:119], v9 offset:41984
v_mfma_f32_16x16x32_bf16 v[56:59], a[72:75], a[16:19], v[56:59]
buffer_load_dwordx4 v13, s[48:51], s64 offen lds
v_mfma_f32_16x16x32_bf16 v[56:59], a[76:79], a[20:23], v[56:59]
ds_read_b128 a[32:35], v2 offset:32768
v_mfma_f32_16x16x32_bf16 v[72:75], a[76:79], a[28:31], v[72:75]
ds_read_b128 a[36:39], v3 offset:32768
v_mfma_f32_16x16x32_bf16 v[72:75], a[72:75], a[24:27], v[72:75]
s_waitcnt lgkmcnt(6)
ds_read_b128 a[40:43], v2 offset:34816
v_mfma_f32_16x16x32_bf16 v[136:139], a[80:83], a[24:27], v[136:139]
s_add_u32 m0, s76, 4096
ds_read_b128 a[44:47], v3 offset:34816
v_mfma_f32_16x16x32_bf16 v[136:139], a[84:87], a[28:31], v[136:139]
s_add_u32 s64, s73, 512
ds_read_b128 a[48:51], v2 offset:36864
v_add_u32 v6, 0x8000, v6
v_mfma_f32_16x16x32_bf16 v[120:123], a[84:87], a[20:23], v[120:123]
buffer_load_dwordx4 v12, s[48:51], s64 offen lds
v_mfma_f32_16x16x32_bf16 v[120:123], a[80:83], a[16:19], v[120:123]
ds_read_b128 a[52:55], v3 offset:36864
v_mfma_f32_16x16x32_bf16 v[104:107], a[80:83], a[8:11], v[104:107]
ds_read_b128 a[56:59], v2 offset:38912
v_mfma_f32_16x16x32_bf16 v[104:107], a[84:87], a[12:15], v[104:107]
s_add_u32 m0, s76, 5120
ds_read_b128 a[60:63], v3 offset:38912
v_mfma_f32_16x16x32_bf16 v[88:91], a[84:87], a[4:7], v[88:91]
s_add_u32 s64, s73, 16896
ds_read_b64_tr_b16 a[72:73], v10 offset:32768
v_mfma_f32_16x16x32_bf16 v[88:91], a[80:83], a[0:3], v[88:91]
buffer_load_dwordx4 v13, s[48:51], s64 offen lds
v_mfma_f32_16x16x32_bf16 v[28:31], a[88:91], a[0:3], v[28:31]
ds_read_b64_tr_b16 a[74:75], v10 offset:33792
v_mfma_f32_16x16x32_bf16 v[28:31], a[92:95], a[4:7], v[28:31]
ds_read_b64_tr_b16 a[76:77], v10 offset:40960
v_add_u32 v7, 0x8000, v7
v_mfma_f32_16x16x32_bf16 v[44:47], a[92:95], a[12:15], v[44:47]
s_add_u32 s65, s79, 1024
ds_read_b64_tr_b16 a[78:79], v10 offset:41984
v_mfma_f32_16x16x32_bf16 v[44:47], a[88:91], a[8:11], v[44:47]
s_add_u32 m0, s76, 6144
buffer_store_dwordx4 a[164:167], v16, s[44:47], s65 offen sc1
v_mfma_f32_16x16x32_bf16 v[60:63], a[88:91], a[16:19], v[60:63]
s_add_u32 s64, s73, 131584
ds_read_b64_tr_b16 a[80:81], v11 offset:32768
v_mfma_f32_16x16x32_bf16 v[60:63], a[92:95], a[20:23], v[60:63]
buffer_load_dwordx4 v12, s[48:51], s64 offen lds
v_mfma_f32_16x16x32_bf16 v[76:79], a[92:95], a[28:31], v[76:79]
ds_read_b64_tr_b16 a[82:83], v11 offset:33792
v_mfma_f32_16x16x32_bf16 v[76:79], a[88:91], a[24:27], v[76:79]
ds_read_b64_tr_b16 a[84:85], v11 offset:40960
v_mfma_f32_16x16x32_bf16 v[140:143], a[96:99], a[24:27], v[140:143]
s_add_u32 m0, s76, 7168
ds_read_b64_tr_b16 a[86:87], v11 offset:41984
v_mfma_f32_16x16x32_bf16 v[140:143], a[100:103], a[28:31], v[140:143]
s_add_u32 s64, s73, 147968
v_add_u32 v8, 0x8000, v8
v_mfma_f32_16x16x32_bf16 v[124:127], a[100:103], a[20:23], v[124:127]
buffer_load_dwordx4 v13, s[48:51], s64 offen lds
v_mfma_f32_16x16x32_bf16 v[124:127], a[96:99], a[16:19], v[124:127]
v_mfma_f32_16x16x32_bf16 v[108:111], a[96:99], a[8:11], v[108:111]
v_mfma_f32_16x16x32_bf16 v[108:111], a[100:103], a[12:15], v[108:111]
v_mfma_f32_16x16x32_bf16 v[92:95], a[100:103], a[4:7], v[92:95]
v_add_u32 v9, 0x8000, v9
v_add_u32 v10, 0x8000, v10
v_mfma_f32_16x16x32_bf16 v[92:95], a[96:99], a[0:3], v[92:95]
v_add_u32 v11, 0x8000, v11
v_mfma_f32_16x16x32_bf16 v[32:35], a[104:107], a[0:3], v[32:35]
v_mfma_f32_16x16x32_bf16 v[32:35], a[108:111], a[4:7], v[32:35]
v_mfma_f32_16x16x32_bf16 v[48:51], a[108:111], a[12:15], v[48:51]
s_waitcnt lgkmcnt(0)
s_barrier
v_mfma_f32_16x16x32_bf16 v[48:51], a[104:107], a[8:11], v[48:51]
s_add_u32 m0, s77, 98304
ds_read_b64_tr_b16 a[88:89], v19 offset:36864
v_mfma_f32_16x16x32_bf16 v[64:67], a[104:107], a[16:19], v[64:67]
s_add_u32 s64, s71, 2621440
ds_read_b64_tr_b16 a[90:91], v19 offset:37120
v_mfma_f32_16x16x32_bf16 v[64:67], a[108:111], a[20:23], v[64:67]
buffer_load_dwordx4 v14, s[56:59], s64 offen lds
v_mfma_f32_16x16x32_bf16 v[80:83], a[108:111], a[28:31], v[80:83]
ds_read_b64_tr_b16 a[92:93], v19 offset:38912
v_mfma_f32_16x16x32_bf16 v[80:83], a[104:107], a[24:27], v[80:83]
ds_read_b64_tr_b16 a[94:95], v19 offset:39168
v_mfma_f32_16x16x32_bf16 v[144:147], a[112:115], a[24:27], v[144:147]
ds_read_b128 a[64:67], v17 offset:32768
v_mfma_f32_16x16x32_bf16 v[144:147], a[116:119], a[28:31], v[144:147]
ds_read_b128 a[68:71], v18 offset:32768
v_mfma_f32_16x16x32_bf16 v[128:131], a[116:119], a[20:23], v[128:131]
ds_read_b64_tr_b16 a[96:97], v21 offset:36864
v_mfma_f32_16x16x32_bf16 v[128:131], a[112:115], a[16:19], v[128:131]
s_add_u32 m0, s78, 114688
ds_read_b64_tr_b16 a[98:99], v21 offset:37120
v_mfma_f32_16x16x32_bf16 v[112:115], a[112:115], a[8:11], v[112:115]
s_add_u32 s64, s75, 1966080
ds_read_b64_tr_b16 a[100:101], v21 offset:38912
v_mfma_f32_16x16x32_bf16 v[112:115], a[116:119], a[12:15], v[112:115]
buffer_load_dwordx4 v23, s[60:63], s64 offen lds
v_mfma_f32_16x16x32_bf16 v[96:99], a[116:119], a[4:7], v[96:99]
ds_read_b64_tr_b16 a[102:103], v21 offset:39168
v_mfma_f32_16x16x32_bf16 v[96:99], a[112:115], a[0:3], v[96:99]
ds_read_b64_tr_b16 a[104:105], v20 offset:36864
v_mfma_f32_16x16x32_bf16 v[36:39], a[72:75], a[0:3], v[36:39]
ds_read_b64_tr_b16 a[106:107], v20 offset:37120
v_mfma_f32_16x16x32_bf16 v[36:39], a[76:79], a[4:7], v[36:39]
ds_read_b64_tr_b16 a[108:109], v20 offset:38912
v_mfma_f32_16x16x32_bf16 v[52:55], a[76:79], a[12:15], v[52:55]
ds_read_b64_tr_b16 a[110:111], v20 offset:39168
v_mfma_f32_16x16x32_bf16 v[52:55], a[72:75], a[8:11], v[52:55]
s_add_u32 m0, s77, 99328
ds_read_b64_tr_b16 a[112:113], v19 offset:40960
v_mfma_f32_16x16x32_bf16 v[68:71], a[72:75], a[16:19], v[68:71]
s_add_u32 s64, s71, 2654208
ds_read_b64_tr_b16 a[114:115], v19 offset:41216
v_mfma_f32_16x16x32_bf16 v[68:71], a[76:79], a[20:23], v[68:71]
s_xor_b32 s68, s66, 8192
buffer_load_dwordx4 v14, s[56:59], s64 offen lds
v_mfma_f32_16x16x32_bf16 v[84:87], a[76:79], a[28:31], v[84:87]
s_mov_b64 exec, 1
buffer_atomic_add a251, v1, s[52:55], s68 offen offset:0 sc1
s_mov_b64 exec, -1
v_mfma_f32_16x16x32_bf16 v[84:87], a[72:75], a[24:27], v[84:87]
ds_read_b64_tr_b16 a[116:117], v19 offset:43008
v_mfma_f32_16x16x32_bf16 v[148:151], a[80:83], a[24:27], v[148:151]
ds_read_b64_tr_b16 a[118:119], v19 offset:43264
v_mfma_f32_16x16x32_bf16 v[148:151], a[84:87], a[28:31], v[148:151]
s_add_u32 s65, s79, 18432
ds_read_b64_tr_b16 a[72:73], v21 offset:40960
v_mfma_f32_16x16x32_bf16 v[132:135], a[84:87], a[20:23], v[132:135]
buffer_store_dwordx4 a[168:171], v16, s[44:47], s65 offen sc1
v_mfma_f32_16x16x32_bf16 v[132:135], a[80:83], a[16:19], v[132:135]
s_add_u32 m0, s78, 118784
ds_read_b64_tr_b16 a[74:75], v21 offset:41216
v_mfma_f32_16x16x32_bf16 v[116:119], a[80:83], a[8:11], v[116:119]
s_add_u32 s64, s75, 1968128
ds_read_b64_tr_b16 a[76:77], v21 offset:43008
v_mfma_f32_16x16x32_bf16 v[116:119], a[84:87], a[12:15], v[116:119]
buffer_load_dwordx4 v23, s[60:63], s64 offen lds
v_mfma_f32_16x16x32_bf16 v[100:103], a[84:87], a[4:7], v[100:103]
ds_read_b64_tr_b16 a[78:79], v21 offset:43264
v_mfma_f32_16x16x32_bf16 v[100:103], a[80:83], a[0:3], v[100:103]
s_waitcnt lgkmcnt(6)
ds_read_b64_tr_b16 a[80:81], v20 offset:40960
v_mfma_f32_16x16x32_bf16 v[184:187], a[88:91], a[32:35], v[184:187]
ds_read_b64_tr_b16 a[82:83], v20 offset:41216
v_mfma_f32_16x16x32_bf16 v[184:187], a[92:95], a[36:39], v[184:187]
ds_read_b64_tr_b16 a[84:85], v20 offset:43008
v_subrev_u32 v17, 0x8000, v17
v_mfma_f32_16x16x32_bf16 v[192:195], a[92:95], a[44:47], v[192:195]
ds_read_b64_tr_b16 a[86:87], v20 offset:43264
v_subrev_u32 v18, 0x8000, v18
v_mfma_f32_16x16x32_bf16 v[192:195], a[88:91], a[40:43], v[192:195]
s_add_u32 m0, s77, 100352
v_mfma_f32_16x16x32_bf16 v[200:203], a[88:91], a[48:51], v[200:203]
s_add_u32 s64, s71, 2686976
v_mfma_f32_16x16x32_bf16 v[200:203], a[92:95], a[52:55], v[200:203]
buffer_load_dwordx4 v15, s[56:59], s64 offen lds
v_mfma_f32_16x16x32_bf16 v[208:211], a[92:95], a[60:63], v[208:211]
v_mfma_f32_16x16x32_bf16 v[208:211], a[88:91], a[56:59], v[208:211]
ds_read_b64_tr_b16 a[88:89], v19 offset:32768
v_mfma_f32_16x16x32_bf16 v[248:251], a[96:99], a[64:67], v[248:251]
ds_read_b64_tr_b16 a[90:91], v19 offset:33024
v_mfma_f32_16x16x32_bf16 v[248:251], a[100:103], a[68:71], v[248:251]
ds_read_b64_tr_b16 a[92:93], v19 offset:34816
v_mfma_f32_16x16x32_bf16 v[212:215], a[108:111], a[60:63], v[212:215]
ds_read_b64_tr_b16 a[94:95], v19 offset:35072
v_mfma_f32_16x16x32_bf16 v[212:215], a[104:107], a[56:59], v[212:215]
s_add_u32 m0, s78, 122880
ds_read_b64_tr_b16 a[96:97], v20 offset:32768
v_mfma_f32_16x16x32_bf16 v[204:207], a[104:107], a[48:51], v[204:207]
s_add_u32 s64, s75, 1970176
ds_read_b64_tr_b16 a[98:99], v20 offset:33024
v_mfma_f32_16x16x32_bf16 v[204:207], a[108:111], a[52:55], v[204:207]
buffer_load_dwordx4 v23, s[60:63], s64 offen lds
v_mfma_f32_16x16x32_bf16 v[196:199], a[108:111], a[44:47], v[196:199]
ds_read_b64_tr_b16 a[100:101], v20 offset:34816
v_mfma_f32_16x16x32_bf16 v[196:199], a[104:107], a[40:43], v[196:199]
ds_read_b64_tr_b16 a[102:103], v20 offset:35072
v_mfma_f32_16x16x32_bf16 v[188:191], a[104:107], a[32:35], v[188:191]
v_mfma_f32_16x16x32_bf16 v[188:191], a[108:111], a[36:39], v[188:191]
s_waitcnt lgkmcnt(7)
ds_read_b64_tr_b16 a[104:105], v4 offset:32768
v_mfma_f32_16x16x32_bf16 v[216:219], a[36:39], a[116:119], v[216:219]
ds_read_b64_tr_b16 a[106:107], v4 offset:33792
v_mfma_f32_16x16x32_bf16 v[216:219], a[32:35], a[112:115], v[216:219]
s_add_u32 m0, s77, 101376
ds_read_b64_tr_b16 a[108:109], v4 offset:40960
v_subrev_u32 v21, 0x8000, v21
v_mfma_f32_16x16x32_bf16 v[224:227], a[40:43], a[112:115], v[224:227]
s_add_u32 s64, s71, 2719744
ds_read_b64_tr_b16 a[110:111], v4 offset:41984
v_mfma_f32_16x16x32_bf16 v[224:227], a[44:47], a[116:119], v[224:227]
buffer_load_dwordx4 v15, s[56:59], s64 offen lds
v_mfma_f32_16x16x32_bf16 v[232:235], a[52:55], a[116:119], v[232:235]
v_mfma_f32_16x16x32_bf16 v[232:235], a[48:51], a[112:115], v[232:235]
v_mfma_f32_16x16x32_bf16 v[240:243], a[56:59], a[112:115], v[240:243]
v_mfma_f32_16x16x32_bf16 v[240:243], a[60:63], a[116:119], v[240:243]
ds_read_b64_tr_b16 a[112:113], v5 offset:32768
v_mfma_f32_16x16x32_bf16 v[252:255], a[68:71], a[76:79], v[252:255]
ds_read_b64_tr_b16 a[114:115], v5 offset:33792
v_mfma_f32_16x16x32_bf16 v[252:255], a[64:67], a[72:75], v[252:255]
s_add_u32 m0, s78, 126976
ds_read_b64_tr_b16 a[116:117], v5 offset:40960
v_mfma_f32_16x16x32_bf16 v[244:247], a[56:59], a[80:83], v[244:247]
s_add_u32 s64, s74, 640
ds_read_b64_tr_b16 a[118:119], v5 offset:41984
v_mfma_f32_16x16x32_bf16 v[244:247], a[60:63], a[84:87], v[244:247]
buffer_load_dwordx4 v22, s[48:51], s64 offen lds
v_mfma_f32_16x16x32_bf16 v[236:239], a[52:55], a[84:87], v[236:239]
ds_read_b64_tr_b16 a[72:73], v6 offset:32768
v_subrev_u32 v19, 0x8000, v19
v_mfma_f32_16x16x32_bf16 v[236:239], a[48:51], a[80:83], v[236:239]
s_add_u32 s65, s79, 6144
ds_read_b64_tr_b16 a[74:75], v6 offset:33792
v_mfma_f32_16x16x32_bf16 v[228:231], a[40:43], a[80:83], v[228:231]
buffer_store_dwordx4 a[172:175], v16, s[44:47], s65 offen sc1
v_mfma_f32_16x16x32_bf16 v[228:231], a[44:47], a[84:87], v[228:231]
ds_read_b64_tr_b16 a[76:77], v6 offset:40960
v_mfma_f32_16x16x32_bf16 v[220:223], a[36:39], a[84:87], v[220:223]
ds_read_b64_tr_b16 a[78:79], v6 offset:41984
v_mfma_f32_16x16x32_bf16 v[220:223], a[32:35], a[80:83], v[220:223]
s_waitcnt lgkmcnt(7)
ds_read_b64_tr_b16 a[80:81], v7 offset:32768
v_mfma_f32_16x16x32_bf16 v[152:155], a[88:91], a[32:35], v[152:155]
ds_read_b64_tr_b16 a[82:83], v7 offset:33792
v_mfma_f32_16x16x32_bf16 v[152:155], a[92:95], a[36:39], v[152:155]
ds_read_b64_tr_b16 a[84:85], v7 offset:40960
v_subrev_u32 v20, 0x8000, v20
v_mfma_f32_16x16x32_bf16 v[160:163], a[92:95], a[44:47], v[160:163]
s_add_u32 m0, s76, 32768
ds_read_b64_tr_b16 a[86:87], v7 offset:41984
v_mfma_f32_16x16x32_bf16 v[160:163], a[88:91], a[40:43], v[160:163]
s_add_u32 s64, s72, 640
v_mfma_f32_16x16x32_bf16 v[168:171], a[88:91], a[48:51], v[168:171]
buffer_load_dwordx4 v12, s[48:51], s64 offen lds
v_mfma_f32_16x16x32_bf16 v[168:171], a[92:95], a[52:55], v[168:171]
v_mfma_f32_16x16x32_bf16 v[176:179], a[92:95], a[60:63], v[176:179]
v_mfma_f32_16x16x32_bf16 v[176:179], a[88:91], a[56:59], v[176:179]
s_add_u32 m0, s76, 33792
ds_read_b64_tr_b16 a[88:89], v8 offset:32768
v_mfma_f32_16x16x32_bf16 v[180:183], a[96:99], a[56:59], v[180:183]
s_add_u32 s64, s72, 17024
ds_read_b64_tr_b16 a[90:91], v8 offset:33792
v_mfma_f32_16x16x32_bf16 v[180:183], a[100:103], a[60:63], v[180:183]
buffer_load_dwordx4 v13, s[48:51], s64 offen lds
v_mfma_f32_16x16x32_bf16 v[172:175], a[100:103], a[52:55], v[172:175]
ds_read_b64_tr_b16 a[92:93], v8 offset:40960
v_subrev_u32 v4, 0x8000, v4
v_mfma_f32_16x16x32_bf16 v[172:175], a[96:99], a[48:51], v[172:175]
ds_read_b64_tr_b16 a[94:95], v8 offset:41984
v_mfma_f32_16x16x32_bf16 v[164:167], a[96:99], a[40:43], v[164:167]
v_mfma_f32_16x16x32_bf16 v[164:167], a[100:103], a[44:47], v[164:167]
s_add_u32 m0, s76, 34816
v_mfma_f32_16x16x32_bf16 v[156:159], a[100:103], a[36:39], v[156:159]
s_add_u32 s64, s72, 131712
v_mfma_f32_16x16x32_bf16 v[156:159], a[96:99], a[32:35], v[156:159]
buffer_load_dwordx4 v12, s[48:51], s64 offen lds
v_mfma_f32_16x16x32_bf16 v[24:27], a[104:107], a[32:35], v[24:27]
ds_read_b64_tr_b16 a[96:97], v9 offset:32768
v_mfma_f32_16x16x32_bf16 v[24:27], a[108:111], a[36:39], v[24:27]
ds_read_b64_tr_b16 a[98:99], v9 offset:33792
v_subrev_u32 v5, 0x8000, v5
v_mfma_f32_16x16x32_bf16 v[40:43], a[108:111], a[44:47], v[40:43]
s_waitcnt vmcnt(14)
s_add_u32 m0, s76, 35840
ds_read_b64_tr_b16 a[100:101], v9 offset:40960
v_mfma_f32_16x16x32_bf16 v[40:43], a[104:107], a[40:43], v[40:43]
s_add_u32 s64, s72, 148096
ds_read_b64_tr_b16 a[102:103], v9 offset:41984
v_mfma_f32_16x16x32_bf16 v[56:59], a[104:107], a[48:51], v[56:59]
buffer_load_dwordx4 v13, s[48:51], s64 offen lds
v_mfma_f32_16x16x32_bf16 v[56:59], a[108:111], a[52:55], v[56:59]
ds_read_b128 a[0:3], v2 offset:0
v_mfma_f32_16x16x32_bf16 v[72:75], a[108:111], a[60:63], v[72:75]
ds_read_b128 a[4:7], v3 offset:0
v_mfma_f32_16x16x32_bf16 v[72:75], a[104:107], a[56:59], v[72:75]
s_waitcnt lgkmcnt(6)
ds_read_b128 a[8:11], v2 offset:2048
v_mfma_f32_16x16x32_bf16 v[136:139], a[112:115], a[56:59], v[136:139]
s_add_u32 m0, s76, 36864
ds_read_b128 a[12:15], v3 offset:2048
v_mfma_f32_16x16x32_bf16 v[136:139], a[116:119], a[60:63], v[136:139]
s_add_u32 s64, s73, 640
ds_read_b128 a[16:19], v2 offset:4096
v_subrev_u32 v6, 0x8000, v6
v_mfma_f32_16x16x32_bf16 v[120:123], a[116:119], a[52:55], v[120:123]
buffer_load_dwordx4 v12, s[48:51], s64 offen lds
v_mfma_f32_16x16x32_bf16 v[120:123], a[112:115], a[48:51], v[120:123]
ds_read_b128 a[20:23], v3 offset:4096
v_mfma_f32_16x16x32_bf16 v[104:107], a[112:115], a[40:43], v[104:107]
ds_read_b128 a[24:27], v2 offset:6144
v_mfma_f32_16x16x32_bf16 v[104:107], a[116:119], a[44:47], v[104:107]
s_add_u32 m0, s76, 37888
ds_read_b128 a[28:31], v3 offset:6144
v_mfma_f32_16x16x32_bf16 v[88:91], a[116:119], a[36:39], v[88:91]
s_add_u32 s64, s73, 17024
ds_read_b64_tr_b16 a[104:105], v10 offset:32768
v_mfma_f32_16x16x32_bf16 v[88:91], a[112:115], a[32:35], v[88:91]
buffer_load_dwordx4 v13, s[48:51], s64 offen lds
v_mfma_f32_16x16x32_bf16 v[28:31], a[72:75], a[32:35], v[28:31]
ds_read_b64_tr_b16 a[106:107], v10 offset:33792
v_mfma_f32_16x16x32_bf16 v[28:31], a[76:79], a[36:39], v[28:31]
s_add_u32 s65, s79, 2048
ds_read_b64_tr_b16 a[108:109], v10 offset:40960
v_subrev_u32 v7, 0x8000, v7
v_mfma_f32_16x16x32_bf16 v[44:47], a[76:79], a[44:47], v[44:47]
buffer_store_dwordx4 a[176:179], v16, s[44:47], s65 offen sc1
v_mfma_f32_16x16x32_bf16 v[44:47], a[72:75], a[40:43], v[44:47]
s_add_u32 m0, s76, 38912
ds_read_b64_tr_b16 a[110:111], v10 offset:41984
v_mfma_f32_16x16x32_bf16 v[60:63], a[72:75], a[48:51], v[60:63]
s_add_u32 s64, s73, 131712
ds_read_b64_tr_b16 a[112:113], v11 offset:32768
v_mfma_f32_16x16x32_bf16 v[60:63], a[76:79], a[52:55], v[60:63]
buffer_load_dwordx4 v12, s[48:51], s64 offen lds
v_mfma_f32_16x16x32_bf16 v[76:79], a[76:79], a[60:63], v[76:79]
ds_read_b64_tr_b16 a[114:115], v11 offset:33792
v_mfma_f32_16x16x32_bf16 v[76:79], a[72:75], a[56:59], v[76:79]
ds_read_b64_tr_b16 a[116:117], v11 offset:40960
v_mfma_f32_16x16x32_bf16 v[140:143], a[80:83], a[56:59], v[140:143]
s_add_u32 m0, s76, 39936
ds_read_b64_tr_b16 a[118:119], v11 offset:41984
v_mfma_f32_16x16x32_bf16 v[140:143], a[84:87], a[60:63], v[140:143]
s_add_u32 s64, s73, 148096
v_subrev_u32 v8, 0x8000, v8
v_mfma_f32_16x16x32_bf16 v[124:127], a[84:87], a[52:55], v[124:127]
buffer_load_dwordx4 v13, s[48:51], s64 offen lds
v_mfma_f32_16x16x32_bf16 v[124:127], a[80:83], a[48:51], v[124:127]
v_mfma_f32_16x16x32_bf16 v[108:111], a[80:83], a[40:43], v[108:111]
v_mfma_f32_16x16x32_bf16 v[108:111], a[84:87], a[44:47], v[108:111]
v_mfma_f32_16x16x32_bf16 v[92:95], a[84:87], a[36:39], v[92:95]
v_subrev_u32 v9, 0x8000, v9
v_subrev_u32 v10, 0x8000, v10
v_mfma_f32_16x16x32_bf16 v[92:95], a[80:83], a[32:35], v[92:95]
v_subrev_u32 v11, 0x8000, v11
v_mfma_f32_16x16x32_bf16 v[32:35], a[88:91], a[32:35], v[32:35]
v_mfma_f32_16x16x32_bf16 v[32:35], a[92:95], a[36:39], v[32:35]
v_mfma_f32_16x16x32_bf16 v[48:51], a[92:95], a[44:47], v[48:51]
s_waitcnt lgkmcnt(0)
s_barrier
v_mfma_f32_16x16x32_bf16 v[48:51], a[88:91], a[40:43], v[48:51]
s_add_u32 m0, s77, 131072
ds_read_b64_tr_b16 a[72:73], v19 offset:4096
v_mfma_f32_16x16x32_bf16 v[64:67], a[88:91], a[48:51], v[64:67]
s_add_u32 s64, s71, 3145728
ds_read_b64_tr_b16 a[74:75], v19 offset:4352
v_mfma_f32_16x16x32_bf16 v[64:67], a[92:95], a[52:55], v[64:67]
buffer_load_dwordx4 v14, s[56:59], s64 offen lds
v_mfma_f32_16x16x32_bf16 v[80:83], a[92:95], a[60:63], v[80:83]
ds_read_b64_tr_b16 a[76:77], v19 offset:6144
v_mfma_f32_16x16x32_bf16 v[80:83], a[88:91], a[56:59], v[80:83]
ds_read_b64_tr_b16 a[78:79], v19 offset:6400
v_mfma_f32_16x16x32_bf16 v[144:147], a[96:99], a[56:59], v[144:147]
ds_read_b128 a[64:67], v17 offset:0
v_mfma_f32_16x16x32_bf16 v[144:147], a[100:103], a[60:63], v[144:147]
ds_read_b128 a[68:71], v18 offset:0
v_mfma_f32_16x16x32_bf16 v[128:131], a[100:103], a[52:55], v[128:131]
ds_read_b64_tr_b16 a[80:81], v21 offset:4096
v_mfma_f32_16x16x32_bf16 v[128:131], a[96:99], a[48:51], v[128:131]
s_add_u32 m0, s78, 147456
ds_read_b64_tr_b16 a[82:83], v21 offset:4352
v_mfma_f32_16x16x32_bf16 v[112:115], a[96:99], a[40:43], v[112:115]
s_add_u32 s64, s75, 2359296
ds_read_b64_tr_b16 a[84:85], v21 offset:6144
v_mfma_f32_16x16x32_bf16 v[112:115], a[100:103], a[44:47], v[112:115]
buffer_load_dwordx4 v23, s[60:63], s64 offen lds
v_mfma_f32_16x16x32_bf16 v[96:99], a[100:103], a[36:39], v[96:99]
ds_read_b64_tr_b16 a[86:87], v21 offset:6400
v_mfma_f32_16x16x32_bf16 v[96:99], a[96:99], a[32:35], v[96:99]
ds_read_b64_tr_b16 a[88:89], v20 offset:4096
v_mfma_f32_16x16x32_bf16 v[36:39], a[104:107], a[32:35], v[36:39]
ds_read_b64_tr_b16 a[90:91], v20 offset:4352
v_mfma_f32_16x16x32_bf16 v[36:39], a[108:111], a[36:39], v[36:39]
ds_read_b64_tr_b16 a[92:93], v20 offset:6144
v_mfma_f32_16x16x32_bf16 v[52:55], a[108:111], a[44:47], v[52:55]
ds_read_b64_tr_b16 a[94:95], v20 offset:6400
v_mfma_f32_16x16x32_bf16 v[52:55], a[104:107], a[40:43], v[52:55]
s_add_u32 m0, s77, 132096
ds_read_b64_tr_b16 a[96:97], v19 offset:8192
v_mfma_f32_16x16x32_bf16 v[68:71], a[104:107], a[48:51], v[68:71]
s_add_u32 s64, s71, 3178496
ds_read_b64_tr_b16 a[98:99], v19 offset:8448
v_mfma_f32_16x16x32_bf16 v[68:71], a[108:111], a[52:55], v[68:71]
s_xor_b32 s68, s66, 12288
buffer_load_dwordx4 v14, s[56:59], s64 offen lds
v_mfma_f32_16x16x32_bf16 v[84:87], a[108:111], a[60:63], v[84:87]
s_mov_b64 exec, 1
buffer_atomic_add a251, v1, s[52:55], s68 offen offset:0 sc1
s_mov_b64 exec, -1
v_mfma_f32_16x16x32_bf16 v[84:87], a[104:107], a[56:59], v[84:87]
ds_read_b64_tr_b16 a[100:101], v19 offset:10240
v_mfma_f32_16x16x32_bf16 v[148:151], a[112:115], a[56:59], v[148:151]
s_add_u32 s65, s79, 19456
ds_read_b64_tr_b16 a[102:103], v19 offset:10496
v_mfma_f32_16x16x32_bf16 v[148:151], a[116:119], a[60:63], v[148:151]
buffer_store_dwordx4 a[180:183], v16, s[44:47], s65 offen sc1
v_mfma_f32_16x16x32_bf16 v[132:135], a[116:119], a[52:55], v[132:135]
ds_read_b64_tr_b16 a[104:105], v21 offset:8192
v_mfma_f32_16x16x32_bf16 v[132:135], a[112:115], a[48:51], v[132:135]
s_add_u32 m0, s78, 151552
ds_read_b64_tr_b16 a[106:107], v21 offset:8448
v_mfma_f32_16x16x32_bf16 v[116:119], a[112:115], a[40:43], v[116:119]
s_add_u32 s64, s75, 2361344
ds_read_b64_tr_b16 a[108:109], v21 offset:10240
v_mfma_f32_16x16x32_bf16 v[116:119], a[116:119], a[44:47], v[116:119]
buffer_load_dwordx4 v23, s[60:63], s64 offen lds
v_mfma_f32_16x16x32_bf16 v[100:103], a[116:119], a[36:39], v[100:103]
ds_read_b64_tr_b16 a[110:111], v21 offset:10496
v_mfma_f32_16x16x32_bf16 v[100:103], a[112:115], a[32:35], v[100:103]
s_waitcnt lgkmcnt(6)
ds_read_b64_tr_b16 a[112:113], v20 offset:8192
v_mfma_f32_16x16x32_bf16 v[184:187], a[72:75], a[0:3], v[184:187]
ds_read_b64_tr_b16 a[114:115], v20 offset:8448
v_mfma_f32_16x16x32_bf16 v[184:187], a[76:79], a[4:7], v[184:187]
ds_read_b64_tr_b16 a[116:117], v20 offset:10240
v_mfma_f32_16x16x32_bf16 v[192:195], a[76:79], a[12:15], v[192:195]
ds_read_b64_tr_b16 a[118:119], v20 offset:10496
v_mfma_f32_16x16x32_bf16 v[192:195], a[72:75], a[8:11], v[192:195]
s_add_u32 m0, s77, 133120
s_add_u32 s17, s78, .-L_pc+6144
v_mfma_f32_16x16x32_bf16 v[200:203], a[72:75], a[16:19], v[200:203]
s_add_u32 s64, s71, 3211264
buffer_load_dword a252, v16, s[88:91], s17 offen
v_mfma_f32_16x16x32_bf16 v[200:203], a[76:79], a[20:23], v[200:203]
buffer_load_dwordx4 v15, s[56:59], s64 offen lds
v_mfma_f32_16x16x32_bf16 v[208:211], a[76:79], a[28:31], v[208:211]
v_mfma_f32_16x16x32_bf16 v[208:211], a[72:75], a[24:27], v[208:211]
ds_read_b64_tr_b16 a[72:73], v19 offset:0
v_mfma_f32_16x16x32_bf16 v[248:251], a[80:83], a[64:67], v[248:251]
ds_read_b64_tr_b16 a[74:75], v19 offset:256
v_mfma_f32_16x16x32_bf16 v[248:251], a[84:87], a[68:71], v[248:251]
ds_read_b64_tr_b16 a[76:77], v19 offset:2048
v_mfma_f32_16x16x32_bf16 v[212:215], a[92:95], a[28:31], v[212:215]
ds_read_b64_tr_b16 a[78:79], v19 offset:2304
v_mfma_f32_16x16x32_bf16 v[212:215], a[88:91], a[24:27], v[212:215]
s_add_u32 m0, s78, 155648
ds_read_b64_tr_b16 a[80:81], v20 offset:0
v_mfma_f32_16x16x32_bf16 v[204:207], a[88:91], a[16:19], v[204:207]
s_add_u32 s64, s75, 2363392
ds_read_b64_tr_b16 a[82:83], v20 offset:256
v_mfma_f32_16x16x32_bf16 v[204:207], a[92:95], a[20:23], v[204:207]
buffer_load_dwordx4 v23, s[60:63], s64 offen lds
v_mfma_f32_16x16x32_bf16 v[196:199], a[92:95], a[12:15], v[196:199]
ds_read_b64_tr_b16 a[84:85], v20 offset:2048
v_mfma_f32_16x16x32_bf16 v[196:199], a[88:91], a[8:11], v[196:199]
ds_read_b64_tr_b16 a[86:87], v20 offset:2304
v_mfma_f32_16x16x32_bf16 v[188:191], a[88:91], a[0:3], v[188:191]
v_mfma_f32_16x16x32_bf16 v[188:191], a[92:95], a[4:7], v[188:191]
s_waitcnt lgkmcnt(7)
ds_read_b64_tr_b16 a[88:89], v4 offset:0
v_mfma_f32_16x16x32_bf16 v[216:219], a[4:7], a[100:103], v[216:219]
ds_read_b64_tr_b16 a[90:91], v4 offset:1024
v_mfma_f32_16x16x32_bf16 v[216:219], a[0:3], a[96:99], v[216:219]
s_add_u32 m0, s77, 134144
ds_read_b64_tr_b16 a[92:93], v4 offset:8192
v_mfma_f32_16x16x32_bf16 v[224:227], a[8:11], a[96:99], v[224:227]
s_add_u32 s64, s71, 3244032
ds_read_b64_tr_b16 a[94:95], v4 offset:9216
v_mfma_f32_16x16x32_bf16 v[224:227], a[12:15], a[100:103], v[224:227]
buffer_load_dwordx4 v15, s[56:59], s64 offen lds
v_mfma_f32_16x16x32_bf16 v[232:235], a[20:23], a[100:103], v[232:235]
v_mfma_f32_16x16x32_bf16 v[232:235], a[16:19], a[96:99], v[232:235]
v_mfma_f32_16x16x32_bf16 v[240:243], a[24:27], a[96:99], v[240:243]
v_mfma_f32_16x16x32_bf16 v[240:243], a[28:31], a[100:103], v[240:243]
ds_read_b64_tr_b16 a[96:97], v5 offset:0
v_mfma_f32_16x16x32_bf16 v[252:255], a[68:71], a[108:111], v[252:255]
ds_read_b64_tr_b16 a[98:99], v5 offset:1024
v_mfma_f32_16x16x32_bf16 v[252:255], a[64:67], a[104:107], v[252:255]
s_add_u32 m0, s78, 159744
ds_read_b64_tr_b16 a[100:101], v5 offset:8192
v_mfma_f32_16x16x32_bf16 v[244:247], a[24:27], a[112:115], v[244:247]
s_add_u32 s64, s74, 768
ds_read_b64_tr_b16 a[102:103], v5 offset:9216
v_mfma_f32_16x16x32_bf16 v[244:247], a[28:31], a[116:119], v[244:247]
buffer_load_dwordx4 v22, s[48:51], s64 offen lds
v_mfma_f32_16x16x32_bf16 v[236:239], a[20:23], a[116:119], v[236:239]
s_add_u32 s65, s79, 7168
ds_read_b64_tr_b16 a[104:105], v6 offset:0
v_mfma_f32_16x16x32_bf16 v[236:239], a[16:19], a[112:115], v[236:239]
buffer_store_dwordx4 a[184:187], v16, s[44:47], s65 offen sc1
v_mfma_f32_16x16x32_bf16 v[228:231], a[8:11], a[112:115], v[228:231]
ds_read_b64_tr_b16 a[106:107], v6 offset:1024
v_mfma_f32_16x16x32_bf16 v[228:231], a[12:15], a[116:119], v[228:231]
ds_read_b64_tr_b16 a[108:109], v6 offset:8192
v_mfma_f32_16x16x32_bf16 v[220:223], a[4:7], a[116:119], v[220:223]
ds_read_b64_tr_b16 a[110:111], v6 offset:9216
v_mfma_f32_16x16x32_bf16 v[220:223], a[0:3], a[112:115], v[220:223]
s_waitcnt lgkmcnt(7)
ds_read_b64_tr_b16 a[112:113], v7 offset:0
v_mfma_f32_16x16x32_bf16 v[152:155], a[72:75], a[0:3], v[152:155]
ds_read_b64_tr_b16 a[114:115], v7 offset:1024
v_mfma_f32_16x16x32_bf16 v[152:155], a[76:79], a[4:7], v[152:155]
ds_read_b64_tr_b16 a[116:117], v7 offset:8192
v_mfma_f32_16x16x32_bf16 v[160:163], a[76:79], a[12:15], v[160:163]
s_add_u32 m0, s76, 0
ds_read_b64_tr_b16 a[118:119], v7 offset:9216
v_mfma_f32_16x16x32_bf16 v[160:163], a[72:75], a[8:11], v[160:163]
s_add_u32 s64, s72, 768
v_mfma_f32_16x16x32_bf16 v[168:171], a[72:75], a[16:19], v[168:171]
buffer_load_dwordx4 v12, s[48:51], s64 offen lds
v_mfma_f32_16x16x32_bf16 v[168:171], a[76:79], a[20:23], v[168:171]
v_mfma_f32_16x16x32_bf16 v[176:179], a[76:79], a[28:31], v[176:179]
v_mfma_f32_16x16x32_bf16 v[176:179], a[72:75], a[24:27], v[176:179]
s_add_u32 m0, s76, 1024
ds_read_b64_tr_b16 a[72:73], v8 offset:0
v_mfma_f32_16x16x32_bf16 v[180:183], a[80:83], a[24:27], v[180:183]
s_add_u32 s64, s72, 17152
ds_read_b64_tr_b16 a[74:75], v8 offset:1024
v_mfma_f32_16x16x32_bf16 v[180:183], a[84:87], a[28:31], v[180:183]
buffer_load_dwordx4 v13, s[48:51], s64 offen lds
v_mfma_f32_16x16x32_bf16 v[172:175], a[84:87], a[20:23], v[172:175]
ds_read_b64_tr_b16 a[76:77], v8 offset:8192
v_mfma_f32_16x16x32_bf16 v[172:175], a[80:83], a[16:19], v[172:175]
ds_read_b64_tr_b16 a[78:79], v8 offset:9216
v_mfma_f32_16x16x32_bf16 v[164:167], a[80:83], a[8:11], v[164:167]
v_mfma_f32_16x16x32_bf16 v[164:167], a[84:87], a[12:15], v[164:167]
s_add_u32 m0, s76, 2048
v_mfma_f32_16x16x32_bf16 v[156:159], a[84:87], a[4:7], v[156:159]
s_add_u32 s64, s72, 131840
v_mfma_f32_16x16x32_bf16 v[156:159], a[80:83], a[0:3], v[156:159]
buffer_load_dwordx4 v12, s[48:51], s64 offen lds
v_mfma_f32_16x16x32_bf16 v[24:27], a[88:91], a[0:3], v[24:27]
ds_read_b64_tr_b16 a[80:81], v9 offset:0
v_mfma_f32_16x16x32_bf16 v[24:27], a[92:95], a[4:7], v[24:27]
ds_read_b64_tr_b16 a[82:83], v9 offset:1024
v_mfma_f32_16x16x32_bf16 v[40:43], a[92:95], a[12:15], v[40:43]
s_waitcnt vmcnt(15)
s_add_u32 m0, s76, 3072
ds_read_b64_tr_b16 a[84:85], v9 offset:8192
v_mfma_f32_16x16x32_bf16 v[40:43], a[88:91], a[8:11], v[40:43]
s_add_u32 s64, s72, 148224
ds_read_b64_tr_b16 a[86:87], v9 offset:9216
v_mfma_f32_16x16x32_bf16 v[56:59], a[88:91], a[16:19], v[56:59]
buffer_load_dwordx4 v13, s[48:51], s64 offen lds
v_mfma_f32_16x16x32_bf16 v[56:59], a[92:95], a[20:23], v[56:59]
ds_read_b128 a[32:35], v2 offset:32768
v_mfma_f32_16x16x32_bf16 v[72:75], a[92:95], a[28:31], v[72:75]
ds_read_b128 a[36:39], v3 offset:32768
v_mfma_f32_16x16x32_bf16 v[72:75], a[88:91], a[24:27], v[72:75]
s_waitcnt lgkmcnt(6)
ds_read_b128 a[40:43], v2 offset:34816
v_mfma_f32_16x16x32_bf16 v[136:139], a[96:99], a[24:27], v[136:139]
s_add_u32 m0, s76, 4096
ds_read_b128 a[44:47], v3 offset:34816
v_mfma_f32_16x16x32_bf16 v[136:139], a[100:103], a[28:31], v[136:139]
s_add_u32 s64, s73, 768
ds_read_b128 a[48:51], v2 offset:36864
v_mfma_f32_16x16x32_bf16 v[120:123], a[100:103], a[20:23], v[120:123]
buffer_load_dwordx4 v12, s[48:51], s64 offen lds
v_mfma_f32_16x16x32_bf16 v[120:123], a[96:99], a[16:19], v[120:123]
ds_read_b128 a[52:55], v3 offset:36864
v_mfma_f32_16x16x32_bf16 v[104:107], a[96:99], a[8:11], v[104:107]
ds_read_b128 a[56:59], v2 offset:38912
v_mfma_f32_16x16x32_bf16 v[104:107], a[100:103], a[12:15], v[104:107]
s_add_u32 m0, s76, 5120
ds_read_b128 a[60:63], v3 offset:38912
v_mfma_f32_16x16x32_bf16 v[88:91], a[100:103], a[4:7], v[88:91]
s_add_u32 s64, s73, 17152
ds_read_b64_tr_b16 a[88:89], v10 offset:0
v_mfma_f32_16x16x32_bf16 v[88:91], a[96:99], a[0:3], v[88:91]
buffer_load_dwordx4 v13, s[48:51], s64 offen lds
v_mfma_f32_16x16x32_bf16 v[28:31], a[104:107], a[0:3], v[28:31]
s_add_u32 s65, s79, 3072
ds_read_b64_tr_b16 a[90:91], v10 offset:1024
v_mfma_f32_16x16x32_bf16 v[28:31], a[108:111], a[4:7], v[28:31]
buffer_store_dwordx4 a[188:191], v16, s[44:47], s65 offen sc1
v_mfma_f32_16x16x32_bf16 v[44:47], a[108:111], a[12:15], v[44:47]
ds_read_b64_tr_b16 a[92:93], v10 offset:8192
v_mfma_f32_16x16x32_bf16 v[44:47], a[104:107], a[8:11], v[44:47]
s_add_u32 m0, s76, 6144
ds_read_b64_tr_b16 a[94:95], v10 offset:9216
v_mfma_f32_16x16x32_bf16 v[60:63], a[104:107], a[16:19], v[60:63]
s_add_u32 s64, s73, 131840
ds_read_b64_tr_b16 a[96:97], v11 offset:0
v_mfma_f32_16x16x32_bf16 v[60:63], a[108:111], a[20:23], v[60:63]
buffer_load_dwordx4 v12, s[48:51], s64 offen lds
v_mfma_f32_16x16x32_bf16 v[76:79], a[108:111], a[28:31], v[76:79]
ds_read_b64_tr_b16 a[98:99], v11 offset:1024
v_mfma_f32_16x16x32_bf16 v[76:79], a[104:107], a[24:27], v[76:79]
ds_read_b64_tr_b16 a[100:101], v11 offset:8192
v_mfma_f32_16x16x32_bf16 v[140:143], a[112:115], a[24:27], v[140:143]
s_add_u32 m0, s76, 7168
ds_read_b64_tr_b16 a[102:103], v11 offset:9216
v_mfma_f32_16x16x32_bf16 v[140:143], a[116:119], a[28:31], v[140:143]
s_add_u32 s64, s73, 148224
v_mfma_f32_16x16x32_bf16 v[124:127], a[116:119], a[20:23], v[124:127]
buffer_load_dwordx4 v13, s[48:51], s64 offen lds
v_mfma_f32_16x16x32_bf16 v[124:127], a[112:115], a[16:19], v[124:127]
v_mfma_f32_16x16x32_bf16 v[108:111], a[112:115], a[8:11], v[108:111]
v_mfma_f32_16x16x32_bf16 v[108:111], a[116:119], a[12:15], v[108:111]
v_mfma_f32_16x16x32_bf16 v[92:95], a[116:119], a[4:7], v[92:95]
v_mfma_f32_16x16x32_bf16 v[92:95], a[112:115], a[0:3], v[92:95]
v_mfma_f32_16x16x32_bf16 v[32:35], a[72:75], a[0:3], v[32:35]
v_mfma_f32_16x16x32_bf16 v[32:35], a[76:79], a[4:7], v[32:35]
v_mfma_f32_16x16x32_bf16 v[48:51], a[76:79], a[12:15], v[48:51]
s_waitcnt lgkmcnt(0)
s_barrier
v_mfma_f32_16x16x32_bf16 v[48:51], a[72:75], a[8:11], v[48:51]
s_add_u32 m0, s77, 65536
ds_read_b64_tr_b16 a[104:105], v19 offset:36864
v_mfma_f32_16x16x32_bf16 v[64:67], a[72:75], a[16:19], v[64:67]
s_add_u32 s64, s71, 3670016
ds_read_b64_tr_b16 a[106:107], v19 offset:37120
v_mfma_f32_16x16x32_bf16 v[64:67], a[76:79], a[20:23], v[64:67]
buffer_load_dwordx4 v14, s[56:59], s64 offen lds
v_mfma_f32_16x16x32_bf16 v[80:83], a[76:79], a[28:31], v[80:83]
ds_read_b64_tr_b16 a[108:109], v19 offset:38912
v_mfma_f32_16x16x32_bf16 v[80:83], a[72:75], a[24:27], v[80:83]
ds_read_b64_tr_b16 a[110:111], v19 offset:39168
v_mfma_f32_16x16x32_bf16 v[144:147], a[80:83], a[24:27], v[144:147]
ds_read_b128 a[64:67], v17 offset:32768
v_mfma_f32_16x16x32_bf16 v[144:147], a[84:87], a[28:31], v[144:147]
ds_read_b128 a[68:71], v18 offset:32768
v_mfma_f32_16x16x32_bf16 v[128:131], a[84:87], a[20:23], v[128:131]
ds_read_b64_tr_b16 a[112:113], v21 offset:36864
v_mfma_f32_16x16x32_bf16 v[128:131], a[80:83], a[16:19], v[128:131]
s_add_u32 m0, s78, 81920
ds_read_b64_tr_b16 a[114:115], v21 offset:37120
v_mfma_f32_16x16x32_bf16 v[112:115], a[80:83], a[8:11], v[112:115]
s_add_u32 s64, s75, 2752512
ds_read_b64_tr_b16 a[116:117], v21 offset:38912
v_mfma_f32_16x16x32_bf16 v[112:115], a[84:87], a[12:15], v[112:115]
buffer_load_dwordx4 v23, s[60:63], s64 offen lds
v_mfma_f32_16x16x32_bf16 v[96:99], a[84:87], a[4:7], v[96:99]
ds_read_b64_tr_b16 a[118:119], v21 offset:39168
v_mfma_f32_16x16x32_bf16 v[96:99], a[80:83], a[0:3], v[96:99]
ds_read_b64_tr_b16 a[72:73], v20 offset:36864
v_mfma_f32_16x16x32_bf16 v[36:39], a[88:91], a[0:3], v[36:39]
ds_read_b64_tr_b16 a[74:75], v20 offset:37120
v_mfma_f32_16x16x32_bf16 v[36:39], a[92:95], a[4:7], v[36:39]
ds_read_b64_tr_b16 a[76:77], v20 offset:38912
v_mfma_f32_16x16x32_bf16 v[52:55], a[92:95], a[12:15], v[52:55]
ds_read_b64_tr_b16 a[78:79], v20 offset:39168
v_mfma_f32_16x16x32_bf16 v[52:55], a[88:91], a[8:11], v[52:55]
s_add_u32 m0, s77, 66560
ds_read_b64_tr_b16 a[80:81], v19 offset:40960
v_mfma_f32_16x16x32_bf16 v[68:71], a[88:91], a[16:19], v[68:71]
s_add_u32 s64, s71, 3702784
ds_read_b64_tr_b16 a[82:83], v19 offset:41216
v_mfma_f32_16x16x32_bf16 v[68:71], a[92:95], a[20:23], v[68:71]
buffer_load_dwordx4 v14, s[56:59], s64 offen lds
v_mfma_f32_16x16x32_bf16 v[84:87], a[92:95], a[28:31], v[84:87]
ds_read_b64_tr_b16 a[84:85], v19 offset:43008
v_mfma_f32_16x16x32_bf16 v[84:87], a[88:91], a[24:27], v[84:87]
s_add_u32 s65, s79, 24576
ds_read_b64_tr_b16 a[86:87], v19 offset:43264
v_mfma_f32_16x16x32_bf16 v[148:151], a[96:99], a[24:27], v[148:151]
buffer_store_dwordx4 a[192:195], v16, s[44:47], s65 offen sc1
v_mfma_f32_16x16x32_bf16 v[148:151], a[100:103], a[28:31], v[148:151]
ds_read_b64_tr_b16 a[88:89], v21 offset:40960
v_mfma_f32_16x16x32_bf16 v[132:135], a[100:103], a[20:23], v[132:135]
ds_read_b64_tr_b16 a[90:91], v21 offset:41216
v_mfma_f32_16x16x32_bf16 v[132:135], a[96:99], a[16:19], v[132:135]
s_add_u32 m0, s78, 86016
ds_read_b64_tr_b16 a[92:93], v21 offset:43008
v_mfma_f32_16x16x32_bf16 v[116:119], a[96:99], a[8:11], v[116:119]
s_add_u32 s64, s75, 2754560
ds_read_b64_tr_b16 a[94:95], v21 offset:43264
v_mfma_f32_16x16x32_bf16 v[116:119], a[100:103], a[12:15], v[116:119]
buffer_load_dwordx4 v23, s[60:63], s64 offen lds
v_mfma_f32_16x16x32_bf16 v[100:103], a[100:103], a[4:7], v[100:103]
v_mfma_f32_16x16x32_bf16 v[100:103], a[96:99], a[0:3], v[100:103]
s_waitcnt lgkmcnt(6)
ds_read_b64_tr_b16 a[96:97], v20 offset:40960
v_mfma_f32_16x16x32_bf16 v[184:187], a[104:107], a[32:35], v[184:187]
ds_read_b64_tr_b16 a[98:99], v20 offset:41216
v_mfma_f32_16x16x32_bf16 v[184:187], a[108:111], a[36:39], v[184:187]
ds_read_b64_tr_b16 a[100:101], v20 offset:43008
v_add_u32 v17, 0x8000, v17
v_mfma_f32_16x16x32_bf16 v[192:195], a[108:111], a[44:47], v[192:195]
ds_read_b64_tr_b16 a[102:103], v20 offset:43264
v_add_u32 v18, 0x8000, v18
v_mfma_f32_16x16x32_bf16 v[192:195], a[104:107], a[40:43], v[192:195]
s_add_u32 m0, s77, 67584
v_mfma_f32_16x16x32_bf16 v[200:203], a[104:107], a[48:51], v[200:203]
s_add_u32 s64, s71, 3735552
v_mfma_f32_16x16x32_bf16 v[200:203], a[108:111], a[52:55], v[200:203]
buffer_load_dwordx4 v15, s[56:59], s64 offen lds
v_mfma_f32_16x16x32_bf16 v[208:211], a[108:111], a[60:63], v[208:211]
v_mfma_f32_16x16x32_bf16 v[208:211], a[104:107], a[56:59], v[208:211]
ds_read_b64_tr_b16 a[104:105], v19 offset:32768
v_mfma_f32_16x16x32_bf16 v[248:251], a[112:115], a[64:67], v[248:251]
ds_read_b64_tr_b16 a[106:107], v19 offset:33024
v_mfma_f32_16x16x32_bf16 v[248:251], a[116:119], a[68:71], v[248:251]
ds_read_b64_tr_b16 a[108:109], v19 offset:34816
v_mfma_f32_16x16x32_bf16 v[212:215], a[76:79], a[60:63], v[212:215]
ds_read_b64_tr_b16 a[110:111], v19 offset:35072
v_mfma_f32_16x16x32_bf16 v[212:215], a[72:75], a[56:59], v[212:215]
s_add_u32 m0, s78, 90112
ds_read_b64_tr_b16 a[112:113], v20 offset:32768
v_mfma_f32_16x16x32_bf16 v[204:207], a[72:75], a[48:51], v[204:207]
s_add_u32 s64, s75, 2756608
ds_read_b64_tr_b16 a[114:115], v20 offset:33024
v_mfma_f32_16x16x32_bf16 v[204:207], a[76:79], a[52:55], v[204:207]
buffer_load_dwordx4 v23, s[60:63], s64 offen lds
v_mfma_f32_16x16x32_bf16 v[196:199], a[76:79], a[44:47], v[196:199]
ds_read_b64_tr_b16 a[116:117], v20 offset:34816
v_mfma_f32_16x16x32_bf16 v[196:199], a[72:75], a[40:43], v[196:199]
ds_read_b64_tr_b16 a[118:119], v20 offset:35072
v_mfma_f32_16x16x32_bf16 v[188:191], a[72:75], a[32:35], v[188:191]
v_mfma_f32_16x16x32_bf16 v[188:191], a[76:79], a[36:39], v[188:191]
s_waitcnt lgkmcnt(7)
ds_read_b64_tr_b16 a[72:73], v4 offset:32768
v_mfma_f32_16x16x32_bf16 v[216:219], a[36:39], a[84:87], v[216:219]
ds_read_b64_tr_b16 a[74:75], v4 offset:33792
v_mfma_f32_16x16x32_bf16 v[216:219], a[32:35], a[80:83], v[216:219]
s_add_u32 m0, s77, 68608
ds_read_b64_tr_b16 a[76:77], v4 offset:40960
v_add_u32 v21, 0x8000, v21
v_mfma_f32_16x16x32_bf16 v[224:227], a[40:43], a[80:83], v[224:227]
s_add_u32 s64, s71, 3768320
ds_read_b64_tr_b16 a[78:79], v4 offset:41984
v_mfma_f32_16x16x32_bf16 v[224:227], a[44:47], a[84:87], v[224:227]
buffer_load_dwordx4 v15, s[56:59], s64 offen lds
v_mfma_f32_16x16x32_bf16 v[232:235], a[52:55], a[84:87], v[232:235]
v_mfma_f32_16x16x32_bf16 v[232:235], a[48:51], a[80:83], v[232:235]
v_mfma_f32_16x16x32_bf16 v[240:243], a[56:59], a[80:83], v[240:243]
v_mfma_f32_16x16x32_bf16 v[240:243], a[60:63], a[84:87], v[240:243]
ds_read_b64_tr_b16 a[80:81], v5 offset:32768
v_mfma_f32_16x16x32_bf16 v[252:255], a[68:71], a[92:95], v[252:255]
ds_read_b64_tr_b16 a[82:83], v5 offset:33792
v_mfma_f32_16x16x32_bf16 v[252:255], a[64:67], a[88:91], v[252:255]
s_add_u32 m0, s78, 94208
ds_read_b64_tr_b16 a[84:85], v5 offset:40960
v_mfma_f32_16x16x32_bf16 v[244:247], a[56:59], a[96:99], v[244:247]
s_add_u32 s64, s74, 896
ds_read_b64_tr_b16 a[86:87], v5 offset:41984
v_mfma_f32_16x16x32_bf16 v[244:247], a[60:63], a[100:103], v[244:247]
s_add_u32 s65, s79, 25600
buffer_load_dwordx4 v22, s[48:51], s64 offen lds
v_mfma_f32_16x16x32_bf16 v[236:239], a[52:55], a[100:103], v[236:239]
buffer_store_dwordx4 a[196:199], v16, s[44:47], s65 offen sc1
v_mfma_f32_16x16x32_bf16 v[236:239], a[48:51], a[96:99], v[236:239]
ds_read_b64_tr_b16 a[88:89], v6 offset:32768
v_add_u32 v19, 0x8000, v19
v_mfma_f32_16x16x32_bf16 v[228:231], a[40:43], a[96:99], v[228:231]
ds_read_b64_tr_b16 a[90:91], v6 offset:33792
v_mfma_f32_16x16x32_bf16 v[228:231], a[44:47], a[100:103], v[228:231]
ds_read_b64_tr_b16 a[92:93], v6 offset:40960
v_mfma_f32_16x16x32_bf16 v[220:223], a[36:39], a[100:103], v[220:223]
ds_read_b64_tr_b16 a[94:95], v6 offset:41984
v_mfma_f32_16x16x32_bf16 v[220:223], a[32:35], a[96:99], v[220:223]
s_waitcnt lgkmcnt(7)
ds_read_b64_tr_b16 a[96:97], v7 offset:32768
v_mfma_f32_16x16x32_bf16 v[152:155], a[104:107], a[32:35], v[152:155]
ds_read_b64_tr_b16 a[98:99], v7 offset:33792
v_mfma_f32_16x16x32_bf16 v[152:155], a[108:111], a[36:39], v[152:155]
ds_read_b64_tr_b16 a[100:101], v7 offset:40960
v_add_u32 v20, 0x8000, v20
v_mfma_f32_16x16x32_bf16 v[160:163], a[108:111], a[44:47], v[160:163]
s_add_u32 m0, s76, 32768
ds_read_b64_tr_b16 a[102:103], v7 offset:41984
v_mfma_f32_16x16x32_bf16 v[160:163], a[104:107], a[40:43], v[160:163]
s_add_u32 s64, s72, 896
v_mfma_f32_16x16x32_bf16 v[168:171], a[104:107], a[48:51], v[168:171]
buffer_load_dwordx4 v12, s[48:51], s64 offen lds
v_mfma_f32_16x16x32_bf16 v[168:171], a[108:111], a[52:55], v[168:171]
v_mfma_f32_16x16x32_bf16 v[176:179], a[108:111], a[60:63], v[176:179]
v_mfma_f32_16x16x32_bf16 v[176:179], a[104:107], a[56:59], v[176:179]
s_add_u32 m0, s76, 33792
ds_read_b64_tr_b16 a[104:105], v8 offset:32768
v_mfma_f32_16x16x32_bf16 v[180:183], a[112:115], a[56:59], v[180:183]
s_add_u32 s64, s72, 17280
ds_read_b64_tr_b16 a[106:107], v8 offset:33792
v_mfma_f32_16x16x32_bf16 v[180:183], a[116:119], a[60:63], v[180:183]
buffer_load_dwordx4 v13, s[48:51], s64 offen lds
v_mfma_f32_16x16x32_bf16 v[172:175], a[116:119], a[52:55], v[172:175]
ds_read_b64_tr_b16 a[108:109], v8 offset:40960
v_add_u32 v4, 0x8000, v4
v_mfma_f32_16x16x32_bf16 v[172:175], a[112:115], a[48:51], v[172:175]
ds_read_b64_tr_b16 a[110:111], v8 offset:41984
v_mfma_f32_16x16x32_bf16 v[164:167], a[112:115], a[40:43], v[164:167]
v_mfma_f32_16x16x32_bf16 v[164:167], a[116:119], a[44:47], v[164:167]
s_add_u32 m0, s76, 34816
v_mfma_f32_16x16x32_bf16 v[156:159], a[116:119], a[36:39], v[156:159]
s_add_u32 s64, s72, 131968
v_mfma_f32_16x16x32_bf16 v[156:159], a[112:115], a[32:35], v[156:159]
buffer_load_dwordx4 v12, s[48:51], s64 offen lds
v_mfma_f32_16x16x32_bf16 v[24:27], a[72:75], a[32:35], v[24:27]
ds_read_b64_tr_b16 a[112:113], v9 offset:32768
v_mfma_f32_16x16x32_bf16 v[24:27], a[76:79], a[36:39], v[24:27]
ds_read_b64_tr_b16 a[114:115], v9 offset:33792
v_add_u32 v5, 0x8000, v5
v_mfma_f32_16x16x32_bf16 v[40:43], a[76:79], a[44:47], v[40:43]
s_waitcnt vmcnt(13)
s_add_u32 m0, s76, 35840
ds_read_b64_tr_b16 a[116:117], v9 offset:40960
v_mfma_f32_16x16x32_bf16 v[40:43], a[72:75], a[40:43], v[40:43]
s_add_u32 s64, s72, 148352
ds_read_b64_tr_b16 a[118:119], v9 offset:41984
v_mfma_f32_16x16x32_bf16 v[56:59], a[72:75], a[48:51], v[56:59]
buffer_load_dwordx4 v13, s[48:51], s64 offen lds
v_mfma_f32_16x16x32_bf16 v[56:59], a[76:79], a[52:55], v[56:59]
ds_read_b128 a[0:3], v2 offset:0
v_mfma_f32_16x16x32_bf16 v[72:75], a[76:79], a[60:63], v[72:75]
ds_read_b128 a[4:7], v3 offset:0
v_mfma_f32_16x16x32_bf16 v[72:75], a[72:75], a[56:59], v[72:75]
s_waitcnt lgkmcnt(6)
ds_read_b128 a[8:11], v2 offset:2048
v_mfma_f32_16x16x32_bf16 v[136:139], a[80:83], a[56:59], v[136:139]
s_add_u32 m0, s76, 36864
ds_read_b128 a[12:15], v3 offset:2048
v_mfma_f32_16x16x32_bf16 v[136:139], a[84:87], a[60:63], v[136:139]
s_add_u32 s64, s73, 896
ds_read_b128 a[16:19], v2 offset:4096
v_add_u32 v6, 0x8000, v6
v_mfma_f32_16x16x32_bf16 v[120:123], a[84:87], a[52:55], v[120:123]
buffer_load_dwordx4 v12, s[48:51], s64 offen lds
v_mfma_f32_16x16x32_bf16 v[120:123], a[80:83], a[48:51], v[120:123]
ds_read_b128 a[20:23], v3 offset:4096
v_mfma_f32_16x16x32_bf16 v[104:107], a[80:83], a[40:43], v[104:107]
ds_read_b128 a[24:27], v2 offset:6144
v_mfma_f32_16x16x32_bf16 v[104:107], a[84:87], a[44:47], v[104:107]
s_add_u32 m0, s76, 37888
ds_read_b128 a[28:31], v3 offset:6144
v_mfma_f32_16x16x32_bf16 v[88:91], a[84:87], a[36:39], v[88:91]
s_add_u32 s64, s73, 17280
ds_read_b64_tr_b16 a[72:73], v10 offset:32768
v_mfma_f32_16x16x32_bf16 v[88:91], a[80:83], a[32:35], v[88:91]
s_add_u32 s65, s79, 9216
buffer_load_dwordx4 v13, s[48:51], s64 offen lds
v_mfma_f32_16x16x32_bf16 v[28:31], a[88:91], a[32:35], v[28:31]
buffer_store_dwordx4 a[200:203], v16, s[44:47], s65 offen sc1
v_mfma_f32_16x16x32_bf16 v[28:31], a[92:95], a[36:39], v[28:31]
ds_read_b64_tr_b16 a[74:75], v10 offset:33792
v_add_u32 v7, 0x8000, v7
v_mfma_f32_16x16x32_bf16 v[44:47], a[92:95], a[44:47], v[44:47]
ds_read_b64_tr_b16 a[76:77], v10 offset:40960
v_mfma_f32_16x16x32_bf16 v[44:47], a[88:91], a[40:43], v[44:47]
s_add_u32 m0, s76, 38912
ds_read_b64_tr_b16 a[78:79], v10 offset:41984
v_mfma_f32_16x16x32_bf16 v[60:63], a[88:91], a[48:51], v[60:63]
s_add_u32 s64, s73, 131968
ds_read_b64_tr_b16 a[80:81], v11 offset:32768
v_mfma_f32_16x16x32_bf16 v[60:63], a[92:95], a[52:55], v[60:63]
buffer_load_dwordx4 v12, s[48:51], s64 offen lds
v_mfma_f32_16x16x32_bf16 v[76:79], a[92:95], a[60:63], v[76:79]
ds_read_b64_tr_b16 a[82:83], v11 offset:33792
v_mfma_f32_16x16x32_bf16 v[76:79], a[88:91], a[56:59], v[76:79]
ds_read_b64_tr_b16 a[84:85], v11 offset:40960
v_mfma_f32_16x16x32_bf16 v[140:143], a[96:99], a[56:59], v[140:143]
s_add_u32 m0, s76, 39936
ds_read_b64_tr_b16 a[86:87], v11 offset:41984
v_mfma_f32_16x16x32_bf16 v[140:143], a[100:103], a[60:63], v[140:143]
s_add_u32 s64, s73, 148352
v_add_u32 v8, 0x8000, v8
v_mfma_f32_16x16x32_bf16 v[124:127], a[100:103], a[52:55], v[124:127]
buffer_load_dwordx4 v13, s[48:51], s64 offen lds
v_mfma_f32_16x16x32_bf16 v[124:127], a[96:99], a[48:51], v[124:127]
v_mfma_f32_16x16x32_bf16 v[108:111], a[96:99], a[40:43], v[108:111]
v_mfma_f32_16x16x32_bf16 v[108:111], a[100:103], a[44:47], v[108:111]
v_mfma_f32_16x16x32_bf16 v[92:95], a[100:103], a[36:39], v[92:95]
v_add_u32 v9, 0x8000, v9
v_add_u32 v10, 0x8000, v10
v_mfma_f32_16x16x32_bf16 v[92:95], a[96:99], a[32:35], v[92:95]
v_add_u32 v11, 0x8000, v11
v_mfma_f32_16x16x32_bf16 v[32:35], a[104:107], a[32:35], v[32:35]
v_mfma_f32_16x16x32_bf16 v[32:35], a[108:111], a[36:39], v[32:35]
v_mfma_f32_16x16x32_bf16 v[48:51], a[108:111], a[44:47], v[48:51]
s_waitcnt lgkmcnt(0)
s_barrier
v_mfma_f32_16x16x32_bf16 v[48:51], a[104:107], a[40:43], v[48:51]
s_add_u32 m0, s77, 98304
ds_read_b64_tr_b16 a[88:89], v19 offset:36864
v_mfma_f32_16x16x32_bf16 v[64:67], a[104:107], a[48:51], v[64:67]
s_add_u32 s64, s71, 4194304
ds_read_b64_tr_b16 a[90:91], v19 offset:37120
v_mfma_f32_16x16x32_bf16 v[64:67], a[108:111], a[52:55], v[64:67]
buffer_load_dwordx4 v14, s[56:59], s64 offen lds
v_mfma_f32_16x16x32_bf16 v[80:83], a[108:111], a[60:63], v[80:83]
ds_read_b64_tr_b16 a[92:93], v19 offset:38912
v_mfma_f32_16x16x32_bf16 v[80:83], a[104:107], a[56:59], v[80:83]
ds_read_b64_tr_b16 a[94:95], v19 offset:39168
v_mfma_f32_16x16x32_bf16 v[144:147], a[112:115], a[56:59], v[144:147]
ds_read_b128 a[64:67], v17 offset:32768
v_mfma_f32_16x16x32_bf16 v[144:147], a[116:119], a[60:63], v[144:147]
ds_read_b128 a[68:71], v18 offset:32768
v_mfma_f32_16x16x32_bf16 v[128:131], a[116:119], a[52:55], v[128:131]
ds_read_b64_tr_b16 a[96:97], v21 offset:36864
v_mfma_f32_16x16x32_bf16 v[128:131], a[112:115], a[48:51], v[128:131]
s_add_u32 m0, s78, 114688
ds_read_b64_tr_b16 a[98:99], v21 offset:37120
v_mfma_f32_16x16x32_bf16 v[112:115], a[112:115], a[40:43], v[112:115]
s_add_u32 s64, s75, 3145728
ds_read_b64_tr_b16 a[100:101], v21 offset:38912
v_mfma_f32_16x16x32_bf16 v[112:115], a[116:119], a[44:47], v[112:115]
buffer_load_dwordx4 v23, s[60:63], s64 offen lds
v_mfma_f32_16x16x32_bf16 v[96:99], a[116:119], a[36:39], v[96:99]
ds_read_b64_tr_b16 a[102:103], v21 offset:39168
v_mfma_f32_16x16x32_bf16 v[96:99], a[112:115], a[32:35], v[96:99]
ds_read_b64_tr_b16 a[104:105], v20 offset:36864
v_mfma_f32_16x16x32_bf16 v[36:39], a[72:75], a[32:35], v[36:39]
ds_read_b64_tr_b16 a[106:107], v20 offset:37120
v_mfma_f32_16x16x32_bf16 v[36:39], a[76:79], a[36:39], v[36:39]
ds_read_b64_tr_b16 a[108:109], v20 offset:38912
v_mfma_f32_16x16x32_bf16 v[52:55], a[76:79], a[44:47], v[52:55]
ds_read_b64_tr_b16 a[110:111], v20 offset:39168
v_mfma_f32_16x16x32_bf16 v[52:55], a[72:75], a[40:43], v[52:55]
s_add_u32 m0, s77, 99328
ds_read_b64_tr_b16 a[112:113], v19 offset:40960
v_mfma_f32_16x16x32_bf16 v[68:71], a[72:75], a[48:51], v[68:71]
s_add_u32 s64, s71, 4227072
ds_read_b64_tr_b16 a[114:115], v19 offset:41216
v_mfma_f32_16x16x32_bf16 v[68:71], a[76:79], a[52:55], v[68:71]
buffer_load_dwordx4 v14, s[56:59], s64 offen lds
v_mfma_f32_16x16x32_bf16 v[84:87], a[76:79], a[60:63], v[84:87]
s_add_u32 s65, s79, 26624
ds_read_b64_tr_b16 a[116:117], v19 offset:43008
v_mfma_f32_16x16x32_bf16 v[84:87], a[72:75], a[56:59], v[84:87]
buffer_store_dwordx4 a[204:207], v16, s[44:47], s65 offen sc1
v_mfma_f32_16x16x32_bf16 v[148:151], a[80:83], a[56:59], v[148:151]
ds_read_b64_tr_b16 a[118:119], v19 offset:43264
v_mfma_f32_16x16x32_bf16 v[148:151], a[84:87], a[60:63], v[148:151]
ds_read_b64_tr_b16 a[72:73], v21 offset:40960
v_mfma_f32_16x16x32_bf16 v[132:135], a[84:87], a[52:55], v[132:135]
ds_read_b64_tr_b16 a[74:75], v21 offset:41216
v_mfma_f32_16x16x32_bf16 v[132:135], a[80:83], a[48:51], v[132:135]
s_add_u32 m0, s78, 118784
ds_read_b64_tr_b16 a[76:77], v21 offset:43008
v_mfma_f32_16x16x32_bf16 v[116:119], a[80:83], a[40:43], v[116:119]
s_add_u32 s64, s75, 3147776
ds_read_b64_tr_b16 a[78:79], v21 offset:43264
v_mfma_f32_16x16x32_bf16 v[116:119], a[84:87], a[44:47], v[116:119]
buffer_load_dwordx4 v23, s[60:63], s64 offen lds
v_mfma_f32_16x16x32_bf16 v[100:103], a[84:87], a[36:39], v[100:103]
v_mfma_f32_16x16x32_bf16 v[100:103], a[80:83], a[32:35], v[100:103]
s_waitcnt lgkmcnt(6)
ds_read_b64_tr_b16 a[80:81], v20 offset:40960
v_mfma_f32_16x16x32_bf16 v[184:187], a[88:91], a[0:3], v[184:187]
ds_read_b64_tr_b16 a[82:83], v20 offset:41216
v_mfma_f32_16x16x32_bf16 v[184:187], a[92:95], a[4:7], v[184:187]
s_add_u32 s17, s78, .-L_pc+6144
ds_read_b64_tr_b16 a[84:85], v20 offset:43008
v_subrev_u32 v17, 0x8000, v17
v_mfma_f32_16x16x32_bf16 v[192:195], a[92:95], a[12:15], v[192:195]
s_add_u32 m0, s77, 100352
ds_read_b64_tr_b16 a[86:87], v20 offset:43264
v_subrev_u32 v18, 0x8000, v18
v_mfma_f32_16x16x32_bf16 v[192:195], a[88:91], a[8:11], v[192:195]
s_cmp_eq_u32 s30, 0
s_cselect_b32 s81, 256, 0
s_cselect_b32 s82, 8, 0
v_mfma_f32_16x16x32_bf16 v[200:203], a[88:91], a[16:19], v[200:203]
s_add_u32 s64, s71, 4259840
buffer_load_dword a252, v16, s[88:91], s17 offen
v_mfma_f32_16x16x32_bf16 v[200:203], a[92:95], a[20:23], v[200:203]
buffer_load_dwordx4 v15, s[56:59], s64 offen lds
v_mfma_f32_16x16x32_bf16 v[208:211], a[92:95], a[28:31], v[208:211]
v_mfma_f32_16x16x32_bf16 v[208:211], a[88:91], a[24:27], v[208:211]
ds_read_b64_tr_b16 a[88:89], v19 offset:32768
v_mfma_f32_16x16x32_bf16 v[248:251], a[96:99], a[64:67], v[248:251]
ds_read_b64_tr_b16 a[90:91], v19 offset:33024
v_mfma_f32_16x16x32_bf16 v[248:251], a[100:103], a[68:71], v[248:251]
ds_read_b64_tr_b16 a[92:93], v19 offset:34816
v_mfma_f32_16x16x32_bf16 v[212:215], a[108:111], a[28:31], v[212:215]
ds_read_b64_tr_b16 a[94:95], v19 offset:35072
v_mfma_f32_16x16x32_bf16 v[212:215], a[104:107], a[24:27], v[212:215]
s_add_u32 m0, s78, 122880
ds_read_b64_tr_b16 a[96:97], v20 offset:32768
v_mfma_f32_16x16x32_bf16 v[204:207], a[104:107], a[16:19], v[204:207]
s_add_u32 s64, s75, 3149824
ds_read_b64_tr_b16 a[98:99], v20 offset:33024
v_mfma_f32_16x16x32_bf16 v[204:207], a[108:111], a[20:23], v[204:207]
buffer_load_dwordx4 v23, s[60:63], s64 offen lds
v_mfma_f32_16x16x32_bf16 v[196:199], a[108:111], a[12:15], v[196:199]
ds_read_b64_tr_b16 a[100:101], v20 offset:34816
v_mfma_f32_16x16x32_bf16 v[196:199], a[104:107], a[8:11], v[196:199]
ds_read_b64_tr_b16 a[102:103], v20 offset:35072
v_mfma_f32_16x16x32_bf16 v[188:191], a[104:107], a[0:3], v[188:191]
v_mfma_f32_16x16x32_bf16 v[188:191], a[108:111], a[4:7], v[188:191]
s_waitcnt lgkmcnt(7)
ds_read_b64_tr_b16 a[104:105], v4 offset:32768
v_mfma_f32_16x16x32_bf16 v[216:219], a[4:7], a[116:119], v[216:219]
ds_read_b64_tr_b16 a[106:107], v4 offset:33792
v_mfma_f32_16x16x32_bf16 v[216:219], a[0:3], a[112:115], v[216:219]
s_add_u32 m0, s77, 101376
ds_read_b64_tr_b16 a[108:109], v4 offset:40960
v_subrev_u32 v21, 0x8000, v21
v_mfma_f32_16x16x32_bf16 v[224:227], a[8:11], a[112:115], v[224:227]
s_add_u32 s64, s71, 4292608
ds_read_b64_tr_b16 a[110:111], v4 offset:41984
v_mfma_f32_16x16x32_bf16 v[224:227], a[12:15], a[116:119], v[224:227]
buffer_load_dwordx4 v15, s[56:59], s64 offen lds
v_mfma_f32_16x16x32_bf16 v[232:235], a[20:23], a[116:119], v[232:235]
v_mfma_f32_16x16x32_bf16 v[232:235], a[16:19], a[112:115], v[232:235]
v_mfma_f32_16x16x32_bf16 v[240:243], a[24:27], a[112:115], v[240:243]
v_mfma_f32_16x16x32_bf16 v[240:243], a[28:31], a[116:119], v[240:243]
ds_read_b64_tr_b16 a[112:113], v5 offset:32768
v_mfma_f32_16x16x32_bf16 v[252:255], a[68:71], a[76:79], v[252:255]
ds_read_b64_tr_b16 a[114:115], v5 offset:33792
v_mfma_f32_16x16x32_bf16 v[252:255], a[64:67], a[72:75], v[252:255]
s_add_u32 m0, s78, 126976
ds_read_b64_tr_b16 a[116:117], v5 offset:40960
v_mfma_f32_16x16x32_bf16 v[244:247], a[24:27], a[80:83], v[244:247]
s_add_u32 s64, s74, 1024
ds_read_b64_tr_b16 a[118:119], v5 offset:41984
v_mfma_f32_16x16x32_bf16 v[244:247], a[28:31], a[84:87], v[244:247]
s_add_u32 s65, s79, 27648
buffer_load_dwordx4 v22, s[48:51], s64 offen lds
v_mfma_f32_16x16x32_bf16 v[236:239], a[20:23], a[84:87], v[236:239]
buffer_store_dwordx4 a[208:211], v16, s[44:47], s65 offen sc1
v_mfma_f32_16x16x32_bf16 v[236:239], a[16:19], a[80:83], v[236:239]
ds_read_b64_tr_b16 a[72:73], v6 offset:32768
v_subrev_u32 v19, 0x8000, v19
v_mfma_f32_16x16x32_bf16 v[228:231], a[8:11], a[80:83], v[228:231]
ds_read_b64_tr_b16 a[74:75], v6 offset:33792
v_mfma_f32_16x16x32_bf16 v[228:231], a[12:15], a[84:87], v[228:231]
ds_read_b64_tr_b16 a[76:77], v6 offset:40960
v_mfma_f32_16x16x32_bf16 v[220:223], a[4:7], a[84:87], v[220:223]
ds_read_b64_tr_b16 a[78:79], v6 offset:41984
v_mfma_f32_16x16x32_bf16 v[220:223], a[0:3], a[80:83], v[220:223]
s_waitcnt lgkmcnt(7)
ds_read_b64_tr_b16 a[80:81], v7 offset:32768
v_mfma_f32_16x16x32_bf16 v[152:155], a[88:91], a[0:3], v[152:155]
ds_read_b64_tr_b16 a[82:83], v7 offset:33792
v_mfma_f32_16x16x32_bf16 v[152:155], a[92:95], a[4:7], v[152:155]
ds_read_b64_tr_b16 a[84:85], v7 offset:40960
v_subrev_u32 v20, 0x8000, v20
v_mfma_f32_16x16x32_bf16 v[160:163], a[92:95], a[12:15], v[160:163]
s_add_u32 m0, s76, 0
ds_read_b64_tr_b16 a[86:87], v7 offset:41984
v_mfma_f32_16x16x32_bf16 v[160:163], a[88:91], a[8:11], v[160:163]
s_add_u32 s64, s72, 1024
v_mfma_f32_16x16x32_bf16 v[168:171], a[88:91], a[16:19], v[168:171]
buffer_load_dwordx4 v12, s[48:51], s64 offen lds
v_mfma_f32_16x16x32_bf16 v[168:171], a[92:95], a[20:23], v[168:171]
v_mfma_f32_16x16x32_bf16 v[176:179], a[92:95], a[28:31], v[176:179]
v_mfma_f32_16x16x32_bf16 v[176:179], a[88:91], a[24:27], v[176:179]
s_add_u32 m0, s76, 1024
ds_read_b64_tr_b16 a[88:89], v8 offset:32768
v_mfma_f32_16x16x32_bf16 v[180:183], a[96:99], a[24:27], v[180:183]
s_add_u32 s64, s72, 17408
ds_read_b64_tr_b16 a[90:91], v8 offset:33792
v_mfma_f32_16x16x32_bf16 v[180:183], a[100:103], a[28:31], v[180:183]
buffer_load_dwordx4 v13, s[48:51], s64 offen lds
v_mfma_f32_16x16x32_bf16 v[172:175], a[100:103], a[20:23], v[172:175]
ds_read_b64_tr_b16 a[92:93], v8 offset:40960
v_subrev_u32 v4, 0x8000, v4
v_mfma_f32_16x16x32_bf16 v[172:175], a[96:99], a[16:19], v[172:175]
ds_read_b64_tr_b16 a[94:95], v8 offset:41984
v_mfma_f32_16x16x32_bf16 v[164:167], a[96:99], a[8:11], v[164:167]
v_mfma_f32_16x16x32_bf16 v[164:167], a[100:103], a[12:15], v[164:167]
s_add_u32 m0, s76, 2048
v_mfma_f32_16x16x32_bf16 v[156:159], a[100:103], a[4:7], v[156:159]
s_add_u32 s64, s72, 132096
v_mfma_f32_16x16x32_bf16 v[156:159], a[96:99], a[0:3], v[156:159]
buffer_load_dwordx4 v12, s[48:51], s64 offen lds
v_mfma_f32_16x16x32_bf16 v[24:27], a[104:107], a[0:3], v[24:27]
ds_read_b64_tr_b16 a[96:97], v9 offset:32768
v_mfma_f32_16x16x32_bf16 v[24:27], a[108:111], a[4:7], v[24:27]
ds_read_b64_tr_b16 a[98:99], v9 offset:33792
v_subrev_u32 v5, 0x8000, v5
v_mfma_f32_16x16x32_bf16 v[40:43], a[108:111], a[12:15], v[40:43]
s_waitcnt vmcnt(14)
s_add_u32 m0, s76, 3072
ds_read_b64_tr_b16 a[100:101], v9 offset:40960
v_mfma_f32_16x16x32_bf16 v[40:43], a[104:107], a[8:11], v[40:43]
s_add_u32 s64, s72, 148480
ds_read_b64_tr_b16 a[102:103], v9 offset:41984
v_mfma_f32_16x16x32_bf16 v[56:59], a[104:107], a[16:19], v[56:59]
buffer_load_dwordx4 v13, s[48:51], s64 offen lds
v_mfma_f32_16x16x32_bf16 v[56:59], a[108:111], a[20:23], v[56:59]
ds_read_b128 a[32:35], v2 offset:32768
v_mfma_f32_16x16x32_bf16 v[72:75], a[108:111], a[28:31], v[72:75]
ds_read_b128 a[36:39], v3 offset:32768
v_mfma_f32_16x16x32_bf16 v[72:75], a[104:107], a[24:27], v[72:75]
s_waitcnt lgkmcnt(6)
ds_read_b128 a[40:43], v2 offset:34816
v_mfma_f32_16x16x32_bf16 v[136:139], a[112:115], a[24:27], v[136:139]
s_add_u32 m0, s76, 4096
ds_read_b128 a[44:47], v3 offset:34816
v_mfma_f32_16x16x32_bf16 v[136:139], a[116:119], a[28:31], v[136:139]
s_add_u32 s64, s73, 1024
ds_read_b128 a[48:51], v2 offset:36864
v_subrev_u32 v6, 0x8000, v6
v_mfma_f32_16x16x32_bf16 v[120:123], a[116:119], a[20:23], v[120:123]
buffer_load_dwordx4 v12, s[48:51], s64 offen lds
v_mfma_f32_16x16x32_bf16 v[120:123], a[112:115], a[16:19], v[120:123]
ds_read_b128 a[52:55], v3 offset:36864
v_mfma_f32_16x16x32_bf16 v[104:107], a[112:115], a[8:11], v[104:107]
ds_read_b128 a[56:59], v2 offset:38912
v_mfma_f32_16x16x32_bf16 v[104:107], a[116:119], a[12:15], v[104:107]
s_add_u32 m0, s76, 5120
ds_read_b128 a[60:63], v3 offset:38912
v_mfma_f32_16x16x32_bf16 v[88:91], a[116:119], a[4:7], v[88:91]
s_add_u32 s64, s73, 17408
ds_read_b64_tr_b16 a[104:105], v10 offset:32768
v_mfma_f32_16x16x32_bf16 v[88:91], a[112:115], a[0:3], v[88:91]
s_add_u32 s65, s79, 11264
buffer_load_dwordx4 v13, s[48:51], s64 offen lds
v_mfma_f32_16x16x32_bf16 v[28:31], a[72:75], a[0:3], v[28:31]
buffer_store_dwordx4 a[212:215], v16, s[44:47], s65 offen sc1
v_mfma_f32_16x16x32_bf16 v[28:31], a[76:79], a[4:7], v[28:31]
ds_read_b64_tr_b16 a[106:107], v10 offset:33792
v_subrev_u32 v7, 0x8000, v7
v_mfma_f32_16x16x32_bf16 v[44:47], a[76:79], a[12:15], v[44:47]
ds_read_b64_tr_b16 a[108:109], v10 offset:40960
v_mfma_f32_16x16x32_bf16 v[44:47], a[72:75], a[8:11], v[44:47]
s_add_u32 m0, s76, 6144
ds_read_b64_tr_b16 a[110:111], v10 offset:41984
v_mfma_f32_16x16x32_bf16 v[60:63], a[72:75], a[16:19], v[60:63]
s_add_u32 s64, s73, 132096
buffer_load_dword v1, off, s[52:55], s78 sc1
v_mfma_f32_16x16x32_bf16 v[60:63], a[76:79], a[20:23], v[60:63]
buffer_load_dwordx4 v12, s[48:51], s64 offen lds
v_mfma_f32_16x16x32_bf16 v[76:79], a[76:79], a[28:31], v[76:79]
ds_read_b64_tr_b16 a[112:113], v11 offset:32768
v_mfma_f32_16x16x32_bf16 v[76:79], a[72:75], a[24:27], v[76:79]
ds_read_b64_tr_b16 a[114:115], v11 offset:33792
v_mfma_f32_16x16x32_bf16 v[140:143], a[80:83], a[24:27], v[140:143]
s_add_u32 m0, s76, 7168
ds_read_b64_tr_b16 a[116:117], v11 offset:40960
v_mfma_f32_16x16x32_bf16 v[140:143], a[84:87], a[28:31], v[140:143]
s_add_u32 s64, s73, 148480
ds_read_b64_tr_b16 a[118:119], v11 offset:41984
v_subrev_u32 v8, 0x8000, v8
v_mfma_f32_16x16x32_bf16 v[124:127], a[84:87], a[20:23], v[124:127]
buffer_load_dwordx4 v13, s[48:51], s64 offen lds
v_mfma_f32_16x16x32_bf16 v[124:127], a[80:83], a[16:19], v[124:127]
v_mfma_f32_16x16x32_bf16 v[108:111], a[80:83], a[8:11], v[108:111]
v_mfma_f32_16x16x32_bf16 v[108:111], a[84:87], a[12:15], v[108:111]
v_mfma_f32_16x16x32_bf16 v[92:95], a[84:87], a[4:7], v[92:95]
v_subrev_u32 v9, 0x8000, v9
v_subrev_u32 v10, 0x8000, v10
v_mfma_f32_16x16x32_bf16 v[92:95], a[80:83], a[0:3], v[92:95]
v_subrev_u32 v11, 0x8000, v11
v_mfma_f32_16x16x32_bf16 v[32:35], a[88:91], a[0:3], v[32:35]
v_mfma_f32_16x16x32_bf16 v[32:35], a[92:95], a[4:7], v[32:35]
v_mfma_f32_16x16x32_bf16 v[48:51], a[92:95], a[12:15], v[48:51]
s_waitcnt lgkmcnt(0)
s_barrier
v_mfma_f32_16x16x32_bf16 v[48:51], a[88:91], a[8:11], v[48:51]
s_add_u32 m0, s77, 131072
ds_read_b64_tr_b16 a[72:73], v19 offset:4096
v_mfma_f32_16x16x32_bf16 v[64:67], a[88:91], a[16:19], v[64:67]
s_add_u32 s64, s71, 4718592
ds_read_b64_tr_b16 a[74:75], v19 offset:4352
v_mfma_f32_16x16x32_bf16 v[64:67], a[92:95], a[20:23], v[64:67]
buffer_load_dwordx4 v14, s[56:59], s64 offen lds
v_mfma_f32_16x16x32_bf16 v[80:83], a[92:95], a[28:31], v[80:83]
ds_read_b64_tr_b16 a[76:77], v19 offset:6144
v_mfma_f32_16x16x32_bf16 v[80:83], a[88:91], a[24:27], v[80:83]
ds_read_b64_tr_b16 a[78:79], v19 offset:6400
v_mfma_f32_16x16x32_bf16 v[144:147], a[96:99], a[24:27], v[144:147]
ds_read_b128 a[64:67], v17 offset:0
v_mfma_f32_16x16x32_bf16 v[144:147], a[100:103], a[28:31], v[144:147]
ds_read_b128 a[68:71], v18 offset:0
v_mfma_f32_16x16x32_bf16 v[128:131], a[100:103], a[20:23], v[128:131]
ds_read_b64_tr_b16 a[80:81], v21 offset:4096
v_mfma_f32_16x16x32_bf16 v[128:131], a[96:99], a[16:19], v[128:131]
s_add_u32 m0, s78, 147456
ds_read_b64_tr_b16 a[82:83], v21 offset:4352
v_mfma_f32_16x16x32_bf16 v[112:115], a[96:99], a[8:11], v[112:115]
s_add_u32 s64, s75, 3538944
ds_read_b64_tr_b16 a[84:85], v21 offset:6144
v_mfma_f32_16x16x32_bf16 v[112:115], a[100:103], a[12:15], v[112:115]
buffer_load_dwordx4 v23, s[60:63], s64 offen lds
v_mfma_f32_16x16x32_bf16 v[96:99], a[100:103], a[4:7], v[96:99]
ds_read_b64_tr_b16 a[86:87], v21 offset:6400
v_mfma_f32_16x16x32_bf16 v[96:99], a[96:99], a[0:3], v[96:99]
ds_read_b64_tr_b16 a[88:89], v20 offset:4096
v_mfma_f32_16x16x32_bf16 v[36:39], a[104:107], a[0:3], v[36:39]
ds_read_b64_tr_b16 a[90:91], v20 offset:4352
v_mfma_f32_16x16x32_bf16 v[36:39], a[108:111], a[4:7], v[36:39]
ds_read_b64_tr_b16 a[92:93], v20 offset:6144
v_mfma_f32_16x16x32_bf16 v[52:55], a[108:111], a[12:15], v[52:55]
ds_read_b64_tr_b16 a[94:95], v20 offset:6400
v_mfma_f32_16x16x32_bf16 v[52:55], a[104:107], a[8:11], v[52:55]
s_add_u32 m0, s77, 132096
ds_read_b64_tr_b16 a[96:97], v19 offset:8192
v_mfma_f32_16x16x32_bf16 v[68:71], a[104:107], a[16:19], v[68:71]
s_add_u32 s64, s71, 4751360
ds_read_b64_tr_b16 a[98:99], v19 offset:8448
v_mfma_f32_16x16x32_bf16 v[68:71], a[108:111], a[20:23], v[68:71]
s_add_u32 s65, s79, 28672
buffer_load_dwordx4 v14, s[56:59], s64 offen lds
v_mfma_f32_16x16x32_bf16 v[84:87], a[108:111], a[28:31], v[84:87]
buffer_store_dwordx4 a[216:219], v16, s[44:47], s65 offen sc1
v_mfma_f32_16x16x32_bf16 v[84:87], a[104:107], a[24:27], v[84:87]
ds_read_b64_tr_b16 a[100:101], v19 offset:10240
v_mfma_f32_16x16x32_bf16 v[148:151], a[112:115], a[24:27], v[148:151]
ds_read_b64_tr_b16 a[102:103], v19 offset:10496
v_mfma_f32_16x16x32_bf16 v[148:151], a[116:119], a[28:31], v[148:151]
ds_read_b64_tr_b16 a[104:105], v21 offset:8192
v_mfma_f32_16x16x32_bf16 v[132:135], a[116:119], a[20:23], v[132:135]
ds_read_b64_tr_b16 a[106:107], v21 offset:8448
v_mfma_f32_16x16x32_bf16 v[132:135], a[112:115], a[16:19], v[132:135]
s_add_u32 m0, s78, 151552
ds_read_b64_tr_b16 a[108:109], v21 offset:10240
v_mfma_f32_16x16x32_bf16 v[116:119], a[112:115], a[8:11], v[116:119]
s_add_u32 s64, s75, 3540992
ds_read_b64_tr_b16 a[110:111], v21 offset:10496
v_mfma_f32_16x16x32_bf16 v[116:119], a[116:119], a[12:15], v[116:119]
buffer_load_dwordx4 v23, s[60:63], s64 offen lds
v_mfma_f32_16x16x32_bf16 v[100:103], a[116:119], a[4:7], v[100:103]
v_mfma_f32_16x16x32_bf16 v[100:103], a[112:115], a[0:3], v[100:103]
s_waitcnt lgkmcnt(6)
ds_read_b64_tr_b16 a[112:113], v20 offset:8192
v_mfma_f32_16x16x32_bf16 v[184:187], a[72:75], a[32:35], v[184:187]
ds_read_b64_tr_b16 a[114:115], v20 offset:8448
v_mfma_f32_16x16x32_bf16 v[184:187], a[76:79], a[36:39], v[184:187]
ds_read_b64_tr_b16 a[116:117], v20 offset:10240
v_mfma_f32_16x16x32_bf16 v[192:195], a[76:79], a[44:47], v[192:195]
ds_read_b64_tr_b16 a[118:119], v20 offset:10496
v_mfma_f32_16x16x32_bf16 v[192:195], a[72:75], a[40:43], v[192:195]
s_add_u32 m0, s77, 133120
v_mfma_f32_16x16x32_bf16 v[200:203], a[72:75], a[48:51], v[200:203]
s_add_u32 s64, s71, 4784128
v_mfma_f32_16x16x32_bf16 v[200:203], a[76:79], a[52:55], v[200:203]
buffer_load_dwordx4 v15, s[56:59], s64 offen lds
v_mfma_f32_16x16x32_bf16 v[208:211], a[76:79], a[60:63], v[208:211]
v_mfma_f32_16x16x32_bf16 v[208:211], a[72:75], a[56:59], v[208:211]
ds_read_b64_tr_b16 a[72:73], v19 offset:0
v_mfma_f32_16x16x32_bf16 v[248:251], a[80:83], a[64:67], v[248:251]
ds_read_b64_tr_b16 a[74:75], v19 offset:256
v_mfma_f32_16x16x32_bf16 v[248:251], a[84:87], a[68:71], v[248:251]
ds_read_b64_tr_b16 a[76:77], v19 offset:2048
v_mfma_f32_16x16x32_bf16 v[212:215], a[92:95], a[60:63], v[212:215]
ds_read_b64_tr_b16 a[78:79], v19 offset:2304
v_mfma_f32_16x16x32_bf16 v[212:215], a[88:91], a[56:59], v[212:215]
s_add_u32 m0, s78, 155648
ds_read_b64_tr_b16 a[80:81], v20 offset:0
v_mfma_f32_16x16x32_bf16 v[204:207], a[88:91], a[48:51], v[204:207]
s_add_u32 s64, s75, 3543040
ds_read_b64_tr_b16 a[82:83], v20 offset:256
v_mfma_f32_16x16x32_bf16 v[204:207], a[92:95], a[52:55], v[204:207]
buffer_load_dwordx4 v23, s[60:63], s64 offen lds
v_mfma_f32_16x16x32_bf16 v[196:199], a[92:95], a[44:47], v[196:199]
ds_read_b64_tr_b16 a[84:85], v20 offset:2048
v_mfma_f32_16x16x32_bf16 v[196:199], a[88:91], a[40:43], v[196:199]
ds_read_b64_tr_b16 a[86:87], v20 offset:2304
v_mfma_f32_16x16x32_bf16 v[188:191], a[88:91], a[32:35], v[188:191]
v_mfma_f32_16x16x32_bf16 v[188:191], a[92:95], a[36:39], v[188:191]
s_waitcnt lgkmcnt(7)
ds_read_b64_tr_b16 a[88:89], v4 offset:0
v_mfma_f32_16x16x32_bf16 v[216:219], a[36:39], a[100:103], v[216:219]
ds_read_b64_tr_b16 a[90:91], v4 offset:1024
v_mfma_f32_16x16x32_bf16 v[216:219], a[32:35], a[96:99], v[216:219]
s_add_u32 m0, s77, 134144
ds_read_b64_tr_b16 a[92:93], v4 offset:8192
v_mfma_f32_16x16x32_bf16 v[224:227], a[40:43], a[96:99], v[224:227]
s_add_u32 s64, s71, 4816896
ds_read_b64_tr_b16 a[94:95], v4 offset:9216
v_mfma_f32_16x16x32_bf16 v[224:227], a[44:47], a[100:103], v[224:227]
buffer_load_dwordx4 v15, s[56:59], s64 offen lds
v_mfma_f32_16x16x32_bf16 v[232:235], a[52:55], a[100:103], v[232:235]
v_mfma_f32_16x16x32_bf16 v[232:235], a[48:51], a[96:99], v[232:235]
v_mfma_f32_16x16x32_bf16 v[240:243], a[56:59], a[96:99], v[240:243]
v_mfma_f32_16x16x32_bf16 v[240:243], a[60:63], a[100:103], v[240:243]
ds_read_b64_tr_b16 a[96:97], v5 offset:0
v_mfma_f32_16x16x32_bf16 v[252:255], a[68:71], a[108:111], v[252:255]
ds_read_b64_tr_b16 a[98:99], v5 offset:1024
v_mfma_f32_16x16x32_bf16 v[252:255], a[64:67], a[104:107], v[252:255]
s_add_u32 m0, s78, 159744
s_add_u32 s65, s79, 29696
ds_read_b64_tr_b16 a[100:101], v5 offset:8192
v_mfma_f32_16x16x32_bf16 v[244:247], a[56:59], a[112:115], v[244:247]
s_add_u32 s64, s74, 1152
buffer_store_dwordx4 a[220:223], v16, s[44:47], s65 offen sc1
v_mfma_f32_16x16x32_bf16 v[244:247], a[60:63], a[116:119], v[244:247]
buffer_load_dwordx4 v22, s[48:51], s64 offen lds
v_mfma_f32_16x16x32_bf16 v[236:239], a[52:55], a[116:119], v[236:239]
ds_read_b64_tr_b16 a[102:103], v5 offset:9216
v_mfma_f32_16x16x32_bf16 v[236:239], a[48:51], a[112:115], v[236:239]
ds_read_b64_tr_b16 a[104:105], v6 offset:0
v_mfma_f32_16x16x32_bf16 v[228:231], a[40:43], a[112:115], v[228:231]
ds_read_b64_tr_b16 a[106:107], v6 offset:1024
v_mfma_f32_16x16x32_bf16 v[228:231], a[44:47], a[116:119], v[228:231]
ds_read_b64_tr_b16 a[108:109], v6 offset:8192
v_mfma_f32_16x16x32_bf16 v[220:223], a[36:39], a[116:119], v[220:223]
ds_read_b64_tr_b16 a[110:111], v6 offset:9216
v_mfma_f32_16x16x32_bf16 v[220:223], a[32:35], a[112:115], v[220:223]
s_waitcnt lgkmcnt(7)
ds_read_b64_tr_b16 a[112:113], v7 offset:0
v_mfma_f32_16x16x32_bf16 v[152:155], a[72:75], a[32:35], v[152:155]
ds_read_b64_tr_b16 a[114:115], v7 offset:1024
v_mfma_f32_16x16x32_bf16 v[152:155], a[76:79], a[36:39], v[152:155]
ds_read_b64_tr_b16 a[116:117], v7 offset:8192
v_mfma_f32_16x16x32_bf16 v[160:163], a[76:79], a[44:47], v[160:163]
s_add_u32 m0, s76, 32768
ds_read_b64_tr_b16 a[118:119], v7 offset:9216
v_mfma_f32_16x16x32_bf16 v[160:163], a[72:75], a[40:43], v[160:163]
s_add_u32 s64, s72, 1152
v_mfma_f32_16x16x32_bf16 v[168:171], a[72:75], a[48:51], v[168:171]
buffer_load_dwordx4 v12, s[48:51], s64 offen lds
v_mfma_f32_16x16x32_bf16 v[168:171], a[76:79], a[52:55], v[168:171]
v_mfma_f32_16x16x32_bf16 v[176:179], a[76:79], a[60:63], v[176:179]
v_mfma_f32_16x16x32_bf16 v[176:179], a[72:75], a[56:59], v[176:179]
s_add_u32 m0, s76, 33792
ds_read_b64_tr_b16 a[72:73], v8 offset:0
v_mfma_f32_16x16x32_bf16 v[180:183], a[80:83], a[56:59], v[180:183]
s_add_u32 s64, s72, 17536
ds_read_b64_tr_b16 a[74:75], v8 offset:1024
v_mfma_f32_16x16x32_bf16 v[180:183], a[84:87], a[60:63], v[180:183]
buffer_load_dwordx4 v13, s[48:51], s64 offen lds
v_mfma_f32_16x16x32_bf16 v[172:175], a[84:87], a[52:55], v[172:175]
ds_read_b64_tr_b16 a[76:77], v8 offset:8192
v_mfma_f32_16x16x32_bf16 v[172:175], a[80:83], a[48:51], v[172:175]
ds_read_b64_tr_b16 a[78:79], v8 offset:9216
v_mfma_f32_16x16x32_bf16 v[164:167], a[80:83], a[40:43], v[164:167]
v_mfma_f32_16x16x32_bf16 v[164:167], a[84:87], a[44:47], v[164:167]
s_add_u32 m0, s76, 34816
v_mfma_f32_16x16x32_bf16 v[156:159], a[84:87], a[36:39], v[156:159]
s_add_u32 s64, s72, 132224
v_mfma_f32_16x16x32_bf16 v[156:159], a[80:83], a[32:35], v[156:159]
buffer_load_dwordx4 v12, s[48:51], s64 offen lds
v_mfma_f32_16x16x32_bf16 v[24:27], a[88:91], a[32:35], v[24:27]
ds_read_b64_tr_b16 a[80:81], v9 offset:0
v_mfma_f32_16x16x32_bf16 v[24:27], a[92:95], a[36:39], v[24:27]
ds_read_b64_tr_b16 a[82:83], v9 offset:1024
v_mfma_f32_16x16x32_bf16 v[40:43], a[92:95], a[44:47], v[40:43]
s_waitcnt vmcnt(13)
s_add_u32 m0, s76, 35840
ds_read_b64_tr_b16 a[84:85], v9 offset:8192
v_mfma_f32_16x16x32_bf16 v[40:43], a[88:91], a[40:43], v[40:43]
s_add_u32 s64, s72, 148608
ds_read_b64_tr_b16 a[86:87], v9 offset:9216
v_mfma_f32_16x16x32_bf16 v[56:59], a[88:91], a[48:51], v[56:59]
buffer_load_dwordx4 v13, s[48:51], s64 offen lds
v_mfma_f32_16x16x32_bf16 v[56:59], a[92:95], a[52:55], v[56:59]
ds_read_b128 a[0:3], v2 offset:0
v_mfma_f32_16x16x32_bf16 v[72:75], a[92:95], a[60:63], v[72:75]
ds_read_b128 a[4:7], v3 offset:0
v_mfma_f32_16x16x32_bf16 v[72:75], a[88:91], a[56:59], v[72:75]
s_waitcnt lgkmcnt(6)
ds_read_b128 a[8:11], v2 offset:2048
v_mfma_f32_16x16x32_bf16 v[136:139], a[96:99], a[56:59], v[136:139]
s_add_u32 m0, s76, 36864
ds_read_b128 a[12:15], v3 offset:2048
v_mfma_f32_16x16x32_bf16 v[136:139], a[100:103], a[60:63], v[136:139]
s_add_u32 s64, s73, 1152
ds_read_b128 a[16:19], v2 offset:4096
v_mfma_f32_16x16x32_bf16 v[120:123], a[100:103], a[52:55], v[120:123]
buffer_load_dwordx4 v12, s[48:51], s64 offen lds
v_mfma_f32_16x16x32_bf16 v[120:123], a[96:99], a[48:51], v[120:123]
ds_read_b128 a[20:23], v3 offset:4096
v_mfma_f32_16x16x32_bf16 v[104:107], a[96:99], a[40:43], v[104:107]
ds_read_b128 a[24:27], v2 offset:6144
v_mfma_f32_16x16x32_bf16 v[104:107], a[100:103], a[44:47], v[104:107]
s_add_u32 m0, s76, 37888
s_add_u32 s65, s79, 13312
ds_read_b128 a[28:31], v3 offset:6144
v_mfma_f32_16x16x32_bf16 v[88:91], a[100:103], a[36:39], v[88:91]
s_add_u32 s64, s73, 17536
buffer_store_dwordx4 a[224:227], v16, s[44:47], s65 offen sc1
v_mfma_f32_16x16x32_bf16 v[88:91], a[96:99], a[32:35], v[88:91]
buffer_load_dwordx4 v13, s[48:51], s64 offen lds
v_mfma_f32_16x16x32_bf16 v[28:31], a[104:107], a[32:35], v[28:31]
v_readfirstlane_b32 s66, v1
s_nop 0
s_cmp_lt_u32 s66, s81
s_cbranch_scc1 L_spin_1
L_spinbk_2:
v_mfma_f32_16x16x32_bf16 v[28:31], a[108:111], a[36:39], v[28:31]
ds_read_b64_tr_b16 a[88:89], v10 offset:0
v_mfma_f32_16x16x32_bf16 v[44:47], a[108:111], a[44:47], v[44:47]
ds_read_b64_tr_b16 a[90:91], v10 offset:1024
v_mfma_f32_16x16x32_bf16 v[44:47], a[104:107], a[40:43], v[44:47]
s_add_u32 m0, s76, 38912
ds_read_b64_tr_b16 a[92:93], v10 offset:8192
v_mfma_f32_16x16x32_bf16 v[60:63], a[104:107], a[48:51], v[60:63]
s_add_u32 s64, s73, 132224
ds_read_b64_tr_b16 a[94:95], v10 offset:9216
v_mfma_f32_16x16x32_bf16 v[60:63], a[108:111], a[52:55], v[60:63]
buffer_load_dwordx4 v12, s[48:51], s64 offen lds
v_mfma_f32_16x16x32_bf16 v[76:79], a[108:111], a[60:63], v[76:79]
ds_read_b64_tr_b16 a[96:97], v11 offset:0
v_mfma_f32_16x16x32_bf16 v[76:79], a[104:107], a[56:59], v[76:79]
ds_read_b64_tr_b16 a[98:99], v11 offset:1024
v_mfma_f32_16x16x32_bf16 v[140:143], a[112:115], a[56:59], v[140:143]
s_add_u32 m0, s76, 39936
ds_read_b64_tr_b16 a[100:101], v11 offset:8192
v_mfma_f32_16x16x32_bf16 v[140:143], a[116:119], a[60:63], v[140:143]
s_add_u32 s64, s73, 148608
ds_read_b64_tr_b16 a[102:103], v11 offset:9216
v_mfma_f32_16x16x32_bf16 v[124:127], a[116:119], a[52:55], v[124:127]
buffer_load_dwordx4 v13, s[48:51], s64 offen lds
v_mfma_f32_16x16x32_bf16 v[124:127], a[112:115], a[48:51], v[124:127]
v_mfma_f32_16x16x32_bf16 v[108:111], a[112:115], a[40:43], v[108:111]
v_mfma_f32_16x16x32_bf16 v[108:111], a[116:119], a[44:47], v[108:111]
v_mfma_f32_16x16x32_bf16 v[92:95], a[116:119], a[36:39], v[92:95]
s_add_u32 s52, s28, 59768832
s_addc_u32 s53, s29, 0
s_mov_b32 s54, 16384
v_mfma_f32_16x16x32_bf16 v[92:95], a[112:115], a[32:35], v[92:95]
v_mfma_f32_16x16x32_bf16 v[32:35], a[72:75], a[32:35], v[32:35]
v_mfma_f32_16x16x32_bf16 v[32:35], a[76:79], a[36:39], v[32:35]
v_mfma_f32_16x16x32_bf16 v[48:51], a[76:79], a[44:47], v[48:51]
s_waitcnt lgkmcnt(0)
s_barrier
v_mfma_f32_16x16x32_bf16 v[48:51], a[72:75], a[40:43], v[48:51]
s_add_u32 m0, s77, 65536
ds_read_b64_tr_b16 a[104:105], v19 offset:36864
v_mfma_f32_16x16x32_bf16 v[64:67], a[72:75], a[48:51], v[64:67]
s_add_u32 s64, s71, 5242880
ds_read_b64_tr_b16 a[106:107], v19 offset:37120
v_mfma_f32_16x16x32_bf16 v[64:67], a[76:79], a[52:55], v[64:67]
buffer_load_dwordx4 v14, s[56:59], s64 offen lds
v_mfma_f32_16x16x32_bf16 v[80:83], a[76:79], a[60:63], v[80:83]
ds_read_b64_tr_b16 a[108:109], v19 offset:38912
v_mfma_f32_16x16x32_bf16 v[80:83], a[72:75], a[56:59], v[80:83]
ds_read_b64_tr_b16 a[110:111], v19 offset:39168
v_mfma_f32_16x16x32_bf16 v[144:147], a[80:83], a[56:59], v[144:147]
ds_read_b128 a[64:67], v17 offset:32768
v_mfma_f32_16x16x32_bf16 v[144:147], a[84:87], a[60:63], v[144:147]
ds_read_b128 a[68:71], v18 offset:32768
v_mfma_f32_16x16x32_bf16 v[128:131], a[84:87], a[52:55], v[128:131]
ds_read_b64_tr_b16 a[112:113], v21 offset:36864
v_mfma_f32_16x16x32_bf16 v[128:131], a[80:83], a[48:51], v[128:131]
s_add_u32 m0, s78, 81920
ds_read_b64_tr_b16 a[114:115], v21 offset:37120
v_mfma_f32_16x16x32_bf16 v[112:115], a[80:83], a[40:43], v[112:115]
s_add_u32 s64, s75, 3932160
ds_read_b64_tr_b16 a[116:117], v21 offset:38912
v_mfma_f32_16x16x32_bf16 v[112:115], a[84:87], a[44:47], v[112:115]
buffer_load_dwordx4 v23, s[60:63], s64 offen lds
v_mfma_f32_16x16x32_bf16 v[96:99], a[84:87], a[36:39], v[96:99]
ds_read_b64_tr_b16 a[118:119], v21 offset:39168
v_mfma_f32_16x16x32_bf16 v[96:99], a[80:83], a[32:35], v[96:99]
ds_read_b64_tr_b16 a[72:73], v20 offset:36864
v_mfma_f32_16x16x32_bf16 v[36:39], a[88:91], a[32:35], v[36:39]
ds_read_b64_tr_b16 a[74:75], v20 offset:37120
v_mfma_f32_16x16x32_bf16 v[36:39], a[92:95], a[36:39], v[36:39]
ds_read_b64_tr_b16 a[76:77], v20 offset:38912
v_mfma_f32_16x16x32_bf16 v[52:55], a[92:95], a[44:47], v[52:55]
ds_read_b64_tr_b16 a[78:79], v20 offset:39168
v_mfma_f32_16x16x32_bf16 v[52:55], a[88:91], a[40:43], v[52:55]
s_add_u32 m0, s77, 66560
ds_read_b64_tr_b16 a[80:81], v19 offset:40960
v_mfma_f32_16x16x32_bf16 v[68:71], a[88:91], a[48:51], v[68:71]
s_add_u32 s64, s71, 5275648
ds_read_b64_tr_b16 a[82:83], v19 offset:41216
v_mfma_f32_16x16x32_bf16 v[68:71], a[92:95], a[52:55], v[68:71]
s_add_u32 s65, s79, 30720
buffer_load_dwordx4 v14, s[56:59], s64 offen lds
v_mfma_f32_16x16x32_bf16 v[84:87], a[92:95], a[60:63], v[84:87]
buffer_store_dwordx4 a[228:231], v16, s[44:47], s65 offen sc1
v_mfma_f32_16x16x32_bf16 v[84:87], a[88:91], a[56:59], v[84:87]
ds_read_b64_tr_b16 a[84:85], v19 offset:43008
v_mfma_f32_16x16x32_bf16 v[148:151], a[96:99], a[56:59], v[148:151]
ds_read_b64_tr_b16 a[86:87], v19 offset:43264
v_mfma_f32_16x16x32_bf16 v[148:151], a[100:103], a[60:63], v[148:151]
ds_read_b64_tr_b16 a[88:89], v21 offset:40960
v_mfma_f32_16x16x32_bf16 v[132:135], a[100:103], a[52:55], v[132:135]
ds_read_b64_tr_b16 a[90:91], v21 offset:41216
v_mfma_f32_16x16x32_bf16 v[132:135], a[96:99], a[48:51], v[132:135]
s_add_u32 m0, s78, 86016
ds_read_b64_tr_b16 a[92:93], v21 offset:43008
v_mfma_f32_16x16x32_bf16 v[116:119], a[96:99], a[40:43], v[116:119]
s_add_u32 s64, s75, 3934208
ds_read_b64_tr_b16 a[94:95], v21 offset:43264
v_mfma_f32_16x16x32_bf16 v[116:119], a[100:103], a[44:47], v[116:119]
buffer_load_dwordx4 v23, s[60:63], s64 offen lds
v_mfma_f32_16x16x32_bf16 v[100:103], a[100:103], a[36:39], v[100:103]
v_mfma_f32_16x16x32_bf16 v[100:103], a[96:99], a[32:35], v[100:103]
s_waitcnt lgkmcnt(6)
ds_read_b64_tr_b16 a[96:97], v20 offset:40960
v_mfma_f32_16x16x32_bf16 v[184:187], a[104:107], a[0:3], v[184:187]
ds_read_b64_tr_b16 a[98:99], v20 offset:41216
v_mfma_f32_16x16x32_bf16 v[184:187], a[108:111], a[4:7], v[184:187]
ds_read_b64_tr_b16 a[100:101], v20 offset:43008
v_add_u32 v17, 0x8000, v17
v_mfma_f32_16x16x32_bf16 v[192:195], a[108:111], a[12:15], v[192:195]
ds_read_b64_tr_b16 a[102:103], v20 offset:43264
v_add_u32 v18, 0x8000, v18
v_mfma_f32_16x16x32_bf16 v[192:195], a[104:107], a[8:11], v[192:195]
s_add_u32 m0, s77, 67584
s_add_u32 s17, s78, .-L_pc+6144
v_mfma_f32_16x16x32_bf16 v[200:203], a[104:107], a[16:19], v[200:203]
s_add_u32 s64, s71, 5308416
buffer_load_dword a252, v16, s[88:91], s17 offen
v_mfma_f32_16x16x32_bf16 v[200:203], a[108:111], a[20:23], v[200:203]
buffer_load_dwordx4 v15, s[56:59], s64 offen lds
v_mfma_f32_16x16x32_bf16 v[208:211], a[108:111], a[28:31], v[208:211]
v_mfma_f32_16x16x32_bf16 v[208:211], a[104:107], a[24:27], v[208:211]
ds_read_b64_tr_b16 a[104:105], v19 offset:32768
v_mfma_f32_16x16x32_bf16 v[248:251], a[112:115], a[64:67], v[248:251]
ds_read_b64_tr_b16 a[106:107], v19 offset:33024
v_mfma_f32_16x16x32_bf16 v[248:251], a[116:119], a[68:71], v[248:251]
ds_read_b64_tr_b16 a[108:109], v19 offset:34816
v_mfma_f32_16x16x32_bf16 v[212:215], a[76:79], a[28:31], v[212:215]
ds_read_b64_tr_b16 a[110:111], v19 offset:35072
v_mfma_f32_16x16x32_bf16 v[212:215], a[72:75], a[24:27], v[212:215]
s_add_u32 m0, s78, 90112
ds_read_b64_tr_b16 a[112:113], v20 offset:32768
v_mfma_f32_16x16x32_bf16 v[204:207], a[72:75], a[16:19], v[204:207]
s_add_u32 s64, s75, 3936256
ds_read_b64_tr_b16 a[114:115], v20 offset:33024
v_mfma_f32_16x16x32_bf16 v[204:207], a[76:79], a[20:23], v[204:207]
buffer_load_dwordx4 v23, s[60:63], s64 offen lds
v_mfma_f32_16x16x32_bf16 v[196:199], a[76:79], a[12:15], v[196:199]
ds_read_b64_tr_b16 a[116:117], v20 offset:34816
v_mfma_f32_16x16x32_bf16 v[196:199], a[72:75], a[8:11], v[196:199]
ds_read_b64_tr_b16 a[118:119], v20 offset:35072
v_mfma_f32_16x16x32_bf16 v[188:191], a[72:75], a[0:3], v[188:191]
v_mfma_f32_16x16x32_bf16 v[188:191], a[76:79], a[4:7], v[188:191]
s_waitcnt lgkmcnt(7)
ds_read_b64_tr_b16 a[72:73], v4 offset:32768
v_mfma_f32_16x16x32_bf16 v[216:219], a[4:7], a[84:87], v[216:219]
ds_read_b64_tr_b16 a[74:75], v4 offset:33792
v_mfma_f32_16x16x32_bf16 v[216:219], a[0:3], a[80:83], v[216:219]
s_add_u32 m0, s77, 68608
ds_read_b64_tr_b16 a[76:77], v4 offset:40960
v_add_u32 v21, 0x8000, v21
v_mfma_f32_16x16x32_bf16 v[224:227], a[8:11], a[80:83], v[224:227]
s_add_u32 s64, s71, 5341184
ds_read_b64_tr_b16 a[78:79], v4 offset:41984
v_mfma_f32_16x16x32_bf16 v[224:227], a[12:15], a[84:87], v[224:227]
buffer_load_dwordx4 v15, s[56:59], s64 offen lds
v_mfma_f32_16x16x32_bf16 v[232:235], a[20:23], a[84:87], v[232:235]
v_mfma_f32_16x16x32_bf16 v[232:235], a[16:19], a[80:83], v[232:235]
v_mfma_f32_16x16x32_bf16 v[240:243], a[24:27], a[80:83], v[240:243]
v_mfma_f32_16x16x32_bf16 v[240:243], a[28:31], a[84:87], v[240:243]
ds_read_b64_tr_b16 a[80:81], v5 offset:32768
v_mfma_f32_16x16x32_bf16 v[252:255], a[68:71], a[92:95], v[252:255]
s_add_u32 s65, s79, 31744
ds_read_b64_tr_b16 a[82:83], v5 offset:33792
v_mfma_f32_16x16x32_bf16 v[252:255], a[64:67], a[88:91], v[252:255]
s_add_u32 m0, s78, 94208
buffer_store_dwordx4 a[232:235], v16, s[44:47], s65 offen sc1
v_mfma_f32_16x16x32_bf16 v[244:247], a[24:27], a[96:99], v[244:247]
s_add_u32 s64, s74, 1280
ds_read_b64_tr_b16 a[84:85], v5 offset:40960
v_mfma_f32_16x16x32_bf16 v[244:247], a[28:31], a[100:103], v[244:247]
buffer_load_dwordx4 v22, s[48:51], s64 offen lds
v_mfma_f32_16x16x32_bf16 v[236:239], a[20:23], a[100:103], v[236:239]
ds_read_b64_tr_b16 a[86:87], v5 offset:41984
v_add_u32 v19, 0x8000, v19
v_mfma_f32_16x16x32_bf16 v[236:239], a[16:19], a[96:99], v[236:239]
ds_read_b64_tr_b16 a[88:89], v6 offset:32768
v_mfma_f32_16x16x32_bf16 v[228:231], a[8:11], a[96:99], v[228:231]
ds_read_b64_tr_b16 a[90:91], v6 offset:33792
v_mfma_f32_16x16x32_bf16 v[228:231], a[12:15], a[100:103], v[228:231]
ds_read_b64_tr_b16 a[92:93], v6 offset:40960
v_mfma_f32_16x16x32_bf16 v[220:223], a[4:7], a[100:103], v[220:223]
ds_read_b64_tr_b16 a[94:95], v6 offset:41984
v_mfma_f32_16x16x32_bf16 v[220:223], a[0:3], a[96:99], v[220:223]
s_waitcnt lgkmcnt(7)
ds_read_b64_tr_b16 a[96:97], v7 offset:32768
v_mfma_f32_16x16x32_bf16 v[152:155], a[104:107], a[0:3], v[152:155]
ds_read_b64_tr_b16 a[98:99], v7 offset:33792
v_mfma_f32_16x16x32_bf16 v[152:155], a[108:111], a[4:7], v[152:155]
ds_read_b64_tr_b16 a[100:101], v7 offset:40960
v_add_u32 v20, 0x8000, v20
v_mfma_f32_16x16x32_bf16 v[160:163], a[108:111], a[12:15], v[160:163]
s_add_u32 m0, s76, 0
ds_read_b64_tr_b16 a[102:103], v7 offset:41984
v_mfma_f32_16x16x32_bf16 v[160:163], a[104:107], a[8:11], v[160:163]
s_add_u32 s64, s72, 1280
v_mfma_f32_16x16x32_bf16 v[168:171], a[104:107], a[16:19], v[168:171]
buffer_load_dwordx4 v12, s[48:51], s64 offen lds
v_mfma_f32_16x16x32_bf16 v[168:171], a[108:111], a[20:23], v[168:171]
v_mfma_f32_16x16x32_bf16 v[176:179], a[108:111], a[28:31], v[176:179]
v_mfma_f32_16x16x32_bf16 v[176:179], a[104:107], a[24:27], v[176:179]
s_add_u32 m0, s76, 1024
ds_read_b64_tr_b16 a[104:105], v8 offset:32768
v_mfma_f32_16x16x32_bf16 v[180:183], a[112:115], a[24:27], v[180:183]
s_add_u32 s64, s72, 17664
ds_read_b64_tr_b16 a[106:107], v8 offset:33792
v_mfma_f32_16x16x32_bf16 v[180:183], a[116:119], a[28:31], v[180:183]
buffer_load_dwordx4 v13, s[48:51], s64 offen lds
v_mfma_f32_16x16x32_bf16 v[172:175], a[116:119], a[20:23], v[172:175]
ds_read_b64_tr_b16 a[108:109], v8 offset:40960
v_add_u32 v4, 0x8000, v4
v_mfma_f32_16x16x32_bf16 v[172:175], a[112:115], a[16:19], v[172:175]
ds_read_b64_tr_b16 a[110:111], v8 offset:41984
v_mfma_f32_16x16x32_bf16 v[164:167], a[112:115], a[8:11], v[164:167]
v_mfma_f32_16x16x32_bf16 v[164:167], a[116:119], a[12:15], v[164:167]
s_add_u32 m0, s76, 2048
v_mfma_f32_16x16x32_bf16 v[156:159], a[116:119], a[4:7], v[156:159]
s_add_u32 s64, s72, 132352
v_mfma_f32_16x16x32_bf16 v[156:159], a[112:115], a[0:3], v[156:159]
buffer_load_dwordx4 v12, s[48:51], s64 offen lds
v_mfma_f32_16x16x32_bf16 v[24:27], a[72:75], a[0:3], v[24:27]
ds_read_b64_tr_b16 a[112:113], v9 offset:32768
v_mfma_f32_16x16x32_bf16 v[24:27], a[76:79], a[4:7], v[24:27]
ds_read_b64_tr_b16 a[114:115], v9 offset:33792
v_add_u32 v5, 0x8000, v5
v_mfma_f32_16x16x32_bf16 v[40:43], a[76:79], a[12:15], v[40:43]
s_waitcnt vmcnt(14)
s_add_u32 m0, s76, 3072
ds_read_b64_tr_b16 a[116:117], v9 offset:40960
v_mfma_f32_16x16x32_bf16 v[40:43], a[72:75], a[8:11], v[40:43]
s_add_u32 s64, s72, 148736
ds_read_b64_tr_b16 a[118:119], v9 offset:41984
v_mfma_f32_16x16x32_bf16 v[56:59], a[72:75], a[16:19], v[56:59]
buffer_load_dwordx4 v13, s[48:51], s64 offen lds
v_mfma_f32_16x16x32_bf16 v[56:59], a[76:79], a[20:23], v[56:59]
ds_read_b128 a[32:35], v2 offset:32768
v_mfma_f32_16x16x32_bf16 v[72:75], a[76:79], a[28:31], v[72:75]
ds_read_b128 a[36:39], v3 offset:32768
v_mfma_f32_16x16x32_bf16 v[72:75], a[72:75], a[24:27], v[72:75]
s_waitcnt lgkmcnt(6)
ds_read_b128 a[40:43], v2 offset:34816
v_mfma_f32_16x16x32_bf16 v[136:139], a[80:83], a[24:27], v[136:139]
s_add_u32 m0, s76, 4096
ds_read_b128 a[44:47], v3 offset:34816
v_mfma_f32_16x16x32_bf16 v[136:139], a[84:87], a[28:31], v[136:139]
s_add_u32 s64, s73, 1280
ds_read_b128 a[48:51], v2 offset:36864
v_add_u32 v6, 0x8000, v6
v_mfma_f32_16x16x32_bf16 v[120:123], a[84:87], a[20:23], v[120:123]
buffer_load_dwordx4 v12, s[48:51], s64 offen lds
v_mfma_f32_16x16x32_bf16 v[120:123], a[80:83], a[16:19], v[120:123]
ds_read_b128 a[52:55], v3 offset:36864
v_mfma_f32_16x16x32_bf16 v[104:107], a[80:83], a[8:11], v[104:107]
ds_read_b128 a[56:59], v2 offset:38912
v_mfma_f32_16x16x32_bf16 v[104:107], a[84:87], a[12:15], v[104:107]
s_add_u32 m0, s76, 5120
s_add_u32 s65, s79, 15360
ds_read_b128 a[60:63], v3 offset:38912
v_mfma_f32_16x16x32_bf16 v[88:91], a[84:87], a[4:7], v[88:91]
s_add_u32 s64, s73, 17664
buffer_store_dwordx4 a[236:239], v16, s[44:47], s65 offen sc1
v_mfma_f32_16x16x32_bf16 v[88:91], a[80:83], a[0:3], v[88:91]
buffer_load_dwordx4 v13, s[48:51], s64 offen lds
v_mfma_f32_16x16x32_bf16 v[28:31], a[88:91], a[0:3], v[28:31]
ds_read_b64_tr_b16 a[72:73], v10 offset:32768
v_mfma_f32_16x16x32_bf16 v[28:31], a[92:95], a[4:7], v[28:31]
ds_read_b64_tr_b16 a[74:75], v10 offset:33792
v_add_u32 v7, 0x8000, v7
v_mfma_f32_16x16x32_bf16 v[44:47], a[92:95], a[12:15], v[44:47]
ds_read_b64_tr_b16 a[76:77], v10 offset:40960
v_mfma_f32_16x16x32_bf16 v[44:47], a[88:91], a[8:11], v[44:47]
s_add_u32 m0, s76, 6144
ds_read_b64_tr_b16 a[78:79], v10 offset:41984
v_mfma_f32_16x16x32_bf16 v[60:63], a[88:91], a[16:19], v[60:63]
s_add_u32 s64, s73, 132352
ds_read_b64_tr_b16 a[80:81], v11 offset:32768
v_mfma_f32_16x16x32_bf16 v[60:63], a[92:95], a[20:23], v[60:63]
buffer_load_dwordx4 v12, s[48:51], s64 offen lds
v_mfma_f32_16x16x32_bf16 v[76:79], a[92:95], a[28:31], v[76:79]
ds_read_b64_tr_b16 a[82:83], v11 offset:33792
v_mfma_f32_16x16x32_bf16 v[76:79], a[88:91], a[24:27], v[76:79]
ds_read_b64_tr_b16 a[84:85], v11 offset:40960
v_mfma_f32_16x16x32_bf16 v[140:143], a[96:99], a[24:27], v[140:143]
s_add_u32 m0, s76, 7168
ds_read_b64_tr_b16 a[86:87], v11 offset:41984
v_mfma_f32_16x16x32_bf16 v[140:143], a[100:103], a[28:31], v[140:143]
s_add_u32 s64, s73, 148736
v_add_u32 v8, 0x8000, v8
v_mfma_f32_16x16x32_bf16 v[124:127], a[100:103], a[20:23], v[124:127]
buffer_load_dwordx4 v13, s[48:51], s64 offen lds
v_mfma_f32_16x16x32_bf16 v[124:127], a[96:99], a[16:19], v[124:127]
v_mfma_f32_16x16x32_bf16 v[108:111], a[96:99], a[8:11], v[108:111]
v_mfma_f32_16x16x32_bf16 v[108:111], a[100:103], a[12:15], v[108:111]
v_mfma_f32_16x16x32_bf16 v[92:95], a[100:103], a[4:7], v[92:95]
v_add_u32 v9, 0x8000, v9
v_add_u32 v10, 0x8000, v10
v_mfma_f32_16x16x32_bf16 v[92:95], a[96:99], a[0:3], v[92:95]
v_add_u32 v11, 0x8000, v11
v_mfma_f32_16x16x32_bf16 v[32:35], a[104:107], a[0:3], v[32:35]
v_mfma_f32_16x16x32_bf16 v[32:35], a[108:111], a[4:7], v[32:35]
v_mfma_f32_16x16x32_bf16 v[48:51], a[108:111], a[12:15], v[48:51]
s_waitcnt lgkmcnt(0)
s_barrier
v_mfma_f32_16x16x32_bf16 v[48:51], a[104:107], a[8:11], v[48:51]
s_add_u32 m0, s77, 98304
ds_read_b64_tr_b16 a[88:89], v19 offset:36864
v_mfma_f32_16x16x32_bf16 v[64:67], a[104:107], a[16:19], v[64:67]
s_add_u32 s64, s71, 5767168
ds_read_b64_tr_b16 a[90:91], v19 offset:37120
v_mfma_f32_16x16x32_bf16 v[64:67], a[108:111], a[20:23], v[64:67]
buffer_load_dwordx4 v14, s[56:59], s64 offen lds
v_mfma_f32_16x16x32_bf16 v[80:83], a[108:111], a[28:31], v[80:83]
ds_read_b64_tr_b16 a[92:93], v19 offset:38912
v_mfma_f32_16x16x32_bf16 v[80:83], a[104:107], a[24:27], v[80:83]
ds_read_b64_tr_b16 a[94:95], v19 offset:39168
v_mfma_f32_16x16x32_bf16 v[144:147], a[112:115], a[24:27], v[144:147]
ds_read_b128 a[64:67], v17 offset:32768
v_mfma_f32_16x16x32_bf16 v[144:147], a[116:119], a[28:31], v[144:147]
ds_read_b128 a[68:71], v18 offset:32768
v_mfma_f32_16x16x32_bf16 v[128:131], a[116:119], a[20:23], v[128:131]
ds_read_b64_tr_b16 a[96:97], v21 offset:36864
v_mfma_f32_16x16x32_bf16 v[128:131], a[112:115], a[16:19], v[128:131]
s_add_u32 m0, s78, 114688
ds_read_b64_tr_b16 a[98:99], v21 offset:37120
v_mfma_f32_16x16x32_bf16 v[112:115], a[112:115], a[8:11], v[112:115]
s_add_u32 s64, s75, 4325376
ds_read_b64_tr_b16 a[100:101], v21 offset:38912
v_mfma_f32_16x16x32_bf16 v[112:115], a[116:119], a[12:15], v[112:115]
buffer_load_dwordx4 v23, s[60:63], s64 offen lds
v_mfma_f32_16x16x32_bf16 v[96:99], a[116:119], a[4:7], v[96:99]
ds_read_b64_tr_b16 a[102:103], v21 offset:39168
v_mfma_f32_16x16x32_bf16 v[96:99], a[112:115], a[0:3], v[96:99]
ds_read_b64_tr_b16 a[104:105], v20 offset:36864
v_mfma_f32_16x16x32_bf16 v[36:39], a[72:75], a[0:3], v[36:39]
ds_read_b64_tr_b16 a[106:107], v20 offset:37120
v_mfma_f32_16x16x32_bf16 v[36:39], a[76:79], a[4:7], v[36:39]
ds_read_b64_tr_b16 a[108:109], v20 offset:38912
v_mfma_f32_16x16x32_bf16 v[52:55], a[76:79], a[12:15], v[52:55]
ds_read_b64_tr_b16 a[110:111], v20 offset:39168
v_mfma_f32_16x16x32_bf16 v[52:55], a[72:75], a[8:11], v[52:55]
s_add_u32 m0, s77, 99328
ds_read_b64_tr_b16 a[112:113], v19 offset:40960
v_mfma_f32_16x16x32_bf16 v[68:71], a[72:75], a[16:19], v[68:71]
s_add_u32 s64, s71, 5799936
ds_read_b64_tr_b16 a[114:115], v19 offset:41216
v_mfma_f32_16x16x32_bf16 v[68:71], a[76:79], a[20:23], v[68:71]
buffer_load_dwordx4 v14, s[56:59], s64 offen lds
v_mfma_f32_16x16x32_bf16 v[84:87], a[76:79], a[28:31], v[84:87]
ds_read_b64_tr_b16 a[116:117], v19 offset:43008
v_mfma_f32_16x16x32_bf16 v[84:87], a[72:75], a[24:27], v[84:87]
ds_read_b64_tr_b16 a[118:119], v19 offset:43264
v_mfma_f32_16x16x32_bf16 v[148:151], a[80:83], a[24:27], v[148:151]
ds_read_b64_tr_b16 a[72:73], v21 offset:40960
v_mfma_f32_16x16x32_bf16 v[148:151], a[84:87], a[28:31], v[148:151]
ds_read_b64_tr_b16 a[74:75], v21 offset:41216
v_mfma_f32_16x16x32_bf16 v[132:135], a[84:87], a[20:23], v[132:135]
ds_read_b64_tr_b16 a[76:77], v21 offset:43008
v_mfma_f32_16x16x32_bf16 v[132:135], a[80:83], a[16:19], v[132:135]
s_add_u32 m0, s78, 118784
ds_read_b64_tr_b16 a[78:79], v21 offset:43264
v_mfma_f32_16x16x32_bf16 v[116:119], a[80:83], a[8:11], v[116:119]
s_add_u32 s64, s75, 4327424
v_mfma_f32_16x16x32_bf16 v[116:119], a[84:87], a[12:15], v[116:119]
buffer_load_dwordx4 v23, s[60:63], s64 offen lds
v_mfma_f32_16x16x32_bf16 v[100:103], a[84:87], a[4:7], v[100:103]
v_mfma_f32_16x16x32_bf16 v[100:103], a[80:83], a[0:3], v[100:103]
s_waitcnt lgkmcnt(6)
ds_read_b64_tr_b16 a[80:81], v20 offset:40960
v_mfma_f32_16x16x32_bf16 v[184:187], a[88:91], a[32:35], v[184:187]
s_lshl_b32 s66, s30, 30
ds_read_b64_tr_b16 a[82:83], v20 offset:41216
v_mfma_f32_16x16x32_bf16 v[184:187], a[92:95], a[36:39], v[184:187]
ds_read_b64_tr_b16 a[84:85], v20 offset:43008
v_lshl_add_u32 v1, v0, 24, s66
v_mfma_f32_16x16x32_bf16 v[192:195], a[92:95], a[44:47], v[192:195]
s_lshl_b32 s80, s31, 8
ds_read_b64_tr_b16 a[86:87], v20 offset:43264
v_subrev_u32 v17, 0x8000, v17
v_mfma_f32_16x16x32_bf16 v[192:195], a[88:91], a[40:43], v[192:195]
s_add_u32 m0, s77, 100352
v_subrev_u32 v18, 0x8000, v18
v_mfma_f32_16x16x32_bf16 v[200:203], a[88:91], a[48:51], v[200:203]
s_add_u32 s64, s71, 5832704
v_mfma_f32_16x16x32_bf16 v[200:203], a[92:95], a[52:55], v[200:203]
buffer_load_dwordx4 v15, s[56:59], s64 offen lds
v_mfma_f32_16x16x32_bf16 v[208:211], a[92:95], a[60:63], v[208:211]
v_mfma_f32_16x16x32_bf16 v[208:211], a[88:91], a[56:59], v[208:211]
ds_read_b64_tr_b16 a[88:89], v19 offset:32768
v_mfma_f32_16x16x32_bf16 v[248:251], a[96:99], a[64:67], v[248:251]
ds_read_b64_tr_b16 a[90:91], v19 offset:33024
v_mfma_f32_16x16x32_bf16 v[248:251], a[100:103], a[68:71], v[248:251]
ds_read_b64_tr_b16 a[92:93], v19 offset:34816
v_mfma_f32_16x16x32_bf16 v[212:215], a[108:111], a[60:63], v[212:215]
ds_read_b64_tr_b16 a[94:95], v19 offset:35072
v_mfma_f32_16x16x32_bf16 v[212:215], a[104:107], a[56:59], v[212:215]
s_add_u32 m0, s78, 122880
ds_read_b64_tr_b16 a[96:97], v20 offset:32768
v_mfma_f32_16x16x32_bf16 v[204:207], a[104:107], a[48:51], v[204:207]
s_add_u32 s64, s75, 4329472
ds_read_b64_tr_b16 a[98:99], v20 offset:33024
v_mfma_f32_16x16x32_bf16 v[204:207], a[108:111], a[52:55], v[204:207]
buffer_load_dwordx4 v23, s[60:63], s64 offen lds
v_mfma_f32_16x16x32_bf16 v[196:199], a[108:111], a[44:47], v[196:199]
ds_read_b64_tr_b16 a[100:101], v20 offset:34816
v_mfma_f32_16x16x32_bf16 v[196:199], a[104:107], a[40:43], v[196:199]
ds_read_b64_tr_b16 a[102:103], v20 offset:35072
v_mfma_f32_16x16x32_bf16 v[188:191], a[104:107], a[32:35], v[188:191]
v_mfma_f32_16x16x32_bf16 v[188:191], a[108:111], a[36:39], v[188:191]
s_waitcnt lgkmcnt(7)
ds_read_b64_tr_b16 a[104:105], v4 offset:32768
v_mfma_f32_16x16x32_bf16 v[216:219], a[36:39], a[116:119], v[216:219]
ds_read_b64_tr_b16 a[106:107], v4 offset:33792
v_mfma_f32_16x16x32_bf16 v[216:219], a[32:35], a[112:115], v[216:219]
s_add_u32 m0, s77, 101376
ds_read_b64_tr_b16 a[108:109], v4 offset:40960
v_subrev_u32 v21, 0x8000, v21
v_mfma_f32_16x16x32_bf16 v[224:227], a[40:43], a[112:115], v[224:227]
s_add_u32 s64, s71, 5865472
ds_read_b64_tr_b16 a[110:111], v4 offset:41984
v_mfma_f32_16x16x32_bf16 v[224:227], a[44:47], a[116:119], v[224:227]
buffer_load_dwordx4 v15, s[56:59], s64 offen lds
v_mfma_f32_16x16x32_bf16 v[232:235], a[52:55], a[116:119], v[232:235]
v_mfma_f32_16x16x32_bf16 v[232:235], a[48:51], a[112:115], v[232:235]
v_mfma_f32_16x16x32_bf16 v[240:243], a[56:59], a[112:115], v[240:243]
v_mfma_f32_16x16x32_bf16 v[240:243], a[60:63], a[116:119], v[240:243]
ds_read_b64_tr_b16 a[112:113], v5 offset:32768
v_mfma_f32_16x16x32_bf16 v[252:255], a[68:71], a[76:79], v[252:255]
ds_read_b64_tr_b16 a[114:115], v5 offset:33792
v_mfma_f32_16x16x32_bf16 v[252:255], a[64:67], a[72:75], v[252:255]
s_add_u32 m0, s78, 126976
ds_read_b64_tr_b16 a[116:117], v5 offset:40960
v_mfma_f32_16x16x32_bf16 v[244:247], a[56:59], a[80:83], v[244:247]
s_add_u32 s64, s74, 1408
ds_read_b64_tr_b16 a[118:119], v5 offset:41984
v_mfma_f32_16x16x32_bf16 v[244:247], a[60:63], a[84:87], v[244:247]
buffer_load_dwordx4 v22, s[48:51], s64 offen lds
v_mfma_f32_16x16x32_bf16 v[236:239], a[52:55], a[84:87], v[236:239]
ds_read_b64_tr_b16 a[72:73], v6 offset:32768
v_subrev_u32 v19, 0x8000, v19
v_mfma_f32_16x16x32_bf16 v[236:239], a[48:51], a[80:83], v[236:239]
ds_read_b64_tr_b16 a[74:75], v6 offset:33792
v_mfma_f32_16x16x32_bf16 v[228:231], a[40:43], a[80:83], v[228:231]
ds_read_b64_tr_b16 a[76:77], v6 offset:40960
v_mfma_f32_16x16x32_bf16 v[228:231], a[44:47], a[84:87], v[228:231]
ds_read_b64_tr_b16 a[78:79], v6 offset:41984
v_mfma_f32_16x16x32_bf16 v[220:223], a[36:39], a[84:87], v[220:223]
v_mfma_f32_16x16x32_bf16 v[220:223], a[32:35], a[80:83], v[220:223]
s_waitcnt lgkmcnt(7)
ds_read_b64_tr_b16 a[80:81], v7 offset:32768
v_mfma_f32_16x16x32_bf16 v[152:155], a[88:91], a[32:35], v[152:155]
ds_read_b64_tr_b16 a[82:83], v7 offset:33792
v_mfma_f32_16x16x32_bf16 v[152:155], a[92:95], a[36:39], v[152:155]
ds_read_b64_tr_b16 a[84:85], v7 offset:40960
v_subrev_u32 v20, 0x8000, v20
v_mfma_f32_16x16x32_bf16 v[160:163], a[92:95], a[44:47], v[160:163]
s_add_u32 m0, s76, 32768
ds_read_b64_tr_b16 a[86:87], v7 offset:41984
v_mfma_f32_16x16x32_bf16 v[160:163], a[88:91], a[40:43], v[160:163]
s_add_u32 s64, s72, 1408
v_mfma_f32_16x16x32_bf16 v[168:171], a[88:91], a[48:51], v[168:171]
buffer_load_dwordx4 v12, s[48:51], s64 offen lds
v_mfma_f32_16x16x32_bf16 v[168:171], a[92:95], a[52:55], v[168:171]
v_mfma_f32_16x16x32_bf16 v[176:179], a[92:95], a[60:63], v[176:179]
v_mfma_f32_16x16x32_bf16 v[176:179], a[88:91], a[56:59], v[176:179]
s_add_u32 m0, s76, 33792
ds_read_b64_tr_b16 a[88:89], v8 offset:32768
v_mfma_f32_16x16x32_bf16 v[180:183], a[96:99], a[56:59], v[180:183]
s_add_u32 s64, s72, 17792
ds_read_b64_tr_b16 a[90:91], v8 offset:33792
v_mfma_f32_16x16x32_bf16 v[180:183], a[100:103], a[60:63], v[180:183]
buffer_load_dwordx4 v13, s[48:51], s64 offen lds
v_mfma_f32_16x16x32_bf16 v[172:175], a[100:103], a[52:55], v[172:175]
ds_read_b64_tr_b16 a[92:93], v8 offset:40960
v_subrev_u32 v4, 0x8000, v4
v_mfma_f32_16x16x32_bf16 v[172:175], a[96:99], a[48:51], v[172:175]
ds_read_b64_tr_b16 a[94:95], v8 offset:41984
v_mfma_f32_16x16x32_bf16 v[164:167], a[96:99], a[40:43], v[164:167]
v_mfma_f32_16x16x32_bf16 v[164:167], a[100:103], a[44:47], v[164:167]
s_add_u32 m0, s76, 34816
v_mfma_f32_16x16x32_bf16 v[156:159], a[100:103], a[36:39], v[156:159]
s_add_u32 s64, s72, 132480
v_mfma_f32_16x16x32_bf16 v[156:159], a[96:99], a[32:35], v[156:159]
buffer_load_dwordx4 v12, s[48:51], s64 offen lds
v_mfma_f32_16x16x32_bf16 v[24:27], a[104:107], a[32:35], v[24:27]
ds_read_b64_tr_b16 a[96:97], v9 offset:32768
v_mfma_f32_16x16x32_bf16 v[24:27], a[108:111], a[36:39], v[24:27]
ds_read_b64_tr_b16 a[98:99], v9 offset:33792
v_subrev_u32 v5, 0x8000, v5
v_mfma_f32_16x16x32_bf16 v[40:43], a[108:111], a[44:47], v[40:43]
s_waitcnt vmcnt(11)
s_add_u32 m0, s76, 35840
ds_read_b64_tr_b16 a[100:101], v9 offset:40960
v_mfma_f32_16x16x32_bf16 v[40:43], a[104:107], a[40:43], v[40:43]
s_add_u32 s64, s72, 148864
ds_read_b64_tr_b16 a[102:103], v9 offset:41984
v_mfma_f32_16x16x32_bf16 v[56:59], a[104:107], a[48:51], v[56:59]
buffer_load_dwordx4 v13, s[48:51], s64 offen lds
v_mfma_f32_16x16x32_bf16 v[56:59], a[108:111], a[52:55], v[56:59]
ds_read_b128 a[0:3], v2 offset:0
v_mfma_f32_16x16x32_bf16 v[72:75], a[108:111], a[60:63], v[72:75]
ds_read_b128 a[4:7], v3 offset:0
v_mfma_f32_16x16x32_bf16 v[72:75], a[104:107], a[56:59], v[72:75]
s_waitcnt lgkmcnt(6)
ds_read_b128 a[8:11], v2 offset:2048
v_mfma_f32_16x16x32_bf16 v[136:139], a[112:115], a[56:59], v[136:139]
s_add_u32 m0, s76, 36864
ds_read_b128 a[12:15], v3 offset:2048
v_mfma_f32_16x16x32_bf16 v[136:139], a[116:119], a[60:63], v[136:139]
s_add_u32 s64, s73, 1408
ds_read_b128 a[16:19], v2 offset:4096
v_subrev_u32 v6, 0x8000, v6
v_mfma_f32_16x16x32_bf16 v[120:123], a[116:119], a[52:55], v[120:123]
buffer_load_dwordx4 v12, s[48:51], s64 offen lds
v_mfma_f32_16x16x32_bf16 v[120:123], a[112:115], a[48:51], v[120:123]
ds_read_b128 a[20:23], v3 offset:4096
v_mfma_f32_16x16x32_bf16 v[104:107], a[112:115], a[40:43], v[104:107]
ds_read_b128 a[24:27], v2 offset:6144
v_mfma_f32_16x16x32_bf16 v[104:107], a[116:119], a[44:47], v[104:107]
s_add_u32 m0, s76, 37888
ds_read_b128 a[28:31], v3 offset:6144
v_mfma_f32_16x16x32_bf16 v[88:91], a[116:119], a[36:39], v[88:91]
s_add_u32 s64, s73, 17792
ds_read_b64_tr_b16 a[104:105], v10 offset:32768
v_mfma_f32_16x16x32_bf16 v[88:91], a[112:115], a[32:35], v[88:91]
buffer_load_dwordx4 v13, s[48:51], s64 offen lds
v_mfma_f32_16x16x32_bf16 v[28:31], a[72:75], a[32:35], v[28:31]
ds_read_b64_tr_b16 a[106:107], v10 offset:33792
v_mfma_f32_16x16x32_bf16 v[28:31], a[76:79], a[36:39], v[28:31]
ds_read_b64_tr_b16 a[108:109], v10 offset:40960
v_subrev_u32 v7, 0x8000, v7
v_mfma_f32_16x16x32_bf16 v[44:47], a[76:79], a[44:47], v[44:47]
ds_read_b64_tr_b16 a[110:111], v10 offset:41984
v_mfma_f32_16x16x32_bf16 v[44:47], a[72:75], a[40:43], v[44:47]
s_add_u32 m0, s76, 38912
ds_read_b64_tr_b16 a[112:113], v11 offset:32768
v_mfma_f32_16x16x32_bf16 v[60:63], a[72:75], a[48:51], v[60:63]
s_add_u32 s64, s73, 132480
ds_read_b64_tr_b16 a[114:115], v11 offset:33792
v_mfma_f32_16x16x32_bf16 v[60:63], a[76:79], a[52:55], v[60:63]
buffer_load_dwordx4 v12, s[48:51], s64 offen lds
v_mfma_f32_16x16x32_bf16 v[76:79], a[76:79], a[60:63], v[76:79]
ds_read_b64_tr_b16 a[116:117], v11 offset:40960
v_mfma_f32_16x16x32_bf16 v[76:79], a[72:75], a[56:59], v[76:79]
ds_read_b64_tr_b16 a[118:119], v11 offset:41984
v_mfma_f32_16x16x32_bf16 v[140:143], a[80:83], a[56:59], v[140:143]
s_add_u32 m0, s76, 39936
v_mfma_f32_16x16x32_bf16 v[140:143], a[84:87], a[60:63], v[140:143]
s_add_u32 s64, s73, 148864
v_subrev_u32 v8, 0x8000, v8
v_mfma_f32_16x16x32_bf16 v[124:127], a[84:87], a[52:55], v[124:127]
buffer_load_dwordx4 v13, s[48:51], s64 offen lds
v_mfma_f32_16x16x32_bf16 v[124:127], a[80:83], a[48:51], v[124:127]
v_mfma_f32_16x16x32_bf16 v[108:111], a[80:83], a[40:43], v[108:111]
v_mfma_f32_16x16x32_bf16 v[108:111], a[84:87], a[44:47], v[108:111]
v_mfma_f32_16x16x32_bf16 v[92:95], a[84:87], a[36:39], v[92:95]
v_subrev_u32 v9, 0x8000, v9
v_subrev_u32 v10, 0x8000, v10
v_mfma_f32_16x16x32_bf16 v[92:95], a[80:83], a[32:35], v[92:95]
v_subrev_u32 v11, 0x8000, v11
v_mfma_f32_16x16x32_bf16 v[32:35], a[88:91], a[32:35], v[32:35]
v_mfma_f32_16x16x32_bf16 v[32:35], a[92:95], a[36:39], v[32:35]
v_mfma_f32_16x16x32_bf16 v[48:51], a[92:95], a[44:47], v[48:51]
s_waitcnt lgkmcnt(0)
s_barrier
v_mfma_f32_16x16x32_bf16 v[48:51], a[88:91], a[40:43], v[48:51]
s_mov_b64 exec, 1
buffer_atomic_add a251, v1, s[52:55], s80 offen offset:0 sc1
s_mov_b64 exec, -1
s_add_u32 m0, s77, 131072
v_mfma_f32_16x16x32_bf16 v[64:67], a[88:91], a[48:51], v[64:67]
s_lshl_b32 s66, s30, 14
s_add_u32 s64, s71, 6291456
ds_read_b64_tr_b16 a[72:73], v19 offset:4096
v_mfma_f32_16x16x32_bf16 v[64:67], a[92:95], a[52:55], v[64:67]
s_add_u32 s80, s80, s66
buffer_load_dwordx4 v14, s[56:59], s64 offen lds
v_mfma_f32_16x16x32_bf16 v[80:83], a[92:95], a[60:63], v[80:83]
ds_read_b64_tr_b16 a[74:75], v19 offset:4352
v_mfma_f32_16x16x32_bf16 v[80:83], a[88:91], a[56:59], v[80:83]
ds_read_b64_tr_b16 a[76:77], v19 offset:6144
v_mfma_f32_16x16x32_bf16 v[144:147], a[96:99], a[56:59], v[144:147]
ds_read_b64_tr_b16 a[78:79], v19 offset:6400
v_mfma_f32_16x16x32_bf16 v[144:147], a[100:103], a[60:63], v[144:147]
ds_read_b128 a[64:67], v17 offset:0
v_mfma_f32_16x16x32_bf16 v[128:131], a[100:103], a[52:55], v[128:131]
ds_read_b128 a[68:71], v18 offset:0
v_mfma_f32_16x16x32_bf16 v[128:131], a[96:99], a[48:51], v[128:131]
s_add_u32 m0, s78, 147456
ds_read_b64_tr_b16 a[80:81], v21 offset:4096
v_mfma_f32_16x16x32_bf16 v[112:115], a[96:99], a[40:43], v[112:115]
s_add_u32 s64, s75, 4718592
ds_read_b64_tr_b16 a[82:83], v21 offset:4352
v_mfma_f32_16x16x32_bf16 v[112:115], a[100:103], a[44:47], v[112:115]
buffer_load_dwordx4 v23, s[60:63], s64 offen lds
v_mfma_f32_16x16x32_bf16 v[96:99], a[100:103], a[36:39], v[96:99]
ds_read_b64_tr_b16 a[84:85], v21 offset:6144
v_mfma_f32_16x16x32_bf16 v[96:99], a[96:99], a[32:35], v[96:99]
ds_read_b64_tr_b16 a[86:87], v21 offset:6400
v_mfma_f32_16x16x32_bf16 v[36:39], a[104:107], a[32:35], v[36:39]
ds_read_b64_tr_b16 a[88:89], v20 offset:4096
v_mfma_f32_16x16x32_bf16 v[36:39], a[108:111], a[36:39], v[36:39]
ds_read_b64_tr_b16 a[90:91], v20 offset:4352
v_mfma_f32_16x16x32_bf16 v[52:55], a[108:111], a[44:47], v[52:55]
ds_read_b64_tr_b16 a[92:93], v20 offset:6144
v_mfma_f32_16x16x32_bf16 v[52:55], a[104:107], a[40:43], v[52:55]
s_add_u32 m0, s77, 132096
ds_read_b64_tr_b16 a[94:95], v20 offset:6400
v_mfma_f32_16x16x32_bf16 v[68:71], a[104:107], a[48:51], v[68:71]
s_add_u32 s64, s71, 6324224
ds_read_b64_tr_b16 a[96:97], v19 offset:8192
v_mfma_f32_16x16x32_bf16 v[68:71], a[108:111], a[52:55], v[68:71]
buffer_load_dwordx4 v14, s[56:59], s64 offen lds
v_mfma_f32_16x16x32_bf16 v[84:87], a[108:111], a[60:63], v[84:87]
ds_read_b64_tr_b16 a[98:99], v19 offset:8448
v_mfma_f32_16x16x32_bf16 v[84:87], a[104:107], a[56:59], v[84:87]
ds_read_b64_tr_b16 a[100:101], v19 offset:10240
v_mfma_f32_16x16x32_bf16 v[148:151], a[112:115], a[56:59], v[148:151]
ds_read_b64_tr_b16 a[102:103], v19 offset:10496
v_mfma_f32_16x16x32_bf16 v[148:151], a[116:119], a[60:63], v[148:151]
ds_read_b64_tr_b16 a[104:105], v21 offset:8192
v_mfma_f32_16x16x32_bf16 v[132:135], a[116:119], a[52:55], v[132:135]
ds_read_b64_tr_b16 a[106:107], v21 offset:8448
v_mfma_f32_16x16x32_bf16 v[132:135], a[112:115], a[48:51], v[132:135]
s_add_u32 m0, s78, 151552
ds_read_b64_tr_b16 a[108:109], v21 offset:10240
v_mfma_f32_16x16x32_bf16 v[116:119], a[112:115], a[40:43], v[116:119]
s_add_u32 s64, s75, 4720640
ds_read_b64_tr_b16 a[110:111], v21 offset:10496
v_mfma_f32_16x16x32_bf16 v[116:119], a[116:119], a[44:47], v[116:119]
buffer_load_dwordx4 v23, s[60:63], s64 offen lds
v_mfma_f32_16x16x32_bf16 v[100:103], a[116:119], a[36:39], v[100:103]
v_mfma_f32_16x16x32_bf16 v[100:103], a[112:115], a[32:35], v[100:103]
s_waitcnt lgkmcnt(7)
ds_read_b64_tr_b16 a[112:113], v20 offset:8192
v_mfma_f32_16x16x32_bf16 v[184:187], a[72:75], a[0:3], v[184:187]
ds_read_b64_tr_b16 a[114:115], v20 offset:8448
v_mfma_f32_16x16x32_bf16 v[184:187], a[76:79], a[4:7], v[184:187]
ds_read_b64_tr_b16 a[116:117], v20 offset:10240
v_mfma_f32_16x16x32_bf16 v[192:195], a[76:79], a[12:15], v[192:195]
ds_read_b64_tr_b16 a[118:119], v20 offset:10496
v_mfma_f32_16x16x32_bf16 v[192:195], a[72:75], a[8:11], v[192:195]
s_add_u32 m0, s77, 133120
s_add_u32 s17, s78, .-L_pc+6144
v_mfma_f32_16x16x32_bf16 v[200:203], a[72:75], a[16:19], v[200:203]
s_add_u32 s64, s71, 6356992
buffer_load_dword a252, v16, s[88:91], s17 offen
v_mfma_f32_16x16x32_bf16 v[200:203], a[76:79], a[20:23], v[200:203]
buffer_load_dwordx4 v15, s[56:59], s64 offen lds
v_mfma_f32_16x16x32_bf16 v[208:211], a[76:79], a[28:31], v[208:211]
v_mfma_f32_16x16x32_bf16 v[208:211], a[72:75], a[24:27], v[208:211]
ds_read_b64_tr_b16 a[72:73], v19 offset:0
v_mfma_f32_16x16x32_bf16 v[248:251], a[80:83], a[64:67], v[248:251]
ds_read_b64_tr_b16 a[74:75], v19 offset:256
v_mfma_f32_16x16x32_bf16 v[248:251], a[84:87], a[68:71], v[248:251]
ds_read_b64_tr_b16 a[76:77], v19 offset:2048
v_mfma_f32_16x16x32_bf16 v[212:215], a[92:95], a[28:31], v[212:215]
ds_read_b64_tr_b16 a[78:79], v19 offset:2304
v_mfma_f32_16x16x32_bf16 v[212:215], a[88:91], a[24:27], v[212:215]
s_add_u32 m0, s78, 155648
ds_read_b64_tr_b16 a[80:81], v20 offset:0
v_mfma_f32_16x16x32_bf16 v[204:207], a[88:91], a[16:19], v[204:207]
s_add_u32 s64, s75, 4722688
ds_read_b64_tr_b16 a[82:83], v20 offset:256
v_mfma_f32_16x16x32_bf16 v[204:207], a[92:95], a[20:23], v[204:207]
buffer_load_dwordx4 v23, s[60:63], s64 offen lds
v_mfma_f32_16x16x32_bf16 v[196:199], a[92:95], a[12:15], v[196:199]
ds_read_b64_tr_b16 a[84:85], v20 offset:2048
v_mfma_f32_16x16x32_bf16 v[196:199], a[88:91], a[8:11], v[196:199]
ds_read_b64_tr_b16 a[86:87], v20 offset:2304
v_mfma_f32_16x16x32_bf16 v[188:191], a[88:91], a[0:3], v[188:191]
v_mfma_f32_16x16x32_bf16 v[188:191], a[92:95], a[4:7], v[188:191]
s_waitcnt lgkmcnt(7)
ds_read_b64_tr_b16 a[88:89], v4 offset:0
v_mfma_f32_16x16x32_bf16 v[216:219], a[4:7], a[100:103], v[216:219]
ds_read_b64_tr_b16 a[90:91], v4 offset:1024
v_mfma_f32_16x16x32_bf16 v[216:219], a[0:3], a[96:99], v[216:219]
s_add_u32 m0, s77, 134144
ds_read_b64_tr_b16 a[92:93], v4 offset:8192
v_mfma_f32_16x16x32_bf16 v[224:227], a[8:11], a[96:99], v[224:227]
s_add_u32 s64, s71, 6389760
ds_read_b64_tr_b16 a[94:95], v4 offset:9216
v_mfma_f32_16x16x32_bf16 v[224:227], a[12:15], a[100:103], v[224:227]
buffer_load_dwordx4 v15, s[56:59], s64 offen lds
v_mfma_f32_16x16x32_bf16 v[232:235], a[20:23], a[100:103], v[232:235]
v_mfma_f32_16x16x32_bf16 v[232:235], a[16:19], a[96:99], v[232:235]
v_mfma_f32_16x16x32_bf16 v[240:243], a[24:27], a[96:99], v[240:243]
v_mfma_f32_16x16x32_bf16 v[240:243], a[28:31], a[100:103], v[240:243]
ds_read_b64_tr_b16 a[96:97], v5 offset:0
v_mfma_f32_16x16x32_bf16 v[252:255], a[68:71], a[108:111], v[252:255]
ds_read_b64_tr_b16 a[98:99], v5 offset:1024
v_mfma_f32_16x16x32_bf16 v[252:255], a[64:67], a[104:107], v[252:255]
s_add_u32 m0, s78, 159744
ds_read_b64_tr_b16 a[100:101], v5 offset:8192
v_mfma_f32_16x16x32_bf16 v[244:247], a[24:27], a[112:115], v[244:247]
s_add_u32 s64, s74, 1536
ds_read_b64_tr_b16 a[102:103], v5 offset:9216
v_mfma_f32_16x16x32_bf16 v[244:247], a[28:31], a[116:119], v[244:247]
buffer_load_dwordx4 v22, s[48:51], s64 offen lds
v_mfma_f32_16x16x32_bf16 v[236:239], a[20:23], a[116:119], v[236:239]
ds_read_b64_tr_b16 a[104:105], v6 offset:0
v_mfma_f32_16x16x32_bf16 v[236:239], a[16:19], a[112:115], v[236:239]
ds_read_b64_tr_b16 a[106:107], v6 offset:1024
v_mfma_f32_16x16x32_bf16 v[228:231], a[8:11], a[112:115], v[228:231]
ds_read_b64_tr_b16 a[108:109], v6 offset:8192
v_mfma_f32_16x16x32_bf16 v[228:231], a[12:15], a[116:119], v[228:231]
ds_read_b64_tr_b16 a[110:111], v6 offset:9216
v_mfma_f32_16x16x32_bf16 v[220:223], a[4:7], a[116:119], v[220:223]
v_mfma_f32_16x16x32_bf16 v[220:223], a[0:3], a[112:115], v[220:223]
s_waitcnt lgkmcnt(7)
ds_read_b64_tr_b16 a[112:113], v7 offset:0
v_mfma_f32_16x16x32_bf16 v[152:155], a[72:75], a[0:3], v[152:155]
ds_read_b64_tr_b16 a[114:115], v7 offset:1024
v_mfma_f32_16x16x32_bf16 v[152:155], a[76:79], a[4:7], v[152:155]
ds_read_b64_tr_b16 a[116:117], v7 offset:8192
v_mfma_f32_16x16x32_bf16 v[160:163], a[76:79], a[12:15], v[160:163]
s_add_u32 m0, s76, 0
ds_read_b64_tr_b16 a[118:119], v7 offset:9216
v_mfma_f32_16x16x32_bf16 v[160:163], a[72:75], a[8:11], v[160:163]
s_add_u32 s64, s72, 1536
v_mfma_f32_16x16x32_bf16 v[168:171], a[72:75], a[16:19], v[168:171]
buffer_load_dwordx4 v12, s[48:51], s64 offen lds
v_mfma_f32_16x16x32_bf16 v[168:171], a[76:79], a[20:23], v[168:171]
v_mfma_f32_16x16x32_bf16 v[176:179], a[76:79], a[28:31], v[176:179]
v_mfma_f32_16x16x32_bf16 v[176:179], a[72:75], a[24:27], v[176:179]
s_add_u32 m0, s76, 1024
ds_read_b64_tr_b16 a[72:73], v8 offset:0
v_mfma_f32_16x16x32_bf16 v[180:183], a[80:83], a[24:27], v[180:183]
s_add_u32 s64, s72, 17920
ds_read_b64_tr_b16 a[74:75], v8 offset:1024
v_mfma_f32_16x16x32_bf16 v[180:183], a[84:87], a[28:31], v[180:183]
buffer_load_dwordx4 v13, s[48:51], s64 offen lds
v_mfma_f32_16x16x32_bf16 v[172:175], a[84:87], a[20:23], v[172:175]
ds_read_b64_tr_b16 a[76:77], v8 offset:8192
v_mfma_f32_16x16x32_bf16 v[172:175], a[80:83], a[16:19], v[172:175]
ds_read_b64_tr_b16 a[78:79], v8 offset:9216
v_mfma_f32_16x16x32_bf16 v[164:167], a[80:83], a[8:11], v[164:167]
v_mfma_f32_16x16x32_bf16 v[164:167], a[84:87], a[12:15], v[164:167]
s_add_u32 m0, s76, 2048
v_mfma_f32_16x16x32_bf16 v[156:159], a[84:87], a[4:7], v[156:159]
s_add_u32 s64, s72, 132608
v_mfma_f32_16x16x32_bf16 v[156:159], a[80:83], a[0:3], v[156:159]
buffer_load_dwordx4 v12, s[48:51], s64 offen lds
v_mfma_f32_16x16x32_bf16 v[24:27], a[88:91], a[0:3], v[24:27]
ds_read_b64_tr_b16 a[80:81], v9 offset:0
v_mfma_f32_16x16x32_bf16 v[24:27], a[92:95], a[4:7], v[24:27]
ds_read_b64_tr_b16 a[82:83], v9 offset:1024
v_mfma_f32_16x16x32_bf16 v[40:43], a[92:95], a[12:15], v[40:43]
s_waitcnt vmcnt(13)
s_add_u32 m0, s76, 3072
ds_read_b64_tr_b16 a[84:85], v9 offset:8192
v_mfma_f32_16x16x32_bf16 v[40:43], a[88:91], a[8:11], v[40:43]
s_add_u32 s64, s72, 148992
ds_read_b64_tr_b16 a[86:87], v9 offset:9216
v_mfma_f32_16x16x32_bf16 v[56:59], a[88:91], a[16:19], v[56:59]
buffer_load_dwordx4 v13, s[48:51], s64 offen lds
v_mfma_f32_16x16x32_bf16 v[56:59], a[92:95], a[20:23], v[56:59]
ds_read_b128 a[32:35], v2 offset:32768
v_mfma_f32_16x16x32_bf16 v[72:75], a[92:95], a[28:31], v[72:75]
ds_read_b128 a[36:39], v3 offset:32768
v_mfma_f32_16x16x32_bf16 v[72:75], a[88:91], a[24:27], v[72:75]
s_waitcnt lgkmcnt(6)
ds_read_b128 a[40:43], v2 offset:34816
v_mfma_f32_16x16x32_bf16 v[136:139], a[96:99], a[24:27], v[136:139]
s_add_u32 m0, s76, 4096
ds_read_b128 a[44:47], v3 offset:34816
v_mfma_f32_16x16x32_bf16 v[136:139], a[100:103], a[28:31], v[136:139]
s_add_u32 s64, s73, 1536
ds_read_b128 a[48:51], v2 offset:36864
v_mfma_f32_16x16x32_bf16 v[120:123], a[100:103], a[20:23], v[120:123]
buffer_load_dwordx4 v12, s[48:51], s64 offen lds
v_mfma_f32_16x16x32_bf16 v[120:123], a[96:99], a[16:19], v[120:123]
ds_read_b128 a[52:55], v3 offset:36864
v_mfma_f32_16x16x32_bf16 v[104:107], a[96:99], a[8:11], v[104:107]
ds_read_b128 a[56:59], v2 offset:38912
v_mfma_f32_16x16x32_bf16 v[104:107], a[100:103], a[12:15], v[104:107]
s_add_u32 m0, s76, 5120
ds_read_b128 a[60:63], v3 offset:38912
v_mfma_f32_16x16x32_bf16 v[88:91], a[100:103], a[4:7], v[88:91]
s_add_u32 s64, s73, 17920
ds_read_b64_tr_b16 a[88:89], v10 offset:0
v_mfma_f32_16x16x32_bf16 v[88:91], a[96:99], a[0:3], v[88:91]
buffer_load_dwordx4 v13, s[48:51], s64 offen lds
v_mfma_f32_16x16x32_bf16 v[28:31], a[104:107], a[0:3], v[28:31]
ds_read_b64_tr_b16 a[90:91], v10 offset:1024
v_mfma_f32_16x16x32_bf16 v[28:31], a[108:111], a[4:7], v[28:31]
ds_read_b64_tr_b16 a[92:93], v10 offset:8192
v_mfma_f32_16x16x32_bf16 v[44:47], a[108:111], a[12:15], v[44:47]
ds_read_b64_tr_b16 a[94:95], v10 offset:9216
v_mfma_f32_16x16x32_bf16 v[44:47], a[104:107], a[8:11], v[44:47]
s_add_u32 m0, s76, 6144
ds_read_b64_tr_b16 a[96:97], v11 offset:0
v_mfma_f32_16x16x32_bf16 v[60:63], a[104:107], a[16:19], v[60:63]
s_add_u32 s64, s73, 132608
ds_read_b64_tr_b16 a[98:99], v11 offset:1024
v_mfma_f32_16x16x32_bf16 v[60:63], a[108:111], a[20:23], v[60:63]
buffer_load_dwordx4 v12, s[48:51], s64 offen lds
v_mfma_f32_16x16x32_bf16 v[76:79], a[108:111], a[28:31], v[76:79]
ds_read_b64_tr_b16 a[100:101], v11 offset:8192
v_mfma_f32_16x16x32_bf16 v[76:79], a[104:107], a[24:27], v[76:79]
ds_read_b64_tr_b16 a[102:103], v11 offset:9216
v_mfma_f32_16x16x32_bf16 v[140:143], a[112:115], a[24:27], v[140:143]
s_add_u32 m0, s76, 7168
v_mfma_f32_16x16x32_bf16 v[140:143], a[116:119], a[28:31], v[140:143]
s_add_u32 s64, s73, 148992
v_mfma_f32_16x16x32_bf16 v[124:127], a[116:119], a[20:23], v[124:127]
buffer_load_dwordx4 v13, s[48:51], s64 offen lds
v_mfma_f32_16x16x32_bf16 v[124:127], a[112:115], a[16:19], v[124:127]
v_mfma_f32_16x16x32_bf16 v[108:111], a[112:115], a[8:11], v[108:111]
v_mfma_f32_16x16x32_bf16 v[108:111], a[116:119], a[12:15], v[108:111]
v_mfma_f32_16x16x32_bf16 v[92:95], a[116:119], a[4:7], v[92:95]
v_mfma_f32_16x16x32_bf16 v[92:95], a[112:115], a[0:3], v[92:95]
v_mfma_f32_16x16x32_bf16 v[32:35], a[72:75], a[0:3], v[32:35]
v_mfma_f32_16x16x32_bf16 v[32:35], a[76:79], a[4:7], v[32:35]
v_mfma_f32_16x16x32_bf16 v[48:51], a[76:79], a[12:15], v[48:51]
s_waitcnt lgkmcnt(0)
s_barrier
v_mfma_f32_16x16x32_bf16 v[48:51], a[72:75], a[8:11], v[48:51]
s_add_u32 m0, s77, 65536
ds_read_b64_tr_b16 a[104:105], v19 offset:36864
v_mfma_f32_16x16x32_bf16 v[64:67], a[72:75], a[16:19], v[64:67]
s_add_u32 s64, s71, 6815744
ds_read_b64_tr_b16 a[106:107], v19 offset:37120
v_mfma_f32_16x16x32_bf16 v[64:67], a[76:79], a[20:23], v[64:67]
buffer_load_dwordx4 v14, s[56:59], s64 offen lds
v_mfma_f32_16x16x32_bf16 v[80:83], a[76:79], a[28:31], v[80:83]
ds_read_b64_tr_b16 a[108:109], v19 offset:38912
v_mfma_f32_16x16x32_bf16 v[80:83], a[72:75], a[24:27], v[80:83]
ds_read_b64_tr_b16 a[110:111], v19 offset:39168
v_mfma_f32_16x16x32_bf16 v[144:147], a[80:83], a[24:27], v[144:147]
ds_read_b128 a[64:67], v17 offset:32768
v_mfma_f32_16x16x32_bf16 v[144:147], a[84:87], a[28:31], v[144:147]
ds_read_b128 a[68:71], v18 offset:32768
v_mfma_f32_16x16x32_bf16 v[128:131], a[84:87], a[20:23], v[128:131]
ds_read_b64_tr_b16 a[112:113], v21 offset:36864
v_mfma_f32_16x16x32_bf16 v[128:131], a[80:83], a[16:19], v[128:131]
s_add_u32 m0, s78, 81920
ds_read_b64_tr_b16 a[114:115], v21 offset:37120
v_mfma_f32_16x16x32_bf16 v[112:115], a[80:83], a[8:11], v[112:115]
s_add_u32 s64, s75, 5111808
ds_read_b64_tr_b16 a[116:117], v21 offset:38912
v_mfma_f32_16x16x32_bf16 v[112:115], a[84:87], a[12:15], v[112:115]
buffer_load_dwordx4 v23, s[60:63], s64 offen lds
v_mfma_f32_16x16x32_bf16 v[96:99], a[84:87], a[4:7], v[96:99]
ds_read_b64_tr_b16 a[118:119], v21 offset:39168
v_mfma_f32_16x16x32_bf16 v[96:99], a[80:83], a[0:3], v[96:99]
ds_read_b64_tr_b16 a[72:73], v20 offset:36864
v_mfma_f32_16x16x32_bf16 v[36:39], a[88:91], a[0:3], v[36:39]
ds_read_b64_tr_b16 a[74:75], v20 offset:37120
v_mfma_f32_16x16x32_bf16 v[36:39], a[92:95], a[4:7], v[36:39]
ds_read_b64_tr_b16 a[76:77], v20 offset:38912
v_mfma_f32_16x16x32_bf16 v[52:55], a[92:95], a[12:15], v[52:55]
ds_read_b64_tr_b16 a[78:79], v20 offset:39168
v_mfma_f32_16x16x32_bf16 v[52:55], a[88:91], a[8:11], v[52:55]
s_add_u32 m0, s77, 66560
ds_read_b64_tr_b16 a[80:81], v19 offset:40960
v_mfma_f32_16x16x32_bf16 v[68:71], a[88:91], a[16:19], v[68:71]
s_add_u32 s64, s71, 6848512
ds_read_b64_tr_b16 a[82:83], v19 offset:41216
v_mfma_f32_16x16x32_bf16 v[68:71], a[92:95], a[20:23], v[68:71]
buffer_load_dwordx4 v14, s[56:59], s64 offen lds
v_mfma_f32_16x16x32_bf16 v[84:87], a[92:95], a[28:31], v[84:87]
ds_read_b64_tr_b16 a[84:85], v19 offset:43008
v_mfma_f32_16x16x32_bf16 v[84:87], a[88:91], a[24:27], v[84:87]
ds_read_b64_tr_b16 a[86:87], v19 offset:43264
v_mfma_f32_16x16x32_bf16 v[148:151], a[96:99], a[24:27], v[148:151]
ds_read_b64_tr_b16 a[88:89], v21 offset:40960
v_mfma_f32_16x16x32_bf16 v[148:151], a[100:103], a[28:31], v[148:151]
ds_read_b64_tr_b16 a[90:91], v21 offset:41216
v_mfma_f32_16x16x32_bf16 v[132:135], a[100:103], a[20:23], v[132:135]
ds_read_b64_tr_b16 a[92:93], v21 offset:43008
v_mfma_f32_16x16x32_bf16 v[132:135], a[96:99], a[16:19], v[132:135]
s_add_u32 m0, s78, 86016
ds_read_b64_tr_b16 a[94:95], v21 offset:43264
v_mfma_f32_16x16x32_bf16 v[116:119], a[96:99], a[8:11], v[116:119]
s_add_u32 s64, s75, 5113856
v_mfma_f32_16x16x32_bf16 v[116:119], a[100:103], a[12:15], v[116:119]
buffer_load_dwordx4 v23, s[60:63], s64 offen lds
v_mfma_f32_16x16x32_bf16 v[100:103], a[100:103], a[4:7], v[100:103]
v_mfma_f32_16x16x32_bf16 v[100:103], a[96:99], a[0:3], v[100:103]
s_waitcnt lgkmcnt(6)
ds_read_b64_tr_b16 a[96:97], v20 offset:40960
v_mfma_f32_16x16x32_bf16 v[184:187], a[104:107], a[32:35], v[184:187]
ds_read_b64_tr_b16 a[98:99], v20 offset:41216
v_mfma_f32_16x16x32_bf16 v[184:187], a[108:111], a[36:39], v[184:187]
ds_read_b64_tr_b16 a[100:101], v20 offset:43008
v_add_u32 v17, 0x8000, v17
v_mfma_f32_16x16x32_bf16 v[192:195], a[108:111], a[44:47], v[192:195]
ds_read_b64_tr_b16 a[102:103], v20 offset:43264
v_add_u32 v18, 0x8000, v18
v_mfma_f32_16x16x32_bf16 v[192:195], a[104:107], a[40:43], v[192:195]
s_add_u32 m0, s77, 67584
v_mfma_f32_16x16x32_bf16 v[200:203], a[104:107], a[48:51], v[200:203]
s_add_u32 s64, s71, 6881280
v_mfma_f32_16x16x32_bf16 v[200:203], a[108:111], a[52:55], v[200:203]
buffer_load_dwordx4 v15, s[56:59], s64 offen lds
v_mfma_f32_16x16x32_bf16 v[208:211], a[108:111], a[60:63], v[208:211]
v_mfma_f32_16x16x32_bf16 v[208:211], a[104:107], a[56:59], v[208:211]
ds_read_b64_tr_b16 a[104:105], v19 offset:32768
v_mfma_f32_16x16x32_bf16 v[248:251], a[112:115], a[64:67], v[248:251]
ds_read_b64_tr_b16 a[106:107], v19 offset:33024
v_mfma_f32_16x16x32_bf16 v[248:251], a[116:119], a[68:71], v[248:251]
ds_read_b64_tr_b16 a[108:109], v19 offset:34816
v_mfma_f32_16x16x32_bf16 v[212:215], a[76:79], a[60:63], v[212:215]
ds_read_b64_tr_b16 a[110:111], v19 offset:35072
v_mfma_f32_16x16x32_bf16 v[212:215], a[72:75], a[56:59], v[212:215]
s_add_u32 m0, s78, 90112
ds_read_b64_tr_b16 a[112:113], v20 offset:32768
v_mfma_f32_16x16x32_bf16 v[204:207], a[72:75], a[48:51], v[204:207]
s_add_u32 s64, s75, 5115904
ds_read_b64_tr_b16 a[114:115], v20 offset:33024
v_mfma_f32_16x16x32_bf16 v[204:207], a[76:79], a[52:55], v[204:207]
buffer_load_dwordx4 v23, s[60:63], s64 offen lds
v_mfma_f32_16x16x32_bf16 v[196:199], a[76:79], a[44:47], v[196:199]
ds_read_b64_tr_b16 a[116:117], v20 offset:34816
v_mfma_f32_16x16x32_bf16 v[196:199], a[72:75], a[40:43], v[196:199]
ds_read_b64_tr_b16 a[118:119], v20 offset:35072
v_mfma_f32_16x16x32_bf16 v[188:191], a[72:75], a[32:35], v[188:191]
v_mfma_f32_16x16x32_bf16 v[188:191], a[76:79], a[36:39], v[188:191]
s_waitcnt lgkmcnt(7)
ds_read_b64_tr_b16 a[72:73], v4 offset:32768
v_mfma_f32_16x16x32_bf16 v[216:219], a[36:39], a[84:87], v[216:219]
ds_read_b64_tr_b16 a[74:75], v4 offset:33792
v_mfma_f32_16x16x32_bf16 v[216:219], a[32:35], a[80:83], v[216:219]
s_add_u32 m0, s77, 68608
ds_read_b64_tr_b16 a[76:77], v4 offset:40960
v_add_u32 v21, 0x8000, v21
v_mfma_f32_16x16x32_bf16 v[224:227], a[40:43], a[80:83], v[224:227]
s_add_u32 s64, s71, 6914048
ds_read_b64_tr_b16 a[78:79], v4 offset:41984
v_mfma_f32_16x16x32_bf16 v[224:227], a[44:47], a[84:87], v[224:227]
buffer_load_dwordx4 v15, s[56:59], s64 offen lds
v_mfma_f32_16x16x32_bf16 v[232:235], a[52:55], a[84:87], v[232:235]
v_mfma_f32_16x16x32_bf16 v[232:235], a[48:51], a[80:83], v[232:235]
v_mfma_f32_16x16x32_bf16 v[240:243], a[56:59], a[80:83], v[240:243]
v_mfma_f32_16x16x32_bf16 v[240:243], a[60:63], a[84:87], v[240:243]
ds_read_b64_tr_b16 a[80:81], v5 offset:32768
v_mfma_f32_16x16x32_bf16 v[252:255], a[68:71], a[92:95], v[252:255]
ds_read_b64_tr_b16 a[82:83], v5 offset:33792
v_mfma_f32_16x16x32_bf16 v[252:255], a[64:67], a[88:91], v[252:255]
s_add_u32 m0, s78, 94208
ds_read_b64_tr_b16 a[84:85], v5 offset:40960
v_mfma_f32_16x16x32_bf16 v[244:247], a[56:59], a[96:99], v[244:247]
s_add_u32 s64, s74, 1664
ds_read_b64_tr_b16 a[86:87], v5 offset:41984
v_mfma_f32_16x16x32_bf16 v[244:247], a[60:63], a[100:103], v[244:247]
buffer_load_dwordx4 v22, s[48:51], s64 offen lds
v_mfma_f32_16x16x32_bf16 v[236:239], a[52:55], a[100:103], v[236:239]
ds_read_b64_tr_b16 a[88:89], v6 offset:32768
v_add_u32 v19, 0x8000, v19
v_mfma_f32_16x16x32_bf16 v[236:239], a[48:51], a[96:99], v[236:239]
ds_read_b64_tr_b16 a[90:91], v6 offset:33792
v_mfma_f32_16x16x32_bf16 v[228:231], a[40:43], a[96:99], v[228:231]
ds_read_b64_tr_b16 a[92:93], v6 offset:40960
v_mfma_f32_16x16x32_bf16 v[228:231], a[44:47], a[100:103], v[228:231]
ds_read_b64_tr_b16 a[94:95], v6 offset:41984
v_mfma_f32_16x16x32_bf16 v[220:223], a[36:39], a[100:103], v[220:223]
v_mfma_f32_16x16x32_bf16 v[220:223], a[32:35], a[96:99], v[220:223]
s_waitcnt lgkmcnt(7)
ds_read_b64_tr_b16 a[96:97], v7 offset:32768
v_mfma_f32_16x16x32_bf16 v[152:155], a[104:107], a[32:35], v[152:155]
ds_read_b64_tr_b16 a[98:99], v7 offset:33792
v_mfma_f32_16x16x32_bf16 v[152:155], a[108:111], a[36:39], v[152:155]
ds_read_b64_tr_b16 a[100:101], v7 offset:40960
v_add_u32 v20, 0x8000, v20
v_mfma_f32_16x16x32_bf16 v[160:163], a[108:111], a[44:47], v[160:163]
s_add_u32 m0, s76, 32768
ds_read_b64_tr_b16 a[102:103], v7 offset:41984
v_mfma_f32_16x16x32_bf16 v[160:163], a[104:107], a[40:43], v[160:163]
s_add_u32 s64, s72, 1664
v_mfma_f32_16x16x32_bf16 v[168:171], a[104:107], a[48:51], v[168:171]
buffer_load_dwordx4 v12, s[48:51], s64 offen lds
v_mfma_f32_16x16x32_bf16 v[168:171], a[108:111], a[52:55], v[168:171]
v_mfma_f32_16x16x32_bf16 v[176:179], a[108:111], a[60:63], v[176:179]
v_mfma_f32_16x16x32_bf16 v[176:179], a[104:107], a[56:59], v[176:179]
s_add_u32 m0, s76, 33792
ds_read_b64_tr_b16 a[104:105], v8 offset:32768
v_mfma_f32_16x16x32_bf16 v[180:183], a[112:115], a[56:59], v[180:183]
s_add_u32 s64, s72, 18048
ds_read_b64_tr_b16 a[106:107], v8 offset:33792
v_mfma_f32_16x16x32_bf16 v[180:183], a[116:119], a[60:63], v[180:183]
buffer_load_dwordx4 v13, s[48:51], s64 offen lds
v_mfma_f32_16x16x32_bf16 v[172:175], a[116:119], a[52:55], v[172:175]
ds_read_b64_tr_b16 a[108:109], v8 offset:40960
v_add_u32 v4, 0x8000, v4
v_mfma_f32_16x16x32_bf16 v[172:175], a[112:115], a[48:51], v[172:175]
ds_read_b64_tr_b16 a[110:111], v8 offset:41984
v_mfma_f32_16x16x32_bf16 v[164:167], a[112:115], a[40:43], v[164:167]
v_mfma_f32_16x16x32_bf16 v[164:167], a[116:119], a[44:47], v[164:167]
s_add_u32 m0, s76, 34816
v_mfma_f32_16x16x32_bf16 v[156:159], a[116:119], a[36:39], v[156:159]
s_add_u32 s64, s72, 132736
v_mfma_f32_16x16x32_bf16 v[156:159], a[112:115], a[32:35], v[156:159]
buffer_load_dwordx4 v12, s[48:51], s64 offen lds
v_mfma_f32_16x16x32_bf16 v[24:27], a[72:75], a[32:35], v[24:27]
ds_read_b64_tr_b16 a[112:113], v9 offset:32768
v_mfma_f32_16x16x32_bf16 v[24:27], a[76:79], a[36:39], v[24:27]
ds_read_b64_tr_b16 a[114:115], v9 offset:33792
v_add_u32 v5, 0x8000, v5
v_mfma_f32_16x16x32_bf16 v[40:43], a[76:79], a[44:47], v[40:43]
s_waitcnt vmcnt(11)
s_add_u32 m0, s76, 35840
ds_read_b64_tr_b16 a[116:117], v9 offset:40960
v_mfma_f32_16x16x32_bf16 v[40:43], a[72:75], a[40:43], v[40:43]
s_add_u32 s64, s72, 149120
ds_read_b64_tr_b16 a[118:119], v9 offset:41984
v_mfma_f32_16x16x32_bf16 v[56:59], a[72:75], a[48:51], v[56:59]
buffer_load_dwordx4 v13, s[48:51], s64 offen lds
v_mfma_f32_16x16x32_bf16 v[56:59], a[76:79], a[52:55], v[56:59]
ds_read_b128 a[0:3], v2 offset:0
v_mfma_f32_16x16x32_bf16 v[72:75], a[76:79], a[60:63], v[72:75]
ds_read_b128 a[4:7], v3 offset:0
v_mfma_f32_16x16x32_bf16 v[72:75], a[72:75], a[56:59], v[72:75]
s_waitcnt lgkmcnt(6)
ds_read_b128 a[8:11], v2 offset:2048
v_mfma_f32_16x16x32_bf16 v[136:139], a[80:83], a[56:59], v[136:139]
s_add_u32 m0, s76, 36864
ds_read_b128 a[12:15], v3 offset:2048
v_mfma_f32_16x16x32_bf16 v[136:139], a[84:87], a[60:63], v[136:139]
s_add_u32 s64, s73, 1664
ds_read_b128 a[16:19], v2 offset:4096
v_add_u32 v6, 0x8000, v6
v_mfma_f32_16x16x32_bf16 v[120:123], a[84:87], a[52:55], v[120:123]
buffer_load_dwordx4 v12, s[48:51], s64 offen lds
v_mfma_f32_16x16x32_bf16 v[120:123], a[80:83], a[48:51], v[120:123]
ds_read_b128 a[20:23], v3 offset:4096
v_mfma_f32_16x16x32_bf16 v[104:107], a[80:83], a[40:43], v[104:107]
ds_read_b128 a[24:27], v2 offset:6144
v_mfma_f32_16x16x32_bf16 v[104:107], a[84:87], a[44:47], v[104:107]
s_add_u32 m0, s76, 37888
ds_read_b128 a[28:31], v3 offset:6144
v_mfma_f32_16x16x32_bf16 v[88:91], a[84:87], a[36:39], v[88:91]
s_add_u32 s64, s73, 18048
ds_read_b64_tr_b16 a[72:73], v10 offset:32768
v_mfma_f32_16x16x32_bf16 v[88:91], a[80:83], a[32:35], v[88:91]
buffer_load_dwordx4 v13, s[48:51], s64 offen lds
v_mfma_f32_16x16x32_bf16 v[28:31], a[88:91], a[32:35], v[28:31]
ds_read_b64_tr_b16 a[74:75], v10 offset:33792
v_mfma_f32_16x16x32_bf16 v[28:31], a[92:95], a[36:39], v[28:31]
ds_read_b64_tr_b16 a[76:77], v10 offset:40960
v_add_u32 v7, 0x8000, v7
v_mfma_f32_16x16x32_bf16 v[44:47], a[92:95], a[44:47], v[44:47]
ds_read_b64_tr_b16 a[78:79], v10 offset:41984
v_mfma_f32_16x16x32_bf16 v[44:47], a[88:91], a[40:43], v[44:47]
s_add_u32 m0, s76, 38912
ds_read_b64_tr_b16 a[80:81], v11 offset:32768
v_mfma_f32_16x16x32_bf16 v[60:63], a[88:91], a[48:51], v[60:63]
s_add_u32 s64, s73, 132736
ds_read_b64_tr_b16 a[82:83], v11 offset:33792
v_mfma_f32_16x16x32_bf16 v[60:63], a[92:95], a[52:55], v[60:63]
buffer_load_dwordx4 v12, s[48:51], s64 offen lds
v_mfma_f32_16x16x32_bf16 v[76:79], a[92:95], a[60:63], v[76:79]
ds_read_b64_tr_b16 a[84:85], v11 offset:40960
v_mfma_f32_16x16x32_bf16 v[76:79], a[88:91], a[56:59], v[76:79]
ds_read_b64_tr_b16 a[86:87], v11 offset:41984
v_mfma_f32_16x16x32_bf16 v[140:143], a[96:99], a[56:59], v[140:143]
s_add_u32 m0, s76, 39936
v_mfma_f32_16x16x32_bf16 v[140:143], a[100:103], a[60:63], v[140:143]
s_add_u32 s64, s73, 149120
v_add_u32 v8, 0x8000, v8
v_mfma_f32_16x16x32_bf16 v[124:127], a[100:103], a[52:55], v[124:127]
buffer_load_dwordx4 v13, s[48:51], s64 offen lds
v_mfma_f32_16x16x32_bf16 v[124:127], a[96:99], a[48:51], v[124:127]
v_mfma_f32_16x16x32_bf16 v[108:111], a[96:99], a[40:43], v[108:111]
v_mfma_f32_16x16x32_bf16 v[108:111], a[100:103], a[44:47], v[108:111]
v_mfma_f32_16x16x32_bf16 v[92:95], a[100:103], a[36:39], v[92:95]
v_add_u32 v9, 0x8000, v9
v_add_u32 v10, 0x8000, v10
v_mfma_f32_16x16x32_bf16 v[92:95], a[96:99], a[32:35], v[92:95]
v_add_u32 v11, 0x8000, v11
v_mfma_f32_16x16x32_bf16 v[32:35], a[104:107], a[32:35], v[32:35]
v_mfma_f32_16x16x32_bf16 v[32:35], a[108:111], a[36:39], v[32:35]
v_mfma_f32_16x16x32_bf16 v[48:51], a[108:111], a[44:47], v[48:51]
s_waitcnt lgkmcnt(0)
s_barrier
v_mfma_f32_16x16x32_bf16 v[48:51], a[104:107], a[40:43], v[48:51]
s_add_u32 m0, s77, 98304
ds_read_b64_tr_b16 a[88:89], v19 offset:36864
v_mfma_f32_16x16x32_bf16 v[64:67], a[104:107], a[48:51], v[64:67]
s_add_u32 s64, s71, 7340032
ds_read_b64_tr_b16 a[90:91], v19 offset:37120
v_mfma_f32_16x16x32_bf16 v[64:67], a[108:111], a[52:55], v[64:67]
buffer_load_dwordx4 v14, s[56:59], s64 offen lds
v_mfma_f32_16x16x32_bf16 v[80:83], a[108:111], a[60:63], v[80:83]
ds_read_b64_tr_b16 a[92:93], v19 offset:38912
v_mfma_f32_16x16x32_bf16 v[80:83], a[104:107], a[56:59], v[80:83]
ds_read_b64_tr_b16 a[94:95], v19 offset:39168
v_mfma_f32_16x16x32_bf16 v[144:147], a[112:115], a[56:59], v[144:147]
ds_read_b128 a[64:67], v17 offset:32768
v_mfma_f32_16x16x32_bf16 v[144:147], a[116:119], a[60:63], v[144:147]
ds_read_b128 a[68:71], v18 offset:32768
v_mfma_f32_16x16x32_bf16 v[128:131], a[116:119], a[52:55], v[128:131]
ds_read_b64_tr_b16 a[96:97], v21 offset:36864
v_mfma_f32_16x16x32_bf16 v[128:131], a[112:115], a[48:51], v[128:131]
s_add_u32 m0, s78, 114688
ds_read_b64_tr_b16 a[98:99], v21 offset:37120
v_mfma_f32_16x16x32_bf16 v[112:115], a[112:115], a[40:43], v[112:115]
s_add_u32 s64, s75, 5505024
ds_read_b64_tr_b16 a[100:101], v21 offset:38912
v_mfma_f32_16x16x32_bf16 v[112:115], a[116:119], a[44:47], v[112:115]
buffer_load_dwordx4 v23, s[60:63], s64 offen lds
v_mfma_f32_16x16x32_bf16 v[96:99], a[116:119], a[36:39], v[96:99]
ds_read_b64_tr_b16 a[102:103], v21 offset:39168
v_mfma_f32_16x16x32_bf16 v[96:99], a[112:115], a[32:35], v[96:99]
ds_read_b64_tr_b16 a[104:105], v20 offset:36864
v_mfma_f32_16x16x32_bf16 v[36:39], a[72:75], a[32:35], v[36:39]
ds_read_b64_tr_b16 a[106:107], v20 offset:37120
v_mfma_f32_16x16x32_bf16 v[36:39], a[76:79], a[36:39], v[36:39]
ds_read_b64_tr_b16 a[108:109], v20 offset:38912
v_mfma_f32_16x16x32_bf16 v[52:55], a[76:79], a[44:47], v[52:55]
ds_read_b64_tr_b16 a[110:111], v20 offset:39168
v_mfma_f32_16x16x32_bf16 v[52:55], a[72:75], a[40:43], v[52:55]
s_add_u32 m0, s77, 99328
ds_read_b64_tr_b16 a[112:113], v19 offset:40960
v_mfma_f32_16x16x32_bf16 v[68:71], a[72:75], a[48:51], v[68:71]
s_add_u32 s64, s71, 7372800
ds_read_b64_tr_b16 a[114:115], v19 offset:41216
v_mfma_f32_16x16x32_bf16 v[68:71], a[76:79], a[52:55], v[68:71]
buffer_load_dwordx4 v14, s[56:59], s64 offen lds
v_mfma_f32_16x16x32_bf16 v[84:87], a[76:79], a[60:63], v[84:87]
ds_read_b64_tr_b16 a[116:117], v19 offset:43008
v_mfma_f32_16x16x32_bf16 v[84:87], a[72:75], a[56:59], v[84:87]
ds_read_b64_tr_b16 a[118:119], v19 offset:43264
v_mfma_f32_16x16x32_bf16 v[148:151], a[80:83], a[56:59], v[148:151]
ds_read_b64_tr_b16 a[72:73], v21 offset:40960
v_mfma_f32_16x16x32_bf16 v[148:151], a[84:87], a[60:63], v[148:151]
ds_read_b64_tr_b16 a[74:75], v21 offset:41216
v_mfma_f32_16x16x32_bf16 v[132:135], a[84:87], a[52:55], v[132:135]
ds_read_b64_tr_b16 a[76:77], v21 offset:43008
v_mfma_f32_16x16x32_bf16 v[132:135], a[80:83], a[48:51], v[132:135]
s_add_u32 m0, s78, 118784
ds_read_b64_tr_b16 a[78:79], v21 offset:43264
v_mfma_f32_16x16x32_bf16 v[116:119], a[80:83], a[40:43], v[116:119]
s_add_u32 s64, s75, 5507072
v_mfma_f32_16x16x32_bf16 v[116:119], a[84:87], a[44:47], v[116:119]
buffer_load_dwordx4 v23, s[60:63], s64 offen lds
v_mfma_f32_16x16x32_bf16 v[100:103], a[84:87], a[36:39], v[100:103]
v_mfma_f32_16x16x32_bf16 v[100:103], a[80:83], a[32:35], v[100:103]
s_waitcnt lgkmcnt(6)
ds_read_b64_tr_b16 a[80:81], v20 offset:40960
v_mfma_f32_16x16x32_bf16 v[184:187], a[88:91], a[0:3], v[184:187]
ds_read_b64_tr_b16 a[82:83], v20 offset:41216
v_mfma_f32_16x16x32_bf16 v[184:187], a[92:95], a[4:7], v[184:187]
ds_read_b64_tr_b16 a[84:85], v20 offset:43008
v_subrev_u32 v17, 0x8000, v17
v_mfma_f32_16x16x32_bf16 v[192:195], a[92:95], a[12:15], v[192:195]
ds_read_b64_tr_b16 a[86:87], v20 offset:43264
v_subrev_u32 v18, 0x8000, v18
v_mfma_f32_16x16x32_bf16 v[192:195], a[88:91], a[8:11], v[192:195]
s_add_u32 m0, s77, 100352
s_add_u32 s17, s78, .-L_pc+6144
v_mfma_f32_16x16x32_bf16 v[200:203], a[88:91], a[16:19], v[200:203]
s_add_u32 s64, s71, 7405568
buffer_load_dword a252, v16, s[88:91], s17 offen
v_mfma_f32_16x16x32_bf16 v[200:203], a[92:95], a[20:23], v[200:203]
buffer_load_dwordx4 v15, s[56:59], s64 offen lds
v_mfma_f32_16x16x32_bf16 v[208:211], a[92:95], a[28:31], v[208:211]
v_mfma_f32_16x16x32_bf16 v[208:211], a[88:91], a[24:27], v[208:211]
ds_read_b64_tr_b16 a[88:89], v19 offset:32768
v_mfma_f32_16x16x32_bf16 v[248:251], a[96:99], a[64:67], v[248:251]
ds_read_b64_tr_b16 a[90:91], v19 offset:33024
v_mfma_f32_16x16x32_bf16 v[248:251], a[100:103], a[68:71], v[248:251]
ds_read_b64_tr_b16 a[92:93], v19 offset:34816
v_mfma_f32_16x16x32_bf16 v[212:215], a[108:111], a[28:31], v[212:215]
ds_read_b64_tr_b16 a[94:95], v19 offset:35072
v_mfma_f32_16x16x32_bf16 v[212:215], a[104:107], a[24:27], v[212:215]
s_add_u32 m0, s78, 122880
ds_read_b64_tr_b16 a[96:97], v20 offset:32768
v_mfma_f32_16x16x32_bf16 v[204:207], a[104:107], a[16:19], v[204:207]
s_add_u32 s64, s75, 5509120
ds_read_b64_tr_b16 a[98:99], v20 offset:33024
v_mfma_f32_16x16x32_bf16 v[204:207], a[108:111], a[20:23], v[204:207]
buffer_load_dwordx4 v23, s[60:63], s64 offen lds
v_mfma_f32_16x16x32_bf16 v[196:199], a[108:111], a[12:15], v[196:199]
ds_read_b64_tr_b16 a[100:101], v20 offset:34816
v_mfma_f32_16x16x32_bf16 v[196:199], a[104:107], a[8:11], v[196:199]
ds_read_b64_tr_b16 a[102:103], v20 offset:35072
v_mfma_f32_16x16x32_bf16 v[188:191], a[104:107], a[0:3], v[188:191]
v_mfma_f32_16x16x32_bf16 v[188:191], a[108:111], a[4:7], v[188:191]
s_waitcnt lgkmcnt(7)
ds_read_b64_tr_b16 a[104:105], v4 offset:32768
v_mfma_f32_16x16x32_bf16 v[216:219], a[4:7], a[116:119], v[216:219]
ds_read_b64_tr_b16 a[106:107], v4 offset:33792
v_mfma_f32_16x16x32_bf16 v[216:219], a[0:3], a[112:115], v[216:219]
s_add_u32 m0, s77, 101376
ds_read_b64_tr_b16 a[108:109], v4 offset:40960
v_subrev_u32 v21, 0x8000, v21
v_mfma_f32_16x16x32_bf16 v[224:227], a[8:11], a[112:115], v[224:227]
s_add_u32 s64, s71, 7438336
ds_read_b64_tr_b16 a[110:111], v4 offset:41984
v_mfma_f32_16x16x32_bf16 v[224:227], a[12:15], a[116:119], v[224:227]
buffer_load_dwordx4 v15, s[56:59], s64 offen lds
v_mfma_f32_16x16x32_bf16 v[232:235], a[20:23], a[116:119], v[232:235]
v_mfma_f32_16x16x32_bf16 v[232:235], a[16:19], a[112:115], v[232:235]
v_mfma_f32_16x16x32_bf16 v[240:243], a[24:27], a[112:115], v[240:243]
v_mfma_f32_16x16x32_bf16 v[240:243], a[28:31], a[116:119], v[240:243]
ds_read_b64_tr_b16 a[112:113], v5 offset:32768
v_mfma_f32_16x16x32_bf16 v[252:255], a[68:71], a[76:79], v[252:255]
ds_read_b64_tr_b16 a[114:115], v5 offset:33792
v_mfma_f32_16x16x32_bf16 v[252:255], a[64:67], a[72:75], v[252:255]
s_add_u32 m0, s78, 126976
ds_read_b64_tr_b16 a[116:117], v5 offset:40960
v_mfma_f32_16x16x32_bf16 v[244:247], a[24:27], a[80:83], v[244:247]
s_add_u32 s64, s74, 1792
ds_read_b64_tr_b16 a[118:119], v5 offset:41984
v_mfma_f32_16x16x32_bf16 v[244:247], a[28:31], a[84:87], v[244:247]
buffer_load_dwordx4 v22, s[48:51], s64 offen lds
v_mfma_f32_16x16x32_bf16 v[236:239], a[20:23], a[84:87], v[236:239]
ds_read_b64_tr_b16 a[72:73], v6 offset:32768
v_subrev_u32 v19, 0x8000, v19
v_mfma_f32_16x16x32_bf16 v[236:239], a[16:19], a[80:83], v[236:239]
ds_read_b64_tr_b16 a[74:75], v6 offset:33792
v_mfma_f32_16x16x32_bf16 v[228:231], a[8:11], a[80:83], v[228:231]
ds_read_b64_tr_b16 a[76:77], v6 offset:40960
v_mfma_f32_16x16x32_bf16 v[228:231], a[12:15], a[84:87], v[228:231]
ds_read_b64_tr_b16 a[78:79], v6 offset:41984
v_mfma_f32_16x16x32_bf16 v[220:223], a[4:7], a[84:87], v[220:223]
v_mfma_f32_16x16x32_bf16 v[220:223], a[0:3], a[80:83], v[220:223]
s_waitcnt lgkmcnt(7)
ds_read_b64_tr_b16 a[80:81], v7 offset:32768
v_mfma_f32_16x16x32_bf16 v[152:155], a[88:91], a[0:3], v[152:155]
ds_read_b64_tr_b16 a[82:83], v7 offset:33792
v_mfma_f32_16x16x32_bf16 v[152:155], a[92:95], a[4:7], v[152:155]
ds_read_b64_tr_b16 a[84:85], v7 offset:40960
v_subrev_u32 v20, 0x8000, v20
v_mfma_f32_16x16x32_bf16 v[160:163], a[92:95], a[12:15], v[160:163]
s_add_u32 m0, s76, 0
ds_read_b64_tr_b16 a[86:87], v7 offset:41984
v_mfma_f32_16x16x32_bf16 v[160:163], a[88:91], a[8:11], v[160:163]
s_add_u32 s64, s72, 1792
v_mfma_f32_16x16x32_bf16 v[168:171], a[88:91], a[16:19], v[168:171]
buffer_load_dwordx4 v12, s[48:51], s64 offen lds
v_mfma_f32_16x16x32_bf16 v[168:171], a[92:95], a[20:23], v[168:171]
v_mfma_f32_16x16x32_bf16 v[176:179], a[92:95], a[28:31], v[176:179]
v_mfma_f32_16x16x32_bf16 v[176:179], a[88:91], a[24:27], v[176:179]
s_add_u32 m0, s76, 1024
ds_read_b64_tr_b16 a[88:89], v8 offset:32768
v_mfma_f32_16x16x32_bf16 v[180:183], a[96:99], a[24:27], v[180:183]
s_add_u32 s64, s72, 18176
ds_read_b64_tr_b16 a[90:91], v8 offset:33792
v_mfma_f32_16x16x32_bf16 v[180:183], a[100:103], a[28:31], v[180:183]
buffer_load_dwordx4 v13, s[48:51], s64 offen lds
v_mfma_f32_16x16x32_bf16 v[172:175], a[100:103], a[20:23], v[172:175]
ds_read_b64_tr_b16 a[92:93], v8 offset:40960
v_subrev_u32 v4, 0x8000, v4
v_mfma_f32_16x16x32_bf16 v[172:175], a[96:99], a[16:19], v[172:175]
ds_read_b64_tr_b16 a[94:95], v8 offset:41984
v_mfma_f32_16x16x32_bf16 v[164:167], a[96:99], a[8:11], v[164:167]
v_mfma_f32_16x16x32_bf16 v[164:167], a[100:103], a[12:15], v[164:167]
s_add_u32 m0, s76, 2048
v_mfma_f32_16x16x32_bf16 v[156:159], a[100:103], a[4:7], v[156:159]
s_add_u32 s64, s72, 132864
v_mfma_f32_16x16x32_bf16 v[156:159], a[96:99], a[0:3], v[156:159]
buffer_load_dwordx4 v12, s[48:51], s64 offen lds
v_mfma_f32_16x16x32_bf16 v[24:27], a[104:107], a[0:3], v[24:27]
ds_read_b64_tr_b16 a[96:97], v9 offset:32768
v_mfma_f32_16x16x32_bf16 v[24:27], a[108:111], a[4:7], v[24:27]
ds_read_b64_tr_b16 a[98:99], v9 offset:33792
v_subrev_u32 v5, 0x8000, v5
v_mfma_f32_16x16x32_bf16 v[40:43], a[108:111], a[12:15], v[40:43]
s_waitcnt vmcnt(12)
s_add_u32 m0, s76, 3072
ds_read_b64_tr_b16 a[100:101], v9 offset:40960
v_mfma_f32_16x16x32_bf16 v[40:43], a[104:107], a[8:11], v[40:43]
s_add_u32 s64, s72, 149248
ds_read_b64_tr_b16 a[102:103], v9 offset:41984
v_mfma_f32_16x16x32_bf16 v[56:59], a[104:107], a[16:19], v[56:59]
buffer_load_dwordx4 v13, s[48:51], s64 offen lds
v_mfma_f32_16x16x32_bf16 v[56:59], a[108:111], a[20:23], v[56:59]
ds_read_b128 a[32:35], v2 offset:32768
v_mfma_f32_16x16x32_bf16 v[72:75], a[108:111], a[28:31], v[72:75]
ds_read_b128 a[36:39], v3 offset:32768
v_mfma_f32_16x16x32_bf16 v[72:75], a[104:107], a[24:27], v[72:75]
s_waitcnt lgkmcnt(6)
ds_read_b128 a[40:43], v2 offset:34816
v_mfma_f32_16x16x32_bf16 v[136:139], a[112:115], a[24:27], v[136:139]
s_add_u32 m0, s76, 4096
ds_read_b128 a[44:47], v3 offset:34816
v_mfma_f32_16x16x32_bf16 v[136:139], a[116:119], a[28:31], v[136:139]
s_add_u32 s64, s73, 1792
ds_read_b128 a[48:51], v2 offset:36864
v_subrev_u32 v6, 0x8000, v6
v_mfma_f32_16x16x32_bf16 v[120:123], a[116:119], a[20:23], v[120:123]
buffer_load_dwordx4 v12, s[48:51], s64 offen lds
v_mfma_f32_16x16x32_bf16 v[120:123], a[112:115], a[16:19], v[120:123]
ds_read_b128 a[52:55], v3 offset:36864
v_mfma_f32_16x16x32_bf16 v[104:107], a[112:115], a[8:11], v[104:107]
ds_read_b128 a[56:59], v2 offset:38912
v_mfma_f32_16x16x32_bf16 v[104:107], a[116:119], a[12:15], v[104:107]
s_add_u32 m0, s76, 5120
ds_read_b128 a[60:63], v3 offset:38912
v_mfma_f32_16x16x32_bf16 v[88:91], a[116:119], a[4:7], v[88:91]
s_add_u32 s64, s73, 18176
ds_read_b64_tr_b16 a[104:105], v10 offset:32768
v_mfma_f32_16x16x32_bf16 v[88:91], a[112:115], a[0:3], v[88:91]
buffer_load_dwordx4 v13, s[48:51], s64 offen lds
v_mfma_f32_16x16x32_bf16 v[28:31], a[72:75], a[0:3], v[28:31]
ds_read_b64_tr_b16 a[106:107], v10 offset:33792
v_mfma_f32_16x16x32_bf16 v[28:31], a[76:79], a[4:7], v[28:31]
ds_read_b64_tr_b16 a[108:109], v10 offset:40960
v_subrev_u32 v7, 0x8000, v7
v_mfma_f32_16x16x32_bf16 v[44:47], a[76:79], a[12:15], v[44:47]
ds_read_b64_tr_b16 a[110:111], v10 offset:41984
v_mfma_f32_16x16x32_bf16 v[44:47], a[72:75], a[8:11], v[44:47]
s_add_u32 m0, s76, 6144
ds_read_b64_tr_b16 a[112:113], v11 offset:32768
v_mfma_f32_16x16x32_bf16 v[60:63], a[72:75], a[16:19], v[60:63]
s_add_u32 s64, s73, 132864
buffer_load_dword v1, off, s[52:55], s80 sc1
v_mfma_f32_16x16x32_bf16 v[60:63], a[76:79], a[20:23], v[60:63]
buffer_load_dwordx4 v12, s[48:51], s64 offen lds
v_mfma_f32_16x16x32_bf16 v[76:79], a[76:79], a[28:31], v[76:79]
ds_read_b64_tr_b16 a[114:115], v11 offset:33792
v_mfma_f32_16x16x32_bf16 v[76:79], a[72:75], a[24:27], v[76:79]
ds_read_b64_tr_b16 a[116:117], v11 offset:40960
v_mfma_f32_16x16x32_bf16 v[140:143], a[80:83], a[24:27], v[140:143]
s_add_u32 m0, s76, 7168
ds_read_b64_tr_b16 a[118:119], v11 offset:41984
v_mfma_f32_16x16x32_bf16 v[140:143], a[84:87], a[28:31], v[140:143]
s_add_u32 s64, s73, 149248
v_subrev_u32 v8, 0x8000, v8
v_mfma_f32_16x16x32_bf16 v[124:127], a[84:87], a[20:23], v[124:127]
buffer_load_dwordx4 v13, s[48:51], s64 offen lds
v_mfma_f32_16x16x32_bf16 v[124:127], a[80:83], a[16:19], v[124:127]
v_mfma_f32_16x16x32_bf16 v[108:111], a[80:83], a[8:11], v[108:111]
v_mfma_f32_16x16x32_bf16 v[108:111], a[84:87], a[12:15], v[108:111]
v_mfma_f32_16x16x32_bf16 v[92:95], a[84:87], a[4:7], v[92:95]
v_subrev_u32 v9, 0x8000, v9
v_subrev_u32 v10, 0x8000, v10
v_mfma_f32_16x16x32_bf16 v[92:95], a[80:83], a[0:3], v[92:95]
v_subrev_u32 v11, 0x8000, v11
v_mfma_f32_16x16x32_bf16 v[32:35], a[88:91], a[0:3], v[32:35]
v_mfma_f32_16x16x32_bf16 v[32:35], a[92:95], a[4:7], v[32:35]
v_mfma_f32_16x16x32_bf16 v[48:51], a[92:95], a[12:15], v[48:51]
s_waitcnt lgkmcnt(0)
s_barrier
v_mfma_f32_16x16x32_bf16 v[48:51], a[88:91], a[8:11], v[48:51]
s_add_u32 m0, s77, 131072
ds_read_b64_tr_b16 a[72:73], v19 offset:4096
v_mfma_f32_16x16x32_bf16 v[64:67], a[88:91], a[16:19], v[64:67]
s_add_u32 s64, s71, 7864320
ds_read_b64_tr_b16 a[74:75], v19 offset:4352
v_mfma_f32_16x16x32_bf16 v[64:67], a[92:95], a[20:23], v[64:67]
buffer_load_dwordx4 v14, s[56:59], s64 offen lds
v_mfma_f32_16x16x32_bf16 v[80:83], a[92:95], a[28:31], v[80:83]
ds_read_b64_tr_b16 a[76:77], v19 offset:6144
v_mfma_f32_16x16x32_bf16 v[80:83], a[88:91], a[24:27], v[80:83]
ds_read_b64_tr_b16 a[78:79], v19 offset:6400
v_mfma_f32_16x16x32_bf16 v[144:147], a[96:99], a[24:27], v[144:147]
ds_read_b128 a[64:67], v17 offset:0
v_mfma_f32_16x16x32_bf16 v[144:147], a[100:103], a[28:31], v[144:147]
ds_read_b128 a[68:71], v18 offset:0
v_mfma_f32_16x16x32_bf16 v[128:131], a[100:103], a[20:23], v[128:131]
ds_read_b64_tr_b16 a[80:81], v21 offset:4096
v_mfma_f32_16x16x32_bf16 v[128:131], a[96:99], a[16:19], v[128:131]
s_add_u32 m0, s78, 147456
ds_read_b64_tr_b16 a[82:83], v21 offset:4352
v_mfma_f32_16x16x32_bf16 v[112:115], a[96:99], a[8:11], v[112:115]
s_add_u32 s64, s75, 5898240
ds_read_b64_tr_b16 a[84:85], v21 offset:6144
v_mfma_f32_16x16x32_bf16 v[112:115], a[100:103], a[12:15], v[112:115]
buffer_load_dwordx4 v23, s[60:63], s64 offen lds
v_mfma_f32_16x16x32_bf16 v[96:99], a[100:103], a[4:7], v[96:99]
ds_read_b64_tr_b16 a[86:87], v21 offset:6400
v_mfma_f32_16x16x32_bf16 v[96:99], a[96:99], a[0:3], v[96:99]
ds_read_b64_tr_b16 a[88:89], v20 offset:4096
v_mfma_f32_16x16x32_bf16 v[36:39], a[104:107], a[0:3], v[36:39]
ds_read_b64_tr_b16 a[90:91], v20 offset:4352
v_mfma_f32_16x16x32_bf16 v[36:39], a[108:111], a[4:7], v[36:39]
ds_read_b64_tr_b16 a[92:93], v20 offset:6144
v_mfma_f32_16x16x32_bf16 v[52:55], a[108:111], a[12:15], v[52:55]
ds_read_b64_tr_b16 a[94:95], v20 offset:6400
v_mfma_f32_16x16x32_bf16 v[52:55], a[104:107], a[8:11], v[52:55]
s_add_u32 m0, s77, 132096
ds_read_b64_tr_b16 a[96:97], v19 offset:8192
v_mfma_f32_16x16x32_bf16 v[68:71], a[104:107], a[16:19], v[68:71]
s_add_u32 s64, s71, 7897088
ds_read_b64_tr_b16 a[98:99], v19 offset:8448
v_mfma_f32_16x16x32_bf16 v[68:71], a[108:111], a[20:23], v[68:71]
buffer_load_dwordx4 v14, s[56:59], s64 offen lds
v_mfma_f32_16x16x32_bf16 v[84:87], a[108:111], a[28:31], v[84:87]
ds_read_b64_tr_b16 a[100:101], v19 offset:10240
v_mfma_f32_16x16x32_bf16 v[84:87], a[104:107], a[24:27], v[84:87]
ds_read_b64_tr_b16 a[102:103], v19 offset:10496
v_mfma_f32_16x16x32_bf16 v[148:151], a[112:115], a[24:27], v[148:151]
ds_read_b64_tr_b16 a[104:105], v21 offset:8192
v_mfma_f32_16x16x32_bf16 v[148:151], a[116:119], a[28:31], v[148:151]
ds_read_b64_tr_b16 a[106:107], v21 offset:8448
v_mfma_f32_16x16x32_bf16 v[132:135], a[116:119], a[20:23], v[132:135]
ds_read_b64_tr_b16 a[108:109], v21 offset:10240
v_mfma_f32_16x16x32_bf16 v[132:135], a[112:115], a[16:19], v[132:135]
s_add_u32 m0, s78, 151552
ds_read_b64_tr_b16 a[110:111], v21 offset:10496
v_mfma_f32_16x16x32_bf16 v[116:119], a[112:115], a[8:11], v[116:119]
s_add_u32 s64, s75, 5900288
v_mfma_f32_16x16x32_bf16 v[116:119], a[116:119], a[12:15], v[116:119]
buffer_load_dwordx4 v23, s[60:63], s64 offen lds
v_mfma_f32_16x16x32_bf16 v[100:103], a[116:119], a[4:7], v[100:103]
v_mfma_f32_16x16x32_bf16 v[100:103], a[112:115], a[0:3], v[100:103]
s_waitcnt lgkmcnt(6)
ds_read_b64_tr_b16 a[112:113], v20 offset:8192
v_mfma_f32_16x16x32_bf16 v[184:187], a[72:75], a[32:35], v[184:187]
ds_read_b64_tr_b16 a[114:115], v20 offset:8448
v_mfma_f32_16x16x32_bf16 v[184:187], a[76:79], a[36:39], v[184:187]
s_add_u32 m0, s77, 133120
ds_read_b64_tr_b16 a[116:117], v20 offset:10240
v_mfma_f32_16x16x32_bf16 v[192:195], a[76:79], a[44:47], v[192:195]
s_add_u32 s64, s71, 7929856
ds_read_b64_tr_b16 a[118:119], v20 offset:10496
v_mfma_f32_16x16x32_bf16 v[192:195], a[72:75], a[40:43], v[192:195]
s_lshl_b32 s68, s31, 20
s_add_u32 s32, s28, s68
s_addc_u32 s33, s29, 0
v_mfma_f32_16x16x32_bf16 v[200:203], a[72:75], a[48:51], v[200:203]
s_add_u32 s68, s16, 1
s_lshl_b32 s34, s68, 16
v_mfma_f32_16x16x32_bf16 v[200:203], a[76:79], a[52:55], v[200:203]
buffer_load_dwordx4 v15, s[56:59], s64 offen lds
v_mfma_f32_16x16x32_bf16 v[208:211], a[76:79], a[60:63], v[208:211]
v_mfma_f32_16x16x32_bf16 v[208:211], a[72:75], a[56:59], v[208:211]
ds_read_b64_tr_b16 a[72:73], v19 offset:0
v_mfma_f32_16x16x32_bf16 v[248:251], a[80:83], a[64:67], v[248:251]
ds_read_b64_tr_b16 a[74:75], v19 offset:256
v_mfma_f32_16x16x32_bf16 v[248:251], a[84:87], a[68:71], v[248:251]
ds_read_b64_tr_b16 a[76:77], v19 offset:2048
v_mfma_f32_16x16x32_bf16 v[212:215], a[92:95], a[60:63], v[212:215]
ds_read_b64_tr_b16 a[78:79], v19 offset:2304
v_mfma_f32_16x16x32_bf16 v[212:215], a[88:91], a[56:59], v[212:215]
s_add_u32 m0, s78, 155648
ds_read_b64_tr_b16 a[80:81], v20 offset:0
v_mfma_f32_16x16x32_bf16 v[204:207], a[88:91], a[48:51], v[204:207]
s_add_u32 s64, s75, 5902336
ds_read_b64_tr_b16 a[82:83], v20 offset:256
v_mfma_f32_16x16x32_bf16 v[204:207], a[92:95], a[52:55], v[204:207]
buffer_load_dwordx4 v23, s[60:63], s64 offen lds
v_mfma_f32_16x16x32_bf16 v[196:199], a[92:95], a[44:47], v[196:199]
ds_read_b64_tr_b16 a[84:85], v20 offset:2048
v_mfma_f32_16x16x32_bf16 v[196:199], a[88:91], a[40:43], v[196:199]
ds_read_b64_tr_b16 a[86:87], v20 offset:2304
v_mfma_f32_16x16x32_bf16 v[188:191], a[88:91], a[32:35], v[188:191]
v_mfma_f32_16x16x32_bf16 v[188:191], a[92:95], a[36:39], v[188:191]
s_waitcnt lgkmcnt(7)
ds_read_b64_tr_b16 a[88:89], v4 offset:0
v_mfma_f32_16x16x32_bf16 v[216:219], a[36:39], a[100:103], v[216:219]
ds_read_b64_tr_b16 a[90:91], v4 offset:1024
v_mfma_f32_16x16x32_bf16 v[216:219], a[32:35], a[96:99], v[216:219]
s_add_u32 m0, s77, 134144
ds_read_b64_tr_b16 a[92:93], v4 offset:8192
v_mfma_f32_16x16x32_bf16 v[224:227], a[40:43], a[96:99], v[224:227]
s_add_u32 s64, s71, 7962624
ds_read_b64_tr_b16 a[94:95], v4 offset:9216
v_mfma_f32_16x16x32_bf16 v[224:227], a[44:47], a[100:103], v[224:227]
buffer_load_dwordx4 v15, s[56:59], s64 offen lds
v_mfma_f32_16x16x32_bf16 v[232:235], a[52:55], a[100:103], v[232:235]
v_mfma_f32_16x16x32_bf16 v[232:235], a[48:51], a[96:99], v[232:235]
v_mfma_f32_16x16x32_bf16 v[240:243], a[56:59], a[96:99], v[240:243]
v_mfma_f32_16x16x32_bf16 v[240:243], a[60:63], a[100:103], v[240:243]
ds_read_b64_tr_b16 a[96:97], v5 offset:0
v_mfma_f32_16x16x32_bf16 v[252:255], a[68:71], a[108:111], v[252:255]
ds_read_b64_tr_b16 a[98:99], v5 offset:1024
v_mfma_f32_16x16x32_bf16 v[252:255], a[64:67], a[104:107], v[252:255]
s_add_u32 m0, s78, 159744
ds_read_b64_tr_b16 a[100:101], v5 offset:8192
v_mfma_f32_16x16x32_bf16 v[244:247], a[56:59], a[112:115], v[244:247]
s_add_u32 s64, s74, 1920
ds_read_b64_tr_b16 a[102:103], v5 offset:9216
v_mfma_f32_16x16x32_bf16 v[244:247], a[60:63], a[116:119], v[244:247]
buffer_load_dwordx4 v22, s[48:51], s64 offen lds
v_mfma_f32_16x16x32_bf16 v[236:239], a[52:55], a[116:119], v[236:239]
ds_read_b64_tr_b16 a[104:105], v6 offset:0
v_mfma_f32_16x16x32_bf16 v[236:239], a[48:51], a[112:115], v[236:239]
ds_read_b64_tr_b16 a[106:107], v6 offset:1024
v_mfma_f32_16x16x32_bf16 v[228:231], a[40:43], a[112:115], v[228:231]
ds_read_b64_tr_b16 a[108:109], v6 offset:8192
v_mfma_f32_16x16x32_bf16 v[228:231], a[44:47], a[116:119], v[228:231]
ds_read_b64_tr_b16 a[110:111], v6 offset:9216
v_mfma_f32_16x16x32_bf16 v[220:223], a[36:39], a[116:119], v[220:223]
v_mfma_f32_16x16x32_bf16 v[220:223], a[32:35], a[112:115], v[220:223]
s_waitcnt lgkmcnt(7)
ds_read_b64_tr_b16 a[112:113], v7 offset:0
v_mfma_f32_16x16x32_bf16 v[152:155], a[72:75], a[32:35], v[152:155]
ds_read_b64_tr_b16 a[114:115], v7 offset:1024
v_mfma_f32_16x16x32_bf16 v[152:155], a[76:79], a[36:39], v[152:155]
ds_read_b64_tr_b16 a[116:117], v7 offset:8192
v_mfma_f32_16x16x32_bf16 v[160:163], a[76:79], a[44:47], v[160:163]
s_add_u32 m0, s76, 32768
ds_read_b64_tr_b16 a[118:119], v7 offset:9216
v_mfma_f32_16x16x32_bf16 v[160:163], a[72:75], a[40:43], v[160:163]
s_add_u32 s64, s72, 1920
v_mfma_f32_16x16x32_bf16 v[168:171], a[72:75], a[48:51], v[168:171]
buffer_load_dwordx4 v12, s[48:51], s64 offen lds
v_mfma_f32_16x16x32_bf16 v[168:171], a[76:79], a[52:55], v[168:171]
v_mfma_f32_16x16x32_bf16 v[176:179], a[76:79], a[60:63], v[176:179]
v_mfma_f32_16x16x32_bf16 v[176:179], a[72:75], a[56:59], v[176:179]
s_add_u32 m0, s76, 33792
ds_read_b64_tr_b16 a[72:73], v8 offset:0
v_mfma_f32_16x16x32_bf16 v[180:183], a[80:83], a[56:59], v[180:183]
s_add_u32 s64, s72, 18304
ds_read_b64_tr_b16 a[74:75], v8 offset:1024
v_mfma_f32_16x16x32_bf16 v[180:183], a[84:87], a[60:63], v[180:183]
buffer_load_dwordx4 v13, s[48:51], s64 offen lds
v_mfma_f32_16x16x32_bf16 v[172:175], a[84:87], a[52:55], v[172:175]
ds_read_b64_tr_b16 a[76:77], v8 offset:8192
v_mfma_f32_16x16x32_bf16 v[172:175], a[80:83], a[48:51], v[172:175]
ds_read_b64_tr_b16 a[78:79], v8 offset:9216
v_mfma_f32_16x16x32_bf16 v[164:167], a[80:83], a[40:43], v[164:167]
v_mfma_f32_16x16x32_bf16 v[164:167], a[84:87], a[44:47], v[164:167]
s_add_u32 m0, s76, 34816
v_mfma_f32_16x16x32_bf16 v[156:159], a[84:87], a[36:39], v[156:159]
s_add_u32 s64, s72, 132992
v_mfma_f32_16x16x32_bf16 v[156:159], a[80:83], a[32:35], v[156:159]
buffer_load_dwordx4 v12, s[48:51], s64 offen lds
v_mfma_f32_16x16x32_bf16 v[24:27], a[88:91], a[32:35], v[24:27]
ds_read_b64_tr_b16 a[80:81], v9 offset:0
v_mfma_f32_16x16x32_bf16 v[24:27], a[92:95], a[36:39], v[24:27]
ds_read_b64_tr_b16 a[82:83], v9 offset:1024
v_mfma_f32_16x16x32_bf16 v[40:43], a[92:95], a[44:47], v[40:43]
s_waitcnt vmcnt(11)
s_add_u32 m0, s76, 35840
ds_read_b64_tr_b16 a[84:85], v9 offset:8192
v_mfma_f32_16x16x32_bf16 v[40:43], a[88:91], a[40:43], v[40:43]
s_add_u32 s64, s72, 149376
ds_read_b64_tr_b16 a[86:87], v9 offset:9216
v_mfma_f32_16x16x32_bf16 v[56:59], a[88:91], a[48:51], v[56:59]
buffer_load_dwordx4 v13, s[48:51], s64 offen lds
v_mfma_f32_16x16x32_bf16 v[56:59], a[92:95], a[52:55], v[56:59]
ds_read_b128 a[0:3], v2 offset:0
v_mfma_f32_16x16x32_bf16 v[72:75], a[92:95], a[60:63], v[72:75]
ds_read_b128 a[4:7], v3 offset:0
v_mfma_f32_16x16x32_bf16 v[72:75], a[88:91], a[56:59], v[72:75]
s_waitcnt lgkmcnt(6)
ds_read_b128 a[8:11], v2 offset:2048
v_mfma_f32_16x16x32_bf16 v[136:139], a[96:99], a[56:59], v[136:139]
s_add_u32 m0, s76, 36864
ds_read_b128 a[12:15], v3 offset:2048
v_mfma_f32_16x16x32_bf16 v[136:139], a[100:103], a[60:63], v[136:139]
s_add_u32 s64, s73, 1920
ds_read_b128 a[16:19], v2 offset:4096
v_mfma_f32_16x16x32_bf16 v[120:123], a[100:103], a[52:55], v[120:123]
buffer_load_dwordx4 v12, s[48:51], s64 offen lds
v_mfma_f32_16x16x32_bf16 v[120:123], a[96:99], a[48:51], v[120:123]
ds_read_b128 a[20:23], v3 offset:4096
v_mfma_f32_16x16x32_bf16 v[104:107], a[96:99], a[40:43], v[104:107]
ds_read_b128 a[24:27], v2 offset:6144
v_mfma_f32_16x16x32_bf16 v[104:107], a[100:103], a[44:47], v[104:107]
s_add_u32 m0, s76, 37888
ds_read_b128 a[28:31], v3 offset:6144
v_mfma_f32_16x16x32_bf16 v[88:91], a[100:103], a[36:39], v[88:91]
s_add_u32 s64, s73, 18304
ds_read_b64_tr_b16 a[88:89], v10 offset:0
v_mfma_f32_16x16x32_bf16 v[88:91], a[96:99], a[32:35], v[88:91]
buffer_load_dwordx4 v13, s[48:51], s64 offen lds
v_mfma_f32_16x16x32_bf16 v[28:31], a[104:107], a[32:35], v[28:31]
ds_read_b64_tr_b16 a[90:91], v10 offset:1024
v_mfma_f32_16x16x32_bf16 v[28:31], a[108:111], a[36:39], v[28:31]
ds_read_b64_tr_b16 a[92:93], v10 offset:8192
v_mfma_f32_16x16x32_bf16 v[44:47], a[108:111], a[44:47], v[44:47]
ds_read_b64_tr_b16 a[94:95], v10 offset:9216
v_mfma_f32_16x16x32_bf16 v[44:47], a[104:107], a[40:43], v[44:47]
s_add_u32 m0, s76, 38912
ds_read_b64_tr_b16 a[96:97], v11 offset:0
v_mfma_f32_16x16x32_bf16 v[60:63], a[104:107], a[48:51], v[60:63]
s_add_u32 s64, s73, 132992
ds_read_b64_tr_b16 a[98:99], v11 offset:1024
v_mfma_f32_16x16x32_bf16 v[60:63], a[108:111], a[52:55], v[60:63]
buffer_load_dwordx4 v12, s[48:51], s64 offen lds
v_mfma_f32_16x16x32_bf16 v[76:79], a[108:111], a[60:63], v[76:79]
ds_read_b64_tr_b16 a[100:101], v11 offset:8192
v_mfma_f32_16x16x32_bf16 v[76:79], a[104:107], a[56:59], v[76:79]
s_add_u32 m0, s76, 39936
ds_read_b64_tr_b16 a[102:103], v11 offset:9216
v_mfma_f32_16x16x32_bf16 v[140:143], a[112:115], a[56:59], v[140:143]
v_readfirstlane_b32 s66, v1
s_nop 0
s_cmp_lt_u32 s66, s82
s_cbranch_scc1 L_spin_4
L_spinbk_5:
v_mfma_f32_16x16x32_bf16 v[140:143], a[116:119], a[60:63], v[140:143]
s_add_u32 s64, s73, 149376
v_mfma_f32_16x16x32_bf16 v[124:127], a[116:119], a[52:55], v[124:127]
buffer_load_dwordx4 v13, s[48:51], s64 offen lds
v_mfma_f32_16x16x32_bf16 v[124:127], a[112:115], a[48:51], v[124:127]
v_mfma_f32_16x16x32_bf16 v[108:111], a[112:115], a[40:43], v[108:111]
v_mfma_f32_16x16x32_bf16 v[108:111], a[116:119], a[44:47], v[108:111]
v_mfma_f32_16x16x32_bf16 v[92:95], a[116:119], a[36:39], v[92:95]
v_mfma_f32_16x16x32_bf16 v[92:95], a[112:115], a[32:35], v[92:95]
v_mfma_f32_16x16x32_bf16 v[32:35], a[72:75], a[32:35], v[32:35]
v_mfma_f32_16x16x32_bf16 v[32:35], a[76:79], a[36:39], v[32:35]
v_mfma_f32_16x16x32_bf16 v[48:51], a[76:79], a[44:47], v[48:51]
s_waitcnt lgkmcnt(0)
s_barrier
v_mfma_f32_16x16x32_bf16 v[48:51], a[72:75], a[40:43], v[48:51]
ds_read_b64_tr_b16 a[104:105], v19 offset:36864
v_mfma_f32_16x16x32_bf16 v[64:67], a[72:75], a[48:51], v[64:67]
ds_read_b64_tr_b16 a[106:107], v19 offset:37120
v_mfma_f32_16x16x32_bf16 v[64:67], a[76:79], a[52:55], v[64:67]
s_mov_b32 m0, s76
ds_read_b64_tr_b16 a[108:109], v19 offset:38912
v_mfma_f32_16x16x32_bf16 v[80:83], a[76:79], a[60:63], v[80:83]
s_lshl_b32 s64, s30, 14
ds_read_b64_tr_b16 a[110:111], v19 offset:39168
v_mfma_f32_16x16x32_bf16 v[80:83], a[72:75], a[56:59], v[80:83]
buffer_load_dwordx4 v16, s[32:35], s64 offen offset:0 sc1 lds
v_mfma_f32_16x16x32_bf16 v[144:147], a[80:83], a[56:59], v[144:147]
ds_read_b128 a[64:67], v17 offset:32768
v_mfma_f32_16x16x32_bf16 v[144:147], a[84:87], a[60:63], v[144:147]
ds_read_b128 a[68:71], v18 offset:32768
v_mfma_f32_16x16x32_bf16 v[128:131], a[84:87], a[52:55], v[128:131]
ds_read_b64_tr_b16 a[112:113], v21 offset:36864
v_mfma_f32_16x16x32_bf16 v[128:131], a[80:83], a[48:51], v[128:131]
ds_read_b64_tr_b16 a[114:115], v21 offset:37120
v_mfma_f32_16x16x32_bf16 v[112:115], a[80:83], a[40:43], v[112:115]
ds_read_b64_tr_b16 a[116:117], v21 offset:38912
v_mfma_f32_16x16x32_bf16 v[112:115], a[84:87], a[44:47], v[112:115]
buffer_load_dwordx4 v16, s[32:35], s64 offen offset:1024 sc1 lds
v_mfma_f32_16x16x32_bf16 v[96:99], a[84:87], a[36:39], v[96:99]
ds_read_b64_tr_b16 a[118:119], v21 offset:39168
v_mfma_f32_16x16x32_bf16 v[96:99], a[80:83], a[32:35], v[96:99]
ds_read_b64_tr_b16 a[72:73], v20 offset:36864
v_mfma_f32_16x16x32_bf16 v[36:39], a[88:91], a[32:35], v[36:39]
ds_read_b64_tr_b16 a[74:75], v20 offset:37120
v_mfma_f32_16x16x32_bf16 v[36:39], a[92:95], a[36:39], v[36:39]
ds_read_b64_tr_b16 a[76:77], v20 offset:38912
v_mfma_f32_16x16x32_bf16 v[52:55], a[92:95], a[44:47], v[52:55]
ds_read_b64_tr_b16 a[78:79], v20 offset:39168
v_mfma_f32_16x16x32_bf16 v[52:55], a[88:91], a[40:43], v[52:55]
buffer_load_dwordx4 v16, s[32:35], s64 offen offset:2048 sc1 lds
v_mfma_f32_16x16x32_bf16 v[68:71], a[88:91], a[48:51], v[68:71]
ds_read_b64_tr_b16 a[80:81], v19 offset:40960
v_mfma_f32_16x16x32_bf16 v[68:71], a[92:95], a[52:55], v[68:71]
ds_read_b64_tr_b16 a[82:83], v19 offset:41216
v_mfma_f32_16x16x32_bf16 v[84:87], a[92:95], a[60:63], v[84:87]
ds_read_b64_tr_b16 a[84:85], v19 offset:43008
v_mfma_f32_16x16x32_bf16 v[84:87], a[88:91], a[56:59], v[84:87]
ds_read_b64_tr_b16 a[86:87], v19 offset:43264
v_mfma_f32_16x16x32_bf16 v[148:151], a[96:99], a[56:59], v[148:151]
ds_read_b64_tr_b16 a[88:89], v21 offset:40960
v_mfma_f32_16x16x32_bf16 v[148:151], a[100:103], a[60:63], v[148:151]
buffer_load_dwordx4 v16, s[32:35], s64 offen offset:3072 sc1 lds
v_mfma_f32_16x16x32_bf16 v[132:135], a[100:103], a[52:55], v[132:135]
ds_read_b64_tr_b16 a[90:91], v21 offset:41216
v_mfma_f32_16x16x32_bf16 v[132:135], a[96:99], a[48:51], v[132:135]
ds_read_b64_tr_b16 a[92:93], v21 offset:43008
v_mfma_f32_16x16x32_bf16 v[116:119], a[96:99], a[40:43], v[116:119]
ds_read_b64_tr_b16 a[94:95], v21 offset:43264
v_mfma_f32_16x16x32_bf16 v[116:119], a[100:103], a[44:47], v[116:119]
s_add_u32 m0, s76, 4096
v_mfma_f32_16x16x32_bf16 v[100:103], a[100:103], a[36:39], v[100:103]
s_add_u32 s64, s64, 4096
v_mfma_f32_16x16x32_bf16 v[100:103], a[96:99], a[32:35], v[100:103]
s_waitcnt lgkmcnt(6)
buffer_load_dwordx4 v16, s[32:35], s64 offen offset:0 sc1 lds
v_mfma_f32_16x16x32_bf16 v[184:187], a[104:107], a[0:3], v[184:187]
ds_read_b64_tr_b16 a[96:97], v20 offset:40960
v_and_b32 v12, 15, v0
v_mfma_f32_16x16x32_bf16 v[184:187], a[108:111], a[4:7], v[184:187]
ds_read_b64_tr_b16 a[98:99], v20 offset:41216
v_lshrrev_b32 v13, 4, v0
v_mfma_f32_16x16x32_bf16 v[192:195], a[108:111], a[12:15], v[192:195]
ds_read_b64_tr_b16 a[100:101], v20 offset:43008
v_lshlrev_b32 v13, 2, v13
v_mfma_f32_16x16x32_bf16 v[192:195], a[104:107], a[8:11], v[192:195]
ds_read_b64_tr_b16 a[102:103], v20 offset:43264
v_sub_u32 v12, v12, v13
v_mfma_f32_16x16x32_bf16 v[200:203], a[104:107], a[16:19], v[200:203]
s_lshl_b32 s66, s30, 4
v_add_u32 v17, 0x8000, v17
v_add_u32 v18, 0x8000, v18
v_mfma_f32_16x16x32_bf16 v[200:203], a[108:111], a[20:23], v[200:203]
buffer_load_dwordx4 v16, s[32:35], s64 offen offset:1024 sc1 lds
v_mfma_f32_16x16x32_bf16 v[208:211], a[108:111], a[28:31], v[208:211]
v_add_u32 v13, s66, v12
v_cmp_gt_i32 s[0:1], 0, v13
v_mfma_f32_16x16x32_bf16 v[208:211], a[104:107], a[24:27], v[208:211]
ds_read_b64_tr_b16 a[104:105], v19 offset:32768
v_cmp_gt_i32 s[4:5], 1, v13
v_mfma_f32_16x16x32_bf16 v[248:251], a[112:115], a[64:67], v[248:251]
ds_read_b64_tr_b16 a[106:107], v19 offset:33024
v_cmp_gt_i32 s[6:7], 2, v13
v_mfma_f32_16x16x32_bf16 v[248:251], a[116:119], a[68:71], v[248:251]
ds_read_b64_tr_b16 a[108:109], v19 offset:34816
v_cmp_gt_i32 s[8:9], 3, v13
v_mfma_f32_16x16x32_bf16 v[212:215], a[76:79], a[28:31], v[212:215]
ds_read_b64_tr_b16 a[110:111], v19 offset:35072
v_cmp_gt_i32 s[10:11], 16, v13
v_mfma_f32_16x16x32_bf16 v[212:215], a[72:75], a[24:27], v[212:215]
buffer_load_dwordx4 v16, s[32:35], s64 offen offset:2048 sc1 lds
v_mfma_f32_16x16x32_bf16 v[204:207], a[72:75], a[16:19], v[204:207]
ds_read_b64_tr_b16 a[112:113], v20 offset:32768
v_cmp_gt_i32 s[12:13], 17, v13
v_mfma_f32_16x16x32_bf16 v[204:207], a[76:79], a[20:23], v[204:207]
ds_read_b64_tr_b16 a[114:115], v20 offset:33024
v_cmp_gt_i32 s[18:19], 18, v13
v_mfma_f32_16x16x32_bf16 v[196:199], a[76:79], a[12:15], v[196:199]
ds_read_b64_tr_b16 a[116:117], v20 offset:34816
v_cmp_gt_i32 s[22:23], 19, v13
v_mfma_f32_16x16x32_bf16 v[196:199], a[72:75], a[8:11], v[196:199]
ds_read_b64_tr_b16 a[118:119], v20 offset:35072
v_cmp_gt_i32 s[26:27], 32, v13
v_mfma_f32_16x16x32_bf16 v[188:191], a[72:75], a[0:3], v[188:191]
v_cmp_gt_i32 s[56:57], 33, v13
v_cmp_gt_i32 s[58:59], 34, v13
v_mfma_f32_16x16x32_bf16 v[188:191], a[76:79], a[4:7], v[188:191]
s_waitcnt lgkmcnt(7)
buffer_load_dwordx4 v16, s[32:35], s64 offen offset:3072 sc1 lds
v_mfma_f32_16x16x32_bf16 v[216:219], a[4:7], a[84:87], v[216:219]
s_lshr_b32 s64, s76, 1
ds_read_b64_tr_b16 a[72:73], v4 offset:32768
v_cmp_gt_i32 s[60:61], 35, v13
v_mfma_f32_16x16x32_bf16 v[216:219], a[0:3], a[80:83], v[216:219]
s_add_u32 m0, s64, 81920
ds_read_b64_tr_b16 a[74:75], v4 offset:33792
v_add_u32 v21, 0x8000, v21
v_mfma_f32_16x16x32_bf16 v[224:227], a[8:11], a[80:83], v[224:227]
s_and_b32 s69, s64, 8192
ds_read_b64_tr_b16 a[76:77], v4 offset:40960
v_cmp_gt_i32 s[62:63], 48, v13
v_mfma_f32_16x16x32_bf16 v[224:227], a[12:15], a[84:87], v[224:227]
s_add_u32 s64, s64, s69
ds_read_b64_tr_b16 a[78:79], v4 offset:41984
v_cmp_gt_i32 s[48:49], 49, v13
v_mfma_f32_16x16x32_bf16 v[232:235], a[20:23], a[84:87], v[232:235]
s_add_u32 s64, s64, 8192
v_cmp_gt_i32 s[50:51], 50, v13
v_cmp_gt_i32 s[100:101], 51, v13
v_mfma_f32_16x16x32_bf16 v[232:235], a[16:19], a[80:83], v[232:235]
buffer_load_dwordx4 v16, s[32:35], s64 offen offset:0 sc1 lds
v_mfma_f32_16x16x32_bf16 v[240:243], a[24:27], a[80:83], v[240:243]
v_lshlrev_b32 v14, 7, v0
v_mfma_f32_16x16x32_bf16 v[240:243], a[28:31], a[84:87], v[240:243]
s_lshl2_add_u32 s66, s2, s30
ds_read_b64_tr_b16 a[80:81], v5 offset:32768
v_mfma_f32_16x16x32_bf16 v[252:255], a[68:71], a[92:95], v[252:255]
s_lshl_b32 s67, s66, 13
ds_read_b64_tr_b16 a[82:83], v5 offset:33792
v_mfma_f32_16x16x32_bf16 v[252:255], a[64:67], a[88:91], v[252:255]
ds_read_b64_tr_b16 a[84:85], v5 offset:40960
v_add_u32 v13, s67, v14
v_mfma_f32_16x16x32_bf16 v[244:247], a[24:27], a[96:99], v[244:247]
ds_read_b64_tr_b16 a[86:87], v5 offset:41984
v_and_b32 v14, 0x7ff, v14
v_mfma_f32_16x16x32_bf16 v[244:247], a[28:31], a[100:103], v[244:247]
s_lshl_b32 s67, s66, 11
buffer_load_dwordx4 v16, s[32:35], s64 offen offset:1024 sc1 lds
v_mfma_f32_16x16x32_bf16 v[236:239], a[20:23], a[100:103], v[236:239]
ds_read_b64_tr_b16 a[88:89], v6 offset:32768
v_add_u32 v19, 0x8000, v19
v_mfma_f32_16x16x32_bf16 v[236:239], a[16:19], a[96:99], v[236:239]
ds_read_b64_tr_b16 a[90:91], v6 offset:33792
v_add_u32 v14, s67, v14
v_mfma_f32_16x16x32_bf16 v[228:231], a[8:11], a[96:99], v[228:231]
ds_read_b64_tr_b16 a[92:93], v6 offset:40960
v_mfma_f32_16x16x32_bf16 v[228:231], a[12:15], a[100:103], v[228:231]
ds_read_b64_tr_b16 a[94:95], v6 offset:41984
v_mfma_f32_16x16x32_bf16 v[220:223], a[4:7], a[100:103], v[220:223]
v_mfma_f32_16x16x32_bf16 v[220:223], a[0:3], a[96:99], v[220:223]
s_waitcnt lgkmcnt(7)
buffer_load_dwordx4 v16, s[32:35], s64 offen offset:2048 sc1 lds
v_mfma_f32_16x16x32_bf16 v[152:155], a[104:107], a[0:3], v[152:155]
ds_read_b64_tr_b16 a[96:97], v7 offset:32768
v_mfma_f32_16x16x32_bf16 v[152:155], a[108:111], a[4:7], v[152:155]
ds_read_b64_tr_b16 a[98:99], v7 offset:33792
v_add_u32 v20, 0x8000, v20
v_mfma_f32_16x16x32_bf16 v[160:163], a[108:111], a[12:15], v[160:163]
ds_read_b64_tr_b16 a[100:101], v7 offset:40960
v_mfma_f32_16x16x32_bf16 v[160:163], a[104:107], a[8:11], v[160:163]
ds_read_b64_tr_b16 a[102:103], v7 offset:41984
v_mfma_f32_16x16x32_bf16 v[168:171], a[104:107], a[16:19], v[168:171]
v_mfma_f32_16x16x32_bf16 v[168:171], a[108:111], a[20:23], v[168:171]
buffer_load_dwordx4 v16, s[32:35], s64 offen offset:3072 sc1 lds
v_mfma_f32_16x16x32_bf16 v[176:179], a[108:111], a[28:31], v[176:179]
v_mfma_f32_16x16x32_bf16 v[176:179], a[104:107], a[24:27], v[176:179]
ds_read_b64_tr_b16 a[104:105], v8 offset:32768
v_mfma_f32_16x16x32_bf16 v[180:183], a[112:115], a[24:27], v[180:183]
ds_read_b64_tr_b16 a[106:107], v8 offset:33792
v_mfma_f32_16x16x32_bf16 v[180:183], a[116:119], a[28:31], v[180:183]
ds_read_b64_tr_b16 a[108:109], v8 offset:40960
v_add_u32 v4, 0x8000, v4
v_mfma_f32_16x16x32_bf16 v[172:175], a[116:119], a[20:23], v[172:175]
ds_read_b64_tr_b16 a[110:111], v8 offset:41984
v_mfma_f32_16x16x32_bf16 v[172:175], a[112:115], a[16:19], v[172:175]
v_mfma_f32_16x16x32_bf16 v[164:167], a[112:115], a[8:11], v[164:167]
v_mfma_f32_16x16x32_bf16 v[164:167], a[116:119], a[12:15], v[164:167]
s_add_u32 s17, s78, .-L_pc+6144
v_mfma_f32_16x16x32_bf16 v[156:159], a[116:119], a[4:7], v[156:159]
s_and_b32 s66, s2, 7
buffer_load_dword a252, v16, s[88:91], s17 offen
v_mfma_f32_16x16x32_bf16 v[156:159], a[112:115], a[0:3], v[156:159]
s_lshr_b32 s67, s2, 3
s_lshr_b32 s83, s66, 2
ds_read_b64_tr_b16 a[112:113], v9 offset:32768
v_mfma_f32_16x16x32_bf16 v[24:27], a[72:75], a[0:3], v[24:27]
s_and_b32 s68, s66, 1
s_and_b32 s69, s67, 7
ds_read_b64_tr_b16 a[114:115], v9 offset:33792
v_mfma_f32_16x16x32_bf16 v[24:27], a[76:79], a[4:7], v[24:27]
s_lshl3_add_u32 s82, s68, s69
ds_read_b64_tr_b16 a[116:117], v9 offset:40960
v_add_u32 v5, 0x8000, v5
v_mfma_f32_16x16x32_bf16 v[40:43], a[76:79], a[12:15], v[40:43]
s_waitcnt vmcnt(13)
s_and_b32 s68, s66, 2
ds_read_b64_tr_b16 a[118:119], v9 offset:41984
v_mfma_f32_16x16x32_bf16 v[40:43], a[72:75], a[8:11], v[40:43]
s_lshr_b32 s69, s67, 3
s_lshl1_add_u32 s87, s68, s69
ds_read_b128 a[32:35], v2 offset:32768
v_mfma_f32_16x16x32_bf16 v[56:59], a[72:75], a[16:19], v[56:59]
s_lshl_b32 s87, s87, 8
s_lshl_b32 s86, s30, 13
ds_read_b128 a[36:39], v3 offset:32768
v_mfma_f32_16x16x32_bf16 v[56:59], a[76:79], a[20:23], v[56:59]
s_lshl_b32 s85, s30, 16
s_add_u32 s85, s85, s87
s_add_u32 s17, s78, .-L_pc+9728
ds_read_b128 a[40:43], v2 offset:34816
v_mfma_f32_16x16x32_bf16 v[72:75], a[76:79], a[28:31], v[72:75]
s_lshl_b32 s66, s83, 20
buffer_load_dword a252, v16, s[88:91], s17 offen
v_mfma_f32_16x16x32_bf16 v[72:75], a[72:75], a[24:27], v[72:75]
s_waitcnt lgkmcnt(7)
s_add_u32 s85, s85, s66
s_mul_i32 s84, s82, 1310720
ds_read_b128 a[44:47], v3 offset:34816
v_mfma_f32_16x16x32_bf16 v[136:139], a[80:83], a[24:27], v[136:139]
s_and_b32 s66, s30, 1
s_lshl_b32 s66, s66, 14
ds_read_b128 a[48:51], v2 offset:36864
v_mfma_f32_16x16x32_bf16 v[136:139], a[84:87], a[28:31], v[136:139]
s_add_u32 s84, s84, s66
ds_read_b128 a[52:55], v3 offset:36864
v_add_u32 v6, 0x8000, v6
v_mfma_f32_16x16x32_bf16 v[120:123], a[84:87], a[20:23], v[120:123]
s_lshl_b32 s66, s83, 17
s_add_u32 s84, s84, s66
ds_read_b128 a[56:59], v2 offset:38912
v_mfma_f32_16x16x32_bf16 v[120:123], a[80:83], a[16:19], v[120:123]
s_add_u32 s84, s84, 34603008
s_sub_u32 s66, 15, s82
ds_read_b128 a[60:63], v3 offset:38912
v_mfma_f32_16x16x32_bf16 v[104:107], a[80:83], a[8:11], v[104:107]
s_min_u32 s66, s66, s82
s_lshl1_add_u32 s66, s66, s83
ds_read_b64_tr_b16 a[72:73], v10 offset:32768
v_mfma_f32_16x16x32_bf16 v[104:107], a[84:87], a[12:15], v[104:107]
s_lshl_b32 s80, s66, 8
s_add_u32 s80, s80, 8192
s_add_u32 s17, s78, .-L_pc+13312
ds_read_b64_tr_b16 a[74:75], v10 offset:33792
v_mfma_f32_16x16x32_bf16 v[88:91], a[84:87], a[4:7], v[88:91]
s_mov_b32 s36, s20
buffer_load_dword a252, v16, s[88:91], s17 offen
v_mfma_f32_16x16x32_bf16 v[88:91], a[80:83], a[0:3], v[88:91]
s_mov_b32 s37, s21
s_mov_b32 s38, 2097152
ds_read_b64_tr_b16 a[76:77], v10 offset:40960
v_mfma_f32_16x16x32_bf16 v[28:31], a[88:91], a[0:3], v[28:31]
s_mov_b32 s40, s14
s_mov_b32 s41, s15
ds_read_b64_tr_b16 a[78:79], v10 offset:41984
v_mfma_f32_16x16x32_bf16 v[28:31], a[92:95], a[4:7], v[28:31]
s_mov_b32 s42, 8388608
ds_read_b64_tr_b16 a[80:81], v11 offset:32768
v_add_u32 v7, 0x8000, v7
v_mfma_f32_16x16x32_bf16 v[44:47], a[92:95], a[12:15], v[44:47]
s_lshl_b32 s66, s30, 11
ds_read_b64_tr_b16 a[82:83], v11 offset:33792
v_mfma_f32_16x16x32_bf16 v[44:47], a[88:91], a[8:11], v[44:47]
s_add_u32 s66, s66, 32768
ds_read_b64_tr_b16 a[84:85], v11 offset:40960
v_mfma_f32_16x16x32_bf16 v[60:63], a[88:91], a[16:19], v[60:63]
ds_read_b64_tr_b16 a[86:87], v11 offset:41984
v_add_u32 v22, s66, v16
v_mfma_f32_16x16x32_bf16 v[60:63], a[92:95], a[20:23], v[60:63]
v_add_u32 v23, 0x10000, v22
v_mfma_f32_16x16x32_bf16 v[76:79], a[92:95], a[28:31], v[76:79]
s_lshr_b32 s66, s30, 1
v_mfma_f32_16x16x32_bf16 v[76:79], a[88:91], a[24:27], v[76:79]
s_lshl_b32 s66, s66, 16
v_mfma_f32_16x16x32_bf16 v[140:143], a[96:99], a[24:27], v[140:143]
s_and_b32 s67, s30, 1
v_mfma_f32_16x16x32_bf16 v[140:143], a[100:103], a[28:31], v[140:143]
s_lshl3_add_u32 s66, s67, s66
v_add_u32 v8, 0x8000, v8
v_mfma_f32_16x16x32_bf16 v[124:127], a[100:103], a[20:23], v[124:127]
s_add_u32 s66, s66, 32768
v_mfma_f32_16x16x32_bf16 v[124:127], a[96:99], a[16:19], v[124:127]
v_add_u32 v15, s66, v16
v_mfma_f32_16x16x32_bf16 v[108:111], a[96:99], a[8:11], v[108:111]
v_and_b32 v1, 15, v0
v_mfma_f32_16x16x32_bf16 v[108:111], a[100:103], a[12:15], v[108:111]
v_lshlrev_b32 v1, 3, v1
v_mfma_f32_16x16x32_bf16 v[92:95], a[100:103], a[4:7], v[92:95]
s_lshl_b32 s66, s30, 7
v_add_u32 v9, 0x8000, v9
v_add_u32 v10, 0x8000, v10
v_mfma_f32_16x16x32_bf16 v[92:95], a[96:99], a[0:3], v[92:95]
s_add_u32 s66, s66, 58720256
v_add_u32 v11, 0x8000, v11
v_mfma_f32_16x16x32_bf16 v[32:35], a[104:107], a[0:3], v[32:35]
s_lshl_b32 s67, s3, 10
v_mfma_f32_16x16x32_bf16 v[32:35], a[108:111], a[4:7], v[32:35]
s_add_u32 s67, s67, s66
v_mfma_f32_16x16x32_bf16 v[48:51], a[108:111], a[12:15], v[48:51]
s_lshl_b32 s68, s16, 10
s_waitcnt lgkmcnt(0)
s_barrier
v_mfma_f32_16x16x32_bf16 v[48:51], a[104:107], a[8:11], v[48:51]
s_add_u32 s68, s68, s66
ds_read_b64_tr_b16 a[88:89], v19 offset:36864
v_mfma_f32_16x16x32_bf16 v[64:67], a[104:107], a[16:19], v[64:67]
ds_read_b64_tr_b16 a[90:91], v19 offset:37120
v_mfma_f32_16x16x32_bf16 v[64:67], a[108:111], a[20:23], v[64:67]
ds_read_b64_tr_b16 a[92:93], v19 offset:38912
v_mfma_f32_16x16x32_bf16 v[80:83], a[108:111], a[28:31], v[80:83]
ds_read_b64_tr_b16 a[94:95], v19 offset:39168
v_mfma_f32_16x16x32_bf16 v[80:83], a[104:107], a[24:27], v[80:83]
ds_read_b128 a[64:67], v17 offset:32768
v_mfma_f32_16x16x32_bf16 v[144:147], a[112:115], a[24:27], v[144:147]
ds_read_b128 a[68:71], v18 offset:32768
v_mfma_f32_16x16x32_bf16 v[144:147], a[116:119], a[28:31], v[144:147]
ds_read_b64_tr_b16 a[96:97], v21 offset:36864
v_mfma_f32_16x16x32_bf16 v[128:131], a[116:119], a[20:23], v[128:131]
ds_read_b64_tr_b16 a[98:99], v21 offset:37120
v_mfma_f32_16x16x32_bf16 v[128:131], a[112:115], a[16:19], v[128:131]
ds_read_b64_tr_b16 a[100:101], v21 offset:38912
v_mfma_f32_16x16x32_bf16 v[112:115], a[112:115], a[8:11], v[112:115]
ds_read_b64_tr_b16 a[102:103], v21 offset:39168
v_mfma_f32_16x16x32_bf16 v[112:115], a[116:119], a[12:15], v[112:115]
ds_read_b64_tr_b16 a[104:105], v20 offset:36864
v_mfma_f32_16x16x32_bf16 v[96:99], a[116:119], a[4:7], v[96:99]
ds_read_b64_tr_b16 a[106:107], v20 offset:37120
v_mfma_f32_16x16x32_bf16 v[96:99], a[112:115], a[0:3], v[96:99]
ds_read_b64_tr_b16 a[108:109], v20 offset:38912
v_mfma_f32_16x16x32_bf16 v[36:39], a[72:75], a[0:3], v[36:39]
ds_read_b64_tr_b16 a[110:111], v20 offset:39168
v_mfma_f32_16x16x32_bf16 v[36:39], a[76:79], a[4:7], v[36:39]
buffer_load_dwordx2 a[232:233], v1, s[44:47], s67 offen offset:0 sc1
v_mfma_f32_16x16x32_bf16 v[52:55], a[76:79], a[12:15], v[52:55]
ds_read_b64_tr_b16 a[112:113], v19 offset:40960
v_mfma_f32_16x16x32_bf16 v[52:55], a[72:75], a[8:11], v[52:55]
buffer_load_dwordx2 a[234:235], v1, s[44:47], s67 offen offset:512 sc1
v_mfma_f32_16x16x32_bf16 v[68:71], a[72:75], a[16:19], v[68:71]
ds_read_b64_tr_b16 a[114:115], v19 offset:41216
v_mfma_f32_16x16x32_bf16 v[68:71], a[76:79], a[20:23], v[68:71]
buffer_load_dwordx2 a[236:237], v1, s[44:47], s68 offen offset:0 sc1
v_mfma_f32_16x16x32_bf16 v[84:87], a[76:79], a[28:31], v[84:87]
ds_read_b64_tr_b16 a[116:117], v19 offset:43008
v_mfma_f32_16x16x32_bf16 v[84:87], a[72:75], a[24:27], v[84:87]
buffer_load_dwordx2 a[238:239], v1, s[44:47], s68 offen offset:512 sc1
v_mfma_f32_16x16x32_bf16 v[148:151], a[80:83], a[24:27], v[148:151]
ds_read_b64_tr_b16 a[118:119], v19 offset:43264
v_mfma_f32_16x16x32_bf16 v[148:151], a[84:87], a[28:31], v[148:151]
ds_read_b64_tr_b16 a[72:73], v21 offset:40960
v_mfma_f32_16x16x32_bf16 v[132:135], a[84:87], a[20:23], v[132:135]
ds_read_b64_tr_b16 a[74:75], v21 offset:41216
v_mfma_f32_16x16x32_bf16 v[132:135], a[80:83], a[16:19], v[132:135]
ds_read_b64_tr_b16 a[76:77], v21 offset:43008
v_mfma_f32_16x16x32_bf16 v[116:119], a[80:83], a[8:11], v[116:119]
ds_read_b64_tr_b16 a[78:79], v21 offset:43264
v_mfma_f32_16x16x32_bf16 v[116:119], a[84:87], a[12:15], v[116:119]
v_mfma_f32_16x16x32_bf16 v[100:103], a[84:87], a[4:7], v[100:103]
v_mfma_f32_16x16x32_bf16 v[100:103], a[80:83], a[0:3], v[100:103]
s_waitcnt lgkmcnt(6)
ds_read_b64_tr_b16 a[80:81], v20 offset:40960
v_mfma_f32_16x16x32_bf16 v[184:187], a[88:91], a[32:35], v[184:187]
global_load_dword a252, v13, s[14:15]
v_mfma_f32_16x16x32_bf16 v[184:187], a[92:95], a[36:39], v[184:187]
ds_read_b64_tr_b16 a[82:83], v20 offset:41216
v_mfma_f32_16x16x32_bf16 v[192:195], a[92:95], a[44:47], v[192:195]
ds_read_b64_tr_b16 a[84:85], v20 offset:43008
v_mfma_f32_16x16x32_bf16 v[192:195], a[88:91], a[40:43], v[192:195]
ds_read_b64_tr_b16 a[86:87], v20 offset:43264
v_mfma_f32_16x16x32_bf16 v[200:203], a[88:91], a[48:51], v[200:203]
global_load_dword a252, v14, s[20:21]
v_mfma_f32_16x16x32_bf16 v[200:203], a[92:95], a[52:55], v[200:203]
v_mfma_f32_16x16x32_bf16 v[208:211], a[92:95], a[60:63], v[208:211]
v_mfma_f32_16x16x32_bf16 v[208:211], a[88:91], a[56:59], v[208:211]
ds_read_b64_tr_b16 a[88:89], v19 offset:32768
v_mfma_f32_16x16x32_bf16 v[248:251], a[96:99], a[64:67], v[248:251]
ds_read_b64_tr_b16 a[90:91], v19 offset:33024
v_mfma_f32_16x16x32_bf16 v[248:251], a[100:103], a[68:71], v[248:251]
ds_read_b64_tr_b16 a[92:93], v19 offset:34816
v_mfma_f32_16x16x32_bf16 v[212:215], a[108:111], a[60:63], v[212:215]
ds_read_b64_tr_b16 a[94:95], v19 offset:35072
v_mfma_f32_16x16x32_bf16 v[212:215], a[104:107], a[56:59], v[212:215]
ds_read_b64_tr_b16 a[96:97], v20 offset:32768
v_mfma_f32_16x16x32_bf16 v[204:207], a[104:107], a[48:51], v[204:207]
ds_read_b64_tr_b16 a[98:99], v20 offset:33024
v_mfma_f32_16x16x32_bf16 v[204:207], a[108:111], a[52:55], v[204:207]
ds_read_b64_tr_b16 a[100:101], v20 offset:34816
v_mfma_f32_16x16x32_bf16 v[196:199], a[108:111], a[44:47], v[196:199]
ds_read_b64_tr_b16 a[102:103], v20 offset:35072
v_mfma_f32_16x16x32_bf16 v[196:199], a[104:107], a[40:43], v[196:199]
s_or_b32 s66, s3, s30
s_cmp_eq_u32 s66, 0
s_cselect_b32 s66, 0xff800000, 0
v_mfma_f32_16x16x32_bf16 v[188:191], a[104:107], a[32:35], v[188:191]
v_mfma_f32_16x16x32_bf16 v[188:191], a[108:111], a[36:39], v[188:191]
s_waitcnt lgkmcnt(7)
ds_read_b64_tr_b16 a[104:105], v4 offset:32768
v_cvt_pk_bf16_f32 v248, v248, v249
v_mfma_f32_16x16x32_bf16 v[216:219], a[36:39], a[116:119], v[216:219]
ds_read_b64_tr_b16 a[106:107], v4 offset:33792
v_cvt_pk_bf16_f32 v249, v250, v251
v_mfma_f32_16x16x32_bf16 v[216:219], a[32:35], a[112:115], v[216:219]
ds_read_b64_tr_b16 a[108:109], v4 offset:40960
v_mfma_f32_16x16x32_bf16 v[224:227], a[40:43], a[112:115], v[224:227]
ds_read_b64_tr_b16 a[110:111], v4 offset:41984
v_mfma_f32_16x16x32_bf16 v[224:227], a[44:47], a[116:119], v[224:227]
ds_write_b64 v15, v[248:249]
v_mfma_f32_16x16x32_bf16 v[232:235], a[52:55], a[116:119], v[232:235]
v_cvt_pk_bf16_f32 v208, v208, v209
v_cvt_pk_bf16_f32 v209, v210, v211
v_mfma_f32_16x16x32_bf16 v[232:235], a[48:51], a[112:115], v[232:235]
v_cvt_pk_bf16_f32 v210, v212, v213
v_cvt_pk_bf16_f32 v211, v214, v215
v_mfma_f32_16x16x32_bf16 v[240:243], a[56:59], a[112:115], v[240:243]
ds_write_b128 v23, v[208:211] offset:10240
v_mfma_f32_16x16x32_bf16 v[240:243], a[60:63], a[116:119], v[240:243]
ds_read_b64_tr_b16 a[112:113], v5 offset:32768
v_cvt_pk_bf16_f32 v200, v200, v201
v_mfma_f32_16x16x32_bf16 v[252:255], a[68:71], a[76:79], v[252:255]
ds_read_b64_tr_b16 a[114:115], v5 offset:33792
v_cvt_pk_bf16_f32 v201, v202, v203
v_mfma_f32_16x16x32_bf16 v[252:255], a[64:67], a[72:75], v[252:255]
ds_read_b64_tr_b16 a[116:117], v5 offset:40960
v_cvt_pk_bf16_f32 v202, v204, v205
v_mfma_f32_16x16x32_bf16 v[244:247], a[56:59], a[80:83], v[244:247]
ds_read_b64_tr_b16 a[118:119], v5 offset:41984
v_cvt_pk_bf16_f32 v203, v206, v207
v_mfma_f32_16x16x32_bf16 v[244:247], a[60:63], a[84:87], v[244:247]
ds_read_b64_tr_b16 a[72:73], v6 offset:32768
v_mfma_f32_16x16x32_bf16 v[236:239], a[52:55], a[84:87], v[236:239]
ds_read_b64_tr_b16 a[74:75], v6 offset:33792
v_mfma_f32_16x16x32_bf16 v[236:239], a[48:51], a[80:83], v[236:239]
ds_read_b64_tr_b16 a[76:77], v6 offset:40960
v_mfma_f32_16x16x32_bf16 v[228:231], a[40:43], a[80:83], v[228:231]
ds_read_b64_tr_b16 a[78:79], v6 offset:41984
v_mfma_f32_16x16x32_bf16 v[228:231], a[44:47], a[84:87], v[228:231]
ds_write_b128 v23, v[200:203] offset:2048
v_mfma_f32_16x16x32_bf16 v[220:223], a[36:39], a[84:87], v[220:223]
v_cvt_pk_bf16_f32 v192, v192, v193
v_cvt_pk_bf16_f32 v193, v194, v195
v_mfma_f32_16x16x32_bf16 v[220:223], a[32:35], a[80:83], v[220:223]
s_waitcnt lgkmcnt(8)
ds_read_b64_tr_b16 a[80:81], v7 offset:32768
v_cvt_pk_bf16_f32 v194, v196, v197
v_mfma_f32_16x16x32_bf16 v[152:155], a[88:91], a[32:35], v[152:155]
ds_read_b64_tr_b16 a[82:83], v7 offset:33792
v_cvt_pk_bf16_f32 v195, v198, v199
v_mfma_f32_16x16x32_bf16 v[152:155], a[92:95], a[36:39], v[152:155]
ds_read_b64_tr_b16 a[84:85], v7 offset:40960
v_mfma_f32_16x16x32_bf16 v[160:163], a[92:95], a[44:47], v[160:163]
ds_read_b64_tr_b16 a[86:87], v7 offset:41984
v_mfma_f32_16x16x32_bf16 v[160:163], a[88:91], a[40:43], v[160:163]
ds_write_b128 v22, v[192:195] offset:10240
v_mfma_f32_16x16x32_bf16 v[168:171], a[88:91], a[48:51], v[168:171]
v_cvt_pk_bf16_f32 v184, v184, v185
v_cvt_pk_bf16_f32 v185, v186, v187
v_mfma_f32_16x16x32_bf16 v[168:171], a[92:95], a[52:55], v[168:171]
v_cvt_pk_bf16_f32 v186, v188, v189
v_cvt_pk_bf16_f32 v187, v190, v191
v_mfma_f32_16x16x32_bf16 v[176:179], a[92:95], a[60:63], v[176:179]
ds_write_b128 v22, v[184:187] offset:2048
v_mfma_f32_16x16x32_bf16 v[176:179], a[88:91], a[56:59], v[176:179]
ds_read_b64_tr_b16 a[88:89], v8 offset:32768
v_cvt_pk_bf16_f32 v252, v252, v253
v_mfma_f32_16x16x32_bf16 v[180:183], a[96:99], a[56:59], v[180:183]
ds_read_b64_tr_b16 a[90:91], v8 offset:33792
v_cvt_pk_bf16_f32 v253, v254, v255
v_mfma_f32_16x16x32_bf16 v[180:183], a[100:103], a[60:63], v[180:183]
ds_read_b64_tr_b16 a[92:93], v8 offset:40960
v_mfma_f32_16x16x32_bf16 v[172:175], a[100:103], a[52:55], v[172:175]
ds_read_b64_tr_b16 a[94:95], v8 offset:41984
v_mfma_f32_16x16x32_bf16 v[172:175], a[96:99], a[48:51], v[172:175]
ds_write_b64 v15, v[252:253] offset:1024
v_mfma_f32_16x16x32_bf16 v[164:167], a[96:99], a[40:43], v[164:167]
v_cvt_pk_bf16_f32 v243, v242, v243
v_cvt_pk_bf16_f32 v242, v240, v241
v_mfma_f32_16x16x32_bf16 v[164:167], a[100:103], a[44:47], v[164:167]
v_cvt_pk_bf16_f32 v247, v246, v247
v_cvt_pk_bf16_f32 v246, v244, v245
v_mfma_f32_16x16x32_bf16 v[156:159], a[100:103], a[36:39], v[156:159]
ds_write_b64 v23, v[242:243] offset:11264
v_mfma_f32_16x16x32_bf16 v[156:159], a[96:99], a[32:35], v[156:159]
ds_read_b64_tr_b16 a[96:97], v9 offset:32768
v_mfma_f32_16x16x32_bf16 v[24:27], a[104:107], a[32:35], v[24:27]
ds_read_b64_tr_b16 a[98:99], v9 offset:33792
v_mfma_f32_16x16x32_bf16 v[24:27], a[108:111], a[36:39], v[24:27]
ds_read_b64_tr_b16 a[100:101], v9 offset:40960
v_mfma_f32_16x16x32_bf16 v[40:43], a[108:111], a[44:47], v[40:43]
ds_read_b64_tr_b16 a[102:103], v9 offset:41984
v_mfma_f32_16x16x32_bf16 v[40:43], a[104:107], a[40:43], v[40:43]
ds_write_b64 v23, v[246:247] offset:11272
v_mfma_f32_16x16x32_bf16 v[56:59], a[104:107], a[48:51], v[56:59]
v_cvt_pk_bf16_f32 v235, v234, v235
v_cvt_pk_bf16_f32 v234, v232, v233
v_mfma_f32_16x16x32_bf16 v[56:59], a[108:111], a[52:55], v[56:59]
v_cvt_pk_bf16_f32 v239, v238, v239
v_cvt_pk_bf16_f32 v238, v236, v237
v_mfma_f32_16x16x32_bf16 v[72:75], a[108:111], a[60:63], v[72:75]
ds_write_b64 v23, v[234:235] offset:3072
v_mfma_f32_16x16x32_bf16 v[72:75], a[104:107], a[56:59], v[72:75]
s_waitcnt lgkmcnt(7)
ds_read_b64_tr_b16 a[104:105], v10 offset:32768
v_mfma_f32_16x16x32_bf16 v[136:139], a[112:115], a[56:59], v[136:139]
ds_read_b64_tr_b16 a[106:107], v10 offset:33792
v_mfma_f32_16x16x32_bf16 v[136:139], a[116:119], a[60:63], v[136:139]
ds_read_b64_tr_b16 a[108:109], v10 offset:40960
v_mfma_f32_16x16x32_bf16 v[120:123], a[116:119], a[52:55], v[120:123]
ds_read_b64_tr_b16 a[110:111], v10 offset:41984
v_mfma_f32_16x16x32_bf16 v[120:123], a[112:115], a[48:51], v[120:123]
ds_write_b64 v23, v[238:239] offset:3080
v_mfma_f32_16x16x32_bf16 v[104:107], a[112:115], a[40:43], v[104:107]
v_cvt_pk_bf16_f32 v227, v226, v227
v_cvt_pk_bf16_f32 v226, v224, v225
v_mfma_f32_16x16x32_bf16 v[104:107], a[116:119], a[44:47], v[104:107]
v_cvt_pk_bf16_f32 v231, v230, v231
v_cvt_pk_bf16_f32 v230, v228, v229
v_mfma_f32_16x16x32_bf16 v[88:91], a[116:119], a[36:39], v[88:91]
ds_write_b64 v22, v[226:227] offset:11264
v_mfma_f32_16x16x32_bf16 v[88:91], a[112:115], a[32:35], v[88:91]
ds_read_b64_tr_b16 a[112:113], v11 offset:32768
v_mfma_f32_16x16x32_bf16 v[28:31], a[72:75], a[32:35], v[28:31]
ds_read_b64_tr_b16 a[114:115], v11 offset:33792
v_mfma_f32_16x16x32_bf16 v[28:31], a[76:79], a[36:39], v[28:31]
ds_read_b64_tr_b16 a[116:117], v11 offset:40960
v_mfma_f32_16x16x32_bf16 v[44:47], a[76:79], a[44:47], v[44:47]
ds_read_b64_tr_b16 a[118:119], v11 offset:41984
v_mfma_f32_16x16x32_bf16 v[44:47], a[72:75], a[40:43], v[44:47]
ds_write_b64 v22, v[230:231] offset:11272
v_mfma_f32_16x16x32_bf16 v[60:63], a[72:75], a[48:51], v[60:63]
v_cvt_pk_bf16_f32 v219, v218, v219
v_cvt_pk_bf16_f32 v218, v216, v217
v_mfma_f32_16x16x32_bf16 v[60:63], a[76:79], a[52:55], v[60:63]
v_cvt_pk_bf16_f32 v223, v222, v223
v_cvt_pk_bf16_f32 v222, v220, v221
v_mfma_f32_16x16x32_bf16 v[76:79], a[76:79], a[60:63], v[76:79]
ds_write_b64 v22, v[218:219] offset:3072
v_mfma_f32_16x16x32_bf16 v[76:79], a[72:75], a[56:59], v[76:79]
ds_write_b64 v22, v[222:223] offset:3080
v_mfma_f32_16x16x32_bf16 v[140:143], a[80:83], a[56:59], v[140:143]
v_cvt_pk_bf16_f32 v176, v176, v177
v_cvt_pk_bf16_f32 v177, v178, v179
v_mfma_f32_16x16x32_bf16 v[140:143], a[84:87], a[60:63], v[140:143]
v_cvt_pk_bf16_f32 v178, v180, v181
v_cvt_pk_bf16_f32 v179, v182, v183
v_mfma_f32_16x16x32_bf16 v[124:127], a[84:87], a[52:55], v[124:127]
v_cvt_pk_bf16_f32 v168, v168, v169
v_cvt_pk_bf16_f32 v169, v170, v171
v_mfma_f32_16x16x32_bf16 v[124:127], a[80:83], a[48:51], v[124:127]
v_cvt_pk_bf16_f32 v170, v172, v173
v_cvt_pk_bf16_f32 v171, v174, v175
v_mfma_f32_16x16x32_bf16 v[108:111], a[80:83], a[40:43], v[108:111]
s_waitcnt lgkmcnt(0)
s_barrier
v_mfma_f32_16x16x32_bf16 v[108:111], a[84:87], a[44:47], v[108:111]
v_cvt_pk_bf16_f32 v160, v160, v161
v_cvt_pk_bf16_f32 v161, v162, v163
v_mfma_f32_16x16x32_bf16 v[92:95], a[84:87], a[36:39], v[92:95]
v_cvt_pk_bf16_f32 v162, v164, v165
v_cvt_pk_bf16_f32 v163, v166, v167
v_mfma_f32_16x16x32_bf16 v[92:95], a[80:83], a[32:35], v[92:95]
v_cvt_pk_bf16_f32 v152, v152, v153
v_cvt_pk_bf16_f32 v153, v154, v155
v_mfma_f32_16x16x32_bf16 v[32:35], a[88:91], a[32:35], v[32:35]
v_cvt_pk_bf16_f32 v154, v156, v157
v_cvt_pk_bf16_f32 v155, v158, v159
v_mfma_f32_16x16x32_bf16 v[32:35], a[92:95], a[36:39], v[32:35]
ds_read_b128 a[0:3], v22 offset:0
v_subrev_u32 v13, 0, v12
v_mfma_f32_16x16x32_bf16 v[48:51], a[92:95], a[44:47], v[48:51]
v_lshlrev_b32 v14, 31, v13
v_mfma_f32_16x16x32_bf16 v[48:51], a[88:91], a[40:43], v[48:51]
ds_read_b128 a[4:7], v22 offset:8192
v_or_b32 v17, v13, v14
v_mfma_f32_16x16x32_bf16 v[64:67], a[88:91], a[48:51], v[64:67]
v_ashrrev_i32 v17, 31, v17
v_mfma_f32_16x16x32_bf16 v[64:67], a[92:95], a[52:55], v[64:67]
ds_read_b128 a[8:11], v23 offset:0
v_and_b32 v248, 0xff800000, v17
v_mfma_f32_16x16x32_bf16 v[80:83], a[92:95], a[60:63], v[80:83]
v_not_b32 v13, v13
v_mfma_f32_16x16x32_bf16 v[80:83], a[88:91], a[56:59], v[80:83]
ds_read_b128 a[12:15], v23 offset:8192
v_or_b32 v17, v13, v14
v_mfma_f32_16x16x32_bf16 v[144:147], a[96:99], a[56:59], v[144:147]
v_ashrrev_i32 v17, 31, v17
v_mfma_f32_16x16x32_bf16 v[144:147], a[100:103], a[60:63], v[144:147]
ds_read_b64 v[216:217], v22 offset:1024
v_and_b32 v252, 0xff800000, v17
v_mfma_f32_16x16x32_bf16 v[128:131], a[100:103], a[52:55], v[128:131]
v_or_b32 v18, s66, v252
v_mfma_f32_16x16x32_bf16 v[128:131], a[96:99], a[48:51], v[128:131]
ds_read_b64 v[220:221], v22 offset:1032
v_subrev_u32 v13, 1, v12
v_mfma_f32_16x16x32_bf16 v[112:115], a[96:99], a[40:43], v[112:115]
v_lshlrev_b32 v14, 31, v13
v_mfma_f32_16x16x32_bf16 v[112:115], a[100:103], a[44:47], v[112:115]
ds_read_b64 v[224:225], v22 offset:9216
v_or_b32 v17, v13, v14
v_mfma_f32_16x16x32_bf16 v[96:99], a[100:103], a[36:39], v[96:99]
v_ashrrev_i32 v17, 31, v17
v_mfma_f32_16x16x32_bf16 v[96:99], a[96:99], a[32:35], v[96:99]
ds_read_b64 v[228:229], v22 offset:9224
v_and_b32 v249, 0xff800000, v17
v_mfma_f32_16x16x32_bf16 v[36:39], a[104:107], a[32:35], v[36:39]
v_not_b32 v13, v13
v_mfma_f32_16x16x32_bf16 v[36:39], a[108:111], a[36:39], v[36:39]
ds_read_b64 v[232:233], v23 offset:1024
v_or_b32 v17, v13, v14
v_mfma_f32_16x16x32_bf16 v[52:55], a[108:111], a[44:47], v[52:55]
v_ashrrev_i32 v17, 31, v17
v_mfma_f32_16x16x32_bf16 v[52:55], a[104:107], a[40:43], v[52:55]
ds_read_b64 v[236:237], v23 offset:1032
v_and_b32 v253, 0xff800000, v17
v_mfma_f32_16x16x32_bf16 v[68:71], a[104:107], a[48:51], v[68:71]
v_or_b32 v19, s66, v253
v_mfma_f32_16x16x32_bf16 v[68:71], a[108:111], a[52:55], v[68:71]
ds_read_b64 v[240:241], v23 offset:9216
v_subrev_u32 v13, 2, v12
v_mfma_f32_16x16x32_bf16 v[84:87], a[108:111], a[60:63], v[84:87]
v_lshlrev_b32 v14, 31, v13
v_mfma_f32_16x16x32_bf16 v[84:87], a[104:107], a[56:59], v[84:87]
ds_read_b64 v[244:245], v23 offset:9224
v_or_b32 v17, v13, v14
v_mfma_f32_16x16x32_bf16 v[148:151], a[112:115], a[56:59], v[148:151]
v_ashrrev_i32 v17, 31, v17
v_and_b32 v250, 0xff800000, v17
v_mfma_f32_16x16x32_bf16 v[148:151], a[116:119], a[60:63], v[148:151]
v_not_b32 v13, v13
v_or_b32 v17, v13, v14
v_mfma_f32_16x16x32_bf16 v[132:135], a[116:119], a[52:55], v[132:135]
v_ashrrev_i32 v17, 31, v17
v_and_b32 v254, 0xff800000, v17
v_mfma_f32_16x16x32_bf16 v[132:135], a[112:115], a[48:51], v[132:135]
v_or_b32 v20, s66, v254
v_subrev_u32 v13, 3, v12
v_mfma_f32_16x16x32_bf16 v[116:119], a[112:115], a[40:43], v[116:119]
v_lshlrev_b32 v14, 31, v13
v_or_b32 v17, v13, v14
v_mfma_f32_16x16x32_bf16 v[116:119], a[116:119], a[44:47], v[116:119]
v_ashrrev_i32 v17, 31, v17
v_and_b32 v251, 0xff800000, v17
v_mfma_f32_16x16x32_bf16 v[100:103], a[116:119], a[36:39], v[100:103]
v_not_b32 v13, v13
v_or_b32 v17, v13, v14
v_mfma_f32_16x16x32_bf16 v[100:103], a[112:115], a[32:35], v[100:103]
v_ashrrev_i32 v17, 31, v17
v_and_b32 v255, 0xff800000, v17
v_or_b32 v21, s66, v255
s_mov_b32 s68, 0x3e0293ee
s_mov_b32 s69, s68
s_mov_b32 s66, 0x3e8293ee
v_mfma_f32_16x16x32_bf16 v[188:191], v[184:187], v[152:155], v[248:251]
v_mfma_f32_16x16x32_bf16 v[196:199], v[192:195], v[160:163], v[248:251]
v_mfma_f32_16x16x32_bf16 v[204:207], v[200:203], v[168:171], v[248:251]
v_mfma_f32_16x16x32_bf16 v[212:215], v[208:211], v[176:179], v[248:251]
s_waitcnt lgkmcnt(11)
v_mfma_f32_16x16x32_bf16 v[156:159], a[0:3], v[152:155], v[18:21]
s_waitcnt lgkmcnt(10)
v_mfma_f32_16x16x32_bf16 v[164:167], a[4:7], v[160:163], v[252:255]
s_waitcnt lgkmcnt(9)
v_mfma_f32_16x16x32_bf16 v[172:175], a[8:11], v[168:171], v[252:255]
s_waitcnt lgkmcnt(8)
v_mfma_f32_16x16x32_bf16 v[180:183], a[12:15], v[176:179], v[252:255]
s_waitcnt vmcnt(2)
s_waitcnt vmcnt(3)
s_waitcnt vmcnt(4)
s_waitcnt vmcnt(5)
v_accvgpr_read_b32 v4, a232
v_accvgpr_read_b32 v5, a233
v_accvgpr_read_b32 v6, a234
v_accvgpr_read_b32 v7, a235
v_accvgpr_read_b32 v8, a236
v_accvgpr_read_b32 v9, a237
v_accvgpr_read_b32 v10, a238
v_accvgpr_read_b32 v11, a239
v_pk_mul_f32 v[24:25], v[24:25], s[68:69]
v_pk_mul_f32 v[26:27], v[26:27], s[68:69]
v_pk_mul_f32 v[88:89], v[88:89], s[68:69]
v_pk_mul_f32 v[90:91], v[90:91], s[68:69]
v_cvt_pk_bf16_f32 v24, v24, v25
v_cvt_pk_bf16_f32 v25, v26, v27
v_cvt_pk_bf16_f32 v26, v88, v89
v_cvt_pk_bf16_f32 v27, v90, v91
v_pk_mul_f32 v[40:41], v[40:41], s[68:69]
v_pk_mul_f32 v[42:43], v[42:43], s[68:69]
v_pk_mul_f32 v[104:105], v[104:105], s[68:69]
v_pk_mul_f32 v[106:107], v[106:107], s[68:69]
v_cvt_pk_bf16_f32 v40, v40, v41
v_cvt_pk_bf16_f32 v41, v42, v43
v_cvt_pk_bf16_f32 v42, v104, v105
v_cvt_pk_bf16_f32 v43, v106, v107
v_max3_f32 v12, v188, v189, v190
v_max3_f32 v12, v12, v191, v156
v_max3_f32 v12, v12, v157, v158
v_max_f32 v12, v12, v159
v_max3_f32 v13, v196, v197, v198
v_max3_f32 v13, v13, v199, v164
v_max3_f32 v13, v13, v165, v166
v_max_f32 v13, v13, v167
v_max3_f32 v14, v204, v205, v206
v_max3_f32 v14, v14, v207, v172
v_max3_f32 v14, v14, v173, v174
v_max_f32 v14, v14, v175
v_max3_f32 v15, v212, v213, v214
v_max3_f32 v15, v15, v215, v180
v_max3_f32 v15, v15, v181, v182
v_max_f32 v15, v15, v183
v_mov_b32 v20, v12
v_mov_b32 v21, v13
v_mov_b32 v22, v14
v_mov_b32 v23, v15
v_permlane16_swap_b32 v20, v12
v_permlane16_swap_b32 v21, v13
v_permlane16_swap_b32 v22, v14
v_permlane16_swap_b32 v23, v15
v_max_f32 v12, v12, v20
v_max_f32 v13, v13, v21
v_max_f32 v14, v14, v22
v_max_f32 v15, v15, v23
v_mov_b32 v20, v12
v_mov_b32 v21, v13
v_mov_b32 v22, v14
v_mov_b32 v23, v15
v_permlane32_swap_b32 v20, v12
v_permlane32_swap_b32 v21, v13
v_permlane32_swap_b32 v22, v14
v_permlane32_swap_b32 v23, v15
v_max_f32 v12, v12, v20
v_max_f32 v13, v13, v21
v_max_f32 v14, v14, v22
v_max_f32 v15, v15, v23
v_mul_f32 v12, s66, v12
v_mul_f32 v13, s66, v13
v_mul_f32 v14, s66, v14
v_mul_f32 v15, s66, v15
v_fma_f32 v156, v156, s66, -v12
v_fma_f32 v157, v157, s66, -v12
v_fma_f32 v158, v158, s66, -v12
v_fma_f32 v159, v159, s66, -v12
v_fma_f32 v188, v188, s66, -v12
v_fma_f32 v189, v189, s66, -v12
v_fma_f32 v190, v190, s66, -v12
v_fma_f32 v191, v191, s66, -v12
v_exp_f32 v156, v156
v_exp_f32 v157, v157
v_exp_f32 v158, v158
v_exp_f32 v159, v159
v_exp_f32 v188, v188
v_exp_f32 v189, v189
v_exp_f32 v190, v190
v_exp_f32 v191, v191
v_cvt_pk_bf16_f32 v156, v156, v157
v_cvt_pk_bf16_f32 v157, v158, v159
v_cvt_pk_bf16_f32 v158, v188, v189
v_cvt_pk_bf16_f32 v159, v190, v191
v_pk_mul_f32 v[56:57], v[56:57], s[68:69]
v_pk_mul_f32 v[58:59], v[58:59], s[68:69]
v_mfma_f32_16x16x32_bf16 v[188:191], a[244:247], v[156:159], 0
s_waitcnt lgkmcnt(7)
v_mfma_f32_16x16x32_bf16 v[152:155], v[216:219], v[156:159], 0
s_waitcnt lgkmcnt(6)
v_mfma_f32_16x16x32_bf16 v[184:187], v[220:223], v[156:159], 0
v_fma_f32 v164, v164, s66, -v13
v_fma_f32 v165, v165, s66, -v13
v_fma_f32 v166, v166, s66, -v13
v_fma_f32 v167, v167, s66, -v13
v_fma_f32 v196, v196, s66, -v13
v_fma_f32 v197, v197, s66, -v13
v_fma_f32 v198, v198, s66, -v13
v_fma_f32 v199, v199, s66, -v13
v_exp_f32 v164, v164
v_exp_f32 v165, v165
v_exp_f32 v166, v166
v_exp_f32 v167, v167
v_exp_f32 v196, v196
v_exp_f32 v197, v197
v_exp_f32 v198, v198
v_exp_f32 v199, v199
v_cvt_pk_bf16_f32 v164, v164, v165
v_cvt_pk_bf16_f32 v165, v166, v167
v_cvt_pk_bf16_f32 v166, v196, v197
v_cvt_pk_bf16_f32 v167, v198, v199
v_pk_mul_f32 v[120:121], v[120:121], s[68:69]
v_pk_mul_f32 v[122:123], v[122:123], s[68:69]
v_mfma_f32_16x16x32_bf16 v[196:199], a[244:247], v[164:167], 0
s_waitcnt lgkmcnt(5)
v_mfma_f32_16x16x32_bf16 v[160:163], v[224:227], v[164:167], 0
s_waitcnt lgkmcnt(4)
v_mfma_f32_16x16x32_bf16 v[192:195], v[228:231], v[164:167], 0
v_fma_f32 v172, v172, s66, -v14
v_fma_f32 v173, v173, s66, -v14
v_fma_f32 v174, v174, s66, -v14
v_fma_f32 v175, v175, s66, -v14
v_fma_f32 v204, v204, s66, -v14
v_fma_f32 v205, v205, s66, -v14
v_fma_f32 v206, v206, s66, -v14
v_fma_f32 v207, v207, s66, -v14
v_exp_f32 v172, v172
v_exp_f32 v173, v173
v_exp_f32 v174, v174
v_exp_f32 v175, v175
v_exp_f32 v204, v204
v_exp_f32 v205, v205
v_exp_f32 v206, v206
v_exp_f32 v207, v207
v_cvt_pk_bf16_f32 v172, v172, v173
v_cvt_pk_bf16_f32 v173, v174, v175
v_cvt_pk_bf16_f32 v174, v204, v205
v_cvt_pk_bf16_f32 v175, v206, v207
v_cvt_pk_bf16_f32 v56, v56, v57
v_cvt_pk_bf16_f32 v57, v58, v59
v_mfma_f32_16x16x32_bf16 v[204:207], a[244:247], v[172:175], 0
s_waitcnt lgkmcnt(3)
v_mfma_f32_16x16x32_bf16 v[168:171], v[232:235], v[172:175], 0
s_waitcnt lgkmcnt(2)
v_mfma_f32_16x16x32_bf16 v[200:203], v[236:239], v[172:175], 0
v_fma_f32 v180, v180, s66, -v15
v_fma_f32 v181, v181, s66, -v15
v_fma_f32 v182, v182, s66, -v15
v_fma_f32 v183, v183, s66, -v15
v_fma_f32 v212, v212, s66, -v15
v_fma_f32 v213, v213, s66, -v15
v_fma_f32 v214, v214, s66, -v15
v_fma_f32 v215, v215, s66, -v15
v_exp_f32 v180, v180
v_exp_f32 v181, v181
v_exp_f32 v182, v182
v_exp_f32 v183, v183
v_exp_f32 v212, v212
v_exp_f32 v213, v213
v_exp_f32 v214, v214
v_exp_f32 v215, v215
v_cvt_pk_bf16_f32 v180, v180, v181
v_cvt_pk_bf16_f32 v181, v182, v183
v_cvt_pk_bf16_f32 v182, v212, v213
v_cvt_pk_bf16_f32 v183, v214, v215
v_cvt_pk_bf16_f32 v58, v120, v121
v_cvt_pk_bf16_f32 v59, v122, v123
v_mfma_f32_16x16x32_bf16 v[212:215], a[244:247], v[180:183], 0
s_waitcnt lgkmcnt(1)
v_mfma_f32_16x16x32_bf16 v[176:179], v[240:243], v[180:183], 0
s_waitcnt lgkmcnt(0)
v_mfma_f32_16x16x32_bf16 v[208:211], v[244:247], v[180:183], 0
v_pk_mul_f32 v[72:73], v[72:73], s[68:69]
v_pk_mul_f32 v[74:75], v[74:75], s[68:69]
v_pk_mul_f32 v[136:137], v[136:137], s[68:69]
v_pk_mul_f32 v[138:139], v[138:139], s[68:69]
v_cvt_pk_bf16_f32 v72, v72, v73
v_cvt_pk_bf16_f32 v73, v74, v75
v_cvt_pk_bf16_f32 v74, v136, v137
v_cvt_pk_bf16_f32 v75, v138, v139
v_pk_mul_f32 v[28:29], v[28:29], s[68:69]
v_pk_mul_f32 v[30:31], v[30:31], s[68:69]
v_pk_mul_f32 v[92:93], v[92:93], s[68:69]
v_pk_mul_f32 v[94:95], v[94:95], s[68:69]
v_cvt_pk_bf16_f32 v28, v28, v29
v_cvt_pk_bf16_f32 v29, v30, v31
v_cvt_pk_bf16_f32 v30, v92, v93
v_cvt_pk_bf16_f32 v31, v94, v95
v_pk_mul_f32 v[44:45], v[44:45], s[68:69]
v_pk_mul_f32 v[46:47], v[46:47], s[68:69]
v_pk_mul_f32 v[108:109], v[108:109], s[68:69]
v_pk_mul_f32 v[110:111], v[110:111], s[68:69]
v_cvt_pk_bf16_f32 v44, v44, v45
v_cvt_pk_bf16_f32 v45, v46, v47
v_cvt_pk_bf16_f32 v46, v108, v109
v_cvt_pk_bf16_f32 v47, v110, v111
s_add_u32 s66, s31, 128
s_lshl_b32 s66, s66, 13
s_add_u32 s66, s66, s78
s_add_u32 s66, s66, 33554432
s_mul_i32 s64, s3, 1310720
s_add_u32 s64, s64, s66
s_mul_i32 s65, s16, 1310720
s_add_u32 s65, s65, s66
v_rcp_f32 v12, v188
v_rcp_f32 v13, v196
v_rcp_f32 v14, v204
v_rcp_f32 v15, v212
v_mul_f32 v12, v12, v5
v_mul_f32 v13, v13, v7
v_mul_f32 v14, v14, v9
v_mul_f32 v15, v15, v11
v_mul_f32 v152, v152, v12
v_mul_f32 v153, v153, v12
v_mul_f32 v154, v154, v12
v_mul_f32 v155, v155, v12
v_mul_f32 v184, v184, v12
v_mul_f32 v185, v185, v12
v_mul_f32 v186, v186, v12
v_mul_f32 v187, v187, v12
v_cvt_pk_bf16_f32 v152, v152, v153
v_cvt_pk_bf16_f32 v153, v154, v155
v_cvt_pk_bf16_f32 v154, v184, v185
v_cvt_pk_bf16_f32 v155, v186, v187
buffer_store_dwordx4 v[152:155], v16, s[44:47], s64 offen sc1
v_mul_f32 v160, v160, v13
v_mul_f32 v161, v161, v13
v_mul_f32 v162, v162, v13
v_mul_f32 v163, v163, v13
v_mul_f32 v192, v192, v13
v_mul_f32 v193, v193, v13
v_mul_f32 v194, v194, v13
v_mul_f32 v195, v195, v13
v_cvt_pk_bf16_f32 v160, v160, v161
v_cvt_pk_bf16_f32 v161, v162, v163
v_cvt_pk_bf16_f32 v162, v192, v193
v_cvt_pk_bf16_f32 v163, v194, v195
s_add_u32 s64, s64, 4096
buffer_store_dwordx4 v[160:163], v16, s[44:47], s64 offen sc1
v_mul_f32 v168, v168, v14
v_mul_f32 v169, v169, v14
v_mul_f32 v170, v170, v14
v_mul_f32 v171, v171, v14
v_mul_f32 v200, v200, v14
v_mul_f32 v201, v201, v14
v_mul_f32 v202, v202, v14
v_mul_f32 v203, v203, v14
v_cvt_pk_bf16_f32 v168, v168, v169
v_cvt_pk_bf16_f32 v169, v170, v171
v_cvt_pk_bf16_f32 v170, v200, v201
v_cvt_pk_bf16_f32 v171, v202, v203
buffer_store_dwordx4 v[168:171], v16, s[44:47], s65 offen sc1
v_mul_f32 v176, v176, v15
v_mul_f32 v177, v177, v15
v_mul_f32 v178, v178, v15
v_mul_f32 v179, v179, v15
v_mul_f32 v208, v208, v15
v_mul_f32 v209, v209, v15
v_mul_f32 v210, v210, v15
v_mul_f32 v211, v211, v15
v_cvt_pk_bf16_f32 v176, v176, v177
v_cvt_pk_bf16_f32 v177, v178, v179
v_cvt_pk_bf16_f32 v178, v208, v209
v_cvt_pk_bf16_f32 v179, v210, v211
s_add_u32 s65, s65, 4096
buffer_store_dwordx4 v[176:179], v16, s[44:47], s65 offen sc1
v_pk_mul_f32 v[60:61], v[60:61], s[68:69]
v_pk_mul_f32 v[62:63], v[62:63], s[68:69]
v_pk_mul_f32 v[124:125], v[124:125], s[68:69]
v_pk_mul_f32 v[126:127], v[126:127], s[68:69]
v_cvt_pk_bf16_f32 v60, v60, v61
v_cvt_pk_bf16_f32 v61, v62, v63
v_cvt_pk_bf16_f32 v62, v124, v125
v_cvt_pk_bf16_f32 v63, v126, v127
v_pk_mul_f32 v[76:77], v[76:77], s[68:69]
v_pk_mul_f32 v[78:79], v[78:79], s[68:69]
v_pk_mul_f32 v[140:141], v[140:141], s[68:69]
v_pk_mul_f32 v[142:143], v[142:143], s[68:69]
v_cvt_pk_bf16_f32 v76, v76, v77
v_cvt_pk_bf16_f32 v77, v78, v79
v_cvt_pk_bf16_f32 v78, v140, v141
v_cvt_pk_bf16_f32 v79, v142, v143
v_pk_mul_f32 v[32:33], v[32:33], s[68:69]
v_pk_mul_f32 v[34:35], v[34:35], s[68:69]
v_pk_mul_f32 v[96:97], v[96:97], s[68:69]
v_pk_mul_f32 v[98:99], v[98:99], s[68:69]
v_cvt_pk_bf16_f32 v32, v32, v33
v_cvt_pk_bf16_f32 v33, v34, v35
v_cvt_pk_bf16_f32 v34, v96, v97
v_cvt_pk_bf16_f32 v35, v98, v99
v_pk_mul_f32 v[48:49], v[48:49], s[68:69]
v_pk_mul_f32 v[50:51], v[50:51], s[68:69]
v_pk_mul_f32 v[112:113], v[112:113], s[68:69]
v_pk_mul_f32 v[114:115], v[114:115], s[68:69]
v_cvt_pk_bf16_f32 v48, v48, v49
v_cvt_pk_bf16_f32 v49, v50, v51
v_cvt_pk_bf16_f32 v50, v112, v113
v_cvt_pk_bf16_f32 v51, v114, v115
v_pk_mul_f32 v[64:65], v[64:65], s[68:69]
v_pk_mul_f32 v[66:67], v[66:67], s[68:69]
v_pk_mul_f32 v[128:129], v[128:129], s[68:69]
v_pk_mul_f32 v[130:131], v[130:131], s[68:69]
v_cvt_pk_bf16_f32 v64, v64, v65
v_cvt_pk_bf16_f32 v65, v66, v67
v_cvt_pk_bf16_f32 v66, v128, v129
v_cvt_pk_bf16_f32 v67, v130, v131
v_pk_mul_f32 v[80:81], v[80:81], s[68:69]
v_pk_mul_f32 v[82:83], v[82:83], s[68:69]
v_pk_mul_f32 v[144:145], v[144:145], s[68:69]
v_pk_mul_f32 v[146:147], v[146:147], s[68:69]
v_cvt_pk_bf16_f32 v80, v80, v81
v_cvt_pk_bf16_f32 v81, v82, v83
v_cvt_pk_bf16_f32 v82, v144, v145
v_cvt_pk_bf16_f32 v83, v146, v147
v_pk_mul_f32 v[36:37], v[36:37], s[68:69]
v_pk_mul_f32 v[38:39], v[38:39], s[68:69]
v_pk_mul_f32 v[100:101], v[100:101], s[68:69]
v_pk_mul_f32 v[102:103], v[102:103], s[68:69]
v_cvt_pk_bf16_f32 v36, v36, v37
v_cvt_pk_bf16_f32 v37, v38, v39
v_cvt_pk_bf16_f32 v38, v100, v101
v_cvt_pk_bf16_f32 v39, v102, v103
v_pk_mul_f32 v[52:53], v[52:53], s[68:69]
v_pk_mul_f32 v[54:55], v[54:55], s[68:69]
v_pk_mul_f32 v[116:117], v[116:117], s[68:69]
v_pk_mul_f32 v[118:119], v[118:119], s[68:69]
v_cvt_pk_bf16_f32 v52, v52, v53
v_cvt_pk_bf16_f32 v53, v54, v55
v_cvt_pk_bf16_f32 v54, v116, v117
v_cvt_pk_bf16_f32 v55, v118, v119
v_pk_mul_f32 v[68:69], v[68:69], s[68:69]
v_pk_mul_f32 v[70:71], v[70:71], s[68:69]
v_pk_mul_f32 v[132:133], v[132:133], s[68:69]
v_pk_mul_f32 v[134:135], v[134:135], s[68:69]
v_cvt_pk_bf16_f32 v68, v68, v69
v_cvt_pk_bf16_f32 v69, v70, v71
v_cvt_pk_bf16_f32 v70, v132, v133
v_cvt_pk_bf16_f32 v71, v134, v135
v_pk_mul_f32 v[84:85], v[84:85], s[68:69]
v_pk_mul_f32 v[86:87], v[86:87], s[68:69]
v_pk_mul_f32 v[148:149], v[148:149], s[68:69]
v_pk_mul_f32 v[150:151], v[150:151], s[68:69]
v_cvt_pk_bf16_f32 v84, v84, v85
v_cvt_pk_bf16_f32 v85, v86, v87
v_cvt_pk_bf16_f32 v86, v148, v149
v_cvt_pk_bf16_f32 v87, v150, v151
s_lshl_b32 s66, s30, 11
v_lshrrev_b32 v14, 4, v0
v_bfe_u32 v12, v0, 1, 3
v_xor_b32 v12, v12, v14
v_lshlrev_b32 v12, 5, v12
v_lshl_add_u32 v12, v14, 11, v12
v_and_b32 v14, 1, v0
v_lshl_add_u32 v12, v14, 4, v12
v_xor_b32 v13, 128, v12
v_add_u32 v14, s66, v16
v_xor_b32 v15, 0x800, v14
s_mov_b32 s73, 0
v_mov_b32 v17, 0xff800000
s_lshl_b32 s66, s31, 15
s_add_u32 s66, s66, s78
s_add_u32 s66, s66, 33554432
s_mul_i32 s74, s3, 1310720
s_add_u32 s74, s74, s66
s_mul_i32 s75, s16, 1310720
s_add_u32 s75, s75, s66
L_attstart_15:
v_mov_b32 v2, v16
v_add_u32 v3, 0x10000, v16
v_mov_b32 v1, 0
s_and_b32 s66, s30, 1
s_lshr_b32 s67, s30, 1
s_lshl_b32 s71, s66, 13
s_lshl_b32 s68, s67, 16
s_add_u32 s71, s71, s68
s_add_u32 s71, s71, 32768
s_lshl_b32 s70, s66, 14
s_mul_i32 s67, s67, 24576
s_sub_u32 s70, s70, s67
s_add_u32 s70, s70, 65536
s_waitcnt lgkmcnt(0)
s_barrier
s_cmp_eq_u32 s3, 0
s_cbranch_scc1 L_F1_7
ds_read_b128 a[144:147], v2 offset:0
ds_read_b128 a[148:151], v2 offset:1024
ds_read_b128 a[152:155], v2 offset:2048
ds_read_b128 a[156:159], v2 offset:3072
ds_read_b128 a[160:163], v2 offset:4096
ds_read_b128 a[164:167], v2 offset:5120
ds_read_b128 a[168:171], v2 offset:6144
ds_read_b128 a[172:175], v2 offset:7168
s_mov_b32 m0, s71
s_nop 0
buffer_load_dwordx4 v16, s[32:35], s70 offen offset:0 sc1 lds
buffer_load_dwordx4 v16, s[32:35], s70 offen offset:1024 sc1 lds
s_waitcnt lgkmcnt(7)
v_mfma_f32_16x16x32_bf16 v[88:91], a[144:147], v[24:27], 0
s_waitcnt lgkmcnt(6)
ds_read_b128 a[176:179], v2 offset:8192
ds_read_b128 a[180:183], v2 offset:9216
v_mfma_f32_16x16x32_bf16 v[88:91], a[148:151], v[28:31], v[88:91]
s_waitcnt lgkmcnt(7)
ds_read_b128 a[184:187], v2 offset:10240
ds_read_b128 a[188:191], v2 offset:11264
v_mfma_f32_16x16x32_bf16 v[88:91], a[152:155], v[32:35], v[88:91]
s_waitcnt lgkmcnt(8)
buffer_load_dwordx4 v16, s[32:35], s70 offen offset:2048 sc1 lds
v_mfma_f32_16x16x32_bf16 v[88:91], a[156:159], v[36:39], v[88:91]
ds_read_b128 a[192:195], v2 offset:12288
ds_read_b128 a[196:199], v2 offset:13312
v_mfma_f32_16x16x32_bf16 v[104:107], a[156:159], v[52:55], 0
v_mfma_f32_16x16x32_bf16 v[104:107], a[152:155], v[48:51], v[104:107]
ds_read_b128 a[200:203], v2 offset:14336
v_mfma_f32_16x16x32_bf16 v[104:107], a[148:151], v[44:47], v[104:107]
v_mfma_f32_16x16x32_bf16 v[104:107], a[144:147], v[40:43], v[104:107]
ds_read_b128 a[204:207], v2 offset:15360
v_mfma_f32_16x16x32_bf16 v[120:123], a[144:147], v[56:59], 0
v_mfma_f32_16x16x32_bf16 v[120:123], a[148:151], v[60:63], v[120:123]
buffer_load_dwordx4 v16, s[32:35], s70 offen offset:3072 sc1 lds
v_mfma_f32_16x16x32_bf16 v[120:123], a[152:155], v[64:67], v[120:123]
v_mfma_f32_16x16x32_bf16 v[120:123], a[156:159], v[68:71], v[120:123]
v_mfma_f32_16x16x32_bf16 v[136:139], a[156:159], v[84:87], 0
v_mfma_f32_16x16x32_bf16 v[136:139], a[152:155], v[80:83], v[136:139]
v_mfma_f32_16x16x32_bf16 v[136:139], a[148:151], v[76:79], v[136:139]
v_mfma_f32_16x16x32_bf16 v[136:139], a[144:147], v[72:75], v[136:139]
s_waitcnt lgkmcnt(0)
s_nop 1
v_max3_f32 v20, v88, v89, v90
v_max_f32 v20, v20, v91
v_max3_f32 v21, v104, v105, v106
v_max_f32 v21, v21, v107
v_max3_f32 v22, v120, v121, v122
v_max_f32 v22, v22, v123
v_max3_f32 v23, v136, v137, v138
v_max_f32 v23, v23, v139
v_mov_b32 v248, v20
v_mov_b32 v249, v21
v_mov_b32 v250, v22
v_mov_b32 v251, v23
v_permlane16_swap_b32 v248, v20
v_permlane16_swap_b32 v249, v21
v_permlane16_swap_b32 v250, v22
v_permlane16_swap_b32 v251, v23
v_max_f32 v20, v20, v248
v_max_f32 v21, v21, v249
v_max_f32 v22, v22, v250
v_max_f32 v23, v23, v251
v_mov_b32 v248, v20
v_mov_b32 v249, v21
v_mov_b32 v250, v22
v_mov_b32 v251, v23
v_permlane32_swap_b32 v248, v20
v_permlane32_swap_b32 v249, v21
v_permlane32_swap_b32 v250, v22
v_permlane32_swap_b32 v251, v23
v_max_f32 v20, v20, v248
v_max_f32 v21, v21, v249
v_max_f32 v22, v22, v250
v_max_f32 v23, v23, v251
s_cmp_eq_u32 s73, 0
s_cselect_b64 vcc, 0, -1
v_cndmask_b32 v20, v20, v252, vcc
v_cndmask_b32 v21, v21, v253, vcc
v_cndmask_b32 v22, v22, v254, vcc
v_cndmask_b32 v23, v23, v255, vcc
v_sub_f32 v228, 0, v23
v_sub_f32 v229, 0, v23
v_sub_f32 v230, 0, v23
v_sub_f32 v231, 0, v23
v_sub_f32 v224, 0, v22
v_sub_f32 v225, 0, v22
v_sub_f32 v226, 0, v22
v_sub_f32 v227, 0, v22
v_sub_f32 v220, 0, v21
v_sub_f32 v221, 0, v21
v_sub_f32 v222, 0, v21
v_sub_f32 v223, 0, v21
v_sub_f32 v216, 0, v20
v_sub_f32 v217, 0, v20
v_sub_f32 v218, 0, v20
v_sub_f32 v219, 0, v20
v_mfma_f32_16x16x32_bf16 v[140:143], a[160:163], v[72:75], v[228:231]
s_add_u32 m0, s71, 4096
v_add_f32 v88, v88, v216
v_add_f32 v89, v89, v216
v_mfma_f32_16x16x32_bf16 v[140:143], a[164:167], v[76:79], v[140:143]
v_add_f32 v90, v90, v216
v_add_f32 v91, v91, v216
v_exp_f32 v88, v88
v_mfma_f32_16x16x32_bf16 v[140:143], a[168:171], v[80:83], v[140:143]
s_add_u32 s64, s70, 4096
v_exp_f32 v89, v89
v_mfma_f32_16x16x32_bf16 v[140:143], a[172:175], v[84:87], v[140:143]
buffer_load_dwordx4 v16, s[32:35], s64 offen offset:0 sc1 lds
v_mfma_f32_16x16x32_bf16 v[124:127], a[172:175], v[68:71], v[224:227]
v_exp_f32 v90, v90
v_mfma_f32_16x16x32_bf16 v[124:127], a[168:171], v[64:67], v[124:127]
v_exp_f32 v91, v91
v_mfma_f32_16x16x32_bf16 v[124:127], a[164:167], v[60:63], v[124:127]
v_add_f32 v104, v104, v220
v_add_f32 v105, v105, v220
v_add_f32 v106, v106, v220
v_add_f32 v107, v107, v220
v_exp_f32 v104, v104
v_mfma_f32_16x16x32_bf16 v[124:127], a[160:163], v[56:59], v[124:127]
v_exp_f32 v105, v105
v_mfma_f32_16x16x32_bf16 v[108:111], a[160:163], v[40:43], v[220:223]
v_exp_f32 v106, v106
v_mfma_f32_16x16x32_bf16 v[108:111], a[164:167], v[44:47], v[108:111]
buffer_load_dwordx4 v16, s[32:35], s64 offen offset:1024 sc1 lds
v_mfma_f32_16x16x32_bf16 v[108:111], a[168:171], v[48:51], v[108:111]
v_cvt_pk_bf16_f32 v152, v88, v89
v_add_f32 v120, v120, v224
v_mfma_f32_16x16x32_bf16 v[108:111], a[172:175], v[52:55], v[108:111]
v_exp_f32 v107, v107
v_mfma_f32_16x16x32_bf16 v[92:95], a[172:175], v[36:39], v[216:219]
v_add_f32 v121, v121, v224
v_add_f32 v122, v122, v224
v_add_f32 v123, v123, v224
v_exp_f32 v120, v120
v_mfma_f32_16x16x32_bf16 v[92:95], a[168:171], v[32:35], v[92:95]
v_cvt_pk_bf16_f32 v153, v90, v91
v_exp_f32 v121, v121
v_mfma_f32_16x16x32_bf16 v[92:95], a[164:167], v[28:31], v[92:95]
v_exp_f32 v122, v122
v_mfma_f32_16x16x32_bf16 v[92:95], a[160:163], v[24:27], v[92:95]
v_exp_f32 v123, v123
v_mfma_f32_16x16x32_bf16 v[96:99], a[176:179], v[24:27], v[216:219]
v_cvt_pk_bf16_f32 v160, v104, v105
v_add_f32 v136, v136, v228
v_mfma_f32_16x16x32_bf16 v[96:99], a[180:183], v[28:31], v[96:99]
buffer_load_dwordx4 v16, s[32:35], s64 offen offset:2048 sc1 lds
v_add_f32 v137, v137, v228
v_add_f32 v138, v138, v228
v_add_f32 v139, v139, v228
v_exp_f32 v136, v136
v_mfma_f32_16x16x32_bf16 v[96:99], a[184:187], v[32:35], v[96:99]
v_exp_f32 v137, v137
v_mfma_f32_16x16x32_bf16 v[96:99], a[188:191], v[36:39], v[96:99]
v_cvt_pk_bf16_f32 v161, v106, v107
v_cvt_pk_bf16_f32 v184, v120, v121
v_mfma_f32_16x16x32_bf16 v[112:115], a[188:191], v[52:55], v[220:223]
v_exp_f32 v138, v138
v_mfma_f32_16x16x32_bf16 v[112:115], a[184:187], v[48:51], v[112:115]
v_exp_f32 v139, v139
v_mfma_f32_16x16x32_bf16 v[112:115], a[180:183], v[44:47], v[112:115]
v_exp_f32 v140, v140
v_mfma_f32_16x16x32_bf16 v[112:115], a[176:179], v[40:43], v[112:115]
v_exp_f32 v141, v141
v_mfma_f32_16x16x32_bf16 v[128:131], a[176:179], v[56:59], v[224:227]
buffer_load_dwordx4 v16, s[32:35], s64 offen offset:3072 sc1 lds
v_cvt_pk_bf16_f32 v185, v122, v123
v_mfma_f32_16x16x32_bf16 v[128:131], a[180:183], v[60:63], v[128:131]
v_exp_f32 v142, v142
v_mfma_f32_16x16x32_bf16 v[128:131], a[184:187], v[64:67], v[128:131]
v_exp_f32 v143, v143
v_mfma_f32_16x16x32_bf16 v[128:131], a[188:191], v[68:71], v[128:131]
v_cvt_pk_bf16_f32 v192, v136, v137
v_cvt_pk_bf16_f32 v193, v138, v139
v_mfma_f32_16x16x32_bf16 v[144:147], a[188:191], v[84:87], v[228:231]
v_exp_f32 v124, v124
v_mfma_f32_16x16x32_bf16 v[144:147], a[184:187], v[80:83], v[144:147]
v_exp_f32 v125, v125
v_mfma_f32_16x16x32_bf16 v[144:147], a[180:183], v[76:79], v[144:147]
s_waitcnt vmcnt(8)
s_barrier
v_mfma_f32_16x16x32_bf16 v[144:147], a[176:179], v[72:75], v[144:147]
v_exp_f32 v126, v126
v_mfma_f32_16x16x32_bf16 v[148:151], a[192:195], v[72:75], v[228:231]
v_cvt_pk_bf16_f32 v194, v140, v141
v_cvt_pk_bf16_f32 v195, v142, v143
v_mfma_f32_16x16x32_bf16 v[148:151], a[196:199], v[76:79], v[148:151]
v_exp_f32 v127, v127
v_mfma_f32_16x16x32_bf16 v[148:151], a[200:203], v[80:83], v[148:151]
s_xor_b32 s71, s71, 16384
v_exp_f32 v108, v108
v_mfma_f32_16x16x32_bf16 v[148:151], a[204:207], v[84:87], v[148:151]
s_add_u32 s70, s70, 32768
v_exp_f32 v109, v109
v_mfma_f32_16x16x32_bf16 v[132:135], a[204:207], v[68:71], v[224:227]
s_mov_b32 m0, s71
v_exp_f32 v110, v110
v_mfma_f32_16x16x32_bf16 v[132:135], a[200:203], v[64:67], v[132:135]
buffer_load_dwordx4 v16, s[32:35], s70 offen offset:0 sc1 lds
v_mfma_f32_16x16x32_bf16 v[132:135], a[196:199], v[60:63], v[132:135]
v_cvt_pk_bf16_f32 v186, v124, v125
v_exp_f32 v111, v111
v_mfma_f32_16x16x32_bf16 v[132:135], a[192:195], v[56:59], v[132:135]
v_exp_f32 v92, v92
v_mfma_f32_16x16x32_bf16 v[116:119], a[192:195], v[40:43], v[220:223]
v_exp_f32 v93, v93
v_mfma_f32_16x16x32_bf16 v[116:119], a[196:199], v[44:47], v[116:119]
ds_read_b128 a[144:147], v2 offset:16384
v_cvt_pk_bf16_f32 v187, v126, v127
v_mfma_f32_16x16x32_bf16 v[116:119], a[200:203], v[48:51], v[116:119]
v_exp_f32 v94, v94
v_mfma_f32_16x16x32_bf16 v[116:119], a[204:207], v[52:55], v[116:119]
ds_read_b128 a[148:151], v2 offset:17408
v_cvt_pk_bf16_f32 v162, v108, v109
v_mfma_f32_16x16x32_bf16 v[100:103], a[204:207], v[36:39], v[216:219]
ds_read_b128 a[152:155], v2 offset:18432
buffer_load_dwordx4 v16, s[32:35], s70 offen offset:1024 sc1 lds
v_exp_f32 v95, v95
v_mfma_f32_16x16x32_bf16 v[100:103], a[200:203], v[32:35], v[100:103]
ds_read_b128 a[156:159], v2 offset:19456
v_exp_f32 v96, v96
v_mfma_f32_16x16x32_bf16 v[100:103], a[196:199], v[28:31], v[100:103]
v_cvt_pk_bf16_f32 v163, v110, v111
v_exp_f32 v97, v97
v_mfma_f32_16x16x32_bf16 v[100:103], a[192:195], v[24:27], v[100:103]
s_waitcnt lgkmcnt(3)
ds_read_b128 a[160:163], v2 offset:20480
ds_read_b128 a[164:167], v2 offset:21504
ds_read_b128 a[168:171], v2 offset:22528
ds_read_b128 a[172:175], v2 offset:23552
v_mfma_f32_16x16x32_bf16 v[88:91], a[144:147], v[24:27], v[216:219]
s_waitcnt lgkmcnt(6)
v_exp_f32 v98, v98
v_mfma_f32_16x16x32_bf16 v[88:91], a[148:151], v[28:31], v[88:91]
s_waitcnt lgkmcnt(5)
v_cvt_pk_bf16_f32 v154, v92, v93
v_exp_f32 v99, v99
v_mfma_f32_16x16x32_bf16 v[88:91], a[152:155], v[32:35], v[88:91]
s_waitcnt lgkmcnt(4)
v_exp_f32 v112, v112
v_mfma_f32_16x16x32_bf16 v[88:91], a[156:159], v[36:39], v[88:91]
v_exp_f32 v113, v113
v_mfma_f32_16x16x32_bf16 v[104:107], a[156:159], v[52:55], v[220:223]
v_cvt_pk_bf16_f32 v155, v94, v95
v_cvt_pk_bf16_f32 v156, v96, v97
v_mfma_f32_16x16x32_bf16 v[104:107], a[152:155], v[48:51], v[104:107]
buffer_load_dwordx4 v16, s[32:35], s70 offen offset:2048 sc1 lds
v_exp_f32 v114, v114
v_mfma_f32_16x16x32_bf16 v[104:107], a[148:151], v[44:47], v[104:107]
v_exp_f32 v115, v115
v_mfma_f32_16x16x32_bf16 v[104:107], a[144:147], v[40:43], v[104:107]
v_exp_f32 v128, v128
v_mfma_f32_16x16x32_bf16 v[120:123], a[144:147], v[56:59], v[224:227]
v_exp_f32 v129, v129
v_mfma_f32_16x16x32_bf16 v[120:123], a[148:151], v[60:63], v[120:123]
v_cvt_pk_bf16_f32 v157, v98, v99
v_cvt_pk_bf16_f32 v164, v112, v113
v_mfma_f32_16x16x32_bf16 v[120:123], a[152:155], v[64:67], v[120:123]
v_exp_f32 v130, v130
v_mfma_f32_16x16x32_bf16 v[120:123], a[156:159], v[68:71], v[120:123]
v_exp_f32 v131, v131
v_mfma_f32_16x16x32_bf16 v[136:139], a[156:159], v[84:87], v[228:231]
v_exp_f32 v144, v144
v_mfma_f32_16x16x32_bf16 v[136:139], a[152:155], v[80:83], v[136:139]
v_exp_f32 v145, v145
v_mfma_f32_16x16x32_bf16 v[136:139], a[148:151], v[76:79], v[136:139]
v_exp_f32 v146, v146
v_mfma_f32_16x16x32_bf16 v[136:139], a[144:147], v[72:75], v[136:139]
s_waitcnt lgkmcnt(0)
v_cvt_pk_bf16_f32 v165, v114, v115
v_cvt_pk_bf16_f32 v188, v128, v129
v_mfma_f32_16x16x32_bf16 v[140:143], a[160:163], v[72:75], v[228:231]
v_exp_f32 v147, v147
v_mfma_f32_16x16x32_bf16 v[140:143], a[164:167], v[76:79], v[140:143]
v_exp_f32 v148, v148
v_mfma_f32_16x16x32_bf16 v[140:143], a[168:171], v[80:83], v[140:143]
v_exp_f32 v149, v149
v_mfma_f32_16x16x32_bf16 v[140:143], a[172:175], v[84:87], v[140:143]
buffer_load_dwordx4 v16, s[32:35], s70 offen offset:3072 sc1 lds
v_mfma_f32_16x16x32_bf16 v[124:127], a[172:175], v[68:71], v[224:227]
v_cvt_pk_bf16_f32 v189, v130, v131
v_cvt_pk_bf16_f32 v196, v144, v145
v_mfma_f32_16x16x32_bf16 v[124:127], a[168:171], v[64:67], v[124:127]
v_exp_f32 v150, v150
v_mfma_f32_16x16x32_bf16 v[124:127], a[164:167], v[60:63], v[124:127]
v_exp_f32 v151, v151
v_mfma_f32_16x16x32_bf16 v[124:127], a[160:163], v[56:59], v[124:127]
v_exp_f32 v132, v132
v_mfma_f32_16x16x32_bf16 v[108:111], a[160:163], v[40:43], v[220:223]
ds_read_b128 a[176:179], v2 offset:24576
v_cvt_pk_bf16_f32 v197, v146, v147
v_mfma_f32_16x16x32_bf16 v[108:111], a[164:167], v[44:47], v[108:111]
ds_read_b128 a[180:183], v2 offset:25600
v_cvt_pk_bf16_f32 v198, v148, v149
v_mfma_f32_16x16x32_bf16 v[108:111], a[168:171], v[48:51], v[108:111]
ds_read_b128 a[184:187], v2 offset:26624
v_exp_f32 v133, v133
v_mfma_f32_16x16x32_bf16 v[108:111], a[172:175], v[52:55], v[108:111]
ds_read_b128 a[188:191], v2 offset:27648
v_exp_f32 v134, v134
v_mfma_f32_16x16x32_bf16 v[92:95], a[172:175], v[36:39], v[216:219]
v_exp_f32 v135, v135
v_mfma_f32_16x16x32_bf16 v[92:95], a[168:171], v[32:35], v[92:95]
v_exp_f32 v116, v116
v_mfma_f32_16x16x32_bf16 v[92:95], a[164:167], v[28:31], v[92:95]
v_exp_f32 v117, v117
v_mfma_f32_16x16x32_bf16 v[92:95], a[160:163], v[24:27], v[92:95]
s_waitcnt lgkmcnt(2)
v_cvt_pk_bf16_f32 v199, v150, v151
v_cvt_pk_bf16_f32 v190, v132, v133
v_mfma_f32_16x16x32_bf16 v[96:99], a[176:179], v[24:27], v[216:219]
v_exp_f32 v118, v118
v_mfma_f32_16x16x32_bf16 v[96:99], a[180:183], v[28:31], v[96:99]
s_waitcnt lgkmcnt(0)
v_exp_f32 v119, v119
v_mfma_f32_16x16x32_bf16 v[96:99], a[184:187], v[32:35], v[96:99]
s_add_u32 m0, s71, 4096
v_exp_f32 v100, v100
v_mfma_f32_16x16x32_bf16 v[96:99], a[188:191], v[36:39], v[96:99]
s_add_u32 s64, s70, 4096
v_exp_f32 v101, v101
v_mfma_f32_16x16x32_bf16 v[112:115], a[188:191], v[52:55], v[220:223]
buffer_load_dwordx4 v16, s[32:35], s64 offen offset:0 sc1 lds
v_mfma_f32_16x16x32_bf16 v[112:115], a[184:187], v[48:51], v[112:115]
v_cvt_pk_bf16_f32 v191, v134, v135
v_cvt_pk_bf16_f32 v166, v116, v117
v_mfma_f32_16x16x32_bf16 v[112:115], a[180:183], v[44:47], v[112:115]
v_exp_f32 v102, v102
v_mfma_f32_16x16x32_bf16 v[112:115], a[176:179], v[40:43], v[112:115]
v_exp_f32 v103, v103
v_mfma_f32_16x16x32_bf16 v[128:131], a[176:179], v[56:59], v[224:227]
s_lshl_b32 s66, s30, 30
ds_read_b128 a[192:195], v2 offset:28672
v_cvt_pk_bf16_f32 v167, v118, v119
v_mfma_f32_16x16x32_bf16 v[128:131], a[180:183], v[60:63], v[128:131]
ds_read_b128 a[196:199], v2 offset:29696
v_exp_f32 v88, v88
v_mfma_f32_16x16x32_bf16 v[128:131], a[184:187], v[64:67], v[128:131]
ds_read_b128 a[200:203], v2 offset:30720
v_exp_f32 v89, v89
v_mfma_f32_16x16x32_bf16 v[128:131], a[188:191], v[68:71], v[128:131]
ds_read_b128 a[204:207], v2 offset:31744
v_cvt_pk_bf16_f32 v158, v100, v101
v_mfma_f32_16x16x32_bf16 v[144:147], a[188:191], v[84:87], v[228:231]
v_exp_f32 v90, v90
v_mfma_f32_16x16x32_bf16 v[144:147], a[184:187], v[80:83], v[144:147]
v_exp_f32 v91, v91
v_mfma_f32_16x16x32_bf16 v[144:147], a[180:183], v[76:79], v[144:147]
v_exp_f32 v104, v104
v_mfma_f32_16x16x32_bf16 v[144:147], a[176:179], v[72:75], v[144:147]
s_waitcnt lgkmcnt(2)
v_exp_f32 v105, v105
v_mfma_f32_16x16x32_bf16 v[148:151], a[192:195], v[72:75], v[228:231]
v_cvt_pk_bf16_f32 v159, v102, v103
v_cvt_pk_bf16_f32 v168, v88, v89
v_mfma_f32_16x16x32_bf16 v[148:151], a[196:199], v[76:79], v[148:151]
s_waitcnt lgkmcnt(0)
v_exp_f32 v106, v106
v_mfma_f32_16x16x32_bf16 v[148:151], a[200:203], v[80:83], v[148:151]
v_exp_f32 v107, v107
v_mfma_f32_16x16x32_bf16 v[148:151], a[204:207], v[84:87], v[148:151]
v_exp_f32 v120, v120
v_mfma_f32_16x16x32_bf16 v[132:135], a[204:207], v[68:71], v[224:227]
buffer_load_dwordx4 v16, s[32:35], s64 offen offset:1024 sc1 lds
v_mfma_f32_16x16x32_bf16 v[132:135], a[200:203], v[64:67], v[132:135]
v_cvt_pk_bf16_f32 v169, v90, v91
v_cvt_pk_bf16_f32 v176, v104, v105
v_mfma_f32_16x16x32_bf16 v[132:135], a[196:199], v[60:63], v[132:135]
v_exp_f32 v121, v121
v_mfma_f32_16x16x32_bf16 v[132:135], a[192:195], v[56:59], v[132:135]
v_exp_f32 v122, v122
v_mfma_f32_16x16x32_bf16 v[116:119], a[192:195], v[40:43], v[220:223]
v_exp_f32 v123, v123
v_mfma_f32_16x16x32_bf16 v[116:119], a[196:199], v[44:47], v[116:119]
v_exp_f32 v136, v136
v_mfma_f32_16x16x32_bf16 v[116:119], a[200:203], v[48:51], v[116:119]
v_exp_f32 v137, v137
v_mfma_f32_16x16x32_bf16 v[116:119], a[204:207], v[52:55], v[116:119]
v_cvt_pk_bf16_f32 v177, v106, v107
v_cvt_pk_bf16_f32 v200, v120, v121
v_mfma_f32_16x16x32_bf16 v[100:103], a[204:207], v[36:39], v[216:219]
v_exp_f32 v138, v138
v_mfma_f32_16x16x32_bf16 v[100:103], a[200:203], v[32:35], v[100:103]
v_exp_f32 v139, v139
v_mfma_f32_16x16x32_bf16 v[100:103], a[196:199], v[28:31], v[100:103]
v_exp_f32 v140, v140
v_mfma_f32_16x16x32_bf16 v[100:103], a[192:195], v[24:27], v[100:103]
ds_read_b128 a[144:147], v3 offset:16384
v_cvt_pk_bf16_f32 v201, v122, v123
v_mfma_f32_16x16x32_bf16 a[128:131], a[244:247], v[152:155], 0
ds_read_b128 a[148:151], v3 offset:24576
v_cvt_pk_bf16_f32 v208, v136, v137
v_mfma_f32_16x16x32_bf16 a[128:131], a[244:247], v[156:159], a[128:131]
v_exp_f32 v141, v141
v_mfma_f32_16x16x32_bf16 a[132:135], a[244:247], v[160:163], 0
v_exp_f32 v142, v142
v_mfma_f32_16x16x32_bf16 a[132:135], a[244:247], v[164:167], a[132:135]
v_exp_f32 v143, v143
v_mfma_f32_16x16x32_bf16 a[136:139], a[244:247], v[184:187], 0
buffer_load_dwordx4 v16, s[32:35], s64 offen offset:2048 sc1 lds
v_mfma_f32_16x16x32_bf16 a[136:139], a[244:247], v[188:191], a[136:139]
v_exp_f32 v124, v124
v_mfma_f32_16x16x32_bf16 a[140:143], a[244:247], v[192:195], 0
v_exp_f32 v125, v125
v_mfma_f32_16x16x32_bf16 a[140:143], a[244:247], v[196:199], a[140:143]
s_waitcnt lgkmcnt(0)
ds_read_b128 a[152:155], v3 offset:17408
v_cvt_pk_bf16_f32 v209, v138, v139
v_mfma_f32_16x16x32_bf16 a[0:3], a[144:147], v[152:155], 0
v_exp_f32 v126, v126
v_mfma_f32_16x16x32_bf16 a[0:3], a[148:151], v[156:159], a[0:3]
ds_read_b128 a[156:159], v3 offset:25600
v_cvt_pk_bf16_f32 v210, v140, v141
v_mfma_f32_16x16x32_bf16 a[32:35], a[148:151], v[164:167], 0
v_exp_f32 v127, v127
v_mfma_f32_16x16x32_bf16 a[32:35], a[144:147], v[160:163], a[32:35]
v_exp_f32 v108, v108
v_mfma_f32_16x16x32_bf16 a[64:67], a[144:147], v[184:187], 0
v_exp_f32 v109, v109
v_mfma_f32_16x16x32_bf16 a[64:67], a[148:151], v[188:191], a[64:67]
v_cvt_pk_bf16_f32 v211, v142, v143
v_cvt_pk_bf16_f32 v202, v124, v125
v_mfma_f32_16x16x32_bf16 a[96:99], a[148:151], v[196:199], 0
v_exp_f32 v110, v110
v_mfma_f32_16x16x32_bf16 a[96:99], a[144:147], v[192:195], a[96:99]
s_waitcnt lgkmcnt(0)
ds_read_b128 a[160:163], v3 offset:18432
v_cvt_pk_bf16_f32 v203, v126, v127
v_mfma_f32_16x16x32_bf16 a[100:103], a[152:155], v[192:195], 0
v_exp_f32 v111, v111
v_mfma_f32_16x16x32_bf16 a[100:103], a[156:159], v[196:199], a[100:103]
ds_read_b128 a[164:167], v3 offset:26624
v_cvt_pk_bf16_f32 v178, v108, v109
v_mfma_f32_16x16x32_bf16 a[68:71], a[156:159], v[188:191], 0
v_exp_f32 v92, v92
v_mfma_f32_16x16x32_bf16 a[68:71], a[152:155], v[184:187], a[68:71]
v_exp_f32 v93, v93
v_mfma_f32_16x16x32_bf16 a[36:39], a[152:155], v[160:163], 0
v_exp_f32 v94, v94
v_mfma_f32_16x16x32_bf16 a[36:39], a[156:159], v[164:167], a[36:39]
buffer_load_dwordx4 v16, s[32:35], s64 offen offset:3072 sc1 lds
v_mfma_f32_16x16x32_bf16 a[4:7], a[156:159], v[156:159], 0
v_exp_f32 v95, v95
v_mfma_f32_16x16x32_bf16 a[4:7], a[152:155], v[152:155], a[4:7]
s_waitcnt lgkmcnt(0)
v_exp_f32 v96, v96
v_mfma_f32_16x16x32_bf16 a[8:11], a[160:163], v[152:155], 0
ds_read_b128 a[168:171], v3 offset:19456
v_cvt_pk_bf16_f32 v179, v110, v111
v_mfma_f32_16x16x32_bf16 a[8:11], a[164:167], v[156:159], a[8:11]
ds_read_b128 a[172:175], v3 offset:27648
v_exp_f32 v97, v97
v_mfma_f32_16x16x32_bf16 a[40:43], a[164:167], v[164:167], 0
v_exp_f32 v98, v98
v_mfma_f32_16x16x32_bf16 a[40:43], a[160:163], v[160:163], a[40:43]
v_exp_f32 v99, v99
v_mfma_f32_16x16x32_bf16 a[72:75], a[160:163], v[184:187], 0
v_cvt_pk_bf16_f32 v170, v92, v93
v_cvt_pk_bf16_f32 v171, v94, v95
v_mfma_f32_16x16x32_bf16 a[72:75], a[164:167], v[188:191], a[72:75]
v_exp_f32 v112, v112
v_mfma_f32_16x16x32_bf16 a[104:107], a[164:167], v[196:199], 0
v_exp_f32 v113, v113
v_mfma_f32_16x16x32_bf16 a[104:107], a[160:163], v[192:195], a[104:107]
s_waitcnt lgkmcnt(0)
ds_read_b128 a[176:179], v3 offset:20480
v_cvt_pk_bf16_f32 v172, v96, v97
v_mfma_f32_16x16x32_bf16 a[108:111], a[168:171], v[192:195], 0
v_exp_f32 v114, v114
v_mfma_f32_16x16x32_bf16 a[108:111], a[172:175], v[196:199], a[108:111]
ds_read_b128 a[180:183], v3 offset:28672
v_xor_b32 v2, 0x8000, v2
v_mfma_f32_16x16x32_bf16 a[76:79], a[172:175], v[188:191], 0
v_exp_f32 v115, v115
v_mfma_f32_16x16x32_bf16 a[76:79], a[168:171], v[184:187], a[76:79]
ds_read_b128 a[184:187], v3 offset:21504
ds_read_b128 a[188:191], v3 offset:29696
ds_read_b128 a[192:195], v3 offset:22528
ds_read_b128 a[196:199], v3 offset:30720
ds_read_b128 a[200:203], v3 offset:23552
ds_read_b128 a[204:207], v3 offset:31744
v_mfma_f32_16x16x32_bf16 a[44:47], a[168:171], v[160:163], 0
s_waitcnt vmcnt(8)
s_barrier
v_cvt_pk_bf16_f32 v173, v98, v99
v_exp_f32 v128, v128
v_mfma_f32_16x16x32_bf16 a[44:47], a[172:175], v[164:167], a[44:47]
v_exp_f32 v129, v129
v_mfma_f32_16x16x32_bf16 a[12:15], a[172:175], v[156:159], 0
v_exp_f32 v130, v130
v_mfma_f32_16x16x32_bf16 a[12:15], a[168:171], v[152:155], a[12:15]
s_waitcnt lgkmcnt(6)
v_cvt_pk_bf16_f32 v180, v112, v113
v_cvt_pk_bf16_f32 v181, v114, v115
v_mfma_f32_16x16x32_bf16 a[16:19], a[176:179], v[152:155], 0
s_xor_b32 s71, s71, 49152
v_exp_f32 v131, v131
v_mfma_f32_16x16x32_bf16 a[16:19], a[180:183], v[156:159], a[16:19]
s_add_u32 s70, s70, 32768
v_exp_f32 v144, v144
v_mfma_f32_16x16x32_bf16 a[48:51], a[180:183], v[164:167], 0
s_mov_b32 m0, s71
v_exp_f32 v145, v145
v_mfma_f32_16x16x32_bf16 a[48:51], a[176:179], v[160:163], a[48:51]
buffer_load_dwordx4 v16, s[32:35], s70 offen offset:0 sc1 lds
v_mfma_f32_16x16x32_bf16 a[80:83], a[176:179], v[184:187], 0
v_exp_f32 v146, v146
v_mfma_f32_16x16x32_bf16 a[80:83], a[180:183], v[188:191], a[80:83]
v_cvt_pk_bf16_f32 v204, v128, v129
v_cvt_pk_bf16_f32 v205, v130, v131
v_mfma_f32_16x16x32_bf16 a[112:115], a[180:183], v[196:199], 0
v_exp_f32 v147, v147
v_mfma_f32_16x16x32_bf16 a[112:115], a[176:179], v[192:195], a[112:115]
s_waitcnt lgkmcnt(0)
v_exp_f32 v148, v148
v_mfma_f32_16x16x32_bf16 a[116:119], a[184:187], v[192:195], 0
v_exp_f32 v149, v149
v_mfma_f32_16x16x32_bf16 a[116:119], a[188:191], v[196:199], a[116:119]
v_exp_f32 v150, v150
v_mfma_f32_16x16x32_bf16 a[84:87], a[188:191], v[188:191], 0
v_exp_f32 v151, v151
v_mfma_f32_16x16x32_bf16 a[84:87], a[184:187], v[184:187], a[84:87]
v_cvt_pk_bf16_f32 v212, v144, v145
v_cvt_pk_bf16_f32 v213, v146, v147
v_mfma_f32_16x16x32_bf16 a[52:55], a[184:187], v[160:163], 0
v_exp_f32 v132, v132
v_mfma_f32_16x16x32_bf16 a[52:55], a[188:191], v[164:167], a[52:55]
v_exp_f32 v133, v133
v_mfma_f32_16x16x32_bf16 a[20:23], a[188:191], v[156:159], 0
v_exp_f32 v134, v134
v_mfma_f32_16x16x32_bf16 a[20:23], a[184:187], v[152:155], a[20:23]
v_exp_f32 v135, v135
v_mfma_f32_16x16x32_bf16 a[24:27], a[192:195], v[152:155], 0
v_exp_f32 v116, v116
v_mfma_f32_16x16x32_bf16 a[24:27], a[196:199], v[156:159], a[24:27]
v_cvt_pk_bf16_f32 v214, v148, v149
v_cvt_pk_bf16_f32 v215, v150, v151
v_mfma_f32_16x16x32_bf16 a[56:59], a[196:199], v[164:167], 0
buffer_load_dwordx4 v16, s[32:35], s70 offen offset:1024 sc1 lds
v_mfma_f32_16x16x32_bf16 a[56:59], a[192:195], v[160:163], a[56:59]
s_add_u32 s17, s78, L_D_8-L_pc+0
v_exp_f32 v117, v117
v_mfma_f32_16x16x32_bf16 a[88:91], a[192:195], v[184:187], 0
buffer_load_dword a252, v16, s[88:91], s17 offen
v_mfma_f32_16x16x32_bf16 a[88:91], a[196:199], v[188:191], a[88:91]
v_exp_f32 v118, v118
v_mfma_f32_16x16x32_bf16 a[120:123], a[196:199], v[196:199], 0
s_add_u32 s17, s78, L_D_8-L_pc+4096
ds_read_b128 a[144:147], v2 offset:0
v_lshl_add_u32 v19, v0, 24, s66
v_mfma_f32_16x16x32_bf16 a[120:123], a[192:195], v[192:195], a[120:123]
s_lshr_b32 s67, s31, 4
v_cvt_pk_bf16_f32 v206, v132, v133
v_cvt_pk_bf16_f32 v207, v134, v135
v_mfma_f32_16x16x32_bf16 a[124:127], a[200:203], v[192:195], 0
s_lshl1_add_u32 s67, s3, s67
v_exp_f32 v119, v119
v_mfma_f32_16x16x32_bf16 a[124:127], a[204:207], v[196:199], a[124:127]
buffer_load_dword a252, v16, s[88:91], s17 offen
v_exp_f32 v100, v100
v_mfma_f32_16x16x32_bf16 a[92:95], a[204:207], v[188:191], 0
s_lshl_b32 s79, s67, 8
v_exp_f32 v101, v101
v_mfma_f32_16x16x32_bf16 a[92:95], a[200:203], v[184:187], a[92:95]
s_add_u32 s79, s79, 8192
s_add_u32 s17, s78, L_D_8-L_pc+8192
ds_read_b128 a[148:151], v2 offset:1024
v_cvt_pk_bf16_f32 v182, v116, v117
v_mfma_f32_16x16x32_bf16 a[60:63], a[200:203], v[160:163], 0
buffer_load_dword a252, v16, s[88:91], s17 offen
ds_read_b128 a[152:155], v2 offset:2048
v_exp_f32 v102, v102
v_mfma_f32_16x16x32_bf16 a[60:63], a[204:207], v[164:167], a[60:63]
s_lshl_b32 s67, s73, 16
ds_read_b128 a[156:159], v2 offset:3072
v_cvt_pk_bf16_f32 v183, v118, v119
v_mfma_f32_16x16x32_bf16 a[28:31], a[204:207], v[156:159], 0
s_add_u32 s67, s67, s79
s_add_u32 s17, s78, L_D_8-L_pc+12288
v_exp_f32 v103, v103
v_mfma_f32_16x16x32_bf16 a[28:31], a[200:203], v[152:155], a[28:31]
s_mov_b64 exec, 1
buffer_atomic_add a251, v19, s[52:55], s67 offen offset:0 sc1
s_mov_b64 exec, -1
buffer_load_dword a252, v16, s[88:91], s17 offen
ds_read_b128 a[160:163], v2 offset:4096
ds_read_b128 a[164:167], v2 offset:5120
ds_read_b128 a[168:171], v2 offset:6144
ds_read_b128 a[172:175], v2 offset:7168
v_cvt_pk_bf16_f32 v174, v100, v101
v_cvt_pk_bf16_f32 v175, v102, v103
v_xor_b32 v3, 0x8000, v3
s_sub_u32 s72, s3, 1
s_cmp_eq_u32 s72, 0
s_cbranch_scc1 L_DD_9
.p2align 3
L_D_8:
s_waitcnt lgkmcnt(7)
v_mfma_f32_16x16x32_bf16 v[88:91], a[144:147], v[24:27], v[216:219]
s_waitcnt lgkmcnt(6)
ds_read_b128 a[176:179], v2 offset:8192
v_mfma_f32_16x16x32_bf16 v[88:91], a[148:151], v[28:31], v[88:91]
s_waitcnt lgkmcnt(6)
ds_read_b128 a[180:183], v2 offset:9216
v_mfma_f32_16x16x32_bf16 v[88:91], a[152:155], v[32:35], v[88:91]
s_waitcnt lgkmcnt(6)
buffer_load_dwordx4 v16, s[32:35], s70 offen offset:2048 sc1 lds
v_mfma_f32_16x16x32_bf16 v[88:91], a[156:159], v[36:39], v[88:91]
ds_read_b128 a[184:187], v2 offset:10240
v_mfma_f32_16x16x32_bf16 v[104:107], a[156:159], v[52:55], v[220:223]
v_mfma_f32_16x16x32_bf16 v[104:107], a[152:155], v[48:51], v[104:107]
v_mfma_f32_16x16x32_bf16 v[104:107], a[148:151], v[44:47], v[104:107]
ds_read_b128 a[188:191], v2 offset:11264
v_mfma_f32_16x16x32_bf16 v[104:107], a[144:147], v[40:43], v[104:107]
v_mfma_f32_16x16x32_bf16 v[120:123], a[144:147], v[56:59], v[224:227]
v_mfma_f32_16x16x32_bf16 v[120:123], a[148:151], v[60:63], v[120:123]
v_mfma_f32_16x16x32_bf16 v[120:123], a[152:155], v[64:67], v[120:123]
v_exp_f32 v88, v88
v_mfma_f32_16x16x32_bf16 v[120:123], a[156:159], v[68:71], v[120:123]
v_exp_f32 v89, v89
v_mfma_f32_16x16x32_bf16 v[136:139], a[156:159], v[84:87], v[228:231]
v_exp_f32 v90, v90
v_mfma_f32_16x16x32_bf16 v[136:139], a[152:155], v[80:83], v[136:139]
v_exp_f32 v91, v91
v_mfma_f32_16x16x32_bf16 v[136:139], a[148:151], v[76:79], v[136:139]
v_exp_f32 v104, v104
v_mfma_f32_16x16x32_bf16 v[136:139], a[144:147], v[72:75], v[136:139]
s_waitcnt lgkmcnt(0)
v_exp_f32 v105, v105
v_mfma_f32_16x16x32_bf16 v[140:143], a[160:163], v[72:75], v[228:231]
v_exp_f32 v106, v106
v_mfma_f32_16x16x32_bf16 v[140:143], a[164:167], v[76:79], v[140:143]
v_exp_f32 v107, v107
v_mfma_f32_16x16x32_bf16 v[140:143], a[168:171], v[80:83], v[140:143]
buffer_load_dwordx4 v16, s[32:35], s70 offen offset:3072 sc1 lds
v_mfma_f32_16x16x32_bf16 v[140:143], a[172:175], v[84:87], v[140:143]
v_cvt_pk_bf16_f32 v152, v88, v89
v_cvt_pk_bf16_f32 v153, v90, v91
v_mfma_f32_16x16x32_bf16 v[124:127], a[172:175], v[68:71], v[224:227]
v_exp_f32 v120, v120
v_mfma_f32_16x16x32_bf16 v[124:127], a[168:171], v[64:67], v[124:127]
v_exp_f32 v121, v121
v_mfma_f32_16x16x32_bf16 v[124:127], a[164:167], v[60:63], v[124:127]
v_exp_f32 v122, v122
v_mfma_f32_16x16x32_bf16 v[124:127], a[160:163], v[56:59], v[124:127]
v_exp_f32 v123, v123
v_mfma_f32_16x16x32_bf16 v[108:111], a[160:163], v[40:43], v[220:223]
v_exp_f32 v136, v136
v_mfma_f32_16x16x32_bf16 v[108:111], a[164:167], v[44:47], v[108:111]
v_exp_f32 v137, v137
v_mfma_f32_16x16x32_bf16 v[108:111], a[168:171], v[48:51], v[108:111]
v_exp_f32 v138, v138
v_mfma_f32_16x16x32_bf16 v[108:111], a[172:175], v[52:55], v[108:111]
v_cvt_pk_bf16_f32 v160, v104, v105
v_cvt_pk_bf16_f32 v161, v106, v107
v_mfma_f32_16x16x32_bf16 v[92:95], a[172:175], v[36:39], v[216:219]
v_exp_f32 v139, v139
v_mfma_f32_16x16x32_bf16 v[92:95], a[168:171], v[32:35], v[92:95]
ds_read_b128 a[192:195], v2 offset:12288
v_cvt_pk_bf16_f32 v184, v120, v121
v_mfma_f32_16x16x32_bf16 v[92:95], a[164:167], v[28:31], v[92:95]
ds_read_b128 a[196:199], v2 offset:13312
v_cvt_pk_bf16_f32 v185, v122, v123
v_mfma_f32_16x16x32_bf16 v[92:95], a[160:163], v[24:27], v[92:95]
v_exp_f32 v140, v140
v_mfma_f32_16x16x32_bf16 v[96:99], a[176:179], v[24:27], v[216:219]
s_add_u32 m0, s71, 4096
ds_read_b128 a[200:203], v2 offset:14336
v_cvt_pk_bf16_f32 v192, v136, v137
v_mfma_f32_16x16x32_bf16 v[96:99], a[180:183], v[28:31], v[96:99]
s_add_u32 s64, s70, 4096
ds_read_b128 a[204:207], v2 offset:15360
v_cvt_pk_bf16_f32 v193, v138, v139
v_mfma_f32_16x16x32_bf16 v[96:99], a[184:187], v[32:35], v[96:99]
buffer_load_dwordx4 v16, s[32:35], s64 offen offset:0 sc1 lds
v_mfma_f32_16x16x32_bf16 v[96:99], a[188:191], v[36:39], v[96:99]
v_exp_f32 v141, v141
v_mfma_f32_16x16x32_bf16 v[112:115], a[188:191], v[52:55], v[220:223]
v_exp_f32 v142, v142
v_mfma_f32_16x16x32_bf16 v[112:115], a[184:187], v[48:51], v[112:115]
v_exp_f32 v143, v143
v_mfma_f32_16x16x32_bf16 v[112:115], a[180:183], v[44:47], v[112:115]
v_exp_f32 v124, v124
v_mfma_f32_16x16x32_bf16 v[112:115], a[176:179], v[40:43], v[112:115]
v_exp_f32 v125, v125
v_mfma_f32_16x16x32_bf16 v[128:131], a[176:179], v[56:59], v[224:227]
v_exp_f32 v126, v126
v_mfma_f32_16x16x32_bf16 v[128:131], a[180:183], v[60:63], v[128:131]
v_exp_f32 v127, v127
v_mfma_f32_16x16x32_bf16 v[128:131], a[184:187], v[64:67], v[128:131]
v_exp_f32 v108, v108
v_mfma_f32_16x16x32_bf16 v[128:131], a[188:191], v[68:71], v[128:131]
v_exp_f32 v109, v109
v_mfma_f32_16x16x32_bf16 v[144:147], a[188:191], v[84:87], v[228:231]
v_exp_f32 v110, v110
v_mfma_f32_16x16x32_bf16 v[144:147], a[184:187], v[80:83], v[144:147]
v_exp_f32 v111, v111
v_mfma_f32_16x16x32_bf16 v[144:147], a[180:183], v[76:79], v[144:147]
ds_read_b128 a[144:147], v3 offset:0
v_cvt_pk_bf16_f32 v194, v140, v141
v_mfma_f32_16x16x32_bf16 v[144:147], a[176:179], v[72:75], v[144:147]
s_waitcnt lgkmcnt(1)
ds_read_b128 a[148:151], v3 offset:8192
v_cvt_pk_bf16_f32 v195, v142, v143
v_mfma_f32_16x16x32_bf16 v[148:151], a[192:195], v[72:75], v[228:231]
v_exp_f32 v92, v92
v_mfma_f32_16x16x32_bf16 v[148:151], a[196:199], v[76:79], v[148:151]
v_exp_f32 v93, v93
v_mfma_f32_16x16x32_bf16 v[148:151], a[200:203], v[80:83], v[148:151]
buffer_load_dwordx4 v16, s[32:35], s64 offen offset:1024 sc1 lds
v_mfma_f32_16x16x32_bf16 v[148:151], a[204:207], v[84:87], v[148:151]
v_exp_f32 v94, v94
v_mfma_f32_16x16x32_bf16 v[132:135], a[204:207], v[68:71], v[224:227]
v_exp_f32 v95, v95
v_mfma_f32_16x16x32_bf16 v[132:135], a[200:203], v[64:67], v[132:135]
ds_read_b128 a[152:155], v3 offset:1024
v_cvt_pk_bf16_f32 v186, v124, v125
v_mfma_f32_16x16x32_bf16 v[132:135], a[196:199], v[60:63], v[132:135]
v_exp_f32 v96, v96
v_mfma_f32_16x16x32_bf16 v[132:135], a[192:195], v[56:59], v[132:135]
ds_read_b128 a[156:159], v3 offset:9216
v_cvt_pk_bf16_f32 v187, v126, v127
v_mfma_f32_16x16x32_bf16 v[116:119], a[192:195], v[40:43], v[220:223]
v_exp_f32 v97, v97
v_mfma_f32_16x16x32_bf16 v[116:119], a[196:199], v[44:47], v[116:119]
v_exp_f32 v98, v98
v_mfma_f32_16x16x32_bf16 v[116:119], a[200:203], v[48:51], v[116:119]
v_exp_f32 v99, v99
v_mfma_f32_16x16x32_bf16 v[116:119], a[204:207], v[52:55], v[116:119]
ds_read_b128 a[160:163], v3 offset:2048
v_cvt_pk_bf16_f32 v162, v108, v109
v_mfma_f32_16x16x32_bf16 v[100:103], a[204:207], v[36:39], v[216:219]
v_exp_f32 v112, v112
v_mfma_f32_16x16x32_bf16 v[100:103], a[200:203], v[32:35], v[100:103]
ds_read_b128 a[164:167], v3 offset:10240
v_cvt_pk_bf16_f32 v163, v110, v111
v_mfma_f32_16x16x32_bf16 v[100:103], a[196:199], v[28:31], v[100:103]
v_exp_f32 v113, v113
v_mfma_f32_16x16x32_bf16 v[100:103], a[192:195], v[24:27], v[100:103]
v_exp_f32 v114, v114
v_mfma_f32_16x16x32_bf16 a[128:131], a[244:247], v[168:171], a[128:131]
v_exp_f32 v115, v115
v_mfma_f32_16x16x32_bf16 a[128:131], a[244:247], v[172:175], a[128:131]
v_exp_f32 v128, v128
v_mfma_f32_16x16x32_bf16 a[132:135], a[244:247], v[176:179], a[132:135]
buffer_load_dwordx4 v16, s[32:35], s64 offen offset:2048 sc1 lds
v_mfma_f32_16x16x32_bf16 a[132:135], a[244:247], v[180:183], a[132:135]
ds_read_b128 a[168:171], v3 offset:3072
v_cvt_pk_bf16_f32 v154, v92, v93
v_mfma_f32_16x16x32_bf16 a[136:139], a[244:247], v[200:203], a[136:139]
ds_read_b128 a[172:175], v3 offset:11264
v_cvt_pk_bf16_f32 v155, v94, v95
v_mfma_f32_16x16x32_bf16 a[136:139], a[244:247], v[204:207], a[136:139]
v_exp_f32 v129, v129
v_mfma_f32_16x16x32_bf16 a[140:143], a[244:247], v[208:211], a[140:143]
v_exp_f32 v130, v130
v_mfma_f32_16x16x32_bf16 a[140:143], a[244:247], v[212:215], a[140:143]
s_waitcnt lgkmcnt(2)
v_exp_f32 v131, v131
v_mfma_f32_16x16x32_bf16 a[0:3], a[144:147], v[168:171], a[0:3]
v_exp_f32 v144, v144
v_mfma_f32_16x16x32_bf16 a[0:3], a[148:151], v[172:175], a[0:3]
ds_read_b128 a[176:179], v3 offset:4096
v_cvt_pk_bf16_f32 v156, v96, v97
v_mfma_f32_16x16x32_bf16 a[32:35], a[148:151], v[180:183], a[32:35]
ds_read_b128 a[180:183], v3 offset:12288
v_cvt_pk_bf16_f32 v157, v98, v99
v_mfma_f32_16x16x32_bf16 a[32:35], a[144:147], v[176:179], a[32:35]
v_exp_f32 v145, v145
v_mfma_f32_16x16x32_bf16 a[64:67], a[144:147], v[200:203], a[64:67]
ds_read_b128 a[184:187], v3 offset:5120
v_cvt_pk_bf16_f32 v164, v112, v113
v_mfma_f32_16x16x32_bf16 a[64:67], a[148:151], v[204:207], a[64:67]
ds_read_b128 a[188:191], v3 offset:13312
v_cvt_pk_bf16_f32 v165, v114, v115
v_mfma_f32_16x16x32_bf16 a[96:99], a[148:151], v[212:215], a[96:99]
ds_read_b128 a[192:195], v3 offset:6144
v_cvt_pk_bf16_f32 v188, v128, v129
v_mfma_f32_16x16x32_bf16 a[96:99], a[144:147], v[208:211], a[96:99]
v_exp_f32 v146, v146
v_mfma_f32_16x16x32_bf16 a[100:103], a[152:155], v[208:211], a[100:103]
v_exp_f32 v147, v147
v_mfma_f32_16x16x32_bf16 a[100:103], a[156:159], v[212:215], a[100:103]
ds_read_b128 a[196:199], v3 offset:14336
v_cvt_pk_bf16_f32 v189, v130, v131
v_mfma_f32_16x16x32_bf16 a[68:71], a[156:159], v[204:207], a[68:71]
buffer_load_dwordx4 v16, s[32:35], s64 offen offset:3072 sc1 lds
v_mfma_f32_16x16x32_bf16 a[68:71], a[152:155], v[200:203], a[68:71]
v_exp_f32 v148, v148
v_mfma_f32_16x16x32_bf16 a[36:39], a[152:155], v[176:179], a[36:39]
v_exp_f32 v149, v149
v_mfma_f32_16x16x32_bf16 a[36:39], a[156:159], v[180:183], a[36:39]
ds_read_b128 a[200:203], v3 offset:7168
v_cvt_pk_bf16_f32 v196, v144, v145
v_mfma_f32_16x16x32_bf16 a[4:7], a[156:159], v[172:175], a[4:7]
v_exp_f32 v150, v150
v_mfma_f32_16x16x32_bf16 a[4:7], a[152:155], v[168:171], a[4:7]
v_exp_f32 v151, v151
v_mfma_f32_16x16x32_bf16 a[8:11], a[160:163], v[168:171], a[8:11]
v_exp_f32 v132, v132
v_mfma_f32_16x16x32_bf16 a[8:11], a[164:167], v[172:175], a[8:11]
ds_read_b128 a[204:207], v3 offset:15360
v_cvt_pk_bf16_f32 v197, v146, v147
v_mfma_f32_16x16x32_bf16 a[40:43], a[164:167], v[180:183], a[40:43]
v_exp_f32 v133, v133
v_mfma_f32_16x16x32_bf16 a[40:43], a[160:163], v[176:179], a[40:43]
v_exp_f32 v134, v134
v_mfma_f32_16x16x32_bf16 a[72:75], a[160:163], v[200:203], a[72:75]
v_exp_f32 v135, v135
v_mfma_f32_16x16x32_bf16 a[72:75], a[164:167], v[204:207], a[72:75]
v_exp_f32 v116, v116
v_mfma_f32_16x16x32_bf16 a[104:107], a[164:167], v[212:215], a[104:107]
v_exp_f32 v117, v117
v_mfma_f32_16x16x32_bf16 a[104:107], a[160:163], v[208:211], a[104:107]
s_waitcnt lgkmcnt(0)
v_exp_f32 v118, v118
v_mfma_f32_16x16x32_bf16 a[108:111], a[168:171], v[208:211], a[108:111]
v_exp_f32 v119, v119
v_mfma_f32_16x16x32_bf16 a[108:111], a[172:175], v[212:215], a[108:111]
v_exp_f32 v100, v100
v_mfma_f32_16x16x32_bf16 a[76:79], a[172:175], v[204:207], a[76:79]
v_exp_f32 v101, v101
v_mfma_f32_16x16x32_bf16 a[76:79], a[168:171], v[200:203], a[76:79]
v_exp_f32 v102, v102
v_mfma_f32_16x16x32_bf16 a[44:47], a[168:171], v[176:179], a[44:47]
s_waitcnt vmcnt(8)
s_barrier
v_mfma_f32_16x16x32_bf16 a[44:47], a[172:175], v[180:183], a[44:47]
s_xor_b32 s71, s71, 16384
ds_read_b128 a[144:147], v2 offset:16384
v_cvt_pk_bf16_f32 v198, v148, v149
v_mfma_f32_16x16x32_bf16 a[12:15], a[172:175], v[172:175], a[12:15]
s_add_u32 s70, s70, 32768
ds_read_b128 a[148:151], v2 offset:17408
v_cvt_pk_bf16_f32 v199, v150, v151
v_mfma_f32_16x16x32_bf16 a[12:15], a[168:171], v[168:171], a[12:15]
s_mov_b32 m0, s71
ds_read_b128 a[152:155], v2 offset:18432
v_cvt_pk_bf16_f32 v190, v132, v133
v_mfma_f32_16x16x32_bf16 a[16:19], a[176:179], v[168:171], a[16:19]
buffer_load_dwordx4 v16, s[32:35], s70 offen offset:0 sc1 lds
v_mfma_f32_16x16x32_bf16 a[16:19], a[180:183], v[172:175], a[16:19]
ds_read_b128 a[156:159], v2 offset:19456
v_cvt_pk_bf16_f32 v191, v134, v135
v_mfma_f32_16x16x32_bf16 a[48:51], a[180:183], v[180:183], a[48:51]
v_exp_f32 v103, v103
v_mfma_f32_16x16x32_bf16 a[48:51], a[176:179], v[176:179], a[48:51]
ds_read_b128 a[160:163], v2 offset:20480
v_cvt_pk_bf16_f32 v166, v116, v117
v_mfma_f32_16x16x32_bf16 a[80:83], a[176:179], v[200:203], a[80:83]
ds_read_b128 a[164:167], v2 offset:21504
v_cvt_pk_bf16_f32 v167, v118, v119
v_mfma_f32_16x16x32_bf16 a[80:83], a[180:183], v[204:207], a[80:83]
ds_read_b128 a[168:171], v2 offset:22528
v_cvt_pk_bf16_f32 v158, v100, v101
v_mfma_f32_16x16x32_bf16 a[112:115], a[180:183], v[212:215], a[112:115]
ds_read_b128 a[172:175], v2 offset:23552
v_cvt_pk_bf16_f32 v159, v102, v103
v_mfma_f32_16x16x32_bf16 a[112:115], a[176:179], v[208:211], a[112:115]
v_mfma_f32_16x16x32_bf16 a[116:119], a[184:187], v[208:211], a[116:119]
v_mfma_f32_16x16x32_bf16 a[116:119], a[188:191], v[212:215], a[116:119]
v_mfma_f32_16x16x32_bf16 a[84:87], a[188:191], v[204:207], a[84:87]
v_mfma_f32_16x16x32_bf16 a[84:87], a[184:187], v[200:203], a[84:87]
v_mfma_f32_16x16x32_bf16 a[52:55], a[184:187], v[176:179], a[52:55]
v_mfma_f32_16x16x32_bf16 a[52:55], a[188:191], v[180:183], a[52:55]
v_mfma_f32_16x16x32_bf16 a[20:23], a[188:191], v[172:175], a[20:23]
v_mfma_f32_16x16x32_bf16 a[20:23], a[184:187], v[168:171], a[20:23]
v_mfma_f32_16x16x32_bf16 a[24:27], a[192:195], v[168:171], a[24:27]
buffer_load_dwordx4 v16, s[32:35], s70 offen offset:1024 sc1 lds
v_mfma_f32_16x16x32_bf16 a[24:27], a[196:199], v[172:175], a[24:27]
v_mfma_f32_16x16x32_bf16 a[56:59], a[196:199], v[180:183], a[56:59]
v_mfma_f32_16x16x32_bf16 a[56:59], a[192:195], v[176:179], a[56:59]
v_mfma_f32_16x16x32_bf16 a[88:91], a[192:195], v[200:203], a[88:91]
v_mfma_f32_16x16x32_bf16 a[88:91], a[196:199], v[204:207], a[88:91]
v_mfma_f32_16x16x32_bf16 a[120:123], a[196:199], v[212:215], a[120:123]
v_mfma_f32_16x16x32_bf16 a[120:123], a[192:195], v[208:211], a[120:123]
v_mfma_f32_16x16x32_bf16 a[124:127], a[200:203], v[208:211], a[124:127]
v_mfma_f32_16x16x32_bf16 a[124:127], a[204:207], v[212:215], a[124:127]
v_mfma_f32_16x16x32_bf16 a[92:95], a[204:207], v[204:207], a[92:95]
v_mfma_f32_16x16x32_bf16 a[92:95], a[200:203], v[200:203], a[92:95]
v_mfma_f32_16x16x32_bf16 a[60:63], a[200:203], v[176:179], a[60:63]
v_mfma_f32_16x16x32_bf16 a[60:63], a[204:207], v[180:183], a[60:63]
v_mfma_f32_16x16x32_bf16 a[28:31], a[204:207], v[172:175], a[28:31]
v_mfma_f32_16x16x32_bf16 a[28:31], a[200:203], v[168:171], a[28:31]
s_waitcnt lgkmcnt(0)
v_mfma_f32_16x16x32_bf16 v[88:91], a[144:147], v[24:27], v[216:219]
ds_read_b128 a[176:179], v2 offset:24576
v_mfma_f32_16x16x32_bf16 v[88:91], a[148:151], v[28:31], v[88:91]
ds_read_b128 a[180:183], v2 offset:25600
v_mfma_f32_16x16x32_bf16 v[88:91], a[152:155], v[32:35], v[88:91]
buffer_load_dwordx4 v16, s[32:35], s70 offen offset:2048 sc1 lds
v_mfma_f32_16x16x32_bf16 v[88:91], a[156:159], v[36:39], v[88:91]
ds_read_b128 a[184:187], v2 offset:26624
v_mfma_f32_16x16x32_bf16 v[104:107], a[156:159], v[52:55], v[220:223]
v_mfma_f32_16x16x32_bf16 v[104:107], a[152:155], v[48:51], v[104:107]
v_mfma_f32_16x16x32_bf16 v[104:107], a[148:151], v[44:47], v[104:107]
ds_read_b128 a[188:191], v2 offset:27648
v_mfma_f32_16x16x32_bf16 v[104:107], a[144:147], v[40:43], v[104:107]
v_mfma_f32_16x16x32_bf16 v[120:123], a[144:147], v[56:59], v[224:227]
v_mfma_f32_16x16x32_bf16 v[120:123], a[148:151], v[60:63], v[120:123]
v_mfma_f32_16x16x32_bf16 v[120:123], a[152:155], v[64:67], v[120:123]
v_exp_f32 v88, v88
v_mfma_f32_16x16x32_bf16 v[120:123], a[156:159], v[68:71], v[120:123]
v_exp_f32 v89, v89
v_mfma_f32_16x16x32_bf16 v[136:139], a[156:159], v[84:87], v[228:231]
v_exp_f32 v90, v90
v_mfma_f32_16x16x32_bf16 v[136:139], a[152:155], v[80:83], v[136:139]
v_exp_f32 v91, v91
v_mfma_f32_16x16x32_bf16 v[136:139], a[148:151], v[76:79], v[136:139]
v_exp_f32 v104, v104
v_mfma_f32_16x16x32_bf16 v[136:139], a[144:147], v[72:75], v[136:139]
v_exp_f32 v105, v105
v_mfma_f32_16x16x32_bf16 v[140:143], a[160:163], v[72:75], v[228:231]
v_exp_f32 v106, v106
v_mfma_f32_16x16x32_bf16 v[140:143], a[164:167], v[76:79], v[140:143]
v_exp_f32 v107, v107
v_mfma_f32_16x16x32_bf16 v[140:143], a[168:171], v[80:83], v[140:143]
buffer_load_dwordx4 v16, s[32:35], s70 offen offset:3072 sc1 lds
v_mfma_f32_16x16x32_bf16 v[140:143], a[172:175], v[84:87], v[140:143]
v_cvt_pk_bf16_f32 v168, v88, v89
v_cvt_pk_bf16_f32 v169, v90, v91
v_mfma_f32_16x16x32_bf16 v[124:127], a[172:175], v[68:71], v[224:227]
v_exp_f32 v120, v120
v_mfma_f32_16x16x32_bf16 v[124:127], a[168:171], v[64:67], v[124:127]
v_exp_f32 v121, v121
v_mfma_f32_16x16x32_bf16 v[124:127], a[164:167], v[60:63], v[124:127]
v_exp_f32 v122, v122
v_mfma_f32_16x16x32_bf16 v[124:127], a[160:163], v[56:59], v[124:127]
v_exp_f32 v123, v123
v_mfma_f32_16x16x32_bf16 v[108:111], a[160:163], v[40:43], v[220:223]
v_exp_f32 v136, v136
v_mfma_f32_16x16x32_bf16 v[108:111], a[164:167], v[44:47], v[108:111]
v_exp_f32 v137, v137
v_mfma_f32_16x16x32_bf16 v[108:111], a[168:171], v[48:51], v[108:111]
v_exp_f32 v138, v138
v_mfma_f32_16x16x32_bf16 v[108:111], a[172:175], v[52:55], v[108:111]
v_cvt_pk_bf16_f32 v176, v104, v105
v_cvt_pk_bf16_f32 v177, v106, v107
v_mfma_f32_16x16x32_bf16 v[92:95], a[172:175], v[36:39], v[216:219]
v_exp_f32 v139, v139
v_mfma_f32_16x16x32_bf16 v[92:95], a[168:171], v[32:35], v[92:95]
ds_read_b128 a[192:195], v2 offset:28672
v_cvt_pk_bf16_f32 v200, v120, v121
v_mfma_f32_16x16x32_bf16 v[92:95], a[164:167], v[28:31], v[92:95]
ds_read_b128 a[196:199], v2 offset:29696
v_cvt_pk_bf16_f32 v201, v122, v123
v_mfma_f32_16x16x32_bf16 v[92:95], a[160:163], v[24:27], v[92:95]
s_waitcnt lgkmcnt(2)
v_exp_f32 v140, v140
v_mfma_f32_16x16x32_bf16 v[96:99], a[176:179], v[24:27], v[216:219]
s_add_u32 m0, s71, 4096
ds_read_b128 a[200:203], v2 offset:30720
v_cvt_pk_bf16_f32 v208, v136, v137
v_mfma_f32_16x16x32_bf16 v[96:99], a[180:183], v[28:31], v[96:99]
s_add_u32 s64, s70, 4096
ds_read_b128 a[204:207], v2 offset:31744
v_cvt_pk_bf16_f32 v209, v138, v139
v_mfma_f32_16x16x32_bf16 v[96:99], a[184:187], v[32:35], v[96:99]
buffer_load_dwordx4 v16, s[32:35], s64 offen offset:0 sc1 lds
v_mfma_f32_16x16x32_bf16 v[96:99], a[188:191], v[36:39], v[96:99]
v_exp_f32 v141, v141
v_mfma_f32_16x16x32_bf16 v[112:115], a[188:191], v[52:55], v[220:223]
v_exp_f32 v142, v142
v_mfma_f32_16x16x32_bf16 v[112:115], a[184:187], v[48:51], v[112:115]
v_exp_f32 v143, v143
v_mfma_f32_16x16x32_bf16 v[112:115], a[180:183], v[44:47], v[112:115]
v_exp_f32 v124, v124
v_mfma_f32_16x16x32_bf16 v[112:115], a[176:179], v[40:43], v[112:115]
v_exp_f32 v125, v125
v_mfma_f32_16x16x32_bf16 v[128:131], a[176:179], v[56:59], v[224:227]
v_exp_f32 v126, v126
v_mfma_f32_16x16x32_bf16 v[128:131], a[180:183], v[60:63], v[128:131]
v_exp_f32 v127, v127
v_mfma_f32_16x16x32_bf16 v[128:131], a[184:187], v[64:67], v[128:131]
v_exp_f32 v108, v108
v_mfma_f32_16x16x32_bf16 v[128:131], a[188:191], v[68:71], v[128:131]
v_exp_f32 v109, v109
v_mfma_f32_16x16x32_bf16 v[144:147], a[188:191], v[84:87], v[228:231]
v_exp_f32 v110, v110
v_mfma_f32_16x16x32_bf16 v[144:147], a[184:187], v[80:83], v[144:147]
v_exp_f32 v111, v111
v_mfma_f32_16x16x32_bf16 v[144:147], a[180:183], v[76:79], v[144:147]
ds_read_b128 a[144:147], v3 offset:16384
v_cvt_pk_bf16_f32 v210, v140, v141
v_mfma_f32_16x16x32_bf16 v[144:147], a[176:179], v[72:75], v[144:147]
s_waitcnt lgkmcnt(1)
ds_read_b128 a[148:151], v3 offset:24576
v_cvt_pk_bf16_f32 v211, v142, v143
v_mfma_f32_16x16x32_bf16 v[148:151], a[192:195], v[72:75], v[228:231]
v_exp_f32 v92, v92
v_mfma_f32_16x16x32_bf16 v[148:151], a[196:199], v[76:79], v[148:151]
v_exp_f32 v93, v93
v_mfma_f32_16x16x32_bf16 v[148:151], a[200:203], v[80:83], v[148:151]
buffer_load_dwordx4 v16, s[32:35], s64 offen offset:1024 sc1 lds
v_mfma_f32_16x16x32_bf16 v[148:151], a[204:207], v[84:87], v[148:151]
v_exp_f32 v94, v94
v_mfma_f32_16x16x32_bf16 v[132:135], a[204:207], v[68:71], v[224:227]
v_exp_f32 v95, v95
v_mfma_f32_16x16x32_bf16 v[132:135], a[200:203], v[64:67], v[132:135]
ds_read_b128 a[152:155], v3 offset:17408
v_cvt_pk_bf16_f32 v202, v124, v125
v_mfma_f32_16x16x32_bf16 v[132:135], a[196:199], v[60:63], v[132:135]
v_exp_f32 v96, v96
v_mfma_f32_16x16x32_bf16 v[132:135], a[192:195], v[56:59], v[132:135]
ds_read_b128 a[156:159], v3 offset:25600
v_cvt_pk_bf16_f32 v203, v126, v127
v_mfma_f32_16x16x32_bf16 v[116:119], a[192:195], v[40:43], v[220:223]
v_exp_f32 v97, v97
v_mfma_f32_16x16x32_bf16 v[116:119], a[196:199], v[44:47], v[116:119]
v_exp_f32 v98, v98
v_mfma_f32_16x16x32_bf16 v[116:119], a[200:203], v[48:51], v[116:119]
v_exp_f32 v99, v99
v_mfma_f32_16x16x32_bf16 v[116:119], a[204:207], v[52:55], v[116:119]
ds_read_b128 a[160:163], v3 offset:18432
v_cvt_pk_bf16_f32 v178, v108, v109
v_mfma_f32_16x16x32_bf16 v[100:103], a[204:207], v[36:39], v[216:219]
v_exp_f32 v112, v112
v_mfma_f32_16x16x32_bf16 v[100:103], a[200:203], v[32:35], v[100:103]
ds_read_b128 a[164:167], v3 offset:26624
v_cvt_pk_bf16_f32 v179, v110, v111
v_mfma_f32_16x16x32_bf16 v[100:103], a[196:199], v[28:31], v[100:103]
v_exp_f32 v113, v113
v_mfma_f32_16x16x32_bf16 v[100:103], a[192:195], v[24:27], v[100:103]
v_exp_f32 v114, v114
v_mfma_f32_16x16x32_bf16 a[128:131], a[244:247], v[152:155], a[128:131]
v_exp_f32 v115, v115
v_mfma_f32_16x16x32_bf16 a[128:131], a[244:247], v[156:159], a[128:131]
v_exp_f32 v128, v128
v_mfma_f32_16x16x32_bf16 a[132:135], a[244:247], v[160:163], a[132:135]
buffer_load_dwordx4 v16, s[32:35], s64 offen offset:2048 sc1 lds
v_mfma_f32_16x16x32_bf16 a[132:135], a[244:247], v[164:167], a[132:135]
ds_read_b128 a[168:171], v3 offset:19456
v_cvt_pk_bf16_f32 v170, v92, v93
v_mfma_f32_16x16x32_bf16 a[136:139], a[244:247], v[184:187], a[136:139]
ds_read_b128 a[172:175], v3 offset:27648
v_cvt_pk_bf16_f32 v171, v94, v95
v_mfma_f32_16x16x32_bf16 a[136:139], a[244:247], v[188:191], a[136:139]
v_exp_f32 v129, v129
v_mfma_f32_16x16x32_bf16 a[140:143], a[244:247], v[192:195], a[140:143]
v_exp_f32 v130, v130
v_mfma_f32_16x16x32_bf16 a[140:143], a[244:247], v[196:199], a[140:143]
s_waitcnt lgkmcnt(2)
v_exp_f32 v131, v131
v_mfma_f32_16x16x32_bf16 a[0:3], a[144:147], v[152:155], a[0:3]
v_exp_f32 v144, v144
v_mfma_f32_16x16x32_bf16 a[0:3], a[148:151], v[156:159], a[0:3]
ds_read_b128 a[176:179], v3 offset:20480
v_cvt_pk_bf16_f32 v172, v96, v97
v_mfma_f32_16x16x32_bf16 a[32:35], a[148:151], v[164:167], a[32:35]
ds_read_b128 a[180:183], v3 offset:28672
v_cvt_pk_bf16_f32 v173, v98, v99
v_mfma_f32_16x16x32_bf16 a[32:35], a[144:147], v[160:163], a[32:35]
v_exp_f32 v145, v145
v_mfma_f32_16x16x32_bf16 a[64:67], a[144:147], v[184:187], a[64:67]
ds_read_b128 a[184:187], v3 offset:21504
v_xor_b32 v2, 0x8000, v2
v_mfma_f32_16x16x32_bf16 a[64:67], a[148:151], v[188:191], a[64:67]
ds_read_b128 a[188:191], v3 offset:29696
v_cvt_pk_bf16_f32 v180, v112, v113
v_mfma_f32_16x16x32_bf16 a[96:99], a[148:151], v[196:199], a[96:99]
ds_read_b128 a[192:195], v3 offset:22528
v_cvt_pk_bf16_f32 v181, v114, v115
v_mfma_f32_16x16x32_bf16 a[96:99], a[144:147], v[192:195], a[96:99]
v_exp_f32 v146, v146
v_mfma_f32_16x16x32_bf16 a[100:103], a[152:155], v[192:195], a[100:103]
v_exp_f32 v147, v147
v_mfma_f32_16x16x32_bf16 a[100:103], a[156:159], v[196:199], a[100:103]
ds_read_b128 a[196:199], v3 offset:30720
v_cvt_pk_bf16_f32 v204, v128, v129
v_mfma_f32_16x16x32_bf16 a[68:71], a[156:159], v[188:191], a[68:71]
buffer_load_dwordx4 v16, s[32:35], s64 offen offset:3072 sc1 lds
v_mfma_f32_16x16x32_bf16 a[68:71], a[152:155], v[184:187], a[68:71]
v_exp_f32 v148, v148
v_mfma_f32_16x16x32_bf16 a[36:39], a[152:155], v[160:163], a[36:39]
v_exp_f32 v149, v149
v_mfma_f32_16x16x32_bf16 a[36:39], a[156:159], v[164:167], a[36:39]
ds_read_b128 a[200:203], v3 offset:23552
v_cvt_pk_bf16_f32 v205, v130, v131
v_mfma_f32_16x16x32_bf16 a[4:7], a[156:159], v[156:159], a[4:7]
v_exp_f32 v150, v150
v_mfma_f32_16x16x32_bf16 a[4:7], a[152:155], v[152:155], a[4:7]
v_exp_f32 v151, v151
v_mfma_f32_16x16x32_bf16 a[8:11], a[160:163], v[152:155], a[8:11]
v_exp_f32 v132, v132
v_mfma_f32_16x16x32_bf16 a[8:11], a[164:167], v[156:159], a[8:11]
ds_read_b128 a[204:207], v3 offset:31744
v_cvt_pk_bf16_f32 v212, v144, v145
v_mfma_f32_16x16x32_bf16 a[40:43], a[164:167], v[164:167], a[40:43]
v_exp_f32 v133, v133
v_mfma_f32_16x16x32_bf16 a[40:43], a[160:163], v[160:163], a[40:43]
v_exp_f32 v134, v134
v_mfma_f32_16x16x32_bf16 a[72:75], a[160:163], v[184:187], a[72:75]
v_exp_f32 v135, v135
v_mfma_f32_16x16x32_bf16 a[72:75], a[164:167], v[188:191], a[72:75]
v_exp_f32 v116, v116
v_mfma_f32_16x16x32_bf16 a[104:107], a[164:167], v[196:199], a[104:107]
v_exp_f32 v117, v117
v_mfma_f32_16x16x32_bf16 a[104:107], a[160:163], v[192:195], a[104:107]
s_waitcnt lgkmcnt(0)
v_exp_f32 v118, v118
v_mfma_f32_16x16x32_bf16 a[108:111], a[168:171], v[192:195], a[108:111]
v_exp_f32 v119, v119
v_mfma_f32_16x16x32_bf16 a[108:111], a[172:175], v[196:199], a[108:111]
v_exp_f32 v100, v100
v_mfma_f32_16x16x32_bf16 a[76:79], a[172:175], v[188:191], a[76:79]
v_exp_f32 v101, v101
v_mfma_f32_16x16x32_bf16 a[76:79], a[168:171], v[184:187], a[76:79]
v_exp_f32 v102, v102
v_mfma_f32_16x16x32_bf16 a[44:47], a[168:171], v[160:163], a[44:47]
s_waitcnt vmcnt(8)
s_barrier
v_mfma_f32_16x16x32_bf16 a[44:47], a[172:175], v[164:167], a[44:47]
s_xor_b32 s71, s71, 49152
ds_read_b128 a[144:147], v2 offset:0
v_cvt_pk_bf16_f32 v213, v146, v147
v_mfma_f32_16x16x32_bf16 a[12:15], a[172:175], v[156:159], a[12:15]
s_add_u32 s70, s70, 32768
ds_read_b128 a[148:151], v2 offset:1024
v_cvt_pk_bf16_f32 v214, v148, v149
v_mfma_f32_16x16x32_bf16 a[12:15], a[168:171], v[152:155], a[12:15]
s_mov_b32 m0, s71
ds_read_b128 a[152:155], v2 offset:2048
v_cvt_pk_bf16_f32 v215, v150, v151
v_mfma_f32_16x16x32_bf16 a[16:19], a[176:179], v[152:155], a[16:19]
buffer_load_dwordx4 v16, s[32:35], s70 offen offset:0 sc1 lds
v_mfma_f32_16x16x32_bf16 a[16:19], a[180:183], v[156:159], a[16:19]
ds_read_b128 a[156:159], v2 offset:3072
v_cvt_pk_bf16_f32 v206, v132, v133
v_mfma_f32_16x16x32_bf16 a[48:51], a[180:183], v[164:167], a[48:51]
v_exp_f32 v103, v103
v_mfma_f32_16x16x32_bf16 a[48:51], a[176:179], v[160:163], a[48:51]
ds_read_b128 a[160:163], v2 offset:4096
v_cvt_pk_bf16_f32 v207, v134, v135
v_mfma_f32_16x16x32_bf16 a[80:83], a[176:179], v[184:187], a[80:83]
ds_read_b128 a[164:167], v2 offset:5120
v_cvt_pk_bf16_f32 v182, v116, v117
v_mfma_f32_16x16x32_bf16 a[80:83], a[180:183], v[188:191], a[80:83]
ds_read_b128 a[168:171], v2 offset:6144
v_xor_b32 v3, 0x8000, v3
v_mfma_f32_16x16x32_bf16 a[112:115], a[180:183], v[196:199], a[112:115]
ds_read_b128 a[172:175], v2 offset:7168
v_cvt_pk_bf16_f32 v183, v118, v119
v_mfma_f32_16x16x32_bf16 a[112:115], a[176:179], v[192:195], a[112:115]
v_cvt_pk_bf16_f32 v174, v100, v101
v_cvt_pk_bf16_f32 v175, v102, v103
v_mfma_f32_16x16x32_bf16 a[116:119], a[184:187], v[192:195], a[116:119]
v_mfma_f32_16x16x32_bf16 a[116:119], a[188:191], v[196:199], a[116:119]
v_mfma_f32_16x16x32_bf16 a[84:87], a[188:191], v[188:191], a[84:87]
v_mfma_f32_16x16x32_bf16 a[84:87], a[184:187], v[184:187], a[84:87]
v_mfma_f32_16x16x32_bf16 a[52:55], a[184:187], v[160:163], a[52:55]
v_mfma_f32_16x16x32_bf16 a[52:55], a[188:191], v[164:167], a[52:55]
v_mfma_f32_16x16x32_bf16 a[20:23], a[188:191], v[156:159], a[20:23]
v_mfma_f32_16x16x32_bf16 a[20:23], a[184:187], v[152:155], a[20:23]
v_mfma_f32_16x16x32_bf16 a[24:27], a[192:195], v[152:155], a[24:27]
buffer_load_dwordx4 v16, s[32:35], s70 offen offset:1024 sc1 lds
v_mfma_f32_16x16x32_bf16 a[24:27], a[196:199], v[156:159], a[24:27]
v_mfma_f32_16x16x32_bf16 a[56:59], a[196:199], v[164:167], a[56:59]
v_mfma_f32_16x16x32_bf16 a[56:59], a[192:195], v[160:163], a[56:59]
v_mfma_f32_16x16x32_bf16 a[88:91], a[192:195], v[184:187], a[88:91]
v_mfma_f32_16x16x32_bf16 a[88:91], a[196:199], v[188:191], a[88:91]
s_sub_u32 s72, s72, 1
v_mfma_f32_16x16x32_bf16 a[120:123], a[196:199], v[196:199], a[120:123]
v_mfma_f32_16x16x32_bf16 a[120:123], a[192:195], v[192:195], a[120:123]
v_mfma_f32_16x16x32_bf16 a[124:127], a[200:203], v[192:195], a[124:127]
v_mfma_f32_16x16x32_bf16 a[124:127], a[204:207], v[196:199], a[124:127]
s_cmp_lg_u32 s72, 0
v_mfma_f32_16x16x32_bf16 a[92:95], a[204:207], v[188:191], a[92:95]
v_mfma_f32_16x16x32_bf16 a[92:95], a[200:203], v[184:187], a[92:95]
v_mfma_f32_16x16x32_bf16 a[60:63], a[200:203], v[160:163], a[60:63]
v_mfma_f32_16x16x32_bf16 a[60:63], a[204:207], v[164:167], a[60:63]
v_mfma_f32_16x16x32_bf16 a[28:31], a[204:207], v[156:159], a[28:31]
v_mfma_f32_16x16x32_bf16 a[28:31], a[200:203], v[152:155], a[28:31]
s_cbranch_scc1 L_D_8
L_DD_9:
s_waitcnt lgkmcnt(7)
v_mfma_f32_16x16x32_bf16 v[104:107], a[144:147], v[40:43], v[220:223]
s_waitcnt lgkmcnt(6)
ds_read_b128 a[176:179], v2 offset:8192
v_cndmask_b32 v88, v216, v17, s[0:1]
v_mfma_f32_16x16x32_bf16 v[104:107], a[148:151], v[44:47], v[104:107]
s_waitcnt lgkmcnt(6)
ds_read_b128 a[180:183], v2 offset:9216
v_cndmask_b32 v89, v216, v17, s[4:5]
v_mfma_f32_16x16x32_bf16 v[104:107], a[152:155], v[48:51], v[104:107]
s_waitcnt lgkmcnt(6)
buffer_load_dwordx4 v16, s[32:35], s70 offen offset:2048 sc1 lds
v_mfma_f32_16x16x32_bf16 v[104:107], a[156:159], v[52:55], v[104:107]
ds_read_b128 a[184:187], v2 offset:10240
v_cndmask_b32 v90, v216, v17, s[6:7]
v_mfma_f32_16x16x32_bf16 v[120:123], a[156:159], v[68:71], v[224:227]
ds_read_b128 a[188:191], v2 offset:11264
v_cndmask_b32 v91, v216, v17, s[8:9]
v_mfma_f32_16x16x32_bf16 v[120:123], a[152:155], v[64:67], v[120:123]
ds_read_b128 a[192:195], v2 offset:12288
v_cndmask_b32 v92, v216, v17, s[10:11]
v_mfma_f32_16x16x32_bf16 v[120:123], a[148:151], v[60:63], v[120:123]
ds_read_b128 a[196:199], v2 offset:13312
v_cndmask_b32 v93, v216, v17, s[12:13]
v_mfma_f32_16x16x32_bf16 v[120:123], a[144:147], v[56:59], v[120:123]
ds_read_b128 a[200:203], v2 offset:14336
v_cndmask_b32 v94, v216, v17, s[18:19]
v_mfma_f32_16x16x32_bf16 v[136:139], a[144:147], v[72:75], v[228:231]
ds_read_b128 a[204:207], v2 offset:15360
v_cndmask_b32 v95, v216, v17, s[22:23]
v_mfma_f32_16x16x32_bf16 v[136:139], a[148:151], v[76:79], v[136:139]
v_cndmask_b32 v96, v216, v17, s[26:27]
v_cndmask_b32 v97, v216, v17, s[56:57]
v_mfma_f32_16x16x32_bf16 v[136:139], a[152:155], v[80:83], v[136:139]
v_exp_f32 v104, v104
v_mfma_f32_16x16x32_bf16 v[136:139], a[156:159], v[84:87], v[136:139]
v_exp_f32 v105, v105
v_mfma_f32_16x16x32_bf16 v[88:91], a[156:159], v[36:39], v[88:91]
v_exp_f32 v106, v106
v_mfma_f32_16x16x32_bf16 v[88:91], a[152:155], v[32:35], v[88:91]
v_exp_f32 v107, v107
v_mfma_f32_16x16x32_bf16 v[88:91], a[148:151], v[28:31], v[88:91]
v_exp_f32 v120, v120
v_mfma_f32_16x16x32_bf16 v[88:91], a[144:147], v[24:27], v[88:91]
s_waitcnt lgkmcnt(0)
v_exp_f32 v121, v121
v_mfma_f32_16x16x32_bf16 v[140:143], a[160:163], v[72:75], v[228:231]
v_exp_f32 v122, v122
v_mfma_f32_16x16x32_bf16 v[140:143], a[164:167], v[76:79], v[140:143]
v_exp_f32 v123, v123
v_mfma_f32_16x16x32_bf16 v[140:143], a[168:171], v[80:83], v[140:143]
buffer_load_dwordx4 v16, s[32:35], s70 offen offset:3072 sc1 lds
v_mfma_f32_16x16x32_bf16 v[140:143], a[172:175], v[84:87], v[140:143]
s_add_u32 m0, s86, 131072
v_cvt_pk_bf16_f32 v160, v104, v105
v_cvt_pk_bf16_f32 v161, v106, v107
v_mfma_f32_16x16x32_bf16 v[124:127], a[172:175], v[68:71], v[224:227]
s_add_u32 s64, s85, 0
v_exp_f32 v136, v136
v_mfma_f32_16x16x32_bf16 v[124:127], a[168:171], v[64:67], v[124:127]
buffer_load_dwordx4 v12, s[36:39], s64 offen lds
v_mfma_f32_16x16x32_bf16 v[124:127], a[164:167], v[60:63], v[124:127]
s_add_u32 m0, s86, 132096
v_exp_f32 v137, v137
v_mfma_f32_16x16x32_bf16 v[124:127], a[160:163], v[56:59], v[124:127]
s_add_u32 s64, s85, 8192
ds_read_b128 a[144:147], v3 offset:0
v_cndmask_b32 v98, v216, v17, s[58:59]
v_mfma_f32_16x16x32_bf16 v[108:111], a[160:163], v[40:43], v[220:223]
buffer_load_dwordx4 v13, s[36:39], s64 offen lds
v_mfma_f32_16x16x32_bf16 v[108:111], a[164:167], v[44:47], v[108:111]
ds_read_b128 a[148:151], v3 offset:8192
v_cndmask_b32 v99, v216, v17, s[60:61]
v_mfma_f32_16x16x32_bf16 v[108:111], a[168:171], v[48:51], v[108:111]
s_add_u32 m0, s86, 133120
v_exp_f32 v138, v138
v_mfma_f32_16x16x32_bf16 v[108:111], a[172:175], v[52:55], v[108:111]
s_add_u32 s64, s85, 16384
v_cvt_pk_bf16_f32 v184, v120, v121
v_cvt_pk_bf16_f32 v185, v122, v123
v_mfma_f32_16x16x32_bf16 v[92:95], a[172:175], v[36:39], v[92:95]
buffer_load_dwordx4 v12, s[36:39], s64 offen lds
v_mfma_f32_16x16x32_bf16 v[92:95], a[168:171], v[32:35], v[92:95]
s_add_u32 m0, s86, 134144
v_exp_f32 v139, v139
v_mfma_f32_16x16x32_bf16 v[92:95], a[164:167], v[28:31], v[92:95]
s_add_u32 s64, s85, 24576
v_exp_f32 v88, v88
v_mfma_f32_16x16x32_bf16 v[92:95], a[160:163], v[24:27], v[92:95]
buffer_load_dwordx4 v13, s[36:39], s64 offen lds
v_mfma_f32_16x16x32_bf16 v[96:99], a[176:179], v[24:27], v[96:99]
s_add_u32 m0, s71, 4096
v_exp_f32 v89, v89
v_mfma_f32_16x16x32_bf16 v[96:99], a[180:183], v[28:31], v[96:99]
s_add_u32 s64, s70, 4096
v_exp_f32 v90, v90
v_mfma_f32_16x16x32_bf16 v[96:99], a[184:187], v[32:35], v[96:99]
buffer_load_dwordx4 v16, s[32:35], s64 offen offset:0 sc1 lds
v_mfma_f32_16x16x32_bf16 v[96:99], a[188:191], v[36:39], v[96:99]
v_cvt_pk_bf16_f32 v192, v136, v137
v_cvt_pk_bf16_f32 v193, v138, v139
v_mfma_f32_16x16x32_bf16 v[112:115], a[188:191], v[52:55], v[220:223]
v_exp_f32 v91, v91
v_mfma_f32_16x16x32_bf16 v[112:115], a[184:187], v[48:51], v[112:115]
v_exp_f32 v140, v140
v_mfma_f32_16x16x32_bf16 v[112:115], a[180:183], v[44:47], v[112:115]
v_exp_f32 v141, v141
v_mfma_f32_16x16x32_bf16 v[112:115], a[176:179], v[40:43], v[112:115]
v_exp_f32 v142, v142
v_mfma_f32_16x16x32_bf16 v[128:131], a[176:179], v[56:59], v[224:227]
v_exp_f32 v143, v143
v_mfma_f32_16x16x32_bf16 v[128:131], a[180:183], v[60:63], v[128:131]
v_exp_f32 v124, v124
v_mfma_f32_16x16x32_bf16 v[128:131], a[184:187], v[64:67], v[128:131]
v_exp_f32 v125, v125
v_mfma_f32_16x16x32_bf16 v[128:131], a[188:191], v[68:71], v[128:131]
v_cvt_pk_bf16_f32 v152, v88, v89
v_cvt_pk_bf16_f32 v153, v90, v91
v_mfma_f32_16x16x32_bf16 v[144:147], a[188:191], v[84:87], v[228:231]
v_exp_f32 v126, v126
v_mfma_f32_16x16x32_bf16 v[144:147], a[184:187], v[80:83], v[144:147]
v_exp_f32 v127, v127
v_mfma_f32_16x16x32_bf16 v[144:147], a[180:183], v[76:79], v[144:147]
ds_read_b128 a[152:155], v3 offset:1024
v_cndmask_b32 v100, v216, v17, s[62:63]
v_mfma_f32_16x16x32_bf16 v[144:147], a[176:179], v[72:75], v[144:147]
ds_read_b128 a[156:159], v3 offset:9216
v_cndmask_b32 v101, v216, v17, s[48:49]
v_mfma_f32_16x16x32_bf16 v[148:151], a[192:195], v[72:75], v[228:231]
ds_read_b128 a[160:163], v3 offset:2048
v_cndmask_b32 v102, v216, v17, s[50:51]
v_mfma_f32_16x16x32_bf16 v[148:151], a[196:199], v[76:79], v[148:151]
ds_read_b128 a[164:167], v3 offset:10240
v_cndmask_b32 v103, v216, v17, s[100:101]
v_mfma_f32_16x16x32_bf16 v[148:151], a[200:203], v[80:83], v[148:151]
buffer_load_dwordx4 v16, s[32:35], s64 offen offset:1024 sc1 lds
v_mfma_f32_16x16x32_bf16 v[148:151], a[204:207], v[84:87], v[148:151]
v_cvt_pk_bf16_f32 v194, v140, v141
v_cvt_pk_bf16_f32 v195, v142, v143
v_mfma_f32_16x16x32_bf16 v[132:135], a[204:207], v[68:71], v[224:227]
v_exp_f32 v108, v108
v_mfma_f32_16x16x32_bf16 v[132:135], a[200:203], v[64:67], v[132:135]
v_exp_f32 v109, v109
v_mfma_f32_16x16x32_bf16 v[132:135], a[196:199], v[60:63], v[132:135]
v_exp_f32 v110, v110
v_mfma_f32_16x16x32_bf16 v[132:135], a[192:195], v[56:59], v[132:135]
v_exp_f32 v111, v111
v_mfma_f32_16x16x32_bf16 v[116:119], a[192:195], v[40:43], v[220:223]
v_exp_f32 v92, v92
v_mfma_f32_16x16x32_bf16 v[116:119], a[196:199], v[44:47], v[116:119]
v_exp_f32 v93, v93
v_mfma_f32_16x16x32_bf16 v[116:119], a[200:203], v[48:51], v[116:119]
v_exp_f32 v94, v94
v_mfma_f32_16x16x32_bf16 v[116:119], a[204:207], v[52:55], v[116:119]
v_cvt_pk_bf16_f32 v186, v124, v125
v_cvt_pk_bf16_f32 v187, v126, v127
v_mfma_f32_16x16x32_bf16 v[100:103], a[204:207], v[36:39], v[100:103]
v_exp_f32 v95, v95
v_mfma_f32_16x16x32_bf16 v[100:103], a[200:203], v[32:35], v[100:103]
v_exp_f32 v96, v96
v_mfma_f32_16x16x32_bf16 v[100:103], a[196:199], v[28:31], v[100:103]
v_exp_f32 v97, v97
v_mfma_f32_16x16x32_bf16 v[100:103], a[192:195], v[24:27], v[100:103]
v_exp_f32 v98, v98
v_mfma_f32_16x16x32_bf16 a[128:131], a[244:247], v[168:171], a[128:131]
v_exp_f32 v99, v99
v_mfma_f32_16x16x32_bf16 a[128:131], a[244:247], v[172:175], a[128:131]
v_exp_f32 v112, v112
v_mfma_f32_16x16x32_bf16 a[132:135], a[244:247], v[176:179], a[132:135]
buffer_load_dwordx4 v16, s[32:35], s64 offen offset:2048 sc1 lds
v_mfma_f32_16x16x32_bf16 a[132:135], a[244:247], v[180:183], a[132:135]
v_cvt_pk_bf16_f32 v162, v108, v109
v_cvt_pk_bf16_f32 v163, v110, v111
v_mfma_f32_16x16x32_bf16 a[136:139], a[244:247], v[200:203], a[136:139]
v_exp_f32 v113, v113
v_mfma_f32_16x16x32_bf16 a[136:139], a[244:247], v[204:207], a[136:139]
v_exp_f32 v114, v114
v_mfma_f32_16x16x32_bf16 a[140:143], a[244:247], v[208:211], a[140:143]
v_exp_f32 v115, v115
v_mfma_f32_16x16x32_bf16 a[140:143], a[244:247], v[212:215], a[140:143]
s_waitcnt lgkmcnt(0)
v_exp_f32 v128, v128
v_mfma_f32_16x16x32_bf16 a[0:3], a[144:147], v[168:171], a[0:3]
ds_read_b128 a[168:171], v3 offset:3072
v_cvt_pk_bf16_f32 v154, v92, v93
v_mfma_f32_16x16x32_bf16 a[0:3], a[148:151], v[172:175], a[0:3]
ds_read_b128 a[172:175], v3 offset:11264
v_cvt_pk_bf16_f32 v155, v94, v95
v_mfma_f32_16x16x32_bf16 a[32:35], a[148:151], v[180:183], a[32:35]
v_exp_f32 v129, v129
v_mfma_f32_16x16x32_bf16 a[32:35], a[144:147], v[176:179], a[32:35]
v_exp_f32 v130, v130
v_mfma_f32_16x16x32_bf16 a[64:67], a[144:147], v[200:203], a[64:67]
v_exp_f32 v131, v131
v_mfma_f32_16x16x32_bf16 a[64:67], a[148:151], v[204:207], a[64:67]
v_exp_f32 v144, v144
v_mfma_f32_16x16x32_bf16 a[96:99], a[148:151], v[212:215], a[96:99]
ds_read_b128 a[176:179], v3 offset:4096
v_cvt_pk_bf16_f32 v156, v96, v97
v_mfma_f32_16x16x32_bf16 a[96:99], a[144:147], v[208:211], a[96:99]
ds_read_b128 a[180:183], v3 offset:12288
v_cvt_pk_bf16_f32 v157, v98, v99
v_mfma_f32_16x16x32_bf16 a[100:103], a[152:155], v[208:211], a[100:103]
v_exp_f32 v145, v145
v_mfma_f32_16x16x32_bf16 a[100:103], a[156:159], v[212:215], a[100:103]
ds_read_b128 a[184:187], v3 offset:5120
v_cvt_pk_bf16_f32 v164, v112, v113
v_mfma_f32_16x16x32_bf16 a[68:71], a[156:159], v[204:207], a[68:71]
buffer_load_dwordx4 v16, s[32:35], s64 offen offset:3072 sc1 lds
v_mfma_f32_16x16x32_bf16 a[68:71], a[152:155], v[200:203], a[68:71]
s_add_u32 m0, s86, 135168
ds_read_b128 a[188:191], v3 offset:13312
v_cvt_pk_bf16_f32 v165, v114, v115
v_mfma_f32_16x16x32_bf16 a[36:39], a[152:155], v[176:179], a[36:39]
s_add_u32 s64, s85, 32768
ds_read_b128 a[192:195], v3 offset:6144
v_cvt_pk_bf16_f32 v188, v128, v129
v_mfma_f32_16x16x32_bf16 a[36:39], a[156:159], v[180:183], a[36:39]
buffer_load_dwordx4 v12, s[36:39], s64 offen lds
v_mfma_f32_16x16x32_bf16 a[4:7], a[156:159], v[172:175], a[4:7]
s_add_u32 m0, s86, 136192
ds_read_b128 a[196:199], v3 offset:14336
v_cvt_pk_bf16_f32 v189, v130, v131
v_mfma_f32_16x16x32_bf16 a[4:7], a[152:155], v[168:171], a[4:7]
s_add_u32 s64, s85, 40960
ds_read_b128 a[200:203], v3 offset:7168
v_cvt_pk_bf16_f32 v196, v144, v145
v_mfma_f32_16x16x32_bf16 a[8:11], a[160:163], v[168:171], a[8:11]
buffer_load_dwordx4 v13, s[36:39], s64 offen lds
v_mfma_f32_16x16x32_bf16 a[8:11], a[164:167], v[172:175], a[8:11]
s_add_u32 m0, s86, 137216
ds_read_b128 a[204:207], v3 offset:15360
v_mfma_f32_16x16x32_bf16 a[40:43], a[164:167], v[180:183], a[40:43]
s_add_u32 s64, s85, 49152
v_exp_f32 v146, v146
v_mfma_f32_16x16x32_bf16 a[40:43], a[160:163], v[176:179], a[40:43]
buffer_load_dwordx4 v12, s[36:39], s64 offen lds
v_mfma_f32_16x16x32_bf16 a[72:75], a[160:163], v[200:203], a[72:75]
s_add_u32 m0, s86, 138240
v_exp_f32 v147, v147
v_mfma_f32_16x16x32_bf16 a[72:75], a[164:167], v[204:207], a[72:75]
s_add_u32 s64, s85, 57344
v_exp_f32 v148, v148
v_mfma_f32_16x16x32_bf16 a[104:107], a[164:167], v[212:215], a[104:107]
buffer_load_dwordx4 v13, s[36:39], s64 offen lds
v_mfma_f32_16x16x32_bf16 a[104:107], a[160:163], v[208:211], a[104:107]
s_waitcnt lgkmcnt(0)
v_exp_f32 v149, v149
v_mfma_f32_16x16x32_bf16 a[108:111], a[168:171], v[208:211], a[108:111]
v_exp_f32 v150, v150
v_mfma_f32_16x16x32_bf16 a[108:111], a[172:175], v[212:215], a[108:111]
v_exp_f32 v151, v151
v_mfma_f32_16x16x32_bf16 a[76:79], a[172:175], v[204:207], a[76:79]
v_exp_f32 v132, v132
v_mfma_f32_16x16x32_bf16 a[76:79], a[168:171], v[200:203], a[76:79]
v_exp_f32 v133, v133
v_mfma_f32_16x16x32_bf16 a[44:47], a[168:171], v[176:179], a[44:47]
s_waitcnt vmcnt(16)
s_barrier
v_mfma_f32_16x16x32_bf16 a[44:47], a[172:175], v[180:183], a[44:47]
s_xor_b32 s71, s71, 16384
v_exp_f32 v134, v134
v_mfma_f32_16x16x32_bf16 a[12:15], a[172:175], v[172:175], a[12:15]
s_add_u32 s70, s70, 32768
v_exp_f32 v135, v135
v_mfma_f32_16x16x32_bf16 a[12:15], a[168:171], v[168:171], a[12:15]
s_mov_b32 m0, s71
v_exp_f32 v116, v116
v_mfma_f32_16x16x32_bf16 a[16:19], a[176:179], v[168:171], a[16:19]
buffer_load_dwordx4 v16, s[32:35], s70 offen offset:0 sc1 lds
v_mfma_f32_16x16x32_bf16 a[16:19], a[180:183], v[172:175], a[16:19]
v_exp_f32 v117, v117
v_mfma_f32_16x16x32_bf16 a[48:51], a[180:183], v[180:183], a[48:51]
v_exp_f32 v118, v118
v_mfma_f32_16x16x32_bf16 a[48:51], a[176:179], v[176:179], a[48:51]
v_exp_f32 v119, v119
v_mfma_f32_16x16x32_bf16 a[80:83], a[176:179], v[200:203], a[80:83]
v_exp_f32 v100, v100
v_mfma_f32_16x16x32_bf16 a[80:83], a[180:183], v[204:207], a[80:83]
v_exp_f32 v101, v101
v_mfma_f32_16x16x32_bf16 a[112:115], a[180:183], v[212:215], a[112:115]
v_cvt_pk_bf16_f32 v197, v146, v147
v_cvt_pk_bf16_f32 v198, v148, v149
v_mfma_f32_16x16x32_bf16 a[112:115], a[176:179], v[208:211], a[112:115]
ds_read_b128 a[144:147], v2 offset:16384
v_cvt_pk_bf16_f32 v199, v150, v151
v_mfma_f32_16x16x32_bf16 a[116:119], a[184:187], v[208:211], a[116:119]
ds_read_b128 a[148:151], v2 offset:17408
v_cvt_pk_bf16_f32 v190, v132, v133
v_mfma_f32_16x16x32_bf16 a[116:119], a[188:191], v[212:215], a[116:119]
v_exp_f32 v102, v102
v_mfma_f32_16x16x32_bf16 a[84:87], a[188:191], v[204:207], a[84:87]
ds_read_b128 a[152:155], v2 offset:18432
v_cvt_pk_bf16_f32 v191, v134, v135
v_mfma_f32_16x16x32_bf16 a[84:87], a[184:187], v[200:203], a[84:87]
ds_read_b128 a[156:159], v2 offset:19456
v_cvt_pk_bf16_f32 v166, v116, v117
v_mfma_f32_16x16x32_bf16 a[52:55], a[184:187], v[176:179], a[52:55]
v_exp_f32 v103, v103
v_mfma_f32_16x16x32_bf16 a[52:55], a[188:191], v[180:183], a[52:55]
ds_read_b128 a[160:163], v2 offset:20480
v_cvt_pk_bf16_f32 v167, v118, v119
v_mfma_f32_16x16x32_bf16 a[20:23], a[188:191], v[172:175], a[20:23]
ds_read_b128 a[164:167], v2 offset:21504
v_cvt_pk_bf16_f32 v158, v100, v101
v_mfma_f32_16x16x32_bf16 a[20:23], a[184:187], v[168:171], a[20:23]
ds_read_b128 a[168:171], v2 offset:22528
v_cvt_pk_bf16_f32 v159, v102, v103
v_mfma_f32_16x16x32_bf16 a[24:27], a[192:195], v[168:171], a[24:27]
buffer_load_dwordx4 v16, s[32:35], s70 offen offset:1024 sc1 lds
v_mfma_f32_16x16x32_bf16 a[24:27], a[196:199], v[172:175], a[24:27]
ds_read_b128 a[172:175], v2 offset:23552
v_cndmask_b32 v104, v220, v17, s[0:1]
v_mfma_f32_16x16x32_bf16 a[56:59], a[196:199], v[180:183], a[56:59]
v_cndmask_b32 v105, v220, v17, s[4:5]
v_cndmask_b32 v106, v220, v17, s[6:7]
v_mfma_f32_16x16x32_bf16 a[56:59], a[192:195], v[176:179], a[56:59]
v_cndmask_b32 v107, v220, v17, s[8:9]
v_cndmask_b32 v108, v220, v17, s[10:11]
v_mfma_f32_16x16x32_bf16 a[88:91], a[192:195], v[200:203], a[88:91]
v_cndmask_b32 v109, v220, v17, s[12:13]
v_cndmask_b32 v110, v220, v17, s[18:19]
v_mfma_f32_16x16x32_bf16 a[88:91], a[196:199], v[204:207], a[88:91]
v_cndmask_b32 v111, v220, v17, s[22:23]
v_cndmask_b32 v112, v220, v17, s[26:27]
v_mfma_f32_16x16x32_bf16 a[120:123], a[196:199], v[212:215], a[120:123]
v_cndmask_b32 v113, v220, v17, s[56:57]
v_cndmask_b32 v114, v220, v17, s[58:59]
v_mfma_f32_16x16x32_bf16 a[120:123], a[192:195], v[208:211], a[120:123]
v_cndmask_b32 v115, v220, v17, s[60:61]
v_cndmask_b32 v116, v220, v17, s[62:63]
v_mfma_f32_16x16x32_bf16 a[124:127], a[200:203], v[208:211], a[124:127]
v_cndmask_b32 v117, v220, v17, s[48:49]
v_cndmask_b32 v118, v220, v17, s[50:51]
v_mfma_f32_16x16x32_bf16 a[124:127], a[204:207], v[212:215], a[124:127]
s_add_u32 s17, s78, L_T_10-L_pc
v_cndmask_b32 v119, v220, v17, s[100:101]
v_mfma_f32_16x16x32_bf16 a[92:95], a[204:207], v[204:207], a[92:95]
buffer_load_dword a252, v16, s[88:91], s17 offen
v_mfma_f32_16x16x32_bf16 a[92:95], a[200:203], v[200:203], a[92:95]
v_mfma_f32_16x16x32_bf16 a[60:63], a[200:203], v[176:179], a[60:63]
s_add_u32 s17, s78, L_T_10-L_pc+4096
v_mfma_f32_16x16x32_bf16 a[60:63], a[204:207], v[180:183], a[60:63]
buffer_load_dword a252, v16, s[88:91], s17 offen
v_mfma_f32_16x16x32_bf16 a[28:31], a[204:207], v[172:175], a[28:31]
v_mfma_f32_16x16x32_bf16 a[28:31], a[200:203], v[168:171], a[28:31]
s_waitcnt lgkmcnt(0)
v_mfma_f32_16x16x32_bf16 v[120:123], a[144:147], v[56:59], v[224:227]
ds_read_b128 a[176:179], v2 offset:24576
v_mfma_f32_16x16x32_bf16 v[120:123], a[148:151], v[60:63], v[120:123]
ds_read_b128 a[180:183], v2 offset:25600
v_mfma_f32_16x16x32_bf16 v[120:123], a[152:155], v[64:67], v[120:123]
buffer_load_dwordx4 v16, s[32:35], s70 offen offset:2048 sc1 lds
v_mfma_f32_16x16x32_bf16 v[120:123], a[156:159], v[68:71], v[120:123]
s_add_u32 s17, s78, L_T1_11-L_pc
ds_read_b128 a[184:187], v2 offset:26624
v_mfma_f32_16x16x32_bf16 v[136:139], a[156:159], v[84:87], v[228:231]
buffer_load_dword a252, v16, s[88:91], s17 offen
v_mfma_f32_16x16x32_bf16 v[136:139], a[152:155], v[80:83], v[136:139]
ds_read_b128 a[188:191], v2 offset:27648
v_mfma_f32_16x16x32_bf16 v[136:139], a[148:151], v[76:79], v[136:139]
s_add_u32 s17, s78, L_T1_11-L_pc+4096
v_mfma_f32_16x16x32_bf16 v[136:139], a[144:147], v[72:75], v[136:139]
buffer_load_dword a252, v16, s[88:91], s17 offen
v_mfma_f32_16x16x32_bf16 v[104:107], a[144:147], v[40:43], v[104:107]
ds_read_b128 a[192:195], v2 offset:28672
v_mfma_f32_16x16x32_bf16 v[104:107], a[148:151], v[44:47], v[104:107]
v_mfma_f32_16x16x32_bf16 v[104:107], a[152:155], v[48:51], v[104:107]
v_exp_f32 v120, v120
v_mfma_f32_16x16x32_bf16 v[104:107], a[156:159], v[52:55], v[104:107]
v_exp_f32 v121, v121
v_mfma_f32_16x16x32_bf16 v[140:143], a[172:175], v[84:87], v[228:231]
v_exp_f32 v122, v122
v_mfma_f32_16x16x32_bf16 v[140:143], a[168:171], v[80:83], v[140:143]
v_exp_f32 v123, v123
v_mfma_f32_16x16x32_bf16 v[140:143], a[164:167], v[76:79], v[140:143]
v_exp_f32 v136, v136
v_mfma_f32_16x16x32_bf16 v[140:143], a[160:163], v[72:75], v[140:143]
v_exp_f32 v137, v137
v_mfma_f32_16x16x32_bf16 v[124:127], a[160:163], v[56:59], v[224:227]
buffer_load_dwordx4 v16, s[32:35], s70 offen offset:3072 sc1 lds
v_mfma_f32_16x16x32_bf16 v[124:127], a[164:167], v[60:63], v[124:127]
v_exp_f32 v138, v138
v_mfma_f32_16x16x32_bf16 v[124:127], a[168:171], v[64:67], v[124:127]
v_exp_f32 v139, v139
v_mfma_f32_16x16x32_bf16 v[124:127], a[172:175], v[68:71], v[124:127]
ds_read_b128 a[196:199], v2 offset:29696
v_cvt_pk_bf16_f32 v200, v120, v121
v_mfma_f32_16x16x32_bf16 v[108:111], a[172:175], v[52:55], v[108:111]
ds_read_b128 a[200:203], v2 offset:30720
v_cvt_pk_bf16_f32 v201, v122, v123
v_mfma_f32_16x16x32_bf16 v[108:111], a[168:171], v[48:51], v[108:111]
v_exp_f32 v104, v104
v_mfma_f32_16x16x32_bf16 v[108:111], a[164:167], v[44:47], v[108:111]
ds_read_b128 a[204:207], v2 offset:31744
v_cvt_pk_bf16_f32 v208, v136, v137
v_mfma_f32_16x16x32_bf16 v[108:111], a[160:163], v[40:43], v[108:111]
s_waitcnt lgkmcnt(3)
v_exp_f32 v105, v105
v_mfma_f32_16x16x32_bf16 v[112:115], a[176:179], v[40:43], v[112:115]
v_exp_f32 v106, v106
v_mfma_f32_16x16x32_bf16 v[112:115], a[180:183], v[44:47], v[112:115]
v_exp_f32 v107, v107
v_mfma_f32_16x16x32_bf16 v[112:115], a[184:187], v[48:51], v[112:115]
v_exp_f32 v140, v140
v_mfma_f32_16x16x32_bf16 v[112:115], a[188:191], v[52:55], v[112:115]
v_exp_f32 v141, v141
v_mfma_f32_16x16x32_bf16 v[128:131], a[188:191], v[68:71], v[224:227]
s_add_u32 m0, s71, 4096
v_exp_f32 v142, v142
v_mfma_f32_16x16x32_bf16 v[128:131], a[184:187], v[64:67], v[128:131]
s_add_u32 s64, s70, 4096
v_exp_f32 v143, v143
v_mfma_f32_16x16x32_bf16 v[128:131], a[180:183], v[60:63], v[128:131]
buffer_load_dwordx4 v16, s[32:35], s64 offen offset:0 sc1 lds
v_mfma_f32_16x16x32_bf16 v[128:131], a[176:179], v[56:59], v[128:131]
v_exp_f32 v124, v124
v_mfma_f32_16x16x32_bf16 v[144:147], a[176:179], v[72:75], v[228:231]
ds_read_b128 a[144:147], v3 offset:16384
v_cvt_pk_bf16_f32 v209, v138, v139
v_mfma_f32_16x16x32_bf16 v[144:147], a[180:183], v[76:79], v[144:147]
v_exp_f32 v125, v125
v_mfma_f32_16x16x32_bf16 v[144:147], a[184:187], v[80:83], v[144:147]
ds_read_b128 a[148:151], v3 offset:24576
v_cvt_pk_bf16_f32 v176, v104, v105
v_mfma_f32_16x16x32_bf16 v[144:147], a[188:191], v[84:87], v[144:147]
s_waitcnt lgkmcnt(2)
v_exp_f32 v126, v126
v_mfma_f32_16x16x32_bf16 v[148:151], a[204:207], v[84:87], v[228:231]
v_exp_f32 v127, v127
v_mfma_f32_16x16x32_bf16 v[148:151], a[200:203], v[80:83], v[148:151]
ds_read_b128 a[152:155], v3 offset:17408
v_cvt_pk_bf16_f32 v177, v106, v107
v_mfma_f32_16x16x32_bf16 v[148:151], a[196:199], v[76:79], v[148:151]
v_exp_f32 v108, v108
v_mfma_f32_16x16x32_bf16 v[148:151], a[192:195], v[72:75], v[148:151]
ds_read_b128 a[156:159], v3 offset:25600
v_cvt_pk_bf16_f32 v210, v140, v141
v_mfma_f32_16x16x32_bf16 v[132:135], a[192:195], v[56:59], v[224:227]
v_exp_f32 v109, v109
v_mfma_f32_16x16x32_bf16 v[132:135], a[196:199], v[60:63], v[132:135]
v_exp_f32 v110, v110
v_mfma_f32_16x16x32_bf16 v[132:135], a[200:203], v[64:67], v[132:135]
v_exp_f32 v111, v111
v_mfma_f32_16x16x32_bf16 v[132:135], a[204:207], v[68:71], v[132:135]
ds_read_b128 a[160:163], v3 offset:18432
v_cvt_pk_bf16_f32 v211, v142, v143
v_mfma_f32_16x16x32_bf16 v[116:119], a[204:207], v[52:55], v[116:119]
buffer_load_dwordx4 v16, s[32:35], s64 offen offset:1024 sc1 lds
v_mfma_f32_16x16x32_bf16 v[116:119], a[200:203], v[48:51], v[116:119]
v_exp_f32 v112, v112
v_mfma_f32_16x16x32_bf16 v[116:119], a[196:199], v[44:47], v[116:119]
ds_read_b128 a[164:167], v3 offset:26624
v_cvt_pk_bf16_f32 v202, v124, v125
v_mfma_f32_16x16x32_bf16 v[116:119], a[192:195], v[40:43], v[116:119]
v_exp_f32 v113, v113
v_mfma_f32_16x16x32_bf16 a[128:131], a[244:247], v[152:155], a[128:131]
v_exp_f32 v114, v114
v_mfma_f32_16x16x32_bf16 a[128:131], a[244:247], v[156:159], a[128:131]
v_exp_f32 v115, v115
v_mfma_f32_16x16x32_bf16 a[132:135], a[244:247], v[160:163], a[132:135]
ds_read_b128 a[168:171], v3 offset:19456
v_cvt_pk_bf16_f32 v203, v126, v127
v_mfma_f32_16x16x32_bf16 a[132:135], a[244:247], v[164:167], a[132:135]
ds_read_b128 a[172:175], v3 offset:27648
v_cvt_pk_bf16_f32 v178, v108, v109
v_mfma_f32_16x16x32_bf16 a[136:139], a[244:247], v[184:187], a[136:139]
v_exp_f32 v128, v128
v_mfma_f32_16x16x32_bf16 a[136:139], a[244:247], v[188:191], a[136:139]
v_exp_f32 v129, v129
v_mfma_f32_16x16x32_bf16 a[140:143], a[244:247], v[192:195], a[140:143]
v_exp_f32 v130, v130
v_mfma_f32_16x16x32_bf16 a[140:143], a[244:247], v[196:199], a[140:143]
s_waitcnt lgkmcnt(2)
ds_read_b128 a[176:179], v3 offset:20480
v_cvt_pk_bf16_f32 v179, v110, v111
v_mfma_f32_16x16x32_bf16 a[0:3], a[144:147], v[152:155], a[0:3]
v_exp_f32 v131, v131
v_mfma_f32_16x16x32_bf16 a[0:3], a[148:151], v[156:159], a[0:3]
ds_read_b128 a[180:183], v3 offset:28672
v_cvt_pk_bf16_f32 v180, v112, v113
v_mfma_f32_16x16x32_bf16 a[32:35], a[148:151], v[164:167], a[32:35]
buffer_load_dwordx4 v16, s[32:35], s64 offen offset:2048 sc1 lds
v_mfma_f32_16x16x32_bf16 a[32:35], a[144:147], v[160:163], a[32:35]
v_exp_f32 v144, v144
v_mfma_f32_16x16x32_bf16 a[64:67], a[144:147], v[184:187], a[64:67]
v_exp_f32 v145, v145
v_mfma_f32_16x16x32_bf16 a[64:67], a[148:151], v[188:191], a[64:67]
ds_read_b128 a[184:187], v3 offset:21504
v_xor_b32 v2, 0x8000, v2
v_mfma_f32_16x16x32_bf16 a[96:99], a[148:151], v[196:199], a[96:99]
v_exp_f32 v146, v146
v_mfma_f32_16x16x32_bf16 a[96:99], a[144:147], v[192:195], a[96:99]
ds_read_b128 a[188:191], v3 offset:29696
v_cvt_pk_bf16_f32 v181, v114, v115
v_mfma_f32_16x16x32_bf16 a[100:103], a[152:155], v[192:195], a[100:103]
v_exp_f32 v147, v147
v_mfma_f32_16x16x32_bf16 a[100:103], a[156:159], v[196:199], a[100:103]
v_exp_f32 v148, v148
v_mfma_f32_16x16x32_bf16 a[68:71], a[156:159], v[188:191], a[68:71]
v_exp_f32 v149, v149
v_mfma_f32_16x16x32_bf16 a[68:71], a[152:155], v[184:187], a[68:71]
ds_read_b128 a[192:195], v3 offset:22528
v_cvt_pk_bf16_f32 v204, v128, v129
v_mfma_f32_16x16x32_bf16 a[36:39], a[152:155], v[160:163], a[36:39]
v_exp_f32 v150, v150
v_mfma_f32_16x16x32_bf16 a[36:39], a[156:159], v[164:167], a[36:39]
v_exp_f32 v151, v151
v_mfma_f32_16x16x32_bf16 a[4:7], a[156:159], v[156:159], a[4:7]
v_exp_f32 v132, v132
v_mfma_f32_16x16x32_bf16 a[4:7], a[152:155], v[152:155], a[4:7]
ds_read_b128 a[196:199], v3 offset:30720
v_cvt_pk_bf16_f32 v205, v130, v131
v_mfma_f32_16x16x32_bf16 a[8:11], a[160:163], v[152:155], a[8:11]
buffer_load_dwordx4 v16, s[32:35], s64 offen offset:3072 sc1 lds
v_mfma_f32_16x16x32_bf16 a[8:11], a[164:167], v[156:159], a[8:11]
v_exp_f32 v133, v133
v_mfma_f32_16x16x32_bf16 a[40:43], a[164:167], v[164:167], a[40:43]
ds_read_b128 a[200:203], v3 offset:23552
v_cvt_pk_bf16_f32 v212, v144, v145
v_mfma_f32_16x16x32_bf16 a[40:43], a[160:163], v[160:163], a[40:43]
v_exp_f32 v134, v134
v_mfma_f32_16x16x32_bf16 a[72:75], a[160:163], v[184:187], a[72:75]
v_exp_f32 v135, v135
v_mfma_f32_16x16x32_bf16 a[72:75], a[164:167], v[188:191], a[72:75]
v_exp_f32 v116, v116
v_mfma_f32_16x16x32_bf16 a[104:107], a[164:167], v[196:199], a[104:107]
ds_read_b128 a[204:207], v3 offset:31744
v_cvt_pk_bf16_f32 v213, v146, v147
v_mfma_f32_16x16x32_bf16 a[104:107], a[160:163], v[192:195], a[104:107]
s_waitcnt lgkmcnt(2)
v_exp_f32 v117, v117
v_mfma_f32_16x16x32_bf16 a[108:111], a[168:171], v[192:195], a[108:111]
v_exp_f32 v118, v118
v_mfma_f32_16x16x32_bf16 a[108:111], a[172:175], v[196:199], a[108:111]
v_exp_f32 v119, v119
v_mfma_f32_16x16x32_bf16 a[76:79], a[172:175], v[188:191], a[76:79]
v_cvt_pk_bf16_f32 v214, v148, v149
v_cvt_pk_bf16_f32 v215, v150, v151
v_mfma_f32_16x16x32_bf16 a[76:79], a[168:171], v[184:187], a[76:79]
v_cvt_pk_bf16_f32 v206, v132, v133
v_cvt_pk_bf16_f32 v207, v134, v135
v_mfma_f32_16x16x32_bf16 a[44:47], a[168:171], v[160:163], a[44:47]
v_cvt_pk_bf16_f32 v182, v116, v117
v_cvt_pk_bf16_f32 v183, v118, v119
v_mfma_f32_16x16x32_bf16 a[44:47], a[172:175], v[164:167], a[44:47]
v_accvgpr_read_b32 v20, a128
v_max_f32 v1, v1, v20
v_mfma_f32_16x16x32_bf16 a[12:15], a[172:175], v[156:159], a[12:15]
v_rcp_f32 v20, v20
v_mfma_f32_16x16x32_bf16 a[12:15], a[168:171], v[152:155], a[12:15]
v_accvgpr_read_b32 v232, a0
v_accvgpr_read_b32 v233, a1
v_mfma_f32_16x16x32_bf16 a[16:19], a[176:179], v[152:155], a[16:19]
s_waitcnt vmcnt(16)
s_barrier
v_mfma_f32_16x16x32_bf16 a[16:19], a[180:183], v[156:159], a[16:19]
s_xor_b32 s71, s71, 49152
ds_read_b128 a[144:147], v2 offset:0
v_xor_b32 v3, 0x8000, v3
v_mfma_f32_16x16x32_bf16 a[48:51], a[180:183], v[164:167], a[48:51]
s_add_u32 s70, s70, 32768
ds_read_b128 a[148:151], v2 offset:1024
v_accvgpr_read_b32 v234, a2
v_mfma_f32_16x16x32_bf16 a[48:51], a[176:179], v[160:163], a[48:51]
s_mov_b32 m0, s71
ds_read_b128 a[152:155], v2 offset:2048
v_accvgpr_read_b32 v235, a3
v_mfma_f32_16x16x32_bf16 a[80:83], a[176:179], v[184:187], a[80:83]
buffer_load_dwordx4 v16, s[32:35], s70 offen offset:0 sc1 lds
v_mfma_f32_16x16x32_bf16 a[80:83], a[180:183], v[188:191], a[80:83]
ds_read_b128 a[156:159], v2 offset:3072
v_accvgpr_read_b32 v236, a4
v_mfma_f32_16x16x32_bf16 a[112:115], a[180:183], v[196:199], a[112:115]
ds_read_b128 a[160:163], v2 offset:4096
v_accvgpr_read_b32 v237, a5
v_mfma_f32_16x16x32_bf16 a[112:115], a[176:179], v[192:195], a[112:115]
ds_read_b128 a[164:167], v2 offset:5120
v_accvgpr_read_b32 v238, a6
v_mfma_f32_16x16x32_bf16 a[116:119], a[184:187], v[192:195], a[116:119]
ds_read_b128 a[168:171], v2 offset:6144
v_accvgpr_read_b32 v239, a7
v_mfma_f32_16x16x32_bf16 a[116:119], a[188:191], v[196:199], a[116:119]
ds_read_b128 a[172:175], v2 offset:7168
v_mul_f32 v20, v20, v4
v_mfma_f32_16x16x32_bf16 a[84:87], a[188:191], v[188:191], a[84:87]
v_mul_f32 v232, v232, v20
v_mul_f32 v233, v233, v20
v_mfma_f32_16x16x32_bf16 a[84:87], a[184:187], v[184:187], a[84:87]
v_mul_f32 v234, v234, v20
v_mul_f32 v235, v235, v20
v_mfma_f32_16x16x32_bf16 a[52:55], a[184:187], v[160:163], a[52:55]
v_mul_f32 v236, v236, v20
v_mul_f32 v237, v237, v20
v_mfma_f32_16x16x32_bf16 a[52:55], a[188:191], v[164:167], a[52:55]
v_mul_f32 v238, v238, v20
v_mul_f32 v239, v239, v20
v_mfma_f32_16x16x32_bf16 a[20:23], a[188:191], v[156:159], a[20:23]
v_cvt_pk_bf16_f32 v232, v232, v233
v_cvt_pk_bf16_f32 v233, v234, v235
v_mfma_f32_16x16x32_bf16 a[20:23], a[184:187], v[152:155], a[20:23]
v_cvt_pk_bf16_f32 v234, v236, v237
v_cvt_pk_bf16_f32 v235, v238, v239
v_mfma_f32_16x16x32_bf16 a[24:27], a[192:195], v[152:155], a[24:27]
s_add_u32 s77, s74, 0
buffer_store_dwordx4 v[232:235], v16, s[44:47], s77 offen sc1
v_mfma_f32_16x16x32_bf16 a[24:27], a[196:199], v[156:159], a[24:27]
v_accvgpr_read_b32 v240, a8
v_accvgpr_read_b32 v241, a9
v_mfma_f32_16x16x32_bf16 a[56:59], a[196:199], v[164:167], a[56:59]
buffer_load_dwordx4 v16, s[32:35], s70 offen offset:1024 sc1 lds
v_mfma_f32_16x16x32_bf16 a[56:59], a[192:195], v[160:163], a[56:59]
v_accvgpr_read_b32 v242, a10
v_accvgpr_read_b32 v243, a11
v_mfma_f32_16x16x32_bf16 a[88:91], a[192:195], v[184:187], a[88:91]
v_accvgpr_read_b32 v244, a12
v_accvgpr_read_b32 v245, a13
v_mfma_f32_16x16x32_bf16 a[88:91], a[196:199], v[188:191], a[88:91]
v_accvgpr_read_b32 v246, a14
v_accvgpr_read_b32 v247, a15
v_mfma_f32_16x16x32_bf16 a[120:123], a[196:199], v[196:199], a[120:123]
v_mul_f32 v240, v240, v20
v_mul_f32 v241, v241, v20
v_mfma_f32_16x16x32_bf16 a[120:123], a[192:195], v[192:195], a[120:123]
s_waitcnt lgkmcnt(0)
v_mul_f32 v242, v242, v20
v_mul_f32 v243, v243, v20
v_mfma_f32_16x16x32_bf16 a[124:127], a[200:203], v[192:195], a[124:127]
v_mul_f32 v244, v244, v20
v_mul_f32 v245, v245, v20
v_mfma_f32_16x16x32_bf16 a[124:127], a[204:207], v[196:199], a[124:127]
v_mul_f32 v246, v246, v20
v_mul_f32 v247, v247, v20
v_mfma_f32_16x16x32_bf16 a[92:95], a[204:207], v[188:191], a[92:95]
v_cvt_pk_bf16_f32 v240, v240, v241
v_cvt_pk_bf16_f32 v241, v242, v243
v_mfma_f32_16x16x32_bf16 a[92:95], a[200:203], v[184:187], a[92:95]
v_cvt_pk_bf16_f32 v242, v244, v245
v_cvt_pk_bf16_f32 v243, v246, v247
v_mfma_f32_16x16x32_bf16 a[60:63], a[200:203], v[160:163], a[60:63]
s_add_u32 s77, s74, 8192
buffer_store_dwordx4 v[240:243], v16, s[44:47], s77 offen sc1
v_mfma_f32_16x16x32_bf16 a[60:63], a[204:207], v[164:167], a[60:63]
v_accvgpr_read_b32 v232, a16
v_accvgpr_read_b32 v233, a17
v_mfma_f32_16x16x32_bf16 a[28:31], a[204:207], v[156:159], a[28:31]
v_accvgpr_read_b32 v234, a18
v_accvgpr_read_b32 v235, a19
v_mfma_f32_16x16x32_bf16 a[28:31], a[200:203], v[152:155], a[28:31]
v_accvgpr_read_b32 v236, a20
v_accvgpr_read_b32 v237, a21
v_accvgpr_read_b32 v238, a22
v_accvgpr_read_b32 v239, a23
v_mul_f32 v232, v232, v20
v_mul_f32 v233, v233, v20
v_mul_f32 v234, v234, v20
v_mul_f32 v235, v235, v20
v_mul_f32 v236, v236, v20
v_mul_f32 v237, v237, v20
v_mul_f32 v238, v238, v20
v_mul_f32 v239, v239, v20
v_cvt_pk_bf16_f32 v232, v232, v233
v_cvt_pk_bf16_f32 v233, v234, v235
v_cvt_pk_bf16_f32 v234, v236, v237
v_cvt_pk_bf16_f32 v235, v238, v239
s_add_u32 s77, s74, 16384
buffer_store_dwordx4 v[232:235], v16, s[44:47], s77 offen sc1
s_cmp_eq_u32 s3, 7
s_cbranch_scc1 L_T1_11
L_T_10:
s_waitcnt lgkmcnt(7)
v_mfma_f32_16x16x32_bf16 v[120:123], a[144:147], v[56:59], v[224:227]
s_waitcnt lgkmcnt(6)
ds_read_b128 a[176:179], v2 offset:8192
v_mfma_f32_16x16x32_bf16 v[120:123], a[148:151], v[60:63], v[120:123]
s_waitcnt lgkmcnt(6)
ds_read_b128 a[180:183], v2 offset:9216
v_mfma_f32_16x16x32_bf16 v[120:123], a[152:155], v[64:67], v[120:123]
s_waitcnt lgkmcnt(6)
buffer_load_dwordx4 v16, s[32:35], s70 offen offset:2048 sc1 lds
v_mfma_f32_16x16x32_bf16 v[120:123], a[156:159], v[68:71], v[120:123]
ds_read_b128 a[184:187], v2 offset:10240
v_mfma_f32_16x16x32_bf16 v[136:139], a[156:159], v[84:87], v[228:231]
ds_read_b128 a[188:191], v2 offset:11264
v_mfma_f32_16x16x32_bf16 v[136:139], a[152:155], v[80:83], v[136:139]
ds_read_b128 a[192:195], v2 offset:12288
v_mfma_f32_16x16x32_bf16 v[136:139], a[148:151], v[76:79], v[136:139]
v_mfma_f32_16x16x32_bf16 v[136:139], a[144:147], v[72:75], v[136:139]
s_waitcnt lgkmcnt(3)
ds_read_b128 a[196:199], v2 offset:13312
v_mfma_f32_16x16x32_bf16 v[140:143], a[160:163], v[72:75], v[228:231]
ds_read_b128 a[200:203], v2 offset:14336
v_accvgpr_read_b32 v240, a24
v_mfma_f32_16x16x32_bf16 v[140:143], a[164:167], v[76:79], v[140:143]
ds_read_b128 a[204:207], v2 offset:15360
v_accvgpr_read_b32 v241, a25
v_mfma_f32_16x16x32_bf16 v[140:143], a[168:171], v[80:83], v[140:143]
v_exp_f32 v120, v120
v_mfma_f32_16x16x32_bf16 v[140:143], a[172:175], v[84:87], v[140:143]
v_exp_f32 v121, v121
v_mfma_f32_16x16x32_bf16 v[124:127], a[172:175], v[68:71], v[224:227]
buffer_load_dwordx4 v16, s[32:35], s70 offen offset:3072 sc1 lds
v_mfma_f32_16x16x32_bf16 v[124:127], a[168:171], v[64:67], v[124:127]
v_exp_f32 v122, v122
v_mfma_f32_16x16x32_bf16 v[124:127], a[164:167], v[60:63], v[124:127]
v_exp_f32 v123, v123
v_mfma_f32_16x16x32_bf16 v[124:127], a[160:163], v[56:59], v[124:127]
v_exp_f32 v136, v136
v_mfma_f32_16x16x32_bf16 v[128:131], a[176:179], v[56:59], v[224:227]
v_exp_f32 v137, v137
v_mfma_f32_16x16x32_bf16 v[128:131], a[180:183], v[60:63], v[128:131]
s_waitcnt lgkmcnt(0)
v_exp_f32 v138, v138
v_mfma_f32_16x16x32_bf16 v[128:131], a[184:187], v[64:67], v[128:131]
v_exp_f32 v139, v139
v_mfma_f32_16x16x32_bf16 v[128:131], a[188:191], v[68:71], v[128:131]
s_add_u32 m0, s71, 4096
v_exp_f32 v140, v140
v_mfma_f32_16x16x32_bf16 v[144:147], a[188:191], v[84:87], v[228:231]
s_add_u32 s64, s70, 4096
v_cvt_pk_bf16_f32 v184, v120, v121
v_cvt_pk_bf16_f32 v185, v122, v123
v_mfma_f32_16x16x32_bf16 v[144:147], a[184:187], v[80:83], v[144:147]
buffer_load_dwordx4 v16, s[32:35], s64 offen offset:0 sc1 lds
v_mfma_f32_16x16x32_bf16 v[144:147], a[180:183], v[76:79], v[144:147]
ds_read_b128 a[144:147], v3 offset:0
v_cvt_pk_bf16_f32 v192, v136, v137
v_mfma_f32_16x16x32_bf16 v[144:147], a[176:179], v[72:75], v[144:147]
ds_read_b128 a[148:151], v3 offset:8192
v_cvt_pk_bf16_f32 v193, v138, v139
v_mfma_f32_16x16x32_bf16 v[148:151], a[192:195], v[72:75], v[228:231]
v_exp_f32 v141, v141
v_mfma_f32_16x16x32_bf16 v[148:151], a[196:199], v[76:79], v[148:151]
v_exp_f32 v142, v142
v_mfma_f32_16x16x32_bf16 v[148:151], a[200:203], v[80:83], v[148:151]
v_exp_f32 v143, v143
v_mfma_f32_16x16x32_bf16 v[148:151], a[204:207], v[84:87], v[148:151]
ds_read_b128 a[152:155], v3 offset:1024
v_cvt_pk_bf16_f32 v194, v140, v141
v_mfma_f32_16x16x32_bf16 v[132:135], a[204:207], v[68:71], v[224:227]
ds_read_b128 a[156:159], v3 offset:9216
v_accvgpr_read_b32 v242, a26
v_mfma_f32_16x16x32_bf16 v[132:135], a[200:203], v[64:67], v[132:135]
v_exp_f32 v124, v124
v_mfma_f32_16x16x32_bf16 v[132:135], a[196:199], v[60:63], v[132:135]
v_exp_f32 v125, v125
v_mfma_f32_16x16x32_bf16 v[132:135], a[192:195], v[56:59], v[132:135]
buffer_load_dwordx4 v16, s[32:35], s64 offen offset:1024 sc1 lds
v_mfma_f32_16x16x32_bf16 a[132:135], a[244:247], v[176:179], a[132:135]
ds_read_b128 a[160:163], v3 offset:2048
v_accvgpr_read_b32 v243, a27
v_mfma_f32_16x16x32_bf16 a[132:135], a[244:247], v[180:183], a[132:135]
ds_read_b128 a[164:167], v3 offset:10240
v_accvgpr_read_b32 v244, a28
v_mfma_f32_16x16x32_bf16 a[136:139], a[244:247], v[200:203], a[136:139]
ds_read_b128 a[168:171], v3 offset:3072
v_accvgpr_read_b32 v245, a29
v_mfma_f32_16x16x32_bf16 a[136:139], a[244:247], v[204:207], a[136:139]
ds_read_b128 a[172:175], v3 offset:11264
v_accvgpr_read_b32 v246, a30
v_mfma_f32_16x16x32_bf16 a[140:143], a[244:247], v[208:211], a[140:143]
ds_read_b128 a[176:179], v3 offset:4096
v_accvgpr_read_b32 v247, a31
v_mfma_f32_16x16x32_bf16 a[140:143], a[244:247], v[212:215], a[140:143]
s_waitcnt lgkmcnt(5)
ds_read_b128 a[180:183], v3 offset:12288
v_mul_f32 v240, v240, v20
v_mfma_f32_16x16x32_bf16 a[32:35], a[144:147], v[176:179], a[32:35]
ds_read_b128 a[184:187], v3 offset:5120
v_mul_f32 v241, v241, v20
v_mfma_f32_16x16x32_bf16 a[32:35], a[148:151], v[180:183], a[32:35]
ds_read_b128 a[188:191], v3 offset:13312
v_mul_f32 v242, v242, v20
v_mfma_f32_16x16x32_bf16 a[64:67], a[148:151], v[204:207], a[64:67]
ds_read_b128 a[192:195], v3 offset:6144
v_mul_f32 v243, v243, v20
v_mfma_f32_16x16x32_bf16 a[64:67], a[144:147], v[200:203], a[64:67]
ds_read_b128 a[196:199], v3 offset:14336
v_mul_f32 v244, v244, v20
v_mfma_f32_16x16x32_bf16 a[96:99], a[144:147], v[208:211], a[96:99]
ds_read_b128 a[200:203], v3 offset:7168
v_mul_f32 v245, v245, v20
v_mul_f32 v246, v246, v20
v_mul_f32 v247, v247, v20
v_cvt_pk_bf16_f32 v240, v240, v241
v_cvt_pk_bf16_f32 v241, v242, v243
v_cvt_pk_bf16_f32 v242, v244, v245
v_cvt_pk_bf16_f32 v243, v246, v247
s_add_u32 s77, s74, 24576
buffer_store_dwordx4 v[240:243], v16, s[44:47], s77 offen sc1
v_mfma_f32_16x16x32_bf16 a[96:99], a[148:151], v[212:215], a[96:99]
v_exp_f32 v126, v126
v_mfma_f32_16x16x32_bf16 a[100:103], a[156:159], v[212:215], a[100:103]
buffer_load_dwordx4 v16, s[32:35], s64 offen offset:2048 sc1 lds
v_cvt_pk_bf16_f32 v195, v142, v143
v_mfma_f32_16x16x32_bf16 a[100:103], a[152:155], v[208:211], a[100:103]
v_exp_f32 v127, v127
v_mfma_f32_16x16x32_bf16 a[68:71], a[152:155], v[200:203], a[68:71]
v_exp_f32 v128, v128
v_mfma_f32_16x16x32_bf16 a[68:71], a[156:159], v[204:207], a[68:71]
v_exp_f32 v129, v129
v_mfma_f32_16x16x32_bf16 a[36:39], a[156:159], v[180:183], a[36:39]
v_exp_f32 v130, v130
v_mfma_f32_16x16x32_bf16 a[36:39], a[152:155], v[176:179], a[36:39]
s_waitcnt lgkmcnt(0)
v_cvt_pk_bf16_f32 v186, v124, v125
v_cvt_pk_bf16_f32 v187, v126, v127
v_mfma_f32_16x16x32_bf16 a[40:43], a[160:163], v[176:179], a[40:43]
v_exp_f32 v131, v131
v_mfma_f32_16x16x32_bf16 a[40:43], a[164:167], v[180:183], a[40:43]
buffer_load_dwordx4 v16, s[32:35], s64 offen offset:3072 sc1 lds
v_mfma_f32_16x16x32_bf16 a[72:75], a[164:167], v[204:207], a[72:75]
v_exp_f32 v144, v144
v_mfma_f32_16x16x32_bf16 a[72:75], a[160:163], v[200:203], a[72:75]
v_exp_f32 v145, v145
v_mfma_f32_16x16x32_bf16 a[104:107], a[160:163], v[208:211], a[104:107]
v_exp_f32 v146, v146
v_mfma_f32_16x16x32_bf16 a[104:107], a[164:167], v[212:215], a[104:107]
ds_read_b128 a[204:207], v3 offset:15360
v_cvt_pk_bf16_f32 v188, v128, v129
v_mfma_f32_16x16x32_bf16 a[108:111], a[172:175], v[212:215], a[108:111]
v_exp_f32 v147, v147
v_mfma_f32_16x16x32_bf16 a[108:111], a[168:171], v[208:211], a[108:111]
v_exp_f32 v148, v148
v_mfma_f32_16x16x32_bf16 a[76:79], a[168:171], v[200:203], a[76:79]
v_exp_f32 v149, v149
v_mfma_f32_16x16x32_bf16 a[76:79], a[172:175], v[204:207], a[76:79]
v_exp_f32 v150, v150
v_mfma_f32_16x16x32_bf16 a[44:47], a[172:175], v[180:183], a[44:47]
v_exp_f32 v151, v151
v_mfma_f32_16x16x32_bf16 a[44:47], a[168:171], v[176:179], a[44:47]
v_exp_f32 v132, v132
v_mfma_f32_16x16x32_bf16 a[48:51], a[176:179], v[176:179], a[48:51]
v_exp_f32 v133, v133
v_mfma_f32_16x16x32_bf16 a[48:51], a[180:183], v[180:183], a[48:51]
s_waitcnt vmcnt(9)
s_barrier
v_cvt_pk_bf16_f32 v189, v130, v131
v_mfma_f32_16x16x32_bf16 a[80:83], a[180:183], v[204:207], a[80:83]
s_xor_b32 s71, s71, 16384
ds_read_b128 a[144:147], v2 offset:16384
v_cvt_pk_bf16_f32 v196, v144, v145
v_mfma_f32_16x16x32_bf16 a[80:83], a[176:179], v[200:203], a[80:83]
s_add_u32 s70, s70, 32768
v_exp_f32 v134, v134
v_mfma_f32_16x16x32_bf16 a[112:115], a[176:179], v[208:211], a[112:115]
s_mov_b32 m0, s71
ds_read_b128 a[148:151], v2 offset:17408
v_cvt_pk_bf16_f32 v197, v146, v147
v_mfma_f32_16x16x32_bf16 a[112:115], a[180:183], v[212:215], a[112:115]
buffer_load_dwordx4 v16, s[32:35], s70 offen offset:0 sc1 lds
v_mfma_f32_16x16x32_bf16 a[116:119], a[188:191], v[212:215], a[116:119]
ds_read_b128 a[152:155], v2 offset:18432
v_cvt_pk_bf16_f32 v198, v148, v149
v_mfma_f32_16x16x32_bf16 a[116:119], a[184:187], v[208:211], a[116:119]
ds_read_b128 a[156:159], v2 offset:19456
v_cvt_pk_bf16_f32 v199, v150, v151
v_mfma_f32_16x16x32_bf16 a[84:87], a[184:187], v[200:203], a[84:87]
v_exp_f32 v135, v135
v_mfma_f32_16x16x32_bf16 a[84:87], a[188:191], v[204:207], a[84:87]
ds_read_b128 a[160:163], v2 offset:20480
v_cvt_pk_bf16_f32 v190, v132, v133
v_mfma_f32_16x16x32_bf16 a[52:55], a[188:191], v[180:183], a[52:55]
ds_read_b128 a[164:167], v2 offset:21504
v_cvt_pk_bf16_f32 v191, v134, v135
v_mfma_f32_16x16x32_bf16 a[52:55], a[184:187], v[176:179], a[52:55]
ds_read_b128 a[168:171], v2 offset:22528
v_accvgpr_read_b32 v21, a132
v_mfma_f32_16x16x32_bf16 a[56:59], a[192:195], v[176:179], a[56:59]
ds_read_b128 a[172:175], v2 offset:23552
v_max_f32 v1, v1, v21
v_mfma_f32_16x16x32_bf16 a[56:59], a[196:199], v[180:183], a[56:59]
v_rcp_f32 v21, v21
v_mfma_f32_16x16x32_bf16 a[88:91], a[196:199], v[204:207], a[88:91]
buffer_load_dwordx4 v16, s[32:35], s70 offen offset:1024 sc1 lds
v_mfma_f32_16x16x32_bf16 a[88:91], a[192:195], v[200:203], a[88:91]
v_accvgpr_read_b32 v232, a32
v_accvgpr_read_b32 v233, a33
v_mfma_f32_16x16x32_bf16 a[120:123], a[192:195], v[208:211], a[120:123]
v_accvgpr_read_b32 v234, a34
v_accvgpr_read_b32 v235, a35
v_mfma_f32_16x16x32_bf16 a[120:123], a[196:199], v[212:215], a[120:123]
s_waitcnt lgkmcnt(1)
v_accvgpr_read_b32 v236, a36
v_accvgpr_read_b32 v237, a37
v_mfma_f32_16x16x32_bf16 a[124:127], a[204:207], v[212:215], a[124:127]
v_accvgpr_read_b32 v238, a38
v_accvgpr_read_b32 v239, a39
v_mfma_f32_16x16x32_bf16 a[124:127], a[200:203], v[208:211], a[124:127]
v_mul_f32 v21, v21, v6
v_mul_f32 v232, v232, v21
v_mfma_f32_16x16x32_bf16 a[92:95], a[200:203], v[200:203], a[92:95]
v_mul_f32 v233, v233, v21
v_mul_f32 v234, v234, v21
v_mfma_f32_16x16x32_bf16 a[92:95], a[204:207], v[204:207], a[92:95]
v_mul_f32 v235, v235, v21
v_mul_f32 v236, v236, v21
v_mfma_f32_16x16x32_bf16 a[60:63], a[204:207], v[180:183], a[60:63]
v_mul_f32 v237, v237, v21
v_mul_f32 v238, v238, v21
v_mfma_f32_16x16x32_bf16 a[60:63], a[200:203], v[176:179], a[60:63]
v_mul_f32 v239, v239, v21
v_cvt_pk_bf16_f32 v232, v232, v233
v_mfma_f32_16x16x32_bf16 v[120:123], a[144:147], v[56:59], v[224:227]
ds_read_b128 a[176:179], v2 offset:24576
ds_read_b128 a[180:183], v2 offset:25600
v_mfma_f32_16x16x32_bf16 v[120:123], a[148:151], v[60:63], v[120:123]
ds_read_b128 a[184:187], v2 offset:26624
v_cvt_pk_bf16_f32 v233, v234, v235
v_mfma_f32_16x16x32_bf16 v[120:123], a[152:155], v[64:67], v[120:123]
buffer_load_dwordx4 v16, s[32:35], s70 offen offset:2048 sc1 lds
v_mfma_f32_16x16x32_bf16 v[120:123], a[156:159], v[68:71], v[120:123]
ds_read_b128 a[188:191], v2 offset:27648
ds_read_b128 a[192:195], v2 offset:28672
v_mfma_f32_16x16x32_bf16 v[136:139], a[156:159], v[84:87], v[228:231]
ds_read_b128 a[196:199], v2 offset:29696
v_cvt_pk_bf16_f32 v234, v236, v237
v_mfma_f32_16x16x32_bf16 v[136:139], a[152:155], v[80:83], v[136:139]
buffer_load_dwordx4 v16, s[32:35], s70 offen offset:3072 sc1 lds
v_mfma_f32_16x16x32_bf16 v[136:139], a[148:151], v[76:79], v[136:139]
ds_read_b128 a[200:203], v2 offset:30720
ds_read_b128 a[204:207], v2 offset:31744
v_mfma_f32_16x16x32_bf16 v[136:139], a[144:147], v[72:75], v[136:139]
v_exp_f32 v120, v120
v_mfma_f32_16x16x32_bf16 v[140:143], a[160:163], v[72:75], v[228:231]
v_exp_f32 v121, v121
v_mfma_f32_16x16x32_bf16 v[140:143], a[164:167], v[76:79], v[140:143]
s_add_u32 m0, s71, 4096
v_exp_f32 v122, v122
v_mfma_f32_16x16x32_bf16 v[140:143], a[168:171], v[80:83], v[140:143]
s_waitcnt lgkmcnt(2)
v_cvt_pk_bf16_f32 v235, v238, v239
s_add_u32 s77, s74, 4096
buffer_store_dwordx4 v[232:235], v16, s[44:47], s77 offen sc1
v_accvgpr_read_b32 v240, a40
v_accvgpr_read_b32 v241, a41
v_accvgpr_read_b32 v242, a42
v_accvgpr_read_b32 v243, a43
v_accvgpr_read_b32 v244, a44
v_accvgpr_read_b32 v245, a45
v_accvgpr_read_b32 v246, a46
v_accvgpr_read_b32 v247, a47
v_mul_f32 v240, v240, v21
v_mul_f32 v241, v241, v21
v_mul_f32 v242, v242, v21
v_mul_f32 v243, v243, v21
v_mul_f32 v244, v244, v21
v_mul_f32 v245, v245, v21
v_mul_f32 v246, v246, v21
v_mul_f32 v247, v247, v21
v_cvt_pk_bf16_f32 v240, v240, v241
v_cvt_pk_bf16_f32 v241, v242, v243
v_cvt_pk_bf16_f32 v242, v244, v245
v_cvt_pk_bf16_f32 v243, v246, v247
s_add_u32 s77, s74, 12288
buffer_store_dwordx4 v[240:243], v16, s[44:47], s77 offen sc1
v_accvgpr_read_b32 v232, a48
v_accvgpr_read_b32 v233, a49
v_accvgpr_read_b32 v234, a50
v_accvgpr_read_b32 v235, a51
v_accvgpr_read_b32 v236, a52
v_accvgpr_read_b32 v237, a53
v_accvgpr_read_b32 v238, a54
v_accvgpr_read_b32 v239, a55
v_mul_f32 v232, v232, v21
v_mul_f32 v233, v233, v21
v_mul_f32 v234, v234, v21
v_mul_f32 v235, v235, v21
v_mul_f32 v236, v236, v21
v_mul_f32 v237, v237, v21
v_mul_f32 v238, v238, v21
v_mul_f32 v239, v239, v21
v_cvt_pk_bf16_f32 v232, v232, v233
v_cvt_pk_bf16_f32 v233, v234, v235
v_cvt_pk_bf16_f32 v234, v236, v237
v_cvt_pk_bf16_f32 v235, v238, v239
s_add_u32 s77, s74, 20480
buffer_store_dwordx4 v[232:235], v16, s[44:47], s77 offen sc1
v_accvgpr_read_b32 v240, a56
v_accvgpr_read_b32 v241, a57
v_accvgpr_read_b32 v242, a58
v_accvgpr_read_b32 v243, a59
v_accvgpr_read_b32 v244, a60
v_accvgpr_read_b32 v245, a61
v_accvgpr_read_b32 v246, a62
v_accvgpr_read_b32 v247, a63
v_mul_f32 v240, v240, v21
v_mul_f32 v241, v241, v21
v_mul_f32 v242, v242, v21
v_mul_f32 v243, v243, v21
v_mul_f32 v244, v244, v21
v_mul_f32 v245, v245, v21
v_mul_f32 v246, v246, v21
v_mul_f32 v247, v247, v21
v_cvt_pk_bf16_f32 v240, v240, v241
v_cvt_pk_bf16_f32 v241, v242, v243
v_cvt_pk_bf16_f32 v242, v244, v245
v_cvt_pk_bf16_f32 v243, v246, v247
s_add_u32 s77, s74, 28672
buffer_store_dwordx4 v[240:243], v16, s[44:47], s77 offen sc1
v_exp_f32 v123, v123
v_mfma_f32_16x16x32_bf16 v[140:143], a[172:175], v[84:87], v[140:143]
v_exp_f32 v136, v136
v_mfma_f32_16x16x32_bf16 v[124:127], a[172:175], v[68:71], v[224:227]
ds_read_b128 a[144:147], v3 offset:16384
v_cvt_pk_bf16_f32 v200, v120, v121
v_mfma_f32_16x16x32_bf16 v[124:127], a[168:171], v[64:67], v[124:127]
s_add_u32 s64, s70, 4096
v_exp_f32 v137, v137
v_mfma_f32_16x16x32_bf16 v[124:127], a[164:167], v[60:63], v[124:127]
ds_read_b128 a[148:151], v3 offset:24576
v_cvt_pk_bf16_f32 v201, v122, v123
v_mfma_f32_16x16x32_bf16 v[124:127], a[160:163], v[56:59], v[124:127]
v_exp_f32 v138, v138
v_mfma_f32_16x16x32_bf16 v[128:131], a[176:179], v[56:59], v[224:227]
ds_read_b128 a[152:155], v3 offset:17408
v_cvt_pk_bf16_f32 v208, v136, v137
v_mfma_f32_16x16x32_bf16 v[128:131], a[180:183], v[60:63], v[128:131]
v_exp_f32 v139, v139
v_mfma_f32_16x16x32_bf16 v[128:131], a[184:187], v[64:67], v[128:131]
ds_read_b128 a[156:159], v3 offset:25600
v_cvt_pk_bf16_f32 v209, v138, v139
v_mfma_f32_16x16x32_bf16 v[128:131], a[188:191], v[68:71], v[128:131]
v_exp_f32 v140, v140
v_mfma_f32_16x16x32_bf16 v[144:147], a[188:191], v[84:87], v[228:231]
buffer_load_dwordx4 v16, s[32:35], s64 offen offset:0 sc1 lds
v_mfma_f32_16x16x32_bf16 v[144:147], a[184:187], v[80:83], v[144:147]
v_exp_f32 v141, v141
v_mfma_f32_16x16x32_bf16 v[144:147], a[180:183], v[76:79], v[144:147]
ds_read_b128 a[160:163], v3 offset:18432
v_cvt_pk_bf16_f32 v210, v140, v141
v_mfma_f32_16x16x32_bf16 v[144:147], a[176:179], v[72:75], v[144:147]
v_exp_f32 v142, v142
v_mfma_f32_16x16x32_bf16 v[148:151], a[192:195], v[72:75], v[228:231]
ds_read_b128 a[164:167], v3 offset:26624
ds_read_b128 a[168:171], v3 offset:19456
v_mfma_f32_16x16x32_bf16 v[148:151], a[196:199], v[76:79], v[148:151]
s_waitcnt lgkmcnt(3)
v_exp_f32 v143, v143
v_mfma_f32_16x16x32_bf16 v[148:151], a[200:203], v[80:83], v[148:151]
ds_read_b128 a[172:175], v3 offset:27648
v_cvt_pk_bf16_f32 v211, v142, v143
v_mfma_f32_16x16x32_bf16 v[148:151], a[204:207], v[84:87], v[148:151]
v_exp_f32 v124, v124
v_mfma_f32_16x16x32_bf16 v[132:135], a[204:207], v[68:71], v[224:227]
buffer_load_dwordx4 v16, s[32:35], s64 offen offset:1024 sc1 lds
v_mfma_f32_16x16x32_bf16 v[132:135], a[200:203], v[64:67], v[132:135]
v_exp_f32 v125, v125
v_mfma_f32_16x16x32_bf16 v[132:135], a[196:199], v[60:63], v[132:135]
ds_read_b128 a[176:179], v3 offset:20480
v_cvt_pk_bf16_f32 v202, v124, v125
v_mfma_f32_16x16x32_bf16 v[132:135], a[192:195], v[56:59], v[132:135]
v_exp_f32 v126, v126
v_mfma_f32_16x16x32_bf16 a[136:139], a[244:247], v[184:187], a[136:139]
ds_read_b128 a[180:183], v3 offset:28672
ds_read_b128 a[184:187], v3 offset:21504
v_mfma_f32_16x16x32_bf16 a[136:139], a[244:247], v[188:191], a[136:139]
v_exp_f32 v127, v127
v_mfma_f32_16x16x32_bf16 a[140:143], a[244:247], v[192:195], a[140:143]
ds_read_b128 a[188:191], v3 offset:29696
v_cvt_pk_bf16_f32 v203, v126, v127
v_mfma_f32_16x16x32_bf16 a[140:143], a[244:247], v[196:199], a[140:143]
v_exp_f32 v128, v128
v_mfma_f32_16x16x32_bf16 a[64:67], a[144:147], v[184:187], a[64:67]
buffer_load_dwordx4 v16, s[32:35], s64 offen offset:2048 sc1 lds
v_mfma_f32_16x16x32_bf16 a[64:67], a[148:151], v[188:191], a[64:67]
v_exp_f32 v129, v129
v_mfma_f32_16x16x32_bf16 a[96:99], a[148:151], v[196:199], a[96:99]
ds_read_b128 a[192:195], v3 offset:22528
v_cvt_pk_bf16_f32 v204, v128, v129
v_mfma_f32_16x16x32_bf16 a[96:99], a[144:147], v[192:195], a[96:99]
v_exp_f32 v130, v130
v_mfma_f32_16x16x32_bf16 a[100:103], a[152:155], v[192:195], a[100:103]
ds_read_b128 a[196:199], v3 offset:30720
v_xor_b32 v2, 0x8000, v2
v_mfma_f32_16x16x32_bf16 a[100:103], a[156:159], v[196:199], a[100:103]
v_exp_f32 v131, v131
v_mfma_f32_16x16x32_bf16 a[68:71], a[156:159], v[188:191], a[68:71]
ds_read_b128 a[200:203], v3 offset:23552
v_cvt_pk_bf16_f32 v205, v130, v131
v_mfma_f32_16x16x32_bf16 a[68:71], a[152:155], v[184:187], a[68:71]
s_waitcnt lgkmcnt(3)
v_exp_f32 v144, v144
v_mfma_f32_16x16x32_bf16 a[72:75], a[160:163], v[184:187], a[72:75]
buffer_load_dwordx4 v16, s[32:35], s64 offen offset:3072 sc1 lds
v_mfma_f32_16x16x32_bf16 a[72:75], a[164:167], v[188:191], a[72:75]
s_xor_b32 s71, s71, 49152
v_exp_f32 v145, v145
v_mfma_f32_16x16x32_bf16 a[104:107], a[164:167], v[196:199], a[104:107]
ds_read_b128 a[204:207], v3 offset:31744
v_cvt_pk_bf16_f32 v212, v144, v145
v_mfma_f32_16x16x32_bf16 a[104:107], a[160:163], v[192:195], a[104:107]
v_exp_f32 v146, v146
v_mfma_f32_16x16x32_bf16 a[108:111], a[168:171], v[192:195], a[108:111]
s_waitcnt vmcnt(12)
s_barrier
v_mfma_f32_16x16x32_bf16 a[108:111], a[172:175], v[196:199], a[108:111]
s_add_u32 s70, s70, 32768
v_exp_f32 v147, v147
v_mfma_f32_16x16x32_bf16 a[76:79], a[172:175], v[188:191], a[76:79]
ds_read_b128 a[144:147], v2 offset:0
v_cvt_pk_bf16_f32 v213, v146, v147
v_mfma_f32_16x16x32_bf16 a[76:79], a[168:171], v[184:187], a[76:79]
v_exp_f32 v148, v148
v_mfma_f32_16x16x32_bf16 a[80:83], a[176:179], v[184:187], a[80:83]
ds_read_b128 a[148:151], v2 offset:1024
v_xor_b32 v3, 0x8000, v3
v_mfma_f32_16x16x32_bf16 a[80:83], a[180:183], v[188:191], a[80:83]
s_mov_b32 m0, s71
v_exp_f32 v149, v149
v_mfma_f32_16x16x32_bf16 a[112:115], a[180:183], v[196:199], a[112:115]
ds_read_b128 a[152:155], v2 offset:2048
v_cvt_pk_bf16_f32 v214, v148, v149
v_mfma_f32_16x16x32_bf16 a[112:115], a[176:179], v[192:195], a[112:115]
v_exp_f32 v150, v150
v_mfma_f32_16x16x32_bf16 a[116:119], a[184:187], v[192:195], a[116:119]
buffer_load_dwordx4 v16, s[32:35], s70 offen offset:0 sc1 lds
v_mfma_f32_16x16x32_bf16 a[116:119], a[188:191], v[196:199], a[116:119]
v_exp_f32 v151, v151
v_mfma_f32_16x16x32_bf16 a[84:87], a[188:191], v[188:191], a[84:87]
ds_read_b128 a[156:159], v2 offset:3072
v_cvt_pk_bf16_f32 v215, v150, v151
v_mfma_f32_16x16x32_bf16 a[84:87], a[184:187], v[184:187], a[84:87]
s_waitcnt lgkmcnt(2)
v_exp_f32 v132, v132
v_mfma_f32_16x16x32_bf16 a[88:91], a[192:195], v[184:187], a[88:91]
ds_read_b128 a[160:163], v2 offset:4096
v_mfma_f32_16x16x32_bf16 a[88:91], a[196:199], v[188:191], a[88:91]
v_exp_f32 v133, v133
v_mfma_f32_16x16x32_bf16 a[120:123], a[196:199], v[196:199], a[120:123]
ds_read_b128 a[164:167], v2 offset:5120
v_cvt_pk_bf16_f32 v206, v132, v133
v_mfma_f32_16x16x32_bf16 a[120:123], a[192:195], v[192:195], a[120:123]
v_exp_f32 v134, v134
v_mfma_f32_16x16x32_bf16 a[124:127], a[200:203], v[192:195], a[124:127]
buffer_load_dwordx4 v16, s[32:35], s70 offen offset:1024 sc1 lds
v_mfma_f32_16x16x32_bf16 a[124:127], a[204:207], v[196:199], a[124:127]
v_exp_f32 v135, v135
v_mfma_f32_16x16x32_bf16 a[92:95], a[204:207], v[188:191], a[92:95]
ds_read_b128 a[168:171], v2 offset:6144
v_cvt_pk_bf16_f32 v207, v134, v135
v_mfma_f32_16x16x32_bf16 a[92:95], a[200:203], v[184:187], a[92:95]
ds_read_b128 a[172:175], v2 offset:7168
s_lshl_b32 s72, s3, 1
s_sub_u32 s72, 13, s72
.p2align 3
L_S_12:
s_waitcnt lgkmcnt(7)
v_mfma_f32_16x16x32_bf16 v[120:123], a[144:147], v[56:59], v[224:227]
s_waitcnt lgkmcnt(6)
ds_read_b128 a[176:179], v2 offset:8192
ds_read_b128 a[180:183], v2 offset:9216
v_mfma_f32_16x16x32_bf16 v[120:123], a[148:151], v[60:63], v[120:123]
s_waitcnt lgkmcnt(7)
ds_read_b128 a[184:187], v2 offset:10240
v_mfma_f32_16x16x32_bf16 v[120:123], a[152:155], v[64:67], v[120:123]
s_waitcnt lgkmcnt(7)
buffer_load_dwordx4 v16, s[32:35], s70 offen offset:2048 sc1 lds
v_mfma_f32_16x16x32_bf16 v[120:123], a[156:159], v[68:71], v[120:123]
ds_read_b128 a[188:191], v2 offset:11264
ds_read_b128 a[192:195], v2 offset:12288
v_mfma_f32_16x16x32_bf16 v[136:139], a[156:159], v[84:87], v[228:231]
ds_read_b128 a[196:199], v2 offset:13312
v_mfma_f32_16x16x32_bf16 v[136:139], a[152:155], v[80:83], v[136:139]
buffer_load_dwordx4 v16, s[32:35], s70 offen offset:3072 sc1 lds
v_mfma_f32_16x16x32_bf16 v[136:139], a[148:151], v[76:79], v[136:139]
ds_read_b128 a[200:203], v2 offset:14336
ds_read_b128 a[204:207], v2 offset:15360
v_mfma_f32_16x16x32_bf16 v[136:139], a[144:147], v[72:75], v[136:139]
s_waitcnt lgkmcnt(5)
v_exp_f32 v120, v120
v_mfma_f32_16x16x32_bf16 v[140:143], a[160:163], v[72:75], v[228:231]
v_exp_f32 v121, v121
v_mfma_f32_16x16x32_bf16 v[140:143], a[164:167], v[76:79], v[140:143]
s_add_u32 m0, s71, 4096
v_exp_f32 v122, v122
v_mfma_f32_16x16x32_bf16 v[140:143], a[168:171], v[80:83], v[140:143]
v_exp_f32 v123, v123
v_mfma_f32_16x16x32_bf16 v[140:143], a[172:175], v[84:87], v[140:143]
v_exp_f32 v136, v136
v_mfma_f32_16x16x32_bf16 v[124:127], a[172:175], v[68:71], v[224:227]
ds_read_b128 a[144:147], v3 offset:0
v_cvt_pk_bf16_f32 v184, v120, v121
v_mfma_f32_16x16x32_bf16 v[124:127], a[168:171], v[64:67], v[124:127]
s_add_u32 s64, s70, 4096
v_exp_f32 v137, v137
v_mfma_f32_16x16x32_bf16 v[124:127], a[164:167], v[60:63], v[124:127]
ds_read_b128 a[148:151], v3 offset:8192
v_cvt_pk_bf16_f32 v185, v122, v123
v_mfma_f32_16x16x32_bf16 v[124:127], a[160:163], v[56:59], v[124:127]
v_exp_f32 v138, v138
v_mfma_f32_16x16x32_bf16 v[128:131], a[176:179], v[56:59], v[224:227]
ds_read_b128 a[152:155], v3 offset:1024
v_cvt_pk_bf16_f32 v192, v136, v137
v_mfma_f32_16x16x32_bf16 v[128:131], a[180:183], v[60:63], v[128:131]
v_exp_f32 v139, v139
v_mfma_f32_16x16x32_bf16 v[128:131], a[184:187], v[64:67], v[128:131]
s_waitcnt lgkmcnt(2)
ds_read_b128 a[156:159], v3 offset:9216
v_cvt_pk_bf16_f32 v193, v138, v139
v_mfma_f32_16x16x32_bf16 v[128:131], a[188:191], v[68:71], v[128:131]
v_exp_f32 v140, v140
v_mfma_f32_16x16x32_bf16 v[144:147], a[188:191], v[84:87], v[228:231]
buffer_load_dwordx4 v16, s[32:35], s64 offen offset:0 sc1 lds
v_mfma_f32_16x16x32_bf16 v[144:147], a[184:187], v[80:83], v[144:147]
v_exp_f32 v141, v141
v_mfma_f32_16x16x32_bf16 v[144:147], a[180:183], v[76:79], v[144:147]
ds_read_b128 a[160:163], v3 offset:2048
v_cvt_pk_bf16_f32 v194, v140, v141
v_mfma_f32_16x16x32_bf16 v[144:147], a[176:179], v[72:75], v[144:147]
v_exp_f32 v142, v142
v_mfma_f32_16x16x32_bf16 v[148:151], a[192:195], v[72:75], v[228:231]
ds_read_b128 a[164:167], v3 offset:10240
ds_read_b128 a[168:171], v3 offset:3072
v_mfma_f32_16x16x32_bf16 v[148:151], a[196:199], v[76:79], v[148:151]
v_exp_f32 v143, v143
v_mfma_f32_16x16x32_bf16 v[148:151], a[200:203], v[80:83], v[148:151]
ds_read_b128 a[172:175], v3 offset:11264
v_cvt_pk_bf16_f32 v195, v142, v143
v_mfma_f32_16x16x32_bf16 v[148:151], a[204:207], v[84:87], v[148:151]
v_exp_f32 v124, v124
v_mfma_f32_16x16x32_bf16 v[132:135], a[204:207], v[68:71], v[224:227]
buffer_load_dwordx4 v16, s[32:35], s64 offen offset:1024 sc1 lds
v_mfma_f32_16x16x32_bf16 v[132:135], a[200:203], v[64:67], v[132:135]
v_exp_f32 v125, v125
v_mfma_f32_16x16x32_bf16 v[132:135], a[196:199], v[60:63], v[132:135]
ds_read_b128 a[176:179], v3 offset:4096
v_cvt_pk_bf16_f32 v186, v124, v125
v_mfma_f32_16x16x32_bf16 v[132:135], a[192:195], v[56:59], v[132:135]
v_exp_f32 v126, v126
v_mfma_f32_16x16x32_bf16 a[136:139], a[244:247], v[200:203], a[136:139]
ds_read_b128 a[180:183], v3 offset:12288
ds_read_b128 a[184:187], v3 offset:5120
v_mfma_f32_16x16x32_bf16 a[136:139], a[244:247], v[204:207], a[136:139]
v_exp_f32 v127, v127
v_mfma_f32_16x16x32_bf16 a[140:143], a[244:247], v[208:211], a[140:143]
ds_read_b128 a[188:191], v3 offset:13312
v_cvt_pk_bf16_f32 v187, v126, v127
v_mfma_f32_16x16x32_bf16 a[140:143], a[244:247], v[212:215], a[140:143]
v_exp_f32 v128, v128
v_mfma_f32_16x16x32_bf16 a[64:67], a[144:147], v[200:203], a[64:67]
s_waitcnt lgkmcnt(3)
buffer_load_dwordx4 v16, s[32:35], s64 offen offset:2048 sc1 lds
v_mfma_f32_16x16x32_bf16 a[64:67], a[148:151], v[204:207], a[64:67]
v_exp_f32 v129, v129
v_mfma_f32_16x16x32_bf16 a[96:99], a[148:151], v[212:215], a[96:99]
ds_read_b128 a[192:195], v3 offset:6144
v_cvt_pk_bf16_f32 v188, v128, v129
v_mfma_f32_16x16x32_bf16 a[96:99], a[144:147], v[208:211], a[96:99]
v_exp_f32 v130, v130
v_mfma_f32_16x16x32_bf16 a[100:103], a[152:155], v[208:211], a[100:103]
ds_read_b128 a[196:199], v3 offset:14336
v_mfma_f32_16x16x32_bf16 a[100:103], a[156:159], v[212:215], a[100:103]
v_exp_f32 v131, v131
v_mfma_f32_16x16x32_bf16 a[68:71], a[156:159], v[204:207], a[68:71]
ds_read_b128 a[200:203], v3 offset:7168
v_cvt_pk_bf16_f32 v189, v130, v131
v_mfma_f32_16x16x32_bf16 a[68:71], a[152:155], v[200:203], a[68:71]
v_exp_f32 v144, v144
v_mfma_f32_16x16x32_bf16 a[72:75], a[160:163], v[200:203], a[72:75]
buffer_load_dwordx4 v16, s[32:35], s64 offen offset:3072 sc1 lds
v_mfma_f32_16x16x32_bf16 a[72:75], a[164:167], v[204:207], a[72:75]
s_xor_b32 s71, s71, 16384
v_exp_f32 v145, v145
v_mfma_f32_16x16x32_bf16 a[104:107], a[164:167], v[212:215], a[104:107]
ds_read_b128 a[204:207], v3 offset:15360
v_cvt_pk_bf16_f32 v196, v144, v145
v_mfma_f32_16x16x32_bf16 a[104:107], a[160:163], v[208:211], a[104:107]
v_exp_f32 v146, v146
v_mfma_f32_16x16x32_bf16 a[108:111], a[168:171], v[208:211], a[108:111]
s_waitcnt vmcnt(8)
s_barrier
v_mfma_f32_16x16x32_bf16 a[108:111], a[172:175], v[212:215], a[108:111]
s_add_u32 s70, s70, 32768
v_exp_f32 v147, v147
v_mfma_f32_16x16x32_bf16 a[76:79], a[172:175], v[204:207], a[76:79]
ds_read_b128 a[144:147], v2 offset:16384
v_cvt_pk_bf16_f32 v197, v146, v147
v_mfma_f32_16x16x32_bf16 a[76:79], a[168:171], v[200:203], a[76:79]
v_exp_f32 v148, v148
v_mfma_f32_16x16x32_bf16 a[80:83], a[176:179], v[200:203], a[80:83]
s_waitcnt lgkmcnt(1)
ds_read_b128 a[148:151], v2 offset:17408
v_mfma_f32_16x16x32_bf16 a[80:83], a[180:183], v[204:207], a[80:83]
s_mov_b32 m0, s71
v_exp_f32 v149, v149
v_mfma_f32_16x16x32_bf16 a[112:115], a[180:183], v[212:215], a[112:115]
ds_read_b128 a[152:155], v2 offset:18432
v_cvt_pk_bf16_f32 v198, v148, v149
v_mfma_f32_16x16x32_bf16 a[112:115], a[176:179], v[208:211], a[112:115]
v_exp_f32 v150, v150
v_mfma_f32_16x16x32_bf16 a[116:119], a[184:187], v[208:211], a[116:119]
buffer_load_dwordx4 v16, s[32:35], s70 offen offset:0 sc1 lds
v_mfma_f32_16x16x32_bf16 a[116:119], a[188:191], v[212:215], a[116:119]
v_exp_f32 v151, v151
v_mfma_f32_16x16x32_bf16 a[84:87], a[188:191], v[204:207], a[84:87]
ds_read_b128 a[156:159], v2 offset:19456
v_cvt_pk_bf16_f32 v199, v150, v151
v_mfma_f32_16x16x32_bf16 a[84:87], a[184:187], v[200:203], a[84:87]
v_exp_f32 v132, v132
v_mfma_f32_16x16x32_bf16 a[88:91], a[192:195], v[200:203], a[88:91]
ds_read_b128 a[160:163], v2 offset:20480
v_mfma_f32_16x16x32_bf16 a[88:91], a[196:199], v[204:207], a[88:91]
v_exp_f32 v133, v133
v_mfma_f32_16x16x32_bf16 a[120:123], a[196:199], v[212:215], a[120:123]
ds_read_b128 a[164:167], v2 offset:21504
v_cvt_pk_bf16_f32 v190, v132, v133
v_mfma_f32_16x16x32_bf16 a[120:123], a[192:195], v[208:211], a[120:123]
v_exp_f32 v134, v134
v_mfma_f32_16x16x32_bf16 a[124:127], a[200:203], v[208:211], a[124:127]
buffer_load_dwordx4 v16, s[32:35], s70 offen offset:1024 sc1 lds
v_mfma_f32_16x16x32_bf16 a[124:127], a[204:207], v[212:215], a[124:127]
v_exp_f32 v135, v135
v_mfma_f32_16x16x32_bf16 a[92:95], a[204:207], v[204:207], a[92:95]
ds_read_b128 a[168:171], v2 offset:22528
v_cvt_pk_bf16_f32 v191, v134, v135
v_mfma_f32_16x16x32_bf16 a[92:95], a[200:203], v[200:203], a[92:95]
s_waitcnt lgkmcnt(2)
ds_read_b128 a[172:175], v2 offset:23552
v_mfma_f32_16x16x32_bf16 v[120:123], a[144:147], v[56:59], v[224:227]
ds_read_b128 a[176:179], v2 offset:24576
ds_read_b128 a[180:183], v2 offset:25600
v_mfma_f32_16x16x32_bf16 v[120:123], a[148:151], v[60:63], v[120:123]
ds_read_b128 a[184:187], v2 offset:26624
v_mfma_f32_16x16x32_bf16 v[120:123], a[152:155], v[64:67], v[120:123]
buffer_load_dwordx4 v16, s[32:35], s70 offen offset:2048 sc1 lds
v_mfma_f32_16x16x32_bf16 v[120:123], a[156:159], v[68:71], v[120:123]
ds_read_b128 a[188:191], v2 offset:27648
ds_read_b128 a[192:195], v2 offset:28672
v_mfma_f32_16x16x32_bf16 v[136:139], a[156:159], v[84:87], v[228:231]
ds_read_b128 a[196:199], v2 offset:29696
v_mfma_f32_16x16x32_bf16 v[136:139], a[152:155], v[80:83], v[136:139]
buffer_load_dwordx4 v16, s[32:35], s70 offen offset:3072 sc1 lds
v_mfma_f32_16x16x32_bf16 v[136:139], a[148:151], v[76:79], v[136:139]
ds_read_b128 a[200:203], v2 offset:30720
ds_read_b128 a[204:207], v2 offset:31744
v_mfma_f32_16x16x32_bf16 v[136:139], a[144:147], v[72:75], v[136:139]
v_exp_f32 v120, v120
v_mfma_f32_16x16x32_bf16 v[140:143], a[160:163], v[72:75], v[228:231]
s_waitcnt lgkmcnt(5)
v_exp_f32 v121, v121
v_mfma_f32_16x16x32_bf16 v[140:143], a[164:167], v[76:79], v[140:143]
s_add_u32 m0, s71, 4096
v_exp_f32 v122, v122
v_mfma_f32_16x16x32_bf16 v[140:143], a[168:171], v[80:83], v[140:143]
v_exp_f32 v123, v123
v_mfma_f32_16x16x32_bf16 v[140:143], a[172:175], v[84:87], v[140:143]
v_exp_f32 v136, v136
v_mfma_f32_16x16x32_bf16 v[124:127], a[172:175], v[68:71], v[224:227]
ds_read_b128 a[144:147], v3 offset:16384
v_cvt_pk_bf16_f32 v200, v120, v121
v_mfma_f32_16x16x32_bf16 v[124:127], a[168:171], v[64:67], v[124:127]
s_add_u32 s64, s70, 4096
v_exp_f32 v137, v137
v_mfma_f32_16x16x32_bf16 v[124:127], a[164:167], v[60:63], v[124:127]
ds_read_b128 a[148:151], v3 offset:24576
v_cvt_pk_bf16_f32 v201, v122, v123
v_mfma_f32_16x16x32_bf16 v[124:127], a[160:163], v[56:59], v[124:127]
v_exp_f32 v138, v138
v_mfma_f32_16x16x32_bf16 v[128:131], a[176:179], v[56:59], v[224:227]
ds_read_b128 a[152:155], v3 offset:17408
v_cvt_pk_bf16_f32 v208, v136, v137
v_mfma_f32_16x16x32_bf16 v[128:131], a[180:183], v[60:63], v[128:131]
v_exp_f32 v139, v139
v_mfma_f32_16x16x32_bf16 v[128:131], a[184:187], v[64:67], v[128:131]
s_waitcnt lgkmcnt(2)
ds_read_b128 a[156:159], v3 offset:25600
v_cvt_pk_bf16_f32 v209, v138, v139
v_mfma_f32_16x16x32_bf16 v[128:131], a[188:191], v[68:71], v[128:131]
v_exp_f32 v140, v140
v_mfma_f32_16x16x32_bf16 v[144:147], a[188:191], v[84:87], v[228:231]
buffer_load_dwordx4 v16, s[32:35], s64 offen offset:0 sc1 lds
v_mfma_f32_16x16x32_bf16 v[144:147], a[184:187], v[80:83], v[144:147]
v_exp_f32 v141, v141
v_mfma_f32_16x16x32_bf16 v[144:147], a[180:183], v[76:79], v[144:147]
ds_read_b128 a[160:163], v3 offset:18432
v_cvt_pk_bf16_f32 v210, v140, v141
v_mfma_f32_16x16x32_bf16 v[144:147], a[176:179], v[72:75], v[144:147]
v_exp_f32 v142, v142
v_mfma_f32_16x16x32_bf16 v[148:151], a[192:195], v[72:75], v[228:231]
ds_read_b128 a[164:167], v3 offset:26624
ds_read_b128 a[168:171], v3 offset:19456
v_mfma_f32_16x16x32_bf16 v[148:151], a[196:199], v[76:79], v[148:151]
v_exp_f32 v143, v143
v_mfma_f32_16x16x32_bf16 v[148:151], a[200:203], v[80:83], v[148:151]
ds_read_b128 a[172:175], v3 offset:27648
v_cvt_pk_bf16_f32 v211, v142, v143
v_mfma_f32_16x16x32_bf16 v[148:151], a[204:207], v[84:87], v[148:151]
v_exp_f32 v124, v124
v_mfma_f32_16x16x32_bf16 v[132:135], a[204:207], v[68:71], v[224:227]
buffer_load_dwordx4 v16, s[32:35], s64 offen offset:1024 sc1 lds
v_mfma_f32_16x16x32_bf16 v[132:135], a[200:203], v[64:67], v[132:135]
v_exp_f32 v125, v125
v_mfma_f32_16x16x32_bf16 v[132:135], a[196:199], v[60:63], v[132:135]
ds_read_b128 a[176:179], v3 offset:20480
v_cvt_pk_bf16_f32 v202, v124, v125
v_mfma_f32_16x16x32_bf16 v[132:135], a[192:195], v[56:59], v[132:135]
v_exp_f32 v126, v126
v_mfma_f32_16x16x32_bf16 a[136:139], a[244:247], v[184:187], a[136:139]
ds_read_b128 a[180:183], v3 offset:28672
ds_read_b128 a[184:187], v3 offset:21504
v_mfma_f32_16x16x32_bf16 a[136:139], a[244:247], v[188:191], a[136:139]
v_exp_f32 v127, v127
v_mfma_f32_16x16x32_bf16 a[140:143], a[244:247], v[192:195], a[140:143]
ds_read_b128 a[188:191], v3 offset:29696
v_cvt_pk_bf16_f32 v203, v126, v127
v_mfma_f32_16x16x32_bf16 a[140:143], a[244:247], v[196:199], a[140:143]
v_exp_f32 v128, v128
v_mfma_f32_16x16x32_bf16 a[64:67], a[144:147], v[184:187], a[64:67]
s_waitcnt lgkmcnt(3)
buffer_load_dwordx4 v16, s[32:35], s64 offen offset:2048 sc1 lds
v_mfma_f32_16x16x32_bf16 a[64:67], a[148:151], v[188:191], a[64:67]
v_exp_f32 v129, v129
v_mfma_f32_16x16x32_bf16 a[96:99], a[148:151], v[196:199], a[96:99]
ds_read_b128 a[192:195], v3 offset:22528
v_cvt_pk_bf16_f32 v204, v128, v129
v_mfma_f32_16x16x32_bf16 a[96:99], a[144:147], v[192:195], a[96:99]
v_exp_f32 v130, v130
v_mfma_f32_16x16x32_bf16 a[100:103], a[152:155], v[192:195], a[100:103]
ds_read_b128 a[196:199], v3 offset:30720
v_xor_b32 v2, 0x8000, v2
v_mfma_f32_16x16x32_bf16 a[100:103], a[156:159], v[196:199], a[100:103]
v_exp_f32 v131, v131
v_mfma_f32_16x16x32_bf16 a[68:71], a[156:159], v[188:191], a[68:71]
ds_read_b128 a[200:203], v3 offset:23552
v_cvt_pk_bf16_f32 v205, v130, v131
v_mfma_f32_16x16x32_bf16 a[68:71], a[152:155], v[184:187], a[68:71]
v_exp_f32 v144, v144
v_mfma_f32_16x16x32_bf16 a[72:75], a[160:163], v[184:187], a[72:75]
buffer_load_dwordx4 v16, s[32:35], s64 offen offset:3072 sc1 lds
v_mfma_f32_16x16x32_bf16 a[72:75], a[164:167], v[188:191], a[72:75]
s_xor_b32 s71, s71, 49152
v_exp_f32 v145, v145
v_mfma_f32_16x16x32_bf16 a[104:107], a[164:167], v[196:199], a[104:107]
ds_read_b128 a[204:207], v3 offset:31744
v_cvt_pk_bf16_f32 v212, v144, v145
v_mfma_f32_16x16x32_bf16 a[104:107], a[160:163], v[192:195], a[104:107]
v_exp_f32 v146, v146
v_mfma_f32_16x16x32_bf16 a[108:111], a[168:171], v[192:195], a[108:111]
s_waitcnt vmcnt(8)
s_barrier
v_mfma_f32_16x16x32_bf16 a[108:111], a[172:175], v[196:199], a[108:111]
s_add_u32 s70, s70, 32768
v_exp_f32 v147, v147
v_mfma_f32_16x16x32_bf16 a[76:79], a[172:175], v[188:191], a[76:79]
ds_read_b128 a[144:147], v2 offset:0
v_cvt_pk_bf16_f32 v213, v146, v147
v_mfma_f32_16x16x32_bf16 a[76:79], a[168:171], v[184:187], a[76:79]
v_exp_f32 v148, v148
v_mfma_f32_16x16x32_bf16 a[80:83], a[176:179], v[184:187], a[80:83]
s_waitcnt lgkmcnt(1)
ds_read_b128 a[148:151], v2 offset:1024
v_xor_b32 v3, 0x8000, v3
v_mfma_f32_16x16x32_bf16 a[80:83], a[180:183], v[188:191], a[80:83]
s_mov_b32 m0, s71
v_exp_f32 v149, v149
v_mfma_f32_16x16x32_bf16 a[112:115], a[180:183], v[196:199], a[112:115]
ds_read_b128 a[152:155], v2 offset:2048
v_cvt_pk_bf16_f32 v214, v148, v149
v_mfma_f32_16x16x32_bf16 a[112:115], a[176:179], v[192:195], a[112:115]
v_exp_f32 v150, v150
v_mfma_f32_16x16x32_bf16 a[116:119], a[184:187], v[192:195], a[116:119]
buffer_load_dwordx4 v16, s[32:35], s70 offen offset:0 sc1 lds
v_mfma_f32_16x16x32_bf16 a[116:119], a[188:191], v[196:199], a[116:119]
s_sub_u32 s72, s72, 1
v_exp_f32 v151, v151
v_mfma_f32_16x16x32_bf16 a[84:87], a[188:191], v[188:191], a[84:87]
ds_read_b128 a[156:159], v2 offset:3072
v_cvt_pk_bf16_f32 v215, v150, v151
v_mfma_f32_16x16x32_bf16 a[84:87], a[184:187], v[184:187], a[84:87]
v_exp_f32 v132, v132
v_mfma_f32_16x16x32_bf16 a[88:91], a[192:195], v[184:187], a[88:91]
ds_read_b128 a[160:163], v2 offset:4096
v_mfma_f32_16x16x32_bf16 a[88:91], a[196:199], v[188:191], a[88:91]
s_cmp_lg_u32 s72, 0
v_exp_f32 v133, v133
v_mfma_f32_16x16x32_bf16 a[120:123], a[196:199], v[196:199], a[120:123]
ds_read_b128 a[164:167], v2 offset:5120
v_cvt_pk_bf16_f32 v206, v132, v133
v_mfma_f32_16x16x32_bf16 a[120:123], a[192:195], v[192:195], a[120:123]
v_exp_f32 v134, v134
v_mfma_f32_16x16x32_bf16 a[124:127], a[200:203], v[192:195], a[124:127]
buffer_load_dwordx4 v16, s[32:35], s70 offen offset:1024 sc1 lds
v_mfma_f32_16x16x32_bf16 a[124:127], a[204:207], v[196:199], a[124:127]
v_exp_f32 v135, v135
v_mfma_f32_16x16x32_bf16 a[92:95], a[204:207], v[188:191], a[92:95]
ds_read_b128 a[168:171], v2 offset:6144
v_cvt_pk_bf16_f32 v207, v134, v135
v_mfma_f32_16x16x32_bf16 a[92:95], a[200:203], v[184:187], a[92:95]
ds_read_b128 a[172:175], v2 offset:7168
s_cbranch_scc1 L_S_12
buffer_load_dword v19, off, s[52:55], s80 sc1
s_add_u32 s17, s78, L_TAIL_14-L_pc+0
buffer_load_dword a252, v16, s[88:91], s17 offen
s_add_u32 s17, s78, L_TAIL_14-L_pc+4096
buffer_load_dword a252, v16, s[88:91], s17 offen
s_waitcnt lgkmcnt(7)
v_mfma_f32_16x16x32_bf16 v[136:139], a[144:147], v[72:75], v[228:231]
s_waitcnt lgkmcnt(6)
ds_read_b128 a[176:179], v2 offset:8192
ds_read_b128 a[180:183], v2 offset:9216
v_mfma_f32_16x16x32_bf16 v[136:139], a[148:151], v[76:79], v[136:139]
s_waitcnt lgkmcnt(7)
ds_read_b128 a[184:187], v2 offset:10240
v_cndmask_b32 v120, v224, v17, s[0:1]
v_cndmask_b32 v121, v224, v17, s[4:5]
v_cndmask_b32 v122, v224, v17, s[6:7]
v_cndmask_b32 v123, v224, v17, s[8:9]
v_mfma_f32_16x16x32_bf16 v[136:139], a[152:155], v[80:83], v[136:139]
s_waitcnt lgkmcnt(7)
buffer_load_dwordx4 v16, s[32:35], s70 offen offset:2048 sc1 lds
v_mfma_f32_16x16x32_bf16 v[136:139], a[156:159], v[84:87], v[136:139]
ds_read_b128 a[188:191], v2 offset:11264
ds_read_b128 a[192:195], v2 offset:12288
v_mfma_f32_16x16x32_bf16 v[120:123], a[156:159], v[68:71], v[120:123]
ds_read_b128 a[196:199], v2 offset:13312
v_cndmask_b32 v124, v224, v17, s[10:11]
v_mfma_f32_16x16x32_bf16 v[120:123], a[152:155], v[64:67], v[120:123]
buffer_load_dwordx4 v16, s[32:35], s70 offen offset:3072 sc1 lds
v_mfma_f32_16x16x32_bf16 v[120:123], a[148:151], v[60:63], v[120:123]
ds_read_b128 a[200:203], v2 offset:14336
ds_read_b128 a[204:207], v2 offset:15360
v_mfma_f32_16x16x32_bf16 v[120:123], a[144:147], v[56:59], v[120:123]
s_waitcnt lgkmcnt(5)
v_exp_f32 v136, v136
v_mfma_f32_16x16x32_bf16 v[140:143], a[160:163], v[72:75], v[228:231]
v_exp_f32 v137, v137
v_mfma_f32_16x16x32_bf16 v[140:143], a[164:167], v[76:79], v[140:143]
s_add_u32 m0, s71, 4096
v_cndmask_b32 v125, v224, v17, s[12:13]
v_cndmask_b32 v126, v224, v17, s[18:19]
v_cndmask_b32 v127, v224, v17, s[22:23]
v_exp_f32 v138, v138
v_mfma_f32_16x16x32_bf16 v[140:143], a[168:171], v[80:83], v[140:143]
v_exp_f32 v139, v139
v_mfma_f32_16x16x32_bf16 v[140:143], a[172:175], v[84:87], v[140:143]
v_exp_f32 v120, v120
v_mfma_f32_16x16x32_bf16 v[124:127], a[172:175], v[68:71], v[124:127]
ds_read_b128 a[144:147], v3 offset:0
v_cvt_pk_bf16_f32 v192, v136, v137
v_mfma_f32_16x16x32_bf16 v[124:127], a[168:171], v[64:67], v[124:127]
s_add_u32 s64, s70, 4096
v_cndmask_b32 v128, v224, v17, s[26:27]
v_cndmask_b32 v129, v224, v17, s[56:57]
v_cndmask_b32 v130, v224, v17, s[58:59]
v_cndmask_b32 v131, v224, v17, s[60:61]
v_exp_f32 v121, v121
v_mfma_f32_16x16x32_bf16 v[124:127], a[164:167], v[60:63], v[124:127]
ds_read_b128 a[148:151], v3 offset:8192
v_cvt_pk_bf16_f32 v193, v138, v139
v_mfma_f32_16x16x32_bf16 v[124:127], a[160:163], v[56:59], v[124:127]
v_exp_f32 v122, v122
v_mfma_f32_16x16x32_bf16 v[128:131], a[176:179], v[56:59], v[128:131]
ds_read_b128 a[152:155], v3 offset:1024
v_cvt_pk_bf16_f32 v184, v120, v121
v_mfma_f32_16x16x32_bf16 v[128:131], a[180:183], v[60:63], v[128:131]
v_exp_f32 v123, v123
v_mfma_f32_16x16x32_bf16 v[128:131], a[184:187], v[64:67], v[128:131]
s_waitcnt lgkmcnt(2)
ds_read_b128 a[156:159], v3 offset:9216
v_cvt_pk_bf16_f32 v185, v122, v123
v_mfma_f32_16x16x32_bf16 v[128:131], a[188:191], v[68:71], v[128:131]
v_exp_f32 v140, v140
v_mfma_f32_16x16x32_bf16 v[144:147], a[188:191], v[84:87], v[228:231]
buffer_load_dwordx4 v16, s[32:35], s64 offen offset:0 sc1 lds
v_mfma_f32_16x16x32_bf16 v[144:147], a[184:187], v[80:83], v[144:147]
v_exp_f32 v141, v141
v_mfma_f32_16x16x32_bf16 v[144:147], a[180:183], v[76:79], v[144:147]
ds_read_b128 a[160:163], v3 offset:2048
v_cvt_pk_bf16_f32 v194, v140, v141
v_mfma_f32_16x16x32_bf16 v[144:147], a[176:179], v[72:75], v[144:147]
v_exp_f32 v142, v142
v_mfma_f32_16x16x32_bf16 v[148:151], a[192:195], v[72:75], v[228:231]
ds_read_b128 a[164:167], v3 offset:10240
ds_read_b128 a[168:171], v3 offset:3072
v_mfma_f32_16x16x32_bf16 v[148:151], a[196:199], v[76:79], v[148:151]
v_cndmask_b32 v132, v224, v17, s[62:63]
v_cndmask_b32 v133, v224, v17, s[48:49]
v_cndmask_b32 v134, v224, v17, s[50:51]
v_cndmask_b32 v135, v224, v17, s[100:101]
v_exp_f32 v143, v143
v_mfma_f32_16x16x32_bf16 v[148:151], a[200:203], v[80:83], v[148:151]
ds_read_b128 a[172:175], v3 offset:11264
v_cvt_pk_bf16_f32 v195, v142, v143
v_mfma_f32_16x16x32_bf16 v[148:151], a[204:207], v[84:87], v[148:151]
v_exp_f32 v124, v124
v_mfma_f32_16x16x32_bf16 v[132:135], a[204:207], v[68:71], v[132:135]
buffer_load_dwordx4 v16, s[32:35], s64 offen offset:1024 sc1 lds
v_mfma_f32_16x16x32_bf16 v[132:135], a[200:203], v[64:67], v[132:135]
v_exp_f32 v125, v125
v_mfma_f32_16x16x32_bf16 v[132:135], a[196:199], v[60:63], v[132:135]
ds_read_b128 a[176:179], v3 offset:4096
v_cvt_pk_bf16_f32 v186, v124, v125
v_mfma_f32_16x16x32_bf16 v[132:135], a[192:195], v[56:59], v[132:135]
v_exp_f32 v126, v126
v_mfma_f32_16x16x32_bf16 a[136:139], a[244:247], v[200:203], a[136:139]
ds_read_b128 a[180:183], v3 offset:12288
ds_read_b128 a[184:187], v3 offset:5120
v_mfma_f32_16x16x32_bf16 a[136:139], a[244:247], v[204:207], a[136:139]
v_exp_f32 v127, v127
v_mfma_f32_16x16x32_bf16 a[140:143], a[244:247], v[208:211], a[140:143]
ds_read_b128 a[188:191], v3 offset:13312
v_cvt_pk_bf16_f32 v187, v126, v127
v_mfma_f32_16x16x32_bf16 a[140:143], a[244:247], v[212:215], a[140:143]
v_exp_f32 v128, v128
v_mfma_f32_16x16x32_bf16 a[64:67], a[144:147], v[200:203], a[64:67]
s_waitcnt lgkmcnt(3)
buffer_load_dwordx4 v16, s[32:35], s64 offen offset:2048 sc1 lds
v_mfma_f32_16x16x32_bf16 a[64:67], a[148:151], v[204:207], a[64:67]
v_exp_f32 v129, v129
v_mfma_f32_16x16x32_bf16 a[96:99], a[148:151], v[212:215], a[96:99]
ds_read_b128 a[192:195], v3 offset:6144
v_cvt_pk_bf16_f32 v188, v128, v129
v_mfma_f32_16x16x32_bf16 a[96:99], a[144:147], v[208:211], a[96:99]
v_exp_f32 v130, v130
v_mfma_f32_16x16x32_bf16 a[100:103], a[152:155], v[208:211], a[100:103]
ds_read_b128 a[196:199], v3 offset:14336
v_mfma_f32_16x16x32_bf16 a[100:103], a[156:159], v[212:215], a[100:103]
v_exp_f32 v131, v131
v_mfma_f32_16x16x32_bf16 a[68:71], a[156:159], v[204:207], a[68:71]
ds_read_b128 a[200:203], v3 offset:7168
v_cvt_pk_bf16_f32 v189, v130, v131
v_mfma_f32_16x16x32_bf16 a[68:71], a[152:155], v[200:203], a[68:71]
v_exp_f32 v144, v144
v_mfma_f32_16x16x32_bf16 a[72:75], a[160:163], v[200:203], a[72:75]
buffer_load_dwordx4 v16, s[32:35], s64 offen offset:3072 sc1 lds
v_mfma_f32_16x16x32_bf16 a[72:75], a[164:167], v[204:207], a[72:75]
v_exp_f32 v145, v145
v_mfma_f32_16x16x32_bf16 a[104:107], a[164:167], v[212:215], a[104:107]
ds_read_b128 a[204:207], v3 offset:15360
v_cvt_pk_bf16_f32 v196, v144, v145
v_mfma_f32_16x16x32_bf16 a[104:107], a[160:163], v[208:211], a[104:107]
v_exp_f32 v146, v146
v_mfma_f32_16x16x32_bf16 a[108:111], a[168:171], v[208:211], a[108:111]
s_waitcnt vmcnt(11)
s_barrier
v_mfma_f32_16x16x32_bf16 a[108:111], a[172:175], v[212:215], a[108:111]
v_exp_f32 v147, v147
v_mfma_f32_16x16x32_bf16 a[76:79], a[172:175], v[204:207], a[76:79]
ds_read_b128 a[144:147], v2 offset:16384
v_cvt_pk_bf16_f32 v197, v146, v147
v_mfma_f32_16x16x32_bf16 a[76:79], a[168:171], v[200:203], a[76:79]
v_exp_f32 v148, v148
v_mfma_f32_16x16x32_bf16 a[80:83], a[176:179], v[200:203], a[80:83]
s_waitcnt vmcnt(8)
v_readfirstlane_b32 s66, v19
s_nop 0
s_cmp_lt_u32 s66, 16
s_cbranch_scc1 L_spin_16
L_spinbk_17:
ds_read_b128 a[148:151], v2 offset:17408
s_waitcnt lgkmcnt(2)
v_mfma_f32_16x16x32_bf16 a[80:83], a[180:183], v[204:207], a[80:83]
v_exp_f32 v149, v149
v_mfma_f32_16x16x32_bf16 a[112:115], a[180:183], v[212:215], a[112:115]
ds_read_b128 a[152:155], v2 offset:18432
v_cvt_pk_bf16_f32 v198, v148, v149
v_mfma_f32_16x16x32_bf16 a[112:115], a[176:179], v[208:211], a[112:115]
v_exp_f32 v150, v150
v_mfma_f32_16x16x32_bf16 a[116:119], a[184:187], v[208:211], a[116:119]
v_cndmask_b32 v136, v228, v17, s[0:1]
v_cndmask_b32 v137, v228, v17, s[4:5]
v_mfma_f32_16x16x32_bf16 a[116:119], a[188:191], v[212:215], a[116:119]
v_exp_f32 v151, v151
v_mfma_f32_16x16x32_bf16 a[84:87], a[188:191], v[204:207], a[84:87]
ds_read_b128 a[156:159], v2 offset:19456
v_cvt_pk_bf16_f32 v199, v150, v151
v_mfma_f32_16x16x32_bf16 a[84:87], a[184:187], v[200:203], a[84:87]
v_exp_f32 v132, v132
v_mfma_f32_16x16x32_bf16 a[88:91], a[192:195], v[200:203], a[88:91]
ds_read_b128 a[160:163], v2 offset:20480
v_cndmask_b32 v138, v228, v17, s[6:7]
v_mfma_f32_16x16x32_bf16 a[88:91], a[196:199], v[204:207], a[88:91]
v_exp_f32 v133, v133
v_mfma_f32_16x16x32_bf16 a[120:123], a[196:199], v[212:215], a[120:123]
ds_read_b128 a[164:167], v2 offset:21504
v_cvt_pk_bf16_f32 v190, v132, v133
v_mfma_f32_16x16x32_bf16 a[120:123], a[192:195], v[208:211], a[120:123]
v_exp_f32 v134, v134
v_mfma_f32_16x16x32_bf16 a[124:127], a[200:203], v[208:211], a[124:127]
v_cndmask_b32 v139, v228, v17, s[8:9]
v_cndmask_b32 v140, v228, v17, s[10:11]
v_mfma_f32_16x16x32_bf16 a[124:127], a[204:207], v[212:215], a[124:127]
v_exp_f32 v135, v135
v_mfma_f32_16x16x32_bf16 a[92:95], a[204:207], v[204:207], a[92:95]
ds_read_b128 a[168:171], v2 offset:22528
v_cvt_pk_bf16_f32 v191, v134, v135
v_mfma_f32_16x16x32_bf16 a[92:95], a[200:203], v[200:203], a[92:95]
s_waitcnt lgkmcnt(2)
ds_read_b128 a[172:175], v2 offset:23552
v_cndmask_b32 v141, v228, v17, s[12:13]
v_mfma_f32_16x16x32_bf16 v[136:139], a[144:147], v[72:75], v[136:139]
ds_read_b128 a[176:179], v2 offset:24576
v_cndmask_b32 v142, v228, v17, s[18:19]
v_mfma_f32_16x16x32_bf16 v[136:139], a[148:151], v[76:79], v[136:139]
ds_read_b128 a[180:183], v2 offset:25600
v_cndmask_b32 v143, v228, v17, s[22:23]
v_mfma_f32_16x16x32_bf16 v[136:139], a[152:155], v[80:83], v[136:139]
ds_read_b128 a[184:187], v2 offset:26624
v_cndmask_b32 v144, v228, v17, s[26:27]
v_mfma_f32_16x16x32_bf16 v[136:139], a[156:159], v[84:87], v[136:139]
s_waitcnt lgkmcnt(3)
ds_read_b128 a[188:191], v2 offset:27648
v_cndmask_b32 v145, v228, v17, s[56:57]
v_mfma_f32_16x16x32_bf16 v[140:143], a[172:175], v[84:87], v[140:143]
ds_read_b128 a[192:195], v2 offset:28672
ds_read_b128 a[196:199], v2 offset:29696
ds_read_b128 a[200:203], v2 offset:30720
ds_read_b128 a[204:207], v2 offset:31744
v_mfma_f32_16x16x32_bf16 v[140:143], a[168:171], v[80:83], v[140:143]
ds_read_b128 a[144:147], v3 offset:16384
v_cndmask_b32 v146, v228, v17, s[58:59]
v_cndmask_b32 v147, v228, v17, s[60:61]
v_mfma_f32_16x16x32_bf16 v[140:143], a[164:167], v[76:79], v[140:143]
ds_read_b128 a[148:151], v3 offset:24576
v_cndmask_b32 v148, v228, v17, s[62:63]
v_mfma_f32_16x16x32_bf16 v[140:143], a[160:163], v[72:75], v[140:143]
s_waitcnt lgkmcnt(8)
ds_read_b128 a[152:155], v3 offset:17408
v_cndmask_b32 v149, v228, v17, s[48:49]
v_mfma_f32_16x16x32_bf16 v[144:147], a[176:179], v[72:75], v[144:147]
ds_read_b128 a[156:159], v3 offset:25600
v_cndmask_b32 v150, v228, v17, s[50:51]
v_mfma_f32_16x16x32_bf16 v[144:147], a[180:183], v[76:79], v[144:147]
s_waitcnt lgkmcnt(8)
ds_read_b128 a[160:163], v3 offset:18432
v_cndmask_b32 v151, v228, v17, s[100:101]
v_mfma_f32_16x16x32_bf16 v[144:147], a[184:187], v[80:83], v[144:147]
v_exp_f32 v136, v136
v_mfma_f32_16x16x32_bf16 v[144:147], a[188:191], v[84:87], v[144:147]
s_waitcnt lgkmcnt(4)
v_exp_f32 v137, v137
v_mfma_f32_16x16x32_bf16 v[148:151], a[204:207], v[84:87], v[148:151]
v_exp_f32 v138, v138
v_mfma_f32_16x16x32_bf16 v[148:151], a[200:203], v[80:83], v[148:151]
s_add_u32 s65, s84, 0
v_exp_f32 v139, v139
v_mfma_f32_16x16x32_bf16 v[148:151], a[196:199], v[76:79], v[148:151]
buffer_load_dwordx4 a[208:211], v14, s[44:47], s65 offen offset:0 sc1
v_mfma_f32_16x16x32_bf16 v[148:151], a[192:195], v[72:75], v[148:151]
ds_read_b128 a[164:167], v3 offset:26624
v_cvt_pk_bf16_f32 v208, v136, v137
v_mfma_f32_16x16x32_bf16 a[136:139], a[244:247], v[184:187], a[136:139]
v_exp_f32 v140, v140
v_mfma_f32_16x16x32_bf16 a[136:139], a[244:247], v[188:191], a[136:139]
buffer_load_dwordx4 a[216:219], v14, s[44:47], s65 offen offset:1024 sc1
v_mfma_f32_16x16x32_bf16 a[140:143], a[244:247], v[192:195], a[140:143]
v_exp_f32 v141, v141
v_mfma_f32_16x16x32_bf16 a[140:143], a[244:247], v[196:199], a[140:143]
ds_read_b128 a[168:171], v3 offset:19456
v_cvt_pk_bf16_f32 v209, v138, v139
v_mfma_f32_16x16x32_bf16 a[64:67], a[144:147], v[184:187], a[64:67]
s_waitcnt lgkmcnt(2)
buffer_load_dwordx4 a[224:227], v15, s[44:47], s65 offen offset:0 sc1
v_mfma_f32_16x16x32_bf16 a[64:67], a[148:151], v[188:191], a[64:67]
ds_read_b128 a[172:175], v3 offset:27648
v_cvt_pk_bf16_f32 v210, v140, v141
v_mfma_f32_16x16x32_bf16 a[96:99], a[148:151], v[196:199], a[96:99]
v_exp_f32 v142, v142
v_mfma_f32_16x16x32_bf16 a[96:99], a[144:147], v[192:195], a[96:99]
buffer_load_dwordx4 a[232:235], v15, s[44:47], s65 offen offset:1024 sc1
v_mfma_f32_16x16x32_bf16 a[100:103], a[152:155], v[192:195], a[100:103]
s_add_u32 s65, s84, 8192
ds_read_b128 a[176:179], v3 offset:20480
v_xor_b32 v2, 0x8000, v2
v_mfma_f32_16x16x32_bf16 a[100:103], a[156:159], v[196:199], a[100:103]
buffer_load_dwordx4 a[212:215], v14, s[44:47], s65 offen offset:0 sc1
v_mfma_f32_16x16x32_bf16 a[68:71], a[156:159], v[188:191], a[68:71]
v_exp_f32 v143, v143
v_mfma_f32_16x16x32_bf16 a[68:71], a[152:155], v[184:187], a[68:71]
ds_read_b128 a[180:183], v3 offset:28672
v_cvt_pk_bf16_f32 v211, v142, v143
v_mfma_f32_16x16x32_bf16 a[72:75], a[160:163], v[184:187], a[72:75]
s_waitcnt lgkmcnt(2)
buffer_load_dwordx4 a[220:223], v14, s[44:47], s65 offen offset:1024 sc1
v_mfma_f32_16x16x32_bf16 a[72:75], a[164:167], v[188:191], a[72:75]
v_exp_f32 v144, v144
v_mfma_f32_16x16x32_bf16 a[104:107], a[164:167], v[196:199], a[104:107]
ds_read_b128 a[184:187], v3 offset:21504
v_accvgpr_read_b32 v22, a136
v_mfma_f32_16x16x32_bf16 a[104:107], a[160:163], v[192:195], a[104:107]
buffer_load_dwordx4 a[228:231], v15, s[44:47], s65 offen offset:0 sc1
v_mfma_f32_16x16x32_bf16 a[108:111], a[168:171], v[192:195], a[108:111]
ds_read_b128 a[188:191], v3 offset:29696
v_max_f32 v1, v1, v22
v_mfma_f32_16x16x32_bf16 a[108:111], a[172:175], v[196:199], a[108:111]
v_exp_f32 v145, v145
v_mfma_f32_16x16x32_bf16 a[76:79], a[172:175], v[188:191], a[76:79]
buffer_load_dwordx4 a[236:239], v15, s[44:47], s65 offen offset:1024 sc1
v_mfma_f32_16x16x32_bf16 a[76:79], a[168:171], v[184:187], a[76:79]
s_waitcnt lgkmcnt(2)
v_exp_f32 v146, v146
v_mfma_f32_16x16x32_bf16 a[80:83], a[176:179], v[184:187], a[80:83]
s_add_u32 s65, s84, 32768
ds_read_b128 a[192:195], v3 offset:22528
v_cvt_pk_bf16_f32 v212, v144, v145
v_mfma_f32_16x16x32_bf16 a[80:83], a[180:183], v[188:191], a[80:83]
buffer_load_dwordx4 v[152:155], v14, s[44:47], s65 offen offset:0 sc1
ds_read_b128 a[196:199], v3 offset:30720
ds_read_b128 a[200:203], v3 offset:23552
ds_read_b128 a[204:207], v3 offset:31744
v_mfma_f32_16x16x32_bf16 a[112:115], a[180:183], v[196:199], a[112:115]
s_waitcnt vmcnt(9)
s_barrier
v_xor_b32 v3, 0x8000, v3
v_mfma_f32_16x16x32_bf16 a[112:115], a[176:179], v[192:195], a[112:115]
s_waitcnt lgkmcnt(4)
buffer_load_dwordx4 v[160:163], v14, s[44:47], s65 offen offset:1024 sc1
v_exp_f32 v147, v147
v_mfma_f32_16x16x32_bf16 a[116:119], a[184:187], v[192:195], a[116:119]
v_exp_f32 v148, v148
v_mfma_f32_16x16x32_bf16 a[116:119], a[188:191], v[196:199], a[116:119]
buffer_load_dwordx4 v[168:171], v15, s[44:47], s65 offen offset:0 sc1
v_mfma_f32_16x16x32_bf16 a[84:87], a[188:191], v[188:191], a[84:87]
v_exp_f32 v149, v149
v_mfma_f32_16x16x32_bf16 a[84:87], a[184:187], v[184:187], a[84:87]
s_waitcnt lgkmcnt(0)
buffer_load_dwordx4 v[176:179], v15, s[44:47], s65 offen offset:1024 sc1
v_mfma_f32_16x16x32_bf16 a[88:91], a[192:195], v[184:187], a[88:91]
s_add_u32 s65, s84, 40960
ds_read_b128 a[144:147], v3 offset:0
v_cvt_pk_bf16_f32 v213, v146, v147
v_mfma_f32_16x16x32_bf16 a[88:91], a[196:199], v[188:191], a[88:91]
buffer_load_dwordx4 v[156:159], v14, s[44:47], s65 offen offset:0 sc1
v_mfma_f32_16x16x32_bf16 a[120:123], a[196:199], v[196:199], a[120:123]
v_exp_f32 v150, v150
v_mfma_f32_16x16x32_bf16 a[120:123], a[192:195], v[192:195], a[120:123]
buffer_load_dwordx4 v[164:167], v14, s[44:47], s65 offen offset:1024 sc1
ds_read_b128 a[148:151], v3 offset:8192
v_mfma_f32_16x16x32_bf16 a[124:127], a[200:203], v[192:195], a[124:127]
ds_read_b128 a[152:155], v3 offset:1024
v_cvt_pk_bf16_f32 v214, v148, v149
v_mfma_f32_16x16x32_bf16 a[124:127], a[204:207], v[196:199], a[124:127]
buffer_load_dwordx4 v[172:175], v15, s[44:47], s65 offen offset:0 sc1
ds_read_b128 a[156:159], v3 offset:9216
v_mfma_f32_16x16x32_bf16 a[92:95], a[204:207], v[188:191], a[92:95]
v_exp_f32 v151, v151
v_mfma_f32_16x16x32_bf16 a[92:95], a[200:203], v[184:187], a[92:95]
buffer_load_dwordx4 v[180:183], v15, s[44:47], s65 offen offset:1024 sc1
ds_read_b128 a[160:163], v3 offset:2048
ds_read_b128 a[164:167], v3 offset:10240
ds_read_b128 a[168:171], v3 offset:3072
ds_read_b128 a[172:175], v3 offset:11264
v_cvt_pk_bf16_f32 v215, v150, v151
v_rcp_f32 v22, v22
v_accvgpr_read_b32 v232, a64
v_accvgpr_read_b32 v233, a65
v_accvgpr_read_b32 v234, a66
v_accvgpr_read_b32 v235, a67
v_accvgpr_read_b32 v236, a68
v_accvgpr_read_b32 v237, a69
v_accvgpr_read_b32 v238, a70
v_accvgpr_read_b32 v239, a71
v_mul_f32 v22, v22, v8
v_mul_f32 v232, v232, v22
v_mul_f32 v233, v233, v22
v_mul_f32 v234, v234, v22
v_mul_f32 v235, v235, v22
v_mul_f32 v236, v236, v22
v_mul_f32 v237, v237, v22
v_mul_f32 v238, v238, v22
v_mul_f32 v239, v239, v22
v_cvt_pk_bf16_f32 v232, v232, v233
v_cvt_pk_bf16_f32 v233, v234, v235
v_cvt_pk_bf16_f32 v234, v236, v237
v_cvt_pk_bf16_f32 v235, v238, v239
s_add_u32 s77, s75, 0
buffer_store_dwordx4 v[232:235], v16, s[44:47], s77 offen sc1
L_TAIL_14:
ds_read_b128 a[176:179], v3 offset:4096
ds_read_b128 a[180:183], v3 offset:12288
ds_read_b128 a[184:187], v3 offset:5120
ds_read_b128 a[188:191], v3 offset:13312
v_mfma_f32_16x16x32_bf16 a[140:143], a[244:247], v[208:211], a[140:143]
ds_read_b128 a[192:195], v3 offset:6144
ds_read_b128 a[196:199], v3 offset:14336
v_mfma_f32_16x16x32_bf16 a[140:143], a[244:247], v[212:215], a[140:143]
s_waitcnt lgkmcnt(13)
s_add_u32 m0, s86, 32768
ds_read_b128 a[200:203], v3 offset:7168
ds_read_b128 a[204:207], v3 offset:15360
v_mfma_f32_16x16x32_bf16 a[96:99], a[144:147], v[208:211], a[96:99]
s_waitcnt lgkmcnt(14)
s_add_u32 s64, s85, 262144
v_accvgpr_read_b32 v240, a72
v_accvgpr_read_b32 v241, a73
v_mfma_f32_16x16x32_bf16 a[96:99], a[148:151], v[212:215], a[96:99]
s_waitcnt lgkmcnt(12)
buffer_load_dwordx4 v12, s[36:39], s64 offen lds
v_mfma_f32_16x16x32_bf16 a[100:103], a[156:159], v[212:215], a[100:103]
s_add_u32 m0, s86, 33792
s_add_u32 s64, s85, 270336
v_accvgpr_read_b32 v242, a74
v_accvgpr_read_b32 v243, a75
v_mfma_f32_16x16x32_bf16 a[100:103], a[152:155], v[208:211], a[100:103]
s_waitcnt lgkmcnt(11)
buffer_load_dwordx4 v13, s[36:39], s64 offen lds
v_mfma_f32_16x16x32_bf16 a[104:107], a[160:163], v[208:211], a[104:107]
s_waitcnt lgkmcnt(10)
s_add_u32 m0, s86, 34816
s_add_u32 s64, s85, 278528
v_accvgpr_read_b32 v244, a76
v_accvgpr_read_b32 v245, a77
v_mfma_f32_16x16x32_bf16 a[104:107], a[164:167], v[212:215], a[104:107]
s_waitcnt lgkmcnt(8)
buffer_load_dwordx4 v12, s[36:39], s64 offen lds
v_mfma_f32_16x16x32_bf16 a[108:111], a[172:175], v[212:215], a[108:111]
s_add_u32 m0, s86, 35840
s_add_u32 s64, s85, 286720
v_accvgpr_read_b32 v246, a78
v_accvgpr_read_b32 v247, a79
v_mfma_f32_16x16x32_bf16 a[108:111], a[168:171], v[208:211], a[108:111]
s_waitcnt lgkmcnt(7)
buffer_load_dwordx4 v13, s[36:39], s64 offen lds
v_mfma_f32_16x16x32_bf16 a[112:115], a[176:179], v[208:211], a[112:115]
s_waitcnt lgkmcnt(6)
s_add_u32 m0, s86, 36864
s_add_u32 s64, s85, 294912
v_mul_f32 v240, v240, v22
v_mul_f32 v241, v241, v22
v_mfma_f32_16x16x32_bf16 a[112:115], a[180:183], v[212:215], a[112:115]
s_waitcnt lgkmcnt(4)
buffer_load_dwordx4 v12, s[36:39], s64 offen lds
v_mfma_f32_16x16x32_bf16 a[116:119], a[188:191], v[212:215], a[116:119]
s_add_u32 m0, s86, 37888
s_add_u32 s64, s85, 303104
v_mul_f32 v242, v242, v22
v_mul_f32 v243, v243, v22
v_mfma_f32_16x16x32_bf16 a[116:119], a[184:187], v[208:211], a[116:119]
s_waitcnt lgkmcnt(3)
buffer_load_dwordx4 v13, s[36:39], s64 offen lds
v_mfma_f32_16x16x32_bf16 a[120:123], a[192:195], v[208:211], a[120:123]
s_waitcnt lgkmcnt(2)
s_add_u32 m0, s86, 38912
s_add_u32 s64, s85, 311296
v_mul_f32 v244, v244, v22
v_mul_f32 v245, v245, v22
v_mfma_f32_16x16x32_bf16 a[120:123], a[196:199], v[212:215], a[120:123]
s_waitcnt lgkmcnt(0)
buffer_load_dwordx4 v12, s[36:39], s64 offen lds
v_mfma_f32_16x16x32_bf16 a[124:127], a[204:207], v[212:215], a[124:127]
s_add_u32 m0, s86, 39936
s_add_u32 s64, s85, 319488
v_mul_f32 v246, v246, v22
v_mul_f32 v247, v247, v22
v_mfma_f32_16x16x32_bf16 a[124:127], a[200:203], v[208:211], a[124:127]
buffer_load_dwordx4 v13, s[36:39], s64 offen lds
v_cvt_pk_bf16_f32 v240, v240, v241
v_cvt_pk_bf16_f32 v241, v242, v243
v_cvt_pk_bf16_f32 v242, v244, v245
v_cvt_pk_bf16_f32 v243, v246, v247
s_add_u32 s77, s75, 8192
buffer_store_dwordx4 v[240:243], v16, s[44:47], s77 offen sc1
v_accvgpr_read_b32 v23, a140
v_max_f32 v1, v1, v23
v_rcp_f32 v23, v23
s_mov_b32 s66, 0x5d800000
v_cmp_le_f32 vcc, s66, v1
s_lshl_b32 s67, s30, 2
s_cmp_lg_u64 vcc, 0
s_cselect_b32 s66, 1, 0
v_mov_b32 v248, s67
v_mov_b32 v249, s66
ds_write_b32 v248, v249
v_accvgpr_read_b32 v232, a80
v_accvgpr_read_b32 v233, a81
v_accvgpr_read_b32 v234, a82
v_accvgpr_read_b32 v235, a83
v_accvgpr_read_b32 v236, a84
v_accvgpr_read_b32 v237, a85
v_accvgpr_read_b32 v238, a86
v_accvgpr_read_b32 v239, a87
v_pk_mul_f32 v[232:233], v[232:233], v[22:23] op_sel_hi:[1,0]
v_pk_mul_f32 v[234:235], v[234:235], v[22:23] op_sel_hi:[1,0]
v_pk_mul_f32 v[236:237], v[236:237], v[22:23] op_sel_hi:[1,0]
v_pk_mul_f32 v[238:239], v[238:239], v[22:23] op_sel_hi:[1,0]
v_cvt_pk_bf16_f32 v232, v232, v233
v_cvt_pk_bf16_f32 v233, v234, v235
v_cvt_pk_bf16_f32 v234, v236, v237
v_cvt_pk_bf16_f32 v235, v238, v239
s_add_u32 s77, s75, 16384
buffer_store_dwordx4 v[232:235], v16, s[44:47], s77 offen sc1
v_accvgpr_read_b32 v240, a88
v_accvgpr_read_b32 v241, a89
v_accvgpr_read_b32 v242, a90
v_accvgpr_read_b32 v243, a91
v_accvgpr_read_b32 v244, a92
v_accvgpr_read_b32 v245, a93
v_accvgpr_read_b32 v246, a94
v_accvgpr_read_b32 v247, a95
v_pk_mul_f32 v[240:241], v[240:241], v[22:23] op_sel_hi:[1,0]
v_pk_mul_f32 v[242:243], v[242:243], v[22:23] op_sel_hi:[1,0]
v_pk_mul_f32 v[244:245], v[244:245], v[22:23] op_sel_hi:[1,0]
v_pk_mul_f32 v[246:247], v[246:247], v[22:23] op_sel_hi:[1,0]
v_cvt_pk_bf16_f32 v240, v240, v241
v_cvt_pk_bf16_f32 v241, v242, v243
v_cvt_pk_bf16_f32 v242, v244, v245
v_cvt_pk_bf16_f32 v243, v246, v247
s_add_u32 s77, s75, 24576
buffer_store_dwordx4 v[240:243], v16, s[44:47], s77 offen sc1
v_accvgpr_read_b32 v232, a96
v_accvgpr_read_b32 v233, a97
v_accvgpr_read_b32 v234, a98
v_accvgpr_read_b32 v235, a99
v_accvgpr_read_b32 v236, a100
v_accvgpr_read_b32 v237, a101
v_accvgpr_read_b32 v238, a102
v_accvgpr_read_b32 v239, a103
v_mul_f32 v23, v23, v10
v_pk_mul_f32 v[232:233], v[232:233], v[22:23] op_sel:[0,1]
v_pk_mul_f32 v[234:235], v[234:235], v[22:23] op_sel:[0,1]
v_pk_mul_f32 v[236:237], v[236:237], v[22:23] op_sel:[0,1]
v_pk_mul_f32 v[238:239], v[238:239], v[22:23] op_sel:[0,1]
v_cvt_pk_bf16_f32 v232, v232, v233
v_cvt_pk_bf16_f32 v233, v234, v235
v_cvt_pk_bf16_f32 v234, v236, v237
v_cvt_pk_bf16_f32 v235, v238, v239
s_add_u32 s77, s75, 4096
buffer_store_dwordx4 v[232:235], v16, s[44:47], s77 offen sc1
v_accvgpr_read_b32 v240, a104
v_accvgpr_read_b32 v241, a105
v_accvgpr_read_b32 v242, a106
v_accvgpr_read_b32 v243, a107
v_accvgpr_read_b32 v244, a108
v_accvgpr_read_b32 v245, a109
v_accvgpr_read_b32 v246, a110
v_accvgpr_read_b32 v247, a111
v_pk_mul_f32 v[240:241], v[240:241], v[22:23] op_sel:[0,1]
v_pk_mul_f32 v[242:243], v[242:243], v[22:23] op_sel:[0,1]
v_pk_mul_f32 v[244:245], v[244:245], v[22:23] op_sel:[0,1]
v_pk_mul_f32 v[246:247], v[246:247], v[22:23] op_sel:[0,1]
v_cvt_pk_bf16_f32 v240, v240, v241
v_cvt_pk_bf16_f32 v241, v242, v243
v_cvt_pk_bf16_f32 v242, v244, v245
v_cvt_pk_bf16_f32 v243, v246, v247
s_add_u32 s77, s75, 12288
buffer_store_dwordx4 v[240:243], v16, s[44:47], s77 offen sc1
v_accvgpr_read_b32 v232, a112
v_accvgpr_read_b32 v233, a113
v_accvgpr_read_b32 v234, a114
v_accvgpr_read_b32 v235, a115
v_accvgpr_read_b32 v236, a116
v_accvgpr_read_b32 v237, a117
v_accvgpr_read_b32 v238, a118
v_accvgpr_read_b32 v239, a119
v_pk_mul_f32 v[232:233], v[232:233], v[22:23] op_sel:[0,1]
v_pk_mul_f32 v[234:235], v[234:235], v[22:23] op_sel:[0,1]
v_pk_mul_f32 v[236:237], v[236:237], v[22:23] op_sel:[0,1]
v_pk_mul_f32 v[238:239], v[238:239], v[22:23] op_sel:[0,1]
v_cvt_pk_bf16_f32 v232, v232, v233
v_cvt_pk_bf16_f32 v233, v234, v235
v_cvt_pk_bf16_f32 v234, v236, v237
v_cvt_pk_bf16_f32 v235, v238, v239
s_add_u32 s77, s75, 20480
buffer_store_dwordx4 v[232:235], v16, s[44:47], s77 offen sc1
v_accvgpr_read_b32 v240, a120
v_accvgpr_read_b32 v241, a121
v_accvgpr_read_b32 v242, a122
v_accvgpr_read_b32 v243, a123
v_accvgpr_read_b32 v244, a124
v_accvgpr_read_b32 v245, a125
v_accvgpr_read_b32 v246, a126
v_accvgpr_read_b32 v247, a127
v_pk_mul_f32 v[240:241], v[240:241], v[22:23] op_sel:[0,1]
v_pk_mul_f32 v[242:243], v[242:243], v[22:23] op_sel:[0,1]
v_pk_mul_f32 v[244:245], v[244:245], v[22:23] op_sel:[0,1]
v_pk_mul_f32 v[246:247], v[246:247], v[22:23] op_sel:[0,1]
v_cvt_pk_bf16_f32 v240, v240, v241
v_cvt_pk_bf16_f32 v241, v242, v243
v_cvt_pk_bf16_f32 v242, v244, v245
v_cvt_pk_bf16_f32 v243, v246, v247
s_add_u32 s77, s75, 28672
buffer_store_dwordx4 v[240:243], v16, s[44:47], s77 offen sc1
v_mov_b32 v248, 0
s_waitcnt lgkmcnt(0)
s_barrier
ds_read_b128 v[248:251], v248
v_lshrrev_b32 v200, 4, v0
v_bfe_u32 v201, v0, 2, 2
v_lshl_add_u32 v202, v200, 2, v201
v_and_b32 v203, 3, v0
v_lshlrev_b32 v203, 3, v203
v_lshl_add_u32 v203, v202, 8, v203
s_and_b32 s66, s30, 1
s_lshl_b32 s66, s66, 14
s_add_u32 s66, s66, 98304
v_add_u32 v203, s66, v203
v_and_b32 v202, 7, v202
s_lshl_b32 s66, s83, 2
v_xor_b32 v202, s66, v202
v_xor_b32 v200, 4, v202
v_lshl_add_u32 v188, v200, 5, v203
v_xor_b32 v200, 5, v202
v_lshl_add_u32 v189, v200, 5, v203
v_xor_b32 v200, 6, v202
v_lshl_add_u32 v190, v200, 5, v203
v_xor_b32 v200, 7, v202
v_lshl_add_u32 v191, v200, 5, v203
v_xor_b32 v200, 0, v202
v_lshl_add_u32 v184, v200, 5, v203
v_xor_b32 v200, 1, v202
v_lshl_add_u32 v185, v200, 5, v203
v_xor_b32 v200, 2, v202
v_lshl_add_u32 v186, v200, 5, v203
v_xor_b32 v200, 3, v202
v_lshl_add_u32 v187, v200, 5, v203
s_waitcnt lgkmcnt(0)
v_or3_b32 v248, v248, v249, v250
v_or_b32 v248, v248, v251
s_nop 0
v_readfirstlane_b32 s66, v248
s_nop 0
s_cmp_gt_u32 s66, s73
s_cbranch_scc1 L_fallback_19
ds_read_b64_tr_b16 a[64:65], v188 offset:32768
ds_read_b64_tr_b16 a[66:67], v188 offset:36864
ds_read_b64_tr_b16 a[68:69], v188 offset:40960
ds_read_b64_tr_b16 a[70:71], v188 offset:45056
ds_read_b64_tr_b16 a[72:73], v189 offset:32768
ds_read_b64_tr_b16 a[74:75], v189 offset:36864
ds_read_b64_tr_b16 a[76:77], v189 offset:40960
ds_read_b64_tr_b16 a[78:79], v189 offset:45056
ds_read_b64_tr_b16 a[80:81], v190 offset:32768
ds_read_b64_tr_b16 a[82:83], v190 offset:36864
ds_read_b64_tr_b16 a[84:85], v190 offset:40960
ds_read_b64_tr_b16 a[86:87], v190 offset:45056
v_xor_b32 v192, 0x10000, v184
v_xor_b32 v193, 0x10000, v185
v_xor_b32 v194, 0x10000, v186
v_xor_b32 v195, 0x10000, v187
v_xor_b32 v196, 0x10000, v188
v_xor_b32 v197, 0x10000, v189
v_xor_b32 v198, 0x10000, v190
v_xor_b32 v199, 0x10000, v191
s_add_u32 s71, s79, 4096
s_add_u32 s72, s80, 4096
s_waitcnt lgkmcnt(10)
s_waitcnt vmcnt(28)
v_mfma_f32_16x16x32_bf16 v[136:139], a[64:67], a[232:235], 0
s_waitcnt vmcnt(24)
s_waitcnt lgkmcnt(8)
s_add_u32 m0, s86, 65536
ds_read_b64_tr_b16 a[88:89], v191 offset:32768
v_mfma_f32_16x16x32_bf16 v[136:139], a[68:71], a[236:239], v[136:139]
s_add_u32 s64, s85, 524288
ds_read_b64_tr_b16 a[90:91], v191 offset:36864
v_mfma_f32_16x16x32_bf16 v[104:107], a[68:71], a[228:231], 0
buffer_load_dwordx4 v12, s[36:39], s64 offen lds
v_mfma_f32_16x16x32_bf16 v[104:107], a[64:67], a[224:227], v[104:107]
s_add_u32 m0, s86, 66560
s_add_u32 s64, s85, 532480
ds_read_b64_tr_b16 a[92:93], v191 offset:40960
v_mfma_f32_16x16x32_bf16 v[72:75], a[64:67], a[216:219], 0
buffer_load_dwordx4 v13, s[36:39], s64 offen lds
v_mfma_f32_16x16x32_bf16 v[72:75], a[68:71], a[220:223], v[72:75]
s_add_u32 m0, s86, 67584
s_add_u32 s64, s85, 540672
ds_read_b64_tr_b16 a[94:95], v191 offset:45056
v_mfma_f32_16x16x32_bf16 v[40:43], a[68:71], a[212:215], 0
buffer_load_dwordx4 v12, s[36:39], s64 offen lds
v_mfma_f32_16x16x32_bf16 v[40:43], a[64:67], a[208:211], v[40:43]
s_waitcnt lgkmcnt(4)
s_add_u32 m0, s86, 68608
s_add_u32 s64, s85, 548864
ds_read_b64_tr_b16 a[96:97], v184 offset:32768
v_mfma_f32_16x16x32_bf16 v[44:47], a[72:75], a[208:211], 0
buffer_load_dwordx4 v13, s[36:39], s64 offen lds
v_mfma_f32_16x16x32_bf16 v[44:47], a[76:79], a[212:215], v[44:47]
s_add_u32 m0, s86, 69632
ds_read_b64_tr_b16 a[98:99], v184 offset:36864
v_mfma_f32_16x16x32_bf16 v[76:79], a[76:79], a[220:223], 0
s_add_u32 s64, s85, 557056
ds_read_b64_tr_b16 a[100:101], v184 offset:40960
v_mfma_f32_16x16x32_bf16 v[76:79], a[72:75], a[216:219], v[76:79]
buffer_load_dwordx4 v12, s[36:39], s64 offen lds
v_mfma_f32_16x16x32_bf16 v[108:111], a[72:75], a[224:227], 0
s_add_u32 m0, s86, 70656
s_add_u32 s64, s85, 565248
ds_read_b64_tr_b16 a[102:103], v184 offset:45056
v_mfma_f32_16x16x32_bf16 v[108:111], a[76:79], a[228:231], v[108:111]
buffer_load_dwordx4 v13, s[36:39], s64 offen lds
v_mfma_f32_16x16x32_bf16 v[140:143], a[76:79], a[236:239], 0
s_add_u32 m0, s86, 71680
s_add_u32 s64, s85, 573440
ds_read_b64_tr_b16 a[104:105], v185 offset:32768
v_mfma_f32_16x16x32_bf16 v[140:143], a[72:75], a[232:235], v[140:143]
buffer_load_dwordx4 v12, s[36:39], s64 offen lds
v_mfma_f32_16x16x32_bf16 v[144:147], a[80:83], a[232:235], 0
s_add_u32 m0, s86, 72704
ds_read_b64_tr_b16 a[106:107], v185 offset:36864
v_mfma_f32_16x16x32_bf16 v[144:147], a[84:87], a[236:239], v[144:147]
s_add_u32 s64, s85, 581632
ds_read_b64_tr_b16 a[108:109], v185 offset:40960
v_mfma_f32_16x16x32_bf16 v[112:115], a[84:87], a[228:231], 0
buffer_load_dwordx4 v13, s[36:39], s64 offen lds
v_mfma_f32_16x16x32_bf16 v[112:115], a[80:83], a[224:227], v[112:115]
s_add_u32 s65, s84, 65536
ds_read_b64_tr_b16 a[110:111], v185 offset:45056
v_mfma_f32_16x16x32_bf16 v[80:83], a[80:83], a[216:219], 0
buffer_load_dwordx4 a[0:3], v14, s[44:47], s65 offen offset:0 sc1
v_mfma_f32_16x16x32_bf16 v[80:83], a[84:87], a[220:223], v[80:83]
ds_read_b64_tr_b16 a[112:113], v186 offset:32768
v_mfma_f32_16x16x32_bf16 v[48:51], a[84:87], a[212:215], 0
buffer_load_dwordx4 a[8:11], v14, s[44:47], s65 offen offset:1024 sc1
v_mfma_f32_16x16x32_bf16 v[48:51], a[80:83], a[208:211], v[48:51]
s_waitcnt lgkmcnt(4)
ds_read_b64_tr_b16 a[114:115], v186 offset:36864
v_mfma_f32_16x16x32_bf16 v[52:55], a[88:91], a[208:211], 0
ds_read_b64_tr_b16 a[116:117], v186 offset:40960
v_mfma_f32_16x16x32_bf16 v[52:55], a[92:95], a[212:215], v[52:55]
buffer_load_dwordx4 a[16:19], v15, s[44:47], s65 offen offset:0 sc1
v_mfma_f32_16x16x32_bf16 v[84:87], a[92:95], a[220:223], 0
ds_read_b64_tr_b16 a[118:119], v186 offset:45056
v_mfma_f32_16x16x32_bf16 v[84:87], a[88:91], a[216:219], v[84:87]
buffer_load_dwordx4 a[24:27], v15, s[44:47], s65 offen offset:1024 sc1
v_mfma_f32_16x16x32_bf16 v[116:119], a[88:91], a[224:227], 0
s_add_u32 s65, s84, 73728
ds_read_b64_tr_b16 a[120:121], v187 offset:32768
v_mfma_f32_16x16x32_bf16 v[116:119], a[92:95], a[228:231], v[116:119]
buffer_load_dwordx4 a[4:7], v14, s[44:47], s65 offen offset:0 sc1
v_mfma_f32_16x16x32_bf16 v[148:151], a[92:95], a[236:239], 0
ds_read_b64_tr_b16 a[122:123], v187 offset:36864
v_mfma_f32_16x16x32_bf16 v[148:151], a[88:91], a[232:235], v[148:151]
ds_read_b64_tr_b16 a[124:125], v187 offset:40960
v_mfma_f32_16x16x32_bf16 v[120:123], a[96:99], a[232:235], 0
buffer_load_dwordx4 a[12:15], v14, s[44:47], s65 offen offset:1024 sc1
v_mfma_f32_16x16x32_bf16 v[120:123], a[100:103], a[236:239], v[120:123]
ds_read_b64_tr_b16 a[126:127], v187 offset:45056
v_mfma_f32_16x16x32_bf16 v[88:91], a[100:103], a[228:231], 0
buffer_load_dwordx4 a[20:23], v15, s[44:47], s65 offen offset:0 sc1
v_mfma_f32_16x16x32_bf16 v[88:91], a[96:99], a[224:227], v[88:91]
v_mfma_f32_16x16x32_bf16 v[56:59], a[96:99], a[216:219], 0
buffer_load_dwordx4 a[28:31], v15, s[44:47], s65 offen offset:1024 sc1
v_mfma_f32_16x16x32_bf16 v[56:59], a[100:103], a[220:223], v[56:59]
v_mfma_f32_16x16x32_bf16 v[24:27], a[100:103], a[212:215], 0
v_mfma_f32_16x16x32_bf16 v[24:27], a[96:99], a[208:211], v[24:27]
s_waitcnt lgkmcnt(1)
v_mfma_f32_16x16x32_bf16 v[28:31], a[104:107], a[208:211], 0
s_waitcnt vmcnt(23)
s_barrier
v_mfma_f32_16x16x32_bf16 v[28:31], a[108:111], a[212:215], v[28:31]
ds_read_b64_tr_b16 a[64:65], v196 offset:0
v_mfma_f32_16x16x32_bf16 v[60:63], a[108:111], a[220:223], 0
s_add_u32 m0, s86, 98304
ds_read_b64_tr_b16 a[66:67], v196 offset:4096
v_mfma_f32_16x16x32_bf16 v[60:63], a[104:107], a[216:219], v[60:63]
s_add_u32 s64, s85, 786432
ds_read_b64_tr_b16 a[68:69], v196 offset:8192
v_mfma_f32_16x16x32_bf16 v[92:95], a[104:107], a[224:227], 0
buffer_load_dwordx4 v12, s[36:39], s64 offen lds
v_mfma_f32_16x16x32_bf16 v[92:95], a[108:111], a[228:231], v[92:95]
ds_read_b64_tr_b16 a[70:71], v196 offset:12288
v_mfma_f32_16x16x32_bf16 v[124:127], a[108:111], a[236:239], 0
s_add_u32 m0, s86, 99328
ds_read_b64_tr_b16 a[72:73], v197 offset:0
v_mfma_f32_16x16x32_bf16 v[124:127], a[104:107], a[232:235], v[124:127]
s_add_u32 s64, s85, 794624
ds_read_b64_tr_b16 a[74:75], v197 offset:4096
v_mfma_f32_16x16x32_bf16 v[128:131], a[112:115], a[232:235], 0
buffer_load_dwordx4 v13, s[36:39], s64 offen lds
v_mfma_f32_16x16x32_bf16 v[128:131], a[116:119], a[236:239], v[128:131]
ds_read_b64_tr_b16 a[76:77], v197 offset:8192
v_mfma_f32_16x16x32_bf16 v[96:99], a[116:119], a[228:231], 0
s_add_u32 m0, s86, 100352
ds_read_b64_tr_b16 a[78:79], v197 offset:12288
v_mfma_f32_16x16x32_bf16 v[96:99], a[112:115], a[224:227], v[96:99]
s_add_u32 s64, s85, 802816
ds_read_b64_tr_b16 a[80:81], v198 offset:0
v_mfma_f32_16x16x32_bf16 v[64:67], a[112:115], a[216:219], 0
buffer_load_dwordx4 v12, s[36:39], s64 offen lds
v_mfma_f32_16x16x32_bf16 v[64:67], a[116:119], a[220:223], v[64:67]
ds_read_b64_tr_b16 a[82:83], v198 offset:4096
v_mfma_f32_16x16x32_bf16 v[32:35], a[116:119], a[212:215], 0
s_add_u32 m0, s86, 101376
ds_read_b64_tr_b16 a[84:85], v198 offset:8192
v_mfma_f32_16x16x32_bf16 v[32:35], a[112:115], a[208:211], v[32:35]
s_add_u32 s64, s85, 811008
ds_read_b64_tr_b16 a[86:87], v198 offset:12288
v_mfma_f32_16x16x32_bf16 v[36:39], a[120:123], a[208:211], 0
s_waitcnt lgkmcnt(6)
buffer_load_dwordx4 v13, s[36:39], s64 offen lds
v_mfma_f32_16x16x32_bf16 v[36:39], a[124:127], a[212:215], v[36:39]
v_mfma_f32_16x16x32_bf16 v[68:71], a[124:127], a[220:223], 0
s_add_u32 m0, s86, 102400
v_mfma_f32_16x16x32_bf16 v[68:71], a[120:123], a[216:219], v[68:71]
s_add_u32 s64, s85, 819200
v_mfma_f32_16x16x32_bf16 v[100:103], a[120:123], a[224:227], 0
buffer_load_dwordx4 v12, s[36:39], s64 offen lds
v_mfma_f32_16x16x32_bf16 v[100:103], a[124:127], a[228:231], v[100:103]
v_mfma_f32_16x16x32_bf16 v[132:135], a[124:127], a[236:239], 0
v_mfma_f32_16x16x32_bf16 v[132:135], a[120:123], a[232:235], v[132:135]
v_mfma_f32_16x16x32_bf16 v[136:139], a[64:67], v[176:179], v[136:139]
s_add_u32 m0, s86, 103424
ds_read_b64_tr_b16 a[88:89], v199 offset:0
v_mfma_f32_16x16x32_bf16 v[136:139], a[68:71], v[180:183], v[136:139]
s_add_u32 s64, s85, 827392
ds_read_b64_tr_b16 a[90:91], v199 offset:4096
v_mfma_f32_16x16x32_bf16 v[104:107], a[68:71], v[172:175], v[104:107]
buffer_load_dwordx4 v13, s[36:39], s64 offen lds
v_mfma_f32_16x16x32_bf16 v[104:107], a[64:67], v[168:171], v[104:107]
s_add_u32 m0, s86, 104448
ds_read_b64_tr_b16 a[92:93], v199 offset:8192
v_mfma_f32_16x16x32_bf16 v[72:75], a[64:67], v[160:163], v[72:75]
s_add_u32 s64, s85, 835584
ds_read_b64_tr_b16 a[94:95], v199 offset:12288
v_mfma_f32_16x16x32_bf16 v[72:75], a[68:71], v[164:167], v[72:75]
buffer_load_dwordx4 v12, s[36:39], s64 offen lds
v_mfma_f32_16x16x32_bf16 v[40:43], a[68:71], v[156:159], v[40:43]
s_add_u32 m0, s86, 105472
ds_read_b64_tr_b16 a[96:97], v192 offset:0
v_mfma_f32_16x16x32_bf16 v[40:43], a[64:67], v[152:155], v[40:43]
s_add_u32 s64, s85, 843776
ds_read_b64_tr_b16 a[98:99], v192 offset:4096
v_mfma_f32_16x16x32_bf16 v[44:47], a[72:75], v[152:155], v[44:47]
s_waitcnt lgkmcnt(5)
buffer_load_dwordx4 v13, s[36:39], s64 offen lds
v_mfma_f32_16x16x32_bf16 v[44:47], a[76:79], v[156:159], v[44:47]
ds_read_b64_tr_b16 a[100:101], v192 offset:8192
v_mfma_f32_16x16x32_bf16 v[76:79], a[76:79], v[164:167], v[76:79]
ds_read_b64_tr_b16 a[102:103], v192 offset:12288
v_mfma_f32_16x16x32_bf16 v[76:79], a[72:75], v[160:163], v[76:79]
s_add_u32 s65, s84, 98304
ds_read_b64_tr_b16 a[104:105], v193 offset:0
v_mfma_f32_16x16x32_bf16 v[108:111], a[72:75], v[168:171], v[108:111]
buffer_load_dwordx4 a[32:35], v14, s[44:47], s65 offen offset:0 sc1
v_mfma_f32_16x16x32_bf16 v[108:111], a[76:79], v[172:175], v[108:111]
ds_read_b64_tr_b16 a[106:107], v193 offset:4096
v_mfma_f32_16x16x32_bf16 v[140:143], a[76:79], v[180:183], v[140:143]
ds_read_b64_tr_b16 a[108:109], v193 offset:8192
v_mfma_f32_16x16x32_bf16 v[140:143], a[72:75], v[176:179], v[140:143]
buffer_load_dwordx4 a[40:43], v14, s[44:47], s65 offen offset:1024 sc1
v_mfma_f32_16x16x32_bf16 v[144:147], a[80:83], v[176:179], v[144:147]
ds_read_b64_tr_b16 a[110:111], v193 offset:12288
v_mfma_f32_16x16x32_bf16 v[144:147], a[84:87], v[180:183], v[144:147]
v_mfma_f32_16x16x32_bf16 v[112:115], a[84:87], v[172:175], v[112:115]
buffer_load_dwordx4 a[48:51], v15, s[44:47], s65 offen offset:0 sc1
v_mfma_f32_16x16x32_bf16 v[112:115], a[80:83], v[168:171], v[112:115]
ds_read_b64_tr_b16 a[112:113], v194 offset:0
v_mfma_f32_16x16x32_bf16 v[80:83], a[80:83], v[160:163], v[80:83]
ds_read_b64_tr_b16 a[114:115], v194 offset:4096
v_mfma_f32_16x16x32_bf16 v[80:83], a[84:87], v[164:167], v[80:83]
ds_read_b64_tr_b16 a[116:117], v194 offset:8192
v_mfma_f32_16x16x32_bf16 v[48:51], a[84:87], v[156:159], v[48:51]
buffer_load_dwordx4 a[56:59], v15, s[44:47], s65 offen offset:1024 sc1
v_mfma_f32_16x16x32_bf16 v[48:51], a[80:83], v[152:155], v[48:51]
s_waitcnt lgkmcnt(4)
ds_read_b64_tr_b16 a[118:119], v194 offset:12288
v_mfma_f32_16x16x32_bf16 v[52:55], a[88:91], v[152:155], v[52:55]
s_add_u32 s65, s84, 106496
v_mfma_f32_16x16x32_bf16 v[52:55], a[92:95], v[156:159], v[52:55]
buffer_load_dwordx4 a[36:39], v14, s[44:47], s65 offen offset:0 sc1
v_mfma_f32_16x16x32_bf16 v[84:87], a[92:95], v[164:167], v[84:87]
ds_read_b64_tr_b16 a[120:121], v195 offset:0
v_mfma_f32_16x16x32_bf16 v[84:87], a[88:91], v[160:163], v[84:87]
ds_read_b64_tr_b16 a[122:123], v195 offset:4096
v_mfma_f32_16x16x32_bf16 v[116:119], a[88:91], v[168:171], v[116:119]
s_lshl_b32 s66, s30, 30
buffer_load_dwordx4 a[44:47], v14, s[44:47], s65 offen offset:1024 sc1
v_mfma_f32_16x16x32_bf16 v[116:119], a[92:95], v[172:175], v[116:119]
ds_read_b64_tr_b16 a[124:125], v195 offset:8192
v_lshl_add_u32 v1, v0, 24, s66
v_mfma_f32_16x16x32_bf16 v[148:151], a[92:95], v[180:183], v[148:151]
ds_read_b64_tr_b16 a[126:127], v195 offset:12288
v_mfma_f32_16x16x32_bf16 v[148:151], a[88:91], v[176:179], v[148:151]
v_mfma_f32_16x16x32_bf16 v[120:123], a[96:99], v[176:179], v[120:123]
buffer_load_dwordx4 a[52:55], v15, s[44:47], s65 offen offset:0 sc1
v_mfma_f32_16x16x32_bf16 v[120:123], a[100:103], v[180:183], v[120:123]
v_mfma_f32_16x16x32_bf16 v[88:91], a[100:103], v[172:175], v[88:91]
v_mfma_f32_16x16x32_bf16 v[88:91], a[96:99], v[168:171], v[88:91]
buffer_load_dwordx4 a[60:63], v15, s[44:47], s65 offen offset:1024 sc1
v_mfma_f32_16x16x32_bf16 v[56:59], a[96:99], v[160:163], v[56:59]
v_mfma_f32_16x16x32_bf16 v[56:59], a[100:103], v[164:167], v[56:59]
v_mfma_f32_16x16x32_bf16 v[24:27], a[100:103], v[156:159], v[24:27]
v_mfma_f32_16x16x32_bf16 v[24:27], a[96:99], v[152:155], v[24:27]
v_mfma_f32_16x16x32_bf16 v[28:31], a[104:107], v[152:155], v[28:31]
s_waitcnt vmcnt(24)
s_barrier
s_waitcnt lgkmcnt(0)
v_mfma_f32_16x16x32_bf16 v[28:31], a[108:111], v[156:159], v[28:31]
s_mul_i32 s66, s83, 3145728
s_add_u32 s85, s85, s66
v_mfma_f32_16x16x32_bf16 v[60:63], a[108:111], v[164:167], v[60:63]
s_mov_b64 exec, 1
buffer_atomic_add a251, v1, s[52:55], s71 offen offset:0 sc1
s_mov_b64 exec, -1
v_mfma_f32_16x16x32_bf16 v[60:63], a[104:107], v[160:163], v[60:63]
s_add_u32 m0, s86, 131072
s_add_u32 s64, s85, 0
ds_read_b64_tr_b16 a[64:65], v196 offset:32768
v_mfma_f32_16x16x32_bf16 v[92:95], a[104:107], v[168:171], v[92:95]
buffer_load_dwordx4 v12, s[40:43], s64 offen lds
v_mfma_f32_16x16x32_bf16 v[92:95], a[108:111], v[172:175], v[92:95]
ds_read_b64_tr_b16 a[66:67], v196 offset:36864
v_mfma_f32_16x16x32_bf16 v[124:127], a[108:111], v[180:183], v[124:127]
s_add_u32 m0, s86, 132096
ds_read_b64_tr_b16 a[68:69], v196 offset:40960
v_mfma_f32_16x16x32_bf16 v[124:127], a[104:107], v[176:179], v[124:127]
s_add_u32 s64, s85, 8192
ds_read_b64_tr_b16 a[70:71], v196 offset:45056
v_mfma_f32_16x16x32_bf16 v[128:131], a[112:115], v[176:179], v[128:131]
buffer_load_dwordx4 v13, s[40:43], s64 offen lds
v_mfma_f32_16x16x32_bf16 v[128:131], a[116:119], v[180:183], v[128:131]
ds_read_b64_tr_b16 a[72:73], v197 offset:32768
v_mfma_f32_16x16x32_bf16 v[96:99], a[116:119], v[172:175], v[96:99]
s_add_u32 m0, s86, 133120
ds_read_b64_tr_b16 a[74:75], v197 offset:36864
v_mfma_f32_16x16x32_bf16 v[96:99], a[112:115], v[168:171], v[96:99]
s_add_u32 s64, s85, 16384
ds_read_b64_tr_b16 a[76:77], v197 offset:40960
v_mfma_f32_16x16x32_bf16 v[64:67], a[112:115], v[160:163], v[64:67]
buffer_load_dwordx4 v12, s[40:43], s64 offen lds
v_mfma_f32_16x16x32_bf16 v[64:67], a[116:119], v[164:167], v[64:67]
ds_read_b64_tr_b16 a[78:79], v197 offset:45056
v_mfma_f32_16x16x32_bf16 v[32:35], a[116:119], v[156:159], v[32:35]
s_add_u32 m0, s86, 134144
ds_read_b64_tr_b16 a[80:81], v198 offset:32768
v_mfma_f32_16x16x32_bf16 v[32:35], a[112:115], v[152:155], v[32:35]
s_add_u32 s64, s85, 24576
ds_read_b64_tr_b16 a[82:83], v198 offset:36864
v_mfma_f32_16x16x32_bf16 v[36:39], a[120:123], v[152:155], v[36:39]
buffer_load_dwordx4 v13, s[40:43], s64 offen lds
v_mfma_f32_16x16x32_bf16 v[36:39], a[124:127], v[156:159], v[36:39]
ds_read_b64_tr_b16 a[84:85], v198 offset:40960
v_mfma_f32_16x16x32_bf16 v[68:71], a[124:127], v[164:167], v[68:71]
s_add_u32 m0, s86, 135168
ds_read_b64_tr_b16 a[86:87], v198 offset:45056
v_mfma_f32_16x16x32_bf16 v[68:71], a[120:123], v[160:163], v[68:71]
s_add_u32 s64, s85, 32768
v_mfma_f32_16x16x32_bf16 v[100:103], a[120:123], v[168:171], v[100:103]
buffer_load_dwordx4 v12, s[40:43], s64 offen lds
v_mfma_f32_16x16x32_bf16 v[100:103], a[124:127], v[172:175], v[100:103]
v_mfma_f32_16x16x32_bf16 v[132:135], a[124:127], v[180:183], v[132:135]
v_mfma_f32_16x16x32_bf16 v[132:135], a[120:123], v[176:179], v[132:135]
s_waitcnt vmcnt(26)
s_waitcnt lgkmcnt(2)
v_mfma_f32_16x16x32_bf16 v[136:139], a[64:67], a[24:27], v[136:139]
s_waitcnt vmcnt(22)
s_add_u32 m0, s86, 136192
ds_read_b64_tr_b16 a[88:89], v199 offset:32768
v_mfma_f32_16x16x32_bf16 v[136:139], a[68:71], a[28:31], v[136:139]
s_add_u32 s64, s85, 40960
ds_read_b64_tr_b16 a[90:91], v199 offset:36864
v_mfma_f32_16x16x32_bf16 v[104:107], a[68:71], a[20:23], v[104:107]
buffer_load_dwordx4 v13, s[40:43], s64 offen lds
v_mfma_f32_16x16x32_bf16 v[104:107], a[64:67], a[16:19], v[104:107]
s_add_u32 m0, s86, 137216
ds_read_b64_tr_b16 a[92:93], v199 offset:40960
v_mfma_f32_16x16x32_bf16 v[72:75], a[64:67], a[8:11], v[72:75]
s_add_u32 s64, s85, 49152
ds_read_b64_tr_b16 a[94:95], v199 offset:45056
v_mfma_f32_16x16x32_bf16 v[72:75], a[68:71], a[12:15], v[72:75]
buffer_load_dwordx4 v12, s[40:43], s64 offen lds
v_mfma_f32_16x16x32_bf16 v[40:43], a[68:71], a[4:7], v[40:43]
s_add_u32 m0, s86, 138240
ds_read_b64_tr_b16 a[96:97], v192 offset:32768
v_mfma_f32_16x16x32_bf16 v[40:43], a[64:67], a[0:3], v[40:43]
s_add_u32 s64, s85, 57344
ds_read_b64_tr_b16 a[98:99], v192 offset:36864
v_mfma_f32_16x16x32_bf16 v[44:47], a[72:75], a[0:3], v[44:47]
buffer_load_dwordx4 v13, s[40:43], s64 offen lds
v_mfma_f32_16x16x32_bf16 v[44:47], a[76:79], a[4:7], v[44:47]
ds_read_b64_tr_b16 a[100:101], v192 offset:40960
v_mfma_f32_16x16x32_bf16 v[76:79], a[76:79], a[12:15], v[76:79]
ds_read_b64_tr_b16 a[102:103], v192 offset:45056
v_mfma_f32_16x16x32_bf16 v[76:79], a[72:75], a[8:11], v[76:79]
ds_read_b64_tr_b16 a[104:105], v193 offset:32768
v_mfma_f32_16x16x32_bf16 v[108:111], a[72:75], a[16:19], v[108:111]
ds_read_b64_tr_b16 a[106:107], v193 offset:36864
v_mfma_f32_16x16x32_bf16 v[108:111], a[76:79], a[20:23], v[108:111]
ds_read_b64_tr_b16 a[108:109], v193 offset:40960
v_mfma_f32_16x16x32_bf16 v[140:143], a[76:79], a[28:31], v[140:143]
s_add_u32 s17, s78, .-L_pc+2048
ds_read_b64_tr_b16 a[110:111], v193 offset:45056
v_mfma_f32_16x16x32_bf16 v[140:143], a[72:75], a[24:27], v[140:143]
buffer_load_dword a252, v16, s[88:91], s17 offen
v_mfma_f32_16x16x32_bf16 v[144:147], a[80:83], a[24:27], v[144:147]
s_waitcnt lgkmcnt(6)
v_mfma_f32_16x16x32_bf16 v[144:147], a[84:87], a[28:31], v[144:147]
s_add_u32 s17, s78, .-L_pc+6144
v_mfma_f32_16x16x32_bf16 v[112:115], a[84:87], a[20:23], v[112:115]
buffer_load_dword a252, v16, s[88:91], s17 offen
v_mfma_f32_16x16x32_bf16 v[112:115], a[80:83], a[16:19], v[112:115]
ds_read_b64_tr_b16 a[112:113], v194 offset:32768
v_mfma_f32_16x16x32_bf16 v[80:83], a[80:83], a[8:11], v[80:83]
s_add_u32 s17, s78, .-L_pc+10240
ds_read_b64_tr_b16 a[114:115], v194 offset:36864
v_mfma_f32_16x16x32_bf16 v[80:83], a[84:87], a[12:15], v[80:83]
buffer_load_dword a252, v16, s[88:91], s17 offen
v_mfma_f32_16x16x32_bf16 v[48:51], a[84:87], a[4:7], v[48:51]
ds_read_b64_tr_b16 a[116:117], v194 offset:40960
v_mfma_f32_16x16x32_bf16 v[48:51], a[80:83], a[0:3], v[48:51]
ds_read_b64_tr_b16 a[118:119], v194 offset:45056
v_mfma_f32_16x16x32_bf16 v[52:55], a[88:91], a[0:3], v[52:55]
buffer_load_dword v19, off, s[52:55], s72 sc1
v_mfma_f32_16x16x32_bf16 v[52:55], a[92:95], a[4:7], v[52:55]
v_mfma_f32_16x16x32_bf16 v[84:87], a[92:95], a[12:15], v[84:87]
ds_read_b64_tr_b16 a[120:121], v195 offset:32768
v_mfma_f32_16x16x32_bf16 v[84:87], a[88:91], a[8:11], v[84:87]
ds_read_b64_tr_b16 a[122:123], v195 offset:36864
v_mfma_f32_16x16x32_bf16 v[116:119], a[88:91], a[16:19], v[116:119]
ds_read_b64_tr_b16 a[124:125], v195 offset:40960
v_mfma_f32_16x16x32_bf16 v[116:119], a[92:95], a[20:23], v[116:119]
ds_read_b64_tr_b16 a[126:127], v195 offset:45056
v_mfma_f32_16x16x32_bf16 v[148:151], a[92:95], a[28:31], v[148:151]
v_mfma_f32_16x16x32_bf16 v[148:151], a[88:91], a[24:27], v[148:151]
v_mfma_f32_16x16x32_bf16 v[120:123], a[96:99], a[24:27], v[120:123]
s_waitcnt lgkmcnt(4)
v_mfma_f32_16x16x32_bf16 v[120:123], a[100:103], a[28:31], v[120:123]
v_mfma_f32_16x16x32_bf16 v[88:91], a[100:103], a[20:23], v[88:91]
v_mfma_f32_16x16x32_bf16 v[88:91], a[96:99], a[16:19], v[88:91]
v_mfma_f32_16x16x32_bf16 v[56:59], a[96:99], a[8:11], v[56:59]
v_mfma_f32_16x16x32_bf16 v[56:59], a[100:103], a[12:15], v[56:59]
v_mfma_f32_16x16x32_bf16 v[24:27], a[100:103], a[4:7], v[24:27]
v_mfma_f32_16x16x32_bf16 v[24:27], a[96:99], a[0:3], v[24:27]
v_mfma_f32_16x16x32_bf16 v[28:31], a[104:107], a[0:3], v[28:31]
s_waitcnt vmcnt(21)
s_barrier
v_mfma_f32_16x16x32_bf16 v[28:31], a[108:111], a[4:7], v[28:31]
ds_read_b64_tr_b16 a[64:65], v188 offset:0
v_mfma_f32_16x16x32_bf16 v[60:63], a[108:111], a[12:15], v[60:63]
s_add_u32 m0, s86, 32768
ds_read_b64_tr_b16 a[66:67], v188 offset:4096
v_mfma_f32_16x16x32_bf16 v[60:63], a[104:107], a[8:11], v[60:63]
s_add_u32 s64, s85, 262144
ds_read_b64_tr_b16 a[68:69], v188 offset:8192
v_mfma_f32_16x16x32_bf16 v[92:95], a[104:107], a[16:19], v[92:95]
buffer_load_dwordx4 v12, s[40:43], s64 offen lds
v_mfma_f32_16x16x32_bf16 v[92:95], a[108:111], a[20:23], v[92:95]
ds_read_b64_tr_b16 a[70:71], v188 offset:12288
v_mfma_f32_16x16x32_bf16 v[124:127], a[108:111], a[28:31], v[124:127]
s_add_u32 m0, s86, 33792
ds_read_b64_tr_b16 a[72:73], v189 offset:0
v_mfma_f32_16x16x32_bf16 v[124:127], a[104:107], a[24:27], v[124:127]
s_add_u32 s64, s85, 270336
ds_read_b64_tr_b16 a[74:75], v189 offset:4096
v_mfma_f32_16x16x32_bf16 v[128:131], a[112:115], a[24:27], v[128:131]
buffer_load_dwordx4 v13, s[40:43], s64 offen lds
v_mfma_f32_16x16x32_bf16 v[128:131], a[116:119], a[28:31], v[128:131]
ds_read_b64_tr_b16 a[76:77], v189 offset:8192
v_mfma_f32_16x16x32_bf16 v[96:99], a[116:119], a[20:23], v[96:99]
s_add_u32 m0, s86, 34816
ds_read_b64_tr_b16 a[78:79], v189 offset:12288
v_mfma_f32_16x16x32_bf16 v[96:99], a[112:115], a[16:19], v[96:99]
s_add_u32 s64, s85, 278528
ds_read_b64_tr_b16 a[80:81], v190 offset:0
v_mfma_f32_16x16x32_bf16 v[64:67], a[112:115], a[8:11], v[64:67]
buffer_load_dwordx4 v12, s[40:43], s64 offen lds
v_mfma_f32_16x16x32_bf16 v[64:67], a[116:119], a[12:15], v[64:67]
ds_read_b64_tr_b16 a[82:83], v190 offset:4096
v_mfma_f32_16x16x32_bf16 v[32:35], a[116:119], a[4:7], v[32:35]
s_add_u32 m0, s86, 35840
ds_read_b64_tr_b16 a[84:85], v190 offset:8192
v_mfma_f32_16x16x32_bf16 v[32:35], a[112:115], a[0:3], v[32:35]
s_waitcnt lgkmcnt(5)
s_add_u32 s64, s85, 286720
ds_read_b64_tr_b16 a[86:87], v190 offset:12288
v_mfma_f32_16x16x32_bf16 v[36:39], a[120:123], a[0:3], v[36:39]
buffer_load_dwordx4 v13, s[40:43], s64 offen lds
v_mfma_f32_16x16x32_bf16 v[36:39], a[124:127], a[4:7], v[36:39]
v_mfma_f32_16x16x32_bf16 v[68:71], a[124:127], a[12:15], v[68:71]
s_add_u32 m0, s86, 36864
v_mfma_f32_16x16x32_bf16 v[68:71], a[120:123], a[8:11], v[68:71]
s_add_u32 s64, s85, 294912
v_mfma_f32_16x16x32_bf16 v[100:103], a[120:123], a[16:19], v[100:103]
buffer_load_dwordx4 v12, s[40:43], s64 offen lds
v_mfma_f32_16x16x32_bf16 v[100:103], a[124:127], a[20:23], v[100:103]
v_mfma_f32_16x16x32_bf16 v[132:135], a[124:127], a[28:31], v[132:135]
v_mfma_f32_16x16x32_bf16 v[132:135], a[120:123], a[24:27], v[132:135]
s_waitcnt vmcnt(22)
v_mfma_f32_16x16x32_bf16 v[136:139], a[64:67], a[56:59], v[136:139]
s_waitcnt vmcnt(5)
v_readfirstlane_b32 s66, v19
s_nop 0
s_cmp_lt_u32 s66, 16
s_cbranch_scc1 L_spin_2024
L_spinbk_2025:
s_mul_i32 s66, s83, 393216
s_add_u32 s84, s84, s66
s_sub_u32 s84, s84, 1048576
v_mfma_f32_16x16x32_bf16 v[136:139], a[68:71], a[60:63], v[136:139]
s_add_u32 s65, s84, 0
ds_read_b64_tr_b16 a[88:89], v191 offset:0
v_mfma_f32_16x16x32_bf16 v[104:107], a[68:71], a[52:55], v[104:107]
buffer_load_dwordx4 a[208:211], v14, s[44:47], s65 offen offset:0 sc1
v_mfma_f32_16x16x32_bf16 v[104:107], a[64:67], a[48:51], v[104:107]
ds_read_b64_tr_b16 a[90:91], v191 offset:4096
v_mfma_f32_16x16x32_bf16 v[72:75], a[64:67], a[40:43], v[72:75]
buffer_load_dwordx4 a[216:219], v14, s[44:47], s65 offen offset:1024 sc1
v_mfma_f32_16x16x32_bf16 v[72:75], a[68:71], a[44:47], v[72:75]
ds_read_b64_tr_b16 a[92:93], v191 offset:8192
v_mfma_f32_16x16x32_bf16 v[40:43], a[68:71], a[36:39], v[40:43]
buffer_load_dwordx4 a[224:227], v15, s[44:47], s65 offen offset:0 sc1
v_mfma_f32_16x16x32_bf16 v[40:43], a[64:67], a[32:35], v[40:43]
ds_read_b64_tr_b16 a[94:95], v191 offset:12288
v_mfma_f32_16x16x32_bf16 v[44:47], a[72:75], a[32:35], v[44:47]
s_waitcnt lgkmcnt(4)
buffer_load_dwordx4 a[232:235], v15, s[44:47], s65 offen offset:1024 sc1
v_mfma_f32_16x16x32_bf16 v[44:47], a[76:79], a[36:39], v[44:47]
s_add_u32 s65, s84, 8192
ds_read_b64_tr_b16 a[96:97], v184 offset:0
v_mfma_f32_16x16x32_bf16 v[76:79], a[76:79], a[44:47], v[76:79]
buffer_load_dwordx4 a[212:215], v14, s[44:47], s65 offen offset:0 sc1
v_mfma_f32_16x16x32_bf16 v[76:79], a[72:75], a[40:43], v[76:79]
ds_read_b64_tr_b16 a[98:99], v184 offset:4096
v_mfma_f32_16x16x32_bf16 v[108:111], a[72:75], a[48:51], v[108:111]
buffer_load_dwordx4 a[220:223], v14, s[44:47], s65 offen offset:1024 sc1
v_mfma_f32_16x16x32_bf16 v[108:111], a[76:79], a[52:55], v[108:111]
ds_read_b64_tr_b16 a[100:101], v184 offset:8192
v_mfma_f32_16x16x32_bf16 v[140:143], a[76:79], a[60:63], v[140:143]
buffer_load_dwordx4 a[228:231], v15, s[44:47], s65 offen offset:0 sc1
v_mfma_f32_16x16x32_bf16 v[140:143], a[72:75], a[56:59], v[140:143]
ds_read_b64_tr_b16 a[102:103], v184 offset:12288
v_mfma_f32_16x16x32_bf16 v[144:147], a[80:83], a[56:59], v[144:147]
buffer_load_dwordx4 a[236:239], v15, s[44:47], s65 offen offset:1024 sc1
v_mfma_f32_16x16x32_bf16 v[144:147], a[84:87], a[60:63], v[144:147]
s_add_u32 m0, s86, 37888
s_add_u32 s64, s85, 303104
ds_read_b64_tr_b16 a[104:105], v185 offset:0
v_mfma_f32_16x16x32_bf16 v[112:115], a[84:87], a[52:55], v[112:115]
buffer_load_dwordx4 v13, s[40:43], s64 offen lds
v_mfma_f32_16x16x32_bf16 v[112:115], a[80:83], a[48:51], v[112:115]
s_add_u32 m0, s86, 38912
s_add_u32 s64, s85, 311296
ds_read_b64_tr_b16 a[106:107], v185 offset:4096
v_mfma_f32_16x16x32_bf16 v[80:83], a[80:83], a[40:43], v[80:83]
buffer_load_dwordx4 v12, s[40:43], s64 offen lds
v_mfma_f32_16x16x32_bf16 v[80:83], a[84:87], a[44:47], v[80:83]
s_add_u32 m0, s86, 39936
s_add_u32 s64, s85, 319488
ds_read_b64_tr_b16 a[108:109], v185 offset:8192
v_mfma_f32_16x16x32_bf16 v[48:51], a[84:87], a[36:39], v[48:51]
buffer_load_dwordx4 v13, s[40:43], s64 offen lds
v_mfma_f32_16x16x32_bf16 v[48:51], a[80:83], a[32:35], v[48:51]
s_waitcnt lgkmcnt(3)
s_add_u32 s65, s84, 32768
ds_read_b64_tr_b16 a[110:111], v185 offset:12288
v_mfma_f32_16x16x32_bf16 v[52:55], a[88:91], a[32:35], v[52:55]
buffer_load_dwordx4 v[152:155], v14, s[44:47], s65 offen offset:0 sc1
v_mfma_f32_16x16x32_bf16 v[52:55], a[92:95], a[36:39], v[52:55]
ds_read_b64_tr_b16 a[112:113], v186 offset:0
v_mfma_f32_16x16x32_bf16 v[84:87], a[92:95], a[44:47], v[84:87]
buffer_load_dwordx4 v[160:163], v14, s[44:47], s65 offen offset:1024 sc1
v_mfma_f32_16x16x32_bf16 v[84:87], a[88:91], a[40:43], v[84:87]
ds_read_b64_tr_b16 a[114:115], v186 offset:4096
v_mfma_f32_16x16x32_bf16 v[116:119], a[88:91], a[48:51], v[116:119]
buffer_load_dwordx4 v[168:171], v15, s[44:47], s65 offen offset:0 sc1
v_mfma_f32_16x16x32_bf16 v[116:119], a[92:95], a[52:55], v[116:119]
ds_read_b64_tr_b16 a[116:117], v186 offset:8192
v_mfma_f32_16x16x32_bf16 v[148:151], a[92:95], a[60:63], v[148:151]
buffer_load_dwordx4 v[176:179], v15, s[44:47], s65 offen offset:1024 sc1
v_mfma_f32_16x16x32_bf16 v[148:151], a[88:91], a[56:59], v[148:151]
s_add_u32 s65, s84, 40960
ds_read_b64_tr_b16 a[118:119], v186 offset:12288
v_mfma_f32_16x16x32_bf16 v[120:123], a[96:99], a[56:59], v[120:123]
buffer_load_dwordx4 v[156:159], v14, s[44:47], s65 offen offset:0 sc1
v_mfma_f32_16x16x32_bf16 v[120:123], a[100:103], a[60:63], v[120:123]
ds_read_b64_tr_b16 a[120:121], v187 offset:0
v_mfma_f32_16x16x32_bf16 v[88:91], a[100:103], a[52:55], v[88:91]
buffer_load_dwordx4 v[164:167], v14, s[44:47], s65 offen offset:1024 sc1
v_mfma_f32_16x16x32_bf16 v[88:91], a[96:99], a[48:51], v[88:91]
ds_read_b64_tr_b16 a[122:123], v187 offset:4096
v_mfma_f32_16x16x32_bf16 v[56:59], a[96:99], a[40:43], v[56:59]
buffer_load_dwordx4 v[172:175], v15, s[44:47], s65 offen offset:0 sc1
v_mfma_f32_16x16x32_bf16 v[56:59], a[100:103], a[44:47], v[56:59]
ds_read_b64_tr_b16 a[124:125], v187 offset:8192
v_mfma_f32_16x16x32_bf16 v[24:27], a[100:103], a[36:39], v[24:27]
ds_read_b64_tr_b16 a[126:127], v187 offset:12288
v_mfma_f32_16x16x32_bf16 v[24:27], a[96:99], a[32:35], v[24:27]
s_waitcnt lgkmcnt(4)
buffer_load_dwordx4 v[180:183], v15, s[44:47], s65 offen offset:1024 sc1
v_mfma_f32_16x16x32_bf16 v[28:31], a[104:107], a[32:35], v[28:31]
s_barrier
v_mfma_f32_16x16x32_bf16 v[28:31], a[108:111], a[36:39], v[28:31]
ds_read_b64_tr_b16 a[64:65], v188 offset:32768
v_mfma_f32_16x16x32_bf16 v[60:63], a[108:111], a[44:47], v[60:63]
s_add_u32 m0, s86, 65536
ds_read_b64_tr_b16 a[66:67], v188 offset:36864
v_mfma_f32_16x16x32_bf16 v[60:63], a[104:107], a[40:43], v[60:63]
s_add_u32 s64, s85, 524288
ds_read_b64_tr_b16 a[68:69], v188 offset:40960
v_mfma_f32_16x16x32_bf16 v[92:95], a[104:107], a[48:51], v[92:95]
buffer_load_dwordx4 v12, s[40:43], s64 offen lds
v_mfma_f32_16x16x32_bf16 v[92:95], a[108:111], a[52:55], v[92:95]
ds_read_b64_tr_b16 a[70:71], v188 offset:45056
v_mfma_f32_16x16x32_bf16 v[124:127], a[108:111], a[60:63], v[124:127]
s_add_u32 m0, s86, 66560
ds_read_b64_tr_b16 a[72:73], v189 offset:32768
v_mfma_f32_16x16x32_bf16 v[124:127], a[104:107], a[56:59], v[124:127]
s_add_u32 s64, s85, 532480
ds_read_b64_tr_b16 a[74:75], v189 offset:36864
v_mfma_f32_16x16x32_bf16 v[128:131], a[112:115], a[56:59], v[128:131]
buffer_load_dwordx4 v13, s[40:43], s64 offen lds
v_mfma_f32_16x16x32_bf16 v[128:131], a[116:119], a[60:63], v[128:131]
ds_read_b64_tr_b16 a[76:77], v189 offset:40960
v_mfma_f32_16x16x32_bf16 v[96:99], a[116:119], a[52:55], v[96:99]
s_add_u32 m0, s86, 67584
ds_read_b64_tr_b16 a[78:79], v189 offset:45056
v_mfma_f32_16x16x32_bf16 v[96:99], a[112:115], a[48:51], v[96:99]
s_add_u32 s64, s85, 540672
ds_read_b64_tr_b16 a[80:81], v190 offset:32768
v_mfma_f32_16x16x32_bf16 v[64:67], a[112:115], a[40:43], v[64:67]
buffer_load_dwordx4 v12, s[40:43], s64 offen lds
v_mfma_f32_16x16x32_bf16 v[64:67], a[116:119], a[44:47], v[64:67]
ds_read_b64_tr_b16 a[82:83], v190 offset:36864
v_mfma_f32_16x16x32_bf16 v[32:35], a[116:119], a[36:39], v[32:35]
s_add_u32 m0, s86, 68608
ds_read_b64_tr_b16 a[84:85], v190 offset:40960
v_mfma_f32_16x16x32_bf16 v[32:35], a[112:115], a[32:35], v[32:35]
s_waitcnt lgkmcnt(5)
s_add_u32 s64, s85, 548864
ds_read_b64_tr_b16 a[86:87], v190 offset:45056
v_mfma_f32_16x16x32_bf16 v[36:39], a[120:123], a[32:35], v[36:39]
buffer_load_dwordx4 v13, s[40:43], s64 offen lds
v_mfma_f32_16x16x32_bf16 v[36:39], a[124:127], a[36:39], v[36:39]
v_mfma_f32_16x16x32_bf16 v[68:71], a[124:127], a[44:47], v[68:71]
s_add_u32 m0, s86, 69632
v_mfma_f32_16x16x32_bf16 v[68:71], a[120:123], a[40:43], v[68:71]
s_add_u32 s64, s85, 557056
v_mfma_f32_16x16x32_bf16 v[100:103], a[120:123], a[48:51], v[100:103]
buffer_load_dwordx4 v12, s[40:43], s64 offen lds
v_mfma_f32_16x16x32_bf16 v[100:103], a[124:127], a[52:55], v[100:103]
v_mfma_f32_16x16x32_bf16 v[132:135], a[124:127], a[60:63], v[132:135]
v_mfma_f32_16x16x32_bf16 v[132:135], a[120:123], a[56:59], v[132:135]
s_mov_b32 s70, 3
.p2align 3
L_p5_2027:
s_waitcnt lgkmcnt(10)
s_waitcnt vmcnt(20)
v_mfma_f32_16x16x32_bf16 v[136:139], a[64:67], a[232:235], v[136:139]
s_waitcnt vmcnt(16)
s_waitcnt lgkmcnt(8)
s_add_u32 m0, s86, 70656
ds_read_b64_tr_b16 a[88:89], v191 offset:32768
v_mfma_f32_16x16x32_bf16 v[136:139], a[68:71], a[236:239], v[136:139]
s_add_u32 s64, s85, 565248
ds_read_b64_tr_b16 a[90:91], v191 offset:36864
v_mfma_f32_16x16x32_bf16 v[104:107], a[68:71], a[228:231], v[104:107]
buffer_load_dwordx4 v13, s[40:43], s64 offen lds
v_mfma_f32_16x16x32_bf16 v[104:107], a[64:67], a[224:227], v[104:107]
s_add_u32 m0, s86, 71680
ds_read_b64_tr_b16 a[92:93], v191 offset:40960
v_mfma_f32_16x16x32_bf16 v[72:75], a[64:67], a[216:219], v[72:75]
s_add_u32 s64, s85, 573440
ds_read_b64_tr_b16 a[94:95], v191 offset:45056
v_mfma_f32_16x16x32_bf16 v[72:75], a[68:71], a[220:223], v[72:75]
buffer_load_dwordx4 v12, s[40:43], s64 offen lds
v_mfma_f32_16x16x32_bf16 v[40:43], a[68:71], a[212:215], v[40:43]
s_add_u32 m0, s86, 72704
ds_read_b64_tr_b16 a[96:97], v184 offset:32768
v_mfma_f32_16x16x32_bf16 v[40:43], a[64:67], a[208:211], v[40:43]
s_waitcnt lgkmcnt(5)
s_add_u32 s64, s85, 581632
ds_read_b64_tr_b16 a[98:99], v184 offset:36864
v_mfma_f32_16x16x32_bf16 v[44:47], a[72:75], a[208:211], v[44:47]
buffer_load_dwordx4 v13, s[40:43], s64 offen lds
v_mfma_f32_16x16x32_bf16 v[44:47], a[76:79], a[212:215], v[44:47]
ds_read_b64_tr_b16 a[100:101], v184 offset:40960
v_mfma_f32_16x16x32_bf16 v[76:79], a[76:79], a[220:223], v[76:79]
ds_read_b64_tr_b16 a[102:103], v184 offset:45056
v_mfma_f32_16x16x32_bf16 v[76:79], a[72:75], a[216:219], v[76:79]
s_add_u32 s65, s84, 65536
ds_read_b64_tr_b16 a[104:105], v185 offset:32768
v_mfma_f32_16x16x32_bf16 v[108:111], a[72:75], a[224:227], v[108:111]
buffer_load_dwordx4 a[0:3], v14, s[44:47], s65 offen offset:0 sc1
v_mfma_f32_16x16x32_bf16 v[108:111], a[76:79], a[228:231], v[108:111]
ds_read_b64_tr_b16 a[106:107], v185 offset:36864
v_mfma_f32_16x16x32_bf16 v[140:143], a[76:79], a[236:239], v[140:143]
ds_read_b64_tr_b16 a[108:109], v185 offset:40960
v_mfma_f32_16x16x32_bf16 v[140:143], a[72:75], a[232:235], v[140:143]
buffer_load_dwordx4 a[8:11], v14, s[44:47], s65 offen offset:1024 sc1
v_mfma_f32_16x16x32_bf16 v[144:147], a[80:83], a[232:235], v[144:147]
ds_read_b64_tr_b16 a[110:111], v185 offset:45056
v_mfma_f32_16x16x32_bf16 v[144:147], a[84:87], a[236:239], v[144:147]
v_mfma_f32_16x16x32_bf16 v[112:115], a[84:87], a[228:231], v[112:115]
buffer_load_dwordx4 a[16:19], v15, s[44:47], s65 offen offset:0 sc1
v_mfma_f32_16x16x32_bf16 v[112:115], a[80:83], a[224:227], v[112:115]
ds_read_b64_tr_b16 a[112:113], v186 offset:32768
v_mfma_f32_16x16x32_bf16 v[80:83], a[80:83], a[216:219], v[80:83]
ds_read_b64_tr_b16 a[114:115], v186 offset:36864
v_mfma_f32_16x16x32_bf16 v[80:83], a[84:87], a[220:223], v[80:83]
ds_read_b64_tr_b16 a[116:117], v186 offset:40960
v_mfma_f32_16x16x32_bf16 v[48:51], a[84:87], a[212:215], v[48:51]
buffer_load_dwordx4 a[24:27], v15, s[44:47], s65 offen offset:1024 sc1
v_mfma_f32_16x16x32_bf16 v[48:51], a[80:83], a[208:211], v[48:51]
s_waitcnt lgkmcnt(4)
ds_read_b64_tr_b16 a[118:119], v186 offset:45056
v_mfma_f32_16x16x32_bf16 v[52:55], a[88:91], a[208:211], v[52:55]
s_add_u32 s65, s84, 73728
v_mfma_f32_16x16x32_bf16 v[52:55], a[92:95], a[212:215], v[52:55]
buffer_load_dwordx4 a[4:7], v14, s[44:47], s65 offen offset:0 sc1
v_mfma_f32_16x16x32_bf16 v[84:87], a[92:95], a[220:223], v[84:87]
ds_read_b64_tr_b16 a[120:121], v187 offset:32768
v_mfma_f32_16x16x32_bf16 v[84:87], a[88:91], a[216:219], v[84:87]
ds_read_b64_tr_b16 a[122:123], v187 offset:36864
v_mfma_f32_16x16x32_bf16 v[116:119], a[88:91], a[224:227], v[116:119]
buffer_load_dwordx4 a[12:15], v14, s[44:47], s65 offen offset:1024 sc1
v_mfma_f32_16x16x32_bf16 v[116:119], a[92:95], a[228:231], v[116:119]
ds_read_b64_tr_b16 a[124:125], v187 offset:40960
v_mfma_f32_16x16x32_bf16 v[148:151], a[92:95], a[236:239], v[148:151]
ds_read_b64_tr_b16 a[126:127], v187 offset:45056
v_mfma_f32_16x16x32_bf16 v[148:151], a[88:91], a[232:235], v[148:151]
v_mfma_f32_16x16x32_bf16 v[120:123], a[96:99], a[232:235], v[120:123]
buffer_load_dwordx4 a[20:23], v15, s[44:47], s65 offen offset:0 sc1
v_mfma_f32_16x16x32_bf16 v[120:123], a[100:103], a[236:239], v[120:123]
v_mfma_f32_16x16x32_bf16 v[88:91], a[100:103], a[228:231], v[88:91]
v_mfma_f32_16x16x32_bf16 v[88:91], a[96:99], a[224:227], v[88:91]
buffer_load_dwordx4 a[28:31], v15, s[44:47], s65 offen offset:1024 sc1
v_mfma_f32_16x16x32_bf16 v[56:59], a[96:99], a[216:219], v[56:59]
v_mfma_f32_16x16x32_bf16 v[56:59], a[100:103], a[220:223], v[56:59]
v_mfma_f32_16x16x32_bf16 v[24:27], a[100:103], a[212:215], v[24:27]
v_mfma_f32_16x16x32_bf16 v[24:27], a[96:99], a[208:211], v[24:27]
v_mfma_f32_16x16x32_bf16 v[28:31], a[104:107], a[208:211], v[28:31]
s_waitcnt vmcnt(24)
s_barrier
s_waitcnt lgkmcnt(0)
v_mfma_f32_16x16x32_bf16 v[28:31], a[108:111], a[212:215], v[28:31]
ds_read_b64_tr_b16 a[64:65], v196 offset:0
v_mfma_f32_16x16x32_bf16 v[60:63], a[108:111], a[220:223], v[60:63]
s_add_u32 m0, s86, 98304
ds_read_b64_tr_b16 a[66:67], v196 offset:4096
v_mfma_f32_16x16x32_bf16 v[60:63], a[104:107], a[216:219], v[60:63]
s_add_u32 s64, s85, 786432
ds_read_b64_tr_b16 a[68:69], v196 offset:8192
v_mfma_f32_16x16x32_bf16 v[92:95], a[104:107], a[224:227], v[92:95]
buffer_load_dwordx4 v12, s[40:43], s64 offen lds
v_mfma_f32_16x16x32_bf16 v[92:95], a[108:111], a[228:231], v[92:95]
ds_read_b64_tr_b16 a[70:71], v196 offset:12288
v_mfma_f32_16x16x32_bf16 v[124:127], a[108:111], a[236:239], v[124:127]
s_add_u32 m0, s86, 99328
ds_read_b64_tr_b16 a[72:73], v197 offset:0
v_mfma_f32_16x16x32_bf16 v[124:127], a[104:107], a[232:235], v[124:127]
s_add_u32 s64, s85, 794624
ds_read_b64_tr_b16 a[74:75], v197 offset:4096
v_mfma_f32_16x16x32_bf16 v[128:131], a[112:115], a[232:235], v[128:131]
buffer_load_dwordx4 v13, s[40:43], s64 offen lds
v_mfma_f32_16x16x32_bf16 v[128:131], a[116:119], a[236:239], v[128:131]
ds_read_b64_tr_b16 a[76:77], v197 offset:8192
v_mfma_f32_16x16x32_bf16 v[96:99], a[116:119], a[228:231], v[96:99]
s_add_u32 m0, s86, 100352
ds_read_b64_tr_b16 a[78:79], v197 offset:12288
v_mfma_f32_16x16x32_bf16 v[96:99], a[112:115], a[224:227], v[96:99]
s_add_u32 s64, s85, 802816
ds_read_b64_tr_b16 a[80:81], v198 offset:0
v_mfma_f32_16x16x32_bf16 v[64:67], a[112:115], a[216:219], v[64:67]
buffer_load_dwordx4 v12, s[40:43], s64 offen lds
v_mfma_f32_16x16x32_bf16 v[64:67], a[116:119], a[220:223], v[64:67]
ds_read_b64_tr_b16 a[82:83], v198 offset:4096
v_mfma_f32_16x16x32_bf16 v[32:35], a[116:119], a[212:215], v[32:35]
s_add_u32 m0, s86, 101376
ds_read_b64_tr_b16 a[84:85], v198 offset:8192
v_mfma_f32_16x16x32_bf16 v[32:35], a[112:115], a[208:211], v[32:35]
s_add_u32 s64, s85, 811008
ds_read_b64_tr_b16 a[86:87], v198 offset:12288
v_mfma_f32_16x16x32_bf16 v[36:39], a[120:123], a[208:211], v[36:39]
buffer_load_dwordx4 v13, s[40:43], s64 offen lds
v_mfma_f32_16x16x32_bf16 v[36:39], a[124:127], a[212:215], v[36:39]
v_mfma_f32_16x16x32_bf16 v[68:71], a[124:127], a[220:223], v[68:71]
s_add_u32 m0, s86, 102400
v_mfma_f32_16x16x32_bf16 v[68:71], a[120:123], a[216:219], v[68:71]
s_add_u32 s64, s85, 819200
v_mfma_f32_16x16x32_bf16 v[100:103], a[120:123], a[224:227], v[100:103]
buffer_load_dwordx4 v12, s[40:43], s64 offen lds
v_mfma_f32_16x16x32_bf16 v[100:103], a[124:127], a[228:231], v[100:103]
v_mfma_f32_16x16x32_bf16 v[132:135], a[124:127], a[236:239], v[132:135]
v_mfma_f32_16x16x32_bf16 v[132:135], a[120:123], a[232:235], v[132:135]
s_waitcnt vmcnt(25)
s_waitcnt lgkmcnt(0)
v_mfma_f32_16x16x32_bf16 v[136:139], a[64:67], v[176:179], v[136:139]
s_waitcnt vmcnt(21)
s_add_u32 m0, s86, 103424
ds_read_b64_tr_b16 a[88:89], v199 offset:0
v_mfma_f32_16x16x32_bf16 v[136:139], a[68:71], v[180:183], v[136:139]
s_add_u32 s64, s85, 827392
ds_read_b64_tr_b16 a[90:91], v199 offset:4096
v_mfma_f32_16x16x32_bf16 v[104:107], a[68:71], v[172:175], v[104:107]
buffer_load_dwordx4 v13, s[40:43], s64 offen lds
v_mfma_f32_16x16x32_bf16 v[104:107], a[64:67], v[168:171], v[104:107]
s_add_u32 m0, s86, 104448
ds_read_b64_tr_b16 a[92:93], v199 offset:8192
v_mfma_f32_16x16x32_bf16 v[72:75], a[64:67], v[160:163], v[72:75]
s_add_u32 s64, s85, 835584
ds_read_b64_tr_b16 a[94:95], v199 offset:12288
v_mfma_f32_16x16x32_bf16 v[72:75], a[68:71], v[164:167], v[72:75]
buffer_load_dwordx4 v12, s[40:43], s64 offen lds
v_mfma_f32_16x16x32_bf16 v[40:43], a[68:71], v[156:159], v[40:43]
s_add_u32 m0, s86, 105472
ds_read_b64_tr_b16 a[96:97], v192 offset:0
v_mfma_f32_16x16x32_bf16 v[40:43], a[64:67], v[152:155], v[40:43]
s_add_u32 s64, s85, 843776
ds_read_b64_tr_b16 a[98:99], v192 offset:4096
v_mfma_f32_16x16x32_bf16 v[44:47], a[72:75], v[152:155], v[44:47]
buffer_load_dwordx4 v13, s[40:43], s64 offen lds
v_mfma_f32_16x16x32_bf16 v[44:47], a[76:79], v[156:159], v[44:47]
ds_read_b64_tr_b16 a[100:101], v192 offset:8192
v_mfma_f32_16x16x32_bf16 v[76:79], a[76:79], v[164:167], v[76:79]
ds_read_b64_tr_b16 a[102:103], v192 offset:12288
v_mfma_f32_16x16x32_bf16 v[76:79], a[72:75], v[160:163], v[76:79]
s_add_u32 s65, s84, 98304
ds_read_b64_tr_b16 a[104:105], v193 offset:0
v_mfma_f32_16x16x32_bf16 v[108:111], a[72:75], v[168:171], v[108:111]
buffer_load_dwordx4 a[32:35], v14, s[44:47], s65 offen offset:0 sc1
v_mfma_f32_16x16x32_bf16 v[108:111], a[76:79], v[172:175], v[108:111]
ds_read_b64_tr_b16 a[106:107], v193 offset:4096
v_mfma_f32_16x16x32_bf16 v[140:143], a[76:79], v[180:183], v[140:143]
ds_read_b64_tr_b16 a[108:109], v193 offset:8192
v_mfma_f32_16x16x32_bf16 v[140:143], a[72:75], v[176:179], v[140:143]
buffer_load_dwordx4 a[40:43], v14, s[44:47], s65 offen offset:1024 sc1
v_mfma_f32_16x16x32_bf16 v[144:147], a[80:83], v[176:179], v[144:147]
ds_read_b64_tr_b16 a[110:111], v193 offset:12288
v_mfma_f32_16x16x32_bf16 v[144:147], a[84:87], v[180:183], v[144:147]
v_mfma_f32_16x16x32_bf16 v[112:115], a[84:87], v[172:175], v[112:115]
buffer_load_dwordx4 a[48:51], v15, s[44:47], s65 offen offset:0 sc1
v_mfma_f32_16x16x32_bf16 v[112:115], a[80:83], v[168:171], v[112:115]
ds_read_b64_tr_b16 a[112:113], v194 offset:0
v_mfma_f32_16x16x32_bf16 v[80:83], a[80:83], v[160:163], v[80:83]
ds_read_b64_tr_b16 a[114:115], v194 offset:4096
v_mfma_f32_16x16x32_bf16 v[80:83], a[84:87], v[164:167], v[80:83]
ds_read_b64_tr_b16 a[116:117], v194 offset:8192
v_mfma_f32_16x16x32_bf16 v[48:51], a[84:87], v[156:159], v[48:51]
buffer_load_dwordx4 a[56:59], v15, s[44:47], s65 offen offset:1024 sc1
v_mfma_f32_16x16x32_bf16 v[48:51], a[80:83], v[152:155], v[48:51]
s_waitcnt lgkmcnt(4)
ds_read_b64_tr_b16 a[118:119], v194 offset:12288
v_mfma_f32_16x16x32_bf16 v[52:55], a[88:91], v[152:155], v[52:55]
s_add_u32 s65, s84, 106496
v_mfma_f32_16x16x32_bf16 v[52:55], a[92:95], v[156:159], v[52:55]
buffer_load_dwordx4 a[36:39], v14, s[44:47], s65 offen offset:0 sc1
v_mfma_f32_16x16x32_bf16 v[84:87], a[92:95], v[164:167], v[84:87]
ds_read_b64_tr_b16 a[120:121], v195 offset:0
v_mfma_f32_16x16x32_bf16 v[84:87], a[88:91], v[160:163], v[84:87]
ds_read_b64_tr_b16 a[122:123], v195 offset:4096
v_mfma_f32_16x16x32_bf16 v[116:119], a[88:91], v[168:171], v[116:119]
buffer_load_dwordx4 a[44:47], v14, s[44:47], s65 offen offset:1024 sc1
v_mfma_f32_16x16x32_bf16 v[116:119], a[92:95], v[172:175], v[116:119]
ds_read_b64_tr_b16 a[124:125], v195 offset:8192
v_mfma_f32_16x16x32_bf16 v[148:151], a[92:95], v[180:183], v[148:151]
ds_read_b64_tr_b16 a[126:127], v195 offset:12288
v_mfma_f32_16x16x32_bf16 v[148:151], a[88:91], v[176:179], v[148:151]
v_mfma_f32_16x16x32_bf16 v[120:123], a[96:99], v[176:179], v[120:123]
buffer_load_dwordx4 a[52:55], v15, s[44:47], s65 offen offset:0 sc1
v_mfma_f32_16x16x32_bf16 v[120:123], a[100:103], v[180:183], v[120:123]
v_mfma_f32_16x16x32_bf16 v[88:91], a[100:103], v[172:175], v[88:91]
v_mfma_f32_16x16x32_bf16 v[88:91], a[96:99], v[168:171], v[88:91]
buffer_load_dwordx4 a[60:63], v15, s[44:47], s65 offen offset:1024 sc1
v_mfma_f32_16x16x32_bf16 v[56:59], a[96:99], v[160:163], v[56:59]
v_mfma_f32_16x16x32_bf16 v[56:59], a[100:103], v[164:167], v[56:59]
v_mfma_f32_16x16x32_bf16 v[24:27], a[100:103], v[156:159], v[24:27]
v_mfma_f32_16x16x32_bf16 v[24:27], a[96:99], v[152:155], v[24:27]
v_mfma_f32_16x16x32_bf16 v[28:31], a[104:107], v[152:155], v[28:31]
s_waitcnt vmcnt(24)
s_barrier
s_waitcnt lgkmcnt(0)
v_mfma_f32_16x16x32_bf16 v[28:31], a[108:111], v[156:159], v[28:31]
ds_read_b64_tr_b16 a[64:65], v196 offset:32768
v_mfma_f32_16x16x32_bf16 v[60:63], a[108:111], v[164:167], v[60:63]
s_add_u32 m0, s86, 131072
ds_read_b64_tr_b16 a[66:67], v196 offset:36864
v_mfma_f32_16x16x32_bf16 v[60:63], a[104:107], v[160:163], v[60:63]
s_add_u32 s64, s85, 1048576
ds_read_b64_tr_b16 a[68:69], v196 offset:40960
v_mfma_f32_16x16x32_bf16 v[92:95], a[104:107], v[168:171], v[92:95]
buffer_load_dwordx4 v12, s[40:43], s64 offen lds
v_mfma_f32_16x16x32_bf16 v[92:95], a[108:111], v[172:175], v[92:95]
ds_read_b64_tr_b16 a[70:71], v196 offset:45056
v_mfma_f32_16x16x32_bf16 v[124:127], a[108:111], v[180:183], v[124:127]
s_add_u32 m0, s86, 132096
ds_read_b64_tr_b16 a[72:73], v197 offset:32768
v_mfma_f32_16x16x32_bf16 v[124:127], a[104:107], v[176:179], v[124:127]
s_add_u32 s64, s85, 1056768
ds_read_b64_tr_b16 a[74:75], v197 offset:36864
v_mfma_f32_16x16x32_bf16 v[128:131], a[112:115], v[176:179], v[128:131]
buffer_load_dwordx4 v13, s[40:43], s64 offen lds
v_mfma_f32_16x16x32_bf16 v[128:131], a[116:119], v[180:183], v[128:131]
ds_read_b64_tr_b16 a[76:77], v197 offset:40960
v_mfma_f32_16x16x32_bf16 v[96:99], a[116:119], v[172:175], v[96:99]
s_add_u32 m0, s86, 133120
ds_read_b64_tr_b16 a[78:79], v197 offset:45056
v_mfma_f32_16x16x32_bf16 v[96:99], a[112:115], v[168:171], v[96:99]
s_add_u32 s64, s85, 1064960
ds_read_b64_tr_b16 a[80:81], v198 offset:32768
v_mfma_f32_16x16x32_bf16 v[64:67], a[112:115], v[160:163], v[64:67]
buffer_load_dwordx4 v12, s[40:43], s64 offen lds
v_mfma_f32_16x16x32_bf16 v[64:67], a[116:119], v[164:167], v[64:67]
ds_read_b64_tr_b16 a[82:83], v198 offset:36864
v_mfma_f32_16x16x32_bf16 v[32:35], a[116:119], v[156:159], v[32:35]
s_add_u32 m0, s86, 134144
ds_read_b64_tr_b16 a[84:85], v198 offset:40960
v_mfma_f32_16x16x32_bf16 v[32:35], a[112:115], v[152:155], v[32:35]
s_add_u32 s64, s85, 1073152
ds_read_b64_tr_b16 a[86:87], v198 offset:45056
v_mfma_f32_16x16x32_bf16 v[36:39], a[120:123], v[152:155], v[36:39]
buffer_load_dwordx4 v13, s[40:43], s64 offen lds
v_mfma_f32_16x16x32_bf16 v[36:39], a[124:127], v[156:159], v[36:39]
v_mfma_f32_16x16x32_bf16 v[68:71], a[124:127], v[164:167], v[68:71]
s_add_u32 m0, s86, 135168
v_mfma_f32_16x16x32_bf16 v[68:71], a[120:123], v[160:163], v[68:71]
s_add_u32 s64, s85, 1081344
v_mfma_f32_16x16x32_bf16 v[100:103], a[120:123], v[168:171], v[100:103]
buffer_load_dwordx4 v12, s[40:43], s64 offen lds
v_mfma_f32_16x16x32_bf16 v[100:103], a[124:127], v[172:175], v[100:103]
v_mfma_f32_16x16x32_bf16 v[132:135], a[124:127], v[180:183], v[132:135]
v_mfma_f32_16x16x32_bf16 v[132:135], a[120:123], v[176:179], v[132:135]
s_waitcnt vmcnt(25)
s_waitcnt lgkmcnt(0)
v_mfma_f32_16x16x32_bf16 v[136:139], a[64:67], a[24:27], v[136:139]
s_waitcnt vmcnt(21)
s_add_u32 m0, s86, 136192
ds_read_b64_tr_b16 a[88:89], v199 offset:32768
v_mfma_f32_16x16x32_bf16 v[136:139], a[68:71], a[28:31], v[136:139]
s_add_u32 s64, s85, 1089536
ds_read_b64_tr_b16 a[90:91], v199 offset:36864
v_mfma_f32_16x16x32_bf16 v[104:107], a[68:71], a[20:23], v[104:107]
buffer_load_dwordx4 v13, s[40:43], s64 offen lds
v_mfma_f32_16x16x32_bf16 v[104:107], a[64:67], a[16:19], v[104:107]
s_add_u32 m0, s86, 137216
ds_read_b64_tr_b16 a[92:93], v199 offset:40960
v_mfma_f32_16x16x32_bf16 v[72:75], a[64:67], a[8:11], v[72:75]
s_add_u32 s64, s85, 1097728
ds_read_b64_tr_b16 a[94:95], v199 offset:45056
v_mfma_f32_16x16x32_bf16 v[72:75], a[68:71], a[12:15], v[72:75]
buffer_load_dwordx4 v12, s[40:43], s64 offen lds
v_mfma_f32_16x16x32_bf16 v[40:43], a[68:71], a[4:7], v[40:43]
s_add_u32 m0, s86, 138240
ds_read_b64_tr_b16 a[96:97], v192 offset:32768
v_mfma_f32_16x16x32_bf16 v[40:43], a[64:67], a[0:3], v[40:43]
s_add_u32 s64, s85, 1105920
ds_read_b64_tr_b16 a[98:99], v192 offset:36864
v_mfma_f32_16x16x32_bf16 v[44:47], a[72:75], a[0:3], v[44:47]
buffer_load_dwordx4 v13, s[40:43], s64 offen lds
v_mfma_f32_16x16x32_bf16 v[44:47], a[76:79], a[4:7], v[44:47]
ds_read_b64_tr_b16 a[100:101], v192 offset:40960
v_mfma_f32_16x16x32_bf16 v[76:79], a[76:79], a[12:15], v[76:79]
ds_read_b64_tr_b16 a[102:103], v192 offset:45056
v_mfma_f32_16x16x32_bf16 v[76:79], a[72:75], a[8:11], v[76:79]
s_add_u32 s65, s84, 131072
ds_read_b64_tr_b16 a[104:105], v193 offset:32768
v_mfma_f32_16x16x32_bf16 v[108:111], a[72:75], a[16:19], v[108:111]
buffer_load_dwordx4 a[208:211], v14, s[44:47], s65 offen offset:0 sc1
v_mfma_f32_16x16x32_bf16 v[108:111], a[76:79], a[20:23], v[108:111]
ds_read_b64_tr_b16 a[106:107], v193 offset:36864
v_mfma_f32_16x16x32_bf16 v[140:143], a[76:79], a[28:31], v[140:143]
ds_read_b64_tr_b16 a[108:109], v193 offset:40960
v_mfma_f32_16x16x32_bf16 v[140:143], a[72:75], a[24:27], v[140:143]
buffer_load_dwordx4 a[216:219], v14, s[44:47], s65 offen offset:1024 sc1
v_mfma_f32_16x16x32_bf16 v[144:147], a[80:83], a[24:27], v[144:147]
ds_read_b64_tr_b16 a[110:111], v193 offset:45056
v_mfma_f32_16x16x32_bf16 v[144:147], a[84:87], a[28:31], v[144:147]
v_mfma_f32_16x16x32_bf16 v[112:115], a[84:87], a[20:23], v[112:115]
buffer_load_dwordx4 a[224:227], v15, s[44:47], s65 offen offset:0 sc1
v_mfma_f32_16x16x32_bf16 v[112:115], a[80:83], a[16:19], v[112:115]
ds_read_b64_tr_b16 a[112:113], v194 offset:32768
v_mfma_f32_16x16x32_bf16 v[80:83], a[80:83], a[8:11], v[80:83]
ds_read_b64_tr_b16 a[114:115], v194 offset:36864
v_mfma_f32_16x16x32_bf16 v[80:83], a[84:87], a[12:15], v[80:83]
ds_read_b64_tr_b16 a[116:117], v194 offset:40960
v_mfma_f32_16x16x32_bf16 v[48:51], a[84:87], a[4:7], v[48:51]
buffer_load_dwordx4 a[232:235], v15, s[44:47], s65 offen offset:1024 sc1
v_mfma_f32_16x16x32_bf16 v[48:51], a[80:83], a[0:3], v[48:51]
s_waitcnt lgkmcnt(4)
ds_read_b64_tr_b16 a[118:119], v194 offset:45056
v_mfma_f32_16x16x32_bf16 v[52:55], a[88:91], a[0:3], v[52:55]
s_add_u32 s65, s84, 139264
v_mfma_f32_16x16x32_bf16 v[52:55], a[92:95], a[4:7], v[52:55]
buffer_load_dwordx4 a[212:215], v14, s[44:47], s65 offen offset:0 sc1
v_mfma_f32_16x16x32_bf16 v[84:87], a[92:95], a[12:15], v[84:87]
ds_read_b64_tr_b16 a[120:121], v195 offset:32768
v_mfma_f32_16x16x32_bf16 v[84:87], a[88:91], a[8:11], v[84:87]
ds_read_b64_tr_b16 a[122:123], v195 offset:36864
v_mfma_f32_16x16x32_bf16 v[116:119], a[88:91], a[16:19], v[116:119]
buffer_load_dwordx4 a[220:223], v14, s[44:47], s65 offen offset:1024 sc1
v_mfma_f32_16x16x32_bf16 v[116:119], a[92:95], a[20:23], v[116:119]
ds_read_b64_tr_b16 a[124:125], v195 offset:40960
v_mfma_f32_16x16x32_bf16 v[148:151], a[92:95], a[28:31], v[148:151]
ds_read_b64_tr_b16 a[126:127], v195 offset:45056
v_mfma_f32_16x16x32_bf16 v[148:151], a[88:91], a[24:27], v[148:151]
v_mfma_f32_16x16x32_bf16 v[120:123], a[96:99], a[24:27], v[120:123]
buffer_load_dwordx4 a[228:231], v15, s[44:47], s65 offen offset:0 sc1
v_mfma_f32_16x16x32_bf16 v[120:123], a[100:103], a[28:31], v[120:123]
v_mfma_f32_16x16x32_bf16 v[88:91], a[100:103], a[20:23], v[88:91]
v_mfma_f32_16x16x32_bf16 v[88:91], a[96:99], a[16:19], v[88:91]
buffer_load_dwordx4 a[236:239], v15, s[44:47], s65 offen offset:1024 sc1
v_mfma_f32_16x16x32_bf16 v[56:59], a[96:99], a[8:11], v[56:59]
v_mfma_f32_16x16x32_bf16 v[56:59], a[100:103], a[12:15], v[56:59]
v_mfma_f32_16x16x32_bf16 v[24:27], a[100:103], a[4:7], v[24:27]
v_mfma_f32_16x16x32_bf16 v[24:27], a[96:99], a[0:3], v[24:27]
v_mfma_f32_16x16x32_bf16 v[28:31], a[104:107], a[0:3], v[28:31]
s_waitcnt vmcnt(24)
s_barrier
s_waitcnt lgkmcnt(0)
v_mfma_f32_16x16x32_bf16 v[28:31], a[108:111], a[4:7], v[28:31]
ds_read_b64_tr_b16 a[64:65], v188 offset:0
v_mfma_f32_16x16x32_bf16 v[60:63], a[108:111], a[12:15], v[60:63]
s_add_u32 m0, s86, 32768
ds_read_b64_tr_b16 a[66:67], v188 offset:4096
v_mfma_f32_16x16x32_bf16 v[60:63], a[104:107], a[8:11], v[60:63]
s_add_u32 s64, s85, 1310720
ds_read_b64_tr_b16 a[68:69], v188 offset:8192
v_mfma_f32_16x16x32_bf16 v[92:95], a[104:107], a[16:19], v[92:95]
buffer_load_dwordx4 v12, s[40:43], s64 offen lds
v_mfma_f32_16x16x32_bf16 v[92:95], a[108:111], a[20:23], v[92:95]
ds_read_b64_tr_b16 a[70:71], v188 offset:12288
v_mfma_f32_16x16x32_bf16 v[124:127], a[108:111], a[28:31], v[124:127]
s_add_u32 m0, s86, 33792
ds_read_b64_tr_b16 a[72:73], v189 offset:0
v_mfma_f32_16x16x32_bf16 v[124:127], a[104:107], a[24:27], v[124:127]
s_add_u32 s64, s85, 1318912
ds_read_b64_tr_b16 a[74:75], v189 offset:4096
v_mfma_f32_16x16x32_bf16 v[128:131], a[112:115], a[24:27], v[128:131]
buffer_load_dwordx4 v13, s[40:43], s64 offen lds
v_mfma_f32_16x16x32_bf16 v[128:131], a[116:119], a[28:31], v[128:131]
ds_read_b64_tr_b16 a[76:77], v189 offset:8192
v_mfma_f32_16x16x32_bf16 v[96:99], a[116:119], a[20:23], v[96:99]
s_add_u32 m0, s86, 34816
ds_read_b64_tr_b16 a[78:79], v189 offset:12288
v_mfma_f32_16x16x32_bf16 v[96:99], a[112:115], a[16:19], v[96:99]
s_add_u32 s64, s85, 1327104
ds_read_b64_tr_b16 a[80:81], v190 offset:0
v_mfma_f32_16x16x32_bf16 v[64:67], a[112:115], a[8:11], v[64:67]
buffer_load_dwordx4 v12, s[40:43], s64 offen lds
v_mfma_f32_16x16x32_bf16 v[64:67], a[116:119], a[12:15], v[64:67]
ds_read_b64_tr_b16 a[82:83], v190 offset:4096
v_mfma_f32_16x16x32_bf16 v[32:35], a[116:119], a[4:7], v[32:35]
s_add_u32 m0, s86, 35840
ds_read_b64_tr_b16 a[84:85], v190 offset:8192
v_mfma_f32_16x16x32_bf16 v[32:35], a[112:115], a[0:3], v[32:35]
s_add_u32 s64, s85, 1335296
ds_read_b64_tr_b16 a[86:87], v190 offset:12288
v_mfma_f32_16x16x32_bf16 v[36:39], a[120:123], a[0:3], v[36:39]
buffer_load_dwordx4 v13, s[40:43], s64 offen lds
v_mfma_f32_16x16x32_bf16 v[36:39], a[124:127], a[4:7], v[36:39]
v_mfma_f32_16x16x32_bf16 v[68:71], a[124:127], a[12:15], v[68:71]
s_add_u32 m0, s86, 36864
v_mfma_f32_16x16x32_bf16 v[68:71], a[120:123], a[8:11], v[68:71]
s_add_u32 s64, s85, 1343488
v_mfma_f32_16x16x32_bf16 v[100:103], a[120:123], a[16:19], v[100:103]
buffer_load_dwordx4 v12, s[40:43], s64 offen lds
v_mfma_f32_16x16x32_bf16 v[100:103], a[124:127], a[20:23], v[100:103]
v_mfma_f32_16x16x32_bf16 v[132:135], a[124:127], a[28:31], v[132:135]
v_mfma_f32_16x16x32_bf16 v[132:135], a[120:123], a[24:27], v[132:135]
s_waitcnt vmcnt(25)
s_waitcnt lgkmcnt(0)
v_mfma_f32_16x16x32_bf16 v[136:139], a[64:67], a[56:59], v[136:139]
s_waitcnt vmcnt(21)
s_add_u32 m0, s86, 37888
ds_read_b64_tr_b16 a[88:89], v191 offset:0
v_mfma_f32_16x16x32_bf16 v[136:139], a[68:71], a[60:63], v[136:139]
s_add_u32 s64, s85, 1351680
ds_read_b64_tr_b16 a[90:91], v191 offset:4096
v_mfma_f32_16x16x32_bf16 v[104:107], a[68:71], a[52:55], v[104:107]
buffer_load_dwordx4 v13, s[40:43], s64 offen lds
v_mfma_f32_16x16x32_bf16 v[104:107], a[64:67], a[48:51], v[104:107]
s_add_u32 m0, s86, 38912
ds_read_b64_tr_b16 a[92:93], v191 offset:8192
v_mfma_f32_16x16x32_bf16 v[72:75], a[64:67], a[40:43], v[72:75]
s_add_u32 s64, s85, 1359872
ds_read_b64_tr_b16 a[94:95], v191 offset:12288
v_mfma_f32_16x16x32_bf16 v[72:75], a[68:71], a[44:47], v[72:75]
buffer_load_dwordx4 v12, s[40:43], s64 offen lds
v_mfma_f32_16x16x32_bf16 v[40:43], a[68:71], a[36:39], v[40:43]
s_add_u32 m0, s86, 39936
ds_read_b64_tr_b16 a[96:97], v184 offset:0
v_mfma_f32_16x16x32_bf16 v[40:43], a[64:67], a[32:35], v[40:43]
s_add_u32 s64, s85, 1368064
ds_read_b64_tr_b16 a[98:99], v184 offset:4096
v_mfma_f32_16x16x32_bf16 v[44:47], a[72:75], a[32:35], v[44:47]
buffer_load_dwordx4 v13, s[40:43], s64 offen lds
v_mfma_f32_16x16x32_bf16 v[44:47], a[76:79], a[36:39], v[44:47]
ds_read_b64_tr_b16 a[100:101], v184 offset:8192
v_mfma_f32_16x16x32_bf16 v[76:79], a[76:79], a[44:47], v[76:79]
ds_read_b64_tr_b16 a[102:103], v184 offset:12288
v_mfma_f32_16x16x32_bf16 v[76:79], a[72:75], a[40:43], v[76:79]
s_add_u32 s65, s84, 163840
ds_read_b64_tr_b16 a[104:105], v185 offset:0
v_mfma_f32_16x16x32_bf16 v[108:111], a[72:75], a[48:51], v[108:111]
buffer_load_dwordx4 v[152:155], v14, s[44:47], s65 offen offset:0 sc1
v_mfma_f32_16x16x32_bf16 v[108:111], a[76:79], a[52:55], v[108:111]
ds_read_b64_tr_b16 a[106:107], v185 offset:4096
v_mfma_f32_16x16x32_bf16 v[140:143], a[76:79], a[60:63], v[140:143]
ds_read_b64_tr_b16 a[108:109], v185 offset:8192
v_mfma_f32_16x16x32_bf16 v[140:143], a[72:75], a[56:59], v[140:143]
buffer_load_dwordx4 v[160:163], v14, s[44:47], s65 offen offset:1024 sc1
v_mfma_f32_16x16x32_bf16 v[144:147], a[80:83], a[56:59], v[144:147]
ds_read_b64_tr_b16 a[110:111], v185 offset:12288
v_mfma_f32_16x16x32_bf16 v[144:147], a[84:87], a[60:63], v[144:147]
v_mfma_f32_16x16x32_bf16 v[112:115], a[84:87], a[52:55], v[112:115]
buffer_load_dwordx4 v[168:171], v15, s[44:47], s65 offen offset:0 sc1
v_mfma_f32_16x16x32_bf16 v[112:115], a[80:83], a[48:51], v[112:115]
ds_read_b64_tr_b16 a[112:113], v186 offset:0
v_mfma_f32_16x16x32_bf16 v[80:83], a[80:83], a[40:43], v[80:83]
ds_read_b64_tr_b16 a[114:115], v186 offset:4096
v_mfma_f32_16x16x32_bf16 v[80:83], a[84:87], a[44:47], v[80:83]
ds_read_b64_tr_b16 a[116:117], v186 offset:8192
v_mfma_f32_16x16x32_bf16 v[48:51], a[84:87], a[36:39], v[48:51]
buffer_load_dwordx4 v[176:179], v15, s[44:47], s65 offen offset:1024 sc1
v_mfma_f32_16x16x32_bf16 v[48:51], a[80:83], a[32:35], v[48:51]
s_waitcnt lgkmcnt(4)
ds_read_b64_tr_b16 a[118:119], v186 offset:12288
v_mfma_f32_16x16x32_bf16 v[52:55], a[88:91], a[32:35], v[52:55]
s_add_u32 s65, s84, 172032
v_mfma_f32_16x16x32_bf16 v[52:55], a[92:95], a[36:39], v[52:55]
buffer_load_dwordx4 v[156:159], v14, s[44:47], s65 offen offset:0 sc1
v_mfma_f32_16x16x32_bf16 v[84:87], a[92:95], a[44:47], v[84:87]
ds_read_b64_tr_b16 a[120:121], v187 offset:0
v_mfma_f32_16x16x32_bf16 v[84:87], a[88:91], a[40:43], v[84:87]
ds_read_b64_tr_b16 a[122:123], v187 offset:4096
v_mfma_f32_16x16x32_bf16 v[116:119], a[88:91], a[48:51], v[116:119]
buffer_load_dwordx4 v[164:167], v14, s[44:47], s65 offen offset:1024 sc1
v_mfma_f32_16x16x32_bf16 v[116:119], a[92:95], a[52:55], v[116:119]
ds_read_b64_tr_b16 a[124:125], v187 offset:8192
v_mfma_f32_16x16x32_bf16 v[148:151], a[92:95], a[60:63], v[148:151]
ds_read_b64_tr_b16 a[126:127], v187 offset:12288
v_mfma_f32_16x16x32_bf16 v[148:151], a[88:91], a[56:59], v[148:151]
v_mfma_f32_16x16x32_bf16 v[120:123], a[96:99], a[56:59], v[120:123]
buffer_load_dwordx4 v[172:175], v15, s[44:47], s65 offen offset:0 sc1
v_mfma_f32_16x16x32_bf16 v[120:123], a[100:103], a[60:63], v[120:123]
v_mfma_f32_16x16x32_bf16 v[88:91], a[100:103], a[52:55], v[88:91]
v_mfma_f32_16x16x32_bf16 v[88:91], a[96:99], a[48:51], v[88:91]
buffer_load_dwordx4 v[180:183], v15, s[44:47], s65 offen offset:1024 sc1
v_mfma_f32_16x16x32_bf16 v[56:59], a[96:99], a[40:43], v[56:59]
v_mfma_f32_16x16x32_bf16 v[56:59], a[100:103], a[44:47], v[56:59]
v_mfma_f32_16x16x32_bf16 v[24:27], a[100:103], a[36:39], v[24:27]
v_mfma_f32_16x16x32_bf16 v[24:27], a[96:99], a[32:35], v[24:27]
v_mfma_f32_16x16x32_bf16 v[28:31], a[104:107], a[32:35], v[28:31]
s_waitcnt vmcnt(24)
s_barrier
s_waitcnt lgkmcnt(0)
v_mfma_f32_16x16x32_bf16 v[28:31], a[108:111], a[36:39], v[28:31]
ds_read_b64_tr_b16 a[64:65], v188 offset:32768
v_mfma_f32_16x16x32_bf16 v[60:63], a[108:111], a[44:47], v[60:63]
s_add_u32 m0, s86, 65536
ds_read_b64_tr_b16 a[66:67], v188 offset:36864
v_mfma_f32_16x16x32_bf16 v[60:63], a[104:107], a[40:43], v[60:63]
s_add_u32 s64, s85, 1572864
ds_read_b64_tr_b16 a[68:69], v188 offset:40960
v_mfma_f32_16x16x32_bf16 v[92:95], a[104:107], a[48:51], v[92:95]
buffer_load_dwordx4 v12, s[40:43], s64 offen lds
v_mfma_f32_16x16x32_bf16 v[92:95], a[108:111], a[52:55], v[92:95]
ds_read_b64_tr_b16 a[70:71], v188 offset:45056
v_mfma_f32_16x16x32_bf16 v[124:127], a[108:111], a[60:63], v[124:127]
s_add_u32 m0, s86, 66560
ds_read_b64_tr_b16 a[72:73], v189 offset:32768
v_mfma_f32_16x16x32_bf16 v[124:127], a[104:107], a[56:59], v[124:127]
s_add_u32 s64, s85, 1581056
ds_read_b64_tr_b16 a[74:75], v189 offset:36864
v_mfma_f32_16x16x32_bf16 v[128:131], a[112:115], a[56:59], v[128:131]
buffer_load_dwordx4 v13, s[40:43], s64 offen lds
v_mfma_f32_16x16x32_bf16 v[128:131], a[116:119], a[60:63], v[128:131]
ds_read_b64_tr_b16 a[76:77], v189 offset:40960
v_mfma_f32_16x16x32_bf16 v[96:99], a[116:119], a[52:55], v[96:99]
s_add_u32 m0, s86, 67584
ds_read_b64_tr_b16 a[78:79], v189 offset:45056
v_mfma_f32_16x16x32_bf16 v[96:99], a[112:115], a[48:51], v[96:99]
s_add_u32 s64, s85, 1589248
ds_read_b64_tr_b16 a[80:81], v190 offset:32768
v_mfma_f32_16x16x32_bf16 v[64:67], a[112:115], a[40:43], v[64:67]
buffer_load_dwordx4 v12, s[40:43], s64 offen lds
v_mfma_f32_16x16x32_bf16 v[64:67], a[116:119], a[44:47], v[64:67]
ds_read_b64_tr_b16 a[82:83], v190 offset:36864
v_mfma_f32_16x16x32_bf16 v[32:35], a[116:119], a[36:39], v[32:35]
s_add_u32 m0, s86, 68608
ds_read_b64_tr_b16 a[84:85], v190 offset:40960
v_mfma_f32_16x16x32_bf16 v[32:35], a[112:115], a[32:35], v[32:35]
s_add_u32 s64, s85, 1597440
ds_read_b64_tr_b16 a[86:87], v190 offset:45056
v_mfma_f32_16x16x32_bf16 v[36:39], a[120:123], a[32:35], v[36:39]
buffer_load_dwordx4 v13, s[40:43], s64 offen lds
v_mfma_f32_16x16x32_bf16 v[36:39], a[124:127], a[36:39], v[36:39]
v_mfma_f32_16x16x32_bf16 v[68:71], a[124:127], a[44:47], v[68:71]
s_add_u32 m0, s86, 69632
v_mfma_f32_16x16x32_bf16 v[68:71], a[120:123], a[40:43], v[68:71]
s_add_u32 s64, s85, 1605632
v_mfma_f32_16x16x32_bf16 v[100:103], a[120:123], a[48:51], v[100:103]
buffer_load_dwordx4 v12, s[40:43], s64 offen lds
v_mfma_f32_16x16x32_bf16 v[100:103], a[124:127], a[52:55], v[100:103]
s_sub_u32 s70, s70, 1
s_add_u32 s84, s84, 131072
s_add_u32 s85, s85, 1048576
v_mfma_f32_16x16x32_bf16 v[132:135], a[124:127], a[60:63], v[132:135]
s_cmp_lg_u32 s70, 0
v_mfma_f32_16x16x32_bf16 v[132:135], a[120:123], a[56:59], v[132:135]
s_cbranch_scc1 L_p5_2027
s_waitcnt lgkmcnt(10)
s_waitcnt vmcnt(25)
v_mfma_f32_16x16x32_bf16 v[136:139], a[64:67], a[232:235], v[136:139]
s_waitcnt vmcnt(21)
s_waitcnt lgkmcnt(8)
s_add_u32 m0, s86, 70656
ds_read_b64_tr_b16 a[88:89], v191 offset:32768
v_mfma_f32_16x16x32_bf16 v[136:139], a[68:71], a[236:239], v[136:139]
s_add_u32 s64, s85, 565248
ds_read_b64_tr_b16 a[90:91], v191 offset:36864
v_mfma_f32_16x16x32_bf16 v[104:107], a[68:71], a[228:231], v[104:107]
buffer_load_dwordx4 v13, s[40:43], s64 offen lds
v_mfma_f32_16x16x32_bf16 v[104:107], a[64:67], a[224:227], v[104:107]
s_add_u32 m0, s86, 71680
ds_read_b64_tr_b16 a[92:93], v191 offset:40960
v_mfma_f32_16x16x32_bf16 v[72:75], a[64:67], a[216:219], v[72:75]
s_add_u32 s64, s85, 573440
ds_read_b64_tr_b16 a[94:95], v191 offset:45056
v_mfma_f32_16x16x32_bf16 v[72:75], a[68:71], a[220:223], v[72:75]
buffer_load_dwordx4 v12, s[40:43], s64 offen lds
v_mfma_f32_16x16x32_bf16 v[40:43], a[68:71], a[212:215], v[40:43]
s_add_u32 m0, s86, 72704
ds_read_b64_tr_b16 a[96:97], v184 offset:32768
v_mfma_f32_16x16x32_bf16 v[40:43], a[64:67], a[208:211], v[40:43]
s_waitcnt lgkmcnt(5)
s_add_u32 s64, s85, 581632
ds_read_b64_tr_b16 a[98:99], v184 offset:36864
v_mfma_f32_16x16x32_bf16 v[44:47], a[72:75], a[208:211], v[44:47]
buffer_load_dwordx4 v13, s[40:43], s64 offen lds
v_mfma_f32_16x16x32_bf16 v[44:47], a[76:79], a[212:215], v[44:47]
ds_read_b64_tr_b16 a[100:101], v184 offset:40960
v_mfma_f32_16x16x32_bf16 v[76:79], a[76:79], a[220:223], v[76:79]
ds_read_b64_tr_b16 a[102:103], v184 offset:45056
v_mfma_f32_16x16x32_bf16 v[76:79], a[72:75], a[216:219], v[76:79]
s_add_u32 s65, s84, 65536
ds_read_b64_tr_b16 a[104:105], v185 offset:32768
v_mfma_f32_16x16x32_bf16 v[108:111], a[72:75], a[224:227], v[108:111]
buffer_load_dwordx4 a[0:3], v14, s[44:47], s65 offen offset:0 sc1
v_mfma_f32_16x16x32_bf16 v[108:111], a[76:79], a[228:231], v[108:111]
ds_read_b64_tr_b16 a[106:107], v185 offset:36864
v_mfma_f32_16x16x32_bf16 v[140:143], a[76:79], a[236:239], v[140:143]
ds_read_b64_tr_b16 a[108:109], v185 offset:40960
v_mfma_f32_16x16x32_bf16 v[140:143], a[72:75], a[232:235], v[140:143]
buffer_load_dwordx4 a[8:11], v14, s[44:47], s65 offen offset:1024 sc1
v_mfma_f32_16x16x32_bf16 v[144:147], a[80:83], a[232:235], v[144:147]
ds_read_b64_tr_b16 a[110:111], v185 offset:45056
v_mfma_f32_16x16x32_bf16 v[144:147], a[84:87], a[236:239], v[144:147]
v_mfma_f32_16x16x32_bf16 v[112:115], a[84:87], a[228:231], v[112:115]
buffer_load_dwordx4 a[16:19], v15, s[44:47], s65 offen offset:0 sc1
v_mfma_f32_16x16x32_bf16 v[112:115], a[80:83], a[224:227], v[112:115]
ds_read_b64_tr_b16 a[112:113], v186 offset:32768
v_mfma_f32_16x16x32_bf16 v[80:83], a[80:83], a[216:219], v[80:83]
ds_read_b64_tr_b16 a[114:115], v186 offset:36864
v_mfma_f32_16x16x32_bf16 v[80:83], a[84:87], a[220:223], v[80:83]
ds_read_b64_tr_b16 a[116:117], v186 offset:40960
v_mfma_f32_16x16x32_bf16 v[48:51], a[84:87], a[212:215], v[48:51]
buffer_load_dwordx4 a[24:27], v15, s[44:47], s65 offen offset:1024 sc1
v_mfma_f32_16x16x32_bf16 v[48:51], a[80:83], a[208:211], v[48:51]
s_waitcnt lgkmcnt(4)
ds_read_b64_tr_b16 a[118:119], v186 offset:45056
v_mfma_f32_16x16x32_bf16 v[52:55], a[88:91], a[208:211], v[52:55]
s_add_u32 s65, s84, 73728
v_mfma_f32_16x16x32_bf16 v[52:55], a[92:95], a[212:215], v[52:55]
buffer_load_dwordx4 a[4:7], v14, s[44:47], s65 offen offset:0 sc1
v_mfma_f32_16x16x32_bf16 v[84:87], a[92:95], a[220:223], v[84:87]
ds_read_b64_tr_b16 a[120:121], v187 offset:32768
v_mfma_f32_16x16x32_bf16 v[84:87], a[88:91], a[216:219], v[84:87]
ds_read_b64_tr_b16 a[122:123], v187 offset:36864
v_mfma_f32_16x16x32_bf16 v[116:119], a[88:91], a[224:227], v[116:119]
buffer_load_dwordx4 a[12:15], v14, s[44:47], s65 offen offset:1024 sc1
v_mfma_f32_16x16x32_bf16 v[116:119], a[92:95], a[228:231], v[116:119]
ds_read_b64_tr_b16 a[124:125], v187 offset:40960
v_mfma_f32_16x16x32_bf16 v[148:151], a[92:95], a[236:239], v[148:151]
ds_read_b64_tr_b16 a[126:127], v187 offset:45056
v_mfma_f32_16x16x32_bf16 v[148:151], a[88:91], a[232:235], v[148:151]
v_mfma_f32_16x16x32_bf16 v[120:123], a[96:99], a[232:235], v[120:123]
buffer_load_dwordx4 a[20:23], v15, s[44:47], s65 offen offset:0 sc1
v_mfma_f32_16x16x32_bf16 v[120:123], a[100:103], a[236:239], v[120:123]
v_mfma_f32_16x16x32_bf16 v[88:91], a[100:103], a[228:231], v[88:91]
v_mfma_f32_16x16x32_bf16 v[88:91], a[96:99], a[224:227], v[88:91]
buffer_load_dwordx4 a[28:31], v15, s[44:47], s65 offen offset:1024 sc1
v_mfma_f32_16x16x32_bf16 v[56:59], a[96:99], a[216:219], v[56:59]
v_mfma_f32_16x16x32_bf16 v[56:59], a[100:103], a[220:223], v[56:59]
v_mfma_f32_16x16x32_bf16 v[24:27], a[100:103], a[212:215], v[24:27]
v_mfma_f32_16x16x32_bf16 v[24:27], a[96:99], a[208:211], v[24:27]
v_mfma_f32_16x16x32_bf16 v[28:31], a[104:107], a[208:211], v[28:31]
s_waitcnt vmcnt(24)
s_barrier
s_waitcnt lgkmcnt(0)
v_mfma_f32_16x16x32_bf16 v[28:31], a[108:111], a[212:215], v[28:31]
ds_read_b64_tr_b16 a[64:65], v196 offset:0
v_mfma_f32_16x16x32_bf16 v[60:63], a[108:111], a[220:223], v[60:63]
s_add_u32 m0, s86, 98304
ds_read_b64_tr_b16 a[66:67], v196 offset:4096
v_mfma_f32_16x16x32_bf16 v[60:63], a[104:107], a[216:219], v[60:63]
s_add_u32 s64, s85, 786432
ds_read_b64_tr_b16 a[68:69], v196 offset:8192
v_mfma_f32_16x16x32_bf16 v[92:95], a[104:107], a[224:227], v[92:95]
buffer_load_dwordx4 v12, s[40:43], s64 offen lds
v_mfma_f32_16x16x32_bf16 v[92:95], a[108:111], a[228:231], v[92:95]
ds_read_b64_tr_b16 a[70:71], v196 offset:12288
v_mfma_f32_16x16x32_bf16 v[124:127], a[108:111], a[236:239], v[124:127]
s_add_u32 m0, s86, 99328
ds_read_b64_tr_b16 a[72:73], v197 offset:0
v_mfma_f32_16x16x32_bf16 v[124:127], a[104:107], a[232:235], v[124:127]
s_add_u32 s64, s85, 794624
ds_read_b64_tr_b16 a[74:75], v197 offset:4096
v_mfma_f32_16x16x32_bf16 v[128:131], a[112:115], a[232:235], v[128:131]
buffer_load_dwordx4 v13, s[40:43], s64 offen lds
v_mfma_f32_16x16x32_bf16 v[128:131], a[116:119], a[236:239], v[128:131]
ds_read_b64_tr_b16 a[76:77], v197 offset:8192
v_mfma_f32_16x16x32_bf16 v[96:99], a[116:119], a[228:231], v[96:99]
s_add_u32 m0, s86, 100352
ds_read_b64_tr_b16 a[78:79], v197 offset:12288
v_mfma_f32_16x16x32_bf16 v[96:99], a[112:115], a[224:227], v[96:99]
s_add_u32 s64, s85, 802816
ds_read_b64_tr_b16 a[80:81], v198 offset:0
v_mfma_f32_16x16x32_bf16 v[64:67], a[112:115], a[216:219], v[64:67]
buffer_load_dwordx4 v12, s[40:43], s64 offen lds
v_mfma_f32_16x16x32_bf16 v[64:67], a[116:119], a[220:223], v[64:67]
ds_read_b64_tr_b16 a[82:83], v198 offset:4096
v_mfma_f32_16x16x32_bf16 v[32:35], a[116:119], a[212:215], v[32:35]
s_add_u32 m0, s86, 101376
ds_read_b64_tr_b16 a[84:85], v198 offset:8192
v_mfma_f32_16x16x32_bf16 v[32:35], a[112:115], a[208:211], v[32:35]
s_add_u32 s64, s85, 811008
ds_read_b64_tr_b16 a[86:87], v198 offset:12288
v_mfma_f32_16x16x32_bf16 v[36:39], a[120:123], a[208:211], v[36:39]
buffer_load_dwordx4 v13, s[40:43], s64 offen lds
v_mfma_f32_16x16x32_bf16 v[36:39], a[124:127], a[212:215], v[36:39]
v_mfma_f32_16x16x32_bf16 v[68:71], a[124:127], a[220:223], v[68:71]
s_add_u32 m0, s86, 102400
v_mfma_f32_16x16x32_bf16 v[68:71], a[120:123], a[216:219], v[68:71]
s_add_u32 s64, s85, 819200
v_mfma_f32_16x16x32_bf16 v[100:103], a[120:123], a[224:227], v[100:103]
buffer_load_dwordx4 v12, s[40:43], s64 offen lds
v_mfma_f32_16x16x32_bf16 v[100:103], a[124:127], a[228:231], v[100:103]
v_mfma_f32_16x16x32_bf16 v[132:135], a[124:127], a[236:239], v[132:135]
v_mfma_f32_16x16x32_bf16 v[132:135], a[120:123], a[232:235], v[132:135]
s_waitcnt vmcnt(25)
s_waitcnt lgkmcnt(0)
v_mfma_f32_16x16x32_bf16 v[136:139], a[64:67], v[176:179], v[136:139]
s_waitcnt vmcnt(21)
s_add_u32 m0, s86, 103424
ds_read_b64_tr_b16 a[88:89], v199 offset:0
v_mfma_f32_16x16x32_bf16 v[136:139], a[68:71], v[180:183], v[136:139]
s_add_u32 s64, s85, 827392
ds_read_b64_tr_b16 a[90:91], v199 offset:4096
v_mfma_f32_16x16x32_bf16 v[104:107], a[68:71], v[172:175], v[104:107]
buffer_load_dwordx4 v13, s[40:43], s64 offen lds
v_mfma_f32_16x16x32_bf16 v[104:107], a[64:67], v[168:171], v[104:107]
s_add_u32 m0, s86, 104448
ds_read_b64_tr_b16 a[92:93], v199 offset:8192
v_mfma_f32_16x16x32_bf16 v[72:75], a[64:67], v[160:163], v[72:75]
s_add_u32 s64, s85, 835584
ds_read_b64_tr_b16 a[94:95], v199 offset:12288
v_mfma_f32_16x16x32_bf16 v[72:75], a[68:71], v[164:167], v[72:75]
buffer_load_dwordx4 v12, s[40:43], s64 offen lds
v_mfma_f32_16x16x32_bf16 v[40:43], a[68:71], v[156:159], v[40:43]
s_add_u32 m0, s86, 105472
ds_read_b64_tr_b16 a[96:97], v192 offset:0
v_mfma_f32_16x16x32_bf16 v[40:43], a[64:67], v[152:155], v[40:43]
s_add_u32 s64, s85, 843776
ds_read_b64_tr_b16 a[98:99], v192 offset:4096
v_mfma_f32_16x16x32_bf16 v[44:47], a[72:75], v[152:155], v[44:47]
buffer_load_dwordx4 v13, s[40:43], s64 offen lds
v_mfma_f32_16x16x32_bf16 v[44:47], a[76:79], v[156:159], v[44:47]
ds_read_b64_tr_b16 a[100:101], v192 offset:8192
v_mfma_f32_16x16x32_bf16 v[76:79], a[76:79], v[164:167], v[76:79]
ds_read_b64_tr_b16 a[102:103], v192 offset:12288
v_mfma_f32_16x16x32_bf16 v[76:79], a[72:75], v[160:163], v[76:79]
s_add_u32 s65, s84, 98304
ds_read_b64_tr_b16 a[104:105], v193 offset:0
v_mfma_f32_16x16x32_bf16 v[108:111], a[72:75], v[168:171], v[108:111]
buffer_load_dwordx4 a[32:35], v14, s[44:47], s65 offen offset:0 sc1
v_mfma_f32_16x16x32_bf16 v[108:111], a[76:79], v[172:175], v[108:111]
ds_read_b64_tr_b16 a[106:107], v193 offset:4096
v_mfma_f32_16x16x32_bf16 v[140:143], a[76:79], v[180:183], v[140:143]
ds_read_b64_tr_b16 a[108:109], v193 offset:8192
v_mfma_f32_16x16x32_bf16 v[140:143], a[72:75], v[176:179], v[140:143]
buffer_load_dwordx4 a[40:43], v14, s[44:47], s65 offen offset:1024 sc1
v_mfma_f32_16x16x32_bf16 v[144:147], a[80:83], v[176:179], v[144:147]
ds_read_b64_tr_b16 a[110:111], v193 offset:12288
v_mfma_f32_16x16x32_bf16 v[144:147], a[84:87], v[180:183], v[144:147]
v_mfma_f32_16x16x32_bf16 v[112:115], a[84:87], v[172:175], v[112:115]
buffer_load_dwordx4 a[48:51], v15, s[44:47], s65 offen offset:0 sc1
v_mfma_f32_16x16x32_bf16 v[112:115], a[80:83], v[168:171], v[112:115]
ds_read_b64_tr_b16 a[112:113], v194 offset:0
v_mfma_f32_16x16x32_bf16 v[80:83], a[80:83], v[160:163], v[80:83]
ds_read_b64_tr_b16 a[114:115], v194 offset:4096
v_mfma_f32_16x16x32_bf16 v[80:83], a[84:87], v[164:167], v[80:83]
ds_read_b64_tr_b16 a[116:117], v194 offset:8192
v_mfma_f32_16x16x32_bf16 v[48:51], a[84:87], v[156:159], v[48:51]
buffer_load_dwordx4 a[56:59], v15, s[44:47], s65 offen offset:1024 sc1
v_mfma_f32_16x16x32_bf16 v[48:51], a[80:83], v[152:155], v[48:51]
s_waitcnt lgkmcnt(4)
ds_read_b64_tr_b16 a[118:119], v194 offset:12288
v_mfma_f32_16x16x32_bf16 v[52:55], a[88:91], v[152:155], v[52:55]
s_add_u32 s65, s84, 106496
v_mfma_f32_16x16x32_bf16 v[52:55], a[92:95], v[156:159], v[52:55]
buffer_load_dwordx4 a[36:39], v14, s[44:47], s65 offen offset:0 sc1
v_mfma_f32_16x16x32_bf16 v[84:87], a[92:95], v[164:167], v[84:87]
ds_read_b64_tr_b16 a[120:121], v195 offset:0
v_mfma_f32_16x16x32_bf16 v[84:87], a[88:91], v[160:163], v[84:87]
ds_read_b64_tr_b16 a[122:123], v195 offset:4096
v_mfma_f32_16x16x32_bf16 v[116:119], a[88:91], v[168:171], v[116:119]
buffer_load_dwordx4 a[44:47], v14, s[44:47], s65 offen offset:1024 sc1
v_mfma_f32_16x16x32_bf16 v[116:119], a[92:95], v[172:175], v[116:119]
ds_read_b64_tr_b16 a[124:125], v195 offset:8192
v_mfma_f32_16x16x32_bf16 v[148:151], a[92:95], v[180:183], v[148:151]
ds_read_b64_tr_b16 a[126:127], v195 offset:12288
v_mfma_f32_16x16x32_bf16 v[148:151], a[88:91], v[176:179], v[148:151]
v_mfma_f32_16x16x32_bf16 v[120:123], a[96:99], v[176:179], v[120:123]
buffer_load_dwordx4 a[52:55], v15, s[44:47], s65 offen offset:0 sc1
v_mfma_f32_16x16x32_bf16 v[120:123], a[100:103], v[180:183], v[120:123]
v_mfma_f32_16x16x32_bf16 v[88:91], a[100:103], v[172:175], v[88:91]
v_mfma_f32_16x16x32_bf16 v[88:91], a[96:99], v[168:171], v[88:91]
buffer_load_dwordx4 a[60:63], v15, s[44:47], s65 offen offset:1024 sc1
v_mfma_f32_16x16x32_bf16 v[56:59], a[96:99], v[160:163], v[56:59]
v_mfma_f32_16x16x32_bf16 v[56:59], a[100:103], v[164:167], v[56:59]
v_mfma_f32_16x16x32_bf16 v[24:27], a[100:103], v[156:159], v[24:27]
v_mfma_f32_16x16x32_bf16 v[24:27], a[96:99], v[152:155], v[24:27]
v_mfma_f32_16x16x32_bf16 v[28:31], a[104:107], v[152:155], v[28:31]
s_waitcnt vmcnt(24)
s_barrier
s_waitcnt lgkmcnt(0)
v_mfma_f32_16x16x32_bf16 v[28:31], a[108:111], v[156:159], v[28:31]
ds_read_b64_tr_b16 a[64:65], v196 offset:32768
v_mfma_f32_16x16x32_bf16 v[60:63], a[108:111], v[164:167], v[60:63]
ds_read_b64_tr_b16 a[66:67], v196 offset:36864
v_mfma_f32_16x16x32_bf16 v[60:63], a[104:107], v[160:163], v[60:63]
ds_read_b64_tr_b16 a[68:69], v196 offset:40960
v_mfma_f32_16x16x32_bf16 v[92:95], a[104:107], v[168:171], v[92:95]
ds_read_b64_tr_b16 a[70:71], v196 offset:45056
v_mfma_f32_16x16x32_bf16 v[92:95], a[108:111], v[172:175], v[92:95]
ds_read_b64_tr_b16 a[72:73], v197 offset:32768
v_mfma_f32_16x16x32_bf16 v[124:127], a[108:111], v[180:183], v[124:127]
ds_read_b64_tr_b16 a[74:75], v197 offset:36864
v_mfma_f32_16x16x32_bf16 v[124:127], a[104:107], v[176:179], v[124:127]
ds_read_b64_tr_b16 a[76:77], v197 offset:40960
v_mfma_f32_16x16x32_bf16 v[128:131], a[112:115], v[176:179], v[128:131]
ds_read_b64_tr_b16 a[78:79], v197 offset:45056
v_mfma_f32_16x16x32_bf16 v[128:131], a[116:119], v[180:183], v[128:131]
ds_read_b64_tr_b16 a[80:81], v198 offset:32768
v_mfma_f32_16x16x32_bf16 v[96:99], a[116:119], v[172:175], v[96:99]
ds_read_b64_tr_b16 a[82:83], v198 offset:36864
v_mfma_f32_16x16x32_bf16 v[96:99], a[112:115], v[168:171], v[96:99]
ds_read_b64_tr_b16 a[84:85], v198 offset:40960
v_mfma_f32_16x16x32_bf16 v[64:67], a[112:115], v[160:163], v[64:67]
ds_read_b64_tr_b16 a[86:87], v198 offset:45056
v_mfma_f32_16x16x32_bf16 v[64:67], a[116:119], v[164:167], v[64:67]
v_mfma_f32_16x16x32_bf16 v[32:35], a[116:119], v[156:159], v[32:35]
v_mfma_f32_16x16x32_bf16 v[32:35], a[112:115], v[152:155], v[32:35]
v_mfma_f32_16x16x32_bf16 v[36:39], a[120:123], v[152:155], v[36:39]
v_mfma_f32_16x16x32_bf16 v[36:39], a[124:127], v[156:159], v[36:39]
v_mfma_f32_16x16x32_bf16 v[68:71], a[124:127], v[164:167], v[68:71]
v_mfma_f32_16x16x32_bf16 v[68:71], a[120:123], v[160:163], v[68:71]
v_mfma_f32_16x16x32_bf16 v[100:103], a[120:123], v[168:171], v[100:103]
v_mfma_f32_16x16x32_bf16 v[100:103], a[124:127], v[172:175], v[100:103]
v_mfma_f32_16x16x32_bf16 v[132:135], a[124:127], v[180:183], v[132:135]
v_mfma_f32_16x16x32_bf16 v[132:135], a[120:123], v[176:179], v[132:135]
s_waitcnt vmcnt(20)
s_waitcnt lgkmcnt(0)
v_mfma_f32_16x16x32_bf16 v[136:139], a[64:67], a[24:27], v[136:139]
s_waitcnt vmcnt(16)
ds_read_b64_tr_b16 a[88:89], v199 offset:32768
v_mfma_f32_16x16x32_bf16 v[136:139], a[68:71], a[28:31], v[136:139]
ds_read_b64_tr_b16 a[90:91], v199 offset:36864
v_mfma_f32_16x16x32_bf16 v[104:107], a[68:71], a[20:23], v[104:107]
s_xor_b32 s66, s2, 4
s_lshl2_add_u32 s66, s66, s30
ds_read_b64_tr_b16 a[92:93], v199 offset:40960
v_mfma_f32_16x16x32_bf16 v[104:107], a[64:67], a[16:19], v[104:107]
s_lshl_b32 s73, s66, 13
s_add_u32 s73, s73, 67108864
ds_read_b64_tr_b16 a[94:95], v199 offset:45056
v_mfma_f32_16x16x32_bf16 v[72:75], a[64:67], a[8:11], v[72:75]
s_add_u32 s74, s73, 4096
s_lshl_b32 s71, s66, 6
ds_read_b64_tr_b16 a[96:97], v192 offset:32768
v_mfma_f32_16x16x32_bf16 v[72:75], a[68:71], a[12:15], v[72:75]
s_lshl2_add_u32 s66, s2, s30
s_lshl_b32 s72, s66, 6
ds_read_b64_tr_b16 a[98:99], v192 offset:36864
v_mfma_f32_16x16x32_bf16 v[40:43], a[68:71], a[4:7], v[40:43]
s_lshl_b32 s75, s66, 13
s_add_u32 s75, s75, 67108864
ds_read_b64_tr_b16 a[100:101], v192 offset:40960
v_mfma_f32_16x16x32_bf16 v[40:43], a[64:67], a[0:3], v[40:43]
s_add_u32 s76, s75, 4096
s_lshl_b32 s77, s82, 18
ds_read_b64_tr_b16 a[102:103], v192 offset:45056
v_mfma_f32_16x16x32_bf16 v[44:47], a[72:75], a[0:3], v[44:47]
s_lshl_b32 s66, s30, 16
s_add_u32 s77, s77, s66
s_add_u32 s77, s77, s87
v_mfma_f32_16x16x32_bf16 v[44:47], a[76:79], a[4:7], v[44:47]
s_lshl_b32 s66, s83, 7
s_add_u32 s77, s77, s66
s_add_u32 s78, s77, 32768
v_mfma_f32_16x16x32_bf16 v[76:79], a[76:79], a[12:15], v[76:79]
ds_read_b64_tr_b16 a[104:105], v193 offset:32768
v_lshlrev_b32 v1, 24, v0
v_mfma_f32_16x16x32_bf16 v[76:79], a[72:75], a[8:11], v[76:79]
ds_read_b64_tr_b16 a[106:107], v193 offset:36864
v_and_b32 v8, 15, v0
v_mfma_f32_16x16x32_bf16 v[108:111], a[72:75], a[16:19], v[108:111]
ds_read_b64_tr_b16 a[108:109], v193 offset:40960
v_lshlrev_b32 v8, 11, v8
v_mfma_f32_16x16x32_bf16 v[108:111], a[76:79], a[20:23], v[108:111]
ds_read_b64_tr_b16 a[110:111], v193 offset:45056
v_bfe_u32 v10, v0, 4, 1
v_mfma_f32_16x16x32_bf16 v[140:143], a[76:79], a[28:31], v[140:143]
v_lshl_add_u32 v8, v10, 5, v8
v_lshrrev_b32 v10, 5, v0
v_mfma_f32_16x16x32_bf16 v[140:143], a[72:75], a[24:27], v[140:143]
v_lshl_add_u32 v8, v10, 4, v8
v_add_u32 v2, s86, v16
v_mfma_f32_16x16x32_bf16 v[144:147], a[80:83], a[24:27], v[144:147]
v_xor_b32 v3, 0x2000, v2
v_mfma_f32_16x16x32_bf16 v[144:147], a[84:87], a[28:31], v[144:147]
s_add_u32 s52, s28, 59834368
s_addc_u32 s53, s29, 0
s_mov_b32 s54, 65536
v_mfma_f32_16x16x32_bf16 v[112:115], a[84:87], a[20:23], v[112:115]
s_mov_b32 s48, s24
s_mov_b32 s49, s25
ds_read_b64_tr_b16 a[112:113], v194 offset:32768
v_mfma_f32_16x16x32_bf16 v[112:115], a[80:83], a[16:19], v[112:115]
s_mov_b32 s50, 4194304
s_mov_b32 s51, 0x20000
ds_read_b64_tr_b16 a[114:115], v194 offset:36864
v_mfma_f32_16x16x32_bf16 v[80:83], a[80:83], a[8:11], v[80:83]
ds_read_b64_tr_b16 a[116:117], v194 offset:40960
v_mfma_f32_16x16x32_bf16 v[80:83], a[84:87], a[12:15], v[80:83]
ds_read_b64_tr_b16 a[118:119], v194 offset:45056
v_mfma_f32_16x16x32_bf16 v[48:51], a[84:87], a[4:7], v[48:51]
v_mfma_f32_16x16x32_bf16 v[48:51], a[80:83], a[0:3], v[48:51]
s_waitcnt lgkmcnt(4)
v_mfma_f32_16x16x32_bf16 v[52:55], a[88:91], a[0:3], v[52:55]
v_mfma_f32_16x16x32_bf16 v[52:55], a[92:95], a[4:7], v[52:55]
v_mfma_f32_16x16x32_bf16 v[84:87], a[92:95], a[12:15], v[84:87]
ds_read_b64_tr_b16 a[120:121], v195 offset:32768
v_mfma_f32_16x16x32_bf16 v[84:87], a[88:91], a[8:11], v[84:87]
ds_read_b64_tr_b16 a[122:123], v195 offset:36864
v_mfma_f32_16x16x32_bf16 v[116:119], a[88:91], a[16:19], v[116:119]
ds_read_b64_tr_b16 a[124:125], v195 offset:40960
v_mfma_f32_16x16x32_bf16 v[116:119], a[92:95], a[20:23], v[116:119]
ds_read_b64_tr_b16 a[126:127], v195 offset:45056
v_mfma_f32_16x16x32_bf16 v[148:151], a[92:95], a[28:31], v[148:151]
v_mfma_f32_16x16x32_bf16 v[148:151], a[88:91], a[24:27], v[148:151]
v_mfma_f32_16x16x32_bf16 v[120:123], a[96:99], a[24:27], v[120:123]
v_mfma_f32_16x16x32_bf16 v[120:123], a[100:103], a[28:31], v[120:123]
v_mfma_f32_16x16x32_bf16 v[88:91], a[100:103], a[20:23], v[88:91]
v_mfma_f32_16x16x32_bf16 v[88:91], a[96:99], a[16:19], v[88:91]
v_mfma_f32_16x16x32_bf16 v[56:59], a[96:99], a[8:11], v[56:59]
v_mfma_f32_16x16x32_bf16 v[56:59], a[100:103], a[12:15], v[56:59]
v_mfma_f32_16x16x32_bf16 v[24:27], a[100:103], a[4:7], v[24:27]
v_mfma_f32_16x16x32_bf16 v[24:27], a[96:99], a[0:3], v[24:27]
v_mfma_f32_16x16x32_bf16 v[28:31], a[104:107], a[0:3], v[28:31]
s_waitcnt vmcnt(8)
s_barrier
v_mfma_f32_16x16x32_bf16 v[28:31], a[108:111], a[4:7], v[28:31]
ds_read_b64_tr_b16 a[64:65], v188 offset:0
v_mfma_f32_16x16x32_bf16 v[60:63], a[108:111], a[12:15], v[60:63]
ds_read_b64_tr_b16 a[66:67], v188 offset:4096
v_mfma_f32_16x16x32_bf16 v[60:63], a[104:107], a[8:11], v[60:63]
ds_read_b64_tr_b16 a[68:69], v188 offset:8192
v_mfma_f32_16x16x32_bf16 v[92:95], a[104:107], a[16:19], v[92:95]
ds_read_b64_tr_b16 a[70:71], v188 offset:12288
v_mfma_f32_16x16x32_bf16 v[92:95], a[108:111], a[20:23], v[92:95]
ds_read_b64_tr_b16 a[72:73], v189 offset:0
v_mfma_f32_16x16x32_bf16 v[124:127], a[108:111], a[28:31], v[124:127]
ds_read_b64_tr_b16 a[74:75], v189 offset:4096
v_mfma_f32_16x16x32_bf16 v[124:127], a[104:107], a[24:27], v[124:127]
s_waitcnt lgkmcnt(6)
ds_read_b64_tr_b16 a[76:77], v189 offset:8192
v_mfma_f32_16x16x32_bf16 v[128:131], a[112:115], a[24:27], v[128:131]
ds_read_b64_tr_b16 a[78:79], v189 offset:12288
v_mfma_f32_16x16x32_bf16 v[128:131], a[116:119], a[28:31], v[128:131]
ds_read_b64_tr_b16 a[80:81], v190 offset:0
v_mfma_f32_16x16x32_bf16 v[96:99], a[116:119], a[20:23], v[96:99]
ds_read_b64_tr_b16 a[82:83], v190 offset:4096
v_mfma_f32_16x16x32_bf16 v[96:99], a[112:115], a[16:19], v[96:99]
ds_read_b64_tr_b16 a[84:85], v190 offset:8192
v_mfma_f32_16x16x32_bf16 v[64:67], a[112:115], a[8:11], v[64:67]
ds_read_b64_tr_b16 a[86:87], v190 offset:12288
v_mfma_f32_16x16x32_bf16 v[64:67], a[116:119], a[12:15], v[64:67]
v_mfma_f32_16x16x32_bf16 v[32:35], a[116:119], a[4:7], v[32:35]
v_mfma_f32_16x16x32_bf16 v[32:35], a[112:115], a[0:3], v[32:35]
v_mfma_f32_16x16x32_bf16 v[36:39], a[120:123], a[0:3], v[36:39]
v_mfma_f32_16x16x32_bf16 v[36:39], a[124:127], a[4:7], v[36:39]
v_mfma_f32_16x16x32_bf16 v[68:71], a[124:127], a[12:15], v[68:71]
v_mfma_f32_16x16x32_bf16 v[68:71], a[120:123], a[8:11], v[68:71]
v_mfma_f32_16x16x32_bf16 v[100:103], a[120:123], a[16:19], v[100:103]
v_mfma_f32_16x16x32_bf16 v[100:103], a[124:127], a[20:23], v[100:103]
v_mfma_f32_16x16x32_bf16 v[132:135], a[124:127], a[28:31], v[132:135]
v_mfma_f32_16x16x32_bf16 v[132:135], a[120:123], a[24:27], v[132:135]
s_waitcnt vmcnt(4)
s_waitcnt lgkmcnt(0)
v_mfma_f32_16x16x32_bf16 v[136:139], a[64:67], a[56:59], v[136:139]
s_waitcnt vmcnt(0)
ds_read_b64_tr_b16 a[88:89], v191 offset:0
v_mfma_f32_16x16x32_bf16 v[136:139], a[68:71], a[60:63], v[136:139]
ds_read_b64_tr_b16 a[90:91], v191 offset:4096
v_mfma_f32_16x16x32_bf16 v[104:107], a[68:71], a[52:55], v[104:107]
ds_read_b64_tr_b16 a[92:93], v191 offset:8192
v_mfma_f32_16x16x32_bf16 v[104:107], a[64:67], a[48:51], v[104:107]
ds_read_b64_tr_b16 a[94:95], v191 offset:12288
v_mfma_f32_16x16x32_bf16 v[72:75], a[64:67], a[40:43], v[72:75]
ds_read_b64_tr_b16 a[96:97], v184 offset:0
v_mfma_f32_16x16x32_bf16 v[72:75], a[68:71], a[44:47], v[72:75]
ds_read_b64_tr_b16 a[98:99], v184 offset:4096
v_mfma_f32_16x16x32_bf16 v[40:43], a[68:71], a[36:39], v[40:43]
ds_read_b64_tr_b16 a[100:101], v184 offset:8192
v_mfma_f32_16x16x32_bf16 v[40:43], a[64:67], a[32:35], v[40:43]
ds_read_b64_tr_b16 a[102:103], v184 offset:12288
v_mfma_f32_16x16x32_bf16 v[44:47], a[72:75], a[32:35], v[44:47]
v_mfma_f32_16x16x32_bf16 v[44:47], a[76:79], a[36:39], v[44:47]
v_mfma_f32_16x16x32_bf16 v[76:79], a[76:79], a[44:47], v[76:79]
ds_read_b64_tr_b16 a[104:105], v185 offset:0
v_mfma_f32_16x16x32_bf16 v[76:79], a[72:75], a[40:43], v[76:79]
ds_read_b64_tr_b16 a[106:107], v185 offset:4096
v_mfma_f32_16x16x32_bf16 v[108:111], a[72:75], a[48:51], v[108:111]
ds_read_b64_tr_b16 a[108:109], v185 offset:8192
v_mfma_f32_16x16x32_bf16 v[108:111], a[76:79], a[52:55], v[108:111]
ds_read_b64_tr_b16 a[110:111], v185 offset:12288
v_mfma_f32_16x16x32_bf16 v[140:143], a[76:79], a[60:63], v[140:143]
ds_write_b128 v3, v[104:107] offset:0
v_mfma_f32_16x16x32_bf16 v[140:143], a[72:75], a[56:59], v[140:143]
ds_write_b128 v3, v[136:139] offset:4096
v_mfma_f32_16x16x32_bf16 v[144:147], a[80:83], a[56:59], v[144:147]
v_mfma_f32_16x16x32_bf16 v[144:147], a[84:87], a[60:63], v[144:147]
v_mfma_f32_16x16x32_bf16 v[112:115], a[84:87], a[52:55], v[112:115]
ds_read_b64_tr_b16 a[112:113], v186 offset:0
v_mfma_f32_16x16x32_bf16 v[112:115], a[80:83], a[48:51], v[112:115]
ds_read_b64_tr_b16 a[114:115], v186 offset:4096
v_mfma_f32_16x16x32_bf16 v[80:83], a[80:83], a[40:43], v[80:83]
ds_read_b64_tr_b16 a[116:117], v186 offset:8192
v_mfma_f32_16x16x32_bf16 v[80:83], a[84:87], a[44:47], v[80:83]
ds_read_b64_tr_b16 a[118:119], v186 offset:12288
v_mfma_f32_16x16x32_bf16 v[48:51], a[84:87], a[36:39], v[48:51]
ds_write_b128 v3, v[108:111] offset:1024
v_mfma_f32_16x16x32_bf16 v[48:51], a[80:83], a[32:35], v[48:51]
s_waitcnt lgkmcnt(5)
ds_write_b128 v3, v[140:143] offset:5120
v_mfma_f32_16x16x32_bf16 v[52:55], a[88:91], a[32:35], v[52:55]
v_mfma_f32_16x16x32_bf16 v[52:55], a[92:95], a[36:39], v[52:55]
v_mfma_f32_16x16x32_bf16 v[84:87], a[92:95], a[44:47], v[84:87]
ds_read_b64_tr_b16 a[120:121], v187 offset:0
v_mfma_f32_16x16x32_bf16 v[84:87], a[88:91], a[40:43], v[84:87]
ds_read_b64_tr_b16 a[122:123], v187 offset:4096
v_mfma_f32_16x16x32_bf16 v[116:119], a[88:91], a[48:51], v[116:119]
ds_read_b64_tr_b16 a[124:125], v187 offset:8192
v_mfma_f32_16x16x32_bf16 v[116:119], a[92:95], a[52:55], v[116:119]
ds_read_b64_tr_b16 a[126:127], v187 offset:12288
v_mfma_f32_16x16x32_bf16 v[148:151], a[92:95], a[60:63], v[148:151]
ds_write_b128 v3, v[112:115] offset:2048
v_mfma_f32_16x16x32_bf16 v[148:151], a[88:91], a[56:59], v[148:151]
ds_write_b128 v3, v[144:147] offset:6144
v_mfma_f32_16x16x32_bf16 v[120:123], a[96:99], a[56:59], v[120:123]
v_mfma_f32_16x16x32_bf16 v[120:123], a[100:103], a[60:63], v[120:123]
v_mfma_f32_16x16x32_bf16 v[88:91], a[100:103], a[52:55], v[88:91]
v_mfma_f32_16x16x32_bf16 v[88:91], a[96:99], a[48:51], v[88:91]
v_mfma_f32_16x16x32_bf16 v[56:59], a[96:99], a[40:43], v[56:59]
v_mfma_f32_16x16x32_bf16 v[56:59], a[100:103], a[44:47], v[56:59]
ds_write_b128 v3, v[116:119] offset:3072
v_mfma_f32_16x16x32_bf16 v[24:27], a[100:103], a[36:39], v[24:27]
v_mfma_f32_16x16x32_bf16 v[24:27], a[96:99], a[32:35], v[24:27]
ds_write_b128 v3, v[148:151] offset:7168
v_mfma_f32_16x16x32_bf16 v[28:31], a[104:107], a[32:35], v[28:31]
v_mfma_f32_16x16x32_bf16 v[28:31], a[108:111], a[36:39], v[28:31]
v_mfma_f32_16x16x32_bf16 v[60:63], a[108:111], a[44:47], v[60:63]
s_waitcnt lgkmcnt(0)
s_barrier
v_mfma_f32_16x16x32_bf16 v[60:63], a[104:107], a[40:43], v[60:63]
ds_read_b128 v[200:203], v2 offset:0
v_mfma_f32_16x16x32_bf16 v[92:95], a[104:107], a[48:51], v[92:95]
ds_read_b128 v[204:207], v2 offset:1024
v_mfma_f32_16x16x32_bf16 v[92:95], a[108:111], a[52:55], v[92:95]
ds_read_b128 v[208:211], v2 offset:2048
v_mfma_f32_16x16x32_bf16 v[124:127], a[108:111], a[60:63], v[124:127]
ds_read_b128 v[212:215], v2 offset:3072
v_mfma_f32_16x16x32_bf16 v[124:127], a[104:107], a[56:59], v[124:127]
ds_read_b128 v[216:219], v2 offset:4096
v_mfma_f32_16x16x32_bf16 v[128:131], a[112:115], a[56:59], v[128:131]
ds_read_b128 v[220:223], v2 offset:5120
v_mfma_f32_16x16x32_bf16 v[128:131], a[116:119], a[60:63], v[128:131]
ds_read_b128 v[224:227], v2 offset:6144
v_mfma_f32_16x16x32_bf16 v[96:99], a[116:119], a[52:55], v[96:99]
s_waitcnt lgkmcnt(6)
ds_read_b128 v[228:231], v2 offset:7168
v_add_f32 v200, v200, v40
v_mfma_f32_16x16x32_bf16 v[96:99], a[112:115], a[48:51], v[96:99]
v_add_f32 v201, v201, v41
v_add_f32 v202, v202, v42
v_mfma_f32_16x16x32_bf16 v[64:67], a[112:115], a[40:43], v[64:67]
v_add_f32 v203, v203, v43
v_mfma_f32_16x16x32_bf16 v[64:67], a[116:119], a[44:47], v[64:67]
buffer_store_dwordx4 v[200:203], v16, s[44:47], s73 offen offset:0 sc1
v_mfma_f32_16x16x32_bf16 v[32:35], a[116:119], a[36:39], v[32:35]
s_waitcnt lgkmcnt(4)
v_add_f32 v204, v204, v44
v_add_f32 v205, v205, v45
v_mfma_f32_16x16x32_bf16 v[32:35], a[112:115], a[32:35], v[32:35]
v_add_f32 v206, v206, v46
v_add_f32 v207, v207, v47
v_mfma_f32_16x16x32_bf16 v[36:39], a[120:123], a[32:35], v[36:39]
buffer_store_dwordx4 v[204:207], v16, s[44:47], s73 offen offset:1024 sc1
v_mfma_f32_16x16x32_bf16 v[36:39], a[124:127], a[36:39], v[36:39]
v_add_f32 v208, v208, v48
v_add_f32 v209, v209, v49
v_mfma_f32_16x16x32_bf16 v[68:71], a[124:127], a[44:47], v[68:71]
v_add_f32 v210, v210, v50
v_add_f32 v211, v211, v51
v_mfma_f32_16x16x32_bf16 v[68:71], a[120:123], a[40:43], v[68:71]
buffer_store_dwordx4 v[208:211], v16, s[44:47], s73 offen offset:2048 sc1
v_mfma_f32_16x16x32_bf16 v[100:103], a[120:123], a[48:51], v[100:103]
v_add_f32 v212, v212, v52
v_add_f32 v213, v213, v53
v_mfma_f32_16x16x32_bf16 v[100:103], a[124:127], a[52:55], v[100:103]
v_add_f32 v214, v214, v54
v_add_f32 v215, v215, v55
v_mfma_f32_16x16x32_bf16 v[132:135], a[124:127], a[60:63], v[132:135]
buffer_store_dwordx4 v[212:215], v16, s[44:47], s73 offen offset:3072 sc1
v_mfma_f32_16x16x32_bf16 v[132:135], a[120:123], a[56:59], v[132:135]
s_waitcnt lgkmcnt(0)
v_add_f32 v216, v216, v72
v_add_f32 v217, v217, v73
v_add_f32 v218, v218, v74
v_add_f32 v219, v219, v75
buffer_store_dwordx4 v[216:219], v16, s[44:47], s74 offen offset:0 sc1
v_add_f32 v220, v220, v76
v_add_f32 v221, v221, v77
v_add_f32 v222, v222, v78
v_add_f32 v223, v223, v79
buffer_store_dwordx4 v[220:223], v16, s[44:47], s74 offen offset:1024 sc1
v_add_f32 v224, v224, v80
v_add_f32 v225, v225, v81
v_add_f32 v226, v226, v82
v_add_f32 v227, v227, v83
buffer_store_dwordx4 v[224:227], v16, s[44:47], s74 offen offset:2048 sc1
v_add_f32 v228, v228, v84
v_add_f32 v229, v229, v85
v_add_f32 v230, v230, v86
v_add_f32 v231, v231, v87
buffer_store_dwordx4 v[228:231], v16, s[44:47], s74 offen offset:3072 sc1
s_nop 4
ds_write_b128 v3, v[88:91] offset:32768
ds_write_b128 v3, v[120:123] offset:36864
ds_write_b128 v3, v[92:95] offset:33792
ds_write_b128 v3, v[124:127] offset:37888
ds_write_b128 v3, v[96:99] offset:34816
ds_write_b128 v3, v[128:131] offset:38912
ds_write_b128 v3, v[100:103] offset:35840
ds_write_b128 v3, v[132:135] offset:39936
s_waitcnt lgkmcnt(0)
s_barrier
ds_read_b128 v[88:91], v2 offset:32768
ds_read_b128 v[92:95], v2 offset:33792
ds_read_b128 v[96:99], v2 offset:34816
ds_read_b128 v[100:103], v2 offset:35840
ds_read_b128 v[120:123], v2 offset:36864
ds_read_b128 v[124:127], v2 offset:37888
ds_read_b128 v[128:131], v2 offset:38912
ds_read_b128 v[132:135], v2 offset:39936
s_waitcnt vmcnt(0)
buffer_store_dword a251, v1, s[52:55], s71 offen sc1
buffer_load_dword v19, off, s[52:55], s72 sc1
s_waitcnt lgkmcnt(7)
v_add_f32 v24, v24, v88
v_add_f32 v25, v25, v89
v_add_f32 v26, v26, v90
v_add_f32 v27, v27, v91
s_waitcnt lgkmcnt(6)
v_add_f32 v28, v28, v92
v_add_f32 v29, v29, v93
v_add_f32 v30, v30, v94
v_add_f32 v31, v31, v95
s_waitcnt lgkmcnt(5)
v_add_f32 v32, v32, v96
v_add_f32 v33, v33, v97
v_add_f32 v34, v34, v98
v_add_f32 v35, v35, v99
s_waitcnt lgkmcnt(4)
v_add_f32 v36, v36, v100
v_add_f32 v37, v37, v101
v_add_f32 v38, v38, v102
v_add_f32 v39, v39, v103
s_waitcnt lgkmcnt(3)
v_add_f32 v56, v56, v120
v_add_f32 v57, v57, v121
v_add_f32 v58, v58, v122
v_add_f32 v59, v59, v123
s_waitcnt lgkmcnt(2)
v_add_f32 v60, v60, v124
v_add_f32 v61, v61, v125
v_add_f32 v62, v62, v126
v_add_f32 v63, v63, v127
s_waitcnt lgkmcnt(1)
v_add_f32 v64, v64, v128
v_add_f32 v65, v65, v129
v_add_f32 v66, v66, v130
v_add_f32 v67, v67, v131
s_waitcnt lgkmcnt(0)
v_add_f32 v68, v68, v132
v_add_f32 v69, v69, v133
v_add_f32 v70, v70, v134
v_add_f32 v71, v71, v135
s_waitcnt vmcnt(0)
v_readfirstlane_b32 s66, v19
s_nop 0
s_cmp_lt_u32 s66, 1
s_cbranch_scc1 L_spin_2028
L_spinbk_2029:
buffer_load_dwordx4 v[40:43], v16, s[44:47], s75 offen offset:0 sc1
buffer_load_dwordx4 v[44:47], v16, s[44:47], s75 offen offset:1024 sc1
buffer_load_dwordx4 v[48:51], v16, s[44:47], s75 offen offset:2048 sc1
buffer_load_dwordx4 v[52:55], v16, s[44:47], s75 offen offset:3072 sc1
buffer_load_dwordx4 v[72:75], v16, s[44:47], s76 offen offset:0 sc1
buffer_load_dwordx4 v[76:79], v16, s[44:47], s76 offen offset:1024 sc1
buffer_load_dwordx4 v[80:83], v16, s[44:47], s76 offen offset:2048 sc1
buffer_load_dwordx4 v[84:87], v16, s[44:47], s76 offen offset:3072 sc1
s_waitcnt vmcnt(7)
v_add_f32 v24, v24, v40
v_add_f32 v25, v25, v41
v_add_f32 v26, v26, v42
v_add_f32 v27, v27, v43
s_waitcnt vmcnt(6)
v_add_f32 v28, v28, v44
v_add_f32 v29, v29, v45
v_add_f32 v30, v30, v46
v_add_f32 v31, v31, v47
v_cvt_pk_bf16_f32 v24, v24, v25
v_cvt_pk_bf16_f32 v25, v26, v27
v_cvt_pk_bf16_f32 v26, v28, v29
v_cvt_pk_bf16_f32 v27, v30, v31
s_nop 1
v_permlane16_swap_b32 v24, v26
v_permlane16_swap_b32 v25, v27
buffer_store_dwordx4 v[24:27], v8, s[48:51], s77 offen offset:0
s_waitcnt vmcnt(6)
v_add_f32 v32, v32, v48
v_add_f32 v33, v33, v49
v_add_f32 v34, v34, v50
v_add_f32 v35, v35, v51
s_waitcnt vmcnt(5)
v_add_f32 v36, v36, v52
v_add_f32 v37, v37, v53
v_add_f32 v38, v38, v54
v_add_f32 v39, v39, v55
v_cvt_pk_bf16_f32 v32, v32, v33
v_cvt_pk_bf16_f32 v33, v34, v35
v_cvt_pk_bf16_f32 v34, v36, v37
v_cvt_pk_bf16_f32 v35, v38, v39
s_nop 1
v_permlane16_swap_b32 v32, v34
v_permlane16_swap_b32 v33, v35
buffer_store_dwordx4 v[32:35], v8, s[48:51], s77 offen offset:64
s_waitcnt vmcnt(5)
v_add_f32 v56, v56, v72
v_add_f32 v57, v57, v73
v_add_f32 v58, v58, v74
v_add_f32 v59, v59, v75
s_waitcnt vmcnt(4)
v_add_f32 v60, v60, v76
v_add_f32 v61, v61, v77
v_add_f32 v62, v62, v78
v_add_f32 v63, v63, v79
v_cvt_pk_bf16_f32 v56, v56, v57
v_cvt_pk_bf16_f32 v57, v58, v59
v_cvt_pk_bf16_f32 v58, v60, v61
v_cvt_pk_bf16_f32 v59, v62, v63
s_nop 1
v_permlane16_swap_b32 v56, v58
v_permlane16_swap_b32 v57, v59
buffer_store_dwordx4 v[56:59], v8, s[48:51], s78 offen offset:0
s_waitcnt vmcnt(4)
v_add_f32 v64, v64, v80
v_add_f32 v65, v65, v81
v_add_f32 v66, v66, v82
v_add_f32 v67, v67, v83
s_waitcnt vmcnt(3)
v_add_f32 v68, v68, v84
v_add_f32 v69, v69, v85
v_add_f32 v70, v70, v86
v_add_f32 v71, v71, v87
v_cvt_pk_bf16_f32 v64, v64, v65
v_cvt_pk_bf16_f32 v65, v66, v67
v_cvt_pk_bf16_f32 v66, v68, v69
v_cvt_pk_bf16_f32 v67, v70, v71
s_nop 1
v_permlane16_swap_b32 v64, v66
v_permlane16_swap_b32 v65, v67
buffer_store_dwordx4 v[64:67], v8, s[48:51], s78 offen offset:64
L_end:
s_endpgm
L_spin_1:
s_mov_b32 s67, 0x8000
L_spinlp_3:
s_sleep 1
buffer_load_dword v1, off, s[52:55], s78 offset:0 sc1
s_waitcnt vmcnt(0)
v_readfirstlane_b32 s66, v1
s_sub_u32 s67, s67, 1
s_cbranch_scc1 L_spinbk_2
s_cmp_lt_u32 s66, s81
s_cbranch_scc1 L_spinlp_3
s_branch L_spinbk_2
L_spin_4:
s_mov_b32 s67, 0x8000
L_spinlp_6:
s_sleep 1
buffer_load_dword v1, off, s[52:55], s80 offset:0 sc1
s_waitcnt vmcnt(0)
v_readfirstlane_b32 s66, v1
s_sub_u32 s67, s67, 1
s_cbranch_scc1 L_spinbk_5
s_cmp_lt_u32 s66, s82
s_cbranch_scc1 L_spinlp_6
s_branch L_spinbk_5
L_spin_16:
s_mov_b32 s67, 0x8000
L_spinlp_18:
s_sleep 1
buffer_load_dword v19, off, s[52:55], s80 offset:0 sc1
s_waitcnt vmcnt(0)
v_readfirstlane_b32 s66, v19
s_sub_u32 s67, s67, 1
s_cbranch_scc1 L_spinbk_17
s_cmp_lt_u32 s66, 16
s_cbranch_scc1 L_spinlp_18
s_branch L_spinbk_17
L_spin_1020:
s_mov_b32 s67, 0x8000
L_spinlp_1022:
s_sleep 1
buffer_load_dword v19, off, s[52:55], s80 offset:0 sc1
s_waitcnt vmcnt(0)
v_readfirstlane_b32 s66, v19
s_sub_u32 s67, s67, 1
s_cbranch_scc1 L_spinbk_1021
s_cmp_lt_u32 s66, 16
s_cbranch_scc1 L_spinlp_1022
s_branch L_spinbk_1021
L_F1_7:
ds_read_b128 a[144:147], v2 offset:0
ds_read_b128 a[148:151], v2 offset:1024
ds_read_b128 a[152:155], v2 offset:2048
ds_read_b128 a[156:159], v2 offset:3072
ds_read_b128 a[160:163], v2 offset:4096
ds_read_b128 a[164:167], v2 offset:5120
ds_read_b128 a[168:171], v2 offset:6144
ds_read_b128 a[172:175], v2 offset:7168
s_mov_b32 m0, s71
s_nop 0
buffer_load_dwordx4 v16, s[32:35], s70 offen offset:0 sc1 lds
buffer_load_dwordx4 v16, s[32:35], s70 offen offset:1024 sc1 lds
s_waitcnt lgkmcnt(7)
v_mfma_f32_16x16x32_bf16 v[104:107], a[144:147], v[40:43], 0
s_waitcnt lgkmcnt(6)
ds_read_b128 a[176:179], v2 offset:8192
v_cndmask_b32 v88, 0, v17, s[0:1]
v_mfma_f32_16x16x32_bf16 v[104:107], a[148:151], v[44:47], v[104:107]
s_waitcnt lgkmcnt(6)
ds_read_b128 a[180:183], v2 offset:9216
v_cndmask_b32 v89, 0, v17, s[4:5]
v_mfma_f32_16x16x32_bf16 v[104:107], a[152:155], v[48:51], v[104:107]
s_waitcnt lgkmcnt(6)
buffer_load_dwordx4 v16, s[32:35], s70 offen offset:2048 sc1 lds
v_mfma_f32_16x16x32_bf16 v[104:107], a[156:159], v[52:55], v[104:107]
ds_read_b128 a[184:187], v2 offset:10240
v_cndmask_b32 v90, 0, v17, s[6:7]
v_mfma_f32_16x16x32_bf16 v[120:123], a[156:159], v[68:71], 0
ds_read_b128 a[188:191], v2 offset:11264
v_cndmask_b32 v91, 0, v17, s[8:9]
v_mfma_f32_16x16x32_bf16 v[120:123], a[152:155], v[64:67], v[120:123]
ds_read_b128 a[192:195], v2 offset:12288
ds_read_b128 a[196:199], v2 offset:13312
v_mfma_f32_16x16x32_bf16 v[120:123], a[148:151], v[60:63], v[120:123]
ds_read_b128 a[200:203], v2 offset:14336
v_mfma_f32_16x16x32_bf16 v[120:123], a[144:147], v[56:59], v[120:123]
ds_read_b128 a[204:207], v2 offset:15360
v_mfma_f32_16x16x32_bf16 v[136:139], a[144:147], v[72:75], 0
v_mfma_f32_16x16x32_bf16 v[136:139], a[148:151], v[76:79], v[136:139]
buffer_load_dwordx4 v16, s[32:35], s70 offen offset:3072 sc1 lds
v_mfma_f32_16x16x32_bf16 v[136:139], a[152:155], v[80:83], v[136:139]
v_mfma_f32_16x16x32_bf16 v[136:139], a[156:159], v[84:87], v[136:139]
v_mfma_f32_16x16x32_bf16 v[88:91], a[156:159], v[36:39], v[88:91]
v_mfma_f32_16x16x32_bf16 v[88:91], a[152:155], v[32:35], v[88:91]
v_mfma_f32_16x16x32_bf16 v[88:91], a[148:151], v[28:31], v[88:91]
v_mfma_f32_16x16x32_bf16 v[88:91], a[144:147], v[24:27], v[88:91]
s_waitcnt lgkmcnt(0)
s_nop 1
v_max3_f32 v21, v104, v105, v106
v_max_f32 v21, v21, v107
v_max3_f32 v22, v120, v121, v122
v_max_f32 v22, v22, v123
v_max3_f32 v23, v136, v137, v138
v_max_f32 v23, v23, v139
v_max3_f32 v20, v88, v89, v90
v_max_f32 v20, v20, v91
v_mov_b32 v248, v20
v_mov_b32 v249, v21
v_mov_b32 v250, v22
v_mov_b32 v251, v23
v_permlane16_swap_b32 v248, v20
v_permlane16_swap_b32 v249, v21
v_permlane16_swap_b32 v250, v22
v_permlane16_swap_b32 v251, v23
v_max_f32 v20, v20, v248
v_max_f32 v21, v21, v249
v_max_f32 v22, v22, v250
v_max_f32 v23, v23, v251
v_mov_b32 v248, v20
v_mov_b32 v249, v21
v_mov_b32 v250, v22
v_mov_b32 v251, v23
v_permlane32_swap_b32 v248, v20
v_permlane32_swap_b32 v249, v21
v_permlane32_swap_b32 v250, v22
v_permlane32_swap_b32 v251, v23
v_max_f32 v20, v20, v248
v_max_f32 v21, v21, v249
v_max_f32 v22, v22, v250
v_max_f32 v23, v23, v251
s_cmp_eq_u32 s73, 0
s_cselect_b64 vcc, 0, -1
v_cndmask_b32 v20, v20, v252, vcc
v_cndmask_b32 v21, v21, v253, vcc
v_cndmask_b32 v22, v22, v254, vcc
v_cndmask_b32 v23, v23, v255, vcc
v_sub_f32 v228, 0, v23
v_sub_f32 v229, 0, v23
v_sub_f32 v230, 0, v23
v_sub_f32 v231, 0, v23
v_sub_f32 v224, 0, v22
v_sub_f32 v225, 0, v22
v_sub_f32 v226, 0, v22
v_sub_f32 v227, 0, v22
v_sub_f32 v220, 0, v21
v_sub_f32 v221, 0, v21
v_sub_f32 v222, 0, v21
v_sub_f32 v223, 0, v21
v_sub_f32 v216, 0, v20
v_sub_f32 v217, 0, v20
v_sub_f32 v218, 0, v20
v_sub_f32 v219, 0, v20
v_mfma_f32_16x16x32_bf16 v[140:143], a[160:163], v[72:75], v[228:231]
s_add_u32 m0, s71, 4096
v_add_f32 v104, v104, v220
v_add_f32 v105, v105, v220
v_mfma_f32_16x16x32_bf16 v[140:143], a[164:167], v[76:79], v[140:143]
v_add_f32 v106, v106, v220
v_add_f32 v107, v107, v220
v_exp_f32 v104, v104
v_mfma_f32_16x16x32_bf16 v[140:143], a[168:171], v[80:83], v[140:143]
s_add_u32 s64, s70, 4096
v_exp_f32 v105, v105
v_mfma_f32_16x16x32_bf16 v[140:143], a[172:175], v[84:87], v[140:143]
buffer_load_dwordx4 v16, s[32:35], s64 offen offset:0 sc1 lds
v_mfma_f32_16x16x32_bf16 v[124:127], a[172:175], v[68:71], v[224:227]
v_exp_f32 v106, v106
v_mfma_f32_16x16x32_bf16 v[124:127], a[168:171], v[64:67], v[124:127]
v_exp_f32 v107, v107
v_mfma_f32_16x16x32_bf16 v[124:127], a[164:167], v[60:63], v[124:127]
v_add_f32 v120, v120, v224
v_add_f32 v121, v121, v224
v_add_f32 v122, v122, v224
v_add_f32 v123, v123, v224
v_exp_f32 v120, v120
v_mfma_f32_16x16x32_bf16 v[124:127], a[160:163], v[56:59], v[124:127]
v_exp_f32 v121, v121
v_mfma_f32_16x16x32_bf16 v[108:111], a[160:163], v[40:43], v[220:223]
v_exp_f32 v122, v122
v_mfma_f32_16x16x32_bf16 v[108:111], a[164:167], v[44:47], v[108:111]
v_cndmask_b32 v92, v216, v17, s[10:11]
v_cndmask_b32 v93, v216, v17, s[12:13]
v_cndmask_b32 v94, v216, v17, s[18:19]
v_cndmask_b32 v95, v216, v17, s[22:23]
v_mfma_f32_16x16x32_bf16 v[108:111], a[168:171], v[48:51], v[108:111]
buffer_load_dwordx4 v16, s[32:35], s64 offen offset:1024 sc1 lds
v_cvt_pk_bf16_f32 v160, v104, v105
v_mfma_f32_16x16x32_bf16 v[108:111], a[172:175], v[52:55], v[108:111]
v_exp_f32 v123, v123
v_mfma_f32_16x16x32_bf16 v[92:95], a[172:175], v[36:39], v[92:95]
v_add_f32 v136, v136, v228
v_add_f32 v137, v137, v228
v_add_f32 v138, v138, v228
v_add_f32 v139, v139, v228
v_exp_f32 v136, v136
v_mfma_f32_16x16x32_bf16 v[92:95], a[168:171], v[32:35], v[92:95]
v_cvt_pk_bf16_f32 v161, v106, v107
v_exp_f32 v137, v137
v_cndmask_b32 v96, v216, v17, s[26:27]
v_cndmask_b32 v97, v216, v17, s[56:57]
v_cndmask_b32 v98, v216, v17, s[58:59]
v_cndmask_b32 v99, v216, v17, s[60:61]
v_mfma_f32_16x16x32_bf16 v[92:95], a[164:167], v[28:31], v[92:95]
v_exp_f32 v138, v138
v_mfma_f32_16x16x32_bf16 v[92:95], a[160:163], v[24:27], v[92:95]
v_exp_f32 v139, v139
v_mfma_f32_16x16x32_bf16 v[96:99], a[176:179], v[24:27], v[96:99]
v_cvt_pk_bf16_f32 v184, v120, v121
v_add_f32 v88, v88, v216
v_mfma_f32_16x16x32_bf16 v[96:99], a[180:183], v[28:31], v[96:99]
buffer_load_dwordx4 v16, s[32:35], s64 offen offset:2048 sc1 lds
v_add_f32 v89, v89, v216
v_add_f32 v90, v90, v216
v_add_f32 v91, v91, v216
v_exp_f32 v88, v88
v_mfma_f32_16x16x32_bf16 v[96:99], a[184:187], v[32:35], v[96:99]
v_exp_f32 v89, v89
v_mfma_f32_16x16x32_bf16 v[96:99], a[188:191], v[36:39], v[96:99]
v_cvt_pk_bf16_f32 v185, v122, v123
v_cvt_pk_bf16_f32 v192, v136, v137
v_mfma_f32_16x16x32_bf16 v[112:115], a[188:191], v[52:55], v[220:223]
v_exp_f32 v90, v90
v_mfma_f32_16x16x32_bf16 v[112:115], a[184:187], v[48:51], v[112:115]
v_exp_f32 v91, v91
v_mfma_f32_16x16x32_bf16 v[112:115], a[180:183], v[44:47], v[112:115]
v_exp_f32 v140, v140
v_mfma_f32_16x16x32_bf16 v[112:115], a[176:179], v[40:43], v[112:115]
v_exp_f32 v141, v141
v_mfma_f32_16x16x32_bf16 v[128:131], a[176:179], v[56:59], v[224:227]
buffer_load_dwordx4 v16, s[32:35], s64 offen offset:3072 sc1 lds
v_cvt_pk_bf16_f32 v193, v138, v139
v_mfma_f32_16x16x32_bf16 v[128:131], a[180:183], v[60:63], v[128:131]
v_exp_f32 v142, v142
v_mfma_f32_16x16x32_bf16 v[128:131], a[184:187], v[64:67], v[128:131]
v_exp_f32 v143, v143
v_mfma_f32_16x16x32_bf16 v[128:131], a[188:191], v[68:71], v[128:131]
v_cvt_pk_bf16_f32 v152, v88, v89
v_cvt_pk_bf16_f32 v153, v90, v91
v_mfma_f32_16x16x32_bf16 v[144:147], a[188:191], v[84:87], v[228:231]
v_exp_f32 v124, v124
v_mfma_f32_16x16x32_bf16 v[144:147], a[184:187], v[80:83], v[144:147]
v_exp_f32 v125, v125
v_mfma_f32_16x16x32_bf16 v[144:147], a[180:183], v[76:79], v[144:147]
s_waitcnt vmcnt(8)
s_barrier
v_mfma_f32_16x16x32_bf16 v[144:147], a[176:179], v[72:75], v[144:147]
v_exp_f32 v126, v126
v_mfma_f32_16x16x32_bf16 v[148:151], a[192:195], v[72:75], v[228:231]
v_cvt_pk_bf16_f32 v194, v140, v141
v_cvt_pk_bf16_f32 v195, v142, v143
v_mfma_f32_16x16x32_bf16 v[148:151], a[196:199], v[76:79], v[148:151]
v_exp_f32 v127, v127
v_mfma_f32_16x16x32_bf16 v[148:151], a[200:203], v[80:83], v[148:151]
s_xor_b32 s71, s71, 16384
v_exp_f32 v108, v108
v_mfma_f32_16x16x32_bf16 v[148:151], a[204:207], v[84:87], v[148:151]
s_add_u32 s70, s70, 32768
v_exp_f32 v109, v109
v_mfma_f32_16x16x32_bf16 v[132:135], a[204:207], v[68:71], v[224:227]
s_mov_b32 m0, s71
v_exp_f32 v110, v110
v_mfma_f32_16x16x32_bf16 v[132:135], a[200:203], v[64:67], v[132:135]
buffer_load_dwordx4 v16, s[32:35], s70 offen offset:0 sc1 lds
v_mfma_f32_16x16x32_bf16 v[132:135], a[196:199], v[60:63], v[132:135]
v_cvt_pk_bf16_f32 v186, v124, v125
v_exp_f32 v111, v111
v_mfma_f32_16x16x32_bf16 v[132:135], a[192:195], v[56:59], v[132:135]
v_exp_f32 v92, v92
v_mfma_f32_16x16x32_bf16 v[116:119], a[192:195], v[40:43], v[220:223]
ds_read_b128 a[144:147], v2 offset:16384
v_cndmask_b32 v100, v216, v17, s[62:63]
v_mfma_f32_16x16x32_bf16 v[116:119], a[196:199], v[44:47], v[116:119]
ds_read_b128 a[148:151], v2 offset:17408
v_cndmask_b32 v101, v216, v17, s[48:49]
v_cndmask_b32 v102, v216, v17, s[50:51]
v_cndmask_b32 v103, v216, v17, s[100:101]
v_cvt_pk_bf16_f32 v187, v126, v127
v_exp_f32 v93, v93
v_mfma_f32_16x16x32_bf16 v[116:119], a[200:203], v[48:51], v[116:119]
v_exp_f32 v94, v94
v_mfma_f32_16x16x32_bf16 v[116:119], a[204:207], v[52:55], v[116:119]
ds_read_b128 a[152:155], v2 offset:18432
v_cvt_pk_bf16_f32 v162, v108, v109
v_mfma_f32_16x16x32_bf16 v[100:103], a[204:207], v[36:39], v[100:103]
buffer_load_dwordx4 v16, s[32:35], s70 offen offset:1024 sc1 lds
v_exp_f32 v95, v95
v_mfma_f32_16x16x32_bf16 v[100:103], a[200:203], v[32:35], v[100:103]
ds_read_b128 a[156:159], v2 offset:19456
v_exp_f32 v96, v96
v_mfma_f32_16x16x32_bf16 v[100:103], a[196:199], v[28:31], v[100:103]
v_cvt_pk_bf16_f32 v163, v110, v111
v_exp_f32 v97, v97
v_mfma_f32_16x16x32_bf16 v[100:103], a[192:195], v[24:27], v[100:103]
s_waitcnt lgkmcnt(2)
ds_read_b128 a[160:163], v2 offset:20480
ds_read_b128 a[164:167], v2 offset:21504
ds_read_b128 a[168:171], v2 offset:22528
ds_read_b128 a[172:175], v2 offset:23552
v_mfma_f32_16x16x32_bf16 v[120:123], a[144:147], v[56:59], v[224:227]
v_exp_f32 v98, v98
v_mfma_f32_16x16x32_bf16 v[120:123], a[148:151], v[60:63], v[120:123]
s_waitcnt lgkmcnt(5)
v_cvt_pk_bf16_f32 v154, v92, v93
v_exp_f32 v99, v99
v_mfma_f32_16x16x32_bf16 v[120:123], a[152:155], v[64:67], v[120:123]
s_waitcnt lgkmcnt(4)
v_exp_f32 v112, v112
v_mfma_f32_16x16x32_bf16 v[120:123], a[156:159], v[68:71], v[120:123]
v_exp_f32 v113, v113
v_mfma_f32_16x16x32_bf16 v[136:139], a[156:159], v[84:87], v[228:231]
v_cvt_pk_bf16_f32 v155, v94, v95
v_cndmask_b32 v104, v220, v17, s[0:1]
v_mfma_f32_16x16x32_bf16 v[136:139], a[152:155], v[80:83], v[136:139]
ds_read_b128 a[176:179], v2 offset:24576
buffer_load_dwordx4 v16, s[32:35], s70 offen offset:2048 sc1 lds
v_cndmask_b32 v105, v220, v17, s[4:5]
v_cndmask_b32 v106, v220, v17, s[6:7]
v_cndmask_b32 v107, v220, v17, s[8:9]
v_exp_f32 v114, v114
v_mfma_f32_16x16x32_bf16 v[136:139], a[148:151], v[76:79], v[136:139]
v_cvt_pk_bf16_f32 v156, v96, v97
v_cvt_pk_bf16_f32 v157, v98, v99
v_mfma_f32_16x16x32_bf16 v[136:139], a[144:147], v[72:75], v[136:139]
v_exp_f32 v115, v115
v_mfma_f32_16x16x32_bf16 v[104:107], a[144:147], v[40:43], v[104:107]
v_exp_f32 v128, v128
v_mfma_f32_16x16x32_bf16 v[104:107], a[148:151], v[44:47], v[104:107]
v_exp_f32 v129, v129
v_mfma_f32_16x16x32_bf16 v[104:107], a[152:155], v[48:51], v[104:107]
v_exp_f32 v130, v130
v_mfma_f32_16x16x32_bf16 v[104:107], a[156:159], v[52:55], v[104:107]
s_waitcnt lgkmcnt(0)
v_exp_f32 v131, v131
v_mfma_f32_16x16x32_bf16 v[140:143], a[172:175], v[84:87], v[228:231]
v_cvt_pk_bf16_f32 v164, v112, v113
v_cvt_pk_bf16_f32 v165, v114, v115
v_mfma_f32_16x16x32_bf16 v[140:143], a[168:171], v[80:83], v[140:143]
v_exp_f32 v144, v144
v_mfma_f32_16x16x32_bf16 v[140:143], a[164:167], v[76:79], v[140:143]
v_exp_f32 v145, v145
v_mfma_f32_16x16x32_bf16 v[140:143], a[160:163], v[72:75], v[140:143]
v_exp_f32 v146, v146
v_mfma_f32_16x16x32_bf16 v[124:127], a[160:163], v[56:59], v[224:227]
ds_read_b128 a[180:183], v2 offset:25600
v_cndmask_b32 v108, v220, v17, s[10:11]
v_mfma_f32_16x16x32_bf16 v[124:127], a[164:167], v[60:63], v[124:127]
ds_read_b128 a[184:187], v2 offset:26624
v_cndmask_b32 v109, v220, v17, s[12:13]
v_cndmask_b32 v110, v220, v17, s[18:19]
v_cndmask_b32 v111, v220, v17, s[22:23]
v_cvt_pk_bf16_f32 v188, v128, v129
v_mfma_f32_16x16x32_bf16 v[124:127], a[168:171], v[64:67], v[124:127]
buffer_load_dwordx4 v16, s[32:35], s70 offen offset:3072 sc1 lds
v_exp_f32 v147, v147
v_mfma_f32_16x16x32_bf16 v[124:127], a[172:175], v[68:71], v[124:127]
s_add_u32 m0, s86, 131072
ds_read_b128 a[188:191], v2 offset:27648
v_exp_f32 v148, v148
v_mfma_f32_16x16x32_bf16 v[108:111], a[172:175], v[52:55], v[108:111]
s_add_u32 s64, s85, 0
v_cvt_pk_bf16_f32 v189, v130, v131
v_exp_f32 v149, v149
v_mfma_f32_16x16x32_bf16 v[108:111], a[168:171], v[48:51], v[108:111]
ds_read_b128 a[192:195], v2 offset:28672
buffer_load_dwordx4 v12, s[36:39], s64 offen lds
v_cndmask_b32 v112, v220, v17, s[26:27]
v_cndmask_b32 v113, v220, v17, s[56:57]
v_cndmask_b32 v114, v220, v17, s[58:59]
v_cndmask_b32 v115, v220, v17, s[60:61]
v_mfma_f32_16x16x32_bf16 v[108:111], a[164:167], v[44:47], v[108:111]
s_add_u32 m0, s86, 132096
v_exp_f32 v150, v150
v_mfma_f32_16x16x32_bf16 v[108:111], a[160:163], v[40:43], v[108:111]
s_add_u32 s64, s85, 8192
v_cvt_pk_bf16_f32 v196, v144, v145
v_exp_f32 v151, v151
v_mfma_f32_16x16x32_bf16 v[112:115], a[176:179], v[40:43], v[112:115]
s_waitcnt lgkmcnt(2)
buffer_load_dwordx4 v13, s[36:39], s64 offen lds
v_exp_f32 v132, v132
v_mfma_f32_16x16x32_bf16 v[112:115], a[180:183], v[44:47], v[112:115]
s_add_u32 m0, s86, 133120
v_exp_f32 v133, v133
v_mfma_f32_16x16x32_bf16 v[112:115], a[184:187], v[48:51], v[112:115]
s_waitcnt lgkmcnt(1)
s_add_u32 s64, s85, 16384
v_cvt_pk_bf16_f32 v197, v146, v147
v_cvt_pk_bf16_f32 v198, v148, v149
v_mfma_f32_16x16x32_bf16 v[112:115], a[188:191], v[52:55], v[112:115]
buffer_load_dwordx4 v12, s[36:39], s64 offen lds
v_exp_f32 v134, v134
v_mfma_f32_16x16x32_bf16 v[128:131], a[188:191], v[68:71], v[224:227]
s_add_u32 m0, s86, 134144
ds_read_b128 a[196:199], v2 offset:29696
ds_read_b128 a[200:203], v2 offset:30720
ds_read_b128 a[204:207], v2 offset:31744
v_mfma_f32_16x16x32_bf16 v[128:131], a[184:187], v[64:67], v[128:131]
s_add_u32 s64, s85, 24576
v_exp_f32 v135, v135
v_mfma_f32_16x16x32_bf16 v[128:131], a[180:183], v[60:63], v[128:131]
buffer_load_dwordx4 v13, s[36:39], s64 offen lds
v_exp_f32 v116, v116
v_mfma_f32_16x16x32_bf16 v[128:131], a[176:179], v[56:59], v[128:131]
s_add_u32 m0, s71, 4096
v_cvt_pk_bf16_f32 v199, v150, v151
v_exp_f32 v117, v117
v_mfma_f32_16x16x32_bf16 v[144:147], a[176:179], v[72:75], v[228:231]
s_add_u32 s64, s70, 4096
v_exp_f32 v118, v118
v_mfma_f32_16x16x32_bf16 v[144:147], a[180:183], v[76:79], v[144:147]
buffer_load_dwordx4 v16, s[32:35], s64 offen offset:0 sc1 lds
v_mfma_f32_16x16x32_bf16 v[144:147], a[184:187], v[80:83], v[144:147]
v_cvt_pk_bf16_f32 v190, v132, v133
v_exp_f32 v119, v119
v_mfma_f32_16x16x32_bf16 v[144:147], a[188:191], v[84:87], v[144:147]
s_waitcnt lgkmcnt(0)
v_exp_f32 v100, v100
v_mfma_f32_16x16x32_bf16 v[148:151], a[204:207], v[84:87], v[228:231]
v_exp_f32 v101, v101
v_mfma_f32_16x16x32_bf16 v[148:151], a[200:203], v[80:83], v[148:151]
v_cvt_pk_bf16_f32 v191, v134, v135
v_cvt_pk_bf16_f32 v166, v116, v117
v_cvt_pk_bf16_f32 v167, v118, v119
v_mfma_f32_16x16x32_bf16 v[148:151], a[196:199], v[76:79], v[148:151]
v_exp_f32 v102, v102
v_mfma_f32_16x16x32_bf16 v[148:151], a[192:195], v[72:75], v[148:151]
v_exp_f32 v103, v103
v_mfma_f32_16x16x32_bf16 v[132:135], a[192:195], v[56:59], v[224:227]
s_lshl_b32 s66, s30, 30
ds_read_b128 a[144:147], v3 offset:16384
v_cndmask_b32 v116, v220, v17, s[62:63]
v_mfma_f32_16x16x32_bf16 v[132:135], a[196:199], v[60:63], v[132:135]
ds_read_b128 a[148:151], v3 offset:24576
v_cndmask_b32 v117, v220, v17, s[48:49]
v_cndmask_b32 v118, v220, v17, s[50:51]
v_cndmask_b32 v119, v220, v17, s[100:101]
v_exp_f32 v120, v120
v_mfma_f32_16x16x32_bf16 v[132:135], a[200:203], v[64:67], v[132:135]
v_exp_f32 v121, v121
v_mfma_f32_16x16x32_bf16 v[132:135], a[204:207], v[68:71], v[132:135]
v_exp_f32 v122, v122
v_mfma_f32_16x16x32_bf16 v[116:119], a[204:207], v[52:55], v[116:119]
v_exp_f32 v123, v123
v_mfma_f32_16x16x32_bf16 v[116:119], a[200:203], v[48:51], v[116:119]
v_cvt_pk_bf16_f32 v158, v100, v101
v_cvt_pk_bf16_f32 v159, v102, v103
v_mfma_f32_16x16x32_bf16 v[116:119], a[196:199], v[44:47], v[116:119]
buffer_load_dwordx4 v16, s[32:35], s64 offen offset:1024 sc1 lds
v_mfma_f32_16x16x32_bf16 v[116:119], a[192:195], v[40:43], v[116:119]
v_exp_f32 v136, v136
v_mfma_f32_16x16x32_bf16 a[128:131], a[244:247], v[152:155], 0
v_exp_f32 v137, v137
v_mfma_f32_16x16x32_bf16 a[128:131], a[244:247], v[156:159], a[128:131]
v_exp_f32 v138, v138
v_mfma_f32_16x16x32_bf16 a[132:135], a[244:247], v[160:163], 0
v_exp_f32 v139, v139
v_mfma_f32_16x16x32_bf16 a[132:135], a[244:247], v[164:167], a[132:135]
v_cvt_pk_bf16_f32 v200, v120, v121
v_cvt_pk_bf16_f32 v201, v122, v123
v_mfma_f32_16x16x32_bf16 a[136:139], a[244:247], v[184:187], 0
v_exp_f32 v104, v104
v_mfma_f32_16x16x32_bf16 a[136:139], a[244:247], v[188:191], a[136:139]
v_exp_f32 v105, v105
v_mfma_f32_16x16x32_bf16 a[140:143], a[244:247], v[192:195], 0
ds_read_b128 a[152:155], v3 offset:17408
v_cvt_pk_bf16_f32 v208, v136, v137
v_mfma_f32_16x16x32_bf16 a[140:143], a[244:247], v[196:199], a[140:143]
s_waitcnt lgkmcnt(1)
v_exp_f32 v106, v106
v_mfma_f32_16x16x32_bf16 a[0:3], a[144:147], v[152:155], 0
ds_read_b128 a[156:159], v3 offset:25600
v_cvt_pk_bf16_f32 v209, v138, v139
v_mfma_f32_16x16x32_bf16 a[0:3], a[148:151], v[156:159], a[0:3]
v_exp_f32 v107, v107
v_mfma_f32_16x16x32_bf16 a[32:35], a[148:151], v[164:167], 0
v_exp_f32 v140, v140
v_mfma_f32_16x16x32_bf16 a[32:35], a[144:147], v[160:163], a[32:35]
buffer_load_dwordx4 v16, s[32:35], s64 offen offset:2048 sc1 lds
v_mfma_f32_16x16x32_bf16 a[64:67], a[144:147], v[184:187], 0
v_exp_f32 v141, v141
v_mfma_f32_16x16x32_bf16 a[64:67], a[148:151], v[188:191], a[64:67]
v_exp_f32 v142, v142
v_mfma_f32_16x16x32_bf16 a[96:99], a[148:151], v[196:199], 0
ds_read_b128 a[160:163], v3 offset:18432
v_cvt_pk_bf16_f32 v176, v104, v105
v_mfma_f32_16x16x32_bf16 a[96:99], a[144:147], v[192:195], a[96:99]
s_waitcnt lgkmcnt(1)
ds_read_b128 a[164:167], v3 offset:26624
v_cvt_pk_bf16_f32 v177, v106, v107
v_mfma_f32_16x16x32_bf16 a[100:103], a[152:155], v[192:195], 0
v_exp_f32 v143, v143
v_mfma_f32_16x16x32_bf16 a[100:103], a[156:159], v[196:199], a[100:103]
v_exp_f32 v124, v124
v_mfma_f32_16x16x32_bf16 a[68:71], a[156:159], v[188:191], 0
v_exp_f32 v125, v125
v_mfma_f32_16x16x32_bf16 a[68:71], a[152:155], v[184:187], a[68:71]
v_exp_f32 v126, v126
v_mfma_f32_16x16x32_bf16 a[36:39], a[152:155], v[160:163], 0
v_exp_f32 v127, v127
v_mfma_f32_16x16x32_bf16 a[36:39], a[156:159], v[164:167], a[36:39]
ds_read_b128 a[168:171], v3 offset:19456
v_cvt_pk_bf16_f32 v210, v140, v141
v_mfma_f32_16x16x32_bf16 a[4:7], a[156:159], v[156:159], 0
ds_read_b128 a[172:175], v3 offset:27648
v_cvt_pk_bf16_f32 v211, v142, v143
v_mfma_f32_16x16x32_bf16 a[4:7], a[152:155], v[152:155], a[4:7]
s_waitcnt lgkmcnt(2)
v_exp_f32 v108, v108
v_mfma_f32_16x16x32_bf16 a[8:11], a[160:163], v[152:155], 0
v_exp_f32 v109, v109
v_mfma_f32_16x16x32_bf16 a[8:11], a[164:167], v[156:159], a[8:11]
buffer_load_dwordx4 v16, s[32:35], s64 offen offset:3072 sc1 lds
v_mfma_f32_16x16x32_bf16 a[40:43], a[164:167], v[164:167], 0
v_exp_f32 v110, v110
v_mfma_f32_16x16x32_bf16 a[40:43], a[160:163], v[160:163], a[40:43]
v_exp_f32 v111, v111
v_mfma_f32_16x16x32_bf16 a[72:75], a[160:163], v[184:187], 0
v_exp_f32 v112, v112
v_mfma_f32_16x16x32_bf16 a[72:75], a[164:167], v[188:191], a[72:75]
v_cvt_pk_bf16_f32 v202, v124, v125
v_cvt_pk_bf16_f32 v203, v126, v127
v_mfma_f32_16x16x32_bf16 a[104:107], a[164:167], v[196:199], 0
ds_read_b128 a[176:179], v3 offset:20480
v_cvt_pk_bf16_f32 v178, v108, v109
v_mfma_f32_16x16x32_bf16 a[104:107], a[160:163], v[192:195], a[104:107]
s_waitcnt lgkmcnt(1)
ds_read_b128 a[180:183], v3 offset:28672
v_xor_b32 v2, 0x8000, v2
v_mfma_f32_16x16x32_bf16 a[108:111], a[168:171], v[192:195], 0
s_add_u32 m0, s86, 135168
v_exp_f32 v113, v113
v_mfma_f32_16x16x32_bf16 a[108:111], a[172:175], v[196:199], a[108:111]
s_add_u32 s64, s85, 32768
v_exp_f32 v114, v114
v_mfma_f32_16x16x32_bf16 a[76:79], a[172:175], v[188:191], 0
buffer_load_dwordx4 v12, s[36:39], s64 offen lds
v_mfma_f32_16x16x32_bf16 a[76:79], a[168:171], v[184:187], a[76:79]
s_add_u32 m0, s86, 136192
v_exp_f32 v115, v115
v_mfma_f32_16x16x32_bf16 a[44:47], a[168:171], v[160:163], 0
s_add_u32 s64, s85, 40960
v_exp_f32 v128, v128
v_mfma_f32_16x16x32_bf16 a[44:47], a[172:175], v[164:167], a[44:47]
buffer_load_dwordx4 v13, s[36:39], s64 offen lds
v_mfma_f32_16x16x32_bf16 a[12:15], a[172:175], v[156:159], 0
ds_read_b128 a[184:187], v3 offset:21504
v_cvt_pk_bf16_f32 v179, v110, v111
v_mfma_f32_16x16x32_bf16 a[12:15], a[168:171], v[152:155], a[12:15]
s_waitcnt lgkmcnt(1)
s_add_u32 m0, s86, 137216
ds_read_b128 a[188:191], v3 offset:29696
ds_read_b128 a[192:195], v3 offset:22528
ds_read_b128 a[196:199], v3 offset:30720
ds_read_b128 a[200:203], v3 offset:23552
ds_read_b128 a[204:207], v3 offset:31744
v_mfma_f32_16x16x32_bf16 a[16:19], a[176:179], v[152:155], 0
s_waitcnt vmcnt(14)
s_barrier
s_add_u32 s64, s85, 49152
v_exp_f32 v129, v129
v_mfma_f32_16x16x32_bf16 a[16:19], a[180:183], v[156:159], a[16:19]
buffer_load_dwordx4 v12, s[36:39], s64 offen lds
v_mfma_f32_16x16x32_bf16 a[48:51], a[180:183], v[164:167], 0
s_add_u32 m0, s86, 138240
v_cvt_pk_bf16_f32 v180, v112, v113
v_exp_f32 v130, v130
v_mfma_f32_16x16x32_bf16 a[48:51], a[176:179], v[160:163], a[48:51]
s_add_u32 s64, s85, 57344
v_exp_f32 v131, v131
v_mfma_f32_16x16x32_bf16 a[80:83], a[176:179], v[184:187], 0
buffer_load_dwordx4 v13, s[36:39], s64 offen lds
v_mfma_f32_16x16x32_bf16 a[80:83], a[180:183], v[188:191], a[80:83]
v_cvt_pk_bf16_f32 v181, v114, v115
v_exp_f32 v144, v144
v_mfma_f32_16x16x32_bf16 a[112:115], a[180:183], v[196:199], 0
s_xor_b32 s71, s71, 49152
s_add_u32 s70, s70, 32768
s_mov_b32 m0, s71
v_exp_f32 v145, v145
v_mfma_f32_16x16x32_bf16 a[112:115], a[176:179], v[192:195], a[112:115]
s_waitcnt lgkmcnt(0)
buffer_load_dwordx4 v16, s[32:35], s70 offen offset:0 sc1 lds
v_mfma_f32_16x16x32_bf16 a[116:119], a[184:187], v[192:195], 0
v_cvt_pk_bf16_f32 v204, v128, v129
v_exp_f32 v146, v146
v_mfma_f32_16x16x32_bf16 a[116:119], a[188:191], v[196:199], a[116:119]
v_exp_f32 v147, v147
v_mfma_f32_16x16x32_bf16 a[84:87], a[188:191], v[188:191], 0
v_exp_f32 v148, v148
v_mfma_f32_16x16x32_bf16 a[84:87], a[184:187], v[184:187], a[84:87]
v_exp_f32 v149, v149
v_mfma_f32_16x16x32_bf16 a[52:55], a[184:187], v[160:163], 0
v_cvt_pk_bf16_f32 v205, v130, v131
v_cvt_pk_bf16_f32 v212, v144, v145
v_mfma_f32_16x16x32_bf16 a[52:55], a[188:191], v[164:167], a[52:55]
v_exp_f32 v150, v150
v_mfma_f32_16x16x32_bf16 a[20:23], a[188:191], v[156:159], 0
v_exp_f32 v151, v151
v_mfma_f32_16x16x32_bf16 a[20:23], a[184:187], v[152:155], a[20:23]
v_exp_f32 v132, v132
v_mfma_f32_16x16x32_bf16 a[24:27], a[192:195], v[152:155], 0
v_exp_f32 v133, v133
v_mfma_f32_16x16x32_bf16 a[24:27], a[196:199], v[156:159], a[24:27]
v_exp_f32 v134, v134
v_mfma_f32_16x16x32_bf16 a[56:59], a[196:199], v[164:167], 0
v_cvt_pk_bf16_f32 v213, v146, v147
v_cvt_pk_bf16_f32 v214, v148, v149
v_mfma_f32_16x16x32_bf16 a[56:59], a[192:195], v[160:163], a[56:59]
s_add_u32 s17, s78, L_D_8-L_pc+0
buffer_load_dwordx4 v16, s[32:35], s70 offen offset:1024 sc1 lds
v_mfma_f32_16x16x32_bf16 a[88:91], a[192:195], v[184:187], 0
buffer_load_dword a252, v16, s[88:91], s17 offen
v_mfma_f32_16x16x32_bf16 a[88:91], a[196:199], v[188:191], a[88:91]
v_exp_f32 v135, v135
v_mfma_f32_16x16x32_bf16 a[120:123], a[196:199], v[196:199], 0
s_add_u32 s17, s78, L_D_8-L_pc+4096
ds_read_b128 a[144:147], v2 offset:0
v_lshl_add_u32 v19, v0, 24, s66
v_mfma_f32_16x16x32_bf16 a[120:123], a[192:195], v[192:195], a[120:123]
s_lshr_b32 s67, s31, 4
buffer_load_dword a252, v16, s[88:91], s17 offen
v_mfma_f32_16x16x32_bf16 a[124:127], a[200:203], v[192:195], 0
s_lshl1_add_u32 s67, s3, s67
v_exp_f32 v116, v116
v_mfma_f32_16x16x32_bf16 a[124:127], a[204:207], v[196:199], a[124:127]
s_lshl_b32 s79, s67, 8
ds_read_b128 a[148:151], v2 offset:1024
v_cvt_pk_bf16_f32 v215, v150, v151
v_mfma_f32_16x16x32_bf16 a[92:95], a[204:207], v[188:191], 0
s_add_u32 s79, s79, 8192
s_add_u32 s17, s78, L_D_8-L_pc+8192
v_exp_f32 v117, v117
v_mfma_f32_16x16x32_bf16 a[92:95], a[200:203], v[184:187], a[92:95]
s_lshl_b32 s67, s73, 16
buffer_load_dword a252, v16, s[88:91], s17 offen
v_mfma_f32_16x16x32_bf16 a[60:63], a[200:203], v[160:163], 0
ds_read_b128 a[152:155], v2 offset:2048
v_cvt_pk_bf16_f32 v206, v132, v133
v_exp_f32 v118, v118
v_mfma_f32_16x16x32_bf16 a[60:63], a[204:207], v[164:167], a[60:63]
s_add_u32 s67, s67, s79
ds_read_b128 a[156:159], v2 offset:3072
v_cvt_pk_bf16_f32 v207, v134, v135
v_mfma_f32_16x16x32_bf16 a[28:31], a[204:207], v[156:159], 0
s_add_u32 s17, s78, L_D_8-L_pc+12288
v_exp_f32 v119, v119
v_mfma_f32_16x16x32_bf16 a[28:31], a[200:203], v[152:155], a[28:31]
s_mov_b64 exec, 1
buffer_atomic_add a251, v19, s[52:55], s67 offen offset:0 sc1
s_mov_b64 exec, -1
buffer_load_dword a252, v16, s[88:91], s17 offen
ds_read_b128 a[160:163], v2 offset:4096
ds_read_b128 a[164:167], v2 offset:5120
ds_read_b128 a[168:171], v2 offset:6144
ds_read_b128 a[172:175], v2 offset:7168
v_cvt_pk_bf16_f32 v182, v116, v117
v_cvt_pk_bf16_f32 v183, v118, v119
v_xor_b32 v3, 0x8000, v3
v_accvgpr_read_b32 v20, a128
v_max_f32 v1, v1, v20
v_rcp_f32 v20, v20
v_accvgpr_read_b32 v232, a0
v_accvgpr_read_b32 v233, a1
v_accvgpr_read_b32 v234, a2
v_accvgpr_read_b32 v235, a3
v_accvgpr_read_b32 v236, a4
v_accvgpr_read_b32 v237, a5
v_accvgpr_read_b32 v238, a6
v_accvgpr_read_b32 v239, a7
v_mul_f32 v20, v20, v4
v_mul_f32 v232, v232, v20
v_mul_f32 v233, v233, v20
v_mul_f32 v234, v234, v20
v_mul_f32 v235, v235, v20
v_mul_f32 v236, v236, v20
v_mul_f32 v237, v237, v20
v_mul_f32 v238, v238, v20
v_mul_f32 v239, v239, v20
v_cvt_pk_bf16_f32 v232, v232, v233
v_cvt_pk_bf16_f32 v233, v234, v235
v_cvt_pk_bf16_f32 v234, v236, v237
v_cvt_pk_bf16_f32 v235, v238, v239
s_add_u32 s77, s74, 0
buffer_store_dwordx4 v[232:235], v16, s[44:47], s77 offen sc1
v_accvgpr_read_b32 v240, a8
v_accvgpr_read_b32 v241, a9
v_accvgpr_read_b32 v242, a10
v_accvgpr_read_b32 v243, a11
v_accvgpr_read_b32 v244, a12
v_accvgpr_read_b32 v245, a13
v_accvgpr_read_b32 v246, a14
v_accvgpr_read_b32 v247, a15
v_mul_f32 v240, v240, v20
v_mul_f32 v241, v241, v20
v_mul_f32 v242, v242, v20
v_mul_f32 v243, v243, v20
v_mul_f32 v244, v244, v20
v_mul_f32 v245, v245, v20
v_mul_f32 v246, v246, v20
v_mul_f32 v247, v247, v20
v_cvt_pk_bf16_f32 v240, v240, v241
v_cvt_pk_bf16_f32 v241, v242, v243
v_cvt_pk_bf16_f32 v242, v244, v245
v_cvt_pk_bf16_f32 v243, v246, v247
s_add_u32 s77, s74, 8192
buffer_store_dwordx4 v[240:243], v16, s[44:47], s77 offen sc1
v_accvgpr_read_b32 v232, a16
v_accvgpr_read_b32 v233, a17
v_accvgpr_read_b32 v234, a18
v_accvgpr_read_b32 v235, a19
v_accvgpr_read_b32 v236, a20
v_accvgpr_read_b32 v237, a21
v_accvgpr_read_b32 v238, a22
v_accvgpr_read_b32 v239, a23
v_mul_f32 v232, v232, v20
v_mul_f32 v233, v233, v20
v_mul_f32 v234, v234, v20
v_mul_f32 v235, v235, v20
v_mul_f32 v236, v236, v20
v_mul_f32 v237, v237, v20
v_mul_f32 v238, v238, v20
v_mul_f32 v239, v239, v20
v_cvt_pk_bf16_f32 v232, v232, v233
v_cvt_pk_bf16_f32 v233, v234, v235
v_cvt_pk_bf16_f32 v234, v236, v237
v_cvt_pk_bf16_f32 v235, v238, v239
s_add_u32 s77, s74, 16384
buffer_store_dwordx4 v[232:235], v16, s[44:47], s77 offen sc1
s_branch L_T_10
L_T1_11:
buffer_load_dword v19, off, s[52:55], s80 sc1
s_add_u32 s17, s78, L_TAIL_14-L_pc+0
buffer_load_dword a252, v16, s[88:91], s17 offen
s_add_u32 s17, s78, L_TAIL_14-L_pc+4096
buffer_load_dword a252, v16, s[88:91], s17 offen
s_waitcnt lgkmcnt(7)
v_mfma_f32_16x16x32_bf16 v[136:139], a[144:147], v[72:75], v[228:231]
s_waitcnt lgkmcnt(6)
ds_read_b128 a[176:179], v2 offset:8192
v_cndmask_b32 v120, v224, v17, s[0:1]
v_mfma_f32_16x16x32_bf16 v[136:139], a[148:151], v[76:79], v[136:139]
s_waitcnt lgkmcnt(6)
ds_read_b128 a[180:183], v2 offset:9216
v_cndmask_b32 v121, v224, v17, s[4:5]
v_cndmask_b32 v122, v224, v17, s[6:7]
v_cndmask_b32 v123, v224, v17, s[8:9]
v_mfma_f32_16x16x32_bf16 v[136:139], a[152:155], v[80:83], v[136:139]
s_waitcnt lgkmcnt(6)
buffer_load_dwordx4 v16, s[32:35], s70 offen offset:2048 sc1 lds
v_mfma_f32_16x16x32_bf16 v[136:139], a[156:159], v[84:87], v[136:139]
ds_read_b128 a[184:187], v2 offset:10240
v_cndmask_b32 v124, v224, v17, s[10:11]
v_mfma_f32_16x16x32_bf16 v[120:123], a[156:159], v[68:71], v[120:123]
ds_read_b128 a[188:191], v2 offset:11264
v_cndmask_b32 v125, v224, v17, s[12:13]
v_mfma_f32_16x16x32_bf16 v[120:123], a[152:155], v[64:67], v[120:123]
ds_read_b128 a[192:195], v2 offset:12288
v_cndmask_b32 v126, v224, v17, s[18:19]
v_mfma_f32_16x16x32_bf16 v[120:123], a[148:151], v[60:63], v[120:123]
ds_read_b128 a[196:199], v2 offset:13312
v_cndmask_b32 v127, v224, v17, s[22:23]
v_mfma_f32_16x16x32_bf16 v[120:123], a[144:147], v[56:59], v[120:123]
s_waitcnt lgkmcnt(4)
ds_read_b128 a[200:203], v2 offset:14336
v_cndmask_b32 v128, v224, v17, s[26:27]
v_mfma_f32_16x16x32_bf16 v[140:143], a[160:163], v[72:75], v[228:231]
ds_read_b128 a[204:207], v2 offset:15360
v_cndmask_b32 v129, v224, v17, s[56:57]
v_mfma_f32_16x16x32_bf16 v[140:143], a[164:167], v[76:79], v[140:143]
ds_read_b128 a[144:147], v3 offset:0
v_cndmask_b32 v130, v224, v17, s[58:59]
v_mfma_f32_16x16x32_bf16 v[140:143], a[168:171], v[80:83], v[140:143]
v_exp_f32 v136, v136
v_mfma_f32_16x16x32_bf16 v[140:143], a[172:175], v[84:87], v[140:143]
v_exp_f32 v137, v137
v_mfma_f32_16x16x32_bf16 v[124:127], a[172:175], v[68:71], v[124:127]
ds_read_b128 a[148:151], v3 offset:8192
v_cndmask_b32 v131, v224, v17, s[60:61]
v_mfma_f32_16x16x32_bf16 v[124:127], a[168:171], v[64:67], v[124:127]
buffer_load_dwordx4 v16, s[32:35], s70 offen offset:3072 sc1 lds
v_mfma_f32_16x16x32_bf16 v[124:127], a[164:167], v[60:63], v[124:127]
v_exp_f32 v138, v138
v_mfma_f32_16x16x32_bf16 v[124:127], a[160:163], v[56:59], v[124:127]
v_exp_f32 v139, v139
v_mfma_f32_16x16x32_bf16 v[128:131], a[176:179], v[56:59], v[128:131]
v_exp_f32 v120, v120
v_mfma_f32_16x16x32_bf16 v[128:131], a[180:183], v[60:63], v[128:131]
s_waitcnt lgkmcnt(1)
v_exp_f32 v121, v121
v_mfma_f32_16x16x32_bf16 v[128:131], a[184:187], v[64:67], v[128:131]
v_exp_f32 v122, v122
v_mfma_f32_16x16x32_bf16 v[128:131], a[188:191], v[68:71], v[128:131]
s_add_u32 m0, s71, 4096
ds_read_b128 a[152:155], v3 offset:1024
v_cndmask_b32 v132, v224, v17, s[62:63]
v_mfma_f32_16x16x32_bf16 v[144:147], a[188:191], v[84:87], v[228:231]
s_add_u32 s64, s70, 4096
v_cvt_pk_bf16_f32 v192, v136, v137
v_cndmask_b32 v133, v224, v17, s[48:49]
v_mfma_f32_16x16x32_bf16 v[144:147], a[184:187], v[80:83], v[144:147]
buffer_load_dwordx4 v16, s[32:35], s64 offen offset:0 sc1 lds
v_mfma_f32_16x16x32_bf16 v[144:147], a[180:183], v[76:79], v[144:147]
ds_read_b128 a[156:159], v3 offset:9216
v_cndmask_b32 v134, v224, v17, s[50:51]
v_mfma_f32_16x16x32_bf16 v[144:147], a[176:179], v[72:75], v[144:147]
ds_read_b128 a[160:163], v3 offset:2048
v_cndmask_b32 v135, v224, v17, s[100:101]
v_mfma_f32_16x16x32_bf16 v[148:151], a[192:195], v[72:75], v[228:231]
v_exp_f32 v123, v123
v_mfma_f32_16x16x32_bf16 v[148:151], a[196:199], v[76:79], v[148:151]
v_cvt_pk_bf16_f32 v193, v138, v139
v_cvt_pk_bf16_f32 v184, v120, v121
v_mfma_f32_16x16x32_bf16 v[148:151], a[200:203], v[80:83], v[148:151]
v_exp_f32 v140, v140
v_mfma_f32_16x16x32_bf16 v[148:151], a[204:207], v[84:87], v[148:151]
v_exp_f32 v141, v141
v_mfma_f32_16x16x32_bf16 v[132:135], a[204:207], v[68:71], v[132:135]
v_exp_f32 v142, v142
v_mfma_f32_16x16x32_bf16 v[132:135], a[200:203], v[64:67], v[132:135]
v_exp_f32 v143, v143
v_mfma_f32_16x16x32_bf16 v[132:135], a[196:199], v[60:63], v[132:135]
v_exp_f32 v124, v124
v_mfma_f32_16x16x32_bf16 v[132:135], a[192:195], v[56:59], v[132:135]
buffer_load_dwordx4 v16, s[32:35], s64 offen offset:1024 sc1 lds
v_mfma_f32_16x16x32_bf16 a[132:135], a[244:247], v[176:179], a[132:135]
v_exp_f32 v125, v125
v_mfma_f32_16x16x32_bf16 a[132:135], a[244:247], v[180:183], a[132:135]
ds_read_b128 a[164:167], v3 offset:10240
v_accvgpr_read_b32 v240, a24
v_mfma_f32_16x16x32_bf16 a[136:139], a[244:247], v[200:203], a[136:139]
ds_read_b128 a[168:171], v3 offset:3072
v_accvgpr_read_b32 v241, a25
v_mfma_f32_16x16x32_bf16 a[136:139], a[244:247], v[204:207], a[136:139]
v_cvt_pk_bf16_f32 v185, v122, v123
v_cvt_pk_bf16_f32 v194, v140, v141
v_mfma_f32_16x16x32_bf16 a[140:143], a[244:247], v[208:211], a[140:143]
ds_read_b128 a[172:175], v3 offset:11264
v_accvgpr_read_b32 v242, a26
v_mfma_f32_16x16x32_bf16 a[140:143], a[244:247], v[212:215], a[140:143]
ds_read_b128 a[176:179], v3 offset:4096
v_accvgpr_read_b32 v243, a27
v_mfma_f32_16x16x32_bf16 a[32:35], a[144:147], v[176:179], a[32:35]
s_waitcnt lgkmcnt(4)
ds_read_b128 a[180:183], v3 offset:12288
v_accvgpr_read_b32 v244, a28
v_mfma_f32_16x16x32_bf16 a[32:35], a[148:151], v[180:183], a[32:35]
ds_read_b128 a[184:187], v3 offset:5120
v_accvgpr_read_b32 v245, a29
v_mfma_f32_16x16x32_bf16 a[64:67], a[148:151], v[204:207], a[64:67]
ds_read_b128 a[188:191], v3 offset:13312
v_accvgpr_read_b32 v246, a30
v_mfma_f32_16x16x32_bf16 a[64:67], a[144:147], v[200:203], a[64:67]
ds_read_b128 a[192:195], v3 offset:6144
v_accvgpr_read_b32 v247, a31
v_mfma_f32_16x16x32_bf16 a[96:99], a[144:147], v[208:211], a[96:99]
ds_read_b128 a[196:199], v3 offset:14336
v_mul_f32 v240, v240, v20
v_mul_f32 v241, v241, v20
v_mul_f32 v242, v242, v20
v_mul_f32 v243, v243, v20
v_mul_f32 v244, v244, v20
v_mul_f32 v245, v245, v20
v_mul_f32 v246, v246, v20
v_mul_f32 v247, v247, v20
v_cvt_pk_bf16_f32 v240, v240, v241
v_cvt_pk_bf16_f32 v241, v242, v243
v_cvt_pk_bf16_f32 v242, v244, v245
v_cvt_pk_bf16_f32 v243, v246, v247
s_add_u32 s77, s74, 24576
buffer_store_dwordx4 v[240:243], v16, s[44:47], s77 offen sc1
v_mfma_f32_16x16x32_bf16 a[96:99], a[148:151], v[212:215], a[96:99]
v_exp_f32 v126, v126
v_mfma_f32_16x16x32_bf16 a[100:103], a[156:159], v[212:215], a[100:103]
buffer_load_dwordx4 v16, s[32:35], s64 offen offset:2048 sc1 lds
v_cvt_pk_bf16_f32 v195, v142, v143
v_mfma_f32_16x16x32_bf16 a[100:103], a[152:155], v[208:211], a[100:103]
v_exp_f32 v127, v127
v_mfma_f32_16x16x32_bf16 a[68:71], a[152:155], v[200:203], a[68:71]
v_exp_f32 v128, v128
v_mfma_f32_16x16x32_bf16 a[68:71], a[156:159], v[204:207], a[68:71]
v_exp_f32 v129, v129
v_mfma_f32_16x16x32_bf16 a[36:39], a[156:159], v[180:183], a[36:39]
v_exp_f32 v130, v130
v_mfma_f32_16x16x32_bf16 a[36:39], a[152:155], v[176:179], a[36:39]
v_cvt_pk_bf16_f32 v186, v124, v125
v_cvt_pk_bf16_f32 v187, v126, v127
v_mfma_f32_16x16x32_bf16 a[40:43], a[160:163], v[176:179], a[40:43]
s_waitcnt lgkmcnt(0)
v_exp_f32 v131, v131
v_mfma_f32_16x16x32_bf16 a[40:43], a[164:167], v[180:183], a[40:43]
buffer_load_dwordx4 v16, s[32:35], s64 offen offset:3072 sc1 lds
v_mfma_f32_16x16x32_bf16 a[72:75], a[164:167], v[204:207], a[72:75]
v_exp_f32 v144, v144
v_mfma_f32_16x16x32_bf16 a[72:75], a[160:163], v[200:203], a[72:75]
v_exp_f32 v145, v145
v_mfma_f32_16x16x32_bf16 a[104:107], a[160:163], v[208:211], a[104:107]
v_exp_f32 v146, v146
v_mfma_f32_16x16x32_bf16 a[104:107], a[164:167], v[212:215], a[104:107]
ds_read_b128 a[200:203], v3 offset:7168
v_cvt_pk_bf16_f32 v188, v128, v129
v_mfma_f32_16x16x32_bf16 a[108:111], a[172:175], v[212:215], a[108:111]
ds_read_b128 a[204:207], v3 offset:15360
v_cvt_pk_bf16_f32 v189, v130, v131
v_mfma_f32_16x16x32_bf16 a[108:111], a[168:171], v[208:211], a[108:111]
v_exp_f32 v147, v147
v_mfma_f32_16x16x32_bf16 a[76:79], a[168:171], v[200:203], a[76:79]
v_exp_f32 v148, v148
v_mfma_f32_16x16x32_bf16 a[76:79], a[172:175], v[204:207], a[76:79]
v_exp_f32 v149, v149
v_mfma_f32_16x16x32_bf16 a[44:47], a[172:175], v[180:183], a[44:47]
v_exp_f32 v150, v150
v_mfma_f32_16x16x32_bf16 a[44:47], a[168:171], v[176:179], a[44:47]
v_exp_f32 v151, v151
v_mfma_f32_16x16x32_bf16 a[48:51], a[176:179], v[176:179], a[48:51]
v_exp_f32 v132, v132
v_mfma_f32_16x16x32_bf16 a[48:51], a[180:183], v[180:183], a[48:51]
s_waitcnt vmcnt(12)
s_barrier
v_mfma_f32_16x16x32_bf16 a[80:83], a[180:183], v[204:207], a[80:83]
v_exp_f32 v133, v133
v_mfma_f32_16x16x32_bf16 a[80:83], a[176:179], v[200:203], a[80:83]
ds_read_b128 a[144:147], v2 offset:16384
v_cvt_pk_bf16_f32 v196, v144, v145
v_mfma_f32_16x16x32_bf16 a[112:115], a[176:179], v[208:211], a[112:115]
v_exp_f32 v134, v134
v_mfma_f32_16x16x32_bf16 a[112:115], a[180:183], v[212:215], a[112:115]
ds_read_b128 a[148:151], v2 offset:17408
v_cvt_pk_bf16_f32 v197, v146, v147
v_mfma_f32_16x16x32_bf16 a[116:119], a[188:191], v[212:215], a[116:119]
ds_read_b128 a[152:155], v2 offset:18432
v_cvt_pk_bf16_f32 v198, v148, v149
v_mfma_f32_16x16x32_bf16 a[116:119], a[184:187], v[208:211], a[116:119]
ds_read_b128 a[156:159], v2 offset:19456
v_cvt_pk_bf16_f32 v199, v150, v151
v_mfma_f32_16x16x32_bf16 a[84:87], a[184:187], v[200:203], a[84:87]
s_waitcnt vmcnt(9)
v_readfirstlane_b32 s66, v19
s_nop 0
s_cmp_lt_u32 s66, 16
s_cbranch_scc1 L_spin_1020
L_spinbk_1021:
v_mfma_f32_16x16x32_bf16 a[84:87], a[188:191], v[204:207], a[84:87]
ds_read_b128 a[160:163], v2 offset:20480
v_cndmask_b32 v136, v228, v17, s[0:1]
v_mfma_f32_16x16x32_bf16 a[52:55], a[188:191], v[180:183], a[52:55]
ds_read_b128 a[164:167], v2 offset:21504
v_cndmask_b32 v137, v228, v17, s[4:5]
v_mfma_f32_16x16x32_bf16 a[52:55], a[184:187], v[176:179], a[52:55]
ds_read_b128 a[168:171], v2 offset:22528
v_cndmask_b32 v138, v228, v17, s[6:7]
v_mfma_f32_16x16x32_bf16 a[56:59], a[192:195], v[176:179], a[56:59]
ds_read_b128 a[172:175], v2 offset:23552
v_cndmask_b32 v139, v228, v17, s[8:9]
v_mfma_f32_16x16x32_bf16 a[56:59], a[196:199], v[180:183], a[56:59]
v_exp_f32 v135, v135
v_mfma_f32_16x16x32_bf16 a[88:91], a[196:199], v[204:207], a[88:91]
v_cndmask_b32 v140, v228, v17, s[10:11]
v_cvt_pk_bf16_f32 v190, v132, v133
v_mfma_f32_16x16x32_bf16 a[88:91], a[192:195], v[200:203], a[88:91]
v_cndmask_b32 v141, v228, v17, s[12:13]
v_cvt_pk_bf16_f32 v191, v134, v135
v_mfma_f32_16x16x32_bf16 a[120:123], a[192:195], v[208:211], a[120:123]
v_cndmask_b32 v142, v228, v17, s[18:19]
v_cndmask_b32 v143, v228, v17, s[22:23]
v_mfma_f32_16x16x32_bf16 a[120:123], a[196:199], v[212:215], a[120:123]
s_waitcnt lgkmcnt(1)
v_cndmask_b32 v144, v228, v17, s[26:27]
v_cndmask_b32 v145, v228, v17, s[56:57]
v_mfma_f32_16x16x32_bf16 a[124:127], a[204:207], v[212:215], a[124:127]
v_cndmask_b32 v146, v228, v17, s[58:59]
v_cndmask_b32 v147, v228, v17, s[60:61]
v_mfma_f32_16x16x32_bf16 a[124:127], a[200:203], v[208:211], a[124:127]
v_cndmask_b32 v148, v228, v17, s[62:63]
v_cndmask_b32 v149, v228, v17, s[48:49]
v_mfma_f32_16x16x32_bf16 a[92:95], a[200:203], v[200:203], a[92:95]
v_cndmask_b32 v150, v228, v17, s[50:51]
v_cndmask_b32 v151, v228, v17, s[100:101]
v_mfma_f32_16x16x32_bf16 a[92:95], a[204:207], v[204:207], a[92:95]
v_accvgpr_read_b32 v21, a132
v_max_f32 v1, v1, v21
v_mfma_f32_16x16x32_bf16 a[60:63], a[204:207], v[180:183], a[60:63]
v_rcp_f32 v21, v21
v_mfma_f32_16x16x32_bf16 a[60:63], a[200:203], v[176:179], a[60:63]
v_accvgpr_read_b32 v232, a32
v_accvgpr_read_b32 v233, a33
v_mfma_f32_16x16x32_bf16 v[136:139], a[144:147], v[72:75], v[136:139]
ds_read_b128 a[176:179], v2 offset:24576
v_accvgpr_read_b32 v234, a34
v_mfma_f32_16x16x32_bf16 v[136:139], a[148:151], v[76:79], v[136:139]
ds_read_b128 a[180:183], v2 offset:25600
v_accvgpr_read_b32 v235, a35
v_mfma_f32_16x16x32_bf16 v[136:139], a[152:155], v[80:83], v[136:139]
ds_read_b128 a[184:187], v2 offset:26624
v_accvgpr_read_b32 v236, a36
v_mfma_f32_16x16x32_bf16 v[136:139], a[156:159], v[84:87], v[136:139]
s_waitcnt lgkmcnt(3)
ds_read_b128 a[188:191], v2 offset:27648
v_accvgpr_read_b32 v237, a37
v_mfma_f32_16x16x32_bf16 v[140:143], a[172:175], v[84:87], v[140:143]
ds_read_b128 a[192:195], v2 offset:28672
ds_read_b128 a[196:199], v2 offset:29696
ds_read_b128 a[200:203], v2 offset:30720
ds_read_b128 a[204:207], v2 offset:31744
v_mfma_f32_16x16x32_bf16 v[140:143], a[168:171], v[80:83], v[140:143]
ds_read_b128 a[144:147], v3 offset:16384
v_accvgpr_read_b32 v238, a38
v_mfma_f32_16x16x32_bf16 v[140:143], a[164:167], v[76:79], v[140:143]
ds_read_b128 a[148:151], v3 offset:24576
v_accvgpr_read_b32 v239, a39
v_mfma_f32_16x16x32_bf16 v[140:143], a[160:163], v[72:75], v[140:143]
s_waitcnt lgkmcnt(8)
ds_read_b128 a[152:155], v3 offset:17408
v_mul_f32 v21, v21, v6
v_mfma_f32_16x16x32_bf16 v[144:147], a[176:179], v[72:75], v[144:147]
ds_read_b128 a[156:159], v3 offset:25600
v_mul_f32 v232, v232, v21
v_mfma_f32_16x16x32_bf16 v[144:147], a[180:183], v[76:79], v[144:147]
s_waitcnt lgkmcnt(8)
ds_read_b128 a[160:163], v3 offset:18432
v_mul_f32 v233, v233, v21
v_mfma_f32_16x16x32_bf16 v[144:147], a[184:187], v[80:83], v[144:147]
ds_read_b128 a[164:167], v3 offset:26624
v_mul_f32 v234, v234, v21
v_mul_f32 v235, v235, v21
v_mul_f32 v236, v236, v21
v_mul_f32 v237, v237, v21
v_mul_f32 v238, v238, v21
v_mul_f32 v239, v239, v21
v_cvt_pk_bf16_f32 v232, v232, v233
v_cvt_pk_bf16_f32 v233, v234, v235
v_cvt_pk_bf16_f32 v234, v236, v237
v_cvt_pk_bf16_f32 v235, v238, v239
s_add_u32 s77, s74, 4096
buffer_store_dwordx4 v[232:235], v16, s[44:47], s77 offen sc1
v_accvgpr_read_b32 v240, a40
v_accvgpr_read_b32 v241, a41
v_accvgpr_read_b32 v242, a42
v_accvgpr_read_b32 v243, a43
v_accvgpr_read_b32 v244, a44
v_accvgpr_read_b32 v245, a45
v_accvgpr_read_b32 v246, a46
v_accvgpr_read_b32 v247, a47
v_mul_f32 v240, v240, v21
v_mul_f32 v241, v241, v21
v_mul_f32 v242, v242, v21
v_mul_f32 v243, v243, v21
v_mul_f32 v244, v244, v21
v_mul_f32 v245, v245, v21
v_mul_f32 v246, v246, v21
v_mul_f32 v247, v247, v21
v_cvt_pk_bf16_f32 v240, v240, v241
v_cvt_pk_bf16_f32 v241, v242, v243
v_cvt_pk_bf16_f32 v242, v244, v245
v_cvt_pk_bf16_f32 v243, v246, v247
s_add_u32 s77, s74, 12288
buffer_store_dwordx4 v[240:243], v16, s[44:47], s77 offen sc1
v_accvgpr_read_b32 v232, a48
v_accvgpr_read_b32 v233, a49
v_accvgpr_read_b32 v234, a50
v_accvgpr_read_b32 v235, a51
v_accvgpr_read_b32 v236, a52
v_accvgpr_read_b32 v237, a53
v_accvgpr_read_b32 v238, a54
v_accvgpr_read_b32 v239, a55
v_mul_f32 v232, v232, v21
v_mul_f32 v233, v233, v21
v_mul_f32 v234, v234, v21
v_mul_f32 v235, v235, v21
v_mul_f32 v236, v236, v21
v_mul_f32 v237, v237, v21
v_mul_f32 v238, v238, v21
v_mul_f32 v239, v239, v21
v_cvt_pk_bf16_f32 v232, v232, v233
v_cvt_pk_bf16_f32 v233, v234, v235
v_cvt_pk_bf16_f32 v234, v236, v237
v_cvt_pk_bf16_f32 v235, v238, v239
s_add_u32 s77, s74, 20480
buffer_store_dwordx4 v[232:235], v16, s[44:47], s77 offen sc1
v_accvgpr_read_b32 v240, a56
v_accvgpr_read_b32 v241, a57
v_accvgpr_read_b32 v242, a58
v_accvgpr_read_b32 v243, a59
v_accvgpr_read_b32 v244, a60
v_accvgpr_read_b32 v245, a61
v_accvgpr_read_b32 v246, a62
v_accvgpr_read_b32 v247, a63
v_mul_f32 v240, v240, v21
v_mul_f32 v241, v241, v21
v_mul_f32 v242, v242, v21
v_mul_f32 v243, v243, v21
v_mul_f32 v244, v244, v21
v_mul_f32 v245, v245, v21
v_mul_f32 v246, v246, v21
v_mul_f32 v247, v247, v21
v_cvt_pk_bf16_f32 v240, v240, v241
v_cvt_pk_bf16_f32 v241, v242, v243
v_cvt_pk_bf16_f32 v242, v244, v245
v_cvt_pk_bf16_f32 v243, v246, v247
s_add_u32 s77, s74, 28672
buffer_store_dwordx4 v[240:243], v16, s[44:47], s77 offen sc1
v_exp_f32 v136, v136
v_mfma_f32_16x16x32_bf16 v[144:147], a[188:191], v[84:87], v[144:147]
s_waitcnt lgkmcnt(5)
v_exp_f32 v137, v137
v_mfma_f32_16x16x32_bf16 v[148:151], a[204:207], v[84:87], v[148:151]
v_exp_f32 v138, v138
v_mfma_f32_16x16x32_bf16 v[148:151], a[200:203], v[80:83], v[148:151]
s_add_u32 s65, s84, 0
v_exp_f32 v139, v139
v_mfma_f32_16x16x32_bf16 v[148:151], a[196:199], v[76:79], v[148:151]
buffer_load_dwordx4 a[208:211], v14, s[44:47], s65 offen offset:0 sc1
v_mfma_f32_16x16x32_bf16 v[148:151], a[192:195], v[72:75], v[148:151]
v_exp_f32 v140, v140
v_mfma_f32_16x16x32_bf16 a[136:139], a[244:247], v[184:187], a[136:139]
buffer_load_dwordx4 a[216:219], v14, s[44:47], s65 offen offset:1024 sc1
v_mfma_f32_16x16x32_bf16 a[136:139], a[244:247], v[188:191], a[136:139]
v_exp_f32 v141, v141
v_mfma_f32_16x16x32_bf16 a[140:143], a[244:247], v[192:195], a[140:143]
ds_read_b128 a[168:171], v3 offset:19456
v_cvt_pk_bf16_f32 v208, v136, v137
v_mfma_f32_16x16x32_bf16 a[140:143], a[244:247], v[196:199], a[140:143]
buffer_load_dwordx4 a[224:227], v15, s[44:47], s65 offen offset:0 sc1
v_mfma_f32_16x16x32_bf16 a[64:67], a[144:147], v[184:187], a[64:67]
s_waitcnt lgkmcnt(1)
ds_read_b128 a[172:175], v3 offset:27648
v_cvt_pk_bf16_f32 v209, v138, v139
v_mfma_f32_16x16x32_bf16 a[64:67], a[148:151], v[188:191], a[64:67]
v_exp_f32 v142, v142
v_mfma_f32_16x16x32_bf16 a[96:99], a[148:151], v[196:199], a[96:99]
buffer_load_dwordx4 a[232:235], v15, s[44:47], s65 offen offset:1024 sc1
v_mfma_f32_16x16x32_bf16 a[96:99], a[144:147], v[192:195], a[96:99]
s_add_u32 s65, s84, 8192
ds_read_b128 a[176:179], v3 offset:20480
v_cvt_pk_bf16_f32 v210, v140, v141
v_mfma_f32_16x16x32_bf16 a[100:103], a[152:155], v[192:195], a[100:103]
buffer_load_dwordx4 a[212:215], v14, s[44:47], s65 offen offset:0 sc1
v_mfma_f32_16x16x32_bf16 a[100:103], a[156:159], v[196:199], a[100:103]
v_exp_f32 v143, v143
v_mfma_f32_16x16x32_bf16 a[68:71], a[156:159], v[188:191], a[68:71]
ds_read_b128 a[180:183], v3 offset:28672
v_xor_b32 v2, 0x8000, v2
v_mfma_f32_16x16x32_bf16 a[68:71], a[152:155], v[184:187], a[68:71]
buffer_load_dwordx4 a[220:223], v14, s[44:47], s65 offen offset:1024 sc1
v_mfma_f32_16x16x32_bf16 a[72:75], a[160:163], v[184:187], a[72:75]
v_exp_f32 v144, v144
v_mfma_f32_16x16x32_bf16 a[72:75], a[164:167], v[188:191], a[72:75]
ds_read_b128 a[184:187], v3 offset:21504
v_cvt_pk_bf16_f32 v211, v142, v143
v_mfma_f32_16x16x32_bf16 a[104:107], a[164:167], v[196:199], a[104:107]
buffer_load_dwordx4 a[228:231], v15, s[44:47], s65 offen offset:0 sc1
v_mfma_f32_16x16x32_bf16 a[104:107], a[160:163], v[192:195], a[104:107]
s_waitcnt lgkmcnt(2)
ds_read_b128 a[188:191], v3 offset:29696
v_accvgpr_read_b32 v22, a136
v_mfma_f32_16x16x32_bf16 a[108:111], a[168:171], v[192:195], a[108:111]
v_exp_f32 v145, v145
v_mfma_f32_16x16x32_bf16 a[108:111], a[172:175], v[196:199], a[108:111]
buffer_load_dwordx4 a[236:239], v15, s[44:47], s65 offen offset:1024 sc1
v_mfma_f32_16x16x32_bf16 a[76:79], a[172:175], v[188:191], a[76:79]
v_exp_f32 v146, v146
v_mfma_f32_16x16x32_bf16 a[76:79], a[168:171], v[184:187], a[76:79]
s_add_u32 s65, s84, 32768
ds_read_b128 a[192:195], v3 offset:22528
v_cvt_pk_bf16_f32 v212, v144, v145
v_mfma_f32_16x16x32_bf16 a[80:83], a[176:179], v[184:187], a[80:83]
s_waitcnt lgkmcnt(2)
buffer_load_dwordx4 v[152:155], v14, s[44:47], s65 offen offset:0 sc1
v_mfma_f32_16x16x32_bf16 a[80:83], a[180:183], v[188:191], a[80:83]
ds_read_b128 a[196:199], v3 offset:30720
ds_read_b128 a[200:203], v3 offset:23552
ds_read_b128 a[204:207], v3 offset:31744
v_mfma_f32_16x16x32_bf16 a[112:115], a[180:183], v[196:199], a[112:115]
s_waitcnt vmcnt(13)
s_barrier
v_xor_b32 v3, 0x8000, v3
v_mfma_f32_16x16x32_bf16 a[112:115], a[176:179], v[192:195], a[112:115]
buffer_load_dwordx4 v[160:163], v14, s[44:47], s65 offen offset:1024 sc1
v_exp_f32 v147, v147
v_mfma_f32_16x16x32_bf16 a[116:119], a[184:187], v[192:195], a[116:119]
s_waitcnt lgkmcnt(4)
v_exp_f32 v148, v148
v_mfma_f32_16x16x32_bf16 a[116:119], a[188:191], v[196:199], a[116:119]
buffer_load_dwordx4 v[168:171], v15, s[44:47], s65 offen offset:0 sc1
v_mfma_f32_16x16x32_bf16 a[84:87], a[188:191], v[188:191], a[84:87]
v_exp_f32 v149, v149
v_mfma_f32_16x16x32_bf16 a[84:87], a[184:187], v[184:187], a[84:87]
s_waitcnt lgkmcnt(0)
buffer_load_dwordx4 v[176:179], v15, s[44:47], s65 offen offset:1024 sc1
v_mfma_f32_16x16x32_bf16 a[88:91], a[192:195], v[184:187], a[88:91]
s_add_u32 s65, s84, 40960
ds_read_b128 a[144:147], v3 offset:0
v_cvt_pk_bf16_f32 v213, v146, v147
v_mfma_f32_16x16x32_bf16 a[88:91], a[196:199], v[188:191], a[88:91]
buffer_load_dwordx4 v[156:159], v14, s[44:47], s65 offen offset:0 sc1
v_mfma_f32_16x16x32_bf16 a[120:123], a[196:199], v[196:199], a[120:123]
v_exp_f32 v150, v150
v_mfma_f32_16x16x32_bf16 a[120:123], a[192:195], v[192:195], a[120:123]
buffer_load_dwordx4 v[164:167], v14, s[44:47], s65 offen offset:1024 sc1
ds_read_b128 a[148:151], v3 offset:8192
v_mfma_f32_16x16x32_bf16 a[124:127], a[200:203], v[192:195], a[124:127]
ds_read_b128 a[152:155], v3 offset:1024
v_cvt_pk_bf16_f32 v214, v148, v149
v_mfma_f32_16x16x32_bf16 a[124:127], a[204:207], v[196:199], a[124:127]
buffer_load_dwordx4 v[172:175], v15, s[44:47], s65 offen offset:0 sc1
ds_read_b128 a[156:159], v3 offset:9216
v_mfma_f32_16x16x32_bf16 a[92:95], a[204:207], v[188:191], a[92:95]
v_exp_f32 v151, v151
v_mfma_f32_16x16x32_bf16 a[92:95], a[200:203], v[184:187], a[92:95]
buffer_load_dwordx4 v[180:183], v15, s[44:47], s65 offen offset:1024 sc1
ds_read_b128 a[160:163], v3 offset:2048
ds_read_b128 a[164:167], v3 offset:10240
ds_read_b128 a[168:171], v3 offset:3072
ds_read_b128 a[172:175], v3 offset:11264
v_cvt_pk_bf16_f32 v215, v150, v151
v_max_f32 v1, v1, v22
v_rcp_f32 v22, v22
v_accvgpr_read_b32 v232, a64
v_accvgpr_read_b32 v233, a65
v_accvgpr_read_b32 v234, a66
v_accvgpr_read_b32 v235, a67
v_accvgpr_read_b32 v236, a68
v_accvgpr_read_b32 v237, a69
v_accvgpr_read_b32 v238, a70
v_accvgpr_read_b32 v239, a71
v_mul_f32 v22, v22, v8
v_mul_f32 v232, v232, v22
v_mul_f32 v233, v233, v22
v_mul_f32 v234, v234, v22
v_mul_f32 v235, v235, v22
v_mul_f32 v236, v236, v22
v_mul_f32 v237, v237, v22
v_mul_f32 v238, v238, v22
v_mul_f32 v239, v239, v22
v_cvt_pk_bf16_f32 v232, v232, v233
v_cvt_pk_bf16_f32 v233, v234, v235
v_cvt_pk_bf16_f32 v234, v236, v237
v_cvt_pk_bf16_f32 v235, v238, v239
s_add_u32 s77, s75, 0
buffer_store_dwordx4 v[232:235], v16, s[44:47], s77 offen sc1
s_branch L_TAIL_14
L_fallback_19:
s_waitcnt vmcnt(0) lgkmcnt(0)
s_barrier
s_mov_b32 s73, 1
s_mov_b32 s81, 0
v_and_b32 v232, 15, v0
v_lshrrev_b32 v233, 4, v0
v_lshlrev_b32 v233, 2, v233
v_sub_u32 v232, v232, v233
s_lshl_b32 s66, s30, 4
v_add_u32 v232, s66, v232
s_lshl_b32 s66, s16, 7
v_add_u32 v234, s66, v232
s_lshl_b32 s66, s3, 7
v_add_u32 v232, s66, v232
v_add_u32 v233, 64, v232
v_add_u32 v235, 64, v234
s_mov_b32 m0, s76
s_lshl_b32 s64, s30, 14
s_nop 0
buffer_load_dwordx4 v16, s[32:35], s64 offen offset:0 sc1 lds
s_nop 0
buffer_load_dwordx4 v16, s[32:35], s64 offen offset:1024 sc1 lds
s_nop 0
buffer_load_dwordx4 v16, s[32:35], s64 offen offset:2048 sc1 lds
s_nop 0
buffer_load_dwordx4 v16, s[32:35], s64 offen offset:3072 sc1 lds
s_add_u32 m0, s76, 4096
s_add_u32 s64, s64, 4096
s_nop 0
buffer_load_dwordx4 v16, s[32:35], s64 offen offset:0 sc1 lds
s_nop 0
buffer_load_dwordx4 v16, s[32:35], s64 offen offset:1024 sc1 lds
s_nop 0
buffer_load_dwordx4 v16, s[32:35], s64 offen offset:2048 sc1 lds
s_nop 0
buffer_load_dwordx4 v16, s[32:35], s64 offen offset:3072 sc1 lds
s_lshr_b32 s64, s76, 1
s_add_u32 m0, s64, 81920
s_and_b32 s69, s64, 8192
s_add_u32 s64, s64, s69
s_add_u32 s64, s64, 8192
s_nop 0
buffer_load_dwordx4 v16, s[32:35], s64 offen offset:0 sc1 lds
s_nop 0
buffer_load_dwordx4 v16, s[32:35], s64 offen offset:1024 sc1 lds
s_nop 0
buffer_load_dwordx4 v16, s[32:35], s64 offen offset:2048 sc1 lds
s_nop 0
buffer_load_dwordx4 v16, s[32:35], s64 offen offset:3072 sc1 lds
v_mov_b32 v20, 0xff800000
v_mov_b32 v21, 0xff800000
v_mov_b32 v22, 0xff800000
v_mov_b32 v23, 0xff800000
L_fbl_1023:
buffer_load_dwordx4 a[144:147], v16, s[32:35], s81 offen offset:0 sc1
buffer_load_dwordx4 a[148:151], v16, s[32:35], s81 offen offset:1024 sc1
buffer_load_dwordx4 a[152:155], v16, s[32:35], s81 offen offset:2048 sc1
buffer_load_dwordx4 a[156:159], v16, s[32:35], s81 offen offset:3072 sc1
s_add_u32 s64, s81, 4096
buffer_load_dwordx4 a[160:163], v16, s[32:35], s64 offen offset:0 sc1
buffer_load_dwordx4 a[164:167], v16, s[32:35], s64 offen offset:1024 sc1
buffer_load_dwordx4 a[168:171], v16, s[32:35], s64 offen offset:2048 sc1
buffer_load_dwordx4 a[172:175], v16, s[32:35], s64 offen offset:3072 sc1
v_subrev_u32 v88, 0, v232
v_ashrrev_i32 v88, 31, v88
v_and_b32 v88, 0xff800000, v88
v_subrev_u32 v89, 1, v232
v_ashrrev_i32 v89, 31, v89
v_and_b32 v89, 0xff800000, v89
v_subrev_u32 v90, 2, v232
v_ashrrev_i32 v90, 31, v90
v_and_b32 v90, 0xff800000, v90
v_subrev_u32 v91, 3, v232
v_ashrrev_i32 v91, 31, v91
v_and_b32 v91, 0xff800000, v91
v_subrev_u32 v92, 16, v232
v_ashrrev_i32 v92, 31, v92
v_and_b32 v92, 0xff800000, v92
v_subrev_u32 v93, 17, v232
v_ashrrev_i32 v93, 31, v93
v_and_b32 v93, 0xff800000, v93
v_subrev_u32 v94, 18, v232
v_ashrrev_i32 v94, 31, v94
v_and_b32 v94, 0xff800000, v94
v_subrev_u32 v95, 19, v232
v_ashrrev_i32 v95, 31, v95
v_and_b32 v95, 0xff800000, v95
v_subrev_u32 v232, 32, v232
v_subrev_u32 v104, 0, v233
v_ashrrev_i32 v104, 31, v104
v_and_b32 v104, 0xff800000, v104
v_subrev_u32 v105, 1, v233
v_ashrrev_i32 v105, 31, v105
v_and_b32 v105, 0xff800000, v105
v_subrev_u32 v106, 2, v233
v_ashrrev_i32 v106, 31, v106
v_and_b32 v106, 0xff800000, v106
v_subrev_u32 v107, 3, v233
v_ashrrev_i32 v107, 31, v107
v_and_b32 v107, 0xff800000, v107
v_subrev_u32 v108, 16, v233
v_ashrrev_i32 v108, 31, v108
v_and_b32 v108, 0xff800000, v108
v_subrev_u32 v109, 17, v233
v_ashrrev_i32 v109, 31, v109
v_and_b32 v109, 0xff800000, v109
v_subrev_u32 v110, 18, v233
v_ashrrev_i32 v110, 31, v110
v_and_b32 v110, 0xff800000, v110
v_subrev_u32 v111, 19, v233
v_ashrrev_i32 v111, 31, v111
v_and_b32 v111, 0xff800000, v111
v_subrev_u32 v233, 32, v233
v_subrev_u32 v120, 0, v234
v_ashrrev_i32 v120, 31, v120
v_and_b32 v120, 0xff800000, v120
v_subrev_u32 v121, 1, v234
v_ashrrev_i32 v121, 31, v121
v_and_b32 v121, 0xff800000, v121
v_subrev_u32 v122, 2, v234
v_ashrrev_i32 v122, 31, v122
v_and_b32 v122, 0xff800000, v122
v_subrev_u32 v123, 3, v234
v_ashrrev_i32 v123, 31, v123
v_and_b32 v123, 0xff800000, v123
v_subrev_u32 v124, 16, v234
v_ashrrev_i32 v124, 31, v124
v_and_b32 v124, 0xff800000, v124
v_subrev_u32 v125, 17, v234
v_ashrrev_i32 v125, 31, v125
v_and_b32 v125, 0xff800000, v125
v_subrev_u32 v126, 18, v234
v_ashrrev_i32 v126, 31, v126
v_and_b32 v126, 0xff800000, v126
v_subrev_u32 v127, 19, v234
v_ashrrev_i32 v127, 31, v127
v_and_b32 v127, 0xff800000, v127
v_subrev_u32 v234, 32, v234
v_subrev_u32 v136, 0, v235
v_ashrrev_i32 v136, 31, v136
v_and_b32 v136, 0xff800000, v136
v_subrev_u32 v137, 1, v235
v_ashrrev_i32 v137, 31, v137
v_and_b32 v137, 0xff800000, v137
v_subrev_u32 v138, 2, v235
v_ashrrev_i32 v138, 31, v138
v_and_b32 v138, 0xff800000, v138
v_subrev_u32 v139, 3, v235
v_ashrrev_i32 v139, 31, v139
v_and_b32 v139, 0xff800000, v139
v_subrev_u32 v140, 16, v235
v_ashrrev_i32 v140, 31, v140
v_and_b32 v140, 0xff800000, v140
v_subrev_u32 v141, 17, v235
v_ashrrev_i32 v141, 31, v141
v_and_b32 v141, 0xff800000, v141
v_subrev_u32 v142, 18, v235
v_ashrrev_i32 v142, 31, v142
v_and_b32 v142, 0xff800000, v142
v_subrev_u32 v143, 19, v235
v_ashrrev_i32 v143, 31, v143
v_and_b32 v143, 0xff800000, v143
v_subrev_u32 v235, 32, v235
s_waitcnt vmcnt(0)
v_mfma_f32_16x16x32_bf16 v[88:91], a[144:147], v[24:27], v[88:91]
v_mfma_f32_16x16x32_bf16 v[104:107], a[144:147], v[40:43], v[104:107]
v_mfma_f32_16x16x32_bf16 v[120:123], a[144:147], v[56:59], v[120:123]
v_mfma_f32_16x16x32_bf16 v[136:139], a[144:147], v[72:75], v[136:139]
v_mfma_f32_16x16x32_bf16 v[88:91], a[148:151], v[28:31], v[88:91]
v_mfma_f32_16x16x32_bf16 v[104:107], a[148:151], v[44:47], v[104:107]
v_mfma_f32_16x16x32_bf16 v[120:123], a[148:151], v[60:63], v[120:123]
v_mfma_f32_16x16x32_bf16 v[136:139], a[148:151], v[76:79], v[136:139]
v_mfma_f32_16x16x32_bf16 v[88:91], a[152:155], v[32:35], v[88:91]
v_mfma_f32_16x16x32_bf16 v[104:107], a[152:155], v[48:51], v[104:107]
v_mfma_f32_16x16x32_bf16 v[120:123], a[152:155], v[64:67], v[120:123]
v_mfma_f32_16x16x32_bf16 v[136:139], a[152:155], v[80:83], v[136:139]
v_mfma_f32_16x16x32_bf16 v[88:91], a[156:159], v[36:39], v[88:91]
v_mfma_f32_16x16x32_bf16 v[104:107], a[156:159], v[52:55], v[104:107]
v_mfma_f32_16x16x32_bf16 v[120:123], a[156:159], v[68:71], v[120:123]
v_mfma_f32_16x16x32_bf16 v[136:139], a[156:159], v[84:87], v[136:139]
v_mfma_f32_16x16x32_bf16 v[92:95], a[160:163], v[24:27], v[92:95]
v_mfma_f32_16x16x32_bf16 v[108:111], a[160:163], v[40:43], v[108:111]
v_mfma_f32_16x16x32_bf16 v[124:127], a[160:163], v[56:59], v[124:127]
v_mfma_f32_16x16x32_bf16 v[140:143], a[160:163], v[72:75], v[140:143]
v_mfma_f32_16x16x32_bf16 v[92:95], a[164:167], v[28:31], v[92:95]
v_mfma_f32_16x16x32_bf16 v[108:111], a[164:167], v[44:47], v[108:111]
v_mfma_f32_16x16x32_bf16 v[124:127], a[164:167], v[60:63], v[124:127]
v_mfma_f32_16x16x32_bf16 v[140:143], a[164:167], v[76:79], v[140:143]
v_mfma_f32_16x16x32_bf16 v[92:95], a[168:171], v[32:35], v[92:95]
v_mfma_f32_16x16x32_bf16 v[108:111], a[168:171], v[48:51], v[108:111]
v_mfma_f32_16x16x32_bf16 v[124:127], a[168:171], v[64:67], v[124:127]
v_mfma_f32_16x16x32_bf16 v[140:143], a[168:171], v[80:83], v[140:143]
v_mfma_f32_16x16x32_bf16 v[92:95], a[172:175], v[36:39], v[92:95]
v_mfma_f32_16x16x32_bf16 v[108:111], a[172:175], v[52:55], v[108:111]
v_mfma_f32_16x16x32_bf16 v[124:127], a[172:175], v[68:71], v[124:127]
v_mfma_f32_16x16x32_bf16 v[140:143], a[172:175], v[84:87], v[140:143]
s_nop 7
v_max3_f32 v20, v20, v88, v89
v_max3_f32 v20, v20, v90, v91
v_max3_f32 v20, v20, v92, v93
v_max3_f32 v20, v20, v94, v95
v_max3_f32 v21, v21, v104, v105
v_max3_f32 v21, v21, v106, v107
v_max3_f32 v21, v21, v108, v109
v_max3_f32 v21, v21, v110, v111
v_max3_f32 v22, v22, v120, v121
v_max3_f32 v22, v22, v122, v123
v_max3_f32 v22, v22, v124, v125
v_max3_f32 v22, v22, v126, v127
v_max3_f32 v23, v23, v136, v137
v_max3_f32 v23, v23, v138, v139
v_max3_f32 v23, v23, v140, v141
v_max3_f32 v23, v23, v142, v143
s_add_u32 s81, s81, 16384
s_cmp_lt_u32 s81, s34
s_cbranch_scc1 L_fbl_1023
v_mov_b32 v248, v20
v_mov_b32 v249, v21
v_mov_b32 v250, v22
v_mov_b32 v251, v23
v_permlane16_swap_b32 v248, v20
v_permlane16_swap_b32 v249, v21
v_permlane16_swap_b32 v250, v22
v_permlane16_swap_b32 v251, v23
v_max_f32 v20, v20, v248
v_max_f32 v21, v21, v249
v_max_f32 v22, v22, v250
v_max_f32 v23, v23, v251
v_mov_b32 v248, v20
v_mov_b32 v249, v21
v_mov_b32 v250, v22
v_mov_b32 v251, v23
v_permlane32_swap_b32 v248, v20
v_permlane32_swap_b32 v249, v21
v_permlane32_swap_b32 v250, v22
v_permlane32_swap_b32 v251, v23
v_max_f32 v20, v20, v248
v_max_f32 v21, v21, v249
v_max_f32 v22, v22, v250
v_max_f32 v23, v23, v251
v_mov_b32 v252, v20
v_mov_b32 v253, v21
v_mov_b32 v254, v22
v_mov_b32 v255, v23
s_branch L_attstart_15
L_spin_2024:
s_mov_b32 s67, 0x8000
L_spinlp_2026:
s_sleep 1
buffer_load_dword v19, off, s[52:55], s72 offset:0 sc1
s_waitcnt vmcnt(0)
v_readfirstlane_b32 s66, v19
s_sub_u32 s67, s67, 1
s_cbranch_scc1 L_spinbk_2025
s_cmp_lt_u32 s66, 16
s_cbranch_scc1 L_spinlp_2026
s_branch L_spinbk_2025
L_spin_2028:
s_mov_b32 s67, 0x8000
L_spinlp_2030:
s_sleep 1
buffer_load_dword v19, off, s[52:55], s72 offset:0 sc1
s_waitcnt vmcnt(0)
v_readfirstlane_b32 s66, v19
s_sub_u32 s67, s67, 1
s_cbranch_scc1 L_spinbk_2029
s_cmp_lt_u32 s66, 1
s_cbranch_scc1 L_spinlp_2030
s_branch L_spinbk_2029
L_codeend:
.section .rodata,"a"
.p2align 6
.amdhsa_kernel gated_mix__compressed_kv_cla__sliding_local_dilated__prompt_kernel
  .amdhsa_next_free_vgpr 512
  .amdhsa_next_free_sgpr 102
  .amdhsa_accum_offset 256
  .amdhsa_group_segment_fixed_size 0
  .amdhsa_kernarg_size 104
  .amdhsa_user_sgpr_count 2
  .amdhsa_user_sgpr_kernarg_segment_ptr 1
  .amdhsa_system_sgpr_workgroup_id_x 1
.end_amdhsa_kernel
```

```asm
; @launch grid=(256,1,1) block=(256,1,1) lds=163840
.amdgcn_target "amdgcn-amd-amdhsa--gfx950"
.text
.globl gated_mix__compressed_kv_cla__sliding_local_dilated__prompt_kernel
.p2align 8
.type gated_mix__compressed_kv_cla__sliding_local_dilated__prompt_kernel,@function
gated_mix__compressed_kv_cla__sliding_local_dilated__prompt_kernel:
s_cmp_ge_u32 s2, 256
s_cbranch_scc1 L_end
s_load_dwordx16 s[4:19], s[0:1], 0
s_load_dwordx8 s[20:27], s[0:1], 64
s_load_dwordx2 s[28:29], s[0:1], 96
s_getpc_b64 s[88:89]
L_pc:
v_lshrrev_b32 v1, 6, v0
s_lshr_b32 s67, s2, 3
v_lshl_add_u32 v24, s67, 2, v1
s_mov_b32 s90, L_codeend-L_pc
s_mov_b32 s91, 0x20000
v_and_b32 v25, 7, v0
v_lshlrev_b32 v25, 7, v25
v_lshl_add_u32 v24, v24, 10, v25
buffer_load_dword a252, v24, s[88:91], 0 offen
v_and_b32 v0, 63, v0
v_readfirstlane_b32 s30, v1
v_lshrrev_b32 v24, 3, v0
v_lshrrev_b32 v25, 4, v0
v_and_b32 v26, 7, v0
v_xor_b32 v26, v26, v25
v_lshlrev_b32 v26, 4, v26
v_lshl_add_u32 v12, v24, 10, v26
v_xor_b32 v13, 64, v12
v_bfe_u32 v26, v0, 1, 3
v_xor_b32 v26, v26, v25
v_lshlrev_b32 v26, 5, v26
v_and_b32 v24, 1, v0
v_lshl_add_u32 v26, v24, 4, v26
v_lshl_add_u32 v14, v25, 13, v26
v_xor_b32 v15, 128, v14
s_and_b32 s66, s2, 7
s_and_b32 s68, s67, 3
s_lshl2_add_u32 s31, s66, s68
s_lshr_b32 s3, s67, 2
s_lshl2_add_u32 s80, s67, s30
s_lshl_b32 s70, s3, 18
s_lshl_b32 s66, s30, 16
s_add_u32 s70, s70, s66
s_lshl_b32 s71, s30, 17
s_lshl_b32 s66, s31, 8
s_add_u32 s71, s71, s66
s_lshl_b32 s76, s30, 13
s_lshl_b32 s77, s30, 12
s_lshl_b32 s78, s30, 10
s_waitcnt lgkmcnt(0)
s_mov_b32 s32, s6
s_mov_b32 s33, s7
s_mov_b32 s34, 2097152
s_mov_b32 s35, 0x20000
s_mov_b32 s36, s10
s_mov_b32 s37, s11
s_mov_b32 s38, 4194304
s_mov_b32 s39, 0x20000
s_mov_b32 s40, s12
s_mov_b32 s41, s13
s_mov_b32 s42, 4194304
s_mov_b32 s43, 0x20000
s_add_u32 m0, s76, 0
s_add_u32 s64, s70, 0
buffer_load_dwordx4 v12, s[32:35], s64 offen lds
s_add_u32 m0, s76, 1024
s_add_u32 s64, s70, 8192
buffer_load_dwordx4 v13, s[32:35], s64 offen lds
s_add_u32 m0, s76, 2048
s_add_u32 s64, s70, 16384
buffer_load_dwordx4 v12, s[32:35], s64 offen lds
s_add_u32 m0, s76, 3072
s_add_u32 s64, s70, 24576
buffer_load_dwordx4 v13, s[32:35], s64 offen lds
s_add_u32 m0, s76, 4096
s_add_u32 s64, s70, 32768
buffer_load_dwordx4 v12, s[32:35], s64 offen lds
s_add_u32 m0, s76, 5120
s_add_u32 s64, s70, 40960
buffer_load_dwordx4 v13, s[32:35], s64 offen lds
s_add_u32 m0, s76, 6144
s_add_u32 s64, s70, 49152
buffer_load_dwordx4 v12, s[32:35], s64 offen lds
s_add_u32 m0, s76, 7168
s_add_u32 s64, s70, 57344
buffer_load_dwordx4 v13, s[32:35], s64 offen lds
s_add_u32 m0, s77, 65536
s_add_u32 s64, s71, 0
buffer_load_dwordx4 v14, s[36:39], s64 offen lds
s_add_u32 m0, s77, 66560
s_add_u32 s64, s71, 32768
buffer_load_dwordx4 v14, s[36:39], s64 offen lds
s_add_u32 m0, s77, 67584
s_add_u32 s64, s71, 65536
buffer_load_dwordx4 v15, s[36:39], s64 offen lds
s_add_u32 m0, s77, 68608
s_add_u32 s64, s71, 98304
buffer_load_dwordx4 v15, s[36:39], s64 offen lds
s_add_u32 m0, s77, 81920
s_add_u32 s64, s71, 0
buffer_load_dwordx4 v14, s[40:43], s64 offen lds
s_add_u32 m0, s77, 82944
s_add_u32 s64, s71, 32768
buffer_load_dwordx4 v14, s[40:43], s64 offen lds
s_add_u32 m0, s77, 83968
s_add_u32 s64, s71, 65536
buffer_load_dwordx4 v15, s[40:43], s64 offen lds
s_add_u32 m0, s77, 84992
s_add_u32 s64, s71, 98304
buffer_load_dwordx4 v15, s[40:43], s64 offen lds
s_mov_b32 s44, s28
s_mov_b32 s45, s29
s_mov_b32 s46, 134217728
s_mov_b32 s47, 0x20000
s_mov_b32 s48, s4
s_mov_b32 s49, s5
s_mov_b32 s50, 4194304
s_mov_b32 s51, 0x20000
s_mov_b32 s52, s26
s_mov_b32 s53, s27
s_mov_b32 s54, 256
s_mov_b32 s55, 0x20000
s_mov_b32 s56, s8
s_mov_b32 s57, s9
s_mov_b32 s58, 8388608
s_mov_b32 s59, 0x20000
s_mov_b32 s60, s18
s_mov_b32 s61, s19
s_mov_b32 s62, 6291456
s_mov_b32 s63, 0x20000
v_accvgpr_write_b32 a251, 1
v_and_b32 v24, 15, v0
v_lshrrev_b32 v26, 1, v24
v_xor_b32 v26, v26, v25
v_lshlrev_b32 v26, 4, v26
v_lshl_add_u32 v26, v24, 7, v26
v_add_u32 v2, s76, v26
v_xor_b32 v3, 64, v2
v_bfe_u32 v24, v0, 2, 2
v_lshl_add_u32 v27, v25, 3, v24
v_and_b32 v1, 3, v0
v_cmp_eq_u32 vcc, 0, v1
v_lshlrev_b32 v1, 3, v1
v_lshl_add_u32 v26, v27, 8, v1
v_add_u32 v26, 65536, v26
v_and_b32 v1, 1, v25
v_lshl_add_u32 v24, v1, 2, v24
v_lshlrev_b32 v16, 4, v0
v_mov_b32 v28, 0x3f803f80
v_cndmask_b32 v28, 0, v28, vcc
v_accvgpr_write_b32 a244, v28
v_accvgpr_write_b32 a245, v28
v_accvgpr_write_b32 a246, v28
v_accvgpr_write_b32 a247, v28
v_xor_b32 v1, 0, v24
v_lshl_add_u32 v4, v1, 5, v26
v_xor_b32 v1, 1, v24
v_lshl_add_u32 v5, v1, 5, v26
v_xor_b32 v1, 2, v24
v_lshl_add_u32 v6, v1, 5, v26
v_xor_b32 v1, 3, v24
v_lshl_add_u32 v7, v1, 5, v26
v_xor_b32 v1, 4, v24
v_lshl_add_u32 v8, v1, 5, v26
v_xor_b32 v1, 5, v24
v_lshl_add_u32 v9, v1, 5, v26
v_xor_b32 v1, 6, v24
v_lshl_add_u32 v10, v1, 5, v26
v_xor_b32 v1, 7, v24
v_lshl_add_u32 v11, v1, 5, v26
s_sub_u32 s16, 15, s3
s_lshl_b32 s72, s3, 18
s_lshl_b32 s73, s16, 18
s_cmp_lt_u32 s30, 2
s_cselect_b32 s67, s3, s16
s_lshl4_add_u32 s74, s31, s67
s_and_b32 s66, s30, 1
s_lshl1_add_u32 s74, s74, s66
s_lshl_b32 s74, s74, 10
s_add_u32 s74, s74, 60817408
s_lshl_b32 s66, s30, 15
s_add_u32 s72, s72, s66
s_add_u32 s73, s73, s66
s_mul_i32 s75, s30, 98304
s_lshl_b32 s66, s31, 6
s_add_u32 s75, s75, s66
s_lshl_b32 s79, s31, 20
s_lshl_b32 s66, s3, 17
s_add_u32 s79, s79, s66
s_lshl_b32 s66, s30, 15
s_add_u32 s79, s79, s66
v_bfe_u32 v23, v0, 1, 1
v_lshrrev_b32 v1, 5, v0
v_xor_b32 v23, v23, v1
v_lshlrev_b32 v23, 5, v23
v_and_b32 v1, 1, v0
v_lshl_add_u32 v23, v1, 4, v23
v_lshrrev_b32 v1, 2, v0
v_mul_u32_u24 v1, 6144, v1
v_add_u32 v23, v1, v23
s_lshl_b32 s81, s80, 13
s_and_b32 s67, s2, 7
s_lshl_b32 s82, s67, 8
s_add_u32 s82, s82, s81
s_lshl_b32 s67, s67, 10
s_add_u32 s81, s81, s67
s_add_u32 s83, s81, 1048576
v_mul_u32_u24 v1, 1792, v25
v_add_u32 v1, v1, v16
s_lshl_b32 s68, s2, 3
s_lshl1_add_u32 s68, s30, s68
v_lshrrev_b32 v18, 5, v0
v_add_u32 v18, s68, v18
v_and_b32 v19, 31, v0
v_lshlrev_b32 v19, 4, v19
v_lshl_add_u32 v18, v18, 11, v19
v_mov_b32 v21, 0
v_min_u32 v20, 1, v0
v_lshlrev_b32 v20, 30, v20
v_accvgpr_write_b32 a240, -1
v_accvgpr_write_b32 a241, -1
v_accvgpr_write_b32 a242, -1
v_accvgpr_write_b32 a243, -1
s_lshr_b32 s69, s2, 6
s_or_b32 s69, s69, s30
s_lshl_b32 s69, s69, 20
s_add_u32 s69, s69, s2
s_lshl_b32 s69, s69, 8
s_add_u32 s69, s69, 59768832
s_add_u32 m0, s77, 98304
s_add_u32 s64, s71, 524288
buffer_load_dwordx4 v14, s[36:39], s64 offen lds
s_add_u32 m0, s77, 99328
s_add_u32 s64, s71, 557056
buffer_load_dwordx4 v14, s[36:39], s64 offen lds
s_add_u32 m0, s77, 100352
s_add_u32 s64, s71, 589824
buffer_load_dwordx4 v15, s[36:39], s64 offen lds
s_add_u32 m0, s77, 101376
s_add_u32 s64, s71, 622592
buffer_load_dwordx4 v15, s[36:39], s64 offen lds
s_add_u32 m0, s77, 114688
s_add_u32 s64, s71, 524288
buffer_load_dwordx4 v14, s[40:43], s64 offen lds
s_add_u32 m0, s77, 115712
s_add_u32 s64, s71, 557056
buffer_load_dwordx4 v14, s[40:43], s64 offen lds
s_add_u32 m0, s77, 116736
s_add_u32 s64, s71, 589824
buffer_load_dwordx4 v15, s[40:43], s64 offen lds
s_add_u32 m0, s77, 117760
s_add_u32 s64, s71, 622592
buffer_load_dwordx4 v15, s[40:43], s64 offen lds
s_waitcnt vmcnt(8)
s_barrier
ds_read_b128 a[0:3], v2 offset:0
ds_read_b128 a[4:7], v3 offset:0
ds_read_b64_tr_b16 a[72:73], v4 offset:0
ds_read_b64_tr_b16 a[74:75], v4 offset:1024
ds_read_b64_tr_b16 a[76:77], v4 offset:8192
ds_read_b64_tr_b16 a[78:79], v4 offset:9216
ds_read_b128 a[8:11], v2 offset:2048
ds_read_b128 a[12:15], v3 offset:2048
ds_read_b128 a[16:19], v2 offset:4096
ds_read_b128 a[20:23], v3 offset:4096
ds_read_b128 a[24:27], v2 offset:6144
ds_read_b128 a[28:31], v3 offset:6144
ds_read_b64_tr_b16 a[80:81], v5 offset:0
ds_read_b64_tr_b16 a[82:83], v5 offset:1024
ds_read_b64_tr_b16 a[84:85], v5 offset:8192
ds_read_b64_tr_b16 a[86:87], v5 offset:9216
ds_read_b64_tr_b16 a[88:89], v6 offset:0
ds_read_b64_tr_b16 a[90:91], v6 offset:1024
ds_read_b64_tr_b16 a[92:93], v6 offset:8192
ds_read_b64_tr_b16 a[94:95], v6 offset:9216
s_waitcnt lgkmcnt(15)
v_mfma_f32_16x16x32_bf16 v[184:187], a[72:75], a[0:3], 0
s_waitcnt lgkmcnt(14)
s_add_u32 m0, s76, 32768
ds_read_b64_tr_b16 a[96:97], v7 offset:0
v_mfma_f32_16x16x32_bf16 v[184:187], a[76:79], a[4:7], v[184:187]
s_waitcnt lgkmcnt(13)
s_add_u32 s64, s70, 128
ds_read_b64_tr_b16 a[98:99], v7 offset:1024
v_mfma_f32_16x16x32_bf16 v[192:195], a[76:79], a[12:15], 0
buffer_load_dwordx4 v12, s[32:35], s64 offen lds
v_mfma_f32_16x16x32_bf16 v[192:195], a[72:75], a[8:11], v[192:195]
s_waitcnt lgkmcnt(13)
s_add_u32 m0, s76, 33792
ds_read_b64_tr_b16 a[100:101], v7 offset:8192
v_mfma_f32_16x16x32_bf16 v[200:203], a[72:75], a[16:19], 0
s_waitcnt lgkmcnt(13)
s_add_u32 s64, s70, 8320
ds_read_b64_tr_b16 a[102:103], v7 offset:9216
v_mfma_f32_16x16x32_bf16 v[200:203], a[76:79], a[20:23], v[200:203]
s_waitcnt lgkmcnt(12)
buffer_load_dwordx4 v13, s[32:35], s64 offen lds
v_mfma_f32_16x16x32_bf16 v[208:211], a[76:79], a[28:31], 0
s_add_u32 m0, s76, 34816
ds_read_b64_tr_b16 a[104:105], v8 offset:0
v_mfma_f32_16x16x32_bf16 v[208:211], a[72:75], a[24:27], v[208:211]
s_waitcnt lgkmcnt(11)
s_add_u32 s64, s70, 16512
ds_read_b64_tr_b16 a[106:107], v8 offset:1024
v_mfma_f32_16x16x32_bf16 v[212:215], a[80:83], a[24:27], 0
s_waitcnt lgkmcnt(10)
buffer_load_dwordx4 v12, s[32:35], s64 offen lds
v_mfma_f32_16x16x32_bf16 v[212:215], a[84:87], a[28:31], v[212:215]
ds_read_b64_tr_b16 a[108:109], v8 offset:8192
v_mfma_f32_16x16x32_bf16 v[204:207], a[84:87], a[20:23], 0
s_add_u32 m0, s76, 35840
s_add_u32 s17, s78, .-L_pc+6144
ds_read_b64_tr_b16 a[110:111], v8 offset:9216
v_mfma_f32_16x16x32_bf16 v[204:207], a[80:83], a[16:19], v[204:207]
s_add_u32 s64, s70, 24704
buffer_load_dword a252, v16, s[88:91], s17 offen
v_mfma_f32_16x16x32_bf16 v[196:199], a[80:83], a[8:11], 0
buffer_load_dwordx4 v13, s[32:35], s64 offen lds
v_mfma_f32_16x16x32_bf16 v[196:199], a[84:87], a[12:15], v[196:199]
s_add_u32 m0, s76, 36864
ds_read_b64_tr_b16 a[112:113], v9 offset:0
v_mfma_f32_16x16x32_bf16 v[188:191], a[84:87], a[4:7], 0
s_add_u32 s64, s70, 32896
ds_read_b64_tr_b16 a[114:115], v9 offset:1024
v_mfma_f32_16x16x32_bf16 v[188:191], a[80:83], a[0:3], v[188:191]
s_waitcnt lgkmcnt(6)
buffer_load_dwordx4 v12, s[32:35], s64 offen lds
v_mfma_f32_16x16x32_bf16 v[216:219], a[88:91], a[0:3], 0
s_add_u32 m0, s76, 37888
ds_read_b64_tr_b16 a[116:117], v9 offset:8192
v_mfma_f32_16x16x32_bf16 v[216:219], a[92:95], a[4:7], v[216:219]
s_add_u32 s64, s70, 41088
ds_read_b64_tr_b16 a[118:119], v9 offset:9216
v_mfma_f32_16x16x32_bf16 v[224:227], a[92:95], a[12:15], 0
buffer_load_dwordx4 v13, s[32:35], s64 offen lds
v_mfma_f32_16x16x32_bf16 v[224:227], a[88:91], a[8:11], v[224:227]
ds_read_b64_tr_b16 a[72:73], v10 offset:0
v_mfma_f32_16x16x32_bf16 v[232:235], a[88:91], a[16:19], 0
s_add_u32 m0, s76, 38912
ds_read_b64_tr_b16 a[74:75], v10 offset:1024
v_mfma_f32_16x16x32_bf16 v[232:235], a[92:95], a[20:23], v[232:235]
s_add_u32 s64, s70, 49280
ds_read_b64_tr_b16 a[76:77], v10 offset:8192
v_mfma_f32_16x16x32_bf16 v[240:243], a[92:95], a[28:31], 0
buffer_load_dwordx4 v12, s[32:35], s64 offen lds
v_mfma_f32_16x16x32_bf16 v[240:243], a[88:91], a[24:27], v[240:243]
s_add_u32 m0, s76, 39936
ds_read_b64_tr_b16 a[78:79], v10 offset:9216
v_mfma_f32_16x16x32_bf16 v[244:247], a[96:99], a[24:27], 0
s_add_u32 s64, s70, 57472
ds_read_b64_tr_b16 a[80:81], v11 offset:0
v_mfma_f32_16x16x32_bf16 v[244:247], a[100:103], a[28:31], v[244:247]
buffer_load_dwordx4 v13, s[32:35], s64 offen lds
v_mfma_f32_16x16x32_bf16 v[236:239], a[100:103], a[20:23], 0
ds_read_b64_tr_b16 a[82:83], v11 offset:1024
v_mfma_f32_16x16x32_bf16 v[236:239], a[96:99], a[16:19], v[236:239]
s_add_u32 m0, s77, 131072
ds_read_b64_tr_b16 a[84:85], v11 offset:8192
v_mfma_f32_16x16x32_bf16 v[228:231], a[96:99], a[8:11], 0
s_add_u32 s64, s71, 1048576
ds_read_b64_tr_b16 a[86:87], v11 offset:9216
v_mfma_f32_16x16x32_bf16 v[228:231], a[100:103], a[12:15], v[228:231]
buffer_load_dwordx4 v14, s[36:39], s64 offen lds
v_mfma_f32_16x16x32_bf16 v[220:223], a[100:103], a[4:7], 0
s_add_u32 m0, s77, 132096
ds_read_b64_tr_b16 a[88:89], v4 offset:16384
v_mfma_f32_16x16x32_bf16 v[220:223], a[96:99], a[0:3], v[220:223]
s_waitcnt lgkmcnt(6)
s_add_u32 s64, s71, 1081344
ds_read_b64_tr_b16 a[90:91], v4 offset:17408
v_mfma_f32_16x16x32_bf16 v[152:155], a[104:107], a[0:3], 0
buffer_load_dwordx4 v14, s[36:39], s64 offen lds
v_mfma_f32_16x16x32_bf16 v[152:155], a[108:111], a[4:7], v[152:155]
s_add_u32 m0, s77, 133120
ds_read_b64_tr_b16 a[92:93], v4 offset:24576
v_mfma_f32_16x16x32_bf16 v[160:163], a[108:111], a[12:15], 0
s_add_u32 s64, s71, 1114112
ds_read_b64_tr_b16 a[94:95], v4 offset:25600
v_mfma_f32_16x16x32_bf16 v[160:163], a[104:107], a[8:11], v[160:163]
buffer_load_dwordx4 v15, s[36:39], s64 offen lds
v_mfma_f32_16x16x32_bf16 v[168:171], a[104:107], a[16:19], 0
ds_read_b64_tr_b16 a[96:97], v5 offset:16384
v_mfma_f32_16x16x32_bf16 v[168:171], a[108:111], a[20:23], v[168:171]
s_add_u32 m0, s77, 134144
ds_read_b64_tr_b16 a[98:99], v5 offset:17408
v_mfma_f32_16x16x32_bf16 v[176:179], a[108:111], a[28:31], 0
s_add_u32 s64, s71, 1146880
ds_read_b64_tr_b16 a[100:101], v5 offset:24576
v_mfma_f32_16x16x32_bf16 v[176:179], a[104:107], a[24:27], v[176:179]
buffer_load_dwordx4 v15, s[36:39], s64 offen lds
v_mfma_f32_16x16x32_bf16 v[180:183], a[112:115], a[24:27], 0
s_add_u32 m0, s77, 147456
global_load_dwordx4 a[144:147], v18, s[4:5] offset:0
v_mfma_f32_16x16x32_bf16 v[180:183], a[116:119], a[28:31], v[180:183]
s_add_u32 s64, s71, 1048576
ds_read_b64_tr_b16 a[102:103], v5 offset:25600
v_mfma_f32_16x16x32_bf16 v[172:175], a[116:119], a[20:23], 0
buffer_load_dwordx4 v14, s[40:43], s64 offen lds
v_mfma_f32_16x16x32_bf16 v[172:175], a[112:115], a[16:19], v[172:175]
s_add_u32 m0, s77, 148480
ds_read_b64_tr_b16 a[104:105], v6 offset:16384
v_mfma_f32_16x16x32_bf16 v[164:167], a[112:115], a[8:11], 0
s_add_u32 s64, s71, 1081344
ds_read_b64_tr_b16 a[106:107], v6 offset:17408
v_mfma_f32_16x16x32_bf16 v[164:167], a[116:119], a[12:15], v[164:167]
buffer_load_dwordx4 v14, s[40:43], s64 offen lds
v_mfma_f32_16x16x32_bf16 v[156:159], a[116:119], a[4:7], 0
ds_read_b64_tr_b16 a[108:109], v6 offset:24576
v_mfma_f32_16x16x32_bf16 v[156:159], a[112:115], a[0:3], v[156:159]
s_add_u32 m0, s77, 149504
ds_read_b64_tr_b16 a[110:111], v6 offset:25600
v_mfma_f32_16x16x32_bf16 v[24:27], a[72:75], a[0:3], 0
s_waitcnt lgkmcnt(5)
s_add_u32 s64, s71, 1114112
ds_read_b64_tr_b16 a[112:113], v7 offset:16384
v_mfma_f32_16x16x32_bf16 v[24:27], a[76:79], a[4:7], v[24:27]
buffer_load_dwordx4 v15, s[40:43], s64 offen lds
v_mfma_f32_16x16x32_bf16 v[40:43], a[76:79], a[12:15], 0
s_add_u32 m0, s77, 150528
ds_read_b64_tr_b16 a[114:115], v7 offset:17408
v_mfma_f32_16x16x32_bf16 v[40:43], a[72:75], a[8:11], v[40:43]
s_add_u32 s64, s71, 1146880
ds_read_b64_tr_b16 a[116:117], v7 offset:24576
v_mfma_f32_16x16x32_bf16 v[56:59], a[72:75], a[16:19], 0
buffer_load_dwordx4 v15, s[40:43], s64 offen lds
v_mfma_f32_16x16x32_bf16 v[56:59], a[76:79], a[20:23], v[56:59]
ds_read_b64_tr_b16 a[118:119], v7 offset:25600
v_mfma_f32_16x16x32_bf16 v[72:75], a[76:79], a[28:31], 0
v_mfma_f32_16x16x32_bf16 v[72:75], a[72:75], a[24:27], v[72:75]
ds_read_b64_tr_b16 a[72:73], v8 offset:16384
v_mfma_f32_16x16x32_bf16 v[136:139], a[80:83], a[24:27], 0
s_add_u32 m0, s76, 0
ds_read_b64_tr_b16 a[74:75], v8 offset:17408
v_mfma_f32_16x16x32_bf16 v[136:139], a[84:87], a[28:31], v[136:139]
s_add_u32 s64, s70, 256
ds_read_b64_tr_b16 a[76:77], v8 offset:24576
v_mfma_f32_16x16x32_bf16 v[120:123], a[84:87], a[20:23], 0
buffer_load_dwordx4 v12, s[32:35], s64 offen lds
v_mfma_f32_16x16x32_bf16 v[120:123], a[80:83], a[16:19], v[120:123]
ds_read_b64_tr_b16 a[78:79], v8 offset:25600
v_mfma_f32_16x16x32_bf16 v[104:107], a[80:83], a[8:11], 0
s_add_u32 m0, s76, 1024
v_mfma_f32_16x16x32_bf16 v[104:107], a[84:87], a[12:15], v[104:107]
s_add_u32 s64, s70, 8448
v_mfma_f32_16x16x32_bf16 v[88:91], a[84:87], a[4:7], 0
buffer_load_dwordx4 v13, s[32:35], s64 offen lds
v_mfma_f32_16x16x32_bf16 v[88:91], a[80:83], a[0:3], v[88:91]
ds_read_b64_tr_b16 a[80:81], v9 offset:16384
v_mfma_f32_16x16x32_bf16 v[28:31], a[0:3], a[88:91], 0
ds_read_b64_tr_b16 a[82:83], v9 offset:17408
v_mfma_f32_16x16x32_bf16 v[28:31], a[4:7], a[92:95], v[28:31]
s_add_u32 m0, s76, 2048
ds_read_b64_tr_b16 a[84:85], v9 offset:24576
v_mfma_f32_16x16x32_bf16 v[44:47], a[12:15], a[92:95], 0
s_add_u32 s64, s70, 16640
ds_read_b64_tr_b16 a[86:87], v9 offset:25600
v_mfma_f32_16x16x32_bf16 v[44:47], a[8:11], a[88:91], v[44:47]
buffer_load_dwordx4 v12, s[32:35], s64 offen lds
v_mfma_f32_16x16x32_bf16 v[60:63], a[16:19], a[88:91], 0
global_load_dwordx4 a[160:163], v19, s[22:23] offset:0
v_mfma_f32_16x16x32_bf16 v[60:63], a[20:23], a[92:95], v[60:63]
v_mfma_f32_16x16x32_bf16 v[76:79], a[28:31], a[92:95], 0
s_add_u32 m0, s76, 3072
v_mfma_f32_16x16x32_bf16 v[76:79], a[24:27], a[88:91], v[76:79]
s_add_u32 s64, s70, 24832
ds_read_b64_tr_b16 a[88:89], v10 offset:16384
v_mfma_f32_16x16x32_bf16 v[140:143], a[24:27], a[96:99], 0
s_waitcnt lgkmcnt(5)
buffer_load_dwordx4 v13, s[32:35], s64 offen lds
v_mfma_f32_16x16x32_bf16 v[140:143], a[28:31], a[100:103], v[140:143]
ds_read_b64_tr_b16 a[90:91], v10 offset:17408
v_mfma_f32_16x16x32_bf16 v[124:127], a[20:23], a[100:103], 0
ds_read_b64_tr_b16 a[92:93], v10 offset:24576
v_mfma_f32_16x16x32_bf16 v[124:127], a[16:19], a[96:99], v[124:127]
s_add_u32 m0, s76, 4096
ds_read_b64_tr_b16 a[94:95], v10 offset:25600
v_mfma_f32_16x16x32_bf16 v[108:111], a[8:11], a[96:99], 0
s_add_u32 s64, s70, 33024
v_mfma_f32_16x16x32_bf16 v[108:111], a[12:15], a[100:103], v[108:111]
buffer_load_dwordx4 v12, s[32:35], s64 offen lds
v_mfma_f32_16x16x32_bf16 v[92:95], a[4:7], a[100:103], 0
v_mfma_f32_16x16x32_bf16 v[92:95], a[0:3], a[96:99], v[92:95]
s_add_u32 m0, s76, 5120
ds_read_b64_tr_b16 a[96:97], v11 offset:16384
v_mfma_f32_16x16x32_bf16 v[32:35], a[0:3], a[104:107], 0
s_add_u32 s64, s70, 41216
ds_read_b64_tr_b16 a[98:99], v11 offset:17408
v_mfma_f32_16x16x32_bf16 v[32:35], a[4:7], a[108:111], v[32:35]
buffer_load_dwordx4 v13, s[32:35], s64 offen lds
v_mfma_f32_16x16x32_bf16 v[48:51], a[12:15], a[108:111], 0
ds_read_b64_tr_b16 a[100:101], v11 offset:24576
v_mfma_f32_16x16x32_bf16 v[48:51], a[8:11], a[104:107], v[48:51]
ds_read_b64_tr_b16 a[102:103], v11 offset:25600
v_mfma_f32_16x16x32_bf16 v[64:67], a[16:19], a[104:107], 0
s_add_u32 m0, s76, 6144
v_mfma_f32_16x16x32_bf16 v[64:67], a[20:23], a[108:111], v[64:67]
s_add_u32 s64, s70, 49408
v_mfma_f32_16x16x32_bf16 v[80:83], a[28:31], a[108:111], 0
buffer_load_dwordx4 v12, s[32:35], s64 offen lds
v_mfma_f32_16x16x32_bf16 v[80:83], a[24:27], a[104:107], v[80:83]
v_mfma_f32_16x16x32_bf16 v[144:147], a[24:27], a[112:115], 0
v_mfma_f32_16x16x32_bf16 v[144:147], a[28:31], a[116:119], v[144:147]
s_add_u32 m0, s76, 7168
v_mfma_f32_16x16x32_bf16 v[128:131], a[20:23], a[116:119], 0
s_add_u32 s64, s70, 57600
v_mfma_f32_16x16x32_bf16 v[128:131], a[16:19], a[112:115], v[128:131]
buffer_load_dwordx4 v13, s[32:35], s64 offen lds
v_mfma_f32_16x16x32_bf16 v[112:115], a[8:11], a[112:115], 0
v_mfma_f32_16x16x32_bf16 v[112:115], a[12:15], a[116:119], v[112:115]
v_mfma_f32_16x16x32_bf16 v[96:99], a[4:7], a[116:119], 0
v_mfma_f32_16x16x32_bf16 v[96:99], a[0:3], a[112:115], v[96:99]
v_mfma_f32_16x16x32_bf16 v[36:39], a[0:3], a[72:75], 0
global_load_dwordx4 a[148:151], v18, s[4:5] offset:512
v_mfma_f32_16x16x32_bf16 v[36:39], a[4:7], a[76:79], v[36:39]
v_mfma_f32_16x16x32_bf16 v[52:55], a[12:15], a[76:79], 0
s_waitcnt vmcnt(28) lgkmcnt(0)
s_barrier
v_mfma_f32_16x16x32_bf16 v[52:55], a[8:11], a[72:75], v[52:55]
s_add_u32 m0, s77, 65536
ds_read_b64_tr_b16 a[104:105], v4 offset:32768
v_mfma_f32_16x16x32_bf16 v[68:71], a[16:19], a[72:75], 0
s_add_u32 s64, s71, 1572864
ds_read_b64_tr_b16 a[106:107], v4 offset:33792
v_mfma_f32_16x16x32_bf16 v[68:71], a[20:23], a[76:79], v[68:71]
buffer_load_dwordx4 v14, s[36:39], s64 offen lds
v_mfma_f32_16x16x32_bf16 v[84:87], a[28:31], a[76:79], 0
ds_read_b64_tr_b16 a[108:109], v4 offset:40960
v_mfma_f32_16x16x32_bf16 v[84:87], a[24:27], a[72:75], v[84:87]
ds_read_b64_tr_b16 a[110:111], v4 offset:41984
v_mfma_f32_16x16x32_bf16 v[148:151], a[24:27], a[80:83], 0
ds_read_b64_tr_b16 a[112:113], v5 offset:32768
v_mfma_f32_16x16x32_bf16 v[148:151], a[28:31], a[84:87], v[148:151]
ds_read_b64_tr_b16 a[114:115], v5 offset:33792
v_mfma_f32_16x16x32_bf16 v[132:135], a[20:23], a[84:87], 0
s_waitcnt vmcnt(20)
ds_read_b128 a[32:35], v2 offset:32768
v_mfma_f32_16x16x32_bf16 v[132:135], a[16:19], a[80:83], v[132:135]
s_add_u32 m0, s77, 66560
ds_read_b128 a[36:39], v3 offset:32768
v_mfma_f32_16x16x32_bf16 v[116:119], a[8:11], a[80:83], 0
s_add_u32 s64, s71, 1605632
ds_read_b128 a[40:43], v2 offset:34816
v_mfma_f32_16x16x32_bf16 v[116:119], a[12:15], a[84:87], v[116:119]
buffer_load_dwordx4 v14, s[36:39], s64 offen lds
v_mfma_f32_16x16x32_bf16 v[100:103], a[4:7], a[84:87], 0
ds_read_b128 a[44:47], v3 offset:34816
v_mfma_f32_16x16x32_bf16 v[100:103], a[0:3], a[80:83], v[100:103]
ds_read_b128 a[48:51], v2 offset:36864
v_mfma_f32_16x16x32_bf16 v[248:251], a[0:3], a[88:91], 0
ds_read_b128 a[52:55], v3 offset:36864
v_mfma_f32_16x16x32_bf16 v[248:251], a[4:7], a[92:95], v[248:251]
ds_read_b128 a[56:59], v2 offset:38912
v_mfma_f32_16x16x32_bf16 v[252:255], a[12:15], a[92:95], 0
ds_read_b128 a[60:63], v3 offset:38912
v_mfma_f32_16x16x32_bf16 v[252:255], a[8:11], a[88:91], v[252:255]
s_add_u32 m0, s77, 67584
ds_read_b64_tr_b16 a[116:117], v5 offset:40960
v_mfma_f32_16x16x32_bf16 a[120:123], a[16:19], a[88:91], 0
s_add_u32 s64, s71, 1638400
ds_read_b64_tr_b16 a[118:119], v5 offset:41984
v_mfma_f32_16x16x32_bf16 a[120:123], a[20:23], a[92:95], a[120:123]
buffer_load_dwordx4 v15, s[36:39], s64 offen lds
v_mfma_f32_16x16x32_bf16 a[124:127], a[28:31], a[92:95], 0
ds_read_b64_tr_b16 a[72:73], v6 offset:32768
v_mfma_f32_16x16x32_bf16 a[124:127], a[24:27], a[88:91], a[124:127]
ds_read_b64_tr_b16 a[74:75], v6 offset:33792
v_mfma_f32_16x16x32_bf16 a[128:131], a[24:27], a[96:99], 0
ds_read_b64_tr_b16 a[76:77], v6 offset:40960
v_mfma_f32_16x16x32_bf16 a[128:131], a[28:31], a[100:103], a[128:131]
ds_read_b64_tr_b16 a[78:79], v6 offset:41984
v_mfma_f32_16x16x32_bf16 a[132:135], a[20:23], a[100:103], 0
ds_read_b64_tr_b16 a[80:81], v7 offset:32768
v_mfma_f32_16x16x32_bf16 a[132:135], a[16:19], a[96:99], a[132:135]
s_add_u32 m0, s77, 68608
ds_read_b64_tr_b16 a[82:83], v7 offset:33792
v_mfma_f32_16x16x32_bf16 a[136:139], a[8:11], a[96:99], 0
s_add_u32 s64, s71, 1671168
global_load_dwordx4 a[164:167], v19, s[22:23] offset:512
v_mfma_f32_16x16x32_bf16 a[136:139], a[12:15], a[100:103], a[136:139]
buffer_load_dwordx4 v15, s[36:39], s64 offen lds
v_mfma_f32_16x16x32_bf16 a[140:143], a[4:7], a[100:103], 0
ds_read_b64_tr_b16 a[84:85], v7 offset:40960
v_mfma_f32_16x16x32_bf16 a[140:143], a[0:3], a[96:99], a[140:143]
s_waitcnt lgkmcnt(7)
ds_read_b64_tr_b16 a[86:87], v7 offset:41984
v_mfma_f32_16x16x32_bf16 v[184:187], a[104:107], a[32:35], v[184:187]
ds_read_b64_tr_b16 a[88:89], v8 offset:32768
v_mfma_f32_16x16x32_bf16 v[184:187], a[108:111], a[36:39], v[184:187]
ds_read_b64_tr_b16 a[90:91], v8 offset:33792
v_mfma_f32_16x16x32_bf16 v[192:195], a[108:111], a[44:47], v[192:195]
ds_read_b64_tr_b16 a[92:93], v8 offset:40960
v_mfma_f32_16x16x32_bf16 v[192:195], a[104:107], a[40:43], v[192:195]
s_add_u32 m0, s77, 81920
ds_read_b64_tr_b16 a[94:95], v8 offset:41984
v_mfma_f32_16x16x32_bf16 v[200:203], a[104:107], a[48:51], v[200:203]
s_add_u32 s64, s71, 1572864
ds_read_b64_tr_b16 a[96:97], v9 offset:32768
v_mfma_f32_16x16x32_bf16 v[200:203], a[108:111], a[52:55], v[200:203]
buffer_load_dwordx4 v14, s[40:43], s64 offen lds
v_mfma_f32_16x16x32_bf16 v[208:211], a[108:111], a[60:63], v[208:211]
ds_read_b64_tr_b16 a[98:99], v9 offset:33792
v_mfma_f32_16x16x32_bf16 v[208:211], a[104:107], a[56:59], v[208:211]
ds_read_b64_tr_b16 a[100:101], v9 offset:40960
v_mfma_f32_16x16x32_bf16 v[212:215], a[112:115], a[56:59], v[212:215]
ds_read_b64_tr_b16 a[102:103], v9 offset:41984
v_mfma_f32_16x16x32_bf16 v[212:215], a[116:119], a[60:63], v[212:215]
ds_read_b64_tr_b16 a[104:105], v10 offset:32768
v_mfma_f32_16x16x32_bf16 v[204:207], a[116:119], a[52:55], v[204:207]
ds_read_b64_tr_b16 a[106:107], v10 offset:33792
v_mfma_f32_16x16x32_bf16 v[204:207], a[112:115], a[48:51], v[204:207]
s_add_u32 m0, s77, 82944
ds_read_b64_tr_b16 a[108:109], v10 offset:40960
v_mfma_f32_16x16x32_bf16 v[196:199], a[112:115], a[40:43], v[196:199]
s_add_u32 s64, s71, 1605632
ds_read_b64_tr_b16 a[110:111], v10 offset:41984
v_mfma_f32_16x16x32_bf16 v[196:199], a[116:119], a[44:47], v[196:199]
buffer_load_dwordx4 v14, s[40:43], s64 offen lds
v_mfma_f32_16x16x32_bf16 v[188:191], a[116:119], a[36:39], v[188:191]
v_mfma_f32_16x16x32_bf16 v[188:191], a[112:115], a[32:35], v[188:191]
s_waitcnt lgkmcnt(7)
ds_read_b64_tr_b16 a[112:113], v11 offset:32768
v_mfma_f32_16x16x32_bf16 v[216:219], a[72:75], a[32:35], v[216:219]
ds_read_b64_tr_b16 a[114:115], v11 offset:33792
v_mfma_f32_16x16x32_bf16 v[216:219], a[76:79], a[36:39], v[216:219]
ds_read_b64_tr_b16 a[116:117], v11 offset:40960
v_mfma_f32_16x16x32_bf16 v[224:227], a[76:79], a[44:47], v[224:227]
ds_read_b64_tr_b16 a[118:119], v11 offset:41984
v_mfma_f32_16x16x32_bf16 v[224:227], a[72:75], a[40:43], v[224:227]
s_add_u32 m0, s77, 83968
v_mfma_f32_16x16x32_bf16 v[232:235], a[72:75], a[48:51], v[232:235]
s_add_u32 s64, s71, 1638400
v_mfma_f32_16x16x32_bf16 v[232:235], a[76:79], a[52:55], v[232:235]
buffer_load_dwordx4 v15, s[40:43], s64 offen lds
v_mfma_f32_16x16x32_bf16 v[240:243], a[76:79], a[60:63], v[240:243]
v_mfma_f32_16x16x32_bf16 v[240:243], a[72:75], a[56:59], v[240:243]
ds_read_b64_tr_b16 a[72:73], v4 offset:49152
v_mfma_f32_16x16x32_bf16 v[244:247], a[80:83], a[56:59], v[244:247]
global_load_dwordx4 a[152:155], v18, s[4:5] offset:1024
v_mfma_f32_16x16x32_bf16 v[244:247], a[84:87], a[60:63], v[244:247]
ds_read_b64_tr_b16 a[74:75], v4 offset:50176
v_mfma_f32_16x16x32_bf16 v[236:239], a[84:87], a[52:55], v[236:239]
ds_read_b64_tr_b16 a[76:77], v4 offset:57344
v_mfma_f32_16x16x32_bf16 v[236:239], a[80:83], a[48:51], v[236:239]
s_add_u32 m0, s77, 84992
ds_read_b64_tr_b16 a[78:79], v4 offset:58368
v_mfma_f32_16x16x32_bf16 v[228:231], a[80:83], a[40:43], v[228:231]
s_add_u32 s64, s71, 1671168
v_mfma_f32_16x16x32_bf16 v[228:231], a[84:87], a[44:47], v[228:231]
buffer_load_dwordx4 v15, s[40:43], s64 offen lds
v_mfma_f32_16x16x32_bf16 v[220:223], a[84:87], a[36:39], v[220:223]
v_mfma_f32_16x16x32_bf16 v[220:223], a[80:83], a[32:35], v[220:223]
ds_read_b64_tr_b16 a[80:81], v5 offset:49152
v_mfma_f32_16x16x32_bf16 v[152:155], a[88:91], a[32:35], v[152:155]
ds_read_b64_tr_b16 a[82:83], v5 offset:50176
v_mfma_f32_16x16x32_bf16 v[152:155], a[92:95], a[36:39], v[152:155]
ds_read_b64_tr_b16 a[84:85], v5 offset:57344
v_mfma_f32_16x16x32_bf16 v[160:163], a[92:95], a[44:47], v[160:163]
ds_read_b64_tr_b16 a[86:87], v5 offset:58368
v_mfma_f32_16x16x32_bf16 v[160:163], a[88:91], a[40:43], v[160:163]
v_mfma_f32_16x16x32_bf16 v[168:171], a[88:91], a[48:51], v[168:171]
v_mfma_f32_16x16x32_bf16 v[168:171], a[92:95], a[52:55], v[168:171]
v_mfma_f32_16x16x32_bf16 v[176:179], a[92:95], a[60:63], v[176:179]
s_add_u32 m0, s76, 32768
v_mfma_f32_16x16x32_bf16 v[176:179], a[88:91], a[56:59], v[176:179]
s_waitcnt lgkmcnt(4)
s_add_u32 s64, s70, 384
ds_read_b64_tr_b16 a[88:89], v6 offset:49152
v_mfma_f32_16x16x32_bf16 v[180:183], a[96:99], a[56:59], v[180:183]
buffer_load_dwordx4 v12, s[32:35], s64 offen lds
v_mfma_f32_16x16x32_bf16 v[180:183], a[100:103], a[60:63], v[180:183]
ds_read_b64_tr_b16 a[90:91], v6 offset:50176
v_mfma_f32_16x16x32_bf16 v[172:175], a[100:103], a[52:55], v[172:175]
ds_read_b64_tr_b16 a[92:93], v6 offset:57344
v_mfma_f32_16x16x32_bf16 v[172:175], a[96:99], a[48:51], v[172:175]
ds_read_b64_tr_b16 a[94:95], v6 offset:58368
v_mfma_f32_16x16x32_bf16 v[164:167], a[96:99], a[40:43], v[164:167]
v_mfma_f32_16x16x32_bf16 v[164:167], a[100:103], a[44:47], v[164:167]
s_add_u32 m0, s76, 33792
v_mfma_f32_16x16x32_bf16 v[156:159], a[100:103], a[36:39], v[156:159]
s_add_u32 s64, s70, 8576
v_mfma_f32_16x16x32_bf16 v[156:159], a[96:99], a[32:35], v[156:159]
buffer_load_dwordx4 v13, s[32:35], s64 offen lds
v_mfma_f32_16x16x32_bf16 v[24:27], a[104:107], a[32:35], v[24:27]
ds_read_b64_tr_b16 a[96:97], v7 offset:49152
v_mfma_f32_16x16x32_bf16 v[24:27], a[108:111], a[36:39], v[24:27]
ds_read_b64_tr_b16 a[98:99], v7 offset:50176
v_mfma_f32_16x16x32_bf16 v[40:43], a[108:111], a[44:47], v[40:43]
ds_read_b64_tr_b16 a[100:101], v7 offset:57344
v_mfma_f32_16x16x32_bf16 v[40:43], a[104:107], a[40:43], v[40:43]
ds_read_b64_tr_b16 a[102:103], v7 offset:58368
v_mfma_f32_16x16x32_bf16 v[56:59], a[104:107], a[48:51], v[56:59]
s_add_u32 m0, s76, 34816
global_load_dwordx4 a[168:171], v19, s[22:23] offset:1024
v_mfma_f32_16x16x32_bf16 v[56:59], a[108:111], a[52:55], v[56:59]
s_add_u32 s64, s70, 16768
v_mfma_f32_16x16x32_bf16 v[72:75], a[108:111], a[60:63], v[72:75]
s_waitcnt vmcnt(14)
buffer_load_dwordx4 v12, s[32:35], s64 offen lds
v_mfma_f32_16x16x32_bf16 v[72:75], a[104:107], a[56:59], v[72:75]
ds_read_b64_tr_b16 a[104:105], v8 offset:49152
v_mfma_f32_16x16x32_bf16 v[136:139], a[112:115], a[56:59], v[136:139]
ds_read_b64_tr_b16 a[106:107], v8 offset:50176
v_mfma_f32_16x16x32_bf16 v[136:139], a[116:119], a[60:63], v[136:139]
ds_read_b64_tr_b16 a[108:109], v8 offset:57344
v_add_u32 v4, 0x8000, v4
v_mfma_f32_16x16x32_bf16 v[120:123], a[116:119], a[52:55], v[120:123]
ds_read_b64_tr_b16 a[110:111], v8 offset:58368
v_mfma_f32_16x16x32_bf16 v[120:123], a[112:115], a[48:51], v[120:123]
s_add_u32 m0, s76, 35840
ds_read_b128 a[0:3], v2 offset:0
v_mfma_f32_16x16x32_bf16 v[104:107], a[112:115], a[40:43], v[104:107]
s_add_u32 s64, s70, 24960
ds_read_b128 a[4:7], v3 offset:0
v_mfma_f32_16x16x32_bf16 v[104:107], a[116:119], a[44:47], v[104:107]
buffer_load_dwordx4 v13, s[32:35], s64 offen lds
v_mfma_f32_16x16x32_bf16 v[88:91], a[116:119], a[36:39], v[88:91]
ds_read_b128 a[8:11], v2 offset:2048
v_mfma_f32_16x16x32_bf16 v[88:91], a[112:115], a[32:35], v[88:91]
ds_read_b128 a[12:15], v3 offset:2048
v_mfma_f32_16x16x32_bf16 v[28:31], a[32:35], a[72:75], v[28:31]
ds_read_b128 a[16:19], v2 offset:4096
v_mfma_f32_16x16x32_bf16 v[28:31], a[36:39], a[76:79], v[28:31]
ds_read_b128 a[20:23], v3 offset:4096
v_add_u32 v5, 0x8000, v5
v_mfma_f32_16x16x32_bf16 v[44:47], a[44:47], a[76:79], v[44:47]
s_add_u32 m0, s76, 36864
ds_read_b128 a[24:27], v2 offset:6144
v_mfma_f32_16x16x32_bf16 v[44:47], a[40:43], a[72:75], v[44:47]
s_add_u32 s64, s70, 33152
ds_read_b128 a[28:31], v3 offset:6144
v_mfma_f32_16x16x32_bf16 v[60:63], a[48:51], a[72:75], v[60:63]
buffer_load_dwordx4 v12, s[32:35], s64 offen lds
v_mfma_f32_16x16x32_bf16 v[60:63], a[52:55], a[76:79], v[60:63]
ds_read_b64_tr_b16 a[112:113], v9 offset:49152
v_mfma_f32_16x16x32_bf16 v[76:79], a[60:63], a[76:79], v[76:79]
ds_read_b64_tr_b16 a[114:115], v9 offset:50176
v_mfma_f32_16x16x32_bf16 v[76:79], a[56:59], a[72:75], v[76:79]
s_waitcnt lgkmcnt(8)
ds_read_b64_tr_b16 a[116:117], v9 offset:57344
v_mfma_f32_16x16x32_bf16 v[140:143], a[56:59], a[80:83], v[140:143]
buffer_load_dword a252, v16, s[56:59], s81 offen
v_mfma_f32_16x16x32_bf16 v[140:143], a[60:63], a[84:87], v[140:143]
s_add_u32 m0, s76, 37888
ds_read_b64_tr_b16 a[118:119], v9 offset:58368
v_add_u32 v6, 0x8000, v6
v_mfma_f32_16x16x32_bf16 v[124:127], a[52:55], a[84:87], v[124:127]
s_add_u32 s64, s70, 41344
ds_read_b64_tr_b16 a[72:73], v10 offset:49152
v_mfma_f32_16x16x32_bf16 v[124:127], a[48:51], a[80:83], v[124:127]
buffer_load_dwordx4 v13, s[32:35], s64 offen lds
v_mfma_f32_16x16x32_bf16 v[108:111], a[40:43], a[80:83], v[108:111]
ds_read_b64_tr_b16 a[74:75], v10 offset:50176
v_mfma_f32_16x16x32_bf16 v[108:111], a[44:47], a[84:87], v[108:111]
ds_read_b64_tr_b16 a[76:77], v10 offset:57344
v_mfma_f32_16x16x32_bf16 v[92:95], a[36:39], a[84:87], v[92:95]
ds_read_b64_tr_b16 a[78:79], v10 offset:58368
v_mfma_f32_16x16x32_bf16 v[92:95], a[32:35], a[80:83], v[92:95]
ds_read_b64_tr_b16 a[80:81], v11 offset:49152
v_mfma_f32_16x16x32_bf16 v[32:35], a[32:35], a[88:91], v[32:35]
s_add_u32 m0, s76, 38912
global_load_dwordx4 a[156:159], v18, s[4:5] offset:1536
v_mfma_f32_16x16x32_bf16 v[32:35], a[36:39], a[92:95], v[32:35]
s_add_u32 s64, s70, 49536
ds_read_b64_tr_b16 a[82:83], v11 offset:50176
v_add_u32 v7, 0x8000, v7
v_mfma_f32_16x16x32_bf16 v[48:51], a[44:47], a[92:95], v[48:51]
buffer_load_dwordx4 v12, s[32:35], s64 offen lds
v_mfma_f32_16x16x32_bf16 v[48:51], a[40:43], a[88:91], v[48:51]
ds_read_b64_tr_b16 a[84:85], v11 offset:57344
v_mfma_f32_16x16x32_bf16 v[64:67], a[48:51], a[88:91], v[64:67]
ds_read_b64_tr_b16 a[86:87], v11 offset:58368
v_mfma_f32_16x16x32_bf16 v[64:67], a[52:55], a[92:95], v[64:67]
v_mfma_f32_16x16x32_bf16 v[80:83], a[60:63], a[92:95], v[80:83]
v_mfma_f32_16x16x32_bf16 v[80:83], a[56:59], a[88:91], v[80:83]
s_add_u32 m0, s76, 39936
v_mfma_f32_16x16x32_bf16 v[144:147], a[56:59], a[96:99], v[144:147]
s_add_u32 s64, s70, 57728
v_mfma_f32_16x16x32_bf16 v[144:147], a[60:63], a[100:103], v[144:147]
buffer_load_dwordx4 v13, s[32:35], s64 offen lds
v_mfma_f32_16x16x32_bf16 v[128:131], a[52:55], a[100:103], v[128:131]
v_add_u32 v8, 0x8000, v8
v_mfma_f32_16x16x32_bf16 v[128:131], a[48:51], a[96:99], v[128:131]
v_mfma_f32_16x16x32_bf16 v[112:115], a[40:43], a[96:99], v[112:115]
v_mfma_f32_16x16x32_bf16 v[112:115], a[44:47], a[100:103], v[112:115]
v_mfma_f32_16x16x32_bf16 v[96:99], a[36:39], a[100:103], v[96:99]
v_add_u32 v9, 0x8000, v9
v_add_u32 v10, 0x8000, v10
v_mfma_f32_16x16x32_bf16 v[96:99], a[32:35], a[96:99], v[96:99]
v_add_u32 v11, 0x8000, v11
v_mfma_f32_16x16x32_bf16 v[36:39], a[32:35], a[104:107], v[36:39]
v_mfma_f32_16x16x32_bf16 v[36:39], a[36:39], a[108:111], v[36:39]
v_mfma_f32_16x16x32_bf16 v[52:55], a[44:47], a[108:111], v[52:55]
s_waitcnt lgkmcnt(0)
s_barrier
v_mfma_f32_16x16x32_bf16 v[52:55], a[40:43], a[104:107], v[52:55]
s_add_u32 m0, s77, 98304
ds_read_b64_tr_b16 a[88:89], v4 offset:32768
v_mfma_f32_16x16x32_bf16 v[68:71], a[48:51], a[104:107], v[68:71]
s_add_u32 s64, s71, 2097152
ds_read_b64_tr_b16 a[90:91], v4 offset:33792
v_mfma_f32_16x16x32_bf16 v[68:71], a[52:55], a[108:111], v[68:71]
buffer_load_dwordx4 v14, s[36:39], s64 offen lds
v_mfma_f32_16x16x32_bf16 v[84:87], a[60:63], a[108:111], v[84:87]
ds_read_b64_tr_b16 a[92:93], v4 offset:40960
v_mfma_f32_16x16x32_bf16 v[84:87], a[56:59], a[104:107], v[84:87]
ds_read_b64_tr_b16 a[94:95], v4 offset:41984
v_mfma_f32_16x16x32_bf16 v[148:151], a[56:59], a[112:115], v[148:151]
ds_read_b64_tr_b16 a[96:97], v5 offset:32768
v_mfma_f32_16x16x32_bf16 v[148:151], a[60:63], a[116:119], v[148:151]
ds_read_b64_tr_b16 a[98:99], v5 offset:33792
v_mfma_f32_16x16x32_bf16 v[132:135], a[52:55], a[116:119], v[132:135]
ds_read_b64_tr_b16 a[100:101], v5 offset:40960
v_mfma_f32_16x16x32_bf16 v[132:135], a[48:51], a[112:115], v[132:135]
s_add_u32 m0, s77, 99328
ds_read_b64_tr_b16 a[102:103], v5 offset:41984
v_mfma_f32_16x16x32_bf16 v[116:119], a[40:43], a[112:115], v[116:119]
s_add_u32 s64, s71, 2129920
global_load_dwordx4 a[172:175], v19, s[22:23] offset:1536
v_mfma_f32_16x16x32_bf16 v[116:119], a[44:47], a[116:119], v[116:119]
buffer_load_dwordx4 v14, s[36:39], s64 offen lds
v_mfma_f32_16x16x32_bf16 v[100:103], a[36:39], a[116:119], v[100:103]
buffer_load_dword a252, v1, s[60:63], s82 offen
v_mfma_f32_16x16x32_bf16 v[100:103], a[32:35], a[112:115], v[100:103]
ds_read_b64_tr_b16 a[104:105], v6 offset:32768
v_mfma_f32_16x16x32_bf16 v[248:251], a[32:35], a[72:75], v[248:251]
ds_read_b64_tr_b16 a[106:107], v6 offset:33792
v_mfma_f32_16x16x32_bf16 v[248:251], a[36:39], a[76:79], v[248:251]
ds_read_b64_tr_b16 a[108:109], v6 offset:40960
v_mfma_f32_16x16x32_bf16 v[252:255], a[44:47], a[76:79], v[252:255]
ds_read_b64_tr_b16 a[110:111], v6 offset:41984
v_mfma_f32_16x16x32_bf16 v[252:255], a[40:43], a[72:75], v[252:255]
s_add_u32 m0, s77, 100352
ds_read_b64_tr_b16 a[112:113], v7 offset:32768
v_mfma_f32_16x16x32_bf16 a[120:123], a[48:51], a[72:75], a[120:123]
s_add_u32 s64, s71, 2162688
ds_read_b64_tr_b16 a[114:115], v7 offset:33792
v_mfma_f32_16x16x32_bf16 a[120:123], a[52:55], a[76:79], a[120:123]
buffer_load_dwordx4 v15, s[36:39], s64 offen lds
v_mfma_f32_16x16x32_bf16 a[124:127], a[60:63], a[76:79], a[124:127]
ds_read_b64_tr_b16 a[116:117], v7 offset:40960
v_mfma_f32_16x16x32_bf16 a[124:127], a[56:59], a[72:75], a[124:127]
ds_read_b64_tr_b16 a[118:119], v7 offset:41984
v_mfma_f32_16x16x32_bf16 a[128:131], a[56:59], a[80:83], a[128:131]
ds_read_b64_tr_b16 a[72:73], v8 offset:32768
v_mfma_f32_16x16x32_bf16 a[128:131], a[60:63], a[84:87], a[128:131]
ds_read_b64_tr_b16 a[74:75], v8 offset:33792
v_mfma_f32_16x16x32_bf16 a[132:135], a[52:55], a[84:87], a[132:135]
ds_read_b64_tr_b16 a[76:77], v8 offset:40960
v_mfma_f32_16x16x32_bf16 a[132:135], a[48:51], a[80:83], a[132:135]
s_add_u32 m0, s77, 101376
ds_read_b64_tr_b16 a[78:79], v8 offset:41984
v_mfma_f32_16x16x32_bf16 a[136:139], a[40:43], a[80:83], a[136:139]
s_add_u32 s64, s71, 2195456
v_mfma_f32_16x16x32_bf16 a[136:139], a[44:47], a[84:87], a[136:139]
buffer_load_dwordx4 v15, s[36:39], s64 offen lds
v_mfma_f32_16x16x32_bf16 a[140:143], a[36:39], a[84:87], a[140:143]
v_mfma_f32_16x16x32_bf16 a[140:143], a[32:35], a[80:83], a[140:143]
s_waitcnt lgkmcnt(6)
ds_read_b64_tr_b16 a[80:81], v9 offset:32768
v_mfma_f32_16x16x32_bf16 v[184:187], a[88:91], a[0:3], v[184:187]
ds_read_b64_tr_b16 a[82:83], v9 offset:33792
v_mfma_f32_16x16x32_bf16 v[184:187], a[92:95], a[4:7], v[184:187]
ds_read_b64_tr_b16 a[84:85], v9 offset:40960
v_mfma_f32_16x16x32_bf16 v[192:195], a[92:95], a[12:15], v[192:195]
ds_read_b64_tr_b16 a[86:87], v9 offset:41984
v_mfma_f32_16x16x32_bf16 v[192:195], a[88:91], a[8:11], v[192:195]
s_add_u32 m0, s77, 114688
s_add_u32 s17, s78, .-L_pc+6144
v_mfma_f32_16x16x32_bf16 v[200:203], a[88:91], a[16:19], v[200:203]
s_add_u32 s64, s71, 2097152
buffer_load_dword a252, v16, s[88:91], s17 offen
v_mfma_f32_16x16x32_bf16 v[200:203], a[92:95], a[20:23], v[200:203]
buffer_load_dwordx4 v14, s[40:43], s64 offen lds
v_mfma_f32_16x16x32_bf16 v[208:211], a[92:95], a[28:31], v[208:211]
v_mfma_f32_16x16x32_bf16 v[208:211], a[88:91], a[24:27], v[208:211]
ds_read_b64_tr_b16 a[88:89], v10 offset:32768
v_mfma_f32_16x16x32_bf16 v[212:215], a[96:99], a[24:27], v[212:215]
ds_read_b64_tr_b16 a[90:91], v10 offset:33792
v_mfma_f32_16x16x32_bf16 v[212:215], a[100:103], a[28:31], v[212:215]
ds_read_b64_tr_b16 a[92:93], v10 offset:40960
v_mfma_f32_16x16x32_bf16 v[204:207], a[100:103], a[20:23], v[204:207]
ds_read_b64_tr_b16 a[94:95], v10 offset:41984
v_mfma_f32_16x16x32_bf16 v[204:207], a[96:99], a[16:19], v[204:207]
s_add_u32 m0, s77, 115712
v_mfma_f32_16x16x32_bf16 v[196:199], a[96:99], a[8:11], v[196:199]
s_add_u32 s64, s71, 2129920
v_mfma_f32_16x16x32_bf16 v[196:199], a[100:103], a[12:15], v[196:199]
buffer_load_dwordx4 v14, s[40:43], s64 offen lds
v_mfma_f32_16x16x32_bf16 v[188:191], a[100:103], a[4:7], v[188:191]
v_mfma_f32_16x16x32_bf16 v[188:191], a[96:99], a[0:3], v[188:191]
s_add_u32 s81, s81, 1048576
ds_read_b64_tr_b16 a[96:97], v11 offset:32768
v_mfma_f32_16x16x32_bf16 v[216:219], a[104:107], a[0:3], v[216:219]
buffer_load_dword a252, v16, s[56:59], s81 offen
v_mfma_f32_16x16x32_bf16 v[216:219], a[108:111], a[4:7], v[216:219]
ds_read_b64_tr_b16 a[98:99], v11 offset:33792
v_mfma_f32_16x16x32_bf16 v[224:227], a[108:111], a[12:15], v[224:227]
ds_read_b64_tr_b16 a[100:101], v11 offset:40960
v_mfma_f32_16x16x32_bf16 v[224:227], a[104:107], a[8:11], v[224:227]
s_add_u32 m0, s77, 116736
ds_read_b64_tr_b16 a[102:103], v11 offset:41984
v_mfma_f32_16x16x32_bf16 v[232:235], a[104:107], a[16:19], v[232:235]
s_add_u32 s64, s71, 2162688
buffer_store_dword v21, v20, s[44:47], s69 offen sc1
v_mfma_f32_16x16x32_bf16 v[232:235], a[108:111], a[20:23], v[232:235]
buffer_load_dwordx4 v15, s[40:43], s64 offen lds
v_mfma_f32_16x16x32_bf16 v[240:243], a[108:111], a[28:31], v[240:243]
v_mfma_f32_16x16x32_bf16 v[240:243], a[104:107], a[24:27], v[240:243]
ds_read_b64_tr_b16 a[104:105], v4 offset:49152
v_mfma_f32_16x16x32_bf16 v[244:247], a[112:115], a[24:27], v[244:247]
s_waitcnt lgkmcnt(5)
ds_read_b64_tr_b16 a[106:107], v4 offset:50176
v_mfma_f32_16x16x32_bf16 v[244:247], a[116:119], a[28:31], v[244:247]
ds_read_b64_tr_b16 a[108:109], v4 offset:57344
v_mfma_f32_16x16x32_bf16 v[236:239], a[116:119], a[20:23], v[236:239]
ds_read_b64_tr_b16 a[110:111], v4 offset:58368
v_mfma_f32_16x16x32_bf16 v[236:239], a[112:115], a[16:19], v[236:239]
s_add_u32 m0, s77, 117760
v_mfma_f32_16x16x32_bf16 v[228:231], a[112:115], a[8:11], v[228:231]
s_add_u32 s64, s71, 2195456
v_mfma_f32_16x16x32_bf16 v[228:231], a[116:119], a[12:15], v[228:231]
buffer_load_dwordx4 v15, s[40:43], s64 offen lds
v_mfma_f32_16x16x32_bf16 v[220:223], a[116:119], a[4:7], v[220:223]
v_mfma_f32_16x16x32_bf16 v[220:223], a[112:115], a[0:3], v[220:223]
ds_read_b64_tr_b16 a[112:113], v5 offset:49152
v_mfma_f32_16x16x32_bf16 v[152:155], a[72:75], a[0:3], v[152:155]
ds_read_b64_tr_b16 a[114:115], v5 offset:50176
v_mfma_f32_16x16x32_bf16 v[152:155], a[76:79], a[4:7], v[152:155]
ds_read_b64_tr_b16 a[116:117], v5 offset:57344
v_mfma_f32_16x16x32_bf16 v[160:163], a[76:79], a[12:15], v[160:163]
ds_read_b64_tr_b16 a[118:119], v5 offset:58368
v_mfma_f32_16x16x32_bf16 v[160:163], a[72:75], a[8:11], v[160:163]
v_mfma_f32_16x16x32_bf16 v[168:171], a[72:75], a[16:19], v[168:171]
v_mfma_f32_16x16x32_bf16 v[168:171], a[76:79], a[20:23], v[168:171]
v_mfma_f32_16x16x32_bf16 v[176:179], a[76:79], a[28:31], v[176:179]
s_add_u32 m0, s76, 0
v_mfma_f32_16x16x32_bf16 v[176:179], a[72:75], a[24:27], v[176:179]
s_add_u32 s64, s70, 512
ds_read_b64_tr_b16 a[72:73], v6 offset:49152
v_mfma_f32_16x16x32_bf16 v[180:183], a[80:83], a[24:27], v[180:183]
buffer_load_dwordx4 v12, s[32:35], s64 offen lds
v_mfma_f32_16x16x32_bf16 v[180:183], a[84:87], a[28:31], v[180:183]
ds_read_b64_tr_b16 a[74:75], v6 offset:50176
v_mfma_f32_16x16x32_bf16 v[172:175], a[84:87], a[20:23], v[172:175]
ds_read_b64_tr_b16 a[76:77], v6 offset:57344
v_mfma_f32_16x16x32_bf16 v[172:175], a[80:83], a[16:19], v[172:175]
ds_read_b64_tr_b16 a[78:79], v6 offset:58368
v_mfma_f32_16x16x32_bf16 v[164:167], a[80:83], a[8:11], v[164:167]
v_mfma_f32_16x16x32_bf16 v[164:167], a[84:87], a[12:15], v[164:167]
s_add_u32 m0, s76, 1024
v_mfma_f32_16x16x32_bf16 v[156:159], a[84:87], a[4:7], v[156:159]
s_add_u32 s64, s70, 8704
v_mfma_f32_16x16x32_bf16 v[156:159], a[80:83], a[0:3], v[156:159]
buffer_load_dwordx4 v13, s[32:35], s64 offen lds
v_mfma_f32_16x16x32_bf16 v[24:27], a[88:91], a[0:3], v[24:27]
ds_read_b64_tr_b16 a[80:81], v7 offset:49152
v_mfma_f32_16x16x32_bf16 v[24:27], a[92:95], a[4:7], v[24:27]
ds_read_b64_tr_b16 a[82:83], v7 offset:50176
v_mfma_f32_16x16x32_bf16 v[40:43], a[92:95], a[12:15], v[40:43]
ds_read_b64_tr_b16 a[84:85], v7 offset:57344
v_mfma_f32_16x16x32_bf16 v[40:43], a[88:91], a[8:11], v[40:43]
s_add_u32 s82, s82, 1048576
ds_read_b64_tr_b16 a[86:87], v7 offset:58368
v_mfma_f32_16x16x32_bf16 v[56:59], a[88:91], a[16:19], v[56:59]
s_add_u32 m0, s76, 2048
buffer_load_dword a252, v1, s[60:63], s82 offen
v_mfma_f32_16x16x32_bf16 v[56:59], a[92:95], a[20:23], v[56:59]
s_add_u32 s64, s70, 16896
v_mfma_f32_16x16x32_bf16 v[72:75], a[92:95], a[28:31], v[72:75]
s_waitcnt vmcnt(16)
buffer_load_dwordx4 v12, s[32:35], s64 offen lds
v_mfma_f32_16x16x32_bf16 v[72:75], a[88:91], a[24:27], v[72:75]
s_waitcnt lgkmcnt(4)
ds_read_b64_tr_b16 a[88:89], v8 offset:49152
v_mfma_f32_16x16x32_bf16 v[136:139], a[96:99], a[24:27], v[136:139]
ds_read_b64_tr_b16 a[90:91], v8 offset:50176
v_mfma_f32_16x16x32_bf16 v[136:139], a[100:103], a[28:31], v[136:139]
ds_read_b64_tr_b16 a[92:93], v8 offset:57344
v_subrev_u32 v4, 0x8000, v4
v_mfma_f32_16x16x32_bf16 v[120:123], a[100:103], a[20:23], v[120:123]
ds_read_b64_tr_b16 a[94:95], v8 offset:58368
v_mfma_f32_16x16x32_bf16 v[120:123], a[96:99], a[16:19], v[120:123]
s_add_u32 m0, s76, 3072
ds_read_b128 a[32:35], v2 offset:32768
v_mfma_f32_16x16x32_bf16 v[104:107], a[96:99], a[8:11], v[104:107]
s_add_u32 s64, s70, 25088
ds_read_b128 a[36:39], v3 offset:32768
v_mfma_f32_16x16x32_bf16 v[104:107], a[100:103], a[12:15], v[104:107]
buffer_load_dwordx4 v13, s[32:35], s64 offen lds
v_mfma_f32_16x16x32_bf16 v[88:91], a[100:103], a[4:7], v[88:91]
ds_read_b128 a[40:43], v2 offset:34816
v_mfma_f32_16x16x32_bf16 v[88:91], a[96:99], a[0:3], v[88:91]
ds_read_b128 a[44:47], v3 offset:34816
v_mfma_f32_16x16x32_bf16 v[28:31], a[0:3], a[104:107], v[28:31]
ds_read_b128 a[48:51], v2 offset:36864
v_mfma_f32_16x16x32_bf16 v[28:31], a[4:7], a[108:111], v[28:31]
ds_read_b128 a[52:55], v3 offset:36864
v_subrev_u32 v5, 0x8000, v5
v_mfma_f32_16x16x32_bf16 v[44:47], a[12:15], a[108:111], v[44:47]
s_add_u32 m0, s76, 4096
ds_read_b128 a[56:59], v2 offset:38912
v_mfma_f32_16x16x32_bf16 v[44:47], a[8:11], a[104:107], v[44:47]
s_add_u32 s64, s70, 33280
ds_read_b128 a[60:63], v3 offset:38912
v_mfma_f32_16x16x32_bf16 v[60:63], a[16:19], a[104:107], v[60:63]
buffer_load_dwordx4 v12, s[32:35], s64 offen lds
v_mfma_f32_16x16x32_bf16 v[60:63], a[20:23], a[108:111], v[60:63]
ds_read_b64_tr_b16 a[96:97], v9 offset:49152
v_mfma_f32_16x16x32_bf16 v[76:79], a[28:31], a[108:111], v[76:79]
ds_read_b64_tr_b16 a[98:99], v9 offset:50176
v_mfma_f32_16x16x32_bf16 v[76:79], a[24:27], a[104:107], v[76:79]
ds_read_b64_tr_b16 a[100:101], v9 offset:57344
v_mfma_f32_16x16x32_bf16 v[140:143], a[24:27], a[112:115], v[140:143]
ds_read_b64_tr_b16 a[102:103], v9 offset:58368
v_mfma_f32_16x16x32_bf16 v[140:143], a[28:31], a[116:119], v[140:143]
s_add_u32 m0, s76, 5120
ds_read_b64_tr_b16 a[104:105], v10 offset:49152
v_subrev_u32 v6, 0x8000, v6
v_mfma_f32_16x16x32_bf16 v[124:127], a[20:23], a[116:119], v[124:127]
s_add_u32 s64, s70, 41472
ds_read_b64_tr_b16 a[106:107], v10 offset:50176
v_mfma_f32_16x16x32_bf16 v[124:127], a[16:19], a[112:115], v[124:127]
buffer_load_dwordx4 v13, s[32:35], s64 offen lds
v_mfma_f32_16x16x32_bf16 v[108:111], a[8:11], a[112:115], v[108:111]
ds_read_b64_tr_b16 a[108:109], v10 offset:57344
v_mfma_f32_16x16x32_bf16 v[108:111], a[12:15], a[116:119], v[108:111]
ds_read_b64_tr_b16 a[110:111], v10 offset:58368
v_mfma_f32_16x16x32_bf16 v[92:95], a[4:7], a[116:119], v[92:95]
v_mfma_f32_16x16x32_bf16 v[92:95], a[0:3], a[112:115], v[92:95]
ds_read_b64_tr_b16 a[112:113], v11 offset:49152
v_mfma_f32_16x16x32_bf16 v[32:35], a[0:3], a[72:75], v[32:35]
s_add_u32 m0, s76, 6144
ds_read_b64_tr_b16 a[114:115], v11 offset:50176
v_mfma_f32_16x16x32_bf16 v[32:35], a[4:7], a[76:79], v[32:35]
s_add_u32 s64, s70, 49664
ds_read_b64_tr_b16 a[116:117], v11 offset:57344
v_subrev_u32 v7, 0x8000, v7
v_mfma_f32_16x16x32_bf16 v[48:51], a[12:15], a[76:79], v[48:51]
buffer_load_dwordx4 v12, s[32:35], s64 offen lds
v_mfma_f32_16x16x32_bf16 v[48:51], a[8:11], a[72:75], v[48:51]
ds_read_b64_tr_b16 a[118:119], v11 offset:58368
v_mfma_f32_16x16x32_bf16 v[64:67], a[16:19], a[72:75], v[64:67]
v_mfma_f32_16x16x32_bf16 v[64:67], a[20:23], a[76:79], v[64:67]
v_mfma_f32_16x16x32_bf16 v[80:83], a[28:31], a[76:79], v[80:83]
v_mfma_f32_16x16x32_bf16 v[80:83], a[24:27], a[72:75], v[80:83]
s_waitcnt lgkmcnt(4)
s_add_u32 m0, s76, 7168
s_add_u32 s81, s81, 1048576
v_mfma_f32_16x16x32_bf16 v[144:147], a[24:27], a[80:83], v[144:147]
s_add_u32 s64, s70, 57856
buffer_load_dword a252, v16, s[56:59], s81 offen
v_mfma_f32_16x16x32_bf16 v[144:147], a[28:31], a[84:87], v[144:147]
buffer_load_dwordx4 v13, s[32:35], s64 offen lds
v_mfma_f32_16x16x32_bf16 v[128:131], a[20:23], a[84:87], v[128:131]
v_subrev_u32 v8, 0x8000, v8
v_mfma_f32_16x16x32_bf16 v[128:131], a[16:19], a[80:83], v[128:131]
v_mfma_f32_16x16x32_bf16 v[112:115], a[8:11], a[80:83], v[112:115]
v_mfma_f32_16x16x32_bf16 v[112:115], a[12:15], a[84:87], v[112:115]
v_mfma_f32_16x16x32_bf16 v[96:99], a[4:7], a[84:87], v[96:99]
v_subrev_u32 v9, 0x8000, v9
v_subrev_u32 v10, 0x8000, v10
v_mfma_f32_16x16x32_bf16 v[96:99], a[0:3], a[80:83], v[96:99]
v_subrev_u32 v11, 0x8000, v11
v_mfma_f32_16x16x32_bf16 v[36:39], a[0:3], a[88:91], v[36:39]
v_mfma_f32_16x16x32_bf16 v[36:39], a[4:7], a[92:95], v[36:39]
v_mfma_f32_16x16x32_bf16 v[52:55], a[12:15], a[92:95], v[52:55]
s_waitcnt lgkmcnt(0)
s_barrier
v_mfma_f32_16x16x32_bf16 v[52:55], a[8:11], a[88:91], v[52:55]
s_add_u32 m0, s77, 131072
ds_read_b64_tr_b16 a[72:73], v4 offset:0
v_mfma_f32_16x16x32_bf16 v[68:71], a[16:19], a[88:91], v[68:71]
s_add_u32 s64, s71, 2621440
ds_read_b64_tr_b16 a[74:75], v4 offset:1024
v_mfma_f32_16x16x32_bf16 v[68:71], a[20:23], a[92:95], v[68:71]
buffer_load_dwordx4 v14, s[36:39], s64 offen lds
v_mfma_f32_16x16x32_bf16 v[84:87], a[28:31], a[92:95], v[84:87]
ds_read_b64_tr_b16 a[76:77], v4 offset:8192
v_mfma_f32_16x16x32_bf16 v[84:87], a[24:27], a[88:91], v[84:87]
ds_read_b64_tr_b16 a[78:79], v4 offset:9216
v_mfma_f32_16x16x32_bf16 v[148:151], a[24:27], a[96:99], v[148:151]
ds_read_b64_tr_b16 a[80:81], v5 offset:0
v_mfma_f32_16x16x32_bf16 v[148:151], a[28:31], a[100:103], v[148:151]
ds_read_b64_tr_b16 a[82:83], v5 offset:1024
v_mfma_f32_16x16x32_bf16 v[132:135], a[20:23], a[100:103], v[132:135]
ds_read_b64_tr_b16 a[84:85], v5 offset:8192
v_mfma_f32_16x16x32_bf16 v[132:135], a[16:19], a[96:99], v[132:135]
s_add_u32 m0, s77, 132096
ds_read_b64_tr_b16 a[86:87], v5 offset:9216
v_mfma_f32_16x16x32_bf16 v[116:119], a[8:11], a[96:99], v[116:119]
s_add_u32 s64, s71, 2654208
ds_read_b64_tr_b16 a[88:89], v6 offset:0
v_mfma_f32_16x16x32_bf16 v[116:119], a[12:15], a[100:103], v[116:119]
buffer_load_dwordx4 v14, s[36:39], s64 offen lds
v_mfma_f32_16x16x32_bf16 v[100:103], a[4:7], a[100:103], v[100:103]
ds_read_b64_tr_b16 a[90:91], v6 offset:1024
v_mfma_f32_16x16x32_bf16 v[100:103], a[0:3], a[96:99], v[100:103]
ds_read_b64_tr_b16 a[92:93], v6 offset:8192
v_mfma_f32_16x16x32_bf16 v[248:251], a[0:3], a[104:107], v[248:251]
ds_read_b64_tr_b16 a[94:95], v6 offset:9216
v_mfma_f32_16x16x32_bf16 v[248:251], a[4:7], a[108:111], v[248:251]
ds_read_b64_tr_b16 a[96:97], v7 offset:0
v_mfma_f32_16x16x32_bf16 v[252:255], a[12:15], a[108:111], v[252:255]
ds_read_b64_tr_b16 a[98:99], v7 offset:1024
v_mfma_f32_16x16x32_bf16 v[252:255], a[8:11], a[104:107], v[252:255]
s_add_u32 m0, s77, 133120
ds_read_b64_tr_b16 a[100:101], v7 offset:8192
v_mfma_f32_16x16x32_bf16 a[120:123], a[16:19], a[104:107], a[120:123]
s_add_u32 s64, s71, 2686976
ds_read_b64_tr_b16 a[102:103], v7 offset:9216
v_mfma_f32_16x16x32_bf16 a[120:123], a[20:23], a[108:111], a[120:123]
buffer_load_dwordx4 v15, s[36:39], s64 offen lds
v_mfma_f32_16x16x32_bf16 a[124:127], a[28:31], a[108:111], a[124:127]
v_mfma_f32_16x16x32_bf16 a[124:127], a[24:27], a[104:107], a[124:127]
ds_read_b64_tr_b16 a[104:105], v8 offset:0
v_mfma_f32_16x16x32_bf16 a[128:131], a[24:27], a[112:115], a[128:131]
ds_read_b64_tr_b16 a[106:107], v8 offset:1024
v_mfma_f32_16x16x32_bf16 a[128:131], a[28:31], a[116:119], a[128:131]
ds_read_b64_tr_b16 a[108:109], v8 offset:8192
v_mfma_f32_16x16x32_bf16 a[132:135], a[20:23], a[116:119], a[132:135]
ds_read_b64_tr_b16 a[110:111], v8 offset:9216
v_mfma_f32_16x16x32_bf16 a[132:135], a[16:19], a[112:115], a[132:135]
s_add_u32 m0, s77, 134144
s_add_u32 s81, s81, 1048576
v_mfma_f32_16x16x32_bf16 a[136:139], a[8:11], a[112:115], a[136:139]
s_add_u32 s64, s71, 2719744
buffer_load_dword a252, v16, s[56:59], s81 offen
v_mfma_f32_16x16x32_bf16 a[136:139], a[12:15], a[116:119], a[136:139]
buffer_load_dwordx4 v15, s[36:39], s64 offen lds
v_mfma_f32_16x16x32_bf16 a[140:143], a[4:7], a[116:119], a[140:143]
v_mfma_f32_16x16x32_bf16 a[140:143], a[0:3], a[112:115], a[140:143]
s_waitcnt lgkmcnt(4)
ds_read_b64_tr_b16 a[112:113], v9 offset:0
v_mfma_f32_16x16x32_bf16 v[184:187], a[72:75], a[32:35], v[184:187]
ds_read_b64_tr_b16 a[114:115], v9 offset:1024
v_mov_b32 v17, 0
v_mfma_f32_16x16x32_bf16 v[184:187], a[76:79], a[36:39], v[184:187]
ds_read_b64_tr_b16 a[116:117], v9 offset:8192
v_accvgpr_read_b32 v19, a144
v_mfma_f32_16x16x32_bf16 v[192:195], a[76:79], a[44:47], v[192:195]
ds_read_b64_tr_b16 a[118:119], v9 offset:9216
v_accvgpr_read_b32 v21, a160
v_mfma_f32_16x16x32_bf16 v[192:195], a[72:75], a[40:43], v[192:195]
s_add_u32 m0, s77, 147456
v_lshlrev_b32 v18, 16, v19
v_and_b32 v19, 0xffff0000, v19
v_mfma_f32_16x16x32_bf16 v[200:203], a[72:75], a[48:51], v[200:203]
s_add_u32 s64, s71, 2621440
v_lshlrev_b32 v20, 16, v21
v_and_b32 v21, 0xffff0000, v21
v_mfma_f32_16x16x32_bf16 v[200:203], a[76:79], a[52:55], v[200:203]
buffer_load_dwordx4 v14, s[40:43], s64 offen lds
v_mfma_f32_16x16x32_bf16 v[208:211], a[76:79], a[60:63], v[208:211]
v_mul_f32 v18, v18, v20
v_mul_f32 v19, v19, v21
v_mfma_f32_16x16x32_bf16 v[208:211], a[72:75], a[56:59], v[208:211]
ds_read_b64_tr_b16 a[72:73], v10 offset:0
v_cvt_pk_bf16_f32 v18, v18, v19
v_mfma_f32_16x16x32_bf16 v[212:215], a[80:83], a[56:59], v[212:215]
ds_read_b64_tr_b16 a[74:75], v10 offset:1024
v_lshlrev_b32 v19, 16, v18
v_mfma_f32_16x16x32_bf16 v[212:215], a[84:87], a[60:63], v[212:215]
ds_read_b64_tr_b16 a[76:77], v10 offset:8192
v_and_b32 v18, 0xffff0000, v18
v_mfma_f32_16x16x32_bf16 v[204:207], a[84:87], a[52:55], v[204:207]
ds_read_b64_tr_b16 a[78:79], v10 offset:9216
v_add_f32 v17, v17, v19
v_mfma_f32_16x16x32_bf16 v[204:207], a[80:83], a[48:51], v[204:207]
s_add_u32 m0, s77, 148480
v_add_f32 v17, v17, v18
v_accvgpr_read_b32 v19, a145
v_mfma_f32_16x16x32_bf16 v[196:199], a[80:83], a[40:43], v[196:199]
s_add_u32 s64, s71, 2654208
v_accvgpr_read_b32 v21, a161
v_lshlrev_b32 v18, 16, v19
v_mfma_f32_16x16x32_bf16 v[196:199], a[84:87], a[44:47], v[196:199]
buffer_load_dwordx4 v14, s[40:43], s64 offen lds
v_mfma_f32_16x16x32_bf16 v[188:191], a[84:87], a[36:39], v[188:191]
v_and_b32 v19, 0xffff0000, v19
v_lshlrev_b32 v20, 16, v21
v_mfma_f32_16x16x32_bf16 v[188:191], a[80:83], a[32:35], v[188:191]
ds_read_b64_tr_b16 a[80:81], v11 offset:0
v_and_b32 v21, 0xffff0000, v21
v_mfma_f32_16x16x32_bf16 v[216:219], a[88:91], a[32:35], v[216:219]
ds_read_b64_tr_b16 a[82:83], v11 offset:1024
v_mul_f32 v18, v18, v20
v_mfma_f32_16x16x32_bf16 v[216:219], a[92:95], a[36:39], v[216:219]
ds_read_b64_tr_b16 a[84:85], v11 offset:8192
v_mul_f32 v19, v19, v21
v_mfma_f32_16x16x32_bf16 v[224:227], a[92:95], a[44:47], v[224:227]
ds_read_b64_tr_b16 a[86:87], v11 offset:9216
v_cvt_pk_bf16_f32 v18, v18, v19
v_mfma_f32_16x16x32_bf16 v[224:227], a[88:91], a[40:43], v[224:227]
s_add_u32 m0, s77, 149504
v_lshlrev_b32 v19, 16, v18
v_and_b32 v18, 0xffff0000, v18
v_mfma_f32_16x16x32_bf16 v[232:235], a[88:91], a[48:51], v[232:235]
s_add_u32 s64, s71, 2686976
v_add_f32 v17, v17, v19
v_add_f32 v17, v17, v18
v_mfma_f32_16x16x32_bf16 v[232:235], a[92:95], a[52:55], v[232:235]
buffer_load_dwordx4 v15, s[40:43], s64 offen lds
v_mfma_f32_16x16x32_bf16 v[240:243], a[92:95], a[60:63], v[240:243]
v_accvgpr_read_b32 v19, a146
v_accvgpr_read_b32 v21, a162
v_mfma_f32_16x16x32_bf16 v[240:243], a[88:91], a[56:59], v[240:243]
ds_read_b64_tr_b16 a[88:89], v4 offset:16384
v_lshlrev_b32 v18, 16, v19
v_mfma_f32_16x16x32_bf16 v[244:247], a[96:99], a[56:59], v[244:247]
ds_read_b64_tr_b16 a[90:91], v4 offset:17408
v_and_b32 v19, 0xffff0000, v19
v_mfma_f32_16x16x32_bf16 v[244:247], a[100:103], a[60:63], v[244:247]
ds_read_b64_tr_b16 a[92:93], v4 offset:24576
v_lshlrev_b32 v20, 16, v21
v_mfma_f32_16x16x32_bf16 v[236:239], a[100:103], a[52:55], v[236:239]
ds_read_b64_tr_b16 a[94:95], v4 offset:25600
v_and_b32 v21, 0xffff0000, v21
v_mfma_f32_16x16x32_bf16 v[236:239], a[96:99], a[48:51], v[236:239]
s_add_u32 m0, s77, 150528
v_mul_f32 v18, v18, v20
v_mul_f32 v19, v19, v21
v_mfma_f32_16x16x32_bf16 v[228:231], a[96:99], a[40:43], v[228:231]
s_add_u32 s64, s71, 2719744
v_cvt_pk_bf16_f32 v18, v18, v19
v_lshlrev_b32 v19, 16, v18
v_mfma_f32_16x16x32_bf16 v[228:231], a[100:103], a[44:47], v[228:231]
buffer_load_dwordx4 v15, s[40:43], s64 offen lds
v_mfma_f32_16x16x32_bf16 v[220:223], a[100:103], a[36:39], v[220:223]
v_and_b32 v18, 0xffff0000, v18
v_add_f32 v17, v17, v19
v_mfma_f32_16x16x32_bf16 v[220:223], a[96:99], a[32:35], v[220:223]
s_waitcnt lgkmcnt(4)
s_add_u32 s82, s82, 1048576
ds_read_b64_tr_b16 a[96:97], v5 offset:16384
v_add_f32 v17, v17, v18
v_mfma_f32_16x16x32_bf16 v[152:155], a[104:107], a[32:35], v[152:155]
buffer_load_dword a252, v1, s[60:63], s82 offen
v_mfma_f32_16x16x32_bf16 v[152:155], a[108:111], a[36:39], v[152:155]
ds_read_b64_tr_b16 a[98:99], v5 offset:17408
v_accvgpr_read_b32 v19, a147
v_mfma_f32_16x16x32_bf16 v[160:163], a[108:111], a[44:47], v[160:163]
ds_read_b64_tr_b16 a[100:101], v5 offset:24576
v_accvgpr_read_b32 v21, a163
v_mfma_f32_16x16x32_bf16 v[160:163], a[104:107], a[40:43], v[160:163]
ds_read_b64_tr_b16 a[102:103], v5 offset:25600
v_lshlrev_b32 v18, 16, v19
v_mfma_f32_16x16x32_bf16 v[168:171], a[104:107], a[48:51], v[168:171]
v_and_b32 v19, 0xffff0000, v19
v_lshlrev_b32 v20, 16, v21
v_mfma_f32_16x16x32_bf16 v[168:171], a[108:111], a[52:55], v[168:171]
v_and_b32 v21, 0xffff0000, v21
v_mul_f32 v18, v18, v20
v_mfma_f32_16x16x32_bf16 v[176:179], a[108:111], a[60:63], v[176:179]
s_add_u32 m0, s76, 32768
v_mul_f32 v19, v19, v21
v_cvt_pk_bf16_f32 v18, v18, v19
v_mfma_f32_16x16x32_bf16 v[176:179], a[104:107], a[56:59], v[176:179]
s_add_u32 s64, s70, 640
ds_read_b64_tr_b16 a[104:105], v6 offset:16384
v_lshlrev_b32 v19, 16, v18
v_mfma_f32_16x16x32_bf16 v[180:183], a[112:115], a[56:59], v[180:183]
buffer_load_dwordx4 v12, s[32:35], s64 offen lds
v_mfma_f32_16x16x32_bf16 v[180:183], a[116:119], a[60:63], v[180:183]
ds_read_b64_tr_b16 a[106:107], v6 offset:17408
v_and_b32 v18, 0xffff0000, v18
v_mfma_f32_16x16x32_bf16 v[172:175], a[116:119], a[52:55], v[172:175]
ds_read_b64_tr_b16 a[108:109], v6 offset:24576
v_add_f32 v17, v17, v19
v_mfma_f32_16x16x32_bf16 v[172:175], a[112:115], a[48:51], v[172:175]
ds_read_b64_tr_b16 a[110:111], v6 offset:25600
v_add_f32 v17, v17, v18
v_mfma_f32_16x16x32_bf16 v[164:167], a[112:115], a[40:43], v[164:167]
v_accvgpr_read_b32 v19, a148
v_accvgpr_read_b32 v21, a164
v_mfma_f32_16x16x32_bf16 v[164:167], a[116:119], a[44:47], v[164:167]
s_add_u32 m0, s76, 33792
v_lshlrev_b32 v18, 16, v19
v_and_b32 v19, 0xffff0000, v19
v_mfma_f32_16x16x32_bf16 v[156:159], a[116:119], a[36:39], v[156:159]
s_add_u32 s64, s70, 8832
v_lshlrev_b32 v20, 16, v21
v_and_b32 v21, 0xffff0000, v21
v_mfma_f32_16x16x32_bf16 v[156:159], a[112:115], a[32:35], v[156:159]
buffer_load_dwordx4 v13, s[32:35], s64 offen lds
v_mfma_f32_16x16x32_bf16 v[24:27], a[72:75], a[32:35], v[24:27]
ds_read_b64_tr_b16 a[112:113], v7 offset:16384
v_mul_f32 v18, v18, v20
v_mfma_f32_16x16x32_bf16 v[24:27], a[76:79], a[36:39], v[24:27]
ds_read_b64_tr_b16 a[114:115], v7 offset:17408
v_mul_f32 v19, v19, v21
v_mfma_f32_16x16x32_bf16 v[40:43], a[76:79], a[44:47], v[40:43]
ds_read_b64_tr_b16 a[116:117], v7 offset:24576
v_cvt_pk_bf16_f32 v18, v18, v19
v_mfma_f32_16x16x32_bf16 v[40:43], a[72:75], a[40:43], v[40:43]
ds_read_b64_tr_b16 a[118:119], v7 offset:25600
v_lshlrev_b32 v19, 16, v18
v_mfma_f32_16x16x32_bf16 v[56:59], a[72:75], a[48:51], v[56:59]
s_add_u32 m0, s76, 34816
v_and_b32 v18, 0xffff0000, v18
v_add_f32 v17, v17, v19
v_mfma_f32_16x16x32_bf16 v[56:59], a[76:79], a[52:55], v[56:59]
s_add_u32 s64, s70, 17024
v_add_f32 v17, v17, v18
v_accvgpr_read_b32 v19, a149
v_mfma_f32_16x16x32_bf16 v[72:75], a[76:79], a[60:63], v[72:75]
s_waitcnt vmcnt(12)
buffer_load_dwordx4 v12, s[32:35], s64 offen lds
v_mfma_f32_16x16x32_bf16 v[72:75], a[72:75], a[56:59], v[72:75]
ds_read_b64_tr_b16 a[72:73], v8 offset:16384
v_accvgpr_read_b32 v21, a165
v_mfma_f32_16x16x32_bf16 v[136:139], a[80:83], a[56:59], v[136:139]
ds_read_b64_tr_b16 a[74:75], v8 offset:17408
v_lshlrev_b32 v18, 16, v19
v_mfma_f32_16x16x32_bf16 v[136:139], a[84:87], a[60:63], v[136:139]
ds_read_b64_tr_b16 a[76:77], v8 offset:24576
v_and_b32 v19, 0xffff0000, v19
v_mfma_f32_16x16x32_bf16 v[120:123], a[84:87], a[52:55], v[120:123]
ds_read_b64_tr_b16 a[78:79], v8 offset:25600
v_lshlrev_b32 v20, 16, v21
v_mfma_f32_16x16x32_bf16 v[120:123], a[80:83], a[48:51], v[120:123]
s_add_u32 m0, s76, 35840
ds_read_b128 a[0:3], v2 offset:0
v_and_b32 v21, 0xffff0000, v21
v_mfma_f32_16x16x32_bf16 v[104:107], a[80:83], a[40:43], v[104:107]
s_add_u32 s64, s70, 25216
ds_read_b128 a[4:7], v3 offset:0
v_mul_f32 v18, v18, v20
v_mfma_f32_16x16x32_bf16 v[104:107], a[84:87], a[44:47], v[104:107]
buffer_load_dwordx4 v13, s[32:35], s64 offen lds
v_mfma_f32_16x16x32_bf16 v[88:91], a[84:87], a[36:39], v[88:91]
ds_read_b128 a[8:11], v2 offset:2048
v_mul_f32 v19, v19, v21
v_mfma_f32_16x16x32_bf16 v[88:91], a[80:83], a[32:35], v[88:91]
s_waitcnt lgkmcnt(7)
ds_read_b128 a[12:15], v3 offset:2048
v_cvt_pk_bf16_f32 v18, v18, v19
v_mfma_f32_16x16x32_bf16 v[28:31], a[32:35], a[88:91], v[28:31]
ds_read_b128 a[16:19], v2 offset:4096
v_lshlrev_b32 v19, 16, v18
v_mfma_f32_16x16x32_bf16 v[28:31], a[36:39], a[92:95], v[28:31]
ds_read_b128 a[20:23], v3 offset:4096
v_and_b32 v18, 0xffff0000, v18
v_mfma_f32_16x16x32_bf16 v[44:47], a[44:47], a[92:95], v[44:47]
s_add_u32 m0, s76, 36864
ds_read_b128 a[24:27], v2 offset:6144
v_add_f32 v17, v17, v19
v_mfma_f32_16x16x32_bf16 v[44:47], a[40:43], a[88:91], v[44:47]
s_add_u32 s64, s70, 33408
ds_read_b128 a[28:31], v3 offset:6144
v_add_f32 v17, v17, v18
v_mfma_f32_16x16x32_bf16 v[60:63], a[48:51], a[88:91], v[60:63]
s_add_u32 s81, s81, 1048576
buffer_load_dwordx4 v12, s[32:35], s64 offen lds
v_mfma_f32_16x16x32_bf16 v[60:63], a[52:55], a[92:95], v[60:63]
buffer_load_dword a252, v16, s[56:59], s81 offen
v_mfma_f32_16x16x32_bf16 v[76:79], a[60:63], a[92:95], v[76:79]
ds_read_b64_tr_b16 a[80:81], v9 offset:16384
v_accvgpr_read_b32 v19, a150
v_mfma_f32_16x16x32_bf16 v[76:79], a[56:59], a[88:91], v[76:79]
ds_read_b64_tr_b16 a[82:83], v9 offset:17408
v_accvgpr_read_b32 v21, a166
v_mfma_f32_16x16x32_bf16 v[140:143], a[56:59], a[96:99], v[140:143]
ds_read_b64_tr_b16 a[84:85], v9 offset:24576
v_lshlrev_b32 v18, 16, v19
v_mfma_f32_16x16x32_bf16 v[140:143], a[60:63], a[100:103], v[140:143]
s_add_u32 m0, s76, 37888
ds_read_b64_tr_b16 a[86:87], v9 offset:25600
v_and_b32 v19, 0xffff0000, v19
v_mfma_f32_16x16x32_bf16 v[124:127], a[52:55], a[100:103], v[124:127]
s_add_u32 s64, s70, 41600
ds_read_b64_tr_b16 a[88:89], v10 offset:16384
v_lshlrev_b32 v20, 16, v21
v_mfma_f32_16x16x32_bf16 v[124:127], a[48:51], a[96:99], v[124:127]
buffer_load_dwordx4 v13, s[32:35], s64 offen lds
v_mfma_f32_16x16x32_bf16 v[108:111], a[40:43], a[96:99], v[108:111]
ds_read_b64_tr_b16 a[90:91], v10 offset:17408
v_and_b32 v21, 0xffff0000, v21
v_mfma_f32_16x16x32_bf16 v[108:111], a[44:47], a[100:103], v[108:111]
ds_read_b64_tr_b16 a[92:93], v10 offset:24576
v_mul_f32 v18, v18, v20
v_mfma_f32_16x16x32_bf16 v[92:95], a[36:39], a[100:103], v[92:95]
ds_read_b64_tr_b16 a[94:95], v10 offset:25600
v_mul_f32 v19, v19, v21
v_mfma_f32_16x16x32_bf16 v[92:95], a[32:35], a[96:99], v[92:95]
ds_read_b64_tr_b16 a[96:97], v11 offset:16384
v_cvt_pk_bf16_f32 v18, v18, v19
v_mfma_f32_16x16x32_bf16 v[32:35], a[32:35], a[104:107], v[32:35]
s_add_u32 m0, s76, 38912
ds_read_b64_tr_b16 a[98:99], v11 offset:17408
v_lshlrev_b32 v19, 16, v18
v_mfma_f32_16x16x32_bf16 v[32:35], a[36:39], a[108:111], v[32:35]
s_add_u32 s64, s70, 49792
ds_read_b64_tr_b16 a[100:101], v11 offset:24576
v_and_b32 v18, 0xffff0000, v18
v_mfma_f32_16x16x32_bf16 v[48:51], a[44:47], a[108:111], v[48:51]
buffer_load_dwordx4 v12, s[32:35], s64 offen lds
v_mfma_f32_16x16x32_bf16 v[48:51], a[40:43], a[104:107], v[48:51]
ds_read_b64_tr_b16 a[102:103], v11 offset:25600
v_add_f32 v17, v17, v19
v_mfma_f32_16x16x32_bf16 v[64:67], a[48:51], a[104:107], v[64:67]
v_add_f32 v17, v17, v18
v_accvgpr_read_b32 v19, a151
v_mfma_f32_16x16x32_bf16 v[64:67], a[52:55], a[108:111], v[64:67]
v_accvgpr_read_b32 v21, a167
v_lshlrev_b32 v18, 16, v19
v_mfma_f32_16x16x32_bf16 v[80:83], a[60:63], a[108:111], v[80:83]
v_and_b32 v19, 0xffff0000, v19
v_lshlrev_b32 v20, 16, v21
v_mfma_f32_16x16x32_bf16 v[80:83], a[56:59], a[104:107], v[80:83]
s_add_u32 m0, s76, 39936
v_and_b32 v21, 0xffff0000, v21
v_mul_f32 v18, v18, v20
v_mfma_f32_16x16x32_bf16 v[144:147], a[56:59], a[112:115], v[144:147]
s_add_u32 s64, s70, 57984
v_mul_f32 v19, v19, v21
v_cvt_pk_bf16_f32 v18, v18, v19
v_mfma_f32_16x16x32_bf16 v[144:147], a[60:63], a[116:119], v[144:147]
buffer_load_dwordx4 v13, s[32:35], s64 offen lds
v_mfma_f32_16x16x32_bf16 v[128:131], a[52:55], a[116:119], v[128:131]
v_lshlrev_b32 v19, 16, v18
v_and_b32 v18, 0xffff0000, v18
v_mfma_f32_16x16x32_bf16 v[128:131], a[48:51], a[112:115], v[128:131]
v_add_f32 v17, v17, v19
v_add_f32 v17, v17, v18
v_mfma_f32_16x16x32_bf16 v[112:115], a[40:43], a[112:115], v[112:115]
v_accvgpr_read_b32 v19, a152
v_accvgpr_read_b32 v21, a168
v_mfma_f32_16x16x32_bf16 v[112:115], a[44:47], a[116:119], v[112:115]
v_lshlrev_b32 v18, 16, v19
v_and_b32 v19, 0xffff0000, v19
v_mfma_f32_16x16x32_bf16 v[96:99], a[36:39], a[116:119], v[96:99]
v_lshlrev_b32 v20, 16, v21
v_and_b32 v21, 0xffff0000, v21
v_mfma_f32_16x16x32_bf16 v[96:99], a[32:35], a[112:115], v[96:99]
s_waitcnt lgkmcnt(0)
v_mul_f32 v18, v18, v20
v_mul_f32 v19, v19, v21
v_mfma_f32_16x16x32_bf16 v[36:39], a[32:35], a[72:75], v[36:39]
v_cvt_pk_bf16_f32 v18, v18, v19
v_lshlrev_b32 v19, 16, v18
v_mfma_f32_16x16x32_bf16 v[36:39], a[36:39], a[76:79], v[36:39]
v_and_b32 v18, 0xffff0000, v18
v_add_f32 v17, v17, v19
v_mfma_f32_16x16x32_bf16 v[52:55], a[44:47], a[76:79], v[52:55]
s_waitcnt lgkmcnt(0)
s_barrier
v_mfma_f32_16x16x32_bf16 v[52:55], a[40:43], a[72:75], v[52:55]
s_add_u32 m0, s77, 65536
ds_read_b64_tr_b16 a[104:105], v4 offset:32768
v_add_f32 v17, v17, v18
v_mfma_f32_16x16x32_bf16 v[68:71], a[48:51], a[72:75], v[68:71]
s_add_u32 s64, s71, 3145728
ds_read_b64_tr_b16 a[106:107], v4 offset:33792
v_accvgpr_read_b32 v19, a153
v_mfma_f32_16x16x32_bf16 v[68:71], a[52:55], a[76:79], v[68:71]
buffer_load_dwordx4 v14, s[36:39], s64 offen lds
v_mfma_f32_16x16x32_bf16 v[84:87], a[60:63], a[76:79], v[84:87]
ds_read_b64_tr_b16 a[108:109], v4 offset:40960
v_accvgpr_read_b32 v21, a169
v_mfma_f32_16x16x32_bf16 v[84:87], a[56:59], a[72:75], v[84:87]
s_add_u32 s82, s82, 1048576
ds_read_b64_tr_b16 a[110:111], v4 offset:41984
v_lshlrev_b32 v18, 16, v19
v_mfma_f32_16x16x32_bf16 v[148:151], a[56:59], a[80:83], v[148:151]
buffer_load_dword a252, v1, s[60:63], s82 offen
v_mfma_f32_16x16x32_bf16 v[148:151], a[60:63], a[84:87], v[148:151]
ds_read_b64_tr_b16 a[112:113], v5 offset:32768
v_and_b32 v19, 0xffff0000, v19
v_mfma_f32_16x16x32_bf16 v[132:135], a[52:55], a[84:87], v[132:135]
ds_read_b64_tr_b16 a[114:115], v5 offset:33792
v_lshlrev_b32 v20, 16, v21
v_mfma_f32_16x16x32_bf16 v[132:135], a[48:51], a[80:83], v[132:135]
s_add_u32 m0, s77, 66560
ds_read_b64_tr_b16 a[116:117], v5 offset:40960
v_and_b32 v21, 0xffff0000, v21
v_mfma_f32_16x16x32_bf16 v[116:119], a[40:43], a[80:83], v[116:119]
s_add_u32 s64, s71, 3178496
ds_read_b64_tr_b16 a[118:119], v5 offset:41984
v_mul_f32 v18, v18, v20
v_mfma_f32_16x16x32_bf16 v[116:119], a[44:47], a[84:87], v[116:119]
buffer_load_dwordx4 v14, s[36:39], s64 offen lds
v_mfma_f32_16x16x32_bf16 v[100:103], a[36:39], a[84:87], v[100:103]
ds_read_b64_tr_b16 a[72:73], v6 offset:32768
v_mul_f32 v19, v19, v21
v_mfma_f32_16x16x32_bf16 v[100:103], a[32:35], a[80:83], v[100:103]
ds_read_b64_tr_b16 a[74:75], v6 offset:33792
v_cvt_pk_bf16_f32 v18, v18, v19
v_mfma_f32_16x16x32_bf16 v[248:251], a[32:35], a[88:91], v[248:251]
ds_read_b64_tr_b16 a[76:77], v6 offset:40960
v_lshlrev_b32 v19, 16, v18
v_mfma_f32_16x16x32_bf16 v[248:251], a[36:39], a[92:95], v[248:251]
ds_read_b64_tr_b16 a[78:79], v6 offset:41984
v_and_b32 v18, 0xffff0000, v18
v_mfma_f32_16x16x32_bf16 v[252:255], a[44:47], a[92:95], v[252:255]
ds_read_b64_tr_b16 a[80:81], v7 offset:32768
v_add_f32 v17, v17, v19
v_mfma_f32_16x16x32_bf16 v[252:255], a[40:43], a[88:91], v[252:255]
s_add_u32 m0, s77, 67584
ds_read_b64_tr_b16 a[82:83], v7 offset:33792
v_add_f32 v17, v17, v18
v_mfma_f32_16x16x32_bf16 a[120:123], a[48:51], a[88:91], a[120:123]
s_add_u32 s64, s71, 3211264
ds_read_b64_tr_b16 a[84:85], v7 offset:40960
v_accvgpr_read_b32 v19, a154
v_mfma_f32_16x16x32_bf16 a[120:123], a[52:55], a[92:95], a[120:123]
buffer_load_dwordx4 v15, s[36:39], s64 offen lds
v_mfma_f32_16x16x32_bf16 a[124:127], a[60:63], a[92:95], a[124:127]
ds_read_b64_tr_b16 a[86:87], v7 offset:41984
v_accvgpr_read_b32 v21, a170
v_mfma_f32_16x16x32_bf16 a[124:127], a[56:59], a[88:91], a[124:127]
ds_read_b64_tr_b16 a[88:89], v8 offset:32768
v_lshlrev_b32 v18, 16, v19
v_mfma_f32_16x16x32_bf16 a[128:131], a[56:59], a[96:99], a[128:131]
ds_read_b64_tr_b16 a[90:91], v8 offset:33792
v_and_b32 v19, 0xffff0000, v19
v_mfma_f32_16x16x32_bf16 a[128:131], a[60:63], a[100:103], a[128:131]
ds_read_b64_tr_b16 a[92:93], v8 offset:40960
v_lshlrev_b32 v20, 16, v21
v_mfma_f32_16x16x32_bf16 a[132:135], a[52:55], a[100:103], a[132:135]
ds_read_b64_tr_b16 a[94:95], v8 offset:41984
v_and_b32 v21, 0xffff0000, v21
v_mfma_f32_16x16x32_bf16 a[132:135], a[48:51], a[96:99], a[132:135]
s_add_u32 m0, s77, 68608
v_mul_f32 v18, v18, v20
v_mul_f32 v19, v19, v21
v_mfma_f32_16x16x32_bf16 a[136:139], a[40:43], a[96:99], a[136:139]
s_add_u32 s64, s71, 3244032
v_cvt_pk_bf16_f32 v18, v18, v19
v_lshlrev_b32 v19, 16, v18
v_mfma_f32_16x16x32_bf16 a[136:139], a[44:47], a[100:103], a[136:139]
buffer_load_dwordx4 v15, s[36:39], s64 offen lds
v_mfma_f32_16x16x32_bf16 a[140:143], a[36:39], a[100:103], a[140:143]
v_and_b32 v18, 0xffff0000, v18
v_add_f32 v17, v17, v19
v_mfma_f32_16x16x32_bf16 a[140:143], a[32:35], a[96:99], a[140:143]
s_waitcnt lgkmcnt(5)
ds_read_b64_tr_b16 a[96:97], v9 offset:32768
v_add_f32 v17, v17, v18
v_mfma_f32_16x16x32_bf16 v[184:187], a[104:107], a[0:3], v[184:187]
ds_read_b64_tr_b16 a[98:99], v9 offset:33792
v_accvgpr_read_b32 v19, a155
v_mfma_f32_16x16x32_bf16 v[184:187], a[108:111], a[4:7], v[184:187]
ds_read_b64_tr_b16 a[100:101], v9 offset:40960
v_accvgpr_read_b32 v21, a171
v_mfma_f32_16x16x32_bf16 v[192:195], a[108:111], a[12:15], v[192:195]
s_add_u32 s17, s78, .-L_pc+6144
ds_read_b64_tr_b16 a[102:103], v9 offset:41984
v_lshlrev_b32 v18, 16, v19
v_mfma_f32_16x16x32_bf16 v[192:195], a[104:107], a[8:11], v[192:195]
s_add_u32 m0, s77, 81920
v_and_b32 v19, 0xffff0000, v19
v_lshlrev_b32 v20, 16, v21
v_mfma_f32_16x16x32_bf16 v[200:203], a[104:107], a[16:19], v[200:203]
s_add_u32 s64, s71, 3145728
buffer_load_dword a252, v16, s[88:91], s17 offen
v_mfma_f32_16x16x32_bf16 v[200:203], a[108:111], a[20:23], v[200:203]
buffer_load_dwordx4 v14, s[40:43], s64 offen lds
v_mfma_f32_16x16x32_bf16 v[208:211], a[108:111], a[28:31], v[208:211]
v_and_b32 v21, 0xffff0000, v21
v_mul_f32 v18, v18, v20
v_mfma_f32_16x16x32_bf16 v[208:211], a[104:107], a[24:27], v[208:211]
ds_read_b64_tr_b16 a[104:105], v10 offset:32768
v_mul_f32 v19, v19, v21
v_mfma_f32_16x16x32_bf16 v[212:215], a[112:115], a[24:27], v[212:215]
ds_read_b64_tr_b16 a[106:107], v10 offset:33792
v_cvt_pk_bf16_f32 v18, v18, v19
v_mfma_f32_16x16x32_bf16 v[212:215], a[116:119], a[28:31], v[212:215]
ds_read_b64_tr_b16 a[108:109], v10 offset:40960
v_lshlrev_b32 v19, 16, v18
v_mfma_f32_16x16x32_bf16 v[204:207], a[116:119], a[20:23], v[204:207]
s_add_u32 s81, s81, 1048576
ds_read_b64_tr_b16 a[110:111], v10 offset:41984
v_and_b32 v18, 0xffff0000, v18
v_mfma_f32_16x16x32_bf16 v[204:207], a[112:115], a[16:19], v[204:207]
s_add_u32 m0, s77, 82944
v_add_f32 v17, v17, v19
v_add_f32 v17, v17, v18
v_mfma_f32_16x16x32_bf16 v[196:199], a[112:115], a[8:11], v[196:199]
s_add_u32 s64, s71, 3178496
buffer_load_dword a252, v16, s[56:59], s81 offen
v_mfma_f32_16x16x32_bf16 v[196:199], a[116:119], a[12:15], v[196:199]
buffer_load_dwordx4 v14, s[40:43], s64 offen lds
v_mfma_f32_16x16x32_bf16 v[188:191], a[116:119], a[4:7], v[188:191]
v_accvgpr_read_b32 v19, a156
v_accvgpr_read_b32 v21, a172
v_mfma_f32_16x16x32_bf16 v[188:191], a[112:115], a[0:3], v[188:191]
ds_read_b64_tr_b16 a[112:113], v11 offset:32768
v_lshlrev_b32 v18, 16, v19
v_mfma_f32_16x16x32_bf16 v[216:219], a[72:75], a[0:3], v[216:219]
ds_read_b64_tr_b16 a[114:115], v11 offset:33792
v_and_b32 v19, 0xffff0000, v19
v_mfma_f32_16x16x32_bf16 v[216:219], a[76:79], a[4:7], v[216:219]
ds_read_b64_tr_b16 a[116:117], v11 offset:40960
v_lshlrev_b32 v20, 16, v21
v_mfma_f32_16x16x32_bf16 v[224:227], a[76:79], a[12:15], v[224:227]
ds_read_b64_tr_b16 a[118:119], v11 offset:41984
v_and_b32 v21, 0xffff0000, v21
v_mfma_f32_16x16x32_bf16 v[224:227], a[72:75], a[8:11], v[224:227]
s_add_u32 m0, s77, 83968
v_mul_f32 v18, v18, v20
v_mul_f32 v19, v19, v21
v_mfma_f32_16x16x32_bf16 v[232:235], a[72:75], a[16:19], v[232:235]
s_add_u32 s64, s71, 3211264
v_cvt_pk_bf16_f32 v18, v18, v19
v_lshlrev_b32 v19, 16, v18
v_mfma_f32_16x16x32_bf16 v[232:235], a[76:79], a[20:23], v[232:235]
buffer_load_dwordx4 v15, s[40:43], s64 offen lds
v_mfma_f32_16x16x32_bf16 v[240:243], a[76:79], a[28:31], v[240:243]
v_and_b32 v18, 0xffff0000, v18
v_add_f32 v17, v17, v19
v_mfma_f32_16x16x32_bf16 v[240:243], a[72:75], a[24:27], v[240:243]
ds_read_b64_tr_b16 a[72:73], v4 offset:49152
v_add_f32 v17, v17, v18
v_mfma_f32_16x16x32_bf16 v[244:247], a[80:83], a[24:27], v[244:247]
s_waitcnt lgkmcnt(5)
ds_read_b64_tr_b16 a[74:75], v4 offset:50176
v_accvgpr_read_b32 v19, a157
v_mfma_f32_16x16x32_bf16 v[244:247], a[84:87], a[28:31], v[244:247]
ds_read_b64_tr_b16 a[76:77], v4 offset:57344
v_accvgpr_read_b32 v21, a173
v_mfma_f32_16x16x32_bf16 v[236:239], a[84:87], a[20:23], v[236:239]
ds_read_b64_tr_b16 a[78:79], v4 offset:58368
v_lshlrev_b32 v18, 16, v19
v_mfma_f32_16x16x32_bf16 v[236:239], a[80:83], a[16:19], v[236:239]
s_add_u32 m0, s77, 84992
v_and_b32 v19, 0xffff0000, v19
v_lshlrev_b32 v20, 16, v21
v_mfma_f32_16x16x32_bf16 v[228:231], a[80:83], a[8:11], v[228:231]
s_add_u32 s64, s71, 3244032
v_and_b32 v21, 0xffff0000, v21
v_mul_f32 v18, v18, v20
v_mfma_f32_16x16x32_bf16 v[228:231], a[84:87], a[12:15], v[228:231]
buffer_load_dwordx4 v15, s[40:43], s64 offen lds
v_mfma_f32_16x16x32_bf16 v[220:223], a[84:87], a[4:7], v[220:223]
v_mul_f32 v19, v19, v21
v_cvt_pk_bf16_f32 v18, v18, v19
v_mfma_f32_16x16x32_bf16 v[220:223], a[80:83], a[0:3], v[220:223]
ds_read_b64_tr_b16 a[80:81], v5 offset:49152
v_lshlrev_b32 v19, 16, v18
v_mfma_f32_16x16x32_bf16 v[152:155], a[88:91], a[0:3], v[152:155]
ds_read_b64_tr_b16 a[82:83], v5 offset:50176
v_and_b32 v18, 0xffff0000, v18
v_mfma_f32_16x16x32_bf16 v[152:155], a[92:95], a[4:7], v[152:155]
ds_read_b64_tr_b16 a[84:85], v5 offset:57344
v_add_f32 v17, v17, v19
v_mfma_f32_16x16x32_bf16 v[160:163], a[92:95], a[12:15], v[160:163]
ds_read_b64_tr_b16 a[86:87], v5 offset:58368
v_add_f32 v17, v17, v18
v_mfma_f32_16x16x32_bf16 v[160:163], a[88:91], a[8:11], v[160:163]
v_accvgpr_read_b32 v19, a158
v_accvgpr_read_b32 v21, a174
v_mfma_f32_16x16x32_bf16 v[168:171], a[88:91], a[16:19], v[168:171]
v_lshlrev_b32 v18, 16, v19
v_and_b32 v19, 0xffff0000, v19
v_mfma_f32_16x16x32_bf16 v[168:171], a[92:95], a[20:23], v[168:171]
v_lshlrev_b32 v20, 16, v21
v_and_b32 v21, 0xffff0000, v21
v_mfma_f32_16x16x32_bf16 v[176:179], a[92:95], a[28:31], v[176:179]
s_add_u32 m0, s76, 0
v_mul_f32 v18, v18, v20
v_mul_f32 v19, v19, v21
v_mfma_f32_16x16x32_bf16 v[176:179], a[88:91], a[24:27], v[176:179]
s_add_u32 s64, s70, 768
ds_read_b64_tr_b16 a[88:89], v6 offset:49152
v_cvt_pk_bf16_f32 v18, v18, v19
v_mfma_f32_16x16x32_bf16 v[180:183], a[96:99], a[24:27], v[180:183]
buffer_load_dwordx4 v12, s[32:35], s64 offen lds
v_mfma_f32_16x16x32_bf16 v[180:183], a[100:103], a[28:31], v[180:183]
ds_read_b64_tr_b16 a[90:91], v6 offset:50176
v_lshlrev_b32 v19, 16, v18
v_mfma_f32_16x16x32_bf16 v[172:175], a[100:103], a[20:23], v[172:175]
ds_read_b64_tr_b16 a[92:93], v6 offset:57344
v_and_b32 v18, 0xffff0000, v18
v_mfma_f32_16x16x32_bf16 v[172:175], a[96:99], a[16:19], v[172:175]
ds_read_b64_tr_b16 a[94:95], v6 offset:58368
v_add_f32 v17, v17, v19
v_mfma_f32_16x16x32_bf16 v[164:167], a[96:99], a[8:11], v[164:167]
v_add_f32 v17, v17, v18
v_accvgpr_read_b32 v19, a159
v_mfma_f32_16x16x32_bf16 v[164:167], a[100:103], a[12:15], v[164:167]
s_add_u32 m0, s76, 1024
v_accvgpr_read_b32 v21, a175
v_lshlrev_b32 v18, 16, v19
v_mfma_f32_16x16x32_bf16 v[156:159], a[100:103], a[4:7], v[156:159]
s_add_u32 s64, s70, 8960
v_and_b32 v19, 0xffff0000, v19
v_lshlrev_b32 v20, 16, v21
v_mfma_f32_16x16x32_bf16 v[156:159], a[96:99], a[0:3], v[156:159]
s_add_u32 s81, s81, 1048576
buffer_load_dwordx4 v13, s[32:35], s64 offen lds
v_mfma_f32_16x16x32_bf16 v[24:27], a[104:107], a[0:3], v[24:27]
buffer_load_dword a252, v16, s[56:59], s81 offen
v_mfma_f32_16x16x32_bf16 v[24:27], a[108:111], a[4:7], v[24:27]
ds_read_b64_tr_b16 a[96:97], v7 offset:49152
v_and_b32 v21, 0xffff0000, v21
v_mfma_f32_16x16x32_bf16 v[40:43], a[108:111], a[12:15], v[40:43]
ds_read_b64_tr_b16 a[98:99], v7 offset:50176
v_mul_f32 v18, v18, v20
v_mfma_f32_16x16x32_bf16 v[40:43], a[104:107], a[8:11], v[40:43]
ds_read_b64_tr_b16 a[100:101], v7 offset:57344
v_mul_f32 v19, v19, v21
v_mfma_f32_16x16x32_bf16 v[56:59], a[104:107], a[16:19], v[56:59]
s_add_u32 m0, s76, 2048
ds_read_b64_tr_b16 a[102:103], v7 offset:58368
v_cvt_pk_bf16_f32 v18, v18, v19
v_mfma_f32_16x16x32_bf16 v[56:59], a[108:111], a[20:23], v[56:59]
s_add_u32 s64, s70, 17152
v_lshlrev_b32 v19, 16, v18
v_and_b32 v18, 0xffff0000, v18
v_mfma_f32_16x16x32_bf16 v[72:75], a[108:111], a[28:31], v[72:75]
s_waitcnt vmcnt(14)
buffer_load_dwordx4 v12, s[32:35], s64 offen lds
v_mfma_f32_16x16x32_bf16 v[72:75], a[104:107], a[24:27], v[72:75]
s_waitcnt lgkmcnt(4)
ds_read_b64_tr_b16 a[104:105], v8 offset:49152
v_add_f32 v17, v17, v19
v_mfma_f32_16x16x32_bf16 v[136:139], a[112:115], a[24:27], v[136:139]
ds_read_b64_tr_b16 a[106:107], v8 offset:50176
v_add_f32 v17, v17, v18
v_mfma_f32_16x16x32_bf16 v[136:139], a[116:119], a[28:31], v[136:139]
ds_read_b64_tr_b16 a[108:109], v8 offset:57344
v_add_u32 v4, 0x8000, v4
v_mfma_f32_16x16x32_bf16 v[120:123], a[116:119], a[20:23], v[120:123]
ds_read_b64_tr_b16 a[110:111], v8 offset:58368
v_add_f32_dpp v17, v17, v17 row_ror:8 row_mask:0xf bank_mask:0xf
v_mfma_f32_16x16x32_bf16 v[120:123], a[112:115], a[16:19], v[120:123]
s_add_u32 m0, s76, 3072
ds_read_b128 a[32:35], v2 offset:32768
v_mfma_f32_16x16x32_bf16 v[104:107], a[112:115], a[8:11], v[104:107]
s_add_u32 s64, s70, 25344
ds_read_b128 a[36:39], v3 offset:32768
v_add_f32_dpp v17, v17, v17 row_ror:4 row_mask:0xf bank_mask:0xf
v_mfma_f32_16x16x32_bf16 v[104:107], a[116:119], a[12:15], v[104:107]
buffer_load_dwordx4 v13, s[32:35], s64 offen lds
v_mfma_f32_16x16x32_bf16 v[88:91], a[116:119], a[4:7], v[88:91]
ds_read_b128 a[40:43], v2 offset:34816
v_add_f32_dpp v17, v17, v17 row_ror:2 row_mask:0xf bank_mask:0xf
v_mfma_f32_16x16x32_bf16 v[88:91], a[112:115], a[0:3], v[88:91]
ds_read_b128 a[44:47], v3 offset:34816
v_mfma_f32_16x16x32_bf16 v[28:31], a[0:3], a[72:75], v[28:31]
ds_read_b128 a[48:51], v2 offset:36864
v_add_f32_dpp v17, v17, v17 row_ror:1 row_mask:0xf bank_mask:0xf
v_mfma_f32_16x16x32_bf16 v[28:31], a[4:7], a[76:79], v[28:31]
ds_read_b128 a[52:55], v3 offset:36864
v_add_u32 v5, 0x8000, v5
v_mfma_f32_16x16x32_bf16 v[44:47], a[12:15], a[76:79], v[44:47]
s_add_u32 m0, s76, 4096
ds_read_b128 a[56:59], v2 offset:38912
v_mov_b32 v18, v17
v_mfma_f32_16x16x32_bf16 v[44:47], a[8:11], a[72:75], v[44:47]
s_add_u32 s64, s70, 33536
ds_read_b128 a[60:63], v3 offset:38912
v_mfma_f32_16x16x32_bf16 v[60:63], a[16:19], a[72:75], v[60:63]
buffer_load_dwordx4 v12, s[32:35], s64 offen lds
v_mfma_f32_16x16x32_bf16 v[60:63], a[20:23], a[76:79], v[60:63]
ds_read_b64_tr_b16 a[112:113], v9 offset:49152
v_permlane16_swap_b32 v18, v17
v_mfma_f32_16x16x32_bf16 v[76:79], a[28:31], a[76:79], v[76:79]
ds_read_b64_tr_b16 a[114:115], v9 offset:50176
v_add_f32 v17, v17, v18
v_mfma_f32_16x16x32_bf16 v[76:79], a[24:27], a[72:75], v[76:79]
ds_read_b64_tr_b16 a[116:117], v9 offset:57344
v_cvt_pk_bf16_f32 v17, v17, v17
v_mfma_f32_16x16x32_bf16 v[140:143], a[24:27], a[80:83], v[140:143]
ds_read_b64_tr_b16 a[118:119], v9 offset:58368
v_and_b32 v17, 0xffff0000, v17
v_mfma_f32_16x16x32_bf16 v[140:143], a[28:31], a[84:87], v[140:143]
s_add_u32 m0, s76, 5120
ds_read_b64_tr_b16 a[72:73], v10 offset:49152
v_add_u32 v6, 0x8000, v6
v_mfma_f32_16x16x32_bf16 v[124:127], a[20:23], a[84:87], v[124:127]
s_add_u32 s64, s70, 41728
ds_read_b64_tr_b16 a[74:75], v10 offset:50176
v_mul_f32 v17, 0xbfb8aa3b, v17
v_mfma_f32_16x16x32_bf16 v[124:127], a[16:19], a[80:83], v[124:127]
buffer_load_dwordx4 v13, s[32:35], s64 offen lds
v_mfma_f32_16x16x32_bf16 v[108:111], a[8:11], a[80:83], v[108:111]
ds_read_b64_tr_b16 a[76:77], v10 offset:57344
v_mfma_f32_16x16x32_bf16 v[108:111], a[12:15], a[84:87], v[108:111]
ds_read_b64_tr_b16 a[78:79], v10 offset:58368
v_mfma_f32_16x16x32_bf16 v[92:95], a[4:7], a[84:87], v[92:95]
v_exp_f32 v17, v17
v_mfma_f32_16x16x32_bf16 v[92:95], a[0:3], a[80:83], v[92:95]
ds_read_b64_tr_b16 a[80:81], v11 offset:49152
v_add_f32 v17, 1.0, v17
v_mfma_f32_16x16x32_bf16 v[32:35], a[0:3], a[88:91], v[32:35]
s_add_u32 m0, s76, 6144
ds_read_b64_tr_b16 a[82:83], v11 offset:50176
v_mfma_f32_16x16x32_bf16 v[32:35], a[4:7], a[92:95], v[32:35]
s_add_u32 s64, s70, 49920
ds_read_b64_tr_b16 a[84:85], v11 offset:57344
v_add_u32 v7, 0x8000, v7
v_mfma_f32_16x16x32_bf16 v[48:51], a[12:15], a[92:95], v[48:51]
buffer_load_dwordx4 v12, s[32:35], s64 offen lds
v_mfma_f32_16x16x32_bf16 v[48:51], a[8:11], a[88:91], v[48:51]
s_add_u32 s82, s82, 1048576
ds_read_b64_tr_b16 a[86:87], v11 offset:58368
v_mfma_f32_16x16x32_bf16 v[64:67], a[16:19], a[88:91], v[64:67]
buffer_load_dword a252, v1, s[60:63], s82 offen
v_mfma_f32_16x16x32_bf16 v[64:67], a[20:23], a[92:95], v[64:67]
v_rcp_f32 v17, v17
v_mfma_f32_16x16x32_bf16 v[80:83], a[28:31], a[92:95], v[80:83]
v_cvt_pk_bf16_f32 v18, v17, v17
v_mfma_f32_16x16x32_bf16 v[80:83], a[24:27], a[88:91], v[80:83]
s_waitcnt lgkmcnt(4)
s_add_u32 m0, s76, 7168
v_and_b32 v18, 0xffff0000, v18
v_mfma_f32_16x16x32_bf16 v[144:147], a[24:27], a[96:99], v[144:147]
s_add_u32 s64, s70, 58112
v_sub_f32 v19, 1.0, v18
v_mfma_f32_16x16x32_bf16 v[144:147], a[28:31], a[100:103], v[144:147]
buffer_load_dwordx4 v13, s[32:35], s64 offen lds
v_mfma_f32_16x16x32_bf16 v[128:131], a[20:23], a[100:103], v[128:131]
v_add_u32 v8, 0x8000, v8
v_cvt_pk_bf16_f32 v19, v19, v19
v_mfma_f32_16x16x32_bf16 v[128:131], a[16:19], a[96:99], v[128:131]
v_and_b32 v19, 0xffff0000, v19
v_mfma_f32_16x16x32_bf16 v[112:115], a[8:11], a[96:99], v[112:115]
v_and_b32 v20, 31, v0
v_mfma_f32_16x16x32_bf16 v[112:115], a[12:15], a[100:103], v[112:115]
v_lshlrev_b32 v20, 27, v20
v_mfma_f32_16x16x32_bf16 v[96:99], a[4:7], a[100:103], v[96:99]
v_add_u32 v9, 0x8000, v9
v_add_u32 v10, 0x8000, v10
v_mfma_f32_16x16x32_bf16 v[96:99], a[0:3], a[96:99], v[96:99]
v_add_u32 v11, 0x8000, v11
v_lshrrev_b32 v21, 2, v0
v_mfma_f32_16x16x32_bf16 v[36:39], a[0:3], a[104:107], v[36:39]
v_add_u32 v20, v20, v21
v_mfma_f32_16x16x32_bf16 v[36:39], a[4:7], a[108:111], v[36:39]
v_mfma_f32_16x16x32_bf16 v[52:55], a[12:15], a[108:111], v[52:55]
s_waitcnt lgkmcnt(0)
s_barrier
v_mfma_f32_16x16x32_bf16 v[52:55], a[8:11], a[104:107], v[52:55]
s_add_u32 m0, s77, 98304
ds_read_b64_tr_b16 a[88:89], v4 offset:32768
v_mfma_f32_16x16x32_bf16 v[68:71], a[16:19], a[104:107], v[68:71]
s_add_u32 s64, s71, 3670016
ds_read_b64_tr_b16 a[90:91], v4 offset:33792
v_mfma_f32_16x16x32_bf16 v[68:71], a[20:23], a[108:111], v[68:71]
buffer_load_dwordx4 v14, s[36:39], s64 offen lds
v_mfma_f32_16x16x32_bf16 v[84:87], a[28:31], a[108:111], v[84:87]
ds_read_b64_tr_b16 a[92:93], v4 offset:40960
v_mfma_f32_16x16x32_bf16 v[84:87], a[24:27], a[104:107], v[84:87]
ds_read_b64_tr_b16 a[94:95], v4 offset:41984
v_mfma_f32_16x16x32_bf16 v[148:151], a[24:27], a[112:115], v[148:151]
ds_read_b64_tr_b16 a[96:97], v5 offset:32768
v_mfma_f32_16x16x32_bf16 v[148:151], a[28:31], a[116:119], v[148:151]
ds_read_b64_tr_b16 a[98:99], v5 offset:33792
v_mfma_f32_16x16x32_bf16 v[132:135], a[20:23], a[116:119], v[132:135]
ds_read_b64_tr_b16 a[100:101], v5 offset:40960
v_mfma_f32_16x16x32_bf16 v[132:135], a[16:19], a[112:115], v[132:135]
s_add_u32 m0, s77, 99328
ds_read_b64_tr_b16 a[102:103], v5 offset:41984
v_mfma_f32_16x16x32_bf16 v[116:119], a[8:11], a[112:115], v[116:119]
s_add_u32 s64, s71, 3702784
ds_read_b64_tr_b16 a[104:105], v6 offset:32768
v_mfma_f32_16x16x32_bf16 v[116:119], a[12:15], a[116:119], v[116:119]
buffer_load_dwordx4 v14, s[36:39], s64 offen lds
v_mfma_f32_16x16x32_bf16 v[100:103], a[4:7], a[116:119], v[100:103]
ds_read_b64_tr_b16 a[106:107], v6 offset:33792
v_mfma_f32_16x16x32_bf16 v[100:103], a[0:3], a[112:115], v[100:103]
ds_read_b64_tr_b16 a[108:109], v6 offset:40960
v_mfma_f32_16x16x32_bf16 v[248:251], a[0:3], a[72:75], v[248:251]
ds_read_b64_tr_b16 a[110:111], v6 offset:41984
v_mfma_f32_16x16x32_bf16 v[248:251], a[4:7], a[76:79], v[248:251]
ds_read_b64_tr_b16 a[112:113], v7 offset:32768
v_mfma_f32_16x16x32_bf16 v[252:255], a[12:15], a[76:79], v[252:255]
ds_read_b64_tr_b16 a[114:115], v7 offset:33792
v_mfma_f32_16x16x32_bf16 v[252:255], a[8:11], a[72:75], v[252:255]
s_add_u32 m0, s77, 100352
ds_read_b64_tr_b16 a[116:117], v7 offset:40960
v_mfma_f32_16x16x32_bf16 a[120:123], a[16:19], a[72:75], a[120:123]
s_add_u32 s64, s71, 3735552
s_lshl2_add_u32 s65, s2, s30
ds_read_b64_tr_b16 a[118:119], v7 offset:41984
v_mfma_f32_16x16x32_bf16 a[120:123], a[20:23], a[76:79], a[120:123]
s_lshl4_add_u32 s65, s65, 58720256
buffer_load_dwordx4 v15, s[36:39], s64 offen lds
v_mfma_f32_16x16x32_bf16 a[124:127], a[28:31], a[76:79], a[124:127]
buffer_store_dwordx2 v[18:19], v20, s[44:47], s65 offen sc1
v_mfma_f32_16x16x32_bf16 a[124:127], a[24:27], a[72:75], a[124:127]
s_add_u32 s81, s81, 1048576
ds_read_b64_tr_b16 a[72:73], v8 offset:32768
v_lshrrev_b32 v21, 4, v0
v_mfma_f32_16x16x32_bf16 a[128:131], a[24:27], a[80:83], a[128:131]
buffer_load_dword a252, v16, s[56:59], s81 offen
v_mfma_f32_16x16x32_bf16 a[128:131], a[28:31], a[84:87], a[128:131]
ds_read_b64_tr_b16 a[74:75], v8 offset:33792
v_bfe_u32 v19, v0, 2, 2
v_mfma_f32_16x16x32_bf16 a[132:135], a[20:23], a[84:87], a[132:135]
ds_read_b64_tr_b16 a[76:77], v8 offset:40960
v_lshl_add_u32 v19, v21, 3, v19
v_mfma_f32_16x16x32_bf16 a[132:135], a[16:19], a[80:83], a[132:135]
s_add_u32 m0, s77, 101376
ds_read_b64_tr_b16 a[78:79], v8 offset:41984
v_lshlrev_b32 v19, 6, v19
v_mfma_f32_16x16x32_bf16 a[136:139], a[8:11], a[80:83], a[136:139]
s_add_u32 s64, s71, 3768320
v_and_b32 v21, 1, v21
v_mfma_f32_16x16x32_bf16 a[136:139], a[12:15], a[84:87], a[136:139]
buffer_load_dwordx4 v15, s[36:39], s64 offen lds
v_mfma_f32_16x16x32_bf16 a[140:143], a[4:7], a[84:87], a[140:143]
v_lshl_add_u32 v19, v21, 5, v19
v_mfma_f32_16x16x32_bf16 a[140:143], a[0:3], a[80:83], a[140:143]
s_waitcnt lgkmcnt(4)
ds_read_b64_tr_b16 a[80:81], v9 offset:32768
v_and_b32 v21, 3, v0
v_mfma_f32_16x16x32_bf16 v[184:187], a[88:91], a[32:35], v[184:187]
ds_read_b64_tr_b16 a[82:83], v9 offset:33792
v_lshl_add_u32 v19, v21, 3, v19
v_mfma_f32_16x16x32_bf16 v[184:187], a[92:95], a[36:39], v[184:187]
ds_read_b64_tr_b16 a[84:85], v9 offset:40960
v_add_u32 v19, 114688, v19
v_mfma_f32_16x16x32_bf16 v[192:195], a[92:95], a[44:47], v[192:195]
ds_read_b64_tr_b16 a[86:87], v9 offset:41984
v_xor_b32 v20, 32, v19
v_mfma_f32_16x16x32_bf16 v[192:195], a[88:91], a[40:43], v[192:195]
s_add_u32 m0, s77, 114688
v_mfma_f32_16x16x32_bf16 v[200:203], a[88:91], a[48:51], v[200:203]
s_add_u32 s64, s71, 3670016
v_mfma_f32_16x16x32_bf16 v[200:203], a[92:95], a[52:55], v[200:203]
buffer_load_dwordx4 v14, s[40:43], s64 offen lds
v_mfma_f32_16x16x32_bf16 v[208:211], a[92:95], a[60:63], v[208:211]
v_mfma_f32_16x16x32_bf16 v[208:211], a[88:91], a[56:59], v[208:211]
ds_read_b64_tr_b16 a[88:89], v10 offset:32768
v_mfma_f32_16x16x32_bf16 v[212:215], a[96:99], a[56:59], v[212:215]
ds_read_b64_tr_b16 a[90:91], v10 offset:33792
v_mfma_f32_16x16x32_bf16 v[212:215], a[100:103], a[60:63], v[212:215]
ds_read_b64_tr_b16 a[92:93], v10 offset:40960
v_mfma_f32_16x16x32_bf16 v[204:207], a[100:103], a[52:55], v[204:207]
ds_read_b64_tr_b16 a[94:95], v10 offset:41984
v_mfma_f32_16x16x32_bf16 v[204:207], a[96:99], a[48:51], v[204:207]
s_add_u32 m0, s77, 115712
v_mfma_f32_16x16x32_bf16 v[196:199], a[96:99], a[40:43], v[196:199]
s_add_u32 s64, s71, 3702784
v_mfma_f32_16x16x32_bf16 v[196:199], a[100:103], a[44:47], v[196:199]
buffer_load_dwordx4 v14, s[40:43], s64 offen lds
v_mfma_f32_16x16x32_bf16 v[188:191], a[100:103], a[36:39], v[188:191]
v_mfma_f32_16x16x32_bf16 v[188:191], a[96:99], a[32:35], v[188:191]
ds_read_b64_tr_b16 a[96:97], v11 offset:32768
v_mfma_f32_16x16x32_bf16 v[216:219], a[104:107], a[32:35], v[216:219]
ds_read_b64_tr_b16 a[98:99], v11 offset:33792
v_mfma_f32_16x16x32_bf16 v[216:219], a[108:111], a[36:39], v[216:219]
ds_read_b64_tr_b16 a[100:101], v11 offset:40960
v_mfma_f32_16x16x32_bf16 v[224:227], a[108:111], a[44:47], v[224:227]
ds_read_b64_tr_b16 a[102:103], v11 offset:41984
v_mfma_f32_16x16x32_bf16 v[224:227], a[104:107], a[40:43], v[224:227]
s_add_u32 m0, s77, 116736
v_mfma_f32_16x16x32_bf16 v[232:235], a[104:107], a[48:51], v[232:235]
s_add_u32 s64, s71, 3735552
v_mfma_f32_16x16x32_bf16 v[232:235], a[108:111], a[52:55], v[232:235]
buffer_load_dwordx4 v15, s[40:43], s64 offen lds
v_mfma_f32_16x16x32_bf16 v[240:243], a[108:111], a[60:63], v[240:243]
v_mfma_f32_16x16x32_bf16 v[240:243], a[104:107], a[56:59], v[240:243]
ds_read_b64_tr_b16 a[104:105], v4 offset:49152
v_mfma_f32_16x16x32_bf16 v[244:247], a[112:115], a[56:59], v[244:247]
ds_read_b64_tr_b16 a[106:107], v4 offset:50176
v_mfma_f32_16x16x32_bf16 v[244:247], a[116:119], a[60:63], v[244:247]
ds_read_b64_tr_b16 a[108:109], v4 offset:57344
v_mfma_f32_16x16x32_bf16 v[236:239], a[116:119], a[52:55], v[236:239]
ds_read_b64_tr_b16 a[110:111], v4 offset:58368
v_mfma_f32_16x16x32_bf16 v[236:239], a[112:115], a[48:51], v[236:239]
s_add_u32 m0, s77, 117760
s_add_u32 s82, s82, 1048576
v_mfma_f32_16x16x32_bf16 v[228:231], a[112:115], a[40:43], v[228:231]
s_add_u32 s64, s71, 3768320
buffer_load_dword a252, v1, s[60:63], s82 offen
v_mfma_f32_16x16x32_bf16 v[228:231], a[116:119], a[44:47], v[228:231]
buffer_load_dwordx4 v15, s[40:43], s64 offen lds
v_mfma_f32_16x16x32_bf16 v[220:223], a[116:119], a[36:39], v[220:223]
v_mfma_f32_16x16x32_bf16 v[220:223], a[112:115], a[32:35], v[220:223]
s_waitcnt lgkmcnt(4)
ds_read_b64_tr_b16 a[112:113], v5 offset:49152
v_mfma_f32_16x16x32_bf16 v[152:155], a[72:75], a[32:35], v[152:155]
ds_read_b64_tr_b16 a[114:115], v5 offset:50176
v_mfma_f32_16x16x32_bf16 v[152:155], a[76:79], a[36:39], v[152:155]
ds_read_b64_tr_b16 a[116:117], v5 offset:57344
v_mfma_f32_16x16x32_bf16 v[160:163], a[76:79], a[44:47], v[160:163]
ds_read_b64_tr_b16 a[118:119], v5 offset:58368
v_mfma_f32_16x16x32_bf16 v[160:163], a[72:75], a[40:43], v[160:163]
v_mfma_f32_16x16x32_bf16 v[168:171], a[72:75], a[48:51], v[168:171]
v_mfma_f32_16x16x32_bf16 v[168:171], a[76:79], a[52:55], v[168:171]
v_mfma_f32_16x16x32_bf16 v[176:179], a[76:79], a[60:63], v[176:179]
s_add_u32 m0, s76, 32768
v_mfma_f32_16x16x32_bf16 v[176:179], a[72:75], a[56:59], v[176:179]
s_add_u32 s64, s70, 896
ds_read_b64_tr_b16 a[72:73], v6 offset:49152
v_mfma_f32_16x16x32_bf16 v[180:183], a[80:83], a[56:59], v[180:183]
buffer_load_dwordx4 v12, s[32:35], s64 offen lds
v_mfma_f32_16x16x32_bf16 v[180:183], a[84:87], a[60:63], v[180:183]
ds_read_b64_tr_b16 a[74:75], v6 offset:50176
v_mfma_f32_16x16x32_bf16 v[172:175], a[84:87], a[52:55], v[172:175]
ds_read_b64_tr_b16 a[76:77], v6 offset:57344
v_mfma_f32_16x16x32_bf16 v[172:175], a[80:83], a[48:51], v[172:175]
ds_read_b64_tr_b16 a[78:79], v6 offset:58368
v_mfma_f32_16x16x32_bf16 v[164:167], a[80:83], a[40:43], v[164:167]
v_mfma_f32_16x16x32_bf16 v[164:167], a[84:87], a[44:47], v[164:167]
s_add_u32 m0, s76, 33792
v_mfma_f32_16x16x32_bf16 v[156:159], a[84:87], a[36:39], v[156:159]
s_add_u32 s64, s70, 9088
v_mfma_f32_16x16x32_bf16 v[156:159], a[80:83], a[32:35], v[156:159]
buffer_load_dwordx4 v13, s[32:35], s64 offen lds
v_mfma_f32_16x16x32_bf16 v[24:27], a[88:91], a[32:35], v[24:27]
ds_read_b64_tr_b16 a[80:81], v7 offset:49152
v_mfma_f32_16x16x32_bf16 v[24:27], a[92:95], a[36:39], v[24:27]
ds_read_b64_tr_b16 a[82:83], v7 offset:50176
v_mfma_f32_16x16x32_bf16 v[40:43], a[92:95], a[44:47], v[40:43]
ds_read_b64_tr_b16 a[84:85], v7 offset:57344
v_mfma_f32_16x16x32_bf16 v[40:43], a[88:91], a[40:43], v[40:43]
ds_read_b64_tr_b16 a[86:87], v7 offset:58368
v_mfma_f32_16x16x32_bf16 v[56:59], a[88:91], a[48:51], v[56:59]
s_add_u32 m0, s76, 34816
v_mfma_f32_16x16x32_bf16 v[56:59], a[92:95], a[52:55], v[56:59]
s_add_u32 s64, s70, 17280
v_mfma_f32_16x16x32_bf16 v[72:75], a[92:95], a[60:63], v[72:75]
s_waitcnt vmcnt(13)
buffer_load_dwordx4 v12, s[32:35], s64 offen lds
v_mfma_f32_16x16x32_bf16 v[72:75], a[88:91], a[56:59], v[72:75]
ds_read_b64_tr_b16 a[88:89], v8 offset:49152
v_mfma_f32_16x16x32_bf16 v[136:139], a[96:99], a[56:59], v[136:139]
ds_read_b64_tr_b16 a[90:91], v8 offset:50176
v_mfma_f32_16x16x32_bf16 v[136:139], a[100:103], a[60:63], v[136:139]
ds_read_b64_tr_b16 a[92:93], v8 offset:57344
v_subrev_u32 v4, 0x8000, v4
v_mfma_f32_16x16x32_bf16 v[120:123], a[100:103], a[52:55], v[120:123]
ds_read_b64_tr_b16 a[94:95], v8 offset:58368
v_mfma_f32_16x16x32_bf16 v[120:123], a[96:99], a[48:51], v[120:123]
s_add_u32 m0, s76, 35840
ds_read_b128 a[0:3], v2 offset:0
v_mfma_f32_16x16x32_bf16 v[104:107], a[96:99], a[40:43], v[104:107]
s_add_u32 s64, s70, 25472
ds_read_b128 a[4:7], v3 offset:0
v_mfma_f32_16x16x32_bf16 v[104:107], a[100:103], a[44:47], v[104:107]
buffer_load_dwordx4 v13, s[32:35], s64 offen lds
v_mfma_f32_16x16x32_bf16 v[88:91], a[100:103], a[36:39], v[88:91]
ds_read_b128 a[8:11], v2 offset:2048
v_mfma_f32_16x16x32_bf16 v[88:91], a[96:99], a[32:35], v[88:91]
s_waitcnt lgkmcnt(7)
ds_read_b128 a[12:15], v3 offset:2048
v_mfma_f32_16x16x32_bf16 v[28:31], a[32:35], a[104:107], v[28:31]
ds_read_b128 a[16:19], v2 offset:4096
v_mfma_f32_16x16x32_bf16 v[28:31], a[36:39], a[108:111], v[28:31]
ds_read_b128 a[20:23], v3 offset:4096
v_subrev_u32 v5, 0x8000, v5
v_mfma_f32_16x16x32_bf16 v[44:47], a[44:47], a[108:111], v[44:47]
s_add_u32 m0, s76, 36864
ds_read_b128 a[24:27], v2 offset:6144
v_mfma_f32_16x16x32_bf16 v[44:47], a[40:43], a[104:107], v[44:47]
s_add_u32 s64, s70, 33664
ds_read_b128 a[28:31], v3 offset:6144
v_mfma_f32_16x16x32_bf16 v[60:63], a[48:51], a[104:107], v[60:63]
buffer_load_dwordx4 v12, s[32:35], s64 offen lds
v_mfma_f32_16x16x32_bf16 v[60:63], a[52:55], a[108:111], v[60:63]
ds_read_b64_tr_b16 a[96:97], v9 offset:49152
v_mfma_f32_16x16x32_bf16 v[76:79], a[60:63], a[108:111], v[76:79]
ds_read_b64_tr_b16 a[98:99], v9 offset:50176
v_mfma_f32_16x16x32_bf16 v[76:79], a[56:59], a[104:107], v[76:79]
ds_read_b64_tr_b16 a[100:101], v9 offset:57344
v_mfma_f32_16x16x32_bf16 v[140:143], a[56:59], a[112:115], v[140:143]
ds_read_b64_tr_b16 a[102:103], v9 offset:58368
v_mfma_f32_16x16x32_bf16 v[140:143], a[60:63], a[116:119], v[140:143]
s_add_u32 m0, s76, 37888
ds_read_b64_tr_b16 a[104:105], v10 offset:49152
v_subrev_u32 v6, 0x8000, v6
v_mfma_f32_16x16x32_bf16 v[124:127], a[52:55], a[116:119], v[124:127]
s_add_u32 s64, s70, 41856
ds_read_b64_tr_b16 a[106:107], v10 offset:50176
v_mfma_f32_16x16x32_bf16 v[124:127], a[48:51], a[112:115], v[124:127]
buffer_load_dwordx4 v13, s[32:35], s64 offen lds
v_mfma_f32_16x16x32_bf16 v[108:111], a[40:43], a[112:115], v[108:111]
ds_read_b64_tr_b16 a[108:109], v10 offset:57344
v_mfma_f32_16x16x32_bf16 v[108:111], a[44:47], a[116:119], v[108:111]
ds_read_b64_tr_b16 a[110:111], v10 offset:58368
v_mfma_f32_16x16x32_bf16 v[92:95], a[36:39], a[116:119], v[92:95]
v_mfma_f32_16x16x32_bf16 v[92:95], a[32:35], a[112:115], v[92:95]
ds_read_b64_tr_b16 a[112:113], v11 offset:49152
v_mfma_f32_16x16x32_bf16 v[32:35], a[32:35], a[72:75], v[32:35]
s_add_u32 m0, s76, 38912
ds_read_b64_tr_b16 a[114:115], v11 offset:50176
v_mfma_f32_16x16x32_bf16 v[32:35], a[36:39], a[76:79], v[32:35]
s_add_u32 s64, s70, 50048
ds_read_b64_tr_b16 a[116:117], v11 offset:57344
v_subrev_u32 v7, 0x8000, v7
v_mfma_f32_16x16x32_bf16 v[48:51], a[44:47], a[76:79], v[48:51]
buffer_load_dwordx4 v12, s[32:35], s64 offen lds
v_mfma_f32_16x16x32_bf16 v[48:51], a[40:43], a[72:75], v[48:51]
ds_read_b64_tr_b16 a[118:119], v11 offset:58368
v_mfma_f32_16x16x32_bf16 v[64:67], a[48:51], a[72:75], v[64:67]
v_mfma_f32_16x16x32_bf16 v[64:67], a[52:55], a[76:79], v[64:67]
v_mfma_f32_16x16x32_bf16 v[80:83], a[60:63], a[76:79], v[80:83]
v_mfma_f32_16x16x32_bf16 v[80:83], a[56:59], a[72:75], v[80:83]
s_add_u32 m0, s76, 39936
v_mfma_f32_16x16x32_bf16 v[144:147], a[56:59], a[80:83], v[144:147]
s_add_u32 s64, s70, 58240
v_mfma_f32_16x16x32_bf16 v[144:147], a[60:63], a[84:87], v[144:147]
buffer_load_dwordx4 v13, s[32:35], s64 offen lds
v_mfma_f32_16x16x32_bf16 v[128:131], a[52:55], a[84:87], v[128:131]
v_subrev_u32 v8, 0x8000, v8
v_mfma_f32_16x16x32_bf16 v[128:131], a[48:51], a[80:83], v[128:131]
v_mfma_f32_16x16x32_bf16 v[112:115], a[40:43], a[80:83], v[112:115]
v_mfma_f32_16x16x32_bf16 v[112:115], a[44:47], a[84:87], v[112:115]
v_mfma_f32_16x16x32_bf16 v[96:99], a[36:39], a[84:87], v[96:99]
v_subrev_u32 v9, 0x8000, v9
v_subrev_u32 v10, 0x8000, v10
v_mfma_f32_16x16x32_bf16 v[96:99], a[32:35], a[80:83], v[96:99]
s_waitcnt lgkmcnt(0)
v_subrev_u32 v11, 0x8000, v11
v_mfma_f32_16x16x32_bf16 v[36:39], a[32:35], a[88:91], v[36:39]
v_mfma_f32_16x16x32_bf16 v[36:39], a[36:39], a[92:95], v[36:39]
v_mfma_f32_16x16x32_bf16 v[52:55], a[44:47], a[92:95], v[52:55]
s_waitcnt lgkmcnt(0)
s_barrier
v_mfma_f32_16x16x32_bf16 v[52:55], a[40:43], a[88:91], v[52:55]
s_add_u32 m0, s77, 131072
ds_read_b64_tr_b16 a[72:73], v4 offset:0
v_mfma_f32_16x16x32_bf16 v[68:71], a[48:51], a[88:91], v[68:71]
s_add_u32 s64, s71, 0
ds_read_b64_tr_b16 a[74:75], v4 offset:1024
v_mfma_f32_16x16x32_bf16 v[68:71], a[52:55], a[92:95], v[68:71]
buffer_load_dwordx4 v14, s[56:59], s64 offen lds
v_mfma_f32_16x16x32_bf16 v[84:87], a[60:63], a[92:95], v[84:87]
ds_read_b64_tr_b16 a[76:77], v4 offset:8192
v_mfma_f32_16x16x32_bf16 v[84:87], a[56:59], a[88:91], v[84:87]
ds_read_b64_tr_b16 a[78:79], v4 offset:9216
v_mfma_f32_16x16x32_bf16 v[148:151], a[56:59], a[96:99], v[148:151]
ds_read_b64_tr_b16 a[80:81], v5 offset:0
v_lshrrev_b32 v13, 3, v0
v_mfma_f32_16x16x32_bf16 v[148:151], a[60:63], a[100:103], v[148:151]
ds_read_b64_tr_b16 a[82:83], v5 offset:1024
v_lshl_add_u32 v12, v13, 10, v12
v_mfma_f32_16x16x32_bf16 v[132:135], a[52:55], a[100:103], v[132:135]
ds_read_b64_tr_b16 a[84:85], v5 offset:8192
v_xor_b32 v13, 64, v12
v_mfma_f32_16x16x32_bf16 v[132:135], a[48:51], a[96:99], v[132:135]
ds_read_b64_tr_b16 a[86:87], v5 offset:9216
v_mfma_f32_16x16x32_bf16 v[116:119], a[40:43], a[96:99], v[116:119]
s_add_u32 m0, s78, 147456
ds_read_b64_tr_b16 a[88:89], v6 offset:0
v_mfma_f32_16x16x32_bf16 v[116:119], a[44:47], a[100:103], v[116:119]
s_add_u32 s64, s75, 0
ds_read_b64_tr_b16 a[90:91], v6 offset:1024
v_mfma_f32_16x16x32_bf16 v[100:103], a[36:39], a[100:103], v[100:103]
buffer_load_dwordx4 v23, s[60:63], s64 offen lds
v_mfma_f32_16x16x32_bf16 v[100:103], a[32:35], a[96:99], v[100:103]
ds_read_b64_tr_b16 a[92:93], v6 offset:8192
v_mfma_f32_16x16x32_bf16 v[248:251], a[32:35], a[104:107], v[248:251]
ds_read_b64_tr_b16 a[94:95], v6 offset:9216
v_mfma_f32_16x16x32_bf16 v[248:251], a[36:39], a[108:111], v[248:251]
ds_read_b64_tr_b16 a[96:97], v7 offset:0
v_mfma_f32_16x16x32_bf16 v[252:255], a[44:47], a[108:111], v[252:255]
ds_read_b64_tr_b16 a[98:99], v7 offset:1024
v_mfma_f32_16x16x32_bf16 v[252:255], a[40:43], a[104:107], v[252:255]
ds_read_b64_tr_b16 a[100:101], v7 offset:8192
v_mfma_f32_16x16x32_bf16 a[120:123], a[48:51], a[104:107], a[120:123]
ds_read_b64_tr_b16 a[102:103], v7 offset:9216
v_mfma_f32_16x16x32_bf16 a[120:123], a[52:55], a[108:111], a[120:123]
s_add_u32 m0, s77, 132096
v_mfma_f32_16x16x32_bf16 a[124:127], a[60:63], a[108:111], a[124:127]
s_add_u32 s64, s71, 32768
v_mfma_f32_16x16x32_bf16 a[124:127], a[56:59], a[104:107], a[124:127]
buffer_load_dwordx4 v14, s[56:59], s64 offen lds
v_mfma_f32_16x16x32_bf16 a[128:131], a[56:59], a[112:115], a[128:131]
ds_read_b64_tr_b16 a[104:105], v8 offset:0
v_mfma_f32_16x16x32_bf16 a[128:131], a[60:63], a[116:119], a[128:131]
ds_read_b64_tr_b16 a[106:107], v8 offset:1024
v_mfma_f32_16x16x32_bf16 a[132:135], a[52:55], a[116:119], a[132:135]
ds_read_b64_tr_b16 a[108:109], v8 offset:8192
v_mfma_f32_16x16x32_bf16 a[132:135], a[48:51], a[112:115], a[132:135]
ds_read_b64_tr_b16 a[110:111], v8 offset:9216
v_mfma_f32_16x16x32_bf16 a[136:139], a[40:43], a[112:115], a[136:139]
v_mfma_f32_16x16x32_bf16 a[136:139], a[44:47], a[116:119], a[136:139]
v_mfma_f32_16x16x32_bf16 a[140:143], a[36:39], a[116:119], a[140:143]
s_add_u32 m0, s78, 151552
v_mfma_f32_16x16x32_bf16 a[140:143], a[32:35], a[112:115], a[140:143]
s_waitcnt lgkmcnt(4)
s_add_u32 s64, s75, 2048
ds_read_b64_tr_b16 a[112:113], v9 offset:0
v_mfma_f32_16x16x32_bf16 v[184:187], a[72:75], a[0:3], v[184:187]
buffer_load_dwordx4 v23, s[60:63], s64 offen lds
v_mfma_f32_16x16x32_bf16 v[184:187], a[76:79], a[4:7], v[184:187]
ds_read_b64_tr_b16 a[114:115], v9 offset:1024
v_mfma_f32_16x16x32_bf16 v[192:195], a[76:79], a[12:15], v[192:195]
ds_read_b64_tr_b16 a[116:117], v9 offset:8192
v_mfma_f32_16x16x32_bf16 v[192:195], a[72:75], a[8:11], v[192:195]
s_add_u32 s17, s78, .-L_pc+6144
ds_read_b64_tr_b16 a[118:119], v9 offset:9216
v_mfma_f32_16x16x32_bf16 v[200:203], a[72:75], a[16:19], v[200:203]
buffer_load_dword a252, v16, s[88:91], s17 offen
v_mfma_f32_16x16x32_bf16 v[200:203], a[76:79], a[20:23], v[200:203]
v_mfma_f32_16x16x32_bf16 v[208:211], a[76:79], a[28:31], v[208:211]
v_mfma_f32_16x16x32_bf16 v[208:211], a[72:75], a[24:27], v[208:211]
ds_read_b64_tr_b16 a[72:73], v10 offset:0
v_mfma_f32_16x16x32_bf16 v[212:215], a[80:83], a[24:27], v[212:215]
s_add_u32 m0, s77, 133120
ds_read_b64_tr_b16 a[74:75], v10 offset:1024
v_mfma_f32_16x16x32_bf16 v[212:215], a[84:87], a[28:31], v[212:215]
s_add_u32 s64, s71, 65536
ds_read_b64_tr_b16 a[76:77], v10 offset:8192
v_mfma_f32_16x16x32_bf16 v[204:207], a[84:87], a[20:23], v[204:207]
buffer_load_dwordx4 v15, s[56:59], s64 offen lds
v_mfma_f32_16x16x32_bf16 v[204:207], a[80:83], a[16:19], v[204:207]
ds_read_b64_tr_b16 a[78:79], v10 offset:9216
v_mfma_f32_16x16x32_bf16 v[196:199], a[80:83], a[8:11], v[196:199]
v_mfma_f32_16x16x32_bf16 v[196:199], a[84:87], a[12:15], v[196:199]
v_mfma_f32_16x16x32_bf16 v[188:191], a[84:87], a[4:7], v[188:191]
v_mfma_f32_16x16x32_bf16 v[188:191], a[80:83], a[0:3], v[188:191]
ds_read_b64_tr_b16 a[80:81], v11 offset:0
v_mfma_f32_16x16x32_bf16 v[216:219], a[88:91], a[0:3], v[216:219]
ds_read_b64_tr_b16 a[82:83], v11 offset:1024
v_mfma_f32_16x16x32_bf16 v[216:219], a[92:95], a[4:7], v[216:219]
s_add_u32 m0, s78, 155648
ds_read_b64_tr_b16 a[84:85], v11 offset:8192
v_mfma_f32_16x16x32_bf16 v[224:227], a[92:95], a[12:15], v[224:227]
s_add_u32 s64, s75, 4096
ds_read_b64_tr_b16 a[86:87], v11 offset:9216
v_mfma_f32_16x16x32_bf16 v[224:227], a[88:91], a[8:11], v[224:227]
buffer_load_dwordx4 v23, s[60:63], s64 offen lds
v_mfma_f32_16x16x32_bf16 v[232:235], a[88:91], a[16:19], v[232:235]
v_mfma_f32_16x16x32_bf16 v[232:235], a[92:95], a[20:23], v[232:235]
v_mfma_f32_16x16x32_bf16 v[240:243], a[92:95], a[28:31], v[240:243]
v_mfma_f32_16x16x32_bf16 v[240:243], a[88:91], a[24:27], v[240:243]
ds_read_b64_tr_b16 a[88:89], v4 offset:16384
v_mfma_f32_16x16x32_bf16 v[244:247], a[96:99], a[24:27], v[244:247]
ds_read_b64_tr_b16 a[90:91], v4 offset:17408
v_mfma_f32_16x16x32_bf16 v[244:247], a[100:103], a[28:31], v[244:247]
ds_read_b64_tr_b16 a[92:93], v4 offset:24576
v_mfma_f32_16x16x32_bf16 v[236:239], a[100:103], a[20:23], v[236:239]
s_add_u32 m0, s77, 134144
ds_read_b64_tr_b16 a[94:95], v4 offset:25600
v_mfma_f32_16x16x32_bf16 v[236:239], a[96:99], a[16:19], v[236:239]
s_add_u32 s64, s71, 98304
v_mfma_f32_16x16x32_bf16 v[228:231], a[96:99], a[8:11], v[228:231]
buffer_load_dwordx4 v15, s[56:59], s64 offen lds
v_mfma_f32_16x16x32_bf16 v[228:231], a[100:103], a[12:15], v[228:231]
v_mfma_f32_16x16x32_bf16 v[220:223], a[100:103], a[4:7], v[220:223]
v_mfma_f32_16x16x32_bf16 v[220:223], a[96:99], a[0:3], v[220:223]
s_waitcnt lgkmcnt(4)
ds_read_b64_tr_b16 a[96:97], v5 offset:16384
v_mfma_f32_16x16x32_bf16 v[152:155], a[104:107], a[0:3], v[152:155]
ds_read_b64_tr_b16 a[98:99], v5 offset:17408
v_mfma_f32_16x16x32_bf16 v[152:155], a[108:111], a[4:7], v[152:155]
ds_read_b64_tr_b16 a[100:101], v5 offset:24576
v_mfma_f32_16x16x32_bf16 v[160:163], a[108:111], a[12:15], v[160:163]
ds_read_b64_tr_b16 a[102:103], v5 offset:25600
v_mfma_f32_16x16x32_bf16 v[160:163], a[104:107], a[8:11], v[160:163]
v_mfma_f32_16x16x32_bf16 v[168:171], a[104:107], a[16:19], v[168:171]
v_mfma_f32_16x16x32_bf16 v[168:171], a[108:111], a[20:23], v[168:171]
v_mfma_f32_16x16x32_bf16 v[176:179], a[108:111], a[28:31], v[176:179]
s_add_u32 m0, s76, 0
v_mfma_f32_16x16x32_bf16 v[176:179], a[104:107], a[24:27], v[176:179]
s_add_u32 s64, s72, 0
ds_read_b64_tr_b16 a[104:105], v6 offset:16384
v_mfma_f32_16x16x32_bf16 v[180:183], a[112:115], a[24:27], v[180:183]
buffer_load_dwordx4 v12, s[48:51], s64 offen lds
v_mfma_f32_16x16x32_bf16 v[180:183], a[116:119], a[28:31], v[180:183]
ds_read_b64_tr_b16 a[106:107], v6 offset:17408
v_mfma_f32_16x16x32_bf16 v[172:175], a[116:119], a[20:23], v[172:175]
ds_read_b64_tr_b16 a[108:109], v6 offset:24576
v_mfma_f32_16x16x32_bf16 v[172:175], a[112:115], a[16:19], v[172:175]
ds_read_b64_tr_b16 a[110:111], v6 offset:25600
v_mfma_f32_16x16x32_bf16 v[164:167], a[112:115], a[8:11], v[164:167]
v_mfma_f32_16x16x32_bf16 v[164:167], a[116:119], a[12:15], v[164:167]
s_add_u32 m0, s76, 1024
v_mfma_f32_16x16x32_bf16 v[156:159], a[116:119], a[4:7], v[156:159]
s_add_u32 s64, s72, 16384
v_mfma_f32_16x16x32_bf16 v[156:159], a[112:115], a[0:3], v[156:159]
buffer_load_dwordx4 v13, s[48:51], s64 offen lds
v_mfma_f32_16x16x32_bf16 v[24:27], a[72:75], a[0:3], v[24:27]
ds_read_b64_tr_b16 a[112:113], v7 offset:16384
v_mfma_f32_16x16x32_bf16 v[24:27], a[76:79], a[4:7], v[24:27]
ds_read_b64_tr_b16 a[114:115], v7 offset:17408
v_mfma_f32_16x16x32_bf16 v[40:43], a[76:79], a[12:15], v[40:43]
ds_read_b64_tr_b16 a[116:117], v7 offset:24576
v_mfma_f32_16x16x32_bf16 v[40:43], a[72:75], a[8:11], v[40:43]
ds_read_b64_tr_b16 a[118:119], v7 offset:25600
v_mfma_f32_16x16x32_bf16 v[56:59], a[72:75], a[16:19], v[56:59]
s_add_u32 m0, s76, 2048
v_mfma_f32_16x16x32_bf16 v[56:59], a[76:79], a[20:23], v[56:59]
s_add_u32 s64, s72, 131072
v_mfma_f32_16x16x32_bf16 v[72:75], a[76:79], a[28:31], v[72:75]
s_waitcnt vmcnt(10)
buffer_load_dwordx4 v12, s[48:51], s64 offen lds
v_mfma_f32_16x16x32_bf16 v[72:75], a[72:75], a[24:27], v[72:75]
ds_read_b64_tr_b16 a[72:73], v8 offset:16384
v_mfma_f32_16x16x32_bf16 v[136:139], a[80:83], a[24:27], v[136:139]
ds_read_b64_tr_b16 a[74:75], v8 offset:17408
v_mfma_f32_16x16x32_bf16 v[136:139], a[84:87], a[28:31], v[136:139]
ds_read_b64_tr_b16 a[76:77], v8 offset:24576
v_mfma_f32_16x16x32_bf16 v[120:123], a[84:87], a[20:23], v[120:123]
ds_read_b64_tr_b16 a[78:79], v8 offset:25600
v_mfma_f32_16x16x32_bf16 v[120:123], a[80:83], a[16:19], v[120:123]
s_add_u32 m0, s76, 3072
ds_read_b128 a[32:35], v2 offset:32768
v_mfma_f32_16x16x32_bf16 v[104:107], a[80:83], a[8:11], v[104:107]
s_add_u32 s64, s72, 147456
ds_read_b128 a[36:39], v3 offset:32768
v_mfma_f32_16x16x32_bf16 v[104:107], a[84:87], a[12:15], v[104:107]
buffer_load_dwordx4 v13, s[48:51], s64 offen lds
v_mfma_f32_16x16x32_bf16 v[88:91], a[84:87], a[4:7], v[88:91]
ds_read_b128 a[40:43], v2 offset:34816
v_mfma_f32_16x16x32_bf16 v[88:91], a[80:83], a[0:3], v[88:91]
s_waitcnt lgkmcnt(7)
ds_read_b128 a[44:47], v3 offset:34816
v_mfma_f32_16x16x32_bf16 v[28:31], a[0:3], a[88:91], v[28:31]
ds_read_b128 a[48:51], v2 offset:36864
v_mfma_f32_16x16x32_bf16 v[28:31], a[4:7], a[92:95], v[28:31]
ds_read_b128 a[52:55], v3 offset:36864
v_mfma_f32_16x16x32_bf16 v[44:47], a[12:15], a[92:95], v[44:47]
s_add_u32 m0, s76, 4096
ds_read_b128 a[56:59], v2 offset:38912
v_mfma_f32_16x16x32_bf16 v[44:47], a[8:11], a[88:91], v[44:47]
s_add_u32 s64, s73, 0
ds_read_b128 a[60:63], v3 offset:38912
v_mfma_f32_16x16x32_bf16 v[60:63], a[16:19], a[88:91], v[60:63]
buffer_load_dwordx4 v12, s[48:51], s64 offen lds
v_mfma_f32_16x16x32_bf16 v[60:63], a[20:23], a[92:95], v[60:63]
ds_read_b64_tr_b16 a[80:81], v9 offset:16384
v_mfma_f32_16x16x32_bf16 v[76:79], a[28:31], a[92:95], v[76:79]
ds_read_b64_tr_b16 a[82:83], v9 offset:17408
v_mfma_f32_16x16x32_bf16 v[76:79], a[24:27], a[88:91], v[76:79]
ds_read_b64_tr_b16 a[84:85], v9 offset:24576
v_mfma_f32_16x16x32_bf16 v[140:143], a[24:27], a[96:99], v[140:143]
ds_read_b64_tr_b16 a[86:87], v9 offset:25600
v_mfma_f32_16x16x32_bf16 v[140:143], a[28:31], a[100:103], v[140:143]
s_add_u32 m0, s76, 5120
ds_read_b64_tr_b16 a[88:89], v10 offset:16384
v_mfma_f32_16x16x32_bf16 v[124:127], a[20:23], a[100:103], v[124:127]
s_add_u32 s64, s73, 16384
ds_read_b64_tr_b16 a[90:91], v10 offset:17408
v_mfma_f32_16x16x32_bf16 v[124:127], a[16:19], a[96:99], v[124:127]
buffer_load_dwordx4 v13, s[48:51], s64 offen lds
v_mfma_f32_16x16x32_bf16 v[108:111], a[8:11], a[96:99], v[108:111]
ds_read_b64_tr_b16 a[92:93], v10 offset:24576
v_mfma_f32_16x16x32_bf16 v[108:111], a[12:15], a[100:103], v[108:111]
ds_read_b64_tr_b16 a[94:95], v10 offset:25600
v_mfma_f32_16x16x32_bf16 v[92:95], a[4:7], a[100:103], v[92:95]
v_mfma_f32_16x16x32_bf16 v[92:95], a[0:3], a[96:99], v[92:95]
ds_read_b64_tr_b16 a[96:97], v11 offset:16384
v_mfma_f32_16x16x32_bf16 v[32:35], a[0:3], a[104:107], v[32:35]
s_add_u32 m0, s76, 6144
ds_read_b64_tr_b16 a[98:99], v11 offset:17408
v_mfma_f32_16x16x32_bf16 v[32:35], a[4:7], a[108:111], v[32:35]
s_add_u32 s64, s73, 131072
ds_read_b64_tr_b16 a[100:101], v11 offset:24576
v_mfma_f32_16x16x32_bf16 v[48:51], a[12:15], a[108:111], v[48:51]
buffer_load_dwordx4 v12, s[48:51], s64 offen lds
v_mfma_f32_16x16x32_bf16 v[48:51], a[8:11], a[104:107], v[48:51]
ds_read_b64_tr_b16 a[102:103], v11 offset:25600
v_mfma_f32_16x16x32_bf16 v[64:67], a[16:19], a[104:107], v[64:67]
v_mfma_f32_16x16x32_bf16 v[64:67], a[20:23], a[108:111], v[64:67]
v_mfma_f32_16x16x32_bf16 v[80:83], a[28:31], a[108:111], v[80:83]
v_mfma_f32_16x16x32_bf16 v[80:83], a[24:27], a[104:107], v[80:83]
s_add_u32 m0, s76, 7168
v_mfma_f32_16x16x32_bf16 v[144:147], a[24:27], a[112:115], v[144:147]
s_add_u32 s64, s73, 147456
v_mfma_f32_16x16x32_bf16 v[144:147], a[28:31], a[116:119], v[144:147]
buffer_load_dwordx4 v13, s[48:51], s64 offen lds
v_mfma_f32_16x16x32_bf16 v[128:131], a[20:23], a[116:119], v[128:131]
v_mfma_f32_16x16x32_bf16 v[128:131], a[16:19], a[112:115], v[128:131]
v_mfma_f32_16x16x32_bf16 v[112:115], a[8:11], a[112:115], v[112:115]
v_mfma_f32_16x16x32_bf16 v[112:115], a[12:15], a[116:119], v[112:115]
v_mfma_f32_16x16x32_bf16 v[96:99], a[4:7], a[116:119], v[96:99]
v_mfma_f32_16x16x32_bf16 v[96:99], a[0:3], a[112:115], v[96:99]
s_waitcnt lgkmcnt(0)
v_mfma_f32_16x16x32_bf16 v[36:39], a[0:3], a[72:75], v[36:39]
v_mfma_f32_16x16x32_bf16 v[36:39], a[4:7], a[76:79], v[36:39]
v_mfma_f32_16x16x32_bf16 v[52:55], a[12:15], a[76:79], v[52:55]
s_waitcnt lgkmcnt(0)
s_barrier
v_mfma_f32_16x16x32_bf16 v[52:55], a[8:11], a[72:75], v[52:55]
s_add_u32 m0, s77, 65536
ds_read_b64_tr_b16 a[104:105], v4 offset:32768
v_mfma_f32_16x16x32_bf16 v[68:71], a[16:19], a[72:75], v[68:71]
s_add_u32 s64, s71, 524288
ds_read_b64_tr_b16 a[106:107], v4 offset:33792
v_mfma_f32_16x16x32_bf16 v[68:71], a[20:23], a[76:79], v[68:71]
buffer_load_dwordx4 v14, s[56:59], s64 offen lds
v_mfma_f32_16x16x32_bf16 v[84:87], a[28:31], a[76:79], v[84:87]
ds_read_b64_tr_b16 a[108:109], v4 offset:40960
v_mfma_f32_16x16x32_bf16 v[84:87], a[24:27], a[72:75], v[84:87]
ds_read_b64_tr_b16 a[110:111], v4 offset:41984
v_mfma_f32_16x16x32_bf16 v[148:151], a[24:27], a[80:83], v[148:151]
ds_read_b64_tr_b16 a[112:113], v5 offset:32768
v_mfma_f32_16x16x32_bf16 v[148:151], a[28:31], a[84:87], v[148:151]
ds_read_b64_tr_b16 a[114:115], v5 offset:33792
v_mfma_f32_16x16x32_bf16 v[132:135], a[20:23], a[84:87], v[132:135]
ds_read_b64_tr_b16 a[116:117], v5 offset:40960
v_mfma_f32_16x16x32_bf16 v[132:135], a[16:19], a[80:83], v[132:135]
ds_read_b64_tr_b16 a[118:119], v5 offset:41984
v_mfma_f32_16x16x32_bf16 v[116:119], a[8:11], a[80:83], v[116:119]
s_add_u32 m0, s78, 81920
ds_read_b64_tr_b16 a[72:73], v6 offset:32768
v_mfma_f32_16x16x32_bf16 v[116:119], a[12:15], a[84:87], v[116:119]
s_add_u32 s64, s75, 393216
ds_read_b64_tr_b16 a[74:75], v6 offset:33792
v_mfma_f32_16x16x32_bf16 v[100:103], a[4:7], a[84:87], v[100:103]
buffer_load_dwordx4 v23, s[60:63], s64 offen lds
v_mfma_f32_16x16x32_bf16 v[100:103], a[0:3], a[80:83], v[100:103]
ds_read_b64_tr_b16 a[76:77], v6 offset:40960
v_mfma_f32_16x16x32_bf16 v[248:251], a[0:3], a[88:91], v[248:251]
ds_read_b64_tr_b16 a[78:79], v6 offset:41984
v_mfma_f32_16x16x32_bf16 v[248:251], a[4:7], a[92:95], v[248:251]
ds_read_b64_tr_b16 a[80:81], v7 offset:32768
v_mfma_f32_16x16x32_bf16 v[252:255], a[12:15], a[92:95], v[252:255]
ds_read_b64_tr_b16 a[82:83], v7 offset:33792
v_mfma_f32_16x16x32_bf16 v[252:255], a[8:11], a[88:91], v[252:255]
ds_read_b64_tr_b16 a[84:85], v7 offset:40960
v_mfma_f32_16x16x32_bf16 a[120:123], a[16:19], a[88:91], a[120:123]
ds_read_b64_tr_b16 a[86:87], v7 offset:41984
v_mfma_f32_16x16x32_bf16 a[120:123], a[20:23], a[92:95], a[120:123]
s_add_u32 m0, s77, 66560
v_mfma_f32_16x16x32_bf16 a[124:127], a[28:31], a[92:95], a[124:127]
s_add_u32 s64, s71, 557056
v_mfma_f32_16x16x32_bf16 a[124:127], a[24:27], a[88:91], a[124:127]
buffer_load_dwordx4 v14, s[56:59], s64 offen lds
v_mfma_f32_16x16x32_bf16 a[128:131], a[24:27], a[96:99], a[128:131]
ds_read_b64_tr_b16 a[88:89], v8 offset:32768
v_mfma_f32_16x16x32_bf16 a[128:131], a[28:31], a[100:103], a[128:131]
ds_read_b64_tr_b16 a[90:91], v8 offset:33792
v_mfma_f32_16x16x32_bf16 a[132:135], a[20:23], a[100:103], a[132:135]
ds_read_b64_tr_b16 a[92:93], v8 offset:40960
v_mfma_f32_16x16x32_bf16 a[132:135], a[16:19], a[96:99], a[132:135]
ds_read_b64_tr_b16 a[94:95], v8 offset:41984
v_mfma_f32_16x16x32_bf16 a[136:139], a[8:11], a[96:99], a[136:139]
v_mfma_f32_16x16x32_bf16 a[136:139], a[12:15], a[100:103], a[136:139]
v_mfma_f32_16x16x32_bf16 a[140:143], a[4:7], a[100:103], a[140:143]
s_add_u32 m0, s78, 86016
v_mfma_f32_16x16x32_bf16 a[140:143], a[0:3], a[96:99], a[140:143]
s_waitcnt lgkmcnt(4)
s_add_u32 s64, s75, 395264
ds_read_b64_tr_b16 a[96:97], v9 offset:32768
v_mfma_f32_16x16x32_bf16 v[184:187], a[104:107], a[32:35], v[184:187]
s_lshl_b32 s66, s30, 30
buffer_load_dwordx4 v23, s[60:63], s64 offen lds
v_mfma_f32_16x16x32_bf16 v[184:187], a[108:111], a[36:39], v[184:187]
ds_read_b64_tr_b16 a[98:99], v9 offset:33792
v_lshl_add_u32 v1, v0, 24, s66
v_mfma_f32_16x16x32_bf16 v[192:195], a[108:111], a[44:47], v[192:195]
s_lshr_b32 s66, s3, 1
ds_read_b64_tr_b16 a[100:101], v9 offset:40960
v_mfma_f32_16x16x32_bf16 v[192:195], a[104:107], a[40:43], v[192:195]
s_lshl_b32 s66, s66, 12
ds_read_b64_tr_b16 a[102:103], v9 offset:41984
v_mfma_f32_16x16x32_bf16 v[200:203], a[104:107], a[48:51], v[200:203]
v_mfma_f32_16x16x32_bf16 v[200:203], a[108:111], a[52:55], v[200:203]
v_mfma_f32_16x16x32_bf16 v[208:211], a[108:111], a[60:63], v[208:211]
v_mfma_f32_16x16x32_bf16 v[208:211], a[104:107], a[56:59], v[208:211]
ds_read_b64_tr_b16 a[104:105], v10 offset:32768
v_mfma_f32_16x16x32_bf16 v[212:215], a[112:115], a[56:59], v[212:215]
s_add_u32 m0, s77, 67584
ds_read_b64_tr_b16 a[106:107], v10 offset:33792
v_mfma_f32_16x16x32_bf16 v[212:215], a[116:119], a[60:63], v[212:215]
s_add_u32 s64, s71, 589824
ds_read_b64_tr_b16 a[108:109], v10 offset:40960
v_mfma_f32_16x16x32_bf16 v[204:207], a[116:119], a[52:55], v[204:207]
buffer_load_dwordx4 v15, s[56:59], s64 offen lds
v_mfma_f32_16x16x32_bf16 v[204:207], a[112:115], a[48:51], v[204:207]
ds_read_b64_tr_b16 a[110:111], v10 offset:41984
v_mfma_f32_16x16x32_bf16 v[196:199], a[112:115], a[40:43], v[196:199]
v_mfma_f32_16x16x32_bf16 v[196:199], a[116:119], a[44:47], v[196:199]
v_mfma_f32_16x16x32_bf16 v[188:191], a[116:119], a[36:39], v[188:191]
v_mfma_f32_16x16x32_bf16 v[188:191], a[112:115], a[32:35], v[188:191]
s_add_u32 s67, s79, 20480
ds_read_b64_tr_b16 a[112:113], v11 offset:32768
v_mfma_f32_16x16x32_bf16 v[216:219], a[72:75], a[32:35], v[216:219]
ds_read_b64_tr_b16 a[114:115], v11 offset:33792
v_mfma_f32_16x16x32_bf16 v[216:219], a[76:79], a[36:39], v[216:219]
s_add_u32 m0, s78, 90112
ds_read_b64_tr_b16 a[116:117], v11 offset:40960
v_cvt_pk_bf16_f32 v215, v214, v215
v_mfma_f32_16x16x32_bf16 v[224:227], a[76:79], a[44:47], v[224:227]
s_add_u32 s64, s75, 397312
ds_read_b64_tr_b16 a[118:119], v11 offset:41984
v_cvt_pk_bf16_f32 v214, v212, v213
v_mfma_f32_16x16x32_bf16 v[224:227], a[72:75], a[40:43], v[224:227]
buffer_load_dwordx4 v23, s[60:63], s64 offen lds
v_mfma_f32_16x16x32_bf16 v[232:235], a[72:75], a[48:51], v[232:235]
v_cvt_pk_bf16_f32 v212, v208, v209
v_cvt_pk_bf16_f32 v213, v210, v211
v_mfma_f32_16x16x32_bf16 v[232:235], a[76:79], a[52:55], v[232:235]
buffer_store_dwordx4 v[212:215], v16, s[44:47], s67 offen sc1
v_mfma_f32_16x16x32_bf16 v[240:243], a[76:79], a[60:63], v[240:243]
v_cvt_pk_bf16_f32 v207, v206, v207
v_cvt_pk_bf16_f32 v206, v204, v205
v_mfma_f32_16x16x32_bf16 v[240:243], a[72:75], a[56:59], v[240:243]
ds_read_b64_tr_b16 a[72:73], v4 offset:49152
v_cvt_pk_bf16_f32 v204, v200, v201
v_mfma_f32_16x16x32_bf16 v[244:247], a[80:83], a[56:59], v[244:247]
ds_read_b64_tr_b16 a[74:75], v4 offset:50176
v_cvt_pk_bf16_f32 v205, v202, v203
v_mfma_f32_16x16x32_bf16 v[244:247], a[84:87], a[60:63], v[244:247]
ds_read_b64_tr_b16 a[76:77], v4 offset:57344
v_accvgpr_write_b32 a144, v204
v_mfma_f32_16x16x32_bf16 v[236:239], a[84:87], a[52:55], v[236:239]
s_add_u32 m0, s77, 68608
ds_read_b64_tr_b16 a[78:79], v4 offset:58368
v_accvgpr_write_b32 a145, v205
v_mfma_f32_16x16x32_bf16 v[236:239], a[80:83], a[48:51], v[236:239]
s_add_u32 s64, s71, 622592
v_accvgpr_write_b32 a146, v206
v_accvgpr_write_b32 a147, v207
v_mfma_f32_16x16x32_bf16 v[228:231], a[80:83], a[40:43], v[228:231]
buffer_load_dwordx4 v15, s[56:59], s64 offen lds
v_mfma_f32_16x16x32_bf16 v[228:231], a[84:87], a[44:47], v[228:231]
v_cvt_pk_bf16_f32 v199, v198, v199
v_cvt_pk_bf16_f32 v198, v196, v197
v_mfma_f32_16x16x32_bf16 v[220:223], a[84:87], a[36:39], v[220:223]
v_cvt_pk_bf16_f32 v196, v192, v193
v_cvt_pk_bf16_f32 v197, v194, v195
v_mfma_f32_16x16x32_bf16 v[220:223], a[80:83], a[32:35], v[220:223]
s_waitcnt lgkmcnt(4)
ds_read_b64_tr_b16 a[80:81], v5 offset:49152
v_accvgpr_write_b32 a148, v196
v_mfma_f32_16x16x32_bf16 v[152:155], a[88:91], a[32:35], v[152:155]
ds_read_b64_tr_b16 a[82:83], v5 offset:50176
v_accvgpr_write_b32 a149, v197
v_mfma_f32_16x16x32_bf16 v[152:155], a[92:95], a[36:39], v[152:155]
ds_read_b64_tr_b16 a[84:85], v5 offset:57344
v_accvgpr_write_b32 a150, v198
v_mfma_f32_16x16x32_bf16 v[160:163], a[92:95], a[44:47], v[160:163]
ds_read_b64_tr_b16 a[86:87], v5 offset:58368
v_accvgpr_write_b32 a151, v199
v_mfma_f32_16x16x32_bf16 v[160:163], a[88:91], a[40:43], v[160:163]
v_cvt_pk_bf16_f32 v191, v190, v191
v_cvt_pk_bf16_f32 v190, v188, v189
v_mfma_f32_16x16x32_bf16 v[168:171], a[88:91], a[48:51], v[168:171]
v_cvt_pk_bf16_f32 v188, v184, v185
v_cvt_pk_bf16_f32 v189, v186, v187
v_mfma_f32_16x16x32_bf16 v[168:171], a[92:95], a[52:55], v[168:171]
v_accvgpr_write_b32 a152, v188
v_accvgpr_write_b32 a153, v189
v_mfma_f32_16x16x32_bf16 v[176:179], a[92:95], a[60:63], v[176:179]
s_add_u32 m0, s76, 32768
v_accvgpr_write_b32 a154, v190
v_accvgpr_write_b32 a155, v191
v_mfma_f32_16x16x32_bf16 v[176:179], a[88:91], a[56:59], v[176:179]
s_add_u32 s67, s79, 21504
s_add_u32 s64, s72, 128
ds_read_b64_tr_b16 a[88:89], v6 offset:49152
v_cvt_pk_bf16_f32 v247, v246, v247
v_mfma_f32_16x16x32_bf16 v[180:183], a[96:99], a[56:59], v[180:183]
buffer_load_dwordx4 v12, s[48:51], s64 offen lds
v_mfma_f32_16x16x32_bf16 v[180:183], a[100:103], a[60:63], v[180:183]
ds_read_b64_tr_b16 a[90:91], v6 offset:50176
v_cvt_pk_bf16_f32 v246, v244, v245
v_mfma_f32_16x16x32_bf16 v[172:175], a[100:103], a[52:55], v[172:175]
ds_read_b64_tr_b16 a[92:93], v6 offset:57344
v_cvt_pk_bf16_f32 v244, v240, v241
v_mfma_f32_16x16x32_bf16 v[172:175], a[96:99], a[48:51], v[172:175]
ds_read_b64_tr_b16 a[94:95], v6 offset:58368
v_cvt_pk_bf16_f32 v245, v242, v243
v_mfma_f32_16x16x32_bf16 v[164:167], a[96:99], a[40:43], v[164:167]
buffer_store_dwordx4 v[244:247], v16, s[44:47], s67 offen sc1
v_mfma_f32_16x16x32_bf16 v[164:167], a[100:103], a[44:47], v[164:167]
s_add_u32 m0, s76, 33792
v_cvt_pk_bf16_f32 v239, v238, v239
v_cvt_pk_bf16_f32 v238, v236, v237
v_mfma_f32_16x16x32_bf16 v[156:159], a[100:103], a[36:39], v[156:159]
s_add_u32 s64, s72, 16512
v_cvt_pk_bf16_f32 v236, v232, v233
v_cvt_pk_bf16_f32 v237, v234, v235
v_mfma_f32_16x16x32_bf16 v[156:159], a[96:99], a[32:35], v[156:159]
buffer_load_dwordx4 v13, s[48:51], s64 offen lds
v_mfma_f32_16x16x32_bf16 v[24:27], a[104:107], a[32:35], v[24:27]
ds_read_b64_tr_b16 a[96:97], v7 offset:49152
v_accvgpr_write_b32 a156, v236
v_mfma_f32_16x16x32_bf16 v[24:27], a[108:111], a[36:39], v[24:27]
ds_read_b64_tr_b16 a[98:99], v7 offset:50176
v_accvgpr_write_b32 a157, v237
v_mfma_f32_16x16x32_bf16 v[40:43], a[108:111], a[44:47], v[40:43]
ds_read_b64_tr_b16 a[100:101], v7 offset:57344
v_accvgpr_write_b32 a158, v238
v_mfma_f32_16x16x32_bf16 v[40:43], a[104:107], a[40:43], v[40:43]
ds_read_b64_tr_b16 a[102:103], v7 offset:58368
v_accvgpr_write_b32 a159, v239
v_mfma_f32_16x16x32_bf16 v[56:59], a[104:107], a[48:51], v[56:59]
s_add_u32 m0, s76, 34816
v_cvt_pk_bf16_f32 v231, v230, v231
v_cvt_pk_bf16_f32 v230, v228, v229
v_mfma_f32_16x16x32_bf16 v[56:59], a[108:111], a[52:55], v[56:59]
s_add_u32 s64, s72, 131200
v_cvt_pk_bf16_f32 v228, v224, v225
v_cvt_pk_bf16_f32 v229, v226, v227
v_mfma_f32_16x16x32_bf16 v[72:75], a[108:111], a[60:63], v[72:75]
s_waitcnt vmcnt(11)
buffer_load_dwordx4 v12, s[48:51], s64 offen lds
v_mfma_f32_16x16x32_bf16 v[72:75], a[104:107], a[56:59], v[72:75]
ds_read_b64_tr_b16 a[104:105], v8 offset:49152
v_accvgpr_write_b32 a160, v228
v_mfma_f32_16x16x32_bf16 v[136:139], a[112:115], a[56:59], v[136:139]
ds_read_b64_tr_b16 a[106:107], v8 offset:50176
v_accvgpr_write_b32 a161, v229
v_mfma_f32_16x16x32_bf16 v[136:139], a[116:119], a[60:63], v[136:139]
ds_read_b64_tr_b16 a[108:109], v8 offset:57344
v_add_u32 v4, 0x8000, v4
v_mfma_f32_16x16x32_bf16 v[120:123], a[116:119], a[52:55], v[120:123]
ds_read_b64_tr_b16 a[110:111], v8 offset:58368
v_accvgpr_write_b32 a162, v230
v_mfma_f32_16x16x32_bf16 v[120:123], a[112:115], a[48:51], v[120:123]
s_add_u32 m0, s76, 35840
ds_read_b128 a[0:3], v2 offset:0
v_accvgpr_write_b32 a163, v231
v_mfma_f32_16x16x32_bf16 v[104:107], a[112:115], a[40:43], v[104:107]
s_add_u32 s64, s72, 147584
ds_read_b128 a[4:7], v3 offset:0
v_cvt_pk_bf16_f32 v223, v222, v223
v_mfma_f32_16x16x32_bf16 v[104:107], a[116:119], a[44:47], v[104:107]
buffer_load_dwordx4 v13, s[48:51], s64 offen lds
v_mfma_f32_16x16x32_bf16 v[88:91], a[116:119], a[36:39], v[88:91]
ds_read_b128 a[8:11], v2 offset:2048
v_cvt_pk_bf16_f32 v222, v220, v221
v_mfma_f32_16x16x32_bf16 v[88:91], a[112:115], a[32:35], v[88:91]
s_waitcnt lgkmcnt(7)
ds_read_b128 a[12:15], v3 offset:2048
v_cvt_pk_bf16_f32 v220, v216, v217
v_mfma_f32_16x16x32_bf16 v[28:31], a[32:35], a[72:75], v[28:31]
ds_read_b128 a[16:19], v2 offset:4096
v_cvt_pk_bf16_f32 v221, v218, v219
v_mfma_f32_16x16x32_bf16 v[28:31], a[36:39], a[76:79], v[28:31]
ds_read_b128 a[20:23], v3 offset:4096
v_add_u32 v5, 0x8000, v5
v_mfma_f32_16x16x32_bf16 v[44:47], a[44:47], a[76:79], v[44:47]
s_add_u32 m0, s76, 36864
ds_read_b128 a[24:27], v2 offset:6144
v_accvgpr_write_b32 a164, v220
v_mfma_f32_16x16x32_bf16 v[44:47], a[40:43], a[72:75], v[44:47]
s_add_u32 s64, s73, 128
ds_read_b128 a[28:31], v3 offset:6144
v_accvgpr_write_b32 a165, v221
v_mfma_f32_16x16x32_bf16 v[60:63], a[48:51], a[72:75], v[60:63]
buffer_load_dwordx4 v12, s[48:51], s64 offen lds
v_mfma_f32_16x16x32_bf16 v[60:63], a[52:55], a[76:79], v[60:63]
ds_read_b64_tr_b16 a[112:113], v9 offset:49152
v_accvgpr_write_b32 a166, v222
v_mfma_f32_16x16x32_bf16 v[76:79], a[60:63], a[76:79], v[76:79]
ds_read_b64_tr_b16 a[114:115], v9 offset:50176
v_accvgpr_write_b32 a167, v223
v_mfma_f32_16x16x32_bf16 v[76:79], a[56:59], a[72:75], v[76:79]
s_add_u32 s67, s79, 22528
ds_read_b64_tr_b16 a[116:117], v9 offset:57344
v_cvt_pk_bf16_f32 v183, v182, v183
v_mfma_f32_16x16x32_bf16 v[140:143], a[56:59], a[80:83], v[140:143]
ds_read_b64_tr_b16 a[118:119], v9 offset:58368
v_cvt_pk_bf16_f32 v182, v180, v181
v_mfma_f32_16x16x32_bf16 v[140:143], a[60:63], a[84:87], v[140:143]
s_add_u32 m0, s76, 37888
ds_read_b64_tr_b16 a[72:73], v10 offset:49152
v_add_u32 v6, 0x8000, v6
v_mfma_f32_16x16x32_bf16 v[124:127], a[52:55], a[84:87], v[124:127]
s_add_u32 s64, s73, 16512
ds_read_b64_tr_b16 a[74:75], v10 offset:50176
v_cvt_pk_bf16_f32 v180, v176, v177
v_mfma_f32_16x16x32_bf16 v[124:127], a[48:51], a[80:83], v[124:127]
buffer_load_dwordx4 v13, s[48:51], s64 offen lds
v_mfma_f32_16x16x32_bf16 v[108:111], a[40:43], a[80:83], v[108:111]
ds_read_b64_tr_b16 a[76:77], v10 offset:57344
v_cvt_pk_bf16_f32 v181, v178, v179
v_mfma_f32_16x16x32_bf16 v[108:111], a[44:47], a[84:87], v[108:111]
ds_read_b64_tr_b16 a[78:79], v10 offset:58368
v_mfma_f32_16x16x32_bf16 v[92:95], a[36:39], a[84:87], v[92:95]
buffer_store_dwordx4 v[180:183], v16, s[44:47], s67 offen sc1
v_mfma_f32_16x16x32_bf16 v[92:95], a[32:35], a[80:83], v[92:95]
ds_read_b64_tr_b16 a[80:81], v11 offset:49152
v_cvt_pk_bf16_f32 v175, v174, v175
v_mfma_f32_16x16x32_bf16 v[32:35], a[32:35], a[88:91], v[32:35]
s_add_u32 m0, s76, 38912
ds_read_b64_tr_b16 a[82:83], v11 offset:50176
v_cvt_pk_bf16_f32 v174, v172, v173
v_mfma_f32_16x16x32_bf16 v[32:35], a[36:39], a[92:95], v[32:35]
s_add_u32 s64, s73, 131200
ds_read_b64_tr_b16 a[84:85], v11 offset:57344
v_add_u32 v7, 0x8000, v7
v_mfma_f32_16x16x32_bf16 v[48:51], a[44:47], a[92:95], v[48:51]
buffer_load_dwordx4 v12, s[48:51], s64 offen lds
v_mfma_f32_16x16x32_bf16 v[48:51], a[40:43], a[88:91], v[48:51]
ds_read_b64_tr_b16 a[86:87], v11 offset:58368
v_cvt_pk_bf16_f32 v172, v168, v169
v_mfma_f32_16x16x32_bf16 v[64:67], a[48:51], a[88:91], v[64:67]
v_cvt_pk_bf16_f32 v173, v170, v171
v_accvgpr_write_b32 a168, v172
v_mfma_f32_16x16x32_bf16 v[64:67], a[52:55], a[92:95], v[64:67]
v_accvgpr_write_b32 a169, v173
v_accvgpr_write_b32 a170, v174
v_mfma_f32_16x16x32_bf16 v[80:83], a[60:63], a[92:95], v[80:83]
v_accvgpr_write_b32 a171, v175
v_cvt_pk_bf16_f32 v167, v166, v167
v_mfma_f32_16x16x32_bf16 v[80:83], a[56:59], a[88:91], v[80:83]
s_add_u32 m0, s76, 39936
v_cvt_pk_bf16_f32 v166, v164, v165
v_cvt_pk_bf16_f32 v164, v160, v161
v_mfma_f32_16x16x32_bf16 v[144:147], a[56:59], a[96:99], v[144:147]
s_add_u32 s64, s73, 147584
v_cvt_pk_bf16_f32 v165, v162, v163
v_accvgpr_write_b32 a172, v164
v_mfma_f32_16x16x32_bf16 v[144:147], a[60:63], a[100:103], v[144:147]
buffer_load_dwordx4 v13, s[48:51], s64 offen lds
v_mfma_f32_16x16x32_bf16 v[128:131], a[52:55], a[100:103], v[128:131]
v_add_u32 v8, 0x8000, v8
v_accvgpr_write_b32 a173, v165
v_mfma_f32_16x16x32_bf16 v[128:131], a[48:51], a[96:99], v[128:131]
v_accvgpr_write_b32 a174, v166
v_accvgpr_write_b32 a175, v167
v_mfma_f32_16x16x32_bf16 v[112:115], a[40:43], a[96:99], v[112:115]
v_cvt_pk_bf16_f32 v159, v158, v159
v_cvt_pk_bf16_f32 v158, v156, v157
v_mfma_f32_16x16x32_bf16 v[112:115], a[44:47], a[100:103], v[112:115]
v_cvt_pk_bf16_f32 v156, v152, v153
v_cvt_pk_bf16_f32 v157, v154, v155
v_mfma_f32_16x16x32_bf16 v[96:99], a[36:39], a[100:103], v[96:99]
v_add_u32 v9, 0x8000, v9
v_add_u32 v10, 0x8000, v10
v_mfma_f32_16x16x32_bf16 v[96:99], a[32:35], a[96:99], v[96:99]
s_waitcnt lgkmcnt(0)
v_add_u32 v11, 0x8000, v11
v_accvgpr_write_b32 a176, v156
v_mfma_f32_16x16x32_bf16 v[36:39], a[32:35], a[104:107], v[36:39]
v_accvgpr_write_b32 a177, v157
v_accvgpr_write_b32 a178, v158
v_mfma_f32_16x16x32_bf16 v[36:39], a[36:39], a[108:111], v[36:39]
v_accvgpr_write_b32 a179, v159
v_mfma_f32_16x16x32_bf16 v[52:55], a[44:47], a[108:111], v[52:55]
s_add_u32 s67, s79, 23552
s_waitcnt lgkmcnt(0)
s_barrier
v_mfma_f32_16x16x32_bf16 v[52:55], a[40:43], a[104:107], v[52:55]
s_add_u32 m0, s77, 98304
ds_read_b64_tr_b16 a[88:89], v19 offset:36864
v_cvt_pk_bf16_f32 v139, v138, v139
v_mfma_f32_16x16x32_bf16 v[68:71], a[48:51], a[104:107], v[68:71]
s_add_u32 s64, s71, 1048576
ds_read_b64_tr_b16 a[90:91], v19 offset:37120
v_cvt_pk_bf16_f32 v138, v136, v137
v_mfma_f32_16x16x32_bf16 v[68:71], a[52:55], a[108:111], v[68:71]
buffer_load_dwordx4 v14, s[56:59], s64 offen lds
v_mfma_f32_16x16x32_bf16 v[84:87], a[60:63], a[108:111], v[84:87]
ds_read_b64_tr_b16 a[92:93], v19 offset:38912
v_cvt_pk_bf16_f32 v136, v72, v73
v_mfma_f32_16x16x32_bf16 v[84:87], a[56:59], a[104:107], v[84:87]
ds_read_b64_tr_b16 a[94:95], v19 offset:39168
v_cvt_pk_bf16_f32 v137, v74, v75
v_mfma_f32_16x16x32_bf16 v[148:151], a[56:59], a[112:115], v[148:151]
ds_read_b64_tr_b16 a[96:97], v20 offset:36864
v_mfma_f32_16x16x32_bf16 v[148:151], a[60:63], a[116:119], v[148:151]
ds_read_b64_tr_b16 a[98:99], v20 offset:37120
v_mfma_f32_16x16x32_bf16 v[132:135], a[52:55], a[116:119], v[132:135]
ds_read_b64_tr_b16 a[100:101], v20 offset:38912
v_mfma_f32_16x16x32_bf16 v[132:135], a[48:51], a[112:115], v[132:135]
ds_read_b64_tr_b16 a[102:103], v20 offset:39168
v_mfma_f32_16x16x32_bf16 v[116:119], a[40:43], a[112:115], v[116:119]
s_add_u32 m0, s78, 114688
ds_read_b64_tr_b16 a[104:105], v19 offset:40960
v_mfma_f32_16x16x32_bf16 v[116:119], a[44:47], a[116:119], v[116:119]
s_add_u32 s64, s75, 786432
ds_read_b64_tr_b16 a[106:107], v19 offset:41216
v_mfma_f32_16x16x32_bf16 v[100:103], a[36:39], a[116:119], v[100:103]
buffer_load_dwordx4 v23, s[60:63], s64 offen lds
v_mfma_f32_16x16x32_bf16 v[100:103], a[32:35], a[112:115], v[100:103]
ds_read_b64_tr_b16 a[108:109], v19 offset:43008
v_mfma_f32_16x16x32_bf16 v[248:251], a[32:35], a[72:75], v[248:251]
ds_read_b64_tr_b16 a[110:111], v19 offset:43264
v_mfma_f32_16x16x32_bf16 v[248:251], a[36:39], a[76:79], v[248:251]
ds_read_b64_tr_b16 a[112:113], v20 offset:40960
v_mfma_f32_16x16x32_bf16 v[252:255], a[44:47], a[76:79], v[252:255]
ds_read_b64_tr_b16 a[114:115], v20 offset:41216
v_mfma_f32_16x16x32_bf16 v[252:255], a[40:43], a[72:75], v[252:255]
ds_read_b64_tr_b16 a[116:117], v20 offset:43008
v_mfma_f32_16x16x32_bf16 a[120:123], a[48:51], a[72:75], a[120:123]
ds_read_b64_tr_b16 a[118:119], v20 offset:43264
v_mfma_f32_16x16x32_bf16 a[120:123], a[52:55], a[76:79], a[120:123]
s_add_u32 m0, s77, 99328
buffer_store_dwordx4 v[136:139], v16, s[44:47], s67 offen sc1
v_mfma_f32_16x16x32_bf16 a[124:127], a[60:63], a[76:79], a[124:127]
s_add_u32 s64, s71, 1081344
v_cvt_pk_bf16_f32 v123, v122, v123
v_cvt_pk_bf16_f32 v122, v120, v121
v_mfma_f32_16x16x32_bf16 a[124:127], a[56:59], a[72:75], a[124:127]
buffer_load_dwordx4 v14, s[56:59], s64 offen lds
v_mfma_f32_16x16x32_bf16 a[128:131], a[56:59], a[80:83], a[128:131]
ds_read_b64_tr_b16 a[72:73], v19 offset:32768
v_cvt_pk_bf16_f32 v120, v56, v57
v_mfma_f32_16x16x32_bf16 a[128:131], a[60:63], a[84:87], a[128:131]
ds_read_b64_tr_b16 a[74:75], v19 offset:33024
v_cvt_pk_bf16_f32 v121, v58, v59
v_mfma_f32_16x16x32_bf16 a[132:135], a[52:55], a[84:87], a[132:135]
ds_read_b64_tr_b16 a[76:77], v19 offset:34816
v_accvgpr_write_b32 a180, v120
v_mfma_f32_16x16x32_bf16 a[132:135], a[48:51], a[80:83], a[132:135]
ds_read_b64_tr_b16 a[78:79], v19 offset:35072
v_accvgpr_write_b32 a181, v121
v_mfma_f32_16x16x32_bf16 a[136:139], a[40:43], a[80:83], a[136:139]
v_accvgpr_write_b32 a182, v122
v_accvgpr_write_b32 a183, v123
v_mfma_f32_16x16x32_bf16 a[136:139], a[44:47], a[84:87], a[136:139]
v_cvt_pk_bf16_f32 v107, v106, v107
v_cvt_pk_bf16_f32 v106, v104, v105
v_mfma_f32_16x16x32_bf16 a[140:143], a[36:39], a[84:87], a[140:143]
s_add_u32 m0, s78, 118784
v_cvt_pk_bf16_f32 v104, v40, v41
v_cvt_pk_bf16_f32 v105, v42, v43
v_mfma_f32_16x16x32_bf16 a[140:143], a[32:35], a[80:83], a[140:143]
s_waitcnt lgkmcnt(4)
s_add_u32 s64, s75, 788480
ds_read_b64_tr_b16 a[80:81], v20 offset:32768
v_accvgpr_write_b32 a184, v104
v_mfma_f32_16x16x32_bf16 v[184:187], a[88:91], a[0:3], 0
buffer_load_dwordx4 v23, s[60:63], s64 offen lds
v_mfma_f32_16x16x32_bf16 v[184:187], a[92:95], a[4:7], v[184:187]
ds_read_b64_tr_b16 a[82:83], v20 offset:33024
v_accvgpr_write_b32 a185, v105
v_mfma_f32_16x16x32_bf16 v[192:195], a[92:95], a[12:15], 0
ds_read_b64_tr_b16 a[84:85], v20 offset:34816
v_accvgpr_write_b32 a186, v106
v_mfma_f32_16x16x32_bf16 v[192:195], a[88:91], a[8:11], v[192:195]
s_add_u32 s17, s78, .-L_pc+6144
ds_read_b64_tr_b16 a[86:87], v20 offset:35072
v_accvgpr_write_b32 a187, v107
v_mfma_f32_16x16x32_bf16 v[200:203], a[88:91], a[16:19], 0
buffer_load_dword a252, v16, s[88:91], s17 offen
v_mfma_f32_16x16x32_bf16 v[200:203], a[92:95], a[20:23], v[200:203]
v_cvt_pk_bf16_f32 v91, v90, v91
v_cvt_pk_bf16_f32 v90, v88, v89
v_mfma_f32_16x16x32_bf16 v[208:211], a[92:95], a[28:31], 0
v_cvt_pk_bf16_f32 v88, v24, v25
v_cvt_pk_bf16_f32 v89, v26, v27
v_mfma_f32_16x16x32_bf16 v[208:211], a[88:91], a[24:27], v[208:211]
ds_read_b64_tr_b16 a[88:89], v4 offset:32768
v_accvgpr_write_b32 a188, v88
v_mfma_f32_16x16x32_bf16 v[212:215], a[96:99], a[24:27], 0
s_add_u32 m0, s77, 100352
ds_read_b64_tr_b16 a[90:91], v4 offset:33792
v_accvgpr_write_b32 a189, v89
v_mfma_f32_16x16x32_bf16 v[212:215], a[100:103], a[28:31], v[212:215]
s_add_u32 s64, s71, 1114112
ds_read_b64_tr_b16 a[92:93], v4 offset:40960
v_accvgpr_write_b32 a190, v90
v_mfma_f32_16x16x32_bf16 v[204:207], a[100:103], a[20:23], 0
buffer_load_dwordx4 v15, s[56:59], s64 offen lds
v_mfma_f32_16x16x32_bf16 v[204:207], a[96:99], a[16:19], v[204:207]
ds_read_b64_tr_b16 a[94:95], v4 offset:41984
v_accvgpr_write_b32 a191, v91
v_mfma_f32_16x16x32_bf16 v[196:199], a[96:99], a[8:11], 0
s_add_u32 s67, s79, 8192
v_cvt_pk_bf16_f32 v47, v46, v47
v_cvt_pk_bf16_f32 v46, v44, v45
v_mfma_f32_16x16x32_bf16 v[196:199], a[100:103], a[12:15], v[196:199]
v_cvt_pk_bf16_f32 v44, v28, v29
v_cvt_pk_bf16_f32 v45, v30, v31
v_mfma_f32_16x16x32_bf16 v[188:191], a[100:103], a[4:7], 0
buffer_store_dwordx4 v[44:47], v16, s[44:47], s67 offen sc1
v_mfma_f32_16x16x32_bf16 v[188:191], a[96:99], a[0:3], v[188:191]
ds_read_b64_tr_b16 a[96:97], v5 offset:32768
v_cvt_pk_bf16_f32 v79, v78, v79
v_mfma_f32_16x16x32_bf16 v[216:219], a[0:3], a[104:107], 0
ds_read_b64_tr_b16 a[98:99], v5 offset:33792
v_cvt_pk_bf16_f32 v78, v76, v77
v_mfma_f32_16x16x32_bf16 v[216:219], a[4:7], a[108:111], v[216:219]
s_add_u32 m0, s78, 122880
ds_read_b64_tr_b16 a[100:101], v5 offset:40960
v_cvt_pk_bf16_f32 v76, v60, v61
v_mfma_f32_16x16x32_bf16 v[224:227], a[12:15], a[108:111], 0
s_add_u32 s64, s75, 790528
ds_read_b64_tr_b16 a[102:103], v5 offset:41984
v_cvt_pk_bf16_f32 v77, v62, v63
v_mfma_f32_16x16x32_bf16 v[224:227], a[8:11], a[104:107], v[224:227]
buffer_load_dwordx4 v23, s[60:63], s64 offen lds
v_mfma_f32_16x16x32_bf16 v[232:235], a[16:19], a[104:107], 0
v_accvgpr_write_b32 a192, v76
v_accvgpr_write_b32 a193, v77
v_mfma_f32_16x16x32_bf16 v[232:235], a[20:23], a[108:111], v[232:235]
v_accvgpr_write_b32 a194, v78
v_accvgpr_write_b32 a195, v79
v_mfma_f32_16x16x32_bf16 v[240:243], a[28:31], a[108:111], 0
v_cvt_pk_bf16_f32 v124, v124, v125
v_cvt_pk_bf16_f32 v125, v126, v127
v_mfma_f32_16x16x32_bf16 v[240:243], a[24:27], a[104:107], v[240:243]
ds_read_b64_tr_b16 a[104:105], v6 offset:32768
v_cvt_pk_bf16_f32 v126, v140, v141
v_mfma_f32_16x16x32_bf16 v[244:247], a[24:27], a[112:115], 0
ds_read_b64_tr_b16 a[106:107], v6 offset:33792
v_cvt_pk_bf16_f32 v127, v142, v143
v_mfma_f32_16x16x32_bf16 v[244:247], a[28:31], a[116:119], v[244:247]
ds_read_b64_tr_b16 a[108:109], v6 offset:40960
v_accvgpr_write_b32 a196, v124
v_mfma_f32_16x16x32_bf16 v[236:239], a[20:23], a[116:119], 0
s_add_u32 m0, s77, 101376
ds_read_b64_tr_b16 a[110:111], v6 offset:41984
v_accvgpr_write_b32 a197, v125
v_mfma_f32_16x16x32_bf16 v[236:239], a[16:19], a[112:115], v[236:239]
s_add_u32 s64, s71, 1146880
v_accvgpr_write_b32 a198, v126
v_accvgpr_write_b32 a199, v127
v_mfma_f32_16x16x32_bf16 v[228:231], a[8:11], a[112:115], 0
buffer_load_dwordx4 v15, s[56:59], s64 offen lds
v_mfma_f32_16x16x32_bf16 v[228:231], a[12:15], a[116:119], v[228:231]
v_cvt_pk_bf16_f32 v92, v92, v93
v_cvt_pk_bf16_f32 v93, v94, v95
v_mfma_f32_16x16x32_bf16 v[220:223], a[4:7], a[116:119], 0
v_cvt_pk_bf16_f32 v94, v108, v109
v_cvt_pk_bf16_f32 v95, v110, v111
v_mfma_f32_16x16x32_bf16 v[220:223], a[0:3], a[112:115], v[220:223]
s_waitcnt lgkmcnt(4)
ds_read_b64_tr_b16 a[112:113], v7 offset:32768
v_accvgpr_write_b32 a200, v92
v_mfma_f32_16x16x32_bf16 v[152:155], a[72:75], a[0:3], 0
ds_read_b64_tr_b16 a[114:115], v7 offset:33792
v_accvgpr_write_b32 a201, v93
v_mfma_f32_16x16x32_bf16 v[152:155], a[76:79], a[4:7], v[152:155]
ds_read_b64_tr_b16 a[116:117], v7 offset:40960
v_accvgpr_write_b32 a202, v94
v_mfma_f32_16x16x32_bf16 v[160:163], a[76:79], a[12:15], 0
ds_read_b64_tr_b16 a[118:119], v7 offset:41984
v_accvgpr_write_b32 a203, v95
v_mfma_f32_16x16x32_bf16 v[160:163], a[72:75], a[8:11], v[160:163]
s_add_u32 s67, s79, 10240
v_cvt_pk_bf16_f32 v51, v50, v51
v_cvt_pk_bf16_f32 v50, v48, v49
v_mfma_f32_16x16x32_bf16 v[168:171], a[72:75], a[16:19], 0
v_cvt_pk_bf16_f32 v48, v32, v33
v_cvt_pk_bf16_f32 v49, v34, v35
v_mfma_f32_16x16x32_bf16 v[168:171], a[76:79], a[20:23], v[168:171]
buffer_store_dwordx4 v[48:51], v16, s[44:47], s67 offen sc1
v_mfma_f32_16x16x32_bf16 v[176:179], a[76:79], a[28:31], 0
s_add_u32 m0, s76, 0
v_subrev_u32 v19, 0x8000, v19
v_subrev_u32 v20, 0x8000, v20
v_mfma_f32_16x16x32_bf16 v[176:179], a[72:75], a[24:27], v[176:179]
s_add_u32 s64, s72, 256
ds_read_b64_tr_b16 a[72:73], v8 offset:32768
v_cvt_pk_bf16_f32 v83, v82, v83
v_mfma_f32_16x16x32_bf16 v[180:183], a[80:83], a[24:27], 0
buffer_load_dwordx4 v12, s[48:51], s64 offen lds
v_mfma_f32_16x16x32_bf16 v[180:183], a[84:87], a[28:31], v[180:183]
ds_read_b64_tr_b16 a[74:75], v8 offset:33792
v_subrev_u32 v4, 0x8000, v4
v_mfma_f32_16x16x32_bf16 v[172:175], a[84:87], a[20:23], 0
ds_read_b64_tr_b16 a[76:77], v8 offset:40960
v_cvt_pk_bf16_f32 v82, v80, v81
v_mfma_f32_16x16x32_bf16 v[172:175], a[80:83], a[16:19], v[172:175]
s_add_u32 m0, s76, 1024
ds_read_b64_tr_b16 a[78:79], v8 offset:41984
v_cvt_pk_bf16_f32 v80, v64, v65
v_mfma_f32_16x16x32_bf16 v[164:167], a[80:83], a[8:11], 0
s_add_u32 s64, s72, 16640
v_cvt_pk_bf16_f32 v81, v66, v67
v_accvgpr_write_b32 a204, v80
v_mfma_f32_16x16x32_bf16 v[164:167], a[84:87], a[12:15], v[164:167]
buffer_load_dwordx4 v13, s[48:51], s64 offen lds
v_mfma_f32_16x16x32_bf16 v[156:159], a[84:87], a[4:7], 0
v_accvgpr_write_b32 a205, v81
v_accvgpr_write_b32 a206, v82
v_mfma_f32_16x16x32_bf16 v[156:159], a[80:83], a[0:3], v[156:159]
ds_read_b64_tr_b16 a[80:81], v9 offset:32768
v_accvgpr_write_b32 a207, v83
v_mfma_f32_16x16x32_bf16 v[24:27], a[88:91], a[0:3], 0
s_add_u32 m0, s76, 2048
ds_read_b64_tr_b16 a[82:83], v9 offset:33792
v_cvt_pk_bf16_f32 v128, v128, v129
v_mfma_f32_16x16x32_bf16 v[24:27], a[92:95], a[4:7], v[24:27]
s_add_u32 s64, s72, 131328
ds_read_b64_tr_b16 a[84:85], v9 offset:40960
v_subrev_u32 v5, 0x8000, v5
v_mfma_f32_16x16x32_bf16 v[40:43], a[92:95], a[12:15], 0
buffer_load_dwordx4 v12, s[48:51], s64 offen lds
v_mfma_f32_16x16x32_bf16 v[40:43], a[88:91], a[8:11], v[40:43]
ds_read_b64_tr_b16 a[86:87], v9 offset:41984
v_cvt_pk_bf16_f32 v129, v130, v131
v_mfma_f32_16x16x32_bf16 v[56:59], a[88:91], a[16:19], 0
s_add_u32 m0, s76, 3072
v_cvt_pk_bf16_f32 v130, v144, v145
v_cvt_pk_bf16_f32 v131, v146, v147
v_mfma_f32_16x16x32_bf16 v[56:59], a[92:95], a[20:23], v[56:59]
s_add_u32 s64, s72, 147712
v_accvgpr_write_b32 a208, v128
v_accvgpr_write_b32 a209, v129
v_mfma_f32_16x16x32_bf16 v[72:75], a[92:95], a[28:31], 0
s_waitcnt vmcnt(14)
ds_read_b128 a[32:35], v2 offset:32768
v_accvgpr_write_b32 a210, v130
v_mfma_f32_16x16x32_bf16 v[72:75], a[88:91], a[24:27], v[72:75]
buffer_load_dwordx4 v13, s[48:51], s64 offen lds
v_mfma_f32_16x16x32_bf16 v[136:139], a[96:99], a[24:27], 0
ds_read_b128 a[36:39], v3 offset:32768
v_accvgpr_write_b32 a211, v131
v_mfma_f32_16x16x32_bf16 v[136:139], a[100:103], a[28:31], v[136:139]
ds_read_b128 a[40:43], v2 offset:34816
v_subrev_u32 v6, 0x8000, v6
v_mfma_f32_16x16x32_bf16 v[120:123], a[100:103], a[20:23], 0
s_add_u32 m0, s76, 4096
ds_read_b128 a[44:47], v3 offset:34816
v_cvt_pk_bf16_f32 v96, v96, v97
v_mfma_f32_16x16x32_bf16 v[120:123], a[96:99], a[16:19], v[120:123]
s_add_u32 s64, s73, 256
ds_read_b128 a[48:51], v2 offset:36864
v_cvt_pk_bf16_f32 v97, v98, v99
v_mfma_f32_16x16x32_bf16 v[104:107], a[96:99], a[8:11], 0
buffer_load_dwordx4 v12, s[48:51], s64 offen lds
v_mfma_f32_16x16x32_bf16 v[104:107], a[100:103], a[12:15], v[104:107]
ds_read_b128 a[52:55], v3 offset:36864
v_cvt_pk_bf16_f32 v98, v112, v113
v_mfma_f32_16x16x32_bf16 v[88:91], a[100:103], a[4:7], 0
ds_read_b128 a[56:59], v2 offset:38912
v_cvt_pk_bf16_f32 v99, v114, v115
v_mfma_f32_16x16x32_bf16 v[88:91], a[96:99], a[0:3], v[88:91]
s_waitcnt lgkmcnt(7)
s_add_u32 m0, s76, 5120
ds_read_b128 a[60:63], v3 offset:38912
v_accvgpr_write_b32 a212, v96
v_mfma_f32_16x16x32_bf16 v[28:31], a[104:107], a[0:3], 0
s_add_u32 s64, s73, 16640
ds_read_b64_tr_b16 a[88:89], v10 offset:32768
v_accvgpr_write_b32 a213, v97
v_mfma_f32_16x16x32_bf16 v[28:31], a[108:111], a[4:7], v[28:31]
buffer_load_dwordx4 v13, s[48:51], s64 offen lds
v_mfma_f32_16x16x32_bf16 v[44:47], a[108:111], a[12:15], 0
ds_read_b64_tr_b16 a[90:91], v10 offset:33792
v_subrev_u32 v7, 0x8000, v7
v_mfma_f32_16x16x32_bf16 v[44:47], a[104:107], a[8:11], v[44:47]
s_add_u32 m0, s76, 6144
ds_read_b64_tr_b16 a[92:93], v10 offset:40960
v_accvgpr_write_b32 a214, v98
v_mfma_f32_16x16x32_bf16 v[60:63], a[104:107], a[16:19], 0
s_add_u32 s64, s73, 131328
ds_read_b64_tr_b16 a[94:95], v10 offset:41984
v_accvgpr_write_b32 a215, v99
v_mfma_f32_16x16x32_bf16 v[60:63], a[108:111], a[20:23], v[60:63]
s_add_u32 s67, s79, 12288
ds_read_b64_tr_b16 a[96:97], v11 offset:32768
v_cvt_pk_bf16_f32 v55, v54, v55
v_mfma_f32_16x16x32_bf16 v[76:79], a[108:111], a[28:31], 0
buffer_load_dwordx4 v12, s[48:51], s64 offen lds
v_mfma_f32_16x16x32_bf16 v[76:79], a[104:107], a[24:27], v[76:79]
ds_read_b64_tr_b16 a[98:99], v11 offset:33792
v_cvt_pk_bf16_f32 v54, v52, v53
v_mfma_f32_16x16x32_bf16 v[140:143], a[112:115], a[24:27], 0
ds_read_b64_tr_b16 a[100:101], v11 offset:40960
v_cvt_pk_bf16_f32 v52, v36, v37
v_mfma_f32_16x16x32_bf16 v[140:143], a[116:119], a[28:31], v[140:143]
s_add_u32 m0, s76, 7168
ds_read_b64_tr_b16 a[102:103], v11 offset:41984
v_subrev_u32 v8, 0x8000, v8
v_mfma_f32_16x16x32_bf16 v[124:127], a[116:119], a[20:23], 0
s_add_u32 s64, s73, 147712
v_cvt_pk_bf16_f32 v53, v38, v39
v_mfma_f32_16x16x32_bf16 v[124:127], a[112:115], a[16:19], v[124:127]
buffer_load_dwordx4 v13, s[48:51], s64 offen lds
v_mfma_f32_16x16x32_bf16 v[108:111], a[112:115], a[8:11], 0
buffer_store_dwordx4 v[52:55], v16, s[44:47], s67 offen sc1
v_mfma_f32_16x16x32_bf16 v[108:111], a[116:119], a[12:15], v[108:111]
v_cvt_pk_bf16_f32 v87, v86, v87
v_cvt_pk_bf16_f32 v86, v84, v85
v_mfma_f32_16x16x32_bf16 v[92:95], a[116:119], a[4:7], 0
v_subrev_u32 v9, 0x8000, v9
v_subrev_u32 v10, 0x8000, v10
v_mfma_f32_16x16x32_bf16 v[92:95], a[112:115], a[0:3], v[92:95]
v_subrev_u32 v11, 0x8000, v11
v_cvt_pk_bf16_f32 v84, v68, v69
v_mfma_f32_16x16x32_bf16 v[32:35], a[72:75], a[0:3], 0
v_cvt_pk_bf16_f32 v85, v70, v71
v_accvgpr_write_b32 a216, v84
v_mfma_f32_16x16x32_bf16 v[32:35], a[76:79], a[4:7], v[32:35]
v_accvgpr_write_b32 a217, v85
v_accvgpr_write_b32 a218, v86
v_mfma_f32_16x16x32_bf16 v[48:51], a[76:79], a[12:15], 0
s_waitcnt lgkmcnt(0)
s_barrier
v_mfma_f32_16x16x32_bf16 v[48:51], a[72:75], a[8:11], v[48:51]
s_add_u32 m0, s77, 131072
ds_read_b64_tr_b16 a[104:105], v19 offset:4096
v_accvgpr_write_b32 a219, v87
v_mfma_f32_16x16x32_bf16 v[64:67], a[72:75], a[16:19], 0
s_add_u32 s64, s71, 1572864
ds_read_b64_tr_b16 a[106:107], v19 offset:4352
v_cvt_pk_bf16_f32 v132, v132, v133
v_mfma_f32_16x16x32_bf16 v[64:67], a[76:79], a[20:23], v[64:67]
buffer_load_dwordx4 v14, s[56:59], s64 offen lds
v_mfma_f32_16x16x32_bf16 v[80:83], a[76:79], a[28:31], 0
ds_read_b64_tr_b16 a[108:109], v19 offset:6144
v_cvt_pk_bf16_f32 v133, v134, v135
v_mfma_f32_16x16x32_bf16 v[80:83], a[72:75], a[24:27], v[80:83]
ds_read_b64_tr_b16 a[110:111], v19 offset:6400
v_cvt_pk_bf16_f32 v134, v148, v149
v_mfma_f32_16x16x32_bf16 v[144:147], a[80:83], a[24:27], 0
ds_read_b64_tr_b16 a[112:113], v20 offset:4096
v_cvt_pk_bf16_f32 v135, v150, v151
v_mfma_f32_16x16x32_bf16 v[144:147], a[84:87], a[28:31], v[144:147]
ds_read_b64_tr_b16 a[114:115], v20 offset:4352
v_accvgpr_write_b32 a220, v132
v_mfma_f32_16x16x32_bf16 v[128:131], a[84:87], a[20:23], 0
ds_read_b64_tr_b16 a[116:117], v20 offset:6144
v_accvgpr_write_b32 a221, v133
v_mfma_f32_16x16x32_bf16 v[128:131], a[80:83], a[16:19], v[128:131]
ds_read_b64_tr_b16 a[118:119], v20 offset:6400
v_accvgpr_write_b32 a222, v134
v_mfma_f32_16x16x32_bf16 v[112:115], a[80:83], a[8:11], 0
s_add_u32 m0, s78, 147456
ds_read_b64_tr_b16 a[72:73], v19 offset:8192
v_accvgpr_write_b32 a223, v135
v_mfma_f32_16x16x32_bf16 v[112:115], a[84:87], a[12:15], v[112:115]
s_add_u32 s64, s75, 1179648
ds_read_b64_tr_b16 a[74:75], v19 offset:8448
v_cvt_pk_bf16_f32 v100, v100, v101
v_mfma_f32_16x16x32_bf16 v[96:99], a[84:87], a[4:7], 0
buffer_load_dwordx4 v23, s[60:63], s64 offen lds
v_mfma_f32_16x16x32_bf16 v[96:99], a[80:83], a[0:3], v[96:99]
ds_read_b64_tr_b16 a[76:77], v19 offset:10240
v_cvt_pk_bf16_f32 v101, v102, v103
v_mfma_f32_16x16x32_bf16 v[36:39], a[88:91], a[0:3], 0
ds_read_b64_tr_b16 a[78:79], v19 offset:10496
v_cvt_pk_bf16_f32 v102, v116, v117
v_mfma_f32_16x16x32_bf16 v[36:39], a[92:95], a[4:7], v[36:39]
ds_read_b64_tr_b16 a[80:81], v20 offset:8192
v_cvt_pk_bf16_f32 v103, v118, v119
v_mfma_f32_16x16x32_bf16 v[52:55], a[92:95], a[12:15], 0
ds_read_b64_tr_b16 a[82:83], v20 offset:8448
v_accvgpr_write_b32 a224, v100
v_mfma_f32_16x16x32_bf16 v[52:55], a[88:91], a[8:11], v[52:55]
ds_read_b64_tr_b16 a[84:85], v20 offset:10240
v_accvgpr_write_b32 a225, v101
v_mfma_f32_16x16x32_bf16 v[68:71], a[88:91], a[16:19], 0
s_add_u32 m0, s77, 132096
ds_read_b64_tr_b16 a[86:87], v20 offset:10496
v_accvgpr_write_b32 a226, v102
v_mfma_f32_16x16x32_bf16 v[68:71], a[92:95], a[20:23], v[68:71]
s_add_u32 s64, s71, 1605632
s_xor_b32 s68, s66, 0
v_accvgpr_write_b32 a227, v103
v_mfma_f32_16x16x32_bf16 v[84:87], a[92:95], a[28:31], 0
s_add_u32 s67, s79, 14336
s_mov_b64 exec, 1
buffer_atomic_add a251, v1, s[52:55], s68 offen offset:0 sc1
s_mov_b64 exec, -1
v_mfma_f32_16x16x32_bf16 v[84:87], a[88:91], a[24:27], v[84:87]
buffer_load_dwordx4 v14, s[56:59], s64 offen lds
v_mfma_f32_16x16x32_bf16 v[148:151], a[96:99], a[24:27], 0
ds_read_b64_tr_b16 a[88:89], v19 offset:0
v_cvt_pk_bf16_f32 v255, v254, v255
v_mfma_f32_16x16x32_bf16 v[148:151], a[100:103], a[28:31], v[148:151]
ds_read_b64_tr_b16 a[90:91], v19 offset:256
v_cvt_pk_bf16_f32 v254, v252, v253
v_mfma_f32_16x16x32_bf16 v[132:135], a[100:103], a[20:23], 0
ds_read_b64_tr_b16 a[92:93], v19 offset:2048
v_cvt_pk_bf16_f32 v252, v248, v249
v_mfma_f32_16x16x32_bf16 v[132:135], a[96:99], a[16:19], v[132:135]
s_add_u32 s65, s79, 16384
ds_read_b64_tr_b16 a[94:95], v19 offset:2304
v_cvt_pk_bf16_f32 v253, v250, v251
v_mfma_f32_16x16x32_bf16 v[116:119], a[96:99], a[8:11], 0
buffer_store_dwordx4 a[144:147], v16, s[44:47], s65 offen sc1
v_mfma_f32_16x16x32_bf16 v[116:119], a[100:103], a[12:15], v[116:119]
buffer_store_dwordx4 v[252:255], v16, s[44:47], s67 offen sc1
v_mfma_f32_16x16x32_bf16 v[100:103], a[100:103], a[4:7], 0
s_add_u32 m0, s78, 151552
v_mfma_f32_16x16x32_bf16 v[100:103], a[96:99], a[0:3], v[100:103]
s_waitcnt lgkmcnt(4)
s_add_u32 s64, s75, 1181696
ds_read_b64_tr_b16 a[96:97], v20 offset:0
v_accvgpr_read_b32 v248, a120
v_mfma_f32_16x16x32_bf16 v[184:187], a[104:107], a[32:35], v[184:187]
buffer_load_dwordx4 v23, s[60:63], s64 offen lds
v_mfma_f32_16x16x32_bf16 v[184:187], a[108:111], a[36:39], v[184:187]
ds_read_b64_tr_b16 a[98:99], v20 offset:256
v_accvgpr_read_b32 v249, a121
v_mfma_f32_16x16x32_bf16 v[192:195], a[108:111], a[44:47], v[192:195]
ds_read_b64_tr_b16 a[100:101], v20 offset:2048
v_accvgpr_read_b32 v250, a122
v_mfma_f32_16x16x32_bf16 v[192:195], a[104:107], a[40:43], v[192:195]
ds_read_b64_tr_b16 a[102:103], v20 offset:2304
v_accvgpr_read_b32 v251, a123
v_mfma_f32_16x16x32_bf16 v[200:203], a[104:107], a[48:51], v[200:203]
v_accvgpr_read_b32 v252, a124
v_accvgpr_read_b32 v253, a125
v_mfma_f32_16x16x32_bf16 v[200:203], a[108:111], a[52:55], v[200:203]
v_accvgpr_read_b32 v254, a126
v_accvgpr_read_b32 v255, a127
v_mfma_f32_16x16x32_bf16 v[208:211], a[108:111], a[60:63], v[208:211]
v_cvt_pk_bf16_f32 v255, v254, v255
v_cvt_pk_bf16_f32 v254, v252, v253
v_mfma_f32_16x16x32_bf16 v[208:211], a[104:107], a[56:59], v[208:211]
ds_read_b64_tr_b16 a[104:105], v4 offset:0
v_cvt_pk_bf16_f32 v252, v248, v249
v_mfma_f32_16x16x32_bf16 v[212:215], a[112:115], a[56:59], v[212:215]
s_add_u32 m0, s77, 133120
ds_read_b64_tr_b16 a[106:107], v4 offset:1024
v_cvt_pk_bf16_f32 v253, v250, v251
v_mfma_f32_16x16x32_bf16 v[212:215], a[116:119], a[60:63], v[212:215]
s_add_u32 s64, s71, 1638400
ds_read_b64_tr_b16 a[108:109], v4 offset:8192
v_accvgpr_write_b32 a228, v252
v_mfma_f32_16x16x32_bf16 v[204:207], a[116:119], a[52:55], v[204:207]
buffer_load_dwordx4 v15, s[56:59], s64 offen lds
v_mfma_f32_16x16x32_bf16 v[204:207], a[112:115], a[48:51], v[204:207]
ds_read_b64_tr_b16 a[110:111], v4 offset:9216
v_accvgpr_write_b32 a229, v253
v_mfma_f32_16x16x32_bf16 v[196:199], a[112:115], a[40:43], v[196:199]
v_accvgpr_write_b32 a230, v254
v_accvgpr_write_b32 a231, v255
v_mfma_f32_16x16x32_bf16 v[196:199], a[116:119], a[44:47], v[196:199]
v_mfma_f32_16x16x32_bf16 v[188:191], a[116:119], a[36:39], v[188:191]
v_accvgpr_read_b32 v248, a132
v_accvgpr_read_b32 v249, a133
v_mfma_f32_16x16x32_bf16 v[188:191], a[112:115], a[32:35], v[188:191]
ds_read_b64_tr_b16 a[112:113], v5 offset:0
v_accvgpr_read_b32 v250, a134
v_mfma_f32_16x16x32_bf16 v[216:219], a[32:35], a[72:75], v[216:219]
ds_read_b64_tr_b16 a[114:115], v5 offset:1024
v_accvgpr_read_b32 v251, a135
v_mfma_f32_16x16x32_bf16 v[216:219], a[36:39], a[76:79], v[216:219]
s_add_u32 m0, s78, 155648
ds_read_b64_tr_b16 a[116:117], v5 offset:8192
v_accvgpr_read_b32 v252, a128
v_mfma_f32_16x16x32_bf16 v[224:227], a[44:47], a[76:79], v[224:227]
s_add_u32 s64, s75, 1183744
ds_read_b64_tr_b16 a[118:119], v5 offset:9216
v_accvgpr_read_b32 v253, a129
v_mfma_f32_16x16x32_bf16 v[224:227], a[40:43], a[72:75], v[224:227]
buffer_load_dwordx4 v23, s[60:63], s64 offen lds
v_mfma_f32_16x16x32_bf16 v[232:235], a[48:51], a[72:75], v[232:235]
v_accvgpr_read_b32 v254, a130
v_accvgpr_read_b32 v255, a131
v_mfma_f32_16x16x32_bf16 v[232:235], a[52:55], a[76:79], v[232:235]
v_cvt_pk_bf16_f32 v255, v254, v255
v_cvt_pk_bf16_f32 v254, v252, v253
v_mfma_f32_16x16x32_bf16 v[240:243], a[60:63], a[76:79], v[240:243]
v_cvt_pk_bf16_f32 v252, v248, v249
v_cvt_pk_bf16_f32 v253, v250, v251
v_mfma_f32_16x16x32_bf16 v[240:243], a[56:59], a[72:75], v[240:243]
ds_read_b64_tr_b16 a[72:73], v6 offset:0
v_accvgpr_write_b32 a232, v252
v_mfma_f32_16x16x32_bf16 v[244:247], a[56:59], a[80:83], v[244:247]
ds_read_b64_tr_b16 a[74:75], v6 offset:1024
v_accvgpr_write_b32 a233, v253
v_mfma_f32_16x16x32_bf16 v[244:247], a[60:63], a[84:87], v[244:247]
ds_read_b64_tr_b16 a[76:77], v6 offset:8192
v_accvgpr_write_b32 a234, v254
v_mfma_f32_16x16x32_bf16 v[236:239], a[52:55], a[84:87], v[236:239]
s_add_u32 m0, s77, 134144
ds_read_b64_tr_b16 a[78:79], v6 offset:9216
v_accvgpr_write_b32 a235, v255
v_mfma_f32_16x16x32_bf16 v[236:239], a[48:51], a[80:83], v[236:239]
s_add_u32 s64, s71, 1671168
v_mfma_f32_16x16x32_bf16 v[228:231], a[40:43], a[80:83], v[228:231]
buffer_load_dwordx4 v15, s[56:59], s64 offen lds
v_mfma_f32_16x16x32_bf16 v[228:231], a[44:47], a[84:87], v[228:231]
v_accvgpr_read_b32 v248, a140
v_accvgpr_read_b32 v249, a141
v_mfma_f32_16x16x32_bf16 v[220:223], a[36:39], a[84:87], v[220:223]
v_accvgpr_read_b32 v250, a142
v_accvgpr_read_b32 v251, a143
v_mfma_f32_16x16x32_bf16 v[220:223], a[32:35], a[80:83], v[220:223]
s_waitcnt lgkmcnt(4)
ds_read_b64_tr_b16 a[80:81], v7 offset:0
v_accvgpr_read_b32 v252, a136
v_mfma_f32_16x16x32_bf16 v[152:155], a[88:91], a[32:35], v[152:155]
ds_read_b64_tr_b16 a[82:83], v7 offset:1024
v_accvgpr_read_b32 v253, a137
v_mfma_f32_16x16x32_bf16 v[152:155], a[92:95], a[36:39], v[152:155]
ds_read_b64_tr_b16 a[84:85], v7 offset:8192
v_accvgpr_read_b32 v254, a138
v_mfma_f32_16x16x32_bf16 v[160:163], a[92:95], a[44:47], v[160:163]
ds_read_b64_tr_b16 a[86:87], v7 offset:9216
v_accvgpr_read_b32 v255, a139
v_mfma_f32_16x16x32_bf16 v[160:163], a[88:91], a[40:43], v[160:163]
v_cvt_pk_bf16_f32 v255, v254, v255
v_cvt_pk_bf16_f32 v254, v252, v253
v_mfma_f32_16x16x32_bf16 v[168:171], a[88:91], a[48:51], v[168:171]
v_cvt_pk_bf16_f32 v252, v248, v249
v_cvt_pk_bf16_f32 v253, v250, v251
v_mfma_f32_16x16x32_bf16 v[168:171], a[92:95], a[52:55], v[168:171]
v_accvgpr_write_b32 a236, v252
v_accvgpr_write_b32 a237, v253
v_mfma_f32_16x16x32_bf16 v[176:179], a[92:95], a[60:63], v[176:179]
s_add_u32 m0, s76, 32768
v_accvgpr_write_b32 a238, v254
v_accvgpr_write_b32 a239, v255
v_mfma_f32_16x16x32_bf16 v[176:179], a[88:91], a[56:59], v[176:179]
s_add_u32 s64, s72, 384
ds_read_b64_tr_b16 a[88:89], v8 offset:0
v_mfma_f32_16x16x32_bf16 v[180:183], a[96:99], a[56:59], v[180:183]
buffer_load_dwordx4 v12, s[48:51], s64 offen lds
v_mfma_f32_16x16x32_bf16 v[180:183], a[100:103], a[60:63], v[180:183]
ds_read_b64_tr_b16 a[90:91], v8 offset:1024
v_mfma_f32_16x16x32_bf16 v[172:175], a[100:103], a[52:55], v[172:175]
ds_read_b64_tr_b16 a[92:93], v8 offset:8192
v_mfma_f32_16x16x32_bf16 v[172:175], a[96:99], a[48:51], v[172:175]
s_add_u32 m0, s76, 33792
ds_read_b64_tr_b16 a[94:95], v8 offset:9216
v_mfma_f32_16x16x32_bf16 v[164:167], a[96:99], a[40:43], v[164:167]
s_add_u32 s64, s72, 16768
v_mfma_f32_16x16x32_bf16 v[164:167], a[100:103], a[44:47], v[164:167]
s_add_u32 s65, s79, 4096
buffer_load_dwordx4 v13, s[48:51], s64 offen lds
v_mfma_f32_16x16x32_bf16 v[156:159], a[100:103], a[36:39], v[156:159]
buffer_store_dwordx4 a[148:151], v16, s[44:47], s65 offen sc1
v_mfma_f32_16x16x32_bf16 v[156:159], a[96:99], a[32:35], v[156:159]
ds_read_b64_tr_b16 a[96:97], v9 offset:0
v_mfma_f32_16x16x32_bf16 v[24:27], a[104:107], a[32:35], v[24:27]
s_add_u32 m0, s76, 34816
ds_read_b64_tr_b16 a[98:99], v9 offset:1024
v_mfma_f32_16x16x32_bf16 v[24:27], a[108:111], a[36:39], v[24:27]
s_add_u32 s64, s72, 131456
ds_read_b64_tr_b16 a[100:101], v9 offset:8192
v_mfma_f32_16x16x32_bf16 v[40:43], a[108:111], a[44:47], v[40:43]
buffer_load_dwordx4 v12, s[48:51], s64 offen lds
v_mfma_f32_16x16x32_bf16 v[40:43], a[104:107], a[40:43], v[40:43]
ds_read_b64_tr_b16 a[102:103], v9 offset:9216
v_mfma_f32_16x16x32_bf16 v[56:59], a[104:107], a[48:51], v[56:59]
v_mfma_f32_16x16x32_bf16 v[56:59], a[108:111], a[52:55], v[56:59]
s_add_u32 m0, s76, 35840
v_mfma_f32_16x16x32_bf16 v[72:75], a[108:111], a[60:63], v[72:75]
s_waitcnt vmcnt(15)
s_add_u32 s64, s72, 147840
ds_read_b128 a[0:3], v2 offset:0
v_mfma_f32_16x16x32_bf16 v[72:75], a[104:107], a[56:59], v[72:75]
buffer_load_dwordx4 v13, s[48:51], s64 offen lds
v_mfma_f32_16x16x32_bf16 v[136:139], a[112:115], a[56:59], v[136:139]
ds_read_b128 a[4:7], v3 offset:0
v_mfma_f32_16x16x32_bf16 v[136:139], a[116:119], a[60:63], v[136:139]
ds_read_b128 a[8:11], v2 offset:2048
v_mfma_f32_16x16x32_bf16 v[120:123], a[116:119], a[52:55], v[120:123]
s_add_u32 m0, s76, 36864
ds_read_b128 a[12:15], v3 offset:2048
v_mfma_f32_16x16x32_bf16 v[120:123], a[112:115], a[48:51], v[120:123]
s_add_u32 s64, s73, 384
ds_read_b128 a[16:19], v2 offset:4096
v_mfma_f32_16x16x32_bf16 v[104:107], a[112:115], a[40:43], v[104:107]
buffer_load_dwordx4 v12, s[48:51], s64 offen lds
v_mfma_f32_16x16x32_bf16 v[104:107], a[116:119], a[44:47], v[104:107]
ds_read_b128 a[20:23], v3 offset:4096
v_mfma_f32_16x16x32_bf16 v[88:91], a[116:119], a[36:39], v[88:91]
ds_read_b128 a[24:27], v2 offset:6144
v_mfma_f32_16x16x32_bf16 v[88:91], a[112:115], a[32:35], v[88:91]
s_waitcnt lgkmcnt(7)
s_add_u32 m0, s76, 37888
ds_read_b128 a[28:31], v3 offset:6144
v_mfma_f32_16x16x32_bf16 v[28:31], a[72:75], a[32:35], v[28:31]
s_add_u32 s64, s73, 16768
ds_read_b64_tr_b16 a[104:105], v10 offset:0
v_mfma_f32_16x16x32_bf16 v[28:31], a[76:79], a[36:39], v[28:31]
buffer_load_dwordx4 v13, s[48:51], s64 offen lds
v_mfma_f32_16x16x32_bf16 v[44:47], a[76:79], a[44:47], v[44:47]
ds_read_b64_tr_b16 a[106:107], v10 offset:1024
v_mfma_f32_16x16x32_bf16 v[44:47], a[72:75], a[40:43], v[44:47]
ds_read_b64_tr_b16 a[108:109], v10 offset:8192
v_mfma_f32_16x16x32_bf16 v[60:63], a[72:75], a[48:51], v[60:63]
s_add_u32 m0, s76, 38912
ds_read_b64_tr_b16 a[110:111], v10 offset:9216
v_mfma_f32_16x16x32_bf16 v[60:63], a[76:79], a[52:55], v[60:63]
s_add_u32 s64, s73, 131456
ds_read_b64_tr_b16 a[112:113], v11 offset:0
v_mfma_f32_16x16x32_bf16 v[76:79], a[76:79], a[60:63], v[76:79]
buffer_load_dwordx4 v12, s[48:51], s64 offen lds
v_mfma_f32_16x16x32_bf16 v[76:79], a[72:75], a[56:59], v[76:79]
ds_read_b64_tr_b16 a[114:115], v11 offset:1024
v_mfma_f32_16x16x32_bf16 v[140:143], a[80:83], a[56:59], v[140:143]
ds_read_b64_tr_b16 a[116:117], v11 offset:8192
v_mfma_f32_16x16x32_bf16 v[140:143], a[84:87], a[60:63], v[140:143]
s_add_u32 m0, s76, 39936
ds_read_b64_tr_b16 a[118:119], v11 offset:9216
v_mfma_f32_16x16x32_bf16 v[124:127], a[84:87], a[52:55], v[124:127]
s_add_u32 s64, s73, 147840
v_mfma_f32_16x16x32_bf16 v[124:127], a[80:83], a[48:51], v[124:127]
buffer_load_dwordx4 v13, s[48:51], s64 offen lds
v_mfma_f32_16x16x32_bf16 v[108:111], a[80:83], a[40:43], v[108:111]
v_mfma_f32_16x16x32_bf16 v[108:111], a[84:87], a[44:47], v[108:111]
v_mfma_f32_16x16x32_bf16 v[92:95], a[84:87], a[36:39], v[92:95]
v_mfma_f32_16x16x32_bf16 v[92:95], a[80:83], a[32:35], v[92:95]
v_mfma_f32_16x16x32_bf16 v[32:35], a[88:91], a[32:35], v[32:35]
v_mfma_f32_16x16x32_bf16 v[32:35], a[92:95], a[36:39], v[32:35]
v_mfma_f32_16x16x32_bf16 v[48:51], a[92:95], a[44:47], v[48:51]
s_waitcnt lgkmcnt(0)
s_barrier
v_mfma_f32_16x16x32_bf16 v[48:51], a[88:91], a[40:43], v[48:51]
s_add_u32 m0, s77, 65536
ds_read_b64_tr_b16 a[72:73], v19 offset:36864
v_mfma_f32_16x16x32_bf16 v[64:67], a[88:91], a[48:51], v[64:67]
s_add_u32 s64, s71, 2097152
ds_read_b64_tr_b16 a[74:75], v19 offset:37120
v_mfma_f32_16x16x32_bf16 v[64:67], a[92:95], a[52:55], v[64:67]
buffer_load_dwordx4 v14, s[56:59], s64 offen lds
v_mfma_f32_16x16x32_bf16 v[80:83], a[92:95], a[60:63], v[80:83]
ds_read_b64_tr_b16 a[76:77], v19 offset:38912
v_mfma_f32_16x16x32_bf16 v[80:83], a[88:91], a[56:59], v[80:83]
ds_read_b64_tr_b16 a[78:79], v19 offset:39168
v_mfma_f32_16x16x32_bf16 v[144:147], a[96:99], a[56:59], v[144:147]
ds_read_b64_tr_b16 a[80:81], v20 offset:36864
v_mfma_f32_16x16x32_bf16 v[144:147], a[100:103], a[60:63], v[144:147]
ds_read_b64_tr_b16 a[82:83], v20 offset:37120
v_mfma_f32_16x16x32_bf16 v[128:131], a[100:103], a[52:55], v[128:131]
ds_read_b64_tr_b16 a[84:85], v20 offset:38912
v_mfma_f32_16x16x32_bf16 v[128:131], a[96:99], a[48:51], v[128:131]
ds_read_b64_tr_b16 a[86:87], v20 offset:39168
v_mfma_f32_16x16x32_bf16 v[112:115], a[96:99], a[40:43], v[112:115]
s_add_u32 m0, s78, 81920
ds_read_b64_tr_b16 a[88:89], v19 offset:40960
v_mfma_f32_16x16x32_bf16 v[112:115], a[100:103], a[44:47], v[112:115]
s_add_u32 s64, s75, 1572864
ds_read_b64_tr_b16 a[90:91], v19 offset:41216
v_mfma_f32_16x16x32_bf16 v[96:99], a[100:103], a[36:39], v[96:99]
s_add_u32 s65, s79, 0
buffer_load_dwordx4 v23, s[60:63], s64 offen lds
v_mfma_f32_16x16x32_bf16 v[96:99], a[96:99], a[32:35], v[96:99]
buffer_store_dwordx4 a[152:155], v16, s[44:47], s65 offen sc1
v_mfma_f32_16x16x32_bf16 v[36:39], a[104:107], a[32:35], v[36:39]
ds_read_b64_tr_b16 a[92:93], v19 offset:43008
v_mfma_f32_16x16x32_bf16 v[36:39], a[108:111], a[36:39], v[36:39]
ds_read_b64_tr_b16 a[94:95], v19 offset:43264
v_mfma_f32_16x16x32_bf16 v[52:55], a[108:111], a[44:47], v[52:55]
ds_read_b64_tr_b16 a[96:97], v20 offset:40960
v_mfma_f32_16x16x32_bf16 v[52:55], a[104:107], a[40:43], v[52:55]
ds_read_b64_tr_b16 a[98:99], v20 offset:41216
v_mfma_f32_16x16x32_bf16 v[68:71], a[104:107], a[48:51], v[68:71]
s_add_u32 m0, s77, 66560
ds_read_b64_tr_b16 a[100:101], v20 offset:43008
v_mfma_f32_16x16x32_bf16 v[68:71], a[108:111], a[52:55], v[68:71]
s_add_u32 s64, s71, 2129920
s_xor_b32 s68, s66, 4096
ds_read_b64_tr_b16 a[102:103], v20 offset:43264
v_mfma_f32_16x16x32_bf16 v[84:87], a[108:111], a[60:63], v[84:87]
s_mov_b64 exec, 1
buffer_atomic_add a251, v1, s[52:55], s68 offen offset:0 sc1
s_mov_b64 exec, -1
v_mfma_f32_16x16x32_bf16 v[84:87], a[104:107], a[56:59], v[84:87]
buffer_load_dwordx4 v14, s[56:59], s64 offen lds
v_mfma_f32_16x16x32_bf16 v[148:151], a[112:115], a[56:59], v[148:151]
ds_read_b64_tr_b16 a[104:105], v19 offset:32768
v_mfma_f32_16x16x32_bf16 v[148:151], a[116:119], a[60:63], v[148:151]
ds_read_b64_tr_b16 a[106:107], v19 offset:33024
v_mfma_f32_16x16x32_bf16 v[132:135], a[116:119], a[52:55], v[132:135]
ds_read_b64_tr_b16 a[108:109], v19 offset:34816
v_mfma_f32_16x16x32_bf16 v[132:135], a[112:115], a[48:51], v[132:135]
ds_read_b64_tr_b16 a[110:111], v19 offset:35072
v_mfma_f32_16x16x32_bf16 v[116:119], a[112:115], a[40:43], v[116:119]
v_mfma_f32_16x16x32_bf16 v[116:119], a[116:119], a[44:47], v[116:119]
v_mfma_f32_16x16x32_bf16 v[100:103], a[116:119], a[36:39], v[100:103]
s_add_u32 m0, s78, 86016
v_mfma_f32_16x16x32_bf16 v[100:103], a[112:115], a[32:35], v[100:103]
s_waitcnt lgkmcnt(4)
s_add_u32 s64, s75, 1574912
ds_read_b64_tr_b16 a[112:113], v20 offset:32768
v_mfma_f32_16x16x32_bf16 v[184:187], a[72:75], a[0:3], v[184:187]
buffer_load_dwordx4 v23, s[60:63], s64 offen lds
v_mfma_f32_16x16x32_bf16 v[184:187], a[76:79], a[4:7], v[184:187]
ds_read_b64_tr_b16 a[114:115], v20 offset:33024
v_mfma_f32_16x16x32_bf16 v[192:195], a[76:79], a[12:15], v[192:195]
ds_read_b64_tr_b16 a[116:117], v20 offset:34816
v_mfma_f32_16x16x32_bf16 v[192:195], a[72:75], a[8:11], v[192:195]
s_add_u32 s17, s78, .-L_pc+6144
ds_read_b64_tr_b16 a[118:119], v20 offset:35072
v_mfma_f32_16x16x32_bf16 v[200:203], a[72:75], a[16:19], v[200:203]
buffer_load_dword a252, v16, s[88:91], s17 offen
v_mfma_f32_16x16x32_bf16 v[200:203], a[76:79], a[20:23], v[200:203]
v_mfma_f32_16x16x32_bf16 v[208:211], a[76:79], a[28:31], v[208:211]
v_mfma_f32_16x16x32_bf16 v[208:211], a[72:75], a[24:27], v[208:211]
ds_read_b64_tr_b16 a[72:73], v4 offset:32768
v_mfma_f32_16x16x32_bf16 v[212:215], a[80:83], a[24:27], v[212:215]
s_add_u32 m0, s77, 67584
ds_read_b64_tr_b16 a[74:75], v4 offset:33792
v_mfma_f32_16x16x32_bf16 v[212:215], a[84:87], a[28:31], v[212:215]
s_add_u32 s64, s71, 2162688
ds_read_b64_tr_b16 a[76:77], v4 offset:40960
v_mfma_f32_16x16x32_bf16 v[204:207], a[84:87], a[20:23], v[204:207]
buffer_load_dwordx4 v15, s[56:59], s64 offen lds
v_mfma_f32_16x16x32_bf16 v[204:207], a[80:83], a[16:19], v[204:207]
ds_read_b64_tr_b16 a[78:79], v4 offset:41984
v_mfma_f32_16x16x32_bf16 v[196:199], a[80:83], a[8:11], v[196:199]
v_mfma_f32_16x16x32_bf16 v[196:199], a[84:87], a[12:15], v[196:199]
v_mfma_f32_16x16x32_bf16 v[188:191], a[84:87], a[4:7], v[188:191]
v_mfma_f32_16x16x32_bf16 v[188:191], a[80:83], a[0:3], v[188:191]
ds_read_b64_tr_b16 a[80:81], v5 offset:32768
v_mfma_f32_16x16x32_bf16 v[216:219], a[0:3], a[88:91], v[216:219]
ds_read_b64_tr_b16 a[82:83], v5 offset:33792
v_mfma_f32_16x16x32_bf16 v[216:219], a[4:7], a[92:95], v[216:219]
s_add_u32 m0, s78, 90112
ds_read_b64_tr_b16 a[84:85], v5 offset:40960
v_mfma_f32_16x16x32_bf16 v[224:227], a[12:15], a[92:95], v[224:227]
s_add_u32 s64, s75, 1576960
ds_read_b64_tr_b16 a[86:87], v5 offset:41984
v_mfma_f32_16x16x32_bf16 v[224:227], a[8:11], a[88:91], v[224:227]
buffer_load_dwordx4 v23, s[60:63], s64 offen lds
v_mfma_f32_16x16x32_bf16 v[232:235], a[16:19], a[88:91], v[232:235]
v_mfma_f32_16x16x32_bf16 v[232:235], a[20:23], a[92:95], v[232:235]
v_mfma_f32_16x16x32_bf16 v[240:243], a[28:31], a[92:95], v[240:243]
v_mfma_f32_16x16x32_bf16 v[240:243], a[24:27], a[88:91], v[240:243]
ds_read_b64_tr_b16 a[88:89], v6 offset:32768
v_mfma_f32_16x16x32_bf16 v[244:247], a[24:27], a[96:99], v[244:247]
ds_read_b64_tr_b16 a[90:91], v6 offset:33792
v_mfma_f32_16x16x32_bf16 v[244:247], a[28:31], a[100:103], v[244:247]
ds_read_b64_tr_b16 a[92:93], v6 offset:40960
v_add_u32 v19, 0x8000, v19
v_mfma_f32_16x16x32_bf16 v[236:239], a[20:23], a[100:103], v[236:239]
s_add_u32 m0, s77, 68608
ds_read_b64_tr_b16 a[94:95], v6 offset:41984
v_mfma_f32_16x16x32_bf16 v[236:239], a[16:19], a[96:99], v[236:239]
s_add_u32 s64, s71, 2195456
v_mfma_f32_16x16x32_bf16 v[228:231], a[8:11], a[96:99], v[228:231]
buffer_load_dwordx4 v15, s[56:59], s64 offen lds
v_mfma_f32_16x16x32_bf16 v[228:231], a[12:15], a[100:103], v[228:231]
v_mfma_f32_16x16x32_bf16 v[220:223], a[4:7], a[100:103], v[220:223]
v_mfma_f32_16x16x32_bf16 v[220:223], a[0:3], a[96:99], v[220:223]
s_waitcnt lgkmcnt(4)
s_add_u32 s65, s79, 17408
ds_read_b64_tr_b16 a[96:97], v7 offset:32768
v_mfma_f32_16x16x32_bf16 v[152:155], a[104:107], a[0:3], v[152:155]
buffer_store_dwordx4 a[156:159], v16, s[44:47], s65 offen sc1
v_mfma_f32_16x16x32_bf16 v[152:155], a[108:111], a[4:7], v[152:155]
ds_read_b64_tr_b16 a[98:99], v7 offset:33792
v_add_u32 v20, 0x8000, v20
v_mfma_f32_16x16x32_bf16 v[160:163], a[108:111], a[12:15], v[160:163]
ds_read_b64_tr_b16 a[100:101], v7 offset:40960
v_mfma_f32_16x16x32_bf16 v[160:163], a[104:107], a[8:11], v[160:163]
ds_read_b64_tr_b16 a[102:103], v7 offset:41984
v_mfma_f32_16x16x32_bf16 v[168:171], a[104:107], a[16:19], v[168:171]
v_mfma_f32_16x16x32_bf16 v[168:171], a[108:111], a[20:23], v[168:171]
v_mfma_f32_16x16x32_bf16 v[176:179], a[108:111], a[28:31], v[176:179]
s_add_u32 m0, s76, 0
v_mfma_f32_16x16x32_bf16 v[176:179], a[104:107], a[24:27], v[176:179]
s_add_u32 s64, s72, 512
ds_read_b64_tr_b16 a[104:105], v8 offset:32768
v_mfma_f32_16x16x32_bf16 v[180:183], a[112:115], a[24:27], v[180:183]
buffer_load_dwordx4 v12, s[48:51], s64 offen lds
v_mfma_f32_16x16x32_bf16 v[180:183], a[116:119], a[28:31], v[180:183]
ds_read_b64_tr_b16 a[106:107], v8 offset:33792
v_add_u32 v4, 0x8000, v4
v_mfma_f32_16x16x32_bf16 v[172:175], a[116:119], a[20:23], v[172:175]
ds_read_b64_tr_b16 a[108:109], v8 offset:40960
v_mfma_f32_16x16x32_bf16 v[172:175], a[112:115], a[16:19], v[172:175]
s_add_u32 m0, s76, 1024
ds_read_b64_tr_b16 a[110:111], v8 offset:41984
v_mfma_f32_16x16x32_bf16 v[164:167], a[112:115], a[8:11], v[164:167]
s_add_u32 s64, s72, 16896
v_mfma_f32_16x16x32_bf16 v[164:167], a[116:119], a[12:15], v[164:167]
buffer_load_dwordx4 v13, s[48:51], s64 offen lds
v_mfma_f32_16x16x32_bf16 v[156:159], a[116:119], a[4:7], v[156:159]
v_mfma_f32_16x16x32_bf16 v[156:159], a[112:115], a[0:3], v[156:159]
ds_read_b64_tr_b16 a[112:113], v9 offset:32768
v_mfma_f32_16x16x32_bf16 v[24:27], a[72:75], a[0:3], v[24:27]
s_add_u32 m0, s76, 2048
ds_read_b64_tr_b16 a[114:115], v9 offset:33792
v_mfma_f32_16x16x32_bf16 v[24:27], a[76:79], a[4:7], v[24:27]
s_add_u32 s64, s72, 131584
ds_read_b64_tr_b16 a[116:117], v9 offset:40960
v_add_u32 v5, 0x8000, v5
v_mfma_f32_16x16x32_bf16 v[40:43], a[76:79], a[12:15], v[40:43]
buffer_load_dwordx4 v12, s[48:51], s64 offen lds
v_mfma_f32_16x16x32_bf16 v[40:43], a[72:75], a[8:11], v[40:43]
ds_read_b64_tr_b16 a[118:119], v9 offset:41984
v_mfma_f32_16x16x32_bf16 v[56:59], a[72:75], a[16:19], v[56:59]
v_mfma_f32_16x16x32_bf16 v[56:59], a[76:79], a[20:23], v[56:59]
s_add_u32 m0, s76, 3072
v_mfma_f32_16x16x32_bf16 v[72:75], a[76:79], a[28:31], v[72:75]
s_waitcnt vmcnt(14)
s_add_u32 s64, s72, 147968
ds_read_b128 a[32:35], v2 offset:32768
v_mfma_f32_16x16x32_bf16 v[72:75], a[72:75], a[24:27], v[72:75]
buffer_load_dwordx4 v13, s[48:51], s64 offen lds
v_mfma_f32_16x16x32_bf16 v[136:139], a[80:83], a[24:27], v[136:139]
ds_read_b128 a[36:39], v3 offset:32768
v_mfma_f32_16x16x32_bf16 v[136:139], a[84:87], a[28:31], v[136:139]
ds_read_b128 a[40:43], v2 offset:34816
v_add_u32 v6, 0x8000, v6
v_mfma_f32_16x16x32_bf16 v[120:123], a[84:87], a[20:23], v[120:123]
s_add_u32 m0, s76, 4096
ds_read_b128 a[44:47], v3 offset:34816
v_mfma_f32_16x16x32_bf16 v[120:123], a[80:83], a[16:19], v[120:123]
s_add_u32 s64, s73, 512
ds_read_b128 a[48:51], v2 offset:36864
v_mfma_f32_16x16x32_bf16 v[104:107], a[80:83], a[8:11], v[104:107]
buffer_load_dwordx4 v12, s[48:51], s64 offen lds
v_mfma_f32_16x16x32_bf16 v[104:107], a[84:87], a[12:15], v[104:107]
ds_read_b128 a[52:55], v3 offset:36864
v_mfma_f32_16x16x32_bf16 v[88:91], a[84:87], a[4:7], v[88:91]
ds_read_b128 a[56:59], v2 offset:38912
v_mfma_f32_16x16x32_bf16 v[88:91], a[80:83], a[0:3], v[88:91]
s_waitcnt lgkmcnt(7)
s_add_u32 m0, s76, 5120
ds_read_b128 a[60:63], v3 offset:38912
v_mfma_f32_16x16x32_bf16 v[28:31], a[88:91], a[0:3], v[28:31]
s_add_u32 s64, s73, 16896
ds_read_b64_tr_b16 a[72:73], v10 offset:32768
v_mfma_f32_16x16x32_bf16 v[28:31], a[92:95], a[4:7], v[28:31]
buffer_load_dwordx4 v13, s[48:51], s64 offen lds
v_mfma_f32_16x16x32_bf16 v[44:47], a[92:95], a[12:15], v[44:47]
ds_read_b64_tr_b16 a[74:75], v10 offset:33792
v_add_u32 v7, 0x8000, v7
v_mfma_f32_16x16x32_bf16 v[44:47], a[88:91], a[8:11], v[44:47]
ds_read_b64_tr_b16 a[76:77], v10 offset:40960
v_mfma_f32_16x16x32_bf16 v[60:63], a[88:91], a[16:19], v[60:63]
s_add_u32 m0, s76, 6144
ds_read_b64_tr_b16 a[78:79], v10 offset:41984
v_mfma_f32_16x16x32_bf16 v[60:63], a[92:95], a[20:23], v[60:63]
s_add_u32 s64, s73, 131584
ds_read_b64_tr_b16 a[80:81], v11 offset:32768
v_mfma_f32_16x16x32_bf16 v[76:79], a[92:95], a[28:31], v[76:79]
buffer_load_dwordx4 v12, s[48:51], s64 offen lds
v_mfma_f32_16x16x32_bf16 v[76:79], a[88:91], a[24:27], v[76:79]
ds_read_b64_tr_b16 a[82:83], v11 offset:33792
v_mfma_f32_16x16x32_bf16 v[140:143], a[96:99], a[24:27], v[140:143]
ds_read_b64_tr_b16 a[84:85], v11 offset:40960
v_mfma_f32_16x16x32_bf16 v[140:143], a[100:103], a[28:31], v[140:143]
s_add_u32 m0, s76, 7168
ds_read_b64_tr_b16 a[86:87], v11 offset:41984
v_add_u32 v8, 0x8000, v8
v_mfma_f32_16x16x32_bf16 v[124:127], a[100:103], a[20:23], v[124:127]
s_add_u32 s64, s73, 147968
v_mfma_f32_16x16x32_bf16 v[124:127], a[96:99], a[16:19], v[124:127]
buffer_load_dwordx4 v13, s[48:51], s64 offen lds
v_mfma_f32_16x16x32_bf16 v[108:111], a[96:99], a[8:11], v[108:111]
v_mfma_f32_16x16x32_bf16 v[108:111], a[100:103], a[12:15], v[108:111]
v_mfma_f32_16x16x32_bf16 v[92:95], a[100:103], a[4:7], v[92:95]
v_add_u32 v9, 0x8000, v9
v_add_u32 v10, 0x8000, v10
v_mfma_f32_16x16x32_bf16 v[92:95], a[96:99], a[0:3], v[92:95]
v_add_u32 v11, 0x8000, v11
v_mfma_f32_16x16x32_bf16 v[32:35], a[104:107], a[0:3], v[32:35]
s_add_u32 s65, s79, 5120
v_mfma_f32_16x16x32_bf16 v[32:35], a[108:111], a[4:7], v[32:35]
buffer_store_dwordx4 a[160:163], v16, s[44:47], s65 offen sc1
v_mfma_f32_16x16x32_bf16 v[48:51], a[108:111], a[12:15], v[48:51]
s_waitcnt lgkmcnt(0)
s_barrier
v_mfma_f32_16x16x32_bf16 v[48:51], a[104:107], a[8:11], v[48:51]
s_add_u32 m0, s77, 98304
ds_read_b64_tr_b16 a[88:89], v19 offset:36864
v_mfma_f32_16x16x32_bf16 v[64:67], a[104:107], a[16:19], v[64:67]
s_add_u32 s64, s71, 2621440
ds_read_b64_tr_b16 a[90:91], v19 offset:37120
v_mfma_f32_16x16x32_bf16 v[64:67], a[108:111], a[20:23], v[64:67]
buffer_load_dwordx4 v14, s[56:59], s64 offen lds
v_mfma_f32_16x16x32_bf16 v[80:83], a[108:111], a[28:31], v[80:83]
ds_read_b64_tr_b16 a[92:93], v19 offset:38912
v_mfma_f32_16x16x32_bf16 v[80:83], a[104:107], a[24:27], v[80:83]
ds_read_b64_tr_b16 a[94:95], v19 offset:39168
v_mfma_f32_16x16x32_bf16 v[144:147], a[112:115], a[24:27], v[144:147]
ds_read_b64_tr_b16 a[96:97], v20 offset:36864
v_mfma_f32_16x16x32_bf16 v[144:147], a[116:119], a[28:31], v[144:147]
ds_read_b64_tr_b16 a[98:99], v20 offset:37120
v_mfma_f32_16x16x32_bf16 v[128:131], a[116:119], a[20:23], v[128:131]
ds_read_b64_tr_b16 a[100:101], v20 offset:38912
v_mfma_f32_16x16x32_bf16 v[128:131], a[112:115], a[16:19], v[128:131]
ds_read_b64_tr_b16 a[102:103], v20 offset:39168
v_mfma_f32_16x16x32_bf16 v[112:115], a[112:115], a[8:11], v[112:115]
s_add_u32 m0, s78, 114688
ds_read_b64_tr_b16 a[104:105], v19 offset:40960
v_mfma_f32_16x16x32_bf16 v[112:115], a[116:119], a[12:15], v[112:115]
s_add_u32 s64, s75, 1966080
ds_read_b64_tr_b16 a[106:107], v19 offset:41216
v_mfma_f32_16x16x32_bf16 v[96:99], a[116:119], a[4:7], v[96:99]
buffer_load_dwordx4 v23, s[60:63], s64 offen lds
v_mfma_f32_16x16x32_bf16 v[96:99], a[112:115], a[0:3], v[96:99]
ds_read_b64_tr_b16 a[108:109], v19 offset:43008
v_mfma_f32_16x16x32_bf16 v[36:39], a[72:75], a[0:3], v[36:39]
ds_read_b64_tr_b16 a[110:111], v19 offset:43264
v_mfma_f32_16x16x32_bf16 v[36:39], a[76:79], a[4:7], v[36:39]
ds_read_b64_tr_b16 a[112:113], v20 offset:40960
v_mfma_f32_16x16x32_bf16 v[52:55], a[76:79], a[12:15], v[52:55]
ds_read_b64_tr_b16 a[114:115], v20 offset:41216
v_mfma_f32_16x16x32_bf16 v[52:55], a[72:75], a[8:11], v[52:55]
ds_read_b64_tr_b16 a[116:117], v20 offset:43008
v_mfma_f32_16x16x32_bf16 v[68:71], a[72:75], a[16:19], v[68:71]
s_add_u32 m0, s77, 99328
ds_read_b64_tr_b16 a[118:119], v20 offset:43264
v_mfma_f32_16x16x32_bf16 v[68:71], a[76:79], a[20:23], v[68:71]
s_add_u32 s64, s71, 2654208
s_xor_b32 s68, s66, 8192
v_mfma_f32_16x16x32_bf16 v[84:87], a[76:79], a[28:31], v[84:87]
s_mov_b64 exec, 1
buffer_atomic_add a251, v1, s[52:55], s68 offen offset:0 sc1
s_mov_b64 exec, -1
v_mfma_f32_16x16x32_bf16 v[84:87], a[72:75], a[24:27], v[84:87]
buffer_load_dwordx4 v14, s[56:59], s64 offen lds
v_mfma_f32_16x16x32_bf16 v[148:151], a[80:83], a[24:27], v[148:151]
ds_read_b64_tr_b16 a[72:73], v19 offset:32768
v_mfma_f32_16x16x32_bf16 v[148:151], a[84:87], a[28:31], v[148:151]
ds_read_b64_tr_b16 a[74:75], v19 offset:33024
v_mfma_f32_16x16x32_bf16 v[132:135], a[84:87], a[20:23], v[132:135]
ds_read_b64_tr_b16 a[76:77], v19 offset:34816
v_mfma_f32_16x16x32_bf16 v[132:135], a[80:83], a[16:19], v[132:135]
ds_read_b64_tr_b16 a[78:79], v19 offset:35072
v_mfma_f32_16x16x32_bf16 v[116:119], a[80:83], a[8:11], v[116:119]
v_mfma_f32_16x16x32_bf16 v[116:119], a[84:87], a[12:15], v[116:119]
v_mfma_f32_16x16x32_bf16 v[100:103], a[84:87], a[4:7], v[100:103]
s_add_u32 m0, s78, 118784
v_mfma_f32_16x16x32_bf16 v[100:103], a[80:83], a[0:3], v[100:103]
s_waitcnt lgkmcnt(4)
s_add_u32 s64, s75, 1968128
ds_read_b64_tr_b16 a[80:81], v20 offset:32768
v_mfma_f32_16x16x32_bf16 v[184:187], a[88:91], a[32:35], v[184:187]
buffer_load_dwordx4 v23, s[60:63], s64 offen lds
v_mfma_f32_16x16x32_bf16 v[184:187], a[92:95], a[36:39], v[184:187]
ds_read_b64_tr_b16 a[82:83], v20 offset:33024
v_mfma_f32_16x16x32_bf16 v[192:195], a[92:95], a[44:47], v[192:195]
ds_read_b64_tr_b16 a[84:85], v20 offset:34816
v_mfma_f32_16x16x32_bf16 v[192:195], a[88:91], a[40:43], v[192:195]
ds_read_b64_tr_b16 a[86:87], v20 offset:35072
v_mfma_f32_16x16x32_bf16 v[200:203], a[88:91], a[48:51], v[200:203]
v_mfma_f32_16x16x32_bf16 v[200:203], a[92:95], a[52:55], v[200:203]
v_mfma_f32_16x16x32_bf16 v[208:211], a[92:95], a[60:63], v[208:211]
v_mfma_f32_16x16x32_bf16 v[208:211], a[88:91], a[56:59], v[208:211]
ds_read_b64_tr_b16 a[88:89], v4 offset:32768
v_mfma_f32_16x16x32_bf16 v[212:215], a[96:99], a[56:59], v[212:215]
s_add_u32 m0, s77, 100352
ds_read_b64_tr_b16 a[90:91], v4 offset:33792
v_mfma_f32_16x16x32_bf16 v[212:215], a[100:103], a[60:63], v[212:215]
s_add_u32 s64, s71, 2686976
ds_read_b64_tr_b16 a[92:93], v4 offset:40960
v_mfma_f32_16x16x32_bf16 v[204:207], a[100:103], a[52:55], v[204:207]
buffer_load_dwordx4 v15, s[56:59], s64 offen lds
v_mfma_f32_16x16x32_bf16 v[204:207], a[96:99], a[48:51], v[204:207]
ds_read_b64_tr_b16 a[94:95], v4 offset:41984
v_mfma_f32_16x16x32_bf16 v[196:199], a[96:99], a[40:43], v[196:199]
v_mfma_f32_16x16x32_bf16 v[196:199], a[100:103], a[44:47], v[196:199]
v_mfma_f32_16x16x32_bf16 v[188:191], a[100:103], a[36:39], v[188:191]
v_mfma_f32_16x16x32_bf16 v[188:191], a[96:99], a[32:35], v[188:191]
ds_read_b64_tr_b16 a[96:97], v5 offset:32768
v_mfma_f32_16x16x32_bf16 v[216:219], a[32:35], a[104:107], v[216:219]
ds_read_b64_tr_b16 a[98:99], v5 offset:33792
v_mfma_f32_16x16x32_bf16 v[216:219], a[36:39], a[108:111], v[216:219]
s_add_u32 m0, s78, 122880
ds_read_b64_tr_b16 a[100:101], v5 offset:40960
v_mfma_f32_16x16x32_bf16 v[224:227], a[44:47], a[108:111], v[224:227]
s_add_u32 s64, s75, 1970176
ds_read_b64_tr_b16 a[102:103], v5 offset:41984
v_mfma_f32_16x16x32_bf16 v[224:227], a[40:43], a[104:107], v[224:227]
s_add_u32 s65, s79, 1024
buffer_load_dwordx4 v23, s[60:63], s64 offen lds
v_mfma_f32_16x16x32_bf16 v[232:235], a[48:51], a[104:107], v[232:235]
buffer_store_dwordx4 a[164:167], v16, s[44:47], s65 offen sc1
v_mfma_f32_16x16x32_bf16 v[232:235], a[52:55], a[108:111], v[232:235]
v_mfma_f32_16x16x32_bf16 v[240:243], a[60:63], a[108:111], v[240:243]
v_mfma_f32_16x16x32_bf16 v[240:243], a[56:59], a[104:107], v[240:243]
ds_read_b64_tr_b16 a[104:105], v6 offset:32768
v_mfma_f32_16x16x32_bf16 v[244:247], a[56:59], a[112:115], v[244:247]
ds_read_b64_tr_b16 a[106:107], v6 offset:33792
v_mfma_f32_16x16x32_bf16 v[244:247], a[60:63], a[116:119], v[244:247]
ds_read_b64_tr_b16 a[108:109], v6 offset:40960
v_subrev_u32 v19, 0x8000, v19
v_mfma_f32_16x16x32_bf16 v[236:239], a[52:55], a[116:119], v[236:239]
s_add_u32 m0, s77, 101376
ds_read_b64_tr_b16 a[110:111], v6 offset:41984
v_mfma_f32_16x16x32_bf16 v[236:239], a[48:51], a[112:115], v[236:239]
s_add_u32 s64, s71, 2719744
v_mfma_f32_16x16x32_bf16 v[228:231], a[40:43], a[112:115], v[228:231]
buffer_load_dwordx4 v15, s[56:59], s64 offen lds
v_mfma_f32_16x16x32_bf16 v[228:231], a[44:47], a[116:119], v[228:231]
v_mfma_f32_16x16x32_bf16 v[220:223], a[36:39], a[116:119], v[220:223]
v_mfma_f32_16x16x32_bf16 v[220:223], a[32:35], a[112:115], v[220:223]
s_waitcnt lgkmcnt(4)
ds_read_b64_tr_b16 a[112:113], v7 offset:32768
v_mfma_f32_16x16x32_bf16 v[152:155], a[72:75], a[32:35], v[152:155]
ds_read_b64_tr_b16 a[114:115], v7 offset:33792
v_mfma_f32_16x16x32_bf16 v[152:155], a[76:79], a[36:39], v[152:155]
ds_read_b64_tr_b16 a[116:117], v7 offset:40960
v_subrev_u32 v20, 0x8000, v20
v_mfma_f32_16x16x32_bf16 v[160:163], a[76:79], a[44:47], v[160:163]
ds_read_b64_tr_b16 a[118:119], v7 offset:41984
v_mfma_f32_16x16x32_bf16 v[160:163], a[72:75], a[40:43], v[160:163]
v_mfma_f32_16x16x32_bf16 v[168:171], a[72:75], a[48:51], v[168:171]
v_mfma_f32_16x16x32_bf16 v[168:171], a[76:79], a[52:55], v[168:171]
v_mfma_f32_16x16x32_bf16 v[176:179], a[76:79], a[60:63], v[176:179]
s_add_u32 m0, s76, 32768
v_mfma_f32_16x16x32_bf16 v[176:179], a[72:75], a[56:59], v[176:179]
s_add_u32 s64, s72, 640
ds_read_b64_tr_b16 a[72:73], v8 offset:32768
v_mfma_f32_16x16x32_bf16 v[180:183], a[80:83], a[56:59], v[180:183]
buffer_load_dwordx4 v12, s[48:51], s64 offen lds
v_mfma_f32_16x16x32_bf16 v[180:183], a[84:87], a[60:63], v[180:183]
ds_read_b64_tr_b16 a[74:75], v8 offset:33792
v_subrev_u32 v4, 0x8000, v4
v_mfma_f32_16x16x32_bf16 v[172:175], a[84:87], a[52:55], v[172:175]
ds_read_b64_tr_b16 a[76:77], v8 offset:40960
v_mfma_f32_16x16x32_bf16 v[172:175], a[80:83], a[48:51], v[172:175]
s_add_u32 m0, s76, 33792
ds_read_b64_tr_b16 a[78:79], v8 offset:41984
v_mfma_f32_16x16x32_bf16 v[164:167], a[80:83], a[40:43], v[164:167]
s_add_u32 s64, s72, 17024
v_mfma_f32_16x16x32_bf16 v[164:167], a[84:87], a[44:47], v[164:167]
buffer_load_dwordx4 v13, s[48:51], s64 offen lds
v_mfma_f32_16x16x32_bf16 v[156:159], a[84:87], a[36:39], v[156:159]
v_mfma_f32_16x16x32_bf16 v[156:159], a[80:83], a[32:35], v[156:159]
ds_read_b64_tr_b16 a[80:81], v9 offset:32768
v_mfma_f32_16x16x32_bf16 v[24:27], a[88:91], a[32:35], v[24:27]
s_add_u32 m0, s76, 34816
ds_read_b64_tr_b16 a[82:83], v9 offset:33792
v_mfma_f32_16x16x32_bf16 v[24:27], a[92:95], a[36:39], v[24:27]
s_add_u32 s64, s72, 131712
ds_read_b64_tr_b16 a[84:85], v9 offset:40960
v_subrev_u32 v5, 0x8000, v5
v_mfma_f32_16x16x32_bf16 v[40:43], a[92:95], a[44:47], v[40:43]
buffer_load_dwordx4 v12, s[48:51], s64 offen lds
v_mfma_f32_16x16x32_bf16 v[40:43], a[88:91], a[40:43], v[40:43]
ds_read_b64_tr_b16 a[86:87], v9 offset:41984
v_mfma_f32_16x16x32_bf16 v[56:59], a[88:91], a[48:51], v[56:59]
v_mfma_f32_16x16x32_bf16 v[56:59], a[92:95], a[52:55], v[56:59]
s_add_u32 m0, s76, 35840
v_mfma_f32_16x16x32_bf16 v[72:75], a[92:95], a[60:63], v[72:75]
s_waitcnt vmcnt(13)
s_add_u32 s64, s72, 148096
ds_read_b128 a[0:3], v2 offset:0
v_mfma_f32_16x16x32_bf16 v[72:75], a[88:91], a[56:59], v[72:75]
buffer_load_dwordx4 v13, s[48:51], s64 offen lds
v_mfma_f32_16x16x32_bf16 v[136:139], a[96:99], a[56:59], v[136:139]
ds_read_b128 a[4:7], v3 offset:0
v_mfma_f32_16x16x32_bf16 v[136:139], a[100:103], a[60:63], v[136:139]
ds_read_b128 a[8:11], v2 offset:2048
v_subrev_u32 v6, 0x8000, v6
v_mfma_f32_16x16x32_bf16 v[120:123], a[100:103], a[52:55], v[120:123]
s_add_u32 m0, s76, 36864
ds_read_b128 a[12:15], v3 offset:2048
v_mfma_f32_16x16x32_bf16 v[120:123], a[96:99], a[48:51], v[120:123]
s_add_u32 s64, s73, 640
ds_read_b128 a[16:19], v2 offset:4096
v_mfma_f32_16x16x32_bf16 v[104:107], a[96:99], a[40:43], v[104:107]
buffer_load_dwordx4 v12, s[48:51], s64 offen lds
v_mfma_f32_16x16x32_bf16 v[104:107], a[100:103], a[44:47], v[104:107]
ds_read_b128 a[20:23], v3 offset:4096
v_mfma_f32_16x16x32_bf16 v[88:91], a[100:103], a[36:39], v[88:91]
ds_read_b128 a[24:27], v2 offset:6144
v_mfma_f32_16x16x32_bf16 v[88:91], a[96:99], a[32:35], v[88:91]
s_waitcnt lgkmcnt(7)
s_add_u32 m0, s76, 37888
ds_read_b128 a[28:31], v3 offset:6144
v_mfma_f32_16x16x32_bf16 v[28:31], a[104:107], a[32:35], v[28:31]
s_add_u32 s64, s73, 17024
ds_read_b64_tr_b16 a[88:89], v10 offset:32768
v_mfma_f32_16x16x32_bf16 v[28:31], a[108:111], a[36:39], v[28:31]
buffer_load_dwordx4 v13, s[48:51], s64 offen lds
v_mfma_f32_16x16x32_bf16 v[44:47], a[108:111], a[44:47], v[44:47]
ds_read_b64_tr_b16 a[90:91], v10 offset:33792
v_subrev_u32 v7, 0x8000, v7
v_mfma_f32_16x16x32_bf16 v[44:47], a[104:107], a[40:43], v[44:47]
s_add_u32 s65, s79, 18432
ds_read_b64_tr_b16 a[92:93], v10 offset:40960
v_mfma_f32_16x16x32_bf16 v[60:63], a[104:107], a[48:51], v[60:63]
s_add_u32 m0, s76, 38912
buffer_store_dwordx4 a[168:171], v16, s[44:47], s65 offen sc1
v_mfma_f32_16x16x32_bf16 v[60:63], a[108:111], a[52:55], v[60:63]
s_add_u32 s64, s73, 131712
ds_read_b64_tr_b16 a[94:95], v10 offset:41984
v_mfma_f32_16x16x32_bf16 v[76:79], a[108:111], a[60:63], v[76:79]
buffer_load_dwordx4 v12, s[48:51], s64 offen lds
v_mfma_f32_16x16x32_bf16 v[76:79], a[104:107], a[56:59], v[76:79]
ds_read_b64_tr_b16 a[96:97], v11 offset:32768
v_mfma_f32_16x16x32_bf16 v[140:143], a[112:115], a[56:59], v[140:143]
ds_read_b64_tr_b16 a[98:99], v11 offset:33792
v_mfma_f32_16x16x32_bf16 v[140:143], a[116:119], a[60:63], v[140:143]
s_add_u32 m0, s76, 39936
ds_read_b64_tr_b16 a[100:101], v11 offset:40960
v_subrev_u32 v8, 0x8000, v8
v_mfma_f32_16x16x32_bf16 v[124:127], a[116:119], a[52:55], v[124:127]
s_add_u32 s64, s73, 148096
ds_read_b64_tr_b16 a[102:103], v11 offset:41984
v_mfma_f32_16x16x32_bf16 v[124:127], a[112:115], a[48:51], v[124:127]
buffer_load_dwordx4 v13, s[48:51], s64 offen lds
v_mfma_f32_16x16x32_bf16 v[108:111], a[112:115], a[40:43], v[108:111]
v_mfma_f32_16x16x32_bf16 v[108:111], a[116:119], a[44:47], v[108:111]
v_mfma_f32_16x16x32_bf16 v[92:95], a[116:119], a[36:39], v[92:95]
v_subrev_u32 v9, 0x8000, v9
v_subrev_u32 v10, 0x8000, v10
v_mfma_f32_16x16x32_bf16 v[92:95], a[112:115], a[32:35], v[92:95]
v_subrev_u32 v11, 0x8000, v11
v_mfma_f32_16x16x32_bf16 v[32:35], a[72:75], a[32:35], v[32:35]
v_mfma_f32_16x16x32_bf16 v[32:35], a[76:79], a[36:39], v[32:35]
v_mfma_f32_16x16x32_bf16 v[48:51], a[76:79], a[44:47], v[48:51]
s_waitcnt lgkmcnt(0)
s_barrier
v_mfma_f32_16x16x32_bf16 v[48:51], a[72:75], a[40:43], v[48:51]
s_add_u32 m0, s77, 131072
ds_read_b64_tr_b16 a[104:105], v19 offset:4096
v_mfma_f32_16x16x32_bf16 v[64:67], a[72:75], a[48:51], v[64:67]
s_add_u32 s64, s71, 3145728
ds_read_b64_tr_b16 a[106:107], v19 offset:4352
v_mfma_f32_16x16x32_bf16 v[64:67], a[76:79], a[52:55], v[64:67]
buffer_load_dwordx4 v14, s[56:59], s64 offen lds
v_mfma_f32_16x16x32_bf16 v[80:83], a[76:79], a[60:63], v[80:83]
ds_read_b64_tr_b16 a[108:109], v19 offset:6144
v_mfma_f32_16x16x32_bf16 v[80:83], a[72:75], a[56:59], v[80:83]
ds_read_b64_tr_b16 a[110:111], v19 offset:6400
v_mfma_f32_16x16x32_bf16 v[144:147], a[80:83], a[56:59], v[144:147]
ds_read_b64_tr_b16 a[112:113], v20 offset:4096
v_mfma_f32_16x16x32_bf16 v[144:147], a[84:87], a[60:63], v[144:147]
ds_read_b64_tr_b16 a[114:115], v20 offset:4352
v_mfma_f32_16x16x32_bf16 v[128:131], a[84:87], a[52:55], v[128:131]
ds_read_b64_tr_b16 a[116:117], v20 offset:6144
v_mfma_f32_16x16x32_bf16 v[128:131], a[80:83], a[48:51], v[128:131]
ds_read_b64_tr_b16 a[118:119], v20 offset:6400
v_mfma_f32_16x16x32_bf16 v[112:115], a[80:83], a[40:43], v[112:115]
s_add_u32 m0, s78, 147456
ds_read_b64_tr_b16 a[72:73], v19 offset:8192
v_mfma_f32_16x16x32_bf16 v[112:115], a[84:87], a[44:47], v[112:115]
s_add_u32 s64, s75, 2359296
ds_read_b64_tr_b16 a[74:75], v19 offset:8448
v_mfma_f32_16x16x32_bf16 v[96:99], a[84:87], a[36:39], v[96:99]
buffer_load_dwordx4 v23, s[60:63], s64 offen lds
v_mfma_f32_16x16x32_bf16 v[96:99], a[80:83], a[32:35], v[96:99]
ds_read_b64_tr_b16 a[76:77], v19 offset:10240
v_mfma_f32_16x16x32_bf16 v[36:39], a[88:91], a[32:35], v[36:39]
ds_read_b64_tr_b16 a[78:79], v19 offset:10496
v_mfma_f32_16x16x32_bf16 v[36:39], a[92:95], a[36:39], v[36:39]
ds_read_b64_tr_b16 a[80:81], v20 offset:8192
v_mfma_f32_16x16x32_bf16 v[52:55], a[92:95], a[44:47], v[52:55]
ds_read_b64_tr_b16 a[82:83], v20 offset:8448
v_mfma_f32_16x16x32_bf16 v[52:55], a[88:91], a[40:43], v[52:55]
ds_read_b64_tr_b16 a[84:85], v20 offset:10240
v_mfma_f32_16x16x32_bf16 v[68:71], a[88:91], a[48:51], v[68:71]
s_add_u32 m0, s77, 132096
ds_read_b64_tr_b16 a[86:87], v20 offset:10496
v_mfma_f32_16x16x32_bf16 v[68:71], a[92:95], a[52:55], v[68:71]
s_add_u32 s64, s71, 3178496
s_xor_b32 s68, s66, 12288
v_mfma_f32_16x16x32_bf16 v[84:87], a[92:95], a[60:63], v[84:87]
s_mov_b64 exec, 1
buffer_atomic_add a251, v1, s[52:55], s68 offen offset:0 sc1
s_mov_b64 exec, -1
v_mfma_f32_16x16x32_bf16 v[84:87], a[88:91], a[56:59], v[84:87]
buffer_load_dwordx4 v14, s[56:59], s64 offen lds
v_mfma_f32_16x16x32_bf16 v[148:151], a[96:99], a[56:59], v[148:151]
ds_read_b64_tr_b16 a[88:89], v19 offset:0
v_mfma_f32_16x16x32_bf16 v[148:151], a[100:103], a[60:63], v[148:151]
ds_read_b64_tr_b16 a[90:91], v19 offset:256
v_mfma_f32_16x16x32_bf16 v[132:135], a[100:103], a[52:55], v[132:135]
ds_read_b64_tr_b16 a[92:93], v19 offset:2048
v_mfma_f32_16x16x32_bf16 v[132:135], a[96:99], a[48:51], v[132:135]
ds_read_b64_tr_b16 a[94:95], v19 offset:2304
v_mfma_f32_16x16x32_bf16 v[116:119], a[96:99], a[40:43], v[116:119]
v_mfma_f32_16x16x32_bf16 v[116:119], a[100:103], a[44:47], v[116:119]
v_mfma_f32_16x16x32_bf16 v[100:103], a[100:103], a[36:39], v[100:103]
s_add_u32 m0, s78, 151552
v_mfma_f32_16x16x32_bf16 v[100:103], a[96:99], a[32:35], v[100:103]
s_waitcnt lgkmcnt(4)
s_add_u32 s64, s75, 2361344
ds_read_b64_tr_b16 a[96:97], v20 offset:0
v_mfma_f32_16x16x32_bf16 v[184:187], a[104:107], a[0:3], v[184:187]
s_mov_b32 s36, s20
buffer_load_dwordx4 v23, s[60:63], s64 offen lds
v_mfma_f32_16x16x32_bf16 v[184:187], a[108:111], a[4:7], v[184:187]
s_mov_b32 s37, s21
ds_read_b64_tr_b16 a[98:99], v20 offset:256
v_mfma_f32_16x16x32_bf16 v[192:195], a[108:111], a[12:15], v[192:195]
s_mov_b32 s38, 2097152
s_add_u32 s17, s78, .-L_pc+6144
ds_read_b64_tr_b16 a[100:101], v20 offset:2048
v_mfma_f32_16x16x32_bf16 v[192:195], a[104:107], a[8:11], v[192:195]
s_mov_b32 s40, s14
s_add_u32 s65, s79, 6144
ds_read_b64_tr_b16 a[102:103], v20 offset:2304
v_mfma_f32_16x16x32_bf16 v[200:203], a[104:107], a[16:19], v[200:203]
s_mov_b32 s41, s15
buffer_load_dword a252, v16, s[88:91], s17 offen
v_mfma_f32_16x16x32_bf16 v[200:203], a[108:111], a[20:23], v[200:203]
s_mov_b32 s42, 8388608
buffer_store_dwordx4 a[172:175], v16, s[44:47], s65 offen sc1
v_mfma_f32_16x16x32_bf16 v[208:211], a[108:111], a[28:31], v[208:211]
v_mfma_f32_16x16x32_bf16 v[208:211], a[104:107], a[24:27], v[208:211]
ds_read_b64_tr_b16 a[104:105], v4 offset:0
v_mfma_f32_16x16x32_bf16 v[212:215], a[112:115], a[24:27], v[212:215]
s_add_u32 m0, s77, 133120
ds_read_b64_tr_b16 a[106:107], v4 offset:1024
v_mfma_f32_16x16x32_bf16 v[212:215], a[116:119], a[28:31], v[212:215]
s_add_u32 s64, s71, 3211264
ds_read_b64_tr_b16 a[108:109], v4 offset:8192
v_mfma_f32_16x16x32_bf16 v[204:207], a[116:119], a[20:23], v[204:207]
buffer_load_dwordx4 v15, s[56:59], s64 offen lds
v_mfma_f32_16x16x32_bf16 v[204:207], a[112:115], a[16:19], v[204:207]
ds_read_b64_tr_b16 a[110:111], v4 offset:9216
v_mfma_f32_16x16x32_bf16 v[196:199], a[112:115], a[8:11], v[196:199]
v_mfma_f32_16x16x32_bf16 v[196:199], a[116:119], a[12:15], v[196:199]
v_mfma_f32_16x16x32_bf16 v[188:191], a[116:119], a[4:7], v[188:191]
v_mfma_f32_16x16x32_bf16 v[188:191], a[112:115], a[0:3], v[188:191]
ds_read_b64_tr_b16 a[112:113], v5 offset:0
v_mfma_f32_16x16x32_bf16 v[216:219], a[0:3], a[72:75], v[216:219]
ds_read_b64_tr_b16 a[114:115], v5 offset:1024
v_mfma_f32_16x16x32_bf16 v[216:219], a[4:7], a[76:79], v[216:219]
s_add_u32 m0, s78, 155648
ds_read_b64_tr_b16 a[116:117], v5 offset:8192
v_mfma_f32_16x16x32_bf16 v[224:227], a[12:15], a[76:79], v[224:227]
s_add_u32 s64, s75, 2363392
ds_read_b64_tr_b16 a[118:119], v5 offset:9216
v_mfma_f32_16x16x32_bf16 v[224:227], a[8:11], a[72:75], v[224:227]
buffer_load_dwordx4 v23, s[60:63], s64 offen lds
v_mfma_f32_16x16x32_bf16 v[232:235], a[16:19], a[72:75], v[232:235]
v_mfma_f32_16x16x32_bf16 v[232:235], a[20:23], a[76:79], v[232:235]
v_mfma_f32_16x16x32_bf16 v[240:243], a[28:31], a[76:79], v[240:243]
v_mfma_f32_16x16x32_bf16 v[240:243], a[24:27], a[72:75], v[240:243]
ds_read_b64_tr_b16 a[72:73], v6 offset:0
v_mfma_f32_16x16x32_bf16 v[244:247], a[24:27], a[80:83], v[244:247]
ds_read_b64_tr_b16 a[74:75], v6 offset:1024
v_mfma_f32_16x16x32_bf16 v[244:247], a[28:31], a[84:87], v[244:247]
ds_read_b64_tr_b16 a[76:77], v6 offset:8192
v_mfma_f32_16x16x32_bf16 v[236:239], a[20:23], a[84:87], v[236:239]
s_add_u32 m0, s77, 134144
ds_read_b64_tr_b16 a[78:79], v6 offset:9216
v_mfma_f32_16x16x32_bf16 v[236:239], a[16:19], a[80:83], v[236:239]
s_add_u32 s64, s71, 3244032
v_mfma_f32_16x16x32_bf16 v[228:231], a[8:11], a[80:83], v[228:231]
buffer_load_dwordx4 v15, s[56:59], s64 offen lds
v_mfma_f32_16x16x32_bf16 v[228:231], a[12:15], a[84:87], v[228:231]
v_mfma_f32_16x16x32_bf16 v[220:223], a[4:7], a[84:87], v[220:223]
v_mfma_f32_16x16x32_bf16 v[220:223], a[0:3], a[80:83], v[220:223]
s_waitcnt lgkmcnt(4)
ds_read_b64_tr_b16 a[80:81], v7 offset:0
v_mfma_f32_16x16x32_bf16 v[152:155], a[88:91], a[0:3], v[152:155]
ds_read_b64_tr_b16 a[82:83], v7 offset:1024
v_mfma_f32_16x16x32_bf16 v[152:155], a[92:95], a[4:7], v[152:155]
ds_read_b64_tr_b16 a[84:85], v7 offset:8192
v_mfma_f32_16x16x32_bf16 v[160:163], a[92:95], a[12:15], v[160:163]
ds_read_b64_tr_b16 a[86:87], v7 offset:9216
v_mfma_f32_16x16x32_bf16 v[160:163], a[88:91], a[8:11], v[160:163]
v_mfma_f32_16x16x32_bf16 v[168:171], a[88:91], a[16:19], v[168:171]
v_mfma_f32_16x16x32_bf16 v[168:171], a[92:95], a[20:23], v[168:171]
v_mfma_f32_16x16x32_bf16 v[176:179], a[92:95], a[28:31], v[176:179]
s_add_u32 m0, s76, 0
v_mfma_f32_16x16x32_bf16 v[176:179], a[88:91], a[24:27], v[176:179]
s_add_u32 s64, s72, 768
ds_read_b64_tr_b16 a[88:89], v8 offset:0
v_mfma_f32_16x16x32_bf16 v[180:183], a[96:99], a[24:27], v[180:183]
buffer_load_dwordx4 v12, s[48:51], s64 offen lds
v_mfma_f32_16x16x32_bf16 v[180:183], a[100:103], a[28:31], v[180:183]
ds_read_b64_tr_b16 a[90:91], v8 offset:1024
v_mfma_f32_16x16x32_bf16 v[172:175], a[100:103], a[20:23], v[172:175]
ds_read_b64_tr_b16 a[92:93], v8 offset:8192
v_mfma_f32_16x16x32_bf16 v[172:175], a[96:99], a[16:19], v[172:175]
s_add_u32 m0, s76, 1024
ds_read_b64_tr_b16 a[94:95], v8 offset:9216
v_mfma_f32_16x16x32_bf16 v[164:167], a[96:99], a[8:11], v[164:167]
s_add_u32 s64, s72, 17152
v_mfma_f32_16x16x32_bf16 v[164:167], a[100:103], a[12:15], v[164:167]
buffer_load_dwordx4 v13, s[48:51], s64 offen lds
v_mfma_f32_16x16x32_bf16 v[156:159], a[100:103], a[4:7], v[156:159]
v_mfma_f32_16x16x32_bf16 v[156:159], a[96:99], a[0:3], v[156:159]
ds_read_b64_tr_b16 a[96:97], v9 offset:0
v_mfma_f32_16x16x32_bf16 v[24:27], a[104:107], a[0:3], v[24:27]
s_add_u32 m0, s76, 2048
ds_read_b64_tr_b16 a[98:99], v9 offset:1024
v_mfma_f32_16x16x32_bf16 v[24:27], a[108:111], a[4:7], v[24:27]
s_add_u32 s64, s72, 131840
ds_read_b64_tr_b16 a[100:101], v9 offset:8192
v_mfma_f32_16x16x32_bf16 v[40:43], a[108:111], a[12:15], v[40:43]
buffer_load_dwordx4 v12, s[48:51], s64 offen lds
v_mfma_f32_16x16x32_bf16 v[40:43], a[104:107], a[8:11], v[40:43]
ds_read_b64_tr_b16 a[102:103], v9 offset:9216
v_mfma_f32_16x16x32_bf16 v[56:59], a[104:107], a[16:19], v[56:59]
v_mfma_f32_16x16x32_bf16 v[56:59], a[108:111], a[20:23], v[56:59]
s_add_u32 m0, s76, 3072
v_mfma_f32_16x16x32_bf16 v[72:75], a[108:111], a[28:31], v[72:75]
s_waitcnt vmcnt(13)
s_add_u32 s64, s72, 148224
ds_read_b128 a[32:35], v2 offset:32768
v_mfma_f32_16x16x32_bf16 v[72:75], a[104:107], a[24:27], v[72:75]
s_add_u32 s65, s79, 2048
buffer_load_dwordx4 v13, s[48:51], s64 offen lds
v_mfma_f32_16x16x32_bf16 v[136:139], a[112:115], a[24:27], v[136:139]
buffer_store_dwordx4 a[176:179], v16, s[44:47], s65 offen sc1
v_mfma_f32_16x16x32_bf16 v[136:139], a[116:119], a[28:31], v[136:139]
ds_read_b128 a[36:39], v3 offset:32768
v_mfma_f32_16x16x32_bf16 v[120:123], a[116:119], a[20:23], v[120:123]
s_add_u32 m0, s76, 4096
ds_read_b128 a[40:43], v2 offset:34816
v_mfma_f32_16x16x32_bf16 v[120:123], a[112:115], a[16:19], v[120:123]
s_add_u32 s64, s73, 768
ds_read_b128 a[44:47], v3 offset:34816
v_mfma_f32_16x16x32_bf16 v[104:107], a[112:115], a[8:11], v[104:107]
buffer_load_dwordx4 v12, s[48:51], s64 offen lds
v_mfma_f32_16x16x32_bf16 v[104:107], a[116:119], a[12:15], v[104:107]
ds_read_b128 a[48:51], v2 offset:36864
v_mfma_f32_16x16x32_bf16 v[88:91], a[116:119], a[4:7], v[88:91]
ds_read_b128 a[52:55], v3 offset:36864
v_mfma_f32_16x16x32_bf16 v[88:91], a[112:115], a[0:3], v[88:91]
s_waitcnt lgkmcnt(6)
s_add_u32 m0, s76, 5120
ds_read_b128 a[56:59], v2 offset:38912
v_mfma_f32_16x16x32_bf16 v[28:31], a[72:75], a[0:3], v[28:31]
s_add_u32 s64, s73, 17152
ds_read_b128 a[60:63], v3 offset:38912
v_mfma_f32_16x16x32_bf16 v[28:31], a[76:79], a[4:7], v[28:31]
buffer_load_dwordx4 v13, s[48:51], s64 offen lds
v_mfma_f32_16x16x32_bf16 v[44:47], a[76:79], a[12:15], v[44:47]
ds_read_b64_tr_b16 a[104:105], v10 offset:0
v_mfma_f32_16x16x32_bf16 v[44:47], a[72:75], a[8:11], v[44:47]
ds_read_b64_tr_b16 a[106:107], v10 offset:1024
v_mfma_f32_16x16x32_bf16 v[60:63], a[72:75], a[16:19], v[60:63]
s_add_u32 m0, s76, 6144
ds_read_b64_tr_b16 a[108:109], v10 offset:8192
v_mfma_f32_16x16x32_bf16 v[60:63], a[76:79], a[20:23], v[60:63]
s_add_u32 s64, s73, 131840
ds_read_b64_tr_b16 a[110:111], v10 offset:9216
v_mfma_f32_16x16x32_bf16 v[76:79], a[76:79], a[28:31], v[76:79]
buffer_load_dwordx4 v12, s[48:51], s64 offen lds
v_mfma_f32_16x16x32_bf16 v[76:79], a[72:75], a[24:27], v[76:79]
ds_read_b64_tr_b16 a[112:113], v11 offset:0
v_mfma_f32_16x16x32_bf16 v[140:143], a[80:83], a[24:27], v[140:143]
ds_read_b64_tr_b16 a[114:115], v11 offset:1024
v_mfma_f32_16x16x32_bf16 v[140:143], a[84:87], a[28:31], v[140:143]
s_add_u32 m0, s76, 7168
ds_read_b64_tr_b16 a[116:117], v11 offset:8192
v_mfma_f32_16x16x32_bf16 v[124:127], a[84:87], a[20:23], v[124:127]
s_add_u32 s64, s73, 148224
ds_read_b64_tr_b16 a[118:119], v11 offset:9216
v_mfma_f32_16x16x32_bf16 v[124:127], a[80:83], a[16:19], v[124:127]
buffer_load_dwordx4 v13, s[48:51], s64 offen lds
v_mfma_f32_16x16x32_bf16 v[108:111], a[80:83], a[8:11], v[108:111]
v_mfma_f32_16x16x32_bf16 v[108:111], a[84:87], a[12:15], v[108:111]
v_mfma_f32_16x16x32_bf16 v[92:95], a[84:87], a[4:7], v[92:95]
v_mfma_f32_16x16x32_bf16 v[92:95], a[80:83], a[0:3], v[92:95]
v_mfma_f32_16x16x32_bf16 v[32:35], a[88:91], a[0:3], v[32:35]
v_mfma_f32_16x16x32_bf16 v[32:35], a[92:95], a[4:7], v[32:35]
v_mfma_f32_16x16x32_bf16 v[48:51], a[92:95], a[12:15], v[48:51]
s_waitcnt lgkmcnt(0)
s_barrier
v_mfma_f32_16x16x32_bf16 v[48:51], a[88:91], a[8:11], v[48:51]
s_add_u32 m0, s77, 65536
ds_read_b64_tr_b16 a[72:73], v19 offset:36864
v_mfma_f32_16x16x32_bf16 v[64:67], a[88:91], a[16:19], v[64:67]
s_add_u32 s64, s71, 3670016
ds_read_b64_tr_b16 a[74:75], v19 offset:37120
v_mfma_f32_16x16x32_bf16 v[64:67], a[92:95], a[20:23], v[64:67]
buffer_load_dwordx4 v14, s[56:59], s64 offen lds
v_mfma_f32_16x16x32_bf16 v[80:83], a[92:95], a[28:31], v[80:83]
ds_read_b64_tr_b16 a[76:77], v19 offset:38912
v_mfma_f32_16x16x32_bf16 v[80:83], a[88:91], a[24:27], v[80:83]
ds_read_b64_tr_b16 a[78:79], v19 offset:39168
v_mfma_f32_16x16x32_bf16 v[144:147], a[96:99], a[24:27], v[144:147]
ds_read_b64_tr_b16 a[80:81], v20 offset:36864
v_mfma_f32_16x16x32_bf16 v[144:147], a[100:103], a[28:31], v[144:147]
ds_read_b64_tr_b16 a[82:83], v20 offset:37120
v_mfma_f32_16x16x32_bf16 v[128:131], a[100:103], a[20:23], v[128:131]
ds_read_b64_tr_b16 a[84:85], v20 offset:38912
v_mfma_f32_16x16x32_bf16 v[128:131], a[96:99], a[16:19], v[128:131]
ds_read_b64_tr_b16 a[86:87], v20 offset:39168
v_mfma_f32_16x16x32_bf16 v[112:115], a[96:99], a[8:11], v[112:115]
s_add_u32 m0, s78, 81920
ds_read_b64_tr_b16 a[88:89], v19 offset:40960
v_mfma_f32_16x16x32_bf16 v[112:115], a[100:103], a[12:15], v[112:115]
s_add_u32 s64, s75, 2752512
ds_read_b64_tr_b16 a[90:91], v19 offset:41216
v_mfma_f32_16x16x32_bf16 v[96:99], a[100:103], a[4:7], v[96:99]
buffer_load_dwordx4 v23, s[60:63], s64 offen lds
v_mfma_f32_16x16x32_bf16 v[96:99], a[96:99], a[0:3], v[96:99]
ds_read_b64_tr_b16 a[92:93], v19 offset:43008
v_mfma_f32_16x16x32_bf16 v[36:39], a[104:107], a[0:3], v[36:39]
ds_read_b64_tr_b16 a[94:95], v19 offset:43264
v_mfma_f32_16x16x32_bf16 v[36:39], a[108:111], a[4:7], v[36:39]
ds_read_b64_tr_b16 a[96:97], v20 offset:40960
v_mfma_f32_16x16x32_bf16 v[52:55], a[108:111], a[12:15], v[52:55]
ds_read_b64_tr_b16 a[98:99], v20 offset:41216
v_mfma_f32_16x16x32_bf16 v[52:55], a[104:107], a[8:11], v[52:55]
ds_read_b64_tr_b16 a[100:101], v20 offset:43008
v_mfma_f32_16x16x32_bf16 v[68:71], a[104:107], a[16:19], v[68:71]
ds_read_b64_tr_b16 a[102:103], v20 offset:43264
v_mfma_f32_16x16x32_bf16 v[68:71], a[108:111], a[20:23], v[68:71]
s_add_u32 m0, s77, 66560
v_mfma_f32_16x16x32_bf16 v[84:87], a[108:111], a[28:31], v[84:87]
s_add_u32 s64, s71, 3702784
v_mfma_f32_16x16x32_bf16 v[84:87], a[104:107], a[24:27], v[84:87]
s_add_u32 s65, s79, 19456
buffer_load_dwordx4 v14, s[56:59], s64 offen lds
v_mfma_f32_16x16x32_bf16 v[148:151], a[112:115], a[24:27], v[148:151]
buffer_store_dwordx4 a[180:183], v16, s[44:47], s65 offen sc1
v_mfma_f32_16x16x32_bf16 v[148:151], a[116:119], a[28:31], v[148:151]
ds_read_b64_tr_b16 a[104:105], v19 offset:32768
v_mfma_f32_16x16x32_bf16 v[132:135], a[116:119], a[20:23], v[132:135]
ds_read_b64_tr_b16 a[106:107], v19 offset:33024
v_mfma_f32_16x16x32_bf16 v[132:135], a[112:115], a[16:19], v[132:135]
ds_read_b64_tr_b16 a[108:109], v19 offset:34816
v_mfma_f32_16x16x32_bf16 v[116:119], a[112:115], a[8:11], v[116:119]
ds_read_b64_tr_b16 a[110:111], v19 offset:35072
v_mfma_f32_16x16x32_bf16 v[116:119], a[116:119], a[12:15], v[116:119]
v_mfma_f32_16x16x32_bf16 v[100:103], a[116:119], a[4:7], v[100:103]
s_add_u32 m0, s78, 86016
v_mfma_f32_16x16x32_bf16 v[100:103], a[112:115], a[0:3], v[100:103]
s_waitcnt lgkmcnt(4)
s_add_u32 s64, s75, 2754560
ds_read_b64_tr_b16 a[112:113], v20 offset:32768
v_mfma_f32_16x16x32_bf16 v[184:187], a[72:75], a[32:35], v[184:187]
buffer_load_dwordx4 v23, s[60:63], s64 offen lds
v_mfma_f32_16x16x32_bf16 v[184:187], a[76:79], a[36:39], v[184:187]
ds_read_b64_tr_b16 a[114:115], v20 offset:33024
v_mfma_f32_16x16x32_bf16 v[192:195], a[76:79], a[44:47], v[192:195]
ds_read_b64_tr_b16 a[116:117], v20 offset:34816
v_mfma_f32_16x16x32_bf16 v[192:195], a[72:75], a[40:43], v[192:195]
ds_read_b64_tr_b16 a[118:119], v20 offset:35072
v_mfma_f32_16x16x32_bf16 v[200:203], a[72:75], a[48:51], v[200:203]
v_mfma_f32_16x16x32_bf16 v[200:203], a[76:79], a[52:55], v[200:203]
v_mfma_f32_16x16x32_bf16 v[208:211], a[76:79], a[60:63], v[208:211]
v_mfma_f32_16x16x32_bf16 v[208:211], a[72:75], a[56:59], v[208:211]
ds_read_b64_tr_b16 a[72:73], v4 offset:32768
v_mfma_f32_16x16x32_bf16 v[212:215], a[80:83], a[56:59], v[212:215]
s_add_u32 m0, s77, 67584
ds_read_b64_tr_b16 a[74:75], v4 offset:33792
v_mfma_f32_16x16x32_bf16 v[212:215], a[84:87], a[60:63], v[212:215]
s_add_u32 s64, s71, 3735552
ds_read_b64_tr_b16 a[76:77], v4 offset:40960
v_mfma_f32_16x16x32_bf16 v[204:207], a[84:87], a[52:55], v[204:207]
buffer_load_dwordx4 v15, s[56:59], s64 offen lds
v_mfma_f32_16x16x32_bf16 v[204:207], a[80:83], a[48:51], v[204:207]
ds_read_b64_tr_b16 a[78:79], v4 offset:41984
v_mfma_f32_16x16x32_bf16 v[196:199], a[80:83], a[40:43], v[196:199]
v_mfma_f32_16x16x32_bf16 v[196:199], a[84:87], a[44:47], v[196:199]
v_mfma_f32_16x16x32_bf16 v[188:191], a[84:87], a[36:39], v[188:191]
v_mfma_f32_16x16x32_bf16 v[188:191], a[80:83], a[32:35], v[188:191]
ds_read_b64_tr_b16 a[80:81], v5 offset:32768
v_mfma_f32_16x16x32_bf16 v[216:219], a[32:35], a[88:91], v[216:219]
ds_read_b64_tr_b16 a[82:83], v5 offset:33792
v_mfma_f32_16x16x32_bf16 v[216:219], a[36:39], a[92:95], v[216:219]
s_add_u32 m0, s78, 90112
ds_read_b64_tr_b16 a[84:85], v5 offset:40960
v_mfma_f32_16x16x32_bf16 v[224:227], a[44:47], a[92:95], v[224:227]
s_add_u32 s64, s75, 2756608
ds_read_b64_tr_b16 a[86:87], v5 offset:41984
v_mfma_f32_16x16x32_bf16 v[224:227], a[40:43], a[88:91], v[224:227]
buffer_load_dwordx4 v23, s[60:63], s64 offen lds
v_mfma_f32_16x16x32_bf16 v[232:235], a[48:51], a[88:91], v[232:235]
v_mfma_f32_16x16x32_bf16 v[232:235], a[52:55], a[92:95], v[232:235]
v_mfma_f32_16x16x32_bf16 v[240:243], a[60:63], a[92:95], v[240:243]
v_mfma_f32_16x16x32_bf16 v[240:243], a[56:59], a[88:91], v[240:243]
ds_read_b64_tr_b16 a[88:89], v6 offset:32768
v_mfma_f32_16x16x32_bf16 v[244:247], a[56:59], a[96:99], v[244:247]
ds_read_b64_tr_b16 a[90:91], v6 offset:33792
v_mfma_f32_16x16x32_bf16 v[244:247], a[60:63], a[100:103], v[244:247]
ds_read_b64_tr_b16 a[92:93], v6 offset:40960
v_add_u32 v19, 0x8000, v19
v_mfma_f32_16x16x32_bf16 v[236:239], a[52:55], a[100:103], v[236:239]
s_add_u32 m0, s77, 68608
ds_read_b64_tr_b16 a[94:95], v6 offset:41984
v_mfma_f32_16x16x32_bf16 v[236:239], a[48:51], a[96:99], v[236:239]
s_add_u32 s64, s71, 3768320
v_mfma_f32_16x16x32_bf16 v[228:231], a[40:43], a[96:99], v[228:231]
buffer_load_dwordx4 v15, s[56:59], s64 offen lds
v_mfma_f32_16x16x32_bf16 v[228:231], a[44:47], a[100:103], v[228:231]
v_mfma_f32_16x16x32_bf16 v[220:223], a[36:39], a[100:103], v[220:223]
v_mfma_f32_16x16x32_bf16 v[220:223], a[32:35], a[96:99], v[220:223]
s_waitcnt lgkmcnt(4)
ds_read_b64_tr_b16 a[96:97], v7 offset:32768
v_mfma_f32_16x16x32_bf16 v[152:155], a[104:107], a[32:35], v[152:155]
ds_read_b64_tr_b16 a[98:99], v7 offset:33792
v_mfma_f32_16x16x32_bf16 v[152:155], a[108:111], a[36:39], v[152:155]
ds_read_b64_tr_b16 a[100:101], v7 offset:40960
v_add_u32 v20, 0x8000, v20
v_mfma_f32_16x16x32_bf16 v[160:163], a[108:111], a[44:47], v[160:163]
ds_read_b64_tr_b16 a[102:103], v7 offset:41984
v_mfma_f32_16x16x32_bf16 v[160:163], a[104:107], a[40:43], v[160:163]
v_mfma_f32_16x16x32_bf16 v[168:171], a[104:107], a[48:51], v[168:171]
v_mfma_f32_16x16x32_bf16 v[168:171], a[108:111], a[52:55], v[168:171]
v_mfma_f32_16x16x32_bf16 v[176:179], a[108:111], a[60:63], v[176:179]
s_add_u32 m0, s76, 32768
v_mfma_f32_16x16x32_bf16 v[176:179], a[104:107], a[56:59], v[176:179]
s_add_u32 s64, s72, 896
ds_read_b64_tr_b16 a[104:105], v8 offset:32768
v_mfma_f32_16x16x32_bf16 v[180:183], a[112:115], a[56:59], v[180:183]
buffer_load_dwordx4 v12, s[48:51], s64 offen lds
v_mfma_f32_16x16x32_bf16 v[180:183], a[116:119], a[60:63], v[180:183]
s_add_u32 s65, s79, 7168
ds_read_b64_tr_b16 a[106:107], v8 offset:33792
v_add_u32 v4, 0x8000, v4
v_mfma_f32_16x16x32_bf16 v[172:175], a[116:119], a[52:55], v[172:175]
buffer_store_dwordx4 a[184:187], v16, s[44:47], s65 offen sc1
v_mfma_f32_16x16x32_bf16 v[172:175], a[112:115], a[48:51], v[172:175]
s_add_u32 m0, s76, 33792
ds_read_b64_tr_b16 a[108:109], v8 offset:40960
v_mfma_f32_16x16x32_bf16 v[164:167], a[112:115], a[40:43], v[164:167]
s_add_u32 s64, s72, 17280
ds_read_b64_tr_b16 a[110:111], v8 offset:41984
v_mfma_f32_16x16x32_bf16 v[164:167], a[116:119], a[44:47], v[164:167]
buffer_load_dwordx4 v13, s[48:51], s64 offen lds
v_mfma_f32_16x16x32_bf16 v[156:159], a[116:119], a[36:39], v[156:159]
v_mfma_f32_16x16x32_bf16 v[156:159], a[112:115], a[32:35], v[156:159]
ds_read_b64_tr_b16 a[112:113], v9 offset:32768
v_mfma_f32_16x16x32_bf16 v[24:27], a[72:75], a[32:35], v[24:27]
s_add_u32 m0, s76, 34816
ds_read_b64_tr_b16 a[114:115], v9 offset:33792
v_mfma_f32_16x16x32_bf16 v[24:27], a[76:79], a[36:39], v[24:27]
s_add_u32 s64, s72, 131968
ds_read_b64_tr_b16 a[116:117], v9 offset:40960
v_add_u32 v5, 0x8000, v5
v_mfma_f32_16x16x32_bf16 v[40:43], a[76:79], a[44:47], v[40:43]
buffer_load_dwordx4 v12, s[48:51], s64 offen lds
v_mfma_f32_16x16x32_bf16 v[40:43], a[72:75], a[40:43], v[40:43]
ds_read_b64_tr_b16 a[118:119], v9 offset:41984
v_mfma_f32_16x16x32_bf16 v[56:59], a[72:75], a[48:51], v[56:59]
v_mfma_f32_16x16x32_bf16 v[56:59], a[76:79], a[52:55], v[56:59]
s_add_u32 m0, s76, 35840
v_mfma_f32_16x16x32_bf16 v[72:75], a[76:79], a[60:63], v[72:75]
s_waitcnt vmcnt(12)
s_add_u32 s64, s72, 148352
ds_read_b128 a[0:3], v2 offset:0
v_mfma_f32_16x16x32_bf16 v[72:75], a[72:75], a[56:59], v[72:75]
buffer_load_dwordx4 v13, s[48:51], s64 offen lds
v_mfma_f32_16x16x32_bf16 v[136:139], a[80:83], a[56:59], v[136:139]
ds_read_b128 a[4:7], v3 offset:0
v_mfma_f32_16x16x32_bf16 v[136:139], a[84:87], a[60:63], v[136:139]
ds_read_b128 a[8:11], v2 offset:2048
v_add_u32 v6, 0x8000, v6
v_mfma_f32_16x16x32_bf16 v[120:123], a[84:87], a[52:55], v[120:123]
s_add_u32 m0, s76, 36864
ds_read_b128 a[12:15], v3 offset:2048
v_mfma_f32_16x16x32_bf16 v[120:123], a[80:83], a[48:51], v[120:123]
s_add_u32 s64, s73, 896
ds_read_b128 a[16:19], v2 offset:4096
v_mfma_f32_16x16x32_bf16 v[104:107], a[80:83], a[40:43], v[104:107]
buffer_load_dwordx4 v12, s[48:51], s64 offen lds
v_mfma_f32_16x16x32_bf16 v[104:107], a[84:87], a[44:47], v[104:107]
ds_read_b128 a[20:23], v3 offset:4096
v_mfma_f32_16x16x32_bf16 v[88:91], a[84:87], a[36:39], v[88:91]
ds_read_b128 a[24:27], v2 offset:6144
v_mfma_f32_16x16x32_bf16 v[88:91], a[80:83], a[32:35], v[88:91]
s_waitcnt lgkmcnt(7)
s_add_u32 m0, s76, 37888
ds_read_b128 a[28:31], v3 offset:6144
v_mfma_f32_16x16x32_bf16 v[28:31], a[88:91], a[32:35], v[28:31]
s_add_u32 s64, s73, 17280
ds_read_b64_tr_b16 a[72:73], v10 offset:32768
v_mfma_f32_16x16x32_bf16 v[28:31], a[92:95], a[36:39], v[28:31]
buffer_load_dwordx4 v13, s[48:51], s64 offen lds
v_mfma_f32_16x16x32_bf16 v[44:47], a[92:95], a[44:47], v[44:47]
ds_read_b64_tr_b16 a[74:75], v10 offset:33792
v_add_u32 v7, 0x8000, v7
v_mfma_f32_16x16x32_bf16 v[44:47], a[88:91], a[40:43], v[44:47]
ds_read_b64_tr_b16 a[76:77], v10 offset:40960
v_mfma_f32_16x16x32_bf16 v[60:63], a[88:91], a[48:51], v[60:63]
s_add_u32 m0, s76, 38912
ds_read_b64_tr_b16 a[78:79], v10 offset:41984
v_mfma_f32_16x16x32_bf16 v[60:63], a[92:95], a[52:55], v[60:63]
s_add_u32 s64, s73, 131968
ds_read_b64_tr_b16 a[80:81], v11 offset:32768
v_mfma_f32_16x16x32_bf16 v[76:79], a[92:95], a[60:63], v[76:79]
buffer_load_dwordx4 v12, s[48:51], s64 offen lds
v_mfma_f32_16x16x32_bf16 v[76:79], a[88:91], a[56:59], v[76:79]
ds_read_b64_tr_b16 a[82:83], v11 offset:33792
v_mfma_f32_16x16x32_bf16 v[140:143], a[96:99], a[56:59], v[140:143]
ds_read_b64_tr_b16 a[84:85], v11 offset:40960
v_mfma_f32_16x16x32_bf16 v[140:143], a[100:103], a[60:63], v[140:143]
s_add_u32 m0, s76, 39936
ds_read_b64_tr_b16 a[86:87], v11 offset:41984
v_add_u32 v8, 0x8000, v8
v_mfma_f32_16x16x32_bf16 v[124:127], a[100:103], a[52:55], v[124:127]
s_add_u32 s64, s73, 148352
v_mfma_f32_16x16x32_bf16 v[124:127], a[96:99], a[48:51], v[124:127]
buffer_load_dwordx4 v13, s[48:51], s64 offen lds
v_mfma_f32_16x16x32_bf16 v[108:111], a[96:99], a[40:43], v[108:111]
v_mfma_f32_16x16x32_bf16 v[108:111], a[100:103], a[44:47], v[108:111]
v_mfma_f32_16x16x32_bf16 v[92:95], a[100:103], a[36:39], v[92:95]
v_add_u32 v9, 0x8000, v9
v_add_u32 v10, 0x8000, v10
v_mfma_f32_16x16x32_bf16 v[92:95], a[96:99], a[32:35], v[92:95]
v_add_u32 v11, 0x8000, v11
v_mfma_f32_16x16x32_bf16 v[32:35], a[104:107], a[32:35], v[32:35]
v_mfma_f32_16x16x32_bf16 v[32:35], a[108:111], a[36:39], v[32:35]
v_mfma_f32_16x16x32_bf16 v[48:51], a[108:111], a[44:47], v[48:51]
s_waitcnt lgkmcnt(0)
s_barrier
v_mfma_f32_16x16x32_bf16 v[48:51], a[104:107], a[40:43], v[48:51]
s_add_u32 m0, s77, 98304
ds_read_b64_tr_b16 a[88:89], v19 offset:36864
v_mfma_f32_16x16x32_bf16 v[64:67], a[104:107], a[48:51], v[64:67]
s_add_u32 s64, s71, 4194304
ds_read_b64_tr_b16 a[90:91], v19 offset:37120
v_mfma_f32_16x16x32_bf16 v[64:67], a[108:111], a[52:55], v[64:67]
buffer_load_dwordx4 v14, s[56:59], s64 offen lds
v_mfma_f32_16x16x32_bf16 v[80:83], a[108:111], a[60:63], v[80:83]
ds_read_b64_tr_b16 a[92:93], v19 offset:38912
v_mfma_f32_16x16x32_bf16 v[80:83], a[104:107], a[56:59], v[80:83]
ds_read_b64_tr_b16 a[94:95], v19 offset:39168
v_mfma_f32_16x16x32_bf16 v[144:147], a[112:115], a[56:59], v[144:147]
ds_read_b64_tr_b16 a[96:97], v20 offset:36864
v_mfma_f32_16x16x32_bf16 v[144:147], a[116:119], a[60:63], v[144:147]
ds_read_b64_tr_b16 a[98:99], v20 offset:37120
v_mfma_f32_16x16x32_bf16 v[128:131], a[116:119], a[52:55], v[128:131]
s_add_u32 s65, s79, 3072
ds_read_b64_tr_b16 a[100:101], v20 offset:38912
v_mfma_f32_16x16x32_bf16 v[128:131], a[112:115], a[48:51], v[128:131]
buffer_store_dwordx4 a[188:191], v16, s[44:47], s65 offen sc1
v_mfma_f32_16x16x32_bf16 v[112:115], a[112:115], a[40:43], v[112:115]
s_add_u32 m0, s78, 114688
ds_read_b64_tr_b16 a[102:103], v20 offset:39168
v_mfma_f32_16x16x32_bf16 v[112:115], a[116:119], a[44:47], v[112:115]
s_add_u32 s64, s75, 3145728
ds_read_b64_tr_b16 a[104:105], v19 offset:40960
v_mfma_f32_16x16x32_bf16 v[96:99], a[116:119], a[36:39], v[96:99]
buffer_load_dwordx4 v23, s[60:63], s64 offen lds
v_mfma_f32_16x16x32_bf16 v[96:99], a[112:115], a[32:35], v[96:99]
ds_read_b64_tr_b16 a[106:107], v19 offset:41216
v_mfma_f32_16x16x32_bf16 v[36:39], a[72:75], a[32:35], v[36:39]
ds_read_b64_tr_b16 a[108:109], v19 offset:43008
v_mfma_f32_16x16x32_bf16 v[36:39], a[76:79], a[36:39], v[36:39]
ds_read_b64_tr_b16 a[110:111], v19 offset:43264
v_mfma_f32_16x16x32_bf16 v[52:55], a[76:79], a[44:47], v[52:55]
ds_read_b64_tr_b16 a[112:113], v20 offset:40960
v_mfma_f32_16x16x32_bf16 v[52:55], a[72:75], a[40:43], v[52:55]
ds_read_b64_tr_b16 a[114:115], v20 offset:41216
v_mfma_f32_16x16x32_bf16 v[68:71], a[72:75], a[48:51], v[68:71]
ds_read_b64_tr_b16 a[116:117], v20 offset:43008
v_mfma_f32_16x16x32_bf16 v[68:71], a[76:79], a[52:55], v[68:71]
s_add_u32 m0, s77, 99328
ds_read_b64_tr_b16 a[118:119], v20 offset:43264
v_mfma_f32_16x16x32_bf16 v[84:87], a[76:79], a[60:63], v[84:87]
s_add_u32 s64, s71, 4227072
v_mfma_f32_16x16x32_bf16 v[84:87], a[72:75], a[56:59], v[84:87]
buffer_load_dwordx4 v14, s[56:59], s64 offen lds
v_mfma_f32_16x16x32_bf16 v[148:151], a[80:83], a[56:59], v[148:151]
ds_read_b64_tr_b16 a[72:73], v19 offset:32768
v_mfma_f32_16x16x32_bf16 v[148:151], a[84:87], a[60:63], v[148:151]
ds_read_b64_tr_b16 a[74:75], v19 offset:33024
v_mfma_f32_16x16x32_bf16 v[132:135], a[84:87], a[52:55], v[132:135]
ds_read_b64_tr_b16 a[76:77], v19 offset:34816
v_mfma_f32_16x16x32_bf16 v[132:135], a[80:83], a[48:51], v[132:135]
ds_read_b64_tr_b16 a[78:79], v19 offset:35072
v_mfma_f32_16x16x32_bf16 v[116:119], a[80:83], a[40:43], v[116:119]
v_mfma_f32_16x16x32_bf16 v[116:119], a[84:87], a[44:47], v[116:119]
v_mfma_f32_16x16x32_bf16 v[100:103], a[84:87], a[36:39], v[100:103]
s_add_u32 m0, s78, 118784
v_mfma_f32_16x16x32_bf16 v[100:103], a[80:83], a[32:35], v[100:103]
s_waitcnt lgkmcnt(4)
s_add_u32 s64, s75, 3147776
ds_read_b64_tr_b16 a[80:81], v20 offset:32768
v_mfma_f32_16x16x32_bf16 v[184:187], a[88:91], a[0:3], v[184:187]
buffer_load_dwordx4 v23, s[60:63], s64 offen lds
v_mfma_f32_16x16x32_bf16 v[184:187], a[92:95], a[4:7], v[184:187]
ds_read_b64_tr_b16 a[82:83], v20 offset:33024
v_mfma_f32_16x16x32_bf16 v[192:195], a[92:95], a[12:15], v[192:195]
ds_read_b64_tr_b16 a[84:85], v20 offset:34816
v_mfma_f32_16x16x32_bf16 v[192:195], a[88:91], a[8:11], v[192:195]
s_add_u32 s17, s78, .-L_pc+6144
ds_read_b64_tr_b16 a[86:87], v20 offset:35072
v_mfma_f32_16x16x32_bf16 v[200:203], a[88:91], a[16:19], v[200:203]
buffer_load_dword a252, v16, s[88:91], s17 offen
v_mfma_f32_16x16x32_bf16 v[200:203], a[92:95], a[20:23], v[200:203]
v_mfma_f32_16x16x32_bf16 v[208:211], a[92:95], a[28:31], v[208:211]
v_mfma_f32_16x16x32_bf16 v[208:211], a[88:91], a[24:27], v[208:211]
ds_read_b64_tr_b16 a[88:89], v4 offset:32768
v_mfma_f32_16x16x32_bf16 v[212:215], a[96:99], a[24:27], v[212:215]
s_add_u32 m0, s77, 100352
ds_read_b64_tr_b16 a[90:91], v4 offset:33792
v_mfma_f32_16x16x32_bf16 v[212:215], a[100:103], a[28:31], v[212:215]
s_add_u32 s64, s71, 4259840
ds_read_b64_tr_b16 a[92:93], v4 offset:40960
v_mfma_f32_16x16x32_bf16 v[204:207], a[100:103], a[20:23], v[204:207]
buffer_load_dwordx4 v15, s[56:59], s64 offen lds
v_mfma_f32_16x16x32_bf16 v[204:207], a[96:99], a[16:19], v[204:207]
ds_read_b64_tr_b16 a[94:95], v4 offset:41984
v_mfma_f32_16x16x32_bf16 v[196:199], a[96:99], a[8:11], v[196:199]
v_mfma_f32_16x16x32_bf16 v[196:199], a[100:103], a[12:15], v[196:199]
v_mfma_f32_16x16x32_bf16 v[188:191], a[100:103], a[4:7], v[188:191]
v_mfma_f32_16x16x32_bf16 v[188:191], a[96:99], a[0:3], v[188:191]
ds_read_b64_tr_b16 a[96:97], v5 offset:32768
v_mfma_f32_16x16x32_bf16 v[216:219], a[0:3], a[104:107], v[216:219]
ds_read_b64_tr_b16 a[98:99], v5 offset:33792
v_mfma_f32_16x16x32_bf16 v[216:219], a[4:7], a[108:111], v[216:219]
s_add_u32 m0, s78, 122880
ds_read_b64_tr_b16 a[100:101], v5 offset:40960
v_mfma_f32_16x16x32_bf16 v[224:227], a[12:15], a[108:111], v[224:227]
s_add_u32 s64, s75, 3149824
ds_read_b64_tr_b16 a[102:103], v5 offset:41984
v_mfma_f32_16x16x32_bf16 v[224:227], a[8:11], a[104:107], v[224:227]
buffer_load_dwordx4 v23, s[60:63], s64 offen lds
v_mfma_f32_16x16x32_bf16 v[232:235], a[16:19], a[104:107], v[232:235]
v_mfma_f32_16x16x32_bf16 v[232:235], a[20:23], a[108:111], v[232:235]
v_mfma_f32_16x16x32_bf16 v[240:243], a[28:31], a[108:111], v[240:243]
v_mfma_f32_16x16x32_bf16 v[240:243], a[24:27], a[104:107], v[240:243]
ds_read_b64_tr_b16 a[104:105], v6 offset:32768
v_mfma_f32_16x16x32_bf16 v[244:247], a[24:27], a[112:115], v[244:247]
ds_read_b64_tr_b16 a[106:107], v6 offset:33792
v_mfma_f32_16x16x32_bf16 v[244:247], a[28:31], a[116:119], v[244:247]
ds_read_b64_tr_b16 a[108:109], v6 offset:40960
v_subrev_u32 v19, 0x8000, v19
v_mfma_f32_16x16x32_bf16 v[236:239], a[20:23], a[116:119], v[236:239]
s_add_u32 m0, s77, 101376
ds_read_b64_tr_b16 a[110:111], v6 offset:41984
v_mfma_f32_16x16x32_bf16 v[236:239], a[16:19], a[112:115], v[236:239]
s_add_u32 s64, s71, 4292608
v_mfma_f32_16x16x32_bf16 v[228:231], a[8:11], a[112:115], v[228:231]
s_add_u32 s65, s79, 24576
buffer_load_dwordx4 v15, s[56:59], s64 offen lds
v_mfma_f32_16x16x32_bf16 v[228:231], a[12:15], a[116:119], v[228:231]
buffer_store_dwordx4 a[192:195], v16, s[44:47], s65 offen sc1
v_mfma_f32_16x16x32_bf16 v[220:223], a[4:7], a[116:119], v[220:223]
v_mfma_f32_16x16x32_bf16 v[220:223], a[0:3], a[112:115], v[220:223]
s_waitcnt lgkmcnt(4)
ds_read_b64_tr_b16 a[112:113], v7 offset:32768
v_mfma_f32_16x16x32_bf16 v[152:155], a[72:75], a[0:3], v[152:155]
ds_read_b64_tr_b16 a[114:115], v7 offset:33792
v_mfma_f32_16x16x32_bf16 v[152:155], a[76:79], a[4:7], v[152:155]
ds_read_b64_tr_b16 a[116:117], v7 offset:40960
v_subrev_u32 v20, 0x8000, v20
v_mfma_f32_16x16x32_bf16 v[160:163], a[76:79], a[12:15], v[160:163]
ds_read_b64_tr_b16 a[118:119], v7 offset:41984
v_mfma_f32_16x16x32_bf16 v[160:163], a[72:75], a[8:11], v[160:163]
v_mfma_f32_16x16x32_bf16 v[168:171], a[72:75], a[16:19], v[168:171]
v_mfma_f32_16x16x32_bf16 v[168:171], a[76:79], a[20:23], v[168:171]
v_mfma_f32_16x16x32_bf16 v[176:179], a[76:79], a[28:31], v[176:179]
s_add_u32 m0, s76, 0
v_mfma_f32_16x16x32_bf16 v[176:179], a[72:75], a[24:27], v[176:179]
s_add_u32 s64, s72, 1024
ds_read_b64_tr_b16 a[72:73], v8 offset:32768
v_mfma_f32_16x16x32_bf16 v[180:183], a[80:83], a[24:27], v[180:183]
buffer_load_dwordx4 v12, s[48:51], s64 offen lds
v_mfma_f32_16x16x32_bf16 v[180:183], a[84:87], a[28:31], v[180:183]
ds_read_b64_tr_b16 a[74:75], v8 offset:33792
v_subrev_u32 v4, 0x8000, v4
v_mfma_f32_16x16x32_bf16 v[172:175], a[84:87], a[20:23], v[172:175]
ds_read_b64_tr_b16 a[76:77], v8 offset:40960
v_mfma_f32_16x16x32_bf16 v[172:175], a[80:83], a[16:19], v[172:175]
s_add_u32 m0, s76, 1024
ds_read_b64_tr_b16 a[78:79], v8 offset:41984
v_mfma_f32_16x16x32_bf16 v[164:167], a[80:83], a[8:11], v[164:167]
s_add_u32 s64, s72, 17408
v_mfma_f32_16x16x32_bf16 v[164:167], a[84:87], a[12:15], v[164:167]
buffer_load_dwordx4 v13, s[48:51], s64 offen lds
v_mfma_f32_16x16x32_bf16 v[156:159], a[84:87], a[4:7], v[156:159]
v_mfma_f32_16x16x32_bf16 v[156:159], a[80:83], a[0:3], v[156:159]
ds_read_b64_tr_b16 a[80:81], v9 offset:32768
v_mfma_f32_16x16x32_bf16 v[24:27], a[88:91], a[0:3], v[24:27]
s_add_u32 m0, s76, 2048
ds_read_b64_tr_b16 a[82:83], v9 offset:33792
v_mfma_f32_16x16x32_bf16 v[24:27], a[92:95], a[4:7], v[24:27]
s_add_u32 s64, s72, 132096
ds_read_b64_tr_b16 a[84:85], v9 offset:40960
v_subrev_u32 v5, 0x8000, v5
v_mfma_f32_16x16x32_bf16 v[40:43], a[92:95], a[12:15], v[40:43]
buffer_load_dwordx4 v12, s[48:51], s64 offen lds
v_mfma_f32_16x16x32_bf16 v[40:43], a[88:91], a[8:11], v[40:43]
ds_read_b64_tr_b16 a[86:87], v9 offset:41984
v_mfma_f32_16x16x32_bf16 v[56:59], a[88:91], a[16:19], v[56:59]
v_mfma_f32_16x16x32_bf16 v[56:59], a[92:95], a[20:23], v[56:59]
s_add_u32 m0, s76, 3072
v_mfma_f32_16x16x32_bf16 v[72:75], a[92:95], a[28:31], v[72:75]
s_waitcnt vmcnt(13)
s_add_u32 s64, s72, 148480
ds_read_b128 a[32:35], v2 offset:32768
v_mfma_f32_16x16x32_bf16 v[72:75], a[88:91], a[24:27], v[72:75]
buffer_load_dwordx4 v13, s[48:51], s64 offen lds
v_mfma_f32_16x16x32_bf16 v[136:139], a[96:99], a[24:27], v[136:139]
ds_read_b128 a[36:39], v3 offset:32768
v_mfma_f32_16x16x32_bf16 v[136:139], a[100:103], a[28:31], v[136:139]
ds_read_b128 a[40:43], v2 offset:34816
v_subrev_u32 v6, 0x8000, v6
v_mfma_f32_16x16x32_bf16 v[120:123], a[100:103], a[20:23], v[120:123]
s_add_u32 m0, s76, 4096
ds_read_b128 a[44:47], v3 offset:34816
v_mfma_f32_16x16x32_bf16 v[120:123], a[96:99], a[16:19], v[120:123]
s_add_u32 s64, s73, 1024
ds_read_b128 a[48:51], v2 offset:36864
v_mfma_f32_16x16x32_bf16 v[104:107], a[96:99], a[8:11], v[104:107]
buffer_load_dwordx4 v12, s[48:51], s64 offen lds
v_mfma_f32_16x16x32_bf16 v[104:107], a[100:103], a[12:15], v[104:107]
ds_read_b128 a[52:55], v3 offset:36864
v_mfma_f32_16x16x32_bf16 v[88:91], a[100:103], a[4:7], v[88:91]
ds_read_b128 a[56:59], v2 offset:38912
v_mfma_f32_16x16x32_bf16 v[88:91], a[96:99], a[0:3], v[88:91]
s_waitcnt lgkmcnt(7)
s_add_u32 m0, s76, 5120
ds_read_b128 a[60:63], v3 offset:38912
v_mfma_f32_16x16x32_bf16 v[28:31], a[104:107], a[0:3], v[28:31]
s_add_u32 s64, s73, 17408
ds_read_b64_tr_b16 a[88:89], v10 offset:32768
v_mfma_f32_16x16x32_bf16 v[28:31], a[108:111], a[4:7], v[28:31]
buffer_load_dwordx4 v13, s[48:51], s64 offen lds
v_mfma_f32_16x16x32_bf16 v[44:47], a[108:111], a[12:15], v[44:47]
ds_read_b64_tr_b16 a[90:91], v10 offset:33792
v_subrev_u32 v7, 0x8000, v7
v_mfma_f32_16x16x32_bf16 v[44:47], a[104:107], a[8:11], v[44:47]
ds_read_b64_tr_b16 a[92:93], v10 offset:40960
v_mfma_f32_16x16x32_bf16 v[60:63], a[104:107], a[16:19], v[60:63]
s_add_u32 m0, s76, 6144
ds_read_b64_tr_b16 a[94:95], v10 offset:41984
v_mfma_f32_16x16x32_bf16 v[60:63], a[108:111], a[20:23], v[60:63]
s_add_u32 s64, s73, 132096
ds_read_b64_tr_b16 a[96:97], v11 offset:32768
v_mfma_f32_16x16x32_bf16 v[76:79], a[108:111], a[28:31], v[76:79]
buffer_load_dwordx4 v12, s[48:51], s64 offen lds
v_mfma_f32_16x16x32_bf16 v[76:79], a[104:107], a[24:27], v[76:79]
ds_read_b64_tr_b16 a[98:99], v11 offset:33792
v_mfma_f32_16x16x32_bf16 v[140:143], a[112:115], a[24:27], v[140:143]
ds_read_b64_tr_b16 a[100:101], v11 offset:40960
v_mfma_f32_16x16x32_bf16 v[140:143], a[116:119], a[28:31], v[140:143]
s_add_u32 m0, s76, 7168
ds_read_b64_tr_b16 a[102:103], v11 offset:41984
v_subrev_u32 v8, 0x8000, v8
v_mfma_f32_16x16x32_bf16 v[124:127], a[116:119], a[20:23], v[124:127]
s_add_u32 s64, s73, 148480
v_mfma_f32_16x16x32_bf16 v[124:127], a[112:115], a[16:19], v[124:127]
buffer_load_dwordx4 v13, s[48:51], s64 offen lds
v_mfma_f32_16x16x32_bf16 v[108:111], a[112:115], a[8:11], v[108:111]
v_mfma_f32_16x16x32_bf16 v[108:111], a[116:119], a[12:15], v[108:111]
v_mfma_f32_16x16x32_bf16 v[92:95], a[116:119], a[4:7], v[92:95]
v_subrev_u32 v9, 0x8000, v9
v_subrev_u32 v10, 0x8000, v10
v_mfma_f32_16x16x32_bf16 v[92:95], a[112:115], a[0:3], v[92:95]
s_add_u32 s65, s79, 25600
v_subrev_u32 v11, 0x8000, v11
v_mfma_f32_16x16x32_bf16 v[32:35], a[72:75], a[0:3], v[32:35]
buffer_store_dwordx4 a[196:199], v16, s[44:47], s65 offen sc1
v_mfma_f32_16x16x32_bf16 v[32:35], a[76:79], a[4:7], v[32:35]
v_mfma_f32_16x16x32_bf16 v[48:51], a[76:79], a[12:15], v[48:51]
s_waitcnt lgkmcnt(0)
s_barrier
v_mfma_f32_16x16x32_bf16 v[48:51], a[72:75], a[8:11], v[48:51]
s_add_u32 m0, s77, 131072
ds_read_b64_tr_b16 a[104:105], v19 offset:4096
v_mfma_f32_16x16x32_bf16 v[64:67], a[72:75], a[16:19], v[64:67]
s_add_u32 s64, s71, 4718592
ds_read_b64_tr_b16 a[106:107], v19 offset:4352
v_mfma_f32_16x16x32_bf16 v[64:67], a[76:79], a[20:23], v[64:67]
buffer_load_dwordx4 v14, s[56:59], s64 offen lds
v_mfma_f32_16x16x32_bf16 v[80:83], a[76:79], a[28:31], v[80:83]
ds_read_b64_tr_b16 a[108:109], v19 offset:6144
v_mfma_f32_16x16x32_bf16 v[80:83], a[72:75], a[24:27], v[80:83]
ds_read_b64_tr_b16 a[110:111], v19 offset:6400
v_mfma_f32_16x16x32_bf16 v[144:147], a[80:83], a[24:27], v[144:147]
ds_read_b64_tr_b16 a[112:113], v20 offset:4096
v_mfma_f32_16x16x32_bf16 v[144:147], a[84:87], a[28:31], v[144:147]
ds_read_b64_tr_b16 a[114:115], v20 offset:4352
v_mfma_f32_16x16x32_bf16 v[128:131], a[84:87], a[20:23], v[128:131]
ds_read_b64_tr_b16 a[116:117], v20 offset:6144
v_mfma_f32_16x16x32_bf16 v[128:131], a[80:83], a[16:19], v[128:131]
ds_read_b64_tr_b16 a[118:119], v20 offset:6400
v_mfma_f32_16x16x32_bf16 v[112:115], a[80:83], a[8:11], v[112:115]
s_add_u32 m0, s78, 147456
ds_read_b64_tr_b16 a[72:73], v19 offset:8192
v_mfma_f32_16x16x32_bf16 v[112:115], a[84:87], a[12:15], v[112:115]
s_add_u32 s64, s75, 3538944
ds_read_b64_tr_b16 a[74:75], v19 offset:8448
v_mfma_f32_16x16x32_bf16 v[96:99], a[84:87], a[4:7], v[96:99]
buffer_load_dwordx4 v23, s[60:63], s64 offen lds
v_mfma_f32_16x16x32_bf16 v[96:99], a[80:83], a[0:3], v[96:99]
ds_read_b64_tr_b16 a[76:77], v19 offset:10240
v_mfma_f32_16x16x32_bf16 v[36:39], a[88:91], a[0:3], v[36:39]
ds_read_b64_tr_b16 a[78:79], v19 offset:10496
v_mfma_f32_16x16x32_bf16 v[36:39], a[92:95], a[4:7], v[36:39]
ds_read_b64_tr_b16 a[80:81], v20 offset:8192
v_mfma_f32_16x16x32_bf16 v[52:55], a[92:95], a[12:15], v[52:55]
ds_read_b64_tr_b16 a[82:83], v20 offset:8448
v_mfma_f32_16x16x32_bf16 v[52:55], a[88:91], a[8:11], v[52:55]
ds_read_b64_tr_b16 a[84:85], v20 offset:10240
v_mfma_f32_16x16x32_bf16 v[68:71], a[88:91], a[16:19], v[68:71]
ds_read_b64_tr_b16 a[86:87], v20 offset:10496
v_mfma_f32_16x16x32_bf16 v[68:71], a[92:95], a[20:23], v[68:71]
s_add_u32 m0, s77, 132096
v_mfma_f32_16x16x32_bf16 v[84:87], a[92:95], a[28:31], v[84:87]
s_add_u32 s64, s71, 4751360
v_mfma_f32_16x16x32_bf16 v[84:87], a[88:91], a[24:27], v[84:87]
buffer_load_dwordx4 v14, s[56:59], s64 offen lds
v_mfma_f32_16x16x32_bf16 v[148:151], a[96:99], a[24:27], v[148:151]
ds_read_b64_tr_b16 a[88:89], v19 offset:0
v_mfma_f32_16x16x32_bf16 v[148:151], a[100:103], a[28:31], v[148:151]
ds_read_b64_tr_b16 a[90:91], v19 offset:256
v_mfma_f32_16x16x32_bf16 v[132:135], a[100:103], a[20:23], v[132:135]
ds_read_b64_tr_b16 a[92:93], v19 offset:2048
v_mfma_f32_16x16x32_bf16 v[132:135], a[96:99], a[16:19], v[132:135]
ds_read_b64_tr_b16 a[94:95], v19 offset:2304
v_mfma_f32_16x16x32_bf16 v[116:119], a[96:99], a[8:11], v[116:119]
v_mfma_f32_16x16x32_bf16 v[116:119], a[100:103], a[12:15], v[116:119]
v_mfma_f32_16x16x32_bf16 v[100:103], a[100:103], a[4:7], v[100:103]
s_add_u32 m0, s78, 151552
v_mfma_f32_16x16x32_bf16 v[100:103], a[96:99], a[0:3], v[100:103]
s_waitcnt lgkmcnt(4)
s_add_u32 s64, s75, 3540992
ds_read_b64_tr_b16 a[96:97], v20 offset:0
v_mfma_f32_16x16x32_bf16 v[184:187], a[104:107], a[32:35], v[184:187]
buffer_load_dwordx4 v23, s[60:63], s64 offen lds
v_mfma_f32_16x16x32_bf16 v[184:187], a[108:111], a[36:39], v[184:187]
ds_read_b64_tr_b16 a[98:99], v20 offset:256
v_mfma_f32_16x16x32_bf16 v[192:195], a[108:111], a[44:47], v[192:195]
ds_read_b64_tr_b16 a[100:101], v20 offset:2048
v_mfma_f32_16x16x32_bf16 v[192:195], a[104:107], a[40:43], v[192:195]
ds_read_b64_tr_b16 a[102:103], v20 offset:2304
v_mfma_f32_16x16x32_bf16 v[200:203], a[104:107], a[48:51], v[200:203]
v_mfma_f32_16x16x32_bf16 v[200:203], a[108:111], a[52:55], v[200:203]
v_mfma_f32_16x16x32_bf16 v[208:211], a[108:111], a[60:63], v[208:211]
v_mfma_f32_16x16x32_bf16 v[208:211], a[104:107], a[56:59], v[208:211]
ds_read_b64_tr_b16 a[104:105], v4 offset:0
v_mfma_f32_16x16x32_bf16 v[212:215], a[112:115], a[56:59], v[212:215]
s_add_u32 m0, s77, 133120
ds_read_b64_tr_b16 a[106:107], v4 offset:1024
v_mfma_f32_16x16x32_bf16 v[212:215], a[116:119], a[60:63], v[212:215]
s_add_u32 s64, s71, 4784128
ds_read_b64_tr_b16 a[108:109], v4 offset:8192
v_mfma_f32_16x16x32_bf16 v[204:207], a[116:119], a[52:55], v[204:207]
buffer_load_dwordx4 v15, s[56:59], s64 offen lds
v_mfma_f32_16x16x32_bf16 v[204:207], a[112:115], a[48:51], v[204:207]
ds_read_b64_tr_b16 a[110:111], v4 offset:9216
v_mfma_f32_16x16x32_bf16 v[196:199], a[112:115], a[40:43], v[196:199]
v_mfma_f32_16x16x32_bf16 v[196:199], a[116:119], a[44:47], v[196:199]
v_mfma_f32_16x16x32_bf16 v[188:191], a[116:119], a[36:39], v[188:191]
s_add_u32 s65, s79, 9216
v_mfma_f32_16x16x32_bf16 v[188:191], a[112:115], a[32:35], v[188:191]
buffer_store_dwordx4 a[200:203], v16, s[44:47], s65 offen sc1
v_mfma_f32_16x16x32_bf16 v[216:219], a[32:35], a[72:75], v[216:219]
ds_read_b64_tr_b16 a[112:113], v5 offset:0
v_mfma_f32_16x16x32_bf16 v[216:219], a[36:39], a[76:79], v[216:219]
s_add_u32 m0, s78, 155648
ds_read_b64_tr_b16 a[114:115], v5 offset:1024
v_mfma_f32_16x16x32_bf16 v[224:227], a[44:47], a[76:79], v[224:227]
s_add_u32 s64, s75, 3543040
ds_read_b64_tr_b16 a[116:117], v5 offset:8192
v_mfma_f32_16x16x32_bf16 v[224:227], a[40:43], a[72:75], v[224:227]
buffer_load_dwordx4 v23, s[60:63], s64 offen lds
v_mfma_f32_16x16x32_bf16 v[232:235], a[48:51], a[72:75], v[232:235]
ds_read_b64_tr_b16 a[118:119], v5 offset:9216
v_mfma_f32_16x16x32_bf16 v[232:235], a[52:55], a[76:79], v[232:235]
v_mfma_f32_16x16x32_bf16 v[240:243], a[60:63], a[76:79], v[240:243]
v_mfma_f32_16x16x32_bf16 v[240:243], a[56:59], a[72:75], v[240:243]
ds_read_b64_tr_b16 a[72:73], v6 offset:0
v_mfma_f32_16x16x32_bf16 v[244:247], a[56:59], a[80:83], v[244:247]
ds_read_b64_tr_b16 a[74:75], v6 offset:1024
v_mfma_f32_16x16x32_bf16 v[244:247], a[60:63], a[84:87], v[244:247]
ds_read_b64_tr_b16 a[76:77], v6 offset:8192
v_mfma_f32_16x16x32_bf16 v[236:239], a[52:55], a[84:87], v[236:239]
s_add_u32 m0, s77, 134144
ds_read_b64_tr_b16 a[78:79], v6 offset:9216
v_mfma_f32_16x16x32_bf16 v[236:239], a[48:51], a[80:83], v[236:239]
s_add_u32 s64, s71, 4816896
v_mfma_f32_16x16x32_bf16 v[228:231], a[40:43], a[80:83], v[228:231]
buffer_load_dwordx4 v15, s[56:59], s64 offen lds
v_mfma_f32_16x16x32_bf16 v[228:231], a[44:47], a[84:87], v[228:231]
v_mfma_f32_16x16x32_bf16 v[220:223], a[36:39], a[84:87], v[220:223]
v_mfma_f32_16x16x32_bf16 v[220:223], a[32:35], a[80:83], v[220:223]
s_waitcnt lgkmcnt(4)
ds_read_b64_tr_b16 a[80:81], v7 offset:0
v_mfma_f32_16x16x32_bf16 v[152:155], a[88:91], a[32:35], v[152:155]
ds_read_b64_tr_b16 a[82:83], v7 offset:1024
v_mfma_f32_16x16x32_bf16 v[152:155], a[92:95], a[36:39], v[152:155]
ds_read_b64_tr_b16 a[84:85], v7 offset:8192
v_mfma_f32_16x16x32_bf16 v[160:163], a[92:95], a[44:47], v[160:163]
ds_read_b64_tr_b16 a[86:87], v7 offset:9216
v_mfma_f32_16x16x32_bf16 v[160:163], a[88:91], a[40:43], v[160:163]
v_mfma_f32_16x16x32_bf16 v[168:171], a[88:91], a[48:51], v[168:171]
v_mfma_f32_16x16x32_bf16 v[168:171], a[92:95], a[52:55], v[168:171]
v_mfma_f32_16x16x32_bf16 v[176:179], a[92:95], a[60:63], v[176:179]
s_add_u32 m0, s76, 32768
v_mfma_f32_16x16x32_bf16 v[176:179], a[88:91], a[56:59], v[176:179]
s_add_u32 s64, s72, 1152
ds_read_b64_tr_b16 a[88:89], v8 offset:0
v_mfma_f32_16x16x32_bf16 v[180:183], a[96:99], a[56:59], v[180:183]
buffer_load_dwordx4 v12, s[48:51], s64 offen lds
v_mfma_f32_16x16x32_bf16 v[180:183], a[100:103], a[60:63], v[180:183]
ds_read_b64_tr_b16 a[90:91], v8 offset:1024
v_mfma_f32_16x16x32_bf16 v[172:175], a[100:103], a[52:55], v[172:175]
ds_read_b64_tr_b16 a[92:93], v8 offset:8192
v_mfma_f32_16x16x32_bf16 v[172:175], a[96:99], a[48:51], v[172:175]
s_add_u32 m0, s76, 33792
ds_read_b64_tr_b16 a[94:95], v8 offset:9216
v_mfma_f32_16x16x32_bf16 v[164:167], a[96:99], a[40:43], v[164:167]
s_add_u32 s64, s72, 17536
v_mfma_f32_16x16x32_bf16 v[164:167], a[100:103], a[44:47], v[164:167]
buffer_load_dwordx4 v13, s[48:51], s64 offen lds
v_mfma_f32_16x16x32_bf16 v[156:159], a[100:103], a[36:39], v[156:159]
v_mfma_f32_16x16x32_bf16 v[156:159], a[96:99], a[32:35], v[156:159]
ds_read_b64_tr_b16 a[96:97], v9 offset:0
v_mfma_f32_16x16x32_bf16 v[24:27], a[104:107], a[32:35], v[24:27]
s_add_u32 m0, s76, 34816
ds_read_b64_tr_b16 a[98:99], v9 offset:1024
v_mfma_f32_16x16x32_bf16 v[24:27], a[108:111], a[36:39], v[24:27]
s_add_u32 s64, s72, 132224
ds_read_b64_tr_b16 a[100:101], v9 offset:8192
v_mfma_f32_16x16x32_bf16 v[40:43], a[108:111], a[44:47], v[40:43]
buffer_load_dwordx4 v12, s[48:51], s64 offen lds
v_mfma_f32_16x16x32_bf16 v[40:43], a[104:107], a[40:43], v[40:43]
ds_read_b64_tr_b16 a[102:103], v9 offset:9216
v_mfma_f32_16x16x32_bf16 v[56:59], a[104:107], a[48:51], v[56:59]
v_mfma_f32_16x16x32_bf16 v[56:59], a[108:111], a[52:55], v[56:59]
s_add_u32 m0, s76, 35840
v_mfma_f32_16x16x32_bf16 v[72:75], a[108:111], a[60:63], v[72:75]
s_waitcnt vmcnt(12)
s_add_u32 s64, s72, 148608
ds_read_b128 a[0:3], v2 offset:0
v_mfma_f32_16x16x32_bf16 v[72:75], a[104:107], a[56:59], v[72:75]
buffer_load_dwordx4 v13, s[48:51], s64 offen lds
v_mfma_f32_16x16x32_bf16 v[136:139], a[112:115], a[56:59], v[136:139]
ds_read_b128 a[4:7], v3 offset:0
v_mfma_f32_16x16x32_bf16 v[136:139], a[116:119], a[60:63], v[136:139]
ds_read_b128 a[8:11], v2 offset:2048
v_mfma_f32_16x16x32_bf16 v[120:123], a[116:119], a[52:55], v[120:123]
s_add_u32 m0, s76, 36864
ds_read_b128 a[12:15], v3 offset:2048
v_mfma_f32_16x16x32_bf16 v[120:123], a[112:115], a[48:51], v[120:123]
s_add_u32 s64, s73, 1152
ds_read_b128 a[16:19], v2 offset:4096
v_mfma_f32_16x16x32_bf16 v[104:107], a[112:115], a[40:43], v[104:107]
buffer_load_dwordx4 v12, s[48:51], s64 offen lds
v_mfma_f32_16x16x32_bf16 v[104:107], a[116:119], a[44:47], v[104:107]
ds_read_b128 a[20:23], v3 offset:4096
v_mfma_f32_16x16x32_bf16 v[88:91], a[116:119], a[36:39], v[88:91]
ds_read_b128 a[24:27], v2 offset:6144
v_mfma_f32_16x16x32_bf16 v[88:91], a[112:115], a[32:35], v[88:91]
s_waitcnt lgkmcnt(7)
s_add_u32 m0, s76, 37888
ds_read_b128 a[28:31], v3 offset:6144
v_mfma_f32_16x16x32_bf16 v[28:31], a[72:75], a[32:35], v[28:31]
s_add_u32 s64, s73, 17536
ds_read_b64_tr_b16 a[104:105], v10 offset:0
v_mfma_f32_16x16x32_bf16 v[28:31], a[76:79], a[36:39], v[28:31]
s_add_u32 s65, s79, 26624
buffer_load_dwordx4 v13, s[48:51], s64 offen lds
v_mfma_f32_16x16x32_bf16 v[44:47], a[76:79], a[44:47], v[44:47]
buffer_store_dwordx4 a[204:207], v16, s[44:47], s65 offen sc1
v_mfma_f32_16x16x32_bf16 v[44:47], a[72:75], a[40:43], v[44:47]
ds_read_b64_tr_b16 a[106:107], v10 offset:1024
v_mfma_f32_16x16x32_bf16 v[60:63], a[72:75], a[48:51], v[60:63]
s_add_u32 m0, s76, 38912
ds_read_b64_tr_b16 a[108:109], v10 offset:8192
v_mfma_f32_16x16x32_bf16 v[60:63], a[76:79], a[52:55], v[60:63]
s_add_u32 s64, s73, 132224
ds_read_b64_tr_b16 a[110:111], v10 offset:9216
v_mfma_f32_16x16x32_bf16 v[76:79], a[76:79], a[60:63], v[76:79]
buffer_load_dwordx4 v12, s[48:51], s64 offen lds
v_mfma_f32_16x16x32_bf16 v[76:79], a[72:75], a[56:59], v[76:79]
ds_read_b64_tr_b16 a[112:113], v11 offset:0
v_mfma_f32_16x16x32_bf16 v[140:143], a[80:83], a[56:59], v[140:143]
ds_read_b64_tr_b16 a[114:115], v11 offset:1024
v_mfma_f32_16x16x32_bf16 v[140:143], a[84:87], a[60:63], v[140:143]
s_add_u32 m0, s76, 39936
ds_read_b64_tr_b16 a[116:117], v11 offset:8192
v_mfma_f32_16x16x32_bf16 v[124:127], a[84:87], a[52:55], v[124:127]
s_add_u32 s64, s73, 148608
ds_read_b64_tr_b16 a[118:119], v11 offset:9216
v_mfma_f32_16x16x32_bf16 v[124:127], a[80:83], a[48:51], v[124:127]
buffer_load_dwordx4 v13, s[48:51], s64 offen lds
v_mfma_f32_16x16x32_bf16 v[108:111], a[80:83], a[40:43], v[108:111]
v_mfma_f32_16x16x32_bf16 v[108:111], a[84:87], a[44:47], v[108:111]
v_mfma_f32_16x16x32_bf16 v[92:95], a[84:87], a[36:39], v[92:95]
v_mfma_f32_16x16x32_bf16 v[92:95], a[80:83], a[32:35], v[92:95]
v_mfma_f32_16x16x32_bf16 v[32:35], a[88:91], a[32:35], v[32:35]
v_mfma_f32_16x16x32_bf16 v[32:35], a[92:95], a[36:39], v[32:35]
v_mfma_f32_16x16x32_bf16 v[48:51], a[92:95], a[44:47], v[48:51]
s_waitcnt lgkmcnt(0)
s_barrier
v_mfma_f32_16x16x32_bf16 v[48:51], a[88:91], a[40:43], v[48:51]
s_add_u32 m0, s77, 65536
ds_read_b64_tr_b16 a[72:73], v19 offset:36864
v_mfma_f32_16x16x32_bf16 v[64:67], a[88:91], a[48:51], v[64:67]
s_add_u32 s64, s71, 5242880
ds_read_b64_tr_b16 a[74:75], v19 offset:37120
v_mfma_f32_16x16x32_bf16 v[64:67], a[92:95], a[52:55], v[64:67]
buffer_load_dwordx4 v14, s[56:59], s64 offen lds
v_mfma_f32_16x16x32_bf16 v[80:83], a[92:95], a[60:63], v[80:83]
ds_read_b64_tr_b16 a[76:77], v19 offset:38912
v_mfma_f32_16x16x32_bf16 v[80:83], a[88:91], a[56:59], v[80:83]
ds_read_b64_tr_b16 a[78:79], v19 offset:39168
v_mfma_f32_16x16x32_bf16 v[144:147], a[96:99], a[56:59], v[144:147]
ds_read_b64_tr_b16 a[80:81], v20 offset:36864
v_mfma_f32_16x16x32_bf16 v[144:147], a[100:103], a[60:63], v[144:147]
ds_read_b64_tr_b16 a[82:83], v20 offset:37120
v_mfma_f32_16x16x32_bf16 v[128:131], a[100:103], a[52:55], v[128:131]
ds_read_b64_tr_b16 a[84:85], v20 offset:38912
v_mfma_f32_16x16x32_bf16 v[128:131], a[96:99], a[48:51], v[128:131]
ds_read_b64_tr_b16 a[86:87], v20 offset:39168
v_mfma_f32_16x16x32_bf16 v[112:115], a[96:99], a[40:43], v[112:115]
s_add_u32 m0, s78, 81920
ds_read_b64_tr_b16 a[88:89], v19 offset:40960
v_mfma_f32_16x16x32_bf16 v[112:115], a[100:103], a[44:47], v[112:115]
s_add_u32 s64, s75, 3932160
ds_read_b64_tr_b16 a[90:91], v19 offset:41216
v_mfma_f32_16x16x32_bf16 v[96:99], a[100:103], a[36:39], v[96:99]
buffer_load_dwordx4 v23, s[60:63], s64 offen lds
v_mfma_f32_16x16x32_bf16 v[96:99], a[96:99], a[32:35], v[96:99]
ds_read_b64_tr_b16 a[92:93], v19 offset:43008
v_mfma_f32_16x16x32_bf16 v[36:39], a[104:107], a[32:35], v[36:39]
ds_read_b64_tr_b16 a[94:95], v19 offset:43264
v_mfma_f32_16x16x32_bf16 v[36:39], a[108:111], a[36:39], v[36:39]
ds_read_b64_tr_b16 a[96:97], v20 offset:40960
v_mfma_f32_16x16x32_bf16 v[52:55], a[108:111], a[44:47], v[52:55]
ds_read_b64_tr_b16 a[98:99], v20 offset:41216
v_mfma_f32_16x16x32_bf16 v[52:55], a[104:107], a[40:43], v[52:55]
ds_read_b64_tr_b16 a[100:101], v20 offset:43008
v_mfma_f32_16x16x32_bf16 v[68:71], a[104:107], a[48:51], v[68:71]
ds_read_b64_tr_b16 a[102:103], v20 offset:43264
v_mfma_f32_16x16x32_bf16 v[68:71], a[108:111], a[52:55], v[68:71]
s_add_u32 m0, s77, 66560
v_mfma_f32_16x16x32_bf16 v[84:87], a[108:111], a[60:63], v[84:87]
s_add_u32 s64, s71, 5275648
v_mfma_f32_16x16x32_bf16 v[84:87], a[104:107], a[56:59], v[84:87]
buffer_load_dwordx4 v14, s[56:59], s64 offen lds
v_mfma_f32_16x16x32_bf16 v[148:151], a[112:115], a[56:59], v[148:151]
ds_read_b64_tr_b16 a[104:105], v19 offset:32768
v_mfma_f32_16x16x32_bf16 v[148:151], a[116:119], a[60:63], v[148:151]
ds_read_b64_tr_b16 a[106:107], v19 offset:33024
v_mfma_f32_16x16x32_bf16 v[132:135], a[116:119], a[52:55], v[132:135]
ds_read_b64_tr_b16 a[108:109], v19 offset:34816
v_mfma_f32_16x16x32_bf16 v[132:135], a[112:115], a[48:51], v[132:135]
ds_read_b64_tr_b16 a[110:111], v19 offset:35072
v_mfma_f32_16x16x32_bf16 v[116:119], a[112:115], a[40:43], v[116:119]
v_mfma_f32_16x16x32_bf16 v[116:119], a[116:119], a[44:47], v[116:119]
v_mfma_f32_16x16x32_bf16 v[100:103], a[116:119], a[36:39], v[100:103]
s_add_u32 m0, s78, 86016
v_mfma_f32_16x16x32_bf16 v[100:103], a[112:115], a[32:35], v[100:103]
s_waitcnt lgkmcnt(4)
s_add_u32 s64, s75, 3934208
ds_read_b64_tr_b16 a[112:113], v20 offset:32768
v_mfma_f32_16x16x32_bf16 v[184:187], a[72:75], a[0:3], v[184:187]
buffer_load_dwordx4 v23, s[60:63], s64 offen lds
v_mfma_f32_16x16x32_bf16 v[184:187], a[76:79], a[4:7], v[184:187]
s_add_u32 s65, s79, 27648
ds_read_b64_tr_b16 a[114:115], v20 offset:33024
v_mfma_f32_16x16x32_bf16 v[192:195], a[76:79], a[12:15], v[192:195]
buffer_store_dwordx4 a[208:211], v16, s[44:47], s65 offen sc1
v_mfma_f32_16x16x32_bf16 v[192:195], a[72:75], a[8:11], v[192:195]
s_add_u32 s17, s78, .-L_pc+6144
ds_read_b64_tr_b16 a[116:117], v20 offset:34816
v_mfma_f32_16x16x32_bf16 v[200:203], a[72:75], a[16:19], v[200:203]
buffer_load_dword a252, v16, s[88:91], s17 offen
v_mfma_f32_16x16x32_bf16 v[200:203], a[76:79], a[20:23], v[200:203]
ds_read_b64_tr_b16 a[118:119], v20 offset:35072
v_mfma_f32_16x16x32_bf16 v[208:211], a[76:79], a[28:31], v[208:211]
v_mfma_f32_16x16x32_bf16 v[208:211], a[72:75], a[24:27], v[208:211]
ds_read_b64_tr_b16 a[72:73], v4 offset:32768
v_mfma_f32_16x16x32_bf16 v[212:215], a[80:83], a[24:27], v[212:215]
s_add_u32 m0, s77, 67584
ds_read_b64_tr_b16 a[74:75], v4 offset:33792
v_mfma_f32_16x16x32_bf16 v[212:215], a[84:87], a[28:31], v[212:215]
s_add_u32 s64, s71, 5308416
ds_read_b64_tr_b16 a[76:77], v4 offset:40960
v_mfma_f32_16x16x32_bf16 v[204:207], a[84:87], a[20:23], v[204:207]
buffer_load_dwordx4 v15, s[56:59], s64 offen lds
v_mfma_f32_16x16x32_bf16 v[204:207], a[80:83], a[16:19], v[204:207]
ds_read_b64_tr_b16 a[78:79], v4 offset:41984
v_mfma_f32_16x16x32_bf16 v[196:199], a[80:83], a[8:11], v[196:199]
v_mfma_f32_16x16x32_bf16 v[196:199], a[84:87], a[12:15], v[196:199]
v_mfma_f32_16x16x32_bf16 v[188:191], a[84:87], a[4:7], v[188:191]
v_mfma_f32_16x16x32_bf16 v[188:191], a[80:83], a[0:3], v[188:191]
ds_read_b64_tr_b16 a[80:81], v5 offset:32768
v_mfma_f32_16x16x32_bf16 v[216:219], a[0:3], a[88:91], v[216:219]
ds_read_b64_tr_b16 a[82:83], v5 offset:33792
v_mfma_f32_16x16x32_bf16 v[216:219], a[4:7], a[92:95], v[216:219]
s_add_u32 m0, s78, 90112
ds_read_b64_tr_b16 a[84:85], v5 offset:40960
v_mfma_f32_16x16x32_bf16 v[224:227], a[12:15], a[92:95], v[224:227]
s_add_u32 s64, s75, 3936256
ds_read_b64_tr_b16 a[86:87], v5 offset:41984
v_mfma_f32_16x16x32_bf16 v[224:227], a[8:11], a[88:91], v[224:227]
buffer_load_dwordx4 v23, s[60:63], s64 offen lds
v_mfma_f32_16x16x32_bf16 v[232:235], a[16:19], a[88:91], v[232:235]
v_mfma_f32_16x16x32_bf16 v[232:235], a[20:23], a[92:95], v[232:235]
v_mfma_f32_16x16x32_bf16 v[240:243], a[28:31], a[92:95], v[240:243]
v_mfma_f32_16x16x32_bf16 v[240:243], a[24:27], a[88:91], v[240:243]
ds_read_b64_tr_b16 a[88:89], v6 offset:32768
v_mfma_f32_16x16x32_bf16 v[244:247], a[24:27], a[96:99], v[244:247]
ds_read_b64_tr_b16 a[90:91], v6 offset:33792
v_mfma_f32_16x16x32_bf16 v[244:247], a[28:31], a[100:103], v[244:247]
ds_read_b64_tr_b16 a[92:93], v6 offset:40960
v_add_u32 v19, 0x8000, v19
v_mfma_f32_16x16x32_bf16 v[236:239], a[20:23], a[100:103], v[236:239]
s_add_u32 m0, s77, 68608
ds_read_b64_tr_b16 a[94:95], v6 offset:41984
v_mfma_f32_16x16x32_bf16 v[236:239], a[16:19], a[96:99], v[236:239]
s_add_u32 s64, s71, 5341184
v_mfma_f32_16x16x32_bf16 v[228:231], a[8:11], a[96:99], v[228:231]
buffer_load_dwordx4 v15, s[56:59], s64 offen lds
v_mfma_f32_16x16x32_bf16 v[228:231], a[12:15], a[100:103], v[228:231]
v_mfma_f32_16x16x32_bf16 v[220:223], a[4:7], a[100:103], v[220:223]
v_mfma_f32_16x16x32_bf16 v[220:223], a[0:3], a[96:99], v[220:223]
s_waitcnt lgkmcnt(4)
ds_read_b64_tr_b16 a[96:97], v7 offset:32768
v_mfma_f32_16x16x32_bf16 v[152:155], a[104:107], a[0:3], v[152:155]
ds_read_b64_tr_b16 a[98:99], v7 offset:33792
v_mfma_f32_16x16x32_bf16 v[152:155], a[108:111], a[4:7], v[152:155]
ds_read_b64_tr_b16 a[100:101], v7 offset:40960
v_add_u32 v20, 0x8000, v20
v_mfma_f32_16x16x32_bf16 v[160:163], a[108:111], a[12:15], v[160:163]
ds_read_b64_tr_b16 a[102:103], v7 offset:41984
v_mfma_f32_16x16x32_bf16 v[160:163], a[104:107], a[8:11], v[160:163]
v_mfma_f32_16x16x32_bf16 v[168:171], a[104:107], a[16:19], v[168:171]
v_mfma_f32_16x16x32_bf16 v[168:171], a[108:111], a[20:23], v[168:171]
v_mfma_f32_16x16x32_bf16 v[176:179], a[108:111], a[28:31], v[176:179]
s_add_u32 m0, s76, 0
v_mfma_f32_16x16x32_bf16 v[176:179], a[104:107], a[24:27], v[176:179]
s_add_u32 s64, s72, 1280
ds_read_b64_tr_b16 a[104:105], v8 offset:32768
v_mfma_f32_16x16x32_bf16 v[180:183], a[112:115], a[24:27], v[180:183]
buffer_load_dwordx4 v12, s[48:51], s64 offen lds
v_mfma_f32_16x16x32_bf16 v[180:183], a[116:119], a[28:31], v[180:183]
ds_read_b64_tr_b16 a[106:107], v8 offset:33792
v_add_u32 v4, 0x8000, v4
v_mfma_f32_16x16x32_bf16 v[172:175], a[116:119], a[20:23], v[172:175]
ds_read_b64_tr_b16 a[108:109], v8 offset:40960
v_mfma_f32_16x16x32_bf16 v[172:175], a[112:115], a[16:19], v[172:175]
s_add_u32 m0, s76, 1024
ds_read_b64_tr_b16 a[110:111], v8 offset:41984
v_mfma_f32_16x16x32_bf16 v[164:167], a[112:115], a[8:11], v[164:167]
s_add_u32 s64, s72, 17664
v_mfma_f32_16x16x32_bf16 v[164:167], a[116:119], a[12:15], v[164:167]
buffer_load_dwordx4 v13, s[48:51], s64 offen lds
v_mfma_f32_16x16x32_bf16 v[156:159], a[116:119], a[4:7], v[156:159]
v_mfma_f32_16x16x32_bf16 v[156:159], a[112:115], a[0:3], v[156:159]
ds_read_b64_tr_b16 a[112:113], v9 offset:32768
v_mfma_f32_16x16x32_bf16 v[24:27], a[72:75], a[0:3], v[24:27]
s_add_u32 m0, s76, 2048
ds_read_b64_tr_b16 a[114:115], v9 offset:33792
v_mfma_f32_16x16x32_bf16 v[24:27], a[76:79], a[4:7], v[24:27]
s_add_u32 s64, s72, 132352
ds_read_b64_tr_b16 a[116:117], v9 offset:40960
v_add_u32 v5, 0x8000, v5
v_mfma_f32_16x16x32_bf16 v[40:43], a[76:79], a[12:15], v[40:43]
buffer_load_dwordx4 v12, s[48:51], s64 offen lds
v_mfma_f32_16x16x32_bf16 v[40:43], a[72:75], a[8:11], v[40:43]
s_add_u32 s65, s79, 11264
ds_read_b64_tr_b16 a[118:119], v9 offset:41984
v_mfma_f32_16x16x32_bf16 v[56:59], a[72:75], a[16:19], v[56:59]
buffer_store_dwordx4 a[212:215], v16, s[44:47], s65 offen sc1
v_mfma_f32_16x16x32_bf16 v[56:59], a[76:79], a[20:23], v[56:59]
s_add_u32 m0, s76, 3072
v_mfma_f32_16x16x32_bf16 v[72:75], a[76:79], a[28:31], v[72:75]
s_waitcnt vmcnt(13)
s_add_u32 s64, s72, 148736
ds_read_b128 a[32:35], v2 offset:32768
v_mfma_f32_16x16x32_bf16 v[72:75], a[72:75], a[24:27], v[72:75]
buffer_load_dwordx4 v13, s[48:51], s64 offen lds
v_mfma_f32_16x16x32_bf16 v[136:139], a[80:83], a[24:27], v[136:139]
ds_read_b128 a[36:39], v3 offset:32768
v_mfma_f32_16x16x32_bf16 v[136:139], a[84:87], a[28:31], v[136:139]
ds_read_b128 a[40:43], v2 offset:34816
v_add_u32 v6, 0x8000, v6
v_mfma_f32_16x16x32_bf16 v[120:123], a[84:87], a[20:23], v[120:123]
s_add_u32 m0, s76, 4096
ds_read_b128 a[44:47], v3 offset:34816
v_mfma_f32_16x16x32_bf16 v[120:123], a[80:83], a[16:19], v[120:123]
s_add_u32 s64, s73, 1280
ds_read_b128 a[48:51], v2 offset:36864
v_mfma_f32_16x16x32_bf16 v[104:107], a[80:83], a[8:11], v[104:107]
buffer_load_dwordx4 v12, s[48:51], s64 offen lds
v_mfma_f32_16x16x32_bf16 v[104:107], a[84:87], a[12:15], v[104:107]
ds_read_b128 a[52:55], v3 offset:36864
v_mfma_f32_16x16x32_bf16 v[88:91], a[84:87], a[4:7], v[88:91]
ds_read_b128 a[56:59], v2 offset:38912
v_mfma_f32_16x16x32_bf16 v[88:91], a[80:83], a[0:3], v[88:91]
s_waitcnt lgkmcnt(7)
s_add_u32 m0, s76, 5120
ds_read_b128 a[60:63], v3 offset:38912
v_mfma_f32_16x16x32_bf16 v[28:31], a[88:91], a[0:3], v[28:31]
s_add_u32 s64, s73, 17664
ds_read_b64_tr_b16 a[72:73], v10 offset:32768
v_mfma_f32_16x16x32_bf16 v[28:31], a[92:95], a[4:7], v[28:31]
buffer_load_dwordx4 v13, s[48:51], s64 offen lds
v_mfma_f32_16x16x32_bf16 v[44:47], a[92:95], a[12:15], v[44:47]
ds_read_b64_tr_b16 a[74:75], v10 offset:33792
v_add_u32 v7, 0x8000, v7
v_mfma_f32_16x16x32_bf16 v[44:47], a[88:91], a[8:11], v[44:47]
ds_read_b64_tr_b16 a[76:77], v10 offset:40960
v_mfma_f32_16x16x32_bf16 v[60:63], a[88:91], a[16:19], v[60:63]
s_add_u32 m0, s76, 6144
ds_read_b64_tr_b16 a[78:79], v10 offset:41984
v_mfma_f32_16x16x32_bf16 v[60:63], a[92:95], a[20:23], v[60:63]
s_add_u32 s64, s73, 132352
ds_read_b64_tr_b16 a[80:81], v11 offset:32768
v_mfma_f32_16x16x32_bf16 v[76:79], a[92:95], a[28:31], v[76:79]
buffer_load_dwordx4 v12, s[48:51], s64 offen lds
v_mfma_f32_16x16x32_bf16 v[76:79], a[88:91], a[24:27], v[76:79]
ds_read_b64_tr_b16 a[82:83], v11 offset:33792
v_mfma_f32_16x16x32_bf16 v[140:143], a[96:99], a[24:27], v[140:143]
ds_read_b64_tr_b16 a[84:85], v11 offset:40960
v_mfma_f32_16x16x32_bf16 v[140:143], a[100:103], a[28:31], v[140:143]
s_add_u32 m0, s76, 7168
ds_read_b64_tr_b16 a[86:87], v11 offset:41984
v_add_u32 v8, 0x8000, v8
v_mfma_f32_16x16x32_bf16 v[124:127], a[100:103], a[20:23], v[124:127]
s_add_u32 s64, s73, 148736
v_mfma_f32_16x16x32_bf16 v[124:127], a[96:99], a[16:19], v[124:127]
buffer_load_dwordx4 v13, s[48:51], s64 offen lds
v_mfma_f32_16x16x32_bf16 v[108:111], a[96:99], a[8:11], v[108:111]
v_mfma_f32_16x16x32_bf16 v[108:111], a[100:103], a[12:15], v[108:111]
v_mfma_f32_16x16x32_bf16 v[92:95], a[100:103], a[4:7], v[92:95]
v_add_u32 v9, 0x8000, v9
v_add_u32 v10, 0x8000, v10
v_mfma_f32_16x16x32_bf16 v[92:95], a[96:99], a[0:3], v[92:95]
v_add_u32 v11, 0x8000, v11
v_mfma_f32_16x16x32_bf16 v[32:35], a[104:107], a[0:3], v[32:35]
v_mfma_f32_16x16x32_bf16 v[32:35], a[108:111], a[4:7], v[32:35]
v_mfma_f32_16x16x32_bf16 v[48:51], a[108:111], a[12:15], v[48:51]
s_waitcnt lgkmcnt(0)
s_barrier
v_mfma_f32_16x16x32_bf16 v[48:51], a[104:107], a[8:11], v[48:51]
s_add_u32 m0, s77, 98304
ds_read_b64_tr_b16 a[88:89], v19 offset:36864
v_mfma_f32_16x16x32_bf16 v[64:67], a[104:107], a[16:19], v[64:67]
s_add_u32 s64, s71, 5767168
ds_read_b64_tr_b16 a[90:91], v19 offset:37120
v_mfma_f32_16x16x32_bf16 v[64:67], a[108:111], a[20:23], v[64:67]
buffer_load_dwordx4 v14, s[56:59], s64 offen lds
v_mfma_f32_16x16x32_bf16 v[80:83], a[108:111], a[28:31], v[80:83]
ds_read_b64_tr_b16 a[92:93], v19 offset:38912
v_mfma_f32_16x16x32_bf16 v[80:83], a[104:107], a[24:27], v[80:83]
ds_read_b64_tr_b16 a[94:95], v19 offset:39168
v_mfma_f32_16x16x32_bf16 v[144:147], a[112:115], a[24:27], v[144:147]
ds_read_b64_tr_b16 a[96:97], v20 offset:36864
v_mfma_f32_16x16x32_bf16 v[144:147], a[116:119], a[28:31], v[144:147]
ds_read_b64_tr_b16 a[98:99], v20 offset:37120
v_mfma_f32_16x16x32_bf16 v[128:131], a[116:119], a[20:23], v[128:131]
ds_read_b64_tr_b16 a[100:101], v20 offset:38912
v_mfma_f32_16x16x32_bf16 v[128:131], a[112:115], a[16:19], v[128:131]
ds_read_b64_tr_b16 a[102:103], v20 offset:39168
v_mfma_f32_16x16x32_bf16 v[112:115], a[112:115], a[8:11], v[112:115]
s_add_u32 m0, s78, 114688
ds_read_b64_tr_b16 a[104:105], v19 offset:40960
v_mfma_f32_16x16x32_bf16 v[112:115], a[116:119], a[12:15], v[112:115]
s_add_u32 s64, s75, 4325376
ds_read_b64_tr_b16 a[106:107], v19 offset:41216
v_mfma_f32_16x16x32_bf16 v[96:99], a[116:119], a[4:7], v[96:99]
buffer_load_dwordx4 v23, s[60:63], s64 offen lds
v_mfma_f32_16x16x32_bf16 v[96:99], a[112:115], a[0:3], v[96:99]
ds_read_b64_tr_b16 a[108:109], v19 offset:43008
v_mfma_f32_16x16x32_bf16 v[36:39], a[72:75], a[0:3], v[36:39]
ds_read_b64_tr_b16 a[110:111], v19 offset:43264
v_mfma_f32_16x16x32_bf16 v[36:39], a[76:79], a[4:7], v[36:39]
ds_read_b64_tr_b16 a[112:113], v20 offset:40960
v_mfma_f32_16x16x32_bf16 v[52:55], a[76:79], a[12:15], v[52:55]
ds_read_b64_tr_b16 a[114:115], v20 offset:41216
v_mfma_f32_16x16x32_bf16 v[52:55], a[72:75], a[8:11], v[52:55]
ds_read_b64_tr_b16 a[116:117], v20 offset:43008
v_mfma_f32_16x16x32_bf16 v[68:71], a[72:75], a[16:19], v[68:71]
s_add_u32 s65, s79, 28672
ds_read_b64_tr_b16 a[118:119], v20 offset:43264
v_mfma_f32_16x16x32_bf16 v[68:71], a[76:79], a[20:23], v[68:71]
s_add_u32 m0, s77, 99328
buffer_store_dwordx4 a[216:219], v16, s[44:47], s65 offen sc1
v_mfma_f32_16x16x32_bf16 v[84:87], a[76:79], a[28:31], v[84:87]
s_add_u32 s64, s71, 5799936
v_mfma_f32_16x16x32_bf16 v[84:87], a[72:75], a[24:27], v[84:87]
buffer_load_dwordx4 v14, s[56:59], s64 offen lds
v_mfma_f32_16x16x32_bf16 v[148:151], a[80:83], a[24:27], v[148:151]
ds_read_b64_tr_b16 a[72:73], v19 offset:32768
v_mfma_f32_16x16x32_bf16 v[148:151], a[84:87], a[28:31], v[148:151]
ds_read_b64_tr_b16 a[74:75], v19 offset:33024
v_mfma_f32_16x16x32_bf16 v[132:135], a[84:87], a[20:23], v[132:135]
ds_read_b64_tr_b16 a[76:77], v19 offset:34816
v_mfma_f32_16x16x32_bf16 v[132:135], a[80:83], a[16:19], v[132:135]
ds_read_b64_tr_b16 a[78:79], v19 offset:35072
v_mfma_f32_16x16x32_bf16 v[116:119], a[80:83], a[8:11], v[116:119]
v_mfma_f32_16x16x32_bf16 v[116:119], a[84:87], a[12:15], v[116:119]
v_mfma_f32_16x16x32_bf16 v[100:103], a[84:87], a[4:7], v[100:103]
s_add_u32 m0, s78, 118784
v_mfma_f32_16x16x32_bf16 v[100:103], a[80:83], a[0:3], v[100:103]
s_waitcnt lgkmcnt(4)
s_add_u32 s64, s75, 4327424
ds_read_b64_tr_b16 a[80:81], v20 offset:32768
v_mfma_f32_16x16x32_bf16 v[184:187], a[88:91], a[32:35], v[184:187]
buffer_load_dwordx4 v23, s[60:63], s64 offen lds
v_mfma_f32_16x16x32_bf16 v[184:187], a[92:95], a[36:39], v[184:187]
ds_read_b64_tr_b16 a[82:83], v20 offset:33024
v_mfma_f32_16x16x32_bf16 v[192:195], a[92:95], a[44:47], v[192:195]
ds_read_b64_tr_b16 a[84:85], v20 offset:34816
v_mfma_f32_16x16x32_bf16 v[192:195], a[88:91], a[40:43], v[192:195]
ds_read_b64_tr_b16 a[86:87], v20 offset:35072
v_mfma_f32_16x16x32_bf16 v[200:203], a[88:91], a[48:51], v[200:203]
s_cmp_eq_u32 s30, 0
s_cselect_b32 s81, 256, 0
v_mfma_f32_16x16x32_bf16 v[200:203], a[92:95], a[52:55], v[200:203]
v_mfma_f32_16x16x32_bf16 v[208:211], a[92:95], a[60:63], v[208:211]
v_mfma_f32_16x16x32_bf16 v[208:211], a[88:91], a[56:59], v[208:211]
ds_read_b64_tr_b16 a[88:89], v4 offset:32768
v_mfma_f32_16x16x32_bf16 v[212:215], a[96:99], a[56:59], v[212:215]
s_add_u32 m0, s77, 100352
ds_read_b64_tr_b16 a[90:91], v4 offset:33792
v_mfma_f32_16x16x32_bf16 v[212:215], a[100:103], a[60:63], v[212:215]
s_add_u32 s64, s71, 5832704
ds_read_b64_tr_b16 a[92:93], v4 offset:40960
v_mfma_f32_16x16x32_bf16 v[204:207], a[100:103], a[52:55], v[204:207]
buffer_load_dwordx4 v15, s[56:59], s64 offen lds
v_mfma_f32_16x16x32_bf16 v[204:207], a[96:99], a[48:51], v[204:207]
ds_read_b64_tr_b16 a[94:95], v4 offset:41984
v_mfma_f32_16x16x32_bf16 v[196:199], a[96:99], a[40:43], v[196:199]
v_mfma_f32_16x16x32_bf16 v[196:199], a[100:103], a[44:47], v[196:199]
v_mfma_f32_16x16x32_bf16 v[188:191], a[100:103], a[36:39], v[188:191]
v_mfma_f32_16x16x32_bf16 v[188:191], a[96:99], a[32:35], v[188:191]
ds_read_b64_tr_b16 a[96:97], v5 offset:32768
v_mfma_f32_16x16x32_bf16 v[216:219], a[32:35], a[104:107], v[216:219]
ds_read_b64_tr_b16 a[98:99], v5 offset:33792
v_mfma_f32_16x16x32_bf16 v[216:219], a[36:39], a[108:111], v[216:219]
s_add_u32 m0, s78, 122880
ds_read_b64_tr_b16 a[100:101], v5 offset:40960
v_mfma_f32_16x16x32_bf16 v[224:227], a[44:47], a[108:111], v[224:227]
s_add_u32 s64, s75, 4329472
ds_read_b64_tr_b16 a[102:103], v5 offset:41984
v_mfma_f32_16x16x32_bf16 v[224:227], a[40:43], a[104:107], v[224:227]
buffer_load_dwordx4 v23, s[60:63], s64 offen lds
v_mfma_f32_16x16x32_bf16 v[232:235], a[48:51], a[104:107], v[232:235]
v_mfma_f32_16x16x32_bf16 v[232:235], a[52:55], a[108:111], v[232:235]
v_mfma_f32_16x16x32_bf16 v[240:243], a[60:63], a[108:111], v[240:243]
v_mfma_f32_16x16x32_bf16 v[240:243], a[56:59], a[104:107], v[240:243]
ds_read_b64_tr_b16 a[104:105], v6 offset:32768
v_mfma_f32_16x16x32_bf16 v[244:247], a[56:59], a[112:115], v[244:247]
ds_read_b64_tr_b16 a[106:107], v6 offset:33792
v_mfma_f32_16x16x32_bf16 v[244:247], a[60:63], a[116:119], v[244:247]
ds_read_b64_tr_b16 a[108:109], v6 offset:40960
v_subrev_u32 v19, 0x8000, v19
v_mfma_f32_16x16x32_bf16 v[236:239], a[52:55], a[116:119], v[236:239]
s_add_u32 m0, s77, 101376
ds_read_b64_tr_b16 a[110:111], v6 offset:41984
v_mfma_f32_16x16x32_bf16 v[236:239], a[48:51], a[112:115], v[236:239]
s_add_u32 s64, s71, 5865472
v_mfma_f32_16x16x32_bf16 v[228:231], a[40:43], a[112:115], v[228:231]
buffer_load_dwordx4 v15, s[56:59], s64 offen lds
v_mfma_f32_16x16x32_bf16 v[228:231], a[44:47], a[116:119], v[228:231]
v_mfma_f32_16x16x32_bf16 v[220:223], a[36:39], a[116:119], v[220:223]
v_mfma_f32_16x16x32_bf16 v[220:223], a[32:35], a[112:115], v[220:223]
s_waitcnt lgkmcnt(4)
ds_read_b64_tr_b16 a[112:113], v7 offset:32768
v_mfma_f32_16x16x32_bf16 v[152:155], a[72:75], a[32:35], v[152:155]
ds_read_b64_tr_b16 a[114:115], v7 offset:33792
v_mfma_f32_16x16x32_bf16 v[152:155], a[76:79], a[36:39], v[152:155]
ds_read_b64_tr_b16 a[116:117], v7 offset:40960
v_subrev_u32 v20, 0x8000, v20
v_mfma_f32_16x16x32_bf16 v[160:163], a[76:79], a[44:47], v[160:163]
ds_read_b64_tr_b16 a[118:119], v7 offset:41984
v_mfma_f32_16x16x32_bf16 v[160:163], a[72:75], a[40:43], v[160:163]
v_mfma_f32_16x16x32_bf16 v[168:171], a[72:75], a[48:51], v[168:171]
v_mfma_f32_16x16x32_bf16 v[168:171], a[76:79], a[52:55], v[168:171]
s_add_u32 s65, s79, 29696
v_mfma_f32_16x16x32_bf16 v[176:179], a[76:79], a[60:63], v[176:179]
s_add_u32 m0, s76, 32768
buffer_store_dwordx4 a[220:223], v16, s[44:47], s65 offen sc1
v_mfma_f32_16x16x32_bf16 v[176:179], a[72:75], a[56:59], v[176:179]
s_add_u32 s64, s72, 1408
ds_read_b64_tr_b16 a[72:73], v8 offset:32768
v_mfma_f32_16x16x32_bf16 v[180:183], a[80:83], a[56:59], v[180:183]
buffer_load_dwordx4 v12, s[48:51], s64 offen lds
v_mfma_f32_16x16x32_bf16 v[180:183], a[84:87], a[60:63], v[180:183]
ds_read_b64_tr_b16 a[74:75], v8 offset:33792
v_subrev_u32 v4, 0x8000, v4
v_mfma_f32_16x16x32_bf16 v[172:175], a[84:87], a[52:55], v[172:175]
ds_read_b64_tr_b16 a[76:77], v8 offset:40960
v_mfma_f32_16x16x32_bf16 v[172:175], a[80:83], a[48:51], v[172:175]
s_add_u32 m0, s76, 33792
ds_read_b64_tr_b16 a[78:79], v8 offset:41984
v_mfma_f32_16x16x32_bf16 v[164:167], a[80:83], a[40:43], v[164:167]
s_add_u32 s64, s72, 17792
v_mfma_f32_16x16x32_bf16 v[164:167], a[84:87], a[44:47], v[164:167]
buffer_load_dwordx4 v13, s[48:51], s64 offen lds
v_mfma_f32_16x16x32_bf16 v[156:159], a[84:87], a[36:39], v[156:159]
v_mfma_f32_16x16x32_bf16 v[156:159], a[80:83], a[32:35], v[156:159]
ds_read_b64_tr_b16 a[80:81], v9 offset:32768
v_mfma_f32_16x16x32_bf16 v[24:27], a[88:91], a[32:35], v[24:27]
s_add_u32 m0, s76, 34816
ds_read_b64_tr_b16 a[82:83], v9 offset:33792
v_mfma_f32_16x16x32_bf16 v[24:27], a[92:95], a[36:39], v[24:27]
s_add_u32 s64, s72, 132480
ds_read_b64_tr_b16 a[84:85], v9 offset:40960
v_subrev_u32 v5, 0x8000, v5
v_mfma_f32_16x16x32_bf16 v[40:43], a[92:95], a[44:47], v[40:43]
buffer_load_dwordx4 v12, s[48:51], s64 offen lds
v_mfma_f32_16x16x32_bf16 v[40:43], a[88:91], a[40:43], v[40:43]
ds_read_b64_tr_b16 a[86:87], v9 offset:41984
v_mfma_f32_16x16x32_bf16 v[56:59], a[88:91], a[48:51], v[56:59]
v_mfma_f32_16x16x32_bf16 v[56:59], a[92:95], a[52:55], v[56:59]
s_add_u32 m0, s76, 35840
v_mfma_f32_16x16x32_bf16 v[72:75], a[92:95], a[60:63], v[72:75]
s_waitcnt vmcnt(12)
s_add_u32 s64, s72, 148864
ds_read_b128 a[0:3], v2 offset:0
v_mfma_f32_16x16x32_bf16 v[72:75], a[88:91], a[56:59], v[72:75]
buffer_load_dwordx4 v13, s[48:51], s64 offen lds
v_mfma_f32_16x16x32_bf16 v[136:139], a[96:99], a[56:59], v[136:139]
ds_read_b128 a[4:7], v3 offset:0
v_mfma_f32_16x16x32_bf16 v[136:139], a[100:103], a[60:63], v[136:139]
ds_read_b128 a[8:11], v2 offset:2048
v_subrev_u32 v6, 0x8000, v6
v_mfma_f32_16x16x32_bf16 v[120:123], a[100:103], a[52:55], v[120:123]
s_add_u32 m0, s76, 36864
ds_read_b128 a[12:15], v3 offset:2048
v_mfma_f32_16x16x32_bf16 v[120:123], a[96:99], a[48:51], v[120:123]
s_add_u32 s64, s73, 1408
ds_read_b128 a[16:19], v2 offset:4096
v_mfma_f32_16x16x32_bf16 v[104:107], a[96:99], a[40:43], v[104:107]
buffer_load_dwordx4 v12, s[48:51], s64 offen lds
v_mfma_f32_16x16x32_bf16 v[104:107], a[100:103], a[44:47], v[104:107]
ds_read_b128 a[20:23], v3 offset:4096
v_mfma_f32_16x16x32_bf16 v[88:91], a[100:103], a[36:39], v[88:91]
ds_read_b128 a[24:27], v2 offset:6144
v_mfma_f32_16x16x32_bf16 v[88:91], a[96:99], a[32:35], v[88:91]
s_waitcnt lgkmcnt(7)
s_add_u32 m0, s76, 37888
ds_read_b128 a[28:31], v3 offset:6144
v_mfma_f32_16x16x32_bf16 v[28:31], a[104:107], a[32:35], v[28:31]
s_add_u32 s64, s73, 17792
ds_read_b64_tr_b16 a[88:89], v10 offset:32768
v_mfma_f32_16x16x32_bf16 v[28:31], a[108:111], a[36:39], v[28:31]
buffer_load_dwordx4 v13, s[48:51], s64 offen lds
v_mfma_f32_16x16x32_bf16 v[44:47], a[108:111], a[44:47], v[44:47]
ds_read_b64_tr_b16 a[90:91], v10 offset:33792
v_subrev_u32 v7, 0x8000, v7
v_mfma_f32_16x16x32_bf16 v[44:47], a[104:107], a[40:43], v[44:47]
ds_read_b64_tr_b16 a[92:93], v10 offset:40960
v_mfma_f32_16x16x32_bf16 v[60:63], a[104:107], a[48:51], v[60:63]
s_add_u32 m0, s76, 38912
buffer_load_dword v1, off, s[52:55], s78 sc1
v_mfma_f32_16x16x32_bf16 v[60:63], a[108:111], a[52:55], v[60:63]
s_add_u32 s64, s73, 132480
ds_read_b64_tr_b16 a[94:95], v10 offset:41984
v_mfma_f32_16x16x32_bf16 v[76:79], a[108:111], a[60:63], v[76:79]
buffer_load_dwordx4 v12, s[48:51], s64 offen lds
v_mfma_f32_16x16x32_bf16 v[76:79], a[104:107], a[56:59], v[76:79]
ds_read_b64_tr_b16 a[96:97], v11 offset:32768
v_mfma_f32_16x16x32_bf16 v[140:143], a[112:115], a[56:59], v[140:143]
ds_read_b64_tr_b16 a[98:99], v11 offset:33792
v_mfma_f32_16x16x32_bf16 v[140:143], a[116:119], a[60:63], v[140:143]
s_add_u32 m0, s76, 39936
ds_read_b64_tr_b16 a[100:101], v11 offset:40960
v_subrev_u32 v8, 0x8000, v8
v_mfma_f32_16x16x32_bf16 v[124:127], a[116:119], a[52:55], v[124:127]
s_add_u32 s64, s73, 148864
ds_read_b64_tr_b16 a[102:103], v11 offset:41984
v_mfma_f32_16x16x32_bf16 v[124:127], a[112:115], a[48:51], v[124:127]
buffer_load_dwordx4 v13, s[48:51], s64 offen lds
v_mfma_f32_16x16x32_bf16 v[108:111], a[112:115], a[40:43], v[108:111]
v_mfma_f32_16x16x32_bf16 v[108:111], a[116:119], a[44:47], v[108:111]
v_mfma_f32_16x16x32_bf16 v[92:95], a[116:119], a[36:39], v[92:95]
v_subrev_u32 v9, 0x8000, v9
v_subrev_u32 v10, 0x8000, v10
v_mfma_f32_16x16x32_bf16 v[92:95], a[112:115], a[32:35], v[92:95]
v_subrev_u32 v11, 0x8000, v11
v_mfma_f32_16x16x32_bf16 v[32:35], a[72:75], a[32:35], v[32:35]
v_mfma_f32_16x16x32_bf16 v[32:35], a[76:79], a[36:39], v[32:35]
v_mfma_f32_16x16x32_bf16 v[48:51], a[76:79], a[44:47], v[48:51]
s_waitcnt lgkmcnt(0)
s_barrier
v_mfma_f32_16x16x32_bf16 v[48:51], a[72:75], a[40:43], v[48:51]
s_add_u32 m0, s77, 131072
ds_read_b64_tr_b16 a[104:105], v19 offset:4096
v_mfma_f32_16x16x32_bf16 v[64:67], a[72:75], a[48:51], v[64:67]
s_add_u32 s64, s71, 6291456
ds_read_b64_tr_b16 a[106:107], v19 offset:4352
v_mfma_f32_16x16x32_bf16 v[64:67], a[76:79], a[52:55], v[64:67]
buffer_load_dwordx4 v14, s[56:59], s64 offen lds
v_mfma_f32_16x16x32_bf16 v[80:83], a[76:79], a[60:63], v[80:83]
ds_read_b64_tr_b16 a[108:109], v19 offset:6144
v_mfma_f32_16x16x32_bf16 v[80:83], a[72:75], a[56:59], v[80:83]
s_add_u32 s65, s79, 13312
ds_read_b64_tr_b16 a[110:111], v19 offset:6400
v_mfma_f32_16x16x32_bf16 v[144:147], a[80:83], a[56:59], v[144:147]
buffer_store_dwordx4 a[224:227], v16, s[44:47], s65 offen sc1
v_mfma_f32_16x16x32_bf16 v[144:147], a[84:87], a[60:63], v[144:147]
ds_read_b64_tr_b16 a[112:113], v20 offset:4096
v_mfma_f32_16x16x32_bf16 v[128:131], a[84:87], a[52:55], v[128:131]
ds_read_b64_tr_b16 a[114:115], v20 offset:4352
v_mfma_f32_16x16x32_bf16 v[128:131], a[80:83], a[48:51], v[128:131]
ds_read_b64_tr_b16 a[116:117], v20 offset:6144
v_mfma_f32_16x16x32_bf16 v[112:115], a[80:83], a[40:43], v[112:115]
s_add_u32 m0, s78, 147456
ds_read_b64_tr_b16 a[118:119], v20 offset:6400
v_mfma_f32_16x16x32_bf16 v[112:115], a[84:87], a[44:47], v[112:115]
s_add_u32 s64, s75, 4718592
ds_read_b64_tr_b16 a[72:73], v19 offset:8192
v_mfma_f32_16x16x32_bf16 v[96:99], a[84:87], a[36:39], v[96:99]
buffer_load_dwordx4 v23, s[60:63], s64 offen lds
v_mfma_f32_16x16x32_bf16 v[96:99], a[80:83], a[32:35], v[96:99]
ds_read_b64_tr_b16 a[74:75], v19 offset:8448
v_mfma_f32_16x16x32_bf16 v[36:39], a[88:91], a[32:35], v[36:39]
ds_read_b64_tr_b16 a[76:77], v19 offset:10240
v_mfma_f32_16x16x32_bf16 v[36:39], a[92:95], a[36:39], v[36:39]
ds_read_b64_tr_b16 a[78:79], v19 offset:10496
v_mfma_f32_16x16x32_bf16 v[52:55], a[92:95], a[44:47], v[52:55]
ds_read_b64_tr_b16 a[80:81], v20 offset:8192
v_mfma_f32_16x16x32_bf16 v[52:55], a[88:91], a[40:43], v[52:55]
ds_read_b64_tr_b16 a[82:83], v20 offset:8448
v_mfma_f32_16x16x32_bf16 v[68:71], a[88:91], a[48:51], v[68:71]
ds_read_b64_tr_b16 a[84:85], v20 offset:10240
v_mfma_f32_16x16x32_bf16 v[68:71], a[92:95], a[52:55], v[68:71]
s_add_u32 m0, s77, 132096
ds_read_b64_tr_b16 a[86:87], v20 offset:10496
v_mfma_f32_16x16x32_bf16 v[84:87], a[92:95], a[60:63], v[84:87]
s_add_u32 s64, s71, 6324224
v_mfma_f32_16x16x32_bf16 v[84:87], a[88:91], a[56:59], v[84:87]
buffer_load_dwordx4 v14, s[56:59], s64 offen lds
v_mfma_f32_16x16x32_bf16 v[148:151], a[96:99], a[56:59], v[148:151]
ds_read_b64_tr_b16 a[88:89], v19 offset:0
v_mfma_f32_16x16x32_bf16 v[148:151], a[100:103], a[60:63], v[148:151]
ds_read_b64_tr_b16 a[90:91], v19 offset:256
v_mfma_f32_16x16x32_bf16 v[132:135], a[100:103], a[52:55], v[132:135]
ds_read_b64_tr_b16 a[92:93], v19 offset:2048
v_mfma_f32_16x16x32_bf16 v[132:135], a[96:99], a[48:51], v[132:135]
ds_read_b64_tr_b16 a[94:95], v19 offset:2304
v_mfma_f32_16x16x32_bf16 v[116:119], a[96:99], a[40:43], v[116:119]
v_mfma_f32_16x16x32_bf16 v[116:119], a[100:103], a[44:47], v[116:119]
v_mfma_f32_16x16x32_bf16 v[100:103], a[100:103], a[36:39], v[100:103]
s_add_u32 m0, s78, 151552
v_mfma_f32_16x16x32_bf16 v[100:103], a[96:99], a[32:35], v[100:103]
s_waitcnt lgkmcnt(4)
s_add_u32 s64, s75, 4720640
ds_read_b64_tr_b16 a[96:97], v20 offset:0
v_mfma_f32_16x16x32_bf16 v[184:187], a[104:107], a[0:3], v[184:187]
buffer_load_dwordx4 v23, s[60:63], s64 offen lds
v_mfma_f32_16x16x32_bf16 v[184:187], a[108:111], a[4:7], v[184:187]
ds_read_b64_tr_b16 a[98:99], v20 offset:256
v_mfma_f32_16x16x32_bf16 v[192:195], a[108:111], a[12:15], v[192:195]
ds_read_b64_tr_b16 a[100:101], v20 offset:2048
v_mfma_f32_16x16x32_bf16 v[192:195], a[104:107], a[8:11], v[192:195]
s_add_u32 s17, s78, .-L_pc+6144
ds_read_b64_tr_b16 a[102:103], v20 offset:2304
v_mfma_f32_16x16x32_bf16 v[200:203], a[104:107], a[16:19], v[200:203]
buffer_load_dword a252, v16, s[88:91], s17 offen
v_mfma_f32_16x16x32_bf16 v[200:203], a[108:111], a[20:23], v[200:203]
v_mfma_f32_16x16x32_bf16 v[208:211], a[108:111], a[28:31], v[208:211]
v_mfma_f32_16x16x32_bf16 v[208:211], a[104:107], a[24:27], v[208:211]
ds_read_b64_tr_b16 a[104:105], v4 offset:0
v_mfma_f32_16x16x32_bf16 v[212:215], a[112:115], a[24:27], v[212:215]
s_add_u32 m0, s77, 133120
ds_read_b64_tr_b16 a[106:107], v4 offset:1024
v_mfma_f32_16x16x32_bf16 v[212:215], a[116:119], a[28:31], v[212:215]
s_add_u32 s64, s71, 6356992
ds_read_b64_tr_b16 a[108:109], v4 offset:8192
v_mfma_f32_16x16x32_bf16 v[204:207], a[116:119], a[20:23], v[204:207]
buffer_load_dwordx4 v15, s[56:59], s64 offen lds
v_mfma_f32_16x16x32_bf16 v[204:207], a[112:115], a[16:19], v[204:207]
ds_read_b64_tr_b16 a[110:111], v4 offset:9216
v_mfma_f32_16x16x32_bf16 v[196:199], a[112:115], a[8:11], v[196:199]
v_mfma_f32_16x16x32_bf16 v[196:199], a[116:119], a[12:15], v[196:199]
v_mfma_f32_16x16x32_bf16 v[188:191], a[116:119], a[4:7], v[188:191]
v_mfma_f32_16x16x32_bf16 v[188:191], a[112:115], a[0:3], v[188:191]
ds_read_b64_tr_b16 a[112:113], v5 offset:0
v_mfma_f32_16x16x32_bf16 v[216:219], a[0:3], a[72:75], v[216:219]
ds_read_b64_tr_b16 a[114:115], v5 offset:1024
v_mfma_f32_16x16x32_bf16 v[216:219], a[4:7], a[76:79], v[216:219]
s_add_u32 m0, s78, 155648
ds_read_b64_tr_b16 a[116:117], v5 offset:8192
v_mfma_f32_16x16x32_bf16 v[224:227], a[12:15], a[76:79], v[224:227]
s_add_u32 s64, s75, 4722688
ds_read_b64_tr_b16 a[118:119], v5 offset:9216
v_mfma_f32_16x16x32_bf16 v[224:227], a[8:11], a[72:75], v[224:227]
buffer_load_dwordx4 v23, s[60:63], s64 offen lds
v_mfma_f32_16x16x32_bf16 v[232:235], a[16:19], a[72:75], v[232:235]
v_mfma_f32_16x16x32_bf16 v[232:235], a[20:23], a[76:79], v[232:235]
v_mfma_f32_16x16x32_bf16 v[240:243], a[28:31], a[76:79], v[240:243]
v_mfma_f32_16x16x32_bf16 v[240:243], a[24:27], a[72:75], v[240:243]
ds_read_b64_tr_b16 a[72:73], v6 offset:0
v_mfma_f32_16x16x32_bf16 v[244:247], a[24:27], a[80:83], v[244:247]
s_add_u32 s65, s79, 30720
ds_read_b64_tr_b16 a[74:75], v6 offset:1024
v_mfma_f32_16x16x32_bf16 v[244:247], a[28:31], a[84:87], v[244:247]
buffer_store_dwordx4 a[228:231], v16, s[44:47], s65 offen sc1
v_mfma_f32_16x16x32_bf16 v[236:239], a[20:23], a[84:87], v[236:239]
s_add_u32 m0, s77, 134144
ds_read_b64_tr_b16 a[76:77], v6 offset:8192
v_mfma_f32_16x16x32_bf16 v[236:239], a[16:19], a[80:83], v[236:239]
s_add_u32 s64, s71, 6389760
ds_read_b64_tr_b16 a[78:79], v6 offset:9216
v_mfma_f32_16x16x32_bf16 v[228:231], a[8:11], a[80:83], v[228:231]
buffer_load_dwordx4 v15, s[56:59], s64 offen lds
v_mfma_f32_16x16x32_bf16 v[228:231], a[12:15], a[84:87], v[228:231]
v_mfma_f32_16x16x32_bf16 v[220:223], a[4:7], a[84:87], v[220:223]
v_mfma_f32_16x16x32_bf16 v[220:223], a[0:3], a[80:83], v[220:223]
s_waitcnt lgkmcnt(4)
ds_read_b64_tr_b16 a[80:81], v7 offset:0
v_mfma_f32_16x16x32_bf16 v[152:155], a[88:91], a[0:3], v[152:155]
ds_read_b64_tr_b16 a[82:83], v7 offset:1024
v_mfma_f32_16x16x32_bf16 v[152:155], a[92:95], a[4:7], v[152:155]
ds_read_b64_tr_b16 a[84:85], v7 offset:8192
v_mfma_f32_16x16x32_bf16 v[160:163], a[92:95], a[12:15], v[160:163]
ds_read_b64_tr_b16 a[86:87], v7 offset:9216
v_mfma_f32_16x16x32_bf16 v[160:163], a[88:91], a[8:11], v[160:163]
v_mfma_f32_16x16x32_bf16 v[168:171], a[88:91], a[16:19], v[168:171]
v_mfma_f32_16x16x32_bf16 v[168:171], a[92:95], a[20:23], v[168:171]
v_mfma_f32_16x16x32_bf16 v[176:179], a[92:95], a[28:31], v[176:179]
s_add_u32 m0, s76, 0
v_mfma_f32_16x16x32_bf16 v[176:179], a[88:91], a[24:27], v[176:179]
s_add_u32 s64, s72, 1536
ds_read_b64_tr_b16 a[88:89], v8 offset:0
v_mfma_f32_16x16x32_bf16 v[180:183], a[96:99], a[24:27], v[180:183]
buffer_load_dwordx4 v12, s[48:51], s64 offen lds
v_mfma_f32_16x16x32_bf16 v[180:183], a[100:103], a[28:31], v[180:183]
ds_read_b64_tr_b16 a[90:91], v8 offset:1024
v_mfma_f32_16x16x32_bf16 v[172:175], a[100:103], a[20:23], v[172:175]
ds_read_b64_tr_b16 a[92:93], v8 offset:8192
v_mfma_f32_16x16x32_bf16 v[172:175], a[96:99], a[16:19], v[172:175]
s_add_u32 m0, s76, 1024
ds_read_b64_tr_b16 a[94:95], v8 offset:9216
v_mfma_f32_16x16x32_bf16 v[164:167], a[96:99], a[8:11], v[164:167]
s_add_u32 s64, s72, 17920
v_mfma_f32_16x16x32_bf16 v[164:167], a[100:103], a[12:15], v[164:167]
buffer_load_dwordx4 v13, s[48:51], s64 offen lds
v_mfma_f32_16x16x32_bf16 v[156:159], a[100:103], a[4:7], v[156:159]
v_mfma_f32_16x16x32_bf16 v[156:159], a[96:99], a[0:3], v[156:159]
ds_read_b64_tr_b16 a[96:97], v9 offset:0
v_mfma_f32_16x16x32_bf16 v[24:27], a[104:107], a[0:3], v[24:27]
s_add_u32 m0, s76, 2048
ds_read_b64_tr_b16 a[98:99], v9 offset:1024
v_mfma_f32_16x16x32_bf16 v[24:27], a[108:111], a[4:7], v[24:27]
s_add_u32 s64, s72, 132608
ds_read_b64_tr_b16 a[100:101], v9 offset:8192
v_mfma_f32_16x16x32_bf16 v[40:43], a[108:111], a[12:15], v[40:43]
buffer_load_dwordx4 v12, s[48:51], s64 offen lds
v_mfma_f32_16x16x32_bf16 v[40:43], a[104:107], a[8:11], v[40:43]
ds_read_b64_tr_b16 a[102:103], v9 offset:9216
v_mfma_f32_16x16x32_bf16 v[56:59], a[104:107], a[16:19], v[56:59]
v_mfma_f32_16x16x32_bf16 v[56:59], a[108:111], a[20:23], v[56:59]
s_add_u32 m0, s76, 3072
v_mfma_f32_16x16x32_bf16 v[72:75], a[108:111], a[28:31], v[72:75]
s_waitcnt vmcnt(13)
s_add_u32 s64, s72, 148992
ds_read_b128 a[32:35], v2 offset:32768
v_mfma_f32_16x16x32_bf16 v[72:75], a[104:107], a[24:27], v[72:75]
buffer_load_dwordx4 v13, s[48:51], s64 offen lds
v_mfma_f32_16x16x32_bf16 v[136:139], a[112:115], a[24:27], v[136:139]
ds_read_b128 a[36:39], v3 offset:32768
v_mfma_f32_16x16x32_bf16 v[136:139], a[116:119], a[28:31], v[136:139]
ds_read_b128 a[40:43], v2 offset:34816
v_mfma_f32_16x16x32_bf16 v[120:123], a[116:119], a[20:23], v[120:123]
s_add_u32 m0, s76, 4096
ds_read_b128 a[44:47], v3 offset:34816
v_mfma_f32_16x16x32_bf16 v[120:123], a[112:115], a[16:19], v[120:123]
s_add_u32 s64, s73, 1536
ds_read_b128 a[48:51], v2 offset:36864
v_mfma_f32_16x16x32_bf16 v[104:107], a[112:115], a[8:11], v[104:107]
buffer_load_dwordx4 v12, s[48:51], s64 offen lds
v_mfma_f32_16x16x32_bf16 v[104:107], a[116:119], a[12:15], v[104:107]
ds_read_b128 a[52:55], v3 offset:36864
v_mfma_f32_16x16x32_bf16 v[88:91], a[116:119], a[4:7], v[88:91]
ds_read_b128 a[56:59], v2 offset:38912
v_mfma_f32_16x16x32_bf16 v[88:91], a[112:115], a[0:3], v[88:91]
s_waitcnt lgkmcnt(7)
s_add_u32 m0, s76, 5120
ds_read_b128 a[60:63], v3 offset:38912
v_mfma_f32_16x16x32_bf16 v[28:31], a[72:75], a[0:3], v[28:31]
s_add_u32 s64, s73, 17920
ds_read_b64_tr_b16 a[104:105], v10 offset:0
v_mfma_f32_16x16x32_bf16 v[28:31], a[76:79], a[4:7], v[28:31]
buffer_load_dwordx4 v13, s[48:51], s64 offen lds
v_mfma_f32_16x16x32_bf16 v[44:47], a[76:79], a[12:15], v[44:47]
ds_read_b64_tr_b16 a[106:107], v10 offset:1024
v_mfma_f32_16x16x32_bf16 v[44:47], a[72:75], a[8:11], v[44:47]
ds_read_b64_tr_b16 a[108:109], v10 offset:8192
v_mfma_f32_16x16x32_bf16 v[60:63], a[72:75], a[16:19], v[60:63]
s_add_u32 m0, s76, 6144
ds_read_b64_tr_b16 a[110:111], v10 offset:9216
v_mfma_f32_16x16x32_bf16 v[60:63], a[76:79], a[20:23], v[60:63]
s_add_u32 s64, s73, 132608
ds_read_b64_tr_b16 a[112:113], v11 offset:0
v_mfma_f32_16x16x32_bf16 v[76:79], a[76:79], a[28:31], v[76:79]
buffer_load_dwordx4 v12, s[48:51], s64 offen lds
v_mfma_f32_16x16x32_bf16 v[76:79], a[72:75], a[24:27], v[76:79]
ds_read_b64_tr_b16 a[114:115], v11 offset:1024
v_mfma_f32_16x16x32_bf16 v[140:143], a[80:83], a[24:27], v[140:143]
s_add_u32 m0, s76, 7168
ds_read_b64_tr_b16 a[116:117], v11 offset:8192
v_mfma_f32_16x16x32_bf16 v[140:143], a[84:87], a[28:31], v[140:143]
s_add_u32 s64, s73, 148992
ds_read_b64_tr_b16 a[118:119], v11 offset:9216
v_mfma_f32_16x16x32_bf16 v[124:127], a[84:87], a[20:23], v[124:127]
v_readfirstlane_b32 vcc_lo, v1
s_nop 0
s_cmp_lt_u32 vcc_lo, s81
s_cbranch_scc1 L_spin_1
L_spinbk_2:
v_mfma_f32_16x16x32_bf16 v[124:127], a[80:83], a[16:19], v[124:127]
s_add_u32 s65, s79, 31744
buffer_load_dwordx4 v13, s[48:51], s64 offen lds
v_mfma_f32_16x16x32_bf16 v[108:111], a[80:83], a[8:11], v[108:111]
buffer_store_dwordx4 a[232:235], v16, s[44:47], s65 offen sc1
v_mfma_f32_16x16x32_bf16 v[108:111], a[84:87], a[12:15], v[108:111]
v_mfma_f32_16x16x32_bf16 v[92:95], a[84:87], a[4:7], v[92:95]
s_add_u32 s52, s28, 59768832
s_addc_u32 s53, s29, 0
s_mov_b32 s54, 16384
v_mfma_f32_16x16x32_bf16 v[92:95], a[80:83], a[0:3], v[92:95]
v_mfma_f32_16x16x32_bf16 v[32:35], a[88:91], a[0:3], v[32:35]
v_mfma_f32_16x16x32_bf16 v[32:35], a[92:95], a[4:7], v[32:35]
v_mfma_f32_16x16x32_bf16 v[48:51], a[92:95], a[12:15], v[48:51]
s_waitcnt lgkmcnt(0)
s_barrier
v_mfma_f32_16x16x32_bf16 v[48:51], a[88:91], a[8:11], v[48:51]
s_add_u32 m0, s77, 65536
ds_read_b64_tr_b16 a[72:73], v19 offset:36864
v_mfma_f32_16x16x32_bf16 v[64:67], a[88:91], a[16:19], v[64:67]
s_add_u32 s64, s71, 6815744
ds_read_b64_tr_b16 a[74:75], v19 offset:37120
v_mfma_f32_16x16x32_bf16 v[64:67], a[92:95], a[20:23], v[64:67]
buffer_load_dwordx4 v14, s[56:59], s64 offen lds
v_mfma_f32_16x16x32_bf16 v[80:83], a[92:95], a[28:31], v[80:83]
ds_read_b64_tr_b16 a[76:77], v19 offset:38912
v_mfma_f32_16x16x32_bf16 v[80:83], a[88:91], a[24:27], v[80:83]
ds_read_b64_tr_b16 a[78:79], v19 offset:39168
v_mfma_f32_16x16x32_bf16 v[144:147], a[96:99], a[24:27], v[144:147]
ds_read_b64_tr_b16 a[80:81], v20 offset:36864
v_mfma_f32_16x16x32_bf16 v[144:147], a[100:103], a[28:31], v[144:147]
ds_read_b64_tr_b16 a[82:83], v20 offset:37120
v_mfma_f32_16x16x32_bf16 v[128:131], a[100:103], a[20:23], v[128:131]
ds_read_b64_tr_b16 a[84:85], v20 offset:38912
v_mfma_f32_16x16x32_bf16 v[128:131], a[96:99], a[16:19], v[128:131]
ds_read_b64_tr_b16 a[86:87], v20 offset:39168
v_mfma_f32_16x16x32_bf16 v[112:115], a[96:99], a[8:11], v[112:115]
s_add_u32 m0, s78, 81920
ds_read_b64_tr_b16 a[88:89], v19 offset:40960
v_mfma_f32_16x16x32_bf16 v[112:115], a[100:103], a[12:15], v[112:115]
s_add_u32 s64, s75, 5111808
ds_read_b64_tr_b16 a[90:91], v19 offset:41216
v_mfma_f32_16x16x32_bf16 v[96:99], a[100:103], a[4:7], v[96:99]
buffer_load_dwordx4 v23, s[60:63], s64 offen lds
v_mfma_f32_16x16x32_bf16 v[96:99], a[96:99], a[0:3], v[96:99]
ds_read_b64_tr_b16 a[92:93], v19 offset:43008
v_mfma_f32_16x16x32_bf16 v[36:39], a[104:107], a[0:3], v[36:39]
ds_read_b64_tr_b16 a[94:95], v19 offset:43264
v_mfma_f32_16x16x32_bf16 v[36:39], a[108:111], a[4:7], v[36:39]
ds_read_b64_tr_b16 a[96:97], v20 offset:40960
v_mfma_f32_16x16x32_bf16 v[52:55], a[108:111], a[12:15], v[52:55]
ds_read_b64_tr_b16 a[98:99], v20 offset:41216
v_mfma_f32_16x16x32_bf16 v[52:55], a[104:107], a[8:11], v[52:55]
ds_read_b64_tr_b16 a[100:101], v20 offset:43008
v_mfma_f32_16x16x32_bf16 v[68:71], a[104:107], a[16:19], v[68:71]
ds_read_b64_tr_b16 a[102:103], v20 offset:43264
v_mfma_f32_16x16x32_bf16 v[68:71], a[108:111], a[20:23], v[68:71]
s_add_u32 m0, s77, 66560
v_mfma_f32_16x16x32_bf16 v[84:87], a[108:111], a[28:31], v[84:87]
s_add_u32 s64, s71, 6848512
v_mfma_f32_16x16x32_bf16 v[84:87], a[104:107], a[24:27], v[84:87]
buffer_load_dwordx4 v14, s[56:59], s64 offen lds
v_mfma_f32_16x16x32_bf16 v[148:151], a[112:115], a[24:27], v[148:151]
ds_read_b64_tr_b16 a[104:105], v19 offset:32768
v_mfma_f32_16x16x32_bf16 v[148:151], a[116:119], a[28:31], v[148:151]
ds_read_b64_tr_b16 a[106:107], v19 offset:33024
v_mfma_f32_16x16x32_bf16 v[132:135], a[116:119], a[20:23], v[132:135]
ds_read_b64_tr_b16 a[108:109], v19 offset:34816
v_mfma_f32_16x16x32_bf16 v[132:135], a[112:115], a[16:19], v[132:135]
ds_read_b64_tr_b16 a[110:111], v19 offset:35072
v_mfma_f32_16x16x32_bf16 v[116:119], a[112:115], a[8:11], v[116:119]
v_mfma_f32_16x16x32_bf16 v[116:119], a[116:119], a[12:15], v[116:119]
v_mfma_f32_16x16x32_bf16 v[100:103], a[116:119], a[4:7], v[100:103]
s_add_u32 m0, s78, 86016
v_mfma_f32_16x16x32_bf16 v[100:103], a[112:115], a[0:3], v[100:103]
s_waitcnt lgkmcnt(4)
s_add_u32 s64, s75, 5113856
ds_read_b64_tr_b16 a[112:113], v20 offset:32768
v_mfma_f32_16x16x32_bf16 v[184:187], a[72:75], a[32:35], v[184:187]
buffer_load_dwordx4 v23, s[60:63], s64 offen lds
v_mfma_f32_16x16x32_bf16 v[184:187], a[76:79], a[36:39], v[184:187]
ds_read_b64_tr_b16 a[114:115], v20 offset:33024
v_mfma_f32_16x16x32_bf16 v[192:195], a[76:79], a[44:47], v[192:195]
ds_read_b64_tr_b16 a[116:117], v20 offset:34816
v_mfma_f32_16x16x32_bf16 v[192:195], a[72:75], a[40:43], v[192:195]
ds_read_b64_tr_b16 a[118:119], v20 offset:35072
v_mfma_f32_16x16x32_bf16 v[200:203], a[72:75], a[48:51], v[200:203]
v_mfma_f32_16x16x32_bf16 v[200:203], a[76:79], a[52:55], v[200:203]
v_mfma_f32_16x16x32_bf16 v[208:211], a[76:79], a[60:63], v[208:211]
v_mfma_f32_16x16x32_bf16 v[208:211], a[72:75], a[56:59], v[208:211]
ds_read_b64_tr_b16 a[72:73], v4 offset:32768
v_mfma_f32_16x16x32_bf16 v[212:215], a[80:83], a[56:59], v[212:215]
s_add_u32 m0, s77, 67584
ds_read_b64_tr_b16 a[74:75], v4 offset:33792
v_mfma_f32_16x16x32_bf16 v[212:215], a[84:87], a[60:63], v[212:215]
s_add_u32 s64, s71, 6881280
ds_read_b64_tr_b16 a[76:77], v4 offset:40960
v_mfma_f32_16x16x32_bf16 v[204:207], a[84:87], a[52:55], v[204:207]
buffer_load_dwordx4 v15, s[56:59], s64 offen lds
v_mfma_f32_16x16x32_bf16 v[204:207], a[80:83], a[48:51], v[204:207]
s_add_u32 s65, s79, 15360
ds_read_b64_tr_b16 a[78:79], v4 offset:41984
v_mfma_f32_16x16x32_bf16 v[196:199], a[80:83], a[40:43], v[196:199]
buffer_store_dwordx4 a[236:239], v16, s[44:47], s65 offen sc1
v_mfma_f32_16x16x32_bf16 v[196:199], a[84:87], a[44:47], v[196:199]
v_mfma_f32_16x16x32_bf16 v[188:191], a[84:87], a[36:39], v[188:191]
v_mfma_f32_16x16x32_bf16 v[188:191], a[80:83], a[32:35], v[188:191]
ds_read_b64_tr_b16 a[80:81], v5 offset:32768
v_mfma_f32_16x16x32_bf16 v[216:219], a[32:35], a[88:91], v[216:219]
ds_read_b64_tr_b16 a[82:83], v5 offset:33792
v_mfma_f32_16x16x32_bf16 v[216:219], a[36:39], a[92:95], v[216:219]
s_add_u32 m0, s78, 90112
ds_read_b64_tr_b16 a[84:85], v5 offset:40960
v_mfma_f32_16x16x32_bf16 v[224:227], a[44:47], a[92:95], v[224:227]
s_add_u32 s64, s75, 5115904
ds_read_b64_tr_b16 a[86:87], v5 offset:41984
v_mfma_f32_16x16x32_bf16 v[224:227], a[40:43], a[88:91], v[224:227]
buffer_load_dwordx4 v23, s[60:63], s64 offen lds
v_mfma_f32_16x16x32_bf16 v[232:235], a[48:51], a[88:91], v[232:235]
v_mfma_f32_16x16x32_bf16 v[232:235], a[52:55], a[92:95], v[232:235]
v_mfma_f32_16x16x32_bf16 v[240:243], a[60:63], a[92:95], v[240:243]
v_mfma_f32_16x16x32_bf16 v[240:243], a[56:59], a[88:91], v[240:243]
ds_read_b64_tr_b16 a[88:89], v6 offset:32768
v_mfma_f32_16x16x32_bf16 v[244:247], a[56:59], a[96:99], v[244:247]
ds_read_b64_tr_b16 a[90:91], v6 offset:33792
v_mfma_f32_16x16x32_bf16 v[244:247], a[60:63], a[100:103], v[244:247]
ds_read_b64_tr_b16 a[92:93], v6 offset:40960
v_add_u32 v19, 0x8000, v19
v_mfma_f32_16x16x32_bf16 v[236:239], a[52:55], a[100:103], v[236:239]
s_add_u32 m0, s77, 68608
ds_read_b64_tr_b16 a[94:95], v6 offset:41984
v_mfma_f32_16x16x32_bf16 v[236:239], a[48:51], a[96:99], v[236:239]
s_add_u32 s64, s71, 6914048
v_mfma_f32_16x16x32_bf16 v[228:231], a[40:43], a[96:99], v[228:231]
buffer_load_dwordx4 v15, s[56:59], s64 offen lds
v_mfma_f32_16x16x32_bf16 v[228:231], a[44:47], a[100:103], v[228:231]
v_mfma_f32_16x16x32_bf16 v[220:223], a[36:39], a[100:103], v[220:223]
v_mfma_f32_16x16x32_bf16 v[220:223], a[32:35], a[96:99], v[220:223]
s_waitcnt lgkmcnt(4)
ds_read_b64_tr_b16 a[96:97], v7 offset:32768
v_mfma_f32_16x16x32_bf16 v[152:155], a[104:107], a[32:35], v[152:155]
ds_read_b64_tr_b16 a[98:99], v7 offset:33792
v_mfma_f32_16x16x32_bf16 v[152:155], a[108:111], a[36:39], v[152:155]
ds_read_b64_tr_b16 a[100:101], v7 offset:40960
v_add_u32 v20, 0x8000, v20
v_mfma_f32_16x16x32_bf16 v[160:163], a[108:111], a[44:47], v[160:163]
ds_read_b64_tr_b16 a[102:103], v7 offset:41984
v_mfma_f32_16x16x32_bf16 v[160:163], a[104:107], a[40:43], v[160:163]
v_mfma_f32_16x16x32_bf16 v[168:171], a[104:107], a[48:51], v[168:171]
v_mfma_f32_16x16x32_bf16 v[168:171], a[108:111], a[52:55], v[168:171]
v_mfma_f32_16x16x32_bf16 v[176:179], a[108:111], a[60:63], v[176:179]
s_add_u32 m0, s76, 32768
v_mfma_f32_16x16x32_bf16 v[176:179], a[104:107], a[56:59], v[176:179]
s_add_u32 s64, s72, 1664
ds_read_b64_tr_b16 a[104:105], v8 offset:32768
v_mfma_f32_16x16x32_bf16 v[180:183], a[112:115], a[56:59], v[180:183]
buffer_load_dwordx4 v12, s[48:51], s64 offen lds
v_mfma_f32_16x16x32_bf16 v[180:183], a[116:119], a[60:63], v[180:183]
ds_read_b64_tr_b16 a[106:107], v8 offset:33792
v_add_u32 v4, 0x8000, v4
v_mfma_f32_16x16x32_bf16 v[172:175], a[116:119], a[52:55], v[172:175]
ds_read_b64_tr_b16 a[108:109], v8 offset:40960
v_mfma_f32_16x16x32_bf16 v[172:175], a[112:115], a[48:51], v[172:175]
s_add_u32 m0, s76, 33792
ds_read_b64_tr_b16 a[110:111], v8 offset:41984
v_mfma_f32_16x16x32_bf16 v[164:167], a[112:115], a[40:43], v[164:167]
s_add_u32 s64, s72, 18048
v_mfma_f32_16x16x32_bf16 v[164:167], a[116:119], a[44:47], v[164:167]
buffer_load_dwordx4 v13, s[48:51], s64 offen lds
v_mfma_f32_16x16x32_bf16 v[156:159], a[116:119], a[36:39], v[156:159]
v_mfma_f32_16x16x32_bf16 v[156:159], a[112:115], a[32:35], v[156:159]
ds_read_b64_tr_b16 a[112:113], v9 offset:32768
v_mfma_f32_16x16x32_bf16 v[24:27], a[72:75], a[32:35], v[24:27]
s_add_u32 m0, s76, 34816
ds_read_b64_tr_b16 a[114:115], v9 offset:33792
v_mfma_f32_16x16x32_bf16 v[24:27], a[76:79], a[36:39], v[24:27]
s_add_u32 s64, s72, 132736
ds_read_b64_tr_b16 a[116:117], v9 offset:40960
v_add_u32 v5, 0x8000, v5
v_mfma_f32_16x16x32_bf16 v[40:43], a[76:79], a[44:47], v[40:43]
buffer_load_dwordx4 v12, s[48:51], s64 offen lds
v_mfma_f32_16x16x32_bf16 v[40:43], a[72:75], a[40:43], v[40:43]
ds_read_b64_tr_b16 a[118:119], v9 offset:41984
v_mfma_f32_16x16x32_bf16 v[56:59], a[72:75], a[48:51], v[56:59]
v_mfma_f32_16x16x32_bf16 v[56:59], a[76:79], a[52:55], v[56:59]
s_add_u32 m0, s76, 35840
v_mfma_f32_16x16x32_bf16 v[72:75], a[76:79], a[60:63], v[72:75]
s_waitcnt vmcnt(12)
s_add_u32 s64, s72, 149120
ds_read_b128 a[0:3], v2 offset:0
v_mfma_f32_16x16x32_bf16 v[72:75], a[72:75], a[56:59], v[72:75]
buffer_load_dwordx4 v13, s[48:51], s64 offen lds
v_mfma_f32_16x16x32_bf16 v[136:139], a[80:83], a[56:59], v[136:139]
ds_read_b128 a[4:7], v3 offset:0
v_mfma_f32_16x16x32_bf16 v[136:139], a[84:87], a[60:63], v[136:139]
ds_read_b128 a[8:11], v2 offset:2048
v_add_u32 v6, 0x8000, v6
v_mfma_f32_16x16x32_bf16 v[120:123], a[84:87], a[52:55], v[120:123]
s_add_u32 m0, s76, 36864
ds_read_b128 a[12:15], v3 offset:2048
v_mfma_f32_16x16x32_bf16 v[120:123], a[80:83], a[48:51], v[120:123]
s_add_u32 s64, s73, 1664
ds_read_b128 a[16:19], v2 offset:4096
v_mfma_f32_16x16x32_bf16 v[104:107], a[80:83], a[40:43], v[104:107]
buffer_load_dwordx4 v12, s[48:51], s64 offen lds
v_mfma_f32_16x16x32_bf16 v[104:107], a[84:87], a[44:47], v[104:107]
ds_read_b128 a[20:23], v3 offset:4096
v_mfma_f32_16x16x32_bf16 v[88:91], a[84:87], a[36:39], v[88:91]
buffer_store_dwordx4 a[240:243], v16, s[44:47], s74 offen sc1
v_mfma_f32_16x16x32_bf16 v[88:91], a[80:83], a[32:35], v[88:91]
s_waitcnt lgkmcnt(6)
s_add_u32 m0, s76, 37888
ds_read_b128 a[24:27], v2 offset:6144
v_mfma_f32_16x16x32_bf16 v[28:31], a[88:91], a[32:35], v[28:31]
s_add_u32 s64, s73, 18048
ds_read_b128 a[28:31], v3 offset:6144
v_mfma_f32_16x16x32_bf16 v[28:31], a[92:95], a[36:39], v[28:31]
buffer_load_dwordx4 v13, s[48:51], s64 offen lds
v_mfma_f32_16x16x32_bf16 v[44:47], a[92:95], a[44:47], v[44:47]
ds_read_b64_tr_b16 a[72:73], v10 offset:32768
v_add_u32 v7, 0x8000, v7
v_mfma_f32_16x16x32_bf16 v[44:47], a[88:91], a[40:43], v[44:47]
ds_read_b64_tr_b16 a[74:75], v10 offset:33792
v_mfma_f32_16x16x32_bf16 v[60:63], a[88:91], a[48:51], v[60:63]
s_add_u32 m0, s76, 38912
ds_read_b64_tr_b16 a[76:77], v10 offset:40960
v_mfma_f32_16x16x32_bf16 v[60:63], a[92:95], a[52:55], v[60:63]
s_add_u32 s64, s73, 132736
ds_read_b64_tr_b16 a[78:79], v10 offset:41984
v_mfma_f32_16x16x32_bf16 v[76:79], a[92:95], a[60:63], v[76:79]
buffer_load_dwordx4 v12, s[48:51], s64 offen lds
v_mfma_f32_16x16x32_bf16 v[76:79], a[88:91], a[56:59], v[76:79]
ds_read_b64_tr_b16 a[80:81], v11 offset:32768
v_mfma_f32_16x16x32_bf16 v[140:143], a[96:99], a[56:59], v[140:143]
ds_read_b64_tr_b16 a[82:83], v11 offset:33792
v_mfma_f32_16x16x32_bf16 v[140:143], a[100:103], a[60:63], v[140:143]
s_add_u32 m0, s76, 39936
ds_read_b64_tr_b16 a[84:85], v11 offset:40960
v_add_u32 v8, 0x8000, v8
v_mfma_f32_16x16x32_bf16 v[124:127], a[100:103], a[52:55], v[124:127]
s_add_u32 s64, s73, 149120
ds_read_b64_tr_b16 a[86:87], v11 offset:41984
v_mfma_f32_16x16x32_bf16 v[124:127], a[96:99], a[48:51], v[124:127]
buffer_load_dwordx4 v13, s[48:51], s64 offen lds
v_mfma_f32_16x16x32_bf16 v[108:111], a[96:99], a[40:43], v[108:111]
v_mfma_f32_16x16x32_bf16 v[108:111], a[100:103], a[44:47], v[108:111]
v_mfma_f32_16x16x32_bf16 v[92:95], a[100:103], a[36:39], v[92:95]
v_add_u32 v9, 0x8000, v9
v_add_u32 v10, 0x8000, v10
v_mfma_f32_16x16x32_bf16 v[92:95], a[96:99], a[32:35], v[92:95]
v_add_u32 v11, 0x8000, v11
v_mfma_f32_16x16x32_bf16 v[32:35], a[104:107], a[32:35], v[32:35]
v_mfma_f32_16x16x32_bf16 v[32:35], a[108:111], a[36:39], v[32:35]
v_mfma_f32_16x16x32_bf16 v[48:51], a[108:111], a[44:47], v[48:51]
s_waitcnt lgkmcnt(0)
s_barrier
v_mfma_f32_16x16x32_bf16 v[48:51], a[104:107], a[40:43], v[48:51]
s_add_u32 m0, s77, 98304
ds_read_b64_tr_b16 a[88:89], v19 offset:36864
v_mfma_f32_16x16x32_bf16 v[64:67], a[104:107], a[48:51], v[64:67]
s_add_u32 s64, s71, 7340032
ds_read_b64_tr_b16 a[90:91], v19 offset:37120
v_mfma_f32_16x16x32_bf16 v[64:67], a[108:111], a[52:55], v[64:67]
buffer_load_dwordx4 v14, s[56:59], s64 offen lds
v_mfma_f32_16x16x32_bf16 v[80:83], a[108:111], a[60:63], v[80:83]
ds_read_b64_tr_b16 a[92:93], v19 offset:38912
v_mfma_f32_16x16x32_bf16 v[80:83], a[104:107], a[56:59], v[80:83]
ds_read_b64_tr_b16 a[94:95], v19 offset:39168
v_mfma_f32_16x16x32_bf16 v[144:147], a[112:115], a[56:59], v[144:147]
ds_read_b64_tr_b16 a[96:97], v20 offset:36864
v_mfma_f32_16x16x32_bf16 v[144:147], a[116:119], a[60:63], v[144:147]
ds_read_b64_tr_b16 a[98:99], v20 offset:37120
v_mfma_f32_16x16x32_bf16 v[128:131], a[116:119], a[52:55], v[128:131]
ds_read_b64_tr_b16 a[100:101], v20 offset:38912
v_mfma_f32_16x16x32_bf16 v[128:131], a[112:115], a[48:51], v[128:131]
ds_read_b64_tr_b16 a[102:103], v20 offset:39168
v_mfma_f32_16x16x32_bf16 v[112:115], a[112:115], a[40:43], v[112:115]
s_add_u32 m0, s78, 114688
ds_read_b64_tr_b16 a[104:105], v19 offset:40960
v_mfma_f32_16x16x32_bf16 v[112:115], a[116:119], a[44:47], v[112:115]
s_add_u32 s64, s75, 5505024
ds_read_b64_tr_b16 a[106:107], v19 offset:41216
v_mfma_f32_16x16x32_bf16 v[96:99], a[116:119], a[36:39], v[96:99]
buffer_load_dwordx4 v23, s[60:63], s64 offen lds
v_mfma_f32_16x16x32_bf16 v[96:99], a[112:115], a[32:35], v[96:99]
ds_read_b64_tr_b16 a[108:109], v19 offset:43008
v_mfma_f32_16x16x32_bf16 v[36:39], a[72:75], a[32:35], v[36:39]
ds_read_b64_tr_b16 a[110:111], v19 offset:43264
v_mfma_f32_16x16x32_bf16 v[36:39], a[76:79], a[36:39], v[36:39]
ds_read_b64_tr_b16 a[112:113], v20 offset:40960
v_mfma_f32_16x16x32_bf16 v[52:55], a[76:79], a[44:47], v[52:55]
ds_read_b64_tr_b16 a[114:115], v20 offset:41216
v_mfma_f32_16x16x32_bf16 v[52:55], a[72:75], a[40:43], v[52:55]
ds_read_b64_tr_b16 a[116:117], v20 offset:43008
v_mfma_f32_16x16x32_bf16 v[68:71], a[72:75], a[48:51], v[68:71]
ds_read_b64_tr_b16 a[118:119], v20 offset:43264
v_mfma_f32_16x16x32_bf16 v[68:71], a[76:79], a[52:55], v[68:71]
s_add_u32 m0, s77, 99328
v_mfma_f32_16x16x32_bf16 v[84:87], a[76:79], a[60:63], v[84:87]
s_add_u32 s64, s71, 7372800
v_mfma_f32_16x16x32_bf16 v[84:87], a[72:75], a[56:59], v[84:87]
buffer_load_dwordx4 v14, s[56:59], s64 offen lds
v_mfma_f32_16x16x32_bf16 v[148:151], a[80:83], a[56:59], v[148:151]
ds_read_b64_tr_b16 a[72:73], v19 offset:32768
v_mfma_f32_16x16x32_bf16 v[148:151], a[84:87], a[60:63], v[148:151]
ds_read_b64_tr_b16 a[74:75], v19 offset:33024
v_mfma_f32_16x16x32_bf16 v[132:135], a[84:87], a[52:55], v[132:135]
ds_read_b64_tr_b16 a[76:77], v19 offset:34816
v_mfma_f32_16x16x32_bf16 v[132:135], a[80:83], a[48:51], v[132:135]
ds_read_b64_tr_b16 a[78:79], v19 offset:35072
v_mfma_f32_16x16x32_bf16 v[116:119], a[80:83], a[40:43], v[116:119]
v_mfma_f32_16x16x32_bf16 v[116:119], a[84:87], a[44:47], v[116:119]
v_mfma_f32_16x16x32_bf16 v[100:103], a[84:87], a[36:39], v[100:103]
s_add_u32 m0, s78, 118784
v_mfma_f32_16x16x32_bf16 v[100:103], a[80:83], a[32:35], v[100:103]
s_waitcnt lgkmcnt(4)
s_add_u32 s64, s75, 5507072
ds_read_b64_tr_b16 a[80:81], v20 offset:32768
v_mfma_f32_16x16x32_bf16 v[184:187], a[88:91], a[0:3], v[184:187]
s_lshl_b32 s66, s30, 30
buffer_load_dwordx4 v23, s[60:63], s64 offen lds
v_mfma_f32_16x16x32_bf16 v[184:187], a[92:95], a[4:7], v[184:187]
ds_read_b64_tr_b16 a[82:83], v20 offset:33024
v_lshl_add_u32 v1, v0, 24, s66
v_mfma_f32_16x16x32_bf16 v[192:195], a[92:95], a[12:15], v[192:195]
s_lshl_b32 s70, s31, 8
ds_read_b64_tr_b16 a[84:85], v20 offset:34816
v_mfma_f32_16x16x32_bf16 v[192:195], a[88:91], a[8:11], v[192:195]
s_add_u32 s17, s78, .-L_pc+6144
ds_read_b64_tr_b16 a[86:87], v20 offset:35072
v_mfma_f32_16x16x32_bf16 v[200:203], a[88:91], a[16:19], v[200:203]
buffer_load_dword a252, v16, s[88:91], s17 offen
v_mfma_f32_16x16x32_bf16 v[200:203], a[92:95], a[20:23], v[200:203]
v_mfma_f32_16x16x32_bf16 v[208:211], a[92:95], a[28:31], v[208:211]
v_mfma_f32_16x16x32_bf16 v[208:211], a[88:91], a[24:27], v[208:211]
ds_read_b64_tr_b16 a[88:89], v4 offset:32768
v_mfma_f32_16x16x32_bf16 v[212:215], a[96:99], a[24:27], v[212:215]
s_add_u32 m0, s77, 100352
ds_read_b64_tr_b16 a[90:91], v4 offset:33792
v_mfma_f32_16x16x32_bf16 v[212:215], a[100:103], a[28:31], v[212:215]
s_add_u32 s64, s71, 7405568
ds_read_b64_tr_b16 a[92:93], v4 offset:40960
v_mfma_f32_16x16x32_bf16 v[204:207], a[100:103], a[20:23], v[204:207]
buffer_load_dwordx4 v15, s[56:59], s64 offen lds
v_mfma_f32_16x16x32_bf16 v[204:207], a[96:99], a[16:19], v[204:207]
ds_read_b64_tr_b16 a[94:95], v4 offset:41984
v_mfma_f32_16x16x32_bf16 v[196:199], a[96:99], a[8:11], v[196:199]
v_mfma_f32_16x16x32_bf16 v[196:199], a[100:103], a[12:15], v[196:199]
v_mfma_f32_16x16x32_bf16 v[188:191], a[100:103], a[4:7], v[188:191]
v_mfma_f32_16x16x32_bf16 v[188:191], a[96:99], a[0:3], v[188:191]
ds_read_b64_tr_b16 a[96:97], v5 offset:32768
v_mfma_f32_16x16x32_bf16 v[216:219], a[0:3], a[104:107], v[216:219]
ds_read_b64_tr_b16 a[98:99], v5 offset:33792
v_mfma_f32_16x16x32_bf16 v[216:219], a[4:7], a[108:111], v[216:219]
s_add_u32 m0, s78, 122880
ds_read_b64_tr_b16 a[100:101], v5 offset:40960
v_mfma_f32_16x16x32_bf16 v[224:227], a[12:15], a[108:111], v[224:227]
s_add_u32 s64, s75, 5509120
ds_read_b64_tr_b16 a[102:103], v5 offset:41984
v_mfma_f32_16x16x32_bf16 v[224:227], a[8:11], a[104:107], v[224:227]
buffer_load_dwordx4 v23, s[60:63], s64 offen lds
v_mfma_f32_16x16x32_bf16 v[232:235], a[16:19], a[104:107], v[232:235]
v_mfma_f32_16x16x32_bf16 v[232:235], a[20:23], a[108:111], v[232:235]
v_mfma_f32_16x16x32_bf16 v[240:243], a[28:31], a[108:111], v[240:243]
v_mfma_f32_16x16x32_bf16 v[240:243], a[24:27], a[104:107], v[240:243]
ds_read_b64_tr_b16 a[104:105], v6 offset:32768
v_mfma_f32_16x16x32_bf16 v[244:247], a[24:27], a[112:115], v[244:247]
ds_read_b64_tr_b16 a[106:107], v6 offset:33792
v_mfma_f32_16x16x32_bf16 v[244:247], a[28:31], a[116:119], v[244:247]
ds_read_b64_tr_b16 a[108:109], v6 offset:40960
v_subrev_u32 v19, 0x8000, v19
v_mfma_f32_16x16x32_bf16 v[236:239], a[20:23], a[116:119], v[236:239]
s_add_u32 m0, s77, 101376
ds_read_b64_tr_b16 a[110:111], v6 offset:41984
v_mfma_f32_16x16x32_bf16 v[236:239], a[16:19], a[112:115], v[236:239]
s_add_u32 s64, s71, 7438336
v_mfma_f32_16x16x32_bf16 v[228:231], a[8:11], a[112:115], v[228:231]
buffer_load_dwordx4 v15, s[56:59], s64 offen lds
v_mfma_f32_16x16x32_bf16 v[228:231], a[12:15], a[116:119], v[228:231]
v_mfma_f32_16x16x32_bf16 v[220:223], a[4:7], a[116:119], v[220:223]
v_mfma_f32_16x16x32_bf16 v[220:223], a[0:3], a[112:115], v[220:223]
s_waitcnt lgkmcnt(4)
ds_read_b64_tr_b16 a[112:113], v7 offset:32768
v_mfma_f32_16x16x32_bf16 v[152:155], a[72:75], a[0:3], v[152:155]
ds_read_b64_tr_b16 a[114:115], v7 offset:33792
v_mfma_f32_16x16x32_bf16 v[152:155], a[76:79], a[4:7], v[152:155]
ds_read_b64_tr_b16 a[116:117], v7 offset:40960
v_subrev_u32 v20, 0x8000, v20
v_mfma_f32_16x16x32_bf16 v[160:163], a[76:79], a[12:15], v[160:163]
ds_read_b64_tr_b16 a[118:119], v7 offset:41984
v_mfma_f32_16x16x32_bf16 v[160:163], a[72:75], a[8:11], v[160:163]
v_mfma_f32_16x16x32_bf16 v[168:171], a[72:75], a[16:19], v[168:171]
v_mfma_f32_16x16x32_bf16 v[168:171], a[76:79], a[20:23], v[168:171]
v_mfma_f32_16x16x32_bf16 v[176:179], a[76:79], a[28:31], v[176:179]
s_add_u32 m0, s76, 0
v_mfma_f32_16x16x32_bf16 v[176:179], a[72:75], a[24:27], v[176:179]
s_add_u32 s64, s72, 1792
ds_read_b64_tr_b16 a[72:73], v8 offset:32768
v_mfma_f32_16x16x32_bf16 v[180:183], a[80:83], a[24:27], v[180:183]
buffer_load_dwordx4 v12, s[48:51], s64 offen lds
v_mfma_f32_16x16x32_bf16 v[180:183], a[84:87], a[28:31], v[180:183]
ds_read_b64_tr_b16 a[74:75], v8 offset:33792
v_subrev_u32 v4, 0x8000, v4
v_mfma_f32_16x16x32_bf16 v[172:175], a[84:87], a[20:23], v[172:175]
ds_read_b64_tr_b16 a[76:77], v8 offset:40960
v_mfma_f32_16x16x32_bf16 v[172:175], a[80:83], a[16:19], v[172:175]
s_add_u32 m0, s76, 1024
ds_read_b64_tr_b16 a[78:79], v8 offset:41984
v_mfma_f32_16x16x32_bf16 v[164:167], a[80:83], a[8:11], v[164:167]
s_add_u32 s64, s72, 18176
v_mfma_f32_16x16x32_bf16 v[164:167], a[84:87], a[12:15], v[164:167]
buffer_load_dwordx4 v13, s[48:51], s64 offen lds
v_mfma_f32_16x16x32_bf16 v[156:159], a[84:87], a[4:7], v[156:159]
v_mfma_f32_16x16x32_bf16 v[156:159], a[80:83], a[0:3], v[156:159]
ds_read_b64_tr_b16 a[80:81], v9 offset:32768
v_mfma_f32_16x16x32_bf16 v[24:27], a[88:91], a[0:3], v[24:27]
s_add_u32 m0, s76, 2048
ds_read_b64_tr_b16 a[82:83], v9 offset:33792
v_mfma_f32_16x16x32_bf16 v[24:27], a[92:95], a[4:7], v[24:27]
s_add_u32 s64, s72, 132864
ds_read_b64_tr_b16 a[84:85], v9 offset:40960
v_subrev_u32 v5, 0x8000, v5
v_mfma_f32_16x16x32_bf16 v[40:43], a[92:95], a[12:15], v[40:43]
buffer_load_dwordx4 v12, s[48:51], s64 offen lds
v_mfma_f32_16x16x32_bf16 v[40:43], a[88:91], a[8:11], v[40:43]
ds_read_b64_tr_b16 a[86:87], v9 offset:41984
v_mfma_f32_16x16x32_bf16 v[56:59], a[88:91], a[16:19], v[56:59]
v_mfma_f32_16x16x32_bf16 v[56:59], a[92:95], a[20:23], v[56:59]
s_add_u32 m0, s76, 3072
v_mfma_f32_16x16x32_bf16 v[72:75], a[92:95], a[28:31], v[72:75]
s_waitcnt vmcnt(11)
s_add_u32 s64, s72, 149248
ds_read_b128 a[32:35], v2 offset:32768
v_mfma_f32_16x16x32_bf16 v[72:75], a[88:91], a[24:27], v[72:75]
buffer_load_dwordx4 v13, s[48:51], s64 offen lds
v_mfma_f32_16x16x32_bf16 v[136:139], a[96:99], a[24:27], v[136:139]
ds_read_b128 a[36:39], v3 offset:32768
v_mfma_f32_16x16x32_bf16 v[136:139], a[100:103], a[28:31], v[136:139]
ds_read_b128 a[40:43], v2 offset:34816
v_subrev_u32 v6, 0x8000, v6
v_mfma_f32_16x16x32_bf16 v[120:123], a[100:103], a[20:23], v[120:123]
s_add_u32 m0, s76, 4096
ds_read_b128 a[44:47], v3 offset:34816
v_mfma_f32_16x16x32_bf16 v[120:123], a[96:99], a[16:19], v[120:123]
s_add_u32 s64, s73, 1792
ds_read_b128 a[48:51], v2 offset:36864
v_mfma_f32_16x16x32_bf16 v[104:107], a[96:99], a[8:11], v[104:107]
buffer_load_dwordx4 v12, s[48:51], s64 offen lds
v_mfma_f32_16x16x32_bf16 v[104:107], a[100:103], a[12:15], v[104:107]
ds_read_b128 a[52:55], v3 offset:36864
v_mfma_f32_16x16x32_bf16 v[88:91], a[100:103], a[4:7], v[88:91]
ds_read_b128 a[56:59], v2 offset:38912
v_mfma_f32_16x16x32_bf16 v[88:91], a[96:99], a[0:3], v[88:91]
s_waitcnt lgkmcnt(7)
s_add_u32 m0, s76, 5120
ds_read_b128 a[60:63], v3 offset:38912
v_mfma_f32_16x16x32_bf16 v[28:31], a[104:107], a[0:3], v[28:31]
s_add_u32 s64, s73, 18176
ds_read_b64_tr_b16 a[88:89], v10 offset:32768
v_mfma_f32_16x16x32_bf16 v[28:31], a[108:111], a[4:7], v[28:31]
buffer_load_dwordx4 v13, s[48:51], s64 offen lds
v_mfma_f32_16x16x32_bf16 v[44:47], a[108:111], a[12:15], v[44:47]
ds_read_b64_tr_b16 a[90:91], v10 offset:33792
v_subrev_u32 v7, 0x8000, v7
v_mfma_f32_16x16x32_bf16 v[44:47], a[104:107], a[8:11], v[44:47]
ds_read_b64_tr_b16 a[92:93], v10 offset:40960
v_mfma_f32_16x16x32_bf16 v[60:63], a[104:107], a[16:19], v[60:63]
s_add_u32 m0, s76, 6144
ds_read_b64_tr_b16 a[94:95], v10 offset:41984
v_mfma_f32_16x16x32_bf16 v[60:63], a[108:111], a[20:23], v[60:63]
s_add_u32 s64, s73, 132864
ds_read_b64_tr_b16 a[96:97], v11 offset:32768
v_mfma_f32_16x16x32_bf16 v[76:79], a[108:111], a[28:31], v[76:79]
buffer_load_dwordx4 v12, s[48:51], s64 offen lds
v_mfma_f32_16x16x32_bf16 v[76:79], a[104:107], a[24:27], v[76:79]
ds_read_b64_tr_b16 a[98:99], v11 offset:33792
v_mfma_f32_16x16x32_bf16 v[140:143], a[112:115], a[24:27], v[140:143]
ds_read_b64_tr_b16 a[100:101], v11 offset:40960
v_mfma_f32_16x16x32_bf16 v[140:143], a[116:119], a[28:31], v[140:143]
s_add_u32 m0, s76, 7168
ds_read_b64_tr_b16 a[102:103], v11 offset:41984
v_subrev_u32 v8, 0x8000, v8
v_mfma_f32_16x16x32_bf16 v[124:127], a[116:119], a[20:23], v[124:127]
s_add_u32 s64, s73, 149248
v_mfma_f32_16x16x32_bf16 v[124:127], a[112:115], a[16:19], v[124:127]
buffer_load_dwordx4 v13, s[48:51], s64 offen lds
v_mfma_f32_16x16x32_bf16 v[108:111], a[112:115], a[8:11], v[108:111]
v_mfma_f32_16x16x32_bf16 v[108:111], a[116:119], a[12:15], v[108:111]
v_mfma_f32_16x16x32_bf16 v[92:95], a[116:119], a[4:7], v[92:95]
v_subrev_u32 v9, 0x8000, v9
v_subrev_u32 v10, 0x8000, v10
v_mfma_f32_16x16x32_bf16 v[92:95], a[112:115], a[0:3], v[92:95]
v_subrev_u32 v11, 0x8000, v11
v_mfma_f32_16x16x32_bf16 v[32:35], a[72:75], a[0:3], v[32:35]
v_mfma_f32_16x16x32_bf16 v[32:35], a[76:79], a[4:7], v[32:35]
v_mfma_f32_16x16x32_bf16 v[48:51], a[76:79], a[12:15], v[48:51]
s_waitcnt lgkmcnt(0)
s_barrier
v_mfma_f32_16x16x32_bf16 v[48:51], a[72:75], a[8:11], v[48:51]
s_mov_b64 exec, 1
buffer_atomic_add a251, v1, s[52:55], s70 offen offset:0 sc1
s_mov_b64 exec, -1
s_add_u32 m0, s77, 131072
v_mfma_f32_16x16x32_bf16 v[64:67], a[72:75], a[16:19], v[64:67]
s_lshl4_add_u32 s70, s78, s70
s_add_u32 s64, s71, 7864320
ds_read_b64_tr_b16 a[104:105], v19 offset:4096
v_mfma_f32_16x16x32_bf16 v[64:67], a[76:79], a[20:23], v[64:67]
s_lshr_b32 s81, s81, 5
buffer_load_dwordx4 v14, s[56:59], s64 offen lds
v_mfma_f32_16x16x32_bf16 v[80:83], a[76:79], a[28:31], v[80:83]
ds_read_b64_tr_b16 a[106:107], v19 offset:4352
v_mfma_f32_16x16x32_bf16 v[80:83], a[72:75], a[24:27], v[80:83]
ds_read_b64_tr_b16 a[108:109], v19 offset:6144
v_mfma_f32_16x16x32_bf16 v[144:147], a[80:83], a[24:27], v[144:147]
ds_read_b64_tr_b16 a[110:111], v19 offset:6400
v_mfma_f32_16x16x32_bf16 v[144:147], a[84:87], a[28:31], v[144:147]
ds_read_b64_tr_b16 a[112:113], v20 offset:4096
v_mfma_f32_16x16x32_bf16 v[128:131], a[84:87], a[20:23], v[128:131]
ds_read_b64_tr_b16 a[114:115], v20 offset:4352
v_mfma_f32_16x16x32_bf16 v[128:131], a[80:83], a[16:19], v[128:131]
ds_read_b64_tr_b16 a[116:117], v20 offset:6144
v_mfma_f32_16x16x32_bf16 v[112:115], a[80:83], a[8:11], v[112:115]
s_add_u32 m0, s78, 147456
ds_read_b64_tr_b16 a[118:119], v20 offset:6400
v_mfma_f32_16x16x32_bf16 v[112:115], a[84:87], a[12:15], v[112:115]
s_add_u32 s64, s75, 5898240
ds_read_b64_tr_b16 a[72:73], v19 offset:8192
v_mfma_f32_16x16x32_bf16 v[96:99], a[84:87], a[4:7], v[96:99]
buffer_load_dwordx4 v23, s[60:63], s64 offen lds
v_mfma_f32_16x16x32_bf16 v[96:99], a[80:83], a[0:3], v[96:99]
ds_read_b64_tr_b16 a[74:75], v19 offset:8448
v_mfma_f32_16x16x32_bf16 v[36:39], a[88:91], a[0:3], v[36:39]
ds_read_b64_tr_b16 a[76:77], v19 offset:10240
v_mfma_f32_16x16x32_bf16 v[36:39], a[92:95], a[4:7], v[36:39]
ds_read_b64_tr_b16 a[78:79], v19 offset:10496
v_mfma_f32_16x16x32_bf16 v[52:55], a[92:95], a[12:15], v[52:55]
ds_read_b64_tr_b16 a[80:81], v20 offset:8192
v_mfma_f32_16x16x32_bf16 v[52:55], a[88:91], a[8:11], v[52:55]
ds_read_b64_tr_b16 a[82:83], v20 offset:8448
v_mfma_f32_16x16x32_bf16 v[68:71], a[88:91], a[16:19], v[68:71]
ds_read_b64_tr_b16 a[84:85], v20 offset:10240
v_mfma_f32_16x16x32_bf16 v[68:71], a[92:95], a[20:23], v[68:71]
s_add_u32 m0, s77, 132096
ds_read_b64_tr_b16 a[86:87], v20 offset:10496
v_mfma_f32_16x16x32_bf16 v[84:87], a[92:95], a[28:31], v[84:87]
s_add_u32 s64, s71, 7897088
v_mfma_f32_16x16x32_bf16 v[84:87], a[88:91], a[24:27], v[84:87]
buffer_load_dwordx4 v14, s[56:59], s64 offen lds
v_mfma_f32_16x16x32_bf16 v[148:151], a[96:99], a[24:27], v[148:151]
ds_read_b64_tr_b16 a[88:89], v19 offset:0
v_mfma_f32_16x16x32_bf16 v[148:151], a[100:103], a[28:31], v[148:151]
ds_read_b64_tr_b16 a[90:91], v19 offset:256
v_mfma_f32_16x16x32_bf16 v[132:135], a[100:103], a[20:23], v[132:135]
ds_read_b64_tr_b16 a[92:93], v19 offset:2048
v_mfma_f32_16x16x32_bf16 v[132:135], a[96:99], a[16:19], v[132:135]
ds_read_b64_tr_b16 a[94:95], v19 offset:2304
v_mfma_f32_16x16x32_bf16 v[116:119], a[96:99], a[8:11], v[116:119]
v_mfma_f32_16x16x32_bf16 v[116:119], a[100:103], a[12:15], v[116:119]
v_mfma_f32_16x16x32_bf16 v[100:103], a[100:103], a[4:7], v[100:103]
s_add_u32 m0, s78, 151552
v_mfma_f32_16x16x32_bf16 v[100:103], a[96:99], a[0:3], v[100:103]
s_waitcnt lgkmcnt(4)
s_add_u32 s64, s75, 5900288
ds_read_b64_tr_b16 a[96:97], v20 offset:0
v_mfma_f32_16x16x32_bf16 v[184:187], a[104:107], a[32:35], v[184:187]
buffer_load_dwordx4 v23, s[60:63], s64 offen lds
v_mfma_f32_16x16x32_bf16 v[184:187], a[108:111], a[36:39], v[184:187]
ds_read_b64_tr_b16 a[98:99], v20 offset:256
v_and_b32 v22, 15, v0
v_mfma_f32_16x16x32_bf16 v[192:195], a[108:111], a[44:47], v[192:195]
ds_read_b64_tr_b16 a[100:101], v20 offset:2048
v_lshlrev_b32 v22, 3, v22
v_mfma_f32_16x16x32_bf16 v[192:195], a[104:107], a[40:43], v[192:195]
s_lshl_b32 s85, s30, 7
s_add_u32 s85, s85, 58720256
ds_read_b64_tr_b16 a[102:103], v20 offset:2304
v_mfma_f32_16x16x32_bf16 v[200:203], a[104:107], a[48:51], v[200:203]
s_lshl_b32 s86, s3, 10
s_add_u32 s86, s86, s85
s_lshl_b32 s87, s16, 10
s_lshl_b32 s68, s31, 20
s_add_u32 s32, s28, s68
s_addc_u32 s33, s29, 0
v_mfma_f32_16x16x32_bf16 v[200:203], a[108:111], a[52:55], v[200:203]
s_add_u32 s87, s87, s85
s_add_u32 s68, s16, 1
s_lshl_b32 s34, s68, 16
v_mfma_f32_16x16x32_bf16 v[208:211], a[108:111], a[60:63], v[208:211]
v_mfma_f32_16x16x32_bf16 v[208:211], a[104:107], a[56:59], v[208:211]
ds_read_b64_tr_b16 a[104:105], v4 offset:0
v_mfma_f32_16x16x32_bf16 v[212:215], a[112:115], a[56:59], v[212:215]
s_add_u32 m0, s77, 133120
ds_read_b64_tr_b16 a[106:107], v4 offset:1024
v_mfma_f32_16x16x32_bf16 v[212:215], a[116:119], a[60:63], v[212:215]
s_add_u32 s64, s71, 7929856
ds_read_b64_tr_b16 a[108:109], v4 offset:8192
v_mfma_f32_16x16x32_bf16 v[204:207], a[116:119], a[52:55], v[204:207]
buffer_load_dwordx4 v15, s[56:59], s64 offen lds
v_mfma_f32_16x16x32_bf16 v[204:207], a[112:115], a[48:51], v[204:207]
ds_read_b64_tr_b16 a[110:111], v4 offset:9216
v_mfma_f32_16x16x32_bf16 v[196:199], a[112:115], a[40:43], v[196:199]
v_mfma_f32_16x16x32_bf16 v[196:199], a[116:119], a[44:47], v[196:199]
v_mfma_f32_16x16x32_bf16 v[188:191], a[116:119], a[36:39], v[188:191]
v_mfma_f32_16x16x32_bf16 v[188:191], a[112:115], a[32:35], v[188:191]
ds_read_b64_tr_b16 a[112:113], v5 offset:0
v_mfma_f32_16x16x32_bf16 v[216:219], a[32:35], a[72:75], v[216:219]
ds_read_b64_tr_b16 a[114:115], v5 offset:1024
v_mfma_f32_16x16x32_bf16 v[216:219], a[36:39], a[76:79], v[216:219]
s_add_u32 m0, s78, 155648
ds_read_b64_tr_b16 a[116:117], v5 offset:8192
v_mfma_f32_16x16x32_bf16 v[224:227], a[44:47], a[76:79], v[224:227]
s_add_u32 s64, s75, 5902336
ds_read_b64_tr_b16 a[118:119], v5 offset:9216
v_mfma_f32_16x16x32_bf16 v[224:227], a[40:43], a[72:75], v[224:227]
buffer_load_dwordx4 v23, s[60:63], s64 offen lds
v_mfma_f32_16x16x32_bf16 v[232:235], a[48:51], a[72:75], v[232:235]
v_mfma_f32_16x16x32_bf16 v[232:235], a[52:55], a[76:79], v[232:235]
v_mfma_f32_16x16x32_bf16 v[240:243], a[60:63], a[76:79], v[240:243]
v_mfma_f32_16x16x32_bf16 v[240:243], a[56:59], a[72:75], v[240:243]
ds_read_b64_tr_b16 a[72:73], v6 offset:0
v_mfma_f32_16x16x32_bf16 v[244:247], a[56:59], a[80:83], v[244:247]
ds_read_b64_tr_b16 a[74:75], v6 offset:1024
v_mfma_f32_16x16x32_bf16 v[244:247], a[60:63], a[84:87], v[244:247]
ds_read_b64_tr_b16 a[76:77], v6 offset:8192
v_mfma_f32_16x16x32_bf16 v[236:239], a[52:55], a[84:87], v[236:239]
s_add_u32 m0, s77, 134144
ds_read_b64_tr_b16 a[78:79], v6 offset:9216
v_mfma_f32_16x16x32_bf16 v[236:239], a[48:51], a[80:83], v[236:239]
s_add_u32 s64, s71, 7962624
v_mfma_f32_16x16x32_bf16 v[228:231], a[40:43], a[80:83], v[228:231]
buffer_load_dwordx4 v15, s[56:59], s64 offen lds
v_mfma_f32_16x16x32_bf16 v[228:231], a[44:47], a[84:87], v[228:231]
v_mfma_f32_16x16x32_bf16 v[220:223], a[36:39], a[84:87], v[220:223]
v_mfma_f32_16x16x32_bf16 v[220:223], a[32:35], a[80:83], v[220:223]
s_waitcnt lgkmcnt(4)
ds_read_b64_tr_b16 a[80:81], v7 offset:0
v_mfma_f32_16x16x32_bf16 v[152:155], a[88:91], a[32:35], v[152:155]
ds_read_b64_tr_b16 a[82:83], v7 offset:1024
v_mfma_f32_16x16x32_bf16 v[152:155], a[92:95], a[36:39], v[152:155]
ds_read_b64_tr_b16 a[84:85], v7 offset:8192
v_mfma_f32_16x16x32_bf16 v[160:163], a[92:95], a[44:47], v[160:163]
ds_read_b64_tr_b16 a[86:87], v7 offset:9216
v_mfma_f32_16x16x32_bf16 v[160:163], a[88:91], a[40:43], v[160:163]
v_mfma_f32_16x16x32_bf16 v[168:171], a[88:91], a[48:51], v[168:171]
v_mfma_f32_16x16x32_bf16 v[168:171], a[92:95], a[52:55], v[168:171]
v_mfma_f32_16x16x32_bf16 v[176:179], a[92:95], a[60:63], v[176:179]
s_add_u32 m0, s76, 32768
v_mfma_f32_16x16x32_bf16 v[176:179], a[88:91], a[56:59], v[176:179]
s_add_u32 s64, s72, 1920
ds_read_b64_tr_b16 a[88:89], v8 offset:0
v_mfma_f32_16x16x32_bf16 v[180:183], a[96:99], a[56:59], v[180:183]
buffer_load_dwordx4 v12, s[48:51], s64 offen lds
v_mfma_f32_16x16x32_bf16 v[180:183], a[100:103], a[60:63], v[180:183]
ds_read_b64_tr_b16 a[90:91], v8 offset:1024
v_mfma_f32_16x16x32_bf16 v[172:175], a[100:103], a[52:55], v[172:175]
ds_read_b64_tr_b16 a[92:93], v8 offset:8192
v_mfma_f32_16x16x32_bf16 v[172:175], a[96:99], a[48:51], v[172:175]
s_add_u32 m0, s76, 33792
ds_read_b64_tr_b16 a[94:95], v8 offset:9216
v_mfma_f32_16x16x32_bf16 v[164:167], a[96:99], a[40:43], v[164:167]
s_add_u32 s64, s72, 18304
v_mfma_f32_16x16x32_bf16 v[164:167], a[100:103], a[44:47], v[164:167]
buffer_load_dwordx4 v13, s[48:51], s64 offen lds
v_mfma_f32_16x16x32_bf16 v[156:159], a[100:103], a[36:39], v[156:159]
v_mfma_f32_16x16x32_bf16 v[156:159], a[96:99], a[32:35], v[156:159]
ds_read_b64_tr_b16 a[96:97], v9 offset:0
v_mfma_f32_16x16x32_bf16 v[24:27], a[104:107], a[32:35], v[24:27]
s_add_u32 m0, s76, 34816
ds_read_b64_tr_b16 a[98:99], v9 offset:1024
v_mfma_f32_16x16x32_bf16 v[24:27], a[108:111], a[36:39], v[24:27]
s_add_u32 s64, s72, 132992
ds_read_b64_tr_b16 a[100:101], v9 offset:8192
v_mfma_f32_16x16x32_bf16 v[40:43], a[108:111], a[44:47], v[40:43]
buffer_load_dwordx4 v12, s[48:51], s64 offen lds
v_mfma_f32_16x16x32_bf16 v[40:43], a[104:107], a[40:43], v[40:43]
ds_read_b64_tr_b16 a[102:103], v9 offset:9216
v_mfma_f32_16x16x32_bf16 v[56:59], a[104:107], a[48:51], v[56:59]
v_mfma_f32_16x16x32_bf16 v[56:59], a[108:111], a[52:55], v[56:59]
s_add_u32 m0, s76, 35840
v_mfma_f32_16x16x32_bf16 v[72:75], a[108:111], a[60:63], v[72:75]
s_waitcnt vmcnt(11)
s_add_u32 s64, s72, 149376
ds_read_b128 a[0:3], v2 offset:0
v_mfma_f32_16x16x32_bf16 v[72:75], a[104:107], a[56:59], v[72:75]
buffer_load_dwordx4 v13, s[48:51], s64 offen lds
v_mfma_f32_16x16x32_bf16 v[136:139], a[112:115], a[56:59], v[136:139]
ds_read_b128 a[4:7], v3 offset:0
v_mfma_f32_16x16x32_bf16 v[136:139], a[116:119], a[60:63], v[136:139]
ds_read_b128 a[8:11], v2 offset:2048
v_mfma_f32_16x16x32_bf16 v[120:123], a[116:119], a[52:55], v[120:123]
s_add_u32 m0, s76, 36864
ds_read_b128 a[12:15], v3 offset:2048
v_mfma_f32_16x16x32_bf16 v[120:123], a[112:115], a[48:51], v[120:123]
s_add_u32 s64, s73, 1920
ds_read_b128 a[16:19], v2 offset:4096
v_mfma_f32_16x16x32_bf16 v[104:107], a[112:115], a[40:43], v[104:107]
buffer_load_dwordx4 v12, s[48:51], s64 offen lds
v_mfma_f32_16x16x32_bf16 v[104:107], a[116:119], a[44:47], v[104:107]
ds_read_b128 a[20:23], v3 offset:4096
v_mfma_f32_16x16x32_bf16 v[88:91], a[116:119], a[36:39], v[88:91]
ds_read_b128 a[24:27], v2 offset:6144
v_mfma_f32_16x16x32_bf16 v[88:91], a[112:115], a[32:35], v[88:91]
s_waitcnt lgkmcnt(7)
s_add_u32 m0, s76, 37888
ds_read_b128 a[28:31], v3 offset:6144
v_mfma_f32_16x16x32_bf16 v[28:31], a[72:75], a[32:35], v[28:31]
s_add_u32 s64, s73, 18304
ds_read_b64_tr_b16 a[104:105], v10 offset:0
v_mfma_f32_16x16x32_bf16 v[28:31], a[76:79], a[36:39], v[28:31]
buffer_load_dwordx4 v13, s[48:51], s64 offen lds
v_mfma_f32_16x16x32_bf16 v[44:47], a[76:79], a[44:47], v[44:47]
ds_read_b64_tr_b16 a[106:107], v10 offset:1024
v_mfma_f32_16x16x32_bf16 v[44:47], a[72:75], a[40:43], v[44:47]
ds_read_b64_tr_b16 a[108:109], v10 offset:8192
v_mfma_f32_16x16x32_bf16 v[60:63], a[72:75], a[48:51], v[60:63]
s_add_u32 m0, s76, 38912
buffer_load_dword v1, off, s[52:55], s70 sc1
v_mfma_f32_16x16x32_bf16 v[60:63], a[76:79], a[52:55], v[60:63]
s_add_u32 s64, s73, 132992
ds_read_b64_tr_b16 a[110:111], v10 offset:9216
v_mfma_f32_16x16x32_bf16 v[76:79], a[76:79], a[60:63], v[76:79]
buffer_load_dwordx4 v12, s[48:51], s64 offen lds
v_mfma_f32_16x16x32_bf16 v[76:79], a[72:75], a[56:59], v[76:79]
ds_read_b64_tr_b16 a[112:113], v11 offset:0
v_mfma_f32_16x16x32_bf16 v[140:143], a[80:83], a[56:59], v[140:143]
ds_read_b64_tr_b16 a[114:115], v11 offset:1024
v_mfma_f32_16x16x32_bf16 v[140:143], a[84:87], a[60:63], v[140:143]
s_add_u32 m0, s76, 39936
ds_read_b64_tr_b16 a[116:117], v11 offset:8192
v_mfma_f32_16x16x32_bf16 v[124:127], a[84:87], a[52:55], v[124:127]
s_add_u32 s64, s73, 149376
ds_read_b64_tr_b16 a[118:119], v11 offset:9216
v_mfma_f32_16x16x32_bf16 v[124:127], a[80:83], a[48:51], v[124:127]
buffer_load_dwordx4 v13, s[48:51], s64 offen lds
v_mfma_f32_16x16x32_bf16 v[108:111], a[80:83], a[40:43], v[108:111]
v_mfma_f32_16x16x32_bf16 v[108:111], a[84:87], a[44:47], v[108:111]
v_mfma_f32_16x16x32_bf16 v[92:95], a[84:87], a[36:39], v[92:95]
buffer_load_dwordx2 a[64:65], v22, s[44:47], s86 offen offset:0 sc1
v_mfma_f32_16x16x32_bf16 v[92:95], a[80:83], a[32:35], v[92:95]
buffer_load_dwordx2 a[66:67], v22, s[44:47], s86 offen offset:512 sc1
v_mfma_f32_16x16x32_bf16 v[32:35], a[88:91], a[32:35], v[32:35]
buffer_load_dwordx2 a[68:69], v22, s[44:47], s87 offen offset:0 sc1
v_mfma_f32_16x16x32_bf16 v[32:35], a[92:95], a[36:39], v[32:35]
buffer_load_dwordx2 a[70:71], v22, s[44:47], s87 offen offset:512 sc1
v_mfma_f32_16x16x32_bf16 v[48:51], a[92:95], a[44:47], v[48:51]
s_waitcnt lgkmcnt(0)
s_barrier
v_mfma_f32_16x16x32_bf16 v[48:51], a[88:91], a[40:43], v[48:51]
ds_read_b64_tr_b16 a[72:73], v19 offset:36864
v_mfma_f32_16x16x32_bf16 v[64:67], a[88:91], a[48:51], v[64:67]
s_lshl2_add_u32 s72, s2, s30
ds_read_b64_tr_b16 a[74:75], v19 offset:37120
v_mfma_f32_16x16x32_bf16 v[64:67], a[92:95], a[52:55], v[64:67]
s_lshl_b32 s72, s72, 12
ds_read_b64_tr_b16 a[76:77], v19 offset:38912
v_mfma_f32_16x16x32_bf16 v[80:83], a[92:95], a[60:63], v[80:83]
s_add_u32 s72, s72, 67108864
ds_read_b64_tr_b16 a[78:79], v19 offset:39168
v_mfma_f32_16x16x32_bf16 v[80:83], a[88:91], a[56:59], v[80:83]
ds_read_b64_tr_b16 a[80:81], v20 offset:36864
v_mfma_f32_16x16x32_bf16 v[144:147], a[96:99], a[56:59], v[144:147]
ds_read_b64_tr_b16 a[82:83], v20 offset:37120
v_mfma_f32_16x16x32_bf16 v[144:147], a[100:103], a[60:63], v[144:147]
ds_read_b64_tr_b16 a[84:85], v20 offset:38912
v_mfma_f32_16x16x32_bf16 v[128:131], a[100:103], a[52:55], v[128:131]
ds_read_b64_tr_b16 a[86:87], v20 offset:39168
v_mfma_f32_16x16x32_bf16 v[128:131], a[96:99], a[48:51], v[128:131]
ds_read_b64_tr_b16 a[88:89], v19 offset:40960
v_mfma_f32_16x16x32_bf16 v[112:115], a[96:99], a[40:43], v[112:115]
ds_read_b64_tr_b16 a[90:91], v19 offset:41216
v_mfma_f32_16x16x32_bf16 v[112:115], a[100:103], a[44:47], v[112:115]
ds_read_b64_tr_b16 a[92:93], v19 offset:43008
v_mfma_f32_16x16x32_bf16 v[96:99], a[100:103], a[36:39], v[96:99]
ds_read_b64_tr_b16 a[94:95], v19 offset:43264
v_mfma_f32_16x16x32_bf16 v[96:99], a[96:99], a[32:35], v[96:99]
ds_read_b64_tr_b16 a[96:97], v20 offset:40960
v_mfma_f32_16x16x32_bf16 v[36:39], a[104:107], a[32:35], v[36:39]
buffer_store_dwordx4 a[240:243], v16, s[44:47], s72 offen offset:0 sc1
v_mfma_f32_16x16x32_bf16 v[36:39], a[108:111], a[36:39], v[36:39]
ds_read_b64_tr_b16 a[98:99], v20 offset:41216
v_mfma_f32_16x16x32_bf16 v[52:55], a[108:111], a[44:47], v[52:55]
ds_read_b64_tr_b16 a[100:101], v20 offset:43008
v_mfma_f32_16x16x32_bf16 v[52:55], a[104:107], a[40:43], v[52:55]
ds_read_b64_tr_b16 a[102:103], v20 offset:43264
v_mfma_f32_16x16x32_bf16 v[68:71], a[104:107], a[48:51], v[68:71]
v_mfma_f32_16x16x32_bf16 v[68:71], a[108:111], a[52:55], v[68:71]
v_mfma_f32_16x16x32_bf16 v[84:87], a[108:111], a[60:63], v[84:87]
v_mfma_f32_16x16x32_bf16 v[84:87], a[104:107], a[56:59], v[84:87]
ds_read_b64_tr_b16 a[104:105], v19 offset:32768
v_mfma_f32_16x16x32_bf16 v[148:151], a[112:115], a[56:59], v[148:151]
ds_read_b64_tr_b16 a[106:107], v19 offset:33024
v_mfma_f32_16x16x32_bf16 v[148:151], a[116:119], a[60:63], v[148:151]
ds_read_b64_tr_b16 a[108:109], v19 offset:34816
v_mfma_f32_16x16x32_bf16 v[132:135], a[116:119], a[52:55], v[132:135]
ds_read_b64_tr_b16 a[110:111], v19 offset:35072
v_mfma_f32_16x16x32_bf16 v[132:135], a[112:115], a[48:51], v[132:135]
v_mfma_f32_16x16x32_bf16 v[116:119], a[112:115], a[40:43], v[116:119]
v_mfma_f32_16x16x32_bf16 v[116:119], a[116:119], a[44:47], v[116:119]
v_mfma_f32_16x16x32_bf16 v[100:103], a[116:119], a[36:39], v[100:103]
buffer_store_dwordx4 a[240:243], v16, s[44:47], s72 offen offset:1024 sc1
v_mfma_f32_16x16x32_bf16 v[100:103], a[112:115], a[32:35], v[100:103]
s_waitcnt lgkmcnt(4)
ds_read_b64_tr_b16 a[112:113], v20 offset:32768
v_mfma_f32_16x16x32_bf16 v[184:187], a[72:75], a[0:3], v[184:187]
ds_read_b64_tr_b16 a[114:115], v20 offset:33024
v_and_b32 v12, 15, v0
v_mfma_f32_16x16x32_bf16 v[184:187], a[76:79], a[4:7], v[184:187]
ds_read_b64_tr_b16 a[116:117], v20 offset:34816
v_lshrrev_b32 v13, 4, v0
v_mfma_f32_16x16x32_bf16 v[192:195], a[76:79], a[12:15], v[192:195]
ds_read_b64_tr_b16 a[118:119], v20 offset:35072
v_lshlrev_b32 v13, 2, v13
v_mfma_f32_16x16x32_bf16 v[192:195], a[72:75], a[8:11], v[192:195]
v_sub_u32 v12, v12, v13
v_mfma_f32_16x16x32_bf16 v[200:203], a[72:75], a[16:19], v[200:203]
s_lshl_b32 s66, s30, 4
v_mfma_f32_16x16x32_bf16 v[200:203], a[76:79], a[20:23], v[200:203]
v_add_u32 v13, s66, v12
v_cmp_gt_i32 s[0:1], 0, v13
v_mfma_f32_16x16x32_bf16 v[208:211], a[76:79], a[28:31], v[208:211]
v_cmp_gt_i32 s[4:5], 1, v13
v_cmp_gt_i32 s[6:7], 2, v13
v_mfma_f32_16x16x32_bf16 v[208:211], a[72:75], a[24:27], v[208:211]
ds_read_b64_tr_b16 a[72:73], v4 offset:32768
v_cmp_gt_i32 s[8:9], 3, v13
v_mfma_f32_16x16x32_bf16 v[212:215], a[80:83], a[24:27], v[212:215]
ds_read_b64_tr_b16 a[74:75], v4 offset:33792
v_cmp_gt_i32 s[10:11], 16, v13
v_mfma_f32_16x16x32_bf16 v[212:215], a[84:87], a[28:31], v[212:215]
ds_read_b64_tr_b16 a[76:77], v4 offset:40960
v_cmp_gt_i32 s[12:13], 17, v13
v_mfma_f32_16x16x32_bf16 v[204:207], a[84:87], a[20:23], v[204:207]
ds_read_b64_tr_b16 a[78:79], v4 offset:41984
v_cmp_gt_i32 s[18:19], 18, v13
v_mfma_f32_16x16x32_bf16 v[204:207], a[80:83], a[16:19], v[204:207]
v_cmp_gt_i32 s[22:23], 19, v13
v_cmp_gt_i32 s[26:27], 32, v13
v_mfma_f32_16x16x32_bf16 v[196:199], a[80:83], a[8:11], v[196:199]
buffer_store_dwordx4 a[240:243], v16, s[44:47], s72 offen offset:2048 sc1
v_mfma_f32_16x16x32_bf16 v[196:199], a[84:87], a[12:15], v[196:199]
v_cmp_gt_i32 s[56:57], 33, v13
v_cmp_gt_i32 s[58:59], 34, v13
v_mfma_f32_16x16x32_bf16 v[188:191], a[84:87], a[4:7], v[188:191]
v_cmp_gt_i32 s[60:61], 35, v13
v_cmp_gt_i32 s[62:63], 48, v13
v_mfma_f32_16x16x32_bf16 v[188:191], a[80:83], a[0:3], v[188:191]
ds_read_b64_tr_b16 a[80:81], v5 offset:32768
v_cmp_gt_i32 s[48:49], 49, v13
v_mfma_f32_16x16x32_bf16 v[216:219], a[0:3], a[88:91], v[216:219]
ds_read_b64_tr_b16 a[82:83], v5 offset:33792
v_cmp_gt_i32 s[50:51], 50, v13
v_mfma_f32_16x16x32_bf16 v[216:219], a[4:7], a[92:95], v[216:219]
ds_read_b64_tr_b16 a[84:85], v5 offset:40960
v_cmp_gt_i32 s[100:101], 51, v13
v_mfma_f32_16x16x32_bf16 v[224:227], a[12:15], a[92:95], v[224:227]
ds_read_b64_tr_b16 a[86:87], v5 offset:41984
v_subrev_u32 v17, 0, v12
v_mfma_f32_16x16x32_bf16 v[224:227], a[8:11], a[88:91], v[224:227]
v_lshlrev_b32 v18, 31, v17
v_or_b32 v21, v17, v18
v_mfma_f32_16x16x32_bf16 v[232:235], a[16:19], a[88:91], v[232:235]
v_ashrrev_i32 v21, 31, v21
v_and_b32 v248, 0xff800000, v21
v_mfma_f32_16x16x32_bf16 v[232:235], a[20:23], a[92:95], v[232:235]
v_not_b32 v17, v17
v_or_b32 v21, v17, v18
v_mfma_f32_16x16x32_bf16 v[240:243], a[28:31], a[92:95], v[240:243]
v_ashrrev_i32 v21, 31, v21
v_and_b32 v252, 0xff800000, v21
v_mfma_f32_16x16x32_bf16 v[240:243], a[24:27], a[88:91], v[240:243]
ds_read_b64_tr_b16 a[88:89], v6 offset:32768
v_subrev_u32 v17, 1, v12
v_mfma_f32_16x16x32_bf16 v[244:247], a[24:27], a[96:99], v[244:247]
ds_read_b64_tr_b16 a[90:91], v6 offset:33792
v_lshlrev_b32 v18, 31, v17
v_mfma_f32_16x16x32_bf16 v[244:247], a[28:31], a[100:103], v[244:247]
ds_read_b64_tr_b16 a[92:93], v6 offset:40960
v_add_u32 v19, 0x8000, v19
v_mfma_f32_16x16x32_bf16 v[236:239], a[20:23], a[100:103], v[236:239]
buffer_store_dwordx4 a[240:243], v16, s[44:47], s72 offen offset:3072 sc1
v_mfma_f32_16x16x32_bf16 v[236:239], a[16:19], a[96:99], v[236:239]
ds_read_b64_tr_b16 a[94:95], v6 offset:41984
v_or_b32 v21, v17, v18
v_mfma_f32_16x16x32_bf16 v[228:231], a[8:11], a[96:99], v[228:231]
v_ashrrev_i32 v21, 31, v21
v_and_b32 v249, 0xff800000, v21
v_mfma_f32_16x16x32_bf16 v[228:231], a[12:15], a[100:103], v[228:231]
v_not_b32 v17, v17
v_or_b32 v21, v17, v18
v_mfma_f32_16x16x32_bf16 v[220:223], a[4:7], a[100:103], v[220:223]
v_ashrrev_i32 v21, 31, v21
v_and_b32 v253, 0xff800000, v21
v_mfma_f32_16x16x32_bf16 v[220:223], a[0:3], a[96:99], v[220:223]
s_waitcnt lgkmcnt(4)
ds_read_b64_tr_b16 a[96:97], v7 offset:32768
v_subrev_u32 v17, 2, v12
v_mfma_f32_16x16x32_bf16 v[152:155], a[104:107], a[0:3], v[152:155]
ds_read_b64_tr_b16 a[98:99], v7 offset:33792
v_lshlrev_b32 v18, 31, v17
v_mfma_f32_16x16x32_bf16 v[152:155], a[108:111], a[4:7], v[152:155]
ds_read_b64_tr_b16 a[100:101], v7 offset:40960
v_add_u32 v20, 0x8000, v20
v_mfma_f32_16x16x32_bf16 v[160:163], a[108:111], a[12:15], v[160:163]
ds_read_b64_tr_b16 a[102:103], v7 offset:41984
v_or_b32 v21, v17, v18
v_mfma_f32_16x16x32_bf16 v[160:163], a[104:107], a[8:11], v[160:163]
v_ashrrev_i32 v21, 31, v21
v_and_b32 v250, 0xff800000, v21
v_mfma_f32_16x16x32_bf16 v[168:171], a[104:107], a[16:19], v[168:171]
v_not_b32 v17, v17
v_or_b32 v21, v17, v18
v_mfma_f32_16x16x32_bf16 v[168:171], a[108:111], a[20:23], v[168:171]
v_ashrrev_i32 v21, 31, v21
v_and_b32 v254, 0xff800000, v21
v_mfma_f32_16x16x32_bf16 v[176:179], a[108:111], a[28:31], v[176:179]
v_subrev_u32 v17, 3, v12
v_lshlrev_b32 v18, 31, v17
v_mfma_f32_16x16x32_bf16 v[176:179], a[104:107], a[24:27], v[176:179]
ds_read_b64_tr_b16 a[104:105], v8 offset:32768
v_or_b32 v21, v17, v18
v_mfma_f32_16x16x32_bf16 v[180:183], a[112:115], a[24:27], v[180:183]
ds_read_b64_tr_b16 a[106:107], v8 offset:33792
v_ashrrev_i32 v21, 31, v21
v_mfma_f32_16x16x32_bf16 v[180:183], a[116:119], a[28:31], v[180:183]
ds_read_b64_tr_b16 a[108:109], v8 offset:40960
v_add_u32 v4, 0x8000, v4
v_mfma_f32_16x16x32_bf16 v[172:175], a[116:119], a[20:23], v[172:175]
ds_read_b64_tr_b16 a[110:111], v8 offset:41984
v_and_b32 v251, 0xff800000, v21
v_mfma_f32_16x16x32_bf16 v[172:175], a[112:115], a[16:19], v[172:175]
v_not_b32 v17, v17
v_or_b32 v21, v17, v18
v_mfma_f32_16x16x32_bf16 v[164:167], a[112:115], a[8:11], v[164:167]
s_add_u32 s17, s78, .-L_pc+6144
v_ashrrev_i32 v21, 31, v21
v_and_b32 v255, 0xff800000, v21
v_mfma_f32_16x16x32_bf16 v[164:167], a[116:119], a[12:15], v[164:167]
s_and_b32 s66, s2, 7
s_lshr_b32 s67, s2, 3
s_lshr_b32 s83, s66, 2
v_mfma_f32_16x16x32_bf16 v[156:159], a[116:119], a[4:7], v[156:159]
s_xor_b32 s83, s83, 1
s_and_b32 s68, s66, 1
s_and_b32 s69, s67, 7
v_mfma_f32_16x16x32_bf16 v[156:159], a[112:115], a[0:3], v[156:159]
s_lshl3_add_u32 s82, s68, s69
s_and_b32 s68, s66, 2
ds_read_b64_tr_b16 a[112:113], v9 offset:32768
v_mfma_f32_16x16x32_bf16 v[24:27], a[72:75], a[0:3], v[24:27]
s_lshr_b32 s69, s67, 3
s_lshl1_add_u32 s87, s68, s69
ds_read_b64_tr_b16 a[114:115], v9 offset:33792
v_mfma_f32_16x16x32_bf16 v[24:27], a[76:79], a[4:7], v[24:27]
s_lshl_b32 s87, s87, 8
ds_read_b64_tr_b16 a[116:117], v9 offset:40960
v_add_u32 v5, 0x8000, v5
v_mfma_f32_16x16x32_bf16 v[40:43], a[76:79], a[12:15], v[40:43]
s_lshl_b32 s86, s30, 13
buffer_load_dword a252, v16, s[88:91], s17 offen
v_mfma_f32_16x16x32_bf16 v[40:43], a[72:75], a[8:11], v[40:43]
s_lshl_b32 s85, s30, 16
s_add_u32 s85, s85, s87
ds_read_b64_tr_b16 a[118:119], v9 offset:41984
v_mfma_f32_16x16x32_bf16 v[56:59], a[72:75], a[16:19], v[56:59]
s_lshl_b32 s66, s83, 20
s_add_u32 s85, s85, s66
s_mul_i32 s84, s82, 1310720
v_mfma_f32_16x16x32_bf16 v[56:59], a[76:79], a[20:23], v[56:59]
s_and_b32 s66, s30, 1
s_lshl_b32 s66, s66, 14
s_add_u32 s84, s84, s66
v_mfma_f32_16x16x32_bf16 v[72:75], a[76:79], a[28:31], v[72:75]
s_waitcnt vmcnt(9)
s_lshl_b32 s66, s83, 17
ds_read_b128 a[32:35], v2 offset:32768
v_mfma_f32_16x16x32_bf16 v[72:75], a[72:75], a[24:27], v[72:75]
s_add_u32 s84, s84, s66
s_add_u32 s84, s84, 34603008
s_add_u32 s17, s78, .-L_pc+9984
ds_read_b128 a[36:39], v3 offset:32768
v_mfma_f32_16x16x32_bf16 v[136:139], a[80:83], a[24:27], v[136:139]
s_sub_u32 s66, 15, s82
buffer_load_dword a252, v16, s[88:91], s17 offen
v_mfma_f32_16x16x32_bf16 v[136:139], a[84:87], a[28:31], v[136:139]
s_min_u32 s66, s66, s82
ds_read_b128 a[40:43], v2 offset:34816
v_add_u32 v6, 0x8000, v6
v_mfma_f32_16x16x32_bf16 v[120:123], a[84:87], a[20:23], v[120:123]
s_lshl1_add_u32 s66, s66, s83
s_lshl_b32 s80, s66, 8
ds_read_b128 a[44:47], v3 offset:34816
v_mfma_f32_16x16x32_bf16 v[120:123], a[80:83], a[16:19], v[120:123]
s_add_u32 s80, s80, 8192
s_and_b32 s67, s30, 1
ds_read_b128 a[48:51], v2 offset:36864
v_mfma_f32_16x16x32_bf16 v[104:107], a[80:83], a[8:11], v[104:107]
s_lshl_b32 s67, s67, 7
s_add_u32 s67, s67, s83
ds_read_b128 a[52:55], v3 offset:36864
v_mfma_f32_16x16x32_bf16 v[104:107], a[84:87], a[12:15], v[104:107]
s_lshl_b32 s67, s67, 7
s_add_u32 s67, s67, 98304
ds_read_b128 a[56:59], v2 offset:38912
v_mfma_f32_16x16x32_bf16 v[88:91], a[84:87], a[4:7], v[88:91]
s_lshl_b32 s66, s30, 11
ds_read_b128 a[60:63], v3 offset:38912
v_lshrrev_b32 v14, 4, v0
v_mfma_f32_16x16x32_bf16 v[88:91], a[80:83], a[0:3], v[88:91]
s_waitcnt lgkmcnt(8)
ds_read_b64_tr_b16 a[72:73], v10 offset:32768
v_bfe_u32 v12, v0, 1, 3
v_mfma_f32_16x16x32_bf16 v[28:31], a[88:91], a[0:3], v[28:31]
ds_read_b64_tr_b16 a[74:75], v10 offset:33792
v_xor_b32 v12, v12, v14
v_mfma_f32_16x16x32_bf16 v[28:31], a[92:95], a[4:7], v[28:31]
ds_read_b64_tr_b16 a[76:77], v10 offset:40960
v_add_u32 v7, 0x8000, v7
v_mfma_f32_16x16x32_bf16 v[44:47], a[92:95], a[12:15], v[44:47]
ds_read_b64_tr_b16 a[78:79], v10 offset:41984
v_lshlrev_b32 v12, 5, v12
v_mfma_f32_16x16x32_bf16 v[44:47], a[88:91], a[8:11], v[44:47]
ds_read_b64_tr_b16 a[80:81], v11 offset:32768
v_lshl_add_u32 v12, v14, 11, v12
v_mfma_f32_16x16x32_bf16 v[60:63], a[88:91], a[16:19], v[60:63]
ds_read_b64_tr_b16 a[82:83], v11 offset:33792
v_and_b32 v14, 1, v0
v_mfma_f32_16x16x32_bf16 v[60:63], a[92:95], a[20:23], v[60:63]
ds_read_b64_tr_b16 a[84:85], v11 offset:40960
v_lshl_add_u32 v12, v14, 4, v12
v_mfma_f32_16x16x32_bf16 v[76:79], a[92:95], a[28:31], v[76:79]
s_add_u32 s17, s78, .-L_pc+13824
ds_read_b64_tr_b16 a[86:87], v11 offset:41984
v_xor_b32 v13, 128, v12
v_mfma_f32_16x16x32_bf16 v[76:79], a[88:91], a[24:27], v[76:79]
buffer_load_dword a252, v16, s[88:91], s17 offen
v_mfma_f32_16x16x32_bf16 v[140:143], a[96:99], a[24:27], v[140:143]
v_readfirstlane_b32 vcc_lo, v1
s_nop 0
s_cmp_lt_u32 vcc_lo, s81
s_cbranch_scc1 L_spin_4
L_spinbk_5:
v_mfma_f32_16x16x32_bf16 v[140:143], a[100:103], a[28:31], v[140:143]
s_add_u32 s17, s78, L_F1-L_pc
v_add_u32 v8, 0x8000, v8
v_lshrrev_b32 v14, 4, v0
v_mfma_f32_16x16x32_bf16 v[124:127], a[100:103], a[20:23], v[124:127]
buffer_load_dword a252, v16, s[88:91], s17 offen
v_mfma_f32_16x16x32_bf16 v[124:127], a[96:99], a[16:19], v[124:127]
v_bfe_u32 v18, v0, 2, 2
v_lshl_add_u32 v14, v14, 2, v18
v_mfma_f32_16x16x32_bf16 v[108:111], a[96:99], a[8:11], v[108:111]
s_add_u32 s17, s78, L_F1-L_pc+4096
v_and_b32 v18, 3, v0
v_lshlrev_b32 v18, 3, v18
v_mfma_f32_16x16x32_bf16 v[108:111], a[100:103], a[12:15], v[108:111]
buffer_load_dword a252, v16, s[88:91], s17 offen
v_mfma_f32_16x16x32_bf16 v[92:95], a[100:103], a[4:7], v[92:95]
v_add_u32 v9, 0x8000, v9
v_add_u32 v10, 0x8000, v10
v_mfma_f32_16x16x32_bf16 v[92:95], a[96:99], a[0:3], v[92:95]
v_add_u32 v11, 0x8000, v11
v_lshl_add_u32 v18, v14, 8, v18
v_mfma_f32_16x16x32_bf16 v[32:35], a[104:107], a[0:3], v[32:35]
v_and_b32 v14, 7, v14
v_lshl_add_u32 v18, v14, 5, v18
v_mfma_f32_16x16x32_bf16 v[32:35], a[108:111], a[4:7], v[32:35]
v_xor_b32 v18, s67, v18
v_add_u32 v14, s66, v16
v_mfma_f32_16x16x32_bf16 v[48:51], a[108:111], a[12:15], v[48:51]
s_waitcnt lgkmcnt(0)
s_barrier
v_mfma_f32_16x16x32_bf16 v[48:51], a[104:107], a[8:11], v[48:51]
ds_read_b64_tr_b16 a[88:89], v19 offset:36864
v_xor_b32 v15, 0x800, v14
v_mfma_f32_16x16x32_bf16 v[64:67], a[104:107], a[16:19], v[64:67]
s_lshr_b32 s66, s30, 1
s_lshl_b32 s66, s66, 16
ds_read_b64_tr_b16 a[90:91], v19 offset:37120
v_mfma_f32_16x16x32_bf16 v[64:67], a[108:111], a[20:23], v[64:67]
s_and_b32 s67, s30, 1
s_lshl_b32 s67, s67, 10
s_mov_b32 m0, s76
ds_read_b64_tr_b16 a[92:93], v19 offset:38912
v_mfma_f32_16x16x32_bf16 v[80:83], a[108:111], a[28:31], v[80:83]
s_add_u32 s66, s66, s67
s_add_u32 s66, s66, 32768
s_lshl_b32 s64, s30, 14
ds_read_b64_tr_b16 a[94:95], v19 offset:39168
v_mfma_f32_16x16x32_bf16 v[80:83], a[104:107], a[24:27], v[80:83]
buffer_load_dwordx4 v16, s[32:35], s64 offen offset:0 sc1 lds
v_mfma_f32_16x16x32_bf16 v[144:147], a[112:115], a[24:27], v[144:147]
ds_read_b64_tr_b16 a[96:97], v20 offset:36864
v_add_u32 v17, s66, v16
v_mfma_f32_16x16x32_bf16 v[144:147], a[116:119], a[28:31], v[144:147]
ds_read_b64_tr_b16 a[98:99], v20 offset:37120
v_lshlrev_b32 v21, 5, v0
v_mfma_f32_16x16x32_bf16 v[128:131], a[116:119], a[20:23], v[128:131]
s_lshl2_add_u32 s73, s2, s30
s_lshl_b32 s73, s73, 11
s_lshl_b32 s66, s30, 11
v_mfma_f32_16x16x32_bf16 v[128:131], a[112:115], a[16:19], v[128:131]
s_add_u32 s66, s66, 32768
buffer_load_dwordx4 v16, s[32:35], s64 offen offset:1024 sc1 lds
v_mfma_f32_16x16x32_bf16 v[112:115], a[112:115], a[8:11], v[112:115]
ds_read_b64_tr_b16 a[100:101], v20 offset:38912
v_add_u32 v2, s66, v16
v_mfma_f32_16x16x32_bf16 v[112:115], a[116:119], a[12:15], v[112:115]
ds_read_b64_tr_b16 a[102:103], v20 offset:39168
v_add_u32 v3, 0x10000, v2
v_mfma_f32_16x16x32_bf16 v[96:99], a[116:119], a[4:7], v[96:99]
ds_read_b64_tr_b16 a[104:105], v19 offset:40960
v_mfma_f32_16x16x32_bf16 v[96:99], a[112:115], a[0:3], v[96:99]
buffer_load_dwordx4 v16, s[32:35], s64 offen offset:2048 sc1 lds
v_mfma_f32_16x16x32_bf16 v[36:39], a[72:75], a[0:3], v[36:39]
ds_read_b64_tr_b16 a[106:107], v19 offset:41216
v_mfma_f32_16x16x32_bf16 v[36:39], a[76:79], a[4:7], v[36:39]
ds_read_b64_tr_b16 a[108:109], v19 offset:43008
v_mfma_f32_16x16x32_bf16 v[52:55], a[76:79], a[12:15], v[52:55]
ds_read_b64_tr_b16 a[110:111], v19 offset:43264
v_mfma_f32_16x16x32_bf16 v[52:55], a[72:75], a[8:11], v[52:55]
buffer_load_dwordx4 v16, s[32:35], s64 offen offset:3072 sc1 lds
v_mfma_f32_16x16x32_bf16 v[68:71], a[72:75], a[16:19], v[68:71]
ds_read_b64_tr_b16 a[112:113], v20 offset:40960
v_mfma_f32_16x16x32_bf16 v[68:71], a[76:79], a[20:23], v[68:71]
s_add_u32 m0, s76, 4096
ds_read_b64_tr_b16 a[114:115], v20 offset:41216
v_mfma_f32_16x16x32_bf16 v[84:87], a[76:79], a[28:31], v[84:87]
s_add_u32 s64, s64, 4096
ds_read_b64_tr_b16 a[116:117], v20 offset:43008
v_mfma_f32_16x16x32_bf16 v[84:87], a[72:75], a[24:27], v[84:87]
buffer_load_dwordx4 v16, s[32:35], s64 offen offset:0 sc1 lds
v_mfma_f32_16x16x32_bf16 v[148:151], a[80:83], a[24:27], v[148:151]
ds_read_b64_tr_b16 a[118:119], v20 offset:43264
v_mfma_f32_16x16x32_bf16 v[148:151], a[84:87], a[28:31], v[148:151]
ds_read_b64_tr_b16 a[72:73], v19 offset:32768
v_mfma_f32_16x16x32_bf16 v[132:135], a[84:87], a[20:23], v[132:135]
ds_read_b64_tr_b16 a[74:75], v19 offset:33024
v_mfma_f32_16x16x32_bf16 v[132:135], a[80:83], a[16:19], v[132:135]
buffer_load_dwordx4 v16, s[32:35], s64 offen offset:1024 sc1 lds
v_mfma_f32_16x16x32_bf16 v[116:119], a[80:83], a[8:11], v[116:119]
ds_read_b64_tr_b16 a[76:77], v19 offset:34816
v_mfma_f32_16x16x32_bf16 v[116:119], a[84:87], a[12:15], v[116:119]
ds_read_b64_tr_b16 a[78:79], v19 offset:35072
v_mfma_f32_16x16x32_bf16 v[100:103], a[84:87], a[4:7], v[100:103]
v_mfma_f32_16x16x32_bf16 v[100:103], a[80:83], a[0:3], v[100:103]
s_waitcnt lgkmcnt(6)
buffer_load_dwordx4 v16, s[32:35], s64 offen offset:2048 sc1 lds
v_mfma_f32_16x16x32_bf16 v[184:187], a[88:91], a[32:35], v[184:187]
ds_read_b64_tr_b16 a[80:81], v20 offset:32768
v_mfma_f32_16x16x32_bf16 v[184:187], a[92:95], a[36:39], v[184:187]
ds_read_b64_tr_b16 a[82:83], v20 offset:33024
v_mfma_f32_16x16x32_bf16 v[192:195], a[92:95], a[44:47], v[192:195]
ds_read_b64_tr_b16 a[84:85], v20 offset:34816
v_mfma_f32_16x16x32_bf16 v[192:195], a[88:91], a[40:43], v[192:195]
buffer_load_dwordx4 v16, s[32:35], s64 offen offset:3072 sc1 lds
v_mfma_f32_16x16x32_bf16 v[200:203], a[88:91], a[48:51], v[200:203]
ds_read_b64_tr_b16 a[86:87], v20 offset:35072
v_mfma_f32_16x16x32_bf16 v[200:203], a[92:95], a[52:55], v[200:203]
s_or_b32 s66, s3, s30
s_cmp_eq_u32 s66, 0
s_cselect_b32 s66, 0xff800000, 0
v_mfma_f32_16x16x32_bf16 v[208:211], a[92:95], a[60:63], v[208:211]
s_and_b32 s67, s74, 0x7800
s_cselect_b32 s67, 0, 0x70000000
s_add_u32 s77, s74, s67
s_lshr_b32 s64, s76, 1
s_add_u32 m0, s64, 81920
s_and_b32 s71, s64, 8192
s_add_u32 s64, s64, s71
s_add_u32 s64, s64, 8192
v_mfma_f32_16x16x32_bf16 v[208:211], a[88:91], a[56:59], v[208:211]
s_sub_u32 s77, s77, 2048
buffer_load_dwordx4 v16, s[32:35], s64 offen offset:0 sc1 lds
v_mfma_f32_16x16x32_bf16 v[212:215], a[96:99], a[56:59], v[212:215]
s_mov_b32 s68, 0x3e0293ee
ds_read_b64_tr_b16 a[88:89], v4 offset:32768
v_mfma_f32_16x16x32_bf16 v[212:215], a[100:103], a[60:63], v[212:215]
s_mov_b32 s69, s68
ds_read_b64_tr_b16 a[90:91], v4 offset:33792
v_mfma_f32_16x16x32_bf16 v[204:207], a[100:103], a[52:55], v[204:207]
ds_read_b64_tr_b16 a[92:93], v4 offset:40960
v_mfma_f32_16x16x32_bf16 v[204:207], a[96:99], a[48:51], v[204:207]
buffer_load_dwordx4 v16, s[32:35], s64 offen offset:1024 sc1 lds
v_mfma_f32_16x16x32_bf16 v[196:199], a[96:99], a[40:43], v[196:199]
ds_read_b64_tr_b16 a[94:95], v4 offset:41984
v_mfma_f32_16x16x32_bf16 v[196:199], a[100:103], a[44:47], v[196:199]
v_mfma_f32_16x16x32_bf16 v[188:191], a[100:103], a[36:39], v[188:191]
v_mfma_f32_16x16x32_bf16 v[188:191], a[96:99], a[32:35], v[188:191]
buffer_load_dwordx4 v16, s[32:35], s64 offen offset:2048 sc1 lds
v_mfma_f32_16x16x32_bf16 v[216:219], a[32:35], a[104:107], v[216:219]
ds_read_b64_tr_b16 a[96:97], v5 offset:32768
v_mfma_f32_16x16x32_bf16 v[216:219], a[36:39], a[108:111], v[216:219]
ds_read_b64_tr_b16 a[98:99], v5 offset:33792
v_cvt_pk_bf16_f32 v208, v208, v209
v_mfma_f32_16x16x32_bf16 v[224:227], a[44:47], a[108:111], v[224:227]
ds_read_b64_tr_b16 a[100:101], v5 offset:40960
v_cvt_pk_bf16_f32 v209, v210, v211
v_mfma_f32_16x16x32_bf16 v[224:227], a[40:43], a[104:107], v[224:227]
buffer_load_dwordx4 v16, s[32:35], s64 offen offset:3072 sc1 lds
v_mfma_f32_16x16x32_bf16 v[232:235], a[48:51], a[104:107], v[232:235]
ds_read_b64_tr_b16 a[102:103], v5 offset:41984
v_cvt_pk_bf16_f32 v210, v212, v213
v_mfma_f32_16x16x32_bf16 v[232:235], a[52:55], a[108:111], v[232:235]
v_cvt_pk_bf16_f32 v211, v214, v215
v_mfma_f32_16x16x32_bf16 v[240:243], a[60:63], a[108:111], v[240:243]
ds_write_b128 v3, v[208:211] offset:10240
v_mfma_f32_16x16x32_bf16 v[240:243], a[56:59], a[104:107], v[240:243]
ds_read_b64_tr_b16 a[104:105], v6 offset:32768
v_cvt_pk_bf16_f32 v200, v200, v201
v_mfma_f32_16x16x32_bf16 v[244:247], a[56:59], a[112:115], v[244:247]
s_waitcnt lgkmcnt(6)
ds_read_b64_tr_b16 a[106:107], v6 offset:33792
v_cvt_pk_bf16_f32 v201, v202, v203
v_mfma_f32_16x16x32_bf16 v[244:247], a[60:63], a[116:119], v[244:247]
ds_read_b64_tr_b16 a[108:109], v6 offset:40960
v_cvt_pk_bf16_f32 v202, v204, v205
v_mfma_f32_16x16x32_bf16 v[236:239], a[52:55], a[116:119], v[236:239]
ds_read_b64_tr_b16 a[110:111], v6 offset:41984
v_cvt_pk_bf16_f32 v203, v206, v207
v_mfma_f32_16x16x32_bf16 v[236:239], a[48:51], a[112:115], v[236:239]
ds_write_b128 v3, v[200:203] offset:2048
v_mfma_f32_16x16x32_bf16 v[228:231], a[40:43], a[112:115], v[228:231]
v_cvt_pk_bf16_f32 v192, v192, v193
v_cvt_pk_bf16_f32 v193, v194, v195
v_mfma_f32_16x16x32_bf16 v[228:231], a[44:47], a[116:119], v[228:231]
v_cvt_pk_bf16_f32 v194, v196, v197
v_cvt_pk_bf16_f32 v195, v198, v199
v_mfma_f32_16x16x32_bf16 v[220:223], a[36:39], a[116:119], v[220:223]
ds_write_b128 v2, v[192:195] offset:10240
v_mfma_f32_16x16x32_bf16 v[220:223], a[32:35], a[112:115], v[220:223]
ds_read_b64_tr_b16 a[112:113], v7 offset:32768
v_cvt_pk_bf16_f32 v184, v184, v185
v_mfma_f32_16x16x32_bf16 v[152:155], a[72:75], a[32:35], v[152:155]
ds_read_b64_tr_b16 a[114:115], v7 offset:33792
v_cvt_pk_bf16_f32 v185, v186, v187
v_mfma_f32_16x16x32_bf16 v[152:155], a[76:79], a[36:39], v[152:155]
ds_read_b64_tr_b16 a[116:117], v7 offset:40960
v_cvt_pk_bf16_f32 v186, v188, v189
v_mfma_f32_16x16x32_bf16 v[160:163], a[76:79], a[44:47], v[160:163]
ds_read_b64_tr_b16 a[118:119], v7 offset:41984
v_cvt_pk_bf16_f32 v187, v190, v191
v_mfma_f32_16x16x32_bf16 v[160:163], a[72:75], a[40:43], v[160:163]
ds_write_b128 v2, v[184:187] offset:2048
v_mfma_f32_16x16x32_bf16 v[168:171], a[72:75], a[48:51], v[168:171]
v_cvt_pk_bf16_f32 v219, v218, v219
v_cvt_pk_bf16_f32 v218, v216, v217
v_mfma_f32_16x16x32_bf16 v[168:171], a[76:79], a[52:55], v[168:171]
ds_write_b64 v2, v[218:219] offset:3072
v_mfma_f32_16x16x32_bf16 v[176:179], a[76:79], a[60:63], v[176:179]
buffer_load_dword a252, v21, s[36:39], s73 offen
v_mfma_f32_16x16x32_bf16 v[176:179], a[72:75], a[56:59], v[176:179]
ds_read_b64_tr_b16 a[72:73], v8 offset:32768
v_cvt_pk_bf16_f32 v227, v226, v227
v_mfma_f32_16x16x32_bf16 v[180:183], a[80:83], a[56:59], v[180:183]
ds_read_b64_tr_b16 a[74:75], v8 offset:33792
v_cvt_pk_bf16_f32 v226, v224, v225
v_mfma_f32_16x16x32_bf16 v[180:183], a[84:87], a[60:63], v[180:183]
ds_write_b64 v2, v[226:227] offset:11264
v_mfma_f32_16x16x32_bf16 v[172:175], a[84:87], a[52:55], v[172:175]
ds_read_b64_tr_b16 a[76:77], v8 offset:40960
v_cvt_pk_bf16_f32 v235, v234, v235
v_mfma_f32_16x16x32_bf16 v[172:175], a[80:83], a[48:51], v[172:175]
ds_read_b64_tr_b16 a[78:79], v8 offset:41984
v_cvt_pk_bf16_f32 v234, v232, v233
v_mfma_f32_16x16x32_bf16 v[164:167], a[80:83], a[40:43], v[164:167]
ds_write_b64 v3, v[234:235] offset:3072
v_mfma_f32_16x16x32_bf16 v[164:167], a[84:87], a[44:47], v[164:167]
v_cvt_pk_bf16_f32 v243, v242, v243
v_cvt_pk_bf16_f32 v242, v240, v241
v_mfma_f32_16x16x32_bf16 v[156:159], a[84:87], a[36:39], v[156:159]
ds_write_b64 v3, v[242:243] offset:11264
v_mfma_f32_16x16x32_bf16 v[156:159], a[80:83], a[32:35], v[156:159]
ds_read_b64_tr_b16 a[80:81], v9 offset:32768
v_cvt_pk_bf16_f32 v247, v246, v247
v_mfma_f32_16x16x32_bf16 v[24:27], a[88:91], a[32:35], v[24:27]
ds_read_b64_tr_b16 a[82:83], v9 offset:33792
v_cvt_pk_bf16_f32 v246, v244, v245
v_mfma_f32_16x16x32_bf16 v[24:27], a[92:95], a[36:39], v[24:27]
ds_write_b64 v3, v[246:247] offset:11272
v_mfma_f32_16x16x32_bf16 v[40:43], a[92:95], a[44:47], v[40:43]
ds_read_b64_tr_b16 a[84:85], v9 offset:40960
v_cvt_pk_bf16_f32 v239, v238, v239
v_cvt_pk_bf16_f32 v238, v236, v237
v_mfma_f32_16x16x32_bf16 v[40:43], a[88:91], a[40:43], v[40:43]
ds_write_b64 v3, v[238:239] offset:3080
v_mfma_f32_16x16x32_bf16 v[56:59], a[88:91], a[48:51], v[56:59]
ds_read_b64_tr_b16 a[86:87], v9 offset:41984
v_cvt_pk_bf16_f32 v231, v230, v231
v_cvt_pk_bf16_f32 v230, v228, v229
v_mfma_f32_16x16x32_bf16 v[56:59], a[92:95], a[52:55], v[56:59]
ds_write_b64 v2, v[230:231] offset:11272
v_mfma_f32_16x16x32_bf16 v[72:75], a[92:95], a[60:63], v[72:75]
v_cvt_pk_bf16_f32 v223, v222, v223
v_cvt_pk_bf16_f32 v222, v220, v221
v_mfma_f32_16x16x32_bf16 v[72:75], a[88:91], a[56:59], v[72:75]
s_waitcnt lgkmcnt(8)
ds_write_b64 v2, v[222:223] offset:3080
v_mfma_f32_16x16x32_bf16 v[136:139], a[96:99], a[56:59], v[136:139]
ds_read_b64_tr_b16 a[88:89], v10 offset:32768
v_cvt_pk_bf16_f32 v176, v176, v177
v_mfma_f32_16x16x32_bf16 v[136:139], a[100:103], a[60:63], v[136:139]
s_waitcnt lgkmcnt(0)
s_barrier
v_mfma_f32_16x16x32_bf16 v[120:123], a[100:103], a[52:55], v[120:123]
ds_read_b128 a[16:19], v17 offset:16384
v_cvt_pk_bf16_f32 v177, v178, v179
v_mfma_f32_16x16x32_bf16 v[120:123], a[96:99], a[48:51], v[120:123]
ds_read_b64_tr_b16 a[90:91], v10 offset:33792
v_cvt_pk_bf16_f32 v178, v180, v181
v_mfma_f32_16x16x32_bf16 v[104:107], a[96:99], a[40:43], v[104:107]
ds_read_b64_tr_b16 a[92:93], v10 offset:40960
v_cvt_pk_bf16_f32 v179, v182, v183
v_mfma_f32_16x16x32_bf16 v[104:107], a[100:103], a[44:47], v[104:107]
ds_read_b64_tr_b16 a[94:95], v10 offset:41984
v_cvt_pk_bf16_f32 v168, v168, v169
v_mfma_f32_16x16x32_bf16 v[88:91], a[100:103], a[36:39], v[88:91]
v_cvt_pk_bf16_f32 v169, v170, v171
v_cvt_pk_bf16_f32 v170, v172, v173
v_mfma_f32_16x16x32_bf16 v[88:91], a[96:99], a[32:35], v[88:91]
ds_read_b64_tr_b16 a[96:97], v11 offset:32768
v_cvt_pk_bf16_f32 v171, v174, v175
v_mfma_f32_16x16x32_bf16 v[28:31], a[104:107], a[32:35], v[28:31]
s_waitcnt lgkmcnt(4)
buffer_store_dwordx4 a[16:19], v16, s[44:47], s74 offen sc1
v_mfma_f32_16x16x32_bf16 v[28:31], a[108:111], a[36:39], v[28:31]
ds_read_b64_tr_b16 a[98:99], v11 offset:33792
v_cvt_pk_bf16_f32 v160, v160, v161
v_mfma_f32_16x16x32_bf16 v[44:47], a[108:111], a[44:47], v[44:47]
ds_read_b64_tr_b16 a[100:101], v11 offset:40960
v_cvt_pk_bf16_f32 v161, v162, v163
v_mfma_f32_16x16x32_bf16 v[44:47], a[104:107], a[40:43], v[44:47]
s_sub_u32 s81, s3, 1
ds_read_b64_tr_b16 a[102:103], v11 offset:41984
v_cvt_pk_bf16_f32 v162, v164, v165
v_mfma_f32_16x16x32_bf16 v[60:63], a[104:107], a[48:51], v[60:63]
s_sub_u32 s67, s3, 2
ds_read_b128 a[4:7], v2 offset:8192
v_cvt_pk_bf16_f32 v163, v166, v167
v_mfma_f32_16x16x32_bf16 v[60:63], a[108:111], a[52:55], v[60:63]
s_mul_i32 s81, s81, s67
ds_read_b128 a[12:15], v3 offset:8192
v_cvt_pk_bf16_f32 v152, v152, v153
v_mfma_f32_16x16x32_bf16 v[76:79], a[108:111], a[60:63], v[76:79]
s_lshl4_add_u32 s81, s81, s31
ds_read_b64 v[224:225], v2 offset:9216
v_cvt_pk_bf16_f32 v153, v154, v155
v_mfma_f32_16x16x32_bf16 v[76:79], a[104:107], a[56:59], v[76:79]
s_lshl2_add_u32 s81, s81, s30
ds_read_b64 v[228:229], v2 offset:9224
v_cvt_pk_bf16_f32 v154, v156, v157
v_mfma_f32_16x16x32_bf16 v[140:143], a[112:115], a[56:59], v[140:143]
s_mul_i32 s81, s81, 3328
ds_read_b64 v[240:241], v3 offset:9216
v_cvt_pk_bf16_f32 v155, v158, v159
v_mfma_f32_16x16x32_bf16 v[140:143], a[116:119], a[60:63], v[140:143]
s_mov_b32 s73, 0
ds_read_b64 v[244:245], v3 offset:9224
v_or_b32 v20, s66, v252
v_mfma_f32_16x16x32_bf16 v[124:127], a[116:119], a[52:55], v[124:127]
s_mov_b32 s72, 0x4000
v_or_b32 v21, s66, v253
v_or_b32 v22, s66, v254
v_mfma_f32_16x16x32_bf16 v[124:127], a[112:115], a[48:51], v[124:127]
s_lshl_b32 s67, s31, 15
v_or_b32 v23, s66, v255
v_mfma_f32_16x16x32_bf16 v[108:111], a[112:115], a[40:43], v[108:111]
s_add_u32 s67, s67, s78
s_mov_b32 s66, 0x3e8293ee
v_mul_f32 v72, s68, v72
v_mfma_f32_16x16x32_bf16 v[108:111], a[116:119], a[44:47], v[108:111]
s_add_u32 s67, s67, 33554432
v_mul_f32 v73, s68, v73
v_mul_f32 v74, s68, v74
v_mfma_f32_16x16x32_bf16 v[92:95], a[116:119], a[36:39], v[92:95]
s_mul_i32 s74, s3, 1310720
v_mul_f32 v75, s68, v75
v_mul_f32 v136, s68, v136
v_mfma_f32_16x16x32_bf16 v[92:95], a[112:115], a[32:35], v[92:95]
s_add_u32 s74, s74, s67
v_mul_f32 v137, s68, v137
v_mul_f32 v138, s68, v138
v_mfma_f32_16x16x32_bf16 v[32:35], a[72:75], a[32:35], v[32:35]
s_mul_i32 s75, s16, 1310720
v_mul_f32 v139, s68, v139
v_cvt_pk_bf16_f32 v72, v72, v73
v_mfma_f32_16x16x32_bf16 v[32:35], a[76:79], a[36:39], v[32:35]
s_add_u32 s75, s75, s67
v_cvt_pk_bf16_f32 v73, v74, v75
v_cvt_pk_bf16_f32 v74, v136, v137
v_mfma_f32_16x16x32_bf16 v[48:51], a[76:79], a[44:47], v[48:51]
s_mul_i32 s67, s31, 24576
v_cvt_pk_bf16_f32 v75, v138, v139
v_mul_f32 v56, s68, v56
v_mfma_f32_16x16x32_bf16 v[48:51], a[72:75], a[40:43], v[48:51]
s_sub_u32 s67, 1052672, s67
v_mul_f32 v57, s68, v57
v_mul_f32 v58, s68, v58
v_mfma_f32_16x16x32_bf16 v[64:67], a[72:75], a[48:51], v[64:67]
s_add_u32 s64, s74, s67
v_mul_f32 v59, s68, v59
v_mul_f32 v120, s68, v120
v_mfma_f32_16x16x32_bf16 v[64:67], a[76:79], a[52:55], v[64:67]
s_add_u32 s65, s75, s67
v_mul_f32 v121, s68, v121
v_mul_f32 v122, s68, v122
v_mfma_f32_16x16x32_bf16 v[80:83], a[76:79], a[60:63], v[80:83]
s_and_b32 s70, s30, 1
v_mul_f32 v123, s68, v123
v_cvt_pk_bf16_f32 v56, v56, v57
v_mfma_f32_16x16x32_bf16 v[80:83], a[72:75], a[56:59], v[80:83]
s_lshr_b32 s67, s30, 1
v_cvt_pk_bf16_f32 v57, v58, v59
v_cvt_pk_bf16_f32 v58, v120, v121
v_mfma_f32_16x16x32_bf16 v[144:147], a[80:83], a[56:59], v[144:147]
s_lshl3_add_u32 s71, s67, s70
v_cvt_pk_bf16_f32 v59, v122, v123
v_mul_f32 v40, s68, v40
v_mfma_f32_16x16x32_bf16 v[144:147], a[84:87], a[60:63], v[144:147]
s_add_u32 s71, s71, 4
v_mul_f32 v41, s68, v41
v_mul_f32 v42, s68, v42
v_mfma_f32_16x16x32_bf16 v[128:131], a[84:87], a[52:55], v[128:131]
s_lshl_b32 s71, s71, 13
v_mul_f32 v43, s68, v43
v_mul_f32 v104, s68, v104
v_mfma_f32_16x16x32_bf16 v[128:131], a[80:83], a[48:51], v[128:131]
s_lshl_b32 s70, s70, 14
v_mul_f32 v105, s68, v105
v_mul_f32 v106, s68, v106
v_mfma_f32_16x16x32_bf16 v[112:115], a[80:83], a[40:43], v[112:115]
s_mul_i32 s67, s67, 24576
v_mul_f32 v107, s68, v107
v_cvt_pk_bf16_f32 v40, v40, v41
v_mfma_f32_16x16x32_bf16 v[112:115], a[84:87], a[44:47], v[112:115]
s_sub_u32 s70, s70, s67
v_cvt_pk_bf16_f32 v41, v42, v43
v_cvt_pk_bf16_f32 v42, v104, v105
v_mfma_f32_16x16x32_bf16 v[96:99], a[84:87], a[36:39], v[96:99]
s_add_u32 s70, s70, 65536
v_cvt_pk_bf16_f32 v43, v106, v107
v_mul_f32 v24, s68, v24
v_mfma_f32_16x16x32_bf16 v[96:99], a[80:83], a[32:35], v[96:99]
s_waitcnt lgkmcnt(0)
v_mul_f32 v25, s68, v25
v_mul_f32 v26, s68, v26
v_mfma_f32_16x16x32_bf16 v[36:39], a[88:91], a[32:35], v[36:39]
v_mul_f32 v27, s68, v27
v_mul_f32 v88, s68, v88
v_mfma_f32_16x16x32_bf16 v[36:39], a[92:95], a[36:39], v[36:39]
v_mul_f32 v89, s68, v89
v_mul_f32 v90, s68, v90
v_mfma_f32_16x16x32_bf16 v[52:55], a[92:95], a[44:47], v[52:55]
v_mul_f32 v91, s68, v91
v_cvt_pk_bf16_f32 v24, v24, v25
v_mfma_f32_16x16x32_bf16 v[52:55], a[88:91], a[40:43], v[52:55]
v_cvt_pk_bf16_f32 v25, v26, v27
v_cvt_pk_bf16_f32 v26, v88, v89
v_mfma_f32_16x16x32_bf16 v[68:71], a[88:91], a[48:51], v[68:71]
v_cvt_pk_bf16_f32 v27, v90, v91
v_mul_f32 v76, s68, v76
v_mfma_f32_16x16x32_bf16 v[68:71], a[92:95], a[52:55], v[68:71]
v_mul_f32 v77, s68, v77
v_mul_f32 v78, s68, v78
v_mfma_f32_16x16x32_bf16 v[84:87], a[92:95], a[60:63], v[84:87]
v_mul_f32 v79, s68, v79
v_mul_f32 v140, s68, v140
v_mfma_f32_16x16x32_bf16 v[84:87], a[88:91], a[56:59], v[84:87]
v_mul_f32 v141, s68, v141
v_mul_f32 v142, s68, v142
v_mfma_f32_16x16x32_bf16 v[148:151], a[96:99], a[56:59], v[148:151]
v_mul_f32 v143, s68, v143
v_cvt_pk_bf16_f32 v76, v76, v77
v_mfma_f32_16x16x32_bf16 v[148:151], a[100:103], a[60:63], v[148:151]
v_cvt_pk_bf16_f32 v77, v78, v79
v_cvt_pk_bf16_f32 v78, v140, v141
v_mfma_f32_16x16x32_bf16 v[132:135], a[100:103], a[52:55], v[132:135]
v_cvt_pk_bf16_f32 v79, v142, v143
v_mul_f32 v60, s68, v60
v_mfma_f32_16x16x32_bf16 v[132:135], a[96:99], a[48:51], v[132:135]
v_mul_f32 v61, s68, v61
v_mul_f32 v62, s68, v62
v_mfma_f32_16x16x32_bf16 v[116:119], a[96:99], a[40:43], v[116:119]
v_mul_f32 v63, s68, v63
v_mul_f32 v124, s68, v124
v_mfma_f32_16x16x32_bf16 v[116:119], a[100:103], a[44:47], v[116:119]
v_mul_f32 v125, s68, v125
v_mul_f32 v126, s68, v126
v_mfma_f32_16x16x32_bf16 v[100:103], a[100:103], a[36:39], v[100:103]
v_mul_f32 v127, s68, v127
v_cvt_pk_bf16_f32 v60, v60, v61
v_mfma_f32_16x16x32_bf16 v[100:103], a[96:99], a[32:35], v[100:103]
v_cvt_pk_bf16_f32 v61, v62, v63
v_cvt_pk_bf16_f32 v62, v124, v125
v_cvt_pk_bf16_f32 v63, v126, v127
buffer_load_dwordx4 v[88:91], v16, s[44:47], s77 offen sc1
v_mfma_f32_16x16x32_bf16 v[196:199], v[192:195], v[160:163], v[248:251]
v_mfma_f32_16x16x32_bf16 v[212:215], v[208:211], v[176:179], v[248:251]
v_mfma_f32_16x16x32_bf16 v[164:167], a[4:7], v[160:163], v[252:255]
v_mfma_f32_16x16x32_bf16 v[180:183], a[12:15], v[176:179], v[252:255]
s_waitcnt vmcnt(24)
s_waitcnt vmcnt(25)
s_waitcnt vmcnt(26)
s_waitcnt vmcnt(27)
v_accvgpr_read_b32 v4, a64
v_accvgpr_read_b32 v5, a65
v_accvgpr_read_b32 v6, a66
v_accvgpr_read_b32 v7, a67
v_accvgpr_read_b32 v8, a68
v_accvgpr_read_b32 v9, a69
v_accvgpr_read_b32 v10, a70
v_accvgpr_read_b32 v11, a71
v_max3_f32 v121, v196, v197, v198
v_max3_f32 v121, v121, v199, v164
v_max3_f32 v121, v121, v165, v166
v_max_f32 v121, v121, v167
v_max3_f32 v123, v212, v213, v214
v_max3_f32 v123, v123, v215, v180
v_max3_f32 v123, v123, v181, v182
v_max_f32 v123, v123, v183
v_mov_b32 v105, v121
v_mov_b32 v107, v123
v_pk_mul_f32 v[28:29], v[28:29], s[68:69]
v_permlane16_swap_b32 v105, v121
v_permlane16_swap_b32 v107, v123
v_max_f32 v121, v121, v105
v_max_f32 v123, v123, v107
v_mov_b32 v105, v121
v_mov_b32 v107, v123
v_pk_mul_f32 v[30:31], v[30:31], s[68:69]
v_permlane32_swap_b32 v105, v121
v_permlane32_swap_b32 v107, v123
v_max_f32 v121, v121, v105
v_max_f32 v123, v123, v107
v_mul_f32 v121, s66, v121
v_mul_f32 v123, s66, v123
v_fma_f32 v164, v164, s66, -v121
v_fma_f32 v165, v165, s66, -v121
v_fma_f32 v166, v166, s66, -v121
v_fma_f32 v167, v167, s66, -v121
v_fma_f32 v196, v196, s66, -v121
v_fma_f32 v197, v197, s66, -v121
v_fma_f32 v198, v198, s66, -v121
v_fma_f32 v199, v199, s66, -v121
v_exp_f32 v164, v164
v_exp_f32 v165, v165
v_exp_f32 v166, v166
v_exp_f32 v167, v167
v_exp_f32 v196, v196
v_exp_f32 v197, v197
v_exp_f32 v198, v198
v_exp_f32 v199, v199
v_cvt_pk_bf16_f32 v164, v164, v165
v_cvt_pk_bf16_f32 v165, v166, v167
v_cvt_pk_bf16_f32 v166, v196, v197
v_cvt_pk_bf16_f32 v167, v198, v199
v_pk_mul_f32 v[92:93], v[92:93], s[68:69]
v_pk_mul_f32 v[94:95], v[94:95], s[68:69]
v_mfma_f32_16x16x32_bf16 v[196:199], a[244:247], v[164:167], 0
v_mfma_f32_16x16x32_bf16 v[160:163], v[224:227], v[164:167], 0
v_mfma_f32_16x16x32_bf16 v[192:195], v[228:231], v[164:167], 0
v_fma_f32 v180, v180, s66, -v123
v_fma_f32 v181, v181, s66, -v123
v_fma_f32 v182, v182, s66, -v123
v_fma_f32 v183, v183, s66, -v123
v_fma_f32 v212, v212, s66, -v123
v_fma_f32 v213, v213, s66, -v123
v_fma_f32 v214, v214, s66, -v123
v_fma_f32 v215, v215, s66, -v123
v_exp_f32 v180, v180
v_exp_f32 v181, v181
v_exp_f32 v182, v182
v_exp_f32 v183, v183
v_exp_f32 v212, v212
v_exp_f32 v213, v213
v_exp_f32 v214, v214
v_exp_f32 v215, v215
v_cvt_pk_bf16_f32 v180, v180, v181
v_cvt_pk_bf16_f32 v181, v182, v183
v_cvt_pk_bf16_f32 v182, v212, v213
v_cvt_pk_bf16_f32 v183, v214, v215
v_cvt_pk_bf16_f32 v28, v28, v29
v_cvt_pk_bf16_f32 v29, v30, v31
v_mfma_f32_16x16x32_bf16 v[212:215], a[244:247], v[180:183], 0
v_mfma_f32_16x16x32_bf16 v[176:179], v[240:243], v[180:183], 0
v_mfma_f32_16x16x32_bf16 v[208:211], v[244:247], v[180:183], 0
v_cvt_pk_bf16_f32 v30, v92, v93
v_cvt_pk_bf16_f32 v31, v94, v95
v_pk_mul_f32 v[44:45], v[44:45], s[68:69]
v_pk_mul_f32 v[46:47], v[46:47], s[68:69]
v_pk_mul_f32 v[108:109], v[108:109], s[68:69]
v_pk_mul_f32 v[110:111], v[110:111], s[68:69]
v_rcp_f32 v121, v196
v_rcp_f32 v123, v212
v_mul_f32 v121, v121, v7
v_mul_f32 v123, v123, v11
v_mul_f32 v160, v160, v121
v_mul_f32 v161, v161, v121
v_mul_f32 v162, v162, v121
v_mul_f32 v163, v163, v121
v_mul_f32 v192, v192, v121
v_mul_f32 v193, v193, v121
v_mul_f32 v194, v194, v121
v_mul_f32 v195, v195, v121
v_cvt_pk_bf16_f32 v160, v160, v161
v_cvt_pk_bf16_f32 v161, v162, v163
v_cvt_pk_bf16_f32 v162, v192, v193
v_cvt_pk_bf16_f32 v163, v194, v195
buffer_store_dwordx4 v[160:163], v16, s[44:47], s64 offen sc1
v_mul_f32 v176, v176, v123
v_mul_f32 v177, v177, v123
v_mul_f32 v178, v178, v123
v_mul_f32 v179, v179, v123
v_mul_f32 v208, v208, v123
v_mul_f32 v209, v209, v123
v_mul_f32 v210, v210, v123
v_mul_f32 v211, v211, v123
v_cvt_pk_bf16_f32 v176, v176, v177
v_cvt_pk_bf16_f32 v177, v178, v179
v_cvt_pk_bf16_f32 v178, v208, v209
v_cvt_pk_bf16_f32 v179, v210, v211
buffer_store_dwordx4 v[176:179], v16, s[44:47], s65 offen sc1
v_cvt_pk_bf16_f32 v44, v44, v45
v_cvt_pk_bf16_f32 v45, v46, v47
v_cvt_pk_bf16_f32 v46, v108, v109
v_cvt_pk_bf16_f32 v47, v110, v111
v_pk_mul_f32 v[32:33], v[32:33], s[68:69]
v_pk_mul_f32 v[34:35], v[34:35], s[68:69]
v_pk_mul_f32 v[96:97], v[96:97], s[68:69]
v_pk_mul_f32 v[98:99], v[98:99], s[68:69]
v_cvt_pk_bf16_f32 v32, v32, v33
v_cvt_pk_bf16_f32 v33, v34, v35
v_cvt_pk_bf16_f32 v34, v96, v97
v_cvt_pk_bf16_f32 v35, v98, v99
v_pk_mul_f32 v[48:49], v[48:49], s[68:69]
v_pk_mul_f32 v[50:51], v[50:51], s[68:69]
v_pk_mul_f32 v[112:113], v[112:113], s[68:69]
v_pk_mul_f32 v[114:115], v[114:115], s[68:69]
v_cvt_pk_bf16_f32 v48, v48, v49
v_cvt_pk_bf16_f32 v49, v50, v51
v_cvt_pk_bf16_f32 v50, v112, v113
v_cvt_pk_bf16_f32 v51, v114, v115
v_pk_mul_f32 v[64:65], v[64:65], s[68:69]
v_pk_mul_f32 v[66:67], v[66:67], s[68:69]
v_pk_mul_f32 v[128:129], v[128:129], s[68:69]
v_pk_mul_f32 v[130:131], v[130:131], s[68:69]
s_waitcnt vmcnt(2)
L_hchk:
v_max3_u32 v1, v88, v89, v90
v_max_u32 v1, v1, v91
v_cmp_eq_u32 vcc, -1, v1
s_cbranch_vccnz L_hretry
L_hgo:
ds_write_b128 v17, v[88:91]
s_sub_u32 s64, s64, 4096
s_sub_u32 s65, s65, 4096
v_cvt_pk_bf16_f32 v64, v64, v65
v_cvt_pk_bf16_f32 v65, v66, v67
v_cvt_pk_bf16_f32 v66, v128, v129
v_cvt_pk_bf16_f32 v67, v130, v131
v_pk_mul_f32 v[80:81], v[80:81], s[68:69]
v_pk_mul_f32 v[82:83], v[82:83], s[68:69]
v_pk_mul_f32 v[144:145], v[144:145], s[68:69]
v_pk_mul_f32 v[146:147], v[146:147], s[68:69]
s_waitcnt lgkmcnt(0)
s_barrier
ds_read_b128 a[0:3], v2 offset:0
ds_read_b128 a[8:11], v3 offset:0
ds_read_b64 v[216:217], v2 offset:1024
ds_read_b64 v[220:221], v2 offset:1032
ds_read_b64 v[232:233], v3 offset:1024
ds_read_b64 v[236:237], v3 offset:1032
v_cvt_pk_bf16_f32 v80, v80, v81
v_cvt_pk_bf16_f32 v81, v82, v83
v_cvt_pk_bf16_f32 v82, v144, v145
v_cvt_pk_bf16_f32 v83, v146, v147
v_pk_mul_f32 v[36:37], v[36:37], s[68:69]
v_pk_mul_f32 v[38:39], v[38:39], s[68:69]
v_pk_mul_f32 v[100:101], v[100:101], s[68:69]
v_pk_mul_f32 v[102:103], v[102:103], s[68:69]
v_cvt_pk_bf16_f32 v36, v36, v37
v_cvt_pk_bf16_f32 v37, v38, v39
v_cvt_pk_bf16_f32 v38, v100, v101
v_cvt_pk_bf16_f32 v39, v102, v103
v_pk_mul_f32 v[52:53], v[52:53], s[68:69]
v_pk_mul_f32 v[54:55], v[54:55], s[68:69]
v_pk_mul_f32 v[116:117], v[116:117], s[68:69]
v_pk_mul_f32 v[118:119], v[118:119], s[68:69]
v_mfma_f32_16x16x32_bf16 v[188:191], v[184:187], v[152:155], v[248:251]
v_mfma_f32_16x16x32_bf16 v[204:207], v[200:203], v[168:171], v[248:251]
s_waitcnt lgkmcnt(5)
v_mfma_f32_16x16x32_bf16 v[156:159], a[0:3], v[152:155], v[20:23]
s_waitcnt lgkmcnt(4)
v_mfma_f32_16x16x32_bf16 v[172:175], a[8:11], v[168:171], v[252:255]
v_cvt_pk_bf16_f32 v52, v52, v53
v_cvt_pk_bf16_f32 v53, v54, v55
v_cvt_pk_bf16_f32 v54, v116, v117
v_cvt_pk_bf16_f32 v55, v118, v119
v_pk_mul_f32 v[68:69], v[68:69], s[68:69]
v_pk_mul_f32 v[70:71], v[70:71], s[68:69]
v_pk_mul_f32 v[132:133], v[132:133], s[68:69]
v_pk_mul_f32 v[134:135], v[134:135], s[68:69]
v_max3_f32 v120, v188, v189, v190
v_max3_f32 v120, v120, v191, v156
v_max3_f32 v120, v120, v157, v158
v_max_f32 v120, v120, v159
v_max3_f32 v122, v204, v205, v206
v_max3_f32 v122, v122, v207, v172
v_max3_f32 v122, v122, v173, v174
v_max_f32 v122, v122, v175
v_mov_b32 v104, v120
v_mov_b32 v106, v122
v_cvt_pk_bf16_f32 v68, v68, v69
v_permlane16_swap_b32 v104, v120
v_permlane16_swap_b32 v106, v122
v_max_f32 v120, v120, v104
v_max_f32 v122, v122, v106
v_mov_b32 v104, v120
v_mov_b32 v106, v122
v_cvt_pk_bf16_f32 v69, v70, v71
v_permlane32_swap_b32 v104, v120
v_permlane32_swap_b32 v106, v122
v_max_f32 v120, v120, v104
v_max_f32 v122, v122, v106
v_mul_f32 v120, s66, v120
v_mul_f32 v122, s66, v122
v_fma_f32 v156, v156, s66, -v120
v_fma_f32 v157, v157, s66, -v120
v_fma_f32 v158, v158, s66, -v120
v_fma_f32 v159, v159, s66, -v120
v_fma_f32 v188, v188, s66, -v120
v_fma_f32 v189, v189, s66, -v120
v_fma_f32 v190, v190, s66, -v120
v_fma_f32 v191, v191, s66, -v120
v_exp_f32 v156, v156
v_exp_f32 v157, v157
v_exp_f32 v158, v158
v_exp_f32 v159, v159
v_exp_f32 v188, v188
v_exp_f32 v189, v189
v_exp_f32 v190, v190
v_exp_f32 v191, v191
v_cvt_pk_bf16_f32 v156, v156, v157
v_cvt_pk_bf16_f32 v157, v158, v159
v_cvt_pk_bf16_f32 v158, v188, v189
v_cvt_pk_bf16_f32 v159, v190, v191
v_cvt_pk_bf16_f32 v70, v132, v133
v_cvt_pk_bf16_f32 v71, v134, v135
v_mfma_f32_16x16x32_bf16 v[188:191], a[244:247], v[156:159], 0
s_waitcnt lgkmcnt(3)
v_mfma_f32_16x16x32_bf16 v[152:155], v[216:219], v[156:159], 0
s_waitcnt lgkmcnt(2)
v_mfma_f32_16x16x32_bf16 v[184:187], v[220:223], v[156:159], 0
v_fma_f32 v172, v172, s66, -v122
v_fma_f32 v173, v173, s66, -v122
v_fma_f32 v174, v174, s66, -v122
v_fma_f32 v175, v175, s66, -v122
v_fma_f32 v204, v204, s66, -v122
v_fma_f32 v205, v205, s66, -v122
v_fma_f32 v206, v206, s66, -v122
v_fma_f32 v207, v207, s66, -v122
v_exp_f32 v172, v172
v_exp_f32 v173, v173
v_exp_f32 v174, v174
v_exp_f32 v175, v175
v_exp_f32 v204, v204
v_exp_f32 v205, v205
v_exp_f32 v206, v206
v_exp_f32 v207, v207
v_cvt_pk_bf16_f32 v172, v172, v173
v_cvt_pk_bf16_f32 v173, v174, v175
v_cvt_pk_bf16_f32 v174, v204, v205
v_cvt_pk_bf16_f32 v175, v206, v207
v_pk_mul_f32 v[84:85], v[84:85], s[68:69]
v_pk_mul_f32 v[86:87], v[86:87], s[68:69]
v_mfma_f32_16x16x32_bf16 v[204:207], a[244:247], v[172:175], 0
s_waitcnt lgkmcnt(1)
v_mfma_f32_16x16x32_bf16 v[168:171], v[232:235], v[172:175], 0
s_waitcnt lgkmcnt(0)
v_mfma_f32_16x16x32_bf16 v[200:203], v[236:239], v[172:175], 0
v_pk_mul_f32 v[148:149], v[148:149], s[68:69]
v_pk_mul_f32 v[150:151], v[150:151], s[68:69]
v_cvt_pk_bf16_f32 v84, v84, v85
v_cvt_pk_bf16_f32 v85, v86, v87
v_cvt_pk_bf16_f32 v86, v148, v149
v_cvt_pk_bf16_f32 v87, v150, v151
v_rcp_f32 v120, v188
v_rcp_f32 v122, v204
v_mul_f32 v120, v120, v5
v_mul_f32 v122, v122, v9
v_mul_f32 v152, v152, v120
v_mul_f32 v153, v153, v120
v_mul_f32 v154, v154, v120
v_mul_f32 v155, v155, v120
v_mul_f32 v184, v184, v120
v_mul_f32 v185, v185, v120
v_mul_f32 v186, v186, v120
v_mul_f32 v187, v187, v120
v_cvt_pk_bf16_f32 v152, v152, v153
v_cvt_pk_bf16_f32 v153, v154, v155
v_cvt_pk_bf16_f32 v154, v184, v185
v_cvt_pk_bf16_f32 v155, v186, v187
buffer_store_dwordx4 v[152:155], v16, s[44:47], s64 offen sc1
v_mul_f32 v168, v168, v122
v_mul_f32 v169, v169, v122
v_mul_f32 v170, v170, v122
v_mul_f32 v171, v171, v122
v_mul_f32 v200, v200, v122
v_mul_f32 v201, v201, v122
v_mul_f32 v202, v202, v122
v_mul_f32 v203, v203, v122
v_cvt_pk_bf16_f32 v168, v168, v169
v_cvt_pk_bf16_f32 v169, v170, v171
v_cvt_pk_bf16_f32 v170, v200, v201
v_cvt_pk_bf16_f32 v171, v202, v203
buffer_store_dwordx4 v[168:171], v16, s[44:47], s65 offen sc1
v_mov_b32 v17, 0xff800000
L_attstart_7:
v_mov_b32 v2, v16
v_add_u32 v3, 0x10000, v16
v_mov_b32 v1, 0
s_waitcnt lgkmcnt(0)
s_barrier
s_cmp_eq_u32 s3, 0
s_cbranch_scc1 L_F1
ds_read_b128 a[144:147], v2 offset:0
ds_read_b128 a[148:151], v2 offset:1024
ds_read_b128 a[152:155], v2 offset:2048
ds_read_b128 a[156:159], v2 offset:3072
ds_read_b128 a[160:163], v2 offset:4096
ds_read_b128 a[164:167], v2 offset:5120
ds_read_b128 a[168:171], v2 offset:6144
ds_read_b128 a[172:175], v2 offset:7168
s_mov_b32 m0, s71
s_nop 0
buffer_load_dwordx4 v16, s[32:35], s70 offen offset:0 sc1 lds
buffer_load_dwordx4 v16, s[32:35], s70 offen offset:1024 sc1 lds
s_waitcnt lgkmcnt(7)
v_mfma_f32_16x16x32_bf16 v[88:91], a[144:147], v[24:27], 0
s_waitcnt lgkmcnt(6)
ds_read_b128 a[176:179], v2 offset:8192
ds_read_b128 a[180:183], v2 offset:9216
v_mfma_f32_16x16x32_bf16 v[88:91], a[148:151], v[28:31], v[88:91]
s_waitcnt lgkmcnt(7)
ds_read_b128 a[184:187], v2 offset:10240
ds_read_b128 a[188:191], v2 offset:11264
v_mfma_f32_16x16x32_bf16 v[88:91], a[152:155], v[32:35], v[88:91]
s_waitcnt lgkmcnt(8)
buffer_load_dwordx4 v16, s[32:35], s70 offen offset:2048 sc1 lds
v_mfma_f32_16x16x32_bf16 v[88:91], a[156:159], v[36:39], v[88:91]
ds_read_b128 a[192:195], v2 offset:12288
ds_read_b128 a[196:199], v2 offset:13312
v_mfma_f32_16x16x32_bf16 v[104:107], a[156:159], v[52:55], 0
v_mfma_f32_16x16x32_bf16 v[104:107], a[152:155], v[48:51], v[104:107]
ds_read_b128 a[200:203], v2 offset:14336
v_mfma_f32_16x16x32_bf16 v[104:107], a[148:151], v[44:47], v[104:107]
v_mfma_f32_16x16x32_bf16 v[104:107], a[144:147], v[40:43], v[104:107]
ds_read_b128 a[204:207], v2 offset:15360
v_mfma_f32_16x16x32_bf16 v[120:123], a[144:147], v[56:59], 0
v_mfma_f32_16x16x32_bf16 v[120:123], a[148:151], v[60:63], v[120:123]
buffer_load_dwordx4 v16, s[32:35], s70 offen offset:3072 sc1 lds
v_mfma_f32_16x16x32_bf16 v[120:123], a[152:155], v[64:67], v[120:123]
v_mfma_f32_16x16x32_bf16 v[120:123], a[156:159], v[68:71], v[120:123]
v_mfma_f32_16x16x32_bf16 v[136:139], a[156:159], v[84:87], 0
v_mfma_f32_16x16x32_bf16 v[136:139], a[152:155], v[80:83], v[136:139]
v_mfma_f32_16x16x32_bf16 v[136:139], a[148:151], v[76:79], v[136:139]
v_mfma_f32_16x16x32_bf16 v[136:139], a[144:147], v[72:75], v[136:139]
s_waitcnt lgkmcnt(0)
s_nop 1
v_max3_f32 v20, v88, v89, v90
v_max_f32 v20, v20, v91
v_max3_f32 v21, v104, v105, v106
v_max_f32 v21, v21, v107
v_max3_f32 v22, v120, v121, v122
v_max_f32 v22, v22, v123
v_max3_f32 v23, v136, v137, v138
v_max_f32 v23, v23, v139
v_mov_b32 v248, v20
v_mov_b32 v249, v21
v_mov_b32 v250, v22
v_mov_b32 v251, v23
v_permlane16_swap_b32 v248, v20
v_permlane16_swap_b32 v249, v21
v_permlane16_swap_b32 v250, v22
v_permlane16_swap_b32 v251, v23
v_max_f32 v20, v20, v248
v_max_f32 v21, v21, v249
v_max_f32 v22, v22, v250
v_max_f32 v23, v23, v251
v_mov_b32 v248, v20
v_mov_b32 v249, v21
v_mov_b32 v250, v22
v_mov_b32 v251, v23
v_permlane32_swap_b32 v248, v20
v_permlane32_swap_b32 v249, v21
v_permlane32_swap_b32 v250, v22
v_permlane32_swap_b32 v251, v23
v_max_f32 v20, v20, v248
v_max_f32 v21, v21, v249
v_max_f32 v22, v22, v250
v_max_f32 v23, v23, v251
s_cmp_eq_u32 s73, 0
s_cselect_b64 vcc, 0, -1
v_cndmask_b32 v20, v20, v252, vcc
v_cndmask_b32 v21, v21, v253, vcc
v_cndmask_b32 v22, v22, v254, vcc
v_cndmask_b32 v23, v23, v255, vcc
v_sub_f32 v228, 0, v23
v_sub_f32 v229, 0, v23
v_sub_f32 v230, 0, v23
v_sub_f32 v231, 0, v23
v_sub_f32 v224, 0, v22
v_sub_f32 v225, 0, v22
v_sub_f32 v226, 0, v22
v_sub_f32 v227, 0, v22
v_sub_f32 v220, 0, v21
v_sub_f32 v221, 0, v21
v_sub_f32 v222, 0, v21
v_sub_f32 v223, 0, v21
v_sub_f32 v216, 0, v20
v_sub_f32 v217, 0, v20
v_sub_f32 v218, 0, v20
v_sub_f32 v219, 0, v20
v_mfma_f32_16x16x32_bf16 v[140:143], a[160:163], v[72:75], v[228:231]
s_add_u32 m0, s71, 4096
v_add_f32 v88, v88, v216
v_add_f32 v89, v89, v216
v_mfma_f32_16x16x32_bf16 v[140:143], a[164:167], v[76:79], v[140:143]
v_add_f32 v90, v90, v216
v_add_f32 v91, v91, v216
v_exp_f32 v88, v88
v_mfma_f32_16x16x32_bf16 v[140:143], a[168:171], v[80:83], v[140:143]
s_add_u32 s64, s70, 4096
v_exp_f32 v89, v89
v_mfma_f32_16x16x32_bf16 v[140:143], a[172:175], v[84:87], v[140:143]
buffer_load_dwordx4 v16, s[32:35], s64 offen offset:0 sc1 lds
v_mfma_f32_16x16x32_bf16 v[124:127], a[172:175], v[68:71], v[224:227]
v_exp_f32 v90, v90
v_mfma_f32_16x16x32_bf16 v[124:127], a[168:171], v[64:67], v[124:127]
v_exp_f32 v91, v91
v_mfma_f32_16x16x32_bf16 v[124:127], a[164:167], v[60:63], v[124:127]
v_add_f32 v104, v104, v220
v_add_f32 v105, v105, v220
v_add_f32 v106, v106, v220
v_add_f32 v107, v107, v220
v_exp_f32 v104, v104
v_mfma_f32_16x16x32_bf16 v[124:127], a[160:163], v[56:59], v[124:127]
v_exp_f32 v105, v105
v_mfma_f32_16x16x32_bf16 v[108:111], a[160:163], v[40:43], v[220:223]
v_exp_f32 v106, v106
v_mfma_f32_16x16x32_bf16 v[108:111], a[164:167], v[44:47], v[108:111]
buffer_load_dwordx4 v16, s[32:35], s64 offen offset:1024 sc1 lds
v_mfma_f32_16x16x32_bf16 v[108:111], a[168:171], v[48:51], v[108:111]
v_cvt_pk_bf16_f32 v152, v88, v89
v_add_f32 v120, v120, v224
v_mfma_f32_16x16x32_bf16 v[108:111], a[172:175], v[52:55], v[108:111]
v_exp_f32 v107, v107
v_mfma_f32_16x16x32_bf16 v[92:95], a[172:175], v[36:39], v[216:219]
v_add_f32 v121, v121, v224
v_add_f32 v122, v122, v224
v_add_f32 v123, v123, v224
v_exp_f32 v120, v120
v_mfma_f32_16x16x32_bf16 v[92:95], a[168:171], v[32:35], v[92:95]
v_cvt_pk_bf16_f32 v153, v90, v91
v_exp_f32 v121, v121
v_mfma_f32_16x16x32_bf16 v[92:95], a[164:167], v[28:31], v[92:95]
v_exp_f32 v122, v122
v_mfma_f32_16x16x32_bf16 v[92:95], a[160:163], v[24:27], v[92:95]
v_exp_f32 v123, v123
v_mfma_f32_16x16x32_bf16 v[96:99], a[176:179], v[24:27], v[216:219]
v_cvt_pk_bf16_f32 v160, v104, v105
v_add_f32 v136, v136, v228
v_mfma_f32_16x16x32_bf16 v[96:99], a[180:183], v[28:31], v[96:99]
buffer_load_dwordx4 v16, s[32:35], s64 offen offset:2048 sc1 lds
v_add_f32 v137, v137, v228
v_add_f32 v138, v138, v228
v_add_f32 v139, v139, v228
v_exp_f32 v136, v136
v_mfma_f32_16x16x32_bf16 v[96:99], a[184:187], v[32:35], v[96:99]
v_exp_f32 v137, v137
v_mfma_f32_16x16x32_bf16 v[96:99], a[188:191], v[36:39], v[96:99]
v_cvt_pk_bf16_f32 v161, v106, v107
v_cvt_pk_bf16_f32 v184, v120, v121
v_mfma_f32_16x16x32_bf16 v[112:115], a[188:191], v[52:55], v[220:223]
v_exp_f32 v138, v138
v_mfma_f32_16x16x32_bf16 v[112:115], a[184:187], v[48:51], v[112:115]
v_exp_f32 v139, v139
v_mfma_f32_16x16x32_bf16 v[112:115], a[180:183], v[44:47], v[112:115]
v_exp_f32 v140, v140
v_mfma_f32_16x16x32_bf16 v[112:115], a[176:179], v[40:43], v[112:115]
v_exp_f32 v141, v141
v_mfma_f32_16x16x32_bf16 v[128:131], a[176:179], v[56:59], v[224:227]
buffer_load_dwordx4 v16, s[32:35], s64 offen offset:3072 sc1 lds
v_cvt_pk_bf16_f32 v185, v122, v123
v_mfma_f32_16x16x32_bf16 v[128:131], a[180:183], v[60:63], v[128:131]
v_exp_f32 v142, v142
v_mfma_f32_16x16x32_bf16 v[128:131], a[184:187], v[64:67], v[128:131]
v_exp_f32 v143, v143
v_mfma_f32_16x16x32_bf16 v[128:131], a[188:191], v[68:71], v[128:131]
v_cvt_pk_bf16_f32 v192, v136, v137
v_cvt_pk_bf16_f32 v193, v138, v139
v_mfma_f32_16x16x32_bf16 v[144:147], a[188:191], v[84:87], v[228:231]
v_exp_f32 v124, v124
v_mfma_f32_16x16x32_bf16 v[144:147], a[184:187], v[80:83], v[144:147]
v_exp_f32 v125, v125
v_mfma_f32_16x16x32_bf16 v[144:147], a[180:183], v[76:79], v[144:147]
s_waitcnt vmcnt(8)
s_barrier
v_mfma_f32_16x16x32_bf16 v[144:147], a[176:179], v[72:75], v[144:147]
v_exp_f32 v126, v126
v_mfma_f32_16x16x32_bf16 v[148:151], a[192:195], v[72:75], v[228:231]
v_cvt_pk_bf16_f32 v194, v140, v141
v_cvt_pk_bf16_f32 v195, v142, v143
v_mfma_f32_16x16x32_bf16 v[148:151], a[196:199], v[76:79], v[148:151]
v_exp_f32 v127, v127
v_mfma_f32_16x16x32_bf16 v[148:151], a[200:203], v[80:83], v[148:151]
s_xor_b32 s71, s71, 16384
v_exp_f32 v108, v108
v_mfma_f32_16x16x32_bf16 v[148:151], a[204:207], v[84:87], v[148:151]
s_add_u32 s70, s70, 32768
v_exp_f32 v109, v109
v_mfma_f32_16x16x32_bf16 v[132:135], a[204:207], v[68:71], v[224:227]
s_mov_b32 m0, s71
v_exp_f32 v110, v110
v_mfma_f32_16x16x32_bf16 v[132:135], a[200:203], v[64:67], v[132:135]
buffer_load_dwordx4 v16, s[32:35], s70 offen offset:0 sc1 lds
v_mfma_f32_16x16x32_bf16 v[132:135], a[196:199], v[60:63], v[132:135]
v_cvt_pk_bf16_f32 v186, v124, v125
v_exp_f32 v111, v111
v_mfma_f32_16x16x32_bf16 v[132:135], a[192:195], v[56:59], v[132:135]
v_exp_f32 v92, v92
v_mfma_f32_16x16x32_bf16 v[116:119], a[192:195], v[40:43], v[220:223]
v_exp_f32 v93, v93
v_mfma_f32_16x16x32_bf16 v[116:119], a[196:199], v[44:47], v[116:119]
ds_read_b128 a[144:147], v2 offset:16384
v_cvt_pk_bf16_f32 v187, v126, v127
v_mfma_f32_16x16x32_bf16 v[116:119], a[200:203], v[48:51], v[116:119]
v_exp_f32 v94, v94
v_mfma_f32_16x16x32_bf16 v[116:119], a[204:207], v[52:55], v[116:119]
ds_read_b128 a[148:151], v2 offset:17408
v_cvt_pk_bf16_f32 v162, v108, v109
v_mfma_f32_16x16x32_bf16 v[100:103], a[204:207], v[36:39], v[216:219]
ds_read_b128 a[152:155], v2 offset:18432
buffer_load_dwordx4 v16, s[32:35], s70 offen offset:1024 sc1 lds
v_exp_f32 v95, v95
v_mfma_f32_16x16x32_bf16 v[100:103], a[200:203], v[32:35], v[100:103]
ds_read_b128 a[156:159], v2 offset:19456
v_exp_f32 v96, v96
v_mfma_f32_16x16x32_bf16 v[100:103], a[196:199], v[28:31], v[100:103]
v_cvt_pk_bf16_f32 v163, v110, v111
v_exp_f32 v97, v97
v_mfma_f32_16x16x32_bf16 v[100:103], a[192:195], v[24:27], v[100:103]
s_waitcnt lgkmcnt(3)
ds_read_b128 a[160:163], v2 offset:20480
ds_read_b128 a[164:167], v2 offset:21504
ds_read_b128 a[168:171], v2 offset:22528
ds_read_b128 a[172:175], v2 offset:23552
v_mfma_f32_16x16x32_bf16 v[88:91], a[144:147], v[24:27], v[216:219]
s_waitcnt lgkmcnt(6)
v_exp_f32 v98, v98
v_mfma_f32_16x16x32_bf16 v[88:91], a[148:151], v[28:31], v[88:91]
s_waitcnt lgkmcnt(5)
v_cvt_pk_bf16_f32 v154, v92, v93
v_exp_f32 v99, v99
v_mfma_f32_16x16x32_bf16 v[88:91], a[152:155], v[32:35], v[88:91]
s_waitcnt lgkmcnt(4)
v_exp_f32 v112, v112
v_mfma_f32_16x16x32_bf16 v[88:91], a[156:159], v[36:39], v[88:91]
v_exp_f32 v113, v113
v_mfma_f32_16x16x32_bf16 v[104:107], a[156:159], v[52:55], v[220:223]
v_cvt_pk_bf16_f32 v155, v94, v95
v_cvt_pk_bf16_f32 v156, v96, v97
v_mfma_f32_16x16x32_bf16 v[104:107], a[152:155], v[48:51], v[104:107]
buffer_load_dwordx4 v16, s[32:35], s70 offen offset:2048 sc1 lds
v_exp_f32 v114, v114
v_mfma_f32_16x16x32_bf16 v[104:107], a[148:151], v[44:47], v[104:107]
v_exp_f32 v115, v115
v_mfma_f32_16x16x32_bf16 v[104:107], a[144:147], v[40:43], v[104:107]
v_exp_f32 v128, v128
v_mfma_f32_16x16x32_bf16 v[120:123], a[144:147], v[56:59], v[224:227]
v_exp_f32 v129, v129
v_mfma_f32_16x16x32_bf16 v[120:123], a[148:151], v[60:63], v[120:123]
v_cvt_pk_bf16_f32 v157, v98, v99
v_cvt_pk_bf16_f32 v164, v112, v113
v_mfma_f32_16x16x32_bf16 v[120:123], a[152:155], v[64:67], v[120:123]
v_exp_f32 v130, v130
v_mfma_f32_16x16x32_bf16 v[120:123], a[156:159], v[68:71], v[120:123]
v_exp_f32 v131, v131
v_mfma_f32_16x16x32_bf16 v[136:139], a[156:159], v[84:87], v[228:231]
v_exp_f32 v144, v144
v_mfma_f32_16x16x32_bf16 v[136:139], a[152:155], v[80:83], v[136:139]
v_exp_f32 v145, v145
v_mfma_f32_16x16x32_bf16 v[136:139], a[148:151], v[76:79], v[136:139]
v_exp_f32 v146, v146
v_mfma_f32_16x16x32_bf16 v[136:139], a[144:147], v[72:75], v[136:139]
s_waitcnt lgkmcnt(0)
v_cvt_pk_bf16_f32 v165, v114, v115
v_cvt_pk_bf16_f32 v188, v128, v129
v_mfma_f32_16x16x32_bf16 v[140:143], a[160:163], v[72:75], v[228:231]
v_exp_f32 v147, v147
v_mfma_f32_16x16x32_bf16 v[140:143], a[164:167], v[76:79], v[140:143]
v_exp_f32 v148, v148
v_mfma_f32_16x16x32_bf16 v[140:143], a[168:171], v[80:83], v[140:143]
v_exp_f32 v149, v149
v_mfma_f32_16x16x32_bf16 v[140:143], a[172:175], v[84:87], v[140:143]
buffer_load_dwordx4 v16, s[32:35], s70 offen offset:3072 sc1 lds
v_mfma_f32_16x16x32_bf16 v[124:127], a[172:175], v[68:71], v[224:227]
v_cvt_pk_bf16_f32 v189, v130, v131
v_cvt_pk_bf16_f32 v196, v144, v145
v_mfma_f32_16x16x32_bf16 v[124:127], a[168:171], v[64:67], v[124:127]
v_exp_f32 v150, v150
v_mfma_f32_16x16x32_bf16 v[124:127], a[164:167], v[60:63], v[124:127]
v_exp_f32 v151, v151
v_mfma_f32_16x16x32_bf16 v[124:127], a[160:163], v[56:59], v[124:127]
v_exp_f32 v132, v132
v_mfma_f32_16x16x32_bf16 v[108:111], a[160:163], v[40:43], v[220:223]
ds_read_b128 a[176:179], v2 offset:24576
v_cvt_pk_bf16_f32 v197, v146, v147
v_mfma_f32_16x16x32_bf16 v[108:111], a[164:167], v[44:47], v[108:111]
ds_read_b128 a[180:183], v2 offset:25600
v_cvt_pk_bf16_f32 v198, v148, v149
v_mfma_f32_16x16x32_bf16 v[108:111], a[168:171], v[48:51], v[108:111]
ds_read_b128 a[184:187], v2 offset:26624
v_exp_f32 v133, v133
v_mfma_f32_16x16x32_bf16 v[108:111], a[172:175], v[52:55], v[108:111]
ds_read_b128 a[188:191], v2 offset:27648
v_exp_f32 v134, v134
v_mfma_f32_16x16x32_bf16 v[92:95], a[172:175], v[36:39], v[216:219]
v_exp_f32 v135, v135
v_mfma_f32_16x16x32_bf16 v[92:95], a[168:171], v[32:35], v[92:95]
v_exp_f32 v116, v116
v_mfma_f32_16x16x32_bf16 v[92:95], a[164:167], v[28:31], v[92:95]
v_exp_f32 v117, v117
v_mfma_f32_16x16x32_bf16 v[92:95], a[160:163], v[24:27], v[92:95]
s_waitcnt lgkmcnt(2)
v_cvt_pk_bf16_f32 v199, v150, v151
v_cvt_pk_bf16_f32 v190, v132, v133
v_mfma_f32_16x16x32_bf16 v[96:99], a[176:179], v[24:27], v[216:219]
v_exp_f32 v118, v118
v_mfma_f32_16x16x32_bf16 v[96:99], a[180:183], v[28:31], v[96:99]
s_waitcnt lgkmcnt(0)
v_exp_f32 v119, v119
v_mfma_f32_16x16x32_bf16 v[96:99], a[184:187], v[32:35], v[96:99]
s_add_u32 m0, s71, 4096
v_exp_f32 v100, v100
v_mfma_f32_16x16x32_bf16 v[96:99], a[188:191], v[36:39], v[96:99]
s_add_u32 s64, s70, 4096
v_exp_f32 v101, v101
v_mfma_f32_16x16x32_bf16 v[112:115], a[188:191], v[52:55], v[220:223]
buffer_load_dwordx4 v16, s[32:35], s64 offen offset:0 sc1 lds
v_mfma_f32_16x16x32_bf16 v[112:115], a[184:187], v[48:51], v[112:115]
v_cvt_pk_bf16_f32 v191, v134, v135
v_cvt_pk_bf16_f32 v166, v116, v117
v_mfma_f32_16x16x32_bf16 v[112:115], a[180:183], v[44:47], v[112:115]
v_exp_f32 v102, v102
v_mfma_f32_16x16x32_bf16 v[112:115], a[176:179], v[40:43], v[112:115]
v_exp_f32 v103, v103
v_mfma_f32_16x16x32_bf16 v[128:131], a[176:179], v[56:59], v[224:227]
s_lshl_b32 s66, s30, 30
ds_read_b128 a[192:195], v2 offset:28672
v_cvt_pk_bf16_f32 v167, v118, v119
v_mfma_f32_16x16x32_bf16 v[128:131], a[180:183], v[60:63], v[128:131]
ds_read_b128 a[196:199], v2 offset:29696
v_exp_f32 v88, v88
v_mfma_f32_16x16x32_bf16 v[128:131], a[184:187], v[64:67], v[128:131]
ds_read_b128 a[200:203], v2 offset:30720
v_exp_f32 v89, v89
v_mfma_f32_16x16x32_bf16 v[128:131], a[188:191], v[68:71], v[128:131]
ds_read_b128 a[204:207], v2 offset:31744
v_cvt_pk_bf16_f32 v158, v100, v101
v_mfma_f32_16x16x32_bf16 v[144:147], a[188:191], v[84:87], v[228:231]
v_exp_f32 v90, v90
v_mfma_f32_16x16x32_bf16 v[144:147], a[184:187], v[80:83], v[144:147]
v_exp_f32 v91, v91
v_mfma_f32_16x16x32_bf16 v[144:147], a[180:183], v[76:79], v[144:147]
v_exp_f32 v104, v104
v_mfma_f32_16x16x32_bf16 v[144:147], a[176:179], v[72:75], v[144:147]
s_waitcnt lgkmcnt(2)
v_exp_f32 v105, v105
v_mfma_f32_16x16x32_bf16 v[148:151], a[192:195], v[72:75], v[228:231]
v_cvt_pk_bf16_f32 v159, v102, v103
v_cvt_pk_bf16_f32 v168, v88, v89
v_mfma_f32_16x16x32_bf16 v[148:151], a[196:199], v[76:79], v[148:151]
s_waitcnt lgkmcnt(0)
v_exp_f32 v106, v106
v_mfma_f32_16x16x32_bf16 v[148:151], a[200:203], v[80:83], v[148:151]
v_exp_f32 v107, v107
v_mfma_f32_16x16x32_bf16 v[148:151], a[204:207], v[84:87], v[148:151]
v_exp_f32 v120, v120
v_mfma_f32_16x16x32_bf16 v[132:135], a[204:207], v[68:71], v[224:227]
buffer_load_dwordx4 v16, s[32:35], s64 offen offset:1024 sc1 lds
v_mfma_f32_16x16x32_bf16 v[132:135], a[200:203], v[64:67], v[132:135]
v_cvt_pk_bf16_f32 v169, v90, v91
v_cvt_pk_bf16_f32 v176, v104, v105
v_mfma_f32_16x16x32_bf16 v[132:135], a[196:199], v[60:63], v[132:135]
v_exp_f32 v121, v121
v_mfma_f32_16x16x32_bf16 v[132:135], a[192:195], v[56:59], v[132:135]
v_exp_f32 v122, v122
v_mfma_f32_16x16x32_bf16 v[116:119], a[192:195], v[40:43], v[220:223]
v_exp_f32 v123, v123
v_mfma_f32_16x16x32_bf16 v[116:119], a[196:199], v[44:47], v[116:119]
v_exp_f32 v136, v136
v_mfma_f32_16x16x32_bf16 v[116:119], a[200:203], v[48:51], v[116:119]
v_exp_f32 v137, v137
v_mfma_f32_16x16x32_bf16 v[116:119], a[204:207], v[52:55], v[116:119]
v_cvt_pk_bf16_f32 v177, v106, v107
v_cvt_pk_bf16_f32 v200, v120, v121
v_mfma_f32_16x16x32_bf16 v[100:103], a[204:207], v[36:39], v[216:219]
v_exp_f32 v138, v138
v_mfma_f32_16x16x32_bf16 v[100:103], a[200:203], v[32:35], v[100:103]
v_exp_f32 v139, v139
v_mfma_f32_16x16x32_bf16 v[100:103], a[196:199], v[28:31], v[100:103]
v_exp_f32 v140, v140
v_mfma_f32_16x16x32_bf16 v[100:103], a[192:195], v[24:27], v[100:103]
ds_read_b128 a[144:147], v3 offset:16384
v_cvt_pk_bf16_f32 v201, v122, v123
v_mfma_f32_16x16x32_bf16 a[128:131], a[244:247], v[152:155], 0
ds_read_b128 a[148:151], v3 offset:24576
v_cvt_pk_bf16_f32 v208, v136, v137
v_mfma_f32_16x16x32_bf16 a[128:131], a[244:247], v[156:159], a[128:131]
v_exp_f32 v141, v141
v_mfma_f32_16x16x32_bf16 a[132:135], a[244:247], v[160:163], 0
v_exp_f32 v142, v142
v_mfma_f32_16x16x32_bf16 a[132:135], a[244:247], v[164:167], a[132:135]
v_exp_f32 v143, v143
v_mfma_f32_16x16x32_bf16 a[136:139], a[244:247], v[184:187], 0
buffer_load_dwordx4 v16, s[32:35], s64 offen offset:2048 sc1 lds
v_mfma_f32_16x16x32_bf16 a[136:139], a[244:247], v[188:191], a[136:139]
v_exp_f32 v124, v124
v_mfma_f32_16x16x32_bf16 a[140:143], a[244:247], v[192:195], 0
v_exp_f32 v125, v125
v_mfma_f32_16x16x32_bf16 a[140:143], a[244:247], v[196:199], a[140:143]
s_waitcnt lgkmcnt(0)
ds_read_b128 a[152:155], v3 offset:17408
v_cvt_pk_bf16_f32 v209, v138, v139
v_mfma_f32_16x16x32_bf16 a[0:3], a[144:147], v[152:155], 0
v_exp_f32 v126, v126
v_mfma_f32_16x16x32_bf16 a[0:3], a[148:151], v[156:159], a[0:3]
ds_read_b128 a[156:159], v3 offset:25600
v_cvt_pk_bf16_f32 v210, v140, v141
v_mfma_f32_16x16x32_bf16 a[32:35], a[148:151], v[164:167], 0
v_exp_f32 v127, v127
v_mfma_f32_16x16x32_bf16 a[32:35], a[144:147], v[160:163], a[32:35]
v_exp_f32 v108, v108
v_mfma_f32_16x16x32_bf16 a[64:67], a[144:147], v[184:187], 0
v_exp_f32 v109, v109
v_mfma_f32_16x16x32_bf16 a[64:67], a[148:151], v[188:191], a[64:67]
v_cvt_pk_bf16_f32 v211, v142, v143
v_cvt_pk_bf16_f32 v202, v124, v125
v_mfma_f32_16x16x32_bf16 a[96:99], a[148:151], v[196:199], 0
v_exp_f32 v110, v110
v_mfma_f32_16x16x32_bf16 a[96:99], a[144:147], v[192:195], a[96:99]
s_waitcnt lgkmcnt(0)
ds_read_b128 a[160:163], v3 offset:18432
v_cvt_pk_bf16_f32 v203, v126, v127
v_mfma_f32_16x16x32_bf16 a[100:103], a[152:155], v[192:195], 0
v_exp_f32 v111, v111
v_mfma_f32_16x16x32_bf16 a[100:103], a[156:159], v[196:199], a[100:103]
ds_read_b128 a[164:167], v3 offset:26624
v_cvt_pk_bf16_f32 v178, v108, v109
v_mfma_f32_16x16x32_bf16 a[68:71], a[156:159], v[188:191], 0
v_exp_f32 v92, v92
v_mfma_f32_16x16x32_bf16 a[68:71], a[152:155], v[184:187], a[68:71]
v_exp_f32 v93, v93
v_mfma_f32_16x16x32_bf16 a[36:39], a[152:155], v[160:163], 0
v_exp_f32 v94, v94
v_mfma_f32_16x16x32_bf16 a[36:39], a[156:159], v[164:167], a[36:39]
buffer_load_dwordx4 v16, s[32:35], s64 offen offset:3072 sc1 lds
v_mfma_f32_16x16x32_bf16 a[4:7], a[156:159], v[156:159], 0
v_exp_f32 v95, v95
v_mfma_f32_16x16x32_bf16 a[4:7], a[152:155], v[152:155], a[4:7]
s_waitcnt lgkmcnt(0)
v_exp_f32 v96, v96
v_mfma_f32_16x16x32_bf16 a[8:11], a[160:163], v[152:155], 0
ds_read_b128 a[168:171], v3 offset:19456
v_cvt_pk_bf16_f32 v179, v110, v111
v_mfma_f32_16x16x32_bf16 a[8:11], a[164:167], v[156:159], a[8:11]
ds_read_b128 a[172:175], v3 offset:27648
v_exp_f32 v97, v97
v_mfma_f32_16x16x32_bf16 a[40:43], a[164:167], v[164:167], 0
v_exp_f32 v98, v98
v_mfma_f32_16x16x32_bf16 a[40:43], a[160:163], v[160:163], a[40:43]
v_exp_f32 v99, v99
v_mfma_f32_16x16x32_bf16 a[72:75], a[160:163], v[184:187], 0
v_cvt_pk_bf16_f32 v170, v92, v93
v_cvt_pk_bf16_f32 v171, v94, v95
v_mfma_f32_16x16x32_bf16 a[72:75], a[164:167], v[188:191], a[72:75]
v_exp_f32 v112, v112
v_mfma_f32_16x16x32_bf16 a[104:107], a[164:167], v[196:199], 0
v_exp_f32 v113, v113
v_mfma_f32_16x16x32_bf16 a[104:107], a[160:163], v[192:195], a[104:107]
s_waitcnt lgkmcnt(0)
ds_read_b128 a[176:179], v3 offset:20480
v_cvt_pk_bf16_f32 v172, v96, v97
v_mfma_f32_16x16x32_bf16 a[108:111], a[168:171], v[192:195], 0
v_exp_f32 v114, v114
v_mfma_f32_16x16x32_bf16 a[108:111], a[172:175], v[196:199], a[108:111]
ds_read_b128 a[180:183], v3 offset:28672
v_xor_b32 v2, 0x8000, v2
v_mfma_f32_16x16x32_bf16 a[76:79], a[172:175], v[188:191], 0
v_exp_f32 v115, v115
v_mfma_f32_16x16x32_bf16 a[76:79], a[168:171], v[184:187], a[76:79]
ds_read_b128 a[184:187], v3 offset:21504
ds_read_b128 a[188:191], v3 offset:29696
ds_read_b128 a[192:195], v3 offset:22528
ds_read_b128 a[196:199], v3 offset:30720
ds_read_b128 a[200:203], v3 offset:23552
ds_read_b128 a[204:207], v3 offset:31744
v_mfma_f32_16x16x32_bf16 a[44:47], a[168:171], v[160:163], 0
s_waitcnt vmcnt(8)
s_barrier
v_cvt_pk_bf16_f32 v173, v98, v99
v_exp_f32 v128, v128
v_mfma_f32_16x16x32_bf16 a[44:47], a[172:175], v[164:167], a[44:47]
v_exp_f32 v129, v129
v_mfma_f32_16x16x32_bf16 a[12:15], a[172:175], v[156:159], 0
v_exp_f32 v130, v130
v_mfma_f32_16x16x32_bf16 a[12:15], a[168:171], v[152:155], a[12:15]
s_waitcnt lgkmcnt(6)
v_cvt_pk_bf16_f32 v180, v112, v113
v_cvt_pk_bf16_f32 v181, v114, v115
v_mfma_f32_16x16x32_bf16 a[16:19], a[176:179], v[152:155], 0
s_xor_b32 s71, s71, 49152
v_exp_f32 v131, v131
v_mfma_f32_16x16x32_bf16 a[16:19], a[180:183], v[156:159], a[16:19]
s_add_u32 s70, s70, 32768
v_exp_f32 v144, v144
v_mfma_f32_16x16x32_bf16 a[48:51], a[180:183], v[164:167], 0
s_mov_b32 m0, s71
v_exp_f32 v145, v145
v_mfma_f32_16x16x32_bf16 a[48:51], a[176:179], v[160:163], a[48:51]
buffer_load_dwordx4 v16, s[32:35], s70 offen offset:0 sc1 lds
v_mfma_f32_16x16x32_bf16 a[80:83], a[176:179], v[184:187], 0
v_exp_f32 v146, v146
v_mfma_f32_16x16x32_bf16 a[80:83], a[180:183], v[188:191], a[80:83]
v_cvt_pk_bf16_f32 v204, v128, v129
v_cvt_pk_bf16_f32 v205, v130, v131
v_mfma_f32_16x16x32_bf16 a[112:115], a[180:183], v[196:199], 0
v_exp_f32 v147, v147
v_mfma_f32_16x16x32_bf16 a[112:115], a[176:179], v[192:195], a[112:115]
s_waitcnt lgkmcnt(0)
v_exp_f32 v148, v148
v_mfma_f32_16x16x32_bf16 a[116:119], a[184:187], v[192:195], 0
v_exp_f32 v149, v149
v_mfma_f32_16x16x32_bf16 a[116:119], a[188:191], v[196:199], a[116:119]
v_exp_f32 v150, v150
v_mfma_f32_16x16x32_bf16 a[84:87], a[188:191], v[188:191], 0
v_exp_f32 v151, v151
v_mfma_f32_16x16x32_bf16 a[84:87], a[184:187], v[184:187], a[84:87]
v_cvt_pk_bf16_f32 v212, v144, v145
v_cvt_pk_bf16_f32 v213, v146, v147
v_mfma_f32_16x16x32_bf16 a[52:55], a[184:187], v[160:163], 0
v_exp_f32 v132, v132
v_mfma_f32_16x16x32_bf16 a[52:55], a[188:191], v[164:167], a[52:55]
v_exp_f32 v133, v133
v_mfma_f32_16x16x32_bf16 a[20:23], a[188:191], v[156:159], 0
v_exp_f32 v134, v134
v_mfma_f32_16x16x32_bf16 a[20:23], a[184:187], v[152:155], a[20:23]
v_exp_f32 v135, v135
v_mfma_f32_16x16x32_bf16 a[24:27], a[192:195], v[152:155], 0
v_exp_f32 v116, v116
v_mfma_f32_16x16x32_bf16 a[24:27], a[196:199], v[156:159], a[24:27]
v_cvt_pk_bf16_f32 v214, v148, v149
v_cvt_pk_bf16_f32 v215, v150, v151
v_mfma_f32_16x16x32_bf16 a[56:59], a[196:199], v[164:167], 0
buffer_load_dwordx4 v16, s[32:35], s70 offen offset:1024 sc1 lds
v_mfma_f32_16x16x32_bf16 a[56:59], a[192:195], v[160:163], a[56:59]
s_add_u32 s17, s78, L_D-L_pc+0
ds_read_b128 a[144:147], v2 offset:0
v_lshl_add_u32 v19, v0, 24, s66
v_mfma_f32_16x16x32_bf16 a[88:91], a[192:195], v[184:187], 0
s_lshr_b32 s67, s31, 4
v_exp_f32 v117, v117
v_mfma_f32_16x16x32_bf16 a[88:91], a[196:199], v[188:191], a[88:91]
s_lshl1_add_u32 s67, s3, s67
v_exp_f32 v118, v118
v_mfma_f32_16x16x32_bf16 a[120:123], a[196:199], v[196:199], 0
s_lshl_b32 s79, s67, 8
v_exp_f32 v119, v119
v_mfma_f32_16x16x32_bf16 a[120:123], a[192:195], v[192:195], a[120:123]
s_add_u32 s79, s79, 8192
v_cvt_pk_bf16_f32 v206, v132, v133
v_cvt_pk_bf16_f32 v207, v134, v135
v_mfma_f32_16x16x32_bf16 a[124:127], a[200:203], v[192:195], 0
s_lshl_b32 s67, s73, 16
buffer_load_dword a252, v16, s[88:91], s17 offen
v_mfma_f32_16x16x32_bf16 a[124:127], a[204:207], v[196:199], a[124:127]
s_xor_b32 s68, s80, 256
v_exp_f32 v100, v100
v_mfma_f32_16x16x32_bf16 a[92:95], a[204:207], v[188:191], 0
s_add_u32 s68, s68, s67
v_exp_f32 v101, v101
v_mfma_f32_16x16x32_bf16 a[92:95], a[200:203], v[184:187], a[92:95]
s_add_u32 s67, s67, s79
s_add_u32 s17, s78, L_D-L_pc+4096
ds_read_b128 a[148:151], v2 offset:1024
v_cvt_pk_bf16_f32 v182, v116, v117
v_mfma_f32_16x16x32_bf16 a[60:63], a[200:203], v[160:163], 0
buffer_load_dword a252, v16, s[88:91], s17 offen
ds_read_b128 a[152:155], v2 offset:2048
v_exp_f32 v102, v102
v_mfma_f32_16x16x32_bf16 a[60:63], a[204:207], v[164:167], a[60:63]
s_add_u32 s17, s78, L_D-L_pc+8192
ds_read_b128 a[156:159], v2 offset:3072
v_cvt_pk_bf16_f32 v183, v118, v119
v_mfma_f32_16x16x32_bf16 a[28:31], a[204:207], v[156:159], 0
s_mov_b64 exec, 1
buffer_atomic_add a251, v19, s[52:55], s67 offen offset:0 sc1
buffer_atomic_add a251, v19, s[52:55], s68 offen offset:0 sc1
s_mov_b64 exec, -1
v_exp_f32 v103, v103
v_mfma_f32_16x16x32_bf16 a[28:31], a[200:203], v[152:155], a[28:31]
ds_read_b128 a[160:163], v2 offset:4096
buffer_load_dword a252, v16, s[88:91], s17 offen
ds_read_b128 a[164:167], v2 offset:5120
ds_read_b128 a[168:171], v2 offset:6144
ds_read_b128 a[172:175], v2 offset:7168
v_mul_u32_u24 v19, 52, v0
v_cvt_pk_bf16_f32 v174, v100, v101
v_cvt_pk_bf16_f32 v175, v102, v103
v_xor_b32 v3, 0x8000, v3
s_sub_u32 s72, s3, 1
s_cmp_eq_u32 s72, 0
s_cbranch_scc1 L_DD
.p2align 3
L_D:
s_waitcnt lgkmcnt(7)
v_mfma_f32_16x16x32_bf16 v[88:91], a[144:147], v[24:27], v[216:219]
s_waitcnt lgkmcnt(6)
ds_read_b128 a[176:179], v2 offset:8192
v_mfma_f32_16x16x32_bf16 v[88:91], a[148:151], v[28:31], v[88:91]
s_waitcnt lgkmcnt(6)
ds_read_b128 a[180:183], v2 offset:9216
v_mfma_f32_16x16x32_bf16 v[88:91], a[152:155], v[32:35], v[88:91]
s_waitcnt lgkmcnt(6)
buffer_load_dwordx4 v16, s[32:35], s70 offen offset:2048 sc1 lds
v_mfma_f32_16x16x32_bf16 v[88:91], a[156:159], v[36:39], v[88:91]
ds_read_b128 a[184:187], v2 offset:10240
v_mfma_f32_16x16x32_bf16 v[104:107], a[156:159], v[52:55], v[220:223]
v_mfma_f32_16x16x32_bf16 v[104:107], a[152:155], v[48:51], v[104:107]
buffer_load_dword a252, v19, s[40:43], s81 offen
v_mfma_f32_16x16x32_bf16 v[104:107], a[148:151], v[44:47], v[104:107]
ds_read_b128 a[188:191], v2 offset:11264
v_mfma_f32_16x16x32_bf16 v[104:107], a[144:147], v[40:43], v[104:107]
v_mfma_f32_16x16x32_bf16 v[120:123], a[144:147], v[56:59], v[224:227]
v_mfma_f32_16x16x32_bf16 v[120:123], a[148:151], v[60:63], v[120:123]
v_mfma_f32_16x16x32_bf16 v[120:123], a[152:155], v[64:67], v[120:123]
v_exp_f32 v88, v88
v_mfma_f32_16x16x32_bf16 v[120:123], a[156:159], v[68:71], v[120:123]
v_exp_f32 v89, v89
v_mfma_f32_16x16x32_bf16 v[136:139], a[156:159], v[84:87], v[228:231]
v_exp_f32 v90, v90
v_mfma_f32_16x16x32_bf16 v[136:139], a[152:155], v[80:83], v[136:139]
v_exp_f32 v91, v91
v_mfma_f32_16x16x32_bf16 v[136:139], a[148:151], v[76:79], v[136:139]
v_exp_f32 v104, v104
v_mfma_f32_16x16x32_bf16 v[136:139], a[144:147], v[72:75], v[136:139]
s_waitcnt lgkmcnt(0)
s_add_u32 s81, s81, 425984
v_exp_f32 v105, v105
v_mfma_f32_16x16x32_bf16 v[140:143], a[160:163], v[72:75], v[228:231]
v_exp_f32 v106, v106
v_mfma_f32_16x16x32_bf16 v[140:143], a[164:167], v[76:79], v[140:143]
v_exp_f32 v107, v107
v_mfma_f32_16x16x32_bf16 v[140:143], a[168:171], v[80:83], v[140:143]
buffer_load_dwordx4 v16, s[32:35], s70 offen offset:3072 sc1 lds
v_mfma_f32_16x16x32_bf16 v[140:143], a[172:175], v[84:87], v[140:143]
v_cvt_pk_bf16_f32 v152, v88, v89
v_cvt_pk_bf16_f32 v153, v90, v91
v_mfma_f32_16x16x32_bf16 v[124:127], a[172:175], v[68:71], v[224:227]
v_exp_f32 v120, v120
v_mfma_f32_16x16x32_bf16 v[124:127], a[168:171], v[64:67], v[124:127]
v_exp_f32 v121, v121
v_mfma_f32_16x16x32_bf16 v[124:127], a[164:167], v[60:63], v[124:127]
v_exp_f32 v122, v122
v_mfma_f32_16x16x32_bf16 v[124:127], a[160:163], v[56:59], v[124:127]
v_exp_f32 v123, v123
v_mfma_f32_16x16x32_bf16 v[108:111], a[160:163], v[40:43], v[220:223]
v_exp_f32 v136, v136
v_mfma_f32_16x16x32_bf16 v[108:111], a[164:167], v[44:47], v[108:111]
v_exp_f32 v137, v137
v_mfma_f32_16x16x32_bf16 v[108:111], a[168:171], v[48:51], v[108:111]
v_exp_f32 v138, v138
v_mfma_f32_16x16x32_bf16 v[108:111], a[172:175], v[52:55], v[108:111]
v_cvt_pk_bf16_f32 v160, v104, v105
v_cvt_pk_bf16_f32 v161, v106, v107
v_mfma_f32_16x16x32_bf16 v[92:95], a[172:175], v[36:39], v[216:219]
v_exp_f32 v139, v139
v_mfma_f32_16x16x32_bf16 v[92:95], a[168:171], v[32:35], v[92:95]
ds_read_b128 a[192:195], v2 offset:12288
v_cvt_pk_bf16_f32 v184, v120, v121
v_mfma_f32_16x16x32_bf16 v[92:95], a[164:167], v[28:31], v[92:95]
ds_read_b128 a[196:199], v2 offset:13312
v_cvt_pk_bf16_f32 v185, v122, v123
v_mfma_f32_16x16x32_bf16 v[92:95], a[160:163], v[24:27], v[92:95]
v_exp_f32 v140, v140
v_mfma_f32_16x16x32_bf16 v[96:99], a[176:179], v[24:27], v[216:219]
s_add_u32 m0, s71, 4096
ds_read_b128 a[200:203], v2 offset:14336
v_cvt_pk_bf16_f32 v192, v136, v137
v_mfma_f32_16x16x32_bf16 v[96:99], a[180:183], v[28:31], v[96:99]
s_add_u32 s64, s70, 4096
ds_read_b128 a[204:207], v2 offset:15360
v_cvt_pk_bf16_f32 v193, v138, v139
v_mfma_f32_16x16x32_bf16 v[96:99], a[184:187], v[32:35], v[96:99]
buffer_load_dwordx4 v16, s[32:35], s64 offen offset:0 sc1 lds
v_mfma_f32_16x16x32_bf16 v[96:99], a[188:191], v[36:39], v[96:99]
v_exp_f32 v141, v141
v_mfma_f32_16x16x32_bf16 v[112:115], a[188:191], v[52:55], v[220:223]
v_exp_f32 v142, v142
v_mfma_f32_16x16x32_bf16 v[112:115], a[184:187], v[48:51], v[112:115]
v_exp_f32 v143, v143
v_mfma_f32_16x16x32_bf16 v[112:115], a[180:183], v[44:47], v[112:115]
v_exp_f32 v124, v124
v_mfma_f32_16x16x32_bf16 v[112:115], a[176:179], v[40:43], v[112:115]
v_exp_f32 v125, v125
v_mfma_f32_16x16x32_bf16 v[128:131], a[176:179], v[56:59], v[224:227]
v_exp_f32 v126, v126
v_mfma_f32_16x16x32_bf16 v[128:131], a[180:183], v[60:63], v[128:131]
v_exp_f32 v127, v127
v_mfma_f32_16x16x32_bf16 v[128:131], a[184:187], v[64:67], v[128:131]
v_exp_f32 v108, v108
v_mfma_f32_16x16x32_bf16 v[128:131], a[188:191], v[68:71], v[128:131]
v_exp_f32 v109, v109
v_mfma_f32_16x16x32_bf16 v[144:147], a[188:191], v[84:87], v[228:231]
v_exp_f32 v110, v110
v_mfma_f32_16x16x32_bf16 v[144:147], a[184:187], v[80:83], v[144:147]
v_exp_f32 v111, v111
v_mfma_f32_16x16x32_bf16 v[144:147], a[180:183], v[76:79], v[144:147]
ds_read_b128 a[144:147], v3 offset:0
v_cvt_pk_bf16_f32 v194, v140, v141
v_mfma_f32_16x16x32_bf16 v[144:147], a[176:179], v[72:75], v[144:147]
s_waitcnt lgkmcnt(1)
ds_read_b128 a[148:151], v3 offset:8192
v_cvt_pk_bf16_f32 v195, v142, v143
v_mfma_f32_16x16x32_bf16 v[148:151], a[192:195], v[72:75], v[228:231]
v_exp_f32 v92, v92
v_mfma_f32_16x16x32_bf16 v[148:151], a[196:199], v[76:79], v[148:151]
v_exp_f32 v93, v93
v_mfma_f32_16x16x32_bf16 v[148:151], a[200:203], v[80:83], v[148:151]
buffer_load_dwordx4 v16, s[32:35], s64 offen offset:1024 sc1 lds
v_mfma_f32_16x16x32_bf16 v[148:151], a[204:207], v[84:87], v[148:151]
v_exp_f32 v94, v94
v_mfma_f32_16x16x32_bf16 v[132:135], a[204:207], v[68:71], v[224:227]
v_exp_f32 v95, v95
v_mfma_f32_16x16x32_bf16 v[132:135], a[200:203], v[64:67], v[132:135]
ds_read_b128 a[152:155], v3 offset:1024
v_cvt_pk_bf16_f32 v186, v124, v125
v_mfma_f32_16x16x32_bf16 v[132:135], a[196:199], v[60:63], v[132:135]
v_exp_f32 v96, v96
v_mfma_f32_16x16x32_bf16 v[132:135], a[192:195], v[56:59], v[132:135]
ds_read_b128 a[156:159], v3 offset:9216
v_cvt_pk_bf16_f32 v187, v126, v127
v_mfma_f32_16x16x32_bf16 v[116:119], a[192:195], v[40:43], v[220:223]
v_exp_f32 v97, v97
v_mfma_f32_16x16x32_bf16 v[116:119], a[196:199], v[44:47], v[116:119]
v_exp_f32 v98, v98
v_mfma_f32_16x16x32_bf16 v[116:119], a[200:203], v[48:51], v[116:119]
v_exp_f32 v99, v99
v_mfma_f32_16x16x32_bf16 v[116:119], a[204:207], v[52:55], v[116:119]
ds_read_b128 a[160:163], v3 offset:2048
v_cvt_pk_bf16_f32 v162, v108, v109
v_mfma_f32_16x16x32_bf16 v[100:103], a[204:207], v[36:39], v[216:219]
v_exp_f32 v112, v112
v_mfma_f32_16x16x32_bf16 v[100:103], a[200:203], v[32:35], v[100:103]
ds_read_b128 a[164:167], v3 offset:10240
v_cvt_pk_bf16_f32 v163, v110, v111
v_mfma_f32_16x16x32_bf16 v[100:103], a[196:199], v[28:31], v[100:103]
v_exp_f32 v113, v113
v_mfma_f32_16x16x32_bf16 v[100:103], a[192:195], v[24:27], v[100:103]
v_exp_f32 v114, v114
v_mfma_f32_16x16x32_bf16 a[128:131], a[244:247], v[168:171], a[128:131]
v_exp_f32 v115, v115
v_mfma_f32_16x16x32_bf16 a[128:131], a[244:247], v[172:175], a[128:131]
v_exp_f32 v128, v128
v_mfma_f32_16x16x32_bf16 a[132:135], a[244:247], v[176:179], a[132:135]
buffer_load_dwordx4 v16, s[32:35], s64 offen offset:2048 sc1 lds
v_mfma_f32_16x16x32_bf16 a[132:135], a[244:247], v[180:183], a[132:135]
ds_read_b128 a[168:171], v3 offset:3072
v_cvt_pk_bf16_f32 v154, v92, v93
v_mfma_f32_16x16x32_bf16 a[136:139], a[244:247], v[200:203], a[136:139]
ds_read_b128 a[172:175], v3 offset:11264
v_cvt_pk_bf16_f32 v155, v94, v95
v_mfma_f32_16x16x32_bf16 a[136:139], a[244:247], v[204:207], a[136:139]
v_exp_f32 v129, v129
v_mfma_f32_16x16x32_bf16 a[140:143], a[244:247], v[208:211], a[140:143]
v_exp_f32 v130, v130
v_mfma_f32_16x16x32_bf16 a[140:143], a[244:247], v[212:215], a[140:143]
s_waitcnt lgkmcnt(2)
v_exp_f32 v131, v131
v_mfma_f32_16x16x32_bf16 a[0:3], a[144:147], v[168:171], a[0:3]
v_exp_f32 v144, v144
v_mfma_f32_16x16x32_bf16 a[0:3], a[148:151], v[172:175], a[0:3]
ds_read_b128 a[176:179], v3 offset:4096
v_cvt_pk_bf16_f32 v156, v96, v97
v_mfma_f32_16x16x32_bf16 a[32:35], a[148:151], v[180:183], a[32:35]
ds_read_b128 a[180:183], v3 offset:12288
v_cvt_pk_bf16_f32 v157, v98, v99
v_mfma_f32_16x16x32_bf16 a[32:35], a[144:147], v[176:179], a[32:35]
v_exp_f32 v145, v145
v_mfma_f32_16x16x32_bf16 a[64:67], a[144:147], v[200:203], a[64:67]
ds_read_b128 a[184:187], v3 offset:5120
v_cvt_pk_bf16_f32 v164, v112, v113
v_mfma_f32_16x16x32_bf16 a[64:67], a[148:151], v[204:207], a[64:67]
ds_read_b128 a[188:191], v3 offset:13312
v_cvt_pk_bf16_f32 v165, v114, v115
v_mfma_f32_16x16x32_bf16 a[96:99], a[148:151], v[212:215], a[96:99]
ds_read_b128 a[192:195], v3 offset:6144
v_cvt_pk_bf16_f32 v188, v128, v129
v_mfma_f32_16x16x32_bf16 a[96:99], a[144:147], v[208:211], a[96:99]
v_exp_f32 v146, v146
v_mfma_f32_16x16x32_bf16 a[100:103], a[152:155], v[208:211], a[100:103]
v_exp_f32 v147, v147
v_mfma_f32_16x16x32_bf16 a[100:103], a[156:159], v[212:215], a[100:103]
ds_read_b128 a[196:199], v3 offset:14336
v_cvt_pk_bf16_f32 v189, v130, v131
v_mfma_f32_16x16x32_bf16 a[68:71], a[156:159], v[204:207], a[68:71]
buffer_load_dwordx4 v16, s[32:35], s64 offen offset:3072 sc1 lds
v_mfma_f32_16x16x32_bf16 a[68:71], a[152:155], v[200:203], a[68:71]
v_exp_f32 v148, v148
v_mfma_f32_16x16x32_bf16 a[36:39], a[152:155], v[176:179], a[36:39]
v_exp_f32 v149, v149
v_mfma_f32_16x16x32_bf16 a[36:39], a[156:159], v[180:183], a[36:39]
ds_read_b128 a[200:203], v3 offset:7168
v_cvt_pk_bf16_f32 v196, v144, v145
v_mfma_f32_16x16x32_bf16 a[4:7], a[156:159], v[172:175], a[4:7]
v_exp_f32 v150, v150
v_mfma_f32_16x16x32_bf16 a[4:7], a[152:155], v[168:171], a[4:7]
v_exp_f32 v151, v151
v_mfma_f32_16x16x32_bf16 a[8:11], a[160:163], v[168:171], a[8:11]
v_exp_f32 v132, v132
v_mfma_f32_16x16x32_bf16 a[8:11], a[164:167], v[172:175], a[8:11]
ds_read_b128 a[204:207], v3 offset:15360
v_cvt_pk_bf16_f32 v197, v146, v147
v_mfma_f32_16x16x32_bf16 a[40:43], a[164:167], v[180:183], a[40:43]
v_exp_f32 v133, v133
v_mfma_f32_16x16x32_bf16 a[40:43], a[160:163], v[176:179], a[40:43]
v_exp_f32 v134, v134
v_mfma_f32_16x16x32_bf16 a[72:75], a[160:163], v[200:203], a[72:75]
v_exp_f32 v135, v135
v_mfma_f32_16x16x32_bf16 a[72:75], a[164:167], v[204:207], a[72:75]
v_exp_f32 v116, v116
v_mfma_f32_16x16x32_bf16 a[104:107], a[164:167], v[212:215], a[104:107]
v_exp_f32 v117, v117
v_mfma_f32_16x16x32_bf16 a[104:107], a[160:163], v[208:211], a[104:107]
s_waitcnt lgkmcnt(0)
v_exp_f32 v118, v118
v_mfma_f32_16x16x32_bf16 a[108:111], a[168:171], v[208:211], a[108:111]
v_exp_f32 v119, v119
v_mfma_f32_16x16x32_bf16 a[108:111], a[172:175], v[212:215], a[108:111]
v_exp_f32 v100, v100
v_mfma_f32_16x16x32_bf16 a[76:79], a[172:175], v[204:207], a[76:79]
v_exp_f32 v101, v101
v_mfma_f32_16x16x32_bf16 a[76:79], a[168:171], v[200:203], a[76:79]
v_exp_f32 v102, v102
v_mfma_f32_16x16x32_bf16 a[44:47], a[168:171], v[176:179], a[44:47]
s_waitcnt vmcnt(9)
s_barrier
v_mfma_f32_16x16x32_bf16 a[44:47], a[172:175], v[180:183], a[44:47]
s_xor_b32 s71, s71, 16384
ds_read_b128 a[144:147], v2 offset:16384
v_cvt_pk_bf16_f32 v198, v148, v149
v_mfma_f32_16x16x32_bf16 a[12:15], a[172:175], v[172:175], a[12:15]
s_add_u32 s70, s70, 32768
ds_read_b128 a[148:151], v2 offset:17408
v_cvt_pk_bf16_f32 v199, v150, v151
v_mfma_f32_16x16x32_bf16 a[12:15], a[168:171], v[168:171], a[12:15]
s_mov_b32 m0, s71
ds_read_b128 a[152:155], v2 offset:18432
v_cvt_pk_bf16_f32 v190, v132, v133
v_mfma_f32_16x16x32_bf16 a[16:19], a[176:179], v[168:171], a[16:19]
buffer_load_dwordx4 v16, s[32:35], s70 offen offset:0 sc1 lds
v_mfma_f32_16x16x32_bf16 a[16:19], a[180:183], v[172:175], a[16:19]
ds_read_b128 a[156:159], v2 offset:19456
v_cvt_pk_bf16_f32 v191, v134, v135
v_mfma_f32_16x16x32_bf16 a[48:51], a[180:183], v[180:183], a[48:51]
v_exp_f32 v103, v103
v_mfma_f32_16x16x32_bf16 a[48:51], a[176:179], v[176:179], a[48:51]
ds_read_b128 a[160:163], v2 offset:20480
v_cvt_pk_bf16_f32 v166, v116, v117
v_mfma_f32_16x16x32_bf16 a[80:83], a[176:179], v[200:203], a[80:83]
ds_read_b128 a[164:167], v2 offset:21504
v_cvt_pk_bf16_f32 v167, v118, v119
v_mfma_f32_16x16x32_bf16 a[80:83], a[180:183], v[204:207], a[80:83]
ds_read_b128 a[168:171], v2 offset:22528
v_cvt_pk_bf16_f32 v158, v100, v101
v_mfma_f32_16x16x32_bf16 a[112:115], a[180:183], v[212:215], a[112:115]
ds_read_b128 a[172:175], v2 offset:23552
v_cvt_pk_bf16_f32 v159, v102, v103
v_mfma_f32_16x16x32_bf16 a[112:115], a[176:179], v[208:211], a[112:115]
v_mfma_f32_16x16x32_bf16 a[116:119], a[184:187], v[208:211], a[116:119]
v_mfma_f32_16x16x32_bf16 a[116:119], a[188:191], v[212:215], a[116:119]
v_mfma_f32_16x16x32_bf16 a[84:87], a[188:191], v[204:207], a[84:87]
v_mfma_f32_16x16x32_bf16 a[84:87], a[184:187], v[200:203], a[84:87]
v_mfma_f32_16x16x32_bf16 a[52:55], a[184:187], v[176:179], a[52:55]
v_mfma_f32_16x16x32_bf16 a[52:55], a[188:191], v[180:183], a[52:55]
v_mfma_f32_16x16x32_bf16 a[20:23], a[188:191], v[172:175], a[20:23]
v_mfma_f32_16x16x32_bf16 a[20:23], a[184:187], v[168:171], a[20:23]
v_mfma_f32_16x16x32_bf16 a[24:27], a[192:195], v[168:171], a[24:27]
buffer_load_dwordx4 v16, s[32:35], s70 offen offset:1024 sc1 lds
v_mfma_f32_16x16x32_bf16 a[24:27], a[196:199], v[172:175], a[24:27]
v_mfma_f32_16x16x32_bf16 a[56:59], a[196:199], v[180:183], a[56:59]
v_mfma_f32_16x16x32_bf16 a[56:59], a[192:195], v[176:179], a[56:59]
v_mfma_f32_16x16x32_bf16 a[88:91], a[192:195], v[200:203], a[88:91]
v_mfma_f32_16x16x32_bf16 a[88:91], a[196:199], v[204:207], a[88:91]
v_mfma_f32_16x16x32_bf16 a[120:123], a[196:199], v[212:215], a[120:123]
v_mfma_f32_16x16x32_bf16 a[120:123], a[192:195], v[208:211], a[120:123]
v_mfma_f32_16x16x32_bf16 a[124:127], a[200:203], v[208:211], a[124:127]
v_mfma_f32_16x16x32_bf16 a[124:127], a[204:207], v[212:215], a[124:127]
v_mfma_f32_16x16x32_bf16 a[92:95], a[204:207], v[204:207], a[92:95]
v_mfma_f32_16x16x32_bf16 a[92:95], a[200:203], v[200:203], a[92:95]
v_mfma_f32_16x16x32_bf16 a[60:63], a[200:203], v[176:179], a[60:63]
v_mfma_f32_16x16x32_bf16 a[60:63], a[204:207], v[180:183], a[60:63]
v_mfma_f32_16x16x32_bf16 a[28:31], a[204:207], v[172:175], a[28:31]
v_mfma_f32_16x16x32_bf16 a[28:31], a[200:203], v[168:171], a[28:31]
s_waitcnt lgkmcnt(0)
v_mfma_f32_16x16x32_bf16 v[88:91], a[144:147], v[24:27], v[216:219]
ds_read_b128 a[176:179], v2 offset:24576
v_mfma_f32_16x16x32_bf16 v[88:91], a[148:151], v[28:31], v[88:91]
ds_read_b128 a[180:183], v2 offset:25600
v_mfma_f32_16x16x32_bf16 v[88:91], a[152:155], v[32:35], v[88:91]
buffer_load_dwordx4 v16, s[32:35], s70 offen offset:2048 sc1 lds
v_mfma_f32_16x16x32_bf16 v[88:91], a[156:159], v[36:39], v[88:91]
ds_read_b128 a[184:187], v2 offset:26624
v_mfma_f32_16x16x32_bf16 v[104:107], a[156:159], v[52:55], v[220:223]
v_mfma_f32_16x16x32_bf16 v[104:107], a[152:155], v[48:51], v[104:107]
v_mfma_f32_16x16x32_bf16 v[104:107], a[148:151], v[44:47], v[104:107]
ds_read_b128 a[188:191], v2 offset:27648
v_mfma_f32_16x16x32_bf16 v[104:107], a[144:147], v[40:43], v[104:107]
v_mfma_f32_16x16x32_bf16 v[120:123], a[144:147], v[56:59], v[224:227]
v_mfma_f32_16x16x32_bf16 v[120:123], a[148:151], v[60:63], v[120:123]
v_mfma_f32_16x16x32_bf16 v[120:123], a[152:155], v[64:67], v[120:123]
v_exp_f32 v88, v88
v_mfma_f32_16x16x32_bf16 v[120:123], a[156:159], v[68:71], v[120:123]
v_exp_f32 v89, v89
v_mfma_f32_16x16x32_bf16 v[136:139], a[156:159], v[84:87], v[228:231]
v_exp_f32 v90, v90
v_mfma_f32_16x16x32_bf16 v[136:139], a[152:155], v[80:83], v[136:139]
v_exp_f32 v91, v91
v_mfma_f32_16x16x32_bf16 v[136:139], a[148:151], v[76:79], v[136:139]
v_exp_f32 v104, v104
v_mfma_f32_16x16x32_bf16 v[136:139], a[144:147], v[72:75], v[136:139]
v_exp_f32 v105, v105
v_mfma_f32_16x16x32_bf16 v[140:143], a[160:163], v[72:75], v[228:231]
v_exp_f32 v106, v106
v_mfma_f32_16x16x32_bf16 v[140:143], a[164:167], v[76:79], v[140:143]
v_exp_f32 v107, v107
v_mfma_f32_16x16x32_bf16 v[140:143], a[168:171], v[80:83], v[140:143]
buffer_load_dwordx4 v16, s[32:35], s70 offen offset:3072 sc1 lds
v_mfma_f32_16x16x32_bf16 v[140:143], a[172:175], v[84:87], v[140:143]
v_cvt_pk_bf16_f32 v168, v88, v89
v_cvt_pk_bf16_f32 v169, v90, v91
v_mfma_f32_16x16x32_bf16 v[124:127], a[172:175], v[68:71], v[224:227]
v_exp_f32 v120, v120
v_mfma_f32_16x16x32_bf16 v[124:127], a[168:171], v[64:67], v[124:127]
v_exp_f32 v121, v121
v_mfma_f32_16x16x32_bf16 v[124:127], a[164:167], v[60:63], v[124:127]
v_exp_f32 v122, v122
v_mfma_f32_16x16x32_bf16 v[124:127], a[160:163], v[56:59], v[124:127]
v_exp_f32 v123, v123
v_mfma_f32_16x16x32_bf16 v[108:111], a[160:163], v[40:43], v[220:223]
v_exp_f32 v136, v136
v_mfma_f32_16x16x32_bf16 v[108:111], a[164:167], v[44:47], v[108:111]
v_exp_f32 v137, v137
v_mfma_f32_16x16x32_bf16 v[108:111], a[168:171], v[48:51], v[108:111]
v_exp_f32 v138, v138
v_mfma_f32_16x16x32_bf16 v[108:111], a[172:175], v[52:55], v[108:111]
v_cvt_pk_bf16_f32 v176, v104, v105
v_cvt_pk_bf16_f32 v177, v106, v107
v_mfma_f32_16x16x32_bf16 v[92:95], a[172:175], v[36:39], v[216:219]
v_exp_f32 v139, v139
v_mfma_f32_16x16x32_bf16 v[92:95], a[168:171], v[32:35], v[92:95]
ds_read_b128 a[192:195], v2 offset:28672
v_cvt_pk_bf16_f32 v200, v120, v121
v_mfma_f32_16x16x32_bf16 v[92:95], a[164:167], v[28:31], v[92:95]
ds_read_b128 a[196:199], v2 offset:29696
v_cvt_pk_bf16_f32 v201, v122, v123
v_mfma_f32_16x16x32_bf16 v[92:95], a[160:163], v[24:27], v[92:95]
s_waitcnt lgkmcnt(2)
v_exp_f32 v140, v140
v_mfma_f32_16x16x32_bf16 v[96:99], a[176:179], v[24:27], v[216:219]
s_add_u32 m0, s71, 4096
ds_read_b128 a[200:203], v2 offset:30720
v_cvt_pk_bf16_f32 v208, v136, v137
v_mfma_f32_16x16x32_bf16 v[96:99], a[180:183], v[28:31], v[96:99]
s_add_u32 s64, s70, 4096
ds_read_b128 a[204:207], v2 offset:31744
v_cvt_pk_bf16_f32 v209, v138, v139
v_mfma_f32_16x16x32_bf16 v[96:99], a[184:187], v[32:35], v[96:99]
buffer_load_dwordx4 v16, s[32:35], s64 offen offset:0 sc1 lds
v_mfma_f32_16x16x32_bf16 v[96:99], a[188:191], v[36:39], v[96:99]
v_exp_f32 v141, v141
v_mfma_f32_16x16x32_bf16 v[112:115], a[188:191], v[52:55], v[220:223]
v_exp_f32 v142, v142
v_mfma_f32_16x16x32_bf16 v[112:115], a[184:187], v[48:51], v[112:115]
v_exp_f32 v143, v143
v_mfma_f32_16x16x32_bf16 v[112:115], a[180:183], v[44:47], v[112:115]
v_exp_f32 v124, v124
v_mfma_f32_16x16x32_bf16 v[112:115], a[176:179], v[40:43], v[112:115]
v_exp_f32 v125, v125
v_mfma_f32_16x16x32_bf16 v[128:131], a[176:179], v[56:59], v[224:227]
v_exp_f32 v126, v126
v_mfma_f32_16x16x32_bf16 v[128:131], a[180:183], v[60:63], v[128:131]
v_exp_f32 v127, v127
v_mfma_f32_16x16x32_bf16 v[128:131], a[184:187], v[64:67], v[128:131]
v_exp_f32 v108, v108
v_mfma_f32_16x16x32_bf16 v[128:131], a[188:191], v[68:71], v[128:131]
v_exp_f32 v109, v109
v_mfma_f32_16x16x32_bf16 v[144:147], a[188:191], v[84:87], v[228:231]
v_exp_f32 v110, v110
v_mfma_f32_16x16x32_bf16 v[144:147], a[184:187], v[80:83], v[144:147]
v_exp_f32 v111, v111
v_mfma_f32_16x16x32_bf16 v[144:147], a[180:183], v[76:79], v[144:147]
ds_read_b128 a[144:147], v3 offset:16384
v_cvt_pk_bf16_f32 v210, v140, v141
v_mfma_f32_16x16x32_bf16 v[144:147], a[176:179], v[72:75], v[144:147]
s_waitcnt lgkmcnt(1)
ds_read_b128 a[148:151], v3 offset:24576
v_cvt_pk_bf16_f32 v211, v142, v143
v_mfma_f32_16x16x32_bf16 v[148:151], a[192:195], v[72:75], v[228:231]
v_exp_f32 v92, v92
v_mfma_f32_16x16x32_bf16 v[148:151], a[196:199], v[76:79], v[148:151]
v_exp_f32 v93, v93
v_mfma_f32_16x16x32_bf16 v[148:151], a[200:203], v[80:83], v[148:151]
buffer_load_dwordx4 v16, s[32:35], s64 offen offset:1024 sc1 lds
v_mfma_f32_16x16x32_bf16 v[148:151], a[204:207], v[84:87], v[148:151]
v_exp_f32 v94, v94
v_mfma_f32_16x16x32_bf16 v[132:135], a[204:207], v[68:71], v[224:227]
v_exp_f32 v95, v95
v_mfma_f32_16x16x32_bf16 v[132:135], a[200:203], v[64:67], v[132:135]
ds_read_b128 a[152:155], v3 offset:17408
v_cvt_pk_bf16_f32 v202, v124, v125
v_mfma_f32_16x16x32_bf16 v[132:135], a[196:199], v[60:63], v[132:135]
v_exp_f32 v96, v96
v_mfma_f32_16x16x32_bf16 v[132:135], a[192:195], v[56:59], v[132:135]
ds_read_b128 a[156:159], v3 offset:25600
v_cvt_pk_bf16_f32 v203, v126, v127
v_mfma_f32_16x16x32_bf16 v[116:119], a[192:195], v[40:43], v[220:223]
v_exp_f32 v97, v97
v_mfma_f32_16x16x32_bf16 v[116:119], a[196:199], v[44:47], v[116:119]
v_exp_f32 v98, v98
v_mfma_f32_16x16x32_bf16 v[116:119], a[200:203], v[48:51], v[116:119]
v_exp_f32 v99, v99
v_mfma_f32_16x16x32_bf16 v[116:119], a[204:207], v[52:55], v[116:119]
ds_read_b128 a[160:163], v3 offset:18432
v_cvt_pk_bf16_f32 v178, v108, v109
v_mfma_f32_16x16x32_bf16 v[100:103], a[204:207], v[36:39], v[216:219]
v_exp_f32 v112, v112
v_mfma_f32_16x16x32_bf16 v[100:103], a[200:203], v[32:35], v[100:103]
ds_read_b128 a[164:167], v3 offset:26624
v_cvt_pk_bf16_f32 v179, v110, v111
v_mfma_f32_16x16x32_bf16 v[100:103], a[196:199], v[28:31], v[100:103]
v_exp_f32 v113, v113
v_mfma_f32_16x16x32_bf16 v[100:103], a[192:195], v[24:27], v[100:103]
v_exp_f32 v114, v114
v_mfma_f32_16x16x32_bf16 a[128:131], a[244:247], v[152:155], a[128:131]
v_exp_f32 v115, v115
v_mfma_f32_16x16x32_bf16 a[128:131], a[244:247], v[156:159], a[128:131]
v_exp_f32 v128, v128
v_mfma_f32_16x16x32_bf16 a[132:135], a[244:247], v[160:163], a[132:135]
buffer_load_dwordx4 v16, s[32:35], s64 offen offset:2048 sc1 lds
v_mfma_f32_16x16x32_bf16 a[132:135], a[244:247], v[164:167], a[132:135]
ds_read_b128 a[168:171], v3 offset:19456
v_cvt_pk_bf16_f32 v170, v92, v93
v_mfma_f32_16x16x32_bf16 a[136:139], a[244:247], v[184:187], a[136:139]
ds_read_b128 a[172:175], v3 offset:27648
v_cvt_pk_bf16_f32 v171, v94, v95
v_mfma_f32_16x16x32_bf16 a[136:139], a[244:247], v[188:191], a[136:139]
v_exp_f32 v129, v129
v_mfma_f32_16x16x32_bf16 a[140:143], a[244:247], v[192:195], a[140:143]
v_exp_f32 v130, v130
v_mfma_f32_16x16x32_bf16 a[140:143], a[244:247], v[196:199], a[140:143]
s_waitcnt lgkmcnt(2)
v_exp_f32 v131, v131
v_mfma_f32_16x16x32_bf16 a[0:3], a[144:147], v[152:155], a[0:3]
v_exp_f32 v144, v144
v_mfma_f32_16x16x32_bf16 a[0:3], a[148:151], v[156:159], a[0:3]
ds_read_b128 a[176:179], v3 offset:20480
v_cvt_pk_bf16_f32 v172, v96, v97
v_mfma_f32_16x16x32_bf16 a[32:35], a[148:151], v[164:167], a[32:35]
ds_read_b128 a[180:183], v3 offset:28672
v_cvt_pk_bf16_f32 v173, v98, v99
v_mfma_f32_16x16x32_bf16 a[32:35], a[144:147], v[160:163], a[32:35]
v_exp_f32 v145, v145
v_mfma_f32_16x16x32_bf16 a[64:67], a[144:147], v[184:187], a[64:67]
ds_read_b128 a[184:187], v3 offset:21504
v_xor_b32 v2, 0x8000, v2
v_mfma_f32_16x16x32_bf16 a[64:67], a[148:151], v[188:191], a[64:67]
ds_read_b128 a[188:191], v3 offset:29696
v_cvt_pk_bf16_f32 v180, v112, v113
v_mfma_f32_16x16x32_bf16 a[96:99], a[148:151], v[196:199], a[96:99]
ds_read_b128 a[192:195], v3 offset:22528
v_cvt_pk_bf16_f32 v181, v114, v115
v_mfma_f32_16x16x32_bf16 a[96:99], a[144:147], v[192:195], a[96:99]
v_exp_f32 v146, v146
v_mfma_f32_16x16x32_bf16 a[100:103], a[152:155], v[192:195], a[100:103]
v_exp_f32 v147, v147
v_mfma_f32_16x16x32_bf16 a[100:103], a[156:159], v[196:199], a[100:103]
ds_read_b128 a[196:199], v3 offset:30720
v_cvt_pk_bf16_f32 v204, v128, v129
v_mfma_f32_16x16x32_bf16 a[68:71], a[156:159], v[188:191], a[68:71]
buffer_load_dwordx4 v16, s[32:35], s64 offen offset:3072 sc1 lds
v_mfma_f32_16x16x32_bf16 a[68:71], a[152:155], v[184:187], a[68:71]
v_exp_f32 v148, v148
v_mfma_f32_16x16x32_bf16 a[36:39], a[152:155], v[160:163], a[36:39]
v_exp_f32 v149, v149
v_mfma_f32_16x16x32_bf16 a[36:39], a[156:159], v[164:167], a[36:39]
ds_read_b128 a[200:203], v3 offset:23552
v_cvt_pk_bf16_f32 v205, v130, v131
v_mfma_f32_16x16x32_bf16 a[4:7], a[156:159], v[156:159], a[4:7]
v_exp_f32 v150, v150
v_mfma_f32_16x16x32_bf16 a[4:7], a[152:155], v[152:155], a[4:7]
v_exp_f32 v151, v151
v_mfma_f32_16x16x32_bf16 a[8:11], a[160:163], v[152:155], a[8:11]
v_exp_f32 v132, v132
v_mfma_f32_16x16x32_bf16 a[8:11], a[164:167], v[156:159], a[8:11]
ds_read_b128 a[204:207], v3 offset:31744
v_cvt_pk_bf16_f32 v212, v144, v145
v_mfma_f32_16x16x32_bf16 a[40:43], a[164:167], v[164:167], a[40:43]
v_exp_f32 v133, v133
v_mfma_f32_16x16x32_bf16 a[40:43], a[160:163], v[160:163], a[40:43]
v_exp_f32 v134, v134
v_mfma_f32_16x16x32_bf16 a[72:75], a[160:163], v[184:187], a[72:75]
v_exp_f32 v135, v135
v_mfma_f32_16x16x32_bf16 a[72:75], a[164:167], v[188:191], a[72:75]
v_exp_f32 v116, v116
v_mfma_f32_16x16x32_bf16 a[104:107], a[164:167], v[196:199], a[104:107]
v_exp_f32 v117, v117
v_mfma_f32_16x16x32_bf16 a[104:107], a[160:163], v[192:195], a[104:107]
s_waitcnt lgkmcnt(0)
v_exp_f32 v118, v118
v_mfma_f32_16x16x32_bf16 a[108:111], a[168:171], v[192:195], a[108:111]
v_exp_f32 v119, v119
v_mfma_f32_16x16x32_bf16 a[108:111], a[172:175], v[196:199], a[108:111]
v_exp_f32 v100, v100
v_mfma_f32_16x16x32_bf16 a[76:79], a[172:175], v[188:191], a[76:79]
v_exp_f32 v101, v101
v_mfma_f32_16x16x32_bf16 a[76:79], a[168:171], v[184:187], a[76:79]
v_exp_f32 v102, v102
v_mfma_f32_16x16x32_bf16 a[44:47], a[168:171], v[160:163], a[44:47]
s_waitcnt vmcnt(8)
s_barrier
v_mfma_f32_16x16x32_bf16 a[44:47], a[172:175], v[164:167], a[44:47]
s_xor_b32 s71, s71, 49152
ds_read_b128 a[144:147], v2 offset:0
v_cvt_pk_bf16_f32 v213, v146, v147
v_mfma_f32_16x16x32_bf16 a[12:15], a[172:175], v[156:159], a[12:15]
s_add_u32 s70, s70, 32768
ds_read_b128 a[148:151], v2 offset:1024
v_cvt_pk_bf16_f32 v214, v148, v149
v_mfma_f32_16x16x32_bf16 a[12:15], a[168:171], v[152:155], a[12:15]
s_mov_b32 m0, s71
ds_read_b128 a[152:155], v2 offset:2048
v_cvt_pk_bf16_f32 v215, v150, v151
v_mfma_f32_16x16x32_bf16 a[16:19], a[176:179], v[152:155], a[16:19]
buffer_load_dwordx4 v16, s[32:35], s70 offen offset:0 sc1 lds
v_mfma_f32_16x16x32_bf16 a[16:19], a[180:183], v[156:159], a[16:19]
s_add_u32 s17, s78, L_DD-L_pc
ds_read_b128 a[156:159], v2 offset:3072
v_cvt_pk_bf16_f32 v206, v132, v133
v_mfma_f32_16x16x32_bf16 a[48:51], a[180:183], v[164:167], a[48:51]
buffer_load_dword a252, v16, s[88:91], s17 offen
v_mfma_f32_16x16x32_bf16 a[48:51], a[176:179], v[160:163], a[48:51]
v_exp_f32 v103, v103
v_mfma_f32_16x16x32_bf16 a[80:83], a[176:179], v[184:187], a[80:83]
s_add_u32 s17, s78, L_DD-L_pc+4096
ds_read_b128 a[160:163], v2 offset:4096
v_cvt_pk_bf16_f32 v207, v134, v135
v_mfma_f32_16x16x32_bf16 a[80:83], a[180:183], v[188:191], a[80:83]
buffer_load_dword a252, v16, s[88:91], s17 offen
v_mfma_f32_16x16x32_bf16 a[112:115], a[180:183], v[196:199], a[112:115]
ds_read_b128 a[164:167], v2 offset:5120
v_cvt_pk_bf16_f32 v182, v116, v117
v_mfma_f32_16x16x32_bf16 a[112:115], a[176:179], v[192:195], a[112:115]
ds_read_b128 a[168:171], v2 offset:6144
v_xor_b32 v3, 0x8000, v3
v_mfma_f32_16x16x32_bf16 a[116:119], a[184:187], v[192:195], a[116:119]
ds_read_b128 a[172:175], v2 offset:7168
v_cvt_pk_bf16_f32 v183, v118, v119
v_mfma_f32_16x16x32_bf16 a[116:119], a[188:191], v[196:199], a[116:119]
v_cvt_pk_bf16_f32 v174, v100, v101
v_cvt_pk_bf16_f32 v175, v102, v103
v_mfma_f32_16x16x32_bf16 a[84:87], a[188:191], v[188:191], a[84:87]
v_mfma_f32_16x16x32_bf16 a[84:87], a[184:187], v[184:187], a[84:87]
v_mfma_f32_16x16x32_bf16 a[52:55], a[184:187], v[160:163], a[52:55]
v_mfma_f32_16x16x32_bf16 a[52:55], a[188:191], v[164:167], a[52:55]
v_mfma_f32_16x16x32_bf16 a[20:23], a[188:191], v[156:159], a[20:23]
v_mfma_f32_16x16x32_bf16 a[20:23], a[184:187], v[152:155], a[20:23]
v_mfma_f32_16x16x32_bf16 a[24:27], a[192:195], v[152:155], a[24:27]
buffer_load_dwordx4 v16, s[32:35], s70 offen offset:1024 sc1 lds
v_mfma_f32_16x16x32_bf16 a[24:27], a[196:199], v[156:159], a[24:27]
v_mfma_f32_16x16x32_bf16 a[56:59], a[196:199], v[164:167], a[56:59]
v_mfma_f32_16x16x32_bf16 a[56:59], a[192:195], v[160:163], a[56:59]
v_mfma_f32_16x16x32_bf16 a[88:91], a[192:195], v[184:187], a[88:91]
v_mfma_f32_16x16x32_bf16 a[88:91], a[196:199], v[188:191], a[88:91]
s_sub_u32 s72, s72, 1
v_mfma_f32_16x16x32_bf16 a[120:123], a[196:199], v[196:199], a[120:123]
v_mfma_f32_16x16x32_bf16 a[120:123], a[192:195], v[192:195], a[120:123]
v_mfma_f32_16x16x32_bf16 a[124:127], a[200:203], v[192:195], a[124:127]
v_mfma_f32_16x16x32_bf16 a[124:127], a[204:207], v[196:199], a[124:127]
s_cmp_lg_u32 s72, 0
v_mfma_f32_16x16x32_bf16 a[92:95], a[204:207], v[188:191], a[92:95]
v_mfma_f32_16x16x32_bf16 a[92:95], a[200:203], v[184:187], a[92:95]
v_mfma_f32_16x16x32_bf16 a[60:63], a[200:203], v[160:163], a[60:63]
v_mfma_f32_16x16x32_bf16 a[60:63], a[204:207], v[164:167], a[60:63]
v_mfma_f32_16x16x32_bf16 a[28:31], a[204:207], v[156:159], a[28:31]
v_mfma_f32_16x16x32_bf16 a[28:31], a[200:203], v[152:155], a[28:31]
s_cbranch_scc1 L_D
L_DD:
s_waitcnt lgkmcnt(7)
v_mfma_f32_16x16x32_bf16 v[104:107], a[144:147], v[40:43], v[220:223]
s_waitcnt lgkmcnt(6)
ds_read_b128 a[176:179], v2 offset:8192
v_cndmask_b32 v88, v216, v17, s[0:1]
v_mfma_f32_16x16x32_bf16 v[104:107], a[148:151], v[44:47], v[104:107]
s_waitcnt lgkmcnt(6)
ds_read_b128 a[180:183], v2 offset:9216
v_cndmask_b32 v89, v216, v17, s[4:5]
v_mfma_f32_16x16x32_bf16 v[104:107], a[152:155], v[48:51], v[104:107]
s_waitcnt lgkmcnt(6)
buffer_load_dwordx4 v16, s[32:35], s70 offen offset:2048 sc1 lds
v_mfma_f32_16x16x32_bf16 v[104:107], a[156:159], v[52:55], v[104:107]
ds_read_b128 a[184:187], v2 offset:10240
v_cndmask_b32 v90, v216, v17, s[6:7]
v_mfma_f32_16x16x32_bf16 v[120:123], a[156:159], v[68:71], v[224:227]
ds_read_b128 a[188:191], v2 offset:11264
v_cndmask_b32 v91, v216, v17, s[8:9]
v_mfma_f32_16x16x32_bf16 v[120:123], a[152:155], v[64:67], v[120:123]
ds_read_b128 a[192:195], v2 offset:12288
v_cndmask_b32 v92, v216, v17, s[10:11]
v_mfma_f32_16x16x32_bf16 v[120:123], a[148:151], v[60:63], v[120:123]
ds_read_b128 a[196:199], v2 offset:13312
v_cndmask_b32 v93, v216, v17, s[12:13]
v_mfma_f32_16x16x32_bf16 v[120:123], a[144:147], v[56:59], v[120:123]
ds_read_b128 a[200:203], v2 offset:14336
v_cndmask_b32 v94, v216, v17, s[18:19]
v_mfma_f32_16x16x32_bf16 v[136:139], a[144:147], v[72:75], v[228:231]
ds_read_b128 a[204:207], v2 offset:15360
v_cndmask_b32 v95, v216, v17, s[22:23]
v_mfma_f32_16x16x32_bf16 v[136:139], a[148:151], v[76:79], v[136:139]
v_cndmask_b32 v96, v216, v17, s[26:27]
v_cndmask_b32 v97, v216, v17, s[56:57]
v_mfma_f32_16x16x32_bf16 v[136:139], a[152:155], v[80:83], v[136:139]
v_exp_f32 v104, v104
v_mfma_f32_16x16x32_bf16 v[136:139], a[156:159], v[84:87], v[136:139]
v_exp_f32 v105, v105
v_mfma_f32_16x16x32_bf16 v[88:91], a[156:159], v[36:39], v[88:91]
v_exp_f32 v106, v106
v_mfma_f32_16x16x32_bf16 v[88:91], a[152:155], v[32:35], v[88:91]
v_exp_f32 v107, v107
v_mfma_f32_16x16x32_bf16 v[88:91], a[148:151], v[28:31], v[88:91]
v_exp_f32 v120, v120
v_mfma_f32_16x16x32_bf16 v[88:91], a[144:147], v[24:27], v[88:91]
s_waitcnt lgkmcnt(0)
v_exp_f32 v121, v121
v_mfma_f32_16x16x32_bf16 v[140:143], a[160:163], v[72:75], v[228:231]
v_exp_f32 v122, v122
v_mfma_f32_16x16x32_bf16 v[140:143], a[164:167], v[76:79], v[140:143]
v_exp_f32 v123, v123
v_mfma_f32_16x16x32_bf16 v[140:143], a[168:171], v[80:83], v[140:143]
buffer_load_dwordx4 v16, s[32:35], s70 offen offset:3072 sc1 lds
v_mfma_f32_16x16x32_bf16 v[140:143], a[172:175], v[84:87], v[140:143]
s_add_u32 m0, s86, 131072
v_cvt_pk_bf16_f32 v160, v104, v105
v_cvt_pk_bf16_f32 v161, v106, v107
v_mfma_f32_16x16x32_bf16 v[124:127], a[172:175], v[68:71], v[224:227]
s_add_u32 s64, s85, 0
v_exp_f32 v136, v136
v_mfma_f32_16x16x32_bf16 v[124:127], a[168:171], v[64:67], v[124:127]
buffer_load_dwordx4 v12, s[36:39], s64 offen lds
v_mfma_f32_16x16x32_bf16 v[124:127], a[164:167], v[60:63], v[124:127]
s_add_u32 m0, s86, 132096
v_exp_f32 v137, v137
v_mfma_f32_16x16x32_bf16 v[124:127], a[160:163], v[56:59], v[124:127]
s_add_u32 s64, s85, 8192
ds_read_b128 a[144:147], v3 offset:0
v_cndmask_b32 v98, v216, v17, s[58:59]
v_mfma_f32_16x16x32_bf16 v[108:111], a[160:163], v[40:43], v[220:223]
buffer_load_dwordx4 v13, s[36:39], s64 offen lds
v_mfma_f32_16x16x32_bf16 v[108:111], a[164:167], v[44:47], v[108:111]
ds_read_b128 a[148:151], v3 offset:8192
v_cndmask_b32 v99, v216, v17, s[60:61]
v_mfma_f32_16x16x32_bf16 v[108:111], a[168:171], v[48:51], v[108:111]
s_add_u32 m0, s86, 133120
v_exp_f32 v138, v138
v_mfma_f32_16x16x32_bf16 v[108:111], a[172:175], v[52:55], v[108:111]
s_add_u32 s64, s85, 16384
v_cvt_pk_bf16_f32 v184, v120, v121
v_cvt_pk_bf16_f32 v185, v122, v123
v_mfma_f32_16x16x32_bf16 v[92:95], a[172:175], v[36:39], v[92:95]
buffer_load_dwordx4 v12, s[36:39], s64 offen lds
v_mfma_f32_16x16x32_bf16 v[92:95], a[168:171], v[32:35], v[92:95]
s_add_u32 m0, s86, 134144
v_exp_f32 v139, v139
v_mfma_f32_16x16x32_bf16 v[92:95], a[164:167], v[28:31], v[92:95]
s_add_u32 s64, s85, 24576
v_exp_f32 v88, v88
v_mfma_f32_16x16x32_bf16 v[92:95], a[160:163], v[24:27], v[92:95]
buffer_load_dwordx4 v13, s[36:39], s64 offen lds
v_mfma_f32_16x16x32_bf16 v[96:99], a[176:179], v[24:27], v[96:99]
s_add_u32 m0, s71, 4096
v_exp_f32 v89, v89
v_mfma_f32_16x16x32_bf16 v[96:99], a[180:183], v[28:31], v[96:99]
s_add_u32 s64, s70, 4096
v_exp_f32 v90, v90
v_mfma_f32_16x16x32_bf16 v[96:99], a[184:187], v[32:35], v[96:99]
buffer_load_dwordx4 v16, s[32:35], s64 offen offset:0 sc1 lds
v_mfma_f32_16x16x32_bf16 v[96:99], a[188:191], v[36:39], v[96:99]
v_cvt_pk_bf16_f32 v192, v136, v137
v_cvt_pk_bf16_f32 v193, v138, v139
v_mfma_f32_16x16x32_bf16 v[112:115], a[188:191], v[52:55], v[220:223]
v_exp_f32 v91, v91
v_mfma_f32_16x16x32_bf16 v[112:115], a[184:187], v[48:51], v[112:115]
v_exp_f32 v140, v140
v_mfma_f32_16x16x32_bf16 v[112:115], a[180:183], v[44:47], v[112:115]
v_exp_f32 v141, v141
v_mfma_f32_16x16x32_bf16 v[112:115], a[176:179], v[40:43], v[112:115]
v_exp_f32 v142, v142
v_mfma_f32_16x16x32_bf16 v[128:131], a[176:179], v[56:59], v[224:227]
v_exp_f32 v143, v143
v_mfma_f32_16x16x32_bf16 v[128:131], a[180:183], v[60:63], v[128:131]
v_exp_f32 v124, v124
v_mfma_f32_16x16x32_bf16 v[128:131], a[184:187], v[64:67], v[128:131]
v_exp_f32 v125, v125
v_mfma_f32_16x16x32_bf16 v[128:131], a[188:191], v[68:71], v[128:131]
v_cvt_pk_bf16_f32 v152, v88, v89
v_cvt_pk_bf16_f32 v153, v90, v91
v_mfma_f32_16x16x32_bf16 v[144:147], a[188:191], v[84:87], v[228:231]
v_exp_f32 v126, v126
v_mfma_f32_16x16x32_bf16 v[144:147], a[184:187], v[80:83], v[144:147]
v_exp_f32 v127, v127
v_mfma_f32_16x16x32_bf16 v[144:147], a[180:183], v[76:79], v[144:147]
ds_read_b128 a[152:155], v3 offset:1024
v_cndmask_b32 v100, v216, v17, s[62:63]
v_mfma_f32_16x16x32_bf16 v[144:147], a[176:179], v[72:75], v[144:147]
ds_read_b128 a[156:159], v3 offset:9216
v_cndmask_b32 v101, v216, v17, s[48:49]
v_mfma_f32_16x16x32_bf16 v[148:151], a[192:195], v[72:75], v[228:231]
ds_read_b128 a[160:163], v3 offset:2048
v_cndmask_b32 v102, v216, v17, s[50:51]
v_mfma_f32_16x16x32_bf16 v[148:151], a[196:199], v[76:79], v[148:151]
ds_read_b128 a[164:167], v3 offset:10240
v_cndmask_b32 v103, v216, v17, s[100:101]
v_mfma_f32_16x16x32_bf16 v[148:151], a[200:203], v[80:83], v[148:151]
buffer_load_dwordx4 v16, s[32:35], s64 offen offset:1024 sc1 lds
v_mfma_f32_16x16x32_bf16 v[148:151], a[204:207], v[84:87], v[148:151]
v_cvt_pk_bf16_f32 v194, v140, v141
v_cvt_pk_bf16_f32 v195, v142, v143
v_mfma_f32_16x16x32_bf16 v[132:135], a[204:207], v[68:71], v[224:227]
v_exp_f32 v108, v108
v_mfma_f32_16x16x32_bf16 v[132:135], a[200:203], v[64:67], v[132:135]
v_exp_f32 v109, v109
v_mfma_f32_16x16x32_bf16 v[132:135], a[196:199], v[60:63], v[132:135]
v_exp_f32 v110, v110
v_mfma_f32_16x16x32_bf16 v[132:135], a[192:195], v[56:59], v[132:135]
v_exp_f32 v111, v111
v_mfma_f32_16x16x32_bf16 v[116:119], a[192:195], v[40:43], v[220:223]
v_exp_f32 v92, v92
v_mfma_f32_16x16x32_bf16 v[116:119], a[196:199], v[44:47], v[116:119]
v_exp_f32 v93, v93
v_mfma_f32_16x16x32_bf16 v[116:119], a[200:203], v[48:51], v[116:119]
v_exp_f32 v94, v94
v_mfma_f32_16x16x32_bf16 v[116:119], a[204:207], v[52:55], v[116:119]
v_cvt_pk_bf16_f32 v186, v124, v125
v_cvt_pk_bf16_f32 v187, v126, v127
v_mfma_f32_16x16x32_bf16 v[100:103], a[204:207], v[36:39], v[100:103]
v_exp_f32 v95, v95
v_mfma_f32_16x16x32_bf16 v[100:103], a[200:203], v[32:35], v[100:103]
v_exp_f32 v96, v96
v_mfma_f32_16x16x32_bf16 v[100:103], a[196:199], v[28:31], v[100:103]
v_exp_f32 v97, v97
v_mfma_f32_16x16x32_bf16 v[100:103], a[192:195], v[24:27], v[100:103]
v_exp_f32 v98, v98
v_mfma_f32_16x16x32_bf16 a[128:131], a[244:247], v[168:171], a[128:131]
v_exp_f32 v99, v99
v_mfma_f32_16x16x32_bf16 a[128:131], a[244:247], v[172:175], a[128:131]
v_exp_f32 v112, v112
v_mfma_f32_16x16x32_bf16 a[132:135], a[244:247], v[176:179], a[132:135]
buffer_load_dwordx4 v16, s[32:35], s64 offen offset:2048 sc1 lds
v_mfma_f32_16x16x32_bf16 a[132:135], a[244:247], v[180:183], a[132:135]
v_cvt_pk_bf16_f32 v162, v108, v109
v_cvt_pk_bf16_f32 v163, v110, v111
v_mfma_f32_16x16x32_bf16 a[136:139], a[244:247], v[200:203], a[136:139]
v_exp_f32 v113, v113
v_mfma_f32_16x16x32_bf16 a[136:139], a[244:247], v[204:207], a[136:139]
v_exp_f32 v114, v114
v_mfma_f32_16x16x32_bf16 a[140:143], a[244:247], v[208:211], a[140:143]
v_exp_f32 v115, v115
v_mfma_f32_16x16x32_bf16 a[140:143], a[244:247], v[212:215], a[140:143]
s_waitcnt lgkmcnt(0)
v_exp_f32 v128, v128
v_mfma_f32_16x16x32_bf16 a[0:3], a[144:147], v[168:171], a[0:3]
ds_read_b128 a[168:171], v3 offset:3072
v_cvt_pk_bf16_f32 v154, v92, v93
v_mfma_f32_16x16x32_bf16 a[0:3], a[148:151], v[172:175], a[0:3]
ds_read_b128 a[172:175], v3 offset:11264
v_cvt_pk_bf16_f32 v155, v94, v95
v_mfma_f32_16x16x32_bf16 a[32:35], a[148:151], v[180:183], a[32:35]
v_exp_f32 v129, v129
v_mfma_f32_16x16x32_bf16 a[32:35], a[144:147], v[176:179], a[32:35]
v_exp_f32 v130, v130
v_mfma_f32_16x16x32_bf16 a[64:67], a[144:147], v[200:203], a[64:67]
v_exp_f32 v131, v131
v_mfma_f32_16x16x32_bf16 a[64:67], a[148:151], v[204:207], a[64:67]
v_exp_f32 v144, v144
v_mfma_f32_16x16x32_bf16 a[96:99], a[148:151], v[212:215], a[96:99]
ds_read_b128 a[176:179], v3 offset:4096
v_cvt_pk_bf16_f32 v156, v96, v97
v_mfma_f32_16x16x32_bf16 a[96:99], a[144:147], v[208:211], a[96:99]
ds_read_b128 a[180:183], v3 offset:12288
v_cvt_pk_bf16_f32 v157, v98, v99
v_mfma_f32_16x16x32_bf16 a[100:103], a[152:155], v[208:211], a[100:103]
v_exp_f32 v145, v145
v_mfma_f32_16x16x32_bf16 a[100:103], a[156:159], v[212:215], a[100:103]
ds_read_b128 a[184:187], v3 offset:5120
v_cvt_pk_bf16_f32 v164, v112, v113
v_mfma_f32_16x16x32_bf16 a[68:71], a[156:159], v[204:207], a[68:71]
buffer_load_dwordx4 v16, s[32:35], s64 offen offset:3072 sc1 lds
v_mfma_f32_16x16x32_bf16 a[68:71], a[152:155], v[200:203], a[68:71]
s_add_u32 m0, s86, 135168
ds_read_b128 a[188:191], v3 offset:13312
v_cvt_pk_bf16_f32 v165, v114, v115
v_mfma_f32_16x16x32_bf16 a[36:39], a[152:155], v[176:179], a[36:39]
s_add_u32 s64, s85, 32768
ds_read_b128 a[192:195], v3 offset:6144
v_cvt_pk_bf16_f32 v188, v128, v129
v_mfma_f32_16x16x32_bf16 a[36:39], a[156:159], v[180:183], a[36:39]
buffer_load_dwordx4 v12, s[36:39], s64 offen lds
v_mfma_f32_16x16x32_bf16 a[4:7], a[156:159], v[172:175], a[4:7]
s_add_u32 m0, s86, 136192
ds_read_b128 a[196:199], v3 offset:14336
v_cvt_pk_bf16_f32 v189, v130, v131
v_mfma_f32_16x16x32_bf16 a[4:7], a[152:155], v[168:171], a[4:7]
s_add_u32 s64, s85, 40960
ds_read_b128 a[200:203], v3 offset:7168
v_cvt_pk_bf16_f32 v196, v144, v145
v_mfma_f32_16x16x32_bf16 a[8:11], a[160:163], v[168:171], a[8:11]
buffer_load_dwordx4 v13, s[36:39], s64 offen lds
v_mfma_f32_16x16x32_bf16 a[8:11], a[164:167], v[172:175], a[8:11]
s_add_u32 m0, s86, 137216
ds_read_b128 a[204:207], v3 offset:15360
v_mfma_f32_16x16x32_bf16 a[40:43], a[164:167], v[180:183], a[40:43]
s_add_u32 s64, s85, 49152
v_exp_f32 v146, v146
v_mfma_f32_16x16x32_bf16 a[40:43], a[160:163], v[176:179], a[40:43]
buffer_load_dwordx4 v12, s[36:39], s64 offen lds
v_mfma_f32_16x16x32_bf16 a[72:75], a[160:163], v[200:203], a[72:75]
s_add_u32 m0, s86, 138240
v_exp_f32 v147, v147
v_mfma_f32_16x16x32_bf16 a[72:75], a[164:167], v[204:207], a[72:75]
s_add_u32 s64, s85, 57344
v_exp_f32 v148, v148
v_mfma_f32_16x16x32_bf16 a[104:107], a[164:167], v[212:215], a[104:107]
buffer_load_dwordx4 v13, s[36:39], s64 offen lds
v_mfma_f32_16x16x32_bf16 a[104:107], a[160:163], v[208:211], a[104:107]
s_waitcnt lgkmcnt(0)
v_exp_f32 v149, v149
v_mfma_f32_16x16x32_bf16 a[108:111], a[168:171], v[208:211], a[108:111]
v_exp_f32 v150, v150
v_mfma_f32_16x16x32_bf16 a[108:111], a[172:175], v[212:215], a[108:111]
v_exp_f32 v151, v151
v_mfma_f32_16x16x32_bf16 a[76:79], a[172:175], v[204:207], a[76:79]
v_exp_f32 v132, v132
v_mfma_f32_16x16x32_bf16 a[76:79], a[168:171], v[200:203], a[76:79]
v_exp_f32 v133, v133
v_mfma_f32_16x16x32_bf16 a[44:47], a[168:171], v[176:179], a[44:47]
s_waitcnt vmcnt(16)
s_barrier
v_mfma_f32_16x16x32_bf16 a[44:47], a[172:175], v[180:183], a[44:47]
s_xor_b32 s71, s71, 16384
v_exp_f32 v134, v134
v_mfma_f32_16x16x32_bf16 a[12:15], a[172:175], v[172:175], a[12:15]
s_add_u32 s70, s70, 32768
v_exp_f32 v135, v135
v_mfma_f32_16x16x32_bf16 a[12:15], a[168:171], v[168:171], a[12:15]
s_mov_b32 m0, s71
v_exp_f32 v116, v116
v_mfma_f32_16x16x32_bf16 a[16:19], a[176:179], v[168:171], a[16:19]
buffer_load_dwordx4 v16, s[32:35], s70 offen offset:0 sc1 lds
v_mfma_f32_16x16x32_bf16 a[16:19], a[180:183], v[172:175], a[16:19]
v_exp_f32 v117, v117
v_mfma_f32_16x16x32_bf16 a[48:51], a[180:183], v[180:183], a[48:51]
v_exp_f32 v118, v118
v_mfma_f32_16x16x32_bf16 a[48:51], a[176:179], v[176:179], a[48:51]
v_exp_f32 v119, v119
v_mfma_f32_16x16x32_bf16 a[80:83], a[176:179], v[200:203], a[80:83]
v_exp_f32 v100, v100
v_mfma_f32_16x16x32_bf16 a[80:83], a[180:183], v[204:207], a[80:83]
v_exp_f32 v101, v101
v_mfma_f32_16x16x32_bf16 a[112:115], a[180:183], v[212:215], a[112:115]
v_cvt_pk_bf16_f32 v197, v146, v147
v_cvt_pk_bf16_f32 v198, v148, v149
v_mfma_f32_16x16x32_bf16 a[112:115], a[176:179], v[208:211], a[112:115]
ds_read_b128 a[144:147], v2 offset:16384
v_cvt_pk_bf16_f32 v199, v150, v151
v_mfma_f32_16x16x32_bf16 a[116:119], a[184:187], v[208:211], a[116:119]
ds_read_b128 a[148:151], v2 offset:17408
v_cvt_pk_bf16_f32 v190, v132, v133
v_mfma_f32_16x16x32_bf16 a[116:119], a[188:191], v[212:215], a[116:119]
v_exp_f32 v102, v102
v_mfma_f32_16x16x32_bf16 a[84:87], a[188:191], v[204:207], a[84:87]
ds_read_b128 a[152:155], v2 offset:18432
v_cvt_pk_bf16_f32 v191, v134, v135
v_mfma_f32_16x16x32_bf16 a[84:87], a[184:187], v[200:203], a[84:87]
ds_read_b128 a[156:159], v2 offset:19456
v_cvt_pk_bf16_f32 v166, v116, v117
v_mfma_f32_16x16x32_bf16 a[52:55], a[184:187], v[176:179], a[52:55]
v_exp_f32 v103, v103
v_mfma_f32_16x16x32_bf16 a[52:55], a[188:191], v[180:183], a[52:55]
ds_read_b128 a[160:163], v2 offset:20480
v_cvt_pk_bf16_f32 v167, v118, v119
v_mfma_f32_16x16x32_bf16 a[20:23], a[188:191], v[172:175], a[20:23]
ds_read_b128 a[164:167], v2 offset:21504
v_cvt_pk_bf16_f32 v158, v100, v101
v_mfma_f32_16x16x32_bf16 a[20:23], a[184:187], v[168:171], a[20:23]
ds_read_b128 a[168:171], v2 offset:22528
v_cvt_pk_bf16_f32 v159, v102, v103
v_mfma_f32_16x16x32_bf16 a[24:27], a[192:195], v[168:171], a[24:27]
buffer_load_dwordx4 v16, s[32:35], s70 offen offset:1024 sc1 lds
v_mfma_f32_16x16x32_bf16 a[24:27], a[196:199], v[172:175], a[24:27]
ds_read_b128 a[172:175], v2 offset:23552
v_cndmask_b32 v104, v220, v17, s[0:1]
v_mfma_f32_16x16x32_bf16 a[56:59], a[196:199], v[180:183], a[56:59]
v_cndmask_b32 v105, v220, v17, s[4:5]
v_cndmask_b32 v106, v220, v17, s[6:7]
v_mfma_f32_16x16x32_bf16 a[56:59], a[192:195], v[176:179], a[56:59]
v_cndmask_b32 v107, v220, v17, s[8:9]
v_cndmask_b32 v108, v220, v17, s[10:11]
v_mfma_f32_16x16x32_bf16 a[88:91], a[192:195], v[200:203], a[88:91]
v_cndmask_b32 v109, v220, v17, s[12:13]
v_cndmask_b32 v110, v220, v17, s[18:19]
v_mfma_f32_16x16x32_bf16 a[88:91], a[196:199], v[204:207], a[88:91]
v_cndmask_b32 v111, v220, v17, s[22:23]
v_cndmask_b32 v112, v220, v17, s[26:27]
v_mfma_f32_16x16x32_bf16 a[120:123], a[196:199], v[212:215], a[120:123]
v_cndmask_b32 v113, v220, v17, s[56:57]
v_cndmask_b32 v114, v220, v17, s[58:59]
v_mfma_f32_16x16x32_bf16 a[120:123], a[192:195], v[208:211], a[120:123]
v_cndmask_b32 v115, v220, v17, s[60:61]
v_cndmask_b32 v116, v220, v17, s[62:63]
v_mfma_f32_16x16x32_bf16 a[124:127], a[200:203], v[208:211], a[124:127]
v_cndmask_b32 v117, v220, v17, s[48:49]
v_cndmask_b32 v118, v220, v17, s[50:51]
v_mfma_f32_16x16x32_bf16 a[124:127], a[204:207], v[212:215], a[124:127]
s_add_u32 s17, s78, L_T-L_pc
v_cndmask_b32 v119, v220, v17, s[100:101]
v_mfma_f32_16x16x32_bf16 a[92:95], a[204:207], v[204:207], a[92:95]
buffer_load_dword a252, v16, s[88:91], s17 offen
v_mfma_f32_16x16x32_bf16 a[92:95], a[200:203], v[200:203], a[92:95]
v_mfma_f32_16x16x32_bf16 a[60:63], a[200:203], v[176:179], a[60:63]
s_add_u32 s17, s78, L_T-L_pc+4096
v_mfma_f32_16x16x32_bf16 a[60:63], a[204:207], v[180:183], a[60:63]
buffer_load_dword a252, v16, s[88:91], s17 offen
v_mfma_f32_16x16x32_bf16 a[28:31], a[204:207], v[172:175], a[28:31]
v_mfma_f32_16x16x32_bf16 a[28:31], a[200:203], v[168:171], a[28:31]
s_waitcnt lgkmcnt(0)
v_mfma_f32_16x16x32_bf16 v[120:123], a[144:147], v[56:59], v[224:227]
ds_read_b128 a[176:179], v2 offset:24576
v_mfma_f32_16x16x32_bf16 v[120:123], a[148:151], v[60:63], v[120:123]
ds_read_b128 a[180:183], v2 offset:25600
v_mfma_f32_16x16x32_bf16 v[120:123], a[152:155], v[64:67], v[120:123]
buffer_load_dwordx4 v16, s[32:35], s70 offen offset:2048 sc1 lds
v_mfma_f32_16x16x32_bf16 v[120:123], a[156:159], v[68:71], v[120:123]
s_add_u32 s17, s78, L_T1-L_pc
ds_read_b128 a[184:187], v2 offset:26624
v_mfma_f32_16x16x32_bf16 v[136:139], a[156:159], v[84:87], v[228:231]
buffer_load_dword a252, v16, s[88:91], s17 offen
v_mfma_f32_16x16x32_bf16 v[136:139], a[152:155], v[80:83], v[136:139]
ds_read_b128 a[188:191], v2 offset:27648
v_mfma_f32_16x16x32_bf16 v[136:139], a[148:151], v[76:79], v[136:139]
s_add_u32 s17, s78, L_T1-L_pc+4096
v_mfma_f32_16x16x32_bf16 v[136:139], a[144:147], v[72:75], v[136:139]
buffer_load_dword a252, v16, s[88:91], s17 offen
v_mfma_f32_16x16x32_bf16 v[104:107], a[144:147], v[40:43], v[104:107]
ds_read_b128 a[192:195], v2 offset:28672
v_mfma_f32_16x16x32_bf16 v[104:107], a[148:151], v[44:47], v[104:107]
v_mfma_f32_16x16x32_bf16 v[104:107], a[152:155], v[48:51], v[104:107]
v_exp_f32 v120, v120
v_mfma_f32_16x16x32_bf16 v[104:107], a[156:159], v[52:55], v[104:107]
v_exp_f32 v121, v121
v_mfma_f32_16x16x32_bf16 v[140:143], a[172:175], v[84:87], v[228:231]
v_exp_f32 v122, v122
v_mfma_f32_16x16x32_bf16 v[140:143], a[168:171], v[80:83], v[140:143]
v_exp_f32 v123, v123
v_mfma_f32_16x16x32_bf16 v[140:143], a[164:167], v[76:79], v[140:143]
v_exp_f32 v136, v136
v_mfma_f32_16x16x32_bf16 v[140:143], a[160:163], v[72:75], v[140:143]
v_exp_f32 v137, v137
v_mfma_f32_16x16x32_bf16 v[124:127], a[160:163], v[56:59], v[224:227]
buffer_load_dwordx4 v16, s[32:35], s70 offen offset:3072 sc1 lds
v_mfma_f32_16x16x32_bf16 v[124:127], a[164:167], v[60:63], v[124:127]
v_exp_f32 v138, v138
v_mfma_f32_16x16x32_bf16 v[124:127], a[168:171], v[64:67], v[124:127]
v_exp_f32 v139, v139
v_mfma_f32_16x16x32_bf16 v[124:127], a[172:175], v[68:71], v[124:127]
ds_read_b128 a[196:199], v2 offset:29696
v_cvt_pk_bf16_f32 v200, v120, v121
v_mfma_f32_16x16x32_bf16 v[108:111], a[172:175], v[52:55], v[108:111]
ds_read_b128 a[200:203], v2 offset:30720
v_cvt_pk_bf16_f32 v201, v122, v123
v_mfma_f32_16x16x32_bf16 v[108:111], a[168:171], v[48:51], v[108:111]
v_exp_f32 v104, v104
v_mfma_f32_16x16x32_bf16 v[108:111], a[164:167], v[44:47], v[108:111]
ds_read_b128 a[204:207], v2 offset:31744
v_cvt_pk_bf16_f32 v208, v136, v137
v_mfma_f32_16x16x32_bf16 v[108:111], a[160:163], v[40:43], v[108:111]
s_waitcnt lgkmcnt(3)
v_exp_f32 v105, v105
v_mfma_f32_16x16x32_bf16 v[112:115], a[176:179], v[40:43], v[112:115]
v_exp_f32 v106, v106
v_mfma_f32_16x16x32_bf16 v[112:115], a[180:183], v[44:47], v[112:115]
v_exp_f32 v107, v107
v_mfma_f32_16x16x32_bf16 v[112:115], a[184:187], v[48:51], v[112:115]
v_exp_f32 v140, v140
v_mfma_f32_16x16x32_bf16 v[112:115], a[188:191], v[52:55], v[112:115]
v_exp_f32 v141, v141
v_mfma_f32_16x16x32_bf16 v[128:131], a[188:191], v[68:71], v[224:227]
s_add_u32 m0, s71, 4096
v_exp_f32 v142, v142
v_mfma_f32_16x16x32_bf16 v[128:131], a[184:187], v[64:67], v[128:131]
s_add_u32 s64, s70, 4096
v_exp_f32 v143, v143
v_mfma_f32_16x16x32_bf16 v[128:131], a[180:183], v[60:63], v[128:131]
buffer_load_dwordx4 v16, s[32:35], s64 offen offset:0 sc1 lds
v_mfma_f32_16x16x32_bf16 v[128:131], a[176:179], v[56:59], v[128:131]
v_exp_f32 v124, v124
v_mfma_f32_16x16x32_bf16 v[144:147], a[176:179], v[72:75], v[228:231]
ds_read_b128 a[144:147], v3 offset:16384
v_cvt_pk_bf16_f32 v209, v138, v139
v_mfma_f32_16x16x32_bf16 v[144:147], a[180:183], v[76:79], v[144:147]
v_exp_f32 v125, v125
v_mfma_f32_16x16x32_bf16 v[144:147], a[184:187], v[80:83], v[144:147]
ds_read_b128 a[148:151], v3 offset:24576
v_cvt_pk_bf16_f32 v176, v104, v105
v_mfma_f32_16x16x32_bf16 v[144:147], a[188:191], v[84:87], v[144:147]
s_waitcnt lgkmcnt(2)
v_exp_f32 v126, v126
v_mfma_f32_16x16x32_bf16 v[148:151], a[204:207], v[84:87], v[228:231]
v_exp_f32 v127, v127
v_mfma_f32_16x16x32_bf16 v[148:151], a[200:203], v[80:83], v[148:151]
ds_read_b128 a[152:155], v3 offset:17408
v_cvt_pk_bf16_f32 v177, v106, v107
v_mfma_f32_16x16x32_bf16 v[148:151], a[196:199], v[76:79], v[148:151]
v_exp_f32 v108, v108
v_mfma_f32_16x16x32_bf16 v[148:151], a[192:195], v[72:75], v[148:151]
ds_read_b128 a[156:159], v3 offset:25600
v_cvt_pk_bf16_f32 v210, v140, v141
v_mfma_f32_16x16x32_bf16 v[132:135], a[192:195], v[56:59], v[224:227]
v_exp_f32 v109, v109
v_mfma_f32_16x16x32_bf16 v[132:135], a[196:199], v[60:63], v[132:135]
v_exp_f32 v110, v110
v_mfma_f32_16x16x32_bf16 v[132:135], a[200:203], v[64:67], v[132:135]
v_exp_f32 v111, v111
v_mfma_f32_16x16x32_bf16 v[132:135], a[204:207], v[68:71], v[132:135]
ds_read_b128 a[160:163], v3 offset:18432
v_cvt_pk_bf16_f32 v211, v142, v143
v_mfma_f32_16x16x32_bf16 v[116:119], a[204:207], v[52:55], v[116:119]
buffer_load_dwordx4 v16, s[32:35], s64 offen offset:1024 sc1 lds
v_mfma_f32_16x16x32_bf16 v[116:119], a[200:203], v[48:51], v[116:119]
v_exp_f32 v112, v112
v_mfma_f32_16x16x32_bf16 v[116:119], a[196:199], v[44:47], v[116:119]
ds_read_b128 a[164:167], v3 offset:26624
v_cvt_pk_bf16_f32 v202, v124, v125
v_mfma_f32_16x16x32_bf16 v[116:119], a[192:195], v[40:43], v[116:119]
v_exp_f32 v113, v113
v_mfma_f32_16x16x32_bf16 a[128:131], a[244:247], v[152:155], a[128:131]
v_exp_f32 v114, v114
v_mfma_f32_16x16x32_bf16 a[128:131], a[244:247], v[156:159], a[128:131]
v_exp_f32 v115, v115
v_mfma_f32_16x16x32_bf16 a[132:135], a[244:247], v[160:163], a[132:135]
ds_read_b128 a[168:171], v3 offset:19456
v_cvt_pk_bf16_f32 v203, v126, v127
v_mfma_f32_16x16x32_bf16 a[132:135], a[244:247], v[164:167], a[132:135]
ds_read_b128 a[172:175], v3 offset:27648
v_cvt_pk_bf16_f32 v178, v108, v109
v_mfma_f32_16x16x32_bf16 a[136:139], a[244:247], v[184:187], a[136:139]
v_exp_f32 v128, v128
v_mfma_f32_16x16x32_bf16 a[136:139], a[244:247], v[188:191], a[136:139]
v_exp_f32 v129, v129
v_mfma_f32_16x16x32_bf16 a[140:143], a[244:247], v[192:195], a[140:143]
v_exp_f32 v130, v130
v_mfma_f32_16x16x32_bf16 a[140:143], a[244:247], v[196:199], a[140:143]
s_waitcnt lgkmcnt(2)
ds_read_b128 a[176:179], v3 offset:20480
v_cvt_pk_bf16_f32 v179, v110, v111
v_mfma_f32_16x16x32_bf16 a[0:3], a[144:147], v[152:155], a[0:3]
v_exp_f32 v131, v131
v_mfma_f32_16x16x32_bf16 a[0:3], a[148:151], v[156:159], a[0:3]
ds_read_b128 a[180:183], v3 offset:28672
v_cvt_pk_bf16_f32 v180, v112, v113
v_mfma_f32_16x16x32_bf16 a[32:35], a[148:151], v[164:167], a[32:35]
buffer_load_dwordx4 v16, s[32:35], s64 offen offset:2048 sc1 lds
v_mfma_f32_16x16x32_bf16 a[32:35], a[144:147], v[160:163], a[32:35]
v_exp_f32 v144, v144
v_mfma_f32_16x16x32_bf16 a[64:67], a[144:147], v[184:187], a[64:67]
v_exp_f32 v145, v145
v_mfma_f32_16x16x32_bf16 a[64:67], a[148:151], v[188:191], a[64:67]
ds_read_b128 a[184:187], v3 offset:21504
v_xor_b32 v2, 0x8000, v2
v_mfma_f32_16x16x32_bf16 a[96:99], a[148:151], v[196:199], a[96:99]
v_exp_f32 v146, v146
v_mfma_f32_16x16x32_bf16 a[96:99], a[144:147], v[192:195], a[96:99]
ds_read_b128 a[188:191], v3 offset:29696
v_cvt_pk_bf16_f32 v181, v114, v115
v_mfma_f32_16x16x32_bf16 a[100:103], a[152:155], v[192:195], a[100:103]
v_exp_f32 v147, v147
v_mfma_f32_16x16x32_bf16 a[100:103], a[156:159], v[196:199], a[100:103]
v_exp_f32 v148, v148
v_mfma_f32_16x16x32_bf16 a[68:71], a[156:159], v[188:191], a[68:71]
v_exp_f32 v149, v149
v_mfma_f32_16x16x32_bf16 a[68:71], a[152:155], v[184:187], a[68:71]
ds_read_b128 a[192:195], v3 offset:22528
v_cvt_pk_bf16_f32 v204, v128, v129
v_mfma_f32_16x16x32_bf16 a[36:39], a[152:155], v[160:163], a[36:39]
v_exp_f32 v150, v150
v_mfma_f32_16x16x32_bf16 a[36:39], a[156:159], v[164:167], a[36:39]
v_exp_f32 v151, v151
v_mfma_f32_16x16x32_bf16 a[4:7], a[156:159], v[156:159], a[4:7]
v_exp_f32 v132, v132
v_mfma_f32_16x16x32_bf16 a[4:7], a[152:155], v[152:155], a[4:7]
ds_read_b128 a[196:199], v3 offset:30720
v_cvt_pk_bf16_f32 v205, v130, v131
v_mfma_f32_16x16x32_bf16 a[8:11], a[160:163], v[152:155], a[8:11]
buffer_load_dwordx4 v16, s[32:35], s64 offen offset:3072 sc1 lds
v_mfma_f32_16x16x32_bf16 a[8:11], a[164:167], v[156:159], a[8:11]
v_exp_f32 v133, v133
v_mfma_f32_16x16x32_bf16 a[40:43], a[164:167], v[164:167], a[40:43]
ds_read_b128 a[200:203], v3 offset:23552
v_cvt_pk_bf16_f32 v212, v144, v145
v_mfma_f32_16x16x32_bf16 a[40:43], a[160:163], v[160:163], a[40:43]
v_exp_f32 v134, v134
v_mfma_f32_16x16x32_bf16 a[72:75], a[160:163], v[184:187], a[72:75]
v_exp_f32 v135, v135
v_mfma_f32_16x16x32_bf16 a[72:75], a[164:167], v[188:191], a[72:75]
v_exp_f32 v116, v116
v_mfma_f32_16x16x32_bf16 a[104:107], a[164:167], v[196:199], a[104:107]
ds_read_b128 a[204:207], v3 offset:31744
v_cvt_pk_bf16_f32 v213, v146, v147
v_mfma_f32_16x16x32_bf16 a[104:107], a[160:163], v[192:195], a[104:107]
s_waitcnt lgkmcnt(2)
v_exp_f32 v117, v117
v_mfma_f32_16x16x32_bf16 a[108:111], a[168:171], v[192:195], a[108:111]
v_exp_f32 v118, v118
v_mfma_f32_16x16x32_bf16 a[108:111], a[172:175], v[196:199], a[108:111]
v_exp_f32 v119, v119
v_mfma_f32_16x16x32_bf16 a[76:79], a[172:175], v[188:191], a[76:79]
v_cvt_pk_bf16_f32 v214, v148, v149
v_cvt_pk_bf16_f32 v215, v150, v151
v_mfma_f32_16x16x32_bf16 a[76:79], a[168:171], v[184:187], a[76:79]
v_cvt_pk_bf16_f32 v206, v132, v133
v_cvt_pk_bf16_f32 v207, v134, v135
v_mfma_f32_16x16x32_bf16 a[44:47], a[168:171], v[160:163], a[44:47]
v_cvt_pk_bf16_f32 v182, v116, v117
v_cvt_pk_bf16_f32 v183, v118, v119
v_mfma_f32_16x16x32_bf16 a[44:47], a[172:175], v[164:167], a[44:47]
v_accvgpr_read_b32 v20, a128
v_max_f32 v1, v1, v20
v_mfma_f32_16x16x32_bf16 a[12:15], a[172:175], v[156:159], a[12:15]
v_rcp_f32 v20, v20
v_mfma_f32_16x16x32_bf16 a[12:15], a[168:171], v[152:155], a[12:15]
v_accvgpr_read_b32 v232, a0
v_accvgpr_read_b32 v233, a1
v_mfma_f32_16x16x32_bf16 a[16:19], a[176:179], v[152:155], a[16:19]
s_waitcnt vmcnt(16)
s_barrier
v_mfma_f32_16x16x32_bf16 a[16:19], a[180:183], v[156:159], a[16:19]
s_xor_b32 s71, s71, 49152
ds_read_b128 a[144:147], v2 offset:0
v_xor_b32 v3, 0x8000, v3
v_mfma_f32_16x16x32_bf16 a[48:51], a[180:183], v[164:167], a[48:51]
s_add_u32 s70, s70, 32768
ds_read_b128 a[148:151], v2 offset:1024
v_accvgpr_read_b32 v234, a2
v_mfma_f32_16x16x32_bf16 a[48:51], a[176:179], v[160:163], a[48:51]
s_mov_b32 m0, s71
ds_read_b128 a[152:155], v2 offset:2048
v_accvgpr_read_b32 v235, a3
v_mfma_f32_16x16x32_bf16 a[80:83], a[176:179], v[184:187], a[80:83]
buffer_load_dwordx4 v16, s[32:35], s70 offen offset:0 sc1 lds
v_mfma_f32_16x16x32_bf16 a[80:83], a[180:183], v[188:191], a[80:83]
ds_read_b128 a[156:159], v2 offset:3072
v_accvgpr_read_b32 v236, a4
v_mfma_f32_16x16x32_bf16 a[112:115], a[180:183], v[196:199], a[112:115]
ds_read_b128 a[160:163], v2 offset:4096
v_accvgpr_read_b32 v237, a5
v_mfma_f32_16x16x32_bf16 a[112:115], a[176:179], v[192:195], a[112:115]
ds_read_b128 a[164:167], v2 offset:5120
v_accvgpr_read_b32 v238, a6
v_mfma_f32_16x16x32_bf16 a[116:119], a[184:187], v[192:195], a[116:119]
ds_read_b128 a[168:171], v2 offset:6144
v_accvgpr_read_b32 v239, a7
v_mfma_f32_16x16x32_bf16 a[116:119], a[188:191], v[196:199], a[116:119]
ds_read_b128 a[172:175], v2 offset:7168
v_mul_f32 v20, v20, v4
v_mfma_f32_16x16x32_bf16 a[84:87], a[188:191], v[188:191], a[84:87]
v_mul_f32 v232, v232, v20
v_mul_f32 v233, v233, v20
v_mfma_f32_16x16x32_bf16 a[84:87], a[184:187], v[184:187], a[84:87]
v_mul_f32 v234, v234, v20
v_mul_f32 v235, v235, v20
v_mfma_f32_16x16x32_bf16 a[52:55], a[184:187], v[160:163], a[52:55]
v_mul_f32 v236, v236, v20
v_mul_f32 v237, v237, v20
v_mfma_f32_16x16x32_bf16 a[52:55], a[188:191], v[164:167], a[52:55]
v_mul_f32 v238, v238, v20
v_mul_f32 v239, v239, v20
v_mfma_f32_16x16x32_bf16 a[20:23], a[188:191], v[156:159], a[20:23]
v_cvt_pk_bf16_f32 v232, v232, v233
v_cvt_pk_bf16_f32 v233, v234, v235
v_mfma_f32_16x16x32_bf16 a[20:23], a[184:187], v[152:155], a[20:23]
v_cvt_pk_bf16_f32 v234, v236, v237
v_cvt_pk_bf16_f32 v235, v238, v239
v_mfma_f32_16x16x32_bf16 a[24:27], a[192:195], v[152:155], a[24:27]
s_add_u32 s77, s74, 0
buffer_store_dwordx4 v[232:235], v16, s[44:47], s77 offen sc1
v_mfma_f32_16x16x32_bf16 a[24:27], a[196:199], v[156:159], a[24:27]
v_accvgpr_read_b32 v240, a8
v_accvgpr_read_b32 v241, a9
v_mfma_f32_16x16x32_bf16 a[56:59], a[196:199], v[164:167], a[56:59]
buffer_load_dwordx4 v16, s[32:35], s70 offen offset:1024 sc1 lds
v_mfma_f32_16x16x32_bf16 a[56:59], a[192:195], v[160:163], a[56:59]
v_accvgpr_read_b32 v242, a10
v_accvgpr_read_b32 v243, a11
v_mfma_f32_16x16x32_bf16 a[88:91], a[192:195], v[184:187], a[88:91]
v_accvgpr_read_b32 v244, a12
v_accvgpr_read_b32 v245, a13
v_mfma_f32_16x16x32_bf16 a[88:91], a[196:199], v[188:191], a[88:91]
v_accvgpr_read_b32 v246, a14
v_accvgpr_read_b32 v247, a15
v_mfma_f32_16x16x32_bf16 a[120:123], a[196:199], v[196:199], a[120:123]
v_mul_f32 v240, v240, v20
v_mul_f32 v241, v241, v20
v_mfma_f32_16x16x32_bf16 a[120:123], a[192:195], v[192:195], a[120:123]
s_waitcnt lgkmcnt(0)
v_mul_f32 v242, v242, v20
v_mul_f32 v243, v243, v20
v_mfma_f32_16x16x32_bf16 a[124:127], a[200:203], v[192:195], a[124:127]
v_mul_f32 v244, v244, v20
v_mul_f32 v245, v245, v20
v_mfma_f32_16x16x32_bf16 a[124:127], a[204:207], v[196:199], a[124:127]
v_mul_f32 v246, v246, v20
v_mul_f32 v247, v247, v20
v_mfma_f32_16x16x32_bf16 a[92:95], a[204:207], v[188:191], a[92:95]
v_cvt_pk_bf16_f32 v240, v240, v241
v_cvt_pk_bf16_f32 v241, v242, v243
v_mfma_f32_16x16x32_bf16 a[92:95], a[200:203], v[184:187], a[92:95]
v_cvt_pk_bf16_f32 v242, v244, v245
v_cvt_pk_bf16_f32 v243, v246, v247
v_mfma_f32_16x16x32_bf16 a[60:63], a[200:203], v[160:163], a[60:63]
s_add_u32 s77, s74, 8192
buffer_store_dwordx4 v[240:243], v16, s[44:47], s77 offen sc1
v_mfma_f32_16x16x32_bf16 a[60:63], a[204:207], v[164:167], a[60:63]
v_accvgpr_read_b32 v232, a16
v_accvgpr_read_b32 v233, a17
v_mfma_f32_16x16x32_bf16 a[28:31], a[204:207], v[156:159], a[28:31]
v_accvgpr_read_b32 v234, a18
v_accvgpr_read_b32 v235, a19
v_mfma_f32_16x16x32_bf16 a[28:31], a[200:203], v[152:155], a[28:31]
v_accvgpr_read_b32 v236, a20
v_accvgpr_read_b32 v237, a21
v_accvgpr_read_b32 v238, a22
v_accvgpr_read_b32 v239, a23
v_mul_f32 v232, v232, v20
v_mul_f32 v233, v233, v20
v_mul_f32 v234, v234, v20
v_mul_f32 v235, v235, v20
v_mul_f32 v236, v236, v20
v_mul_f32 v237, v237, v20
v_mul_f32 v238, v238, v20
v_mul_f32 v239, v239, v20
v_cvt_pk_bf16_f32 v232, v232, v233
v_cvt_pk_bf16_f32 v233, v234, v235
v_cvt_pk_bf16_f32 v234, v236, v237
v_cvt_pk_bf16_f32 v235, v238, v239
s_add_u32 s77, s74, 16384
buffer_store_dwordx4 v[232:235], v16, s[44:47], s77 offen sc1
s_cmp_eq_u32 s3, 7
s_cbranch_scc1 L_T1
L_T:
s_waitcnt lgkmcnt(7)
v_mfma_f32_16x16x32_bf16 v[120:123], a[144:147], v[56:59], v[224:227]
s_waitcnt lgkmcnt(6)
ds_read_b128 a[176:179], v2 offset:8192
v_mfma_f32_16x16x32_bf16 v[120:123], a[148:151], v[60:63], v[120:123]
s_waitcnt lgkmcnt(6)
ds_read_b128 a[180:183], v2 offset:9216
v_mfma_f32_16x16x32_bf16 v[120:123], a[152:155], v[64:67], v[120:123]
s_waitcnt lgkmcnt(6)
buffer_load_dwordx4 v16, s[32:35], s70 offen offset:2048 sc1 lds
v_mfma_f32_16x16x32_bf16 v[120:123], a[156:159], v[68:71], v[120:123]
ds_read_b128 a[184:187], v2 offset:10240
v_mfma_f32_16x16x32_bf16 v[136:139], a[156:159], v[84:87], v[228:231]
ds_read_b128 a[188:191], v2 offset:11264
v_mfma_f32_16x16x32_bf16 v[136:139], a[152:155], v[80:83], v[136:139]
ds_read_b128 a[192:195], v2 offset:12288
v_mfma_f32_16x16x32_bf16 v[136:139], a[148:151], v[76:79], v[136:139]
v_mfma_f32_16x16x32_bf16 v[136:139], a[144:147], v[72:75], v[136:139]
s_waitcnt lgkmcnt(3)
ds_read_b128 a[196:199], v2 offset:13312
v_mfma_f32_16x16x32_bf16 v[140:143], a[160:163], v[72:75], v[228:231]
ds_read_b128 a[200:203], v2 offset:14336
v_accvgpr_read_b32 v240, a24
v_mfma_f32_16x16x32_bf16 v[140:143], a[164:167], v[76:79], v[140:143]
ds_read_b128 a[204:207], v2 offset:15360
v_accvgpr_read_b32 v241, a25
v_mfma_f32_16x16x32_bf16 v[140:143], a[168:171], v[80:83], v[140:143]
v_exp_f32 v120, v120
v_mfma_f32_16x16x32_bf16 v[140:143], a[172:175], v[84:87], v[140:143]
v_exp_f32 v121, v121
v_mfma_f32_16x16x32_bf16 v[124:127], a[172:175], v[68:71], v[224:227]
buffer_load_dwordx4 v16, s[32:35], s70 offen offset:3072 sc1 lds
v_mfma_f32_16x16x32_bf16 v[124:127], a[168:171], v[64:67], v[124:127]
v_exp_f32 v122, v122
v_mfma_f32_16x16x32_bf16 v[124:127], a[164:167], v[60:63], v[124:127]
v_exp_f32 v123, v123
v_mfma_f32_16x16x32_bf16 v[124:127], a[160:163], v[56:59], v[124:127]
v_exp_f32 v136, v136
v_mfma_f32_16x16x32_bf16 v[128:131], a[176:179], v[56:59], v[224:227]
v_exp_f32 v137, v137
v_mfma_f32_16x16x32_bf16 v[128:131], a[180:183], v[60:63], v[128:131]
s_waitcnt lgkmcnt(0)
v_exp_f32 v138, v138
v_mfma_f32_16x16x32_bf16 v[128:131], a[184:187], v[64:67], v[128:131]
v_exp_f32 v139, v139
v_mfma_f32_16x16x32_bf16 v[128:131], a[188:191], v[68:71], v[128:131]
s_add_u32 m0, s71, 4096
v_exp_f32 v140, v140
v_mfma_f32_16x16x32_bf16 v[144:147], a[188:191], v[84:87], v[228:231]
s_add_u32 s64, s70, 4096
v_cvt_pk_bf16_f32 v184, v120, v121
v_cvt_pk_bf16_f32 v185, v122, v123
v_mfma_f32_16x16x32_bf16 v[144:147], a[184:187], v[80:83], v[144:147]
buffer_load_dwordx4 v16, s[32:35], s64 offen offset:0 sc1 lds
v_mfma_f32_16x16x32_bf16 v[144:147], a[180:183], v[76:79], v[144:147]
ds_read_b128 a[144:147], v3 offset:0
v_cvt_pk_bf16_f32 v192, v136, v137
v_mfma_f32_16x16x32_bf16 v[144:147], a[176:179], v[72:75], v[144:147]
ds_read_b128 a[148:151], v3 offset:8192
v_cvt_pk_bf16_f32 v193, v138, v139
v_mfma_f32_16x16x32_bf16 v[148:151], a[192:195], v[72:75], v[228:231]
v_exp_f32 v141, v141
v_mfma_f32_16x16x32_bf16 v[148:151], a[196:199], v[76:79], v[148:151]
v_exp_f32 v142, v142
v_mfma_f32_16x16x32_bf16 v[148:151], a[200:203], v[80:83], v[148:151]
v_exp_f32 v143, v143
v_mfma_f32_16x16x32_bf16 v[148:151], a[204:207], v[84:87], v[148:151]
ds_read_b128 a[152:155], v3 offset:1024
v_cvt_pk_bf16_f32 v194, v140, v141
v_mfma_f32_16x16x32_bf16 v[132:135], a[204:207], v[68:71], v[224:227]
ds_read_b128 a[156:159], v3 offset:9216
v_accvgpr_read_b32 v242, a26
v_mfma_f32_16x16x32_bf16 v[132:135], a[200:203], v[64:67], v[132:135]
v_exp_f32 v124, v124
v_mfma_f32_16x16x32_bf16 v[132:135], a[196:199], v[60:63], v[132:135]
v_exp_f32 v125, v125
v_mfma_f32_16x16x32_bf16 v[132:135], a[192:195], v[56:59], v[132:135]
buffer_load_dwordx4 v16, s[32:35], s64 offen offset:1024 sc1 lds
v_mfma_f32_16x16x32_bf16 a[132:135], a[244:247], v[176:179], a[132:135]
ds_read_b128 a[160:163], v3 offset:2048
v_accvgpr_read_b32 v243, a27
v_mfma_f32_16x16x32_bf16 a[132:135], a[244:247], v[180:183], a[132:135]
ds_read_b128 a[164:167], v3 offset:10240
v_accvgpr_read_b32 v244, a28
v_mfma_f32_16x16x32_bf16 a[136:139], a[244:247], v[200:203], a[136:139]
ds_read_b128 a[168:171], v3 offset:3072
v_accvgpr_read_b32 v245, a29
v_mfma_f32_16x16x32_bf16 a[136:139], a[244:247], v[204:207], a[136:139]
ds_read_b128 a[172:175], v3 offset:11264
v_accvgpr_read_b32 v246, a30
v_mfma_f32_16x16x32_bf16 a[140:143], a[244:247], v[208:211], a[140:143]
ds_read_b128 a[176:179], v3 offset:4096
v_accvgpr_read_b32 v247, a31
v_mfma_f32_16x16x32_bf16 a[140:143], a[244:247], v[212:215], a[140:143]
s_waitcnt lgkmcnt(5)
ds_read_b128 a[180:183], v3 offset:12288
v_mul_f32 v240, v240, v20
v_mfma_f32_16x16x32_bf16 a[32:35], a[144:147], v[176:179], a[32:35]
ds_read_b128 a[184:187], v3 offset:5120
v_mul_f32 v241, v241, v20
v_mfma_f32_16x16x32_bf16 a[32:35], a[148:151], v[180:183], a[32:35]
ds_read_b128 a[188:191], v3 offset:13312
v_mul_f32 v242, v242, v20
v_mfma_f32_16x16x32_bf16 a[64:67], a[148:151], v[204:207], a[64:67]
ds_read_b128 a[192:195], v3 offset:6144
v_mul_f32 v243, v243, v20
v_mfma_f32_16x16x32_bf16 a[64:67], a[144:147], v[200:203], a[64:67]
ds_read_b128 a[196:199], v3 offset:14336
v_mul_f32 v244, v244, v20
v_mfma_f32_16x16x32_bf16 a[96:99], a[144:147], v[208:211], a[96:99]
ds_read_b128 a[200:203], v3 offset:7168
v_mul_f32 v245, v245, v20
v_mul_f32 v246, v246, v20
v_mul_f32 v247, v247, v20
v_cvt_pk_bf16_f32 v240, v240, v241
v_cvt_pk_bf16_f32 v241, v242, v243
v_cvt_pk_bf16_f32 v242, v244, v245
v_cvt_pk_bf16_f32 v243, v246, v247
s_add_u32 s77, s74, 24576
buffer_store_dwordx4 v[240:243], v16, s[44:47], s77 offen sc1
v_mfma_f32_16x16x32_bf16 a[96:99], a[148:151], v[212:215], a[96:99]
v_exp_f32 v126, v126
v_mfma_f32_16x16x32_bf16 a[100:103], a[156:159], v[212:215], a[100:103]
buffer_load_dwordx4 v16, s[32:35], s64 offen offset:2048 sc1 lds
v_cvt_pk_bf16_f32 v195, v142, v143
v_mfma_f32_16x16x32_bf16 a[100:103], a[152:155], v[208:211], a[100:103]
v_exp_f32 v127, v127
v_mfma_f32_16x16x32_bf16 a[68:71], a[152:155], v[200:203], a[68:71]
v_exp_f32 v128, v128
v_mfma_f32_16x16x32_bf16 a[68:71], a[156:159], v[204:207], a[68:71]
v_exp_f32 v129, v129
v_mfma_f32_16x16x32_bf16 a[36:39], a[156:159], v[180:183], a[36:39]
v_exp_f32 v130, v130
v_mfma_f32_16x16x32_bf16 a[36:39], a[152:155], v[176:179], a[36:39]
s_waitcnt lgkmcnt(0)
v_cvt_pk_bf16_f32 v186, v124, v125
v_cvt_pk_bf16_f32 v187, v126, v127
v_mfma_f32_16x16x32_bf16 a[40:43], a[160:163], v[176:179], a[40:43]
v_exp_f32 v131, v131
v_mfma_f32_16x16x32_bf16 a[40:43], a[164:167], v[180:183], a[40:43]
buffer_load_dwordx4 v16, s[32:35], s64 offen offset:3072 sc1 lds
v_mfma_f32_16x16x32_bf16 a[72:75], a[164:167], v[204:207], a[72:75]
v_exp_f32 v144, v144
v_mfma_f32_16x16x32_bf16 a[72:75], a[160:163], v[200:203], a[72:75]
v_exp_f32 v145, v145
v_mfma_f32_16x16x32_bf16 a[104:107], a[160:163], v[208:211], a[104:107]
v_exp_f32 v146, v146
v_mfma_f32_16x16x32_bf16 a[104:107], a[164:167], v[212:215], a[104:107]
ds_read_b128 a[204:207], v3 offset:15360
v_cvt_pk_bf16_f32 v188, v128, v129
v_mfma_f32_16x16x32_bf16 a[108:111], a[172:175], v[212:215], a[108:111]
v_exp_f32 v147, v147
v_mfma_f32_16x16x32_bf16 a[108:111], a[168:171], v[208:211], a[108:111]
v_exp_f32 v148, v148
v_mfma_f32_16x16x32_bf16 a[76:79], a[168:171], v[200:203], a[76:79]
v_exp_f32 v149, v149
v_mfma_f32_16x16x32_bf16 a[76:79], a[172:175], v[204:207], a[76:79]
v_exp_f32 v150, v150
v_mfma_f32_16x16x32_bf16 a[44:47], a[172:175], v[180:183], a[44:47]
v_exp_f32 v151, v151
v_mfma_f32_16x16x32_bf16 a[44:47], a[168:171], v[176:179], a[44:47]
v_exp_f32 v132, v132
v_mfma_f32_16x16x32_bf16 a[48:51], a[176:179], v[176:179], a[48:51]
v_exp_f32 v133, v133
v_mfma_f32_16x16x32_bf16 a[48:51], a[180:183], v[180:183], a[48:51]
s_waitcnt vmcnt(9)
s_barrier
v_cvt_pk_bf16_f32 v189, v130, v131
v_mfma_f32_16x16x32_bf16 a[80:83], a[180:183], v[204:207], a[80:83]
s_xor_b32 s71, s71, 16384
ds_read_b128 a[144:147], v2 offset:16384
v_cvt_pk_bf16_f32 v196, v144, v145
v_mfma_f32_16x16x32_bf16 a[80:83], a[176:179], v[200:203], a[80:83]
s_add_u32 s70, s70, 32768
v_exp_f32 v134, v134
v_mfma_f32_16x16x32_bf16 a[112:115], a[176:179], v[208:211], a[112:115]
s_mov_b32 m0, s71
ds_read_b128 a[148:151], v2 offset:17408
v_cvt_pk_bf16_f32 v197, v146, v147
v_mfma_f32_16x16x32_bf16 a[112:115], a[180:183], v[212:215], a[112:115]
buffer_load_dwordx4 v16, s[32:35], s70 offen offset:0 sc1 lds
v_mfma_f32_16x16x32_bf16 a[116:119], a[188:191], v[212:215], a[116:119]
ds_read_b128 a[152:155], v2 offset:18432
v_cvt_pk_bf16_f32 v198, v148, v149
v_mfma_f32_16x16x32_bf16 a[116:119], a[184:187], v[208:211], a[116:119]
ds_read_b128 a[156:159], v2 offset:19456
v_cvt_pk_bf16_f32 v199, v150, v151
v_mfma_f32_16x16x32_bf16 a[84:87], a[184:187], v[200:203], a[84:87]
v_exp_f32 v135, v135
v_mfma_f32_16x16x32_bf16 a[84:87], a[188:191], v[204:207], a[84:87]
ds_read_b128 a[160:163], v2 offset:20480
v_cvt_pk_bf16_f32 v190, v132, v133
v_mfma_f32_16x16x32_bf16 a[52:55], a[188:191], v[180:183], a[52:55]
ds_read_b128 a[164:167], v2 offset:21504
v_cvt_pk_bf16_f32 v191, v134, v135
v_mfma_f32_16x16x32_bf16 a[52:55], a[184:187], v[176:179], a[52:55]
ds_read_b128 a[168:171], v2 offset:22528
v_accvgpr_read_b32 v21, a132
v_mfma_f32_16x16x32_bf16 a[56:59], a[192:195], v[176:179], a[56:59]
ds_read_b128 a[172:175], v2 offset:23552
v_max_f32 v1, v1, v21
v_mfma_f32_16x16x32_bf16 a[56:59], a[196:199], v[180:183], a[56:59]
v_rcp_f32 v21, v21
v_mfma_f32_16x16x32_bf16 a[88:91], a[196:199], v[204:207], a[88:91]
buffer_load_dwordx4 v16, s[32:35], s70 offen offset:1024 sc1 lds
v_mfma_f32_16x16x32_bf16 a[88:91], a[192:195], v[200:203], a[88:91]
v_accvgpr_read_b32 v232, a32
v_accvgpr_read_b32 v233, a33
v_mfma_f32_16x16x32_bf16 a[120:123], a[192:195], v[208:211], a[120:123]
v_accvgpr_read_b32 v234, a34
v_accvgpr_read_b32 v235, a35
v_mfma_f32_16x16x32_bf16 a[120:123], a[196:199], v[212:215], a[120:123]
s_waitcnt lgkmcnt(1)
v_accvgpr_read_b32 v236, a36
v_accvgpr_read_b32 v237, a37
v_mfma_f32_16x16x32_bf16 a[124:127], a[204:207], v[212:215], a[124:127]
v_accvgpr_read_b32 v238, a38
v_accvgpr_read_b32 v239, a39
v_mfma_f32_16x16x32_bf16 a[124:127], a[200:203], v[208:211], a[124:127]
v_mul_f32 v21, v21, v6
v_mul_f32 v232, v232, v21
v_mfma_f32_16x16x32_bf16 a[92:95], a[200:203], v[200:203], a[92:95]
v_mul_f32 v233, v233, v21
v_mul_f32 v234, v234, v21
v_mfma_f32_16x16x32_bf16 a[92:95], a[204:207], v[204:207], a[92:95]
v_mul_f32 v235, v235, v21
v_mul_f32 v236, v236, v21
v_mfma_f32_16x16x32_bf16 a[60:63], a[204:207], v[180:183], a[60:63]
v_mul_f32 v237, v237, v21
v_mul_f32 v238, v238, v21
v_mfma_f32_16x16x32_bf16 a[60:63], a[200:203], v[176:179], a[60:63]
v_mul_f32 v239, v239, v21
v_cvt_pk_bf16_f32 v232, v232, v233
v_mfma_f32_16x16x32_bf16 v[120:123], a[144:147], v[56:59], v[224:227]
ds_read_b128 a[176:179], v2 offset:24576
ds_read_b128 a[180:183], v2 offset:25600
v_mfma_f32_16x16x32_bf16 v[120:123], a[148:151], v[60:63], v[120:123]
ds_read_b128 a[184:187], v2 offset:26624
v_cvt_pk_bf16_f32 v233, v234, v235
v_mfma_f32_16x16x32_bf16 v[120:123], a[152:155], v[64:67], v[120:123]
buffer_load_dwordx4 v16, s[32:35], s70 offen offset:2048 sc1 lds
v_mfma_f32_16x16x32_bf16 v[120:123], a[156:159], v[68:71], v[120:123]
ds_read_b128 a[188:191], v2 offset:27648
ds_read_b128 a[192:195], v2 offset:28672
v_mfma_f32_16x16x32_bf16 v[136:139], a[156:159], v[84:87], v[228:231]
ds_read_b128 a[196:199], v2 offset:29696
v_cvt_pk_bf16_f32 v234, v236, v237
v_mfma_f32_16x16x32_bf16 v[136:139], a[152:155], v[80:83], v[136:139]
buffer_load_dwordx4 v16, s[32:35], s70 offen offset:3072 sc1 lds
v_mfma_f32_16x16x32_bf16 v[136:139], a[148:151], v[76:79], v[136:139]
ds_read_b128 a[200:203], v2 offset:30720
ds_read_b128 a[204:207], v2 offset:31744
v_mfma_f32_16x16x32_bf16 v[136:139], a[144:147], v[72:75], v[136:139]
v_exp_f32 v120, v120
v_mfma_f32_16x16x32_bf16 v[140:143], a[160:163], v[72:75], v[228:231]
v_exp_f32 v121, v121
v_mfma_f32_16x16x32_bf16 v[140:143], a[164:167], v[76:79], v[140:143]
s_add_u32 m0, s71, 4096
v_exp_f32 v122, v122
v_mfma_f32_16x16x32_bf16 v[140:143], a[168:171], v[80:83], v[140:143]
s_waitcnt lgkmcnt(2)
v_cvt_pk_bf16_f32 v235, v238, v239
s_add_u32 s77, s74, 4096
buffer_store_dwordx4 v[232:235], v16, s[44:47], s77 offen sc1
v_accvgpr_read_b32 v240, a40
v_accvgpr_read_b32 v241, a41
v_accvgpr_read_b32 v242, a42
v_accvgpr_read_b32 v243, a43
v_accvgpr_read_b32 v244, a44
v_accvgpr_read_b32 v245, a45
v_accvgpr_read_b32 v246, a46
v_accvgpr_read_b32 v247, a47
v_mul_f32 v240, v240, v21
v_mul_f32 v241, v241, v21
v_mul_f32 v242, v242, v21
v_mul_f32 v243, v243, v21
v_mul_f32 v244, v244, v21
v_mul_f32 v245, v245, v21
v_mul_f32 v246, v246, v21
v_mul_f32 v247, v247, v21
v_cvt_pk_bf16_f32 v240, v240, v241
v_cvt_pk_bf16_f32 v241, v242, v243
v_cvt_pk_bf16_f32 v242, v244, v245
v_cvt_pk_bf16_f32 v243, v246, v247
s_add_u32 s77, s74, 12288
buffer_store_dwordx4 v[240:243], v16, s[44:47], s77 offen sc1
v_accvgpr_read_b32 v232, a48
v_accvgpr_read_b32 v233, a49
v_accvgpr_read_b32 v234, a50
v_accvgpr_read_b32 v235, a51
v_accvgpr_read_b32 v236, a52
v_accvgpr_read_b32 v237, a53
v_accvgpr_read_b32 v238, a54
v_accvgpr_read_b32 v239, a55
v_mul_f32 v232, v232, v21
v_mul_f32 v233, v233, v21
v_mul_f32 v234, v234, v21
v_mul_f32 v235, v235, v21
v_mul_f32 v236, v236, v21
v_mul_f32 v237, v237, v21
v_mul_f32 v238, v238, v21
v_mul_f32 v239, v239, v21
v_cvt_pk_bf16_f32 v232, v232, v233
v_cvt_pk_bf16_f32 v233, v234, v235
v_cvt_pk_bf16_f32 v234, v236, v237
v_cvt_pk_bf16_f32 v235, v238, v239
s_add_u32 s77, s74, 20480
buffer_store_dwordx4 v[232:235], v16, s[44:47], s77 offen sc1
v_accvgpr_read_b32 v240, a56
v_accvgpr_read_b32 v241, a57
v_accvgpr_read_b32 v242, a58
v_accvgpr_read_b32 v243, a59
v_accvgpr_read_b32 v244, a60
v_accvgpr_read_b32 v245, a61
v_accvgpr_read_b32 v246, a62
v_accvgpr_read_b32 v247, a63
v_mul_f32 v240, v240, v21
v_mul_f32 v241, v241, v21
v_mul_f32 v242, v242, v21
v_mul_f32 v243, v243, v21
v_mul_f32 v244, v244, v21
v_mul_f32 v245, v245, v21
v_mul_f32 v246, v246, v21
v_mul_f32 v247, v247, v21
v_cvt_pk_bf16_f32 v240, v240, v241
v_cvt_pk_bf16_f32 v241, v242, v243
v_cvt_pk_bf16_f32 v242, v244, v245
v_cvt_pk_bf16_f32 v243, v246, v247
s_add_u32 s77, s74, 28672
buffer_store_dwordx4 v[240:243], v16, s[44:47], s77 offen sc1
v_exp_f32 v123, v123
v_mfma_f32_16x16x32_bf16 v[140:143], a[172:175], v[84:87], v[140:143]
v_exp_f32 v136, v136
v_mfma_f32_16x16x32_bf16 v[124:127], a[172:175], v[68:71], v[224:227]
ds_read_b128 a[144:147], v3 offset:16384
v_cvt_pk_bf16_f32 v200, v120, v121
v_mfma_f32_16x16x32_bf16 v[124:127], a[168:171], v[64:67], v[124:127]
s_add_u32 s64, s70, 4096
v_exp_f32 v137, v137
v_mfma_f32_16x16x32_bf16 v[124:127], a[164:167], v[60:63], v[124:127]
ds_read_b128 a[148:151], v3 offset:24576
v_cvt_pk_bf16_f32 v201, v122, v123
v_mfma_f32_16x16x32_bf16 v[124:127], a[160:163], v[56:59], v[124:127]
v_exp_f32 v138, v138
v_mfma_f32_16x16x32_bf16 v[128:131], a[176:179], v[56:59], v[224:227]
ds_read_b128 a[152:155], v3 offset:17408
v_cvt_pk_bf16_f32 v208, v136, v137
v_mfma_f32_16x16x32_bf16 v[128:131], a[180:183], v[60:63], v[128:131]
v_exp_f32 v139, v139
v_mfma_f32_16x16x32_bf16 v[128:131], a[184:187], v[64:67], v[128:131]
ds_read_b128 a[156:159], v3 offset:25600
v_cvt_pk_bf16_f32 v209, v138, v139
v_mfma_f32_16x16x32_bf16 v[128:131], a[188:191], v[68:71], v[128:131]
v_exp_f32 v140, v140
v_mfma_f32_16x16x32_bf16 v[144:147], a[188:191], v[84:87], v[228:231]
buffer_load_dwordx4 v16, s[32:35], s64 offen offset:0 sc1 lds
v_mfma_f32_16x16x32_bf16 v[144:147], a[184:187], v[80:83], v[144:147]
v_exp_f32 v141, v141
v_mfma_f32_16x16x32_bf16 v[144:147], a[180:183], v[76:79], v[144:147]
ds_read_b128 a[160:163], v3 offset:18432
v_cvt_pk_bf16_f32 v210, v140, v141
v_mfma_f32_16x16x32_bf16 v[144:147], a[176:179], v[72:75], v[144:147]
v_exp_f32 v142, v142
v_mfma_f32_16x16x32_bf16 v[148:151], a[192:195], v[72:75], v[228:231]
ds_read_b128 a[164:167], v3 offset:26624
ds_read_b128 a[168:171], v3 offset:19456
v_mfma_f32_16x16x32_bf16 v[148:151], a[196:199], v[76:79], v[148:151]
s_waitcnt lgkmcnt(3)
v_exp_f32 v143, v143
v_mfma_f32_16x16x32_bf16 v[148:151], a[200:203], v[80:83], v[148:151]
ds_read_b128 a[172:175], v3 offset:27648
v_cvt_pk_bf16_f32 v211, v142, v143
v_mfma_f32_16x16x32_bf16 v[148:151], a[204:207], v[84:87], v[148:151]
v_exp_f32 v124, v124
v_mfma_f32_16x16x32_bf16 v[132:135], a[204:207], v[68:71], v[224:227]
buffer_load_dwordx4 v16, s[32:35], s64 offen offset:1024 sc1 lds
v_mfma_f32_16x16x32_bf16 v[132:135], a[200:203], v[64:67], v[132:135]
v_exp_f32 v125, v125
v_mfma_f32_16x16x32_bf16 v[132:135], a[196:199], v[60:63], v[132:135]
ds_read_b128 a[176:179], v3 offset:20480
v_cvt_pk_bf16_f32 v202, v124, v125
v_mfma_f32_16x16x32_bf16 v[132:135], a[192:195], v[56:59], v[132:135]
v_exp_f32 v126, v126
v_mfma_f32_16x16x32_bf16 a[136:139], a[244:247], v[184:187], a[136:139]
ds_read_b128 a[180:183], v3 offset:28672
ds_read_b128 a[184:187], v3 offset:21504
v_mfma_f32_16x16x32_bf16 a[136:139], a[244:247], v[188:191], a[136:139]
v_exp_f32 v127, v127
v_mfma_f32_16x16x32_bf16 a[140:143], a[244:247], v[192:195], a[140:143]
ds_read_b128 a[188:191], v3 offset:29696
v_cvt_pk_bf16_f32 v203, v126, v127
v_mfma_f32_16x16x32_bf16 a[140:143], a[244:247], v[196:199], a[140:143]
v_exp_f32 v128, v128
v_mfma_f32_16x16x32_bf16 a[64:67], a[144:147], v[184:187], a[64:67]
buffer_load_dwordx4 v16, s[32:35], s64 offen offset:2048 sc1 lds
v_mfma_f32_16x16x32_bf16 a[64:67], a[148:151], v[188:191], a[64:67]
v_exp_f32 v129, v129
v_mfma_f32_16x16x32_bf16 a[96:99], a[148:151], v[196:199], a[96:99]
ds_read_b128 a[192:195], v3 offset:22528
v_cvt_pk_bf16_f32 v204, v128, v129
v_mfma_f32_16x16x32_bf16 a[96:99], a[144:147], v[192:195], a[96:99]
v_exp_f32 v130, v130
v_mfma_f32_16x16x32_bf16 a[100:103], a[152:155], v[192:195], a[100:103]
ds_read_b128 a[196:199], v3 offset:30720
v_xor_b32 v2, 0x8000, v2
v_mfma_f32_16x16x32_bf16 a[100:103], a[156:159], v[196:199], a[100:103]
v_exp_f32 v131, v131
v_mfma_f32_16x16x32_bf16 a[68:71], a[156:159], v[188:191], a[68:71]
ds_read_b128 a[200:203], v3 offset:23552
v_cvt_pk_bf16_f32 v205, v130, v131
v_mfma_f32_16x16x32_bf16 a[68:71], a[152:155], v[184:187], a[68:71]
s_waitcnt lgkmcnt(3)
v_exp_f32 v144, v144
v_mfma_f32_16x16x32_bf16 a[72:75], a[160:163], v[184:187], a[72:75]
buffer_load_dwordx4 v16, s[32:35], s64 offen offset:3072 sc1 lds
v_mfma_f32_16x16x32_bf16 a[72:75], a[164:167], v[188:191], a[72:75]
s_xor_b32 s71, s71, 49152
v_exp_f32 v145, v145
v_mfma_f32_16x16x32_bf16 a[104:107], a[164:167], v[196:199], a[104:107]
ds_read_b128 a[204:207], v3 offset:31744
v_cvt_pk_bf16_f32 v212, v144, v145
v_mfma_f32_16x16x32_bf16 a[104:107], a[160:163], v[192:195], a[104:107]
v_exp_f32 v146, v146
v_mfma_f32_16x16x32_bf16 a[108:111], a[168:171], v[192:195], a[108:111]
s_waitcnt vmcnt(12)
s_barrier
v_mfma_f32_16x16x32_bf16 a[108:111], a[172:175], v[196:199], a[108:111]
s_add_u32 s70, s70, 32768
v_exp_f32 v147, v147
v_mfma_f32_16x16x32_bf16 a[76:79], a[172:175], v[188:191], a[76:79]
ds_read_b128 a[144:147], v2 offset:0
v_cvt_pk_bf16_f32 v213, v146, v147
v_mfma_f32_16x16x32_bf16 a[76:79], a[168:171], v[184:187], a[76:79]
v_exp_f32 v148, v148
v_mfma_f32_16x16x32_bf16 a[80:83], a[176:179], v[184:187], a[80:83]
ds_read_b128 a[148:151], v2 offset:1024
v_xor_b32 v3, 0x8000, v3
v_mfma_f32_16x16x32_bf16 a[80:83], a[180:183], v[188:191], a[80:83]
s_mov_b32 m0, s71
v_exp_f32 v149, v149
v_mfma_f32_16x16x32_bf16 a[112:115], a[180:183], v[196:199], a[112:115]
ds_read_b128 a[152:155], v2 offset:2048
v_cvt_pk_bf16_f32 v214, v148, v149
v_mfma_f32_16x16x32_bf16 a[112:115], a[176:179], v[192:195], a[112:115]
v_exp_f32 v150, v150
v_mfma_f32_16x16x32_bf16 a[116:119], a[184:187], v[192:195], a[116:119]
buffer_load_dwordx4 v16, s[32:35], s70 offen offset:0 sc1 lds
v_mfma_f32_16x16x32_bf16 a[116:119], a[188:191], v[196:199], a[116:119]
v_exp_f32 v151, v151
v_mfma_f32_16x16x32_bf16 a[84:87], a[188:191], v[188:191], a[84:87]
ds_read_b128 a[156:159], v2 offset:3072
v_cvt_pk_bf16_f32 v215, v150, v151
v_mfma_f32_16x16x32_bf16 a[84:87], a[184:187], v[184:187], a[84:87]
s_waitcnt lgkmcnt(2)
v_exp_f32 v132, v132
v_mfma_f32_16x16x32_bf16 a[88:91], a[192:195], v[184:187], a[88:91]
ds_read_b128 a[160:163], v2 offset:4096
v_mfma_f32_16x16x32_bf16 a[88:91], a[196:199], v[188:191], a[88:91]
v_exp_f32 v133, v133
v_mfma_f32_16x16x32_bf16 a[120:123], a[196:199], v[196:199], a[120:123]
ds_read_b128 a[164:167], v2 offset:5120
v_cvt_pk_bf16_f32 v206, v132, v133
v_mfma_f32_16x16x32_bf16 a[120:123], a[192:195], v[192:195], a[120:123]
v_exp_f32 v134, v134
v_mfma_f32_16x16x32_bf16 a[124:127], a[200:203], v[192:195], a[124:127]
buffer_load_dwordx4 v16, s[32:35], s70 offen offset:1024 sc1 lds
v_mfma_f32_16x16x32_bf16 a[124:127], a[204:207], v[196:199], a[124:127]
v_exp_f32 v135, v135
v_mfma_f32_16x16x32_bf16 a[92:95], a[204:207], v[188:191], a[92:95]
ds_read_b128 a[168:171], v2 offset:6144
v_cvt_pk_bf16_f32 v207, v134, v135
v_mfma_f32_16x16x32_bf16 a[92:95], a[200:203], v[184:187], a[92:95]
ds_read_b128 a[172:175], v2 offset:7168
s_lshl_b32 s72, s3, 1
s_sub_u32 s72, 13, s72
.p2align 3
L_S:
s_waitcnt lgkmcnt(7)
v_mfma_f32_16x16x32_bf16 v[120:123], a[144:147], v[56:59], v[224:227]
s_waitcnt lgkmcnt(6)
ds_read_b128 a[176:179], v2 offset:8192
ds_read_b128 a[180:183], v2 offset:9216
v_mfma_f32_16x16x32_bf16 v[120:123], a[148:151], v[60:63], v[120:123]
s_waitcnt lgkmcnt(7)
ds_read_b128 a[184:187], v2 offset:10240
v_mfma_f32_16x16x32_bf16 v[120:123], a[152:155], v[64:67], v[120:123]
s_waitcnt lgkmcnt(7)
buffer_load_dwordx4 v16, s[32:35], s70 offen offset:2048 sc1 lds
v_mfma_f32_16x16x32_bf16 v[120:123], a[156:159], v[68:71], v[120:123]
ds_read_b128 a[188:191], v2 offset:11264
ds_read_b128 a[192:195], v2 offset:12288
v_mfma_f32_16x16x32_bf16 v[136:139], a[156:159], v[84:87], v[228:231]
ds_read_b128 a[196:199], v2 offset:13312
v_mfma_f32_16x16x32_bf16 v[136:139], a[152:155], v[80:83], v[136:139]
buffer_load_dwordx4 v16, s[32:35], s70 offen offset:3072 sc1 lds
v_mfma_f32_16x16x32_bf16 v[136:139], a[148:151], v[76:79], v[136:139]
ds_read_b128 a[200:203], v2 offset:14336
ds_read_b128 a[204:207], v2 offset:15360
v_mfma_f32_16x16x32_bf16 v[136:139], a[144:147], v[72:75], v[136:139]
s_waitcnt lgkmcnt(5)
v_exp_f32 v120, v120
v_mfma_f32_16x16x32_bf16 v[140:143], a[160:163], v[72:75], v[228:231]
v_exp_f32 v121, v121
v_mfma_f32_16x16x32_bf16 v[140:143], a[164:167], v[76:79], v[140:143]
s_add_u32 m0, s71, 4096
v_exp_f32 v122, v122
v_mfma_f32_16x16x32_bf16 v[140:143], a[168:171], v[80:83], v[140:143]
v_exp_f32 v123, v123
v_mfma_f32_16x16x32_bf16 v[140:143], a[172:175], v[84:87], v[140:143]
v_exp_f32 v136, v136
v_mfma_f32_16x16x32_bf16 v[124:127], a[172:175], v[68:71], v[224:227]
ds_read_b128 a[144:147], v3 offset:0
v_cvt_pk_bf16_f32 v184, v120, v121
v_mfma_f32_16x16x32_bf16 v[124:127], a[168:171], v[64:67], v[124:127]
s_add_u32 s64, s70, 4096
v_exp_f32 v137, v137
v_mfma_f32_16x16x32_bf16 v[124:127], a[164:167], v[60:63], v[124:127]
ds_read_b128 a[148:151], v3 offset:8192
v_cvt_pk_bf16_f32 v185, v122, v123
v_mfma_f32_16x16x32_bf16 v[124:127], a[160:163], v[56:59], v[124:127]
v_exp_f32 v138, v138
v_mfma_f32_16x16x32_bf16 v[128:131], a[176:179], v[56:59], v[224:227]
ds_read_b128 a[152:155], v3 offset:1024
v_cvt_pk_bf16_f32 v192, v136, v137
v_mfma_f32_16x16x32_bf16 v[128:131], a[180:183], v[60:63], v[128:131]
v_exp_f32 v139, v139
v_mfma_f32_16x16x32_bf16 v[128:131], a[184:187], v[64:67], v[128:131]
s_waitcnt lgkmcnt(2)
ds_read_b128 a[156:159], v3 offset:9216
v_cvt_pk_bf16_f32 v193, v138, v139
v_mfma_f32_16x16x32_bf16 v[128:131], a[188:191], v[68:71], v[128:131]
v_exp_f32 v140, v140
v_mfma_f32_16x16x32_bf16 v[144:147], a[188:191], v[84:87], v[228:231]
buffer_load_dwordx4 v16, s[32:35], s64 offen offset:0 sc1 lds
v_mfma_f32_16x16x32_bf16 v[144:147], a[184:187], v[80:83], v[144:147]
v_exp_f32 v141, v141
v_mfma_f32_16x16x32_bf16 v[144:147], a[180:183], v[76:79], v[144:147]
ds_read_b128 a[160:163], v3 offset:2048
v_cvt_pk_bf16_f32 v194, v140, v141
v_mfma_f32_16x16x32_bf16 v[144:147], a[176:179], v[72:75], v[144:147]
v_exp_f32 v142, v142
v_mfma_f32_16x16x32_bf16 v[148:151], a[192:195], v[72:75], v[228:231]
ds_read_b128 a[164:167], v3 offset:10240
ds_read_b128 a[168:171], v3 offset:3072
v_mfma_f32_16x16x32_bf16 v[148:151], a[196:199], v[76:79], v[148:151]
v_exp_f32 v143, v143
v_mfma_f32_16x16x32_bf16 v[148:151], a[200:203], v[80:83], v[148:151]
ds_read_b128 a[172:175], v3 offset:11264
v_cvt_pk_bf16_f32 v195, v142, v143
v_mfma_f32_16x16x32_bf16 v[148:151], a[204:207], v[84:87], v[148:151]
v_exp_f32 v124, v124
v_mfma_f32_16x16x32_bf16 v[132:135], a[204:207], v[68:71], v[224:227]
buffer_load_dwordx4 v16, s[32:35], s64 offen offset:1024 sc1 lds
v_mfma_f32_16x16x32_bf16 v[132:135], a[200:203], v[64:67], v[132:135]
v_exp_f32 v125, v125
v_mfma_f32_16x16x32_bf16 v[132:135], a[196:199], v[60:63], v[132:135]
ds_read_b128 a[176:179], v3 offset:4096
v_cvt_pk_bf16_f32 v186, v124, v125
v_mfma_f32_16x16x32_bf16 v[132:135], a[192:195], v[56:59], v[132:135]
v_exp_f32 v126, v126
v_mfma_f32_16x16x32_bf16 a[136:139], a[244:247], v[200:203], a[136:139]
ds_read_b128 a[180:183], v3 offset:12288
ds_read_b128 a[184:187], v3 offset:5120
v_mfma_f32_16x16x32_bf16 a[136:139], a[244:247], v[204:207], a[136:139]
v_exp_f32 v127, v127
v_mfma_f32_16x16x32_bf16 a[140:143], a[244:247], v[208:211], a[140:143]
ds_read_b128 a[188:191], v3 offset:13312
v_cvt_pk_bf16_f32 v187, v126, v127
v_mfma_f32_16x16x32_bf16 a[140:143], a[244:247], v[212:215], a[140:143]
v_exp_f32 v128, v128
v_mfma_f32_16x16x32_bf16 a[64:67], a[144:147], v[200:203], a[64:67]
s_waitcnt lgkmcnt(3)
buffer_load_dwordx4 v16, s[32:35], s64 offen offset:2048 sc1 lds
v_mfma_f32_16x16x32_bf16 a[64:67], a[148:151], v[204:207], a[64:67]
v_exp_f32 v129, v129
v_mfma_f32_16x16x32_bf16 a[96:99], a[148:151], v[212:215], a[96:99]
ds_read_b128 a[192:195], v3 offset:6144
v_cvt_pk_bf16_f32 v188, v128, v129
v_mfma_f32_16x16x32_bf16 a[96:99], a[144:147], v[208:211], a[96:99]
v_exp_f32 v130, v130
v_mfma_f32_16x16x32_bf16 a[100:103], a[152:155], v[208:211], a[100:103]
ds_read_b128 a[196:199], v3 offset:14336
v_mfma_f32_16x16x32_bf16 a[100:103], a[156:159], v[212:215], a[100:103]
v_exp_f32 v131, v131
v_mfma_f32_16x16x32_bf16 a[68:71], a[156:159], v[204:207], a[68:71]
ds_read_b128 a[200:203], v3 offset:7168
v_cvt_pk_bf16_f32 v189, v130, v131
v_mfma_f32_16x16x32_bf16 a[68:71], a[152:155], v[200:203], a[68:71]
v_exp_f32 v144, v144
v_mfma_f32_16x16x32_bf16 a[72:75], a[160:163], v[200:203], a[72:75]
buffer_load_dwordx4 v16, s[32:35], s64 offen offset:3072 sc1 lds
v_mfma_f32_16x16x32_bf16 a[72:75], a[164:167], v[204:207], a[72:75]
s_xor_b32 s71, s71, 16384
v_exp_f32 v145, v145
v_mfma_f32_16x16x32_bf16 a[104:107], a[164:167], v[212:215], a[104:107]
ds_read_b128 a[204:207], v3 offset:15360
v_cvt_pk_bf16_f32 v196, v144, v145
v_mfma_f32_16x16x32_bf16 a[104:107], a[160:163], v[208:211], a[104:107]
v_exp_f32 v146, v146
v_mfma_f32_16x16x32_bf16 a[108:111], a[168:171], v[208:211], a[108:111]
s_waitcnt vmcnt(8)
s_barrier
v_mfma_f32_16x16x32_bf16 a[108:111], a[172:175], v[212:215], a[108:111]
s_add_u32 s70, s70, 32768
v_exp_f32 v147, v147
v_mfma_f32_16x16x32_bf16 a[76:79], a[172:175], v[204:207], a[76:79]
ds_read_b128 a[144:147], v2 offset:16384
v_cvt_pk_bf16_f32 v197, v146, v147
v_mfma_f32_16x16x32_bf16 a[76:79], a[168:171], v[200:203], a[76:79]
v_exp_f32 v148, v148
v_mfma_f32_16x16x32_bf16 a[80:83], a[176:179], v[200:203], a[80:83]
s_waitcnt lgkmcnt(1)
ds_read_b128 a[148:151], v2 offset:17408
v_mfma_f32_16x16x32_bf16 a[80:83], a[180:183], v[204:207], a[80:83]
s_mov_b32 m0, s71
v_exp_f32 v149, v149
v_mfma_f32_16x16x32_bf16 a[112:115], a[180:183], v[212:215], a[112:115]
ds_read_b128 a[152:155], v2 offset:18432
v_cvt_pk_bf16_f32 v198, v148, v149
v_mfma_f32_16x16x32_bf16 a[112:115], a[176:179], v[208:211], a[112:115]
v_exp_f32 v150, v150
v_mfma_f32_16x16x32_bf16 a[116:119], a[184:187], v[208:211], a[116:119]
buffer_load_dwordx4 v16, s[32:35], s70 offen offset:0 sc1 lds
v_mfma_f32_16x16x32_bf16 a[116:119], a[188:191], v[212:215], a[116:119]
v_exp_f32 v151, v151
v_mfma_f32_16x16x32_bf16 a[84:87], a[188:191], v[204:207], a[84:87]
ds_read_b128 a[156:159], v2 offset:19456
v_cvt_pk_bf16_f32 v199, v150, v151
v_mfma_f32_16x16x32_bf16 a[84:87], a[184:187], v[200:203], a[84:87]
v_exp_f32 v132, v132
v_mfma_f32_16x16x32_bf16 a[88:91], a[192:195], v[200:203], a[88:91]
ds_read_b128 a[160:163], v2 offset:20480
v_mfma_f32_16x16x32_bf16 a[88:91], a[196:199], v[204:207], a[88:91]
v_exp_f32 v133, v133
v_mfma_f32_16x16x32_bf16 a[120:123], a[196:199], v[212:215], a[120:123]
ds_read_b128 a[164:167], v2 offset:21504
v_cvt_pk_bf16_f32 v190, v132, v133
v_mfma_f32_16x16x32_bf16 a[120:123], a[192:195], v[208:211], a[120:123]
v_exp_f32 v134, v134
v_mfma_f32_16x16x32_bf16 a[124:127], a[200:203], v[208:211], a[124:127]
buffer_load_dwordx4 v16, s[32:35], s70 offen offset:1024 sc1 lds
v_mfma_f32_16x16x32_bf16 a[124:127], a[204:207], v[212:215], a[124:127]
v_exp_f32 v135, v135
v_mfma_f32_16x16x32_bf16 a[92:95], a[204:207], v[204:207], a[92:95]
ds_read_b128 a[168:171], v2 offset:22528
v_cvt_pk_bf16_f32 v191, v134, v135
v_mfma_f32_16x16x32_bf16 a[92:95], a[200:203], v[200:203], a[92:95]
s_waitcnt lgkmcnt(2)
ds_read_b128 a[172:175], v2 offset:23552
v_mfma_f32_16x16x32_bf16 v[120:123], a[144:147], v[56:59], v[224:227]
ds_read_b128 a[176:179], v2 offset:24576
ds_read_b128 a[180:183], v2 offset:25600
v_mfma_f32_16x16x32_bf16 v[120:123], a[148:151], v[60:63], v[120:123]
ds_read_b128 a[184:187], v2 offset:26624
v_mfma_f32_16x16x32_bf16 v[120:123], a[152:155], v[64:67], v[120:123]
buffer_load_dwordx4 v16, s[32:35], s70 offen offset:2048 sc1 lds
v_mfma_f32_16x16x32_bf16 v[120:123], a[156:159], v[68:71], v[120:123]
ds_read_b128 a[188:191], v2 offset:27648
ds_read_b128 a[192:195], v2 offset:28672
v_mfma_f32_16x16x32_bf16 v[136:139], a[156:159], v[84:87], v[228:231]
ds_read_b128 a[196:199], v2 offset:29696
v_mfma_f32_16x16x32_bf16 v[136:139], a[152:155], v[80:83], v[136:139]
buffer_load_dwordx4 v16, s[32:35], s70 offen offset:3072 sc1 lds
v_mfma_f32_16x16x32_bf16 v[136:139], a[148:151], v[76:79], v[136:139]
ds_read_b128 a[200:203], v2 offset:30720
ds_read_b128 a[204:207], v2 offset:31744
v_mfma_f32_16x16x32_bf16 v[136:139], a[144:147], v[72:75], v[136:139]
v_exp_f32 v120, v120
v_mfma_f32_16x16x32_bf16 v[140:143], a[160:163], v[72:75], v[228:231]
s_waitcnt lgkmcnt(5)
v_exp_f32 v121, v121
v_mfma_f32_16x16x32_bf16 v[140:143], a[164:167], v[76:79], v[140:143]
s_add_u32 m0, s71, 4096
v_exp_f32 v122, v122
v_mfma_f32_16x16x32_bf16 v[140:143], a[168:171], v[80:83], v[140:143]
v_exp_f32 v123, v123
v_mfma_f32_16x16x32_bf16 v[140:143], a[172:175], v[84:87], v[140:143]
v_exp_f32 v136, v136
v_mfma_f32_16x16x32_bf16 v[124:127], a[172:175], v[68:71], v[224:227]
ds_read_b128 a[144:147], v3 offset:16384
v_cvt_pk_bf16_f32 v200, v120, v121
v_mfma_f32_16x16x32_bf16 v[124:127], a[168:171], v[64:67], v[124:127]
s_add_u32 s64, s70, 4096
v_exp_f32 v137, v137
v_mfma_f32_16x16x32_bf16 v[124:127], a[164:167], v[60:63], v[124:127]
ds_read_b128 a[148:151], v3 offset:24576
v_cvt_pk_bf16_f32 v201, v122, v123
v_mfma_f32_16x16x32_bf16 v[124:127], a[160:163], v[56:59], v[124:127]
v_exp_f32 v138, v138
v_mfma_f32_16x16x32_bf16 v[128:131], a[176:179], v[56:59], v[224:227]
ds_read_b128 a[152:155], v3 offset:17408
v_cvt_pk_bf16_f32 v208, v136, v137
v_mfma_f32_16x16x32_bf16 v[128:131], a[180:183], v[60:63], v[128:131]
v_exp_f32 v139, v139
v_mfma_f32_16x16x32_bf16 v[128:131], a[184:187], v[64:67], v[128:131]
s_waitcnt lgkmcnt(2)
ds_read_b128 a[156:159], v3 offset:25600
v_cvt_pk_bf16_f32 v209, v138, v139
v_mfma_f32_16x16x32_bf16 v[128:131], a[188:191], v[68:71], v[128:131]
v_exp_f32 v140, v140
v_mfma_f32_16x16x32_bf16 v[144:147], a[188:191], v[84:87], v[228:231]
buffer_load_dwordx4 v16, s[32:35], s64 offen offset:0 sc1 lds
v_mfma_f32_16x16x32_bf16 v[144:147], a[184:187], v[80:83], v[144:147]
v_exp_f32 v141, v141
v_mfma_f32_16x16x32_bf16 v[144:147], a[180:183], v[76:79], v[144:147]
ds_read_b128 a[160:163], v3 offset:18432
v_cvt_pk_bf16_f32 v210, v140, v141
v_mfma_f32_16x16x32_bf16 v[144:147], a[176:179], v[72:75], v[144:147]
v_exp_f32 v142, v142
v_mfma_f32_16x16x32_bf16 v[148:151], a[192:195], v[72:75], v[228:231]
ds_read_b128 a[164:167], v3 offset:26624
ds_read_b128 a[168:171], v3 offset:19456
v_mfma_f32_16x16x32_bf16 v[148:151], a[196:199], v[76:79], v[148:151]
v_exp_f32 v143, v143
v_mfma_f32_16x16x32_bf16 v[148:151], a[200:203], v[80:83], v[148:151]
ds_read_b128 a[172:175], v3 offset:27648
v_cvt_pk_bf16_f32 v211, v142, v143
v_mfma_f32_16x16x32_bf16 v[148:151], a[204:207], v[84:87], v[148:151]
v_exp_f32 v124, v124
v_mfma_f32_16x16x32_bf16 v[132:135], a[204:207], v[68:71], v[224:227]
buffer_load_dwordx4 v16, s[32:35], s64 offen offset:1024 sc1 lds
v_mfma_f32_16x16x32_bf16 v[132:135], a[200:203], v[64:67], v[132:135]
v_exp_f32 v125, v125
v_mfma_f32_16x16x32_bf16 v[132:135], a[196:199], v[60:63], v[132:135]
ds_read_b128 a[176:179], v3 offset:20480
v_cvt_pk_bf16_f32 v202, v124, v125
v_mfma_f32_16x16x32_bf16 v[132:135], a[192:195], v[56:59], v[132:135]
v_exp_f32 v126, v126
v_mfma_f32_16x16x32_bf16 a[136:139], a[244:247], v[184:187], a[136:139]
ds_read_b128 a[180:183], v3 offset:28672
ds_read_b128 a[184:187], v3 offset:21504
v_mfma_f32_16x16x32_bf16 a[136:139], a[244:247], v[188:191], a[136:139]
v_exp_f32 v127, v127
v_mfma_f32_16x16x32_bf16 a[140:143], a[244:247], v[192:195], a[140:143]
ds_read_b128 a[188:191], v3 offset:29696
v_cvt_pk_bf16_f32 v203, v126, v127
v_mfma_f32_16x16x32_bf16 a[140:143], a[244:247], v[196:199], a[140:143]
v_exp_f32 v128, v128
v_mfma_f32_16x16x32_bf16 a[64:67], a[144:147], v[184:187], a[64:67]
s_waitcnt lgkmcnt(3)
buffer_load_dwordx4 v16, s[32:35], s64 offen offset:2048 sc1 lds
v_mfma_f32_16x16x32_bf16 a[64:67], a[148:151], v[188:191], a[64:67]
v_exp_f32 v129, v129
v_mfma_f32_16x16x32_bf16 a[96:99], a[148:151], v[196:199], a[96:99]
ds_read_b128 a[192:195], v3 offset:22528
v_cvt_pk_bf16_f32 v204, v128, v129
v_mfma_f32_16x16x32_bf16 a[96:99], a[144:147], v[192:195], a[96:99]
v_exp_f32 v130, v130
v_mfma_f32_16x16x32_bf16 a[100:103], a[152:155], v[192:195], a[100:103]
ds_read_b128 a[196:199], v3 offset:30720
v_xor_b32 v2, 0x8000, v2
v_mfma_f32_16x16x32_bf16 a[100:103], a[156:159], v[196:199], a[100:103]
v_exp_f32 v131, v131
v_mfma_f32_16x16x32_bf16 a[68:71], a[156:159], v[188:191], a[68:71]
ds_read_b128 a[200:203], v3 offset:23552
v_cvt_pk_bf16_f32 v205, v130, v131
v_mfma_f32_16x16x32_bf16 a[68:71], a[152:155], v[184:187], a[68:71]
v_exp_f32 v144, v144
v_mfma_f32_16x16x32_bf16 a[72:75], a[160:163], v[184:187], a[72:75]
buffer_load_dwordx4 v16, s[32:35], s64 offen offset:3072 sc1 lds
v_mfma_f32_16x16x32_bf16 a[72:75], a[164:167], v[188:191], a[72:75]
s_xor_b32 s71, s71, 49152
v_exp_f32 v145, v145
v_mfma_f32_16x16x32_bf16 a[104:107], a[164:167], v[196:199], a[104:107]
ds_read_b128 a[204:207], v3 offset:31744
v_cvt_pk_bf16_f32 v212, v144, v145
v_mfma_f32_16x16x32_bf16 a[104:107], a[160:163], v[192:195], a[104:107]
v_exp_f32 v146, v146
v_mfma_f32_16x16x32_bf16 a[108:111], a[168:171], v[192:195], a[108:111]
s_waitcnt vmcnt(8)
s_barrier
v_mfma_f32_16x16x32_bf16 a[108:111], a[172:175], v[196:199], a[108:111]
s_add_u32 s70, s70, 32768
v_exp_f32 v147, v147
v_mfma_f32_16x16x32_bf16 a[76:79], a[172:175], v[188:191], a[76:79]
ds_read_b128 a[144:147], v2 offset:0
v_cvt_pk_bf16_f32 v213, v146, v147
v_mfma_f32_16x16x32_bf16 a[76:79], a[168:171], v[184:187], a[76:79]
v_exp_f32 v148, v148
v_mfma_f32_16x16x32_bf16 a[80:83], a[176:179], v[184:187], a[80:83]
s_waitcnt lgkmcnt(1)
ds_read_b128 a[148:151], v2 offset:1024
v_xor_b32 v3, 0x8000, v3
v_mfma_f32_16x16x32_bf16 a[80:83], a[180:183], v[188:191], a[80:83]
s_mov_b32 m0, s71
v_exp_f32 v149, v149
v_mfma_f32_16x16x32_bf16 a[112:115], a[180:183], v[196:199], a[112:115]
ds_read_b128 a[152:155], v2 offset:2048
v_cvt_pk_bf16_f32 v214, v148, v149
v_mfma_f32_16x16x32_bf16 a[112:115], a[176:179], v[192:195], a[112:115]
v_exp_f32 v150, v150
v_mfma_f32_16x16x32_bf16 a[116:119], a[184:187], v[192:195], a[116:119]
buffer_load_dwordx4 v16, s[32:35], s70 offen offset:0 sc1 lds
v_mfma_f32_16x16x32_bf16 a[116:119], a[188:191], v[196:199], a[116:119]
s_sub_u32 s72, s72, 1
v_exp_f32 v151, v151
v_mfma_f32_16x16x32_bf16 a[84:87], a[188:191], v[188:191], a[84:87]
ds_read_b128 a[156:159], v2 offset:3072
v_cvt_pk_bf16_f32 v215, v150, v151
v_mfma_f32_16x16x32_bf16 a[84:87], a[184:187], v[184:187], a[84:87]
v_exp_f32 v132, v132
v_mfma_f32_16x16x32_bf16 a[88:91], a[192:195], v[184:187], a[88:91]
ds_read_b128 a[160:163], v2 offset:4096
v_mfma_f32_16x16x32_bf16 a[88:91], a[196:199], v[188:191], a[88:91]
s_cmp_lg_u32 s72, 0
v_exp_f32 v133, v133
v_mfma_f32_16x16x32_bf16 a[120:123], a[196:199], v[196:199], a[120:123]
ds_read_b128 a[164:167], v2 offset:5120
v_cvt_pk_bf16_f32 v206, v132, v133
v_mfma_f32_16x16x32_bf16 a[120:123], a[192:195], v[192:195], a[120:123]
v_exp_f32 v134, v134
v_mfma_f32_16x16x32_bf16 a[124:127], a[200:203], v[192:195], a[124:127]
buffer_load_dwordx4 v16, s[32:35], s70 offen offset:1024 sc1 lds
v_mfma_f32_16x16x32_bf16 a[124:127], a[204:207], v[196:199], a[124:127]
v_exp_f32 v135, v135
v_mfma_f32_16x16x32_bf16 a[92:95], a[204:207], v[188:191], a[92:95]
ds_read_b128 a[168:171], v2 offset:6144
v_cvt_pk_bf16_f32 v207, v134, v135
v_mfma_f32_16x16x32_bf16 a[92:95], a[200:203], v[184:187], a[92:95]
ds_read_b128 a[172:175], v2 offset:7168
s_cbranch_scc1 L_S
buffer_load_dword v19, off, s[52:55], s80 sc1
s_add_u32 s17, s78, L_TAIL-L_pc+0
buffer_load_dword a252, v16, s[88:91], s17 offen
s_add_u32 s17, s78, L_TAIL-L_pc+4096
buffer_load_dword a252, v16, s[88:91], s17 offen
s_waitcnt lgkmcnt(7)
v_mfma_f32_16x16x32_bf16 v[136:139], a[144:147], v[72:75], v[228:231]
s_waitcnt lgkmcnt(6)
ds_read_b128 a[176:179], v2 offset:8192
ds_read_b128 a[180:183], v2 offset:9216
v_mfma_f32_16x16x32_bf16 v[136:139], a[148:151], v[76:79], v[136:139]
s_waitcnt lgkmcnt(7)
ds_read_b128 a[184:187], v2 offset:10240
v_cndmask_b32 v120, v224, v17, s[0:1]
v_cndmask_b32 v121, v224, v17, s[4:5]
v_cndmask_b32 v122, v224, v17, s[6:7]
v_cndmask_b32 v123, v224, v17, s[8:9]
v_mfma_f32_16x16x32_bf16 v[136:139], a[152:155], v[80:83], v[136:139]
s_waitcnt lgkmcnt(7)
buffer_load_dwordx4 v16, s[32:35], s70 offen offset:2048 sc1 lds
v_mfma_f32_16x16x32_bf16 v[136:139], a[156:159], v[84:87], v[136:139]
ds_read_b128 a[188:191], v2 offset:11264
ds_read_b128 a[192:195], v2 offset:12288
v_mfma_f32_16x16x32_bf16 v[120:123], a[156:159], v[68:71], v[120:123]
ds_read_b128 a[196:199], v2 offset:13312
v_cndmask_b32 v124, v224, v17, s[10:11]
v_mfma_f32_16x16x32_bf16 v[120:123], a[152:155], v[64:67], v[120:123]
buffer_load_dwordx4 v16, s[32:35], s70 offen offset:3072 sc1 lds
v_mfma_f32_16x16x32_bf16 v[120:123], a[148:151], v[60:63], v[120:123]
ds_read_b128 a[200:203], v2 offset:14336
ds_read_b128 a[204:207], v2 offset:15360
v_mfma_f32_16x16x32_bf16 v[120:123], a[144:147], v[56:59], v[120:123]
s_waitcnt lgkmcnt(5)
v_exp_f32 v136, v136
v_mfma_f32_16x16x32_bf16 v[140:143], a[160:163], v[72:75], v[228:231]
v_exp_f32 v137, v137
v_mfma_f32_16x16x32_bf16 v[140:143], a[164:167], v[76:79], v[140:143]
s_add_u32 m0, s71, 4096
v_cndmask_b32 v125, v224, v17, s[12:13]
v_cndmask_b32 v126, v224, v17, s[18:19]
v_cndmask_b32 v127, v224, v17, s[22:23]
v_exp_f32 v138, v138
v_mfma_f32_16x16x32_bf16 v[140:143], a[168:171], v[80:83], v[140:143]
v_exp_f32 v139, v139
v_mfma_f32_16x16x32_bf16 v[140:143], a[172:175], v[84:87], v[140:143]
v_exp_f32 v120, v120
v_mfma_f32_16x16x32_bf16 v[124:127], a[172:175], v[68:71], v[124:127]
ds_read_b128 a[144:147], v3 offset:0
v_cvt_pk_bf16_f32 v192, v136, v137
v_mfma_f32_16x16x32_bf16 v[124:127], a[168:171], v[64:67], v[124:127]
s_add_u32 s64, s70, 4096
v_cndmask_b32 v128, v224, v17, s[26:27]
v_cndmask_b32 v129, v224, v17, s[56:57]
v_cndmask_b32 v130, v224, v17, s[58:59]
v_cndmask_b32 v131, v224, v17, s[60:61]
v_exp_f32 v121, v121
v_mfma_f32_16x16x32_bf16 v[124:127], a[164:167], v[60:63], v[124:127]
ds_read_b128 a[148:151], v3 offset:8192
v_cvt_pk_bf16_f32 v193, v138, v139
v_mfma_f32_16x16x32_bf16 v[124:127], a[160:163], v[56:59], v[124:127]
v_exp_f32 v122, v122
v_mfma_f32_16x16x32_bf16 v[128:131], a[176:179], v[56:59], v[128:131]
ds_read_b128 a[152:155], v3 offset:1024
v_cvt_pk_bf16_f32 v184, v120, v121
v_mfma_f32_16x16x32_bf16 v[128:131], a[180:183], v[60:63], v[128:131]
v_exp_f32 v123, v123
v_mfma_f32_16x16x32_bf16 v[128:131], a[184:187], v[64:67], v[128:131]
s_waitcnt lgkmcnt(2)
ds_read_b128 a[156:159], v3 offset:9216
v_cvt_pk_bf16_f32 v185, v122, v123
v_mfma_f32_16x16x32_bf16 v[128:131], a[188:191], v[68:71], v[128:131]
v_exp_f32 v140, v140
v_mfma_f32_16x16x32_bf16 v[144:147], a[188:191], v[84:87], v[228:231]
buffer_load_dwordx4 v16, s[32:35], s64 offen offset:0 sc1 lds
v_mfma_f32_16x16x32_bf16 v[144:147], a[184:187], v[80:83], v[144:147]
v_exp_f32 v141, v141
v_mfma_f32_16x16x32_bf16 v[144:147], a[180:183], v[76:79], v[144:147]
ds_read_b128 a[160:163], v3 offset:2048
v_cvt_pk_bf16_f32 v194, v140, v141
v_mfma_f32_16x16x32_bf16 v[144:147], a[176:179], v[72:75], v[144:147]
v_exp_f32 v142, v142
v_mfma_f32_16x16x32_bf16 v[148:151], a[192:195], v[72:75], v[228:231]
ds_read_b128 a[164:167], v3 offset:10240
ds_read_b128 a[168:171], v3 offset:3072
v_mfma_f32_16x16x32_bf16 v[148:151], a[196:199], v[76:79], v[148:151]
v_cndmask_b32 v132, v224, v17, s[62:63]
v_cndmask_b32 v133, v224, v17, s[48:49]
v_cndmask_b32 v134, v224, v17, s[50:51]
v_cndmask_b32 v135, v224, v17, s[100:101]
v_exp_f32 v143, v143
v_mfma_f32_16x16x32_bf16 v[148:151], a[200:203], v[80:83], v[148:151]
ds_read_b128 a[172:175], v3 offset:11264
v_cvt_pk_bf16_f32 v195, v142, v143
v_mfma_f32_16x16x32_bf16 v[148:151], a[204:207], v[84:87], v[148:151]
v_exp_f32 v124, v124
v_mfma_f32_16x16x32_bf16 v[132:135], a[204:207], v[68:71], v[132:135]
buffer_load_dwordx4 v16, s[32:35], s64 offen offset:1024 sc1 lds
v_mfma_f32_16x16x32_bf16 v[132:135], a[200:203], v[64:67], v[132:135]
v_exp_f32 v125, v125
v_mfma_f32_16x16x32_bf16 v[132:135], a[196:199], v[60:63], v[132:135]
ds_read_b128 a[176:179], v3 offset:4096
v_cvt_pk_bf16_f32 v186, v124, v125
v_mfma_f32_16x16x32_bf16 v[132:135], a[192:195], v[56:59], v[132:135]
v_exp_f32 v126, v126
v_mfma_f32_16x16x32_bf16 a[136:139], a[244:247], v[200:203], a[136:139]
ds_read_b128 a[180:183], v3 offset:12288
ds_read_b128 a[184:187], v3 offset:5120
v_mfma_f32_16x16x32_bf16 a[136:139], a[244:247], v[204:207], a[136:139]
v_exp_f32 v127, v127
v_mfma_f32_16x16x32_bf16 a[140:143], a[244:247], v[208:211], a[140:143]
ds_read_b128 a[188:191], v3 offset:13312
v_cvt_pk_bf16_f32 v187, v126, v127
v_mfma_f32_16x16x32_bf16 a[140:143], a[244:247], v[212:215], a[140:143]
v_exp_f32 v128, v128
v_mfma_f32_16x16x32_bf16 a[64:67], a[144:147], v[200:203], a[64:67]
s_waitcnt lgkmcnt(3)
buffer_load_dwordx4 v16, s[32:35], s64 offen offset:2048 sc1 lds
v_mfma_f32_16x16x32_bf16 a[64:67], a[148:151], v[204:207], a[64:67]
v_exp_f32 v129, v129
v_mfma_f32_16x16x32_bf16 a[96:99], a[148:151], v[212:215], a[96:99]
ds_read_b128 a[192:195], v3 offset:6144
v_cvt_pk_bf16_f32 v188, v128, v129
v_mfma_f32_16x16x32_bf16 a[96:99], a[144:147], v[208:211], a[96:99]
v_exp_f32 v130, v130
v_mfma_f32_16x16x32_bf16 a[100:103], a[152:155], v[208:211], a[100:103]
ds_read_b128 a[196:199], v3 offset:14336
v_mfma_f32_16x16x32_bf16 a[100:103], a[156:159], v[212:215], a[100:103]
v_exp_f32 v131, v131
v_mfma_f32_16x16x32_bf16 a[68:71], a[156:159], v[204:207], a[68:71]
ds_read_b128 a[200:203], v3 offset:7168
v_cvt_pk_bf16_f32 v189, v130, v131
v_mfma_f32_16x16x32_bf16 a[68:71], a[152:155], v[200:203], a[68:71]
v_exp_f32 v144, v144
v_mfma_f32_16x16x32_bf16 a[72:75], a[160:163], v[200:203], a[72:75]
buffer_load_dwordx4 v16, s[32:35], s64 offen offset:3072 sc1 lds
v_mfma_f32_16x16x32_bf16 a[72:75], a[164:167], v[204:207], a[72:75]
v_exp_f32 v145, v145
v_mfma_f32_16x16x32_bf16 a[104:107], a[164:167], v[212:215], a[104:107]
ds_read_b128 a[204:207], v3 offset:15360
v_cvt_pk_bf16_f32 v196, v144, v145
v_mfma_f32_16x16x32_bf16 a[104:107], a[160:163], v[208:211], a[104:107]
v_exp_f32 v146, v146
v_mfma_f32_16x16x32_bf16 a[108:111], a[168:171], v[208:211], a[108:111]
s_waitcnt vmcnt(11)
s_barrier
v_mfma_f32_16x16x32_bf16 a[108:111], a[172:175], v[212:215], a[108:111]
v_exp_f32 v147, v147
v_mfma_f32_16x16x32_bf16 a[76:79], a[172:175], v[204:207], a[76:79]
ds_read_b128 a[144:147], v2 offset:16384
v_cvt_pk_bf16_f32 v197, v146, v147
v_mfma_f32_16x16x32_bf16 a[76:79], a[168:171], v[200:203], a[76:79]
v_exp_f32 v148, v148
v_mfma_f32_16x16x32_bf16 a[80:83], a[176:179], v[200:203], a[80:83]
s_waitcnt vmcnt(8)
v_readfirstlane_b32 vcc_lo, v19
s_nop 0
s_cmp_lt_u32 vcc_lo, 32
s_cbranch_scc1 L_spin_8
L_spinbk_9:
ds_read_b128 a[148:151], v2 offset:17408
s_waitcnt lgkmcnt(2)
v_mfma_f32_16x16x32_bf16 a[80:83], a[180:183], v[204:207], a[80:83]
v_exp_f32 v149, v149
v_mfma_f32_16x16x32_bf16 a[112:115], a[180:183], v[212:215], a[112:115]
ds_read_b128 a[152:155], v2 offset:18432
v_cvt_pk_bf16_f32 v198, v148, v149
v_mfma_f32_16x16x32_bf16 a[112:115], a[176:179], v[208:211], a[112:115]
v_exp_f32 v150, v150
v_mfma_f32_16x16x32_bf16 a[116:119], a[184:187], v[208:211], a[116:119]
v_cndmask_b32 v136, v228, v17, s[0:1]
v_cndmask_b32 v137, v228, v17, s[4:5]
v_mfma_f32_16x16x32_bf16 a[116:119], a[188:191], v[212:215], a[116:119]
v_exp_f32 v151, v151
v_mfma_f32_16x16x32_bf16 a[84:87], a[188:191], v[204:207], a[84:87]
ds_read_b128 a[156:159], v2 offset:19456
v_cvt_pk_bf16_f32 v199, v150, v151
v_mfma_f32_16x16x32_bf16 a[84:87], a[184:187], v[200:203], a[84:87]
v_exp_f32 v132, v132
v_mfma_f32_16x16x32_bf16 a[88:91], a[192:195], v[200:203], a[88:91]
ds_read_b128 a[160:163], v2 offset:20480
v_cndmask_b32 v138, v228, v17, s[6:7]
v_mfma_f32_16x16x32_bf16 a[88:91], a[196:199], v[204:207], a[88:91]
v_exp_f32 v133, v133
v_mfma_f32_16x16x32_bf16 a[120:123], a[196:199], v[212:215], a[120:123]
ds_read_b128 a[164:167], v2 offset:21504
v_cvt_pk_bf16_f32 v190, v132, v133
v_mfma_f32_16x16x32_bf16 a[120:123], a[192:195], v[208:211], a[120:123]
v_exp_f32 v134, v134
v_mfma_f32_16x16x32_bf16 a[124:127], a[200:203], v[208:211], a[124:127]
v_cndmask_b32 v139, v228, v17, s[8:9]
v_cndmask_b32 v140, v228, v17, s[10:11]
v_mfma_f32_16x16x32_bf16 a[124:127], a[204:207], v[212:215], a[124:127]
v_exp_f32 v135, v135
v_mfma_f32_16x16x32_bf16 a[92:95], a[204:207], v[204:207], a[92:95]
ds_read_b128 a[168:171], v2 offset:22528
v_cvt_pk_bf16_f32 v191, v134, v135
v_mfma_f32_16x16x32_bf16 a[92:95], a[200:203], v[200:203], a[92:95]
s_waitcnt lgkmcnt(2)
ds_read_b128 a[172:175], v2 offset:23552
v_cndmask_b32 v141, v228, v17, s[12:13]
v_mfma_f32_16x16x32_bf16 v[136:139], a[144:147], v[72:75], v[136:139]
ds_read_b128 a[176:179], v2 offset:24576
v_cndmask_b32 v142, v228, v17, s[18:19]
v_mfma_f32_16x16x32_bf16 v[136:139], a[148:151], v[76:79], v[136:139]
ds_read_b128 a[180:183], v2 offset:25600
v_cndmask_b32 v143, v228, v17, s[22:23]
v_mfma_f32_16x16x32_bf16 v[136:139], a[152:155], v[80:83], v[136:139]
ds_read_b128 a[184:187], v2 offset:26624
v_cndmask_b32 v144, v228, v17, s[26:27]
v_mfma_f32_16x16x32_bf16 v[136:139], a[156:159], v[84:87], v[136:139]
s_waitcnt lgkmcnt(3)
ds_read_b128 a[188:191], v2 offset:27648
v_cndmask_b32 v145, v228, v17, s[56:57]
v_mfma_f32_16x16x32_bf16 v[140:143], a[172:175], v[84:87], v[140:143]
ds_read_b128 a[192:195], v2 offset:28672
ds_read_b128 a[196:199], v2 offset:29696
ds_read_b128 a[200:203], v2 offset:30720
ds_read_b128 a[204:207], v2 offset:31744
v_mfma_f32_16x16x32_bf16 v[140:143], a[168:171], v[80:83], v[140:143]
ds_read_b128 a[144:147], v3 offset:16384
v_cndmask_b32 v146, v228, v17, s[58:59]
v_cndmask_b32 v147, v228, v17, s[60:61]
v_mfma_f32_16x16x32_bf16 v[140:143], a[164:167], v[76:79], v[140:143]
ds_read_b128 a[148:151], v3 offset:24576
v_cndmask_b32 v148, v228, v17, s[62:63]
v_mfma_f32_16x16x32_bf16 v[140:143], a[160:163], v[72:75], v[140:143]
s_waitcnt lgkmcnt(8)
ds_read_b128 a[152:155], v3 offset:17408
v_cndmask_b32 v149, v228, v17, s[48:49]
v_mfma_f32_16x16x32_bf16 v[144:147], a[176:179], v[72:75], v[144:147]
ds_read_b128 a[156:159], v3 offset:25600
v_cndmask_b32 v150, v228, v17, s[50:51]
v_mfma_f32_16x16x32_bf16 v[144:147], a[180:183], v[76:79], v[144:147]
s_waitcnt lgkmcnt(8)
ds_read_b128 a[160:163], v3 offset:18432
v_cndmask_b32 v151, v228, v17, s[100:101]
v_mfma_f32_16x16x32_bf16 v[144:147], a[184:187], v[80:83], v[144:147]
v_exp_f32 v136, v136
v_mfma_f32_16x16x32_bf16 v[144:147], a[188:191], v[84:87], v[144:147]
s_waitcnt lgkmcnt(4)
v_exp_f32 v137, v137
v_mfma_f32_16x16x32_bf16 v[148:151], a[204:207], v[84:87], v[148:151]
v_exp_f32 v138, v138
v_mfma_f32_16x16x32_bf16 v[148:151], a[200:203], v[80:83], v[148:151]
s_add_u32 s65, s84, 0
v_exp_f32 v139, v139
v_mfma_f32_16x16x32_bf16 v[148:151], a[196:199], v[76:79], v[148:151]
buffer_load_dwordx4 a[208:211], v14, s[44:47], s65 offen offset:0 sc1
v_mfma_f32_16x16x32_bf16 v[148:151], a[192:195], v[72:75], v[148:151]
ds_read_b128 a[164:167], v3 offset:26624
v_cvt_pk_bf16_f32 v208, v136, v137
v_mfma_f32_16x16x32_bf16 a[136:139], a[244:247], v[184:187], a[136:139]
v_exp_f32 v140, v140
v_mfma_f32_16x16x32_bf16 a[136:139], a[244:247], v[188:191], a[136:139]
buffer_load_dwordx4 a[216:219], v14, s[44:47], s65 offen offset:1024 sc1
v_mfma_f32_16x16x32_bf16 a[140:143], a[244:247], v[192:195], a[140:143]
v_exp_f32 v141, v141
v_mfma_f32_16x16x32_bf16 a[140:143], a[244:247], v[196:199], a[140:143]
ds_read_b128 a[168:171], v3 offset:19456
v_cvt_pk_bf16_f32 v209, v138, v139
v_mfma_f32_16x16x32_bf16 a[64:67], a[144:147], v[184:187], a[64:67]
s_waitcnt lgkmcnt(2)
buffer_load_dwordx4 a[224:227], v15, s[44:47], s65 offen offset:0 sc1
v_mfma_f32_16x16x32_bf16 a[64:67], a[148:151], v[188:191], a[64:67]
ds_read_b128 a[172:175], v3 offset:27648
v_cvt_pk_bf16_f32 v210, v140, v141
v_mfma_f32_16x16x32_bf16 a[96:99], a[148:151], v[196:199], a[96:99]
v_exp_f32 v142, v142
v_mfma_f32_16x16x32_bf16 a[96:99], a[144:147], v[192:195], a[96:99]
buffer_load_dwordx4 a[232:235], v15, s[44:47], s65 offen offset:1024 sc1
v_mfma_f32_16x16x32_bf16 a[100:103], a[152:155], v[192:195], a[100:103]
s_add_u32 s65, s84, 8192
ds_read_b128 a[176:179], v3 offset:20480
v_xor_b32 v2, 0x8000, v2
v_mfma_f32_16x16x32_bf16 a[100:103], a[156:159], v[196:199], a[100:103]
buffer_load_dwordx4 a[212:215], v14, s[44:47], s65 offen offset:0 sc1
v_mfma_f32_16x16x32_bf16 a[68:71], a[156:159], v[188:191], a[68:71]
v_exp_f32 v143, v143
v_mfma_f32_16x16x32_bf16 a[68:71], a[152:155], v[184:187], a[68:71]
ds_read_b128 a[180:183], v3 offset:28672
v_cvt_pk_bf16_f32 v211, v142, v143
v_mfma_f32_16x16x32_bf16 a[72:75], a[160:163], v[184:187], a[72:75]
s_waitcnt lgkmcnt(2)
buffer_load_dwordx4 a[220:223], v14, s[44:47], s65 offen offset:1024 sc1
v_mfma_f32_16x16x32_bf16 a[72:75], a[164:167], v[188:191], a[72:75]
v_exp_f32 v144, v144
v_mfma_f32_16x16x32_bf16 a[104:107], a[164:167], v[196:199], a[104:107]
ds_read_b128 a[184:187], v3 offset:21504
v_accvgpr_read_b32 v22, a136
v_mfma_f32_16x16x32_bf16 a[104:107], a[160:163], v[192:195], a[104:107]
buffer_load_dwordx4 a[228:231], v15, s[44:47], s65 offen offset:0 sc1
v_mfma_f32_16x16x32_bf16 a[108:111], a[168:171], v[192:195], a[108:111]
ds_read_b128 a[188:191], v3 offset:29696
v_max_f32 v1, v1, v22
v_mfma_f32_16x16x32_bf16 a[108:111], a[172:175], v[196:199], a[108:111]
v_exp_f32 v145, v145
v_mfma_f32_16x16x32_bf16 a[76:79], a[172:175], v[188:191], a[76:79]
buffer_load_dwordx4 a[236:239], v15, s[44:47], s65 offen offset:1024 sc1
v_mfma_f32_16x16x32_bf16 a[76:79], a[168:171], v[184:187], a[76:79]
s_waitcnt lgkmcnt(2)
v_exp_f32 v146, v146
v_mfma_f32_16x16x32_bf16 a[80:83], a[176:179], v[184:187], a[80:83]
s_add_u32 s65, s84, 32768
ds_read_b128 a[192:195], v3 offset:22528
v_cvt_pk_bf16_f32 v212, v144, v145
v_mfma_f32_16x16x32_bf16 a[80:83], a[180:183], v[188:191], a[80:83]
buffer_load_dwordx4 v[152:155], v14, s[44:47], s65 offen offset:0 sc1
ds_read_b128 a[196:199], v3 offset:30720
ds_read_b128 a[200:203], v3 offset:23552
ds_read_b128 a[204:207], v3 offset:31744
v_mfma_f32_16x16x32_bf16 a[112:115], a[180:183], v[196:199], a[112:115]
s_waitcnt vmcnt(9)
s_barrier
v_xor_b32 v3, 0x8000, v3
v_mfma_f32_16x16x32_bf16 a[112:115], a[176:179], v[192:195], a[112:115]
s_waitcnt lgkmcnt(4)
buffer_load_dwordx4 v[160:163], v14, s[44:47], s65 offen offset:1024 sc1
v_exp_f32 v147, v147
v_mfma_f32_16x16x32_bf16 a[116:119], a[184:187], v[192:195], a[116:119]
v_exp_f32 v148, v148
v_mfma_f32_16x16x32_bf16 a[116:119], a[188:191], v[196:199], a[116:119]
buffer_load_dwordx4 v[168:171], v15, s[44:47], s65 offen offset:0 sc1
v_mfma_f32_16x16x32_bf16 a[84:87], a[188:191], v[188:191], a[84:87]
v_exp_f32 v149, v149
v_mfma_f32_16x16x32_bf16 a[84:87], a[184:187], v[184:187], a[84:87]
s_waitcnt lgkmcnt(0)
buffer_load_dwordx4 v[176:179], v15, s[44:47], s65 offen offset:1024 sc1
v_mfma_f32_16x16x32_bf16 a[88:91], a[192:195], v[184:187], a[88:91]
s_add_u32 s65, s84, 40960
ds_read_b128 a[144:147], v3 offset:0
v_cvt_pk_bf16_f32 v213, v146, v147
v_mfma_f32_16x16x32_bf16 a[88:91], a[196:199], v[188:191], a[88:91]
buffer_load_dwordx4 v[156:159], v14, s[44:47], s65 offen offset:0 sc1
v_mfma_f32_16x16x32_bf16 a[120:123], a[196:199], v[196:199], a[120:123]
v_exp_f32 v150, v150
v_mfma_f32_16x16x32_bf16 a[120:123], a[192:195], v[192:195], a[120:123]
buffer_load_dwordx4 v[164:167], v14, s[44:47], s65 offen offset:1024 sc1
ds_read_b128 a[148:151], v3 offset:8192
v_mfma_f32_16x16x32_bf16 a[124:127], a[200:203], v[192:195], a[124:127]
ds_read_b128 a[152:155], v3 offset:1024
v_cvt_pk_bf16_f32 v214, v148, v149
v_mfma_f32_16x16x32_bf16 a[124:127], a[204:207], v[196:199], a[124:127]
buffer_load_dwordx4 v[172:175], v15, s[44:47], s65 offen offset:0 sc1
ds_read_b128 a[156:159], v3 offset:9216
v_mfma_f32_16x16x32_bf16 a[92:95], a[204:207], v[188:191], a[92:95]
v_exp_f32 v151, v151
v_mfma_f32_16x16x32_bf16 a[92:95], a[200:203], v[184:187], a[92:95]
buffer_load_dwordx4 v[180:183], v15, s[44:47], s65 offen offset:1024 sc1
ds_read_b128 a[160:163], v3 offset:2048
ds_read_b128 a[164:167], v3 offset:10240
ds_read_b128 a[168:171], v3 offset:3072
ds_read_b128 a[172:175], v3 offset:11264
v_cvt_pk_bf16_f32 v215, v150, v151
v_rcp_f32 v22, v22
v_accvgpr_read_b32 v232, a64
v_accvgpr_read_b32 v233, a65
v_accvgpr_read_b32 v234, a66
v_accvgpr_read_b32 v235, a67
v_accvgpr_read_b32 v236, a68
v_accvgpr_read_b32 v237, a69
v_accvgpr_read_b32 v238, a70
v_accvgpr_read_b32 v239, a71
v_mul_f32 v22, v22, v8
v_mul_f32 v232, v232, v22
v_mul_f32 v233, v233, v22
v_mul_f32 v234, v234, v22
v_mul_f32 v235, v235, v22
v_mul_f32 v236, v236, v22
v_mul_f32 v237, v237, v22
v_mul_f32 v238, v238, v22
v_mul_f32 v239, v239, v22
v_cvt_pk_bf16_f32 v232, v232, v233
v_cvt_pk_bf16_f32 v233, v234, v235
v_cvt_pk_bf16_f32 v234, v236, v237
v_cvt_pk_bf16_f32 v235, v238, v239
s_add_u32 s77, s75, 0
buffer_store_dwordx4 v[232:235], v16, s[44:47], s77 offen sc1
L_TAIL:
ds_read_b128 a[176:179], v3 offset:4096
ds_read_b128 a[180:183], v3 offset:12288
ds_read_b128 a[184:187], v3 offset:5120
ds_read_b128 a[188:191], v3 offset:13312
v_mfma_f32_16x16x32_bf16 a[140:143], a[244:247], v[208:211], a[140:143]
ds_read_b128 a[192:195], v3 offset:6144
ds_read_b128 a[196:199], v3 offset:14336
v_mfma_f32_16x16x32_bf16 a[140:143], a[244:247], v[212:215], a[140:143]
s_waitcnt lgkmcnt(13)
s_add_u32 m0, s86, 32768
ds_read_b128 a[200:203], v3 offset:7168
ds_read_b128 a[204:207], v3 offset:15360
v_mfma_f32_16x16x32_bf16 a[96:99], a[144:147], v[208:211], a[96:99]
s_waitcnt lgkmcnt(14)
s_add_u32 s64, s85, 262144
v_accvgpr_read_b32 v240, a72
v_accvgpr_read_b32 v241, a73
v_mfma_f32_16x16x32_bf16 a[96:99], a[148:151], v[212:215], a[96:99]
s_waitcnt lgkmcnt(12)
buffer_load_dwordx4 v12, s[36:39], s64 offen lds
v_mfma_f32_16x16x32_bf16 a[100:103], a[156:159], v[212:215], a[100:103]
s_add_u32 m0, s86, 33792
s_add_u32 s64, s85, 270336
v_accvgpr_read_b32 v242, a74
v_accvgpr_read_b32 v243, a75
v_mfma_f32_16x16x32_bf16 a[100:103], a[152:155], v[208:211], a[100:103]
s_waitcnt lgkmcnt(11)
buffer_load_dwordx4 v13, s[36:39], s64 offen lds
v_mfma_f32_16x16x32_bf16 a[104:107], a[160:163], v[208:211], a[104:107]
s_waitcnt lgkmcnt(10)
s_add_u32 m0, s86, 34816
s_add_u32 s64, s85, 278528
v_accvgpr_read_b32 v244, a76
v_accvgpr_read_b32 v245, a77
v_mfma_f32_16x16x32_bf16 a[104:107], a[164:167], v[212:215], a[104:107]
s_waitcnt lgkmcnt(8)
buffer_load_dwordx4 v12, s[36:39], s64 offen lds
v_mfma_f32_16x16x32_bf16 a[108:111], a[172:175], v[212:215], a[108:111]
s_add_u32 m0, s86, 35840
s_add_u32 s64, s85, 286720
v_accvgpr_read_b32 v246, a78
v_accvgpr_read_b32 v247, a79
v_mfma_f32_16x16x32_bf16 a[108:111], a[168:171], v[208:211], a[108:111]
s_waitcnt lgkmcnt(7)
buffer_load_dwordx4 v13, s[36:39], s64 offen lds
v_mfma_f32_16x16x32_bf16 a[112:115], a[176:179], v[208:211], a[112:115]
s_waitcnt lgkmcnt(6)
s_add_u32 m0, s86, 36864
s_add_u32 s64, s85, 294912
v_mul_f32 v240, v240, v22
v_mul_f32 v241, v241, v22
v_mfma_f32_16x16x32_bf16 a[112:115], a[180:183], v[212:215], a[112:115]
s_waitcnt lgkmcnt(4)
buffer_load_dwordx4 v12, s[36:39], s64 offen lds
v_mfma_f32_16x16x32_bf16 a[116:119], a[188:191], v[212:215], a[116:119]
s_add_u32 m0, s86, 37888
s_add_u32 s64, s85, 303104
v_mul_f32 v242, v242, v22
v_mul_f32 v243, v243, v22
v_mfma_f32_16x16x32_bf16 a[116:119], a[184:187], v[208:211], a[116:119]
s_waitcnt lgkmcnt(3)
buffer_load_dwordx4 v13, s[36:39], s64 offen lds
v_mfma_f32_16x16x32_bf16 a[120:123], a[192:195], v[208:211], a[120:123]
s_waitcnt lgkmcnt(2)
s_add_u32 m0, s86, 38912
s_add_u32 s64, s85, 311296
v_mul_f32 v244, v244, v22
v_mul_f32 v245, v245, v22
v_mfma_f32_16x16x32_bf16 a[120:123], a[196:199], v[212:215], a[120:123]
s_waitcnt lgkmcnt(0)
buffer_load_dwordx4 v12, s[36:39], s64 offen lds
v_mfma_f32_16x16x32_bf16 a[124:127], a[204:207], v[212:215], a[124:127]
s_add_u32 m0, s86, 39936
s_add_u32 s64, s85, 319488
v_mul_f32 v246, v246, v22
v_mul_f32 v247, v247, v22
v_mfma_f32_16x16x32_bf16 a[124:127], a[200:203], v[208:211], a[124:127]
buffer_load_dwordx4 v13, s[36:39], s64 offen lds
v_cvt_pk_bf16_f32 v240, v240, v241
v_cvt_pk_bf16_f32 v241, v242, v243
v_cvt_pk_bf16_f32 v242, v244, v245
v_cvt_pk_bf16_f32 v243, v246, v247
s_add_u32 s77, s75, 8192
buffer_store_dwordx4 v[240:243], v16, s[44:47], s77 offen sc1
v_accvgpr_read_b32 v23, a140
v_max_f32 v1, v1, v23
v_rcp_f32 v23, v23
s_mov_b32 s66, 0x5d800000
v_cmp_le_f32 vcc, s66, v1
s_lshl_b32 s67, s30, 2
s_cmp_lg_u64 vcc, 0
s_cselect_b32 s66, 1, 0
v_mov_b32 v248, s67
v_mov_b32 v249, s66
ds_write_b32 v248, v249
v_accvgpr_read_b32 v232, a80
v_accvgpr_read_b32 v233, a81
v_accvgpr_read_b32 v234, a82
v_accvgpr_read_b32 v235, a83
v_accvgpr_read_b32 v236, a84
v_accvgpr_read_b32 v237, a85
v_accvgpr_read_b32 v238, a86
v_accvgpr_read_b32 v239, a87
v_pk_mul_f32 v[232:233], v[232:233], v[22:23] op_sel_hi:[1,0]
v_pk_mul_f32 v[234:235], v[234:235], v[22:23] op_sel_hi:[1,0]
v_pk_mul_f32 v[236:237], v[236:237], v[22:23] op_sel_hi:[1,0]
v_pk_mul_f32 v[238:239], v[238:239], v[22:23] op_sel_hi:[1,0]
v_cvt_pk_bf16_f32 v232, v232, v233
v_cvt_pk_bf16_f32 v233, v234, v235
v_cvt_pk_bf16_f32 v234, v236, v237
v_cvt_pk_bf16_f32 v235, v238, v239
s_add_u32 s77, s75, 16384
buffer_store_dwordx4 v[232:235], v16, s[44:47], s77 offen sc1
v_accvgpr_read_b32 v240, a88
v_accvgpr_read_b32 v241, a89
v_accvgpr_read_b32 v242, a90
v_accvgpr_read_b32 v243, a91
v_accvgpr_read_b32 v244, a92
v_accvgpr_read_b32 v245, a93
v_accvgpr_read_b32 v246, a94
v_accvgpr_read_b32 v247, a95
v_pk_mul_f32 v[240:241], v[240:241], v[22:23] op_sel_hi:[1,0]
v_pk_mul_f32 v[242:243], v[242:243], v[22:23] op_sel_hi:[1,0]
v_pk_mul_f32 v[244:245], v[244:245], v[22:23] op_sel_hi:[1,0]
v_pk_mul_f32 v[246:247], v[246:247], v[22:23] op_sel_hi:[1,0]
v_cvt_pk_bf16_f32 v240, v240, v241
v_cvt_pk_bf16_f32 v241, v242, v243
v_cvt_pk_bf16_f32 v242, v244, v245
v_cvt_pk_bf16_f32 v243, v246, v247
s_add_u32 s77, s75, 24576
buffer_store_dwordx4 v[240:243], v16, s[44:47], s77 offen sc1
v_accvgpr_read_b32 v232, a96
v_accvgpr_read_b32 v233, a97
v_accvgpr_read_b32 v234, a98
v_accvgpr_read_b32 v235, a99
v_accvgpr_read_b32 v236, a100
v_accvgpr_read_b32 v237, a101
v_accvgpr_read_b32 v238, a102
v_accvgpr_read_b32 v239, a103
v_mul_f32 v23, v23, v10
v_pk_mul_f32 v[232:233], v[232:233], v[22:23] op_sel:[0,1]
v_pk_mul_f32 v[234:235], v[234:235], v[22:23] op_sel:[0,1]
v_pk_mul_f32 v[236:237], v[236:237], v[22:23] op_sel:[0,1]
v_pk_mul_f32 v[238:239], v[238:239], v[22:23] op_sel:[0,1]
v_cvt_pk_bf16_f32 v232, v232, v233
v_cvt_pk_bf16_f32 v233, v234, v235
v_cvt_pk_bf16_f32 v234, v236, v237
v_cvt_pk_bf16_f32 v235, v238, v239
s_add_u32 s77, s75, 4096
buffer_store_dwordx4 v[232:235], v16, s[44:47], s77 offen sc1
v_accvgpr_read_b32 v240, a104
v_accvgpr_read_b32 v241, a105
v_accvgpr_read_b32 v242, a106
v_accvgpr_read_b32 v243, a107
v_accvgpr_read_b32 v244, a108
v_accvgpr_read_b32 v245, a109
v_accvgpr_read_b32 v246, a110
v_accvgpr_read_b32 v247, a111
v_pk_mul_f32 v[240:241], v[240:241], v[22:23] op_sel:[0,1]
v_pk_mul_f32 v[242:243], v[242:243], v[22:23] op_sel:[0,1]
v_pk_mul_f32 v[244:245], v[244:245], v[22:23] op_sel:[0,1]
v_pk_mul_f32 v[246:247], v[246:247], v[22:23] op_sel:[0,1]
v_cvt_pk_bf16_f32 v240, v240, v241
v_cvt_pk_bf16_f32 v241, v242, v243
v_cvt_pk_bf16_f32 v242, v244, v245
v_cvt_pk_bf16_f32 v243, v246, v247
s_add_u32 s77, s75, 12288
buffer_store_dwordx4 v[240:243], v16, s[44:47], s77 offen sc1
v_accvgpr_read_b32 v232, a112
v_accvgpr_read_b32 v233, a113
v_accvgpr_read_b32 v234, a114
v_accvgpr_read_b32 v235, a115
v_accvgpr_read_b32 v236, a116
v_accvgpr_read_b32 v237, a117
v_accvgpr_read_b32 v238, a118
v_accvgpr_read_b32 v239, a119
v_pk_mul_f32 v[232:233], v[232:233], v[22:23] op_sel:[0,1]
v_pk_mul_f32 v[234:235], v[234:235], v[22:23] op_sel:[0,1]
v_pk_mul_f32 v[236:237], v[236:237], v[22:23] op_sel:[0,1]
v_pk_mul_f32 v[238:239], v[238:239], v[22:23] op_sel:[0,1]
v_cvt_pk_bf16_f32 v232, v232, v233
v_cvt_pk_bf16_f32 v233, v234, v235
v_cvt_pk_bf16_f32 v234, v236, v237
v_cvt_pk_bf16_f32 v235, v238, v239
s_add_u32 s77, s75, 20480
buffer_store_dwordx4 v[232:235], v16, s[44:47], s77 offen sc1
v_accvgpr_read_b32 v240, a120
v_accvgpr_read_b32 v241, a121
v_accvgpr_read_b32 v242, a122
v_accvgpr_read_b32 v243, a123
v_accvgpr_read_b32 v244, a124
v_accvgpr_read_b32 v245, a125
v_accvgpr_read_b32 v246, a126
v_accvgpr_read_b32 v247, a127
v_pk_mul_f32 v[240:241], v[240:241], v[22:23] op_sel:[0,1]
v_pk_mul_f32 v[242:243], v[242:243], v[22:23] op_sel:[0,1]
v_pk_mul_f32 v[244:245], v[244:245], v[22:23] op_sel:[0,1]
v_pk_mul_f32 v[246:247], v[246:247], v[22:23] op_sel:[0,1]
v_cvt_pk_bf16_f32 v240, v240, v241
v_cvt_pk_bf16_f32 v241, v242, v243
v_cvt_pk_bf16_f32 v242, v244, v245
v_cvt_pk_bf16_f32 v243, v246, v247
s_add_u32 s77, s75, 28672
buffer_store_dwordx4 v[240:243], v16, s[44:47], s77 offen sc1
v_mov_b32 v248, 0
s_waitcnt lgkmcnt(0)
s_barrier
ds_read_b128 v[248:251], v248
v_xor_b32 v188, 128, v18
v_xor_b32 v189, 160, v18
v_xor_b32 v190, 192, v18
ds_read_b64_tr_b16 a[64:65], v188 offset:32768
ds_read_b64_tr_b16 a[66:67], v188 offset:36864
ds_read_b64_tr_b16 a[68:69], v188 offset:40960
ds_read_b64_tr_b16 a[70:71], v188 offset:45056
ds_read_b64_tr_b16 a[72:73], v189 offset:32768
ds_read_b64_tr_b16 a[74:75], v189 offset:36864
ds_read_b64_tr_b16 a[76:77], v189 offset:40960
ds_read_b64_tr_b16 a[78:79], v189 offset:45056
ds_read_b64_tr_b16 a[80:81], v190 offset:32768
ds_read_b64_tr_b16 a[82:83], v190 offset:36864
ds_read_b64_tr_b16 a[84:85], v190 offset:40960
ds_read_b64_tr_b16 a[86:87], v190 offset:45056
v_xor_b32 v191, 224, v18
v_xor_b32 v184, 0, v18
v_xor_b32 v185, 32, v18
v_xor_b32 v186, 64, v18
v_xor_b32 v187, 96, v18
s_waitcnt lgkmcnt(12)
v_or3_b32 v248, v248, v249, v250
v_or_b32 v248, v248, v251
s_nop 0
v_readfirstlane_b32 s66, v248
s_nop 0
s_cmp_gt_u32 s66, s73
s_cbranch_scc1 L_fallback_11
s_waitcnt lgkmcnt(10)
s_waitcnt vmcnt(28)
v_mfma_f32_16x16x32_bf16 v[136:139], a[64:67], a[232:235], 0
s_waitcnt vmcnt(24)
s_waitcnt lgkmcnt(8)
s_add_u32 m0, s86, 65536
ds_read_b64_tr_b16 a[88:89], v191 offset:32768
v_xor_b32 v192, 0x10000, v184
v_mfma_f32_16x16x32_bf16 v[136:139], a[68:71], a[236:239], v[136:139]
s_add_u32 s64, s85, 524288
ds_read_b64_tr_b16 a[90:91], v191 offset:36864
v_xor_b32 v193, 0x10000, v185
v_mfma_f32_16x16x32_bf16 v[104:107], a[68:71], a[228:231], 0
buffer_load_dwordx4 v12, s[36:39], s64 offen lds
v_mfma_f32_16x16x32_bf16 v[104:107], a[64:67], a[224:227], v[104:107]
s_add_u32 m0, s86, 66560
s_add_u32 s64, s85, 532480
ds_read_b64_tr_b16 a[92:93], v191 offset:40960
v_xor_b32 v194, 0x10000, v186
v_mfma_f32_16x16x32_bf16 v[72:75], a[64:67], a[216:219], 0
buffer_load_dwordx4 v13, s[36:39], s64 offen lds
v_mfma_f32_16x16x32_bf16 v[72:75], a[68:71], a[220:223], v[72:75]
s_add_u32 m0, s86, 67584
s_add_u32 s64, s85, 540672
ds_read_b64_tr_b16 a[94:95], v191 offset:45056
v_xor_b32 v195, 0x10000, v187
v_mfma_f32_16x16x32_bf16 v[40:43], a[68:71], a[212:215], 0
buffer_load_dwordx4 v12, s[36:39], s64 offen lds
v_mfma_f32_16x16x32_bf16 v[40:43], a[64:67], a[208:211], v[40:43]
s_waitcnt lgkmcnt(4)
s_add_u32 m0, s86, 68608
s_add_u32 s64, s85, 548864
ds_read_b64_tr_b16 a[96:97], v184 offset:32768
v_xor_b32 v196, 0x10000, v188
v_mfma_f32_16x16x32_bf16 v[44:47], a[72:75], a[208:211], 0
buffer_load_dwordx4 v13, s[36:39], s64 offen lds
v_mfma_f32_16x16x32_bf16 v[44:47], a[76:79], a[212:215], v[44:47]
s_add_u32 m0, s86, 69632
ds_read_b64_tr_b16 a[98:99], v184 offset:36864
v_xor_b32 v197, 0x10000, v189
v_mfma_f32_16x16x32_bf16 v[76:79], a[76:79], a[220:223], 0
s_add_u32 s64, s85, 557056
ds_read_b64_tr_b16 a[100:101], v184 offset:40960
v_xor_b32 v198, 0x10000, v190
v_mfma_f32_16x16x32_bf16 v[76:79], a[72:75], a[216:219], v[76:79]
buffer_load_dwordx4 v12, s[36:39], s64 offen lds
v_mfma_f32_16x16x32_bf16 v[108:111], a[72:75], a[224:227], 0
s_add_u32 m0, s86, 70656
s_add_u32 s64, s85, 565248
ds_read_b64_tr_b16 a[102:103], v184 offset:45056
v_xor_b32 v199, 0x10000, v191
v_mfma_f32_16x16x32_bf16 v[108:111], a[76:79], a[228:231], v[108:111]
buffer_load_dwordx4 v13, s[36:39], s64 offen lds
v_mfma_f32_16x16x32_bf16 v[140:143], a[76:79], a[236:239], 0
s_add_u32 m0, s86, 71680
s_add_u32 s64, s85, 573440
ds_read_b64_tr_b16 a[104:105], v185 offset:32768
v_mfma_f32_16x16x32_bf16 v[140:143], a[72:75], a[232:235], v[140:143]
buffer_load_dwordx4 v12, s[36:39], s64 offen lds
v_mfma_f32_16x16x32_bf16 v[144:147], a[80:83], a[232:235], 0
s_add_u32 m0, s86, 72704
ds_read_b64_tr_b16 a[106:107], v185 offset:36864
v_mfma_f32_16x16x32_bf16 v[144:147], a[84:87], a[236:239], v[144:147]
s_add_u32 s64, s85, 581632
ds_read_b64_tr_b16 a[108:109], v185 offset:40960
v_mfma_f32_16x16x32_bf16 v[112:115], a[84:87], a[228:231], 0
buffer_load_dwordx4 v13, s[36:39], s64 offen lds
v_mfma_f32_16x16x32_bf16 v[112:115], a[80:83], a[224:227], v[112:115]
s_add_u32 s65, s84, 65536
ds_read_b64_tr_b16 a[110:111], v185 offset:45056
v_mfma_f32_16x16x32_bf16 v[80:83], a[80:83], a[216:219], 0
buffer_load_dwordx4 a[0:3], v14, s[44:47], s65 offen offset:0 sc1
v_mfma_f32_16x16x32_bf16 v[80:83], a[84:87], a[220:223], v[80:83]
ds_read_b64_tr_b16 a[112:113], v186 offset:32768
v_mfma_f32_16x16x32_bf16 v[48:51], a[84:87], a[212:215], 0
buffer_load_dwordx4 a[8:11], v14, s[44:47], s65 offen offset:1024 sc1
v_mfma_f32_16x16x32_bf16 v[48:51], a[80:83], a[208:211], v[48:51]
s_waitcnt lgkmcnt(4)
ds_read_b64_tr_b16 a[114:115], v186 offset:36864
v_mfma_f32_16x16x32_bf16 v[52:55], a[88:91], a[208:211], 0
ds_read_b64_tr_b16 a[116:117], v186 offset:40960
v_mfma_f32_16x16x32_bf16 v[52:55], a[92:95], a[212:215], v[52:55]
buffer_load_dwordx4 a[16:19], v15, s[44:47], s65 offen offset:0 sc1
v_mfma_f32_16x16x32_bf16 v[84:87], a[92:95], a[220:223], 0
ds_read_b64_tr_b16 a[118:119], v186 offset:45056
v_mfma_f32_16x16x32_bf16 v[84:87], a[88:91], a[216:219], v[84:87]
buffer_load_dwordx4 a[24:27], v15, s[44:47], s65 offen offset:1024 sc1
v_mfma_f32_16x16x32_bf16 v[116:119], a[88:91], a[224:227], 0
s_add_u32 s65, s84, 73728
ds_read_b64_tr_b16 a[120:121], v187 offset:32768
v_mfma_f32_16x16x32_bf16 v[116:119], a[92:95], a[228:231], v[116:119]
buffer_load_dwordx4 a[4:7], v14, s[44:47], s65 offen offset:0 sc1
v_mfma_f32_16x16x32_bf16 v[148:151], a[92:95], a[236:239], 0
ds_read_b64_tr_b16 a[122:123], v187 offset:36864
v_mfma_f32_16x16x32_bf16 v[148:151], a[88:91], a[232:235], v[148:151]
ds_read_b64_tr_b16 a[124:125], v187 offset:40960
v_mfma_f32_16x16x32_bf16 v[120:123], a[96:99], a[232:235], 0
buffer_load_dwordx4 a[12:15], v14, s[44:47], s65 offen offset:1024 sc1
v_mfma_f32_16x16x32_bf16 v[120:123], a[100:103], a[236:239], v[120:123]
ds_read_b64_tr_b16 a[126:127], v187 offset:45056
v_mfma_f32_16x16x32_bf16 v[88:91], a[100:103], a[228:231], 0
buffer_load_dwordx4 a[20:23], v15, s[44:47], s65 offen offset:0 sc1
v_mfma_f32_16x16x32_bf16 v[88:91], a[96:99], a[224:227], v[88:91]
v_mfma_f32_16x16x32_bf16 v[56:59], a[96:99], a[216:219], 0
buffer_load_dwordx4 a[28:31], v15, s[44:47], s65 offen offset:1024 sc1
v_mfma_f32_16x16x32_bf16 v[56:59], a[100:103], a[220:223], v[56:59]
v_mfma_f32_16x16x32_bf16 v[24:27], a[100:103], a[212:215], 0
v_mfma_f32_16x16x32_bf16 v[24:27], a[96:99], a[208:211], v[24:27]
s_waitcnt lgkmcnt(1)
v_mfma_f32_16x16x32_bf16 v[28:31], a[104:107], a[208:211], 0
s_add_u32 s71, s79, 4096
s_add_u32 s72, s80, 4096
s_waitcnt vmcnt(23)
s_barrier
v_mfma_f32_16x16x32_bf16 v[28:31], a[108:111], a[212:215], v[28:31]
s_add_u32 m0, s86, 98304
ds_read_b64_tr_b16 a[64:65], v196 offset:0
v_mfma_f32_16x16x32_bf16 v[60:63], a[108:111], a[220:223], 0
s_add_u32 s64, s85, 786432
ds_read_b64_tr_b16 a[66:67], v196 offset:4096
v_mfma_f32_16x16x32_bf16 v[60:63], a[104:107], a[216:219], v[60:63]
buffer_load_dwordx4 v12, s[36:39], s64 offen lds
v_mfma_f32_16x16x32_bf16 v[92:95], a[104:107], a[224:227], 0
ds_read_b64_tr_b16 a[68:69], v196 offset:8192
v_mfma_f32_16x16x32_bf16 v[92:95], a[108:111], a[228:231], v[92:95]
s_add_u32 m0, s86, 99328
ds_read_b64_tr_b16 a[70:71], v196 offset:12288
v_mfma_f32_16x16x32_bf16 v[124:127], a[108:111], a[236:239], 0
s_add_u32 s64, s85, 794624
ds_read_b64_tr_b16 a[72:73], v197 offset:0
v_mfma_f32_16x16x32_bf16 v[124:127], a[104:107], a[232:235], v[124:127]
buffer_load_dwordx4 v13, s[36:39], s64 offen lds
v_mfma_f32_16x16x32_bf16 v[128:131], a[112:115], a[232:235], 0
ds_read_b64_tr_b16 a[74:75], v197 offset:4096
v_mfma_f32_16x16x32_bf16 v[128:131], a[116:119], a[236:239], v[128:131]
s_add_u32 m0, s86, 100352
ds_read_b64_tr_b16 a[76:77], v197 offset:8192
v_mfma_f32_16x16x32_bf16 v[96:99], a[116:119], a[228:231], 0
s_add_u32 s64, s85, 802816
ds_read_b64_tr_b16 a[78:79], v197 offset:12288
v_mfma_f32_16x16x32_bf16 v[96:99], a[112:115], a[224:227], v[96:99]
buffer_load_dwordx4 v12, s[36:39], s64 offen lds
v_mfma_f32_16x16x32_bf16 v[64:67], a[112:115], a[216:219], 0
ds_read_b64_tr_b16 a[80:81], v198 offset:0
v_mfma_f32_16x16x32_bf16 v[64:67], a[116:119], a[220:223], v[64:67]
s_add_u32 m0, s86, 101376
ds_read_b64_tr_b16 a[82:83], v198 offset:4096
v_mfma_f32_16x16x32_bf16 v[32:35], a[116:119], a[212:215], 0
s_add_u32 s64, s85, 811008
ds_read_b64_tr_b16 a[84:85], v198 offset:8192
v_mfma_f32_16x16x32_bf16 v[32:35], a[112:115], a[208:211], v[32:35]
buffer_load_dwordx4 v13, s[36:39], s64 offen lds
v_mfma_f32_16x16x32_bf16 v[36:39], a[120:123], a[208:211], 0
s_waitcnt lgkmcnt(5)
ds_read_b64_tr_b16 a[86:87], v198 offset:12288
v_mfma_f32_16x16x32_bf16 v[36:39], a[124:127], a[212:215], v[36:39]
s_add_u32 m0, s86, 102400
v_mfma_f32_16x16x32_bf16 v[68:71], a[124:127], a[220:223], 0
s_add_u32 s64, s85, 819200
v_mfma_f32_16x16x32_bf16 v[68:71], a[120:123], a[216:219], v[68:71]
buffer_load_dwordx4 v12, s[36:39], s64 offen lds
v_mfma_f32_16x16x32_bf16 v[100:103], a[120:123], a[224:227], 0
v_mfma_f32_16x16x32_bf16 v[100:103], a[124:127], a[228:231], v[100:103]
v_mfma_f32_16x16x32_bf16 v[132:135], a[124:127], a[236:239], 0
v_mfma_f32_16x16x32_bf16 v[132:135], a[120:123], a[232:235], v[132:135]
v_mfma_f32_16x16x32_bf16 v[136:139], a[64:67], v[176:179], v[136:139]
s_add_u32 m0, s86, 103424
ds_read_b64_tr_b16 a[88:89], v199 offset:0
v_mfma_f32_16x16x32_bf16 v[136:139], a[68:71], v[180:183], v[136:139]
s_add_u32 s64, s85, 827392
ds_read_b64_tr_b16 a[90:91], v199 offset:4096
v_mfma_f32_16x16x32_bf16 v[104:107], a[68:71], v[172:175], v[104:107]
buffer_load_dwordx4 v13, s[36:39], s64 offen lds
v_mfma_f32_16x16x32_bf16 v[104:107], a[64:67], v[168:171], v[104:107]
s_add_u32 m0, s86, 104448
ds_read_b64_tr_b16 a[92:93], v199 offset:8192
v_mfma_f32_16x16x32_bf16 v[72:75], a[64:67], v[160:163], v[72:75]
s_add_u32 s64, s85, 835584
ds_read_b64_tr_b16 a[94:95], v199 offset:12288
v_mfma_f32_16x16x32_bf16 v[72:75], a[68:71], v[164:167], v[72:75]
buffer_load_dwordx4 v12, s[36:39], s64 offen lds
v_mfma_f32_16x16x32_bf16 v[40:43], a[68:71], v[156:159], v[40:43]
s_add_u32 m0, s86, 105472
ds_read_b64_tr_b16 a[96:97], v192 offset:0
v_mfma_f32_16x16x32_bf16 v[40:43], a[64:67], v[152:155], v[40:43]
s_add_u32 s64, s85, 843776
ds_read_b64_tr_b16 a[98:99], v192 offset:4096
v_mfma_f32_16x16x32_bf16 v[44:47], a[72:75], v[152:155], v[44:47]
s_waitcnt lgkmcnt(5)
buffer_load_dwordx4 v13, s[36:39], s64 offen lds
v_mfma_f32_16x16x32_bf16 v[44:47], a[76:79], v[156:159], v[44:47]
ds_read_b64_tr_b16 a[100:101], v192 offset:8192
v_mfma_f32_16x16x32_bf16 v[76:79], a[76:79], v[164:167], v[76:79]
ds_read_b64_tr_b16 a[102:103], v192 offset:12288
v_mfma_f32_16x16x32_bf16 v[76:79], a[72:75], v[160:163], v[76:79]
s_add_u32 s65, s84, 98304
ds_read_b64_tr_b16 a[104:105], v193 offset:0
v_mfma_f32_16x16x32_bf16 v[108:111], a[72:75], v[168:171], v[108:111]
buffer_load_dwordx4 a[32:35], v14, s[44:47], s65 offen offset:0 sc1
v_mfma_f32_16x16x32_bf16 v[108:111], a[76:79], v[172:175], v[108:111]
ds_read_b64_tr_b16 a[106:107], v193 offset:4096
v_mfma_f32_16x16x32_bf16 v[140:143], a[76:79], v[180:183], v[140:143]
ds_read_b64_tr_b16 a[108:109], v193 offset:8192
v_mfma_f32_16x16x32_bf16 v[140:143], a[72:75], v[176:179], v[140:143]
buffer_load_dwordx4 a[40:43], v14, s[44:47], s65 offen offset:1024 sc1
v_mfma_f32_16x16x32_bf16 v[144:147], a[80:83], v[176:179], v[144:147]
ds_read_b64_tr_b16 a[110:111], v193 offset:12288
v_mfma_f32_16x16x32_bf16 v[144:147], a[84:87], v[180:183], v[144:147]
v_mfma_f32_16x16x32_bf16 v[112:115], a[84:87], v[172:175], v[112:115]
buffer_load_dwordx4 a[48:51], v15, s[44:47], s65 offen offset:0 sc1
v_mfma_f32_16x16x32_bf16 v[112:115], a[80:83], v[168:171], v[112:115]
ds_read_b64_tr_b16 a[112:113], v194 offset:0
v_mfma_f32_16x16x32_bf16 v[80:83], a[80:83], v[160:163], v[80:83]
ds_read_b64_tr_b16 a[114:115], v194 offset:4096
v_mfma_f32_16x16x32_bf16 v[80:83], a[84:87], v[164:167], v[80:83]
ds_read_b64_tr_b16 a[116:117], v194 offset:8192
v_mfma_f32_16x16x32_bf16 v[48:51], a[84:87], v[156:159], v[48:51]
buffer_load_dwordx4 a[56:59], v15, s[44:47], s65 offen offset:1024 sc1
v_mfma_f32_16x16x32_bf16 v[48:51], a[80:83], v[152:155], v[48:51]
s_waitcnt lgkmcnt(4)
ds_read_b64_tr_b16 a[118:119], v194 offset:12288
v_mfma_f32_16x16x32_bf16 v[52:55], a[88:91], v[152:155], v[52:55]
s_add_u32 s65, s84, 106496
v_mfma_f32_16x16x32_bf16 v[52:55], a[92:95], v[156:159], v[52:55]
buffer_load_dwordx4 a[36:39], v14, s[44:47], s65 offen offset:0 sc1
v_mfma_f32_16x16x32_bf16 v[84:87], a[92:95], v[164:167], v[84:87]
ds_read_b64_tr_b16 a[120:121], v195 offset:0
v_mfma_f32_16x16x32_bf16 v[84:87], a[88:91], v[160:163], v[84:87]
ds_read_b64_tr_b16 a[122:123], v195 offset:4096
v_mfma_f32_16x16x32_bf16 v[116:119], a[88:91], v[168:171], v[116:119]
s_lshl_b32 s66, s30, 30
buffer_load_dwordx4 a[44:47], v14, s[44:47], s65 offen offset:1024 sc1
v_mfma_f32_16x16x32_bf16 v[116:119], a[92:95], v[172:175], v[116:119]
ds_read_b64_tr_b16 a[124:125], v195 offset:8192
v_lshl_add_u32 v1, v0, 24, s66
v_mfma_f32_16x16x32_bf16 v[148:151], a[92:95], v[180:183], v[148:151]
ds_read_b64_tr_b16 a[126:127], v195 offset:12288
v_mfma_f32_16x16x32_bf16 v[148:151], a[88:91], v[176:179], v[148:151]
v_mfma_f32_16x16x32_bf16 v[120:123], a[96:99], v[176:179], v[120:123]
buffer_load_dwordx4 a[52:55], v15, s[44:47], s65 offen offset:0 sc1
v_mfma_f32_16x16x32_bf16 v[120:123], a[100:103], v[180:183], v[120:123]
v_mfma_f32_16x16x32_bf16 v[88:91], a[100:103], v[172:175], v[88:91]
v_mfma_f32_16x16x32_bf16 v[88:91], a[96:99], v[168:171], v[88:91]
buffer_load_dwordx4 a[60:63], v15, s[44:47], s65 offen offset:1024 sc1
v_mfma_f32_16x16x32_bf16 v[56:59], a[96:99], v[160:163], v[56:59]
v_mfma_f32_16x16x32_bf16 v[56:59], a[100:103], v[164:167], v[56:59]
v_mfma_f32_16x16x32_bf16 v[24:27], a[100:103], v[156:159], v[24:27]
v_mfma_f32_16x16x32_bf16 v[24:27], a[96:99], v[152:155], v[24:27]
v_mfma_f32_16x16x32_bf16 v[28:31], a[104:107], v[152:155], v[28:31]
s_waitcnt vmcnt(24)
s_barrier
s_waitcnt lgkmcnt(0)
v_mfma_f32_16x16x32_bf16 v[28:31], a[108:111], v[156:159], v[28:31]
s_mul_i32 s66, s83, 3145728
s_add_u32 s85, s85, s66
v_mfma_f32_16x16x32_bf16 v[60:63], a[108:111], v[164:167], v[60:63]
s_mov_b64 exec, 1
buffer_atomic_add a251, v1, s[52:55], s71 offen offset:0 sc1
s_mov_b64 exec, -1
v_mfma_f32_16x16x32_bf16 v[60:63], a[104:107], v[160:163], v[60:63]
s_add_u32 m0, s86, 131072
ds_read_b64_tr_b16 a[64:65], v196 offset:32768
v_mfma_f32_16x16x32_bf16 v[92:95], a[104:107], v[168:171], v[92:95]
s_add_u32 s64, s85, 0
ds_read_b64_tr_b16 a[66:67], v196 offset:36864
v_mfma_f32_16x16x32_bf16 v[92:95], a[108:111], v[172:175], v[92:95]
buffer_load_dwordx4 v12, s[40:43], s64 offen lds
v_mfma_f32_16x16x32_bf16 v[124:127], a[108:111], v[180:183], v[124:127]
ds_read_b64_tr_b16 a[68:69], v196 offset:40960
v_mfma_f32_16x16x32_bf16 v[124:127], a[104:107], v[176:179], v[124:127]
s_add_u32 m0, s86, 132096
ds_read_b64_tr_b16 a[70:71], v196 offset:45056
v_mfma_f32_16x16x32_bf16 v[128:131], a[112:115], v[176:179], v[128:131]
s_add_u32 s64, s85, 8192
ds_read_b64_tr_b16 a[72:73], v197 offset:32768
v_mfma_f32_16x16x32_bf16 v[128:131], a[116:119], v[180:183], v[128:131]
buffer_load_dwordx4 v13, s[40:43], s64 offen lds
v_mfma_f32_16x16x32_bf16 v[96:99], a[116:119], v[172:175], v[96:99]
ds_read_b64_tr_b16 a[74:75], v197 offset:36864
v_mfma_f32_16x16x32_bf16 v[96:99], a[112:115], v[168:171], v[96:99]
ds_read_b64_tr_b16 a[76:77], v197 offset:40960
v_mfma_f32_16x16x32_bf16 v[64:67], a[112:115], v[160:163], v[64:67]
s_add_u32 m0, s86, 133120
ds_read_b64_tr_b16 a[78:79], v197 offset:45056
v_mfma_f32_16x16x32_bf16 v[64:67], a[116:119], v[164:167], v[64:67]
s_add_u32 s64, s85, 16384
ds_read_b64_tr_b16 a[80:81], v198 offset:32768
v_mfma_f32_16x16x32_bf16 v[32:35], a[116:119], v[156:159], v[32:35]
buffer_load_dwordx4 v12, s[40:43], s64 offen lds
v_mfma_f32_16x16x32_bf16 v[32:35], a[112:115], v[152:155], v[32:35]
ds_read_b64_tr_b16 a[82:83], v198 offset:36864
v_mfma_f32_16x16x32_bf16 v[36:39], a[120:123], v[152:155], v[36:39]
ds_read_b64_tr_b16 a[84:85], v198 offset:40960
v_mfma_f32_16x16x32_bf16 v[36:39], a[124:127], v[156:159], v[36:39]
s_add_u32 m0, s86, 134144
ds_read_b64_tr_b16 a[86:87], v198 offset:45056
v_mfma_f32_16x16x32_bf16 v[68:71], a[124:127], v[164:167], v[68:71]
s_add_u32 s64, s85, 24576
v_mfma_f32_16x16x32_bf16 v[68:71], a[120:123], v[160:163], v[68:71]
buffer_load_dwordx4 v13, s[40:43], s64 offen lds
v_mfma_f32_16x16x32_bf16 v[100:103], a[120:123], v[168:171], v[100:103]
v_mfma_f32_16x16x32_bf16 v[100:103], a[124:127], v[172:175], v[100:103]
v_mfma_f32_16x16x32_bf16 v[132:135], a[124:127], v[180:183], v[132:135]
v_mfma_f32_16x16x32_bf16 v[132:135], a[120:123], v[176:179], v[132:135]
s_waitcnt vmcnt(25)
s_waitcnt lgkmcnt(2)
v_mfma_f32_16x16x32_bf16 v[136:139], a[64:67], a[24:27], v[136:139]
s_waitcnt vmcnt(21)
s_add_u32 m0, s86, 135168
ds_read_b64_tr_b16 a[88:89], v199 offset:32768
v_mfma_f32_16x16x32_bf16 v[136:139], a[68:71], a[28:31], v[136:139]
s_add_u32 s64, s85, 32768
ds_read_b64_tr_b16 a[90:91], v199 offset:36864
v_mfma_f32_16x16x32_bf16 v[104:107], a[68:71], a[20:23], v[104:107]
buffer_load_dwordx4 v12, s[40:43], s64 offen lds
v_mfma_f32_16x16x32_bf16 v[104:107], a[64:67], a[16:19], v[104:107]
ds_read_b64_tr_b16 a[92:93], v199 offset:40960
v_mfma_f32_16x16x32_bf16 v[72:75], a[64:67], a[8:11], v[72:75]
s_add_u32 m0, s86, 136192
ds_read_b64_tr_b16 a[94:95], v199 offset:45056
v_mfma_f32_16x16x32_bf16 v[72:75], a[68:71], a[12:15], v[72:75]
s_add_u32 s64, s85, 40960
ds_read_b64_tr_b16 a[96:97], v192 offset:32768
v_mfma_f32_16x16x32_bf16 v[40:43], a[68:71], a[4:7], v[40:43]
buffer_load_dwordx4 v13, s[40:43], s64 offen lds
v_mfma_f32_16x16x32_bf16 v[40:43], a[64:67], a[0:3], v[40:43]
ds_read_b64_tr_b16 a[98:99], v192 offset:36864
v_mfma_f32_16x16x32_bf16 v[44:47], a[72:75], a[0:3], v[44:47]
ds_read_b64_tr_b16 a[100:101], v192 offset:40960
v_mfma_f32_16x16x32_bf16 v[44:47], a[76:79], a[4:7], v[44:47]
s_add_u32 m0, s86, 137216
ds_read_b64_tr_b16 a[102:103], v192 offset:45056
v_mfma_f32_16x16x32_bf16 v[76:79], a[76:79], a[12:15], v[76:79]
s_add_u32 s64, s85, 49152
ds_read_b64_tr_b16 a[104:105], v193 offset:32768
v_mfma_f32_16x16x32_bf16 v[76:79], a[72:75], a[8:11], v[76:79]
buffer_load_dwordx4 v12, s[40:43], s64 offen lds
v_mfma_f32_16x16x32_bf16 v[108:111], a[72:75], a[16:19], v[108:111]
ds_read_b64_tr_b16 a[106:107], v193 offset:36864
v_mfma_f32_16x16x32_bf16 v[108:111], a[76:79], a[20:23], v[108:111]
s_add_u32 m0, s86, 138240
ds_read_b64_tr_b16 a[108:109], v193 offset:40960
v_mfma_f32_16x16x32_bf16 v[140:143], a[76:79], a[28:31], v[140:143]
s_add_u32 s64, s85, 57344
ds_read_b64_tr_b16 a[110:111], v193 offset:45056
v_mfma_f32_16x16x32_bf16 v[140:143], a[72:75], a[24:27], v[140:143]
s_add_u32 s17, s78, .-L_pc+2048
buffer_load_dwordx4 v13, s[40:43], s64 offen lds
v_mfma_f32_16x16x32_bf16 v[144:147], a[80:83], a[24:27], v[144:147]
s_waitcnt lgkmcnt(5)
buffer_load_dword a252, v16, s[88:91], s17 offen
v_mfma_f32_16x16x32_bf16 v[144:147], a[84:87], a[28:31], v[144:147]
v_mfma_f32_16x16x32_bf16 v[112:115], a[84:87], a[20:23], v[112:115]
s_add_u32 s17, s78, .-L_pc+6144
ds_read_b64_tr_b16 a[112:113], v194 offset:32768
v_mfma_f32_16x16x32_bf16 v[112:115], a[80:83], a[16:19], v[112:115]
buffer_load_dword a252, v16, s[88:91], s17 offen
v_mfma_f32_16x16x32_bf16 v[80:83], a[80:83], a[8:11], v[80:83]
ds_read_b64_tr_b16 a[114:115], v194 offset:36864
v_mfma_f32_16x16x32_bf16 v[80:83], a[84:87], a[12:15], v[80:83]
s_add_u32 s17, s78, .-L_pc+10240
ds_read_b64_tr_b16 a[116:117], v194 offset:40960
v_mfma_f32_16x16x32_bf16 v[48:51], a[84:87], a[4:7], v[48:51]
buffer_load_dword a252, v16, s[88:91], s17 offen
v_mfma_f32_16x16x32_bf16 v[48:51], a[80:83], a[0:3], v[48:51]
ds_read_b64_tr_b16 a[118:119], v194 offset:45056
v_mfma_f32_16x16x32_bf16 v[52:55], a[88:91], a[0:3], v[52:55]
buffer_load_dword v19, off, s[52:55], s72 sc1
v_mfma_f32_16x16x32_bf16 v[52:55], a[92:95], a[4:7], v[52:55]
v_mfma_f32_16x16x32_bf16 v[84:87], a[92:95], a[12:15], v[84:87]
ds_read_b64_tr_b16 a[120:121], v195 offset:32768
v_mfma_f32_16x16x32_bf16 v[84:87], a[88:91], a[8:11], v[84:87]
ds_read_b64_tr_b16 a[122:123], v195 offset:36864
v_mfma_f32_16x16x32_bf16 v[116:119], a[88:91], a[16:19], v[116:119]
ds_read_b64_tr_b16 a[124:125], v195 offset:40960
v_mfma_f32_16x16x32_bf16 v[116:119], a[92:95], a[20:23], v[116:119]
ds_read_b64_tr_b16 a[126:127], v195 offset:45056
v_mfma_f32_16x16x32_bf16 v[148:151], a[92:95], a[28:31], v[148:151]
v_mfma_f32_16x16x32_bf16 v[148:151], a[88:91], a[24:27], v[148:151]
v_mfma_f32_16x16x32_bf16 v[120:123], a[96:99], a[24:27], v[120:123]
s_waitcnt lgkmcnt(4)
v_mfma_f32_16x16x32_bf16 v[120:123], a[100:103], a[28:31], v[120:123]
v_mfma_f32_16x16x32_bf16 v[88:91], a[100:103], a[20:23], v[88:91]
v_mfma_f32_16x16x32_bf16 v[88:91], a[96:99], a[16:19], v[88:91]
v_mfma_f32_16x16x32_bf16 v[56:59], a[96:99], a[8:11], v[56:59]
v_mfma_f32_16x16x32_bf16 v[56:59], a[100:103], a[12:15], v[56:59]
v_mfma_f32_16x16x32_bf16 v[24:27], a[100:103], a[4:7], v[24:27]
v_mfma_f32_16x16x32_bf16 v[24:27], a[96:99], a[0:3], v[24:27]
v_mfma_f32_16x16x32_bf16 v[28:31], a[104:107], a[0:3], v[28:31]
s_waitcnt vmcnt(21)
s_barrier
v_mfma_f32_16x16x32_bf16 v[28:31], a[108:111], a[4:7], v[28:31]
s_add_u32 m0, s86, 32768
ds_read_b64_tr_b16 a[64:65], v188 offset:0
v_mfma_f32_16x16x32_bf16 v[60:63], a[108:111], a[12:15], v[60:63]
s_add_u32 s64, s85, 262144
ds_read_b64_tr_b16 a[66:67], v188 offset:4096
v_mfma_f32_16x16x32_bf16 v[60:63], a[104:107], a[8:11], v[60:63]
buffer_load_dwordx4 v12, s[40:43], s64 offen lds
v_mfma_f32_16x16x32_bf16 v[92:95], a[104:107], a[16:19], v[92:95]
s_add_u32 m0, s86, 33792
ds_read_b64_tr_b16 a[68:69], v188 offset:8192
v_mfma_f32_16x16x32_bf16 v[92:95], a[108:111], a[20:23], v[92:95]
s_add_u32 s64, s85, 270336
ds_read_b64_tr_b16 a[70:71], v188 offset:12288
v_mfma_f32_16x16x32_bf16 v[124:127], a[108:111], a[28:31], v[124:127]
buffer_load_dwordx4 v13, s[40:43], s64 offen lds
v_mfma_f32_16x16x32_bf16 v[124:127], a[104:107], a[24:27], v[124:127]
ds_read_b64_tr_b16 a[72:73], v189 offset:0
v_mfma_f32_16x16x32_bf16 v[128:131], a[112:115], a[24:27], v[128:131]
s_add_u32 m0, s86, 34816
ds_read_b64_tr_b16 a[74:75], v189 offset:4096
v_mfma_f32_16x16x32_bf16 v[128:131], a[116:119], a[28:31], v[128:131]
s_add_u32 s64, s85, 278528
ds_read_b64_tr_b16 a[76:77], v189 offset:8192
v_mfma_f32_16x16x32_bf16 v[96:99], a[116:119], a[20:23], v[96:99]
buffer_load_dwordx4 v12, s[40:43], s64 offen lds
v_mfma_f32_16x16x32_bf16 v[96:99], a[112:115], a[16:19], v[96:99]
s_add_u32 m0, s86, 35840
ds_read_b64_tr_b16 a[78:79], v189 offset:12288
v_mfma_f32_16x16x32_bf16 v[64:67], a[112:115], a[8:11], v[64:67]
s_add_u32 s64, s85, 286720
ds_read_b64_tr_b16 a[80:81], v190 offset:0
v_mfma_f32_16x16x32_bf16 v[64:67], a[116:119], a[12:15], v[64:67]
buffer_load_dwordx4 v13, s[40:43], s64 offen lds
v_mfma_f32_16x16x32_bf16 v[32:35], a[116:119], a[4:7], v[32:35]
ds_read_b64_tr_b16 a[82:83], v190 offset:4096
v_mfma_f32_16x16x32_bf16 v[32:35], a[112:115], a[0:3], v[32:35]
s_waitcnt lgkmcnt(5)
s_add_u32 m0, s86, 36864
ds_read_b64_tr_b16 a[84:85], v190 offset:8192
v_mfma_f32_16x16x32_bf16 v[36:39], a[120:123], a[0:3], v[36:39]
s_add_u32 s64, s85, 294912
ds_read_b64_tr_b16 a[86:87], v190 offset:12288
v_mfma_f32_16x16x32_bf16 v[36:39], a[124:127], a[4:7], v[36:39]
buffer_load_dwordx4 v12, s[40:43], s64 offen lds
v_mfma_f32_16x16x32_bf16 v[68:71], a[124:127], a[12:15], v[68:71]
s_add_u32 m0, s86, 37888
v_mfma_f32_16x16x32_bf16 v[68:71], a[120:123], a[8:11], v[68:71]
s_add_u32 s64, s85, 303104
v_mfma_f32_16x16x32_bf16 v[100:103], a[120:123], a[16:19], v[100:103]
buffer_load_dwordx4 v13, s[40:43], s64 offen lds
v_mfma_f32_16x16x32_bf16 v[100:103], a[124:127], a[20:23], v[100:103]
v_mfma_f32_16x16x32_bf16 v[132:135], a[124:127], a[28:31], v[132:135]
v_mfma_f32_16x16x32_bf16 v[132:135], a[120:123], a[24:27], v[132:135]
s_waitcnt vmcnt(23)
v_mfma_f32_16x16x32_bf16 v[136:139], a[64:67], a[56:59], v[136:139]
s_waitcnt vmcnt(6)
v_readfirstlane_b32 vcc_lo, v19
s_nop 0
s_cmp_lt_u32 vcc_lo, 16
s_cbranch_scc1 L_spin_2016
L_spinbk_2017:
s_mul_i32 s66, s83, 393216
s_add_u32 s84, s84, s66
s_sub_u32 s84, s84, 1048576
v_mfma_f32_16x16x32_bf16 v[136:139], a[68:71], a[60:63], v[136:139]
s_add_u32 s65, s84, 0
ds_read_b64_tr_b16 a[88:89], v191 offset:0
v_mfma_f32_16x16x32_bf16 v[104:107], a[68:71], a[52:55], v[104:107]
buffer_load_dwordx4 a[208:211], v14, s[44:47], s65 offen offset:0 sc1
v_mfma_f32_16x16x32_bf16 v[104:107], a[64:67], a[48:51], v[104:107]
ds_read_b64_tr_b16 a[90:91], v191 offset:4096
v_mfma_f32_16x16x32_bf16 v[72:75], a[64:67], a[40:43], v[72:75]
buffer_load_dwordx4 a[216:219], v14, s[44:47], s65 offen offset:1024 sc1
v_mfma_f32_16x16x32_bf16 v[72:75], a[68:71], a[44:47], v[72:75]
ds_read_b64_tr_b16 a[92:93], v191 offset:8192
v_mfma_f32_16x16x32_bf16 v[40:43], a[68:71], a[36:39], v[40:43]
buffer_load_dwordx4 a[224:227], v15, s[44:47], s65 offen offset:0 sc1
v_mfma_f32_16x16x32_bf16 v[40:43], a[64:67], a[32:35], v[40:43]
s_waitcnt lgkmcnt(3)
ds_read_b64_tr_b16 a[94:95], v191 offset:12288
v_mfma_f32_16x16x32_bf16 v[44:47], a[72:75], a[32:35], v[44:47]
buffer_load_dwordx4 a[232:235], v15, s[44:47], s65 offen offset:1024 sc1
v_mfma_f32_16x16x32_bf16 v[44:47], a[76:79], a[36:39], v[44:47]
s_add_u32 s65, s84, 8192
ds_read_b64_tr_b16 a[96:97], v184 offset:0
v_mfma_f32_16x16x32_bf16 v[76:79], a[76:79], a[44:47], v[76:79]
buffer_load_dwordx4 a[212:215], v14, s[44:47], s65 offen offset:0 sc1
v_mfma_f32_16x16x32_bf16 v[76:79], a[72:75], a[40:43], v[76:79]
ds_read_b64_tr_b16 a[98:99], v184 offset:4096
v_mfma_f32_16x16x32_bf16 v[108:111], a[72:75], a[48:51], v[108:111]
buffer_load_dwordx4 a[220:223], v14, s[44:47], s65 offen offset:1024 sc1
v_mfma_f32_16x16x32_bf16 v[108:111], a[76:79], a[52:55], v[108:111]
ds_read_b64_tr_b16 a[100:101], v184 offset:8192
v_mfma_f32_16x16x32_bf16 v[140:143], a[76:79], a[60:63], v[140:143]
buffer_load_dwordx4 a[228:231], v15, s[44:47], s65 offen offset:0 sc1
v_mfma_f32_16x16x32_bf16 v[140:143], a[72:75], a[56:59], v[140:143]
ds_read_b64_tr_b16 a[102:103], v184 offset:12288
v_mfma_f32_16x16x32_bf16 v[144:147], a[80:83], a[56:59], v[144:147]
buffer_load_dwordx4 a[236:239], v15, s[44:47], s65 offen offset:1024 sc1
v_mfma_f32_16x16x32_bf16 v[144:147], a[84:87], a[60:63], v[144:147]
s_add_u32 m0, s86, 38912
s_add_u32 s64, s85, 311296
ds_read_b64_tr_b16 a[104:105], v185 offset:0
v_mfma_f32_16x16x32_bf16 v[112:115], a[84:87], a[52:55], v[112:115]
buffer_load_dwordx4 v12, s[40:43], s64 offen lds
v_mfma_f32_16x16x32_bf16 v[112:115], a[80:83], a[48:51], v[112:115]
s_add_u32 m0, s86, 39936
s_add_u32 s64, s85, 319488
ds_read_b64_tr_b16 a[106:107], v185 offset:4096
v_mfma_f32_16x16x32_bf16 v[80:83], a[80:83], a[40:43], v[80:83]
buffer_load_dwordx4 v13, s[40:43], s64 offen lds
v_mfma_f32_16x16x32_bf16 v[80:83], a[84:87], a[44:47], v[80:83]
s_add_u32 s65, s84, 32768
ds_read_b64_tr_b16 a[108:109], v185 offset:8192
v_mfma_f32_16x16x32_bf16 v[48:51], a[84:87], a[36:39], v[48:51]
buffer_load_dwordx4 v[152:155], v14, s[44:47], s65 offen offset:0 sc1
v_mfma_f32_16x16x32_bf16 v[48:51], a[80:83], a[32:35], v[48:51]
s_waitcnt lgkmcnt(3)
ds_read_b64_tr_b16 a[110:111], v185 offset:12288
v_mfma_f32_16x16x32_bf16 v[52:55], a[88:91], a[32:35], v[52:55]
buffer_load_dwordx4 v[160:163], v14, s[44:47], s65 offen offset:1024 sc1
v_mfma_f32_16x16x32_bf16 v[52:55], a[92:95], a[36:39], v[52:55]
ds_read_b64_tr_b16 a[112:113], v186 offset:0
v_mfma_f32_16x16x32_bf16 v[84:87], a[92:95], a[44:47], v[84:87]
buffer_load_dwordx4 v[168:171], v15, s[44:47], s65 offen offset:0 sc1
v_mfma_f32_16x16x32_bf16 v[84:87], a[88:91], a[40:43], v[84:87]
ds_read_b64_tr_b16 a[114:115], v186 offset:4096
v_mfma_f32_16x16x32_bf16 v[116:119], a[88:91], a[48:51], v[116:119]
buffer_load_dwordx4 v[176:179], v15, s[44:47], s65 offen offset:1024 sc1
v_mfma_f32_16x16x32_bf16 v[116:119], a[92:95], a[52:55], v[116:119]
s_add_u32 s65, s84, 40960
ds_read_b64_tr_b16 a[116:117], v186 offset:8192
v_mfma_f32_16x16x32_bf16 v[148:151], a[92:95], a[60:63], v[148:151]
buffer_load_dwordx4 v[156:159], v14, s[44:47], s65 offen offset:0 sc1
v_mfma_f32_16x16x32_bf16 v[148:151], a[88:91], a[56:59], v[148:151]
ds_read_b64_tr_b16 a[118:119], v186 offset:12288
v_mfma_f32_16x16x32_bf16 v[120:123], a[96:99], a[56:59], v[120:123]
buffer_load_dwordx4 v[164:167], v14, s[44:47], s65 offen offset:1024 sc1
v_mfma_f32_16x16x32_bf16 v[120:123], a[100:103], a[60:63], v[120:123]
ds_read_b64_tr_b16 a[120:121], v187 offset:0
v_mfma_f32_16x16x32_bf16 v[88:91], a[100:103], a[52:55], v[88:91]
buffer_load_dwordx4 v[172:175], v15, s[44:47], s65 offen offset:0 sc1
v_mfma_f32_16x16x32_bf16 v[88:91], a[96:99], a[48:51], v[88:91]
ds_read_b64_tr_b16 a[122:123], v187 offset:4096
v_mfma_f32_16x16x32_bf16 v[56:59], a[96:99], a[40:43], v[56:59]
buffer_load_dwordx4 v[180:183], v15, s[44:47], s65 offen offset:1024 sc1
v_mfma_f32_16x16x32_bf16 v[56:59], a[100:103], a[44:47], v[56:59]
ds_read_b64_tr_b16 a[124:125], v187 offset:8192
v_mfma_f32_16x16x32_bf16 v[24:27], a[100:103], a[36:39], v[24:27]
ds_read_b64_tr_b16 a[126:127], v187 offset:12288
v_mfma_f32_16x16x32_bf16 v[24:27], a[96:99], a[32:35], v[24:27]
s_waitcnt lgkmcnt(4)
v_mfma_f32_16x16x32_bf16 v[28:31], a[104:107], a[32:35], v[28:31]
s_barrier
v_mfma_f32_16x16x32_bf16 v[28:31], a[108:111], a[36:39], v[28:31]
s_add_u32 m0, s86, 65536
ds_read_b64_tr_b16 a[64:65], v188 offset:32768
v_mfma_f32_16x16x32_bf16 v[60:63], a[108:111], a[44:47], v[60:63]
s_add_u32 s64, s85, 524288
ds_read_b64_tr_b16 a[66:67], v188 offset:36864
v_mfma_f32_16x16x32_bf16 v[60:63], a[104:107], a[40:43], v[60:63]
buffer_load_dwordx4 v12, s[40:43], s64 offen lds
v_mfma_f32_16x16x32_bf16 v[92:95], a[104:107], a[48:51], v[92:95]
ds_read_b64_tr_b16 a[68:69], v188 offset:40960
v_mfma_f32_16x16x32_bf16 v[92:95], a[108:111], a[52:55], v[92:95]
s_add_u32 m0, s86, 66560
ds_read_b64_tr_b16 a[70:71], v188 offset:45056
v_mfma_f32_16x16x32_bf16 v[124:127], a[108:111], a[60:63], v[124:127]
s_add_u32 s64, s85, 532480
ds_read_b64_tr_b16 a[72:73], v189 offset:32768
v_mfma_f32_16x16x32_bf16 v[124:127], a[104:107], a[56:59], v[124:127]
buffer_load_dwordx4 v13, s[40:43], s64 offen lds
v_mfma_f32_16x16x32_bf16 v[128:131], a[112:115], a[56:59], v[128:131]
ds_read_b64_tr_b16 a[74:75], v189 offset:36864
v_mfma_f32_16x16x32_bf16 v[128:131], a[116:119], a[60:63], v[128:131]
s_add_u32 m0, s86, 67584
ds_read_b64_tr_b16 a[76:77], v189 offset:40960
v_mfma_f32_16x16x32_bf16 v[96:99], a[116:119], a[52:55], v[96:99]
s_add_u32 s64, s85, 540672
ds_read_b64_tr_b16 a[78:79], v189 offset:45056
v_mfma_f32_16x16x32_bf16 v[96:99], a[112:115], a[48:51], v[96:99]
buffer_load_dwordx4 v12, s[40:43], s64 offen lds
v_mfma_f32_16x16x32_bf16 v[64:67], a[112:115], a[40:43], v[64:67]
ds_read_b64_tr_b16 a[80:81], v190 offset:32768
v_mfma_f32_16x16x32_bf16 v[64:67], a[116:119], a[44:47], v[64:67]
s_add_u32 m0, s86, 68608
ds_read_b64_tr_b16 a[82:83], v190 offset:36864
v_mfma_f32_16x16x32_bf16 v[32:35], a[116:119], a[36:39], v[32:35]
s_add_u32 s64, s85, 548864
ds_read_b64_tr_b16 a[84:85], v190 offset:40960
v_mfma_f32_16x16x32_bf16 v[32:35], a[112:115], a[32:35], v[32:35]
s_waitcnt lgkmcnt(6)
buffer_load_dwordx4 v13, s[40:43], s64 offen lds
v_mfma_f32_16x16x32_bf16 v[36:39], a[120:123], a[32:35], v[36:39]
ds_read_b64_tr_b16 a[86:87], v190 offset:45056
v_mfma_f32_16x16x32_bf16 v[36:39], a[124:127], a[36:39], v[36:39]
s_add_u32 m0, s86, 69632
v_mfma_f32_16x16x32_bf16 v[68:71], a[124:127], a[44:47], v[68:71]
s_add_u32 s64, s85, 557056
v_mfma_f32_16x16x32_bf16 v[68:71], a[120:123], a[40:43], v[68:71]
buffer_load_dwordx4 v12, s[40:43], s64 offen lds
v_mfma_f32_16x16x32_bf16 v[100:103], a[120:123], a[48:51], v[100:103]
v_mfma_f32_16x16x32_bf16 v[100:103], a[124:127], a[52:55], v[100:103]
v_mfma_f32_16x16x32_bf16 v[132:135], a[124:127], a[60:63], v[132:135]
v_mfma_f32_16x16x32_bf16 v[132:135], a[120:123], a[56:59], v[132:135]
s_mov_b32 s70, 3
.p2align 3
L_p5_2019:
s_waitcnt vmcnt(19)
v_mfma_f32_16x16x32_bf16 v[136:139], a[64:67], a[232:235], v[136:139]
s_waitcnt vmcnt(15)
s_add_u32 m0, s86, 70656
s_add_u32 s64, s85, 565248
ds_read_b64_tr_b16 a[88:89], v191 offset:32768
v_mfma_f32_16x16x32_bf16 v[136:139], a[68:71], a[236:239], v[136:139]
buffer_load_dwordx4 v13, s[40:43], s64 offen lds
v_mfma_f32_16x16x32_bf16 v[104:107], a[68:71], a[228:231], v[104:107]
s_add_u32 m0, s86, 71680
ds_read_b64_tr_b16 a[90:91], v191 offset:36864
v_mfma_f32_16x16x32_bf16 v[104:107], a[64:67], a[224:227], v[104:107]
s_add_u32 s64, s85, 573440
ds_read_b64_tr_b16 a[92:93], v191 offset:40960
v_mfma_f32_16x16x32_bf16 v[72:75], a[64:67], a[216:219], v[72:75]
buffer_load_dwordx4 v12, s[40:43], s64 offen lds
v_mfma_f32_16x16x32_bf16 v[72:75], a[68:71], a[220:223], v[72:75]
s_add_u32 m0, s86, 72704
ds_read_b64_tr_b16 a[94:95], v191 offset:45056
v_mfma_f32_16x16x32_bf16 v[40:43], a[68:71], a[212:215], v[40:43]
s_add_u32 s64, s85, 581632
ds_read_b64_tr_b16 a[96:97], v184 offset:32768
v_mfma_f32_16x16x32_bf16 v[40:43], a[64:67], a[208:211], v[40:43]
s_waitcnt lgkmcnt(5)
buffer_load_dwordx4 v13, s[40:43], s64 offen lds
v_mfma_f32_16x16x32_bf16 v[44:47], a[72:75], a[208:211], v[44:47]
ds_read_b64_tr_b16 a[98:99], v184 offset:36864
v_mfma_f32_16x16x32_bf16 v[44:47], a[76:79], a[212:215], v[44:47]
ds_read_b64_tr_b16 a[100:101], v184 offset:40960
v_mfma_f32_16x16x32_bf16 v[76:79], a[76:79], a[220:223], v[76:79]
s_add_u32 s65, s84, 65536
ds_read_b64_tr_b16 a[102:103], v184 offset:45056
v_mfma_f32_16x16x32_bf16 v[76:79], a[72:75], a[216:219], v[76:79]
buffer_load_dwordx4 a[0:3], v14, s[44:47], s65 offen offset:0 sc1
v_mfma_f32_16x16x32_bf16 v[108:111], a[72:75], a[224:227], v[108:111]
ds_read_b64_tr_b16 a[104:105], v185 offset:32768
v_mfma_f32_16x16x32_bf16 v[108:111], a[76:79], a[228:231], v[108:111]
ds_read_b64_tr_b16 a[106:107], v185 offset:36864
v_mfma_f32_16x16x32_bf16 v[140:143], a[76:79], a[236:239], v[140:143]
buffer_load_dwordx4 a[8:11], v14, s[44:47], s65 offen offset:1024 sc1
v_mfma_f32_16x16x32_bf16 v[140:143], a[72:75], a[232:235], v[140:143]
ds_read_b64_tr_b16 a[108:109], v185 offset:40960
v_mfma_f32_16x16x32_bf16 v[144:147], a[80:83], a[232:235], v[144:147]
ds_read_b64_tr_b16 a[110:111], v185 offset:45056
v_mfma_f32_16x16x32_bf16 v[144:147], a[84:87], a[236:239], v[144:147]
v_mfma_f32_16x16x32_bf16 v[112:115], a[84:87], a[228:231], v[112:115]
buffer_load_dwordx4 a[16:19], v15, s[44:47], s65 offen offset:0 sc1
v_mfma_f32_16x16x32_bf16 v[112:115], a[80:83], a[224:227], v[112:115]
ds_read_b64_tr_b16 a[112:113], v186 offset:32768
v_mfma_f32_16x16x32_bf16 v[80:83], a[80:83], a[216:219], v[80:83]
ds_read_b64_tr_b16 a[114:115], v186 offset:36864
v_mfma_f32_16x16x32_bf16 v[80:83], a[84:87], a[220:223], v[80:83]
buffer_load_dwordx4 a[24:27], v15, s[44:47], s65 offen offset:1024 sc1
v_mfma_f32_16x16x32_bf16 v[48:51], a[84:87], a[212:215], v[48:51]
ds_read_b64_tr_b16 a[116:117], v186 offset:40960
v_mfma_f32_16x16x32_bf16 v[48:51], a[80:83], a[208:211], v[48:51]
s_waitcnt lgkmcnt(4)
ds_read_b64_tr_b16 a[118:119], v186 offset:45056
v_mfma_f32_16x16x32_bf16 v[52:55], a[88:91], a[208:211], v[52:55]
s_add_u32 s65, s84, 73728
v_mfma_f32_16x16x32_bf16 v[52:55], a[92:95], a[212:215], v[52:55]
buffer_load_dwordx4 a[4:7], v14, s[44:47], s65 offen offset:0 sc1
v_mfma_f32_16x16x32_bf16 v[84:87], a[92:95], a[220:223], v[84:87]
ds_read_b64_tr_b16 a[120:121], v187 offset:32768
v_mfma_f32_16x16x32_bf16 v[84:87], a[88:91], a[216:219], v[84:87]
ds_read_b64_tr_b16 a[122:123], v187 offset:36864
v_mfma_f32_16x16x32_bf16 v[116:119], a[88:91], a[224:227], v[116:119]
buffer_load_dwordx4 a[12:15], v14, s[44:47], s65 offen offset:1024 sc1
v_mfma_f32_16x16x32_bf16 v[116:119], a[92:95], a[228:231], v[116:119]
ds_read_b64_tr_b16 a[124:125], v187 offset:40960
v_mfma_f32_16x16x32_bf16 v[148:151], a[92:95], a[236:239], v[148:151]
ds_read_b64_tr_b16 a[126:127], v187 offset:45056
v_mfma_f32_16x16x32_bf16 v[148:151], a[88:91], a[232:235], v[148:151]
v_mfma_f32_16x16x32_bf16 v[120:123], a[96:99], a[232:235], v[120:123]
buffer_load_dwordx4 a[20:23], v15, s[44:47], s65 offen offset:0 sc1
v_mfma_f32_16x16x32_bf16 v[120:123], a[100:103], a[236:239], v[120:123]
v_mfma_f32_16x16x32_bf16 v[88:91], a[100:103], a[228:231], v[88:91]
v_mfma_f32_16x16x32_bf16 v[88:91], a[96:99], a[224:227], v[88:91]
buffer_load_dwordx4 a[28:31], v15, s[44:47], s65 offen offset:1024 sc1
v_mfma_f32_16x16x32_bf16 v[56:59], a[96:99], a[216:219], v[56:59]
v_mfma_f32_16x16x32_bf16 v[56:59], a[100:103], a[220:223], v[56:59]
v_mfma_f32_16x16x32_bf16 v[24:27], a[100:103], a[212:215], v[24:27]
v_mfma_f32_16x16x32_bf16 v[24:27], a[96:99], a[208:211], v[24:27]
v_mfma_f32_16x16x32_bf16 v[28:31], a[104:107], a[208:211], v[28:31]
s_waitcnt vmcnt(24)
s_barrier
s_waitcnt lgkmcnt(0)
v_mfma_f32_16x16x32_bf16 v[28:31], a[108:111], a[212:215], v[28:31]
s_add_u32 m0, s86, 98304
ds_read_b64_tr_b16 a[64:65], v196 offset:0
v_mfma_f32_16x16x32_bf16 v[60:63], a[108:111], a[220:223], v[60:63]
s_add_u32 s64, s85, 786432
ds_read_b64_tr_b16 a[66:67], v196 offset:4096
v_mfma_f32_16x16x32_bf16 v[60:63], a[104:107], a[216:219], v[60:63]
buffer_load_dwordx4 v12, s[40:43], s64 offen lds
v_mfma_f32_16x16x32_bf16 v[92:95], a[104:107], a[224:227], v[92:95]
ds_read_b64_tr_b16 a[68:69], v196 offset:8192
v_mfma_f32_16x16x32_bf16 v[92:95], a[108:111], a[228:231], v[92:95]
s_add_u32 m0, s86, 99328
ds_read_b64_tr_b16 a[70:71], v196 offset:12288
v_mfma_f32_16x16x32_bf16 v[124:127], a[108:111], a[236:239], v[124:127]
s_add_u32 s64, s85, 794624
ds_read_b64_tr_b16 a[72:73], v197 offset:0
v_mfma_f32_16x16x32_bf16 v[124:127], a[104:107], a[232:235], v[124:127]
buffer_load_dwordx4 v13, s[40:43], s64 offen lds
v_mfma_f32_16x16x32_bf16 v[128:131], a[112:115], a[232:235], v[128:131]
ds_read_b64_tr_b16 a[74:75], v197 offset:4096
v_mfma_f32_16x16x32_bf16 v[128:131], a[116:119], a[236:239], v[128:131]
s_add_u32 m0, s86, 100352
ds_read_b64_tr_b16 a[76:77], v197 offset:8192
v_mfma_f32_16x16x32_bf16 v[96:99], a[116:119], a[228:231], v[96:99]
s_add_u32 s64, s85, 802816
ds_read_b64_tr_b16 a[78:79], v197 offset:12288
v_mfma_f32_16x16x32_bf16 v[96:99], a[112:115], a[224:227], v[96:99]
buffer_load_dwordx4 v12, s[40:43], s64 offen lds
v_mfma_f32_16x16x32_bf16 v[64:67], a[112:115], a[216:219], v[64:67]
ds_read_b64_tr_b16 a[80:81], v198 offset:0
v_mfma_f32_16x16x32_bf16 v[64:67], a[116:119], a[220:223], v[64:67]
s_add_u32 m0, s86, 101376
ds_read_b64_tr_b16 a[82:83], v198 offset:4096
v_mfma_f32_16x16x32_bf16 v[32:35], a[116:119], a[212:215], v[32:35]
s_add_u32 s64, s85, 811008
ds_read_b64_tr_b16 a[84:85], v198 offset:8192
v_mfma_f32_16x16x32_bf16 v[32:35], a[112:115], a[208:211], v[32:35]
buffer_load_dwordx4 v13, s[40:43], s64 offen lds
v_mfma_f32_16x16x32_bf16 v[36:39], a[120:123], a[208:211], v[36:39]
ds_read_b64_tr_b16 a[86:87], v198 offset:12288
v_mfma_f32_16x16x32_bf16 v[36:39], a[124:127], a[212:215], v[36:39]
s_add_u32 m0, s86, 102400
v_mfma_f32_16x16x32_bf16 v[68:71], a[124:127], a[220:223], v[68:71]
s_add_u32 s64, s85, 819200
v_mfma_f32_16x16x32_bf16 v[68:71], a[120:123], a[216:219], v[68:71]
buffer_load_dwordx4 v12, s[40:43], s64 offen lds
v_mfma_f32_16x16x32_bf16 v[100:103], a[120:123], a[224:227], v[100:103]
v_mfma_f32_16x16x32_bf16 v[100:103], a[124:127], a[228:231], v[100:103]
v_mfma_f32_16x16x32_bf16 v[132:135], a[124:127], a[236:239], v[132:135]
v_mfma_f32_16x16x32_bf16 v[132:135], a[120:123], a[232:235], v[132:135]
s_waitcnt vmcnt(25)
s_waitcnt lgkmcnt(1)
s_add_u32 m0, s86, 103424
v_mfma_f32_16x16x32_bf16 v[136:139], a[64:67], v[176:179], v[136:139]
s_waitcnt vmcnt(21)
s_add_u32 s64, s85, 827392
ds_read_b64_tr_b16 a[88:89], v199 offset:0
v_mfma_f32_16x16x32_bf16 v[136:139], a[68:71], v[180:183], v[136:139]
buffer_load_dwordx4 v13, s[40:43], s64 offen lds
v_mfma_f32_16x16x32_bf16 v[104:107], a[68:71], v[172:175], v[104:107]
s_add_u32 m0, s86, 104448
ds_read_b64_tr_b16 a[90:91], v199 offset:4096
v_mfma_f32_16x16x32_bf16 v[104:107], a[64:67], v[168:171], v[104:107]
s_add_u32 s64, s85, 835584
ds_read_b64_tr_b16 a[92:93], v199 offset:8192
v_mfma_f32_16x16x32_bf16 v[72:75], a[64:67], v[160:163], v[72:75]
buffer_load_dwordx4 v12, s[40:43], s64 offen lds
v_mfma_f32_16x16x32_bf16 v[72:75], a[68:71], v[164:167], v[72:75]
s_add_u32 m0, s86, 105472
ds_read_b64_tr_b16 a[94:95], v199 offset:12288
v_mfma_f32_16x16x32_bf16 v[40:43], a[68:71], v[156:159], v[40:43]
s_add_u32 s64, s85, 843776
ds_read_b64_tr_b16 a[96:97], v192 offset:0
v_mfma_f32_16x16x32_bf16 v[40:43], a[64:67], v[152:155], v[40:43]
buffer_load_dwordx4 v13, s[40:43], s64 offen lds
v_mfma_f32_16x16x32_bf16 v[44:47], a[72:75], v[152:155], v[44:47]
ds_read_b64_tr_b16 a[98:99], v192 offset:4096
v_mfma_f32_16x16x32_bf16 v[44:47], a[76:79], v[156:159], v[44:47]
ds_read_b64_tr_b16 a[100:101], v192 offset:8192
v_mfma_f32_16x16x32_bf16 v[76:79], a[76:79], v[164:167], v[76:79]
s_add_u32 s65, s84, 98304
ds_read_b64_tr_b16 a[102:103], v192 offset:12288
v_mfma_f32_16x16x32_bf16 v[76:79], a[72:75], v[160:163], v[76:79]
buffer_load_dwordx4 a[32:35], v14, s[44:47], s65 offen offset:0 sc1
v_mfma_f32_16x16x32_bf16 v[108:111], a[72:75], v[168:171], v[108:111]
ds_read_b64_tr_b16 a[104:105], v193 offset:0
v_mfma_f32_16x16x32_bf16 v[108:111], a[76:79], v[172:175], v[108:111]
ds_read_b64_tr_b16 a[106:107], v193 offset:4096
v_mfma_f32_16x16x32_bf16 v[140:143], a[76:79], v[180:183], v[140:143]
buffer_load_dwordx4 a[40:43], v14, s[44:47], s65 offen offset:1024 sc1
v_mfma_f32_16x16x32_bf16 v[140:143], a[72:75], v[176:179], v[140:143]
ds_read_b64_tr_b16 a[108:109], v193 offset:8192
v_mfma_f32_16x16x32_bf16 v[144:147], a[80:83], v[176:179], v[144:147]
s_waitcnt lgkmcnt(5)
ds_read_b64_tr_b16 a[110:111], v193 offset:12288
v_mfma_f32_16x16x32_bf16 v[144:147], a[84:87], v[180:183], v[144:147]
v_mfma_f32_16x16x32_bf16 v[112:115], a[84:87], v[172:175], v[112:115]
buffer_load_dwordx4 a[48:51], v15, s[44:47], s65 offen offset:0 sc1
v_mfma_f32_16x16x32_bf16 v[112:115], a[80:83], v[168:171], v[112:115]
ds_read_b64_tr_b16 a[112:113], v194 offset:0
v_mfma_f32_16x16x32_bf16 v[80:83], a[80:83], v[160:163], v[80:83]
ds_read_b64_tr_b16 a[114:115], v194 offset:4096
v_mfma_f32_16x16x32_bf16 v[80:83], a[84:87], v[164:167], v[80:83]
buffer_load_dwordx4 a[56:59], v15, s[44:47], s65 offen offset:1024 sc1
v_mfma_f32_16x16x32_bf16 v[48:51], a[84:87], v[156:159], v[48:51]
ds_read_b64_tr_b16 a[116:117], v194 offset:8192
v_mfma_f32_16x16x32_bf16 v[48:51], a[80:83], v[152:155], v[48:51]
ds_read_b64_tr_b16 a[118:119], v194 offset:12288
v_mfma_f32_16x16x32_bf16 v[52:55], a[88:91], v[152:155], v[52:55]
s_add_u32 s65, s84, 106496
v_mfma_f32_16x16x32_bf16 v[52:55], a[92:95], v[156:159], v[52:55]
buffer_load_dwordx4 a[36:39], v14, s[44:47], s65 offen offset:0 sc1
v_mfma_f32_16x16x32_bf16 v[84:87], a[92:95], v[164:167], v[84:87]
ds_read_b64_tr_b16 a[120:121], v195 offset:0
v_mfma_f32_16x16x32_bf16 v[84:87], a[88:91], v[160:163], v[84:87]
ds_read_b64_tr_b16 a[122:123], v195 offset:4096
v_mfma_f32_16x16x32_bf16 v[116:119], a[88:91], v[168:171], v[116:119]
buffer_load_dwordx4 a[44:47], v14, s[44:47], s65 offen offset:1024 sc1
v_mfma_f32_16x16x32_bf16 v[116:119], a[92:95], v[172:175], v[116:119]
ds_read_b64_tr_b16 a[124:125], v195 offset:8192
v_mfma_f32_16x16x32_bf16 v[148:151], a[92:95], v[180:183], v[148:151]
ds_read_b64_tr_b16 a[126:127], v195 offset:12288
v_mfma_f32_16x16x32_bf16 v[148:151], a[88:91], v[176:179], v[148:151]
v_mfma_f32_16x16x32_bf16 v[120:123], a[96:99], v[176:179], v[120:123]
s_waitcnt lgkmcnt(4)
buffer_load_dwordx4 a[52:55], v15, s[44:47], s65 offen offset:0 sc1
v_mfma_f32_16x16x32_bf16 v[120:123], a[100:103], v[180:183], v[120:123]
v_mfma_f32_16x16x32_bf16 v[88:91], a[100:103], v[172:175], v[88:91]
v_mfma_f32_16x16x32_bf16 v[88:91], a[96:99], v[168:171], v[88:91]
buffer_load_dwordx4 a[60:63], v15, s[44:47], s65 offen offset:1024 sc1
v_mfma_f32_16x16x32_bf16 v[56:59], a[96:99], v[160:163], v[56:59]
v_mfma_f32_16x16x32_bf16 v[56:59], a[100:103], v[164:167], v[56:59]
v_mfma_f32_16x16x32_bf16 v[24:27], a[100:103], v[156:159], v[24:27]
v_mfma_f32_16x16x32_bf16 v[24:27], a[96:99], v[152:155], v[24:27]
v_mfma_f32_16x16x32_bf16 v[28:31], a[104:107], v[152:155], v[28:31]
s_waitcnt vmcnt(24)
s_barrier
v_mfma_f32_16x16x32_bf16 v[28:31], a[108:111], v[156:159], v[28:31]
s_add_u32 m0, s86, 131072
ds_read_b64_tr_b16 a[64:65], v196 offset:32768
v_mfma_f32_16x16x32_bf16 v[60:63], a[108:111], v[164:167], v[60:63]
s_add_u32 s64, s85, 1048576
ds_read_b64_tr_b16 a[66:67], v196 offset:36864
v_mfma_f32_16x16x32_bf16 v[60:63], a[104:107], v[160:163], v[60:63]
buffer_load_dwordx4 v12, s[40:43], s64 offen lds
v_mfma_f32_16x16x32_bf16 v[92:95], a[104:107], v[168:171], v[92:95]
ds_read_b64_tr_b16 a[68:69], v196 offset:40960
v_mfma_f32_16x16x32_bf16 v[92:95], a[108:111], v[172:175], v[92:95]
s_add_u32 m0, s86, 132096
ds_read_b64_tr_b16 a[70:71], v196 offset:45056
v_mfma_f32_16x16x32_bf16 v[124:127], a[108:111], v[180:183], v[124:127]
s_add_u32 s64, s85, 1056768
ds_read_b64_tr_b16 a[72:73], v197 offset:32768
v_mfma_f32_16x16x32_bf16 v[124:127], a[104:107], v[176:179], v[124:127]
buffer_load_dwordx4 v13, s[40:43], s64 offen lds
v_mfma_f32_16x16x32_bf16 v[128:131], a[112:115], v[176:179], v[128:131]
ds_read_b64_tr_b16 a[74:75], v197 offset:36864
v_mfma_f32_16x16x32_bf16 v[128:131], a[116:119], v[180:183], v[128:131]
s_add_u32 m0, s86, 133120
ds_read_b64_tr_b16 a[76:77], v197 offset:40960
v_mfma_f32_16x16x32_bf16 v[96:99], a[116:119], v[172:175], v[96:99]
s_add_u32 s64, s85, 1064960
ds_read_b64_tr_b16 a[78:79], v197 offset:45056
v_mfma_f32_16x16x32_bf16 v[96:99], a[112:115], v[168:171], v[96:99]
buffer_load_dwordx4 v12, s[40:43], s64 offen lds
v_mfma_f32_16x16x32_bf16 v[64:67], a[112:115], v[160:163], v[64:67]
ds_read_b64_tr_b16 a[80:81], v198 offset:32768
v_mfma_f32_16x16x32_bf16 v[64:67], a[116:119], v[164:167], v[64:67]
s_add_u32 m0, s86, 134144
ds_read_b64_tr_b16 a[82:83], v198 offset:36864
v_mfma_f32_16x16x32_bf16 v[32:35], a[116:119], v[156:159], v[32:35]
s_add_u32 s64, s85, 1073152
ds_read_b64_tr_b16 a[84:85], v198 offset:40960
v_mfma_f32_16x16x32_bf16 v[32:35], a[112:115], v[152:155], v[32:35]
s_waitcnt lgkmcnt(6)
buffer_load_dwordx4 v13, s[40:43], s64 offen lds
v_mfma_f32_16x16x32_bf16 v[36:39], a[120:123], v[152:155], v[36:39]
ds_read_b64_tr_b16 a[86:87], v198 offset:45056
v_mfma_f32_16x16x32_bf16 v[36:39], a[124:127], v[156:159], v[36:39]
s_add_u32 m0, s86, 135168
v_mfma_f32_16x16x32_bf16 v[68:71], a[124:127], v[164:167], v[68:71]
s_add_u32 s64, s85, 1081344
v_mfma_f32_16x16x32_bf16 v[68:71], a[120:123], v[160:163], v[68:71]
buffer_load_dwordx4 v12, s[40:43], s64 offen lds
v_mfma_f32_16x16x32_bf16 v[100:103], a[120:123], v[168:171], v[100:103]
v_mfma_f32_16x16x32_bf16 v[100:103], a[124:127], v[172:175], v[100:103]
v_mfma_f32_16x16x32_bf16 v[132:135], a[124:127], v[180:183], v[132:135]
v_mfma_f32_16x16x32_bf16 v[132:135], a[120:123], v[176:179], v[132:135]
s_waitcnt vmcnt(25)
s_add_u32 m0, s86, 136192
v_mfma_f32_16x16x32_bf16 v[136:139], a[64:67], a[24:27], v[136:139]
s_waitcnt vmcnt(21)
s_add_u32 s64, s85, 1089536
ds_read_b64_tr_b16 a[88:89], v199 offset:32768
v_mfma_f32_16x16x32_bf16 v[136:139], a[68:71], a[28:31], v[136:139]
buffer_load_dwordx4 v13, s[40:43], s64 offen lds
v_mfma_f32_16x16x32_bf16 v[104:107], a[68:71], a[20:23], v[104:107]
s_add_u32 m0, s86, 137216
ds_read_b64_tr_b16 a[90:91], v199 offset:36864
v_mfma_f32_16x16x32_bf16 v[104:107], a[64:67], a[16:19], v[104:107]
s_add_u32 s64, s85, 1097728
ds_read_b64_tr_b16 a[92:93], v199 offset:40960
v_mfma_f32_16x16x32_bf16 v[72:75], a[64:67], a[8:11], v[72:75]
buffer_load_dwordx4 v12, s[40:43], s64 offen lds
v_mfma_f32_16x16x32_bf16 v[72:75], a[68:71], a[12:15], v[72:75]
s_add_u32 m0, s86, 138240
ds_read_b64_tr_b16 a[94:95], v199 offset:45056
v_mfma_f32_16x16x32_bf16 v[40:43], a[68:71], a[4:7], v[40:43]
s_add_u32 s64, s85, 1105920
ds_read_b64_tr_b16 a[96:97], v192 offset:32768
v_mfma_f32_16x16x32_bf16 v[40:43], a[64:67], a[0:3], v[40:43]
s_waitcnt lgkmcnt(5)
buffer_load_dwordx4 v13, s[40:43], s64 offen lds
v_mfma_f32_16x16x32_bf16 v[44:47], a[72:75], a[0:3], v[44:47]
ds_read_b64_tr_b16 a[98:99], v192 offset:36864
v_mfma_f32_16x16x32_bf16 v[44:47], a[76:79], a[4:7], v[44:47]
ds_read_b64_tr_b16 a[100:101], v192 offset:40960
v_mfma_f32_16x16x32_bf16 v[76:79], a[76:79], a[12:15], v[76:79]
s_add_u32 s65, s84, 131072
ds_read_b64_tr_b16 a[102:103], v192 offset:45056
v_mfma_f32_16x16x32_bf16 v[76:79], a[72:75], a[8:11], v[76:79]
buffer_load_dwordx4 a[208:211], v14, s[44:47], s65 offen offset:0 sc1
v_mfma_f32_16x16x32_bf16 v[108:111], a[72:75], a[16:19], v[108:111]
ds_read_b64_tr_b16 a[104:105], v193 offset:32768
v_mfma_f32_16x16x32_bf16 v[108:111], a[76:79], a[20:23], v[108:111]
ds_read_b64_tr_b16 a[106:107], v193 offset:36864
v_mfma_f32_16x16x32_bf16 v[140:143], a[76:79], a[28:31], v[140:143]
buffer_load_dwordx4 a[216:219], v14, s[44:47], s65 offen offset:1024 sc1
v_mfma_f32_16x16x32_bf16 v[140:143], a[72:75], a[24:27], v[140:143]
ds_read_b64_tr_b16 a[108:109], v193 offset:40960
v_mfma_f32_16x16x32_bf16 v[144:147], a[80:83], a[24:27], v[144:147]
ds_read_b64_tr_b16 a[110:111], v193 offset:45056
v_mfma_f32_16x16x32_bf16 v[144:147], a[84:87], a[28:31], v[144:147]
v_mfma_f32_16x16x32_bf16 v[112:115], a[84:87], a[20:23], v[112:115]
buffer_load_dwordx4 a[224:227], v15, s[44:47], s65 offen offset:0 sc1
v_mfma_f32_16x16x32_bf16 v[112:115], a[80:83], a[16:19], v[112:115]
ds_read_b64_tr_b16 a[112:113], v194 offset:32768
v_mfma_f32_16x16x32_bf16 v[80:83], a[80:83], a[8:11], v[80:83]
ds_read_b64_tr_b16 a[114:115], v194 offset:36864
v_mfma_f32_16x16x32_bf16 v[80:83], a[84:87], a[12:15], v[80:83]
buffer_load_dwordx4 a[232:235], v15, s[44:47], s65 offen offset:1024 sc1
v_mfma_f32_16x16x32_bf16 v[48:51], a[84:87], a[4:7], v[48:51]
ds_read_b64_tr_b16 a[116:117], v194 offset:40960
v_mfma_f32_16x16x32_bf16 v[48:51], a[80:83], a[0:3], v[48:51]
s_waitcnt lgkmcnt(4)
ds_read_b64_tr_b16 a[118:119], v194 offset:45056
v_mfma_f32_16x16x32_bf16 v[52:55], a[88:91], a[0:3], v[52:55]
s_add_u32 s65, s84, 139264
v_mfma_f32_16x16x32_bf16 v[52:55], a[92:95], a[4:7], v[52:55]
buffer_load_dwordx4 a[212:215], v14, s[44:47], s65 offen offset:0 sc1
v_mfma_f32_16x16x32_bf16 v[84:87], a[92:95], a[12:15], v[84:87]
ds_read_b64_tr_b16 a[120:121], v195 offset:32768
v_mfma_f32_16x16x32_bf16 v[84:87], a[88:91], a[8:11], v[84:87]
ds_read_b64_tr_b16 a[122:123], v195 offset:36864
v_mfma_f32_16x16x32_bf16 v[116:119], a[88:91], a[16:19], v[116:119]
buffer_load_dwordx4 a[220:223], v14, s[44:47], s65 offen offset:1024 sc1
v_mfma_f32_16x16x32_bf16 v[116:119], a[92:95], a[20:23], v[116:119]
ds_read_b64_tr_b16 a[124:125], v195 offset:40960
v_mfma_f32_16x16x32_bf16 v[148:151], a[92:95], a[28:31], v[148:151]
ds_read_b64_tr_b16 a[126:127], v195 offset:45056
v_mfma_f32_16x16x32_bf16 v[148:151], a[88:91], a[24:27], v[148:151]
v_mfma_f32_16x16x32_bf16 v[120:123], a[96:99], a[24:27], v[120:123]
buffer_load_dwordx4 a[228:231], v15, s[44:47], s65 offen offset:0 sc1
v_mfma_f32_16x16x32_bf16 v[120:123], a[100:103], a[28:31], v[120:123]
v_mfma_f32_16x16x32_bf16 v[88:91], a[100:103], a[20:23], v[88:91]
v_mfma_f32_16x16x32_bf16 v[88:91], a[96:99], a[16:19], v[88:91]
buffer_load_dwordx4 a[236:239], v15, s[44:47], s65 offen offset:1024 sc1
v_mfma_f32_16x16x32_bf16 v[56:59], a[96:99], a[8:11], v[56:59]
v_mfma_f32_16x16x32_bf16 v[56:59], a[100:103], a[12:15], v[56:59]
v_mfma_f32_16x16x32_bf16 v[24:27], a[100:103], a[4:7], v[24:27]
v_mfma_f32_16x16x32_bf16 v[24:27], a[96:99], a[0:3], v[24:27]
v_mfma_f32_16x16x32_bf16 v[28:31], a[104:107], a[0:3], v[28:31]
s_waitcnt vmcnt(24)
s_barrier
s_waitcnt lgkmcnt(0)
v_mfma_f32_16x16x32_bf16 v[28:31], a[108:111], a[4:7], v[28:31]
s_add_u32 m0, s86, 32768
ds_read_b64_tr_b16 a[64:65], v188 offset:0
v_mfma_f32_16x16x32_bf16 v[60:63], a[108:111], a[12:15], v[60:63]
s_add_u32 s64, s85, 1310720
ds_read_b64_tr_b16 a[66:67], v188 offset:4096
v_mfma_f32_16x16x32_bf16 v[60:63], a[104:107], a[8:11], v[60:63]
buffer_load_dwordx4 v12, s[40:43], s64 offen lds
v_mfma_f32_16x16x32_bf16 v[92:95], a[104:107], a[16:19], v[92:95]
ds_read_b64_tr_b16 a[68:69], v188 offset:8192
v_mfma_f32_16x16x32_bf16 v[92:95], a[108:111], a[20:23], v[92:95]
s_add_u32 m0, s86, 33792
ds_read_b64_tr_b16 a[70:71], v188 offset:12288
v_mfma_f32_16x16x32_bf16 v[124:127], a[108:111], a[28:31], v[124:127]
s_add_u32 s64, s85, 1318912
ds_read_b64_tr_b16 a[72:73], v189 offset:0
v_mfma_f32_16x16x32_bf16 v[124:127], a[104:107], a[24:27], v[124:127]
buffer_load_dwordx4 v13, s[40:43], s64 offen lds
v_mfma_f32_16x16x32_bf16 v[128:131], a[112:115], a[24:27], v[128:131]
ds_read_b64_tr_b16 a[74:75], v189 offset:4096
v_mfma_f32_16x16x32_bf16 v[128:131], a[116:119], a[28:31], v[128:131]
s_add_u32 m0, s86, 34816
ds_read_b64_tr_b16 a[76:77], v189 offset:8192
v_mfma_f32_16x16x32_bf16 v[96:99], a[116:119], a[20:23], v[96:99]
s_add_u32 s64, s85, 1327104
ds_read_b64_tr_b16 a[78:79], v189 offset:12288
v_mfma_f32_16x16x32_bf16 v[96:99], a[112:115], a[16:19], v[96:99]
buffer_load_dwordx4 v12, s[40:43], s64 offen lds
v_mfma_f32_16x16x32_bf16 v[64:67], a[112:115], a[8:11], v[64:67]
ds_read_b64_tr_b16 a[80:81], v190 offset:0
v_mfma_f32_16x16x32_bf16 v[64:67], a[116:119], a[12:15], v[64:67]
s_add_u32 m0, s86, 35840
ds_read_b64_tr_b16 a[82:83], v190 offset:4096
v_mfma_f32_16x16x32_bf16 v[32:35], a[116:119], a[4:7], v[32:35]
s_add_u32 s64, s85, 1335296
ds_read_b64_tr_b16 a[84:85], v190 offset:8192
v_mfma_f32_16x16x32_bf16 v[32:35], a[112:115], a[0:3], v[32:35]
buffer_load_dwordx4 v13, s[40:43], s64 offen lds
v_mfma_f32_16x16x32_bf16 v[36:39], a[120:123], a[0:3], v[36:39]
ds_read_b64_tr_b16 a[86:87], v190 offset:12288
v_mfma_f32_16x16x32_bf16 v[36:39], a[124:127], a[4:7], v[36:39]
s_add_u32 m0, s86, 36864
v_mfma_f32_16x16x32_bf16 v[68:71], a[124:127], a[12:15], v[68:71]
s_add_u32 s64, s85, 1343488
v_mfma_f32_16x16x32_bf16 v[68:71], a[120:123], a[8:11], v[68:71]
buffer_load_dwordx4 v12, s[40:43], s64 offen lds
v_mfma_f32_16x16x32_bf16 v[100:103], a[120:123], a[16:19], v[100:103]
v_mfma_f32_16x16x32_bf16 v[100:103], a[124:127], a[20:23], v[100:103]
v_mfma_f32_16x16x32_bf16 v[132:135], a[124:127], a[28:31], v[132:135]
v_mfma_f32_16x16x32_bf16 v[132:135], a[120:123], a[24:27], v[132:135]
s_waitcnt vmcnt(25)
s_waitcnt lgkmcnt(1)
s_add_u32 m0, s86, 37888
v_mfma_f32_16x16x32_bf16 v[136:139], a[64:67], a[56:59], v[136:139]
s_waitcnt vmcnt(21)
s_add_u32 s64, s85, 1351680
ds_read_b64_tr_b16 a[88:89], v191 offset:0
v_mfma_f32_16x16x32_bf16 v[136:139], a[68:71], a[60:63], v[136:139]
buffer_load_dwordx4 v13, s[40:43], s64 offen lds
v_mfma_f32_16x16x32_bf16 v[104:107], a[68:71], a[52:55], v[104:107]
s_add_u32 m0, s86, 38912
ds_read_b64_tr_b16 a[90:91], v191 offset:4096
v_mfma_f32_16x16x32_bf16 v[104:107], a[64:67], a[48:51], v[104:107]
s_add_u32 s64, s85, 1359872
ds_read_b64_tr_b16 a[92:93], v191 offset:8192
v_mfma_f32_16x16x32_bf16 v[72:75], a[64:67], a[40:43], v[72:75]
buffer_load_dwordx4 v12, s[40:43], s64 offen lds
v_mfma_f32_16x16x32_bf16 v[72:75], a[68:71], a[44:47], v[72:75]
s_add_u32 m0, s86, 39936
ds_read_b64_tr_b16 a[94:95], v191 offset:12288
v_mfma_f32_16x16x32_bf16 v[40:43], a[68:71], a[36:39], v[40:43]
s_add_u32 s64, s85, 1368064
ds_read_b64_tr_b16 a[96:97], v184 offset:0
v_mfma_f32_16x16x32_bf16 v[40:43], a[64:67], a[32:35], v[40:43]
buffer_load_dwordx4 v13, s[40:43], s64 offen lds
v_mfma_f32_16x16x32_bf16 v[44:47], a[72:75], a[32:35], v[44:47]
ds_read_b64_tr_b16 a[98:99], v184 offset:4096
v_mfma_f32_16x16x32_bf16 v[44:47], a[76:79], a[36:39], v[44:47]
ds_read_b64_tr_b16 a[100:101], v184 offset:8192
v_mfma_f32_16x16x32_bf16 v[76:79], a[76:79], a[44:47], v[76:79]
s_add_u32 s65, s84, 163840
ds_read_b64_tr_b16 a[102:103], v184 offset:12288
v_mfma_f32_16x16x32_bf16 v[76:79], a[72:75], a[40:43], v[76:79]
buffer_load_dwordx4 v[152:155], v14, s[44:47], s65 offen offset:0 sc1
v_mfma_f32_16x16x32_bf16 v[108:111], a[72:75], a[48:51], v[108:111]
ds_read_b64_tr_b16 a[104:105], v185 offset:0
v_mfma_f32_16x16x32_bf16 v[108:111], a[76:79], a[52:55], v[108:111]
ds_read_b64_tr_b16 a[106:107], v185 offset:4096
v_mfma_f32_16x16x32_bf16 v[140:143], a[76:79], a[60:63], v[140:143]
buffer_load_dwordx4 v[160:163], v14, s[44:47], s65 offen offset:1024 sc1
v_mfma_f32_16x16x32_bf16 v[140:143], a[72:75], a[56:59], v[140:143]
ds_read_b64_tr_b16 a[108:109], v185 offset:8192
v_mfma_f32_16x16x32_bf16 v[144:147], a[80:83], a[56:59], v[144:147]
s_waitcnt lgkmcnt(5)
ds_read_b64_tr_b16 a[110:111], v185 offset:12288
v_mfma_f32_16x16x32_bf16 v[144:147], a[84:87], a[60:63], v[144:147]
v_mfma_f32_16x16x32_bf16 v[112:115], a[84:87], a[52:55], v[112:115]
buffer_load_dwordx4 v[168:171], v15, s[44:47], s65 offen offset:0 sc1
v_mfma_f32_16x16x32_bf16 v[112:115], a[80:83], a[48:51], v[112:115]
ds_read_b64_tr_b16 a[112:113], v186 offset:0
v_mfma_f32_16x16x32_bf16 v[80:83], a[80:83], a[40:43], v[80:83]
ds_read_b64_tr_b16 a[114:115], v186 offset:4096
v_mfma_f32_16x16x32_bf16 v[80:83], a[84:87], a[44:47], v[80:83]
buffer_load_dwordx4 v[176:179], v15, s[44:47], s65 offen offset:1024 sc1
v_mfma_f32_16x16x32_bf16 v[48:51], a[84:87], a[36:39], v[48:51]
ds_read_b64_tr_b16 a[116:117], v186 offset:8192
v_mfma_f32_16x16x32_bf16 v[48:51], a[80:83], a[32:35], v[48:51]
ds_read_b64_tr_b16 a[118:119], v186 offset:12288
v_mfma_f32_16x16x32_bf16 v[52:55], a[88:91], a[32:35], v[52:55]
s_add_u32 s65, s84, 172032
v_mfma_f32_16x16x32_bf16 v[52:55], a[92:95], a[36:39], v[52:55]
buffer_load_dwordx4 v[156:159], v14, s[44:47], s65 offen offset:0 sc1
v_mfma_f32_16x16x32_bf16 v[84:87], a[92:95], a[44:47], v[84:87]
ds_read_b64_tr_b16 a[120:121], v187 offset:0
v_mfma_f32_16x16x32_bf16 v[84:87], a[88:91], a[40:43], v[84:87]
ds_read_b64_tr_b16 a[122:123], v187 offset:4096
v_mfma_f32_16x16x32_bf16 v[116:119], a[88:91], a[48:51], v[116:119]
buffer_load_dwordx4 v[164:167], v14, s[44:47], s65 offen offset:1024 sc1
v_mfma_f32_16x16x32_bf16 v[116:119], a[92:95], a[52:55], v[116:119]
ds_read_b64_tr_b16 a[124:125], v187 offset:8192
v_mfma_f32_16x16x32_bf16 v[148:151], a[92:95], a[60:63], v[148:151]
ds_read_b64_tr_b16 a[126:127], v187 offset:12288
v_mfma_f32_16x16x32_bf16 v[148:151], a[88:91], a[56:59], v[148:151]
v_mfma_f32_16x16x32_bf16 v[120:123], a[96:99], a[56:59], v[120:123]
s_waitcnt lgkmcnt(4)
buffer_load_dwordx4 v[172:175], v15, s[44:47], s65 offen offset:0 sc1
v_mfma_f32_16x16x32_bf16 v[120:123], a[100:103], a[60:63], v[120:123]
v_mfma_f32_16x16x32_bf16 v[88:91], a[100:103], a[52:55], v[88:91]
v_mfma_f32_16x16x32_bf16 v[88:91], a[96:99], a[48:51], v[88:91]
buffer_load_dwordx4 v[180:183], v15, s[44:47], s65 offen offset:1024 sc1
v_mfma_f32_16x16x32_bf16 v[56:59], a[96:99], a[40:43], v[56:59]
v_mfma_f32_16x16x32_bf16 v[56:59], a[100:103], a[44:47], v[56:59]
v_mfma_f32_16x16x32_bf16 v[24:27], a[100:103], a[36:39], v[24:27]
v_mfma_f32_16x16x32_bf16 v[24:27], a[96:99], a[32:35], v[24:27]
v_mfma_f32_16x16x32_bf16 v[28:31], a[104:107], a[32:35], v[28:31]
s_waitcnt vmcnt(24)
s_barrier
v_mfma_f32_16x16x32_bf16 v[28:31], a[108:111], a[36:39], v[28:31]
s_add_u32 m0, s86, 65536
ds_read_b64_tr_b16 a[64:65], v188 offset:32768
v_mfma_f32_16x16x32_bf16 v[60:63], a[108:111], a[44:47], v[60:63]
s_add_u32 s64, s85, 1572864
ds_read_b64_tr_b16 a[66:67], v188 offset:36864
v_mfma_f32_16x16x32_bf16 v[60:63], a[104:107], a[40:43], v[60:63]
buffer_load_dwordx4 v12, s[40:43], s64 offen lds
v_mfma_f32_16x16x32_bf16 v[92:95], a[104:107], a[48:51], v[92:95]
ds_read_b64_tr_b16 a[68:69], v188 offset:40960
v_mfma_f32_16x16x32_bf16 v[92:95], a[108:111], a[52:55], v[92:95]
s_add_u32 m0, s86, 66560
ds_read_b64_tr_b16 a[70:71], v188 offset:45056
v_mfma_f32_16x16x32_bf16 v[124:127], a[108:111], a[60:63], v[124:127]
s_add_u32 s64, s85, 1581056
ds_read_b64_tr_b16 a[72:73], v189 offset:32768
v_mfma_f32_16x16x32_bf16 v[124:127], a[104:107], a[56:59], v[124:127]
buffer_load_dwordx4 v13, s[40:43], s64 offen lds
v_mfma_f32_16x16x32_bf16 v[128:131], a[112:115], a[56:59], v[128:131]
ds_read_b64_tr_b16 a[74:75], v189 offset:36864
v_mfma_f32_16x16x32_bf16 v[128:131], a[116:119], a[60:63], v[128:131]
s_add_u32 m0, s86, 67584
ds_read_b64_tr_b16 a[76:77], v189 offset:40960
v_mfma_f32_16x16x32_bf16 v[96:99], a[116:119], a[52:55], v[96:99]
s_add_u32 s64, s85, 1589248
ds_read_b64_tr_b16 a[78:79], v189 offset:45056
v_mfma_f32_16x16x32_bf16 v[96:99], a[112:115], a[48:51], v[96:99]
buffer_load_dwordx4 v12, s[40:43], s64 offen lds
v_mfma_f32_16x16x32_bf16 v[64:67], a[112:115], a[40:43], v[64:67]
ds_read_b64_tr_b16 a[80:81], v190 offset:32768
v_mfma_f32_16x16x32_bf16 v[64:67], a[116:119], a[44:47], v[64:67]
s_add_u32 m0, s86, 68608
ds_read_b64_tr_b16 a[82:83], v190 offset:36864
v_mfma_f32_16x16x32_bf16 v[32:35], a[116:119], a[36:39], v[32:35]
s_add_u32 s64, s85, 1597440
ds_read_b64_tr_b16 a[84:85], v190 offset:40960
v_mfma_f32_16x16x32_bf16 v[32:35], a[112:115], a[32:35], v[32:35]
s_waitcnt lgkmcnt(6)
buffer_load_dwordx4 v13, s[40:43], s64 offen lds
v_mfma_f32_16x16x32_bf16 v[36:39], a[120:123], a[32:35], v[36:39]
ds_read_b64_tr_b16 a[86:87], v190 offset:45056
v_mfma_f32_16x16x32_bf16 v[36:39], a[124:127], a[36:39], v[36:39]
s_add_u32 m0, s86, 69632
v_mfma_f32_16x16x32_bf16 v[68:71], a[124:127], a[44:47], v[68:71]
s_add_u32 s64, s85, 1605632
v_mfma_f32_16x16x32_bf16 v[68:71], a[120:123], a[40:43], v[68:71]
buffer_load_dwordx4 v12, s[40:43], s64 offen lds
v_mfma_f32_16x16x32_bf16 v[100:103], a[120:123], a[48:51], v[100:103]
s_sub_u32 s70, s70, 1
s_add_u32 s84, s84, 131072
s_add_u32 s85, s85, 1048576
v_mfma_f32_16x16x32_bf16 v[100:103], a[124:127], a[52:55], v[100:103]
s_cmp_lg_u32 s70, 0
v_mfma_f32_16x16x32_bf16 v[132:135], a[124:127], a[60:63], v[132:135]
v_mfma_f32_16x16x32_bf16 v[132:135], a[120:123], a[56:59], v[132:135]
s_cbranch_scc1 L_p5_2019
s_waitcnt vmcnt(25)
v_mfma_f32_16x16x32_bf16 v[136:139], a[64:67], a[232:235], v[136:139]
s_waitcnt vmcnt(21)
s_add_u32 m0, s86, 70656
s_add_u32 s64, s85, 565248
ds_read_b64_tr_b16 a[88:89], v191 offset:32768
v_mfma_f32_16x16x32_bf16 v[136:139], a[68:71], a[236:239], v[136:139]
buffer_load_dwordx4 v13, s[40:43], s64 offen lds
v_mfma_f32_16x16x32_bf16 v[104:107], a[68:71], a[228:231], v[104:107]
s_add_u32 m0, s86, 71680
ds_read_b64_tr_b16 a[90:91], v191 offset:36864
v_mfma_f32_16x16x32_bf16 v[104:107], a[64:67], a[224:227], v[104:107]
s_add_u32 s64, s85, 573440
ds_read_b64_tr_b16 a[92:93], v191 offset:40960
v_mfma_f32_16x16x32_bf16 v[72:75], a[64:67], a[216:219], v[72:75]
buffer_load_dwordx4 v12, s[40:43], s64 offen lds
v_mfma_f32_16x16x32_bf16 v[72:75], a[68:71], a[220:223], v[72:75]
s_add_u32 m0, s86, 72704
ds_read_b64_tr_b16 a[94:95], v191 offset:45056
v_mfma_f32_16x16x32_bf16 v[40:43], a[68:71], a[212:215], v[40:43]
s_add_u32 s64, s85, 581632
ds_read_b64_tr_b16 a[96:97], v184 offset:32768
v_mfma_f32_16x16x32_bf16 v[40:43], a[64:67], a[208:211], v[40:43]
s_waitcnt lgkmcnt(5)
buffer_load_dwordx4 v13, s[40:43], s64 offen lds
v_mfma_f32_16x16x32_bf16 v[44:47], a[72:75], a[208:211], v[44:47]
ds_read_b64_tr_b16 a[98:99], v184 offset:36864
v_mfma_f32_16x16x32_bf16 v[44:47], a[76:79], a[212:215], v[44:47]
ds_read_b64_tr_b16 a[100:101], v184 offset:40960
v_mfma_f32_16x16x32_bf16 v[76:79], a[76:79], a[220:223], v[76:79]
s_add_u32 s65, s84, 65536
ds_read_b64_tr_b16 a[102:103], v184 offset:45056
v_mfma_f32_16x16x32_bf16 v[76:79], a[72:75], a[216:219], v[76:79]
buffer_load_dwordx4 a[0:3], v14, s[44:47], s65 offen offset:0 sc1
v_mfma_f32_16x16x32_bf16 v[108:111], a[72:75], a[224:227], v[108:111]
ds_read_b64_tr_b16 a[104:105], v185 offset:32768
v_mfma_f32_16x16x32_bf16 v[108:111], a[76:79], a[228:231], v[108:111]
ds_read_b64_tr_b16 a[106:107], v185 offset:36864
v_mfma_f32_16x16x32_bf16 v[140:143], a[76:79], a[236:239], v[140:143]
buffer_load_dwordx4 a[8:11], v14, s[44:47], s65 offen offset:1024 sc1
v_mfma_f32_16x16x32_bf16 v[140:143], a[72:75], a[232:235], v[140:143]
ds_read_b64_tr_b16 a[108:109], v185 offset:40960
v_mfma_f32_16x16x32_bf16 v[144:147], a[80:83], a[232:235], v[144:147]
ds_read_b64_tr_b16 a[110:111], v185 offset:45056
v_mfma_f32_16x16x32_bf16 v[144:147], a[84:87], a[236:239], v[144:147]
v_mfma_f32_16x16x32_bf16 v[112:115], a[84:87], a[228:231], v[112:115]
buffer_load_dwordx4 a[16:19], v15, s[44:47], s65 offen offset:0 sc1
v_mfma_f32_16x16x32_bf16 v[112:115], a[80:83], a[224:227], v[112:115]
ds_read_b64_tr_b16 a[112:113], v186 offset:32768
v_mfma_f32_16x16x32_bf16 v[80:83], a[80:83], a[216:219], v[80:83]
ds_read_b64_tr_b16 a[114:115], v186 offset:36864
v_mfma_f32_16x16x32_bf16 v[80:83], a[84:87], a[220:223], v[80:83]
buffer_load_dwordx4 a[24:27], v15, s[44:47], s65 offen offset:1024 sc1
v_mfma_f32_16x16x32_bf16 v[48:51], a[84:87], a[212:215], v[48:51]
ds_read_b64_tr_b16 a[116:117], v186 offset:40960
v_mfma_f32_16x16x32_bf16 v[48:51], a[80:83], a[208:211], v[48:51]
s_waitcnt lgkmcnt(4)
ds_read_b64_tr_b16 a[118:119], v186 offset:45056
v_mfma_f32_16x16x32_bf16 v[52:55], a[88:91], a[208:211], v[52:55]
s_add_u32 s65, s84, 73728
v_mfma_f32_16x16x32_bf16 v[52:55], a[92:95], a[212:215], v[52:55]
buffer_load_dwordx4 a[4:7], v14, s[44:47], s65 offen offset:0 sc1
v_mfma_f32_16x16x32_bf16 v[84:87], a[92:95], a[220:223], v[84:87]
ds_read_b64_tr_b16 a[120:121], v187 offset:32768
v_mfma_f32_16x16x32_bf16 v[84:87], a[88:91], a[216:219], v[84:87]
ds_read_b64_tr_b16 a[122:123], v187 offset:36864
v_mfma_f32_16x16x32_bf16 v[116:119], a[88:91], a[224:227], v[116:119]
buffer_load_dwordx4 a[12:15], v14, s[44:47], s65 offen offset:1024 sc1
v_mfma_f32_16x16x32_bf16 v[116:119], a[92:95], a[228:231], v[116:119]
ds_read_b64_tr_b16 a[124:125], v187 offset:40960
v_mfma_f32_16x16x32_bf16 v[148:151], a[92:95], a[236:239], v[148:151]
ds_read_b64_tr_b16 a[126:127], v187 offset:45056
v_mfma_f32_16x16x32_bf16 v[148:151], a[88:91], a[232:235], v[148:151]
v_mfma_f32_16x16x32_bf16 v[120:123], a[96:99], a[232:235], v[120:123]
buffer_load_dwordx4 a[20:23], v15, s[44:47], s65 offen offset:0 sc1
v_mfma_f32_16x16x32_bf16 v[120:123], a[100:103], a[236:239], v[120:123]
v_mfma_f32_16x16x32_bf16 v[88:91], a[100:103], a[228:231], v[88:91]
v_mfma_f32_16x16x32_bf16 v[88:91], a[96:99], a[224:227], v[88:91]
buffer_load_dwordx4 a[28:31], v15, s[44:47], s65 offen offset:1024 sc1
v_mfma_f32_16x16x32_bf16 v[56:59], a[96:99], a[216:219], v[56:59]
v_mfma_f32_16x16x32_bf16 v[56:59], a[100:103], a[220:223], v[56:59]
v_mfma_f32_16x16x32_bf16 v[24:27], a[100:103], a[212:215], v[24:27]
v_mfma_f32_16x16x32_bf16 v[24:27], a[96:99], a[208:211], v[24:27]
v_mfma_f32_16x16x32_bf16 v[28:31], a[104:107], a[208:211], v[28:31]
s_waitcnt vmcnt(24)
s_barrier
s_waitcnt lgkmcnt(0)
v_mfma_f32_16x16x32_bf16 v[28:31], a[108:111], a[212:215], v[28:31]
s_add_u32 m0, s86, 98304
ds_read_b64_tr_b16 a[64:65], v196 offset:0
v_mfma_f32_16x16x32_bf16 v[60:63], a[108:111], a[220:223], v[60:63]
s_add_u32 s64, s85, 786432
ds_read_b64_tr_b16 a[66:67], v196 offset:4096
v_mfma_f32_16x16x32_bf16 v[60:63], a[104:107], a[216:219], v[60:63]
buffer_load_dwordx4 v12, s[40:43], s64 offen lds
v_mfma_f32_16x16x32_bf16 v[92:95], a[104:107], a[224:227], v[92:95]
ds_read_b64_tr_b16 a[68:69], v196 offset:8192
v_mfma_f32_16x16x32_bf16 v[92:95], a[108:111], a[228:231], v[92:95]
s_add_u32 m0, s86, 99328
ds_read_b64_tr_b16 a[70:71], v196 offset:12288
v_mfma_f32_16x16x32_bf16 v[124:127], a[108:111], a[236:239], v[124:127]
s_add_u32 s64, s85, 794624
ds_read_b64_tr_b16 a[72:73], v197 offset:0
v_mfma_f32_16x16x32_bf16 v[124:127], a[104:107], a[232:235], v[124:127]
buffer_load_dwordx4 v13, s[40:43], s64 offen lds
v_mfma_f32_16x16x32_bf16 v[128:131], a[112:115], a[232:235], v[128:131]
ds_read_b64_tr_b16 a[74:75], v197 offset:4096
v_mfma_f32_16x16x32_bf16 v[128:131], a[116:119], a[236:239], v[128:131]
s_add_u32 m0, s86, 100352
ds_read_b64_tr_b16 a[76:77], v197 offset:8192
v_mfma_f32_16x16x32_bf16 v[96:99], a[116:119], a[228:231], v[96:99]
s_add_u32 s64, s85, 802816
ds_read_b64_tr_b16 a[78:79], v197 offset:12288
v_mfma_f32_16x16x32_bf16 v[96:99], a[112:115], a[224:227], v[96:99]
buffer_load_dwordx4 v12, s[40:43], s64 offen lds
v_mfma_f32_16x16x32_bf16 v[64:67], a[112:115], a[216:219], v[64:67]
ds_read_b64_tr_b16 a[80:81], v198 offset:0
v_mfma_f32_16x16x32_bf16 v[64:67], a[116:119], a[220:223], v[64:67]
s_add_u32 m0, s86, 101376
ds_read_b64_tr_b16 a[82:83], v198 offset:4096
v_mfma_f32_16x16x32_bf16 v[32:35], a[116:119], a[212:215], v[32:35]
s_add_u32 s64, s85, 811008
ds_read_b64_tr_b16 a[84:85], v198 offset:8192
v_mfma_f32_16x16x32_bf16 v[32:35], a[112:115], a[208:211], v[32:35]
buffer_load_dwordx4 v13, s[40:43], s64 offen lds
v_mfma_f32_16x16x32_bf16 v[36:39], a[120:123], a[208:211], v[36:39]
ds_read_b64_tr_b16 a[86:87], v198 offset:12288
v_mfma_f32_16x16x32_bf16 v[36:39], a[124:127], a[212:215], v[36:39]
s_add_u32 m0, s86, 102400
v_mfma_f32_16x16x32_bf16 v[68:71], a[124:127], a[220:223], v[68:71]
s_add_u32 s64, s85, 819200
v_mfma_f32_16x16x32_bf16 v[68:71], a[120:123], a[216:219], v[68:71]
buffer_load_dwordx4 v12, s[40:43], s64 offen lds
v_mfma_f32_16x16x32_bf16 v[100:103], a[120:123], a[224:227], v[100:103]
v_mfma_f32_16x16x32_bf16 v[100:103], a[124:127], a[228:231], v[100:103]
v_mfma_f32_16x16x32_bf16 v[132:135], a[124:127], a[236:239], v[132:135]
v_mfma_f32_16x16x32_bf16 v[132:135], a[120:123], a[232:235], v[132:135]
s_waitcnt vmcnt(25)
s_waitcnt lgkmcnt(1)
s_add_u32 m0, s86, 103424
v_mfma_f32_16x16x32_bf16 v[136:139], a[64:67], v[176:179], v[136:139]
s_waitcnt vmcnt(21)
s_add_u32 s64, s85, 827392
ds_read_b64_tr_b16 a[88:89], v199 offset:0
v_mfma_f32_16x16x32_bf16 v[136:139], a[68:71], v[180:183], v[136:139]
buffer_load_dwordx4 v13, s[40:43], s64 offen lds
v_mfma_f32_16x16x32_bf16 v[104:107], a[68:71], v[172:175], v[104:107]
s_add_u32 m0, s86, 104448
ds_read_b64_tr_b16 a[90:91], v199 offset:4096
v_mfma_f32_16x16x32_bf16 v[104:107], a[64:67], v[168:171], v[104:107]
s_add_u32 s64, s85, 835584
ds_read_b64_tr_b16 a[92:93], v199 offset:8192
v_mfma_f32_16x16x32_bf16 v[72:75], a[64:67], v[160:163], v[72:75]
buffer_load_dwordx4 v12, s[40:43], s64 offen lds
v_mfma_f32_16x16x32_bf16 v[72:75], a[68:71], v[164:167], v[72:75]
s_add_u32 m0, s86, 105472
ds_read_b64_tr_b16 a[94:95], v199 offset:12288
v_mfma_f32_16x16x32_bf16 v[40:43], a[68:71], v[156:159], v[40:43]
s_add_u32 s64, s85, 843776
ds_read_b64_tr_b16 a[96:97], v192 offset:0
v_mfma_f32_16x16x32_bf16 v[40:43], a[64:67], v[152:155], v[40:43]
buffer_load_dwordx4 v13, s[40:43], s64 offen lds
v_mfma_f32_16x16x32_bf16 v[44:47], a[72:75], v[152:155], v[44:47]
ds_read_b64_tr_b16 a[98:99], v192 offset:4096
v_mfma_f32_16x16x32_bf16 v[44:47], a[76:79], v[156:159], v[44:47]
ds_read_b64_tr_b16 a[100:101], v192 offset:8192
v_mfma_f32_16x16x32_bf16 v[76:79], a[76:79], v[164:167], v[76:79]
s_add_u32 s65, s84, 98304
ds_read_b64_tr_b16 a[102:103], v192 offset:12288
v_mfma_f32_16x16x32_bf16 v[76:79], a[72:75], v[160:163], v[76:79]
buffer_load_dwordx4 a[32:35], v14, s[44:47], s65 offen offset:0 sc1
v_mfma_f32_16x16x32_bf16 v[108:111], a[72:75], v[168:171], v[108:111]
ds_read_b64_tr_b16 a[104:105], v193 offset:0
v_mfma_f32_16x16x32_bf16 v[108:111], a[76:79], v[172:175], v[108:111]
ds_read_b64_tr_b16 a[106:107], v193 offset:4096
v_mfma_f32_16x16x32_bf16 v[140:143], a[76:79], v[180:183], v[140:143]
buffer_load_dwordx4 a[40:43], v14, s[44:47], s65 offen offset:1024 sc1
v_mfma_f32_16x16x32_bf16 v[140:143], a[72:75], v[176:179], v[140:143]
ds_read_b64_tr_b16 a[108:109], v193 offset:8192
v_mfma_f32_16x16x32_bf16 v[144:147], a[80:83], v[176:179], v[144:147]
s_waitcnt lgkmcnt(5)
ds_read_b64_tr_b16 a[110:111], v193 offset:12288
v_mfma_f32_16x16x32_bf16 v[144:147], a[84:87], v[180:183], v[144:147]
v_mfma_f32_16x16x32_bf16 v[112:115], a[84:87], v[172:175], v[112:115]
buffer_load_dwordx4 a[48:51], v15, s[44:47], s65 offen offset:0 sc1
v_mfma_f32_16x16x32_bf16 v[112:115], a[80:83], v[168:171], v[112:115]
ds_read_b64_tr_b16 a[112:113], v194 offset:0
v_mfma_f32_16x16x32_bf16 v[80:83], a[80:83], v[160:163], v[80:83]
ds_read_b64_tr_b16 a[114:115], v194 offset:4096
v_mfma_f32_16x16x32_bf16 v[80:83], a[84:87], v[164:167], v[80:83]
buffer_load_dwordx4 a[56:59], v15, s[44:47], s65 offen offset:1024 sc1
v_mfma_f32_16x16x32_bf16 v[48:51], a[84:87], v[156:159], v[48:51]
ds_read_b64_tr_b16 a[116:117], v194 offset:8192
v_mfma_f32_16x16x32_bf16 v[48:51], a[80:83], v[152:155], v[48:51]
ds_read_b64_tr_b16 a[118:119], v194 offset:12288
v_mfma_f32_16x16x32_bf16 v[52:55], a[88:91], v[152:155], v[52:55]
s_add_u32 s65, s84, 106496
v_mfma_f32_16x16x32_bf16 v[52:55], a[92:95], v[156:159], v[52:55]
buffer_load_dwordx4 a[36:39], v14, s[44:47], s65 offen offset:0 sc1
v_mfma_f32_16x16x32_bf16 v[84:87], a[92:95], v[164:167], v[84:87]
ds_read_b64_tr_b16 a[120:121], v195 offset:0
v_mfma_f32_16x16x32_bf16 v[84:87], a[88:91], v[160:163], v[84:87]
ds_read_b64_tr_b16 a[122:123], v195 offset:4096
v_mfma_f32_16x16x32_bf16 v[116:119], a[88:91], v[168:171], v[116:119]
buffer_load_dwordx4 a[44:47], v14, s[44:47], s65 offen offset:1024 sc1
v_mfma_f32_16x16x32_bf16 v[116:119], a[92:95], v[172:175], v[116:119]
ds_read_b64_tr_b16 a[124:125], v195 offset:8192
v_mfma_f32_16x16x32_bf16 v[148:151], a[92:95], v[180:183], v[148:151]
ds_read_b64_tr_b16 a[126:127], v195 offset:12288
v_mfma_f32_16x16x32_bf16 v[148:151], a[88:91], v[176:179], v[148:151]
v_mfma_f32_16x16x32_bf16 v[120:123], a[96:99], v[176:179], v[120:123]
s_waitcnt lgkmcnt(4)
buffer_load_dwordx4 a[52:55], v15, s[44:47], s65 offen offset:0 sc1
v_mfma_f32_16x16x32_bf16 v[120:123], a[100:103], v[180:183], v[120:123]
v_mfma_f32_16x16x32_bf16 v[88:91], a[100:103], v[172:175], v[88:91]
v_mfma_f32_16x16x32_bf16 v[88:91], a[96:99], v[168:171], v[88:91]
buffer_load_dwordx4 a[60:63], v15, s[44:47], s65 offen offset:1024 sc1
v_mfma_f32_16x16x32_bf16 v[56:59], a[96:99], v[160:163], v[56:59]
v_mfma_f32_16x16x32_bf16 v[56:59], a[100:103], v[164:167], v[56:59]
v_mfma_f32_16x16x32_bf16 v[24:27], a[100:103], v[156:159], v[24:27]
v_mfma_f32_16x16x32_bf16 v[24:27], a[96:99], v[152:155], v[24:27]
v_mfma_f32_16x16x32_bf16 v[28:31], a[104:107], v[152:155], v[28:31]
s_waitcnt vmcnt(24)
s_barrier
v_mfma_f32_16x16x32_bf16 v[28:31], a[108:111], v[156:159], v[28:31]
ds_read_b64_tr_b16 a[64:65], v196 offset:32768
v_mfma_f32_16x16x32_bf16 v[60:63], a[108:111], v[164:167], v[60:63]
ds_read_b64_tr_b16 a[66:67], v196 offset:36864
v_mfma_f32_16x16x32_bf16 v[60:63], a[104:107], v[160:163], v[60:63]
ds_read_b64_tr_b16 a[68:69], v196 offset:40960
v_mfma_f32_16x16x32_bf16 v[92:95], a[104:107], v[168:171], v[92:95]
s_xor_b32 s66, s2, 4
s_lshl2_add_u32 s66, s66, s30
ds_read_b64_tr_b16 a[70:71], v196 offset:45056
v_mfma_f32_16x16x32_bf16 v[92:95], a[108:111], v[172:175], v[92:95]
s_lshl_b32 s73, s66, 12
s_add_u32 s73, s73, 67108864
ds_read_b64_tr_b16 a[72:73], v197 offset:32768
v_mfma_f32_16x16x32_bf16 v[124:127], a[108:111], v[180:183], v[124:127]
s_lshl2_add_u32 s66, s2, s30
s_lshl_b32 s75, s66, 12
ds_read_b64_tr_b16 a[74:75], v197 offset:36864
v_mfma_f32_16x16x32_bf16 v[124:127], a[104:107], v[176:179], v[124:127]
s_add_u32 s75, s75, 67108864
s_lshl_b32 s77, s82, 18
ds_read_b64_tr_b16 a[76:77], v197 offset:40960
v_mfma_f32_16x16x32_bf16 v[128:131], a[112:115], v[176:179], v[128:131]
s_lshl_b32 s66, s30, 16
s_add_u32 s77, s77, s66
ds_read_b64_tr_b16 a[78:79], v197 offset:45056
v_mfma_f32_16x16x32_bf16 v[128:131], a[116:119], v[180:183], v[128:131]
s_add_u32 s77, s77, s87
s_lshl_b32 s66, s83, 7
ds_read_b64_tr_b16 a[80:81], v198 offset:32768
v_mfma_f32_16x16x32_bf16 v[96:99], a[116:119], v[172:175], v[96:99]
s_add_u32 s77, s77, s66
ds_read_b64_tr_b16 a[82:83], v198 offset:36864
v_lshlrev_b32 v1, 24, v0
v_mfma_f32_16x16x32_bf16 v[96:99], a[112:115], v[168:171], v[96:99]
ds_read_b64_tr_b16 a[84:85], v198 offset:40960
v_and_b32 v8, 7, v0
v_mfma_f32_16x16x32_bf16 v[64:67], a[112:115], v[160:163], v[64:67]
ds_read_b64_tr_b16 a[86:87], v198 offset:45056
v_lshlrev_b32 v8, 11, v8
v_mfma_f32_16x16x32_bf16 v[64:67], a[116:119], v[164:167], v[64:67]
v_bfe_u32 v10, v0, 3, 1
v_lshl_add_u32 v8, v10, 6, v8
v_mfma_f32_16x16x32_bf16 v[32:35], a[116:119], v[156:159], v[32:35]
v_bfe_u32 v10, v0, 4, 1
v_lshl_add_u32 v8, v10, 5, v8
v_mfma_f32_16x16x32_bf16 v[32:35], a[112:115], v[152:155], v[32:35]
s_waitcnt lgkmcnt(5)
v_lshrrev_b32 v10, 5, v0
v_lshl_add_u32 v8, v10, 4, v8
v_mfma_f32_16x16x32_bf16 v[36:39], a[120:123], v[152:155], v[36:39]
v_add_u32 v2, s86, v16
v_xor_b32 v3, 0x2000, v2
v_mfma_f32_16x16x32_bf16 v[36:39], a[124:127], v[156:159], v[36:39]
v_mov_b32 v232, 0
v_mov_b32 v233, 0
v_mfma_f32_16x16x32_bf16 v[68:71], a[124:127], v[164:167], v[68:71]
v_mov_b32 v236, 0
v_mov_b32 v237, 0
v_mfma_f32_16x16x32_bf16 v[68:71], a[120:123], v[160:163], v[68:71]
v_and_b32 v9, 1, v0
v_lshlrev_b32 v9, 4, v9
v_mfma_f32_16x16x32_bf16 v[100:103], a[120:123], v[168:171], v[100:103]
v_mov_b32 v10, 0x3f80
v_lshlrev_b32 v9, v9, v10
v_mfma_f32_16x16x32_bf16 v[100:103], a[124:127], v[172:175], v[100:103]
v_lshrrev_b32 v10, 4, v0
v_lshlrev_b32 v10, 1, v10
v_mfma_f32_16x16x32_bf16 v[132:135], a[124:127], v[180:183], v[132:135]
v_bfe_u32 v11, v0, 1, 3
v_xor_b32 v10, v10, v11
v_mfma_f32_16x16x32_bf16 v[132:135], a[120:123], v[176:179], v[132:135]
s_waitcnt vmcnt(20)
v_subrev_u32 v11, 1, v10
v_ashrrev_i32 v11, 31, v11
v_mfma_f32_16x16x32_bf16 v[136:139], a[64:67], a[24:27], v[136:139]
s_waitcnt vmcnt(16)
ds_read_b64_tr_b16 a[88:89], v199 offset:32768
v_and_b32 v234, v11, v9
v_mfma_f32_16x16x32_bf16 v[136:139], a[68:71], a[28:31], v[136:139]
ds_read_b64_tr_b16 a[90:91], v199 offset:36864
v_xor_b32 v10, 1, v10
v_mfma_f32_16x16x32_bf16 v[104:107], a[68:71], a[20:23], v[104:107]
ds_read_b64_tr_b16 a[92:93], v199 offset:40960
v_subrev_u32 v11, 1, v10
v_mfma_f32_16x16x32_bf16 v[104:107], a[64:67], a[16:19], v[104:107]
ds_read_b64_tr_b16 a[94:95], v199 offset:45056
v_ashrrev_i32 v11, 31, v11
v_mfma_f32_16x16x32_bf16 v[72:75], a[64:67], a[8:11], v[72:75]
v_and_b32 v235, v11, v9
v_mfma_f32_16x16x32_bf16 v[72:75], a[68:71], a[12:15], v[72:75]
s_mov_b32 s48, s24
s_mov_b32 s49, s25
s_mov_b32 s50, 4194304
v_mfma_f32_16x16x32_bf16 v[40:43], a[68:71], a[4:7], v[40:43]
s_mov_b32 s51, 0x20000
s_waitcnt vmcnt(8)
s_barrier
v_mfma_f32_16x16x32_bf16 v[40:43], a[64:67], a[0:3], v[40:43]
ds_read_b64_tr_b16 a[96:97], v188 offset:0
v_mfma_f32_16x16x32_bf16 v[44:47], a[72:75], a[0:3], v[44:47]
s_waitcnt lgkmcnt(4)
ds_read_b64_tr_b16 a[98:99], v188 offset:4096
v_mfma_f32_16x16x32_bf16 v[44:47], a[76:79], a[4:7], v[44:47]
ds_read_b64_tr_b16 a[100:101], v188 offset:8192
v_mfma_f32_16x16x32_bf16 v[76:79], a[76:79], a[12:15], v[76:79]
ds_read_b64_tr_b16 a[102:103], v188 offset:12288
v_mfma_f32_16x16x32_bf16 v[76:79], a[72:75], a[8:11], v[76:79]
ds_read_b64_tr_b16 a[104:105], v189 offset:0
v_mfma_f32_16x16x32_bf16 v[108:111], a[72:75], a[16:19], v[108:111]
ds_read_b64_tr_b16 a[106:107], v189 offset:4096
v_mfma_f32_16x16x32_bf16 v[108:111], a[76:79], a[20:23], v[108:111]
ds_read_b64_tr_b16 a[108:109], v189 offset:8192
v_mfma_f32_16x16x32_bf16 v[140:143], a[76:79], a[28:31], v[140:143]
ds_read_b64_tr_b16 a[110:111], v189 offset:12288
v_mfma_f32_16x16x32_bf16 v[140:143], a[72:75], a[24:27], v[140:143]
v_mfma_f32_16x16x32_bf16 v[144:147], a[80:83], a[24:27], v[144:147]
v_mfma_f32_16x16x32_bf16 v[144:147], a[84:87], a[28:31], v[144:147]
v_mfma_f32_16x16x32_bf16 v[112:115], a[84:87], a[20:23], v[112:115]
ds_read_b64_tr_b16 a[112:113], v190 offset:0
v_mfma_f32_16x16x32_bf16 v[112:115], a[80:83], a[16:19], v[112:115]
ds_read_b64_tr_b16 a[114:115], v190 offset:4096
v_mfma_f32_16x16x32_bf16 v[80:83], a[80:83], a[8:11], v[80:83]
ds_read_b64_tr_b16 a[116:117], v190 offset:8192
v_mfma_f32_16x16x32_bf16 v[80:83], a[84:87], a[12:15], v[80:83]
ds_read_b64_tr_b16 a[118:119], v190 offset:12288
v_mfma_f32_16x16x32_bf16 v[48:51], a[84:87], a[4:7], v[48:51]
v_mfma_f32_16x16x32_bf16 v[48:51], a[80:83], a[0:3], v[48:51]
s_waitcnt lgkmcnt(4)
v_mfma_f32_16x16x32_bf16 v[52:55], a[88:91], a[0:3], v[52:55]
v_mfma_f32_16x16x32_bf16 v[52:55], a[92:95], a[4:7], v[52:55]
v_mfma_f32_16x16x32_bf16 v[84:87], a[92:95], a[12:15], v[84:87]
ds_read_b64_tr_b16 a[120:121], v191 offset:0
v_mfma_f32_16x16x32_bf16 v[84:87], a[88:91], a[8:11], v[84:87]
ds_read_b64_tr_b16 a[122:123], v191 offset:4096
v_mfma_f32_16x16x32_bf16 v[116:119], a[88:91], a[16:19], v[116:119]
ds_read_b64_tr_b16 a[124:125], v191 offset:8192
v_mfma_f32_16x16x32_bf16 v[116:119], a[92:95], a[20:23], v[116:119]
ds_read_b64_tr_b16 a[126:127], v191 offset:12288
v_mfma_f32_16x16x32_bf16 v[148:151], a[92:95], a[28:31], v[148:151]
v_mfma_f32_16x16x32_bf16 v[148:151], a[88:91], a[24:27], v[148:151]
s_waitcnt vmcnt(4)
v_mfma_f32_16x16x32_bf16 v[136:139], a[96:99], a[56:59], v[136:139]
s_waitcnt vmcnt(0)
v_mfma_f32_16x16x32_bf16 v[136:139], a[100:103], a[60:63], v[136:139]
v_mfma_f32_16x16x32_bf16 v[104:107], a[100:103], a[52:55], v[104:107]
ds_read_b64_tr_b16 a[64:65], v192 offset:32768
v_mfma_f32_16x16x32_bf16 v[104:107], a[96:99], a[48:51], v[104:107]
ds_read_b64_tr_b16 a[66:67], v192 offset:36864
v_mfma_f32_16x16x32_bf16 v[72:75], a[96:99], a[40:43], v[72:75]
ds_read_b64_tr_b16 a[68:69], v192 offset:40960
v_mfma_f32_16x16x32_bf16 v[72:75], a[100:103], a[44:47], v[72:75]
ds_read_b64_tr_b16 a[70:71], v192 offset:45056
v_mfma_f32_16x16x32_bf16 v[40:43], a[100:103], a[36:39], v[40:43]
v_mfma_f32_16x16x32_bf16 v[40:43], a[96:99], a[32:35], v[40:43]
v_mfma_f32_16x16x32_bf16 v[44:47], a[104:107], a[32:35], v[44:47]
ds_write_b128 v3, v[136:139] offset:4096
v_mfma_f32_16x16x32_bf16 v[44:47], a[108:111], a[36:39], v[44:47]
v_mfma_f32_16x16x32_bf16 v[76:79], a[108:111], a[44:47], v[76:79]
ds_write_b128 v3, v[104:107] offset:0
v_mfma_f32_16x16x32_bf16 v[76:79], a[104:107], a[40:43], v[76:79]
ds_read_b64_tr_b16 a[72:73], v193 offset:32768
v_mfma_f32_16x16x32_bf16 v[108:111], a[104:107], a[48:51], v[108:111]
ds_read_b64_tr_b16 a[74:75], v193 offset:36864
v_mfma_f32_16x16x32_bf16 v[108:111], a[108:111], a[52:55], v[108:111]
ds_read_b64_tr_b16 a[76:77], v193 offset:40960
v_mfma_f32_16x16x32_bf16 v[140:143], a[108:111], a[60:63], v[140:143]
ds_read_b64_tr_b16 a[78:79], v193 offset:45056
v_mfma_f32_16x16x32_bf16 v[140:143], a[104:107], a[56:59], v[140:143]
s_waitcnt lgkmcnt(6)
v_mfma_f32_16x16x32_bf16 v[144:147], a[112:115], a[56:59], v[144:147]
v_mfma_f32_16x16x32_bf16 v[144:147], a[116:119], a[60:63], v[144:147]
v_mfma_f32_16x16x32_bf16 v[112:115], a[116:119], a[52:55], v[112:115]
ds_read_b64_tr_b16 a[80:81], v194 offset:32768
v_mfma_f32_16x16x32_bf16 v[112:115], a[112:115], a[48:51], v[112:115]
ds_read_b64_tr_b16 a[82:83], v194 offset:36864
v_mfma_f32_16x16x32_bf16 v[80:83], a[112:115], a[40:43], v[80:83]
ds_write_b128 v3, v[108:111] offset:1024
v_mfma_f32_16x16x32_bf16 v[80:83], a[116:119], a[44:47], v[80:83]
ds_read_b64_tr_b16 a[84:85], v194 offset:40960
v_mfma_f32_16x16x32_bf16 v[48:51], a[116:119], a[36:39], v[48:51]
ds_write_b128 v3, v[140:143] offset:5120
v_mfma_f32_16x16x32_bf16 v[48:51], a[112:115], a[32:35], v[48:51]
ds_read_b64_tr_b16 a[86:87], v194 offset:45056
v_mfma_f32_16x16x32_bf16 v[52:55], a[120:123], a[32:35], v[52:55]
ds_write_b128 v3, v[144:147] offset:6144
v_mfma_f32_16x16x32_bf16 v[52:55], a[124:127], a[36:39], v[52:55]
v_mfma_f32_16x16x32_bf16 v[84:87], a[124:127], a[44:47], v[84:87]
ds_write_b128 v3, v[112:115] offset:2048
v_mfma_f32_16x16x32_bf16 v[84:87], a[120:123], a[40:43], v[84:87]
ds_read_b64_tr_b16 a[88:89], v195 offset:32768
v_mfma_f32_16x16x32_bf16 v[116:119], a[120:123], a[48:51], v[116:119]
ds_read_b64_tr_b16 a[90:91], v195 offset:36864
v_mfma_f32_16x16x32_bf16 v[116:119], a[124:127], a[52:55], v[116:119]
ds_read_b64_tr_b16 a[92:93], v195 offset:40960
v_mfma_f32_16x16x32_bf16 v[148:151], a[124:127], a[60:63], v[148:151]
ds_read_b64_tr_b16 a[94:95], v195 offset:45056
v_mfma_f32_16x16x32_bf16 v[148:151], a[120:123], a[56:59], v[148:151]
v_mfma_f32_16x16x32_bf16 v[120:123], a[64:67], a[24:27], v[120:123]
v_mfma_f32_16x16x32_bf16 v[120:123], a[68:71], a[28:31], v[120:123]
v_mfma_f32_16x16x32_bf16 v[88:91], a[68:71], a[20:23], v[88:91]
ds_read_b64_tr_b16 a[96:97], v184 offset:0
v_mfma_f32_16x16x32_bf16 v[88:91], a[64:67], a[16:19], v[88:91]
ds_read_b64_tr_b16 a[98:99], v184 offset:4096
v_mfma_f32_16x16x32_bf16 v[56:59], a[64:67], a[8:11], v[56:59]
ds_write_b128 v3, v[116:119] offset:3072
v_mfma_f32_16x16x32_bf16 v[56:59], a[68:71], a[12:15], v[56:59]
ds_read_b64_tr_b16 a[100:101], v184 offset:8192
v_mfma_f32_16x16x32_bf16 v[24:27], a[68:71], a[4:7], v[24:27]
ds_write_b128 v3, v[148:151] offset:7168
v_mfma_f32_16x16x32_bf16 v[24:27], a[64:67], a[0:3], v[24:27]
s_waitcnt lgkmcnt(5)
ds_read_b64_tr_b16 a[102:103], v184 offset:12288
v_mfma_f32_16x16x32_bf16 v[28:31], a[72:75], a[0:3], v[28:31]
v_mfma_f32_16x16x32_bf16 v[28:31], a[76:79], a[4:7], v[28:31]
s_waitcnt lgkmcnt(0)
s_barrier
v_mfma_f32_16x16x32_bf16 v[60:63], a[76:79], a[12:15], v[60:63]
ds_read_b128 v[200:203], v2 offset:0
ds_read_b128 v[204:207], v2 offset:1024
v_mfma_f32_16x16x32_bf16 v[60:63], a[72:75], a[8:11], v[60:63]
ds_read_b128 v[208:211], v2 offset:2048
ds_read_b128 v[212:215], v2 offset:3072
v_mfma_f32_16x16x32_bf16 v[92:95], a[72:75], a[16:19], v[92:95]
ds_read_b128 v[216:219], v2 offset:4096
ds_read_b128 v[220:223], v2 offset:5120
v_mfma_f32_16x16x32_bf16 v[92:95], a[76:79], a[20:23], v[92:95]
ds_read_b128 v[224:227], v2 offset:6144
ds_read_b128 v[228:231], v2 offset:7168
v_mfma_f32_16x16x32_bf16 v[124:127], a[76:79], a[28:31], v[124:127]
ds_read_b64_tr_b16 a[104:105], v185 offset:0
v_mfma_f32_16x16x32_bf16 v[124:127], a[72:75], a[24:27], v[124:127]
ds_read_b64_tr_b16 a[106:107], v185 offset:4096
v_mfma_f32_16x16x32_bf16 v[128:131], a[80:83], a[24:27], v[128:131]
ds_read_b64_tr_b16 a[108:109], v185 offset:8192
v_mfma_f32_16x16x32_bf16 v[128:131], a[84:87], a[28:31], v[128:131]
ds_read_b64_tr_b16 a[110:111], v185 offset:12288
v_mfma_f32_16x16x32_bf16 v[96:99], a[84:87], a[20:23], v[96:99]
s_waitcnt lgkmcnt(10)
ds_read_b64_tr_b16 a[112:113], v186 offset:0
v_add_f32 v200, v200, v40
v_mfma_f32_16x16x32_bf16 v[96:99], a[80:83], a[16:19], v[96:99]
ds_read_b64_tr_b16 a[114:115], v186 offset:4096
v_add_f32 v201, v201, v41
v_mfma_f32_16x16x32_bf16 v[64:67], a[80:83], a[8:11], v[64:67]
ds_read_b64_tr_b16 a[116:117], v186 offset:8192
v_add_f32 v202, v202, v42
v_mfma_f32_16x16x32_bf16 v[64:67], a[84:87], a[12:15], v[64:67]
ds_read_b64_tr_b16 a[118:119], v186 offset:12288
v_add_f32 v203, v203, v43
v_mfma_f32_16x16x32_bf16 v[32:35], a[84:87], a[4:7], v[32:35]
v_add_f32 v204, v204, v44
v_add_f32 v205, v205, v45
v_mfma_f32_16x16x32_bf16 v[32:35], a[80:83], a[0:3], v[32:35]
v_add_f32 v206, v206, v46
v_add_f32 v207, v207, v47
v_mfma_f32_16x16x32_bf16 v[36:39], a[88:91], a[0:3], v[36:39]
v_cvt_pk_bf16_f32 v200, v200, v201
v_cvt_pk_bf16_f32 v201, v202, v203
v_mfma_f32_16x16x32_bf16 v[36:39], a[92:95], a[4:7], v[36:39]
v_cvt_pk_bf16_f32 v202, v204, v205
v_cvt_pk_bf16_f32 v203, v206, v207
v_mfma_f32_16x16x32_bf16 v[68:71], a[92:95], a[12:15], v[68:71]
buffer_store_dwordx4 v[200:203], v16, s[44:47], s73 offen offset:0 sc1
v_mfma_f32_16x16x32_bf16 v[68:71], a[88:91], a[8:11], v[68:71]
s_waitcnt lgkmcnt(2)
ds_read_b64_tr_b16 a[120:121], v187 offset:0
v_add_f32 v208, v208, v48
v_mfma_f32_16x16x32_bf16 v[100:103], a[88:91], a[16:19], v[100:103]
ds_read_b64_tr_b16 a[122:123], v187 offset:4096
v_add_f32 v209, v209, v49
v_mfma_f32_16x16x32_bf16 v[100:103], a[92:95], a[20:23], v[100:103]
ds_read_b64_tr_b16 a[124:125], v187 offset:8192
v_add_f32 v210, v210, v50
v_mfma_f32_16x16x32_bf16 v[132:135], a[92:95], a[28:31], v[132:135]
ds_read_b64_tr_b16 a[126:127], v187 offset:12288
v_add_f32 v211, v211, v51
v_mfma_f32_16x16x32_bf16 v[132:135], a[88:91], a[24:27], v[132:135]
v_add_f32 v212, v212, v52
v_add_f32 v213, v213, v53
v_mfma_f32_16x16x32_bf16 v[120:123], a[96:99], a[56:59], v[120:123]
v_add_f32 v214, v214, v54
v_add_f32 v215, v215, v55
v_mfma_f32_16x16x32_bf16 v[120:123], a[100:103], a[60:63], v[120:123]
v_cvt_pk_bf16_f32 v208, v208, v209
v_cvt_pk_bf16_f32 v209, v210, v211
v_cvt_pk_bf16_f32 v210, v212, v213
v_cvt_pk_bf16_f32 v211, v214, v215
v_mfma_f32_16x16x32_bf16 v[88:91], a[100:103], a[52:55], v[88:91]
buffer_store_dwordx4 v[208:211], v16, s[44:47], s73 offen offset:1024 sc1
v_mfma_f32_16x16x32_bf16 v[88:91], a[96:99], a[48:51], v[88:91]
v_add_f32 v216, v216, v72
v_add_f32 v217, v217, v73
v_mfma_f32_16x16x32_bf16 v[56:59], a[96:99], a[40:43], v[56:59]
v_add_f32 v218, v218, v74
v_add_f32 v219, v219, v75
v_mfma_f32_16x16x32_bf16 v[56:59], a[100:103], a[44:47], v[56:59]
v_add_f32 v220, v220, v76
v_add_f32 v221, v221, v77
v_mfma_f32_16x16x32_bf16 v[24:27], a[100:103], a[36:39], v[24:27]
v_add_f32 v222, v222, v78
v_add_f32 v223, v223, v79
v_mfma_f32_16x16x32_bf16 v[24:27], a[96:99], a[32:35], v[24:27]
v_cvt_pk_bf16_f32 v216, v216, v217
v_cvt_pk_bf16_f32 v217, v218, v219
v_mfma_f32_16x16x32_bf16 v[28:31], a[104:107], a[32:35], v[28:31]
v_cvt_pk_bf16_f32 v218, v220, v221
v_cvt_pk_bf16_f32 v219, v222, v223
v_mfma_f32_16x16x32_bf16 v[28:31], a[108:111], a[36:39], v[28:31]
buffer_store_dwordx4 v[216:219], v16, s[44:47], s73 offen offset:2048 sc1
v_mfma_f32_16x16x32_bf16 v[60:63], a[108:111], a[44:47], v[60:63]
v_add_f32 v224, v224, v80
v_add_f32 v225, v225, v81
v_mfma_f32_16x16x32_bf16 v[60:63], a[104:107], a[40:43], v[60:63]
v_add_f32 v226, v226, v82
v_add_f32 v227, v227, v83
v_mfma_f32_16x16x32_bf16 v[92:95], a[104:107], a[48:51], v[92:95]
v_add_f32 v228, v228, v84
v_add_f32 v229, v229, v85
v_mfma_f32_16x16x32_bf16 v[92:95], a[108:111], a[52:55], v[92:95]
v_add_f32 v230, v230, v86
v_add_f32 v231, v231, v87
v_mfma_f32_16x16x32_bf16 v[124:127], a[108:111], a[60:63], v[124:127]
v_cvt_pk_bf16_f32 v224, v224, v225
v_cvt_pk_bf16_f32 v225, v226, v227
v_mfma_f32_16x16x32_bf16 v[124:127], a[104:107], a[56:59], v[124:127]
v_cvt_pk_bf16_f32 v226, v228, v229
v_cvt_pk_bf16_f32 v227, v230, v231
v_mfma_f32_16x16x32_bf16 v[128:131], a[112:115], a[56:59], v[128:131]
s_waitcnt lgkmcnt(0)
buffer_store_dwordx4 v[224:227], v16, s[44:47], s73 offen offset:3072 sc1
v_mfma_f32_16x16x32_bf16 v[128:131], a[116:119], a[60:63], v[128:131]
ds_write_b128 v3, v[120:123] offset:36864
v_mfma_f32_16x16x32_bf16 v[96:99], a[116:119], a[52:55], v[96:99]
ds_write_b128 v3, v[88:91] offset:32768
v_mfma_f32_16x16x32_bf16 v[96:99], a[112:115], a[48:51], v[96:99]
v_mfma_f32_16x16x32_bf16 v[64:67], a[112:115], a[40:43], v[64:67]
ds_write_b128 v3, v[92:95] offset:33792
v_mfma_f32_16x16x32_bf16 v[64:67], a[116:119], a[44:47], v[64:67]
v_mfma_f32_16x16x32_bf16 v[32:35], a[116:119], a[36:39], v[32:35]
ds_write_b128 v3, v[124:127] offset:37888
v_mfma_f32_16x16x32_bf16 v[32:35], a[112:115], a[32:35], v[32:35]
v_mfma_f32_16x16x32_bf16 v[36:39], a[120:123], a[32:35], v[36:39]
ds_write_b128 v3, v[128:131] offset:38912
v_mfma_f32_16x16x32_bf16 v[36:39], a[124:127], a[36:39], v[36:39]
v_mfma_f32_16x16x32_bf16 v[68:71], a[124:127], a[44:47], v[68:71]
ds_write_b128 v3, v[96:99] offset:34816
v_mfma_f32_16x16x32_bf16 v[68:71], a[120:123], a[40:43], v[68:71]
v_mfma_f32_16x16x32_bf16 v[100:103], a[120:123], a[48:51], v[100:103]
v_mfma_f32_16x16x32_bf16 v[100:103], a[124:127], a[52:55], v[100:103]
v_mfma_f32_16x16x32_bf16 v[132:135], a[124:127], a[60:63], v[132:135]
v_mfma_f32_16x16x32_bf16 v[132:135], a[120:123], a[56:59], v[132:135]
buffer_load_dwordx4 v[152:155], v16, s[44:47], s75 offen offset:0 sc1
buffer_load_dwordx4 v[156:159], v16, s[44:47], s75 offen offset:1024 sc1
buffer_load_dwordx4 v[160:163], v16, s[44:47], s75 offen offset:2048 sc1
buffer_load_dwordx4 v[164:167], v16, s[44:47], s75 offen offset:3072 sc1
s_nop 3
ds_write_b128 v3, v[100:103] offset:35840
ds_write_b128 v3, v[132:135] offset:39936
s_mov_b32 s72, 0x4000
s_waitcnt lgkmcnt(0)
s_barrier
ds_read_b128 v[88:91], v2 offset:32768
ds_read_b128 v[92:95], v2 offset:33792
ds_read_b128 v[96:99], v2 offset:34816
ds_read_b128 v[100:103], v2 offset:35840
ds_read_b128 v[120:123], v2 offset:36864
ds_read_b128 v[124:127], v2 offset:37888
ds_read_b128 v[128:131], v2 offset:38912
ds_read_b128 v[132:135], v2 offset:39936
s_waitcnt lgkmcnt(7)
v_add_f32 v24, v24, v88
v_add_f32 v25, v25, v89
v_add_f32 v26, v26, v90
v_add_f32 v27, v27, v91
s_waitcnt lgkmcnt(6)
v_add_f32 v28, v28, v92
v_add_f32 v29, v29, v93
v_add_f32 v30, v30, v94
v_add_f32 v31, v31, v95
s_waitcnt lgkmcnt(5)
v_add_f32 v32, v32, v96
v_add_f32 v33, v33, v97
v_add_f32 v34, v34, v98
v_add_f32 v35, v35, v99
s_waitcnt lgkmcnt(4)
v_add_f32 v36, v36, v100
v_add_f32 v37, v37, v101
v_add_f32 v38, v38, v102
v_add_f32 v39, v39, v103
s_waitcnt lgkmcnt(3)
v_add_f32 v56, v56, v120
v_add_f32 v57, v57, v121
v_add_f32 v58, v58, v122
v_add_f32 v59, v59, v123
s_waitcnt lgkmcnt(2)
v_add_f32 v60, v60, v124
v_add_f32 v61, v61, v125
v_add_f32 v62, v62, v126
v_add_f32 v63, v63, v127
s_waitcnt lgkmcnt(1)
v_add_f32 v64, v64, v128
v_add_f32 v65, v65, v129
v_add_f32 v66, v66, v130
v_add_f32 v67, v67, v131
s_waitcnt lgkmcnt(0)
v_add_f32 v68, v68, v132
v_add_f32 v69, v69, v133
v_add_f32 v70, v70, v134
v_add_f32 v71, v71, v135
L_xchk:
s_waitcnt vmcnt(0)
v_max3_u32 v9, v152, v153, v154
v_max3_u32 v9, v9, v155, v156
v_max3_u32 v9, v9, v157, v158
v_max3_u32 v9, v9, v159, v160
v_max3_u32 v9, v9, v161, v162
v_max3_u32 v9, v9, v163, v164
v_max3_u32 v9, v9, v165, v166
v_max_u32 v9, v9, v167
v_cmp_eq_u32 vcc, -1, v9
s_cbranch_vccnz L_xretry
L_xgo:
v_mfma_f32_16x16x32_bf16 v[24:27], v[234:237], v[152:155], v[24:27]
v_mfma_f32_16x16x32_bf16 v[28:31], v[232:235], v[152:155], v[28:31]
v_mfma_f32_16x16x32_bf16 v[32:35], v[234:237], v[156:159], v[32:35]
v_mfma_f32_16x16x32_bf16 v[36:39], v[232:235], v[156:159], v[36:39]
v_mfma_f32_16x16x32_bf16 v[56:59], v[234:237], v[160:163], v[56:59]
v_mfma_f32_16x16x32_bf16 v[60:63], v[232:235], v[160:163], v[60:63]
v_mfma_f32_16x16x32_bf16 v[64:67], v[234:237], v[164:167], v[64:67]
v_mfma_f32_16x16x32_bf16 v[68:71], v[232:235], v[164:167], v[68:71]
s_nop 1
v_cvt_pk_bf16_f32 v24, v24, v25
v_cvt_pk_bf16_f32 v25, v26, v27
v_cvt_pk_bf16_f32 v26, v28, v29
v_cvt_pk_bf16_f32 v27, v30, v31
v_cvt_pk_bf16_f32 v32, v32, v33
v_cvt_pk_bf16_f32 v33, v34, v35
v_cvt_pk_bf16_f32 v34, v36, v37
v_cvt_pk_bf16_f32 v35, v38, v39
v_permlane16_swap_b32 v24, v26
v_permlane16_swap_b32 v25, v27
v_permlane16_swap_b32 v32, v34
v_permlane16_swap_b32 v33, v35
v_mov_b32 v28, v24
v_mov_b32 v29, v25
v_mov_b32 v30, v26
v_mov_b32 v31, v27
v_mov_b32_dpp v24, v32 row_ror:8 row_mask:0xf bank_mask:0xc
v_mov_b32_dpp v25, v33 row_ror:8 row_mask:0xf bank_mask:0xc
v_mov_b32_dpp v26, v34 row_ror:8 row_mask:0xf bank_mask:0xc
v_mov_b32_dpp v27, v35 row_ror:8 row_mask:0xf bank_mask:0xc
v_mov_b32_dpp v32, v28 row_ror:8 row_mask:0xf bank_mask:0x3
v_mov_b32_dpp v33, v29 row_ror:8 row_mask:0xf bank_mask:0x3
v_mov_b32_dpp v34, v30 row_ror:8 row_mask:0xf bank_mask:0x3
v_mov_b32_dpp v35, v31 row_ror:8 row_mask:0xf bank_mask:0x3
buffer_store_dwordx4 v[24:27], v8, s[48:51], s77 offen sc1
s_add_u32 s77, s77, 16384
buffer_store_dwordx4 v[32:35], v8, s[48:51], s77 offen sc1
s_add_u32 s77, s77, 16384
v_cvt_pk_bf16_f32 v56, v56, v57
v_cvt_pk_bf16_f32 v57, v58, v59
v_cvt_pk_bf16_f32 v58, v60, v61
v_cvt_pk_bf16_f32 v59, v62, v63
v_cvt_pk_bf16_f32 v64, v64, v65
v_cvt_pk_bf16_f32 v65, v66, v67
v_cvt_pk_bf16_f32 v66, v68, v69
v_cvt_pk_bf16_f32 v67, v70, v71
v_permlane16_swap_b32 v56, v58
v_permlane16_swap_b32 v57, v59
v_permlane16_swap_b32 v64, v66
v_permlane16_swap_b32 v65, v67
v_mov_b32 v60, v56
v_mov_b32 v61, v57
v_mov_b32 v62, v58
v_mov_b32 v63, v59
v_mov_b32_dpp v56, v64 row_ror:8 row_mask:0xf bank_mask:0xc
v_mov_b32_dpp v57, v65 row_ror:8 row_mask:0xf bank_mask:0xc
v_mov_b32_dpp v58, v66 row_ror:8 row_mask:0xf bank_mask:0xc
v_mov_b32_dpp v59, v67 row_ror:8 row_mask:0xf bank_mask:0xc
v_mov_b32_dpp v64, v60 row_ror:8 row_mask:0xf bank_mask:0x3
v_mov_b32_dpp v65, v61 row_ror:8 row_mask:0xf bank_mask:0x3
v_mov_b32_dpp v66, v62 row_ror:8 row_mask:0xf bank_mask:0x3
v_mov_b32_dpp v67, v63 row_ror:8 row_mask:0xf bank_mask:0x3
buffer_store_dwordx4 v[56:59], v8, s[48:51], s77 offen sc1
s_add_u32 s77, s77, 16384
buffer_store_dwordx4 v[64:67], v8, s[48:51], s77 offen sc1
s_add_u32 s77, s77, 16384
L_end:
s_endpgm
L_spin_1:
s_mov_b32 vcc_hi, 0x8000
L_spinlp_3:
s_sleep 1
buffer_load_dword v1, off, s[52:55], s78 offset:0 sc1
s_waitcnt vmcnt(0)
v_readfirstlane_b32 vcc_lo, v1
s_sub_u32 vcc_hi, vcc_hi, 1
s_cbranch_scc1 L_spinbk_2
s_cmp_lt_u32 vcc_lo, s81
s_cbranch_scc1 L_spinlp_3
s_branch L_spinbk_2
L_spin_4:
s_mov_b32 vcc_hi, 0x8000
L_spinlp_6:
s_sleep 1
buffer_load_dword v1, off, s[52:55], s70 offset:0 sc1
s_waitcnt vmcnt(0)
v_readfirstlane_b32 vcc_lo, v1
s_sub_u32 vcc_hi, vcc_hi, 1
s_cbranch_scc1 L_spinbk_5
s_cmp_lt_u32 vcc_lo, s81
s_cbranch_scc1 L_spinlp_6
s_branch L_spinbk_5
L_hretry:
s_sub_u32 s72, s72, 1
s_cbranch_scc1 L_hgo
buffer_load_dwordx4 v[88:91], v16, s[44:47], s77 offen sc1
s_waitcnt vmcnt(0)
s_branch L_hchk
L_spin_8:
s_mov_b32 vcc_hi, 0x8000
L_spinlp_10:
s_sleep 1
buffer_load_dword v19, off, s[52:55], s80 offset:0 sc1
s_waitcnt vmcnt(0)
v_readfirstlane_b32 vcc_lo, v19
s_sub_u32 vcc_hi, vcc_hi, 1
s_cbranch_scc1 L_spinbk_9
s_cmp_lt_u32 vcc_lo, 32
s_cbranch_scc1 L_spinlp_10
s_branch L_spinbk_9
L_spin_1012:
s_mov_b32 vcc_hi, 0x8000
L_spinlp_1014:
s_sleep 1
buffer_load_dword v19, off, s[52:55], s80 offset:0 sc1
s_waitcnt vmcnt(0)
v_readfirstlane_b32 vcc_lo, v19
s_sub_u32 vcc_hi, vcc_hi, 1
s_cbranch_scc1 L_spinbk_1013
s_cmp_lt_u32 vcc_lo, 32
s_cbranch_scc1 L_spinlp_1014
s_branch L_spinbk_1013
L_F1:
ds_read_b128 a[144:147], v2 offset:0
ds_read_b128 a[148:151], v2 offset:1024
ds_read_b128 a[152:155], v2 offset:2048
ds_read_b128 a[156:159], v2 offset:3072
ds_read_b128 a[160:163], v2 offset:4096
ds_read_b128 a[164:167], v2 offset:5120
ds_read_b128 a[168:171], v2 offset:6144
ds_read_b128 a[172:175], v2 offset:7168
s_mov_b32 m0, s71
s_nop 0
buffer_load_dwordx4 v16, s[32:35], s70 offen offset:0 sc1 lds
buffer_load_dwordx4 v16, s[32:35], s70 offen offset:1024 sc1 lds
s_waitcnt lgkmcnt(7)
v_mfma_f32_16x16x32_bf16 v[104:107], a[144:147], v[40:43], 0
s_waitcnt lgkmcnt(6)
ds_read_b128 a[176:179], v2 offset:8192
v_cndmask_b32 v88, 0, v17, s[0:1]
v_mfma_f32_16x16x32_bf16 v[104:107], a[148:151], v[44:47], v[104:107]
s_waitcnt lgkmcnt(6)
ds_read_b128 a[180:183], v2 offset:9216
v_cndmask_b32 v89, 0, v17, s[4:5]
v_mfma_f32_16x16x32_bf16 v[104:107], a[152:155], v[48:51], v[104:107]
s_waitcnt lgkmcnt(6)
buffer_load_dwordx4 v16, s[32:35], s70 offen offset:2048 sc1 lds
v_mfma_f32_16x16x32_bf16 v[104:107], a[156:159], v[52:55], v[104:107]
ds_read_b128 a[184:187], v2 offset:10240
v_cndmask_b32 v90, 0, v17, s[6:7]
v_mfma_f32_16x16x32_bf16 v[120:123], a[156:159], v[68:71], 0
ds_read_b128 a[188:191], v2 offset:11264
v_cndmask_b32 v91, 0, v17, s[8:9]
v_mfma_f32_16x16x32_bf16 v[120:123], a[152:155], v[64:67], v[120:123]
ds_read_b128 a[192:195], v2 offset:12288
ds_read_b128 a[196:199], v2 offset:13312
v_mfma_f32_16x16x32_bf16 v[120:123], a[148:151], v[60:63], v[120:123]
ds_read_b128 a[200:203], v2 offset:14336
v_mfma_f32_16x16x32_bf16 v[120:123], a[144:147], v[56:59], v[120:123]
ds_read_b128 a[204:207], v2 offset:15360
v_mfma_f32_16x16x32_bf16 v[136:139], a[144:147], v[72:75], 0
v_mfma_f32_16x16x32_bf16 v[136:139], a[148:151], v[76:79], v[136:139]
buffer_load_dwordx4 v16, s[32:35], s70 offen offset:3072 sc1 lds
v_mfma_f32_16x16x32_bf16 v[136:139], a[152:155], v[80:83], v[136:139]
v_mfma_f32_16x16x32_bf16 v[136:139], a[156:159], v[84:87], v[136:139]
v_mfma_f32_16x16x32_bf16 v[88:91], a[156:159], v[36:39], v[88:91]
v_mfma_f32_16x16x32_bf16 v[88:91], a[152:155], v[32:35], v[88:91]
v_mfma_f32_16x16x32_bf16 v[88:91], a[148:151], v[28:31], v[88:91]
v_mfma_f32_16x16x32_bf16 v[88:91], a[144:147], v[24:27], v[88:91]
s_waitcnt lgkmcnt(0)
s_nop 1
v_max3_f32 v21, v104, v105, v106
v_max_f32 v21, v21, v107
v_max3_f32 v22, v120, v121, v122
v_max_f32 v22, v22, v123
v_max3_f32 v23, v136, v137, v138
v_max_f32 v23, v23, v139
v_max3_f32 v20, v88, v89, v90
v_max_f32 v20, v20, v91
v_mov_b32 v248, v20
v_mov_b32 v249, v21
v_mov_b32 v250, v22
v_mov_b32 v251, v23
v_permlane16_swap_b32 v248, v20
v_permlane16_swap_b32 v249, v21
v_permlane16_swap_b32 v250, v22
v_permlane16_swap_b32 v251, v23
v_max_f32 v20, v20, v248
v_max_f32 v21, v21, v249
v_max_f32 v22, v22, v250
v_max_f32 v23, v23, v251
v_mov_b32 v248, v20
v_mov_b32 v249, v21
v_mov_b32 v250, v22
v_mov_b32 v251, v23
v_permlane32_swap_b32 v248, v20
v_permlane32_swap_b32 v249, v21
v_permlane32_swap_b32 v250, v22
v_permlane32_swap_b32 v251, v23
v_max_f32 v20, v20, v248
v_max_f32 v21, v21, v249
v_max_f32 v22, v22, v250
v_max_f32 v23, v23, v251
s_cmp_eq_u32 s73, 0
s_cselect_b64 vcc, 0, -1
v_cndmask_b32 v20, v20, v252, vcc
v_cndmask_b32 v21, v21, v253, vcc
v_cndmask_b32 v22, v22, v254, vcc
v_cndmask_b32 v23, v23, v255, vcc
v_sub_f32 v228, 0, v23
v_sub_f32 v229, 0, v23
v_sub_f32 v230, 0, v23
v_sub_f32 v231, 0, v23
v_sub_f32 v224, 0, v22
v_sub_f32 v225, 0, v22
v_sub_f32 v226, 0, v22
v_sub_f32 v227, 0, v22
v_sub_f32 v220, 0, v21
v_sub_f32 v221, 0, v21
v_sub_f32 v222, 0, v21
v_sub_f32 v223, 0, v21
v_sub_f32 v216, 0, v20
v_sub_f32 v217, 0, v20
v_sub_f32 v218, 0, v20
v_sub_f32 v219, 0, v20
v_mfma_f32_16x16x32_bf16 v[140:143], a[160:163], v[72:75], v[228:231]
s_add_u32 m0, s71, 4096
v_add_f32 v104, v104, v220
v_add_f32 v105, v105, v220
v_mfma_f32_16x16x32_bf16 v[140:143], a[164:167], v[76:79], v[140:143]
v_add_f32 v106, v106, v220
v_add_f32 v107, v107, v220
v_exp_f32 v104, v104
v_mfma_f32_16x16x32_bf16 v[140:143], a[168:171], v[80:83], v[140:143]
s_add_u32 s64, s70, 4096
v_exp_f32 v105, v105
v_mfma_f32_16x16x32_bf16 v[140:143], a[172:175], v[84:87], v[140:143]
buffer_load_dwordx4 v16, s[32:35], s64 offen offset:0 sc1 lds
v_mfma_f32_16x16x32_bf16 v[124:127], a[172:175], v[68:71], v[224:227]
v_exp_f32 v106, v106
v_mfma_f32_16x16x32_bf16 v[124:127], a[168:171], v[64:67], v[124:127]
v_exp_f32 v107, v107
v_mfma_f32_16x16x32_bf16 v[124:127], a[164:167], v[60:63], v[124:127]
v_add_f32 v120, v120, v224
v_add_f32 v121, v121, v224
v_add_f32 v122, v122, v224
v_add_f32 v123, v123, v224
v_exp_f32 v120, v120
v_mfma_f32_16x16x32_bf16 v[124:127], a[160:163], v[56:59], v[124:127]
v_exp_f32 v121, v121
v_mfma_f32_16x16x32_bf16 v[108:111], a[160:163], v[40:43], v[220:223]
v_exp_f32 v122, v122
v_mfma_f32_16x16x32_bf16 v[108:111], a[164:167], v[44:47], v[108:111]
v_cndmask_b32 v92, v216, v17, s[10:11]
v_cndmask_b32 v93, v216, v17, s[12:13]
v_cndmask_b32 v94, v216, v17, s[18:19]
v_cndmask_b32 v95, v216, v17, s[22:23]
v_mfma_f32_16x16x32_bf16 v[108:111], a[168:171], v[48:51], v[108:111]
buffer_load_dwordx4 v16, s[32:35], s64 offen offset:1024 sc1 lds
v_cvt_pk_bf16_f32 v160, v104, v105
v_mfma_f32_16x16x32_bf16 v[108:111], a[172:175], v[52:55], v[108:111]
v_exp_f32 v123, v123
v_mfma_f32_16x16x32_bf16 v[92:95], a[172:175], v[36:39], v[92:95]
v_add_f32 v136, v136, v228
v_add_f32 v137, v137, v228
v_add_f32 v138, v138, v228
v_add_f32 v139, v139, v228
v_exp_f32 v136, v136
v_mfma_f32_16x16x32_bf16 v[92:95], a[168:171], v[32:35], v[92:95]
v_cvt_pk_bf16_f32 v161, v106, v107
v_exp_f32 v137, v137
v_cndmask_b32 v96, v216, v17, s[26:27]
v_cndmask_b32 v97, v216, v17, s[56:57]
v_cndmask_b32 v98, v216, v17, s[58:59]
v_cndmask_b32 v99, v216, v17, s[60:61]
v_mfma_f32_16x16x32_bf16 v[92:95], a[164:167], v[28:31], v[92:95]
v_exp_f32 v138, v138
v_mfma_f32_16x16x32_bf16 v[92:95], a[160:163], v[24:27], v[92:95]
v_exp_f32 v139, v139
v_mfma_f32_16x16x32_bf16 v[96:99], a[176:179], v[24:27], v[96:99]
v_cvt_pk_bf16_f32 v184, v120, v121
v_add_f32 v88, v88, v216
v_mfma_f32_16x16x32_bf16 v[96:99], a[180:183], v[28:31], v[96:99]
buffer_load_dwordx4 v16, s[32:35], s64 offen offset:2048 sc1 lds
v_add_f32 v89, v89, v216
v_add_f32 v90, v90, v216
v_add_f32 v91, v91, v216
v_exp_f32 v88, v88
v_mfma_f32_16x16x32_bf16 v[96:99], a[184:187], v[32:35], v[96:99]
v_exp_f32 v89, v89
v_mfma_f32_16x16x32_bf16 v[96:99], a[188:191], v[36:39], v[96:99]
v_cvt_pk_bf16_f32 v185, v122, v123
v_cvt_pk_bf16_f32 v192, v136, v137
v_mfma_f32_16x16x32_bf16 v[112:115], a[188:191], v[52:55], v[220:223]
v_exp_f32 v90, v90
v_mfma_f32_16x16x32_bf16 v[112:115], a[184:187], v[48:51], v[112:115]
v_exp_f32 v91, v91
v_mfma_f32_16x16x32_bf16 v[112:115], a[180:183], v[44:47], v[112:115]
v_exp_f32 v140, v140
v_mfma_f32_16x16x32_bf16 v[112:115], a[176:179], v[40:43], v[112:115]
v_exp_f32 v141, v141
v_mfma_f32_16x16x32_bf16 v[128:131], a[176:179], v[56:59], v[224:227]
buffer_load_dwordx4 v16, s[32:35], s64 offen offset:3072 sc1 lds
v_cvt_pk_bf16_f32 v193, v138, v139
v_mfma_f32_16x16x32_bf16 v[128:131], a[180:183], v[60:63], v[128:131]
v_exp_f32 v142, v142
v_mfma_f32_16x16x32_bf16 v[128:131], a[184:187], v[64:67], v[128:131]
v_exp_f32 v143, v143
v_mfma_f32_16x16x32_bf16 v[128:131], a[188:191], v[68:71], v[128:131]
v_cvt_pk_bf16_f32 v152, v88, v89
v_cvt_pk_bf16_f32 v153, v90, v91
v_mfma_f32_16x16x32_bf16 v[144:147], a[188:191], v[84:87], v[228:231]
v_exp_f32 v124, v124
v_mfma_f32_16x16x32_bf16 v[144:147], a[184:187], v[80:83], v[144:147]
v_exp_f32 v125, v125
v_mfma_f32_16x16x32_bf16 v[144:147], a[180:183], v[76:79], v[144:147]
s_waitcnt vmcnt(8)
s_barrier
v_mfma_f32_16x16x32_bf16 v[144:147], a[176:179], v[72:75], v[144:147]
v_exp_f32 v126, v126
v_mfma_f32_16x16x32_bf16 v[148:151], a[192:195], v[72:75], v[228:231]
v_cvt_pk_bf16_f32 v194, v140, v141
v_cvt_pk_bf16_f32 v195, v142, v143
v_mfma_f32_16x16x32_bf16 v[148:151], a[196:199], v[76:79], v[148:151]
v_exp_f32 v127, v127
v_mfma_f32_16x16x32_bf16 v[148:151], a[200:203], v[80:83], v[148:151]
s_xor_b32 s71, s71, 16384
v_exp_f32 v108, v108
v_mfma_f32_16x16x32_bf16 v[148:151], a[204:207], v[84:87], v[148:151]
s_add_u32 s70, s70, 32768
v_exp_f32 v109, v109
v_mfma_f32_16x16x32_bf16 v[132:135], a[204:207], v[68:71], v[224:227]
s_mov_b32 m0, s71
v_exp_f32 v110, v110
v_mfma_f32_16x16x32_bf16 v[132:135], a[200:203], v[64:67], v[132:135]
buffer_load_dwordx4 v16, s[32:35], s70 offen offset:0 sc1 lds
v_mfma_f32_16x16x32_bf16 v[132:135], a[196:199], v[60:63], v[132:135]
v_cvt_pk_bf16_f32 v186, v124, v125
v_exp_f32 v111, v111
v_mfma_f32_16x16x32_bf16 v[132:135], a[192:195], v[56:59], v[132:135]
v_exp_f32 v92, v92
v_mfma_f32_16x16x32_bf16 v[116:119], a[192:195], v[40:43], v[220:223]
ds_read_b128 a[144:147], v2 offset:16384
v_cndmask_b32 v100, v216, v17, s[62:63]
v_mfma_f32_16x16x32_bf16 v[116:119], a[196:199], v[44:47], v[116:119]
ds_read_b128 a[148:151], v2 offset:17408
v_cndmask_b32 v101, v216, v17, s[48:49]
v_cndmask_b32 v102, v216, v17, s[50:51]
v_cndmask_b32 v103, v216, v17, s[100:101]
v_cvt_pk_bf16_f32 v187, v126, v127
v_exp_f32 v93, v93
v_mfma_f32_16x16x32_bf16 v[116:119], a[200:203], v[48:51], v[116:119]
v_exp_f32 v94, v94
v_mfma_f32_16x16x32_bf16 v[116:119], a[204:207], v[52:55], v[116:119]
ds_read_b128 a[152:155], v2 offset:18432
v_cvt_pk_bf16_f32 v162, v108, v109
v_mfma_f32_16x16x32_bf16 v[100:103], a[204:207], v[36:39], v[100:103]
buffer_load_dwordx4 v16, s[32:35], s70 offen offset:1024 sc1 lds
v_exp_f32 v95, v95
v_mfma_f32_16x16x32_bf16 v[100:103], a[200:203], v[32:35], v[100:103]
ds_read_b128 a[156:159], v2 offset:19456
v_exp_f32 v96, v96
v_mfma_f32_16x16x32_bf16 v[100:103], a[196:199], v[28:31], v[100:103]
v_cvt_pk_bf16_f32 v163, v110, v111
v_exp_f32 v97, v97
v_mfma_f32_16x16x32_bf16 v[100:103], a[192:195], v[24:27], v[100:103]
s_waitcnt lgkmcnt(2)
ds_read_b128 a[160:163], v2 offset:20480
ds_read_b128 a[164:167], v2 offset:21504
ds_read_b128 a[168:171], v2 offset:22528
ds_read_b128 a[172:175], v2 offset:23552
v_mfma_f32_16x16x32_bf16 v[120:123], a[144:147], v[56:59], v[224:227]
v_exp_f32 v98, v98
v_mfma_f32_16x16x32_bf16 v[120:123], a[148:151], v[60:63], v[120:123]
s_waitcnt lgkmcnt(5)
v_cvt_pk_bf16_f32 v154, v92, v93
v_exp_f32 v99, v99
v_mfma_f32_16x16x32_bf16 v[120:123], a[152:155], v[64:67], v[120:123]
s_waitcnt lgkmcnt(4)
v_exp_f32 v112, v112
v_mfma_f32_16x16x32_bf16 v[120:123], a[156:159], v[68:71], v[120:123]
v_exp_f32 v113, v113
v_mfma_f32_16x16x32_bf16 v[136:139], a[156:159], v[84:87], v[228:231]
v_cvt_pk_bf16_f32 v155, v94, v95
v_cndmask_b32 v104, v220, v17, s[0:1]
v_mfma_f32_16x16x32_bf16 v[136:139], a[152:155], v[80:83], v[136:139]
ds_read_b128 a[176:179], v2 offset:24576
buffer_load_dwordx4 v16, s[32:35], s70 offen offset:2048 sc1 lds
v_cndmask_b32 v105, v220, v17, s[4:5]
v_cndmask_b32 v106, v220, v17, s[6:7]
v_cndmask_b32 v107, v220, v17, s[8:9]
v_exp_f32 v114, v114
v_mfma_f32_16x16x32_bf16 v[136:139], a[148:151], v[76:79], v[136:139]
v_cvt_pk_bf16_f32 v156, v96, v97
v_cvt_pk_bf16_f32 v157, v98, v99
v_mfma_f32_16x16x32_bf16 v[136:139], a[144:147], v[72:75], v[136:139]
v_exp_f32 v115, v115
v_mfma_f32_16x16x32_bf16 v[104:107], a[144:147], v[40:43], v[104:107]
v_exp_f32 v128, v128
v_mfma_f32_16x16x32_bf16 v[104:107], a[148:151], v[44:47], v[104:107]
v_exp_f32 v129, v129
v_mfma_f32_16x16x32_bf16 v[104:107], a[152:155], v[48:51], v[104:107]
v_exp_f32 v130, v130
v_mfma_f32_16x16x32_bf16 v[104:107], a[156:159], v[52:55], v[104:107]
s_waitcnt lgkmcnt(0)
v_exp_f32 v131, v131
v_mfma_f32_16x16x32_bf16 v[140:143], a[172:175], v[84:87], v[228:231]
v_cvt_pk_bf16_f32 v164, v112, v113
v_cvt_pk_bf16_f32 v165, v114, v115
v_mfma_f32_16x16x32_bf16 v[140:143], a[168:171], v[80:83], v[140:143]
v_exp_f32 v144, v144
v_mfma_f32_16x16x32_bf16 v[140:143], a[164:167], v[76:79], v[140:143]
v_exp_f32 v145, v145
v_mfma_f32_16x16x32_bf16 v[140:143], a[160:163], v[72:75], v[140:143]
v_exp_f32 v146, v146
v_mfma_f32_16x16x32_bf16 v[124:127], a[160:163], v[56:59], v[224:227]
ds_read_b128 a[180:183], v2 offset:25600
v_cndmask_b32 v108, v220, v17, s[10:11]
v_mfma_f32_16x16x32_bf16 v[124:127], a[164:167], v[60:63], v[124:127]
ds_read_b128 a[184:187], v2 offset:26624
v_cndmask_b32 v109, v220, v17, s[12:13]
v_cndmask_b32 v110, v220, v17, s[18:19]
v_cndmask_b32 v111, v220, v17, s[22:23]
v_cvt_pk_bf16_f32 v188, v128, v129
v_mfma_f32_16x16x32_bf16 v[124:127], a[168:171], v[64:67], v[124:127]
buffer_load_dwordx4 v16, s[32:35], s70 offen offset:3072 sc1 lds
v_exp_f32 v147, v147
v_mfma_f32_16x16x32_bf16 v[124:127], a[172:175], v[68:71], v[124:127]
s_add_u32 m0, s86, 131072
ds_read_b128 a[188:191], v2 offset:27648
v_exp_f32 v148, v148
v_mfma_f32_16x16x32_bf16 v[108:111], a[172:175], v[52:55], v[108:111]
s_add_u32 s64, s85, 0
v_cvt_pk_bf16_f32 v189, v130, v131
v_exp_f32 v149, v149
v_mfma_f32_16x16x32_bf16 v[108:111], a[168:171], v[48:51], v[108:111]
ds_read_b128 a[192:195], v2 offset:28672
buffer_load_dwordx4 v12, s[36:39], s64 offen lds
v_cndmask_b32 v112, v220, v17, s[26:27]
v_cndmask_b32 v113, v220, v17, s[56:57]
v_cndmask_b32 v114, v220, v17, s[58:59]
v_cndmask_b32 v115, v220, v17, s[60:61]
v_mfma_f32_16x16x32_bf16 v[108:111], a[164:167], v[44:47], v[108:111]
s_add_u32 m0, s86, 132096
v_exp_f32 v150, v150
v_mfma_f32_16x16x32_bf16 v[108:111], a[160:163], v[40:43], v[108:111]
s_add_u32 s64, s85, 8192
v_cvt_pk_bf16_f32 v196, v144, v145
v_exp_f32 v151, v151
v_mfma_f32_16x16x32_bf16 v[112:115], a[176:179], v[40:43], v[112:115]
s_waitcnt lgkmcnt(2)
buffer_load_dwordx4 v13, s[36:39], s64 offen lds
v_exp_f32 v132, v132
v_mfma_f32_16x16x32_bf16 v[112:115], a[180:183], v[44:47], v[112:115]
s_add_u32 m0, s86, 133120
v_exp_f32 v133, v133
v_mfma_f32_16x16x32_bf16 v[112:115], a[184:187], v[48:51], v[112:115]
s_waitcnt lgkmcnt(1)
s_add_u32 s64, s85, 16384
v_cvt_pk_bf16_f32 v197, v146, v147
v_cvt_pk_bf16_f32 v198, v148, v149
v_mfma_f32_16x16x32_bf16 v[112:115], a[188:191], v[52:55], v[112:115]
buffer_load_dwordx4 v12, s[36:39], s64 offen lds
v_exp_f32 v134, v134
v_mfma_f32_16x16x32_bf16 v[128:131], a[188:191], v[68:71], v[224:227]
s_add_u32 m0, s86, 134144
ds_read_b128 a[196:199], v2 offset:29696
ds_read_b128 a[200:203], v2 offset:30720
ds_read_b128 a[204:207], v2 offset:31744
v_mfma_f32_16x16x32_bf16 v[128:131], a[184:187], v[64:67], v[128:131]
s_add_u32 s64, s85, 24576
v_exp_f32 v135, v135
v_mfma_f32_16x16x32_bf16 v[128:131], a[180:183], v[60:63], v[128:131]
buffer_load_dwordx4 v13, s[36:39], s64 offen lds
v_exp_f32 v116, v116
v_mfma_f32_16x16x32_bf16 v[128:131], a[176:179], v[56:59], v[128:131]
s_add_u32 m0, s71, 4096
v_cvt_pk_bf16_f32 v199, v150, v151
v_exp_f32 v117, v117
v_mfma_f32_16x16x32_bf16 v[144:147], a[176:179], v[72:75], v[228:231]
s_add_u32 s64, s70, 4096
v_exp_f32 v118, v118
v_mfma_f32_16x16x32_bf16 v[144:147], a[180:183], v[76:79], v[144:147]
buffer_load_dwordx4 v16, s[32:35], s64 offen offset:0 sc1 lds
v_mfma_f32_16x16x32_bf16 v[144:147], a[184:187], v[80:83], v[144:147]
v_cvt_pk_bf16_f32 v190, v132, v133
v_exp_f32 v119, v119
v_mfma_f32_16x16x32_bf16 v[144:147], a[188:191], v[84:87], v[144:147]
s_waitcnt lgkmcnt(0)
v_exp_f32 v100, v100
v_mfma_f32_16x16x32_bf16 v[148:151], a[204:207], v[84:87], v[228:231]
v_exp_f32 v101, v101
v_mfma_f32_16x16x32_bf16 v[148:151], a[200:203], v[80:83], v[148:151]
v_cvt_pk_bf16_f32 v191, v134, v135
v_cvt_pk_bf16_f32 v166, v116, v117
v_cvt_pk_bf16_f32 v167, v118, v119
v_mfma_f32_16x16x32_bf16 v[148:151], a[196:199], v[76:79], v[148:151]
v_exp_f32 v102, v102
v_mfma_f32_16x16x32_bf16 v[148:151], a[192:195], v[72:75], v[148:151]
v_exp_f32 v103, v103
v_mfma_f32_16x16x32_bf16 v[132:135], a[192:195], v[56:59], v[224:227]
s_lshl_b32 s66, s30, 30
ds_read_b128 a[144:147], v3 offset:16384
v_cndmask_b32 v116, v220, v17, s[62:63]
v_mfma_f32_16x16x32_bf16 v[132:135], a[196:199], v[60:63], v[132:135]
ds_read_b128 a[148:151], v3 offset:24576
v_cndmask_b32 v117, v220, v17, s[48:49]
v_cndmask_b32 v118, v220, v17, s[50:51]
v_cndmask_b32 v119, v220, v17, s[100:101]
v_exp_f32 v120, v120
v_mfma_f32_16x16x32_bf16 v[132:135], a[200:203], v[64:67], v[132:135]
v_exp_f32 v121, v121
v_mfma_f32_16x16x32_bf16 v[132:135], a[204:207], v[68:71], v[132:135]
v_exp_f32 v122, v122
v_mfma_f32_16x16x32_bf16 v[116:119], a[204:207], v[52:55], v[116:119]
v_exp_f32 v123, v123
v_mfma_f32_16x16x32_bf16 v[116:119], a[200:203], v[48:51], v[116:119]
v_cvt_pk_bf16_f32 v158, v100, v101
v_cvt_pk_bf16_f32 v159, v102, v103
v_mfma_f32_16x16x32_bf16 v[116:119], a[196:199], v[44:47], v[116:119]
buffer_load_dwordx4 v16, s[32:35], s64 offen offset:1024 sc1 lds
v_mfma_f32_16x16x32_bf16 v[116:119], a[192:195], v[40:43], v[116:119]
v_exp_f32 v136, v136
v_mfma_f32_16x16x32_bf16 a[128:131], a[244:247], v[152:155], 0
v_exp_f32 v137, v137
v_mfma_f32_16x16x32_bf16 a[128:131], a[244:247], v[156:159], a[128:131]
v_exp_f32 v138, v138
v_mfma_f32_16x16x32_bf16 a[132:135], a[244:247], v[160:163], 0
v_exp_f32 v139, v139
v_mfma_f32_16x16x32_bf16 a[132:135], a[244:247], v[164:167], a[132:135]
v_cvt_pk_bf16_f32 v200, v120, v121
v_cvt_pk_bf16_f32 v201, v122, v123
v_mfma_f32_16x16x32_bf16 a[136:139], a[244:247], v[184:187], 0
v_exp_f32 v104, v104
v_mfma_f32_16x16x32_bf16 a[136:139], a[244:247], v[188:191], a[136:139]
v_exp_f32 v105, v105
v_mfma_f32_16x16x32_bf16 a[140:143], a[244:247], v[192:195], 0
ds_read_b128 a[152:155], v3 offset:17408
v_cvt_pk_bf16_f32 v208, v136, v137
v_mfma_f32_16x16x32_bf16 a[140:143], a[244:247], v[196:199], a[140:143]
s_waitcnt lgkmcnt(1)
v_exp_f32 v106, v106
v_mfma_f32_16x16x32_bf16 a[0:3], a[144:147], v[152:155], 0
ds_read_b128 a[156:159], v3 offset:25600
v_cvt_pk_bf16_f32 v209, v138, v139
v_mfma_f32_16x16x32_bf16 a[0:3], a[148:151], v[156:159], a[0:3]
v_exp_f32 v107, v107
v_mfma_f32_16x16x32_bf16 a[32:35], a[148:151], v[164:167], 0
v_exp_f32 v140, v140
v_mfma_f32_16x16x32_bf16 a[32:35], a[144:147], v[160:163], a[32:35]
buffer_load_dwordx4 v16, s[32:35], s64 offen offset:2048 sc1 lds
v_mfma_f32_16x16x32_bf16 a[64:67], a[144:147], v[184:187], 0
v_exp_f32 v141, v141
v_mfma_f32_16x16x32_bf16 a[64:67], a[148:151], v[188:191], a[64:67]
v_exp_f32 v142, v142
v_mfma_f32_16x16x32_bf16 a[96:99], a[148:151], v[196:199], 0
ds_read_b128 a[160:163], v3 offset:18432
v_cvt_pk_bf16_f32 v176, v104, v105
v_mfma_f32_16x16x32_bf16 a[96:99], a[144:147], v[192:195], a[96:99]
s_waitcnt lgkmcnt(1)
ds_read_b128 a[164:167], v3 offset:26624
v_cvt_pk_bf16_f32 v177, v106, v107
v_mfma_f32_16x16x32_bf16 a[100:103], a[152:155], v[192:195], 0
v_exp_f32 v143, v143
v_mfma_f32_16x16x32_bf16 a[100:103], a[156:159], v[196:199], a[100:103]
v_exp_f32 v124, v124
v_mfma_f32_16x16x32_bf16 a[68:71], a[156:159], v[188:191], 0
v_exp_f32 v125, v125
v_mfma_f32_16x16x32_bf16 a[68:71], a[152:155], v[184:187], a[68:71]
v_exp_f32 v126, v126
v_mfma_f32_16x16x32_bf16 a[36:39], a[152:155], v[160:163], 0
v_exp_f32 v127, v127
v_mfma_f32_16x16x32_bf16 a[36:39], a[156:159], v[164:167], a[36:39]
ds_read_b128 a[168:171], v3 offset:19456
v_cvt_pk_bf16_f32 v210, v140, v141
v_mfma_f32_16x16x32_bf16 a[4:7], a[156:159], v[156:159], 0
ds_read_b128 a[172:175], v3 offset:27648
v_cvt_pk_bf16_f32 v211, v142, v143
v_mfma_f32_16x16x32_bf16 a[4:7], a[152:155], v[152:155], a[4:7]
s_waitcnt lgkmcnt(2)
v_exp_f32 v108, v108
v_mfma_f32_16x16x32_bf16 a[8:11], a[160:163], v[152:155], 0
v_exp_f32 v109, v109
v_mfma_f32_16x16x32_bf16 a[8:11], a[164:167], v[156:159], a[8:11]
buffer_load_dwordx4 v16, s[32:35], s64 offen offset:3072 sc1 lds
v_mfma_f32_16x16x32_bf16 a[40:43], a[164:167], v[164:167], 0
v_exp_f32 v110, v110
v_mfma_f32_16x16x32_bf16 a[40:43], a[160:163], v[160:163], a[40:43]
v_exp_f32 v111, v111
v_mfma_f32_16x16x32_bf16 a[72:75], a[160:163], v[184:187], 0
v_exp_f32 v112, v112
v_mfma_f32_16x16x32_bf16 a[72:75], a[164:167], v[188:191], a[72:75]
v_cvt_pk_bf16_f32 v202, v124, v125
v_cvt_pk_bf16_f32 v203, v126, v127
v_mfma_f32_16x16x32_bf16 a[104:107], a[164:167], v[196:199], 0
ds_read_b128 a[176:179], v3 offset:20480
v_cvt_pk_bf16_f32 v178, v108, v109
v_mfma_f32_16x16x32_bf16 a[104:107], a[160:163], v[192:195], a[104:107]
s_waitcnt lgkmcnt(1)
ds_read_b128 a[180:183], v3 offset:28672
v_xor_b32 v2, 0x8000, v2
v_mfma_f32_16x16x32_bf16 a[108:111], a[168:171], v[192:195], 0
s_add_u32 m0, s86, 135168
v_exp_f32 v113, v113
v_mfma_f32_16x16x32_bf16 a[108:111], a[172:175], v[196:199], a[108:111]
s_add_u32 s64, s85, 32768
v_exp_f32 v114, v114
v_mfma_f32_16x16x32_bf16 a[76:79], a[172:175], v[188:191], 0
buffer_load_dwordx4 v12, s[36:39], s64 offen lds
v_mfma_f32_16x16x32_bf16 a[76:79], a[168:171], v[184:187], a[76:79]
s_add_u32 m0, s86, 136192
v_exp_f32 v115, v115
v_mfma_f32_16x16x32_bf16 a[44:47], a[168:171], v[160:163], 0
s_add_u32 s64, s85, 40960
v_exp_f32 v128, v128
v_mfma_f32_16x16x32_bf16 a[44:47], a[172:175], v[164:167], a[44:47]
buffer_load_dwordx4 v13, s[36:39], s64 offen lds
v_mfma_f32_16x16x32_bf16 a[12:15], a[172:175], v[156:159], 0
ds_read_b128 a[184:187], v3 offset:21504
v_cvt_pk_bf16_f32 v179, v110, v111
v_mfma_f32_16x16x32_bf16 a[12:15], a[168:171], v[152:155], a[12:15]
s_waitcnt lgkmcnt(1)
s_add_u32 m0, s86, 137216
ds_read_b128 a[188:191], v3 offset:29696
ds_read_b128 a[192:195], v3 offset:22528
ds_read_b128 a[196:199], v3 offset:30720
ds_read_b128 a[200:203], v3 offset:23552
ds_read_b128 a[204:207], v3 offset:31744
v_mfma_f32_16x16x32_bf16 a[16:19], a[176:179], v[152:155], 0
s_waitcnt vmcnt(14)
s_barrier
s_add_u32 s64, s85, 49152
v_exp_f32 v129, v129
v_mfma_f32_16x16x32_bf16 a[16:19], a[180:183], v[156:159], a[16:19]
buffer_load_dwordx4 v12, s[36:39], s64 offen lds
v_mfma_f32_16x16x32_bf16 a[48:51], a[180:183], v[164:167], 0
s_add_u32 m0, s86, 138240
v_cvt_pk_bf16_f32 v180, v112, v113
v_exp_f32 v130, v130
v_mfma_f32_16x16x32_bf16 a[48:51], a[176:179], v[160:163], a[48:51]
s_add_u32 s64, s85, 57344
v_exp_f32 v131, v131
v_mfma_f32_16x16x32_bf16 a[80:83], a[176:179], v[184:187], 0
buffer_load_dwordx4 v13, s[36:39], s64 offen lds
v_mfma_f32_16x16x32_bf16 a[80:83], a[180:183], v[188:191], a[80:83]
v_cvt_pk_bf16_f32 v181, v114, v115
v_exp_f32 v144, v144
v_mfma_f32_16x16x32_bf16 a[112:115], a[180:183], v[196:199], 0
s_xor_b32 s71, s71, 49152
s_add_u32 s70, s70, 32768
s_mov_b32 m0, s71
v_exp_f32 v145, v145
v_mfma_f32_16x16x32_bf16 a[112:115], a[176:179], v[192:195], a[112:115]
s_waitcnt lgkmcnt(0)
buffer_load_dwordx4 v16, s[32:35], s70 offen offset:0 sc1 lds
v_mfma_f32_16x16x32_bf16 a[116:119], a[184:187], v[192:195], 0
v_cvt_pk_bf16_f32 v204, v128, v129
v_exp_f32 v146, v146
v_mfma_f32_16x16x32_bf16 a[116:119], a[188:191], v[196:199], a[116:119]
v_exp_f32 v147, v147
v_mfma_f32_16x16x32_bf16 a[84:87], a[188:191], v[188:191], 0
v_exp_f32 v148, v148
v_mfma_f32_16x16x32_bf16 a[84:87], a[184:187], v[184:187], a[84:87]
v_exp_f32 v149, v149
v_mfma_f32_16x16x32_bf16 a[52:55], a[184:187], v[160:163], 0
v_cvt_pk_bf16_f32 v205, v130, v131
v_cvt_pk_bf16_f32 v212, v144, v145
v_mfma_f32_16x16x32_bf16 a[52:55], a[188:191], v[164:167], a[52:55]
v_exp_f32 v150, v150
v_mfma_f32_16x16x32_bf16 a[20:23], a[188:191], v[156:159], 0
v_exp_f32 v151, v151
v_mfma_f32_16x16x32_bf16 a[20:23], a[184:187], v[152:155], a[20:23]
v_exp_f32 v132, v132
v_mfma_f32_16x16x32_bf16 a[24:27], a[192:195], v[152:155], 0
v_exp_f32 v133, v133
v_mfma_f32_16x16x32_bf16 a[24:27], a[196:199], v[156:159], a[24:27]
ds_read_b128 a[144:147], v2 offset:0
v_lshl_add_u32 v19, v0, 24, s66
v_mfma_f32_16x16x32_bf16 a[56:59], a[196:199], v[164:167], 0
s_lshr_b32 s67, s31, 4
v_cvt_pk_bf16_f32 v213, v146, v147
v_cvt_pk_bf16_f32 v214, v148, v149
v_mfma_f32_16x16x32_bf16 a[56:59], a[192:195], v[160:163], a[56:59]
s_lshl1_add_u32 s67, s3, s67
v_exp_f32 v134, v134
v_mfma_f32_16x16x32_bf16 a[88:91], a[192:195], v[184:187], 0
s_lshl_b32 s79, s67, 8
buffer_load_dwordx4 v16, s[32:35], s70 offen offset:1024 sc1 lds
v_mfma_f32_16x16x32_bf16 a[88:91], a[196:199], v[188:191], a[88:91]
s_add_u32 s79, s79, 8192
v_exp_f32 v135, v135
v_mfma_f32_16x16x32_bf16 a[120:123], a[196:199], v[196:199], 0
s_lshl_b32 s67, s73, 16
v_exp_f32 v116, v116
v_mfma_f32_16x16x32_bf16 a[120:123], a[192:195], v[192:195], a[120:123]
s_xor_b32 s68, s80, 256
v_exp_f32 v117, v117
v_mfma_f32_16x16x32_bf16 a[124:127], a[200:203], v[192:195], 0
s_add_u32 s68, s68, s67
s_add_u32 s17, s78, L_T-L_pc+0
ds_read_b128 a[148:151], v2 offset:1024
v_cvt_pk_bf16_f32 v215, v150, v151
v_mfma_f32_16x16x32_bf16 a[124:127], a[204:207], v[196:199], a[124:127]
s_add_u32 s67, s67, s79
buffer_load_dword a252, v16, s[88:91], s17 offen
v_mfma_f32_16x16x32_bf16 a[92:95], a[204:207], v[188:191], 0
v_exp_f32 v118, v118
v_mfma_f32_16x16x32_bf16 a[92:95], a[200:203], v[184:187], a[92:95]
ds_read_b128 a[152:155], v2 offset:2048
v_cvt_pk_bf16_f32 v206, v132, v133
v_mfma_f32_16x16x32_bf16 a[60:63], a[200:203], v[160:163], 0
ds_read_b128 a[156:159], v2 offset:3072
v_cvt_pk_bf16_f32 v207, v134, v135
v_mfma_f32_16x16x32_bf16 a[60:63], a[204:207], v[164:167], a[60:63]
s_mov_b64 exec, 1
buffer_atomic_add a251, v19, s[52:55], s67 offen offset:0 sc1
buffer_atomic_add a251, v19, s[52:55], s68 offen offset:0 sc1
s_mov_b64 exec, -1
v_mfma_f32_16x16x32_bf16 a[28:31], a[204:207], v[156:159], 0
s_add_u32 s17, s78, L_T-L_pc+4096
v_exp_f32 v119, v119
v_mfma_f32_16x16x32_bf16 a[28:31], a[200:203], v[152:155], a[28:31]
ds_read_b128 a[160:163], v2 offset:4096
buffer_load_dword a252, v16, s[88:91], s17 offen
ds_read_b128 a[164:167], v2 offset:5120
ds_read_b128 a[168:171], v2 offset:6144
ds_read_b128 a[172:175], v2 offset:7168
v_mul_u32_u24 v19, 52, v0
v_cvt_pk_bf16_f32 v182, v116, v117
v_cvt_pk_bf16_f32 v183, v118, v119
v_xor_b32 v3, 0x8000, v3
v_accvgpr_read_b32 v20, a128
v_max_f32 v1, v1, v20
v_rcp_f32 v20, v20
v_accvgpr_read_b32 v232, a0
v_accvgpr_read_b32 v233, a1
v_accvgpr_read_b32 v234, a2
v_accvgpr_read_b32 v235, a3
v_accvgpr_read_b32 v236, a4
v_accvgpr_read_b32 v237, a5
v_accvgpr_read_b32 v238, a6
v_accvgpr_read_b32 v239, a7
v_mul_f32 v20, v20, v4
v_mul_f32 v232, v232, v20
v_mul_f32 v233, v233, v20
v_mul_f32 v234, v234, v20
v_mul_f32 v235, v235, v20
v_mul_f32 v236, v236, v20
v_mul_f32 v237, v237, v20
v_mul_f32 v238, v238, v20
v_mul_f32 v239, v239, v20
v_cvt_pk_bf16_f32 v232, v232, v233
v_cvt_pk_bf16_f32 v233, v234, v235
v_cvt_pk_bf16_f32 v234, v236, v237
v_cvt_pk_bf16_f32 v235, v238, v239
s_add_u32 s77, s74, 0
buffer_store_dwordx4 v[232:235], v16, s[44:47], s77 offen sc1
v_accvgpr_read_b32 v240, a8
v_accvgpr_read_b32 v241, a9
v_accvgpr_read_b32 v242, a10
v_accvgpr_read_b32 v243, a11
v_accvgpr_read_b32 v244, a12
v_accvgpr_read_b32 v245, a13
v_accvgpr_read_b32 v246, a14
v_accvgpr_read_b32 v247, a15
v_mul_f32 v240, v240, v20
v_mul_f32 v241, v241, v20
v_mul_f32 v242, v242, v20
v_mul_f32 v243, v243, v20
v_mul_f32 v244, v244, v20
v_mul_f32 v245, v245, v20
v_mul_f32 v246, v246, v20
v_mul_f32 v247, v247, v20
v_cvt_pk_bf16_f32 v240, v240, v241
v_cvt_pk_bf16_f32 v241, v242, v243
v_cvt_pk_bf16_f32 v242, v244, v245
v_cvt_pk_bf16_f32 v243, v246, v247
s_add_u32 s77, s74, 8192
buffer_store_dwordx4 v[240:243], v16, s[44:47], s77 offen sc1
v_accvgpr_read_b32 v232, a16
v_accvgpr_read_b32 v233, a17
v_accvgpr_read_b32 v234, a18
v_accvgpr_read_b32 v235, a19
v_accvgpr_read_b32 v236, a20
v_accvgpr_read_b32 v237, a21
v_accvgpr_read_b32 v238, a22
v_accvgpr_read_b32 v239, a23
v_mul_f32 v232, v232, v20
v_mul_f32 v233, v233, v20
v_mul_f32 v234, v234, v20
v_mul_f32 v235, v235, v20
v_mul_f32 v236, v236, v20
v_mul_f32 v237, v237, v20
v_mul_f32 v238, v238, v20
v_mul_f32 v239, v239, v20
v_cvt_pk_bf16_f32 v232, v232, v233
v_cvt_pk_bf16_f32 v233, v234, v235
v_cvt_pk_bf16_f32 v234, v236, v237
v_cvt_pk_bf16_f32 v235, v238, v239
s_add_u32 s77, s74, 16384
buffer_store_dwordx4 v[232:235], v16, s[44:47], s77 offen sc1
s_branch L_T
L_T1:
buffer_load_dword v19, off, s[52:55], s80 sc1
s_add_u32 s17, s78, L_TAIL-L_pc+0
buffer_load_dword a252, v16, s[88:91], s17 offen
s_add_u32 s17, s78, L_TAIL-L_pc+4096
buffer_load_dword a252, v16, s[88:91], s17 offen
s_waitcnt lgkmcnt(7)
v_mfma_f32_16x16x32_bf16 v[136:139], a[144:147], v[72:75], v[228:231]
s_waitcnt lgkmcnt(6)
ds_read_b128 a[176:179], v2 offset:8192
v_cndmask_b32 v120, v224, v17, s[0:1]
v_mfma_f32_16x16x32_bf16 v[136:139], a[148:151], v[76:79], v[136:139]
s_waitcnt lgkmcnt(6)
ds_read_b128 a[180:183], v2 offset:9216
v_cndmask_b32 v121, v224, v17, s[4:5]
v_cndmask_b32 v122, v224, v17, s[6:7]
v_cndmask_b32 v123, v224, v17, s[8:9]
v_mfma_f32_16x16x32_bf16 v[136:139], a[152:155], v[80:83], v[136:139]
s_waitcnt lgkmcnt(6)
buffer_load_dwordx4 v16, s[32:35], s70 offen offset:2048 sc1 lds
v_mfma_f32_16x16x32_bf16 v[136:139], a[156:159], v[84:87], v[136:139]
ds_read_b128 a[184:187], v2 offset:10240
v_cndmask_b32 v124, v224, v17, s[10:11]
v_mfma_f32_16x16x32_bf16 v[120:123], a[156:159], v[68:71], v[120:123]
ds_read_b128 a[188:191], v2 offset:11264
v_cndmask_b32 v125, v224, v17, s[12:13]
v_mfma_f32_16x16x32_bf16 v[120:123], a[152:155], v[64:67], v[120:123]
ds_read_b128 a[192:195], v2 offset:12288
v_cndmask_b32 v126, v224, v17, s[18:19]
v_mfma_f32_16x16x32_bf16 v[120:123], a[148:151], v[60:63], v[120:123]
ds_read_b128 a[196:199], v2 offset:13312
v_cndmask_b32 v127, v224, v17, s[22:23]
v_mfma_f32_16x16x32_bf16 v[120:123], a[144:147], v[56:59], v[120:123]
s_waitcnt lgkmcnt(4)
ds_read_b128 a[200:203], v2 offset:14336
v_cndmask_b32 v128, v224, v17, s[26:27]
v_mfma_f32_16x16x32_bf16 v[140:143], a[160:163], v[72:75], v[228:231]
ds_read_b128 a[204:207], v2 offset:15360
v_cndmask_b32 v129, v224, v17, s[56:57]
v_mfma_f32_16x16x32_bf16 v[140:143], a[164:167], v[76:79], v[140:143]
ds_read_b128 a[144:147], v3 offset:0
v_cndmask_b32 v130, v224, v17, s[58:59]
v_mfma_f32_16x16x32_bf16 v[140:143], a[168:171], v[80:83], v[140:143]
v_exp_f32 v136, v136
v_mfma_f32_16x16x32_bf16 v[140:143], a[172:175], v[84:87], v[140:143]
v_exp_f32 v137, v137
v_mfma_f32_16x16x32_bf16 v[124:127], a[172:175], v[68:71], v[124:127]
ds_read_b128 a[148:151], v3 offset:8192
v_cndmask_b32 v131, v224, v17, s[60:61]
v_mfma_f32_16x16x32_bf16 v[124:127], a[168:171], v[64:67], v[124:127]
buffer_load_dwordx4 v16, s[32:35], s70 offen offset:3072 sc1 lds
v_mfma_f32_16x16x32_bf16 v[124:127], a[164:167], v[60:63], v[124:127]
v_exp_f32 v138, v138
v_mfma_f32_16x16x32_bf16 v[124:127], a[160:163], v[56:59], v[124:127]
v_exp_f32 v139, v139
v_mfma_f32_16x16x32_bf16 v[128:131], a[176:179], v[56:59], v[128:131]
v_exp_f32 v120, v120
v_mfma_f32_16x16x32_bf16 v[128:131], a[180:183], v[60:63], v[128:131]
s_waitcnt lgkmcnt(1)
v_exp_f32 v121, v121
v_mfma_f32_16x16x32_bf16 v[128:131], a[184:187], v[64:67], v[128:131]
v_exp_f32 v122, v122
v_mfma_f32_16x16x32_bf16 v[128:131], a[188:191], v[68:71], v[128:131]
s_add_u32 m0, s71, 4096
ds_read_b128 a[152:155], v3 offset:1024
v_cndmask_b32 v132, v224, v17, s[62:63]
v_mfma_f32_16x16x32_bf16 v[144:147], a[188:191], v[84:87], v[228:231]
s_add_u32 s64, s70, 4096
v_cvt_pk_bf16_f32 v192, v136, v137
v_cndmask_b32 v133, v224, v17, s[48:49]
v_mfma_f32_16x16x32_bf16 v[144:147], a[184:187], v[80:83], v[144:147]
buffer_load_dwordx4 v16, s[32:35], s64 offen offset:0 sc1 lds
v_mfma_f32_16x16x32_bf16 v[144:147], a[180:183], v[76:79], v[144:147]
ds_read_b128 a[156:159], v3 offset:9216
v_cndmask_b32 v134, v224, v17, s[50:51]
v_mfma_f32_16x16x32_bf16 v[144:147], a[176:179], v[72:75], v[144:147]
ds_read_b128 a[160:163], v3 offset:2048
v_cndmask_b32 v135, v224, v17, s[100:101]
v_mfma_f32_16x16x32_bf16 v[148:151], a[192:195], v[72:75], v[228:231]
v_exp_f32 v123, v123
v_mfma_f32_16x16x32_bf16 v[148:151], a[196:199], v[76:79], v[148:151]
v_cvt_pk_bf16_f32 v193, v138, v139
v_cvt_pk_bf16_f32 v184, v120, v121
v_mfma_f32_16x16x32_bf16 v[148:151], a[200:203], v[80:83], v[148:151]
v_exp_f32 v140, v140
v_mfma_f32_16x16x32_bf16 v[148:151], a[204:207], v[84:87], v[148:151]
v_exp_f32 v141, v141
v_mfma_f32_16x16x32_bf16 v[132:135], a[204:207], v[68:71], v[132:135]
v_exp_f32 v142, v142
v_mfma_f32_16x16x32_bf16 v[132:135], a[200:203], v[64:67], v[132:135]
v_exp_f32 v143, v143
v_mfma_f32_16x16x32_bf16 v[132:135], a[196:199], v[60:63], v[132:135]
v_exp_f32 v124, v124
v_mfma_f32_16x16x32_bf16 v[132:135], a[192:195], v[56:59], v[132:135]
buffer_load_dwordx4 v16, s[32:35], s64 offen offset:1024 sc1 lds
v_mfma_f32_16x16x32_bf16 a[132:135], a[244:247], v[176:179], a[132:135]
v_exp_f32 v125, v125
v_mfma_f32_16x16x32_bf16 a[132:135], a[244:247], v[180:183], a[132:135]
ds_read_b128 a[164:167], v3 offset:10240
v_accvgpr_read_b32 v240, a24
v_mfma_f32_16x16x32_bf16 a[136:139], a[244:247], v[200:203], a[136:139]
ds_read_b128 a[168:171], v3 offset:3072
v_accvgpr_read_b32 v241, a25
v_mfma_f32_16x16x32_bf16 a[136:139], a[244:247], v[204:207], a[136:139]
v_cvt_pk_bf16_f32 v185, v122, v123
v_cvt_pk_bf16_f32 v194, v140, v141
v_mfma_f32_16x16x32_bf16 a[140:143], a[244:247], v[208:211], a[140:143]
ds_read_b128 a[172:175], v3 offset:11264
v_accvgpr_read_b32 v242, a26
v_mfma_f32_16x16x32_bf16 a[140:143], a[244:247], v[212:215], a[140:143]
ds_read_b128 a[176:179], v3 offset:4096
v_accvgpr_read_b32 v243, a27
v_mfma_f32_16x16x32_bf16 a[32:35], a[144:147], v[176:179], a[32:35]
s_waitcnt lgkmcnt(4)
ds_read_b128 a[180:183], v3 offset:12288
v_accvgpr_read_b32 v244, a28
v_mfma_f32_16x16x32_bf16 a[32:35], a[148:151], v[180:183], a[32:35]
ds_read_b128 a[184:187], v3 offset:5120
v_accvgpr_read_b32 v245, a29
v_mfma_f32_16x16x32_bf16 a[64:67], a[148:151], v[204:207], a[64:67]
ds_read_b128 a[188:191], v3 offset:13312
v_accvgpr_read_b32 v246, a30
v_mfma_f32_16x16x32_bf16 a[64:67], a[144:147], v[200:203], a[64:67]
ds_read_b128 a[192:195], v3 offset:6144
v_accvgpr_read_b32 v247, a31
v_mfma_f32_16x16x32_bf16 a[96:99], a[144:147], v[208:211], a[96:99]
ds_read_b128 a[196:199], v3 offset:14336
v_mul_f32 v240, v240, v20
v_mul_f32 v241, v241, v20
v_mul_f32 v242, v242, v20
v_mul_f32 v243, v243, v20
v_mul_f32 v244, v244, v20
v_mul_f32 v245, v245, v20
v_mul_f32 v246, v246, v20
v_mul_f32 v247, v247, v20
v_cvt_pk_bf16_f32 v240, v240, v241
v_cvt_pk_bf16_f32 v241, v242, v243
v_cvt_pk_bf16_f32 v242, v244, v245
v_cvt_pk_bf16_f32 v243, v246, v247
s_add_u32 s77, s74, 24576
buffer_store_dwordx4 v[240:243], v16, s[44:47], s77 offen sc1
v_mfma_f32_16x16x32_bf16 a[96:99], a[148:151], v[212:215], a[96:99]
v_exp_f32 v126, v126
v_mfma_f32_16x16x32_bf16 a[100:103], a[156:159], v[212:215], a[100:103]
buffer_load_dwordx4 v16, s[32:35], s64 offen offset:2048 sc1 lds
v_cvt_pk_bf16_f32 v195, v142, v143
v_mfma_f32_16x16x32_bf16 a[100:103], a[152:155], v[208:211], a[100:103]
v_exp_f32 v127, v127
v_mfma_f32_16x16x32_bf16 a[68:71], a[152:155], v[200:203], a[68:71]
v_exp_f32 v128, v128
v_mfma_f32_16x16x32_bf16 a[68:71], a[156:159], v[204:207], a[68:71]
v_exp_f32 v129, v129
v_mfma_f32_16x16x32_bf16 a[36:39], a[156:159], v[180:183], a[36:39]
v_exp_f32 v130, v130
v_mfma_f32_16x16x32_bf16 a[36:39], a[152:155], v[176:179], a[36:39]
v_cvt_pk_bf16_f32 v186, v124, v125
v_cvt_pk_bf16_f32 v187, v126, v127
v_mfma_f32_16x16x32_bf16 a[40:43], a[160:163], v[176:179], a[40:43]
s_waitcnt lgkmcnt(0)
v_exp_f32 v131, v131
v_mfma_f32_16x16x32_bf16 a[40:43], a[164:167], v[180:183], a[40:43]
buffer_load_dwordx4 v16, s[32:35], s64 offen offset:3072 sc1 lds
v_mfma_f32_16x16x32_bf16 a[72:75], a[164:167], v[204:207], a[72:75]
v_exp_f32 v144, v144
v_mfma_f32_16x16x32_bf16 a[72:75], a[160:163], v[200:203], a[72:75]
v_exp_f32 v145, v145
v_mfma_f32_16x16x32_bf16 a[104:107], a[160:163], v[208:211], a[104:107]
v_exp_f32 v146, v146
v_mfma_f32_16x16x32_bf16 a[104:107], a[164:167], v[212:215], a[104:107]
ds_read_b128 a[200:203], v3 offset:7168
v_cvt_pk_bf16_f32 v188, v128, v129
v_mfma_f32_16x16x32_bf16 a[108:111], a[172:175], v[212:215], a[108:111]
ds_read_b128 a[204:207], v3 offset:15360
v_cvt_pk_bf16_f32 v189, v130, v131
v_mfma_f32_16x16x32_bf16 a[108:111], a[168:171], v[208:211], a[108:111]
v_exp_f32 v147, v147
v_mfma_f32_16x16x32_bf16 a[76:79], a[168:171], v[200:203], a[76:79]
v_exp_f32 v148, v148
v_mfma_f32_16x16x32_bf16 a[76:79], a[172:175], v[204:207], a[76:79]
v_exp_f32 v149, v149
v_mfma_f32_16x16x32_bf16 a[44:47], a[172:175], v[180:183], a[44:47]
v_exp_f32 v150, v150
v_mfma_f32_16x16x32_bf16 a[44:47], a[168:171], v[176:179], a[44:47]
v_exp_f32 v151, v151
v_mfma_f32_16x16x32_bf16 a[48:51], a[176:179], v[176:179], a[48:51]
v_exp_f32 v132, v132
v_mfma_f32_16x16x32_bf16 a[48:51], a[180:183], v[180:183], a[48:51]
s_waitcnt vmcnt(12)
s_barrier
v_mfma_f32_16x16x32_bf16 a[80:83], a[180:183], v[204:207], a[80:83]
v_exp_f32 v133, v133
v_mfma_f32_16x16x32_bf16 a[80:83], a[176:179], v[200:203], a[80:83]
ds_read_b128 a[144:147], v2 offset:16384
v_cvt_pk_bf16_f32 v196, v144, v145
v_mfma_f32_16x16x32_bf16 a[112:115], a[176:179], v[208:211], a[112:115]
v_exp_f32 v134, v134
v_mfma_f32_16x16x32_bf16 a[112:115], a[180:183], v[212:215], a[112:115]
ds_read_b128 a[148:151], v2 offset:17408
v_cvt_pk_bf16_f32 v197, v146, v147
v_mfma_f32_16x16x32_bf16 a[116:119], a[188:191], v[212:215], a[116:119]
ds_read_b128 a[152:155], v2 offset:18432
v_cvt_pk_bf16_f32 v198, v148, v149
v_mfma_f32_16x16x32_bf16 a[116:119], a[184:187], v[208:211], a[116:119]
ds_read_b128 a[156:159], v2 offset:19456
v_cvt_pk_bf16_f32 v199, v150, v151
v_mfma_f32_16x16x32_bf16 a[84:87], a[184:187], v[200:203], a[84:87]
s_waitcnt vmcnt(9)
v_readfirstlane_b32 vcc_lo, v19
s_nop 0
s_cmp_lt_u32 vcc_lo, 32
s_cbranch_scc1 L_spin_1012
L_spinbk_1013:
v_mfma_f32_16x16x32_bf16 a[84:87], a[188:191], v[204:207], a[84:87]
ds_read_b128 a[160:163], v2 offset:20480
v_cndmask_b32 v136, v228, v17, s[0:1]
v_mfma_f32_16x16x32_bf16 a[52:55], a[188:191], v[180:183], a[52:55]
ds_read_b128 a[164:167], v2 offset:21504
v_cndmask_b32 v137, v228, v17, s[4:5]
v_mfma_f32_16x16x32_bf16 a[52:55], a[184:187], v[176:179], a[52:55]
ds_read_b128 a[168:171], v2 offset:22528
v_cndmask_b32 v138, v228, v17, s[6:7]
v_mfma_f32_16x16x32_bf16 a[56:59], a[192:195], v[176:179], a[56:59]
ds_read_b128 a[172:175], v2 offset:23552
v_cndmask_b32 v139, v228, v17, s[8:9]
v_mfma_f32_16x16x32_bf16 a[56:59], a[196:199], v[180:183], a[56:59]
v_exp_f32 v135, v135
v_mfma_f32_16x16x32_bf16 a[88:91], a[196:199], v[204:207], a[88:91]
v_cndmask_b32 v140, v228, v17, s[10:11]
v_cvt_pk_bf16_f32 v190, v132, v133
v_mfma_f32_16x16x32_bf16 a[88:91], a[192:195], v[200:203], a[88:91]
v_cndmask_b32 v141, v228, v17, s[12:13]
v_cvt_pk_bf16_f32 v191, v134, v135
v_mfma_f32_16x16x32_bf16 a[120:123], a[192:195], v[208:211], a[120:123]
v_cndmask_b32 v142, v228, v17, s[18:19]
v_cndmask_b32 v143, v228, v17, s[22:23]
v_mfma_f32_16x16x32_bf16 a[120:123], a[196:199], v[212:215], a[120:123]
s_waitcnt lgkmcnt(1)
v_cndmask_b32 v144, v228, v17, s[26:27]
v_cndmask_b32 v145, v228, v17, s[56:57]
v_mfma_f32_16x16x32_bf16 a[124:127], a[204:207], v[212:215], a[124:127]
v_cndmask_b32 v146, v228, v17, s[58:59]
v_cndmask_b32 v147, v228, v17, s[60:61]
v_mfma_f32_16x16x32_bf16 a[124:127], a[200:203], v[208:211], a[124:127]
v_cndmask_b32 v148, v228, v17, s[62:63]
v_cndmask_b32 v149, v228, v17, s[48:49]
v_mfma_f32_16x16x32_bf16 a[92:95], a[200:203], v[200:203], a[92:95]
v_cndmask_b32 v150, v228, v17, s[50:51]
v_cndmask_b32 v151, v228, v17, s[100:101]
v_mfma_f32_16x16x32_bf16 a[92:95], a[204:207], v[204:207], a[92:95]
v_accvgpr_read_b32 v21, a132
v_max_f32 v1, v1, v21
v_mfma_f32_16x16x32_bf16 a[60:63], a[204:207], v[180:183], a[60:63]
v_rcp_f32 v21, v21
v_mfma_f32_16x16x32_bf16 a[60:63], a[200:203], v[176:179], a[60:63]
v_accvgpr_read_b32 v232, a32
v_accvgpr_read_b32 v233, a33
v_mfma_f32_16x16x32_bf16 v[136:139], a[144:147], v[72:75], v[136:139]
ds_read_b128 a[176:179], v2 offset:24576
v_accvgpr_read_b32 v234, a34
v_mfma_f32_16x16x32_bf16 v[136:139], a[148:151], v[76:79], v[136:139]
ds_read_b128 a[180:183], v2 offset:25600
v_accvgpr_read_b32 v235, a35
v_mfma_f32_16x16x32_bf16 v[136:139], a[152:155], v[80:83], v[136:139]
ds_read_b128 a[184:187], v2 offset:26624
v_accvgpr_read_b32 v236, a36
v_mfma_f32_16x16x32_bf16 v[136:139], a[156:159], v[84:87], v[136:139]
s_waitcnt lgkmcnt(3)
ds_read_b128 a[188:191], v2 offset:27648
v_accvgpr_read_b32 v237, a37
v_mfma_f32_16x16x32_bf16 v[140:143], a[172:175], v[84:87], v[140:143]
ds_read_b128 a[192:195], v2 offset:28672
ds_read_b128 a[196:199], v2 offset:29696
ds_read_b128 a[200:203], v2 offset:30720
ds_read_b128 a[204:207], v2 offset:31744
v_mfma_f32_16x16x32_bf16 v[140:143], a[168:171], v[80:83], v[140:143]
ds_read_b128 a[144:147], v3 offset:16384
v_accvgpr_read_b32 v238, a38
v_mfma_f32_16x16x32_bf16 v[140:143], a[164:167], v[76:79], v[140:143]
ds_read_b128 a[148:151], v3 offset:24576
v_accvgpr_read_b32 v239, a39
v_mfma_f32_16x16x32_bf16 v[140:143], a[160:163], v[72:75], v[140:143]
s_waitcnt lgkmcnt(8)
ds_read_b128 a[152:155], v3 offset:17408
v_mul_f32 v21, v21, v6
v_mfma_f32_16x16x32_bf16 v[144:147], a[176:179], v[72:75], v[144:147]
ds_read_b128 a[156:159], v3 offset:25600
v_mul_f32 v232, v232, v21
v_mfma_f32_16x16x32_bf16 v[144:147], a[180:183], v[76:79], v[144:147]
s_waitcnt lgkmcnt(8)
ds_read_b128 a[160:163], v3 offset:18432
v_mul_f32 v233, v233, v21
v_mfma_f32_16x16x32_bf16 v[144:147], a[184:187], v[80:83], v[144:147]
ds_read_b128 a[164:167], v3 offset:26624
v_mul_f32 v234, v234, v21
v_mul_f32 v235, v235, v21
v_mul_f32 v236, v236, v21
v_mul_f32 v237, v237, v21
v_mul_f32 v238, v238, v21
v_mul_f32 v239, v239, v21
v_cvt_pk_bf16_f32 v232, v232, v233
v_cvt_pk_bf16_f32 v233, v234, v235
v_cvt_pk_bf16_f32 v234, v236, v237
v_cvt_pk_bf16_f32 v235, v238, v239
s_add_u32 s77, s74, 4096
buffer_store_dwordx4 v[232:235], v16, s[44:47], s77 offen sc1
v_accvgpr_read_b32 v240, a40
v_accvgpr_read_b32 v241, a41
v_accvgpr_read_b32 v242, a42
v_accvgpr_read_b32 v243, a43
v_accvgpr_read_b32 v244, a44
v_accvgpr_read_b32 v245, a45
v_accvgpr_read_b32 v246, a46
v_accvgpr_read_b32 v247, a47
v_mul_f32 v240, v240, v21
v_mul_f32 v241, v241, v21
v_mul_f32 v242, v242, v21
v_mul_f32 v243, v243, v21
v_mul_f32 v244, v244, v21
v_mul_f32 v245, v245, v21
v_mul_f32 v246, v246, v21
v_mul_f32 v247, v247, v21
v_cvt_pk_bf16_f32 v240, v240, v241
v_cvt_pk_bf16_f32 v241, v242, v243
v_cvt_pk_bf16_f32 v242, v244, v245
v_cvt_pk_bf16_f32 v243, v246, v247
s_add_u32 s77, s74, 12288
buffer_store_dwordx4 v[240:243], v16, s[44:47], s77 offen sc1
v_accvgpr_read_b32 v232, a48
v_accvgpr_read_b32 v233, a49
v_accvgpr_read_b32 v234, a50
v_accvgpr_read_b32 v235, a51
v_accvgpr_read_b32 v236, a52
v_accvgpr_read_b32 v237, a53
v_accvgpr_read_b32 v238, a54
v_accvgpr_read_b32 v239, a55
v_mul_f32 v232, v232, v21
v_mul_f32 v233, v233, v21
v_mul_f32 v234, v234, v21
v_mul_f32 v235, v235, v21
v_mul_f32 v236, v236, v21
v_mul_f32 v237, v237, v21
v_mul_f32 v238, v238, v21
v_mul_f32 v239, v239, v21
v_cvt_pk_bf16_f32 v232, v232, v233
v_cvt_pk_bf16_f32 v233, v234, v235
v_cvt_pk_bf16_f32 v234, v236, v237
v_cvt_pk_bf16_f32 v235, v238, v239
s_add_u32 s77, s74, 20480
buffer_store_dwordx4 v[232:235], v16, s[44:47], s77 offen sc1
v_accvgpr_read_b32 v240, a56
v_accvgpr_read_b32 v241, a57
v_accvgpr_read_b32 v242, a58
v_accvgpr_read_b32 v243, a59
v_accvgpr_read_b32 v244, a60
v_accvgpr_read_b32 v245, a61
v_accvgpr_read_b32 v246, a62
v_accvgpr_read_b32 v247, a63
v_mul_f32 v240, v240, v21
v_mul_f32 v241, v241, v21
v_mul_f32 v242, v242, v21
v_mul_f32 v243, v243, v21
v_mul_f32 v244, v244, v21
v_mul_f32 v245, v245, v21
v_mul_f32 v246, v246, v21
v_mul_f32 v247, v247, v21
v_cvt_pk_bf16_f32 v240, v240, v241
v_cvt_pk_bf16_f32 v241, v242, v243
v_cvt_pk_bf16_f32 v242, v244, v245
v_cvt_pk_bf16_f32 v243, v246, v247
s_add_u32 s77, s74, 28672
buffer_store_dwordx4 v[240:243], v16, s[44:47], s77 offen sc1
v_exp_f32 v136, v136
v_mfma_f32_16x16x32_bf16 v[144:147], a[188:191], v[84:87], v[144:147]
s_waitcnt lgkmcnt(5)
v_exp_f32 v137, v137
v_mfma_f32_16x16x32_bf16 v[148:151], a[204:207], v[84:87], v[148:151]
v_exp_f32 v138, v138
v_mfma_f32_16x16x32_bf16 v[148:151], a[200:203], v[80:83], v[148:151]
s_add_u32 s65, s84, 0
v_exp_f32 v139, v139
v_mfma_f32_16x16x32_bf16 v[148:151], a[196:199], v[76:79], v[148:151]
buffer_load_dwordx4 a[208:211], v14, s[44:47], s65 offen offset:0 sc1
v_mfma_f32_16x16x32_bf16 v[148:151], a[192:195], v[72:75], v[148:151]
v_exp_f32 v140, v140
v_mfma_f32_16x16x32_bf16 a[136:139], a[244:247], v[184:187], a[136:139]
buffer_load_dwordx4 a[216:219], v14, s[44:47], s65 offen offset:1024 sc1
v_mfma_f32_16x16x32_bf16 a[136:139], a[244:247], v[188:191], a[136:139]
v_exp_f32 v141, v141
v_mfma_f32_16x16x32_bf16 a[140:143], a[244:247], v[192:195], a[140:143]
ds_read_b128 a[168:171], v3 offset:19456
v_cvt_pk_bf16_f32 v208, v136, v137
v_mfma_f32_16x16x32_bf16 a[140:143], a[244:247], v[196:199], a[140:143]
buffer_load_dwordx4 a[224:227], v15, s[44:47], s65 offen offset:0 sc1
v_mfma_f32_16x16x32_bf16 a[64:67], a[144:147], v[184:187], a[64:67]
s_waitcnt lgkmcnt(1)
ds_read_b128 a[172:175], v3 offset:27648
v_cvt_pk_bf16_f32 v209, v138, v139
v_mfma_f32_16x16x32_bf16 a[64:67], a[148:151], v[188:191], a[64:67]
v_exp_f32 v142, v142
v_mfma_f32_16x16x32_bf16 a[96:99], a[148:151], v[196:199], a[96:99]
buffer_load_dwordx4 a[232:235], v15, s[44:47], s65 offen offset:1024 sc1
v_mfma_f32_16x16x32_bf16 a[96:99], a[144:147], v[192:195], a[96:99]
s_add_u32 s65, s84, 8192
ds_read_b128 a[176:179], v3 offset:20480
v_cvt_pk_bf16_f32 v210, v140, v141
v_mfma_f32_16x16x32_bf16 a[100:103], a[152:155], v[192:195], a[100:103]
buffer_load_dwordx4 a[212:215], v14, s[44:47], s65 offen offset:0 sc1
v_mfma_f32_16x16x32_bf16 a[100:103], a[156:159], v[196:199], a[100:103]
v_exp_f32 v143, v143
v_mfma_f32_16x16x32_bf16 a[68:71], a[156:159], v[188:191], a[68:71]
ds_read_b128 a[180:183], v3 offset:28672
v_xor_b32 v2, 0x8000, v2
v_mfma_f32_16x16x32_bf16 a[68:71], a[152:155], v[184:187], a[68:71]
buffer_load_dwordx4 a[220:223], v14, s[44:47], s65 offen offset:1024 sc1
v_mfma_f32_16x16x32_bf16 a[72:75], a[160:163], v[184:187], a[72:75]
v_exp_f32 v144, v144
v_mfma_f32_16x16x32_bf16 a[72:75], a[164:167], v[188:191], a[72:75]
ds_read_b128 a[184:187], v3 offset:21504
v_cvt_pk_bf16_f32 v211, v142, v143
v_mfma_f32_16x16x32_bf16 a[104:107], a[164:167], v[196:199], a[104:107]
buffer_load_dwordx4 a[228:231], v15, s[44:47], s65 offen offset:0 sc1
v_mfma_f32_16x16x32_bf16 a[104:107], a[160:163], v[192:195], a[104:107]
s_waitcnt lgkmcnt(2)
ds_read_b128 a[188:191], v3 offset:29696
v_accvgpr_read_b32 v22, a136
v_mfma_f32_16x16x32_bf16 a[108:111], a[168:171], v[192:195], a[108:111]
v_exp_f32 v145, v145
v_mfma_f32_16x16x32_bf16 a[108:111], a[172:175], v[196:199], a[108:111]
buffer_load_dwordx4 a[236:239], v15, s[44:47], s65 offen offset:1024 sc1
v_mfma_f32_16x16x32_bf16 a[76:79], a[172:175], v[188:191], a[76:79]
v_exp_f32 v146, v146
v_mfma_f32_16x16x32_bf16 a[76:79], a[168:171], v[184:187], a[76:79]
s_add_u32 s65, s84, 32768
ds_read_b128 a[192:195], v3 offset:22528
v_cvt_pk_bf16_f32 v212, v144, v145
v_mfma_f32_16x16x32_bf16 a[80:83], a[176:179], v[184:187], a[80:83]
s_waitcnt lgkmcnt(2)
buffer_load_dwordx4 v[152:155], v14, s[44:47], s65 offen offset:0 sc1
v_mfma_f32_16x16x32_bf16 a[80:83], a[180:183], v[188:191], a[80:83]
ds_read_b128 a[196:199], v3 offset:30720
ds_read_b128 a[200:203], v3 offset:23552
ds_read_b128 a[204:207], v3 offset:31744
v_mfma_f32_16x16x32_bf16 a[112:115], a[180:183], v[196:199], a[112:115]
s_waitcnt vmcnt(13)
s_barrier
v_xor_b32 v3, 0x8000, v3
v_mfma_f32_16x16x32_bf16 a[112:115], a[176:179], v[192:195], a[112:115]
buffer_load_dwordx4 v[160:163], v14, s[44:47], s65 offen offset:1024 sc1
v_exp_f32 v147, v147
v_mfma_f32_16x16x32_bf16 a[116:119], a[184:187], v[192:195], a[116:119]
s_waitcnt lgkmcnt(4)
v_exp_f32 v148, v148
v_mfma_f32_16x16x32_bf16 a[116:119], a[188:191], v[196:199], a[116:119]
buffer_load_dwordx4 v[168:171], v15, s[44:47], s65 offen offset:0 sc1
v_mfma_f32_16x16x32_bf16 a[84:87], a[188:191], v[188:191], a[84:87]
v_exp_f32 v149, v149
v_mfma_f32_16x16x32_bf16 a[84:87], a[184:187], v[184:187], a[84:87]
s_waitcnt lgkmcnt(0)
buffer_load_dwordx4 v[176:179], v15, s[44:47], s65 offen offset:1024 sc1
v_mfma_f32_16x16x32_bf16 a[88:91], a[192:195], v[184:187], a[88:91]
s_add_u32 s65, s84, 40960
ds_read_b128 a[144:147], v3 offset:0
v_cvt_pk_bf16_f32 v213, v146, v147
v_mfma_f32_16x16x32_bf16 a[88:91], a[196:199], v[188:191], a[88:91]
buffer_load_dwordx4 v[156:159], v14, s[44:47], s65 offen offset:0 sc1
v_mfma_f32_16x16x32_bf16 a[120:123], a[196:199], v[196:199], a[120:123]
v_exp_f32 v150, v150
v_mfma_f32_16x16x32_bf16 a[120:123], a[192:195], v[192:195], a[120:123]
buffer_load_dwordx4 v[164:167], v14, s[44:47], s65 offen offset:1024 sc1
ds_read_b128 a[148:151], v3 offset:8192
v_mfma_f32_16x16x32_bf16 a[124:127], a[200:203], v[192:195], a[124:127]
ds_read_b128 a[152:155], v3 offset:1024
v_cvt_pk_bf16_f32 v214, v148, v149
v_mfma_f32_16x16x32_bf16 a[124:127], a[204:207], v[196:199], a[124:127]
buffer_load_dwordx4 v[172:175], v15, s[44:47], s65 offen offset:0 sc1
ds_read_b128 a[156:159], v3 offset:9216
v_mfma_f32_16x16x32_bf16 a[92:95], a[204:207], v[188:191], a[92:95]
v_exp_f32 v151, v151
v_mfma_f32_16x16x32_bf16 a[92:95], a[200:203], v[184:187], a[92:95]
buffer_load_dwordx4 v[180:183], v15, s[44:47], s65 offen offset:1024 sc1
ds_read_b128 a[160:163], v3 offset:2048
ds_read_b128 a[164:167], v3 offset:10240
ds_read_b128 a[168:171], v3 offset:3072
ds_read_b128 a[172:175], v3 offset:11264
v_cvt_pk_bf16_f32 v215, v150, v151
v_max_f32 v1, v1, v22
v_rcp_f32 v22, v22
v_accvgpr_read_b32 v232, a64
v_accvgpr_read_b32 v233, a65
v_accvgpr_read_b32 v234, a66
v_accvgpr_read_b32 v235, a67
v_accvgpr_read_b32 v236, a68
v_accvgpr_read_b32 v237, a69
v_accvgpr_read_b32 v238, a70
v_accvgpr_read_b32 v239, a71
v_mul_f32 v22, v22, v8
v_mul_f32 v232, v232, v22
v_mul_f32 v233, v233, v22
v_mul_f32 v234, v234, v22
v_mul_f32 v235, v235, v22
v_mul_f32 v236, v236, v22
v_mul_f32 v237, v237, v22
v_mul_f32 v238, v238, v22
v_mul_f32 v239, v239, v22
v_cvt_pk_bf16_f32 v232, v232, v233
v_cvt_pk_bf16_f32 v233, v234, v235
v_cvt_pk_bf16_f32 v234, v236, v237
v_cvt_pk_bf16_f32 v235, v238, v239
s_add_u32 s77, s75, 0
buffer_store_dwordx4 v[232:235], v16, s[44:47], s77 offen sc1
s_branch L_TAIL
L_fallback_11:
s_waitcnt vmcnt(0) lgkmcnt(0)
s_barrier
s_mov_b32 s73, 1
s_mov_b32 s81, 0
v_and_b32 v232, 15, v0
v_lshrrev_b32 v233, 4, v0
v_lshlrev_b32 v233, 2, v233
v_sub_u32 v232, v232, v233
s_lshl_b32 s66, s30, 4
v_add_u32 v232, s66, v232
s_lshl_b32 s66, s16, 7
v_add_u32 v234, s66, v232
s_lshl_b32 s66, s3, 7
v_add_u32 v232, s66, v232
v_add_u32 v233, 64, v232
v_add_u32 v235, 64, v234
s_mov_b32 m0, s76
s_lshl_b32 s64, s30, 14
s_nop 0
buffer_load_dwordx4 v16, s[32:35], s64 offen offset:0 sc1 lds
s_nop 0
buffer_load_dwordx4 v16, s[32:35], s64 offen offset:1024 sc1 lds
s_nop 0
buffer_load_dwordx4 v16, s[32:35], s64 offen offset:2048 sc1 lds
s_nop 0
buffer_load_dwordx4 v16, s[32:35], s64 offen offset:3072 sc1 lds
s_add_u32 m0, s76, 4096
s_add_u32 s64, s64, 4096
s_nop 0
buffer_load_dwordx4 v16, s[32:35], s64 offen offset:0 sc1 lds
s_nop 0
buffer_load_dwordx4 v16, s[32:35], s64 offen offset:1024 sc1 lds
s_nop 0
buffer_load_dwordx4 v16, s[32:35], s64 offen offset:2048 sc1 lds
s_nop 0
buffer_load_dwordx4 v16, s[32:35], s64 offen offset:3072 sc1 lds
s_lshr_b32 s64, s76, 1
s_add_u32 m0, s64, 81920
s_and_b32 s71, s64, 8192
s_add_u32 s64, s64, s71
s_add_u32 s64, s64, 8192
s_nop 0
buffer_load_dwordx4 v16, s[32:35], s64 offen offset:0 sc1 lds
s_nop 0
buffer_load_dwordx4 v16, s[32:35], s64 offen offset:1024 sc1 lds
s_nop 0
buffer_load_dwordx4 v16, s[32:35], s64 offen offset:2048 sc1 lds
s_nop 0
buffer_load_dwordx4 v16, s[32:35], s64 offen offset:3072 sc1 lds
v_mov_b32 v20, 0xff800000
v_mov_b32 v21, 0xff800000
v_mov_b32 v22, 0xff800000
v_mov_b32 v23, 0xff800000
L_fbl_1015:
buffer_load_dwordx4 a[144:147], v16, s[32:35], s81 offen offset:0 sc1
buffer_load_dwordx4 a[148:151], v16, s[32:35], s81 offen offset:1024 sc1
buffer_load_dwordx4 a[152:155], v16, s[32:35], s81 offen offset:2048 sc1
buffer_load_dwordx4 a[156:159], v16, s[32:35], s81 offen offset:3072 sc1
s_add_u32 s64, s81, 4096
buffer_load_dwordx4 a[160:163], v16, s[32:35], s64 offen offset:0 sc1
buffer_load_dwordx4 a[164:167], v16, s[32:35], s64 offen offset:1024 sc1
buffer_load_dwordx4 a[168:171], v16, s[32:35], s64 offen offset:2048 sc1
buffer_load_dwordx4 a[172:175], v16, s[32:35], s64 offen offset:3072 sc1
v_subrev_u32 v88, 0, v232
v_ashrrev_i32 v88, 31, v88
v_and_b32 v88, 0xff800000, v88
v_subrev_u32 v89, 1, v232
v_ashrrev_i32 v89, 31, v89
v_and_b32 v89, 0xff800000, v89
v_subrev_u32 v90, 2, v232
v_ashrrev_i32 v90, 31, v90
v_and_b32 v90, 0xff800000, v90
v_subrev_u32 v91, 3, v232
v_ashrrev_i32 v91, 31, v91
v_and_b32 v91, 0xff800000, v91
v_subrev_u32 v92, 16, v232
v_ashrrev_i32 v92, 31, v92
v_and_b32 v92, 0xff800000, v92
v_subrev_u32 v93, 17, v232
v_ashrrev_i32 v93, 31, v93
v_and_b32 v93, 0xff800000, v93
v_subrev_u32 v94, 18, v232
v_ashrrev_i32 v94, 31, v94
v_and_b32 v94, 0xff800000, v94
v_subrev_u32 v95, 19, v232
v_ashrrev_i32 v95, 31, v95
v_and_b32 v95, 0xff800000, v95
v_subrev_u32 v232, 32, v232
v_subrev_u32 v104, 0, v233
v_ashrrev_i32 v104, 31, v104
v_and_b32 v104, 0xff800000, v104
v_subrev_u32 v105, 1, v233
v_ashrrev_i32 v105, 31, v105
v_and_b32 v105, 0xff800000, v105
v_subrev_u32 v106, 2, v233
v_ashrrev_i32 v106, 31, v106
v_and_b32 v106, 0xff800000, v106
v_subrev_u32 v107, 3, v233
v_ashrrev_i32 v107, 31, v107
v_and_b32 v107, 0xff800000, v107
v_subrev_u32 v108, 16, v233
v_ashrrev_i32 v108, 31, v108
v_and_b32 v108, 0xff800000, v108
v_subrev_u32 v109, 17, v233
v_ashrrev_i32 v109, 31, v109
v_and_b32 v109, 0xff800000, v109
v_subrev_u32 v110, 18, v233
v_ashrrev_i32 v110, 31, v110
v_and_b32 v110, 0xff800000, v110
v_subrev_u32 v111, 19, v233
v_ashrrev_i32 v111, 31, v111
v_and_b32 v111, 0xff800000, v111
v_subrev_u32 v233, 32, v233
v_subrev_u32 v120, 0, v234
v_ashrrev_i32 v120, 31, v120
v_and_b32 v120, 0xff800000, v120
v_subrev_u32 v121, 1, v234
v_ashrrev_i32 v121, 31, v121
v_and_b32 v121, 0xff800000, v121
v_subrev_u32 v122, 2, v234
v_ashrrev_i32 v122, 31, v122
v_and_b32 v122, 0xff800000, v122
v_subrev_u32 v123, 3, v234
v_ashrrev_i32 v123, 31, v123
v_and_b32 v123, 0xff800000, v123
v_subrev_u32 v124, 16, v234
v_ashrrev_i32 v124, 31, v124
v_and_b32 v124, 0xff800000, v124
v_subrev_u32 v125, 17, v234
v_ashrrev_i32 v125, 31, v125
v_and_b32 v125, 0xff800000, v125
v_subrev_u32 v126, 18, v234
v_ashrrev_i32 v126, 31, v126
v_and_b32 v126, 0xff800000, v126
v_subrev_u32 v127, 19, v234
v_ashrrev_i32 v127, 31, v127
v_and_b32 v127, 0xff800000, v127
v_subrev_u32 v234, 32, v234
v_subrev_u32 v136, 0, v235
v_ashrrev_i32 v136, 31, v136
v_and_b32 v136, 0xff800000, v136
v_subrev_u32 v137, 1, v235
v_ashrrev_i32 v137, 31, v137
v_and_b32 v137, 0xff800000, v137
v_subrev_u32 v138, 2, v235
v_ashrrev_i32 v138, 31, v138
v_and_b32 v138, 0xff800000, v138
v_subrev_u32 v139, 3, v235
v_ashrrev_i32 v139, 31, v139
v_and_b32 v139, 0xff800000, v139
v_subrev_u32 v140, 16, v235
v_ashrrev_i32 v140, 31, v140
v_and_b32 v140, 0xff800000, v140
v_subrev_u32 v141, 17, v235
v_ashrrev_i32 v141, 31, v141
v_and_b32 v141, 0xff800000, v141
v_subrev_u32 v142, 18, v235
v_ashrrev_i32 v142, 31, v142
v_and_b32 v142, 0xff800000, v142
v_subrev_u32 v143, 19, v235
v_ashrrev_i32 v143, 31, v143
v_and_b32 v143, 0xff800000, v143
v_subrev_u32 v235, 32, v235
s_waitcnt vmcnt(0)
v_mfma_f32_16x16x32_bf16 v[88:91], a[144:147], v[24:27], v[88:91]
v_mfma_f32_16x16x32_bf16 v[104:107], a[144:147], v[40:43], v[104:107]
v_mfma_f32_16x16x32_bf16 v[120:123], a[144:147], v[56:59], v[120:123]
v_mfma_f32_16x16x32_bf16 v[136:139], a[144:147], v[72:75], v[136:139]
v_mfma_f32_16x16x32_bf16 v[88:91], a[148:151], v[28:31], v[88:91]
v_mfma_f32_16x16x32_bf16 v[104:107], a[148:151], v[44:47], v[104:107]
v_mfma_f32_16x16x32_bf16 v[120:123], a[148:151], v[60:63], v[120:123]
v_mfma_f32_16x16x32_bf16 v[136:139], a[148:151], v[76:79], v[136:139]
v_mfma_f32_16x16x32_bf16 v[88:91], a[152:155], v[32:35], v[88:91]
v_mfma_f32_16x16x32_bf16 v[104:107], a[152:155], v[48:51], v[104:107]
v_mfma_f32_16x16x32_bf16 v[120:123], a[152:155], v[64:67], v[120:123]
v_mfma_f32_16x16x32_bf16 v[136:139], a[152:155], v[80:83], v[136:139]
v_mfma_f32_16x16x32_bf16 v[88:91], a[156:159], v[36:39], v[88:91]
v_mfma_f32_16x16x32_bf16 v[104:107], a[156:159], v[52:55], v[104:107]
v_mfma_f32_16x16x32_bf16 v[120:123], a[156:159], v[68:71], v[120:123]
v_mfma_f32_16x16x32_bf16 v[136:139], a[156:159], v[84:87], v[136:139]
v_mfma_f32_16x16x32_bf16 v[92:95], a[160:163], v[24:27], v[92:95]
v_mfma_f32_16x16x32_bf16 v[108:111], a[160:163], v[40:43], v[108:111]
v_mfma_f32_16x16x32_bf16 v[124:127], a[160:163], v[56:59], v[124:127]
v_mfma_f32_16x16x32_bf16 v[140:143], a[160:163], v[72:75], v[140:143]
v_mfma_f32_16x16x32_bf16 v[92:95], a[164:167], v[28:31], v[92:95]
v_mfma_f32_16x16x32_bf16 v[108:111], a[164:167], v[44:47], v[108:111]
v_mfma_f32_16x16x32_bf16 v[124:127], a[164:167], v[60:63], v[124:127]
v_mfma_f32_16x16x32_bf16 v[140:143], a[164:167], v[76:79], v[140:143]
v_mfma_f32_16x16x32_bf16 v[92:95], a[168:171], v[32:35], v[92:95]
v_mfma_f32_16x16x32_bf16 v[108:111], a[168:171], v[48:51], v[108:111]
v_mfma_f32_16x16x32_bf16 v[124:127], a[168:171], v[64:67], v[124:127]
v_mfma_f32_16x16x32_bf16 v[140:143], a[168:171], v[80:83], v[140:143]
v_mfma_f32_16x16x32_bf16 v[92:95], a[172:175], v[36:39], v[92:95]
v_mfma_f32_16x16x32_bf16 v[108:111], a[172:175], v[52:55], v[108:111]
v_mfma_f32_16x16x32_bf16 v[124:127], a[172:175], v[68:71], v[124:127]
v_mfma_f32_16x16x32_bf16 v[140:143], a[172:175], v[84:87], v[140:143]
s_nop 7
v_max3_f32 v20, v20, v88, v89
v_max3_f32 v20, v20, v90, v91
v_max3_f32 v20, v20, v92, v93
v_max3_f32 v20, v20, v94, v95
v_max3_f32 v21, v21, v104, v105
v_max3_f32 v21, v21, v106, v107
v_max3_f32 v21, v21, v108, v109
v_max3_f32 v21, v21, v110, v111
v_max3_f32 v22, v22, v120, v121
v_max3_f32 v22, v22, v122, v123
v_max3_f32 v22, v22, v124, v125
v_max3_f32 v22, v22, v126, v127
v_max3_f32 v23, v23, v136, v137
v_max3_f32 v23, v23, v138, v139
v_max3_f32 v23, v23, v140, v141
v_max3_f32 v23, v23, v142, v143
s_add_u32 s81, s81, 16384
s_cmp_lt_u32 s81, s34
s_cbranch_scc1 L_fbl_1015
v_mov_b32 v248, v20
v_mov_b32 v249, v21
v_mov_b32 v250, v22
v_mov_b32 v251, v23
v_permlane16_swap_b32 v248, v20
v_permlane16_swap_b32 v249, v21
v_permlane16_swap_b32 v250, v22
v_permlane16_swap_b32 v251, v23
v_max_f32 v20, v20, v248
v_max_f32 v21, v21, v249
v_max_f32 v22, v22, v250
v_max_f32 v23, v23, v251
v_mov_b32 v248, v20
v_mov_b32 v249, v21
v_mov_b32 v250, v22
v_mov_b32 v251, v23
v_permlane32_swap_b32 v248, v20
v_permlane32_swap_b32 v249, v21
v_permlane32_swap_b32 v250, v22
v_permlane32_swap_b32 v251, v23
v_max_f32 v20, v20, v248
v_max_f32 v21, v21, v249
v_max_f32 v22, v22, v250
v_max_f32 v23, v23, v251
v_mov_b32 v252, v20
v_mov_b32 v253, v21
v_mov_b32 v254, v22
v_mov_b32 v255, v23
s_and_b32 s70, s30, 1
s_lshr_b32 s67, s30, 1
s_lshl3_add_u32 s71, s67, s70
s_add_u32 s71, s71, 4
s_lshl_b32 s71, s71, 13
s_lshl_b32 s70, s70, 14
s_mul_i32 s67, s67, 24576
s_sub_u32 s70, s70, s67
s_add_u32 s70, s70, 65536
s_branch L_attstart_7
L_spin_2016:
s_mov_b32 vcc_hi, 0x8000
L_spinlp_2018:
s_sleep 1
buffer_load_dword v19, off, s[52:55], s72 offset:0 sc1
s_waitcnt vmcnt(0)
v_readfirstlane_b32 vcc_lo, v19
s_sub_u32 vcc_hi, vcc_hi, 1
s_cbranch_scc1 L_spinbk_2017
s_cmp_lt_u32 vcc_lo, 16
s_cbranch_scc1 L_spinlp_2018
s_branch L_spinbk_2017
L_xretry:
s_sub_u32 s72, s72, 1
s_cbranch_scc1 L_xgo
buffer_load_dwordx4 v[152:155], v16, s[44:47], s75 offen offset:0 sc1
buffer_load_dwordx4 v[156:159], v16, s[44:47], s75 offen offset:1024 sc1
buffer_load_dwordx4 v[160:163], v16, s[44:47], s75 offen offset:2048 sc1
buffer_load_dwordx4 v[164:167], v16, s[44:47], s75 offen offset:3072 sc1
s_branch L_xchk
L_codeend:
.section .rodata,"a"
.p2align 6
.amdhsa_kernel gated_mix__compressed_kv_cla__sliding_local_dilated__prompt_kernel
  .amdhsa_next_free_vgpr 512
  .amdhsa_next_free_sgpr 102
  .amdhsa_accum_offset 256
  .amdhsa_group_segment_fixed_size 0
  .amdhsa_kernarg_size 104
  .amdhsa_user_sgpr_count 2
  .amdhsa_user_sgpr_kernarg_segment_ptr 1
  .amdhsa_system_sgpr_workgroup_id_x 1
.end_amdhsa_kernel
```

```asm
; @launch grid=(256,1,1) block=(256,1,1) lds=163840
.amdgcn_target "amdgcn-amd-amdhsa--gfx950"
.text
.globl gated_mix__compressed_kv_cla__sliding_local_dilated__prompt_kernel
.p2align 8
.type gated_mix__compressed_kv_cla__sliding_local_dilated__prompt_kernel,@function
gated_mix__compressed_kv_cla__sliding_local_dilated__prompt_kernel:
s_cmp_ge_u32 s2, 256
s_cbranch_scc1 L_end
s_load_dwordx16 s[4:19], s[0:1], 0
s_load_dwordx8 s[20:27], s[0:1], 64
s_load_dwordx2 s[28:29], s[0:1], 96
s_getpc_b64 s[88:89]
L_pc:
v_lshrrev_b32 v1, 6, v0
s_lshr_b32 s67, s2, 3
v_lshl_add_u32 v24, s67, 2, v1
s_mov_b32 s90, L_codeend-L_pc
s_mov_b32 s91, 0x20000
v_and_b32 v25, 7, v0
v_lshlrev_b32 v25, 7, v25
v_lshl_add_u32 v24, v24, 10, v25
buffer_load_dword a252, v24, s[88:91], 0 offen
v_and_b32 v0, 63, v0
v_readfirstlane_b32 s30, v1
v_lshrrev_b32 v24, 3, v0
v_lshrrev_b32 v25, 4, v0
v_and_b32 v26, 7, v0
v_xor_b32 v26, v26, v25
v_lshlrev_b32 v26, 4, v26
v_lshl_add_u32 v12, v24, 10, v26
v_xor_b32 v13, 64, v12
v_bfe_u32 v26, v0, 1, 3
v_xor_b32 v26, v26, v25
v_lshlrev_b32 v26, 5, v26
v_and_b32 v24, 1, v0
v_lshl_add_u32 v26, v24, 4, v26
v_lshl_add_u32 v14, v25, 13, v26
v_xor_b32 v15, 128, v14
s_and_b32 s66, s2, 7
s_and_b32 s68, s67, 3
s_lshl2_add_u32 s31, s66, s68
s_lshr_b32 s3, s67, 2
s_lshl2_add_u32 s80, s67, s30
s_lshl_b32 s70, s3, 18
s_lshl_b32 s66, s30, 16
s_add_u32 s70, s70, s66
s_lshl_b32 s71, s30, 17
s_lshl_b32 s66, s31, 8
s_add_u32 s71, s71, s66
s_lshl_b32 s76, s30, 13
s_lshl_b32 s77, s30, 12
s_lshl_b32 s78, s30, 10
s_waitcnt lgkmcnt(0)
s_mov_b32 s32, s6
s_mov_b32 s33, s7
s_mov_b32 s34, 2097152
s_mov_b32 s35, 0x20000
s_mov_b32 s36, s10
s_mov_b32 s37, s11
s_mov_b32 s38, 4194304
s_mov_b32 s39, 0x20000
s_mov_b32 s40, s12
s_mov_b32 s41, s13
s_mov_b32 s42, 4194304
s_mov_b32 s43, 0x20000
s_add_u32 m0, s76, 0
s_add_u32 s64, s70, 0
buffer_load_dwordx4 v12, s[32:35], s64 offen lds
s_add_u32 m0, s76, 1024
s_add_u32 s64, s70, 8192
buffer_load_dwordx4 v13, s[32:35], s64 offen lds
s_add_u32 m0, s76, 2048
s_add_u32 s64, s70, 16384
buffer_load_dwordx4 v12, s[32:35], s64 offen lds
s_add_u32 m0, s76, 3072
s_add_u32 s64, s70, 24576
buffer_load_dwordx4 v13, s[32:35], s64 offen lds
s_add_u32 m0, s76, 4096
s_add_u32 s64, s70, 32768
buffer_load_dwordx4 v12, s[32:35], s64 offen lds
s_add_u32 m0, s76, 5120
s_add_u32 s64, s70, 40960
buffer_load_dwordx4 v13, s[32:35], s64 offen lds
s_add_u32 m0, s76, 6144
s_add_u32 s64, s70, 49152
buffer_load_dwordx4 v12, s[32:35], s64 offen lds
s_add_u32 m0, s76, 7168
s_add_u32 s64, s70, 57344
buffer_load_dwordx4 v13, s[32:35], s64 offen lds
s_add_u32 m0, s77, 65536
s_add_u32 s64, s71, 0
buffer_load_dwordx4 v14, s[36:39], s64 offen lds
s_add_u32 m0, s77, 66560
s_add_u32 s64, s71, 32768
buffer_load_dwordx4 v14, s[36:39], s64 offen lds
s_add_u32 m0, s77, 67584
s_add_u32 s64, s71, 65536
buffer_load_dwordx4 v15, s[36:39], s64 offen lds
s_add_u32 m0, s77, 68608
s_add_u32 s64, s71, 98304
buffer_load_dwordx4 v15, s[36:39], s64 offen lds
s_add_u32 m0, s77, 81920
s_add_u32 s64, s71, 0
buffer_load_dwordx4 v14, s[40:43], s64 offen lds
s_add_u32 m0, s77, 82944
s_add_u32 s64, s71, 32768
buffer_load_dwordx4 v14, s[40:43], s64 offen lds
s_add_u32 m0, s77, 83968
s_add_u32 s64, s71, 65536
buffer_load_dwordx4 v15, s[40:43], s64 offen lds
s_add_u32 m0, s77, 84992
s_add_u32 s64, s71, 98304
buffer_load_dwordx4 v15, s[40:43], s64 offen lds
s_mov_b32 s44, s28
s_mov_b32 s45, s29
s_mov_b32 s46, 134217728
s_mov_b32 s47, 0x20000
s_mov_b32 s48, s4
s_mov_b32 s49, s5
s_mov_b32 s50, 4194304
s_mov_b32 s51, 0x20000
s_mov_b32 s52, s26
s_mov_b32 s53, s27
s_mov_b32 s54, 256
s_mov_b32 s55, 0x20000
s_mov_b32 s56, s8
s_mov_b32 s57, s9
s_mov_b32 s58, 8388608
s_mov_b32 s59, 0x20000
s_mov_b32 s60, s18
s_mov_b32 s61, s19
s_mov_b32 s62, 6291456
s_mov_b32 s63, 0x20000
v_accvgpr_write_b32 a251, 1
v_and_b32 v24, 15, v0
v_lshrrev_b32 v26, 1, v24
v_xor_b32 v26, v26, v25
v_lshlrev_b32 v26, 4, v26
v_lshl_add_u32 v26, v24, 7, v26
v_add_u32 v2, s76, v26
v_xor_b32 v3, 64, v2
v_bfe_u32 v24, v0, 2, 2
v_lshl_add_u32 v27, v25, 3, v24
v_and_b32 v1, 3, v0
v_cmp_eq_u32 vcc, 0, v1
v_lshlrev_b32 v1, 3, v1
v_lshl_add_u32 v26, v27, 8, v1
v_add_u32 v26, 65536, v26
v_and_b32 v1, 1, v25
v_lshl_add_u32 v24, v1, 2, v24
v_lshlrev_b32 v16, 4, v0
v_mov_b32 v28, 0x3f803f80
v_cndmask_b32 v28, 0, v28, vcc
v_accvgpr_write_b32 a244, v28
v_accvgpr_write_b32 a245, v28
v_accvgpr_write_b32 a246, v28
v_accvgpr_write_b32 a247, v28
v_xor_b32 v1, 0, v24
v_lshl_add_u32 v4, v1, 5, v26
v_xor_b32 v1, 1, v24
v_lshl_add_u32 v5, v1, 5, v26
v_xor_b32 v1, 2, v24
v_lshl_add_u32 v6, v1, 5, v26
v_xor_b32 v1, 3, v24
v_lshl_add_u32 v7, v1, 5, v26
v_xor_b32 v1, 4, v24
v_lshl_add_u32 v8, v1, 5, v26
v_xor_b32 v1, 5, v24
v_lshl_add_u32 v9, v1, 5, v26
v_xor_b32 v1, 6, v24
v_lshl_add_u32 v10, v1, 5, v26
v_xor_b32 v1, 7, v24
v_lshl_add_u32 v11, v1, 5, v26
s_sub_u32 s16, 15, s3
s_lshl_b32 s72, s3, 18
s_lshl_b32 s73, s16, 18
s_cmp_lt_u32 s30, 2
s_cselect_b32 s67, s3, s16
s_lshl4_add_u32 s74, s31, s67
s_and_b32 s66, s30, 1
s_lshl1_add_u32 s74, s74, s66
s_lshl_b32 s74, s74, 10
s_add_u32 s74, s74, 60817408
s_lshl_b32 s66, s30, 15
s_add_u32 s72, s72, s66
s_add_u32 s73, s73, s66
s_mul_i32 s75, s30, 98304
s_lshl_b32 s66, s31, 6
s_add_u32 s75, s75, s66
s_lshl_b32 s79, s31, 20
s_lshl_b32 s66, s3, 17
s_add_u32 s79, s79, s66
s_lshl_b32 s66, s30, 15
s_add_u32 s79, s79, s66
v_bfe_u32 v23, v0, 1, 1
v_lshrrev_b32 v1, 5, v0
v_xor_b32 v23, v23, v1
v_lshlrev_b32 v23, 5, v23
v_and_b32 v1, 1, v0
v_lshl_add_u32 v23, v1, 4, v23
v_lshrrev_b32 v1, 2, v0
v_mul_u32_u24 v1, 6144, v1
v_add_u32 v23, v1, v23
s_lshl_b32 s81, s80, 13
s_and_b32 s67, s2, 7
s_lshl_b32 s82, s67, 8
s_add_u32 s82, s82, s81
s_lshl_b32 s67, s67, 10
s_add_u32 s81, s81, s67
s_add_u32 s83, s81, 1048576
v_mul_u32_u24 v1, 1792, v25
v_add_u32 v1, v1, v16
s_lshl_b32 s68, s2, 3
s_lshl1_add_u32 s68, s30, s68
v_lshrrev_b32 v18, 5, v0
v_add_u32 v18, s68, v18
v_and_b32 v19, 31, v0
v_lshlrev_b32 v19, 4, v19
v_lshl_add_u32 v18, v18, 11, v19
v_mov_b32 v21, 0
v_min_u32 v20, 1, v0
v_lshlrev_b32 v20, 30, v20
v_accvgpr_write_b32 a240, -1
v_accvgpr_write_b32 a241, -1
v_accvgpr_write_b32 a242, -1
v_accvgpr_write_b32 a243, -1
s_lshr_b32 s69, s2, 7
s_or_b32 s69, s69, s30
s_lshl_b32 s69, s69, 21
s_add_u32 s69, s69, s2
s_lshl_b32 s69, s69, 7
s_add_u32 s69, s69, 59768832
s_add_u32 m0, s77, 98304
s_add_u32 s64, s71, 524288
buffer_load_dwordx4 v14, s[36:39], s64 offen lds
s_add_u32 m0, s77, 99328
s_add_u32 s64, s71, 557056
buffer_load_dwordx4 v14, s[36:39], s64 offen lds
s_add_u32 m0, s77, 100352
s_add_u32 s64, s71, 589824
buffer_load_dwordx4 v15, s[36:39], s64 offen lds
s_add_u32 m0, s77, 101376
s_add_u32 s64, s71, 622592
buffer_load_dwordx4 v15, s[36:39], s64 offen lds
s_add_u32 m0, s77, 114688
s_add_u32 s64, s71, 524288
buffer_load_dwordx4 v14, s[40:43], s64 offen lds
s_add_u32 m0, s77, 115712
s_add_u32 s64, s71, 557056
buffer_load_dwordx4 v14, s[40:43], s64 offen lds
s_add_u32 m0, s77, 116736
s_add_u32 s64, s71, 589824
buffer_load_dwordx4 v15, s[40:43], s64 offen lds
s_add_u32 m0, s77, 117760
s_add_u32 s64, s71, 622592
buffer_load_dwordx4 v15, s[40:43], s64 offen lds
s_waitcnt vmcnt(8)
s_barrier
ds_read_b128 a[0:3], v2 offset:0
ds_read_b128 a[4:7], v3 offset:0
ds_read_b64_tr_b16 a[72:73], v4 offset:0
ds_read_b64_tr_b16 a[74:75], v4 offset:1024
ds_read_b64_tr_b16 a[76:77], v4 offset:8192
ds_read_b64_tr_b16 a[78:79], v4 offset:9216
ds_read_b128 a[8:11], v2 offset:2048
ds_read_b128 a[12:15], v3 offset:2048
ds_read_b128 a[16:19], v2 offset:4096
ds_read_b128 a[20:23], v3 offset:4096
ds_read_b128 a[24:27], v2 offset:6144
ds_read_b128 a[28:31], v3 offset:6144
ds_read_b64_tr_b16 a[80:81], v5 offset:0
ds_read_b64_tr_b16 a[82:83], v5 offset:1024
ds_read_b64_tr_b16 a[84:85], v5 offset:8192
ds_read_b64_tr_b16 a[86:87], v5 offset:9216
ds_read_b64_tr_b16 a[88:89], v6 offset:0
ds_read_b64_tr_b16 a[90:91], v6 offset:1024
ds_read_b64_tr_b16 a[92:93], v6 offset:8192
ds_read_b64_tr_b16 a[94:95], v6 offset:9216
s_waitcnt lgkmcnt(15)
v_mfma_f32_16x16x32_bf16 v[184:187], a[72:75], a[0:3], 0
s_waitcnt lgkmcnt(14)
s_add_u32 m0, s76, 32768
ds_read_b64_tr_b16 a[96:97], v7 offset:0
v_mfma_f32_16x16x32_bf16 v[184:187], a[76:79], a[4:7], v[184:187]
s_waitcnt lgkmcnt(13)
s_add_u32 s64, s70, 128
ds_read_b64_tr_b16 a[98:99], v7 offset:1024
v_mfma_f32_16x16x32_bf16 v[192:195], a[76:79], a[12:15], 0
buffer_load_dwordx4 v12, s[32:35], s64 offen lds
v_mfma_f32_16x16x32_bf16 v[192:195], a[72:75], a[8:11], v[192:195]
s_waitcnt lgkmcnt(13)
s_add_u32 m0, s76, 33792
ds_read_b64_tr_b16 a[100:101], v7 offset:8192
v_mfma_f32_16x16x32_bf16 v[200:203], a[72:75], a[16:19], 0
s_waitcnt lgkmcnt(13)
s_add_u32 s64, s70, 8320
ds_read_b64_tr_b16 a[102:103], v7 offset:9216
v_mfma_f32_16x16x32_bf16 v[200:203], a[76:79], a[20:23], v[200:203]
s_waitcnt lgkmcnt(12)
buffer_load_dwordx4 v13, s[32:35], s64 offen lds
v_mfma_f32_16x16x32_bf16 v[208:211], a[76:79], a[28:31], 0
s_add_u32 m0, s76, 34816
ds_read_b64_tr_b16 a[104:105], v8 offset:0
v_mfma_f32_16x16x32_bf16 v[208:211], a[72:75], a[24:27], v[208:211]
s_waitcnt lgkmcnt(11)
s_add_u32 s64, s70, 16512
ds_read_b64_tr_b16 a[106:107], v8 offset:1024
v_mfma_f32_16x16x32_bf16 v[212:215], a[80:83], a[24:27], 0
s_waitcnt lgkmcnt(10)
buffer_load_dwordx4 v12, s[32:35], s64 offen lds
v_mfma_f32_16x16x32_bf16 v[212:215], a[84:87], a[28:31], v[212:215]
ds_read_b64_tr_b16 a[108:109], v8 offset:8192
v_mfma_f32_16x16x32_bf16 v[204:207], a[84:87], a[20:23], 0
s_add_u32 m0, s76, 35840
s_add_u32 s17, s78, .-L_pc+6144
ds_read_b64_tr_b16 a[110:111], v8 offset:9216
v_mfma_f32_16x16x32_bf16 v[204:207], a[80:83], a[16:19], v[204:207]
s_add_u32 s64, s70, 24704
buffer_load_dword a252, v16, s[88:91], s17 offen
v_mfma_f32_16x16x32_bf16 v[196:199], a[80:83], a[8:11], 0
buffer_load_dwordx4 v13, s[32:35], s64 offen lds
v_mfma_f32_16x16x32_bf16 v[196:199], a[84:87], a[12:15], v[196:199]
s_add_u32 m0, s76, 36864
ds_read_b64_tr_b16 a[112:113], v9 offset:0
v_mfma_f32_16x16x32_bf16 v[188:191], a[84:87], a[4:7], 0
s_add_u32 s64, s70, 32896
ds_read_b64_tr_b16 a[114:115], v9 offset:1024
v_mfma_f32_16x16x32_bf16 v[188:191], a[80:83], a[0:3], v[188:191]
s_waitcnt lgkmcnt(6)
buffer_load_dwordx4 v12, s[32:35], s64 offen lds
v_mfma_f32_16x16x32_bf16 v[216:219], a[88:91], a[0:3], 0
s_add_u32 m0, s76, 37888
ds_read_b64_tr_b16 a[116:117], v9 offset:8192
v_mfma_f32_16x16x32_bf16 v[216:219], a[92:95], a[4:7], v[216:219]
s_add_u32 s64, s70, 41088
ds_read_b64_tr_b16 a[118:119], v9 offset:9216
v_mfma_f32_16x16x32_bf16 v[224:227], a[92:95], a[12:15], 0
buffer_load_dwordx4 v13, s[32:35], s64 offen lds
v_mfma_f32_16x16x32_bf16 v[224:227], a[88:91], a[8:11], v[224:227]
ds_read_b64_tr_b16 a[72:73], v10 offset:0
v_mfma_f32_16x16x32_bf16 v[232:235], a[88:91], a[16:19], 0
s_add_u32 m0, s76, 38912
ds_read_b64_tr_b16 a[74:75], v10 offset:1024
v_mfma_f32_16x16x32_bf16 v[232:235], a[92:95], a[20:23], v[232:235]
s_add_u32 s64, s70, 49280
ds_read_b64_tr_b16 a[76:77], v10 offset:8192
v_mfma_f32_16x16x32_bf16 v[240:243], a[92:95], a[28:31], 0
buffer_load_dwordx4 v12, s[32:35], s64 offen lds
v_mfma_f32_16x16x32_bf16 v[240:243], a[88:91], a[24:27], v[240:243]
s_add_u32 m0, s76, 39936
ds_read_b64_tr_b16 a[78:79], v10 offset:9216
v_mfma_f32_16x16x32_bf16 v[244:247], a[96:99], a[24:27], 0
s_add_u32 s64, s70, 57472
ds_read_b64_tr_b16 a[80:81], v11 offset:0
v_mfma_f32_16x16x32_bf16 v[244:247], a[100:103], a[28:31], v[244:247]
buffer_load_dwordx4 v13, s[32:35], s64 offen lds
v_mfma_f32_16x16x32_bf16 v[236:239], a[100:103], a[20:23], 0
ds_read_b64_tr_b16 a[82:83], v11 offset:1024
v_mfma_f32_16x16x32_bf16 v[236:239], a[96:99], a[16:19], v[236:239]
s_add_u32 m0, s77, 131072
ds_read_b64_tr_b16 a[84:85], v11 offset:8192
v_mfma_f32_16x16x32_bf16 v[228:231], a[96:99], a[8:11], 0
s_add_u32 s64, s71, 1048576
ds_read_b64_tr_b16 a[86:87], v11 offset:9216
v_mfma_f32_16x16x32_bf16 v[228:231], a[100:103], a[12:15], v[228:231]
buffer_load_dwordx4 v14, s[36:39], s64 offen lds
v_mfma_f32_16x16x32_bf16 v[220:223], a[100:103], a[4:7], 0
s_add_u32 m0, s77, 132096
ds_read_b64_tr_b16 a[88:89], v4 offset:16384
v_mfma_f32_16x16x32_bf16 v[220:223], a[96:99], a[0:3], v[220:223]
s_waitcnt lgkmcnt(6)
s_add_u32 s64, s71, 1081344
ds_read_b64_tr_b16 a[90:91], v4 offset:17408
v_mfma_f32_16x16x32_bf16 v[152:155], a[104:107], a[0:3], 0
buffer_load_dwordx4 v14, s[36:39], s64 offen lds
v_mfma_f32_16x16x32_bf16 v[152:155], a[108:111], a[4:7], v[152:155]
s_add_u32 m0, s77, 133120
ds_read_b64_tr_b16 a[92:93], v4 offset:24576
v_mfma_f32_16x16x32_bf16 v[160:163], a[108:111], a[12:15], 0
s_add_u32 s64, s71, 1114112
ds_read_b64_tr_b16 a[94:95], v4 offset:25600
v_mfma_f32_16x16x32_bf16 v[160:163], a[104:107], a[8:11], v[160:163]
buffer_load_dwordx4 v15, s[36:39], s64 offen lds
v_mfma_f32_16x16x32_bf16 v[168:171], a[104:107], a[16:19], 0
ds_read_b64_tr_b16 a[96:97], v5 offset:16384
v_mfma_f32_16x16x32_bf16 v[168:171], a[108:111], a[20:23], v[168:171]
s_add_u32 m0, s77, 134144
ds_read_b64_tr_b16 a[98:99], v5 offset:17408
v_mfma_f32_16x16x32_bf16 v[176:179], a[108:111], a[28:31], 0
s_add_u32 s64, s71, 1146880
ds_read_b64_tr_b16 a[100:101], v5 offset:24576
v_mfma_f32_16x16x32_bf16 v[176:179], a[104:107], a[24:27], v[176:179]
buffer_load_dwordx4 v15, s[36:39], s64 offen lds
v_mfma_f32_16x16x32_bf16 v[180:183], a[112:115], a[24:27], 0
s_add_u32 m0, s77, 147456
global_load_dwordx4 a[144:147], v18, s[4:5] offset:0
v_mfma_f32_16x16x32_bf16 v[180:183], a[116:119], a[28:31], v[180:183]
s_add_u32 s64, s71, 1048576
ds_read_b64_tr_b16 a[102:103], v5 offset:25600
v_mfma_f32_16x16x32_bf16 v[172:175], a[116:119], a[20:23], 0
buffer_load_dwordx4 v14, s[40:43], s64 offen lds
v_mfma_f32_16x16x32_bf16 v[172:175], a[112:115], a[16:19], v[172:175]
s_add_u32 m0, s77, 148480
ds_read_b64_tr_b16 a[104:105], v6 offset:16384
v_mfma_f32_16x16x32_bf16 v[164:167], a[112:115], a[8:11], 0
s_add_u32 s64, s71, 1081344
ds_read_b64_tr_b16 a[106:107], v6 offset:17408
v_mfma_f32_16x16x32_bf16 v[164:167], a[116:119], a[12:15], v[164:167]
buffer_load_dwordx4 v14, s[40:43], s64 offen lds
v_mfma_f32_16x16x32_bf16 v[156:159], a[116:119], a[4:7], 0
ds_read_b64_tr_b16 a[108:109], v6 offset:24576
v_mfma_f32_16x16x32_bf16 v[156:159], a[112:115], a[0:3], v[156:159]
s_add_u32 m0, s77, 149504
ds_read_b64_tr_b16 a[110:111], v6 offset:25600
v_mfma_f32_16x16x32_bf16 v[24:27], a[72:75], a[0:3], 0
s_waitcnt lgkmcnt(5)
s_add_u32 s64, s71, 1114112
ds_read_b64_tr_b16 a[112:113], v7 offset:16384
v_mfma_f32_16x16x32_bf16 v[24:27], a[76:79], a[4:7], v[24:27]
buffer_load_dwordx4 v15, s[40:43], s64 offen lds
v_mfma_f32_16x16x32_bf16 v[40:43], a[76:79], a[12:15], 0
s_add_u32 m0, s77, 150528
ds_read_b64_tr_b16 a[114:115], v7 offset:17408
v_mfma_f32_16x16x32_bf16 v[40:43], a[72:75], a[8:11], v[40:43]
s_add_u32 s64, s71, 1146880
ds_read_b64_tr_b16 a[116:117], v7 offset:24576
v_mfma_f32_16x16x32_bf16 v[56:59], a[72:75], a[16:19], 0
buffer_load_dwordx4 v15, s[40:43], s64 offen lds
v_mfma_f32_16x16x32_bf16 v[56:59], a[76:79], a[20:23], v[56:59]
ds_read_b64_tr_b16 a[118:119], v7 offset:25600
v_mfma_f32_16x16x32_bf16 v[72:75], a[76:79], a[28:31], 0
v_mfma_f32_16x16x32_bf16 v[72:75], a[72:75], a[24:27], v[72:75]
ds_read_b64_tr_b16 a[72:73], v8 offset:16384
v_mfma_f32_16x16x32_bf16 v[136:139], a[80:83], a[24:27], 0
s_add_u32 m0, s76, 0
ds_read_b64_tr_b16 a[74:75], v8 offset:17408
v_mfma_f32_16x16x32_bf16 v[136:139], a[84:87], a[28:31], v[136:139]
s_add_u32 s64, s70, 256
ds_read_b64_tr_b16 a[76:77], v8 offset:24576
v_mfma_f32_16x16x32_bf16 v[120:123], a[84:87], a[20:23], 0
buffer_load_dwordx4 v12, s[32:35], s64 offen lds
v_mfma_f32_16x16x32_bf16 v[120:123], a[80:83], a[16:19], v[120:123]
ds_read_b64_tr_b16 a[78:79], v8 offset:25600
v_mfma_f32_16x16x32_bf16 v[104:107], a[80:83], a[8:11], 0
s_add_u32 m0, s76, 1024
v_mfma_f32_16x16x32_bf16 v[104:107], a[84:87], a[12:15], v[104:107]
s_add_u32 s64, s70, 8448
v_mfma_f32_16x16x32_bf16 v[88:91], a[84:87], a[4:7], 0
buffer_load_dwordx4 v13, s[32:35], s64 offen lds
v_mfma_f32_16x16x32_bf16 v[88:91], a[80:83], a[0:3], v[88:91]
ds_read_b64_tr_b16 a[80:81], v9 offset:16384
v_mfma_f32_16x16x32_bf16 v[28:31], a[0:3], a[88:91], 0
ds_read_b64_tr_b16 a[82:83], v9 offset:17408
v_mfma_f32_16x16x32_bf16 v[28:31], a[4:7], a[92:95], v[28:31]
s_add_u32 m0, s76, 2048
ds_read_b64_tr_b16 a[84:85], v9 offset:24576
v_mfma_f32_16x16x32_bf16 v[44:47], a[12:15], a[92:95], 0
s_add_u32 s64, s70, 16640
ds_read_b64_tr_b16 a[86:87], v9 offset:25600
v_mfma_f32_16x16x32_bf16 v[44:47], a[8:11], a[88:91], v[44:47]
buffer_load_dwordx4 v12, s[32:35], s64 offen lds
v_mfma_f32_16x16x32_bf16 v[60:63], a[16:19], a[88:91], 0
global_load_dwordx4 a[160:163], v19, s[22:23] offset:0
v_mfma_f32_16x16x32_bf16 v[60:63], a[20:23], a[92:95], v[60:63]
v_mfma_f32_16x16x32_bf16 v[76:79], a[28:31], a[92:95], 0
s_add_u32 m0, s76, 3072
v_mfma_f32_16x16x32_bf16 v[76:79], a[24:27], a[88:91], v[76:79]
s_add_u32 s64, s70, 24832
ds_read_b64_tr_b16 a[88:89], v10 offset:16384
v_mfma_f32_16x16x32_bf16 v[140:143], a[24:27], a[96:99], 0
s_waitcnt lgkmcnt(5)
buffer_load_dwordx4 v13, s[32:35], s64 offen lds
v_mfma_f32_16x16x32_bf16 v[140:143], a[28:31], a[100:103], v[140:143]
ds_read_b64_tr_b16 a[90:91], v10 offset:17408
v_mfma_f32_16x16x32_bf16 v[124:127], a[20:23], a[100:103], 0
ds_read_b64_tr_b16 a[92:93], v10 offset:24576
v_mfma_f32_16x16x32_bf16 v[124:127], a[16:19], a[96:99], v[124:127]
s_add_u32 m0, s76, 4096
ds_read_b64_tr_b16 a[94:95], v10 offset:25600
v_mfma_f32_16x16x32_bf16 v[108:111], a[8:11], a[96:99], 0
s_add_u32 s64, s70, 33024
v_mfma_f32_16x16x32_bf16 v[108:111], a[12:15], a[100:103], v[108:111]
buffer_load_dwordx4 v12, s[32:35], s64 offen lds
v_mfma_f32_16x16x32_bf16 v[92:95], a[4:7], a[100:103], 0
v_mfma_f32_16x16x32_bf16 v[92:95], a[0:3], a[96:99], v[92:95]
s_add_u32 m0, s76, 5120
ds_read_b64_tr_b16 a[96:97], v11 offset:16384
v_mfma_f32_16x16x32_bf16 v[32:35], a[0:3], a[104:107], 0
s_add_u32 s64, s70, 41216
ds_read_b64_tr_b16 a[98:99], v11 offset:17408
v_mfma_f32_16x16x32_bf16 v[32:35], a[4:7], a[108:111], v[32:35]
buffer_load_dwordx4 v13, s[32:35], s64 offen lds
v_mfma_f32_16x16x32_bf16 v[48:51], a[12:15], a[108:111], 0
ds_read_b64_tr_b16 a[100:101], v11 offset:24576
v_mfma_f32_16x16x32_bf16 v[48:51], a[8:11], a[104:107], v[48:51]
ds_read_b64_tr_b16 a[102:103], v11 offset:25600
v_mfma_f32_16x16x32_bf16 v[64:67], a[16:19], a[104:107], 0
s_add_u32 m0, s76, 6144
v_mfma_f32_16x16x32_bf16 v[64:67], a[20:23], a[108:111], v[64:67]
s_add_u32 s64, s70, 49408
v_mfma_f32_16x16x32_bf16 v[80:83], a[28:31], a[108:111], 0
buffer_load_dwordx4 v12, s[32:35], s64 offen lds
v_mfma_f32_16x16x32_bf16 v[80:83], a[24:27], a[104:107], v[80:83]
v_mfma_f32_16x16x32_bf16 v[144:147], a[24:27], a[112:115], 0
v_mfma_f32_16x16x32_bf16 v[144:147], a[28:31], a[116:119], v[144:147]
s_add_u32 m0, s76, 7168
v_mfma_f32_16x16x32_bf16 v[128:131], a[20:23], a[116:119], 0
s_add_u32 s64, s70, 57600
v_mfma_f32_16x16x32_bf16 v[128:131], a[16:19], a[112:115], v[128:131]
buffer_load_dwordx4 v13, s[32:35], s64 offen lds
v_mfma_f32_16x16x32_bf16 v[112:115], a[8:11], a[112:115], 0
v_mfma_f32_16x16x32_bf16 v[112:115], a[12:15], a[116:119], v[112:115]
v_mfma_f32_16x16x32_bf16 v[96:99], a[4:7], a[116:119], 0
v_mfma_f32_16x16x32_bf16 v[96:99], a[0:3], a[112:115], v[96:99]
v_mfma_f32_16x16x32_bf16 v[36:39], a[0:3], a[72:75], 0
global_load_dwordx4 a[148:151], v18, s[4:5] offset:512
v_mfma_f32_16x16x32_bf16 v[36:39], a[4:7], a[76:79], v[36:39]
v_mfma_f32_16x16x32_bf16 v[52:55], a[12:15], a[76:79], 0
s_waitcnt vmcnt(28) lgkmcnt(0)
s_barrier
v_mfma_f32_16x16x32_bf16 v[52:55], a[8:11], a[72:75], v[52:55]
s_add_u32 m0, s77, 65536
ds_read_b64_tr_b16 a[104:105], v4 offset:32768
v_mfma_f32_16x16x32_bf16 v[68:71], a[16:19], a[72:75], 0
s_add_u32 s64, s71, 1572864
ds_read_b64_tr_b16 a[106:107], v4 offset:33792
v_mfma_f32_16x16x32_bf16 v[68:71], a[20:23], a[76:79], v[68:71]
buffer_load_dwordx4 v14, s[36:39], s64 offen lds
v_mfma_f32_16x16x32_bf16 v[84:87], a[28:31], a[76:79], 0
ds_read_b64_tr_b16 a[108:109], v4 offset:40960
v_mfma_f32_16x16x32_bf16 v[84:87], a[24:27], a[72:75], v[84:87]
ds_read_b64_tr_b16 a[110:111], v4 offset:41984
v_mfma_f32_16x16x32_bf16 v[148:151], a[24:27], a[80:83], 0
ds_read_b64_tr_b16 a[112:113], v5 offset:32768
v_mfma_f32_16x16x32_bf16 v[148:151], a[28:31], a[84:87], v[148:151]
ds_read_b64_tr_b16 a[114:115], v5 offset:33792
v_mfma_f32_16x16x32_bf16 v[132:135], a[20:23], a[84:87], 0
s_waitcnt vmcnt(20)
ds_read_b128 a[32:35], v2 offset:32768
v_mfma_f32_16x16x32_bf16 v[132:135], a[16:19], a[80:83], v[132:135]
s_add_u32 m0, s77, 66560
ds_read_b128 a[36:39], v3 offset:32768
v_mfma_f32_16x16x32_bf16 v[116:119], a[8:11], a[80:83], 0
s_add_u32 s64, s71, 1605632
ds_read_b128 a[40:43], v2 offset:34816
v_mfma_f32_16x16x32_bf16 v[116:119], a[12:15], a[84:87], v[116:119]
buffer_load_dwordx4 v14, s[36:39], s64 offen lds
v_mfma_f32_16x16x32_bf16 v[100:103], a[4:7], a[84:87], 0
ds_read_b128 a[44:47], v3 offset:34816
v_mfma_f32_16x16x32_bf16 v[100:103], a[0:3], a[80:83], v[100:103]
ds_read_b128 a[48:51], v2 offset:36864
v_mfma_f32_16x16x32_bf16 v[248:251], a[0:3], a[88:91], 0
ds_read_b128 a[52:55], v3 offset:36864
v_mfma_f32_16x16x32_bf16 v[248:251], a[4:7], a[92:95], v[248:251]
ds_read_b128 a[56:59], v2 offset:38912
v_mfma_f32_16x16x32_bf16 v[252:255], a[12:15], a[92:95], 0
ds_read_b128 a[60:63], v3 offset:38912
v_mfma_f32_16x16x32_bf16 v[252:255], a[8:11], a[88:91], v[252:255]
s_add_u32 m0, s77, 67584
ds_read_b64_tr_b16 a[116:117], v5 offset:40960
v_mfma_f32_16x16x32_bf16 a[120:123], a[16:19], a[88:91], 0
s_add_u32 s64, s71, 1638400
ds_read_b64_tr_b16 a[118:119], v5 offset:41984
v_mfma_f32_16x16x32_bf16 a[120:123], a[20:23], a[92:95], a[120:123]
buffer_load_dwordx4 v15, s[36:39], s64 offen lds
v_mfma_f32_16x16x32_bf16 a[124:127], a[28:31], a[92:95], 0
ds_read_b64_tr_b16 a[72:73], v6 offset:32768
v_mfma_f32_16x16x32_bf16 a[124:127], a[24:27], a[88:91], a[124:127]
ds_read_b64_tr_b16 a[74:75], v6 offset:33792
v_mfma_f32_16x16x32_bf16 a[128:131], a[24:27], a[96:99], 0
ds_read_b64_tr_b16 a[76:77], v6 offset:40960
v_mfma_f32_16x16x32_bf16 a[128:131], a[28:31], a[100:103], a[128:131]
ds_read_b64_tr_b16 a[78:79], v6 offset:41984
v_mfma_f32_16x16x32_bf16 a[132:135], a[20:23], a[100:103], 0
ds_read_b64_tr_b16 a[80:81], v7 offset:32768
v_mfma_f32_16x16x32_bf16 a[132:135], a[16:19], a[96:99], a[132:135]
s_add_u32 m0, s77, 68608
ds_read_b64_tr_b16 a[82:83], v7 offset:33792
v_mfma_f32_16x16x32_bf16 a[136:139], a[8:11], a[96:99], 0
s_add_u32 s64, s71, 1671168
global_load_dwordx4 a[164:167], v19, s[22:23] offset:512
v_mfma_f32_16x16x32_bf16 a[136:139], a[12:15], a[100:103], a[136:139]
buffer_load_dwordx4 v15, s[36:39], s64 offen lds
v_mfma_f32_16x16x32_bf16 a[140:143], a[4:7], a[100:103], 0
ds_read_b64_tr_b16 a[84:85], v7 offset:40960
v_mfma_f32_16x16x32_bf16 a[140:143], a[0:3], a[96:99], a[140:143]
s_waitcnt lgkmcnt(7)
ds_read_b64_tr_b16 a[86:87], v7 offset:41984
v_mfma_f32_16x16x32_bf16 v[184:187], a[104:107], a[32:35], v[184:187]
ds_read_b64_tr_b16 a[88:89], v8 offset:32768
v_mfma_f32_16x16x32_bf16 v[184:187], a[108:111], a[36:39], v[184:187]
ds_read_b64_tr_b16 a[90:91], v8 offset:33792
v_mfma_f32_16x16x32_bf16 v[192:195], a[108:111], a[44:47], v[192:195]
ds_read_b64_tr_b16 a[92:93], v8 offset:40960
v_mfma_f32_16x16x32_bf16 v[192:195], a[104:107], a[40:43], v[192:195]
s_add_u32 m0, s77, 81920
ds_read_b64_tr_b16 a[94:95], v8 offset:41984
v_mfma_f32_16x16x32_bf16 v[200:203], a[104:107], a[48:51], v[200:203]
s_add_u32 s64, s71, 1572864
ds_read_b64_tr_b16 a[96:97], v9 offset:32768
v_mfma_f32_16x16x32_bf16 v[200:203], a[108:111], a[52:55], v[200:203]
buffer_load_dwordx4 v14, s[40:43], s64 offen lds
v_mfma_f32_16x16x32_bf16 v[208:211], a[108:111], a[60:63], v[208:211]
ds_read_b64_tr_b16 a[98:99], v9 offset:33792
v_mfma_f32_16x16x32_bf16 v[208:211], a[104:107], a[56:59], v[208:211]
ds_read_b64_tr_b16 a[100:101], v9 offset:40960
v_mfma_f32_16x16x32_bf16 v[212:215], a[112:115], a[56:59], v[212:215]
ds_read_b64_tr_b16 a[102:103], v9 offset:41984
v_mfma_f32_16x16x32_bf16 v[212:215], a[116:119], a[60:63], v[212:215]
ds_read_b64_tr_b16 a[104:105], v10 offset:32768
v_mfma_f32_16x16x32_bf16 v[204:207], a[116:119], a[52:55], v[204:207]
ds_read_b64_tr_b16 a[106:107], v10 offset:33792
v_mfma_f32_16x16x32_bf16 v[204:207], a[112:115], a[48:51], v[204:207]
s_add_u32 m0, s77, 82944
ds_read_b64_tr_b16 a[108:109], v10 offset:40960
v_mfma_f32_16x16x32_bf16 v[196:199], a[112:115], a[40:43], v[196:199]
s_add_u32 s64, s71, 1605632
ds_read_b64_tr_b16 a[110:111], v10 offset:41984
v_mfma_f32_16x16x32_bf16 v[196:199], a[116:119], a[44:47], v[196:199]
buffer_load_dwordx4 v14, s[40:43], s64 offen lds
v_mfma_f32_16x16x32_bf16 v[188:191], a[116:119], a[36:39], v[188:191]
v_mfma_f32_16x16x32_bf16 v[188:191], a[112:115], a[32:35], v[188:191]
s_waitcnt lgkmcnt(7)
ds_read_b64_tr_b16 a[112:113], v11 offset:32768
v_mfma_f32_16x16x32_bf16 v[216:219], a[72:75], a[32:35], v[216:219]
ds_read_b64_tr_b16 a[114:115], v11 offset:33792
v_mfma_f32_16x16x32_bf16 v[216:219], a[76:79], a[36:39], v[216:219]
ds_read_b64_tr_b16 a[116:117], v11 offset:40960
v_mfma_f32_16x16x32_bf16 v[224:227], a[76:79], a[44:47], v[224:227]
ds_read_b64_tr_b16 a[118:119], v11 offset:41984
v_mfma_f32_16x16x32_bf16 v[224:227], a[72:75], a[40:43], v[224:227]
s_add_u32 m0, s77, 83968
v_mfma_f32_16x16x32_bf16 v[232:235], a[72:75], a[48:51], v[232:235]
s_add_u32 s64, s71, 1638400
v_mfma_f32_16x16x32_bf16 v[232:235], a[76:79], a[52:55], v[232:235]
buffer_load_dwordx4 v15, s[40:43], s64 offen lds
v_mfma_f32_16x16x32_bf16 v[240:243], a[76:79], a[60:63], v[240:243]
v_mfma_f32_16x16x32_bf16 v[240:243], a[72:75], a[56:59], v[240:243]
ds_read_b64_tr_b16 a[72:73], v4 offset:49152
v_mfma_f32_16x16x32_bf16 v[244:247], a[80:83], a[56:59], v[244:247]
global_load_dwordx4 a[152:155], v18, s[4:5] offset:1024
v_mfma_f32_16x16x32_bf16 v[244:247], a[84:87], a[60:63], v[244:247]
ds_read_b64_tr_b16 a[74:75], v4 offset:50176
v_mfma_f32_16x16x32_bf16 v[236:239], a[84:87], a[52:55], v[236:239]
ds_read_b64_tr_b16 a[76:77], v4 offset:57344
v_mfma_f32_16x16x32_bf16 v[236:239], a[80:83], a[48:51], v[236:239]
s_add_u32 m0, s77, 84992
ds_read_b64_tr_b16 a[78:79], v4 offset:58368
v_mfma_f32_16x16x32_bf16 v[228:231], a[80:83], a[40:43], v[228:231]
s_add_u32 s64, s71, 1671168
v_mfma_f32_16x16x32_bf16 v[228:231], a[84:87], a[44:47], v[228:231]
buffer_load_dwordx4 v15, s[40:43], s64 offen lds
v_mfma_f32_16x16x32_bf16 v[220:223], a[84:87], a[36:39], v[220:223]
v_mfma_f32_16x16x32_bf16 v[220:223], a[80:83], a[32:35], v[220:223]
ds_read_b64_tr_b16 a[80:81], v5 offset:49152
v_mfma_f32_16x16x32_bf16 v[152:155], a[88:91], a[32:35], v[152:155]
ds_read_b64_tr_b16 a[82:83], v5 offset:50176
v_mfma_f32_16x16x32_bf16 v[152:155], a[92:95], a[36:39], v[152:155]
ds_read_b64_tr_b16 a[84:85], v5 offset:57344
v_mfma_f32_16x16x32_bf16 v[160:163], a[92:95], a[44:47], v[160:163]
ds_read_b64_tr_b16 a[86:87], v5 offset:58368
v_mfma_f32_16x16x32_bf16 v[160:163], a[88:91], a[40:43], v[160:163]
v_mfma_f32_16x16x32_bf16 v[168:171], a[88:91], a[48:51], v[168:171]
v_mfma_f32_16x16x32_bf16 v[168:171], a[92:95], a[52:55], v[168:171]
v_mfma_f32_16x16x32_bf16 v[176:179], a[92:95], a[60:63], v[176:179]
s_add_u32 m0, s76, 32768
v_mfma_f32_16x16x32_bf16 v[176:179], a[88:91], a[56:59], v[176:179]
s_waitcnt lgkmcnt(4)
s_add_u32 s64, s70, 384
ds_read_b64_tr_b16 a[88:89], v6 offset:49152
v_mfma_f32_16x16x32_bf16 v[180:183], a[96:99], a[56:59], v[180:183]
buffer_load_dwordx4 v12, s[32:35], s64 offen lds
v_mfma_f32_16x16x32_bf16 v[180:183], a[100:103], a[60:63], v[180:183]
ds_read_b64_tr_b16 a[90:91], v6 offset:50176
v_mfma_f32_16x16x32_bf16 v[172:175], a[100:103], a[52:55], v[172:175]
ds_read_b64_tr_b16 a[92:93], v6 offset:57344
v_mfma_f32_16x16x32_bf16 v[172:175], a[96:99], a[48:51], v[172:175]
ds_read_b64_tr_b16 a[94:95], v6 offset:58368
v_mfma_f32_16x16x32_bf16 v[164:167], a[96:99], a[40:43], v[164:167]
v_mfma_f32_16x16x32_bf16 v[164:167], a[100:103], a[44:47], v[164:167]
s_add_u32 m0, s76, 33792
v_mfma_f32_16x16x32_bf16 v[156:159], a[100:103], a[36:39], v[156:159]
s_add_u32 s64, s70, 8576
v_mfma_f32_16x16x32_bf16 v[156:159], a[96:99], a[32:35], v[156:159]
buffer_load_dwordx4 v13, s[32:35], s64 offen lds
v_mfma_f32_16x16x32_bf16 v[24:27], a[104:107], a[32:35], v[24:27]
ds_read_b64_tr_b16 a[96:97], v7 offset:49152
v_mfma_f32_16x16x32_bf16 v[24:27], a[108:111], a[36:39], v[24:27]
ds_read_b64_tr_b16 a[98:99], v7 offset:50176
v_mfma_f32_16x16x32_bf16 v[40:43], a[108:111], a[44:47], v[40:43]
ds_read_b64_tr_b16 a[100:101], v7 offset:57344
v_mfma_f32_16x16x32_bf16 v[40:43], a[104:107], a[40:43], v[40:43]
ds_read_b64_tr_b16 a[102:103], v7 offset:58368
v_mfma_f32_16x16x32_bf16 v[56:59], a[104:107], a[48:51], v[56:59]
s_add_u32 m0, s76, 34816
global_load_dwordx4 a[168:171], v19, s[22:23] offset:1024
v_mfma_f32_16x16x32_bf16 v[56:59], a[108:111], a[52:55], v[56:59]
s_add_u32 s64, s70, 16768
v_mfma_f32_16x16x32_bf16 v[72:75], a[108:111], a[60:63], v[72:75]
s_waitcnt vmcnt(14)
buffer_load_dwordx4 v12, s[32:35], s64 offen lds
v_mfma_f32_16x16x32_bf16 v[72:75], a[104:107], a[56:59], v[72:75]
ds_read_b64_tr_b16 a[104:105], v8 offset:49152
v_mfma_f32_16x16x32_bf16 v[136:139], a[112:115], a[56:59], v[136:139]
ds_read_b64_tr_b16 a[106:107], v8 offset:50176
v_mfma_f32_16x16x32_bf16 v[136:139], a[116:119], a[60:63], v[136:139]
ds_read_b64_tr_b16 a[108:109], v8 offset:57344
v_add_u32 v4, 0x8000, v4
v_mfma_f32_16x16x32_bf16 v[120:123], a[116:119], a[52:55], v[120:123]
ds_read_b64_tr_b16 a[110:111], v8 offset:58368
v_mfma_f32_16x16x32_bf16 v[120:123], a[112:115], a[48:51], v[120:123]
s_add_u32 m0, s76, 35840
ds_read_b128 a[0:3], v2 offset:0
v_mfma_f32_16x16x32_bf16 v[104:107], a[112:115], a[40:43], v[104:107]
s_add_u32 s64, s70, 24960
ds_read_b128 a[4:7], v3 offset:0
v_mfma_f32_16x16x32_bf16 v[104:107], a[116:119], a[44:47], v[104:107]
buffer_load_dwordx4 v13, s[32:35], s64 offen lds
v_mfma_f32_16x16x32_bf16 v[88:91], a[116:119], a[36:39], v[88:91]
ds_read_b128 a[8:11], v2 offset:2048
v_mfma_f32_16x16x32_bf16 v[88:91], a[112:115], a[32:35], v[88:91]
ds_read_b128 a[12:15], v3 offset:2048
v_mfma_f32_16x16x32_bf16 v[28:31], a[32:35], a[72:75], v[28:31]
ds_read_b128 a[16:19], v2 offset:4096
v_mfma_f32_16x16x32_bf16 v[28:31], a[36:39], a[76:79], v[28:31]
ds_read_b128 a[20:23], v3 offset:4096
v_add_u32 v5, 0x8000, v5
v_mfma_f32_16x16x32_bf16 v[44:47], a[44:47], a[76:79], v[44:47]
s_add_u32 m0, s76, 36864
ds_read_b128 a[24:27], v2 offset:6144
v_mfma_f32_16x16x32_bf16 v[44:47], a[40:43], a[72:75], v[44:47]
s_add_u32 s64, s70, 33152
ds_read_b128 a[28:31], v3 offset:6144
v_mfma_f32_16x16x32_bf16 v[60:63], a[48:51], a[72:75], v[60:63]
buffer_load_dwordx4 v12, s[32:35], s64 offen lds
v_mfma_f32_16x16x32_bf16 v[60:63], a[52:55], a[76:79], v[60:63]
ds_read_b64_tr_b16 a[112:113], v9 offset:49152
v_mfma_f32_16x16x32_bf16 v[76:79], a[60:63], a[76:79], v[76:79]
ds_read_b64_tr_b16 a[114:115], v9 offset:50176
v_mfma_f32_16x16x32_bf16 v[76:79], a[56:59], a[72:75], v[76:79]
s_waitcnt lgkmcnt(8)
ds_read_b64_tr_b16 a[116:117], v9 offset:57344
v_mfma_f32_16x16x32_bf16 v[140:143], a[56:59], a[80:83], v[140:143]
buffer_load_dword a252, v16, s[56:59], s81 offen
v_mfma_f32_16x16x32_bf16 v[140:143], a[60:63], a[84:87], v[140:143]
s_add_u32 m0, s76, 37888
ds_read_b64_tr_b16 a[118:119], v9 offset:58368
v_add_u32 v6, 0x8000, v6
v_mfma_f32_16x16x32_bf16 v[124:127], a[52:55], a[84:87], v[124:127]
s_add_u32 s64, s70, 41344
ds_read_b64_tr_b16 a[72:73], v10 offset:49152
v_mfma_f32_16x16x32_bf16 v[124:127], a[48:51], a[80:83], v[124:127]
buffer_load_dwordx4 v13, s[32:35], s64 offen lds
v_mfma_f32_16x16x32_bf16 v[108:111], a[40:43], a[80:83], v[108:111]
ds_read_b64_tr_b16 a[74:75], v10 offset:50176
v_mfma_f32_16x16x32_bf16 v[108:111], a[44:47], a[84:87], v[108:111]
ds_read_b64_tr_b16 a[76:77], v10 offset:57344
v_mfma_f32_16x16x32_bf16 v[92:95], a[36:39], a[84:87], v[92:95]
ds_read_b64_tr_b16 a[78:79], v10 offset:58368
v_mfma_f32_16x16x32_bf16 v[92:95], a[32:35], a[80:83], v[92:95]
ds_read_b64_tr_b16 a[80:81], v11 offset:49152
v_mfma_f32_16x16x32_bf16 v[32:35], a[32:35], a[88:91], v[32:35]
s_add_u32 m0, s76, 38912
global_load_dwordx4 a[156:159], v18, s[4:5] offset:1536
v_mfma_f32_16x16x32_bf16 v[32:35], a[36:39], a[92:95], v[32:35]
s_add_u32 s64, s70, 49536
ds_read_b64_tr_b16 a[82:83], v11 offset:50176
v_add_u32 v7, 0x8000, v7
v_mfma_f32_16x16x32_bf16 v[48:51], a[44:47], a[92:95], v[48:51]
buffer_load_dwordx4 v12, s[32:35], s64 offen lds
v_mfma_f32_16x16x32_bf16 v[48:51], a[40:43], a[88:91], v[48:51]
ds_read_b64_tr_b16 a[84:85], v11 offset:57344
v_mfma_f32_16x16x32_bf16 v[64:67], a[48:51], a[88:91], v[64:67]
ds_read_b64_tr_b16 a[86:87], v11 offset:58368
v_mfma_f32_16x16x32_bf16 v[64:67], a[52:55], a[92:95], v[64:67]
v_mfma_f32_16x16x32_bf16 v[80:83], a[60:63], a[92:95], v[80:83]
v_mfma_f32_16x16x32_bf16 v[80:83], a[56:59], a[88:91], v[80:83]
s_add_u32 m0, s76, 39936
v_mfma_f32_16x16x32_bf16 v[144:147], a[56:59], a[96:99], v[144:147]
s_add_u32 s64, s70, 57728
v_mfma_f32_16x16x32_bf16 v[144:147], a[60:63], a[100:103], v[144:147]
buffer_load_dwordx4 v13, s[32:35], s64 offen lds
v_mfma_f32_16x16x32_bf16 v[128:131], a[52:55], a[100:103], v[128:131]
v_add_u32 v8, 0x8000, v8
v_mfma_f32_16x16x32_bf16 v[128:131], a[48:51], a[96:99], v[128:131]
v_mfma_f32_16x16x32_bf16 v[112:115], a[40:43], a[96:99], v[112:115]
v_mfma_f32_16x16x32_bf16 v[112:115], a[44:47], a[100:103], v[112:115]
v_mfma_f32_16x16x32_bf16 v[96:99], a[36:39], a[100:103], v[96:99]
v_add_u32 v9, 0x8000, v9
v_add_u32 v10, 0x8000, v10
v_mfma_f32_16x16x32_bf16 v[96:99], a[32:35], a[96:99], v[96:99]
v_add_u32 v11, 0x8000, v11
v_mfma_f32_16x16x32_bf16 v[36:39], a[32:35], a[104:107], v[36:39]
v_mfma_f32_16x16x32_bf16 v[36:39], a[36:39], a[108:111], v[36:39]
v_mfma_f32_16x16x32_bf16 v[52:55], a[44:47], a[108:111], v[52:55]
s_waitcnt lgkmcnt(0)
s_barrier
v_mfma_f32_16x16x32_bf16 v[52:55], a[40:43], a[104:107], v[52:55]
s_add_u32 m0, s77, 98304
ds_read_b64_tr_b16 a[88:89], v4 offset:32768
v_mfma_f32_16x16x32_bf16 v[68:71], a[48:51], a[104:107], v[68:71]
s_add_u32 s64, s71, 2097152
ds_read_b64_tr_b16 a[90:91], v4 offset:33792
v_mfma_f32_16x16x32_bf16 v[68:71], a[52:55], a[108:111], v[68:71]
buffer_load_dwordx4 v14, s[36:39], s64 offen lds
v_mfma_f32_16x16x32_bf16 v[84:87], a[60:63], a[108:111], v[84:87]
ds_read_b64_tr_b16 a[92:93], v4 offset:40960
v_mfma_f32_16x16x32_bf16 v[84:87], a[56:59], a[104:107], v[84:87]
ds_read_b64_tr_b16 a[94:95], v4 offset:41984
v_mfma_f32_16x16x32_bf16 v[148:151], a[56:59], a[112:115], v[148:151]
ds_read_b64_tr_b16 a[96:97], v5 offset:32768
v_mfma_f32_16x16x32_bf16 v[148:151], a[60:63], a[116:119], v[148:151]
ds_read_b64_tr_b16 a[98:99], v5 offset:33792
v_mfma_f32_16x16x32_bf16 v[132:135], a[52:55], a[116:119], v[132:135]
ds_read_b64_tr_b16 a[100:101], v5 offset:40960
v_mfma_f32_16x16x32_bf16 v[132:135], a[48:51], a[112:115], v[132:135]
s_add_u32 m0, s77, 99328
ds_read_b64_tr_b16 a[102:103], v5 offset:41984
v_mfma_f32_16x16x32_bf16 v[116:119], a[40:43], a[112:115], v[116:119]
s_add_u32 s64, s71, 2129920
global_load_dwordx4 a[172:175], v19, s[22:23] offset:1536
v_mfma_f32_16x16x32_bf16 v[116:119], a[44:47], a[116:119], v[116:119]
buffer_load_dwordx4 v14, s[36:39], s64 offen lds
v_mfma_f32_16x16x32_bf16 v[100:103], a[36:39], a[116:119], v[100:103]
buffer_load_dword a252, v1, s[60:63], s82 offen
v_mfma_f32_16x16x32_bf16 v[100:103], a[32:35], a[112:115], v[100:103]
ds_read_b64_tr_b16 a[104:105], v6 offset:32768
v_mfma_f32_16x16x32_bf16 v[248:251], a[32:35], a[72:75], v[248:251]
ds_read_b64_tr_b16 a[106:107], v6 offset:33792
v_mfma_f32_16x16x32_bf16 v[248:251], a[36:39], a[76:79], v[248:251]
ds_read_b64_tr_b16 a[108:109], v6 offset:40960
v_mfma_f32_16x16x32_bf16 v[252:255], a[44:47], a[76:79], v[252:255]
ds_read_b64_tr_b16 a[110:111], v6 offset:41984
v_mfma_f32_16x16x32_bf16 v[252:255], a[40:43], a[72:75], v[252:255]
s_add_u32 m0, s77, 100352
ds_read_b64_tr_b16 a[112:113], v7 offset:32768
v_mfma_f32_16x16x32_bf16 a[120:123], a[48:51], a[72:75], a[120:123]
s_add_u32 s64, s71, 2162688
ds_read_b64_tr_b16 a[114:115], v7 offset:33792
v_mfma_f32_16x16x32_bf16 a[120:123], a[52:55], a[76:79], a[120:123]
buffer_load_dwordx4 v15, s[36:39], s64 offen lds
v_mfma_f32_16x16x32_bf16 a[124:127], a[60:63], a[76:79], a[124:127]
ds_read_b64_tr_b16 a[116:117], v7 offset:40960
v_mfma_f32_16x16x32_bf16 a[124:127], a[56:59], a[72:75], a[124:127]
ds_read_b64_tr_b16 a[118:119], v7 offset:41984
v_mfma_f32_16x16x32_bf16 a[128:131], a[56:59], a[80:83], a[128:131]
ds_read_b64_tr_b16 a[72:73], v8 offset:32768
v_mfma_f32_16x16x32_bf16 a[128:131], a[60:63], a[84:87], a[128:131]
ds_read_b64_tr_b16 a[74:75], v8 offset:33792
v_mfma_f32_16x16x32_bf16 a[132:135], a[52:55], a[84:87], a[132:135]
ds_read_b64_tr_b16 a[76:77], v8 offset:40960
v_mfma_f32_16x16x32_bf16 a[132:135], a[48:51], a[80:83], a[132:135]
s_add_u32 m0, s77, 101376
ds_read_b64_tr_b16 a[78:79], v8 offset:41984
v_mfma_f32_16x16x32_bf16 a[136:139], a[40:43], a[80:83], a[136:139]
s_add_u32 s64, s71, 2195456
v_mfma_f32_16x16x32_bf16 a[136:139], a[44:47], a[84:87], a[136:139]
buffer_load_dwordx4 v15, s[36:39], s64 offen lds
v_mfma_f32_16x16x32_bf16 a[140:143], a[36:39], a[84:87], a[140:143]
v_mfma_f32_16x16x32_bf16 a[140:143], a[32:35], a[80:83], a[140:143]
s_waitcnt lgkmcnt(6)
ds_read_b64_tr_b16 a[80:81], v9 offset:32768
v_mfma_f32_16x16x32_bf16 v[184:187], a[88:91], a[0:3], v[184:187]
ds_read_b64_tr_b16 a[82:83], v9 offset:33792
v_mfma_f32_16x16x32_bf16 v[184:187], a[92:95], a[4:7], v[184:187]
ds_read_b64_tr_b16 a[84:85], v9 offset:40960
v_mfma_f32_16x16x32_bf16 v[192:195], a[92:95], a[12:15], v[192:195]
ds_read_b64_tr_b16 a[86:87], v9 offset:41984
v_mfma_f32_16x16x32_bf16 v[192:195], a[88:91], a[8:11], v[192:195]
s_add_u32 m0, s77, 114688
s_add_u32 s17, s78, .-L_pc+6144
v_mfma_f32_16x16x32_bf16 v[200:203], a[88:91], a[16:19], v[200:203]
s_add_u32 s64, s71, 2097152
buffer_load_dword a252, v16, s[88:91], s17 offen
v_mfma_f32_16x16x32_bf16 v[200:203], a[92:95], a[20:23], v[200:203]
buffer_load_dwordx4 v14, s[40:43], s64 offen lds
v_mfma_f32_16x16x32_bf16 v[208:211], a[92:95], a[28:31], v[208:211]
v_mfma_f32_16x16x32_bf16 v[208:211], a[88:91], a[24:27], v[208:211]
ds_read_b64_tr_b16 a[88:89], v10 offset:32768
v_mfma_f32_16x16x32_bf16 v[212:215], a[96:99], a[24:27], v[212:215]
ds_read_b64_tr_b16 a[90:91], v10 offset:33792
v_mfma_f32_16x16x32_bf16 v[212:215], a[100:103], a[28:31], v[212:215]
ds_read_b64_tr_b16 a[92:93], v10 offset:40960
v_mfma_f32_16x16x32_bf16 v[204:207], a[100:103], a[20:23], v[204:207]
ds_read_b64_tr_b16 a[94:95], v10 offset:41984
v_mfma_f32_16x16x32_bf16 v[204:207], a[96:99], a[16:19], v[204:207]
s_add_u32 m0, s77, 115712
v_mfma_f32_16x16x32_bf16 v[196:199], a[96:99], a[8:11], v[196:199]
s_add_u32 s64, s71, 2129920
v_mfma_f32_16x16x32_bf16 v[196:199], a[100:103], a[12:15], v[196:199]
buffer_load_dwordx4 v14, s[40:43], s64 offen lds
v_mfma_f32_16x16x32_bf16 v[188:191], a[100:103], a[4:7], v[188:191]
v_mfma_f32_16x16x32_bf16 v[188:191], a[96:99], a[0:3], v[188:191]
s_add_u32 s81, s81, 1048576
ds_read_b64_tr_b16 a[96:97], v11 offset:32768
v_mfma_f32_16x16x32_bf16 v[216:219], a[104:107], a[0:3], v[216:219]
buffer_load_dword a252, v16, s[56:59], s81 offen
v_mfma_f32_16x16x32_bf16 v[216:219], a[108:111], a[4:7], v[216:219]
ds_read_b64_tr_b16 a[98:99], v11 offset:33792
v_mfma_f32_16x16x32_bf16 v[224:227], a[108:111], a[12:15], v[224:227]
ds_read_b64_tr_b16 a[100:101], v11 offset:40960
v_mfma_f32_16x16x32_bf16 v[224:227], a[104:107], a[8:11], v[224:227]
s_add_u32 m0, s77, 116736
ds_read_b64_tr_b16 a[102:103], v11 offset:41984
v_mfma_f32_16x16x32_bf16 v[232:235], a[104:107], a[16:19], v[232:235]
s_add_u32 s64, s71, 2162688
buffer_store_dword v21, v20, s[44:47], s69 offen sc1
v_mfma_f32_16x16x32_bf16 v[232:235], a[108:111], a[20:23], v[232:235]
buffer_load_dwordx4 v15, s[40:43], s64 offen lds
v_mfma_f32_16x16x32_bf16 v[240:243], a[108:111], a[28:31], v[240:243]
v_mfma_f32_16x16x32_bf16 v[240:243], a[104:107], a[24:27], v[240:243]
ds_read_b64_tr_b16 a[104:105], v4 offset:49152
v_mfma_f32_16x16x32_bf16 v[244:247], a[112:115], a[24:27], v[244:247]
s_waitcnt lgkmcnt(5)
ds_read_b64_tr_b16 a[106:107], v4 offset:50176
v_mfma_f32_16x16x32_bf16 v[244:247], a[116:119], a[28:31], v[244:247]
ds_read_b64_tr_b16 a[108:109], v4 offset:57344
v_mfma_f32_16x16x32_bf16 v[236:239], a[116:119], a[20:23], v[236:239]
ds_read_b64_tr_b16 a[110:111], v4 offset:58368
v_mfma_f32_16x16x32_bf16 v[236:239], a[112:115], a[16:19], v[236:239]
s_add_u32 m0, s77, 117760
v_mfma_f32_16x16x32_bf16 v[228:231], a[112:115], a[8:11], v[228:231]
s_add_u32 s64, s71, 2195456
v_mfma_f32_16x16x32_bf16 v[228:231], a[116:119], a[12:15], v[228:231]
buffer_load_dwordx4 v15, s[40:43], s64 offen lds
v_mfma_f32_16x16x32_bf16 v[220:223], a[116:119], a[4:7], v[220:223]
v_mfma_f32_16x16x32_bf16 v[220:223], a[112:115], a[0:3], v[220:223]
ds_read_b64_tr_b16 a[112:113], v5 offset:49152
v_mfma_f32_16x16x32_bf16 v[152:155], a[72:75], a[0:3], v[152:155]
ds_read_b64_tr_b16 a[114:115], v5 offset:50176
v_mfma_f32_16x16x32_bf16 v[152:155], a[76:79], a[4:7], v[152:155]
ds_read_b64_tr_b16 a[116:117], v5 offset:57344
v_mfma_f32_16x16x32_bf16 v[160:163], a[76:79], a[12:15], v[160:163]
ds_read_b64_tr_b16 a[118:119], v5 offset:58368
v_mfma_f32_16x16x32_bf16 v[160:163], a[72:75], a[8:11], v[160:163]
v_mfma_f32_16x16x32_bf16 v[168:171], a[72:75], a[16:19], v[168:171]
v_mfma_f32_16x16x32_bf16 v[168:171], a[76:79], a[20:23], v[168:171]
v_mfma_f32_16x16x32_bf16 v[176:179], a[76:79], a[28:31], v[176:179]
s_add_u32 m0, s76, 0
v_mfma_f32_16x16x32_bf16 v[176:179], a[72:75], a[24:27], v[176:179]
s_add_u32 s64, s70, 512
ds_read_b64_tr_b16 a[72:73], v6 offset:49152
v_mfma_f32_16x16x32_bf16 v[180:183], a[80:83], a[24:27], v[180:183]
buffer_load_dwordx4 v12, s[32:35], s64 offen lds
v_mfma_f32_16x16x32_bf16 v[180:183], a[84:87], a[28:31], v[180:183]
ds_read_b64_tr_b16 a[74:75], v6 offset:50176
v_mfma_f32_16x16x32_bf16 v[172:175], a[84:87], a[20:23], v[172:175]
ds_read_b64_tr_b16 a[76:77], v6 offset:57344
v_mfma_f32_16x16x32_bf16 v[172:175], a[80:83], a[16:19], v[172:175]
ds_read_b64_tr_b16 a[78:79], v6 offset:58368
v_mfma_f32_16x16x32_bf16 v[164:167], a[80:83], a[8:11], v[164:167]
v_mfma_f32_16x16x32_bf16 v[164:167], a[84:87], a[12:15], v[164:167]
s_add_u32 m0, s76, 1024
v_mfma_f32_16x16x32_bf16 v[156:159], a[84:87], a[4:7], v[156:159]
s_add_u32 s64, s70, 8704
v_mfma_f32_16x16x32_bf16 v[156:159], a[80:83], a[0:3], v[156:159]
buffer_load_dwordx4 v13, s[32:35], s64 offen lds
v_mfma_f32_16x16x32_bf16 v[24:27], a[88:91], a[0:3], v[24:27]
ds_read_b64_tr_b16 a[80:81], v7 offset:49152
v_mfma_f32_16x16x32_bf16 v[24:27], a[92:95], a[4:7], v[24:27]
ds_read_b64_tr_b16 a[82:83], v7 offset:50176
v_mfma_f32_16x16x32_bf16 v[40:43], a[92:95], a[12:15], v[40:43]
ds_read_b64_tr_b16 a[84:85], v7 offset:57344
v_mfma_f32_16x16x32_bf16 v[40:43], a[88:91], a[8:11], v[40:43]
s_add_u32 s82, s82, 1048576
ds_read_b64_tr_b16 a[86:87], v7 offset:58368
v_mfma_f32_16x16x32_bf16 v[56:59], a[88:91], a[16:19], v[56:59]
s_add_u32 m0, s76, 2048
buffer_load_dword a252, v1, s[60:63], s82 offen
v_mfma_f32_16x16x32_bf16 v[56:59], a[92:95], a[20:23], v[56:59]
s_add_u32 s64, s70, 16896
v_mfma_f32_16x16x32_bf16 v[72:75], a[92:95], a[28:31], v[72:75]
s_waitcnt vmcnt(16)
buffer_load_dwordx4 v12, s[32:35], s64 offen lds
v_mfma_f32_16x16x32_bf16 v[72:75], a[88:91], a[24:27], v[72:75]
s_waitcnt lgkmcnt(4)
ds_read_b64_tr_b16 a[88:89], v8 offset:49152
v_mfma_f32_16x16x32_bf16 v[136:139], a[96:99], a[24:27], v[136:139]
ds_read_b64_tr_b16 a[90:91], v8 offset:50176
v_mfma_f32_16x16x32_bf16 v[136:139], a[100:103], a[28:31], v[136:139]
ds_read_b64_tr_b16 a[92:93], v8 offset:57344
v_subrev_u32 v4, 0x8000, v4
v_mfma_f32_16x16x32_bf16 v[120:123], a[100:103], a[20:23], v[120:123]
ds_read_b64_tr_b16 a[94:95], v8 offset:58368
v_mfma_f32_16x16x32_bf16 v[120:123], a[96:99], a[16:19], v[120:123]
s_add_u32 m0, s76, 3072
ds_read_b128 a[32:35], v2 offset:32768
v_mfma_f32_16x16x32_bf16 v[104:107], a[96:99], a[8:11], v[104:107]
s_add_u32 s64, s70, 25088
ds_read_b128 a[36:39], v3 offset:32768
v_mfma_f32_16x16x32_bf16 v[104:107], a[100:103], a[12:15], v[104:107]
buffer_load_dwordx4 v13, s[32:35], s64 offen lds
v_mfma_f32_16x16x32_bf16 v[88:91], a[100:103], a[4:7], v[88:91]
ds_read_b128 a[40:43], v2 offset:34816
v_mfma_f32_16x16x32_bf16 v[88:91], a[96:99], a[0:3], v[88:91]
ds_read_b128 a[44:47], v3 offset:34816
v_mfma_f32_16x16x32_bf16 v[28:31], a[0:3], a[104:107], v[28:31]
ds_read_b128 a[48:51], v2 offset:36864
v_mfma_f32_16x16x32_bf16 v[28:31], a[4:7], a[108:111], v[28:31]
ds_read_b128 a[52:55], v3 offset:36864
v_subrev_u32 v5, 0x8000, v5
v_mfma_f32_16x16x32_bf16 v[44:47], a[12:15], a[108:111], v[44:47]
s_add_u32 m0, s76, 4096
ds_read_b128 a[56:59], v2 offset:38912
v_mfma_f32_16x16x32_bf16 v[44:47], a[8:11], a[104:107], v[44:47]
s_add_u32 s64, s70, 33280
ds_read_b128 a[60:63], v3 offset:38912
v_mfma_f32_16x16x32_bf16 v[60:63], a[16:19], a[104:107], v[60:63]
buffer_load_dwordx4 v12, s[32:35], s64 offen lds
v_mfma_f32_16x16x32_bf16 v[60:63], a[20:23], a[108:111], v[60:63]
ds_read_b64_tr_b16 a[96:97], v9 offset:49152
v_mfma_f32_16x16x32_bf16 v[76:79], a[28:31], a[108:111], v[76:79]
ds_read_b64_tr_b16 a[98:99], v9 offset:50176
v_mfma_f32_16x16x32_bf16 v[76:79], a[24:27], a[104:107], v[76:79]
ds_read_b64_tr_b16 a[100:101], v9 offset:57344
v_mfma_f32_16x16x32_bf16 v[140:143], a[24:27], a[112:115], v[140:143]
ds_read_b64_tr_b16 a[102:103], v9 offset:58368
v_mfma_f32_16x16x32_bf16 v[140:143], a[28:31], a[116:119], v[140:143]
s_add_u32 m0, s76, 5120
ds_read_b64_tr_b16 a[104:105], v10 offset:49152
v_subrev_u32 v6, 0x8000, v6
v_mfma_f32_16x16x32_bf16 v[124:127], a[20:23], a[116:119], v[124:127]
s_add_u32 s64, s70, 41472
ds_read_b64_tr_b16 a[106:107], v10 offset:50176
v_mfma_f32_16x16x32_bf16 v[124:127], a[16:19], a[112:115], v[124:127]
buffer_load_dwordx4 v13, s[32:35], s64 offen lds
v_mfma_f32_16x16x32_bf16 v[108:111], a[8:11], a[112:115], v[108:111]
ds_read_b64_tr_b16 a[108:109], v10 offset:57344
v_mfma_f32_16x16x32_bf16 v[108:111], a[12:15], a[116:119], v[108:111]
ds_read_b64_tr_b16 a[110:111], v10 offset:58368
v_mfma_f32_16x16x32_bf16 v[92:95], a[4:7], a[116:119], v[92:95]
v_mfma_f32_16x16x32_bf16 v[92:95], a[0:3], a[112:115], v[92:95]
ds_read_b64_tr_b16 a[112:113], v11 offset:49152
v_mfma_f32_16x16x32_bf16 v[32:35], a[0:3], a[72:75], v[32:35]
s_add_u32 m0, s76, 6144
ds_read_b64_tr_b16 a[114:115], v11 offset:50176
v_mfma_f32_16x16x32_bf16 v[32:35], a[4:7], a[76:79], v[32:35]
s_add_u32 s64, s70, 49664
ds_read_b64_tr_b16 a[116:117], v11 offset:57344
v_subrev_u32 v7, 0x8000, v7
v_mfma_f32_16x16x32_bf16 v[48:51], a[12:15], a[76:79], v[48:51]
buffer_load_dwordx4 v12, s[32:35], s64 offen lds
v_mfma_f32_16x16x32_bf16 v[48:51], a[8:11], a[72:75], v[48:51]
ds_read_b64_tr_b16 a[118:119], v11 offset:58368
v_mfma_f32_16x16x32_bf16 v[64:67], a[16:19], a[72:75], v[64:67]
v_mfma_f32_16x16x32_bf16 v[64:67], a[20:23], a[76:79], v[64:67]
v_mfma_f32_16x16x32_bf16 v[80:83], a[28:31], a[76:79], v[80:83]
v_mfma_f32_16x16x32_bf16 v[80:83], a[24:27], a[72:75], v[80:83]
s_waitcnt lgkmcnt(4)
s_add_u32 m0, s76, 7168
s_add_u32 s81, s81, 1048576
v_mfma_f32_16x16x32_bf16 v[144:147], a[24:27], a[80:83], v[144:147]
s_add_u32 s64, s70, 57856
buffer_load_dword a252, v16, s[56:59], s81 offen
v_mfma_f32_16x16x32_bf16 v[144:147], a[28:31], a[84:87], v[144:147]
buffer_load_dwordx4 v13, s[32:35], s64 offen lds
v_mfma_f32_16x16x32_bf16 v[128:131], a[20:23], a[84:87], v[128:131]
v_subrev_u32 v8, 0x8000, v8
v_mfma_f32_16x16x32_bf16 v[128:131], a[16:19], a[80:83], v[128:131]
v_mfma_f32_16x16x32_bf16 v[112:115], a[8:11], a[80:83], v[112:115]
v_mfma_f32_16x16x32_bf16 v[112:115], a[12:15], a[84:87], v[112:115]
v_mfma_f32_16x16x32_bf16 v[96:99], a[4:7], a[84:87], v[96:99]
v_subrev_u32 v9, 0x8000, v9
v_subrev_u32 v10, 0x8000, v10
v_mfma_f32_16x16x32_bf16 v[96:99], a[0:3], a[80:83], v[96:99]
v_subrev_u32 v11, 0x8000, v11
v_mfma_f32_16x16x32_bf16 v[36:39], a[0:3], a[88:91], v[36:39]
v_mfma_f32_16x16x32_bf16 v[36:39], a[4:7], a[92:95], v[36:39]
v_mfma_f32_16x16x32_bf16 v[52:55], a[12:15], a[92:95], v[52:55]
s_waitcnt lgkmcnt(0)
s_barrier
v_mfma_f32_16x16x32_bf16 v[52:55], a[8:11], a[88:91], v[52:55]
s_add_u32 m0, s77, 131072
ds_read_b64_tr_b16 a[72:73], v4 offset:0
v_mfma_f32_16x16x32_bf16 v[68:71], a[16:19], a[88:91], v[68:71]
s_add_u32 s64, s71, 2621440
ds_read_b64_tr_b16 a[74:75], v4 offset:1024
v_mfma_f32_16x16x32_bf16 v[68:71], a[20:23], a[92:95], v[68:71]
buffer_load_dwordx4 v14, s[36:39], s64 offen lds
v_mfma_f32_16x16x32_bf16 v[84:87], a[28:31], a[92:95], v[84:87]
ds_read_b64_tr_b16 a[76:77], v4 offset:8192
v_mfma_f32_16x16x32_bf16 v[84:87], a[24:27], a[88:91], v[84:87]
ds_read_b64_tr_b16 a[78:79], v4 offset:9216
v_mfma_f32_16x16x32_bf16 v[148:151], a[24:27], a[96:99], v[148:151]
ds_read_b64_tr_b16 a[80:81], v5 offset:0
v_mfma_f32_16x16x32_bf16 v[148:151], a[28:31], a[100:103], v[148:151]
ds_read_b64_tr_b16 a[82:83], v5 offset:1024
v_mfma_f32_16x16x32_bf16 v[132:135], a[20:23], a[100:103], v[132:135]
ds_read_b64_tr_b16 a[84:85], v5 offset:8192
v_mfma_f32_16x16x32_bf16 v[132:135], a[16:19], a[96:99], v[132:135]
s_add_u32 m0, s77, 132096
ds_read_b64_tr_b16 a[86:87], v5 offset:9216
v_mfma_f32_16x16x32_bf16 v[116:119], a[8:11], a[96:99], v[116:119]
s_add_u32 s64, s71, 2654208
ds_read_b64_tr_b16 a[88:89], v6 offset:0
v_mfma_f32_16x16x32_bf16 v[116:119], a[12:15], a[100:103], v[116:119]
buffer_load_dwordx4 v14, s[36:39], s64 offen lds
v_mfma_f32_16x16x32_bf16 v[100:103], a[4:7], a[100:103], v[100:103]
ds_read_b64_tr_b16 a[90:91], v6 offset:1024
v_mfma_f32_16x16x32_bf16 v[100:103], a[0:3], a[96:99], v[100:103]
ds_read_b64_tr_b16 a[92:93], v6 offset:8192
v_mfma_f32_16x16x32_bf16 v[248:251], a[0:3], a[104:107], v[248:251]
ds_read_b64_tr_b16 a[94:95], v6 offset:9216
v_mfma_f32_16x16x32_bf16 v[248:251], a[4:7], a[108:111], v[248:251]
ds_read_b64_tr_b16 a[96:97], v7 offset:0
v_mfma_f32_16x16x32_bf16 v[252:255], a[12:15], a[108:111], v[252:255]
ds_read_b64_tr_b16 a[98:99], v7 offset:1024
v_mfma_f32_16x16x32_bf16 v[252:255], a[8:11], a[104:107], v[252:255]
s_add_u32 m0, s77, 133120
ds_read_b64_tr_b16 a[100:101], v7 offset:8192
v_mfma_f32_16x16x32_bf16 a[120:123], a[16:19], a[104:107], a[120:123]
s_add_u32 s64, s71, 2686976
ds_read_b64_tr_b16 a[102:103], v7 offset:9216
v_mfma_f32_16x16x32_bf16 a[120:123], a[20:23], a[108:111], a[120:123]
buffer_load_dwordx4 v15, s[36:39], s64 offen lds
v_mfma_f32_16x16x32_bf16 a[124:127], a[28:31], a[108:111], a[124:127]
v_mfma_f32_16x16x32_bf16 a[124:127], a[24:27], a[104:107], a[124:127]
ds_read_b64_tr_b16 a[104:105], v8 offset:0
v_mfma_f32_16x16x32_bf16 a[128:131], a[24:27], a[112:115], a[128:131]
ds_read_b64_tr_b16 a[106:107], v8 offset:1024
v_mfma_f32_16x16x32_bf16 a[128:131], a[28:31], a[116:119], a[128:131]
ds_read_b64_tr_b16 a[108:109], v8 offset:8192
v_mfma_f32_16x16x32_bf16 a[132:135], a[20:23], a[116:119], a[132:135]
ds_read_b64_tr_b16 a[110:111], v8 offset:9216
v_mfma_f32_16x16x32_bf16 a[132:135], a[16:19], a[112:115], a[132:135]
s_add_u32 m0, s77, 134144
s_add_u32 s81, s81, 1048576
v_mfma_f32_16x16x32_bf16 a[136:139], a[8:11], a[112:115], a[136:139]
s_add_u32 s64, s71, 2719744
buffer_load_dword a252, v16, s[56:59], s81 offen
v_mfma_f32_16x16x32_bf16 a[136:139], a[12:15], a[116:119], a[136:139]
buffer_load_dwordx4 v15, s[36:39], s64 offen lds
v_mfma_f32_16x16x32_bf16 a[140:143], a[4:7], a[116:119], a[140:143]
v_mfma_f32_16x16x32_bf16 a[140:143], a[0:3], a[112:115], a[140:143]
s_waitcnt lgkmcnt(4)
ds_read_b64_tr_b16 a[112:113], v9 offset:0
v_mfma_f32_16x16x32_bf16 v[184:187], a[72:75], a[32:35], v[184:187]
ds_read_b64_tr_b16 a[114:115], v9 offset:1024
v_mov_b32 v17, 0
v_mfma_f32_16x16x32_bf16 v[184:187], a[76:79], a[36:39], v[184:187]
ds_read_b64_tr_b16 a[116:117], v9 offset:8192
v_accvgpr_read_b32 v19, a144
v_mfma_f32_16x16x32_bf16 v[192:195], a[76:79], a[44:47], v[192:195]
ds_read_b64_tr_b16 a[118:119], v9 offset:9216
v_accvgpr_read_b32 v21, a160
v_mfma_f32_16x16x32_bf16 v[192:195], a[72:75], a[40:43], v[192:195]
s_add_u32 m0, s77, 147456
v_lshlrev_b32 v18, 16, v19
v_and_b32 v19, 0xffff0000, v19
v_mfma_f32_16x16x32_bf16 v[200:203], a[72:75], a[48:51], v[200:203]
s_add_u32 s64, s71, 2621440
v_lshlrev_b32 v20, 16, v21
v_and_b32 v21, 0xffff0000, v21
v_mfma_f32_16x16x32_bf16 v[200:203], a[76:79], a[52:55], v[200:203]
buffer_load_dwordx4 v14, s[40:43], s64 offen lds
v_mfma_f32_16x16x32_bf16 v[208:211], a[76:79], a[60:63], v[208:211]
v_mul_f32 v18, v18, v20
v_mul_f32 v19, v19, v21
v_mfma_f32_16x16x32_bf16 v[208:211], a[72:75], a[56:59], v[208:211]
ds_read_b64_tr_b16 a[72:73], v10 offset:0
v_cvt_pk_bf16_f32 v18, v18, v19
v_mfma_f32_16x16x32_bf16 v[212:215], a[80:83], a[56:59], v[212:215]
ds_read_b64_tr_b16 a[74:75], v10 offset:1024
v_lshlrev_b32 v19, 16, v18
v_mfma_f32_16x16x32_bf16 v[212:215], a[84:87], a[60:63], v[212:215]
ds_read_b64_tr_b16 a[76:77], v10 offset:8192
v_and_b32 v18, 0xffff0000, v18
v_mfma_f32_16x16x32_bf16 v[204:207], a[84:87], a[52:55], v[204:207]
ds_read_b64_tr_b16 a[78:79], v10 offset:9216
v_add_f32 v17, v17, v19
v_mfma_f32_16x16x32_bf16 v[204:207], a[80:83], a[48:51], v[204:207]
s_add_u32 m0, s77, 148480
v_add_f32 v17, v17, v18
v_accvgpr_read_b32 v19, a145
v_mfma_f32_16x16x32_bf16 v[196:199], a[80:83], a[40:43], v[196:199]
s_add_u32 s64, s71, 2654208
v_accvgpr_read_b32 v21, a161
v_lshlrev_b32 v18, 16, v19
v_mfma_f32_16x16x32_bf16 v[196:199], a[84:87], a[44:47], v[196:199]
buffer_load_dwordx4 v14, s[40:43], s64 offen lds
v_mfma_f32_16x16x32_bf16 v[188:191], a[84:87], a[36:39], v[188:191]
v_and_b32 v19, 0xffff0000, v19
v_lshlrev_b32 v20, 16, v21
v_mfma_f32_16x16x32_bf16 v[188:191], a[80:83], a[32:35], v[188:191]
ds_read_b64_tr_b16 a[80:81], v11 offset:0
v_and_b32 v21, 0xffff0000, v21
v_mfma_f32_16x16x32_bf16 v[216:219], a[88:91], a[32:35], v[216:219]
ds_read_b64_tr_b16 a[82:83], v11 offset:1024
v_mul_f32 v18, v18, v20
v_mfma_f32_16x16x32_bf16 v[216:219], a[92:95], a[36:39], v[216:219]
ds_read_b64_tr_b16 a[84:85], v11 offset:8192
v_mul_f32 v19, v19, v21
v_mfma_f32_16x16x32_bf16 v[224:227], a[92:95], a[44:47], v[224:227]
ds_read_b64_tr_b16 a[86:87], v11 offset:9216
v_cvt_pk_bf16_f32 v18, v18, v19
v_mfma_f32_16x16x32_bf16 v[224:227], a[88:91], a[40:43], v[224:227]
s_add_u32 m0, s77, 149504
v_lshlrev_b32 v19, 16, v18
v_and_b32 v18, 0xffff0000, v18
v_mfma_f32_16x16x32_bf16 v[232:235], a[88:91], a[48:51], v[232:235]
s_add_u32 s64, s71, 2686976
v_add_f32 v17, v17, v19
v_add_f32 v17, v17, v18
v_mfma_f32_16x16x32_bf16 v[232:235], a[92:95], a[52:55], v[232:235]
buffer_load_dwordx4 v15, s[40:43], s64 offen lds
v_mfma_f32_16x16x32_bf16 v[240:243], a[92:95], a[60:63], v[240:243]
v_accvgpr_read_b32 v19, a146
v_accvgpr_read_b32 v21, a162
v_mfma_f32_16x16x32_bf16 v[240:243], a[88:91], a[56:59], v[240:243]
ds_read_b64_tr_b16 a[88:89], v4 offset:16384
v_lshlrev_b32 v18, 16, v19
v_mfma_f32_16x16x32_bf16 v[244:247], a[96:99], a[56:59], v[244:247]
ds_read_b64_tr_b16 a[90:91], v4 offset:17408
v_and_b32 v19, 0xffff0000, v19
v_mfma_f32_16x16x32_bf16 v[244:247], a[100:103], a[60:63], v[244:247]
ds_read_b64_tr_b16 a[92:93], v4 offset:24576
v_lshlrev_b32 v20, 16, v21
v_mfma_f32_16x16x32_bf16 v[236:239], a[100:103], a[52:55], v[236:239]
ds_read_b64_tr_b16 a[94:95], v4 offset:25600
v_and_b32 v21, 0xffff0000, v21
v_mfma_f32_16x16x32_bf16 v[236:239], a[96:99], a[48:51], v[236:239]
s_add_u32 m0, s77, 150528
v_mul_f32 v18, v18, v20
v_mul_f32 v19, v19, v21
v_mfma_f32_16x16x32_bf16 v[228:231], a[96:99], a[40:43], v[228:231]
s_add_u32 s64, s71, 2719744
v_cvt_pk_bf16_f32 v18, v18, v19
v_lshlrev_b32 v19, 16, v18
v_mfma_f32_16x16x32_bf16 v[228:231], a[100:103], a[44:47], v[228:231]
buffer_load_dwordx4 v15, s[40:43], s64 offen lds
v_mfma_f32_16x16x32_bf16 v[220:223], a[100:103], a[36:39], v[220:223]
v_and_b32 v18, 0xffff0000, v18
v_add_f32 v17, v17, v19
v_mfma_f32_16x16x32_bf16 v[220:223], a[96:99], a[32:35], v[220:223]
s_waitcnt lgkmcnt(4)
s_add_u32 s82, s82, 1048576
ds_read_b64_tr_b16 a[96:97], v5 offset:16384
v_add_f32 v17, v17, v18
v_mfma_f32_16x16x32_bf16 v[152:155], a[104:107], a[32:35], v[152:155]
buffer_load_dword a252, v1, s[60:63], s82 offen
v_mfma_f32_16x16x32_bf16 v[152:155], a[108:111], a[36:39], v[152:155]
ds_read_b64_tr_b16 a[98:99], v5 offset:17408
v_accvgpr_read_b32 v19, a147
v_mfma_f32_16x16x32_bf16 v[160:163], a[108:111], a[44:47], v[160:163]
ds_read_b64_tr_b16 a[100:101], v5 offset:24576
v_accvgpr_read_b32 v21, a163
v_mfma_f32_16x16x32_bf16 v[160:163], a[104:107], a[40:43], v[160:163]
ds_read_b64_tr_b16 a[102:103], v5 offset:25600
v_lshlrev_b32 v18, 16, v19
v_mfma_f32_16x16x32_bf16 v[168:171], a[104:107], a[48:51], v[168:171]
v_and_b32 v19, 0xffff0000, v19
v_lshlrev_b32 v20, 16, v21
v_mfma_f32_16x16x32_bf16 v[168:171], a[108:111], a[52:55], v[168:171]
v_and_b32 v21, 0xffff0000, v21
v_mul_f32 v18, v18, v20
v_mfma_f32_16x16x32_bf16 v[176:179], a[108:111], a[60:63], v[176:179]
s_add_u32 m0, s76, 32768
v_mul_f32 v19, v19, v21
v_cvt_pk_bf16_f32 v18, v18, v19
v_mfma_f32_16x16x32_bf16 v[176:179], a[104:107], a[56:59], v[176:179]
s_add_u32 s64, s70, 640
ds_read_b64_tr_b16 a[104:105], v6 offset:16384
v_lshlrev_b32 v19, 16, v18
v_mfma_f32_16x16x32_bf16 v[180:183], a[112:115], a[56:59], v[180:183]
buffer_load_dwordx4 v12, s[32:35], s64 offen lds
v_mfma_f32_16x16x32_bf16 v[180:183], a[116:119], a[60:63], v[180:183]
ds_read_b64_tr_b16 a[106:107], v6 offset:17408
v_and_b32 v18, 0xffff0000, v18
v_mfma_f32_16x16x32_bf16 v[172:175], a[116:119], a[52:55], v[172:175]
ds_read_b64_tr_b16 a[108:109], v6 offset:24576
v_add_f32 v17, v17, v19
v_mfma_f32_16x16x32_bf16 v[172:175], a[112:115], a[48:51], v[172:175]
ds_read_b64_tr_b16 a[110:111], v6 offset:25600
v_add_f32 v17, v17, v18
v_mfma_f32_16x16x32_bf16 v[164:167], a[112:115], a[40:43], v[164:167]
v_accvgpr_read_b32 v19, a148
v_accvgpr_read_b32 v21, a164
v_mfma_f32_16x16x32_bf16 v[164:167], a[116:119], a[44:47], v[164:167]
s_add_u32 m0, s76, 33792
v_lshlrev_b32 v18, 16, v19
v_and_b32 v19, 0xffff0000, v19
v_mfma_f32_16x16x32_bf16 v[156:159], a[116:119], a[36:39], v[156:159]
s_add_u32 s64, s70, 8832
v_lshlrev_b32 v20, 16, v21
v_and_b32 v21, 0xffff0000, v21
v_mfma_f32_16x16x32_bf16 v[156:159], a[112:115], a[32:35], v[156:159]
buffer_load_dwordx4 v13, s[32:35], s64 offen lds
v_mfma_f32_16x16x32_bf16 v[24:27], a[72:75], a[32:35], v[24:27]
ds_read_b64_tr_b16 a[112:113], v7 offset:16384
v_mul_f32 v18, v18, v20
v_mfma_f32_16x16x32_bf16 v[24:27], a[76:79], a[36:39], v[24:27]
ds_read_b64_tr_b16 a[114:115], v7 offset:17408
v_mul_f32 v19, v19, v21
v_mfma_f32_16x16x32_bf16 v[40:43], a[76:79], a[44:47], v[40:43]
ds_read_b64_tr_b16 a[116:117], v7 offset:24576
v_cvt_pk_bf16_f32 v18, v18, v19
v_mfma_f32_16x16x32_bf16 v[40:43], a[72:75], a[40:43], v[40:43]
ds_read_b64_tr_b16 a[118:119], v7 offset:25600
v_lshlrev_b32 v19, 16, v18
v_mfma_f32_16x16x32_bf16 v[56:59], a[72:75], a[48:51], v[56:59]
s_add_u32 m0, s76, 34816
v_and_b32 v18, 0xffff0000, v18
v_add_f32 v17, v17, v19
v_mfma_f32_16x16x32_bf16 v[56:59], a[76:79], a[52:55], v[56:59]
s_add_u32 s64, s70, 17024
v_add_f32 v17, v17, v18
v_accvgpr_read_b32 v19, a149
v_mfma_f32_16x16x32_bf16 v[72:75], a[76:79], a[60:63], v[72:75]
s_waitcnt vmcnt(12)
buffer_load_dwordx4 v12, s[32:35], s64 offen lds
v_mfma_f32_16x16x32_bf16 v[72:75], a[72:75], a[56:59], v[72:75]
ds_read_b64_tr_b16 a[72:73], v8 offset:16384
v_accvgpr_read_b32 v21, a165
v_mfma_f32_16x16x32_bf16 v[136:139], a[80:83], a[56:59], v[136:139]
ds_read_b64_tr_b16 a[74:75], v8 offset:17408
v_lshlrev_b32 v18, 16, v19
v_mfma_f32_16x16x32_bf16 v[136:139], a[84:87], a[60:63], v[136:139]
ds_read_b64_tr_b16 a[76:77], v8 offset:24576
v_and_b32 v19, 0xffff0000, v19
v_mfma_f32_16x16x32_bf16 v[120:123], a[84:87], a[52:55], v[120:123]
ds_read_b64_tr_b16 a[78:79], v8 offset:25600
v_lshlrev_b32 v20, 16, v21
v_mfma_f32_16x16x32_bf16 v[120:123], a[80:83], a[48:51], v[120:123]
s_add_u32 m0, s76, 35840
ds_read_b128 a[0:3], v2 offset:0
v_and_b32 v21, 0xffff0000, v21
v_mfma_f32_16x16x32_bf16 v[104:107], a[80:83], a[40:43], v[104:107]
s_add_u32 s64, s70, 25216
ds_read_b128 a[4:7], v3 offset:0
v_mul_f32 v18, v18, v20
v_mfma_f32_16x16x32_bf16 v[104:107], a[84:87], a[44:47], v[104:107]
buffer_load_dwordx4 v13, s[32:35], s64 offen lds
v_mfma_f32_16x16x32_bf16 v[88:91], a[84:87], a[36:39], v[88:91]
ds_read_b128 a[8:11], v2 offset:2048
v_mul_f32 v19, v19, v21
v_mfma_f32_16x16x32_bf16 v[88:91], a[80:83], a[32:35], v[88:91]
s_waitcnt lgkmcnt(7)
ds_read_b128 a[12:15], v3 offset:2048
v_cvt_pk_bf16_f32 v18, v18, v19
v_mfma_f32_16x16x32_bf16 v[28:31], a[32:35], a[88:91], v[28:31]
ds_read_b128 a[16:19], v2 offset:4096
v_lshlrev_b32 v19, 16, v18
v_mfma_f32_16x16x32_bf16 v[28:31], a[36:39], a[92:95], v[28:31]
ds_read_b128 a[20:23], v3 offset:4096
v_and_b32 v18, 0xffff0000, v18
v_mfma_f32_16x16x32_bf16 v[44:47], a[44:47], a[92:95], v[44:47]
s_add_u32 m0, s76, 36864
ds_read_b128 a[24:27], v2 offset:6144
v_add_f32 v17, v17, v19
v_mfma_f32_16x16x32_bf16 v[44:47], a[40:43], a[88:91], v[44:47]
s_add_u32 s64, s70, 33408
ds_read_b128 a[28:31], v3 offset:6144
v_add_f32 v17, v17, v18
v_mfma_f32_16x16x32_bf16 v[60:63], a[48:51], a[88:91], v[60:63]
s_add_u32 s81, s81, 1048576
buffer_load_dwordx4 v12, s[32:35], s64 offen lds
v_mfma_f32_16x16x32_bf16 v[60:63], a[52:55], a[92:95], v[60:63]
buffer_load_dword a252, v16, s[56:59], s81 offen
v_mfma_f32_16x16x32_bf16 v[76:79], a[60:63], a[92:95], v[76:79]
ds_read_b64_tr_b16 a[80:81], v9 offset:16384
v_accvgpr_read_b32 v19, a150
v_mfma_f32_16x16x32_bf16 v[76:79], a[56:59], a[88:91], v[76:79]
ds_read_b64_tr_b16 a[82:83], v9 offset:17408
v_accvgpr_read_b32 v21, a166
v_mfma_f32_16x16x32_bf16 v[140:143], a[56:59], a[96:99], v[140:143]
ds_read_b64_tr_b16 a[84:85], v9 offset:24576
v_lshlrev_b32 v18, 16, v19
v_mfma_f32_16x16x32_bf16 v[140:143], a[60:63], a[100:103], v[140:143]
s_add_u32 m0, s76, 37888
ds_read_b64_tr_b16 a[86:87], v9 offset:25600
v_and_b32 v19, 0xffff0000, v19
v_mfma_f32_16x16x32_bf16 v[124:127], a[52:55], a[100:103], v[124:127]
s_add_u32 s64, s70, 41600
ds_read_b64_tr_b16 a[88:89], v10 offset:16384
v_lshlrev_b32 v20, 16, v21
v_mfma_f32_16x16x32_bf16 v[124:127], a[48:51], a[96:99], v[124:127]
buffer_load_dwordx4 v13, s[32:35], s64 offen lds
v_mfma_f32_16x16x32_bf16 v[108:111], a[40:43], a[96:99], v[108:111]
ds_read_b64_tr_b16 a[90:91], v10 offset:17408
v_and_b32 v21, 0xffff0000, v21
v_mfma_f32_16x16x32_bf16 v[108:111], a[44:47], a[100:103], v[108:111]
ds_read_b64_tr_b16 a[92:93], v10 offset:24576
v_mul_f32 v18, v18, v20
v_mfma_f32_16x16x32_bf16 v[92:95], a[36:39], a[100:103], v[92:95]
ds_read_b64_tr_b16 a[94:95], v10 offset:25600
v_mul_f32 v19, v19, v21
v_mfma_f32_16x16x32_bf16 v[92:95], a[32:35], a[96:99], v[92:95]
ds_read_b64_tr_b16 a[96:97], v11 offset:16384
v_cvt_pk_bf16_f32 v18, v18, v19
v_mfma_f32_16x16x32_bf16 v[32:35], a[32:35], a[104:107], v[32:35]
s_add_u32 m0, s76, 38912
ds_read_b64_tr_b16 a[98:99], v11 offset:17408
v_lshlrev_b32 v19, 16, v18
v_mfma_f32_16x16x32_bf16 v[32:35], a[36:39], a[108:111], v[32:35]
s_add_u32 s64, s70, 49792
ds_read_b64_tr_b16 a[100:101], v11 offset:24576
v_and_b32 v18, 0xffff0000, v18
v_mfma_f32_16x16x32_bf16 v[48:51], a[44:47], a[108:111], v[48:51]
buffer_load_dwordx4 v12, s[32:35], s64 offen lds
v_mfma_f32_16x16x32_bf16 v[48:51], a[40:43], a[104:107], v[48:51]
ds_read_b64_tr_b16 a[102:103], v11 offset:25600
v_add_f32 v17, v17, v19
v_mfma_f32_16x16x32_bf16 v[64:67], a[48:51], a[104:107], v[64:67]
v_add_f32 v17, v17, v18
v_accvgpr_read_b32 v19, a151
v_mfma_f32_16x16x32_bf16 v[64:67], a[52:55], a[108:111], v[64:67]
v_accvgpr_read_b32 v21, a167
v_lshlrev_b32 v18, 16, v19
v_mfma_f32_16x16x32_bf16 v[80:83], a[60:63], a[108:111], v[80:83]
v_and_b32 v19, 0xffff0000, v19
v_lshlrev_b32 v20, 16, v21
v_mfma_f32_16x16x32_bf16 v[80:83], a[56:59], a[104:107], v[80:83]
s_add_u32 m0, s76, 39936
v_and_b32 v21, 0xffff0000, v21
v_mul_f32 v18, v18, v20
v_mfma_f32_16x16x32_bf16 v[144:147], a[56:59], a[112:115], v[144:147]
s_add_u32 s64, s70, 57984
v_mul_f32 v19, v19, v21
v_cvt_pk_bf16_f32 v18, v18, v19
v_mfma_f32_16x16x32_bf16 v[144:147], a[60:63], a[116:119], v[144:147]
buffer_load_dwordx4 v13, s[32:35], s64 offen lds
v_mfma_f32_16x16x32_bf16 v[128:131], a[52:55], a[116:119], v[128:131]
v_lshlrev_b32 v19, 16, v18
v_and_b32 v18, 0xffff0000, v18
v_mfma_f32_16x16x32_bf16 v[128:131], a[48:51], a[112:115], v[128:131]
v_add_f32 v17, v17, v19
v_add_f32 v17, v17, v18
v_mfma_f32_16x16x32_bf16 v[112:115], a[40:43], a[112:115], v[112:115]
v_accvgpr_read_b32 v19, a152
v_accvgpr_read_b32 v21, a168
v_mfma_f32_16x16x32_bf16 v[112:115], a[44:47], a[116:119], v[112:115]
v_lshlrev_b32 v18, 16, v19
v_and_b32 v19, 0xffff0000, v19
v_mfma_f32_16x16x32_bf16 v[96:99], a[36:39], a[116:119], v[96:99]
v_lshlrev_b32 v20, 16, v21
v_and_b32 v21, 0xffff0000, v21
v_mfma_f32_16x16x32_bf16 v[96:99], a[32:35], a[112:115], v[96:99]
s_waitcnt lgkmcnt(0)
v_mul_f32 v18, v18, v20
v_mul_f32 v19, v19, v21
v_mfma_f32_16x16x32_bf16 v[36:39], a[32:35], a[72:75], v[36:39]
v_cvt_pk_bf16_f32 v18, v18, v19
v_lshlrev_b32 v19, 16, v18
v_mfma_f32_16x16x32_bf16 v[36:39], a[36:39], a[76:79], v[36:39]
v_and_b32 v18, 0xffff0000, v18
v_add_f32 v17, v17, v19
v_mfma_f32_16x16x32_bf16 v[52:55], a[44:47], a[76:79], v[52:55]
s_waitcnt lgkmcnt(0)
s_barrier
v_mfma_f32_16x16x32_bf16 v[52:55], a[40:43], a[72:75], v[52:55]
s_add_u32 m0, s77, 65536
ds_read_b64_tr_b16 a[104:105], v4 offset:32768
v_add_f32 v17, v17, v18
v_mfma_f32_16x16x32_bf16 v[68:71], a[48:51], a[72:75], v[68:71]
s_add_u32 s64, s71, 3145728
ds_read_b64_tr_b16 a[106:107], v4 offset:33792
v_accvgpr_read_b32 v19, a153
v_mfma_f32_16x16x32_bf16 v[68:71], a[52:55], a[76:79], v[68:71]
buffer_load_dwordx4 v14, s[36:39], s64 offen lds
v_mfma_f32_16x16x32_bf16 v[84:87], a[60:63], a[76:79], v[84:87]
ds_read_b64_tr_b16 a[108:109], v4 offset:40960
v_accvgpr_read_b32 v21, a169
v_mfma_f32_16x16x32_bf16 v[84:87], a[56:59], a[72:75], v[84:87]
s_add_u32 s82, s82, 1048576
ds_read_b64_tr_b16 a[110:111], v4 offset:41984
v_lshlrev_b32 v18, 16, v19
v_mfma_f32_16x16x32_bf16 v[148:151], a[56:59], a[80:83], v[148:151]
buffer_load_dword a252, v1, s[60:63], s82 offen
v_mfma_f32_16x16x32_bf16 v[148:151], a[60:63], a[84:87], v[148:151]
ds_read_b64_tr_b16 a[112:113], v5 offset:32768
v_and_b32 v19, 0xffff0000, v19
v_mfma_f32_16x16x32_bf16 v[132:135], a[52:55], a[84:87], v[132:135]
ds_read_b64_tr_b16 a[114:115], v5 offset:33792
v_lshlrev_b32 v20, 16, v21
v_mfma_f32_16x16x32_bf16 v[132:135], a[48:51], a[80:83], v[132:135]
s_add_u32 m0, s77, 66560
ds_read_b64_tr_b16 a[116:117], v5 offset:40960
v_and_b32 v21, 0xffff0000, v21
v_mfma_f32_16x16x32_bf16 v[116:119], a[40:43], a[80:83], v[116:119]
s_add_u32 s64, s71, 3178496
ds_read_b64_tr_b16 a[118:119], v5 offset:41984
v_mul_f32 v18, v18, v20
v_mfma_f32_16x16x32_bf16 v[116:119], a[44:47], a[84:87], v[116:119]
buffer_load_dwordx4 v14, s[36:39], s64 offen lds
v_mfma_f32_16x16x32_bf16 v[100:103], a[36:39], a[84:87], v[100:103]
ds_read_b64_tr_b16 a[72:73], v6 offset:32768
v_mul_f32 v19, v19, v21
v_mfma_f32_16x16x32_bf16 v[100:103], a[32:35], a[80:83], v[100:103]
ds_read_b64_tr_b16 a[74:75], v6 offset:33792
v_cvt_pk_bf16_f32 v18, v18, v19
v_mfma_f32_16x16x32_bf16 v[248:251], a[32:35], a[88:91], v[248:251]
ds_read_b64_tr_b16 a[76:77], v6 offset:40960
v_lshlrev_b32 v19, 16, v18
v_mfma_f32_16x16x32_bf16 v[248:251], a[36:39], a[92:95], v[248:251]
ds_read_b64_tr_b16 a[78:79], v6 offset:41984
v_and_b32 v18, 0xffff0000, v18
v_mfma_f32_16x16x32_bf16 v[252:255], a[44:47], a[92:95], v[252:255]
ds_read_b64_tr_b16 a[80:81], v7 offset:32768
v_add_f32 v17, v17, v19
v_mfma_f32_16x16x32_bf16 v[252:255], a[40:43], a[88:91], v[252:255]
s_add_u32 m0, s77, 67584
ds_read_b64_tr_b16 a[82:83], v7 offset:33792
v_add_f32 v17, v17, v18
v_mfma_f32_16x16x32_bf16 a[120:123], a[48:51], a[88:91], a[120:123]
s_add_u32 s64, s71, 3211264
ds_read_b64_tr_b16 a[84:85], v7 offset:40960
v_accvgpr_read_b32 v19, a154
v_mfma_f32_16x16x32_bf16 a[120:123], a[52:55], a[92:95], a[120:123]
buffer_load_dwordx4 v15, s[36:39], s64 offen lds
v_mfma_f32_16x16x32_bf16 a[124:127], a[60:63], a[92:95], a[124:127]
ds_read_b64_tr_b16 a[86:87], v7 offset:41984
v_accvgpr_read_b32 v21, a170
v_mfma_f32_16x16x32_bf16 a[124:127], a[56:59], a[88:91], a[124:127]
ds_read_b64_tr_b16 a[88:89], v8 offset:32768
v_lshlrev_b32 v18, 16, v19
v_mfma_f32_16x16x32_bf16 a[128:131], a[56:59], a[96:99], a[128:131]
ds_read_b64_tr_b16 a[90:91], v8 offset:33792
v_and_b32 v19, 0xffff0000, v19
v_mfma_f32_16x16x32_bf16 a[128:131], a[60:63], a[100:103], a[128:131]
ds_read_b64_tr_b16 a[92:93], v8 offset:40960
v_lshlrev_b32 v20, 16, v21
v_mfma_f32_16x16x32_bf16 a[132:135], a[52:55], a[100:103], a[132:135]
ds_read_b64_tr_b16 a[94:95], v8 offset:41984
v_and_b32 v21, 0xffff0000, v21
v_mfma_f32_16x16x32_bf16 a[132:135], a[48:51], a[96:99], a[132:135]
s_add_u32 m0, s77, 68608
v_mul_f32 v18, v18, v20
v_mul_f32 v19, v19, v21
v_mfma_f32_16x16x32_bf16 a[136:139], a[40:43], a[96:99], a[136:139]
s_add_u32 s64, s71, 3244032
v_cvt_pk_bf16_f32 v18, v18, v19
v_lshlrev_b32 v19, 16, v18
v_mfma_f32_16x16x32_bf16 a[136:139], a[44:47], a[100:103], a[136:139]
buffer_load_dwordx4 v15, s[36:39], s64 offen lds
v_mfma_f32_16x16x32_bf16 a[140:143], a[36:39], a[100:103], a[140:143]
v_and_b32 v18, 0xffff0000, v18
v_add_f32 v17, v17, v19
v_mfma_f32_16x16x32_bf16 a[140:143], a[32:35], a[96:99], a[140:143]
s_waitcnt lgkmcnt(5)
ds_read_b64_tr_b16 a[96:97], v9 offset:32768
v_add_f32 v17, v17, v18
v_mfma_f32_16x16x32_bf16 v[184:187], a[104:107], a[0:3], v[184:187]
ds_read_b64_tr_b16 a[98:99], v9 offset:33792
v_accvgpr_read_b32 v19, a155
v_mfma_f32_16x16x32_bf16 v[184:187], a[108:111], a[4:7], v[184:187]
ds_read_b64_tr_b16 a[100:101], v9 offset:40960
v_accvgpr_read_b32 v21, a171
v_mfma_f32_16x16x32_bf16 v[192:195], a[108:111], a[12:15], v[192:195]
s_add_u32 s17, s78, .-L_pc+6144
ds_read_b64_tr_b16 a[102:103], v9 offset:41984
v_lshlrev_b32 v18, 16, v19
v_mfma_f32_16x16x32_bf16 v[192:195], a[104:107], a[8:11], v[192:195]
s_add_u32 m0, s77, 81920
v_and_b32 v19, 0xffff0000, v19
v_lshlrev_b32 v20, 16, v21
v_mfma_f32_16x16x32_bf16 v[200:203], a[104:107], a[16:19], v[200:203]
s_add_u32 s64, s71, 3145728
buffer_load_dword a252, v16, s[88:91], s17 offen
v_mfma_f32_16x16x32_bf16 v[200:203], a[108:111], a[20:23], v[200:203]
buffer_load_dwordx4 v14, s[40:43], s64 offen lds
v_mfma_f32_16x16x32_bf16 v[208:211], a[108:111], a[28:31], v[208:211]
v_and_b32 v21, 0xffff0000, v21
v_mul_f32 v18, v18, v20
v_mfma_f32_16x16x32_bf16 v[208:211], a[104:107], a[24:27], v[208:211]
ds_read_b64_tr_b16 a[104:105], v10 offset:32768
v_mul_f32 v19, v19, v21
v_mfma_f32_16x16x32_bf16 v[212:215], a[112:115], a[24:27], v[212:215]
ds_read_b64_tr_b16 a[106:107], v10 offset:33792
v_cvt_pk_bf16_f32 v18, v18, v19
v_mfma_f32_16x16x32_bf16 v[212:215], a[116:119], a[28:31], v[212:215]
ds_read_b64_tr_b16 a[108:109], v10 offset:40960
v_lshlrev_b32 v19, 16, v18
v_mfma_f32_16x16x32_bf16 v[204:207], a[116:119], a[20:23], v[204:207]
s_add_u32 s81, s81, 1048576
ds_read_b64_tr_b16 a[110:111], v10 offset:41984
v_and_b32 v18, 0xffff0000, v18
v_mfma_f32_16x16x32_bf16 v[204:207], a[112:115], a[16:19], v[204:207]
s_add_u32 m0, s77, 82944
v_add_f32 v17, v17, v19
v_add_f32 v17, v17, v18
v_mfma_f32_16x16x32_bf16 v[196:199], a[112:115], a[8:11], v[196:199]
s_add_u32 s64, s71, 3178496
buffer_load_dword a252, v16, s[56:59], s81 offen
v_mfma_f32_16x16x32_bf16 v[196:199], a[116:119], a[12:15], v[196:199]
buffer_load_dwordx4 v14, s[40:43], s64 offen lds
v_mfma_f32_16x16x32_bf16 v[188:191], a[116:119], a[4:7], v[188:191]
v_accvgpr_read_b32 v19, a156
v_accvgpr_read_b32 v21, a172
v_mfma_f32_16x16x32_bf16 v[188:191], a[112:115], a[0:3], v[188:191]
ds_read_b64_tr_b16 a[112:113], v11 offset:32768
v_lshlrev_b32 v18, 16, v19
v_mfma_f32_16x16x32_bf16 v[216:219], a[72:75], a[0:3], v[216:219]
ds_read_b64_tr_b16 a[114:115], v11 offset:33792
v_and_b32 v19, 0xffff0000, v19
v_mfma_f32_16x16x32_bf16 v[216:219], a[76:79], a[4:7], v[216:219]
ds_read_b64_tr_b16 a[116:117], v11 offset:40960
v_lshlrev_b32 v20, 16, v21
v_mfma_f32_16x16x32_bf16 v[224:227], a[76:79], a[12:15], v[224:227]
ds_read_b64_tr_b16 a[118:119], v11 offset:41984
v_and_b32 v21, 0xffff0000, v21
v_mfma_f32_16x16x32_bf16 v[224:227], a[72:75], a[8:11], v[224:227]
s_add_u32 m0, s77, 83968
v_mul_f32 v18, v18, v20
v_mul_f32 v19, v19, v21
v_mfma_f32_16x16x32_bf16 v[232:235], a[72:75], a[16:19], v[232:235]
s_add_u32 s64, s71, 3211264
v_cvt_pk_bf16_f32 v18, v18, v19
v_lshlrev_b32 v19, 16, v18
v_mfma_f32_16x16x32_bf16 v[232:235], a[76:79], a[20:23], v[232:235]
buffer_load_dwordx4 v15, s[40:43], s64 offen lds
v_mfma_f32_16x16x32_bf16 v[240:243], a[76:79], a[28:31], v[240:243]
v_and_b32 v18, 0xffff0000, v18
v_add_f32 v17, v17, v19
v_mfma_f32_16x16x32_bf16 v[240:243], a[72:75], a[24:27], v[240:243]
ds_read_b64_tr_b16 a[72:73], v4 offset:49152
v_add_f32 v17, v17, v18
v_mfma_f32_16x16x32_bf16 v[244:247], a[80:83], a[24:27], v[244:247]
s_waitcnt lgkmcnt(5)
ds_read_b64_tr_b16 a[74:75], v4 offset:50176
v_accvgpr_read_b32 v19, a157
v_mfma_f32_16x16x32_bf16 v[244:247], a[84:87], a[28:31], v[244:247]
ds_read_b64_tr_b16 a[76:77], v4 offset:57344
v_accvgpr_read_b32 v21, a173
v_mfma_f32_16x16x32_bf16 v[236:239], a[84:87], a[20:23], v[236:239]
ds_read_b64_tr_b16 a[78:79], v4 offset:58368
v_lshlrev_b32 v18, 16, v19
v_mfma_f32_16x16x32_bf16 v[236:239], a[80:83], a[16:19], v[236:239]
s_add_u32 m0, s77, 84992
v_and_b32 v19, 0xffff0000, v19
v_lshlrev_b32 v20, 16, v21
v_mfma_f32_16x16x32_bf16 v[228:231], a[80:83], a[8:11], v[228:231]
s_add_u32 s64, s71, 3244032
v_and_b32 v21, 0xffff0000, v21
v_mul_f32 v18, v18, v20
v_mfma_f32_16x16x32_bf16 v[228:231], a[84:87], a[12:15], v[228:231]
buffer_load_dwordx4 v15, s[40:43], s64 offen lds
v_mfma_f32_16x16x32_bf16 v[220:223], a[84:87], a[4:7], v[220:223]
v_mul_f32 v19, v19, v21
v_cvt_pk_bf16_f32 v18, v18, v19
v_mfma_f32_16x16x32_bf16 v[220:223], a[80:83], a[0:3], v[220:223]
ds_read_b64_tr_b16 a[80:81], v5 offset:49152
v_lshlrev_b32 v19, 16, v18
v_mfma_f32_16x16x32_bf16 v[152:155], a[88:91], a[0:3], v[152:155]
ds_read_b64_tr_b16 a[82:83], v5 offset:50176
v_and_b32 v18, 0xffff0000, v18
v_mfma_f32_16x16x32_bf16 v[152:155], a[92:95], a[4:7], v[152:155]
ds_read_b64_tr_b16 a[84:85], v5 offset:57344
v_add_f32 v17, v17, v19
v_mfma_f32_16x16x32_bf16 v[160:163], a[92:95], a[12:15], v[160:163]
ds_read_b64_tr_b16 a[86:87], v5 offset:58368
v_add_f32 v17, v17, v18
v_mfma_f32_16x16x32_bf16 v[160:163], a[88:91], a[8:11], v[160:163]
v_accvgpr_read_b32 v19, a158
v_accvgpr_read_b32 v21, a174
v_mfma_f32_16x16x32_bf16 v[168:171], a[88:91], a[16:19], v[168:171]
v_lshlrev_b32 v18, 16, v19
v_and_b32 v19, 0xffff0000, v19
v_mfma_f32_16x16x32_bf16 v[168:171], a[92:95], a[20:23], v[168:171]
v_lshlrev_b32 v20, 16, v21
v_and_b32 v21, 0xffff0000, v21
v_mfma_f32_16x16x32_bf16 v[176:179], a[92:95], a[28:31], v[176:179]
s_add_u32 m0, s76, 0
v_mul_f32 v18, v18, v20
v_mul_f32 v19, v19, v21
v_mfma_f32_16x16x32_bf16 v[176:179], a[88:91], a[24:27], v[176:179]
s_add_u32 s64, s70, 768
ds_read_b64_tr_b16 a[88:89], v6 offset:49152
v_cvt_pk_bf16_f32 v18, v18, v19
v_mfma_f32_16x16x32_bf16 v[180:183], a[96:99], a[24:27], v[180:183]
buffer_load_dwordx4 v12, s[32:35], s64 offen lds
v_mfma_f32_16x16x32_bf16 v[180:183], a[100:103], a[28:31], v[180:183]
ds_read_b64_tr_b16 a[90:91], v6 offset:50176
v_lshlrev_b32 v19, 16, v18
v_mfma_f32_16x16x32_bf16 v[172:175], a[100:103], a[20:23], v[172:175]
ds_read_b64_tr_b16 a[92:93], v6 offset:57344
v_and_b32 v18, 0xffff0000, v18
v_mfma_f32_16x16x32_bf16 v[172:175], a[96:99], a[16:19], v[172:175]
ds_read_b64_tr_b16 a[94:95], v6 offset:58368
v_add_f32 v17, v17, v19
v_mfma_f32_16x16x32_bf16 v[164:167], a[96:99], a[8:11], v[164:167]
v_add_f32 v17, v17, v18
v_accvgpr_read_b32 v19, a159
v_mfma_f32_16x16x32_bf16 v[164:167], a[100:103], a[12:15], v[164:167]
s_add_u32 m0, s76, 1024
v_accvgpr_read_b32 v21, a175
v_lshlrev_b32 v18, 16, v19
v_mfma_f32_16x16x32_bf16 v[156:159], a[100:103], a[4:7], v[156:159]
s_add_u32 s64, s70, 8960
v_and_b32 v19, 0xffff0000, v19
v_lshlrev_b32 v20, 16, v21
v_mfma_f32_16x16x32_bf16 v[156:159], a[96:99], a[0:3], v[156:159]
s_add_u32 s81, s81, 1048576
buffer_load_dwordx4 v13, s[32:35], s64 offen lds
v_mfma_f32_16x16x32_bf16 v[24:27], a[104:107], a[0:3], v[24:27]
buffer_load_dword a252, v16, s[56:59], s81 offen
v_mfma_f32_16x16x32_bf16 v[24:27], a[108:111], a[4:7], v[24:27]
ds_read_b64_tr_b16 a[96:97], v7 offset:49152
v_and_b32 v21, 0xffff0000, v21
v_mfma_f32_16x16x32_bf16 v[40:43], a[108:111], a[12:15], v[40:43]
ds_read_b64_tr_b16 a[98:99], v7 offset:50176
v_mul_f32 v18, v18, v20
v_mfma_f32_16x16x32_bf16 v[40:43], a[104:107], a[8:11], v[40:43]
ds_read_b64_tr_b16 a[100:101], v7 offset:57344
v_mul_f32 v19, v19, v21
v_mfma_f32_16x16x32_bf16 v[56:59], a[104:107], a[16:19], v[56:59]
s_add_u32 m0, s76, 2048
ds_read_b64_tr_b16 a[102:103], v7 offset:58368
v_cvt_pk_bf16_f32 v18, v18, v19
v_mfma_f32_16x16x32_bf16 v[56:59], a[108:111], a[20:23], v[56:59]
s_add_u32 s64, s70, 17152
v_lshlrev_b32 v19, 16, v18
v_and_b32 v18, 0xffff0000, v18
v_mfma_f32_16x16x32_bf16 v[72:75], a[108:111], a[28:31], v[72:75]
s_waitcnt vmcnt(14)
buffer_load_dwordx4 v12, s[32:35], s64 offen lds
v_mfma_f32_16x16x32_bf16 v[72:75], a[104:107], a[24:27], v[72:75]
s_waitcnt lgkmcnt(4)
ds_read_b64_tr_b16 a[104:105], v8 offset:49152
v_add_f32 v17, v17, v19
v_mfma_f32_16x16x32_bf16 v[136:139], a[112:115], a[24:27], v[136:139]
ds_read_b64_tr_b16 a[106:107], v8 offset:50176
v_add_f32 v17, v17, v18
v_mfma_f32_16x16x32_bf16 v[136:139], a[116:119], a[28:31], v[136:139]
ds_read_b64_tr_b16 a[108:109], v8 offset:57344
v_add_u32 v4, 0x8000, v4
v_mfma_f32_16x16x32_bf16 v[120:123], a[116:119], a[20:23], v[120:123]
ds_read_b64_tr_b16 a[110:111], v8 offset:58368
v_add_f32_dpp v17, v17, v17 row_ror:8 row_mask:0xf bank_mask:0xf
v_mfma_f32_16x16x32_bf16 v[120:123], a[112:115], a[16:19], v[120:123]
s_add_u32 m0, s76, 3072
ds_read_b128 a[32:35], v2 offset:32768
v_mfma_f32_16x16x32_bf16 v[104:107], a[112:115], a[8:11], v[104:107]
s_add_u32 s64, s70, 25344
ds_read_b128 a[36:39], v3 offset:32768
v_add_f32_dpp v17, v17, v17 row_ror:4 row_mask:0xf bank_mask:0xf
v_mfma_f32_16x16x32_bf16 v[104:107], a[116:119], a[12:15], v[104:107]
buffer_load_dwordx4 v13, s[32:35], s64 offen lds
v_mfma_f32_16x16x32_bf16 v[88:91], a[116:119], a[4:7], v[88:91]
ds_read_b128 a[40:43], v2 offset:34816
v_add_f32_dpp v17, v17, v17 row_ror:2 row_mask:0xf bank_mask:0xf
v_mfma_f32_16x16x32_bf16 v[88:91], a[112:115], a[0:3], v[88:91]
ds_read_b128 a[44:47], v3 offset:34816
v_mfma_f32_16x16x32_bf16 v[28:31], a[0:3], a[72:75], v[28:31]
ds_read_b128 a[48:51], v2 offset:36864
v_add_f32_dpp v17, v17, v17 row_ror:1 row_mask:0xf bank_mask:0xf
v_mfma_f32_16x16x32_bf16 v[28:31], a[4:7], a[76:79], v[28:31]
ds_read_b128 a[52:55], v3 offset:36864
v_add_u32 v5, 0x8000, v5
v_mfma_f32_16x16x32_bf16 v[44:47], a[12:15], a[76:79], v[44:47]
s_add_u32 m0, s76, 4096
ds_read_b128 a[56:59], v2 offset:38912
v_mov_b32 v18, v17
v_mfma_f32_16x16x32_bf16 v[44:47], a[8:11], a[72:75], v[44:47]
s_add_u32 s64, s70, 33536
ds_read_b128 a[60:63], v3 offset:38912
v_mfma_f32_16x16x32_bf16 v[60:63], a[16:19], a[72:75], v[60:63]
buffer_load_dwordx4 v12, s[32:35], s64 offen lds
v_mfma_f32_16x16x32_bf16 v[60:63], a[20:23], a[76:79], v[60:63]
ds_read_b64_tr_b16 a[112:113], v9 offset:49152
v_permlane16_swap_b32 v18, v17
v_mfma_f32_16x16x32_bf16 v[76:79], a[28:31], a[76:79], v[76:79]
ds_read_b64_tr_b16 a[114:115], v9 offset:50176
v_add_f32 v17, v17, v18
v_mfma_f32_16x16x32_bf16 v[76:79], a[24:27], a[72:75], v[76:79]
ds_read_b64_tr_b16 a[116:117], v9 offset:57344
v_cvt_pk_bf16_f32 v17, v17, v17
v_mfma_f32_16x16x32_bf16 v[140:143], a[24:27], a[80:83], v[140:143]
ds_read_b64_tr_b16 a[118:119], v9 offset:58368
v_and_b32 v17, 0xffff0000, v17
v_mfma_f32_16x16x32_bf16 v[140:143], a[28:31], a[84:87], v[140:143]
s_add_u32 m0, s76, 5120
ds_read_b64_tr_b16 a[72:73], v10 offset:49152
v_add_u32 v6, 0x8000, v6
v_mfma_f32_16x16x32_bf16 v[124:127], a[20:23], a[84:87], v[124:127]
s_add_u32 s64, s70, 41728
ds_read_b64_tr_b16 a[74:75], v10 offset:50176
v_mul_f32 v17, 0xbfb8aa3b, v17
v_mfma_f32_16x16x32_bf16 v[124:127], a[16:19], a[80:83], v[124:127]
buffer_load_dwordx4 v13, s[32:35], s64 offen lds
v_mfma_f32_16x16x32_bf16 v[108:111], a[8:11], a[80:83], v[108:111]
ds_read_b64_tr_b16 a[76:77], v10 offset:57344
v_mfma_f32_16x16x32_bf16 v[108:111], a[12:15], a[84:87], v[108:111]
ds_read_b64_tr_b16 a[78:79], v10 offset:58368
v_mfma_f32_16x16x32_bf16 v[92:95], a[4:7], a[84:87], v[92:95]
v_exp_f32 v17, v17
v_mfma_f32_16x16x32_bf16 v[92:95], a[0:3], a[80:83], v[92:95]
ds_read_b64_tr_b16 a[80:81], v11 offset:49152
v_add_f32 v17, 1.0, v17
v_mfma_f32_16x16x32_bf16 v[32:35], a[0:3], a[88:91], v[32:35]
s_add_u32 m0, s76, 6144
ds_read_b64_tr_b16 a[82:83], v11 offset:50176
v_mfma_f32_16x16x32_bf16 v[32:35], a[4:7], a[92:95], v[32:35]
s_add_u32 s64, s70, 49920
ds_read_b64_tr_b16 a[84:85], v11 offset:57344
v_add_u32 v7, 0x8000, v7
v_mfma_f32_16x16x32_bf16 v[48:51], a[12:15], a[92:95], v[48:51]
buffer_load_dwordx4 v12, s[32:35], s64 offen lds
v_mfma_f32_16x16x32_bf16 v[48:51], a[8:11], a[88:91], v[48:51]
s_add_u32 s82, s82, 1048576
ds_read_b64_tr_b16 a[86:87], v11 offset:58368
v_mfma_f32_16x16x32_bf16 v[64:67], a[16:19], a[88:91], v[64:67]
buffer_load_dword a252, v1, s[60:63], s82 offen
v_mfma_f32_16x16x32_bf16 v[64:67], a[20:23], a[92:95], v[64:67]
v_rcp_f32 v17, v17
v_mfma_f32_16x16x32_bf16 v[80:83], a[28:31], a[92:95], v[80:83]
v_cvt_pk_bf16_f32 v18, v17, v17
v_mfma_f32_16x16x32_bf16 v[80:83], a[24:27], a[88:91], v[80:83]
s_waitcnt lgkmcnt(4)
s_add_u32 m0, s76, 7168
v_and_b32 v18, 0xffff0000, v18
v_mfma_f32_16x16x32_bf16 v[144:147], a[24:27], a[96:99], v[144:147]
s_add_u32 s64, s70, 58112
v_sub_f32 v19, 1.0, v18
v_mfma_f32_16x16x32_bf16 v[144:147], a[28:31], a[100:103], v[144:147]
buffer_load_dwordx4 v13, s[32:35], s64 offen lds
v_mfma_f32_16x16x32_bf16 v[128:131], a[20:23], a[100:103], v[128:131]
v_add_u32 v8, 0x8000, v8
v_cvt_pk_bf16_f32 v19, v19, v19
v_mfma_f32_16x16x32_bf16 v[128:131], a[16:19], a[96:99], v[128:131]
v_and_b32 v19, 0xffff0000, v19
v_mfma_f32_16x16x32_bf16 v[112:115], a[8:11], a[96:99], v[112:115]
v_and_b32 v20, 31, v0
v_mfma_f32_16x16x32_bf16 v[112:115], a[12:15], a[100:103], v[112:115]
v_lshlrev_b32 v20, 27, v20
v_mfma_f32_16x16x32_bf16 v[96:99], a[4:7], a[100:103], v[96:99]
v_add_u32 v9, 0x8000, v9
v_add_u32 v10, 0x8000, v10
v_mfma_f32_16x16x32_bf16 v[96:99], a[0:3], a[96:99], v[96:99]
v_add_u32 v11, 0x8000, v11
v_lshrrev_b32 v21, 2, v0
v_mfma_f32_16x16x32_bf16 v[36:39], a[0:3], a[104:107], v[36:39]
v_add_u32 v20, v20, v21
v_mfma_f32_16x16x32_bf16 v[36:39], a[4:7], a[108:111], v[36:39]
v_mfma_f32_16x16x32_bf16 v[52:55], a[12:15], a[108:111], v[52:55]
s_waitcnt lgkmcnt(0)
s_barrier
v_mfma_f32_16x16x32_bf16 v[52:55], a[8:11], a[104:107], v[52:55]
s_add_u32 m0, s77, 98304
ds_read_b64_tr_b16 a[88:89], v4 offset:32768
v_mfma_f32_16x16x32_bf16 v[68:71], a[16:19], a[104:107], v[68:71]
s_add_u32 s64, s71, 3670016
ds_read_b64_tr_b16 a[90:91], v4 offset:33792
v_mfma_f32_16x16x32_bf16 v[68:71], a[20:23], a[108:111], v[68:71]
buffer_load_dwordx4 v14, s[36:39], s64 offen lds
v_mfma_f32_16x16x32_bf16 v[84:87], a[28:31], a[108:111], v[84:87]
ds_read_b64_tr_b16 a[92:93], v4 offset:40960
v_mfma_f32_16x16x32_bf16 v[84:87], a[24:27], a[104:107], v[84:87]
ds_read_b64_tr_b16 a[94:95], v4 offset:41984
v_mfma_f32_16x16x32_bf16 v[148:151], a[24:27], a[112:115], v[148:151]
ds_read_b64_tr_b16 a[96:97], v5 offset:32768
v_mfma_f32_16x16x32_bf16 v[148:151], a[28:31], a[116:119], v[148:151]
ds_read_b64_tr_b16 a[98:99], v5 offset:33792
v_mfma_f32_16x16x32_bf16 v[132:135], a[20:23], a[116:119], v[132:135]
ds_read_b64_tr_b16 a[100:101], v5 offset:40960
v_mfma_f32_16x16x32_bf16 v[132:135], a[16:19], a[112:115], v[132:135]
s_add_u32 m0, s77, 99328
ds_read_b64_tr_b16 a[102:103], v5 offset:41984
v_mfma_f32_16x16x32_bf16 v[116:119], a[8:11], a[112:115], v[116:119]
s_add_u32 s64, s71, 3702784
ds_read_b64_tr_b16 a[104:105], v6 offset:32768
v_mfma_f32_16x16x32_bf16 v[116:119], a[12:15], a[116:119], v[116:119]
buffer_load_dwordx4 v14, s[36:39], s64 offen lds
v_mfma_f32_16x16x32_bf16 v[100:103], a[4:7], a[116:119], v[100:103]
ds_read_b64_tr_b16 a[106:107], v6 offset:33792
v_mfma_f32_16x16x32_bf16 v[100:103], a[0:3], a[112:115], v[100:103]
ds_read_b64_tr_b16 a[108:109], v6 offset:40960
v_mfma_f32_16x16x32_bf16 v[248:251], a[0:3], a[72:75], v[248:251]
ds_read_b64_tr_b16 a[110:111], v6 offset:41984
v_mfma_f32_16x16x32_bf16 v[248:251], a[4:7], a[76:79], v[248:251]
ds_read_b64_tr_b16 a[112:113], v7 offset:32768
v_mfma_f32_16x16x32_bf16 v[252:255], a[12:15], a[76:79], v[252:255]
ds_read_b64_tr_b16 a[114:115], v7 offset:33792
v_mfma_f32_16x16x32_bf16 v[252:255], a[8:11], a[72:75], v[252:255]
s_add_u32 m0, s77, 100352
ds_read_b64_tr_b16 a[116:117], v7 offset:40960
v_mfma_f32_16x16x32_bf16 a[120:123], a[16:19], a[72:75], a[120:123]
s_add_u32 s64, s71, 3735552
s_lshl2_add_u32 s65, s2, s30
ds_read_b64_tr_b16 a[118:119], v7 offset:41984
v_mfma_f32_16x16x32_bf16 a[120:123], a[20:23], a[76:79], a[120:123]
s_lshl4_add_u32 s65, s65, 58720256
buffer_load_dwordx4 v15, s[36:39], s64 offen lds
v_mfma_f32_16x16x32_bf16 a[124:127], a[28:31], a[76:79], a[124:127]
buffer_store_dwordx2 v[18:19], v20, s[44:47], s65 offen sc1
v_mfma_f32_16x16x32_bf16 a[124:127], a[24:27], a[72:75], a[124:127]
s_add_u32 s81, s81, 1048576
ds_read_b64_tr_b16 a[72:73], v8 offset:32768
v_lshrrev_b32 v21, 4, v0
v_mfma_f32_16x16x32_bf16 a[128:131], a[24:27], a[80:83], a[128:131]
buffer_load_dword a252, v16, s[56:59], s81 offen
v_mfma_f32_16x16x32_bf16 a[128:131], a[28:31], a[84:87], a[128:131]
ds_read_b64_tr_b16 a[74:75], v8 offset:33792
v_bfe_u32 v19, v0, 2, 2
v_mfma_f32_16x16x32_bf16 a[132:135], a[20:23], a[84:87], a[132:135]
ds_read_b64_tr_b16 a[76:77], v8 offset:40960
v_lshl_add_u32 v19, v21, 3, v19
v_mfma_f32_16x16x32_bf16 a[132:135], a[16:19], a[80:83], a[132:135]
s_add_u32 m0, s77, 101376
ds_read_b64_tr_b16 a[78:79], v8 offset:41984
v_lshlrev_b32 v19, 6, v19
v_mfma_f32_16x16x32_bf16 a[136:139], a[8:11], a[80:83], a[136:139]
s_add_u32 s64, s71, 3768320
v_and_b32 v21, 1, v21
v_mfma_f32_16x16x32_bf16 a[136:139], a[12:15], a[84:87], a[136:139]
buffer_load_dwordx4 v15, s[36:39], s64 offen lds
v_mfma_f32_16x16x32_bf16 a[140:143], a[4:7], a[84:87], a[140:143]
v_lshl_add_u32 v19, v21, 5, v19
v_mfma_f32_16x16x32_bf16 a[140:143], a[0:3], a[80:83], a[140:143]
s_waitcnt lgkmcnt(4)
ds_read_b64_tr_b16 a[80:81], v9 offset:32768
v_and_b32 v21, 3, v0
v_mfma_f32_16x16x32_bf16 v[184:187], a[88:91], a[32:35], v[184:187]
ds_read_b64_tr_b16 a[82:83], v9 offset:33792
v_lshl_add_u32 v19, v21, 3, v19
v_mfma_f32_16x16x32_bf16 v[184:187], a[92:95], a[36:39], v[184:187]
ds_read_b64_tr_b16 a[84:85], v9 offset:40960
v_add_u32 v19, 114688, v19
v_mfma_f32_16x16x32_bf16 v[192:195], a[92:95], a[44:47], v[192:195]
ds_read_b64_tr_b16 a[86:87], v9 offset:41984
v_xor_b32 v20, 32, v19
v_mfma_f32_16x16x32_bf16 v[192:195], a[88:91], a[40:43], v[192:195]
s_add_u32 m0, s77, 114688
v_mfma_f32_16x16x32_bf16 v[200:203], a[88:91], a[48:51], v[200:203]
s_add_u32 s64, s71, 3670016
v_mfma_f32_16x16x32_bf16 v[200:203], a[92:95], a[52:55], v[200:203]
buffer_load_dwordx4 v14, s[40:43], s64 offen lds
v_mfma_f32_16x16x32_bf16 v[208:211], a[92:95], a[60:63], v[208:211]
v_mfma_f32_16x16x32_bf16 v[208:211], a[88:91], a[56:59], v[208:211]
ds_read_b64_tr_b16 a[88:89], v10 offset:32768
v_mfma_f32_16x16x32_bf16 v[212:215], a[96:99], a[56:59], v[212:215]
ds_read_b64_tr_b16 a[90:91], v10 offset:33792
v_mfma_f32_16x16x32_bf16 v[212:215], a[100:103], a[60:63], v[212:215]
ds_read_b64_tr_b16 a[92:93], v10 offset:40960
v_mfma_f32_16x16x32_bf16 v[204:207], a[100:103], a[52:55], v[204:207]
ds_read_b64_tr_b16 a[94:95], v10 offset:41984
v_mfma_f32_16x16x32_bf16 v[204:207], a[96:99], a[48:51], v[204:207]
s_add_u32 m0, s77, 115712
v_mfma_f32_16x16x32_bf16 v[196:199], a[96:99], a[40:43], v[196:199]
s_add_u32 s64, s71, 3702784
v_mfma_f32_16x16x32_bf16 v[196:199], a[100:103], a[44:47], v[196:199]
buffer_load_dwordx4 v14, s[40:43], s64 offen lds
v_mfma_f32_16x16x32_bf16 v[188:191], a[100:103], a[36:39], v[188:191]
v_mfma_f32_16x16x32_bf16 v[188:191], a[96:99], a[32:35], v[188:191]
ds_read_b64_tr_b16 a[96:97], v11 offset:32768
v_mfma_f32_16x16x32_bf16 v[216:219], a[104:107], a[32:35], v[216:219]
ds_read_b64_tr_b16 a[98:99], v11 offset:33792
v_mfma_f32_16x16x32_bf16 v[216:219], a[108:111], a[36:39], v[216:219]
ds_read_b64_tr_b16 a[100:101], v11 offset:40960
v_mfma_f32_16x16x32_bf16 v[224:227], a[108:111], a[44:47], v[224:227]
ds_read_b64_tr_b16 a[102:103], v11 offset:41984
v_mfma_f32_16x16x32_bf16 v[224:227], a[104:107], a[40:43], v[224:227]
s_add_u32 m0, s77, 116736
v_mfma_f32_16x16x32_bf16 v[232:235], a[104:107], a[48:51], v[232:235]
s_add_u32 s64, s71, 3735552
v_mfma_f32_16x16x32_bf16 v[232:235], a[108:111], a[52:55], v[232:235]
buffer_load_dwordx4 v15, s[40:43], s64 offen lds
v_mfma_f32_16x16x32_bf16 v[240:243], a[108:111], a[60:63], v[240:243]
v_mfma_f32_16x16x32_bf16 v[240:243], a[104:107], a[56:59], v[240:243]
ds_read_b64_tr_b16 a[104:105], v4 offset:49152
v_mfma_f32_16x16x32_bf16 v[244:247], a[112:115], a[56:59], v[244:247]
ds_read_b64_tr_b16 a[106:107], v4 offset:50176
v_mfma_f32_16x16x32_bf16 v[244:247], a[116:119], a[60:63], v[244:247]
ds_read_b64_tr_b16 a[108:109], v4 offset:57344
v_mfma_f32_16x16x32_bf16 v[236:239], a[116:119], a[52:55], v[236:239]
ds_read_b64_tr_b16 a[110:111], v4 offset:58368
v_mfma_f32_16x16x32_bf16 v[236:239], a[112:115], a[48:51], v[236:239]
s_add_u32 m0, s77, 117760
s_add_u32 s82, s82, 1048576
v_mfma_f32_16x16x32_bf16 v[228:231], a[112:115], a[40:43], v[228:231]
s_add_u32 s64, s71, 3768320
buffer_load_dword a252, v1, s[60:63], s82 offen
v_mfma_f32_16x16x32_bf16 v[228:231], a[116:119], a[44:47], v[228:231]
buffer_load_dwordx4 v15, s[40:43], s64 offen lds
v_mfma_f32_16x16x32_bf16 v[220:223], a[116:119], a[36:39], v[220:223]
v_mfma_f32_16x16x32_bf16 v[220:223], a[112:115], a[32:35], v[220:223]
s_waitcnt lgkmcnt(4)
ds_read_b64_tr_b16 a[112:113], v5 offset:49152
v_mfma_f32_16x16x32_bf16 v[152:155], a[72:75], a[32:35], v[152:155]
ds_read_b64_tr_b16 a[114:115], v5 offset:50176
v_mfma_f32_16x16x32_bf16 v[152:155], a[76:79], a[36:39], v[152:155]
ds_read_b64_tr_b16 a[116:117], v5 offset:57344
v_mfma_f32_16x16x32_bf16 v[160:163], a[76:79], a[44:47], v[160:163]
ds_read_b64_tr_b16 a[118:119], v5 offset:58368
v_mfma_f32_16x16x32_bf16 v[160:163], a[72:75], a[40:43], v[160:163]
v_mfma_f32_16x16x32_bf16 v[168:171], a[72:75], a[48:51], v[168:171]
v_mfma_f32_16x16x32_bf16 v[168:171], a[76:79], a[52:55], v[168:171]
v_mfma_f32_16x16x32_bf16 v[176:179], a[76:79], a[60:63], v[176:179]
s_add_u32 m0, s76, 32768
v_mfma_f32_16x16x32_bf16 v[176:179], a[72:75], a[56:59], v[176:179]
s_add_u32 s64, s70, 896
ds_read_b64_tr_b16 a[72:73], v6 offset:49152
v_mfma_f32_16x16x32_bf16 v[180:183], a[80:83], a[56:59], v[180:183]
buffer_load_dwordx4 v12, s[32:35], s64 offen lds
v_mfma_f32_16x16x32_bf16 v[180:183], a[84:87], a[60:63], v[180:183]
ds_read_b64_tr_b16 a[74:75], v6 offset:50176
v_mfma_f32_16x16x32_bf16 v[172:175], a[84:87], a[52:55], v[172:175]
ds_read_b64_tr_b16 a[76:77], v6 offset:57344
v_mfma_f32_16x16x32_bf16 v[172:175], a[80:83], a[48:51], v[172:175]
ds_read_b64_tr_b16 a[78:79], v6 offset:58368
v_mfma_f32_16x16x32_bf16 v[164:167], a[80:83], a[40:43], v[164:167]
v_mfma_f32_16x16x32_bf16 v[164:167], a[84:87], a[44:47], v[164:167]
s_add_u32 m0, s76, 33792
v_mfma_f32_16x16x32_bf16 v[156:159], a[84:87], a[36:39], v[156:159]
s_add_u32 s64, s70, 9088
v_mfma_f32_16x16x32_bf16 v[156:159], a[80:83], a[32:35], v[156:159]
buffer_load_dwordx4 v13, s[32:35], s64 offen lds
v_mfma_f32_16x16x32_bf16 v[24:27], a[88:91], a[32:35], v[24:27]
ds_read_b64_tr_b16 a[80:81], v7 offset:49152
v_mfma_f32_16x16x32_bf16 v[24:27], a[92:95], a[36:39], v[24:27]
ds_read_b64_tr_b16 a[82:83], v7 offset:50176
v_mfma_f32_16x16x32_bf16 v[40:43], a[92:95], a[44:47], v[40:43]
ds_read_b64_tr_b16 a[84:85], v7 offset:57344
v_mfma_f32_16x16x32_bf16 v[40:43], a[88:91], a[40:43], v[40:43]
ds_read_b64_tr_b16 a[86:87], v7 offset:58368
v_mfma_f32_16x16x32_bf16 v[56:59], a[88:91], a[48:51], v[56:59]
s_add_u32 m0, s76, 34816
v_mfma_f32_16x16x32_bf16 v[56:59], a[92:95], a[52:55], v[56:59]
s_add_u32 s64, s70, 17280
v_mfma_f32_16x16x32_bf16 v[72:75], a[92:95], a[60:63], v[72:75]
s_waitcnt vmcnt(13)
buffer_load_dwordx4 v12, s[32:35], s64 offen lds
v_mfma_f32_16x16x32_bf16 v[72:75], a[88:91], a[56:59], v[72:75]
ds_read_b64_tr_b16 a[88:89], v8 offset:49152
v_mfma_f32_16x16x32_bf16 v[136:139], a[96:99], a[56:59], v[136:139]
ds_read_b64_tr_b16 a[90:91], v8 offset:50176
v_mfma_f32_16x16x32_bf16 v[136:139], a[100:103], a[60:63], v[136:139]
ds_read_b64_tr_b16 a[92:93], v8 offset:57344
v_subrev_u32 v4, 0x8000, v4
v_mfma_f32_16x16x32_bf16 v[120:123], a[100:103], a[52:55], v[120:123]
ds_read_b64_tr_b16 a[94:95], v8 offset:58368
v_mfma_f32_16x16x32_bf16 v[120:123], a[96:99], a[48:51], v[120:123]
s_add_u32 m0, s76, 35840
ds_read_b128 a[0:3], v2 offset:0
v_mfma_f32_16x16x32_bf16 v[104:107], a[96:99], a[40:43], v[104:107]
s_add_u32 s64, s70, 25472
ds_read_b128 a[4:7], v3 offset:0
v_mfma_f32_16x16x32_bf16 v[104:107], a[100:103], a[44:47], v[104:107]
buffer_load_dwordx4 v13, s[32:35], s64 offen lds
v_mfma_f32_16x16x32_bf16 v[88:91], a[100:103], a[36:39], v[88:91]
ds_read_b128 a[8:11], v2 offset:2048
v_mfma_f32_16x16x32_bf16 v[88:91], a[96:99], a[32:35], v[88:91]
s_waitcnt lgkmcnt(7)
ds_read_b128 a[12:15], v3 offset:2048
v_mfma_f32_16x16x32_bf16 v[28:31], a[32:35], a[104:107], v[28:31]
ds_read_b128 a[16:19], v2 offset:4096
v_mfma_f32_16x16x32_bf16 v[28:31], a[36:39], a[108:111], v[28:31]
ds_read_b128 a[20:23], v3 offset:4096
v_subrev_u32 v5, 0x8000, v5
v_mfma_f32_16x16x32_bf16 v[44:47], a[44:47], a[108:111], v[44:47]
s_add_u32 m0, s76, 36864
ds_read_b128 a[24:27], v2 offset:6144
v_mfma_f32_16x16x32_bf16 v[44:47], a[40:43], a[104:107], v[44:47]
s_add_u32 s64, s70, 33664
ds_read_b128 a[28:31], v3 offset:6144
v_mfma_f32_16x16x32_bf16 v[60:63], a[48:51], a[104:107], v[60:63]
buffer_load_dwordx4 v12, s[32:35], s64 offen lds
v_mfma_f32_16x16x32_bf16 v[60:63], a[52:55], a[108:111], v[60:63]
ds_read_b64_tr_b16 a[96:97], v9 offset:49152
v_mfma_f32_16x16x32_bf16 v[76:79], a[60:63], a[108:111], v[76:79]
ds_read_b64_tr_b16 a[98:99], v9 offset:50176
v_mfma_f32_16x16x32_bf16 v[76:79], a[56:59], a[104:107], v[76:79]
ds_read_b64_tr_b16 a[100:101], v9 offset:57344
v_mfma_f32_16x16x32_bf16 v[140:143], a[56:59], a[112:115], v[140:143]
ds_read_b64_tr_b16 a[102:103], v9 offset:58368
v_mfma_f32_16x16x32_bf16 v[140:143], a[60:63], a[116:119], v[140:143]
s_add_u32 m0, s76, 37888
ds_read_b64_tr_b16 a[104:105], v10 offset:49152
v_subrev_u32 v6, 0x8000, v6
v_mfma_f32_16x16x32_bf16 v[124:127], a[52:55], a[116:119], v[124:127]
s_add_u32 s64, s70, 41856
ds_read_b64_tr_b16 a[106:107], v10 offset:50176
v_mfma_f32_16x16x32_bf16 v[124:127], a[48:51], a[112:115], v[124:127]
buffer_load_dwordx4 v13, s[32:35], s64 offen lds
v_mfma_f32_16x16x32_bf16 v[108:111], a[40:43], a[112:115], v[108:111]
ds_read_b64_tr_b16 a[108:109], v10 offset:57344
v_mfma_f32_16x16x32_bf16 v[108:111], a[44:47], a[116:119], v[108:111]
ds_read_b64_tr_b16 a[110:111], v10 offset:58368
v_mfma_f32_16x16x32_bf16 v[92:95], a[36:39], a[116:119], v[92:95]
v_mfma_f32_16x16x32_bf16 v[92:95], a[32:35], a[112:115], v[92:95]
ds_read_b64_tr_b16 a[112:113], v11 offset:49152
v_mfma_f32_16x16x32_bf16 v[32:35], a[32:35], a[72:75], v[32:35]
s_add_u32 m0, s76, 38912
ds_read_b64_tr_b16 a[114:115], v11 offset:50176
v_mfma_f32_16x16x32_bf16 v[32:35], a[36:39], a[76:79], v[32:35]
s_add_u32 s64, s70, 50048
ds_read_b64_tr_b16 a[116:117], v11 offset:57344
v_subrev_u32 v7, 0x8000, v7
v_mfma_f32_16x16x32_bf16 v[48:51], a[44:47], a[76:79], v[48:51]
buffer_load_dwordx4 v12, s[32:35], s64 offen lds
v_mfma_f32_16x16x32_bf16 v[48:51], a[40:43], a[72:75], v[48:51]
ds_read_b64_tr_b16 a[118:119], v11 offset:58368
v_mfma_f32_16x16x32_bf16 v[64:67], a[48:51], a[72:75], v[64:67]
v_mfma_f32_16x16x32_bf16 v[64:67], a[52:55], a[76:79], v[64:67]
v_mfma_f32_16x16x32_bf16 v[80:83], a[60:63], a[76:79], v[80:83]
v_mfma_f32_16x16x32_bf16 v[80:83], a[56:59], a[72:75], v[80:83]
s_add_u32 m0, s76, 39936
v_mfma_f32_16x16x32_bf16 v[144:147], a[56:59], a[80:83], v[144:147]
s_add_u32 s64, s70, 58240
v_mfma_f32_16x16x32_bf16 v[144:147], a[60:63], a[84:87], v[144:147]
buffer_load_dwordx4 v13, s[32:35], s64 offen lds
v_mfma_f32_16x16x32_bf16 v[128:131], a[52:55], a[84:87], v[128:131]
v_subrev_u32 v8, 0x8000, v8
v_mfma_f32_16x16x32_bf16 v[128:131], a[48:51], a[80:83], v[128:131]
v_mfma_f32_16x16x32_bf16 v[112:115], a[40:43], a[80:83], v[112:115]
v_mfma_f32_16x16x32_bf16 v[112:115], a[44:47], a[84:87], v[112:115]
v_mfma_f32_16x16x32_bf16 v[96:99], a[36:39], a[84:87], v[96:99]
v_subrev_u32 v9, 0x8000, v9
v_subrev_u32 v10, 0x8000, v10
v_mfma_f32_16x16x32_bf16 v[96:99], a[32:35], a[80:83], v[96:99]
s_waitcnt lgkmcnt(0)
v_subrev_u32 v11, 0x8000, v11
v_mfma_f32_16x16x32_bf16 v[36:39], a[32:35], a[88:91], v[36:39]
v_mfma_f32_16x16x32_bf16 v[36:39], a[36:39], a[92:95], v[36:39]
v_mfma_f32_16x16x32_bf16 v[52:55], a[44:47], a[92:95], v[52:55]
s_waitcnt lgkmcnt(0)
s_barrier
v_mfma_f32_16x16x32_bf16 v[52:55], a[40:43], a[88:91], v[52:55]
s_add_u32 m0, s77, 131072
ds_read_b64_tr_b16 a[72:73], v4 offset:0
v_mfma_f32_16x16x32_bf16 v[68:71], a[48:51], a[88:91], v[68:71]
s_add_u32 s64, s71, 0
ds_read_b64_tr_b16 a[74:75], v4 offset:1024
v_mfma_f32_16x16x32_bf16 v[68:71], a[52:55], a[92:95], v[68:71]
buffer_load_dwordx4 v14, s[56:59], s64 offen lds
v_mfma_f32_16x16x32_bf16 v[84:87], a[60:63], a[92:95], v[84:87]
ds_read_b64_tr_b16 a[76:77], v4 offset:8192
v_mfma_f32_16x16x32_bf16 v[84:87], a[56:59], a[88:91], v[84:87]
ds_read_b64_tr_b16 a[78:79], v4 offset:9216
v_mfma_f32_16x16x32_bf16 v[148:151], a[56:59], a[96:99], v[148:151]
ds_read_b64_tr_b16 a[80:81], v5 offset:0
v_lshrrev_b32 v13, 3, v0
v_mfma_f32_16x16x32_bf16 v[148:151], a[60:63], a[100:103], v[148:151]
ds_read_b64_tr_b16 a[82:83], v5 offset:1024
v_lshl_add_u32 v12, v13, 10, v12
v_mfma_f32_16x16x32_bf16 v[132:135], a[52:55], a[100:103], v[132:135]
ds_read_b64_tr_b16 a[84:85], v5 offset:8192
v_xor_b32 v13, 64, v12
v_mfma_f32_16x16x32_bf16 v[132:135], a[48:51], a[96:99], v[132:135]
ds_read_b64_tr_b16 a[86:87], v5 offset:9216
v_mfma_f32_16x16x32_bf16 v[116:119], a[40:43], a[96:99], v[116:119]
s_add_u32 m0, s78, 147456
ds_read_b64_tr_b16 a[88:89], v6 offset:0
v_mfma_f32_16x16x32_bf16 v[116:119], a[44:47], a[100:103], v[116:119]
s_add_u32 s64, s75, 0
ds_read_b64_tr_b16 a[90:91], v6 offset:1024
v_mfma_f32_16x16x32_bf16 v[100:103], a[36:39], a[100:103], v[100:103]
buffer_load_dwordx4 v23, s[60:63], s64 offen lds
v_mfma_f32_16x16x32_bf16 v[100:103], a[32:35], a[96:99], v[100:103]
ds_read_b64_tr_b16 a[92:93], v6 offset:8192
v_mfma_f32_16x16x32_bf16 v[248:251], a[32:35], a[104:107], v[248:251]
ds_read_b64_tr_b16 a[94:95], v6 offset:9216
v_mfma_f32_16x16x32_bf16 v[248:251], a[36:39], a[108:111], v[248:251]
ds_read_b64_tr_b16 a[96:97], v7 offset:0
v_mfma_f32_16x16x32_bf16 v[252:255], a[44:47], a[108:111], v[252:255]
ds_read_b64_tr_b16 a[98:99], v7 offset:1024
v_mfma_f32_16x16x32_bf16 v[252:255], a[40:43], a[104:107], v[252:255]
ds_read_b64_tr_b16 a[100:101], v7 offset:8192
v_mfma_f32_16x16x32_bf16 a[120:123], a[48:51], a[104:107], a[120:123]
ds_read_b64_tr_b16 a[102:103], v7 offset:9216
v_mfma_f32_16x16x32_bf16 a[120:123], a[52:55], a[108:111], a[120:123]
s_add_u32 m0, s77, 132096
v_mfma_f32_16x16x32_bf16 a[124:127], a[60:63], a[108:111], a[124:127]
s_add_u32 s64, s71, 32768
v_mfma_f32_16x16x32_bf16 a[124:127], a[56:59], a[104:107], a[124:127]
buffer_load_dwordx4 v14, s[56:59], s64 offen lds
v_mfma_f32_16x16x32_bf16 a[128:131], a[56:59], a[112:115], a[128:131]
ds_read_b64_tr_b16 a[104:105], v8 offset:0
v_mfma_f32_16x16x32_bf16 a[128:131], a[60:63], a[116:119], a[128:131]
ds_read_b64_tr_b16 a[106:107], v8 offset:1024
v_mfma_f32_16x16x32_bf16 a[132:135], a[52:55], a[116:119], a[132:135]
ds_read_b64_tr_b16 a[108:109], v8 offset:8192
v_mfma_f32_16x16x32_bf16 a[132:135], a[48:51], a[112:115], a[132:135]
ds_read_b64_tr_b16 a[110:111], v8 offset:9216
v_mfma_f32_16x16x32_bf16 a[136:139], a[40:43], a[112:115], a[136:139]
v_mfma_f32_16x16x32_bf16 a[136:139], a[44:47], a[116:119], a[136:139]
v_mfma_f32_16x16x32_bf16 a[140:143], a[36:39], a[116:119], a[140:143]
s_add_u32 m0, s78, 151552
v_mfma_f32_16x16x32_bf16 a[140:143], a[32:35], a[112:115], a[140:143]
s_waitcnt lgkmcnt(4)
s_add_u32 s64, s75, 2048
ds_read_b64_tr_b16 a[112:113], v9 offset:0
v_mfma_f32_16x16x32_bf16 v[184:187], a[72:75], a[0:3], v[184:187]
buffer_load_dwordx4 v23, s[60:63], s64 offen lds
v_mfma_f32_16x16x32_bf16 v[184:187], a[76:79], a[4:7], v[184:187]
ds_read_b64_tr_b16 a[114:115], v9 offset:1024
v_mfma_f32_16x16x32_bf16 v[192:195], a[76:79], a[12:15], v[192:195]
ds_read_b64_tr_b16 a[116:117], v9 offset:8192
v_mfma_f32_16x16x32_bf16 v[192:195], a[72:75], a[8:11], v[192:195]
s_add_u32 s17, s78, .-L_pc+6144
ds_read_b64_tr_b16 a[118:119], v9 offset:9216
v_mfma_f32_16x16x32_bf16 v[200:203], a[72:75], a[16:19], v[200:203]
buffer_load_dword a252, v16, s[88:91], s17 offen
v_mfma_f32_16x16x32_bf16 v[200:203], a[76:79], a[20:23], v[200:203]
v_mfma_f32_16x16x32_bf16 v[208:211], a[76:79], a[28:31], v[208:211]
v_mfma_f32_16x16x32_bf16 v[208:211], a[72:75], a[24:27], v[208:211]
ds_read_b64_tr_b16 a[72:73], v10 offset:0
v_mfma_f32_16x16x32_bf16 v[212:215], a[80:83], a[24:27], v[212:215]
s_add_u32 m0, s77, 133120
ds_read_b64_tr_b16 a[74:75], v10 offset:1024
v_mfma_f32_16x16x32_bf16 v[212:215], a[84:87], a[28:31], v[212:215]
s_add_u32 s64, s71, 65536
ds_read_b64_tr_b16 a[76:77], v10 offset:8192
v_mfma_f32_16x16x32_bf16 v[204:207], a[84:87], a[20:23], v[204:207]
buffer_load_dwordx4 v15, s[56:59], s64 offen lds
v_mfma_f32_16x16x32_bf16 v[204:207], a[80:83], a[16:19], v[204:207]
ds_read_b64_tr_b16 a[78:79], v10 offset:9216
v_mfma_f32_16x16x32_bf16 v[196:199], a[80:83], a[8:11], v[196:199]
v_mfma_f32_16x16x32_bf16 v[196:199], a[84:87], a[12:15], v[196:199]
v_mfma_f32_16x16x32_bf16 v[188:191], a[84:87], a[4:7], v[188:191]
v_mfma_f32_16x16x32_bf16 v[188:191], a[80:83], a[0:3], v[188:191]
ds_read_b64_tr_b16 a[80:81], v11 offset:0
v_mfma_f32_16x16x32_bf16 v[216:219], a[88:91], a[0:3], v[216:219]
ds_read_b64_tr_b16 a[82:83], v11 offset:1024
v_mfma_f32_16x16x32_bf16 v[216:219], a[92:95], a[4:7], v[216:219]
s_add_u32 m0, s78, 155648
ds_read_b64_tr_b16 a[84:85], v11 offset:8192
v_mfma_f32_16x16x32_bf16 v[224:227], a[92:95], a[12:15], v[224:227]
s_add_u32 s64, s75, 4096
ds_read_b64_tr_b16 a[86:87], v11 offset:9216
v_mfma_f32_16x16x32_bf16 v[224:227], a[88:91], a[8:11], v[224:227]
buffer_load_dwordx4 v23, s[60:63], s64 offen lds
v_mfma_f32_16x16x32_bf16 v[232:235], a[88:91], a[16:19], v[232:235]
v_mfma_f32_16x16x32_bf16 v[232:235], a[92:95], a[20:23], v[232:235]
v_mfma_f32_16x16x32_bf16 v[240:243], a[92:95], a[28:31], v[240:243]
v_mfma_f32_16x16x32_bf16 v[240:243], a[88:91], a[24:27], v[240:243]
ds_read_b64_tr_b16 a[88:89], v4 offset:16384
v_mfma_f32_16x16x32_bf16 v[244:247], a[96:99], a[24:27], v[244:247]
ds_read_b64_tr_b16 a[90:91], v4 offset:17408
v_mfma_f32_16x16x32_bf16 v[244:247], a[100:103], a[28:31], v[244:247]
ds_read_b64_tr_b16 a[92:93], v4 offset:24576
v_mfma_f32_16x16x32_bf16 v[236:239], a[100:103], a[20:23], v[236:239]
s_add_u32 m0, s77, 134144
ds_read_b64_tr_b16 a[94:95], v4 offset:25600
v_mfma_f32_16x16x32_bf16 v[236:239], a[96:99], a[16:19], v[236:239]
s_add_u32 s64, s71, 98304
v_mfma_f32_16x16x32_bf16 v[228:231], a[96:99], a[8:11], v[228:231]
buffer_load_dwordx4 v15, s[56:59], s64 offen lds
v_mfma_f32_16x16x32_bf16 v[228:231], a[100:103], a[12:15], v[228:231]
v_mfma_f32_16x16x32_bf16 v[220:223], a[100:103], a[4:7], v[220:223]
v_mfma_f32_16x16x32_bf16 v[220:223], a[96:99], a[0:3], v[220:223]
s_waitcnt lgkmcnt(4)
ds_read_b64_tr_b16 a[96:97], v5 offset:16384
v_mfma_f32_16x16x32_bf16 v[152:155], a[104:107], a[0:3], v[152:155]
ds_read_b64_tr_b16 a[98:99], v5 offset:17408
v_mfma_f32_16x16x32_bf16 v[152:155], a[108:111], a[4:7], v[152:155]
ds_read_b64_tr_b16 a[100:101], v5 offset:24576
v_mfma_f32_16x16x32_bf16 v[160:163], a[108:111], a[12:15], v[160:163]
ds_read_b64_tr_b16 a[102:103], v5 offset:25600
v_mfma_f32_16x16x32_bf16 v[160:163], a[104:107], a[8:11], v[160:163]
v_mfma_f32_16x16x32_bf16 v[168:171], a[104:107], a[16:19], v[168:171]
v_mfma_f32_16x16x32_bf16 v[168:171], a[108:111], a[20:23], v[168:171]
v_mfma_f32_16x16x32_bf16 v[176:179], a[108:111], a[28:31], v[176:179]
s_add_u32 m0, s76, 0
v_mfma_f32_16x16x32_bf16 v[176:179], a[104:107], a[24:27], v[176:179]
s_add_u32 s64, s72, 0
ds_read_b64_tr_b16 a[104:105], v6 offset:16384
v_mfma_f32_16x16x32_bf16 v[180:183], a[112:115], a[24:27], v[180:183]
buffer_load_dwordx4 v12, s[48:51], s64 offen lds
v_mfma_f32_16x16x32_bf16 v[180:183], a[116:119], a[28:31], v[180:183]
ds_read_b64_tr_b16 a[106:107], v6 offset:17408
v_mfma_f32_16x16x32_bf16 v[172:175], a[116:119], a[20:23], v[172:175]
ds_read_b64_tr_b16 a[108:109], v6 offset:24576
v_mfma_f32_16x16x32_bf16 v[172:175], a[112:115], a[16:19], v[172:175]
ds_read_b64_tr_b16 a[110:111], v6 offset:25600
v_mfma_f32_16x16x32_bf16 v[164:167], a[112:115], a[8:11], v[164:167]
v_mfma_f32_16x16x32_bf16 v[164:167], a[116:119], a[12:15], v[164:167]
s_add_u32 m0, s76, 1024
v_mfma_f32_16x16x32_bf16 v[156:159], a[116:119], a[4:7], v[156:159]
s_add_u32 s64, s72, 16384
v_mfma_f32_16x16x32_bf16 v[156:159], a[112:115], a[0:3], v[156:159]
buffer_load_dwordx4 v13, s[48:51], s64 offen lds
v_mfma_f32_16x16x32_bf16 v[24:27], a[72:75], a[0:3], v[24:27]
ds_read_b64_tr_b16 a[112:113], v7 offset:16384
v_mfma_f32_16x16x32_bf16 v[24:27], a[76:79], a[4:7], v[24:27]
ds_read_b64_tr_b16 a[114:115], v7 offset:17408
v_mfma_f32_16x16x32_bf16 v[40:43], a[76:79], a[12:15], v[40:43]
ds_read_b64_tr_b16 a[116:117], v7 offset:24576
v_mfma_f32_16x16x32_bf16 v[40:43], a[72:75], a[8:11], v[40:43]
ds_read_b64_tr_b16 a[118:119], v7 offset:25600
v_mfma_f32_16x16x32_bf16 v[56:59], a[72:75], a[16:19], v[56:59]
s_add_u32 m0, s76, 2048
v_mfma_f32_16x16x32_bf16 v[56:59], a[76:79], a[20:23], v[56:59]
s_add_u32 s64, s72, 131072
v_mfma_f32_16x16x32_bf16 v[72:75], a[76:79], a[28:31], v[72:75]
s_waitcnt vmcnt(10)
buffer_load_dwordx4 v12, s[48:51], s64 offen lds
v_mfma_f32_16x16x32_bf16 v[72:75], a[72:75], a[24:27], v[72:75]
ds_read_b64_tr_b16 a[72:73], v8 offset:16384
v_mfma_f32_16x16x32_bf16 v[136:139], a[80:83], a[24:27], v[136:139]
ds_read_b64_tr_b16 a[74:75], v8 offset:17408
v_mfma_f32_16x16x32_bf16 v[136:139], a[84:87], a[28:31], v[136:139]
ds_read_b64_tr_b16 a[76:77], v8 offset:24576
v_mfma_f32_16x16x32_bf16 v[120:123], a[84:87], a[20:23], v[120:123]
ds_read_b64_tr_b16 a[78:79], v8 offset:25600
v_mfma_f32_16x16x32_bf16 v[120:123], a[80:83], a[16:19], v[120:123]
s_add_u32 m0, s76, 3072
ds_read_b128 a[32:35], v2 offset:32768
v_mfma_f32_16x16x32_bf16 v[104:107], a[80:83], a[8:11], v[104:107]
s_add_u32 s64, s72, 147456
ds_read_b128 a[36:39], v3 offset:32768
v_mfma_f32_16x16x32_bf16 v[104:107], a[84:87], a[12:15], v[104:107]
buffer_load_dwordx4 v13, s[48:51], s64 offen lds
v_mfma_f32_16x16x32_bf16 v[88:91], a[84:87], a[4:7], v[88:91]
ds_read_b128 a[40:43], v2 offset:34816
v_mfma_f32_16x16x32_bf16 v[88:91], a[80:83], a[0:3], v[88:91]
s_waitcnt lgkmcnt(7)
ds_read_b128 a[44:47], v3 offset:34816
v_mfma_f32_16x16x32_bf16 v[28:31], a[0:3], a[88:91], v[28:31]
ds_read_b128 a[48:51], v2 offset:36864
v_mfma_f32_16x16x32_bf16 v[28:31], a[4:7], a[92:95], v[28:31]
ds_read_b128 a[52:55], v3 offset:36864
v_mfma_f32_16x16x32_bf16 v[44:47], a[12:15], a[92:95], v[44:47]
s_add_u32 m0, s76, 4096
ds_read_b128 a[56:59], v2 offset:38912
v_mfma_f32_16x16x32_bf16 v[44:47], a[8:11], a[88:91], v[44:47]
s_add_u32 s64, s73, 0
ds_read_b128 a[60:63], v3 offset:38912
v_mfma_f32_16x16x32_bf16 v[60:63], a[16:19], a[88:91], v[60:63]
buffer_load_dwordx4 v12, s[48:51], s64 offen lds
v_mfma_f32_16x16x32_bf16 v[60:63], a[20:23], a[92:95], v[60:63]
ds_read_b64_tr_b16 a[80:81], v9 offset:16384
v_mfma_f32_16x16x32_bf16 v[76:79], a[28:31], a[92:95], v[76:79]
ds_read_b64_tr_b16 a[82:83], v9 offset:17408
v_mfma_f32_16x16x32_bf16 v[76:79], a[24:27], a[88:91], v[76:79]
ds_read_b64_tr_b16 a[84:85], v9 offset:24576
v_mfma_f32_16x16x32_bf16 v[140:143], a[24:27], a[96:99], v[140:143]
ds_read_b64_tr_b16 a[86:87], v9 offset:25600
v_mfma_f32_16x16x32_bf16 v[140:143], a[28:31], a[100:103], v[140:143]
s_add_u32 m0, s76, 5120
ds_read_b64_tr_b16 a[88:89], v10 offset:16384
v_mfma_f32_16x16x32_bf16 v[124:127], a[20:23], a[100:103], v[124:127]
s_add_u32 s64, s73, 16384
ds_read_b64_tr_b16 a[90:91], v10 offset:17408
v_mfma_f32_16x16x32_bf16 v[124:127], a[16:19], a[96:99], v[124:127]
buffer_load_dwordx4 v13, s[48:51], s64 offen lds
v_mfma_f32_16x16x32_bf16 v[108:111], a[8:11], a[96:99], v[108:111]
ds_read_b64_tr_b16 a[92:93], v10 offset:24576
v_mfma_f32_16x16x32_bf16 v[108:111], a[12:15], a[100:103], v[108:111]
ds_read_b64_tr_b16 a[94:95], v10 offset:25600
v_mfma_f32_16x16x32_bf16 v[92:95], a[4:7], a[100:103], v[92:95]
v_mfma_f32_16x16x32_bf16 v[92:95], a[0:3], a[96:99], v[92:95]
ds_read_b64_tr_b16 a[96:97], v11 offset:16384
v_mfma_f32_16x16x32_bf16 v[32:35], a[0:3], a[104:107], v[32:35]
s_add_u32 m0, s76, 6144
ds_read_b64_tr_b16 a[98:99], v11 offset:17408
v_mfma_f32_16x16x32_bf16 v[32:35], a[4:7], a[108:111], v[32:35]
s_add_u32 s64, s73, 131072
ds_read_b64_tr_b16 a[100:101], v11 offset:24576
v_mfma_f32_16x16x32_bf16 v[48:51], a[12:15], a[108:111], v[48:51]
buffer_load_dwordx4 v12, s[48:51], s64 offen lds
v_mfma_f32_16x16x32_bf16 v[48:51], a[8:11], a[104:107], v[48:51]
ds_read_b64_tr_b16 a[102:103], v11 offset:25600
v_mfma_f32_16x16x32_bf16 v[64:67], a[16:19], a[104:107], v[64:67]
v_mfma_f32_16x16x32_bf16 v[64:67], a[20:23], a[108:111], v[64:67]
v_mfma_f32_16x16x32_bf16 v[80:83], a[28:31], a[108:111], v[80:83]
v_mfma_f32_16x16x32_bf16 v[80:83], a[24:27], a[104:107], v[80:83]
s_add_u32 m0, s76, 7168
v_mfma_f32_16x16x32_bf16 v[144:147], a[24:27], a[112:115], v[144:147]
s_add_u32 s64, s73, 147456
v_mfma_f32_16x16x32_bf16 v[144:147], a[28:31], a[116:119], v[144:147]
buffer_load_dwordx4 v13, s[48:51], s64 offen lds
v_mfma_f32_16x16x32_bf16 v[128:131], a[20:23], a[116:119], v[128:131]
v_mfma_f32_16x16x32_bf16 v[128:131], a[16:19], a[112:115], v[128:131]
v_mfma_f32_16x16x32_bf16 v[112:115], a[8:11], a[112:115], v[112:115]
v_mfma_f32_16x16x32_bf16 v[112:115], a[12:15], a[116:119], v[112:115]
v_mfma_f32_16x16x32_bf16 v[96:99], a[4:7], a[116:119], v[96:99]
v_mfma_f32_16x16x32_bf16 v[96:99], a[0:3], a[112:115], v[96:99]
s_waitcnt lgkmcnt(0)
v_mfma_f32_16x16x32_bf16 v[36:39], a[0:3], a[72:75], v[36:39]
v_mfma_f32_16x16x32_bf16 v[36:39], a[4:7], a[76:79], v[36:39]
v_mfma_f32_16x16x32_bf16 v[52:55], a[12:15], a[76:79], v[52:55]
s_waitcnt lgkmcnt(0)
s_barrier
v_mfma_f32_16x16x32_bf16 v[52:55], a[8:11], a[72:75], v[52:55]
s_add_u32 m0, s77, 65536
ds_read_b64_tr_b16 a[104:105], v4 offset:32768
v_mfma_f32_16x16x32_bf16 v[68:71], a[16:19], a[72:75], v[68:71]
s_add_u32 s64, s71, 524288
ds_read_b64_tr_b16 a[106:107], v4 offset:33792
v_mfma_f32_16x16x32_bf16 v[68:71], a[20:23], a[76:79], v[68:71]
buffer_load_dwordx4 v14, s[56:59], s64 offen lds
v_mfma_f32_16x16x32_bf16 v[84:87], a[28:31], a[76:79], v[84:87]
ds_read_b64_tr_b16 a[108:109], v4 offset:40960
v_mfma_f32_16x16x32_bf16 v[84:87], a[24:27], a[72:75], v[84:87]
ds_read_b64_tr_b16 a[110:111], v4 offset:41984
v_mfma_f32_16x16x32_bf16 v[148:151], a[24:27], a[80:83], v[148:151]
ds_read_b64_tr_b16 a[112:113], v5 offset:32768
v_mfma_f32_16x16x32_bf16 v[148:151], a[28:31], a[84:87], v[148:151]
ds_read_b64_tr_b16 a[114:115], v5 offset:33792
v_mfma_f32_16x16x32_bf16 v[132:135], a[20:23], a[84:87], v[132:135]
ds_read_b64_tr_b16 a[116:117], v5 offset:40960
v_mfma_f32_16x16x32_bf16 v[132:135], a[16:19], a[80:83], v[132:135]
ds_read_b64_tr_b16 a[118:119], v5 offset:41984
v_mfma_f32_16x16x32_bf16 v[116:119], a[8:11], a[80:83], v[116:119]
s_add_u32 m0, s78, 81920
ds_read_b64_tr_b16 a[72:73], v6 offset:32768
v_mfma_f32_16x16x32_bf16 v[116:119], a[12:15], a[84:87], v[116:119]
s_add_u32 s64, s75, 393216
ds_read_b64_tr_b16 a[74:75], v6 offset:33792
v_mfma_f32_16x16x32_bf16 v[100:103], a[4:7], a[84:87], v[100:103]
buffer_load_dwordx4 v23, s[60:63], s64 offen lds
v_mfma_f32_16x16x32_bf16 v[100:103], a[0:3], a[80:83], v[100:103]
ds_read_b64_tr_b16 a[76:77], v6 offset:40960
v_mfma_f32_16x16x32_bf16 v[248:251], a[0:3], a[88:91], v[248:251]
ds_read_b64_tr_b16 a[78:79], v6 offset:41984
v_mfma_f32_16x16x32_bf16 v[248:251], a[4:7], a[92:95], v[248:251]
ds_read_b64_tr_b16 a[80:81], v7 offset:32768
v_mfma_f32_16x16x32_bf16 v[252:255], a[12:15], a[92:95], v[252:255]
ds_read_b64_tr_b16 a[82:83], v7 offset:33792
v_mfma_f32_16x16x32_bf16 v[252:255], a[8:11], a[88:91], v[252:255]
ds_read_b64_tr_b16 a[84:85], v7 offset:40960
v_mfma_f32_16x16x32_bf16 a[120:123], a[16:19], a[88:91], a[120:123]
ds_read_b64_tr_b16 a[86:87], v7 offset:41984
v_mfma_f32_16x16x32_bf16 a[120:123], a[20:23], a[92:95], a[120:123]
s_add_u32 m0, s77, 66560
v_mfma_f32_16x16x32_bf16 a[124:127], a[28:31], a[92:95], a[124:127]
s_add_u32 s64, s71, 557056
v_mfma_f32_16x16x32_bf16 a[124:127], a[24:27], a[88:91], a[124:127]
buffer_load_dwordx4 v14, s[56:59], s64 offen lds
v_mfma_f32_16x16x32_bf16 a[128:131], a[24:27], a[96:99], a[128:131]
ds_read_b64_tr_b16 a[88:89], v8 offset:32768
v_mfma_f32_16x16x32_bf16 a[128:131], a[28:31], a[100:103], a[128:131]
ds_read_b64_tr_b16 a[90:91], v8 offset:33792
v_mfma_f32_16x16x32_bf16 a[132:135], a[20:23], a[100:103], a[132:135]
ds_read_b64_tr_b16 a[92:93], v8 offset:40960
v_mfma_f32_16x16x32_bf16 a[132:135], a[16:19], a[96:99], a[132:135]
ds_read_b64_tr_b16 a[94:95], v8 offset:41984
v_mfma_f32_16x16x32_bf16 a[136:139], a[8:11], a[96:99], a[136:139]
v_mfma_f32_16x16x32_bf16 a[136:139], a[12:15], a[100:103], a[136:139]
v_mfma_f32_16x16x32_bf16 a[140:143], a[4:7], a[100:103], a[140:143]
s_add_u32 m0, s78, 86016
v_mfma_f32_16x16x32_bf16 a[140:143], a[0:3], a[96:99], a[140:143]
s_waitcnt lgkmcnt(4)
s_add_u32 s64, s75, 395264
ds_read_b64_tr_b16 a[96:97], v9 offset:32768
v_mfma_f32_16x16x32_bf16 v[184:187], a[104:107], a[32:35], v[184:187]
s_lshl_b32 s66, s30, 30
buffer_load_dwordx4 v23, s[60:63], s64 offen lds
v_mfma_f32_16x16x32_bf16 v[184:187], a[108:111], a[36:39], v[184:187]
ds_read_b64_tr_b16 a[98:99], v9 offset:33792
v_lshl_add_u32 v1, v0, 24, s66
v_mfma_f32_16x16x32_bf16 v[192:195], a[108:111], a[44:47], v[192:195]
s_lshr_b32 s66, s3, 1
ds_read_b64_tr_b16 a[100:101], v9 offset:40960
v_mfma_f32_16x16x32_bf16 v[192:195], a[104:107], a[40:43], v[192:195]
s_lshl_b32 s66, s66, 12
ds_read_b64_tr_b16 a[102:103], v9 offset:41984
v_mfma_f32_16x16x32_bf16 v[200:203], a[104:107], a[48:51], v[200:203]
v_mfma_f32_16x16x32_bf16 v[200:203], a[108:111], a[52:55], v[200:203]
v_mfma_f32_16x16x32_bf16 v[208:211], a[108:111], a[60:63], v[208:211]
v_mfma_f32_16x16x32_bf16 v[208:211], a[104:107], a[56:59], v[208:211]
ds_read_b64_tr_b16 a[104:105], v10 offset:32768
v_mfma_f32_16x16x32_bf16 v[212:215], a[112:115], a[56:59], v[212:215]
s_add_u32 m0, s77, 67584
ds_read_b64_tr_b16 a[106:107], v10 offset:33792
v_mfma_f32_16x16x32_bf16 v[212:215], a[116:119], a[60:63], v[212:215]
s_add_u32 s64, s71, 589824
ds_read_b64_tr_b16 a[108:109], v10 offset:40960
v_mfma_f32_16x16x32_bf16 v[204:207], a[116:119], a[52:55], v[204:207]
buffer_load_dwordx4 v15, s[56:59], s64 offen lds
v_mfma_f32_16x16x32_bf16 v[204:207], a[112:115], a[48:51], v[204:207]
ds_read_b64_tr_b16 a[110:111], v10 offset:41984
v_mfma_f32_16x16x32_bf16 v[196:199], a[112:115], a[40:43], v[196:199]
v_mfma_f32_16x16x32_bf16 v[196:199], a[116:119], a[44:47], v[196:199]
v_mfma_f32_16x16x32_bf16 v[188:191], a[116:119], a[36:39], v[188:191]
v_mfma_f32_16x16x32_bf16 v[188:191], a[112:115], a[32:35], v[188:191]
s_add_u32 s67, s79, 20480
ds_read_b64_tr_b16 a[112:113], v11 offset:32768
v_mfma_f32_16x16x32_bf16 v[216:219], a[72:75], a[32:35], v[216:219]
ds_read_b64_tr_b16 a[114:115], v11 offset:33792
v_mfma_f32_16x16x32_bf16 v[216:219], a[76:79], a[36:39], v[216:219]
s_add_u32 m0, s78, 90112
ds_read_b64_tr_b16 a[116:117], v11 offset:40960
v_cvt_pk_bf16_f32 v215, v214, v215
v_mfma_f32_16x16x32_bf16 v[224:227], a[76:79], a[44:47], v[224:227]
s_add_u32 s64, s75, 397312
ds_read_b64_tr_b16 a[118:119], v11 offset:41984
v_cvt_pk_bf16_f32 v214, v212, v213
v_mfma_f32_16x16x32_bf16 v[224:227], a[72:75], a[40:43], v[224:227]
buffer_load_dwordx4 v23, s[60:63], s64 offen lds
v_mfma_f32_16x16x32_bf16 v[232:235], a[72:75], a[48:51], v[232:235]
v_cvt_pk_bf16_f32 v212, v208, v209
v_cvt_pk_bf16_f32 v213, v210, v211
v_mfma_f32_16x16x32_bf16 v[232:235], a[76:79], a[52:55], v[232:235]
buffer_store_dwordx4 v[212:215], v16, s[44:47], s67 offen sc1
v_mfma_f32_16x16x32_bf16 v[240:243], a[76:79], a[60:63], v[240:243]
v_cvt_pk_bf16_f32 v207, v206, v207
v_cvt_pk_bf16_f32 v206, v204, v205
v_mfma_f32_16x16x32_bf16 v[240:243], a[72:75], a[56:59], v[240:243]
ds_read_b64_tr_b16 a[72:73], v4 offset:49152
v_cvt_pk_bf16_f32 v204, v200, v201
v_mfma_f32_16x16x32_bf16 v[244:247], a[80:83], a[56:59], v[244:247]
ds_read_b64_tr_b16 a[74:75], v4 offset:50176
v_cvt_pk_bf16_f32 v205, v202, v203
v_mfma_f32_16x16x32_bf16 v[244:247], a[84:87], a[60:63], v[244:247]
ds_read_b64_tr_b16 a[76:77], v4 offset:57344
v_accvgpr_write_b32 a144, v204
v_mfma_f32_16x16x32_bf16 v[236:239], a[84:87], a[52:55], v[236:239]
s_add_u32 m0, s77, 68608
ds_read_b64_tr_b16 a[78:79], v4 offset:58368
v_accvgpr_write_b32 a145, v205
v_mfma_f32_16x16x32_bf16 v[236:239], a[80:83], a[48:51], v[236:239]
s_add_u32 s64, s71, 622592
v_accvgpr_write_b32 a146, v206
v_accvgpr_write_b32 a147, v207
v_mfma_f32_16x16x32_bf16 v[228:231], a[80:83], a[40:43], v[228:231]
buffer_load_dwordx4 v15, s[56:59], s64 offen lds
v_mfma_f32_16x16x32_bf16 v[228:231], a[84:87], a[44:47], v[228:231]
v_cvt_pk_bf16_f32 v199, v198, v199
v_cvt_pk_bf16_f32 v198, v196, v197
v_mfma_f32_16x16x32_bf16 v[220:223], a[84:87], a[36:39], v[220:223]
v_cvt_pk_bf16_f32 v196, v192, v193
v_cvt_pk_bf16_f32 v197, v194, v195
v_mfma_f32_16x16x32_bf16 v[220:223], a[80:83], a[32:35], v[220:223]
s_waitcnt lgkmcnt(4)
ds_read_b64_tr_b16 a[80:81], v5 offset:49152
v_accvgpr_write_b32 a148, v196
v_mfma_f32_16x16x32_bf16 v[152:155], a[88:91], a[32:35], v[152:155]
ds_read_b64_tr_b16 a[82:83], v5 offset:50176
v_accvgpr_write_b32 a149, v197
v_mfma_f32_16x16x32_bf16 v[152:155], a[92:95], a[36:39], v[152:155]
ds_read_b64_tr_b16 a[84:85], v5 offset:57344
v_accvgpr_write_b32 a150, v198
v_mfma_f32_16x16x32_bf16 v[160:163], a[92:95], a[44:47], v[160:163]
ds_read_b64_tr_b16 a[86:87], v5 offset:58368
v_accvgpr_write_b32 a151, v199
v_mfma_f32_16x16x32_bf16 v[160:163], a[88:91], a[40:43], v[160:163]
v_cvt_pk_bf16_f32 v191, v190, v191
v_cvt_pk_bf16_f32 v190, v188, v189
v_mfma_f32_16x16x32_bf16 v[168:171], a[88:91], a[48:51], v[168:171]
v_cvt_pk_bf16_f32 v188, v184, v185
v_cvt_pk_bf16_f32 v189, v186, v187
v_mfma_f32_16x16x32_bf16 v[168:171], a[92:95], a[52:55], v[168:171]
v_accvgpr_write_b32 a152, v188
v_accvgpr_write_b32 a153, v189
v_mfma_f32_16x16x32_bf16 v[176:179], a[92:95], a[60:63], v[176:179]
s_add_u32 m0, s76, 32768
v_accvgpr_write_b32 a154, v190
v_accvgpr_write_b32 a155, v191
v_mfma_f32_16x16x32_bf16 v[176:179], a[88:91], a[56:59], v[176:179]
s_add_u32 s67, s79, 21504
s_add_u32 s64, s72, 128
ds_read_b64_tr_b16 a[88:89], v6 offset:49152
v_cvt_pk_bf16_f32 v247, v246, v247
v_mfma_f32_16x16x32_bf16 v[180:183], a[96:99], a[56:59], v[180:183]
buffer_load_dwordx4 v12, s[48:51], s64 offen lds
v_mfma_f32_16x16x32_bf16 v[180:183], a[100:103], a[60:63], v[180:183]
ds_read_b64_tr_b16 a[90:91], v6 offset:50176
v_cvt_pk_bf16_f32 v246, v244, v245
v_mfma_f32_16x16x32_bf16 v[172:175], a[100:103], a[52:55], v[172:175]
ds_read_b64_tr_b16 a[92:93], v6 offset:57344
v_cvt_pk_bf16_f32 v244, v240, v241
v_mfma_f32_16x16x32_bf16 v[172:175], a[96:99], a[48:51], v[172:175]
ds_read_b64_tr_b16 a[94:95], v6 offset:58368
v_cvt_pk_bf16_f32 v245, v242, v243
v_mfma_f32_16x16x32_bf16 v[164:167], a[96:99], a[40:43], v[164:167]
buffer_store_dwordx4 v[244:247], v16, s[44:47], s67 offen sc1
v_mfma_f32_16x16x32_bf16 v[164:167], a[100:103], a[44:47], v[164:167]
s_add_u32 m0, s76, 33792
v_cvt_pk_bf16_f32 v239, v238, v239
v_cvt_pk_bf16_f32 v238, v236, v237
v_mfma_f32_16x16x32_bf16 v[156:159], a[100:103], a[36:39], v[156:159]
s_add_u32 s64, s72, 16512
v_cvt_pk_bf16_f32 v236, v232, v233
v_cvt_pk_bf16_f32 v237, v234, v235
v_mfma_f32_16x16x32_bf16 v[156:159], a[96:99], a[32:35], v[156:159]
buffer_load_dwordx4 v13, s[48:51], s64 offen lds
v_mfma_f32_16x16x32_bf16 v[24:27], a[104:107], a[32:35], v[24:27]
ds_read_b64_tr_b16 a[96:97], v7 offset:49152
v_accvgpr_write_b32 a156, v236
v_mfma_f32_16x16x32_bf16 v[24:27], a[108:111], a[36:39], v[24:27]
ds_read_b64_tr_b16 a[98:99], v7 offset:50176
v_accvgpr_write_b32 a157, v237
v_mfma_f32_16x16x32_bf16 v[40:43], a[108:111], a[44:47], v[40:43]
ds_read_b64_tr_b16 a[100:101], v7 offset:57344
v_accvgpr_write_b32 a158, v238
v_mfma_f32_16x16x32_bf16 v[40:43], a[104:107], a[40:43], v[40:43]
ds_read_b64_tr_b16 a[102:103], v7 offset:58368
v_accvgpr_write_b32 a159, v239
v_mfma_f32_16x16x32_bf16 v[56:59], a[104:107], a[48:51], v[56:59]
s_add_u32 m0, s76, 34816
v_cvt_pk_bf16_f32 v231, v230, v231
v_cvt_pk_bf16_f32 v230, v228, v229
v_mfma_f32_16x16x32_bf16 v[56:59], a[108:111], a[52:55], v[56:59]
s_add_u32 s64, s72, 131200
v_cvt_pk_bf16_f32 v228, v224, v225
v_cvt_pk_bf16_f32 v229, v226, v227
v_mfma_f32_16x16x32_bf16 v[72:75], a[108:111], a[60:63], v[72:75]
s_waitcnt vmcnt(11)
buffer_load_dwordx4 v12, s[48:51], s64 offen lds
v_mfma_f32_16x16x32_bf16 v[72:75], a[104:107], a[56:59], v[72:75]
ds_read_b64_tr_b16 a[104:105], v8 offset:49152
v_accvgpr_write_b32 a160, v228
v_mfma_f32_16x16x32_bf16 v[136:139], a[112:115], a[56:59], v[136:139]
ds_read_b64_tr_b16 a[106:107], v8 offset:50176
v_accvgpr_write_b32 a161, v229
v_mfma_f32_16x16x32_bf16 v[136:139], a[116:119], a[60:63], v[136:139]
ds_read_b64_tr_b16 a[108:109], v8 offset:57344
v_add_u32 v4, 0x8000, v4
v_mfma_f32_16x16x32_bf16 v[120:123], a[116:119], a[52:55], v[120:123]
ds_read_b64_tr_b16 a[110:111], v8 offset:58368
v_accvgpr_write_b32 a162, v230
v_mfma_f32_16x16x32_bf16 v[120:123], a[112:115], a[48:51], v[120:123]
s_add_u32 m0, s76, 35840
ds_read_b128 a[0:3], v2 offset:0
v_accvgpr_write_b32 a163, v231
v_mfma_f32_16x16x32_bf16 v[104:107], a[112:115], a[40:43], v[104:107]
s_add_u32 s64, s72, 147584
ds_read_b128 a[4:7], v3 offset:0
v_cvt_pk_bf16_f32 v223, v222, v223
v_mfma_f32_16x16x32_bf16 v[104:107], a[116:119], a[44:47], v[104:107]
buffer_load_dwordx4 v13, s[48:51], s64 offen lds
v_mfma_f32_16x16x32_bf16 v[88:91], a[116:119], a[36:39], v[88:91]
ds_read_b128 a[8:11], v2 offset:2048
v_cvt_pk_bf16_f32 v222, v220, v221
v_mfma_f32_16x16x32_bf16 v[88:91], a[112:115], a[32:35], v[88:91]
s_waitcnt lgkmcnt(7)
ds_read_b128 a[12:15], v3 offset:2048
v_cvt_pk_bf16_f32 v220, v216, v217
v_mfma_f32_16x16x32_bf16 v[28:31], a[32:35], a[72:75], v[28:31]
ds_read_b128 a[16:19], v2 offset:4096
v_cvt_pk_bf16_f32 v221, v218, v219
v_mfma_f32_16x16x32_bf16 v[28:31], a[36:39], a[76:79], v[28:31]
ds_read_b128 a[20:23], v3 offset:4096
v_add_u32 v5, 0x8000, v5
v_mfma_f32_16x16x32_bf16 v[44:47], a[44:47], a[76:79], v[44:47]
s_add_u32 m0, s76, 36864
ds_read_b128 a[24:27], v2 offset:6144
v_accvgpr_write_b32 a164, v220
v_mfma_f32_16x16x32_bf16 v[44:47], a[40:43], a[72:75], v[44:47]
s_add_u32 s64, s73, 128
ds_read_b128 a[28:31], v3 offset:6144
v_accvgpr_write_b32 a165, v221
v_mfma_f32_16x16x32_bf16 v[60:63], a[48:51], a[72:75], v[60:63]
buffer_load_dwordx4 v12, s[48:51], s64 offen lds
v_mfma_f32_16x16x32_bf16 v[60:63], a[52:55], a[76:79], v[60:63]
ds_read_b64_tr_b16 a[112:113], v9 offset:49152
v_accvgpr_write_b32 a166, v222
v_mfma_f32_16x16x32_bf16 v[76:79], a[60:63], a[76:79], v[76:79]
ds_read_b64_tr_b16 a[114:115], v9 offset:50176
v_accvgpr_write_b32 a167, v223
v_mfma_f32_16x16x32_bf16 v[76:79], a[56:59], a[72:75], v[76:79]
s_add_u32 s67, s79, 22528
ds_read_b64_tr_b16 a[116:117], v9 offset:57344
v_cvt_pk_bf16_f32 v183, v182, v183
v_mfma_f32_16x16x32_bf16 v[140:143], a[56:59], a[80:83], v[140:143]
ds_read_b64_tr_b16 a[118:119], v9 offset:58368
v_cvt_pk_bf16_f32 v182, v180, v181
v_mfma_f32_16x16x32_bf16 v[140:143], a[60:63], a[84:87], v[140:143]
s_add_u32 m0, s76, 37888
ds_read_b64_tr_b16 a[72:73], v10 offset:49152
v_add_u32 v6, 0x8000, v6
v_mfma_f32_16x16x32_bf16 v[124:127], a[52:55], a[84:87], v[124:127]
s_add_u32 s64, s73, 16512
ds_read_b64_tr_b16 a[74:75], v10 offset:50176
v_cvt_pk_bf16_f32 v180, v176, v177
v_mfma_f32_16x16x32_bf16 v[124:127], a[48:51], a[80:83], v[124:127]
buffer_load_dwordx4 v13, s[48:51], s64 offen lds
v_mfma_f32_16x16x32_bf16 v[108:111], a[40:43], a[80:83], v[108:111]
ds_read_b64_tr_b16 a[76:77], v10 offset:57344
v_cvt_pk_bf16_f32 v181, v178, v179
v_mfma_f32_16x16x32_bf16 v[108:111], a[44:47], a[84:87], v[108:111]
ds_read_b64_tr_b16 a[78:79], v10 offset:58368
v_mfma_f32_16x16x32_bf16 v[92:95], a[36:39], a[84:87], v[92:95]
buffer_store_dwordx4 v[180:183], v16, s[44:47], s67 offen sc1
v_mfma_f32_16x16x32_bf16 v[92:95], a[32:35], a[80:83], v[92:95]
ds_read_b64_tr_b16 a[80:81], v11 offset:49152
v_cvt_pk_bf16_f32 v175, v174, v175
v_mfma_f32_16x16x32_bf16 v[32:35], a[32:35], a[88:91], v[32:35]
s_add_u32 m0, s76, 38912
ds_read_b64_tr_b16 a[82:83], v11 offset:50176
v_cvt_pk_bf16_f32 v174, v172, v173
v_mfma_f32_16x16x32_bf16 v[32:35], a[36:39], a[92:95], v[32:35]
s_add_u32 s64, s73, 131200
ds_read_b64_tr_b16 a[84:85], v11 offset:57344
v_add_u32 v7, 0x8000, v7
v_mfma_f32_16x16x32_bf16 v[48:51], a[44:47], a[92:95], v[48:51]
buffer_load_dwordx4 v12, s[48:51], s64 offen lds
v_mfma_f32_16x16x32_bf16 v[48:51], a[40:43], a[88:91], v[48:51]
ds_read_b64_tr_b16 a[86:87], v11 offset:58368
v_cvt_pk_bf16_f32 v172, v168, v169
v_mfma_f32_16x16x32_bf16 v[64:67], a[48:51], a[88:91], v[64:67]
v_cvt_pk_bf16_f32 v173, v170, v171
v_accvgpr_write_b32 a168, v172
v_mfma_f32_16x16x32_bf16 v[64:67], a[52:55], a[92:95], v[64:67]
v_accvgpr_write_b32 a169, v173
v_accvgpr_write_b32 a170, v174
v_mfma_f32_16x16x32_bf16 v[80:83], a[60:63], a[92:95], v[80:83]
v_accvgpr_write_b32 a171, v175
v_cvt_pk_bf16_f32 v167, v166, v167
v_mfma_f32_16x16x32_bf16 v[80:83], a[56:59], a[88:91], v[80:83]
s_add_u32 m0, s76, 39936
v_cvt_pk_bf16_f32 v166, v164, v165
v_cvt_pk_bf16_f32 v164, v160, v161
v_mfma_f32_16x16x32_bf16 v[144:147], a[56:59], a[96:99], v[144:147]
s_add_u32 s64, s73, 147584
v_cvt_pk_bf16_f32 v165, v162, v163
v_accvgpr_write_b32 a172, v164
v_mfma_f32_16x16x32_bf16 v[144:147], a[60:63], a[100:103], v[144:147]
buffer_load_dwordx4 v13, s[48:51], s64 offen lds
v_mfma_f32_16x16x32_bf16 v[128:131], a[52:55], a[100:103], v[128:131]
v_add_u32 v8, 0x8000, v8
v_accvgpr_write_b32 a173, v165
v_mfma_f32_16x16x32_bf16 v[128:131], a[48:51], a[96:99], v[128:131]
v_accvgpr_write_b32 a174, v166
v_accvgpr_write_b32 a175, v167
v_mfma_f32_16x16x32_bf16 v[112:115], a[40:43], a[96:99], v[112:115]
v_cvt_pk_bf16_f32 v159, v158, v159
v_cvt_pk_bf16_f32 v158, v156, v157
v_mfma_f32_16x16x32_bf16 v[112:115], a[44:47], a[100:103], v[112:115]
v_cvt_pk_bf16_f32 v156, v152, v153
v_cvt_pk_bf16_f32 v157, v154, v155
v_mfma_f32_16x16x32_bf16 v[96:99], a[36:39], a[100:103], v[96:99]
v_add_u32 v9, 0x8000, v9
v_add_u32 v10, 0x8000, v10
v_mfma_f32_16x16x32_bf16 v[96:99], a[32:35], a[96:99], v[96:99]
s_waitcnt lgkmcnt(0)
v_add_u32 v11, 0x8000, v11
v_accvgpr_write_b32 a176, v156
v_mfma_f32_16x16x32_bf16 v[36:39], a[32:35], a[104:107], v[36:39]
v_accvgpr_write_b32 a177, v157
v_accvgpr_write_b32 a178, v158
v_mfma_f32_16x16x32_bf16 v[36:39], a[36:39], a[108:111], v[36:39]
v_accvgpr_write_b32 a179, v159
v_mfma_f32_16x16x32_bf16 v[52:55], a[44:47], a[108:111], v[52:55]
s_add_u32 s67, s79, 23552
s_waitcnt lgkmcnt(0)
s_barrier
v_mfma_f32_16x16x32_bf16 v[52:55], a[40:43], a[104:107], v[52:55]
s_add_u32 m0, s77, 98304
ds_read_b64_tr_b16 a[88:89], v19 offset:36864
v_cvt_pk_bf16_f32 v139, v138, v139
v_mfma_f32_16x16x32_bf16 v[68:71], a[48:51], a[104:107], v[68:71]
s_add_u32 s64, s71, 1048576
ds_read_b64_tr_b16 a[90:91], v19 offset:37120
v_cvt_pk_bf16_f32 v138, v136, v137
v_mfma_f32_16x16x32_bf16 v[68:71], a[52:55], a[108:111], v[68:71]
buffer_load_dwordx4 v14, s[56:59], s64 offen lds
v_mfma_f32_16x16x32_bf16 v[84:87], a[60:63], a[108:111], v[84:87]
ds_read_b64_tr_b16 a[92:93], v19 offset:38912
v_cvt_pk_bf16_f32 v136, v72, v73
v_mfma_f32_16x16x32_bf16 v[84:87], a[56:59], a[104:107], v[84:87]
ds_read_b64_tr_b16 a[94:95], v19 offset:39168
v_cvt_pk_bf16_f32 v137, v74, v75
v_mfma_f32_16x16x32_bf16 v[148:151], a[56:59], a[112:115], v[148:151]
ds_read_b64_tr_b16 a[96:97], v20 offset:36864
v_mfma_f32_16x16x32_bf16 v[148:151], a[60:63], a[116:119], v[148:151]
ds_read_b64_tr_b16 a[98:99], v20 offset:37120
v_mfma_f32_16x16x32_bf16 v[132:135], a[52:55], a[116:119], v[132:135]
ds_read_b64_tr_b16 a[100:101], v20 offset:38912
v_mfma_f32_16x16x32_bf16 v[132:135], a[48:51], a[112:115], v[132:135]
ds_read_b64_tr_b16 a[102:103], v20 offset:39168
v_mfma_f32_16x16x32_bf16 v[116:119], a[40:43], a[112:115], v[116:119]
s_add_u32 m0, s78, 114688
ds_read_b64_tr_b16 a[104:105], v19 offset:40960
v_mfma_f32_16x16x32_bf16 v[116:119], a[44:47], a[116:119], v[116:119]
s_add_u32 s64, s75, 786432
ds_read_b64_tr_b16 a[106:107], v19 offset:41216
v_mfma_f32_16x16x32_bf16 v[100:103], a[36:39], a[116:119], v[100:103]
buffer_load_dwordx4 v23, s[60:63], s64 offen lds
v_mfma_f32_16x16x32_bf16 v[100:103], a[32:35], a[112:115], v[100:103]
ds_read_b64_tr_b16 a[108:109], v19 offset:43008
v_mfma_f32_16x16x32_bf16 v[248:251], a[32:35], a[72:75], v[248:251]
ds_read_b64_tr_b16 a[110:111], v19 offset:43264
v_mfma_f32_16x16x32_bf16 v[248:251], a[36:39], a[76:79], v[248:251]
ds_read_b64_tr_b16 a[112:113], v20 offset:40960
v_mfma_f32_16x16x32_bf16 v[252:255], a[44:47], a[76:79], v[252:255]
ds_read_b64_tr_b16 a[114:115], v20 offset:41216
v_mfma_f32_16x16x32_bf16 v[252:255], a[40:43], a[72:75], v[252:255]
ds_read_b64_tr_b16 a[116:117], v20 offset:43008
v_mfma_f32_16x16x32_bf16 a[120:123], a[48:51], a[72:75], a[120:123]
ds_read_b64_tr_b16 a[118:119], v20 offset:43264
v_mfma_f32_16x16x32_bf16 a[120:123], a[52:55], a[76:79], a[120:123]
s_add_u32 m0, s77, 99328
buffer_store_dwordx4 v[136:139], v16, s[44:47], s67 offen sc1
v_mfma_f32_16x16x32_bf16 a[124:127], a[60:63], a[76:79], a[124:127]
s_add_u32 s64, s71, 1081344
v_cvt_pk_bf16_f32 v123, v122, v123
v_cvt_pk_bf16_f32 v122, v120, v121
v_mfma_f32_16x16x32_bf16 a[124:127], a[56:59], a[72:75], a[124:127]
buffer_load_dwordx4 v14, s[56:59], s64 offen lds
v_mfma_f32_16x16x32_bf16 a[128:131], a[56:59], a[80:83], a[128:131]
ds_read_b64_tr_b16 a[72:73], v19 offset:32768
v_cvt_pk_bf16_f32 v120, v56, v57
v_mfma_f32_16x16x32_bf16 a[128:131], a[60:63], a[84:87], a[128:131]
ds_read_b64_tr_b16 a[74:75], v19 offset:33024
v_cvt_pk_bf16_f32 v121, v58, v59
v_mfma_f32_16x16x32_bf16 a[132:135], a[52:55], a[84:87], a[132:135]
ds_read_b64_tr_b16 a[76:77], v19 offset:34816
v_accvgpr_write_b32 a180, v120
v_mfma_f32_16x16x32_bf16 a[132:135], a[48:51], a[80:83], a[132:135]
ds_read_b64_tr_b16 a[78:79], v19 offset:35072
v_accvgpr_write_b32 a181, v121
v_mfma_f32_16x16x32_bf16 a[136:139], a[40:43], a[80:83], a[136:139]
v_accvgpr_write_b32 a182, v122
v_accvgpr_write_b32 a183, v123
v_mfma_f32_16x16x32_bf16 a[136:139], a[44:47], a[84:87], a[136:139]
v_cvt_pk_bf16_f32 v107, v106, v107
v_cvt_pk_bf16_f32 v106, v104, v105
v_mfma_f32_16x16x32_bf16 a[140:143], a[36:39], a[84:87], a[140:143]
s_add_u32 m0, s78, 118784
v_cvt_pk_bf16_f32 v104, v40, v41
v_cvt_pk_bf16_f32 v105, v42, v43
v_mfma_f32_16x16x32_bf16 a[140:143], a[32:35], a[80:83], a[140:143]
s_waitcnt lgkmcnt(4)
s_add_u32 s64, s75, 788480
ds_read_b64_tr_b16 a[80:81], v20 offset:32768
v_accvgpr_write_b32 a184, v104
v_mfma_f32_16x16x32_bf16 v[184:187], a[88:91], a[0:3], 0
buffer_load_dwordx4 v23, s[60:63], s64 offen lds
v_mfma_f32_16x16x32_bf16 v[184:187], a[92:95], a[4:7], v[184:187]
ds_read_b64_tr_b16 a[82:83], v20 offset:33024
v_accvgpr_write_b32 a185, v105
v_mfma_f32_16x16x32_bf16 v[192:195], a[92:95], a[12:15], 0
ds_read_b64_tr_b16 a[84:85], v20 offset:34816
v_accvgpr_write_b32 a186, v106
v_mfma_f32_16x16x32_bf16 v[192:195], a[88:91], a[8:11], v[192:195]
s_add_u32 s17, s78, .-L_pc+6144
ds_read_b64_tr_b16 a[86:87], v20 offset:35072
v_accvgpr_write_b32 a187, v107
v_mfma_f32_16x16x32_bf16 v[200:203], a[88:91], a[16:19], 0
buffer_load_dword a252, v16, s[88:91], s17 offen
v_mfma_f32_16x16x32_bf16 v[200:203], a[92:95], a[20:23], v[200:203]
v_cvt_pk_bf16_f32 v91, v90, v91
v_cvt_pk_bf16_f32 v90, v88, v89
v_mfma_f32_16x16x32_bf16 v[208:211], a[92:95], a[28:31], 0
v_cvt_pk_bf16_f32 v88, v24, v25
v_cvt_pk_bf16_f32 v89, v26, v27
v_mfma_f32_16x16x32_bf16 v[208:211], a[88:91], a[24:27], v[208:211]
ds_read_b64_tr_b16 a[88:89], v4 offset:32768
v_accvgpr_write_b32 a188, v88
v_mfma_f32_16x16x32_bf16 v[212:215], a[96:99], a[24:27], 0
s_add_u32 m0, s77, 100352
ds_read_b64_tr_b16 a[90:91], v4 offset:33792
v_accvgpr_write_b32 a189, v89
v_mfma_f32_16x16x32_bf16 v[212:215], a[100:103], a[28:31], v[212:215]
s_add_u32 s64, s71, 1114112
ds_read_b64_tr_b16 a[92:93], v4 offset:40960
v_accvgpr_write_b32 a190, v90
v_mfma_f32_16x16x32_bf16 v[204:207], a[100:103], a[20:23], 0
buffer_load_dwordx4 v15, s[56:59], s64 offen lds
v_mfma_f32_16x16x32_bf16 v[204:207], a[96:99], a[16:19], v[204:207]
ds_read_b64_tr_b16 a[94:95], v4 offset:41984
v_accvgpr_write_b32 a191, v91
v_mfma_f32_16x16x32_bf16 v[196:199], a[96:99], a[8:11], 0
s_add_u32 s67, s79, 8192
v_cvt_pk_bf16_f32 v47, v46, v47
v_cvt_pk_bf16_f32 v46, v44, v45
v_mfma_f32_16x16x32_bf16 v[196:199], a[100:103], a[12:15], v[196:199]
v_cvt_pk_bf16_f32 v44, v28, v29
v_cvt_pk_bf16_f32 v45, v30, v31
v_mfma_f32_16x16x32_bf16 v[188:191], a[100:103], a[4:7], 0
buffer_store_dwordx4 v[44:47], v16, s[44:47], s67 offen sc1
v_mfma_f32_16x16x32_bf16 v[188:191], a[96:99], a[0:3], v[188:191]
ds_read_b64_tr_b16 a[96:97], v5 offset:32768
v_cvt_pk_bf16_f32 v79, v78, v79
v_mfma_f32_16x16x32_bf16 v[216:219], a[0:3], a[104:107], 0
ds_read_b64_tr_b16 a[98:99], v5 offset:33792
v_cvt_pk_bf16_f32 v78, v76, v77
v_mfma_f32_16x16x32_bf16 v[216:219], a[4:7], a[108:111], v[216:219]
s_add_u32 m0, s78, 122880
ds_read_b64_tr_b16 a[100:101], v5 offset:40960
v_cvt_pk_bf16_f32 v76, v60, v61
v_mfma_f32_16x16x32_bf16 v[224:227], a[12:15], a[108:111], 0
s_add_u32 s64, s75, 790528
ds_read_b64_tr_b16 a[102:103], v5 offset:41984
v_cvt_pk_bf16_f32 v77, v62, v63
v_mfma_f32_16x16x32_bf16 v[224:227], a[8:11], a[104:107], v[224:227]
buffer_load_dwordx4 v23, s[60:63], s64 offen lds
v_mfma_f32_16x16x32_bf16 v[232:235], a[16:19], a[104:107], 0
v_accvgpr_write_b32 a192, v76
v_accvgpr_write_b32 a193, v77
v_mfma_f32_16x16x32_bf16 v[232:235], a[20:23], a[108:111], v[232:235]
v_accvgpr_write_b32 a194, v78
v_accvgpr_write_b32 a195, v79
v_mfma_f32_16x16x32_bf16 v[240:243], a[28:31], a[108:111], 0
v_cvt_pk_bf16_f32 v124, v124, v125
v_cvt_pk_bf16_f32 v125, v126, v127
v_mfma_f32_16x16x32_bf16 v[240:243], a[24:27], a[104:107], v[240:243]
ds_read_b64_tr_b16 a[104:105], v6 offset:32768
v_cvt_pk_bf16_f32 v126, v140, v141
v_mfma_f32_16x16x32_bf16 v[244:247], a[24:27], a[112:115], 0
ds_read_b64_tr_b16 a[106:107], v6 offset:33792
v_cvt_pk_bf16_f32 v127, v142, v143
v_mfma_f32_16x16x32_bf16 v[244:247], a[28:31], a[116:119], v[244:247]
ds_read_b64_tr_b16 a[108:109], v6 offset:40960
v_accvgpr_write_b32 a196, v124
v_mfma_f32_16x16x32_bf16 v[236:239], a[20:23], a[116:119], 0
s_add_u32 m0, s77, 101376
ds_read_b64_tr_b16 a[110:111], v6 offset:41984
v_accvgpr_write_b32 a197, v125
v_mfma_f32_16x16x32_bf16 v[236:239], a[16:19], a[112:115], v[236:239]
s_add_u32 s64, s71, 1146880
v_accvgpr_write_b32 a198, v126
v_accvgpr_write_b32 a199, v127
v_mfma_f32_16x16x32_bf16 v[228:231], a[8:11], a[112:115], 0
buffer_load_dwordx4 v15, s[56:59], s64 offen lds
v_mfma_f32_16x16x32_bf16 v[228:231], a[12:15], a[116:119], v[228:231]
v_cvt_pk_bf16_f32 v92, v92, v93
v_cvt_pk_bf16_f32 v93, v94, v95
v_mfma_f32_16x16x32_bf16 v[220:223], a[4:7], a[116:119], 0
v_cvt_pk_bf16_f32 v94, v108, v109
v_cvt_pk_bf16_f32 v95, v110, v111
v_mfma_f32_16x16x32_bf16 v[220:223], a[0:3], a[112:115], v[220:223]
s_waitcnt lgkmcnt(4)
ds_read_b64_tr_b16 a[112:113], v7 offset:32768
v_accvgpr_write_b32 a200, v92
v_mfma_f32_16x16x32_bf16 v[152:155], a[72:75], a[0:3], 0
ds_read_b64_tr_b16 a[114:115], v7 offset:33792
v_accvgpr_write_b32 a201, v93
v_mfma_f32_16x16x32_bf16 v[152:155], a[76:79], a[4:7], v[152:155]
ds_read_b64_tr_b16 a[116:117], v7 offset:40960
v_accvgpr_write_b32 a202, v94
v_mfma_f32_16x16x32_bf16 v[160:163], a[76:79], a[12:15], 0
ds_read_b64_tr_b16 a[118:119], v7 offset:41984
v_accvgpr_write_b32 a203, v95
v_mfma_f32_16x16x32_bf16 v[160:163], a[72:75], a[8:11], v[160:163]
s_add_u32 s67, s79, 10240
v_cvt_pk_bf16_f32 v51, v50, v51
v_cvt_pk_bf16_f32 v50, v48, v49
v_mfma_f32_16x16x32_bf16 v[168:171], a[72:75], a[16:19], 0
v_cvt_pk_bf16_f32 v48, v32, v33
v_cvt_pk_bf16_f32 v49, v34, v35
v_mfma_f32_16x16x32_bf16 v[168:171], a[76:79], a[20:23], v[168:171]
buffer_store_dwordx4 v[48:51], v16, s[44:47], s67 offen sc1
v_mfma_f32_16x16x32_bf16 v[176:179], a[76:79], a[28:31], 0
s_add_u32 m0, s76, 0
v_subrev_u32 v19, 0x8000, v19
v_subrev_u32 v20, 0x8000, v20
v_mfma_f32_16x16x32_bf16 v[176:179], a[72:75], a[24:27], v[176:179]
s_add_u32 s64, s72, 256
ds_read_b64_tr_b16 a[72:73], v8 offset:32768
v_cvt_pk_bf16_f32 v83, v82, v83
v_mfma_f32_16x16x32_bf16 v[180:183], a[80:83], a[24:27], 0
buffer_load_dwordx4 v12, s[48:51], s64 offen lds
v_mfma_f32_16x16x32_bf16 v[180:183], a[84:87], a[28:31], v[180:183]
ds_read_b64_tr_b16 a[74:75], v8 offset:33792
v_subrev_u32 v4, 0x8000, v4
v_mfma_f32_16x16x32_bf16 v[172:175], a[84:87], a[20:23], 0
ds_read_b64_tr_b16 a[76:77], v8 offset:40960
v_cvt_pk_bf16_f32 v82, v80, v81
v_mfma_f32_16x16x32_bf16 v[172:175], a[80:83], a[16:19], v[172:175]
s_add_u32 m0, s76, 1024
ds_read_b64_tr_b16 a[78:79], v8 offset:41984
v_cvt_pk_bf16_f32 v80, v64, v65
v_mfma_f32_16x16x32_bf16 v[164:167], a[80:83], a[8:11], 0
s_add_u32 s64, s72, 16640
v_cvt_pk_bf16_f32 v81, v66, v67
v_accvgpr_write_b32 a204, v80
v_mfma_f32_16x16x32_bf16 v[164:167], a[84:87], a[12:15], v[164:167]
buffer_load_dwordx4 v13, s[48:51], s64 offen lds
v_mfma_f32_16x16x32_bf16 v[156:159], a[84:87], a[4:7], 0
v_accvgpr_write_b32 a205, v81
v_accvgpr_write_b32 a206, v82
v_mfma_f32_16x16x32_bf16 v[156:159], a[80:83], a[0:3], v[156:159]
ds_read_b64_tr_b16 a[80:81], v9 offset:32768
v_accvgpr_write_b32 a207, v83
v_mfma_f32_16x16x32_bf16 v[24:27], a[88:91], a[0:3], 0
s_add_u32 m0, s76, 2048
ds_read_b64_tr_b16 a[82:83], v9 offset:33792
v_cvt_pk_bf16_f32 v128, v128, v129
v_mfma_f32_16x16x32_bf16 v[24:27], a[92:95], a[4:7], v[24:27]
s_add_u32 s64, s72, 131328
ds_read_b64_tr_b16 a[84:85], v9 offset:40960
v_subrev_u32 v5, 0x8000, v5
v_mfma_f32_16x16x32_bf16 v[40:43], a[92:95], a[12:15], 0
buffer_load_dwordx4 v12, s[48:51], s64 offen lds
v_mfma_f32_16x16x32_bf16 v[40:43], a[88:91], a[8:11], v[40:43]
ds_read_b64_tr_b16 a[86:87], v9 offset:41984
v_cvt_pk_bf16_f32 v129, v130, v131
v_mfma_f32_16x16x32_bf16 v[56:59], a[88:91], a[16:19], 0
s_add_u32 m0, s76, 3072
v_cvt_pk_bf16_f32 v130, v144, v145
v_cvt_pk_bf16_f32 v131, v146, v147
v_mfma_f32_16x16x32_bf16 v[56:59], a[92:95], a[20:23], v[56:59]
s_add_u32 s64, s72, 147712
v_accvgpr_write_b32 a208, v128
v_accvgpr_write_b32 a209, v129
v_mfma_f32_16x16x32_bf16 v[72:75], a[92:95], a[28:31], 0
s_waitcnt vmcnt(14)
ds_read_b128 a[32:35], v2 offset:32768
v_accvgpr_write_b32 a210, v130
v_mfma_f32_16x16x32_bf16 v[72:75], a[88:91], a[24:27], v[72:75]
buffer_load_dwordx4 v13, s[48:51], s64 offen lds
v_mfma_f32_16x16x32_bf16 v[136:139], a[96:99], a[24:27], 0
ds_read_b128 a[36:39], v3 offset:32768
v_accvgpr_write_b32 a211, v131
v_mfma_f32_16x16x32_bf16 v[136:139], a[100:103], a[28:31], v[136:139]
ds_read_b128 a[40:43], v2 offset:34816
v_subrev_u32 v6, 0x8000, v6
v_mfma_f32_16x16x32_bf16 v[120:123], a[100:103], a[20:23], 0
s_add_u32 m0, s76, 4096
ds_read_b128 a[44:47], v3 offset:34816
v_cvt_pk_bf16_f32 v96, v96, v97
v_mfma_f32_16x16x32_bf16 v[120:123], a[96:99], a[16:19], v[120:123]
s_add_u32 s64, s73, 256
ds_read_b128 a[48:51], v2 offset:36864
v_cvt_pk_bf16_f32 v97, v98, v99
v_mfma_f32_16x16x32_bf16 v[104:107], a[96:99], a[8:11], 0
buffer_load_dwordx4 v12, s[48:51], s64 offen lds
v_mfma_f32_16x16x32_bf16 v[104:107], a[100:103], a[12:15], v[104:107]
ds_read_b128 a[52:55], v3 offset:36864
v_cvt_pk_bf16_f32 v98, v112, v113
v_mfma_f32_16x16x32_bf16 v[88:91], a[100:103], a[4:7], 0
ds_read_b128 a[56:59], v2 offset:38912
v_cvt_pk_bf16_f32 v99, v114, v115
v_mfma_f32_16x16x32_bf16 v[88:91], a[96:99], a[0:3], v[88:91]
s_waitcnt lgkmcnt(7)
s_add_u32 m0, s76, 5120
ds_read_b128 a[60:63], v3 offset:38912
v_accvgpr_write_b32 a212, v96
v_mfma_f32_16x16x32_bf16 v[28:31], a[104:107], a[0:3], 0
s_add_u32 s64, s73, 16640
ds_read_b64_tr_b16 a[88:89], v10 offset:32768
v_accvgpr_write_b32 a213, v97
v_mfma_f32_16x16x32_bf16 v[28:31], a[108:111], a[4:7], v[28:31]
buffer_load_dwordx4 v13, s[48:51], s64 offen lds
v_mfma_f32_16x16x32_bf16 v[44:47], a[108:111], a[12:15], 0
ds_read_b64_tr_b16 a[90:91], v10 offset:33792
v_subrev_u32 v7, 0x8000, v7
v_mfma_f32_16x16x32_bf16 v[44:47], a[104:107], a[8:11], v[44:47]
s_add_u32 m0, s76, 6144
ds_read_b64_tr_b16 a[92:93], v10 offset:40960
v_accvgpr_write_b32 a214, v98
v_mfma_f32_16x16x32_bf16 v[60:63], a[104:107], a[16:19], 0
s_add_u32 s64, s73, 131328
ds_read_b64_tr_b16 a[94:95], v10 offset:41984
v_accvgpr_write_b32 a215, v99
v_mfma_f32_16x16x32_bf16 v[60:63], a[108:111], a[20:23], v[60:63]
s_add_u32 s67, s79, 12288
ds_read_b64_tr_b16 a[96:97], v11 offset:32768
v_cvt_pk_bf16_f32 v55, v54, v55
v_mfma_f32_16x16x32_bf16 v[76:79], a[108:111], a[28:31], 0
buffer_load_dwordx4 v12, s[48:51], s64 offen lds
v_mfma_f32_16x16x32_bf16 v[76:79], a[104:107], a[24:27], v[76:79]
ds_read_b64_tr_b16 a[98:99], v11 offset:33792
v_cvt_pk_bf16_f32 v54, v52, v53
v_mfma_f32_16x16x32_bf16 v[140:143], a[112:115], a[24:27], 0
ds_read_b64_tr_b16 a[100:101], v11 offset:40960
v_cvt_pk_bf16_f32 v52, v36, v37
v_mfma_f32_16x16x32_bf16 v[140:143], a[116:119], a[28:31], v[140:143]
s_add_u32 m0, s76, 7168
ds_read_b64_tr_b16 a[102:103], v11 offset:41984
v_subrev_u32 v8, 0x8000, v8
v_mfma_f32_16x16x32_bf16 v[124:127], a[116:119], a[20:23], 0
s_add_u32 s64, s73, 147712
v_cvt_pk_bf16_f32 v53, v38, v39
v_mfma_f32_16x16x32_bf16 v[124:127], a[112:115], a[16:19], v[124:127]
buffer_load_dwordx4 v13, s[48:51], s64 offen lds
v_mfma_f32_16x16x32_bf16 v[108:111], a[112:115], a[8:11], 0
buffer_store_dwordx4 v[52:55], v16, s[44:47], s67 offen sc1
v_mfma_f32_16x16x32_bf16 v[108:111], a[116:119], a[12:15], v[108:111]
v_cvt_pk_bf16_f32 v87, v86, v87
v_cvt_pk_bf16_f32 v86, v84, v85
v_mfma_f32_16x16x32_bf16 v[92:95], a[116:119], a[4:7], 0
v_subrev_u32 v9, 0x8000, v9
v_subrev_u32 v10, 0x8000, v10
v_mfma_f32_16x16x32_bf16 v[92:95], a[112:115], a[0:3], v[92:95]
v_subrev_u32 v11, 0x8000, v11
v_cvt_pk_bf16_f32 v84, v68, v69
v_mfma_f32_16x16x32_bf16 v[32:35], a[72:75], a[0:3], 0
v_cvt_pk_bf16_f32 v85, v70, v71
v_accvgpr_write_b32 a216, v84
v_mfma_f32_16x16x32_bf16 v[32:35], a[76:79], a[4:7], v[32:35]
v_accvgpr_write_b32 a217, v85
v_accvgpr_write_b32 a218, v86
v_mfma_f32_16x16x32_bf16 v[48:51], a[76:79], a[12:15], 0
s_waitcnt lgkmcnt(0)
s_barrier
v_mfma_f32_16x16x32_bf16 v[48:51], a[72:75], a[8:11], v[48:51]
s_add_u32 m0, s77, 131072
ds_read_b64_tr_b16 a[104:105], v19 offset:4096
v_accvgpr_write_b32 a219, v87
v_mfma_f32_16x16x32_bf16 v[64:67], a[72:75], a[16:19], 0
s_add_u32 s64, s71, 1572864
ds_read_b64_tr_b16 a[106:107], v19 offset:4352
v_cvt_pk_bf16_f32 v132, v132, v133
v_mfma_f32_16x16x32_bf16 v[64:67], a[76:79], a[20:23], v[64:67]
buffer_load_dwordx4 v14, s[56:59], s64 offen lds
v_mfma_f32_16x16x32_bf16 v[80:83], a[76:79], a[28:31], 0
ds_read_b64_tr_b16 a[108:109], v19 offset:6144
v_cvt_pk_bf16_f32 v133, v134, v135
v_mfma_f32_16x16x32_bf16 v[80:83], a[72:75], a[24:27], v[80:83]
ds_read_b64_tr_b16 a[110:111], v19 offset:6400
v_cvt_pk_bf16_f32 v134, v148, v149
v_mfma_f32_16x16x32_bf16 v[144:147], a[80:83], a[24:27], 0
ds_read_b64_tr_b16 a[112:113], v20 offset:4096
v_cvt_pk_bf16_f32 v135, v150, v151
v_mfma_f32_16x16x32_bf16 v[144:147], a[84:87], a[28:31], v[144:147]
ds_read_b64_tr_b16 a[114:115], v20 offset:4352
v_accvgpr_write_b32 a220, v132
v_mfma_f32_16x16x32_bf16 v[128:131], a[84:87], a[20:23], 0
ds_read_b64_tr_b16 a[116:117], v20 offset:6144
v_accvgpr_write_b32 a221, v133
v_mfma_f32_16x16x32_bf16 v[128:131], a[80:83], a[16:19], v[128:131]
ds_read_b64_tr_b16 a[118:119], v20 offset:6400
v_accvgpr_write_b32 a222, v134
v_mfma_f32_16x16x32_bf16 v[112:115], a[80:83], a[8:11], 0
s_add_u32 m0, s78, 147456
ds_read_b64_tr_b16 a[72:73], v19 offset:8192
v_accvgpr_write_b32 a223, v135
v_mfma_f32_16x16x32_bf16 v[112:115], a[84:87], a[12:15], v[112:115]
s_add_u32 s64, s75, 1179648
ds_read_b64_tr_b16 a[74:75], v19 offset:8448
v_cvt_pk_bf16_f32 v100, v100, v101
v_mfma_f32_16x16x32_bf16 v[96:99], a[84:87], a[4:7], 0
buffer_load_dwordx4 v23, s[60:63], s64 offen lds
v_mfma_f32_16x16x32_bf16 v[96:99], a[80:83], a[0:3], v[96:99]
ds_read_b64_tr_b16 a[76:77], v19 offset:10240
v_cvt_pk_bf16_f32 v101, v102, v103
v_mfma_f32_16x16x32_bf16 v[36:39], a[88:91], a[0:3], 0
ds_read_b64_tr_b16 a[78:79], v19 offset:10496
v_cvt_pk_bf16_f32 v102, v116, v117
v_mfma_f32_16x16x32_bf16 v[36:39], a[92:95], a[4:7], v[36:39]
ds_read_b64_tr_b16 a[80:81], v20 offset:8192
v_cvt_pk_bf16_f32 v103, v118, v119
v_mfma_f32_16x16x32_bf16 v[52:55], a[92:95], a[12:15], 0
ds_read_b64_tr_b16 a[82:83], v20 offset:8448
v_accvgpr_write_b32 a224, v100
v_mfma_f32_16x16x32_bf16 v[52:55], a[88:91], a[8:11], v[52:55]
ds_read_b64_tr_b16 a[84:85], v20 offset:10240
v_accvgpr_write_b32 a225, v101
v_mfma_f32_16x16x32_bf16 v[68:71], a[88:91], a[16:19], 0
s_add_u32 m0, s77, 132096
ds_read_b64_tr_b16 a[86:87], v20 offset:10496
v_accvgpr_write_b32 a226, v102
v_mfma_f32_16x16x32_bf16 v[68:71], a[92:95], a[20:23], v[68:71]
s_add_u32 s64, s71, 1605632
s_xor_b32 s68, s66, 0
v_accvgpr_write_b32 a227, v103
v_mfma_f32_16x16x32_bf16 v[84:87], a[92:95], a[28:31], 0
s_add_u32 s67, s79, 14336
s_mov_b64 exec, 1
buffer_atomic_add a251, v1, s[52:55], s68 offen offset:0 sc1
s_mov_b64 exec, -1
v_mfma_f32_16x16x32_bf16 v[84:87], a[88:91], a[24:27], v[84:87]
buffer_load_dwordx4 v14, s[56:59], s64 offen lds
v_mfma_f32_16x16x32_bf16 v[148:151], a[96:99], a[24:27], 0
ds_read_b64_tr_b16 a[88:89], v19 offset:0
v_cvt_pk_bf16_f32 v255, v254, v255
v_mfma_f32_16x16x32_bf16 v[148:151], a[100:103], a[28:31], v[148:151]
ds_read_b64_tr_b16 a[90:91], v19 offset:256
v_cvt_pk_bf16_f32 v254, v252, v253
v_mfma_f32_16x16x32_bf16 v[132:135], a[100:103], a[20:23], 0
ds_read_b64_tr_b16 a[92:93], v19 offset:2048
v_cvt_pk_bf16_f32 v252, v248, v249
v_mfma_f32_16x16x32_bf16 v[132:135], a[96:99], a[16:19], v[132:135]
s_add_u32 s65, s79, 16384
ds_read_b64_tr_b16 a[94:95], v19 offset:2304
v_cvt_pk_bf16_f32 v253, v250, v251
v_mfma_f32_16x16x32_bf16 v[116:119], a[96:99], a[8:11], 0
buffer_store_dwordx4 a[144:147], v16, s[44:47], s65 offen sc1
v_mfma_f32_16x16x32_bf16 v[116:119], a[100:103], a[12:15], v[116:119]
buffer_store_dwordx4 v[252:255], v16, s[44:47], s67 offen sc1
v_mfma_f32_16x16x32_bf16 v[100:103], a[100:103], a[4:7], 0
s_add_u32 m0, s78, 151552
v_mfma_f32_16x16x32_bf16 v[100:103], a[96:99], a[0:3], v[100:103]
s_waitcnt lgkmcnt(4)
s_add_u32 s64, s75, 1181696
ds_read_b64_tr_b16 a[96:97], v20 offset:0
v_accvgpr_read_b32 v248, a120
v_mfma_f32_16x16x32_bf16 v[184:187], a[104:107], a[32:35], v[184:187]
buffer_load_dwordx4 v23, s[60:63], s64 offen lds
v_mfma_f32_16x16x32_bf16 v[184:187], a[108:111], a[36:39], v[184:187]
ds_read_b64_tr_b16 a[98:99], v20 offset:256
v_accvgpr_read_b32 v249, a121
v_mfma_f32_16x16x32_bf16 v[192:195], a[108:111], a[44:47], v[192:195]
ds_read_b64_tr_b16 a[100:101], v20 offset:2048
v_accvgpr_read_b32 v250, a122
v_mfma_f32_16x16x32_bf16 v[192:195], a[104:107], a[40:43], v[192:195]
ds_read_b64_tr_b16 a[102:103], v20 offset:2304
v_accvgpr_read_b32 v251, a123
v_mfma_f32_16x16x32_bf16 v[200:203], a[104:107], a[48:51], v[200:203]
v_accvgpr_read_b32 v252, a124
v_accvgpr_read_b32 v253, a125
v_mfma_f32_16x16x32_bf16 v[200:203], a[108:111], a[52:55], v[200:203]
v_accvgpr_read_b32 v254, a126
v_accvgpr_read_b32 v255, a127
v_mfma_f32_16x16x32_bf16 v[208:211], a[108:111], a[60:63], v[208:211]
v_cvt_pk_bf16_f32 v255, v254, v255
v_cvt_pk_bf16_f32 v254, v252, v253
v_mfma_f32_16x16x32_bf16 v[208:211], a[104:107], a[56:59], v[208:211]
ds_read_b64_tr_b16 a[104:105], v4 offset:0
v_cvt_pk_bf16_f32 v252, v248, v249
v_mfma_f32_16x16x32_bf16 v[212:215], a[112:115], a[56:59], v[212:215]
s_add_u32 m0, s77, 133120
ds_read_b64_tr_b16 a[106:107], v4 offset:1024
v_cvt_pk_bf16_f32 v253, v250, v251
v_mfma_f32_16x16x32_bf16 v[212:215], a[116:119], a[60:63], v[212:215]
s_add_u32 s64, s71, 1638400
ds_read_b64_tr_b16 a[108:109], v4 offset:8192
v_accvgpr_write_b32 a228, v252
v_mfma_f32_16x16x32_bf16 v[204:207], a[116:119], a[52:55], v[204:207]
buffer_load_dwordx4 v15, s[56:59], s64 offen lds
v_mfma_f32_16x16x32_bf16 v[204:207], a[112:115], a[48:51], v[204:207]
ds_read_b64_tr_b16 a[110:111], v4 offset:9216
v_accvgpr_write_b32 a229, v253
v_mfma_f32_16x16x32_bf16 v[196:199], a[112:115], a[40:43], v[196:199]
v_accvgpr_write_b32 a230, v254
v_accvgpr_write_b32 a231, v255
v_mfma_f32_16x16x32_bf16 v[196:199], a[116:119], a[44:47], v[196:199]
v_mfma_f32_16x16x32_bf16 v[188:191], a[116:119], a[36:39], v[188:191]
v_accvgpr_read_b32 v248, a132
v_accvgpr_read_b32 v249, a133
v_mfma_f32_16x16x32_bf16 v[188:191], a[112:115], a[32:35], v[188:191]
ds_read_b64_tr_b16 a[112:113], v5 offset:0
v_accvgpr_read_b32 v250, a134
v_mfma_f32_16x16x32_bf16 v[216:219], a[32:35], a[72:75], v[216:219]
ds_read_b64_tr_b16 a[114:115], v5 offset:1024
v_accvgpr_read_b32 v251, a135
v_mfma_f32_16x16x32_bf16 v[216:219], a[36:39], a[76:79], v[216:219]
s_add_u32 m0, s78, 155648
ds_read_b64_tr_b16 a[116:117], v5 offset:8192
v_accvgpr_read_b32 v252, a128
v_mfma_f32_16x16x32_bf16 v[224:227], a[44:47], a[76:79], v[224:227]
s_add_u32 s64, s75, 1183744
ds_read_b64_tr_b16 a[118:119], v5 offset:9216
v_accvgpr_read_b32 v253, a129
v_mfma_f32_16x16x32_bf16 v[224:227], a[40:43], a[72:75], v[224:227]
buffer_load_dwordx4 v23, s[60:63], s64 offen lds
v_mfma_f32_16x16x32_bf16 v[232:235], a[48:51], a[72:75], v[232:235]
v_accvgpr_read_b32 v254, a130
v_accvgpr_read_b32 v255, a131
v_mfma_f32_16x16x32_bf16 v[232:235], a[52:55], a[76:79], v[232:235]
v_cvt_pk_bf16_f32 v255, v254, v255
v_cvt_pk_bf16_f32 v254, v252, v253
v_mfma_f32_16x16x32_bf16 v[240:243], a[60:63], a[76:79], v[240:243]
v_cvt_pk_bf16_f32 v252, v248, v249
v_cvt_pk_bf16_f32 v253, v250, v251
v_mfma_f32_16x16x32_bf16 v[240:243], a[56:59], a[72:75], v[240:243]
ds_read_b64_tr_b16 a[72:73], v6 offset:0
v_accvgpr_write_b32 a232, v252
v_mfma_f32_16x16x32_bf16 v[244:247], a[56:59], a[80:83], v[244:247]
ds_read_b64_tr_b16 a[74:75], v6 offset:1024
v_accvgpr_write_b32 a233, v253
v_mfma_f32_16x16x32_bf16 v[244:247], a[60:63], a[84:87], v[244:247]
ds_read_b64_tr_b16 a[76:77], v6 offset:8192
v_accvgpr_write_b32 a234, v254
v_mfma_f32_16x16x32_bf16 v[236:239], a[52:55], a[84:87], v[236:239]
s_add_u32 m0, s77, 134144
ds_read_b64_tr_b16 a[78:79], v6 offset:9216
v_accvgpr_write_b32 a235, v255
v_mfma_f32_16x16x32_bf16 v[236:239], a[48:51], a[80:83], v[236:239]
s_add_u32 s64, s71, 1671168
v_mfma_f32_16x16x32_bf16 v[228:231], a[40:43], a[80:83], v[228:231]
buffer_load_dwordx4 v15, s[56:59], s64 offen lds
v_mfma_f32_16x16x32_bf16 v[228:231], a[44:47], a[84:87], v[228:231]
v_accvgpr_read_b32 v248, a140
v_accvgpr_read_b32 v249, a141
v_mfma_f32_16x16x32_bf16 v[220:223], a[36:39], a[84:87], v[220:223]
v_accvgpr_read_b32 v250, a142
v_accvgpr_read_b32 v251, a143
v_mfma_f32_16x16x32_bf16 v[220:223], a[32:35], a[80:83], v[220:223]
s_waitcnt lgkmcnt(4)
ds_read_b64_tr_b16 a[80:81], v7 offset:0
v_accvgpr_read_b32 v252, a136
v_mfma_f32_16x16x32_bf16 v[152:155], a[88:91], a[32:35], v[152:155]
ds_read_b64_tr_b16 a[82:83], v7 offset:1024
v_accvgpr_read_b32 v253, a137
v_mfma_f32_16x16x32_bf16 v[152:155], a[92:95], a[36:39], v[152:155]
ds_read_b64_tr_b16 a[84:85], v7 offset:8192
v_accvgpr_read_b32 v254, a138
v_mfma_f32_16x16x32_bf16 v[160:163], a[92:95], a[44:47], v[160:163]
ds_read_b64_tr_b16 a[86:87], v7 offset:9216
v_accvgpr_read_b32 v255, a139
v_mfma_f32_16x16x32_bf16 v[160:163], a[88:91], a[40:43], v[160:163]
v_cvt_pk_bf16_f32 v255, v254, v255
v_cvt_pk_bf16_f32 v254, v252, v253
v_mfma_f32_16x16x32_bf16 v[168:171], a[88:91], a[48:51], v[168:171]
v_cvt_pk_bf16_f32 v252, v248, v249
v_cvt_pk_bf16_f32 v253, v250, v251
v_mfma_f32_16x16x32_bf16 v[168:171], a[92:95], a[52:55], v[168:171]
v_accvgpr_write_b32 a236, v252
v_accvgpr_write_b32 a237, v253
v_mfma_f32_16x16x32_bf16 v[176:179], a[92:95], a[60:63], v[176:179]
s_add_u32 m0, s76, 32768
v_accvgpr_write_b32 a238, v254
v_accvgpr_write_b32 a239, v255
v_mfma_f32_16x16x32_bf16 v[176:179], a[88:91], a[56:59], v[176:179]
s_add_u32 s64, s72, 384
ds_read_b64_tr_b16 a[88:89], v8 offset:0
v_mfma_f32_16x16x32_bf16 v[180:183], a[96:99], a[56:59], v[180:183]
buffer_load_dwordx4 v12, s[48:51], s64 offen lds
v_mfma_f32_16x16x32_bf16 v[180:183], a[100:103], a[60:63], v[180:183]
ds_read_b64_tr_b16 a[90:91], v8 offset:1024
v_mfma_f32_16x16x32_bf16 v[172:175], a[100:103], a[52:55], v[172:175]
ds_read_b64_tr_b16 a[92:93], v8 offset:8192
v_mfma_f32_16x16x32_bf16 v[172:175], a[96:99], a[48:51], v[172:175]
s_add_u32 m0, s76, 33792
ds_read_b64_tr_b16 a[94:95], v8 offset:9216
v_mfma_f32_16x16x32_bf16 v[164:167], a[96:99], a[40:43], v[164:167]
s_add_u32 s64, s72, 16768
v_mfma_f32_16x16x32_bf16 v[164:167], a[100:103], a[44:47], v[164:167]
s_add_u32 s65, s79, 4096
buffer_load_dwordx4 v13, s[48:51], s64 offen lds
v_mfma_f32_16x16x32_bf16 v[156:159], a[100:103], a[36:39], v[156:159]
buffer_store_dwordx4 a[148:151], v16, s[44:47], s65 offen sc1
v_mfma_f32_16x16x32_bf16 v[156:159], a[96:99], a[32:35], v[156:159]
ds_read_b64_tr_b16 a[96:97], v9 offset:0
v_mfma_f32_16x16x32_bf16 v[24:27], a[104:107], a[32:35], v[24:27]
s_add_u32 m0, s76, 34816
ds_read_b64_tr_b16 a[98:99], v9 offset:1024
v_mfma_f32_16x16x32_bf16 v[24:27], a[108:111], a[36:39], v[24:27]
s_add_u32 s64, s72, 131456
ds_read_b64_tr_b16 a[100:101], v9 offset:8192
v_mfma_f32_16x16x32_bf16 v[40:43], a[108:111], a[44:47], v[40:43]
buffer_load_dwordx4 v12, s[48:51], s64 offen lds
v_mfma_f32_16x16x32_bf16 v[40:43], a[104:107], a[40:43], v[40:43]
ds_read_b64_tr_b16 a[102:103], v9 offset:9216
v_mfma_f32_16x16x32_bf16 v[56:59], a[104:107], a[48:51], v[56:59]
v_mfma_f32_16x16x32_bf16 v[56:59], a[108:111], a[52:55], v[56:59]
s_add_u32 m0, s76, 35840
v_mfma_f32_16x16x32_bf16 v[72:75], a[108:111], a[60:63], v[72:75]
s_waitcnt vmcnt(15)
s_add_u32 s64, s72, 147840
ds_read_b128 a[0:3], v2 offset:0
v_mfma_f32_16x16x32_bf16 v[72:75], a[104:107], a[56:59], v[72:75]
buffer_load_dwordx4 v13, s[48:51], s64 offen lds
v_mfma_f32_16x16x32_bf16 v[136:139], a[112:115], a[56:59], v[136:139]
ds_read_b128 a[4:7], v3 offset:0
v_mfma_f32_16x16x32_bf16 v[136:139], a[116:119], a[60:63], v[136:139]
ds_read_b128 a[8:11], v2 offset:2048
v_mfma_f32_16x16x32_bf16 v[120:123], a[116:119], a[52:55], v[120:123]
s_add_u32 m0, s76, 36864
ds_read_b128 a[12:15], v3 offset:2048
v_mfma_f32_16x16x32_bf16 v[120:123], a[112:115], a[48:51], v[120:123]
s_add_u32 s64, s73, 384
ds_read_b128 a[16:19], v2 offset:4096
v_mfma_f32_16x16x32_bf16 v[104:107], a[112:115], a[40:43], v[104:107]
buffer_load_dwordx4 v12, s[48:51], s64 offen lds
v_mfma_f32_16x16x32_bf16 v[104:107], a[116:119], a[44:47], v[104:107]
ds_read_b128 a[20:23], v3 offset:4096
v_mfma_f32_16x16x32_bf16 v[88:91], a[116:119], a[36:39], v[88:91]
ds_read_b128 a[24:27], v2 offset:6144
v_mfma_f32_16x16x32_bf16 v[88:91], a[112:115], a[32:35], v[88:91]
s_waitcnt lgkmcnt(7)
s_add_u32 m0, s76, 37888
ds_read_b128 a[28:31], v3 offset:6144
v_mfma_f32_16x16x32_bf16 v[28:31], a[72:75], a[32:35], v[28:31]
s_add_u32 s64, s73, 16768
ds_read_b64_tr_b16 a[104:105], v10 offset:0
v_mfma_f32_16x16x32_bf16 v[28:31], a[76:79], a[36:39], v[28:31]
buffer_load_dwordx4 v13, s[48:51], s64 offen lds
v_mfma_f32_16x16x32_bf16 v[44:47], a[76:79], a[44:47], v[44:47]
ds_read_b64_tr_b16 a[106:107], v10 offset:1024
v_mfma_f32_16x16x32_bf16 v[44:47], a[72:75], a[40:43], v[44:47]
ds_read_b64_tr_b16 a[108:109], v10 offset:8192
v_mfma_f32_16x16x32_bf16 v[60:63], a[72:75], a[48:51], v[60:63]
s_add_u32 m0, s76, 38912
ds_read_b64_tr_b16 a[110:111], v10 offset:9216
v_mfma_f32_16x16x32_bf16 v[60:63], a[76:79], a[52:55], v[60:63]
s_add_u32 s64, s73, 131456
ds_read_b64_tr_b16 a[112:113], v11 offset:0
v_mfma_f32_16x16x32_bf16 v[76:79], a[76:79], a[60:63], v[76:79]
buffer_load_dwordx4 v12, s[48:51], s64 offen lds
v_mfma_f32_16x16x32_bf16 v[76:79], a[72:75], a[56:59], v[76:79]
ds_read_b64_tr_b16 a[114:115], v11 offset:1024
v_mfma_f32_16x16x32_bf16 v[140:143], a[80:83], a[56:59], v[140:143]
ds_read_b64_tr_b16 a[116:117], v11 offset:8192
v_mfma_f32_16x16x32_bf16 v[140:143], a[84:87], a[60:63], v[140:143]
s_add_u32 m0, s76, 39936
ds_read_b64_tr_b16 a[118:119], v11 offset:9216
v_mfma_f32_16x16x32_bf16 v[124:127], a[84:87], a[52:55], v[124:127]
s_add_u32 s64, s73, 147840
v_mfma_f32_16x16x32_bf16 v[124:127], a[80:83], a[48:51], v[124:127]
buffer_load_dwordx4 v13, s[48:51], s64 offen lds
v_mfma_f32_16x16x32_bf16 v[108:111], a[80:83], a[40:43], v[108:111]
v_mfma_f32_16x16x32_bf16 v[108:111], a[84:87], a[44:47], v[108:111]
v_mfma_f32_16x16x32_bf16 v[92:95], a[84:87], a[36:39], v[92:95]
v_mfma_f32_16x16x32_bf16 v[92:95], a[80:83], a[32:35], v[92:95]
v_mfma_f32_16x16x32_bf16 v[32:35], a[88:91], a[32:35], v[32:35]
v_mfma_f32_16x16x32_bf16 v[32:35], a[92:95], a[36:39], v[32:35]
v_mfma_f32_16x16x32_bf16 v[48:51], a[92:95], a[44:47], v[48:51]
s_waitcnt lgkmcnt(0)
s_barrier
v_mfma_f32_16x16x32_bf16 v[48:51], a[88:91], a[40:43], v[48:51]
s_add_u32 m0, s77, 65536
ds_read_b64_tr_b16 a[72:73], v19 offset:36864
v_mfma_f32_16x16x32_bf16 v[64:67], a[88:91], a[48:51], v[64:67]
s_add_u32 s64, s71, 2097152
ds_read_b64_tr_b16 a[74:75], v19 offset:37120
v_mfma_f32_16x16x32_bf16 v[64:67], a[92:95], a[52:55], v[64:67]
buffer_load_dwordx4 v14, s[56:59], s64 offen lds
v_mfma_f32_16x16x32_bf16 v[80:83], a[92:95], a[60:63], v[80:83]
ds_read_b64_tr_b16 a[76:77], v19 offset:38912
v_mfma_f32_16x16x32_bf16 v[80:83], a[88:91], a[56:59], v[80:83]
ds_read_b64_tr_b16 a[78:79], v19 offset:39168
v_mfma_f32_16x16x32_bf16 v[144:147], a[96:99], a[56:59], v[144:147]
ds_read_b64_tr_b16 a[80:81], v20 offset:36864
v_mfma_f32_16x16x32_bf16 v[144:147], a[100:103], a[60:63], v[144:147]
ds_read_b64_tr_b16 a[82:83], v20 offset:37120
v_mfma_f32_16x16x32_bf16 v[128:131], a[100:103], a[52:55], v[128:131]
ds_read_b64_tr_b16 a[84:85], v20 offset:38912
v_mfma_f32_16x16x32_bf16 v[128:131], a[96:99], a[48:51], v[128:131]
ds_read_b64_tr_b16 a[86:87], v20 offset:39168
v_mfma_f32_16x16x32_bf16 v[112:115], a[96:99], a[40:43], v[112:115]
s_add_u32 m0, s78, 81920
ds_read_b64_tr_b16 a[88:89], v19 offset:40960
v_mfma_f32_16x16x32_bf16 v[112:115], a[100:103], a[44:47], v[112:115]
s_add_u32 s64, s75, 1572864
ds_read_b64_tr_b16 a[90:91], v19 offset:41216
v_mfma_f32_16x16x32_bf16 v[96:99], a[100:103], a[36:39], v[96:99]
s_add_u32 s65, s79, 0
buffer_load_dwordx4 v23, s[60:63], s64 offen lds
v_mfma_f32_16x16x32_bf16 v[96:99], a[96:99], a[32:35], v[96:99]
buffer_store_dwordx4 a[152:155], v16, s[44:47], s65 offen sc1
v_mfma_f32_16x16x32_bf16 v[36:39], a[104:107], a[32:35], v[36:39]
ds_read_b64_tr_b16 a[92:93], v19 offset:43008
v_mfma_f32_16x16x32_bf16 v[36:39], a[108:111], a[36:39], v[36:39]
ds_read_b64_tr_b16 a[94:95], v19 offset:43264
v_mfma_f32_16x16x32_bf16 v[52:55], a[108:111], a[44:47], v[52:55]
ds_read_b64_tr_b16 a[96:97], v20 offset:40960
v_mfma_f32_16x16x32_bf16 v[52:55], a[104:107], a[40:43], v[52:55]
ds_read_b64_tr_b16 a[98:99], v20 offset:41216
v_mfma_f32_16x16x32_bf16 v[68:71], a[104:107], a[48:51], v[68:71]
s_add_u32 m0, s77, 66560
ds_read_b64_tr_b16 a[100:101], v20 offset:43008
v_mfma_f32_16x16x32_bf16 v[68:71], a[108:111], a[52:55], v[68:71]
s_add_u32 s64, s71, 2129920
s_xor_b32 s68, s66, 4096
ds_read_b64_tr_b16 a[102:103], v20 offset:43264
v_mfma_f32_16x16x32_bf16 v[84:87], a[108:111], a[60:63], v[84:87]
s_mov_b64 exec, 1
buffer_atomic_add a251, v1, s[52:55], s68 offen offset:0 sc1
s_mov_b64 exec, -1
v_mfma_f32_16x16x32_bf16 v[84:87], a[104:107], a[56:59], v[84:87]
buffer_load_dwordx4 v14, s[56:59], s64 offen lds
v_mfma_f32_16x16x32_bf16 v[148:151], a[112:115], a[56:59], v[148:151]
ds_read_b64_tr_b16 a[104:105], v19 offset:32768
v_mfma_f32_16x16x32_bf16 v[148:151], a[116:119], a[60:63], v[148:151]
ds_read_b64_tr_b16 a[106:107], v19 offset:33024
v_mfma_f32_16x16x32_bf16 v[132:135], a[116:119], a[52:55], v[132:135]
ds_read_b64_tr_b16 a[108:109], v19 offset:34816
v_mfma_f32_16x16x32_bf16 v[132:135], a[112:115], a[48:51], v[132:135]
ds_read_b64_tr_b16 a[110:111], v19 offset:35072
v_mfma_f32_16x16x32_bf16 v[116:119], a[112:115], a[40:43], v[116:119]
v_mfma_f32_16x16x32_bf16 v[116:119], a[116:119], a[44:47], v[116:119]
v_mfma_f32_16x16x32_bf16 v[100:103], a[116:119], a[36:39], v[100:103]
s_add_u32 m0, s78, 86016
v_mfma_f32_16x16x32_bf16 v[100:103], a[112:115], a[32:35], v[100:103]
s_waitcnt lgkmcnt(4)
s_add_u32 s64, s75, 1574912
ds_read_b64_tr_b16 a[112:113], v20 offset:32768
v_mfma_f32_16x16x32_bf16 v[184:187], a[72:75], a[0:3], v[184:187]
buffer_load_dwordx4 v23, s[60:63], s64 offen lds
v_mfma_f32_16x16x32_bf16 v[184:187], a[76:79], a[4:7], v[184:187]
ds_read_b64_tr_b16 a[114:115], v20 offset:33024
v_mfma_f32_16x16x32_bf16 v[192:195], a[76:79], a[12:15], v[192:195]
ds_read_b64_tr_b16 a[116:117], v20 offset:34816
v_mfma_f32_16x16x32_bf16 v[192:195], a[72:75], a[8:11], v[192:195]
s_add_u32 s17, s78, .-L_pc+6144
ds_read_b64_tr_b16 a[118:119], v20 offset:35072
v_mfma_f32_16x16x32_bf16 v[200:203], a[72:75], a[16:19], v[200:203]
buffer_load_dword a252, v16, s[88:91], s17 offen
v_mfma_f32_16x16x32_bf16 v[200:203], a[76:79], a[20:23], v[200:203]
v_mfma_f32_16x16x32_bf16 v[208:211], a[76:79], a[28:31], v[208:211]
v_mfma_f32_16x16x32_bf16 v[208:211], a[72:75], a[24:27], v[208:211]
ds_read_b64_tr_b16 a[72:73], v4 offset:32768
v_mfma_f32_16x16x32_bf16 v[212:215], a[80:83], a[24:27], v[212:215]
s_add_u32 m0, s77, 67584
ds_read_b64_tr_b16 a[74:75], v4 offset:33792
v_mfma_f32_16x16x32_bf16 v[212:215], a[84:87], a[28:31], v[212:215]
s_add_u32 s64, s71, 2162688
ds_read_b64_tr_b16 a[76:77], v4 offset:40960
v_mfma_f32_16x16x32_bf16 v[204:207], a[84:87], a[20:23], v[204:207]
buffer_load_dwordx4 v15, s[56:59], s64 offen lds
v_mfma_f32_16x16x32_bf16 v[204:207], a[80:83], a[16:19], v[204:207]
ds_read_b64_tr_b16 a[78:79], v4 offset:41984
v_mfma_f32_16x16x32_bf16 v[196:199], a[80:83], a[8:11], v[196:199]
v_mfma_f32_16x16x32_bf16 v[196:199], a[84:87], a[12:15], v[196:199]
v_mfma_f32_16x16x32_bf16 v[188:191], a[84:87], a[4:7], v[188:191]
v_mfma_f32_16x16x32_bf16 v[188:191], a[80:83], a[0:3], v[188:191]
ds_read_b64_tr_b16 a[80:81], v5 offset:32768
v_mfma_f32_16x16x32_bf16 v[216:219], a[0:3], a[88:91], v[216:219]
ds_read_b64_tr_b16 a[82:83], v5 offset:33792
v_mfma_f32_16x16x32_bf16 v[216:219], a[4:7], a[92:95], v[216:219]
s_add_u32 m0, s78, 90112
ds_read_b64_tr_b16 a[84:85], v5 offset:40960
v_mfma_f32_16x16x32_bf16 v[224:227], a[12:15], a[92:95], v[224:227]
s_add_u32 s64, s75, 1576960
ds_read_b64_tr_b16 a[86:87], v5 offset:41984
v_mfma_f32_16x16x32_bf16 v[224:227], a[8:11], a[88:91], v[224:227]
buffer_load_dwordx4 v23, s[60:63], s64 offen lds
v_mfma_f32_16x16x32_bf16 v[232:235], a[16:19], a[88:91], v[232:235]
v_mfma_f32_16x16x32_bf16 v[232:235], a[20:23], a[92:95], v[232:235]
v_mfma_f32_16x16x32_bf16 v[240:243], a[28:31], a[92:95], v[240:243]
v_mfma_f32_16x16x32_bf16 v[240:243], a[24:27], a[88:91], v[240:243]
ds_read_b64_tr_b16 a[88:89], v6 offset:32768
v_mfma_f32_16x16x32_bf16 v[244:247], a[24:27], a[96:99], v[244:247]
ds_read_b64_tr_b16 a[90:91], v6 offset:33792
v_mfma_f32_16x16x32_bf16 v[244:247], a[28:31], a[100:103], v[244:247]
ds_read_b64_tr_b16 a[92:93], v6 offset:40960
v_add_u32 v19, 0x8000, v19
v_mfma_f32_16x16x32_bf16 v[236:239], a[20:23], a[100:103], v[236:239]
s_add_u32 m0, s77, 68608
ds_read_b64_tr_b16 a[94:95], v6 offset:41984
v_mfma_f32_16x16x32_bf16 v[236:239], a[16:19], a[96:99], v[236:239]
s_add_u32 s64, s71, 2195456
v_mfma_f32_16x16x32_bf16 v[228:231], a[8:11], a[96:99], v[228:231]
buffer_load_dwordx4 v15, s[56:59], s64 offen lds
v_mfma_f32_16x16x32_bf16 v[228:231], a[12:15], a[100:103], v[228:231]
v_mfma_f32_16x16x32_bf16 v[220:223], a[4:7], a[100:103], v[220:223]
v_mfma_f32_16x16x32_bf16 v[220:223], a[0:3], a[96:99], v[220:223]
s_waitcnt lgkmcnt(4)
s_add_u32 s65, s79, 17408
ds_read_b64_tr_b16 a[96:97], v7 offset:32768
v_mfma_f32_16x16x32_bf16 v[152:155], a[104:107], a[0:3], v[152:155]
buffer_store_dwordx4 a[156:159], v16, s[44:47], s65 offen sc1
v_mfma_f32_16x16x32_bf16 v[152:155], a[108:111], a[4:7], v[152:155]
ds_read_b64_tr_b16 a[98:99], v7 offset:33792
v_add_u32 v20, 0x8000, v20
v_mfma_f32_16x16x32_bf16 v[160:163], a[108:111], a[12:15], v[160:163]
ds_read_b64_tr_b16 a[100:101], v7 offset:40960
v_mfma_f32_16x16x32_bf16 v[160:163], a[104:107], a[8:11], v[160:163]
ds_read_b64_tr_b16 a[102:103], v7 offset:41984
v_mfma_f32_16x16x32_bf16 v[168:171], a[104:107], a[16:19], v[168:171]
v_mfma_f32_16x16x32_bf16 v[168:171], a[108:111], a[20:23], v[168:171]
v_mfma_f32_16x16x32_bf16 v[176:179], a[108:111], a[28:31], v[176:179]
s_add_u32 m0, s76, 0
v_mfma_f32_16x16x32_bf16 v[176:179], a[104:107], a[24:27], v[176:179]
s_add_u32 s64, s72, 512
ds_read_b64_tr_b16 a[104:105], v8 offset:32768
v_mfma_f32_16x16x32_bf16 v[180:183], a[112:115], a[24:27], v[180:183]
buffer_load_dwordx4 v12, s[48:51], s64 offen lds
v_mfma_f32_16x16x32_bf16 v[180:183], a[116:119], a[28:31], v[180:183]
ds_read_b64_tr_b16 a[106:107], v8 offset:33792
v_add_u32 v4, 0x8000, v4
v_mfma_f32_16x16x32_bf16 v[172:175], a[116:119], a[20:23], v[172:175]
ds_read_b64_tr_b16 a[108:109], v8 offset:40960
v_mfma_f32_16x16x32_bf16 v[172:175], a[112:115], a[16:19], v[172:175]
s_add_u32 m0, s76, 1024
ds_read_b64_tr_b16 a[110:111], v8 offset:41984
v_mfma_f32_16x16x32_bf16 v[164:167], a[112:115], a[8:11], v[164:167]
s_add_u32 s64, s72, 16896
v_mfma_f32_16x16x32_bf16 v[164:167], a[116:119], a[12:15], v[164:167]
buffer_load_dwordx4 v13, s[48:51], s64 offen lds
v_mfma_f32_16x16x32_bf16 v[156:159], a[116:119], a[4:7], v[156:159]
v_mfma_f32_16x16x32_bf16 v[156:159], a[112:115], a[0:3], v[156:159]
ds_read_b64_tr_b16 a[112:113], v9 offset:32768
v_mfma_f32_16x16x32_bf16 v[24:27], a[72:75], a[0:3], v[24:27]
s_add_u32 m0, s76, 2048
ds_read_b64_tr_b16 a[114:115], v9 offset:33792
v_mfma_f32_16x16x32_bf16 v[24:27], a[76:79], a[4:7], v[24:27]
s_add_u32 s64, s72, 131584
ds_read_b64_tr_b16 a[116:117], v9 offset:40960
v_add_u32 v5, 0x8000, v5
v_mfma_f32_16x16x32_bf16 v[40:43], a[76:79], a[12:15], v[40:43]
buffer_load_dwordx4 v12, s[48:51], s64 offen lds
v_mfma_f32_16x16x32_bf16 v[40:43], a[72:75], a[8:11], v[40:43]
ds_read_b64_tr_b16 a[118:119], v9 offset:41984
v_mfma_f32_16x16x32_bf16 v[56:59], a[72:75], a[16:19], v[56:59]
v_mfma_f32_16x16x32_bf16 v[56:59], a[76:79], a[20:23], v[56:59]
s_add_u32 m0, s76, 3072
v_mfma_f32_16x16x32_bf16 v[72:75], a[76:79], a[28:31], v[72:75]
s_waitcnt vmcnt(14)
s_add_u32 s64, s72, 147968
ds_read_b128 a[32:35], v2 offset:32768
v_mfma_f32_16x16x32_bf16 v[72:75], a[72:75], a[24:27], v[72:75]
buffer_load_dwordx4 v13, s[48:51], s64 offen lds
v_mfma_f32_16x16x32_bf16 v[136:139], a[80:83], a[24:27], v[136:139]
ds_read_b128 a[36:39], v3 offset:32768
v_mfma_f32_16x16x32_bf16 v[136:139], a[84:87], a[28:31], v[136:139]
ds_read_b128 a[40:43], v2 offset:34816
v_add_u32 v6, 0x8000, v6
v_mfma_f32_16x16x32_bf16 v[120:123], a[84:87], a[20:23], v[120:123]
s_add_u32 m0, s76, 4096
ds_read_b128 a[44:47], v3 offset:34816
v_mfma_f32_16x16x32_bf16 v[120:123], a[80:83], a[16:19], v[120:123]
s_add_u32 s64, s73, 512
ds_read_b128 a[48:51], v2 offset:36864
v_mfma_f32_16x16x32_bf16 v[104:107], a[80:83], a[8:11], v[104:107]
buffer_load_dwordx4 v12, s[48:51], s64 offen lds
v_mfma_f32_16x16x32_bf16 v[104:107], a[84:87], a[12:15], v[104:107]
ds_read_b128 a[52:55], v3 offset:36864
v_mfma_f32_16x16x32_bf16 v[88:91], a[84:87], a[4:7], v[88:91]
ds_read_b128 a[56:59], v2 offset:38912
v_mfma_f32_16x16x32_bf16 v[88:91], a[80:83], a[0:3], v[88:91]
s_waitcnt lgkmcnt(7)
s_add_u32 m0, s76, 5120
ds_read_b128 a[60:63], v3 offset:38912
v_mfma_f32_16x16x32_bf16 v[28:31], a[88:91], a[0:3], v[28:31]
s_add_u32 s64, s73, 16896
ds_read_b64_tr_b16 a[72:73], v10 offset:32768
v_mfma_f32_16x16x32_bf16 v[28:31], a[92:95], a[4:7], v[28:31]
buffer_load_dwordx4 v13, s[48:51], s64 offen lds
v_mfma_f32_16x16x32_bf16 v[44:47], a[92:95], a[12:15], v[44:47]
ds_read_b64_tr_b16 a[74:75], v10 offset:33792
v_add_u32 v7, 0x8000, v7
v_mfma_f32_16x16x32_bf16 v[44:47], a[88:91], a[8:11], v[44:47]
ds_read_b64_tr_b16 a[76:77], v10 offset:40960
v_mfma_f32_16x16x32_bf16 v[60:63], a[88:91], a[16:19], v[60:63]
s_add_u32 m0, s76, 6144
ds_read_b64_tr_b16 a[78:79], v10 offset:41984
v_mfma_f32_16x16x32_bf16 v[60:63], a[92:95], a[20:23], v[60:63]
s_add_u32 s64, s73, 131584
ds_read_b64_tr_b16 a[80:81], v11 offset:32768
v_mfma_f32_16x16x32_bf16 v[76:79], a[92:95], a[28:31], v[76:79]
buffer_load_dwordx4 v12, s[48:51], s64 offen lds
v_mfma_f32_16x16x32_bf16 v[76:79], a[88:91], a[24:27], v[76:79]
ds_read_b64_tr_b16 a[82:83], v11 offset:33792
v_mfma_f32_16x16x32_bf16 v[140:143], a[96:99], a[24:27], v[140:143]
ds_read_b64_tr_b16 a[84:85], v11 offset:40960
v_mfma_f32_16x16x32_bf16 v[140:143], a[100:103], a[28:31], v[140:143]
s_add_u32 m0, s76, 7168
ds_read_b64_tr_b16 a[86:87], v11 offset:41984
v_add_u32 v8, 0x8000, v8
v_mfma_f32_16x16x32_bf16 v[124:127], a[100:103], a[20:23], v[124:127]
s_add_u32 s64, s73, 147968
v_mfma_f32_16x16x32_bf16 v[124:127], a[96:99], a[16:19], v[124:127]
buffer_load_dwordx4 v13, s[48:51], s64 offen lds
v_mfma_f32_16x16x32_bf16 v[108:111], a[96:99], a[8:11], v[108:111]
v_mfma_f32_16x16x32_bf16 v[108:111], a[100:103], a[12:15], v[108:111]
v_mfma_f32_16x16x32_bf16 v[92:95], a[100:103], a[4:7], v[92:95]
v_add_u32 v9, 0x8000, v9
v_add_u32 v10, 0x8000, v10
v_mfma_f32_16x16x32_bf16 v[92:95], a[96:99], a[0:3], v[92:95]
v_add_u32 v11, 0x8000, v11
v_mfma_f32_16x16x32_bf16 v[32:35], a[104:107], a[0:3], v[32:35]
s_add_u32 s65, s79, 5120
v_mfma_f32_16x16x32_bf16 v[32:35], a[108:111], a[4:7], v[32:35]
buffer_store_dwordx4 a[160:163], v16, s[44:47], s65 offen sc1
v_mfma_f32_16x16x32_bf16 v[48:51], a[108:111], a[12:15], v[48:51]
s_waitcnt lgkmcnt(0)
s_barrier
v_mfma_f32_16x16x32_bf16 v[48:51], a[104:107], a[8:11], v[48:51]
s_add_u32 m0, s77, 98304
ds_read_b64_tr_b16 a[88:89], v19 offset:36864
v_mfma_f32_16x16x32_bf16 v[64:67], a[104:107], a[16:19], v[64:67]
s_add_u32 s64, s71, 2621440
ds_read_b64_tr_b16 a[90:91], v19 offset:37120
v_mfma_f32_16x16x32_bf16 v[64:67], a[108:111], a[20:23], v[64:67]
buffer_load_dwordx4 v14, s[56:59], s64 offen lds
v_mfma_f32_16x16x32_bf16 v[80:83], a[108:111], a[28:31], v[80:83]
ds_read_b64_tr_b16 a[92:93], v19 offset:38912
v_mfma_f32_16x16x32_bf16 v[80:83], a[104:107], a[24:27], v[80:83]
ds_read_b64_tr_b16 a[94:95], v19 offset:39168
v_mfma_f32_16x16x32_bf16 v[144:147], a[112:115], a[24:27], v[144:147]
ds_read_b64_tr_b16 a[96:97], v20 offset:36864
v_mfma_f32_16x16x32_bf16 v[144:147], a[116:119], a[28:31], v[144:147]
ds_read_b64_tr_b16 a[98:99], v20 offset:37120
v_mfma_f32_16x16x32_bf16 v[128:131], a[116:119], a[20:23], v[128:131]
ds_read_b64_tr_b16 a[100:101], v20 offset:38912
v_mfma_f32_16x16x32_bf16 v[128:131], a[112:115], a[16:19], v[128:131]
ds_read_b64_tr_b16 a[102:103], v20 offset:39168
v_mfma_f32_16x16x32_bf16 v[112:115], a[112:115], a[8:11], v[112:115]
s_add_u32 m0, s78, 114688
ds_read_b64_tr_b16 a[104:105], v19 offset:40960
v_mfma_f32_16x16x32_bf16 v[112:115], a[116:119], a[12:15], v[112:115]
s_add_u32 s64, s75, 1966080
ds_read_b64_tr_b16 a[106:107], v19 offset:41216
v_mfma_f32_16x16x32_bf16 v[96:99], a[116:119], a[4:7], v[96:99]
buffer_load_dwordx4 v23, s[60:63], s64 offen lds
v_mfma_f32_16x16x32_bf16 v[96:99], a[112:115], a[0:3], v[96:99]
ds_read_b64_tr_b16 a[108:109], v19 offset:43008
v_mfma_f32_16x16x32_bf16 v[36:39], a[72:75], a[0:3], v[36:39]
ds_read_b64_tr_b16 a[110:111], v19 offset:43264
v_mfma_f32_16x16x32_bf16 v[36:39], a[76:79], a[4:7], v[36:39]
ds_read_b64_tr_b16 a[112:113], v20 offset:40960
v_mfma_f32_16x16x32_bf16 v[52:55], a[76:79], a[12:15], v[52:55]
ds_read_b64_tr_b16 a[114:115], v20 offset:41216
v_mfma_f32_16x16x32_bf16 v[52:55], a[72:75], a[8:11], v[52:55]
ds_read_b64_tr_b16 a[116:117], v20 offset:43008
v_mfma_f32_16x16x32_bf16 v[68:71], a[72:75], a[16:19], v[68:71]
s_add_u32 m0, s77, 99328
ds_read_b64_tr_b16 a[118:119], v20 offset:43264
v_mfma_f32_16x16x32_bf16 v[68:71], a[76:79], a[20:23], v[68:71]
s_add_u32 s64, s71, 2654208
s_xor_b32 s68, s66, 8192
v_mfma_f32_16x16x32_bf16 v[84:87], a[76:79], a[28:31], v[84:87]
s_mov_b64 exec, 1
buffer_atomic_add a251, v1, s[52:55], s68 offen offset:0 sc1
s_mov_b64 exec, -1
v_mfma_f32_16x16x32_bf16 v[84:87], a[72:75], a[24:27], v[84:87]
buffer_load_dwordx4 v14, s[56:59], s64 offen lds
v_mfma_f32_16x16x32_bf16 v[148:151], a[80:83], a[24:27], v[148:151]
ds_read_b64_tr_b16 a[72:73], v19 offset:32768
v_mfma_f32_16x16x32_bf16 v[148:151], a[84:87], a[28:31], v[148:151]
ds_read_b64_tr_b16 a[74:75], v19 offset:33024
v_mfma_f32_16x16x32_bf16 v[132:135], a[84:87], a[20:23], v[132:135]
ds_read_b64_tr_b16 a[76:77], v19 offset:34816
v_mfma_f32_16x16x32_bf16 v[132:135], a[80:83], a[16:19], v[132:135]
ds_read_b64_tr_b16 a[78:79], v19 offset:35072
v_mfma_f32_16x16x32_bf16 v[116:119], a[80:83], a[8:11], v[116:119]
v_mfma_f32_16x16x32_bf16 v[116:119], a[84:87], a[12:15], v[116:119]
v_mfma_f32_16x16x32_bf16 v[100:103], a[84:87], a[4:7], v[100:103]
s_add_u32 m0, s78, 118784
v_mfma_f32_16x16x32_bf16 v[100:103], a[80:83], a[0:3], v[100:103]
s_waitcnt lgkmcnt(4)
s_add_u32 s64, s75, 1968128
ds_read_b64_tr_b16 a[80:81], v20 offset:32768
v_mfma_f32_16x16x32_bf16 v[184:187], a[88:91], a[32:35], v[184:187]
buffer_load_dwordx4 v23, s[60:63], s64 offen lds
v_mfma_f32_16x16x32_bf16 v[184:187], a[92:95], a[36:39], v[184:187]
ds_read_b64_tr_b16 a[82:83], v20 offset:33024
v_mfma_f32_16x16x32_bf16 v[192:195], a[92:95], a[44:47], v[192:195]
ds_read_b64_tr_b16 a[84:85], v20 offset:34816
v_mfma_f32_16x16x32_bf16 v[192:195], a[88:91], a[40:43], v[192:195]
ds_read_b64_tr_b16 a[86:87], v20 offset:35072
v_mfma_f32_16x16x32_bf16 v[200:203], a[88:91], a[48:51], v[200:203]
v_mfma_f32_16x16x32_bf16 v[200:203], a[92:95], a[52:55], v[200:203]
v_mfma_f32_16x16x32_bf16 v[208:211], a[92:95], a[60:63], v[208:211]
v_mfma_f32_16x16x32_bf16 v[208:211], a[88:91], a[56:59], v[208:211]
ds_read_b64_tr_b16 a[88:89], v4 offset:32768
v_mfma_f32_16x16x32_bf16 v[212:215], a[96:99], a[56:59], v[212:215]
s_add_u32 m0, s77, 100352
ds_read_b64_tr_b16 a[90:91], v4 offset:33792
v_mfma_f32_16x16x32_bf16 v[212:215], a[100:103], a[60:63], v[212:215]
s_add_u32 s64, s71, 2686976
ds_read_b64_tr_b16 a[92:93], v4 offset:40960
v_mfma_f32_16x16x32_bf16 v[204:207], a[100:103], a[52:55], v[204:207]
buffer_load_dwordx4 v15, s[56:59], s64 offen lds
v_mfma_f32_16x16x32_bf16 v[204:207], a[96:99], a[48:51], v[204:207]
ds_read_b64_tr_b16 a[94:95], v4 offset:41984
v_mfma_f32_16x16x32_bf16 v[196:199], a[96:99], a[40:43], v[196:199]
v_mfma_f32_16x16x32_bf16 v[196:199], a[100:103], a[44:47], v[196:199]
v_mfma_f32_16x16x32_bf16 v[188:191], a[100:103], a[36:39], v[188:191]
v_mfma_f32_16x16x32_bf16 v[188:191], a[96:99], a[32:35], v[188:191]
ds_read_b64_tr_b16 a[96:97], v5 offset:32768
v_mfma_f32_16x16x32_bf16 v[216:219], a[32:35], a[104:107], v[216:219]
ds_read_b64_tr_b16 a[98:99], v5 offset:33792
v_mfma_f32_16x16x32_bf16 v[216:219], a[36:39], a[108:111], v[216:219]
s_add_u32 m0, s78, 122880
ds_read_b64_tr_b16 a[100:101], v5 offset:40960
v_mfma_f32_16x16x32_bf16 v[224:227], a[44:47], a[108:111], v[224:227]
s_add_u32 s64, s75, 1970176
ds_read_b64_tr_b16 a[102:103], v5 offset:41984
v_mfma_f32_16x16x32_bf16 v[224:227], a[40:43], a[104:107], v[224:227]
s_add_u32 s65, s79, 1024
buffer_load_dwordx4 v23, s[60:63], s64 offen lds
v_mfma_f32_16x16x32_bf16 v[232:235], a[48:51], a[104:107], v[232:235]
buffer_store_dwordx4 a[164:167], v16, s[44:47], s65 offen sc1
v_mfma_f32_16x16x32_bf16 v[232:235], a[52:55], a[108:111], v[232:235]
v_mfma_f32_16x16x32_bf16 v[240:243], a[60:63], a[108:111], v[240:243]
v_mfma_f32_16x16x32_bf16 v[240:243], a[56:59], a[104:107], v[240:243]
ds_read_b64_tr_b16 a[104:105], v6 offset:32768
v_mfma_f32_16x16x32_bf16 v[244:247], a[56:59], a[112:115], v[244:247]
ds_read_b64_tr_b16 a[106:107], v6 offset:33792
v_mfma_f32_16x16x32_bf16 v[244:247], a[60:63], a[116:119], v[244:247]
ds_read_b64_tr_b16 a[108:109], v6 offset:40960
v_subrev_u32 v19, 0x8000, v19
v_mfma_f32_16x16x32_bf16 v[236:239], a[52:55], a[116:119], v[236:239]
s_add_u32 m0, s77, 101376
ds_read_b64_tr_b16 a[110:111], v6 offset:41984
v_mfma_f32_16x16x32_bf16 v[236:239], a[48:51], a[112:115], v[236:239]
s_add_u32 s64, s71, 2719744
v_mfma_f32_16x16x32_bf16 v[228:231], a[40:43], a[112:115], v[228:231]
buffer_load_dwordx4 v15, s[56:59], s64 offen lds
v_mfma_f32_16x16x32_bf16 v[228:231], a[44:47], a[116:119], v[228:231]
v_mfma_f32_16x16x32_bf16 v[220:223], a[36:39], a[116:119], v[220:223]
v_mfma_f32_16x16x32_bf16 v[220:223], a[32:35], a[112:115], v[220:223]
s_waitcnt lgkmcnt(4)
ds_read_b64_tr_b16 a[112:113], v7 offset:32768
v_mfma_f32_16x16x32_bf16 v[152:155], a[72:75], a[32:35], v[152:155]
ds_read_b64_tr_b16 a[114:115], v7 offset:33792
v_mfma_f32_16x16x32_bf16 v[152:155], a[76:79], a[36:39], v[152:155]
ds_read_b64_tr_b16 a[116:117], v7 offset:40960
v_subrev_u32 v20, 0x8000, v20
v_mfma_f32_16x16x32_bf16 v[160:163], a[76:79], a[44:47], v[160:163]
ds_read_b64_tr_b16 a[118:119], v7 offset:41984
v_mfma_f32_16x16x32_bf16 v[160:163], a[72:75], a[40:43], v[160:163]
v_mfma_f32_16x16x32_bf16 v[168:171], a[72:75], a[48:51], v[168:171]
v_mfma_f32_16x16x32_bf16 v[168:171], a[76:79], a[52:55], v[168:171]
v_mfma_f32_16x16x32_bf16 v[176:179], a[76:79], a[60:63], v[176:179]
s_add_u32 m0, s76, 32768
v_mfma_f32_16x16x32_bf16 v[176:179], a[72:75], a[56:59], v[176:179]
s_add_u32 s64, s72, 640
ds_read_b64_tr_b16 a[72:73], v8 offset:32768
v_mfma_f32_16x16x32_bf16 v[180:183], a[80:83], a[56:59], v[180:183]
buffer_load_dwordx4 v12, s[48:51], s64 offen lds
v_mfma_f32_16x16x32_bf16 v[180:183], a[84:87], a[60:63], v[180:183]
ds_read_b64_tr_b16 a[74:75], v8 offset:33792
v_subrev_u32 v4, 0x8000, v4
v_mfma_f32_16x16x32_bf16 v[172:175], a[84:87], a[52:55], v[172:175]
ds_read_b64_tr_b16 a[76:77], v8 offset:40960
v_mfma_f32_16x16x32_bf16 v[172:175], a[80:83], a[48:51], v[172:175]
s_add_u32 m0, s76, 33792
ds_read_b64_tr_b16 a[78:79], v8 offset:41984
v_mfma_f32_16x16x32_bf16 v[164:167], a[80:83], a[40:43], v[164:167]
s_add_u32 s64, s72, 17024
v_mfma_f32_16x16x32_bf16 v[164:167], a[84:87], a[44:47], v[164:167]
buffer_load_dwordx4 v13, s[48:51], s64 offen lds
v_mfma_f32_16x16x32_bf16 v[156:159], a[84:87], a[36:39], v[156:159]
v_mfma_f32_16x16x32_bf16 v[156:159], a[80:83], a[32:35], v[156:159]
ds_read_b64_tr_b16 a[80:81], v9 offset:32768
v_mfma_f32_16x16x32_bf16 v[24:27], a[88:91], a[32:35], v[24:27]
s_add_u32 m0, s76, 34816
ds_read_b64_tr_b16 a[82:83], v9 offset:33792
v_mfma_f32_16x16x32_bf16 v[24:27], a[92:95], a[36:39], v[24:27]
s_add_u32 s64, s72, 131712
ds_read_b64_tr_b16 a[84:85], v9 offset:40960
v_subrev_u32 v5, 0x8000, v5
v_mfma_f32_16x16x32_bf16 v[40:43], a[92:95], a[44:47], v[40:43]
buffer_load_dwordx4 v12, s[48:51], s64 offen lds
v_mfma_f32_16x16x32_bf16 v[40:43], a[88:91], a[40:43], v[40:43]
ds_read_b64_tr_b16 a[86:87], v9 offset:41984
v_mfma_f32_16x16x32_bf16 v[56:59], a[88:91], a[48:51], v[56:59]
v_mfma_f32_16x16x32_bf16 v[56:59], a[92:95], a[52:55], v[56:59]
s_add_u32 m0, s76, 35840
v_mfma_f32_16x16x32_bf16 v[72:75], a[92:95], a[60:63], v[72:75]
s_waitcnt vmcnt(13)
s_add_u32 s64, s72, 148096
ds_read_b128 a[0:3], v2 offset:0
v_mfma_f32_16x16x32_bf16 v[72:75], a[88:91], a[56:59], v[72:75]
buffer_load_dwordx4 v13, s[48:51], s64 offen lds
v_mfma_f32_16x16x32_bf16 v[136:139], a[96:99], a[56:59], v[136:139]
ds_read_b128 a[4:7], v3 offset:0
v_mfma_f32_16x16x32_bf16 v[136:139], a[100:103], a[60:63], v[136:139]
ds_read_b128 a[8:11], v2 offset:2048
v_subrev_u32 v6, 0x8000, v6
v_mfma_f32_16x16x32_bf16 v[120:123], a[100:103], a[52:55], v[120:123]
s_add_u32 m0, s76, 36864
ds_read_b128 a[12:15], v3 offset:2048
v_mfma_f32_16x16x32_bf16 v[120:123], a[96:99], a[48:51], v[120:123]
s_add_u32 s64, s73, 640
ds_read_b128 a[16:19], v2 offset:4096
v_mfma_f32_16x16x32_bf16 v[104:107], a[96:99], a[40:43], v[104:107]
buffer_load_dwordx4 v12, s[48:51], s64 offen lds
v_mfma_f32_16x16x32_bf16 v[104:107], a[100:103], a[44:47], v[104:107]
ds_read_b128 a[20:23], v3 offset:4096
v_mfma_f32_16x16x32_bf16 v[88:91], a[100:103], a[36:39], v[88:91]
ds_read_b128 a[24:27], v2 offset:6144
v_mfma_f32_16x16x32_bf16 v[88:91], a[96:99], a[32:35], v[88:91]
s_waitcnt lgkmcnt(7)
s_add_u32 m0, s76, 37888
ds_read_b128 a[28:31], v3 offset:6144
v_mfma_f32_16x16x32_bf16 v[28:31], a[104:107], a[32:35], v[28:31]
s_add_u32 s64, s73, 17024
ds_read_b64_tr_b16 a[88:89], v10 offset:32768
v_mfma_f32_16x16x32_bf16 v[28:31], a[108:111], a[36:39], v[28:31]
buffer_load_dwordx4 v13, s[48:51], s64 offen lds
v_mfma_f32_16x16x32_bf16 v[44:47], a[108:111], a[44:47], v[44:47]
ds_read_b64_tr_b16 a[90:91], v10 offset:33792
v_subrev_u32 v7, 0x8000, v7
v_mfma_f32_16x16x32_bf16 v[44:47], a[104:107], a[40:43], v[44:47]
s_add_u32 s65, s79, 18432
ds_read_b64_tr_b16 a[92:93], v10 offset:40960
v_mfma_f32_16x16x32_bf16 v[60:63], a[104:107], a[48:51], v[60:63]
s_add_u32 m0, s76, 38912
buffer_store_dwordx4 a[168:171], v16, s[44:47], s65 offen sc1
v_mfma_f32_16x16x32_bf16 v[60:63], a[108:111], a[52:55], v[60:63]
s_add_u32 s64, s73, 131712
ds_read_b64_tr_b16 a[94:95], v10 offset:41984
v_mfma_f32_16x16x32_bf16 v[76:79], a[108:111], a[60:63], v[76:79]
buffer_load_dwordx4 v12, s[48:51], s64 offen lds
v_mfma_f32_16x16x32_bf16 v[76:79], a[104:107], a[56:59], v[76:79]
ds_read_b64_tr_b16 a[96:97], v11 offset:32768
v_mfma_f32_16x16x32_bf16 v[140:143], a[112:115], a[56:59], v[140:143]
ds_read_b64_tr_b16 a[98:99], v11 offset:33792
v_mfma_f32_16x16x32_bf16 v[140:143], a[116:119], a[60:63], v[140:143]
s_add_u32 m0, s76, 39936
ds_read_b64_tr_b16 a[100:101], v11 offset:40960
v_subrev_u32 v8, 0x8000, v8
v_mfma_f32_16x16x32_bf16 v[124:127], a[116:119], a[52:55], v[124:127]
s_add_u32 s64, s73, 148096
ds_read_b64_tr_b16 a[102:103], v11 offset:41984
v_mfma_f32_16x16x32_bf16 v[124:127], a[112:115], a[48:51], v[124:127]
buffer_load_dwordx4 v13, s[48:51], s64 offen lds
v_mfma_f32_16x16x32_bf16 v[108:111], a[112:115], a[40:43], v[108:111]
v_mfma_f32_16x16x32_bf16 v[108:111], a[116:119], a[44:47], v[108:111]
v_mfma_f32_16x16x32_bf16 v[92:95], a[116:119], a[36:39], v[92:95]
v_subrev_u32 v9, 0x8000, v9
v_subrev_u32 v10, 0x8000, v10
v_mfma_f32_16x16x32_bf16 v[92:95], a[112:115], a[32:35], v[92:95]
v_subrev_u32 v11, 0x8000, v11
v_mfma_f32_16x16x32_bf16 v[32:35], a[72:75], a[32:35], v[32:35]
v_mfma_f32_16x16x32_bf16 v[32:35], a[76:79], a[36:39], v[32:35]
v_mfma_f32_16x16x32_bf16 v[48:51], a[76:79], a[44:47], v[48:51]
s_waitcnt lgkmcnt(0)
s_barrier
v_mfma_f32_16x16x32_bf16 v[48:51], a[72:75], a[40:43], v[48:51]
s_add_u32 m0, s77, 131072
ds_read_b64_tr_b16 a[104:105], v19 offset:4096
v_mfma_f32_16x16x32_bf16 v[64:67], a[72:75], a[48:51], v[64:67]
s_add_u32 s64, s71, 3145728
ds_read_b64_tr_b16 a[106:107], v19 offset:4352
v_mfma_f32_16x16x32_bf16 v[64:67], a[76:79], a[52:55], v[64:67]
buffer_load_dwordx4 v14, s[56:59], s64 offen lds
v_mfma_f32_16x16x32_bf16 v[80:83], a[76:79], a[60:63], v[80:83]
ds_read_b64_tr_b16 a[108:109], v19 offset:6144
v_mfma_f32_16x16x32_bf16 v[80:83], a[72:75], a[56:59], v[80:83]
ds_read_b64_tr_b16 a[110:111], v19 offset:6400
v_mfma_f32_16x16x32_bf16 v[144:147], a[80:83], a[56:59], v[144:147]
ds_read_b64_tr_b16 a[112:113], v20 offset:4096
v_mfma_f32_16x16x32_bf16 v[144:147], a[84:87], a[60:63], v[144:147]
ds_read_b64_tr_b16 a[114:115], v20 offset:4352
v_mfma_f32_16x16x32_bf16 v[128:131], a[84:87], a[52:55], v[128:131]
ds_read_b64_tr_b16 a[116:117], v20 offset:6144
v_mfma_f32_16x16x32_bf16 v[128:131], a[80:83], a[48:51], v[128:131]
ds_read_b64_tr_b16 a[118:119], v20 offset:6400
v_mfma_f32_16x16x32_bf16 v[112:115], a[80:83], a[40:43], v[112:115]
s_add_u32 m0, s78, 147456
ds_read_b64_tr_b16 a[72:73], v19 offset:8192
v_mfma_f32_16x16x32_bf16 v[112:115], a[84:87], a[44:47], v[112:115]
s_add_u32 s64, s75, 2359296
ds_read_b64_tr_b16 a[74:75], v19 offset:8448
v_mfma_f32_16x16x32_bf16 v[96:99], a[84:87], a[36:39], v[96:99]
buffer_load_dwordx4 v23, s[60:63], s64 offen lds
v_mfma_f32_16x16x32_bf16 v[96:99], a[80:83], a[32:35], v[96:99]
ds_read_b64_tr_b16 a[76:77], v19 offset:10240
v_mfma_f32_16x16x32_bf16 v[36:39], a[88:91], a[32:35], v[36:39]
ds_read_b64_tr_b16 a[78:79], v19 offset:10496
v_mfma_f32_16x16x32_bf16 v[36:39], a[92:95], a[36:39], v[36:39]
ds_read_b64_tr_b16 a[80:81], v20 offset:8192
v_mfma_f32_16x16x32_bf16 v[52:55], a[92:95], a[44:47], v[52:55]
ds_read_b64_tr_b16 a[82:83], v20 offset:8448
v_mfma_f32_16x16x32_bf16 v[52:55], a[88:91], a[40:43], v[52:55]
ds_read_b64_tr_b16 a[84:85], v20 offset:10240
v_mfma_f32_16x16x32_bf16 v[68:71], a[88:91], a[48:51], v[68:71]
s_add_u32 m0, s77, 132096
ds_read_b64_tr_b16 a[86:87], v20 offset:10496
v_mfma_f32_16x16x32_bf16 v[68:71], a[92:95], a[52:55], v[68:71]
s_add_u32 s64, s71, 3178496
s_xor_b32 s68, s66, 12288
v_mfma_f32_16x16x32_bf16 v[84:87], a[92:95], a[60:63], v[84:87]
s_mov_b64 exec, 1
buffer_atomic_add a251, v1, s[52:55], s68 offen offset:0 sc1
s_mov_b64 exec, -1
v_mfma_f32_16x16x32_bf16 v[84:87], a[88:91], a[56:59], v[84:87]
buffer_load_dwordx4 v14, s[56:59], s64 offen lds
v_mfma_f32_16x16x32_bf16 v[148:151], a[96:99], a[56:59], v[148:151]
ds_read_b64_tr_b16 a[88:89], v19 offset:0
v_mfma_f32_16x16x32_bf16 v[148:151], a[100:103], a[60:63], v[148:151]
ds_read_b64_tr_b16 a[90:91], v19 offset:256
v_mfma_f32_16x16x32_bf16 v[132:135], a[100:103], a[52:55], v[132:135]
ds_read_b64_tr_b16 a[92:93], v19 offset:2048
v_mfma_f32_16x16x32_bf16 v[132:135], a[96:99], a[48:51], v[132:135]
ds_read_b64_tr_b16 a[94:95], v19 offset:2304
v_mfma_f32_16x16x32_bf16 v[116:119], a[96:99], a[40:43], v[116:119]
v_mfma_f32_16x16x32_bf16 v[116:119], a[100:103], a[44:47], v[116:119]
v_mfma_f32_16x16x32_bf16 v[100:103], a[100:103], a[36:39], v[100:103]
s_add_u32 m0, s78, 151552
v_mfma_f32_16x16x32_bf16 v[100:103], a[96:99], a[32:35], v[100:103]
s_waitcnt lgkmcnt(4)
s_add_u32 s64, s75, 2361344
ds_read_b64_tr_b16 a[96:97], v20 offset:0
v_mfma_f32_16x16x32_bf16 v[184:187], a[104:107], a[0:3], v[184:187]
s_mov_b32 s36, s20
buffer_load_dwordx4 v23, s[60:63], s64 offen lds
v_mfma_f32_16x16x32_bf16 v[184:187], a[108:111], a[4:7], v[184:187]
s_mov_b32 s37, s21
ds_read_b64_tr_b16 a[98:99], v20 offset:256
v_mfma_f32_16x16x32_bf16 v[192:195], a[108:111], a[12:15], v[192:195]
s_mov_b32 s38, 2097152
s_add_u32 s17, s78, .-L_pc+6144
ds_read_b64_tr_b16 a[100:101], v20 offset:2048
v_mfma_f32_16x16x32_bf16 v[192:195], a[104:107], a[8:11], v[192:195]
s_mov_b32 s40, s14
s_add_u32 s65, s79, 6144
ds_read_b64_tr_b16 a[102:103], v20 offset:2304
v_mfma_f32_16x16x32_bf16 v[200:203], a[104:107], a[16:19], v[200:203]
s_mov_b32 s41, s15
buffer_load_dword a252, v16, s[88:91], s17 offen
v_mfma_f32_16x16x32_bf16 v[200:203], a[108:111], a[20:23], v[200:203]
s_mov_b32 s42, 8388608
buffer_store_dwordx4 a[172:175], v16, s[44:47], s65 offen sc1
v_mfma_f32_16x16x32_bf16 v[208:211], a[108:111], a[28:31], v[208:211]
v_mfma_f32_16x16x32_bf16 v[208:211], a[104:107], a[24:27], v[208:211]
ds_read_b64_tr_b16 a[104:105], v4 offset:0
v_mfma_f32_16x16x32_bf16 v[212:215], a[112:115], a[24:27], v[212:215]
s_add_u32 m0, s77, 133120
ds_read_b64_tr_b16 a[106:107], v4 offset:1024
v_mfma_f32_16x16x32_bf16 v[212:215], a[116:119], a[28:31], v[212:215]
s_add_u32 s64, s71, 3211264
ds_read_b64_tr_b16 a[108:109], v4 offset:8192
v_mfma_f32_16x16x32_bf16 v[204:207], a[116:119], a[20:23], v[204:207]
buffer_load_dwordx4 v15, s[56:59], s64 offen lds
v_mfma_f32_16x16x32_bf16 v[204:207], a[112:115], a[16:19], v[204:207]
ds_read_b64_tr_b16 a[110:111], v4 offset:9216
v_mfma_f32_16x16x32_bf16 v[196:199], a[112:115], a[8:11], v[196:199]
v_mfma_f32_16x16x32_bf16 v[196:199], a[116:119], a[12:15], v[196:199]
v_mfma_f32_16x16x32_bf16 v[188:191], a[116:119], a[4:7], v[188:191]
v_mfma_f32_16x16x32_bf16 v[188:191], a[112:115], a[0:3], v[188:191]
ds_read_b64_tr_b16 a[112:113], v5 offset:0
v_mfma_f32_16x16x32_bf16 v[216:219], a[0:3], a[72:75], v[216:219]
ds_read_b64_tr_b16 a[114:115], v5 offset:1024
v_mfma_f32_16x16x32_bf16 v[216:219], a[4:7], a[76:79], v[216:219]
s_add_u32 m0, s78, 155648
ds_read_b64_tr_b16 a[116:117], v5 offset:8192
v_mfma_f32_16x16x32_bf16 v[224:227], a[12:15], a[76:79], v[224:227]
s_add_u32 s64, s75, 2363392
ds_read_b64_tr_b16 a[118:119], v5 offset:9216
v_mfma_f32_16x16x32_bf16 v[224:227], a[8:11], a[72:75], v[224:227]
buffer_load_dwordx4 v23, s[60:63], s64 offen lds
v_mfma_f32_16x16x32_bf16 v[232:235], a[16:19], a[72:75], v[232:235]
v_mfma_f32_16x16x32_bf16 v[232:235], a[20:23], a[76:79], v[232:235]
v_mfma_f32_16x16x32_bf16 v[240:243], a[28:31], a[76:79], v[240:243]
v_mfma_f32_16x16x32_bf16 v[240:243], a[24:27], a[72:75], v[240:243]
ds_read_b64_tr_b16 a[72:73], v6 offset:0
v_mfma_f32_16x16x32_bf16 v[244:247], a[24:27], a[80:83], v[244:247]
ds_read_b64_tr_b16 a[74:75], v6 offset:1024
v_mfma_f32_16x16x32_bf16 v[244:247], a[28:31], a[84:87], v[244:247]
ds_read_b64_tr_b16 a[76:77], v6 offset:8192
v_mfma_f32_16x16x32_bf16 v[236:239], a[20:23], a[84:87], v[236:239]
s_add_u32 m0, s77, 134144
ds_read_b64_tr_b16 a[78:79], v6 offset:9216
v_mfma_f32_16x16x32_bf16 v[236:239], a[16:19], a[80:83], v[236:239]
s_add_u32 s64, s71, 3244032
v_mfma_f32_16x16x32_bf16 v[228:231], a[8:11], a[80:83], v[228:231]
buffer_load_dwordx4 v15, s[56:59], s64 offen lds
v_mfma_f32_16x16x32_bf16 v[228:231], a[12:15], a[84:87], v[228:231]
v_mfma_f32_16x16x32_bf16 v[220:223], a[4:7], a[84:87], v[220:223]
v_mfma_f32_16x16x32_bf16 v[220:223], a[0:3], a[80:83], v[220:223]
s_waitcnt lgkmcnt(4)
ds_read_b64_tr_b16 a[80:81], v7 offset:0
v_mfma_f32_16x16x32_bf16 v[152:155], a[88:91], a[0:3], v[152:155]
ds_read_b64_tr_b16 a[82:83], v7 offset:1024
v_mfma_f32_16x16x32_bf16 v[152:155], a[92:95], a[4:7], v[152:155]
ds_read_b64_tr_b16 a[84:85], v7 offset:8192
v_mfma_f32_16x16x32_bf16 v[160:163], a[92:95], a[12:15], v[160:163]
ds_read_b64_tr_b16 a[86:87], v7 offset:9216
v_mfma_f32_16x16x32_bf16 v[160:163], a[88:91], a[8:11], v[160:163]
v_mfma_f32_16x16x32_bf16 v[168:171], a[88:91], a[16:19], v[168:171]
v_mfma_f32_16x16x32_bf16 v[168:171], a[92:95], a[20:23], v[168:171]
v_mfma_f32_16x16x32_bf16 v[176:179], a[92:95], a[28:31], v[176:179]
s_add_u32 m0, s76, 0
v_mfma_f32_16x16x32_bf16 v[176:179], a[88:91], a[24:27], v[176:179]
s_add_u32 s64, s72, 768
ds_read_b64_tr_b16 a[88:89], v8 offset:0
v_mfma_f32_16x16x32_bf16 v[180:183], a[96:99], a[24:27], v[180:183]
buffer_load_dwordx4 v12, s[48:51], s64 offen lds
v_mfma_f32_16x16x32_bf16 v[180:183], a[100:103], a[28:31], v[180:183]
ds_read_b64_tr_b16 a[90:91], v8 offset:1024
v_mfma_f32_16x16x32_bf16 v[172:175], a[100:103], a[20:23], v[172:175]
ds_read_b64_tr_b16 a[92:93], v8 offset:8192
v_mfma_f32_16x16x32_bf16 v[172:175], a[96:99], a[16:19], v[172:175]
s_add_u32 m0, s76, 1024
ds_read_b64_tr_b16 a[94:95], v8 offset:9216
v_mfma_f32_16x16x32_bf16 v[164:167], a[96:99], a[8:11], v[164:167]
s_add_u32 s64, s72, 17152
v_mfma_f32_16x16x32_bf16 v[164:167], a[100:103], a[12:15], v[164:167]
buffer_load_dwordx4 v13, s[48:51], s64 offen lds
v_mfma_f32_16x16x32_bf16 v[156:159], a[100:103], a[4:7], v[156:159]
v_mfma_f32_16x16x32_bf16 v[156:159], a[96:99], a[0:3], v[156:159]
ds_read_b64_tr_b16 a[96:97], v9 offset:0
v_mfma_f32_16x16x32_bf16 v[24:27], a[104:107], a[0:3], v[24:27]
s_add_u32 m0, s76, 2048
ds_read_b64_tr_b16 a[98:99], v9 offset:1024
v_mfma_f32_16x16x32_bf16 v[24:27], a[108:111], a[4:7], v[24:27]
s_add_u32 s64, s72, 131840
ds_read_b64_tr_b16 a[100:101], v9 offset:8192
v_mfma_f32_16x16x32_bf16 v[40:43], a[108:111], a[12:15], v[40:43]
buffer_load_dwordx4 v12, s[48:51], s64 offen lds
v_mfma_f32_16x16x32_bf16 v[40:43], a[104:107], a[8:11], v[40:43]
ds_read_b64_tr_b16 a[102:103], v9 offset:9216
v_mfma_f32_16x16x32_bf16 v[56:59], a[104:107], a[16:19], v[56:59]
v_mfma_f32_16x16x32_bf16 v[56:59], a[108:111], a[20:23], v[56:59]
s_add_u32 m0, s76, 3072
v_mfma_f32_16x16x32_bf16 v[72:75], a[108:111], a[28:31], v[72:75]
s_waitcnt vmcnt(13)
s_add_u32 s64, s72, 148224
ds_read_b128 a[32:35], v2 offset:32768
v_mfma_f32_16x16x32_bf16 v[72:75], a[104:107], a[24:27], v[72:75]
s_add_u32 s65, s79, 2048
buffer_load_dwordx4 v13, s[48:51], s64 offen lds
v_mfma_f32_16x16x32_bf16 v[136:139], a[112:115], a[24:27], v[136:139]
buffer_store_dwordx4 a[176:179], v16, s[44:47], s65 offen sc1
v_mfma_f32_16x16x32_bf16 v[136:139], a[116:119], a[28:31], v[136:139]
ds_read_b128 a[36:39], v3 offset:32768
v_mfma_f32_16x16x32_bf16 v[120:123], a[116:119], a[20:23], v[120:123]
s_add_u32 m0, s76, 4096
ds_read_b128 a[40:43], v2 offset:34816
v_mfma_f32_16x16x32_bf16 v[120:123], a[112:115], a[16:19], v[120:123]
s_add_u32 s64, s73, 768
ds_read_b128 a[44:47], v3 offset:34816
v_mfma_f32_16x16x32_bf16 v[104:107], a[112:115], a[8:11], v[104:107]
buffer_load_dwordx4 v12, s[48:51], s64 offen lds
v_mfma_f32_16x16x32_bf16 v[104:107], a[116:119], a[12:15], v[104:107]
ds_read_b128 a[48:51], v2 offset:36864
v_mfma_f32_16x16x32_bf16 v[88:91], a[116:119], a[4:7], v[88:91]
ds_read_b128 a[52:55], v3 offset:36864
v_mfma_f32_16x16x32_bf16 v[88:91], a[112:115], a[0:3], v[88:91]
s_waitcnt lgkmcnt(6)
s_add_u32 m0, s76, 5120
ds_read_b128 a[56:59], v2 offset:38912
v_mfma_f32_16x16x32_bf16 v[28:31], a[72:75], a[0:3], v[28:31]
s_add_u32 s64, s73, 17152
ds_read_b128 a[60:63], v3 offset:38912
v_mfma_f32_16x16x32_bf16 v[28:31], a[76:79], a[4:7], v[28:31]
buffer_load_dwordx4 v13, s[48:51], s64 offen lds
v_mfma_f32_16x16x32_bf16 v[44:47], a[76:79], a[12:15], v[44:47]
ds_read_b64_tr_b16 a[104:105], v10 offset:0
v_mfma_f32_16x16x32_bf16 v[44:47], a[72:75], a[8:11], v[44:47]
ds_read_b64_tr_b16 a[106:107], v10 offset:1024
v_mfma_f32_16x16x32_bf16 v[60:63], a[72:75], a[16:19], v[60:63]
s_add_u32 m0, s76, 6144
ds_read_b64_tr_b16 a[108:109], v10 offset:8192
v_mfma_f32_16x16x32_bf16 v[60:63], a[76:79], a[20:23], v[60:63]
s_add_u32 s64, s73, 131840
ds_read_b64_tr_b16 a[110:111], v10 offset:9216
v_mfma_f32_16x16x32_bf16 v[76:79], a[76:79], a[28:31], v[76:79]
buffer_load_dwordx4 v12, s[48:51], s64 offen lds
v_mfma_f32_16x16x32_bf16 v[76:79], a[72:75], a[24:27], v[76:79]
ds_read_b64_tr_b16 a[112:113], v11 offset:0
v_mfma_f32_16x16x32_bf16 v[140:143], a[80:83], a[24:27], v[140:143]
ds_read_b64_tr_b16 a[114:115], v11 offset:1024
v_mfma_f32_16x16x32_bf16 v[140:143], a[84:87], a[28:31], v[140:143]
s_add_u32 m0, s76, 7168
ds_read_b64_tr_b16 a[116:117], v11 offset:8192
v_mfma_f32_16x16x32_bf16 v[124:127], a[84:87], a[20:23], v[124:127]
s_add_u32 s64, s73, 148224
ds_read_b64_tr_b16 a[118:119], v11 offset:9216
v_mfma_f32_16x16x32_bf16 v[124:127], a[80:83], a[16:19], v[124:127]
buffer_load_dwordx4 v13, s[48:51], s64 offen lds
v_mfma_f32_16x16x32_bf16 v[108:111], a[80:83], a[8:11], v[108:111]
v_mfma_f32_16x16x32_bf16 v[108:111], a[84:87], a[12:15], v[108:111]
v_mfma_f32_16x16x32_bf16 v[92:95], a[84:87], a[4:7], v[92:95]
v_mfma_f32_16x16x32_bf16 v[92:95], a[80:83], a[0:3], v[92:95]
v_mfma_f32_16x16x32_bf16 v[32:35], a[88:91], a[0:3], v[32:35]
v_mfma_f32_16x16x32_bf16 v[32:35], a[92:95], a[4:7], v[32:35]
v_mfma_f32_16x16x32_bf16 v[48:51], a[92:95], a[12:15], v[48:51]
s_waitcnt lgkmcnt(0)
s_barrier
v_mfma_f32_16x16x32_bf16 v[48:51], a[88:91], a[8:11], v[48:51]
s_add_u32 m0, s77, 65536
ds_read_b64_tr_b16 a[72:73], v19 offset:36864
v_mfma_f32_16x16x32_bf16 v[64:67], a[88:91], a[16:19], v[64:67]
s_add_u32 s64, s71, 3670016
ds_read_b64_tr_b16 a[74:75], v19 offset:37120
v_mfma_f32_16x16x32_bf16 v[64:67], a[92:95], a[20:23], v[64:67]
buffer_load_dwordx4 v14, s[56:59], s64 offen lds
v_mfma_f32_16x16x32_bf16 v[80:83], a[92:95], a[28:31], v[80:83]
ds_read_b64_tr_b16 a[76:77], v19 offset:38912
v_mfma_f32_16x16x32_bf16 v[80:83], a[88:91], a[24:27], v[80:83]
ds_read_b64_tr_b16 a[78:79], v19 offset:39168
v_mfma_f32_16x16x32_bf16 v[144:147], a[96:99], a[24:27], v[144:147]
ds_read_b64_tr_b16 a[80:81], v20 offset:36864
v_mfma_f32_16x16x32_bf16 v[144:147], a[100:103], a[28:31], v[144:147]
ds_read_b64_tr_b16 a[82:83], v20 offset:37120
v_mfma_f32_16x16x32_bf16 v[128:131], a[100:103], a[20:23], v[128:131]
ds_read_b64_tr_b16 a[84:85], v20 offset:38912
v_mfma_f32_16x16x32_bf16 v[128:131], a[96:99], a[16:19], v[128:131]
ds_read_b64_tr_b16 a[86:87], v20 offset:39168
v_mfma_f32_16x16x32_bf16 v[112:115], a[96:99], a[8:11], v[112:115]
s_add_u32 m0, s78, 81920
ds_read_b64_tr_b16 a[88:89], v19 offset:40960
v_mfma_f32_16x16x32_bf16 v[112:115], a[100:103], a[12:15], v[112:115]
s_add_u32 s64, s75, 2752512
ds_read_b64_tr_b16 a[90:91], v19 offset:41216
v_mfma_f32_16x16x32_bf16 v[96:99], a[100:103], a[4:7], v[96:99]
buffer_load_dwordx4 v23, s[60:63], s64 offen lds
v_mfma_f32_16x16x32_bf16 v[96:99], a[96:99], a[0:3], v[96:99]
ds_read_b64_tr_b16 a[92:93], v19 offset:43008
v_mfma_f32_16x16x32_bf16 v[36:39], a[104:107], a[0:3], v[36:39]
ds_read_b64_tr_b16 a[94:95], v19 offset:43264
v_mfma_f32_16x16x32_bf16 v[36:39], a[108:111], a[4:7], v[36:39]
ds_read_b64_tr_b16 a[96:97], v20 offset:40960
v_mfma_f32_16x16x32_bf16 v[52:55], a[108:111], a[12:15], v[52:55]
ds_read_b64_tr_b16 a[98:99], v20 offset:41216
v_mfma_f32_16x16x32_bf16 v[52:55], a[104:107], a[8:11], v[52:55]
ds_read_b64_tr_b16 a[100:101], v20 offset:43008
v_mfma_f32_16x16x32_bf16 v[68:71], a[104:107], a[16:19], v[68:71]
ds_read_b64_tr_b16 a[102:103], v20 offset:43264
v_mfma_f32_16x16x32_bf16 v[68:71], a[108:111], a[20:23], v[68:71]
s_add_u32 m0, s77, 66560
v_mfma_f32_16x16x32_bf16 v[84:87], a[108:111], a[28:31], v[84:87]
s_add_u32 s64, s71, 3702784
v_mfma_f32_16x16x32_bf16 v[84:87], a[104:107], a[24:27], v[84:87]
s_add_u32 s65, s79, 19456
buffer_load_dwordx4 v14, s[56:59], s64 offen lds
v_mfma_f32_16x16x32_bf16 v[148:151], a[112:115], a[24:27], v[148:151]
buffer_store_dwordx4 a[180:183], v16, s[44:47], s65 offen sc1
v_mfma_f32_16x16x32_bf16 v[148:151], a[116:119], a[28:31], v[148:151]
ds_read_b64_tr_b16 a[104:105], v19 offset:32768
v_mfma_f32_16x16x32_bf16 v[132:135], a[116:119], a[20:23], v[132:135]
ds_read_b64_tr_b16 a[106:107], v19 offset:33024
v_mfma_f32_16x16x32_bf16 v[132:135], a[112:115], a[16:19], v[132:135]
ds_read_b64_tr_b16 a[108:109], v19 offset:34816
v_mfma_f32_16x16x32_bf16 v[116:119], a[112:115], a[8:11], v[116:119]
ds_read_b64_tr_b16 a[110:111], v19 offset:35072
v_mfma_f32_16x16x32_bf16 v[116:119], a[116:119], a[12:15], v[116:119]
v_mfma_f32_16x16x32_bf16 v[100:103], a[116:119], a[4:7], v[100:103]
s_add_u32 m0, s78, 86016
v_mfma_f32_16x16x32_bf16 v[100:103], a[112:115], a[0:3], v[100:103]
s_waitcnt lgkmcnt(4)
s_add_u32 s64, s75, 2754560
ds_read_b64_tr_b16 a[112:113], v20 offset:32768
v_mfma_f32_16x16x32_bf16 v[184:187], a[72:75], a[32:35], v[184:187]
buffer_load_dwordx4 v23, s[60:63], s64 offen lds
v_mfma_f32_16x16x32_bf16 v[184:187], a[76:79], a[36:39], v[184:187]
ds_read_b64_tr_b16 a[114:115], v20 offset:33024
v_mfma_f32_16x16x32_bf16 v[192:195], a[76:79], a[44:47], v[192:195]
ds_read_b64_tr_b16 a[116:117], v20 offset:34816
v_mfma_f32_16x16x32_bf16 v[192:195], a[72:75], a[40:43], v[192:195]
ds_read_b64_tr_b16 a[118:119], v20 offset:35072
v_mfma_f32_16x16x32_bf16 v[200:203], a[72:75], a[48:51], v[200:203]
v_mfma_f32_16x16x32_bf16 v[200:203], a[76:79], a[52:55], v[200:203]
v_mfma_f32_16x16x32_bf16 v[208:211], a[76:79], a[60:63], v[208:211]
v_mfma_f32_16x16x32_bf16 v[208:211], a[72:75], a[56:59], v[208:211]
ds_read_b64_tr_b16 a[72:73], v4 offset:32768
v_mfma_f32_16x16x32_bf16 v[212:215], a[80:83], a[56:59], v[212:215]
s_add_u32 m0, s77, 67584
ds_read_b64_tr_b16 a[74:75], v4 offset:33792
v_mfma_f32_16x16x32_bf16 v[212:215], a[84:87], a[60:63], v[212:215]
s_add_u32 s64, s71, 3735552
ds_read_b64_tr_b16 a[76:77], v4 offset:40960
v_mfma_f32_16x16x32_bf16 v[204:207], a[84:87], a[52:55], v[204:207]
buffer_load_dwordx4 v15, s[56:59], s64 offen lds
v_mfma_f32_16x16x32_bf16 v[204:207], a[80:83], a[48:51], v[204:207]
ds_read_b64_tr_b16 a[78:79], v4 offset:41984
v_mfma_f32_16x16x32_bf16 v[196:199], a[80:83], a[40:43], v[196:199]
v_mfma_f32_16x16x32_bf16 v[196:199], a[84:87], a[44:47], v[196:199]
v_mfma_f32_16x16x32_bf16 v[188:191], a[84:87], a[36:39], v[188:191]
v_mfma_f32_16x16x32_bf16 v[188:191], a[80:83], a[32:35], v[188:191]
ds_read_b64_tr_b16 a[80:81], v5 offset:32768
v_mfma_f32_16x16x32_bf16 v[216:219], a[32:35], a[88:91], v[216:219]
ds_read_b64_tr_b16 a[82:83], v5 offset:33792
v_mfma_f32_16x16x32_bf16 v[216:219], a[36:39], a[92:95], v[216:219]
s_add_u32 m0, s78, 90112
ds_read_b64_tr_b16 a[84:85], v5 offset:40960
v_mfma_f32_16x16x32_bf16 v[224:227], a[44:47], a[92:95], v[224:227]
s_add_u32 s64, s75, 2756608
ds_read_b64_tr_b16 a[86:87], v5 offset:41984
v_mfma_f32_16x16x32_bf16 v[224:227], a[40:43], a[88:91], v[224:227]
buffer_load_dwordx4 v23, s[60:63], s64 offen lds
v_mfma_f32_16x16x32_bf16 v[232:235], a[48:51], a[88:91], v[232:235]
v_mfma_f32_16x16x32_bf16 v[232:235], a[52:55], a[92:95], v[232:235]
v_mfma_f32_16x16x32_bf16 v[240:243], a[60:63], a[92:95], v[240:243]
v_mfma_f32_16x16x32_bf16 v[240:243], a[56:59], a[88:91], v[240:243]
ds_read_b64_tr_b16 a[88:89], v6 offset:32768
v_mfma_f32_16x16x32_bf16 v[244:247], a[56:59], a[96:99], v[244:247]
ds_read_b64_tr_b16 a[90:91], v6 offset:33792
v_mfma_f32_16x16x32_bf16 v[244:247], a[60:63], a[100:103], v[244:247]
ds_read_b64_tr_b16 a[92:93], v6 offset:40960
v_add_u32 v19, 0x8000, v19
v_mfma_f32_16x16x32_bf16 v[236:239], a[52:55], a[100:103], v[236:239]
s_add_u32 m0, s77, 68608
ds_read_b64_tr_b16 a[94:95], v6 offset:41984
v_mfma_f32_16x16x32_bf16 v[236:239], a[48:51], a[96:99], v[236:239]
s_add_u32 s64, s71, 3768320
v_mfma_f32_16x16x32_bf16 v[228:231], a[40:43], a[96:99], v[228:231]
buffer_load_dwordx4 v15, s[56:59], s64 offen lds
v_mfma_f32_16x16x32_bf16 v[228:231], a[44:47], a[100:103], v[228:231]
v_mfma_f32_16x16x32_bf16 v[220:223], a[36:39], a[100:103], v[220:223]
v_mfma_f32_16x16x32_bf16 v[220:223], a[32:35], a[96:99], v[220:223]
s_waitcnt lgkmcnt(4)
ds_read_b64_tr_b16 a[96:97], v7 offset:32768
v_mfma_f32_16x16x32_bf16 v[152:155], a[104:107], a[32:35], v[152:155]
ds_read_b64_tr_b16 a[98:99], v7 offset:33792
v_mfma_f32_16x16x32_bf16 v[152:155], a[108:111], a[36:39], v[152:155]
ds_read_b64_tr_b16 a[100:101], v7 offset:40960
v_add_u32 v20, 0x8000, v20
v_mfma_f32_16x16x32_bf16 v[160:163], a[108:111], a[44:47], v[160:163]
ds_read_b64_tr_b16 a[102:103], v7 offset:41984
v_mfma_f32_16x16x32_bf16 v[160:163], a[104:107], a[40:43], v[160:163]
v_mfma_f32_16x16x32_bf16 v[168:171], a[104:107], a[48:51], v[168:171]
v_mfma_f32_16x16x32_bf16 v[168:171], a[108:111], a[52:55], v[168:171]
v_mfma_f32_16x16x32_bf16 v[176:179], a[108:111], a[60:63], v[176:179]
s_add_u32 m0, s76, 32768
v_mfma_f32_16x16x32_bf16 v[176:179], a[104:107], a[56:59], v[176:179]
s_add_u32 s64, s72, 896
ds_read_b64_tr_b16 a[104:105], v8 offset:32768
v_mfma_f32_16x16x32_bf16 v[180:183], a[112:115], a[56:59], v[180:183]
buffer_load_dwordx4 v12, s[48:51], s64 offen lds
v_mfma_f32_16x16x32_bf16 v[180:183], a[116:119], a[60:63], v[180:183]
s_add_u32 s65, s79, 7168
ds_read_b64_tr_b16 a[106:107], v8 offset:33792
v_add_u32 v4, 0x8000, v4
v_mfma_f32_16x16x32_bf16 v[172:175], a[116:119], a[52:55], v[172:175]
buffer_store_dwordx4 a[184:187], v16, s[44:47], s65 offen sc1
v_mfma_f32_16x16x32_bf16 v[172:175], a[112:115], a[48:51], v[172:175]
s_add_u32 m0, s76, 33792
ds_read_b64_tr_b16 a[108:109], v8 offset:40960
v_mfma_f32_16x16x32_bf16 v[164:167], a[112:115], a[40:43], v[164:167]
s_add_u32 s64, s72, 17280
ds_read_b64_tr_b16 a[110:111], v8 offset:41984
v_mfma_f32_16x16x32_bf16 v[164:167], a[116:119], a[44:47], v[164:167]
buffer_load_dwordx4 v13, s[48:51], s64 offen lds
v_mfma_f32_16x16x32_bf16 v[156:159], a[116:119], a[36:39], v[156:159]
v_mfma_f32_16x16x32_bf16 v[156:159], a[112:115], a[32:35], v[156:159]
ds_read_b64_tr_b16 a[112:113], v9 offset:32768
v_mfma_f32_16x16x32_bf16 v[24:27], a[72:75], a[32:35], v[24:27]
s_add_u32 m0, s76, 34816
ds_read_b64_tr_b16 a[114:115], v9 offset:33792
v_mfma_f32_16x16x32_bf16 v[24:27], a[76:79], a[36:39], v[24:27]
s_add_u32 s64, s72, 131968
ds_read_b64_tr_b16 a[116:117], v9 offset:40960
v_add_u32 v5, 0x8000, v5
v_mfma_f32_16x16x32_bf16 v[40:43], a[76:79], a[44:47], v[40:43]
buffer_load_dwordx4 v12, s[48:51], s64 offen lds
v_mfma_f32_16x16x32_bf16 v[40:43], a[72:75], a[40:43], v[40:43]
ds_read_b64_tr_b16 a[118:119], v9 offset:41984
v_mfma_f32_16x16x32_bf16 v[56:59], a[72:75], a[48:51], v[56:59]
v_mfma_f32_16x16x32_bf16 v[56:59], a[76:79], a[52:55], v[56:59]
s_add_u32 m0, s76, 35840
v_mfma_f32_16x16x32_bf16 v[72:75], a[76:79], a[60:63], v[72:75]
s_waitcnt vmcnt(12)
s_add_u32 s64, s72, 148352
ds_read_b128 a[0:3], v2 offset:0
v_mfma_f32_16x16x32_bf16 v[72:75], a[72:75], a[56:59], v[72:75]
buffer_load_dwordx4 v13, s[48:51], s64 offen lds
v_mfma_f32_16x16x32_bf16 v[136:139], a[80:83], a[56:59], v[136:139]
ds_read_b128 a[4:7], v3 offset:0
v_mfma_f32_16x16x32_bf16 v[136:139], a[84:87], a[60:63], v[136:139]
ds_read_b128 a[8:11], v2 offset:2048
v_add_u32 v6, 0x8000, v6
v_mfma_f32_16x16x32_bf16 v[120:123], a[84:87], a[52:55], v[120:123]
s_add_u32 m0, s76, 36864
ds_read_b128 a[12:15], v3 offset:2048
v_mfma_f32_16x16x32_bf16 v[120:123], a[80:83], a[48:51], v[120:123]
s_add_u32 s64, s73, 896
ds_read_b128 a[16:19], v2 offset:4096
v_mfma_f32_16x16x32_bf16 v[104:107], a[80:83], a[40:43], v[104:107]
buffer_load_dwordx4 v12, s[48:51], s64 offen lds
v_mfma_f32_16x16x32_bf16 v[104:107], a[84:87], a[44:47], v[104:107]
ds_read_b128 a[20:23], v3 offset:4096
v_mfma_f32_16x16x32_bf16 v[88:91], a[84:87], a[36:39], v[88:91]
ds_read_b128 a[24:27], v2 offset:6144
v_mfma_f32_16x16x32_bf16 v[88:91], a[80:83], a[32:35], v[88:91]
s_waitcnt lgkmcnt(7)
s_add_u32 m0, s76, 37888
ds_read_b128 a[28:31], v3 offset:6144
v_mfma_f32_16x16x32_bf16 v[28:31], a[88:91], a[32:35], v[28:31]
s_add_u32 s64, s73, 17280
ds_read_b64_tr_b16 a[72:73], v10 offset:32768
v_mfma_f32_16x16x32_bf16 v[28:31], a[92:95], a[36:39], v[28:31]
buffer_load_dwordx4 v13, s[48:51], s64 offen lds
v_mfma_f32_16x16x32_bf16 v[44:47], a[92:95], a[44:47], v[44:47]
ds_read_b64_tr_b16 a[74:75], v10 offset:33792
v_add_u32 v7, 0x8000, v7
v_mfma_f32_16x16x32_bf16 v[44:47], a[88:91], a[40:43], v[44:47]
ds_read_b64_tr_b16 a[76:77], v10 offset:40960
v_mfma_f32_16x16x32_bf16 v[60:63], a[88:91], a[48:51], v[60:63]
s_add_u32 m0, s76, 38912
ds_read_b64_tr_b16 a[78:79], v10 offset:41984
v_mfma_f32_16x16x32_bf16 v[60:63], a[92:95], a[52:55], v[60:63]
s_add_u32 s64, s73, 131968
ds_read_b64_tr_b16 a[80:81], v11 offset:32768
v_mfma_f32_16x16x32_bf16 v[76:79], a[92:95], a[60:63], v[76:79]
buffer_load_dwordx4 v12, s[48:51], s64 offen lds
v_mfma_f32_16x16x32_bf16 v[76:79], a[88:91], a[56:59], v[76:79]
ds_read_b64_tr_b16 a[82:83], v11 offset:33792
v_mfma_f32_16x16x32_bf16 v[140:143], a[96:99], a[56:59], v[140:143]
ds_read_b64_tr_b16 a[84:85], v11 offset:40960
v_mfma_f32_16x16x32_bf16 v[140:143], a[100:103], a[60:63], v[140:143]
s_add_u32 m0, s76, 39936
ds_read_b64_tr_b16 a[86:87], v11 offset:41984
v_add_u32 v8, 0x8000, v8
v_mfma_f32_16x16x32_bf16 v[124:127], a[100:103], a[52:55], v[124:127]
s_add_u32 s64, s73, 148352
v_mfma_f32_16x16x32_bf16 v[124:127], a[96:99], a[48:51], v[124:127]
buffer_load_dwordx4 v13, s[48:51], s64 offen lds
v_mfma_f32_16x16x32_bf16 v[108:111], a[96:99], a[40:43], v[108:111]
v_mfma_f32_16x16x32_bf16 v[108:111], a[100:103], a[44:47], v[108:111]
v_mfma_f32_16x16x32_bf16 v[92:95], a[100:103], a[36:39], v[92:95]
v_add_u32 v9, 0x8000, v9
v_add_u32 v10, 0x8000, v10
v_mfma_f32_16x16x32_bf16 v[92:95], a[96:99], a[32:35], v[92:95]
v_add_u32 v11, 0x8000, v11
v_mfma_f32_16x16x32_bf16 v[32:35], a[104:107], a[32:35], v[32:35]
v_mfma_f32_16x16x32_bf16 v[32:35], a[108:111], a[36:39], v[32:35]
v_mfma_f32_16x16x32_bf16 v[48:51], a[108:111], a[44:47], v[48:51]
s_waitcnt lgkmcnt(0)
s_barrier
v_mfma_f32_16x16x32_bf16 v[48:51], a[104:107], a[40:43], v[48:51]
s_add_u32 m0, s77, 98304
ds_read_b64_tr_b16 a[88:89], v19 offset:36864
v_mfma_f32_16x16x32_bf16 v[64:67], a[104:107], a[48:51], v[64:67]
s_add_u32 s64, s71, 4194304
ds_read_b64_tr_b16 a[90:91], v19 offset:37120
v_mfma_f32_16x16x32_bf16 v[64:67], a[108:111], a[52:55], v[64:67]
buffer_load_dwordx4 v14, s[56:59], s64 offen lds
v_mfma_f32_16x16x32_bf16 v[80:83], a[108:111], a[60:63], v[80:83]
ds_read_b64_tr_b16 a[92:93], v19 offset:38912
v_mfma_f32_16x16x32_bf16 v[80:83], a[104:107], a[56:59], v[80:83]
ds_read_b64_tr_b16 a[94:95], v19 offset:39168
v_mfma_f32_16x16x32_bf16 v[144:147], a[112:115], a[56:59], v[144:147]
ds_read_b64_tr_b16 a[96:97], v20 offset:36864
v_mfma_f32_16x16x32_bf16 v[144:147], a[116:119], a[60:63], v[144:147]
ds_read_b64_tr_b16 a[98:99], v20 offset:37120
v_mfma_f32_16x16x32_bf16 v[128:131], a[116:119], a[52:55], v[128:131]
s_add_u32 s65, s79, 3072
ds_read_b64_tr_b16 a[100:101], v20 offset:38912
v_mfma_f32_16x16x32_bf16 v[128:131], a[112:115], a[48:51], v[128:131]
buffer_store_dwordx4 a[188:191], v16, s[44:47], s65 offen sc1
v_mfma_f32_16x16x32_bf16 v[112:115], a[112:115], a[40:43], v[112:115]
s_add_u32 m0, s78, 114688
ds_read_b64_tr_b16 a[102:103], v20 offset:39168
v_mfma_f32_16x16x32_bf16 v[112:115], a[116:119], a[44:47], v[112:115]
s_add_u32 s64, s75, 3145728
ds_read_b64_tr_b16 a[104:105], v19 offset:40960
v_mfma_f32_16x16x32_bf16 v[96:99], a[116:119], a[36:39], v[96:99]
buffer_load_dwordx4 v23, s[60:63], s64 offen lds
v_mfma_f32_16x16x32_bf16 v[96:99], a[112:115], a[32:35], v[96:99]
ds_read_b64_tr_b16 a[106:107], v19 offset:41216
v_mfma_f32_16x16x32_bf16 v[36:39], a[72:75], a[32:35], v[36:39]
ds_read_b64_tr_b16 a[108:109], v19 offset:43008
v_mfma_f32_16x16x32_bf16 v[36:39], a[76:79], a[36:39], v[36:39]
ds_read_b64_tr_b16 a[110:111], v19 offset:43264
v_mfma_f32_16x16x32_bf16 v[52:55], a[76:79], a[44:47], v[52:55]
ds_read_b64_tr_b16 a[112:113], v20 offset:40960
v_mfma_f32_16x16x32_bf16 v[52:55], a[72:75], a[40:43], v[52:55]
ds_read_b64_tr_b16 a[114:115], v20 offset:41216
v_mfma_f32_16x16x32_bf16 v[68:71], a[72:75], a[48:51], v[68:71]
ds_read_b64_tr_b16 a[116:117], v20 offset:43008
v_mfma_f32_16x16x32_bf16 v[68:71], a[76:79], a[52:55], v[68:71]
s_add_u32 m0, s77, 99328
ds_read_b64_tr_b16 a[118:119], v20 offset:43264
v_mfma_f32_16x16x32_bf16 v[84:87], a[76:79], a[60:63], v[84:87]
s_add_u32 s64, s71, 4227072
v_mfma_f32_16x16x32_bf16 v[84:87], a[72:75], a[56:59], v[84:87]
buffer_load_dwordx4 v14, s[56:59], s64 offen lds
v_mfma_f32_16x16x32_bf16 v[148:151], a[80:83], a[56:59], v[148:151]
ds_read_b64_tr_b16 a[72:73], v19 offset:32768
v_mfma_f32_16x16x32_bf16 v[148:151], a[84:87], a[60:63], v[148:151]
ds_read_b64_tr_b16 a[74:75], v19 offset:33024
v_mfma_f32_16x16x32_bf16 v[132:135], a[84:87], a[52:55], v[132:135]
ds_read_b64_tr_b16 a[76:77], v19 offset:34816
v_mfma_f32_16x16x32_bf16 v[132:135], a[80:83], a[48:51], v[132:135]
ds_read_b64_tr_b16 a[78:79], v19 offset:35072
v_mfma_f32_16x16x32_bf16 v[116:119], a[80:83], a[40:43], v[116:119]
v_mfma_f32_16x16x32_bf16 v[116:119], a[84:87], a[44:47], v[116:119]
v_mfma_f32_16x16x32_bf16 v[100:103], a[84:87], a[36:39], v[100:103]
s_add_u32 m0, s78, 118784
v_mfma_f32_16x16x32_bf16 v[100:103], a[80:83], a[32:35], v[100:103]
s_waitcnt lgkmcnt(4)
s_add_u32 s64, s75, 3147776
ds_read_b64_tr_b16 a[80:81], v20 offset:32768
v_mfma_f32_16x16x32_bf16 v[184:187], a[88:91], a[0:3], v[184:187]
buffer_load_dwordx4 v23, s[60:63], s64 offen lds
v_mfma_f32_16x16x32_bf16 v[184:187], a[92:95], a[4:7], v[184:187]
ds_read_b64_tr_b16 a[82:83], v20 offset:33024
v_mfma_f32_16x16x32_bf16 v[192:195], a[92:95], a[12:15], v[192:195]
ds_read_b64_tr_b16 a[84:85], v20 offset:34816
v_mfma_f32_16x16x32_bf16 v[192:195], a[88:91], a[8:11], v[192:195]
s_add_u32 s17, s78, .-L_pc+6144
ds_read_b64_tr_b16 a[86:87], v20 offset:35072
v_mfma_f32_16x16x32_bf16 v[200:203], a[88:91], a[16:19], v[200:203]
buffer_load_dword a252, v16, s[88:91], s17 offen
v_mfma_f32_16x16x32_bf16 v[200:203], a[92:95], a[20:23], v[200:203]
v_mfma_f32_16x16x32_bf16 v[208:211], a[92:95], a[28:31], v[208:211]
v_mfma_f32_16x16x32_bf16 v[208:211], a[88:91], a[24:27], v[208:211]
ds_read_b64_tr_b16 a[88:89], v4 offset:32768
v_mfma_f32_16x16x32_bf16 v[212:215], a[96:99], a[24:27], v[212:215]
s_add_u32 m0, s77, 100352
ds_read_b64_tr_b16 a[90:91], v4 offset:33792
v_mfma_f32_16x16x32_bf16 v[212:215], a[100:103], a[28:31], v[212:215]
s_add_u32 s64, s71, 4259840
ds_read_b64_tr_b16 a[92:93], v4 offset:40960
v_mfma_f32_16x16x32_bf16 v[204:207], a[100:103], a[20:23], v[204:207]
buffer_load_dwordx4 v15, s[56:59], s64 offen lds
v_mfma_f32_16x16x32_bf16 v[204:207], a[96:99], a[16:19], v[204:207]
ds_read_b64_tr_b16 a[94:95], v4 offset:41984
v_mfma_f32_16x16x32_bf16 v[196:199], a[96:99], a[8:11], v[196:199]
v_mfma_f32_16x16x32_bf16 v[196:199], a[100:103], a[12:15], v[196:199]
v_mfma_f32_16x16x32_bf16 v[188:191], a[100:103], a[4:7], v[188:191]
v_mfma_f32_16x16x32_bf16 v[188:191], a[96:99], a[0:3], v[188:191]
ds_read_b64_tr_b16 a[96:97], v5 offset:32768
v_mfma_f32_16x16x32_bf16 v[216:219], a[0:3], a[104:107], v[216:219]
ds_read_b64_tr_b16 a[98:99], v5 offset:33792
v_mfma_f32_16x16x32_bf16 v[216:219], a[4:7], a[108:111], v[216:219]
s_add_u32 m0, s78, 122880
ds_read_b64_tr_b16 a[100:101], v5 offset:40960
v_mfma_f32_16x16x32_bf16 v[224:227], a[12:15], a[108:111], v[224:227]
s_add_u32 s64, s75, 3149824
ds_read_b64_tr_b16 a[102:103], v5 offset:41984
v_mfma_f32_16x16x32_bf16 v[224:227], a[8:11], a[104:107], v[224:227]
buffer_load_dwordx4 v23, s[60:63], s64 offen lds
v_mfma_f32_16x16x32_bf16 v[232:235], a[16:19], a[104:107], v[232:235]
v_mfma_f32_16x16x32_bf16 v[232:235], a[20:23], a[108:111], v[232:235]
v_mfma_f32_16x16x32_bf16 v[240:243], a[28:31], a[108:111], v[240:243]
v_mfma_f32_16x16x32_bf16 v[240:243], a[24:27], a[104:107], v[240:243]
ds_read_b64_tr_b16 a[104:105], v6 offset:32768
v_mfma_f32_16x16x32_bf16 v[244:247], a[24:27], a[112:115], v[244:247]
ds_read_b64_tr_b16 a[106:107], v6 offset:33792
v_mfma_f32_16x16x32_bf16 v[244:247], a[28:31], a[116:119], v[244:247]
ds_read_b64_tr_b16 a[108:109], v6 offset:40960
v_subrev_u32 v19, 0x8000, v19
v_mfma_f32_16x16x32_bf16 v[236:239], a[20:23], a[116:119], v[236:239]
s_add_u32 m0, s77, 101376
ds_read_b64_tr_b16 a[110:111], v6 offset:41984
v_mfma_f32_16x16x32_bf16 v[236:239], a[16:19], a[112:115], v[236:239]
s_add_u32 s64, s71, 4292608
v_mfma_f32_16x16x32_bf16 v[228:231], a[8:11], a[112:115], v[228:231]
s_add_u32 s65, s79, 24576
buffer_load_dwordx4 v15, s[56:59], s64 offen lds
v_mfma_f32_16x16x32_bf16 v[228:231], a[12:15], a[116:119], v[228:231]
buffer_store_dwordx4 a[192:195], v16, s[44:47], s65 offen sc1
v_mfma_f32_16x16x32_bf16 v[220:223], a[4:7], a[116:119], v[220:223]
v_mfma_f32_16x16x32_bf16 v[220:223], a[0:3], a[112:115], v[220:223]
s_waitcnt lgkmcnt(4)
ds_read_b64_tr_b16 a[112:113], v7 offset:32768
v_mfma_f32_16x16x32_bf16 v[152:155], a[72:75], a[0:3], v[152:155]
ds_read_b64_tr_b16 a[114:115], v7 offset:33792
v_mfma_f32_16x16x32_bf16 v[152:155], a[76:79], a[4:7], v[152:155]
ds_read_b64_tr_b16 a[116:117], v7 offset:40960
v_subrev_u32 v20, 0x8000, v20
v_mfma_f32_16x16x32_bf16 v[160:163], a[76:79], a[12:15], v[160:163]
ds_read_b64_tr_b16 a[118:119], v7 offset:41984
v_mfma_f32_16x16x32_bf16 v[160:163], a[72:75], a[8:11], v[160:163]
v_mfma_f32_16x16x32_bf16 v[168:171], a[72:75], a[16:19], v[168:171]
v_mfma_f32_16x16x32_bf16 v[168:171], a[76:79], a[20:23], v[168:171]
v_mfma_f32_16x16x32_bf16 v[176:179], a[76:79], a[28:31], v[176:179]
s_add_u32 m0, s76, 0
v_mfma_f32_16x16x32_bf16 v[176:179], a[72:75], a[24:27], v[176:179]
s_add_u32 s64, s72, 1024
ds_read_b64_tr_b16 a[72:73], v8 offset:32768
v_mfma_f32_16x16x32_bf16 v[180:183], a[80:83], a[24:27], v[180:183]
buffer_load_dwordx4 v12, s[48:51], s64 offen lds
v_mfma_f32_16x16x32_bf16 v[180:183], a[84:87], a[28:31], v[180:183]
ds_read_b64_tr_b16 a[74:75], v8 offset:33792
v_subrev_u32 v4, 0x8000, v4
v_mfma_f32_16x16x32_bf16 v[172:175], a[84:87], a[20:23], v[172:175]
ds_read_b64_tr_b16 a[76:77], v8 offset:40960
v_mfma_f32_16x16x32_bf16 v[172:175], a[80:83], a[16:19], v[172:175]
s_add_u32 m0, s76, 1024
ds_read_b64_tr_b16 a[78:79], v8 offset:41984
v_mfma_f32_16x16x32_bf16 v[164:167], a[80:83], a[8:11], v[164:167]
s_add_u32 s64, s72, 17408
v_mfma_f32_16x16x32_bf16 v[164:167], a[84:87], a[12:15], v[164:167]
buffer_load_dwordx4 v13, s[48:51], s64 offen lds
v_mfma_f32_16x16x32_bf16 v[156:159], a[84:87], a[4:7], v[156:159]
v_mfma_f32_16x16x32_bf16 v[156:159], a[80:83], a[0:3], v[156:159]
ds_read_b64_tr_b16 a[80:81], v9 offset:32768
v_mfma_f32_16x16x32_bf16 v[24:27], a[88:91], a[0:3], v[24:27]
s_add_u32 m0, s76, 2048
ds_read_b64_tr_b16 a[82:83], v9 offset:33792
v_mfma_f32_16x16x32_bf16 v[24:27], a[92:95], a[4:7], v[24:27]
s_add_u32 s64, s72, 132096
ds_read_b64_tr_b16 a[84:85], v9 offset:40960
v_subrev_u32 v5, 0x8000, v5
v_mfma_f32_16x16x32_bf16 v[40:43], a[92:95], a[12:15], v[40:43]
buffer_load_dwordx4 v12, s[48:51], s64 offen lds
v_mfma_f32_16x16x32_bf16 v[40:43], a[88:91], a[8:11], v[40:43]
ds_read_b64_tr_b16 a[86:87], v9 offset:41984
v_mfma_f32_16x16x32_bf16 v[56:59], a[88:91], a[16:19], v[56:59]
v_mfma_f32_16x16x32_bf16 v[56:59], a[92:95], a[20:23], v[56:59]
s_add_u32 m0, s76, 3072
v_mfma_f32_16x16x32_bf16 v[72:75], a[92:95], a[28:31], v[72:75]
s_waitcnt vmcnt(13)
s_add_u32 s64, s72, 148480
ds_read_b128 a[32:35], v2 offset:32768
v_mfma_f32_16x16x32_bf16 v[72:75], a[88:91], a[24:27], v[72:75]
buffer_load_dwordx4 v13, s[48:51], s64 offen lds
v_mfma_f32_16x16x32_bf16 v[136:139], a[96:99], a[24:27], v[136:139]
ds_read_b128 a[36:39], v3 offset:32768
v_mfma_f32_16x16x32_bf16 v[136:139], a[100:103], a[28:31], v[136:139]
ds_read_b128 a[40:43], v2 offset:34816
v_subrev_u32 v6, 0x8000, v6
v_mfma_f32_16x16x32_bf16 v[120:123], a[100:103], a[20:23], v[120:123]
s_add_u32 m0, s76, 4096
ds_read_b128 a[44:47], v3 offset:34816
v_mfma_f32_16x16x32_bf16 v[120:123], a[96:99], a[16:19], v[120:123]
s_add_u32 s64, s73, 1024
ds_read_b128 a[48:51], v2 offset:36864
v_mfma_f32_16x16x32_bf16 v[104:107], a[96:99], a[8:11], v[104:107]
buffer_load_dwordx4 v12, s[48:51], s64 offen lds
v_mfma_f32_16x16x32_bf16 v[104:107], a[100:103], a[12:15], v[104:107]
ds_read_b128 a[52:55], v3 offset:36864
v_mfma_f32_16x16x32_bf16 v[88:91], a[100:103], a[4:7], v[88:91]
ds_read_b128 a[56:59], v2 offset:38912
v_mfma_f32_16x16x32_bf16 v[88:91], a[96:99], a[0:3], v[88:91]
s_waitcnt lgkmcnt(7)
s_add_u32 m0, s76, 5120
ds_read_b128 a[60:63], v3 offset:38912
v_mfma_f32_16x16x32_bf16 v[28:31], a[104:107], a[0:3], v[28:31]
s_add_u32 s64, s73, 17408
ds_read_b64_tr_b16 a[88:89], v10 offset:32768
v_mfma_f32_16x16x32_bf16 v[28:31], a[108:111], a[4:7], v[28:31]
buffer_load_dwordx4 v13, s[48:51], s64 offen lds
v_mfma_f32_16x16x32_bf16 v[44:47], a[108:111], a[12:15], v[44:47]
ds_read_b64_tr_b16 a[90:91], v10 offset:33792
v_subrev_u32 v7, 0x8000, v7
v_mfma_f32_16x16x32_bf16 v[44:47], a[104:107], a[8:11], v[44:47]
ds_read_b64_tr_b16 a[92:93], v10 offset:40960
v_mfma_f32_16x16x32_bf16 v[60:63], a[104:107], a[16:19], v[60:63]
s_add_u32 m0, s76, 6144
ds_read_b64_tr_b16 a[94:95], v10 offset:41984
v_mfma_f32_16x16x32_bf16 v[60:63], a[108:111], a[20:23], v[60:63]
s_add_u32 s64, s73, 132096
ds_read_b64_tr_b16 a[96:97], v11 offset:32768
v_mfma_f32_16x16x32_bf16 v[76:79], a[108:111], a[28:31], v[76:79]
buffer_load_dwordx4 v12, s[48:51], s64 offen lds
v_mfma_f32_16x16x32_bf16 v[76:79], a[104:107], a[24:27], v[76:79]
ds_read_b64_tr_b16 a[98:99], v11 offset:33792
v_mfma_f32_16x16x32_bf16 v[140:143], a[112:115], a[24:27], v[140:143]
ds_read_b64_tr_b16 a[100:101], v11 offset:40960
v_mfma_f32_16x16x32_bf16 v[140:143], a[116:119], a[28:31], v[140:143]
s_add_u32 m0, s76, 7168
ds_read_b64_tr_b16 a[102:103], v11 offset:41984
v_subrev_u32 v8, 0x8000, v8
v_mfma_f32_16x16x32_bf16 v[124:127], a[116:119], a[20:23], v[124:127]
s_add_u32 s64, s73, 148480
v_mfma_f32_16x16x32_bf16 v[124:127], a[112:115], a[16:19], v[124:127]
buffer_load_dwordx4 v13, s[48:51], s64 offen lds
v_mfma_f32_16x16x32_bf16 v[108:111], a[112:115], a[8:11], v[108:111]
v_mfma_f32_16x16x32_bf16 v[108:111], a[116:119], a[12:15], v[108:111]
v_mfma_f32_16x16x32_bf16 v[92:95], a[116:119], a[4:7], v[92:95]
v_subrev_u32 v9, 0x8000, v9
v_subrev_u32 v10, 0x8000, v10
v_mfma_f32_16x16x32_bf16 v[92:95], a[112:115], a[0:3], v[92:95]
s_add_u32 s65, s79, 25600
v_subrev_u32 v11, 0x8000, v11
v_mfma_f32_16x16x32_bf16 v[32:35], a[72:75], a[0:3], v[32:35]
buffer_store_dwordx4 a[196:199], v16, s[44:47], s65 offen sc1
v_mfma_f32_16x16x32_bf16 v[32:35], a[76:79], a[4:7], v[32:35]
v_mfma_f32_16x16x32_bf16 v[48:51], a[76:79], a[12:15], v[48:51]
s_waitcnt lgkmcnt(0)
s_barrier
v_mfma_f32_16x16x32_bf16 v[48:51], a[72:75], a[8:11], v[48:51]
s_add_u32 m0, s77, 131072
ds_read_b64_tr_b16 a[104:105], v19 offset:4096
v_mfma_f32_16x16x32_bf16 v[64:67], a[72:75], a[16:19], v[64:67]
s_add_u32 s64, s71, 4718592
ds_read_b64_tr_b16 a[106:107], v19 offset:4352
v_mfma_f32_16x16x32_bf16 v[64:67], a[76:79], a[20:23], v[64:67]
buffer_load_dwordx4 v14, s[56:59], s64 offen lds
v_mfma_f32_16x16x32_bf16 v[80:83], a[76:79], a[28:31], v[80:83]
ds_read_b64_tr_b16 a[108:109], v19 offset:6144
v_mfma_f32_16x16x32_bf16 v[80:83], a[72:75], a[24:27], v[80:83]
ds_read_b64_tr_b16 a[110:111], v19 offset:6400
v_mfma_f32_16x16x32_bf16 v[144:147], a[80:83], a[24:27], v[144:147]
ds_read_b64_tr_b16 a[112:113], v20 offset:4096
v_mfma_f32_16x16x32_bf16 v[144:147], a[84:87], a[28:31], v[144:147]
ds_read_b64_tr_b16 a[114:115], v20 offset:4352
v_mfma_f32_16x16x32_bf16 v[128:131], a[84:87], a[20:23], v[128:131]
ds_read_b64_tr_b16 a[116:117], v20 offset:6144
v_mfma_f32_16x16x32_bf16 v[128:131], a[80:83], a[16:19], v[128:131]
ds_read_b64_tr_b16 a[118:119], v20 offset:6400
v_mfma_f32_16x16x32_bf16 v[112:115], a[80:83], a[8:11], v[112:115]
s_add_u32 m0, s78, 147456
ds_read_b64_tr_b16 a[72:73], v19 offset:8192
v_mfma_f32_16x16x32_bf16 v[112:115], a[84:87], a[12:15], v[112:115]
s_add_u32 s64, s75, 3538944
ds_read_b64_tr_b16 a[74:75], v19 offset:8448
v_mfma_f32_16x16x32_bf16 v[96:99], a[84:87], a[4:7], v[96:99]
buffer_load_dwordx4 v23, s[60:63], s64 offen lds
v_mfma_f32_16x16x32_bf16 v[96:99], a[80:83], a[0:3], v[96:99]
ds_read_b64_tr_b16 a[76:77], v19 offset:10240
v_mfma_f32_16x16x32_bf16 v[36:39], a[88:91], a[0:3], v[36:39]
ds_read_b64_tr_b16 a[78:79], v19 offset:10496
v_mfma_f32_16x16x32_bf16 v[36:39], a[92:95], a[4:7], v[36:39]
ds_read_b64_tr_b16 a[80:81], v20 offset:8192
v_mfma_f32_16x16x32_bf16 v[52:55], a[92:95], a[12:15], v[52:55]
ds_read_b64_tr_b16 a[82:83], v20 offset:8448
v_mfma_f32_16x16x32_bf16 v[52:55], a[88:91], a[8:11], v[52:55]
ds_read_b64_tr_b16 a[84:85], v20 offset:10240
v_mfma_f32_16x16x32_bf16 v[68:71], a[88:91], a[16:19], v[68:71]
ds_read_b64_tr_b16 a[86:87], v20 offset:10496
v_mfma_f32_16x16x32_bf16 v[68:71], a[92:95], a[20:23], v[68:71]
s_add_u32 m0, s77, 132096
v_mfma_f32_16x16x32_bf16 v[84:87], a[92:95], a[28:31], v[84:87]
s_add_u32 s64, s71, 4751360
v_mfma_f32_16x16x32_bf16 v[84:87], a[88:91], a[24:27], v[84:87]
buffer_load_dwordx4 v14, s[56:59], s64 offen lds
v_mfma_f32_16x16x32_bf16 v[148:151], a[96:99], a[24:27], v[148:151]
ds_read_b64_tr_b16 a[88:89], v19 offset:0
v_mfma_f32_16x16x32_bf16 v[148:151], a[100:103], a[28:31], v[148:151]
ds_read_b64_tr_b16 a[90:91], v19 offset:256
v_mfma_f32_16x16x32_bf16 v[132:135], a[100:103], a[20:23], v[132:135]
ds_read_b64_tr_b16 a[92:93], v19 offset:2048
v_mfma_f32_16x16x32_bf16 v[132:135], a[96:99], a[16:19], v[132:135]
ds_read_b64_tr_b16 a[94:95], v19 offset:2304
v_mfma_f32_16x16x32_bf16 v[116:119], a[96:99], a[8:11], v[116:119]
v_mfma_f32_16x16x32_bf16 v[116:119], a[100:103], a[12:15], v[116:119]
v_mfma_f32_16x16x32_bf16 v[100:103], a[100:103], a[4:7], v[100:103]
s_add_u32 m0, s78, 151552
v_mfma_f32_16x16x32_bf16 v[100:103], a[96:99], a[0:3], v[100:103]
s_waitcnt lgkmcnt(4)
s_add_u32 s64, s75, 3540992
ds_read_b64_tr_b16 a[96:97], v20 offset:0
v_mfma_f32_16x16x32_bf16 v[184:187], a[104:107], a[32:35], v[184:187]
buffer_load_dwordx4 v23, s[60:63], s64 offen lds
v_mfma_f32_16x16x32_bf16 v[184:187], a[108:111], a[36:39], v[184:187]
ds_read_b64_tr_b16 a[98:99], v20 offset:256
v_mfma_f32_16x16x32_bf16 v[192:195], a[108:111], a[44:47], v[192:195]
ds_read_b64_tr_b16 a[100:101], v20 offset:2048
v_mfma_f32_16x16x32_bf16 v[192:195], a[104:107], a[40:43], v[192:195]
ds_read_b64_tr_b16 a[102:103], v20 offset:2304
v_mfma_f32_16x16x32_bf16 v[200:203], a[104:107], a[48:51], v[200:203]
v_mfma_f32_16x16x32_bf16 v[200:203], a[108:111], a[52:55], v[200:203]
v_mfma_f32_16x16x32_bf16 v[208:211], a[108:111], a[60:63], v[208:211]
v_mfma_f32_16x16x32_bf16 v[208:211], a[104:107], a[56:59], v[208:211]
ds_read_b64_tr_b16 a[104:105], v4 offset:0
v_mfma_f32_16x16x32_bf16 v[212:215], a[112:115], a[56:59], v[212:215]
s_add_u32 m0, s77, 133120
ds_read_b64_tr_b16 a[106:107], v4 offset:1024
v_mfma_f32_16x16x32_bf16 v[212:215], a[116:119], a[60:63], v[212:215]
s_add_u32 s64, s71, 4784128
ds_read_b64_tr_b16 a[108:109], v4 offset:8192
v_mfma_f32_16x16x32_bf16 v[204:207], a[116:119], a[52:55], v[204:207]
buffer_load_dwordx4 v15, s[56:59], s64 offen lds
v_mfma_f32_16x16x32_bf16 v[204:207], a[112:115], a[48:51], v[204:207]
ds_read_b64_tr_b16 a[110:111], v4 offset:9216
v_mfma_f32_16x16x32_bf16 v[196:199], a[112:115], a[40:43], v[196:199]
v_mfma_f32_16x16x32_bf16 v[196:199], a[116:119], a[44:47], v[196:199]
v_mfma_f32_16x16x32_bf16 v[188:191], a[116:119], a[36:39], v[188:191]
s_add_u32 s65, s79, 9216
v_mfma_f32_16x16x32_bf16 v[188:191], a[112:115], a[32:35], v[188:191]
buffer_store_dwordx4 a[200:203], v16, s[44:47], s65 offen sc1
v_mfma_f32_16x16x32_bf16 v[216:219], a[32:35], a[72:75], v[216:219]
ds_read_b64_tr_b16 a[112:113], v5 offset:0
v_mfma_f32_16x16x32_bf16 v[216:219], a[36:39], a[76:79], v[216:219]
s_add_u32 m0, s78, 155648
ds_read_b64_tr_b16 a[114:115], v5 offset:1024
v_mfma_f32_16x16x32_bf16 v[224:227], a[44:47], a[76:79], v[224:227]
s_add_u32 s64, s75, 3543040
ds_read_b64_tr_b16 a[116:117], v5 offset:8192
v_mfma_f32_16x16x32_bf16 v[224:227], a[40:43], a[72:75], v[224:227]
buffer_load_dwordx4 v23, s[60:63], s64 offen lds
v_mfma_f32_16x16x32_bf16 v[232:235], a[48:51], a[72:75], v[232:235]
ds_read_b64_tr_b16 a[118:119], v5 offset:9216
v_mfma_f32_16x16x32_bf16 v[232:235], a[52:55], a[76:79], v[232:235]
v_mfma_f32_16x16x32_bf16 v[240:243], a[60:63], a[76:79], v[240:243]
v_mfma_f32_16x16x32_bf16 v[240:243], a[56:59], a[72:75], v[240:243]
ds_read_b64_tr_b16 a[72:73], v6 offset:0
v_mfma_f32_16x16x32_bf16 v[244:247], a[56:59], a[80:83], v[244:247]
ds_read_b64_tr_b16 a[74:75], v6 offset:1024
v_mfma_f32_16x16x32_bf16 v[244:247], a[60:63], a[84:87], v[244:247]
ds_read_b64_tr_b16 a[76:77], v6 offset:8192
v_mfma_f32_16x16x32_bf16 v[236:239], a[52:55], a[84:87], v[236:239]
s_add_u32 m0, s77, 134144
ds_read_b64_tr_b16 a[78:79], v6 offset:9216
v_mfma_f32_16x16x32_bf16 v[236:239], a[48:51], a[80:83], v[236:239]
s_add_u32 s64, s71, 4816896
v_mfma_f32_16x16x32_bf16 v[228:231], a[40:43], a[80:83], v[228:231]
buffer_load_dwordx4 v15, s[56:59], s64 offen lds
v_mfma_f32_16x16x32_bf16 v[228:231], a[44:47], a[84:87], v[228:231]
v_mfma_f32_16x16x32_bf16 v[220:223], a[36:39], a[84:87], v[220:223]
v_mfma_f32_16x16x32_bf16 v[220:223], a[32:35], a[80:83], v[220:223]
s_waitcnt lgkmcnt(4)
ds_read_b64_tr_b16 a[80:81], v7 offset:0
v_mfma_f32_16x16x32_bf16 v[152:155], a[88:91], a[32:35], v[152:155]
ds_read_b64_tr_b16 a[82:83], v7 offset:1024
v_mfma_f32_16x16x32_bf16 v[152:155], a[92:95], a[36:39], v[152:155]
ds_read_b64_tr_b16 a[84:85], v7 offset:8192
v_mfma_f32_16x16x32_bf16 v[160:163], a[92:95], a[44:47], v[160:163]
ds_read_b64_tr_b16 a[86:87], v7 offset:9216
v_mfma_f32_16x16x32_bf16 v[160:163], a[88:91], a[40:43], v[160:163]
v_mfma_f32_16x16x32_bf16 v[168:171], a[88:91], a[48:51], v[168:171]
v_mfma_f32_16x16x32_bf16 v[168:171], a[92:95], a[52:55], v[168:171]
v_mfma_f32_16x16x32_bf16 v[176:179], a[92:95], a[60:63], v[176:179]
s_add_u32 m0, s76, 32768
v_mfma_f32_16x16x32_bf16 v[176:179], a[88:91], a[56:59], v[176:179]
s_add_u32 s64, s72, 1152
ds_read_b64_tr_b16 a[88:89], v8 offset:0
v_mfma_f32_16x16x32_bf16 v[180:183], a[96:99], a[56:59], v[180:183]
buffer_load_dwordx4 v12, s[48:51], s64 offen lds
v_mfma_f32_16x16x32_bf16 v[180:183], a[100:103], a[60:63], v[180:183]
ds_read_b64_tr_b16 a[90:91], v8 offset:1024
v_mfma_f32_16x16x32_bf16 v[172:175], a[100:103], a[52:55], v[172:175]
ds_read_b64_tr_b16 a[92:93], v8 offset:8192
v_mfma_f32_16x16x32_bf16 v[172:175], a[96:99], a[48:51], v[172:175]
s_add_u32 m0, s76, 33792
ds_read_b64_tr_b16 a[94:95], v8 offset:9216
v_mfma_f32_16x16x32_bf16 v[164:167], a[96:99], a[40:43], v[164:167]
s_add_u32 s64, s72, 17536
v_mfma_f32_16x16x32_bf16 v[164:167], a[100:103], a[44:47], v[164:167]
buffer_load_dwordx4 v13, s[48:51], s64 offen lds
v_mfma_f32_16x16x32_bf16 v[156:159], a[100:103], a[36:39], v[156:159]
v_mfma_f32_16x16x32_bf16 v[156:159], a[96:99], a[32:35], v[156:159]
ds_read_b64_tr_b16 a[96:97], v9 offset:0
v_mfma_f32_16x16x32_bf16 v[24:27], a[104:107], a[32:35], v[24:27]
s_add_u32 m0, s76, 34816
ds_read_b64_tr_b16 a[98:99], v9 offset:1024
v_mfma_f32_16x16x32_bf16 v[24:27], a[108:111], a[36:39], v[24:27]
s_add_u32 s64, s72, 132224
ds_read_b64_tr_b16 a[100:101], v9 offset:8192
v_mfma_f32_16x16x32_bf16 v[40:43], a[108:111], a[44:47], v[40:43]
buffer_load_dwordx4 v12, s[48:51], s64 offen lds
v_mfma_f32_16x16x32_bf16 v[40:43], a[104:107], a[40:43], v[40:43]
ds_read_b64_tr_b16 a[102:103], v9 offset:9216
v_mfma_f32_16x16x32_bf16 v[56:59], a[104:107], a[48:51], v[56:59]
v_mfma_f32_16x16x32_bf16 v[56:59], a[108:111], a[52:55], v[56:59]
s_add_u32 m0, s76, 35840
v_mfma_f32_16x16x32_bf16 v[72:75], a[108:111], a[60:63], v[72:75]
s_waitcnt vmcnt(12)
s_add_u32 s64, s72, 148608
ds_read_b128 a[0:3], v2 offset:0
v_mfma_f32_16x16x32_bf16 v[72:75], a[104:107], a[56:59], v[72:75]
buffer_load_dwordx4 v13, s[48:51], s64 offen lds
v_mfma_f32_16x16x32_bf16 v[136:139], a[112:115], a[56:59], v[136:139]
ds_read_b128 a[4:7], v3 offset:0
v_mfma_f32_16x16x32_bf16 v[136:139], a[116:119], a[60:63], v[136:139]
ds_read_b128 a[8:11], v2 offset:2048
v_mfma_f32_16x16x32_bf16 v[120:123], a[116:119], a[52:55], v[120:123]
s_add_u32 m0, s76, 36864
ds_read_b128 a[12:15], v3 offset:2048
v_mfma_f32_16x16x32_bf16 v[120:123], a[112:115], a[48:51], v[120:123]
s_add_u32 s64, s73, 1152
ds_read_b128 a[16:19], v2 offset:4096
v_mfma_f32_16x16x32_bf16 v[104:107], a[112:115], a[40:43], v[104:107]
buffer_load_dwordx4 v12, s[48:51], s64 offen lds
v_mfma_f32_16x16x32_bf16 v[104:107], a[116:119], a[44:47], v[104:107]
ds_read_b128 a[20:23], v3 offset:4096
v_mfma_f32_16x16x32_bf16 v[88:91], a[116:119], a[36:39], v[88:91]
ds_read_b128 a[24:27], v2 offset:6144
v_mfma_f32_16x16x32_bf16 v[88:91], a[112:115], a[32:35], v[88:91]
s_waitcnt lgkmcnt(7)
s_add_u32 m0, s76, 37888
ds_read_b128 a[28:31], v3 offset:6144
v_mfma_f32_16x16x32_bf16 v[28:31], a[72:75], a[32:35], v[28:31]
s_add_u32 s64, s73, 17536
ds_read_b64_tr_b16 a[104:105], v10 offset:0
v_mfma_f32_16x16x32_bf16 v[28:31], a[76:79], a[36:39], v[28:31]
s_add_u32 s65, s79, 26624
buffer_load_dwordx4 v13, s[48:51], s64 offen lds
v_mfma_f32_16x16x32_bf16 v[44:47], a[76:79], a[44:47], v[44:47]
buffer_store_dwordx4 a[204:207], v16, s[44:47], s65 offen sc1
v_mfma_f32_16x16x32_bf16 v[44:47], a[72:75], a[40:43], v[44:47]
ds_read_b64_tr_b16 a[106:107], v10 offset:1024
v_mfma_f32_16x16x32_bf16 v[60:63], a[72:75], a[48:51], v[60:63]
s_add_u32 m0, s76, 38912
ds_read_b64_tr_b16 a[108:109], v10 offset:8192
v_mfma_f32_16x16x32_bf16 v[60:63], a[76:79], a[52:55], v[60:63]
s_add_u32 s64, s73, 132224
ds_read_b64_tr_b16 a[110:111], v10 offset:9216
v_mfma_f32_16x16x32_bf16 v[76:79], a[76:79], a[60:63], v[76:79]
buffer_load_dwordx4 v12, s[48:51], s64 offen lds
v_mfma_f32_16x16x32_bf16 v[76:79], a[72:75], a[56:59], v[76:79]
ds_read_b64_tr_b16 a[112:113], v11 offset:0
v_mfma_f32_16x16x32_bf16 v[140:143], a[80:83], a[56:59], v[140:143]
ds_read_b64_tr_b16 a[114:115], v11 offset:1024
v_mfma_f32_16x16x32_bf16 v[140:143], a[84:87], a[60:63], v[140:143]
s_add_u32 m0, s76, 39936
ds_read_b64_tr_b16 a[116:117], v11 offset:8192
v_mfma_f32_16x16x32_bf16 v[124:127], a[84:87], a[52:55], v[124:127]
s_add_u32 s64, s73, 148608
ds_read_b64_tr_b16 a[118:119], v11 offset:9216
v_mfma_f32_16x16x32_bf16 v[124:127], a[80:83], a[48:51], v[124:127]
buffer_load_dwordx4 v13, s[48:51], s64 offen lds
v_mfma_f32_16x16x32_bf16 v[108:111], a[80:83], a[40:43], v[108:111]
v_mfma_f32_16x16x32_bf16 v[108:111], a[84:87], a[44:47], v[108:111]
v_mfma_f32_16x16x32_bf16 v[92:95], a[84:87], a[36:39], v[92:95]
v_mfma_f32_16x16x32_bf16 v[92:95], a[80:83], a[32:35], v[92:95]
v_mfma_f32_16x16x32_bf16 v[32:35], a[88:91], a[32:35], v[32:35]
v_mfma_f32_16x16x32_bf16 v[32:35], a[92:95], a[36:39], v[32:35]
v_mfma_f32_16x16x32_bf16 v[48:51], a[92:95], a[44:47], v[48:51]
s_waitcnt lgkmcnt(0)
s_barrier
v_mfma_f32_16x16x32_bf16 v[48:51], a[88:91], a[40:43], v[48:51]
s_add_u32 m0, s77, 65536
ds_read_b64_tr_b16 a[72:73], v19 offset:36864
v_mfma_f32_16x16x32_bf16 v[64:67], a[88:91], a[48:51], v[64:67]
s_add_u32 s64, s71, 5242880
ds_read_b64_tr_b16 a[74:75], v19 offset:37120
v_mfma_f32_16x16x32_bf16 v[64:67], a[92:95], a[52:55], v[64:67]
buffer_load_dwordx4 v14, s[56:59], s64 offen lds
v_mfma_f32_16x16x32_bf16 v[80:83], a[92:95], a[60:63], v[80:83]
ds_read_b64_tr_b16 a[76:77], v19 offset:38912
v_mfma_f32_16x16x32_bf16 v[80:83], a[88:91], a[56:59], v[80:83]
ds_read_b64_tr_b16 a[78:79], v19 offset:39168
v_mfma_f32_16x16x32_bf16 v[144:147], a[96:99], a[56:59], v[144:147]
ds_read_b64_tr_b16 a[80:81], v20 offset:36864
v_mfma_f32_16x16x32_bf16 v[144:147], a[100:103], a[60:63], v[144:147]
ds_read_b64_tr_b16 a[82:83], v20 offset:37120
v_mfma_f32_16x16x32_bf16 v[128:131], a[100:103], a[52:55], v[128:131]
ds_read_b64_tr_b16 a[84:85], v20 offset:38912
v_mfma_f32_16x16x32_bf16 v[128:131], a[96:99], a[48:51], v[128:131]
ds_read_b64_tr_b16 a[86:87], v20 offset:39168
v_mfma_f32_16x16x32_bf16 v[112:115], a[96:99], a[40:43], v[112:115]
s_add_u32 m0, s78, 81920
ds_read_b64_tr_b16 a[88:89], v19 offset:40960
v_mfma_f32_16x16x32_bf16 v[112:115], a[100:103], a[44:47], v[112:115]
s_add_u32 s64, s75, 3932160
ds_read_b64_tr_b16 a[90:91], v19 offset:41216
v_mfma_f32_16x16x32_bf16 v[96:99], a[100:103], a[36:39], v[96:99]
buffer_load_dwordx4 v23, s[60:63], s64 offen lds
v_mfma_f32_16x16x32_bf16 v[96:99], a[96:99], a[32:35], v[96:99]
ds_read_b64_tr_b16 a[92:93], v19 offset:43008
v_mfma_f32_16x16x32_bf16 v[36:39], a[104:107], a[32:35], v[36:39]
ds_read_b64_tr_b16 a[94:95], v19 offset:43264
v_mfma_f32_16x16x32_bf16 v[36:39], a[108:111], a[36:39], v[36:39]
ds_read_b64_tr_b16 a[96:97], v20 offset:40960
v_mfma_f32_16x16x32_bf16 v[52:55], a[108:111], a[44:47], v[52:55]
ds_read_b64_tr_b16 a[98:99], v20 offset:41216
v_mfma_f32_16x16x32_bf16 v[52:55], a[104:107], a[40:43], v[52:55]
ds_read_b64_tr_b16 a[100:101], v20 offset:43008
v_mfma_f32_16x16x32_bf16 v[68:71], a[104:107], a[48:51], v[68:71]
ds_read_b64_tr_b16 a[102:103], v20 offset:43264
v_mfma_f32_16x16x32_bf16 v[68:71], a[108:111], a[52:55], v[68:71]
s_add_u32 m0, s77, 66560
v_mfma_f32_16x16x32_bf16 v[84:87], a[108:111], a[60:63], v[84:87]
s_add_u32 s64, s71, 5275648
v_mfma_f32_16x16x32_bf16 v[84:87], a[104:107], a[56:59], v[84:87]
buffer_load_dwordx4 v14, s[56:59], s64 offen lds
v_mfma_f32_16x16x32_bf16 v[148:151], a[112:115], a[56:59], v[148:151]
ds_read_b64_tr_b16 a[104:105], v19 offset:32768
v_mfma_f32_16x16x32_bf16 v[148:151], a[116:119], a[60:63], v[148:151]
ds_read_b64_tr_b16 a[106:107], v19 offset:33024
v_mfma_f32_16x16x32_bf16 v[132:135], a[116:119], a[52:55], v[132:135]
ds_read_b64_tr_b16 a[108:109], v19 offset:34816
v_mfma_f32_16x16x32_bf16 v[132:135], a[112:115], a[48:51], v[132:135]
ds_read_b64_tr_b16 a[110:111], v19 offset:35072
v_mfma_f32_16x16x32_bf16 v[116:119], a[112:115], a[40:43], v[116:119]
v_mfma_f32_16x16x32_bf16 v[116:119], a[116:119], a[44:47], v[116:119]
v_mfma_f32_16x16x32_bf16 v[100:103], a[116:119], a[36:39], v[100:103]
s_add_u32 m0, s78, 86016
v_mfma_f32_16x16x32_bf16 v[100:103], a[112:115], a[32:35], v[100:103]
s_waitcnt lgkmcnt(4)
s_add_u32 s64, s75, 3934208
ds_read_b64_tr_b16 a[112:113], v20 offset:32768
v_mfma_f32_16x16x32_bf16 v[184:187], a[72:75], a[0:3], v[184:187]
buffer_load_dwordx4 v23, s[60:63], s64 offen lds
v_mfma_f32_16x16x32_bf16 v[184:187], a[76:79], a[4:7], v[184:187]
s_add_u32 s65, s79, 27648
ds_read_b64_tr_b16 a[114:115], v20 offset:33024
v_mfma_f32_16x16x32_bf16 v[192:195], a[76:79], a[12:15], v[192:195]
buffer_store_dwordx4 a[208:211], v16, s[44:47], s65 offen sc1
v_mfma_f32_16x16x32_bf16 v[192:195], a[72:75], a[8:11], v[192:195]
s_add_u32 s17, s78, .-L_pc+6144
ds_read_b64_tr_b16 a[116:117], v20 offset:34816
v_mfma_f32_16x16x32_bf16 v[200:203], a[72:75], a[16:19], v[200:203]
buffer_load_dword a252, v16, s[88:91], s17 offen
v_mfma_f32_16x16x32_bf16 v[200:203], a[76:79], a[20:23], v[200:203]
ds_read_b64_tr_b16 a[118:119], v20 offset:35072
v_mfma_f32_16x16x32_bf16 v[208:211], a[76:79], a[28:31], v[208:211]
v_mfma_f32_16x16x32_bf16 v[208:211], a[72:75], a[24:27], v[208:211]
ds_read_b64_tr_b16 a[72:73], v4 offset:32768
v_mfma_f32_16x16x32_bf16 v[212:215], a[80:83], a[24:27], v[212:215]
s_add_u32 m0, s77, 67584
ds_read_b64_tr_b16 a[74:75], v4 offset:33792
v_mfma_f32_16x16x32_bf16 v[212:215], a[84:87], a[28:31], v[212:215]
s_add_u32 s64, s71, 5308416
ds_read_b64_tr_b16 a[76:77], v4 offset:40960
v_mfma_f32_16x16x32_bf16 v[204:207], a[84:87], a[20:23], v[204:207]
buffer_load_dwordx4 v15, s[56:59], s64 offen lds
v_mfma_f32_16x16x32_bf16 v[204:207], a[80:83], a[16:19], v[204:207]
ds_read_b64_tr_b16 a[78:79], v4 offset:41984
v_mfma_f32_16x16x32_bf16 v[196:199], a[80:83], a[8:11], v[196:199]
v_mfma_f32_16x16x32_bf16 v[196:199], a[84:87], a[12:15], v[196:199]
v_mfma_f32_16x16x32_bf16 v[188:191], a[84:87], a[4:7], v[188:191]
v_mfma_f32_16x16x32_bf16 v[188:191], a[80:83], a[0:3], v[188:191]
ds_read_b64_tr_b16 a[80:81], v5 offset:32768
v_mfma_f32_16x16x32_bf16 v[216:219], a[0:3], a[88:91], v[216:219]
ds_read_b64_tr_b16 a[82:83], v5 offset:33792
v_mfma_f32_16x16x32_bf16 v[216:219], a[4:7], a[92:95], v[216:219]
s_add_u32 m0, s78, 90112
ds_read_b64_tr_b16 a[84:85], v5 offset:40960
v_mfma_f32_16x16x32_bf16 v[224:227], a[12:15], a[92:95], v[224:227]
s_add_u32 s64, s75, 3936256
ds_read_b64_tr_b16 a[86:87], v5 offset:41984
v_mfma_f32_16x16x32_bf16 v[224:227], a[8:11], a[88:91], v[224:227]
buffer_load_dwordx4 v23, s[60:63], s64 offen lds
v_mfma_f32_16x16x32_bf16 v[232:235], a[16:19], a[88:91], v[232:235]
v_mfma_f32_16x16x32_bf16 v[232:235], a[20:23], a[92:95], v[232:235]
v_mfma_f32_16x16x32_bf16 v[240:243], a[28:31], a[92:95], v[240:243]
v_mfma_f32_16x16x32_bf16 v[240:243], a[24:27], a[88:91], v[240:243]
ds_read_b64_tr_b16 a[88:89], v6 offset:32768
v_mfma_f32_16x16x32_bf16 v[244:247], a[24:27], a[96:99], v[244:247]
ds_read_b64_tr_b16 a[90:91], v6 offset:33792
v_mfma_f32_16x16x32_bf16 v[244:247], a[28:31], a[100:103], v[244:247]
ds_read_b64_tr_b16 a[92:93], v6 offset:40960
v_add_u32 v19, 0x8000, v19
v_mfma_f32_16x16x32_bf16 v[236:239], a[20:23], a[100:103], v[236:239]
s_add_u32 m0, s77, 68608
ds_read_b64_tr_b16 a[94:95], v6 offset:41984
v_mfma_f32_16x16x32_bf16 v[236:239], a[16:19], a[96:99], v[236:239]
s_add_u32 s64, s71, 5341184
v_mfma_f32_16x16x32_bf16 v[228:231], a[8:11], a[96:99], v[228:231]
buffer_load_dwordx4 v15, s[56:59], s64 offen lds
v_mfma_f32_16x16x32_bf16 v[228:231], a[12:15], a[100:103], v[228:231]
v_mfma_f32_16x16x32_bf16 v[220:223], a[4:7], a[100:103], v[220:223]
v_mfma_f32_16x16x32_bf16 v[220:223], a[0:3], a[96:99], v[220:223]
s_waitcnt lgkmcnt(4)
ds_read_b64_tr_b16 a[96:97], v7 offset:32768
v_mfma_f32_16x16x32_bf16 v[152:155], a[104:107], a[0:3], v[152:155]
ds_read_b64_tr_b16 a[98:99], v7 offset:33792
v_mfma_f32_16x16x32_bf16 v[152:155], a[108:111], a[4:7], v[152:155]
ds_read_b64_tr_b16 a[100:101], v7 offset:40960
v_add_u32 v20, 0x8000, v20
v_mfma_f32_16x16x32_bf16 v[160:163], a[108:111], a[12:15], v[160:163]
ds_read_b64_tr_b16 a[102:103], v7 offset:41984
v_mfma_f32_16x16x32_bf16 v[160:163], a[104:107], a[8:11], v[160:163]
v_mfma_f32_16x16x32_bf16 v[168:171], a[104:107], a[16:19], v[168:171]
v_mfma_f32_16x16x32_bf16 v[168:171], a[108:111], a[20:23], v[168:171]
v_mfma_f32_16x16x32_bf16 v[176:179], a[108:111], a[28:31], v[176:179]
s_add_u32 m0, s76, 0
v_mfma_f32_16x16x32_bf16 v[176:179], a[104:107], a[24:27], v[176:179]
s_add_u32 s64, s72, 1280
ds_read_b64_tr_b16 a[104:105], v8 offset:32768
v_mfma_f32_16x16x32_bf16 v[180:183], a[112:115], a[24:27], v[180:183]
buffer_load_dwordx4 v12, s[48:51], s64 offen lds
v_mfma_f32_16x16x32_bf16 v[180:183], a[116:119], a[28:31], v[180:183]
ds_read_b64_tr_b16 a[106:107], v8 offset:33792
v_add_u32 v4, 0x8000, v4
v_mfma_f32_16x16x32_bf16 v[172:175], a[116:119], a[20:23], v[172:175]
ds_read_b64_tr_b16 a[108:109], v8 offset:40960
v_mfma_f32_16x16x32_bf16 v[172:175], a[112:115], a[16:19], v[172:175]
s_add_u32 m0, s76, 1024
ds_read_b64_tr_b16 a[110:111], v8 offset:41984
v_mfma_f32_16x16x32_bf16 v[164:167], a[112:115], a[8:11], v[164:167]
s_add_u32 s64, s72, 17664
v_mfma_f32_16x16x32_bf16 v[164:167], a[116:119], a[12:15], v[164:167]
buffer_load_dwordx4 v13, s[48:51], s64 offen lds
v_mfma_f32_16x16x32_bf16 v[156:159], a[116:119], a[4:7], v[156:159]
v_mfma_f32_16x16x32_bf16 v[156:159], a[112:115], a[0:3], v[156:159]
ds_read_b64_tr_b16 a[112:113], v9 offset:32768
v_mfma_f32_16x16x32_bf16 v[24:27], a[72:75], a[0:3], v[24:27]
s_add_u32 m0, s76, 2048
ds_read_b64_tr_b16 a[114:115], v9 offset:33792
v_mfma_f32_16x16x32_bf16 v[24:27], a[76:79], a[4:7], v[24:27]
s_add_u32 s64, s72, 132352
ds_read_b64_tr_b16 a[116:117], v9 offset:40960
v_add_u32 v5, 0x8000, v5
v_mfma_f32_16x16x32_bf16 v[40:43], a[76:79], a[12:15], v[40:43]
buffer_load_dwordx4 v12, s[48:51], s64 offen lds
v_mfma_f32_16x16x32_bf16 v[40:43], a[72:75], a[8:11], v[40:43]
s_add_u32 s65, s79, 11264
ds_read_b64_tr_b16 a[118:119], v9 offset:41984
v_mfma_f32_16x16x32_bf16 v[56:59], a[72:75], a[16:19], v[56:59]
buffer_store_dwordx4 a[212:215], v16, s[44:47], s65 offen sc1
v_mfma_f32_16x16x32_bf16 v[56:59], a[76:79], a[20:23], v[56:59]
s_add_u32 m0, s76, 3072
v_mfma_f32_16x16x32_bf16 v[72:75], a[76:79], a[28:31], v[72:75]
s_waitcnt vmcnt(13)
s_add_u32 s64, s72, 148736
ds_read_b128 a[32:35], v2 offset:32768
v_mfma_f32_16x16x32_bf16 v[72:75], a[72:75], a[24:27], v[72:75]
buffer_load_dwordx4 v13, s[48:51], s64 offen lds
v_mfma_f32_16x16x32_bf16 v[136:139], a[80:83], a[24:27], v[136:139]
ds_read_b128 a[36:39], v3 offset:32768
v_mfma_f32_16x16x32_bf16 v[136:139], a[84:87], a[28:31], v[136:139]
ds_read_b128 a[40:43], v2 offset:34816
v_add_u32 v6, 0x8000, v6
v_mfma_f32_16x16x32_bf16 v[120:123], a[84:87], a[20:23], v[120:123]
s_add_u32 m0, s76, 4096
ds_read_b128 a[44:47], v3 offset:34816
v_mfma_f32_16x16x32_bf16 v[120:123], a[80:83], a[16:19], v[120:123]
s_add_u32 s64, s73, 1280
ds_read_b128 a[48:51], v2 offset:36864
v_mfma_f32_16x16x32_bf16 v[104:107], a[80:83], a[8:11], v[104:107]
buffer_load_dwordx4 v12, s[48:51], s64 offen lds
v_mfma_f32_16x16x32_bf16 v[104:107], a[84:87], a[12:15], v[104:107]
ds_read_b128 a[52:55], v3 offset:36864
v_mfma_f32_16x16x32_bf16 v[88:91], a[84:87], a[4:7], v[88:91]
ds_read_b128 a[56:59], v2 offset:38912
v_mfma_f32_16x16x32_bf16 v[88:91], a[80:83], a[0:3], v[88:91]
s_waitcnt lgkmcnt(7)
s_add_u32 m0, s76, 5120
ds_read_b128 a[60:63], v3 offset:38912
v_mfma_f32_16x16x32_bf16 v[28:31], a[88:91], a[0:3], v[28:31]
s_add_u32 s64, s73, 17664
ds_read_b64_tr_b16 a[72:73], v10 offset:32768
v_mfma_f32_16x16x32_bf16 v[28:31], a[92:95], a[4:7], v[28:31]
buffer_load_dwordx4 v13, s[48:51], s64 offen lds
v_mfma_f32_16x16x32_bf16 v[44:47], a[92:95], a[12:15], v[44:47]
ds_read_b64_tr_b16 a[74:75], v10 offset:33792
v_add_u32 v7, 0x8000, v7
v_mfma_f32_16x16x32_bf16 v[44:47], a[88:91], a[8:11], v[44:47]
ds_read_b64_tr_b16 a[76:77], v10 offset:40960
v_mfma_f32_16x16x32_bf16 v[60:63], a[88:91], a[16:19], v[60:63]
s_add_u32 m0, s76, 6144
ds_read_b64_tr_b16 a[78:79], v10 offset:41984
v_mfma_f32_16x16x32_bf16 v[60:63], a[92:95], a[20:23], v[60:63]
s_add_u32 s64, s73, 132352
ds_read_b64_tr_b16 a[80:81], v11 offset:32768
v_mfma_f32_16x16x32_bf16 v[76:79], a[92:95], a[28:31], v[76:79]
buffer_load_dwordx4 v12, s[48:51], s64 offen lds
v_mfma_f32_16x16x32_bf16 v[76:79], a[88:91], a[24:27], v[76:79]
ds_read_b64_tr_b16 a[82:83], v11 offset:33792
v_mfma_f32_16x16x32_bf16 v[140:143], a[96:99], a[24:27], v[140:143]
ds_read_b64_tr_b16 a[84:85], v11 offset:40960
v_mfma_f32_16x16x32_bf16 v[140:143], a[100:103], a[28:31], v[140:143]
s_add_u32 m0, s76, 7168
ds_read_b64_tr_b16 a[86:87], v11 offset:41984
v_add_u32 v8, 0x8000, v8
v_mfma_f32_16x16x32_bf16 v[124:127], a[100:103], a[20:23], v[124:127]
s_add_u32 s64, s73, 148736
v_mfma_f32_16x16x32_bf16 v[124:127], a[96:99], a[16:19], v[124:127]
buffer_load_dwordx4 v13, s[48:51], s64 offen lds
v_mfma_f32_16x16x32_bf16 v[108:111], a[96:99], a[8:11], v[108:111]
v_mfma_f32_16x16x32_bf16 v[108:111], a[100:103], a[12:15], v[108:111]
v_mfma_f32_16x16x32_bf16 v[92:95], a[100:103], a[4:7], v[92:95]
v_add_u32 v9, 0x8000, v9
v_add_u32 v10, 0x8000, v10
v_mfma_f32_16x16x32_bf16 v[92:95], a[96:99], a[0:3], v[92:95]
v_add_u32 v11, 0x8000, v11
v_mfma_f32_16x16x32_bf16 v[32:35], a[104:107], a[0:3], v[32:35]
v_mfma_f32_16x16x32_bf16 v[32:35], a[108:111], a[4:7], v[32:35]
v_mfma_f32_16x16x32_bf16 v[48:51], a[108:111], a[12:15], v[48:51]
s_waitcnt lgkmcnt(0)
s_barrier
v_mfma_f32_16x16x32_bf16 v[48:51], a[104:107], a[8:11], v[48:51]
s_add_u32 m0, s77, 98304
ds_read_b64_tr_b16 a[88:89], v19 offset:36864
v_mfma_f32_16x16x32_bf16 v[64:67], a[104:107], a[16:19], v[64:67]
s_add_u32 s64, s71, 5767168
ds_read_b64_tr_b16 a[90:91], v19 offset:37120
v_mfma_f32_16x16x32_bf16 v[64:67], a[108:111], a[20:23], v[64:67]
buffer_load_dwordx4 v14, s[56:59], s64 offen lds
v_mfma_f32_16x16x32_bf16 v[80:83], a[108:111], a[28:31], v[80:83]
ds_read_b64_tr_b16 a[92:93], v19 offset:38912
v_mfma_f32_16x16x32_bf16 v[80:83], a[104:107], a[24:27], v[80:83]
ds_read_b64_tr_b16 a[94:95], v19 offset:39168
v_mfma_f32_16x16x32_bf16 v[144:147], a[112:115], a[24:27], v[144:147]
ds_read_b64_tr_b16 a[96:97], v20 offset:36864
v_mfma_f32_16x16x32_bf16 v[144:147], a[116:119], a[28:31], v[144:147]
ds_read_b64_tr_b16 a[98:99], v20 offset:37120
v_mfma_f32_16x16x32_bf16 v[128:131], a[116:119], a[20:23], v[128:131]
ds_read_b64_tr_b16 a[100:101], v20 offset:38912
v_mfma_f32_16x16x32_bf16 v[128:131], a[112:115], a[16:19], v[128:131]
ds_read_b64_tr_b16 a[102:103], v20 offset:39168
v_mfma_f32_16x16x32_bf16 v[112:115], a[112:115], a[8:11], v[112:115]
s_add_u32 m0, s78, 114688
ds_read_b64_tr_b16 a[104:105], v19 offset:40960
v_mfma_f32_16x16x32_bf16 v[112:115], a[116:119], a[12:15], v[112:115]
s_add_u32 s64, s75, 4325376
ds_read_b64_tr_b16 a[106:107], v19 offset:41216
v_mfma_f32_16x16x32_bf16 v[96:99], a[116:119], a[4:7], v[96:99]
buffer_load_dwordx4 v23, s[60:63], s64 offen lds
v_mfma_f32_16x16x32_bf16 v[96:99], a[112:115], a[0:3], v[96:99]
ds_read_b64_tr_b16 a[108:109], v19 offset:43008
v_mfma_f32_16x16x32_bf16 v[36:39], a[72:75], a[0:3], v[36:39]
ds_read_b64_tr_b16 a[110:111], v19 offset:43264
v_mfma_f32_16x16x32_bf16 v[36:39], a[76:79], a[4:7], v[36:39]
ds_read_b64_tr_b16 a[112:113], v20 offset:40960
v_mfma_f32_16x16x32_bf16 v[52:55], a[76:79], a[12:15], v[52:55]
ds_read_b64_tr_b16 a[114:115], v20 offset:41216
v_mfma_f32_16x16x32_bf16 v[52:55], a[72:75], a[8:11], v[52:55]
ds_read_b64_tr_b16 a[116:117], v20 offset:43008
v_mfma_f32_16x16x32_bf16 v[68:71], a[72:75], a[16:19], v[68:71]
s_add_u32 s65, s79, 28672
ds_read_b64_tr_b16 a[118:119], v20 offset:43264
v_mfma_f32_16x16x32_bf16 v[68:71], a[76:79], a[20:23], v[68:71]
s_add_u32 m0, s77, 99328
buffer_store_dwordx4 a[216:219], v16, s[44:47], s65 offen sc1
v_mfma_f32_16x16x32_bf16 v[84:87], a[76:79], a[28:31], v[84:87]
s_add_u32 s64, s71, 5799936
v_mfma_f32_16x16x32_bf16 v[84:87], a[72:75], a[24:27], v[84:87]
buffer_load_dwordx4 v14, s[56:59], s64 offen lds
v_mfma_f32_16x16x32_bf16 v[148:151], a[80:83], a[24:27], v[148:151]
ds_read_b64_tr_b16 a[72:73], v19 offset:32768
v_mfma_f32_16x16x32_bf16 v[148:151], a[84:87], a[28:31], v[148:151]
ds_read_b64_tr_b16 a[74:75], v19 offset:33024
v_mfma_f32_16x16x32_bf16 v[132:135], a[84:87], a[20:23], v[132:135]
ds_read_b64_tr_b16 a[76:77], v19 offset:34816
v_mfma_f32_16x16x32_bf16 v[132:135], a[80:83], a[16:19], v[132:135]
ds_read_b64_tr_b16 a[78:79], v19 offset:35072
v_mfma_f32_16x16x32_bf16 v[116:119], a[80:83], a[8:11], v[116:119]
v_mfma_f32_16x16x32_bf16 v[116:119], a[84:87], a[12:15], v[116:119]
v_mfma_f32_16x16x32_bf16 v[100:103], a[84:87], a[4:7], v[100:103]
s_add_u32 m0, s78, 118784
v_mfma_f32_16x16x32_bf16 v[100:103], a[80:83], a[0:3], v[100:103]
s_waitcnt lgkmcnt(4)
s_add_u32 s64, s75, 4327424
ds_read_b64_tr_b16 a[80:81], v20 offset:32768
v_mfma_f32_16x16x32_bf16 v[184:187], a[88:91], a[32:35], v[184:187]
buffer_load_dwordx4 v23, s[60:63], s64 offen lds
v_mfma_f32_16x16x32_bf16 v[184:187], a[92:95], a[36:39], v[184:187]
ds_read_b64_tr_b16 a[82:83], v20 offset:33024
v_mfma_f32_16x16x32_bf16 v[192:195], a[92:95], a[44:47], v[192:195]
ds_read_b64_tr_b16 a[84:85], v20 offset:34816
v_mfma_f32_16x16x32_bf16 v[192:195], a[88:91], a[40:43], v[192:195]
ds_read_b64_tr_b16 a[86:87], v20 offset:35072
v_mfma_f32_16x16x32_bf16 v[200:203], a[88:91], a[48:51], v[200:203]
s_cmp_eq_u32 s30, 0
s_cselect_b32 s81, 256, 0
v_mfma_f32_16x16x32_bf16 v[200:203], a[92:95], a[52:55], v[200:203]
v_mfma_f32_16x16x32_bf16 v[208:211], a[92:95], a[60:63], v[208:211]
v_mfma_f32_16x16x32_bf16 v[208:211], a[88:91], a[56:59], v[208:211]
ds_read_b64_tr_b16 a[88:89], v4 offset:32768
v_mfma_f32_16x16x32_bf16 v[212:215], a[96:99], a[56:59], v[212:215]
s_add_u32 m0, s77, 100352
ds_read_b64_tr_b16 a[90:91], v4 offset:33792
v_mfma_f32_16x16x32_bf16 v[212:215], a[100:103], a[60:63], v[212:215]
s_add_u32 s64, s71, 5832704
ds_read_b64_tr_b16 a[92:93], v4 offset:40960
v_mfma_f32_16x16x32_bf16 v[204:207], a[100:103], a[52:55], v[204:207]
buffer_load_dwordx4 v15, s[56:59], s64 offen lds
v_mfma_f32_16x16x32_bf16 v[204:207], a[96:99], a[48:51], v[204:207]
ds_read_b64_tr_b16 a[94:95], v4 offset:41984
v_mfma_f32_16x16x32_bf16 v[196:199], a[96:99], a[40:43], v[196:199]
v_mfma_f32_16x16x32_bf16 v[196:199], a[100:103], a[44:47], v[196:199]
v_mfma_f32_16x16x32_bf16 v[188:191], a[100:103], a[36:39], v[188:191]
v_mfma_f32_16x16x32_bf16 v[188:191], a[96:99], a[32:35], v[188:191]
ds_read_b64_tr_b16 a[96:97], v5 offset:32768
v_mfma_f32_16x16x32_bf16 v[216:219], a[32:35], a[104:107], v[216:219]
ds_read_b64_tr_b16 a[98:99], v5 offset:33792
v_mfma_f32_16x16x32_bf16 v[216:219], a[36:39], a[108:111], v[216:219]
s_add_u32 m0, s78, 122880
ds_read_b64_tr_b16 a[100:101], v5 offset:40960
v_mfma_f32_16x16x32_bf16 v[224:227], a[44:47], a[108:111], v[224:227]
s_add_u32 s64, s75, 4329472
ds_read_b64_tr_b16 a[102:103], v5 offset:41984
v_mfma_f32_16x16x32_bf16 v[224:227], a[40:43], a[104:107], v[224:227]
buffer_load_dwordx4 v23, s[60:63], s64 offen lds
v_mfma_f32_16x16x32_bf16 v[232:235], a[48:51], a[104:107], v[232:235]
v_mfma_f32_16x16x32_bf16 v[232:235], a[52:55], a[108:111], v[232:235]
v_mfma_f32_16x16x32_bf16 v[240:243], a[60:63], a[108:111], v[240:243]
v_mfma_f32_16x16x32_bf16 v[240:243], a[56:59], a[104:107], v[240:243]
ds_read_b64_tr_b16 a[104:105], v6 offset:32768
v_mfma_f32_16x16x32_bf16 v[244:247], a[56:59], a[112:115], v[244:247]
ds_read_b64_tr_b16 a[106:107], v6 offset:33792
v_mfma_f32_16x16x32_bf16 v[244:247], a[60:63], a[116:119], v[244:247]
ds_read_b64_tr_b16 a[108:109], v6 offset:40960
v_subrev_u32 v19, 0x8000, v19
v_mfma_f32_16x16x32_bf16 v[236:239], a[52:55], a[116:119], v[236:239]
s_add_u32 m0, s77, 101376
ds_read_b64_tr_b16 a[110:111], v6 offset:41984
v_mfma_f32_16x16x32_bf16 v[236:239], a[48:51], a[112:115], v[236:239]
s_add_u32 s64, s71, 5865472
v_mfma_f32_16x16x32_bf16 v[228:231], a[40:43], a[112:115], v[228:231]
buffer_load_dwordx4 v15, s[56:59], s64 offen lds
v_mfma_f32_16x16x32_bf16 v[228:231], a[44:47], a[116:119], v[228:231]
v_mfma_f32_16x16x32_bf16 v[220:223], a[36:39], a[116:119], v[220:223]
v_mfma_f32_16x16x32_bf16 v[220:223], a[32:35], a[112:115], v[220:223]
s_waitcnt lgkmcnt(4)
ds_read_b64_tr_b16 a[112:113], v7 offset:32768
v_mfma_f32_16x16x32_bf16 v[152:155], a[72:75], a[32:35], v[152:155]
ds_read_b64_tr_b16 a[114:115], v7 offset:33792
v_mfma_f32_16x16x32_bf16 v[152:155], a[76:79], a[36:39], v[152:155]
ds_read_b64_tr_b16 a[116:117], v7 offset:40960
v_subrev_u32 v20, 0x8000, v20
v_mfma_f32_16x16x32_bf16 v[160:163], a[76:79], a[44:47], v[160:163]
ds_read_b64_tr_b16 a[118:119], v7 offset:41984
v_mfma_f32_16x16x32_bf16 v[160:163], a[72:75], a[40:43], v[160:163]
v_mfma_f32_16x16x32_bf16 v[168:171], a[72:75], a[48:51], v[168:171]
v_mfma_f32_16x16x32_bf16 v[168:171], a[76:79], a[52:55], v[168:171]
s_add_u32 s65, s79, 29696
v_mfma_f32_16x16x32_bf16 v[176:179], a[76:79], a[60:63], v[176:179]
s_add_u32 m0, s76, 32768
buffer_store_dwordx4 a[220:223], v16, s[44:47], s65 offen sc1
v_mfma_f32_16x16x32_bf16 v[176:179], a[72:75], a[56:59], v[176:179]
s_add_u32 s64, s72, 1408
ds_read_b64_tr_b16 a[72:73], v8 offset:32768
v_mfma_f32_16x16x32_bf16 v[180:183], a[80:83], a[56:59], v[180:183]
buffer_load_dwordx4 v12, s[48:51], s64 offen lds
v_mfma_f32_16x16x32_bf16 v[180:183], a[84:87], a[60:63], v[180:183]
ds_read_b64_tr_b16 a[74:75], v8 offset:33792
v_subrev_u32 v4, 0x8000, v4
v_mfma_f32_16x16x32_bf16 v[172:175], a[84:87], a[52:55], v[172:175]
ds_read_b64_tr_b16 a[76:77], v8 offset:40960
v_mfma_f32_16x16x32_bf16 v[172:175], a[80:83], a[48:51], v[172:175]
s_add_u32 m0, s76, 33792
ds_read_b64_tr_b16 a[78:79], v8 offset:41984
v_mfma_f32_16x16x32_bf16 v[164:167], a[80:83], a[40:43], v[164:167]
s_add_u32 s64, s72, 17792
v_mfma_f32_16x16x32_bf16 v[164:167], a[84:87], a[44:47], v[164:167]
buffer_load_dwordx4 v13, s[48:51], s64 offen lds
v_mfma_f32_16x16x32_bf16 v[156:159], a[84:87], a[36:39], v[156:159]
v_mfma_f32_16x16x32_bf16 v[156:159], a[80:83], a[32:35], v[156:159]
ds_read_b64_tr_b16 a[80:81], v9 offset:32768
v_mfma_f32_16x16x32_bf16 v[24:27], a[88:91], a[32:35], v[24:27]
s_add_u32 m0, s76, 34816
ds_read_b64_tr_b16 a[82:83], v9 offset:33792
v_mfma_f32_16x16x32_bf16 v[24:27], a[92:95], a[36:39], v[24:27]
s_add_u32 s64, s72, 132480
ds_read_b64_tr_b16 a[84:85], v9 offset:40960
v_subrev_u32 v5, 0x8000, v5
v_mfma_f32_16x16x32_bf16 v[40:43], a[92:95], a[44:47], v[40:43]
buffer_load_dwordx4 v12, s[48:51], s64 offen lds
v_mfma_f32_16x16x32_bf16 v[40:43], a[88:91], a[40:43], v[40:43]
ds_read_b64_tr_b16 a[86:87], v9 offset:41984
v_mfma_f32_16x16x32_bf16 v[56:59], a[88:91], a[48:51], v[56:59]
v_mfma_f32_16x16x32_bf16 v[56:59], a[92:95], a[52:55], v[56:59]
s_add_u32 m0, s76, 35840
v_mfma_f32_16x16x32_bf16 v[72:75], a[92:95], a[60:63], v[72:75]
s_waitcnt vmcnt(12)
s_add_u32 s64, s72, 148864
ds_read_b128 a[0:3], v2 offset:0
v_mfma_f32_16x16x32_bf16 v[72:75], a[88:91], a[56:59], v[72:75]
buffer_load_dwordx4 v13, s[48:51], s64 offen lds
v_mfma_f32_16x16x32_bf16 v[136:139], a[96:99], a[56:59], v[136:139]
ds_read_b128 a[4:7], v3 offset:0
v_mfma_f32_16x16x32_bf16 v[136:139], a[100:103], a[60:63], v[136:139]
ds_read_b128 a[8:11], v2 offset:2048
v_subrev_u32 v6, 0x8000, v6
v_mfma_f32_16x16x32_bf16 v[120:123], a[100:103], a[52:55], v[120:123]
s_add_u32 m0, s76, 36864
ds_read_b128 a[12:15], v3 offset:2048
v_mfma_f32_16x16x32_bf16 v[120:123], a[96:99], a[48:51], v[120:123]
s_add_u32 s64, s73, 1408
ds_read_b128 a[16:19], v2 offset:4096
v_mfma_f32_16x16x32_bf16 v[104:107], a[96:99], a[40:43], v[104:107]
buffer_load_dwordx4 v12, s[48:51], s64 offen lds
v_mfma_f32_16x16x32_bf16 v[104:107], a[100:103], a[44:47], v[104:107]
ds_read_b128 a[20:23], v3 offset:4096
v_mfma_f32_16x16x32_bf16 v[88:91], a[100:103], a[36:39], v[88:91]
ds_read_b128 a[24:27], v2 offset:6144
v_mfma_f32_16x16x32_bf16 v[88:91], a[96:99], a[32:35], v[88:91]
s_waitcnt lgkmcnt(7)
s_add_u32 m0, s76, 37888
ds_read_b128 a[28:31], v3 offset:6144
v_mfma_f32_16x16x32_bf16 v[28:31], a[104:107], a[32:35], v[28:31]
s_add_u32 s64, s73, 17792
ds_read_b64_tr_b16 a[88:89], v10 offset:32768
v_mfma_f32_16x16x32_bf16 v[28:31], a[108:111], a[36:39], v[28:31]
buffer_load_dwordx4 v13, s[48:51], s64 offen lds
v_mfma_f32_16x16x32_bf16 v[44:47], a[108:111], a[44:47], v[44:47]
ds_read_b64_tr_b16 a[90:91], v10 offset:33792
v_subrev_u32 v7, 0x8000, v7
v_mfma_f32_16x16x32_bf16 v[44:47], a[104:107], a[40:43], v[44:47]
ds_read_b64_tr_b16 a[92:93], v10 offset:40960
v_mfma_f32_16x16x32_bf16 v[60:63], a[104:107], a[48:51], v[60:63]
s_add_u32 m0, s76, 38912
buffer_load_dword v1, off, s[52:55], s78 sc1
v_mfma_f32_16x16x32_bf16 v[60:63], a[108:111], a[52:55], v[60:63]
s_add_u32 s64, s73, 132480
ds_read_b64_tr_b16 a[94:95], v10 offset:41984
v_mfma_f32_16x16x32_bf16 v[76:79], a[108:111], a[60:63], v[76:79]
buffer_load_dwordx4 v12, s[48:51], s64 offen lds
v_mfma_f32_16x16x32_bf16 v[76:79], a[104:107], a[56:59], v[76:79]
ds_read_b64_tr_b16 a[96:97], v11 offset:32768
v_mfma_f32_16x16x32_bf16 v[140:143], a[112:115], a[56:59], v[140:143]
ds_read_b64_tr_b16 a[98:99], v11 offset:33792
v_mfma_f32_16x16x32_bf16 v[140:143], a[116:119], a[60:63], v[140:143]
s_add_u32 m0, s76, 39936
ds_read_b64_tr_b16 a[100:101], v11 offset:40960
v_subrev_u32 v8, 0x8000, v8
v_mfma_f32_16x16x32_bf16 v[124:127], a[116:119], a[52:55], v[124:127]
s_add_u32 s64, s73, 148864
ds_read_b64_tr_b16 a[102:103], v11 offset:41984
v_mfma_f32_16x16x32_bf16 v[124:127], a[112:115], a[48:51], v[124:127]
buffer_load_dwordx4 v13, s[48:51], s64 offen lds
v_mfma_f32_16x16x32_bf16 v[108:111], a[112:115], a[40:43], v[108:111]
v_mfma_f32_16x16x32_bf16 v[108:111], a[116:119], a[44:47], v[108:111]
v_mfma_f32_16x16x32_bf16 v[92:95], a[116:119], a[36:39], v[92:95]
v_subrev_u32 v9, 0x8000, v9
v_subrev_u32 v10, 0x8000, v10
v_mfma_f32_16x16x32_bf16 v[92:95], a[112:115], a[32:35], v[92:95]
v_subrev_u32 v11, 0x8000, v11
v_mfma_f32_16x16x32_bf16 v[32:35], a[72:75], a[32:35], v[32:35]
v_mfma_f32_16x16x32_bf16 v[32:35], a[76:79], a[36:39], v[32:35]
v_mfma_f32_16x16x32_bf16 v[48:51], a[76:79], a[44:47], v[48:51]
s_waitcnt lgkmcnt(0)
s_barrier
v_mfma_f32_16x16x32_bf16 v[48:51], a[72:75], a[40:43], v[48:51]
s_add_u32 m0, s77, 131072
ds_read_b64_tr_b16 a[104:105], v19 offset:4096
v_mfma_f32_16x16x32_bf16 v[64:67], a[72:75], a[48:51], v[64:67]
s_add_u32 s64, s71, 6291456
ds_read_b64_tr_b16 a[106:107], v19 offset:4352
v_mfma_f32_16x16x32_bf16 v[64:67], a[76:79], a[52:55], v[64:67]
buffer_load_dwordx4 v14, s[56:59], s64 offen lds
v_mfma_f32_16x16x32_bf16 v[80:83], a[76:79], a[60:63], v[80:83]
ds_read_b64_tr_b16 a[108:109], v19 offset:6144
v_mfma_f32_16x16x32_bf16 v[80:83], a[72:75], a[56:59], v[80:83]
s_add_u32 s65, s79, 13312
ds_read_b64_tr_b16 a[110:111], v19 offset:6400
v_mfma_f32_16x16x32_bf16 v[144:147], a[80:83], a[56:59], v[144:147]
buffer_store_dwordx4 a[224:227], v16, s[44:47], s65 offen sc1
v_mfma_f32_16x16x32_bf16 v[144:147], a[84:87], a[60:63], v[144:147]
ds_read_b64_tr_b16 a[112:113], v20 offset:4096
v_mfma_f32_16x16x32_bf16 v[128:131], a[84:87], a[52:55], v[128:131]
ds_read_b64_tr_b16 a[114:115], v20 offset:4352
v_mfma_f32_16x16x32_bf16 v[128:131], a[80:83], a[48:51], v[128:131]
ds_read_b64_tr_b16 a[116:117], v20 offset:6144
v_mfma_f32_16x16x32_bf16 v[112:115], a[80:83], a[40:43], v[112:115]
s_add_u32 m0, s78, 147456
ds_read_b64_tr_b16 a[118:119], v20 offset:6400
v_mfma_f32_16x16x32_bf16 v[112:115], a[84:87], a[44:47], v[112:115]
s_add_u32 s64, s75, 4718592
ds_read_b64_tr_b16 a[72:73], v19 offset:8192
v_mfma_f32_16x16x32_bf16 v[96:99], a[84:87], a[36:39], v[96:99]
buffer_load_dwordx4 v23, s[60:63], s64 offen lds
v_mfma_f32_16x16x32_bf16 v[96:99], a[80:83], a[32:35], v[96:99]
ds_read_b64_tr_b16 a[74:75], v19 offset:8448
v_mfma_f32_16x16x32_bf16 v[36:39], a[88:91], a[32:35], v[36:39]
ds_read_b64_tr_b16 a[76:77], v19 offset:10240
v_mfma_f32_16x16x32_bf16 v[36:39], a[92:95], a[36:39], v[36:39]
ds_read_b64_tr_b16 a[78:79], v19 offset:10496
v_mfma_f32_16x16x32_bf16 v[52:55], a[92:95], a[44:47], v[52:55]
ds_read_b64_tr_b16 a[80:81], v20 offset:8192
v_mfma_f32_16x16x32_bf16 v[52:55], a[88:91], a[40:43], v[52:55]
ds_read_b64_tr_b16 a[82:83], v20 offset:8448
v_mfma_f32_16x16x32_bf16 v[68:71], a[88:91], a[48:51], v[68:71]
ds_read_b64_tr_b16 a[84:85], v20 offset:10240
v_mfma_f32_16x16x32_bf16 v[68:71], a[92:95], a[52:55], v[68:71]
s_add_u32 m0, s77, 132096
ds_read_b64_tr_b16 a[86:87], v20 offset:10496
v_mfma_f32_16x16x32_bf16 v[84:87], a[92:95], a[60:63], v[84:87]
s_add_u32 s64, s71, 6324224
v_mfma_f32_16x16x32_bf16 v[84:87], a[88:91], a[56:59], v[84:87]
buffer_load_dwordx4 v14, s[56:59], s64 offen lds
v_mfma_f32_16x16x32_bf16 v[148:151], a[96:99], a[56:59], v[148:151]
ds_read_b64_tr_b16 a[88:89], v19 offset:0
v_mfma_f32_16x16x32_bf16 v[148:151], a[100:103], a[60:63], v[148:151]
ds_read_b64_tr_b16 a[90:91], v19 offset:256
v_mfma_f32_16x16x32_bf16 v[132:135], a[100:103], a[52:55], v[132:135]
ds_read_b64_tr_b16 a[92:93], v19 offset:2048
v_mfma_f32_16x16x32_bf16 v[132:135], a[96:99], a[48:51], v[132:135]
ds_read_b64_tr_b16 a[94:95], v19 offset:2304
v_mfma_f32_16x16x32_bf16 v[116:119], a[96:99], a[40:43], v[116:119]
v_mfma_f32_16x16x32_bf16 v[116:119], a[100:103], a[44:47], v[116:119]
v_mfma_f32_16x16x32_bf16 v[100:103], a[100:103], a[36:39], v[100:103]
s_add_u32 m0, s78, 151552
v_mfma_f32_16x16x32_bf16 v[100:103], a[96:99], a[32:35], v[100:103]
s_waitcnt lgkmcnt(4)
s_add_u32 s64, s75, 4720640
ds_read_b64_tr_b16 a[96:97], v20 offset:0
v_mfma_f32_16x16x32_bf16 v[184:187], a[104:107], a[0:3], v[184:187]
buffer_load_dwordx4 v23, s[60:63], s64 offen lds
v_mfma_f32_16x16x32_bf16 v[184:187], a[108:111], a[4:7], v[184:187]
ds_read_b64_tr_b16 a[98:99], v20 offset:256
v_mfma_f32_16x16x32_bf16 v[192:195], a[108:111], a[12:15], v[192:195]
ds_read_b64_tr_b16 a[100:101], v20 offset:2048
v_mfma_f32_16x16x32_bf16 v[192:195], a[104:107], a[8:11], v[192:195]
s_add_u32 s17, s78, .-L_pc+6144
ds_read_b64_tr_b16 a[102:103], v20 offset:2304
v_mfma_f32_16x16x32_bf16 v[200:203], a[104:107], a[16:19], v[200:203]
buffer_load_dword a252, v16, s[88:91], s17 offen
v_mfma_f32_16x16x32_bf16 v[200:203], a[108:111], a[20:23], v[200:203]
v_mfma_f32_16x16x32_bf16 v[208:211], a[108:111], a[28:31], v[208:211]
v_mfma_f32_16x16x32_bf16 v[208:211], a[104:107], a[24:27], v[208:211]
ds_read_b64_tr_b16 a[104:105], v4 offset:0
v_mfma_f32_16x16x32_bf16 v[212:215], a[112:115], a[24:27], v[212:215]
s_add_u32 m0, s77, 133120
ds_read_b64_tr_b16 a[106:107], v4 offset:1024
v_mfma_f32_16x16x32_bf16 v[212:215], a[116:119], a[28:31], v[212:215]
s_add_u32 s64, s71, 6356992
ds_read_b64_tr_b16 a[108:109], v4 offset:8192
v_mfma_f32_16x16x32_bf16 v[204:207], a[116:119], a[20:23], v[204:207]
buffer_load_dwordx4 v15, s[56:59], s64 offen lds
v_mfma_f32_16x16x32_bf16 v[204:207], a[112:115], a[16:19], v[204:207]
ds_read_b64_tr_b16 a[110:111], v4 offset:9216
v_mfma_f32_16x16x32_bf16 v[196:199], a[112:115], a[8:11], v[196:199]
v_mfma_f32_16x16x32_bf16 v[196:199], a[116:119], a[12:15], v[196:199]
v_mfma_f32_16x16x32_bf16 v[188:191], a[116:119], a[4:7], v[188:191]
v_mfma_f32_16x16x32_bf16 v[188:191], a[112:115], a[0:3], v[188:191]
ds_read_b64_tr_b16 a[112:113], v5 offset:0
v_mfma_f32_16x16x32_bf16 v[216:219], a[0:3], a[72:75], v[216:219]
ds_read_b64_tr_b16 a[114:115], v5 offset:1024
v_mfma_f32_16x16x32_bf16 v[216:219], a[4:7], a[76:79], v[216:219]
s_add_u32 m0, s78, 155648
ds_read_b64_tr_b16 a[116:117], v5 offset:8192
v_mfma_f32_16x16x32_bf16 v[224:227], a[12:15], a[76:79], v[224:227]
s_add_u32 s64, s75, 4722688
ds_read_b64_tr_b16 a[118:119], v5 offset:9216
v_mfma_f32_16x16x32_bf16 v[224:227], a[8:11], a[72:75], v[224:227]
buffer_load_dwordx4 v23, s[60:63], s64 offen lds
v_mfma_f32_16x16x32_bf16 v[232:235], a[16:19], a[72:75], v[232:235]
v_mfma_f32_16x16x32_bf16 v[232:235], a[20:23], a[76:79], v[232:235]
v_mfma_f32_16x16x32_bf16 v[240:243], a[28:31], a[76:79], v[240:243]
v_mfma_f32_16x16x32_bf16 v[240:243], a[24:27], a[72:75], v[240:243]
ds_read_b64_tr_b16 a[72:73], v6 offset:0
v_mfma_f32_16x16x32_bf16 v[244:247], a[24:27], a[80:83], v[244:247]
s_add_u32 s65, s79, 30720
ds_read_b64_tr_b16 a[74:75], v6 offset:1024
v_mfma_f32_16x16x32_bf16 v[244:247], a[28:31], a[84:87], v[244:247]
buffer_store_dwordx4 a[228:231], v16, s[44:47], s65 offen sc1
v_mfma_f32_16x16x32_bf16 v[236:239], a[20:23], a[84:87], v[236:239]
s_add_u32 m0, s77, 134144
ds_read_b64_tr_b16 a[76:77], v6 offset:8192
v_mfma_f32_16x16x32_bf16 v[236:239], a[16:19], a[80:83], v[236:239]
s_add_u32 s64, s71, 6389760
ds_read_b64_tr_b16 a[78:79], v6 offset:9216
v_mfma_f32_16x16x32_bf16 v[228:231], a[8:11], a[80:83], v[228:231]
buffer_load_dwordx4 v15, s[56:59], s64 offen lds
v_mfma_f32_16x16x32_bf16 v[228:231], a[12:15], a[84:87], v[228:231]
v_mfma_f32_16x16x32_bf16 v[220:223], a[4:7], a[84:87], v[220:223]
v_mfma_f32_16x16x32_bf16 v[220:223], a[0:3], a[80:83], v[220:223]
s_waitcnt lgkmcnt(4)
ds_read_b64_tr_b16 a[80:81], v7 offset:0
v_mfma_f32_16x16x32_bf16 v[152:155], a[88:91], a[0:3], v[152:155]
ds_read_b64_tr_b16 a[82:83], v7 offset:1024
v_mfma_f32_16x16x32_bf16 v[152:155], a[92:95], a[4:7], v[152:155]
ds_read_b64_tr_b16 a[84:85], v7 offset:8192
v_mfma_f32_16x16x32_bf16 v[160:163], a[92:95], a[12:15], v[160:163]
ds_read_b64_tr_b16 a[86:87], v7 offset:9216
v_mfma_f32_16x16x32_bf16 v[160:163], a[88:91], a[8:11], v[160:163]
v_mfma_f32_16x16x32_bf16 v[168:171], a[88:91], a[16:19], v[168:171]
v_mfma_f32_16x16x32_bf16 v[168:171], a[92:95], a[20:23], v[168:171]
v_mfma_f32_16x16x32_bf16 v[176:179], a[92:95], a[28:31], v[176:179]
s_add_u32 m0, s76, 0
v_mfma_f32_16x16x32_bf16 v[176:179], a[88:91], a[24:27], v[176:179]
s_add_u32 s64, s72, 1536
ds_read_b64_tr_b16 a[88:89], v8 offset:0
v_mfma_f32_16x16x32_bf16 v[180:183], a[96:99], a[24:27], v[180:183]
buffer_load_dwordx4 v12, s[48:51], s64 offen lds
v_mfma_f32_16x16x32_bf16 v[180:183], a[100:103], a[28:31], v[180:183]
ds_read_b64_tr_b16 a[90:91], v8 offset:1024
v_mfma_f32_16x16x32_bf16 v[172:175], a[100:103], a[20:23], v[172:175]
ds_read_b64_tr_b16 a[92:93], v8 offset:8192
v_mfma_f32_16x16x32_bf16 v[172:175], a[96:99], a[16:19], v[172:175]
s_add_u32 m0, s76, 1024
ds_read_b64_tr_b16 a[94:95], v8 offset:9216
v_mfma_f32_16x16x32_bf16 v[164:167], a[96:99], a[8:11], v[164:167]
s_add_u32 s64, s72, 17920
v_mfma_f32_16x16x32_bf16 v[164:167], a[100:103], a[12:15], v[164:167]
buffer_load_dwordx4 v13, s[48:51], s64 offen lds
v_mfma_f32_16x16x32_bf16 v[156:159], a[100:103], a[4:7], v[156:159]
v_mfma_f32_16x16x32_bf16 v[156:159], a[96:99], a[0:3], v[156:159]
ds_read_b64_tr_b16 a[96:97], v9 offset:0
v_mfma_f32_16x16x32_bf16 v[24:27], a[104:107], a[0:3], v[24:27]
s_add_u32 m0, s76, 2048
ds_read_b64_tr_b16 a[98:99], v9 offset:1024
v_mfma_f32_16x16x32_bf16 v[24:27], a[108:111], a[4:7], v[24:27]
s_add_u32 s64, s72, 132608
ds_read_b64_tr_b16 a[100:101], v9 offset:8192
v_mfma_f32_16x16x32_bf16 v[40:43], a[108:111], a[12:15], v[40:43]
buffer_load_dwordx4 v12, s[48:51], s64 offen lds
v_mfma_f32_16x16x32_bf16 v[40:43], a[104:107], a[8:11], v[40:43]
ds_read_b64_tr_b16 a[102:103], v9 offset:9216
v_mfma_f32_16x16x32_bf16 v[56:59], a[104:107], a[16:19], v[56:59]
v_mfma_f32_16x16x32_bf16 v[56:59], a[108:111], a[20:23], v[56:59]
s_add_u32 m0, s76, 3072
v_mfma_f32_16x16x32_bf16 v[72:75], a[108:111], a[28:31], v[72:75]
s_waitcnt vmcnt(13)
s_add_u32 s64, s72, 148992
ds_read_b128 a[32:35], v2 offset:32768
v_mfma_f32_16x16x32_bf16 v[72:75], a[104:107], a[24:27], v[72:75]
buffer_load_dwordx4 v13, s[48:51], s64 offen lds
v_mfma_f32_16x16x32_bf16 v[136:139], a[112:115], a[24:27], v[136:139]
ds_read_b128 a[36:39], v3 offset:32768
v_mfma_f32_16x16x32_bf16 v[136:139], a[116:119], a[28:31], v[136:139]
ds_read_b128 a[40:43], v2 offset:34816
v_mfma_f32_16x16x32_bf16 v[120:123], a[116:119], a[20:23], v[120:123]
s_add_u32 m0, s76, 4096
ds_read_b128 a[44:47], v3 offset:34816
v_mfma_f32_16x16x32_bf16 v[120:123], a[112:115], a[16:19], v[120:123]
s_add_u32 s64, s73, 1536
ds_read_b128 a[48:51], v2 offset:36864
v_mfma_f32_16x16x32_bf16 v[104:107], a[112:115], a[8:11], v[104:107]
buffer_load_dwordx4 v12, s[48:51], s64 offen lds
v_mfma_f32_16x16x32_bf16 v[104:107], a[116:119], a[12:15], v[104:107]
ds_read_b128 a[52:55], v3 offset:36864
v_mfma_f32_16x16x32_bf16 v[88:91], a[116:119], a[4:7], v[88:91]
ds_read_b128 a[56:59], v2 offset:38912
v_mfma_f32_16x16x32_bf16 v[88:91], a[112:115], a[0:3], v[88:91]
s_waitcnt lgkmcnt(7)
s_add_u32 m0, s76, 5120
ds_read_b128 a[60:63], v3 offset:38912
v_mfma_f32_16x16x32_bf16 v[28:31], a[72:75], a[0:3], v[28:31]
s_add_u32 s64, s73, 17920
ds_read_b64_tr_b16 a[104:105], v10 offset:0
v_mfma_f32_16x16x32_bf16 v[28:31], a[76:79], a[4:7], v[28:31]
buffer_load_dwordx4 v13, s[48:51], s64 offen lds
v_mfma_f32_16x16x32_bf16 v[44:47], a[76:79], a[12:15], v[44:47]
ds_read_b64_tr_b16 a[106:107], v10 offset:1024
v_mfma_f32_16x16x32_bf16 v[44:47], a[72:75], a[8:11], v[44:47]
ds_read_b64_tr_b16 a[108:109], v10 offset:8192
v_mfma_f32_16x16x32_bf16 v[60:63], a[72:75], a[16:19], v[60:63]
s_add_u32 m0, s76, 6144
ds_read_b64_tr_b16 a[110:111], v10 offset:9216
v_mfma_f32_16x16x32_bf16 v[60:63], a[76:79], a[20:23], v[60:63]
s_add_u32 s64, s73, 132608
ds_read_b64_tr_b16 a[112:113], v11 offset:0
v_mfma_f32_16x16x32_bf16 v[76:79], a[76:79], a[28:31], v[76:79]
buffer_load_dwordx4 v12, s[48:51], s64 offen lds
v_mfma_f32_16x16x32_bf16 v[76:79], a[72:75], a[24:27], v[76:79]
ds_read_b64_tr_b16 a[114:115], v11 offset:1024
v_mfma_f32_16x16x32_bf16 v[140:143], a[80:83], a[24:27], v[140:143]
s_add_u32 m0, s76, 7168
ds_read_b64_tr_b16 a[116:117], v11 offset:8192
v_mfma_f32_16x16x32_bf16 v[140:143], a[84:87], a[28:31], v[140:143]
s_add_u32 s64, s73, 148992
ds_read_b64_tr_b16 a[118:119], v11 offset:9216
v_mfma_f32_16x16x32_bf16 v[124:127], a[84:87], a[20:23], v[124:127]
v_readfirstlane_b32 vcc_lo, v1
s_nop 0
s_cmp_lt_u32 vcc_lo, s81
s_cbranch_scc1 L_spin_1
L_spinbk_2:
v_mfma_f32_16x16x32_bf16 v[124:127], a[80:83], a[16:19], v[124:127]
s_add_u32 s65, s79, 31744
buffer_load_dwordx4 v13, s[48:51], s64 offen lds
v_mfma_f32_16x16x32_bf16 v[108:111], a[80:83], a[8:11], v[108:111]
buffer_store_dwordx4 a[232:235], v16, s[44:47], s65 offen sc1
v_mfma_f32_16x16x32_bf16 v[108:111], a[84:87], a[12:15], v[108:111]
v_mfma_f32_16x16x32_bf16 v[92:95], a[84:87], a[4:7], v[92:95]
s_add_u32 s52, s28, 59768832
s_addc_u32 s53, s29, 0
s_mov_b32 s54, 16384
v_mfma_f32_16x16x32_bf16 v[92:95], a[80:83], a[0:3], v[92:95]
v_mfma_f32_16x16x32_bf16 v[32:35], a[88:91], a[0:3], v[32:35]
v_mfma_f32_16x16x32_bf16 v[32:35], a[92:95], a[4:7], v[32:35]
v_mfma_f32_16x16x32_bf16 v[48:51], a[92:95], a[12:15], v[48:51]
s_waitcnt lgkmcnt(0)
s_barrier
v_mfma_f32_16x16x32_bf16 v[48:51], a[88:91], a[8:11], v[48:51]
s_add_u32 m0, s77, 65536
ds_read_b64_tr_b16 a[72:73], v19 offset:36864
v_mfma_f32_16x16x32_bf16 v[64:67], a[88:91], a[16:19], v[64:67]
s_add_u32 s64, s71, 6815744
ds_read_b64_tr_b16 a[74:75], v19 offset:37120
v_mfma_f32_16x16x32_bf16 v[64:67], a[92:95], a[20:23], v[64:67]
buffer_load_dwordx4 v14, s[56:59], s64 offen lds
v_mfma_f32_16x16x32_bf16 v[80:83], a[92:95], a[28:31], v[80:83]
ds_read_b64_tr_b16 a[76:77], v19 offset:38912
v_mfma_f32_16x16x32_bf16 v[80:83], a[88:91], a[24:27], v[80:83]
ds_read_b64_tr_b16 a[78:79], v19 offset:39168
v_mfma_f32_16x16x32_bf16 v[144:147], a[96:99], a[24:27], v[144:147]
ds_read_b64_tr_b16 a[80:81], v20 offset:36864
v_mfma_f32_16x16x32_bf16 v[144:147], a[100:103], a[28:31], v[144:147]
ds_read_b64_tr_b16 a[82:83], v20 offset:37120
v_mfma_f32_16x16x32_bf16 v[128:131], a[100:103], a[20:23], v[128:131]
ds_read_b64_tr_b16 a[84:85], v20 offset:38912
v_mfma_f32_16x16x32_bf16 v[128:131], a[96:99], a[16:19], v[128:131]
ds_read_b64_tr_b16 a[86:87], v20 offset:39168
v_mfma_f32_16x16x32_bf16 v[112:115], a[96:99], a[8:11], v[112:115]
s_add_u32 m0, s78, 81920
ds_read_b64_tr_b16 a[88:89], v19 offset:40960
v_mfma_f32_16x16x32_bf16 v[112:115], a[100:103], a[12:15], v[112:115]
s_add_u32 s64, s75, 5111808
ds_read_b64_tr_b16 a[90:91], v19 offset:41216
v_mfma_f32_16x16x32_bf16 v[96:99], a[100:103], a[4:7], v[96:99]
buffer_load_dwordx4 v23, s[60:63], s64 offen lds
v_mfma_f32_16x16x32_bf16 v[96:99], a[96:99], a[0:3], v[96:99]
ds_read_b64_tr_b16 a[92:93], v19 offset:43008
v_mfma_f32_16x16x32_bf16 v[36:39], a[104:107], a[0:3], v[36:39]
ds_read_b64_tr_b16 a[94:95], v19 offset:43264
v_mfma_f32_16x16x32_bf16 v[36:39], a[108:111], a[4:7], v[36:39]
ds_read_b64_tr_b16 a[96:97], v20 offset:40960
v_mfma_f32_16x16x32_bf16 v[52:55], a[108:111], a[12:15], v[52:55]
ds_read_b64_tr_b16 a[98:99], v20 offset:41216
v_mfma_f32_16x16x32_bf16 v[52:55], a[104:107], a[8:11], v[52:55]
ds_read_b64_tr_b16 a[100:101], v20 offset:43008
v_mfma_f32_16x16x32_bf16 v[68:71], a[104:107], a[16:19], v[68:71]
ds_read_b64_tr_b16 a[102:103], v20 offset:43264
v_mfma_f32_16x16x32_bf16 v[68:71], a[108:111], a[20:23], v[68:71]
s_add_u32 m0, s77, 66560
v_mfma_f32_16x16x32_bf16 v[84:87], a[108:111], a[28:31], v[84:87]
s_add_u32 s64, s71, 6848512
v_mfma_f32_16x16x32_bf16 v[84:87], a[104:107], a[24:27], v[84:87]
buffer_load_dwordx4 v14, s[56:59], s64 offen lds
v_mfma_f32_16x16x32_bf16 v[148:151], a[112:115], a[24:27], v[148:151]
ds_read_b64_tr_b16 a[104:105], v19 offset:32768
v_mfma_f32_16x16x32_bf16 v[148:151], a[116:119], a[28:31], v[148:151]
ds_read_b64_tr_b16 a[106:107], v19 offset:33024
v_mfma_f32_16x16x32_bf16 v[132:135], a[116:119], a[20:23], v[132:135]
ds_read_b64_tr_b16 a[108:109], v19 offset:34816
v_mfma_f32_16x16x32_bf16 v[132:135], a[112:115], a[16:19], v[132:135]
ds_read_b64_tr_b16 a[110:111], v19 offset:35072
v_mfma_f32_16x16x32_bf16 v[116:119], a[112:115], a[8:11], v[116:119]
v_mfma_f32_16x16x32_bf16 v[116:119], a[116:119], a[12:15], v[116:119]
v_mfma_f32_16x16x32_bf16 v[100:103], a[116:119], a[4:7], v[100:103]
s_add_u32 m0, s78, 86016
v_mfma_f32_16x16x32_bf16 v[100:103], a[112:115], a[0:3], v[100:103]
s_waitcnt lgkmcnt(4)
s_add_u32 s64, s75, 5113856
ds_read_b64_tr_b16 a[112:113], v20 offset:32768
v_mfma_f32_16x16x32_bf16 v[184:187], a[72:75], a[32:35], v[184:187]
buffer_load_dwordx4 v23, s[60:63], s64 offen lds
v_mfma_f32_16x16x32_bf16 v[184:187], a[76:79], a[36:39], v[184:187]
ds_read_b64_tr_b16 a[114:115], v20 offset:33024
v_mfma_f32_16x16x32_bf16 v[192:195], a[76:79], a[44:47], v[192:195]
ds_read_b64_tr_b16 a[116:117], v20 offset:34816
v_mfma_f32_16x16x32_bf16 v[192:195], a[72:75], a[40:43], v[192:195]
ds_read_b64_tr_b16 a[118:119], v20 offset:35072
v_mfma_f32_16x16x32_bf16 v[200:203], a[72:75], a[48:51], v[200:203]
v_mfma_f32_16x16x32_bf16 v[200:203], a[76:79], a[52:55], v[200:203]
v_mfma_f32_16x16x32_bf16 v[208:211], a[76:79], a[60:63], v[208:211]
v_mfma_f32_16x16x32_bf16 v[208:211], a[72:75], a[56:59], v[208:211]
ds_read_b64_tr_b16 a[72:73], v4 offset:32768
v_mfma_f32_16x16x32_bf16 v[212:215], a[80:83], a[56:59], v[212:215]
s_add_u32 m0, s77, 67584
ds_read_b64_tr_b16 a[74:75], v4 offset:33792
v_mfma_f32_16x16x32_bf16 v[212:215], a[84:87], a[60:63], v[212:215]
s_add_u32 s64, s71, 6881280
ds_read_b64_tr_b16 a[76:77], v4 offset:40960
v_mfma_f32_16x16x32_bf16 v[204:207], a[84:87], a[52:55], v[204:207]
buffer_load_dwordx4 v15, s[56:59], s64 offen lds
v_mfma_f32_16x16x32_bf16 v[204:207], a[80:83], a[48:51], v[204:207]
s_add_u32 s65, s79, 15360
ds_read_b64_tr_b16 a[78:79], v4 offset:41984
v_mfma_f32_16x16x32_bf16 v[196:199], a[80:83], a[40:43], v[196:199]
buffer_store_dwordx4 a[236:239], v16, s[44:47], s65 offen sc1
v_mfma_f32_16x16x32_bf16 v[196:199], a[84:87], a[44:47], v[196:199]
v_mfma_f32_16x16x32_bf16 v[188:191], a[84:87], a[36:39], v[188:191]
v_mfma_f32_16x16x32_bf16 v[188:191], a[80:83], a[32:35], v[188:191]
ds_read_b64_tr_b16 a[80:81], v5 offset:32768
v_mfma_f32_16x16x32_bf16 v[216:219], a[32:35], a[88:91], v[216:219]
ds_read_b64_tr_b16 a[82:83], v5 offset:33792
v_mfma_f32_16x16x32_bf16 v[216:219], a[36:39], a[92:95], v[216:219]
s_add_u32 m0, s78, 90112
ds_read_b64_tr_b16 a[84:85], v5 offset:40960
v_mfma_f32_16x16x32_bf16 v[224:227], a[44:47], a[92:95], v[224:227]
s_add_u32 s64, s75, 5115904
ds_read_b64_tr_b16 a[86:87], v5 offset:41984
v_mfma_f32_16x16x32_bf16 v[224:227], a[40:43], a[88:91], v[224:227]
buffer_load_dwordx4 v23, s[60:63], s64 offen lds
v_mfma_f32_16x16x32_bf16 v[232:235], a[48:51], a[88:91], v[232:235]
v_mfma_f32_16x16x32_bf16 v[232:235], a[52:55], a[92:95], v[232:235]
v_mfma_f32_16x16x32_bf16 v[240:243], a[60:63], a[92:95], v[240:243]
v_mfma_f32_16x16x32_bf16 v[240:243], a[56:59], a[88:91], v[240:243]
ds_read_b64_tr_b16 a[88:89], v6 offset:32768
v_mfma_f32_16x16x32_bf16 v[244:247], a[56:59], a[96:99], v[244:247]
ds_read_b64_tr_b16 a[90:91], v6 offset:33792
v_mfma_f32_16x16x32_bf16 v[244:247], a[60:63], a[100:103], v[244:247]
ds_read_b64_tr_b16 a[92:93], v6 offset:40960
v_add_u32 v19, 0x8000, v19
v_mfma_f32_16x16x32_bf16 v[236:239], a[52:55], a[100:103], v[236:239]
s_add_u32 m0, s77, 68608
ds_read_b64_tr_b16 a[94:95], v6 offset:41984
v_mfma_f32_16x16x32_bf16 v[236:239], a[48:51], a[96:99], v[236:239]
s_add_u32 s64, s71, 6914048
v_mfma_f32_16x16x32_bf16 v[228:231], a[40:43], a[96:99], v[228:231]
buffer_load_dwordx4 v15, s[56:59], s64 offen lds
v_mfma_f32_16x16x32_bf16 v[228:231], a[44:47], a[100:103], v[228:231]
v_mfma_f32_16x16x32_bf16 v[220:223], a[36:39], a[100:103], v[220:223]
v_mfma_f32_16x16x32_bf16 v[220:223], a[32:35], a[96:99], v[220:223]
s_waitcnt lgkmcnt(4)
ds_read_b64_tr_b16 a[96:97], v7 offset:32768
v_mfma_f32_16x16x32_bf16 v[152:155], a[104:107], a[32:35], v[152:155]
ds_read_b64_tr_b16 a[98:99], v7 offset:33792
v_mfma_f32_16x16x32_bf16 v[152:155], a[108:111], a[36:39], v[152:155]
ds_read_b64_tr_b16 a[100:101], v7 offset:40960
v_add_u32 v20, 0x8000, v20
v_mfma_f32_16x16x32_bf16 v[160:163], a[108:111], a[44:47], v[160:163]
ds_read_b64_tr_b16 a[102:103], v7 offset:41984
v_mfma_f32_16x16x32_bf16 v[160:163], a[104:107], a[40:43], v[160:163]
v_mfma_f32_16x16x32_bf16 v[168:171], a[104:107], a[48:51], v[168:171]
v_mfma_f32_16x16x32_bf16 v[168:171], a[108:111], a[52:55], v[168:171]
v_mfma_f32_16x16x32_bf16 v[176:179], a[108:111], a[60:63], v[176:179]
s_add_u32 m0, s76, 32768
v_mfma_f32_16x16x32_bf16 v[176:179], a[104:107], a[56:59], v[176:179]
s_add_u32 s64, s72, 1664
ds_read_b64_tr_b16 a[104:105], v8 offset:32768
v_mfma_f32_16x16x32_bf16 v[180:183], a[112:115], a[56:59], v[180:183]
buffer_load_dwordx4 v12, s[48:51], s64 offen lds
v_mfma_f32_16x16x32_bf16 v[180:183], a[116:119], a[60:63], v[180:183]
ds_read_b64_tr_b16 a[106:107], v8 offset:33792
v_add_u32 v4, 0x8000, v4
v_mfma_f32_16x16x32_bf16 v[172:175], a[116:119], a[52:55], v[172:175]
ds_read_b64_tr_b16 a[108:109], v8 offset:40960
v_mfma_f32_16x16x32_bf16 v[172:175], a[112:115], a[48:51], v[172:175]
s_add_u32 m0, s76, 33792
ds_read_b64_tr_b16 a[110:111], v8 offset:41984
v_mfma_f32_16x16x32_bf16 v[164:167], a[112:115], a[40:43], v[164:167]
s_add_u32 s64, s72, 18048
v_mfma_f32_16x16x32_bf16 v[164:167], a[116:119], a[44:47], v[164:167]
buffer_load_dwordx4 v13, s[48:51], s64 offen lds
v_mfma_f32_16x16x32_bf16 v[156:159], a[116:119], a[36:39], v[156:159]
v_mfma_f32_16x16x32_bf16 v[156:159], a[112:115], a[32:35], v[156:159]
ds_read_b64_tr_b16 a[112:113], v9 offset:32768
v_mfma_f32_16x16x32_bf16 v[24:27], a[72:75], a[32:35], v[24:27]
s_add_u32 m0, s76, 34816
ds_read_b64_tr_b16 a[114:115], v9 offset:33792
v_mfma_f32_16x16x32_bf16 v[24:27], a[76:79], a[36:39], v[24:27]
s_add_u32 s64, s72, 132736
ds_read_b64_tr_b16 a[116:117], v9 offset:40960
v_add_u32 v5, 0x8000, v5
v_mfma_f32_16x16x32_bf16 v[40:43], a[76:79], a[44:47], v[40:43]
buffer_load_dwordx4 v12, s[48:51], s64 offen lds
v_mfma_f32_16x16x32_bf16 v[40:43], a[72:75], a[40:43], v[40:43]
ds_read_b64_tr_b16 a[118:119], v9 offset:41984
v_mfma_f32_16x16x32_bf16 v[56:59], a[72:75], a[48:51], v[56:59]
v_mfma_f32_16x16x32_bf16 v[56:59], a[76:79], a[52:55], v[56:59]
s_add_u32 m0, s76, 35840
v_mfma_f32_16x16x32_bf16 v[72:75], a[76:79], a[60:63], v[72:75]
s_waitcnt vmcnt(12)
s_add_u32 s64, s72, 149120
ds_read_b128 a[0:3], v2 offset:0
v_mfma_f32_16x16x32_bf16 v[72:75], a[72:75], a[56:59], v[72:75]
buffer_load_dwordx4 v13, s[48:51], s64 offen lds
v_mfma_f32_16x16x32_bf16 v[136:139], a[80:83], a[56:59], v[136:139]
ds_read_b128 a[4:7], v3 offset:0
v_mfma_f32_16x16x32_bf16 v[136:139], a[84:87], a[60:63], v[136:139]
ds_read_b128 a[8:11], v2 offset:2048
v_add_u32 v6, 0x8000, v6
v_mfma_f32_16x16x32_bf16 v[120:123], a[84:87], a[52:55], v[120:123]
s_add_u32 m0, s76, 36864
ds_read_b128 a[12:15], v3 offset:2048
v_mfma_f32_16x16x32_bf16 v[120:123], a[80:83], a[48:51], v[120:123]
s_add_u32 s64, s73, 1664
ds_read_b128 a[16:19], v2 offset:4096
v_mfma_f32_16x16x32_bf16 v[104:107], a[80:83], a[40:43], v[104:107]
buffer_load_dwordx4 v12, s[48:51], s64 offen lds
v_mfma_f32_16x16x32_bf16 v[104:107], a[84:87], a[44:47], v[104:107]
ds_read_b128 a[20:23], v3 offset:4096
v_mfma_f32_16x16x32_bf16 v[88:91], a[84:87], a[36:39], v[88:91]
buffer_store_dwordx4 a[240:243], v16, s[44:47], s74 offen sc1
v_mfma_f32_16x16x32_bf16 v[88:91], a[80:83], a[32:35], v[88:91]
s_waitcnt lgkmcnt(6)
s_add_u32 m0, s76, 37888
ds_read_b128 a[24:27], v2 offset:6144
v_mfma_f32_16x16x32_bf16 v[28:31], a[88:91], a[32:35], v[28:31]
s_add_u32 s64, s73, 18048
ds_read_b128 a[28:31], v3 offset:6144
v_mfma_f32_16x16x32_bf16 v[28:31], a[92:95], a[36:39], v[28:31]
buffer_load_dwordx4 v13, s[48:51], s64 offen lds
v_mfma_f32_16x16x32_bf16 v[44:47], a[92:95], a[44:47], v[44:47]
ds_read_b64_tr_b16 a[72:73], v10 offset:32768
v_add_u32 v7, 0x8000, v7
v_mfma_f32_16x16x32_bf16 v[44:47], a[88:91], a[40:43], v[44:47]
ds_read_b64_tr_b16 a[74:75], v10 offset:33792
v_mfma_f32_16x16x32_bf16 v[60:63], a[88:91], a[48:51], v[60:63]
s_add_u32 m0, s76, 38912
ds_read_b64_tr_b16 a[76:77], v10 offset:40960
v_mfma_f32_16x16x32_bf16 v[60:63], a[92:95], a[52:55], v[60:63]
s_add_u32 s64, s73, 132736
ds_read_b64_tr_b16 a[78:79], v10 offset:41984
v_mfma_f32_16x16x32_bf16 v[76:79], a[92:95], a[60:63], v[76:79]
buffer_load_dwordx4 v12, s[48:51], s64 offen lds
v_mfma_f32_16x16x32_bf16 v[76:79], a[88:91], a[56:59], v[76:79]
ds_read_b64_tr_b16 a[80:81], v11 offset:32768
v_mfma_f32_16x16x32_bf16 v[140:143], a[96:99], a[56:59], v[140:143]
ds_read_b64_tr_b16 a[82:83], v11 offset:33792
v_mfma_f32_16x16x32_bf16 v[140:143], a[100:103], a[60:63], v[140:143]
s_add_u32 m0, s76, 39936
ds_read_b64_tr_b16 a[84:85], v11 offset:40960
v_add_u32 v8, 0x8000, v8
v_mfma_f32_16x16x32_bf16 v[124:127], a[100:103], a[52:55], v[124:127]
s_add_u32 s64, s73, 149120
ds_read_b64_tr_b16 a[86:87], v11 offset:41984
v_mfma_f32_16x16x32_bf16 v[124:127], a[96:99], a[48:51], v[124:127]
buffer_load_dwordx4 v13, s[48:51], s64 offen lds
v_mfma_f32_16x16x32_bf16 v[108:111], a[96:99], a[40:43], v[108:111]
v_mfma_f32_16x16x32_bf16 v[108:111], a[100:103], a[44:47], v[108:111]
v_mfma_f32_16x16x32_bf16 v[92:95], a[100:103], a[36:39], v[92:95]
v_add_u32 v9, 0x8000, v9
v_add_u32 v10, 0x8000, v10
v_mfma_f32_16x16x32_bf16 v[92:95], a[96:99], a[32:35], v[92:95]
v_add_u32 v11, 0x8000, v11
v_mfma_f32_16x16x32_bf16 v[32:35], a[104:107], a[32:35], v[32:35]
v_mfma_f32_16x16x32_bf16 v[32:35], a[108:111], a[36:39], v[32:35]
v_mfma_f32_16x16x32_bf16 v[48:51], a[108:111], a[44:47], v[48:51]
s_waitcnt lgkmcnt(0)
s_barrier
v_mfma_f32_16x16x32_bf16 v[48:51], a[104:107], a[40:43], v[48:51]
s_add_u32 m0, s77, 98304
ds_read_b64_tr_b16 a[88:89], v19 offset:36864
v_mfma_f32_16x16x32_bf16 v[64:67], a[104:107], a[48:51], v[64:67]
s_add_u32 s64, s71, 7340032
ds_read_b64_tr_b16 a[90:91], v19 offset:37120
v_mfma_f32_16x16x32_bf16 v[64:67], a[108:111], a[52:55], v[64:67]
buffer_load_dwordx4 v14, s[56:59], s64 offen lds
v_mfma_f32_16x16x32_bf16 v[80:83], a[108:111], a[60:63], v[80:83]
ds_read_b64_tr_b16 a[92:93], v19 offset:38912
v_mfma_f32_16x16x32_bf16 v[80:83], a[104:107], a[56:59], v[80:83]
ds_read_b64_tr_b16 a[94:95], v19 offset:39168
v_mfma_f32_16x16x32_bf16 v[144:147], a[112:115], a[56:59], v[144:147]
ds_read_b64_tr_b16 a[96:97], v20 offset:36864
v_mfma_f32_16x16x32_bf16 v[144:147], a[116:119], a[60:63], v[144:147]
ds_read_b64_tr_b16 a[98:99], v20 offset:37120
v_mfma_f32_16x16x32_bf16 v[128:131], a[116:119], a[52:55], v[128:131]
ds_read_b64_tr_b16 a[100:101], v20 offset:38912
v_mfma_f32_16x16x32_bf16 v[128:131], a[112:115], a[48:51], v[128:131]
ds_read_b64_tr_b16 a[102:103], v20 offset:39168
v_mfma_f32_16x16x32_bf16 v[112:115], a[112:115], a[40:43], v[112:115]
s_add_u32 m0, s78, 114688
ds_read_b64_tr_b16 a[104:105], v19 offset:40960
v_mfma_f32_16x16x32_bf16 v[112:115], a[116:119], a[44:47], v[112:115]
s_add_u32 s64, s75, 5505024
ds_read_b64_tr_b16 a[106:107], v19 offset:41216
v_mfma_f32_16x16x32_bf16 v[96:99], a[116:119], a[36:39], v[96:99]
buffer_load_dwordx4 v23, s[60:63], s64 offen lds
v_mfma_f32_16x16x32_bf16 v[96:99], a[112:115], a[32:35], v[96:99]
ds_read_b64_tr_b16 a[108:109], v19 offset:43008
v_mfma_f32_16x16x32_bf16 v[36:39], a[72:75], a[32:35], v[36:39]
ds_read_b64_tr_b16 a[110:111], v19 offset:43264
v_mfma_f32_16x16x32_bf16 v[36:39], a[76:79], a[36:39], v[36:39]
ds_read_b64_tr_b16 a[112:113], v20 offset:40960
v_mfma_f32_16x16x32_bf16 v[52:55], a[76:79], a[44:47], v[52:55]
ds_read_b64_tr_b16 a[114:115], v20 offset:41216
v_mfma_f32_16x16x32_bf16 v[52:55], a[72:75], a[40:43], v[52:55]
ds_read_b64_tr_b16 a[116:117], v20 offset:43008
v_mfma_f32_16x16x32_bf16 v[68:71], a[72:75], a[48:51], v[68:71]
ds_read_b64_tr_b16 a[118:119], v20 offset:43264
v_mfma_f32_16x16x32_bf16 v[68:71], a[76:79], a[52:55], v[68:71]
s_add_u32 m0, s77, 99328
v_mfma_f32_16x16x32_bf16 v[84:87], a[76:79], a[60:63], v[84:87]
s_add_u32 s64, s71, 7372800
v_mfma_f32_16x16x32_bf16 v[84:87], a[72:75], a[56:59], v[84:87]
buffer_load_dwordx4 v14, s[56:59], s64 offen lds
v_mfma_f32_16x16x32_bf16 v[148:151], a[80:83], a[56:59], v[148:151]
ds_read_b64_tr_b16 a[72:73], v19 offset:32768
v_mfma_f32_16x16x32_bf16 v[148:151], a[84:87], a[60:63], v[148:151]
ds_read_b64_tr_b16 a[74:75], v19 offset:33024
v_mfma_f32_16x16x32_bf16 v[132:135], a[84:87], a[52:55], v[132:135]
ds_read_b64_tr_b16 a[76:77], v19 offset:34816
v_mfma_f32_16x16x32_bf16 v[132:135], a[80:83], a[48:51], v[132:135]
ds_read_b64_tr_b16 a[78:79], v19 offset:35072
v_mfma_f32_16x16x32_bf16 v[116:119], a[80:83], a[40:43], v[116:119]
v_mfma_f32_16x16x32_bf16 v[116:119], a[84:87], a[44:47], v[116:119]
v_mfma_f32_16x16x32_bf16 v[100:103], a[84:87], a[36:39], v[100:103]
s_add_u32 m0, s78, 118784
v_mfma_f32_16x16x32_bf16 v[100:103], a[80:83], a[32:35], v[100:103]
s_waitcnt lgkmcnt(4)
s_add_u32 s64, s75, 5507072
ds_read_b64_tr_b16 a[80:81], v20 offset:32768
v_mfma_f32_16x16x32_bf16 v[184:187], a[88:91], a[0:3], v[184:187]
s_lshl_b32 s66, s30, 30
buffer_load_dwordx4 v23, s[60:63], s64 offen lds
v_mfma_f32_16x16x32_bf16 v[184:187], a[92:95], a[4:7], v[184:187]
ds_read_b64_tr_b16 a[82:83], v20 offset:33024
v_lshl_add_u32 v1, v0, 24, s66
v_mfma_f32_16x16x32_bf16 v[192:195], a[92:95], a[12:15], v[192:195]
s_lshl_b32 s70, s31, 8
ds_read_b64_tr_b16 a[84:85], v20 offset:34816
v_mfma_f32_16x16x32_bf16 v[192:195], a[88:91], a[8:11], v[192:195]
s_add_u32 s17, s78, .-L_pc+6144
ds_read_b64_tr_b16 a[86:87], v20 offset:35072
v_mfma_f32_16x16x32_bf16 v[200:203], a[88:91], a[16:19], v[200:203]
buffer_load_dword a252, v16, s[88:91], s17 offen
v_mfma_f32_16x16x32_bf16 v[200:203], a[92:95], a[20:23], v[200:203]
v_mfma_f32_16x16x32_bf16 v[208:211], a[92:95], a[28:31], v[208:211]
v_mfma_f32_16x16x32_bf16 v[208:211], a[88:91], a[24:27], v[208:211]
ds_read_b64_tr_b16 a[88:89], v4 offset:32768
v_mfma_f32_16x16x32_bf16 v[212:215], a[96:99], a[24:27], v[212:215]
s_add_u32 m0, s77, 100352
ds_read_b64_tr_b16 a[90:91], v4 offset:33792
v_mfma_f32_16x16x32_bf16 v[212:215], a[100:103], a[28:31], v[212:215]
s_add_u32 s64, s71, 7405568
ds_read_b64_tr_b16 a[92:93], v4 offset:40960
v_mfma_f32_16x16x32_bf16 v[204:207], a[100:103], a[20:23], v[204:207]
buffer_load_dwordx4 v15, s[56:59], s64 offen lds
v_mfma_f32_16x16x32_bf16 v[204:207], a[96:99], a[16:19], v[204:207]
ds_read_b64_tr_b16 a[94:95], v4 offset:41984
v_mfma_f32_16x16x32_bf16 v[196:199], a[96:99], a[8:11], v[196:199]
v_mfma_f32_16x16x32_bf16 v[196:199], a[100:103], a[12:15], v[196:199]
v_mfma_f32_16x16x32_bf16 v[188:191], a[100:103], a[4:7], v[188:191]
v_mfma_f32_16x16x32_bf16 v[188:191], a[96:99], a[0:3], v[188:191]
ds_read_b64_tr_b16 a[96:97], v5 offset:32768
v_mfma_f32_16x16x32_bf16 v[216:219], a[0:3], a[104:107], v[216:219]
ds_read_b64_tr_b16 a[98:99], v5 offset:33792
v_mfma_f32_16x16x32_bf16 v[216:219], a[4:7], a[108:111], v[216:219]
s_add_u32 m0, s78, 122880
ds_read_b64_tr_b16 a[100:101], v5 offset:40960
v_mfma_f32_16x16x32_bf16 v[224:227], a[12:15], a[108:111], v[224:227]
s_add_u32 s64, s75, 5509120
ds_read_b64_tr_b16 a[102:103], v5 offset:41984
v_mfma_f32_16x16x32_bf16 v[224:227], a[8:11], a[104:107], v[224:227]
buffer_load_dwordx4 v23, s[60:63], s64 offen lds
v_mfma_f32_16x16x32_bf16 v[232:235], a[16:19], a[104:107], v[232:235]
v_mfma_f32_16x16x32_bf16 v[232:235], a[20:23], a[108:111], v[232:235]
v_mfma_f32_16x16x32_bf16 v[240:243], a[28:31], a[108:111], v[240:243]
v_mfma_f32_16x16x32_bf16 v[240:243], a[24:27], a[104:107], v[240:243]
ds_read_b64_tr_b16 a[104:105], v6 offset:32768
v_mfma_f32_16x16x32_bf16 v[244:247], a[24:27], a[112:115], v[244:247]
ds_read_b64_tr_b16 a[106:107], v6 offset:33792
v_mfma_f32_16x16x32_bf16 v[244:247], a[28:31], a[116:119], v[244:247]
ds_read_b64_tr_b16 a[108:109], v6 offset:40960
v_subrev_u32 v19, 0x8000, v19
v_mfma_f32_16x16x32_bf16 v[236:239], a[20:23], a[116:119], v[236:239]
s_add_u32 m0, s77, 101376
ds_read_b64_tr_b16 a[110:111], v6 offset:41984
v_mfma_f32_16x16x32_bf16 v[236:239], a[16:19], a[112:115], v[236:239]
s_add_u32 s64, s71, 7438336
v_mfma_f32_16x16x32_bf16 v[228:231], a[8:11], a[112:115], v[228:231]
buffer_load_dwordx4 v15, s[56:59], s64 offen lds
v_mfma_f32_16x16x32_bf16 v[228:231], a[12:15], a[116:119], v[228:231]
v_mfma_f32_16x16x32_bf16 v[220:223], a[4:7], a[116:119], v[220:223]
v_mfma_f32_16x16x32_bf16 v[220:223], a[0:3], a[112:115], v[220:223]
s_waitcnt lgkmcnt(4)
ds_read_b64_tr_b16 a[112:113], v7 offset:32768
v_mfma_f32_16x16x32_bf16 v[152:155], a[72:75], a[0:3], v[152:155]
ds_read_b64_tr_b16 a[114:115], v7 offset:33792
v_mfma_f32_16x16x32_bf16 v[152:155], a[76:79], a[4:7], v[152:155]
ds_read_b64_tr_b16 a[116:117], v7 offset:40960
v_subrev_u32 v20, 0x8000, v20
v_mfma_f32_16x16x32_bf16 v[160:163], a[76:79], a[12:15], v[160:163]
ds_read_b64_tr_b16 a[118:119], v7 offset:41984
v_mfma_f32_16x16x32_bf16 v[160:163], a[72:75], a[8:11], v[160:163]
v_mfma_f32_16x16x32_bf16 v[168:171], a[72:75], a[16:19], v[168:171]
v_mfma_f32_16x16x32_bf16 v[168:171], a[76:79], a[20:23], v[168:171]
v_mfma_f32_16x16x32_bf16 v[176:179], a[76:79], a[28:31], v[176:179]
s_add_u32 m0, s76, 0
v_mfma_f32_16x16x32_bf16 v[176:179], a[72:75], a[24:27], v[176:179]
s_add_u32 s64, s72, 1792
ds_read_b64_tr_b16 a[72:73], v8 offset:32768
v_mfma_f32_16x16x32_bf16 v[180:183], a[80:83], a[24:27], v[180:183]
buffer_load_dwordx4 v12, s[48:51], s64 offen lds
v_mfma_f32_16x16x32_bf16 v[180:183], a[84:87], a[28:31], v[180:183]
ds_read_b64_tr_b16 a[74:75], v8 offset:33792
v_subrev_u32 v4, 0x8000, v4
v_mfma_f32_16x16x32_bf16 v[172:175], a[84:87], a[20:23], v[172:175]
ds_read_b64_tr_b16 a[76:77], v8 offset:40960
v_mfma_f32_16x16x32_bf16 v[172:175], a[80:83], a[16:19], v[172:175]
s_add_u32 m0, s76, 1024
ds_read_b64_tr_b16 a[78:79], v8 offset:41984
v_mfma_f32_16x16x32_bf16 v[164:167], a[80:83], a[8:11], v[164:167]
s_add_u32 s64, s72, 18176
v_mfma_f32_16x16x32_bf16 v[164:167], a[84:87], a[12:15], v[164:167]
buffer_load_dwordx4 v13, s[48:51], s64 offen lds
v_mfma_f32_16x16x32_bf16 v[156:159], a[84:87], a[4:7], v[156:159]
v_mfma_f32_16x16x32_bf16 v[156:159], a[80:83], a[0:3], v[156:159]
ds_read_b64_tr_b16 a[80:81], v9 offset:32768
v_mfma_f32_16x16x32_bf16 v[24:27], a[88:91], a[0:3], v[24:27]
s_add_u32 m0, s76, 2048
ds_read_b64_tr_b16 a[82:83], v9 offset:33792
v_mfma_f32_16x16x32_bf16 v[24:27], a[92:95], a[4:7], v[24:27]
s_add_u32 s64, s72, 132864
ds_read_b64_tr_b16 a[84:85], v9 offset:40960
v_subrev_u32 v5, 0x8000, v5
v_mfma_f32_16x16x32_bf16 v[40:43], a[92:95], a[12:15], v[40:43]
buffer_load_dwordx4 v12, s[48:51], s64 offen lds
v_mfma_f32_16x16x32_bf16 v[40:43], a[88:91], a[8:11], v[40:43]
ds_read_b64_tr_b16 a[86:87], v9 offset:41984
v_mfma_f32_16x16x32_bf16 v[56:59], a[88:91], a[16:19], v[56:59]
v_mfma_f32_16x16x32_bf16 v[56:59], a[92:95], a[20:23], v[56:59]
s_add_u32 m0, s76, 3072
v_mfma_f32_16x16x32_bf16 v[72:75], a[92:95], a[28:31], v[72:75]
s_waitcnt vmcnt(11)
s_add_u32 s64, s72, 149248
ds_read_b128 a[32:35], v2 offset:32768
v_mfma_f32_16x16x32_bf16 v[72:75], a[88:91], a[24:27], v[72:75]
buffer_load_dwordx4 v13, s[48:51], s64 offen lds
v_mfma_f32_16x16x32_bf16 v[136:139], a[96:99], a[24:27], v[136:139]
ds_read_b128 a[36:39], v3 offset:32768
v_mfma_f32_16x16x32_bf16 v[136:139], a[100:103], a[28:31], v[136:139]
ds_read_b128 a[40:43], v2 offset:34816
v_subrev_u32 v6, 0x8000, v6
v_mfma_f32_16x16x32_bf16 v[120:123], a[100:103], a[20:23], v[120:123]
s_add_u32 m0, s76, 4096
ds_read_b128 a[44:47], v3 offset:34816
v_mfma_f32_16x16x32_bf16 v[120:123], a[96:99], a[16:19], v[120:123]
s_add_u32 s64, s73, 1792
ds_read_b128 a[48:51], v2 offset:36864
v_mfma_f32_16x16x32_bf16 v[104:107], a[96:99], a[8:11], v[104:107]
buffer_load_dwordx4 v12, s[48:51], s64 offen lds
v_mfma_f32_16x16x32_bf16 v[104:107], a[100:103], a[12:15], v[104:107]
ds_read_b128 a[52:55], v3 offset:36864
v_mfma_f32_16x16x32_bf16 v[88:91], a[100:103], a[4:7], v[88:91]
ds_read_b128 a[56:59], v2 offset:38912
v_mfma_f32_16x16x32_bf16 v[88:91], a[96:99], a[0:3], v[88:91]
s_waitcnt lgkmcnt(7)
s_add_u32 m0, s76, 5120
ds_read_b128 a[60:63], v3 offset:38912
v_mfma_f32_16x16x32_bf16 v[28:31], a[104:107], a[0:3], v[28:31]
s_add_u32 s64, s73, 18176
ds_read_b64_tr_b16 a[88:89], v10 offset:32768
v_mfma_f32_16x16x32_bf16 v[28:31], a[108:111], a[4:7], v[28:31]
buffer_load_dwordx4 v13, s[48:51], s64 offen lds
v_mfma_f32_16x16x32_bf16 v[44:47], a[108:111], a[12:15], v[44:47]
ds_read_b64_tr_b16 a[90:91], v10 offset:33792
v_subrev_u32 v7, 0x8000, v7
v_mfma_f32_16x16x32_bf16 v[44:47], a[104:107], a[8:11], v[44:47]
ds_read_b64_tr_b16 a[92:93], v10 offset:40960
v_mfma_f32_16x16x32_bf16 v[60:63], a[104:107], a[16:19], v[60:63]
s_add_u32 m0, s76, 6144
ds_read_b64_tr_b16 a[94:95], v10 offset:41984
v_mfma_f32_16x16x32_bf16 v[60:63], a[108:111], a[20:23], v[60:63]
s_add_u32 s64, s73, 132864
ds_read_b64_tr_b16 a[96:97], v11 offset:32768
v_mfma_f32_16x16x32_bf16 v[76:79], a[108:111], a[28:31], v[76:79]
buffer_load_dwordx4 v12, s[48:51], s64 offen lds
v_mfma_f32_16x16x32_bf16 v[76:79], a[104:107], a[24:27], v[76:79]
ds_read_b64_tr_b16 a[98:99], v11 offset:33792
v_mfma_f32_16x16x32_bf16 v[140:143], a[112:115], a[24:27], v[140:143]
ds_read_b64_tr_b16 a[100:101], v11 offset:40960
v_mfma_f32_16x16x32_bf16 v[140:143], a[116:119], a[28:31], v[140:143]
s_add_u32 m0, s76, 7168
ds_read_b64_tr_b16 a[102:103], v11 offset:41984
v_subrev_u32 v8, 0x8000, v8
v_mfma_f32_16x16x32_bf16 v[124:127], a[116:119], a[20:23], v[124:127]
s_add_u32 s64, s73, 149248
v_mfma_f32_16x16x32_bf16 v[124:127], a[112:115], a[16:19], v[124:127]
buffer_load_dwordx4 v13, s[48:51], s64 offen lds
v_mfma_f32_16x16x32_bf16 v[108:111], a[112:115], a[8:11], v[108:111]
v_mfma_f32_16x16x32_bf16 v[108:111], a[116:119], a[12:15], v[108:111]
v_mfma_f32_16x16x32_bf16 v[92:95], a[116:119], a[4:7], v[92:95]
v_subrev_u32 v9, 0x8000, v9
v_subrev_u32 v10, 0x8000, v10
v_mfma_f32_16x16x32_bf16 v[92:95], a[112:115], a[0:3], v[92:95]
v_subrev_u32 v11, 0x8000, v11
v_mfma_f32_16x16x32_bf16 v[32:35], a[72:75], a[0:3], v[32:35]
v_mfma_f32_16x16x32_bf16 v[32:35], a[76:79], a[4:7], v[32:35]
v_mfma_f32_16x16x32_bf16 v[48:51], a[76:79], a[12:15], v[48:51]
s_waitcnt lgkmcnt(0)
s_barrier
v_mfma_f32_16x16x32_bf16 v[48:51], a[72:75], a[8:11], v[48:51]
s_mov_b64 exec, 1
buffer_atomic_add a251, v1, s[52:55], s70 offen offset:0 sc1
s_mov_b64 exec, -1
s_add_u32 m0, s77, 131072
v_mfma_f32_16x16x32_bf16 v[64:67], a[72:75], a[16:19], v[64:67]
s_lshl4_add_u32 s70, s78, s70
s_add_u32 s64, s71, 7864320
ds_read_b64_tr_b16 a[104:105], v19 offset:4096
v_mfma_f32_16x16x32_bf16 v[64:67], a[76:79], a[20:23], v[64:67]
s_lshr_b32 s81, s81, 5
buffer_load_dwordx4 v14, s[56:59], s64 offen lds
v_mfma_f32_16x16x32_bf16 v[80:83], a[76:79], a[28:31], v[80:83]
ds_read_b64_tr_b16 a[106:107], v19 offset:4352
v_mfma_f32_16x16x32_bf16 v[80:83], a[72:75], a[24:27], v[80:83]
ds_read_b64_tr_b16 a[108:109], v19 offset:6144
v_mfma_f32_16x16x32_bf16 v[144:147], a[80:83], a[24:27], v[144:147]
ds_read_b64_tr_b16 a[110:111], v19 offset:6400
v_mfma_f32_16x16x32_bf16 v[144:147], a[84:87], a[28:31], v[144:147]
ds_read_b64_tr_b16 a[112:113], v20 offset:4096
v_mfma_f32_16x16x32_bf16 v[128:131], a[84:87], a[20:23], v[128:131]
ds_read_b64_tr_b16 a[114:115], v20 offset:4352
v_mfma_f32_16x16x32_bf16 v[128:131], a[80:83], a[16:19], v[128:131]
ds_read_b64_tr_b16 a[116:117], v20 offset:6144
v_mfma_f32_16x16x32_bf16 v[112:115], a[80:83], a[8:11], v[112:115]
s_add_u32 m0, s78, 147456
ds_read_b64_tr_b16 a[118:119], v20 offset:6400
v_mfma_f32_16x16x32_bf16 v[112:115], a[84:87], a[12:15], v[112:115]
s_add_u32 s64, s75, 5898240
ds_read_b64_tr_b16 a[72:73], v19 offset:8192
v_mfma_f32_16x16x32_bf16 v[96:99], a[84:87], a[4:7], v[96:99]
buffer_load_dwordx4 v23, s[60:63], s64 offen lds
v_mfma_f32_16x16x32_bf16 v[96:99], a[80:83], a[0:3], v[96:99]
ds_read_b64_tr_b16 a[74:75], v19 offset:8448
v_mfma_f32_16x16x32_bf16 v[36:39], a[88:91], a[0:3], v[36:39]
ds_read_b64_tr_b16 a[76:77], v19 offset:10240
v_mfma_f32_16x16x32_bf16 v[36:39], a[92:95], a[4:7], v[36:39]
ds_read_b64_tr_b16 a[78:79], v19 offset:10496
v_mfma_f32_16x16x32_bf16 v[52:55], a[92:95], a[12:15], v[52:55]
ds_read_b64_tr_b16 a[80:81], v20 offset:8192
v_mfma_f32_16x16x32_bf16 v[52:55], a[88:91], a[8:11], v[52:55]
ds_read_b64_tr_b16 a[82:83], v20 offset:8448
v_mfma_f32_16x16x32_bf16 v[68:71], a[88:91], a[16:19], v[68:71]
ds_read_b64_tr_b16 a[84:85], v20 offset:10240
v_mfma_f32_16x16x32_bf16 v[68:71], a[92:95], a[20:23], v[68:71]
s_add_u32 m0, s77, 132096
ds_read_b64_tr_b16 a[86:87], v20 offset:10496
v_mfma_f32_16x16x32_bf16 v[84:87], a[92:95], a[28:31], v[84:87]
s_add_u32 s64, s71, 7897088
v_mfma_f32_16x16x32_bf16 v[84:87], a[88:91], a[24:27], v[84:87]
buffer_load_dwordx4 v14, s[56:59], s64 offen lds
v_mfma_f32_16x16x32_bf16 v[148:151], a[96:99], a[24:27], v[148:151]
ds_read_b64_tr_b16 a[88:89], v19 offset:0
v_mfma_f32_16x16x32_bf16 v[148:151], a[100:103], a[28:31], v[148:151]
ds_read_b64_tr_b16 a[90:91], v19 offset:256
v_mfma_f32_16x16x32_bf16 v[132:135], a[100:103], a[20:23], v[132:135]
ds_read_b64_tr_b16 a[92:93], v19 offset:2048
v_mfma_f32_16x16x32_bf16 v[132:135], a[96:99], a[16:19], v[132:135]
ds_read_b64_tr_b16 a[94:95], v19 offset:2304
v_mfma_f32_16x16x32_bf16 v[116:119], a[96:99], a[8:11], v[116:119]
v_mfma_f32_16x16x32_bf16 v[116:119], a[100:103], a[12:15], v[116:119]
v_mfma_f32_16x16x32_bf16 v[100:103], a[100:103], a[4:7], v[100:103]
s_add_u32 m0, s78, 151552
v_mfma_f32_16x16x32_bf16 v[100:103], a[96:99], a[0:3], v[100:103]
s_waitcnt lgkmcnt(4)
s_add_u32 s64, s75, 5900288
ds_read_b64_tr_b16 a[96:97], v20 offset:0
v_mfma_f32_16x16x32_bf16 v[184:187], a[104:107], a[32:35], v[184:187]
buffer_load_dwordx4 v23, s[60:63], s64 offen lds
v_mfma_f32_16x16x32_bf16 v[184:187], a[108:111], a[36:39], v[184:187]
ds_read_b64_tr_b16 a[98:99], v20 offset:256
v_and_b32 v22, 15, v0
v_mfma_f32_16x16x32_bf16 v[192:195], a[108:111], a[44:47], v[192:195]
ds_read_b64_tr_b16 a[100:101], v20 offset:2048
v_lshlrev_b32 v22, 3, v22
v_mfma_f32_16x16x32_bf16 v[192:195], a[104:107], a[40:43], v[192:195]
s_lshl_b32 s85, s30, 7
s_add_u32 s85, s85, 58720256
ds_read_b64_tr_b16 a[102:103], v20 offset:2304
v_mfma_f32_16x16x32_bf16 v[200:203], a[104:107], a[48:51], v[200:203]
s_lshl_b32 s86, s3, 10
s_add_u32 s86, s86, s85
s_lshl_b32 s87, s16, 10
s_lshl_b32 s68, s31, 20
s_add_u32 s32, s28, s68
s_addc_u32 s33, s29, 0
v_mfma_f32_16x16x32_bf16 v[200:203], a[108:111], a[52:55], v[200:203]
s_add_u32 s87, s87, s85
s_add_u32 s68, s16, 1
s_lshl_b32 s34, s68, 16
v_mfma_f32_16x16x32_bf16 v[208:211], a[108:111], a[60:63], v[208:211]
v_mfma_f32_16x16x32_bf16 v[208:211], a[104:107], a[56:59], v[208:211]
ds_read_b64_tr_b16 a[104:105], v4 offset:0
v_mfma_f32_16x16x32_bf16 v[212:215], a[112:115], a[56:59], v[212:215]
s_add_u32 m0, s77, 133120
ds_read_b64_tr_b16 a[106:107], v4 offset:1024
v_mfma_f32_16x16x32_bf16 v[212:215], a[116:119], a[60:63], v[212:215]
s_add_u32 s64, s71, 7929856
ds_read_b64_tr_b16 a[108:109], v4 offset:8192
v_mfma_f32_16x16x32_bf16 v[204:207], a[116:119], a[52:55], v[204:207]
buffer_load_dwordx4 v15, s[56:59], s64 offen lds
v_mfma_f32_16x16x32_bf16 v[204:207], a[112:115], a[48:51], v[204:207]
ds_read_b64_tr_b16 a[110:111], v4 offset:9216
v_mfma_f32_16x16x32_bf16 v[196:199], a[112:115], a[40:43], v[196:199]
v_mfma_f32_16x16x32_bf16 v[196:199], a[116:119], a[44:47], v[196:199]
v_mfma_f32_16x16x32_bf16 v[188:191], a[116:119], a[36:39], v[188:191]
v_mfma_f32_16x16x32_bf16 v[188:191], a[112:115], a[32:35], v[188:191]
ds_read_b64_tr_b16 a[112:113], v5 offset:0
v_mfma_f32_16x16x32_bf16 v[216:219], a[32:35], a[72:75], v[216:219]
ds_read_b64_tr_b16 a[114:115], v5 offset:1024
v_mfma_f32_16x16x32_bf16 v[216:219], a[36:39], a[76:79], v[216:219]
s_add_u32 m0, s78, 155648
ds_read_b64_tr_b16 a[116:117], v5 offset:8192
v_mfma_f32_16x16x32_bf16 v[224:227], a[44:47], a[76:79], v[224:227]
s_add_u32 s64, s75, 5902336
ds_read_b64_tr_b16 a[118:119], v5 offset:9216
v_mfma_f32_16x16x32_bf16 v[224:227], a[40:43], a[72:75], v[224:227]
buffer_load_dwordx4 v23, s[60:63], s64 offen lds
v_mfma_f32_16x16x32_bf16 v[232:235], a[48:51], a[72:75], v[232:235]
v_mfma_f32_16x16x32_bf16 v[232:235], a[52:55], a[76:79], v[232:235]
v_mfma_f32_16x16x32_bf16 v[240:243], a[60:63], a[76:79], v[240:243]
v_mfma_f32_16x16x32_bf16 v[240:243], a[56:59], a[72:75], v[240:243]
ds_read_b64_tr_b16 a[72:73], v6 offset:0
v_mfma_f32_16x16x32_bf16 v[244:247], a[56:59], a[80:83], v[244:247]
ds_read_b64_tr_b16 a[74:75], v6 offset:1024
v_mfma_f32_16x16x32_bf16 v[244:247], a[60:63], a[84:87], v[244:247]
ds_read_b64_tr_b16 a[76:77], v6 offset:8192
v_mfma_f32_16x16x32_bf16 v[236:239], a[52:55], a[84:87], v[236:239]
s_add_u32 m0, s77, 134144
ds_read_b64_tr_b16 a[78:79], v6 offset:9216
v_mfma_f32_16x16x32_bf16 v[236:239], a[48:51], a[80:83], v[236:239]
s_add_u32 s64, s71, 7962624
v_mfma_f32_16x16x32_bf16 v[228:231], a[40:43], a[80:83], v[228:231]
buffer_load_dwordx4 v15, s[56:59], s64 offen lds
v_mfma_f32_16x16x32_bf16 v[228:231], a[44:47], a[84:87], v[228:231]
v_mfma_f32_16x16x32_bf16 v[220:223], a[36:39], a[84:87], v[220:223]
v_mfma_f32_16x16x32_bf16 v[220:223], a[32:35], a[80:83], v[220:223]
s_waitcnt lgkmcnt(4)
ds_read_b64_tr_b16 a[80:81], v7 offset:0
v_mfma_f32_16x16x32_bf16 v[152:155], a[88:91], a[32:35], v[152:155]
ds_read_b64_tr_b16 a[82:83], v7 offset:1024
v_mfma_f32_16x16x32_bf16 v[152:155], a[92:95], a[36:39], v[152:155]
ds_read_b64_tr_b16 a[84:85], v7 offset:8192
v_mfma_f32_16x16x32_bf16 v[160:163], a[92:95], a[44:47], v[160:163]
ds_read_b64_tr_b16 a[86:87], v7 offset:9216
v_mfma_f32_16x16x32_bf16 v[160:163], a[88:91], a[40:43], v[160:163]
v_mfma_f32_16x16x32_bf16 v[168:171], a[88:91], a[48:51], v[168:171]
v_mfma_f32_16x16x32_bf16 v[168:171], a[92:95], a[52:55], v[168:171]
v_mfma_f32_16x16x32_bf16 v[176:179], a[92:95], a[60:63], v[176:179]
s_add_u32 m0, s76, 32768
v_mfma_f32_16x16x32_bf16 v[176:179], a[88:91], a[56:59], v[176:179]
s_add_u32 s64, s72, 1920
ds_read_b64_tr_b16 a[88:89], v8 offset:0
v_mfma_f32_16x16x32_bf16 v[180:183], a[96:99], a[56:59], v[180:183]
buffer_load_dwordx4 v12, s[48:51], s64 offen lds
v_mfma_f32_16x16x32_bf16 v[180:183], a[100:103], a[60:63], v[180:183]
ds_read_b64_tr_b16 a[90:91], v8 offset:1024
v_mfma_f32_16x16x32_bf16 v[172:175], a[100:103], a[52:55], v[172:175]
ds_read_b64_tr_b16 a[92:93], v8 offset:8192
v_mfma_f32_16x16x32_bf16 v[172:175], a[96:99], a[48:51], v[172:175]
s_add_u32 m0, s76, 33792
ds_read_b64_tr_b16 a[94:95], v8 offset:9216
v_mfma_f32_16x16x32_bf16 v[164:167], a[96:99], a[40:43], v[164:167]
s_add_u32 s64, s72, 18304
v_mfma_f32_16x16x32_bf16 v[164:167], a[100:103], a[44:47], v[164:167]
buffer_load_dwordx4 v13, s[48:51], s64 offen lds
v_mfma_f32_16x16x32_bf16 v[156:159], a[100:103], a[36:39], v[156:159]
v_mfma_f32_16x16x32_bf16 v[156:159], a[96:99], a[32:35], v[156:159]
ds_read_b64_tr_b16 a[96:97], v9 offset:0
v_mfma_f32_16x16x32_bf16 v[24:27], a[104:107], a[32:35], v[24:27]
s_add_u32 m0, s76, 34816
ds_read_b64_tr_b16 a[98:99], v9 offset:1024
v_mfma_f32_16x16x32_bf16 v[24:27], a[108:111], a[36:39], v[24:27]
s_add_u32 s64, s72, 132992
ds_read_b64_tr_b16 a[100:101], v9 offset:8192
v_mfma_f32_16x16x32_bf16 v[40:43], a[108:111], a[44:47], v[40:43]
buffer_load_dwordx4 v12, s[48:51], s64 offen lds
v_mfma_f32_16x16x32_bf16 v[40:43], a[104:107], a[40:43], v[40:43]
ds_read_b64_tr_b16 a[102:103], v9 offset:9216
v_mfma_f32_16x16x32_bf16 v[56:59], a[104:107], a[48:51], v[56:59]
v_mfma_f32_16x16x32_bf16 v[56:59], a[108:111], a[52:55], v[56:59]
s_add_u32 m0, s76, 35840
v_mfma_f32_16x16x32_bf16 v[72:75], a[108:111], a[60:63], v[72:75]
s_waitcnt vmcnt(11)
s_add_u32 s64, s72, 149376
ds_read_b128 a[0:3], v2 offset:0
v_mfma_f32_16x16x32_bf16 v[72:75], a[104:107], a[56:59], v[72:75]
buffer_load_dwordx4 v13, s[48:51], s64 offen lds
v_mfma_f32_16x16x32_bf16 v[136:139], a[112:115], a[56:59], v[136:139]
ds_read_b128 a[4:7], v3 offset:0
v_mfma_f32_16x16x32_bf16 v[136:139], a[116:119], a[60:63], v[136:139]
ds_read_b128 a[8:11], v2 offset:2048
v_mfma_f32_16x16x32_bf16 v[120:123], a[116:119], a[52:55], v[120:123]
s_add_u32 m0, s76, 36864
ds_read_b128 a[12:15], v3 offset:2048
v_mfma_f32_16x16x32_bf16 v[120:123], a[112:115], a[48:51], v[120:123]
s_add_u32 s64, s73, 1920
ds_read_b128 a[16:19], v2 offset:4096
v_mfma_f32_16x16x32_bf16 v[104:107], a[112:115], a[40:43], v[104:107]
buffer_load_dwordx4 v12, s[48:51], s64 offen lds
v_mfma_f32_16x16x32_bf16 v[104:107], a[116:119], a[44:47], v[104:107]
ds_read_b128 a[20:23], v3 offset:4096
v_mfma_f32_16x16x32_bf16 v[88:91], a[116:119], a[36:39], v[88:91]
ds_read_b128 a[24:27], v2 offset:6144
v_mfma_f32_16x16x32_bf16 v[88:91], a[112:115], a[32:35], v[88:91]
s_waitcnt lgkmcnt(7)
s_add_u32 m0, s76, 37888
ds_read_b128 a[28:31], v3 offset:6144
v_mfma_f32_16x16x32_bf16 v[28:31], a[72:75], a[32:35], v[28:31]
s_add_u32 s64, s73, 18304
ds_read_b64_tr_b16 a[104:105], v10 offset:0
v_mfma_f32_16x16x32_bf16 v[28:31], a[76:79], a[36:39], v[28:31]
buffer_load_dwordx4 v13, s[48:51], s64 offen lds
v_mfma_f32_16x16x32_bf16 v[44:47], a[76:79], a[44:47], v[44:47]
ds_read_b64_tr_b16 a[106:107], v10 offset:1024
v_mfma_f32_16x16x32_bf16 v[44:47], a[72:75], a[40:43], v[44:47]
ds_read_b64_tr_b16 a[108:109], v10 offset:8192
v_mfma_f32_16x16x32_bf16 v[60:63], a[72:75], a[48:51], v[60:63]
s_add_u32 m0, s76, 38912
buffer_load_dword v1, off, s[52:55], s70 sc1
v_mfma_f32_16x16x32_bf16 v[60:63], a[76:79], a[52:55], v[60:63]
s_add_u32 s64, s73, 132992
ds_read_b64_tr_b16 a[110:111], v10 offset:9216
v_mfma_f32_16x16x32_bf16 v[76:79], a[76:79], a[60:63], v[76:79]
buffer_load_dwordx4 v12, s[48:51], s64 offen lds
v_mfma_f32_16x16x32_bf16 v[76:79], a[72:75], a[56:59], v[76:79]
ds_read_b64_tr_b16 a[112:113], v11 offset:0
v_mfma_f32_16x16x32_bf16 v[140:143], a[80:83], a[56:59], v[140:143]
ds_read_b64_tr_b16 a[114:115], v11 offset:1024
v_mfma_f32_16x16x32_bf16 v[140:143], a[84:87], a[60:63], v[140:143]
s_add_u32 m0, s76, 39936
ds_read_b64_tr_b16 a[116:117], v11 offset:8192
v_mfma_f32_16x16x32_bf16 v[124:127], a[84:87], a[52:55], v[124:127]
s_add_u32 s64, s73, 149376
ds_read_b64_tr_b16 a[118:119], v11 offset:9216
v_mfma_f32_16x16x32_bf16 v[124:127], a[80:83], a[48:51], v[124:127]
buffer_load_dwordx4 v13, s[48:51], s64 offen lds
v_mfma_f32_16x16x32_bf16 v[108:111], a[80:83], a[40:43], v[108:111]
v_mfma_f32_16x16x32_bf16 v[108:111], a[84:87], a[44:47], v[108:111]
v_mfma_f32_16x16x32_bf16 v[92:95], a[84:87], a[36:39], v[92:95]
buffer_load_dwordx2 a[64:65], v22, s[44:47], s86 offen offset:0 sc1
v_mfma_f32_16x16x32_bf16 v[92:95], a[80:83], a[32:35], v[92:95]
buffer_load_dwordx2 a[66:67], v22, s[44:47], s86 offen offset:512 sc1
v_mfma_f32_16x16x32_bf16 v[32:35], a[88:91], a[32:35], v[32:35]
buffer_load_dwordx2 a[68:69], v22, s[44:47], s87 offen offset:0 sc1
v_mfma_f32_16x16x32_bf16 v[32:35], a[92:95], a[36:39], v[32:35]
buffer_load_dwordx2 a[70:71], v22, s[44:47], s87 offen offset:512 sc1
v_mfma_f32_16x16x32_bf16 v[48:51], a[92:95], a[44:47], v[48:51]
s_waitcnt lgkmcnt(0)
s_barrier
v_mfma_f32_16x16x32_bf16 v[48:51], a[88:91], a[40:43], v[48:51]
ds_read_b64_tr_b16 a[72:73], v19 offset:36864
v_mfma_f32_16x16x32_bf16 v[64:67], a[88:91], a[48:51], v[64:67]
s_lshl2_add_u32 s72, s2, s30
ds_read_b64_tr_b16 a[74:75], v19 offset:37120
v_mfma_f32_16x16x32_bf16 v[64:67], a[92:95], a[52:55], v[64:67]
s_lshl_b32 s72, s72, 12
ds_read_b64_tr_b16 a[76:77], v19 offset:38912
v_mfma_f32_16x16x32_bf16 v[80:83], a[92:95], a[60:63], v[80:83]
s_add_u32 s72, s72, 67108864
ds_read_b64_tr_b16 a[78:79], v19 offset:39168
v_mfma_f32_16x16x32_bf16 v[80:83], a[88:91], a[56:59], v[80:83]
ds_read_b64_tr_b16 a[80:81], v20 offset:36864
v_mfma_f32_16x16x32_bf16 v[144:147], a[96:99], a[56:59], v[144:147]
ds_read_b64_tr_b16 a[82:83], v20 offset:37120
v_mfma_f32_16x16x32_bf16 v[144:147], a[100:103], a[60:63], v[144:147]
ds_read_b64_tr_b16 a[84:85], v20 offset:38912
v_mfma_f32_16x16x32_bf16 v[128:131], a[100:103], a[52:55], v[128:131]
ds_read_b64_tr_b16 a[86:87], v20 offset:39168
v_mfma_f32_16x16x32_bf16 v[128:131], a[96:99], a[48:51], v[128:131]
ds_read_b64_tr_b16 a[88:89], v19 offset:40960
v_mfma_f32_16x16x32_bf16 v[112:115], a[96:99], a[40:43], v[112:115]
ds_read_b64_tr_b16 a[90:91], v19 offset:41216
v_mfma_f32_16x16x32_bf16 v[112:115], a[100:103], a[44:47], v[112:115]
ds_read_b64_tr_b16 a[92:93], v19 offset:43008
v_mfma_f32_16x16x32_bf16 v[96:99], a[100:103], a[36:39], v[96:99]
ds_read_b64_tr_b16 a[94:95], v19 offset:43264
v_mfma_f32_16x16x32_bf16 v[96:99], a[96:99], a[32:35], v[96:99]
ds_read_b64_tr_b16 a[96:97], v20 offset:40960
v_mfma_f32_16x16x32_bf16 v[36:39], a[104:107], a[32:35], v[36:39]
buffer_store_dwordx4 a[240:243], v16, s[44:47], s72 offen offset:0 sc1
v_mfma_f32_16x16x32_bf16 v[36:39], a[108:111], a[36:39], v[36:39]
ds_read_b64_tr_b16 a[98:99], v20 offset:41216
v_mfma_f32_16x16x32_bf16 v[52:55], a[108:111], a[44:47], v[52:55]
ds_read_b64_tr_b16 a[100:101], v20 offset:43008
v_mfma_f32_16x16x32_bf16 v[52:55], a[104:107], a[40:43], v[52:55]
ds_read_b64_tr_b16 a[102:103], v20 offset:43264
v_mfma_f32_16x16x32_bf16 v[68:71], a[104:107], a[48:51], v[68:71]
v_mfma_f32_16x16x32_bf16 v[68:71], a[108:111], a[52:55], v[68:71]
v_mfma_f32_16x16x32_bf16 v[84:87], a[108:111], a[60:63], v[84:87]
v_mfma_f32_16x16x32_bf16 v[84:87], a[104:107], a[56:59], v[84:87]
ds_read_b64_tr_b16 a[104:105], v19 offset:32768
v_mfma_f32_16x16x32_bf16 v[148:151], a[112:115], a[56:59], v[148:151]
ds_read_b64_tr_b16 a[106:107], v19 offset:33024
v_mfma_f32_16x16x32_bf16 v[148:151], a[116:119], a[60:63], v[148:151]
ds_read_b64_tr_b16 a[108:109], v19 offset:34816
v_mfma_f32_16x16x32_bf16 v[132:135], a[116:119], a[52:55], v[132:135]
ds_read_b64_tr_b16 a[110:111], v19 offset:35072
v_mfma_f32_16x16x32_bf16 v[132:135], a[112:115], a[48:51], v[132:135]
v_mfma_f32_16x16x32_bf16 v[116:119], a[112:115], a[40:43], v[116:119]
v_mfma_f32_16x16x32_bf16 v[116:119], a[116:119], a[44:47], v[116:119]
v_mfma_f32_16x16x32_bf16 v[100:103], a[116:119], a[36:39], v[100:103]
buffer_store_dwordx4 a[240:243], v16, s[44:47], s72 offen offset:1024 sc1
v_mfma_f32_16x16x32_bf16 v[100:103], a[112:115], a[32:35], v[100:103]
s_waitcnt lgkmcnt(4)
ds_read_b64_tr_b16 a[112:113], v20 offset:32768
v_mfma_f32_16x16x32_bf16 v[184:187], a[72:75], a[0:3], v[184:187]
ds_read_b64_tr_b16 a[114:115], v20 offset:33024
v_and_b32 v12, 15, v0
v_mfma_f32_16x16x32_bf16 v[184:187], a[76:79], a[4:7], v[184:187]
ds_read_b64_tr_b16 a[116:117], v20 offset:34816
v_lshrrev_b32 v13, 4, v0
v_mfma_f32_16x16x32_bf16 v[192:195], a[76:79], a[12:15], v[192:195]
ds_read_b64_tr_b16 a[118:119], v20 offset:35072
v_lshlrev_b32 v13, 2, v13
v_mfma_f32_16x16x32_bf16 v[192:195], a[72:75], a[8:11], v[192:195]
v_sub_u32 v12, v12, v13
v_mfma_f32_16x16x32_bf16 v[200:203], a[72:75], a[16:19], v[200:203]
s_lshl_b32 s66, s30, 4
v_mfma_f32_16x16x32_bf16 v[200:203], a[76:79], a[20:23], v[200:203]
v_add_u32 v13, s66, v12
v_cmp_gt_i32 s[0:1], 0, v13
v_mfma_f32_16x16x32_bf16 v[208:211], a[76:79], a[28:31], v[208:211]
v_cmp_gt_i32 s[4:5], 1, v13
v_cmp_gt_i32 s[6:7], 2, v13
v_mfma_f32_16x16x32_bf16 v[208:211], a[72:75], a[24:27], v[208:211]
ds_read_b64_tr_b16 a[72:73], v4 offset:32768
v_cmp_gt_i32 s[8:9], 3, v13
v_mfma_f32_16x16x32_bf16 v[212:215], a[80:83], a[24:27], v[212:215]
ds_read_b64_tr_b16 a[74:75], v4 offset:33792
v_cmp_gt_i32 s[10:11], 16, v13
v_mfma_f32_16x16x32_bf16 v[212:215], a[84:87], a[28:31], v[212:215]
ds_read_b64_tr_b16 a[76:77], v4 offset:40960
v_cmp_gt_i32 s[12:13], 17, v13
v_mfma_f32_16x16x32_bf16 v[204:207], a[84:87], a[20:23], v[204:207]
ds_read_b64_tr_b16 a[78:79], v4 offset:41984
v_cmp_gt_i32 s[18:19], 18, v13
v_mfma_f32_16x16x32_bf16 v[204:207], a[80:83], a[16:19], v[204:207]
v_cmp_gt_i32 s[22:23], 19, v13
v_cmp_gt_i32 s[26:27], 32, v13
v_mfma_f32_16x16x32_bf16 v[196:199], a[80:83], a[8:11], v[196:199]
buffer_store_dwordx4 a[240:243], v16, s[44:47], s72 offen offset:2048 sc1
v_mfma_f32_16x16x32_bf16 v[196:199], a[84:87], a[12:15], v[196:199]
v_cmp_gt_i32 s[56:57], 33, v13
v_cmp_gt_i32 s[58:59], 34, v13
v_mfma_f32_16x16x32_bf16 v[188:191], a[84:87], a[4:7], v[188:191]
v_cmp_gt_i32 s[60:61], 35, v13
v_cmp_gt_i32 s[62:63], 48, v13
v_mfma_f32_16x16x32_bf16 v[188:191], a[80:83], a[0:3], v[188:191]
ds_read_b64_tr_b16 a[80:81], v5 offset:32768
v_cmp_gt_i32 s[48:49], 49, v13
v_mfma_f32_16x16x32_bf16 v[216:219], a[0:3], a[88:91], v[216:219]
ds_read_b64_tr_b16 a[82:83], v5 offset:33792
v_cmp_gt_i32 s[50:51], 50, v13
v_mfma_f32_16x16x32_bf16 v[216:219], a[4:7], a[92:95], v[216:219]
ds_read_b64_tr_b16 a[84:85], v5 offset:40960
v_cmp_gt_i32 s[100:101], 51, v13
v_mfma_f32_16x16x32_bf16 v[224:227], a[12:15], a[92:95], v[224:227]
ds_read_b64_tr_b16 a[86:87], v5 offset:41984
v_subrev_u32 v17, 0, v12
v_mfma_f32_16x16x32_bf16 v[224:227], a[8:11], a[88:91], v[224:227]
v_lshlrev_b32 v18, 31, v17
v_or_b32 v21, v17, v18
v_mfma_f32_16x16x32_bf16 v[232:235], a[16:19], a[88:91], v[232:235]
v_ashrrev_i32 v21, 31, v21
v_and_b32 v248, 0xff800000, v21
v_mfma_f32_16x16x32_bf16 v[232:235], a[20:23], a[92:95], v[232:235]
v_not_b32 v17, v17
v_or_b32 v21, v17, v18
v_mfma_f32_16x16x32_bf16 v[240:243], a[28:31], a[92:95], v[240:243]
v_ashrrev_i32 v21, 31, v21
v_and_b32 v252, 0xff800000, v21
v_mfma_f32_16x16x32_bf16 v[240:243], a[24:27], a[88:91], v[240:243]
ds_read_b64_tr_b16 a[88:89], v6 offset:32768
v_subrev_u32 v17, 1, v12
v_mfma_f32_16x16x32_bf16 v[244:247], a[24:27], a[96:99], v[244:247]
ds_read_b64_tr_b16 a[90:91], v6 offset:33792
v_lshlrev_b32 v18, 31, v17
v_mfma_f32_16x16x32_bf16 v[244:247], a[28:31], a[100:103], v[244:247]
ds_read_b64_tr_b16 a[92:93], v6 offset:40960
v_add_u32 v19, 0x8000, v19
v_mfma_f32_16x16x32_bf16 v[236:239], a[20:23], a[100:103], v[236:239]
buffer_store_dwordx4 a[240:243], v16, s[44:47], s72 offen offset:3072 sc1
v_mfma_f32_16x16x32_bf16 v[236:239], a[16:19], a[96:99], v[236:239]
ds_read_b64_tr_b16 a[94:95], v6 offset:41984
v_or_b32 v21, v17, v18
v_mfma_f32_16x16x32_bf16 v[228:231], a[8:11], a[96:99], v[228:231]
v_ashrrev_i32 v21, 31, v21
v_and_b32 v249, 0xff800000, v21
v_mfma_f32_16x16x32_bf16 v[228:231], a[12:15], a[100:103], v[228:231]
v_not_b32 v17, v17
v_or_b32 v21, v17, v18
v_mfma_f32_16x16x32_bf16 v[220:223], a[4:7], a[100:103], v[220:223]
v_ashrrev_i32 v21, 31, v21
v_and_b32 v253, 0xff800000, v21
v_mfma_f32_16x16x32_bf16 v[220:223], a[0:3], a[96:99], v[220:223]
s_waitcnt lgkmcnt(4)
ds_read_b64_tr_b16 a[96:97], v7 offset:32768
v_subrev_u32 v17, 2, v12
v_mfma_f32_16x16x32_bf16 v[152:155], a[104:107], a[0:3], v[152:155]
ds_read_b64_tr_b16 a[98:99], v7 offset:33792
v_lshlrev_b32 v18, 31, v17
v_mfma_f32_16x16x32_bf16 v[152:155], a[108:111], a[4:7], v[152:155]
ds_read_b64_tr_b16 a[100:101], v7 offset:40960
v_add_u32 v20, 0x8000, v20
v_mfma_f32_16x16x32_bf16 v[160:163], a[108:111], a[12:15], v[160:163]
ds_read_b64_tr_b16 a[102:103], v7 offset:41984
v_or_b32 v21, v17, v18
v_mfma_f32_16x16x32_bf16 v[160:163], a[104:107], a[8:11], v[160:163]
v_ashrrev_i32 v21, 31, v21
v_and_b32 v250, 0xff800000, v21
v_mfma_f32_16x16x32_bf16 v[168:171], a[104:107], a[16:19], v[168:171]
v_not_b32 v17, v17
v_or_b32 v21, v17, v18
v_mfma_f32_16x16x32_bf16 v[168:171], a[108:111], a[20:23], v[168:171]
v_ashrrev_i32 v21, 31, v21
v_and_b32 v254, 0xff800000, v21
v_mfma_f32_16x16x32_bf16 v[176:179], a[108:111], a[28:31], v[176:179]
v_subrev_u32 v17, 3, v12
v_lshlrev_b32 v18, 31, v17
v_mfma_f32_16x16x32_bf16 v[176:179], a[104:107], a[24:27], v[176:179]
ds_read_b64_tr_b16 a[104:105], v8 offset:32768
v_or_b32 v21, v17, v18
v_mfma_f32_16x16x32_bf16 v[180:183], a[112:115], a[24:27], v[180:183]
ds_read_b64_tr_b16 a[106:107], v8 offset:33792
v_ashrrev_i32 v21, 31, v21
v_mfma_f32_16x16x32_bf16 v[180:183], a[116:119], a[28:31], v[180:183]
ds_read_b64_tr_b16 a[108:109], v8 offset:40960
v_add_u32 v4, 0x8000, v4
v_mfma_f32_16x16x32_bf16 v[172:175], a[116:119], a[20:23], v[172:175]
ds_read_b64_tr_b16 a[110:111], v8 offset:41984
v_and_b32 v251, 0xff800000, v21
v_mfma_f32_16x16x32_bf16 v[172:175], a[112:115], a[16:19], v[172:175]
v_not_b32 v17, v17
v_or_b32 v21, v17, v18
v_mfma_f32_16x16x32_bf16 v[164:167], a[112:115], a[8:11], v[164:167]
s_add_u32 s17, s78, .-L_pc+6144
v_ashrrev_i32 v21, 31, v21
v_and_b32 v255, 0xff800000, v21
v_mfma_f32_16x16x32_bf16 v[164:167], a[116:119], a[12:15], v[164:167]
s_and_b32 s66, s2, 7
s_lshr_b32 s67, s2, 3
s_and_b32 s83, s66, 1
v_mfma_f32_16x16x32_bf16 v[156:159], a[116:119], a[4:7], v[156:159]
s_and_b32 s68, s66, 2
s_and_b32 s69, s67, 7
s_lshl2_add_u32 s82, s68, s69
v_mfma_f32_16x16x32_bf16 v[156:159], a[112:115], a[0:3], v[156:159]
s_and_b32 s68, s66, 4
s_lshr_b32 s69, s67, 3
ds_read_b64_tr_b16 a[112:113], v9 offset:32768
v_mfma_f32_16x16x32_bf16 v[24:27], a[72:75], a[0:3], v[24:27]
s_xor_b32 s69, s69, 0
s_add_u32 s87, s68, s69
ds_read_b64_tr_b16 a[114:115], v9 offset:33792
v_mfma_f32_16x16x32_bf16 v[24:27], a[76:79], a[4:7], v[24:27]
s_lshl_b32 s87, s87, 8
ds_read_b64_tr_b16 a[116:117], v9 offset:40960
v_add_u32 v5, 0x8000, v5
v_mfma_f32_16x16x32_bf16 v[40:43], a[76:79], a[12:15], v[40:43]
s_lshl_b32 s86, s30, 13
buffer_load_dword a252, v16, s[88:91], s17 offen
v_mfma_f32_16x16x32_bf16 v[40:43], a[72:75], a[8:11], v[40:43]
s_lshl_b32 s85, s30, 16
s_add_u32 s85, s85, s87
ds_read_b64_tr_b16 a[118:119], v9 offset:41984
v_mfma_f32_16x16x32_bf16 v[56:59], a[72:75], a[16:19], v[56:59]
s_mul_i32 s66, s83, 1310720
s_add_u32 s85, s85, s66
s_mul_i32 s84, s82, 1310720
v_mfma_f32_16x16x32_bf16 v[56:59], a[76:79], a[20:23], v[56:59]
s_and_b32 s66, s30, 1
s_lshl_b32 s66, s66, 14
s_add_u32 s84, s84, s66
v_mfma_f32_16x16x32_bf16 v[72:75], a[76:79], a[28:31], v[72:75]
s_waitcnt vmcnt(9)
s_mul_i32 s66, s83, 163840
ds_read_b128 a[32:35], v2 offset:32768
v_mfma_f32_16x16x32_bf16 v[72:75], a[72:75], a[24:27], v[72:75]
s_add_u32 s84, s84, s66
s_add_u32 s84, s84, 34603008
s_add_u32 s17, s78, .-L_pc+9984
ds_read_b128 a[36:39], v3 offset:32768
v_mfma_f32_16x16x32_bf16 v[136:139], a[80:83], a[24:27], v[136:139]
s_sub_u32 s66, 15, s82
buffer_load_dword a252, v16, s[88:91], s17 offen
v_mfma_f32_16x16x32_bf16 v[136:139], a[84:87], a[28:31], v[136:139]
s_min_u32 s66, s66, s82
ds_read_b128 a[40:43], v2 offset:34816
v_add_u32 v6, 0x8000, v6
v_mfma_f32_16x16x32_bf16 v[120:123], a[84:87], a[20:23], v[120:123]
s_lshl1_add_u32 s66, s66, s83
s_lshl_b32 s80, s66, 8
ds_read_b128 a[44:47], v3 offset:34816
v_mfma_f32_16x16x32_bf16 v[120:123], a[80:83], a[16:19], v[120:123]
s_add_u32 s80, s80, 8192
s_and_b32 s67, s30, 1
ds_read_b128 a[48:51], v2 offset:36864
v_mfma_f32_16x16x32_bf16 v[104:107], a[80:83], a[8:11], v[104:107]
s_lshl_b32 s67, s67, 7
s_add_u32 s67, s67, s83
ds_read_b128 a[52:55], v3 offset:36864
v_mfma_f32_16x16x32_bf16 v[104:107], a[84:87], a[12:15], v[104:107]
s_lshl_b32 s67, s67, 7
s_add_u32 s67, s67, 98304
ds_read_b128 a[56:59], v2 offset:38912
v_mfma_f32_16x16x32_bf16 v[88:91], a[84:87], a[4:7], v[88:91]
s_lshl_b32 s66, s30, 11
ds_read_b128 a[60:63], v3 offset:38912
v_lshrrev_b32 v14, 4, v0
v_mfma_f32_16x16x32_bf16 v[88:91], a[80:83], a[0:3], v[88:91]
s_waitcnt lgkmcnt(8)
ds_read_b64_tr_b16 a[72:73], v10 offset:32768
v_bfe_u32 v12, v0, 1, 3
v_mfma_f32_16x16x32_bf16 v[28:31], a[88:91], a[0:3], v[28:31]
ds_read_b64_tr_b16 a[74:75], v10 offset:33792
v_xor_b32 v12, v12, v14
v_mfma_f32_16x16x32_bf16 v[28:31], a[92:95], a[4:7], v[28:31]
ds_read_b64_tr_b16 a[76:77], v10 offset:40960
v_add_u32 v7, 0x8000, v7
v_mfma_f32_16x16x32_bf16 v[44:47], a[92:95], a[12:15], v[44:47]
ds_read_b64_tr_b16 a[78:79], v10 offset:41984
v_lshlrev_b32 v12, 5, v12
v_mfma_f32_16x16x32_bf16 v[44:47], a[88:91], a[8:11], v[44:47]
ds_read_b64_tr_b16 a[80:81], v11 offset:32768
v_lshl_add_u32 v12, v14, 11, v12
v_mfma_f32_16x16x32_bf16 v[60:63], a[88:91], a[16:19], v[60:63]
ds_read_b64_tr_b16 a[82:83], v11 offset:33792
v_and_b32 v14, 1, v0
v_mfma_f32_16x16x32_bf16 v[60:63], a[92:95], a[20:23], v[60:63]
ds_read_b64_tr_b16 a[84:85], v11 offset:40960
v_lshl_add_u32 v12, v14, 4, v12
v_mfma_f32_16x16x32_bf16 v[76:79], a[92:95], a[28:31], v[76:79]
s_add_u32 s17, s78, .-L_pc+13824
ds_read_b64_tr_b16 a[86:87], v11 offset:41984
v_xor_b32 v13, 128, v12
v_mfma_f32_16x16x32_bf16 v[76:79], a[88:91], a[24:27], v[76:79]
buffer_load_dword a252, v16, s[88:91], s17 offen
v_mfma_f32_16x16x32_bf16 v[140:143], a[96:99], a[24:27], v[140:143]
v_readfirstlane_b32 vcc_lo, v1
s_nop 0
s_cmp_lt_u32 vcc_lo, s81
s_cbranch_scc1 L_spin_4
L_spinbk_5:
v_mfma_f32_16x16x32_bf16 v[140:143], a[100:103], a[28:31], v[140:143]
s_add_u32 s17, s78, L_F1-L_pc
v_add_u32 v8, 0x8000, v8
v_lshrrev_b32 v14, 4, v0
v_mfma_f32_16x16x32_bf16 v[124:127], a[100:103], a[20:23], v[124:127]
buffer_load_dword a252, v16, s[88:91], s17 offen
v_mfma_f32_16x16x32_bf16 v[124:127], a[96:99], a[16:19], v[124:127]
v_bfe_u32 v18, v0, 2, 2
v_lshl_add_u32 v14, v14, 2, v18
v_mfma_f32_16x16x32_bf16 v[108:111], a[96:99], a[8:11], v[108:111]
s_add_u32 s17, s78, L_F1-L_pc+4096
v_and_b32 v18, 3, v0
v_lshlrev_b32 v18, 3, v18
v_mfma_f32_16x16x32_bf16 v[108:111], a[100:103], a[12:15], v[108:111]
buffer_load_dword a252, v16, s[88:91], s17 offen
v_mfma_f32_16x16x32_bf16 v[92:95], a[100:103], a[4:7], v[92:95]
v_add_u32 v9, 0x8000, v9
v_add_u32 v10, 0x8000, v10
v_mfma_f32_16x16x32_bf16 v[92:95], a[96:99], a[0:3], v[92:95]
v_add_u32 v11, 0x8000, v11
v_lshl_add_u32 v18, v14, 8, v18
v_mfma_f32_16x16x32_bf16 v[32:35], a[104:107], a[0:3], v[32:35]
v_and_b32 v14, 7, v14
v_lshl_add_u32 v18, v14, 5, v18
v_mfma_f32_16x16x32_bf16 v[32:35], a[108:111], a[4:7], v[32:35]
v_xor_b32 v18, s67, v18
v_add_u32 v14, s66, v16
v_mfma_f32_16x16x32_bf16 v[48:51], a[108:111], a[12:15], v[48:51]
s_waitcnt lgkmcnt(0)
s_barrier
v_mfma_f32_16x16x32_bf16 v[48:51], a[104:107], a[8:11], v[48:51]
ds_read_b64_tr_b16 a[88:89], v19 offset:36864
v_xor_b32 v15, 0x800, v14
v_mfma_f32_16x16x32_bf16 v[64:67], a[104:107], a[16:19], v[64:67]
s_lshr_b32 s66, s30, 1
s_lshl_b32 s66, s66, 16
ds_read_b64_tr_b16 a[90:91], v19 offset:37120
v_mfma_f32_16x16x32_bf16 v[64:67], a[108:111], a[20:23], v[64:67]
s_and_b32 s67, s30, 1
s_lshl_b32 s67, s67, 10
s_mov_b32 m0, s76
ds_read_b64_tr_b16 a[92:93], v19 offset:38912
v_mfma_f32_16x16x32_bf16 v[80:83], a[108:111], a[28:31], v[80:83]
s_add_u32 s66, s66, s67
s_add_u32 s66, s66, 32768
s_lshl_b32 s64, s30, 14
ds_read_b64_tr_b16 a[94:95], v19 offset:39168
v_mfma_f32_16x16x32_bf16 v[80:83], a[104:107], a[24:27], v[80:83]
buffer_load_dwordx4 v16, s[32:35], s64 offen offset:0 sc1 lds
v_mfma_f32_16x16x32_bf16 v[144:147], a[112:115], a[24:27], v[144:147]
ds_read_b64_tr_b16 a[96:97], v20 offset:36864
v_add_u32 v17, s66, v16
v_mfma_f32_16x16x32_bf16 v[144:147], a[116:119], a[28:31], v[144:147]
ds_read_b64_tr_b16 a[98:99], v20 offset:37120
v_lshlrev_b32 v21, 5, v0
v_mfma_f32_16x16x32_bf16 v[128:131], a[116:119], a[20:23], v[128:131]
s_lshl2_add_u32 s73, s2, s30
s_lshl_b32 s73, s73, 11
s_lshl_b32 s66, s30, 11
v_mfma_f32_16x16x32_bf16 v[128:131], a[112:115], a[16:19], v[128:131]
s_add_u32 s66, s66, 32768
buffer_load_dwordx4 v16, s[32:35], s64 offen offset:1024 sc1 lds
v_mfma_f32_16x16x32_bf16 v[112:115], a[112:115], a[8:11], v[112:115]
ds_read_b64_tr_b16 a[100:101], v20 offset:38912
v_add_u32 v2, s66, v16
v_mfma_f32_16x16x32_bf16 v[112:115], a[116:119], a[12:15], v[112:115]
ds_read_b64_tr_b16 a[102:103], v20 offset:39168
v_add_u32 v3, 0x10000, v2
v_mfma_f32_16x16x32_bf16 v[96:99], a[116:119], a[4:7], v[96:99]
ds_read_b64_tr_b16 a[104:105], v19 offset:40960
v_mfma_f32_16x16x32_bf16 v[96:99], a[112:115], a[0:3], v[96:99]
buffer_load_dwordx4 v16, s[32:35], s64 offen offset:2048 sc1 lds
v_mfma_f32_16x16x32_bf16 v[36:39], a[72:75], a[0:3], v[36:39]
ds_read_b64_tr_b16 a[106:107], v19 offset:41216
v_mfma_f32_16x16x32_bf16 v[36:39], a[76:79], a[4:7], v[36:39]
ds_read_b64_tr_b16 a[108:109], v19 offset:43008
v_mfma_f32_16x16x32_bf16 v[52:55], a[76:79], a[12:15], v[52:55]
ds_read_b64_tr_b16 a[110:111], v19 offset:43264
v_mfma_f32_16x16x32_bf16 v[52:55], a[72:75], a[8:11], v[52:55]
buffer_load_dwordx4 v16, s[32:35], s64 offen offset:3072 sc1 lds
v_mfma_f32_16x16x32_bf16 v[68:71], a[72:75], a[16:19], v[68:71]
ds_read_b64_tr_b16 a[112:113], v20 offset:40960
v_mfma_f32_16x16x32_bf16 v[68:71], a[76:79], a[20:23], v[68:71]
s_add_u32 m0, s76, 4096
ds_read_b64_tr_b16 a[114:115], v20 offset:41216
v_mfma_f32_16x16x32_bf16 v[84:87], a[76:79], a[28:31], v[84:87]
s_add_u32 s64, s64, 4096
ds_read_b64_tr_b16 a[116:117], v20 offset:43008
v_mfma_f32_16x16x32_bf16 v[84:87], a[72:75], a[24:27], v[84:87]
buffer_load_dwordx4 v16, s[32:35], s64 offen offset:0 sc1 lds
v_mfma_f32_16x16x32_bf16 v[148:151], a[80:83], a[24:27], v[148:151]
ds_read_b64_tr_b16 a[118:119], v20 offset:43264
v_mfma_f32_16x16x32_bf16 v[148:151], a[84:87], a[28:31], v[148:151]
ds_read_b64_tr_b16 a[72:73], v19 offset:32768
v_mfma_f32_16x16x32_bf16 v[132:135], a[84:87], a[20:23], v[132:135]
ds_read_b64_tr_b16 a[74:75], v19 offset:33024
v_mfma_f32_16x16x32_bf16 v[132:135], a[80:83], a[16:19], v[132:135]
buffer_load_dwordx4 v16, s[32:35], s64 offen offset:1024 sc1 lds
v_mfma_f32_16x16x32_bf16 v[116:119], a[80:83], a[8:11], v[116:119]
ds_read_b64_tr_b16 a[76:77], v19 offset:34816
v_mfma_f32_16x16x32_bf16 v[116:119], a[84:87], a[12:15], v[116:119]
ds_read_b64_tr_b16 a[78:79], v19 offset:35072
v_mfma_f32_16x16x32_bf16 v[100:103], a[84:87], a[4:7], v[100:103]
v_mfma_f32_16x16x32_bf16 v[100:103], a[80:83], a[0:3], v[100:103]
s_waitcnt lgkmcnt(6)
buffer_load_dwordx4 v16, s[32:35], s64 offen offset:2048 sc1 lds
v_mfma_f32_16x16x32_bf16 v[184:187], a[88:91], a[32:35], v[184:187]
ds_read_b64_tr_b16 a[80:81], v20 offset:32768
v_mfma_f32_16x16x32_bf16 v[184:187], a[92:95], a[36:39], v[184:187]
ds_read_b64_tr_b16 a[82:83], v20 offset:33024
v_mfma_f32_16x16x32_bf16 v[192:195], a[92:95], a[44:47], v[192:195]
ds_read_b64_tr_b16 a[84:85], v20 offset:34816
v_mfma_f32_16x16x32_bf16 v[192:195], a[88:91], a[40:43], v[192:195]
buffer_load_dwordx4 v16, s[32:35], s64 offen offset:3072 sc1 lds
v_mfma_f32_16x16x32_bf16 v[200:203], a[88:91], a[48:51], v[200:203]
ds_read_b64_tr_b16 a[86:87], v20 offset:35072
v_mfma_f32_16x16x32_bf16 v[200:203], a[92:95], a[52:55], v[200:203]
s_or_b32 s66, s3, s30
s_cmp_eq_u32 s66, 0
s_cselect_b32 s66, 0xff800000, 0
v_mfma_f32_16x16x32_bf16 v[208:211], a[92:95], a[60:63], v[208:211]
s_and_b32 s67, s74, 0x7800
s_cselect_b32 s67, 0, 0x70000000
s_add_u32 s77, s74, s67
s_lshr_b32 s64, s76, 1
s_add_u32 m0, s64, 81920
s_and_b32 s71, s64, 8192
s_add_u32 s64, s64, s71
s_add_u32 s64, s64, 8192
v_mfma_f32_16x16x32_bf16 v[208:211], a[88:91], a[56:59], v[208:211]
s_sub_u32 s77, s77, 2048
buffer_load_dwordx4 v16, s[32:35], s64 offen offset:0 sc1 lds
v_mfma_f32_16x16x32_bf16 v[212:215], a[96:99], a[56:59], v[212:215]
s_mov_b32 s68, 0x3e0293ee
ds_read_b64_tr_b16 a[88:89], v4 offset:32768
v_mfma_f32_16x16x32_bf16 v[212:215], a[100:103], a[60:63], v[212:215]
s_mov_b32 s69, s68
ds_read_b64_tr_b16 a[90:91], v4 offset:33792
v_mfma_f32_16x16x32_bf16 v[204:207], a[100:103], a[52:55], v[204:207]
ds_read_b64_tr_b16 a[92:93], v4 offset:40960
v_mfma_f32_16x16x32_bf16 v[204:207], a[96:99], a[48:51], v[204:207]
buffer_load_dwordx4 v16, s[32:35], s64 offen offset:1024 sc1 lds
v_mfma_f32_16x16x32_bf16 v[196:199], a[96:99], a[40:43], v[196:199]
ds_read_b64_tr_b16 a[94:95], v4 offset:41984
v_mfma_f32_16x16x32_bf16 v[196:199], a[100:103], a[44:47], v[196:199]
v_mfma_f32_16x16x32_bf16 v[188:191], a[100:103], a[36:39], v[188:191]
v_mfma_f32_16x16x32_bf16 v[188:191], a[96:99], a[32:35], v[188:191]
buffer_load_dwordx4 v16, s[32:35], s64 offen offset:2048 sc1 lds
v_mfma_f32_16x16x32_bf16 v[216:219], a[32:35], a[104:107], v[216:219]
ds_read_b64_tr_b16 a[96:97], v5 offset:32768
v_mfma_f32_16x16x32_bf16 v[216:219], a[36:39], a[108:111], v[216:219]
ds_read_b64_tr_b16 a[98:99], v5 offset:33792
v_cvt_pk_bf16_f32 v208, v208, v209
v_mfma_f32_16x16x32_bf16 v[224:227], a[44:47], a[108:111], v[224:227]
ds_read_b64_tr_b16 a[100:101], v5 offset:40960
v_cvt_pk_bf16_f32 v209, v210, v211
v_mfma_f32_16x16x32_bf16 v[224:227], a[40:43], a[104:107], v[224:227]
buffer_load_dwordx4 v16, s[32:35], s64 offen offset:3072 sc1 lds
v_mfma_f32_16x16x32_bf16 v[232:235], a[48:51], a[104:107], v[232:235]
ds_read_b64_tr_b16 a[102:103], v5 offset:41984
v_cvt_pk_bf16_f32 v210, v212, v213
v_mfma_f32_16x16x32_bf16 v[232:235], a[52:55], a[108:111], v[232:235]
v_cvt_pk_bf16_f32 v211, v214, v215
v_mfma_f32_16x16x32_bf16 v[240:243], a[60:63], a[108:111], v[240:243]
ds_write_b128 v3, v[208:211] offset:10240
v_mfma_f32_16x16x32_bf16 v[240:243], a[56:59], a[104:107], v[240:243]
ds_read_b64_tr_b16 a[104:105], v6 offset:32768
v_cvt_pk_bf16_f32 v200, v200, v201
v_mfma_f32_16x16x32_bf16 v[244:247], a[56:59], a[112:115], v[244:247]
s_waitcnt lgkmcnt(6)
ds_read_b64_tr_b16 a[106:107], v6 offset:33792
v_cvt_pk_bf16_f32 v201, v202, v203
v_mfma_f32_16x16x32_bf16 v[244:247], a[60:63], a[116:119], v[244:247]
ds_read_b64_tr_b16 a[108:109], v6 offset:40960
v_cvt_pk_bf16_f32 v202, v204, v205
v_mfma_f32_16x16x32_bf16 v[236:239], a[52:55], a[116:119], v[236:239]
ds_read_b64_tr_b16 a[110:111], v6 offset:41984
v_cvt_pk_bf16_f32 v203, v206, v207
v_mfma_f32_16x16x32_bf16 v[236:239], a[48:51], a[112:115], v[236:239]
ds_write_b128 v3, v[200:203] offset:2048
v_mfma_f32_16x16x32_bf16 v[228:231], a[40:43], a[112:115], v[228:231]
v_cvt_pk_bf16_f32 v192, v192, v193
v_cvt_pk_bf16_f32 v193, v194, v195
v_mfma_f32_16x16x32_bf16 v[228:231], a[44:47], a[116:119], v[228:231]
v_cvt_pk_bf16_f32 v194, v196, v197
v_cvt_pk_bf16_f32 v195, v198, v199
v_mfma_f32_16x16x32_bf16 v[220:223], a[36:39], a[116:119], v[220:223]
ds_write_b128 v2, v[192:195] offset:10240
v_mfma_f32_16x16x32_bf16 v[220:223], a[32:35], a[112:115], v[220:223]
ds_read_b64_tr_b16 a[112:113], v7 offset:32768
v_cvt_pk_bf16_f32 v184, v184, v185
v_mfma_f32_16x16x32_bf16 v[152:155], a[72:75], a[32:35], v[152:155]
ds_read_b64_tr_b16 a[114:115], v7 offset:33792
v_cvt_pk_bf16_f32 v185, v186, v187
v_mfma_f32_16x16x32_bf16 v[152:155], a[76:79], a[36:39], v[152:155]
ds_read_b64_tr_b16 a[116:117], v7 offset:40960
v_cvt_pk_bf16_f32 v186, v188, v189
v_mfma_f32_16x16x32_bf16 v[160:163], a[76:79], a[44:47], v[160:163]
ds_read_b64_tr_b16 a[118:119], v7 offset:41984
v_cvt_pk_bf16_f32 v187, v190, v191
v_mfma_f32_16x16x32_bf16 v[160:163], a[72:75], a[40:43], v[160:163]
ds_write_b128 v2, v[184:187] offset:2048
v_mfma_f32_16x16x32_bf16 v[168:171], a[72:75], a[48:51], v[168:171]
v_cvt_pk_bf16_f32 v219, v218, v219
v_cvt_pk_bf16_f32 v218, v216, v217
v_mfma_f32_16x16x32_bf16 v[168:171], a[76:79], a[52:55], v[168:171]
ds_write_b64 v2, v[218:219] offset:3072
v_mfma_f32_16x16x32_bf16 v[176:179], a[76:79], a[60:63], v[176:179]
buffer_load_dword a252, v21, s[36:39], s73 offen
v_mfma_f32_16x16x32_bf16 v[176:179], a[72:75], a[56:59], v[176:179]
ds_read_b64_tr_b16 a[72:73], v8 offset:32768
v_cvt_pk_bf16_f32 v227, v226, v227
v_mfma_f32_16x16x32_bf16 v[180:183], a[80:83], a[56:59], v[180:183]
ds_read_b64_tr_b16 a[74:75], v8 offset:33792
v_cvt_pk_bf16_f32 v226, v224, v225
v_mfma_f32_16x16x32_bf16 v[180:183], a[84:87], a[60:63], v[180:183]
ds_write_b64 v2, v[226:227] offset:11264
v_mfma_f32_16x16x32_bf16 v[172:175], a[84:87], a[52:55], v[172:175]
ds_read_b64_tr_b16 a[76:77], v8 offset:40960
v_cvt_pk_bf16_f32 v235, v234, v235
v_mfma_f32_16x16x32_bf16 v[172:175], a[80:83], a[48:51], v[172:175]
ds_read_b64_tr_b16 a[78:79], v8 offset:41984
v_cvt_pk_bf16_f32 v234, v232, v233
v_mfma_f32_16x16x32_bf16 v[164:167], a[80:83], a[40:43], v[164:167]
ds_write_b64 v3, v[234:235] offset:3072
v_mfma_f32_16x16x32_bf16 v[164:167], a[84:87], a[44:47], v[164:167]
v_cvt_pk_bf16_f32 v243, v242, v243
v_cvt_pk_bf16_f32 v242, v240, v241
v_mfma_f32_16x16x32_bf16 v[156:159], a[84:87], a[36:39], v[156:159]
ds_write_b64 v3, v[242:243] offset:11264
v_mfma_f32_16x16x32_bf16 v[156:159], a[80:83], a[32:35], v[156:159]
ds_read_b64_tr_b16 a[80:81], v9 offset:32768
v_cvt_pk_bf16_f32 v247, v246, v247
v_mfma_f32_16x16x32_bf16 v[24:27], a[88:91], a[32:35], v[24:27]
ds_read_b64_tr_b16 a[82:83], v9 offset:33792
v_cvt_pk_bf16_f32 v246, v244, v245
v_mfma_f32_16x16x32_bf16 v[24:27], a[92:95], a[36:39], v[24:27]
ds_write_b64 v3, v[246:247] offset:11272
v_mfma_f32_16x16x32_bf16 v[40:43], a[92:95], a[44:47], v[40:43]
ds_read_b64_tr_b16 a[84:85], v9 offset:40960
v_cvt_pk_bf16_f32 v239, v238, v239
v_cvt_pk_bf16_f32 v238, v236, v237
v_mfma_f32_16x16x32_bf16 v[40:43], a[88:91], a[40:43], v[40:43]
ds_write_b64 v3, v[238:239] offset:3080
v_mfma_f32_16x16x32_bf16 v[56:59], a[88:91], a[48:51], v[56:59]
ds_read_b64_tr_b16 a[86:87], v9 offset:41984
v_cvt_pk_bf16_f32 v231, v230, v231
v_cvt_pk_bf16_f32 v230, v228, v229
v_mfma_f32_16x16x32_bf16 v[56:59], a[92:95], a[52:55], v[56:59]
ds_write_b64 v2, v[230:231] offset:11272
v_mfma_f32_16x16x32_bf16 v[72:75], a[92:95], a[60:63], v[72:75]
v_cvt_pk_bf16_f32 v223, v222, v223
v_cvt_pk_bf16_f32 v222, v220, v221
v_mfma_f32_16x16x32_bf16 v[72:75], a[88:91], a[56:59], v[72:75]
s_waitcnt lgkmcnt(8)
ds_write_b64 v2, v[222:223] offset:3080
v_mfma_f32_16x16x32_bf16 v[136:139], a[96:99], a[56:59], v[136:139]
ds_read_b64_tr_b16 a[88:89], v10 offset:32768
v_cvt_pk_bf16_f32 v176, v176, v177
v_mfma_f32_16x16x32_bf16 v[136:139], a[100:103], a[60:63], v[136:139]
s_waitcnt lgkmcnt(0)
s_barrier
v_mfma_f32_16x16x32_bf16 v[120:123], a[100:103], a[52:55], v[120:123]
ds_read_b128 a[16:19], v17 offset:16384
v_cvt_pk_bf16_f32 v177, v178, v179
v_mfma_f32_16x16x32_bf16 v[120:123], a[96:99], a[48:51], v[120:123]
ds_read_b64_tr_b16 a[90:91], v10 offset:33792
v_cvt_pk_bf16_f32 v178, v180, v181
v_mfma_f32_16x16x32_bf16 v[104:107], a[96:99], a[40:43], v[104:107]
ds_read_b64_tr_b16 a[92:93], v10 offset:40960
v_cvt_pk_bf16_f32 v179, v182, v183
v_mfma_f32_16x16x32_bf16 v[104:107], a[100:103], a[44:47], v[104:107]
ds_read_b64_tr_b16 a[94:95], v10 offset:41984
v_cvt_pk_bf16_f32 v168, v168, v169
v_mfma_f32_16x16x32_bf16 v[88:91], a[100:103], a[36:39], v[88:91]
v_cvt_pk_bf16_f32 v169, v170, v171
v_cvt_pk_bf16_f32 v170, v172, v173
v_mfma_f32_16x16x32_bf16 v[88:91], a[96:99], a[32:35], v[88:91]
ds_read_b64_tr_b16 a[96:97], v11 offset:32768
v_cvt_pk_bf16_f32 v171, v174, v175
v_mfma_f32_16x16x32_bf16 v[28:31], a[104:107], a[32:35], v[28:31]
s_waitcnt lgkmcnt(4)
buffer_store_dwordx4 a[16:19], v16, s[44:47], s74 offen sc1
v_mfma_f32_16x16x32_bf16 v[28:31], a[108:111], a[36:39], v[28:31]
ds_read_b64_tr_b16 a[98:99], v11 offset:33792
v_cvt_pk_bf16_f32 v160, v160, v161
v_mfma_f32_16x16x32_bf16 v[44:47], a[108:111], a[44:47], v[44:47]
ds_read_b64_tr_b16 a[100:101], v11 offset:40960
v_cvt_pk_bf16_f32 v161, v162, v163
v_mfma_f32_16x16x32_bf16 v[44:47], a[104:107], a[40:43], v[44:47]
s_sub_u32 s81, s3, 1
ds_read_b64_tr_b16 a[102:103], v11 offset:41984
v_cvt_pk_bf16_f32 v162, v164, v165
v_mfma_f32_16x16x32_bf16 v[60:63], a[104:107], a[48:51], v[60:63]
s_sub_u32 s67, s3, 2
ds_read_b128 a[4:7], v2 offset:8192
v_cvt_pk_bf16_f32 v163, v166, v167
v_mfma_f32_16x16x32_bf16 v[60:63], a[108:111], a[52:55], v[60:63]
s_mul_i32 s81, s81, s67
ds_read_b128 a[12:15], v3 offset:8192
v_cvt_pk_bf16_f32 v152, v152, v153
v_mfma_f32_16x16x32_bf16 v[76:79], a[108:111], a[60:63], v[76:79]
s_lshl4_add_u32 s81, s81, s31
ds_read_b64 v[224:225], v2 offset:9216
v_cvt_pk_bf16_f32 v153, v154, v155
v_mfma_f32_16x16x32_bf16 v[76:79], a[104:107], a[56:59], v[76:79]
s_lshl2_add_u32 s81, s81, s30
ds_read_b64 v[228:229], v2 offset:9224
v_cvt_pk_bf16_f32 v154, v156, v157
v_mfma_f32_16x16x32_bf16 v[140:143], a[112:115], a[56:59], v[140:143]
s_mul_i32 s81, s81, 3328
ds_read_b64 v[240:241], v3 offset:9216
v_cvt_pk_bf16_f32 v155, v158, v159
v_mfma_f32_16x16x32_bf16 v[140:143], a[116:119], a[60:63], v[140:143]
s_mov_b32 s73, 0
ds_read_b64 v[244:245], v3 offset:9224
v_or_b32 v20, s66, v252
v_mfma_f32_16x16x32_bf16 v[124:127], a[116:119], a[52:55], v[124:127]
s_mov_b32 s72, 0x4000
v_or_b32 v21, s66, v253
v_or_b32 v22, s66, v254
v_mfma_f32_16x16x32_bf16 v[124:127], a[112:115], a[48:51], v[124:127]
s_lshl_b32 s67, s31, 15
v_or_b32 v23, s66, v255
v_mfma_f32_16x16x32_bf16 v[108:111], a[112:115], a[40:43], v[108:111]
s_add_u32 s67, s67, s78
s_mov_b32 s66, 0x3e8293ee
v_mul_f32 v72, s68, v72
v_mfma_f32_16x16x32_bf16 v[108:111], a[116:119], a[44:47], v[108:111]
s_add_u32 s67, s67, 33554432
v_mul_f32 v73, s68, v73
v_mul_f32 v74, s68, v74
v_mfma_f32_16x16x32_bf16 v[92:95], a[116:119], a[36:39], v[92:95]
s_mul_i32 s74, s3, 1310720
v_mul_f32 v75, s68, v75
v_mul_f32 v136, s68, v136
v_mfma_f32_16x16x32_bf16 v[92:95], a[112:115], a[32:35], v[92:95]
s_add_u32 s74, s74, s67
v_mul_f32 v137, s68, v137
v_mul_f32 v138, s68, v138
v_mfma_f32_16x16x32_bf16 v[32:35], a[72:75], a[32:35], v[32:35]
s_mul_i32 s75, s16, 1310720
v_mul_f32 v139, s68, v139
v_cvt_pk_bf16_f32 v72, v72, v73
v_mfma_f32_16x16x32_bf16 v[32:35], a[76:79], a[36:39], v[32:35]
s_add_u32 s75, s75, s67
v_cvt_pk_bf16_f32 v73, v74, v75
v_cvt_pk_bf16_f32 v74, v136, v137
v_mfma_f32_16x16x32_bf16 v[48:51], a[76:79], a[44:47], v[48:51]
s_mul_i32 s67, s31, 24576
v_cvt_pk_bf16_f32 v75, v138, v139
v_mul_f32 v56, s68, v56
v_mfma_f32_16x16x32_bf16 v[48:51], a[72:75], a[40:43], v[48:51]
s_sub_u32 s67, 1052672, s67
v_mul_f32 v57, s68, v57
v_mul_f32 v58, s68, v58
v_mfma_f32_16x16x32_bf16 v[64:67], a[72:75], a[48:51], v[64:67]
s_add_u32 s64, s74, s67
v_mul_f32 v59, s68, v59
v_mul_f32 v120, s68, v120
v_mfma_f32_16x16x32_bf16 v[64:67], a[76:79], a[52:55], v[64:67]
s_add_u32 s65, s75, s67
v_mul_f32 v121, s68, v121
v_mul_f32 v122, s68, v122
v_mfma_f32_16x16x32_bf16 v[80:83], a[76:79], a[60:63], v[80:83]
s_and_b32 s70, s30, 1
v_mul_f32 v123, s68, v123
v_cvt_pk_bf16_f32 v56, v56, v57
v_mfma_f32_16x16x32_bf16 v[80:83], a[72:75], a[56:59], v[80:83]
s_lshr_b32 s67, s30, 1
v_cvt_pk_bf16_f32 v57, v58, v59
v_cvt_pk_bf16_f32 v58, v120, v121
v_mfma_f32_16x16x32_bf16 v[144:147], a[80:83], a[56:59], v[144:147]
s_lshl3_add_u32 s71, s67, s70
v_cvt_pk_bf16_f32 v59, v122, v123
v_mul_f32 v40, s68, v40
v_mfma_f32_16x16x32_bf16 v[144:147], a[84:87], a[60:63], v[144:147]
s_add_u32 s71, s71, 4
v_mul_f32 v41, s68, v41
v_mul_f32 v42, s68, v42
v_mfma_f32_16x16x32_bf16 v[128:131], a[84:87], a[52:55], v[128:131]
s_lshl_b32 s71, s71, 13
v_mul_f32 v43, s68, v43
v_mul_f32 v104, s68, v104
v_mfma_f32_16x16x32_bf16 v[128:131], a[80:83], a[48:51], v[128:131]
s_lshl_b32 s70, s70, 14
v_mul_f32 v105, s68, v105
v_mul_f32 v106, s68, v106
v_mfma_f32_16x16x32_bf16 v[112:115], a[80:83], a[40:43], v[112:115]
s_mul_i32 s67, s67, 24576
v_mul_f32 v107, s68, v107
v_cvt_pk_bf16_f32 v40, v40, v41
v_mfma_f32_16x16x32_bf16 v[112:115], a[84:87], a[44:47], v[112:115]
s_sub_u32 s70, s70, s67
v_cvt_pk_bf16_f32 v41, v42, v43
v_cvt_pk_bf16_f32 v42, v104, v105
v_mfma_f32_16x16x32_bf16 v[96:99], a[84:87], a[36:39], v[96:99]
s_add_u32 s70, s70, 65536
v_cvt_pk_bf16_f32 v43, v106, v107
v_mul_f32 v24, s68, v24
v_mfma_f32_16x16x32_bf16 v[96:99], a[80:83], a[32:35], v[96:99]
s_waitcnt lgkmcnt(0)
v_mul_f32 v25, s68, v25
v_mul_f32 v26, s68, v26
v_mfma_f32_16x16x32_bf16 v[36:39], a[88:91], a[32:35], v[36:39]
v_mul_f32 v27, s68, v27
v_mul_f32 v88, s68, v88
v_mfma_f32_16x16x32_bf16 v[36:39], a[92:95], a[36:39], v[36:39]
v_mul_f32 v89, s68, v89
v_mul_f32 v90, s68, v90
v_mfma_f32_16x16x32_bf16 v[52:55], a[92:95], a[44:47], v[52:55]
v_mul_f32 v91, s68, v91
v_cvt_pk_bf16_f32 v24, v24, v25
v_mfma_f32_16x16x32_bf16 v[52:55], a[88:91], a[40:43], v[52:55]
v_cvt_pk_bf16_f32 v25, v26, v27
v_cvt_pk_bf16_f32 v26, v88, v89
v_mfma_f32_16x16x32_bf16 v[68:71], a[88:91], a[48:51], v[68:71]
v_cvt_pk_bf16_f32 v27, v90, v91
v_mul_f32 v76, s68, v76
v_mfma_f32_16x16x32_bf16 v[68:71], a[92:95], a[52:55], v[68:71]
v_mul_f32 v77, s68, v77
v_mul_f32 v78, s68, v78
v_mfma_f32_16x16x32_bf16 v[84:87], a[92:95], a[60:63], v[84:87]
v_mul_f32 v79, s68, v79
v_mul_f32 v140, s68, v140
v_mfma_f32_16x16x32_bf16 v[84:87], a[88:91], a[56:59], v[84:87]
v_mul_f32 v141, s68, v141
v_mul_f32 v142, s68, v142
v_mfma_f32_16x16x32_bf16 v[148:151], a[96:99], a[56:59], v[148:151]
v_mul_f32 v143, s68, v143
v_cvt_pk_bf16_f32 v76, v76, v77
v_mfma_f32_16x16x32_bf16 v[148:151], a[100:103], a[60:63], v[148:151]
v_cvt_pk_bf16_f32 v77, v78, v79
v_cvt_pk_bf16_f32 v78, v140, v141
v_mfma_f32_16x16x32_bf16 v[132:135], a[100:103], a[52:55], v[132:135]
v_cvt_pk_bf16_f32 v79, v142, v143
v_mul_f32 v60, s68, v60
v_mfma_f32_16x16x32_bf16 v[132:135], a[96:99], a[48:51], v[132:135]
v_mul_f32 v61, s68, v61
v_mul_f32 v62, s68, v62
v_mfma_f32_16x16x32_bf16 v[116:119], a[96:99], a[40:43], v[116:119]
v_mul_f32 v63, s68, v63
v_mul_f32 v124, s68, v124
v_mfma_f32_16x16x32_bf16 v[116:119], a[100:103], a[44:47], v[116:119]
v_mul_f32 v125, s68, v125
v_mul_f32 v126, s68, v126
v_mfma_f32_16x16x32_bf16 v[100:103], a[100:103], a[36:39], v[100:103]
v_mul_f32 v127, s68, v127
v_cvt_pk_bf16_f32 v60, v60, v61
v_mfma_f32_16x16x32_bf16 v[100:103], a[96:99], a[32:35], v[100:103]
v_cvt_pk_bf16_f32 v61, v62, v63
v_cvt_pk_bf16_f32 v62, v124, v125
v_cvt_pk_bf16_f32 v63, v126, v127
buffer_load_dwordx4 v[88:91], v16, s[44:47], s77 offen sc1
v_mfma_f32_16x16x32_bf16 v[196:199], v[192:195], v[160:163], v[248:251]
v_mfma_f32_16x16x32_bf16 v[212:215], v[208:211], v[176:179], v[248:251]
v_mfma_f32_16x16x32_bf16 v[164:167], a[4:7], v[160:163], v[252:255]
v_mfma_f32_16x16x32_bf16 v[180:183], a[12:15], v[176:179], v[252:255]
s_waitcnt vmcnt(24)
s_waitcnt vmcnt(25)
s_waitcnt vmcnt(26)
s_waitcnt vmcnt(27)
v_accvgpr_read_b32 v4, a64
v_accvgpr_read_b32 v5, a65
v_accvgpr_read_b32 v6, a66
v_accvgpr_read_b32 v7, a67
v_accvgpr_read_b32 v8, a68
v_accvgpr_read_b32 v9, a69
v_accvgpr_read_b32 v10, a70
v_accvgpr_read_b32 v11, a71
v_max3_f32 v121, v196, v197, v198
v_max3_f32 v121, v121, v199, v164
v_max3_f32 v121, v121, v165, v166
v_max_f32 v121, v121, v167
v_max3_f32 v123, v212, v213, v214
v_max3_f32 v123, v123, v215, v180
v_max3_f32 v123, v123, v181, v182
v_max_f32 v123, v123, v183
v_mov_b32 v105, v121
v_mov_b32 v107, v123
v_pk_mul_f32 v[28:29], v[28:29], s[68:69]
v_permlane16_swap_b32 v105, v121
v_permlane16_swap_b32 v107, v123
v_max_f32 v121, v121, v105
v_max_f32 v123, v123, v107
v_mov_b32 v105, v121
v_mov_b32 v107, v123
v_pk_mul_f32 v[30:31], v[30:31], s[68:69]
v_permlane32_swap_b32 v105, v121
v_permlane32_swap_b32 v107, v123
v_max_f32 v121, v121, v105
v_max_f32 v123, v123, v107
v_mul_f32 v121, s66, v121
v_mul_f32 v123, s66, v123
v_fma_f32 v164, v164, s66, -v121
v_fma_f32 v165, v165, s66, -v121
v_fma_f32 v166, v166, s66, -v121
v_fma_f32 v167, v167, s66, -v121
v_fma_f32 v196, v196, s66, -v121
v_fma_f32 v197, v197, s66, -v121
v_fma_f32 v198, v198, s66, -v121
v_fma_f32 v199, v199, s66, -v121
v_exp_f32 v164, v164
v_exp_f32 v165, v165
v_exp_f32 v166, v166
v_exp_f32 v167, v167
v_exp_f32 v196, v196
v_exp_f32 v197, v197
v_exp_f32 v198, v198
v_exp_f32 v199, v199
v_cvt_pk_bf16_f32 v164, v164, v165
v_cvt_pk_bf16_f32 v165, v166, v167
v_cvt_pk_bf16_f32 v166, v196, v197
v_cvt_pk_bf16_f32 v167, v198, v199
v_pk_mul_f32 v[92:93], v[92:93], s[68:69]
v_pk_mul_f32 v[94:95], v[94:95], s[68:69]
v_mfma_f32_16x16x32_bf16 v[196:199], a[244:247], v[164:167], 0
v_mfma_f32_16x16x32_bf16 v[160:163], v[224:227], v[164:167], 0
v_mfma_f32_16x16x32_bf16 v[192:195], v[228:231], v[164:167], 0
v_fma_f32 v180, v180, s66, -v123
v_fma_f32 v181, v181, s66, -v123
v_fma_f32 v182, v182, s66, -v123
v_fma_f32 v183, v183, s66, -v123
v_fma_f32 v212, v212, s66, -v123
v_fma_f32 v213, v213, s66, -v123
v_fma_f32 v214, v214, s66, -v123
v_fma_f32 v215, v215, s66, -v123
v_exp_f32 v180, v180
v_exp_f32 v181, v181
v_exp_f32 v182, v182
v_exp_f32 v183, v183
v_exp_f32 v212, v212
v_exp_f32 v213, v213
v_exp_f32 v214, v214
v_exp_f32 v215, v215
v_cvt_pk_bf16_f32 v180, v180, v181
v_cvt_pk_bf16_f32 v181, v182, v183
v_cvt_pk_bf16_f32 v182, v212, v213
v_cvt_pk_bf16_f32 v183, v214, v215
v_cvt_pk_bf16_f32 v28, v28, v29
v_cvt_pk_bf16_f32 v29, v30, v31
v_mfma_f32_16x16x32_bf16 v[212:215], a[244:247], v[180:183], 0
v_mfma_f32_16x16x32_bf16 v[176:179], v[240:243], v[180:183], 0
v_mfma_f32_16x16x32_bf16 v[208:211], v[244:247], v[180:183], 0
v_cvt_pk_bf16_f32 v30, v92, v93
v_cvt_pk_bf16_f32 v31, v94, v95
v_pk_mul_f32 v[44:45], v[44:45], s[68:69]
v_pk_mul_f32 v[46:47], v[46:47], s[68:69]
v_pk_mul_f32 v[108:109], v[108:109], s[68:69]
v_pk_mul_f32 v[110:111], v[110:111], s[68:69]
v_rcp_f32 v121, v196
v_rcp_f32 v123, v212
v_mul_f32 v121, v121, v7
v_mul_f32 v123, v123, v11
v_mul_f32 v160, v160, v121
v_mul_f32 v161, v161, v121
v_mul_f32 v162, v162, v121
v_mul_f32 v163, v163, v121
v_mul_f32 v192, v192, v121
v_mul_f32 v193, v193, v121
v_mul_f32 v194, v194, v121
v_mul_f32 v195, v195, v121
v_cvt_pk_bf16_f32 v160, v160, v161
v_cvt_pk_bf16_f32 v161, v162, v163
v_cvt_pk_bf16_f32 v162, v192, v193
v_cvt_pk_bf16_f32 v163, v194, v195
buffer_store_dwordx4 v[160:163], v16, s[44:47], s64 offen sc1
v_mul_f32 v176, v176, v123
v_mul_f32 v177, v177, v123
v_mul_f32 v178, v178, v123
v_mul_f32 v179, v179, v123
v_mul_f32 v208, v208, v123
v_mul_f32 v209, v209, v123
v_mul_f32 v210, v210, v123
v_mul_f32 v211, v211, v123
v_cvt_pk_bf16_f32 v176, v176, v177
v_cvt_pk_bf16_f32 v177, v178, v179
v_cvt_pk_bf16_f32 v178, v208, v209
v_cvt_pk_bf16_f32 v179, v210, v211
buffer_store_dwordx4 v[176:179], v16, s[44:47], s65 offen sc1
v_cvt_pk_bf16_f32 v44, v44, v45
v_cvt_pk_bf16_f32 v45, v46, v47
v_cvt_pk_bf16_f32 v46, v108, v109
v_cvt_pk_bf16_f32 v47, v110, v111
v_pk_mul_f32 v[32:33], v[32:33], s[68:69]
v_pk_mul_f32 v[34:35], v[34:35], s[68:69]
v_pk_mul_f32 v[96:97], v[96:97], s[68:69]
v_pk_mul_f32 v[98:99], v[98:99], s[68:69]
v_cvt_pk_bf16_f32 v32, v32, v33
v_cvt_pk_bf16_f32 v33, v34, v35
v_cvt_pk_bf16_f32 v34, v96, v97
v_cvt_pk_bf16_f32 v35, v98, v99
v_pk_mul_f32 v[48:49], v[48:49], s[68:69]
v_pk_mul_f32 v[50:51], v[50:51], s[68:69]
v_pk_mul_f32 v[112:113], v[112:113], s[68:69]
v_pk_mul_f32 v[114:115], v[114:115], s[68:69]
v_cvt_pk_bf16_f32 v48, v48, v49
v_cvt_pk_bf16_f32 v49, v50, v51
v_cvt_pk_bf16_f32 v50, v112, v113
v_cvt_pk_bf16_f32 v51, v114, v115
v_pk_mul_f32 v[64:65], v[64:65], s[68:69]
v_pk_mul_f32 v[66:67], v[66:67], s[68:69]
v_pk_mul_f32 v[128:129], v[128:129], s[68:69]
v_pk_mul_f32 v[130:131], v[130:131], s[68:69]
s_waitcnt vmcnt(2)
L_hchk:
v_max3_u32 v1, v88, v89, v90
v_max_u32 v1, v1, v91
v_cmp_eq_u32 vcc, -1, v1
s_cbranch_vccnz L_hretry
L_hgo:
ds_write_b128 v17, v[88:91]
s_sub_u32 s64, s64, 4096
s_sub_u32 s65, s65, 4096
v_cvt_pk_bf16_f32 v64, v64, v65
v_cvt_pk_bf16_f32 v65, v66, v67
v_cvt_pk_bf16_f32 v66, v128, v129
v_cvt_pk_bf16_f32 v67, v130, v131
v_pk_mul_f32 v[80:81], v[80:81], s[68:69]
v_pk_mul_f32 v[82:83], v[82:83], s[68:69]
v_pk_mul_f32 v[144:145], v[144:145], s[68:69]
v_pk_mul_f32 v[146:147], v[146:147], s[68:69]
s_waitcnt lgkmcnt(0)
s_barrier
ds_read_b128 a[0:3], v2 offset:0
ds_read_b128 a[8:11], v3 offset:0
ds_read_b64 v[216:217], v2 offset:1024
ds_read_b64 v[220:221], v2 offset:1032
ds_read_b64 v[232:233], v3 offset:1024
ds_read_b64 v[236:237], v3 offset:1032
v_cvt_pk_bf16_f32 v80, v80, v81
v_cvt_pk_bf16_f32 v81, v82, v83
v_cvt_pk_bf16_f32 v82, v144, v145
v_cvt_pk_bf16_f32 v83, v146, v147
v_pk_mul_f32 v[36:37], v[36:37], s[68:69]
v_pk_mul_f32 v[38:39], v[38:39], s[68:69]
v_pk_mul_f32 v[100:101], v[100:101], s[68:69]
v_pk_mul_f32 v[102:103], v[102:103], s[68:69]
v_cvt_pk_bf16_f32 v36, v36, v37
v_cvt_pk_bf16_f32 v37, v38, v39
v_cvt_pk_bf16_f32 v38, v100, v101
v_cvt_pk_bf16_f32 v39, v102, v103
v_pk_mul_f32 v[52:53], v[52:53], s[68:69]
v_pk_mul_f32 v[54:55], v[54:55], s[68:69]
v_pk_mul_f32 v[116:117], v[116:117], s[68:69]
v_pk_mul_f32 v[118:119], v[118:119], s[68:69]
v_mfma_f32_16x16x32_bf16 v[188:191], v[184:187], v[152:155], v[248:251]
v_mfma_f32_16x16x32_bf16 v[204:207], v[200:203], v[168:171], v[248:251]
s_waitcnt lgkmcnt(5)
v_mfma_f32_16x16x32_bf16 v[156:159], a[0:3], v[152:155], v[20:23]
s_waitcnt lgkmcnt(4)
v_mfma_f32_16x16x32_bf16 v[172:175], a[8:11], v[168:171], v[252:255]
v_cvt_pk_bf16_f32 v52, v52, v53
v_cvt_pk_bf16_f32 v53, v54, v55
v_cvt_pk_bf16_f32 v54, v116, v117
v_cvt_pk_bf16_f32 v55, v118, v119
v_pk_mul_f32 v[68:69], v[68:69], s[68:69]
v_pk_mul_f32 v[70:71], v[70:71], s[68:69]
v_pk_mul_f32 v[132:133], v[132:133], s[68:69]
v_pk_mul_f32 v[134:135], v[134:135], s[68:69]
v_max3_f32 v120, v188, v189, v190
v_max3_f32 v120, v120, v191, v156
v_max3_f32 v120, v120, v157, v158
v_max_f32 v120, v120, v159
v_max3_f32 v122, v204, v205, v206
v_max3_f32 v122, v122, v207, v172
v_max3_f32 v122, v122, v173, v174
v_max_f32 v122, v122, v175
v_mov_b32 v104, v120
v_mov_b32 v106, v122
v_cvt_pk_bf16_f32 v68, v68, v69
v_permlane16_swap_b32 v104, v120
v_permlane16_swap_b32 v106, v122
v_max_f32 v120, v120, v104
v_max_f32 v122, v122, v106
v_mov_b32 v104, v120
v_mov_b32 v106, v122
v_cvt_pk_bf16_f32 v69, v70, v71
v_permlane32_swap_b32 v104, v120
v_permlane32_swap_b32 v106, v122
v_max_f32 v120, v120, v104
v_max_f32 v122, v122, v106
v_mul_f32 v120, s66, v120
v_mul_f32 v122, s66, v122
v_fma_f32 v156, v156, s66, -v120
v_fma_f32 v157, v157, s66, -v120
v_fma_f32 v158, v158, s66, -v120
v_fma_f32 v159, v159, s66, -v120
v_fma_f32 v188, v188, s66, -v120
v_fma_f32 v189, v189, s66, -v120
v_fma_f32 v190, v190, s66, -v120
v_fma_f32 v191, v191, s66, -v120
v_exp_f32 v156, v156
v_exp_f32 v157, v157
v_exp_f32 v158, v158
v_exp_f32 v159, v159
v_exp_f32 v188, v188
v_exp_f32 v189, v189
v_exp_f32 v190, v190
v_exp_f32 v191, v191
v_cvt_pk_bf16_f32 v156, v156, v157
v_cvt_pk_bf16_f32 v157, v158, v159
v_cvt_pk_bf16_f32 v158, v188, v189
v_cvt_pk_bf16_f32 v159, v190, v191
v_cvt_pk_bf16_f32 v70, v132, v133
v_cvt_pk_bf16_f32 v71, v134, v135
v_mfma_f32_16x16x32_bf16 v[188:191], a[244:247], v[156:159], 0
s_waitcnt lgkmcnt(3)
v_mfma_f32_16x16x32_bf16 v[152:155], v[216:219], v[156:159], 0
s_waitcnt lgkmcnt(2)
v_mfma_f32_16x16x32_bf16 v[184:187], v[220:223], v[156:159], 0
v_fma_f32 v172, v172, s66, -v122
v_fma_f32 v173, v173, s66, -v122
v_fma_f32 v174, v174, s66, -v122
v_fma_f32 v175, v175, s66, -v122
v_fma_f32 v204, v204, s66, -v122
v_fma_f32 v205, v205, s66, -v122
v_fma_f32 v206, v206, s66, -v122
v_fma_f32 v207, v207, s66, -v122
v_exp_f32 v172, v172
v_exp_f32 v173, v173
v_exp_f32 v174, v174
v_exp_f32 v175, v175
v_exp_f32 v204, v204
v_exp_f32 v205, v205
v_exp_f32 v206, v206
v_exp_f32 v207, v207
v_cvt_pk_bf16_f32 v172, v172, v173
v_cvt_pk_bf16_f32 v173, v174, v175
v_cvt_pk_bf16_f32 v174, v204, v205
v_cvt_pk_bf16_f32 v175, v206, v207
v_pk_mul_f32 v[84:85], v[84:85], s[68:69]
v_pk_mul_f32 v[86:87], v[86:87], s[68:69]
v_mfma_f32_16x16x32_bf16 v[204:207], a[244:247], v[172:175], 0
s_waitcnt lgkmcnt(1)
v_mfma_f32_16x16x32_bf16 v[168:171], v[232:235], v[172:175], 0
s_waitcnt lgkmcnt(0)
v_mfma_f32_16x16x32_bf16 v[200:203], v[236:239], v[172:175], 0
v_pk_mul_f32 v[148:149], v[148:149], s[68:69]
v_pk_mul_f32 v[150:151], v[150:151], s[68:69]
v_cvt_pk_bf16_f32 v84, v84, v85
v_cvt_pk_bf16_f32 v85, v86, v87
v_cvt_pk_bf16_f32 v86, v148, v149
v_cvt_pk_bf16_f32 v87, v150, v151
v_rcp_f32 v120, v188
v_rcp_f32 v122, v204
v_mul_f32 v120, v120, v5
v_mul_f32 v122, v122, v9
v_mul_f32 v152, v152, v120
v_mul_f32 v153, v153, v120
v_mul_f32 v154, v154, v120
v_mul_f32 v155, v155, v120
v_mul_f32 v184, v184, v120
v_mul_f32 v185, v185, v120
v_mul_f32 v186, v186, v120
v_mul_f32 v187, v187, v120
v_cvt_pk_bf16_f32 v152, v152, v153
v_cvt_pk_bf16_f32 v153, v154, v155
v_cvt_pk_bf16_f32 v154, v184, v185
v_cvt_pk_bf16_f32 v155, v186, v187
buffer_store_dwordx4 v[152:155], v16, s[44:47], s64 offen sc1
v_mul_f32 v168, v168, v122
v_mul_f32 v169, v169, v122
v_mul_f32 v170, v170, v122
v_mul_f32 v171, v171, v122
v_mul_f32 v200, v200, v122
v_mul_f32 v201, v201, v122
v_mul_f32 v202, v202, v122
v_mul_f32 v203, v203, v122
v_cvt_pk_bf16_f32 v168, v168, v169
v_cvt_pk_bf16_f32 v169, v170, v171
v_cvt_pk_bf16_f32 v170, v200, v201
v_cvt_pk_bf16_f32 v171, v202, v203
buffer_store_dwordx4 v[168:171], v16, s[44:47], s65 offen sc1
v_mov_b32 v17, 0xff800000
L_attstart_7:
v_mov_b32 v2, v16
v_add_u32 v3, 0x10000, v16
v_mov_b32 v1, 0
s_waitcnt lgkmcnt(0)
s_barrier
s_cmp_eq_u32 s3, 0
s_cbranch_scc1 L_F1
ds_read_b128 a[144:147], v2 offset:0
ds_read_b128 a[148:151], v2 offset:1024
ds_read_b128 a[152:155], v2 offset:2048
ds_read_b128 a[156:159], v2 offset:3072
ds_read_b128 a[160:163], v2 offset:4096
ds_read_b128 a[164:167], v2 offset:5120
ds_read_b128 a[168:171], v2 offset:6144
ds_read_b128 a[172:175], v2 offset:7168
s_mov_b32 m0, s71
s_nop 0
buffer_load_dwordx4 v16, s[32:35], s70 offen offset:0 sc1 lds
buffer_load_dwordx4 v16, s[32:35], s70 offen offset:1024 sc1 lds
s_waitcnt lgkmcnt(7)
v_mfma_f32_16x16x32_bf16 v[88:91], a[144:147], v[24:27], 0
s_waitcnt lgkmcnt(6)
ds_read_b128 a[176:179], v2 offset:8192
ds_read_b128 a[180:183], v2 offset:9216
v_mfma_f32_16x16x32_bf16 v[88:91], a[148:151], v[28:31], v[88:91]
s_waitcnt lgkmcnt(7)
ds_read_b128 a[184:187], v2 offset:10240
ds_read_b128 a[188:191], v2 offset:11264
v_mfma_f32_16x16x32_bf16 v[88:91], a[152:155], v[32:35], v[88:91]
s_waitcnt lgkmcnt(8)
buffer_load_dwordx4 v16, s[32:35], s70 offen offset:2048 sc1 lds
v_mfma_f32_16x16x32_bf16 v[88:91], a[156:159], v[36:39], v[88:91]
ds_read_b128 a[192:195], v2 offset:12288
ds_read_b128 a[196:199], v2 offset:13312
v_mfma_f32_16x16x32_bf16 v[104:107], a[156:159], v[52:55], 0
v_mfma_f32_16x16x32_bf16 v[104:107], a[152:155], v[48:51], v[104:107]
ds_read_b128 a[200:203], v2 offset:14336
v_mfma_f32_16x16x32_bf16 v[104:107], a[148:151], v[44:47], v[104:107]
v_mfma_f32_16x16x32_bf16 v[104:107], a[144:147], v[40:43], v[104:107]
ds_read_b128 a[204:207], v2 offset:15360
v_mfma_f32_16x16x32_bf16 v[120:123], a[144:147], v[56:59], 0
v_mfma_f32_16x16x32_bf16 v[120:123], a[148:151], v[60:63], v[120:123]
buffer_load_dwordx4 v16, s[32:35], s70 offen offset:3072 sc1 lds
v_mfma_f32_16x16x32_bf16 v[120:123], a[152:155], v[64:67], v[120:123]
v_mfma_f32_16x16x32_bf16 v[120:123], a[156:159], v[68:71], v[120:123]
v_mfma_f32_16x16x32_bf16 v[136:139], a[156:159], v[84:87], 0
v_mfma_f32_16x16x32_bf16 v[136:139], a[152:155], v[80:83], v[136:139]
v_mfma_f32_16x16x32_bf16 v[136:139], a[148:151], v[76:79], v[136:139]
v_mfma_f32_16x16x32_bf16 v[136:139], a[144:147], v[72:75], v[136:139]
s_waitcnt lgkmcnt(0)
s_nop 1
v_max3_f32 v20, v88, v89, v90
v_max_f32 v20, v20, v91
v_max3_f32 v21, v104, v105, v106
v_max_f32 v21, v21, v107
v_max3_f32 v22, v120, v121, v122
v_max_f32 v22, v22, v123
v_max3_f32 v23, v136, v137, v138
v_max_f32 v23, v23, v139
v_mov_b32 v248, v20
v_mov_b32 v249, v21
v_mov_b32 v250, v22
v_mov_b32 v251, v23
v_permlane16_swap_b32 v248, v20
v_permlane16_swap_b32 v249, v21
v_permlane16_swap_b32 v250, v22
v_permlane16_swap_b32 v251, v23
v_max_f32 v20, v20, v248
v_max_f32 v21, v21, v249
v_max_f32 v22, v22, v250
v_max_f32 v23, v23, v251
v_mov_b32 v248, v20
v_mov_b32 v249, v21
v_mov_b32 v250, v22
v_mov_b32 v251, v23
v_permlane32_swap_b32 v248, v20
v_permlane32_swap_b32 v249, v21
v_permlane32_swap_b32 v250, v22
v_permlane32_swap_b32 v251, v23
v_max_f32 v20, v20, v248
v_max_f32 v21, v21, v249
v_max_f32 v22, v22, v250
v_max_f32 v23, v23, v251
s_cmp_eq_u32 s73, 0
s_cselect_b64 vcc, 0, -1
v_cndmask_b32 v20, v20, v252, vcc
v_cndmask_b32 v21, v21, v253, vcc
v_cndmask_b32 v22, v22, v254, vcc
v_cndmask_b32 v23, v23, v255, vcc
v_sub_f32 v228, 0, v23
v_sub_f32 v229, 0, v23
v_sub_f32 v230, 0, v23
v_sub_f32 v231, 0, v23
v_sub_f32 v224, 0, v22
v_sub_f32 v225, 0, v22
v_sub_f32 v226, 0, v22
v_sub_f32 v227, 0, v22
v_sub_f32 v220, 0, v21
v_sub_f32 v221, 0, v21
v_sub_f32 v222, 0, v21
v_sub_f32 v223, 0, v21
v_sub_f32 v216, 0, v20
v_sub_f32 v217, 0, v20
v_sub_f32 v218, 0, v20
v_sub_f32 v219, 0, v20
v_mfma_f32_16x16x32_bf16 v[140:143], a[160:163], v[72:75], v[228:231]
s_add_u32 m0, s71, 4096
v_add_f32 v88, v88, v216
v_add_f32 v89, v89, v216
v_mfma_f32_16x16x32_bf16 v[140:143], a[164:167], v[76:79], v[140:143]
v_add_f32 v90, v90, v216
v_add_f32 v91, v91, v216
v_exp_f32 v88, v88
v_mfma_f32_16x16x32_bf16 v[140:143], a[168:171], v[80:83], v[140:143]
s_add_u32 s64, s70, 4096
v_exp_f32 v89, v89
v_mfma_f32_16x16x32_bf16 v[140:143], a[172:175], v[84:87], v[140:143]
buffer_load_dwordx4 v16, s[32:35], s64 offen offset:0 sc1 lds
v_mfma_f32_16x16x32_bf16 v[124:127], a[172:175], v[68:71], v[224:227]
v_exp_f32 v90, v90
v_mfma_f32_16x16x32_bf16 v[124:127], a[168:171], v[64:67], v[124:127]
v_exp_f32 v91, v91
v_mfma_f32_16x16x32_bf16 v[124:127], a[164:167], v[60:63], v[124:127]
v_add_f32 v104, v104, v220
v_add_f32 v105, v105, v220
v_add_f32 v106, v106, v220
v_add_f32 v107, v107, v220
v_exp_f32 v104, v104
v_mfma_f32_16x16x32_bf16 v[124:127], a[160:163], v[56:59], v[124:127]
v_exp_f32 v105, v105
v_mfma_f32_16x16x32_bf16 v[108:111], a[160:163], v[40:43], v[220:223]
v_exp_f32 v106, v106
v_mfma_f32_16x16x32_bf16 v[108:111], a[164:167], v[44:47], v[108:111]
buffer_load_dwordx4 v16, s[32:35], s64 offen offset:1024 sc1 lds
v_mfma_f32_16x16x32_bf16 v[108:111], a[168:171], v[48:51], v[108:111]
v_cvt_pk_bf16_f32 v152, v88, v89
v_add_f32 v120, v120, v224
v_mfma_f32_16x16x32_bf16 v[108:111], a[172:175], v[52:55], v[108:111]
v_exp_f32 v107, v107
v_mfma_f32_16x16x32_bf16 v[92:95], a[172:175], v[36:39], v[216:219]
v_add_f32 v121, v121, v224
v_add_f32 v122, v122, v224
v_add_f32 v123, v123, v224
v_exp_f32 v120, v120
v_mfma_f32_16x16x32_bf16 v[92:95], a[168:171], v[32:35], v[92:95]
v_cvt_pk_bf16_f32 v153, v90, v91
v_exp_f32 v121, v121
v_mfma_f32_16x16x32_bf16 v[92:95], a[164:167], v[28:31], v[92:95]
v_exp_f32 v122, v122
v_mfma_f32_16x16x32_bf16 v[92:95], a[160:163], v[24:27], v[92:95]
v_exp_f32 v123, v123
v_mfma_f32_16x16x32_bf16 v[96:99], a[176:179], v[24:27], v[216:219]
v_cvt_pk_bf16_f32 v160, v104, v105
v_add_f32 v136, v136, v228
v_mfma_f32_16x16x32_bf16 v[96:99], a[180:183], v[28:31], v[96:99]
buffer_load_dwordx4 v16, s[32:35], s64 offen offset:2048 sc1 lds
v_add_f32 v137, v137, v228
v_add_f32 v138, v138, v228
v_add_f32 v139, v139, v228
v_exp_f32 v136, v136
v_mfma_f32_16x16x32_bf16 v[96:99], a[184:187], v[32:35], v[96:99]
v_exp_f32 v137, v137
v_mfma_f32_16x16x32_bf16 v[96:99], a[188:191], v[36:39], v[96:99]
v_cvt_pk_bf16_f32 v161, v106, v107
v_cvt_pk_bf16_f32 v184, v120, v121
v_mfma_f32_16x16x32_bf16 v[112:115], a[188:191], v[52:55], v[220:223]
v_exp_f32 v138, v138
v_mfma_f32_16x16x32_bf16 v[112:115], a[184:187], v[48:51], v[112:115]
v_exp_f32 v139, v139
v_mfma_f32_16x16x32_bf16 v[112:115], a[180:183], v[44:47], v[112:115]
v_exp_f32 v140, v140
v_mfma_f32_16x16x32_bf16 v[112:115], a[176:179], v[40:43], v[112:115]
v_exp_f32 v141, v141
v_mfma_f32_16x16x32_bf16 v[128:131], a[176:179], v[56:59], v[224:227]
buffer_load_dwordx4 v16, s[32:35], s64 offen offset:3072 sc1 lds
v_cvt_pk_bf16_f32 v185, v122, v123
v_mfma_f32_16x16x32_bf16 v[128:131], a[180:183], v[60:63], v[128:131]
v_exp_f32 v142, v142
v_mfma_f32_16x16x32_bf16 v[128:131], a[184:187], v[64:67], v[128:131]
v_exp_f32 v143, v143
v_mfma_f32_16x16x32_bf16 v[128:131], a[188:191], v[68:71], v[128:131]
v_cvt_pk_bf16_f32 v192, v136, v137
v_cvt_pk_bf16_f32 v193, v138, v139
v_mfma_f32_16x16x32_bf16 v[144:147], a[188:191], v[84:87], v[228:231]
v_exp_f32 v124, v124
v_mfma_f32_16x16x32_bf16 v[144:147], a[184:187], v[80:83], v[144:147]
v_exp_f32 v125, v125
v_mfma_f32_16x16x32_bf16 v[144:147], a[180:183], v[76:79], v[144:147]
s_waitcnt vmcnt(8)
s_barrier
v_mfma_f32_16x16x32_bf16 v[144:147], a[176:179], v[72:75], v[144:147]
v_exp_f32 v126, v126
v_mfma_f32_16x16x32_bf16 v[148:151], a[192:195], v[72:75], v[228:231]
v_cvt_pk_bf16_f32 v194, v140, v141
v_cvt_pk_bf16_f32 v195, v142, v143
v_mfma_f32_16x16x32_bf16 v[148:151], a[196:199], v[76:79], v[148:151]
v_exp_f32 v127, v127
v_mfma_f32_16x16x32_bf16 v[148:151], a[200:203], v[80:83], v[148:151]
s_xor_b32 s71, s71, 16384
v_exp_f32 v108, v108
v_mfma_f32_16x16x32_bf16 v[148:151], a[204:207], v[84:87], v[148:151]
s_add_u32 s70, s70, 32768
v_exp_f32 v109, v109
v_mfma_f32_16x16x32_bf16 v[132:135], a[204:207], v[68:71], v[224:227]
s_mov_b32 m0, s71
v_exp_f32 v110, v110
v_mfma_f32_16x16x32_bf16 v[132:135], a[200:203], v[64:67], v[132:135]
buffer_load_dwordx4 v16, s[32:35], s70 offen offset:0 sc1 lds
v_mfma_f32_16x16x32_bf16 v[132:135], a[196:199], v[60:63], v[132:135]
v_cvt_pk_bf16_f32 v186, v124, v125
v_exp_f32 v111, v111
v_mfma_f32_16x16x32_bf16 v[132:135], a[192:195], v[56:59], v[132:135]
v_exp_f32 v92, v92
v_mfma_f32_16x16x32_bf16 v[116:119], a[192:195], v[40:43], v[220:223]
v_exp_f32 v93, v93
v_mfma_f32_16x16x32_bf16 v[116:119], a[196:199], v[44:47], v[116:119]
ds_read_b128 a[144:147], v2 offset:16384
v_cvt_pk_bf16_f32 v187, v126, v127
v_mfma_f32_16x16x32_bf16 v[116:119], a[200:203], v[48:51], v[116:119]
v_exp_f32 v94, v94
v_mfma_f32_16x16x32_bf16 v[116:119], a[204:207], v[52:55], v[116:119]
ds_read_b128 a[148:151], v2 offset:17408
v_cvt_pk_bf16_f32 v162, v108, v109
v_mfma_f32_16x16x32_bf16 v[100:103], a[204:207], v[36:39], v[216:219]
ds_read_b128 a[152:155], v2 offset:18432
buffer_load_dwordx4 v16, s[32:35], s70 offen offset:1024 sc1 lds
v_exp_f32 v95, v95
v_mfma_f32_16x16x32_bf16 v[100:103], a[200:203], v[32:35], v[100:103]
ds_read_b128 a[156:159], v2 offset:19456
v_exp_f32 v96, v96
v_mfma_f32_16x16x32_bf16 v[100:103], a[196:199], v[28:31], v[100:103]
v_cvt_pk_bf16_f32 v163, v110, v111
v_exp_f32 v97, v97
v_mfma_f32_16x16x32_bf16 v[100:103], a[192:195], v[24:27], v[100:103]
s_waitcnt lgkmcnt(3)
ds_read_b128 a[160:163], v2 offset:20480
ds_read_b128 a[164:167], v2 offset:21504
ds_read_b128 a[168:171], v2 offset:22528
ds_read_b128 a[172:175], v2 offset:23552
v_mfma_f32_16x16x32_bf16 v[88:91], a[144:147], v[24:27], v[216:219]
s_waitcnt lgkmcnt(6)
v_exp_f32 v98, v98
v_mfma_f32_16x16x32_bf16 v[88:91], a[148:151], v[28:31], v[88:91]
s_waitcnt lgkmcnt(5)
v_cvt_pk_bf16_f32 v154, v92, v93
v_exp_f32 v99, v99
v_mfma_f32_16x16x32_bf16 v[88:91], a[152:155], v[32:35], v[88:91]
s_waitcnt lgkmcnt(4)
v_exp_f32 v112, v112
v_mfma_f32_16x16x32_bf16 v[88:91], a[156:159], v[36:39], v[88:91]
v_exp_f32 v113, v113
v_mfma_f32_16x16x32_bf16 v[104:107], a[156:159], v[52:55], v[220:223]
v_cvt_pk_bf16_f32 v155, v94, v95
v_cvt_pk_bf16_f32 v156, v96, v97
v_mfma_f32_16x16x32_bf16 v[104:107], a[152:155], v[48:51], v[104:107]
buffer_load_dwordx4 v16, s[32:35], s70 offen offset:2048 sc1 lds
v_exp_f32 v114, v114
v_mfma_f32_16x16x32_bf16 v[104:107], a[148:151], v[44:47], v[104:107]
v_exp_f32 v115, v115
v_mfma_f32_16x16x32_bf16 v[104:107], a[144:147], v[40:43], v[104:107]
v_exp_f32 v128, v128
v_mfma_f32_16x16x32_bf16 v[120:123], a[144:147], v[56:59], v[224:227]
v_exp_f32 v129, v129
v_mfma_f32_16x16x32_bf16 v[120:123], a[148:151], v[60:63], v[120:123]
v_cvt_pk_bf16_f32 v157, v98, v99
v_cvt_pk_bf16_f32 v164, v112, v113
v_mfma_f32_16x16x32_bf16 v[120:123], a[152:155], v[64:67], v[120:123]
v_exp_f32 v130, v130
v_mfma_f32_16x16x32_bf16 v[120:123], a[156:159], v[68:71], v[120:123]
v_exp_f32 v131, v131
v_mfma_f32_16x16x32_bf16 v[136:139], a[156:159], v[84:87], v[228:231]
v_exp_f32 v144, v144
v_mfma_f32_16x16x32_bf16 v[136:139], a[152:155], v[80:83], v[136:139]
v_exp_f32 v145, v145
v_mfma_f32_16x16x32_bf16 v[136:139], a[148:151], v[76:79], v[136:139]
v_exp_f32 v146, v146
v_mfma_f32_16x16x32_bf16 v[136:139], a[144:147], v[72:75], v[136:139]
s_waitcnt lgkmcnt(0)
v_cvt_pk_bf16_f32 v165, v114, v115
v_cvt_pk_bf16_f32 v188, v128, v129
v_mfma_f32_16x16x32_bf16 v[140:143], a[160:163], v[72:75], v[228:231]
v_exp_f32 v147, v147
v_mfma_f32_16x16x32_bf16 v[140:143], a[164:167], v[76:79], v[140:143]
v_exp_f32 v148, v148
v_mfma_f32_16x16x32_bf16 v[140:143], a[168:171], v[80:83], v[140:143]
v_exp_f32 v149, v149
v_mfma_f32_16x16x32_bf16 v[140:143], a[172:175], v[84:87], v[140:143]
buffer_load_dwordx4 v16, s[32:35], s70 offen offset:3072 sc1 lds
v_mfma_f32_16x16x32_bf16 v[124:127], a[172:175], v[68:71], v[224:227]
v_cvt_pk_bf16_f32 v189, v130, v131
v_cvt_pk_bf16_f32 v196, v144, v145
v_mfma_f32_16x16x32_bf16 v[124:127], a[168:171], v[64:67], v[124:127]
v_exp_f32 v150, v150
v_mfma_f32_16x16x32_bf16 v[124:127], a[164:167], v[60:63], v[124:127]
v_exp_f32 v151, v151
v_mfma_f32_16x16x32_bf16 v[124:127], a[160:163], v[56:59], v[124:127]
v_exp_f32 v132, v132
v_mfma_f32_16x16x32_bf16 v[108:111], a[160:163], v[40:43], v[220:223]
ds_read_b128 a[176:179], v2 offset:24576
v_cvt_pk_bf16_f32 v197, v146, v147
v_mfma_f32_16x16x32_bf16 v[108:111], a[164:167], v[44:47], v[108:111]
ds_read_b128 a[180:183], v2 offset:25600
v_cvt_pk_bf16_f32 v198, v148, v149
v_mfma_f32_16x16x32_bf16 v[108:111], a[168:171], v[48:51], v[108:111]
ds_read_b128 a[184:187], v2 offset:26624
v_exp_f32 v133, v133
v_mfma_f32_16x16x32_bf16 v[108:111], a[172:175], v[52:55], v[108:111]
ds_read_b128 a[188:191], v2 offset:27648
v_exp_f32 v134, v134
v_mfma_f32_16x16x32_bf16 v[92:95], a[172:175], v[36:39], v[216:219]
v_exp_f32 v135, v135
v_mfma_f32_16x16x32_bf16 v[92:95], a[168:171], v[32:35], v[92:95]
v_exp_f32 v116, v116
v_mfma_f32_16x16x32_bf16 v[92:95], a[164:167], v[28:31], v[92:95]
v_exp_f32 v117, v117
v_mfma_f32_16x16x32_bf16 v[92:95], a[160:163], v[24:27], v[92:95]
s_waitcnt lgkmcnt(2)
v_cvt_pk_bf16_f32 v199, v150, v151
v_cvt_pk_bf16_f32 v190, v132, v133
v_mfma_f32_16x16x32_bf16 v[96:99], a[176:179], v[24:27], v[216:219]
v_exp_f32 v118, v118
v_mfma_f32_16x16x32_bf16 v[96:99], a[180:183], v[28:31], v[96:99]
s_waitcnt lgkmcnt(0)
v_exp_f32 v119, v119
v_mfma_f32_16x16x32_bf16 v[96:99], a[184:187], v[32:35], v[96:99]
s_add_u32 m0, s71, 4096
v_exp_f32 v100, v100
v_mfma_f32_16x16x32_bf16 v[96:99], a[188:191], v[36:39], v[96:99]
s_add_u32 s64, s70, 4096
v_exp_f32 v101, v101
v_mfma_f32_16x16x32_bf16 v[112:115], a[188:191], v[52:55], v[220:223]
buffer_load_dwordx4 v16, s[32:35], s64 offen offset:0 sc1 lds
v_mfma_f32_16x16x32_bf16 v[112:115], a[184:187], v[48:51], v[112:115]
v_cvt_pk_bf16_f32 v191, v134, v135
v_cvt_pk_bf16_f32 v166, v116, v117
v_mfma_f32_16x16x32_bf16 v[112:115], a[180:183], v[44:47], v[112:115]
v_exp_f32 v102, v102
v_mfma_f32_16x16x32_bf16 v[112:115], a[176:179], v[40:43], v[112:115]
v_exp_f32 v103, v103
v_mfma_f32_16x16x32_bf16 v[128:131], a[176:179], v[56:59], v[224:227]
s_lshl_b32 s66, s30, 30
ds_read_b128 a[192:195], v2 offset:28672
v_cvt_pk_bf16_f32 v167, v118, v119
v_mfma_f32_16x16x32_bf16 v[128:131], a[180:183], v[60:63], v[128:131]
ds_read_b128 a[196:199], v2 offset:29696
v_exp_f32 v88, v88
v_mfma_f32_16x16x32_bf16 v[128:131], a[184:187], v[64:67], v[128:131]
ds_read_b128 a[200:203], v2 offset:30720
v_exp_f32 v89, v89
v_mfma_f32_16x16x32_bf16 v[128:131], a[188:191], v[68:71], v[128:131]
ds_read_b128 a[204:207], v2 offset:31744
v_cvt_pk_bf16_f32 v158, v100, v101
v_mfma_f32_16x16x32_bf16 v[144:147], a[188:191], v[84:87], v[228:231]
v_exp_f32 v90, v90
v_mfma_f32_16x16x32_bf16 v[144:147], a[184:187], v[80:83], v[144:147]
v_exp_f32 v91, v91
v_mfma_f32_16x16x32_bf16 v[144:147], a[180:183], v[76:79], v[144:147]
v_exp_f32 v104, v104
v_mfma_f32_16x16x32_bf16 v[144:147], a[176:179], v[72:75], v[144:147]
s_waitcnt lgkmcnt(2)
v_exp_f32 v105, v105
v_mfma_f32_16x16x32_bf16 v[148:151], a[192:195], v[72:75], v[228:231]
v_cvt_pk_bf16_f32 v159, v102, v103
v_cvt_pk_bf16_f32 v168, v88, v89
v_mfma_f32_16x16x32_bf16 v[148:151], a[196:199], v[76:79], v[148:151]
s_waitcnt lgkmcnt(0)
v_exp_f32 v106, v106
v_mfma_f32_16x16x32_bf16 v[148:151], a[200:203], v[80:83], v[148:151]
v_exp_f32 v107, v107
v_mfma_f32_16x16x32_bf16 v[148:151], a[204:207], v[84:87], v[148:151]
v_exp_f32 v120, v120
v_mfma_f32_16x16x32_bf16 v[132:135], a[204:207], v[68:71], v[224:227]
buffer_load_dwordx4 v16, s[32:35], s64 offen offset:1024 sc1 lds
v_mfma_f32_16x16x32_bf16 v[132:135], a[200:203], v[64:67], v[132:135]
v_cvt_pk_bf16_f32 v169, v90, v91
v_cvt_pk_bf16_f32 v176, v104, v105
v_mfma_f32_16x16x32_bf16 v[132:135], a[196:199], v[60:63], v[132:135]
v_exp_f32 v121, v121
v_mfma_f32_16x16x32_bf16 v[132:135], a[192:195], v[56:59], v[132:135]
v_exp_f32 v122, v122
v_mfma_f32_16x16x32_bf16 v[116:119], a[192:195], v[40:43], v[220:223]
v_exp_f32 v123, v123
v_mfma_f32_16x16x32_bf16 v[116:119], a[196:199], v[44:47], v[116:119]
v_exp_f32 v136, v136
v_mfma_f32_16x16x32_bf16 v[116:119], a[200:203], v[48:51], v[116:119]
v_exp_f32 v137, v137
v_mfma_f32_16x16x32_bf16 v[116:119], a[204:207], v[52:55], v[116:119]
v_cvt_pk_bf16_f32 v177, v106, v107
v_cvt_pk_bf16_f32 v200, v120, v121
v_mfma_f32_16x16x32_bf16 v[100:103], a[204:207], v[36:39], v[216:219]
v_exp_f32 v138, v138
v_mfma_f32_16x16x32_bf16 v[100:103], a[200:203], v[32:35], v[100:103]
v_exp_f32 v139, v139
v_mfma_f32_16x16x32_bf16 v[100:103], a[196:199], v[28:31], v[100:103]
v_exp_f32 v140, v140
v_mfma_f32_16x16x32_bf16 v[100:103], a[192:195], v[24:27], v[100:103]
ds_read_b128 a[144:147], v3 offset:16384
v_cvt_pk_bf16_f32 v201, v122, v123
v_mfma_f32_16x16x32_bf16 a[128:131], a[244:247], v[152:155], 0
ds_read_b128 a[148:151], v3 offset:24576
v_cvt_pk_bf16_f32 v208, v136, v137
v_mfma_f32_16x16x32_bf16 a[128:131], a[244:247], v[156:159], a[128:131]
v_exp_f32 v141, v141
v_mfma_f32_16x16x32_bf16 a[132:135], a[244:247], v[160:163], 0
v_exp_f32 v142, v142
v_mfma_f32_16x16x32_bf16 a[132:135], a[244:247], v[164:167], a[132:135]
v_exp_f32 v143, v143
v_mfma_f32_16x16x32_bf16 a[136:139], a[244:247], v[184:187], 0
buffer_load_dwordx4 v16, s[32:35], s64 offen offset:2048 sc1 lds
v_mfma_f32_16x16x32_bf16 a[136:139], a[244:247], v[188:191], a[136:139]
v_exp_f32 v124, v124
v_mfma_f32_16x16x32_bf16 a[140:143], a[244:247], v[192:195], 0
v_exp_f32 v125, v125
v_mfma_f32_16x16x32_bf16 a[140:143], a[244:247], v[196:199], a[140:143]
s_waitcnt lgkmcnt(0)
ds_read_b128 a[152:155], v3 offset:17408
v_cvt_pk_bf16_f32 v209, v138, v139
v_mfma_f32_16x16x32_bf16 a[0:3], a[144:147], v[152:155], 0
v_exp_f32 v126, v126
v_mfma_f32_16x16x32_bf16 a[0:3], a[148:151], v[156:159], a[0:3]
ds_read_b128 a[156:159], v3 offset:25600
v_cvt_pk_bf16_f32 v210, v140, v141
v_mfma_f32_16x16x32_bf16 a[32:35], a[148:151], v[164:167], 0
v_exp_f32 v127, v127
v_mfma_f32_16x16x32_bf16 a[32:35], a[144:147], v[160:163], a[32:35]
v_exp_f32 v108, v108
v_mfma_f32_16x16x32_bf16 a[64:67], a[144:147], v[184:187], 0
v_exp_f32 v109, v109
v_mfma_f32_16x16x32_bf16 a[64:67], a[148:151], v[188:191], a[64:67]
v_cvt_pk_bf16_f32 v211, v142, v143
v_cvt_pk_bf16_f32 v202, v124, v125
v_mfma_f32_16x16x32_bf16 a[96:99], a[148:151], v[196:199], 0
v_exp_f32 v110, v110
v_mfma_f32_16x16x32_bf16 a[96:99], a[144:147], v[192:195], a[96:99]
s_waitcnt lgkmcnt(0)
ds_read_b128 a[160:163], v3 offset:18432
v_cvt_pk_bf16_f32 v203, v126, v127
v_mfma_f32_16x16x32_bf16 a[100:103], a[152:155], v[192:195], 0
v_exp_f32 v111, v111
v_mfma_f32_16x16x32_bf16 a[100:103], a[156:159], v[196:199], a[100:103]
ds_read_b128 a[164:167], v3 offset:26624
v_cvt_pk_bf16_f32 v178, v108, v109
v_mfma_f32_16x16x32_bf16 a[68:71], a[156:159], v[188:191], 0
v_exp_f32 v92, v92
v_mfma_f32_16x16x32_bf16 a[68:71], a[152:155], v[184:187], a[68:71]
v_exp_f32 v93, v93
v_mfma_f32_16x16x32_bf16 a[36:39], a[152:155], v[160:163], 0
v_exp_f32 v94, v94
v_mfma_f32_16x16x32_bf16 a[36:39], a[156:159], v[164:167], a[36:39]
buffer_load_dwordx4 v16, s[32:35], s64 offen offset:3072 sc1 lds
v_mfma_f32_16x16x32_bf16 a[4:7], a[156:159], v[156:159], 0
v_exp_f32 v95, v95
v_mfma_f32_16x16x32_bf16 a[4:7], a[152:155], v[152:155], a[4:7]
s_waitcnt lgkmcnt(0)
v_exp_f32 v96, v96
v_mfma_f32_16x16x32_bf16 a[8:11], a[160:163], v[152:155], 0
ds_read_b128 a[168:171], v3 offset:19456
v_cvt_pk_bf16_f32 v179, v110, v111
v_mfma_f32_16x16x32_bf16 a[8:11], a[164:167], v[156:159], a[8:11]
ds_read_b128 a[172:175], v3 offset:27648
v_exp_f32 v97, v97
v_mfma_f32_16x16x32_bf16 a[40:43], a[164:167], v[164:167], 0
v_exp_f32 v98, v98
v_mfma_f32_16x16x32_bf16 a[40:43], a[160:163], v[160:163], a[40:43]
v_exp_f32 v99, v99
v_mfma_f32_16x16x32_bf16 a[72:75], a[160:163], v[184:187], 0
v_cvt_pk_bf16_f32 v170, v92, v93
v_cvt_pk_bf16_f32 v171, v94, v95
v_mfma_f32_16x16x32_bf16 a[72:75], a[164:167], v[188:191], a[72:75]
v_exp_f32 v112, v112
v_mfma_f32_16x16x32_bf16 a[104:107], a[164:167], v[196:199], 0
v_exp_f32 v113, v113
v_mfma_f32_16x16x32_bf16 a[104:107], a[160:163], v[192:195], a[104:107]
s_waitcnt lgkmcnt(0)
ds_read_b128 a[176:179], v3 offset:20480
v_cvt_pk_bf16_f32 v172, v96, v97
v_mfma_f32_16x16x32_bf16 a[108:111], a[168:171], v[192:195], 0
v_exp_f32 v114, v114
v_mfma_f32_16x16x32_bf16 a[108:111], a[172:175], v[196:199], a[108:111]
ds_read_b128 a[180:183], v3 offset:28672
v_xor_b32 v2, 0x8000, v2
v_mfma_f32_16x16x32_bf16 a[76:79], a[172:175], v[188:191], 0
v_exp_f32 v115, v115
v_mfma_f32_16x16x32_bf16 a[76:79], a[168:171], v[184:187], a[76:79]
ds_read_b128 a[184:187], v3 offset:21504
ds_read_b128 a[188:191], v3 offset:29696
ds_read_b128 a[192:195], v3 offset:22528
ds_read_b128 a[196:199], v3 offset:30720
ds_read_b128 a[200:203], v3 offset:23552
ds_read_b128 a[204:207], v3 offset:31744
v_mfma_f32_16x16x32_bf16 a[44:47], a[168:171], v[160:163], 0
s_waitcnt vmcnt(8)
s_barrier
v_cvt_pk_bf16_f32 v173, v98, v99
v_exp_f32 v128, v128
v_mfma_f32_16x16x32_bf16 a[44:47], a[172:175], v[164:167], a[44:47]
v_exp_f32 v129, v129
v_mfma_f32_16x16x32_bf16 a[12:15], a[172:175], v[156:159], 0
v_exp_f32 v130, v130
v_mfma_f32_16x16x32_bf16 a[12:15], a[168:171], v[152:155], a[12:15]
s_waitcnt lgkmcnt(6)
v_cvt_pk_bf16_f32 v180, v112, v113
v_cvt_pk_bf16_f32 v181, v114, v115
v_mfma_f32_16x16x32_bf16 a[16:19], a[176:179], v[152:155], 0
s_xor_b32 s71, s71, 49152
v_exp_f32 v131, v131
v_mfma_f32_16x16x32_bf16 a[16:19], a[180:183], v[156:159], a[16:19]
s_add_u32 s70, s70, 32768
v_exp_f32 v144, v144
v_mfma_f32_16x16x32_bf16 a[48:51], a[180:183], v[164:167], 0
s_mov_b32 m0, s71
v_exp_f32 v145, v145
v_mfma_f32_16x16x32_bf16 a[48:51], a[176:179], v[160:163], a[48:51]
buffer_load_dwordx4 v16, s[32:35], s70 offen offset:0 sc1 lds
v_mfma_f32_16x16x32_bf16 a[80:83], a[176:179], v[184:187], 0
v_exp_f32 v146, v146
v_mfma_f32_16x16x32_bf16 a[80:83], a[180:183], v[188:191], a[80:83]
v_cvt_pk_bf16_f32 v204, v128, v129
v_cvt_pk_bf16_f32 v205, v130, v131
v_mfma_f32_16x16x32_bf16 a[112:115], a[180:183], v[196:199], 0
v_exp_f32 v147, v147
v_mfma_f32_16x16x32_bf16 a[112:115], a[176:179], v[192:195], a[112:115]
s_waitcnt lgkmcnt(0)
v_exp_f32 v148, v148
v_mfma_f32_16x16x32_bf16 a[116:119], a[184:187], v[192:195], 0
v_exp_f32 v149, v149
v_mfma_f32_16x16x32_bf16 a[116:119], a[188:191], v[196:199], a[116:119]
v_exp_f32 v150, v150
v_mfma_f32_16x16x32_bf16 a[84:87], a[188:191], v[188:191], 0
v_exp_f32 v151, v151
v_mfma_f32_16x16x32_bf16 a[84:87], a[184:187], v[184:187], a[84:87]
v_cvt_pk_bf16_f32 v212, v144, v145
v_cvt_pk_bf16_f32 v213, v146, v147
v_mfma_f32_16x16x32_bf16 a[52:55], a[184:187], v[160:163], 0
v_exp_f32 v132, v132
v_mfma_f32_16x16x32_bf16 a[52:55], a[188:191], v[164:167], a[52:55]
v_exp_f32 v133, v133
v_mfma_f32_16x16x32_bf16 a[20:23], a[188:191], v[156:159], 0
ds_read_b128 a[144:147], v2 offset:0
v_lshl_add_u32 v19, v0, 24, s66
v_mfma_f32_16x16x32_bf16 a[20:23], a[184:187], v[152:155], a[20:23]
s_lshr_b32 s67, s31, 4
v_exp_f32 v134, v134
v_mfma_f32_16x16x32_bf16 a[24:27], a[192:195], v[152:155], 0
s_lshl1_add_u32 s67, s3, s67
v_exp_f32 v135, v135
v_mfma_f32_16x16x32_bf16 a[24:27], a[196:199], v[156:159], a[24:27]
s_lshl_b32 s79, s67, 8
v_cvt_pk_bf16_f32 v214, v148, v149
v_cvt_pk_bf16_f32 v215, v150, v151
v_mfma_f32_16x16x32_bf16 a[56:59], a[196:199], v[164:167], 0
s_add_u32 s79, s79, 8192
v_exp_f32 v116, v116
v_mfma_f32_16x16x32_bf16 a[56:59], a[192:195], v[160:163], a[56:59]
s_add_u32 s69, s31, 12
buffer_load_dwordx4 v16, s[32:35], s70 offen offset:1024 sc1 lds
v_mfma_f32_16x16x32_bf16 a[88:91], a[192:195], v[184:187], 0
s_lshr_b32 s69, s69, 5
v_exp_f32 v117, v117
v_mfma_f32_16x16x32_bf16 a[88:91], a[196:199], v[188:191], a[88:91]
s_lshl1_add_u32 s69, s3, s69
v_exp_f32 v118, v118
v_mfma_f32_16x16x32_bf16 a[120:123], a[196:199], v[196:199], 0
s_lshl_b32 s69, s69, 8
v_exp_f32 v119, v119
v_mfma_f32_16x16x32_bf16 a[120:123], a[192:195], v[192:195], a[120:123]
s_add_u32 s69, s69, 8192
s_add_u32 s17, s78, L_D-L_pc+0
v_cvt_pk_bf16_f32 v206, v132, v133
v_cvt_pk_bf16_f32 v207, v134, v135
v_mfma_f32_16x16x32_bf16 a[124:127], a[200:203], v[192:195], 0
s_lshl_b32 s67, s73, 16
buffer_load_dword a252, v16, s[88:91], s17 offen
v_mfma_f32_16x16x32_bf16 a[124:127], a[204:207], v[196:199], a[124:127]
s_xor_b32 s68, s80, 256
v_exp_f32 v100, v100
v_mfma_f32_16x16x32_bf16 a[92:95], a[204:207], v[188:191], 0
s_add_u32 s68, s68, s67
v_exp_f32 v101, v101
v_mfma_f32_16x16x32_bf16 a[92:95], a[200:203], v[184:187], a[92:95]
s_add_u32 s67, s67, s69
s_add_u32 s17, s78, L_D-L_pc+4096
ds_read_b128 a[148:151], v2 offset:1024
v_cvt_pk_bf16_f32 v182, v116, v117
v_mfma_f32_16x16x32_bf16 a[60:63], a[200:203], v[160:163], 0
buffer_load_dword a252, v16, s[88:91], s17 offen
ds_read_b128 a[152:155], v2 offset:2048
v_exp_f32 v102, v102
v_mfma_f32_16x16x32_bf16 a[60:63], a[204:207], v[164:167], a[60:63]
s_add_u32 s17, s78, L_D-L_pc+8192
ds_read_b128 a[156:159], v2 offset:3072
v_cvt_pk_bf16_f32 v183, v118, v119
v_mfma_f32_16x16x32_bf16 a[28:31], a[204:207], v[156:159], 0
s_mov_b64 exec, 1
buffer_atomic_add a251, v19, s[52:55], s67 offen offset:0 sc1
buffer_atomic_add a251, v19, s[52:55], s68 offen offset:0 sc1
s_mov_b64 exec, -1
v_exp_f32 v103, v103
v_mfma_f32_16x16x32_bf16 a[28:31], a[200:203], v[152:155], a[28:31]
ds_read_b128 a[160:163], v2 offset:4096
buffer_load_dword a252, v16, s[88:91], s17 offen
ds_read_b128 a[164:167], v2 offset:5120
ds_read_b128 a[168:171], v2 offset:6144
ds_read_b128 a[172:175], v2 offset:7168
v_mul_u32_u24 v19, 52, v0
v_cvt_pk_bf16_f32 v174, v100, v101
v_cvt_pk_bf16_f32 v175, v102, v103
v_xor_b32 v3, 0x8000, v3
s_sub_u32 s72, s3, 1
s_cmp_eq_u32 s72, 0
s_cbranch_scc1 L_DD
.p2align 3
L_D:
s_waitcnt lgkmcnt(7)
v_mfma_f32_16x16x32_bf16 v[88:91], a[144:147], v[24:27], v[216:219]
s_waitcnt lgkmcnt(6)
ds_read_b128 a[176:179], v2 offset:8192
v_mfma_f32_16x16x32_bf16 v[88:91], a[148:151], v[28:31], v[88:91]
s_waitcnt lgkmcnt(6)
ds_read_b128 a[180:183], v2 offset:9216
v_mfma_f32_16x16x32_bf16 v[88:91], a[152:155], v[32:35], v[88:91]
s_waitcnt lgkmcnt(6)
buffer_load_dwordx4 v16, s[32:35], s70 offen offset:2048 sc1 lds
v_mfma_f32_16x16x32_bf16 v[88:91], a[156:159], v[36:39], v[88:91]
ds_read_b128 a[184:187], v2 offset:10240
v_mfma_f32_16x16x32_bf16 v[104:107], a[156:159], v[52:55], v[220:223]
v_mfma_f32_16x16x32_bf16 v[104:107], a[152:155], v[48:51], v[104:107]
buffer_load_dword a252, v19, s[40:43], s81 offen
v_mfma_f32_16x16x32_bf16 v[104:107], a[148:151], v[44:47], v[104:107]
ds_read_b128 a[188:191], v2 offset:11264
v_mfma_f32_16x16x32_bf16 v[104:107], a[144:147], v[40:43], v[104:107]
v_mfma_f32_16x16x32_bf16 v[120:123], a[144:147], v[56:59], v[224:227]
v_mfma_f32_16x16x32_bf16 v[120:123], a[148:151], v[60:63], v[120:123]
v_mfma_f32_16x16x32_bf16 v[120:123], a[152:155], v[64:67], v[120:123]
v_exp_f32 v88, v88
v_mfma_f32_16x16x32_bf16 v[120:123], a[156:159], v[68:71], v[120:123]
v_exp_f32 v89, v89
v_mfma_f32_16x16x32_bf16 v[136:139], a[156:159], v[84:87], v[228:231]
v_exp_f32 v90, v90
v_mfma_f32_16x16x32_bf16 v[136:139], a[152:155], v[80:83], v[136:139]
v_exp_f32 v91, v91
v_mfma_f32_16x16x32_bf16 v[136:139], a[148:151], v[76:79], v[136:139]
v_exp_f32 v104, v104
v_mfma_f32_16x16x32_bf16 v[136:139], a[144:147], v[72:75], v[136:139]
s_waitcnt lgkmcnt(0)
s_add_u32 s81, s81, 425984
v_exp_f32 v105, v105
v_mfma_f32_16x16x32_bf16 v[140:143], a[160:163], v[72:75], v[228:231]
v_exp_f32 v106, v106
v_mfma_f32_16x16x32_bf16 v[140:143], a[164:167], v[76:79], v[140:143]
v_exp_f32 v107, v107
v_mfma_f32_16x16x32_bf16 v[140:143], a[168:171], v[80:83], v[140:143]
buffer_load_dwordx4 v16, s[32:35], s70 offen offset:3072 sc1 lds
v_mfma_f32_16x16x32_bf16 v[140:143], a[172:175], v[84:87], v[140:143]
v_cvt_pk_bf16_f32 v152, v88, v89
v_cvt_pk_bf16_f32 v153, v90, v91
v_mfma_f32_16x16x32_bf16 v[124:127], a[172:175], v[68:71], v[224:227]
v_exp_f32 v120, v120
v_mfma_f32_16x16x32_bf16 v[124:127], a[168:171], v[64:67], v[124:127]
v_exp_f32 v121, v121
v_mfma_f32_16x16x32_bf16 v[124:127], a[164:167], v[60:63], v[124:127]
v_exp_f32 v122, v122
v_mfma_f32_16x16x32_bf16 v[124:127], a[160:163], v[56:59], v[124:127]
v_exp_f32 v123, v123
v_mfma_f32_16x16x32_bf16 v[108:111], a[160:163], v[40:43], v[220:223]
v_exp_f32 v136, v136
v_mfma_f32_16x16x32_bf16 v[108:111], a[164:167], v[44:47], v[108:111]
v_exp_f32 v137, v137
v_mfma_f32_16x16x32_bf16 v[108:111], a[168:171], v[48:51], v[108:111]
v_exp_f32 v138, v138
v_mfma_f32_16x16x32_bf16 v[108:111], a[172:175], v[52:55], v[108:111]
v_cvt_pk_bf16_f32 v160, v104, v105
v_cvt_pk_bf16_f32 v161, v106, v107
v_mfma_f32_16x16x32_bf16 v[92:95], a[172:175], v[36:39], v[216:219]
v_exp_f32 v139, v139
v_mfma_f32_16x16x32_bf16 v[92:95], a[168:171], v[32:35], v[92:95]
ds_read_b128 a[192:195], v2 offset:12288
v_cvt_pk_bf16_f32 v184, v120, v121
v_mfma_f32_16x16x32_bf16 v[92:95], a[164:167], v[28:31], v[92:95]
ds_read_b128 a[196:199], v2 offset:13312
v_cvt_pk_bf16_f32 v185, v122, v123
v_mfma_f32_16x16x32_bf16 v[92:95], a[160:163], v[24:27], v[92:95]
v_exp_f32 v140, v140
v_mfma_f32_16x16x32_bf16 v[96:99], a[176:179], v[24:27], v[216:219]
s_add_u32 m0, s71, 4096
ds_read_b128 a[200:203], v2 offset:14336
v_cvt_pk_bf16_f32 v192, v136, v137
v_mfma_f32_16x16x32_bf16 v[96:99], a[180:183], v[28:31], v[96:99]
s_add_u32 s64, s70, 4096
ds_read_b128 a[204:207], v2 offset:15360
v_cvt_pk_bf16_f32 v193, v138, v139
v_mfma_f32_16x16x32_bf16 v[96:99], a[184:187], v[32:35], v[96:99]
buffer_load_dwordx4 v16, s[32:35], s64 offen offset:0 sc1 lds
v_mfma_f32_16x16x32_bf16 v[96:99], a[188:191], v[36:39], v[96:99]
v_exp_f32 v141, v141
v_mfma_f32_16x16x32_bf16 v[112:115], a[188:191], v[52:55], v[220:223]
v_exp_f32 v142, v142
v_mfma_f32_16x16x32_bf16 v[112:115], a[184:187], v[48:51], v[112:115]
v_exp_f32 v143, v143
v_mfma_f32_16x16x32_bf16 v[112:115], a[180:183], v[44:47], v[112:115]
v_exp_f32 v124, v124
v_mfma_f32_16x16x32_bf16 v[112:115], a[176:179], v[40:43], v[112:115]
v_exp_f32 v125, v125
v_mfma_f32_16x16x32_bf16 v[128:131], a[176:179], v[56:59], v[224:227]
v_exp_f32 v126, v126
v_mfma_f32_16x16x32_bf16 v[128:131], a[180:183], v[60:63], v[128:131]
v_exp_f32 v127, v127
v_mfma_f32_16x16x32_bf16 v[128:131], a[184:187], v[64:67], v[128:131]
v_exp_f32 v108, v108
v_mfma_f32_16x16x32_bf16 v[128:131], a[188:191], v[68:71], v[128:131]
v_exp_f32 v109, v109
v_mfma_f32_16x16x32_bf16 v[144:147], a[188:191], v[84:87], v[228:231]
v_exp_f32 v110, v110
v_mfma_f32_16x16x32_bf16 v[144:147], a[184:187], v[80:83], v[144:147]
v_exp_f32 v111, v111
v_mfma_f32_16x16x32_bf16 v[144:147], a[180:183], v[76:79], v[144:147]
ds_read_b128 a[144:147], v3 offset:0
v_cvt_pk_bf16_f32 v194, v140, v141
v_mfma_f32_16x16x32_bf16 v[144:147], a[176:179], v[72:75], v[144:147]
s_waitcnt lgkmcnt(1)
ds_read_b128 a[148:151], v3 offset:8192
v_cvt_pk_bf16_f32 v195, v142, v143
v_mfma_f32_16x16x32_bf16 v[148:151], a[192:195], v[72:75], v[228:231]
v_exp_f32 v92, v92
v_mfma_f32_16x16x32_bf16 v[148:151], a[196:199], v[76:79], v[148:151]
v_exp_f32 v93, v93
v_mfma_f32_16x16x32_bf16 v[148:151], a[200:203], v[80:83], v[148:151]
buffer_load_dwordx4 v16, s[32:35], s64 offen offset:1024 sc1 lds
v_mfma_f32_16x16x32_bf16 v[148:151], a[204:207], v[84:87], v[148:151]
v_exp_f32 v94, v94
v_mfma_f32_16x16x32_bf16 v[132:135], a[204:207], v[68:71], v[224:227]
v_exp_f32 v95, v95
v_mfma_f32_16x16x32_bf16 v[132:135], a[200:203], v[64:67], v[132:135]
ds_read_b128 a[152:155], v3 offset:1024
v_cvt_pk_bf16_f32 v186, v124, v125
v_mfma_f32_16x16x32_bf16 v[132:135], a[196:199], v[60:63], v[132:135]
v_exp_f32 v96, v96
v_mfma_f32_16x16x32_bf16 v[132:135], a[192:195], v[56:59], v[132:135]
ds_read_b128 a[156:159], v3 offset:9216
v_cvt_pk_bf16_f32 v187, v126, v127
v_mfma_f32_16x16x32_bf16 v[116:119], a[192:195], v[40:43], v[220:223]
v_exp_f32 v97, v97
v_mfma_f32_16x16x32_bf16 v[116:119], a[196:199], v[44:47], v[116:119]
v_exp_f32 v98, v98
v_mfma_f32_16x16x32_bf16 v[116:119], a[200:203], v[48:51], v[116:119]
v_exp_f32 v99, v99
v_mfma_f32_16x16x32_bf16 v[116:119], a[204:207], v[52:55], v[116:119]
ds_read_b128 a[160:163], v3 offset:2048
v_cvt_pk_bf16_f32 v162, v108, v109
v_mfma_f32_16x16x32_bf16 v[100:103], a[204:207], v[36:39], v[216:219]
v_exp_f32 v112, v112
v_mfma_f32_16x16x32_bf16 v[100:103], a[200:203], v[32:35], v[100:103]
ds_read_b128 a[164:167], v3 offset:10240
v_cvt_pk_bf16_f32 v163, v110, v111
v_mfma_f32_16x16x32_bf16 v[100:103], a[196:199], v[28:31], v[100:103]
v_exp_f32 v113, v113
v_mfma_f32_16x16x32_bf16 v[100:103], a[192:195], v[24:27], v[100:103]
v_exp_f32 v114, v114
v_mfma_f32_16x16x32_bf16 a[128:131], a[244:247], v[168:171], a[128:131]
v_exp_f32 v115, v115
v_mfma_f32_16x16x32_bf16 a[128:131], a[244:247], v[172:175], a[128:131]
v_exp_f32 v128, v128
v_mfma_f32_16x16x32_bf16 a[132:135], a[244:247], v[176:179], a[132:135]
buffer_load_dwordx4 v16, s[32:35], s64 offen offset:2048 sc1 lds
v_mfma_f32_16x16x32_bf16 a[132:135], a[244:247], v[180:183], a[132:135]
ds_read_b128 a[168:171], v3 offset:3072
v_cvt_pk_bf16_f32 v154, v92, v93
v_mfma_f32_16x16x32_bf16 a[136:139], a[244:247], v[200:203], a[136:139]
ds_read_b128 a[172:175], v3 offset:11264
v_cvt_pk_bf16_f32 v155, v94, v95
v_mfma_f32_16x16x32_bf16 a[136:139], a[244:247], v[204:207], a[136:139]
v_exp_f32 v129, v129
v_mfma_f32_16x16x32_bf16 a[140:143], a[244:247], v[208:211], a[140:143]
v_exp_f32 v130, v130
v_mfma_f32_16x16x32_bf16 a[140:143], a[244:247], v[212:215], a[140:143]
s_waitcnt lgkmcnt(2)
v_exp_f32 v131, v131
v_mfma_f32_16x16x32_bf16 a[0:3], a[144:147], v[168:171], a[0:3]
v_exp_f32 v144, v144
v_mfma_f32_16x16x32_bf16 a[0:3], a[148:151], v[172:175], a[0:3]
ds_read_b128 a[176:179], v3 offset:4096
v_cvt_pk_bf16_f32 v156, v96, v97
v_mfma_f32_16x16x32_bf16 a[32:35], a[148:151], v[180:183], a[32:35]
ds_read_b128 a[180:183], v3 offset:12288
v_cvt_pk_bf16_f32 v157, v98, v99
v_mfma_f32_16x16x32_bf16 a[32:35], a[144:147], v[176:179], a[32:35]
v_exp_f32 v145, v145
v_mfma_f32_16x16x32_bf16 a[64:67], a[144:147], v[200:203], a[64:67]
ds_read_b128 a[184:187], v3 offset:5120
v_cvt_pk_bf16_f32 v164, v112, v113
v_mfma_f32_16x16x32_bf16 a[64:67], a[148:151], v[204:207], a[64:67]
ds_read_b128 a[188:191], v3 offset:13312
v_cvt_pk_bf16_f32 v165, v114, v115
v_mfma_f32_16x16x32_bf16 a[96:99], a[148:151], v[212:215], a[96:99]
ds_read_b128 a[192:195], v3 offset:6144
v_cvt_pk_bf16_f32 v188, v128, v129
v_mfma_f32_16x16x32_bf16 a[96:99], a[144:147], v[208:211], a[96:99]
v_exp_f32 v146, v146
v_mfma_f32_16x16x32_bf16 a[100:103], a[152:155], v[208:211], a[100:103]
v_exp_f32 v147, v147
v_mfma_f32_16x16x32_bf16 a[100:103], a[156:159], v[212:215], a[100:103]
ds_read_b128 a[196:199], v3 offset:14336
v_cvt_pk_bf16_f32 v189, v130, v131
v_mfma_f32_16x16x32_bf16 a[68:71], a[156:159], v[204:207], a[68:71]
buffer_load_dwordx4 v16, s[32:35], s64 offen offset:3072 sc1 lds
v_mfma_f32_16x16x32_bf16 a[68:71], a[152:155], v[200:203], a[68:71]
v_exp_f32 v148, v148
v_mfma_f32_16x16x32_bf16 a[36:39], a[152:155], v[176:179], a[36:39]
v_exp_f32 v149, v149
v_mfma_f32_16x16x32_bf16 a[36:39], a[156:159], v[180:183], a[36:39]
ds_read_b128 a[200:203], v3 offset:7168
v_cvt_pk_bf16_f32 v196, v144, v145
v_mfma_f32_16x16x32_bf16 a[4:7], a[156:159], v[172:175], a[4:7]
v_exp_f32 v150, v150
v_mfma_f32_16x16x32_bf16 a[4:7], a[152:155], v[168:171], a[4:7]
v_exp_f32 v151, v151
v_mfma_f32_16x16x32_bf16 a[8:11], a[160:163], v[168:171], a[8:11]
v_exp_f32 v132, v132
v_mfma_f32_16x16x32_bf16 a[8:11], a[164:167], v[172:175], a[8:11]
ds_read_b128 a[204:207], v3 offset:15360
v_cvt_pk_bf16_f32 v197, v146, v147
v_mfma_f32_16x16x32_bf16 a[40:43], a[164:167], v[180:183], a[40:43]
v_exp_f32 v133, v133
v_mfma_f32_16x16x32_bf16 a[40:43], a[160:163], v[176:179], a[40:43]
v_exp_f32 v134, v134
v_mfma_f32_16x16x32_bf16 a[72:75], a[160:163], v[200:203], a[72:75]
v_exp_f32 v135, v135
v_mfma_f32_16x16x32_bf16 a[72:75], a[164:167], v[204:207], a[72:75]
v_exp_f32 v116, v116
v_mfma_f32_16x16x32_bf16 a[104:107], a[164:167], v[212:215], a[104:107]
v_exp_f32 v117, v117
v_mfma_f32_16x16x32_bf16 a[104:107], a[160:163], v[208:211], a[104:107]
s_waitcnt lgkmcnt(0)
v_exp_f32 v118, v118
v_mfma_f32_16x16x32_bf16 a[108:111], a[168:171], v[208:211], a[108:111]
v_exp_f32 v119, v119
v_mfma_f32_16x16x32_bf16 a[108:111], a[172:175], v[212:215], a[108:111]
v_exp_f32 v100, v100
v_mfma_f32_16x16x32_bf16 a[76:79], a[172:175], v[204:207], a[76:79]
v_exp_f32 v101, v101
v_mfma_f32_16x16x32_bf16 a[76:79], a[168:171], v[200:203], a[76:79]
v_exp_f32 v102, v102
v_mfma_f32_16x16x32_bf16 a[44:47], a[168:171], v[176:179], a[44:47]
s_waitcnt vmcnt(9)
s_barrier
v_mfma_f32_16x16x32_bf16 a[44:47], a[172:175], v[180:183], a[44:47]
s_xor_b32 s71, s71, 16384
ds_read_b128 a[144:147], v2 offset:16384
v_cvt_pk_bf16_f32 v198, v148, v149
v_mfma_f32_16x16x32_bf16 a[12:15], a[172:175], v[172:175], a[12:15]
s_add_u32 s70, s70, 32768
ds_read_b128 a[148:151], v2 offset:17408
v_cvt_pk_bf16_f32 v199, v150, v151
v_mfma_f32_16x16x32_bf16 a[12:15], a[168:171], v[168:171], a[12:15]
s_mov_b32 m0, s71
ds_read_b128 a[152:155], v2 offset:18432
v_cvt_pk_bf16_f32 v190, v132, v133
v_mfma_f32_16x16x32_bf16 a[16:19], a[176:179], v[168:171], a[16:19]
buffer_load_dwordx4 v16, s[32:35], s70 offen offset:0 sc1 lds
v_mfma_f32_16x16x32_bf16 a[16:19], a[180:183], v[172:175], a[16:19]
ds_read_b128 a[156:159], v2 offset:19456
v_cvt_pk_bf16_f32 v191, v134, v135
v_mfma_f32_16x16x32_bf16 a[48:51], a[180:183], v[180:183], a[48:51]
v_exp_f32 v103, v103
v_mfma_f32_16x16x32_bf16 a[48:51], a[176:179], v[176:179], a[48:51]
ds_read_b128 a[160:163], v2 offset:20480
v_cvt_pk_bf16_f32 v166, v116, v117
v_mfma_f32_16x16x32_bf16 a[80:83], a[176:179], v[200:203], a[80:83]
ds_read_b128 a[164:167], v2 offset:21504
v_cvt_pk_bf16_f32 v167, v118, v119
v_mfma_f32_16x16x32_bf16 a[80:83], a[180:183], v[204:207], a[80:83]
ds_read_b128 a[168:171], v2 offset:22528
v_cvt_pk_bf16_f32 v158, v100, v101
v_mfma_f32_16x16x32_bf16 a[112:115], a[180:183], v[212:215], a[112:115]
ds_read_b128 a[172:175], v2 offset:23552
v_cvt_pk_bf16_f32 v159, v102, v103
v_mfma_f32_16x16x32_bf16 a[112:115], a[176:179], v[208:211], a[112:115]
v_mfma_f32_16x16x32_bf16 a[116:119], a[184:187], v[208:211], a[116:119]
v_mfma_f32_16x16x32_bf16 a[116:119], a[188:191], v[212:215], a[116:119]
v_mfma_f32_16x16x32_bf16 a[84:87], a[188:191], v[204:207], a[84:87]
v_mfma_f32_16x16x32_bf16 a[84:87], a[184:187], v[200:203], a[84:87]
v_mfma_f32_16x16x32_bf16 a[52:55], a[184:187], v[176:179], a[52:55]
v_mfma_f32_16x16x32_bf16 a[52:55], a[188:191], v[180:183], a[52:55]
v_mfma_f32_16x16x32_bf16 a[20:23], a[188:191], v[172:175], a[20:23]
v_mfma_f32_16x16x32_bf16 a[20:23], a[184:187], v[168:171], a[20:23]
v_mfma_f32_16x16x32_bf16 a[24:27], a[192:195], v[168:171], a[24:27]
buffer_load_dwordx4 v16, s[32:35], s70 offen offset:1024 sc1 lds
v_mfma_f32_16x16x32_bf16 a[24:27], a[196:199], v[172:175], a[24:27]
v_mfma_f32_16x16x32_bf16 a[56:59], a[196:199], v[180:183], a[56:59]
v_mfma_f32_16x16x32_bf16 a[56:59], a[192:195], v[176:179], a[56:59]
v_mfma_f32_16x16x32_bf16 a[88:91], a[192:195], v[200:203], a[88:91]
v_mfma_f32_16x16x32_bf16 a[88:91], a[196:199], v[204:207], a[88:91]
v_mfma_f32_16x16x32_bf16 a[120:123], a[196:199], v[212:215], a[120:123]
v_mfma_f32_16x16x32_bf16 a[120:123], a[192:195], v[208:211], a[120:123]
v_mfma_f32_16x16x32_bf16 a[124:127], a[200:203], v[208:211], a[124:127]
v_mfma_f32_16x16x32_bf16 a[124:127], a[204:207], v[212:215], a[124:127]
v_mfma_f32_16x16x32_bf16 a[92:95], a[204:207], v[204:207], a[92:95]
v_mfma_f32_16x16x32_bf16 a[92:95], a[200:203], v[200:203], a[92:95]
v_mfma_f32_16x16x32_bf16 a[60:63], a[200:203], v[176:179], a[60:63]
v_mfma_f32_16x16x32_bf16 a[60:63], a[204:207], v[180:183], a[60:63]
v_mfma_f32_16x16x32_bf16 a[28:31], a[204:207], v[172:175], a[28:31]
v_mfma_f32_16x16x32_bf16 a[28:31], a[200:203], v[168:171], a[28:31]
s_waitcnt lgkmcnt(0)
v_mfma_f32_16x16x32_bf16 v[88:91], a[144:147], v[24:27], v[216:219]
ds_read_b128 a[176:179], v2 offset:24576
v_mfma_f32_16x16x32_bf16 v[88:91], a[148:151], v[28:31], v[88:91]
ds_read_b128 a[180:183], v2 offset:25600
v_mfma_f32_16x16x32_bf16 v[88:91], a[152:155], v[32:35], v[88:91]
buffer_load_dwordx4 v16, s[32:35], s70 offen offset:2048 sc1 lds
v_mfma_f32_16x16x32_bf16 v[88:91], a[156:159], v[36:39], v[88:91]
ds_read_b128 a[184:187], v2 offset:26624
v_mfma_f32_16x16x32_bf16 v[104:107], a[156:159], v[52:55], v[220:223]
v_mfma_f32_16x16x32_bf16 v[104:107], a[152:155], v[48:51], v[104:107]
v_mfma_f32_16x16x32_bf16 v[104:107], a[148:151], v[44:47], v[104:107]
ds_read_b128 a[188:191], v2 offset:27648
v_mfma_f32_16x16x32_bf16 v[104:107], a[144:147], v[40:43], v[104:107]
v_mfma_f32_16x16x32_bf16 v[120:123], a[144:147], v[56:59], v[224:227]
v_mfma_f32_16x16x32_bf16 v[120:123], a[148:151], v[60:63], v[120:123]
v_mfma_f32_16x16x32_bf16 v[120:123], a[152:155], v[64:67], v[120:123]
v_exp_f32 v88, v88
v_mfma_f32_16x16x32_bf16 v[120:123], a[156:159], v[68:71], v[120:123]
v_exp_f32 v89, v89
v_mfma_f32_16x16x32_bf16 v[136:139], a[156:159], v[84:87], v[228:231]
v_exp_f32 v90, v90
v_mfma_f32_16x16x32_bf16 v[136:139], a[152:155], v[80:83], v[136:139]
v_exp_f32 v91, v91
v_mfma_f32_16x16x32_bf16 v[136:139], a[148:151], v[76:79], v[136:139]
v_exp_f32 v104, v104
v_mfma_f32_16x16x32_bf16 v[136:139], a[144:147], v[72:75], v[136:139]
v_exp_f32 v105, v105
v_mfma_f32_16x16x32_bf16 v[140:143], a[160:163], v[72:75], v[228:231]
v_exp_f32 v106, v106
v_mfma_f32_16x16x32_bf16 v[140:143], a[164:167], v[76:79], v[140:143]
v_exp_f32 v107, v107
v_mfma_f32_16x16x32_bf16 v[140:143], a[168:171], v[80:83], v[140:143]
buffer_load_dwordx4 v16, s[32:35], s70 offen offset:3072 sc1 lds
v_mfma_f32_16x16x32_bf16 v[140:143], a[172:175], v[84:87], v[140:143]
v_cvt_pk_bf16_f32 v168, v88, v89
v_cvt_pk_bf16_f32 v169, v90, v91
v_mfma_f32_16x16x32_bf16 v[124:127], a[172:175], v[68:71], v[224:227]
v_exp_f32 v120, v120
v_mfma_f32_16x16x32_bf16 v[124:127], a[168:171], v[64:67], v[124:127]
v_exp_f32 v121, v121
v_mfma_f32_16x16x32_bf16 v[124:127], a[164:167], v[60:63], v[124:127]
v_exp_f32 v122, v122
v_mfma_f32_16x16x32_bf16 v[124:127], a[160:163], v[56:59], v[124:127]
v_exp_f32 v123, v123
v_mfma_f32_16x16x32_bf16 v[108:111], a[160:163], v[40:43], v[220:223]
v_exp_f32 v136, v136
v_mfma_f32_16x16x32_bf16 v[108:111], a[164:167], v[44:47], v[108:111]
v_exp_f32 v137, v137
v_mfma_f32_16x16x32_bf16 v[108:111], a[168:171], v[48:51], v[108:111]
v_exp_f32 v138, v138
v_mfma_f32_16x16x32_bf16 v[108:111], a[172:175], v[52:55], v[108:111]
v_cvt_pk_bf16_f32 v176, v104, v105
v_cvt_pk_bf16_f32 v177, v106, v107
v_mfma_f32_16x16x32_bf16 v[92:95], a[172:175], v[36:39], v[216:219]
v_exp_f32 v139, v139
v_mfma_f32_16x16x32_bf16 v[92:95], a[168:171], v[32:35], v[92:95]
ds_read_b128 a[192:195], v2 offset:28672
v_cvt_pk_bf16_f32 v200, v120, v121
v_mfma_f32_16x16x32_bf16 v[92:95], a[164:167], v[28:31], v[92:95]
ds_read_b128 a[196:199], v2 offset:29696
v_cvt_pk_bf16_f32 v201, v122, v123
v_mfma_f32_16x16x32_bf16 v[92:95], a[160:163], v[24:27], v[92:95]
s_waitcnt lgkmcnt(2)
v_exp_f32 v140, v140
v_mfma_f32_16x16x32_bf16 v[96:99], a[176:179], v[24:27], v[216:219]
s_add_u32 m0, s71, 4096
ds_read_b128 a[200:203], v2 offset:30720
v_cvt_pk_bf16_f32 v208, v136, v137
v_mfma_f32_16x16x32_bf16 v[96:99], a[180:183], v[28:31], v[96:99]
s_add_u32 s64, s70, 4096
ds_read_b128 a[204:207], v2 offset:31744
v_cvt_pk_bf16_f32 v209, v138, v139
v_mfma_f32_16x16x32_bf16 v[96:99], a[184:187], v[32:35], v[96:99]
buffer_load_dwordx4 v16, s[32:35], s64 offen offset:0 sc1 lds
v_mfma_f32_16x16x32_bf16 v[96:99], a[188:191], v[36:39], v[96:99]
v_exp_f32 v141, v141
v_mfma_f32_16x16x32_bf16 v[112:115], a[188:191], v[52:55], v[220:223]
v_exp_f32 v142, v142
v_mfma_f32_16x16x32_bf16 v[112:115], a[184:187], v[48:51], v[112:115]
v_exp_f32 v143, v143
v_mfma_f32_16x16x32_bf16 v[112:115], a[180:183], v[44:47], v[112:115]
v_exp_f32 v124, v124
v_mfma_f32_16x16x32_bf16 v[112:115], a[176:179], v[40:43], v[112:115]
v_exp_f32 v125, v125
v_mfma_f32_16x16x32_bf16 v[128:131], a[176:179], v[56:59], v[224:227]
v_exp_f32 v126, v126
v_mfma_f32_16x16x32_bf16 v[128:131], a[180:183], v[60:63], v[128:131]
v_exp_f32 v127, v127
v_mfma_f32_16x16x32_bf16 v[128:131], a[184:187], v[64:67], v[128:131]
v_exp_f32 v108, v108
v_mfma_f32_16x16x32_bf16 v[128:131], a[188:191], v[68:71], v[128:131]
v_exp_f32 v109, v109
v_mfma_f32_16x16x32_bf16 v[144:147], a[188:191], v[84:87], v[228:231]
v_exp_f32 v110, v110
v_mfma_f32_16x16x32_bf16 v[144:147], a[184:187], v[80:83], v[144:147]
v_exp_f32 v111, v111
v_mfma_f32_16x16x32_bf16 v[144:147], a[180:183], v[76:79], v[144:147]
ds_read_b128 a[144:147], v3 offset:16384
v_cvt_pk_bf16_f32 v210, v140, v141
v_mfma_f32_16x16x32_bf16 v[144:147], a[176:179], v[72:75], v[144:147]
s_waitcnt lgkmcnt(1)
ds_read_b128 a[148:151], v3 offset:24576
v_cvt_pk_bf16_f32 v211, v142, v143
v_mfma_f32_16x16x32_bf16 v[148:151], a[192:195], v[72:75], v[228:231]
v_exp_f32 v92, v92
v_mfma_f32_16x16x32_bf16 v[148:151], a[196:199], v[76:79], v[148:151]
v_exp_f32 v93, v93
v_mfma_f32_16x16x32_bf16 v[148:151], a[200:203], v[80:83], v[148:151]
buffer_load_dwordx4 v16, s[32:35], s64 offen offset:1024 sc1 lds
v_mfma_f32_16x16x32_bf16 v[148:151], a[204:207], v[84:87], v[148:151]
v_exp_f32 v94, v94
v_mfma_f32_16x16x32_bf16 v[132:135], a[204:207], v[68:71], v[224:227]
v_exp_f32 v95, v95
v_mfma_f32_16x16x32_bf16 v[132:135], a[200:203], v[64:67], v[132:135]
ds_read_b128 a[152:155], v3 offset:17408
v_cvt_pk_bf16_f32 v202, v124, v125
v_mfma_f32_16x16x32_bf16 v[132:135], a[196:199], v[60:63], v[132:135]
v_exp_f32 v96, v96
v_mfma_f32_16x16x32_bf16 v[132:135], a[192:195], v[56:59], v[132:135]
ds_read_b128 a[156:159], v3 offset:25600
v_cvt_pk_bf16_f32 v203, v126, v127
v_mfma_f32_16x16x32_bf16 v[116:119], a[192:195], v[40:43], v[220:223]
v_exp_f32 v97, v97
v_mfma_f32_16x16x32_bf16 v[116:119], a[196:199], v[44:47], v[116:119]
v_exp_f32 v98, v98
v_mfma_f32_16x16x32_bf16 v[116:119], a[200:203], v[48:51], v[116:119]
v_exp_f32 v99, v99
v_mfma_f32_16x16x32_bf16 v[116:119], a[204:207], v[52:55], v[116:119]
ds_read_b128 a[160:163], v3 offset:18432
v_cvt_pk_bf16_f32 v178, v108, v109
v_mfma_f32_16x16x32_bf16 v[100:103], a[204:207], v[36:39], v[216:219]
v_exp_f32 v112, v112
v_mfma_f32_16x16x32_bf16 v[100:103], a[200:203], v[32:35], v[100:103]
ds_read_b128 a[164:167], v3 offset:26624
v_cvt_pk_bf16_f32 v179, v110, v111
v_mfma_f32_16x16x32_bf16 v[100:103], a[196:199], v[28:31], v[100:103]
v_exp_f32 v113, v113
v_mfma_f32_16x16x32_bf16 v[100:103], a[192:195], v[24:27], v[100:103]
v_exp_f32 v114, v114
v_mfma_f32_16x16x32_bf16 a[128:131], a[244:247], v[152:155], a[128:131]
v_exp_f32 v115, v115
v_mfma_f32_16x16x32_bf16 a[128:131], a[244:247], v[156:159], a[128:131]
v_exp_f32 v128, v128
v_mfma_f32_16x16x32_bf16 a[132:135], a[244:247], v[160:163], a[132:135]
buffer_load_dwordx4 v16, s[32:35], s64 offen offset:2048 sc1 lds
v_mfma_f32_16x16x32_bf16 a[132:135], a[244:247], v[164:167], a[132:135]
ds_read_b128 a[168:171], v3 offset:19456
v_cvt_pk_bf16_f32 v170, v92, v93
v_mfma_f32_16x16x32_bf16 a[136:139], a[244:247], v[184:187], a[136:139]
ds_read_b128 a[172:175], v3 offset:27648
v_cvt_pk_bf16_f32 v171, v94, v95
v_mfma_f32_16x16x32_bf16 a[136:139], a[244:247], v[188:191], a[136:139]
v_exp_f32 v129, v129
v_mfma_f32_16x16x32_bf16 a[140:143], a[244:247], v[192:195], a[140:143]
v_exp_f32 v130, v130
v_mfma_f32_16x16x32_bf16 a[140:143], a[244:247], v[196:199], a[140:143]
s_waitcnt lgkmcnt(2)
v_exp_f32 v131, v131
v_mfma_f32_16x16x32_bf16 a[0:3], a[144:147], v[152:155], a[0:3]
v_exp_f32 v144, v144
v_mfma_f32_16x16x32_bf16 a[0:3], a[148:151], v[156:159], a[0:3]
ds_read_b128 a[176:179], v3 offset:20480
v_cvt_pk_bf16_f32 v172, v96, v97
v_mfma_f32_16x16x32_bf16 a[32:35], a[148:151], v[164:167], a[32:35]
ds_read_b128 a[180:183], v3 offset:28672
v_cvt_pk_bf16_f32 v173, v98, v99
v_mfma_f32_16x16x32_bf16 a[32:35], a[144:147], v[160:163], a[32:35]
v_exp_f32 v145, v145
v_mfma_f32_16x16x32_bf16 a[64:67], a[144:147], v[184:187], a[64:67]
ds_read_b128 a[184:187], v3 offset:21504
v_xor_b32 v2, 0x8000, v2
v_mfma_f32_16x16x32_bf16 a[64:67], a[148:151], v[188:191], a[64:67]
ds_read_b128 a[188:191], v3 offset:29696
v_cvt_pk_bf16_f32 v180, v112, v113
v_mfma_f32_16x16x32_bf16 a[96:99], a[148:151], v[196:199], a[96:99]
ds_read_b128 a[192:195], v3 offset:22528
v_cvt_pk_bf16_f32 v181, v114, v115
v_mfma_f32_16x16x32_bf16 a[96:99], a[144:147], v[192:195], a[96:99]
v_exp_f32 v146, v146
v_mfma_f32_16x16x32_bf16 a[100:103], a[152:155], v[192:195], a[100:103]
v_exp_f32 v147, v147
v_mfma_f32_16x16x32_bf16 a[100:103], a[156:159], v[196:199], a[100:103]
ds_read_b128 a[196:199], v3 offset:30720
v_cvt_pk_bf16_f32 v204, v128, v129
v_mfma_f32_16x16x32_bf16 a[68:71], a[156:159], v[188:191], a[68:71]
buffer_load_dwordx4 v16, s[32:35], s64 offen offset:3072 sc1 lds
v_mfma_f32_16x16x32_bf16 a[68:71], a[152:155], v[184:187], a[68:71]
v_exp_f32 v148, v148
v_mfma_f32_16x16x32_bf16 a[36:39], a[152:155], v[160:163], a[36:39]
v_exp_f32 v149, v149
v_mfma_f32_16x16x32_bf16 a[36:39], a[156:159], v[164:167], a[36:39]
ds_read_b128 a[200:203], v3 offset:23552
v_cvt_pk_bf16_f32 v205, v130, v131
v_mfma_f32_16x16x32_bf16 a[4:7], a[156:159], v[156:159], a[4:7]
v_exp_f32 v150, v150
v_mfma_f32_16x16x32_bf16 a[4:7], a[152:155], v[152:155], a[4:7]
v_exp_f32 v151, v151
v_mfma_f32_16x16x32_bf16 a[8:11], a[160:163], v[152:155], a[8:11]
v_exp_f32 v132, v132
v_mfma_f32_16x16x32_bf16 a[8:11], a[164:167], v[156:159], a[8:11]
ds_read_b128 a[204:207], v3 offset:31744
v_cvt_pk_bf16_f32 v212, v144, v145
v_mfma_f32_16x16x32_bf16 a[40:43], a[164:167], v[164:167], a[40:43]
v_exp_f32 v133, v133
v_mfma_f32_16x16x32_bf16 a[40:43], a[160:163], v[160:163], a[40:43]
v_exp_f32 v134, v134
v_mfma_f32_16x16x32_bf16 a[72:75], a[160:163], v[184:187], a[72:75]
v_exp_f32 v135, v135
v_mfma_f32_16x16x32_bf16 a[72:75], a[164:167], v[188:191], a[72:75]
v_exp_f32 v116, v116
v_mfma_f32_16x16x32_bf16 a[104:107], a[164:167], v[196:199], a[104:107]
v_exp_f32 v117, v117
v_mfma_f32_16x16x32_bf16 a[104:107], a[160:163], v[192:195], a[104:107]
s_waitcnt lgkmcnt(0)
v_exp_f32 v118, v118
v_mfma_f32_16x16x32_bf16 a[108:111], a[168:171], v[192:195], a[108:111]
v_exp_f32 v119, v119
v_mfma_f32_16x16x32_bf16 a[108:111], a[172:175], v[196:199], a[108:111]
v_exp_f32 v100, v100
v_mfma_f32_16x16x32_bf16 a[76:79], a[172:175], v[188:191], a[76:79]
v_exp_f32 v101, v101
v_mfma_f32_16x16x32_bf16 a[76:79], a[168:171], v[184:187], a[76:79]
v_exp_f32 v102, v102
v_mfma_f32_16x16x32_bf16 a[44:47], a[168:171], v[160:163], a[44:47]
s_waitcnt vmcnt(8)
s_barrier
v_mfma_f32_16x16x32_bf16 a[44:47], a[172:175], v[164:167], a[44:47]
s_xor_b32 s71, s71, 49152
ds_read_b128 a[144:147], v2 offset:0
v_cvt_pk_bf16_f32 v213, v146, v147
v_mfma_f32_16x16x32_bf16 a[12:15], a[172:175], v[156:159], a[12:15]
s_add_u32 s70, s70, 32768
ds_read_b128 a[148:151], v2 offset:1024
v_cvt_pk_bf16_f32 v214, v148, v149
v_mfma_f32_16x16x32_bf16 a[12:15], a[168:171], v[152:155], a[12:15]
s_mov_b32 m0, s71
ds_read_b128 a[152:155], v2 offset:2048
v_cvt_pk_bf16_f32 v215, v150, v151
v_mfma_f32_16x16x32_bf16 a[16:19], a[176:179], v[152:155], a[16:19]
buffer_load_dwordx4 v16, s[32:35], s70 offen offset:0 sc1 lds
v_mfma_f32_16x16x32_bf16 a[16:19], a[180:183], v[156:159], a[16:19]
s_add_u32 s17, s78, L_DD-L_pc
ds_read_b128 a[156:159], v2 offset:3072
v_cvt_pk_bf16_f32 v206, v132, v133
v_mfma_f32_16x16x32_bf16 a[48:51], a[180:183], v[164:167], a[48:51]
buffer_load_dword a252, v16, s[88:91], s17 offen
v_mfma_f32_16x16x32_bf16 a[48:51], a[176:179], v[160:163], a[48:51]
v_exp_f32 v103, v103
v_mfma_f32_16x16x32_bf16 a[80:83], a[176:179], v[184:187], a[80:83]
s_add_u32 s17, s78, L_DD-L_pc+4096
ds_read_b128 a[160:163], v2 offset:4096
v_cvt_pk_bf16_f32 v207, v134, v135
v_mfma_f32_16x16x32_bf16 a[80:83], a[180:183], v[188:191], a[80:83]
buffer_load_dword a252, v16, s[88:91], s17 offen
v_mfma_f32_16x16x32_bf16 a[112:115], a[180:183], v[196:199], a[112:115]
ds_read_b128 a[164:167], v2 offset:5120
v_cvt_pk_bf16_f32 v182, v116, v117
v_mfma_f32_16x16x32_bf16 a[112:115], a[176:179], v[192:195], a[112:115]
ds_read_b128 a[168:171], v2 offset:6144
v_xor_b32 v3, 0x8000, v3
v_mfma_f32_16x16x32_bf16 a[116:119], a[184:187], v[192:195], a[116:119]
ds_read_b128 a[172:175], v2 offset:7168
v_cvt_pk_bf16_f32 v183, v118, v119
v_mfma_f32_16x16x32_bf16 a[116:119], a[188:191], v[196:199], a[116:119]
v_cvt_pk_bf16_f32 v174, v100, v101
v_cvt_pk_bf16_f32 v175, v102, v103
v_mfma_f32_16x16x32_bf16 a[84:87], a[188:191], v[188:191], a[84:87]
v_mfma_f32_16x16x32_bf16 a[84:87], a[184:187], v[184:187], a[84:87]
v_mfma_f32_16x16x32_bf16 a[52:55], a[184:187], v[160:163], a[52:55]
v_mfma_f32_16x16x32_bf16 a[52:55], a[188:191], v[164:167], a[52:55]
v_mfma_f32_16x16x32_bf16 a[20:23], a[188:191], v[156:159], a[20:23]
v_mfma_f32_16x16x32_bf16 a[20:23], a[184:187], v[152:155], a[20:23]
v_mfma_f32_16x16x32_bf16 a[24:27], a[192:195], v[152:155], a[24:27]
buffer_load_dwordx4 v16, s[32:35], s70 offen offset:1024 sc1 lds
v_mfma_f32_16x16x32_bf16 a[24:27], a[196:199], v[156:159], a[24:27]
v_mfma_f32_16x16x32_bf16 a[56:59], a[196:199], v[164:167], a[56:59]
v_mfma_f32_16x16x32_bf16 a[56:59], a[192:195], v[160:163], a[56:59]
v_mfma_f32_16x16x32_bf16 a[88:91], a[192:195], v[184:187], a[88:91]
v_mfma_f32_16x16x32_bf16 a[88:91], a[196:199], v[188:191], a[88:91]
s_sub_u32 s72, s72, 1
v_mfma_f32_16x16x32_bf16 a[120:123], a[196:199], v[196:199], a[120:123]
v_mfma_f32_16x16x32_bf16 a[120:123], a[192:195], v[192:195], a[120:123]
v_mfma_f32_16x16x32_bf16 a[124:127], a[200:203], v[192:195], a[124:127]
v_mfma_f32_16x16x32_bf16 a[124:127], a[204:207], v[196:199], a[124:127]
s_cmp_lg_u32 s72, 0
v_mfma_f32_16x16x32_bf16 a[92:95], a[204:207], v[188:191], a[92:95]
v_mfma_f32_16x16x32_bf16 a[92:95], a[200:203], v[184:187], a[92:95]
v_mfma_f32_16x16x32_bf16 a[60:63], a[200:203], v[160:163], a[60:63]
v_mfma_f32_16x16x32_bf16 a[60:63], a[204:207], v[164:167], a[60:63]
v_mfma_f32_16x16x32_bf16 a[28:31], a[204:207], v[156:159], a[28:31]
v_mfma_f32_16x16x32_bf16 a[28:31], a[200:203], v[152:155], a[28:31]
s_cbranch_scc1 L_D
L_DD:
s_waitcnt lgkmcnt(7)
v_mfma_f32_16x16x32_bf16 v[104:107], a[144:147], v[40:43], v[220:223]
s_waitcnt lgkmcnt(6)
ds_read_b128 a[176:179], v2 offset:8192
v_cndmask_b32 v88, v216, v17, s[0:1]
v_mfma_f32_16x16x32_bf16 v[104:107], a[148:151], v[44:47], v[104:107]
s_waitcnt lgkmcnt(6)
ds_read_b128 a[180:183], v2 offset:9216
v_cndmask_b32 v89, v216, v17, s[4:5]
v_mfma_f32_16x16x32_bf16 v[104:107], a[152:155], v[48:51], v[104:107]
s_waitcnt lgkmcnt(6)
buffer_load_dwordx4 v16, s[32:35], s70 offen offset:2048 sc1 lds
v_mfma_f32_16x16x32_bf16 v[104:107], a[156:159], v[52:55], v[104:107]
ds_read_b128 a[184:187], v2 offset:10240
v_cndmask_b32 v90, v216, v17, s[6:7]
v_mfma_f32_16x16x32_bf16 v[120:123], a[156:159], v[68:71], v[224:227]
ds_read_b128 a[188:191], v2 offset:11264
v_cndmask_b32 v91, v216, v17, s[8:9]
v_mfma_f32_16x16x32_bf16 v[120:123], a[152:155], v[64:67], v[120:123]
ds_read_b128 a[192:195], v2 offset:12288
v_cndmask_b32 v92, v216, v17, s[10:11]
v_mfma_f32_16x16x32_bf16 v[120:123], a[148:151], v[60:63], v[120:123]
ds_read_b128 a[196:199], v2 offset:13312
v_cndmask_b32 v93, v216, v17, s[12:13]
v_mfma_f32_16x16x32_bf16 v[120:123], a[144:147], v[56:59], v[120:123]
ds_read_b128 a[200:203], v2 offset:14336
v_cndmask_b32 v94, v216, v17, s[18:19]
v_mfma_f32_16x16x32_bf16 v[136:139], a[144:147], v[72:75], v[228:231]
ds_read_b128 a[204:207], v2 offset:15360
v_cndmask_b32 v95, v216, v17, s[22:23]
v_mfma_f32_16x16x32_bf16 v[136:139], a[148:151], v[76:79], v[136:139]
v_cndmask_b32 v96, v216, v17, s[26:27]
v_cndmask_b32 v97, v216, v17, s[56:57]
v_mfma_f32_16x16x32_bf16 v[136:139], a[152:155], v[80:83], v[136:139]
v_exp_f32 v104, v104
v_mfma_f32_16x16x32_bf16 v[136:139], a[156:159], v[84:87], v[136:139]
v_exp_f32 v105, v105
v_mfma_f32_16x16x32_bf16 v[88:91], a[156:159], v[36:39], v[88:91]
v_exp_f32 v106, v106
v_mfma_f32_16x16x32_bf16 v[88:91], a[152:155], v[32:35], v[88:91]
v_exp_f32 v107, v107
v_mfma_f32_16x16x32_bf16 v[88:91], a[148:151], v[28:31], v[88:91]
v_exp_f32 v120, v120
v_mfma_f32_16x16x32_bf16 v[88:91], a[144:147], v[24:27], v[88:91]
s_waitcnt lgkmcnt(0)
v_exp_f32 v121, v121
v_mfma_f32_16x16x32_bf16 v[140:143], a[160:163], v[72:75], v[228:231]
v_exp_f32 v122, v122
v_mfma_f32_16x16x32_bf16 v[140:143], a[164:167], v[76:79], v[140:143]
v_exp_f32 v123, v123
v_mfma_f32_16x16x32_bf16 v[140:143], a[168:171], v[80:83], v[140:143]
buffer_load_dwordx4 v16, s[32:35], s70 offen offset:3072 sc1 lds
v_mfma_f32_16x16x32_bf16 v[140:143], a[172:175], v[84:87], v[140:143]
s_add_u32 m0, s86, 131072
v_cvt_pk_bf16_f32 v160, v104, v105
v_cvt_pk_bf16_f32 v161, v106, v107
v_mfma_f32_16x16x32_bf16 v[124:127], a[172:175], v[68:71], v[224:227]
s_add_u32 s64, s85, 0
v_exp_f32 v136, v136
v_mfma_f32_16x16x32_bf16 v[124:127], a[168:171], v[64:67], v[124:127]
buffer_load_dwordx4 v12, s[36:39], s64 offen lds
v_mfma_f32_16x16x32_bf16 v[124:127], a[164:167], v[60:63], v[124:127]
s_add_u32 m0, s86, 132096
v_exp_f32 v137, v137
v_mfma_f32_16x16x32_bf16 v[124:127], a[160:163], v[56:59], v[124:127]
s_add_u32 s64, s85, 8192
ds_read_b128 a[144:147], v3 offset:0
v_cndmask_b32 v98, v216, v17, s[58:59]
v_mfma_f32_16x16x32_bf16 v[108:111], a[160:163], v[40:43], v[220:223]
buffer_load_dwordx4 v13, s[36:39], s64 offen lds
v_mfma_f32_16x16x32_bf16 v[108:111], a[164:167], v[44:47], v[108:111]
ds_read_b128 a[148:151], v3 offset:8192
v_cndmask_b32 v99, v216, v17, s[60:61]
v_mfma_f32_16x16x32_bf16 v[108:111], a[168:171], v[48:51], v[108:111]
s_add_u32 m0, s86, 133120
v_exp_f32 v138, v138
v_mfma_f32_16x16x32_bf16 v[108:111], a[172:175], v[52:55], v[108:111]
s_add_u32 s64, s85, 16384
v_cvt_pk_bf16_f32 v184, v120, v121
v_cvt_pk_bf16_f32 v185, v122, v123
v_mfma_f32_16x16x32_bf16 v[92:95], a[172:175], v[36:39], v[92:95]
buffer_load_dwordx4 v12, s[36:39], s64 offen lds
v_mfma_f32_16x16x32_bf16 v[92:95], a[168:171], v[32:35], v[92:95]
s_add_u32 m0, s86, 134144
v_exp_f32 v139, v139
v_mfma_f32_16x16x32_bf16 v[92:95], a[164:167], v[28:31], v[92:95]
s_add_u32 s64, s85, 24576
v_exp_f32 v88, v88
v_mfma_f32_16x16x32_bf16 v[92:95], a[160:163], v[24:27], v[92:95]
buffer_load_dwordx4 v13, s[36:39], s64 offen lds
v_mfma_f32_16x16x32_bf16 v[96:99], a[176:179], v[24:27], v[96:99]
s_add_u32 m0, s71, 4096
v_exp_f32 v89, v89
v_mfma_f32_16x16x32_bf16 v[96:99], a[180:183], v[28:31], v[96:99]
s_add_u32 s64, s70, 4096
v_exp_f32 v90, v90
v_mfma_f32_16x16x32_bf16 v[96:99], a[184:187], v[32:35], v[96:99]
buffer_load_dwordx4 v16, s[32:35], s64 offen offset:0 sc1 lds
v_mfma_f32_16x16x32_bf16 v[96:99], a[188:191], v[36:39], v[96:99]
v_cvt_pk_bf16_f32 v192, v136, v137
v_cvt_pk_bf16_f32 v193, v138, v139
v_mfma_f32_16x16x32_bf16 v[112:115], a[188:191], v[52:55], v[220:223]
v_exp_f32 v91, v91
v_mfma_f32_16x16x32_bf16 v[112:115], a[184:187], v[48:51], v[112:115]
v_exp_f32 v140, v140
v_mfma_f32_16x16x32_bf16 v[112:115], a[180:183], v[44:47], v[112:115]
v_exp_f32 v141, v141
v_mfma_f32_16x16x32_bf16 v[112:115], a[176:179], v[40:43], v[112:115]
v_exp_f32 v142, v142
v_mfma_f32_16x16x32_bf16 v[128:131], a[176:179], v[56:59], v[224:227]
v_exp_f32 v143, v143
v_mfma_f32_16x16x32_bf16 v[128:131], a[180:183], v[60:63], v[128:131]
v_exp_f32 v124, v124
v_mfma_f32_16x16x32_bf16 v[128:131], a[184:187], v[64:67], v[128:131]
v_exp_f32 v125, v125
v_mfma_f32_16x16x32_bf16 v[128:131], a[188:191], v[68:71], v[128:131]
v_cvt_pk_bf16_f32 v152, v88, v89
v_cvt_pk_bf16_f32 v153, v90, v91
v_mfma_f32_16x16x32_bf16 v[144:147], a[188:191], v[84:87], v[228:231]
v_exp_f32 v126, v126
v_mfma_f32_16x16x32_bf16 v[144:147], a[184:187], v[80:83], v[144:147]
v_exp_f32 v127, v127
v_mfma_f32_16x16x32_bf16 v[144:147], a[180:183], v[76:79], v[144:147]
ds_read_b128 a[152:155], v3 offset:1024
v_cndmask_b32 v100, v216, v17, s[62:63]
v_mfma_f32_16x16x32_bf16 v[144:147], a[176:179], v[72:75], v[144:147]
ds_read_b128 a[156:159], v3 offset:9216
v_cndmask_b32 v101, v216, v17, s[48:49]
v_mfma_f32_16x16x32_bf16 v[148:151], a[192:195], v[72:75], v[228:231]
ds_read_b128 a[160:163], v3 offset:2048
v_cndmask_b32 v102, v216, v17, s[50:51]
v_mfma_f32_16x16x32_bf16 v[148:151], a[196:199], v[76:79], v[148:151]
ds_read_b128 a[164:167], v3 offset:10240
v_cndmask_b32 v103, v216, v17, s[100:101]
v_mfma_f32_16x16x32_bf16 v[148:151], a[200:203], v[80:83], v[148:151]
buffer_load_dwordx4 v16, s[32:35], s64 offen offset:1024 sc1 lds
v_mfma_f32_16x16x32_bf16 v[148:151], a[204:207], v[84:87], v[148:151]
v_cvt_pk_bf16_f32 v194, v140, v141
v_cvt_pk_bf16_f32 v195, v142, v143
v_mfma_f32_16x16x32_bf16 v[132:135], a[204:207], v[68:71], v[224:227]
v_exp_f32 v108, v108
v_mfma_f32_16x16x32_bf16 v[132:135], a[200:203], v[64:67], v[132:135]
v_exp_f32 v109, v109
v_mfma_f32_16x16x32_bf16 v[132:135], a[196:199], v[60:63], v[132:135]
v_exp_f32 v110, v110
v_mfma_f32_16x16x32_bf16 v[132:135], a[192:195], v[56:59], v[132:135]
v_exp_f32 v111, v111
v_mfma_f32_16x16x32_bf16 v[116:119], a[192:195], v[40:43], v[220:223]
v_exp_f32 v92, v92
v_mfma_f32_16x16x32_bf16 v[116:119], a[196:199], v[44:47], v[116:119]
v_exp_f32 v93, v93
v_mfma_f32_16x16x32_bf16 v[116:119], a[200:203], v[48:51], v[116:119]
v_exp_f32 v94, v94
v_mfma_f32_16x16x32_bf16 v[116:119], a[204:207], v[52:55], v[116:119]
v_cvt_pk_bf16_f32 v186, v124, v125
v_cvt_pk_bf16_f32 v187, v126, v127
v_mfma_f32_16x16x32_bf16 v[100:103], a[204:207], v[36:39], v[100:103]
v_exp_f32 v95, v95
v_mfma_f32_16x16x32_bf16 v[100:103], a[200:203], v[32:35], v[100:103]
v_exp_f32 v96, v96
v_mfma_f32_16x16x32_bf16 v[100:103], a[196:199], v[28:31], v[100:103]
v_exp_f32 v97, v97
v_mfma_f32_16x16x32_bf16 v[100:103], a[192:195], v[24:27], v[100:103]
v_exp_f32 v98, v98
v_mfma_f32_16x16x32_bf16 a[128:131], a[244:247], v[168:171], a[128:131]
v_exp_f32 v99, v99
v_mfma_f32_16x16x32_bf16 a[128:131], a[244:247], v[172:175], a[128:131]
v_exp_f32 v112, v112
v_mfma_f32_16x16x32_bf16 a[132:135], a[244:247], v[176:179], a[132:135]
buffer_load_dwordx4 v16, s[32:35], s64 offen offset:2048 sc1 lds
v_mfma_f32_16x16x32_bf16 a[132:135], a[244:247], v[180:183], a[132:135]
v_cvt_pk_bf16_f32 v162, v108, v109
v_cvt_pk_bf16_f32 v163, v110, v111
v_mfma_f32_16x16x32_bf16 a[136:139], a[244:247], v[200:203], a[136:139]
v_exp_f32 v113, v113
v_mfma_f32_16x16x32_bf16 a[136:139], a[244:247], v[204:207], a[136:139]
v_exp_f32 v114, v114
v_mfma_f32_16x16x32_bf16 a[140:143], a[244:247], v[208:211], a[140:143]
v_exp_f32 v115, v115
v_mfma_f32_16x16x32_bf16 a[140:143], a[244:247], v[212:215], a[140:143]
s_waitcnt lgkmcnt(0)
v_exp_f32 v128, v128
v_mfma_f32_16x16x32_bf16 a[0:3], a[144:147], v[168:171], a[0:3]
ds_read_b128 a[168:171], v3 offset:3072
v_cvt_pk_bf16_f32 v154, v92, v93
v_mfma_f32_16x16x32_bf16 a[0:3], a[148:151], v[172:175], a[0:3]
ds_read_b128 a[172:175], v3 offset:11264
v_cvt_pk_bf16_f32 v155, v94, v95
v_mfma_f32_16x16x32_bf16 a[32:35], a[148:151], v[180:183], a[32:35]
v_exp_f32 v129, v129
v_mfma_f32_16x16x32_bf16 a[32:35], a[144:147], v[176:179], a[32:35]
v_exp_f32 v130, v130
v_mfma_f32_16x16x32_bf16 a[64:67], a[144:147], v[200:203], a[64:67]
v_exp_f32 v131, v131
v_mfma_f32_16x16x32_bf16 a[64:67], a[148:151], v[204:207], a[64:67]
v_exp_f32 v144, v144
v_mfma_f32_16x16x32_bf16 a[96:99], a[148:151], v[212:215], a[96:99]
ds_read_b128 a[176:179], v3 offset:4096
v_cvt_pk_bf16_f32 v156, v96, v97
v_mfma_f32_16x16x32_bf16 a[96:99], a[144:147], v[208:211], a[96:99]
ds_read_b128 a[180:183], v3 offset:12288
v_cvt_pk_bf16_f32 v157, v98, v99
v_mfma_f32_16x16x32_bf16 a[100:103], a[152:155], v[208:211], a[100:103]
v_exp_f32 v145, v145
v_mfma_f32_16x16x32_bf16 a[100:103], a[156:159], v[212:215], a[100:103]
ds_read_b128 a[184:187], v3 offset:5120
v_cvt_pk_bf16_f32 v164, v112, v113
v_mfma_f32_16x16x32_bf16 a[68:71], a[156:159], v[204:207], a[68:71]
buffer_load_dwordx4 v16, s[32:35], s64 offen offset:3072 sc1 lds
v_mfma_f32_16x16x32_bf16 a[68:71], a[152:155], v[200:203], a[68:71]
s_add_u32 m0, s86, 135168
ds_read_b128 a[188:191], v3 offset:13312
v_cvt_pk_bf16_f32 v165, v114, v115
v_mfma_f32_16x16x32_bf16 a[36:39], a[152:155], v[176:179], a[36:39]
s_add_u32 s64, s85, 32768
ds_read_b128 a[192:195], v3 offset:6144
v_cvt_pk_bf16_f32 v188, v128, v129
v_mfma_f32_16x16x32_bf16 a[36:39], a[156:159], v[180:183], a[36:39]
buffer_load_dwordx4 v12, s[36:39], s64 offen lds
v_mfma_f32_16x16x32_bf16 a[4:7], a[156:159], v[172:175], a[4:7]
s_add_u32 m0, s86, 136192
ds_read_b128 a[196:199], v3 offset:14336
v_cvt_pk_bf16_f32 v189, v130, v131
v_mfma_f32_16x16x32_bf16 a[4:7], a[152:155], v[168:171], a[4:7]
s_add_u32 s64, s85, 40960
ds_read_b128 a[200:203], v3 offset:7168
v_cvt_pk_bf16_f32 v196, v144, v145
v_mfma_f32_16x16x32_bf16 a[8:11], a[160:163], v[168:171], a[8:11]
buffer_load_dwordx4 v13, s[36:39], s64 offen lds
v_mfma_f32_16x16x32_bf16 a[8:11], a[164:167], v[172:175], a[8:11]
s_add_u32 m0, s86, 137216
ds_read_b128 a[204:207], v3 offset:15360
v_mfma_f32_16x16x32_bf16 a[40:43], a[164:167], v[180:183], a[40:43]
s_add_u32 s64, s85, 49152
v_exp_f32 v146, v146
v_mfma_f32_16x16x32_bf16 a[40:43], a[160:163], v[176:179], a[40:43]
buffer_load_dwordx4 v12, s[36:39], s64 offen lds
v_mfma_f32_16x16x32_bf16 a[72:75], a[160:163], v[200:203], a[72:75]
s_add_u32 m0, s86, 138240
v_exp_f32 v147, v147
v_mfma_f32_16x16x32_bf16 a[72:75], a[164:167], v[204:207], a[72:75]
s_add_u32 s64, s85, 57344
v_exp_f32 v148, v148
v_mfma_f32_16x16x32_bf16 a[104:107], a[164:167], v[212:215], a[104:107]
buffer_load_dwordx4 v13, s[36:39], s64 offen lds
v_mfma_f32_16x16x32_bf16 a[104:107], a[160:163], v[208:211], a[104:107]
s_waitcnt lgkmcnt(0)
v_exp_f32 v149, v149
v_mfma_f32_16x16x32_bf16 a[108:111], a[168:171], v[208:211], a[108:111]
v_exp_f32 v150, v150
v_mfma_f32_16x16x32_bf16 a[108:111], a[172:175], v[212:215], a[108:111]
v_exp_f32 v151, v151
v_mfma_f32_16x16x32_bf16 a[76:79], a[172:175], v[204:207], a[76:79]
v_exp_f32 v132, v132
v_mfma_f32_16x16x32_bf16 a[76:79], a[168:171], v[200:203], a[76:79]
v_exp_f32 v133, v133
v_mfma_f32_16x16x32_bf16 a[44:47], a[168:171], v[176:179], a[44:47]
s_waitcnt vmcnt(16)
s_barrier
v_mfma_f32_16x16x32_bf16 a[44:47], a[172:175], v[180:183], a[44:47]
s_xor_b32 s71, s71, 16384
v_exp_f32 v134, v134
v_mfma_f32_16x16x32_bf16 a[12:15], a[172:175], v[172:175], a[12:15]
s_add_u32 s70, s70, 32768
v_exp_f32 v135, v135
v_mfma_f32_16x16x32_bf16 a[12:15], a[168:171], v[168:171], a[12:15]
s_mov_b32 m0, s71
v_exp_f32 v116, v116
v_mfma_f32_16x16x32_bf16 a[16:19], a[176:179], v[168:171], a[16:19]
buffer_load_dwordx4 v16, s[32:35], s70 offen offset:0 sc1 lds
v_mfma_f32_16x16x32_bf16 a[16:19], a[180:183], v[172:175], a[16:19]
v_exp_f32 v117, v117
v_mfma_f32_16x16x32_bf16 a[48:51], a[180:183], v[180:183], a[48:51]
v_exp_f32 v118, v118
v_mfma_f32_16x16x32_bf16 a[48:51], a[176:179], v[176:179], a[48:51]
v_exp_f32 v119, v119
v_mfma_f32_16x16x32_bf16 a[80:83], a[176:179], v[200:203], a[80:83]
v_exp_f32 v100, v100
v_mfma_f32_16x16x32_bf16 a[80:83], a[180:183], v[204:207], a[80:83]
v_exp_f32 v101, v101
v_mfma_f32_16x16x32_bf16 a[112:115], a[180:183], v[212:215], a[112:115]
v_cvt_pk_bf16_f32 v197, v146, v147
v_cvt_pk_bf16_f32 v198, v148, v149
v_mfma_f32_16x16x32_bf16 a[112:115], a[176:179], v[208:211], a[112:115]
ds_read_b128 a[144:147], v2 offset:16384
v_cvt_pk_bf16_f32 v199, v150, v151
v_mfma_f32_16x16x32_bf16 a[116:119], a[184:187], v[208:211], a[116:119]
ds_read_b128 a[148:151], v2 offset:17408
v_cvt_pk_bf16_f32 v190, v132, v133
v_mfma_f32_16x16x32_bf16 a[116:119], a[188:191], v[212:215], a[116:119]
v_exp_f32 v102, v102
v_mfma_f32_16x16x32_bf16 a[84:87], a[188:191], v[204:207], a[84:87]
ds_read_b128 a[152:155], v2 offset:18432
v_cvt_pk_bf16_f32 v191, v134, v135
v_mfma_f32_16x16x32_bf16 a[84:87], a[184:187], v[200:203], a[84:87]
ds_read_b128 a[156:159], v2 offset:19456
v_cvt_pk_bf16_f32 v166, v116, v117
v_mfma_f32_16x16x32_bf16 a[52:55], a[184:187], v[176:179], a[52:55]
v_exp_f32 v103, v103
v_mfma_f32_16x16x32_bf16 a[52:55], a[188:191], v[180:183], a[52:55]
ds_read_b128 a[160:163], v2 offset:20480
v_cvt_pk_bf16_f32 v167, v118, v119
v_mfma_f32_16x16x32_bf16 a[20:23], a[188:191], v[172:175], a[20:23]
ds_read_b128 a[164:167], v2 offset:21504
v_cvt_pk_bf16_f32 v158, v100, v101
v_mfma_f32_16x16x32_bf16 a[20:23], a[184:187], v[168:171], a[20:23]
ds_read_b128 a[168:171], v2 offset:22528
v_cvt_pk_bf16_f32 v159, v102, v103
v_mfma_f32_16x16x32_bf16 a[24:27], a[192:195], v[168:171], a[24:27]
buffer_load_dwordx4 v16, s[32:35], s70 offen offset:1024 sc1 lds
v_mfma_f32_16x16x32_bf16 a[24:27], a[196:199], v[172:175], a[24:27]
ds_read_b128 a[172:175], v2 offset:23552
v_cndmask_b32 v104, v220, v17, s[0:1]
v_mfma_f32_16x16x32_bf16 a[56:59], a[196:199], v[180:183], a[56:59]
v_cndmask_b32 v105, v220, v17, s[4:5]
v_cndmask_b32 v106, v220, v17, s[6:7]
v_mfma_f32_16x16x32_bf16 a[56:59], a[192:195], v[176:179], a[56:59]
v_cndmask_b32 v107, v220, v17, s[8:9]
v_cndmask_b32 v108, v220, v17, s[10:11]
v_mfma_f32_16x16x32_bf16 a[88:91], a[192:195], v[200:203], a[88:91]
v_cndmask_b32 v109, v220, v17, s[12:13]
v_cndmask_b32 v110, v220, v17, s[18:19]
v_mfma_f32_16x16x32_bf16 a[88:91], a[196:199], v[204:207], a[88:91]
v_cndmask_b32 v111, v220, v17, s[22:23]
v_cndmask_b32 v112, v220, v17, s[26:27]
v_mfma_f32_16x16x32_bf16 a[120:123], a[196:199], v[212:215], a[120:123]
v_cndmask_b32 v113, v220, v17, s[56:57]
v_cndmask_b32 v114, v220, v17, s[58:59]
v_mfma_f32_16x16x32_bf16 a[120:123], a[192:195], v[208:211], a[120:123]
v_cndmask_b32 v115, v220, v17, s[60:61]
v_cndmask_b32 v116, v220, v17, s[62:63]
v_mfma_f32_16x16x32_bf16 a[124:127], a[200:203], v[208:211], a[124:127]
v_cndmask_b32 v117, v220, v17, s[48:49]
v_cndmask_b32 v118, v220, v17, s[50:51]
v_mfma_f32_16x16x32_bf16 a[124:127], a[204:207], v[212:215], a[124:127]
s_add_u32 s17, s78, L_T-L_pc
v_cndmask_b32 v119, v220, v17, s[100:101]
v_mfma_f32_16x16x32_bf16 a[92:95], a[204:207], v[204:207], a[92:95]
buffer_load_dword a252, v16, s[88:91], s17 offen
v_mfma_f32_16x16x32_bf16 a[92:95], a[200:203], v[200:203], a[92:95]
v_mfma_f32_16x16x32_bf16 a[60:63], a[200:203], v[176:179], a[60:63]
s_add_u32 s17, s78, L_T-L_pc+4096
v_mfma_f32_16x16x32_bf16 a[60:63], a[204:207], v[180:183], a[60:63]
buffer_load_dword a252, v16, s[88:91], s17 offen
v_mfma_f32_16x16x32_bf16 a[28:31], a[204:207], v[172:175], a[28:31]
v_mfma_f32_16x16x32_bf16 a[28:31], a[200:203], v[168:171], a[28:31]
s_waitcnt lgkmcnt(0)
v_mfma_f32_16x16x32_bf16 v[120:123], a[144:147], v[56:59], v[224:227]
ds_read_b128 a[176:179], v2 offset:24576
v_mfma_f32_16x16x32_bf16 v[120:123], a[148:151], v[60:63], v[120:123]
ds_read_b128 a[180:183], v2 offset:25600
v_mfma_f32_16x16x32_bf16 v[120:123], a[152:155], v[64:67], v[120:123]
buffer_load_dwordx4 v16, s[32:35], s70 offen offset:2048 sc1 lds
v_mfma_f32_16x16x32_bf16 v[120:123], a[156:159], v[68:71], v[120:123]
s_add_u32 s17, s78, L_T1-L_pc
ds_read_b128 a[184:187], v2 offset:26624
v_mfma_f32_16x16x32_bf16 v[136:139], a[156:159], v[84:87], v[228:231]
buffer_load_dword a252, v16, s[88:91], s17 offen
v_mfma_f32_16x16x32_bf16 v[136:139], a[152:155], v[80:83], v[136:139]
ds_read_b128 a[188:191], v2 offset:27648
v_mfma_f32_16x16x32_bf16 v[136:139], a[148:151], v[76:79], v[136:139]
s_add_u32 s17, s78, L_T1-L_pc+4096
v_mfma_f32_16x16x32_bf16 v[136:139], a[144:147], v[72:75], v[136:139]
buffer_load_dword a252, v16, s[88:91], s17 offen
v_mfma_f32_16x16x32_bf16 v[104:107], a[144:147], v[40:43], v[104:107]
ds_read_b128 a[192:195], v2 offset:28672
v_mfma_f32_16x16x32_bf16 v[104:107], a[148:151], v[44:47], v[104:107]
v_mfma_f32_16x16x32_bf16 v[104:107], a[152:155], v[48:51], v[104:107]
v_exp_f32 v120, v120
v_mfma_f32_16x16x32_bf16 v[104:107], a[156:159], v[52:55], v[104:107]
v_exp_f32 v121, v121
v_mfma_f32_16x16x32_bf16 v[140:143], a[172:175], v[84:87], v[228:231]
v_exp_f32 v122, v122
v_mfma_f32_16x16x32_bf16 v[140:143], a[168:171], v[80:83], v[140:143]
v_exp_f32 v123, v123
v_mfma_f32_16x16x32_bf16 v[140:143], a[164:167], v[76:79], v[140:143]
v_exp_f32 v136, v136
v_mfma_f32_16x16x32_bf16 v[140:143], a[160:163], v[72:75], v[140:143]
v_exp_f32 v137, v137
v_mfma_f32_16x16x32_bf16 v[124:127], a[160:163], v[56:59], v[224:227]
buffer_load_dwordx4 v16, s[32:35], s70 offen offset:3072 sc1 lds
v_mfma_f32_16x16x32_bf16 v[124:127], a[164:167], v[60:63], v[124:127]
v_exp_f32 v138, v138
v_mfma_f32_16x16x32_bf16 v[124:127], a[168:171], v[64:67], v[124:127]
v_exp_f32 v139, v139
v_mfma_f32_16x16x32_bf16 v[124:127], a[172:175], v[68:71], v[124:127]
ds_read_b128 a[196:199], v2 offset:29696
v_cvt_pk_bf16_f32 v200, v120, v121
v_mfma_f32_16x16x32_bf16 v[108:111], a[172:175], v[52:55], v[108:111]
ds_read_b128 a[200:203], v2 offset:30720
v_cvt_pk_bf16_f32 v201, v122, v123
v_mfma_f32_16x16x32_bf16 v[108:111], a[168:171], v[48:51], v[108:111]
v_exp_f32 v104, v104
v_mfma_f32_16x16x32_bf16 v[108:111], a[164:167], v[44:47], v[108:111]
ds_read_b128 a[204:207], v2 offset:31744
v_cvt_pk_bf16_f32 v208, v136, v137
v_mfma_f32_16x16x32_bf16 v[108:111], a[160:163], v[40:43], v[108:111]
s_waitcnt lgkmcnt(3)
v_exp_f32 v105, v105
v_mfma_f32_16x16x32_bf16 v[112:115], a[176:179], v[40:43], v[112:115]
v_exp_f32 v106, v106
v_mfma_f32_16x16x32_bf16 v[112:115], a[180:183], v[44:47], v[112:115]
v_exp_f32 v107, v107
v_mfma_f32_16x16x32_bf16 v[112:115], a[184:187], v[48:51], v[112:115]
v_exp_f32 v140, v140
v_mfma_f32_16x16x32_bf16 v[112:115], a[188:191], v[52:55], v[112:115]
v_exp_f32 v141, v141
v_mfma_f32_16x16x32_bf16 v[128:131], a[188:191], v[68:71], v[224:227]
s_add_u32 m0, s71, 4096
v_exp_f32 v142, v142
v_mfma_f32_16x16x32_bf16 v[128:131], a[184:187], v[64:67], v[128:131]
s_add_u32 s64, s70, 4096
v_exp_f32 v143, v143
v_mfma_f32_16x16x32_bf16 v[128:131], a[180:183], v[60:63], v[128:131]
buffer_load_dwordx4 v16, s[32:35], s64 offen offset:0 sc1 lds
v_mfma_f32_16x16x32_bf16 v[128:131], a[176:179], v[56:59], v[128:131]
v_exp_f32 v124, v124
v_mfma_f32_16x16x32_bf16 v[144:147], a[176:179], v[72:75], v[228:231]
ds_read_b128 a[144:147], v3 offset:16384
v_cvt_pk_bf16_f32 v209, v138, v139
v_mfma_f32_16x16x32_bf16 v[144:147], a[180:183], v[76:79], v[144:147]
v_exp_f32 v125, v125
v_mfma_f32_16x16x32_bf16 v[144:147], a[184:187], v[80:83], v[144:147]
ds_read_b128 a[148:151], v3 offset:24576
v_cvt_pk_bf16_f32 v176, v104, v105
v_mfma_f32_16x16x32_bf16 v[144:147], a[188:191], v[84:87], v[144:147]
s_waitcnt lgkmcnt(2)
v_exp_f32 v126, v126
v_mfma_f32_16x16x32_bf16 v[148:151], a[204:207], v[84:87], v[228:231]
v_exp_f32 v127, v127
v_mfma_f32_16x16x32_bf16 v[148:151], a[200:203], v[80:83], v[148:151]
ds_read_b128 a[152:155], v3 offset:17408
v_cvt_pk_bf16_f32 v177, v106, v107
v_mfma_f32_16x16x32_bf16 v[148:151], a[196:199], v[76:79], v[148:151]
v_exp_f32 v108, v108
v_mfma_f32_16x16x32_bf16 v[148:151], a[192:195], v[72:75], v[148:151]
ds_read_b128 a[156:159], v3 offset:25600
v_cvt_pk_bf16_f32 v210, v140, v141
v_mfma_f32_16x16x32_bf16 v[132:135], a[192:195], v[56:59], v[224:227]
v_exp_f32 v109, v109
v_mfma_f32_16x16x32_bf16 v[132:135], a[196:199], v[60:63], v[132:135]
v_exp_f32 v110, v110
v_mfma_f32_16x16x32_bf16 v[132:135], a[200:203], v[64:67], v[132:135]
v_exp_f32 v111, v111
v_mfma_f32_16x16x32_bf16 v[132:135], a[204:207], v[68:71], v[132:135]
ds_read_b128 a[160:163], v3 offset:18432
v_cvt_pk_bf16_f32 v211, v142, v143
v_mfma_f32_16x16x32_bf16 v[116:119], a[204:207], v[52:55], v[116:119]
buffer_load_dwordx4 v16, s[32:35], s64 offen offset:1024 sc1 lds
v_mfma_f32_16x16x32_bf16 v[116:119], a[200:203], v[48:51], v[116:119]
v_exp_f32 v112, v112
v_mfma_f32_16x16x32_bf16 v[116:119], a[196:199], v[44:47], v[116:119]
ds_read_b128 a[164:167], v3 offset:26624
v_cvt_pk_bf16_f32 v202, v124, v125
v_mfma_f32_16x16x32_bf16 v[116:119], a[192:195], v[40:43], v[116:119]
v_exp_f32 v113, v113
v_mfma_f32_16x16x32_bf16 a[128:131], a[244:247], v[152:155], a[128:131]
v_exp_f32 v114, v114
v_mfma_f32_16x16x32_bf16 a[128:131], a[244:247], v[156:159], a[128:131]
v_exp_f32 v115, v115
v_mfma_f32_16x16x32_bf16 a[132:135], a[244:247], v[160:163], a[132:135]
ds_read_b128 a[168:171], v3 offset:19456
v_cvt_pk_bf16_f32 v203, v126, v127
v_mfma_f32_16x16x32_bf16 a[132:135], a[244:247], v[164:167], a[132:135]
ds_read_b128 a[172:175], v3 offset:27648
v_cvt_pk_bf16_f32 v178, v108, v109
v_mfma_f32_16x16x32_bf16 a[136:139], a[244:247], v[184:187], a[136:139]
v_exp_f32 v128, v128
v_mfma_f32_16x16x32_bf16 a[136:139], a[244:247], v[188:191], a[136:139]
v_exp_f32 v129, v129
v_mfma_f32_16x16x32_bf16 a[140:143], a[244:247], v[192:195], a[140:143]
v_exp_f32 v130, v130
v_mfma_f32_16x16x32_bf16 a[140:143], a[244:247], v[196:199], a[140:143]
s_waitcnt lgkmcnt(2)
ds_read_b128 a[176:179], v3 offset:20480
v_cvt_pk_bf16_f32 v179, v110, v111
v_mfma_f32_16x16x32_bf16 a[0:3], a[144:147], v[152:155], a[0:3]
v_exp_f32 v131, v131
v_mfma_f32_16x16x32_bf16 a[0:3], a[148:151], v[156:159], a[0:3]
ds_read_b128 a[180:183], v3 offset:28672
v_cvt_pk_bf16_f32 v180, v112, v113
v_mfma_f32_16x16x32_bf16 a[32:35], a[148:151], v[164:167], a[32:35]
buffer_load_dwordx4 v16, s[32:35], s64 offen offset:2048 sc1 lds
v_mfma_f32_16x16x32_bf16 a[32:35], a[144:147], v[160:163], a[32:35]
v_exp_f32 v144, v144
v_mfma_f32_16x16x32_bf16 a[64:67], a[144:147], v[184:187], a[64:67]
v_exp_f32 v145, v145
v_mfma_f32_16x16x32_bf16 a[64:67], a[148:151], v[188:191], a[64:67]
ds_read_b128 a[184:187], v3 offset:21504
v_xor_b32 v2, 0x8000, v2
v_mfma_f32_16x16x32_bf16 a[96:99], a[148:151], v[196:199], a[96:99]
v_exp_f32 v146, v146
v_mfma_f32_16x16x32_bf16 a[96:99], a[144:147], v[192:195], a[96:99]
ds_read_b128 a[188:191], v3 offset:29696
v_cvt_pk_bf16_f32 v181, v114, v115
v_mfma_f32_16x16x32_bf16 a[100:103], a[152:155], v[192:195], a[100:103]
v_exp_f32 v147, v147
v_mfma_f32_16x16x32_bf16 a[100:103], a[156:159], v[196:199], a[100:103]
v_exp_f32 v148, v148
v_mfma_f32_16x16x32_bf16 a[68:71], a[156:159], v[188:191], a[68:71]
v_exp_f32 v149, v149
v_mfma_f32_16x16x32_bf16 a[68:71], a[152:155], v[184:187], a[68:71]
ds_read_b128 a[192:195], v3 offset:22528
v_cvt_pk_bf16_f32 v204, v128, v129
v_mfma_f32_16x16x32_bf16 a[36:39], a[152:155], v[160:163], a[36:39]
v_exp_f32 v150, v150
v_mfma_f32_16x16x32_bf16 a[36:39], a[156:159], v[164:167], a[36:39]
v_exp_f32 v151, v151
v_mfma_f32_16x16x32_bf16 a[4:7], a[156:159], v[156:159], a[4:7]
v_exp_f32 v132, v132
v_mfma_f32_16x16x32_bf16 a[4:7], a[152:155], v[152:155], a[4:7]
ds_read_b128 a[196:199], v3 offset:30720
v_cvt_pk_bf16_f32 v205, v130, v131
v_mfma_f32_16x16x32_bf16 a[8:11], a[160:163], v[152:155], a[8:11]
buffer_load_dwordx4 v16, s[32:35], s64 offen offset:3072 sc1 lds
v_mfma_f32_16x16x32_bf16 a[8:11], a[164:167], v[156:159], a[8:11]
v_exp_f32 v133, v133
v_mfma_f32_16x16x32_bf16 a[40:43], a[164:167], v[164:167], a[40:43]
ds_read_b128 a[200:203], v3 offset:23552
v_cvt_pk_bf16_f32 v212, v144, v145
v_mfma_f32_16x16x32_bf16 a[40:43], a[160:163], v[160:163], a[40:43]
v_exp_f32 v134, v134
v_mfma_f32_16x16x32_bf16 a[72:75], a[160:163], v[184:187], a[72:75]
v_exp_f32 v135, v135
v_mfma_f32_16x16x32_bf16 a[72:75], a[164:167], v[188:191], a[72:75]
v_exp_f32 v116, v116
v_mfma_f32_16x16x32_bf16 a[104:107], a[164:167], v[196:199], a[104:107]
ds_read_b128 a[204:207], v3 offset:31744
v_cvt_pk_bf16_f32 v213, v146, v147
v_mfma_f32_16x16x32_bf16 a[104:107], a[160:163], v[192:195], a[104:107]
s_waitcnt lgkmcnt(2)
v_exp_f32 v117, v117
v_mfma_f32_16x16x32_bf16 a[108:111], a[168:171], v[192:195], a[108:111]
v_exp_f32 v118, v118
v_mfma_f32_16x16x32_bf16 a[108:111], a[172:175], v[196:199], a[108:111]
v_exp_f32 v119, v119
v_mfma_f32_16x16x32_bf16 a[76:79], a[172:175], v[188:191], a[76:79]
v_cvt_pk_bf16_f32 v214, v148, v149
v_cvt_pk_bf16_f32 v215, v150, v151
v_mfma_f32_16x16x32_bf16 a[76:79], a[168:171], v[184:187], a[76:79]
v_cvt_pk_bf16_f32 v206, v132, v133
v_cvt_pk_bf16_f32 v207, v134, v135
v_mfma_f32_16x16x32_bf16 a[44:47], a[168:171], v[160:163], a[44:47]
v_cvt_pk_bf16_f32 v182, v116, v117
v_cvt_pk_bf16_f32 v183, v118, v119
v_mfma_f32_16x16x32_bf16 a[44:47], a[172:175], v[164:167], a[44:47]
v_accvgpr_read_b32 v20, a128
v_max_f32 v1, v1, v20
v_mfma_f32_16x16x32_bf16 a[12:15], a[172:175], v[156:159], a[12:15]
v_rcp_f32 v20, v20
v_mfma_f32_16x16x32_bf16 a[12:15], a[168:171], v[152:155], a[12:15]
v_accvgpr_read_b32 v232, a0
v_accvgpr_read_b32 v233, a1
v_mfma_f32_16x16x32_bf16 a[16:19], a[176:179], v[152:155], a[16:19]
s_waitcnt vmcnt(16)
s_barrier
v_mfma_f32_16x16x32_bf16 a[16:19], a[180:183], v[156:159], a[16:19]
s_xor_b32 s71, s71, 49152
ds_read_b128 a[144:147], v2 offset:0
v_xor_b32 v3, 0x8000, v3
v_mfma_f32_16x16x32_bf16 a[48:51], a[180:183], v[164:167], a[48:51]
s_add_u32 s70, s70, 32768
ds_read_b128 a[148:151], v2 offset:1024
v_accvgpr_read_b32 v234, a2
v_mfma_f32_16x16x32_bf16 a[48:51], a[176:179], v[160:163], a[48:51]
s_mov_b32 m0, s71
ds_read_b128 a[152:155], v2 offset:2048
v_accvgpr_read_b32 v235, a3
v_mfma_f32_16x16x32_bf16 a[80:83], a[176:179], v[184:187], a[80:83]
buffer_load_dwordx4 v16, s[32:35], s70 offen offset:0 sc1 lds
v_mfma_f32_16x16x32_bf16 a[80:83], a[180:183], v[188:191], a[80:83]
ds_read_b128 a[156:159], v2 offset:3072
v_accvgpr_read_b32 v236, a4
v_mfma_f32_16x16x32_bf16 a[112:115], a[180:183], v[196:199], a[112:115]
ds_read_b128 a[160:163], v2 offset:4096
v_accvgpr_read_b32 v237, a5
v_mfma_f32_16x16x32_bf16 a[112:115], a[176:179], v[192:195], a[112:115]
ds_read_b128 a[164:167], v2 offset:5120
v_accvgpr_read_b32 v238, a6
v_mfma_f32_16x16x32_bf16 a[116:119], a[184:187], v[192:195], a[116:119]
ds_read_b128 a[168:171], v2 offset:6144
v_accvgpr_read_b32 v239, a7
v_mfma_f32_16x16x32_bf16 a[116:119], a[188:191], v[196:199], a[116:119]
ds_read_b128 a[172:175], v2 offset:7168
v_mul_f32 v20, v20, v4
v_mfma_f32_16x16x32_bf16 a[84:87], a[188:191], v[188:191], a[84:87]
v_mul_f32 v232, v232, v20
v_mul_f32 v233, v233, v20
v_mfma_f32_16x16x32_bf16 a[84:87], a[184:187], v[184:187], a[84:87]
v_mul_f32 v234, v234, v20
v_mul_f32 v235, v235, v20
v_mfma_f32_16x16x32_bf16 a[52:55], a[184:187], v[160:163], a[52:55]
v_mul_f32 v236, v236, v20
v_mul_f32 v237, v237, v20
v_mfma_f32_16x16x32_bf16 a[52:55], a[188:191], v[164:167], a[52:55]
v_mul_f32 v238, v238, v20
v_mul_f32 v239, v239, v20
v_mfma_f32_16x16x32_bf16 a[20:23], a[188:191], v[156:159], a[20:23]
v_cvt_pk_bf16_f32 v232, v232, v233
v_cvt_pk_bf16_f32 v233, v234, v235
v_mfma_f32_16x16x32_bf16 a[20:23], a[184:187], v[152:155], a[20:23]
v_cvt_pk_bf16_f32 v234, v236, v237
v_cvt_pk_bf16_f32 v235, v238, v239
v_mfma_f32_16x16x32_bf16 a[24:27], a[192:195], v[152:155], a[24:27]
s_add_u32 s77, s74, 0
buffer_store_dwordx4 v[232:235], v16, s[44:47], s77 offen sc1
v_mfma_f32_16x16x32_bf16 a[24:27], a[196:199], v[156:159], a[24:27]
v_accvgpr_read_b32 v240, a8
v_accvgpr_read_b32 v241, a9
v_mfma_f32_16x16x32_bf16 a[56:59], a[196:199], v[164:167], a[56:59]
buffer_load_dwordx4 v16, s[32:35], s70 offen offset:1024 sc1 lds
v_mfma_f32_16x16x32_bf16 a[56:59], a[192:195], v[160:163], a[56:59]
v_accvgpr_read_b32 v242, a10
v_accvgpr_read_b32 v243, a11
v_mfma_f32_16x16x32_bf16 a[88:91], a[192:195], v[184:187], a[88:91]
v_accvgpr_read_b32 v244, a12
v_accvgpr_read_b32 v245, a13
v_mfma_f32_16x16x32_bf16 a[88:91], a[196:199], v[188:191], a[88:91]
v_accvgpr_read_b32 v246, a14
v_accvgpr_read_b32 v247, a15
v_mfma_f32_16x16x32_bf16 a[120:123], a[196:199], v[196:199], a[120:123]
v_mul_f32 v240, v240, v20
v_mul_f32 v241, v241, v20
v_mfma_f32_16x16x32_bf16 a[120:123], a[192:195], v[192:195], a[120:123]
s_waitcnt lgkmcnt(0)
v_mul_f32 v242, v242, v20
v_mul_f32 v243, v243, v20
v_mfma_f32_16x16x32_bf16 a[124:127], a[200:203], v[192:195], a[124:127]
v_mul_f32 v244, v244, v20
v_mul_f32 v245, v245, v20
v_mfma_f32_16x16x32_bf16 a[124:127], a[204:207], v[196:199], a[124:127]
v_mul_f32 v246, v246, v20
v_mul_f32 v247, v247, v20
v_mfma_f32_16x16x32_bf16 a[92:95], a[204:207], v[188:191], a[92:95]
v_cvt_pk_bf16_f32 v240, v240, v241
v_cvt_pk_bf16_f32 v241, v242, v243
v_mfma_f32_16x16x32_bf16 a[92:95], a[200:203], v[184:187], a[92:95]
v_cvt_pk_bf16_f32 v242, v244, v245
v_cvt_pk_bf16_f32 v243, v246, v247
v_mfma_f32_16x16x32_bf16 a[60:63], a[200:203], v[160:163], a[60:63]
s_add_u32 s77, s74, 8192
buffer_store_dwordx4 v[240:243], v16, s[44:47], s77 offen sc1
v_mfma_f32_16x16x32_bf16 a[60:63], a[204:207], v[164:167], a[60:63]
v_accvgpr_read_b32 v232, a16
v_accvgpr_read_b32 v233, a17
v_mfma_f32_16x16x32_bf16 a[28:31], a[204:207], v[156:159], a[28:31]
v_accvgpr_read_b32 v234, a18
v_accvgpr_read_b32 v235, a19
v_mfma_f32_16x16x32_bf16 a[28:31], a[200:203], v[152:155], a[28:31]
v_accvgpr_read_b32 v236, a20
v_accvgpr_read_b32 v237, a21
v_accvgpr_read_b32 v238, a22
v_accvgpr_read_b32 v239, a23
v_mul_f32 v232, v232, v20
v_mul_f32 v233, v233, v20
v_mul_f32 v234, v234, v20
v_mul_f32 v235, v235, v20
v_mul_f32 v236, v236, v20
v_mul_f32 v237, v237, v20
v_mul_f32 v238, v238, v20
v_mul_f32 v239, v239, v20
v_cvt_pk_bf16_f32 v232, v232, v233
v_cvt_pk_bf16_f32 v233, v234, v235
v_cvt_pk_bf16_f32 v234, v236, v237
v_cvt_pk_bf16_f32 v235, v238, v239
s_add_u32 s77, s74, 16384
buffer_store_dwordx4 v[232:235], v16, s[44:47], s77 offen sc1
s_cmp_eq_u32 s3, 7
s_cbranch_scc1 L_T1
L_T:
s_waitcnt lgkmcnt(7)
v_mfma_f32_16x16x32_bf16 v[120:123], a[144:147], v[56:59], v[224:227]
s_waitcnt lgkmcnt(6)
ds_read_b128 a[176:179], v2 offset:8192
v_mfma_f32_16x16x32_bf16 v[120:123], a[148:151], v[60:63], v[120:123]
s_waitcnt lgkmcnt(6)
ds_read_b128 a[180:183], v2 offset:9216
v_mfma_f32_16x16x32_bf16 v[120:123], a[152:155], v[64:67], v[120:123]
s_waitcnt lgkmcnt(6)
buffer_load_dwordx4 v16, s[32:35], s70 offen offset:2048 sc1 lds
v_mfma_f32_16x16x32_bf16 v[120:123], a[156:159], v[68:71], v[120:123]
ds_read_b128 a[184:187], v2 offset:10240
v_mfma_f32_16x16x32_bf16 v[136:139], a[156:159], v[84:87], v[228:231]
ds_read_b128 a[188:191], v2 offset:11264
v_mfma_f32_16x16x32_bf16 v[136:139], a[152:155], v[80:83], v[136:139]
ds_read_b128 a[192:195], v2 offset:12288
v_mfma_f32_16x16x32_bf16 v[136:139], a[148:151], v[76:79], v[136:139]
v_mfma_f32_16x16x32_bf16 v[136:139], a[144:147], v[72:75], v[136:139]
s_waitcnt lgkmcnt(3)
ds_read_b128 a[196:199], v2 offset:13312
v_mfma_f32_16x16x32_bf16 v[140:143], a[160:163], v[72:75], v[228:231]
ds_read_b128 a[200:203], v2 offset:14336
v_accvgpr_read_b32 v240, a24
v_mfma_f32_16x16x32_bf16 v[140:143], a[164:167], v[76:79], v[140:143]
ds_read_b128 a[204:207], v2 offset:15360
v_accvgpr_read_b32 v241, a25
v_mfma_f32_16x16x32_bf16 v[140:143], a[168:171], v[80:83], v[140:143]
v_exp_f32 v120, v120
v_mfma_f32_16x16x32_bf16 v[140:143], a[172:175], v[84:87], v[140:143]
v_exp_f32 v121, v121
v_mfma_f32_16x16x32_bf16 v[124:127], a[172:175], v[68:71], v[224:227]
buffer_load_dwordx4 v16, s[32:35], s70 offen offset:3072 sc1 lds
v_mfma_f32_16x16x32_bf16 v[124:127], a[168:171], v[64:67], v[124:127]
v_exp_f32 v122, v122
v_mfma_f32_16x16x32_bf16 v[124:127], a[164:167], v[60:63], v[124:127]
v_exp_f32 v123, v123
v_mfma_f32_16x16x32_bf16 v[124:127], a[160:163], v[56:59], v[124:127]
v_exp_f32 v136, v136
v_mfma_f32_16x16x32_bf16 v[128:131], a[176:179], v[56:59], v[224:227]
v_exp_f32 v137, v137
v_mfma_f32_16x16x32_bf16 v[128:131], a[180:183], v[60:63], v[128:131]
s_waitcnt lgkmcnt(0)
v_exp_f32 v138, v138
v_mfma_f32_16x16x32_bf16 v[128:131], a[184:187], v[64:67], v[128:131]
v_exp_f32 v139, v139
v_mfma_f32_16x16x32_bf16 v[128:131], a[188:191], v[68:71], v[128:131]
s_add_u32 m0, s71, 4096
v_exp_f32 v140, v140
v_mfma_f32_16x16x32_bf16 v[144:147], a[188:191], v[84:87], v[228:231]
s_add_u32 s64, s70, 4096
v_cvt_pk_bf16_f32 v184, v120, v121
v_cvt_pk_bf16_f32 v185, v122, v123
v_mfma_f32_16x16x32_bf16 v[144:147], a[184:187], v[80:83], v[144:147]
buffer_load_dwordx4 v16, s[32:35], s64 offen offset:0 sc1 lds
v_mfma_f32_16x16x32_bf16 v[144:147], a[180:183], v[76:79], v[144:147]
ds_read_b128 a[144:147], v3 offset:0
v_cvt_pk_bf16_f32 v192, v136, v137
v_mfma_f32_16x16x32_bf16 v[144:147], a[176:179], v[72:75], v[144:147]
ds_read_b128 a[148:151], v3 offset:8192
v_cvt_pk_bf16_f32 v193, v138, v139
v_mfma_f32_16x16x32_bf16 v[148:151], a[192:195], v[72:75], v[228:231]
v_exp_f32 v141, v141
v_mfma_f32_16x16x32_bf16 v[148:151], a[196:199], v[76:79], v[148:151]
v_exp_f32 v142, v142
v_mfma_f32_16x16x32_bf16 v[148:151], a[200:203], v[80:83], v[148:151]
v_exp_f32 v143, v143
v_mfma_f32_16x16x32_bf16 v[148:151], a[204:207], v[84:87], v[148:151]
ds_read_b128 a[152:155], v3 offset:1024
v_cvt_pk_bf16_f32 v194, v140, v141
v_mfma_f32_16x16x32_bf16 v[132:135], a[204:207], v[68:71], v[224:227]
ds_read_b128 a[156:159], v3 offset:9216
v_accvgpr_read_b32 v242, a26
v_mfma_f32_16x16x32_bf16 v[132:135], a[200:203], v[64:67], v[132:135]
v_exp_f32 v124, v124
v_mfma_f32_16x16x32_bf16 v[132:135], a[196:199], v[60:63], v[132:135]
v_exp_f32 v125, v125
v_mfma_f32_16x16x32_bf16 v[132:135], a[192:195], v[56:59], v[132:135]
buffer_load_dwordx4 v16, s[32:35], s64 offen offset:1024 sc1 lds
v_mfma_f32_16x16x32_bf16 a[132:135], a[244:247], v[176:179], a[132:135]
ds_read_b128 a[160:163], v3 offset:2048
v_accvgpr_read_b32 v243, a27
v_mfma_f32_16x16x32_bf16 a[132:135], a[244:247], v[180:183], a[132:135]
ds_read_b128 a[164:167], v3 offset:10240
v_accvgpr_read_b32 v244, a28
v_mfma_f32_16x16x32_bf16 a[136:139], a[244:247], v[200:203], a[136:139]
ds_read_b128 a[168:171], v3 offset:3072
v_accvgpr_read_b32 v245, a29
v_mfma_f32_16x16x32_bf16 a[136:139], a[244:247], v[204:207], a[136:139]
ds_read_b128 a[172:175], v3 offset:11264
v_accvgpr_read_b32 v246, a30
v_mfma_f32_16x16x32_bf16 a[140:143], a[244:247], v[208:211], a[140:143]
ds_read_b128 a[176:179], v3 offset:4096
v_accvgpr_read_b32 v247, a31
v_mfma_f32_16x16x32_bf16 a[140:143], a[244:247], v[212:215], a[140:143]
s_waitcnt lgkmcnt(5)
ds_read_b128 a[180:183], v3 offset:12288
v_mul_f32 v240, v240, v20
v_mfma_f32_16x16x32_bf16 a[32:35], a[144:147], v[176:179], a[32:35]
ds_read_b128 a[184:187], v3 offset:5120
v_mul_f32 v241, v241, v20
v_mfma_f32_16x16x32_bf16 a[32:35], a[148:151], v[180:183], a[32:35]
ds_read_b128 a[188:191], v3 offset:13312
v_mul_f32 v242, v242, v20
v_mfma_f32_16x16x32_bf16 a[64:67], a[148:151], v[204:207], a[64:67]
ds_read_b128 a[192:195], v3 offset:6144
v_mul_f32 v243, v243, v20
v_mfma_f32_16x16x32_bf16 a[64:67], a[144:147], v[200:203], a[64:67]
ds_read_b128 a[196:199], v3 offset:14336
v_mul_f32 v244, v244, v20
v_mfma_f32_16x16x32_bf16 a[96:99], a[144:147], v[208:211], a[96:99]
ds_read_b128 a[200:203], v3 offset:7168
v_mul_f32 v245, v245, v20
v_mul_f32 v246, v246, v20
v_mul_f32 v247, v247, v20
v_cvt_pk_bf16_f32 v240, v240, v241
v_cvt_pk_bf16_f32 v241, v242, v243
v_cvt_pk_bf16_f32 v242, v244, v245
v_cvt_pk_bf16_f32 v243, v246, v247
s_add_u32 s77, s74, 24576
buffer_store_dwordx4 v[240:243], v16, s[44:47], s77 offen sc1
v_mfma_f32_16x16x32_bf16 a[96:99], a[148:151], v[212:215], a[96:99]
v_exp_f32 v126, v126
v_mfma_f32_16x16x32_bf16 a[100:103], a[156:159], v[212:215], a[100:103]
buffer_load_dwordx4 v16, s[32:35], s64 offen offset:2048 sc1 lds
v_cvt_pk_bf16_f32 v195, v142, v143
v_mfma_f32_16x16x32_bf16 a[100:103], a[152:155], v[208:211], a[100:103]
v_exp_f32 v127, v127
v_mfma_f32_16x16x32_bf16 a[68:71], a[152:155], v[200:203], a[68:71]
v_exp_f32 v128, v128
v_mfma_f32_16x16x32_bf16 a[68:71], a[156:159], v[204:207], a[68:71]
v_exp_f32 v129, v129
v_mfma_f32_16x16x32_bf16 a[36:39], a[156:159], v[180:183], a[36:39]
v_exp_f32 v130, v130
v_mfma_f32_16x16x32_bf16 a[36:39], a[152:155], v[176:179], a[36:39]
s_waitcnt lgkmcnt(0)
v_cvt_pk_bf16_f32 v186, v124, v125
v_cvt_pk_bf16_f32 v187, v126, v127
v_mfma_f32_16x16x32_bf16 a[40:43], a[160:163], v[176:179], a[40:43]
v_exp_f32 v131, v131
v_mfma_f32_16x16x32_bf16 a[40:43], a[164:167], v[180:183], a[40:43]
buffer_load_dwordx4 v16, s[32:35], s64 offen offset:3072 sc1 lds
v_mfma_f32_16x16x32_bf16 a[72:75], a[164:167], v[204:207], a[72:75]
v_exp_f32 v144, v144
v_mfma_f32_16x16x32_bf16 a[72:75], a[160:163], v[200:203], a[72:75]
v_exp_f32 v145, v145
v_mfma_f32_16x16x32_bf16 a[104:107], a[160:163], v[208:211], a[104:107]
v_exp_f32 v146, v146
v_mfma_f32_16x16x32_bf16 a[104:107], a[164:167], v[212:215], a[104:107]
ds_read_b128 a[204:207], v3 offset:15360
v_cvt_pk_bf16_f32 v188, v128, v129
v_mfma_f32_16x16x32_bf16 a[108:111], a[172:175], v[212:215], a[108:111]
v_exp_f32 v147, v147
v_mfma_f32_16x16x32_bf16 a[108:111], a[168:171], v[208:211], a[108:111]
v_exp_f32 v148, v148
v_mfma_f32_16x16x32_bf16 a[76:79], a[168:171], v[200:203], a[76:79]
v_exp_f32 v149, v149
v_mfma_f32_16x16x32_bf16 a[76:79], a[172:175], v[204:207], a[76:79]
v_exp_f32 v150, v150
v_mfma_f32_16x16x32_bf16 a[44:47], a[172:175], v[180:183], a[44:47]
v_exp_f32 v151, v151
v_mfma_f32_16x16x32_bf16 a[44:47], a[168:171], v[176:179], a[44:47]
v_exp_f32 v132, v132
v_mfma_f32_16x16x32_bf16 a[48:51], a[176:179], v[176:179], a[48:51]
v_exp_f32 v133, v133
v_mfma_f32_16x16x32_bf16 a[48:51], a[180:183], v[180:183], a[48:51]
s_waitcnt vmcnt(9)
s_barrier
v_cvt_pk_bf16_f32 v189, v130, v131
v_mfma_f32_16x16x32_bf16 a[80:83], a[180:183], v[204:207], a[80:83]
s_xor_b32 s71, s71, 16384
ds_read_b128 a[144:147], v2 offset:16384
v_cvt_pk_bf16_f32 v196, v144, v145
v_mfma_f32_16x16x32_bf16 a[80:83], a[176:179], v[200:203], a[80:83]
s_add_u32 s70, s70, 32768
v_exp_f32 v134, v134
v_mfma_f32_16x16x32_bf16 a[112:115], a[176:179], v[208:211], a[112:115]
s_mov_b32 m0, s71
ds_read_b128 a[148:151], v2 offset:17408
v_cvt_pk_bf16_f32 v197, v146, v147
v_mfma_f32_16x16x32_bf16 a[112:115], a[180:183], v[212:215], a[112:115]
buffer_load_dwordx4 v16, s[32:35], s70 offen offset:0 sc1 lds
v_mfma_f32_16x16x32_bf16 a[116:119], a[188:191], v[212:215], a[116:119]
ds_read_b128 a[152:155], v2 offset:18432
v_cvt_pk_bf16_f32 v198, v148, v149
v_mfma_f32_16x16x32_bf16 a[116:119], a[184:187], v[208:211], a[116:119]
ds_read_b128 a[156:159], v2 offset:19456
v_cvt_pk_bf16_f32 v199, v150, v151
v_mfma_f32_16x16x32_bf16 a[84:87], a[184:187], v[200:203], a[84:87]
v_exp_f32 v135, v135
v_mfma_f32_16x16x32_bf16 a[84:87], a[188:191], v[204:207], a[84:87]
ds_read_b128 a[160:163], v2 offset:20480
v_cvt_pk_bf16_f32 v190, v132, v133
v_mfma_f32_16x16x32_bf16 a[52:55], a[188:191], v[180:183], a[52:55]
ds_read_b128 a[164:167], v2 offset:21504
v_cvt_pk_bf16_f32 v191, v134, v135
v_mfma_f32_16x16x32_bf16 a[52:55], a[184:187], v[176:179], a[52:55]
ds_read_b128 a[168:171], v2 offset:22528
v_accvgpr_read_b32 v21, a132
v_mfma_f32_16x16x32_bf16 a[56:59], a[192:195], v[176:179], a[56:59]
ds_read_b128 a[172:175], v2 offset:23552
v_max_f32 v1, v1, v21
v_mfma_f32_16x16x32_bf16 a[56:59], a[196:199], v[180:183], a[56:59]
v_rcp_f32 v21, v21
v_mfma_f32_16x16x32_bf16 a[88:91], a[196:199], v[204:207], a[88:91]
buffer_load_dwordx4 v16, s[32:35], s70 offen offset:1024 sc1 lds
v_mfma_f32_16x16x32_bf16 a[88:91], a[192:195], v[200:203], a[88:91]
v_accvgpr_read_b32 v232, a32
v_accvgpr_read_b32 v233, a33
v_mfma_f32_16x16x32_bf16 a[120:123], a[192:195], v[208:211], a[120:123]
v_accvgpr_read_b32 v234, a34
v_accvgpr_read_b32 v235, a35
v_mfma_f32_16x16x32_bf16 a[120:123], a[196:199], v[212:215], a[120:123]
s_waitcnt lgkmcnt(1)
v_accvgpr_read_b32 v236, a36
v_accvgpr_read_b32 v237, a37
v_mfma_f32_16x16x32_bf16 a[124:127], a[204:207], v[212:215], a[124:127]
v_accvgpr_read_b32 v238, a38
v_accvgpr_read_b32 v239, a39
v_mfma_f32_16x16x32_bf16 a[124:127], a[200:203], v[208:211], a[124:127]
v_mul_f32 v21, v21, v6
v_mul_f32 v232, v232, v21
v_mfma_f32_16x16x32_bf16 a[92:95], a[200:203], v[200:203], a[92:95]
v_mul_f32 v233, v233, v21
v_mul_f32 v234, v234, v21
v_mfma_f32_16x16x32_bf16 a[92:95], a[204:207], v[204:207], a[92:95]
v_mul_f32 v235, v235, v21
v_mul_f32 v236, v236, v21
v_mfma_f32_16x16x32_bf16 a[60:63], a[204:207], v[180:183], a[60:63]
v_mul_f32 v237, v237, v21
v_mul_f32 v238, v238, v21
v_mfma_f32_16x16x32_bf16 a[60:63], a[200:203], v[176:179], a[60:63]
v_mul_f32 v239, v239, v21
v_cvt_pk_bf16_f32 v232, v232, v233
v_mfma_f32_16x16x32_bf16 v[120:123], a[144:147], v[56:59], v[224:227]
ds_read_b128 a[176:179], v2 offset:24576
ds_read_b128 a[180:183], v2 offset:25600
v_mfma_f32_16x16x32_bf16 v[120:123], a[148:151], v[60:63], v[120:123]
ds_read_b128 a[184:187], v2 offset:26624
v_cvt_pk_bf16_f32 v233, v234, v235
v_mfma_f32_16x16x32_bf16 v[120:123], a[152:155], v[64:67], v[120:123]
buffer_load_dwordx4 v16, s[32:35], s70 offen offset:2048 sc1 lds
v_mfma_f32_16x16x32_bf16 v[120:123], a[156:159], v[68:71], v[120:123]
ds_read_b128 a[188:191], v2 offset:27648
ds_read_b128 a[192:195], v2 offset:28672
v_mfma_f32_16x16x32_bf16 v[136:139], a[156:159], v[84:87], v[228:231]
ds_read_b128 a[196:199], v2 offset:29696
v_cvt_pk_bf16_f32 v234, v236, v237
v_mfma_f32_16x16x32_bf16 v[136:139], a[152:155], v[80:83], v[136:139]
buffer_load_dwordx4 v16, s[32:35], s70 offen offset:3072 sc1 lds
v_mfma_f32_16x16x32_bf16 v[136:139], a[148:151], v[76:79], v[136:139]
ds_read_b128 a[200:203], v2 offset:30720
ds_read_b128 a[204:207], v2 offset:31744
v_mfma_f32_16x16x32_bf16 v[136:139], a[144:147], v[72:75], v[136:139]
v_exp_f32 v120, v120
v_mfma_f32_16x16x32_bf16 v[140:143], a[160:163], v[72:75], v[228:231]
v_exp_f32 v121, v121
v_mfma_f32_16x16x32_bf16 v[140:143], a[164:167], v[76:79], v[140:143]
s_add_u32 m0, s71, 4096
v_exp_f32 v122, v122
v_mfma_f32_16x16x32_bf16 v[140:143], a[168:171], v[80:83], v[140:143]
s_waitcnt lgkmcnt(2)
v_cvt_pk_bf16_f32 v235, v238, v239
s_add_u32 s77, s74, 4096
buffer_store_dwordx4 v[232:235], v16, s[44:47], s77 offen sc1
v_accvgpr_read_b32 v240, a40
v_accvgpr_read_b32 v241, a41
v_accvgpr_read_b32 v242, a42
v_accvgpr_read_b32 v243, a43
v_accvgpr_read_b32 v244, a44
v_accvgpr_read_b32 v245, a45
v_accvgpr_read_b32 v246, a46
v_accvgpr_read_b32 v247, a47
v_mul_f32 v240, v240, v21
v_mul_f32 v241, v241, v21
v_mul_f32 v242, v242, v21
v_mul_f32 v243, v243, v21
v_mul_f32 v244, v244, v21
v_mul_f32 v245, v245, v21
v_mul_f32 v246, v246, v21
v_mul_f32 v247, v247, v21
v_cvt_pk_bf16_f32 v240, v240, v241
v_cvt_pk_bf16_f32 v241, v242, v243
v_cvt_pk_bf16_f32 v242, v244, v245
v_cvt_pk_bf16_f32 v243, v246, v247
s_add_u32 s77, s74, 12288
buffer_store_dwordx4 v[240:243], v16, s[44:47], s77 offen sc1
v_accvgpr_read_b32 v232, a48
v_accvgpr_read_b32 v233, a49
v_accvgpr_read_b32 v234, a50
v_accvgpr_read_b32 v235, a51
v_accvgpr_read_b32 v236, a52
v_accvgpr_read_b32 v237, a53
v_accvgpr_read_b32 v238, a54
v_accvgpr_read_b32 v239, a55
v_mul_f32 v232, v232, v21
v_mul_f32 v233, v233, v21
v_mul_f32 v234, v234, v21
v_mul_f32 v235, v235, v21
v_mul_f32 v236, v236, v21
v_mul_f32 v237, v237, v21
v_mul_f32 v238, v238, v21
v_mul_f32 v239, v239, v21
v_cvt_pk_bf16_f32 v232, v232, v233
v_cvt_pk_bf16_f32 v233, v234, v235
v_cvt_pk_bf16_f32 v234, v236, v237
v_cvt_pk_bf16_f32 v235, v238, v239
s_add_u32 s77, s74, 20480
buffer_store_dwordx4 v[232:235], v16, s[44:47], s77 offen sc1
v_accvgpr_read_b32 v240, a56
v_accvgpr_read_b32 v241, a57
v_accvgpr_read_b32 v242, a58
v_accvgpr_read_b32 v243, a59
v_accvgpr_read_b32 v244, a60
v_accvgpr_read_b32 v245, a61
v_accvgpr_read_b32 v246, a62
v_accvgpr_read_b32 v247, a63
v_mul_f32 v240, v240, v21
v_mul_f32 v241, v241, v21
v_mul_f32 v242, v242, v21
v_mul_f32 v243, v243, v21
v_mul_f32 v244, v244, v21
v_mul_f32 v245, v245, v21
v_mul_f32 v246, v246, v21
v_mul_f32 v247, v247, v21
v_cvt_pk_bf16_f32 v240, v240, v241
v_cvt_pk_bf16_f32 v241, v242, v243
v_cvt_pk_bf16_f32 v242, v244, v245
v_cvt_pk_bf16_f32 v243, v246, v247
s_add_u32 s77, s74, 28672
buffer_store_dwordx4 v[240:243], v16, s[44:47], s77 offen sc1
v_exp_f32 v123, v123
v_mfma_f32_16x16x32_bf16 v[140:143], a[172:175], v[84:87], v[140:143]
v_exp_f32 v136, v136
v_mfma_f32_16x16x32_bf16 v[124:127], a[172:175], v[68:71], v[224:227]
ds_read_b128 a[144:147], v3 offset:16384
v_cvt_pk_bf16_f32 v200, v120, v121
v_mfma_f32_16x16x32_bf16 v[124:127], a[168:171], v[64:67], v[124:127]
s_add_u32 s64, s70, 4096
v_exp_f32 v137, v137
v_mfma_f32_16x16x32_bf16 v[124:127], a[164:167], v[60:63], v[124:127]
ds_read_b128 a[148:151], v3 offset:24576
v_cvt_pk_bf16_f32 v201, v122, v123
v_mfma_f32_16x16x32_bf16 v[124:127], a[160:163], v[56:59], v[124:127]
v_exp_f32 v138, v138
v_mfma_f32_16x16x32_bf16 v[128:131], a[176:179], v[56:59], v[224:227]
ds_read_b128 a[152:155], v3 offset:17408
v_cvt_pk_bf16_f32 v208, v136, v137
v_mfma_f32_16x16x32_bf16 v[128:131], a[180:183], v[60:63], v[128:131]
v_exp_f32 v139, v139
v_mfma_f32_16x16x32_bf16 v[128:131], a[184:187], v[64:67], v[128:131]
ds_read_b128 a[156:159], v3 offset:25600
v_cvt_pk_bf16_f32 v209, v138, v139
v_mfma_f32_16x16x32_bf16 v[128:131], a[188:191], v[68:71], v[128:131]
v_exp_f32 v140, v140
v_mfma_f32_16x16x32_bf16 v[144:147], a[188:191], v[84:87], v[228:231]
buffer_load_dwordx4 v16, s[32:35], s64 offen offset:0 sc1 lds
v_mfma_f32_16x16x32_bf16 v[144:147], a[184:187], v[80:83], v[144:147]
v_exp_f32 v141, v141
v_mfma_f32_16x16x32_bf16 v[144:147], a[180:183], v[76:79], v[144:147]
ds_read_b128 a[160:163], v3 offset:18432
v_cvt_pk_bf16_f32 v210, v140, v141
v_mfma_f32_16x16x32_bf16 v[144:147], a[176:179], v[72:75], v[144:147]
v_exp_f32 v142, v142
v_mfma_f32_16x16x32_bf16 v[148:151], a[192:195], v[72:75], v[228:231]
ds_read_b128 a[164:167], v3 offset:26624
ds_read_b128 a[168:171], v3 offset:19456
v_mfma_f32_16x16x32_bf16 v[148:151], a[196:199], v[76:79], v[148:151]
s_waitcnt lgkmcnt(3)
v_exp_f32 v143, v143
v_mfma_f32_16x16x32_bf16 v[148:151], a[200:203], v[80:83], v[148:151]
ds_read_b128 a[172:175], v3 offset:27648
v_cvt_pk_bf16_f32 v211, v142, v143
v_mfma_f32_16x16x32_bf16 v[148:151], a[204:207], v[84:87], v[148:151]
v_exp_f32 v124, v124
v_mfma_f32_16x16x32_bf16 v[132:135], a[204:207], v[68:71], v[224:227]
buffer_load_dwordx4 v16, s[32:35], s64 offen offset:1024 sc1 lds
v_mfma_f32_16x16x32_bf16 v[132:135], a[200:203], v[64:67], v[132:135]
v_exp_f32 v125, v125
v_mfma_f32_16x16x32_bf16 v[132:135], a[196:199], v[60:63], v[132:135]
ds_read_b128 a[176:179], v3 offset:20480
v_cvt_pk_bf16_f32 v202, v124, v125
v_mfma_f32_16x16x32_bf16 v[132:135], a[192:195], v[56:59], v[132:135]
v_exp_f32 v126, v126
v_mfma_f32_16x16x32_bf16 a[136:139], a[244:247], v[184:187], a[136:139]
ds_read_b128 a[180:183], v3 offset:28672
ds_read_b128 a[184:187], v3 offset:21504
v_mfma_f32_16x16x32_bf16 a[136:139], a[244:247], v[188:191], a[136:139]
v_exp_f32 v127, v127
v_mfma_f32_16x16x32_bf16 a[140:143], a[244:247], v[192:195], a[140:143]
ds_read_b128 a[188:191], v3 offset:29696
v_cvt_pk_bf16_f32 v203, v126, v127
v_mfma_f32_16x16x32_bf16 a[140:143], a[244:247], v[196:199], a[140:143]
v_exp_f32 v128, v128
v_mfma_f32_16x16x32_bf16 a[64:67], a[144:147], v[184:187], a[64:67]
buffer_load_dwordx4 v16, s[32:35], s64 offen offset:2048 sc1 lds
v_mfma_f32_16x16x32_bf16 a[64:67], a[148:151], v[188:191], a[64:67]
v_exp_f32 v129, v129
v_mfma_f32_16x16x32_bf16 a[96:99], a[148:151], v[196:199], a[96:99]
ds_read_b128 a[192:195], v3 offset:22528
v_cvt_pk_bf16_f32 v204, v128, v129
v_mfma_f32_16x16x32_bf16 a[96:99], a[144:147], v[192:195], a[96:99]
v_exp_f32 v130, v130
v_mfma_f32_16x16x32_bf16 a[100:103], a[152:155], v[192:195], a[100:103]
ds_read_b128 a[196:199], v3 offset:30720
v_xor_b32 v2, 0x8000, v2
v_mfma_f32_16x16x32_bf16 a[100:103], a[156:159], v[196:199], a[100:103]
v_exp_f32 v131, v131
v_mfma_f32_16x16x32_bf16 a[68:71], a[156:159], v[188:191], a[68:71]
ds_read_b128 a[200:203], v3 offset:23552
v_cvt_pk_bf16_f32 v205, v130, v131
v_mfma_f32_16x16x32_bf16 a[68:71], a[152:155], v[184:187], a[68:71]
s_waitcnt lgkmcnt(3)
v_exp_f32 v144, v144
v_mfma_f32_16x16x32_bf16 a[72:75], a[160:163], v[184:187], a[72:75]
buffer_load_dwordx4 v16, s[32:35], s64 offen offset:3072 sc1 lds
v_mfma_f32_16x16x32_bf16 a[72:75], a[164:167], v[188:191], a[72:75]
s_xor_b32 s71, s71, 49152
v_exp_f32 v145, v145
v_mfma_f32_16x16x32_bf16 a[104:107], a[164:167], v[196:199], a[104:107]
ds_read_b128 a[204:207], v3 offset:31744
v_cvt_pk_bf16_f32 v212, v144, v145
v_mfma_f32_16x16x32_bf16 a[104:107], a[160:163], v[192:195], a[104:107]
v_exp_f32 v146, v146
v_mfma_f32_16x16x32_bf16 a[108:111], a[168:171], v[192:195], a[108:111]
s_waitcnt vmcnt(12)
s_barrier
v_mfma_f32_16x16x32_bf16 a[108:111], a[172:175], v[196:199], a[108:111]
s_add_u32 s70, s70, 32768
v_exp_f32 v147, v147
v_mfma_f32_16x16x32_bf16 a[76:79], a[172:175], v[188:191], a[76:79]
ds_read_b128 a[144:147], v2 offset:0
v_cvt_pk_bf16_f32 v213, v146, v147
v_mfma_f32_16x16x32_bf16 a[76:79], a[168:171], v[184:187], a[76:79]
v_exp_f32 v148, v148
v_mfma_f32_16x16x32_bf16 a[80:83], a[176:179], v[184:187], a[80:83]
ds_read_b128 a[148:151], v2 offset:1024
v_xor_b32 v3, 0x8000, v3
v_mfma_f32_16x16x32_bf16 a[80:83], a[180:183], v[188:191], a[80:83]
s_mov_b32 m0, s71
v_exp_f32 v149, v149
v_mfma_f32_16x16x32_bf16 a[112:115], a[180:183], v[196:199], a[112:115]
ds_read_b128 a[152:155], v2 offset:2048
v_cvt_pk_bf16_f32 v214, v148, v149
v_mfma_f32_16x16x32_bf16 a[112:115], a[176:179], v[192:195], a[112:115]
v_exp_f32 v150, v150
v_mfma_f32_16x16x32_bf16 a[116:119], a[184:187], v[192:195], a[116:119]
buffer_load_dwordx4 v16, s[32:35], s70 offen offset:0 sc1 lds
v_mfma_f32_16x16x32_bf16 a[116:119], a[188:191], v[196:199], a[116:119]
v_exp_f32 v151, v151
v_mfma_f32_16x16x32_bf16 a[84:87], a[188:191], v[188:191], a[84:87]
ds_read_b128 a[156:159], v2 offset:3072
v_cvt_pk_bf16_f32 v215, v150, v151
v_mfma_f32_16x16x32_bf16 a[84:87], a[184:187], v[184:187], a[84:87]
s_waitcnt lgkmcnt(2)
v_exp_f32 v132, v132
v_mfma_f32_16x16x32_bf16 a[88:91], a[192:195], v[184:187], a[88:91]
ds_read_b128 a[160:163], v2 offset:4096
v_mfma_f32_16x16x32_bf16 a[88:91], a[196:199], v[188:191], a[88:91]
v_exp_f32 v133, v133
v_mfma_f32_16x16x32_bf16 a[120:123], a[196:199], v[196:199], a[120:123]
ds_read_b128 a[164:167], v2 offset:5120
v_cvt_pk_bf16_f32 v206, v132, v133
v_mfma_f32_16x16x32_bf16 a[120:123], a[192:195], v[192:195], a[120:123]
v_exp_f32 v134, v134
v_mfma_f32_16x16x32_bf16 a[124:127], a[200:203], v[192:195], a[124:127]
buffer_load_dwordx4 v16, s[32:35], s70 offen offset:1024 sc1 lds
v_mfma_f32_16x16x32_bf16 a[124:127], a[204:207], v[196:199], a[124:127]
v_exp_f32 v135, v135
v_mfma_f32_16x16x32_bf16 a[92:95], a[204:207], v[188:191], a[92:95]
ds_read_b128 a[168:171], v2 offset:6144
v_cvt_pk_bf16_f32 v207, v134, v135
v_mfma_f32_16x16x32_bf16 a[92:95], a[200:203], v[184:187], a[92:95]
ds_read_b128 a[172:175], v2 offset:7168
s_lshl_b32 s72, s3, 1
s_sub_u32 s72, 13, s72
.p2align 3
L_S:
s_waitcnt lgkmcnt(7)
v_mfma_f32_16x16x32_bf16 v[120:123], a[144:147], v[56:59], v[224:227]
s_waitcnt lgkmcnt(6)
ds_read_b128 a[176:179], v2 offset:8192
ds_read_b128 a[180:183], v2 offset:9216
v_mfma_f32_16x16x32_bf16 v[120:123], a[148:151], v[60:63], v[120:123]
s_waitcnt lgkmcnt(7)
ds_read_b128 a[184:187], v2 offset:10240
v_mfma_f32_16x16x32_bf16 v[120:123], a[152:155], v[64:67], v[120:123]
s_waitcnt lgkmcnt(7)
buffer_load_dwordx4 v16, s[32:35], s70 offen offset:2048 sc1 lds
v_mfma_f32_16x16x32_bf16 v[120:123], a[156:159], v[68:71], v[120:123]
ds_read_b128 a[188:191], v2 offset:11264
ds_read_b128 a[192:195], v2 offset:12288
v_mfma_f32_16x16x32_bf16 v[136:139], a[156:159], v[84:87], v[228:231]
ds_read_b128 a[196:199], v2 offset:13312
v_mfma_f32_16x16x32_bf16 v[136:139], a[152:155], v[80:83], v[136:139]
buffer_load_dwordx4 v16, s[32:35], s70 offen offset:3072 sc1 lds
v_mfma_f32_16x16x32_bf16 v[136:139], a[148:151], v[76:79], v[136:139]
ds_read_b128 a[200:203], v2 offset:14336
ds_read_b128 a[204:207], v2 offset:15360
v_mfma_f32_16x16x32_bf16 v[136:139], a[144:147], v[72:75], v[136:139]
s_waitcnt lgkmcnt(5)
v_exp_f32 v120, v120
v_mfma_f32_16x16x32_bf16 v[140:143], a[160:163], v[72:75], v[228:231]
v_exp_f32 v121, v121
v_mfma_f32_16x16x32_bf16 v[140:143], a[164:167], v[76:79], v[140:143]
s_add_u32 m0, s71, 4096
v_exp_f32 v122, v122
v_mfma_f32_16x16x32_bf16 v[140:143], a[168:171], v[80:83], v[140:143]
v_exp_f32 v123, v123
v_mfma_f32_16x16x32_bf16 v[140:143], a[172:175], v[84:87], v[140:143]
v_exp_f32 v136, v136
v_mfma_f32_16x16x32_bf16 v[124:127], a[172:175], v[68:71], v[224:227]
ds_read_b128 a[144:147], v3 offset:0
v_cvt_pk_bf16_f32 v184, v120, v121
v_mfma_f32_16x16x32_bf16 v[124:127], a[168:171], v[64:67], v[124:127]
s_add_u32 s64, s70, 4096
v_exp_f32 v137, v137
v_mfma_f32_16x16x32_bf16 v[124:127], a[164:167], v[60:63], v[124:127]
ds_read_b128 a[148:151], v3 offset:8192
v_cvt_pk_bf16_f32 v185, v122, v123
v_mfma_f32_16x16x32_bf16 v[124:127], a[160:163], v[56:59], v[124:127]
v_exp_f32 v138, v138
v_mfma_f32_16x16x32_bf16 v[128:131], a[176:179], v[56:59], v[224:227]
ds_read_b128 a[152:155], v3 offset:1024
v_cvt_pk_bf16_f32 v192, v136, v137
v_mfma_f32_16x16x32_bf16 v[128:131], a[180:183], v[60:63], v[128:131]
v_exp_f32 v139, v139
v_mfma_f32_16x16x32_bf16 v[128:131], a[184:187], v[64:67], v[128:131]
s_waitcnt lgkmcnt(2)
ds_read_b128 a[156:159], v3 offset:9216
v_cvt_pk_bf16_f32 v193, v138, v139
v_mfma_f32_16x16x32_bf16 v[128:131], a[188:191], v[68:71], v[128:131]
v_exp_f32 v140, v140
v_mfma_f32_16x16x32_bf16 v[144:147], a[188:191], v[84:87], v[228:231]
buffer_load_dwordx4 v16, s[32:35], s64 offen offset:0 sc1 lds
v_mfma_f32_16x16x32_bf16 v[144:147], a[184:187], v[80:83], v[144:147]
v_exp_f32 v141, v141
v_mfma_f32_16x16x32_bf16 v[144:147], a[180:183], v[76:79], v[144:147]
ds_read_b128 a[160:163], v3 offset:2048
v_cvt_pk_bf16_f32 v194, v140, v141
v_mfma_f32_16x16x32_bf16 v[144:147], a[176:179], v[72:75], v[144:147]
v_exp_f32 v142, v142
v_mfma_f32_16x16x32_bf16 v[148:151], a[192:195], v[72:75], v[228:231]
ds_read_b128 a[164:167], v3 offset:10240
ds_read_b128 a[168:171], v3 offset:3072
v_mfma_f32_16x16x32_bf16 v[148:151], a[196:199], v[76:79], v[148:151]
v_exp_f32 v143, v143
v_mfma_f32_16x16x32_bf16 v[148:151], a[200:203], v[80:83], v[148:151]
ds_read_b128 a[172:175], v3 offset:11264
v_cvt_pk_bf16_f32 v195, v142, v143
v_mfma_f32_16x16x32_bf16 v[148:151], a[204:207], v[84:87], v[148:151]
v_exp_f32 v124, v124
v_mfma_f32_16x16x32_bf16 v[132:135], a[204:207], v[68:71], v[224:227]
buffer_load_dwordx4 v16, s[32:35], s64 offen offset:1024 sc1 lds
v_mfma_f32_16x16x32_bf16 v[132:135], a[200:203], v[64:67], v[132:135]
v_exp_f32 v125, v125
v_mfma_f32_16x16x32_bf16 v[132:135], a[196:199], v[60:63], v[132:135]
ds_read_b128 a[176:179], v3 offset:4096
v_cvt_pk_bf16_f32 v186, v124, v125
v_mfma_f32_16x16x32_bf16 v[132:135], a[192:195], v[56:59], v[132:135]
v_exp_f32 v126, v126
v_mfma_f32_16x16x32_bf16 a[136:139], a[244:247], v[200:203], a[136:139]
ds_read_b128 a[180:183], v3 offset:12288
ds_read_b128 a[184:187], v3 offset:5120
v_mfma_f32_16x16x32_bf16 a[136:139], a[244:247], v[204:207], a[136:139]
v_exp_f32 v127, v127
v_mfma_f32_16x16x32_bf16 a[140:143], a[244:247], v[208:211], a[140:143]
ds_read_b128 a[188:191], v3 offset:13312
v_cvt_pk_bf16_f32 v187, v126, v127
v_mfma_f32_16x16x32_bf16 a[140:143], a[244:247], v[212:215], a[140:143]
v_exp_f32 v128, v128
v_mfma_f32_16x16x32_bf16 a[64:67], a[144:147], v[200:203], a[64:67]
s_waitcnt lgkmcnt(3)
buffer_load_dwordx4 v16, s[32:35], s64 offen offset:2048 sc1 lds
v_mfma_f32_16x16x32_bf16 a[64:67], a[148:151], v[204:207], a[64:67]
v_exp_f32 v129, v129
v_mfma_f32_16x16x32_bf16 a[96:99], a[148:151], v[212:215], a[96:99]
ds_read_b128 a[192:195], v3 offset:6144
v_cvt_pk_bf16_f32 v188, v128, v129
v_mfma_f32_16x16x32_bf16 a[96:99], a[144:147], v[208:211], a[96:99]
v_exp_f32 v130, v130
v_mfma_f32_16x16x32_bf16 a[100:103], a[152:155], v[208:211], a[100:103]
ds_read_b128 a[196:199], v3 offset:14336
v_mfma_f32_16x16x32_bf16 a[100:103], a[156:159], v[212:215], a[100:103]
v_exp_f32 v131, v131
v_mfma_f32_16x16x32_bf16 a[68:71], a[156:159], v[204:207], a[68:71]
ds_read_b128 a[200:203], v3 offset:7168
v_cvt_pk_bf16_f32 v189, v130, v131
v_mfma_f32_16x16x32_bf16 a[68:71], a[152:155], v[200:203], a[68:71]
v_exp_f32 v144, v144
v_mfma_f32_16x16x32_bf16 a[72:75], a[160:163], v[200:203], a[72:75]
buffer_load_dwordx4 v16, s[32:35], s64 offen offset:3072 sc1 lds
v_mfma_f32_16x16x32_bf16 a[72:75], a[164:167], v[204:207], a[72:75]
s_xor_b32 s71, s71, 16384
v_exp_f32 v145, v145
v_mfma_f32_16x16x32_bf16 a[104:107], a[164:167], v[212:215], a[104:107]
ds_read_b128 a[204:207], v3 offset:15360
v_cvt_pk_bf16_f32 v196, v144, v145
v_mfma_f32_16x16x32_bf16 a[104:107], a[160:163], v[208:211], a[104:107]
v_exp_f32 v146, v146
v_mfma_f32_16x16x32_bf16 a[108:111], a[168:171], v[208:211], a[108:111]
s_waitcnt vmcnt(8)
s_barrier
v_mfma_f32_16x16x32_bf16 a[108:111], a[172:175], v[212:215], a[108:111]
s_add_u32 s70, s70, 32768
v_exp_f32 v147, v147
v_mfma_f32_16x16x32_bf16 a[76:79], a[172:175], v[204:207], a[76:79]
ds_read_b128 a[144:147], v2 offset:16384
v_cvt_pk_bf16_f32 v197, v146, v147
v_mfma_f32_16x16x32_bf16 a[76:79], a[168:171], v[200:203], a[76:79]
v_exp_f32 v148, v148
v_mfma_f32_16x16x32_bf16 a[80:83], a[176:179], v[200:203], a[80:83]
s_waitcnt lgkmcnt(1)
ds_read_b128 a[148:151], v2 offset:17408
v_mfma_f32_16x16x32_bf16 a[80:83], a[180:183], v[204:207], a[80:83]
s_mov_b32 m0, s71
v_exp_f32 v149, v149
v_mfma_f32_16x16x32_bf16 a[112:115], a[180:183], v[212:215], a[112:115]
ds_read_b128 a[152:155], v2 offset:18432
v_cvt_pk_bf16_f32 v198, v148, v149
v_mfma_f32_16x16x32_bf16 a[112:115], a[176:179], v[208:211], a[112:115]
v_exp_f32 v150, v150
v_mfma_f32_16x16x32_bf16 a[116:119], a[184:187], v[208:211], a[116:119]
buffer_load_dwordx4 v16, s[32:35], s70 offen offset:0 sc1 lds
v_mfma_f32_16x16x32_bf16 a[116:119], a[188:191], v[212:215], a[116:119]
v_exp_f32 v151, v151
v_mfma_f32_16x16x32_bf16 a[84:87], a[188:191], v[204:207], a[84:87]
ds_read_b128 a[156:159], v2 offset:19456
v_cvt_pk_bf16_f32 v199, v150, v151
v_mfma_f32_16x16x32_bf16 a[84:87], a[184:187], v[200:203], a[84:87]
v_exp_f32 v132, v132
v_mfma_f32_16x16x32_bf16 a[88:91], a[192:195], v[200:203], a[88:91]
ds_read_b128 a[160:163], v2 offset:20480
v_mfma_f32_16x16x32_bf16 a[88:91], a[196:199], v[204:207], a[88:91]
v_exp_f32 v133, v133
v_mfma_f32_16x16x32_bf16 a[120:123], a[196:199], v[212:215], a[120:123]
ds_read_b128 a[164:167], v2 offset:21504
v_cvt_pk_bf16_f32 v190, v132, v133
v_mfma_f32_16x16x32_bf16 a[120:123], a[192:195], v[208:211], a[120:123]
v_exp_f32 v134, v134
v_mfma_f32_16x16x32_bf16 a[124:127], a[200:203], v[208:211], a[124:127]
buffer_load_dwordx4 v16, s[32:35], s70 offen offset:1024 sc1 lds
v_mfma_f32_16x16x32_bf16 a[124:127], a[204:207], v[212:215], a[124:127]
v_exp_f32 v135, v135
v_mfma_f32_16x16x32_bf16 a[92:95], a[204:207], v[204:207], a[92:95]
ds_read_b128 a[168:171], v2 offset:22528
v_cvt_pk_bf16_f32 v191, v134, v135
v_mfma_f32_16x16x32_bf16 a[92:95], a[200:203], v[200:203], a[92:95]
s_waitcnt lgkmcnt(2)
ds_read_b128 a[172:175], v2 offset:23552
v_mfma_f32_16x16x32_bf16 v[120:123], a[144:147], v[56:59], v[224:227]
ds_read_b128 a[176:179], v2 offset:24576
ds_read_b128 a[180:183], v2 offset:25600
v_mfma_f32_16x16x32_bf16 v[120:123], a[148:151], v[60:63], v[120:123]
ds_read_b128 a[184:187], v2 offset:26624
v_mfma_f32_16x16x32_bf16 v[120:123], a[152:155], v[64:67], v[120:123]
buffer_load_dwordx4 v16, s[32:35], s70 offen offset:2048 sc1 lds
v_mfma_f32_16x16x32_bf16 v[120:123], a[156:159], v[68:71], v[120:123]
ds_read_b128 a[188:191], v2 offset:27648
ds_read_b128 a[192:195], v2 offset:28672
v_mfma_f32_16x16x32_bf16 v[136:139], a[156:159], v[84:87], v[228:231]
ds_read_b128 a[196:199], v2 offset:29696
v_mfma_f32_16x16x32_bf16 v[136:139], a[152:155], v[80:83], v[136:139]
buffer_load_dwordx4 v16, s[32:35], s70 offen offset:3072 sc1 lds
v_mfma_f32_16x16x32_bf16 v[136:139], a[148:151], v[76:79], v[136:139]
ds_read_b128 a[200:203], v2 offset:30720
ds_read_b128 a[204:207], v2 offset:31744
v_mfma_f32_16x16x32_bf16 v[136:139], a[144:147], v[72:75], v[136:139]
v_exp_f32 v120, v120
v_mfma_f32_16x16x32_bf16 v[140:143], a[160:163], v[72:75], v[228:231]
s_waitcnt lgkmcnt(5)
v_exp_f32 v121, v121
v_mfma_f32_16x16x32_bf16 v[140:143], a[164:167], v[76:79], v[140:143]
s_add_u32 m0, s71, 4096
v_exp_f32 v122, v122
v_mfma_f32_16x16x32_bf16 v[140:143], a[168:171], v[80:83], v[140:143]
v_exp_f32 v123, v123
v_mfma_f32_16x16x32_bf16 v[140:143], a[172:175], v[84:87], v[140:143]
v_exp_f32 v136, v136
v_mfma_f32_16x16x32_bf16 v[124:127], a[172:175], v[68:71], v[224:227]
ds_read_b128 a[144:147], v3 offset:16384
v_cvt_pk_bf16_f32 v200, v120, v121
v_mfma_f32_16x16x32_bf16 v[124:127], a[168:171], v[64:67], v[124:127]
s_add_u32 s64, s70, 4096
v_exp_f32 v137, v137
v_mfma_f32_16x16x32_bf16 v[124:127], a[164:167], v[60:63], v[124:127]
ds_read_b128 a[148:151], v3 offset:24576
v_cvt_pk_bf16_f32 v201, v122, v123
v_mfma_f32_16x16x32_bf16 v[124:127], a[160:163], v[56:59], v[124:127]
v_exp_f32 v138, v138
v_mfma_f32_16x16x32_bf16 v[128:131], a[176:179], v[56:59], v[224:227]
ds_read_b128 a[152:155], v3 offset:17408
v_cvt_pk_bf16_f32 v208, v136, v137
v_mfma_f32_16x16x32_bf16 v[128:131], a[180:183], v[60:63], v[128:131]
v_exp_f32 v139, v139
v_mfma_f32_16x16x32_bf16 v[128:131], a[184:187], v[64:67], v[128:131]
s_waitcnt lgkmcnt(2)
ds_read_b128 a[156:159], v3 offset:25600
v_cvt_pk_bf16_f32 v209, v138, v139
v_mfma_f32_16x16x32_bf16 v[128:131], a[188:191], v[68:71], v[128:131]
v_exp_f32 v140, v140
v_mfma_f32_16x16x32_bf16 v[144:147], a[188:191], v[84:87], v[228:231]
buffer_load_dwordx4 v16, s[32:35], s64 offen offset:0 sc1 lds
v_mfma_f32_16x16x32_bf16 v[144:147], a[184:187], v[80:83], v[144:147]
v_exp_f32 v141, v141
v_mfma_f32_16x16x32_bf16 v[144:147], a[180:183], v[76:79], v[144:147]
ds_read_b128 a[160:163], v3 offset:18432
v_cvt_pk_bf16_f32 v210, v140, v141
v_mfma_f32_16x16x32_bf16 v[144:147], a[176:179], v[72:75], v[144:147]
v_exp_f32 v142, v142
v_mfma_f32_16x16x32_bf16 v[148:151], a[192:195], v[72:75], v[228:231]
ds_read_b128 a[164:167], v3 offset:26624
ds_read_b128 a[168:171], v3 offset:19456
v_mfma_f32_16x16x32_bf16 v[148:151], a[196:199], v[76:79], v[148:151]
v_exp_f32 v143, v143
v_mfma_f32_16x16x32_bf16 v[148:151], a[200:203], v[80:83], v[148:151]
ds_read_b128 a[172:175], v3 offset:27648
v_cvt_pk_bf16_f32 v211, v142, v143
v_mfma_f32_16x16x32_bf16 v[148:151], a[204:207], v[84:87], v[148:151]
v_exp_f32 v124, v124
v_mfma_f32_16x16x32_bf16 v[132:135], a[204:207], v[68:71], v[224:227]
buffer_load_dwordx4 v16, s[32:35], s64 offen offset:1024 sc1 lds
v_mfma_f32_16x16x32_bf16 v[132:135], a[200:203], v[64:67], v[132:135]
v_exp_f32 v125, v125
v_mfma_f32_16x16x32_bf16 v[132:135], a[196:199], v[60:63], v[132:135]
ds_read_b128 a[176:179], v3 offset:20480
v_cvt_pk_bf16_f32 v202, v124, v125
v_mfma_f32_16x16x32_bf16 v[132:135], a[192:195], v[56:59], v[132:135]
v_exp_f32 v126, v126
v_mfma_f32_16x16x32_bf16 a[136:139], a[244:247], v[184:187], a[136:139]
ds_read_b128 a[180:183], v3 offset:28672
ds_read_b128 a[184:187], v3 offset:21504
v_mfma_f32_16x16x32_bf16 a[136:139], a[244:247], v[188:191], a[136:139]
v_exp_f32 v127, v127
v_mfma_f32_16x16x32_bf16 a[140:143], a[244:247], v[192:195], a[140:143]
ds_read_b128 a[188:191], v3 offset:29696
v_cvt_pk_bf16_f32 v203, v126, v127
v_mfma_f32_16x16x32_bf16 a[140:143], a[244:247], v[196:199], a[140:143]
v_exp_f32 v128, v128
v_mfma_f32_16x16x32_bf16 a[64:67], a[144:147], v[184:187], a[64:67]
s_waitcnt lgkmcnt(3)
buffer_load_dwordx4 v16, s[32:35], s64 offen offset:2048 sc1 lds
v_mfma_f32_16x16x32_bf16 a[64:67], a[148:151], v[188:191], a[64:67]
v_exp_f32 v129, v129
v_mfma_f32_16x16x32_bf16 a[96:99], a[148:151], v[196:199], a[96:99]
ds_read_b128 a[192:195], v3 offset:22528
v_cvt_pk_bf16_f32 v204, v128, v129
v_mfma_f32_16x16x32_bf16 a[96:99], a[144:147], v[192:195], a[96:99]
v_exp_f32 v130, v130
v_mfma_f32_16x16x32_bf16 a[100:103], a[152:155], v[192:195], a[100:103]
ds_read_b128 a[196:199], v3 offset:30720
v_xor_b32 v2, 0x8000, v2
v_mfma_f32_16x16x32_bf16 a[100:103], a[156:159], v[196:199], a[100:103]
v_exp_f32 v131, v131
v_mfma_f32_16x16x32_bf16 a[68:71], a[156:159], v[188:191], a[68:71]
ds_read_b128 a[200:203], v3 offset:23552
v_cvt_pk_bf16_f32 v205, v130, v131
v_mfma_f32_16x16x32_bf16 a[68:71], a[152:155], v[184:187], a[68:71]
v_exp_f32 v144, v144
v_mfma_f32_16x16x32_bf16 a[72:75], a[160:163], v[184:187], a[72:75]
buffer_load_dwordx4 v16, s[32:35], s64 offen offset:3072 sc1 lds
v_mfma_f32_16x16x32_bf16 a[72:75], a[164:167], v[188:191], a[72:75]
s_xor_b32 s71, s71, 49152
v_exp_f32 v145, v145
v_mfma_f32_16x16x32_bf16 a[104:107], a[164:167], v[196:199], a[104:107]
ds_read_b128 a[204:207], v3 offset:31744
v_cvt_pk_bf16_f32 v212, v144, v145
v_mfma_f32_16x16x32_bf16 a[104:107], a[160:163], v[192:195], a[104:107]
v_exp_f32 v146, v146
v_mfma_f32_16x16x32_bf16 a[108:111], a[168:171], v[192:195], a[108:111]
s_waitcnt vmcnt(8)
s_barrier
v_mfma_f32_16x16x32_bf16 a[108:111], a[172:175], v[196:199], a[108:111]
s_add_u32 s70, s70, 32768
v_exp_f32 v147, v147
v_mfma_f32_16x16x32_bf16 a[76:79], a[172:175], v[188:191], a[76:79]
ds_read_b128 a[144:147], v2 offset:0
v_cvt_pk_bf16_f32 v213, v146, v147
v_mfma_f32_16x16x32_bf16 a[76:79], a[168:171], v[184:187], a[76:79]
v_exp_f32 v148, v148
v_mfma_f32_16x16x32_bf16 a[80:83], a[176:179], v[184:187], a[80:83]
s_waitcnt lgkmcnt(1)
ds_read_b128 a[148:151], v2 offset:1024
v_xor_b32 v3, 0x8000, v3
v_mfma_f32_16x16x32_bf16 a[80:83], a[180:183], v[188:191], a[80:83]
s_mov_b32 m0, s71
v_exp_f32 v149, v149
v_mfma_f32_16x16x32_bf16 a[112:115], a[180:183], v[196:199], a[112:115]
ds_read_b128 a[152:155], v2 offset:2048
v_cvt_pk_bf16_f32 v214, v148, v149
v_mfma_f32_16x16x32_bf16 a[112:115], a[176:179], v[192:195], a[112:115]
v_exp_f32 v150, v150
v_mfma_f32_16x16x32_bf16 a[116:119], a[184:187], v[192:195], a[116:119]
buffer_load_dwordx4 v16, s[32:35], s70 offen offset:0 sc1 lds
v_mfma_f32_16x16x32_bf16 a[116:119], a[188:191], v[196:199], a[116:119]
s_sub_u32 s72, s72, 1
v_exp_f32 v151, v151
v_mfma_f32_16x16x32_bf16 a[84:87], a[188:191], v[188:191], a[84:87]
ds_read_b128 a[156:159], v2 offset:3072
v_cvt_pk_bf16_f32 v215, v150, v151
v_mfma_f32_16x16x32_bf16 a[84:87], a[184:187], v[184:187], a[84:87]
v_exp_f32 v132, v132
v_mfma_f32_16x16x32_bf16 a[88:91], a[192:195], v[184:187], a[88:91]
ds_read_b128 a[160:163], v2 offset:4096
v_mfma_f32_16x16x32_bf16 a[88:91], a[196:199], v[188:191], a[88:91]
s_cmp_lg_u32 s72, 0
v_exp_f32 v133, v133
v_mfma_f32_16x16x32_bf16 a[120:123], a[196:199], v[196:199], a[120:123]
ds_read_b128 a[164:167], v2 offset:5120
v_cvt_pk_bf16_f32 v206, v132, v133
v_mfma_f32_16x16x32_bf16 a[120:123], a[192:195], v[192:195], a[120:123]
v_exp_f32 v134, v134
v_mfma_f32_16x16x32_bf16 a[124:127], a[200:203], v[192:195], a[124:127]
buffer_load_dwordx4 v16, s[32:35], s70 offen offset:1024 sc1 lds
v_mfma_f32_16x16x32_bf16 a[124:127], a[204:207], v[196:199], a[124:127]
v_exp_f32 v135, v135
v_mfma_f32_16x16x32_bf16 a[92:95], a[204:207], v[188:191], a[92:95]
ds_read_b128 a[168:171], v2 offset:6144
v_cvt_pk_bf16_f32 v207, v134, v135
v_mfma_f32_16x16x32_bf16 a[92:95], a[200:203], v[184:187], a[92:95]
ds_read_b128 a[172:175], v2 offset:7168
s_cbranch_scc1 L_S
buffer_load_dword v19, off, s[52:55], s80 sc1
s_add_u32 s17, s78, L_TAIL-L_pc
buffer_load_dword a252, v16, s[88:91], s17 offen
s_add_u32 s17, s78, L_TAIL-L_pc+4096
buffer_load_dword a252, v16, s[88:91], s17 offen
s_add_u32 s17, s78, L_p5f0-L_pc
buffer_load_dword a252, v16, s[88:91], s17 offen
s_add_u32 s17, s78, L_p5f0-L_pc+4096
buffer_load_dword a252, v16, s[88:91], s17 offen
s_waitcnt lgkmcnt(7)
v_mfma_f32_16x16x32_bf16 v[136:139], a[144:147], v[72:75], v[228:231]
s_waitcnt lgkmcnt(6)
ds_read_b128 a[176:179], v2 offset:8192
ds_read_b128 a[180:183], v2 offset:9216
v_mfma_f32_16x16x32_bf16 v[136:139], a[148:151], v[76:79], v[136:139]
s_waitcnt lgkmcnt(7)
ds_read_b128 a[184:187], v2 offset:10240
v_cndmask_b32 v120, v224, v17, s[0:1]
v_cndmask_b32 v121, v224, v17, s[4:5]
v_cndmask_b32 v122, v224, v17, s[6:7]
v_cndmask_b32 v123, v224, v17, s[8:9]
v_mfma_f32_16x16x32_bf16 v[136:139], a[152:155], v[80:83], v[136:139]
s_waitcnt lgkmcnt(7)
buffer_load_dwordx4 v16, s[32:35], s70 offen offset:2048 sc1 lds
v_mfma_f32_16x16x32_bf16 v[136:139], a[156:159], v[84:87], v[136:139]
ds_read_b128 a[188:191], v2 offset:11264
ds_read_b128 a[192:195], v2 offset:12288
v_mfma_f32_16x16x32_bf16 v[120:123], a[156:159], v[68:71], v[120:123]
ds_read_b128 a[196:199], v2 offset:13312
v_cndmask_b32 v124, v224, v17, s[10:11]
v_mfma_f32_16x16x32_bf16 v[120:123], a[152:155], v[64:67], v[120:123]
buffer_load_dwordx4 v16, s[32:35], s70 offen offset:3072 sc1 lds
v_mfma_f32_16x16x32_bf16 v[120:123], a[148:151], v[60:63], v[120:123]
ds_read_b128 a[200:203], v2 offset:14336
ds_read_b128 a[204:207], v2 offset:15360
v_mfma_f32_16x16x32_bf16 v[120:123], a[144:147], v[56:59], v[120:123]
s_waitcnt lgkmcnt(5)
v_exp_f32 v136, v136
v_mfma_f32_16x16x32_bf16 v[140:143], a[160:163], v[72:75], v[228:231]
v_exp_f32 v137, v137
v_mfma_f32_16x16x32_bf16 v[140:143], a[164:167], v[76:79], v[140:143]
s_add_u32 m0, s71, 4096
v_cndmask_b32 v125, v224, v17, s[12:13]
v_cndmask_b32 v126, v224, v17, s[18:19]
v_cndmask_b32 v127, v224, v17, s[22:23]
v_exp_f32 v138, v138
v_mfma_f32_16x16x32_bf16 v[140:143], a[168:171], v[80:83], v[140:143]
v_exp_f32 v139, v139
v_mfma_f32_16x16x32_bf16 v[140:143], a[172:175], v[84:87], v[140:143]
v_exp_f32 v120, v120
v_mfma_f32_16x16x32_bf16 v[124:127], a[172:175], v[68:71], v[124:127]
ds_read_b128 a[144:147], v3 offset:0
v_cvt_pk_bf16_f32 v192, v136, v137
v_mfma_f32_16x16x32_bf16 v[124:127], a[168:171], v[64:67], v[124:127]
s_add_u32 s64, s70, 4096
v_cndmask_b32 v128, v224, v17, s[26:27]
v_cndmask_b32 v129, v224, v17, s[56:57]
v_cndmask_b32 v130, v224, v17, s[58:59]
v_cndmask_b32 v131, v224, v17, s[60:61]
v_exp_f32 v121, v121
v_mfma_f32_16x16x32_bf16 v[124:127], a[164:167], v[60:63], v[124:127]
s_mul_i32 s69, s83, 8
ds_read_b128 a[148:151], v3 offset:8192
v_cvt_pk_bf16_f32 v193, v138, v139
v_mfma_f32_16x16x32_bf16 v[124:127], a[160:163], v[56:59], v[124:127]
s_sub_u32 s69, 36, s69
v_exp_f32 v122, v122
v_mfma_f32_16x16x32_bf16 v[128:131], a[176:179], v[56:59], v[128:131]
ds_read_b128 a[152:155], v3 offset:1024
v_cvt_pk_bf16_f32 v184, v120, v121
v_mfma_f32_16x16x32_bf16 v[128:131], a[180:183], v[60:63], v[128:131]
v_exp_f32 v123, v123
v_mfma_f32_16x16x32_bf16 v[128:131], a[184:187], v[64:67], v[128:131]
s_waitcnt lgkmcnt(2)
ds_read_b128 a[156:159], v3 offset:9216
v_cvt_pk_bf16_f32 v185, v122, v123
v_mfma_f32_16x16x32_bf16 v[128:131], a[188:191], v[68:71], v[128:131]
v_exp_f32 v140, v140
v_mfma_f32_16x16x32_bf16 v[144:147], a[188:191], v[84:87], v[228:231]
buffer_load_dwordx4 v16, s[32:35], s64 offen offset:0 sc1 lds
v_mfma_f32_16x16x32_bf16 v[144:147], a[184:187], v[80:83], v[144:147]
v_exp_f32 v141, v141
v_mfma_f32_16x16x32_bf16 v[144:147], a[180:183], v[76:79], v[144:147]
ds_read_b128 a[160:163], v3 offset:2048
v_cvt_pk_bf16_f32 v194, v140, v141
v_mfma_f32_16x16x32_bf16 v[144:147], a[176:179], v[72:75], v[144:147]
v_exp_f32 v142, v142
v_mfma_f32_16x16x32_bf16 v[148:151], a[192:195], v[72:75], v[228:231]
ds_read_b128 a[164:167], v3 offset:10240
ds_read_b128 a[168:171], v3 offset:3072
v_mfma_f32_16x16x32_bf16 v[148:151], a[196:199], v[76:79], v[148:151]
v_cndmask_b32 v132, v224, v17, s[62:63]
v_cndmask_b32 v133, v224, v17, s[48:49]
v_cndmask_b32 v134, v224, v17, s[50:51]
v_cndmask_b32 v135, v224, v17, s[100:101]
v_exp_f32 v143, v143
v_mfma_f32_16x16x32_bf16 v[148:151], a[200:203], v[80:83], v[148:151]
ds_read_b128 a[172:175], v3 offset:11264
v_cvt_pk_bf16_f32 v195, v142, v143
v_mfma_f32_16x16x32_bf16 v[148:151], a[204:207], v[84:87], v[148:151]
v_exp_f32 v124, v124
v_mfma_f32_16x16x32_bf16 v[132:135], a[204:207], v[68:71], v[132:135]
buffer_load_dwordx4 v16, s[32:35], s64 offen offset:1024 sc1 lds
v_mfma_f32_16x16x32_bf16 v[132:135], a[200:203], v[64:67], v[132:135]
v_exp_f32 v125, v125
v_mfma_f32_16x16x32_bf16 v[132:135], a[196:199], v[60:63], v[132:135]
ds_read_b128 a[176:179], v3 offset:4096
v_cvt_pk_bf16_f32 v186, v124, v125
v_mfma_f32_16x16x32_bf16 v[132:135], a[192:195], v[56:59], v[132:135]
v_exp_f32 v126, v126
v_mfma_f32_16x16x32_bf16 a[136:139], a[244:247], v[200:203], a[136:139]
ds_read_b128 a[180:183], v3 offset:12288
ds_read_b128 a[184:187], v3 offset:5120
v_mfma_f32_16x16x32_bf16 a[136:139], a[244:247], v[204:207], a[136:139]
v_exp_f32 v127, v127
v_mfma_f32_16x16x32_bf16 a[140:143], a[244:247], v[208:211], a[140:143]
ds_read_b128 a[188:191], v3 offset:13312
v_cvt_pk_bf16_f32 v187, v126, v127
v_mfma_f32_16x16x32_bf16 a[140:143], a[244:247], v[212:215], a[140:143]
v_exp_f32 v128, v128
v_mfma_f32_16x16x32_bf16 a[64:67], a[144:147], v[200:203], a[64:67]
s_waitcnt lgkmcnt(3)
buffer_load_dwordx4 v16, s[32:35], s64 offen offset:2048 sc1 lds
v_mfma_f32_16x16x32_bf16 a[64:67], a[148:151], v[204:207], a[64:67]
v_exp_f32 v129, v129
v_mfma_f32_16x16x32_bf16 a[96:99], a[148:151], v[212:215], a[96:99]
ds_read_b128 a[192:195], v3 offset:6144
v_cvt_pk_bf16_f32 v188, v128, v129
v_mfma_f32_16x16x32_bf16 a[96:99], a[144:147], v[208:211], a[96:99]
v_exp_f32 v130, v130
v_mfma_f32_16x16x32_bf16 a[100:103], a[152:155], v[208:211], a[100:103]
ds_read_b128 a[196:199], v3 offset:14336
v_mfma_f32_16x16x32_bf16 a[100:103], a[156:159], v[212:215], a[100:103]
v_exp_f32 v131, v131
v_mfma_f32_16x16x32_bf16 a[68:71], a[156:159], v[204:207], a[68:71]
ds_read_b128 a[200:203], v3 offset:7168
v_cvt_pk_bf16_f32 v189, v130, v131
v_mfma_f32_16x16x32_bf16 a[68:71], a[152:155], v[200:203], a[68:71]
v_exp_f32 v144, v144
v_mfma_f32_16x16x32_bf16 a[72:75], a[160:163], v[200:203], a[72:75]
buffer_load_dwordx4 v16, s[32:35], s64 offen offset:3072 sc1 lds
v_mfma_f32_16x16x32_bf16 a[72:75], a[164:167], v[204:207], a[72:75]
v_exp_f32 v145, v145
v_mfma_f32_16x16x32_bf16 a[104:107], a[164:167], v[212:215], a[104:107]
ds_read_b128 a[204:207], v3 offset:15360
v_cvt_pk_bf16_f32 v196, v144, v145
v_mfma_f32_16x16x32_bf16 a[104:107], a[160:163], v[208:211], a[104:107]
v_exp_f32 v146, v146
v_mfma_f32_16x16x32_bf16 a[108:111], a[168:171], v[208:211], a[108:111]
s_waitcnt vmcnt(13)
s_barrier
v_mfma_f32_16x16x32_bf16 a[108:111], a[172:175], v[212:215], a[108:111]
v_exp_f32 v147, v147
v_mfma_f32_16x16x32_bf16 a[76:79], a[172:175], v[204:207], a[76:79]
ds_read_b128 a[144:147], v2 offset:16384
v_cvt_pk_bf16_f32 v197, v146, v147
v_mfma_f32_16x16x32_bf16 a[76:79], a[168:171], v[200:203], a[76:79]
v_exp_f32 v148, v148
v_mfma_f32_16x16x32_bf16 a[80:83], a[176:179], v[200:203], a[80:83]
s_waitcnt vmcnt(10)
v_readfirstlane_b32 vcc_lo, v19
s_nop 0
s_cmp_lt_u32 vcc_lo, s69
s_cbranch_scc1 L_spin_8
L_spinbk_9:
ds_read_b128 a[148:151], v2 offset:17408
s_waitcnt lgkmcnt(2)
v_mfma_f32_16x16x32_bf16 a[80:83], a[180:183], v[204:207], a[80:83]
v_exp_f32 v149, v149
v_mfma_f32_16x16x32_bf16 a[112:115], a[180:183], v[212:215], a[112:115]
ds_read_b128 a[152:155], v2 offset:18432
v_cvt_pk_bf16_f32 v198, v148, v149
v_mfma_f32_16x16x32_bf16 a[112:115], a[176:179], v[208:211], a[112:115]
v_exp_f32 v150, v150
v_mfma_f32_16x16x32_bf16 a[116:119], a[184:187], v[208:211], a[116:119]
v_cndmask_b32 v136, v228, v17, s[0:1]
v_cndmask_b32 v137, v228, v17, s[4:5]
v_mfma_f32_16x16x32_bf16 a[116:119], a[188:191], v[212:215], a[116:119]
v_exp_f32 v151, v151
v_mfma_f32_16x16x32_bf16 a[84:87], a[188:191], v[204:207], a[84:87]
ds_read_b128 a[156:159], v2 offset:19456
v_cvt_pk_bf16_f32 v199, v150, v151
v_mfma_f32_16x16x32_bf16 a[84:87], a[184:187], v[200:203], a[84:87]
v_exp_f32 v132, v132
v_mfma_f32_16x16x32_bf16 a[88:91], a[192:195], v[200:203], a[88:91]
ds_read_b128 a[160:163], v2 offset:20480
v_cndmask_b32 v138, v228, v17, s[6:7]
v_mfma_f32_16x16x32_bf16 a[88:91], a[196:199], v[204:207], a[88:91]
v_exp_f32 v133, v133
v_mfma_f32_16x16x32_bf16 a[120:123], a[196:199], v[212:215], a[120:123]
ds_read_b128 a[164:167], v2 offset:21504
v_cvt_pk_bf16_f32 v190, v132, v133
v_mfma_f32_16x16x32_bf16 a[120:123], a[192:195], v[208:211], a[120:123]
v_exp_f32 v134, v134
v_mfma_f32_16x16x32_bf16 a[124:127], a[200:203], v[208:211], a[124:127]
v_cndmask_b32 v139, v228, v17, s[8:9]
v_cndmask_b32 v140, v228, v17, s[10:11]
v_mfma_f32_16x16x32_bf16 a[124:127], a[204:207], v[212:215], a[124:127]
v_exp_f32 v135, v135
v_mfma_f32_16x16x32_bf16 a[92:95], a[204:207], v[204:207], a[92:95]
ds_read_b128 a[168:171], v2 offset:22528
v_cvt_pk_bf16_f32 v191, v134, v135
v_mfma_f32_16x16x32_bf16 a[92:95], a[200:203], v[200:203], a[92:95]
s_waitcnt lgkmcnt(2)
ds_read_b128 a[172:175], v2 offset:23552
v_cndmask_b32 v141, v228, v17, s[12:13]
v_mfma_f32_16x16x32_bf16 v[136:139], a[144:147], v[72:75], v[136:139]
ds_read_b128 a[176:179], v2 offset:24576
v_cndmask_b32 v142, v228, v17, s[18:19]
v_mfma_f32_16x16x32_bf16 v[136:139], a[148:151], v[76:79], v[136:139]
ds_read_b128 a[180:183], v2 offset:25600
v_cndmask_b32 v143, v228, v17, s[22:23]
v_mfma_f32_16x16x32_bf16 v[136:139], a[152:155], v[80:83], v[136:139]
ds_read_b128 a[184:187], v2 offset:26624
v_cndmask_b32 v144, v228, v17, s[26:27]
v_mfma_f32_16x16x32_bf16 v[136:139], a[156:159], v[84:87], v[136:139]
s_waitcnt lgkmcnt(3)
ds_read_b128 a[188:191], v2 offset:27648
v_cndmask_b32 v145, v228, v17, s[56:57]
v_mfma_f32_16x16x32_bf16 v[140:143], a[172:175], v[84:87], v[140:143]
ds_read_b128 a[192:195], v2 offset:28672
ds_read_b128 a[196:199], v2 offset:29696
ds_read_b128 a[200:203], v2 offset:30720
ds_read_b128 a[204:207], v2 offset:31744
v_mfma_f32_16x16x32_bf16 v[140:143], a[168:171], v[80:83], v[140:143]
ds_read_b128 a[144:147], v3 offset:16384
v_cndmask_b32 v146, v228, v17, s[58:59]
v_cndmask_b32 v147, v228, v17, s[60:61]
v_mfma_f32_16x16x32_bf16 v[140:143], a[164:167], v[76:79], v[140:143]
ds_read_b128 a[148:151], v3 offset:24576
v_cndmask_b32 v148, v228, v17, s[62:63]
v_mfma_f32_16x16x32_bf16 v[140:143], a[160:163], v[72:75], v[140:143]
s_waitcnt lgkmcnt(8)
ds_read_b128 a[152:155], v3 offset:17408
v_cndmask_b32 v149, v228, v17, s[48:49]
v_mfma_f32_16x16x32_bf16 v[144:147], a[176:179], v[72:75], v[144:147]
ds_read_b128 a[156:159], v3 offset:25600
v_cndmask_b32 v150, v228, v17, s[50:51]
v_mfma_f32_16x16x32_bf16 v[144:147], a[180:183], v[76:79], v[144:147]
s_waitcnt lgkmcnt(8)
ds_read_b128 a[160:163], v3 offset:18432
v_cndmask_b32 v151, v228, v17, s[100:101]
v_mfma_f32_16x16x32_bf16 v[144:147], a[184:187], v[80:83], v[144:147]
v_exp_f32 v136, v136
v_mfma_f32_16x16x32_bf16 v[144:147], a[188:191], v[84:87], v[144:147]
s_waitcnt lgkmcnt(4)
v_exp_f32 v137, v137
v_mfma_f32_16x16x32_bf16 v[148:151], a[204:207], v[84:87], v[148:151]
v_exp_f32 v138, v138
v_mfma_f32_16x16x32_bf16 v[148:151], a[200:203], v[80:83], v[148:151]
s_add_u32 s65, s84, 0
v_exp_f32 v139, v139
v_mfma_f32_16x16x32_bf16 v[148:151], a[196:199], v[76:79], v[148:151]
buffer_load_dwordx4 a[208:211], v14, s[44:47], s65 offen offset:0 sc1
v_mfma_f32_16x16x32_bf16 v[148:151], a[192:195], v[72:75], v[148:151]
ds_read_b128 a[164:167], v3 offset:26624
v_cvt_pk_bf16_f32 v208, v136, v137
v_mfma_f32_16x16x32_bf16 a[136:139], a[244:247], v[184:187], a[136:139]
v_exp_f32 v140, v140
v_mfma_f32_16x16x32_bf16 a[136:139], a[244:247], v[188:191], a[136:139]
buffer_load_dwordx4 a[216:219], v14, s[44:47], s65 offen offset:1024 sc1
v_mfma_f32_16x16x32_bf16 a[140:143], a[244:247], v[192:195], a[140:143]
v_exp_f32 v141, v141
v_mfma_f32_16x16x32_bf16 a[140:143], a[244:247], v[196:199], a[140:143]
ds_read_b128 a[168:171], v3 offset:19456
v_cvt_pk_bf16_f32 v209, v138, v139
v_mfma_f32_16x16x32_bf16 a[64:67], a[144:147], v[184:187], a[64:67]
s_waitcnt lgkmcnt(2)
buffer_load_dwordx4 a[224:227], v15, s[44:47], s65 offen offset:0 sc1
v_mfma_f32_16x16x32_bf16 a[64:67], a[148:151], v[188:191], a[64:67]
ds_read_b128 a[172:175], v3 offset:27648
v_cvt_pk_bf16_f32 v210, v140, v141
v_mfma_f32_16x16x32_bf16 a[96:99], a[148:151], v[196:199], a[96:99]
v_exp_f32 v142, v142
v_mfma_f32_16x16x32_bf16 a[96:99], a[144:147], v[192:195], a[96:99]
buffer_load_dwordx4 a[232:235], v15, s[44:47], s65 offen offset:1024 sc1
v_mfma_f32_16x16x32_bf16 a[100:103], a[152:155], v[192:195], a[100:103]
s_add_u32 s65, s84, 8192
ds_read_b128 a[176:179], v3 offset:20480
v_xor_b32 v2, 0x8000, v2
v_mfma_f32_16x16x32_bf16 a[100:103], a[156:159], v[196:199], a[100:103]
buffer_load_dwordx4 a[212:215], v14, s[44:47], s65 offen offset:0 sc1
v_mfma_f32_16x16x32_bf16 a[68:71], a[156:159], v[188:191], a[68:71]
v_exp_f32 v143, v143
v_mfma_f32_16x16x32_bf16 a[68:71], a[152:155], v[184:187], a[68:71]
ds_read_b128 a[180:183], v3 offset:28672
v_cvt_pk_bf16_f32 v211, v142, v143
v_mfma_f32_16x16x32_bf16 a[72:75], a[160:163], v[184:187], a[72:75]
s_waitcnt lgkmcnt(2)
buffer_load_dwordx4 a[220:223], v14, s[44:47], s65 offen offset:1024 sc1
v_mfma_f32_16x16x32_bf16 a[72:75], a[164:167], v[188:191], a[72:75]
v_exp_f32 v144, v144
v_mfma_f32_16x16x32_bf16 a[104:107], a[164:167], v[196:199], a[104:107]
ds_read_b128 a[184:187], v3 offset:21504
v_accvgpr_read_b32 v22, a136
v_mfma_f32_16x16x32_bf16 a[104:107], a[160:163], v[192:195], a[104:107]
buffer_load_dwordx4 a[228:231], v15, s[44:47], s65 offen offset:0 sc1
v_mfma_f32_16x16x32_bf16 a[108:111], a[168:171], v[192:195], a[108:111]
ds_read_b128 a[188:191], v3 offset:29696
v_max_f32 v1, v1, v22
v_mfma_f32_16x16x32_bf16 a[108:111], a[172:175], v[196:199], a[108:111]
v_exp_f32 v145, v145
v_mfma_f32_16x16x32_bf16 a[76:79], a[172:175], v[188:191], a[76:79]
buffer_load_dwordx4 a[236:239], v15, s[44:47], s65 offen offset:1024 sc1
v_mfma_f32_16x16x32_bf16 a[76:79], a[168:171], v[184:187], a[76:79]
s_waitcnt lgkmcnt(2)
v_exp_f32 v146, v146
v_mfma_f32_16x16x32_bf16 a[80:83], a[176:179], v[184:187], a[80:83]
s_add_u32 s65, s84, 32768
ds_read_b128 a[192:195], v3 offset:22528
v_cvt_pk_bf16_f32 v212, v144, v145
v_mfma_f32_16x16x32_bf16 a[80:83], a[180:183], v[188:191], a[80:83]
buffer_load_dwordx4 v[152:155], v14, s[44:47], s65 offen offset:0 sc1
ds_read_b128 a[196:199], v3 offset:30720
ds_read_b128 a[200:203], v3 offset:23552
ds_read_b128 a[204:207], v3 offset:31744
v_mfma_f32_16x16x32_bf16 a[112:115], a[180:183], v[196:199], a[112:115]
s_waitcnt vmcnt(9)
s_barrier
v_xor_b32 v3, 0x8000, v3
v_mfma_f32_16x16x32_bf16 a[112:115], a[176:179], v[192:195], a[112:115]
s_waitcnt lgkmcnt(4)
buffer_load_dwordx4 v[160:163], v14, s[44:47], s65 offen offset:1024 sc1
v_exp_f32 v147, v147
v_mfma_f32_16x16x32_bf16 a[116:119], a[184:187], v[192:195], a[116:119]
v_exp_f32 v148, v148
v_mfma_f32_16x16x32_bf16 a[116:119], a[188:191], v[196:199], a[116:119]
buffer_load_dwordx4 v[168:171], v15, s[44:47], s65 offen offset:0 sc1
v_mfma_f32_16x16x32_bf16 a[84:87], a[188:191], v[188:191], a[84:87]
v_exp_f32 v149, v149
v_mfma_f32_16x16x32_bf16 a[84:87], a[184:187], v[184:187], a[84:87]
s_waitcnt lgkmcnt(0)
buffer_load_dwordx4 v[176:179], v15, s[44:47], s65 offen offset:1024 sc1
v_mfma_f32_16x16x32_bf16 a[88:91], a[192:195], v[184:187], a[88:91]
s_add_u32 s65, s84, 40960
ds_read_b128 a[144:147], v3 offset:0
v_cvt_pk_bf16_f32 v213, v146, v147
v_mfma_f32_16x16x32_bf16 a[88:91], a[196:199], v[188:191], a[88:91]
buffer_load_dwordx4 v[156:159], v14, s[44:47], s65 offen offset:0 sc1
v_mfma_f32_16x16x32_bf16 a[120:123], a[196:199], v[196:199], a[120:123]
v_exp_f32 v150, v150
v_mfma_f32_16x16x32_bf16 a[120:123], a[192:195], v[192:195], a[120:123]
buffer_load_dwordx4 v[164:167], v14, s[44:47], s65 offen offset:1024 sc1
ds_read_b128 a[148:151], v3 offset:8192
v_mfma_f32_16x16x32_bf16 a[124:127], a[200:203], v[192:195], a[124:127]
ds_read_b128 a[152:155], v3 offset:1024
v_cvt_pk_bf16_f32 v214, v148, v149
v_mfma_f32_16x16x32_bf16 a[124:127], a[204:207], v[196:199], a[124:127]
buffer_load_dwordx4 v[172:175], v15, s[44:47], s65 offen offset:0 sc1
ds_read_b128 a[156:159], v3 offset:9216
v_mfma_f32_16x16x32_bf16 a[92:95], a[204:207], v[188:191], a[92:95]
v_exp_f32 v151, v151
v_mfma_f32_16x16x32_bf16 a[92:95], a[200:203], v[184:187], a[92:95]
buffer_load_dwordx4 v[180:183], v15, s[44:47], s65 offen offset:1024 sc1
ds_read_b128 a[160:163], v3 offset:2048
ds_read_b128 a[164:167], v3 offset:10240
ds_read_b128 a[168:171], v3 offset:3072
ds_read_b128 a[172:175], v3 offset:11264
v_cvt_pk_bf16_f32 v215, v150, v151
v_rcp_f32 v22, v22
v_accvgpr_read_b32 v232, a64
v_accvgpr_read_b32 v233, a65
v_accvgpr_read_b32 v234, a66
v_accvgpr_read_b32 v235, a67
v_accvgpr_read_b32 v236, a68
v_accvgpr_read_b32 v237, a69
v_accvgpr_read_b32 v238, a70
v_accvgpr_read_b32 v239, a71
v_mul_f32 v22, v22, v8
v_mul_f32 v232, v232, v22
v_mul_f32 v233, v233, v22
v_mul_f32 v234, v234, v22
v_mul_f32 v235, v235, v22
v_mul_f32 v236, v236, v22
v_mul_f32 v237, v237, v22
v_mul_f32 v238, v238, v22
v_mul_f32 v239, v239, v22
v_cvt_pk_bf16_f32 v232, v232, v233
v_cvt_pk_bf16_f32 v233, v234, v235
v_cvt_pk_bf16_f32 v234, v236, v237
v_cvt_pk_bf16_f32 v235, v238, v239
s_add_u32 s77, s75, 0
buffer_store_dwordx4 v[232:235], v16, s[44:47], s77 offen sc1
L_TAIL:
ds_read_b128 a[176:179], v3 offset:4096
ds_read_b128 a[180:183], v3 offset:12288
ds_read_b128 a[184:187], v3 offset:5120
ds_read_b128 a[188:191], v3 offset:13312
v_mfma_f32_16x16x32_bf16 a[140:143], a[244:247], v[208:211], a[140:143]
ds_read_b128 a[192:195], v3 offset:6144
ds_read_b128 a[196:199], v3 offset:14336
v_mfma_f32_16x16x32_bf16 a[140:143], a[244:247], v[212:215], a[140:143]
s_waitcnt lgkmcnt(13)
s_add_u32 m0, s86, 32768
ds_read_b128 a[200:203], v3 offset:7168
ds_read_b128 a[204:207], v3 offset:15360
v_mfma_f32_16x16x32_bf16 a[96:99], a[144:147], v[208:211], a[96:99]
s_waitcnt lgkmcnt(14)
s_add_u32 s64, s85, 262144
v_accvgpr_read_b32 v240, a72
v_accvgpr_read_b32 v241, a73
v_mfma_f32_16x16x32_bf16 a[96:99], a[148:151], v[212:215], a[96:99]
s_waitcnt lgkmcnt(12)
buffer_load_dwordx4 v12, s[36:39], s64 offen lds
v_mfma_f32_16x16x32_bf16 a[100:103], a[156:159], v[212:215], a[100:103]
s_add_u32 m0, s86, 33792
s_add_u32 s64, s85, 270336
v_accvgpr_read_b32 v242, a74
v_accvgpr_read_b32 v243, a75
v_mfma_f32_16x16x32_bf16 a[100:103], a[152:155], v[208:211], a[100:103]
s_waitcnt lgkmcnt(11)
buffer_load_dwordx4 v13, s[36:39], s64 offen lds
v_mfma_f32_16x16x32_bf16 a[104:107], a[160:163], v[208:211], a[104:107]
s_waitcnt lgkmcnt(10)
s_add_u32 m0, s86, 34816
s_add_u32 s64, s85, 278528
v_accvgpr_read_b32 v244, a76
v_accvgpr_read_b32 v245, a77
v_mfma_f32_16x16x32_bf16 a[104:107], a[164:167], v[212:215], a[104:107]
s_waitcnt lgkmcnt(8)
buffer_load_dwordx4 v12, s[36:39], s64 offen lds
v_mfma_f32_16x16x32_bf16 a[108:111], a[172:175], v[212:215], a[108:111]
s_add_u32 m0, s86, 35840
s_add_u32 s64, s85, 286720
v_accvgpr_read_b32 v246, a78
v_accvgpr_read_b32 v247, a79
v_mfma_f32_16x16x32_bf16 a[108:111], a[168:171], v[208:211], a[108:111]
s_waitcnt lgkmcnt(7)
buffer_load_dwordx4 v13, s[36:39], s64 offen lds
v_mfma_f32_16x16x32_bf16 a[112:115], a[176:179], v[208:211], a[112:115]
s_waitcnt lgkmcnt(6)
s_add_u32 m0, s86, 36864
s_add_u32 s64, s85, 294912
v_mul_f32 v240, v240, v22
v_mul_f32 v241, v241, v22
v_mfma_f32_16x16x32_bf16 a[112:115], a[180:183], v[212:215], a[112:115]
s_waitcnt lgkmcnt(4)
buffer_load_dwordx4 v12, s[36:39], s64 offen lds
v_mfma_f32_16x16x32_bf16 a[116:119], a[188:191], v[212:215], a[116:119]
s_add_u32 m0, s86, 37888
s_add_u32 s64, s85, 303104
v_mul_f32 v242, v242, v22
v_mul_f32 v243, v243, v22
v_mfma_f32_16x16x32_bf16 a[116:119], a[184:187], v[208:211], a[116:119]
s_waitcnt lgkmcnt(3)
buffer_load_dwordx4 v13, s[36:39], s64 offen lds
v_mfma_f32_16x16x32_bf16 a[120:123], a[192:195], v[208:211], a[120:123]
s_waitcnt lgkmcnt(2)
s_add_u32 m0, s86, 38912
s_add_u32 s64, s85, 311296
v_mul_f32 v244, v244, v22
v_mul_f32 v245, v245, v22
v_mfma_f32_16x16x32_bf16 a[120:123], a[196:199], v[212:215], a[120:123]
s_waitcnt lgkmcnt(0)
buffer_load_dwordx4 v12, s[36:39], s64 offen lds
v_mfma_f32_16x16x32_bf16 a[124:127], a[204:207], v[212:215], a[124:127]
s_add_u32 m0, s86, 39936
s_add_u32 s64, s85, 319488
v_mul_f32 v246, v246, v22
v_mul_f32 v247, v247, v22
v_mfma_f32_16x16x32_bf16 a[124:127], a[200:203], v[208:211], a[124:127]
buffer_load_dwordx4 v13, s[36:39], s64 offen lds
v_cvt_pk_bf16_f32 v240, v240, v241
v_cvt_pk_bf16_f32 v241, v242, v243
v_cvt_pk_bf16_f32 v242, v244, v245
v_cvt_pk_bf16_f32 v243, v246, v247
s_add_u32 s77, s75, 8192
buffer_store_dwordx4 v[240:243], v16, s[44:47], s77 offen sc1
v_accvgpr_read_b32 v23, a140
v_max_f32 v1, v1, v23
v_rcp_f32 v23, v23
s_mov_b32 s66, 0x5d800000
v_cmp_le_f32 vcc, s66, v1
s_lshl_b32 s67, s30, 2
s_cmp_lg_u64 vcc, 0
s_cselect_b32 s66, 1, 0
v_mov_b32 v248, s67
v_mov_b32 v249, s66
ds_write_b32 v248, v249
v_accvgpr_read_b32 v232, a80
v_accvgpr_read_b32 v233, a81
v_accvgpr_read_b32 v234, a82
v_accvgpr_read_b32 v235, a83
v_accvgpr_read_b32 v236, a84
v_accvgpr_read_b32 v237, a85
v_accvgpr_read_b32 v238, a86
v_accvgpr_read_b32 v239, a87
v_pk_mul_f32 v[232:233], v[232:233], v[22:23] op_sel_hi:[1,0]
v_pk_mul_f32 v[234:235], v[234:235], v[22:23] op_sel_hi:[1,0]
v_pk_mul_f32 v[236:237], v[236:237], v[22:23] op_sel_hi:[1,0]
v_pk_mul_f32 v[238:239], v[238:239], v[22:23] op_sel_hi:[1,0]
v_cvt_pk_bf16_f32 v232, v232, v233
v_cvt_pk_bf16_f32 v233, v234, v235
v_cvt_pk_bf16_f32 v234, v236, v237
v_cvt_pk_bf16_f32 v235, v238, v239
s_add_u32 s77, s75, 16384
buffer_store_dwordx4 v[232:235], v16, s[44:47], s77 offen sc1
v_accvgpr_read_b32 v240, a88
v_accvgpr_read_b32 v241, a89
v_accvgpr_read_b32 v242, a90
v_accvgpr_read_b32 v243, a91
v_accvgpr_read_b32 v244, a92
v_accvgpr_read_b32 v245, a93
v_accvgpr_read_b32 v246, a94
v_accvgpr_read_b32 v247, a95
v_pk_mul_f32 v[240:241], v[240:241], v[22:23] op_sel_hi:[1,0]
v_pk_mul_f32 v[242:243], v[242:243], v[22:23] op_sel_hi:[1,0]
v_pk_mul_f32 v[244:245], v[244:245], v[22:23] op_sel_hi:[1,0]
v_pk_mul_f32 v[246:247], v[246:247], v[22:23] op_sel_hi:[1,0]
v_cvt_pk_bf16_f32 v240, v240, v241
v_cvt_pk_bf16_f32 v241, v242, v243
v_cvt_pk_bf16_f32 v242, v244, v245
v_cvt_pk_bf16_f32 v243, v246, v247
s_add_u32 s77, s75, 24576
buffer_store_dwordx4 v[240:243], v16, s[44:47], s77 offen sc1
v_accvgpr_read_b32 v232, a96
v_accvgpr_read_b32 v233, a97
v_accvgpr_read_b32 v234, a98
v_accvgpr_read_b32 v235, a99
v_accvgpr_read_b32 v236, a100
v_accvgpr_read_b32 v237, a101
v_accvgpr_read_b32 v238, a102
v_accvgpr_read_b32 v239, a103
v_mul_f32 v23, v23, v10
v_pk_mul_f32 v[232:233], v[232:233], v[22:23] op_sel:[0,1]
v_pk_mul_f32 v[234:235], v[234:235], v[22:23] op_sel:[0,1]
v_pk_mul_f32 v[236:237], v[236:237], v[22:23] op_sel:[0,1]
v_pk_mul_f32 v[238:239], v[238:239], v[22:23] op_sel:[0,1]
v_cvt_pk_bf16_f32 v232, v232, v233
v_cvt_pk_bf16_f32 v233, v234, v235
v_cvt_pk_bf16_f32 v234, v236, v237
v_cvt_pk_bf16_f32 v235, v238, v239
s_add_u32 s77, s75, 4096
buffer_store_dwordx4 v[232:235], v16, s[44:47], s77 offen sc1
v_accvgpr_read_b32 v240, a104
v_accvgpr_read_b32 v241, a105
v_accvgpr_read_b32 v242, a106
v_accvgpr_read_b32 v243, a107
v_accvgpr_read_b32 v244, a108
v_accvgpr_read_b32 v245, a109
v_accvgpr_read_b32 v246, a110
v_accvgpr_read_b32 v247, a111
v_pk_mul_f32 v[240:241], v[240:241], v[22:23] op_sel:[0,1]
v_pk_mul_f32 v[242:243], v[242:243], v[22:23] op_sel:[0,1]
v_pk_mul_f32 v[244:245], v[244:245], v[22:23] op_sel:[0,1]
v_pk_mul_f32 v[246:247], v[246:247], v[22:23] op_sel:[0,1]
v_cvt_pk_bf16_f32 v240, v240, v241
v_cvt_pk_bf16_f32 v241, v242, v243
v_cvt_pk_bf16_f32 v242, v244, v245
v_cvt_pk_bf16_f32 v243, v246, v247
s_add_u32 s77, s75, 12288
buffer_store_dwordx4 v[240:243], v16, s[44:47], s77 offen sc1
v_accvgpr_read_b32 v232, a112
v_accvgpr_read_b32 v233, a113
v_accvgpr_read_b32 v234, a114
v_accvgpr_read_b32 v235, a115
v_accvgpr_read_b32 v236, a116
v_accvgpr_read_b32 v237, a117
v_accvgpr_read_b32 v238, a118
v_accvgpr_read_b32 v239, a119
v_pk_mul_f32 v[232:233], v[232:233], v[22:23] op_sel:[0,1]
v_pk_mul_f32 v[234:235], v[234:235], v[22:23] op_sel:[0,1]
v_pk_mul_f32 v[236:237], v[236:237], v[22:23] op_sel:[0,1]
v_pk_mul_f32 v[238:239], v[238:239], v[22:23] op_sel:[0,1]
v_cvt_pk_bf16_f32 v232, v232, v233
v_cvt_pk_bf16_f32 v233, v234, v235
v_cvt_pk_bf16_f32 v234, v236, v237
v_cvt_pk_bf16_f32 v235, v238, v239
s_add_u32 s77, s75, 20480
buffer_store_dwordx4 v[232:235], v16, s[44:47], s77 offen sc1
v_accvgpr_read_b32 v240, a120
v_accvgpr_read_b32 v241, a121
v_accvgpr_read_b32 v242, a122
v_accvgpr_read_b32 v243, a123
v_accvgpr_read_b32 v244, a124
v_accvgpr_read_b32 v245, a125
v_accvgpr_read_b32 v246, a126
v_accvgpr_read_b32 v247, a127
v_pk_mul_f32 v[240:241], v[240:241], v[22:23] op_sel:[0,1]
v_pk_mul_f32 v[242:243], v[242:243], v[22:23] op_sel:[0,1]
v_pk_mul_f32 v[244:245], v[244:245], v[22:23] op_sel:[0,1]
v_pk_mul_f32 v[246:247], v[246:247], v[22:23] op_sel:[0,1]
v_cvt_pk_bf16_f32 v240, v240, v241
v_cvt_pk_bf16_f32 v241, v242, v243
v_cvt_pk_bf16_f32 v242, v244, v245
v_cvt_pk_bf16_f32 v243, v246, v247
s_add_u32 s77, s75, 28672
buffer_store_dwordx4 v[240:243], v16, s[44:47], s77 offen sc1
v_mov_b32 v248, 0
s_waitcnt lgkmcnt(0)
s_barrier
ds_read_b128 v[248:251], v248
v_xor_b32 v188, 128, v18
v_xor_b32 v189, 160, v18
v_xor_b32 v190, 192, v18
ds_read_b64_tr_b16 a[64:65], v188 offset:32768
ds_read_b64_tr_b16 a[66:67], v188 offset:36864
ds_read_b64_tr_b16 a[68:69], v188 offset:40960
ds_read_b64_tr_b16 a[70:71], v188 offset:45056
ds_read_b64_tr_b16 a[72:73], v189 offset:32768
ds_read_b64_tr_b16 a[74:75], v189 offset:36864
ds_read_b64_tr_b16 a[76:77], v189 offset:40960
ds_read_b64_tr_b16 a[78:79], v189 offset:45056
ds_read_b64_tr_b16 a[80:81], v190 offset:32768
ds_read_b64_tr_b16 a[82:83], v190 offset:36864
ds_read_b64_tr_b16 a[84:85], v190 offset:40960
ds_read_b64_tr_b16 a[86:87], v190 offset:45056
v_xor_b32 v191, 224, v18
v_xor_b32 v184, 0, v18
v_xor_b32 v185, 32, v18
v_xor_b32 v186, 64, v18
v_xor_b32 v187, 96, v18
s_waitcnt lgkmcnt(12)
v_or3_b32 v248, v248, v249, v250
v_or_b32 v248, v248, v251
s_nop 0
v_readfirstlane_b32 s66, v248
s_nop 0
s_cmp_gt_u32 s66, s73
s_cbranch_scc1 L_fallback_11
s_cmp_eq_u32 s83, 0
s_cbranch_scc1 L_p5f0
s_waitcnt lgkmcnt(10)
s_waitcnt vmcnt(28)
v_mfma_f32_16x16x32_bf16 v[136:139], a[64:67], a[232:235], 0
s_waitcnt vmcnt(24)
s_waitcnt lgkmcnt(8)
s_add_u32 m0, s86, 98304
ds_read_b64_tr_b16 a[88:89], v191 offset:32768
v_xor_b32 v192, 0x10000, v184
v_mfma_f32_16x16x32_bf16 v[136:139], a[68:71], a[236:239], v[136:139]
s_add_u32 s64, s85, 524288
ds_read_b64_tr_b16 a[90:91], v191 offset:36864
v_xor_b32 v193, 0x10000, v185
v_mfma_f32_16x16x32_bf16 v[104:107], a[68:71], a[228:231], 0
buffer_load_dwordx4 v12, s[36:39], s64 offen lds
v_mfma_f32_16x16x32_bf16 v[104:107], a[64:67], a[224:227], v[104:107]
s_add_u32 m0, s86, 99328
s_add_u32 s64, s85, 532480
ds_read_b64_tr_b16 a[92:93], v191 offset:40960
v_xor_b32 v194, 0x10000, v186
v_mfma_f32_16x16x32_bf16 v[72:75], a[64:67], a[216:219], 0
s_and_b32 s71, s31, 4
buffer_load_dwordx4 v13, s[36:39], s64 offen lds
v_mfma_f32_16x16x32_bf16 v[72:75], a[68:71], a[220:223], v[72:75]
s_lshl_b32 s71, s71, 5
s_add_u32 s71, s71, s79
s_add_u32 m0, s86, 100352
s_add_u32 s64, s85, 540672
ds_read_b64_tr_b16 a[94:95], v191 offset:45056
v_mfma_f32_16x16x32_bf16 v[40:43], a[68:71], a[212:215], 0
s_add_u32 s71, s71, 4096
buffer_load_dwordx4 v12, s[36:39], s64 offen lds
v_mfma_f32_16x16x32_bf16 v[40:43], a[64:67], a[208:211], v[40:43]
s_waitcnt lgkmcnt(4)
s_add_u32 s72, s80, 4096
s_add_u32 m0, s86, 101376
s_add_u32 s64, s85, 548864
ds_read_b64_tr_b16 a[96:97], v184 offset:32768
v_xor_b32 v195, 0x10000, v187
v_mfma_f32_16x16x32_bf16 v[44:47], a[72:75], a[208:211], 0
buffer_load_dwordx4 v13, s[36:39], s64 offen lds
v_mfma_f32_16x16x32_bf16 v[44:47], a[76:79], a[212:215], v[44:47]
s_add_u32 m0, s86, 102400
ds_read_b64_tr_b16 a[98:99], v184 offset:36864
v_xor_b32 v196, 0x10000, v188
v_mfma_f32_16x16x32_bf16 v[76:79], a[76:79], a[220:223], 0
s_add_u32 s64, s85, 557056
ds_read_b64_tr_b16 a[100:101], v184 offset:40960
v_xor_b32 v197, 0x10000, v189
v_mfma_f32_16x16x32_bf16 v[76:79], a[72:75], a[216:219], v[76:79]
buffer_load_dwordx4 v12, s[36:39], s64 offen lds
v_mfma_f32_16x16x32_bf16 v[108:111], a[72:75], a[224:227], 0
s_add_u32 m0, s86, 103424
s_add_u32 s64, s85, 565248
ds_read_b64_tr_b16 a[102:103], v184 offset:45056
v_xor_b32 v198, 0x10000, v190
v_mfma_f32_16x16x32_bf16 v[108:111], a[76:79], a[228:231], v[108:111]
buffer_load_dwordx4 v13, s[36:39], s64 offen lds
v_mfma_f32_16x16x32_bf16 v[140:143], a[76:79], a[236:239], 0
s_add_u32 m0, s86, 104448
s_add_u32 s64, s85, 573440
ds_read_b64_tr_b16 a[104:105], v185 offset:32768
v_xor_b32 v199, 0x10000, v191
v_mfma_f32_16x16x32_bf16 v[140:143], a[72:75], a[232:235], v[140:143]
buffer_load_dwordx4 v12, s[36:39], s64 offen lds
v_mfma_f32_16x16x32_bf16 v[144:147], a[80:83], a[232:235], 0
s_add_u32 m0, s86, 105472
ds_read_b64_tr_b16 a[106:107], v185 offset:36864
v_mfma_f32_16x16x32_bf16 v[144:147], a[84:87], a[236:239], v[144:147]
s_add_u32 s64, s85, 581632
ds_read_b64_tr_b16 a[108:109], v185 offset:40960
v_mfma_f32_16x16x32_bf16 v[112:115], a[84:87], a[228:231], 0
buffer_load_dwordx4 v13, s[36:39], s64 offen lds
v_mfma_f32_16x16x32_bf16 v[112:115], a[80:83], a[224:227], v[112:115]
s_add_u32 s65, s84, 65536
ds_read_b64_tr_b16 a[110:111], v185 offset:45056
v_mfma_f32_16x16x32_bf16 v[80:83], a[80:83], a[216:219], 0
buffer_load_dwordx4 a[32:35], v14, s[44:47], s65 offen offset:0 sc1
v_mfma_f32_16x16x32_bf16 v[80:83], a[84:87], a[220:223], v[80:83]
ds_read_b64_tr_b16 a[112:113], v186 offset:32768
v_mfma_f32_16x16x32_bf16 v[48:51], a[84:87], a[212:215], 0
buffer_load_dwordx4 a[40:43], v14, s[44:47], s65 offen offset:1024 sc1
v_mfma_f32_16x16x32_bf16 v[48:51], a[80:83], a[208:211], v[48:51]
s_waitcnt lgkmcnt(4)
ds_read_b64_tr_b16 a[114:115], v186 offset:36864
v_mfma_f32_16x16x32_bf16 v[52:55], a[88:91], a[208:211], 0
ds_read_b64_tr_b16 a[116:117], v186 offset:40960
v_mfma_f32_16x16x32_bf16 v[52:55], a[92:95], a[212:215], v[52:55]
buffer_load_dwordx4 a[48:51], v15, s[44:47], s65 offen offset:0 sc1
v_mfma_f32_16x16x32_bf16 v[84:87], a[92:95], a[220:223], 0
ds_read_b64_tr_b16 a[118:119], v186 offset:45056
v_mfma_f32_16x16x32_bf16 v[84:87], a[88:91], a[216:219], v[84:87]
buffer_load_dwordx4 a[56:59], v15, s[44:47], s65 offen offset:1024 sc1
v_mfma_f32_16x16x32_bf16 v[116:119], a[88:91], a[224:227], 0
s_add_u32 s65, s84, 73728
ds_read_b64_tr_b16 a[120:121], v187 offset:32768
v_mfma_f32_16x16x32_bf16 v[116:119], a[92:95], a[228:231], v[116:119]
buffer_load_dwordx4 a[36:39], v14, s[44:47], s65 offen offset:0 sc1
v_mfma_f32_16x16x32_bf16 v[148:151], a[92:95], a[236:239], 0
ds_read_b64_tr_b16 a[122:123], v187 offset:36864
v_mfma_f32_16x16x32_bf16 v[148:151], a[88:91], a[232:235], v[148:151]
ds_read_b64_tr_b16 a[124:125], v187 offset:40960
v_mfma_f32_16x16x32_bf16 v[120:123], a[96:99], a[232:235], 0
buffer_load_dwordx4 a[44:47], v14, s[44:47], s65 offen offset:1024 sc1
v_mfma_f32_16x16x32_bf16 v[120:123], a[100:103], a[236:239], v[120:123]
ds_read_b64_tr_b16 a[126:127], v187 offset:45056
v_mfma_f32_16x16x32_bf16 v[88:91], a[100:103], a[228:231], 0
buffer_load_dwordx4 a[52:55], v15, s[44:47], s65 offen offset:0 sc1
v_mfma_f32_16x16x32_bf16 v[88:91], a[96:99], a[224:227], v[88:91]
v_mfma_f32_16x16x32_bf16 v[56:59], a[96:99], a[216:219], 0
buffer_load_dwordx4 a[60:63], v15, s[44:47], s65 offen offset:1024 sc1
v_mfma_f32_16x16x32_bf16 v[56:59], a[100:103], a[220:223], v[56:59]
v_mfma_f32_16x16x32_bf16 v[24:27], a[100:103], a[212:215], 0
v_mfma_f32_16x16x32_bf16 v[24:27], a[96:99], a[208:211], v[24:27]
s_waitcnt lgkmcnt(1)
buffer_load_dword v19, off, s[52:55], s72 sc1
v_mfma_f32_16x16x32_bf16 v[28:31], a[104:107], a[208:211], 0
s_add_u32 s85, s85, 2883584
s_waitcnt vmcnt(24) lgkmcnt(0)
s_barrier
v_mfma_f32_16x16x32_bf16 v[28:31], a[108:111], a[212:215], v[28:31]
ds_read_b64_tr_b16 a[64:65], v196 offset:0
v_mfma_f32_16x16x32_bf16 v[60:63], a[108:111], a[220:223], 0
ds_read_b64_tr_b16 a[66:67], v196 offset:4096
v_mfma_f32_16x16x32_bf16 v[60:63], a[104:107], a[216:219], v[60:63]
s_add_u32 m0, s86, 131072
ds_read_b64_tr_b16 a[68:69], v196 offset:8192
v_mfma_f32_16x16x32_bf16 v[92:95], a[104:107], a[224:227], 0
s_add_u32 s64, s85, 0
ds_read_b64_tr_b16 a[70:71], v196 offset:12288
v_mfma_f32_16x16x32_bf16 v[92:95], a[108:111], a[228:231], v[92:95]
buffer_load_dwordx4 v12, s[40:43], s64 offen lds
v_mfma_f32_16x16x32_bf16 v[124:127], a[108:111], a[236:239], 0
s_add_u32 m0, s86, 132096
ds_read_b64_tr_b16 a[72:73], v197 offset:0
v_mfma_f32_16x16x32_bf16 v[124:127], a[104:107], a[232:235], v[124:127]
s_add_u32 s64, s85, 8192
ds_read_b64_tr_b16 a[74:75], v197 offset:4096
v_mfma_f32_16x16x32_bf16 v[128:131], a[112:115], a[232:235], 0
buffer_load_dwordx4 v13, s[40:43], s64 offen lds
v_mfma_f32_16x16x32_bf16 v[128:131], a[116:119], a[236:239], v[128:131]
ds_read_b64_tr_b16 a[76:77], v197 offset:8192
v_mfma_f32_16x16x32_bf16 v[96:99], a[116:119], a[228:231], 0
s_add_u32 m0, s86, 133120
ds_read_b64_tr_b16 a[78:79], v197 offset:12288
v_mfma_f32_16x16x32_bf16 v[96:99], a[112:115], a[224:227], v[96:99]
s_add_u32 s64, s85, 16384
ds_read_b64_tr_b16 a[80:81], v198 offset:0
v_mfma_f32_16x16x32_bf16 v[64:67], a[112:115], a[216:219], 0
buffer_load_dwordx4 v12, s[40:43], s64 offen lds
v_mfma_f32_16x16x32_bf16 v[64:67], a[116:119], a[220:223], v[64:67]
ds_read_b64_tr_b16 a[82:83], v198 offset:4096
v_mfma_f32_16x16x32_bf16 v[32:35], a[116:119], a[212:215], 0
s_add_u32 m0, s86, 134144
ds_read_b64_tr_b16 a[84:85], v198 offset:8192
v_mfma_f32_16x16x32_bf16 v[32:35], a[112:115], a[208:211], v[32:35]
s_add_u32 s64, s85, 24576
ds_read_b64_tr_b16 a[86:87], v198 offset:12288
v_mfma_f32_16x16x32_bf16 v[36:39], a[120:123], a[208:211], 0
buffer_load_dwordx4 v13, s[40:43], s64 offen lds
v_mfma_f32_16x16x32_bf16 v[36:39], a[124:127], a[212:215], v[36:39]
v_mfma_f32_16x16x32_bf16 v[68:71], a[124:127], a[220:223], 0
s_add_u32 m0, s86, 135168
v_mfma_f32_16x16x32_bf16 v[68:71], a[120:123], a[216:219], v[68:71]
s_add_u32 s64, s85, 32768
v_mfma_f32_16x16x32_bf16 v[100:103], a[120:123], a[224:227], 0
buffer_load_dwordx4 v12, s[40:43], s64 offen lds
v_mfma_f32_16x16x32_bf16 v[100:103], a[124:127], a[228:231], v[100:103]
v_mfma_f32_16x16x32_bf16 v[132:135], a[124:127], a[236:239], 0
v_mfma_f32_16x16x32_bf16 v[132:135], a[120:123], a[232:235], v[132:135]
s_waitcnt lgkmcnt(0)
v_mfma_f32_16x16x32_bf16 v[136:139], a[64:67], v[176:179], v[136:139]
s_waitcnt vmcnt(5)
v_readfirstlane_b32 vcc_lo, v19
s_nop 0
s_cmp_lt_u32 vcc_lo, 8
s_cbranch_scc1 L_spin_2016
L_spinbk_2017:
s_sub_u32 s84, s84, 688128
v_mfma_f32_16x16x32_bf16 v[136:139], a[68:71], v[180:183], v[136:139]
s_add_u32 m0, s86, 136192
s_add_u32 s64, s85, 40960
ds_read_b64_tr_b16 a[88:89], v199 offset:0
v_mfma_f32_16x16x32_bf16 v[104:107], a[68:71], v[172:175], v[104:107]
buffer_load_dwordx4 v13, s[40:43], s64 offen lds
v_mfma_f32_16x16x32_bf16 v[104:107], a[64:67], v[168:171], v[104:107]
s_add_u32 m0, s86, 137216
ds_read_b64_tr_b16 a[90:91], v199 offset:4096
v_mfma_f32_16x16x32_bf16 v[72:75], a[64:67], v[160:163], v[72:75]
s_add_u32 s64, s85, 49152
ds_read_b64_tr_b16 a[92:93], v199 offset:8192
v_mfma_f32_16x16x32_bf16 v[72:75], a[68:71], v[164:167], v[72:75]
buffer_load_dwordx4 v12, s[40:43], s64 offen lds
v_mfma_f32_16x16x32_bf16 v[40:43], a[68:71], v[156:159], v[40:43]
s_add_u32 m0, s86, 138240
ds_read_b64_tr_b16 a[94:95], v199 offset:12288
v_mfma_f32_16x16x32_bf16 v[40:43], a[64:67], v[152:155], v[40:43]
s_add_u32 s64, s85, 57344
ds_read_b64_tr_b16 a[96:97], v192 offset:0
v_mfma_f32_16x16x32_bf16 v[44:47], a[72:75], v[152:155], v[44:47]
buffer_load_dwordx4 v13, s[40:43], s64 offen lds
v_mfma_f32_16x16x32_bf16 v[44:47], a[76:79], v[156:159], v[44:47]
ds_read_b64_tr_b16 a[98:99], v192 offset:4096
v_mfma_f32_16x16x32_bf16 v[76:79], a[76:79], v[164:167], v[76:79]
ds_read_b64_tr_b16 a[100:101], v192 offset:8192
v_mfma_f32_16x16x32_bf16 v[76:79], a[72:75], v[160:163], v[76:79]
s_add_u32 s65, s84, 0
ds_read_b64_tr_b16 a[102:103], v192 offset:12288
v_mfma_f32_16x16x32_bf16 v[108:111], a[72:75], v[168:171], v[108:111]
buffer_load_dwordx4 a[208:211], v14, s[44:47], s65 offen offset:0 sc1
v_mfma_f32_16x16x32_bf16 v[108:111], a[76:79], v[172:175], v[108:111]
ds_read_b64_tr_b16 a[104:105], v193 offset:0
v_mfma_f32_16x16x32_bf16 v[140:143], a[76:79], v[180:183], v[140:143]
ds_read_b64_tr_b16 a[106:107], v193 offset:4096
v_mfma_f32_16x16x32_bf16 v[140:143], a[72:75], v[176:179], v[140:143]
buffer_load_dwordx4 a[216:219], v14, s[44:47], s65 offen offset:1024 sc1
v_mfma_f32_16x16x32_bf16 v[144:147], a[80:83], v[176:179], v[144:147]
ds_read_b64_tr_b16 a[108:109], v193 offset:8192
v_mfma_f32_16x16x32_bf16 v[144:147], a[84:87], v[180:183], v[144:147]
ds_read_b64_tr_b16 a[110:111], v193 offset:12288
v_mfma_f32_16x16x32_bf16 v[112:115], a[84:87], v[172:175], v[112:115]
s_add_u32 s17, s78, L_p5loop-L_pc+0
buffer_load_dwordx4 a[224:227], v15, s[44:47], s65 offen offset:0 sc1
v_mfma_f32_16x16x32_bf16 v[112:115], a[80:83], v[168:171], v[112:115]
buffer_load_dword a252, v16, s[88:91], s17 offen
v_mfma_f32_16x16x32_bf16 v[80:83], a[80:83], v[160:163], v[80:83]
ds_read_b64_tr_b16 a[112:113], v194 offset:0
v_mfma_f32_16x16x32_bf16 v[80:83], a[84:87], v[164:167], v[80:83]
ds_read_b64_tr_b16 a[114:115], v194 offset:4096
v_mfma_f32_16x16x32_bf16 v[48:51], a[84:87], v[156:159], v[48:51]
buffer_load_dwordx4 a[232:235], v15, s[44:47], s65 offen offset:1024 sc1
v_mfma_f32_16x16x32_bf16 v[48:51], a[80:83], v[152:155], v[48:51]
s_waitcnt lgkmcnt(4)
ds_read_b64_tr_b16 a[116:117], v194 offset:8192
v_mfma_f32_16x16x32_bf16 v[52:55], a[88:91], v[152:155], v[52:55]
s_add_u32 s65, s84, 8192
ds_read_b64_tr_b16 a[118:119], v194 offset:12288
v_mfma_f32_16x16x32_bf16 v[52:55], a[92:95], v[156:159], v[52:55]
s_add_u32 s17, s78, L_p5loop-L_pc+4096
buffer_load_dwordx4 a[212:215], v14, s[44:47], s65 offen offset:0 sc1
v_mfma_f32_16x16x32_bf16 v[84:87], a[92:95], v[164:167], v[84:87]
buffer_load_dword a252, v16, s[88:91], s17 offen
v_mfma_f32_16x16x32_bf16 v[84:87], a[88:91], v[160:163], v[84:87]
ds_read_b64_tr_b16 a[120:121], v195 offset:0
v_mfma_f32_16x16x32_bf16 v[116:119], a[88:91], v[168:171], v[116:119]
s_lshl_b32 s66, s30, 30
buffer_load_dwordx4 a[220:223], v14, s[44:47], s65 offen offset:1024 sc1
v_mfma_f32_16x16x32_bf16 v[116:119], a[92:95], v[172:175], v[116:119]
ds_read_b64_tr_b16 a[122:123], v195 offset:4096
v_lshl_add_u32 v1, v0, 24, s66
v_mfma_f32_16x16x32_bf16 v[148:151], a[92:95], v[180:183], v[148:151]
ds_read_b64_tr_b16 a[124:125], v195 offset:8192
v_mfma_f32_16x16x32_bf16 v[148:151], a[88:91], v[176:179], v[148:151]
ds_read_b64_tr_b16 a[126:127], v195 offset:12288
v_mfma_f32_16x16x32_bf16 v[120:123], a[96:99], v[176:179], v[120:123]
s_add_u32 s17, s78, L_p5loop-L_pc+8192
buffer_load_dwordx4 a[228:231], v15, s[44:47], s65 offen offset:0 sc1
v_mfma_f32_16x16x32_bf16 v[120:123], a[100:103], v[180:183], v[120:123]
buffer_load_dword a252, v16, s[88:91], s17 offen
v_mfma_f32_16x16x32_bf16 v[88:91], a[100:103], v[172:175], v[88:91]
v_mfma_f32_16x16x32_bf16 v[88:91], a[96:99], v[168:171], v[88:91]
buffer_load_dwordx4 a[236:239], v15, s[44:47], s65 offen offset:1024 sc1
v_mfma_f32_16x16x32_bf16 v[56:59], a[96:99], v[160:163], v[56:59]
v_mfma_f32_16x16x32_bf16 v[56:59], a[100:103], v[164:167], v[56:59]
v_mfma_f32_16x16x32_bf16 v[24:27], a[100:103], v[156:159], v[24:27]
v_mfma_f32_16x16x32_bf16 v[24:27], a[96:99], v[152:155], v[24:27]
v_mfma_f32_16x16x32_bf16 v[28:31], a[104:107], v[152:155], v[28:31]
s_waitcnt lgkmcnt(0)
s_barrier
v_mfma_f32_16x16x32_bf16 v[28:31], a[108:111], v[156:159], v[28:31]
s_mov_b64 exec, 1
buffer_atomic_add a251, v1, s[52:55], s71 offen offset:0 sc1
s_mov_b64 exec, -1
v_mfma_f32_16x16x32_bf16 v[60:63], a[108:111], v[164:167], v[60:63]
ds_read_b64_tr_b16 a[64:65], v188 offset:0
v_mfma_f32_16x16x32_bf16 v[60:63], a[104:107], v[160:163], v[60:63]
s_add_u32 m0, s86, 32768
ds_read_b64_tr_b16 a[66:67], v188 offset:4096
v_mfma_f32_16x16x32_bf16 v[92:95], a[104:107], v[168:171], v[92:95]
s_add_u32 s64, s85, 262144
ds_read_b64_tr_b16 a[68:69], v188 offset:8192
v_mfma_f32_16x16x32_bf16 v[92:95], a[108:111], v[172:175], v[92:95]
buffer_load_dwordx4 v12, s[40:43], s64 offen lds
v_mfma_f32_16x16x32_bf16 v[124:127], a[108:111], v[180:183], v[124:127]
s_add_u32 m0, s86, 33792
ds_read_b64_tr_b16 a[70:71], v188 offset:12288
v_mfma_f32_16x16x32_bf16 v[124:127], a[104:107], v[176:179], v[124:127]
s_add_u32 s64, s85, 270336
ds_read_b64_tr_b16 a[72:73], v189 offset:0
v_mfma_f32_16x16x32_bf16 v[128:131], a[112:115], v[176:179], v[128:131]
buffer_load_dwordx4 v13, s[40:43], s64 offen lds
v_mfma_f32_16x16x32_bf16 v[128:131], a[116:119], v[180:183], v[128:131]
ds_read_b64_tr_b16 a[74:75], v189 offset:4096
v_mfma_f32_16x16x32_bf16 v[96:99], a[116:119], v[172:175], v[96:99]
s_add_u32 m0, s86, 34816
ds_read_b64_tr_b16 a[76:77], v189 offset:8192
v_mfma_f32_16x16x32_bf16 v[96:99], a[112:115], v[168:171], v[96:99]
s_add_u32 s64, s85, 278528
ds_read_b64_tr_b16 a[78:79], v189 offset:12288
v_mfma_f32_16x16x32_bf16 v[64:67], a[112:115], v[160:163], v[64:67]
buffer_load_dwordx4 v12, s[40:43], s64 offen lds
v_mfma_f32_16x16x32_bf16 v[64:67], a[116:119], v[164:167], v[64:67]
ds_read_b64_tr_b16 a[80:81], v190 offset:0
v_mfma_f32_16x16x32_bf16 v[32:35], a[116:119], v[156:159], v[32:35]
s_add_u32 m0, s86, 35840
ds_read_b64_tr_b16 a[82:83], v190 offset:4096
v_mfma_f32_16x16x32_bf16 v[32:35], a[112:115], v[152:155], v[32:35]
s_add_u32 s64, s85, 286720
ds_read_b64_tr_b16 a[84:85], v190 offset:8192
v_mfma_f32_16x16x32_bf16 v[36:39], a[120:123], v[152:155], v[36:39]
buffer_load_dwordx4 v13, s[40:43], s64 offen lds
v_mfma_f32_16x16x32_bf16 v[36:39], a[124:127], v[156:159], v[36:39]
ds_read_b64_tr_b16 a[86:87], v190 offset:12288
v_mfma_f32_16x16x32_bf16 v[68:71], a[124:127], v[164:167], v[68:71]
s_add_u32 m0, s86, 36864
v_mfma_f32_16x16x32_bf16 v[68:71], a[120:123], v[160:163], v[68:71]
s_add_u32 s64, s85, 294912
v_mfma_f32_16x16x32_bf16 v[100:103], a[120:123], v[168:171], v[100:103]
buffer_load_dwordx4 v12, s[40:43], s64 offen lds
v_mfma_f32_16x16x32_bf16 v[100:103], a[124:127], v[172:175], v[100:103]
v_mfma_f32_16x16x32_bf16 v[132:135], a[124:127], v[180:183], v[132:135]
v_mfma_f32_16x16x32_bf16 v[132:135], a[120:123], v[176:179], v[132:135]
s_waitcnt lgkmcnt(1)
v_mfma_f32_16x16x32_bf16 v[136:139], a[64:67], a[56:59], v[136:139]
s_add_u32 m0, s86, 37888
ds_read_b64_tr_b16 a[88:89], v191 offset:0
v_mfma_f32_16x16x32_bf16 v[136:139], a[68:71], a[60:63], v[136:139]
s_add_u32 s64, s85, 303104
ds_read_b64_tr_b16 a[90:91], v191 offset:4096
v_mfma_f32_16x16x32_bf16 v[104:107], a[68:71], a[52:55], v[104:107]
buffer_load_dwordx4 v13, s[40:43], s64 offen lds
v_mfma_f32_16x16x32_bf16 v[104:107], a[64:67], a[48:51], v[104:107]
s_add_u32 m0, s86, 38912
ds_read_b64_tr_b16 a[92:93], v191 offset:8192
v_mfma_f32_16x16x32_bf16 v[72:75], a[64:67], a[40:43], v[72:75]
s_add_u32 s64, s85, 311296
ds_read_b64_tr_b16 a[94:95], v191 offset:12288
v_mfma_f32_16x16x32_bf16 v[72:75], a[68:71], a[44:47], v[72:75]
buffer_load_dwordx4 v12, s[40:43], s64 offen lds
v_mfma_f32_16x16x32_bf16 v[40:43], a[68:71], a[36:39], v[40:43]
s_add_u32 m0, s86, 39936
ds_read_b64_tr_b16 a[96:97], v184 offset:0
v_mfma_f32_16x16x32_bf16 v[40:43], a[64:67], a[32:35], v[40:43]
s_add_u32 s64, s85, 319488
ds_read_b64_tr_b16 a[98:99], v184 offset:4096
v_mfma_f32_16x16x32_bf16 v[44:47], a[72:75], a[32:35], v[44:47]
buffer_load_dwordx4 v13, s[40:43], s64 offen lds
v_mfma_f32_16x16x32_bf16 v[44:47], a[76:79], a[36:39], v[44:47]
ds_read_b64_tr_b16 a[100:101], v184 offset:8192
v_mfma_f32_16x16x32_bf16 v[76:79], a[76:79], a[44:47], v[76:79]
ds_read_b64_tr_b16 a[102:103], v184 offset:12288
v_mfma_f32_16x16x32_bf16 v[76:79], a[72:75], a[40:43], v[76:79]
s_add_u32 s65, s84, 32768
ds_read_b64_tr_b16 a[104:105], v185 offset:0
v_mfma_f32_16x16x32_bf16 v[108:111], a[72:75], a[48:51], v[108:111]
buffer_load_dwordx4 v[152:155], v14, s[44:47], s65 offen offset:0 sc1
v_mfma_f32_16x16x32_bf16 v[108:111], a[76:79], a[52:55], v[108:111]
ds_read_b64_tr_b16 a[106:107], v185 offset:4096
v_mfma_f32_16x16x32_bf16 v[140:143], a[76:79], a[60:63], v[140:143]
ds_read_b64_tr_b16 a[108:109], v185 offset:8192
v_mfma_f32_16x16x32_bf16 v[140:143], a[72:75], a[56:59], v[140:143]
buffer_load_dwordx4 v[160:163], v14, s[44:47], s65 offen offset:1024 sc1
v_mfma_f32_16x16x32_bf16 v[144:147], a[80:83], a[56:59], v[144:147]
s_waitcnt lgkmcnt(5)
ds_read_b64_tr_b16 a[110:111], v185 offset:12288
v_mfma_f32_16x16x32_bf16 v[144:147], a[84:87], a[60:63], v[144:147]
v_mfma_f32_16x16x32_bf16 v[112:115], a[84:87], a[52:55], v[112:115]
buffer_load_dwordx4 v[168:171], v15, s[44:47], s65 offen offset:0 sc1
v_mfma_f32_16x16x32_bf16 v[112:115], a[80:83], a[48:51], v[112:115]
ds_read_b64_tr_b16 a[112:113], v186 offset:0
v_mfma_f32_16x16x32_bf16 v[80:83], a[80:83], a[40:43], v[80:83]
ds_read_b64_tr_b16 a[114:115], v186 offset:4096
v_mfma_f32_16x16x32_bf16 v[80:83], a[84:87], a[44:47], v[80:83]
ds_read_b64_tr_b16 a[116:117], v186 offset:8192
v_mfma_f32_16x16x32_bf16 v[48:51], a[84:87], a[36:39], v[48:51]
buffer_load_dwordx4 v[176:179], v15, s[44:47], s65 offen offset:1024 sc1
v_mfma_f32_16x16x32_bf16 v[48:51], a[80:83], a[32:35], v[48:51]
ds_read_b64_tr_b16 a[118:119], v186 offset:12288
v_mfma_f32_16x16x32_bf16 v[52:55], a[88:91], a[32:35], v[52:55]
s_add_u32 s65, s84, 40960
v_mfma_f32_16x16x32_bf16 v[52:55], a[92:95], a[36:39], v[52:55]
buffer_load_dwordx4 v[156:159], v14, s[44:47], s65 offen offset:0 sc1
v_mfma_f32_16x16x32_bf16 v[84:87], a[92:95], a[44:47], v[84:87]
ds_read_b64_tr_b16 a[120:121], v187 offset:0
v_mfma_f32_16x16x32_bf16 v[84:87], a[88:91], a[40:43], v[84:87]
ds_read_b64_tr_b16 a[122:123], v187 offset:4096
v_mfma_f32_16x16x32_bf16 v[116:119], a[88:91], a[48:51], v[116:119]
buffer_load_dwordx4 v[164:167], v14, s[44:47], s65 offen offset:1024 sc1
v_mfma_f32_16x16x32_bf16 v[116:119], a[92:95], a[52:55], v[116:119]
ds_read_b64_tr_b16 a[124:125], v187 offset:8192
v_mfma_f32_16x16x32_bf16 v[148:151], a[92:95], a[60:63], v[148:151]
ds_read_b64_tr_b16 a[126:127], v187 offset:12288
v_mfma_f32_16x16x32_bf16 v[148:151], a[88:91], a[56:59], v[148:151]
v_mfma_f32_16x16x32_bf16 v[120:123], a[96:99], a[56:59], v[120:123]
s_waitcnt lgkmcnt(4)
buffer_load_dwordx4 v[172:175], v15, s[44:47], s65 offen offset:0 sc1
v_mfma_f32_16x16x32_bf16 v[120:123], a[100:103], a[60:63], v[120:123]
v_mfma_f32_16x16x32_bf16 v[88:91], a[100:103], a[52:55], v[88:91]
v_mfma_f32_16x16x32_bf16 v[88:91], a[96:99], a[48:51], v[88:91]
buffer_load_dwordx4 v[180:183], v15, s[44:47], s65 offen offset:1024 sc1
v_mfma_f32_16x16x32_bf16 v[56:59], a[96:99], a[40:43], v[56:59]
v_mfma_f32_16x16x32_bf16 v[56:59], a[100:103], a[44:47], v[56:59]
v_mfma_f32_16x16x32_bf16 v[24:27], a[100:103], a[36:39], v[24:27]
v_mfma_f32_16x16x32_bf16 v[24:27], a[96:99], a[32:35], v[24:27]
v_mfma_f32_16x16x32_bf16 v[28:31], a[104:107], a[32:35], v[28:31]
s_waitcnt vmcnt(28)
s_barrier
v_mfma_f32_16x16x32_bf16 v[28:31], a[108:111], a[36:39], v[28:31]
ds_read_b64_tr_b16 a[64:65], v188 offset:32768
v_mfma_f32_16x16x32_bf16 v[60:63], a[108:111], a[44:47], v[60:63]
ds_read_b64_tr_b16 a[66:67], v188 offset:36864
v_mfma_f32_16x16x32_bf16 v[60:63], a[104:107], a[40:43], v[60:63]
s_add_u32 m0, s86, 65536
ds_read_b64_tr_b16 a[68:69], v188 offset:40960
v_mfma_f32_16x16x32_bf16 v[92:95], a[104:107], a[48:51], v[92:95]
s_add_u32 s64, s85, 524288
ds_read_b64_tr_b16 a[70:71], v188 offset:45056
v_mfma_f32_16x16x32_bf16 v[92:95], a[108:111], a[52:55], v[92:95]
buffer_load_dwordx4 v12, s[40:43], s64 offen lds
v_mfma_f32_16x16x32_bf16 v[124:127], a[108:111], a[60:63], v[124:127]
s_add_u32 m0, s86, 66560
ds_read_b64_tr_b16 a[72:73], v189 offset:32768
v_mfma_f32_16x16x32_bf16 v[124:127], a[104:107], a[56:59], v[124:127]
s_add_u32 s64, s85, 532480
ds_read_b64_tr_b16 a[74:75], v189 offset:36864
v_mfma_f32_16x16x32_bf16 v[128:131], a[112:115], a[56:59], v[128:131]
buffer_load_dwordx4 v13, s[40:43], s64 offen lds
v_mfma_f32_16x16x32_bf16 v[128:131], a[116:119], a[60:63], v[128:131]
ds_read_b64_tr_b16 a[76:77], v189 offset:40960
v_mfma_f32_16x16x32_bf16 v[96:99], a[116:119], a[52:55], v[96:99]
s_add_u32 m0, s86, 67584
ds_read_b64_tr_b16 a[78:79], v189 offset:45056
v_mfma_f32_16x16x32_bf16 v[96:99], a[112:115], a[48:51], v[96:99]
s_add_u32 s64, s85, 540672
ds_read_b64_tr_b16 a[80:81], v190 offset:32768
v_mfma_f32_16x16x32_bf16 v[64:67], a[112:115], a[40:43], v[64:67]
buffer_load_dwordx4 v12, s[40:43], s64 offen lds
v_mfma_f32_16x16x32_bf16 v[64:67], a[116:119], a[44:47], v[64:67]
ds_read_b64_tr_b16 a[82:83], v190 offset:36864
v_mfma_f32_16x16x32_bf16 v[32:35], a[116:119], a[36:39], v[32:35]
s_add_u32 m0, s86, 68608
ds_read_b64_tr_b16 a[84:85], v190 offset:40960
v_mfma_f32_16x16x32_bf16 v[32:35], a[112:115], a[32:35], v[32:35]
s_waitcnt lgkmcnt(5)
s_add_u32 s64, s85, 548864
ds_read_b64_tr_b16 a[86:87], v190 offset:45056
v_mfma_f32_16x16x32_bf16 v[36:39], a[120:123], a[32:35], v[36:39]
buffer_load_dwordx4 v13, s[40:43], s64 offen lds
v_mfma_f32_16x16x32_bf16 v[36:39], a[124:127], a[36:39], v[36:39]
v_mfma_f32_16x16x32_bf16 v[68:71], a[124:127], a[44:47], v[68:71]
s_add_u32 m0, s86, 69632
v_mfma_f32_16x16x32_bf16 v[68:71], a[120:123], a[40:43], v[68:71]
s_add_u32 s64, s85, 557056
v_mfma_f32_16x16x32_bf16 v[100:103], a[120:123], a[48:51], v[100:103]
buffer_load_dwordx4 v12, s[40:43], s64 offen lds
v_mfma_f32_16x16x32_bf16 v[100:103], a[124:127], a[52:55], v[100:103]
s_mov_b32 s70, 3
s_mov_b32 s73, 2
v_mfma_f32_16x16x32_bf16 v[132:135], a[124:127], a[60:63], v[132:135]
v_mfma_f32_16x16x32_bf16 v[132:135], a[120:123], a[56:59], v[132:135]
L_p5join:
.p2align 3
L_p5loop:
s_waitcnt lgkmcnt(10)
s_waitcnt vmcnt(19)
v_mfma_f32_16x16x32_bf16 v[136:139], a[64:67], a[232:235], v[136:139]
s_waitcnt vmcnt(15)
s_waitcnt lgkmcnt(8)
s_add_u32 m0, s86, 70656
s_add_u32 s64, s85, 565248
ds_read_b64_tr_b16 a[88:89], v191 offset:32768
v_mfma_f32_16x16x32_bf16 v[136:139], a[68:71], a[236:239], v[136:139]
buffer_load_dwordx4 v13, s[40:43], s64 offen lds
v_mfma_f32_16x16x32_bf16 v[104:107], a[68:71], a[228:231], v[104:107]
s_add_u32 m0, s86, 71680
ds_read_b64_tr_b16 a[90:91], v191 offset:36864
v_mfma_f32_16x16x32_bf16 v[104:107], a[64:67], a[224:227], v[104:107]
s_add_u32 s64, s85, 573440
ds_read_b64_tr_b16 a[92:93], v191 offset:40960
v_mfma_f32_16x16x32_bf16 v[72:75], a[64:67], a[216:219], v[72:75]
buffer_load_dwordx4 v12, s[40:43], s64 offen lds
v_mfma_f32_16x16x32_bf16 v[72:75], a[68:71], a[220:223], v[72:75]
s_add_u32 m0, s86, 72704
ds_read_b64_tr_b16 a[94:95], v191 offset:45056
v_mfma_f32_16x16x32_bf16 v[40:43], a[68:71], a[212:215], v[40:43]
s_add_u32 s64, s85, 581632
ds_read_b64_tr_b16 a[96:97], v184 offset:32768
v_mfma_f32_16x16x32_bf16 v[40:43], a[64:67], a[208:211], v[40:43]
s_waitcnt lgkmcnt(5)
buffer_load_dwordx4 v13, s[40:43], s64 offen lds
v_mfma_f32_16x16x32_bf16 v[44:47], a[72:75], a[208:211], v[44:47]
ds_read_b64_tr_b16 a[98:99], v184 offset:36864
v_mfma_f32_16x16x32_bf16 v[44:47], a[76:79], a[212:215], v[44:47]
ds_read_b64_tr_b16 a[100:101], v184 offset:40960
v_mfma_f32_16x16x32_bf16 v[76:79], a[76:79], a[220:223], v[76:79]
s_add_u32 s65, s84, 65536
ds_read_b64_tr_b16 a[102:103], v184 offset:45056
v_mfma_f32_16x16x32_bf16 v[76:79], a[72:75], a[216:219], v[76:79]
buffer_load_dwordx4 a[0:3], v14, s[44:47], s65 offen offset:0 sc1
v_mfma_f32_16x16x32_bf16 v[108:111], a[72:75], a[224:227], v[108:111]
ds_read_b64_tr_b16 a[104:105], v185 offset:32768
v_mfma_f32_16x16x32_bf16 v[108:111], a[76:79], a[228:231], v[108:111]
ds_read_b64_tr_b16 a[106:107], v185 offset:36864
v_mfma_f32_16x16x32_bf16 v[140:143], a[76:79], a[236:239], v[140:143]
buffer_load_dwordx4 a[8:11], v14, s[44:47], s65 offen offset:1024 sc1
v_mfma_f32_16x16x32_bf16 v[140:143], a[72:75], a[232:235], v[140:143]
ds_read_b64_tr_b16 a[108:109], v185 offset:40960
v_mfma_f32_16x16x32_bf16 v[144:147], a[80:83], a[232:235], v[144:147]
ds_read_b64_tr_b16 a[110:111], v185 offset:45056
v_mfma_f32_16x16x32_bf16 v[144:147], a[84:87], a[236:239], v[144:147]
v_mfma_f32_16x16x32_bf16 v[112:115], a[84:87], a[228:231], v[112:115]
buffer_load_dwordx4 a[16:19], v15, s[44:47], s65 offen offset:0 sc1
v_mfma_f32_16x16x32_bf16 v[112:115], a[80:83], a[224:227], v[112:115]
ds_read_b64_tr_b16 a[112:113], v186 offset:32768
v_mfma_f32_16x16x32_bf16 v[80:83], a[80:83], a[216:219], v[80:83]
ds_read_b64_tr_b16 a[114:115], v186 offset:36864
v_mfma_f32_16x16x32_bf16 v[80:83], a[84:87], a[220:223], v[80:83]
buffer_load_dwordx4 a[24:27], v15, s[44:47], s65 offen offset:1024 sc1
v_mfma_f32_16x16x32_bf16 v[48:51], a[84:87], a[212:215], v[48:51]
ds_read_b64_tr_b16 a[116:117], v186 offset:40960
v_mfma_f32_16x16x32_bf16 v[48:51], a[80:83], a[208:211], v[48:51]
s_waitcnt lgkmcnt(4)
ds_read_b64_tr_b16 a[118:119], v186 offset:45056
v_mfma_f32_16x16x32_bf16 v[52:55], a[88:91], a[208:211], v[52:55]
s_add_u32 s65, s84, 73728
v_mfma_f32_16x16x32_bf16 v[52:55], a[92:95], a[212:215], v[52:55]
buffer_load_dwordx4 a[4:7], v14, s[44:47], s65 offen offset:0 sc1
v_mfma_f32_16x16x32_bf16 v[84:87], a[92:95], a[220:223], v[84:87]
ds_read_b64_tr_b16 a[120:121], v187 offset:32768
v_mfma_f32_16x16x32_bf16 v[84:87], a[88:91], a[216:219], v[84:87]
ds_read_b64_tr_b16 a[122:123], v187 offset:36864
v_mfma_f32_16x16x32_bf16 v[116:119], a[88:91], a[224:227], v[116:119]
buffer_load_dwordx4 a[12:15], v14, s[44:47], s65 offen offset:1024 sc1
v_mfma_f32_16x16x32_bf16 v[116:119], a[92:95], a[228:231], v[116:119]
ds_read_b64_tr_b16 a[124:125], v187 offset:40960
v_mfma_f32_16x16x32_bf16 v[148:151], a[92:95], a[236:239], v[148:151]
ds_read_b64_tr_b16 a[126:127], v187 offset:45056
v_mfma_f32_16x16x32_bf16 v[148:151], a[88:91], a[232:235], v[148:151]
v_mfma_f32_16x16x32_bf16 v[120:123], a[96:99], a[232:235], v[120:123]
buffer_load_dwordx4 a[20:23], v15, s[44:47], s65 offen offset:0 sc1
v_mfma_f32_16x16x32_bf16 v[120:123], a[100:103], a[236:239], v[120:123]
v_mfma_f32_16x16x32_bf16 v[88:91], a[100:103], a[228:231], v[88:91]
v_mfma_f32_16x16x32_bf16 v[88:91], a[96:99], a[224:227], v[88:91]
buffer_load_dwordx4 a[28:31], v15, s[44:47], s65 offen offset:1024 sc1
v_mfma_f32_16x16x32_bf16 v[56:59], a[96:99], a[216:219], v[56:59]
v_mfma_f32_16x16x32_bf16 v[56:59], a[100:103], a[220:223], v[56:59]
v_mfma_f32_16x16x32_bf16 v[24:27], a[100:103], a[212:215], v[24:27]
v_mfma_f32_16x16x32_bf16 v[24:27], a[96:99], a[208:211], v[24:27]
v_mfma_f32_16x16x32_bf16 v[28:31], a[104:107], a[208:211], v[28:31]
s_waitcnt vmcnt(24)
s_barrier
s_waitcnt lgkmcnt(0)
v_mfma_f32_16x16x32_bf16 v[28:31], a[108:111], a[212:215], v[28:31]
s_add_u32 m0, s86, 98304
ds_read_b64_tr_b16 a[64:65], v196 offset:0
v_mfma_f32_16x16x32_bf16 v[60:63], a[108:111], a[220:223], v[60:63]
s_add_u32 s64, s85, 786432
ds_read_b64_tr_b16 a[66:67], v196 offset:4096
v_mfma_f32_16x16x32_bf16 v[60:63], a[104:107], a[216:219], v[60:63]
buffer_load_dwordx4 v12, s[40:43], s64 offen lds
v_mfma_f32_16x16x32_bf16 v[92:95], a[104:107], a[224:227], v[92:95]
ds_read_b64_tr_b16 a[68:69], v196 offset:8192
v_mfma_f32_16x16x32_bf16 v[92:95], a[108:111], a[228:231], v[92:95]
s_add_u32 m0, s86, 99328
ds_read_b64_tr_b16 a[70:71], v196 offset:12288
v_mfma_f32_16x16x32_bf16 v[124:127], a[108:111], a[236:239], v[124:127]
s_add_u32 s64, s85, 794624
ds_read_b64_tr_b16 a[72:73], v197 offset:0
v_mfma_f32_16x16x32_bf16 v[124:127], a[104:107], a[232:235], v[124:127]
buffer_load_dwordx4 v13, s[40:43], s64 offen lds
v_mfma_f32_16x16x32_bf16 v[128:131], a[112:115], a[232:235], v[128:131]
ds_read_b64_tr_b16 a[74:75], v197 offset:4096
v_mfma_f32_16x16x32_bf16 v[128:131], a[116:119], a[236:239], v[128:131]
s_add_u32 m0, s86, 100352
ds_read_b64_tr_b16 a[76:77], v197 offset:8192
v_mfma_f32_16x16x32_bf16 v[96:99], a[116:119], a[228:231], v[96:99]
s_add_u32 s64, s85, 802816
ds_read_b64_tr_b16 a[78:79], v197 offset:12288
v_mfma_f32_16x16x32_bf16 v[96:99], a[112:115], a[224:227], v[96:99]
buffer_load_dwordx4 v12, s[40:43], s64 offen lds
v_mfma_f32_16x16x32_bf16 v[64:67], a[112:115], a[216:219], v[64:67]
ds_read_b64_tr_b16 a[80:81], v198 offset:0
v_mfma_f32_16x16x32_bf16 v[64:67], a[116:119], a[220:223], v[64:67]
s_add_u32 m0, s86, 101376
ds_read_b64_tr_b16 a[82:83], v198 offset:4096
v_mfma_f32_16x16x32_bf16 v[32:35], a[116:119], a[212:215], v[32:35]
s_add_u32 s64, s85, 811008
ds_read_b64_tr_b16 a[84:85], v198 offset:8192
v_mfma_f32_16x16x32_bf16 v[32:35], a[112:115], a[208:211], v[32:35]
buffer_load_dwordx4 v13, s[40:43], s64 offen lds
v_mfma_f32_16x16x32_bf16 v[36:39], a[120:123], a[208:211], v[36:39]
ds_read_b64_tr_b16 a[86:87], v198 offset:12288
v_mfma_f32_16x16x32_bf16 v[36:39], a[124:127], a[212:215], v[36:39]
s_add_u32 m0, s86, 102400
v_mfma_f32_16x16x32_bf16 v[68:71], a[124:127], a[220:223], v[68:71]
s_add_u32 s64, s85, 819200
v_mfma_f32_16x16x32_bf16 v[68:71], a[120:123], a[216:219], v[68:71]
buffer_load_dwordx4 v12, s[40:43], s64 offen lds
v_mfma_f32_16x16x32_bf16 v[100:103], a[120:123], a[224:227], v[100:103]
v_mfma_f32_16x16x32_bf16 v[100:103], a[124:127], a[228:231], v[100:103]
v_mfma_f32_16x16x32_bf16 v[132:135], a[124:127], a[236:239], v[132:135]
v_mfma_f32_16x16x32_bf16 v[132:135], a[120:123], a[232:235], v[132:135]
s_waitcnt vmcnt(25)
s_waitcnt lgkmcnt(1)
s_add_u32 m0, s86, 103424
buffer_load_dword v19, off, s[52:55], s72 offset:128 sc1
v_mfma_f32_16x16x32_bf16 v[136:139], a[64:67], v[176:179], v[136:139]
s_waitcnt vmcnt(22)
s_add_u32 s64, s85, 827392
ds_read_b64_tr_b16 a[88:89], v199 offset:0
v_mfma_f32_16x16x32_bf16 v[136:139], a[68:71], v[180:183], v[136:139]
buffer_load_dwordx4 v13, s[40:43], s64 offen lds
v_mfma_f32_16x16x32_bf16 v[104:107], a[68:71], v[172:175], v[104:107]
s_add_u32 m0, s86, 104448
ds_read_b64_tr_b16 a[90:91], v199 offset:4096
v_mfma_f32_16x16x32_bf16 v[104:107], a[64:67], v[168:171], v[104:107]
s_add_u32 s64, s85, 835584
ds_read_b64_tr_b16 a[92:93], v199 offset:8192
v_mfma_f32_16x16x32_bf16 v[72:75], a[64:67], v[160:163], v[72:75]
buffer_load_dwordx4 v12, s[40:43], s64 offen lds
v_mfma_f32_16x16x32_bf16 v[72:75], a[68:71], v[164:167], v[72:75]
s_add_u32 m0, s86, 105472
ds_read_b64_tr_b16 a[94:95], v199 offset:12288
v_mfma_f32_16x16x32_bf16 v[40:43], a[68:71], v[156:159], v[40:43]
s_add_u32 s64, s85, 843776
ds_read_b64_tr_b16 a[96:97], v192 offset:0
v_mfma_f32_16x16x32_bf16 v[40:43], a[64:67], v[152:155], v[40:43]
buffer_load_dwordx4 v13, s[40:43], s64 offen lds
v_mfma_f32_16x16x32_bf16 v[44:47], a[72:75], v[152:155], v[44:47]
ds_read_b64_tr_b16 a[98:99], v192 offset:4096
v_mfma_f32_16x16x32_bf16 v[44:47], a[76:79], v[156:159], v[44:47]
ds_read_b64_tr_b16 a[100:101], v192 offset:8192
v_mfma_f32_16x16x32_bf16 v[76:79], a[76:79], v[164:167], v[76:79]
s_add_u32 s65, s84, 98304
ds_read_b64_tr_b16 a[102:103], v192 offset:12288
v_mfma_f32_16x16x32_bf16 v[76:79], a[72:75], v[160:163], v[76:79]
buffer_load_dwordx4 a[32:35], v14, s[44:47], s65 offen offset:0 sc1
v_mfma_f32_16x16x32_bf16 v[108:111], a[72:75], v[168:171], v[108:111]
ds_read_b64_tr_b16 a[104:105], v193 offset:0
v_mfma_f32_16x16x32_bf16 v[108:111], a[76:79], v[172:175], v[108:111]
ds_read_b64_tr_b16 a[106:107], v193 offset:4096
v_mfma_f32_16x16x32_bf16 v[140:143], a[76:79], v[180:183], v[140:143]
buffer_load_dwordx4 a[40:43], v14, s[44:47], s65 offen offset:1024 sc1
v_mfma_f32_16x16x32_bf16 v[140:143], a[72:75], v[176:179], v[140:143]
ds_read_b64_tr_b16 a[108:109], v193 offset:8192
v_mfma_f32_16x16x32_bf16 v[144:147], a[80:83], v[176:179], v[144:147]
s_waitcnt lgkmcnt(5)
s_lshl_b32 s75, s73, 20
s_add_u32 s85, s85, s75
ds_read_b64_tr_b16 a[110:111], v193 offset:12288
v_mfma_f32_16x16x32_bf16 v[144:147], a[84:87], v[180:183], v[144:147]
s_lshr_b32 s74, s73, 28
s_and_b32 s74, s74, 8
v_mfma_f32_16x16x32_bf16 v[112:115], a[84:87], v[172:175], v[112:115]
buffer_load_dwordx4 a[48:51], v15, s[44:47], s65 offen offset:0 sc1
v_mfma_f32_16x16x32_bf16 v[112:115], a[80:83], v[168:171], v[112:115]
ds_read_b64_tr_b16 a[112:113], v194 offset:0
v_mfma_f32_16x16x32_bf16 v[80:83], a[80:83], v[160:163], v[80:83]
ds_read_b64_tr_b16 a[114:115], v194 offset:4096
v_mfma_f32_16x16x32_bf16 v[80:83], a[84:87], v[164:167], v[80:83]
buffer_load_dwordx4 a[56:59], v15, s[44:47], s65 offen offset:1024 sc1
v_mfma_f32_16x16x32_bf16 v[48:51], a[84:87], v[156:159], v[48:51]
ds_read_b64_tr_b16 a[116:117], v194 offset:8192
v_mfma_f32_16x16x32_bf16 v[48:51], a[80:83], v[152:155], v[48:51]
ds_read_b64_tr_b16 a[118:119], v194 offset:12288
v_mfma_f32_16x16x32_bf16 v[52:55], a[88:91], v[152:155], v[52:55]
s_add_u32 s65, s84, 106496
v_mfma_f32_16x16x32_bf16 v[52:55], a[92:95], v[156:159], v[52:55]
buffer_load_dwordx4 a[36:39], v14, s[44:47], s65 offen offset:0 sc1
v_mfma_f32_16x16x32_bf16 v[84:87], a[92:95], v[164:167], v[84:87]
ds_read_b64_tr_b16 a[120:121], v195 offset:0
v_mfma_f32_16x16x32_bf16 v[84:87], a[88:91], v[160:163], v[84:87]
ds_read_b64_tr_b16 a[122:123], v195 offset:4096
v_mfma_f32_16x16x32_bf16 v[116:119], a[88:91], v[168:171], v[116:119]
buffer_load_dwordx4 a[44:47], v14, s[44:47], s65 offen offset:1024 sc1
v_mfma_f32_16x16x32_bf16 v[116:119], a[92:95], v[172:175], v[116:119]
ds_read_b64_tr_b16 a[124:125], v195 offset:8192
v_mfma_f32_16x16x32_bf16 v[148:151], a[92:95], v[180:183], v[148:151]
ds_read_b64_tr_b16 a[126:127], v195 offset:12288
v_mfma_f32_16x16x32_bf16 v[148:151], a[88:91], v[176:179], v[148:151]
v_mfma_f32_16x16x32_bf16 v[120:123], a[96:99], v[176:179], v[120:123]
s_waitcnt lgkmcnt(4)
buffer_load_dwordx4 a[52:55], v15, s[44:47], s65 offen offset:0 sc1
v_mfma_f32_16x16x32_bf16 v[120:123], a[100:103], v[180:183], v[120:123]
v_mfma_f32_16x16x32_bf16 v[88:91], a[100:103], v[172:175], v[88:91]
v_mfma_f32_16x16x32_bf16 v[88:91], a[96:99], v[168:171], v[88:91]
buffer_load_dwordx4 a[60:63], v15, s[44:47], s65 offen offset:1024 sc1
v_mfma_f32_16x16x32_bf16 v[56:59], a[96:99], v[160:163], v[56:59]
v_mfma_f32_16x16x32_bf16 v[56:59], a[100:103], v[164:167], v[56:59]
v_mfma_f32_16x16x32_bf16 v[24:27], a[100:103], v[156:159], v[24:27]
v_mfma_f32_16x16x32_bf16 v[24:27], a[96:99], v[152:155], v[24:27]
v_mfma_f32_16x16x32_bf16 v[28:31], a[104:107], v[152:155], v[28:31]
s_waitcnt vmcnt(25)
s_barrier
v_mfma_f32_16x16x32_bf16 v[28:31], a[108:111], v[156:159], v[28:31]
s_add_u32 m0, s86, 131072
ds_read_b64_tr_b16 a[64:65], v196 offset:32768
v_mfma_f32_16x16x32_bf16 v[60:63], a[108:111], v[164:167], v[60:63]
s_add_u32 s64, s85, 0
ds_read_b64_tr_b16 a[66:67], v196 offset:36864
v_mfma_f32_16x16x32_bf16 v[60:63], a[104:107], v[160:163], v[60:63]
buffer_load_dwordx4 v12, s[40:43], s64 offen lds
v_mfma_f32_16x16x32_bf16 v[92:95], a[104:107], v[168:171], v[92:95]
s_lshl_b32 s75, s73, 17
s_add_u32 s84, s84, s75
ds_read_b64_tr_b16 a[68:69], v196 offset:40960
v_mfma_f32_16x16x32_bf16 v[92:95], a[108:111], v[172:175], v[92:95]
s_add_u32 m0, s86, 132096
ds_read_b64_tr_b16 a[70:71], v196 offset:45056
v_mfma_f32_16x16x32_bf16 v[124:127], a[108:111], v[180:183], v[124:127]
s_add_u32 s64, s85, 8192
ds_read_b64_tr_b16 a[72:73], v197 offset:32768
v_mfma_f32_16x16x32_bf16 v[124:127], a[104:107], v[176:179], v[124:127]
buffer_load_dwordx4 v13, s[40:43], s64 offen lds
v_mfma_f32_16x16x32_bf16 v[128:131], a[112:115], v[176:179], v[128:131]
ds_read_b64_tr_b16 a[74:75], v197 offset:36864
v_mfma_f32_16x16x32_bf16 v[128:131], a[116:119], v[180:183], v[128:131]
s_add_u32 m0, s86, 133120
ds_read_b64_tr_b16 a[76:77], v197 offset:40960
v_mfma_f32_16x16x32_bf16 v[96:99], a[116:119], v[172:175], v[96:99]
s_add_u32 s64, s85, 16384
ds_read_b64_tr_b16 a[78:79], v197 offset:45056
v_mfma_f32_16x16x32_bf16 v[96:99], a[112:115], v[168:171], v[96:99]
buffer_load_dwordx4 v12, s[40:43], s64 offen lds
v_mfma_f32_16x16x32_bf16 v[64:67], a[112:115], v[160:163], v[64:67]
ds_read_b64_tr_b16 a[80:81], v198 offset:32768
v_mfma_f32_16x16x32_bf16 v[64:67], a[116:119], v[164:167], v[64:67]
s_add_u32 m0, s86, 134144
ds_read_b64_tr_b16 a[82:83], v198 offset:36864
v_mfma_f32_16x16x32_bf16 v[32:35], a[116:119], v[156:159], v[32:35]
s_add_u32 s64, s85, 24576
ds_read_b64_tr_b16 a[84:85], v198 offset:40960
v_mfma_f32_16x16x32_bf16 v[32:35], a[112:115], v[152:155], v[32:35]
s_waitcnt lgkmcnt(6)
buffer_load_dwordx4 v13, s[40:43], s64 offen lds
v_mfma_f32_16x16x32_bf16 v[36:39], a[120:123], v[152:155], v[36:39]
ds_read_b64_tr_b16 a[86:87], v198 offset:45056
v_mfma_f32_16x16x32_bf16 v[36:39], a[124:127], v[156:159], v[36:39]
s_add_u32 m0, s86, 135168
v_mfma_f32_16x16x32_bf16 v[68:71], a[124:127], v[164:167], v[68:71]
s_add_u32 s64, s85, 32768
v_mfma_f32_16x16x32_bf16 v[68:71], a[120:123], v[160:163], v[68:71]
buffer_load_dwordx4 v12, s[40:43], s64 offen lds
v_mfma_f32_16x16x32_bf16 v[100:103], a[120:123], v[168:171], v[100:103]
v_mfma_f32_16x16x32_bf16 v[100:103], a[124:127], v[172:175], v[100:103]
v_mfma_f32_16x16x32_bf16 v[132:135], a[124:127], v[180:183], v[132:135]
v_mfma_f32_16x16x32_bf16 v[132:135], a[120:123], v[176:179], v[132:135]
s_waitcnt vmcnt(26)
v_mfma_f32_16x16x32_bf16 v[136:139], a[64:67], a[24:27], v[136:139]
s_waitcnt vmcnt(16)
v_readfirstlane_b32 vcc_lo, v19
s_nop 0
s_cmp_lt_u32 vcc_lo, s74
s_cbranch_scc1 L_spin_4022
L_spinbk_4023:
v_mfma_f32_16x16x32_bf16 v[136:139], a[68:71], a[28:31], v[136:139]
s_add_u32 m0, s86, 136192
ds_read_b64_tr_b16 a[88:89], v199 offset:32768
v_mfma_f32_16x16x32_bf16 v[104:107], a[68:71], a[20:23], v[104:107]
s_add_u32 s64, s85, 40960
ds_read_b64_tr_b16 a[90:91], v199 offset:36864
v_mfma_f32_16x16x32_bf16 v[104:107], a[64:67], a[16:19], v[104:107]
buffer_load_dwordx4 v13, s[40:43], s64 offen lds
v_mfma_f32_16x16x32_bf16 v[72:75], a[64:67], a[8:11], v[72:75]
s_add_u32 m0, s86, 137216
ds_read_b64_tr_b16 a[92:93], v199 offset:40960
v_mfma_f32_16x16x32_bf16 v[72:75], a[68:71], a[12:15], v[72:75]
s_add_u32 s64, s85, 49152
ds_read_b64_tr_b16 a[94:95], v199 offset:45056
v_mfma_f32_16x16x32_bf16 v[40:43], a[68:71], a[4:7], v[40:43]
buffer_load_dwordx4 v12, s[40:43], s64 offen lds
v_mfma_f32_16x16x32_bf16 v[40:43], a[64:67], a[0:3], v[40:43]
s_waitcnt lgkmcnt(4)
s_add_u32 m0, s86, 138240
ds_read_b64_tr_b16 a[96:97], v192 offset:32768
v_mfma_f32_16x16x32_bf16 v[44:47], a[72:75], a[0:3], v[44:47]
s_add_u32 s64, s85, 57344
ds_read_b64_tr_b16 a[98:99], v192 offset:36864
v_mfma_f32_16x16x32_bf16 v[44:47], a[76:79], a[4:7], v[44:47]
buffer_load_dwordx4 v13, s[40:43], s64 offen lds
v_mfma_f32_16x16x32_bf16 v[76:79], a[76:79], a[12:15], v[76:79]
ds_read_b64_tr_b16 a[100:101], v192 offset:40960
v_mfma_f32_16x16x32_bf16 v[76:79], a[72:75], a[8:11], v[76:79]
s_add_u32 s65, s84, 0
ds_read_b64_tr_b16 a[102:103], v192 offset:45056
v_mfma_f32_16x16x32_bf16 v[108:111], a[72:75], a[16:19], v[108:111]
buffer_load_dwordx4 a[208:211], v14, s[44:47], s65 offen offset:0 sc1
v_mfma_f32_16x16x32_bf16 v[108:111], a[76:79], a[20:23], v[108:111]
ds_read_b64_tr_b16 a[104:105], v193 offset:32768
v_mfma_f32_16x16x32_bf16 v[140:143], a[76:79], a[28:31], v[140:143]
ds_read_b64_tr_b16 a[106:107], v193 offset:36864
v_mfma_f32_16x16x32_bf16 v[140:143], a[72:75], a[24:27], v[140:143]
ds_read_b64_tr_b16 a[108:109], v193 offset:40960
v_mfma_f32_16x16x32_bf16 v[144:147], a[80:83], a[24:27], v[144:147]
buffer_load_dwordx4 a[216:219], v14, s[44:47], s65 offen offset:1024 sc1
v_mfma_f32_16x16x32_bf16 v[144:147], a[84:87], a[28:31], v[144:147]
ds_read_b64_tr_b16 a[110:111], v193 offset:45056
v_mfma_f32_16x16x32_bf16 v[112:115], a[84:87], a[20:23], v[112:115]
ds_read_b64_tr_b16 a[112:113], v194 offset:32768
v_mfma_f32_16x16x32_bf16 v[112:115], a[80:83], a[16:19], v[112:115]
buffer_load_dwordx4 a[224:227], v15, s[44:47], s65 offen offset:0 sc1
v_mfma_f32_16x16x32_bf16 v[80:83], a[80:83], a[8:11], v[80:83]
ds_read_b64_tr_b16 a[114:115], v194 offset:36864
v_mfma_f32_16x16x32_bf16 v[80:83], a[84:87], a[12:15], v[80:83]
ds_read_b64_tr_b16 a[116:117], v194 offset:40960
v_mfma_f32_16x16x32_bf16 v[48:51], a[84:87], a[4:7], v[48:51]
buffer_load_dwordx4 a[232:235], v15, s[44:47], s65 offen offset:1024 sc1
v_mfma_f32_16x16x32_bf16 v[48:51], a[80:83], a[0:3], v[48:51]
s_waitcnt lgkmcnt(4)
ds_read_b64_tr_b16 a[118:119], v194 offset:45056
v_mfma_f32_16x16x32_bf16 v[52:55], a[88:91], a[0:3], v[52:55]
s_add_u32 s65, s84, 8192
v_mfma_f32_16x16x32_bf16 v[52:55], a[92:95], a[4:7], v[52:55]
buffer_load_dwordx4 a[212:215], v14, s[44:47], s65 offen offset:0 sc1
v_mfma_f32_16x16x32_bf16 v[84:87], a[92:95], a[12:15], v[84:87]
ds_read_b64_tr_b16 a[120:121], v195 offset:32768
v_mfma_f32_16x16x32_bf16 v[84:87], a[88:91], a[8:11], v[84:87]
ds_read_b64_tr_b16 a[122:123], v195 offset:36864
v_mfma_f32_16x16x32_bf16 v[116:119], a[88:91], a[16:19], v[116:119]
ds_read_b64_tr_b16 a[124:125], v195 offset:40960
v_mfma_f32_16x16x32_bf16 v[116:119], a[92:95], a[20:23], v[116:119]
buffer_load_dwordx4 a[220:223], v14, s[44:47], s65 offen offset:1024 sc1
v_mfma_f32_16x16x32_bf16 v[148:151], a[92:95], a[28:31], v[148:151]
ds_read_b64_tr_b16 a[126:127], v195 offset:45056
v_mfma_f32_16x16x32_bf16 v[148:151], a[88:91], a[24:27], v[148:151]
v_mfma_f32_16x16x32_bf16 v[120:123], a[96:99], a[24:27], v[120:123]
buffer_load_dwordx4 a[228:231], v15, s[44:47], s65 offen offset:0 sc1
v_mfma_f32_16x16x32_bf16 v[120:123], a[100:103], a[28:31], v[120:123]
v_mfma_f32_16x16x32_bf16 v[88:91], a[100:103], a[20:23], v[88:91]
v_mfma_f32_16x16x32_bf16 v[88:91], a[96:99], a[16:19], v[88:91]
buffer_load_dwordx4 a[236:239], v15, s[44:47], s65 offen offset:1024 sc1
v_mfma_f32_16x16x32_bf16 v[56:59], a[96:99], a[8:11], v[56:59]
v_mfma_f32_16x16x32_bf16 v[56:59], a[100:103], a[12:15], v[56:59]
v_mfma_f32_16x16x32_bf16 v[24:27], a[100:103], a[4:7], v[24:27]
v_mfma_f32_16x16x32_bf16 v[24:27], a[96:99], a[0:3], v[24:27]
v_mfma_f32_16x16x32_bf16 v[28:31], a[104:107], a[0:3], v[28:31]
s_waitcnt vmcnt(24)
s_barrier
s_waitcnt lgkmcnt(0)
v_mfma_f32_16x16x32_bf16 v[28:31], a[108:111], a[4:7], v[28:31]
s_add_u32 m0, s86, 32768
ds_read_b64_tr_b16 a[64:65], v188 offset:0
v_mfma_f32_16x16x32_bf16 v[60:63], a[108:111], a[12:15], v[60:63]
s_add_u32 s64, s85, 262144
ds_read_b64_tr_b16 a[66:67], v188 offset:4096
v_mfma_f32_16x16x32_bf16 v[60:63], a[104:107], a[8:11], v[60:63]
buffer_load_dwordx4 v12, s[40:43], s64 offen lds
v_mfma_f32_16x16x32_bf16 v[92:95], a[104:107], a[16:19], v[92:95]
ds_read_b64_tr_b16 a[68:69], v188 offset:8192
v_mfma_f32_16x16x32_bf16 v[92:95], a[108:111], a[20:23], v[92:95]
s_add_u32 m0, s86, 33792
ds_read_b64_tr_b16 a[70:71], v188 offset:12288
v_mfma_f32_16x16x32_bf16 v[124:127], a[108:111], a[28:31], v[124:127]
s_add_u32 s64, s85, 270336
ds_read_b64_tr_b16 a[72:73], v189 offset:0
v_mfma_f32_16x16x32_bf16 v[124:127], a[104:107], a[24:27], v[124:127]
buffer_load_dwordx4 v13, s[40:43], s64 offen lds
v_mfma_f32_16x16x32_bf16 v[128:131], a[112:115], a[24:27], v[128:131]
ds_read_b64_tr_b16 a[74:75], v189 offset:4096
v_mfma_f32_16x16x32_bf16 v[128:131], a[116:119], a[28:31], v[128:131]
s_add_u32 m0, s86, 34816
ds_read_b64_tr_b16 a[76:77], v189 offset:8192
v_mfma_f32_16x16x32_bf16 v[96:99], a[116:119], a[20:23], v[96:99]
s_add_u32 s64, s85, 278528
ds_read_b64_tr_b16 a[78:79], v189 offset:12288
v_mfma_f32_16x16x32_bf16 v[96:99], a[112:115], a[16:19], v[96:99]
buffer_load_dwordx4 v12, s[40:43], s64 offen lds
v_mfma_f32_16x16x32_bf16 v[64:67], a[112:115], a[8:11], v[64:67]
ds_read_b64_tr_b16 a[80:81], v190 offset:0
v_mfma_f32_16x16x32_bf16 v[64:67], a[116:119], a[12:15], v[64:67]
s_add_u32 m0, s86, 35840
ds_read_b64_tr_b16 a[82:83], v190 offset:4096
v_mfma_f32_16x16x32_bf16 v[32:35], a[116:119], a[4:7], v[32:35]
s_add_u32 s64, s85, 286720
ds_read_b64_tr_b16 a[84:85], v190 offset:8192
v_mfma_f32_16x16x32_bf16 v[32:35], a[112:115], a[0:3], v[32:35]
buffer_load_dwordx4 v13, s[40:43], s64 offen lds
v_mfma_f32_16x16x32_bf16 v[36:39], a[120:123], a[0:3], v[36:39]
ds_read_b64_tr_b16 a[86:87], v190 offset:12288
v_mfma_f32_16x16x32_bf16 v[36:39], a[124:127], a[4:7], v[36:39]
s_add_u32 m0, s86, 36864
v_mfma_f32_16x16x32_bf16 v[68:71], a[124:127], a[12:15], v[68:71]
s_add_u32 s64, s85, 294912
v_mfma_f32_16x16x32_bf16 v[68:71], a[120:123], a[8:11], v[68:71]
buffer_load_dwordx4 v12, s[40:43], s64 offen lds
v_mfma_f32_16x16x32_bf16 v[100:103], a[120:123], a[16:19], v[100:103]
v_mfma_f32_16x16x32_bf16 v[100:103], a[124:127], a[20:23], v[100:103]
v_mfma_f32_16x16x32_bf16 v[132:135], a[124:127], a[28:31], v[132:135]
v_mfma_f32_16x16x32_bf16 v[132:135], a[120:123], a[24:27], v[132:135]
s_waitcnt vmcnt(25)
s_waitcnt lgkmcnt(1)
s_add_u32 m0, s86, 37888
v_mfma_f32_16x16x32_bf16 v[136:139], a[64:67], a[56:59], v[136:139]
s_waitcnt vmcnt(21)
s_add_u32 s64, s85, 303104
ds_read_b64_tr_b16 a[88:89], v191 offset:0
v_mfma_f32_16x16x32_bf16 v[136:139], a[68:71], a[60:63], v[136:139]
buffer_load_dwordx4 v13, s[40:43], s64 offen lds
v_mfma_f32_16x16x32_bf16 v[104:107], a[68:71], a[52:55], v[104:107]
s_add_u32 m0, s86, 38912
ds_read_b64_tr_b16 a[90:91], v191 offset:4096
v_mfma_f32_16x16x32_bf16 v[104:107], a[64:67], a[48:51], v[104:107]
s_add_u32 s64, s85, 311296
ds_read_b64_tr_b16 a[92:93], v191 offset:8192
v_mfma_f32_16x16x32_bf16 v[72:75], a[64:67], a[40:43], v[72:75]
buffer_load_dwordx4 v12, s[40:43], s64 offen lds
v_mfma_f32_16x16x32_bf16 v[72:75], a[68:71], a[44:47], v[72:75]
s_add_u32 m0, s86, 39936
ds_read_b64_tr_b16 a[94:95], v191 offset:12288
v_mfma_f32_16x16x32_bf16 v[40:43], a[68:71], a[36:39], v[40:43]
s_add_u32 s64, s85, 319488
ds_read_b64_tr_b16 a[96:97], v184 offset:0
v_mfma_f32_16x16x32_bf16 v[40:43], a[64:67], a[32:35], v[40:43]
buffer_load_dwordx4 v13, s[40:43], s64 offen lds
v_mfma_f32_16x16x32_bf16 v[44:47], a[72:75], a[32:35], v[44:47]
ds_read_b64_tr_b16 a[98:99], v184 offset:4096
v_mfma_f32_16x16x32_bf16 v[44:47], a[76:79], a[36:39], v[44:47]
ds_read_b64_tr_b16 a[100:101], v184 offset:8192
v_mfma_f32_16x16x32_bf16 v[76:79], a[76:79], a[44:47], v[76:79]
s_add_u32 s65, s84, 32768
ds_read_b64_tr_b16 a[102:103], v184 offset:12288
v_mfma_f32_16x16x32_bf16 v[76:79], a[72:75], a[40:43], v[76:79]
buffer_load_dwordx4 v[152:155], v14, s[44:47], s65 offen offset:0 sc1
v_mfma_f32_16x16x32_bf16 v[108:111], a[72:75], a[48:51], v[108:111]
ds_read_b64_tr_b16 a[104:105], v185 offset:0
v_mfma_f32_16x16x32_bf16 v[108:111], a[76:79], a[52:55], v[108:111]
ds_read_b64_tr_b16 a[106:107], v185 offset:4096
v_mfma_f32_16x16x32_bf16 v[140:143], a[76:79], a[60:63], v[140:143]
buffer_load_dwordx4 v[160:163], v14, s[44:47], s65 offen offset:1024 sc1
v_mfma_f32_16x16x32_bf16 v[140:143], a[72:75], a[56:59], v[140:143]
ds_read_b64_tr_b16 a[108:109], v185 offset:8192
v_mfma_f32_16x16x32_bf16 v[144:147], a[80:83], a[56:59], v[144:147]
s_waitcnt lgkmcnt(5)
ds_read_b64_tr_b16 a[110:111], v185 offset:12288
v_mfma_f32_16x16x32_bf16 v[144:147], a[84:87], a[60:63], v[144:147]
v_mfma_f32_16x16x32_bf16 v[112:115], a[84:87], a[52:55], v[112:115]
buffer_load_dwordx4 v[168:171], v15, s[44:47], s65 offen offset:0 sc1
v_mfma_f32_16x16x32_bf16 v[112:115], a[80:83], a[48:51], v[112:115]
ds_read_b64_tr_b16 a[112:113], v186 offset:0
v_mfma_f32_16x16x32_bf16 v[80:83], a[80:83], a[40:43], v[80:83]
ds_read_b64_tr_b16 a[114:115], v186 offset:4096
v_mfma_f32_16x16x32_bf16 v[80:83], a[84:87], a[44:47], v[80:83]
buffer_load_dwordx4 v[176:179], v15, s[44:47], s65 offen offset:1024 sc1
v_mfma_f32_16x16x32_bf16 v[48:51], a[84:87], a[36:39], v[48:51]
ds_read_b64_tr_b16 a[116:117], v186 offset:8192
v_mfma_f32_16x16x32_bf16 v[48:51], a[80:83], a[32:35], v[48:51]
ds_read_b64_tr_b16 a[118:119], v186 offset:12288
v_mfma_f32_16x16x32_bf16 v[52:55], a[88:91], a[32:35], v[52:55]
s_add_u32 s65, s84, 40960
v_mfma_f32_16x16x32_bf16 v[52:55], a[92:95], a[36:39], v[52:55]
buffer_load_dwordx4 v[156:159], v14, s[44:47], s65 offen offset:0 sc1
v_mfma_f32_16x16x32_bf16 v[84:87], a[92:95], a[44:47], v[84:87]
ds_read_b64_tr_b16 a[120:121], v187 offset:0
v_mfma_f32_16x16x32_bf16 v[84:87], a[88:91], a[40:43], v[84:87]
ds_read_b64_tr_b16 a[122:123], v187 offset:4096
v_mfma_f32_16x16x32_bf16 v[116:119], a[88:91], a[48:51], v[116:119]
buffer_load_dwordx4 v[164:167], v14, s[44:47], s65 offen offset:1024 sc1
v_mfma_f32_16x16x32_bf16 v[116:119], a[92:95], a[52:55], v[116:119]
ds_read_b64_tr_b16 a[124:125], v187 offset:8192
v_mfma_f32_16x16x32_bf16 v[148:151], a[92:95], a[60:63], v[148:151]
ds_read_b64_tr_b16 a[126:127], v187 offset:12288
v_mfma_f32_16x16x32_bf16 v[148:151], a[88:91], a[56:59], v[148:151]
v_mfma_f32_16x16x32_bf16 v[120:123], a[96:99], a[56:59], v[120:123]
s_waitcnt lgkmcnt(4)
buffer_load_dwordx4 v[172:175], v15, s[44:47], s65 offen offset:0 sc1
v_mfma_f32_16x16x32_bf16 v[120:123], a[100:103], a[60:63], v[120:123]
v_mfma_f32_16x16x32_bf16 v[88:91], a[100:103], a[52:55], v[88:91]
v_mfma_f32_16x16x32_bf16 v[88:91], a[96:99], a[48:51], v[88:91]
buffer_load_dwordx4 v[180:183], v15, s[44:47], s65 offen offset:1024 sc1
v_mfma_f32_16x16x32_bf16 v[56:59], a[96:99], a[40:43], v[56:59]
v_mfma_f32_16x16x32_bf16 v[56:59], a[100:103], a[44:47], v[56:59]
v_mfma_f32_16x16x32_bf16 v[24:27], a[100:103], a[36:39], v[24:27]
v_mfma_f32_16x16x32_bf16 v[24:27], a[96:99], a[32:35], v[24:27]
v_mfma_f32_16x16x32_bf16 v[28:31], a[104:107], a[32:35], v[28:31]
s_waitcnt vmcnt(24)
s_barrier
v_mfma_f32_16x16x32_bf16 v[28:31], a[108:111], a[36:39], v[28:31]
s_add_u32 m0, s86, 65536
ds_read_b64_tr_b16 a[64:65], v188 offset:32768
v_mfma_f32_16x16x32_bf16 v[60:63], a[108:111], a[44:47], v[60:63]
s_add_u32 s64, s85, 524288
ds_read_b64_tr_b16 a[66:67], v188 offset:36864
v_mfma_f32_16x16x32_bf16 v[60:63], a[104:107], a[40:43], v[60:63]
buffer_load_dwordx4 v12, s[40:43], s64 offen lds
v_mfma_f32_16x16x32_bf16 v[92:95], a[104:107], a[48:51], v[92:95]
ds_read_b64_tr_b16 a[68:69], v188 offset:40960
v_mfma_f32_16x16x32_bf16 v[92:95], a[108:111], a[52:55], v[92:95]
s_add_u32 m0, s86, 66560
ds_read_b64_tr_b16 a[70:71], v188 offset:45056
v_mfma_f32_16x16x32_bf16 v[124:127], a[108:111], a[60:63], v[124:127]
s_add_u32 s64, s85, 532480
ds_read_b64_tr_b16 a[72:73], v189 offset:32768
v_mfma_f32_16x16x32_bf16 v[124:127], a[104:107], a[56:59], v[124:127]
buffer_load_dwordx4 v13, s[40:43], s64 offen lds
v_mfma_f32_16x16x32_bf16 v[128:131], a[112:115], a[56:59], v[128:131]
ds_read_b64_tr_b16 a[74:75], v189 offset:36864
v_mfma_f32_16x16x32_bf16 v[128:131], a[116:119], a[60:63], v[128:131]
s_add_u32 m0, s86, 67584
ds_read_b64_tr_b16 a[76:77], v189 offset:40960
v_mfma_f32_16x16x32_bf16 v[96:99], a[116:119], a[52:55], v[96:99]
s_add_u32 s64, s85, 540672
ds_read_b64_tr_b16 a[78:79], v189 offset:45056
v_mfma_f32_16x16x32_bf16 v[96:99], a[112:115], a[48:51], v[96:99]
buffer_load_dwordx4 v12, s[40:43], s64 offen lds
v_mfma_f32_16x16x32_bf16 v[64:67], a[112:115], a[40:43], v[64:67]
ds_read_b64_tr_b16 a[80:81], v190 offset:32768
v_mfma_f32_16x16x32_bf16 v[64:67], a[116:119], a[44:47], v[64:67]
s_add_u32 m0, s86, 68608
ds_read_b64_tr_b16 a[82:83], v190 offset:36864
v_mfma_f32_16x16x32_bf16 v[32:35], a[116:119], a[36:39], v[32:35]
s_add_u32 s64, s85, 548864
ds_read_b64_tr_b16 a[84:85], v190 offset:40960
v_mfma_f32_16x16x32_bf16 v[32:35], a[112:115], a[32:35], v[32:35]
s_waitcnt lgkmcnt(6)
buffer_load_dwordx4 v13, s[40:43], s64 offen lds
v_mfma_f32_16x16x32_bf16 v[36:39], a[120:123], a[32:35], v[36:39]
ds_read_b64_tr_b16 a[86:87], v190 offset:45056
v_mfma_f32_16x16x32_bf16 v[36:39], a[124:127], a[36:39], v[36:39]
s_add_u32 m0, s86, 69632
v_mfma_f32_16x16x32_bf16 v[68:71], a[124:127], a[44:47], v[68:71]
s_add_u32 s64, s85, 557056
v_mfma_f32_16x16x32_bf16 v[68:71], a[120:123], a[40:43], v[68:71]
buffer_load_dwordx4 v12, s[40:43], s64 offen lds
v_mfma_f32_16x16x32_bf16 v[100:103], a[120:123], a[48:51], v[100:103]
s_sub_u32 s73, 1, s73
s_sub_u32 s70, s70, 1
s_cmp_lg_u32 s70, 0
v_mfma_f32_16x16x32_bf16 v[100:103], a[124:127], a[52:55], v[100:103]
v_mfma_f32_16x16x32_bf16 v[132:135], a[124:127], a[60:63], v[132:135]
v_mfma_f32_16x16x32_bf16 v[132:135], a[120:123], a[56:59], v[132:135]
s_cbranch_scc1 L_p5loop
s_waitcnt lgkmcnt(10)
s_waitcnt vmcnt(25)
v_mfma_f32_16x16x32_bf16 v[136:139], a[64:67], a[232:235], v[136:139]
s_waitcnt vmcnt(21)
s_waitcnt lgkmcnt(8)
s_add_u32 m0, s86, 70656
s_add_u32 s64, s85, 565248
ds_read_b64_tr_b16 a[88:89], v191 offset:32768
v_mfma_f32_16x16x32_bf16 v[136:139], a[68:71], a[236:239], v[136:139]
buffer_load_dwordx4 v13, s[40:43], s64 offen lds
v_mfma_f32_16x16x32_bf16 v[104:107], a[68:71], a[228:231], v[104:107]
s_add_u32 m0, s86, 71680
ds_read_b64_tr_b16 a[90:91], v191 offset:36864
v_mfma_f32_16x16x32_bf16 v[104:107], a[64:67], a[224:227], v[104:107]
s_add_u32 s64, s85, 573440
ds_read_b64_tr_b16 a[92:93], v191 offset:40960
v_mfma_f32_16x16x32_bf16 v[72:75], a[64:67], a[216:219], v[72:75]
buffer_load_dwordx4 v12, s[40:43], s64 offen lds
v_mfma_f32_16x16x32_bf16 v[72:75], a[68:71], a[220:223], v[72:75]
s_add_u32 m0, s86, 72704
ds_read_b64_tr_b16 a[94:95], v191 offset:45056
v_mfma_f32_16x16x32_bf16 v[40:43], a[68:71], a[212:215], v[40:43]
s_add_u32 s64, s85, 581632
ds_read_b64_tr_b16 a[96:97], v184 offset:32768
v_mfma_f32_16x16x32_bf16 v[40:43], a[64:67], a[208:211], v[40:43]
s_waitcnt lgkmcnt(5)
buffer_load_dwordx4 v13, s[40:43], s64 offen lds
v_mfma_f32_16x16x32_bf16 v[44:47], a[72:75], a[208:211], v[44:47]
ds_read_b64_tr_b16 a[98:99], v184 offset:36864
v_mfma_f32_16x16x32_bf16 v[44:47], a[76:79], a[212:215], v[44:47]
ds_read_b64_tr_b16 a[100:101], v184 offset:40960
v_mfma_f32_16x16x32_bf16 v[76:79], a[76:79], a[220:223], v[76:79]
s_add_u32 s65, s84, 65536
ds_read_b64_tr_b16 a[102:103], v184 offset:45056
v_mfma_f32_16x16x32_bf16 v[76:79], a[72:75], a[216:219], v[76:79]
buffer_load_dwordx4 a[0:3], v14, s[44:47], s65 offen offset:0 sc1
v_mfma_f32_16x16x32_bf16 v[108:111], a[72:75], a[224:227], v[108:111]
ds_read_b64_tr_b16 a[104:105], v185 offset:32768
v_mfma_f32_16x16x32_bf16 v[108:111], a[76:79], a[228:231], v[108:111]
ds_read_b64_tr_b16 a[106:107], v185 offset:36864
v_mfma_f32_16x16x32_bf16 v[140:143], a[76:79], a[236:239], v[140:143]
buffer_load_dwordx4 a[8:11], v14, s[44:47], s65 offen offset:1024 sc1
v_mfma_f32_16x16x32_bf16 v[140:143], a[72:75], a[232:235], v[140:143]
ds_read_b64_tr_b16 a[108:109], v185 offset:40960
v_mfma_f32_16x16x32_bf16 v[144:147], a[80:83], a[232:235], v[144:147]
ds_read_b64_tr_b16 a[110:111], v185 offset:45056
v_mfma_f32_16x16x32_bf16 v[144:147], a[84:87], a[236:239], v[144:147]
v_mfma_f32_16x16x32_bf16 v[112:115], a[84:87], a[228:231], v[112:115]
buffer_load_dwordx4 a[16:19], v15, s[44:47], s65 offen offset:0 sc1
v_mfma_f32_16x16x32_bf16 v[112:115], a[80:83], a[224:227], v[112:115]
ds_read_b64_tr_b16 a[112:113], v186 offset:32768
v_mfma_f32_16x16x32_bf16 v[80:83], a[80:83], a[216:219], v[80:83]
ds_read_b64_tr_b16 a[114:115], v186 offset:36864
v_mfma_f32_16x16x32_bf16 v[80:83], a[84:87], a[220:223], v[80:83]
buffer_load_dwordx4 a[24:27], v15, s[44:47], s65 offen offset:1024 sc1
v_mfma_f32_16x16x32_bf16 v[48:51], a[84:87], a[212:215], v[48:51]
ds_read_b64_tr_b16 a[116:117], v186 offset:40960
v_mfma_f32_16x16x32_bf16 v[48:51], a[80:83], a[208:211], v[48:51]
s_waitcnt lgkmcnt(4)
ds_read_b64_tr_b16 a[118:119], v186 offset:45056
v_mfma_f32_16x16x32_bf16 v[52:55], a[88:91], a[208:211], v[52:55]
s_add_u32 s65, s84, 73728
v_mfma_f32_16x16x32_bf16 v[52:55], a[92:95], a[212:215], v[52:55]
buffer_load_dwordx4 a[4:7], v14, s[44:47], s65 offen offset:0 sc1
v_mfma_f32_16x16x32_bf16 v[84:87], a[92:95], a[220:223], v[84:87]
ds_read_b64_tr_b16 a[120:121], v187 offset:32768
v_mfma_f32_16x16x32_bf16 v[84:87], a[88:91], a[216:219], v[84:87]
ds_read_b64_tr_b16 a[122:123], v187 offset:36864
v_mfma_f32_16x16x32_bf16 v[116:119], a[88:91], a[224:227], v[116:119]
buffer_load_dwordx4 a[12:15], v14, s[44:47], s65 offen offset:1024 sc1
v_mfma_f32_16x16x32_bf16 v[116:119], a[92:95], a[228:231], v[116:119]
ds_read_b64_tr_b16 a[124:125], v187 offset:40960
v_mfma_f32_16x16x32_bf16 v[148:151], a[92:95], a[236:239], v[148:151]
ds_read_b64_tr_b16 a[126:127], v187 offset:45056
v_mfma_f32_16x16x32_bf16 v[148:151], a[88:91], a[232:235], v[148:151]
v_mfma_f32_16x16x32_bf16 v[120:123], a[96:99], a[232:235], v[120:123]
buffer_load_dwordx4 a[20:23], v15, s[44:47], s65 offen offset:0 sc1
v_mfma_f32_16x16x32_bf16 v[120:123], a[100:103], a[236:239], v[120:123]
v_mfma_f32_16x16x32_bf16 v[88:91], a[100:103], a[228:231], v[88:91]
v_mfma_f32_16x16x32_bf16 v[88:91], a[96:99], a[224:227], v[88:91]
buffer_load_dwordx4 a[28:31], v15, s[44:47], s65 offen offset:1024 sc1
v_mfma_f32_16x16x32_bf16 v[56:59], a[96:99], a[216:219], v[56:59]
v_mfma_f32_16x16x32_bf16 v[56:59], a[100:103], a[220:223], v[56:59]
v_mfma_f32_16x16x32_bf16 v[24:27], a[100:103], a[212:215], v[24:27]
v_mfma_f32_16x16x32_bf16 v[24:27], a[96:99], a[208:211], v[24:27]
v_mfma_f32_16x16x32_bf16 v[28:31], a[104:107], a[208:211], v[28:31]
s_waitcnt vmcnt(24)
s_barrier
s_waitcnt lgkmcnt(0)
v_mfma_f32_16x16x32_bf16 v[28:31], a[108:111], a[212:215], v[28:31]
s_add_u32 m0, s86, 98304
ds_read_b64_tr_b16 a[64:65], v196 offset:0
v_mfma_f32_16x16x32_bf16 v[60:63], a[108:111], a[220:223], v[60:63]
s_add_u32 s64, s85, 786432
ds_read_b64_tr_b16 a[66:67], v196 offset:4096
v_mfma_f32_16x16x32_bf16 v[60:63], a[104:107], a[216:219], v[60:63]
buffer_load_dwordx4 v12, s[40:43], s64 offen lds
v_mfma_f32_16x16x32_bf16 v[92:95], a[104:107], a[224:227], v[92:95]
ds_read_b64_tr_b16 a[68:69], v196 offset:8192
v_mfma_f32_16x16x32_bf16 v[92:95], a[108:111], a[228:231], v[92:95]
s_add_u32 m0, s86, 99328
ds_read_b64_tr_b16 a[70:71], v196 offset:12288
v_mfma_f32_16x16x32_bf16 v[124:127], a[108:111], a[236:239], v[124:127]
s_add_u32 s64, s85, 794624
ds_read_b64_tr_b16 a[72:73], v197 offset:0
v_mfma_f32_16x16x32_bf16 v[124:127], a[104:107], a[232:235], v[124:127]
buffer_load_dwordx4 v13, s[40:43], s64 offen lds
v_mfma_f32_16x16x32_bf16 v[128:131], a[112:115], a[232:235], v[128:131]
ds_read_b64_tr_b16 a[74:75], v197 offset:4096
v_mfma_f32_16x16x32_bf16 v[128:131], a[116:119], a[236:239], v[128:131]
s_add_u32 m0, s86, 100352
ds_read_b64_tr_b16 a[76:77], v197 offset:8192
v_mfma_f32_16x16x32_bf16 v[96:99], a[116:119], a[228:231], v[96:99]
s_add_u32 s64, s85, 802816
ds_read_b64_tr_b16 a[78:79], v197 offset:12288
v_mfma_f32_16x16x32_bf16 v[96:99], a[112:115], a[224:227], v[96:99]
buffer_load_dwordx4 v12, s[40:43], s64 offen lds
v_mfma_f32_16x16x32_bf16 v[64:67], a[112:115], a[216:219], v[64:67]
ds_read_b64_tr_b16 a[80:81], v198 offset:0
v_mfma_f32_16x16x32_bf16 v[64:67], a[116:119], a[220:223], v[64:67]
s_add_u32 m0, s86, 101376
ds_read_b64_tr_b16 a[82:83], v198 offset:4096
v_mfma_f32_16x16x32_bf16 v[32:35], a[116:119], a[212:215], v[32:35]
s_add_u32 s64, s85, 811008
ds_read_b64_tr_b16 a[84:85], v198 offset:8192
v_mfma_f32_16x16x32_bf16 v[32:35], a[112:115], a[208:211], v[32:35]
buffer_load_dwordx4 v13, s[40:43], s64 offen lds
v_mfma_f32_16x16x32_bf16 v[36:39], a[120:123], a[208:211], v[36:39]
ds_read_b64_tr_b16 a[86:87], v198 offset:12288
v_mfma_f32_16x16x32_bf16 v[36:39], a[124:127], a[212:215], v[36:39]
s_add_u32 m0, s86, 102400
v_mfma_f32_16x16x32_bf16 v[68:71], a[124:127], a[220:223], v[68:71]
s_add_u32 s64, s85, 819200
v_mfma_f32_16x16x32_bf16 v[68:71], a[120:123], a[216:219], v[68:71]
buffer_load_dwordx4 v12, s[40:43], s64 offen lds
v_mfma_f32_16x16x32_bf16 v[100:103], a[120:123], a[224:227], v[100:103]
v_mfma_f32_16x16x32_bf16 v[100:103], a[124:127], a[228:231], v[100:103]
v_mfma_f32_16x16x32_bf16 v[132:135], a[124:127], a[236:239], v[132:135]
v_mfma_f32_16x16x32_bf16 v[132:135], a[120:123], a[232:235], v[132:135]
s_waitcnt vmcnt(25)
s_waitcnt lgkmcnt(1)
s_add_u32 m0, s86, 103424
v_mfma_f32_16x16x32_bf16 v[136:139], a[64:67], v[176:179], v[136:139]
s_waitcnt vmcnt(21)
s_add_u32 s64, s85, 827392
ds_read_b64_tr_b16 a[88:89], v199 offset:0
v_mfma_f32_16x16x32_bf16 v[136:139], a[68:71], v[180:183], v[136:139]
buffer_load_dwordx4 v13, s[40:43], s64 offen lds
v_mfma_f32_16x16x32_bf16 v[104:107], a[68:71], v[172:175], v[104:107]
s_add_u32 m0, s86, 104448
ds_read_b64_tr_b16 a[90:91], v199 offset:4096
v_mfma_f32_16x16x32_bf16 v[104:107], a[64:67], v[168:171], v[104:107]
s_add_u32 s64, s85, 835584
ds_read_b64_tr_b16 a[92:93], v199 offset:8192
v_mfma_f32_16x16x32_bf16 v[72:75], a[64:67], v[160:163], v[72:75]
buffer_load_dwordx4 v12, s[40:43], s64 offen lds
v_mfma_f32_16x16x32_bf16 v[72:75], a[68:71], v[164:167], v[72:75]
s_add_u32 m0, s86, 105472
ds_read_b64_tr_b16 a[94:95], v199 offset:12288
v_mfma_f32_16x16x32_bf16 v[40:43], a[68:71], v[156:159], v[40:43]
s_add_u32 s64, s85, 843776
ds_read_b64_tr_b16 a[96:97], v192 offset:0
v_mfma_f32_16x16x32_bf16 v[40:43], a[64:67], v[152:155], v[40:43]
buffer_load_dwordx4 v13, s[40:43], s64 offen lds
v_mfma_f32_16x16x32_bf16 v[44:47], a[72:75], v[152:155], v[44:47]
ds_read_b64_tr_b16 a[98:99], v192 offset:4096
v_mfma_f32_16x16x32_bf16 v[44:47], a[76:79], v[156:159], v[44:47]
ds_read_b64_tr_b16 a[100:101], v192 offset:8192
v_mfma_f32_16x16x32_bf16 v[76:79], a[76:79], v[164:167], v[76:79]
s_add_u32 s65, s84, 98304
ds_read_b64_tr_b16 a[102:103], v192 offset:12288
v_mfma_f32_16x16x32_bf16 v[76:79], a[72:75], v[160:163], v[76:79]
buffer_load_dwordx4 a[32:35], v14, s[44:47], s65 offen offset:0 sc1
v_mfma_f32_16x16x32_bf16 v[108:111], a[72:75], v[168:171], v[108:111]
ds_read_b64_tr_b16 a[104:105], v193 offset:0
v_mfma_f32_16x16x32_bf16 v[108:111], a[76:79], v[172:175], v[108:111]
ds_read_b64_tr_b16 a[106:107], v193 offset:4096
v_mfma_f32_16x16x32_bf16 v[140:143], a[76:79], v[180:183], v[140:143]
buffer_load_dwordx4 a[40:43], v14, s[44:47], s65 offen offset:1024 sc1
v_mfma_f32_16x16x32_bf16 v[140:143], a[72:75], v[176:179], v[140:143]
ds_read_b64_tr_b16 a[108:109], v193 offset:8192
v_mfma_f32_16x16x32_bf16 v[144:147], a[80:83], v[176:179], v[144:147]
s_waitcnt lgkmcnt(5)
ds_read_b64_tr_b16 a[110:111], v193 offset:12288
v_mfma_f32_16x16x32_bf16 v[144:147], a[84:87], v[180:183], v[144:147]
v_mfma_f32_16x16x32_bf16 v[112:115], a[84:87], v[172:175], v[112:115]
buffer_load_dwordx4 a[48:51], v15, s[44:47], s65 offen offset:0 sc1
v_mfma_f32_16x16x32_bf16 v[112:115], a[80:83], v[168:171], v[112:115]
ds_read_b64_tr_b16 a[112:113], v194 offset:0
v_mfma_f32_16x16x32_bf16 v[80:83], a[80:83], v[160:163], v[80:83]
ds_read_b64_tr_b16 a[114:115], v194 offset:4096
v_mfma_f32_16x16x32_bf16 v[80:83], a[84:87], v[164:167], v[80:83]
buffer_load_dwordx4 a[56:59], v15, s[44:47], s65 offen offset:1024 sc1
v_mfma_f32_16x16x32_bf16 v[48:51], a[84:87], v[156:159], v[48:51]
ds_read_b64_tr_b16 a[116:117], v194 offset:8192
v_mfma_f32_16x16x32_bf16 v[48:51], a[80:83], v[152:155], v[48:51]
ds_read_b64_tr_b16 a[118:119], v194 offset:12288
v_mfma_f32_16x16x32_bf16 v[52:55], a[88:91], v[152:155], v[52:55]
s_add_u32 s65, s84, 106496
v_mfma_f32_16x16x32_bf16 v[52:55], a[92:95], v[156:159], v[52:55]
buffer_load_dwordx4 a[36:39], v14, s[44:47], s65 offen offset:0 sc1
v_mfma_f32_16x16x32_bf16 v[84:87], a[92:95], v[164:167], v[84:87]
ds_read_b64_tr_b16 a[120:121], v195 offset:0
v_mfma_f32_16x16x32_bf16 v[84:87], a[88:91], v[160:163], v[84:87]
ds_read_b64_tr_b16 a[122:123], v195 offset:4096
v_mfma_f32_16x16x32_bf16 v[116:119], a[88:91], v[168:171], v[116:119]
buffer_load_dwordx4 a[44:47], v14, s[44:47], s65 offen offset:1024 sc1
v_mfma_f32_16x16x32_bf16 v[116:119], a[92:95], v[172:175], v[116:119]
ds_read_b64_tr_b16 a[124:125], v195 offset:8192
v_mfma_f32_16x16x32_bf16 v[148:151], a[92:95], v[180:183], v[148:151]
ds_read_b64_tr_b16 a[126:127], v195 offset:12288
v_mfma_f32_16x16x32_bf16 v[148:151], a[88:91], v[176:179], v[148:151]
v_mfma_f32_16x16x32_bf16 v[120:123], a[96:99], v[176:179], v[120:123]
s_waitcnt lgkmcnt(4)
buffer_load_dwordx4 a[52:55], v15, s[44:47], s65 offen offset:0 sc1
v_mfma_f32_16x16x32_bf16 v[120:123], a[100:103], v[180:183], v[120:123]
v_mfma_f32_16x16x32_bf16 v[88:91], a[100:103], v[172:175], v[88:91]
v_mfma_f32_16x16x32_bf16 v[88:91], a[96:99], v[168:171], v[88:91]
buffer_load_dwordx4 a[60:63], v15, s[44:47], s65 offen offset:1024 sc1
v_mfma_f32_16x16x32_bf16 v[56:59], a[96:99], v[160:163], v[56:59]
v_mfma_f32_16x16x32_bf16 v[56:59], a[100:103], v[164:167], v[56:59]
v_mfma_f32_16x16x32_bf16 v[24:27], a[100:103], v[156:159], v[24:27]
v_mfma_f32_16x16x32_bf16 v[24:27], a[96:99], v[152:155], v[24:27]
v_mfma_f32_16x16x32_bf16 v[28:31], a[104:107], v[152:155], v[28:31]
s_waitcnt vmcnt(24)
s_barrier
v_mfma_f32_16x16x32_bf16 v[28:31], a[108:111], v[156:159], v[28:31]
ds_read_b64_tr_b16 a[64:65], v196 offset:32768
v_mfma_f32_16x16x32_bf16 v[60:63], a[108:111], v[164:167], v[60:63]
ds_read_b64_tr_b16 a[66:67], v196 offset:36864
v_mfma_f32_16x16x32_bf16 v[60:63], a[104:107], v[160:163], v[60:63]
ds_read_b64_tr_b16 a[68:69], v196 offset:40960
v_mfma_f32_16x16x32_bf16 v[92:95], a[104:107], v[168:171], v[92:95]
s_xor_b32 s66, s2, 1
s_lshl2_add_u32 s66, s66, s30
ds_read_b64_tr_b16 a[70:71], v196 offset:45056
v_mfma_f32_16x16x32_bf16 v[92:95], a[108:111], v[172:175], v[92:95]
s_lshl_b32 s73, s66, 12
s_add_u32 s73, s73, 67108864
ds_read_b64_tr_b16 a[72:73], v197 offset:32768
v_mfma_f32_16x16x32_bf16 v[124:127], a[108:111], v[180:183], v[124:127]
s_lshl2_add_u32 s66, s2, s30
s_lshl_b32 s75, s66, 12
ds_read_b64_tr_b16 a[74:75], v197 offset:36864
v_mfma_f32_16x16x32_bf16 v[124:127], a[104:107], v[176:179], v[124:127]
s_add_u32 s75, s75, 67108864
s_lshl_b32 s77, s82, 18
ds_read_b64_tr_b16 a[76:77], v197 offset:40960
v_mfma_f32_16x16x32_bf16 v[128:131], a[112:115], v[176:179], v[128:131]
s_lshl_b32 s66, s30, 16
s_add_u32 s77, s77, s66
ds_read_b64_tr_b16 a[78:79], v197 offset:45056
v_mfma_f32_16x16x32_bf16 v[128:131], a[116:119], v[180:183], v[128:131]
s_add_u32 s77, s77, s87
s_lshl_b32 s66, s83, 7
ds_read_b64_tr_b16 a[80:81], v198 offset:32768
v_mfma_f32_16x16x32_bf16 v[96:99], a[116:119], v[172:175], v[96:99]
s_add_u32 s77, s77, s66
ds_read_b64_tr_b16 a[82:83], v198 offset:36864
v_lshlrev_b32 v1, 24, v0
v_mfma_f32_16x16x32_bf16 v[96:99], a[112:115], v[168:171], v[96:99]
ds_read_b64_tr_b16 a[84:85], v198 offset:40960
v_and_b32 v8, 7, v0
v_mfma_f32_16x16x32_bf16 v[64:67], a[112:115], v[160:163], v[64:67]
ds_read_b64_tr_b16 a[86:87], v198 offset:45056
v_lshlrev_b32 v8, 11, v8
v_mfma_f32_16x16x32_bf16 v[64:67], a[116:119], v[164:167], v[64:67]
v_bfe_u32 v10, v0, 3, 1
v_lshl_add_u32 v8, v10, 6, v8
v_mfma_f32_16x16x32_bf16 v[32:35], a[116:119], v[156:159], v[32:35]
v_bfe_u32 v10, v0, 4, 1
v_lshl_add_u32 v8, v10, 5, v8
v_mfma_f32_16x16x32_bf16 v[32:35], a[112:115], v[152:155], v[32:35]
s_waitcnt lgkmcnt(5)
v_lshrrev_b32 v10, 5, v0
v_lshl_add_u32 v8, v10, 4, v8
v_mfma_f32_16x16x32_bf16 v[36:39], a[120:123], v[152:155], v[36:39]
v_add_u32 v2, s86, v16
v_xor_b32 v3, 0x2000, v2
v_mfma_f32_16x16x32_bf16 v[36:39], a[124:127], v[156:159], v[36:39]
v_mov_b32 v232, 0
v_mov_b32 v233, 0
v_mfma_f32_16x16x32_bf16 v[68:71], a[124:127], v[164:167], v[68:71]
v_mov_b32 v236, 0
v_mov_b32 v237, 0
v_mfma_f32_16x16x32_bf16 v[68:71], a[120:123], v[160:163], v[68:71]
v_and_b32 v9, 1, v0
v_lshlrev_b32 v9, 4, v9
v_mfma_f32_16x16x32_bf16 v[100:103], a[120:123], v[168:171], v[100:103]
v_mov_b32 v10, 0x3f80
v_lshlrev_b32 v9, v9, v10
v_mfma_f32_16x16x32_bf16 v[100:103], a[124:127], v[172:175], v[100:103]
v_lshrrev_b32 v10, 4, v0
v_lshlrev_b32 v10, 1, v10
v_mfma_f32_16x16x32_bf16 v[132:135], a[124:127], v[180:183], v[132:135]
v_bfe_u32 v11, v0, 1, 3
v_xor_b32 v10, v10, v11
v_mfma_f32_16x16x32_bf16 v[132:135], a[120:123], v[176:179], v[132:135]
s_waitcnt vmcnt(20)
v_subrev_u32 v11, 1, v10
v_ashrrev_i32 v11, 31, v11
v_mfma_f32_16x16x32_bf16 v[136:139], a[64:67], a[24:27], v[136:139]
s_waitcnt vmcnt(16)
ds_read_b64_tr_b16 a[88:89], v199 offset:32768
v_and_b32 v234, v11, v9
v_mfma_f32_16x16x32_bf16 v[136:139], a[68:71], a[28:31], v[136:139]
ds_read_b64_tr_b16 a[90:91], v199 offset:36864
v_xor_b32 v10, 1, v10
v_mfma_f32_16x16x32_bf16 v[104:107], a[68:71], a[20:23], v[104:107]
ds_read_b64_tr_b16 a[92:93], v199 offset:40960
v_subrev_u32 v11, 1, v10
v_mfma_f32_16x16x32_bf16 v[104:107], a[64:67], a[16:19], v[104:107]
ds_read_b64_tr_b16 a[94:95], v199 offset:45056
v_ashrrev_i32 v11, 31, v11
v_mfma_f32_16x16x32_bf16 v[72:75], a[64:67], a[8:11], v[72:75]
v_and_b32 v235, v11, v9
v_mfma_f32_16x16x32_bf16 v[72:75], a[68:71], a[12:15], v[72:75]
s_mov_b32 s48, s24
s_mov_b32 s49, s25
s_mov_b32 s50, 4194304
v_mfma_f32_16x16x32_bf16 v[40:43], a[68:71], a[4:7], v[40:43]
s_mov_b32 s51, 0x20000
s_waitcnt vmcnt(8)
s_barrier
v_mfma_f32_16x16x32_bf16 v[40:43], a[64:67], a[0:3], v[40:43]
ds_read_b64_tr_b16 a[96:97], v188 offset:0
v_mfma_f32_16x16x32_bf16 v[44:47], a[72:75], a[0:3], v[44:47]
s_waitcnt lgkmcnt(4)
ds_read_b64_tr_b16 a[98:99], v188 offset:4096
v_mfma_f32_16x16x32_bf16 v[44:47], a[76:79], a[4:7], v[44:47]
ds_read_b64_tr_b16 a[100:101], v188 offset:8192
v_mfma_f32_16x16x32_bf16 v[76:79], a[76:79], a[12:15], v[76:79]
ds_read_b64_tr_b16 a[102:103], v188 offset:12288
v_mfma_f32_16x16x32_bf16 v[76:79], a[72:75], a[8:11], v[76:79]
ds_read_b64_tr_b16 a[104:105], v189 offset:0
v_mfma_f32_16x16x32_bf16 v[108:111], a[72:75], a[16:19], v[108:111]
ds_read_b64_tr_b16 a[106:107], v189 offset:4096
v_mfma_f32_16x16x32_bf16 v[108:111], a[76:79], a[20:23], v[108:111]
ds_read_b64_tr_b16 a[108:109], v189 offset:8192
v_mfma_f32_16x16x32_bf16 v[140:143], a[76:79], a[28:31], v[140:143]
ds_read_b64_tr_b16 a[110:111], v189 offset:12288
v_mfma_f32_16x16x32_bf16 v[140:143], a[72:75], a[24:27], v[140:143]
v_mfma_f32_16x16x32_bf16 v[144:147], a[80:83], a[24:27], v[144:147]
v_mfma_f32_16x16x32_bf16 v[144:147], a[84:87], a[28:31], v[144:147]
v_mfma_f32_16x16x32_bf16 v[112:115], a[84:87], a[20:23], v[112:115]
ds_read_b64_tr_b16 a[112:113], v190 offset:0
v_mfma_f32_16x16x32_bf16 v[112:115], a[80:83], a[16:19], v[112:115]
ds_read_b64_tr_b16 a[114:115], v190 offset:4096
v_mfma_f32_16x16x32_bf16 v[80:83], a[80:83], a[8:11], v[80:83]
ds_read_b64_tr_b16 a[116:117], v190 offset:8192
v_mfma_f32_16x16x32_bf16 v[80:83], a[84:87], a[12:15], v[80:83]
ds_read_b64_tr_b16 a[118:119], v190 offset:12288
v_mfma_f32_16x16x32_bf16 v[48:51], a[84:87], a[4:7], v[48:51]
v_mfma_f32_16x16x32_bf16 v[48:51], a[80:83], a[0:3], v[48:51]
s_waitcnt lgkmcnt(4)
v_mfma_f32_16x16x32_bf16 v[52:55], a[88:91], a[0:3], v[52:55]
v_mfma_f32_16x16x32_bf16 v[52:55], a[92:95], a[4:7], v[52:55]
v_mfma_f32_16x16x32_bf16 v[84:87], a[92:95], a[12:15], v[84:87]
ds_read_b64_tr_b16 a[120:121], v191 offset:0
v_mfma_f32_16x16x32_bf16 v[84:87], a[88:91], a[8:11], v[84:87]
ds_read_b64_tr_b16 a[122:123], v191 offset:4096
v_mfma_f32_16x16x32_bf16 v[116:119], a[88:91], a[16:19], v[116:119]
ds_read_b64_tr_b16 a[124:125], v191 offset:8192
v_mfma_f32_16x16x32_bf16 v[116:119], a[92:95], a[20:23], v[116:119]
ds_read_b64_tr_b16 a[126:127], v191 offset:12288
v_mfma_f32_16x16x32_bf16 v[148:151], a[92:95], a[28:31], v[148:151]
v_mfma_f32_16x16x32_bf16 v[148:151], a[88:91], a[24:27], v[148:151]
s_waitcnt vmcnt(4)
v_mfma_f32_16x16x32_bf16 v[136:139], a[96:99], a[56:59], v[136:139]
s_waitcnt vmcnt(0)
v_mfma_f32_16x16x32_bf16 v[136:139], a[100:103], a[60:63], v[136:139]
v_mfma_f32_16x16x32_bf16 v[104:107], a[100:103], a[52:55], v[104:107]
ds_read_b64_tr_b16 a[64:65], v192 offset:32768
v_mfma_f32_16x16x32_bf16 v[104:107], a[96:99], a[48:51], v[104:107]
ds_read_b64_tr_b16 a[66:67], v192 offset:36864
v_mfma_f32_16x16x32_bf16 v[72:75], a[96:99], a[40:43], v[72:75]
ds_read_b64_tr_b16 a[68:69], v192 offset:40960
v_mfma_f32_16x16x32_bf16 v[72:75], a[100:103], a[44:47], v[72:75]
ds_read_b64_tr_b16 a[70:71], v192 offset:45056
v_mfma_f32_16x16x32_bf16 v[40:43], a[100:103], a[36:39], v[40:43]
v_mfma_f32_16x16x32_bf16 v[40:43], a[96:99], a[32:35], v[40:43]
v_mfma_f32_16x16x32_bf16 v[44:47], a[104:107], a[32:35], v[44:47]
ds_write_b128 v3, v[136:139] offset:4096
v_mfma_f32_16x16x32_bf16 v[44:47], a[108:111], a[36:39], v[44:47]
v_mfma_f32_16x16x32_bf16 v[76:79], a[108:111], a[44:47], v[76:79]
ds_write_b128 v3, v[104:107] offset:0
v_mfma_f32_16x16x32_bf16 v[76:79], a[104:107], a[40:43], v[76:79]
ds_read_b64_tr_b16 a[72:73], v193 offset:32768
v_mfma_f32_16x16x32_bf16 v[108:111], a[104:107], a[48:51], v[108:111]
ds_read_b64_tr_b16 a[74:75], v193 offset:36864
v_mfma_f32_16x16x32_bf16 v[108:111], a[108:111], a[52:55], v[108:111]
ds_read_b64_tr_b16 a[76:77], v193 offset:40960
v_mfma_f32_16x16x32_bf16 v[140:143], a[108:111], a[60:63], v[140:143]
ds_read_b64_tr_b16 a[78:79], v193 offset:45056
v_mfma_f32_16x16x32_bf16 v[140:143], a[104:107], a[56:59], v[140:143]
s_waitcnt lgkmcnt(6)
v_mfma_f32_16x16x32_bf16 v[144:147], a[112:115], a[56:59], v[144:147]
v_mfma_f32_16x16x32_bf16 v[144:147], a[116:119], a[60:63], v[144:147]
v_mfma_f32_16x16x32_bf16 v[112:115], a[116:119], a[52:55], v[112:115]
ds_read_b64_tr_b16 a[80:81], v194 offset:32768
v_mfma_f32_16x16x32_bf16 v[112:115], a[112:115], a[48:51], v[112:115]
ds_read_b64_tr_b16 a[82:83], v194 offset:36864
v_mfma_f32_16x16x32_bf16 v[80:83], a[112:115], a[40:43], v[80:83]
ds_write_b128 v3, v[108:111] offset:1024
v_mfma_f32_16x16x32_bf16 v[80:83], a[116:119], a[44:47], v[80:83]
ds_read_b64_tr_b16 a[84:85], v194 offset:40960
v_mfma_f32_16x16x32_bf16 v[48:51], a[116:119], a[36:39], v[48:51]
ds_write_b128 v3, v[140:143] offset:5120
v_mfma_f32_16x16x32_bf16 v[48:51], a[112:115], a[32:35], v[48:51]
ds_read_b64_tr_b16 a[86:87], v194 offset:45056
v_mfma_f32_16x16x32_bf16 v[52:55], a[120:123], a[32:35], v[52:55]
ds_write_b128 v3, v[144:147] offset:6144
v_mfma_f32_16x16x32_bf16 v[52:55], a[124:127], a[36:39], v[52:55]
v_mfma_f32_16x16x32_bf16 v[84:87], a[124:127], a[44:47], v[84:87]
ds_write_b128 v3, v[112:115] offset:2048
v_mfma_f32_16x16x32_bf16 v[84:87], a[120:123], a[40:43], v[84:87]
ds_read_b64_tr_b16 a[88:89], v195 offset:32768
v_mfma_f32_16x16x32_bf16 v[116:119], a[120:123], a[48:51], v[116:119]
ds_read_b64_tr_b16 a[90:91], v195 offset:36864
v_mfma_f32_16x16x32_bf16 v[116:119], a[124:127], a[52:55], v[116:119]
ds_read_b64_tr_b16 a[92:93], v195 offset:40960
v_mfma_f32_16x16x32_bf16 v[148:151], a[124:127], a[60:63], v[148:151]
ds_read_b64_tr_b16 a[94:95], v195 offset:45056
v_mfma_f32_16x16x32_bf16 v[148:151], a[120:123], a[56:59], v[148:151]
v_mfma_f32_16x16x32_bf16 v[120:123], a[64:67], a[24:27], v[120:123]
v_mfma_f32_16x16x32_bf16 v[120:123], a[68:71], a[28:31], v[120:123]
v_mfma_f32_16x16x32_bf16 v[88:91], a[68:71], a[20:23], v[88:91]
ds_read_b64_tr_b16 a[96:97], v184 offset:0
v_mfma_f32_16x16x32_bf16 v[88:91], a[64:67], a[16:19], v[88:91]
ds_read_b64_tr_b16 a[98:99], v184 offset:4096
v_mfma_f32_16x16x32_bf16 v[56:59], a[64:67], a[8:11], v[56:59]
ds_write_b128 v3, v[116:119] offset:3072
v_mfma_f32_16x16x32_bf16 v[56:59], a[68:71], a[12:15], v[56:59]
ds_read_b64_tr_b16 a[100:101], v184 offset:8192
v_mfma_f32_16x16x32_bf16 v[24:27], a[68:71], a[4:7], v[24:27]
ds_write_b128 v3, v[148:151] offset:7168
v_mfma_f32_16x16x32_bf16 v[24:27], a[64:67], a[0:3], v[24:27]
s_waitcnt lgkmcnt(5)
ds_read_b64_tr_b16 a[102:103], v184 offset:12288
v_mfma_f32_16x16x32_bf16 v[28:31], a[72:75], a[0:3], v[28:31]
v_mfma_f32_16x16x32_bf16 v[28:31], a[76:79], a[4:7], v[28:31]
s_waitcnt lgkmcnt(0)
s_barrier
v_mfma_f32_16x16x32_bf16 v[60:63], a[76:79], a[12:15], v[60:63]
ds_read_b128 v[200:203], v2 offset:0
ds_read_b128 v[204:207], v2 offset:1024
v_mfma_f32_16x16x32_bf16 v[60:63], a[72:75], a[8:11], v[60:63]
ds_read_b128 v[208:211], v2 offset:2048
ds_read_b128 v[212:215], v2 offset:3072
v_mfma_f32_16x16x32_bf16 v[92:95], a[72:75], a[16:19], v[92:95]
ds_read_b128 v[216:219], v2 offset:4096
ds_read_b128 v[220:223], v2 offset:5120
v_mfma_f32_16x16x32_bf16 v[92:95], a[76:79], a[20:23], v[92:95]
ds_read_b128 v[224:227], v2 offset:6144
ds_read_b128 v[228:231], v2 offset:7168
v_mfma_f32_16x16x32_bf16 v[124:127], a[76:79], a[28:31], v[124:127]
ds_read_b64_tr_b16 a[104:105], v185 offset:0
v_mfma_f32_16x16x32_bf16 v[124:127], a[72:75], a[24:27], v[124:127]
ds_read_b64_tr_b16 a[106:107], v185 offset:4096
v_mfma_f32_16x16x32_bf16 v[128:131], a[80:83], a[24:27], v[128:131]
ds_read_b64_tr_b16 a[108:109], v185 offset:8192
v_mfma_f32_16x16x32_bf16 v[128:131], a[84:87], a[28:31], v[128:131]
ds_read_b64_tr_b16 a[110:111], v185 offset:12288
v_mfma_f32_16x16x32_bf16 v[96:99], a[84:87], a[20:23], v[96:99]
s_waitcnt lgkmcnt(10)
ds_read_b64_tr_b16 a[112:113], v186 offset:0
v_add_f32 v200, v200, v40
v_mfma_f32_16x16x32_bf16 v[96:99], a[80:83], a[16:19], v[96:99]
ds_read_b64_tr_b16 a[114:115], v186 offset:4096
v_add_f32 v201, v201, v41
v_mfma_f32_16x16x32_bf16 v[64:67], a[80:83], a[8:11], v[64:67]
ds_read_b64_tr_b16 a[116:117], v186 offset:8192
v_add_f32 v202, v202, v42
v_mfma_f32_16x16x32_bf16 v[64:67], a[84:87], a[12:15], v[64:67]
ds_read_b64_tr_b16 a[118:119], v186 offset:12288
v_add_f32 v203, v203, v43
v_mfma_f32_16x16x32_bf16 v[32:35], a[84:87], a[4:7], v[32:35]
v_add_f32 v204, v204, v44
v_add_f32 v205, v205, v45
v_mfma_f32_16x16x32_bf16 v[32:35], a[80:83], a[0:3], v[32:35]
v_add_f32 v206, v206, v46
v_add_f32 v207, v207, v47
v_mfma_f32_16x16x32_bf16 v[36:39], a[88:91], a[0:3], v[36:39]
v_cvt_pk_bf16_f32 v200, v200, v201
v_cvt_pk_bf16_f32 v201, v202, v203
v_mfma_f32_16x16x32_bf16 v[36:39], a[92:95], a[4:7], v[36:39]
v_cvt_pk_bf16_f32 v202, v204, v205
v_cvt_pk_bf16_f32 v203, v206, v207
v_mfma_f32_16x16x32_bf16 v[68:71], a[92:95], a[12:15], v[68:71]
buffer_store_dwordx4 v[200:203], v16, s[44:47], s73 offen offset:0 sc1
v_mfma_f32_16x16x32_bf16 v[68:71], a[88:91], a[8:11], v[68:71]
s_waitcnt lgkmcnt(2)
ds_read_b64_tr_b16 a[120:121], v187 offset:0
v_add_f32 v208, v208, v48
v_mfma_f32_16x16x32_bf16 v[100:103], a[88:91], a[16:19], v[100:103]
ds_read_b64_tr_b16 a[122:123], v187 offset:4096
v_add_f32 v209, v209, v49
v_mfma_f32_16x16x32_bf16 v[100:103], a[92:95], a[20:23], v[100:103]
ds_read_b64_tr_b16 a[124:125], v187 offset:8192
v_add_f32 v210, v210, v50
v_mfma_f32_16x16x32_bf16 v[132:135], a[92:95], a[28:31], v[132:135]
ds_read_b64_tr_b16 a[126:127], v187 offset:12288
v_add_f32 v211, v211, v51
v_mfma_f32_16x16x32_bf16 v[132:135], a[88:91], a[24:27], v[132:135]
v_add_f32 v212, v212, v52
v_add_f32 v213, v213, v53
v_mfma_f32_16x16x32_bf16 v[120:123], a[96:99], a[56:59], v[120:123]
v_add_f32 v214, v214, v54
v_add_f32 v215, v215, v55
v_mfma_f32_16x16x32_bf16 v[120:123], a[100:103], a[60:63], v[120:123]
v_cvt_pk_bf16_f32 v208, v208, v209
v_cvt_pk_bf16_f32 v209, v210, v211
v_cvt_pk_bf16_f32 v210, v212, v213
v_cvt_pk_bf16_f32 v211, v214, v215
v_mfma_f32_16x16x32_bf16 v[88:91], a[100:103], a[52:55], v[88:91]
buffer_store_dwordx4 v[208:211], v16, s[44:47], s73 offen offset:1024 sc1
v_mfma_f32_16x16x32_bf16 v[88:91], a[96:99], a[48:51], v[88:91]
v_add_f32 v216, v216, v72
v_add_f32 v217, v217, v73
v_mfma_f32_16x16x32_bf16 v[56:59], a[96:99], a[40:43], v[56:59]
v_add_f32 v218, v218, v74
v_add_f32 v219, v219, v75
v_mfma_f32_16x16x32_bf16 v[56:59], a[100:103], a[44:47], v[56:59]
v_add_f32 v220, v220, v76
v_add_f32 v221, v221, v77
v_mfma_f32_16x16x32_bf16 v[24:27], a[100:103], a[36:39], v[24:27]
v_add_f32 v222, v222, v78
v_add_f32 v223, v223, v79
v_mfma_f32_16x16x32_bf16 v[24:27], a[96:99], a[32:35], v[24:27]
v_cvt_pk_bf16_f32 v216, v216, v217
v_cvt_pk_bf16_f32 v217, v218, v219
v_mfma_f32_16x16x32_bf16 v[28:31], a[104:107], a[32:35], v[28:31]
v_cvt_pk_bf16_f32 v218, v220, v221
v_cvt_pk_bf16_f32 v219, v222, v223
v_mfma_f32_16x16x32_bf16 v[28:31], a[108:111], a[36:39], v[28:31]
buffer_store_dwordx4 v[216:219], v16, s[44:47], s73 offen offset:2048 sc1
v_mfma_f32_16x16x32_bf16 v[60:63], a[108:111], a[44:47], v[60:63]
v_add_f32 v224, v224, v80
v_add_f32 v225, v225, v81
v_mfma_f32_16x16x32_bf16 v[60:63], a[104:107], a[40:43], v[60:63]
v_add_f32 v226, v226, v82
v_add_f32 v227, v227, v83
v_mfma_f32_16x16x32_bf16 v[92:95], a[104:107], a[48:51], v[92:95]
v_add_f32 v228, v228, v84
v_add_f32 v229, v229, v85
v_mfma_f32_16x16x32_bf16 v[92:95], a[108:111], a[52:55], v[92:95]
v_add_f32 v230, v230, v86
v_add_f32 v231, v231, v87
v_mfma_f32_16x16x32_bf16 v[124:127], a[108:111], a[60:63], v[124:127]
v_cvt_pk_bf16_f32 v224, v224, v225
v_cvt_pk_bf16_f32 v225, v226, v227
v_mfma_f32_16x16x32_bf16 v[124:127], a[104:107], a[56:59], v[124:127]
v_cvt_pk_bf16_f32 v226, v228, v229
v_cvt_pk_bf16_f32 v227, v230, v231
v_mfma_f32_16x16x32_bf16 v[128:131], a[112:115], a[56:59], v[128:131]
s_waitcnt lgkmcnt(0)
buffer_store_dwordx4 v[224:227], v16, s[44:47], s73 offen offset:3072 sc1
v_mfma_f32_16x16x32_bf16 v[128:131], a[116:119], a[60:63], v[128:131]
ds_write_b128 v3, v[120:123] offset:36864
v_mfma_f32_16x16x32_bf16 v[96:99], a[116:119], a[52:55], v[96:99]
ds_write_b128 v3, v[88:91] offset:32768
v_mfma_f32_16x16x32_bf16 v[96:99], a[112:115], a[48:51], v[96:99]
v_mfma_f32_16x16x32_bf16 v[64:67], a[112:115], a[40:43], v[64:67]
ds_write_b128 v3, v[92:95] offset:33792
v_mfma_f32_16x16x32_bf16 v[64:67], a[116:119], a[44:47], v[64:67]
v_mfma_f32_16x16x32_bf16 v[32:35], a[116:119], a[36:39], v[32:35]
ds_write_b128 v3, v[124:127] offset:37888
v_mfma_f32_16x16x32_bf16 v[32:35], a[112:115], a[32:35], v[32:35]
v_mfma_f32_16x16x32_bf16 v[36:39], a[120:123], a[32:35], v[36:39]
ds_write_b128 v3, v[128:131] offset:38912
v_mfma_f32_16x16x32_bf16 v[36:39], a[124:127], a[36:39], v[36:39]
v_mfma_f32_16x16x32_bf16 v[68:71], a[124:127], a[44:47], v[68:71]
ds_write_b128 v3, v[96:99] offset:34816
v_mfma_f32_16x16x32_bf16 v[68:71], a[120:123], a[40:43], v[68:71]
v_mfma_f32_16x16x32_bf16 v[100:103], a[120:123], a[48:51], v[100:103]
v_mfma_f32_16x16x32_bf16 v[100:103], a[124:127], a[52:55], v[100:103]
v_mfma_f32_16x16x32_bf16 v[132:135], a[124:127], a[60:63], v[132:135]
v_mfma_f32_16x16x32_bf16 v[132:135], a[120:123], a[56:59], v[132:135]
buffer_load_dwordx4 v[152:155], v16, s[44:47], s75 offen offset:0 sc1
buffer_load_dwordx4 v[156:159], v16, s[44:47], s75 offen offset:1024 sc1
buffer_load_dwordx4 v[160:163], v16, s[44:47], s75 offen offset:2048 sc1
buffer_load_dwordx4 v[164:167], v16, s[44:47], s75 offen offset:3072 sc1
s_nop 3
ds_write_b128 v3, v[100:103] offset:35840
ds_write_b128 v3, v[132:135] offset:39936
s_mov_b32 s72, 0x4000
s_waitcnt lgkmcnt(0)
s_barrier
ds_read_b128 v[88:91], v2 offset:32768
ds_read_b128 v[92:95], v2 offset:33792
ds_read_b128 v[96:99], v2 offset:34816
ds_read_b128 v[100:103], v2 offset:35840
ds_read_b128 v[120:123], v2 offset:36864
ds_read_b128 v[124:127], v2 offset:37888
ds_read_b128 v[128:131], v2 offset:38912
ds_read_b128 v[132:135], v2 offset:39936
s_waitcnt lgkmcnt(7)
v_add_f32 v24, v24, v88
v_add_f32 v25, v25, v89
v_add_f32 v26, v26, v90
v_add_f32 v27, v27, v91
s_waitcnt lgkmcnt(6)
v_add_f32 v28, v28, v92
v_add_f32 v29, v29, v93
v_add_f32 v30, v30, v94
v_add_f32 v31, v31, v95
s_waitcnt lgkmcnt(5)
v_add_f32 v32, v32, v96
v_add_f32 v33, v33, v97
v_add_f32 v34, v34, v98
v_add_f32 v35, v35, v99
s_waitcnt lgkmcnt(4)
v_add_f32 v36, v36, v100
v_add_f32 v37, v37, v101
v_add_f32 v38, v38, v102
v_add_f32 v39, v39, v103
s_waitcnt lgkmcnt(3)
v_add_f32 v56, v56, v120
v_add_f32 v57, v57, v121
v_add_f32 v58, v58, v122
v_add_f32 v59, v59, v123
s_waitcnt lgkmcnt(2)
v_add_f32 v60, v60, v124
v_add_f32 v61, v61, v125
v_add_f32 v62, v62, v126
v_add_f32 v63, v63, v127
s_waitcnt lgkmcnt(1)
v_add_f32 v64, v64, v128
v_add_f32 v65, v65, v129
v_add_f32 v66, v66, v130
v_add_f32 v67, v67, v131
s_waitcnt lgkmcnt(0)
v_add_f32 v68, v68, v132
v_add_f32 v69, v69, v133
v_add_f32 v70, v70, v134
v_add_f32 v71, v71, v135
L_xchk:
s_waitcnt vmcnt(0)
v_max3_u32 v9, v152, v153, v154
v_max3_u32 v9, v9, v155, v156
v_max3_u32 v9, v9, v157, v158
v_max3_u32 v9, v9, v159, v160
v_max3_u32 v9, v9, v161, v162
v_max3_u32 v9, v9, v163, v164
v_max3_u32 v9, v9, v165, v166
v_max_u32 v9, v9, v167
v_cmp_eq_u32 vcc, -1, v9
s_cbranch_vccnz L_xretry
L_xgo:
v_mfma_f32_16x16x32_bf16 v[24:27], v[234:237], v[152:155], v[24:27]
v_mfma_f32_16x16x32_bf16 v[28:31], v[232:235], v[152:155], v[28:31]
v_mfma_f32_16x16x32_bf16 v[32:35], v[234:237], v[156:159], v[32:35]
v_mfma_f32_16x16x32_bf16 v[36:39], v[232:235], v[156:159], v[36:39]
v_mfma_f32_16x16x32_bf16 v[56:59], v[234:237], v[160:163], v[56:59]
v_mfma_f32_16x16x32_bf16 v[60:63], v[232:235], v[160:163], v[60:63]
v_mfma_f32_16x16x32_bf16 v[64:67], v[234:237], v[164:167], v[64:67]
v_mfma_f32_16x16x32_bf16 v[68:71], v[232:235], v[164:167], v[68:71]
s_nop 1
v_cvt_pk_bf16_f32 v24, v24, v25
v_cvt_pk_bf16_f32 v25, v26, v27
v_cvt_pk_bf16_f32 v26, v28, v29
v_cvt_pk_bf16_f32 v27, v30, v31
v_cvt_pk_bf16_f32 v32, v32, v33
v_cvt_pk_bf16_f32 v33, v34, v35
v_cvt_pk_bf16_f32 v34, v36, v37
v_cvt_pk_bf16_f32 v35, v38, v39
v_permlane16_swap_b32 v24, v26
v_permlane16_swap_b32 v25, v27
v_permlane16_swap_b32 v32, v34
v_permlane16_swap_b32 v33, v35
v_mov_b32 v28, v24
v_mov_b32 v29, v25
v_mov_b32 v30, v26
v_mov_b32 v31, v27
v_mov_b32_dpp v24, v32 row_ror:8 row_mask:0xf bank_mask:0xc
v_mov_b32_dpp v25, v33 row_ror:8 row_mask:0xf bank_mask:0xc
v_mov_b32_dpp v26, v34 row_ror:8 row_mask:0xf bank_mask:0xc
v_mov_b32_dpp v27, v35 row_ror:8 row_mask:0xf bank_mask:0xc
v_mov_b32_dpp v32, v28 row_ror:8 row_mask:0xf bank_mask:0x3
v_mov_b32_dpp v33, v29 row_ror:8 row_mask:0xf bank_mask:0x3
v_mov_b32_dpp v34, v30 row_ror:8 row_mask:0xf bank_mask:0x3
v_mov_b32_dpp v35, v31 row_ror:8 row_mask:0xf bank_mask:0x3
buffer_store_dwordx4 v[24:27], v8, s[48:51], s77 offen sc1
s_add_u32 s77, s77, 16384
buffer_store_dwordx4 v[32:35], v8, s[48:51], s77 offen sc1
s_add_u32 s77, s77, 16384
v_cvt_pk_bf16_f32 v56, v56, v57
v_cvt_pk_bf16_f32 v57, v58, v59
v_cvt_pk_bf16_f32 v58, v60, v61
v_cvt_pk_bf16_f32 v59, v62, v63
v_cvt_pk_bf16_f32 v64, v64, v65
v_cvt_pk_bf16_f32 v65, v66, v67
v_cvt_pk_bf16_f32 v66, v68, v69
v_cvt_pk_bf16_f32 v67, v70, v71
v_permlane16_swap_b32 v56, v58
v_permlane16_swap_b32 v57, v59
v_permlane16_swap_b32 v64, v66
v_permlane16_swap_b32 v65, v67
v_mov_b32 v60, v56
v_mov_b32 v61, v57
v_mov_b32 v62, v58
v_mov_b32 v63, v59
v_mov_b32_dpp v56, v64 row_ror:8 row_mask:0xf bank_mask:0xc
v_mov_b32_dpp v57, v65 row_ror:8 row_mask:0xf bank_mask:0xc
v_mov_b32_dpp v58, v66 row_ror:8 row_mask:0xf bank_mask:0xc
v_mov_b32_dpp v59, v67 row_ror:8 row_mask:0xf bank_mask:0xc
v_mov_b32_dpp v64, v60 row_ror:8 row_mask:0xf bank_mask:0x3
v_mov_b32_dpp v65, v61 row_ror:8 row_mask:0xf bank_mask:0x3
v_mov_b32_dpp v66, v62 row_ror:8 row_mask:0xf bank_mask:0x3
v_mov_b32_dpp v67, v63 row_ror:8 row_mask:0xf bank_mask:0x3
buffer_store_dwordx4 v[56:59], v8, s[48:51], s77 offen sc1
s_add_u32 s77, s77, 16384
buffer_store_dwordx4 v[64:67], v8, s[48:51], s77 offen sc1
s_add_u32 s77, s77, 16384
L_end:
s_endpgm
L_spin_1:
s_mov_b32 vcc_hi, 0x8000
L_spinlp_3:
s_sleep 1
buffer_load_dword v1, off, s[52:55], s78 offset:0 sc1
s_waitcnt vmcnt(0)
v_readfirstlane_b32 vcc_lo, v1
s_sub_u32 vcc_hi, vcc_hi, 1
s_cbranch_scc1 L_spinbk_2
s_cmp_lt_u32 vcc_lo, s81
s_cbranch_scc1 L_spinlp_3
s_branch L_spinbk_2
L_spin_4:
s_mov_b32 vcc_hi, 0x8000
L_spinlp_6:
s_sleep 1
buffer_load_dword v1, off, s[52:55], s70 offset:0 sc1
s_waitcnt vmcnt(0)
v_readfirstlane_b32 vcc_lo, v1
s_sub_u32 vcc_hi, vcc_hi, 1
s_cbranch_scc1 L_spinbk_5
s_cmp_lt_u32 vcc_lo, s81
s_cbranch_scc1 L_spinlp_6
s_branch L_spinbk_5
L_hretry:
s_sub_u32 s72, s72, 1
s_cbranch_scc1 L_hgo
buffer_load_dwordx4 v[88:91], v16, s[44:47], s77 offen sc1
s_waitcnt vmcnt(0)
s_branch L_hchk
L_spin_8:
s_mov_b32 vcc_hi, 0x8000
L_spinlp_10:
s_sleep 1
buffer_load_dword v19, off, s[52:55], s80 offset:0 sc1
s_waitcnt vmcnt(0)
v_readfirstlane_b32 vcc_lo, v19
s_sub_u32 vcc_hi, vcc_hi, 1
s_cbranch_scc1 L_spinbk_9
s_cmp_lt_u32 vcc_lo, s69
s_cbranch_scc1 L_spinlp_10
s_branch L_spinbk_9
L_spin_1012:
s_mov_b32 vcc_hi, 0x8000
L_spinlp_1014:
s_sleep 1
buffer_load_dword v19, off, s[52:55], s80 offset:0 sc1
s_waitcnt vmcnt(0)
v_readfirstlane_b32 vcc_lo, v19
s_sub_u32 vcc_hi, vcc_hi, 1
s_cbranch_scc1 L_spinbk_1013
s_cmp_lt_u32 vcc_lo, s69
s_cbranch_scc1 L_spinlp_1014
s_branch L_spinbk_1013
L_F1:
ds_read_b128 a[144:147], v2 offset:0
ds_read_b128 a[148:151], v2 offset:1024
ds_read_b128 a[152:155], v2 offset:2048
ds_read_b128 a[156:159], v2 offset:3072
ds_read_b128 a[160:163], v2 offset:4096
ds_read_b128 a[164:167], v2 offset:5120
ds_read_b128 a[168:171], v2 offset:6144
ds_read_b128 a[172:175], v2 offset:7168
s_mov_b32 m0, s71
s_nop 0
buffer_load_dwordx4 v16, s[32:35], s70 offen offset:0 sc1 lds
buffer_load_dwordx4 v16, s[32:35], s70 offen offset:1024 sc1 lds
s_waitcnt lgkmcnt(7)
v_mfma_f32_16x16x32_bf16 v[104:107], a[144:147], v[40:43], 0
s_waitcnt lgkmcnt(6)
ds_read_b128 a[176:179], v2 offset:8192
v_cndmask_b32 v88, 0, v17, s[0:1]
v_mfma_f32_16x16x32_bf16 v[104:107], a[148:151], v[44:47], v[104:107]
s_waitcnt lgkmcnt(6)
ds_read_b128 a[180:183], v2 offset:9216
v_cndmask_b32 v89, 0, v17, s[4:5]
v_mfma_f32_16x16x32_bf16 v[104:107], a[152:155], v[48:51], v[104:107]
s_waitcnt lgkmcnt(6)
buffer_load_dwordx4 v16, s[32:35], s70 offen offset:2048 sc1 lds
v_mfma_f32_16x16x32_bf16 v[104:107], a[156:159], v[52:55], v[104:107]
ds_read_b128 a[184:187], v2 offset:10240
v_cndmask_b32 v90, 0, v17, s[6:7]
v_mfma_f32_16x16x32_bf16 v[120:123], a[156:159], v[68:71], 0
ds_read_b128 a[188:191], v2 offset:11264
v_cndmask_b32 v91, 0, v17, s[8:9]
v_mfma_f32_16x16x32_bf16 v[120:123], a[152:155], v[64:67], v[120:123]
ds_read_b128 a[192:195], v2 offset:12288
ds_read_b128 a[196:199], v2 offset:13312
v_mfma_f32_16x16x32_bf16 v[120:123], a[148:151], v[60:63], v[120:123]
ds_read_b128 a[200:203], v2 offset:14336
v_mfma_f32_16x16x32_bf16 v[120:123], a[144:147], v[56:59], v[120:123]
ds_read_b128 a[204:207], v2 offset:15360
v_mfma_f32_16x16x32_bf16 v[136:139], a[144:147], v[72:75], 0
v_mfma_f32_16x16x32_bf16 v[136:139], a[148:151], v[76:79], v[136:139]
buffer_load_dwordx4 v16, s[32:35], s70 offen offset:3072 sc1 lds
v_mfma_f32_16x16x32_bf16 v[136:139], a[152:155], v[80:83], v[136:139]
v_mfma_f32_16x16x32_bf16 v[136:139], a[156:159], v[84:87], v[136:139]
v_mfma_f32_16x16x32_bf16 v[88:91], a[156:159], v[36:39], v[88:91]
v_mfma_f32_16x16x32_bf16 v[88:91], a[152:155], v[32:35], v[88:91]
v_mfma_f32_16x16x32_bf16 v[88:91], a[148:151], v[28:31], v[88:91]
v_mfma_f32_16x16x32_bf16 v[88:91], a[144:147], v[24:27], v[88:91]
s_waitcnt lgkmcnt(0)
s_nop 1
v_max3_f32 v21, v104, v105, v106
v_max_f32 v21, v21, v107
v_max3_f32 v22, v120, v121, v122
v_max_f32 v22, v22, v123
v_max3_f32 v23, v136, v137, v138
v_max_f32 v23, v23, v139
v_max3_f32 v20, v88, v89, v90
v_max_f32 v20, v20, v91
v_mov_b32 v248, v20
v_mov_b32 v249, v21
v_mov_b32 v250, v22
v_mov_b32 v251, v23
v_permlane16_swap_b32 v248, v20
v_permlane16_swap_b32 v249, v21
v_permlane16_swap_b32 v250, v22
v_permlane16_swap_b32 v251, v23
v_max_f32 v20, v20, v248
v_max_f32 v21, v21, v249
v_max_f32 v22, v22, v250
v_max_f32 v23, v23, v251
v_mov_b32 v248, v20
v_mov_b32 v249, v21
v_mov_b32 v250, v22
v_mov_b32 v251, v23
v_permlane32_swap_b32 v248, v20
v_permlane32_swap_b32 v249, v21
v_permlane32_swap_b32 v250, v22
v_permlane32_swap_b32 v251, v23
v_max_f32 v20, v20, v248
v_max_f32 v21, v21, v249
v_max_f32 v22, v22, v250
v_max_f32 v23, v23, v251
s_cmp_eq_u32 s73, 0
s_cselect_b64 vcc, 0, -1
v_cndmask_b32 v20, v20, v252, vcc
v_cndmask_b32 v21, v21, v253, vcc
v_cndmask_b32 v22, v22, v254, vcc
v_cndmask_b32 v23, v23, v255, vcc
v_sub_f32 v228, 0, v23
v_sub_f32 v229, 0, v23
v_sub_f32 v230, 0, v23
v_sub_f32 v231, 0, v23
v_sub_f32 v224, 0, v22
v_sub_f32 v225, 0, v22
v_sub_f32 v226, 0, v22
v_sub_f32 v227, 0, v22
v_sub_f32 v220, 0, v21
v_sub_f32 v221, 0, v21
v_sub_f32 v222, 0, v21
v_sub_f32 v223, 0, v21
v_sub_f32 v216, 0, v20
v_sub_f32 v217, 0, v20
v_sub_f32 v218, 0, v20
v_sub_f32 v219, 0, v20
v_mfma_f32_16x16x32_bf16 v[140:143], a[160:163], v[72:75], v[228:231]
s_add_u32 m0, s71, 4096
v_add_f32 v104, v104, v220
v_add_f32 v105, v105, v220
v_mfma_f32_16x16x32_bf16 v[140:143], a[164:167], v[76:79], v[140:143]
v_add_f32 v106, v106, v220
v_add_f32 v107, v107, v220
v_exp_f32 v104, v104
v_mfma_f32_16x16x32_bf16 v[140:143], a[168:171], v[80:83], v[140:143]
s_add_u32 s64, s70, 4096
v_exp_f32 v105, v105
v_mfma_f32_16x16x32_bf16 v[140:143], a[172:175], v[84:87], v[140:143]
buffer_load_dwordx4 v16, s[32:35], s64 offen offset:0 sc1 lds
v_mfma_f32_16x16x32_bf16 v[124:127], a[172:175], v[68:71], v[224:227]
v_exp_f32 v106, v106
v_mfma_f32_16x16x32_bf16 v[124:127], a[168:171], v[64:67], v[124:127]
v_exp_f32 v107, v107
v_mfma_f32_16x16x32_bf16 v[124:127], a[164:167], v[60:63], v[124:127]
v_add_f32 v120, v120, v224
v_add_f32 v121, v121, v224
v_add_f32 v122, v122, v224
v_add_f32 v123, v123, v224
v_exp_f32 v120, v120
v_mfma_f32_16x16x32_bf16 v[124:127], a[160:163], v[56:59], v[124:127]
v_exp_f32 v121, v121
v_mfma_f32_16x16x32_bf16 v[108:111], a[160:163], v[40:43], v[220:223]
v_exp_f32 v122, v122
v_mfma_f32_16x16x32_bf16 v[108:111], a[164:167], v[44:47], v[108:111]
v_cndmask_b32 v92, v216, v17, s[10:11]
v_cndmask_b32 v93, v216, v17, s[12:13]
v_cndmask_b32 v94, v216, v17, s[18:19]
v_cndmask_b32 v95, v216, v17, s[22:23]
v_mfma_f32_16x16x32_bf16 v[108:111], a[168:171], v[48:51], v[108:111]
buffer_load_dwordx4 v16, s[32:35], s64 offen offset:1024 sc1 lds
v_cvt_pk_bf16_f32 v160, v104, v105
v_mfma_f32_16x16x32_bf16 v[108:111], a[172:175], v[52:55], v[108:111]
v_exp_f32 v123, v123
v_mfma_f32_16x16x32_bf16 v[92:95], a[172:175], v[36:39], v[92:95]
v_add_f32 v136, v136, v228
v_add_f32 v137, v137, v228
v_add_f32 v138, v138, v228
v_add_f32 v139, v139, v228
v_exp_f32 v136, v136
v_mfma_f32_16x16x32_bf16 v[92:95], a[168:171], v[32:35], v[92:95]
v_cvt_pk_bf16_f32 v161, v106, v107
v_exp_f32 v137, v137
v_cndmask_b32 v96, v216, v17, s[26:27]
v_cndmask_b32 v97, v216, v17, s[56:57]
v_cndmask_b32 v98, v216, v17, s[58:59]
v_cndmask_b32 v99, v216, v17, s[60:61]
v_mfma_f32_16x16x32_bf16 v[92:95], a[164:167], v[28:31], v[92:95]
v_exp_f32 v138, v138
v_mfma_f32_16x16x32_bf16 v[92:95], a[160:163], v[24:27], v[92:95]
v_exp_f32 v139, v139
v_mfma_f32_16x16x32_bf16 v[96:99], a[176:179], v[24:27], v[96:99]
v_cvt_pk_bf16_f32 v184, v120, v121
v_add_f32 v88, v88, v216
v_mfma_f32_16x16x32_bf16 v[96:99], a[180:183], v[28:31], v[96:99]
buffer_load_dwordx4 v16, s[32:35], s64 offen offset:2048 sc1 lds
v_add_f32 v89, v89, v216
v_add_f32 v90, v90, v216
v_add_f32 v91, v91, v216
v_exp_f32 v88, v88
v_mfma_f32_16x16x32_bf16 v[96:99], a[184:187], v[32:35], v[96:99]
v_exp_f32 v89, v89
v_mfma_f32_16x16x32_bf16 v[96:99], a[188:191], v[36:39], v[96:99]
v_cvt_pk_bf16_f32 v185, v122, v123
v_cvt_pk_bf16_f32 v192, v136, v137
v_mfma_f32_16x16x32_bf16 v[112:115], a[188:191], v[52:55], v[220:223]
v_exp_f32 v90, v90
v_mfma_f32_16x16x32_bf16 v[112:115], a[184:187], v[48:51], v[112:115]
v_exp_f32 v91, v91
v_mfma_f32_16x16x32_bf16 v[112:115], a[180:183], v[44:47], v[112:115]
v_exp_f32 v140, v140
v_mfma_f32_16x16x32_bf16 v[112:115], a[176:179], v[40:43], v[112:115]
v_exp_f32 v141, v141
v_mfma_f32_16x16x32_bf16 v[128:131], a[176:179], v[56:59], v[224:227]
buffer_load_dwordx4 v16, s[32:35], s64 offen offset:3072 sc1 lds
v_cvt_pk_bf16_f32 v193, v138, v139
v_mfma_f32_16x16x32_bf16 v[128:131], a[180:183], v[60:63], v[128:131]
v_exp_f32 v142, v142
v_mfma_f32_16x16x32_bf16 v[128:131], a[184:187], v[64:67], v[128:131]
v_exp_f32 v143, v143
v_mfma_f32_16x16x32_bf16 v[128:131], a[188:191], v[68:71], v[128:131]
v_cvt_pk_bf16_f32 v152, v88, v89
v_cvt_pk_bf16_f32 v153, v90, v91
v_mfma_f32_16x16x32_bf16 v[144:147], a[188:191], v[84:87], v[228:231]
v_exp_f32 v124, v124
v_mfma_f32_16x16x32_bf16 v[144:147], a[184:187], v[80:83], v[144:147]
v_exp_f32 v125, v125
v_mfma_f32_16x16x32_bf16 v[144:147], a[180:183], v[76:79], v[144:147]
s_waitcnt vmcnt(8)
s_barrier
v_mfma_f32_16x16x32_bf16 v[144:147], a[176:179], v[72:75], v[144:147]
v_exp_f32 v126, v126
v_mfma_f32_16x16x32_bf16 v[148:151], a[192:195], v[72:75], v[228:231]
v_cvt_pk_bf16_f32 v194, v140, v141
v_cvt_pk_bf16_f32 v195, v142, v143
v_mfma_f32_16x16x32_bf16 v[148:151], a[196:199], v[76:79], v[148:151]
v_exp_f32 v127, v127
v_mfma_f32_16x16x32_bf16 v[148:151], a[200:203], v[80:83], v[148:151]
s_xor_b32 s71, s71, 16384
v_exp_f32 v108, v108
v_mfma_f32_16x16x32_bf16 v[148:151], a[204:207], v[84:87], v[148:151]
s_add_u32 s70, s70, 32768
v_exp_f32 v109, v109
v_mfma_f32_16x16x32_bf16 v[132:135], a[204:207], v[68:71], v[224:227]
s_mov_b32 m0, s71
v_exp_f32 v110, v110
v_mfma_f32_16x16x32_bf16 v[132:135], a[200:203], v[64:67], v[132:135]
buffer_load_dwordx4 v16, s[32:35], s70 offen offset:0 sc1 lds
v_mfma_f32_16x16x32_bf16 v[132:135], a[196:199], v[60:63], v[132:135]
v_cvt_pk_bf16_f32 v186, v124, v125
v_exp_f32 v111, v111
v_mfma_f32_16x16x32_bf16 v[132:135], a[192:195], v[56:59], v[132:135]
v_exp_f32 v92, v92
v_mfma_f32_16x16x32_bf16 v[116:119], a[192:195], v[40:43], v[220:223]
ds_read_b128 a[144:147], v2 offset:16384
v_cndmask_b32 v100, v216, v17, s[62:63]
v_mfma_f32_16x16x32_bf16 v[116:119], a[196:199], v[44:47], v[116:119]
ds_read_b128 a[148:151], v2 offset:17408
v_cndmask_b32 v101, v216, v17, s[48:49]
v_cndmask_b32 v102, v216, v17, s[50:51]
v_cndmask_b32 v103, v216, v17, s[100:101]
v_cvt_pk_bf16_f32 v187, v126, v127
v_exp_f32 v93, v93
v_mfma_f32_16x16x32_bf16 v[116:119], a[200:203], v[48:51], v[116:119]
v_exp_f32 v94, v94
v_mfma_f32_16x16x32_bf16 v[116:119], a[204:207], v[52:55], v[116:119]
ds_read_b128 a[152:155], v2 offset:18432
v_cvt_pk_bf16_f32 v162, v108, v109
v_mfma_f32_16x16x32_bf16 v[100:103], a[204:207], v[36:39], v[100:103]
buffer_load_dwordx4 v16, s[32:35], s70 offen offset:1024 sc1 lds
v_exp_f32 v95, v95
v_mfma_f32_16x16x32_bf16 v[100:103], a[200:203], v[32:35], v[100:103]
ds_read_b128 a[156:159], v2 offset:19456
v_exp_f32 v96, v96
v_mfma_f32_16x16x32_bf16 v[100:103], a[196:199], v[28:31], v[100:103]
v_cvt_pk_bf16_f32 v163, v110, v111
v_exp_f32 v97, v97
v_mfma_f32_16x16x32_bf16 v[100:103], a[192:195], v[24:27], v[100:103]
s_waitcnt lgkmcnt(2)
ds_read_b128 a[160:163], v2 offset:20480
ds_read_b128 a[164:167], v2 offset:21504
ds_read_b128 a[168:171], v2 offset:22528
ds_read_b128 a[172:175], v2 offset:23552
v_mfma_f32_16x16x32_bf16 v[120:123], a[144:147], v[56:59], v[224:227]
v_exp_f32 v98, v98
v_mfma_f32_16x16x32_bf16 v[120:123], a[148:151], v[60:63], v[120:123]
s_waitcnt lgkmcnt(5)
v_cvt_pk_bf16_f32 v154, v92, v93
v_exp_f32 v99, v99
v_mfma_f32_16x16x32_bf16 v[120:123], a[152:155], v[64:67], v[120:123]
s_waitcnt lgkmcnt(4)
v_exp_f32 v112, v112
v_mfma_f32_16x16x32_bf16 v[120:123], a[156:159], v[68:71], v[120:123]
v_exp_f32 v113, v113
v_mfma_f32_16x16x32_bf16 v[136:139], a[156:159], v[84:87], v[228:231]
v_cvt_pk_bf16_f32 v155, v94, v95
v_cndmask_b32 v104, v220, v17, s[0:1]
v_mfma_f32_16x16x32_bf16 v[136:139], a[152:155], v[80:83], v[136:139]
ds_read_b128 a[176:179], v2 offset:24576
buffer_load_dwordx4 v16, s[32:35], s70 offen offset:2048 sc1 lds
v_cndmask_b32 v105, v220, v17, s[4:5]
v_cndmask_b32 v106, v220, v17, s[6:7]
v_cndmask_b32 v107, v220, v17, s[8:9]
v_exp_f32 v114, v114
v_mfma_f32_16x16x32_bf16 v[136:139], a[148:151], v[76:79], v[136:139]
v_cvt_pk_bf16_f32 v156, v96, v97
v_cvt_pk_bf16_f32 v157, v98, v99
v_mfma_f32_16x16x32_bf16 v[136:139], a[144:147], v[72:75], v[136:139]
v_exp_f32 v115, v115
v_mfma_f32_16x16x32_bf16 v[104:107], a[144:147], v[40:43], v[104:107]
v_exp_f32 v128, v128
v_mfma_f32_16x16x32_bf16 v[104:107], a[148:151], v[44:47], v[104:107]
v_exp_f32 v129, v129
v_mfma_f32_16x16x32_bf16 v[104:107], a[152:155], v[48:51], v[104:107]
v_exp_f32 v130, v130
v_mfma_f32_16x16x32_bf16 v[104:107], a[156:159], v[52:55], v[104:107]
s_waitcnt lgkmcnt(0)
v_exp_f32 v131, v131
v_mfma_f32_16x16x32_bf16 v[140:143], a[172:175], v[84:87], v[228:231]
v_cvt_pk_bf16_f32 v164, v112, v113
v_cvt_pk_bf16_f32 v165, v114, v115
v_mfma_f32_16x16x32_bf16 v[140:143], a[168:171], v[80:83], v[140:143]
v_exp_f32 v144, v144
v_mfma_f32_16x16x32_bf16 v[140:143], a[164:167], v[76:79], v[140:143]
v_exp_f32 v145, v145
v_mfma_f32_16x16x32_bf16 v[140:143], a[160:163], v[72:75], v[140:143]
v_exp_f32 v146, v146
v_mfma_f32_16x16x32_bf16 v[124:127], a[160:163], v[56:59], v[224:227]
ds_read_b128 a[180:183], v2 offset:25600
v_cndmask_b32 v108, v220, v17, s[10:11]
v_mfma_f32_16x16x32_bf16 v[124:127], a[164:167], v[60:63], v[124:127]
ds_read_b128 a[184:187], v2 offset:26624
v_cndmask_b32 v109, v220, v17, s[12:13]
v_cndmask_b32 v110, v220, v17, s[18:19]
v_cndmask_b32 v111, v220, v17, s[22:23]
v_cvt_pk_bf16_f32 v188, v128, v129
v_mfma_f32_16x16x32_bf16 v[124:127], a[168:171], v[64:67], v[124:127]
buffer_load_dwordx4 v16, s[32:35], s70 offen offset:3072 sc1 lds
v_exp_f32 v147, v147
v_mfma_f32_16x16x32_bf16 v[124:127], a[172:175], v[68:71], v[124:127]
s_add_u32 m0, s86, 131072
ds_read_b128 a[188:191], v2 offset:27648
v_exp_f32 v148, v148
v_mfma_f32_16x16x32_bf16 v[108:111], a[172:175], v[52:55], v[108:111]
s_add_u32 s64, s85, 0
v_cvt_pk_bf16_f32 v189, v130, v131
v_exp_f32 v149, v149
v_mfma_f32_16x16x32_bf16 v[108:111], a[168:171], v[48:51], v[108:111]
ds_read_b128 a[192:195], v2 offset:28672
buffer_load_dwordx4 v12, s[36:39], s64 offen lds
v_cndmask_b32 v112, v220, v17, s[26:27]
v_cndmask_b32 v113, v220, v17, s[56:57]
v_cndmask_b32 v114, v220, v17, s[58:59]
v_cndmask_b32 v115, v220, v17, s[60:61]
v_mfma_f32_16x16x32_bf16 v[108:111], a[164:167], v[44:47], v[108:111]
s_add_u32 m0, s86, 132096
v_exp_f32 v150, v150
v_mfma_f32_16x16x32_bf16 v[108:111], a[160:163], v[40:43], v[108:111]
s_add_u32 s64, s85, 8192
v_cvt_pk_bf16_f32 v196, v144, v145
v_exp_f32 v151, v151
v_mfma_f32_16x16x32_bf16 v[112:115], a[176:179], v[40:43], v[112:115]
s_waitcnt lgkmcnt(2)
buffer_load_dwordx4 v13, s[36:39], s64 offen lds
v_exp_f32 v132, v132
v_mfma_f32_16x16x32_bf16 v[112:115], a[180:183], v[44:47], v[112:115]
s_add_u32 m0, s86, 133120
v_exp_f32 v133, v133
v_mfma_f32_16x16x32_bf16 v[112:115], a[184:187], v[48:51], v[112:115]
s_waitcnt lgkmcnt(1)
s_add_u32 s64, s85, 16384
v_cvt_pk_bf16_f32 v197, v146, v147
v_cvt_pk_bf16_f32 v198, v148, v149
v_mfma_f32_16x16x32_bf16 v[112:115], a[188:191], v[52:55], v[112:115]
buffer_load_dwordx4 v12, s[36:39], s64 offen lds
v_exp_f32 v134, v134
v_mfma_f32_16x16x32_bf16 v[128:131], a[188:191], v[68:71], v[224:227]
s_add_u32 m0, s86, 134144
ds_read_b128 a[196:199], v2 offset:29696
ds_read_b128 a[200:203], v2 offset:30720
ds_read_b128 a[204:207], v2 offset:31744
v_mfma_f32_16x16x32_bf16 v[128:131], a[184:187], v[64:67], v[128:131]
s_add_u32 s64, s85, 24576
v_exp_f32 v135, v135
v_mfma_f32_16x16x32_bf16 v[128:131], a[180:183], v[60:63], v[128:131]
buffer_load_dwordx4 v13, s[36:39], s64 offen lds
v_exp_f32 v116, v116
v_mfma_f32_16x16x32_bf16 v[128:131], a[176:179], v[56:59], v[128:131]
s_add_u32 m0, s71, 4096
v_cvt_pk_bf16_f32 v199, v150, v151
v_exp_f32 v117, v117
v_mfma_f32_16x16x32_bf16 v[144:147], a[176:179], v[72:75], v[228:231]
s_add_u32 s64, s70, 4096
v_exp_f32 v118, v118
v_mfma_f32_16x16x32_bf16 v[144:147], a[180:183], v[76:79], v[144:147]
buffer_load_dwordx4 v16, s[32:35], s64 offen offset:0 sc1 lds
v_mfma_f32_16x16x32_bf16 v[144:147], a[184:187], v[80:83], v[144:147]
v_cvt_pk_bf16_f32 v190, v132, v133
v_exp_f32 v119, v119
v_mfma_f32_16x16x32_bf16 v[144:147], a[188:191], v[84:87], v[144:147]
s_waitcnt lgkmcnt(0)
v_exp_f32 v100, v100
v_mfma_f32_16x16x32_bf16 v[148:151], a[204:207], v[84:87], v[228:231]
v_exp_f32 v101, v101
v_mfma_f32_16x16x32_bf16 v[148:151], a[200:203], v[80:83], v[148:151]
v_cvt_pk_bf16_f32 v191, v134, v135
v_cvt_pk_bf16_f32 v166, v116, v117
v_cvt_pk_bf16_f32 v167, v118, v119
v_mfma_f32_16x16x32_bf16 v[148:151], a[196:199], v[76:79], v[148:151]
v_exp_f32 v102, v102
v_mfma_f32_16x16x32_bf16 v[148:151], a[192:195], v[72:75], v[148:151]
v_exp_f32 v103, v103
v_mfma_f32_16x16x32_bf16 v[132:135], a[192:195], v[56:59], v[224:227]
s_lshl_b32 s66, s30, 30
ds_read_b128 a[144:147], v3 offset:16384
v_cndmask_b32 v116, v220, v17, s[62:63]
v_mfma_f32_16x16x32_bf16 v[132:135], a[196:199], v[60:63], v[132:135]
ds_read_b128 a[148:151], v3 offset:24576
v_cndmask_b32 v117, v220, v17, s[48:49]
v_cndmask_b32 v118, v220, v17, s[50:51]
v_cndmask_b32 v119, v220, v17, s[100:101]
v_exp_f32 v120, v120
v_mfma_f32_16x16x32_bf16 v[132:135], a[200:203], v[64:67], v[132:135]
v_exp_f32 v121, v121
v_mfma_f32_16x16x32_bf16 v[132:135], a[204:207], v[68:71], v[132:135]
v_exp_f32 v122, v122
v_mfma_f32_16x16x32_bf16 v[116:119], a[204:207], v[52:55], v[116:119]
v_exp_f32 v123, v123
v_mfma_f32_16x16x32_bf16 v[116:119], a[200:203], v[48:51], v[116:119]
v_cvt_pk_bf16_f32 v158, v100, v101
v_cvt_pk_bf16_f32 v159, v102, v103
v_mfma_f32_16x16x32_bf16 v[116:119], a[196:199], v[44:47], v[116:119]
buffer_load_dwordx4 v16, s[32:35], s64 offen offset:1024 sc1 lds
v_mfma_f32_16x16x32_bf16 v[116:119], a[192:195], v[40:43], v[116:119]
v_exp_f32 v136, v136
v_mfma_f32_16x16x32_bf16 a[128:131], a[244:247], v[152:155], 0
v_exp_f32 v137, v137
v_mfma_f32_16x16x32_bf16 a[128:131], a[244:247], v[156:159], a[128:131]
v_exp_f32 v138, v138
v_mfma_f32_16x16x32_bf16 a[132:135], a[244:247], v[160:163], 0
v_exp_f32 v139, v139
v_mfma_f32_16x16x32_bf16 a[132:135], a[244:247], v[164:167], a[132:135]
v_cvt_pk_bf16_f32 v200, v120, v121
v_cvt_pk_bf16_f32 v201, v122, v123
v_mfma_f32_16x16x32_bf16 a[136:139], a[244:247], v[184:187], 0
v_exp_f32 v104, v104
v_mfma_f32_16x16x32_bf16 a[136:139], a[244:247], v[188:191], a[136:139]
v_exp_f32 v105, v105
v_mfma_f32_16x16x32_bf16 a[140:143], a[244:247], v[192:195], 0
ds_read_b128 a[152:155], v3 offset:17408
v_cvt_pk_bf16_f32 v208, v136, v137
v_mfma_f32_16x16x32_bf16 a[140:143], a[244:247], v[196:199], a[140:143]
s_waitcnt lgkmcnt(1)
v_exp_f32 v106, v106
v_mfma_f32_16x16x32_bf16 a[0:3], a[144:147], v[152:155], 0
ds_read_b128 a[156:159], v3 offset:25600
v_cvt_pk_bf16_f32 v209, v138, v139
v_mfma_f32_16x16x32_bf16 a[0:3], a[148:151], v[156:159], a[0:3]
v_exp_f32 v107, v107
v_mfma_f32_16x16x32_bf16 a[32:35], a[148:151], v[164:167], 0
v_exp_f32 v140, v140
v_mfma_f32_16x16x32_bf16 a[32:35], a[144:147], v[160:163], a[32:35]
buffer_load_dwordx4 v16, s[32:35], s64 offen offset:2048 sc1 lds
v_mfma_f32_16x16x32_bf16 a[64:67], a[144:147], v[184:187], 0
v_exp_f32 v141, v141
v_mfma_f32_16x16x32_bf16 a[64:67], a[148:151], v[188:191], a[64:67]
v_exp_f32 v142, v142
v_mfma_f32_16x16x32_bf16 a[96:99], a[148:151], v[196:199], 0
ds_read_b128 a[160:163], v3 offset:18432
v_cvt_pk_bf16_f32 v176, v104, v105
v_mfma_f32_16x16x32_bf16 a[96:99], a[144:147], v[192:195], a[96:99]
s_waitcnt lgkmcnt(1)
ds_read_b128 a[164:167], v3 offset:26624
v_cvt_pk_bf16_f32 v177, v106, v107
v_mfma_f32_16x16x32_bf16 a[100:103], a[152:155], v[192:195], 0
v_exp_f32 v143, v143
v_mfma_f32_16x16x32_bf16 a[100:103], a[156:159], v[196:199], a[100:103]
v_exp_f32 v124, v124
v_mfma_f32_16x16x32_bf16 a[68:71], a[156:159], v[188:191], 0
v_exp_f32 v125, v125
v_mfma_f32_16x16x32_bf16 a[68:71], a[152:155], v[184:187], a[68:71]
v_exp_f32 v126, v126
v_mfma_f32_16x16x32_bf16 a[36:39], a[152:155], v[160:163], 0
v_exp_f32 v127, v127
v_mfma_f32_16x16x32_bf16 a[36:39], a[156:159], v[164:167], a[36:39]
ds_read_b128 a[168:171], v3 offset:19456
v_cvt_pk_bf16_f32 v210, v140, v141
v_mfma_f32_16x16x32_bf16 a[4:7], a[156:159], v[156:159], 0
ds_read_b128 a[172:175], v3 offset:27648
v_cvt_pk_bf16_f32 v211, v142, v143
v_mfma_f32_16x16x32_bf16 a[4:7], a[152:155], v[152:155], a[4:7]
s_waitcnt lgkmcnt(2)
v_exp_f32 v108, v108
v_mfma_f32_16x16x32_bf16 a[8:11], a[160:163], v[152:155], 0
v_exp_f32 v109, v109
v_mfma_f32_16x16x32_bf16 a[8:11], a[164:167], v[156:159], a[8:11]
buffer_load_dwordx4 v16, s[32:35], s64 offen offset:3072 sc1 lds
v_mfma_f32_16x16x32_bf16 a[40:43], a[164:167], v[164:167], 0
v_exp_f32 v110, v110
v_mfma_f32_16x16x32_bf16 a[40:43], a[160:163], v[160:163], a[40:43]
v_exp_f32 v111, v111
v_mfma_f32_16x16x32_bf16 a[72:75], a[160:163], v[184:187], 0
v_exp_f32 v112, v112
v_mfma_f32_16x16x32_bf16 a[72:75], a[164:167], v[188:191], a[72:75]
v_cvt_pk_bf16_f32 v202, v124, v125
v_cvt_pk_bf16_f32 v203, v126, v127
v_mfma_f32_16x16x32_bf16 a[104:107], a[164:167], v[196:199], 0
ds_read_b128 a[176:179], v3 offset:20480
v_cvt_pk_bf16_f32 v178, v108, v109
v_mfma_f32_16x16x32_bf16 a[104:107], a[160:163], v[192:195], a[104:107]
s_waitcnt lgkmcnt(1)
ds_read_b128 a[180:183], v3 offset:28672
v_xor_b32 v2, 0x8000, v2
v_mfma_f32_16x16x32_bf16 a[108:111], a[168:171], v[192:195], 0
s_add_u32 m0, s86, 135168
v_exp_f32 v113, v113
v_mfma_f32_16x16x32_bf16 a[108:111], a[172:175], v[196:199], a[108:111]
s_add_u32 s64, s85, 32768
v_exp_f32 v114, v114
v_mfma_f32_16x16x32_bf16 a[76:79], a[172:175], v[188:191], 0
buffer_load_dwordx4 v12, s[36:39], s64 offen lds
v_mfma_f32_16x16x32_bf16 a[76:79], a[168:171], v[184:187], a[76:79]
s_add_u32 m0, s86, 136192
v_exp_f32 v115, v115
v_mfma_f32_16x16x32_bf16 a[44:47], a[168:171], v[160:163], 0
s_add_u32 s64, s85, 40960
v_exp_f32 v128, v128
v_mfma_f32_16x16x32_bf16 a[44:47], a[172:175], v[164:167], a[44:47]
buffer_load_dwordx4 v13, s[36:39], s64 offen lds
v_mfma_f32_16x16x32_bf16 a[12:15], a[172:175], v[156:159], 0
ds_read_b128 a[184:187], v3 offset:21504
v_cvt_pk_bf16_f32 v179, v110, v111
v_mfma_f32_16x16x32_bf16 a[12:15], a[168:171], v[152:155], a[12:15]
s_waitcnt lgkmcnt(1)
s_add_u32 m0, s86, 137216
ds_read_b128 a[188:191], v3 offset:29696
ds_read_b128 a[192:195], v3 offset:22528
ds_read_b128 a[196:199], v3 offset:30720
ds_read_b128 a[200:203], v3 offset:23552
ds_read_b128 a[204:207], v3 offset:31744
v_mfma_f32_16x16x32_bf16 a[16:19], a[176:179], v[152:155], 0
s_waitcnt vmcnt(14)
s_barrier
s_add_u32 s64, s85, 49152
v_exp_f32 v129, v129
v_mfma_f32_16x16x32_bf16 a[16:19], a[180:183], v[156:159], a[16:19]
buffer_load_dwordx4 v12, s[36:39], s64 offen lds
v_mfma_f32_16x16x32_bf16 a[48:51], a[180:183], v[164:167], 0
s_add_u32 m0, s86, 138240
v_cvt_pk_bf16_f32 v180, v112, v113
v_exp_f32 v130, v130
v_mfma_f32_16x16x32_bf16 a[48:51], a[176:179], v[160:163], a[48:51]
s_add_u32 s64, s85, 57344
v_exp_f32 v131, v131
v_mfma_f32_16x16x32_bf16 a[80:83], a[176:179], v[184:187], 0
buffer_load_dwordx4 v13, s[36:39], s64 offen lds
v_mfma_f32_16x16x32_bf16 a[80:83], a[180:183], v[188:191], a[80:83]
v_cvt_pk_bf16_f32 v181, v114, v115
v_exp_f32 v144, v144
v_mfma_f32_16x16x32_bf16 a[112:115], a[180:183], v[196:199], 0
s_xor_b32 s71, s71, 49152
s_add_u32 s70, s70, 32768
s_mov_b32 m0, s71
v_exp_f32 v145, v145
v_mfma_f32_16x16x32_bf16 a[112:115], a[176:179], v[192:195], a[112:115]
s_waitcnt lgkmcnt(0)
buffer_load_dwordx4 v16, s[32:35], s70 offen offset:0 sc1 lds
v_mfma_f32_16x16x32_bf16 a[116:119], a[184:187], v[192:195], 0
v_cvt_pk_bf16_f32 v204, v128, v129
v_exp_f32 v146, v146
v_mfma_f32_16x16x32_bf16 a[116:119], a[188:191], v[196:199], a[116:119]
v_exp_f32 v147, v147
v_mfma_f32_16x16x32_bf16 a[84:87], a[188:191], v[188:191], 0
v_exp_f32 v148, v148
v_mfma_f32_16x16x32_bf16 a[84:87], a[184:187], v[184:187], a[84:87]
v_exp_f32 v149, v149
v_mfma_f32_16x16x32_bf16 a[52:55], a[184:187], v[160:163], 0
v_cvt_pk_bf16_f32 v205, v130, v131
v_cvt_pk_bf16_f32 v212, v144, v145
v_mfma_f32_16x16x32_bf16 a[52:55], a[188:191], v[164:167], a[52:55]
v_exp_f32 v150, v150
v_mfma_f32_16x16x32_bf16 a[20:23], a[188:191], v[156:159], 0
ds_read_b128 a[144:147], v2 offset:0
v_lshl_add_u32 v19, v0, 24, s66
v_mfma_f32_16x16x32_bf16 a[20:23], a[184:187], v[152:155], a[20:23]
s_lshr_b32 s67, s31, 4
v_exp_f32 v151, v151
v_mfma_f32_16x16x32_bf16 a[24:27], a[192:195], v[152:155], 0
s_lshl1_add_u32 s67, s3, s67
v_exp_f32 v132, v132
v_mfma_f32_16x16x32_bf16 a[24:27], a[196:199], v[156:159], a[24:27]
s_lshl_b32 s79, s67, 8
v_exp_f32 v133, v133
v_mfma_f32_16x16x32_bf16 a[56:59], a[196:199], v[164:167], 0
s_add_u32 s79, s79, 8192
v_cvt_pk_bf16_f32 v213, v146, v147
v_cvt_pk_bf16_f32 v214, v148, v149
v_mfma_f32_16x16x32_bf16 a[56:59], a[192:195], v[160:163], a[56:59]
s_add_u32 s69, s31, 12
v_exp_f32 v134, v134
v_mfma_f32_16x16x32_bf16 a[88:91], a[192:195], v[184:187], 0
s_lshr_b32 s69, s69, 5
buffer_load_dwordx4 v16, s[32:35], s70 offen offset:1024 sc1 lds
v_mfma_f32_16x16x32_bf16 a[88:91], a[196:199], v[188:191], a[88:91]
s_lshl1_add_u32 s69, s3, s69
v_exp_f32 v135, v135
v_mfma_f32_16x16x32_bf16 a[120:123], a[196:199], v[196:199], 0
s_lshl_b32 s69, s69, 8
v_exp_f32 v116, v116
v_mfma_f32_16x16x32_bf16 a[120:123], a[192:195], v[192:195], a[120:123]
s_add_u32 s69, s69, 8192
v_exp_f32 v117, v117
v_mfma_f32_16x16x32_bf16 a[124:127], a[200:203], v[192:195], 0
s_lshl_b32 s67, s73, 16
s_add_u32 s17, s78, L_T-L_pc+0
ds_read_b128 a[148:151], v2 offset:1024
v_cvt_pk_bf16_f32 v215, v150, v151
v_mfma_f32_16x16x32_bf16 a[124:127], a[204:207], v[196:199], a[124:127]
s_xor_b32 s68, s80, 256
buffer_load_dword a252, v16, s[88:91], s17 offen
v_mfma_f32_16x16x32_bf16 a[92:95], a[204:207], v[188:191], 0
s_add_u32 s68, s68, s67
v_exp_f32 v118, v118
v_mfma_f32_16x16x32_bf16 a[92:95], a[200:203], v[184:187], a[92:95]
s_add_u32 s67, s67, s69
ds_read_b128 a[152:155], v2 offset:2048
v_cvt_pk_bf16_f32 v206, v132, v133
v_mfma_f32_16x16x32_bf16 a[60:63], a[200:203], v[160:163], 0
ds_read_b128 a[156:159], v2 offset:3072
v_cvt_pk_bf16_f32 v207, v134, v135
v_mfma_f32_16x16x32_bf16 a[60:63], a[204:207], v[164:167], a[60:63]
s_mov_b64 exec, 1
buffer_atomic_add a251, v19, s[52:55], s67 offen offset:0 sc1
buffer_atomic_add a251, v19, s[52:55], s68 offen offset:0 sc1
s_mov_b64 exec, -1
v_mfma_f32_16x16x32_bf16 a[28:31], a[204:207], v[156:159], 0
s_add_u32 s17, s78, L_T-L_pc+4096
v_exp_f32 v119, v119
v_mfma_f32_16x16x32_bf16 a[28:31], a[200:203], v[152:155], a[28:31]
ds_read_b128 a[160:163], v2 offset:4096
buffer_load_dword a252, v16, s[88:91], s17 offen
ds_read_b128 a[164:167], v2 offset:5120
ds_read_b128 a[168:171], v2 offset:6144
ds_read_b128 a[172:175], v2 offset:7168
v_mul_u32_u24 v19, 52, v0
v_cvt_pk_bf16_f32 v182, v116, v117
v_cvt_pk_bf16_f32 v183, v118, v119
v_xor_b32 v3, 0x8000, v3
v_accvgpr_read_b32 v20, a128
v_max_f32 v1, v1, v20
v_rcp_f32 v20, v20
v_accvgpr_read_b32 v232, a0
v_accvgpr_read_b32 v233, a1
v_accvgpr_read_b32 v234, a2
v_accvgpr_read_b32 v235, a3
v_accvgpr_read_b32 v236, a4
v_accvgpr_read_b32 v237, a5
v_accvgpr_read_b32 v238, a6
v_accvgpr_read_b32 v239, a7
v_mul_f32 v20, v20, v4
v_mul_f32 v232, v232, v20
v_mul_f32 v233, v233, v20
v_mul_f32 v234, v234, v20
v_mul_f32 v235, v235, v20
v_mul_f32 v236, v236, v20
v_mul_f32 v237, v237, v20
v_mul_f32 v238, v238, v20
v_mul_f32 v239, v239, v20
v_cvt_pk_bf16_f32 v232, v232, v233
v_cvt_pk_bf16_f32 v233, v234, v235
v_cvt_pk_bf16_f32 v234, v236, v237
v_cvt_pk_bf16_f32 v235, v238, v239
s_add_u32 s77, s74, 0
buffer_store_dwordx4 v[232:235], v16, s[44:47], s77 offen sc1
v_accvgpr_read_b32 v240, a8
v_accvgpr_read_b32 v241, a9
v_accvgpr_read_b32 v242, a10
v_accvgpr_read_b32 v243, a11
v_accvgpr_read_b32 v244, a12
v_accvgpr_read_b32 v245, a13
v_accvgpr_read_b32 v246, a14
v_accvgpr_read_b32 v247, a15
v_mul_f32 v240, v240, v20
v_mul_f32 v241, v241, v20
v_mul_f32 v242, v242, v20
v_mul_f32 v243, v243, v20
v_mul_f32 v244, v244, v20
v_mul_f32 v245, v245, v20
v_mul_f32 v246, v246, v20
v_mul_f32 v247, v247, v20
v_cvt_pk_bf16_f32 v240, v240, v241
v_cvt_pk_bf16_f32 v241, v242, v243
v_cvt_pk_bf16_f32 v242, v244, v245
v_cvt_pk_bf16_f32 v243, v246, v247
s_add_u32 s77, s74, 8192
buffer_store_dwordx4 v[240:243], v16, s[44:47], s77 offen sc1
v_accvgpr_read_b32 v232, a16
v_accvgpr_read_b32 v233, a17
v_accvgpr_read_b32 v234, a18
v_accvgpr_read_b32 v235, a19
v_accvgpr_read_b32 v236, a20
v_accvgpr_read_b32 v237, a21
v_accvgpr_read_b32 v238, a22
v_accvgpr_read_b32 v239, a23
v_mul_f32 v232, v232, v20
v_mul_f32 v233, v233, v20
v_mul_f32 v234, v234, v20
v_mul_f32 v235, v235, v20
v_mul_f32 v236, v236, v20
v_mul_f32 v237, v237, v20
v_mul_f32 v238, v238, v20
v_mul_f32 v239, v239, v20
v_cvt_pk_bf16_f32 v232, v232, v233
v_cvt_pk_bf16_f32 v233, v234, v235
v_cvt_pk_bf16_f32 v234, v236, v237
v_cvt_pk_bf16_f32 v235, v238, v239
s_add_u32 s77, s74, 16384
buffer_store_dwordx4 v[232:235], v16, s[44:47], s77 offen sc1
s_branch L_T
L_T1:
buffer_load_dword v19, off, s[52:55], s80 sc1
s_add_u32 s17, s78, L_TAIL-L_pc
buffer_load_dword a252, v16, s[88:91], s17 offen
s_add_u32 s17, s78, L_TAIL-L_pc+4096
buffer_load_dword a252, v16, s[88:91], s17 offen
s_add_u32 s17, s78, L_p5f0-L_pc
buffer_load_dword a252, v16, s[88:91], s17 offen
s_add_u32 s17, s78, L_p5f0-L_pc+4096
buffer_load_dword a252, v16, s[88:91], s17 offen
s_waitcnt lgkmcnt(7)
v_mfma_f32_16x16x32_bf16 v[136:139], a[144:147], v[72:75], v[228:231]
s_waitcnt lgkmcnt(6)
ds_read_b128 a[176:179], v2 offset:8192
v_cndmask_b32 v120, v224, v17, s[0:1]
v_mfma_f32_16x16x32_bf16 v[136:139], a[148:151], v[76:79], v[136:139]
s_waitcnt lgkmcnt(6)
ds_read_b128 a[180:183], v2 offset:9216
v_cndmask_b32 v121, v224, v17, s[4:5]
v_cndmask_b32 v122, v224, v17, s[6:7]
v_cndmask_b32 v123, v224, v17, s[8:9]
v_mfma_f32_16x16x32_bf16 v[136:139], a[152:155], v[80:83], v[136:139]
s_waitcnt lgkmcnt(6)
buffer_load_dwordx4 v16, s[32:35], s70 offen offset:2048 sc1 lds
v_mfma_f32_16x16x32_bf16 v[136:139], a[156:159], v[84:87], v[136:139]
ds_read_b128 a[184:187], v2 offset:10240
v_cndmask_b32 v124, v224, v17, s[10:11]
v_mfma_f32_16x16x32_bf16 v[120:123], a[156:159], v[68:71], v[120:123]
ds_read_b128 a[188:191], v2 offset:11264
v_cndmask_b32 v125, v224, v17, s[12:13]
v_mfma_f32_16x16x32_bf16 v[120:123], a[152:155], v[64:67], v[120:123]
ds_read_b128 a[192:195], v2 offset:12288
v_cndmask_b32 v126, v224, v17, s[18:19]
v_mfma_f32_16x16x32_bf16 v[120:123], a[148:151], v[60:63], v[120:123]
ds_read_b128 a[196:199], v2 offset:13312
v_cndmask_b32 v127, v224, v17, s[22:23]
v_mfma_f32_16x16x32_bf16 v[120:123], a[144:147], v[56:59], v[120:123]
s_waitcnt lgkmcnt(4)
ds_read_b128 a[200:203], v2 offset:14336
v_cndmask_b32 v128, v224, v17, s[26:27]
v_mfma_f32_16x16x32_bf16 v[140:143], a[160:163], v[72:75], v[228:231]
ds_read_b128 a[204:207], v2 offset:15360
v_cndmask_b32 v129, v224, v17, s[56:57]
v_mfma_f32_16x16x32_bf16 v[140:143], a[164:167], v[76:79], v[140:143]
ds_read_b128 a[144:147], v3 offset:0
v_cndmask_b32 v130, v224, v17, s[58:59]
v_mfma_f32_16x16x32_bf16 v[140:143], a[168:171], v[80:83], v[140:143]
v_exp_f32 v136, v136
v_mfma_f32_16x16x32_bf16 v[140:143], a[172:175], v[84:87], v[140:143]
v_exp_f32 v137, v137
v_mfma_f32_16x16x32_bf16 v[124:127], a[172:175], v[68:71], v[124:127]
ds_read_b128 a[148:151], v3 offset:8192
v_cndmask_b32 v131, v224, v17, s[60:61]
v_mfma_f32_16x16x32_bf16 v[124:127], a[168:171], v[64:67], v[124:127]
buffer_load_dwordx4 v16, s[32:35], s70 offen offset:3072 sc1 lds
v_mfma_f32_16x16x32_bf16 v[124:127], a[164:167], v[60:63], v[124:127]
s_mul_i32 s69, s83, 8
v_exp_f32 v138, v138
v_mfma_f32_16x16x32_bf16 v[124:127], a[160:163], v[56:59], v[124:127]
s_sub_u32 s69, 36, s69
v_exp_f32 v139, v139
v_mfma_f32_16x16x32_bf16 v[128:131], a[176:179], v[56:59], v[128:131]
v_exp_f32 v120, v120
v_mfma_f32_16x16x32_bf16 v[128:131], a[180:183], v[60:63], v[128:131]
s_waitcnt lgkmcnt(1)
v_exp_f32 v121, v121
v_mfma_f32_16x16x32_bf16 v[128:131], a[184:187], v[64:67], v[128:131]
v_exp_f32 v122, v122
v_mfma_f32_16x16x32_bf16 v[128:131], a[188:191], v[68:71], v[128:131]
s_add_u32 m0, s71, 4096
ds_read_b128 a[152:155], v3 offset:1024
v_cndmask_b32 v132, v224, v17, s[62:63]
v_mfma_f32_16x16x32_bf16 v[144:147], a[188:191], v[84:87], v[228:231]
s_add_u32 s64, s70, 4096
v_cvt_pk_bf16_f32 v192, v136, v137
v_cndmask_b32 v133, v224, v17, s[48:49]
v_mfma_f32_16x16x32_bf16 v[144:147], a[184:187], v[80:83], v[144:147]
buffer_load_dwordx4 v16, s[32:35], s64 offen offset:0 sc1 lds
v_mfma_f32_16x16x32_bf16 v[144:147], a[180:183], v[76:79], v[144:147]
ds_read_b128 a[156:159], v3 offset:9216
v_cndmask_b32 v134, v224, v17, s[50:51]
v_mfma_f32_16x16x32_bf16 v[144:147], a[176:179], v[72:75], v[144:147]
ds_read_b128 a[160:163], v3 offset:2048
v_cndmask_b32 v135, v224, v17, s[100:101]
v_mfma_f32_16x16x32_bf16 v[148:151], a[192:195], v[72:75], v[228:231]
v_exp_f32 v123, v123
v_mfma_f32_16x16x32_bf16 v[148:151], a[196:199], v[76:79], v[148:151]
v_cvt_pk_bf16_f32 v193, v138, v139
v_cvt_pk_bf16_f32 v184, v120, v121
v_mfma_f32_16x16x32_bf16 v[148:151], a[200:203], v[80:83], v[148:151]
v_exp_f32 v140, v140
v_mfma_f32_16x16x32_bf16 v[148:151], a[204:207], v[84:87], v[148:151]
v_exp_f32 v141, v141
v_mfma_f32_16x16x32_bf16 v[132:135], a[204:207], v[68:71], v[132:135]
v_exp_f32 v142, v142
v_mfma_f32_16x16x32_bf16 v[132:135], a[200:203], v[64:67], v[132:135]
v_exp_f32 v143, v143
v_mfma_f32_16x16x32_bf16 v[132:135], a[196:199], v[60:63], v[132:135]
v_exp_f32 v124, v124
v_mfma_f32_16x16x32_bf16 v[132:135], a[192:195], v[56:59], v[132:135]
buffer_load_dwordx4 v16, s[32:35], s64 offen offset:1024 sc1 lds
v_mfma_f32_16x16x32_bf16 a[132:135], a[244:247], v[176:179], a[132:135]
v_exp_f32 v125, v125
v_mfma_f32_16x16x32_bf16 a[132:135], a[244:247], v[180:183], a[132:135]
ds_read_b128 a[164:167], v3 offset:10240
v_accvgpr_read_b32 v240, a24
v_mfma_f32_16x16x32_bf16 a[136:139], a[244:247], v[200:203], a[136:139]
ds_read_b128 a[168:171], v3 offset:3072
v_accvgpr_read_b32 v241, a25
v_mfma_f32_16x16x32_bf16 a[136:139], a[244:247], v[204:207], a[136:139]
v_cvt_pk_bf16_f32 v185, v122, v123
v_cvt_pk_bf16_f32 v194, v140, v141
v_mfma_f32_16x16x32_bf16 a[140:143], a[244:247], v[208:211], a[140:143]
ds_read_b128 a[172:175], v3 offset:11264
v_accvgpr_read_b32 v242, a26
v_mfma_f32_16x16x32_bf16 a[140:143], a[244:247], v[212:215], a[140:143]
ds_read_b128 a[176:179], v3 offset:4096
v_accvgpr_read_b32 v243, a27
v_mfma_f32_16x16x32_bf16 a[32:35], a[144:147], v[176:179], a[32:35]
s_waitcnt lgkmcnt(4)
ds_read_b128 a[180:183], v3 offset:12288
v_accvgpr_read_b32 v244, a28
v_mfma_f32_16x16x32_bf16 a[32:35], a[148:151], v[180:183], a[32:35]
ds_read_b128 a[184:187], v3 offset:5120
v_accvgpr_read_b32 v245, a29
v_mfma_f32_16x16x32_bf16 a[64:67], a[148:151], v[204:207], a[64:67]
ds_read_b128 a[188:191], v3 offset:13312
v_accvgpr_read_b32 v246, a30
v_mfma_f32_16x16x32_bf16 a[64:67], a[144:147], v[200:203], a[64:67]
ds_read_b128 a[192:195], v3 offset:6144
v_accvgpr_read_b32 v247, a31
v_mfma_f32_16x16x32_bf16 a[96:99], a[144:147], v[208:211], a[96:99]
ds_read_b128 a[196:199], v3 offset:14336
v_mul_f32 v240, v240, v20
v_mul_f32 v241, v241, v20
v_mul_f32 v242, v242, v20
v_mul_f32 v243, v243, v20
v_mul_f32 v244, v244, v20
v_mul_f32 v245, v245, v20
v_mul_f32 v246, v246, v20
v_mul_f32 v247, v247, v20
v_cvt_pk_bf16_f32 v240, v240, v241
v_cvt_pk_bf16_f32 v241, v242, v243
v_cvt_pk_bf16_f32 v242, v244, v245
v_cvt_pk_bf16_f32 v243, v246, v247
s_add_u32 s77, s74, 24576
buffer_store_dwordx4 v[240:243], v16, s[44:47], s77 offen sc1
v_mfma_f32_16x16x32_bf16 a[96:99], a[148:151], v[212:215], a[96:99]
v_exp_f32 v126, v126
v_mfma_f32_16x16x32_bf16 a[100:103], a[156:159], v[212:215], a[100:103]
buffer_load_dwordx4 v16, s[32:35], s64 offen offset:2048 sc1 lds
v_cvt_pk_bf16_f32 v195, v142, v143
v_mfma_f32_16x16x32_bf16 a[100:103], a[152:155], v[208:211], a[100:103]
v_exp_f32 v127, v127
v_mfma_f32_16x16x32_bf16 a[68:71], a[152:155], v[200:203], a[68:71]
v_exp_f32 v128, v128
v_mfma_f32_16x16x32_bf16 a[68:71], a[156:159], v[204:207], a[68:71]
v_exp_f32 v129, v129
v_mfma_f32_16x16x32_bf16 a[36:39], a[156:159], v[180:183], a[36:39]
v_exp_f32 v130, v130
v_mfma_f32_16x16x32_bf16 a[36:39], a[152:155], v[176:179], a[36:39]
v_cvt_pk_bf16_f32 v186, v124, v125
v_cvt_pk_bf16_f32 v187, v126, v127
v_mfma_f32_16x16x32_bf16 a[40:43], a[160:163], v[176:179], a[40:43]
s_waitcnt lgkmcnt(0)
v_exp_f32 v131, v131
v_mfma_f32_16x16x32_bf16 a[40:43], a[164:167], v[180:183], a[40:43]
buffer_load_dwordx4 v16, s[32:35], s64 offen offset:3072 sc1 lds
v_mfma_f32_16x16x32_bf16 a[72:75], a[164:167], v[204:207], a[72:75]
v_exp_f32 v144, v144
v_mfma_f32_16x16x32_bf16 a[72:75], a[160:163], v[200:203], a[72:75]
v_exp_f32 v145, v145
v_mfma_f32_16x16x32_bf16 a[104:107], a[160:163], v[208:211], a[104:107]
v_exp_f32 v146, v146
v_mfma_f32_16x16x32_bf16 a[104:107], a[164:167], v[212:215], a[104:107]
ds_read_b128 a[200:203], v3 offset:7168
v_cvt_pk_bf16_f32 v188, v128, v129
v_mfma_f32_16x16x32_bf16 a[108:111], a[172:175], v[212:215], a[108:111]
ds_read_b128 a[204:207], v3 offset:15360
v_cvt_pk_bf16_f32 v189, v130, v131
v_mfma_f32_16x16x32_bf16 a[108:111], a[168:171], v[208:211], a[108:111]
v_exp_f32 v147, v147
v_mfma_f32_16x16x32_bf16 a[76:79], a[168:171], v[200:203], a[76:79]
v_exp_f32 v148, v148
v_mfma_f32_16x16x32_bf16 a[76:79], a[172:175], v[204:207], a[76:79]
v_exp_f32 v149, v149
v_mfma_f32_16x16x32_bf16 a[44:47], a[172:175], v[180:183], a[44:47]
v_exp_f32 v150, v150
v_mfma_f32_16x16x32_bf16 a[44:47], a[168:171], v[176:179], a[44:47]
v_exp_f32 v151, v151
v_mfma_f32_16x16x32_bf16 a[48:51], a[176:179], v[176:179], a[48:51]
v_exp_f32 v132, v132
v_mfma_f32_16x16x32_bf16 a[48:51], a[180:183], v[180:183], a[48:51]
s_waitcnt vmcnt(14)
s_barrier
v_mfma_f32_16x16x32_bf16 a[80:83], a[180:183], v[204:207], a[80:83]
v_exp_f32 v133, v133
v_mfma_f32_16x16x32_bf16 a[80:83], a[176:179], v[200:203], a[80:83]
ds_read_b128 a[144:147], v2 offset:16384
v_cvt_pk_bf16_f32 v196, v144, v145
v_mfma_f32_16x16x32_bf16 a[112:115], a[176:179], v[208:211], a[112:115]
v_exp_f32 v134, v134
v_mfma_f32_16x16x32_bf16 a[112:115], a[180:183], v[212:215], a[112:115]
ds_read_b128 a[148:151], v2 offset:17408
v_cvt_pk_bf16_f32 v197, v146, v147
v_mfma_f32_16x16x32_bf16 a[116:119], a[188:191], v[212:215], a[116:119]
ds_read_b128 a[152:155], v2 offset:18432
v_cvt_pk_bf16_f32 v198, v148, v149
v_mfma_f32_16x16x32_bf16 a[116:119], a[184:187], v[208:211], a[116:119]
ds_read_b128 a[156:159], v2 offset:19456
v_cvt_pk_bf16_f32 v199, v150, v151
v_mfma_f32_16x16x32_bf16 a[84:87], a[184:187], v[200:203], a[84:87]
s_waitcnt vmcnt(11)
v_readfirstlane_b32 vcc_lo, v19
s_nop 0
s_cmp_lt_u32 vcc_lo, s69
s_cbranch_scc1 L_spin_1012
L_spinbk_1013:
v_mfma_f32_16x16x32_bf16 a[84:87], a[188:191], v[204:207], a[84:87]
ds_read_b128 a[160:163], v2 offset:20480
v_cndmask_b32 v136, v228, v17, s[0:1]
v_mfma_f32_16x16x32_bf16 a[52:55], a[188:191], v[180:183], a[52:55]
ds_read_b128 a[164:167], v2 offset:21504
v_cndmask_b32 v137, v228, v17, s[4:5]
v_mfma_f32_16x16x32_bf16 a[52:55], a[184:187], v[176:179], a[52:55]
ds_read_b128 a[168:171], v2 offset:22528
v_cndmask_b32 v138, v228, v17, s[6:7]
v_mfma_f32_16x16x32_bf16 a[56:59], a[192:195], v[176:179], a[56:59]
ds_read_b128 a[172:175], v2 offset:23552
v_cndmask_b32 v139, v228, v17, s[8:9]
v_mfma_f32_16x16x32_bf16 a[56:59], a[196:199], v[180:183], a[56:59]
v_exp_f32 v135, v135
v_mfma_f32_16x16x32_bf16 a[88:91], a[196:199], v[204:207], a[88:91]
v_cndmask_b32 v140, v228, v17, s[10:11]
v_cvt_pk_bf16_f32 v190, v132, v133
v_mfma_f32_16x16x32_bf16 a[88:91], a[192:195], v[200:203], a[88:91]
v_cndmask_b32 v141, v228, v17, s[12:13]
v_cvt_pk_bf16_f32 v191, v134, v135
v_mfma_f32_16x16x32_bf16 a[120:123], a[192:195], v[208:211], a[120:123]
v_cndmask_b32 v142, v228, v17, s[18:19]
v_cndmask_b32 v143, v228, v17, s[22:23]
v_mfma_f32_16x16x32_bf16 a[120:123], a[196:199], v[212:215], a[120:123]
s_waitcnt lgkmcnt(1)
v_cndmask_b32 v144, v228, v17, s[26:27]
v_cndmask_b32 v145, v228, v17, s[56:57]
v_mfma_f32_16x16x32_bf16 a[124:127], a[204:207], v[212:215], a[124:127]
v_cndmask_b32 v146, v228, v17, s[58:59]
v_cndmask_b32 v147, v228, v17, s[60:61]
v_mfma_f32_16x16x32_bf16 a[124:127], a[200:203], v[208:211], a[124:127]
v_cndmask_b32 v148, v228, v17, s[62:63]
v_cndmask_b32 v149, v228, v17, s[48:49]
v_mfma_f32_16x16x32_bf16 a[92:95], a[200:203], v[200:203], a[92:95]
v_cndmask_b32 v150, v228, v17, s[50:51]
v_cndmask_b32 v151, v228, v17, s[100:101]
v_mfma_f32_16x16x32_bf16 a[92:95], a[204:207], v[204:207], a[92:95]
v_accvgpr_read_b32 v21, a132
v_max_f32 v1, v1, v21
v_mfma_f32_16x16x32_bf16 a[60:63], a[204:207], v[180:183], a[60:63]
v_rcp_f32 v21, v21
v_mfma_f32_16x16x32_bf16 a[60:63], a[200:203], v[176:179], a[60:63]
v_accvgpr_read_b32 v232, a32
v_accvgpr_read_b32 v233, a33
v_mfma_f32_16x16x32_bf16 v[136:139], a[144:147], v[72:75], v[136:139]
ds_read_b128 a[176:179], v2 offset:24576
v_accvgpr_read_b32 v234, a34
v_mfma_f32_16x16x32_bf16 v[136:139], a[148:151], v[76:79], v[136:139]
ds_read_b128 a[180:183], v2 offset:25600
v_accvgpr_read_b32 v235, a35
v_mfma_f32_16x16x32_bf16 v[136:139], a[152:155], v[80:83], v[136:139]
ds_read_b128 a[184:187], v2 offset:26624
v_accvgpr_read_b32 v236, a36
v_mfma_f32_16x16x32_bf16 v[136:139], a[156:159], v[84:87], v[136:139]
s_waitcnt lgkmcnt(3)
ds_read_b128 a[188:191], v2 offset:27648
v_accvgpr_read_b32 v237, a37
v_mfma_f32_16x16x32_bf16 v[140:143], a[172:175], v[84:87], v[140:143]
ds_read_b128 a[192:195], v2 offset:28672
ds_read_b128 a[196:199], v2 offset:29696
ds_read_b128 a[200:203], v2 offset:30720
ds_read_b128 a[204:207], v2 offset:31744
v_mfma_f32_16x16x32_bf16 v[140:143], a[168:171], v[80:83], v[140:143]
ds_read_b128 a[144:147], v3 offset:16384
v_accvgpr_read_b32 v238, a38
v_mfma_f32_16x16x32_bf16 v[140:143], a[164:167], v[76:79], v[140:143]
ds_read_b128 a[148:151], v3 offset:24576
v_accvgpr_read_b32 v239, a39
v_mfma_f32_16x16x32_bf16 v[140:143], a[160:163], v[72:75], v[140:143]
s_waitcnt lgkmcnt(8)
ds_read_b128 a[152:155], v3 offset:17408
v_mul_f32 v21, v21, v6
v_mfma_f32_16x16x32_bf16 v[144:147], a[176:179], v[72:75], v[144:147]
ds_read_b128 a[156:159], v3 offset:25600
v_mul_f32 v232, v232, v21
v_mfma_f32_16x16x32_bf16 v[144:147], a[180:183], v[76:79], v[144:147]
s_waitcnt lgkmcnt(8)
ds_read_b128 a[160:163], v3 offset:18432
v_mul_f32 v233, v233, v21
v_mfma_f32_16x16x32_bf16 v[144:147], a[184:187], v[80:83], v[144:147]
ds_read_b128 a[164:167], v3 offset:26624
v_mul_f32 v234, v234, v21
v_mul_f32 v235, v235, v21
v_mul_f32 v236, v236, v21
v_mul_f32 v237, v237, v21
v_mul_f32 v238, v238, v21
v_mul_f32 v239, v239, v21
v_cvt_pk_bf16_f32 v232, v232, v233
v_cvt_pk_bf16_f32 v233, v234, v235
v_cvt_pk_bf16_f32 v234, v236, v237
v_cvt_pk_bf16_f32 v235, v238, v239
s_add_u32 s77, s74, 4096
buffer_store_dwordx4 v[232:235], v16, s[44:47], s77 offen sc1
v_accvgpr_read_b32 v240, a40
v_accvgpr_read_b32 v241, a41
v_accvgpr_read_b32 v242, a42
v_accvgpr_read_b32 v243, a43
v_accvgpr_read_b32 v244, a44
v_accvgpr_read_b32 v245, a45
v_accvgpr_read_b32 v246, a46
v_accvgpr_read_b32 v247, a47
v_mul_f32 v240, v240, v21
v_mul_f32 v241, v241, v21
v_mul_f32 v242, v242, v21
v_mul_f32 v243, v243, v21
v_mul_f32 v244, v244, v21
v_mul_f32 v245, v245, v21
v_mul_f32 v246, v246, v21
v_mul_f32 v247, v247, v21
v_cvt_pk_bf16_f32 v240, v240, v241
v_cvt_pk_bf16_f32 v241, v242, v243
v_cvt_pk_bf16_f32 v242, v244, v245
v_cvt_pk_bf16_f32 v243, v246, v247
s_add_u32 s77, s74, 12288
buffer_store_dwordx4 v[240:243], v16, s[44:47], s77 offen sc1
v_accvgpr_read_b32 v232, a48
v_accvgpr_read_b32 v233, a49
v_accvgpr_read_b32 v234, a50
v_accvgpr_read_b32 v235, a51
v_accvgpr_read_b32 v236, a52
v_accvgpr_read_b32 v237, a53
v_accvgpr_read_b32 v238, a54
v_accvgpr_read_b32 v239, a55
v_mul_f32 v232, v232, v21
v_mul_f32 v233, v233, v21
v_mul_f32 v234, v234, v21
v_mul_f32 v235, v235, v21
v_mul_f32 v236, v236, v21
v_mul_f32 v237, v237, v21
v_mul_f32 v238, v238, v21
v_mul_f32 v239, v239, v21
v_cvt_pk_bf16_f32 v232, v232, v233
v_cvt_pk_bf16_f32 v233, v234, v235
v_cvt_pk_bf16_f32 v234, v236, v237
v_cvt_pk_bf16_f32 v235, v238, v239
s_add_u32 s77, s74, 20480
buffer_store_dwordx4 v[232:235], v16, s[44:47], s77 offen sc1
v_accvgpr_read_b32 v240, a56
v_accvgpr_read_b32 v241, a57
v_accvgpr_read_b32 v242, a58
v_accvgpr_read_b32 v243, a59
v_accvgpr_read_b32 v244, a60
v_accvgpr_read_b32 v245, a61
v_accvgpr_read_b32 v246, a62
v_accvgpr_read_b32 v247, a63
v_mul_f32 v240, v240, v21
v_mul_f32 v241, v241, v21
v_mul_f32 v242, v242, v21
v_mul_f32 v243, v243, v21
v_mul_f32 v244, v244, v21
v_mul_f32 v245, v245, v21
v_mul_f32 v246, v246, v21
v_mul_f32 v247, v247, v21
v_cvt_pk_bf16_f32 v240, v240, v241
v_cvt_pk_bf16_f32 v241, v242, v243
v_cvt_pk_bf16_f32 v242, v244, v245
v_cvt_pk_bf16_f32 v243, v246, v247
s_add_u32 s77, s74, 28672
buffer_store_dwordx4 v[240:243], v16, s[44:47], s77 offen sc1
v_exp_f32 v136, v136
v_mfma_f32_16x16x32_bf16 v[144:147], a[188:191], v[84:87], v[144:147]
s_waitcnt lgkmcnt(5)
v_exp_f32 v137, v137
v_mfma_f32_16x16x32_bf16 v[148:151], a[204:207], v[84:87], v[148:151]
v_exp_f32 v138, v138
v_mfma_f32_16x16x32_bf16 v[148:151], a[200:203], v[80:83], v[148:151]
s_add_u32 s65, s84, 0
v_exp_f32 v139, v139
v_mfma_f32_16x16x32_bf16 v[148:151], a[196:199], v[76:79], v[148:151]
buffer_load_dwordx4 a[208:211], v14, s[44:47], s65 offen offset:0 sc1
v_mfma_f32_16x16x32_bf16 v[148:151], a[192:195], v[72:75], v[148:151]
v_exp_f32 v140, v140
v_mfma_f32_16x16x32_bf16 a[136:139], a[244:247], v[184:187], a[136:139]
buffer_load_dwordx4 a[216:219], v14, s[44:47], s65 offen offset:1024 sc1
v_mfma_f32_16x16x32_bf16 a[136:139], a[244:247], v[188:191], a[136:139]
v_exp_f32 v141, v141
v_mfma_f32_16x16x32_bf16 a[140:143], a[244:247], v[192:195], a[140:143]
ds_read_b128 a[168:171], v3 offset:19456
v_cvt_pk_bf16_f32 v208, v136, v137
v_mfma_f32_16x16x32_bf16 a[140:143], a[244:247], v[196:199], a[140:143]
buffer_load_dwordx4 a[224:227], v15, s[44:47], s65 offen offset:0 sc1
v_mfma_f32_16x16x32_bf16 a[64:67], a[144:147], v[184:187], a[64:67]
s_waitcnt lgkmcnt(1)
ds_read_b128 a[172:175], v3 offset:27648
v_cvt_pk_bf16_f32 v209, v138, v139
v_mfma_f32_16x16x32_bf16 a[64:67], a[148:151], v[188:191], a[64:67]
v_exp_f32 v142, v142
v_mfma_f32_16x16x32_bf16 a[96:99], a[148:151], v[196:199], a[96:99]
buffer_load_dwordx4 a[232:235], v15, s[44:47], s65 offen offset:1024 sc1
v_mfma_f32_16x16x32_bf16 a[96:99], a[144:147], v[192:195], a[96:99]
s_add_u32 s65, s84, 8192
ds_read_b128 a[176:179], v3 offset:20480
v_cvt_pk_bf16_f32 v210, v140, v141
v_mfma_f32_16x16x32_bf16 a[100:103], a[152:155], v[192:195], a[100:103]
buffer_load_dwordx4 a[212:215], v14, s[44:47], s65 offen offset:0 sc1
v_mfma_f32_16x16x32_bf16 a[100:103], a[156:159], v[196:199], a[100:103]
v_exp_f32 v143, v143
v_mfma_f32_16x16x32_bf16 a[68:71], a[156:159], v[188:191], a[68:71]
ds_read_b128 a[180:183], v3 offset:28672
v_xor_b32 v2, 0x8000, v2
v_mfma_f32_16x16x32_bf16 a[68:71], a[152:155], v[184:187], a[68:71]
buffer_load_dwordx4 a[220:223], v14, s[44:47], s65 offen offset:1024 sc1
v_mfma_f32_16x16x32_bf16 a[72:75], a[160:163], v[184:187], a[72:75]
v_exp_f32 v144, v144
v_mfma_f32_16x16x32_bf16 a[72:75], a[164:167], v[188:191], a[72:75]
ds_read_b128 a[184:187], v3 offset:21504
v_cvt_pk_bf16_f32 v211, v142, v143
v_mfma_f32_16x16x32_bf16 a[104:107], a[164:167], v[196:199], a[104:107]
buffer_load_dwordx4 a[228:231], v15, s[44:47], s65 offen offset:0 sc1
v_mfma_f32_16x16x32_bf16 a[104:107], a[160:163], v[192:195], a[104:107]
s_waitcnt lgkmcnt(2)
ds_read_b128 a[188:191], v3 offset:29696
v_accvgpr_read_b32 v22, a136
v_mfma_f32_16x16x32_bf16 a[108:111], a[168:171], v[192:195], a[108:111]
v_exp_f32 v145, v145
v_mfma_f32_16x16x32_bf16 a[108:111], a[172:175], v[196:199], a[108:111]
buffer_load_dwordx4 a[236:239], v15, s[44:47], s65 offen offset:1024 sc1
v_mfma_f32_16x16x32_bf16 a[76:79], a[172:175], v[188:191], a[76:79]
v_exp_f32 v146, v146
v_mfma_f32_16x16x32_bf16 a[76:79], a[168:171], v[184:187], a[76:79]
s_add_u32 s65, s84, 32768
ds_read_b128 a[192:195], v3 offset:22528
v_cvt_pk_bf16_f32 v212, v144, v145
v_mfma_f32_16x16x32_bf16 a[80:83], a[176:179], v[184:187], a[80:83]
s_waitcnt lgkmcnt(2)
buffer_load_dwordx4 v[152:155], v14, s[44:47], s65 offen offset:0 sc1
v_mfma_f32_16x16x32_bf16 a[80:83], a[180:183], v[188:191], a[80:83]
ds_read_b128 a[196:199], v3 offset:30720
ds_read_b128 a[200:203], v3 offset:23552
ds_read_b128 a[204:207], v3 offset:31744
v_mfma_f32_16x16x32_bf16 a[112:115], a[180:183], v[196:199], a[112:115]
s_waitcnt vmcnt(13)
s_barrier
v_xor_b32 v3, 0x8000, v3
v_mfma_f32_16x16x32_bf16 a[112:115], a[176:179], v[192:195], a[112:115]
buffer_load_dwordx4 v[160:163], v14, s[44:47], s65 offen offset:1024 sc1
v_exp_f32 v147, v147
v_mfma_f32_16x16x32_bf16 a[116:119], a[184:187], v[192:195], a[116:119]
s_waitcnt lgkmcnt(4)
v_exp_f32 v148, v148
v_mfma_f32_16x16x32_bf16 a[116:119], a[188:191], v[196:199], a[116:119]
buffer_load_dwordx4 v[168:171], v15, s[44:47], s65 offen offset:0 sc1
v_mfma_f32_16x16x32_bf16 a[84:87], a[188:191], v[188:191], a[84:87]
v_exp_f32 v149, v149
v_mfma_f32_16x16x32_bf16 a[84:87], a[184:187], v[184:187], a[84:87]
s_waitcnt lgkmcnt(0)
buffer_load_dwordx4 v[176:179], v15, s[44:47], s65 offen offset:1024 sc1
v_mfma_f32_16x16x32_bf16 a[88:91], a[192:195], v[184:187], a[88:91]
s_add_u32 s65, s84, 40960
ds_read_b128 a[144:147], v3 offset:0
v_cvt_pk_bf16_f32 v213, v146, v147
v_mfma_f32_16x16x32_bf16 a[88:91], a[196:199], v[188:191], a[88:91]
buffer_load_dwordx4 v[156:159], v14, s[44:47], s65 offen offset:0 sc1
v_mfma_f32_16x16x32_bf16 a[120:123], a[196:199], v[196:199], a[120:123]
v_exp_f32 v150, v150
v_mfma_f32_16x16x32_bf16 a[120:123], a[192:195], v[192:195], a[120:123]
buffer_load_dwordx4 v[164:167], v14, s[44:47], s65 offen offset:1024 sc1
ds_read_b128 a[148:151], v3 offset:8192
v_mfma_f32_16x16x32_bf16 a[124:127], a[200:203], v[192:195], a[124:127]
ds_read_b128 a[152:155], v3 offset:1024
v_cvt_pk_bf16_f32 v214, v148, v149
v_mfma_f32_16x16x32_bf16 a[124:127], a[204:207], v[196:199], a[124:127]
buffer_load_dwordx4 v[172:175], v15, s[44:47], s65 offen offset:0 sc1
ds_read_b128 a[156:159], v3 offset:9216
v_mfma_f32_16x16x32_bf16 a[92:95], a[204:207], v[188:191], a[92:95]
v_exp_f32 v151, v151
v_mfma_f32_16x16x32_bf16 a[92:95], a[200:203], v[184:187], a[92:95]
buffer_load_dwordx4 v[180:183], v15, s[44:47], s65 offen offset:1024 sc1
ds_read_b128 a[160:163], v3 offset:2048
ds_read_b128 a[164:167], v3 offset:10240
ds_read_b128 a[168:171], v3 offset:3072
ds_read_b128 a[172:175], v3 offset:11264
v_cvt_pk_bf16_f32 v215, v150, v151
v_max_f32 v1, v1, v22
v_rcp_f32 v22, v22
v_accvgpr_read_b32 v232, a64
v_accvgpr_read_b32 v233, a65
v_accvgpr_read_b32 v234, a66
v_accvgpr_read_b32 v235, a67
v_accvgpr_read_b32 v236, a68
v_accvgpr_read_b32 v237, a69
v_accvgpr_read_b32 v238, a70
v_accvgpr_read_b32 v239, a71
v_mul_f32 v22, v22, v8
v_mul_f32 v232, v232, v22
v_mul_f32 v233, v233, v22
v_mul_f32 v234, v234, v22
v_mul_f32 v235, v235, v22
v_mul_f32 v236, v236, v22
v_mul_f32 v237, v237, v22
v_mul_f32 v238, v238, v22
v_mul_f32 v239, v239, v22
v_cvt_pk_bf16_f32 v232, v232, v233
v_cvt_pk_bf16_f32 v233, v234, v235
v_cvt_pk_bf16_f32 v234, v236, v237
v_cvt_pk_bf16_f32 v235, v238, v239
s_add_u32 s77, s75, 0
buffer_store_dwordx4 v[232:235], v16, s[44:47], s77 offen sc1
s_branch L_TAIL
L_fallback_11:
s_waitcnt vmcnt(0) lgkmcnt(0)
s_barrier
s_mov_b32 s73, 1
s_mov_b32 s81, 0
v_and_b32 v232, 15, v0
v_lshrrev_b32 v233, 4, v0
v_lshlrev_b32 v233, 2, v233
v_sub_u32 v232, v232, v233
s_lshl_b32 s66, s30, 4
v_add_u32 v232, s66, v232
s_lshl_b32 s66, s16, 7
v_add_u32 v234, s66, v232
s_lshl_b32 s66, s3, 7
v_add_u32 v232, s66, v232
v_add_u32 v233, 64, v232
v_add_u32 v235, 64, v234
s_mov_b32 m0, s76
s_lshl_b32 s64, s30, 14
s_nop 0
buffer_load_dwordx4 v16, s[32:35], s64 offen offset:0 sc1 lds
s_nop 0
buffer_load_dwordx4 v16, s[32:35], s64 offen offset:1024 sc1 lds
s_nop 0
buffer_load_dwordx4 v16, s[32:35], s64 offen offset:2048 sc1 lds
s_nop 0
buffer_load_dwordx4 v16, s[32:35], s64 offen offset:3072 sc1 lds
s_add_u32 m0, s76, 4096
s_add_u32 s64, s64, 4096
s_nop 0
buffer_load_dwordx4 v16, s[32:35], s64 offen offset:0 sc1 lds
s_nop 0
buffer_load_dwordx4 v16, s[32:35], s64 offen offset:1024 sc1 lds
s_nop 0
buffer_load_dwordx4 v16, s[32:35], s64 offen offset:2048 sc1 lds
s_nop 0
buffer_load_dwordx4 v16, s[32:35], s64 offen offset:3072 sc1 lds
s_lshr_b32 s64, s76, 1
s_add_u32 m0, s64, 81920
s_and_b32 s71, s64, 8192
s_add_u32 s64, s64, s71
s_add_u32 s64, s64, 8192
s_nop 0
buffer_load_dwordx4 v16, s[32:35], s64 offen offset:0 sc1 lds
s_nop 0
buffer_load_dwordx4 v16, s[32:35], s64 offen offset:1024 sc1 lds
s_nop 0
buffer_load_dwordx4 v16, s[32:35], s64 offen offset:2048 sc1 lds
s_nop 0
buffer_load_dwordx4 v16, s[32:35], s64 offen offset:3072 sc1 lds
v_mov_b32 v20, 0xff800000
v_mov_b32 v21, 0xff800000
v_mov_b32 v22, 0xff800000
v_mov_b32 v23, 0xff800000
L_fbl_1015:
buffer_load_dwordx4 a[144:147], v16, s[32:35], s81 offen offset:0 sc1
buffer_load_dwordx4 a[148:151], v16, s[32:35], s81 offen offset:1024 sc1
buffer_load_dwordx4 a[152:155], v16, s[32:35], s81 offen offset:2048 sc1
buffer_load_dwordx4 a[156:159], v16, s[32:35], s81 offen offset:3072 sc1
s_add_u32 s64, s81, 4096
buffer_load_dwordx4 a[160:163], v16, s[32:35], s64 offen offset:0 sc1
buffer_load_dwordx4 a[164:167], v16, s[32:35], s64 offen offset:1024 sc1
buffer_load_dwordx4 a[168:171], v16, s[32:35], s64 offen offset:2048 sc1
buffer_load_dwordx4 a[172:175], v16, s[32:35], s64 offen offset:3072 sc1
v_subrev_u32 v88, 0, v232
v_ashrrev_i32 v88, 31, v88
v_and_b32 v88, 0xff800000, v88
v_subrev_u32 v89, 1, v232
v_ashrrev_i32 v89, 31, v89
v_and_b32 v89, 0xff800000, v89
v_subrev_u32 v90, 2, v232
v_ashrrev_i32 v90, 31, v90
v_and_b32 v90, 0xff800000, v90
v_subrev_u32 v91, 3, v232
v_ashrrev_i32 v91, 31, v91
v_and_b32 v91, 0xff800000, v91
v_subrev_u32 v92, 16, v232
v_ashrrev_i32 v92, 31, v92
v_and_b32 v92, 0xff800000, v92
v_subrev_u32 v93, 17, v232
v_ashrrev_i32 v93, 31, v93
v_and_b32 v93, 0xff800000, v93
v_subrev_u32 v94, 18, v232
v_ashrrev_i32 v94, 31, v94
v_and_b32 v94, 0xff800000, v94
v_subrev_u32 v95, 19, v232
v_ashrrev_i32 v95, 31, v95
v_and_b32 v95, 0xff800000, v95
v_subrev_u32 v232, 32, v232
v_subrev_u32 v104, 0, v233
v_ashrrev_i32 v104, 31, v104
v_and_b32 v104, 0xff800000, v104
v_subrev_u32 v105, 1, v233
v_ashrrev_i32 v105, 31, v105
v_and_b32 v105, 0xff800000, v105
v_subrev_u32 v106, 2, v233
v_ashrrev_i32 v106, 31, v106
v_and_b32 v106, 0xff800000, v106
v_subrev_u32 v107, 3, v233
v_ashrrev_i32 v107, 31, v107
v_and_b32 v107, 0xff800000, v107
v_subrev_u32 v108, 16, v233
v_ashrrev_i32 v108, 31, v108
v_and_b32 v108, 0xff800000, v108
v_subrev_u32 v109, 17, v233
v_ashrrev_i32 v109, 31, v109
v_and_b32 v109, 0xff800000, v109
v_subrev_u32 v110, 18, v233
v_ashrrev_i32 v110, 31, v110
v_and_b32 v110, 0xff800000, v110
v_subrev_u32 v111, 19, v233
v_ashrrev_i32 v111, 31, v111
v_and_b32 v111, 0xff800000, v111
v_subrev_u32 v233, 32, v233
v_subrev_u32 v120, 0, v234
v_ashrrev_i32 v120, 31, v120
v_and_b32 v120, 0xff800000, v120
v_subrev_u32 v121, 1, v234
v_ashrrev_i32 v121, 31, v121
v_and_b32 v121, 0xff800000, v121
v_subrev_u32 v122, 2, v234
v_ashrrev_i32 v122, 31, v122
v_and_b32 v122, 0xff800000, v122
v_subrev_u32 v123, 3, v234
v_ashrrev_i32 v123, 31, v123
v_and_b32 v123, 0xff800000, v123
v_subrev_u32 v124, 16, v234
v_ashrrev_i32 v124, 31, v124
v_and_b32 v124, 0xff800000, v124
v_subrev_u32 v125, 17, v234
v_ashrrev_i32 v125, 31, v125
v_and_b32 v125, 0xff800000, v125
v_subrev_u32 v126, 18, v234
v_ashrrev_i32 v126, 31, v126
v_and_b32 v126, 0xff800000, v126
v_subrev_u32 v127, 19, v234
v_ashrrev_i32 v127, 31, v127
v_and_b32 v127, 0xff800000, v127
v_subrev_u32 v234, 32, v234
v_subrev_u32 v136, 0, v235
v_ashrrev_i32 v136, 31, v136
v_and_b32 v136, 0xff800000, v136
v_subrev_u32 v137, 1, v235
v_ashrrev_i32 v137, 31, v137
v_and_b32 v137, 0xff800000, v137
v_subrev_u32 v138, 2, v235
v_ashrrev_i32 v138, 31, v138
v_and_b32 v138, 0xff800000, v138
v_subrev_u32 v139, 3, v235
v_ashrrev_i32 v139, 31, v139
v_and_b32 v139, 0xff800000, v139
v_subrev_u32 v140, 16, v235
v_ashrrev_i32 v140, 31, v140
v_and_b32 v140, 0xff800000, v140
v_subrev_u32 v141, 17, v235
v_ashrrev_i32 v141, 31, v141
v_and_b32 v141, 0xff800000, v141
v_subrev_u32 v142, 18, v235
v_ashrrev_i32 v142, 31, v142
v_and_b32 v142, 0xff800000, v142
v_subrev_u32 v143, 19, v235
v_ashrrev_i32 v143, 31, v143
v_and_b32 v143, 0xff800000, v143
v_subrev_u32 v235, 32, v235
s_waitcnt vmcnt(0)
v_mfma_f32_16x16x32_bf16 v[88:91], a[144:147], v[24:27], v[88:91]
v_mfma_f32_16x16x32_bf16 v[104:107], a[144:147], v[40:43], v[104:107]
v_mfma_f32_16x16x32_bf16 v[120:123], a[144:147], v[56:59], v[120:123]
v_mfma_f32_16x16x32_bf16 v[136:139], a[144:147], v[72:75], v[136:139]
v_mfma_f32_16x16x32_bf16 v[88:91], a[148:151], v[28:31], v[88:91]
v_mfma_f32_16x16x32_bf16 v[104:107], a[148:151], v[44:47], v[104:107]
v_mfma_f32_16x16x32_bf16 v[120:123], a[148:151], v[60:63], v[120:123]
v_mfma_f32_16x16x32_bf16 v[136:139], a[148:151], v[76:79], v[136:139]
v_mfma_f32_16x16x32_bf16 v[88:91], a[152:155], v[32:35], v[88:91]
v_mfma_f32_16x16x32_bf16 v[104:107], a[152:155], v[48:51], v[104:107]
v_mfma_f32_16x16x32_bf16 v[120:123], a[152:155], v[64:67], v[120:123]
v_mfma_f32_16x16x32_bf16 v[136:139], a[152:155], v[80:83], v[136:139]
v_mfma_f32_16x16x32_bf16 v[88:91], a[156:159], v[36:39], v[88:91]
v_mfma_f32_16x16x32_bf16 v[104:107], a[156:159], v[52:55], v[104:107]
v_mfma_f32_16x16x32_bf16 v[120:123], a[156:159], v[68:71], v[120:123]
v_mfma_f32_16x16x32_bf16 v[136:139], a[156:159], v[84:87], v[136:139]
v_mfma_f32_16x16x32_bf16 v[92:95], a[160:163], v[24:27], v[92:95]
v_mfma_f32_16x16x32_bf16 v[108:111], a[160:163], v[40:43], v[108:111]
v_mfma_f32_16x16x32_bf16 v[124:127], a[160:163], v[56:59], v[124:127]
v_mfma_f32_16x16x32_bf16 v[140:143], a[160:163], v[72:75], v[140:143]
v_mfma_f32_16x16x32_bf16 v[92:95], a[164:167], v[28:31], v[92:95]
v_mfma_f32_16x16x32_bf16 v[108:111], a[164:167], v[44:47], v[108:111]
v_mfma_f32_16x16x32_bf16 v[124:127], a[164:167], v[60:63], v[124:127]
v_mfma_f32_16x16x32_bf16 v[140:143], a[164:167], v[76:79], v[140:143]
v_mfma_f32_16x16x32_bf16 v[92:95], a[168:171], v[32:35], v[92:95]
v_mfma_f32_16x16x32_bf16 v[108:111], a[168:171], v[48:51], v[108:111]
v_mfma_f32_16x16x32_bf16 v[124:127], a[168:171], v[64:67], v[124:127]
v_mfma_f32_16x16x32_bf16 v[140:143], a[168:171], v[80:83], v[140:143]
v_mfma_f32_16x16x32_bf16 v[92:95], a[172:175], v[36:39], v[92:95]
v_mfma_f32_16x16x32_bf16 v[108:111], a[172:175], v[52:55], v[108:111]
v_mfma_f32_16x16x32_bf16 v[124:127], a[172:175], v[68:71], v[124:127]
v_mfma_f32_16x16x32_bf16 v[140:143], a[172:175], v[84:87], v[140:143]
s_nop 7
v_max3_f32 v20, v20, v88, v89
v_max3_f32 v20, v20, v90, v91
v_max3_f32 v20, v20, v92, v93
v_max3_f32 v20, v20, v94, v95
v_max3_f32 v21, v21, v104, v105
v_max3_f32 v21, v21, v106, v107
v_max3_f32 v21, v21, v108, v109
v_max3_f32 v21, v21, v110, v111
v_max3_f32 v22, v22, v120, v121
v_max3_f32 v22, v22, v122, v123
v_max3_f32 v22, v22, v124, v125
v_max3_f32 v22, v22, v126, v127
v_max3_f32 v23, v23, v136, v137
v_max3_f32 v23, v23, v138, v139
v_max3_f32 v23, v23, v140, v141
v_max3_f32 v23, v23, v142, v143
s_add_u32 s81, s81, 16384
s_cmp_lt_u32 s81, s34
s_cbranch_scc1 L_fbl_1015
v_mov_b32 v248, v20
v_mov_b32 v249, v21
v_mov_b32 v250, v22
v_mov_b32 v251, v23
v_permlane16_swap_b32 v248, v20
v_permlane16_swap_b32 v249, v21
v_permlane16_swap_b32 v250, v22
v_permlane16_swap_b32 v251, v23
v_max_f32 v20, v20, v248
v_max_f32 v21, v21, v249
v_max_f32 v22, v22, v250
v_max_f32 v23, v23, v251
v_mov_b32 v248, v20
v_mov_b32 v249, v21
v_mov_b32 v250, v22
v_mov_b32 v251, v23
v_permlane32_swap_b32 v248, v20
v_permlane32_swap_b32 v249, v21
v_permlane32_swap_b32 v250, v22
v_permlane32_swap_b32 v251, v23
v_max_f32 v20, v20, v248
v_max_f32 v21, v21, v249
v_max_f32 v22, v22, v250
v_max_f32 v23, v23, v251
v_mov_b32 v252, v20
v_mov_b32 v253, v21
v_mov_b32 v254, v22
v_mov_b32 v255, v23
s_and_b32 s70, s30, 1
s_lshr_b32 s67, s30, 1
s_lshl3_add_u32 s71, s67, s70
s_add_u32 s71, s71, 4
s_lshl_b32 s71, s71, 13
s_lshl_b32 s70, s70, 14
s_mul_i32 s67, s67, 24576
s_sub_u32 s70, s70, s67
s_add_u32 s70, s70, 65536
s_branch L_attstart_7
L_spin_2016:
s_mov_b32 vcc_hi, 0x8000
L_spinlp_2018:
s_sleep 1
buffer_load_dword v19, off, s[52:55], s72 offset:0 sc1
s_waitcnt vmcnt(0)
v_readfirstlane_b32 vcc_lo, v19
s_sub_u32 vcc_hi, vcc_hi, 1
s_cbranch_scc1 L_spinbk_2017
s_cmp_lt_u32 vcc_lo, 8
s_cbranch_scc1 L_spinlp_2018
s_branch L_spinbk_2017
L_spin_3019:
s_mov_b32 vcc_hi, 0x8000
L_spinlp_3021:
s_sleep 1
buffer_load_dword v19, off, s[52:55], s72 offset:0 sc1
s_waitcnt vmcnt(0)
v_readfirstlane_b32 vcc_lo, v19
s_sub_u32 vcc_hi, vcc_hi, 1
s_cbranch_scc1 L_spinbk_3020
s_cmp_lt_u32 vcc_lo, 8
s_cbranch_scc1 L_spinlp_3021
s_branch L_spinbk_3020
L_p5f0:
s_waitcnt lgkmcnt(10)
s_waitcnt vmcnt(28)
v_mfma_f32_16x16x32_bf16 v[136:139], a[64:67], a[232:235], 0
s_waitcnt vmcnt(24)
s_waitcnt lgkmcnt(8)
s_add_u32 m0, s86, 65536
ds_read_b64_tr_b16 a[88:89], v191 offset:32768
v_xor_b32 v192, 0x10000, v184
v_mfma_f32_16x16x32_bf16 v[136:139], a[68:71], a[236:239], v[136:139]
s_add_u32 s64, s85, 524288
ds_read_b64_tr_b16 a[90:91], v191 offset:36864
v_xor_b32 v193, 0x10000, v185
v_mfma_f32_16x16x32_bf16 v[104:107], a[68:71], a[228:231], 0
buffer_load_dwordx4 v12, s[36:39], s64 offen lds
v_mfma_f32_16x16x32_bf16 v[104:107], a[64:67], a[224:227], v[104:107]
s_add_u32 m0, s86, 66560
s_add_u32 s64, s85, 532480
ds_read_b64_tr_b16 a[92:93], v191 offset:40960
v_xor_b32 v194, 0x10000, v186
v_mfma_f32_16x16x32_bf16 v[72:75], a[64:67], a[216:219], 0
s_and_b32 s71, s31, 4
buffer_load_dwordx4 v13, s[36:39], s64 offen lds
v_mfma_f32_16x16x32_bf16 v[72:75], a[68:71], a[220:223], v[72:75]
s_lshl_b32 s71, s71, 5
s_add_u32 s71, s71, s79
s_add_u32 m0, s86, 67584
s_add_u32 s64, s85, 540672
ds_read_b64_tr_b16 a[94:95], v191 offset:45056
v_mfma_f32_16x16x32_bf16 v[40:43], a[68:71], a[212:215], 0
s_add_u32 s71, s71, 4096
buffer_load_dwordx4 v12, s[36:39], s64 offen lds
v_mfma_f32_16x16x32_bf16 v[40:43], a[64:67], a[208:211], v[40:43]
s_waitcnt lgkmcnt(4)
s_add_u32 s72, s80, 4096
s_add_u32 m0, s86, 68608
s_add_u32 s64, s85, 548864
ds_read_b64_tr_b16 a[96:97], v184 offset:32768
v_xor_b32 v195, 0x10000, v187
v_mfma_f32_16x16x32_bf16 v[44:47], a[72:75], a[208:211], 0
buffer_load_dwordx4 v13, s[36:39], s64 offen lds
v_mfma_f32_16x16x32_bf16 v[44:47], a[76:79], a[212:215], v[44:47]
s_add_u32 m0, s86, 69632
ds_read_b64_tr_b16 a[98:99], v184 offset:36864
v_xor_b32 v196, 0x10000, v188
v_mfma_f32_16x16x32_bf16 v[76:79], a[76:79], a[220:223], 0
s_add_u32 s64, s85, 557056
ds_read_b64_tr_b16 a[100:101], v184 offset:40960
v_xor_b32 v197, 0x10000, v189
v_mfma_f32_16x16x32_bf16 v[76:79], a[72:75], a[216:219], v[76:79]
buffer_load_dwordx4 v12, s[36:39], s64 offen lds
v_mfma_f32_16x16x32_bf16 v[108:111], a[72:75], a[224:227], 0
s_add_u32 m0, s86, 70656
s_add_u32 s64, s85, 565248
ds_read_b64_tr_b16 a[102:103], v184 offset:45056
v_xor_b32 v198, 0x10000, v190
v_mfma_f32_16x16x32_bf16 v[108:111], a[76:79], a[228:231], v[108:111]
buffer_load_dwordx4 v13, s[36:39], s64 offen lds
v_mfma_f32_16x16x32_bf16 v[140:143], a[76:79], a[236:239], 0
s_add_u32 m0, s86, 71680
s_add_u32 s64, s85, 573440
ds_read_b64_tr_b16 a[104:105], v185 offset:32768
v_xor_b32 v199, 0x10000, v191
v_mfma_f32_16x16x32_bf16 v[140:143], a[72:75], a[232:235], v[140:143]
buffer_load_dwordx4 v12, s[36:39], s64 offen lds
v_mfma_f32_16x16x32_bf16 v[144:147], a[80:83], a[232:235], 0
s_add_u32 m0, s86, 72704
ds_read_b64_tr_b16 a[106:107], v185 offset:36864
v_mfma_f32_16x16x32_bf16 v[144:147], a[84:87], a[236:239], v[144:147]
s_add_u32 s64, s85, 581632
ds_read_b64_tr_b16 a[108:109], v185 offset:40960
v_mfma_f32_16x16x32_bf16 v[112:115], a[84:87], a[228:231], 0
buffer_load_dwordx4 v13, s[36:39], s64 offen lds
v_mfma_f32_16x16x32_bf16 v[112:115], a[80:83], a[224:227], v[112:115]
s_add_u32 s65, s84, 65536
ds_read_b64_tr_b16 a[110:111], v185 offset:45056
v_mfma_f32_16x16x32_bf16 v[80:83], a[80:83], a[216:219], 0
buffer_load_dwordx4 a[0:3], v14, s[44:47], s65 offen offset:0 sc1
v_mfma_f32_16x16x32_bf16 v[80:83], a[84:87], a[220:223], v[80:83]
ds_read_b64_tr_b16 a[112:113], v186 offset:32768
v_mfma_f32_16x16x32_bf16 v[48:51], a[84:87], a[212:215], 0
buffer_load_dwordx4 a[8:11], v14, s[44:47], s65 offen offset:1024 sc1
v_mfma_f32_16x16x32_bf16 v[48:51], a[80:83], a[208:211], v[48:51]
s_waitcnt lgkmcnt(4)
ds_read_b64_tr_b16 a[114:115], v186 offset:36864
v_mfma_f32_16x16x32_bf16 v[52:55], a[88:91], a[208:211], 0
ds_read_b64_tr_b16 a[116:117], v186 offset:40960
v_mfma_f32_16x16x32_bf16 v[52:55], a[92:95], a[212:215], v[52:55]
buffer_load_dwordx4 a[16:19], v15, s[44:47], s65 offen offset:0 sc1
v_mfma_f32_16x16x32_bf16 v[84:87], a[92:95], a[220:223], 0
ds_read_b64_tr_b16 a[118:119], v186 offset:45056
v_mfma_f32_16x16x32_bf16 v[84:87], a[88:91], a[216:219], v[84:87]
buffer_load_dwordx4 a[24:27], v15, s[44:47], s65 offen offset:1024 sc1
v_mfma_f32_16x16x32_bf16 v[116:119], a[88:91], a[224:227], 0
s_add_u32 s65, s84, 73728
ds_read_b64_tr_b16 a[120:121], v187 offset:32768
v_mfma_f32_16x16x32_bf16 v[116:119], a[92:95], a[228:231], v[116:119]
buffer_load_dwordx4 a[4:7], v14, s[44:47], s65 offen offset:0 sc1
v_mfma_f32_16x16x32_bf16 v[148:151], a[92:95], a[236:239], 0
ds_read_b64_tr_b16 a[122:123], v187 offset:36864
v_mfma_f32_16x16x32_bf16 v[148:151], a[88:91], a[232:235], v[148:151]
ds_read_b64_tr_b16 a[124:125], v187 offset:40960
v_mfma_f32_16x16x32_bf16 v[120:123], a[96:99], a[232:235], 0
buffer_load_dwordx4 a[12:15], v14, s[44:47], s65 offen offset:1024 sc1
v_mfma_f32_16x16x32_bf16 v[120:123], a[100:103], a[236:239], v[120:123]
ds_read_b64_tr_b16 a[126:127], v187 offset:45056
v_mfma_f32_16x16x32_bf16 v[88:91], a[100:103], a[228:231], 0
buffer_load_dwordx4 a[20:23], v15, s[44:47], s65 offen offset:0 sc1
v_mfma_f32_16x16x32_bf16 v[88:91], a[96:99], a[224:227], v[88:91]
v_mfma_f32_16x16x32_bf16 v[56:59], a[96:99], a[216:219], 0
buffer_load_dwordx4 a[28:31], v15, s[44:47], s65 offen offset:1024 sc1
v_mfma_f32_16x16x32_bf16 v[56:59], a[100:103], a[220:223], v[56:59]
v_mfma_f32_16x16x32_bf16 v[24:27], a[100:103], a[212:215], 0
v_mfma_f32_16x16x32_bf16 v[24:27], a[96:99], a[208:211], v[24:27]
s_waitcnt lgkmcnt(1)
v_mfma_f32_16x16x32_bf16 v[28:31], a[104:107], a[208:211], 0
s_waitcnt vmcnt(23)
s_barrier
v_mfma_f32_16x16x32_bf16 v[28:31], a[108:111], a[212:215], v[28:31]
ds_read_b64_tr_b16 a[64:65], v196 offset:0
v_mfma_f32_16x16x32_bf16 v[60:63], a[108:111], a[220:223], 0
ds_read_b64_tr_b16 a[66:67], v196 offset:4096
v_mfma_f32_16x16x32_bf16 v[60:63], a[104:107], a[216:219], v[60:63]
s_add_u32 m0, s86, 0
ds_read_b64_tr_b16 a[68:69], v196 offset:8192
v_mfma_f32_16x16x32_bf16 v[92:95], a[104:107], a[224:227], 0
s_add_u32 s64, s85, 786432
ds_read_b64_tr_b16 a[70:71], v196 offset:12288
v_mfma_f32_16x16x32_bf16 v[92:95], a[108:111], a[228:231], v[92:95]
buffer_load_dwordx4 v12, s[36:39], s64 offen lds
v_mfma_f32_16x16x32_bf16 v[124:127], a[108:111], a[236:239], 0
s_add_u32 m0, s86, 1024
ds_read_b64_tr_b16 a[72:73], v197 offset:0
v_mfma_f32_16x16x32_bf16 v[124:127], a[104:107], a[232:235], v[124:127]
s_add_u32 s64, s85, 794624
ds_read_b64_tr_b16 a[74:75], v197 offset:4096
v_mfma_f32_16x16x32_bf16 v[128:131], a[112:115], a[232:235], 0
buffer_load_dwordx4 v13, s[36:39], s64 offen lds
v_mfma_f32_16x16x32_bf16 v[128:131], a[116:119], a[236:239], v[128:131]
ds_read_b64_tr_b16 a[76:77], v197 offset:8192
v_mfma_f32_16x16x32_bf16 v[96:99], a[116:119], a[228:231], 0
s_add_u32 m0, s86, 2048
ds_read_b64_tr_b16 a[78:79], v197 offset:12288
v_mfma_f32_16x16x32_bf16 v[96:99], a[112:115], a[224:227], v[96:99]
s_add_u32 s64, s85, 802816
ds_read_b64_tr_b16 a[80:81], v198 offset:0
v_mfma_f32_16x16x32_bf16 v[64:67], a[112:115], a[216:219], 0
buffer_load_dwordx4 v12, s[36:39], s64 offen lds
v_mfma_f32_16x16x32_bf16 v[64:67], a[116:119], a[220:223], v[64:67]
ds_read_b64_tr_b16 a[82:83], v198 offset:4096
v_mfma_f32_16x16x32_bf16 v[32:35], a[116:119], a[212:215], 0
s_add_u32 m0, s86, 3072
ds_read_b64_tr_b16 a[84:85], v198 offset:8192
v_mfma_f32_16x16x32_bf16 v[32:35], a[112:115], a[208:211], v[32:35]
s_add_u32 s64, s85, 811008
ds_read_b64_tr_b16 a[86:87], v198 offset:12288
v_mfma_f32_16x16x32_bf16 v[36:39], a[120:123], a[208:211], 0
s_waitcnt lgkmcnt(6)
buffer_load_dwordx4 v13, s[36:39], s64 offen lds
v_mfma_f32_16x16x32_bf16 v[36:39], a[124:127], a[212:215], v[36:39]
v_mfma_f32_16x16x32_bf16 v[68:71], a[124:127], a[220:223], 0
s_add_u32 m0, s86, 4096
v_mfma_f32_16x16x32_bf16 v[68:71], a[120:123], a[216:219], v[68:71]
s_add_u32 s64, s85, 819200
v_mfma_f32_16x16x32_bf16 v[100:103], a[120:123], a[224:227], 0
buffer_load_dwordx4 v12, s[36:39], s64 offen lds
v_mfma_f32_16x16x32_bf16 v[100:103], a[124:127], a[228:231], v[100:103]
v_mfma_f32_16x16x32_bf16 v[132:135], a[124:127], a[236:239], 0
v_mfma_f32_16x16x32_bf16 v[132:135], a[120:123], a[232:235], v[132:135]
v_mfma_f32_16x16x32_bf16 v[136:139], a[64:67], v[176:179], v[136:139]
s_add_u32 m0, s86, 5120
ds_read_b64_tr_b16 a[88:89], v199 offset:0
v_xor_b32 v200, 0x18000, v184
v_mfma_f32_16x16x32_bf16 v[136:139], a[68:71], v[180:183], v[136:139]
s_add_u32 s64, s85, 827392
ds_read_b64_tr_b16 a[90:91], v199 offset:4096
v_xor_b32 v201, 0x18000, v185
v_mfma_f32_16x16x32_bf16 v[104:107], a[68:71], v[172:175], v[104:107]
buffer_load_dwordx4 v13, s[36:39], s64 offen lds
v_mfma_f32_16x16x32_bf16 v[104:107], a[64:67], v[168:171], v[104:107]
s_add_u32 m0, s86, 6144
ds_read_b64_tr_b16 a[92:93], v199 offset:8192
v_xor_b32 v202, 0x18000, v186
v_mfma_f32_16x16x32_bf16 v[72:75], a[64:67], v[160:163], v[72:75]
s_add_u32 s64, s85, 835584
ds_read_b64_tr_b16 a[94:95], v199 offset:12288
v_xor_b32 v203, 0x18000, v187
v_mfma_f32_16x16x32_bf16 v[72:75], a[68:71], v[164:167], v[72:75]
buffer_load_dwordx4 v12, s[36:39], s64 offen lds
v_mfma_f32_16x16x32_bf16 v[40:43], a[68:71], v[156:159], v[40:43]
s_add_u32 m0, s86, 7168
ds_read_b64_tr_b16 a[96:97], v192 offset:0
v_xor_b32 v204, 0x18000, v188
v_mfma_f32_16x16x32_bf16 v[40:43], a[64:67], v[152:155], v[40:43]
s_add_u32 s64, s85, 843776
ds_read_b64_tr_b16 a[98:99], v192 offset:4096
v_xor_b32 v205, 0x18000, v189
v_mfma_f32_16x16x32_bf16 v[44:47], a[72:75], v[152:155], v[44:47]
s_waitcnt lgkmcnt(5)
buffer_load_dwordx4 v13, s[36:39], s64 offen lds
v_mfma_f32_16x16x32_bf16 v[44:47], a[76:79], v[156:159], v[44:47]
ds_read_b64_tr_b16 a[100:101], v192 offset:8192
v_xor_b32 v206, 0x18000, v190
v_mfma_f32_16x16x32_bf16 v[76:79], a[76:79], v[164:167], v[76:79]
ds_read_b64_tr_b16 a[102:103], v192 offset:12288
v_xor_b32 v207, 0x18000, v191
v_mfma_f32_16x16x32_bf16 v[76:79], a[72:75], v[160:163], v[76:79]
s_add_u32 s65, s84, 98304
ds_read_b64_tr_b16 a[104:105], v193 offset:0
v_mfma_f32_16x16x32_bf16 v[108:111], a[72:75], v[168:171], v[108:111]
buffer_load_dwordx4 a[128:131], v14, s[44:47], s65 offen offset:0 sc1
v_mfma_f32_16x16x32_bf16 v[108:111], a[76:79], v[172:175], v[108:111]
ds_read_b64_tr_b16 a[106:107], v193 offset:4096
v_mfma_f32_16x16x32_bf16 v[140:143], a[76:79], v[180:183], v[140:143]
ds_read_b64_tr_b16 a[108:109], v193 offset:8192
v_mfma_f32_16x16x32_bf16 v[140:143], a[72:75], v[176:179], v[140:143]
buffer_load_dwordx4 a[136:139], v14, s[44:47], s65 offen offset:1024 sc1
v_mfma_f32_16x16x32_bf16 v[144:147], a[80:83], v[176:179], v[144:147]
ds_read_b64_tr_b16 a[110:111], v193 offset:12288
v_mfma_f32_16x16x32_bf16 v[144:147], a[84:87], v[180:183], v[144:147]
v_mfma_f32_16x16x32_bf16 v[112:115], a[84:87], v[172:175], v[112:115]
buffer_load_dwordx4 a[144:147], v15, s[44:47], s65 offen offset:0 sc1
v_mfma_f32_16x16x32_bf16 v[112:115], a[80:83], v[168:171], v[112:115]
ds_read_b64_tr_b16 a[112:113], v194 offset:0
v_mfma_f32_16x16x32_bf16 v[80:83], a[80:83], v[160:163], v[80:83]
ds_read_b64_tr_b16 a[114:115], v194 offset:4096
v_mfma_f32_16x16x32_bf16 v[80:83], a[84:87], v[164:167], v[80:83]
ds_read_b64_tr_b16 a[116:117], v194 offset:8192
v_mfma_f32_16x16x32_bf16 v[48:51], a[84:87], v[156:159], v[48:51]
buffer_load_dwordx4 a[152:155], v15, s[44:47], s65 offen offset:1024 sc1
v_mfma_f32_16x16x32_bf16 v[48:51], a[80:83], v[152:155], v[48:51]
s_waitcnt lgkmcnt(4)
ds_read_b64_tr_b16 a[118:119], v194 offset:12288
v_mfma_f32_16x16x32_bf16 v[52:55], a[88:91], v[152:155], v[52:55]
s_add_u32 s65, s84, 106496
v_mfma_f32_16x16x32_bf16 v[52:55], a[92:95], v[156:159], v[52:55]
buffer_load_dwordx4 a[132:135], v14, s[44:47], s65 offen offset:0 sc1
v_mfma_f32_16x16x32_bf16 v[84:87], a[92:95], v[164:167], v[84:87]
ds_read_b64_tr_b16 a[120:121], v195 offset:0
v_mfma_f32_16x16x32_bf16 v[84:87], a[88:91], v[160:163], v[84:87]
ds_read_b64_tr_b16 a[122:123], v195 offset:4096
v_mfma_f32_16x16x32_bf16 v[116:119], a[88:91], v[168:171], v[116:119]
s_lshl_b32 s66, s30, 30
buffer_load_dwordx4 a[140:143], v14, s[44:47], s65 offen offset:1024 sc1
v_mfma_f32_16x16x32_bf16 v[116:119], a[92:95], v[172:175], v[116:119]
ds_read_b64_tr_b16 a[124:125], v195 offset:8192
v_lshl_add_u32 v1, v0, 24, s66
v_mfma_f32_16x16x32_bf16 v[148:151], a[92:95], v[180:183], v[148:151]
ds_read_b64_tr_b16 a[126:127], v195 offset:12288
v_mfma_f32_16x16x32_bf16 v[148:151], a[88:91], v[176:179], v[148:151]
v_mfma_f32_16x16x32_bf16 v[120:123], a[96:99], v[176:179], v[120:123]
buffer_load_dwordx4 a[148:151], v15, s[44:47], s65 offen offset:0 sc1
v_mfma_f32_16x16x32_bf16 v[120:123], a[100:103], v[180:183], v[120:123]
v_mfma_f32_16x16x32_bf16 v[88:91], a[100:103], v[172:175], v[88:91]
v_mfma_f32_16x16x32_bf16 v[88:91], a[96:99], v[168:171], v[88:91]
buffer_load_dwordx4 a[156:159], v15, s[44:47], s65 offen offset:1024 sc1
v_mfma_f32_16x16x32_bf16 v[56:59], a[96:99], v[160:163], v[56:59]
v_mfma_f32_16x16x32_bf16 v[56:59], a[100:103], v[164:167], v[56:59]
v_mfma_f32_16x16x32_bf16 v[24:27], a[100:103], v[156:159], v[24:27]
v_mfma_f32_16x16x32_bf16 v[24:27], a[96:99], v[152:155], v[24:27]
v_mfma_f32_16x16x32_bf16 v[28:31], a[104:107], v[152:155], v[28:31]
s_waitcnt vmcnt(24)
s_barrier
s_waitcnt lgkmcnt(0)
v_mfma_f32_16x16x32_bf16 v[28:31], a[108:111], v[156:159], v[28:31]
s_mov_b64 exec, 1
buffer_atomic_add a251, v1, s[52:55], s71 offen offset:0 sc1
s_mov_b64 exec, -1
v_mfma_f32_16x16x32_bf16 v[60:63], a[108:111], v[164:167], v[60:63]
ds_read_b64_tr_b16 a[64:65], v196 offset:32768
v_mfma_f32_16x16x32_bf16 v[60:63], a[104:107], v[160:163], v[60:63]
s_add_u32 m0, s86, 98304
ds_read_b64_tr_b16 a[66:67], v196 offset:36864
v_mfma_f32_16x16x32_bf16 v[92:95], a[104:107], v[168:171], v[92:95]
s_add_u32 s64, s85, 1048576
ds_read_b64_tr_b16 a[68:69], v196 offset:40960
v_mfma_f32_16x16x32_bf16 v[92:95], a[108:111], v[172:175], v[92:95]
buffer_load_dwordx4 v12, s[36:39], s64 offen lds
v_mfma_f32_16x16x32_bf16 v[124:127], a[108:111], v[180:183], v[124:127]
s_add_u32 m0, s86, 99328
ds_read_b64_tr_b16 a[70:71], v196 offset:45056
v_mfma_f32_16x16x32_bf16 v[124:127], a[104:107], v[176:179], v[124:127]
s_add_u32 s64, s85, 1056768
ds_read_b64_tr_b16 a[72:73], v197 offset:32768
v_mfma_f32_16x16x32_bf16 v[128:131], a[112:115], v[176:179], v[128:131]
buffer_load_dwordx4 v13, s[36:39], s64 offen lds
v_mfma_f32_16x16x32_bf16 v[128:131], a[116:119], v[180:183], v[128:131]
ds_read_b64_tr_b16 a[74:75], v197 offset:36864
v_mfma_f32_16x16x32_bf16 v[96:99], a[116:119], v[172:175], v[96:99]
s_add_u32 m0, s86, 100352
ds_read_b64_tr_b16 a[76:77], v197 offset:40960
v_mfma_f32_16x16x32_bf16 v[96:99], a[112:115], v[168:171], v[96:99]
s_add_u32 s64, s85, 1064960
ds_read_b64_tr_b16 a[78:79], v197 offset:45056
v_mfma_f32_16x16x32_bf16 v[64:67], a[112:115], v[160:163], v[64:67]
buffer_load_dwordx4 v12, s[36:39], s64 offen lds
v_mfma_f32_16x16x32_bf16 v[64:67], a[116:119], v[164:167], v[64:67]
ds_read_b64_tr_b16 a[80:81], v198 offset:32768
v_mfma_f32_16x16x32_bf16 v[32:35], a[116:119], v[156:159], v[32:35]
s_add_u32 m0, s86, 101376
ds_read_b64_tr_b16 a[82:83], v198 offset:36864
v_mfma_f32_16x16x32_bf16 v[32:35], a[112:115], v[152:155], v[32:35]
s_add_u32 s64, s85, 1073152
ds_read_b64_tr_b16 a[84:85], v198 offset:40960
v_mfma_f32_16x16x32_bf16 v[36:39], a[120:123], v[152:155], v[36:39]
buffer_load_dwordx4 v13, s[36:39], s64 offen lds
v_mfma_f32_16x16x32_bf16 v[36:39], a[124:127], v[156:159], v[36:39]
ds_read_b64_tr_b16 a[86:87], v198 offset:45056
v_mfma_f32_16x16x32_bf16 v[68:71], a[124:127], v[164:167], v[68:71]
s_add_u32 m0, s86, 102400
v_mfma_f32_16x16x32_bf16 v[68:71], a[120:123], v[160:163], v[68:71]
s_add_u32 s64, s85, 1081344
v_mfma_f32_16x16x32_bf16 v[100:103], a[120:123], v[168:171], v[100:103]
buffer_load_dwordx4 v12, s[36:39], s64 offen lds
v_mfma_f32_16x16x32_bf16 v[100:103], a[124:127], v[172:175], v[100:103]
v_mfma_f32_16x16x32_bf16 v[132:135], a[124:127], v[180:183], v[132:135]
v_mfma_f32_16x16x32_bf16 v[132:135], a[120:123], v[176:179], v[132:135]
s_waitcnt vmcnt(26)
s_waitcnt lgkmcnt(1)
v_mfma_f32_16x16x32_bf16 v[136:139], a[64:67], a[24:27], v[136:139]
s_waitcnt vmcnt(22)
s_add_u32 m0, s86, 103424
ds_read_b64_tr_b16 a[88:89], v199 offset:32768
v_mfma_f32_16x16x32_bf16 v[136:139], a[68:71], a[28:31], v[136:139]
s_add_u32 s64, s85, 1089536
ds_read_b64_tr_b16 a[90:91], v199 offset:36864
v_mfma_f32_16x16x32_bf16 v[104:107], a[68:71], a[20:23], v[104:107]
buffer_load_dwordx4 v13, s[36:39], s64 offen lds
v_mfma_f32_16x16x32_bf16 v[104:107], a[64:67], a[16:19], v[104:107]
s_add_u32 m0, s86, 104448
ds_read_b64_tr_b16 a[92:93], v199 offset:40960
v_mfma_f32_16x16x32_bf16 v[72:75], a[64:67], a[8:11], v[72:75]
s_add_u32 s64, s85, 1097728
ds_read_b64_tr_b16 a[94:95], v199 offset:45056
v_mfma_f32_16x16x32_bf16 v[72:75], a[68:71], a[12:15], v[72:75]
buffer_load_dwordx4 v12, s[36:39], s64 offen lds
v_mfma_f32_16x16x32_bf16 v[40:43], a[68:71], a[4:7], v[40:43]
s_add_u32 m0, s86, 105472
ds_read_b64_tr_b16 a[96:97], v192 offset:32768
v_mfma_f32_16x16x32_bf16 v[40:43], a[64:67], a[0:3], v[40:43]
s_add_u32 s64, s85, 1105920
ds_read_b64_tr_b16 a[98:99], v192 offset:36864
v_mfma_f32_16x16x32_bf16 v[44:47], a[72:75], a[0:3], v[44:47]
buffer_load_dwordx4 v13, s[36:39], s64 offen lds
v_mfma_f32_16x16x32_bf16 v[44:47], a[76:79], a[4:7], v[44:47]
ds_read_b64_tr_b16 a[100:101], v192 offset:40960
v_mfma_f32_16x16x32_bf16 v[76:79], a[76:79], a[12:15], v[76:79]
ds_read_b64_tr_b16 a[102:103], v192 offset:45056
v_mfma_f32_16x16x32_bf16 v[76:79], a[72:75], a[8:11], v[76:79]
s_add_u32 s65, s84, 131072
ds_read_b64_tr_b16 a[104:105], v193 offset:32768
v_mfma_f32_16x16x32_bf16 v[108:111], a[72:75], a[16:19], v[108:111]
buffer_load_dwordx4 a[32:35], v14, s[44:47], s65 offen offset:0 sc1
v_mfma_f32_16x16x32_bf16 v[108:111], a[76:79], a[20:23], v[108:111]
ds_read_b64_tr_b16 a[106:107], v193 offset:36864
v_mfma_f32_16x16x32_bf16 v[140:143], a[76:79], a[28:31], v[140:143]
ds_read_b64_tr_b16 a[108:109], v193 offset:40960
v_mfma_f32_16x16x32_bf16 v[140:143], a[72:75], a[24:27], v[140:143]
buffer_load_dwordx4 a[40:43], v14, s[44:47], s65 offen offset:1024 sc1
v_mfma_f32_16x16x32_bf16 v[144:147], a[80:83], a[24:27], v[144:147]
s_waitcnt lgkmcnt(5)
ds_read_b64_tr_b16 a[110:111], v193 offset:45056
v_mfma_f32_16x16x32_bf16 v[144:147], a[84:87], a[28:31], v[144:147]
v_mfma_f32_16x16x32_bf16 v[112:115], a[84:87], a[20:23], v[112:115]
buffer_load_dwordx4 a[48:51], v15, s[44:47], s65 offen offset:0 sc1
v_mfma_f32_16x16x32_bf16 v[112:115], a[80:83], a[16:19], v[112:115]
ds_read_b64_tr_b16 a[112:113], v194 offset:32768
v_mfma_f32_16x16x32_bf16 v[80:83], a[80:83], a[8:11], v[80:83]
ds_read_b64_tr_b16 a[114:115], v194 offset:36864
v_mfma_f32_16x16x32_bf16 v[80:83], a[84:87], a[12:15], v[80:83]
ds_read_b64_tr_b16 a[116:117], v194 offset:40960
v_mfma_f32_16x16x32_bf16 v[48:51], a[84:87], a[4:7], v[48:51]
buffer_load_dwordx4 a[56:59], v15, s[44:47], s65 offen offset:1024 sc1
v_mfma_f32_16x16x32_bf16 v[48:51], a[80:83], a[0:3], v[48:51]
ds_read_b64_tr_b16 a[118:119], v194 offset:45056
v_mfma_f32_16x16x32_bf16 v[52:55], a[88:91], a[0:3], v[52:55]
s_add_u32 s65, s84, 139264
v_mfma_f32_16x16x32_bf16 v[52:55], a[92:95], a[4:7], v[52:55]
buffer_load_dwordx4 a[36:39], v14, s[44:47], s65 offen offset:0 sc1
v_mfma_f32_16x16x32_bf16 v[84:87], a[92:95], a[12:15], v[84:87]
ds_read_b64_tr_b16 a[120:121], v195 offset:32768
v_mfma_f32_16x16x32_bf16 v[84:87], a[88:91], a[8:11], v[84:87]
ds_read_b64_tr_b16 a[122:123], v195 offset:36864
v_mfma_f32_16x16x32_bf16 v[116:119], a[88:91], a[16:19], v[116:119]
buffer_load_dwordx4 a[44:47], v14, s[44:47], s65 offen offset:1024 sc1
v_mfma_f32_16x16x32_bf16 v[116:119], a[92:95], a[20:23], v[116:119]
ds_read_b64_tr_b16 a[124:125], v195 offset:40960
v_mfma_f32_16x16x32_bf16 v[148:151], a[92:95], a[28:31], v[148:151]
ds_read_b64_tr_b16 a[126:127], v195 offset:45056
v_mfma_f32_16x16x32_bf16 v[148:151], a[88:91], a[24:27], v[148:151]
v_mfma_f32_16x16x32_bf16 v[120:123], a[96:99], a[24:27], v[120:123]
s_waitcnt lgkmcnt(4)
buffer_load_dwordx4 a[52:55], v15, s[44:47], s65 offen offset:0 sc1
v_mfma_f32_16x16x32_bf16 v[120:123], a[100:103], a[28:31], v[120:123]
v_mfma_f32_16x16x32_bf16 v[88:91], a[100:103], a[20:23], v[88:91]
v_mfma_f32_16x16x32_bf16 v[88:91], a[96:99], a[16:19], v[88:91]
buffer_load_dwordx4 a[60:63], v15, s[44:47], s65 offen offset:1024 sc1
v_mfma_f32_16x16x32_bf16 v[56:59], a[96:99], a[8:11], v[56:59]
v_mfma_f32_16x16x32_bf16 v[56:59], a[100:103], a[12:15], v[56:59]
v_mfma_f32_16x16x32_bf16 v[24:27], a[100:103], a[4:7], v[24:27]
v_mfma_f32_16x16x32_bf16 v[24:27], a[96:99], a[0:3], v[24:27]
v_mfma_f32_16x16x32_bf16 v[28:31], a[104:107], a[0:3], v[28:31]
s_waitcnt vmcnt(25)
s_barrier
v_mfma_f32_16x16x32_bf16 v[28:31], a[108:111], a[4:7], v[28:31]
ds_read_b64_tr_b16 a[64:65], v204 offset:0
v_mfma_f32_16x16x32_bf16 v[60:63], a[108:111], a[12:15], v[60:63]
ds_read_b64_tr_b16 a[66:67], v204 offset:4096
v_mfma_f32_16x16x32_bf16 v[60:63], a[104:107], a[8:11], v[60:63]
s_add_u32 m0, s86, 131072
ds_read_b64_tr_b16 a[68:69], v204 offset:8192
v_mfma_f32_16x16x32_bf16 v[92:95], a[104:107], a[16:19], v[92:95]
s_add_u32 s64, s85, 0
ds_read_b64_tr_b16 a[70:71], v204 offset:12288
v_mfma_f32_16x16x32_bf16 v[92:95], a[108:111], a[20:23], v[92:95]
buffer_load_dwordx4 v12, s[40:43], s64 offen lds
v_mfma_f32_16x16x32_bf16 v[124:127], a[108:111], a[28:31], v[124:127]
s_add_u32 m0, s86, 132096
ds_read_b64_tr_b16 a[72:73], v205 offset:0
v_mfma_f32_16x16x32_bf16 v[124:127], a[104:107], a[24:27], v[124:127]
s_add_u32 s64, s85, 8192
ds_read_b64_tr_b16 a[74:75], v205 offset:4096
v_mfma_f32_16x16x32_bf16 v[128:131], a[112:115], a[24:27], v[128:131]
buffer_load_dwordx4 v13, s[40:43], s64 offen lds
v_mfma_f32_16x16x32_bf16 v[128:131], a[116:119], a[28:31], v[128:131]
ds_read_b64_tr_b16 a[76:77], v205 offset:8192
v_mfma_f32_16x16x32_bf16 v[96:99], a[116:119], a[20:23], v[96:99]
s_add_u32 m0, s86, 133120
ds_read_b64_tr_b16 a[78:79], v205 offset:12288
v_mfma_f32_16x16x32_bf16 v[96:99], a[112:115], a[16:19], v[96:99]
s_add_u32 s64, s85, 16384
ds_read_b64_tr_b16 a[80:81], v206 offset:0
v_mfma_f32_16x16x32_bf16 v[64:67], a[112:115], a[8:11], v[64:67]
buffer_load_dwordx4 v12, s[40:43], s64 offen lds
v_mfma_f32_16x16x32_bf16 v[64:67], a[116:119], a[12:15], v[64:67]
ds_read_b64_tr_b16 a[82:83], v206 offset:4096
v_mfma_f32_16x16x32_bf16 v[32:35], a[116:119], a[4:7], v[32:35]
s_add_u32 m0, s86, 134144
ds_read_b64_tr_b16 a[84:85], v206 offset:8192
v_mfma_f32_16x16x32_bf16 v[32:35], a[112:115], a[0:3], v[32:35]
s_waitcnt lgkmcnt(5)
s_add_u32 s64, s85, 24576
ds_read_b64_tr_b16 a[86:87], v206 offset:12288
v_mfma_f32_16x16x32_bf16 v[36:39], a[120:123], a[0:3], v[36:39]
buffer_load_dwordx4 v13, s[40:43], s64 offen lds
v_mfma_f32_16x16x32_bf16 v[36:39], a[124:127], a[4:7], v[36:39]
v_mfma_f32_16x16x32_bf16 v[68:71], a[124:127], a[12:15], v[68:71]
s_add_u32 m0, s86, 135168
v_mfma_f32_16x16x32_bf16 v[68:71], a[120:123], a[8:11], v[68:71]
s_add_u32 s64, s85, 32768
v_mfma_f32_16x16x32_bf16 v[100:103], a[120:123], a[16:19], v[100:103]
buffer_load_dwordx4 v12, s[40:43], s64 offen lds
v_mfma_f32_16x16x32_bf16 v[100:103], a[124:127], a[20:23], v[100:103]
v_mfma_f32_16x16x32_bf16 v[132:135], a[124:127], a[28:31], v[132:135]
v_mfma_f32_16x16x32_bf16 v[132:135], a[120:123], a[24:27], v[132:135]
s_waitcnt vmcnt(26)
v_mfma_f32_16x16x32_bf16 v[136:139], a[64:67], a[152:155], v[136:139]
s_waitcnt vmcnt(22)
s_add_u32 m0, s86, 136192
ds_read_b64_tr_b16 a[88:89], v207 offset:0
v_mfma_f32_16x16x32_bf16 v[136:139], a[68:71], a[156:159], v[136:139]
s_add_u32 s64, s85, 40960
ds_read_b64_tr_b16 a[90:91], v207 offset:4096
v_mfma_f32_16x16x32_bf16 v[104:107], a[68:71], a[148:151], v[104:107]
buffer_load_dwordx4 v13, s[40:43], s64 offen lds
v_mfma_f32_16x16x32_bf16 v[104:107], a[64:67], a[144:147], v[104:107]
ds_read_b64_tr_b16 a[92:93], v207 offset:8192
v_mfma_f32_16x16x32_bf16 v[72:75], a[64:67], a[136:139], v[72:75]
ds_read_b64_tr_b16 a[94:95], v207 offset:12288
v_mfma_f32_16x16x32_bf16 v[72:75], a[68:71], a[140:143], v[72:75]
ds_read_b64_tr_b16 a[96:97], v200 offset:0
v_mfma_f32_16x16x32_bf16 v[40:43], a[68:71], a[132:135], v[40:43]
ds_read_b64_tr_b16 a[98:99], v200 offset:4096
v_mfma_f32_16x16x32_bf16 v[40:43], a[64:67], a[128:131], v[40:43]
ds_read_b64_tr_b16 a[100:101], v200 offset:8192
v_mfma_f32_16x16x32_bf16 v[44:47], a[72:75], a[128:131], v[44:47]
s_waitcnt lgkmcnt(6)
s_add_u32 m0, s86, 137216
ds_read_b64_tr_b16 a[102:103], v200 offset:12288
v_mfma_f32_16x16x32_bf16 v[44:47], a[76:79], a[132:135], v[44:47]
s_add_u32 s64, s85, 49152
v_mfma_f32_16x16x32_bf16 v[76:79], a[76:79], a[140:143], v[76:79]
buffer_load_dwordx4 v12, s[40:43], s64 offen lds
v_mfma_f32_16x16x32_bf16 v[76:79], a[72:75], a[136:139], v[76:79]
ds_read_b64_tr_b16 a[104:105], v201 offset:0
v_mfma_f32_16x16x32_bf16 v[108:111], a[72:75], a[144:147], v[108:111]
ds_read_b64_tr_b16 a[106:107], v201 offset:4096
v_mfma_f32_16x16x32_bf16 v[108:111], a[76:79], a[148:151], v[108:111]
ds_read_b64_tr_b16 a[108:109], v201 offset:8192
v_mfma_f32_16x16x32_bf16 v[140:143], a[76:79], a[156:159], v[140:143]
ds_read_b64_tr_b16 a[110:111], v201 offset:12288
v_mfma_f32_16x16x32_bf16 v[140:143], a[72:75], a[152:155], v[140:143]
v_mfma_f32_16x16x32_bf16 v[144:147], a[80:83], a[152:155], v[144:147]
v_mfma_f32_16x16x32_bf16 v[144:147], a[84:87], a[156:159], v[144:147]
s_add_u32 m0, s86, 138240
s_add_u32 s17, s78, L_p5loop-L_pc+0
v_mfma_f32_16x16x32_bf16 v[112:115], a[84:87], a[148:151], v[112:115]
s_add_u32 s64, s85, 57344
buffer_load_dword a252, v16, s[88:91], s17 offen
v_mfma_f32_16x16x32_bf16 v[112:115], a[80:83], a[144:147], v[112:115]
buffer_load_dwordx4 v13, s[40:43], s64 offen lds
v_mfma_f32_16x16x32_bf16 v[80:83], a[80:83], a[136:139], v[80:83]
s_add_u32 s17, s78, L_p5loop-L_pc+4096
ds_read_b64_tr_b16 a[112:113], v202 offset:0
v_mfma_f32_16x16x32_bf16 v[80:83], a[84:87], a[140:143], v[80:83]
buffer_load_dword a252, v16, s[88:91], s17 offen
v_mfma_f32_16x16x32_bf16 v[48:51], a[84:87], a[132:135], v[48:51]
ds_read_b64_tr_b16 a[114:115], v202 offset:4096
v_mfma_f32_16x16x32_bf16 v[48:51], a[80:83], a[128:131], v[48:51]
s_waitcnt lgkmcnt(2)
s_add_u32 s17, s78, L_p5loop-L_pc+8192
ds_read_b64_tr_b16 a[116:117], v202 offset:8192
v_mfma_f32_16x16x32_bf16 v[52:55], a[88:91], a[128:131], v[52:55]
buffer_load_dword a252, v16, s[88:91], s17 offen
v_mfma_f32_16x16x32_bf16 v[52:55], a[92:95], a[132:135], v[52:55]
ds_read_b64_tr_b16 a[118:119], v202 offset:12288
v_mfma_f32_16x16x32_bf16 v[84:87], a[92:95], a[140:143], v[84:87]
ds_read_b64_tr_b16 a[120:121], v203 offset:0
v_mfma_f32_16x16x32_bf16 v[84:87], a[88:91], a[136:139], v[84:87]
ds_read_b64_tr_b16 a[122:123], v203 offset:4096
v_mfma_f32_16x16x32_bf16 v[116:119], a[88:91], a[144:147], v[116:119]
ds_read_b64_tr_b16 a[124:125], v203 offset:8192
v_mfma_f32_16x16x32_bf16 v[116:119], a[92:95], a[148:151], v[116:119]
ds_read_b64_tr_b16 a[126:127], v203 offset:12288
v_mfma_f32_16x16x32_bf16 v[148:151], a[92:95], a[156:159], v[148:151]
buffer_load_dword v19, off, s[52:55], s72 sc1
v_mfma_f32_16x16x32_bf16 v[148:151], a[88:91], a[152:155], v[148:151]
v_mfma_f32_16x16x32_bf16 v[120:123], a[96:99], a[152:155], v[120:123]
v_mfma_f32_16x16x32_bf16 v[120:123], a[100:103], a[156:159], v[120:123]
v_mfma_f32_16x16x32_bf16 v[88:91], a[100:103], a[148:151], v[88:91]
v_mfma_f32_16x16x32_bf16 v[88:91], a[96:99], a[144:147], v[88:91]
v_mfma_f32_16x16x32_bf16 v[56:59], a[96:99], a[136:139], v[56:59]
v_mfma_f32_16x16x32_bf16 v[56:59], a[100:103], a[140:143], v[56:59]
v_mfma_f32_16x16x32_bf16 v[24:27], a[100:103], a[132:135], v[24:27]
v_mfma_f32_16x16x32_bf16 v[24:27], a[96:99], a[128:131], v[24:27]
v_mfma_f32_16x16x32_bf16 v[28:31], a[104:107], a[128:131], v[28:31]
s_waitcnt vmcnt(20)
s_barrier
v_mfma_f32_16x16x32_bf16 v[28:31], a[108:111], a[132:135], v[28:31]
ds_read_b64_tr_b16 a[64:65], v188 offset:0
v_mfma_f32_16x16x32_bf16 v[60:63], a[108:111], a[140:143], v[60:63]
ds_read_b64_tr_b16 a[66:67], v188 offset:4096
v_mfma_f32_16x16x32_bf16 v[60:63], a[104:107], a[136:139], v[60:63]
s_add_u32 m0, s86, 32768
ds_read_b64_tr_b16 a[68:69], v188 offset:8192
v_mfma_f32_16x16x32_bf16 v[92:95], a[104:107], a[144:147], v[92:95]
s_add_u32 s64, s85, 262144
ds_read_b64_tr_b16 a[70:71], v188 offset:12288
v_mfma_f32_16x16x32_bf16 v[92:95], a[108:111], a[148:151], v[92:95]
buffer_load_dwordx4 v12, s[40:43], s64 offen lds
v_mfma_f32_16x16x32_bf16 v[124:127], a[108:111], a[156:159], v[124:127]
s_add_u32 m0, s86, 33792
ds_read_b64_tr_b16 a[72:73], v189 offset:0
v_mfma_f32_16x16x32_bf16 v[124:127], a[104:107], a[152:155], v[124:127]
s_waitcnt lgkmcnt(5)
s_add_u32 s64, s85, 270336
ds_read_b64_tr_b16 a[74:75], v189 offset:4096
v_mfma_f32_16x16x32_bf16 v[128:131], a[112:115], a[152:155], v[128:131]
buffer_load_dwordx4 v13, s[40:43], s64 offen lds
v_mfma_f32_16x16x32_bf16 v[128:131], a[116:119], a[156:159], v[128:131]
s_add_u32 m0, s86, 34816
ds_read_b64_tr_b16 a[76:77], v189 offset:8192
v_mfma_f32_16x16x32_bf16 v[96:99], a[116:119], a[148:151], v[96:99]
s_add_u32 s64, s85, 278528
ds_read_b64_tr_b16 a[78:79], v189 offset:12288
v_mfma_f32_16x16x32_bf16 v[96:99], a[112:115], a[144:147], v[96:99]
buffer_load_dwordx4 v12, s[40:43], s64 offen lds
v_mfma_f32_16x16x32_bf16 v[64:67], a[112:115], a[136:139], v[64:67]
s_add_u32 m0, s86, 35840
ds_read_b64_tr_b16 a[80:81], v190 offset:0
v_mfma_f32_16x16x32_bf16 v[64:67], a[116:119], a[140:143], v[64:67]
s_add_u32 s64, s85, 286720
ds_read_b64_tr_b16 a[82:83], v190 offset:4096
v_mfma_f32_16x16x32_bf16 v[32:35], a[116:119], a[132:135], v[32:35]
buffer_load_dwordx4 v13, s[40:43], s64 offen lds
v_mfma_f32_16x16x32_bf16 v[32:35], a[112:115], a[128:131], v[32:35]
s_add_u32 m0, s86, 36864
ds_read_b64_tr_b16 a[84:85], v190 offset:8192
v_mfma_f32_16x16x32_bf16 v[36:39], a[120:123], a[128:131], v[36:39]
s_add_u32 s64, s85, 294912
ds_read_b64_tr_b16 a[86:87], v190 offset:12288
v_mfma_f32_16x16x32_bf16 v[36:39], a[124:127], a[132:135], v[36:39]
buffer_load_dwordx4 v12, s[40:43], s64 offen lds
v_mfma_f32_16x16x32_bf16 v[68:71], a[124:127], a[140:143], v[68:71]
s_add_u32 m0, s86, 37888
v_mfma_f32_16x16x32_bf16 v[68:71], a[120:123], a[136:139], v[68:71]
s_add_u32 s64, s85, 303104
v_mfma_f32_16x16x32_bf16 v[100:103], a[120:123], a[144:147], v[100:103]
buffer_load_dwordx4 v13, s[40:43], s64 offen lds
v_mfma_f32_16x16x32_bf16 v[100:103], a[124:127], a[148:151], v[100:103]
v_mfma_f32_16x16x32_bf16 v[132:135], a[124:127], a[156:159], v[132:135]
v_mfma_f32_16x16x32_bf16 v[132:135], a[120:123], a[152:155], v[132:135]
s_waitcnt vmcnt(22)
s_waitcnt lgkmcnt(1)
v_mfma_f32_16x16x32_bf16 v[136:139], a[64:67], a[56:59], v[136:139]
s_waitcnt vmcnt(6)
v_readfirstlane_b32 vcc_lo, v19
s_nop 0
s_cmp_lt_u32 vcc_lo, 8
s_cbranch_scc1 L_spin_3019
L_spinbk_3020:
s_sub_u32 s84, s84, 1048576
v_mfma_f32_16x16x32_bf16 v[136:139], a[68:71], a[60:63], v[136:139]
s_add_u32 s65, s84, 0
ds_read_b64_tr_b16 a[88:89], v191 offset:0
v_mfma_f32_16x16x32_bf16 v[104:107], a[68:71], a[52:55], v[104:107]
buffer_load_dwordx4 a[208:211], v14, s[44:47], s65 offen offset:0 sc1
v_mfma_f32_16x16x32_bf16 v[104:107], a[64:67], a[48:51], v[104:107]
ds_read_b64_tr_b16 a[90:91], v191 offset:4096
v_mfma_f32_16x16x32_bf16 v[72:75], a[64:67], a[40:43], v[72:75]
buffer_load_dwordx4 a[216:219], v14, s[44:47], s65 offen offset:1024 sc1
v_mfma_f32_16x16x32_bf16 v[72:75], a[68:71], a[44:47], v[72:75]
ds_read_b64_tr_b16 a[92:93], v191 offset:8192
v_mfma_f32_16x16x32_bf16 v[40:43], a[68:71], a[36:39], v[40:43]
buffer_load_dwordx4 a[224:227], v15, s[44:47], s65 offen offset:0 sc1
v_mfma_f32_16x16x32_bf16 v[40:43], a[64:67], a[32:35], v[40:43]
ds_read_b64_tr_b16 a[94:95], v191 offset:12288
v_mfma_f32_16x16x32_bf16 v[44:47], a[72:75], a[32:35], v[44:47]
buffer_load_dwordx4 a[232:235], v15, s[44:47], s65 offen offset:1024 sc1
v_mfma_f32_16x16x32_bf16 v[44:47], a[76:79], a[36:39], v[44:47]
s_add_u32 s65, s84, 8192
ds_read_b64_tr_b16 a[96:97], v184 offset:0
v_mfma_f32_16x16x32_bf16 v[76:79], a[76:79], a[44:47], v[76:79]
buffer_load_dwordx4 a[212:215], v14, s[44:47], s65 offen offset:0 sc1
v_mfma_f32_16x16x32_bf16 v[76:79], a[72:75], a[40:43], v[76:79]
ds_read_b64_tr_b16 a[98:99], v184 offset:4096
v_mfma_f32_16x16x32_bf16 v[108:111], a[72:75], a[48:51], v[108:111]
buffer_load_dwordx4 a[220:223], v14, s[44:47], s65 offen offset:1024 sc1
v_mfma_f32_16x16x32_bf16 v[108:111], a[76:79], a[52:55], v[108:111]
ds_read_b64_tr_b16 a[100:101], v184 offset:8192
v_mfma_f32_16x16x32_bf16 v[140:143], a[76:79], a[60:63], v[140:143]
buffer_load_dwordx4 a[228:231], v15, s[44:47], s65 offen offset:0 sc1
v_mfma_f32_16x16x32_bf16 v[140:143], a[72:75], a[56:59], v[140:143]
ds_read_b64_tr_b16 a[102:103], v184 offset:12288
v_mfma_f32_16x16x32_bf16 v[144:147], a[80:83], a[56:59], v[144:147]
s_waitcnt lgkmcnt(4)
buffer_load_dwordx4 a[236:239], v15, s[44:47], s65 offen offset:1024 sc1
v_mfma_f32_16x16x32_bf16 v[144:147], a[84:87], a[60:63], v[144:147]
s_add_u32 m0, s86, 38912
s_add_u32 s64, s85, 311296
ds_read_b64_tr_b16 a[104:105], v185 offset:0
v_mfma_f32_16x16x32_bf16 v[112:115], a[84:87], a[52:55], v[112:115]
buffer_load_dwordx4 v12, s[40:43], s64 offen lds
v_mfma_f32_16x16x32_bf16 v[112:115], a[80:83], a[48:51], v[112:115]
s_add_u32 m0, s86, 39936
s_add_u32 s64, s85, 319488
ds_read_b64_tr_b16 a[106:107], v185 offset:4096
v_mfma_f32_16x16x32_bf16 v[80:83], a[80:83], a[40:43], v[80:83]
buffer_load_dwordx4 v13, s[40:43], s64 offen lds
v_mfma_f32_16x16x32_bf16 v[80:83], a[84:87], a[44:47], v[80:83]
s_add_u32 s65, s84, 32768
ds_read_b64_tr_b16 a[108:109], v185 offset:8192
v_mfma_f32_16x16x32_bf16 v[48:51], a[84:87], a[36:39], v[48:51]
buffer_load_dwordx4 v[152:155], v14, s[44:47], s65 offen offset:0 sc1
v_mfma_f32_16x16x32_bf16 v[48:51], a[80:83], a[32:35], v[48:51]
ds_read_b64_tr_b16 a[110:111], v185 offset:12288
v_mfma_f32_16x16x32_bf16 v[52:55], a[88:91], a[32:35], v[52:55]
buffer_load_dwordx4 v[160:163], v14, s[44:47], s65 offen offset:1024 sc1
v_mfma_f32_16x16x32_bf16 v[52:55], a[92:95], a[36:39], v[52:55]
ds_read_b64_tr_b16 a[112:113], v186 offset:0
v_mfma_f32_16x16x32_bf16 v[84:87], a[92:95], a[44:47], v[84:87]
buffer_load_dwordx4 v[168:171], v15, s[44:47], s65 offen offset:0 sc1
v_mfma_f32_16x16x32_bf16 v[84:87], a[88:91], a[40:43], v[84:87]
ds_read_b64_tr_b16 a[114:115], v186 offset:4096
v_mfma_f32_16x16x32_bf16 v[116:119], a[88:91], a[48:51], v[116:119]
buffer_load_dwordx4 v[176:179], v15, s[44:47], s65 offen offset:1024 sc1
v_mfma_f32_16x16x32_bf16 v[116:119], a[92:95], a[52:55], v[116:119]
s_add_u32 s65, s84, 40960
ds_read_b64_tr_b16 a[116:117], v186 offset:8192
v_mfma_f32_16x16x32_bf16 v[148:151], a[92:95], a[60:63], v[148:151]
buffer_load_dwordx4 v[156:159], v14, s[44:47], s65 offen offset:0 sc1
v_mfma_f32_16x16x32_bf16 v[148:151], a[88:91], a[56:59], v[148:151]
s_waitcnt lgkmcnt(3)
ds_read_b64_tr_b16 a[118:119], v186 offset:12288
v_mfma_f32_16x16x32_bf16 v[120:123], a[96:99], a[56:59], v[120:123]
buffer_load_dwordx4 v[164:167], v14, s[44:47], s65 offen offset:1024 sc1
v_mfma_f32_16x16x32_bf16 v[120:123], a[100:103], a[60:63], v[120:123]
ds_read_b64_tr_b16 a[120:121], v187 offset:0
v_mfma_f32_16x16x32_bf16 v[88:91], a[100:103], a[52:55], v[88:91]
buffer_load_dwordx4 v[172:175], v15, s[44:47], s65 offen offset:0 sc1
v_mfma_f32_16x16x32_bf16 v[88:91], a[96:99], a[48:51], v[88:91]
ds_read_b64_tr_b16 a[122:123], v187 offset:4096
v_mfma_f32_16x16x32_bf16 v[56:59], a[96:99], a[40:43], v[56:59]
buffer_load_dwordx4 v[180:183], v15, s[44:47], s65 offen offset:1024 sc1
v_mfma_f32_16x16x32_bf16 v[56:59], a[100:103], a[44:47], v[56:59]
ds_read_b64_tr_b16 a[124:125], v187 offset:8192
v_mfma_f32_16x16x32_bf16 v[24:27], a[100:103], a[36:39], v[24:27]
ds_read_b64_tr_b16 a[126:127], v187 offset:12288
v_mfma_f32_16x16x32_bf16 v[24:27], a[96:99], a[32:35], v[24:27]
v_mfma_f32_16x16x32_bf16 v[28:31], a[104:107], a[32:35], v[28:31]
s_barrier
v_mfma_f32_16x16x32_bf16 v[28:31], a[108:111], a[36:39], v[28:31]
ds_read_b64_tr_b16 a[64:65], v188 offset:32768
v_mfma_f32_16x16x32_bf16 v[60:63], a[108:111], a[44:47], v[60:63]
ds_read_b64_tr_b16 a[66:67], v188 offset:36864
v_mfma_f32_16x16x32_bf16 v[60:63], a[104:107], a[40:43], v[60:63]
s_add_u32 m0, s86, 65536
ds_read_b64_tr_b16 a[68:69], v188 offset:40960
v_mfma_f32_16x16x32_bf16 v[92:95], a[104:107], a[48:51], v[92:95]
s_add_u32 s64, s85, 524288
ds_read_b64_tr_b16 a[70:71], v188 offset:45056
v_mfma_f32_16x16x32_bf16 v[92:95], a[108:111], a[52:55], v[92:95]
buffer_load_dwordx4 v12, s[40:43], s64 offen lds
v_mfma_f32_16x16x32_bf16 v[124:127], a[108:111], a[60:63], v[124:127]
s_add_u32 m0, s86, 66560
ds_read_b64_tr_b16 a[72:73], v189 offset:32768
v_mfma_f32_16x16x32_bf16 v[124:127], a[104:107], a[56:59], v[124:127]
s_waitcnt lgkmcnt(5)
s_add_u32 s64, s85, 532480
ds_read_b64_tr_b16 a[74:75], v189 offset:36864
v_mfma_f32_16x16x32_bf16 v[128:131], a[112:115], a[56:59], v[128:131]
buffer_load_dwordx4 v13, s[40:43], s64 offen lds
v_mfma_f32_16x16x32_bf16 v[128:131], a[116:119], a[60:63], v[128:131]
ds_read_b64_tr_b16 a[76:77], v189 offset:40960
v_mfma_f32_16x16x32_bf16 v[96:99], a[116:119], a[52:55], v[96:99]
s_add_u32 m0, s86, 67584
ds_read_b64_tr_b16 a[78:79], v189 offset:45056
v_mfma_f32_16x16x32_bf16 v[96:99], a[112:115], a[48:51], v[96:99]
s_add_u32 s64, s85, 540672
ds_read_b64_tr_b16 a[80:81], v190 offset:32768
v_mfma_f32_16x16x32_bf16 v[64:67], a[112:115], a[40:43], v[64:67]
buffer_load_dwordx4 v12, s[40:43], s64 offen lds
v_mfma_f32_16x16x32_bf16 v[64:67], a[116:119], a[44:47], v[64:67]
ds_read_b64_tr_b16 a[82:83], v190 offset:36864
v_mfma_f32_16x16x32_bf16 v[32:35], a[116:119], a[36:39], v[32:35]
s_add_u32 m0, s86, 68608
ds_read_b64_tr_b16 a[84:85], v190 offset:40960
v_mfma_f32_16x16x32_bf16 v[32:35], a[112:115], a[32:35], v[32:35]
s_add_u32 s64, s85, 548864
ds_read_b64_tr_b16 a[86:87], v190 offset:45056
v_mfma_f32_16x16x32_bf16 v[36:39], a[120:123], a[32:35], v[36:39]
buffer_load_dwordx4 v13, s[40:43], s64 offen lds
v_mfma_f32_16x16x32_bf16 v[36:39], a[124:127], a[36:39], v[36:39]
v_mfma_f32_16x16x32_bf16 v[68:71], a[124:127], a[44:47], v[68:71]
s_add_u32 m0, s86, 69632
v_mfma_f32_16x16x32_bf16 v[68:71], a[120:123], a[40:43], v[68:71]
s_add_u32 s64, s85, 557056
v_mfma_f32_16x16x32_bf16 v[100:103], a[120:123], a[48:51], v[100:103]
buffer_load_dwordx4 v12, s[40:43], s64 offen lds
v_mfma_f32_16x16x32_bf16 v[100:103], a[124:127], a[52:55], v[100:103]
s_mov_b32 s70, 3
s_mov_b32 s73, 2
v_mfma_f32_16x16x32_bf16 v[132:135], a[124:127], a[60:63], v[132:135]
v_mfma_f32_16x16x32_bf16 v[132:135], a[120:123], a[56:59], v[132:135]
s_branch L_p5join
L_spin_4022:
s_mov_b32 vcc_hi, 0x8000
L_spinlp_4024:
s_sleep 1
buffer_load_dword v19, off, s[52:55], s72 offset:128 sc1
s_waitcnt vmcnt(0)
v_readfirstlane_b32 vcc_lo, v19
s_sub_u32 vcc_hi, vcc_hi, 1
s_cbranch_scc1 L_spinbk_4023
s_cmp_lt_u32 vcc_lo, s74
s_cbranch_scc1 L_spinlp_4024
s_branch L_spinbk_4023
L_xretry:
s_sub_u32 s72, s72, 1
s_cbranch_scc1 L_xgo
buffer_load_dwordx4 v[152:155], v16, s[44:47], s75 offen offset:0 sc1
buffer_load_dwordx4 v[156:159], v16, s[44:47], s75 offen offset:1024 sc1
buffer_load_dwordx4 v[160:163], v16, s[44:47], s75 offen offset:2048 sc1
buffer_load_dwordx4 v[164:167], v16, s[44:47], s75 offen offset:3072 sc1
s_branch L_xchk
L_codeend:
.section .rodata,"a"
.p2align 6
.amdhsa_kernel gated_mix__compressed_kv_cla__sliding_local_dilated__prompt_kernel
  .amdhsa_next_free_vgpr 512
  .amdhsa_next_free_sgpr 102
  .amdhsa_accum_offset 256
  .amdhsa_group_segment_fixed_size 0
  .amdhsa_kernarg_size 104
  .amdhsa_user_sgpr_count 2
  .amdhsa_user_sgpr_kernarg_segment_ptr 1
  .amdhsa_system_sgpr_workgroup_id_x 1
.end_amdhsa_kernel
```

```asm
; @launch grid=(256,1,1) block=(256,1,1) lds=163840
.amdgcn_target "amdgcn-amd-amdhsa--gfx950"
.text
.globl gated_mix__compressed_kv_cla__sliding_local_dilated__prompt_kernel
.p2align 8
.type gated_mix__compressed_kv_cla__sliding_local_dilated__prompt_kernel,@function
gated_mix__compressed_kv_cla__sliding_local_dilated__prompt_kernel:
s_cmp_ge_u32 s2, 256
s_cbranch_scc1 L_end
s_load_dwordx16 s[4:19], s[0:1], 0
s_load_dwordx8 s[20:27], s[0:1], 64
s_load_dwordx2 s[28:29], s[0:1], 96
s_getpc_b64 s[88:89]
L_pc:
v_lshrrev_b32 v1, 6, v0
s_lshr_b32 s67, s2, 3
v_lshl_add_u32 v24, s67, 2, v1
s_mov_b32 s90, L_codeend-L_pc
s_mov_b32 s91, 0x20000
v_and_b32 v25, 7, v0
v_lshlrev_b32 v25, 7, v25
v_lshl_add_u32 v24, v24, 10, v25
buffer_load_dword a252, v24, s[88:91], 0 offen
v_and_b32 v0, 63, v0
v_readfirstlane_b32 s30, v1
v_lshrrev_b32 v24, 3, v0
v_lshrrev_b32 v25, 4, v0
v_and_b32 v26, 7, v0
v_xor_b32 v26, v26, v25
v_lshlrev_b32 v26, 4, v26
v_lshl_add_u32 v12, v24, 10, v26
v_xor_b32 v13, 64, v12
v_bfe_u32 v26, v0, 1, 3
v_xor_b32 v26, v26, v25
v_lshlrev_b32 v26, 5, v26
v_and_b32 v24, 1, v0
v_lshl_add_u32 v26, v24, 4, v26
v_lshl_add_u32 v14, v25, 13, v26
v_xor_b32 v15, 128, v14
s_and_b32 s66, s2, 7
s_and_b32 s68, s67, 3
s_lshl2_add_u32 s31, s66, s68
s_lshr_b32 s3, s67, 2
s_lshl2_add_u32 s80, s67, s30
s_lshl_b32 s70, s3, 18
s_lshl_b32 s66, s30, 16
s_add_u32 s70, s70, s66
s_lshl_b32 s71, s30, 17
s_lshl_b32 s66, s31, 8
s_add_u32 s71, s71, s66
s_lshl_b32 s76, s30, 13
s_lshl_b32 s77, s30, 12
s_lshl_b32 s78, s30, 10
s_waitcnt lgkmcnt(0)
s_mov_b32 s32, s6
s_mov_b32 s33, s7
s_mov_b32 s34, 2097152
s_mov_b32 s35, 0x20000
s_mov_b32 s36, s10
s_mov_b32 s37, s11
s_mov_b32 s38, 4194304
s_mov_b32 s39, 0x20000
s_mov_b32 s40, s12
s_mov_b32 s41, s13
s_mov_b32 s42, 4194304
s_mov_b32 s43, 0x20000
s_add_u32 m0, s76, 0
s_add_u32 s64, s70, 0
buffer_load_dwordx4 v12, s[32:35], s64 offen lds
s_add_u32 m0, s76, 1024
s_add_u32 s64, s70, 8192
buffer_load_dwordx4 v13, s[32:35], s64 offen lds
s_add_u32 m0, s76, 2048
s_add_u32 s64, s70, 16384
buffer_load_dwordx4 v12, s[32:35], s64 offen lds
s_add_u32 m0, s76, 3072
s_add_u32 s64, s70, 24576
buffer_load_dwordx4 v13, s[32:35], s64 offen lds
s_add_u32 m0, s77, 65536
s_add_u32 s64, s71, 0
buffer_load_dwordx4 v14, s[36:39], s64 offen lds
s_add_u32 m0, s77, 66560
s_add_u32 s64, s71, 32768
buffer_load_dwordx4 v14, s[36:39], s64 offen lds
s_add_u32 m0, s77, 67584
s_add_u32 s64, s71, 65536
buffer_load_dwordx4 v15, s[36:39], s64 offen lds
s_add_u32 m0, s77, 68608
s_add_u32 s64, s71, 98304
buffer_load_dwordx4 v15, s[36:39], s64 offen lds
s_mov_b32 s44, s28
s_mov_b32 s45, s29
s_mov_b32 s46, 134217728
s_mov_b32 s47, 0x20000
s_mov_b32 s48, s4
s_mov_b32 s49, s5
s_mov_b32 s50, 4194304
s_mov_b32 s51, 0x20000
s_mov_b32 s52, s26
s_mov_b32 s53, s27
s_mov_b32 s54, 256
s_mov_b32 s55, 0x20000
s_mov_b32 s56, s8
s_mov_b32 s57, s9
s_mov_b32 s58, 8388608
s_mov_b32 s59, 0x20000
s_mov_b32 s60, s18
s_mov_b32 s61, s19
s_mov_b32 s62, 6291456
s_mov_b32 s63, 0x20000
v_accvgpr_write_b32 a251, 1
v_and_b32 v24, 15, v0
v_lshrrev_b32 v26, 1, v24
v_xor_b32 v26, v26, v25
v_lshlrev_b32 v26, 4, v26
v_lshl_add_u32 v26, v24, 7, v26
v_add_u32 v2, s76, v26
v_xor_b32 v3, 64, v2
v_bfe_u32 v24, v0, 2, 2
v_lshl_add_u32 v27, v25, 3, v24
v_and_b32 v1, 3, v0
v_cmp_eq_u32 vcc, 0, v1
v_lshlrev_b32 v1, 3, v1
v_lshl_add_u32 v26, v27, 8, v1
v_add_u32 v26, 65536, v26
v_and_b32 v1, 1, v25
v_lshl_add_u32 v24, v1, 2, v24
v_lshlrev_b32 v16, 4, v0
v_mov_b32 v28, 0x3f803f80
v_cndmask_b32 v28, 0, v28, vcc
v_accvgpr_write_b32 a244, v28
v_accvgpr_write_b32 a245, v28
v_accvgpr_write_b32 a246, v28
v_accvgpr_write_b32 a247, v28
v_xor_b32 v1, 0, v24
v_lshl_add_u32 v4, v1, 5, v26
v_xor_b32 v1, 1, v24
v_lshl_add_u32 v5, v1, 5, v26
v_xor_b32 v1, 2, v24
v_lshl_add_u32 v6, v1, 5, v26
v_xor_b32 v1, 3, v24
v_lshl_add_u32 v7, v1, 5, v26
v_xor_b32 v1, 4, v24
v_lshl_add_u32 v8, v1, 5, v26
v_xor_b32 v1, 5, v24
v_lshl_add_u32 v9, v1, 5, v26
v_xor_b32 v1, 6, v24
v_lshl_add_u32 v10, v1, 5, v26
v_xor_b32 v1, 7, v24
v_lshl_add_u32 v11, v1, 5, v26
s_sub_u32 s16, 15, s3
s_lshl_b32 s72, s3, 18
s_lshl_b32 s73, s16, 18
s_cmp_lt_u32 s30, 2
s_cselect_b32 s67, s3, s16
s_lshl4_add_u32 s74, s31, s67
s_and_b32 s66, s30, 1
s_lshl1_add_u32 s74, s74, s66
s_lshl_b32 s74, s74, 10
s_add_u32 s74, s74, 60817408
s_lshl_b32 s66, s30, 15
s_add_u32 s72, s72, s66
s_add_u32 s73, s73, s66
s_mul_i32 s75, s30, 98304
s_lshl_b32 s66, s31, 6
s_add_u32 s75, s75, s66
s_lshl_b32 s79, s31, 20
s_lshl_b32 s66, s3, 17
s_add_u32 s79, s79, s66
s_lshl_b32 s66, s30, 15
s_add_u32 s79, s79, s66
v_bfe_u32 v23, v0, 1, 1
v_lshrrev_b32 v1, 5, v0
v_xor_b32 v23, v23, v1
v_lshlrev_b32 v23, 5, v23
v_and_b32 v1, 1, v0
v_lshl_add_u32 v23, v1, 4, v23
v_lshrrev_b32 v1, 2, v0
v_mul_u32_u24 v1, 6144, v1
v_add_u32 v23, v1, v23
s_lshl_b32 s81, s80, 13
s_and_b32 s67, s2, 7
s_lshl_b32 s82, s67, 8
s_add_u32 s82, s82, s81
s_lshl_b32 s67, s67, 10
s_add_u32 s81, s81, s67
s_add_u32 s83, s81, 1048576
v_mul_u32_u24 v1, 1792, v25
v_add_u32 v1, v1, v16
s_lshl_b32 s68, s2, 3
s_lshl1_add_u32 s68, s30, s68
v_lshrrev_b32 v18, 5, v0
v_add_u32 v18, s68, v18
v_and_b32 v19, 31, v0
v_lshlrev_b32 v19, 4, v19
v_lshl_add_u32 v18, v18, 11, v19
v_mov_b32 v21, 0
v_min_u32 v20, 1, v0
v_lshlrev_b32 v20, 30, v20
v_accvgpr_write_b32 a240, -1
v_accvgpr_write_b32 a241, -1
v_accvgpr_write_b32 a242, -1
v_accvgpr_write_b32 a243, -1
s_lshr_b32 s69, s2, 7
s_or_b32 s69, s69, s30
s_lshl_b32 s69, s69, 21
s_add_u32 s69, s69, s2
s_lshl_b32 s69, s69, 7
s_add_u32 s69, s69, 59768832
s_add_u32 m0, s76, 4096
s_add_u32 s64, s70, 32768
buffer_load_dwordx4 v12, s[32:35], s64 offen lds
s_add_u32 m0, s76, 5120
s_add_u32 s64, s70, 40960
buffer_load_dwordx4 v13, s[32:35], s64 offen lds
s_add_u32 m0, s76, 6144
s_add_u32 s64, s70, 49152
buffer_load_dwordx4 v12, s[32:35], s64 offen lds
s_add_u32 m0, s76, 7168
s_add_u32 s64, s70, 57344
buffer_load_dwordx4 v13, s[32:35], s64 offen lds
s_add_u32 m0, s77, 81920
s_add_u32 s64, s71, 0
buffer_load_dwordx4 v14, s[40:43], s64 offen lds
s_add_u32 m0, s77, 82944
s_add_u32 s64, s71, 32768
buffer_load_dwordx4 v14, s[40:43], s64 offen lds
s_add_u32 m0, s77, 83968
s_add_u32 s64, s71, 65536
buffer_load_dwordx4 v15, s[40:43], s64 offen lds
s_add_u32 m0, s77, 84992
s_add_u32 s64, s71, 98304
buffer_load_dwordx4 v15, s[40:43], s64 offen lds
s_waitcnt vmcnt(8)
s_barrier
ds_read_b128 a[0:3], v2 offset:0
ds_read_b128 a[4:7], v3 offset:0
ds_read_b64_tr_b16 a[176:177], v4 offset:0
ds_read_b64_tr_b16 a[178:179], v4 offset:1024
ds_read_b64_tr_b16 a[180:181], v4 offset:8192
ds_read_b64_tr_b16 a[182:183], v4 offset:9216
ds_read_b128 a[8:11], v2 offset:2048
ds_read_b128 a[12:15], v3 offset:2048
ds_read_b64_tr_b16 a[184:185], v5 offset:0
ds_read_b64_tr_b16 a[186:187], v5 offset:1024
ds_read_b64_tr_b16 a[188:189], v5 offset:8192
ds_read_b64_tr_b16 a[190:191], v5 offset:9216
ds_read_b64_tr_b16 a[88:89], v6 offset:0
ds_read_b64_tr_b16 a[90:91], v6 offset:1024
ds_read_b64_tr_b16 a[92:93], v6 offset:8192
ds_read_b64_tr_b16 a[94:95], v6 offset:9216
s_waitcnt lgkmcnt(12)
v_mfma_f32_16x16x32_bf16 v[184:187], a[176:179], a[0:3], 0
s_waitcnt lgkmcnt(10)
s_add_u32 m0, s77, 98304
ds_read_b64_tr_b16 a[96:97], v7 offset:0
v_mfma_f32_16x16x32_bf16 v[184:187], a[180:183], a[4:7], v[184:187]
s_waitcnt lgkmcnt(9)
s_add_u32 s64, s71, 524288
ds_read_b64_tr_b16 a[98:99], v7 offset:1024
v_mfma_f32_16x16x32_bf16 v[192:195], a[180:183], a[12:15], 0
buffer_load_dwordx4 v14, s[36:39], s64 offen lds
v_mfma_f32_16x16x32_bf16 v[192:195], a[176:179], a[8:11], v[192:195]
s_waitcnt lgkmcnt(8)
ds_read_b64_tr_b16 a[100:101], v7 offset:8192
v_mfma_f32_16x16x32_bf16 v[196:199], a[184:187], a[8:11], 0
s_waitcnt lgkmcnt(7)
s_add_u32 m0, s77, 99328
ds_read_b64_tr_b16 a[102:103], v7 offset:9216
v_mfma_f32_16x16x32_bf16 v[196:199], a[188:191], a[12:15], v[196:199]
s_add_u32 s64, s71, 557056
ds_read_b64_tr_b16 a[104:105], v8 offset:0
v_mfma_f32_16x16x32_bf16 v[188:191], a[188:191], a[4:7], 0
buffer_load_dwordx4 v14, s[36:39], s64 offen lds
v_mfma_f32_16x16x32_bf16 v[188:191], a[184:187], a[0:3], v[188:191]
s_waitcnt lgkmcnt(7)
ds_read_b64_tr_b16 a[106:107], v8 offset:1024
v_mfma_f32_16x16x32_bf16 v[216:219], a[88:91], a[0:3], 0
s_waitcnt lgkmcnt(6)
s_add_u32 m0, s77, 100352
ds_read_b64_tr_b16 a[108:109], v8 offset:8192
v_mfma_f32_16x16x32_bf16 v[216:219], a[92:95], a[4:7], v[216:219]
s_add_u32 s64, s71, 589824
ds_read_b64_tr_b16 a[110:111], v8 offset:9216
v_mfma_f32_16x16x32_bf16 v[224:227], a[92:95], a[12:15], 0
buffer_load_dwordx4 v15, s[36:39], s64 offen lds
v_mfma_f32_16x16x32_bf16 v[224:227], a[88:91], a[8:11], v[224:227]
s_waitcnt lgkmcnt(6)
ds_read_b64_tr_b16 a[112:113], v9 offset:0
v_mfma_f32_16x16x32_bf16 v[228:231], a[96:99], a[8:11], 0
s_waitcnt lgkmcnt(5)
ds_read_b64_tr_b16 a[114:115], v9 offset:1024
v_mfma_f32_16x16x32_bf16 v[228:231], a[100:103], a[12:15], v[228:231]
s_add_u32 m0, s77, 101376
ds_read_b64_tr_b16 a[116:117], v9 offset:8192
v_mfma_f32_16x16x32_bf16 v[220:223], a[100:103], a[4:7], 0
s_add_u32 s64, s71, 622592
ds_read_b64_tr_b16 a[118:119], v9 offset:9216
v_mfma_f32_16x16x32_bf16 v[220:223], a[96:99], a[0:3], v[220:223]
s_waitcnt lgkmcnt(6)
buffer_load_dwordx4 v15, s[36:39], s64 offen lds
v_mfma_f32_16x16x32_bf16 v[152:155], a[104:107], a[0:3], 0
s_waitcnt lgkmcnt(4)
ds_read_b64_tr_b16 a[72:73], v10 offset:0
v_mfma_f32_16x16x32_bf16 v[152:155], a[108:111], a[4:7], v[152:155]
s_add_u32 m0, s77, 114688
ds_read_b64_tr_b16 a[74:75], v10 offset:1024
v_mfma_f32_16x16x32_bf16 v[160:163], a[108:111], a[12:15], 0
s_add_u32 s64, s71, 524288
ds_read_b64_tr_b16 a[76:77], v10 offset:8192
ds_read_b64_tr_b16 a[78:79], v10 offset:9216
v_mfma_f32_16x16x32_bf16 v[160:163], a[104:107], a[8:11], v[160:163]
s_waitcnt lgkmcnt(6)
buffer_load_dwordx4 v14, s[40:43], s64 offen lds
v_mfma_f32_16x16x32_bf16 v[164:167], a[112:115], a[8:11], 0
s_waitcnt lgkmcnt(4)
s_add_u32 m0, s77, 115712
ds_read_b64_tr_b16 a[80:81], v11 offset:0
v_mfma_f32_16x16x32_bf16 v[164:167], a[116:119], a[12:15], v[164:167]
s_add_u32 s64, s71, 557056
ds_read_b64_tr_b16 a[82:83], v11 offset:1024
v_mfma_f32_16x16x32_bf16 v[156:159], a[116:119], a[4:7], 0
ds_read_b64_tr_b16 a[84:85], v11 offset:8192
ds_read_b64_tr_b16 a[86:87], v11 offset:9216
s_waitcnt vmcnt(9)
v_mfma_f32_16x16x32_bf16 v[156:159], a[112:115], a[0:3], v[156:159]
s_waitcnt lgkmcnt(6)
buffer_load_dwordx4 v14, s[40:43], s64 offen lds
v_mfma_f32_16x16x32_bf16 v[24:27], a[72:75], a[0:3], 0
s_waitcnt lgkmcnt(4)
s_add_u32 m0, s77, 116736
ds_read_b128 a[16:19], v2 offset:4096
ds_read_b128 a[20:23], v3 offset:4096
v_mfma_f32_16x16x32_bf16 v[24:27], a[76:79], a[4:7], v[24:27]
s_add_u32 s64, s71, 589824
ds_read_b128 a[24:27], v2 offset:6144
ds_read_b128 a[28:31], v3 offset:6144
v_mfma_f32_16x16x32_bf16 v[40:43], a[76:79], a[12:15], 0
s_add_u32 s17, s78, .-L_pc+6144
buffer_load_dwordx4 v15, s[40:43], s64 offen lds
v_mfma_f32_16x16x32_bf16 v[40:43], a[72:75], a[8:11], v[40:43]
s_waitcnt lgkmcnt(6)
buffer_load_dword a252, v16, s[88:91], s17 offen
v_mfma_f32_16x16x32_bf16 v[104:107], a[80:83], a[8:11], 0
s_waitcnt lgkmcnt(4)
s_add_u32 m0, s77, 117760
v_mfma_f32_16x16x32_bf16 v[104:107], a[84:87], a[12:15], v[104:107]
s_add_u32 s64, s71, 622592
v_mfma_f32_16x16x32_bf16 v[88:91], a[84:87], a[4:7], 0
buffer_load_dwordx4 v15, s[40:43], s64 offen lds
v_mfma_f32_16x16x32_bf16 v[88:91], a[80:83], a[0:3], v[88:91]
s_waitcnt lgkmcnt(3)
v_mfma_f32_16x16x32_bf16 v[232:235], a[88:91], a[16:19], 0
s_waitcnt lgkmcnt(2)
v_mfma_f32_16x16x32_bf16 v[232:235], a[92:95], a[20:23], v[232:235]
s_waitcnt lgkmcnt(0)
s_add_u32 m0, s76, 32768
v_mfma_f32_16x16x32_bf16 v[240:243], a[92:95], a[28:31], 0
s_add_u32 s64, s70, 128
v_mfma_f32_16x16x32_bf16 v[240:243], a[88:91], a[24:27], v[240:243]
buffer_load_dwordx4 v12, s[32:35], s64 offen lds
v_mfma_f32_16x16x32_bf16 v[244:247], a[96:99], a[24:27], 0
s_add_u32 m0, s76, 33792
v_mfma_f32_16x16x32_bf16 v[244:247], a[100:103], a[28:31], v[244:247]
s_add_u32 s64, s70, 8320
v_mfma_f32_16x16x32_bf16 v[236:239], a[100:103], a[20:23], 0
s_waitcnt vmcnt(10)
s_barrier
v_mfma_f32_16x16x32_bf16 v[236:239], a[96:99], a[16:19], v[236:239]
buffer_load_dwordx4 v13, s[32:35], s64 offen lds
v_mfma_f32_16x16x32_bf16 v[168:171], a[104:107], a[16:19], 0
ds_read_b64_tr_b16 a[88:89], v4 offset:16384
v_mfma_f32_16x16x32_bf16 v[168:171], a[108:111], a[20:23], v[168:171]
s_add_u32 m0, s76, 34816
ds_read_b64_tr_b16 a[90:91], v4 offset:17408
v_mfma_f32_16x16x32_bf16 v[176:179], a[108:111], a[28:31], 0
s_add_u32 s64, s70, 16512
ds_read_b64_tr_b16 a[92:93], v4 offset:24576
v_mfma_f32_16x16x32_bf16 v[176:179], a[104:107], a[24:27], v[176:179]
buffer_load_dwordx4 v12, s[32:35], s64 offen lds
v_mfma_f32_16x16x32_bf16 v[180:183], a[112:115], a[24:27], 0
ds_read_b64_tr_b16 a[94:95], v4 offset:25600
v_mfma_f32_16x16x32_bf16 v[180:183], a[116:119], a[28:31], v[180:183]
s_add_u32 m0, s76, 35840
ds_read_b64_tr_b16 a[96:97], v5 offset:16384
v_mfma_f32_16x16x32_bf16 v[172:175], a[116:119], a[20:23], 0
s_add_u32 s64, s70, 24704
ds_read_b64_tr_b16 a[98:99], v5 offset:17408
v_mfma_f32_16x16x32_bf16 v[172:175], a[112:115], a[16:19], v[172:175]
buffer_load_dwordx4 v13, s[32:35], s64 offen lds
v_mfma_f32_16x16x32_bf16 v[56:59], a[72:75], a[16:19], 0
ds_read_b64_tr_b16 a[100:101], v5 offset:24576
v_mfma_f32_16x16x32_bf16 v[56:59], a[76:79], a[20:23], v[56:59]
s_add_u32 m0, s76, 36864
ds_read_b64_tr_b16 a[102:103], v5 offset:25600
v_mfma_f32_16x16x32_bf16 v[72:75], a[76:79], a[28:31], 0
s_add_u32 s64, s70, 32896
ds_read_b64_tr_b16 a[104:105], v6 offset:16384
v_mfma_f32_16x16x32_bf16 v[72:75], a[72:75], a[24:27], v[72:75]
buffer_load_dwordx4 v12, s[32:35], s64 offen lds
v_mfma_f32_16x16x32_bf16 v[136:139], a[80:83], a[24:27], 0
ds_read_b64_tr_b16 a[106:107], v6 offset:17408
v_mfma_f32_16x16x32_bf16 v[136:139], a[84:87], a[28:31], v[136:139]
s_add_u32 m0, s76, 37888
ds_read_b64_tr_b16 a[108:109], v6 offset:24576
v_mfma_f32_16x16x32_bf16 v[120:123], a[84:87], a[20:23], 0
s_add_u32 s64, s70, 41088
ds_read_b64_tr_b16 a[110:111], v6 offset:25600
v_mfma_f32_16x16x32_bf16 v[120:123], a[80:83], a[16:19], v[120:123]
buffer_load_dwordx4 v13, s[32:35], s64 offen lds
v_mfma_f32_16x16x32_bf16 v[200:203], a[176:179], a[16:19], 0
ds_read_b64_tr_b16 a[112:113], v7 offset:16384
v_mfma_f32_16x16x32_bf16 v[200:203], a[180:183], a[20:23], v[200:203]
s_add_u32 m0, s76, 38912
ds_read_b64_tr_b16 a[114:115], v7 offset:17408
v_mfma_f32_16x16x32_bf16 v[208:211], a[180:183], a[28:31], 0
s_add_u32 s64, s70, 49280
ds_read_b64_tr_b16 a[116:117], v7 offset:24576
v_mfma_f32_16x16x32_bf16 v[208:211], a[176:179], a[24:27], v[208:211]
buffer_load_dwordx4 v12, s[32:35], s64 offen lds
v_mfma_f32_16x16x32_bf16 v[212:215], a[184:187], a[24:27], 0
ds_read_b64_tr_b16 a[118:119], v7 offset:25600
v_mfma_f32_16x16x32_bf16 v[212:215], a[188:191], a[28:31], v[212:215]
s_add_u32 m0, s76, 39936
ds_read_b64_tr_b16 a[72:73], v8 offset:16384
v_mfma_f32_16x16x32_bf16 v[204:207], a[188:191], a[20:23], 0
s_add_u32 s64, s70, 57472
ds_read_b64_tr_b16 a[74:75], v8 offset:17408
v_mfma_f32_16x16x32_bf16 v[204:207], a[184:187], a[16:19], v[204:207]
s_waitcnt lgkmcnt(7)
buffer_load_dwordx4 v13, s[32:35], s64 offen lds
v_mfma_f32_16x16x32_bf16 v[28:31], a[0:3], a[88:91], 0
ds_read_b64_tr_b16 a[76:77], v8 offset:24576
v_mfma_f32_16x16x32_bf16 v[28:31], a[4:7], a[92:95], v[28:31]
ds_read_b64_tr_b16 a[78:79], v8 offset:25600
v_mfma_f32_16x16x32_bf16 v[44:47], a[12:15], a[92:95], 0
ds_read_b64_tr_b16 a[80:81], v9 offset:16384
v_mfma_f32_16x16x32_bf16 v[44:47], a[8:11], a[88:91], v[44:47]
ds_read_b64_tr_b16 a[82:83], v9 offset:17408
v_mfma_f32_16x16x32_bf16 v[60:63], a[16:19], a[88:91], 0
s_add_u32 m0, s77, 131072
ds_read_b64_tr_b16 a[84:85], v9 offset:24576
v_mfma_f32_16x16x32_bf16 v[60:63], a[20:23], a[92:95], v[60:63]
s_add_u32 s64, s71, 1048576
ds_read_b64_tr_b16 a[86:87], v9 offset:25600
v_mfma_f32_16x16x32_bf16 v[76:79], a[28:31], a[92:95], 0
buffer_load_dwordx4 v14, s[36:39], s64 offen lds
v_mfma_f32_16x16x32_bf16 v[76:79], a[24:27], a[88:91], v[76:79]
s_add_u32 m0, s77, 132096
ds_read_b64_tr_b16 a[88:89], v10 offset:16384
v_mfma_f32_16x16x32_bf16 v[140:143], a[24:27], a[96:99], 0
s_add_u32 s64, s71, 1081344
ds_read_b64_tr_b16 a[90:91], v10 offset:17408
v_mfma_f32_16x16x32_bf16 v[140:143], a[28:31], a[100:103], v[140:143]
buffer_load_dwordx4 v14, s[36:39], s64 offen lds
v_mfma_f32_16x16x32_bf16 v[124:127], a[20:23], a[100:103], 0
ds_read_b64_tr_b16 a[92:93], v10 offset:24576
v_mfma_f32_16x16x32_bf16 v[124:127], a[16:19], a[96:99], v[124:127]
s_add_u32 m0, s77, 133120
ds_read_b64_tr_b16 a[94:95], v10 offset:25600
v_mfma_f32_16x16x32_bf16 v[108:111], a[8:11], a[96:99], 0
s_add_u32 s64, s71, 1114112
v_mfma_f32_16x16x32_bf16 v[108:111], a[12:15], a[100:103], v[108:111]
buffer_load_dwordx4 v15, s[36:39], s64 offen lds
v_mfma_f32_16x16x32_bf16 v[92:95], a[4:7], a[100:103], 0
v_mfma_f32_16x16x32_bf16 v[92:95], a[0:3], a[96:99], v[92:95]
s_add_u32 m0, s77, 134144
ds_read_b64_tr_b16 a[96:97], v11 offset:16384
v_mfma_f32_16x16x32_bf16 v[32:35], a[0:3], a[104:107], 0
s_waitcnt lgkmcnt(5)
s_add_u32 s64, s71, 1146880
ds_read_b64_tr_b16 a[98:99], v11 offset:17408
v_mfma_f32_16x16x32_bf16 v[32:35], a[4:7], a[108:111], v[32:35]
buffer_load_dwordx4 v15, s[36:39], s64 offen lds
v_mfma_f32_16x16x32_bf16 v[48:51], a[12:15], a[108:111], 0
ds_read_b64_tr_b16 a[100:101], v11 offset:24576
v_mfma_f32_16x16x32_bf16 v[48:51], a[8:11], a[104:107], v[48:51]
s_add_u32 m0, s77, 147456
ds_read_b64_tr_b16 a[102:103], v11 offset:25600
v_mfma_f32_16x16x32_bf16 v[64:67], a[16:19], a[104:107], 0
s_add_u32 s64, s71, 1048576
v_mfma_f32_16x16x32_bf16 v[64:67], a[20:23], a[108:111], v[64:67]
buffer_load_dwordx4 v14, s[40:43], s64 offen lds
v_mfma_f32_16x16x32_bf16 v[80:83], a[28:31], a[108:111], 0
s_add_u32 m0, s77, 148480
v_mfma_f32_16x16x32_bf16 v[80:83], a[24:27], a[104:107], v[80:83]
s_add_u32 s64, s71, 1081344
v_mfma_f32_16x16x32_bf16 v[144:147], a[24:27], a[112:115], 0
buffer_load_dwordx4 v14, s[40:43], s64 offen lds
v_mfma_f32_16x16x32_bf16 v[144:147], a[28:31], a[116:119], v[144:147]
v_mfma_f32_16x16x32_bf16 v[128:131], a[20:23], a[116:119], 0
s_add_u32 m0, s77, 149504
v_mfma_f32_16x16x32_bf16 v[128:131], a[16:19], a[112:115], v[128:131]
s_add_u32 s64, s71, 1114112
v_mfma_f32_16x16x32_bf16 v[112:115], a[8:11], a[112:115], 0
buffer_load_dwordx4 v15, s[40:43], s64 offen lds
v_mfma_f32_16x16x32_bf16 v[112:115], a[12:15], a[116:119], v[112:115]
v_mfma_f32_16x16x32_bf16 v[96:99], a[4:7], a[116:119], 0
s_add_u32 m0, s77, 150528
v_mfma_f32_16x16x32_bf16 v[96:99], a[0:3], a[112:115], v[96:99]
s_add_u32 s64, s71, 1146880
v_mfma_f32_16x16x32_bf16 v[36:39], a[0:3], a[72:75], 0
buffer_load_dwordx4 v15, s[40:43], s64 offen lds
v_mfma_f32_16x16x32_bf16 v[36:39], a[4:7], a[76:79], v[36:39]
s_add_u32 m0, s76, 0
v_mfma_f32_16x16x32_bf16 v[52:55], a[12:15], a[76:79], 0
s_waitcnt vmcnt(16) lgkmcnt(0)
s_barrier
v_mfma_f32_16x16x32_bf16 v[52:55], a[8:11], a[72:75], v[52:55]
s_add_u32 s64, s70, 256
ds_read_b64_tr_b16 a[104:105], v4 offset:32768
v_mfma_f32_16x16x32_bf16 v[68:71], a[16:19], a[72:75], 0
buffer_load_dwordx4 v12, s[32:35], s64 offen lds
v_mfma_f32_16x16x32_bf16 v[68:71], a[20:23], a[76:79], v[68:71]
s_add_u32 m0, s76, 1024
global_load_dwordx4 a[144:147], v18, s[4:5] offset:0
v_mfma_f32_16x16x32_bf16 v[84:87], a[28:31], a[76:79], 0
s_add_u32 s64, s70, 8448
ds_read_b64_tr_b16 a[106:107], v4 offset:33792
v_mfma_f32_16x16x32_bf16 v[84:87], a[24:27], a[72:75], v[84:87]
buffer_load_dwordx4 v13, s[32:35], s64 offen lds
v_mfma_f32_16x16x32_bf16 v[148:151], a[24:27], a[80:83], 0
ds_read_b64_tr_b16 a[108:109], v4 offset:40960
v_mfma_f32_16x16x32_bf16 v[148:151], a[28:31], a[84:87], v[148:151]
s_add_u32 m0, s76, 2048
ds_read_b64_tr_b16 a[110:111], v4 offset:41984
v_mfma_f32_16x16x32_bf16 v[132:135], a[20:23], a[84:87], 0
s_waitcnt vmcnt(11)
s_add_u32 s64, s70, 16640
ds_read_b128 a[32:35], v2 offset:32768
v_mfma_f32_16x16x32_bf16 v[132:135], a[16:19], a[80:83], v[132:135]
buffer_load_dwordx4 v12, s[32:35], s64 offen lds
v_mfma_f32_16x16x32_bf16 v[116:119], a[8:11], a[80:83], 0
ds_read_b128 a[36:39], v3 offset:32768
v_mfma_f32_16x16x32_bf16 v[116:119], a[12:15], a[84:87], v[116:119]
s_add_u32 m0, s76, 3072
ds_read_b128 a[40:43], v2 offset:34816
v_mfma_f32_16x16x32_bf16 v[100:103], a[4:7], a[84:87], 0
s_add_u32 s64, s70, 24832
ds_read_b128 a[44:47], v3 offset:34816
v_mfma_f32_16x16x32_bf16 v[100:103], a[0:3], a[80:83], v[100:103]
buffer_load_dwordx4 v13, s[32:35], s64 offen lds
v_mfma_f32_16x16x32_bf16 v[248:251], a[0:3], a[88:91], 0
ds_read_b128 a[48:51], v2 offset:36864
v_mfma_f32_16x16x32_bf16 v[248:251], a[4:7], a[92:95], v[248:251]
s_add_u32 m0, s76, 4096
ds_read_b128 a[52:55], v3 offset:36864
v_mfma_f32_16x16x32_bf16 v[252:255], a[12:15], a[92:95], 0
s_add_u32 s64, s70, 33024
ds_read_b128 a[56:59], v2 offset:38912
v_mfma_f32_16x16x32_bf16 v[252:255], a[8:11], a[88:91], v[252:255]
buffer_load_dwordx4 v12, s[32:35], s64 offen lds
v_mfma_f32_16x16x32_bf16 a[120:123], a[16:19], a[88:91], 0
s_add_u32 m0, s76, 5120
ds_read_b128 a[60:63], v3 offset:38912
v_mfma_f32_16x16x32_bf16 a[120:123], a[20:23], a[92:95], a[120:123]
s_add_u32 s64, s70, 41216
ds_read_b64_tr_b16 a[112:113], v5 offset:32768
v_mfma_f32_16x16x32_bf16 a[124:127], a[28:31], a[92:95], 0
buffer_load_dwordx4 v13, s[32:35], s64 offen lds
v_mfma_f32_16x16x32_bf16 a[124:127], a[24:27], a[88:91], a[124:127]
ds_read_b64_tr_b16 a[114:115], v5 offset:33792
v_mfma_f32_16x16x32_bf16 a[128:131], a[24:27], a[96:99], 0
s_add_u32 m0, s76, 6144
ds_read_b64_tr_b16 a[116:117], v5 offset:40960
v_mfma_f32_16x16x32_bf16 a[128:131], a[28:31], a[100:103], a[128:131]
s_add_u32 s64, s70, 49408
ds_read_b64_tr_b16 a[118:119], v5 offset:41984
v_mfma_f32_16x16x32_bf16 a[132:135], a[20:23], a[100:103], 0
buffer_load_dwordx4 v12, s[32:35], s64 offen lds
v_mfma_f32_16x16x32_bf16 a[132:135], a[16:19], a[96:99], a[132:135]
global_load_dwordx4 a[160:163], v19, s[22:23] offset:0
v_mfma_f32_16x16x32_bf16 a[136:139], a[8:11], a[96:99], 0
s_add_u32 m0, s76, 7168
ds_read_b64_tr_b16 a[72:73], v6 offset:32768
v_mfma_f32_16x16x32_bf16 a[136:139], a[12:15], a[100:103], a[136:139]
s_add_u32 s64, s70, 57600
ds_read_b64_tr_b16 a[74:75], v6 offset:33792
v_mfma_f32_16x16x32_bf16 a[140:143], a[4:7], a[100:103], 0
buffer_load_dwordx4 v13, s[32:35], s64 offen lds
v_mfma_f32_16x16x32_bf16 a[140:143], a[0:3], a[96:99], a[140:143]
s_waitcnt lgkmcnt(5)
ds_read_b64_tr_b16 a[76:77], v6 offset:40960
v_mfma_f32_16x16x32_bf16 v[184:187], a[104:107], a[32:35], v[184:187]
ds_read_b64_tr_b16 a[78:79], v6 offset:41984
v_mfma_f32_16x16x32_bf16 v[184:187], a[108:111], a[36:39], v[184:187]
ds_read_b64_tr_b16 a[80:81], v7 offset:32768
v_mfma_f32_16x16x32_bf16 v[192:195], a[108:111], a[44:47], v[192:195]
s_add_u32 m0, s77, 65536
ds_read_b64_tr_b16 a[82:83], v7 offset:33792
v_mfma_f32_16x16x32_bf16 v[192:195], a[104:107], a[40:43], v[192:195]
s_add_u32 s64, s71, 1572864
ds_read_b64_tr_b16 a[84:85], v7 offset:40960
v_mfma_f32_16x16x32_bf16 v[200:203], a[104:107], a[48:51], v[200:203]
buffer_load_dwordx4 v14, s[36:39], s64 offen lds
v_mfma_f32_16x16x32_bf16 v[200:203], a[108:111], a[52:55], v[200:203]
ds_read_b64_tr_b16 a[86:87], v7 offset:41984
v_mfma_f32_16x16x32_bf16 v[208:211], a[108:111], a[60:63], v[208:211]
s_add_u32 m0, s77, 66560
ds_read_b64_tr_b16 a[88:89], v8 offset:32768
v_mfma_f32_16x16x32_bf16 v[208:211], a[104:107], a[56:59], v[208:211]
s_waitcnt lgkmcnt(7)
s_add_u32 s64, s71, 1605632
ds_read_b64_tr_b16 a[90:91], v8 offset:33792
v_mfma_f32_16x16x32_bf16 v[212:215], a[112:115], a[56:59], v[212:215]
buffer_load_dwordx4 v14, s[36:39], s64 offen lds
v_mfma_f32_16x16x32_bf16 v[212:215], a[116:119], a[60:63], v[212:215]
ds_read_b64_tr_b16 a[92:93], v8 offset:40960
v_mfma_f32_16x16x32_bf16 v[204:207], a[116:119], a[52:55], v[204:207]
s_add_u32 m0, s77, 67584
ds_read_b64_tr_b16 a[94:95], v8 offset:41984
v_mfma_f32_16x16x32_bf16 v[204:207], a[112:115], a[48:51], v[204:207]
s_add_u32 s64, s71, 1638400
ds_read_b64_tr_b16 a[96:97], v9 offset:32768
v_mfma_f32_16x16x32_bf16 v[196:199], a[112:115], a[40:43], v[196:199]
buffer_load_dwordx4 v15, s[36:39], s64 offen lds
v_mfma_f32_16x16x32_bf16 v[196:199], a[116:119], a[44:47], v[196:199]
ds_read_b64_tr_b16 a[98:99], v9 offset:33792
v_mfma_f32_16x16x32_bf16 v[188:191], a[116:119], a[36:39], v[188:191]
s_add_u32 m0, s77, 68608
ds_read_b64_tr_b16 a[100:101], v9 offset:40960
v_mfma_f32_16x16x32_bf16 v[188:191], a[112:115], a[32:35], v[188:191]
s_add_u32 s64, s71, 1671168
ds_read_b64_tr_b16 a[102:103], v9 offset:41984
v_mfma_f32_16x16x32_bf16 v[216:219], a[72:75], a[32:35], v[216:219]
s_waitcnt lgkmcnt(7)
buffer_load_dwordx4 v15, s[36:39], s64 offen lds
v_mfma_f32_16x16x32_bf16 v[216:219], a[76:79], a[36:39], v[216:219]
global_load_dwordx4 a[148:151], v18, s[4:5] offset:512
v_mfma_f32_16x16x32_bf16 v[224:227], a[76:79], a[44:47], v[224:227]
ds_read_b64_tr_b16 a[104:105], v10 offset:32768
v_mfma_f32_16x16x32_bf16 v[224:227], a[72:75], a[40:43], v[224:227]
s_add_u32 m0, s77, 81920
ds_read_b64_tr_b16 a[106:107], v10 offset:33792
v_mfma_f32_16x16x32_bf16 v[232:235], a[72:75], a[48:51], v[232:235]
s_add_u32 s64, s71, 1572864
ds_read_b64_tr_b16 a[108:109], v10 offset:40960
v_mfma_f32_16x16x32_bf16 v[232:235], a[76:79], a[52:55], v[232:235]
buffer_load_dwordx4 v14, s[40:43], s64 offen lds
v_mfma_f32_16x16x32_bf16 v[240:243], a[76:79], a[60:63], v[240:243]
ds_read_b64_tr_b16 a[110:111], v10 offset:41984
v_mfma_f32_16x16x32_bf16 v[240:243], a[72:75], a[56:59], v[240:243]
s_add_u32 m0, s77, 82944
ds_read_b64_tr_b16 a[112:113], v11 offset:32768
v_mfma_f32_16x16x32_bf16 v[244:247], a[80:83], a[56:59], v[244:247]
s_add_u32 s64, s71, 1605632
ds_read_b64_tr_b16 a[114:115], v11 offset:33792
v_mfma_f32_16x16x32_bf16 v[244:247], a[84:87], a[60:63], v[244:247]
buffer_load_dwordx4 v14, s[40:43], s64 offen lds
v_mfma_f32_16x16x32_bf16 v[236:239], a[84:87], a[52:55], v[236:239]
ds_read_b64_tr_b16 a[116:117], v11 offset:40960
v_mfma_f32_16x16x32_bf16 v[236:239], a[80:83], a[48:51], v[236:239]
s_add_u32 m0, s77, 83968
ds_read_b64_tr_b16 a[118:119], v11 offset:41984
v_mfma_f32_16x16x32_bf16 v[228:231], a[80:83], a[40:43], v[228:231]
s_add_u32 s64, s71, 1638400
ds_read_b64_tr_b16 a[72:73], v4 offset:49152
v_mfma_f32_16x16x32_bf16 v[228:231], a[84:87], a[44:47], v[228:231]
buffer_load_dwordx4 v15, s[40:43], s64 offen lds
v_mfma_f32_16x16x32_bf16 v[220:223], a[84:87], a[36:39], v[220:223]
ds_read_b64_tr_b16 a[74:75], v4 offset:50176
v_mfma_f32_16x16x32_bf16 v[220:223], a[80:83], a[32:35], v[220:223]
s_waitcnt lgkmcnt(7)
s_add_u32 m0, s77, 84992
ds_read_b64_tr_b16 a[76:77], v4 offset:57344
v_mfma_f32_16x16x32_bf16 v[152:155], a[88:91], a[32:35], v[152:155]
s_add_u32 s64, s71, 1671168
ds_read_b64_tr_b16 a[78:79], v4 offset:58368
v_mfma_f32_16x16x32_bf16 v[152:155], a[92:95], a[36:39], v[152:155]
buffer_load_dwordx4 v15, s[40:43], s64 offen lds
v_mfma_f32_16x16x32_bf16 v[160:163], a[92:95], a[44:47], v[160:163]
ds_read_b64_tr_b16 a[80:81], v5 offset:49152
v_mfma_f32_16x16x32_bf16 v[160:163], a[88:91], a[40:43], v[160:163]
ds_read_b64_tr_b16 a[82:83], v5 offset:50176
v_mfma_f32_16x16x32_bf16 v[168:171], a[88:91], a[48:51], v[168:171]
ds_read_b64_tr_b16 a[84:85], v5 offset:57344
v_mfma_f32_16x16x32_bf16 v[168:171], a[92:95], a[52:55], v[168:171]
ds_read_b64_tr_b16 a[86:87], v5 offset:58368
v_mfma_f32_16x16x32_bf16 v[176:179], a[92:95], a[60:63], v[176:179]
s_add_u32 m0, s76, 32768
global_load_dwordx4 a[164:167], v19, s[22:23] offset:512
v_mfma_f32_16x16x32_bf16 v[176:179], a[88:91], a[56:59], v[176:179]
s_add_u32 s64, s70, 384
ds_read_b64_tr_b16 a[88:89], v6 offset:49152
v_mfma_f32_16x16x32_bf16 v[180:183], a[96:99], a[56:59], v[180:183]
buffer_load_dwordx4 v12, s[32:35], s64 offen lds
v_mfma_f32_16x16x32_bf16 v[180:183], a[100:103], a[60:63], v[180:183]
ds_read_b64_tr_b16 a[90:91], v6 offset:50176
v_mfma_f32_16x16x32_bf16 v[172:175], a[100:103], a[52:55], v[172:175]
ds_read_b64_tr_b16 a[92:93], v6 offset:57344
v_mfma_f32_16x16x32_bf16 v[172:175], a[96:99], a[48:51], v[172:175]
ds_read_b64_tr_b16 a[94:95], v6 offset:58368
v_mfma_f32_16x16x32_bf16 v[164:167], a[96:99], a[40:43], v[164:167]
v_mfma_f32_16x16x32_bf16 v[164:167], a[100:103], a[44:47], v[164:167]
s_add_u32 m0, s76, 33792
v_mfma_f32_16x16x32_bf16 v[156:159], a[100:103], a[36:39], v[156:159]
s_add_u32 s64, s70, 8576
v_mfma_f32_16x16x32_bf16 v[156:159], a[96:99], a[32:35], v[156:159]
buffer_load_dwordx4 v13, s[32:35], s64 offen lds
v_mfma_f32_16x16x32_bf16 v[24:27], a[104:107], a[32:35], v[24:27]
s_waitcnt lgkmcnt(4)
ds_read_b64_tr_b16 a[96:97], v7 offset:49152
v_mfma_f32_16x16x32_bf16 v[24:27], a[108:111], a[36:39], v[24:27]
ds_read_b64_tr_b16 a[98:99], v7 offset:50176
v_mfma_f32_16x16x32_bf16 v[40:43], a[108:111], a[44:47], v[40:43]
ds_read_b64_tr_b16 a[100:101], v7 offset:57344
v_mfma_f32_16x16x32_bf16 v[40:43], a[104:107], a[40:43], v[40:43]
ds_read_b64_tr_b16 a[102:103], v7 offset:58368
v_mfma_f32_16x16x32_bf16 v[56:59], a[104:107], a[48:51], v[56:59]
s_add_u32 m0, s76, 34816
v_mfma_f32_16x16x32_bf16 v[56:59], a[108:111], a[52:55], v[56:59]
s_add_u32 s64, s70, 16768
v_mfma_f32_16x16x32_bf16 v[72:75], a[108:111], a[60:63], v[72:75]
s_waitcnt vmcnt(12)
buffer_load_dwordx4 v12, s[32:35], s64 offen lds
v_mfma_f32_16x16x32_bf16 v[72:75], a[104:107], a[56:59], v[72:75]
ds_read_b64_tr_b16 a[104:105], v8 offset:49152
v_mfma_f32_16x16x32_bf16 v[136:139], a[112:115], a[56:59], v[136:139]
ds_read_b64_tr_b16 a[106:107], v8 offset:50176
v_mfma_f32_16x16x32_bf16 v[136:139], a[116:119], a[60:63], v[136:139]
ds_read_b64_tr_b16 a[108:109], v8 offset:57344
v_add_u32 v4, 0x8000, v4
v_mfma_f32_16x16x32_bf16 v[120:123], a[116:119], a[52:55], v[120:123]
ds_read_b64_tr_b16 a[110:111], v8 offset:58368
v_mfma_f32_16x16x32_bf16 v[120:123], a[112:115], a[48:51], v[120:123]
s_add_u32 m0, s76, 35840
ds_read_b128 a[0:3], v2 offset:0
v_mfma_f32_16x16x32_bf16 v[104:107], a[112:115], a[40:43], v[104:107]
s_add_u32 s64, s70, 24960
global_load_dwordx4 a[152:155], v18, s[4:5] offset:1024
v_mfma_f32_16x16x32_bf16 v[104:107], a[116:119], a[44:47], v[104:107]
buffer_load_dwordx4 v13, s[32:35], s64 offen lds
v_mfma_f32_16x16x32_bf16 v[88:91], a[116:119], a[36:39], v[88:91]
ds_read_b128 a[4:7], v3 offset:0
v_mfma_f32_16x16x32_bf16 v[88:91], a[112:115], a[32:35], v[88:91]
ds_read_b128 a[8:11], v2 offset:2048
v_mfma_f32_16x16x32_bf16 v[28:31], a[32:35], a[72:75], v[28:31]
ds_read_b128 a[12:15], v3 offset:2048
v_mfma_f32_16x16x32_bf16 v[28:31], a[36:39], a[76:79], v[28:31]
ds_read_b128 a[16:19], v2 offset:4096
v_add_u32 v5, 0x8000, v5
v_mfma_f32_16x16x32_bf16 v[44:47], a[44:47], a[76:79], v[44:47]
s_add_u32 m0, s76, 36864
ds_read_b128 a[20:23], v3 offset:4096
v_mfma_f32_16x16x32_bf16 v[44:47], a[40:43], a[72:75], v[44:47]
s_add_u32 s64, s70, 33152
ds_read_b128 a[24:27], v2 offset:6144
v_mfma_f32_16x16x32_bf16 v[60:63], a[48:51], a[72:75], v[60:63]
buffer_load_dwordx4 v12, s[32:35], s64 offen lds
v_mfma_f32_16x16x32_bf16 v[60:63], a[52:55], a[76:79], v[60:63]
ds_read_b128 a[28:31], v3 offset:6144
v_mfma_f32_16x16x32_bf16 v[76:79], a[60:63], a[76:79], v[76:79]
ds_read_b64_tr_b16 a[112:113], v9 offset:49152
v_mfma_f32_16x16x32_bf16 v[76:79], a[56:59], a[72:75], v[76:79]
ds_read_b64_tr_b16 a[114:115], v9 offset:50176
v_mfma_f32_16x16x32_bf16 v[140:143], a[56:59], a[80:83], v[140:143]
ds_read_b64_tr_b16 a[116:117], v9 offset:57344
v_mfma_f32_16x16x32_bf16 v[140:143], a[60:63], a[84:87], v[140:143]
s_add_u32 m0, s76, 37888
ds_read_b64_tr_b16 a[118:119], v9 offset:58368
v_add_u32 v6, 0x8000, v6
v_mfma_f32_16x16x32_bf16 v[124:127], a[52:55], a[84:87], v[124:127]
s_add_u32 s64, s70, 41344
ds_read_b64_tr_b16 a[72:73], v10 offset:49152
v_mfma_f32_16x16x32_bf16 v[124:127], a[48:51], a[80:83], v[124:127]
buffer_load_dwordx4 v13, s[32:35], s64 offen lds
v_mfma_f32_16x16x32_bf16 v[108:111], a[40:43], a[80:83], v[108:111]
ds_read_b64_tr_b16 a[74:75], v10 offset:50176
v_mfma_f32_16x16x32_bf16 v[108:111], a[44:47], a[84:87], v[108:111]
ds_read_b64_tr_b16 a[76:77], v10 offset:57344
v_mfma_f32_16x16x32_bf16 v[92:95], a[36:39], a[84:87], v[92:95]
ds_read_b64_tr_b16 a[78:79], v10 offset:58368
v_mfma_f32_16x16x32_bf16 v[92:95], a[32:35], a[80:83], v[92:95]
s_waitcnt lgkmcnt(8)
ds_read_b64_tr_b16 a[80:81], v11 offset:49152
v_mfma_f32_16x16x32_bf16 v[32:35], a[32:35], a[88:91], v[32:35]
s_add_u32 m0, s76, 38912
ds_read_b64_tr_b16 a[82:83], v11 offset:50176
v_mfma_f32_16x16x32_bf16 v[32:35], a[36:39], a[92:95], v[32:35]
s_add_u32 s64, s70, 49536
ds_read_b64_tr_b16 a[84:85], v11 offset:57344
v_add_u32 v7, 0x8000, v7
v_mfma_f32_16x16x32_bf16 v[48:51], a[44:47], a[92:95], v[48:51]
buffer_load_dwordx4 v12, s[32:35], s64 offen lds
v_mfma_f32_16x16x32_bf16 v[48:51], a[40:43], a[88:91], v[48:51]
global_load_dwordx4 a[168:171], v19, s[22:23] offset:1024
v_mfma_f32_16x16x32_bf16 v[64:67], a[48:51], a[88:91], v[64:67]
ds_read_b64_tr_b16 a[86:87], v11 offset:58368
v_mfma_f32_16x16x32_bf16 v[64:67], a[52:55], a[92:95], v[64:67]
v_mfma_f32_16x16x32_bf16 v[80:83], a[60:63], a[92:95], v[80:83]
v_mfma_f32_16x16x32_bf16 v[80:83], a[56:59], a[88:91], v[80:83]
s_add_u32 m0, s76, 39936
v_mfma_f32_16x16x32_bf16 v[144:147], a[56:59], a[96:99], v[144:147]
s_add_u32 s64, s70, 57728
v_mfma_f32_16x16x32_bf16 v[144:147], a[60:63], a[100:103], v[144:147]
buffer_load_dwordx4 v13, s[32:35], s64 offen lds
v_mfma_f32_16x16x32_bf16 v[128:131], a[52:55], a[100:103], v[128:131]
v_add_u32 v8, 0x8000, v8
v_mfma_f32_16x16x32_bf16 v[128:131], a[48:51], a[96:99], v[128:131]
v_mfma_f32_16x16x32_bf16 v[112:115], a[40:43], a[96:99], v[112:115]
v_mfma_f32_16x16x32_bf16 v[112:115], a[44:47], a[100:103], v[112:115]
v_mfma_f32_16x16x32_bf16 v[96:99], a[36:39], a[100:103], v[96:99]
v_add_u32 v9, 0x8000, v9
v_add_u32 v10, 0x8000, v10
v_mfma_f32_16x16x32_bf16 v[96:99], a[32:35], a[96:99], v[96:99]
v_add_u32 v11, 0x8000, v11
v_mfma_f32_16x16x32_bf16 v[36:39], a[32:35], a[104:107], v[36:39]
v_mfma_f32_16x16x32_bf16 v[36:39], a[36:39], a[108:111], v[36:39]
v_mfma_f32_16x16x32_bf16 v[52:55], a[44:47], a[108:111], v[52:55]
s_waitcnt lgkmcnt(0)
s_barrier
v_mfma_f32_16x16x32_bf16 v[52:55], a[40:43], a[104:107], v[52:55]
s_add_u32 m0, s77, 98304
ds_read_b64_tr_b16 a[88:89], v4 offset:32768
v_mfma_f32_16x16x32_bf16 v[68:71], a[48:51], a[104:107], v[68:71]
s_add_u32 s64, s71, 2097152
ds_read_b64_tr_b16 a[90:91], v4 offset:33792
v_mfma_f32_16x16x32_bf16 v[68:71], a[52:55], a[108:111], v[68:71]
buffer_load_dwordx4 v14, s[36:39], s64 offen lds
v_mfma_f32_16x16x32_bf16 v[84:87], a[60:63], a[108:111], v[84:87]
ds_read_b64_tr_b16 a[92:93], v4 offset:40960
v_mfma_f32_16x16x32_bf16 v[84:87], a[56:59], a[104:107], v[84:87]
ds_read_b64_tr_b16 a[94:95], v4 offset:41984
v_mfma_f32_16x16x32_bf16 v[148:151], a[56:59], a[112:115], v[148:151]
global_load_dwordx4 a[156:159], v18, s[4:5] offset:1536
v_mfma_f32_16x16x32_bf16 v[148:151], a[60:63], a[116:119], v[148:151]
ds_read_b64_tr_b16 a[96:97], v5 offset:32768
v_mfma_f32_16x16x32_bf16 v[132:135], a[52:55], a[116:119], v[132:135]
ds_read_b64_tr_b16 a[98:99], v5 offset:33792
v_mfma_f32_16x16x32_bf16 v[132:135], a[48:51], a[112:115], v[132:135]
s_add_u32 m0, s77, 99328
ds_read_b64_tr_b16 a[100:101], v5 offset:40960
v_mfma_f32_16x16x32_bf16 v[116:119], a[40:43], a[112:115], v[116:119]
s_add_u32 s64, s71, 2129920
ds_read_b64_tr_b16 a[102:103], v5 offset:41984
v_mfma_f32_16x16x32_bf16 v[116:119], a[44:47], a[116:119], v[116:119]
buffer_load_dwordx4 v14, s[36:39], s64 offen lds
v_mfma_f32_16x16x32_bf16 v[100:103], a[36:39], a[116:119], v[100:103]
ds_read_b64_tr_b16 a[104:105], v6 offset:32768
v_mfma_f32_16x16x32_bf16 v[100:103], a[32:35], a[112:115], v[100:103]
ds_read_b64_tr_b16 a[106:107], v6 offset:33792
v_mfma_f32_16x16x32_bf16 v[248:251], a[32:35], a[72:75], v[248:251]
ds_read_b64_tr_b16 a[108:109], v6 offset:40960
v_mfma_f32_16x16x32_bf16 v[248:251], a[36:39], a[76:79], v[248:251]
ds_read_b64_tr_b16 a[110:111], v6 offset:41984
v_mfma_f32_16x16x32_bf16 v[252:255], a[44:47], a[76:79], v[252:255]
ds_read_b64_tr_b16 a[112:113], v7 offset:32768
v_mfma_f32_16x16x32_bf16 v[252:255], a[40:43], a[72:75], v[252:255]
s_add_u32 m0, s77, 100352
ds_read_b64_tr_b16 a[114:115], v7 offset:33792
v_mfma_f32_16x16x32_bf16 a[120:123], a[48:51], a[72:75], a[120:123]
s_add_u32 s64, s71, 2162688
ds_read_b64_tr_b16 a[116:117], v7 offset:40960
v_mfma_f32_16x16x32_bf16 a[120:123], a[52:55], a[76:79], a[120:123]
buffer_load_dwordx4 v15, s[36:39], s64 offen lds
v_mfma_f32_16x16x32_bf16 a[124:127], a[60:63], a[76:79], a[124:127]
ds_read_b64_tr_b16 a[118:119], v7 offset:41984
v_mfma_f32_16x16x32_bf16 a[124:127], a[56:59], a[72:75], a[124:127]
ds_read_b64_tr_b16 a[72:73], v8 offset:32768
v_mfma_f32_16x16x32_bf16 a[128:131], a[56:59], a[80:83], a[128:131]
ds_read_b64_tr_b16 a[74:75], v8 offset:33792
v_mfma_f32_16x16x32_bf16 a[128:131], a[60:63], a[84:87], a[128:131]
ds_read_b64_tr_b16 a[76:77], v8 offset:40960
v_mfma_f32_16x16x32_bf16 a[132:135], a[52:55], a[84:87], a[132:135]
ds_read_b64_tr_b16 a[78:79], v8 offset:41984
v_mfma_f32_16x16x32_bf16 a[132:135], a[48:51], a[80:83], a[132:135]
s_add_u32 m0, s77, 101376
v_mfma_f32_16x16x32_bf16 a[136:139], a[40:43], a[80:83], a[136:139]
s_add_u32 s64, s71, 2195456
v_mfma_f32_16x16x32_bf16 a[136:139], a[44:47], a[84:87], a[136:139]
buffer_load_dwordx4 v15, s[36:39], s64 offen lds
v_mfma_f32_16x16x32_bf16 a[140:143], a[36:39], a[84:87], a[140:143]
global_load_dwordx4 a[172:175], v19, s[22:23] offset:1536
v_mfma_f32_16x16x32_bf16 a[140:143], a[32:35], a[80:83], a[140:143]
s_waitcnt lgkmcnt(5)
ds_read_b64_tr_b16 a[80:81], v9 offset:32768
v_mfma_f32_16x16x32_bf16 v[184:187], a[88:91], a[0:3], v[184:187]
ds_read_b64_tr_b16 a[82:83], v9 offset:33792
v_mfma_f32_16x16x32_bf16 v[184:187], a[92:95], a[4:7], v[184:187]
ds_read_b64_tr_b16 a[84:85], v9 offset:40960
v_mfma_f32_16x16x32_bf16 v[192:195], a[92:95], a[12:15], v[192:195]
ds_read_b64_tr_b16 a[86:87], v9 offset:41984
v_mfma_f32_16x16x32_bf16 v[192:195], a[88:91], a[8:11], v[192:195]
s_add_u32 m0, s77, 114688
s_add_u32 s17, s78, .-L_pc+6144
v_mfma_f32_16x16x32_bf16 v[200:203], a[88:91], a[16:19], v[200:203]
s_add_u32 s64, s71, 2097152
buffer_load_dword a252, v16, s[88:91], s17 offen
v_mfma_f32_16x16x32_bf16 v[200:203], a[92:95], a[20:23], v[200:203]
buffer_load_dwordx4 v14, s[40:43], s64 offen lds
v_mfma_f32_16x16x32_bf16 v[208:211], a[92:95], a[28:31], v[208:211]
v_mfma_f32_16x16x32_bf16 v[208:211], a[88:91], a[24:27], v[208:211]
ds_read_b64_tr_b16 a[88:89], v10 offset:32768
v_mfma_f32_16x16x32_bf16 v[212:215], a[96:99], a[24:27], v[212:215]
ds_read_b64_tr_b16 a[90:91], v10 offset:33792
v_mfma_f32_16x16x32_bf16 v[212:215], a[100:103], a[28:31], v[212:215]
ds_read_b64_tr_b16 a[92:93], v10 offset:40960
v_mfma_f32_16x16x32_bf16 v[204:207], a[100:103], a[20:23], v[204:207]
ds_read_b64_tr_b16 a[94:95], v10 offset:41984
v_mfma_f32_16x16x32_bf16 v[204:207], a[96:99], a[16:19], v[204:207]
s_add_u32 m0, s77, 115712
v_mfma_f32_16x16x32_bf16 v[196:199], a[96:99], a[8:11], v[196:199]
s_add_u32 s64, s71, 2129920
v_mfma_f32_16x16x32_bf16 v[196:199], a[100:103], a[12:15], v[196:199]
buffer_load_dwordx4 v14, s[40:43], s64 offen lds
v_mfma_f32_16x16x32_bf16 v[188:191], a[100:103], a[4:7], v[188:191]
v_mfma_f32_16x16x32_bf16 v[188:191], a[96:99], a[0:3], v[188:191]
ds_read_b64_tr_b16 a[96:97], v11 offset:32768
v_mfma_f32_16x16x32_bf16 v[216:219], a[104:107], a[0:3], v[216:219]
ds_read_b64_tr_b16 a[98:99], v11 offset:33792
v_mfma_f32_16x16x32_bf16 v[216:219], a[108:111], a[4:7], v[216:219]
ds_read_b64_tr_b16 a[100:101], v11 offset:40960
v_mfma_f32_16x16x32_bf16 v[224:227], a[108:111], a[12:15], v[224:227]
ds_read_b64_tr_b16 a[102:103], v11 offset:41984
v_mfma_f32_16x16x32_bf16 v[224:227], a[104:107], a[8:11], v[224:227]
s_add_u32 m0, s77, 116736
v_mfma_f32_16x16x32_bf16 v[232:235], a[104:107], a[16:19], v[232:235]
s_add_u32 s64, s71, 2162688
buffer_store_dword v21, v20, s[44:47], s69 offen sc1
v_mfma_f32_16x16x32_bf16 v[232:235], a[108:111], a[20:23], v[232:235]
buffer_load_dwordx4 v15, s[40:43], s64 offen lds
v_mfma_f32_16x16x32_bf16 v[240:243], a[108:111], a[28:31], v[240:243]
v_mfma_f32_16x16x32_bf16 v[240:243], a[104:107], a[24:27], v[240:243]
ds_read_b64_tr_b16 a[104:105], v4 offset:49152
v_mfma_f32_16x16x32_bf16 v[244:247], a[112:115], a[24:27], v[244:247]
s_waitcnt lgkmcnt(5)
buffer_load_dword a252, v16, s[56:59], s81 offen
v_mfma_f32_16x16x32_bf16 v[244:247], a[116:119], a[28:31], v[244:247]
ds_read_b64_tr_b16 a[106:107], v4 offset:50176
v_mfma_f32_16x16x32_bf16 v[236:239], a[116:119], a[20:23], v[236:239]
ds_read_b64_tr_b16 a[108:109], v4 offset:57344
v_mfma_f32_16x16x32_bf16 v[236:239], a[112:115], a[16:19], v[236:239]
s_add_u32 m0, s77, 117760
ds_read_b64_tr_b16 a[110:111], v4 offset:58368
v_mfma_f32_16x16x32_bf16 v[228:231], a[112:115], a[8:11], v[228:231]
s_add_u32 s64, s71, 2195456
v_mfma_f32_16x16x32_bf16 v[228:231], a[116:119], a[12:15], v[228:231]
buffer_load_dwordx4 v15, s[40:43], s64 offen lds
v_mfma_f32_16x16x32_bf16 v[220:223], a[116:119], a[4:7], v[220:223]
v_mfma_f32_16x16x32_bf16 v[220:223], a[112:115], a[0:3], v[220:223]
ds_read_b64_tr_b16 a[112:113], v5 offset:49152
v_mfma_f32_16x16x32_bf16 v[152:155], a[72:75], a[0:3], v[152:155]
ds_read_b64_tr_b16 a[114:115], v5 offset:50176
v_mfma_f32_16x16x32_bf16 v[152:155], a[76:79], a[4:7], v[152:155]
ds_read_b64_tr_b16 a[116:117], v5 offset:57344
v_mfma_f32_16x16x32_bf16 v[160:163], a[76:79], a[12:15], v[160:163]
ds_read_b64_tr_b16 a[118:119], v5 offset:58368
v_mfma_f32_16x16x32_bf16 v[160:163], a[72:75], a[8:11], v[160:163]
v_mfma_f32_16x16x32_bf16 v[168:171], a[72:75], a[16:19], v[168:171]
v_mfma_f32_16x16x32_bf16 v[168:171], a[76:79], a[20:23], v[168:171]
v_mfma_f32_16x16x32_bf16 v[176:179], a[76:79], a[28:31], v[176:179]
s_add_u32 m0, s76, 0
v_mfma_f32_16x16x32_bf16 v[176:179], a[72:75], a[24:27], v[176:179]
s_add_u32 s64, s70, 512
ds_read_b64_tr_b16 a[72:73], v6 offset:49152
v_mfma_f32_16x16x32_bf16 v[180:183], a[80:83], a[24:27], v[180:183]
buffer_load_dwordx4 v12, s[32:35], s64 offen lds
v_mfma_f32_16x16x32_bf16 v[180:183], a[84:87], a[28:31], v[180:183]
ds_read_b64_tr_b16 a[74:75], v6 offset:50176
v_mfma_f32_16x16x32_bf16 v[172:175], a[84:87], a[20:23], v[172:175]
ds_read_b64_tr_b16 a[76:77], v6 offset:57344
v_mfma_f32_16x16x32_bf16 v[172:175], a[80:83], a[16:19], v[172:175]
ds_read_b64_tr_b16 a[78:79], v6 offset:58368
v_mfma_f32_16x16x32_bf16 v[164:167], a[80:83], a[8:11], v[164:167]
v_mfma_f32_16x16x32_bf16 v[164:167], a[84:87], a[12:15], v[164:167]
s_add_u32 m0, s76, 1024
v_mfma_f32_16x16x32_bf16 v[156:159], a[84:87], a[4:7], v[156:159]
s_add_u32 s64, s70, 8704
v_mfma_f32_16x16x32_bf16 v[156:159], a[80:83], a[0:3], v[156:159]
buffer_load_dwordx4 v13, s[32:35], s64 offen lds
v_mfma_f32_16x16x32_bf16 v[24:27], a[88:91], a[0:3], v[24:27]
ds_read_b64_tr_b16 a[80:81], v7 offset:49152
v_mfma_f32_16x16x32_bf16 v[24:27], a[92:95], a[4:7], v[24:27]
ds_read_b64_tr_b16 a[82:83], v7 offset:50176
v_mfma_f32_16x16x32_bf16 v[40:43], a[92:95], a[12:15], v[40:43]
ds_read_b64_tr_b16 a[84:85], v7 offset:57344
v_mfma_f32_16x16x32_bf16 v[40:43], a[88:91], a[8:11], v[40:43]
ds_read_b64_tr_b16 a[86:87], v7 offset:58368
v_mfma_f32_16x16x32_bf16 v[56:59], a[88:91], a[16:19], v[56:59]
s_add_u32 m0, s76, 2048
v_mfma_f32_16x16x32_bf16 v[56:59], a[92:95], a[20:23], v[56:59]
s_add_u32 s64, s70, 16896
v_mfma_f32_16x16x32_bf16 v[72:75], a[92:95], a[28:31], v[72:75]
s_waitcnt vmcnt(15)
buffer_load_dwordx4 v12, s[32:35], s64 offen lds
v_mfma_f32_16x16x32_bf16 v[72:75], a[88:91], a[24:27], v[72:75]
s_waitcnt lgkmcnt(4)
ds_read_b64_tr_b16 a[88:89], v8 offset:49152
v_mfma_f32_16x16x32_bf16 v[136:139], a[96:99], a[24:27], v[136:139]
buffer_load_dword a252, v1, s[60:63], s82 offen
v_mfma_f32_16x16x32_bf16 v[136:139], a[100:103], a[28:31], v[136:139]
ds_read_b64_tr_b16 a[90:91], v8 offset:50176
v_subrev_u32 v4, 0x8000, v4
v_mfma_f32_16x16x32_bf16 v[120:123], a[100:103], a[20:23], v[120:123]
ds_read_b64_tr_b16 a[92:93], v8 offset:57344
v_mfma_f32_16x16x32_bf16 v[120:123], a[96:99], a[16:19], v[120:123]
s_add_u32 m0, s76, 3072
ds_read_b64_tr_b16 a[94:95], v8 offset:58368
v_mfma_f32_16x16x32_bf16 v[104:107], a[96:99], a[8:11], v[104:107]
s_add_u32 s64, s70, 25088
ds_read_b128 a[32:35], v2 offset:32768
v_mfma_f32_16x16x32_bf16 v[104:107], a[100:103], a[12:15], v[104:107]
buffer_load_dwordx4 v13, s[32:35], s64 offen lds
v_mfma_f32_16x16x32_bf16 v[88:91], a[100:103], a[4:7], v[88:91]
ds_read_b128 a[36:39], v3 offset:32768
v_mfma_f32_16x16x32_bf16 v[88:91], a[96:99], a[0:3], v[88:91]
ds_read_b128 a[40:43], v2 offset:34816
v_mfma_f32_16x16x32_bf16 v[28:31], a[0:3], a[104:107], v[28:31]
ds_read_b128 a[44:47], v3 offset:34816
v_mfma_f32_16x16x32_bf16 v[28:31], a[4:7], a[108:111], v[28:31]
ds_read_b128 a[48:51], v2 offset:36864
v_subrev_u32 v5, 0x8000, v5
v_mfma_f32_16x16x32_bf16 v[44:47], a[12:15], a[108:111], v[44:47]
s_add_u32 m0, s76, 4096
ds_read_b128 a[52:55], v3 offset:36864
v_mfma_f32_16x16x32_bf16 v[44:47], a[8:11], a[104:107], v[44:47]
s_add_u32 s64, s70, 33280
ds_read_b128 a[56:59], v2 offset:38912
v_mfma_f32_16x16x32_bf16 v[60:63], a[16:19], a[104:107], v[60:63]
buffer_load_dwordx4 v12, s[32:35], s64 offen lds
v_mfma_f32_16x16x32_bf16 v[60:63], a[20:23], a[108:111], v[60:63]
ds_read_b128 a[60:63], v3 offset:38912
v_mfma_f32_16x16x32_bf16 v[76:79], a[28:31], a[108:111], v[76:79]
ds_read_b64_tr_b16 a[96:97], v9 offset:49152
v_mfma_f32_16x16x32_bf16 v[76:79], a[24:27], a[104:107], v[76:79]
ds_read_b64_tr_b16 a[98:99], v9 offset:50176
v_mfma_f32_16x16x32_bf16 v[140:143], a[24:27], a[112:115], v[140:143]
ds_read_b64_tr_b16 a[100:101], v9 offset:57344
v_mfma_f32_16x16x32_bf16 v[140:143], a[28:31], a[116:119], v[140:143]
s_add_u32 m0, s76, 5120
ds_read_b64_tr_b16 a[102:103], v9 offset:58368
v_subrev_u32 v6, 0x8000, v6
v_mfma_f32_16x16x32_bf16 v[124:127], a[20:23], a[116:119], v[124:127]
s_add_u32 s64, s70, 41472
ds_read_b64_tr_b16 a[104:105], v10 offset:49152
v_mfma_f32_16x16x32_bf16 v[124:127], a[16:19], a[112:115], v[124:127]
buffer_load_dwordx4 v13, s[32:35], s64 offen lds
v_mfma_f32_16x16x32_bf16 v[108:111], a[8:11], a[112:115], v[108:111]
ds_read_b64_tr_b16 a[106:107], v10 offset:50176
v_mfma_f32_16x16x32_bf16 v[108:111], a[12:15], a[116:119], v[108:111]
ds_read_b64_tr_b16 a[108:109], v10 offset:57344
v_mfma_f32_16x16x32_bf16 v[92:95], a[4:7], a[116:119], v[92:95]
ds_read_b64_tr_b16 a[110:111], v10 offset:58368
v_mfma_f32_16x16x32_bf16 v[92:95], a[0:3], a[112:115], v[92:95]
ds_read_b64_tr_b16 a[112:113], v11 offset:49152
v_mfma_f32_16x16x32_bf16 v[32:35], a[0:3], a[72:75], v[32:35]
s_add_u32 m0, s76, 6144
ds_read_b64_tr_b16 a[114:115], v11 offset:50176
v_mfma_f32_16x16x32_bf16 v[32:35], a[4:7], a[76:79], v[32:35]
s_add_u32 s64, s70, 49664
ds_read_b64_tr_b16 a[116:117], v11 offset:57344
v_subrev_u32 v7, 0x8000, v7
v_mfma_f32_16x16x32_bf16 v[48:51], a[12:15], a[76:79], v[48:51]
buffer_load_dwordx4 v12, s[32:35], s64 offen lds
v_mfma_f32_16x16x32_bf16 v[48:51], a[8:11], a[72:75], v[48:51]
ds_read_b64_tr_b16 a[118:119], v11 offset:58368
v_mfma_f32_16x16x32_bf16 v[64:67], a[16:19], a[72:75], v[64:67]
v_mfma_f32_16x16x32_bf16 v[64:67], a[20:23], a[76:79], v[64:67]
v_mfma_f32_16x16x32_bf16 v[80:83], a[28:31], a[76:79], v[80:83]
v_mfma_f32_16x16x32_bf16 v[80:83], a[24:27], a[72:75], v[80:83]
s_waitcnt lgkmcnt(5)
s_add_u32 m0, s76, 7168
s_add_u32 s81, s81, 1048576
v_mfma_f32_16x16x32_bf16 v[144:147], a[24:27], a[80:83], v[144:147]
s_add_u32 s64, s70, 57856
buffer_load_dword a252, v16, s[56:59], s81 offen
v_mfma_f32_16x16x32_bf16 v[144:147], a[28:31], a[84:87], v[144:147]
buffer_load_dwordx4 v13, s[32:35], s64 offen lds
v_mfma_f32_16x16x32_bf16 v[128:131], a[20:23], a[84:87], v[128:131]
v_subrev_u32 v8, 0x8000, v8
v_mfma_f32_16x16x32_bf16 v[128:131], a[16:19], a[80:83], v[128:131]
v_mfma_f32_16x16x32_bf16 v[112:115], a[8:11], a[80:83], v[112:115]
v_mfma_f32_16x16x32_bf16 v[112:115], a[12:15], a[84:87], v[112:115]
v_mfma_f32_16x16x32_bf16 v[96:99], a[4:7], a[84:87], v[96:99]
v_subrev_u32 v9, 0x8000, v9
v_subrev_u32 v10, 0x8000, v10
v_mfma_f32_16x16x32_bf16 v[96:99], a[0:3], a[80:83], v[96:99]
v_subrev_u32 v11, 0x8000, v11
v_mfma_f32_16x16x32_bf16 v[36:39], a[0:3], a[88:91], v[36:39]
v_mfma_f32_16x16x32_bf16 v[36:39], a[4:7], a[92:95], v[36:39]
v_mfma_f32_16x16x32_bf16 v[52:55], a[12:15], a[92:95], v[52:55]
s_waitcnt lgkmcnt(0)
s_barrier
v_mfma_f32_16x16x32_bf16 v[52:55], a[8:11], a[88:91], v[52:55]
s_add_u32 m0, s77, 131072
ds_read_b64_tr_b16 a[72:73], v4 offset:0
v_mfma_f32_16x16x32_bf16 v[68:71], a[16:19], a[88:91], v[68:71]
s_add_u32 s64, s71, 2621440
ds_read_b64_tr_b16 a[74:75], v4 offset:1024
v_mfma_f32_16x16x32_bf16 v[68:71], a[20:23], a[92:95], v[68:71]
buffer_load_dwordx4 v14, s[36:39], s64 offen lds
v_mfma_f32_16x16x32_bf16 v[84:87], a[28:31], a[92:95], v[84:87]
ds_read_b64_tr_b16 a[76:77], v4 offset:8192
v_mfma_f32_16x16x32_bf16 v[84:87], a[24:27], a[88:91], v[84:87]
ds_read_b64_tr_b16 a[78:79], v4 offset:9216
v_mfma_f32_16x16x32_bf16 v[148:151], a[24:27], a[96:99], v[148:151]
ds_read_b64_tr_b16 a[80:81], v5 offset:0
v_mfma_f32_16x16x32_bf16 v[148:151], a[28:31], a[100:103], v[148:151]
ds_read_b64_tr_b16 a[82:83], v5 offset:1024
v_mfma_f32_16x16x32_bf16 v[132:135], a[20:23], a[100:103], v[132:135]
ds_read_b64_tr_b16 a[84:85], v5 offset:8192
v_mfma_f32_16x16x32_bf16 v[132:135], a[16:19], a[96:99], v[132:135]
s_add_u32 m0, s77, 132096
ds_read_b64_tr_b16 a[86:87], v5 offset:9216
v_mfma_f32_16x16x32_bf16 v[116:119], a[8:11], a[96:99], v[116:119]
s_add_u32 s64, s71, 2654208
ds_read_b64_tr_b16 a[88:89], v6 offset:0
v_mfma_f32_16x16x32_bf16 v[116:119], a[12:15], a[100:103], v[116:119]
buffer_load_dwordx4 v14, s[36:39], s64 offen lds
v_mfma_f32_16x16x32_bf16 v[100:103], a[4:7], a[100:103], v[100:103]
ds_read_b64_tr_b16 a[90:91], v6 offset:1024
v_mfma_f32_16x16x32_bf16 v[100:103], a[0:3], a[96:99], v[100:103]
ds_read_b64_tr_b16 a[92:93], v6 offset:8192
v_mfma_f32_16x16x32_bf16 v[248:251], a[0:3], a[104:107], v[248:251]
ds_read_b64_tr_b16 a[94:95], v6 offset:9216
v_mfma_f32_16x16x32_bf16 v[248:251], a[4:7], a[108:111], v[248:251]
ds_read_b64_tr_b16 a[96:97], v7 offset:0
v_mfma_f32_16x16x32_bf16 v[252:255], a[12:15], a[108:111], v[252:255]
ds_read_b64_tr_b16 a[98:99], v7 offset:1024
v_mfma_f32_16x16x32_bf16 v[252:255], a[8:11], a[104:107], v[252:255]
s_add_u32 m0, s77, 133120
ds_read_b64_tr_b16 a[100:101], v7 offset:8192
v_mfma_f32_16x16x32_bf16 a[120:123], a[16:19], a[104:107], a[120:123]
s_add_u32 s64, s71, 2686976
ds_read_b64_tr_b16 a[102:103], v7 offset:9216
v_mfma_f32_16x16x32_bf16 a[120:123], a[20:23], a[108:111], a[120:123]
buffer_load_dwordx4 v15, s[36:39], s64 offen lds
v_mfma_f32_16x16x32_bf16 a[124:127], a[28:31], a[108:111], a[124:127]
v_mfma_f32_16x16x32_bf16 a[124:127], a[24:27], a[104:107], a[124:127]
s_add_u32 s82, s82, 1048576
ds_read_b64_tr_b16 a[104:105], v8 offset:0
v_mfma_f32_16x16x32_bf16 a[128:131], a[24:27], a[112:115], a[128:131]
buffer_load_dword a252, v1, s[60:63], s82 offen
v_mfma_f32_16x16x32_bf16 a[128:131], a[28:31], a[116:119], a[128:131]
ds_read_b64_tr_b16 a[106:107], v8 offset:1024
v_mfma_f32_16x16x32_bf16 a[132:135], a[20:23], a[116:119], a[132:135]
ds_read_b64_tr_b16 a[108:109], v8 offset:8192
v_mfma_f32_16x16x32_bf16 a[132:135], a[16:19], a[112:115], a[132:135]
s_add_u32 m0, s77, 134144
ds_read_b64_tr_b16 a[110:111], v8 offset:9216
v_mfma_f32_16x16x32_bf16 a[136:139], a[8:11], a[112:115], a[136:139]
s_add_u32 s64, s71, 2719744
v_mfma_f32_16x16x32_bf16 a[136:139], a[12:15], a[116:119], a[136:139]
buffer_load_dwordx4 v15, s[36:39], s64 offen lds
v_mfma_f32_16x16x32_bf16 a[140:143], a[4:7], a[116:119], a[140:143]
v_mfma_f32_16x16x32_bf16 a[140:143], a[0:3], a[112:115], a[140:143]
s_waitcnt lgkmcnt(4)
ds_read_b64_tr_b16 a[112:113], v9 offset:0
v_mfma_f32_16x16x32_bf16 v[184:187], a[72:75], a[32:35], v[184:187]
ds_read_b64_tr_b16 a[114:115], v9 offset:1024
v_mov_b32 v17, 0
v_mfma_f32_16x16x32_bf16 v[184:187], a[76:79], a[36:39], v[184:187]
ds_read_b64_tr_b16 a[116:117], v9 offset:8192
v_accvgpr_read_b32 v19, a144
v_mfma_f32_16x16x32_bf16 v[192:195], a[76:79], a[44:47], v[192:195]
ds_read_b64_tr_b16 a[118:119], v9 offset:9216
v_accvgpr_read_b32 v21, a160
v_mfma_f32_16x16x32_bf16 v[192:195], a[72:75], a[40:43], v[192:195]
s_add_u32 m0, s77, 147456
v_lshlrev_b32 v18, 16, v19
v_and_b32 v19, 0xffff0000, v19
v_mfma_f32_16x16x32_bf16 v[200:203], a[72:75], a[48:51], v[200:203]
s_add_u32 s64, s71, 2621440
v_lshlrev_b32 v20, 16, v21
v_and_b32 v21, 0xffff0000, v21
v_mfma_f32_16x16x32_bf16 v[200:203], a[76:79], a[52:55], v[200:203]
buffer_load_dwordx4 v14, s[40:43], s64 offen lds
v_mfma_f32_16x16x32_bf16 v[208:211], a[76:79], a[60:63], v[208:211]
v_mul_f32 v18, v18, v20
v_mul_f32 v19, v19, v21
v_mfma_f32_16x16x32_bf16 v[208:211], a[72:75], a[56:59], v[208:211]
ds_read_b64_tr_b16 a[72:73], v10 offset:0
v_cvt_pk_bf16_f32 v18, v18, v19
v_mfma_f32_16x16x32_bf16 v[212:215], a[80:83], a[56:59], v[212:215]
ds_read_b64_tr_b16 a[74:75], v10 offset:1024
v_lshlrev_b32 v19, 16, v18
v_mfma_f32_16x16x32_bf16 v[212:215], a[84:87], a[60:63], v[212:215]
ds_read_b64_tr_b16 a[76:77], v10 offset:8192
v_and_b32 v18, 0xffff0000, v18
v_mfma_f32_16x16x32_bf16 v[204:207], a[84:87], a[52:55], v[204:207]
ds_read_b64_tr_b16 a[78:79], v10 offset:9216
v_add_f32 v17, v17, v19
v_mfma_f32_16x16x32_bf16 v[204:207], a[80:83], a[48:51], v[204:207]
s_add_u32 m0, s77, 148480
v_add_f32 v17, v17, v18
v_accvgpr_read_b32 v19, a145
v_mfma_f32_16x16x32_bf16 v[196:199], a[80:83], a[40:43], v[196:199]
s_add_u32 s64, s71, 2654208
v_accvgpr_read_b32 v21, a161
v_lshlrev_b32 v18, 16, v19
v_mfma_f32_16x16x32_bf16 v[196:199], a[84:87], a[44:47], v[196:199]
buffer_load_dwordx4 v14, s[40:43], s64 offen lds
v_mfma_f32_16x16x32_bf16 v[188:191], a[84:87], a[36:39], v[188:191]
v_and_b32 v19, 0xffff0000, v19
v_lshlrev_b32 v20, 16, v21
v_mfma_f32_16x16x32_bf16 v[188:191], a[80:83], a[32:35], v[188:191]
ds_read_b64_tr_b16 a[80:81], v11 offset:0
v_and_b32 v21, 0xffff0000, v21
v_mfma_f32_16x16x32_bf16 v[216:219], a[88:91], a[32:35], v[216:219]
ds_read_b64_tr_b16 a[82:83], v11 offset:1024
v_mul_f32 v18, v18, v20
v_mfma_f32_16x16x32_bf16 v[216:219], a[92:95], a[36:39], v[216:219]
ds_read_b64_tr_b16 a[84:85], v11 offset:8192
v_mul_f32 v19, v19, v21
v_mfma_f32_16x16x32_bf16 v[224:227], a[92:95], a[44:47], v[224:227]
ds_read_b64_tr_b16 a[86:87], v11 offset:9216
v_cvt_pk_bf16_f32 v18, v18, v19
v_mfma_f32_16x16x32_bf16 v[224:227], a[88:91], a[40:43], v[224:227]
s_add_u32 m0, s77, 149504
v_lshlrev_b32 v19, 16, v18
v_and_b32 v18, 0xffff0000, v18
v_mfma_f32_16x16x32_bf16 v[232:235], a[88:91], a[48:51], v[232:235]
s_add_u32 s64, s71, 2686976
v_add_f32 v17, v17, v19
v_add_f32 v17, v17, v18
v_mfma_f32_16x16x32_bf16 v[232:235], a[92:95], a[52:55], v[232:235]
buffer_load_dwordx4 v15, s[40:43], s64 offen lds
v_mfma_f32_16x16x32_bf16 v[240:243], a[92:95], a[60:63], v[240:243]
v_accvgpr_read_b32 v19, a146
v_accvgpr_read_b32 v21, a162
v_mfma_f32_16x16x32_bf16 v[240:243], a[88:91], a[56:59], v[240:243]
s_add_u32 s81, s81, 1048576
ds_read_b64_tr_b16 a[88:89], v4 offset:16384
v_lshlrev_b32 v18, 16, v19
v_mfma_f32_16x16x32_bf16 v[244:247], a[96:99], a[56:59], v[244:247]
buffer_load_dword a252, v16, s[56:59], s81 offen
v_mfma_f32_16x16x32_bf16 v[244:247], a[100:103], a[60:63], v[244:247]
ds_read_b64_tr_b16 a[90:91], v4 offset:17408
v_and_b32 v19, 0xffff0000, v19
v_mfma_f32_16x16x32_bf16 v[236:239], a[100:103], a[52:55], v[236:239]
ds_read_b64_tr_b16 a[92:93], v4 offset:24576
v_lshlrev_b32 v20, 16, v21
v_mfma_f32_16x16x32_bf16 v[236:239], a[96:99], a[48:51], v[236:239]
s_add_u32 m0, s77, 150528
ds_read_b64_tr_b16 a[94:95], v4 offset:25600
v_and_b32 v21, 0xffff0000, v21
v_mfma_f32_16x16x32_bf16 v[228:231], a[96:99], a[40:43], v[228:231]
s_add_u32 s64, s71, 2719744
v_mul_f32 v18, v18, v20
v_mul_f32 v19, v19, v21
v_mfma_f32_16x16x32_bf16 v[228:231], a[100:103], a[44:47], v[228:231]
buffer_load_dwordx4 v15, s[40:43], s64 offen lds
v_mfma_f32_16x16x32_bf16 v[220:223], a[100:103], a[36:39], v[220:223]
v_cvt_pk_bf16_f32 v18, v18, v19
v_lshlrev_b32 v19, 16, v18
v_mfma_f32_16x16x32_bf16 v[220:223], a[96:99], a[32:35], v[220:223]
s_waitcnt lgkmcnt(4)
ds_read_b64_tr_b16 a[96:97], v5 offset:16384
v_and_b32 v18, 0xffff0000, v18
v_mfma_f32_16x16x32_bf16 v[152:155], a[104:107], a[32:35], v[152:155]
ds_read_b64_tr_b16 a[98:99], v5 offset:17408
v_add_f32 v17, v17, v19
v_mfma_f32_16x16x32_bf16 v[152:155], a[108:111], a[36:39], v[152:155]
ds_read_b64_tr_b16 a[100:101], v5 offset:24576
v_add_f32 v17, v17, v18
v_mfma_f32_16x16x32_bf16 v[160:163], a[108:111], a[44:47], v[160:163]
ds_read_b64_tr_b16 a[102:103], v5 offset:25600
v_accvgpr_read_b32 v19, a147
v_mfma_f32_16x16x32_bf16 v[160:163], a[104:107], a[40:43], v[160:163]
v_accvgpr_read_b32 v21, a163
v_lshlrev_b32 v18, 16, v19
v_mfma_f32_16x16x32_bf16 v[168:171], a[104:107], a[48:51], v[168:171]
v_and_b32 v19, 0xffff0000, v19
v_lshlrev_b32 v20, 16, v21
v_mfma_f32_16x16x32_bf16 v[168:171], a[108:111], a[52:55], v[168:171]
v_and_b32 v21, 0xffff0000, v21
v_mul_f32 v18, v18, v20
v_mfma_f32_16x16x32_bf16 v[176:179], a[108:111], a[60:63], v[176:179]
s_add_u32 m0, s76, 32768
v_mul_f32 v19, v19, v21
v_cvt_pk_bf16_f32 v18, v18, v19
v_mfma_f32_16x16x32_bf16 v[176:179], a[104:107], a[56:59], v[176:179]
s_add_u32 s64, s70, 640
ds_read_b64_tr_b16 a[104:105], v6 offset:16384
v_lshlrev_b32 v19, 16, v18
v_mfma_f32_16x16x32_bf16 v[180:183], a[112:115], a[56:59], v[180:183]
buffer_load_dwordx4 v12, s[32:35], s64 offen lds
v_mfma_f32_16x16x32_bf16 v[180:183], a[116:119], a[60:63], v[180:183]
ds_read_b64_tr_b16 a[106:107], v6 offset:17408
v_and_b32 v18, 0xffff0000, v18
v_mfma_f32_16x16x32_bf16 v[172:175], a[116:119], a[52:55], v[172:175]
ds_read_b64_tr_b16 a[108:109], v6 offset:24576
v_add_f32 v17, v17, v19
v_mfma_f32_16x16x32_bf16 v[172:175], a[112:115], a[48:51], v[172:175]
ds_read_b64_tr_b16 a[110:111], v6 offset:25600
v_add_f32 v17, v17, v18
v_mfma_f32_16x16x32_bf16 v[164:167], a[112:115], a[40:43], v[164:167]
v_accvgpr_read_b32 v19, a148
v_accvgpr_read_b32 v21, a164
v_mfma_f32_16x16x32_bf16 v[164:167], a[116:119], a[44:47], v[164:167]
s_add_u32 m0, s76, 33792
v_lshlrev_b32 v18, 16, v19
v_and_b32 v19, 0xffff0000, v19
v_mfma_f32_16x16x32_bf16 v[156:159], a[116:119], a[36:39], v[156:159]
s_add_u32 s64, s70, 8832
v_lshlrev_b32 v20, 16, v21
v_and_b32 v21, 0xffff0000, v21
v_mfma_f32_16x16x32_bf16 v[156:159], a[112:115], a[32:35], v[156:159]
buffer_load_dwordx4 v13, s[32:35], s64 offen lds
v_mfma_f32_16x16x32_bf16 v[24:27], a[72:75], a[32:35], v[24:27]
ds_read_b64_tr_b16 a[112:113], v7 offset:16384
v_mul_f32 v18, v18, v20
v_mfma_f32_16x16x32_bf16 v[24:27], a[76:79], a[36:39], v[24:27]
ds_read_b64_tr_b16 a[114:115], v7 offset:17408
v_mul_f32 v19, v19, v21
v_mfma_f32_16x16x32_bf16 v[40:43], a[76:79], a[44:47], v[40:43]
ds_read_b64_tr_b16 a[116:117], v7 offset:24576
v_cvt_pk_bf16_f32 v18, v18, v19
v_mfma_f32_16x16x32_bf16 v[40:43], a[72:75], a[40:43], v[40:43]
ds_read_b64_tr_b16 a[118:119], v7 offset:25600
v_lshlrev_b32 v19, 16, v18
v_mfma_f32_16x16x32_bf16 v[56:59], a[72:75], a[48:51], v[56:59]
s_add_u32 m0, s76, 34816
v_and_b32 v18, 0xffff0000, v18
v_add_f32 v17, v17, v19
v_mfma_f32_16x16x32_bf16 v[56:59], a[76:79], a[52:55], v[56:59]
s_add_u32 s64, s70, 17024
v_add_f32 v17, v17, v18
v_accvgpr_read_b32 v19, a149
v_mfma_f32_16x16x32_bf16 v[72:75], a[76:79], a[60:63], v[72:75]
s_waitcnt vmcnt(12)
buffer_load_dwordx4 v12, s[32:35], s64 offen lds
v_mfma_f32_16x16x32_bf16 v[72:75], a[72:75], a[56:59], v[72:75]
s_add_u32 s81, s81, 1048576
ds_read_b64_tr_b16 a[72:73], v8 offset:16384
v_accvgpr_read_b32 v21, a165
v_mfma_f32_16x16x32_bf16 v[136:139], a[80:83], a[56:59], v[136:139]
buffer_load_dword a252, v16, s[56:59], s81 offen
v_mfma_f32_16x16x32_bf16 v[136:139], a[84:87], a[60:63], v[136:139]
ds_read_b64_tr_b16 a[74:75], v8 offset:17408
v_lshlrev_b32 v18, 16, v19
v_mfma_f32_16x16x32_bf16 v[120:123], a[84:87], a[52:55], v[120:123]
ds_read_b64_tr_b16 a[76:77], v8 offset:24576
v_and_b32 v19, 0xffff0000, v19
v_mfma_f32_16x16x32_bf16 v[120:123], a[80:83], a[48:51], v[120:123]
s_add_u32 m0, s76, 35840
ds_read_b64_tr_b16 a[78:79], v8 offset:25600
v_lshlrev_b32 v20, 16, v21
v_mfma_f32_16x16x32_bf16 v[104:107], a[80:83], a[40:43], v[104:107]
s_add_u32 s64, s70, 25216
ds_read_b128 a[0:3], v2 offset:0
v_and_b32 v21, 0xffff0000, v21
v_mfma_f32_16x16x32_bf16 v[104:107], a[84:87], a[44:47], v[104:107]
buffer_load_dwordx4 v13, s[32:35], s64 offen lds
v_mfma_f32_16x16x32_bf16 v[88:91], a[84:87], a[36:39], v[88:91]
ds_read_b128 a[4:7], v3 offset:0
v_mul_f32 v18, v18, v20
v_mfma_f32_16x16x32_bf16 v[88:91], a[80:83], a[32:35], v[88:91]
s_waitcnt lgkmcnt(6)
ds_read_b128 a[8:11], v2 offset:2048
v_mul_f32 v19, v19, v21
v_mfma_f32_16x16x32_bf16 v[28:31], a[32:35], a[88:91], v[28:31]
ds_read_b128 a[12:15], v3 offset:2048
v_cvt_pk_bf16_f32 v18, v18, v19
v_mfma_f32_16x16x32_bf16 v[28:31], a[36:39], a[92:95], v[28:31]
ds_read_b128 a[16:19], v2 offset:4096
v_lshlrev_b32 v19, 16, v18
v_mfma_f32_16x16x32_bf16 v[44:47], a[44:47], a[92:95], v[44:47]
s_add_u32 m0, s76, 36864
ds_read_b128 a[20:23], v3 offset:4096
v_and_b32 v18, 0xffff0000, v18
v_mfma_f32_16x16x32_bf16 v[44:47], a[40:43], a[88:91], v[44:47]
s_add_u32 s64, s70, 33408
ds_read_b128 a[24:27], v2 offset:6144
v_add_f32 v17, v17, v19
v_mfma_f32_16x16x32_bf16 v[60:63], a[48:51], a[88:91], v[60:63]
buffer_load_dwordx4 v12, s[32:35], s64 offen lds
v_mfma_f32_16x16x32_bf16 v[60:63], a[52:55], a[92:95], v[60:63]
ds_read_b128 a[28:31], v3 offset:6144
v_add_f32 v17, v17, v18
v_mfma_f32_16x16x32_bf16 v[76:79], a[60:63], a[92:95], v[76:79]
ds_read_b64_tr_b16 a[80:81], v9 offset:16384
v_accvgpr_read_b32 v19, a150
v_mfma_f32_16x16x32_bf16 v[76:79], a[56:59], a[88:91], v[76:79]
ds_read_b64_tr_b16 a[82:83], v9 offset:17408
v_accvgpr_read_b32 v21, a166
v_mfma_f32_16x16x32_bf16 v[140:143], a[56:59], a[96:99], v[140:143]
ds_read_b64_tr_b16 a[84:85], v9 offset:24576
v_lshlrev_b32 v18, 16, v19
v_mfma_f32_16x16x32_bf16 v[140:143], a[60:63], a[100:103], v[140:143]
s_add_u32 m0, s76, 37888
ds_read_b64_tr_b16 a[86:87], v9 offset:25600
v_and_b32 v19, 0xffff0000, v19
v_mfma_f32_16x16x32_bf16 v[124:127], a[52:55], a[100:103], v[124:127]
s_add_u32 s64, s70, 41600
ds_read_b64_tr_b16 a[88:89], v10 offset:16384
v_lshlrev_b32 v20, 16, v21
v_mfma_f32_16x16x32_bf16 v[124:127], a[48:51], a[96:99], v[124:127]
buffer_load_dwordx4 v13, s[32:35], s64 offen lds
v_mfma_f32_16x16x32_bf16 v[108:111], a[40:43], a[96:99], v[108:111]
ds_read_b64_tr_b16 a[90:91], v10 offset:17408
v_and_b32 v21, 0xffff0000, v21
v_mfma_f32_16x16x32_bf16 v[108:111], a[44:47], a[100:103], v[108:111]
ds_read_b64_tr_b16 a[92:93], v10 offset:24576
v_mul_f32 v18, v18, v20
v_mfma_f32_16x16x32_bf16 v[92:95], a[36:39], a[100:103], v[92:95]
ds_read_b64_tr_b16 a[94:95], v10 offset:25600
v_mul_f32 v19, v19, v21
v_mfma_f32_16x16x32_bf16 v[92:95], a[32:35], a[96:99], v[92:95]
ds_read_b64_tr_b16 a[96:97], v11 offset:16384
v_cvt_pk_bf16_f32 v18, v18, v19
v_mfma_f32_16x16x32_bf16 v[32:35], a[32:35], a[104:107], v[32:35]
s_add_u32 m0, s76, 38912
ds_read_b64_tr_b16 a[98:99], v11 offset:17408
v_lshlrev_b32 v19, 16, v18
v_mfma_f32_16x16x32_bf16 v[32:35], a[36:39], a[108:111], v[32:35]
s_add_u32 s64, s70, 49792
ds_read_b64_tr_b16 a[100:101], v11 offset:24576
v_and_b32 v18, 0xffff0000, v18
v_mfma_f32_16x16x32_bf16 v[48:51], a[44:47], a[108:111], v[48:51]
buffer_load_dwordx4 v12, s[32:35], s64 offen lds
v_mfma_f32_16x16x32_bf16 v[48:51], a[40:43], a[104:107], v[48:51]
ds_read_b64_tr_b16 a[102:103], v11 offset:25600
v_add_f32 v17, v17, v19
v_mfma_f32_16x16x32_bf16 v[64:67], a[48:51], a[104:107], v[64:67]
v_add_f32 v17, v17, v18
v_accvgpr_read_b32 v19, a151
v_mfma_f32_16x16x32_bf16 v[64:67], a[52:55], a[108:111], v[64:67]
v_accvgpr_read_b32 v21, a167
v_lshlrev_b32 v18, 16, v19
v_mfma_f32_16x16x32_bf16 v[80:83], a[60:63], a[108:111], v[80:83]
s_add_u32 s82, s82, 1048576
v_and_b32 v19, 0xffff0000, v19
v_lshlrev_b32 v20, 16, v21
v_mfma_f32_16x16x32_bf16 v[80:83], a[56:59], a[104:107], v[80:83]
s_add_u32 m0, s76, 39936
v_and_b32 v21, 0xffff0000, v21
v_mul_f32 v18, v18, v20
v_mfma_f32_16x16x32_bf16 v[144:147], a[56:59], a[112:115], v[144:147]
s_add_u32 s64, s70, 57984
buffer_load_dword a252, v1, s[60:63], s82 offen
v_mfma_f32_16x16x32_bf16 v[144:147], a[60:63], a[116:119], v[144:147]
buffer_load_dwordx4 v13, s[32:35], s64 offen lds
v_mfma_f32_16x16x32_bf16 v[128:131], a[52:55], a[116:119], v[128:131]
v_mul_f32 v19, v19, v21
v_cvt_pk_bf16_f32 v18, v18, v19
v_mfma_f32_16x16x32_bf16 v[128:131], a[48:51], a[112:115], v[128:131]
v_lshlrev_b32 v19, 16, v18
v_and_b32 v18, 0xffff0000, v18
v_mfma_f32_16x16x32_bf16 v[112:115], a[40:43], a[112:115], v[112:115]
v_add_f32 v17, v17, v19
v_add_f32 v17, v17, v18
v_mfma_f32_16x16x32_bf16 v[112:115], a[44:47], a[116:119], v[112:115]
v_accvgpr_read_b32 v19, a152
v_accvgpr_read_b32 v21, a168
v_mfma_f32_16x16x32_bf16 v[96:99], a[36:39], a[116:119], v[96:99]
v_lshlrev_b32 v18, 16, v19
v_and_b32 v19, 0xffff0000, v19
v_mfma_f32_16x16x32_bf16 v[96:99], a[32:35], a[112:115], v[96:99]
s_waitcnt lgkmcnt(0)
v_lshlrev_b32 v20, 16, v21
v_and_b32 v21, 0xffff0000, v21
v_mfma_f32_16x16x32_bf16 v[36:39], a[32:35], a[72:75], v[36:39]
v_mul_f32 v18, v18, v20
v_mul_f32 v19, v19, v21
v_mfma_f32_16x16x32_bf16 v[36:39], a[36:39], a[76:79], v[36:39]
v_cvt_pk_bf16_f32 v18, v18, v19
v_lshlrev_b32 v19, 16, v18
v_mfma_f32_16x16x32_bf16 v[52:55], a[44:47], a[76:79], v[52:55]
s_waitcnt lgkmcnt(0)
s_barrier
v_mfma_f32_16x16x32_bf16 v[52:55], a[40:43], a[72:75], v[52:55]
s_add_u32 m0, s77, 65536
ds_read_b64_tr_b16 a[104:105], v4 offset:32768
v_and_b32 v18, 0xffff0000, v18
v_mfma_f32_16x16x32_bf16 v[68:71], a[48:51], a[72:75], v[68:71]
s_add_u32 s64, s71, 3145728
ds_read_b64_tr_b16 a[106:107], v4 offset:33792
v_add_f32 v17, v17, v19
v_mfma_f32_16x16x32_bf16 v[68:71], a[52:55], a[76:79], v[68:71]
buffer_load_dwordx4 v14, s[36:39], s64 offen lds
v_mfma_f32_16x16x32_bf16 v[84:87], a[60:63], a[76:79], v[84:87]
ds_read_b64_tr_b16 a[108:109], v4 offset:40960
v_add_f32 v17, v17, v18
v_mfma_f32_16x16x32_bf16 v[84:87], a[56:59], a[72:75], v[84:87]
ds_read_b64_tr_b16 a[110:111], v4 offset:41984
v_accvgpr_read_b32 v19, a153
v_mfma_f32_16x16x32_bf16 v[148:151], a[56:59], a[80:83], v[148:151]
ds_read_b64_tr_b16 a[112:113], v5 offset:32768
v_accvgpr_read_b32 v21, a169
v_mfma_f32_16x16x32_bf16 v[148:151], a[60:63], a[84:87], v[148:151]
ds_read_b64_tr_b16 a[114:115], v5 offset:33792
v_lshlrev_b32 v18, 16, v19
v_mfma_f32_16x16x32_bf16 v[132:135], a[52:55], a[84:87], v[132:135]
ds_read_b64_tr_b16 a[116:117], v5 offset:40960
v_and_b32 v19, 0xffff0000, v19
v_mfma_f32_16x16x32_bf16 v[132:135], a[48:51], a[80:83], v[132:135]
s_add_u32 m0, s77, 66560
ds_read_b64_tr_b16 a[118:119], v5 offset:41984
v_lshlrev_b32 v20, 16, v21
v_mfma_f32_16x16x32_bf16 v[116:119], a[40:43], a[80:83], v[116:119]
s_add_u32 s64, s71, 3178496
ds_read_b64_tr_b16 a[72:73], v6 offset:32768
v_and_b32 v21, 0xffff0000, v21
v_mfma_f32_16x16x32_bf16 v[116:119], a[44:47], a[84:87], v[116:119]
buffer_load_dwordx4 v14, s[36:39], s64 offen lds
v_mfma_f32_16x16x32_bf16 v[100:103], a[36:39], a[84:87], v[100:103]
ds_read_b64_tr_b16 a[74:75], v6 offset:33792
v_mul_f32 v18, v18, v20
v_mfma_f32_16x16x32_bf16 v[100:103], a[32:35], a[80:83], v[100:103]
ds_read_b64_tr_b16 a[76:77], v6 offset:40960
v_mul_f32 v19, v19, v21
v_mfma_f32_16x16x32_bf16 v[248:251], a[32:35], a[88:91], v[248:251]
ds_read_b64_tr_b16 a[78:79], v6 offset:41984
v_cvt_pk_bf16_f32 v18, v18, v19
v_mfma_f32_16x16x32_bf16 v[248:251], a[36:39], a[92:95], v[248:251]
ds_read_b64_tr_b16 a[80:81], v7 offset:32768
v_lshlrev_b32 v19, 16, v18
v_mfma_f32_16x16x32_bf16 v[252:255], a[44:47], a[92:95], v[252:255]
ds_read_b64_tr_b16 a[82:83], v7 offset:33792
v_and_b32 v18, 0xffff0000, v18
v_mfma_f32_16x16x32_bf16 v[252:255], a[40:43], a[88:91], v[252:255]
s_add_u32 m0, s77, 67584
ds_read_b64_tr_b16 a[84:85], v7 offset:40960
v_add_f32 v17, v17, v19
v_mfma_f32_16x16x32_bf16 a[120:123], a[48:51], a[88:91], a[120:123]
s_add_u32 s64, s71, 3211264
ds_read_b64_tr_b16 a[86:87], v7 offset:41984
v_add_f32 v17, v17, v18
v_mfma_f32_16x16x32_bf16 a[120:123], a[52:55], a[92:95], a[120:123]
buffer_load_dwordx4 v15, s[36:39], s64 offen lds
v_mfma_f32_16x16x32_bf16 a[124:127], a[60:63], a[92:95], a[124:127]
v_accvgpr_read_b32 v19, a154
v_accvgpr_read_b32 v21, a170
v_mfma_f32_16x16x32_bf16 a[124:127], a[56:59], a[88:91], a[124:127]
s_add_u32 s81, s81, 1048576
ds_read_b64_tr_b16 a[88:89], v8 offset:32768
v_lshlrev_b32 v18, 16, v19
v_mfma_f32_16x16x32_bf16 a[128:131], a[56:59], a[96:99], a[128:131]
buffer_load_dword a252, v16, s[56:59], s81 offen
v_mfma_f32_16x16x32_bf16 a[128:131], a[60:63], a[100:103], a[128:131]
ds_read_b64_tr_b16 a[90:91], v8 offset:33792
v_and_b32 v19, 0xffff0000, v19
v_mfma_f32_16x16x32_bf16 a[132:135], a[52:55], a[100:103], a[132:135]
ds_read_b64_tr_b16 a[92:93], v8 offset:40960
v_lshlrev_b32 v20, 16, v21
v_mfma_f32_16x16x32_bf16 a[132:135], a[48:51], a[96:99], a[132:135]
s_add_u32 m0, s77, 68608
ds_read_b64_tr_b16 a[94:95], v8 offset:41984
v_and_b32 v21, 0xffff0000, v21
v_mfma_f32_16x16x32_bf16 a[136:139], a[40:43], a[96:99], a[136:139]
s_add_u32 s64, s71, 3244032
v_mul_f32 v18, v18, v20
v_mul_f32 v19, v19, v21
v_mfma_f32_16x16x32_bf16 a[136:139], a[44:47], a[100:103], a[136:139]
buffer_load_dwordx4 v15, s[36:39], s64 offen lds
v_mfma_f32_16x16x32_bf16 a[140:143], a[36:39], a[100:103], a[140:143]
v_cvt_pk_bf16_f32 v18, v18, v19
v_lshlrev_b32 v19, 16, v18
v_mfma_f32_16x16x32_bf16 a[140:143], a[32:35], a[96:99], a[140:143]
s_waitcnt lgkmcnt(4)
ds_read_b64_tr_b16 a[96:97], v9 offset:32768
v_and_b32 v18, 0xffff0000, v18
v_mfma_f32_16x16x32_bf16 v[184:187], a[104:107], a[0:3], v[184:187]
ds_read_b64_tr_b16 a[98:99], v9 offset:33792
v_add_f32 v17, v17, v19
v_mfma_f32_16x16x32_bf16 v[184:187], a[108:111], a[4:7], v[184:187]
ds_read_b64_tr_b16 a[100:101], v9 offset:40960
v_add_f32 v17, v17, v18
v_mfma_f32_16x16x32_bf16 v[192:195], a[108:111], a[12:15], v[192:195]
s_add_u32 s17, s78, .-L_pc+6144
ds_read_b64_tr_b16 a[102:103], v9 offset:41984
v_accvgpr_read_b32 v19, a155
v_mfma_f32_16x16x32_bf16 v[192:195], a[104:107], a[8:11], v[192:195]
s_add_u32 m0, s77, 81920
v_accvgpr_read_b32 v21, a171
v_lshlrev_b32 v18, 16, v19
v_mfma_f32_16x16x32_bf16 v[200:203], a[104:107], a[16:19], v[200:203]
s_add_u32 s64, s71, 3145728
buffer_load_dword a252, v16, s[88:91], s17 offen
v_mfma_f32_16x16x32_bf16 v[200:203], a[108:111], a[20:23], v[200:203]
buffer_load_dwordx4 v14, s[40:43], s64 offen lds
v_mfma_f32_16x16x32_bf16 v[208:211], a[108:111], a[28:31], v[208:211]
v_and_b32 v19, 0xffff0000, v19
v_lshlrev_b32 v20, 16, v21
v_mfma_f32_16x16x32_bf16 v[208:211], a[104:107], a[24:27], v[208:211]
ds_read_b64_tr_b16 a[104:105], v10 offset:32768
v_and_b32 v21, 0xffff0000, v21
v_mfma_f32_16x16x32_bf16 v[212:215], a[112:115], a[24:27], v[212:215]
ds_read_b64_tr_b16 a[106:107], v10 offset:33792
v_mul_f32 v18, v18, v20
v_mfma_f32_16x16x32_bf16 v[212:215], a[116:119], a[28:31], v[212:215]
ds_read_b64_tr_b16 a[108:109], v10 offset:40960
v_mul_f32 v19, v19, v21
v_mfma_f32_16x16x32_bf16 v[204:207], a[116:119], a[20:23], v[204:207]
ds_read_b64_tr_b16 a[110:111], v10 offset:41984
v_cvt_pk_bf16_f32 v18, v18, v19
v_mfma_f32_16x16x32_bf16 v[204:207], a[112:115], a[16:19], v[204:207]
s_add_u32 m0, s77, 82944
v_lshlrev_b32 v19, 16, v18
v_and_b32 v18, 0xffff0000, v18
v_mfma_f32_16x16x32_bf16 v[196:199], a[112:115], a[8:11], v[196:199]
s_add_u32 s64, s71, 3178496
v_add_f32 v17, v17, v19
v_add_f32 v17, v17, v18
v_mfma_f32_16x16x32_bf16 v[196:199], a[116:119], a[12:15], v[196:199]
buffer_load_dwordx4 v14, s[40:43], s64 offen lds
v_mfma_f32_16x16x32_bf16 v[188:191], a[116:119], a[4:7], v[188:191]
v_accvgpr_read_b32 v19, a156
v_accvgpr_read_b32 v21, a172
v_mfma_f32_16x16x32_bf16 v[188:191], a[112:115], a[0:3], v[188:191]
ds_read_b64_tr_b16 a[112:113], v11 offset:32768
v_lshlrev_b32 v18, 16, v19
v_mfma_f32_16x16x32_bf16 v[216:219], a[72:75], a[0:3], v[216:219]
ds_read_b64_tr_b16 a[114:115], v11 offset:33792
v_and_b32 v19, 0xffff0000, v19
v_mfma_f32_16x16x32_bf16 v[216:219], a[76:79], a[4:7], v[216:219]
ds_read_b64_tr_b16 a[116:117], v11 offset:40960
v_lshlrev_b32 v20, 16, v21
v_mfma_f32_16x16x32_bf16 v[224:227], a[76:79], a[12:15], v[224:227]
ds_read_b64_tr_b16 a[118:119], v11 offset:41984
v_and_b32 v21, 0xffff0000, v21
v_mfma_f32_16x16x32_bf16 v[224:227], a[72:75], a[8:11], v[224:227]
s_add_u32 m0, s77, 83968
v_mul_f32 v18, v18, v20
v_mul_f32 v19, v19, v21
v_mfma_f32_16x16x32_bf16 v[232:235], a[72:75], a[16:19], v[232:235]
s_add_u32 s64, s71, 3211264
v_cvt_pk_bf16_f32 v18, v18, v19
v_lshlrev_b32 v19, 16, v18
v_mfma_f32_16x16x32_bf16 v[232:235], a[76:79], a[20:23], v[232:235]
buffer_load_dwordx4 v15, s[40:43], s64 offen lds
v_mfma_f32_16x16x32_bf16 v[240:243], a[76:79], a[28:31], v[240:243]
v_and_b32 v18, 0xffff0000, v18
v_add_f32 v17, v17, v19
v_mfma_f32_16x16x32_bf16 v[240:243], a[72:75], a[24:27], v[240:243]
s_add_u32 s82, s82, 1048576
ds_read_b64_tr_b16 a[72:73], v4 offset:49152
v_add_f32 v17, v17, v18
v_mfma_f32_16x16x32_bf16 v[244:247], a[80:83], a[24:27], v[244:247]
buffer_load_dword a252, v1, s[60:63], s82 offen
v_mfma_f32_16x16x32_bf16 v[244:247], a[84:87], a[28:31], v[244:247]
ds_read_b64_tr_b16 a[74:75], v4 offset:50176
v_accvgpr_read_b32 v19, a157
v_mfma_f32_16x16x32_bf16 v[236:239], a[84:87], a[20:23], v[236:239]
ds_read_b64_tr_b16 a[76:77], v4 offset:57344
v_accvgpr_read_b32 v21, a173
v_mfma_f32_16x16x32_bf16 v[236:239], a[80:83], a[16:19], v[236:239]
s_add_u32 m0, s77, 84992
ds_read_b64_tr_b16 a[78:79], v4 offset:58368
v_lshlrev_b32 v18, 16, v19
v_mfma_f32_16x16x32_bf16 v[228:231], a[80:83], a[8:11], v[228:231]
s_add_u32 s64, s71, 3244032
v_and_b32 v19, 0xffff0000, v19
v_lshlrev_b32 v20, 16, v21
v_mfma_f32_16x16x32_bf16 v[228:231], a[84:87], a[12:15], v[228:231]
buffer_load_dwordx4 v15, s[40:43], s64 offen lds
v_mfma_f32_16x16x32_bf16 v[220:223], a[84:87], a[4:7], v[220:223]
v_and_b32 v21, 0xffff0000, v21
v_mul_f32 v18, v18, v20
v_mfma_f32_16x16x32_bf16 v[220:223], a[80:83], a[0:3], v[220:223]
s_waitcnt lgkmcnt(4)
ds_read_b64_tr_b16 a[80:81], v5 offset:49152
v_mul_f32 v19, v19, v21
v_mfma_f32_16x16x32_bf16 v[152:155], a[88:91], a[0:3], v[152:155]
ds_read_b64_tr_b16 a[82:83], v5 offset:50176
v_cvt_pk_bf16_f32 v18, v18, v19
v_mfma_f32_16x16x32_bf16 v[152:155], a[92:95], a[4:7], v[152:155]
ds_read_b64_tr_b16 a[84:85], v5 offset:57344
v_lshlrev_b32 v19, 16, v18
v_mfma_f32_16x16x32_bf16 v[160:163], a[92:95], a[12:15], v[160:163]
ds_read_b64_tr_b16 a[86:87], v5 offset:58368
v_and_b32 v18, 0xffff0000, v18
v_mfma_f32_16x16x32_bf16 v[160:163], a[88:91], a[8:11], v[160:163]
v_add_f32 v17, v17, v19
v_add_f32 v17, v17, v18
v_mfma_f32_16x16x32_bf16 v[168:171], a[88:91], a[16:19], v[168:171]
v_accvgpr_read_b32 v19, a158
v_accvgpr_read_b32 v21, a174
v_mfma_f32_16x16x32_bf16 v[168:171], a[92:95], a[20:23], v[168:171]
v_lshlrev_b32 v18, 16, v19
v_and_b32 v19, 0xffff0000, v19
v_mfma_f32_16x16x32_bf16 v[176:179], a[92:95], a[28:31], v[176:179]
s_add_u32 m0, s76, 0
v_lshlrev_b32 v20, 16, v21
v_and_b32 v21, 0xffff0000, v21
v_mfma_f32_16x16x32_bf16 v[176:179], a[88:91], a[24:27], v[176:179]
s_add_u32 s64, s70, 768
ds_read_b64_tr_b16 a[88:89], v6 offset:49152
v_mul_f32 v18, v18, v20
v_mfma_f32_16x16x32_bf16 v[180:183], a[96:99], a[24:27], v[180:183]
buffer_load_dwordx4 v12, s[32:35], s64 offen lds
v_mfma_f32_16x16x32_bf16 v[180:183], a[100:103], a[28:31], v[180:183]
ds_read_b64_tr_b16 a[90:91], v6 offset:50176
v_mul_f32 v19, v19, v21
v_mfma_f32_16x16x32_bf16 v[172:175], a[100:103], a[20:23], v[172:175]
ds_read_b64_tr_b16 a[92:93], v6 offset:57344
v_cvt_pk_bf16_f32 v18, v18, v19
v_mfma_f32_16x16x32_bf16 v[172:175], a[96:99], a[16:19], v[172:175]
ds_read_b64_tr_b16 a[94:95], v6 offset:58368
v_lshlrev_b32 v19, 16, v18
v_mfma_f32_16x16x32_bf16 v[164:167], a[96:99], a[8:11], v[164:167]
v_and_b32 v18, 0xffff0000, v18
v_add_f32 v17, v17, v19
v_mfma_f32_16x16x32_bf16 v[164:167], a[100:103], a[12:15], v[164:167]
s_add_u32 m0, s76, 1024
v_add_f32 v17, v17, v18
v_accvgpr_read_b32 v19, a159
v_mfma_f32_16x16x32_bf16 v[156:159], a[100:103], a[4:7], v[156:159]
s_add_u32 s64, s70, 8960
v_accvgpr_read_b32 v21, a175
v_lshlrev_b32 v18, 16, v19
v_mfma_f32_16x16x32_bf16 v[156:159], a[96:99], a[0:3], v[156:159]
buffer_load_dwordx4 v13, s[32:35], s64 offen lds
v_mfma_f32_16x16x32_bf16 v[24:27], a[104:107], a[0:3], v[24:27]
ds_read_b64_tr_b16 a[96:97], v7 offset:49152
v_and_b32 v19, 0xffff0000, v19
v_mfma_f32_16x16x32_bf16 v[24:27], a[108:111], a[4:7], v[24:27]
ds_read_b64_tr_b16 a[98:99], v7 offset:50176
v_lshlrev_b32 v20, 16, v21
v_mfma_f32_16x16x32_bf16 v[40:43], a[108:111], a[12:15], v[40:43]
ds_read_b64_tr_b16 a[100:101], v7 offset:57344
v_and_b32 v21, 0xffff0000, v21
v_mfma_f32_16x16x32_bf16 v[40:43], a[104:107], a[8:11], v[40:43]
ds_read_b64_tr_b16 a[102:103], v7 offset:58368
v_mul_f32 v18, v18, v20
v_mfma_f32_16x16x32_bf16 v[56:59], a[104:107], a[16:19], v[56:59]
s_add_u32 m0, s76, 2048
v_mul_f32 v19, v19, v21
v_cvt_pk_bf16_f32 v18, v18, v19
v_mfma_f32_16x16x32_bf16 v[56:59], a[108:111], a[20:23], v[56:59]
s_add_u32 s64, s70, 17152
v_lshlrev_b32 v19, 16, v18
v_and_b32 v18, 0xffff0000, v18
v_mfma_f32_16x16x32_bf16 v[72:75], a[108:111], a[28:31], v[72:75]
s_waitcnt vmcnt(13)
buffer_load_dwordx4 v12, s[32:35], s64 offen lds
v_mfma_f32_16x16x32_bf16 v[72:75], a[104:107], a[24:27], v[72:75]
s_add_u32 s81, s81, 1048576
ds_read_b64_tr_b16 a[104:105], v8 offset:49152
v_add_f32 v17, v17, v19
v_mfma_f32_16x16x32_bf16 v[136:139], a[112:115], a[24:27], v[136:139]
buffer_load_dword a252, v16, s[56:59], s81 offen
v_mfma_f32_16x16x32_bf16 v[136:139], a[116:119], a[28:31], v[136:139]
ds_read_b64_tr_b16 a[106:107], v8 offset:50176
v_add_u32 v4, 0x8000, v4
v_mfma_f32_16x16x32_bf16 v[120:123], a[116:119], a[20:23], v[120:123]
ds_read_b64_tr_b16 a[108:109], v8 offset:57344
v_add_f32 v17, v17, v18
v_mfma_f32_16x16x32_bf16 v[120:123], a[112:115], a[16:19], v[120:123]
s_add_u32 m0, s76, 3072
ds_read_b64_tr_b16 a[110:111], v8 offset:58368
v_mfma_f32_16x16x32_bf16 v[104:107], a[112:115], a[8:11], v[104:107]
s_add_u32 s64, s70, 25344
ds_read_b128 a[32:35], v2 offset:32768
v_add_f32_dpp v17, v17, v17 row_ror:8 row_mask:0xf bank_mask:0xf
v_mfma_f32_16x16x32_bf16 v[104:107], a[116:119], a[12:15], v[104:107]
buffer_load_dwordx4 v13, s[32:35], s64 offen lds
v_mfma_f32_16x16x32_bf16 v[88:91], a[116:119], a[4:7], v[88:91]
ds_read_b128 a[36:39], v3 offset:32768
v_add_f32_dpp v17, v17, v17 row_ror:4 row_mask:0xf bank_mask:0xf
v_mfma_f32_16x16x32_bf16 v[88:91], a[112:115], a[0:3], v[88:91]
s_waitcnt lgkmcnt(6)
ds_read_b128 a[40:43], v2 offset:34816
v_mfma_f32_16x16x32_bf16 v[28:31], a[0:3], a[72:75], v[28:31]
ds_read_b128 a[44:47], v3 offset:34816
v_add_f32_dpp v17, v17, v17 row_ror:2 row_mask:0xf bank_mask:0xf
v_mfma_f32_16x16x32_bf16 v[28:31], a[4:7], a[76:79], v[28:31]
ds_read_b128 a[48:51], v2 offset:36864
v_add_u32 v5, 0x8000, v5
v_mfma_f32_16x16x32_bf16 v[44:47], a[12:15], a[76:79], v[44:47]
s_add_u32 m0, s76, 4096
ds_read_b128 a[52:55], v3 offset:36864
v_add_f32_dpp v17, v17, v17 row_ror:1 row_mask:0xf bank_mask:0xf
v_mfma_f32_16x16x32_bf16 v[44:47], a[8:11], a[72:75], v[44:47]
s_add_u32 s64, s70, 33536
ds_read_b128 a[56:59], v2 offset:38912
v_mov_b32 v18, v17
v_mfma_f32_16x16x32_bf16 v[60:63], a[16:19], a[72:75], v[60:63]
buffer_load_dwordx4 v12, s[32:35], s64 offen lds
v_mfma_f32_16x16x32_bf16 v[60:63], a[20:23], a[76:79], v[60:63]
ds_read_b128 a[60:63], v3 offset:38912
v_permlane16_swap_b32 v18, v17
v_mfma_f32_16x16x32_bf16 v[76:79], a[28:31], a[76:79], v[76:79]
ds_read_b64_tr_b16 a[112:113], v9 offset:49152
v_add_f32 v17, v17, v18
v_mfma_f32_16x16x32_bf16 v[76:79], a[24:27], a[72:75], v[76:79]
ds_read_b64_tr_b16 a[114:115], v9 offset:50176
v_cvt_pk_bf16_f32 v17, v17, v17
v_mfma_f32_16x16x32_bf16 v[140:143], a[24:27], a[80:83], v[140:143]
ds_read_b64_tr_b16 a[116:117], v9 offset:57344
v_and_b32 v17, 0xffff0000, v17
v_mfma_f32_16x16x32_bf16 v[140:143], a[28:31], a[84:87], v[140:143]
s_add_u32 m0, s76, 5120
ds_read_b64_tr_b16 a[118:119], v9 offset:58368
v_add_u32 v6, 0x8000, v6
v_mfma_f32_16x16x32_bf16 v[124:127], a[20:23], a[84:87], v[124:127]
s_add_u32 s64, s70, 41728
ds_read_b64_tr_b16 a[72:73], v10 offset:49152
v_mul_f32 v17, 0xbfb8aa3b, v17
v_mfma_f32_16x16x32_bf16 v[124:127], a[16:19], a[80:83], v[124:127]
buffer_load_dwordx4 v13, s[32:35], s64 offen lds
v_mfma_f32_16x16x32_bf16 v[108:111], a[8:11], a[80:83], v[108:111]
ds_read_b64_tr_b16 a[74:75], v10 offset:50176
v_mfma_f32_16x16x32_bf16 v[108:111], a[12:15], a[84:87], v[108:111]
ds_read_b64_tr_b16 a[76:77], v10 offset:57344
v_mfma_f32_16x16x32_bf16 v[92:95], a[4:7], a[84:87], v[92:95]
ds_read_b64_tr_b16 a[78:79], v10 offset:58368
v_mfma_f32_16x16x32_bf16 v[92:95], a[0:3], a[80:83], v[92:95]
ds_read_b64_tr_b16 a[80:81], v11 offset:49152
v_mfma_f32_16x16x32_bf16 v[32:35], a[0:3], a[88:91], v[32:35]
s_add_u32 m0, s76, 6144
ds_read_b64_tr_b16 a[82:83], v11 offset:50176
v_mfma_f32_16x16x32_bf16 v[32:35], a[4:7], a[92:95], v[32:35]
s_add_u32 s64, s70, 49920
ds_read_b64_tr_b16 a[84:85], v11 offset:57344
v_add_u32 v7, 0x8000, v7
v_mfma_f32_16x16x32_bf16 v[48:51], a[12:15], a[92:95], v[48:51]
buffer_load_dwordx4 v12, s[32:35], s64 offen lds
v_mfma_f32_16x16x32_bf16 v[48:51], a[8:11], a[88:91], v[48:51]
ds_read_b64_tr_b16 a[86:87], v11 offset:58368
v_mfma_f32_16x16x32_bf16 v[64:67], a[16:19], a[88:91], v[64:67]
v_exp_f32 v17, v17
v_mfma_f32_16x16x32_bf16 v[64:67], a[20:23], a[92:95], v[64:67]
v_add_f32 v17, 1.0, v17
v_mfma_f32_16x16x32_bf16 v[80:83], a[28:31], a[92:95], v[80:83]
v_rcp_f32 v17, v17
v_mfma_f32_16x16x32_bf16 v[80:83], a[24:27], a[88:91], v[80:83]
s_add_u32 m0, s76, 7168
s_add_u32 s81, s81, 1048576
v_cvt_pk_bf16_f32 v18, v17, v17
v_mfma_f32_16x16x32_bf16 v[144:147], a[24:27], a[96:99], v[144:147]
s_add_u32 s64, s70, 58112
buffer_load_dword a252, v16, s[56:59], s81 offen
v_mfma_f32_16x16x32_bf16 v[144:147], a[28:31], a[100:103], v[144:147]
buffer_load_dwordx4 v13, s[32:35], s64 offen lds
v_mfma_f32_16x16x32_bf16 v[128:131], a[20:23], a[100:103], v[128:131]
v_add_u32 v8, 0x8000, v8
v_and_b32 v18, 0xffff0000, v18
v_mfma_f32_16x16x32_bf16 v[128:131], a[16:19], a[96:99], v[128:131]
v_sub_f32 v19, 1.0, v18
v_mfma_f32_16x16x32_bf16 v[112:115], a[8:11], a[96:99], v[112:115]
v_cvt_pk_bf16_f32 v19, v19, v19
v_mfma_f32_16x16x32_bf16 v[112:115], a[12:15], a[100:103], v[112:115]
v_and_b32 v19, 0xffff0000, v19
v_mfma_f32_16x16x32_bf16 v[96:99], a[4:7], a[100:103], v[96:99]
v_add_u32 v9, 0x8000, v9
v_add_u32 v10, 0x8000, v10
v_mfma_f32_16x16x32_bf16 v[96:99], a[0:3], a[96:99], v[96:99]
s_waitcnt lgkmcnt(0)
v_add_u32 v11, 0x8000, v11
v_and_b32 v20, 31, v0
v_mfma_f32_16x16x32_bf16 v[36:39], a[0:3], a[104:107], v[36:39]
v_lshlrev_b32 v20, 27, v20
v_mfma_f32_16x16x32_bf16 v[36:39], a[4:7], a[108:111], v[36:39]
v_lshrrev_b32 v21, 2, v0
v_mfma_f32_16x16x32_bf16 v[52:55], a[12:15], a[108:111], v[52:55]
s_waitcnt lgkmcnt(0)
s_barrier
v_mfma_f32_16x16x32_bf16 v[52:55], a[8:11], a[104:107], v[52:55]
s_add_u32 m0, s77, 98304
ds_read_b64_tr_b16 a[88:89], v4 offset:32768
v_add_u32 v20, v20, v21
v_mfma_f32_16x16x32_bf16 v[68:71], a[16:19], a[104:107], v[68:71]
s_add_u32 s64, s71, 3670016
ds_read_b64_tr_b16 a[90:91], v4 offset:33792
v_mfma_f32_16x16x32_bf16 v[68:71], a[20:23], a[108:111], v[68:71]
buffer_load_dwordx4 v14, s[36:39], s64 offen lds
v_mfma_f32_16x16x32_bf16 v[84:87], a[28:31], a[108:111], v[84:87]
ds_read_b64_tr_b16 a[92:93], v4 offset:40960
v_mfma_f32_16x16x32_bf16 v[84:87], a[24:27], a[104:107], v[84:87]
ds_read_b64_tr_b16 a[94:95], v4 offset:41984
v_mfma_f32_16x16x32_bf16 v[148:151], a[24:27], a[112:115], v[148:151]
ds_read_b64_tr_b16 a[96:97], v5 offset:32768
v_mfma_f32_16x16x32_bf16 v[148:151], a[28:31], a[116:119], v[148:151]
ds_read_b64_tr_b16 a[98:99], v5 offset:33792
v_mfma_f32_16x16x32_bf16 v[132:135], a[20:23], a[116:119], v[132:135]
ds_read_b64_tr_b16 a[100:101], v5 offset:40960
v_mfma_f32_16x16x32_bf16 v[132:135], a[16:19], a[112:115], v[132:135]
s_add_u32 m0, s77, 99328
ds_read_b64_tr_b16 a[102:103], v5 offset:41984
v_mfma_f32_16x16x32_bf16 v[116:119], a[8:11], a[112:115], v[116:119]
s_add_u32 s64, s71, 3702784
ds_read_b64_tr_b16 a[104:105], v6 offset:32768
v_mfma_f32_16x16x32_bf16 v[116:119], a[12:15], a[116:119], v[116:119]
buffer_load_dwordx4 v14, s[36:39], s64 offen lds
v_mfma_f32_16x16x32_bf16 v[100:103], a[4:7], a[116:119], v[100:103]
ds_read_b64_tr_b16 a[106:107], v6 offset:33792
v_mfma_f32_16x16x32_bf16 v[100:103], a[0:3], a[112:115], v[100:103]
ds_read_b64_tr_b16 a[108:109], v6 offset:40960
v_mfma_f32_16x16x32_bf16 v[248:251], a[0:3], a[72:75], v[248:251]
ds_read_b64_tr_b16 a[110:111], v6 offset:41984
v_mfma_f32_16x16x32_bf16 v[248:251], a[4:7], a[76:79], v[248:251]
ds_read_b64_tr_b16 a[112:113], v7 offset:32768
v_mfma_f32_16x16x32_bf16 v[252:255], a[12:15], a[76:79], v[252:255]
ds_read_b64_tr_b16 a[114:115], v7 offset:33792
v_mfma_f32_16x16x32_bf16 v[252:255], a[8:11], a[72:75], v[252:255]
s_add_u32 m0, s77, 100352
ds_read_b64_tr_b16 a[116:117], v7 offset:40960
v_mfma_f32_16x16x32_bf16 a[120:123], a[16:19], a[72:75], a[120:123]
s_add_u32 s64, s71, 3735552
s_lshl2_add_u32 s65, s2, s30
ds_read_b64_tr_b16 a[118:119], v7 offset:41984
v_mfma_f32_16x16x32_bf16 a[120:123], a[20:23], a[76:79], a[120:123]
s_lshl4_add_u32 s65, s65, 58720256
buffer_load_dwordx4 v15, s[36:39], s64 offen lds
v_mfma_f32_16x16x32_bf16 a[124:127], a[28:31], a[76:79], a[124:127]
buffer_store_dwordx2 v[18:19], v20, s[44:47], s65 offen sc1
v_mfma_f32_16x16x32_bf16 a[124:127], a[24:27], a[72:75], a[124:127]
s_add_u32 s82, s82, 1048576
ds_read_b64_tr_b16 a[72:73], v8 offset:32768
v_lshrrev_b32 v21, 4, v0
v_mfma_f32_16x16x32_bf16 a[128:131], a[24:27], a[80:83], a[128:131]
buffer_load_dword a252, v1, s[60:63], s82 offen
v_mfma_f32_16x16x32_bf16 a[128:131], a[28:31], a[84:87], a[128:131]
ds_read_b64_tr_b16 a[74:75], v8 offset:33792
v_bfe_u32 v19, v0, 2, 2
v_mfma_f32_16x16x32_bf16 a[132:135], a[20:23], a[84:87], a[132:135]
ds_read_b64_tr_b16 a[76:77], v8 offset:40960
v_lshl_add_u32 v19, v21, 3, v19
v_mfma_f32_16x16x32_bf16 a[132:135], a[16:19], a[80:83], a[132:135]
s_add_u32 m0, s77, 101376
ds_read_b64_tr_b16 a[78:79], v8 offset:41984
v_lshlrev_b32 v19, 6, v19
v_mfma_f32_16x16x32_bf16 a[136:139], a[8:11], a[80:83], a[136:139]
s_add_u32 s64, s71, 3768320
v_and_b32 v21, 1, v21
v_mfma_f32_16x16x32_bf16 a[136:139], a[12:15], a[84:87], a[136:139]
buffer_load_dwordx4 v15, s[36:39], s64 offen lds
v_mfma_f32_16x16x32_bf16 a[140:143], a[4:7], a[84:87], a[140:143]
v_lshl_add_u32 v19, v21, 5, v19
v_mfma_f32_16x16x32_bf16 a[140:143], a[0:3], a[80:83], a[140:143]
s_waitcnt lgkmcnt(4)
ds_read_b64_tr_b16 a[80:81], v9 offset:32768
v_and_b32 v21, 3, v0
v_mfma_f32_16x16x32_bf16 v[184:187], a[88:91], a[32:35], v[184:187]
ds_read_b64_tr_b16 a[82:83], v9 offset:33792
v_lshl_add_u32 v19, v21, 3, v19
v_mfma_f32_16x16x32_bf16 v[184:187], a[92:95], a[36:39], v[184:187]
ds_read_b64_tr_b16 a[84:85], v9 offset:40960
v_add_u32 v19, 114688, v19
v_mfma_f32_16x16x32_bf16 v[192:195], a[92:95], a[44:47], v[192:195]
ds_read_b64_tr_b16 a[86:87], v9 offset:41984
v_xor_b32 v20, 32, v19
v_mfma_f32_16x16x32_bf16 v[192:195], a[88:91], a[40:43], v[192:195]
s_add_u32 m0, s77, 114688
v_mfma_f32_16x16x32_bf16 v[200:203], a[88:91], a[48:51], v[200:203]
s_add_u32 s64, s71, 3670016
v_mfma_f32_16x16x32_bf16 v[200:203], a[92:95], a[52:55], v[200:203]
buffer_load_dwordx4 v14, s[40:43], s64 offen lds
v_mfma_f32_16x16x32_bf16 v[208:211], a[92:95], a[60:63], v[208:211]
v_mfma_f32_16x16x32_bf16 v[208:211], a[88:91], a[56:59], v[208:211]
ds_read_b64_tr_b16 a[88:89], v10 offset:32768
v_mfma_f32_16x16x32_bf16 v[212:215], a[96:99], a[56:59], v[212:215]
ds_read_b64_tr_b16 a[90:91], v10 offset:33792
v_mfma_f32_16x16x32_bf16 v[212:215], a[100:103], a[60:63], v[212:215]
ds_read_b64_tr_b16 a[92:93], v10 offset:40960
v_mfma_f32_16x16x32_bf16 v[204:207], a[100:103], a[52:55], v[204:207]
ds_read_b64_tr_b16 a[94:95], v10 offset:41984
v_mfma_f32_16x16x32_bf16 v[204:207], a[96:99], a[48:51], v[204:207]
s_add_u32 m0, s77, 115712
v_mfma_f32_16x16x32_bf16 v[196:199], a[96:99], a[40:43], v[196:199]
s_add_u32 s64, s71, 3702784
v_mfma_f32_16x16x32_bf16 v[196:199], a[100:103], a[44:47], v[196:199]
buffer_load_dwordx4 v14, s[40:43], s64 offen lds
v_mfma_f32_16x16x32_bf16 v[188:191], a[100:103], a[36:39], v[188:191]
v_mfma_f32_16x16x32_bf16 v[188:191], a[96:99], a[32:35], v[188:191]
ds_read_b64_tr_b16 a[96:97], v11 offset:32768
v_mfma_f32_16x16x32_bf16 v[216:219], a[104:107], a[32:35], v[216:219]
ds_read_b64_tr_b16 a[98:99], v11 offset:33792
v_mfma_f32_16x16x32_bf16 v[216:219], a[108:111], a[36:39], v[216:219]
ds_read_b64_tr_b16 a[100:101], v11 offset:40960
v_mfma_f32_16x16x32_bf16 v[224:227], a[108:111], a[44:47], v[224:227]
ds_read_b64_tr_b16 a[102:103], v11 offset:41984
v_mfma_f32_16x16x32_bf16 v[224:227], a[104:107], a[40:43], v[224:227]
s_add_u32 m0, s77, 116736
v_mfma_f32_16x16x32_bf16 v[232:235], a[104:107], a[48:51], v[232:235]
s_add_u32 s64, s71, 3735552
v_mfma_f32_16x16x32_bf16 v[232:235], a[108:111], a[52:55], v[232:235]
buffer_load_dwordx4 v15, s[40:43], s64 offen lds
v_mfma_f32_16x16x32_bf16 v[240:243], a[108:111], a[60:63], v[240:243]
v_mfma_f32_16x16x32_bf16 v[240:243], a[104:107], a[56:59], v[240:243]
s_add_u32 s81, s81, 1048576
ds_read_b64_tr_b16 a[104:105], v4 offset:49152
v_mfma_f32_16x16x32_bf16 v[244:247], a[112:115], a[56:59], v[244:247]
buffer_load_dword a252, v16, s[56:59], s81 offen
v_mfma_f32_16x16x32_bf16 v[244:247], a[116:119], a[60:63], v[244:247]
ds_read_b64_tr_b16 a[106:107], v4 offset:50176
v_mfma_f32_16x16x32_bf16 v[236:239], a[116:119], a[52:55], v[236:239]
ds_read_b64_tr_b16 a[108:109], v4 offset:57344
v_mfma_f32_16x16x32_bf16 v[236:239], a[112:115], a[48:51], v[236:239]
s_add_u32 m0, s77, 117760
ds_read_b64_tr_b16 a[110:111], v4 offset:58368
v_mfma_f32_16x16x32_bf16 v[228:231], a[112:115], a[40:43], v[228:231]
s_add_u32 s64, s71, 3768320
v_mfma_f32_16x16x32_bf16 v[228:231], a[116:119], a[44:47], v[228:231]
buffer_load_dwordx4 v15, s[40:43], s64 offen lds
v_mfma_f32_16x16x32_bf16 v[220:223], a[116:119], a[36:39], v[220:223]
v_mfma_f32_16x16x32_bf16 v[220:223], a[112:115], a[32:35], v[220:223]
s_waitcnt lgkmcnt(4)
ds_read_b64_tr_b16 a[112:113], v5 offset:49152
v_mfma_f32_16x16x32_bf16 v[152:155], a[72:75], a[32:35], v[152:155]
ds_read_b64_tr_b16 a[114:115], v5 offset:50176
v_mfma_f32_16x16x32_bf16 v[152:155], a[76:79], a[36:39], v[152:155]
ds_read_b64_tr_b16 a[116:117], v5 offset:57344
v_mfma_f32_16x16x32_bf16 v[160:163], a[76:79], a[44:47], v[160:163]
ds_read_b64_tr_b16 a[118:119], v5 offset:58368
v_mfma_f32_16x16x32_bf16 v[160:163], a[72:75], a[40:43], v[160:163]
v_mfma_f32_16x16x32_bf16 v[168:171], a[72:75], a[48:51], v[168:171]
v_mfma_f32_16x16x32_bf16 v[168:171], a[76:79], a[52:55], v[168:171]
v_mfma_f32_16x16x32_bf16 v[176:179], a[76:79], a[60:63], v[176:179]
s_add_u32 m0, s76, 32768
v_mfma_f32_16x16x32_bf16 v[176:179], a[72:75], a[56:59], v[176:179]
s_add_u32 s64, s70, 896
ds_read_b64_tr_b16 a[72:73], v6 offset:49152
v_mfma_f32_16x16x32_bf16 v[180:183], a[80:83], a[56:59], v[180:183]
buffer_load_dwordx4 v12, s[32:35], s64 offen lds
v_mfma_f32_16x16x32_bf16 v[180:183], a[84:87], a[60:63], v[180:183]
ds_read_b64_tr_b16 a[74:75], v6 offset:50176
v_mfma_f32_16x16x32_bf16 v[172:175], a[84:87], a[52:55], v[172:175]
ds_read_b64_tr_b16 a[76:77], v6 offset:57344
v_mfma_f32_16x16x32_bf16 v[172:175], a[80:83], a[48:51], v[172:175]
ds_read_b64_tr_b16 a[78:79], v6 offset:58368
v_mfma_f32_16x16x32_bf16 v[164:167], a[80:83], a[40:43], v[164:167]
v_mfma_f32_16x16x32_bf16 v[164:167], a[84:87], a[44:47], v[164:167]
s_add_u32 m0, s76, 33792
v_mfma_f32_16x16x32_bf16 v[156:159], a[84:87], a[36:39], v[156:159]
s_add_u32 s64, s70, 9088
v_mfma_f32_16x16x32_bf16 v[156:159], a[80:83], a[32:35], v[156:159]
buffer_load_dwordx4 v13, s[32:35], s64 offen lds
v_mfma_f32_16x16x32_bf16 v[24:27], a[88:91], a[32:35], v[24:27]
ds_read_b64_tr_b16 a[80:81], v7 offset:49152
v_mfma_f32_16x16x32_bf16 v[24:27], a[92:95], a[36:39], v[24:27]
ds_read_b64_tr_b16 a[82:83], v7 offset:50176
v_mfma_f32_16x16x32_bf16 v[40:43], a[92:95], a[44:47], v[40:43]
ds_read_b64_tr_b16 a[84:85], v7 offset:57344
v_mfma_f32_16x16x32_bf16 v[40:43], a[88:91], a[40:43], v[40:43]
ds_read_b64_tr_b16 a[86:87], v7 offset:58368
v_mfma_f32_16x16x32_bf16 v[56:59], a[88:91], a[48:51], v[56:59]
s_add_u32 m0, s76, 34816
v_mfma_f32_16x16x32_bf16 v[56:59], a[92:95], a[52:55], v[56:59]
s_add_u32 s64, s70, 17280
v_mfma_f32_16x16x32_bf16 v[72:75], a[92:95], a[60:63], v[72:75]
s_waitcnt vmcnt(13)
buffer_load_dwordx4 v12, s[32:35], s64 offen lds
v_mfma_f32_16x16x32_bf16 v[72:75], a[88:91], a[56:59], v[72:75]
s_add_u32 s82, s82, 1048576
ds_read_b64_tr_b16 a[88:89], v8 offset:49152
v_mfma_f32_16x16x32_bf16 v[136:139], a[96:99], a[56:59], v[136:139]
buffer_load_dword a252, v1, s[60:63], s82 offen
v_mfma_f32_16x16x32_bf16 v[136:139], a[100:103], a[60:63], v[136:139]
ds_read_b64_tr_b16 a[90:91], v8 offset:50176
v_subrev_u32 v4, 0x8000, v4
v_mfma_f32_16x16x32_bf16 v[120:123], a[100:103], a[52:55], v[120:123]
ds_read_b64_tr_b16 a[92:93], v8 offset:57344
v_mfma_f32_16x16x32_bf16 v[120:123], a[96:99], a[48:51], v[120:123]
s_add_u32 m0, s76, 35840
ds_read_b64_tr_b16 a[94:95], v8 offset:58368
v_mfma_f32_16x16x32_bf16 v[104:107], a[96:99], a[40:43], v[104:107]
s_add_u32 s64, s70, 25472
ds_read_b128 a[0:3], v2 offset:0
v_mfma_f32_16x16x32_bf16 v[104:107], a[100:103], a[44:47], v[104:107]
buffer_load_dwordx4 v13, s[32:35], s64 offen lds
v_mfma_f32_16x16x32_bf16 v[88:91], a[100:103], a[36:39], v[88:91]
ds_read_b128 a[4:7], v3 offset:0
v_mfma_f32_16x16x32_bf16 v[88:91], a[96:99], a[32:35], v[88:91]
s_waitcnt lgkmcnt(6)
ds_read_b128 a[8:11], v2 offset:2048
v_mfma_f32_16x16x32_bf16 v[28:31], a[32:35], a[104:107], v[28:31]
ds_read_b128 a[12:15], v3 offset:2048
v_mfma_f32_16x16x32_bf16 v[28:31], a[36:39], a[108:111], v[28:31]
ds_read_b128 a[16:19], v2 offset:4096
v_subrev_u32 v5, 0x8000, v5
v_mfma_f32_16x16x32_bf16 v[44:47], a[44:47], a[108:111], v[44:47]
s_add_u32 m0, s76, 36864
ds_read_b128 a[20:23], v3 offset:4096
v_mfma_f32_16x16x32_bf16 v[44:47], a[40:43], a[104:107], v[44:47]
s_add_u32 s64, s70, 33664
ds_read_b128 a[24:27], v2 offset:6144
v_mfma_f32_16x16x32_bf16 v[60:63], a[48:51], a[104:107], v[60:63]
buffer_load_dwordx4 v12, s[32:35], s64 offen lds
v_mfma_f32_16x16x32_bf16 v[60:63], a[52:55], a[108:111], v[60:63]
ds_read_b128 a[28:31], v3 offset:6144
v_mfma_f32_16x16x32_bf16 v[76:79], a[60:63], a[108:111], v[76:79]
ds_read_b64_tr_b16 a[96:97], v9 offset:49152
v_mfma_f32_16x16x32_bf16 v[76:79], a[56:59], a[104:107], v[76:79]
ds_read_b64_tr_b16 a[98:99], v9 offset:50176
v_mfma_f32_16x16x32_bf16 v[140:143], a[56:59], a[112:115], v[140:143]
ds_read_b64_tr_b16 a[100:101], v9 offset:57344
v_mfma_f32_16x16x32_bf16 v[140:143], a[60:63], a[116:119], v[140:143]
s_add_u32 m0, s76, 37888
ds_read_b64_tr_b16 a[102:103], v9 offset:58368
v_subrev_u32 v6, 0x8000, v6
v_mfma_f32_16x16x32_bf16 v[124:127], a[52:55], a[116:119], v[124:127]
s_add_u32 s64, s70, 41856
ds_read_b64_tr_b16 a[104:105], v10 offset:49152
v_mfma_f32_16x16x32_bf16 v[124:127], a[48:51], a[112:115], v[124:127]
buffer_load_dwordx4 v13, s[32:35], s64 offen lds
v_mfma_f32_16x16x32_bf16 v[108:111], a[40:43], a[112:115], v[108:111]
ds_read_b64_tr_b16 a[106:107], v10 offset:50176
v_mfma_f32_16x16x32_bf16 v[108:111], a[44:47], a[116:119], v[108:111]
ds_read_b64_tr_b16 a[108:109], v10 offset:57344
v_mfma_f32_16x16x32_bf16 v[92:95], a[36:39], a[116:119], v[92:95]
ds_read_b64_tr_b16 a[110:111], v10 offset:58368
v_mfma_f32_16x16x32_bf16 v[92:95], a[32:35], a[112:115], v[92:95]
ds_read_b64_tr_b16 a[112:113], v11 offset:49152
v_mfma_f32_16x16x32_bf16 v[32:35], a[32:35], a[72:75], v[32:35]
s_add_u32 m0, s76, 38912
ds_read_b64_tr_b16 a[114:115], v11 offset:50176
v_mfma_f32_16x16x32_bf16 v[32:35], a[36:39], a[76:79], v[32:35]
s_add_u32 s64, s70, 50048
ds_read_b64_tr_b16 a[116:117], v11 offset:57344
v_subrev_u32 v7, 0x8000, v7
v_mfma_f32_16x16x32_bf16 v[48:51], a[44:47], a[76:79], v[48:51]
buffer_load_dwordx4 v12, s[32:35], s64 offen lds
v_mfma_f32_16x16x32_bf16 v[48:51], a[40:43], a[72:75], v[48:51]
ds_read_b64_tr_b16 a[118:119], v11 offset:58368
v_mfma_f32_16x16x32_bf16 v[64:67], a[48:51], a[72:75], v[64:67]
v_mfma_f32_16x16x32_bf16 v[64:67], a[52:55], a[76:79], v[64:67]
v_mfma_f32_16x16x32_bf16 v[80:83], a[60:63], a[76:79], v[80:83]
v_mfma_f32_16x16x32_bf16 v[80:83], a[56:59], a[72:75], v[80:83]
s_add_u32 m0, s76, 39936
v_mfma_f32_16x16x32_bf16 v[144:147], a[56:59], a[80:83], v[144:147]
s_add_u32 s64, s70, 58240
v_mfma_f32_16x16x32_bf16 v[144:147], a[60:63], a[84:87], v[144:147]
buffer_load_dwordx4 v13, s[32:35], s64 offen lds
v_mfma_f32_16x16x32_bf16 v[128:131], a[52:55], a[84:87], v[128:131]
v_subrev_u32 v8, 0x8000, v8
v_mfma_f32_16x16x32_bf16 v[128:131], a[48:51], a[80:83], v[128:131]
v_mfma_f32_16x16x32_bf16 v[112:115], a[40:43], a[80:83], v[112:115]
v_mfma_f32_16x16x32_bf16 v[112:115], a[44:47], a[84:87], v[112:115]
v_mfma_f32_16x16x32_bf16 v[96:99], a[36:39], a[84:87], v[96:99]
v_subrev_u32 v9, 0x8000, v9
v_subrev_u32 v10, 0x8000, v10
v_mfma_f32_16x16x32_bf16 v[96:99], a[32:35], a[80:83], v[96:99]
s_waitcnt lgkmcnt(0)
v_subrev_u32 v11, 0x8000, v11
v_mfma_f32_16x16x32_bf16 v[36:39], a[32:35], a[88:91], v[36:39]
v_mfma_f32_16x16x32_bf16 v[36:39], a[36:39], a[92:95], v[36:39]
v_mfma_f32_16x16x32_bf16 v[52:55], a[44:47], a[92:95], v[52:55]
s_waitcnt lgkmcnt(0)
s_barrier
v_mfma_f32_16x16x32_bf16 v[52:55], a[40:43], a[88:91], v[52:55]
s_add_u32 m0, s77, 131072
ds_read_b64_tr_b16 a[72:73], v4 offset:0
v_mfma_f32_16x16x32_bf16 v[68:71], a[48:51], a[88:91], v[68:71]
s_add_u32 s64, s71, 0
ds_read_b64_tr_b16 a[74:75], v4 offset:1024
v_mfma_f32_16x16x32_bf16 v[68:71], a[52:55], a[92:95], v[68:71]
buffer_load_dwordx4 v14, s[56:59], s64 offen lds
v_mfma_f32_16x16x32_bf16 v[84:87], a[60:63], a[92:95], v[84:87]
ds_read_b64_tr_b16 a[76:77], v4 offset:8192
v_mfma_f32_16x16x32_bf16 v[84:87], a[56:59], a[88:91], v[84:87]
ds_read_b64_tr_b16 a[78:79], v4 offset:9216
v_mfma_f32_16x16x32_bf16 v[148:151], a[56:59], a[96:99], v[148:151]
ds_read_b64_tr_b16 a[80:81], v5 offset:0
v_lshrrev_b32 v13, 3, v0
v_mfma_f32_16x16x32_bf16 v[148:151], a[60:63], a[100:103], v[148:151]
ds_read_b64_tr_b16 a[82:83], v5 offset:1024
v_lshl_add_u32 v12, v13, 10, v12
v_mfma_f32_16x16x32_bf16 v[132:135], a[52:55], a[100:103], v[132:135]
ds_read_b64_tr_b16 a[84:85], v5 offset:8192
v_xor_b32 v13, 64, v12
v_mfma_f32_16x16x32_bf16 v[132:135], a[48:51], a[96:99], v[132:135]
ds_read_b64_tr_b16 a[86:87], v5 offset:9216
v_mfma_f32_16x16x32_bf16 v[116:119], a[40:43], a[96:99], v[116:119]
s_add_u32 m0, s78, 147456
ds_read_b64_tr_b16 a[88:89], v6 offset:0
v_mfma_f32_16x16x32_bf16 v[116:119], a[44:47], a[100:103], v[116:119]
s_add_u32 s64, s75, 0
ds_read_b64_tr_b16 a[90:91], v6 offset:1024
v_mfma_f32_16x16x32_bf16 v[100:103], a[36:39], a[100:103], v[100:103]
buffer_load_dwordx4 v23, s[60:63], s64 offen lds
v_mfma_f32_16x16x32_bf16 v[100:103], a[32:35], a[96:99], v[100:103]
ds_read_b64_tr_b16 a[92:93], v6 offset:8192
v_mfma_f32_16x16x32_bf16 v[248:251], a[32:35], a[104:107], v[248:251]
ds_read_b64_tr_b16 a[94:95], v6 offset:9216
v_mfma_f32_16x16x32_bf16 v[248:251], a[36:39], a[108:111], v[248:251]
ds_read_b64_tr_b16 a[96:97], v7 offset:0
v_mfma_f32_16x16x32_bf16 v[252:255], a[44:47], a[108:111], v[252:255]
ds_read_b64_tr_b16 a[98:99], v7 offset:1024
v_mfma_f32_16x16x32_bf16 v[252:255], a[40:43], a[104:107], v[252:255]
ds_read_b64_tr_b16 a[100:101], v7 offset:8192
v_mfma_f32_16x16x32_bf16 a[120:123], a[48:51], a[104:107], a[120:123]
ds_read_b64_tr_b16 a[102:103], v7 offset:9216
v_mfma_f32_16x16x32_bf16 a[120:123], a[52:55], a[108:111], a[120:123]
s_add_u32 m0, s77, 132096
v_mfma_f32_16x16x32_bf16 a[124:127], a[60:63], a[108:111], a[124:127]
s_add_u32 s64, s71, 32768
v_mfma_f32_16x16x32_bf16 a[124:127], a[56:59], a[104:107], a[124:127]
buffer_load_dwordx4 v14, s[56:59], s64 offen lds
v_mfma_f32_16x16x32_bf16 a[128:131], a[56:59], a[112:115], a[128:131]
ds_read_b64_tr_b16 a[104:105], v8 offset:0
v_mfma_f32_16x16x32_bf16 a[128:131], a[60:63], a[116:119], a[128:131]
ds_read_b64_tr_b16 a[106:107], v8 offset:1024
v_mfma_f32_16x16x32_bf16 a[132:135], a[52:55], a[116:119], a[132:135]
ds_read_b64_tr_b16 a[108:109], v8 offset:8192
v_mfma_f32_16x16x32_bf16 a[132:135], a[48:51], a[112:115], a[132:135]
ds_read_b64_tr_b16 a[110:111], v8 offset:9216
v_mfma_f32_16x16x32_bf16 a[136:139], a[40:43], a[112:115], a[136:139]
v_mfma_f32_16x16x32_bf16 a[136:139], a[44:47], a[116:119], a[136:139]
v_mfma_f32_16x16x32_bf16 a[140:143], a[36:39], a[116:119], a[140:143]
s_add_u32 m0, s78, 151552
v_mfma_f32_16x16x32_bf16 a[140:143], a[32:35], a[112:115], a[140:143]
s_waitcnt lgkmcnt(4)
s_add_u32 s64, s75, 2048
ds_read_b64_tr_b16 a[112:113], v9 offset:0
v_mfma_f32_16x16x32_bf16 v[184:187], a[72:75], a[0:3], v[184:187]
buffer_load_dwordx4 v23, s[60:63], s64 offen lds
v_mfma_f32_16x16x32_bf16 v[184:187], a[76:79], a[4:7], v[184:187]
ds_read_b64_tr_b16 a[114:115], v9 offset:1024
v_mfma_f32_16x16x32_bf16 v[192:195], a[76:79], a[12:15], v[192:195]
ds_read_b64_tr_b16 a[116:117], v9 offset:8192
v_mfma_f32_16x16x32_bf16 v[192:195], a[72:75], a[8:11], v[192:195]
s_add_u32 s17, s78, .-L_pc+6144
ds_read_b64_tr_b16 a[118:119], v9 offset:9216
v_mfma_f32_16x16x32_bf16 v[200:203], a[72:75], a[16:19], v[200:203]
buffer_load_dword a252, v16, s[88:91], s17 offen
v_mfma_f32_16x16x32_bf16 v[200:203], a[76:79], a[20:23], v[200:203]
v_mfma_f32_16x16x32_bf16 v[208:211], a[76:79], a[28:31], v[208:211]
v_mfma_f32_16x16x32_bf16 v[208:211], a[72:75], a[24:27], v[208:211]
ds_read_b64_tr_b16 a[72:73], v10 offset:0
v_mfma_f32_16x16x32_bf16 v[212:215], a[80:83], a[24:27], v[212:215]
s_add_u32 m0, s77, 133120
ds_read_b64_tr_b16 a[74:75], v10 offset:1024
v_mfma_f32_16x16x32_bf16 v[212:215], a[84:87], a[28:31], v[212:215]
s_add_u32 s64, s71, 65536
ds_read_b64_tr_b16 a[76:77], v10 offset:8192
v_mfma_f32_16x16x32_bf16 v[204:207], a[84:87], a[20:23], v[204:207]
buffer_load_dwordx4 v15, s[56:59], s64 offen lds
v_mfma_f32_16x16x32_bf16 v[204:207], a[80:83], a[16:19], v[204:207]
ds_read_b64_tr_b16 a[78:79], v10 offset:9216
v_mfma_f32_16x16x32_bf16 v[196:199], a[80:83], a[8:11], v[196:199]
v_mfma_f32_16x16x32_bf16 v[196:199], a[84:87], a[12:15], v[196:199]
v_mfma_f32_16x16x32_bf16 v[188:191], a[84:87], a[4:7], v[188:191]
v_mfma_f32_16x16x32_bf16 v[188:191], a[80:83], a[0:3], v[188:191]
ds_read_b64_tr_b16 a[80:81], v11 offset:0
v_mfma_f32_16x16x32_bf16 v[216:219], a[88:91], a[0:3], v[216:219]
ds_read_b64_tr_b16 a[82:83], v11 offset:1024
v_mfma_f32_16x16x32_bf16 v[216:219], a[92:95], a[4:7], v[216:219]
s_add_u32 m0, s78, 155648
ds_read_b64_tr_b16 a[84:85], v11 offset:8192
v_mfma_f32_16x16x32_bf16 v[224:227], a[92:95], a[12:15], v[224:227]
s_add_u32 s64, s75, 4096
ds_read_b64_tr_b16 a[86:87], v11 offset:9216
v_mfma_f32_16x16x32_bf16 v[224:227], a[88:91], a[8:11], v[224:227]
buffer_load_dwordx4 v23, s[60:63], s64 offen lds
v_mfma_f32_16x16x32_bf16 v[232:235], a[88:91], a[16:19], v[232:235]
v_mfma_f32_16x16x32_bf16 v[232:235], a[92:95], a[20:23], v[232:235]
v_mfma_f32_16x16x32_bf16 v[240:243], a[92:95], a[28:31], v[240:243]
v_mfma_f32_16x16x32_bf16 v[240:243], a[88:91], a[24:27], v[240:243]
ds_read_b64_tr_b16 a[88:89], v4 offset:16384
v_mfma_f32_16x16x32_bf16 v[244:247], a[96:99], a[24:27], v[244:247]
ds_read_b64_tr_b16 a[90:91], v4 offset:17408
v_mfma_f32_16x16x32_bf16 v[244:247], a[100:103], a[28:31], v[244:247]
ds_read_b64_tr_b16 a[92:93], v4 offset:24576
v_mfma_f32_16x16x32_bf16 v[236:239], a[100:103], a[20:23], v[236:239]
s_add_u32 m0, s77, 134144
ds_read_b64_tr_b16 a[94:95], v4 offset:25600
v_mfma_f32_16x16x32_bf16 v[236:239], a[96:99], a[16:19], v[236:239]
s_add_u32 s64, s71, 98304
v_mfma_f32_16x16x32_bf16 v[228:231], a[96:99], a[8:11], v[228:231]
buffer_load_dwordx4 v15, s[56:59], s64 offen lds
v_mfma_f32_16x16x32_bf16 v[228:231], a[100:103], a[12:15], v[228:231]
v_mfma_f32_16x16x32_bf16 v[220:223], a[100:103], a[4:7], v[220:223]
v_mfma_f32_16x16x32_bf16 v[220:223], a[96:99], a[0:3], v[220:223]
s_waitcnt lgkmcnt(4)
ds_read_b64_tr_b16 a[96:97], v5 offset:16384
v_mfma_f32_16x16x32_bf16 v[152:155], a[104:107], a[0:3], v[152:155]
ds_read_b64_tr_b16 a[98:99], v5 offset:17408
v_mfma_f32_16x16x32_bf16 v[152:155], a[108:111], a[4:7], v[152:155]
ds_read_b64_tr_b16 a[100:101], v5 offset:24576
v_mfma_f32_16x16x32_bf16 v[160:163], a[108:111], a[12:15], v[160:163]
ds_read_b64_tr_b16 a[102:103], v5 offset:25600
v_mfma_f32_16x16x32_bf16 v[160:163], a[104:107], a[8:11], v[160:163]
v_mfma_f32_16x16x32_bf16 v[168:171], a[104:107], a[16:19], v[168:171]
v_mfma_f32_16x16x32_bf16 v[168:171], a[108:111], a[20:23], v[168:171]
v_mfma_f32_16x16x32_bf16 v[176:179], a[108:111], a[28:31], v[176:179]
s_add_u32 m0, s76, 0
v_mfma_f32_16x16x32_bf16 v[176:179], a[104:107], a[24:27], v[176:179]
s_add_u32 s64, s72, 0
ds_read_b64_tr_b16 a[104:105], v6 offset:16384
v_mfma_f32_16x16x32_bf16 v[180:183], a[112:115], a[24:27], v[180:183]
buffer_load_dwordx4 v12, s[48:51], s64 offen lds
v_mfma_f32_16x16x32_bf16 v[180:183], a[116:119], a[28:31], v[180:183]
ds_read_b64_tr_b16 a[106:107], v6 offset:17408
v_mfma_f32_16x16x32_bf16 v[172:175], a[116:119], a[20:23], v[172:175]
ds_read_b64_tr_b16 a[108:109], v6 offset:24576
v_mfma_f32_16x16x32_bf16 v[172:175], a[112:115], a[16:19], v[172:175]
ds_read_b64_tr_b16 a[110:111], v6 offset:25600
v_mfma_f32_16x16x32_bf16 v[164:167], a[112:115], a[8:11], v[164:167]
v_mfma_f32_16x16x32_bf16 v[164:167], a[116:119], a[12:15], v[164:167]
s_add_u32 m0, s76, 1024
v_mfma_f32_16x16x32_bf16 v[156:159], a[116:119], a[4:7], v[156:159]
s_add_u32 s64, s72, 16384
v_mfma_f32_16x16x32_bf16 v[156:159], a[112:115], a[0:3], v[156:159]
buffer_load_dwordx4 v13, s[48:51], s64 offen lds
v_mfma_f32_16x16x32_bf16 v[24:27], a[72:75], a[0:3], v[24:27]
ds_read_b64_tr_b16 a[112:113], v7 offset:16384
v_mfma_f32_16x16x32_bf16 v[24:27], a[76:79], a[4:7], v[24:27]
ds_read_b64_tr_b16 a[114:115], v7 offset:17408
v_mfma_f32_16x16x32_bf16 v[40:43], a[76:79], a[12:15], v[40:43]
ds_read_b64_tr_b16 a[116:117], v7 offset:24576
v_mfma_f32_16x16x32_bf16 v[40:43], a[72:75], a[8:11], v[40:43]
ds_read_b64_tr_b16 a[118:119], v7 offset:25600
v_mfma_f32_16x16x32_bf16 v[56:59], a[72:75], a[16:19], v[56:59]
s_add_u32 m0, s76, 2048
v_mfma_f32_16x16x32_bf16 v[56:59], a[76:79], a[20:23], v[56:59]
s_add_u32 s64, s72, 131072
v_mfma_f32_16x16x32_bf16 v[72:75], a[76:79], a[28:31], v[72:75]
s_waitcnt vmcnt(10)
buffer_load_dwordx4 v12, s[48:51], s64 offen lds
v_mfma_f32_16x16x32_bf16 v[72:75], a[72:75], a[24:27], v[72:75]
ds_read_b64_tr_b16 a[72:73], v8 offset:16384
v_mfma_f32_16x16x32_bf16 v[136:139], a[80:83], a[24:27], v[136:139]
ds_read_b64_tr_b16 a[74:75], v8 offset:17408
v_mfma_f32_16x16x32_bf16 v[136:139], a[84:87], a[28:31], v[136:139]
ds_read_b64_tr_b16 a[76:77], v8 offset:24576
v_mfma_f32_16x16x32_bf16 v[120:123], a[84:87], a[20:23], v[120:123]
ds_read_b64_tr_b16 a[78:79], v8 offset:25600
v_mfma_f32_16x16x32_bf16 v[120:123], a[80:83], a[16:19], v[120:123]
s_add_u32 m0, s76, 3072
ds_read_b128 a[32:35], v2 offset:32768
v_mfma_f32_16x16x32_bf16 v[104:107], a[80:83], a[8:11], v[104:107]
s_add_u32 s64, s72, 147456
ds_read_b128 a[36:39], v3 offset:32768
v_mfma_f32_16x16x32_bf16 v[104:107], a[84:87], a[12:15], v[104:107]
buffer_load_dwordx4 v13, s[48:51], s64 offen lds
v_mfma_f32_16x16x32_bf16 v[88:91], a[84:87], a[4:7], v[88:91]
ds_read_b128 a[40:43], v2 offset:34816
v_mfma_f32_16x16x32_bf16 v[88:91], a[80:83], a[0:3], v[88:91]
s_waitcnt lgkmcnt(7)
ds_read_b128 a[44:47], v3 offset:34816
v_mfma_f32_16x16x32_bf16 v[28:31], a[0:3], a[88:91], v[28:31]
ds_read_b128 a[48:51], v2 offset:36864
v_mfma_f32_16x16x32_bf16 v[28:31], a[4:7], a[92:95], v[28:31]
ds_read_b128 a[52:55], v3 offset:36864
v_mfma_f32_16x16x32_bf16 v[44:47], a[12:15], a[92:95], v[44:47]
s_add_u32 m0, s76, 4096
ds_read_b128 a[56:59], v2 offset:38912
v_mfma_f32_16x16x32_bf16 v[44:47], a[8:11], a[88:91], v[44:47]
s_add_u32 s64, s73, 0
ds_read_b128 a[60:63], v3 offset:38912
v_mfma_f32_16x16x32_bf16 v[60:63], a[16:19], a[88:91], v[60:63]
buffer_load_dwordx4 v12, s[48:51], s64 offen lds
v_mfma_f32_16x16x32_bf16 v[60:63], a[20:23], a[92:95], v[60:63]
ds_read_b64_tr_b16 a[80:81], v9 offset:16384
v_mfma_f32_16x16x32_bf16 v[76:79], a[28:31], a[92:95], v[76:79]
ds_read_b64_tr_b16 a[82:83], v9 offset:17408
v_mfma_f32_16x16x32_bf16 v[76:79], a[24:27], a[88:91], v[76:79]
ds_read_b64_tr_b16 a[84:85], v9 offset:24576
v_mfma_f32_16x16x32_bf16 v[140:143], a[24:27], a[96:99], v[140:143]
ds_read_b64_tr_b16 a[86:87], v9 offset:25600
v_mfma_f32_16x16x32_bf16 v[140:143], a[28:31], a[100:103], v[140:143]
s_add_u32 m0, s76, 5120
ds_read_b64_tr_b16 a[88:89], v10 offset:16384
v_mfma_f32_16x16x32_bf16 v[124:127], a[20:23], a[100:103], v[124:127]
s_add_u32 s64, s73, 16384
ds_read_b64_tr_b16 a[90:91], v10 offset:17408
v_mfma_f32_16x16x32_bf16 v[124:127], a[16:19], a[96:99], v[124:127]
buffer_load_dwordx4 v13, s[48:51], s64 offen lds
v_mfma_f32_16x16x32_bf16 v[108:111], a[8:11], a[96:99], v[108:111]
ds_read_b64_tr_b16 a[92:93], v10 offset:24576
v_mfma_f32_16x16x32_bf16 v[108:111], a[12:15], a[100:103], v[108:111]
ds_read_b64_tr_b16 a[94:95], v10 offset:25600
v_mfma_f32_16x16x32_bf16 v[92:95], a[4:7], a[100:103], v[92:95]
v_mfma_f32_16x16x32_bf16 v[92:95], a[0:3], a[96:99], v[92:95]
ds_read_b64_tr_b16 a[96:97], v11 offset:16384
v_mfma_f32_16x16x32_bf16 v[32:35], a[0:3], a[104:107], v[32:35]
s_add_u32 m0, s76, 6144
ds_read_b64_tr_b16 a[98:99], v11 offset:17408
v_mfma_f32_16x16x32_bf16 v[32:35], a[4:7], a[108:111], v[32:35]
s_add_u32 s64, s73, 131072
ds_read_b64_tr_b16 a[100:101], v11 offset:24576
v_mfma_f32_16x16x32_bf16 v[48:51], a[12:15], a[108:111], v[48:51]
buffer_load_dwordx4 v12, s[48:51], s64 offen lds
v_mfma_f32_16x16x32_bf16 v[48:51], a[8:11], a[104:107], v[48:51]
ds_read_b64_tr_b16 a[102:103], v11 offset:25600
v_mfma_f32_16x16x32_bf16 v[64:67], a[16:19], a[104:107], v[64:67]
v_mfma_f32_16x16x32_bf16 v[64:67], a[20:23], a[108:111], v[64:67]
v_mfma_f32_16x16x32_bf16 v[80:83], a[28:31], a[108:111], v[80:83]
v_mfma_f32_16x16x32_bf16 v[80:83], a[24:27], a[104:107], v[80:83]
s_add_u32 m0, s76, 7168
v_mfma_f32_16x16x32_bf16 v[144:147], a[24:27], a[112:115], v[144:147]
s_add_u32 s64, s73, 147456
v_mfma_f32_16x16x32_bf16 v[144:147], a[28:31], a[116:119], v[144:147]
buffer_load_dwordx4 v13, s[48:51], s64 offen lds
v_mfma_f32_16x16x32_bf16 v[128:131], a[20:23], a[116:119], v[128:131]
v_mfma_f32_16x16x32_bf16 v[128:131], a[16:19], a[112:115], v[128:131]
v_mfma_f32_16x16x32_bf16 v[112:115], a[8:11], a[112:115], v[112:115]
v_mfma_f32_16x16x32_bf16 v[112:115], a[12:15], a[116:119], v[112:115]
v_mfma_f32_16x16x32_bf16 v[96:99], a[4:7], a[116:119], v[96:99]
v_mfma_f32_16x16x32_bf16 v[96:99], a[0:3], a[112:115], v[96:99]
s_waitcnt lgkmcnt(0)
v_mfma_f32_16x16x32_bf16 v[36:39], a[0:3], a[72:75], v[36:39]
v_mfma_f32_16x16x32_bf16 v[36:39], a[4:7], a[76:79], v[36:39]
v_mfma_f32_16x16x32_bf16 v[52:55], a[12:15], a[76:79], v[52:55]
s_waitcnt lgkmcnt(0)
s_barrier
v_mfma_f32_16x16x32_bf16 v[52:55], a[8:11], a[72:75], v[52:55]
s_add_u32 m0, s77, 65536
ds_read_b64_tr_b16 a[104:105], v4 offset:32768
v_mfma_f32_16x16x32_bf16 v[68:71], a[16:19], a[72:75], v[68:71]
s_add_u32 s64, s71, 524288
ds_read_b64_tr_b16 a[106:107], v4 offset:33792
v_mfma_f32_16x16x32_bf16 v[68:71], a[20:23], a[76:79], v[68:71]
buffer_load_dwordx4 v14, s[56:59], s64 offen lds
v_mfma_f32_16x16x32_bf16 v[84:87], a[28:31], a[76:79], v[84:87]
ds_read_b64_tr_b16 a[108:109], v4 offset:40960
v_mfma_f32_16x16x32_bf16 v[84:87], a[24:27], a[72:75], v[84:87]
ds_read_b64_tr_b16 a[110:111], v4 offset:41984
v_mfma_f32_16x16x32_bf16 v[148:151], a[24:27], a[80:83], v[148:151]
ds_read_b64_tr_b16 a[112:113], v5 offset:32768
v_mfma_f32_16x16x32_bf16 v[148:151], a[28:31], a[84:87], v[148:151]
ds_read_b64_tr_b16 a[114:115], v5 offset:33792
v_mfma_f32_16x16x32_bf16 v[132:135], a[20:23], a[84:87], v[132:135]
ds_read_b64_tr_b16 a[116:117], v5 offset:40960
v_mfma_f32_16x16x32_bf16 v[132:135], a[16:19], a[80:83], v[132:135]
ds_read_b64_tr_b16 a[118:119], v5 offset:41984
v_mfma_f32_16x16x32_bf16 v[116:119], a[8:11], a[80:83], v[116:119]
s_add_u32 m0, s78, 81920
ds_read_b64_tr_b16 a[72:73], v6 offset:32768
v_mfma_f32_16x16x32_bf16 v[116:119], a[12:15], a[84:87], v[116:119]
s_add_u32 s64, s75, 393216
ds_read_b64_tr_b16 a[74:75], v6 offset:33792
v_mfma_f32_16x16x32_bf16 v[100:103], a[4:7], a[84:87], v[100:103]
buffer_load_dwordx4 v23, s[60:63], s64 offen lds
v_mfma_f32_16x16x32_bf16 v[100:103], a[0:3], a[80:83], v[100:103]
ds_read_b64_tr_b16 a[76:77], v6 offset:40960
v_mfma_f32_16x16x32_bf16 v[248:251], a[0:3], a[88:91], v[248:251]
ds_read_b64_tr_b16 a[78:79], v6 offset:41984
v_mfma_f32_16x16x32_bf16 v[248:251], a[4:7], a[92:95], v[248:251]
ds_read_b64_tr_b16 a[80:81], v7 offset:32768
v_mfma_f32_16x16x32_bf16 v[252:255], a[12:15], a[92:95], v[252:255]
ds_read_b64_tr_b16 a[82:83], v7 offset:33792
v_mfma_f32_16x16x32_bf16 v[252:255], a[8:11], a[88:91], v[252:255]
ds_read_b64_tr_b16 a[84:85], v7 offset:40960
v_mfma_f32_16x16x32_bf16 a[120:123], a[16:19], a[88:91], a[120:123]
ds_read_b64_tr_b16 a[86:87], v7 offset:41984
v_mfma_f32_16x16x32_bf16 a[120:123], a[20:23], a[92:95], a[120:123]
s_add_u32 m0, s77, 66560
v_mfma_f32_16x16x32_bf16 a[124:127], a[28:31], a[92:95], a[124:127]
s_add_u32 s64, s71, 557056
v_mfma_f32_16x16x32_bf16 a[124:127], a[24:27], a[88:91], a[124:127]
buffer_load_dwordx4 v14, s[56:59], s64 offen lds
v_mfma_f32_16x16x32_bf16 a[128:131], a[24:27], a[96:99], a[128:131]
ds_read_b64_tr_b16 a[88:89], v8 offset:32768
v_mfma_f32_16x16x32_bf16 a[128:131], a[28:31], a[100:103], a[128:131]
ds_read_b64_tr_b16 a[90:91], v8 offset:33792
v_mfma_f32_16x16x32_bf16 a[132:135], a[20:23], a[100:103], a[132:135]
ds_read_b64_tr_b16 a[92:93], v8 offset:40960
v_mfma_f32_16x16x32_bf16 a[132:135], a[16:19], a[96:99], a[132:135]
ds_read_b64_tr_b16 a[94:95], v8 offset:41984
v_mfma_f32_16x16x32_bf16 a[136:139], a[8:11], a[96:99], a[136:139]
v_mfma_f32_16x16x32_bf16 a[136:139], a[12:15], a[100:103], a[136:139]
v_mfma_f32_16x16x32_bf16 a[140:143], a[4:7], a[100:103], a[140:143]
s_add_u32 m0, s78, 86016
v_mfma_f32_16x16x32_bf16 a[140:143], a[0:3], a[96:99], a[140:143]
s_waitcnt lgkmcnt(4)
s_add_u32 s64, s75, 395264
ds_read_b64_tr_b16 a[96:97], v9 offset:32768
v_mfma_f32_16x16x32_bf16 v[184:187], a[104:107], a[32:35], v[184:187]
s_lshl_b32 s66, s30, 30
buffer_load_dwordx4 v23, s[60:63], s64 offen lds
v_mfma_f32_16x16x32_bf16 v[184:187], a[108:111], a[36:39], v[184:187]
ds_read_b64_tr_b16 a[98:99], v9 offset:33792
v_lshl_add_u32 v1, v0, 24, s66
v_mfma_f32_16x16x32_bf16 v[192:195], a[108:111], a[44:47], v[192:195]
s_lshr_b32 s66, s3, 1
ds_read_b64_tr_b16 a[100:101], v9 offset:40960
v_mfma_f32_16x16x32_bf16 v[192:195], a[104:107], a[40:43], v[192:195]
s_lshl_b32 s66, s66, 12
ds_read_b64_tr_b16 a[102:103], v9 offset:41984
v_mfma_f32_16x16x32_bf16 v[200:203], a[104:107], a[48:51], v[200:203]
v_mfma_f32_16x16x32_bf16 v[200:203], a[108:111], a[52:55], v[200:203]
v_mfma_f32_16x16x32_bf16 v[208:211], a[108:111], a[60:63], v[208:211]
v_mfma_f32_16x16x32_bf16 v[208:211], a[104:107], a[56:59], v[208:211]
ds_read_b64_tr_b16 a[104:105], v10 offset:32768
v_mfma_f32_16x16x32_bf16 v[212:215], a[112:115], a[56:59], v[212:215]
s_add_u32 m0, s77, 67584
ds_read_b64_tr_b16 a[106:107], v10 offset:33792
v_mfma_f32_16x16x32_bf16 v[212:215], a[116:119], a[60:63], v[212:215]
s_add_u32 s64, s71, 589824
ds_read_b64_tr_b16 a[108:109], v10 offset:40960
v_mfma_f32_16x16x32_bf16 v[204:207], a[116:119], a[52:55], v[204:207]
buffer_load_dwordx4 v15, s[56:59], s64 offen lds
v_mfma_f32_16x16x32_bf16 v[204:207], a[112:115], a[48:51], v[204:207]
ds_read_b64_tr_b16 a[110:111], v10 offset:41984
v_mfma_f32_16x16x32_bf16 v[196:199], a[112:115], a[40:43], v[196:199]
v_mfma_f32_16x16x32_bf16 v[196:199], a[116:119], a[44:47], v[196:199]
v_mfma_f32_16x16x32_bf16 v[188:191], a[116:119], a[36:39], v[188:191]
v_mfma_f32_16x16x32_bf16 v[188:191], a[112:115], a[32:35], v[188:191]
s_add_u32 s67, s79, 20480
ds_read_b64_tr_b16 a[112:113], v11 offset:32768
v_mfma_f32_16x16x32_bf16 v[216:219], a[72:75], a[32:35], v[216:219]
ds_read_b64_tr_b16 a[114:115], v11 offset:33792
v_mfma_f32_16x16x32_bf16 v[216:219], a[76:79], a[36:39], v[216:219]
s_add_u32 m0, s78, 90112
ds_read_b64_tr_b16 a[116:117], v11 offset:40960
v_cvt_pk_bf16_f32 v215, v214, v215
v_mfma_f32_16x16x32_bf16 v[224:227], a[76:79], a[44:47], v[224:227]
s_add_u32 s64, s75, 397312
ds_read_b64_tr_b16 a[118:119], v11 offset:41984
v_cvt_pk_bf16_f32 v214, v212, v213
v_mfma_f32_16x16x32_bf16 v[224:227], a[72:75], a[40:43], v[224:227]
buffer_load_dwordx4 v23, s[60:63], s64 offen lds
v_mfma_f32_16x16x32_bf16 v[232:235], a[72:75], a[48:51], v[232:235]
v_cvt_pk_bf16_f32 v212, v208, v209
v_cvt_pk_bf16_f32 v213, v210, v211
v_mfma_f32_16x16x32_bf16 v[232:235], a[76:79], a[52:55], v[232:235]
buffer_store_dwordx4 v[212:215], v16, s[44:47], s67 offen sc1
v_mfma_f32_16x16x32_bf16 v[240:243], a[76:79], a[60:63], v[240:243]
v_cvt_pk_bf16_f32 v207, v206, v207
v_cvt_pk_bf16_f32 v206, v204, v205
v_mfma_f32_16x16x32_bf16 v[240:243], a[72:75], a[56:59], v[240:243]
ds_read_b64_tr_b16 a[72:73], v4 offset:49152
v_cvt_pk_bf16_f32 v204, v200, v201
v_mfma_f32_16x16x32_bf16 v[244:247], a[80:83], a[56:59], v[244:247]
ds_read_b64_tr_b16 a[74:75], v4 offset:50176
v_cvt_pk_bf16_f32 v205, v202, v203
v_mfma_f32_16x16x32_bf16 v[244:247], a[84:87], a[60:63], v[244:247]
ds_read_b64_tr_b16 a[76:77], v4 offset:57344
v_accvgpr_write_b32 a144, v204
v_mfma_f32_16x16x32_bf16 v[236:239], a[84:87], a[52:55], v[236:239]
s_add_u32 m0, s77, 68608
ds_read_b64_tr_b16 a[78:79], v4 offset:58368
v_accvgpr_write_b32 a145, v205
v_mfma_f32_16x16x32_bf16 v[236:239], a[80:83], a[48:51], v[236:239]
s_add_u32 s64, s71, 622592
v_accvgpr_write_b32 a146, v206
v_accvgpr_write_b32 a147, v207
v_mfma_f32_16x16x32_bf16 v[228:231], a[80:83], a[40:43], v[228:231]
buffer_load_dwordx4 v15, s[56:59], s64 offen lds
v_mfma_f32_16x16x32_bf16 v[228:231], a[84:87], a[44:47], v[228:231]
v_cvt_pk_bf16_f32 v199, v198, v199
v_cvt_pk_bf16_f32 v198, v196, v197
v_mfma_f32_16x16x32_bf16 v[220:223], a[84:87], a[36:39], v[220:223]
v_cvt_pk_bf16_f32 v196, v192, v193
v_cvt_pk_bf16_f32 v197, v194, v195
v_mfma_f32_16x16x32_bf16 v[220:223], a[80:83], a[32:35], v[220:223]
s_waitcnt lgkmcnt(4)
ds_read_b64_tr_b16 a[80:81], v5 offset:49152
v_accvgpr_write_b32 a148, v196
v_mfma_f32_16x16x32_bf16 v[152:155], a[88:91], a[32:35], v[152:155]
ds_read_b64_tr_b16 a[82:83], v5 offset:50176
v_accvgpr_write_b32 a149, v197
v_mfma_f32_16x16x32_bf16 v[152:155], a[92:95], a[36:39], v[152:155]
ds_read_b64_tr_b16 a[84:85], v5 offset:57344
v_accvgpr_write_b32 a150, v198
v_mfma_f32_16x16x32_bf16 v[160:163], a[92:95], a[44:47], v[160:163]
ds_read_b64_tr_b16 a[86:87], v5 offset:58368
v_accvgpr_write_b32 a151, v199
v_mfma_f32_16x16x32_bf16 v[160:163], a[88:91], a[40:43], v[160:163]
v_cvt_pk_bf16_f32 v191, v190, v191
v_cvt_pk_bf16_f32 v190, v188, v189
v_mfma_f32_16x16x32_bf16 v[168:171], a[88:91], a[48:51], v[168:171]
v_cvt_pk_bf16_f32 v188, v184, v185
v_cvt_pk_bf16_f32 v189, v186, v187
v_mfma_f32_16x16x32_bf16 v[168:171], a[92:95], a[52:55], v[168:171]
v_accvgpr_write_b32 a152, v188
v_accvgpr_write_b32 a153, v189
v_mfma_f32_16x16x32_bf16 v[176:179], a[92:95], a[60:63], v[176:179]
s_add_u32 m0, s76, 32768
v_accvgpr_write_b32 a154, v190
v_accvgpr_write_b32 a155, v191
v_mfma_f32_16x16x32_bf16 v[176:179], a[88:91], a[56:59], v[176:179]
s_add_u32 s67, s79, 21504
s_add_u32 s64, s72, 128
ds_read_b64_tr_b16 a[88:89], v6 offset:49152
v_cvt_pk_bf16_f32 v247, v246, v247
v_mfma_f32_16x16x32_bf16 v[180:183], a[96:99], a[56:59], v[180:183]
buffer_load_dwordx4 v12, s[48:51], s64 offen lds
v_mfma_f32_16x16x32_bf16 v[180:183], a[100:103], a[60:63], v[180:183]
ds_read_b64_tr_b16 a[90:91], v6 offset:50176
v_cvt_pk_bf16_f32 v246, v244, v245
v_mfma_f32_16x16x32_bf16 v[172:175], a[100:103], a[52:55], v[172:175]
ds_read_b64_tr_b16 a[92:93], v6 offset:57344
v_cvt_pk_bf16_f32 v244, v240, v241
v_mfma_f32_16x16x32_bf16 v[172:175], a[96:99], a[48:51], v[172:175]
ds_read_b64_tr_b16 a[94:95], v6 offset:58368
v_cvt_pk_bf16_f32 v245, v242, v243
v_mfma_f32_16x16x32_bf16 v[164:167], a[96:99], a[40:43], v[164:167]
buffer_store_dwordx4 v[244:247], v16, s[44:47], s67 offen sc1
v_mfma_f32_16x16x32_bf16 v[164:167], a[100:103], a[44:47], v[164:167]
s_add_u32 m0, s76, 33792
v_cvt_pk_bf16_f32 v239, v238, v239
v_cvt_pk_bf16_f32 v238, v236, v237
v_mfma_f32_16x16x32_bf16 v[156:159], a[100:103], a[36:39], v[156:159]
s_add_u32 s64, s72, 16512
v_cvt_pk_bf16_f32 v236, v232, v233
v_cvt_pk_bf16_f32 v237, v234, v235
v_mfma_f32_16x16x32_bf16 v[156:159], a[96:99], a[32:35], v[156:159]
buffer_load_dwordx4 v13, s[48:51], s64 offen lds
v_mfma_f32_16x16x32_bf16 v[24:27], a[104:107], a[32:35], v[24:27]
ds_read_b64_tr_b16 a[96:97], v7 offset:49152
v_accvgpr_write_b32 a156, v236
v_mfma_f32_16x16x32_bf16 v[24:27], a[108:111], a[36:39], v[24:27]
ds_read_b64_tr_b16 a[98:99], v7 offset:50176
v_accvgpr_write_b32 a157, v237
v_mfma_f32_16x16x32_bf16 v[40:43], a[108:111], a[44:47], v[40:43]
ds_read_b64_tr_b16 a[100:101], v7 offset:57344
v_accvgpr_write_b32 a158, v238
v_mfma_f32_16x16x32_bf16 v[40:43], a[104:107], a[40:43], v[40:43]
ds_read_b64_tr_b16 a[102:103], v7 offset:58368
v_accvgpr_write_b32 a159, v239
v_mfma_f32_16x16x32_bf16 v[56:59], a[104:107], a[48:51], v[56:59]
s_add_u32 m0, s76, 34816
v_cvt_pk_bf16_f32 v231, v230, v231
v_cvt_pk_bf16_f32 v230, v228, v229
v_mfma_f32_16x16x32_bf16 v[56:59], a[108:111], a[52:55], v[56:59]
s_add_u32 s64, s72, 131200
v_cvt_pk_bf16_f32 v228, v224, v225
v_cvt_pk_bf16_f32 v229, v226, v227
v_mfma_f32_16x16x32_bf16 v[72:75], a[108:111], a[60:63], v[72:75]
s_waitcnt vmcnt(11)
buffer_load_dwordx4 v12, s[48:51], s64 offen lds
v_mfma_f32_16x16x32_bf16 v[72:75], a[104:107], a[56:59], v[72:75]
ds_read_b64_tr_b16 a[104:105], v8 offset:49152
v_accvgpr_write_b32 a160, v228
v_mfma_f32_16x16x32_bf16 v[136:139], a[112:115], a[56:59], v[136:139]
ds_read_b64_tr_b16 a[106:107], v8 offset:50176
v_accvgpr_write_b32 a161, v229
v_mfma_f32_16x16x32_bf16 v[136:139], a[116:119], a[60:63], v[136:139]
ds_read_b64_tr_b16 a[108:109], v8 offset:57344
v_add_u32 v4, 0x8000, v4
v_mfma_f32_16x16x32_bf16 v[120:123], a[116:119], a[52:55], v[120:123]
ds_read_b64_tr_b16 a[110:111], v8 offset:58368
v_accvgpr_write_b32 a162, v230
v_mfma_f32_16x16x32_bf16 v[120:123], a[112:115], a[48:51], v[120:123]
s_add_u32 m0, s76, 35840
ds_read_b128 a[0:3], v2 offset:0
v_accvgpr_write_b32 a163, v231
v_mfma_f32_16x16x32_bf16 v[104:107], a[112:115], a[40:43], v[104:107]
s_add_u32 s64, s72, 147584
ds_read_b128 a[4:7], v3 offset:0
v_cvt_pk_bf16_f32 v223, v222, v223
v_mfma_f32_16x16x32_bf16 v[104:107], a[116:119], a[44:47], v[104:107]
buffer_load_dwordx4 v13, s[48:51], s64 offen lds
v_mfma_f32_16x16x32_bf16 v[88:91], a[116:119], a[36:39], v[88:91]
ds_read_b128 a[8:11], v2 offset:2048
v_cvt_pk_bf16_f32 v222, v220, v221
v_mfma_f32_16x16x32_bf16 v[88:91], a[112:115], a[32:35], v[88:91]
s_waitcnt lgkmcnt(7)
ds_read_b128 a[12:15], v3 offset:2048
v_cvt_pk_bf16_f32 v220, v216, v217
v_mfma_f32_16x16x32_bf16 v[28:31], a[32:35], a[72:75], v[28:31]
ds_read_b128 a[16:19], v2 offset:4096
v_cvt_pk_bf16_f32 v221, v218, v219
v_mfma_f32_16x16x32_bf16 v[28:31], a[36:39], a[76:79], v[28:31]
ds_read_b128 a[20:23], v3 offset:4096
v_add_u32 v5, 0x8000, v5
v_mfma_f32_16x16x32_bf16 v[44:47], a[44:47], a[76:79], v[44:47]
s_add_u32 m0, s76, 36864
ds_read_b128 a[24:27], v2 offset:6144
v_accvgpr_write_b32 a164, v220
v_mfma_f32_16x16x32_bf16 v[44:47], a[40:43], a[72:75], v[44:47]
s_add_u32 s64, s73, 128
ds_read_b128 a[28:31], v3 offset:6144
v_accvgpr_write_b32 a165, v221
v_mfma_f32_16x16x32_bf16 v[60:63], a[48:51], a[72:75], v[60:63]
buffer_load_dwordx4 v12, s[48:51], s64 offen lds
v_mfma_f32_16x16x32_bf16 v[60:63], a[52:55], a[76:79], v[60:63]
ds_read_b64_tr_b16 a[112:113], v9 offset:49152
v_accvgpr_write_b32 a166, v222
v_mfma_f32_16x16x32_bf16 v[76:79], a[60:63], a[76:79], v[76:79]
ds_read_b64_tr_b16 a[114:115], v9 offset:50176
v_accvgpr_write_b32 a167, v223
v_mfma_f32_16x16x32_bf16 v[76:79], a[56:59], a[72:75], v[76:79]
s_add_u32 s67, s79, 22528
ds_read_b64_tr_b16 a[116:117], v9 offset:57344
v_cvt_pk_bf16_f32 v183, v182, v183
v_mfma_f32_16x16x32_bf16 v[140:143], a[56:59], a[80:83], v[140:143]
ds_read_b64_tr_b16 a[118:119], v9 offset:58368
v_cvt_pk_bf16_f32 v182, v180, v181
v_mfma_f32_16x16x32_bf16 v[140:143], a[60:63], a[84:87], v[140:143]
s_add_u32 m0, s76, 37888
ds_read_b64_tr_b16 a[72:73], v10 offset:49152
v_add_u32 v6, 0x8000, v6
v_mfma_f32_16x16x32_bf16 v[124:127], a[52:55], a[84:87], v[124:127]
s_add_u32 s64, s73, 16512
ds_read_b64_tr_b16 a[74:75], v10 offset:50176
v_cvt_pk_bf16_f32 v180, v176, v177
v_mfma_f32_16x16x32_bf16 v[124:127], a[48:51], a[80:83], v[124:127]
buffer_load_dwordx4 v13, s[48:51], s64 offen lds
v_mfma_f32_16x16x32_bf16 v[108:111], a[40:43], a[80:83], v[108:111]
ds_read_b64_tr_b16 a[76:77], v10 offset:57344
v_cvt_pk_bf16_f32 v181, v178, v179
v_mfma_f32_16x16x32_bf16 v[108:111], a[44:47], a[84:87], v[108:111]
ds_read_b64_tr_b16 a[78:79], v10 offset:58368
v_mfma_f32_16x16x32_bf16 v[92:95], a[36:39], a[84:87], v[92:95]
buffer_store_dwordx4 v[180:183], v16, s[44:47], s67 offen sc1
v_mfma_f32_16x16x32_bf16 v[92:95], a[32:35], a[80:83], v[92:95]
ds_read_b64_tr_b16 a[80:81], v11 offset:49152
v_cvt_pk_bf16_f32 v175, v174, v175
v_mfma_f32_16x16x32_bf16 v[32:35], a[32:35], a[88:91], v[32:35]
s_add_u32 m0, s76, 38912
ds_read_b64_tr_b16 a[82:83], v11 offset:50176
v_cvt_pk_bf16_f32 v174, v172, v173
v_mfma_f32_16x16x32_bf16 v[32:35], a[36:39], a[92:95], v[32:35]
s_add_u32 s64, s73, 131200
ds_read_b64_tr_b16 a[84:85], v11 offset:57344
v_add_u32 v7, 0x8000, v7
v_mfma_f32_16x16x32_bf16 v[48:51], a[44:47], a[92:95], v[48:51]
buffer_load_dwordx4 v12, s[48:51], s64 offen lds
v_mfma_f32_16x16x32_bf16 v[48:51], a[40:43], a[88:91], v[48:51]
ds_read_b64_tr_b16 a[86:87], v11 offset:58368
v_cvt_pk_bf16_f32 v172, v168, v169
v_mfma_f32_16x16x32_bf16 v[64:67], a[48:51], a[88:91], v[64:67]
v_cvt_pk_bf16_f32 v173, v170, v171
v_accvgpr_write_b32 a168, v172
v_mfma_f32_16x16x32_bf16 v[64:67], a[52:55], a[92:95], v[64:67]
v_accvgpr_write_b32 a169, v173
v_accvgpr_write_b32 a170, v174
v_mfma_f32_16x16x32_bf16 v[80:83], a[60:63], a[92:95], v[80:83]
v_accvgpr_write_b32 a171, v175
v_cvt_pk_bf16_f32 v167, v166, v167
v_mfma_f32_16x16x32_bf16 v[80:83], a[56:59], a[88:91], v[80:83]
s_add_u32 m0, s76, 39936
v_cvt_pk_bf16_f32 v166, v164, v165
v_cvt_pk_bf16_f32 v164, v160, v161
v_mfma_f32_16x16x32_bf16 v[144:147], a[56:59], a[96:99], v[144:147]
s_add_u32 s64, s73, 147584
v_cvt_pk_bf16_f32 v165, v162, v163
v_accvgpr_write_b32 a172, v164
v_mfma_f32_16x16x32_bf16 v[144:147], a[60:63], a[100:103], v[144:147]
buffer_load_dwordx4 v13, s[48:51], s64 offen lds
v_mfma_f32_16x16x32_bf16 v[128:131], a[52:55], a[100:103], v[128:131]
v_add_u32 v8, 0x8000, v8
v_accvgpr_write_b32 a173, v165
v_mfma_f32_16x16x32_bf16 v[128:131], a[48:51], a[96:99], v[128:131]
v_accvgpr_write_b32 a174, v166
v_accvgpr_write_b32 a175, v167
v_mfma_f32_16x16x32_bf16 v[112:115], a[40:43], a[96:99], v[112:115]
v_cvt_pk_bf16_f32 v159, v158, v159
v_cvt_pk_bf16_f32 v158, v156, v157
v_mfma_f32_16x16x32_bf16 v[112:115], a[44:47], a[100:103], v[112:115]
v_cvt_pk_bf16_f32 v156, v152, v153
v_cvt_pk_bf16_f32 v157, v154, v155
v_mfma_f32_16x16x32_bf16 v[96:99], a[36:39], a[100:103], v[96:99]
v_add_u32 v9, 0x8000, v9
v_add_u32 v10, 0x8000, v10
v_mfma_f32_16x16x32_bf16 v[96:99], a[32:35], a[96:99], v[96:99]
s_waitcnt lgkmcnt(0)
v_add_u32 v11, 0x8000, v11
v_accvgpr_write_b32 a176, v156
v_mfma_f32_16x16x32_bf16 v[36:39], a[32:35], a[104:107], v[36:39]
v_accvgpr_write_b32 a177, v157
v_accvgpr_write_b32 a178, v158
v_mfma_f32_16x16x32_bf16 v[36:39], a[36:39], a[108:111], v[36:39]
v_accvgpr_write_b32 a179, v159
v_mfma_f32_16x16x32_bf16 v[52:55], a[44:47], a[108:111], v[52:55]
s_add_u32 s67, s79, 23552
s_waitcnt lgkmcnt(0)
s_barrier
v_mfma_f32_16x16x32_bf16 v[52:55], a[40:43], a[104:107], v[52:55]
s_add_u32 m0, s77, 98304
ds_read_b64_tr_b16 a[88:89], v19 offset:36864
v_cvt_pk_bf16_f32 v139, v138, v139
v_mfma_f32_16x16x32_bf16 v[68:71], a[48:51], a[104:107], v[68:71]
s_add_u32 s64, s71, 1048576
ds_read_b64_tr_b16 a[90:91], v19 offset:37120
v_cvt_pk_bf16_f32 v138, v136, v137
v_mfma_f32_16x16x32_bf16 v[68:71], a[52:55], a[108:111], v[68:71]
buffer_load_dwordx4 v14, s[56:59], s64 offen lds
v_mfma_f32_16x16x32_bf16 v[84:87], a[60:63], a[108:111], v[84:87]
ds_read_b64_tr_b16 a[92:93], v19 offset:38912
v_cvt_pk_bf16_f32 v136, v72, v73
v_mfma_f32_16x16x32_bf16 v[84:87], a[56:59], a[104:107], v[84:87]
ds_read_b64_tr_b16 a[94:95], v19 offset:39168
v_cvt_pk_bf16_f32 v137, v74, v75
v_mfma_f32_16x16x32_bf16 v[148:151], a[56:59], a[112:115], v[148:151]
ds_read_b64_tr_b16 a[96:97], v20 offset:36864
v_mfma_f32_16x16x32_bf16 v[148:151], a[60:63], a[116:119], v[148:151]
ds_read_b64_tr_b16 a[98:99], v20 offset:37120
v_mfma_f32_16x16x32_bf16 v[132:135], a[52:55], a[116:119], v[132:135]
ds_read_b64_tr_b16 a[100:101], v20 offset:38912
v_mfma_f32_16x16x32_bf16 v[132:135], a[48:51], a[112:115], v[132:135]
ds_read_b64_tr_b16 a[102:103], v20 offset:39168
v_mfma_f32_16x16x32_bf16 v[116:119], a[40:43], a[112:115], v[116:119]
s_add_u32 m0, s78, 114688
ds_read_b64_tr_b16 a[104:105], v19 offset:40960
v_mfma_f32_16x16x32_bf16 v[116:119], a[44:47], a[116:119], v[116:119]
s_add_u32 s64, s75, 786432
ds_read_b64_tr_b16 a[106:107], v19 offset:41216
v_mfma_f32_16x16x32_bf16 v[100:103], a[36:39], a[116:119], v[100:103]
buffer_load_dwordx4 v23, s[60:63], s64 offen lds
v_mfma_f32_16x16x32_bf16 v[100:103], a[32:35], a[112:115], v[100:103]
ds_read_b64_tr_b16 a[108:109], v19 offset:43008
v_mfma_f32_16x16x32_bf16 v[248:251], a[32:35], a[72:75], v[248:251]
ds_read_b64_tr_b16 a[110:111], v19 offset:43264
v_mfma_f32_16x16x32_bf16 v[248:251], a[36:39], a[76:79], v[248:251]
ds_read_b64_tr_b16 a[112:113], v20 offset:40960
v_mfma_f32_16x16x32_bf16 v[252:255], a[44:47], a[76:79], v[252:255]
ds_read_b64_tr_b16 a[114:115], v20 offset:41216
v_mfma_f32_16x16x32_bf16 v[252:255], a[40:43], a[72:75], v[252:255]
ds_read_b64_tr_b16 a[116:117], v20 offset:43008
v_mfma_f32_16x16x32_bf16 a[120:123], a[48:51], a[72:75], a[120:123]
ds_read_b64_tr_b16 a[118:119], v20 offset:43264
v_mfma_f32_16x16x32_bf16 a[120:123], a[52:55], a[76:79], a[120:123]
s_add_u32 m0, s77, 99328
buffer_store_dwordx4 v[136:139], v16, s[44:47], s67 offen sc1
v_mfma_f32_16x16x32_bf16 a[124:127], a[60:63], a[76:79], a[124:127]
s_add_u32 s64, s71, 1081344
v_cvt_pk_bf16_f32 v123, v122, v123
v_cvt_pk_bf16_f32 v122, v120, v121
v_mfma_f32_16x16x32_bf16 a[124:127], a[56:59], a[72:75], a[124:127]
buffer_load_dwordx4 v14, s[56:59], s64 offen lds
v_mfma_f32_16x16x32_bf16 a[128:131], a[56:59], a[80:83], a[128:131]
ds_read_b64_tr_b16 a[72:73], v19 offset:32768
v_cvt_pk_bf16_f32 v120, v56, v57
v_mfma_f32_16x16x32_bf16 a[128:131], a[60:63], a[84:87], a[128:131]
ds_read_b64_tr_b16 a[74:75], v19 offset:33024
v_cvt_pk_bf16_f32 v121, v58, v59
v_mfma_f32_16x16x32_bf16 a[132:135], a[52:55], a[84:87], a[132:135]
ds_read_b64_tr_b16 a[76:77], v19 offset:34816
v_accvgpr_write_b32 a180, v120
v_mfma_f32_16x16x32_bf16 a[132:135], a[48:51], a[80:83], a[132:135]
ds_read_b64_tr_b16 a[78:79], v19 offset:35072
v_accvgpr_write_b32 a181, v121
v_mfma_f32_16x16x32_bf16 a[136:139], a[40:43], a[80:83], a[136:139]
v_accvgpr_write_b32 a182, v122
v_accvgpr_write_b32 a183, v123
v_mfma_f32_16x16x32_bf16 a[136:139], a[44:47], a[84:87], a[136:139]
v_cvt_pk_bf16_f32 v107, v106, v107
v_cvt_pk_bf16_f32 v106, v104, v105
v_mfma_f32_16x16x32_bf16 a[140:143], a[36:39], a[84:87], a[140:143]
s_add_u32 m0, s78, 118784
v_cvt_pk_bf16_f32 v104, v40, v41
v_cvt_pk_bf16_f32 v105, v42, v43
v_mfma_f32_16x16x32_bf16 a[140:143], a[32:35], a[80:83], a[140:143]
s_waitcnt lgkmcnt(4)
s_add_u32 s64, s75, 788480
ds_read_b64_tr_b16 a[80:81], v20 offset:32768
v_accvgpr_write_b32 a184, v104
v_mfma_f32_16x16x32_bf16 v[184:187], a[88:91], a[0:3], 0
buffer_load_dwordx4 v23, s[60:63], s64 offen lds
v_mfma_f32_16x16x32_bf16 v[184:187], a[92:95], a[4:7], v[184:187]
ds_read_b64_tr_b16 a[82:83], v20 offset:33024
v_accvgpr_write_b32 a185, v105
v_mfma_f32_16x16x32_bf16 v[192:195], a[92:95], a[12:15], 0
ds_read_b64_tr_b16 a[84:85], v20 offset:34816
v_accvgpr_write_b32 a186, v106
v_mfma_f32_16x16x32_bf16 v[192:195], a[88:91], a[8:11], v[192:195]
s_add_u32 s17, s78, .-L_pc+6144
ds_read_b64_tr_b16 a[86:87], v20 offset:35072
v_accvgpr_write_b32 a187, v107
v_mfma_f32_16x16x32_bf16 v[200:203], a[88:91], a[16:19], 0
buffer_load_dword a252, v16, s[88:91], s17 offen
v_mfma_f32_16x16x32_bf16 v[200:203], a[92:95], a[20:23], v[200:203]
v_cvt_pk_bf16_f32 v91, v90, v91
v_cvt_pk_bf16_f32 v90, v88, v89
v_mfma_f32_16x16x32_bf16 v[208:211], a[92:95], a[28:31], 0
v_cvt_pk_bf16_f32 v88, v24, v25
v_cvt_pk_bf16_f32 v89, v26, v27
v_mfma_f32_16x16x32_bf16 v[208:211], a[88:91], a[24:27], v[208:211]
ds_read_b64_tr_b16 a[88:89], v4 offset:32768
v_accvgpr_write_b32 a188, v88
v_mfma_f32_16x16x32_bf16 v[212:215], a[96:99], a[24:27], 0
s_add_u32 m0, s77, 100352
ds_read_b64_tr_b16 a[90:91], v4 offset:33792
v_accvgpr_write_b32 a189, v89
v_mfma_f32_16x16x32_bf16 v[212:215], a[100:103], a[28:31], v[212:215]
s_add_u32 s64, s71, 1114112
ds_read_b64_tr_b16 a[92:93], v4 offset:40960
v_accvgpr_write_b32 a190, v90
v_mfma_f32_16x16x32_bf16 v[204:207], a[100:103], a[20:23], 0
buffer_load_dwordx4 v15, s[56:59], s64 offen lds
v_mfma_f32_16x16x32_bf16 v[204:207], a[96:99], a[16:19], v[204:207]
ds_read_b64_tr_b16 a[94:95], v4 offset:41984
v_accvgpr_write_b32 a191, v91
v_mfma_f32_16x16x32_bf16 v[196:199], a[96:99], a[8:11], 0
s_add_u32 s67, s79, 8192
v_cvt_pk_bf16_f32 v47, v46, v47
v_cvt_pk_bf16_f32 v46, v44, v45
v_mfma_f32_16x16x32_bf16 v[196:199], a[100:103], a[12:15], v[196:199]
v_cvt_pk_bf16_f32 v44, v28, v29
v_cvt_pk_bf16_f32 v45, v30, v31
v_mfma_f32_16x16x32_bf16 v[188:191], a[100:103], a[4:7], 0
buffer_store_dwordx4 v[44:47], v16, s[44:47], s67 offen sc1
v_mfma_f32_16x16x32_bf16 v[188:191], a[96:99], a[0:3], v[188:191]
ds_read_b64_tr_b16 a[96:97], v5 offset:32768
v_cvt_pk_bf16_f32 v79, v78, v79
v_mfma_f32_16x16x32_bf16 v[216:219], a[0:3], a[104:107], 0
ds_read_b64_tr_b16 a[98:99], v5 offset:33792
v_cvt_pk_bf16_f32 v78, v76, v77
v_mfma_f32_16x16x32_bf16 v[216:219], a[4:7], a[108:111], v[216:219]
s_add_u32 m0, s78, 122880
ds_read_b64_tr_b16 a[100:101], v5 offset:40960
v_cvt_pk_bf16_f32 v76, v60, v61
v_mfma_f32_16x16x32_bf16 v[224:227], a[12:15], a[108:111], 0
s_add_u32 s64, s75, 790528
ds_read_b64_tr_b16 a[102:103], v5 offset:41984
v_cvt_pk_bf16_f32 v77, v62, v63
v_mfma_f32_16x16x32_bf16 v[224:227], a[8:11], a[104:107], v[224:227]
buffer_load_dwordx4 v23, s[60:63], s64 offen lds
v_mfma_f32_16x16x32_bf16 v[232:235], a[16:19], a[104:107], 0
v_accvgpr_write_b32 a192, v76
v_accvgpr_write_b32 a193, v77
v_mfma_f32_16x16x32_bf16 v[232:235], a[20:23], a[108:111], v[232:235]
v_accvgpr_write_b32 a194, v78
v_accvgpr_write_b32 a195, v79
v_mfma_f32_16x16x32_bf16 v[240:243], a[28:31], a[108:111], 0
v_cvt_pk_bf16_f32 v124, v124, v125
v_cvt_pk_bf16_f32 v125, v126, v127
v_mfma_f32_16x16x32_bf16 v[240:243], a[24:27], a[104:107], v[240:243]
ds_read_b64_tr_b16 a[104:105], v6 offset:32768
v_cvt_pk_bf16_f32 v126, v140, v141
v_mfma_f32_16x16x32_bf16 v[244:247], a[24:27], a[112:115], 0
ds_read_b64_tr_b16 a[106:107], v6 offset:33792
v_cvt_pk_bf16_f32 v127, v142, v143
v_mfma_f32_16x16x32_bf16 v[244:247], a[28:31], a[116:119], v[244:247]
ds_read_b64_tr_b16 a[108:109], v6 offset:40960
v_accvgpr_write_b32 a196, v124
v_mfma_f32_16x16x32_bf16 v[236:239], a[20:23], a[116:119], 0
s_add_u32 m0, s77, 101376
ds_read_b64_tr_b16 a[110:111], v6 offset:41984
v_accvgpr_write_b32 a197, v125
v_mfma_f32_16x16x32_bf16 v[236:239], a[16:19], a[112:115], v[236:239]
s_add_u32 s64, s71, 1146880
v_accvgpr_write_b32 a198, v126
v_accvgpr_write_b32 a199, v127
v_mfma_f32_16x16x32_bf16 v[228:231], a[8:11], a[112:115], 0
buffer_load_dwordx4 v15, s[56:59], s64 offen lds
v_mfma_f32_16x16x32_bf16 v[228:231], a[12:15], a[116:119], v[228:231]
v_cvt_pk_bf16_f32 v92, v92, v93
v_cvt_pk_bf16_f32 v93, v94, v95
v_mfma_f32_16x16x32_bf16 v[220:223], a[4:7], a[116:119], 0
v_cvt_pk_bf16_f32 v94, v108, v109
v_cvt_pk_bf16_f32 v95, v110, v111
v_mfma_f32_16x16x32_bf16 v[220:223], a[0:3], a[112:115], v[220:223]
s_waitcnt lgkmcnt(4)
ds_read_b64_tr_b16 a[112:113], v7 offset:32768
v_accvgpr_write_b32 a200, v92
v_mfma_f32_16x16x32_bf16 v[152:155], a[72:75], a[0:3], 0
ds_read_b64_tr_b16 a[114:115], v7 offset:33792
v_accvgpr_write_b32 a201, v93
v_mfma_f32_16x16x32_bf16 v[152:155], a[76:79], a[4:7], v[152:155]
ds_read_b64_tr_b16 a[116:117], v7 offset:40960
v_accvgpr_write_b32 a202, v94
v_mfma_f32_16x16x32_bf16 v[160:163], a[76:79], a[12:15], 0
ds_read_b64_tr_b16 a[118:119], v7 offset:41984
v_accvgpr_write_b32 a203, v95
v_mfma_f32_16x16x32_bf16 v[160:163], a[72:75], a[8:11], v[160:163]
s_add_u32 s67, s79, 10240
v_cvt_pk_bf16_f32 v51, v50, v51
v_cvt_pk_bf16_f32 v50, v48, v49
v_mfma_f32_16x16x32_bf16 v[168:171], a[72:75], a[16:19], 0
v_cvt_pk_bf16_f32 v48, v32, v33
v_cvt_pk_bf16_f32 v49, v34, v35
v_mfma_f32_16x16x32_bf16 v[168:171], a[76:79], a[20:23], v[168:171]
buffer_store_dwordx4 v[48:51], v16, s[44:47], s67 offen sc1
v_mfma_f32_16x16x32_bf16 v[176:179], a[76:79], a[28:31], 0
s_add_u32 m0, s76, 0
v_subrev_u32 v19, 0x8000, v19
v_subrev_u32 v20, 0x8000, v20
v_mfma_f32_16x16x32_bf16 v[176:179], a[72:75], a[24:27], v[176:179]
s_add_u32 s64, s72, 256
ds_read_b64_tr_b16 a[72:73], v8 offset:32768
v_cvt_pk_bf16_f32 v83, v82, v83
v_mfma_f32_16x16x32_bf16 v[180:183], a[80:83], a[24:27], 0
buffer_load_dwordx4 v12, s[48:51], s64 offen lds
v_mfma_f32_16x16x32_bf16 v[180:183], a[84:87], a[28:31], v[180:183]
ds_read_b64_tr_b16 a[74:75], v8 offset:33792
v_subrev_u32 v4, 0x8000, v4
v_mfma_f32_16x16x32_bf16 v[172:175], a[84:87], a[20:23], 0
ds_read_b64_tr_b16 a[76:77], v8 offset:40960
v_cvt_pk_bf16_f32 v82, v80, v81
v_mfma_f32_16x16x32_bf16 v[172:175], a[80:83], a[16:19], v[172:175]
s_add_u32 m0, s76, 1024
ds_read_b64_tr_b16 a[78:79], v8 offset:41984
v_cvt_pk_bf16_f32 v80, v64, v65
v_mfma_f32_16x16x32_bf16 v[164:167], a[80:83], a[8:11], 0
s_add_u32 s64, s72, 16640
v_cvt_pk_bf16_f32 v81, v66, v67
v_accvgpr_write_b32 a204, v80
v_mfma_f32_16x16x32_bf16 v[164:167], a[84:87], a[12:15], v[164:167]
buffer_load_dwordx4 v13, s[48:51], s64 offen lds
v_mfma_f32_16x16x32_bf16 v[156:159], a[84:87], a[4:7], 0
v_accvgpr_write_b32 a205, v81
v_accvgpr_write_b32 a206, v82
v_mfma_f32_16x16x32_bf16 v[156:159], a[80:83], a[0:3], v[156:159]
ds_read_b64_tr_b16 a[80:81], v9 offset:32768
v_accvgpr_write_b32 a207, v83
v_mfma_f32_16x16x32_bf16 v[24:27], a[88:91], a[0:3], 0
s_add_u32 m0, s76, 2048
ds_read_b64_tr_b16 a[82:83], v9 offset:33792
v_cvt_pk_bf16_f32 v128, v128, v129
v_mfma_f32_16x16x32_bf16 v[24:27], a[92:95], a[4:7], v[24:27]
s_add_u32 s64, s72, 131328
ds_read_b64_tr_b16 a[84:85], v9 offset:40960
v_subrev_u32 v5, 0x8000, v5
v_mfma_f32_16x16x32_bf16 v[40:43], a[92:95], a[12:15], 0
buffer_load_dwordx4 v12, s[48:51], s64 offen lds
v_mfma_f32_16x16x32_bf16 v[40:43], a[88:91], a[8:11], v[40:43]
ds_read_b64_tr_b16 a[86:87], v9 offset:41984
v_cvt_pk_bf16_f32 v129, v130, v131
v_mfma_f32_16x16x32_bf16 v[56:59], a[88:91], a[16:19], 0
s_add_u32 m0, s76, 3072
v_cvt_pk_bf16_f32 v130, v144, v145
v_cvt_pk_bf16_f32 v131, v146, v147
v_mfma_f32_16x16x32_bf16 v[56:59], a[92:95], a[20:23], v[56:59]
s_add_u32 s64, s72, 147712
v_accvgpr_write_b32 a208, v128
v_accvgpr_write_b32 a209, v129
v_mfma_f32_16x16x32_bf16 v[72:75], a[92:95], a[28:31], 0
s_waitcnt vmcnt(14)
ds_read_b128 a[32:35], v2 offset:32768
v_accvgpr_write_b32 a210, v130
v_mfma_f32_16x16x32_bf16 v[72:75], a[88:91], a[24:27], v[72:75]
buffer_load_dwordx4 v13, s[48:51], s64 offen lds
v_mfma_f32_16x16x32_bf16 v[136:139], a[96:99], a[24:27], 0
ds_read_b128 a[36:39], v3 offset:32768
v_accvgpr_write_b32 a211, v131
v_mfma_f32_16x16x32_bf16 v[136:139], a[100:103], a[28:31], v[136:139]
ds_read_b128 a[40:43], v2 offset:34816
v_subrev_u32 v6, 0x8000, v6
v_mfma_f32_16x16x32_bf16 v[120:123], a[100:103], a[20:23], 0
s_add_u32 m0, s76, 4096
ds_read_b128 a[44:47], v3 offset:34816
v_cvt_pk_bf16_f32 v96, v96, v97
v_mfma_f32_16x16x32_bf16 v[120:123], a[96:99], a[16:19], v[120:123]
s_add_u32 s64, s73, 256
ds_read_b128 a[48:51], v2 offset:36864
v_cvt_pk_bf16_f32 v97, v98, v99
v_mfma_f32_16x16x32_bf16 v[104:107], a[96:99], a[8:11], 0
buffer_load_dwordx4 v12, s[48:51], s64 offen lds
v_mfma_f32_16x16x32_bf16 v[104:107], a[100:103], a[12:15], v[104:107]
ds_read_b128 a[52:55], v3 offset:36864
v_cvt_pk_bf16_f32 v98, v112, v113
v_mfma_f32_16x16x32_bf16 v[88:91], a[100:103], a[4:7], 0
ds_read_b128 a[56:59], v2 offset:38912
v_cvt_pk_bf16_f32 v99, v114, v115
v_mfma_f32_16x16x32_bf16 v[88:91], a[96:99], a[0:3], v[88:91]
s_waitcnt lgkmcnt(7)
s_add_u32 m0, s76, 5120
ds_read_b128 a[60:63], v3 offset:38912
v_accvgpr_write_b32 a212, v96
v_mfma_f32_16x16x32_bf16 v[28:31], a[104:107], a[0:3], 0
s_add_u32 s64, s73, 16640
ds_read_b64_tr_b16 a[88:89], v10 offset:32768
v_accvgpr_write_b32 a213, v97
v_mfma_f32_16x16x32_bf16 v[28:31], a[108:111], a[4:7], v[28:31]
buffer_load_dwordx4 v13, s[48:51], s64 offen lds
v_mfma_f32_16x16x32_bf16 v[44:47], a[108:111], a[12:15], 0
ds_read_b64_tr_b16 a[90:91], v10 offset:33792
v_subrev_u32 v7, 0x8000, v7
v_mfma_f32_16x16x32_bf16 v[44:47], a[104:107], a[8:11], v[44:47]
s_add_u32 m0, s76, 6144
ds_read_b64_tr_b16 a[92:93], v10 offset:40960
v_accvgpr_write_b32 a214, v98
v_mfma_f32_16x16x32_bf16 v[60:63], a[104:107], a[16:19], 0
s_add_u32 s64, s73, 131328
ds_read_b64_tr_b16 a[94:95], v10 offset:41984
v_accvgpr_write_b32 a215, v99
v_mfma_f32_16x16x32_bf16 v[60:63], a[108:111], a[20:23], v[60:63]
s_add_u32 s67, s79, 12288
ds_read_b64_tr_b16 a[96:97], v11 offset:32768
v_cvt_pk_bf16_f32 v55, v54, v55
v_mfma_f32_16x16x32_bf16 v[76:79], a[108:111], a[28:31], 0
buffer_load_dwordx4 v12, s[48:51], s64 offen lds
v_mfma_f32_16x16x32_bf16 v[76:79], a[104:107], a[24:27], v[76:79]
ds_read_b64_tr_b16 a[98:99], v11 offset:33792
v_cvt_pk_bf16_f32 v54, v52, v53
v_mfma_f32_16x16x32_bf16 v[140:143], a[112:115], a[24:27], 0
ds_read_b64_tr_b16 a[100:101], v11 offset:40960
v_cvt_pk_bf16_f32 v52, v36, v37
v_mfma_f32_16x16x32_bf16 v[140:143], a[116:119], a[28:31], v[140:143]
s_add_u32 m0, s76, 7168
ds_read_b64_tr_b16 a[102:103], v11 offset:41984
v_subrev_u32 v8, 0x8000, v8
v_mfma_f32_16x16x32_bf16 v[124:127], a[116:119], a[20:23], 0
s_add_u32 s64, s73, 147712
v_cvt_pk_bf16_f32 v53, v38, v39
v_mfma_f32_16x16x32_bf16 v[124:127], a[112:115], a[16:19], v[124:127]
buffer_load_dwordx4 v13, s[48:51], s64 offen lds
v_mfma_f32_16x16x32_bf16 v[108:111], a[112:115], a[8:11], 0
buffer_store_dwordx4 v[52:55], v16, s[44:47], s67 offen sc1
v_mfma_f32_16x16x32_bf16 v[108:111], a[116:119], a[12:15], v[108:111]
v_cvt_pk_bf16_f32 v87, v86, v87
v_cvt_pk_bf16_f32 v86, v84, v85
v_mfma_f32_16x16x32_bf16 v[92:95], a[116:119], a[4:7], 0
v_subrev_u32 v9, 0x8000, v9
v_subrev_u32 v10, 0x8000, v10
v_mfma_f32_16x16x32_bf16 v[92:95], a[112:115], a[0:3], v[92:95]
v_subrev_u32 v11, 0x8000, v11
v_cvt_pk_bf16_f32 v84, v68, v69
v_mfma_f32_16x16x32_bf16 v[32:35], a[72:75], a[0:3], 0
v_cvt_pk_bf16_f32 v85, v70, v71
v_accvgpr_write_b32 a216, v84
v_mfma_f32_16x16x32_bf16 v[32:35], a[76:79], a[4:7], v[32:35]
v_accvgpr_write_b32 a217, v85
v_accvgpr_write_b32 a218, v86
v_mfma_f32_16x16x32_bf16 v[48:51], a[76:79], a[12:15], 0
s_waitcnt lgkmcnt(0)
s_barrier
v_mfma_f32_16x16x32_bf16 v[48:51], a[72:75], a[8:11], v[48:51]
s_add_u32 m0, s77, 131072
ds_read_b64_tr_b16 a[104:105], v19 offset:4096
v_accvgpr_write_b32 a219, v87
v_mfma_f32_16x16x32_bf16 v[64:67], a[72:75], a[16:19], 0
s_add_u32 s64, s71, 1572864
ds_read_b64_tr_b16 a[106:107], v19 offset:4352
v_cvt_pk_bf16_f32 v132, v132, v133
v_mfma_f32_16x16x32_bf16 v[64:67], a[76:79], a[20:23], v[64:67]
buffer_load_dwordx4 v14, s[56:59], s64 offen lds
v_mfma_f32_16x16x32_bf16 v[80:83], a[76:79], a[28:31], 0
ds_read_b64_tr_b16 a[108:109], v19 offset:6144
v_cvt_pk_bf16_f32 v133, v134, v135
v_mfma_f32_16x16x32_bf16 v[80:83], a[72:75], a[24:27], v[80:83]
ds_read_b64_tr_b16 a[110:111], v19 offset:6400
v_cvt_pk_bf16_f32 v134, v148, v149
v_mfma_f32_16x16x32_bf16 v[144:147], a[80:83], a[24:27], 0
ds_read_b64_tr_b16 a[112:113], v20 offset:4096
v_cvt_pk_bf16_f32 v135, v150, v151
v_mfma_f32_16x16x32_bf16 v[144:147], a[84:87], a[28:31], v[144:147]
ds_read_b64_tr_b16 a[114:115], v20 offset:4352
v_accvgpr_write_b32 a220, v132
v_mfma_f32_16x16x32_bf16 v[128:131], a[84:87], a[20:23], 0
ds_read_b64_tr_b16 a[116:117], v20 offset:6144
v_accvgpr_write_b32 a221, v133
v_mfma_f32_16x16x32_bf16 v[128:131], a[80:83], a[16:19], v[128:131]
ds_read_b64_tr_b16 a[118:119], v20 offset:6400
v_accvgpr_write_b32 a222, v134
v_mfma_f32_16x16x32_bf16 v[112:115], a[80:83], a[8:11], 0
s_add_u32 m0, s78, 147456
ds_read_b64_tr_b16 a[72:73], v19 offset:8192
v_accvgpr_write_b32 a223, v135
v_mfma_f32_16x16x32_bf16 v[112:115], a[84:87], a[12:15], v[112:115]
s_add_u32 s64, s75, 1179648
ds_read_b64_tr_b16 a[74:75], v19 offset:8448
v_cvt_pk_bf16_f32 v100, v100, v101
v_mfma_f32_16x16x32_bf16 v[96:99], a[84:87], a[4:7], 0
buffer_load_dwordx4 v23, s[60:63], s64 offen lds
v_mfma_f32_16x16x32_bf16 v[96:99], a[80:83], a[0:3], v[96:99]
ds_read_b64_tr_b16 a[76:77], v19 offset:10240
v_cvt_pk_bf16_f32 v101, v102, v103
v_mfma_f32_16x16x32_bf16 v[36:39], a[88:91], a[0:3], 0
ds_read_b64_tr_b16 a[78:79], v19 offset:10496
v_cvt_pk_bf16_f32 v102, v116, v117
v_mfma_f32_16x16x32_bf16 v[36:39], a[92:95], a[4:7], v[36:39]
ds_read_b64_tr_b16 a[80:81], v20 offset:8192
v_cvt_pk_bf16_f32 v103, v118, v119
v_mfma_f32_16x16x32_bf16 v[52:55], a[92:95], a[12:15], 0
ds_read_b64_tr_b16 a[82:83], v20 offset:8448
v_accvgpr_write_b32 a224, v100
v_mfma_f32_16x16x32_bf16 v[52:55], a[88:91], a[8:11], v[52:55]
ds_read_b64_tr_b16 a[84:85], v20 offset:10240
v_accvgpr_write_b32 a225, v101
v_mfma_f32_16x16x32_bf16 v[68:71], a[88:91], a[16:19], 0
s_add_u32 m0, s77, 132096
ds_read_b64_tr_b16 a[86:87], v20 offset:10496
v_accvgpr_write_b32 a226, v102
v_mfma_f32_16x16x32_bf16 v[68:71], a[92:95], a[20:23], v[68:71]
s_add_u32 s64, s71, 1605632
s_xor_b32 s68, s66, 0
v_accvgpr_write_b32 a227, v103
v_mfma_f32_16x16x32_bf16 v[84:87], a[92:95], a[28:31], 0
s_add_u32 s67, s79, 14336
s_mov_b64 exec, 1
buffer_atomic_add a251, v1, s[52:55], s68 offen offset:0 sc1
s_mov_b64 exec, -1
v_mfma_f32_16x16x32_bf16 v[84:87], a[88:91], a[24:27], v[84:87]
buffer_load_dwordx4 v14, s[56:59], s64 offen lds
v_mfma_f32_16x16x32_bf16 v[148:151], a[96:99], a[24:27], 0
ds_read_b64_tr_b16 a[88:89], v19 offset:0
v_cvt_pk_bf16_f32 v255, v254, v255
v_mfma_f32_16x16x32_bf16 v[148:151], a[100:103], a[28:31], v[148:151]
ds_read_b64_tr_b16 a[90:91], v19 offset:256
v_cvt_pk_bf16_f32 v254, v252, v253
v_mfma_f32_16x16x32_bf16 v[132:135], a[100:103], a[20:23], 0
ds_read_b64_tr_b16 a[92:93], v19 offset:2048
v_cvt_pk_bf16_f32 v252, v248, v249
v_mfma_f32_16x16x32_bf16 v[132:135], a[96:99], a[16:19], v[132:135]
s_add_u32 s65, s79, 16384
ds_read_b64_tr_b16 a[94:95], v19 offset:2304
v_cvt_pk_bf16_f32 v253, v250, v251
v_mfma_f32_16x16x32_bf16 v[116:119], a[96:99], a[8:11], 0
buffer_store_dwordx4 a[144:147], v16, s[44:47], s65 offen sc1
v_mfma_f32_16x16x32_bf16 v[116:119], a[100:103], a[12:15], v[116:119]
buffer_store_dwordx4 v[252:255], v16, s[44:47], s67 offen sc1
v_mfma_f32_16x16x32_bf16 v[100:103], a[100:103], a[4:7], 0
s_add_u32 m0, s78, 151552
v_mfma_f32_16x16x32_bf16 v[100:103], a[96:99], a[0:3], v[100:103]
s_waitcnt lgkmcnt(4)
s_add_u32 s64, s75, 1181696
ds_read_b64_tr_b16 a[96:97], v20 offset:0
v_accvgpr_read_b32 v248, a120
v_mfma_f32_16x16x32_bf16 v[184:187], a[104:107], a[32:35], v[184:187]
buffer_load_dwordx4 v23, s[60:63], s64 offen lds
v_mfma_f32_16x16x32_bf16 v[184:187], a[108:111], a[36:39], v[184:187]
ds_read_b64_tr_b16 a[98:99], v20 offset:256
v_accvgpr_read_b32 v249, a121
v_mfma_f32_16x16x32_bf16 v[192:195], a[108:111], a[44:47], v[192:195]
ds_read_b64_tr_b16 a[100:101], v20 offset:2048
v_accvgpr_read_b32 v250, a122
v_mfma_f32_16x16x32_bf16 v[192:195], a[104:107], a[40:43], v[192:195]
ds_read_b64_tr_b16 a[102:103], v20 offset:2304
v_accvgpr_read_b32 v251, a123
v_mfma_f32_16x16x32_bf16 v[200:203], a[104:107], a[48:51], v[200:203]
v_accvgpr_read_b32 v252, a124
v_accvgpr_read_b32 v253, a125
v_mfma_f32_16x16x32_bf16 v[200:203], a[108:111], a[52:55], v[200:203]
v_accvgpr_read_b32 v254, a126
v_accvgpr_read_b32 v255, a127
v_mfma_f32_16x16x32_bf16 v[208:211], a[108:111], a[60:63], v[208:211]
v_cvt_pk_bf16_f32 v255, v254, v255
v_cvt_pk_bf16_f32 v254, v252, v253
v_mfma_f32_16x16x32_bf16 v[208:211], a[104:107], a[56:59], v[208:211]
ds_read_b64_tr_b16 a[104:105], v4 offset:0
v_cvt_pk_bf16_f32 v252, v248, v249
v_mfma_f32_16x16x32_bf16 v[212:215], a[112:115], a[56:59], v[212:215]
s_add_u32 m0, s77, 133120
ds_read_b64_tr_b16 a[106:107], v4 offset:1024
v_cvt_pk_bf16_f32 v253, v250, v251
v_mfma_f32_16x16x32_bf16 v[212:215], a[116:119], a[60:63], v[212:215]
s_add_u32 s64, s71, 1638400
ds_read_b64_tr_b16 a[108:109], v4 offset:8192
v_accvgpr_write_b32 a228, v252
v_mfma_f32_16x16x32_bf16 v[204:207], a[116:119], a[52:55], v[204:207]
buffer_load_dwordx4 v15, s[56:59], s64 offen lds
v_mfma_f32_16x16x32_bf16 v[204:207], a[112:115], a[48:51], v[204:207]
ds_read_b64_tr_b16 a[110:111], v4 offset:9216
v_accvgpr_write_b32 a229, v253
v_mfma_f32_16x16x32_bf16 v[196:199], a[112:115], a[40:43], v[196:199]
v_accvgpr_write_b32 a230, v254
v_accvgpr_write_b32 a231, v255
v_mfma_f32_16x16x32_bf16 v[196:199], a[116:119], a[44:47], v[196:199]
v_mfma_f32_16x16x32_bf16 v[188:191], a[116:119], a[36:39], v[188:191]
v_accvgpr_read_b32 v248, a132
v_accvgpr_read_b32 v249, a133
v_mfma_f32_16x16x32_bf16 v[188:191], a[112:115], a[32:35], v[188:191]
ds_read_b64_tr_b16 a[112:113], v5 offset:0
v_accvgpr_read_b32 v250, a134
v_mfma_f32_16x16x32_bf16 v[216:219], a[32:35], a[72:75], v[216:219]
ds_read_b64_tr_b16 a[114:115], v5 offset:1024
v_accvgpr_read_b32 v251, a135
v_mfma_f32_16x16x32_bf16 v[216:219], a[36:39], a[76:79], v[216:219]
s_add_u32 m0, s78, 155648
ds_read_b64_tr_b16 a[116:117], v5 offset:8192
v_accvgpr_read_b32 v252, a128
v_mfma_f32_16x16x32_bf16 v[224:227], a[44:47], a[76:79], v[224:227]
s_add_u32 s64, s75, 1183744
ds_read_b64_tr_b16 a[118:119], v5 offset:9216
v_accvgpr_read_b32 v253, a129
v_mfma_f32_16x16x32_bf16 v[224:227], a[40:43], a[72:75], v[224:227]
buffer_load_dwordx4 v23, s[60:63], s64 offen lds
v_mfma_f32_16x16x32_bf16 v[232:235], a[48:51], a[72:75], v[232:235]
v_accvgpr_read_b32 v254, a130
v_accvgpr_read_b32 v255, a131
v_mfma_f32_16x16x32_bf16 v[232:235], a[52:55], a[76:79], v[232:235]
v_cvt_pk_bf16_f32 v255, v254, v255
v_cvt_pk_bf16_f32 v254, v252, v253
v_mfma_f32_16x16x32_bf16 v[240:243], a[60:63], a[76:79], v[240:243]
v_cvt_pk_bf16_f32 v252, v248, v249
v_cvt_pk_bf16_f32 v253, v250, v251
v_mfma_f32_16x16x32_bf16 v[240:243], a[56:59], a[72:75], v[240:243]
ds_read_b64_tr_b16 a[72:73], v6 offset:0
v_accvgpr_write_b32 a232, v252
v_mfma_f32_16x16x32_bf16 v[244:247], a[56:59], a[80:83], v[244:247]
ds_read_b64_tr_b16 a[74:75], v6 offset:1024
v_accvgpr_write_b32 a233, v253
v_mfma_f32_16x16x32_bf16 v[244:247], a[60:63], a[84:87], v[244:247]
ds_read_b64_tr_b16 a[76:77], v6 offset:8192
v_accvgpr_write_b32 a234, v254
v_mfma_f32_16x16x32_bf16 v[236:239], a[52:55], a[84:87], v[236:239]
s_add_u32 m0, s77, 134144
ds_read_b64_tr_b16 a[78:79], v6 offset:9216
v_accvgpr_write_b32 a235, v255
v_mfma_f32_16x16x32_bf16 v[236:239], a[48:51], a[80:83], v[236:239]
s_add_u32 s64, s71, 1671168
v_mfma_f32_16x16x32_bf16 v[228:231], a[40:43], a[80:83], v[228:231]
buffer_load_dwordx4 v15, s[56:59], s64 offen lds
v_mfma_f32_16x16x32_bf16 v[228:231], a[44:47], a[84:87], v[228:231]
v_accvgpr_read_b32 v248, a140
v_accvgpr_read_b32 v249, a141
v_mfma_f32_16x16x32_bf16 v[220:223], a[36:39], a[84:87], v[220:223]
v_accvgpr_read_b32 v250, a142
v_accvgpr_read_b32 v251, a143
v_mfma_f32_16x16x32_bf16 v[220:223], a[32:35], a[80:83], v[220:223]
s_waitcnt lgkmcnt(4)
ds_read_b64_tr_b16 a[80:81], v7 offset:0
v_accvgpr_read_b32 v252, a136
v_mfma_f32_16x16x32_bf16 v[152:155], a[88:91], a[32:35], v[152:155]
ds_read_b64_tr_b16 a[82:83], v7 offset:1024
v_accvgpr_read_b32 v253, a137
v_mfma_f32_16x16x32_bf16 v[152:155], a[92:95], a[36:39], v[152:155]
ds_read_b64_tr_b16 a[84:85], v7 offset:8192
v_accvgpr_read_b32 v254, a138
v_mfma_f32_16x16x32_bf16 v[160:163], a[92:95], a[44:47], v[160:163]
ds_read_b64_tr_b16 a[86:87], v7 offset:9216
v_accvgpr_read_b32 v255, a139
v_mfma_f32_16x16x32_bf16 v[160:163], a[88:91], a[40:43], v[160:163]
v_cvt_pk_bf16_f32 v255, v254, v255
v_cvt_pk_bf16_f32 v254, v252, v253
v_mfma_f32_16x16x32_bf16 v[168:171], a[88:91], a[48:51], v[168:171]
v_cvt_pk_bf16_f32 v252, v248, v249
v_cvt_pk_bf16_f32 v253, v250, v251
v_mfma_f32_16x16x32_bf16 v[168:171], a[92:95], a[52:55], v[168:171]
v_accvgpr_write_b32 a236, v252
v_accvgpr_write_b32 a237, v253
v_mfma_f32_16x16x32_bf16 v[176:179], a[92:95], a[60:63], v[176:179]
s_add_u32 m0, s76, 32768
v_accvgpr_write_b32 a238, v254
v_accvgpr_write_b32 a239, v255
v_mfma_f32_16x16x32_bf16 v[176:179], a[88:91], a[56:59], v[176:179]
s_add_u32 s64, s72, 384
ds_read_b64_tr_b16 a[88:89], v8 offset:0
v_mfma_f32_16x16x32_bf16 v[180:183], a[96:99], a[56:59], v[180:183]
buffer_load_dwordx4 v12, s[48:51], s64 offen lds
v_mfma_f32_16x16x32_bf16 v[180:183], a[100:103], a[60:63], v[180:183]
ds_read_b64_tr_b16 a[90:91], v8 offset:1024
v_mfma_f32_16x16x32_bf16 v[172:175], a[100:103], a[52:55], v[172:175]
ds_read_b64_tr_b16 a[92:93], v8 offset:8192
v_mfma_f32_16x16x32_bf16 v[172:175], a[96:99], a[48:51], v[172:175]
s_add_u32 m0, s76, 33792
ds_read_b64_tr_b16 a[94:95], v8 offset:9216
v_mfma_f32_16x16x32_bf16 v[164:167], a[96:99], a[40:43], v[164:167]
s_add_u32 s64, s72, 16768
v_mfma_f32_16x16x32_bf16 v[164:167], a[100:103], a[44:47], v[164:167]
s_add_u32 s65, s79, 4096
buffer_load_dwordx4 v13, s[48:51], s64 offen lds
v_mfma_f32_16x16x32_bf16 v[156:159], a[100:103], a[36:39], v[156:159]
buffer_store_dwordx4 a[148:151], v16, s[44:47], s65 offen sc1
v_mfma_f32_16x16x32_bf16 v[156:159], a[96:99], a[32:35], v[156:159]
ds_read_b64_tr_b16 a[96:97], v9 offset:0
v_mfma_f32_16x16x32_bf16 v[24:27], a[104:107], a[32:35], v[24:27]
s_add_u32 m0, s76, 34816
ds_read_b64_tr_b16 a[98:99], v9 offset:1024
v_mfma_f32_16x16x32_bf16 v[24:27], a[108:111], a[36:39], v[24:27]
s_add_u32 s64, s72, 131456
ds_read_b64_tr_b16 a[100:101], v9 offset:8192
v_mfma_f32_16x16x32_bf16 v[40:43], a[108:111], a[44:47], v[40:43]
buffer_load_dwordx4 v12, s[48:51], s64 offen lds
v_mfma_f32_16x16x32_bf16 v[40:43], a[104:107], a[40:43], v[40:43]
ds_read_b64_tr_b16 a[102:103], v9 offset:9216
v_mfma_f32_16x16x32_bf16 v[56:59], a[104:107], a[48:51], v[56:59]
v_mfma_f32_16x16x32_bf16 v[56:59], a[108:111], a[52:55], v[56:59]
s_add_u32 m0, s76, 35840
v_mfma_f32_16x16x32_bf16 v[72:75], a[108:111], a[60:63], v[72:75]
s_waitcnt vmcnt(15)
s_add_u32 s64, s72, 147840
ds_read_b128 a[0:3], v2 offset:0
v_mfma_f32_16x16x32_bf16 v[72:75], a[104:107], a[56:59], v[72:75]
buffer_load_dwordx4 v13, s[48:51], s64 offen lds
v_mfma_f32_16x16x32_bf16 v[136:139], a[112:115], a[56:59], v[136:139]
ds_read_b128 a[4:7], v3 offset:0
v_mfma_f32_16x16x32_bf16 v[136:139], a[116:119], a[60:63], v[136:139]
ds_read_b128 a[8:11], v2 offset:2048
v_mfma_f32_16x16x32_bf16 v[120:123], a[116:119], a[52:55], v[120:123]
s_add_u32 m0, s76, 36864
ds_read_b128 a[12:15], v3 offset:2048
v_mfma_f32_16x16x32_bf16 v[120:123], a[112:115], a[48:51], v[120:123]
s_add_u32 s64, s73, 384
ds_read_b128 a[16:19], v2 offset:4096
v_mfma_f32_16x16x32_bf16 v[104:107], a[112:115], a[40:43], v[104:107]
buffer_load_dwordx4 v12, s[48:51], s64 offen lds
v_mfma_f32_16x16x32_bf16 v[104:107], a[116:119], a[44:47], v[104:107]
ds_read_b128 a[20:23], v3 offset:4096
v_mfma_f32_16x16x32_bf16 v[88:91], a[116:119], a[36:39], v[88:91]
ds_read_b128 a[24:27], v2 offset:6144
v_mfma_f32_16x16x32_bf16 v[88:91], a[112:115], a[32:35], v[88:91]
s_waitcnt lgkmcnt(7)
s_add_u32 m0, s76, 37888
ds_read_b128 a[28:31], v3 offset:6144
v_mfma_f32_16x16x32_bf16 v[28:31], a[72:75], a[32:35], v[28:31]
s_add_u32 s64, s73, 16768
ds_read_b64_tr_b16 a[104:105], v10 offset:0
v_mfma_f32_16x16x32_bf16 v[28:31], a[76:79], a[36:39], v[28:31]
buffer_load_dwordx4 v13, s[48:51], s64 offen lds
v_mfma_f32_16x16x32_bf16 v[44:47], a[76:79], a[44:47], v[44:47]
ds_read_b64_tr_b16 a[106:107], v10 offset:1024
v_mfma_f32_16x16x32_bf16 v[44:47], a[72:75], a[40:43], v[44:47]
ds_read_b64_tr_b16 a[108:109], v10 offset:8192
v_mfma_f32_16x16x32_bf16 v[60:63], a[72:75], a[48:51], v[60:63]
s_add_u32 m0, s76, 38912
ds_read_b64_tr_b16 a[110:111], v10 offset:9216
v_mfma_f32_16x16x32_bf16 v[60:63], a[76:79], a[52:55], v[60:63]
s_add_u32 s64, s73, 131456
ds_read_b64_tr_b16 a[112:113], v11 offset:0
v_mfma_f32_16x16x32_bf16 v[76:79], a[76:79], a[60:63], v[76:79]
buffer_load_dwordx4 v12, s[48:51], s64 offen lds
v_mfma_f32_16x16x32_bf16 v[76:79], a[72:75], a[56:59], v[76:79]
ds_read_b64_tr_b16 a[114:115], v11 offset:1024
v_mfma_f32_16x16x32_bf16 v[140:143], a[80:83], a[56:59], v[140:143]
ds_read_b64_tr_b16 a[116:117], v11 offset:8192
v_mfma_f32_16x16x32_bf16 v[140:143], a[84:87], a[60:63], v[140:143]
s_add_u32 m0, s76, 39936
ds_read_b64_tr_b16 a[118:119], v11 offset:9216
v_mfma_f32_16x16x32_bf16 v[124:127], a[84:87], a[52:55], v[124:127]
s_add_u32 s64, s73, 147840
v_mfma_f32_16x16x32_bf16 v[124:127], a[80:83], a[48:51], v[124:127]
buffer_load_dwordx4 v13, s[48:51], s64 offen lds
v_mfma_f32_16x16x32_bf16 v[108:111], a[80:83], a[40:43], v[108:111]
v_mfma_f32_16x16x32_bf16 v[108:111], a[84:87], a[44:47], v[108:111]
v_mfma_f32_16x16x32_bf16 v[92:95], a[84:87], a[36:39], v[92:95]
v_mfma_f32_16x16x32_bf16 v[92:95], a[80:83], a[32:35], v[92:95]
v_mfma_f32_16x16x32_bf16 v[32:35], a[88:91], a[32:35], v[32:35]
v_mfma_f32_16x16x32_bf16 v[32:35], a[92:95], a[36:39], v[32:35]
v_mfma_f32_16x16x32_bf16 v[48:51], a[92:95], a[44:47], v[48:51]
s_waitcnt lgkmcnt(0)
s_barrier
v_mfma_f32_16x16x32_bf16 v[48:51], a[88:91], a[40:43], v[48:51]
s_add_u32 m0, s77, 65536
ds_read_b64_tr_b16 a[72:73], v19 offset:36864
v_mfma_f32_16x16x32_bf16 v[64:67], a[88:91], a[48:51], v[64:67]
s_add_u32 s64, s71, 2097152
ds_read_b64_tr_b16 a[74:75], v19 offset:37120
v_mfma_f32_16x16x32_bf16 v[64:67], a[92:95], a[52:55], v[64:67]
buffer_load_dwordx4 v14, s[56:59], s64 offen lds
v_mfma_f32_16x16x32_bf16 v[80:83], a[92:95], a[60:63], v[80:83]
ds_read_b64_tr_b16 a[76:77], v19 offset:38912
v_mfma_f32_16x16x32_bf16 v[80:83], a[88:91], a[56:59], v[80:83]
ds_read_b64_tr_b16 a[78:79], v19 offset:39168
v_mfma_f32_16x16x32_bf16 v[144:147], a[96:99], a[56:59], v[144:147]
ds_read_b64_tr_b16 a[80:81], v20 offset:36864
v_mfma_f32_16x16x32_bf16 v[144:147], a[100:103], a[60:63], v[144:147]
ds_read_b64_tr_b16 a[82:83], v20 offset:37120
v_mfma_f32_16x16x32_bf16 v[128:131], a[100:103], a[52:55], v[128:131]
ds_read_b64_tr_b16 a[84:85], v20 offset:38912
v_mfma_f32_16x16x32_bf16 v[128:131], a[96:99], a[48:51], v[128:131]
ds_read_b64_tr_b16 a[86:87], v20 offset:39168
v_mfma_f32_16x16x32_bf16 v[112:115], a[96:99], a[40:43], v[112:115]
s_add_u32 m0, s78, 81920
ds_read_b64_tr_b16 a[88:89], v19 offset:40960
v_mfma_f32_16x16x32_bf16 v[112:115], a[100:103], a[44:47], v[112:115]
s_add_u32 s64, s75, 1572864
ds_read_b64_tr_b16 a[90:91], v19 offset:41216
v_mfma_f32_16x16x32_bf16 v[96:99], a[100:103], a[36:39], v[96:99]
s_add_u32 s65, s79, 0
buffer_load_dwordx4 v23, s[60:63], s64 offen lds
v_mfma_f32_16x16x32_bf16 v[96:99], a[96:99], a[32:35], v[96:99]
buffer_store_dwordx4 a[152:155], v16, s[44:47], s65 offen sc1
v_mfma_f32_16x16x32_bf16 v[36:39], a[104:107], a[32:35], v[36:39]
ds_read_b64_tr_b16 a[92:93], v19 offset:43008
v_mfma_f32_16x16x32_bf16 v[36:39], a[108:111], a[36:39], v[36:39]
ds_read_b64_tr_b16 a[94:95], v19 offset:43264
v_mfma_f32_16x16x32_bf16 v[52:55], a[108:111], a[44:47], v[52:55]
ds_read_b64_tr_b16 a[96:97], v20 offset:40960
v_mfma_f32_16x16x32_bf16 v[52:55], a[104:107], a[40:43], v[52:55]
ds_read_b64_tr_b16 a[98:99], v20 offset:41216
v_mfma_f32_16x16x32_bf16 v[68:71], a[104:107], a[48:51], v[68:71]
s_add_u32 m0, s77, 66560
ds_read_b64_tr_b16 a[100:101], v20 offset:43008
v_mfma_f32_16x16x32_bf16 v[68:71], a[108:111], a[52:55], v[68:71]
s_add_u32 s64, s71, 2129920
s_xor_b32 s68, s66, 4096
ds_read_b64_tr_b16 a[102:103], v20 offset:43264
v_mfma_f32_16x16x32_bf16 v[84:87], a[108:111], a[60:63], v[84:87]
s_mov_b64 exec, 1
buffer_atomic_add a251, v1, s[52:55], s68 offen offset:0 sc1
s_mov_b64 exec, -1
v_mfma_f32_16x16x32_bf16 v[84:87], a[104:107], a[56:59], v[84:87]
buffer_load_dwordx4 v14, s[56:59], s64 offen lds
v_mfma_f32_16x16x32_bf16 v[148:151], a[112:115], a[56:59], v[148:151]
ds_read_b64_tr_b16 a[104:105], v19 offset:32768
v_mfma_f32_16x16x32_bf16 v[148:151], a[116:119], a[60:63], v[148:151]
ds_read_b64_tr_b16 a[106:107], v19 offset:33024
v_mfma_f32_16x16x32_bf16 v[132:135], a[116:119], a[52:55], v[132:135]
ds_read_b64_tr_b16 a[108:109], v19 offset:34816
v_mfma_f32_16x16x32_bf16 v[132:135], a[112:115], a[48:51], v[132:135]
ds_read_b64_tr_b16 a[110:111], v19 offset:35072
v_mfma_f32_16x16x32_bf16 v[116:119], a[112:115], a[40:43], v[116:119]
v_mfma_f32_16x16x32_bf16 v[116:119], a[116:119], a[44:47], v[116:119]
v_mfma_f32_16x16x32_bf16 v[100:103], a[116:119], a[36:39], v[100:103]
s_add_u32 m0, s78, 86016
v_mfma_f32_16x16x32_bf16 v[100:103], a[112:115], a[32:35], v[100:103]
s_waitcnt lgkmcnt(4)
s_add_u32 s64, s75, 1574912
ds_read_b64_tr_b16 a[112:113], v20 offset:32768
v_mfma_f32_16x16x32_bf16 v[184:187], a[72:75], a[0:3], v[184:187]
buffer_load_dwordx4 v23, s[60:63], s64 offen lds
v_mfma_f32_16x16x32_bf16 v[184:187], a[76:79], a[4:7], v[184:187]
ds_read_b64_tr_b16 a[114:115], v20 offset:33024
v_mfma_f32_16x16x32_bf16 v[192:195], a[76:79], a[12:15], v[192:195]
ds_read_b64_tr_b16 a[116:117], v20 offset:34816
v_mfma_f32_16x16x32_bf16 v[192:195], a[72:75], a[8:11], v[192:195]
s_add_u32 s17, s78, .-L_pc+6144
ds_read_b64_tr_b16 a[118:119], v20 offset:35072
v_mfma_f32_16x16x32_bf16 v[200:203], a[72:75], a[16:19], v[200:203]
buffer_load_dword a252, v16, s[88:91], s17 offen
v_mfma_f32_16x16x32_bf16 v[200:203], a[76:79], a[20:23], v[200:203]
v_mfma_f32_16x16x32_bf16 v[208:211], a[76:79], a[28:31], v[208:211]
v_mfma_f32_16x16x32_bf16 v[208:211], a[72:75], a[24:27], v[208:211]
ds_read_b64_tr_b16 a[72:73], v4 offset:32768
v_mfma_f32_16x16x32_bf16 v[212:215], a[80:83], a[24:27], v[212:215]
s_add_u32 m0, s77, 67584
ds_read_b64_tr_b16 a[74:75], v4 offset:33792
v_mfma_f32_16x16x32_bf16 v[212:215], a[84:87], a[28:31], v[212:215]
s_add_u32 s64, s71, 2162688
ds_read_b64_tr_b16 a[76:77], v4 offset:40960
v_mfma_f32_16x16x32_bf16 v[204:207], a[84:87], a[20:23], v[204:207]
buffer_load_dwordx4 v15, s[56:59], s64 offen lds
v_mfma_f32_16x16x32_bf16 v[204:207], a[80:83], a[16:19], v[204:207]
ds_read_b64_tr_b16 a[78:79], v4 offset:41984
v_mfma_f32_16x16x32_bf16 v[196:199], a[80:83], a[8:11], v[196:199]
v_mfma_f32_16x16x32_bf16 v[196:199], a[84:87], a[12:15], v[196:199]
v_mfma_f32_16x16x32_bf16 v[188:191], a[84:87], a[4:7], v[188:191]
v_mfma_f32_16x16x32_bf16 v[188:191], a[80:83], a[0:3], v[188:191]
ds_read_b64_tr_b16 a[80:81], v5 offset:32768
v_mfma_f32_16x16x32_bf16 v[216:219], a[0:3], a[88:91], v[216:219]
ds_read_b64_tr_b16 a[82:83], v5 offset:33792
v_mfma_f32_16x16x32_bf16 v[216:219], a[4:7], a[92:95], v[216:219]
s_add_u32 m0, s78, 90112
ds_read_b64_tr_b16 a[84:85], v5 offset:40960
v_mfma_f32_16x16x32_bf16 v[224:227], a[12:15], a[92:95], v[224:227]
s_add_u32 s64, s75, 1576960
ds_read_b64_tr_b16 a[86:87], v5 offset:41984
v_mfma_f32_16x16x32_bf16 v[224:227], a[8:11], a[88:91], v[224:227]
buffer_load_dwordx4 v23, s[60:63], s64 offen lds
v_mfma_f32_16x16x32_bf16 v[232:235], a[16:19], a[88:91], v[232:235]
v_mfma_f32_16x16x32_bf16 v[232:235], a[20:23], a[92:95], v[232:235]
v_mfma_f32_16x16x32_bf16 v[240:243], a[28:31], a[92:95], v[240:243]
v_mfma_f32_16x16x32_bf16 v[240:243], a[24:27], a[88:91], v[240:243]
ds_read_b64_tr_b16 a[88:89], v6 offset:32768
v_mfma_f32_16x16x32_bf16 v[244:247], a[24:27], a[96:99], v[244:247]
ds_read_b64_tr_b16 a[90:91], v6 offset:33792
v_mfma_f32_16x16x32_bf16 v[244:247], a[28:31], a[100:103], v[244:247]
ds_read_b64_tr_b16 a[92:93], v6 offset:40960
v_add_u32 v19, 0x8000, v19
v_mfma_f32_16x16x32_bf16 v[236:239], a[20:23], a[100:103], v[236:239]
s_add_u32 m0, s77, 68608
ds_read_b64_tr_b16 a[94:95], v6 offset:41984
v_mfma_f32_16x16x32_bf16 v[236:239], a[16:19], a[96:99], v[236:239]
s_add_u32 s64, s71, 2195456
v_mfma_f32_16x16x32_bf16 v[228:231], a[8:11], a[96:99], v[228:231]
buffer_load_dwordx4 v15, s[56:59], s64 offen lds
v_mfma_f32_16x16x32_bf16 v[228:231], a[12:15], a[100:103], v[228:231]
v_mfma_f32_16x16x32_bf16 v[220:223], a[4:7], a[100:103], v[220:223]
v_mfma_f32_16x16x32_bf16 v[220:223], a[0:3], a[96:99], v[220:223]
s_waitcnt lgkmcnt(4)
s_add_u32 s65, s79, 17408
ds_read_b64_tr_b16 a[96:97], v7 offset:32768
v_mfma_f32_16x16x32_bf16 v[152:155], a[104:107], a[0:3], v[152:155]
buffer_store_dwordx4 a[156:159], v16, s[44:47], s65 offen sc1
v_mfma_f32_16x16x32_bf16 v[152:155], a[108:111], a[4:7], v[152:155]
ds_read_b64_tr_b16 a[98:99], v7 offset:33792
v_add_u32 v20, 0x8000, v20
v_mfma_f32_16x16x32_bf16 v[160:163], a[108:111], a[12:15], v[160:163]
ds_read_b64_tr_b16 a[100:101], v7 offset:40960
v_mfma_f32_16x16x32_bf16 v[160:163], a[104:107], a[8:11], v[160:163]
ds_read_b64_tr_b16 a[102:103], v7 offset:41984
v_mfma_f32_16x16x32_bf16 v[168:171], a[104:107], a[16:19], v[168:171]
v_mfma_f32_16x16x32_bf16 v[168:171], a[108:111], a[20:23], v[168:171]
v_mfma_f32_16x16x32_bf16 v[176:179], a[108:111], a[28:31], v[176:179]
s_add_u32 m0, s76, 0
v_mfma_f32_16x16x32_bf16 v[176:179], a[104:107], a[24:27], v[176:179]
s_add_u32 s64, s72, 512
ds_read_b64_tr_b16 a[104:105], v8 offset:32768
v_mfma_f32_16x16x32_bf16 v[180:183], a[112:115], a[24:27], v[180:183]
buffer_load_dwordx4 v12, s[48:51], s64 offen lds
v_mfma_f32_16x16x32_bf16 v[180:183], a[116:119], a[28:31], v[180:183]
ds_read_b64_tr_b16 a[106:107], v8 offset:33792
v_add_u32 v4, 0x8000, v4
v_mfma_f32_16x16x32_bf16 v[172:175], a[116:119], a[20:23], v[172:175]
ds_read_b64_tr_b16 a[108:109], v8 offset:40960
v_mfma_f32_16x16x32_bf16 v[172:175], a[112:115], a[16:19], v[172:175]
s_add_u32 m0, s76, 1024
ds_read_b64_tr_b16 a[110:111], v8 offset:41984
v_mfma_f32_16x16x32_bf16 v[164:167], a[112:115], a[8:11], v[164:167]
s_add_u32 s64, s72, 16896
v_mfma_f32_16x16x32_bf16 v[164:167], a[116:119], a[12:15], v[164:167]
buffer_load_dwordx4 v13, s[48:51], s64 offen lds
v_mfma_f32_16x16x32_bf16 v[156:159], a[116:119], a[4:7], v[156:159]
v_mfma_f32_16x16x32_bf16 v[156:159], a[112:115], a[0:3], v[156:159]
ds_read_b64_tr_b16 a[112:113], v9 offset:32768
v_mfma_f32_16x16x32_bf16 v[24:27], a[72:75], a[0:3], v[24:27]
s_add_u32 m0, s76, 2048
ds_read_b64_tr_b16 a[114:115], v9 offset:33792
v_mfma_f32_16x16x32_bf16 v[24:27], a[76:79], a[4:7], v[24:27]
s_add_u32 s64, s72, 131584
ds_read_b64_tr_b16 a[116:117], v9 offset:40960
v_add_u32 v5, 0x8000, v5
v_mfma_f32_16x16x32_bf16 v[40:43], a[76:79], a[12:15], v[40:43]
buffer_load_dwordx4 v12, s[48:51], s64 offen lds
v_mfma_f32_16x16x32_bf16 v[40:43], a[72:75], a[8:11], v[40:43]
ds_read_b64_tr_b16 a[118:119], v9 offset:41984
v_mfma_f32_16x16x32_bf16 v[56:59], a[72:75], a[16:19], v[56:59]
v_mfma_f32_16x16x32_bf16 v[56:59], a[76:79], a[20:23], v[56:59]
s_add_u32 m0, s76, 3072
v_mfma_f32_16x16x32_bf16 v[72:75], a[76:79], a[28:31], v[72:75]
s_waitcnt vmcnt(14)
s_add_u32 s64, s72, 147968
ds_read_b128 a[32:35], v2 offset:32768
v_mfma_f32_16x16x32_bf16 v[72:75], a[72:75], a[24:27], v[72:75]
buffer_load_dwordx4 v13, s[48:51], s64 offen lds
v_mfma_f32_16x16x32_bf16 v[136:139], a[80:83], a[24:27], v[136:139]
ds_read_b128 a[36:39], v3 offset:32768
v_mfma_f32_16x16x32_bf16 v[136:139], a[84:87], a[28:31], v[136:139]
ds_read_b128 a[40:43], v2 offset:34816
v_add_u32 v6, 0x8000, v6
v_mfma_f32_16x16x32_bf16 v[120:123], a[84:87], a[20:23], v[120:123]
s_add_u32 m0, s76, 4096
ds_read_b128 a[44:47], v3 offset:34816
v_mfma_f32_16x16x32_bf16 v[120:123], a[80:83], a[16:19], v[120:123]
s_add_u32 s64, s73, 512
ds_read_b128 a[48:51], v2 offset:36864
v_mfma_f32_16x16x32_bf16 v[104:107], a[80:83], a[8:11], v[104:107]
buffer_load_dwordx4 v12, s[48:51], s64 offen lds
v_mfma_f32_16x16x32_bf16 v[104:107], a[84:87], a[12:15], v[104:107]
ds_read_b128 a[52:55], v3 offset:36864
v_mfma_f32_16x16x32_bf16 v[88:91], a[84:87], a[4:7], v[88:91]
ds_read_b128 a[56:59], v2 offset:38912
v_mfma_f32_16x16x32_bf16 v[88:91], a[80:83], a[0:3], v[88:91]
s_waitcnt lgkmcnt(7)
s_add_u32 m0, s76, 5120
ds_read_b128 a[60:63], v3 offset:38912
v_mfma_f32_16x16x32_bf16 v[28:31], a[88:91], a[0:3], v[28:31]
s_add_u32 s64, s73, 16896
ds_read_b64_tr_b16 a[72:73], v10 offset:32768
v_mfma_f32_16x16x32_bf16 v[28:31], a[92:95], a[4:7], v[28:31]
buffer_load_dwordx4 v13, s[48:51], s64 offen lds
v_mfma_f32_16x16x32_bf16 v[44:47], a[92:95], a[12:15], v[44:47]
ds_read_b64_tr_b16 a[74:75], v10 offset:33792
v_add_u32 v7, 0x8000, v7
v_mfma_f32_16x16x32_bf16 v[44:47], a[88:91], a[8:11], v[44:47]
ds_read_b64_tr_b16 a[76:77], v10 offset:40960
v_mfma_f32_16x16x32_bf16 v[60:63], a[88:91], a[16:19], v[60:63]
s_add_u32 m0, s76, 6144
ds_read_b64_tr_b16 a[78:79], v10 offset:41984
v_mfma_f32_16x16x32_bf16 v[60:63], a[92:95], a[20:23], v[60:63]
s_add_u32 s64, s73, 131584
ds_read_b64_tr_b16 a[80:81], v11 offset:32768
v_mfma_f32_16x16x32_bf16 v[76:79], a[92:95], a[28:31], v[76:79]
buffer_load_dwordx4 v12, s[48:51], s64 offen lds
v_mfma_f32_16x16x32_bf16 v[76:79], a[88:91], a[24:27], v[76:79]
ds_read_b64_tr_b16 a[82:83], v11 offset:33792
v_mfma_f32_16x16x32_bf16 v[140:143], a[96:99], a[24:27], v[140:143]
ds_read_b64_tr_b16 a[84:85], v11 offset:40960
v_mfma_f32_16x16x32_bf16 v[140:143], a[100:103], a[28:31], v[140:143]
s_add_u32 m0, s76, 7168
ds_read_b64_tr_b16 a[86:87], v11 offset:41984
v_add_u32 v8, 0x8000, v8
v_mfma_f32_16x16x32_bf16 v[124:127], a[100:103], a[20:23], v[124:127]
s_add_u32 s64, s73, 147968
v_mfma_f32_16x16x32_bf16 v[124:127], a[96:99], a[16:19], v[124:127]
buffer_load_dwordx4 v13, s[48:51], s64 offen lds
v_mfma_f32_16x16x32_bf16 v[108:111], a[96:99], a[8:11], v[108:111]
v_mfma_f32_16x16x32_bf16 v[108:111], a[100:103], a[12:15], v[108:111]
v_mfma_f32_16x16x32_bf16 v[92:95], a[100:103], a[4:7], v[92:95]
v_add_u32 v9, 0x8000, v9
v_add_u32 v10, 0x8000, v10
v_mfma_f32_16x16x32_bf16 v[92:95], a[96:99], a[0:3], v[92:95]
v_add_u32 v11, 0x8000, v11
v_mfma_f32_16x16x32_bf16 v[32:35], a[104:107], a[0:3], v[32:35]
s_add_u32 s65, s79, 5120
v_mfma_f32_16x16x32_bf16 v[32:35], a[108:111], a[4:7], v[32:35]
buffer_store_dwordx4 a[160:163], v16, s[44:47], s65 offen sc1
v_mfma_f32_16x16x32_bf16 v[48:51], a[108:111], a[12:15], v[48:51]
s_waitcnt lgkmcnt(0)
s_barrier
v_mfma_f32_16x16x32_bf16 v[48:51], a[104:107], a[8:11], v[48:51]
s_add_u32 m0, s77, 98304
ds_read_b64_tr_b16 a[88:89], v19 offset:36864
v_mfma_f32_16x16x32_bf16 v[64:67], a[104:107], a[16:19], v[64:67]
s_add_u32 s64, s71, 2621440
ds_read_b64_tr_b16 a[90:91], v19 offset:37120
v_mfma_f32_16x16x32_bf16 v[64:67], a[108:111], a[20:23], v[64:67]
buffer_load_dwordx4 v14, s[56:59], s64 offen lds
v_mfma_f32_16x16x32_bf16 v[80:83], a[108:111], a[28:31], v[80:83]
ds_read_b64_tr_b16 a[92:93], v19 offset:38912
v_mfma_f32_16x16x32_bf16 v[80:83], a[104:107], a[24:27], v[80:83]
ds_read_b64_tr_b16 a[94:95], v19 offset:39168
v_mfma_f32_16x16x32_bf16 v[144:147], a[112:115], a[24:27], v[144:147]
ds_read_b64_tr_b16 a[96:97], v20 offset:36864
v_mfma_f32_16x16x32_bf16 v[144:147], a[116:119], a[28:31], v[144:147]
ds_read_b64_tr_b16 a[98:99], v20 offset:37120
v_mfma_f32_16x16x32_bf16 v[128:131], a[116:119], a[20:23], v[128:131]
ds_read_b64_tr_b16 a[100:101], v20 offset:38912
v_mfma_f32_16x16x32_bf16 v[128:131], a[112:115], a[16:19], v[128:131]
ds_read_b64_tr_b16 a[102:103], v20 offset:39168
v_mfma_f32_16x16x32_bf16 v[112:115], a[112:115], a[8:11], v[112:115]
s_add_u32 m0, s78, 114688
ds_read_b64_tr_b16 a[104:105], v19 offset:40960
v_mfma_f32_16x16x32_bf16 v[112:115], a[116:119], a[12:15], v[112:115]
s_add_u32 s64, s75, 1966080
ds_read_b64_tr_b16 a[106:107], v19 offset:41216
v_mfma_f32_16x16x32_bf16 v[96:99], a[116:119], a[4:7], v[96:99]
buffer_load_dwordx4 v23, s[60:63], s64 offen lds
v_mfma_f32_16x16x32_bf16 v[96:99], a[112:115], a[0:3], v[96:99]
ds_read_b64_tr_b16 a[108:109], v19 offset:43008
v_mfma_f32_16x16x32_bf16 v[36:39], a[72:75], a[0:3], v[36:39]
ds_read_b64_tr_b16 a[110:111], v19 offset:43264
v_mfma_f32_16x16x32_bf16 v[36:39], a[76:79], a[4:7], v[36:39]
ds_read_b64_tr_b16 a[112:113], v20 offset:40960
v_mfma_f32_16x16x32_bf16 v[52:55], a[76:79], a[12:15], v[52:55]
ds_read_b64_tr_b16 a[114:115], v20 offset:41216
v_mfma_f32_16x16x32_bf16 v[52:55], a[72:75], a[8:11], v[52:55]
ds_read_b64_tr_b16 a[116:117], v20 offset:43008
v_mfma_f32_16x16x32_bf16 v[68:71], a[72:75], a[16:19], v[68:71]
s_add_u32 m0, s77, 99328
ds_read_b64_tr_b16 a[118:119], v20 offset:43264
v_mfma_f32_16x16x32_bf16 v[68:71], a[76:79], a[20:23], v[68:71]
s_add_u32 s64, s71, 2654208
s_xor_b32 s68, s66, 8192
v_mfma_f32_16x16x32_bf16 v[84:87], a[76:79], a[28:31], v[84:87]
s_mov_b64 exec, 1
buffer_atomic_add a251, v1, s[52:55], s68 offen offset:0 sc1
s_mov_b64 exec, -1
v_mfma_f32_16x16x32_bf16 v[84:87], a[72:75], a[24:27], v[84:87]
buffer_load_dwordx4 v14, s[56:59], s64 offen lds
v_mfma_f32_16x16x32_bf16 v[148:151], a[80:83], a[24:27], v[148:151]
ds_read_b64_tr_b16 a[72:73], v19 offset:32768
v_mfma_f32_16x16x32_bf16 v[148:151], a[84:87], a[28:31], v[148:151]
ds_read_b64_tr_b16 a[74:75], v19 offset:33024
v_mfma_f32_16x16x32_bf16 v[132:135], a[84:87], a[20:23], v[132:135]
ds_read_b64_tr_b16 a[76:77], v19 offset:34816
v_mfma_f32_16x16x32_bf16 v[132:135], a[80:83], a[16:19], v[132:135]
ds_read_b64_tr_b16 a[78:79], v19 offset:35072
v_mfma_f32_16x16x32_bf16 v[116:119], a[80:83], a[8:11], v[116:119]
v_mfma_f32_16x16x32_bf16 v[116:119], a[84:87], a[12:15], v[116:119]
v_mfma_f32_16x16x32_bf16 v[100:103], a[84:87], a[4:7], v[100:103]
s_add_u32 m0, s78, 118784
v_mfma_f32_16x16x32_bf16 v[100:103], a[80:83], a[0:3], v[100:103]
s_waitcnt lgkmcnt(4)
s_add_u32 s64, s75, 1968128
ds_read_b64_tr_b16 a[80:81], v20 offset:32768
v_mfma_f32_16x16x32_bf16 v[184:187], a[88:91], a[32:35], v[184:187]
buffer_load_dwordx4 v23, s[60:63], s64 offen lds
v_mfma_f32_16x16x32_bf16 v[184:187], a[92:95], a[36:39], v[184:187]
ds_read_b64_tr_b16 a[82:83], v20 offset:33024
v_mfma_f32_16x16x32_bf16 v[192:195], a[92:95], a[44:47], v[192:195]
ds_read_b64_tr_b16 a[84:85], v20 offset:34816
v_mfma_f32_16x16x32_bf16 v[192:195], a[88:91], a[40:43], v[192:195]
ds_read_b64_tr_b16 a[86:87], v20 offset:35072
v_mfma_f32_16x16x32_bf16 v[200:203], a[88:91], a[48:51], v[200:203]
v_mfma_f32_16x16x32_bf16 v[200:203], a[92:95], a[52:55], v[200:203]
v_mfma_f32_16x16x32_bf16 v[208:211], a[92:95], a[60:63], v[208:211]
v_mfma_f32_16x16x32_bf16 v[208:211], a[88:91], a[56:59], v[208:211]
ds_read_b64_tr_b16 a[88:89], v4 offset:32768
v_mfma_f32_16x16x32_bf16 v[212:215], a[96:99], a[56:59], v[212:215]
s_add_u32 m0, s77, 100352
ds_read_b64_tr_b16 a[90:91], v4 offset:33792
v_mfma_f32_16x16x32_bf16 v[212:215], a[100:103], a[60:63], v[212:215]
s_add_u32 s64, s71, 2686976
ds_read_b64_tr_b16 a[92:93], v4 offset:40960
v_mfma_f32_16x16x32_bf16 v[204:207], a[100:103], a[52:55], v[204:207]
buffer_load_dwordx4 v15, s[56:59], s64 offen lds
v_mfma_f32_16x16x32_bf16 v[204:207], a[96:99], a[48:51], v[204:207]
ds_read_b64_tr_b16 a[94:95], v4 offset:41984
v_mfma_f32_16x16x32_bf16 v[196:199], a[96:99], a[40:43], v[196:199]
v_mfma_f32_16x16x32_bf16 v[196:199], a[100:103], a[44:47], v[196:199]
v_mfma_f32_16x16x32_bf16 v[188:191], a[100:103], a[36:39], v[188:191]
v_mfma_f32_16x16x32_bf16 v[188:191], a[96:99], a[32:35], v[188:191]
ds_read_b64_tr_b16 a[96:97], v5 offset:32768
v_mfma_f32_16x16x32_bf16 v[216:219], a[32:35], a[104:107], v[216:219]
ds_read_b64_tr_b16 a[98:99], v5 offset:33792
v_mfma_f32_16x16x32_bf16 v[216:219], a[36:39], a[108:111], v[216:219]
s_add_u32 m0, s78, 122880
ds_read_b64_tr_b16 a[100:101], v5 offset:40960
v_mfma_f32_16x16x32_bf16 v[224:227], a[44:47], a[108:111], v[224:227]
s_add_u32 s64, s75, 1970176
ds_read_b64_tr_b16 a[102:103], v5 offset:41984
v_mfma_f32_16x16x32_bf16 v[224:227], a[40:43], a[104:107], v[224:227]
s_add_u32 s65, s79, 1024
buffer_load_dwordx4 v23, s[60:63], s64 offen lds
v_mfma_f32_16x16x32_bf16 v[232:235], a[48:51], a[104:107], v[232:235]
buffer_store_dwordx4 a[164:167], v16, s[44:47], s65 offen sc1
v_mfma_f32_16x16x32_bf16 v[232:235], a[52:55], a[108:111], v[232:235]
v_mfma_f32_16x16x32_bf16 v[240:243], a[60:63], a[108:111], v[240:243]
v_mfma_f32_16x16x32_bf16 v[240:243], a[56:59], a[104:107], v[240:243]
ds_read_b64_tr_b16 a[104:105], v6 offset:32768
v_mfma_f32_16x16x32_bf16 v[244:247], a[56:59], a[112:115], v[244:247]
ds_read_b64_tr_b16 a[106:107], v6 offset:33792
v_mfma_f32_16x16x32_bf16 v[244:247], a[60:63], a[116:119], v[244:247]
ds_read_b64_tr_b16 a[108:109], v6 offset:40960
v_subrev_u32 v19, 0x8000, v19
v_mfma_f32_16x16x32_bf16 v[236:239], a[52:55], a[116:119], v[236:239]
s_add_u32 m0, s77, 101376
ds_read_b64_tr_b16 a[110:111], v6 offset:41984
v_mfma_f32_16x16x32_bf16 v[236:239], a[48:51], a[112:115], v[236:239]
s_add_u32 s64, s71, 2719744
v_mfma_f32_16x16x32_bf16 v[228:231], a[40:43], a[112:115], v[228:231]
buffer_load_dwordx4 v15, s[56:59], s64 offen lds
v_mfma_f32_16x16x32_bf16 v[228:231], a[44:47], a[116:119], v[228:231]
v_mfma_f32_16x16x32_bf16 v[220:223], a[36:39], a[116:119], v[220:223]
v_mfma_f32_16x16x32_bf16 v[220:223], a[32:35], a[112:115], v[220:223]
s_waitcnt lgkmcnt(4)
ds_read_b64_tr_b16 a[112:113], v7 offset:32768
v_mfma_f32_16x16x32_bf16 v[152:155], a[72:75], a[32:35], v[152:155]
ds_read_b64_tr_b16 a[114:115], v7 offset:33792
v_mfma_f32_16x16x32_bf16 v[152:155], a[76:79], a[36:39], v[152:155]
ds_read_b64_tr_b16 a[116:117], v7 offset:40960
v_subrev_u32 v20, 0x8000, v20
v_mfma_f32_16x16x32_bf16 v[160:163], a[76:79], a[44:47], v[160:163]
ds_read_b64_tr_b16 a[118:119], v7 offset:41984
v_mfma_f32_16x16x32_bf16 v[160:163], a[72:75], a[40:43], v[160:163]
v_mfma_f32_16x16x32_bf16 v[168:171], a[72:75], a[48:51], v[168:171]
v_mfma_f32_16x16x32_bf16 v[168:171], a[76:79], a[52:55], v[168:171]
v_mfma_f32_16x16x32_bf16 v[176:179], a[76:79], a[60:63], v[176:179]
s_add_u32 m0, s76, 32768
v_mfma_f32_16x16x32_bf16 v[176:179], a[72:75], a[56:59], v[176:179]
s_add_u32 s64, s72, 640
ds_read_b64_tr_b16 a[72:73], v8 offset:32768
v_mfma_f32_16x16x32_bf16 v[180:183], a[80:83], a[56:59], v[180:183]
buffer_load_dwordx4 v12, s[48:51], s64 offen lds
v_mfma_f32_16x16x32_bf16 v[180:183], a[84:87], a[60:63], v[180:183]
ds_read_b64_tr_b16 a[74:75], v8 offset:33792
v_subrev_u32 v4, 0x8000, v4
v_mfma_f32_16x16x32_bf16 v[172:175], a[84:87], a[52:55], v[172:175]
ds_read_b64_tr_b16 a[76:77], v8 offset:40960
v_mfma_f32_16x16x32_bf16 v[172:175], a[80:83], a[48:51], v[172:175]
s_add_u32 m0, s76, 33792
ds_read_b64_tr_b16 a[78:79], v8 offset:41984
v_mfma_f32_16x16x32_bf16 v[164:167], a[80:83], a[40:43], v[164:167]
s_add_u32 s64, s72, 17024
v_mfma_f32_16x16x32_bf16 v[164:167], a[84:87], a[44:47], v[164:167]
buffer_load_dwordx4 v13, s[48:51], s64 offen lds
v_mfma_f32_16x16x32_bf16 v[156:159], a[84:87], a[36:39], v[156:159]
v_mfma_f32_16x16x32_bf16 v[156:159], a[80:83], a[32:35], v[156:159]
ds_read_b64_tr_b16 a[80:81], v9 offset:32768
v_mfma_f32_16x16x32_bf16 v[24:27], a[88:91], a[32:35], v[24:27]
s_add_u32 m0, s76, 34816
ds_read_b64_tr_b16 a[82:83], v9 offset:33792
v_mfma_f32_16x16x32_bf16 v[24:27], a[92:95], a[36:39], v[24:27]
s_add_u32 s64, s72, 131712
ds_read_b64_tr_b16 a[84:85], v9 offset:40960
v_subrev_u32 v5, 0x8000, v5
v_mfma_f32_16x16x32_bf16 v[40:43], a[92:95], a[44:47], v[40:43]
buffer_load_dwordx4 v12, s[48:51], s64 offen lds
v_mfma_f32_16x16x32_bf16 v[40:43], a[88:91], a[40:43], v[40:43]
ds_read_b64_tr_b16 a[86:87], v9 offset:41984
v_mfma_f32_16x16x32_bf16 v[56:59], a[88:91], a[48:51], v[56:59]
v_mfma_f32_16x16x32_bf16 v[56:59], a[92:95], a[52:55], v[56:59]
s_add_u32 m0, s76, 35840
v_mfma_f32_16x16x32_bf16 v[72:75], a[92:95], a[60:63], v[72:75]
s_waitcnt vmcnt(13)
s_add_u32 s64, s72, 148096
ds_read_b128 a[0:3], v2 offset:0
v_mfma_f32_16x16x32_bf16 v[72:75], a[88:91], a[56:59], v[72:75]
buffer_load_dwordx4 v13, s[48:51], s64 offen lds
v_mfma_f32_16x16x32_bf16 v[136:139], a[96:99], a[56:59], v[136:139]
ds_read_b128 a[4:7], v3 offset:0
v_mfma_f32_16x16x32_bf16 v[136:139], a[100:103], a[60:63], v[136:139]
ds_read_b128 a[8:11], v2 offset:2048
v_subrev_u32 v6, 0x8000, v6
v_mfma_f32_16x16x32_bf16 v[120:123], a[100:103], a[52:55], v[120:123]
s_add_u32 m0, s76, 36864
ds_read_b128 a[12:15], v3 offset:2048
v_mfma_f32_16x16x32_bf16 v[120:123], a[96:99], a[48:51], v[120:123]
s_add_u32 s64, s73, 640
ds_read_b128 a[16:19], v2 offset:4096
v_mfma_f32_16x16x32_bf16 v[104:107], a[96:99], a[40:43], v[104:107]
buffer_load_dwordx4 v12, s[48:51], s64 offen lds
v_mfma_f32_16x16x32_bf16 v[104:107], a[100:103], a[44:47], v[104:107]
ds_read_b128 a[20:23], v3 offset:4096
v_mfma_f32_16x16x32_bf16 v[88:91], a[100:103], a[36:39], v[88:91]
ds_read_b128 a[24:27], v2 offset:6144
v_mfma_f32_16x16x32_bf16 v[88:91], a[96:99], a[32:35], v[88:91]
s_waitcnt lgkmcnt(7)
s_add_u32 m0, s76, 37888
ds_read_b128 a[28:31], v3 offset:6144
v_mfma_f32_16x16x32_bf16 v[28:31], a[104:107], a[32:35], v[28:31]
s_add_u32 s64, s73, 17024
ds_read_b64_tr_b16 a[88:89], v10 offset:32768
v_mfma_f32_16x16x32_bf16 v[28:31], a[108:111], a[36:39], v[28:31]
buffer_load_dwordx4 v13, s[48:51], s64 offen lds
v_mfma_f32_16x16x32_bf16 v[44:47], a[108:111], a[44:47], v[44:47]
ds_read_b64_tr_b16 a[90:91], v10 offset:33792
v_subrev_u32 v7, 0x8000, v7
v_mfma_f32_16x16x32_bf16 v[44:47], a[104:107], a[40:43], v[44:47]
s_add_u32 s65, s79, 18432
ds_read_b64_tr_b16 a[92:93], v10 offset:40960
v_mfma_f32_16x16x32_bf16 v[60:63], a[104:107], a[48:51], v[60:63]
s_add_u32 m0, s76, 38912
buffer_store_dwordx4 a[168:171], v16, s[44:47], s65 offen sc1
v_mfma_f32_16x16x32_bf16 v[60:63], a[108:111], a[52:55], v[60:63]
s_add_u32 s64, s73, 131712
ds_read_b64_tr_b16 a[94:95], v10 offset:41984
v_mfma_f32_16x16x32_bf16 v[76:79], a[108:111], a[60:63], v[76:79]
buffer_load_dwordx4 v12, s[48:51], s64 offen lds
v_mfma_f32_16x16x32_bf16 v[76:79], a[104:107], a[56:59], v[76:79]
ds_read_b64_tr_b16 a[96:97], v11 offset:32768
v_mfma_f32_16x16x32_bf16 v[140:143], a[112:115], a[56:59], v[140:143]
ds_read_b64_tr_b16 a[98:99], v11 offset:33792
v_mfma_f32_16x16x32_bf16 v[140:143], a[116:119], a[60:63], v[140:143]
s_add_u32 m0, s76, 39936
ds_read_b64_tr_b16 a[100:101], v11 offset:40960
v_subrev_u32 v8, 0x8000, v8
v_mfma_f32_16x16x32_bf16 v[124:127], a[116:119], a[52:55], v[124:127]
s_add_u32 s64, s73, 148096
ds_read_b64_tr_b16 a[102:103], v11 offset:41984
v_mfma_f32_16x16x32_bf16 v[124:127], a[112:115], a[48:51], v[124:127]
buffer_load_dwordx4 v13, s[48:51], s64 offen lds
v_mfma_f32_16x16x32_bf16 v[108:111], a[112:115], a[40:43], v[108:111]
v_mfma_f32_16x16x32_bf16 v[108:111], a[116:119], a[44:47], v[108:111]
v_mfma_f32_16x16x32_bf16 v[92:95], a[116:119], a[36:39], v[92:95]
v_subrev_u32 v9, 0x8000, v9
v_subrev_u32 v10, 0x8000, v10
v_mfma_f32_16x16x32_bf16 v[92:95], a[112:115], a[32:35], v[92:95]
v_subrev_u32 v11, 0x8000, v11
v_mfma_f32_16x16x32_bf16 v[32:35], a[72:75], a[32:35], v[32:35]
v_mfma_f32_16x16x32_bf16 v[32:35], a[76:79], a[36:39], v[32:35]
v_mfma_f32_16x16x32_bf16 v[48:51], a[76:79], a[44:47], v[48:51]
s_waitcnt lgkmcnt(0)
s_barrier
v_mfma_f32_16x16x32_bf16 v[48:51], a[72:75], a[40:43], v[48:51]
s_add_u32 m0, s77, 131072
ds_read_b64_tr_b16 a[104:105], v19 offset:4096
v_mfma_f32_16x16x32_bf16 v[64:67], a[72:75], a[48:51], v[64:67]
s_add_u32 s64, s71, 3145728
ds_read_b64_tr_b16 a[106:107], v19 offset:4352
v_mfma_f32_16x16x32_bf16 v[64:67], a[76:79], a[52:55], v[64:67]
buffer_load_dwordx4 v14, s[56:59], s64 offen lds
v_mfma_f32_16x16x32_bf16 v[80:83], a[76:79], a[60:63], v[80:83]
ds_read_b64_tr_b16 a[108:109], v19 offset:6144
v_mfma_f32_16x16x32_bf16 v[80:83], a[72:75], a[56:59], v[80:83]
ds_read_b64_tr_b16 a[110:111], v19 offset:6400
v_mfma_f32_16x16x32_bf16 v[144:147], a[80:83], a[56:59], v[144:147]
ds_read_b64_tr_b16 a[112:113], v20 offset:4096
v_mfma_f32_16x16x32_bf16 v[144:147], a[84:87], a[60:63], v[144:147]
ds_read_b64_tr_b16 a[114:115], v20 offset:4352
v_mfma_f32_16x16x32_bf16 v[128:131], a[84:87], a[52:55], v[128:131]
ds_read_b64_tr_b16 a[116:117], v20 offset:6144
v_mfma_f32_16x16x32_bf16 v[128:131], a[80:83], a[48:51], v[128:131]
ds_read_b64_tr_b16 a[118:119], v20 offset:6400
v_mfma_f32_16x16x32_bf16 v[112:115], a[80:83], a[40:43], v[112:115]
s_add_u32 m0, s78, 147456
ds_read_b64_tr_b16 a[72:73], v19 offset:8192
v_mfma_f32_16x16x32_bf16 v[112:115], a[84:87], a[44:47], v[112:115]
s_add_u32 s64, s75, 2359296
ds_read_b64_tr_b16 a[74:75], v19 offset:8448
v_mfma_f32_16x16x32_bf16 v[96:99], a[84:87], a[36:39], v[96:99]
buffer_load_dwordx4 v23, s[60:63], s64 offen lds
v_mfma_f32_16x16x32_bf16 v[96:99], a[80:83], a[32:35], v[96:99]
ds_read_b64_tr_b16 a[76:77], v19 offset:10240
v_mfma_f32_16x16x32_bf16 v[36:39], a[88:91], a[32:35], v[36:39]
ds_read_b64_tr_b16 a[78:79], v19 offset:10496
v_mfma_f32_16x16x32_bf16 v[36:39], a[92:95], a[36:39], v[36:39]
ds_read_b64_tr_b16 a[80:81], v20 offset:8192
v_mfma_f32_16x16x32_bf16 v[52:55], a[92:95], a[44:47], v[52:55]
ds_read_b64_tr_b16 a[82:83], v20 offset:8448
v_mfma_f32_16x16x32_bf16 v[52:55], a[88:91], a[40:43], v[52:55]
ds_read_b64_tr_b16 a[84:85], v20 offset:10240
v_mfma_f32_16x16x32_bf16 v[68:71], a[88:91], a[48:51], v[68:71]
s_add_u32 m0, s77, 132096
ds_read_b64_tr_b16 a[86:87], v20 offset:10496
v_mfma_f32_16x16x32_bf16 v[68:71], a[92:95], a[52:55], v[68:71]
s_add_u32 s64, s71, 3178496
s_xor_b32 s68, s66, 12288
v_mfma_f32_16x16x32_bf16 v[84:87], a[92:95], a[60:63], v[84:87]
s_mov_b64 exec, 1
buffer_atomic_add a251, v1, s[52:55], s68 offen offset:0 sc1
s_mov_b64 exec, -1
v_mfma_f32_16x16x32_bf16 v[84:87], a[88:91], a[56:59], v[84:87]
buffer_load_dwordx4 v14, s[56:59], s64 offen lds
v_mfma_f32_16x16x32_bf16 v[148:151], a[96:99], a[56:59], v[148:151]
ds_read_b64_tr_b16 a[88:89], v19 offset:0
v_mfma_f32_16x16x32_bf16 v[148:151], a[100:103], a[60:63], v[148:151]
ds_read_b64_tr_b16 a[90:91], v19 offset:256
v_mfma_f32_16x16x32_bf16 v[132:135], a[100:103], a[52:55], v[132:135]
ds_read_b64_tr_b16 a[92:93], v19 offset:2048
v_mfma_f32_16x16x32_bf16 v[132:135], a[96:99], a[48:51], v[132:135]
ds_read_b64_tr_b16 a[94:95], v19 offset:2304
v_mfma_f32_16x16x32_bf16 v[116:119], a[96:99], a[40:43], v[116:119]
v_mfma_f32_16x16x32_bf16 v[116:119], a[100:103], a[44:47], v[116:119]
v_mfma_f32_16x16x32_bf16 v[100:103], a[100:103], a[36:39], v[100:103]
s_add_u32 m0, s78, 151552
v_mfma_f32_16x16x32_bf16 v[100:103], a[96:99], a[32:35], v[100:103]
s_waitcnt lgkmcnt(4)
s_add_u32 s64, s75, 2361344
ds_read_b64_tr_b16 a[96:97], v20 offset:0
v_mfma_f32_16x16x32_bf16 v[184:187], a[104:107], a[0:3], v[184:187]
s_mov_b32 s36, s20
buffer_load_dwordx4 v23, s[60:63], s64 offen lds
v_mfma_f32_16x16x32_bf16 v[184:187], a[108:111], a[4:7], v[184:187]
s_mov_b32 s37, s21
ds_read_b64_tr_b16 a[98:99], v20 offset:256
v_mfma_f32_16x16x32_bf16 v[192:195], a[108:111], a[12:15], v[192:195]
s_mov_b32 s38, 2097152
s_add_u32 s17, s78, .-L_pc+6144
ds_read_b64_tr_b16 a[100:101], v20 offset:2048
v_mfma_f32_16x16x32_bf16 v[192:195], a[104:107], a[8:11], v[192:195]
s_mov_b32 s40, s14
s_add_u32 s65, s79, 6144
ds_read_b64_tr_b16 a[102:103], v20 offset:2304
v_mfma_f32_16x16x32_bf16 v[200:203], a[104:107], a[16:19], v[200:203]
s_mov_b32 s41, s15
buffer_load_dword a252, v16, s[88:91], s17 offen
v_mfma_f32_16x16x32_bf16 v[200:203], a[108:111], a[20:23], v[200:203]
s_mov_b32 s42, 8388608
buffer_store_dwordx4 a[172:175], v16, s[44:47], s65 offen sc1
v_mfma_f32_16x16x32_bf16 v[208:211], a[108:111], a[28:31], v[208:211]
v_mfma_f32_16x16x32_bf16 v[208:211], a[104:107], a[24:27], v[208:211]
ds_read_b64_tr_b16 a[104:105], v4 offset:0
v_mfma_f32_16x16x32_bf16 v[212:215], a[112:115], a[24:27], v[212:215]
s_add_u32 m0, s77, 133120
ds_read_b64_tr_b16 a[106:107], v4 offset:1024
v_mfma_f32_16x16x32_bf16 v[212:215], a[116:119], a[28:31], v[212:215]
s_add_u32 s64, s71, 3211264
ds_read_b64_tr_b16 a[108:109], v4 offset:8192
v_mfma_f32_16x16x32_bf16 v[204:207], a[116:119], a[20:23], v[204:207]
buffer_load_dwordx4 v15, s[56:59], s64 offen lds
v_mfma_f32_16x16x32_bf16 v[204:207], a[112:115], a[16:19], v[204:207]
ds_read_b64_tr_b16 a[110:111], v4 offset:9216
v_mfma_f32_16x16x32_bf16 v[196:199], a[112:115], a[8:11], v[196:199]
v_mfma_f32_16x16x32_bf16 v[196:199], a[116:119], a[12:15], v[196:199]
v_mfma_f32_16x16x32_bf16 v[188:191], a[116:119], a[4:7], v[188:191]
v_mfma_f32_16x16x32_bf16 v[188:191], a[112:115], a[0:3], v[188:191]
ds_read_b64_tr_b16 a[112:113], v5 offset:0
v_mfma_f32_16x16x32_bf16 v[216:219], a[0:3], a[72:75], v[216:219]
ds_read_b64_tr_b16 a[114:115], v5 offset:1024
v_mfma_f32_16x16x32_bf16 v[216:219], a[4:7], a[76:79], v[216:219]
s_add_u32 m0, s78, 155648
ds_read_b64_tr_b16 a[116:117], v5 offset:8192
v_mfma_f32_16x16x32_bf16 v[224:227], a[12:15], a[76:79], v[224:227]
s_add_u32 s64, s75, 2363392
ds_read_b64_tr_b16 a[118:119], v5 offset:9216
v_mfma_f32_16x16x32_bf16 v[224:227], a[8:11], a[72:75], v[224:227]
buffer_load_dwordx4 v23, s[60:63], s64 offen lds
v_mfma_f32_16x16x32_bf16 v[232:235], a[16:19], a[72:75], v[232:235]
v_mfma_f32_16x16x32_bf16 v[232:235], a[20:23], a[76:79], v[232:235]
v_mfma_f32_16x16x32_bf16 v[240:243], a[28:31], a[76:79], v[240:243]
v_mfma_f32_16x16x32_bf16 v[240:243], a[24:27], a[72:75], v[240:243]
ds_read_b64_tr_b16 a[72:73], v6 offset:0
v_mfma_f32_16x16x32_bf16 v[244:247], a[24:27], a[80:83], v[244:247]
ds_read_b64_tr_b16 a[74:75], v6 offset:1024
v_mfma_f32_16x16x32_bf16 v[244:247], a[28:31], a[84:87], v[244:247]
ds_read_b64_tr_b16 a[76:77], v6 offset:8192
v_mfma_f32_16x16x32_bf16 v[236:239], a[20:23], a[84:87], v[236:239]
s_add_u32 m0, s77, 134144
ds_read_b64_tr_b16 a[78:79], v6 offset:9216
v_mfma_f32_16x16x32_bf16 v[236:239], a[16:19], a[80:83], v[236:239]
s_add_u32 s64, s71, 3244032
v_mfma_f32_16x16x32_bf16 v[228:231], a[8:11], a[80:83], v[228:231]
buffer_load_dwordx4 v15, s[56:59], s64 offen lds
v_mfma_f32_16x16x32_bf16 v[228:231], a[12:15], a[84:87], v[228:231]
v_mfma_f32_16x16x32_bf16 v[220:223], a[4:7], a[84:87], v[220:223]
v_mfma_f32_16x16x32_bf16 v[220:223], a[0:3], a[80:83], v[220:223]
s_waitcnt lgkmcnt(4)
ds_read_b64_tr_b16 a[80:81], v7 offset:0
v_mfma_f32_16x16x32_bf16 v[152:155], a[88:91], a[0:3], v[152:155]
ds_read_b64_tr_b16 a[82:83], v7 offset:1024
v_mfma_f32_16x16x32_bf16 v[152:155], a[92:95], a[4:7], v[152:155]
ds_read_b64_tr_b16 a[84:85], v7 offset:8192
v_mfma_f32_16x16x32_bf16 v[160:163], a[92:95], a[12:15], v[160:163]
ds_read_b64_tr_b16 a[86:87], v7 offset:9216
v_mfma_f32_16x16x32_bf16 v[160:163], a[88:91], a[8:11], v[160:163]
v_mfma_f32_16x16x32_bf16 v[168:171], a[88:91], a[16:19], v[168:171]
v_mfma_f32_16x16x32_bf16 v[168:171], a[92:95], a[20:23], v[168:171]
v_mfma_f32_16x16x32_bf16 v[176:179], a[92:95], a[28:31], v[176:179]
s_add_u32 m0, s76, 0
v_mfma_f32_16x16x32_bf16 v[176:179], a[88:91], a[24:27], v[176:179]
s_add_u32 s64, s72, 768
ds_read_b64_tr_b16 a[88:89], v8 offset:0
v_mfma_f32_16x16x32_bf16 v[180:183], a[96:99], a[24:27], v[180:183]
buffer_load_dwordx4 v12, s[48:51], s64 offen lds
v_mfma_f32_16x16x32_bf16 v[180:183], a[100:103], a[28:31], v[180:183]
ds_read_b64_tr_b16 a[90:91], v8 offset:1024
v_mfma_f32_16x16x32_bf16 v[172:175], a[100:103], a[20:23], v[172:175]
ds_read_b64_tr_b16 a[92:93], v8 offset:8192
v_mfma_f32_16x16x32_bf16 v[172:175], a[96:99], a[16:19], v[172:175]
s_add_u32 m0, s76, 1024
ds_read_b64_tr_b16 a[94:95], v8 offset:9216
v_mfma_f32_16x16x32_bf16 v[164:167], a[96:99], a[8:11], v[164:167]
s_add_u32 s64, s72, 17152
v_mfma_f32_16x16x32_bf16 v[164:167], a[100:103], a[12:15], v[164:167]
buffer_load_dwordx4 v13, s[48:51], s64 offen lds
v_mfma_f32_16x16x32_bf16 v[156:159], a[100:103], a[4:7], v[156:159]
v_mfma_f32_16x16x32_bf16 v[156:159], a[96:99], a[0:3], v[156:159]
ds_read_b64_tr_b16 a[96:97], v9 offset:0
v_mfma_f32_16x16x32_bf16 v[24:27], a[104:107], a[0:3], v[24:27]
s_add_u32 m0, s76, 2048
ds_read_b64_tr_b16 a[98:99], v9 offset:1024
v_mfma_f32_16x16x32_bf16 v[24:27], a[108:111], a[4:7], v[24:27]
s_add_u32 s64, s72, 131840
ds_read_b64_tr_b16 a[100:101], v9 offset:8192
v_mfma_f32_16x16x32_bf16 v[40:43], a[108:111], a[12:15], v[40:43]
buffer_load_dwordx4 v12, s[48:51], s64 offen lds
v_mfma_f32_16x16x32_bf16 v[40:43], a[104:107], a[8:11], v[40:43]
ds_read_b64_tr_b16 a[102:103], v9 offset:9216
v_mfma_f32_16x16x32_bf16 v[56:59], a[104:107], a[16:19], v[56:59]
v_mfma_f32_16x16x32_bf16 v[56:59], a[108:111], a[20:23], v[56:59]
s_add_u32 m0, s76, 3072
v_mfma_f32_16x16x32_bf16 v[72:75], a[108:111], a[28:31], v[72:75]
s_waitcnt vmcnt(13)
s_add_u32 s64, s72, 148224
ds_read_b128 a[32:35], v2 offset:32768
v_mfma_f32_16x16x32_bf16 v[72:75], a[104:107], a[24:27], v[72:75]
s_add_u32 s65, s79, 2048
buffer_load_dwordx4 v13, s[48:51], s64 offen lds
v_mfma_f32_16x16x32_bf16 v[136:139], a[112:115], a[24:27], v[136:139]
buffer_store_dwordx4 a[176:179], v16, s[44:47], s65 offen sc1
v_mfma_f32_16x16x32_bf16 v[136:139], a[116:119], a[28:31], v[136:139]
ds_read_b128 a[36:39], v3 offset:32768
v_mfma_f32_16x16x32_bf16 v[120:123], a[116:119], a[20:23], v[120:123]
s_add_u32 m0, s76, 4096
ds_read_b128 a[40:43], v2 offset:34816
v_mfma_f32_16x16x32_bf16 v[120:123], a[112:115], a[16:19], v[120:123]
s_add_u32 s64, s73, 768
ds_read_b128 a[44:47], v3 offset:34816
v_mfma_f32_16x16x32_bf16 v[104:107], a[112:115], a[8:11], v[104:107]
buffer_load_dwordx4 v12, s[48:51], s64 offen lds
v_mfma_f32_16x16x32_bf16 v[104:107], a[116:119], a[12:15], v[104:107]
ds_read_b128 a[48:51], v2 offset:36864
v_mfma_f32_16x16x32_bf16 v[88:91], a[116:119], a[4:7], v[88:91]
ds_read_b128 a[52:55], v3 offset:36864
v_mfma_f32_16x16x32_bf16 v[88:91], a[112:115], a[0:3], v[88:91]
s_waitcnt lgkmcnt(6)
s_add_u32 m0, s76, 5120
ds_read_b128 a[56:59], v2 offset:38912
v_mfma_f32_16x16x32_bf16 v[28:31], a[72:75], a[0:3], v[28:31]
s_add_u32 s64, s73, 17152
ds_read_b128 a[60:63], v3 offset:38912
v_mfma_f32_16x16x32_bf16 v[28:31], a[76:79], a[4:7], v[28:31]
buffer_load_dwordx4 v13, s[48:51], s64 offen lds
v_mfma_f32_16x16x32_bf16 v[44:47], a[76:79], a[12:15], v[44:47]
ds_read_b64_tr_b16 a[104:105], v10 offset:0
v_mfma_f32_16x16x32_bf16 v[44:47], a[72:75], a[8:11], v[44:47]
ds_read_b64_tr_b16 a[106:107], v10 offset:1024
v_mfma_f32_16x16x32_bf16 v[60:63], a[72:75], a[16:19], v[60:63]
s_add_u32 m0, s76, 6144
ds_read_b64_tr_b16 a[108:109], v10 offset:8192
v_mfma_f32_16x16x32_bf16 v[60:63], a[76:79], a[20:23], v[60:63]
s_add_u32 s64, s73, 131840
ds_read_b64_tr_b16 a[110:111], v10 offset:9216
v_mfma_f32_16x16x32_bf16 v[76:79], a[76:79], a[28:31], v[76:79]
buffer_load_dwordx4 v12, s[48:51], s64 offen lds
v_mfma_f32_16x16x32_bf16 v[76:79], a[72:75], a[24:27], v[76:79]
ds_read_b64_tr_b16 a[112:113], v11 offset:0
v_mfma_f32_16x16x32_bf16 v[140:143], a[80:83], a[24:27], v[140:143]
ds_read_b64_tr_b16 a[114:115], v11 offset:1024
v_mfma_f32_16x16x32_bf16 v[140:143], a[84:87], a[28:31], v[140:143]
s_add_u32 m0, s76, 7168
ds_read_b64_tr_b16 a[116:117], v11 offset:8192
v_mfma_f32_16x16x32_bf16 v[124:127], a[84:87], a[20:23], v[124:127]
s_add_u32 s64, s73, 148224
ds_read_b64_tr_b16 a[118:119], v11 offset:9216
v_mfma_f32_16x16x32_bf16 v[124:127], a[80:83], a[16:19], v[124:127]
buffer_load_dwordx4 v13, s[48:51], s64 offen lds
v_mfma_f32_16x16x32_bf16 v[108:111], a[80:83], a[8:11], v[108:111]
v_mfma_f32_16x16x32_bf16 v[108:111], a[84:87], a[12:15], v[108:111]
v_mfma_f32_16x16x32_bf16 v[92:95], a[84:87], a[4:7], v[92:95]
v_mfma_f32_16x16x32_bf16 v[92:95], a[80:83], a[0:3], v[92:95]
v_mfma_f32_16x16x32_bf16 v[32:35], a[88:91], a[0:3], v[32:35]
v_mfma_f32_16x16x32_bf16 v[32:35], a[92:95], a[4:7], v[32:35]
v_mfma_f32_16x16x32_bf16 v[48:51], a[92:95], a[12:15], v[48:51]
s_waitcnt lgkmcnt(0)
s_barrier
v_mfma_f32_16x16x32_bf16 v[48:51], a[88:91], a[8:11], v[48:51]
s_add_u32 m0, s77, 65536
ds_read_b64_tr_b16 a[72:73], v19 offset:36864
v_mfma_f32_16x16x32_bf16 v[64:67], a[88:91], a[16:19], v[64:67]
s_add_u32 s64, s71, 3670016
ds_read_b64_tr_b16 a[74:75], v19 offset:37120
v_mfma_f32_16x16x32_bf16 v[64:67], a[92:95], a[20:23], v[64:67]
buffer_load_dwordx4 v14, s[56:59], s64 offen lds
v_mfma_f32_16x16x32_bf16 v[80:83], a[92:95], a[28:31], v[80:83]
ds_read_b64_tr_b16 a[76:77], v19 offset:38912
v_mfma_f32_16x16x32_bf16 v[80:83], a[88:91], a[24:27], v[80:83]
ds_read_b64_tr_b16 a[78:79], v19 offset:39168
v_mfma_f32_16x16x32_bf16 v[144:147], a[96:99], a[24:27], v[144:147]
ds_read_b64_tr_b16 a[80:81], v20 offset:36864
v_mfma_f32_16x16x32_bf16 v[144:147], a[100:103], a[28:31], v[144:147]
ds_read_b64_tr_b16 a[82:83], v20 offset:37120
v_mfma_f32_16x16x32_bf16 v[128:131], a[100:103], a[20:23], v[128:131]
ds_read_b64_tr_b16 a[84:85], v20 offset:38912
v_mfma_f32_16x16x32_bf16 v[128:131], a[96:99], a[16:19], v[128:131]
ds_read_b64_tr_b16 a[86:87], v20 offset:39168
v_mfma_f32_16x16x32_bf16 v[112:115], a[96:99], a[8:11], v[112:115]
s_add_u32 m0, s78, 81920
ds_read_b64_tr_b16 a[88:89], v19 offset:40960
v_mfma_f32_16x16x32_bf16 v[112:115], a[100:103], a[12:15], v[112:115]
s_add_u32 s64, s75, 2752512
ds_read_b64_tr_b16 a[90:91], v19 offset:41216
v_mfma_f32_16x16x32_bf16 v[96:99], a[100:103], a[4:7], v[96:99]
buffer_load_dwordx4 v23, s[60:63], s64 offen lds
v_mfma_f32_16x16x32_bf16 v[96:99], a[96:99], a[0:3], v[96:99]
ds_read_b64_tr_b16 a[92:93], v19 offset:43008
v_mfma_f32_16x16x32_bf16 v[36:39], a[104:107], a[0:3], v[36:39]
ds_read_b64_tr_b16 a[94:95], v19 offset:43264
v_mfma_f32_16x16x32_bf16 v[36:39], a[108:111], a[4:7], v[36:39]
ds_read_b64_tr_b16 a[96:97], v20 offset:40960
v_mfma_f32_16x16x32_bf16 v[52:55], a[108:111], a[12:15], v[52:55]
ds_read_b64_tr_b16 a[98:99], v20 offset:41216
v_mfma_f32_16x16x32_bf16 v[52:55], a[104:107], a[8:11], v[52:55]
ds_read_b64_tr_b16 a[100:101], v20 offset:43008
v_mfma_f32_16x16x32_bf16 v[68:71], a[104:107], a[16:19], v[68:71]
ds_read_b64_tr_b16 a[102:103], v20 offset:43264
v_mfma_f32_16x16x32_bf16 v[68:71], a[108:111], a[20:23], v[68:71]
s_add_u32 m0, s77, 66560
v_mfma_f32_16x16x32_bf16 v[84:87], a[108:111], a[28:31], v[84:87]
s_add_u32 s64, s71, 3702784
v_mfma_f32_16x16x32_bf16 v[84:87], a[104:107], a[24:27], v[84:87]
s_add_u32 s65, s79, 19456
buffer_load_dwordx4 v14, s[56:59], s64 offen lds
v_mfma_f32_16x16x32_bf16 v[148:151], a[112:115], a[24:27], v[148:151]
buffer_store_dwordx4 a[180:183], v16, s[44:47], s65 offen sc1
v_mfma_f32_16x16x32_bf16 v[148:151], a[116:119], a[28:31], v[148:151]
ds_read_b64_tr_b16 a[104:105], v19 offset:32768
v_mfma_f32_16x16x32_bf16 v[132:135], a[116:119], a[20:23], v[132:135]
ds_read_b64_tr_b16 a[106:107], v19 offset:33024
v_mfma_f32_16x16x32_bf16 v[132:135], a[112:115], a[16:19], v[132:135]
ds_read_b64_tr_b16 a[108:109], v19 offset:34816
v_mfma_f32_16x16x32_bf16 v[116:119], a[112:115], a[8:11], v[116:119]
ds_read_b64_tr_b16 a[110:111], v19 offset:35072
v_mfma_f32_16x16x32_bf16 v[116:119], a[116:119], a[12:15], v[116:119]
v_mfma_f32_16x16x32_bf16 v[100:103], a[116:119], a[4:7], v[100:103]
s_add_u32 m0, s78, 86016
v_mfma_f32_16x16x32_bf16 v[100:103], a[112:115], a[0:3], v[100:103]
s_waitcnt lgkmcnt(4)
s_add_u32 s64, s75, 2754560
ds_read_b64_tr_b16 a[112:113], v20 offset:32768
v_mfma_f32_16x16x32_bf16 v[184:187], a[72:75], a[32:35], v[184:187]
buffer_load_dwordx4 v23, s[60:63], s64 offen lds
v_mfma_f32_16x16x32_bf16 v[184:187], a[76:79], a[36:39], v[184:187]
ds_read_b64_tr_b16 a[114:115], v20 offset:33024
v_mfma_f32_16x16x32_bf16 v[192:195], a[76:79], a[44:47], v[192:195]
ds_read_b64_tr_b16 a[116:117], v20 offset:34816
v_mfma_f32_16x16x32_bf16 v[192:195], a[72:75], a[40:43], v[192:195]
ds_read_b64_tr_b16 a[118:119], v20 offset:35072
v_mfma_f32_16x16x32_bf16 v[200:203], a[72:75], a[48:51], v[200:203]
v_mfma_f32_16x16x32_bf16 v[200:203], a[76:79], a[52:55], v[200:203]
v_mfma_f32_16x16x32_bf16 v[208:211], a[76:79], a[60:63], v[208:211]
v_mfma_f32_16x16x32_bf16 v[208:211], a[72:75], a[56:59], v[208:211]
ds_read_b64_tr_b16 a[72:73], v4 offset:32768
v_mfma_f32_16x16x32_bf16 v[212:215], a[80:83], a[56:59], v[212:215]
s_add_u32 m0, s77, 67584
ds_read_b64_tr_b16 a[74:75], v4 offset:33792
v_mfma_f32_16x16x32_bf16 v[212:215], a[84:87], a[60:63], v[212:215]
s_add_u32 s64, s71, 3735552
ds_read_b64_tr_b16 a[76:77], v4 offset:40960
v_mfma_f32_16x16x32_bf16 v[204:207], a[84:87], a[52:55], v[204:207]
buffer_load_dwordx4 v15, s[56:59], s64 offen lds
v_mfma_f32_16x16x32_bf16 v[204:207], a[80:83], a[48:51], v[204:207]
ds_read_b64_tr_b16 a[78:79], v4 offset:41984
v_mfma_f32_16x16x32_bf16 v[196:199], a[80:83], a[40:43], v[196:199]
v_mfma_f32_16x16x32_bf16 v[196:199], a[84:87], a[44:47], v[196:199]
v_mfma_f32_16x16x32_bf16 v[188:191], a[84:87], a[36:39], v[188:191]
v_mfma_f32_16x16x32_bf16 v[188:191], a[80:83], a[32:35], v[188:191]
ds_read_b64_tr_b16 a[80:81], v5 offset:32768
v_mfma_f32_16x16x32_bf16 v[216:219], a[32:35], a[88:91], v[216:219]
ds_read_b64_tr_b16 a[82:83], v5 offset:33792
v_mfma_f32_16x16x32_bf16 v[216:219], a[36:39], a[92:95], v[216:219]
s_add_u32 m0, s78, 90112
ds_read_b64_tr_b16 a[84:85], v5 offset:40960
v_mfma_f32_16x16x32_bf16 v[224:227], a[44:47], a[92:95], v[224:227]
s_add_u32 s64, s75, 2756608
ds_read_b64_tr_b16 a[86:87], v5 offset:41984
v_mfma_f32_16x16x32_bf16 v[224:227], a[40:43], a[88:91], v[224:227]
buffer_load_dwordx4 v23, s[60:63], s64 offen lds
v_mfma_f32_16x16x32_bf16 v[232:235], a[48:51], a[88:91], v[232:235]
v_mfma_f32_16x16x32_bf16 v[232:235], a[52:55], a[92:95], v[232:235]
v_mfma_f32_16x16x32_bf16 v[240:243], a[60:63], a[92:95], v[240:243]
v_mfma_f32_16x16x32_bf16 v[240:243], a[56:59], a[88:91], v[240:243]
ds_read_b64_tr_b16 a[88:89], v6 offset:32768
v_mfma_f32_16x16x32_bf16 v[244:247], a[56:59], a[96:99], v[244:247]
ds_read_b64_tr_b16 a[90:91], v6 offset:33792
v_mfma_f32_16x16x32_bf16 v[244:247], a[60:63], a[100:103], v[244:247]
ds_read_b64_tr_b16 a[92:93], v6 offset:40960
v_add_u32 v19, 0x8000, v19
v_mfma_f32_16x16x32_bf16 v[236:239], a[52:55], a[100:103], v[236:239]
s_add_u32 m0, s77, 68608
ds_read_b64_tr_b16 a[94:95], v6 offset:41984
v_mfma_f32_16x16x32_bf16 v[236:239], a[48:51], a[96:99], v[236:239]
s_add_u32 s64, s71, 3768320
v_mfma_f32_16x16x32_bf16 v[228:231], a[40:43], a[96:99], v[228:231]
buffer_load_dwordx4 v15, s[56:59], s64 offen lds
v_mfma_f32_16x16x32_bf16 v[228:231], a[44:47], a[100:103], v[228:231]
v_mfma_f32_16x16x32_bf16 v[220:223], a[36:39], a[100:103], v[220:223]
v_mfma_f32_16x16x32_bf16 v[220:223], a[32:35], a[96:99], v[220:223]
s_waitcnt lgkmcnt(4)
ds_read_b64_tr_b16 a[96:97], v7 offset:32768
v_mfma_f32_16x16x32_bf16 v[152:155], a[104:107], a[32:35], v[152:155]
ds_read_b64_tr_b16 a[98:99], v7 offset:33792
v_mfma_f32_16x16x32_bf16 v[152:155], a[108:111], a[36:39], v[152:155]
ds_read_b64_tr_b16 a[100:101], v7 offset:40960
v_add_u32 v20, 0x8000, v20
v_mfma_f32_16x16x32_bf16 v[160:163], a[108:111], a[44:47], v[160:163]
ds_read_b64_tr_b16 a[102:103], v7 offset:41984
v_mfma_f32_16x16x32_bf16 v[160:163], a[104:107], a[40:43], v[160:163]
v_mfma_f32_16x16x32_bf16 v[168:171], a[104:107], a[48:51], v[168:171]
v_mfma_f32_16x16x32_bf16 v[168:171], a[108:111], a[52:55], v[168:171]
v_mfma_f32_16x16x32_bf16 v[176:179], a[108:111], a[60:63], v[176:179]
s_add_u32 m0, s76, 32768
v_mfma_f32_16x16x32_bf16 v[176:179], a[104:107], a[56:59], v[176:179]
s_add_u32 s64, s72, 896
ds_read_b64_tr_b16 a[104:105], v8 offset:32768
v_mfma_f32_16x16x32_bf16 v[180:183], a[112:115], a[56:59], v[180:183]
buffer_load_dwordx4 v12, s[48:51], s64 offen lds
v_mfma_f32_16x16x32_bf16 v[180:183], a[116:119], a[60:63], v[180:183]
s_add_u32 s65, s79, 7168
ds_read_b64_tr_b16 a[106:107], v8 offset:33792
v_add_u32 v4, 0x8000, v4
v_mfma_f32_16x16x32_bf16 v[172:175], a[116:119], a[52:55], v[172:175]
buffer_store_dwordx4 a[184:187], v16, s[44:47], s65 offen sc1
v_mfma_f32_16x16x32_bf16 v[172:175], a[112:115], a[48:51], v[172:175]
s_add_u32 m0, s76, 33792
ds_read_b64_tr_b16 a[108:109], v8 offset:40960
v_mfma_f32_16x16x32_bf16 v[164:167], a[112:115], a[40:43], v[164:167]
s_add_u32 s64, s72, 17280
ds_read_b64_tr_b16 a[110:111], v8 offset:41984
v_mfma_f32_16x16x32_bf16 v[164:167], a[116:119], a[44:47], v[164:167]
buffer_load_dwordx4 v13, s[48:51], s64 offen lds
v_mfma_f32_16x16x32_bf16 v[156:159], a[116:119], a[36:39], v[156:159]
v_mfma_f32_16x16x32_bf16 v[156:159], a[112:115], a[32:35], v[156:159]
ds_read_b64_tr_b16 a[112:113], v9 offset:32768
v_mfma_f32_16x16x32_bf16 v[24:27], a[72:75], a[32:35], v[24:27]
s_add_u32 m0, s76, 34816
ds_read_b64_tr_b16 a[114:115], v9 offset:33792
v_mfma_f32_16x16x32_bf16 v[24:27], a[76:79], a[36:39], v[24:27]
s_add_u32 s64, s72, 131968
ds_read_b64_tr_b16 a[116:117], v9 offset:40960
v_add_u32 v5, 0x8000, v5
v_mfma_f32_16x16x32_bf16 v[40:43], a[76:79], a[44:47], v[40:43]
buffer_load_dwordx4 v12, s[48:51], s64 offen lds
v_mfma_f32_16x16x32_bf16 v[40:43], a[72:75], a[40:43], v[40:43]
ds_read_b64_tr_b16 a[118:119], v9 offset:41984
v_mfma_f32_16x16x32_bf16 v[56:59], a[72:75], a[48:51], v[56:59]
v_mfma_f32_16x16x32_bf16 v[56:59], a[76:79], a[52:55], v[56:59]
s_add_u32 m0, s76, 35840
v_mfma_f32_16x16x32_bf16 v[72:75], a[76:79], a[60:63], v[72:75]
s_waitcnt vmcnt(12)
s_add_u32 s64, s72, 148352
ds_read_b128 a[0:3], v2 offset:0
v_mfma_f32_16x16x32_bf16 v[72:75], a[72:75], a[56:59], v[72:75]
buffer_load_dwordx4 v13, s[48:51], s64 offen lds
v_mfma_f32_16x16x32_bf16 v[136:139], a[80:83], a[56:59], v[136:139]
ds_read_b128 a[4:7], v3 offset:0
v_mfma_f32_16x16x32_bf16 v[136:139], a[84:87], a[60:63], v[136:139]
ds_read_b128 a[8:11], v2 offset:2048
v_add_u32 v6, 0x8000, v6
v_mfma_f32_16x16x32_bf16 v[120:123], a[84:87], a[52:55], v[120:123]
s_add_u32 m0, s76, 36864
ds_read_b128 a[12:15], v3 offset:2048
v_mfma_f32_16x16x32_bf16 v[120:123], a[80:83], a[48:51], v[120:123]
s_add_u32 s64, s73, 896
ds_read_b128 a[16:19], v2 offset:4096
v_mfma_f32_16x16x32_bf16 v[104:107], a[80:83], a[40:43], v[104:107]
buffer_load_dwordx4 v12, s[48:51], s64 offen lds
v_mfma_f32_16x16x32_bf16 v[104:107], a[84:87], a[44:47], v[104:107]
ds_read_b128 a[20:23], v3 offset:4096
v_mfma_f32_16x16x32_bf16 v[88:91], a[84:87], a[36:39], v[88:91]
ds_read_b128 a[24:27], v2 offset:6144
v_mfma_f32_16x16x32_bf16 v[88:91], a[80:83], a[32:35], v[88:91]
s_waitcnt lgkmcnt(7)
s_add_u32 m0, s76, 37888
ds_read_b128 a[28:31], v3 offset:6144
v_mfma_f32_16x16x32_bf16 v[28:31], a[88:91], a[32:35], v[28:31]
s_add_u32 s64, s73, 17280
ds_read_b64_tr_b16 a[72:73], v10 offset:32768
v_mfma_f32_16x16x32_bf16 v[28:31], a[92:95], a[36:39], v[28:31]
buffer_load_dwordx4 v13, s[48:51], s64 offen lds
v_mfma_f32_16x16x32_bf16 v[44:47], a[92:95], a[44:47], v[44:47]
ds_read_b64_tr_b16 a[74:75], v10 offset:33792
v_add_u32 v7, 0x8000, v7
v_mfma_f32_16x16x32_bf16 v[44:47], a[88:91], a[40:43], v[44:47]
ds_read_b64_tr_b16 a[76:77], v10 offset:40960
v_mfma_f32_16x16x32_bf16 v[60:63], a[88:91], a[48:51], v[60:63]
s_add_u32 m0, s76, 38912
ds_read_b64_tr_b16 a[78:79], v10 offset:41984
v_mfma_f32_16x16x32_bf16 v[60:63], a[92:95], a[52:55], v[60:63]
s_add_u32 s64, s73, 131968
ds_read_b64_tr_b16 a[80:81], v11 offset:32768
v_mfma_f32_16x16x32_bf16 v[76:79], a[92:95], a[60:63], v[76:79]
buffer_load_dwordx4 v12, s[48:51], s64 offen lds
v_mfma_f32_16x16x32_bf16 v[76:79], a[88:91], a[56:59], v[76:79]
ds_read_b64_tr_b16 a[82:83], v11 offset:33792
v_mfma_f32_16x16x32_bf16 v[140:143], a[96:99], a[56:59], v[140:143]
ds_read_b64_tr_b16 a[84:85], v11 offset:40960
v_mfma_f32_16x16x32_bf16 v[140:143], a[100:103], a[60:63], v[140:143]
s_add_u32 m0, s76, 39936
ds_read_b64_tr_b16 a[86:87], v11 offset:41984
v_add_u32 v8, 0x8000, v8
v_mfma_f32_16x16x32_bf16 v[124:127], a[100:103], a[52:55], v[124:127]
s_add_u32 s64, s73, 148352
v_mfma_f32_16x16x32_bf16 v[124:127], a[96:99], a[48:51], v[124:127]
buffer_load_dwordx4 v13, s[48:51], s64 offen lds
v_mfma_f32_16x16x32_bf16 v[108:111], a[96:99], a[40:43], v[108:111]
v_mfma_f32_16x16x32_bf16 v[108:111], a[100:103], a[44:47], v[108:111]
v_mfma_f32_16x16x32_bf16 v[92:95], a[100:103], a[36:39], v[92:95]
v_add_u32 v9, 0x8000, v9
v_add_u32 v10, 0x8000, v10
v_mfma_f32_16x16x32_bf16 v[92:95], a[96:99], a[32:35], v[92:95]
v_add_u32 v11, 0x8000, v11
v_mfma_f32_16x16x32_bf16 v[32:35], a[104:107], a[32:35], v[32:35]
v_mfma_f32_16x16x32_bf16 v[32:35], a[108:111], a[36:39], v[32:35]
v_mfma_f32_16x16x32_bf16 v[48:51], a[108:111], a[44:47], v[48:51]
s_waitcnt lgkmcnt(0)
s_barrier
v_mfma_f32_16x16x32_bf16 v[48:51], a[104:107], a[40:43], v[48:51]
s_add_u32 m0, s77, 98304
ds_read_b64_tr_b16 a[88:89], v19 offset:36864
v_mfma_f32_16x16x32_bf16 v[64:67], a[104:107], a[48:51], v[64:67]
s_add_u32 s64, s71, 4194304
ds_read_b64_tr_b16 a[90:91], v19 offset:37120
v_mfma_f32_16x16x32_bf16 v[64:67], a[108:111], a[52:55], v[64:67]
buffer_load_dwordx4 v14, s[56:59], s64 offen lds
v_mfma_f32_16x16x32_bf16 v[80:83], a[108:111], a[60:63], v[80:83]
ds_read_b64_tr_b16 a[92:93], v19 offset:38912
v_mfma_f32_16x16x32_bf16 v[80:83], a[104:107], a[56:59], v[80:83]
ds_read_b64_tr_b16 a[94:95], v19 offset:39168
v_mfma_f32_16x16x32_bf16 v[144:147], a[112:115], a[56:59], v[144:147]
ds_read_b64_tr_b16 a[96:97], v20 offset:36864
v_mfma_f32_16x16x32_bf16 v[144:147], a[116:119], a[60:63], v[144:147]
ds_read_b64_tr_b16 a[98:99], v20 offset:37120
v_mfma_f32_16x16x32_bf16 v[128:131], a[116:119], a[52:55], v[128:131]
s_add_u32 s65, s79, 3072
ds_read_b64_tr_b16 a[100:101], v20 offset:38912
v_mfma_f32_16x16x32_bf16 v[128:131], a[112:115], a[48:51], v[128:131]
buffer_store_dwordx4 a[188:191], v16, s[44:47], s65 offen sc1
v_mfma_f32_16x16x32_bf16 v[112:115], a[112:115], a[40:43], v[112:115]
s_add_u32 m0, s78, 114688
ds_read_b64_tr_b16 a[102:103], v20 offset:39168
v_mfma_f32_16x16x32_bf16 v[112:115], a[116:119], a[44:47], v[112:115]
s_add_u32 s64, s75, 3145728
ds_read_b64_tr_b16 a[104:105], v19 offset:40960
v_mfma_f32_16x16x32_bf16 v[96:99], a[116:119], a[36:39], v[96:99]
buffer_load_dwordx4 v23, s[60:63], s64 offen lds
v_mfma_f32_16x16x32_bf16 v[96:99], a[112:115], a[32:35], v[96:99]
ds_read_b64_tr_b16 a[106:107], v19 offset:41216
v_mfma_f32_16x16x32_bf16 v[36:39], a[72:75], a[32:35], v[36:39]
ds_read_b64_tr_b16 a[108:109], v19 offset:43008
v_mfma_f32_16x16x32_bf16 v[36:39], a[76:79], a[36:39], v[36:39]
ds_read_b64_tr_b16 a[110:111], v19 offset:43264
v_mfma_f32_16x16x32_bf16 v[52:55], a[76:79], a[44:47], v[52:55]
ds_read_b64_tr_b16 a[112:113], v20 offset:40960
v_mfma_f32_16x16x32_bf16 v[52:55], a[72:75], a[40:43], v[52:55]
ds_read_b64_tr_b16 a[114:115], v20 offset:41216
v_mfma_f32_16x16x32_bf16 v[68:71], a[72:75], a[48:51], v[68:71]
ds_read_b64_tr_b16 a[116:117], v20 offset:43008
v_mfma_f32_16x16x32_bf16 v[68:71], a[76:79], a[52:55], v[68:71]
s_add_u32 m0, s77, 99328
ds_read_b64_tr_b16 a[118:119], v20 offset:43264
v_mfma_f32_16x16x32_bf16 v[84:87], a[76:79], a[60:63], v[84:87]
s_add_u32 s64, s71, 4227072
v_mfma_f32_16x16x32_bf16 v[84:87], a[72:75], a[56:59], v[84:87]
buffer_load_dwordx4 v14, s[56:59], s64 offen lds
v_mfma_f32_16x16x32_bf16 v[148:151], a[80:83], a[56:59], v[148:151]
ds_read_b64_tr_b16 a[72:73], v19 offset:32768
v_mfma_f32_16x16x32_bf16 v[148:151], a[84:87], a[60:63], v[148:151]
ds_read_b64_tr_b16 a[74:75], v19 offset:33024
v_mfma_f32_16x16x32_bf16 v[132:135], a[84:87], a[52:55], v[132:135]
ds_read_b64_tr_b16 a[76:77], v19 offset:34816
v_mfma_f32_16x16x32_bf16 v[132:135], a[80:83], a[48:51], v[132:135]
ds_read_b64_tr_b16 a[78:79], v19 offset:35072
v_mfma_f32_16x16x32_bf16 v[116:119], a[80:83], a[40:43], v[116:119]
v_mfma_f32_16x16x32_bf16 v[116:119], a[84:87], a[44:47], v[116:119]
v_mfma_f32_16x16x32_bf16 v[100:103], a[84:87], a[36:39], v[100:103]
s_add_u32 m0, s78, 118784
v_mfma_f32_16x16x32_bf16 v[100:103], a[80:83], a[32:35], v[100:103]
s_waitcnt lgkmcnt(4)
s_add_u32 s64, s75, 3147776
ds_read_b64_tr_b16 a[80:81], v20 offset:32768
v_mfma_f32_16x16x32_bf16 v[184:187], a[88:91], a[0:3], v[184:187]
buffer_load_dwordx4 v23, s[60:63], s64 offen lds
v_mfma_f32_16x16x32_bf16 v[184:187], a[92:95], a[4:7], v[184:187]
ds_read_b64_tr_b16 a[82:83], v20 offset:33024
v_mfma_f32_16x16x32_bf16 v[192:195], a[92:95], a[12:15], v[192:195]
ds_read_b64_tr_b16 a[84:85], v20 offset:34816
v_mfma_f32_16x16x32_bf16 v[192:195], a[88:91], a[8:11], v[192:195]
s_add_u32 s17, s78, .-L_pc+6144
ds_read_b64_tr_b16 a[86:87], v20 offset:35072
v_mfma_f32_16x16x32_bf16 v[200:203], a[88:91], a[16:19], v[200:203]
buffer_load_dword a252, v16, s[88:91], s17 offen
v_mfma_f32_16x16x32_bf16 v[200:203], a[92:95], a[20:23], v[200:203]
v_mfma_f32_16x16x32_bf16 v[208:211], a[92:95], a[28:31], v[208:211]
v_mfma_f32_16x16x32_bf16 v[208:211], a[88:91], a[24:27], v[208:211]
ds_read_b64_tr_b16 a[88:89], v4 offset:32768
v_mfma_f32_16x16x32_bf16 v[212:215], a[96:99], a[24:27], v[212:215]
s_add_u32 m0, s77, 100352
ds_read_b64_tr_b16 a[90:91], v4 offset:33792
v_mfma_f32_16x16x32_bf16 v[212:215], a[100:103], a[28:31], v[212:215]
s_add_u32 s64, s71, 4259840
ds_read_b64_tr_b16 a[92:93], v4 offset:40960
v_mfma_f32_16x16x32_bf16 v[204:207], a[100:103], a[20:23], v[204:207]
buffer_load_dwordx4 v15, s[56:59], s64 offen lds
v_mfma_f32_16x16x32_bf16 v[204:207], a[96:99], a[16:19], v[204:207]
ds_read_b64_tr_b16 a[94:95], v4 offset:41984
v_mfma_f32_16x16x32_bf16 v[196:199], a[96:99], a[8:11], v[196:199]
v_mfma_f32_16x16x32_bf16 v[196:199], a[100:103], a[12:15], v[196:199]
v_mfma_f32_16x16x32_bf16 v[188:191], a[100:103], a[4:7], v[188:191]
v_mfma_f32_16x16x32_bf16 v[188:191], a[96:99], a[0:3], v[188:191]
ds_read_b64_tr_b16 a[96:97], v5 offset:32768
v_mfma_f32_16x16x32_bf16 v[216:219], a[0:3], a[104:107], v[216:219]
ds_read_b64_tr_b16 a[98:99], v5 offset:33792
v_mfma_f32_16x16x32_bf16 v[216:219], a[4:7], a[108:111], v[216:219]
s_add_u32 m0, s78, 122880
ds_read_b64_tr_b16 a[100:101], v5 offset:40960
v_mfma_f32_16x16x32_bf16 v[224:227], a[12:15], a[108:111], v[224:227]
s_add_u32 s64, s75, 3149824
ds_read_b64_tr_b16 a[102:103], v5 offset:41984
v_mfma_f32_16x16x32_bf16 v[224:227], a[8:11], a[104:107], v[224:227]
buffer_load_dwordx4 v23, s[60:63], s64 offen lds
v_mfma_f32_16x16x32_bf16 v[232:235], a[16:19], a[104:107], v[232:235]
v_mfma_f32_16x16x32_bf16 v[232:235], a[20:23], a[108:111], v[232:235]
v_mfma_f32_16x16x32_bf16 v[240:243], a[28:31], a[108:111], v[240:243]
v_mfma_f32_16x16x32_bf16 v[240:243], a[24:27], a[104:107], v[240:243]
ds_read_b64_tr_b16 a[104:105], v6 offset:32768
v_mfma_f32_16x16x32_bf16 v[244:247], a[24:27], a[112:115], v[244:247]
ds_read_b64_tr_b16 a[106:107], v6 offset:33792
v_mfma_f32_16x16x32_bf16 v[244:247], a[28:31], a[116:119], v[244:247]
ds_read_b64_tr_b16 a[108:109], v6 offset:40960
v_subrev_u32 v19, 0x8000, v19
v_mfma_f32_16x16x32_bf16 v[236:239], a[20:23], a[116:119], v[236:239]
s_add_u32 m0, s77, 101376
ds_read_b64_tr_b16 a[110:111], v6 offset:41984
v_mfma_f32_16x16x32_bf16 v[236:239], a[16:19], a[112:115], v[236:239]
s_add_u32 s64, s71, 4292608
v_mfma_f32_16x16x32_bf16 v[228:231], a[8:11], a[112:115], v[228:231]
s_add_u32 s65, s79, 24576
buffer_load_dwordx4 v15, s[56:59], s64 offen lds
v_mfma_f32_16x16x32_bf16 v[228:231], a[12:15], a[116:119], v[228:231]
buffer_store_dwordx4 a[192:195], v16, s[44:47], s65 offen sc1
v_mfma_f32_16x16x32_bf16 v[220:223], a[4:7], a[116:119], v[220:223]
v_mfma_f32_16x16x32_bf16 v[220:223], a[0:3], a[112:115], v[220:223]
s_waitcnt lgkmcnt(4)
ds_read_b64_tr_b16 a[112:113], v7 offset:32768
v_mfma_f32_16x16x32_bf16 v[152:155], a[72:75], a[0:3], v[152:155]
ds_read_b64_tr_b16 a[114:115], v7 offset:33792
v_mfma_f32_16x16x32_bf16 v[152:155], a[76:79], a[4:7], v[152:155]
ds_read_b64_tr_b16 a[116:117], v7 offset:40960
v_subrev_u32 v20, 0x8000, v20
v_mfma_f32_16x16x32_bf16 v[160:163], a[76:79], a[12:15], v[160:163]
ds_read_b64_tr_b16 a[118:119], v7 offset:41984
v_mfma_f32_16x16x32_bf16 v[160:163], a[72:75], a[8:11], v[160:163]
v_mfma_f32_16x16x32_bf16 v[168:171], a[72:75], a[16:19], v[168:171]
v_mfma_f32_16x16x32_bf16 v[168:171], a[76:79], a[20:23], v[168:171]
v_mfma_f32_16x16x32_bf16 v[176:179], a[76:79], a[28:31], v[176:179]
s_add_u32 m0, s76, 0
v_mfma_f32_16x16x32_bf16 v[176:179], a[72:75], a[24:27], v[176:179]
s_add_u32 s64, s72, 1024
ds_read_b64_tr_b16 a[72:73], v8 offset:32768
v_mfma_f32_16x16x32_bf16 v[180:183], a[80:83], a[24:27], v[180:183]
buffer_load_dwordx4 v12, s[48:51], s64 offen lds
v_mfma_f32_16x16x32_bf16 v[180:183], a[84:87], a[28:31], v[180:183]
ds_read_b64_tr_b16 a[74:75], v8 offset:33792
v_subrev_u32 v4, 0x8000, v4
v_mfma_f32_16x16x32_bf16 v[172:175], a[84:87], a[20:23], v[172:175]
ds_read_b64_tr_b16 a[76:77], v8 offset:40960
v_mfma_f32_16x16x32_bf16 v[172:175], a[80:83], a[16:19], v[172:175]
s_add_u32 m0, s76, 1024
ds_read_b64_tr_b16 a[78:79], v8 offset:41984
v_mfma_f32_16x16x32_bf16 v[164:167], a[80:83], a[8:11], v[164:167]
s_add_u32 s64, s72, 17408
v_mfma_f32_16x16x32_bf16 v[164:167], a[84:87], a[12:15], v[164:167]
buffer_load_dwordx4 v13, s[48:51], s64 offen lds
v_mfma_f32_16x16x32_bf16 v[156:159], a[84:87], a[4:7], v[156:159]
v_mfma_f32_16x16x32_bf16 v[156:159], a[80:83], a[0:3], v[156:159]
ds_read_b64_tr_b16 a[80:81], v9 offset:32768
v_mfma_f32_16x16x32_bf16 v[24:27], a[88:91], a[0:3], v[24:27]
s_add_u32 m0, s76, 2048
ds_read_b64_tr_b16 a[82:83], v9 offset:33792
v_mfma_f32_16x16x32_bf16 v[24:27], a[92:95], a[4:7], v[24:27]
s_add_u32 s64, s72, 132096
ds_read_b64_tr_b16 a[84:85], v9 offset:40960
v_subrev_u32 v5, 0x8000, v5
v_mfma_f32_16x16x32_bf16 v[40:43], a[92:95], a[12:15], v[40:43]
buffer_load_dwordx4 v12, s[48:51], s64 offen lds
v_mfma_f32_16x16x32_bf16 v[40:43], a[88:91], a[8:11], v[40:43]
ds_read_b64_tr_b16 a[86:87], v9 offset:41984
v_mfma_f32_16x16x32_bf16 v[56:59], a[88:91], a[16:19], v[56:59]
v_mfma_f32_16x16x32_bf16 v[56:59], a[92:95], a[20:23], v[56:59]
s_add_u32 m0, s76, 3072
v_mfma_f32_16x16x32_bf16 v[72:75], a[92:95], a[28:31], v[72:75]
s_waitcnt vmcnt(13)
s_add_u32 s64, s72, 148480
ds_read_b128 a[32:35], v2 offset:32768
v_mfma_f32_16x16x32_bf16 v[72:75], a[88:91], a[24:27], v[72:75]
buffer_load_dwordx4 v13, s[48:51], s64 offen lds
v_mfma_f32_16x16x32_bf16 v[136:139], a[96:99], a[24:27], v[136:139]
ds_read_b128 a[36:39], v3 offset:32768
v_mfma_f32_16x16x32_bf16 v[136:139], a[100:103], a[28:31], v[136:139]
ds_read_b128 a[40:43], v2 offset:34816
v_subrev_u32 v6, 0x8000, v6
v_mfma_f32_16x16x32_bf16 v[120:123], a[100:103], a[20:23], v[120:123]
s_add_u32 m0, s76, 4096
ds_read_b128 a[44:47], v3 offset:34816
v_mfma_f32_16x16x32_bf16 v[120:123], a[96:99], a[16:19], v[120:123]
s_add_u32 s64, s73, 1024
ds_read_b128 a[48:51], v2 offset:36864
v_mfma_f32_16x16x32_bf16 v[104:107], a[96:99], a[8:11], v[104:107]
buffer_load_dwordx4 v12, s[48:51], s64 offen lds
v_mfma_f32_16x16x32_bf16 v[104:107], a[100:103], a[12:15], v[104:107]
ds_read_b128 a[52:55], v3 offset:36864
v_mfma_f32_16x16x32_bf16 v[88:91], a[100:103], a[4:7], v[88:91]
ds_read_b128 a[56:59], v2 offset:38912
v_mfma_f32_16x16x32_bf16 v[88:91], a[96:99], a[0:3], v[88:91]
s_waitcnt lgkmcnt(7)
s_add_u32 m0, s76, 5120
ds_read_b128 a[60:63], v3 offset:38912
v_mfma_f32_16x16x32_bf16 v[28:31], a[104:107], a[0:3], v[28:31]
s_add_u32 s64, s73, 17408
ds_read_b64_tr_b16 a[88:89], v10 offset:32768
v_mfma_f32_16x16x32_bf16 v[28:31], a[108:111], a[4:7], v[28:31]
buffer_load_dwordx4 v13, s[48:51], s64 offen lds
v_mfma_f32_16x16x32_bf16 v[44:47], a[108:111], a[12:15], v[44:47]
ds_read_b64_tr_b16 a[90:91], v10 offset:33792
v_subrev_u32 v7, 0x8000, v7
v_mfma_f32_16x16x32_bf16 v[44:47], a[104:107], a[8:11], v[44:47]
ds_read_b64_tr_b16 a[92:93], v10 offset:40960
v_mfma_f32_16x16x32_bf16 v[60:63], a[104:107], a[16:19], v[60:63]
s_add_u32 m0, s76, 6144
ds_read_b64_tr_b16 a[94:95], v10 offset:41984
v_mfma_f32_16x16x32_bf16 v[60:63], a[108:111], a[20:23], v[60:63]
s_add_u32 s64, s73, 132096
ds_read_b64_tr_b16 a[96:97], v11 offset:32768
v_mfma_f32_16x16x32_bf16 v[76:79], a[108:111], a[28:31], v[76:79]
buffer_load_dwordx4 v12, s[48:51], s64 offen lds
v_mfma_f32_16x16x32_bf16 v[76:79], a[104:107], a[24:27], v[76:79]
ds_read_b64_tr_b16 a[98:99], v11 offset:33792
v_mfma_f32_16x16x32_bf16 v[140:143], a[112:115], a[24:27], v[140:143]
ds_read_b64_tr_b16 a[100:101], v11 offset:40960
v_mfma_f32_16x16x32_bf16 v[140:143], a[116:119], a[28:31], v[140:143]
s_add_u32 m0, s76, 7168
ds_read_b64_tr_b16 a[102:103], v11 offset:41984
v_subrev_u32 v8, 0x8000, v8
v_mfma_f32_16x16x32_bf16 v[124:127], a[116:119], a[20:23], v[124:127]
s_add_u32 s64, s73, 148480
v_mfma_f32_16x16x32_bf16 v[124:127], a[112:115], a[16:19], v[124:127]
buffer_load_dwordx4 v13, s[48:51], s64 offen lds
v_mfma_f32_16x16x32_bf16 v[108:111], a[112:115], a[8:11], v[108:111]
v_mfma_f32_16x16x32_bf16 v[108:111], a[116:119], a[12:15], v[108:111]
v_mfma_f32_16x16x32_bf16 v[92:95], a[116:119], a[4:7], v[92:95]
v_subrev_u32 v9, 0x8000, v9
v_subrev_u32 v10, 0x8000, v10
v_mfma_f32_16x16x32_bf16 v[92:95], a[112:115], a[0:3], v[92:95]
s_add_u32 s65, s79, 25600
v_subrev_u32 v11, 0x8000, v11
v_mfma_f32_16x16x32_bf16 v[32:35], a[72:75], a[0:3], v[32:35]
buffer_store_dwordx4 a[196:199], v16, s[44:47], s65 offen sc1
v_mfma_f32_16x16x32_bf16 v[32:35], a[76:79], a[4:7], v[32:35]
v_mfma_f32_16x16x32_bf16 v[48:51], a[76:79], a[12:15], v[48:51]
s_waitcnt lgkmcnt(0)
s_barrier
v_mfma_f32_16x16x32_bf16 v[48:51], a[72:75], a[8:11], v[48:51]
s_add_u32 m0, s77, 131072
ds_read_b64_tr_b16 a[104:105], v19 offset:4096
v_mfma_f32_16x16x32_bf16 v[64:67], a[72:75], a[16:19], v[64:67]
s_add_u32 s64, s71, 4718592
ds_read_b64_tr_b16 a[106:107], v19 offset:4352
v_mfma_f32_16x16x32_bf16 v[64:67], a[76:79], a[20:23], v[64:67]
buffer_load_dwordx4 v14, s[56:59], s64 offen lds
v_mfma_f32_16x16x32_bf16 v[80:83], a[76:79], a[28:31], v[80:83]
ds_read_b64_tr_b16 a[108:109], v19 offset:6144
v_mfma_f32_16x16x32_bf16 v[80:83], a[72:75], a[24:27], v[80:83]
ds_read_b64_tr_b16 a[110:111], v19 offset:6400
v_mfma_f32_16x16x32_bf16 v[144:147], a[80:83], a[24:27], v[144:147]
ds_read_b64_tr_b16 a[112:113], v20 offset:4096
v_mfma_f32_16x16x32_bf16 v[144:147], a[84:87], a[28:31], v[144:147]
ds_read_b64_tr_b16 a[114:115], v20 offset:4352
v_mfma_f32_16x16x32_bf16 v[128:131], a[84:87], a[20:23], v[128:131]
ds_read_b64_tr_b16 a[116:117], v20 offset:6144
v_mfma_f32_16x16x32_bf16 v[128:131], a[80:83], a[16:19], v[128:131]
ds_read_b64_tr_b16 a[118:119], v20 offset:6400
v_mfma_f32_16x16x32_bf16 v[112:115], a[80:83], a[8:11], v[112:115]
s_add_u32 m0, s78, 147456
ds_read_b64_tr_b16 a[72:73], v19 offset:8192
v_mfma_f32_16x16x32_bf16 v[112:115], a[84:87], a[12:15], v[112:115]
s_add_u32 s64, s75, 3538944
ds_read_b64_tr_b16 a[74:75], v19 offset:8448
v_mfma_f32_16x16x32_bf16 v[96:99], a[84:87], a[4:7], v[96:99]
buffer_load_dwordx4 v23, s[60:63], s64 offen lds
v_mfma_f32_16x16x32_bf16 v[96:99], a[80:83], a[0:3], v[96:99]
ds_read_b64_tr_b16 a[76:77], v19 offset:10240
v_mfma_f32_16x16x32_bf16 v[36:39], a[88:91], a[0:3], v[36:39]
ds_read_b64_tr_b16 a[78:79], v19 offset:10496
v_mfma_f32_16x16x32_bf16 v[36:39], a[92:95], a[4:7], v[36:39]
ds_read_b64_tr_b16 a[80:81], v20 offset:8192
v_mfma_f32_16x16x32_bf16 v[52:55], a[92:95], a[12:15], v[52:55]
ds_read_b64_tr_b16 a[82:83], v20 offset:8448
v_mfma_f32_16x16x32_bf16 v[52:55], a[88:91], a[8:11], v[52:55]
ds_read_b64_tr_b16 a[84:85], v20 offset:10240
v_mfma_f32_16x16x32_bf16 v[68:71], a[88:91], a[16:19], v[68:71]
ds_read_b64_tr_b16 a[86:87], v20 offset:10496
v_mfma_f32_16x16x32_bf16 v[68:71], a[92:95], a[20:23], v[68:71]
s_add_u32 m0, s77, 132096
v_mfma_f32_16x16x32_bf16 v[84:87], a[92:95], a[28:31], v[84:87]
s_add_u32 s64, s71, 4751360
v_mfma_f32_16x16x32_bf16 v[84:87], a[88:91], a[24:27], v[84:87]
buffer_load_dwordx4 v14, s[56:59], s64 offen lds
v_mfma_f32_16x16x32_bf16 v[148:151], a[96:99], a[24:27], v[148:151]
ds_read_b64_tr_b16 a[88:89], v19 offset:0
v_mfma_f32_16x16x32_bf16 v[148:151], a[100:103], a[28:31], v[148:151]
ds_read_b64_tr_b16 a[90:91], v19 offset:256
v_mfma_f32_16x16x32_bf16 v[132:135], a[100:103], a[20:23], v[132:135]
ds_read_b64_tr_b16 a[92:93], v19 offset:2048
v_mfma_f32_16x16x32_bf16 v[132:135], a[96:99], a[16:19], v[132:135]
ds_read_b64_tr_b16 a[94:95], v19 offset:2304
v_mfma_f32_16x16x32_bf16 v[116:119], a[96:99], a[8:11], v[116:119]
v_mfma_f32_16x16x32_bf16 v[116:119], a[100:103], a[12:15], v[116:119]
v_mfma_f32_16x16x32_bf16 v[100:103], a[100:103], a[4:7], v[100:103]
s_add_u32 m0, s78, 151552
v_mfma_f32_16x16x32_bf16 v[100:103], a[96:99], a[0:3], v[100:103]
s_waitcnt lgkmcnt(4)
s_add_u32 s64, s75, 3540992
ds_read_b64_tr_b16 a[96:97], v20 offset:0
v_mfma_f32_16x16x32_bf16 v[184:187], a[104:107], a[32:35], v[184:187]
buffer_load_dwordx4 v23, s[60:63], s64 offen lds
v_mfma_f32_16x16x32_bf16 v[184:187], a[108:111], a[36:39], v[184:187]
ds_read_b64_tr_b16 a[98:99], v20 offset:256
v_mfma_f32_16x16x32_bf16 v[192:195], a[108:111], a[44:47], v[192:195]
ds_read_b64_tr_b16 a[100:101], v20 offset:2048
v_mfma_f32_16x16x32_bf16 v[192:195], a[104:107], a[40:43], v[192:195]
ds_read_b64_tr_b16 a[102:103], v20 offset:2304
v_mfma_f32_16x16x32_bf16 v[200:203], a[104:107], a[48:51], v[200:203]
v_mfma_f32_16x16x32_bf16 v[200:203], a[108:111], a[52:55], v[200:203]
v_mfma_f32_16x16x32_bf16 v[208:211], a[108:111], a[60:63], v[208:211]
v_mfma_f32_16x16x32_bf16 v[208:211], a[104:107], a[56:59], v[208:211]
ds_read_b64_tr_b16 a[104:105], v4 offset:0
v_mfma_f32_16x16x32_bf16 v[212:215], a[112:115], a[56:59], v[212:215]
s_add_u32 m0, s77, 133120
ds_read_b64_tr_b16 a[106:107], v4 offset:1024
v_mfma_f32_16x16x32_bf16 v[212:215], a[116:119], a[60:63], v[212:215]
s_add_u32 s64, s71, 4784128
ds_read_b64_tr_b16 a[108:109], v4 offset:8192
v_mfma_f32_16x16x32_bf16 v[204:207], a[116:119], a[52:55], v[204:207]
buffer_load_dwordx4 v15, s[56:59], s64 offen lds
v_mfma_f32_16x16x32_bf16 v[204:207], a[112:115], a[48:51], v[204:207]
ds_read_b64_tr_b16 a[110:111], v4 offset:9216
v_mfma_f32_16x16x32_bf16 v[196:199], a[112:115], a[40:43], v[196:199]
v_mfma_f32_16x16x32_bf16 v[196:199], a[116:119], a[44:47], v[196:199]
v_mfma_f32_16x16x32_bf16 v[188:191], a[116:119], a[36:39], v[188:191]
s_add_u32 s65, s79, 9216
v_mfma_f32_16x16x32_bf16 v[188:191], a[112:115], a[32:35], v[188:191]
buffer_store_dwordx4 a[200:203], v16, s[44:47], s65 offen sc1
v_mfma_f32_16x16x32_bf16 v[216:219], a[32:35], a[72:75], v[216:219]
ds_read_b64_tr_b16 a[112:113], v5 offset:0
v_mfma_f32_16x16x32_bf16 v[216:219], a[36:39], a[76:79], v[216:219]
s_add_u32 m0, s78, 155648
ds_read_b64_tr_b16 a[114:115], v5 offset:1024
v_mfma_f32_16x16x32_bf16 v[224:227], a[44:47], a[76:79], v[224:227]
s_add_u32 s64, s75, 3543040
ds_read_b64_tr_b16 a[116:117], v5 offset:8192
v_mfma_f32_16x16x32_bf16 v[224:227], a[40:43], a[72:75], v[224:227]
buffer_load_dwordx4 v23, s[60:63], s64 offen lds
v_mfma_f32_16x16x32_bf16 v[232:235], a[48:51], a[72:75], v[232:235]
ds_read_b64_tr_b16 a[118:119], v5 offset:9216
v_mfma_f32_16x16x32_bf16 v[232:235], a[52:55], a[76:79], v[232:235]
v_mfma_f32_16x16x32_bf16 v[240:243], a[60:63], a[76:79], v[240:243]
v_mfma_f32_16x16x32_bf16 v[240:243], a[56:59], a[72:75], v[240:243]
ds_read_b64_tr_b16 a[72:73], v6 offset:0
v_mfma_f32_16x16x32_bf16 v[244:247], a[56:59], a[80:83], v[244:247]
ds_read_b64_tr_b16 a[74:75], v6 offset:1024
v_mfma_f32_16x16x32_bf16 v[244:247], a[60:63], a[84:87], v[244:247]
ds_read_b64_tr_b16 a[76:77], v6 offset:8192
v_mfma_f32_16x16x32_bf16 v[236:239], a[52:55], a[84:87], v[236:239]
s_add_u32 m0, s77, 134144
ds_read_b64_tr_b16 a[78:79], v6 offset:9216
v_mfma_f32_16x16x32_bf16 v[236:239], a[48:51], a[80:83], v[236:239]
s_add_u32 s64, s71, 4816896
v_mfma_f32_16x16x32_bf16 v[228:231], a[40:43], a[80:83], v[228:231]
buffer_load_dwordx4 v15, s[56:59], s64 offen lds
v_mfma_f32_16x16x32_bf16 v[228:231], a[44:47], a[84:87], v[228:231]
v_mfma_f32_16x16x32_bf16 v[220:223], a[36:39], a[84:87], v[220:223]
v_mfma_f32_16x16x32_bf16 v[220:223], a[32:35], a[80:83], v[220:223]
s_waitcnt lgkmcnt(4)
ds_read_b64_tr_b16 a[80:81], v7 offset:0
v_mfma_f32_16x16x32_bf16 v[152:155], a[88:91], a[32:35], v[152:155]
ds_read_b64_tr_b16 a[82:83], v7 offset:1024
v_mfma_f32_16x16x32_bf16 v[152:155], a[92:95], a[36:39], v[152:155]
ds_read_b64_tr_b16 a[84:85], v7 offset:8192
v_mfma_f32_16x16x32_bf16 v[160:163], a[92:95], a[44:47], v[160:163]
ds_read_b64_tr_b16 a[86:87], v7 offset:9216
v_mfma_f32_16x16x32_bf16 v[160:163], a[88:91], a[40:43], v[160:163]
v_mfma_f32_16x16x32_bf16 v[168:171], a[88:91], a[48:51], v[168:171]
v_mfma_f32_16x16x32_bf16 v[168:171], a[92:95], a[52:55], v[168:171]
v_mfma_f32_16x16x32_bf16 v[176:179], a[92:95], a[60:63], v[176:179]
s_add_u32 m0, s76, 32768
v_mfma_f32_16x16x32_bf16 v[176:179], a[88:91], a[56:59], v[176:179]
s_add_u32 s64, s72, 1152
ds_read_b64_tr_b16 a[88:89], v8 offset:0
v_mfma_f32_16x16x32_bf16 v[180:183], a[96:99], a[56:59], v[180:183]
buffer_load_dwordx4 v12, s[48:51], s64 offen lds
v_mfma_f32_16x16x32_bf16 v[180:183], a[100:103], a[60:63], v[180:183]
ds_read_b64_tr_b16 a[90:91], v8 offset:1024
v_mfma_f32_16x16x32_bf16 v[172:175], a[100:103], a[52:55], v[172:175]
ds_read_b64_tr_b16 a[92:93], v8 offset:8192
v_mfma_f32_16x16x32_bf16 v[172:175], a[96:99], a[48:51], v[172:175]
s_add_u32 m0, s76, 33792
ds_read_b64_tr_b16 a[94:95], v8 offset:9216
v_mfma_f32_16x16x32_bf16 v[164:167], a[96:99], a[40:43], v[164:167]
s_add_u32 s64, s72, 17536
v_mfma_f32_16x16x32_bf16 v[164:167], a[100:103], a[44:47], v[164:167]
buffer_load_dwordx4 v13, s[48:51], s64 offen lds
v_mfma_f32_16x16x32_bf16 v[156:159], a[100:103], a[36:39], v[156:159]
v_mfma_f32_16x16x32_bf16 v[156:159], a[96:99], a[32:35], v[156:159]
ds_read_b64_tr_b16 a[96:97], v9 offset:0
v_mfma_f32_16x16x32_bf16 v[24:27], a[104:107], a[32:35], v[24:27]
s_add_u32 m0, s76, 34816
ds_read_b64_tr_b16 a[98:99], v9 offset:1024
v_mfma_f32_16x16x32_bf16 v[24:27], a[108:111], a[36:39], v[24:27]
s_add_u32 s64, s72, 132224
ds_read_b64_tr_b16 a[100:101], v9 offset:8192
v_mfma_f32_16x16x32_bf16 v[40:43], a[108:111], a[44:47], v[40:43]
buffer_load_dwordx4 v12, s[48:51], s64 offen lds
v_mfma_f32_16x16x32_bf16 v[40:43], a[104:107], a[40:43], v[40:43]
ds_read_b64_tr_b16 a[102:103], v9 offset:9216
v_mfma_f32_16x16x32_bf16 v[56:59], a[104:107], a[48:51], v[56:59]
v_mfma_f32_16x16x32_bf16 v[56:59], a[108:111], a[52:55], v[56:59]
s_add_u32 m0, s76, 35840
v_mfma_f32_16x16x32_bf16 v[72:75], a[108:111], a[60:63], v[72:75]
s_waitcnt vmcnt(12)
s_add_u32 s64, s72, 148608
ds_read_b128 a[0:3], v2 offset:0
v_mfma_f32_16x16x32_bf16 v[72:75], a[104:107], a[56:59], v[72:75]
buffer_load_dwordx4 v13, s[48:51], s64 offen lds
v_mfma_f32_16x16x32_bf16 v[136:139], a[112:115], a[56:59], v[136:139]
ds_read_b128 a[4:7], v3 offset:0
v_mfma_f32_16x16x32_bf16 v[136:139], a[116:119], a[60:63], v[136:139]
ds_read_b128 a[8:11], v2 offset:2048
v_mfma_f32_16x16x32_bf16 v[120:123], a[116:119], a[52:55], v[120:123]
s_add_u32 m0, s76, 36864
ds_read_b128 a[12:15], v3 offset:2048
v_mfma_f32_16x16x32_bf16 v[120:123], a[112:115], a[48:51], v[120:123]
s_add_u32 s64, s73, 1152
ds_read_b128 a[16:19], v2 offset:4096
v_mfma_f32_16x16x32_bf16 v[104:107], a[112:115], a[40:43], v[104:107]
buffer_load_dwordx4 v12, s[48:51], s64 offen lds
v_mfma_f32_16x16x32_bf16 v[104:107], a[116:119], a[44:47], v[104:107]
ds_read_b128 a[20:23], v3 offset:4096
v_mfma_f32_16x16x32_bf16 v[88:91], a[116:119], a[36:39], v[88:91]
ds_read_b128 a[24:27], v2 offset:6144
v_mfma_f32_16x16x32_bf16 v[88:91], a[112:115], a[32:35], v[88:91]
s_waitcnt lgkmcnt(7)
s_add_u32 m0, s76, 37888
ds_read_b128 a[28:31], v3 offset:6144
v_mfma_f32_16x16x32_bf16 v[28:31], a[72:75], a[32:35], v[28:31]
s_add_u32 s64, s73, 17536
ds_read_b64_tr_b16 a[104:105], v10 offset:0
v_mfma_f32_16x16x32_bf16 v[28:31], a[76:79], a[36:39], v[28:31]
s_add_u32 s65, s79, 26624
buffer_load_dwordx4 v13, s[48:51], s64 offen lds
v_mfma_f32_16x16x32_bf16 v[44:47], a[76:79], a[44:47], v[44:47]
buffer_store_dwordx4 a[204:207], v16, s[44:47], s65 offen sc1
v_mfma_f32_16x16x32_bf16 v[44:47], a[72:75], a[40:43], v[44:47]
ds_read_b64_tr_b16 a[106:107], v10 offset:1024
v_mfma_f32_16x16x32_bf16 v[60:63], a[72:75], a[48:51], v[60:63]
s_add_u32 m0, s76, 38912
ds_read_b64_tr_b16 a[108:109], v10 offset:8192
v_mfma_f32_16x16x32_bf16 v[60:63], a[76:79], a[52:55], v[60:63]
s_add_u32 s64, s73, 132224
ds_read_b64_tr_b16 a[110:111], v10 offset:9216
v_mfma_f32_16x16x32_bf16 v[76:79], a[76:79], a[60:63], v[76:79]
buffer_load_dwordx4 v12, s[48:51], s64 offen lds
v_mfma_f32_16x16x32_bf16 v[76:79], a[72:75], a[56:59], v[76:79]
ds_read_b64_tr_b16 a[112:113], v11 offset:0
v_mfma_f32_16x16x32_bf16 v[140:143], a[80:83], a[56:59], v[140:143]
ds_read_b64_tr_b16 a[114:115], v11 offset:1024
v_mfma_f32_16x16x32_bf16 v[140:143], a[84:87], a[60:63], v[140:143]
s_add_u32 m0, s76, 39936
ds_read_b64_tr_b16 a[116:117], v11 offset:8192
v_mfma_f32_16x16x32_bf16 v[124:127], a[84:87], a[52:55], v[124:127]
s_add_u32 s64, s73, 148608
ds_read_b64_tr_b16 a[118:119], v11 offset:9216
v_mfma_f32_16x16x32_bf16 v[124:127], a[80:83], a[48:51], v[124:127]
buffer_load_dwordx4 v13, s[48:51], s64 offen lds
v_mfma_f32_16x16x32_bf16 v[108:111], a[80:83], a[40:43], v[108:111]
v_mfma_f32_16x16x32_bf16 v[108:111], a[84:87], a[44:47], v[108:111]
v_mfma_f32_16x16x32_bf16 v[92:95], a[84:87], a[36:39], v[92:95]
v_mfma_f32_16x16x32_bf16 v[92:95], a[80:83], a[32:35], v[92:95]
v_mfma_f32_16x16x32_bf16 v[32:35], a[88:91], a[32:35], v[32:35]
v_mfma_f32_16x16x32_bf16 v[32:35], a[92:95], a[36:39], v[32:35]
v_mfma_f32_16x16x32_bf16 v[48:51], a[92:95], a[44:47], v[48:51]
s_waitcnt lgkmcnt(0)
s_barrier
v_mfma_f32_16x16x32_bf16 v[48:51], a[88:91], a[40:43], v[48:51]
s_add_u32 m0, s77, 65536
ds_read_b64_tr_b16 a[72:73], v19 offset:36864
v_mfma_f32_16x16x32_bf16 v[64:67], a[88:91], a[48:51], v[64:67]
s_add_u32 s64, s71, 5242880
ds_read_b64_tr_b16 a[74:75], v19 offset:37120
v_mfma_f32_16x16x32_bf16 v[64:67], a[92:95], a[52:55], v[64:67]
buffer_load_dwordx4 v14, s[56:59], s64 offen lds
v_mfma_f32_16x16x32_bf16 v[80:83], a[92:95], a[60:63], v[80:83]
ds_read_b64_tr_b16 a[76:77], v19 offset:38912
v_mfma_f32_16x16x32_bf16 v[80:83], a[88:91], a[56:59], v[80:83]
ds_read_b64_tr_b16 a[78:79], v19 offset:39168
v_mfma_f32_16x16x32_bf16 v[144:147], a[96:99], a[56:59], v[144:147]
ds_read_b64_tr_b16 a[80:81], v20 offset:36864
v_mfma_f32_16x16x32_bf16 v[144:147], a[100:103], a[60:63], v[144:147]
ds_read_b64_tr_b16 a[82:83], v20 offset:37120
v_mfma_f32_16x16x32_bf16 v[128:131], a[100:103], a[52:55], v[128:131]
ds_read_b64_tr_b16 a[84:85], v20 offset:38912
v_mfma_f32_16x16x32_bf16 v[128:131], a[96:99], a[48:51], v[128:131]
ds_read_b64_tr_b16 a[86:87], v20 offset:39168
v_mfma_f32_16x16x32_bf16 v[112:115], a[96:99], a[40:43], v[112:115]
s_add_u32 m0, s78, 81920
ds_read_b64_tr_b16 a[88:89], v19 offset:40960
v_mfma_f32_16x16x32_bf16 v[112:115], a[100:103], a[44:47], v[112:115]
s_add_u32 s64, s75, 3932160
ds_read_b64_tr_b16 a[90:91], v19 offset:41216
v_mfma_f32_16x16x32_bf16 v[96:99], a[100:103], a[36:39], v[96:99]
buffer_load_dwordx4 v23, s[60:63], s64 offen lds
v_mfma_f32_16x16x32_bf16 v[96:99], a[96:99], a[32:35], v[96:99]
ds_read_b64_tr_b16 a[92:93], v19 offset:43008
v_mfma_f32_16x16x32_bf16 v[36:39], a[104:107], a[32:35], v[36:39]
ds_read_b64_tr_b16 a[94:95], v19 offset:43264
v_mfma_f32_16x16x32_bf16 v[36:39], a[108:111], a[36:39], v[36:39]
ds_read_b64_tr_b16 a[96:97], v20 offset:40960
v_mfma_f32_16x16x32_bf16 v[52:55], a[108:111], a[44:47], v[52:55]
ds_read_b64_tr_b16 a[98:99], v20 offset:41216
v_mfma_f32_16x16x32_bf16 v[52:55], a[104:107], a[40:43], v[52:55]
ds_read_b64_tr_b16 a[100:101], v20 offset:43008
v_mfma_f32_16x16x32_bf16 v[68:71], a[104:107], a[48:51], v[68:71]
ds_read_b64_tr_b16 a[102:103], v20 offset:43264
v_mfma_f32_16x16x32_bf16 v[68:71], a[108:111], a[52:55], v[68:71]
s_add_u32 m0, s77, 66560
v_mfma_f32_16x16x32_bf16 v[84:87], a[108:111], a[60:63], v[84:87]
s_add_u32 s64, s71, 5275648
v_mfma_f32_16x16x32_bf16 v[84:87], a[104:107], a[56:59], v[84:87]
buffer_load_dwordx4 v14, s[56:59], s64 offen lds
v_mfma_f32_16x16x32_bf16 v[148:151], a[112:115], a[56:59], v[148:151]
ds_read_b64_tr_b16 a[104:105], v19 offset:32768
v_mfma_f32_16x16x32_bf16 v[148:151], a[116:119], a[60:63], v[148:151]
ds_read_b64_tr_b16 a[106:107], v19 offset:33024
v_mfma_f32_16x16x32_bf16 v[132:135], a[116:119], a[52:55], v[132:135]
ds_read_b64_tr_b16 a[108:109], v19 offset:34816
v_mfma_f32_16x16x32_bf16 v[132:135], a[112:115], a[48:51], v[132:135]
ds_read_b64_tr_b16 a[110:111], v19 offset:35072
v_mfma_f32_16x16x32_bf16 v[116:119], a[112:115], a[40:43], v[116:119]
v_mfma_f32_16x16x32_bf16 v[116:119], a[116:119], a[44:47], v[116:119]
v_mfma_f32_16x16x32_bf16 v[100:103], a[116:119], a[36:39], v[100:103]
s_add_u32 m0, s78, 86016
v_mfma_f32_16x16x32_bf16 v[100:103], a[112:115], a[32:35], v[100:103]
s_waitcnt lgkmcnt(4)
s_add_u32 s64, s75, 3934208
ds_read_b64_tr_b16 a[112:113], v20 offset:32768
v_mfma_f32_16x16x32_bf16 v[184:187], a[72:75], a[0:3], v[184:187]
buffer_load_dwordx4 v23, s[60:63], s64 offen lds
v_mfma_f32_16x16x32_bf16 v[184:187], a[76:79], a[4:7], v[184:187]
s_add_u32 s65, s79, 27648
ds_read_b64_tr_b16 a[114:115], v20 offset:33024
v_mfma_f32_16x16x32_bf16 v[192:195], a[76:79], a[12:15], v[192:195]
buffer_store_dwordx4 a[208:211], v16, s[44:47], s65 offen sc1
v_mfma_f32_16x16x32_bf16 v[192:195], a[72:75], a[8:11], v[192:195]
s_add_u32 s17, s78, .-L_pc+6144
ds_read_b64_tr_b16 a[116:117], v20 offset:34816
v_mfma_f32_16x16x32_bf16 v[200:203], a[72:75], a[16:19], v[200:203]
buffer_load_dword a252, v16, s[88:91], s17 offen
v_mfma_f32_16x16x32_bf16 v[200:203], a[76:79], a[20:23], v[200:203]
ds_read_b64_tr_b16 a[118:119], v20 offset:35072
v_mfma_f32_16x16x32_bf16 v[208:211], a[76:79], a[28:31], v[208:211]
v_mfma_f32_16x16x32_bf16 v[208:211], a[72:75], a[24:27], v[208:211]
ds_read_b64_tr_b16 a[72:73], v4 offset:32768
v_mfma_f32_16x16x32_bf16 v[212:215], a[80:83], a[24:27], v[212:215]
s_add_u32 m0, s77, 67584
ds_read_b64_tr_b16 a[74:75], v4 offset:33792
v_mfma_f32_16x16x32_bf16 v[212:215], a[84:87], a[28:31], v[212:215]
s_add_u32 s64, s71, 5308416
ds_read_b64_tr_b16 a[76:77], v4 offset:40960
v_mfma_f32_16x16x32_bf16 v[204:207], a[84:87], a[20:23], v[204:207]
buffer_load_dwordx4 v15, s[56:59], s64 offen lds
v_mfma_f32_16x16x32_bf16 v[204:207], a[80:83], a[16:19], v[204:207]
ds_read_b64_tr_b16 a[78:79], v4 offset:41984
v_mfma_f32_16x16x32_bf16 v[196:199], a[80:83], a[8:11], v[196:199]
v_mfma_f32_16x16x32_bf16 v[196:199], a[84:87], a[12:15], v[196:199]
v_mfma_f32_16x16x32_bf16 v[188:191], a[84:87], a[4:7], v[188:191]
v_mfma_f32_16x16x32_bf16 v[188:191], a[80:83], a[0:3], v[188:191]
ds_read_b64_tr_b16 a[80:81], v5 offset:32768
v_mfma_f32_16x16x32_bf16 v[216:219], a[0:3], a[88:91], v[216:219]
ds_read_b64_tr_b16 a[82:83], v5 offset:33792
v_mfma_f32_16x16x32_bf16 v[216:219], a[4:7], a[92:95], v[216:219]
s_add_u32 m0, s78, 90112
ds_read_b64_tr_b16 a[84:85], v5 offset:40960
v_mfma_f32_16x16x32_bf16 v[224:227], a[12:15], a[92:95], v[224:227]
s_add_u32 s64, s75, 3936256
ds_read_b64_tr_b16 a[86:87], v5 offset:41984
v_mfma_f32_16x16x32_bf16 v[224:227], a[8:11], a[88:91], v[224:227]
buffer_load_dwordx4 v23, s[60:63], s64 offen lds
v_mfma_f32_16x16x32_bf16 v[232:235], a[16:19], a[88:91], v[232:235]
v_mfma_f32_16x16x32_bf16 v[232:235], a[20:23], a[92:95], v[232:235]
v_mfma_f32_16x16x32_bf16 v[240:243], a[28:31], a[92:95], v[240:243]
v_mfma_f32_16x16x32_bf16 v[240:243], a[24:27], a[88:91], v[240:243]
ds_read_b64_tr_b16 a[88:89], v6 offset:32768
v_mfma_f32_16x16x32_bf16 v[244:247], a[24:27], a[96:99], v[244:247]
ds_read_b64_tr_b16 a[90:91], v6 offset:33792
v_mfma_f32_16x16x32_bf16 v[244:247], a[28:31], a[100:103], v[244:247]
ds_read_b64_tr_b16 a[92:93], v6 offset:40960
v_add_u32 v19, 0x8000, v19
v_mfma_f32_16x16x32_bf16 v[236:239], a[20:23], a[100:103], v[236:239]
s_add_u32 m0, s77, 68608
ds_read_b64_tr_b16 a[94:95], v6 offset:41984
v_mfma_f32_16x16x32_bf16 v[236:239], a[16:19], a[96:99], v[236:239]
s_add_u32 s64, s71, 5341184
v_mfma_f32_16x16x32_bf16 v[228:231], a[8:11], a[96:99], v[228:231]
buffer_load_dwordx4 v15, s[56:59], s64 offen lds
v_mfma_f32_16x16x32_bf16 v[228:231], a[12:15], a[100:103], v[228:231]
v_mfma_f32_16x16x32_bf16 v[220:223], a[4:7], a[100:103], v[220:223]
v_mfma_f32_16x16x32_bf16 v[220:223], a[0:3], a[96:99], v[220:223]
s_waitcnt lgkmcnt(4)
ds_read_b64_tr_b16 a[96:97], v7 offset:32768
v_mfma_f32_16x16x32_bf16 v[152:155], a[104:107], a[0:3], v[152:155]
ds_read_b64_tr_b16 a[98:99], v7 offset:33792
v_mfma_f32_16x16x32_bf16 v[152:155], a[108:111], a[4:7], v[152:155]
ds_read_b64_tr_b16 a[100:101], v7 offset:40960
v_add_u32 v20, 0x8000, v20
v_mfma_f32_16x16x32_bf16 v[160:163], a[108:111], a[12:15], v[160:163]
ds_read_b64_tr_b16 a[102:103], v7 offset:41984
v_mfma_f32_16x16x32_bf16 v[160:163], a[104:107], a[8:11], v[160:163]
v_mfma_f32_16x16x32_bf16 v[168:171], a[104:107], a[16:19], v[168:171]
v_mfma_f32_16x16x32_bf16 v[168:171], a[108:111], a[20:23], v[168:171]
v_mfma_f32_16x16x32_bf16 v[176:179], a[108:111], a[28:31], v[176:179]
s_add_u32 m0, s76, 0
v_mfma_f32_16x16x32_bf16 v[176:179], a[104:107], a[24:27], v[176:179]
s_add_u32 s64, s72, 1280
ds_read_b64_tr_b16 a[104:105], v8 offset:32768
v_mfma_f32_16x16x32_bf16 v[180:183], a[112:115], a[24:27], v[180:183]
buffer_load_dwordx4 v12, s[48:51], s64 offen lds
v_mfma_f32_16x16x32_bf16 v[180:183], a[116:119], a[28:31], v[180:183]
ds_read_b64_tr_b16 a[106:107], v8 offset:33792
v_add_u32 v4, 0x8000, v4
v_mfma_f32_16x16x32_bf16 v[172:175], a[116:119], a[20:23], v[172:175]
ds_read_b64_tr_b16 a[108:109], v8 offset:40960
v_mfma_f32_16x16x32_bf16 v[172:175], a[112:115], a[16:19], v[172:175]
s_add_u32 m0, s76, 1024
ds_read_b64_tr_b16 a[110:111], v8 offset:41984
v_mfma_f32_16x16x32_bf16 v[164:167], a[112:115], a[8:11], v[164:167]
s_add_u32 s64, s72, 17664
v_mfma_f32_16x16x32_bf16 v[164:167], a[116:119], a[12:15], v[164:167]
buffer_load_dwordx4 v13, s[48:51], s64 offen lds
v_mfma_f32_16x16x32_bf16 v[156:159], a[116:119], a[4:7], v[156:159]
v_mfma_f32_16x16x32_bf16 v[156:159], a[112:115], a[0:3], v[156:159]
ds_read_b64_tr_b16 a[112:113], v9 offset:32768
v_mfma_f32_16x16x32_bf16 v[24:27], a[72:75], a[0:3], v[24:27]
s_add_u32 m0, s76, 2048
ds_read_b64_tr_b16 a[114:115], v9 offset:33792
v_mfma_f32_16x16x32_bf16 v[24:27], a[76:79], a[4:7], v[24:27]
s_add_u32 s64, s72, 132352
ds_read_b64_tr_b16 a[116:117], v9 offset:40960
v_add_u32 v5, 0x8000, v5
v_mfma_f32_16x16x32_bf16 v[40:43], a[76:79], a[12:15], v[40:43]
buffer_load_dwordx4 v12, s[48:51], s64 offen lds
v_mfma_f32_16x16x32_bf16 v[40:43], a[72:75], a[8:11], v[40:43]
s_add_u32 s65, s79, 11264
ds_read_b64_tr_b16 a[118:119], v9 offset:41984
v_mfma_f32_16x16x32_bf16 v[56:59], a[72:75], a[16:19], v[56:59]
buffer_store_dwordx4 a[212:215], v16, s[44:47], s65 offen sc1
v_mfma_f32_16x16x32_bf16 v[56:59], a[76:79], a[20:23], v[56:59]
s_add_u32 m0, s76, 3072
v_mfma_f32_16x16x32_bf16 v[72:75], a[76:79], a[28:31], v[72:75]
s_waitcnt vmcnt(13)
s_add_u32 s64, s72, 148736
ds_read_b128 a[32:35], v2 offset:32768
v_mfma_f32_16x16x32_bf16 v[72:75], a[72:75], a[24:27], v[72:75]
buffer_load_dwordx4 v13, s[48:51], s64 offen lds
v_mfma_f32_16x16x32_bf16 v[136:139], a[80:83], a[24:27], v[136:139]
ds_read_b128 a[36:39], v3 offset:32768
v_mfma_f32_16x16x32_bf16 v[136:139], a[84:87], a[28:31], v[136:139]
ds_read_b128 a[40:43], v2 offset:34816
v_add_u32 v6, 0x8000, v6
v_mfma_f32_16x16x32_bf16 v[120:123], a[84:87], a[20:23], v[120:123]
s_add_u32 m0, s76, 4096
ds_read_b128 a[44:47], v3 offset:34816
v_mfma_f32_16x16x32_bf16 v[120:123], a[80:83], a[16:19], v[120:123]
s_add_u32 s64, s73, 1280
ds_read_b128 a[48:51], v2 offset:36864
v_mfma_f32_16x16x32_bf16 v[104:107], a[80:83], a[8:11], v[104:107]
buffer_load_dwordx4 v12, s[48:51], s64 offen lds
v_mfma_f32_16x16x32_bf16 v[104:107], a[84:87], a[12:15], v[104:107]
ds_read_b128 a[52:55], v3 offset:36864
v_mfma_f32_16x16x32_bf16 v[88:91], a[84:87], a[4:7], v[88:91]
ds_read_b128 a[56:59], v2 offset:38912
v_mfma_f32_16x16x32_bf16 v[88:91], a[80:83], a[0:3], v[88:91]
s_waitcnt lgkmcnt(7)
s_add_u32 m0, s76, 5120
ds_read_b128 a[60:63], v3 offset:38912
v_mfma_f32_16x16x32_bf16 v[28:31], a[88:91], a[0:3], v[28:31]
s_add_u32 s64, s73, 17664
ds_read_b64_tr_b16 a[72:73], v10 offset:32768
v_mfma_f32_16x16x32_bf16 v[28:31], a[92:95], a[4:7], v[28:31]
buffer_load_dwordx4 v13, s[48:51], s64 offen lds
v_mfma_f32_16x16x32_bf16 v[44:47], a[92:95], a[12:15], v[44:47]
ds_read_b64_tr_b16 a[74:75], v10 offset:33792
v_add_u32 v7, 0x8000, v7
v_mfma_f32_16x16x32_bf16 v[44:47], a[88:91], a[8:11], v[44:47]
ds_read_b64_tr_b16 a[76:77], v10 offset:40960
v_mfma_f32_16x16x32_bf16 v[60:63], a[88:91], a[16:19], v[60:63]
s_add_u32 m0, s76, 6144
ds_read_b64_tr_b16 a[78:79], v10 offset:41984
v_mfma_f32_16x16x32_bf16 v[60:63], a[92:95], a[20:23], v[60:63]
s_add_u32 s64, s73, 132352
ds_read_b64_tr_b16 a[80:81], v11 offset:32768
v_mfma_f32_16x16x32_bf16 v[76:79], a[92:95], a[28:31], v[76:79]
buffer_load_dwordx4 v12, s[48:51], s64 offen lds
v_mfma_f32_16x16x32_bf16 v[76:79], a[88:91], a[24:27], v[76:79]
ds_read_b64_tr_b16 a[82:83], v11 offset:33792
v_mfma_f32_16x16x32_bf16 v[140:143], a[96:99], a[24:27], v[140:143]
ds_read_b64_tr_b16 a[84:85], v11 offset:40960
v_mfma_f32_16x16x32_bf16 v[140:143], a[100:103], a[28:31], v[140:143]
s_add_u32 m0, s76, 7168
ds_read_b64_tr_b16 a[86:87], v11 offset:41984
v_add_u32 v8, 0x8000, v8
v_mfma_f32_16x16x32_bf16 v[124:127], a[100:103], a[20:23], v[124:127]
s_add_u32 s64, s73, 148736
v_mfma_f32_16x16x32_bf16 v[124:127], a[96:99], a[16:19], v[124:127]
buffer_load_dwordx4 v13, s[48:51], s64 offen lds
v_mfma_f32_16x16x32_bf16 v[108:111], a[96:99], a[8:11], v[108:111]
v_mfma_f32_16x16x32_bf16 v[108:111], a[100:103], a[12:15], v[108:111]
v_mfma_f32_16x16x32_bf16 v[92:95], a[100:103], a[4:7], v[92:95]
v_add_u32 v9, 0x8000, v9
v_add_u32 v10, 0x8000, v10
v_mfma_f32_16x16x32_bf16 v[92:95], a[96:99], a[0:3], v[92:95]
v_add_u32 v11, 0x8000, v11
v_mfma_f32_16x16x32_bf16 v[32:35], a[104:107], a[0:3], v[32:35]
v_mfma_f32_16x16x32_bf16 v[32:35], a[108:111], a[4:7], v[32:35]
v_mfma_f32_16x16x32_bf16 v[48:51], a[108:111], a[12:15], v[48:51]
s_waitcnt lgkmcnt(0)
s_barrier
v_mfma_f32_16x16x32_bf16 v[48:51], a[104:107], a[8:11], v[48:51]
s_add_u32 m0, s77, 98304
ds_read_b64_tr_b16 a[88:89], v19 offset:36864
v_mfma_f32_16x16x32_bf16 v[64:67], a[104:107], a[16:19], v[64:67]
s_add_u32 s64, s71, 5767168
ds_read_b64_tr_b16 a[90:91], v19 offset:37120
v_mfma_f32_16x16x32_bf16 v[64:67], a[108:111], a[20:23], v[64:67]
buffer_load_dwordx4 v14, s[56:59], s64 offen lds
v_mfma_f32_16x16x32_bf16 v[80:83], a[108:111], a[28:31], v[80:83]
ds_read_b64_tr_b16 a[92:93], v19 offset:38912
v_mfma_f32_16x16x32_bf16 v[80:83], a[104:107], a[24:27], v[80:83]
ds_read_b64_tr_b16 a[94:95], v19 offset:39168
v_mfma_f32_16x16x32_bf16 v[144:147], a[112:115], a[24:27], v[144:147]
ds_read_b64_tr_b16 a[96:97], v20 offset:36864
v_mfma_f32_16x16x32_bf16 v[144:147], a[116:119], a[28:31], v[144:147]
ds_read_b64_tr_b16 a[98:99], v20 offset:37120
v_mfma_f32_16x16x32_bf16 v[128:131], a[116:119], a[20:23], v[128:131]
ds_read_b64_tr_b16 a[100:101], v20 offset:38912
v_mfma_f32_16x16x32_bf16 v[128:131], a[112:115], a[16:19], v[128:131]
ds_read_b64_tr_b16 a[102:103], v20 offset:39168
v_mfma_f32_16x16x32_bf16 v[112:115], a[112:115], a[8:11], v[112:115]
s_add_u32 m0, s78, 114688
ds_read_b64_tr_b16 a[104:105], v19 offset:40960
v_mfma_f32_16x16x32_bf16 v[112:115], a[116:119], a[12:15], v[112:115]
s_add_u32 s64, s75, 4325376
ds_read_b64_tr_b16 a[106:107], v19 offset:41216
v_mfma_f32_16x16x32_bf16 v[96:99], a[116:119], a[4:7], v[96:99]
buffer_load_dwordx4 v23, s[60:63], s64 offen lds
v_mfma_f32_16x16x32_bf16 v[96:99], a[112:115], a[0:3], v[96:99]
ds_read_b64_tr_b16 a[108:109], v19 offset:43008
v_mfma_f32_16x16x32_bf16 v[36:39], a[72:75], a[0:3], v[36:39]
ds_read_b64_tr_b16 a[110:111], v19 offset:43264
v_mfma_f32_16x16x32_bf16 v[36:39], a[76:79], a[4:7], v[36:39]
ds_read_b64_tr_b16 a[112:113], v20 offset:40960
v_mfma_f32_16x16x32_bf16 v[52:55], a[76:79], a[12:15], v[52:55]
ds_read_b64_tr_b16 a[114:115], v20 offset:41216
v_mfma_f32_16x16x32_bf16 v[52:55], a[72:75], a[8:11], v[52:55]
ds_read_b64_tr_b16 a[116:117], v20 offset:43008
v_mfma_f32_16x16x32_bf16 v[68:71], a[72:75], a[16:19], v[68:71]
s_add_u32 s65, s79, 28672
ds_read_b64_tr_b16 a[118:119], v20 offset:43264
v_mfma_f32_16x16x32_bf16 v[68:71], a[76:79], a[20:23], v[68:71]
s_add_u32 m0, s77, 99328
buffer_store_dwordx4 a[216:219], v16, s[44:47], s65 offen sc1
v_mfma_f32_16x16x32_bf16 v[84:87], a[76:79], a[28:31], v[84:87]
s_add_u32 s64, s71, 5799936
v_mfma_f32_16x16x32_bf16 v[84:87], a[72:75], a[24:27], v[84:87]
buffer_load_dwordx4 v14, s[56:59], s64 offen lds
v_mfma_f32_16x16x32_bf16 v[148:151], a[80:83], a[24:27], v[148:151]
ds_read_b64_tr_b16 a[72:73], v19 offset:32768
v_mfma_f32_16x16x32_bf16 v[148:151], a[84:87], a[28:31], v[148:151]
ds_read_b64_tr_b16 a[74:75], v19 offset:33024
v_mfma_f32_16x16x32_bf16 v[132:135], a[84:87], a[20:23], v[132:135]
ds_read_b64_tr_b16 a[76:77], v19 offset:34816
v_mfma_f32_16x16x32_bf16 v[132:135], a[80:83], a[16:19], v[132:135]
ds_read_b64_tr_b16 a[78:79], v19 offset:35072
v_mfma_f32_16x16x32_bf16 v[116:119], a[80:83], a[8:11], v[116:119]
v_mfma_f32_16x16x32_bf16 v[116:119], a[84:87], a[12:15], v[116:119]
v_mfma_f32_16x16x32_bf16 v[100:103], a[84:87], a[4:7], v[100:103]
s_add_u32 m0, s78, 118784
v_mfma_f32_16x16x32_bf16 v[100:103], a[80:83], a[0:3], v[100:103]
s_waitcnt lgkmcnt(4)
s_add_u32 s64, s75, 4327424
ds_read_b64_tr_b16 a[80:81], v20 offset:32768
v_mfma_f32_16x16x32_bf16 v[184:187], a[88:91], a[32:35], v[184:187]
buffer_load_dwordx4 v23, s[60:63], s64 offen lds
v_mfma_f32_16x16x32_bf16 v[184:187], a[92:95], a[36:39], v[184:187]
ds_read_b64_tr_b16 a[82:83], v20 offset:33024
v_mfma_f32_16x16x32_bf16 v[192:195], a[92:95], a[44:47], v[192:195]
ds_read_b64_tr_b16 a[84:85], v20 offset:34816
v_mfma_f32_16x16x32_bf16 v[192:195], a[88:91], a[40:43], v[192:195]
ds_read_b64_tr_b16 a[86:87], v20 offset:35072
v_mfma_f32_16x16x32_bf16 v[200:203], a[88:91], a[48:51], v[200:203]
s_cmp_eq_u32 s30, 0
s_cselect_b32 s81, 256, 0
v_mfma_f32_16x16x32_bf16 v[200:203], a[92:95], a[52:55], v[200:203]
v_mfma_f32_16x16x32_bf16 v[208:211], a[92:95], a[60:63], v[208:211]
v_mfma_f32_16x16x32_bf16 v[208:211], a[88:91], a[56:59], v[208:211]
ds_read_b64_tr_b16 a[88:89], v4 offset:32768
v_mfma_f32_16x16x32_bf16 v[212:215], a[96:99], a[56:59], v[212:215]
s_add_u32 m0, s77, 100352
ds_read_b64_tr_b16 a[90:91], v4 offset:33792
v_mfma_f32_16x16x32_bf16 v[212:215], a[100:103], a[60:63], v[212:215]
s_add_u32 s64, s71, 5832704
ds_read_b64_tr_b16 a[92:93], v4 offset:40960
v_mfma_f32_16x16x32_bf16 v[204:207], a[100:103], a[52:55], v[204:207]
buffer_load_dwordx4 v15, s[56:59], s64 offen lds
v_mfma_f32_16x16x32_bf16 v[204:207], a[96:99], a[48:51], v[204:207]
ds_read_b64_tr_b16 a[94:95], v4 offset:41984
v_mfma_f32_16x16x32_bf16 v[196:199], a[96:99], a[40:43], v[196:199]
v_mfma_f32_16x16x32_bf16 v[196:199], a[100:103], a[44:47], v[196:199]
v_mfma_f32_16x16x32_bf16 v[188:191], a[100:103], a[36:39], v[188:191]
v_mfma_f32_16x16x32_bf16 v[188:191], a[96:99], a[32:35], v[188:191]
ds_read_b64_tr_b16 a[96:97], v5 offset:32768
v_mfma_f32_16x16x32_bf16 v[216:219], a[32:35], a[104:107], v[216:219]
ds_read_b64_tr_b16 a[98:99], v5 offset:33792
v_mfma_f32_16x16x32_bf16 v[216:219], a[36:39], a[108:111], v[216:219]
s_add_u32 m0, s78, 122880
ds_read_b64_tr_b16 a[100:101], v5 offset:40960
v_mfma_f32_16x16x32_bf16 v[224:227], a[44:47], a[108:111], v[224:227]
s_add_u32 s64, s75, 4329472
ds_read_b64_tr_b16 a[102:103], v5 offset:41984
v_mfma_f32_16x16x32_bf16 v[224:227], a[40:43], a[104:107], v[224:227]
buffer_load_dwordx4 v23, s[60:63], s64 offen lds
v_mfma_f32_16x16x32_bf16 v[232:235], a[48:51], a[104:107], v[232:235]
v_mfma_f32_16x16x32_bf16 v[232:235], a[52:55], a[108:111], v[232:235]
v_mfma_f32_16x16x32_bf16 v[240:243], a[60:63], a[108:111], v[240:243]
v_mfma_f32_16x16x32_bf16 v[240:243], a[56:59], a[104:107], v[240:243]
ds_read_b64_tr_b16 a[104:105], v6 offset:32768
v_mfma_f32_16x16x32_bf16 v[244:247], a[56:59], a[112:115], v[244:247]
ds_read_b64_tr_b16 a[106:107], v6 offset:33792
v_mfma_f32_16x16x32_bf16 v[244:247], a[60:63], a[116:119], v[244:247]
ds_read_b64_tr_b16 a[108:109], v6 offset:40960
v_subrev_u32 v19, 0x8000, v19
v_mfma_f32_16x16x32_bf16 v[236:239], a[52:55], a[116:119], v[236:239]
s_add_u32 m0, s77, 101376
ds_read_b64_tr_b16 a[110:111], v6 offset:41984
v_mfma_f32_16x16x32_bf16 v[236:239], a[48:51], a[112:115], v[236:239]
s_add_u32 s64, s71, 5865472
v_mfma_f32_16x16x32_bf16 v[228:231], a[40:43], a[112:115], v[228:231]
buffer_load_dwordx4 v15, s[56:59], s64 offen lds
v_mfma_f32_16x16x32_bf16 v[228:231], a[44:47], a[116:119], v[228:231]
v_mfma_f32_16x16x32_bf16 v[220:223], a[36:39], a[116:119], v[220:223]
v_mfma_f32_16x16x32_bf16 v[220:223], a[32:35], a[112:115], v[220:223]
s_waitcnt lgkmcnt(4)
ds_read_b64_tr_b16 a[112:113], v7 offset:32768
v_mfma_f32_16x16x32_bf16 v[152:155], a[72:75], a[32:35], v[152:155]
ds_read_b64_tr_b16 a[114:115], v7 offset:33792
v_mfma_f32_16x16x32_bf16 v[152:155], a[76:79], a[36:39], v[152:155]
ds_read_b64_tr_b16 a[116:117], v7 offset:40960
v_subrev_u32 v20, 0x8000, v20
v_mfma_f32_16x16x32_bf16 v[160:163], a[76:79], a[44:47], v[160:163]
ds_read_b64_tr_b16 a[118:119], v7 offset:41984
v_mfma_f32_16x16x32_bf16 v[160:163], a[72:75], a[40:43], v[160:163]
v_mfma_f32_16x16x32_bf16 v[168:171], a[72:75], a[48:51], v[168:171]
v_mfma_f32_16x16x32_bf16 v[168:171], a[76:79], a[52:55], v[168:171]
s_add_u32 s65, s79, 29696
v_mfma_f32_16x16x32_bf16 v[176:179], a[76:79], a[60:63], v[176:179]
s_add_u32 m0, s76, 32768
buffer_store_dwordx4 a[220:223], v16, s[44:47], s65 offen sc1
v_mfma_f32_16x16x32_bf16 v[176:179], a[72:75], a[56:59], v[176:179]
s_add_u32 s64, s72, 1408
ds_read_b64_tr_b16 a[72:73], v8 offset:32768
v_mfma_f32_16x16x32_bf16 v[180:183], a[80:83], a[56:59], v[180:183]
buffer_load_dwordx4 v12, s[48:51], s64 offen lds
v_mfma_f32_16x16x32_bf16 v[180:183], a[84:87], a[60:63], v[180:183]
ds_read_b64_tr_b16 a[74:75], v8 offset:33792
v_subrev_u32 v4, 0x8000, v4
v_mfma_f32_16x16x32_bf16 v[172:175], a[84:87], a[52:55], v[172:175]
ds_read_b64_tr_b16 a[76:77], v8 offset:40960
v_mfma_f32_16x16x32_bf16 v[172:175], a[80:83], a[48:51], v[172:175]
s_add_u32 m0, s76, 33792
ds_read_b64_tr_b16 a[78:79], v8 offset:41984
v_mfma_f32_16x16x32_bf16 v[164:167], a[80:83], a[40:43], v[164:167]
s_add_u32 s64, s72, 17792
v_mfma_f32_16x16x32_bf16 v[164:167], a[84:87], a[44:47], v[164:167]
buffer_load_dwordx4 v13, s[48:51], s64 offen lds
v_mfma_f32_16x16x32_bf16 v[156:159], a[84:87], a[36:39], v[156:159]
v_mfma_f32_16x16x32_bf16 v[156:159], a[80:83], a[32:35], v[156:159]
ds_read_b64_tr_b16 a[80:81], v9 offset:32768
v_mfma_f32_16x16x32_bf16 v[24:27], a[88:91], a[32:35], v[24:27]
s_add_u32 m0, s76, 34816
ds_read_b64_tr_b16 a[82:83], v9 offset:33792
v_mfma_f32_16x16x32_bf16 v[24:27], a[92:95], a[36:39], v[24:27]
s_add_u32 s64, s72, 132480
ds_read_b64_tr_b16 a[84:85], v9 offset:40960
v_subrev_u32 v5, 0x8000, v5
v_mfma_f32_16x16x32_bf16 v[40:43], a[92:95], a[44:47], v[40:43]
buffer_load_dwordx4 v12, s[48:51], s64 offen lds
v_mfma_f32_16x16x32_bf16 v[40:43], a[88:91], a[40:43], v[40:43]
ds_read_b64_tr_b16 a[86:87], v9 offset:41984
v_mfma_f32_16x16x32_bf16 v[56:59], a[88:91], a[48:51], v[56:59]
v_mfma_f32_16x16x32_bf16 v[56:59], a[92:95], a[52:55], v[56:59]
s_add_u32 m0, s76, 35840
v_mfma_f32_16x16x32_bf16 v[72:75], a[92:95], a[60:63], v[72:75]
s_waitcnt vmcnt(12)
s_add_u32 s64, s72, 148864
ds_read_b128 a[0:3], v2 offset:0
v_mfma_f32_16x16x32_bf16 v[72:75], a[88:91], a[56:59], v[72:75]
buffer_load_dwordx4 v13, s[48:51], s64 offen lds
v_mfma_f32_16x16x32_bf16 v[136:139], a[96:99], a[56:59], v[136:139]
ds_read_b128 a[4:7], v3 offset:0
v_mfma_f32_16x16x32_bf16 v[136:139], a[100:103], a[60:63], v[136:139]
ds_read_b128 a[8:11], v2 offset:2048
v_subrev_u32 v6, 0x8000, v6
v_mfma_f32_16x16x32_bf16 v[120:123], a[100:103], a[52:55], v[120:123]
s_add_u32 m0, s76, 36864
ds_read_b128 a[12:15], v3 offset:2048
v_mfma_f32_16x16x32_bf16 v[120:123], a[96:99], a[48:51], v[120:123]
s_add_u32 s64, s73, 1408
ds_read_b128 a[16:19], v2 offset:4096
v_mfma_f32_16x16x32_bf16 v[104:107], a[96:99], a[40:43], v[104:107]
buffer_load_dwordx4 v12, s[48:51], s64 offen lds
v_mfma_f32_16x16x32_bf16 v[104:107], a[100:103], a[44:47], v[104:107]
ds_read_b128 a[20:23], v3 offset:4096
v_mfma_f32_16x16x32_bf16 v[88:91], a[100:103], a[36:39], v[88:91]
ds_read_b128 a[24:27], v2 offset:6144
v_mfma_f32_16x16x32_bf16 v[88:91], a[96:99], a[32:35], v[88:91]
s_waitcnt lgkmcnt(7)
s_add_u32 m0, s76, 37888
ds_read_b128 a[28:31], v3 offset:6144
v_mfma_f32_16x16x32_bf16 v[28:31], a[104:107], a[32:35], v[28:31]
s_add_u32 s64, s73, 17792
ds_read_b64_tr_b16 a[88:89], v10 offset:32768
v_mfma_f32_16x16x32_bf16 v[28:31], a[108:111], a[36:39], v[28:31]
buffer_load_dwordx4 v13, s[48:51], s64 offen lds
v_mfma_f32_16x16x32_bf16 v[44:47], a[108:111], a[44:47], v[44:47]
ds_read_b64_tr_b16 a[90:91], v10 offset:33792
v_subrev_u32 v7, 0x8000, v7
v_mfma_f32_16x16x32_bf16 v[44:47], a[104:107], a[40:43], v[44:47]
ds_read_b64_tr_b16 a[92:93], v10 offset:40960
v_mfma_f32_16x16x32_bf16 v[60:63], a[104:107], a[48:51], v[60:63]
s_add_u32 m0, s76, 38912
buffer_load_dword v1, off, s[52:55], s78 sc1
v_mfma_f32_16x16x32_bf16 v[60:63], a[108:111], a[52:55], v[60:63]
s_add_u32 s64, s73, 132480
ds_read_b64_tr_b16 a[94:95], v10 offset:41984
v_mfma_f32_16x16x32_bf16 v[76:79], a[108:111], a[60:63], v[76:79]
buffer_load_dwordx4 v12, s[48:51], s64 offen lds
v_mfma_f32_16x16x32_bf16 v[76:79], a[104:107], a[56:59], v[76:79]
ds_read_b64_tr_b16 a[96:97], v11 offset:32768
v_mfma_f32_16x16x32_bf16 v[140:143], a[112:115], a[56:59], v[140:143]
ds_read_b64_tr_b16 a[98:99], v11 offset:33792
v_mfma_f32_16x16x32_bf16 v[140:143], a[116:119], a[60:63], v[140:143]
s_add_u32 m0, s76, 39936
ds_read_b64_tr_b16 a[100:101], v11 offset:40960
v_subrev_u32 v8, 0x8000, v8
v_mfma_f32_16x16x32_bf16 v[124:127], a[116:119], a[52:55], v[124:127]
s_add_u32 s64, s73, 148864
ds_read_b64_tr_b16 a[102:103], v11 offset:41984
v_mfma_f32_16x16x32_bf16 v[124:127], a[112:115], a[48:51], v[124:127]
buffer_load_dwordx4 v13, s[48:51], s64 offen lds
v_mfma_f32_16x16x32_bf16 v[108:111], a[112:115], a[40:43], v[108:111]
v_mfma_f32_16x16x32_bf16 v[108:111], a[116:119], a[44:47], v[108:111]
v_mfma_f32_16x16x32_bf16 v[92:95], a[116:119], a[36:39], v[92:95]
v_subrev_u32 v9, 0x8000, v9
v_subrev_u32 v10, 0x8000, v10
v_mfma_f32_16x16x32_bf16 v[92:95], a[112:115], a[32:35], v[92:95]
v_subrev_u32 v11, 0x8000, v11
v_mfma_f32_16x16x32_bf16 v[32:35], a[72:75], a[32:35], v[32:35]
v_mfma_f32_16x16x32_bf16 v[32:35], a[76:79], a[36:39], v[32:35]
v_mfma_f32_16x16x32_bf16 v[48:51], a[76:79], a[44:47], v[48:51]
s_waitcnt lgkmcnt(0)
s_barrier
v_mfma_f32_16x16x32_bf16 v[48:51], a[72:75], a[40:43], v[48:51]
s_add_u32 m0, s77, 131072
ds_read_b64_tr_b16 a[104:105], v19 offset:4096
v_mfma_f32_16x16x32_bf16 v[64:67], a[72:75], a[48:51], v[64:67]
s_add_u32 s64, s71, 6291456
ds_read_b64_tr_b16 a[106:107], v19 offset:4352
v_mfma_f32_16x16x32_bf16 v[64:67], a[76:79], a[52:55], v[64:67]
buffer_load_dwordx4 v14, s[56:59], s64 offen lds
v_mfma_f32_16x16x32_bf16 v[80:83], a[76:79], a[60:63], v[80:83]
ds_read_b64_tr_b16 a[108:109], v19 offset:6144
v_mfma_f32_16x16x32_bf16 v[80:83], a[72:75], a[56:59], v[80:83]
s_add_u32 s65, s79, 13312
ds_read_b64_tr_b16 a[110:111], v19 offset:6400
v_mfma_f32_16x16x32_bf16 v[144:147], a[80:83], a[56:59], v[144:147]
buffer_store_dwordx4 a[224:227], v16, s[44:47], s65 offen sc1
v_mfma_f32_16x16x32_bf16 v[144:147], a[84:87], a[60:63], v[144:147]
ds_read_b64_tr_b16 a[112:113], v20 offset:4096
v_mfma_f32_16x16x32_bf16 v[128:131], a[84:87], a[52:55], v[128:131]
ds_read_b64_tr_b16 a[114:115], v20 offset:4352
v_mfma_f32_16x16x32_bf16 v[128:131], a[80:83], a[48:51], v[128:131]
ds_read_b64_tr_b16 a[116:117], v20 offset:6144
v_mfma_f32_16x16x32_bf16 v[112:115], a[80:83], a[40:43], v[112:115]
s_add_u32 m0, s78, 147456
ds_read_b64_tr_b16 a[118:119], v20 offset:6400
v_mfma_f32_16x16x32_bf16 v[112:115], a[84:87], a[44:47], v[112:115]
s_add_u32 s64, s75, 4718592
ds_read_b64_tr_b16 a[72:73], v19 offset:8192
v_mfma_f32_16x16x32_bf16 v[96:99], a[84:87], a[36:39], v[96:99]
buffer_load_dwordx4 v23, s[60:63], s64 offen lds
v_mfma_f32_16x16x32_bf16 v[96:99], a[80:83], a[32:35], v[96:99]
ds_read_b64_tr_b16 a[74:75], v19 offset:8448
v_mfma_f32_16x16x32_bf16 v[36:39], a[88:91], a[32:35], v[36:39]
ds_read_b64_tr_b16 a[76:77], v19 offset:10240
v_mfma_f32_16x16x32_bf16 v[36:39], a[92:95], a[36:39], v[36:39]
ds_read_b64_tr_b16 a[78:79], v19 offset:10496
v_mfma_f32_16x16x32_bf16 v[52:55], a[92:95], a[44:47], v[52:55]
ds_read_b64_tr_b16 a[80:81], v20 offset:8192
v_mfma_f32_16x16x32_bf16 v[52:55], a[88:91], a[40:43], v[52:55]
ds_read_b64_tr_b16 a[82:83], v20 offset:8448
v_mfma_f32_16x16x32_bf16 v[68:71], a[88:91], a[48:51], v[68:71]
ds_read_b64_tr_b16 a[84:85], v20 offset:10240
v_mfma_f32_16x16x32_bf16 v[68:71], a[92:95], a[52:55], v[68:71]
s_add_u32 m0, s77, 132096
ds_read_b64_tr_b16 a[86:87], v20 offset:10496
v_mfma_f32_16x16x32_bf16 v[84:87], a[92:95], a[60:63], v[84:87]
s_add_u32 s64, s71, 6324224
v_mfma_f32_16x16x32_bf16 v[84:87], a[88:91], a[56:59], v[84:87]
buffer_load_dwordx4 v14, s[56:59], s64 offen lds
v_mfma_f32_16x16x32_bf16 v[148:151], a[96:99], a[56:59], v[148:151]
ds_read_b64_tr_b16 a[88:89], v19 offset:0
v_mfma_f32_16x16x32_bf16 v[148:151], a[100:103], a[60:63], v[148:151]
ds_read_b64_tr_b16 a[90:91], v19 offset:256
v_mfma_f32_16x16x32_bf16 v[132:135], a[100:103], a[52:55], v[132:135]
ds_read_b64_tr_b16 a[92:93], v19 offset:2048
v_mfma_f32_16x16x32_bf16 v[132:135], a[96:99], a[48:51], v[132:135]
ds_read_b64_tr_b16 a[94:95], v19 offset:2304
v_mfma_f32_16x16x32_bf16 v[116:119], a[96:99], a[40:43], v[116:119]
v_mfma_f32_16x16x32_bf16 v[116:119], a[100:103], a[44:47], v[116:119]
v_mfma_f32_16x16x32_bf16 v[100:103], a[100:103], a[36:39], v[100:103]
s_add_u32 m0, s78, 151552
v_mfma_f32_16x16x32_bf16 v[100:103], a[96:99], a[32:35], v[100:103]
s_waitcnt lgkmcnt(4)
s_add_u32 s64, s75, 4720640
ds_read_b64_tr_b16 a[96:97], v20 offset:0
v_mfma_f32_16x16x32_bf16 v[184:187], a[104:107], a[0:3], v[184:187]
buffer_load_dwordx4 v23, s[60:63], s64 offen lds
v_mfma_f32_16x16x32_bf16 v[184:187], a[108:111], a[4:7], v[184:187]
ds_read_b64_tr_b16 a[98:99], v20 offset:256
v_mfma_f32_16x16x32_bf16 v[192:195], a[108:111], a[12:15], v[192:195]
ds_read_b64_tr_b16 a[100:101], v20 offset:2048
v_mfma_f32_16x16x32_bf16 v[192:195], a[104:107], a[8:11], v[192:195]
s_add_u32 s17, s78, .-L_pc+6144
ds_read_b64_tr_b16 a[102:103], v20 offset:2304
v_mfma_f32_16x16x32_bf16 v[200:203], a[104:107], a[16:19], v[200:203]
buffer_load_dword a252, v16, s[88:91], s17 offen
v_mfma_f32_16x16x32_bf16 v[200:203], a[108:111], a[20:23], v[200:203]
v_mfma_f32_16x16x32_bf16 v[208:211], a[108:111], a[28:31], v[208:211]
v_mfma_f32_16x16x32_bf16 v[208:211], a[104:107], a[24:27], v[208:211]
ds_read_b64_tr_b16 a[104:105], v4 offset:0
v_mfma_f32_16x16x32_bf16 v[212:215], a[112:115], a[24:27], v[212:215]
s_add_u32 m0, s77, 133120
ds_read_b64_tr_b16 a[106:107], v4 offset:1024
v_mfma_f32_16x16x32_bf16 v[212:215], a[116:119], a[28:31], v[212:215]
s_add_u32 s64, s71, 6356992
ds_read_b64_tr_b16 a[108:109], v4 offset:8192
v_mfma_f32_16x16x32_bf16 v[204:207], a[116:119], a[20:23], v[204:207]
buffer_load_dwordx4 v15, s[56:59], s64 offen lds
v_mfma_f32_16x16x32_bf16 v[204:207], a[112:115], a[16:19], v[204:207]
ds_read_b64_tr_b16 a[110:111], v4 offset:9216
v_mfma_f32_16x16x32_bf16 v[196:199], a[112:115], a[8:11], v[196:199]
v_mfma_f32_16x16x32_bf16 v[196:199], a[116:119], a[12:15], v[196:199]
v_mfma_f32_16x16x32_bf16 v[188:191], a[116:119], a[4:7], v[188:191]
v_mfma_f32_16x16x32_bf16 v[188:191], a[112:115], a[0:3], v[188:191]
ds_read_b64_tr_b16 a[112:113], v5 offset:0
v_mfma_f32_16x16x32_bf16 v[216:219], a[0:3], a[72:75], v[216:219]
ds_read_b64_tr_b16 a[114:115], v5 offset:1024
v_mfma_f32_16x16x32_bf16 v[216:219], a[4:7], a[76:79], v[216:219]
s_add_u32 m0, s78, 155648
ds_read_b64_tr_b16 a[116:117], v5 offset:8192
v_mfma_f32_16x16x32_bf16 v[224:227], a[12:15], a[76:79], v[224:227]
s_add_u32 s64, s75, 4722688
ds_read_b64_tr_b16 a[118:119], v5 offset:9216
v_mfma_f32_16x16x32_bf16 v[224:227], a[8:11], a[72:75], v[224:227]
buffer_load_dwordx4 v23, s[60:63], s64 offen lds
v_mfma_f32_16x16x32_bf16 v[232:235], a[16:19], a[72:75], v[232:235]
v_mfma_f32_16x16x32_bf16 v[232:235], a[20:23], a[76:79], v[232:235]
v_mfma_f32_16x16x32_bf16 v[240:243], a[28:31], a[76:79], v[240:243]
v_mfma_f32_16x16x32_bf16 v[240:243], a[24:27], a[72:75], v[240:243]
ds_read_b64_tr_b16 a[72:73], v6 offset:0
v_mfma_f32_16x16x32_bf16 v[244:247], a[24:27], a[80:83], v[244:247]
s_add_u32 s65, s79, 30720
ds_read_b64_tr_b16 a[74:75], v6 offset:1024
v_mfma_f32_16x16x32_bf16 v[244:247], a[28:31], a[84:87], v[244:247]
buffer_store_dwordx4 a[228:231], v16, s[44:47], s65 offen sc1
v_mfma_f32_16x16x32_bf16 v[236:239], a[20:23], a[84:87], v[236:239]
s_add_u32 m0, s77, 134144
ds_read_b64_tr_b16 a[76:77], v6 offset:8192
v_mfma_f32_16x16x32_bf16 v[236:239], a[16:19], a[80:83], v[236:239]
s_add_u32 s64, s71, 6389760
ds_read_b64_tr_b16 a[78:79], v6 offset:9216
v_mfma_f32_16x16x32_bf16 v[228:231], a[8:11], a[80:83], v[228:231]
buffer_load_dwordx4 v15, s[56:59], s64 offen lds
v_mfma_f32_16x16x32_bf16 v[228:231], a[12:15], a[84:87], v[228:231]
v_mfma_f32_16x16x32_bf16 v[220:223], a[4:7], a[84:87], v[220:223]
v_mfma_f32_16x16x32_bf16 v[220:223], a[0:3], a[80:83], v[220:223]
s_waitcnt lgkmcnt(4)
ds_read_b64_tr_b16 a[80:81], v7 offset:0
v_mfma_f32_16x16x32_bf16 v[152:155], a[88:91], a[0:3], v[152:155]
ds_read_b64_tr_b16 a[82:83], v7 offset:1024
v_mfma_f32_16x16x32_bf16 v[152:155], a[92:95], a[4:7], v[152:155]
ds_read_b64_tr_b16 a[84:85], v7 offset:8192
v_mfma_f32_16x16x32_bf16 v[160:163], a[92:95], a[12:15], v[160:163]
ds_read_b64_tr_b16 a[86:87], v7 offset:9216
v_mfma_f32_16x16x32_bf16 v[160:163], a[88:91], a[8:11], v[160:163]
v_mfma_f32_16x16x32_bf16 v[168:171], a[88:91], a[16:19], v[168:171]
v_mfma_f32_16x16x32_bf16 v[168:171], a[92:95], a[20:23], v[168:171]
v_mfma_f32_16x16x32_bf16 v[176:179], a[92:95], a[28:31], v[176:179]
s_add_u32 m0, s76, 0
v_mfma_f32_16x16x32_bf16 v[176:179], a[88:91], a[24:27], v[176:179]
s_add_u32 s64, s72, 1536
ds_read_b64_tr_b16 a[88:89], v8 offset:0
v_mfma_f32_16x16x32_bf16 v[180:183], a[96:99], a[24:27], v[180:183]
buffer_load_dwordx4 v12, s[48:51], s64 offen lds
v_mfma_f32_16x16x32_bf16 v[180:183], a[100:103], a[28:31], v[180:183]
ds_read_b64_tr_b16 a[90:91], v8 offset:1024
v_mfma_f32_16x16x32_bf16 v[172:175], a[100:103], a[20:23], v[172:175]
ds_read_b64_tr_b16 a[92:93], v8 offset:8192
v_mfma_f32_16x16x32_bf16 v[172:175], a[96:99], a[16:19], v[172:175]
s_add_u32 m0, s76, 1024
ds_read_b64_tr_b16 a[94:95], v8 offset:9216
v_mfma_f32_16x16x32_bf16 v[164:167], a[96:99], a[8:11], v[164:167]
s_add_u32 s64, s72, 17920
v_mfma_f32_16x16x32_bf16 v[164:167], a[100:103], a[12:15], v[164:167]
buffer_load_dwordx4 v13, s[48:51], s64 offen lds
v_mfma_f32_16x16x32_bf16 v[156:159], a[100:103], a[4:7], v[156:159]
v_mfma_f32_16x16x32_bf16 v[156:159], a[96:99], a[0:3], v[156:159]
ds_read_b64_tr_b16 a[96:97], v9 offset:0
v_mfma_f32_16x16x32_bf16 v[24:27], a[104:107], a[0:3], v[24:27]
s_add_u32 m0, s76, 2048
ds_read_b64_tr_b16 a[98:99], v9 offset:1024
v_mfma_f32_16x16x32_bf16 v[24:27], a[108:111], a[4:7], v[24:27]
s_add_u32 s64, s72, 132608
ds_read_b64_tr_b16 a[100:101], v9 offset:8192
v_mfma_f32_16x16x32_bf16 v[40:43], a[108:111], a[12:15], v[40:43]
buffer_load_dwordx4 v12, s[48:51], s64 offen lds
v_mfma_f32_16x16x32_bf16 v[40:43], a[104:107], a[8:11], v[40:43]
ds_read_b64_tr_b16 a[102:103], v9 offset:9216
v_mfma_f32_16x16x32_bf16 v[56:59], a[104:107], a[16:19], v[56:59]
v_mfma_f32_16x16x32_bf16 v[56:59], a[108:111], a[20:23], v[56:59]
s_add_u32 m0, s76, 3072
v_mfma_f32_16x16x32_bf16 v[72:75], a[108:111], a[28:31], v[72:75]
s_waitcnt vmcnt(13)
s_add_u32 s64, s72, 148992
ds_read_b128 a[32:35], v2 offset:32768
v_mfma_f32_16x16x32_bf16 v[72:75], a[104:107], a[24:27], v[72:75]
buffer_load_dwordx4 v13, s[48:51], s64 offen lds
v_mfma_f32_16x16x32_bf16 v[136:139], a[112:115], a[24:27], v[136:139]
ds_read_b128 a[36:39], v3 offset:32768
v_mfma_f32_16x16x32_bf16 v[136:139], a[116:119], a[28:31], v[136:139]
ds_read_b128 a[40:43], v2 offset:34816
v_mfma_f32_16x16x32_bf16 v[120:123], a[116:119], a[20:23], v[120:123]
s_add_u32 m0, s76, 4096
ds_read_b128 a[44:47], v3 offset:34816
v_mfma_f32_16x16x32_bf16 v[120:123], a[112:115], a[16:19], v[120:123]
s_add_u32 s64, s73, 1536
ds_read_b128 a[48:51], v2 offset:36864
v_mfma_f32_16x16x32_bf16 v[104:107], a[112:115], a[8:11], v[104:107]
buffer_load_dwordx4 v12, s[48:51], s64 offen lds
v_mfma_f32_16x16x32_bf16 v[104:107], a[116:119], a[12:15], v[104:107]
ds_read_b128 a[52:55], v3 offset:36864
v_mfma_f32_16x16x32_bf16 v[88:91], a[116:119], a[4:7], v[88:91]
ds_read_b128 a[56:59], v2 offset:38912
v_mfma_f32_16x16x32_bf16 v[88:91], a[112:115], a[0:3], v[88:91]
s_waitcnt lgkmcnt(7)
s_add_u32 m0, s76, 5120
ds_read_b128 a[60:63], v3 offset:38912
v_mfma_f32_16x16x32_bf16 v[28:31], a[72:75], a[0:3], v[28:31]
s_add_u32 s64, s73, 17920
ds_read_b64_tr_b16 a[104:105], v10 offset:0
v_mfma_f32_16x16x32_bf16 v[28:31], a[76:79], a[4:7], v[28:31]
buffer_load_dwordx4 v13, s[48:51], s64 offen lds
v_mfma_f32_16x16x32_bf16 v[44:47], a[76:79], a[12:15], v[44:47]
ds_read_b64_tr_b16 a[106:107], v10 offset:1024
v_mfma_f32_16x16x32_bf16 v[44:47], a[72:75], a[8:11], v[44:47]
ds_read_b64_tr_b16 a[108:109], v10 offset:8192
v_mfma_f32_16x16x32_bf16 v[60:63], a[72:75], a[16:19], v[60:63]
s_add_u32 m0, s76, 6144
ds_read_b64_tr_b16 a[110:111], v10 offset:9216
v_mfma_f32_16x16x32_bf16 v[60:63], a[76:79], a[20:23], v[60:63]
s_add_u32 s64, s73, 132608
ds_read_b64_tr_b16 a[112:113], v11 offset:0
v_mfma_f32_16x16x32_bf16 v[76:79], a[76:79], a[28:31], v[76:79]
buffer_load_dwordx4 v12, s[48:51], s64 offen lds
v_mfma_f32_16x16x32_bf16 v[76:79], a[72:75], a[24:27], v[76:79]
ds_read_b64_tr_b16 a[114:115], v11 offset:1024
v_mfma_f32_16x16x32_bf16 v[140:143], a[80:83], a[24:27], v[140:143]
s_add_u32 m0, s76, 7168
ds_read_b64_tr_b16 a[116:117], v11 offset:8192
v_mfma_f32_16x16x32_bf16 v[140:143], a[84:87], a[28:31], v[140:143]
s_add_u32 s64, s73, 148992
ds_read_b64_tr_b16 a[118:119], v11 offset:9216
v_mfma_f32_16x16x32_bf16 v[124:127], a[84:87], a[20:23], v[124:127]
v_readfirstlane_b32 vcc_lo, v1
s_nop 0
s_cmp_lt_u32 vcc_lo, s81
s_cbranch_scc1 L_spin_1
L_spinbk_2:
v_mfma_f32_16x16x32_bf16 v[124:127], a[80:83], a[16:19], v[124:127]
s_add_u32 s65, s79, 31744
buffer_load_dwordx4 v13, s[48:51], s64 offen lds
v_mfma_f32_16x16x32_bf16 v[108:111], a[80:83], a[8:11], v[108:111]
buffer_store_dwordx4 a[232:235], v16, s[44:47], s65 offen sc1
v_mfma_f32_16x16x32_bf16 v[108:111], a[84:87], a[12:15], v[108:111]
v_mfma_f32_16x16x32_bf16 v[92:95], a[84:87], a[4:7], v[92:95]
s_add_u32 s52, s28, 59768832
s_addc_u32 s53, s29, 0
s_mov_b32 s54, 16384
v_mfma_f32_16x16x32_bf16 v[92:95], a[80:83], a[0:3], v[92:95]
v_mfma_f32_16x16x32_bf16 v[32:35], a[88:91], a[0:3], v[32:35]
v_mfma_f32_16x16x32_bf16 v[32:35], a[92:95], a[4:7], v[32:35]
v_mfma_f32_16x16x32_bf16 v[48:51], a[92:95], a[12:15], v[48:51]
s_waitcnt lgkmcnt(0)
s_barrier
v_mfma_f32_16x16x32_bf16 v[48:51], a[88:91], a[8:11], v[48:51]
s_add_u32 m0, s77, 65536
ds_read_b64_tr_b16 a[72:73], v19 offset:36864
v_mfma_f32_16x16x32_bf16 v[64:67], a[88:91], a[16:19], v[64:67]
s_add_u32 s64, s71, 6815744
ds_read_b64_tr_b16 a[74:75], v19 offset:37120
v_mfma_f32_16x16x32_bf16 v[64:67], a[92:95], a[20:23], v[64:67]
buffer_load_dwordx4 v14, s[56:59], s64 offen lds
v_mfma_f32_16x16x32_bf16 v[80:83], a[92:95], a[28:31], v[80:83]
ds_read_b64_tr_b16 a[76:77], v19 offset:38912
v_mfma_f32_16x16x32_bf16 v[80:83], a[88:91], a[24:27], v[80:83]
ds_read_b64_tr_b16 a[78:79], v19 offset:39168
v_mfma_f32_16x16x32_bf16 v[144:147], a[96:99], a[24:27], v[144:147]
ds_read_b64_tr_b16 a[80:81], v20 offset:36864
v_mfma_f32_16x16x32_bf16 v[144:147], a[100:103], a[28:31], v[144:147]
ds_read_b64_tr_b16 a[82:83], v20 offset:37120
v_mfma_f32_16x16x32_bf16 v[128:131], a[100:103], a[20:23], v[128:131]
ds_read_b64_tr_b16 a[84:85], v20 offset:38912
v_mfma_f32_16x16x32_bf16 v[128:131], a[96:99], a[16:19], v[128:131]
ds_read_b64_tr_b16 a[86:87], v20 offset:39168
v_mfma_f32_16x16x32_bf16 v[112:115], a[96:99], a[8:11], v[112:115]
s_add_u32 m0, s78, 81920
ds_read_b64_tr_b16 a[88:89], v19 offset:40960
v_mfma_f32_16x16x32_bf16 v[112:115], a[100:103], a[12:15], v[112:115]
s_add_u32 s64, s75, 5111808
ds_read_b64_tr_b16 a[90:91], v19 offset:41216
v_mfma_f32_16x16x32_bf16 v[96:99], a[100:103], a[4:7], v[96:99]
buffer_load_dwordx4 v23, s[60:63], s64 offen lds
v_mfma_f32_16x16x32_bf16 v[96:99], a[96:99], a[0:3], v[96:99]
ds_read_b64_tr_b16 a[92:93], v19 offset:43008
v_mfma_f32_16x16x32_bf16 v[36:39], a[104:107], a[0:3], v[36:39]
ds_read_b64_tr_b16 a[94:95], v19 offset:43264
v_mfma_f32_16x16x32_bf16 v[36:39], a[108:111], a[4:7], v[36:39]
ds_read_b64_tr_b16 a[96:97], v20 offset:40960
v_mfma_f32_16x16x32_bf16 v[52:55], a[108:111], a[12:15], v[52:55]
ds_read_b64_tr_b16 a[98:99], v20 offset:41216
v_mfma_f32_16x16x32_bf16 v[52:55], a[104:107], a[8:11], v[52:55]
ds_read_b64_tr_b16 a[100:101], v20 offset:43008
v_mfma_f32_16x16x32_bf16 v[68:71], a[104:107], a[16:19], v[68:71]
ds_read_b64_tr_b16 a[102:103], v20 offset:43264
v_mfma_f32_16x16x32_bf16 v[68:71], a[108:111], a[20:23], v[68:71]
s_add_u32 m0, s77, 66560
v_mfma_f32_16x16x32_bf16 v[84:87], a[108:111], a[28:31], v[84:87]
s_add_u32 s64, s71, 6848512
v_mfma_f32_16x16x32_bf16 v[84:87], a[104:107], a[24:27], v[84:87]
buffer_load_dwordx4 v14, s[56:59], s64 offen lds
v_mfma_f32_16x16x32_bf16 v[148:151], a[112:115], a[24:27], v[148:151]
ds_read_b64_tr_b16 a[104:105], v19 offset:32768
v_mfma_f32_16x16x32_bf16 v[148:151], a[116:119], a[28:31], v[148:151]
ds_read_b64_tr_b16 a[106:107], v19 offset:33024
v_mfma_f32_16x16x32_bf16 v[132:135], a[116:119], a[20:23], v[132:135]
ds_read_b64_tr_b16 a[108:109], v19 offset:34816
v_mfma_f32_16x16x32_bf16 v[132:135], a[112:115], a[16:19], v[132:135]
ds_read_b64_tr_b16 a[110:111], v19 offset:35072
v_mfma_f32_16x16x32_bf16 v[116:119], a[112:115], a[8:11], v[116:119]
v_mfma_f32_16x16x32_bf16 v[116:119], a[116:119], a[12:15], v[116:119]
v_mfma_f32_16x16x32_bf16 v[100:103], a[116:119], a[4:7], v[100:103]
s_add_u32 m0, s78, 86016
v_mfma_f32_16x16x32_bf16 v[100:103], a[112:115], a[0:3], v[100:103]
s_waitcnt lgkmcnt(4)
s_add_u32 s64, s75, 5113856
ds_read_b64_tr_b16 a[112:113], v20 offset:32768
v_mfma_f32_16x16x32_bf16 v[184:187], a[72:75], a[32:35], v[184:187]
buffer_load_dwordx4 v23, s[60:63], s64 offen lds
v_mfma_f32_16x16x32_bf16 v[184:187], a[76:79], a[36:39], v[184:187]
ds_read_b64_tr_b16 a[114:115], v20 offset:33024
v_mfma_f32_16x16x32_bf16 v[192:195], a[76:79], a[44:47], v[192:195]
ds_read_b64_tr_b16 a[116:117], v20 offset:34816
v_mfma_f32_16x16x32_bf16 v[192:195], a[72:75], a[40:43], v[192:195]
ds_read_b64_tr_b16 a[118:119], v20 offset:35072
v_mfma_f32_16x16x32_bf16 v[200:203], a[72:75], a[48:51], v[200:203]
v_mfma_f32_16x16x32_bf16 v[200:203], a[76:79], a[52:55], v[200:203]
v_mfma_f32_16x16x32_bf16 v[208:211], a[76:79], a[60:63], v[208:211]
v_mfma_f32_16x16x32_bf16 v[208:211], a[72:75], a[56:59], v[208:211]
ds_read_b64_tr_b16 a[72:73], v4 offset:32768
v_mfma_f32_16x16x32_bf16 v[212:215], a[80:83], a[56:59], v[212:215]
s_add_u32 m0, s77, 67584
ds_read_b64_tr_b16 a[74:75], v4 offset:33792
v_mfma_f32_16x16x32_bf16 v[212:215], a[84:87], a[60:63], v[212:215]
s_add_u32 s64, s71, 6881280
ds_read_b64_tr_b16 a[76:77], v4 offset:40960
v_mfma_f32_16x16x32_bf16 v[204:207], a[84:87], a[52:55], v[204:207]
buffer_load_dwordx4 v15, s[56:59], s64 offen lds
v_mfma_f32_16x16x32_bf16 v[204:207], a[80:83], a[48:51], v[204:207]
s_add_u32 s65, s79, 15360
ds_read_b64_tr_b16 a[78:79], v4 offset:41984
v_mfma_f32_16x16x32_bf16 v[196:199], a[80:83], a[40:43], v[196:199]
buffer_store_dwordx4 a[236:239], v16, s[44:47], s65 offen sc1
v_mfma_f32_16x16x32_bf16 v[196:199], a[84:87], a[44:47], v[196:199]
v_mfma_f32_16x16x32_bf16 v[188:191], a[84:87], a[36:39], v[188:191]
v_mfma_f32_16x16x32_bf16 v[188:191], a[80:83], a[32:35], v[188:191]
ds_read_b64_tr_b16 a[80:81], v5 offset:32768
v_mfma_f32_16x16x32_bf16 v[216:219], a[32:35], a[88:91], v[216:219]
ds_read_b64_tr_b16 a[82:83], v5 offset:33792
v_mfma_f32_16x16x32_bf16 v[216:219], a[36:39], a[92:95], v[216:219]
s_add_u32 m0, s78, 90112
ds_read_b64_tr_b16 a[84:85], v5 offset:40960
v_mfma_f32_16x16x32_bf16 v[224:227], a[44:47], a[92:95], v[224:227]
s_add_u32 s64, s75, 5115904
ds_read_b64_tr_b16 a[86:87], v5 offset:41984
v_mfma_f32_16x16x32_bf16 v[224:227], a[40:43], a[88:91], v[224:227]
buffer_load_dwordx4 v23, s[60:63], s64 offen lds
v_mfma_f32_16x16x32_bf16 v[232:235], a[48:51], a[88:91], v[232:235]
v_mfma_f32_16x16x32_bf16 v[232:235], a[52:55], a[92:95], v[232:235]
v_mfma_f32_16x16x32_bf16 v[240:243], a[60:63], a[92:95], v[240:243]
v_mfma_f32_16x16x32_bf16 v[240:243], a[56:59], a[88:91], v[240:243]
ds_read_b64_tr_b16 a[88:89], v6 offset:32768
v_mfma_f32_16x16x32_bf16 v[244:247], a[56:59], a[96:99], v[244:247]
ds_read_b64_tr_b16 a[90:91], v6 offset:33792
v_mfma_f32_16x16x32_bf16 v[244:247], a[60:63], a[100:103], v[244:247]
ds_read_b64_tr_b16 a[92:93], v6 offset:40960
v_add_u32 v19, 0x8000, v19
v_mfma_f32_16x16x32_bf16 v[236:239], a[52:55], a[100:103], v[236:239]
s_add_u32 m0, s77, 68608
ds_read_b64_tr_b16 a[94:95], v6 offset:41984
v_mfma_f32_16x16x32_bf16 v[236:239], a[48:51], a[96:99], v[236:239]
s_add_u32 s64, s71, 6914048
v_mfma_f32_16x16x32_bf16 v[228:231], a[40:43], a[96:99], v[228:231]
buffer_load_dwordx4 v15, s[56:59], s64 offen lds
v_mfma_f32_16x16x32_bf16 v[228:231], a[44:47], a[100:103], v[228:231]
v_mfma_f32_16x16x32_bf16 v[220:223], a[36:39], a[100:103], v[220:223]
v_mfma_f32_16x16x32_bf16 v[220:223], a[32:35], a[96:99], v[220:223]
s_waitcnt lgkmcnt(4)
ds_read_b64_tr_b16 a[96:97], v7 offset:32768
v_mfma_f32_16x16x32_bf16 v[152:155], a[104:107], a[32:35], v[152:155]
ds_read_b64_tr_b16 a[98:99], v7 offset:33792
v_mfma_f32_16x16x32_bf16 v[152:155], a[108:111], a[36:39], v[152:155]
ds_read_b64_tr_b16 a[100:101], v7 offset:40960
v_add_u32 v20, 0x8000, v20
v_mfma_f32_16x16x32_bf16 v[160:163], a[108:111], a[44:47], v[160:163]
ds_read_b64_tr_b16 a[102:103], v7 offset:41984
v_mfma_f32_16x16x32_bf16 v[160:163], a[104:107], a[40:43], v[160:163]
v_mfma_f32_16x16x32_bf16 v[168:171], a[104:107], a[48:51], v[168:171]
v_mfma_f32_16x16x32_bf16 v[168:171], a[108:111], a[52:55], v[168:171]
v_mfma_f32_16x16x32_bf16 v[176:179], a[108:111], a[60:63], v[176:179]
s_add_u32 m0, s76, 32768
v_mfma_f32_16x16x32_bf16 v[176:179], a[104:107], a[56:59], v[176:179]
s_add_u32 s64, s72, 1664
ds_read_b64_tr_b16 a[104:105], v8 offset:32768
v_mfma_f32_16x16x32_bf16 v[180:183], a[112:115], a[56:59], v[180:183]
buffer_load_dwordx4 v12, s[48:51], s64 offen lds
v_mfma_f32_16x16x32_bf16 v[180:183], a[116:119], a[60:63], v[180:183]
ds_read_b64_tr_b16 a[106:107], v8 offset:33792
v_add_u32 v4, 0x8000, v4
v_mfma_f32_16x16x32_bf16 v[172:175], a[116:119], a[52:55], v[172:175]
ds_read_b64_tr_b16 a[108:109], v8 offset:40960
v_mfma_f32_16x16x32_bf16 v[172:175], a[112:115], a[48:51], v[172:175]
s_add_u32 m0, s76, 33792
ds_read_b64_tr_b16 a[110:111], v8 offset:41984
v_mfma_f32_16x16x32_bf16 v[164:167], a[112:115], a[40:43], v[164:167]
s_add_u32 s64, s72, 18048
v_mfma_f32_16x16x32_bf16 v[164:167], a[116:119], a[44:47], v[164:167]
buffer_load_dwordx4 v13, s[48:51], s64 offen lds
v_mfma_f32_16x16x32_bf16 v[156:159], a[116:119], a[36:39], v[156:159]
v_mfma_f32_16x16x32_bf16 v[156:159], a[112:115], a[32:35], v[156:159]
ds_read_b64_tr_b16 a[112:113], v9 offset:32768
v_mfma_f32_16x16x32_bf16 v[24:27], a[72:75], a[32:35], v[24:27]
s_add_u32 m0, s76, 34816
ds_read_b64_tr_b16 a[114:115], v9 offset:33792
v_mfma_f32_16x16x32_bf16 v[24:27], a[76:79], a[36:39], v[24:27]
s_add_u32 s64, s72, 132736
ds_read_b64_tr_b16 a[116:117], v9 offset:40960
v_add_u32 v5, 0x8000, v5
v_mfma_f32_16x16x32_bf16 v[40:43], a[76:79], a[44:47], v[40:43]
buffer_load_dwordx4 v12, s[48:51], s64 offen lds
v_mfma_f32_16x16x32_bf16 v[40:43], a[72:75], a[40:43], v[40:43]
ds_read_b64_tr_b16 a[118:119], v9 offset:41984
v_mfma_f32_16x16x32_bf16 v[56:59], a[72:75], a[48:51], v[56:59]
v_mfma_f32_16x16x32_bf16 v[56:59], a[76:79], a[52:55], v[56:59]
s_add_u32 m0, s76, 35840
v_mfma_f32_16x16x32_bf16 v[72:75], a[76:79], a[60:63], v[72:75]
s_waitcnt vmcnt(12)
s_add_u32 s64, s72, 149120
ds_read_b128 a[0:3], v2 offset:0
v_mfma_f32_16x16x32_bf16 v[72:75], a[72:75], a[56:59], v[72:75]
buffer_load_dwordx4 v13, s[48:51], s64 offen lds
v_mfma_f32_16x16x32_bf16 v[136:139], a[80:83], a[56:59], v[136:139]
ds_read_b128 a[4:7], v3 offset:0
v_mfma_f32_16x16x32_bf16 v[136:139], a[84:87], a[60:63], v[136:139]
ds_read_b128 a[8:11], v2 offset:2048
v_add_u32 v6, 0x8000, v6
v_mfma_f32_16x16x32_bf16 v[120:123], a[84:87], a[52:55], v[120:123]
s_add_u32 m0, s76, 36864
ds_read_b128 a[12:15], v3 offset:2048
v_mfma_f32_16x16x32_bf16 v[120:123], a[80:83], a[48:51], v[120:123]
s_add_u32 s64, s73, 1664
ds_read_b128 a[16:19], v2 offset:4096
v_mfma_f32_16x16x32_bf16 v[104:107], a[80:83], a[40:43], v[104:107]
buffer_load_dwordx4 v12, s[48:51], s64 offen lds
v_mfma_f32_16x16x32_bf16 v[104:107], a[84:87], a[44:47], v[104:107]
ds_read_b128 a[20:23], v3 offset:4096
v_mfma_f32_16x16x32_bf16 v[88:91], a[84:87], a[36:39], v[88:91]
buffer_store_dwordx4 a[240:243], v16, s[44:47], s74 offen sc1
v_mfma_f32_16x16x32_bf16 v[88:91], a[80:83], a[32:35], v[88:91]
s_waitcnt lgkmcnt(6)
s_add_u32 m0, s76, 37888
ds_read_b128 a[24:27], v2 offset:6144
v_mfma_f32_16x16x32_bf16 v[28:31], a[88:91], a[32:35], v[28:31]
s_add_u32 s64, s73, 18048
ds_read_b128 a[28:31], v3 offset:6144
v_mfma_f32_16x16x32_bf16 v[28:31], a[92:95], a[36:39], v[28:31]
buffer_load_dwordx4 v13, s[48:51], s64 offen lds
v_mfma_f32_16x16x32_bf16 v[44:47], a[92:95], a[44:47], v[44:47]
ds_read_b64_tr_b16 a[72:73], v10 offset:32768
v_add_u32 v7, 0x8000, v7
v_mfma_f32_16x16x32_bf16 v[44:47], a[88:91], a[40:43], v[44:47]
ds_read_b64_tr_b16 a[74:75], v10 offset:33792
v_mfma_f32_16x16x32_bf16 v[60:63], a[88:91], a[48:51], v[60:63]
s_add_u32 m0, s76, 38912
ds_read_b64_tr_b16 a[76:77], v10 offset:40960
v_mfma_f32_16x16x32_bf16 v[60:63], a[92:95], a[52:55], v[60:63]
s_add_u32 s64, s73, 132736
ds_read_b64_tr_b16 a[78:79], v10 offset:41984
v_mfma_f32_16x16x32_bf16 v[76:79], a[92:95], a[60:63], v[76:79]
buffer_load_dwordx4 v12, s[48:51], s64 offen lds
v_mfma_f32_16x16x32_bf16 v[76:79], a[88:91], a[56:59], v[76:79]
ds_read_b64_tr_b16 a[80:81], v11 offset:32768
v_mfma_f32_16x16x32_bf16 v[140:143], a[96:99], a[56:59], v[140:143]
ds_read_b64_tr_b16 a[82:83], v11 offset:33792
v_mfma_f32_16x16x32_bf16 v[140:143], a[100:103], a[60:63], v[140:143]
s_add_u32 m0, s76, 39936
ds_read_b64_tr_b16 a[84:85], v11 offset:40960
v_add_u32 v8, 0x8000, v8
v_mfma_f32_16x16x32_bf16 v[124:127], a[100:103], a[52:55], v[124:127]
s_add_u32 s64, s73, 149120
ds_read_b64_tr_b16 a[86:87], v11 offset:41984
v_mfma_f32_16x16x32_bf16 v[124:127], a[96:99], a[48:51], v[124:127]
buffer_load_dwordx4 v13, s[48:51], s64 offen lds
v_mfma_f32_16x16x32_bf16 v[108:111], a[96:99], a[40:43], v[108:111]
v_mfma_f32_16x16x32_bf16 v[108:111], a[100:103], a[44:47], v[108:111]
v_mfma_f32_16x16x32_bf16 v[92:95], a[100:103], a[36:39], v[92:95]
v_add_u32 v9, 0x8000, v9
v_add_u32 v10, 0x8000, v10
v_mfma_f32_16x16x32_bf16 v[92:95], a[96:99], a[32:35], v[92:95]
v_add_u32 v11, 0x8000, v11
v_mfma_f32_16x16x32_bf16 v[32:35], a[104:107], a[32:35], v[32:35]
v_mfma_f32_16x16x32_bf16 v[32:35], a[108:111], a[36:39], v[32:35]
v_mfma_f32_16x16x32_bf16 v[48:51], a[108:111], a[44:47], v[48:51]
s_waitcnt lgkmcnt(0)
s_barrier
v_mfma_f32_16x16x32_bf16 v[48:51], a[104:107], a[40:43], v[48:51]
s_add_u32 m0, s77, 98304
ds_read_b64_tr_b16 a[88:89], v19 offset:36864
v_mfma_f32_16x16x32_bf16 v[64:67], a[104:107], a[48:51], v[64:67]
s_add_u32 s64, s71, 7340032
ds_read_b64_tr_b16 a[90:91], v19 offset:37120
v_mfma_f32_16x16x32_bf16 v[64:67], a[108:111], a[52:55], v[64:67]
buffer_load_dwordx4 v14, s[56:59], s64 offen lds
v_mfma_f32_16x16x32_bf16 v[80:83], a[108:111], a[60:63], v[80:83]
ds_read_b64_tr_b16 a[92:93], v19 offset:38912
v_mfma_f32_16x16x32_bf16 v[80:83], a[104:107], a[56:59], v[80:83]
ds_read_b64_tr_b16 a[94:95], v19 offset:39168
v_mfma_f32_16x16x32_bf16 v[144:147], a[112:115], a[56:59], v[144:147]
ds_read_b64_tr_b16 a[96:97], v20 offset:36864
v_mfma_f32_16x16x32_bf16 v[144:147], a[116:119], a[60:63], v[144:147]
ds_read_b64_tr_b16 a[98:99], v20 offset:37120
v_mfma_f32_16x16x32_bf16 v[128:131], a[116:119], a[52:55], v[128:131]
ds_read_b64_tr_b16 a[100:101], v20 offset:38912
v_mfma_f32_16x16x32_bf16 v[128:131], a[112:115], a[48:51], v[128:131]
ds_read_b64_tr_b16 a[102:103], v20 offset:39168
v_mfma_f32_16x16x32_bf16 v[112:115], a[112:115], a[40:43], v[112:115]
s_add_u32 m0, s78, 114688
ds_read_b64_tr_b16 a[104:105], v19 offset:40960
v_mfma_f32_16x16x32_bf16 v[112:115], a[116:119], a[44:47], v[112:115]
s_add_u32 s64, s75, 5505024
ds_read_b64_tr_b16 a[106:107], v19 offset:41216
v_mfma_f32_16x16x32_bf16 v[96:99], a[116:119], a[36:39], v[96:99]
buffer_load_dwordx4 v23, s[60:63], s64 offen lds
v_mfma_f32_16x16x32_bf16 v[96:99], a[112:115], a[32:35], v[96:99]
ds_read_b64_tr_b16 a[108:109], v19 offset:43008
v_mfma_f32_16x16x32_bf16 v[36:39], a[72:75], a[32:35], v[36:39]
ds_read_b64_tr_b16 a[110:111], v19 offset:43264
v_mfma_f32_16x16x32_bf16 v[36:39], a[76:79], a[36:39], v[36:39]
ds_read_b64_tr_b16 a[112:113], v20 offset:40960
v_mfma_f32_16x16x32_bf16 v[52:55], a[76:79], a[44:47], v[52:55]
ds_read_b64_tr_b16 a[114:115], v20 offset:41216
v_mfma_f32_16x16x32_bf16 v[52:55], a[72:75], a[40:43], v[52:55]
ds_read_b64_tr_b16 a[116:117], v20 offset:43008
v_mfma_f32_16x16x32_bf16 v[68:71], a[72:75], a[48:51], v[68:71]
ds_read_b64_tr_b16 a[118:119], v20 offset:43264
v_mfma_f32_16x16x32_bf16 v[68:71], a[76:79], a[52:55], v[68:71]
s_add_u32 m0, s77, 99328
v_mfma_f32_16x16x32_bf16 v[84:87], a[76:79], a[60:63], v[84:87]
s_add_u32 s64, s71, 7372800
v_mfma_f32_16x16x32_bf16 v[84:87], a[72:75], a[56:59], v[84:87]
buffer_load_dwordx4 v14, s[56:59], s64 offen lds
v_mfma_f32_16x16x32_bf16 v[148:151], a[80:83], a[56:59], v[148:151]
ds_read_b64_tr_b16 a[72:73], v19 offset:32768
v_mfma_f32_16x16x32_bf16 v[148:151], a[84:87], a[60:63], v[148:151]
ds_read_b64_tr_b16 a[74:75], v19 offset:33024
v_mfma_f32_16x16x32_bf16 v[132:135], a[84:87], a[52:55], v[132:135]
ds_read_b64_tr_b16 a[76:77], v19 offset:34816
v_mfma_f32_16x16x32_bf16 v[132:135], a[80:83], a[48:51], v[132:135]
ds_read_b64_tr_b16 a[78:79], v19 offset:35072
v_mfma_f32_16x16x32_bf16 v[116:119], a[80:83], a[40:43], v[116:119]
v_mfma_f32_16x16x32_bf16 v[116:119], a[84:87], a[44:47], v[116:119]
v_mfma_f32_16x16x32_bf16 v[100:103], a[84:87], a[36:39], v[100:103]
s_add_u32 m0, s78, 118784
v_mfma_f32_16x16x32_bf16 v[100:103], a[80:83], a[32:35], v[100:103]
s_waitcnt lgkmcnt(4)
s_add_u32 s64, s75, 5507072
ds_read_b64_tr_b16 a[80:81], v20 offset:32768
v_mfma_f32_16x16x32_bf16 v[184:187], a[88:91], a[0:3], v[184:187]
s_lshl_b32 s66, s30, 30
buffer_load_dwordx4 v23, s[60:63], s64 offen lds
v_mfma_f32_16x16x32_bf16 v[184:187], a[92:95], a[4:7], v[184:187]
ds_read_b64_tr_b16 a[82:83], v20 offset:33024
v_lshl_add_u32 v1, v0, 24, s66
v_mfma_f32_16x16x32_bf16 v[192:195], a[92:95], a[12:15], v[192:195]
s_lshl_b32 s70, s31, 8
ds_read_b64_tr_b16 a[84:85], v20 offset:34816
v_mfma_f32_16x16x32_bf16 v[192:195], a[88:91], a[8:11], v[192:195]
s_add_u32 s17, s78, .-L_pc+6144
ds_read_b64_tr_b16 a[86:87], v20 offset:35072
v_mfma_f32_16x16x32_bf16 v[200:203], a[88:91], a[16:19], v[200:203]
buffer_load_dword a252, v16, s[88:91], s17 offen
v_mfma_f32_16x16x32_bf16 v[200:203], a[92:95], a[20:23], v[200:203]
v_mfma_f32_16x16x32_bf16 v[208:211], a[92:95], a[28:31], v[208:211]
v_mfma_f32_16x16x32_bf16 v[208:211], a[88:91], a[24:27], v[208:211]
ds_read_b64_tr_b16 a[88:89], v4 offset:32768
v_mfma_f32_16x16x32_bf16 v[212:215], a[96:99], a[24:27], v[212:215]
s_add_u32 m0, s77, 100352
ds_read_b64_tr_b16 a[90:91], v4 offset:33792
v_mfma_f32_16x16x32_bf16 v[212:215], a[100:103], a[28:31], v[212:215]
s_add_u32 s64, s71, 7405568
ds_read_b64_tr_b16 a[92:93], v4 offset:40960
v_mfma_f32_16x16x32_bf16 v[204:207], a[100:103], a[20:23], v[204:207]
buffer_load_dwordx4 v15, s[56:59], s64 offen lds
v_mfma_f32_16x16x32_bf16 v[204:207], a[96:99], a[16:19], v[204:207]
ds_read_b64_tr_b16 a[94:95], v4 offset:41984
v_mfma_f32_16x16x32_bf16 v[196:199], a[96:99], a[8:11], v[196:199]
v_mfma_f32_16x16x32_bf16 v[196:199], a[100:103], a[12:15], v[196:199]
v_mfma_f32_16x16x32_bf16 v[188:191], a[100:103], a[4:7], v[188:191]
v_mfma_f32_16x16x32_bf16 v[188:191], a[96:99], a[0:3], v[188:191]
ds_read_b64_tr_b16 a[96:97], v5 offset:32768
v_mfma_f32_16x16x32_bf16 v[216:219], a[0:3], a[104:107], v[216:219]
ds_read_b64_tr_b16 a[98:99], v5 offset:33792
v_mfma_f32_16x16x32_bf16 v[216:219], a[4:7], a[108:111], v[216:219]
s_add_u32 m0, s78, 122880
ds_read_b64_tr_b16 a[100:101], v5 offset:40960
v_mfma_f32_16x16x32_bf16 v[224:227], a[12:15], a[108:111], v[224:227]
s_add_u32 s64, s75, 5509120
ds_read_b64_tr_b16 a[102:103], v5 offset:41984
v_mfma_f32_16x16x32_bf16 v[224:227], a[8:11], a[104:107], v[224:227]
buffer_load_dwordx4 v23, s[60:63], s64 offen lds
v_mfma_f32_16x16x32_bf16 v[232:235], a[16:19], a[104:107], v[232:235]
v_mfma_f32_16x16x32_bf16 v[232:235], a[20:23], a[108:111], v[232:235]
v_mfma_f32_16x16x32_bf16 v[240:243], a[28:31], a[108:111], v[240:243]
v_mfma_f32_16x16x32_bf16 v[240:243], a[24:27], a[104:107], v[240:243]
ds_read_b64_tr_b16 a[104:105], v6 offset:32768
v_mfma_f32_16x16x32_bf16 v[244:247], a[24:27], a[112:115], v[244:247]
ds_read_b64_tr_b16 a[106:107], v6 offset:33792
v_mfma_f32_16x16x32_bf16 v[244:247], a[28:31], a[116:119], v[244:247]
ds_read_b64_tr_b16 a[108:109], v6 offset:40960
v_subrev_u32 v19, 0x8000, v19
v_mfma_f32_16x16x32_bf16 v[236:239], a[20:23], a[116:119], v[236:239]
s_add_u32 m0, s77, 101376
ds_read_b64_tr_b16 a[110:111], v6 offset:41984
v_mfma_f32_16x16x32_bf16 v[236:239], a[16:19], a[112:115], v[236:239]
s_add_u32 s64, s71, 7438336
v_mfma_f32_16x16x32_bf16 v[228:231], a[8:11], a[112:115], v[228:231]
buffer_load_dwordx4 v15, s[56:59], s64 offen lds
v_mfma_f32_16x16x32_bf16 v[228:231], a[12:15], a[116:119], v[228:231]
v_mfma_f32_16x16x32_bf16 v[220:223], a[4:7], a[116:119], v[220:223]
v_mfma_f32_16x16x32_bf16 v[220:223], a[0:3], a[112:115], v[220:223]
s_waitcnt lgkmcnt(4)
ds_read_b64_tr_b16 a[112:113], v7 offset:32768
v_mfma_f32_16x16x32_bf16 v[152:155], a[72:75], a[0:3], v[152:155]
ds_read_b64_tr_b16 a[114:115], v7 offset:33792
v_mfma_f32_16x16x32_bf16 v[152:155], a[76:79], a[4:7], v[152:155]
ds_read_b64_tr_b16 a[116:117], v7 offset:40960
v_subrev_u32 v20, 0x8000, v20
v_mfma_f32_16x16x32_bf16 v[160:163], a[76:79], a[12:15], v[160:163]
ds_read_b64_tr_b16 a[118:119], v7 offset:41984
v_mfma_f32_16x16x32_bf16 v[160:163], a[72:75], a[8:11], v[160:163]
v_mfma_f32_16x16x32_bf16 v[168:171], a[72:75], a[16:19], v[168:171]
v_mfma_f32_16x16x32_bf16 v[168:171], a[76:79], a[20:23], v[168:171]
v_mfma_f32_16x16x32_bf16 v[176:179], a[76:79], a[28:31], v[176:179]
s_add_u32 m0, s76, 0
v_mfma_f32_16x16x32_bf16 v[176:179], a[72:75], a[24:27], v[176:179]
s_add_u32 s64, s72, 1792
ds_read_b64_tr_b16 a[72:73], v8 offset:32768
v_mfma_f32_16x16x32_bf16 v[180:183], a[80:83], a[24:27], v[180:183]
buffer_load_dwordx4 v12, s[48:51], s64 offen lds
v_mfma_f32_16x16x32_bf16 v[180:183], a[84:87], a[28:31], v[180:183]
ds_read_b64_tr_b16 a[74:75], v8 offset:33792
v_subrev_u32 v4, 0x8000, v4
v_mfma_f32_16x16x32_bf16 v[172:175], a[84:87], a[20:23], v[172:175]
ds_read_b64_tr_b16 a[76:77], v8 offset:40960
v_mfma_f32_16x16x32_bf16 v[172:175], a[80:83], a[16:19], v[172:175]
s_add_u32 m0, s76, 1024
ds_read_b64_tr_b16 a[78:79], v8 offset:41984
v_mfma_f32_16x16x32_bf16 v[164:167], a[80:83], a[8:11], v[164:167]
s_add_u32 s64, s72, 18176
v_mfma_f32_16x16x32_bf16 v[164:167], a[84:87], a[12:15], v[164:167]
buffer_load_dwordx4 v13, s[48:51], s64 offen lds
v_mfma_f32_16x16x32_bf16 v[156:159], a[84:87], a[4:7], v[156:159]
v_mfma_f32_16x16x32_bf16 v[156:159], a[80:83], a[0:3], v[156:159]
ds_read_b64_tr_b16 a[80:81], v9 offset:32768
v_mfma_f32_16x16x32_bf16 v[24:27], a[88:91], a[0:3], v[24:27]
s_add_u32 m0, s76, 2048
ds_read_b64_tr_b16 a[82:83], v9 offset:33792
v_mfma_f32_16x16x32_bf16 v[24:27], a[92:95], a[4:7], v[24:27]
s_add_u32 s64, s72, 132864
ds_read_b64_tr_b16 a[84:85], v9 offset:40960
v_subrev_u32 v5, 0x8000, v5
v_mfma_f32_16x16x32_bf16 v[40:43], a[92:95], a[12:15], v[40:43]
buffer_load_dwordx4 v12, s[48:51], s64 offen lds
v_mfma_f32_16x16x32_bf16 v[40:43], a[88:91], a[8:11], v[40:43]
ds_read_b64_tr_b16 a[86:87], v9 offset:41984
v_mfma_f32_16x16x32_bf16 v[56:59], a[88:91], a[16:19], v[56:59]
v_mfma_f32_16x16x32_bf16 v[56:59], a[92:95], a[20:23], v[56:59]
s_add_u32 m0, s76, 3072
v_mfma_f32_16x16x32_bf16 v[72:75], a[92:95], a[28:31], v[72:75]
s_waitcnt vmcnt(11)
s_add_u32 s64, s72, 149248
ds_read_b128 a[32:35], v2 offset:32768
v_mfma_f32_16x16x32_bf16 v[72:75], a[88:91], a[24:27], v[72:75]
buffer_load_dwordx4 v13, s[48:51], s64 offen lds
v_mfma_f32_16x16x32_bf16 v[136:139], a[96:99], a[24:27], v[136:139]
ds_read_b128 a[36:39], v3 offset:32768
v_mfma_f32_16x16x32_bf16 v[136:139], a[100:103], a[28:31], v[136:139]
ds_read_b128 a[40:43], v2 offset:34816
v_subrev_u32 v6, 0x8000, v6
v_mfma_f32_16x16x32_bf16 v[120:123], a[100:103], a[20:23], v[120:123]
s_add_u32 m0, s76, 4096
ds_read_b128 a[44:47], v3 offset:34816
v_mfma_f32_16x16x32_bf16 v[120:123], a[96:99], a[16:19], v[120:123]
s_add_u32 s64, s73, 1792
ds_read_b128 a[48:51], v2 offset:36864
v_mfma_f32_16x16x32_bf16 v[104:107], a[96:99], a[8:11], v[104:107]
buffer_load_dwordx4 v12, s[48:51], s64 offen lds
v_mfma_f32_16x16x32_bf16 v[104:107], a[100:103], a[12:15], v[104:107]
ds_read_b128 a[52:55], v3 offset:36864
v_mfma_f32_16x16x32_bf16 v[88:91], a[100:103], a[4:7], v[88:91]
ds_read_b128 a[56:59], v2 offset:38912
v_mfma_f32_16x16x32_bf16 v[88:91], a[96:99], a[0:3], v[88:91]
s_waitcnt lgkmcnt(7)
s_add_u32 m0, s76, 5120
ds_read_b128 a[60:63], v3 offset:38912
v_mfma_f32_16x16x32_bf16 v[28:31], a[104:107], a[0:3], v[28:31]
s_add_u32 s64, s73, 18176
ds_read_b64_tr_b16 a[88:89], v10 offset:32768
v_mfma_f32_16x16x32_bf16 v[28:31], a[108:111], a[4:7], v[28:31]
buffer_load_dwordx4 v13, s[48:51], s64 offen lds
v_mfma_f32_16x16x32_bf16 v[44:47], a[108:111], a[12:15], v[44:47]
ds_read_b64_tr_b16 a[90:91], v10 offset:33792
v_subrev_u32 v7, 0x8000, v7
v_mfma_f32_16x16x32_bf16 v[44:47], a[104:107], a[8:11], v[44:47]
ds_read_b64_tr_b16 a[92:93], v10 offset:40960
v_mfma_f32_16x16x32_bf16 v[60:63], a[104:107], a[16:19], v[60:63]
s_add_u32 m0, s76, 6144
ds_read_b64_tr_b16 a[94:95], v10 offset:41984
v_mfma_f32_16x16x32_bf16 v[60:63], a[108:111], a[20:23], v[60:63]
s_add_u32 s64, s73, 132864
ds_read_b64_tr_b16 a[96:97], v11 offset:32768
v_mfma_f32_16x16x32_bf16 v[76:79], a[108:111], a[28:31], v[76:79]
buffer_load_dwordx4 v12, s[48:51], s64 offen lds
v_mfma_f32_16x16x32_bf16 v[76:79], a[104:107], a[24:27], v[76:79]
ds_read_b64_tr_b16 a[98:99], v11 offset:33792
v_mfma_f32_16x16x32_bf16 v[140:143], a[112:115], a[24:27], v[140:143]
ds_read_b64_tr_b16 a[100:101], v11 offset:40960
v_mfma_f32_16x16x32_bf16 v[140:143], a[116:119], a[28:31], v[140:143]
s_add_u32 m0, s76, 7168
ds_read_b64_tr_b16 a[102:103], v11 offset:41984
v_subrev_u32 v8, 0x8000, v8
v_mfma_f32_16x16x32_bf16 v[124:127], a[116:119], a[20:23], v[124:127]
s_add_u32 s64, s73, 149248
v_mfma_f32_16x16x32_bf16 v[124:127], a[112:115], a[16:19], v[124:127]
buffer_load_dwordx4 v13, s[48:51], s64 offen lds
v_mfma_f32_16x16x32_bf16 v[108:111], a[112:115], a[8:11], v[108:111]
v_mfma_f32_16x16x32_bf16 v[108:111], a[116:119], a[12:15], v[108:111]
v_mfma_f32_16x16x32_bf16 v[92:95], a[116:119], a[4:7], v[92:95]
v_subrev_u32 v9, 0x8000, v9
v_subrev_u32 v10, 0x8000, v10
v_mfma_f32_16x16x32_bf16 v[92:95], a[112:115], a[0:3], v[92:95]
v_subrev_u32 v11, 0x8000, v11
v_mfma_f32_16x16x32_bf16 v[32:35], a[72:75], a[0:3], v[32:35]
v_mfma_f32_16x16x32_bf16 v[32:35], a[76:79], a[4:7], v[32:35]
v_mfma_f32_16x16x32_bf16 v[48:51], a[76:79], a[12:15], v[48:51]
s_waitcnt lgkmcnt(0)
s_barrier
v_mfma_f32_16x16x32_bf16 v[48:51], a[72:75], a[8:11], v[48:51]
s_mov_b64 exec, 1
buffer_atomic_add a251, v1, s[52:55], s70 offen offset:0 sc1
s_mov_b64 exec, -1
s_add_u32 m0, s77, 131072
v_mfma_f32_16x16x32_bf16 v[64:67], a[72:75], a[16:19], v[64:67]
s_lshl4_add_u32 s70, s78, s70
s_add_u32 s64, s71, 7864320
ds_read_b64_tr_b16 a[104:105], v19 offset:4096
v_mfma_f32_16x16x32_bf16 v[64:67], a[76:79], a[20:23], v[64:67]
s_lshr_b32 s81, s81, 5
buffer_load_dwordx4 v14, s[56:59], s64 offen lds
v_mfma_f32_16x16x32_bf16 v[80:83], a[76:79], a[28:31], v[80:83]
ds_read_b64_tr_b16 a[106:107], v19 offset:4352
v_mfma_f32_16x16x32_bf16 v[80:83], a[72:75], a[24:27], v[80:83]
ds_read_b64_tr_b16 a[108:109], v19 offset:6144
v_mfma_f32_16x16x32_bf16 v[144:147], a[80:83], a[24:27], v[144:147]
ds_read_b64_tr_b16 a[110:111], v19 offset:6400
v_mfma_f32_16x16x32_bf16 v[144:147], a[84:87], a[28:31], v[144:147]
ds_read_b64_tr_b16 a[112:113], v20 offset:4096
v_mfma_f32_16x16x32_bf16 v[128:131], a[84:87], a[20:23], v[128:131]
ds_read_b64_tr_b16 a[114:115], v20 offset:4352
v_mfma_f32_16x16x32_bf16 v[128:131], a[80:83], a[16:19], v[128:131]
ds_read_b64_tr_b16 a[116:117], v20 offset:6144
v_mfma_f32_16x16x32_bf16 v[112:115], a[80:83], a[8:11], v[112:115]
s_add_u32 m0, s78, 147456
ds_read_b64_tr_b16 a[118:119], v20 offset:6400
v_mfma_f32_16x16x32_bf16 v[112:115], a[84:87], a[12:15], v[112:115]
s_add_u32 s64, s75, 5898240
ds_read_b64_tr_b16 a[72:73], v19 offset:8192
v_mfma_f32_16x16x32_bf16 v[96:99], a[84:87], a[4:7], v[96:99]
buffer_load_dwordx4 v23, s[60:63], s64 offen lds
v_mfma_f32_16x16x32_bf16 v[96:99], a[80:83], a[0:3], v[96:99]
ds_read_b64_tr_b16 a[74:75], v19 offset:8448
v_mfma_f32_16x16x32_bf16 v[36:39], a[88:91], a[0:3], v[36:39]
ds_read_b64_tr_b16 a[76:77], v19 offset:10240
v_mfma_f32_16x16x32_bf16 v[36:39], a[92:95], a[4:7], v[36:39]
ds_read_b64_tr_b16 a[78:79], v19 offset:10496
v_mfma_f32_16x16x32_bf16 v[52:55], a[92:95], a[12:15], v[52:55]
ds_read_b64_tr_b16 a[80:81], v20 offset:8192
v_mfma_f32_16x16x32_bf16 v[52:55], a[88:91], a[8:11], v[52:55]
ds_read_b64_tr_b16 a[82:83], v20 offset:8448
v_mfma_f32_16x16x32_bf16 v[68:71], a[88:91], a[16:19], v[68:71]
ds_read_b64_tr_b16 a[84:85], v20 offset:10240
v_mfma_f32_16x16x32_bf16 v[68:71], a[92:95], a[20:23], v[68:71]
s_add_u32 m0, s77, 132096
ds_read_b64_tr_b16 a[86:87], v20 offset:10496
v_mfma_f32_16x16x32_bf16 v[84:87], a[92:95], a[28:31], v[84:87]
s_add_u32 s64, s71, 7897088
v_mfma_f32_16x16x32_bf16 v[84:87], a[88:91], a[24:27], v[84:87]
buffer_load_dwordx4 v14, s[56:59], s64 offen lds
v_mfma_f32_16x16x32_bf16 v[148:151], a[96:99], a[24:27], v[148:151]
ds_read_b64_tr_b16 a[88:89], v19 offset:0
v_mfma_f32_16x16x32_bf16 v[148:151], a[100:103], a[28:31], v[148:151]
ds_read_b64_tr_b16 a[90:91], v19 offset:256
v_mfma_f32_16x16x32_bf16 v[132:135], a[100:103], a[20:23], v[132:135]
ds_read_b64_tr_b16 a[92:93], v19 offset:2048
v_mfma_f32_16x16x32_bf16 v[132:135], a[96:99], a[16:19], v[132:135]
ds_read_b64_tr_b16 a[94:95], v19 offset:2304
v_mfma_f32_16x16x32_bf16 v[116:119], a[96:99], a[8:11], v[116:119]
v_mfma_f32_16x16x32_bf16 v[116:119], a[100:103], a[12:15], v[116:119]
v_mfma_f32_16x16x32_bf16 v[100:103], a[100:103], a[4:7], v[100:103]
s_add_u32 m0, s78, 151552
v_mfma_f32_16x16x32_bf16 v[100:103], a[96:99], a[0:3], v[100:103]
s_waitcnt lgkmcnt(4)
s_add_u32 s64, s75, 5900288
ds_read_b64_tr_b16 a[96:97], v20 offset:0
v_mfma_f32_16x16x32_bf16 v[184:187], a[104:107], a[32:35], v[184:187]
buffer_load_dwordx4 v23, s[60:63], s64 offen lds
v_mfma_f32_16x16x32_bf16 v[184:187], a[108:111], a[36:39], v[184:187]
ds_read_b64_tr_b16 a[98:99], v20 offset:256
v_and_b32 v22, 15, v0
v_mfma_f32_16x16x32_bf16 v[192:195], a[108:111], a[44:47], v[192:195]
ds_read_b64_tr_b16 a[100:101], v20 offset:2048
v_lshlrev_b32 v22, 3, v22
v_mfma_f32_16x16x32_bf16 v[192:195], a[104:107], a[40:43], v[192:195]
s_lshl_b32 s85, s30, 7
s_add_u32 s85, s85, 58720256
ds_read_b64_tr_b16 a[102:103], v20 offset:2304
v_mfma_f32_16x16x32_bf16 v[200:203], a[104:107], a[48:51], v[200:203]
s_lshl_b32 s86, s3, 10
s_add_u32 s86, s86, s85
s_lshl_b32 s87, s16, 10
s_lshl_b32 s68, s31, 20
s_add_u32 s32, s28, s68
s_addc_u32 s33, s29, 0
v_mfma_f32_16x16x32_bf16 v[200:203], a[108:111], a[52:55], v[200:203]
s_add_u32 s87, s87, s85
s_add_u32 s68, s16, 1
s_lshl_b32 s34, s68, 16
v_mfma_f32_16x16x32_bf16 v[208:211], a[108:111], a[60:63], v[208:211]
v_mfma_f32_16x16x32_bf16 v[208:211], a[104:107], a[56:59], v[208:211]
ds_read_b64_tr_b16 a[104:105], v4 offset:0
v_mfma_f32_16x16x32_bf16 v[212:215], a[112:115], a[56:59], v[212:215]
s_add_u32 m0, s77, 133120
ds_read_b64_tr_b16 a[106:107], v4 offset:1024
v_mfma_f32_16x16x32_bf16 v[212:215], a[116:119], a[60:63], v[212:215]
s_add_u32 s64, s71, 7929856
ds_read_b64_tr_b16 a[108:109], v4 offset:8192
v_mfma_f32_16x16x32_bf16 v[204:207], a[116:119], a[52:55], v[204:207]
buffer_load_dwordx4 v15, s[56:59], s64 offen lds
v_mfma_f32_16x16x32_bf16 v[204:207], a[112:115], a[48:51], v[204:207]
ds_read_b64_tr_b16 a[110:111], v4 offset:9216
v_mfma_f32_16x16x32_bf16 v[196:199], a[112:115], a[40:43], v[196:199]
v_mfma_f32_16x16x32_bf16 v[196:199], a[116:119], a[44:47], v[196:199]
v_mfma_f32_16x16x32_bf16 v[188:191], a[116:119], a[36:39], v[188:191]
v_mfma_f32_16x16x32_bf16 v[188:191], a[112:115], a[32:35], v[188:191]
ds_read_b64_tr_b16 a[112:113], v5 offset:0
v_mfma_f32_16x16x32_bf16 v[216:219], a[32:35], a[72:75], v[216:219]
ds_read_b64_tr_b16 a[114:115], v5 offset:1024
v_mfma_f32_16x16x32_bf16 v[216:219], a[36:39], a[76:79], v[216:219]
s_add_u32 m0, s78, 155648
ds_read_b64_tr_b16 a[116:117], v5 offset:8192
v_mfma_f32_16x16x32_bf16 v[224:227], a[44:47], a[76:79], v[224:227]
s_add_u32 s64, s75, 5902336
ds_read_b64_tr_b16 a[118:119], v5 offset:9216
v_mfma_f32_16x16x32_bf16 v[224:227], a[40:43], a[72:75], v[224:227]
buffer_load_dwordx4 v23, s[60:63], s64 offen lds
v_mfma_f32_16x16x32_bf16 v[232:235], a[48:51], a[72:75], v[232:235]
v_mfma_f32_16x16x32_bf16 v[232:235], a[52:55], a[76:79], v[232:235]
v_mfma_f32_16x16x32_bf16 v[240:243], a[60:63], a[76:79], v[240:243]
v_mfma_f32_16x16x32_bf16 v[240:243], a[56:59], a[72:75], v[240:243]
ds_read_b64_tr_b16 a[72:73], v6 offset:0
v_mfma_f32_16x16x32_bf16 v[244:247], a[56:59], a[80:83], v[244:247]
ds_read_b64_tr_b16 a[74:75], v6 offset:1024
v_mfma_f32_16x16x32_bf16 v[244:247], a[60:63], a[84:87], v[244:247]
ds_read_b64_tr_b16 a[76:77], v6 offset:8192
v_mfma_f32_16x16x32_bf16 v[236:239], a[52:55], a[84:87], v[236:239]
s_add_u32 m0, s77, 134144
ds_read_b64_tr_b16 a[78:79], v6 offset:9216
v_mfma_f32_16x16x32_bf16 v[236:239], a[48:51], a[80:83], v[236:239]
s_add_u32 s64, s71, 7962624
v_mfma_f32_16x16x32_bf16 v[228:231], a[40:43], a[80:83], v[228:231]
buffer_load_dwordx4 v15, s[56:59], s64 offen lds
v_mfma_f32_16x16x32_bf16 v[228:231], a[44:47], a[84:87], v[228:231]
v_mfma_f32_16x16x32_bf16 v[220:223], a[36:39], a[84:87], v[220:223]
v_mfma_f32_16x16x32_bf16 v[220:223], a[32:35], a[80:83], v[220:223]
s_waitcnt lgkmcnt(4)
ds_read_b64_tr_b16 a[80:81], v7 offset:0
v_mfma_f32_16x16x32_bf16 v[152:155], a[88:91], a[32:35], v[152:155]
ds_read_b64_tr_b16 a[82:83], v7 offset:1024
v_mfma_f32_16x16x32_bf16 v[152:155], a[92:95], a[36:39], v[152:155]
ds_read_b64_tr_b16 a[84:85], v7 offset:8192
v_mfma_f32_16x16x32_bf16 v[160:163], a[92:95], a[44:47], v[160:163]
ds_read_b64_tr_b16 a[86:87], v7 offset:9216
v_mfma_f32_16x16x32_bf16 v[160:163], a[88:91], a[40:43], v[160:163]
v_mfma_f32_16x16x32_bf16 v[168:171], a[88:91], a[48:51], v[168:171]
v_mfma_f32_16x16x32_bf16 v[168:171], a[92:95], a[52:55], v[168:171]
v_mfma_f32_16x16x32_bf16 v[176:179], a[92:95], a[60:63], v[176:179]
s_add_u32 m0, s76, 32768
v_mfma_f32_16x16x32_bf16 v[176:179], a[88:91], a[56:59], v[176:179]
s_add_u32 s64, s72, 1920
ds_read_b64_tr_b16 a[88:89], v8 offset:0
v_mfma_f32_16x16x32_bf16 v[180:183], a[96:99], a[56:59], v[180:183]
buffer_load_dwordx4 v12, s[48:51], s64 offen lds
v_mfma_f32_16x16x32_bf16 v[180:183], a[100:103], a[60:63], v[180:183]
ds_read_b64_tr_b16 a[90:91], v8 offset:1024
v_mfma_f32_16x16x32_bf16 v[172:175], a[100:103], a[52:55], v[172:175]
ds_read_b64_tr_b16 a[92:93], v8 offset:8192
v_mfma_f32_16x16x32_bf16 v[172:175], a[96:99], a[48:51], v[172:175]
s_add_u32 m0, s76, 33792
ds_read_b64_tr_b16 a[94:95], v8 offset:9216
v_mfma_f32_16x16x32_bf16 v[164:167], a[96:99], a[40:43], v[164:167]
s_add_u32 s64, s72, 18304
v_mfma_f32_16x16x32_bf16 v[164:167], a[100:103], a[44:47], v[164:167]
buffer_load_dwordx4 v13, s[48:51], s64 offen lds
v_mfma_f32_16x16x32_bf16 v[156:159], a[100:103], a[36:39], v[156:159]
v_mfma_f32_16x16x32_bf16 v[156:159], a[96:99], a[32:35], v[156:159]
ds_read_b64_tr_b16 a[96:97], v9 offset:0
v_mfma_f32_16x16x32_bf16 v[24:27], a[104:107], a[32:35], v[24:27]
s_add_u32 m0, s76, 34816
ds_read_b64_tr_b16 a[98:99], v9 offset:1024
v_mfma_f32_16x16x32_bf16 v[24:27], a[108:111], a[36:39], v[24:27]
s_add_u32 s64, s72, 132992
ds_read_b64_tr_b16 a[100:101], v9 offset:8192
v_mfma_f32_16x16x32_bf16 v[40:43], a[108:111], a[44:47], v[40:43]
buffer_load_dwordx4 v12, s[48:51], s64 offen lds
v_mfma_f32_16x16x32_bf16 v[40:43], a[104:107], a[40:43], v[40:43]
ds_read_b64_tr_b16 a[102:103], v9 offset:9216
v_mfma_f32_16x16x32_bf16 v[56:59], a[104:107], a[48:51], v[56:59]
v_mfma_f32_16x16x32_bf16 v[56:59], a[108:111], a[52:55], v[56:59]
s_add_u32 m0, s76, 35840
v_mfma_f32_16x16x32_bf16 v[72:75], a[108:111], a[60:63], v[72:75]
s_waitcnt vmcnt(11)
s_add_u32 s64, s72, 149376
ds_read_b128 a[0:3], v2 offset:0
v_mfma_f32_16x16x32_bf16 v[72:75], a[104:107], a[56:59], v[72:75]
buffer_load_dwordx4 v13, s[48:51], s64 offen lds
v_mfma_f32_16x16x32_bf16 v[136:139], a[112:115], a[56:59], v[136:139]
ds_read_b128 a[4:7], v3 offset:0
v_mfma_f32_16x16x32_bf16 v[136:139], a[116:119], a[60:63], v[136:139]
ds_read_b128 a[8:11], v2 offset:2048
v_mfma_f32_16x16x32_bf16 v[120:123], a[116:119], a[52:55], v[120:123]
s_add_u32 m0, s76, 36864
ds_read_b128 a[12:15], v3 offset:2048
v_mfma_f32_16x16x32_bf16 v[120:123], a[112:115], a[48:51], v[120:123]
s_add_u32 s64, s73, 1920
ds_read_b128 a[16:19], v2 offset:4096
v_mfma_f32_16x16x32_bf16 v[104:107], a[112:115], a[40:43], v[104:107]
buffer_load_dwordx4 v12, s[48:51], s64 offen lds
v_mfma_f32_16x16x32_bf16 v[104:107], a[116:119], a[44:47], v[104:107]
ds_read_b128 a[20:23], v3 offset:4096
v_mfma_f32_16x16x32_bf16 v[88:91], a[116:119], a[36:39], v[88:91]
ds_read_b128 a[24:27], v2 offset:6144
v_mfma_f32_16x16x32_bf16 v[88:91], a[112:115], a[32:35], v[88:91]
s_waitcnt lgkmcnt(7)
s_add_u32 m0, s76, 37888
ds_read_b128 a[28:31], v3 offset:6144
v_mfma_f32_16x16x32_bf16 v[28:31], a[72:75], a[32:35], v[28:31]
s_add_u32 s64, s73, 18304
ds_read_b64_tr_b16 a[104:105], v10 offset:0
v_mfma_f32_16x16x32_bf16 v[28:31], a[76:79], a[36:39], v[28:31]
buffer_load_dwordx4 v13, s[48:51], s64 offen lds
v_mfma_f32_16x16x32_bf16 v[44:47], a[76:79], a[44:47], v[44:47]
ds_read_b64_tr_b16 a[106:107], v10 offset:1024
v_mfma_f32_16x16x32_bf16 v[44:47], a[72:75], a[40:43], v[44:47]
ds_read_b64_tr_b16 a[108:109], v10 offset:8192
v_mfma_f32_16x16x32_bf16 v[60:63], a[72:75], a[48:51], v[60:63]
s_add_u32 m0, s76, 38912
buffer_load_dword v1, off, s[52:55], s70 sc1
v_mfma_f32_16x16x32_bf16 v[60:63], a[76:79], a[52:55], v[60:63]
s_add_u32 s64, s73, 132992
ds_read_b64_tr_b16 a[110:111], v10 offset:9216
v_mfma_f32_16x16x32_bf16 v[76:79], a[76:79], a[60:63], v[76:79]
buffer_load_dwordx4 v12, s[48:51], s64 offen lds
v_mfma_f32_16x16x32_bf16 v[76:79], a[72:75], a[56:59], v[76:79]
ds_read_b64_tr_b16 a[112:113], v11 offset:0
v_mfma_f32_16x16x32_bf16 v[140:143], a[80:83], a[56:59], v[140:143]
ds_read_b64_tr_b16 a[114:115], v11 offset:1024
v_mfma_f32_16x16x32_bf16 v[140:143], a[84:87], a[60:63], v[140:143]
s_add_u32 m0, s76, 39936
ds_read_b64_tr_b16 a[116:117], v11 offset:8192
v_mfma_f32_16x16x32_bf16 v[124:127], a[84:87], a[52:55], v[124:127]
s_add_u32 s64, s73, 149376
ds_read_b64_tr_b16 a[118:119], v11 offset:9216
v_mfma_f32_16x16x32_bf16 v[124:127], a[80:83], a[48:51], v[124:127]
buffer_load_dwordx4 v13, s[48:51], s64 offen lds
v_mfma_f32_16x16x32_bf16 v[108:111], a[80:83], a[40:43], v[108:111]
v_mfma_f32_16x16x32_bf16 v[108:111], a[84:87], a[44:47], v[108:111]
v_mfma_f32_16x16x32_bf16 v[92:95], a[84:87], a[36:39], v[92:95]
buffer_load_dwordx2 a[64:65], v22, s[44:47], s86 offen offset:0 sc1
v_mfma_f32_16x16x32_bf16 v[92:95], a[80:83], a[32:35], v[92:95]
buffer_load_dwordx2 a[66:67], v22, s[44:47], s86 offen offset:512 sc1
v_mfma_f32_16x16x32_bf16 v[32:35], a[88:91], a[32:35], v[32:35]
buffer_load_dwordx2 a[68:69], v22, s[44:47], s87 offen offset:0 sc1
v_mfma_f32_16x16x32_bf16 v[32:35], a[92:95], a[36:39], v[32:35]
buffer_load_dwordx2 a[70:71], v22, s[44:47], s87 offen offset:512 sc1
v_mfma_f32_16x16x32_bf16 v[48:51], a[92:95], a[44:47], v[48:51]
s_waitcnt lgkmcnt(0)
s_barrier
v_mfma_f32_16x16x32_bf16 v[48:51], a[88:91], a[40:43], v[48:51]
ds_read_b64_tr_b16 a[72:73], v19 offset:36864
v_mfma_f32_16x16x32_bf16 v[64:67], a[88:91], a[48:51], v[64:67]
s_lshl2_add_u32 s72, s2, s30
ds_read_b64_tr_b16 a[74:75], v19 offset:37120
v_mfma_f32_16x16x32_bf16 v[64:67], a[92:95], a[52:55], v[64:67]
s_lshl_b32 s72, s72, 12
ds_read_b64_tr_b16 a[76:77], v19 offset:38912
v_mfma_f32_16x16x32_bf16 v[80:83], a[92:95], a[60:63], v[80:83]
s_add_u32 s72, s72, 67108864
ds_read_b64_tr_b16 a[78:79], v19 offset:39168
v_mfma_f32_16x16x32_bf16 v[80:83], a[88:91], a[56:59], v[80:83]
ds_read_b64_tr_b16 a[80:81], v20 offset:36864
v_mfma_f32_16x16x32_bf16 v[144:147], a[96:99], a[56:59], v[144:147]
ds_read_b64_tr_b16 a[82:83], v20 offset:37120
v_mfma_f32_16x16x32_bf16 v[144:147], a[100:103], a[60:63], v[144:147]
ds_read_b64_tr_b16 a[84:85], v20 offset:38912
v_mfma_f32_16x16x32_bf16 v[128:131], a[100:103], a[52:55], v[128:131]
ds_read_b64_tr_b16 a[86:87], v20 offset:39168
v_mfma_f32_16x16x32_bf16 v[128:131], a[96:99], a[48:51], v[128:131]
ds_read_b64_tr_b16 a[88:89], v19 offset:40960
v_mfma_f32_16x16x32_bf16 v[112:115], a[96:99], a[40:43], v[112:115]
ds_read_b64_tr_b16 a[90:91], v19 offset:41216
v_mfma_f32_16x16x32_bf16 v[112:115], a[100:103], a[44:47], v[112:115]
ds_read_b64_tr_b16 a[92:93], v19 offset:43008
v_mfma_f32_16x16x32_bf16 v[96:99], a[100:103], a[36:39], v[96:99]
ds_read_b64_tr_b16 a[94:95], v19 offset:43264
v_mfma_f32_16x16x32_bf16 v[96:99], a[96:99], a[32:35], v[96:99]
ds_read_b64_tr_b16 a[96:97], v20 offset:40960
v_mfma_f32_16x16x32_bf16 v[36:39], a[104:107], a[32:35], v[36:39]
buffer_store_dwordx4 a[240:243], v16, s[44:47], s72 offen offset:0 sc1
v_mfma_f32_16x16x32_bf16 v[36:39], a[108:111], a[36:39], v[36:39]
ds_read_b64_tr_b16 a[98:99], v20 offset:41216
v_mfma_f32_16x16x32_bf16 v[52:55], a[108:111], a[44:47], v[52:55]
ds_read_b64_tr_b16 a[100:101], v20 offset:43008
v_mfma_f32_16x16x32_bf16 v[52:55], a[104:107], a[40:43], v[52:55]
ds_read_b64_tr_b16 a[102:103], v20 offset:43264
v_mfma_f32_16x16x32_bf16 v[68:71], a[104:107], a[48:51], v[68:71]
v_mfma_f32_16x16x32_bf16 v[68:71], a[108:111], a[52:55], v[68:71]
v_mfma_f32_16x16x32_bf16 v[84:87], a[108:111], a[60:63], v[84:87]
v_mfma_f32_16x16x32_bf16 v[84:87], a[104:107], a[56:59], v[84:87]
ds_read_b64_tr_b16 a[104:105], v19 offset:32768
v_mfma_f32_16x16x32_bf16 v[148:151], a[112:115], a[56:59], v[148:151]
ds_read_b64_tr_b16 a[106:107], v19 offset:33024
v_mfma_f32_16x16x32_bf16 v[148:151], a[116:119], a[60:63], v[148:151]
ds_read_b64_tr_b16 a[108:109], v19 offset:34816
v_mfma_f32_16x16x32_bf16 v[132:135], a[116:119], a[52:55], v[132:135]
ds_read_b64_tr_b16 a[110:111], v19 offset:35072
v_mfma_f32_16x16x32_bf16 v[132:135], a[112:115], a[48:51], v[132:135]
v_mfma_f32_16x16x32_bf16 v[116:119], a[112:115], a[40:43], v[116:119]
v_mfma_f32_16x16x32_bf16 v[116:119], a[116:119], a[44:47], v[116:119]
v_mfma_f32_16x16x32_bf16 v[100:103], a[116:119], a[36:39], v[100:103]
buffer_store_dwordx4 a[240:243], v16, s[44:47], s72 offen offset:1024 sc1
v_mfma_f32_16x16x32_bf16 v[100:103], a[112:115], a[32:35], v[100:103]
s_waitcnt lgkmcnt(4)
ds_read_b64_tr_b16 a[112:113], v20 offset:32768
v_mfma_f32_16x16x32_bf16 v[184:187], a[72:75], a[0:3], v[184:187]
ds_read_b64_tr_b16 a[114:115], v20 offset:33024
v_and_b32 v12, 15, v0
v_mfma_f32_16x16x32_bf16 v[184:187], a[76:79], a[4:7], v[184:187]
ds_read_b64_tr_b16 a[116:117], v20 offset:34816
v_lshrrev_b32 v13, 4, v0
v_mfma_f32_16x16x32_bf16 v[192:195], a[76:79], a[12:15], v[192:195]
ds_read_b64_tr_b16 a[118:119], v20 offset:35072
v_lshlrev_b32 v13, 2, v13
v_mfma_f32_16x16x32_bf16 v[192:195], a[72:75], a[8:11], v[192:195]
v_sub_u32 v12, v12, v13
v_mfma_f32_16x16x32_bf16 v[200:203], a[72:75], a[16:19], v[200:203]
s_lshl_b32 s66, s30, 4
v_mfma_f32_16x16x32_bf16 v[200:203], a[76:79], a[20:23], v[200:203]
v_add_u32 v13, s66, v12
v_cmp_gt_i32 s[0:1], 0, v13
v_mfma_f32_16x16x32_bf16 v[208:211], a[76:79], a[28:31], v[208:211]
v_cmp_gt_i32 s[4:5], 1, v13
v_cmp_gt_i32 s[6:7], 2, v13
v_mfma_f32_16x16x32_bf16 v[208:211], a[72:75], a[24:27], v[208:211]
ds_read_b64_tr_b16 a[72:73], v4 offset:32768
v_cmp_gt_i32 s[8:9], 3, v13
v_mfma_f32_16x16x32_bf16 v[212:215], a[80:83], a[24:27], v[212:215]
ds_read_b64_tr_b16 a[74:75], v4 offset:33792
v_cmp_gt_i32 s[10:11], 16, v13
v_mfma_f32_16x16x32_bf16 v[212:215], a[84:87], a[28:31], v[212:215]
ds_read_b64_tr_b16 a[76:77], v4 offset:40960
v_cmp_gt_i32 s[12:13], 17, v13
v_mfma_f32_16x16x32_bf16 v[204:207], a[84:87], a[20:23], v[204:207]
ds_read_b64_tr_b16 a[78:79], v4 offset:41984
v_cmp_gt_i32 s[18:19], 18, v13
v_mfma_f32_16x16x32_bf16 v[204:207], a[80:83], a[16:19], v[204:207]
v_cmp_gt_i32 s[22:23], 19, v13
v_cmp_gt_i32 s[26:27], 32, v13
v_mfma_f32_16x16x32_bf16 v[196:199], a[80:83], a[8:11], v[196:199]
buffer_store_dwordx4 a[240:243], v16, s[44:47], s72 offen offset:2048 sc1
v_mfma_f32_16x16x32_bf16 v[196:199], a[84:87], a[12:15], v[196:199]
v_cmp_gt_i32 s[56:57], 33, v13
v_cmp_gt_i32 s[58:59], 34, v13
v_mfma_f32_16x16x32_bf16 v[188:191], a[84:87], a[4:7], v[188:191]
v_cmp_gt_i32 s[60:61], 35, v13
v_cmp_gt_i32 s[62:63], 48, v13
v_mfma_f32_16x16x32_bf16 v[188:191], a[80:83], a[0:3], v[188:191]
ds_read_b64_tr_b16 a[80:81], v5 offset:32768
v_cmp_gt_i32 s[48:49], 49, v13
v_mfma_f32_16x16x32_bf16 v[216:219], a[0:3], a[88:91], v[216:219]
ds_read_b64_tr_b16 a[82:83], v5 offset:33792
v_cmp_gt_i32 s[50:51], 50, v13
v_mfma_f32_16x16x32_bf16 v[216:219], a[4:7], a[92:95], v[216:219]
ds_read_b64_tr_b16 a[84:85], v5 offset:40960
v_cmp_gt_i32 s[100:101], 51, v13
v_mfma_f32_16x16x32_bf16 v[224:227], a[12:15], a[92:95], v[224:227]
ds_read_b64_tr_b16 a[86:87], v5 offset:41984
v_subrev_u32 v17, 0, v12
v_mfma_f32_16x16x32_bf16 v[224:227], a[8:11], a[88:91], v[224:227]
v_lshlrev_b32 v18, 31, v17
v_or_b32 v21, v17, v18
v_mfma_f32_16x16x32_bf16 v[232:235], a[16:19], a[88:91], v[232:235]
v_ashrrev_i32 v21, 31, v21
v_and_b32 v248, 0xff800000, v21
v_mfma_f32_16x16x32_bf16 v[232:235], a[20:23], a[92:95], v[232:235]
v_not_b32 v17, v17
v_or_b32 v21, v17, v18
v_mfma_f32_16x16x32_bf16 v[240:243], a[28:31], a[92:95], v[240:243]
v_ashrrev_i32 v21, 31, v21
v_and_b32 v252, 0xff800000, v21
v_mfma_f32_16x16x32_bf16 v[240:243], a[24:27], a[88:91], v[240:243]
ds_read_b64_tr_b16 a[88:89], v6 offset:32768
v_subrev_u32 v17, 1, v12
v_mfma_f32_16x16x32_bf16 v[244:247], a[24:27], a[96:99], v[244:247]
ds_read_b64_tr_b16 a[90:91], v6 offset:33792
v_lshlrev_b32 v18, 31, v17
v_mfma_f32_16x16x32_bf16 v[244:247], a[28:31], a[100:103], v[244:247]
ds_read_b64_tr_b16 a[92:93], v6 offset:40960
v_add_u32 v19, 0x8000, v19
v_mfma_f32_16x16x32_bf16 v[236:239], a[20:23], a[100:103], v[236:239]
buffer_store_dwordx4 a[240:243], v16, s[44:47], s72 offen offset:3072 sc1
v_mfma_f32_16x16x32_bf16 v[236:239], a[16:19], a[96:99], v[236:239]
ds_read_b64_tr_b16 a[94:95], v6 offset:41984
v_or_b32 v21, v17, v18
v_mfma_f32_16x16x32_bf16 v[228:231], a[8:11], a[96:99], v[228:231]
v_ashrrev_i32 v21, 31, v21
v_and_b32 v249, 0xff800000, v21
v_mfma_f32_16x16x32_bf16 v[228:231], a[12:15], a[100:103], v[228:231]
v_not_b32 v17, v17
v_or_b32 v21, v17, v18
v_mfma_f32_16x16x32_bf16 v[220:223], a[4:7], a[100:103], v[220:223]
v_ashrrev_i32 v21, 31, v21
v_and_b32 v253, 0xff800000, v21
v_mfma_f32_16x16x32_bf16 v[220:223], a[0:3], a[96:99], v[220:223]
s_waitcnt lgkmcnt(4)
ds_read_b64_tr_b16 a[96:97], v7 offset:32768
v_subrev_u32 v17, 2, v12
v_mfma_f32_16x16x32_bf16 v[152:155], a[104:107], a[0:3], v[152:155]
ds_read_b64_tr_b16 a[98:99], v7 offset:33792
v_lshlrev_b32 v18, 31, v17
v_mfma_f32_16x16x32_bf16 v[152:155], a[108:111], a[4:7], v[152:155]
ds_read_b64_tr_b16 a[100:101], v7 offset:40960
v_add_u32 v20, 0x8000, v20
v_mfma_f32_16x16x32_bf16 v[160:163], a[108:111], a[12:15], v[160:163]
ds_read_b64_tr_b16 a[102:103], v7 offset:41984
v_or_b32 v21, v17, v18
v_mfma_f32_16x16x32_bf16 v[160:163], a[104:107], a[8:11], v[160:163]
v_ashrrev_i32 v21, 31, v21
v_and_b32 v250, 0xff800000, v21
v_mfma_f32_16x16x32_bf16 v[168:171], a[104:107], a[16:19], v[168:171]
v_not_b32 v17, v17
v_or_b32 v21, v17, v18
v_mfma_f32_16x16x32_bf16 v[168:171], a[108:111], a[20:23], v[168:171]
v_ashrrev_i32 v21, 31, v21
v_and_b32 v254, 0xff800000, v21
v_mfma_f32_16x16x32_bf16 v[176:179], a[108:111], a[28:31], v[176:179]
v_subrev_u32 v17, 3, v12
v_lshlrev_b32 v18, 31, v17
v_mfma_f32_16x16x32_bf16 v[176:179], a[104:107], a[24:27], v[176:179]
ds_read_b64_tr_b16 a[104:105], v8 offset:32768
v_or_b32 v21, v17, v18
v_mfma_f32_16x16x32_bf16 v[180:183], a[112:115], a[24:27], v[180:183]
ds_read_b64_tr_b16 a[106:107], v8 offset:33792
v_ashrrev_i32 v21, 31, v21
v_mfma_f32_16x16x32_bf16 v[180:183], a[116:119], a[28:31], v[180:183]
ds_read_b64_tr_b16 a[108:109], v8 offset:40960
v_add_u32 v4, 0x8000, v4
v_mfma_f32_16x16x32_bf16 v[172:175], a[116:119], a[20:23], v[172:175]
ds_read_b64_tr_b16 a[110:111], v8 offset:41984
v_and_b32 v251, 0xff800000, v21
v_mfma_f32_16x16x32_bf16 v[172:175], a[112:115], a[16:19], v[172:175]
v_not_b32 v17, v17
v_or_b32 v21, v17, v18
v_mfma_f32_16x16x32_bf16 v[164:167], a[112:115], a[8:11], v[164:167]
s_add_u32 s17, s78, .-L_pc+6144
v_ashrrev_i32 v21, 31, v21
v_and_b32 v255, 0xff800000, v21
v_mfma_f32_16x16x32_bf16 v[164:167], a[116:119], a[12:15], v[164:167]
s_and_b32 s66, s2, 7
s_lshr_b32 s67, s2, 3
s_and_b32 s83, s66, 1
v_mfma_f32_16x16x32_bf16 v[156:159], a[116:119], a[4:7], v[156:159]
s_and_b32 s68, s66, 2
s_and_b32 s69, s67, 7
s_lshl2_add_u32 s82, s68, s69
v_mfma_f32_16x16x32_bf16 v[156:159], a[112:115], a[0:3], v[156:159]
s_and_b32 s68, s66, 4
s_lshr_b32 s69, s67, 3
ds_read_b64_tr_b16 a[112:113], v9 offset:32768
v_mfma_f32_16x16x32_bf16 v[24:27], a[72:75], a[0:3], v[24:27]
s_xor_b32 s69, s69, 0
s_add_u32 s87, s68, s69
ds_read_b64_tr_b16 a[114:115], v9 offset:33792
v_mfma_f32_16x16x32_bf16 v[24:27], a[76:79], a[4:7], v[24:27]
s_lshl_b32 s87, s87, 8
ds_read_b64_tr_b16 a[116:117], v9 offset:40960
v_add_u32 v5, 0x8000, v5
v_mfma_f32_16x16x32_bf16 v[40:43], a[76:79], a[12:15], v[40:43]
s_lshl_b32 s86, s30, 13
buffer_load_dword a252, v16, s[88:91], s17 offen
v_mfma_f32_16x16x32_bf16 v[40:43], a[72:75], a[8:11], v[40:43]
s_lshl_b32 s85, s30, 16
s_add_u32 s85, s85, s87
ds_read_b64_tr_b16 a[118:119], v9 offset:41984
v_mfma_f32_16x16x32_bf16 v[56:59], a[72:75], a[16:19], v[56:59]
s_mul_i32 s66, s83, 1310720
s_add_u32 s85, s85, s66
s_mul_i32 s84, s82, 1310720
v_mfma_f32_16x16x32_bf16 v[56:59], a[76:79], a[20:23], v[56:59]
s_and_b32 s66, s30, 1
s_lshl_b32 s66, s66, 14
s_add_u32 s84, s84, s66
v_mfma_f32_16x16x32_bf16 v[72:75], a[76:79], a[28:31], v[72:75]
s_waitcnt vmcnt(9)
s_mul_i32 s66, s83, 163840
ds_read_b128 a[32:35], v2 offset:32768
v_mfma_f32_16x16x32_bf16 v[72:75], a[72:75], a[24:27], v[72:75]
s_add_u32 s84, s84, s66
s_add_u32 s84, s84, 34603008
s_add_u32 s17, s78, .-L_pc+9984
ds_read_b128 a[36:39], v3 offset:32768
v_mfma_f32_16x16x32_bf16 v[136:139], a[80:83], a[24:27], v[136:139]
s_sub_u32 s66, 15, s82
buffer_load_dword a252, v16, s[88:91], s17 offen
v_mfma_f32_16x16x32_bf16 v[136:139], a[84:87], a[28:31], v[136:139]
s_min_u32 s66, s66, s82
ds_read_b128 a[40:43], v2 offset:34816
v_add_u32 v6, 0x8000, v6
v_mfma_f32_16x16x32_bf16 v[120:123], a[84:87], a[20:23], v[120:123]
s_lshl1_add_u32 s66, s66, s83
s_lshl_b32 s80, s66, 8
ds_read_b128 a[44:47], v3 offset:34816
v_mfma_f32_16x16x32_bf16 v[120:123], a[80:83], a[16:19], v[120:123]
s_add_u32 s80, s80, 8192
s_and_b32 s67, s30, 1
ds_read_b128 a[48:51], v2 offset:36864
v_mfma_f32_16x16x32_bf16 v[104:107], a[80:83], a[8:11], v[104:107]
s_lshl_b32 s67, s67, 7
s_add_u32 s67, s67, s83
ds_read_b128 a[52:55], v3 offset:36864
v_mfma_f32_16x16x32_bf16 v[104:107], a[84:87], a[12:15], v[104:107]
s_lshl_b32 s67, s67, 7
s_add_u32 s67, s67, 98304
ds_read_b128 a[56:59], v2 offset:38912
v_mfma_f32_16x16x32_bf16 v[88:91], a[84:87], a[4:7], v[88:91]
s_lshl_b32 s66, s30, 11
ds_read_b128 a[60:63], v3 offset:38912
v_lshrrev_b32 v14, 4, v0
v_mfma_f32_16x16x32_bf16 v[88:91], a[80:83], a[0:3], v[88:91]
s_waitcnt lgkmcnt(8)
ds_read_b64_tr_b16 a[72:73], v10 offset:32768
v_bfe_u32 v12, v0, 1, 3
v_mfma_f32_16x16x32_bf16 v[28:31], a[88:91], a[0:3], v[28:31]
ds_read_b64_tr_b16 a[74:75], v10 offset:33792
v_xor_b32 v12, v12, v14
v_mfma_f32_16x16x32_bf16 v[28:31], a[92:95], a[4:7], v[28:31]
ds_read_b64_tr_b16 a[76:77], v10 offset:40960
v_add_u32 v7, 0x8000, v7
v_mfma_f32_16x16x32_bf16 v[44:47], a[92:95], a[12:15], v[44:47]
ds_read_b64_tr_b16 a[78:79], v10 offset:41984
v_lshlrev_b32 v12, 5, v12
v_mfma_f32_16x16x32_bf16 v[44:47], a[88:91], a[8:11], v[44:47]
ds_read_b64_tr_b16 a[80:81], v11 offset:32768
v_lshl_add_u32 v12, v14, 11, v12
v_mfma_f32_16x16x32_bf16 v[60:63], a[88:91], a[16:19], v[60:63]
ds_read_b64_tr_b16 a[82:83], v11 offset:33792
v_and_b32 v14, 1, v0
v_mfma_f32_16x16x32_bf16 v[60:63], a[92:95], a[20:23], v[60:63]
ds_read_b64_tr_b16 a[84:85], v11 offset:40960
v_lshl_add_u32 v12, v14, 4, v12
v_mfma_f32_16x16x32_bf16 v[76:79], a[92:95], a[28:31], v[76:79]
s_add_u32 s17, s78, .-L_pc+13824
ds_read_b64_tr_b16 a[86:87], v11 offset:41984
v_xor_b32 v13, 128, v12
v_mfma_f32_16x16x32_bf16 v[76:79], a[88:91], a[24:27], v[76:79]
buffer_load_dword a252, v16, s[88:91], s17 offen
v_mfma_f32_16x16x32_bf16 v[140:143], a[96:99], a[24:27], v[140:143]
v_readfirstlane_b32 vcc_lo, v1
s_nop 0
s_cmp_lt_u32 vcc_lo, s81
s_cbranch_scc1 L_spin_4
L_spinbk_5:
v_mfma_f32_16x16x32_bf16 v[140:143], a[100:103], a[28:31], v[140:143]
s_add_u32 s17, s78, L_F1-L_pc
v_add_u32 v8, 0x8000, v8
v_lshrrev_b32 v14, 4, v0
v_mfma_f32_16x16x32_bf16 v[124:127], a[100:103], a[20:23], v[124:127]
buffer_load_dword a252, v16, s[88:91], s17 offen
v_mfma_f32_16x16x32_bf16 v[124:127], a[96:99], a[16:19], v[124:127]
v_bfe_u32 v18, v0, 2, 2
v_lshl_add_u32 v14, v14, 2, v18
v_mfma_f32_16x16x32_bf16 v[108:111], a[96:99], a[8:11], v[108:111]
s_add_u32 s17, s78, L_F1-L_pc+4096
v_and_b32 v18, 3, v0
v_lshlrev_b32 v18, 3, v18
v_mfma_f32_16x16x32_bf16 v[108:111], a[100:103], a[12:15], v[108:111]
buffer_load_dword a252, v16, s[88:91], s17 offen
v_mfma_f32_16x16x32_bf16 v[92:95], a[100:103], a[4:7], v[92:95]
v_add_u32 v9, 0x8000, v9
v_add_u32 v10, 0x8000, v10
v_mfma_f32_16x16x32_bf16 v[92:95], a[96:99], a[0:3], v[92:95]
v_add_u32 v11, 0x8000, v11
v_lshl_add_u32 v18, v14, 8, v18
v_mfma_f32_16x16x32_bf16 v[32:35], a[104:107], a[0:3], v[32:35]
v_and_b32 v14, 7, v14
v_lshl_add_u32 v18, v14, 5, v18
v_mfma_f32_16x16x32_bf16 v[32:35], a[108:111], a[4:7], v[32:35]
v_xor_b32 v18, s67, v18
v_add_u32 v14, s66, v16
v_mfma_f32_16x16x32_bf16 v[48:51], a[108:111], a[12:15], v[48:51]
s_waitcnt lgkmcnt(0)
s_barrier
v_mfma_f32_16x16x32_bf16 v[48:51], a[104:107], a[8:11], v[48:51]
ds_read_b64_tr_b16 a[88:89], v19 offset:36864
v_xor_b32 v15, 0x800, v14
v_mfma_f32_16x16x32_bf16 v[64:67], a[104:107], a[16:19], v[64:67]
s_lshr_b32 s66, s30, 1
s_lshl_b32 s66, s66, 16
ds_read_b64_tr_b16 a[90:91], v19 offset:37120
v_mfma_f32_16x16x32_bf16 v[64:67], a[108:111], a[20:23], v[64:67]
s_and_b32 s67, s30, 1
s_lshl_b32 s67, s67, 10
s_mov_b32 m0, s76
ds_read_b64_tr_b16 a[92:93], v19 offset:38912
v_mfma_f32_16x16x32_bf16 v[80:83], a[108:111], a[28:31], v[80:83]
s_add_u32 s66, s66, s67
s_add_u32 s66, s66, 32768
s_lshl_b32 s64, s30, 14
ds_read_b64_tr_b16 a[94:95], v19 offset:39168
v_mfma_f32_16x16x32_bf16 v[80:83], a[104:107], a[24:27], v[80:83]
buffer_load_dwordx4 v16, s[32:35], s64 offen offset:0 sc1 lds
v_mfma_f32_16x16x32_bf16 v[144:147], a[112:115], a[24:27], v[144:147]
ds_read_b64_tr_b16 a[96:97], v20 offset:36864
v_add_u32 v17, s66, v16
v_mfma_f32_16x16x32_bf16 v[144:147], a[116:119], a[28:31], v[144:147]
ds_read_b64_tr_b16 a[98:99], v20 offset:37120
v_lshlrev_b32 v21, 5, v0
v_mfma_f32_16x16x32_bf16 v[128:131], a[116:119], a[20:23], v[128:131]
s_lshl2_add_u32 s73, s2, s30
s_lshl_b32 s73, s73, 11
s_lshl_b32 s66, s30, 11
v_mfma_f32_16x16x32_bf16 v[128:131], a[112:115], a[16:19], v[128:131]
s_add_u32 s66, s66, 32768
buffer_load_dwordx4 v16, s[32:35], s64 offen offset:1024 sc1 lds
v_mfma_f32_16x16x32_bf16 v[112:115], a[112:115], a[8:11], v[112:115]
ds_read_b64_tr_b16 a[100:101], v20 offset:38912
v_add_u32 v2, s66, v16
v_mfma_f32_16x16x32_bf16 v[112:115], a[116:119], a[12:15], v[112:115]
ds_read_b64_tr_b16 a[102:103], v20 offset:39168
v_add_u32 v3, 0x10000, v2
v_mfma_f32_16x16x32_bf16 v[96:99], a[116:119], a[4:7], v[96:99]
ds_read_b64_tr_b16 a[104:105], v19 offset:40960
v_mfma_f32_16x16x32_bf16 v[96:99], a[112:115], a[0:3], v[96:99]
buffer_load_dwordx4 v16, s[32:35], s64 offen offset:2048 sc1 lds
v_mfma_f32_16x16x32_bf16 v[36:39], a[72:75], a[0:3], v[36:39]
ds_read_b64_tr_b16 a[106:107], v19 offset:41216
v_mfma_f32_16x16x32_bf16 v[36:39], a[76:79], a[4:7], v[36:39]
ds_read_b64_tr_b16 a[108:109], v19 offset:43008
v_mfma_f32_16x16x32_bf16 v[52:55], a[76:79], a[12:15], v[52:55]
ds_read_b64_tr_b16 a[110:111], v19 offset:43264
v_mfma_f32_16x16x32_bf16 v[52:55], a[72:75], a[8:11], v[52:55]
buffer_load_dwordx4 v16, s[32:35], s64 offen offset:3072 sc1 lds
v_mfma_f32_16x16x32_bf16 v[68:71], a[72:75], a[16:19], v[68:71]
ds_read_b64_tr_b16 a[112:113], v20 offset:40960
v_mfma_f32_16x16x32_bf16 v[68:71], a[76:79], a[20:23], v[68:71]
s_add_u32 m0, s76, 4096
ds_read_b64_tr_b16 a[114:115], v20 offset:41216
v_mfma_f32_16x16x32_bf16 v[84:87], a[76:79], a[28:31], v[84:87]
s_add_u32 s64, s64, 4096
ds_read_b64_tr_b16 a[116:117], v20 offset:43008
v_mfma_f32_16x16x32_bf16 v[84:87], a[72:75], a[24:27], v[84:87]
buffer_load_dwordx4 v16, s[32:35], s64 offen offset:0 sc1 lds
v_mfma_f32_16x16x32_bf16 v[148:151], a[80:83], a[24:27], v[148:151]
ds_read_b64_tr_b16 a[118:119], v20 offset:43264
v_mfma_f32_16x16x32_bf16 v[148:151], a[84:87], a[28:31], v[148:151]
ds_read_b64_tr_b16 a[72:73], v19 offset:32768
v_mfma_f32_16x16x32_bf16 v[132:135], a[84:87], a[20:23], v[132:135]
ds_read_b64_tr_b16 a[74:75], v19 offset:33024
v_mfma_f32_16x16x32_bf16 v[132:135], a[80:83], a[16:19], v[132:135]
buffer_load_dwordx4 v16, s[32:35], s64 offen offset:1024 sc1 lds
v_mfma_f32_16x16x32_bf16 v[116:119], a[80:83], a[8:11], v[116:119]
ds_read_b64_tr_b16 a[76:77], v19 offset:34816
v_mfma_f32_16x16x32_bf16 v[116:119], a[84:87], a[12:15], v[116:119]
ds_read_b64_tr_b16 a[78:79], v19 offset:35072
v_mfma_f32_16x16x32_bf16 v[100:103], a[84:87], a[4:7], v[100:103]
v_mfma_f32_16x16x32_bf16 v[100:103], a[80:83], a[0:3], v[100:103]
s_waitcnt lgkmcnt(6)
buffer_load_dwordx4 v16, s[32:35], s64 offen offset:2048 sc1 lds
v_mfma_f32_16x16x32_bf16 v[184:187], a[88:91], a[32:35], v[184:187]
ds_read_b64_tr_b16 a[80:81], v20 offset:32768
v_mfma_f32_16x16x32_bf16 v[184:187], a[92:95], a[36:39], v[184:187]
ds_read_b64_tr_b16 a[82:83], v20 offset:33024
v_mfma_f32_16x16x32_bf16 v[192:195], a[92:95], a[44:47], v[192:195]
ds_read_b64_tr_b16 a[84:85], v20 offset:34816
v_mfma_f32_16x16x32_bf16 v[192:195], a[88:91], a[40:43], v[192:195]
buffer_load_dwordx4 v16, s[32:35], s64 offen offset:3072 sc1 lds
v_mfma_f32_16x16x32_bf16 v[200:203], a[88:91], a[48:51], v[200:203]
ds_read_b64_tr_b16 a[86:87], v20 offset:35072
v_mfma_f32_16x16x32_bf16 v[200:203], a[92:95], a[52:55], v[200:203]
s_or_b32 s66, s3, s30
s_cmp_eq_u32 s66, 0
s_cselect_b32 s66, 0xff800000, 0
v_mfma_f32_16x16x32_bf16 v[208:211], a[92:95], a[60:63], v[208:211]
s_and_b32 s67, s74, 0x7800
s_cselect_b32 s67, 0, 0x70000000
s_add_u32 s77, s74, s67
s_lshr_b32 s64, s76, 1
s_add_u32 m0, s64, 81920
s_and_b32 s71, s64, 8192
s_add_u32 s64, s64, s71
s_add_u32 s64, s64, 8192
v_mfma_f32_16x16x32_bf16 v[208:211], a[88:91], a[56:59], v[208:211]
s_sub_u32 s77, s77, 2048
buffer_load_dwordx4 v16, s[32:35], s64 offen offset:0 sc1 lds
v_mfma_f32_16x16x32_bf16 v[212:215], a[96:99], a[56:59], v[212:215]
s_mov_b32 s68, 0x3e0293ee
ds_read_b64_tr_b16 a[88:89], v4 offset:32768
v_mfma_f32_16x16x32_bf16 v[212:215], a[100:103], a[60:63], v[212:215]
s_mov_b32 s69, s68
ds_read_b64_tr_b16 a[90:91], v4 offset:33792
v_mfma_f32_16x16x32_bf16 v[204:207], a[100:103], a[52:55], v[204:207]
ds_read_b64_tr_b16 a[92:93], v4 offset:40960
v_mfma_f32_16x16x32_bf16 v[204:207], a[96:99], a[48:51], v[204:207]
buffer_load_dwordx4 v16, s[32:35], s64 offen offset:1024 sc1 lds
v_mfma_f32_16x16x32_bf16 v[196:199], a[96:99], a[40:43], v[196:199]
ds_read_b64_tr_b16 a[94:95], v4 offset:41984
v_mfma_f32_16x16x32_bf16 v[196:199], a[100:103], a[44:47], v[196:199]
v_mfma_f32_16x16x32_bf16 v[188:191], a[100:103], a[36:39], v[188:191]
v_mfma_f32_16x16x32_bf16 v[188:191], a[96:99], a[32:35], v[188:191]
buffer_load_dwordx4 v16, s[32:35], s64 offen offset:2048 sc1 lds
v_mfma_f32_16x16x32_bf16 v[216:219], a[32:35], a[104:107], v[216:219]
ds_read_b64_tr_b16 a[96:97], v5 offset:32768
v_mfma_f32_16x16x32_bf16 v[216:219], a[36:39], a[108:111], v[216:219]
ds_read_b64_tr_b16 a[98:99], v5 offset:33792
v_cvt_pk_bf16_f32 v208, v208, v209
v_mfma_f32_16x16x32_bf16 v[224:227], a[44:47], a[108:111], v[224:227]
ds_read_b64_tr_b16 a[100:101], v5 offset:40960
v_cvt_pk_bf16_f32 v209, v210, v211
v_mfma_f32_16x16x32_bf16 v[224:227], a[40:43], a[104:107], v[224:227]
buffer_load_dwordx4 v16, s[32:35], s64 offen offset:3072 sc1 lds
v_mfma_f32_16x16x32_bf16 v[232:235], a[48:51], a[104:107], v[232:235]
ds_read_b64_tr_b16 a[102:103], v5 offset:41984
v_cvt_pk_bf16_f32 v210, v212, v213
v_mfma_f32_16x16x32_bf16 v[232:235], a[52:55], a[108:111], v[232:235]
v_cvt_pk_bf16_f32 v211, v214, v215
v_mfma_f32_16x16x32_bf16 v[240:243], a[60:63], a[108:111], v[240:243]
ds_write_b128 v3, v[208:211] offset:10240
v_mfma_f32_16x16x32_bf16 v[240:243], a[56:59], a[104:107], v[240:243]
ds_read_b64_tr_b16 a[104:105], v6 offset:32768
v_cvt_pk_bf16_f32 v200, v200, v201
v_mfma_f32_16x16x32_bf16 v[244:247], a[56:59], a[112:115], v[244:247]
s_waitcnt lgkmcnt(6)
ds_read_b64_tr_b16 a[106:107], v6 offset:33792
v_cvt_pk_bf16_f32 v201, v202, v203
v_mfma_f32_16x16x32_bf16 v[244:247], a[60:63], a[116:119], v[244:247]
ds_read_b64_tr_b16 a[108:109], v6 offset:40960
v_cvt_pk_bf16_f32 v202, v204, v205
v_mfma_f32_16x16x32_bf16 v[236:239], a[52:55], a[116:119], v[236:239]
ds_read_b64_tr_b16 a[110:111], v6 offset:41984
v_cvt_pk_bf16_f32 v203, v206, v207
v_mfma_f32_16x16x32_bf16 v[236:239], a[48:51], a[112:115], v[236:239]
ds_write_b128 v3, v[200:203] offset:2048
v_mfma_f32_16x16x32_bf16 v[228:231], a[40:43], a[112:115], v[228:231]
v_cvt_pk_bf16_f32 v192, v192, v193
v_cvt_pk_bf16_f32 v193, v194, v195
v_mfma_f32_16x16x32_bf16 v[228:231], a[44:47], a[116:119], v[228:231]
v_cvt_pk_bf16_f32 v194, v196, v197
v_cvt_pk_bf16_f32 v195, v198, v199
v_mfma_f32_16x16x32_bf16 v[220:223], a[36:39], a[116:119], v[220:223]
ds_write_b128 v2, v[192:195] offset:10240
v_mfma_f32_16x16x32_bf16 v[220:223], a[32:35], a[112:115], v[220:223]
ds_read_b64_tr_b16 a[112:113], v7 offset:32768
v_cvt_pk_bf16_f32 v184, v184, v185
v_mfma_f32_16x16x32_bf16 v[152:155], a[72:75], a[32:35], v[152:155]
ds_read_b64_tr_b16 a[114:115], v7 offset:33792
v_cvt_pk_bf16_f32 v185, v186, v187
v_mfma_f32_16x16x32_bf16 v[152:155], a[76:79], a[36:39], v[152:155]
ds_read_b64_tr_b16 a[116:117], v7 offset:40960
v_cvt_pk_bf16_f32 v186, v188, v189
v_mfma_f32_16x16x32_bf16 v[160:163], a[76:79], a[44:47], v[160:163]
ds_read_b64_tr_b16 a[118:119], v7 offset:41984
v_cvt_pk_bf16_f32 v187, v190, v191
v_mfma_f32_16x16x32_bf16 v[160:163], a[72:75], a[40:43], v[160:163]
ds_write_b128 v2, v[184:187] offset:2048
v_mfma_f32_16x16x32_bf16 v[168:171], a[72:75], a[48:51], v[168:171]
v_cvt_pk_bf16_f32 v219, v218, v219
v_cvt_pk_bf16_f32 v218, v216, v217
v_mfma_f32_16x16x32_bf16 v[168:171], a[76:79], a[52:55], v[168:171]
ds_write_b64 v2, v[218:219] offset:3072
v_mfma_f32_16x16x32_bf16 v[176:179], a[76:79], a[60:63], v[176:179]
buffer_load_dword a252, v21, s[36:39], s73 offen
v_mfma_f32_16x16x32_bf16 v[176:179], a[72:75], a[56:59], v[176:179]
ds_read_b64_tr_b16 a[72:73], v8 offset:32768
v_cvt_pk_bf16_f32 v227, v226, v227
v_mfma_f32_16x16x32_bf16 v[180:183], a[80:83], a[56:59], v[180:183]
ds_read_b64_tr_b16 a[74:75], v8 offset:33792
v_cvt_pk_bf16_f32 v226, v224, v225
v_mfma_f32_16x16x32_bf16 v[180:183], a[84:87], a[60:63], v[180:183]
ds_write_b64 v2, v[226:227] offset:11264
v_mfma_f32_16x16x32_bf16 v[172:175], a[84:87], a[52:55], v[172:175]
ds_read_b64_tr_b16 a[76:77], v8 offset:40960
v_cvt_pk_bf16_f32 v235, v234, v235
v_mfma_f32_16x16x32_bf16 v[172:175], a[80:83], a[48:51], v[172:175]
ds_read_b64_tr_b16 a[78:79], v8 offset:41984
v_cvt_pk_bf16_f32 v234, v232, v233
v_mfma_f32_16x16x32_bf16 v[164:167], a[80:83], a[40:43], v[164:167]
ds_write_b64 v3, v[234:235] offset:3072
v_mfma_f32_16x16x32_bf16 v[164:167], a[84:87], a[44:47], v[164:167]
v_cvt_pk_bf16_f32 v243, v242, v243
v_cvt_pk_bf16_f32 v242, v240, v241
v_mfma_f32_16x16x32_bf16 v[156:159], a[84:87], a[36:39], v[156:159]
ds_write_b64 v3, v[242:243] offset:11264
v_mfma_f32_16x16x32_bf16 v[156:159], a[80:83], a[32:35], v[156:159]
ds_read_b64_tr_b16 a[80:81], v9 offset:32768
v_cvt_pk_bf16_f32 v247, v246, v247
v_mfma_f32_16x16x32_bf16 v[24:27], a[88:91], a[32:35], v[24:27]
ds_read_b64_tr_b16 a[82:83], v9 offset:33792
v_cvt_pk_bf16_f32 v246, v244, v245
v_mfma_f32_16x16x32_bf16 v[24:27], a[92:95], a[36:39], v[24:27]
ds_write_b64 v3, v[246:247] offset:11272
v_mfma_f32_16x16x32_bf16 v[40:43], a[92:95], a[44:47], v[40:43]
ds_read_b64_tr_b16 a[84:85], v9 offset:40960
v_cvt_pk_bf16_f32 v239, v238, v239
v_cvt_pk_bf16_f32 v238, v236, v237
v_mfma_f32_16x16x32_bf16 v[40:43], a[88:91], a[40:43], v[40:43]
ds_write_b64 v3, v[238:239] offset:3080
v_mfma_f32_16x16x32_bf16 v[56:59], a[88:91], a[48:51], v[56:59]
ds_read_b64_tr_b16 a[86:87], v9 offset:41984
v_cvt_pk_bf16_f32 v231, v230, v231
v_cvt_pk_bf16_f32 v230, v228, v229
v_mfma_f32_16x16x32_bf16 v[56:59], a[92:95], a[52:55], v[56:59]
ds_write_b64 v2, v[230:231] offset:11272
v_mfma_f32_16x16x32_bf16 v[72:75], a[92:95], a[60:63], v[72:75]
v_cvt_pk_bf16_f32 v223, v222, v223
v_cvt_pk_bf16_f32 v222, v220, v221
v_mfma_f32_16x16x32_bf16 v[72:75], a[88:91], a[56:59], v[72:75]
s_waitcnt lgkmcnt(8)
ds_write_b64 v2, v[222:223] offset:3080
v_mfma_f32_16x16x32_bf16 v[136:139], a[96:99], a[56:59], v[136:139]
ds_read_b64_tr_b16 a[88:89], v10 offset:32768
v_cvt_pk_bf16_f32 v176, v176, v177
v_mfma_f32_16x16x32_bf16 v[136:139], a[100:103], a[60:63], v[136:139]
s_waitcnt lgkmcnt(0)
s_barrier
v_mfma_f32_16x16x32_bf16 v[120:123], a[100:103], a[52:55], v[120:123]
ds_read_b128 a[16:19], v17 offset:16384
v_cvt_pk_bf16_f32 v177, v178, v179
v_mfma_f32_16x16x32_bf16 v[120:123], a[96:99], a[48:51], v[120:123]
ds_read_b64_tr_b16 a[90:91], v10 offset:33792
v_cvt_pk_bf16_f32 v178, v180, v181
v_mfma_f32_16x16x32_bf16 v[104:107], a[96:99], a[40:43], v[104:107]
ds_read_b64_tr_b16 a[92:93], v10 offset:40960
v_cvt_pk_bf16_f32 v179, v182, v183
v_mfma_f32_16x16x32_bf16 v[104:107], a[100:103], a[44:47], v[104:107]
ds_read_b64_tr_b16 a[94:95], v10 offset:41984
v_cvt_pk_bf16_f32 v168, v168, v169
v_mfma_f32_16x16x32_bf16 v[88:91], a[100:103], a[36:39], v[88:91]
v_cvt_pk_bf16_f32 v169, v170, v171
v_cvt_pk_bf16_f32 v170, v172, v173
v_mfma_f32_16x16x32_bf16 v[88:91], a[96:99], a[32:35], v[88:91]
ds_read_b64_tr_b16 a[96:97], v11 offset:32768
v_cvt_pk_bf16_f32 v171, v174, v175
v_mfma_f32_16x16x32_bf16 v[28:31], a[104:107], a[32:35], v[28:31]
s_waitcnt lgkmcnt(4)
buffer_store_dwordx4 a[16:19], v16, s[44:47], s74 offen sc1
v_mfma_f32_16x16x32_bf16 v[28:31], a[108:111], a[36:39], v[28:31]
ds_read_b64_tr_b16 a[98:99], v11 offset:33792
v_cvt_pk_bf16_f32 v160, v160, v161
v_mfma_f32_16x16x32_bf16 v[44:47], a[108:111], a[44:47], v[44:47]
ds_read_b64_tr_b16 a[100:101], v11 offset:40960
v_cvt_pk_bf16_f32 v161, v162, v163
v_mfma_f32_16x16x32_bf16 v[44:47], a[104:107], a[40:43], v[44:47]
s_sub_u32 s81, s3, 1
ds_read_b64_tr_b16 a[102:103], v11 offset:41984
v_cvt_pk_bf16_f32 v162, v164, v165
v_mfma_f32_16x16x32_bf16 v[60:63], a[104:107], a[48:51], v[60:63]
s_sub_u32 s67, s3, 2
ds_read_b128 a[4:7], v2 offset:8192
v_cvt_pk_bf16_f32 v163, v166, v167
v_mfma_f32_16x16x32_bf16 v[60:63], a[108:111], a[52:55], v[60:63]
s_mul_i32 s81, s81, s67
ds_read_b128 a[12:15], v3 offset:8192
v_cvt_pk_bf16_f32 v152, v152, v153
v_mfma_f32_16x16x32_bf16 v[76:79], a[108:111], a[60:63], v[76:79]
s_lshl4_add_u32 s81, s81, s31
ds_read_b64 v[224:225], v2 offset:9216
v_cvt_pk_bf16_f32 v153, v154, v155
v_mfma_f32_16x16x32_bf16 v[76:79], a[104:107], a[56:59], v[76:79]
s_lshl2_add_u32 s81, s81, s30
ds_read_b64 v[228:229], v2 offset:9224
v_cvt_pk_bf16_f32 v154, v156, v157
v_mfma_f32_16x16x32_bf16 v[140:143], a[112:115], a[56:59], v[140:143]
s_mul_i32 s81, s81, 3328
ds_read_b64 v[240:241], v3 offset:9216
v_cvt_pk_bf16_f32 v155, v158, v159
v_mfma_f32_16x16x32_bf16 v[140:143], a[116:119], a[60:63], v[140:143]
s_mov_b32 s73, 0
ds_read_b64 v[244:245], v3 offset:9224
v_or_b32 v20, s66, v252
v_mfma_f32_16x16x32_bf16 v[124:127], a[116:119], a[52:55], v[124:127]
s_mov_b32 s72, 0x20000
v_or_b32 v21, s66, v253
v_or_b32 v22, s66, v254
v_mfma_f32_16x16x32_bf16 v[124:127], a[112:115], a[48:51], v[124:127]
s_lshl_b32 s67, s31, 15
v_or_b32 v23, s66, v255
v_mfma_f32_16x16x32_bf16 v[108:111], a[112:115], a[40:43], v[108:111]
s_add_u32 s67, s67, s78
s_mov_b32 s66, 0x3e8293ee
v_mul_f32 v72, s68, v72
v_mfma_f32_16x16x32_bf16 v[108:111], a[116:119], a[44:47], v[108:111]
s_add_u32 s67, s67, 33554432
v_mul_f32 v73, s68, v73
v_mul_f32 v74, s68, v74
v_mfma_f32_16x16x32_bf16 v[92:95], a[116:119], a[36:39], v[92:95]
s_mul_i32 s74, s3, 1310720
v_mul_f32 v75, s68, v75
v_mul_f32 v136, s68, v136
v_mfma_f32_16x16x32_bf16 v[92:95], a[112:115], a[32:35], v[92:95]
s_add_u32 s74, s74, s67
v_mul_f32 v137, s68, v137
v_mul_f32 v138, s68, v138
v_mfma_f32_16x16x32_bf16 v[32:35], a[72:75], a[32:35], v[32:35]
s_mul_i32 s75, s16, 1310720
v_mul_f32 v139, s68, v139
v_cvt_pk_bf16_f32 v72, v72, v73
v_mfma_f32_16x16x32_bf16 v[32:35], a[76:79], a[36:39], v[32:35]
s_add_u32 s75, s75, s67
v_cvt_pk_bf16_f32 v73, v74, v75
v_cvt_pk_bf16_f32 v74, v136, v137
v_mfma_f32_16x16x32_bf16 v[48:51], a[76:79], a[44:47], v[48:51]
s_mul_i32 s67, s31, 24576
v_cvt_pk_bf16_f32 v75, v138, v139
v_mul_f32 v56, s68, v56
v_mfma_f32_16x16x32_bf16 v[48:51], a[72:75], a[40:43], v[48:51]
s_sub_u32 s67, 1052672, s67
v_mul_f32 v57, s68, v57
v_mul_f32 v58, s68, v58
v_mfma_f32_16x16x32_bf16 v[64:67], a[72:75], a[48:51], v[64:67]
s_add_u32 s64, s74, s67
v_mul_f32 v59, s68, v59
v_mul_f32 v120, s68, v120
v_mfma_f32_16x16x32_bf16 v[64:67], a[76:79], a[52:55], v[64:67]
s_add_u32 s65, s75, s67
v_mul_f32 v121, s68, v121
v_mul_f32 v122, s68, v122
v_mfma_f32_16x16x32_bf16 v[80:83], a[76:79], a[60:63], v[80:83]
s_and_b32 s70, s30, 1
v_mul_f32 v123, s68, v123
v_cvt_pk_bf16_f32 v56, v56, v57
v_mfma_f32_16x16x32_bf16 v[80:83], a[72:75], a[56:59], v[80:83]
s_lshr_b32 s67, s30, 1
v_cvt_pk_bf16_f32 v57, v58, v59
v_cvt_pk_bf16_f32 v58, v120, v121
v_mfma_f32_16x16x32_bf16 v[144:147], a[80:83], a[56:59], v[144:147]
s_lshl3_add_u32 s71, s67, s70
v_cvt_pk_bf16_f32 v59, v122, v123
v_mul_f32 v40, s68, v40
v_mfma_f32_16x16x32_bf16 v[144:147], a[84:87], a[60:63], v[144:147]
s_add_u32 s71, s71, 4
v_mul_f32 v41, s68, v41
v_mul_f32 v42, s68, v42
v_mfma_f32_16x16x32_bf16 v[128:131], a[84:87], a[52:55], v[128:131]
s_lshl_b32 s71, s71, 13
v_mul_f32 v43, s68, v43
v_mul_f32 v104, s68, v104
v_mfma_f32_16x16x32_bf16 v[128:131], a[80:83], a[48:51], v[128:131]
s_lshl_b32 s70, s70, 14
v_mul_f32 v105, s68, v105
v_mul_f32 v106, s68, v106
v_mfma_f32_16x16x32_bf16 v[112:115], a[80:83], a[40:43], v[112:115]
s_mul_i32 s67, s67, 24576
v_mul_f32 v107, s68, v107
v_cvt_pk_bf16_f32 v40, v40, v41
v_mfma_f32_16x16x32_bf16 v[112:115], a[84:87], a[44:47], v[112:115]
s_sub_u32 s70, s70, s67
v_cvt_pk_bf16_f32 v41, v42, v43
v_cvt_pk_bf16_f32 v42, v104, v105
v_mfma_f32_16x16x32_bf16 v[96:99], a[84:87], a[36:39], v[96:99]
s_add_u32 s70, s70, 65536
v_cvt_pk_bf16_f32 v43, v106, v107
v_mul_f32 v24, s68, v24
v_mfma_f32_16x16x32_bf16 v[96:99], a[80:83], a[32:35], v[96:99]
s_waitcnt lgkmcnt(0)
v_mul_f32 v25, s68, v25
v_mul_f32 v26, s68, v26
v_mfma_f32_16x16x32_bf16 v[36:39], a[88:91], a[32:35], v[36:39]
v_mul_f32 v27, s68, v27
v_mul_f32 v88, s68, v88
v_mfma_f32_16x16x32_bf16 v[36:39], a[92:95], a[36:39], v[36:39]
v_mul_f32 v89, s68, v89
v_mul_f32 v90, s68, v90
v_mfma_f32_16x16x32_bf16 v[52:55], a[92:95], a[44:47], v[52:55]
v_mul_f32 v91, s68, v91
v_cvt_pk_bf16_f32 v24, v24, v25
v_mfma_f32_16x16x32_bf16 v[52:55], a[88:91], a[40:43], v[52:55]
v_cvt_pk_bf16_f32 v25, v26, v27
v_cvt_pk_bf16_f32 v26, v88, v89
v_mfma_f32_16x16x32_bf16 v[68:71], a[88:91], a[48:51], v[68:71]
v_cvt_pk_bf16_f32 v27, v90, v91
v_mul_f32 v76, s68, v76
v_mfma_f32_16x16x32_bf16 v[68:71], a[92:95], a[52:55], v[68:71]
v_mul_f32 v77, s68, v77
v_mul_f32 v78, s68, v78
v_mfma_f32_16x16x32_bf16 v[84:87], a[92:95], a[60:63], v[84:87]
v_mul_f32 v79, s68, v79
v_mul_f32 v140, s68, v140
v_mfma_f32_16x16x32_bf16 v[84:87], a[88:91], a[56:59], v[84:87]
v_mul_f32 v141, s68, v141
v_mul_f32 v142, s68, v142
v_mfma_f32_16x16x32_bf16 v[148:151], a[96:99], a[56:59], v[148:151]
v_mul_f32 v143, s68, v143
v_cvt_pk_bf16_f32 v76, v76, v77
v_mfma_f32_16x16x32_bf16 v[148:151], a[100:103], a[60:63], v[148:151]
v_cvt_pk_bf16_f32 v77, v78, v79
v_cvt_pk_bf16_f32 v78, v140, v141
v_mfma_f32_16x16x32_bf16 v[132:135], a[100:103], a[52:55], v[132:135]
v_cvt_pk_bf16_f32 v79, v142, v143
v_mul_f32 v60, s68, v60
v_mfma_f32_16x16x32_bf16 v[132:135], a[96:99], a[48:51], v[132:135]
v_mul_f32 v61, s68, v61
v_mul_f32 v62, s68, v62
v_mfma_f32_16x16x32_bf16 v[116:119], a[96:99], a[40:43], v[116:119]
v_mul_f32 v63, s68, v63
v_mul_f32 v124, s68, v124
v_mfma_f32_16x16x32_bf16 v[116:119], a[100:103], a[44:47], v[116:119]
v_mul_f32 v125, s68, v125
v_mul_f32 v126, s68, v126
v_mfma_f32_16x16x32_bf16 v[100:103], a[100:103], a[36:39], v[100:103]
v_mul_f32 v127, s68, v127
v_cvt_pk_bf16_f32 v60, v60, v61
v_mfma_f32_16x16x32_bf16 v[100:103], a[96:99], a[32:35], v[100:103]
v_cvt_pk_bf16_f32 v61, v62, v63
v_cvt_pk_bf16_f32 v62, v124, v125
v_cvt_pk_bf16_f32 v63, v126, v127
buffer_load_dwordx4 v[88:91], v16, s[44:47], s77 offen sc1
v_mfma_f32_16x16x32_bf16 v[196:199], v[192:195], v[160:163], v[248:251]
v_mfma_f32_16x16x32_bf16 v[212:215], v[208:211], v[176:179], v[248:251]
v_mfma_f32_16x16x32_bf16 v[164:167], a[4:7], v[160:163], v[252:255]
v_mfma_f32_16x16x32_bf16 v[180:183], a[12:15], v[176:179], v[252:255]
s_waitcnt vmcnt(24)
s_waitcnt vmcnt(25)
s_waitcnt vmcnt(26)
s_waitcnt vmcnt(27)
v_accvgpr_read_b32 v4, a64
v_accvgpr_read_b32 v5, a65
v_accvgpr_read_b32 v6, a66
v_accvgpr_read_b32 v7, a67
v_accvgpr_read_b32 v8, a68
v_accvgpr_read_b32 v9, a69
v_accvgpr_read_b32 v10, a70
v_accvgpr_read_b32 v11, a71
v_max3_f32 v121, v196, v197, v198
v_max3_f32 v121, v121, v199, v164
v_max3_f32 v121, v121, v165, v166
v_max_f32 v121, v121, v167
v_max3_f32 v123, v212, v213, v214
v_max3_f32 v123, v123, v215, v180
v_max3_f32 v123, v123, v181, v182
v_max_f32 v123, v123, v183
v_mov_b32 v105, v121
v_mov_b32 v107, v123
v_pk_mul_f32 v[28:29], v[28:29], s[68:69]
v_permlane16_swap_b32 v105, v121
v_permlane16_swap_b32 v107, v123
v_max_f32 v121, v121, v105
v_max_f32 v123, v123, v107
v_mov_b32 v105, v121
v_mov_b32 v107, v123
v_pk_mul_f32 v[30:31], v[30:31], s[68:69]
v_permlane32_swap_b32 v105, v121
v_permlane32_swap_b32 v107, v123
v_max_f32 v121, v121, v105
v_max_f32 v123, v123, v107
v_mul_f32 v121, s66, v121
v_mul_f32 v123, s66, v123
v_fma_f32 v164, v164, s66, -v121
v_fma_f32 v165, v165, s66, -v121
v_fma_f32 v166, v166, s66, -v121
v_fma_f32 v167, v167, s66, -v121
v_fma_f32 v196, v196, s66, -v121
v_fma_f32 v197, v197, s66, -v121
v_fma_f32 v198, v198, s66, -v121
v_fma_f32 v199, v199, s66, -v121
v_exp_f32 v164, v164
v_exp_f32 v165, v165
v_exp_f32 v166, v166
v_exp_f32 v167, v167
v_exp_f32 v196, v196
v_exp_f32 v197, v197
v_exp_f32 v198, v198
v_exp_f32 v199, v199
v_cvt_pk_bf16_f32 v164, v164, v165
v_cvt_pk_bf16_f32 v165, v166, v167
v_cvt_pk_bf16_f32 v166, v196, v197
v_cvt_pk_bf16_f32 v167, v198, v199
v_pk_mul_f32 v[92:93], v[92:93], s[68:69]
v_pk_mul_f32 v[94:95], v[94:95], s[68:69]
v_mfma_f32_16x16x32_bf16 v[196:199], a[244:247], v[164:167], 0
v_mfma_f32_16x16x32_bf16 v[160:163], v[224:227], v[164:167], 0
v_mfma_f32_16x16x32_bf16 v[192:195], v[228:231], v[164:167], 0
v_fma_f32 v180, v180, s66, -v123
v_fma_f32 v181, v181, s66, -v123
v_fma_f32 v182, v182, s66, -v123
v_fma_f32 v183, v183, s66, -v123
v_fma_f32 v212, v212, s66, -v123
v_fma_f32 v213, v213, s66, -v123
v_fma_f32 v214, v214, s66, -v123
v_fma_f32 v215, v215, s66, -v123
v_exp_f32 v180, v180
v_exp_f32 v181, v181
v_exp_f32 v182, v182
v_exp_f32 v183, v183
v_exp_f32 v212, v212
v_exp_f32 v213, v213
v_exp_f32 v214, v214
v_exp_f32 v215, v215
v_cvt_pk_bf16_f32 v180, v180, v181
v_cvt_pk_bf16_f32 v181, v182, v183
v_cvt_pk_bf16_f32 v182, v212, v213
v_cvt_pk_bf16_f32 v183, v214, v215
v_cvt_pk_bf16_f32 v28, v28, v29
v_cvt_pk_bf16_f32 v29, v30, v31
v_mfma_f32_16x16x32_bf16 v[212:215], a[244:247], v[180:183], 0
v_mfma_f32_16x16x32_bf16 v[176:179], v[240:243], v[180:183], 0
v_mfma_f32_16x16x32_bf16 v[208:211], v[244:247], v[180:183], 0
v_cvt_pk_bf16_f32 v30, v92, v93
v_cvt_pk_bf16_f32 v31, v94, v95
v_pk_mul_f32 v[44:45], v[44:45], s[68:69]
v_pk_mul_f32 v[46:47], v[46:47], s[68:69]
v_pk_mul_f32 v[108:109], v[108:109], s[68:69]
v_pk_mul_f32 v[110:111], v[110:111], s[68:69]
v_rcp_f32 v121, v196
v_rcp_f32 v123, v212
v_mul_f32 v121, v121, v7
v_mul_f32 v123, v123, v11
v_mul_f32 v160, v160, v121
v_mul_f32 v161, v161, v121
v_mul_f32 v162, v162, v121
v_mul_f32 v163, v163, v121
v_mul_f32 v192, v192, v121
v_mul_f32 v193, v193, v121
v_mul_f32 v194, v194, v121
v_mul_f32 v195, v195, v121
v_cvt_pk_bf16_f32 v160, v160, v161
v_cvt_pk_bf16_f32 v161, v162, v163
v_cvt_pk_bf16_f32 v162, v192, v193
v_cvt_pk_bf16_f32 v163, v194, v195
buffer_store_dwordx4 v[160:163], v16, s[44:47], s64 offen sc1
v_mul_f32 v176, v176, v123
v_mul_f32 v177, v177, v123
v_mul_f32 v178, v178, v123
v_mul_f32 v179, v179, v123
v_mul_f32 v208, v208, v123
v_mul_f32 v209, v209, v123
v_mul_f32 v210, v210, v123
v_mul_f32 v211, v211, v123
v_cvt_pk_bf16_f32 v176, v176, v177
v_cvt_pk_bf16_f32 v177, v178, v179
v_cvt_pk_bf16_f32 v178, v208, v209
v_cvt_pk_bf16_f32 v179, v210, v211
buffer_store_dwordx4 v[176:179], v16, s[44:47], s65 offen sc1
v_cvt_pk_bf16_f32 v44, v44, v45
v_cvt_pk_bf16_f32 v45, v46, v47
v_cvt_pk_bf16_f32 v46, v108, v109
v_cvt_pk_bf16_f32 v47, v110, v111
v_pk_mul_f32 v[32:33], v[32:33], s[68:69]
v_pk_mul_f32 v[34:35], v[34:35], s[68:69]
v_pk_mul_f32 v[96:97], v[96:97], s[68:69]
v_pk_mul_f32 v[98:99], v[98:99], s[68:69]
v_cvt_pk_bf16_f32 v32, v32, v33
v_cvt_pk_bf16_f32 v33, v34, v35
v_cvt_pk_bf16_f32 v34, v96, v97
v_cvt_pk_bf16_f32 v35, v98, v99
v_pk_mul_f32 v[48:49], v[48:49], s[68:69]
v_pk_mul_f32 v[50:51], v[50:51], s[68:69]
v_pk_mul_f32 v[112:113], v[112:113], s[68:69]
v_pk_mul_f32 v[114:115], v[114:115], s[68:69]
v_cvt_pk_bf16_f32 v48, v48, v49
v_cvt_pk_bf16_f32 v49, v50, v51
v_cvt_pk_bf16_f32 v50, v112, v113
v_cvt_pk_bf16_f32 v51, v114, v115
v_pk_mul_f32 v[64:65], v[64:65], s[68:69]
v_pk_mul_f32 v[66:67], v[66:67], s[68:69]
v_pk_mul_f32 v[128:129], v[128:129], s[68:69]
v_pk_mul_f32 v[130:131], v[130:131], s[68:69]
s_waitcnt vmcnt(2)
L_hchk:
v_max3_u32 v1, v88, v89, v90
v_max_u32 v1, v1, v91
v_cmp_eq_u32 vcc, -1, v1
s_cbranch_vccnz L_hretry
L_hgo:
ds_write_b128 v17, v[88:91]
s_sub_u32 s64, s64, 4096
s_sub_u32 s65, s65, 4096
v_cvt_pk_bf16_f32 v64, v64, v65
v_cvt_pk_bf16_f32 v65, v66, v67
v_cvt_pk_bf16_f32 v66, v128, v129
v_cvt_pk_bf16_f32 v67, v130, v131
v_pk_mul_f32 v[80:81], v[80:81], s[68:69]
v_pk_mul_f32 v[82:83], v[82:83], s[68:69]
v_pk_mul_f32 v[144:145], v[144:145], s[68:69]
v_pk_mul_f32 v[146:147], v[146:147], s[68:69]
s_waitcnt lgkmcnt(0)
s_barrier
ds_read_b128 a[0:3], v2 offset:0
ds_read_b128 a[8:11], v3 offset:0
ds_read_b64 v[216:217], v2 offset:1024
ds_read_b64 v[220:221], v2 offset:1032
ds_read_b64 v[232:233], v3 offset:1024
ds_read_b64 v[236:237], v3 offset:1032
v_cvt_pk_bf16_f32 v80, v80, v81
v_cvt_pk_bf16_f32 v81, v82, v83
v_cvt_pk_bf16_f32 v82, v144, v145
v_cvt_pk_bf16_f32 v83, v146, v147
v_pk_mul_f32 v[36:37], v[36:37], s[68:69]
v_pk_mul_f32 v[38:39], v[38:39], s[68:69]
v_pk_mul_f32 v[100:101], v[100:101], s[68:69]
v_pk_mul_f32 v[102:103], v[102:103], s[68:69]
v_cvt_pk_bf16_f32 v36, v36, v37
v_cvt_pk_bf16_f32 v37, v38, v39
v_cvt_pk_bf16_f32 v38, v100, v101
v_cvt_pk_bf16_f32 v39, v102, v103
v_pk_mul_f32 v[52:53], v[52:53], s[68:69]
v_pk_mul_f32 v[54:55], v[54:55], s[68:69]
v_pk_mul_f32 v[116:117], v[116:117], s[68:69]
v_pk_mul_f32 v[118:119], v[118:119], s[68:69]
v_mfma_f32_16x16x32_bf16 v[188:191], v[184:187], v[152:155], v[248:251]
v_mfma_f32_16x16x32_bf16 v[204:207], v[200:203], v[168:171], v[248:251]
s_waitcnt lgkmcnt(5)
v_mfma_f32_16x16x32_bf16 v[156:159], a[0:3], v[152:155], v[20:23]
s_waitcnt lgkmcnt(4)
v_mfma_f32_16x16x32_bf16 v[172:175], a[8:11], v[168:171], v[252:255]
v_cvt_pk_bf16_f32 v52, v52, v53
v_cvt_pk_bf16_f32 v53, v54, v55
v_cvt_pk_bf16_f32 v54, v116, v117
v_cvt_pk_bf16_f32 v55, v118, v119
v_pk_mul_f32 v[68:69], v[68:69], s[68:69]
v_pk_mul_f32 v[70:71], v[70:71], s[68:69]
v_pk_mul_f32 v[132:133], v[132:133], s[68:69]
v_pk_mul_f32 v[134:135], v[134:135], s[68:69]
v_max3_f32 v120, v188, v189, v190
v_max3_f32 v120, v120, v191, v156
v_max3_f32 v120, v120, v157, v158
v_max_f32 v120, v120, v159
v_max3_f32 v122, v204, v205, v206
v_max3_f32 v122, v122, v207, v172
v_max3_f32 v122, v122, v173, v174
v_max_f32 v122, v122, v175
v_mov_b32 v104, v120
v_mov_b32 v106, v122
v_cvt_pk_bf16_f32 v68, v68, v69
v_permlane16_swap_b32 v104, v120
v_permlane16_swap_b32 v106, v122
v_max_f32 v120, v120, v104
v_max_f32 v122, v122, v106
v_mov_b32 v104, v120
v_mov_b32 v106, v122
v_cvt_pk_bf16_f32 v69, v70, v71
v_permlane32_swap_b32 v104, v120
v_permlane32_swap_b32 v106, v122
v_max_f32 v120, v120, v104
v_max_f32 v122, v122, v106
v_mul_f32 v120, s66, v120
v_mul_f32 v122, s66, v122
v_fma_f32 v156, v156, s66, -v120
v_fma_f32 v157, v157, s66, -v120
v_fma_f32 v158, v158, s66, -v120
v_fma_f32 v159, v159, s66, -v120
v_fma_f32 v188, v188, s66, -v120
v_fma_f32 v189, v189, s66, -v120
v_fma_f32 v190, v190, s66, -v120
v_fma_f32 v191, v191, s66, -v120
v_exp_f32 v156, v156
v_exp_f32 v157, v157
v_exp_f32 v158, v158
v_exp_f32 v159, v159
v_exp_f32 v188, v188
v_exp_f32 v189, v189
v_exp_f32 v190, v190
v_exp_f32 v191, v191
v_cvt_pk_bf16_f32 v156, v156, v157
v_cvt_pk_bf16_f32 v157, v158, v159
v_cvt_pk_bf16_f32 v158, v188, v189
v_cvt_pk_bf16_f32 v159, v190, v191
v_cvt_pk_bf16_f32 v70, v132, v133
v_cvt_pk_bf16_f32 v71, v134, v135
v_mfma_f32_16x16x32_bf16 v[188:191], a[244:247], v[156:159], 0
s_waitcnt lgkmcnt(3)
v_mfma_f32_16x16x32_bf16 v[152:155], v[216:219], v[156:159], 0
s_waitcnt lgkmcnt(2)
v_mfma_f32_16x16x32_bf16 v[184:187], v[220:223], v[156:159], 0
v_fma_f32 v172, v172, s66, -v122
v_fma_f32 v173, v173, s66, -v122
v_fma_f32 v174, v174, s66, -v122
v_fma_f32 v175, v175, s66, -v122
v_fma_f32 v204, v204, s66, -v122
v_fma_f32 v205, v205, s66, -v122
v_fma_f32 v206, v206, s66, -v122
v_fma_f32 v207, v207, s66, -v122
v_exp_f32 v172, v172
v_exp_f32 v173, v173
v_exp_f32 v174, v174
v_exp_f32 v175, v175
v_exp_f32 v204, v204
v_exp_f32 v205, v205
v_exp_f32 v206, v206
v_exp_f32 v207, v207
v_cvt_pk_bf16_f32 v172, v172, v173
v_cvt_pk_bf16_f32 v173, v174, v175
v_cvt_pk_bf16_f32 v174, v204, v205
v_cvt_pk_bf16_f32 v175, v206, v207
v_pk_mul_f32 v[84:85], v[84:85], s[68:69]
v_pk_mul_f32 v[86:87], v[86:87], s[68:69]
v_mfma_f32_16x16x32_bf16 v[204:207], a[244:247], v[172:175], 0
s_waitcnt lgkmcnt(1)
v_mfma_f32_16x16x32_bf16 v[168:171], v[232:235], v[172:175], 0
s_waitcnt lgkmcnt(0)
v_mfma_f32_16x16x32_bf16 v[200:203], v[236:239], v[172:175], 0
v_pk_mul_f32 v[148:149], v[148:149], s[68:69]
v_pk_mul_f32 v[150:151], v[150:151], s[68:69]
v_cvt_pk_bf16_f32 v84, v84, v85
v_cvt_pk_bf16_f32 v85, v86, v87
v_cvt_pk_bf16_f32 v86, v148, v149
v_cvt_pk_bf16_f32 v87, v150, v151
v_rcp_f32 v120, v188
v_rcp_f32 v122, v204
v_mul_f32 v120, v120, v5
v_mul_f32 v122, v122, v9
v_mul_f32 v152, v152, v120
v_mul_f32 v153, v153, v120
v_mul_f32 v154, v154, v120
v_mul_f32 v155, v155, v120
v_mul_f32 v184, v184, v120
v_mul_f32 v185, v185, v120
v_mul_f32 v186, v186, v120
v_mul_f32 v187, v187, v120
v_cvt_pk_bf16_f32 v152, v152, v153
v_cvt_pk_bf16_f32 v153, v154, v155
v_cvt_pk_bf16_f32 v154, v184, v185
v_cvt_pk_bf16_f32 v155, v186, v187
buffer_store_dwordx4 v[152:155], v16, s[44:47], s64 offen sc1
v_mul_f32 v168, v168, v122
v_mul_f32 v169, v169, v122
v_mul_f32 v170, v170, v122
v_mul_f32 v171, v171, v122
v_mul_f32 v200, v200, v122
v_mul_f32 v201, v201, v122
v_mul_f32 v202, v202, v122
v_mul_f32 v203, v203, v122
v_cvt_pk_bf16_f32 v168, v168, v169
v_cvt_pk_bf16_f32 v169, v170, v171
v_cvt_pk_bf16_f32 v170, v200, v201
v_cvt_pk_bf16_f32 v171, v202, v203
buffer_store_dwordx4 v[168:171], v16, s[44:47], s65 offen sc1
v_mov_b32 v17, 0xff800000
L_attstart_7:
v_mov_b32 v2, v16
v_add_u32 v3, 0x10000, v16
v_mov_b32 v1, 0
s_waitcnt lgkmcnt(0)
s_barrier
s_cmp_eq_u32 s3, 0
s_cbranch_scc1 L_F1
ds_read_b128 a[144:147], v2 offset:0
ds_read_b128 a[148:151], v2 offset:1024
ds_read_b128 a[152:155], v2 offset:2048
ds_read_b128 a[156:159], v2 offset:3072
ds_read_b128 a[160:163], v2 offset:4096
ds_read_b128 a[164:167], v2 offset:5120
ds_read_b128 a[168:171], v2 offset:6144
ds_read_b128 a[172:175], v2 offset:7168
s_mov_b32 m0, s71
s_nop 0
buffer_load_dwordx4 v16, s[32:35], s70 offen offset:0 sc1 lds
buffer_load_dwordx4 v16, s[32:35], s70 offen offset:1024 sc1 lds
s_waitcnt lgkmcnt(7)
v_mfma_f32_16x16x32_bf16 v[88:91], a[144:147], v[24:27], 0
s_waitcnt lgkmcnt(6)
ds_read_b128 a[176:179], v2 offset:8192
ds_read_b128 a[180:183], v2 offset:9216
v_mfma_f32_16x16x32_bf16 v[88:91], a[148:151], v[28:31], v[88:91]
s_waitcnt lgkmcnt(7)
ds_read_b128 a[184:187], v2 offset:10240
ds_read_b128 a[188:191], v2 offset:11264
v_mfma_f32_16x16x32_bf16 v[88:91], a[152:155], v[32:35], v[88:91]
s_waitcnt lgkmcnt(8)
buffer_load_dwordx4 v16, s[32:35], s70 offen offset:2048 sc1 lds
v_mfma_f32_16x16x32_bf16 v[88:91], a[156:159], v[36:39], v[88:91]
ds_read_b128 a[192:195], v2 offset:12288
ds_read_b128 a[196:199], v2 offset:13312
v_mfma_f32_16x16x32_bf16 v[104:107], a[156:159], v[52:55], 0
v_mfma_f32_16x16x32_bf16 v[104:107], a[152:155], v[48:51], v[104:107]
ds_read_b128 a[200:203], v2 offset:14336
v_mfma_f32_16x16x32_bf16 v[104:107], a[148:151], v[44:47], v[104:107]
v_mfma_f32_16x16x32_bf16 v[104:107], a[144:147], v[40:43], v[104:107]
ds_read_b128 a[204:207], v2 offset:15360
v_mfma_f32_16x16x32_bf16 v[120:123], a[144:147], v[56:59], 0
v_mfma_f32_16x16x32_bf16 v[120:123], a[148:151], v[60:63], v[120:123]
buffer_load_dwordx4 v16, s[32:35], s70 offen offset:3072 sc1 lds
v_mfma_f32_16x16x32_bf16 v[120:123], a[152:155], v[64:67], v[120:123]
v_mfma_f32_16x16x32_bf16 v[120:123], a[156:159], v[68:71], v[120:123]
v_mfma_f32_16x16x32_bf16 v[136:139], a[156:159], v[84:87], 0
v_mfma_f32_16x16x32_bf16 v[136:139], a[152:155], v[80:83], v[136:139]
v_mfma_f32_16x16x32_bf16 v[136:139], a[148:151], v[76:79], v[136:139]
v_mfma_f32_16x16x32_bf16 v[136:139], a[144:147], v[72:75], v[136:139]
s_waitcnt lgkmcnt(0)
s_nop 1
v_max3_f32 v20, v88, v89, v90
v_max_f32 v20, v20, v91
v_max3_f32 v21, v104, v105, v106
v_max_f32 v21, v21, v107
v_max3_f32 v22, v120, v121, v122
v_max_f32 v22, v22, v123
v_max3_f32 v23, v136, v137, v138
v_max_f32 v23, v23, v139
v_mov_b32 v248, v20
v_mov_b32 v249, v21
v_mov_b32 v250, v22
v_mov_b32 v251, v23
v_permlane16_swap_b32 v248, v20
v_permlane16_swap_b32 v249, v21
v_permlane16_swap_b32 v250, v22
v_permlane16_swap_b32 v251, v23
v_max_f32 v20, v20, v248
v_max_f32 v21, v21, v249
v_max_f32 v22, v22, v250
v_max_f32 v23, v23, v251
v_mov_b32 v248, v20
v_mov_b32 v249, v21
v_mov_b32 v250, v22
v_mov_b32 v251, v23
v_permlane32_swap_b32 v248, v20
v_permlane32_swap_b32 v249, v21
v_permlane32_swap_b32 v250, v22
v_permlane32_swap_b32 v251, v23
v_max_f32 v20, v20, v248
v_max_f32 v21, v21, v249
v_max_f32 v22, v22, v250
v_max_f32 v23, v23, v251
s_cmp_eq_u32 s73, 0
s_cselect_b64 vcc, 0, -1
v_cndmask_b32 v20, v20, v252, vcc
v_cndmask_b32 v21, v21, v253, vcc
v_cndmask_b32 v22, v22, v254, vcc
v_cndmask_b32 v23, v23, v255, vcc
v_sub_f32 v228, 0, v23
v_sub_f32 v229, 0, v23
v_sub_f32 v230, 0, v23
v_sub_f32 v231, 0, v23
v_sub_f32 v224, 0, v22
v_sub_f32 v225, 0, v22
v_sub_f32 v226, 0, v22
v_sub_f32 v227, 0, v22
v_sub_f32 v220, 0, v21
v_sub_f32 v221, 0, v21
v_sub_f32 v222, 0, v21
v_sub_f32 v223, 0, v21
v_sub_f32 v216, 0, v20
v_sub_f32 v217, 0, v20
v_sub_f32 v218, 0, v20
v_sub_f32 v219, 0, v20
v_mfma_f32_16x16x32_bf16 v[140:143], a[160:163], v[72:75], v[228:231]
s_add_u32 m0, s71, 4096
v_add_f32 v88, v88, v216
v_add_f32 v89, v89, v216
v_mfma_f32_16x16x32_bf16 v[140:143], a[164:167], v[76:79], v[140:143]
v_add_f32 v90, v90, v216
v_add_f32 v91, v91, v216
v_exp_f32 v88, v88
v_mfma_f32_16x16x32_bf16 v[140:143], a[168:171], v[80:83], v[140:143]
s_add_u32 s64, s70, 4096
v_exp_f32 v89, v89
v_mfma_f32_16x16x32_bf16 v[140:143], a[172:175], v[84:87], v[140:143]
buffer_load_dwordx4 v16, s[32:35], s64 offen offset:0 sc1 lds
v_mfma_f32_16x16x32_bf16 v[124:127], a[172:175], v[68:71], v[224:227]
v_exp_f32 v90, v90
v_mfma_f32_16x16x32_bf16 v[124:127], a[168:171], v[64:67], v[124:127]
v_exp_f32 v91, v91
v_mfma_f32_16x16x32_bf16 v[124:127], a[164:167], v[60:63], v[124:127]
v_add_f32 v104, v104, v220
v_add_f32 v105, v105, v220
v_add_f32 v106, v106, v220
v_add_f32 v107, v107, v220
v_exp_f32 v104, v104
v_mfma_f32_16x16x32_bf16 v[124:127], a[160:163], v[56:59], v[124:127]
v_exp_f32 v105, v105
v_mfma_f32_16x16x32_bf16 v[108:111], a[160:163], v[40:43], v[220:223]
v_exp_f32 v106, v106
v_mfma_f32_16x16x32_bf16 v[108:111], a[164:167], v[44:47], v[108:111]
buffer_load_dwordx4 v16, s[32:35], s64 offen offset:1024 sc1 lds
v_mfma_f32_16x16x32_bf16 v[108:111], a[168:171], v[48:51], v[108:111]
v_cvt_pk_bf16_f32 v152, v88, v89
v_add_f32 v120, v120, v224
v_mfma_f32_16x16x32_bf16 v[108:111], a[172:175], v[52:55], v[108:111]
v_exp_f32 v107, v107
v_mfma_f32_16x16x32_bf16 v[92:95], a[172:175], v[36:39], v[216:219]
v_add_f32 v121, v121, v224
v_add_f32 v122, v122, v224
v_add_f32 v123, v123, v224
v_exp_f32 v120, v120
v_mfma_f32_16x16x32_bf16 v[92:95], a[168:171], v[32:35], v[92:95]
v_cvt_pk_bf16_f32 v153, v90, v91
v_exp_f32 v121, v121
v_mfma_f32_16x16x32_bf16 v[92:95], a[164:167], v[28:31], v[92:95]
v_exp_f32 v122, v122
v_mfma_f32_16x16x32_bf16 v[92:95], a[160:163], v[24:27], v[92:95]
v_exp_f32 v123, v123
v_mfma_f32_16x16x32_bf16 v[96:99], a[176:179], v[24:27], v[216:219]
v_cvt_pk_bf16_f32 v160, v104, v105
v_add_f32 v136, v136, v228
v_mfma_f32_16x16x32_bf16 v[96:99], a[180:183], v[28:31], v[96:99]
buffer_load_dwordx4 v16, s[32:35], s64 offen offset:2048 sc1 lds
v_add_f32 v137, v137, v228
v_add_f32 v138, v138, v228
v_add_f32 v139, v139, v228
v_exp_f32 v136, v136
v_mfma_f32_16x16x32_bf16 v[96:99], a[184:187], v[32:35], v[96:99]
v_exp_f32 v137, v137
v_mfma_f32_16x16x32_bf16 v[96:99], a[188:191], v[36:39], v[96:99]
v_cvt_pk_bf16_f32 v161, v106, v107
v_cvt_pk_bf16_f32 v184, v120, v121
v_mfma_f32_16x16x32_bf16 v[112:115], a[188:191], v[52:55], v[220:223]
v_exp_f32 v138, v138
v_mfma_f32_16x16x32_bf16 v[112:115], a[184:187], v[48:51], v[112:115]
v_exp_f32 v139, v139
v_mfma_f32_16x16x32_bf16 v[112:115], a[180:183], v[44:47], v[112:115]
v_exp_f32 v140, v140
v_mfma_f32_16x16x32_bf16 v[112:115], a[176:179], v[40:43], v[112:115]
v_exp_f32 v141, v141
v_mfma_f32_16x16x32_bf16 v[128:131], a[176:179], v[56:59], v[224:227]
buffer_load_dwordx4 v16, s[32:35], s64 offen offset:3072 sc1 lds
v_cvt_pk_bf16_f32 v185, v122, v123
v_mfma_f32_16x16x32_bf16 v[128:131], a[180:183], v[60:63], v[128:131]
v_exp_f32 v142, v142
v_mfma_f32_16x16x32_bf16 v[128:131], a[184:187], v[64:67], v[128:131]
v_exp_f32 v143, v143
v_mfma_f32_16x16x32_bf16 v[128:131], a[188:191], v[68:71], v[128:131]
v_cvt_pk_bf16_f32 v192, v136, v137
v_cvt_pk_bf16_f32 v193, v138, v139
v_mfma_f32_16x16x32_bf16 v[144:147], a[188:191], v[84:87], v[228:231]
v_exp_f32 v124, v124
v_mfma_f32_16x16x32_bf16 v[144:147], a[184:187], v[80:83], v[144:147]
v_exp_f32 v125, v125
v_mfma_f32_16x16x32_bf16 v[144:147], a[180:183], v[76:79], v[144:147]
s_waitcnt vmcnt(8)
s_barrier
v_mfma_f32_16x16x32_bf16 v[144:147], a[176:179], v[72:75], v[144:147]
v_exp_f32 v126, v126
v_mfma_f32_16x16x32_bf16 v[148:151], a[192:195], v[72:75], v[228:231]
v_cvt_pk_bf16_f32 v194, v140, v141
v_cvt_pk_bf16_f32 v195, v142, v143
v_mfma_f32_16x16x32_bf16 v[148:151], a[196:199], v[76:79], v[148:151]
v_exp_f32 v127, v127
v_mfma_f32_16x16x32_bf16 v[148:151], a[200:203], v[80:83], v[148:151]
s_xor_b32 s71, s71, 16384
v_exp_f32 v108, v108
v_mfma_f32_16x16x32_bf16 v[148:151], a[204:207], v[84:87], v[148:151]
s_add_u32 s70, s70, 32768
v_exp_f32 v109, v109
v_mfma_f32_16x16x32_bf16 v[132:135], a[204:207], v[68:71], v[224:227]
s_mov_b32 m0, s71
v_exp_f32 v110, v110
v_mfma_f32_16x16x32_bf16 v[132:135], a[200:203], v[64:67], v[132:135]
buffer_load_dwordx4 v16, s[32:35], s70 offen offset:0 sc1 lds
v_mfma_f32_16x16x32_bf16 v[132:135], a[196:199], v[60:63], v[132:135]
v_cvt_pk_bf16_f32 v186, v124, v125
v_exp_f32 v111, v111
v_mfma_f32_16x16x32_bf16 v[132:135], a[192:195], v[56:59], v[132:135]
v_exp_f32 v92, v92
v_mfma_f32_16x16x32_bf16 v[116:119], a[192:195], v[40:43], v[220:223]
v_exp_f32 v93, v93
v_mfma_f32_16x16x32_bf16 v[116:119], a[196:199], v[44:47], v[116:119]
ds_read_b128 a[144:147], v2 offset:16384
v_cvt_pk_bf16_f32 v187, v126, v127
v_mfma_f32_16x16x32_bf16 v[116:119], a[200:203], v[48:51], v[116:119]
v_exp_f32 v94, v94
v_mfma_f32_16x16x32_bf16 v[116:119], a[204:207], v[52:55], v[116:119]
ds_read_b128 a[148:151], v2 offset:17408
v_cvt_pk_bf16_f32 v162, v108, v109
v_mfma_f32_16x16x32_bf16 v[100:103], a[204:207], v[36:39], v[216:219]
ds_read_b128 a[152:155], v2 offset:18432
buffer_load_dwordx4 v16, s[32:35], s70 offen offset:1024 sc1 lds
v_exp_f32 v95, v95
v_mfma_f32_16x16x32_bf16 v[100:103], a[200:203], v[32:35], v[100:103]
ds_read_b128 a[156:159], v2 offset:19456
v_exp_f32 v96, v96
v_mfma_f32_16x16x32_bf16 v[100:103], a[196:199], v[28:31], v[100:103]
v_cvt_pk_bf16_f32 v163, v110, v111
v_exp_f32 v97, v97
v_mfma_f32_16x16x32_bf16 v[100:103], a[192:195], v[24:27], v[100:103]
s_waitcnt lgkmcnt(3)
ds_read_b128 a[160:163], v2 offset:20480
ds_read_b128 a[164:167], v2 offset:21504
ds_read_b128 a[168:171], v2 offset:22528
ds_read_b128 a[172:175], v2 offset:23552
v_mfma_f32_16x16x32_bf16 v[88:91], a[144:147], v[24:27], v[216:219]
s_waitcnt lgkmcnt(6)
v_exp_f32 v98, v98
v_mfma_f32_16x16x32_bf16 v[88:91], a[148:151], v[28:31], v[88:91]
s_waitcnt lgkmcnt(5)
v_cvt_pk_bf16_f32 v154, v92, v93
v_exp_f32 v99, v99
v_mfma_f32_16x16x32_bf16 v[88:91], a[152:155], v[32:35], v[88:91]
s_waitcnt lgkmcnt(4)
v_exp_f32 v112, v112
v_mfma_f32_16x16x32_bf16 v[88:91], a[156:159], v[36:39], v[88:91]
v_exp_f32 v113, v113
v_mfma_f32_16x16x32_bf16 v[104:107], a[156:159], v[52:55], v[220:223]
v_cvt_pk_bf16_f32 v155, v94, v95
v_cvt_pk_bf16_f32 v156, v96, v97
v_mfma_f32_16x16x32_bf16 v[104:107], a[152:155], v[48:51], v[104:107]
buffer_load_dwordx4 v16, s[32:35], s70 offen offset:2048 sc1 lds
v_exp_f32 v114, v114
v_mfma_f32_16x16x32_bf16 v[104:107], a[148:151], v[44:47], v[104:107]
v_exp_f32 v115, v115
v_mfma_f32_16x16x32_bf16 v[104:107], a[144:147], v[40:43], v[104:107]
v_exp_f32 v128, v128
v_mfma_f32_16x16x32_bf16 v[120:123], a[144:147], v[56:59], v[224:227]
v_exp_f32 v129, v129
v_mfma_f32_16x16x32_bf16 v[120:123], a[148:151], v[60:63], v[120:123]
v_cvt_pk_bf16_f32 v157, v98, v99
v_cvt_pk_bf16_f32 v164, v112, v113
v_mfma_f32_16x16x32_bf16 v[120:123], a[152:155], v[64:67], v[120:123]
v_exp_f32 v130, v130
v_mfma_f32_16x16x32_bf16 v[120:123], a[156:159], v[68:71], v[120:123]
v_exp_f32 v131, v131
v_mfma_f32_16x16x32_bf16 v[136:139], a[156:159], v[84:87], v[228:231]
v_exp_f32 v144, v144
v_mfma_f32_16x16x32_bf16 v[136:139], a[152:155], v[80:83], v[136:139]
v_exp_f32 v145, v145
v_mfma_f32_16x16x32_bf16 v[136:139], a[148:151], v[76:79], v[136:139]
v_exp_f32 v146, v146
v_mfma_f32_16x16x32_bf16 v[136:139], a[144:147], v[72:75], v[136:139]
s_waitcnt lgkmcnt(0)
v_cvt_pk_bf16_f32 v165, v114, v115
v_cvt_pk_bf16_f32 v188, v128, v129
v_mfma_f32_16x16x32_bf16 v[140:143], a[160:163], v[72:75], v[228:231]
v_exp_f32 v147, v147
v_mfma_f32_16x16x32_bf16 v[140:143], a[164:167], v[76:79], v[140:143]
v_exp_f32 v148, v148
v_mfma_f32_16x16x32_bf16 v[140:143], a[168:171], v[80:83], v[140:143]
v_exp_f32 v149, v149
v_mfma_f32_16x16x32_bf16 v[140:143], a[172:175], v[84:87], v[140:143]
buffer_load_dwordx4 v16, s[32:35], s70 offen offset:3072 sc1 lds
v_mfma_f32_16x16x32_bf16 v[124:127], a[172:175], v[68:71], v[224:227]
v_cvt_pk_bf16_f32 v189, v130, v131
v_cvt_pk_bf16_f32 v196, v144, v145
v_mfma_f32_16x16x32_bf16 v[124:127], a[168:171], v[64:67], v[124:127]
v_exp_f32 v150, v150
v_mfma_f32_16x16x32_bf16 v[124:127], a[164:167], v[60:63], v[124:127]
v_exp_f32 v151, v151
v_mfma_f32_16x16x32_bf16 v[124:127], a[160:163], v[56:59], v[124:127]
v_exp_f32 v132, v132
v_mfma_f32_16x16x32_bf16 v[108:111], a[160:163], v[40:43], v[220:223]
ds_read_b128 a[176:179], v2 offset:24576
v_cvt_pk_bf16_f32 v197, v146, v147
v_mfma_f32_16x16x32_bf16 v[108:111], a[164:167], v[44:47], v[108:111]
ds_read_b128 a[180:183], v2 offset:25600
v_cvt_pk_bf16_f32 v198, v148, v149
v_mfma_f32_16x16x32_bf16 v[108:111], a[168:171], v[48:51], v[108:111]
ds_read_b128 a[184:187], v2 offset:26624
v_exp_f32 v133, v133
v_mfma_f32_16x16x32_bf16 v[108:111], a[172:175], v[52:55], v[108:111]
ds_read_b128 a[188:191], v2 offset:27648
v_exp_f32 v134, v134
v_mfma_f32_16x16x32_bf16 v[92:95], a[172:175], v[36:39], v[216:219]
v_exp_f32 v135, v135
v_mfma_f32_16x16x32_bf16 v[92:95], a[168:171], v[32:35], v[92:95]
v_exp_f32 v116, v116
v_mfma_f32_16x16x32_bf16 v[92:95], a[164:167], v[28:31], v[92:95]
v_exp_f32 v117, v117
v_mfma_f32_16x16x32_bf16 v[92:95], a[160:163], v[24:27], v[92:95]
s_waitcnt lgkmcnt(2)
v_cvt_pk_bf16_f32 v199, v150, v151
v_cvt_pk_bf16_f32 v190, v132, v133
v_mfma_f32_16x16x32_bf16 v[96:99], a[176:179], v[24:27], v[216:219]
v_exp_f32 v118, v118
v_mfma_f32_16x16x32_bf16 v[96:99], a[180:183], v[28:31], v[96:99]
s_waitcnt lgkmcnt(0)
v_exp_f32 v119, v119
v_mfma_f32_16x16x32_bf16 v[96:99], a[184:187], v[32:35], v[96:99]
s_add_u32 m0, s71, 4096
v_exp_f32 v100, v100
v_mfma_f32_16x16x32_bf16 v[96:99], a[188:191], v[36:39], v[96:99]
s_add_u32 s64, s70, 4096
v_exp_f32 v101, v101
v_mfma_f32_16x16x32_bf16 v[112:115], a[188:191], v[52:55], v[220:223]
buffer_load_dwordx4 v16, s[32:35], s64 offen offset:0 sc1 lds
v_mfma_f32_16x16x32_bf16 v[112:115], a[184:187], v[48:51], v[112:115]
v_cvt_pk_bf16_f32 v191, v134, v135
v_cvt_pk_bf16_f32 v166, v116, v117
v_mfma_f32_16x16x32_bf16 v[112:115], a[180:183], v[44:47], v[112:115]
v_exp_f32 v102, v102
v_mfma_f32_16x16x32_bf16 v[112:115], a[176:179], v[40:43], v[112:115]
v_exp_f32 v103, v103
v_mfma_f32_16x16x32_bf16 v[128:131], a[176:179], v[56:59], v[224:227]
s_lshl_b32 s66, s30, 30
ds_read_b128 a[192:195], v2 offset:28672
v_cvt_pk_bf16_f32 v167, v118, v119
v_mfma_f32_16x16x32_bf16 v[128:131], a[180:183], v[60:63], v[128:131]
ds_read_b128 a[196:199], v2 offset:29696
v_exp_f32 v88, v88
v_mfma_f32_16x16x32_bf16 v[128:131], a[184:187], v[64:67], v[128:131]
ds_read_b128 a[200:203], v2 offset:30720
v_exp_f32 v89, v89
v_mfma_f32_16x16x32_bf16 v[128:131], a[188:191], v[68:71], v[128:131]
ds_read_b128 a[204:207], v2 offset:31744
v_cvt_pk_bf16_f32 v158, v100, v101
v_mfma_f32_16x16x32_bf16 v[144:147], a[188:191], v[84:87], v[228:231]
v_exp_f32 v90, v90
v_mfma_f32_16x16x32_bf16 v[144:147], a[184:187], v[80:83], v[144:147]
v_exp_f32 v91, v91
v_mfma_f32_16x16x32_bf16 v[144:147], a[180:183], v[76:79], v[144:147]
v_exp_f32 v104, v104
v_mfma_f32_16x16x32_bf16 v[144:147], a[176:179], v[72:75], v[144:147]
s_waitcnt lgkmcnt(2)
v_exp_f32 v105, v105
v_mfma_f32_16x16x32_bf16 v[148:151], a[192:195], v[72:75], v[228:231]
v_cvt_pk_bf16_f32 v159, v102, v103
v_cvt_pk_bf16_f32 v168, v88, v89
v_mfma_f32_16x16x32_bf16 v[148:151], a[196:199], v[76:79], v[148:151]
s_waitcnt lgkmcnt(0)
v_exp_f32 v106, v106
v_mfma_f32_16x16x32_bf16 v[148:151], a[200:203], v[80:83], v[148:151]
v_exp_f32 v107, v107
v_mfma_f32_16x16x32_bf16 v[148:151], a[204:207], v[84:87], v[148:151]
v_exp_f32 v120, v120
v_mfma_f32_16x16x32_bf16 v[132:135], a[204:207], v[68:71], v[224:227]
buffer_load_dwordx4 v16, s[32:35], s64 offen offset:1024 sc1 lds
v_mfma_f32_16x16x32_bf16 v[132:135], a[200:203], v[64:67], v[132:135]
v_cvt_pk_bf16_f32 v169, v90, v91
v_cvt_pk_bf16_f32 v176, v104, v105
v_mfma_f32_16x16x32_bf16 v[132:135], a[196:199], v[60:63], v[132:135]
v_exp_f32 v121, v121
v_mfma_f32_16x16x32_bf16 v[132:135], a[192:195], v[56:59], v[132:135]
v_exp_f32 v122, v122
v_mfma_f32_16x16x32_bf16 v[116:119], a[192:195], v[40:43], v[220:223]
v_exp_f32 v123, v123
v_mfma_f32_16x16x32_bf16 v[116:119], a[196:199], v[44:47], v[116:119]
v_exp_f32 v136, v136
v_mfma_f32_16x16x32_bf16 v[116:119], a[200:203], v[48:51], v[116:119]
v_exp_f32 v137, v137
v_mfma_f32_16x16x32_bf16 v[116:119], a[204:207], v[52:55], v[116:119]
v_cvt_pk_bf16_f32 v177, v106, v107
v_cvt_pk_bf16_f32 v200, v120, v121
v_mfma_f32_16x16x32_bf16 v[100:103], a[204:207], v[36:39], v[216:219]
v_exp_f32 v138, v138
v_mfma_f32_16x16x32_bf16 v[100:103], a[200:203], v[32:35], v[100:103]
v_exp_f32 v139, v139
v_mfma_f32_16x16x32_bf16 v[100:103], a[196:199], v[28:31], v[100:103]
v_exp_f32 v140, v140
v_mfma_f32_16x16x32_bf16 v[100:103], a[192:195], v[24:27], v[100:103]
ds_read_b128 a[144:147], v3 offset:16384
v_cvt_pk_bf16_f32 v201, v122, v123
v_mfma_f32_16x16x32_bf16 a[128:131], a[244:247], v[152:155], 0
ds_read_b128 a[148:151], v3 offset:24576
v_cvt_pk_bf16_f32 v208, v136, v137
v_mfma_f32_16x16x32_bf16 a[128:131], a[244:247], v[156:159], a[128:131]
v_exp_f32 v141, v141
v_mfma_f32_16x16x32_bf16 a[132:135], a[244:247], v[160:163], 0
v_exp_f32 v142, v142
v_mfma_f32_16x16x32_bf16 a[132:135], a[244:247], v[164:167], a[132:135]
v_exp_f32 v143, v143
v_mfma_f32_16x16x32_bf16 a[136:139], a[244:247], v[184:187], 0
buffer_load_dwordx4 v16, s[32:35], s64 offen offset:2048 sc1 lds
v_mfma_f32_16x16x32_bf16 a[136:139], a[244:247], v[188:191], a[136:139]
v_exp_f32 v124, v124
v_mfma_f32_16x16x32_bf16 a[140:143], a[244:247], v[192:195], 0
v_exp_f32 v125, v125
v_mfma_f32_16x16x32_bf16 a[140:143], a[244:247], v[196:199], a[140:143]
s_waitcnt lgkmcnt(0)
ds_read_b128 a[152:155], v3 offset:17408
v_cvt_pk_bf16_f32 v209, v138, v139
v_mfma_f32_16x16x32_bf16 a[0:3], a[144:147], v[152:155], 0
v_exp_f32 v126, v126
v_mfma_f32_16x16x32_bf16 a[0:3], a[148:151], v[156:159], a[0:3]
ds_read_b128 a[156:159], v3 offset:25600
v_cvt_pk_bf16_f32 v210, v140, v141
v_mfma_f32_16x16x32_bf16 a[32:35], a[148:151], v[164:167], 0
v_exp_f32 v127, v127
v_mfma_f32_16x16x32_bf16 a[32:35], a[144:147], v[160:163], a[32:35]
v_exp_f32 v108, v108
v_mfma_f32_16x16x32_bf16 a[64:67], a[144:147], v[184:187], 0
v_exp_f32 v109, v109
v_mfma_f32_16x16x32_bf16 a[64:67], a[148:151], v[188:191], a[64:67]
v_cvt_pk_bf16_f32 v211, v142, v143
v_cvt_pk_bf16_f32 v202, v124, v125
v_mfma_f32_16x16x32_bf16 a[96:99], a[148:151], v[196:199], 0
v_exp_f32 v110, v110
v_mfma_f32_16x16x32_bf16 a[96:99], a[144:147], v[192:195], a[96:99]
s_waitcnt lgkmcnt(0)
ds_read_b128 a[160:163], v3 offset:18432
v_cvt_pk_bf16_f32 v203, v126, v127
v_mfma_f32_16x16x32_bf16 a[100:103], a[152:155], v[192:195], 0
v_exp_f32 v111, v111
v_mfma_f32_16x16x32_bf16 a[100:103], a[156:159], v[196:199], a[100:103]
ds_read_b128 a[164:167], v3 offset:26624
v_cvt_pk_bf16_f32 v178, v108, v109
v_mfma_f32_16x16x32_bf16 a[68:71], a[156:159], v[188:191], 0
v_exp_f32 v92, v92
v_mfma_f32_16x16x32_bf16 a[68:71], a[152:155], v[184:187], a[68:71]
v_exp_f32 v93, v93
v_mfma_f32_16x16x32_bf16 a[36:39], a[152:155], v[160:163], 0
v_exp_f32 v94, v94
v_mfma_f32_16x16x32_bf16 a[36:39], a[156:159], v[164:167], a[36:39]
buffer_load_dwordx4 v16, s[32:35], s64 offen offset:3072 sc1 lds
v_mfma_f32_16x16x32_bf16 a[4:7], a[156:159], v[156:159], 0
v_exp_f32 v95, v95
v_mfma_f32_16x16x32_bf16 a[4:7], a[152:155], v[152:155], a[4:7]
s_waitcnt lgkmcnt(0)
v_exp_f32 v96, v96
v_mfma_f32_16x16x32_bf16 a[8:11], a[160:163], v[152:155], 0
ds_read_b128 a[168:171], v3 offset:19456
v_cvt_pk_bf16_f32 v179, v110, v111
v_mfma_f32_16x16x32_bf16 a[8:11], a[164:167], v[156:159], a[8:11]
ds_read_b128 a[172:175], v3 offset:27648
v_exp_f32 v97, v97
v_mfma_f32_16x16x32_bf16 a[40:43], a[164:167], v[164:167], 0
v_exp_f32 v98, v98
v_mfma_f32_16x16x32_bf16 a[40:43], a[160:163], v[160:163], a[40:43]
v_exp_f32 v99, v99
v_mfma_f32_16x16x32_bf16 a[72:75], a[160:163], v[184:187], 0
v_cvt_pk_bf16_f32 v170, v92, v93
v_cvt_pk_bf16_f32 v171, v94, v95
v_mfma_f32_16x16x32_bf16 a[72:75], a[164:167], v[188:191], a[72:75]
v_exp_f32 v112, v112
v_mfma_f32_16x16x32_bf16 a[104:107], a[164:167], v[196:199], 0
v_exp_f32 v113, v113
v_mfma_f32_16x16x32_bf16 a[104:107], a[160:163], v[192:195], a[104:107]
s_waitcnt lgkmcnt(0)
ds_read_b128 a[176:179], v3 offset:20480
v_cvt_pk_bf16_f32 v172, v96, v97
v_mfma_f32_16x16x32_bf16 a[108:111], a[168:171], v[192:195], 0
v_exp_f32 v114, v114
v_mfma_f32_16x16x32_bf16 a[108:111], a[172:175], v[196:199], a[108:111]
ds_read_b128 a[180:183], v3 offset:28672
v_xor_b32 v2, 0x8000, v2
v_mfma_f32_16x16x32_bf16 a[76:79], a[172:175], v[188:191], 0
v_exp_f32 v115, v115
v_mfma_f32_16x16x32_bf16 a[76:79], a[168:171], v[184:187], a[76:79]
ds_read_b128 a[184:187], v3 offset:21504
ds_read_b128 a[188:191], v3 offset:29696
ds_read_b128 a[192:195], v3 offset:22528
ds_read_b128 a[196:199], v3 offset:30720
ds_read_b128 a[200:203], v3 offset:23552
ds_read_b128 a[204:207], v3 offset:31744
v_mfma_f32_16x16x32_bf16 a[44:47], a[168:171], v[160:163], 0
s_waitcnt vmcnt(8)
s_barrier
v_cvt_pk_bf16_f32 v173, v98, v99
v_exp_f32 v128, v128
v_mfma_f32_16x16x32_bf16 a[44:47], a[172:175], v[164:167], a[44:47]
v_exp_f32 v129, v129
v_mfma_f32_16x16x32_bf16 a[12:15], a[172:175], v[156:159], 0
v_exp_f32 v130, v130
v_mfma_f32_16x16x32_bf16 a[12:15], a[168:171], v[152:155], a[12:15]
s_waitcnt lgkmcnt(6)
v_cvt_pk_bf16_f32 v180, v112, v113
v_cvt_pk_bf16_f32 v181, v114, v115
v_mfma_f32_16x16x32_bf16 a[16:19], a[176:179], v[152:155], 0
s_xor_b32 s71, s71, 49152
v_exp_f32 v131, v131
v_mfma_f32_16x16x32_bf16 a[16:19], a[180:183], v[156:159], a[16:19]
s_add_u32 s70, s70, 32768
v_exp_f32 v144, v144
v_mfma_f32_16x16x32_bf16 a[48:51], a[180:183], v[164:167], 0
s_mov_b32 m0, s71
v_exp_f32 v145, v145
v_mfma_f32_16x16x32_bf16 a[48:51], a[176:179], v[160:163], a[48:51]
buffer_load_dwordx4 v16, s[32:35], s70 offen offset:0 sc1 lds
v_mfma_f32_16x16x32_bf16 a[80:83], a[176:179], v[184:187], 0
v_exp_f32 v146, v146
v_mfma_f32_16x16x32_bf16 a[80:83], a[180:183], v[188:191], a[80:83]
v_cvt_pk_bf16_f32 v204, v128, v129
v_cvt_pk_bf16_f32 v205, v130, v131
v_mfma_f32_16x16x32_bf16 a[112:115], a[180:183], v[196:199], 0
v_exp_f32 v147, v147
v_mfma_f32_16x16x32_bf16 a[112:115], a[176:179], v[192:195], a[112:115]
s_waitcnt lgkmcnt(0)
v_exp_f32 v148, v148
v_mfma_f32_16x16x32_bf16 a[116:119], a[184:187], v[192:195], 0
v_exp_f32 v149, v149
v_mfma_f32_16x16x32_bf16 a[116:119], a[188:191], v[196:199], a[116:119]
v_exp_f32 v150, v150
v_mfma_f32_16x16x32_bf16 a[84:87], a[188:191], v[188:191], 0
v_exp_f32 v151, v151
v_mfma_f32_16x16x32_bf16 a[84:87], a[184:187], v[184:187], a[84:87]
v_cvt_pk_bf16_f32 v212, v144, v145
v_cvt_pk_bf16_f32 v213, v146, v147
v_mfma_f32_16x16x32_bf16 a[52:55], a[184:187], v[160:163], 0
v_exp_f32 v132, v132
v_mfma_f32_16x16x32_bf16 a[52:55], a[188:191], v[164:167], a[52:55]
v_exp_f32 v133, v133
v_mfma_f32_16x16x32_bf16 a[20:23], a[188:191], v[156:159], 0
ds_read_b128 a[144:147], v2 offset:0
v_lshl_add_u32 v19, v0, 24, s66
v_mfma_f32_16x16x32_bf16 a[20:23], a[184:187], v[152:155], a[20:23]
s_lshr_b32 s67, s31, 4
v_exp_f32 v134, v134
v_mfma_f32_16x16x32_bf16 a[24:27], a[192:195], v[152:155], 0
s_lshl1_add_u32 s67, s3, s67
v_exp_f32 v135, v135
v_mfma_f32_16x16x32_bf16 a[24:27], a[196:199], v[156:159], a[24:27]
s_lshl_b32 s79, s67, 8
v_cvt_pk_bf16_f32 v214, v148, v149
v_cvt_pk_bf16_f32 v215, v150, v151
v_mfma_f32_16x16x32_bf16 a[56:59], a[196:199], v[164:167], 0
s_add_u32 s79, s79, 8192
v_exp_f32 v116, v116
v_mfma_f32_16x16x32_bf16 a[56:59], a[192:195], v[160:163], a[56:59]
s_add_u32 s69, s31, 12
buffer_load_dwordx4 v16, s[32:35], s70 offen offset:1024 sc1 lds
v_mfma_f32_16x16x32_bf16 a[88:91], a[192:195], v[184:187], 0
s_lshr_b32 s69, s69, 5
v_exp_f32 v117, v117
v_mfma_f32_16x16x32_bf16 a[88:91], a[196:199], v[188:191], a[88:91]
s_lshl1_add_u32 s69, s3, s69
v_exp_f32 v118, v118
v_mfma_f32_16x16x32_bf16 a[120:123], a[196:199], v[196:199], 0
s_lshl_b32 s69, s69, 8
v_exp_f32 v119, v119
v_mfma_f32_16x16x32_bf16 a[120:123], a[192:195], v[192:195], a[120:123]
s_add_u32 s69, s69, 8192
s_add_u32 s17, s78, L_D-L_pc+0
v_cvt_pk_bf16_f32 v206, v132, v133
v_cvt_pk_bf16_f32 v207, v134, v135
v_mfma_f32_16x16x32_bf16 a[124:127], a[200:203], v[192:195], 0
s_lshl_b32 s67, s73, 16
buffer_load_dword a252, v16, s[88:91], s17 offen
v_mfma_f32_16x16x32_bf16 a[124:127], a[204:207], v[196:199], a[124:127]
s_xor_b32 s68, s80, 256
v_exp_f32 v100, v100
v_mfma_f32_16x16x32_bf16 a[92:95], a[204:207], v[188:191], 0
s_add_u32 s68, s68, s67
v_exp_f32 v101, v101
v_mfma_f32_16x16x32_bf16 a[92:95], a[200:203], v[184:187], a[92:95]
s_add_u32 s67, s67, s69
s_add_u32 s17, s78, L_D-L_pc+4096
ds_read_b128 a[148:151], v2 offset:1024
v_cvt_pk_bf16_f32 v182, v116, v117
v_mfma_f32_16x16x32_bf16 a[60:63], a[200:203], v[160:163], 0
buffer_load_dword a252, v16, s[88:91], s17 offen
ds_read_b128 a[152:155], v2 offset:2048
v_exp_f32 v102, v102
v_mfma_f32_16x16x32_bf16 a[60:63], a[204:207], v[164:167], a[60:63]
s_add_u32 s17, s78, L_D-L_pc+8192
ds_read_b128 a[156:159], v2 offset:3072
v_cvt_pk_bf16_f32 v183, v118, v119
v_mfma_f32_16x16x32_bf16 a[28:31], a[204:207], v[156:159], 0
s_mov_b64 exec, 1
buffer_atomic_add a251, v19, s[52:55], s67 offen offset:0 sc1
buffer_atomic_add a251, v19, s[52:55], s68 offen offset:0 sc1
s_mov_b64 exec, -1
v_exp_f32 v103, v103
v_mfma_f32_16x16x32_bf16 a[28:31], a[200:203], v[152:155], a[28:31]
ds_read_b128 a[160:163], v2 offset:4096
buffer_load_dword a252, v16, s[88:91], s17 offen
ds_read_b128 a[164:167], v2 offset:5120
ds_read_b128 a[168:171], v2 offset:6144
ds_read_b128 a[172:175], v2 offset:7168
v_mul_u32_u24 v19, 52, v0
v_cvt_pk_bf16_f32 v174, v100, v101
v_cvt_pk_bf16_f32 v175, v102, v103
v_xor_b32 v3, 0x8000, v3
s_sub_u32 s72, s3, 1
s_cmp_eq_u32 s72, 0
s_cbranch_scc1 L_DD
.p2align 3
L_D:
s_waitcnt lgkmcnt(7)
v_mfma_f32_16x16x32_bf16 v[88:91], a[144:147], v[24:27], v[216:219]
s_waitcnt lgkmcnt(6)
ds_read_b128 a[176:179], v2 offset:8192
v_mfma_f32_16x16x32_bf16 v[88:91], a[148:151], v[28:31], v[88:91]
s_waitcnt lgkmcnt(6)
ds_read_b128 a[180:183], v2 offset:9216
v_mfma_f32_16x16x32_bf16 v[88:91], a[152:155], v[32:35], v[88:91]
s_waitcnt lgkmcnt(6)
buffer_load_dwordx4 v16, s[32:35], s70 offen offset:2048 sc1 lds
v_mfma_f32_16x16x32_bf16 v[88:91], a[156:159], v[36:39], v[88:91]
ds_read_b128 a[184:187], v2 offset:10240
v_mfma_f32_16x16x32_bf16 v[104:107], a[156:159], v[52:55], v[220:223]
v_mfma_f32_16x16x32_bf16 v[104:107], a[152:155], v[48:51], v[104:107]
buffer_load_dword a252, v19, s[40:43], s81 offen
v_mfma_f32_16x16x32_bf16 v[104:107], a[148:151], v[44:47], v[104:107]
ds_read_b128 a[188:191], v2 offset:11264
v_mfma_f32_16x16x32_bf16 v[104:107], a[144:147], v[40:43], v[104:107]
v_mfma_f32_16x16x32_bf16 v[120:123], a[144:147], v[56:59], v[224:227]
v_mfma_f32_16x16x32_bf16 v[120:123], a[148:151], v[60:63], v[120:123]
v_mfma_f32_16x16x32_bf16 v[120:123], a[152:155], v[64:67], v[120:123]
v_exp_f32 v88, v88
v_mfma_f32_16x16x32_bf16 v[120:123], a[156:159], v[68:71], v[120:123]
v_exp_f32 v89, v89
v_mfma_f32_16x16x32_bf16 v[136:139], a[156:159], v[84:87], v[228:231]
v_exp_f32 v90, v90
v_mfma_f32_16x16x32_bf16 v[136:139], a[152:155], v[80:83], v[136:139]
v_exp_f32 v91, v91
v_mfma_f32_16x16x32_bf16 v[136:139], a[148:151], v[76:79], v[136:139]
v_exp_f32 v104, v104
v_mfma_f32_16x16x32_bf16 v[136:139], a[144:147], v[72:75], v[136:139]
s_waitcnt lgkmcnt(0)
s_add_u32 s81, s81, 425984
v_exp_f32 v105, v105
v_mfma_f32_16x16x32_bf16 v[140:143], a[160:163], v[72:75], v[228:231]
v_exp_f32 v106, v106
v_mfma_f32_16x16x32_bf16 v[140:143], a[164:167], v[76:79], v[140:143]
v_exp_f32 v107, v107
v_mfma_f32_16x16x32_bf16 v[140:143], a[168:171], v[80:83], v[140:143]
buffer_load_dwordx4 v16, s[32:35], s70 offen offset:3072 sc1 lds
v_mfma_f32_16x16x32_bf16 v[140:143], a[172:175], v[84:87], v[140:143]
v_cvt_pk_bf16_f32 v152, v88, v89
v_cvt_pk_bf16_f32 v153, v90, v91
v_mfma_f32_16x16x32_bf16 v[124:127], a[172:175], v[68:71], v[224:227]
v_exp_f32 v120, v120
v_mfma_f32_16x16x32_bf16 v[124:127], a[168:171], v[64:67], v[124:127]
v_exp_f32 v121, v121
v_mfma_f32_16x16x32_bf16 v[124:127], a[164:167], v[60:63], v[124:127]
v_exp_f32 v122, v122
v_mfma_f32_16x16x32_bf16 v[124:127], a[160:163], v[56:59], v[124:127]
v_exp_f32 v123, v123
v_mfma_f32_16x16x32_bf16 v[108:111], a[160:163], v[40:43], v[220:223]
v_exp_f32 v136, v136
v_mfma_f32_16x16x32_bf16 v[108:111], a[164:167], v[44:47], v[108:111]
v_exp_f32 v137, v137
v_mfma_f32_16x16x32_bf16 v[108:111], a[168:171], v[48:51], v[108:111]
v_exp_f32 v138, v138
v_mfma_f32_16x16x32_bf16 v[108:111], a[172:175], v[52:55], v[108:111]
v_cvt_pk_bf16_f32 v160, v104, v105
v_cvt_pk_bf16_f32 v161, v106, v107
v_mfma_f32_16x16x32_bf16 v[92:95], a[172:175], v[36:39], v[216:219]
v_exp_f32 v139, v139
v_mfma_f32_16x16x32_bf16 v[92:95], a[168:171], v[32:35], v[92:95]
ds_read_b128 a[192:195], v2 offset:12288
v_cvt_pk_bf16_f32 v184, v120, v121
v_mfma_f32_16x16x32_bf16 v[92:95], a[164:167], v[28:31], v[92:95]
ds_read_b128 a[196:199], v2 offset:13312
v_cvt_pk_bf16_f32 v185, v122, v123
v_mfma_f32_16x16x32_bf16 v[92:95], a[160:163], v[24:27], v[92:95]
v_exp_f32 v140, v140
v_mfma_f32_16x16x32_bf16 v[96:99], a[176:179], v[24:27], v[216:219]
s_add_u32 m0, s71, 4096
ds_read_b128 a[200:203], v2 offset:14336
v_cvt_pk_bf16_f32 v192, v136, v137
v_mfma_f32_16x16x32_bf16 v[96:99], a[180:183], v[28:31], v[96:99]
s_add_u32 s64, s70, 4096
ds_read_b128 a[204:207], v2 offset:15360
v_cvt_pk_bf16_f32 v193, v138, v139
v_mfma_f32_16x16x32_bf16 v[96:99], a[184:187], v[32:35], v[96:99]
buffer_load_dwordx4 v16, s[32:35], s64 offen offset:0 sc1 lds
v_mfma_f32_16x16x32_bf16 v[96:99], a[188:191], v[36:39], v[96:99]
v_exp_f32 v141, v141
v_mfma_f32_16x16x32_bf16 v[112:115], a[188:191], v[52:55], v[220:223]
v_exp_f32 v142, v142
v_mfma_f32_16x16x32_bf16 v[112:115], a[184:187], v[48:51], v[112:115]
v_exp_f32 v143, v143
v_mfma_f32_16x16x32_bf16 v[112:115], a[180:183], v[44:47], v[112:115]
v_exp_f32 v124, v124
v_mfma_f32_16x16x32_bf16 v[112:115], a[176:179], v[40:43], v[112:115]
v_exp_f32 v125, v125
v_mfma_f32_16x16x32_bf16 v[128:131], a[176:179], v[56:59], v[224:227]
v_exp_f32 v126, v126
v_mfma_f32_16x16x32_bf16 v[128:131], a[180:183], v[60:63], v[128:131]
v_exp_f32 v127, v127
v_mfma_f32_16x16x32_bf16 v[128:131], a[184:187], v[64:67], v[128:131]
v_exp_f32 v108, v108
v_mfma_f32_16x16x32_bf16 v[128:131], a[188:191], v[68:71], v[128:131]
v_exp_f32 v109, v109
v_mfma_f32_16x16x32_bf16 v[144:147], a[188:191], v[84:87], v[228:231]
v_exp_f32 v110, v110
v_mfma_f32_16x16x32_bf16 v[144:147], a[184:187], v[80:83], v[144:147]
v_exp_f32 v111, v111
v_mfma_f32_16x16x32_bf16 v[144:147], a[180:183], v[76:79], v[144:147]
ds_read_b128 a[144:147], v3 offset:0
v_cvt_pk_bf16_f32 v194, v140, v141
v_mfma_f32_16x16x32_bf16 v[144:147], a[176:179], v[72:75], v[144:147]
s_waitcnt lgkmcnt(1)
ds_read_b128 a[148:151], v3 offset:8192
v_cvt_pk_bf16_f32 v195, v142, v143
v_mfma_f32_16x16x32_bf16 v[148:151], a[192:195], v[72:75], v[228:231]
v_exp_f32 v92, v92
v_mfma_f32_16x16x32_bf16 v[148:151], a[196:199], v[76:79], v[148:151]
v_exp_f32 v93, v93
v_mfma_f32_16x16x32_bf16 v[148:151], a[200:203], v[80:83], v[148:151]
buffer_load_dwordx4 v16, s[32:35], s64 offen offset:1024 sc1 lds
v_mfma_f32_16x16x32_bf16 v[148:151], a[204:207], v[84:87], v[148:151]
v_exp_f32 v94, v94
v_mfma_f32_16x16x32_bf16 v[132:135], a[204:207], v[68:71], v[224:227]
v_exp_f32 v95, v95
v_mfma_f32_16x16x32_bf16 v[132:135], a[200:203], v[64:67], v[132:135]
ds_read_b128 a[152:155], v3 offset:1024
v_cvt_pk_bf16_f32 v186, v124, v125
v_mfma_f32_16x16x32_bf16 v[132:135], a[196:199], v[60:63], v[132:135]
v_exp_f32 v96, v96
v_mfma_f32_16x16x32_bf16 v[132:135], a[192:195], v[56:59], v[132:135]
ds_read_b128 a[156:159], v3 offset:9216
v_cvt_pk_bf16_f32 v187, v126, v127
v_mfma_f32_16x16x32_bf16 v[116:119], a[192:195], v[40:43], v[220:223]
v_exp_f32 v97, v97
v_mfma_f32_16x16x32_bf16 v[116:119], a[196:199], v[44:47], v[116:119]
v_exp_f32 v98, v98
v_mfma_f32_16x16x32_bf16 v[116:119], a[200:203], v[48:51], v[116:119]
v_exp_f32 v99, v99
v_mfma_f32_16x16x32_bf16 v[116:119], a[204:207], v[52:55], v[116:119]
ds_read_b128 a[160:163], v3 offset:2048
v_cvt_pk_bf16_f32 v162, v108, v109
v_mfma_f32_16x16x32_bf16 v[100:103], a[204:207], v[36:39], v[216:219]
v_exp_f32 v112, v112
v_mfma_f32_16x16x32_bf16 v[100:103], a[200:203], v[32:35], v[100:103]
ds_read_b128 a[164:167], v3 offset:10240
v_cvt_pk_bf16_f32 v163, v110, v111
v_mfma_f32_16x16x32_bf16 v[100:103], a[196:199], v[28:31], v[100:103]
v_exp_f32 v113, v113
v_mfma_f32_16x16x32_bf16 v[100:103], a[192:195], v[24:27], v[100:103]
v_exp_f32 v114, v114
v_mfma_f32_16x16x32_bf16 a[128:131], a[244:247], v[168:171], a[128:131]
v_exp_f32 v115, v115
v_mfma_f32_16x16x32_bf16 a[128:131], a[244:247], v[172:175], a[128:131]
v_exp_f32 v128, v128
v_mfma_f32_16x16x32_bf16 a[132:135], a[244:247], v[176:179], a[132:135]
buffer_load_dwordx4 v16, s[32:35], s64 offen offset:2048 sc1 lds
v_mfma_f32_16x16x32_bf16 a[132:135], a[244:247], v[180:183], a[132:135]
ds_read_b128 a[168:171], v3 offset:3072
v_cvt_pk_bf16_f32 v154, v92, v93
v_mfma_f32_16x16x32_bf16 a[136:139], a[244:247], v[200:203], a[136:139]
ds_read_b128 a[172:175], v3 offset:11264
v_cvt_pk_bf16_f32 v155, v94, v95
v_mfma_f32_16x16x32_bf16 a[136:139], a[244:247], v[204:207], a[136:139]
v_exp_f32 v129, v129
v_mfma_f32_16x16x32_bf16 a[140:143], a[244:247], v[208:211], a[140:143]
v_exp_f32 v130, v130
v_mfma_f32_16x16x32_bf16 a[140:143], a[244:247], v[212:215], a[140:143]
s_waitcnt lgkmcnt(2)
v_exp_f32 v131, v131
v_mfma_f32_16x16x32_bf16 a[0:3], a[144:147], v[168:171], a[0:3]
v_exp_f32 v144, v144
v_mfma_f32_16x16x32_bf16 a[0:3], a[148:151], v[172:175], a[0:3]
ds_read_b128 a[176:179], v3 offset:4096
v_cvt_pk_bf16_f32 v156, v96, v97
v_mfma_f32_16x16x32_bf16 a[32:35], a[148:151], v[180:183], a[32:35]
ds_read_b128 a[180:183], v3 offset:12288
v_cvt_pk_bf16_f32 v157, v98, v99
v_mfma_f32_16x16x32_bf16 a[32:35], a[144:147], v[176:179], a[32:35]
v_exp_f32 v145, v145
v_mfma_f32_16x16x32_bf16 a[64:67], a[144:147], v[200:203], a[64:67]
ds_read_b128 a[184:187], v3 offset:5120
v_cvt_pk_bf16_f32 v164, v112, v113
v_mfma_f32_16x16x32_bf16 a[64:67], a[148:151], v[204:207], a[64:67]
ds_read_b128 a[188:191], v3 offset:13312
v_cvt_pk_bf16_f32 v165, v114, v115
v_mfma_f32_16x16x32_bf16 a[96:99], a[148:151], v[212:215], a[96:99]
ds_read_b128 a[192:195], v3 offset:6144
v_cvt_pk_bf16_f32 v188, v128, v129
v_mfma_f32_16x16x32_bf16 a[96:99], a[144:147], v[208:211], a[96:99]
v_exp_f32 v146, v146
v_mfma_f32_16x16x32_bf16 a[100:103], a[152:155], v[208:211], a[100:103]
v_exp_f32 v147, v147
v_mfma_f32_16x16x32_bf16 a[100:103], a[156:159], v[212:215], a[100:103]
ds_read_b128 a[196:199], v3 offset:14336
v_cvt_pk_bf16_f32 v189, v130, v131
v_mfma_f32_16x16x32_bf16 a[68:71], a[156:159], v[204:207], a[68:71]
buffer_load_dwordx4 v16, s[32:35], s64 offen offset:3072 sc1 lds
v_mfma_f32_16x16x32_bf16 a[68:71], a[152:155], v[200:203], a[68:71]
v_exp_f32 v148, v148
v_mfma_f32_16x16x32_bf16 a[36:39], a[152:155], v[176:179], a[36:39]
v_exp_f32 v149, v149
v_mfma_f32_16x16x32_bf16 a[36:39], a[156:159], v[180:183], a[36:39]
ds_read_b128 a[200:203], v3 offset:7168
v_cvt_pk_bf16_f32 v196, v144, v145
v_mfma_f32_16x16x32_bf16 a[4:7], a[156:159], v[172:175], a[4:7]
v_exp_f32 v150, v150
v_mfma_f32_16x16x32_bf16 a[4:7], a[152:155], v[168:171], a[4:7]
v_exp_f32 v151, v151
v_mfma_f32_16x16x32_bf16 a[8:11], a[160:163], v[168:171], a[8:11]
v_exp_f32 v132, v132
v_mfma_f32_16x16x32_bf16 a[8:11], a[164:167], v[172:175], a[8:11]
ds_read_b128 a[204:207], v3 offset:15360
v_cvt_pk_bf16_f32 v197, v146, v147
v_mfma_f32_16x16x32_bf16 a[40:43], a[164:167], v[180:183], a[40:43]
v_exp_f32 v133, v133
v_mfma_f32_16x16x32_bf16 a[40:43], a[160:163], v[176:179], a[40:43]
v_exp_f32 v134, v134
v_mfma_f32_16x16x32_bf16 a[72:75], a[160:163], v[200:203], a[72:75]
v_exp_f32 v135, v135
v_mfma_f32_16x16x32_bf16 a[72:75], a[164:167], v[204:207], a[72:75]
v_exp_f32 v116, v116
v_mfma_f32_16x16x32_bf16 a[104:107], a[164:167], v[212:215], a[104:107]
v_exp_f32 v117, v117
v_mfma_f32_16x16x32_bf16 a[104:107], a[160:163], v[208:211], a[104:107]
s_waitcnt lgkmcnt(0)
v_exp_f32 v118, v118
v_mfma_f32_16x16x32_bf16 a[108:111], a[168:171], v[208:211], a[108:111]
v_exp_f32 v119, v119
v_mfma_f32_16x16x32_bf16 a[108:111], a[172:175], v[212:215], a[108:111]
v_exp_f32 v100, v100
v_mfma_f32_16x16x32_bf16 a[76:79], a[172:175], v[204:207], a[76:79]
v_exp_f32 v101, v101
v_mfma_f32_16x16x32_bf16 a[76:79], a[168:171], v[200:203], a[76:79]
v_exp_f32 v102, v102
v_mfma_f32_16x16x32_bf16 a[44:47], a[168:171], v[176:179], a[44:47]
s_waitcnt vmcnt(9)
s_barrier
v_mfma_f32_16x16x32_bf16 a[44:47], a[172:175], v[180:183], a[44:47]
s_xor_b32 s71, s71, 16384
ds_read_b128 a[144:147], v2 offset:16384
v_cvt_pk_bf16_f32 v198, v148, v149
v_mfma_f32_16x16x32_bf16 a[12:15], a[172:175], v[172:175], a[12:15]
s_add_u32 s70, s70, 32768
ds_read_b128 a[148:151], v2 offset:17408
v_cvt_pk_bf16_f32 v199, v150, v151
v_mfma_f32_16x16x32_bf16 a[12:15], a[168:171], v[168:171], a[12:15]
s_mov_b32 m0, s71
ds_read_b128 a[152:155], v2 offset:18432
v_cvt_pk_bf16_f32 v190, v132, v133
v_mfma_f32_16x16x32_bf16 a[16:19], a[176:179], v[168:171], a[16:19]
buffer_load_dwordx4 v16, s[32:35], s70 offen offset:0 sc1 lds
v_mfma_f32_16x16x32_bf16 a[16:19], a[180:183], v[172:175], a[16:19]
ds_read_b128 a[156:159], v2 offset:19456
v_cvt_pk_bf16_f32 v191, v134, v135
v_mfma_f32_16x16x32_bf16 a[48:51], a[180:183], v[180:183], a[48:51]
v_exp_f32 v103, v103
v_mfma_f32_16x16x32_bf16 a[48:51], a[176:179], v[176:179], a[48:51]
ds_read_b128 a[160:163], v2 offset:20480
v_cvt_pk_bf16_f32 v166, v116, v117
v_mfma_f32_16x16x32_bf16 a[80:83], a[176:179], v[200:203], a[80:83]
ds_read_b128 a[164:167], v2 offset:21504
v_cvt_pk_bf16_f32 v167, v118, v119
v_mfma_f32_16x16x32_bf16 a[80:83], a[180:183], v[204:207], a[80:83]
ds_read_b128 a[168:171], v2 offset:22528
v_cvt_pk_bf16_f32 v158, v100, v101
v_mfma_f32_16x16x32_bf16 a[112:115], a[180:183], v[212:215], a[112:115]
ds_read_b128 a[172:175], v2 offset:23552
v_cvt_pk_bf16_f32 v159, v102, v103
v_mfma_f32_16x16x32_bf16 a[112:115], a[176:179], v[208:211], a[112:115]
v_mfma_f32_16x16x32_bf16 a[116:119], a[184:187], v[208:211], a[116:119]
v_mfma_f32_16x16x32_bf16 a[116:119], a[188:191], v[212:215], a[116:119]
v_mfma_f32_16x16x32_bf16 a[84:87], a[188:191], v[204:207], a[84:87]
v_mfma_f32_16x16x32_bf16 a[84:87], a[184:187], v[200:203], a[84:87]
v_mfma_f32_16x16x32_bf16 a[52:55], a[184:187], v[176:179], a[52:55]
v_mfma_f32_16x16x32_bf16 a[52:55], a[188:191], v[180:183], a[52:55]
v_mfma_f32_16x16x32_bf16 a[20:23], a[188:191], v[172:175], a[20:23]
v_mfma_f32_16x16x32_bf16 a[20:23], a[184:187], v[168:171], a[20:23]
v_mfma_f32_16x16x32_bf16 a[24:27], a[192:195], v[168:171], a[24:27]
buffer_load_dwordx4 v16, s[32:35], s70 offen offset:1024 sc1 lds
v_mfma_f32_16x16x32_bf16 a[24:27], a[196:199], v[172:175], a[24:27]
v_mfma_f32_16x16x32_bf16 a[56:59], a[196:199], v[180:183], a[56:59]
v_mfma_f32_16x16x32_bf16 a[56:59], a[192:195], v[176:179], a[56:59]
v_mfma_f32_16x16x32_bf16 a[88:91], a[192:195], v[200:203], a[88:91]
v_mfma_f32_16x16x32_bf16 a[88:91], a[196:199], v[204:207], a[88:91]
v_mfma_f32_16x16x32_bf16 a[120:123], a[196:199], v[212:215], a[120:123]
v_mfma_f32_16x16x32_bf16 a[120:123], a[192:195], v[208:211], a[120:123]
v_mfma_f32_16x16x32_bf16 a[124:127], a[200:203], v[208:211], a[124:127]
v_mfma_f32_16x16x32_bf16 a[124:127], a[204:207], v[212:215], a[124:127]
v_mfma_f32_16x16x32_bf16 a[92:95], a[204:207], v[204:207], a[92:95]
v_mfma_f32_16x16x32_bf16 a[92:95], a[200:203], v[200:203], a[92:95]
v_mfma_f32_16x16x32_bf16 a[60:63], a[200:203], v[176:179], a[60:63]
v_mfma_f32_16x16x32_bf16 a[60:63], a[204:207], v[180:183], a[60:63]
v_mfma_f32_16x16x32_bf16 a[28:31], a[204:207], v[172:175], a[28:31]
v_mfma_f32_16x16x32_bf16 a[28:31], a[200:203], v[168:171], a[28:31]
s_waitcnt lgkmcnt(0)
v_mfma_f32_16x16x32_bf16 v[88:91], a[144:147], v[24:27], v[216:219]
ds_read_b128 a[176:179], v2 offset:24576
v_mfma_f32_16x16x32_bf16 v[88:91], a[148:151], v[28:31], v[88:91]
ds_read_b128 a[180:183], v2 offset:25600
v_mfma_f32_16x16x32_bf16 v[88:91], a[152:155], v[32:35], v[88:91]
buffer_load_dwordx4 v16, s[32:35], s70 offen offset:2048 sc1 lds
v_mfma_f32_16x16x32_bf16 v[88:91], a[156:159], v[36:39], v[88:91]
ds_read_b128 a[184:187], v2 offset:26624
v_mfma_f32_16x16x32_bf16 v[104:107], a[156:159], v[52:55], v[220:223]
v_mfma_f32_16x16x32_bf16 v[104:107], a[152:155], v[48:51], v[104:107]
v_mfma_f32_16x16x32_bf16 v[104:107], a[148:151], v[44:47], v[104:107]
ds_read_b128 a[188:191], v2 offset:27648
v_mfma_f32_16x16x32_bf16 v[104:107], a[144:147], v[40:43], v[104:107]
v_mfma_f32_16x16x32_bf16 v[120:123], a[144:147], v[56:59], v[224:227]
v_mfma_f32_16x16x32_bf16 v[120:123], a[148:151], v[60:63], v[120:123]
v_mfma_f32_16x16x32_bf16 v[120:123], a[152:155], v[64:67], v[120:123]
v_exp_f32 v88, v88
v_mfma_f32_16x16x32_bf16 v[120:123], a[156:159], v[68:71], v[120:123]
v_exp_f32 v89, v89
v_mfma_f32_16x16x32_bf16 v[136:139], a[156:159], v[84:87], v[228:231]
v_exp_f32 v90, v90
v_mfma_f32_16x16x32_bf16 v[136:139], a[152:155], v[80:83], v[136:139]
v_exp_f32 v91, v91
v_mfma_f32_16x16x32_bf16 v[136:139], a[148:151], v[76:79], v[136:139]
v_exp_f32 v104, v104
v_mfma_f32_16x16x32_bf16 v[136:139], a[144:147], v[72:75], v[136:139]
v_exp_f32 v105, v105
v_mfma_f32_16x16x32_bf16 v[140:143], a[160:163], v[72:75], v[228:231]
v_exp_f32 v106, v106
v_mfma_f32_16x16x32_bf16 v[140:143], a[164:167], v[76:79], v[140:143]
v_exp_f32 v107, v107
v_mfma_f32_16x16x32_bf16 v[140:143], a[168:171], v[80:83], v[140:143]
buffer_load_dwordx4 v16, s[32:35], s70 offen offset:3072 sc1 lds
v_mfma_f32_16x16x32_bf16 v[140:143], a[172:175], v[84:87], v[140:143]
v_cvt_pk_bf16_f32 v168, v88, v89
v_cvt_pk_bf16_f32 v169, v90, v91
v_mfma_f32_16x16x32_bf16 v[124:127], a[172:175], v[68:71], v[224:227]
v_exp_f32 v120, v120
v_mfma_f32_16x16x32_bf16 v[124:127], a[168:171], v[64:67], v[124:127]
v_exp_f32 v121, v121
v_mfma_f32_16x16x32_bf16 v[124:127], a[164:167], v[60:63], v[124:127]
v_exp_f32 v122, v122
v_mfma_f32_16x16x32_bf16 v[124:127], a[160:163], v[56:59], v[124:127]
v_exp_f32 v123, v123
v_mfma_f32_16x16x32_bf16 v[108:111], a[160:163], v[40:43], v[220:223]
v_exp_f32 v136, v136
v_mfma_f32_16x16x32_bf16 v[108:111], a[164:167], v[44:47], v[108:111]
v_exp_f32 v137, v137
v_mfma_f32_16x16x32_bf16 v[108:111], a[168:171], v[48:51], v[108:111]
v_exp_f32 v138, v138
v_mfma_f32_16x16x32_bf16 v[108:111], a[172:175], v[52:55], v[108:111]
v_cvt_pk_bf16_f32 v176, v104, v105
v_cvt_pk_bf16_f32 v177, v106, v107
v_mfma_f32_16x16x32_bf16 v[92:95], a[172:175], v[36:39], v[216:219]
v_exp_f32 v139, v139
v_mfma_f32_16x16x32_bf16 v[92:95], a[168:171], v[32:35], v[92:95]
ds_read_b128 a[192:195], v2 offset:28672
v_cvt_pk_bf16_f32 v200, v120, v121
v_mfma_f32_16x16x32_bf16 v[92:95], a[164:167], v[28:31], v[92:95]
ds_read_b128 a[196:199], v2 offset:29696
v_cvt_pk_bf16_f32 v201, v122, v123
v_mfma_f32_16x16x32_bf16 v[92:95], a[160:163], v[24:27], v[92:95]
s_waitcnt lgkmcnt(2)
v_exp_f32 v140, v140
v_mfma_f32_16x16x32_bf16 v[96:99], a[176:179], v[24:27], v[216:219]
s_add_u32 m0, s71, 4096
ds_read_b128 a[200:203], v2 offset:30720
v_cvt_pk_bf16_f32 v208, v136, v137
v_mfma_f32_16x16x32_bf16 v[96:99], a[180:183], v[28:31], v[96:99]
s_add_u32 s64, s70, 4096
ds_read_b128 a[204:207], v2 offset:31744
v_cvt_pk_bf16_f32 v209, v138, v139
v_mfma_f32_16x16x32_bf16 v[96:99], a[184:187], v[32:35], v[96:99]
buffer_load_dwordx4 v16, s[32:35], s64 offen offset:0 sc1 lds
v_mfma_f32_16x16x32_bf16 v[96:99], a[188:191], v[36:39], v[96:99]
v_exp_f32 v141, v141
v_mfma_f32_16x16x32_bf16 v[112:115], a[188:191], v[52:55], v[220:223]
v_exp_f32 v142, v142
v_mfma_f32_16x16x32_bf16 v[112:115], a[184:187], v[48:51], v[112:115]
v_exp_f32 v143, v143
v_mfma_f32_16x16x32_bf16 v[112:115], a[180:183], v[44:47], v[112:115]
v_exp_f32 v124, v124
v_mfma_f32_16x16x32_bf16 v[112:115], a[176:179], v[40:43], v[112:115]
v_exp_f32 v125, v125
v_mfma_f32_16x16x32_bf16 v[128:131], a[176:179], v[56:59], v[224:227]
v_exp_f32 v126, v126
v_mfma_f32_16x16x32_bf16 v[128:131], a[180:183], v[60:63], v[128:131]
v_exp_f32 v127, v127
v_mfma_f32_16x16x32_bf16 v[128:131], a[184:187], v[64:67], v[128:131]
v_exp_f32 v108, v108
v_mfma_f32_16x16x32_bf16 v[128:131], a[188:191], v[68:71], v[128:131]
v_exp_f32 v109, v109
v_mfma_f32_16x16x32_bf16 v[144:147], a[188:191], v[84:87], v[228:231]
v_exp_f32 v110, v110
v_mfma_f32_16x16x32_bf16 v[144:147], a[184:187], v[80:83], v[144:147]
v_exp_f32 v111, v111
v_mfma_f32_16x16x32_bf16 v[144:147], a[180:183], v[76:79], v[144:147]
ds_read_b128 a[144:147], v3 offset:16384
v_cvt_pk_bf16_f32 v210, v140, v141
v_mfma_f32_16x16x32_bf16 v[144:147], a[176:179], v[72:75], v[144:147]
s_waitcnt lgkmcnt(1)
ds_read_b128 a[148:151], v3 offset:24576
v_cvt_pk_bf16_f32 v211, v142, v143
v_mfma_f32_16x16x32_bf16 v[148:151], a[192:195], v[72:75], v[228:231]
v_exp_f32 v92, v92
v_mfma_f32_16x16x32_bf16 v[148:151], a[196:199], v[76:79], v[148:151]
v_exp_f32 v93, v93
v_mfma_f32_16x16x32_bf16 v[148:151], a[200:203], v[80:83], v[148:151]
buffer_load_dwordx4 v16, s[32:35], s64 offen offset:1024 sc1 lds
v_mfma_f32_16x16x32_bf16 v[148:151], a[204:207], v[84:87], v[148:151]
v_exp_f32 v94, v94
v_mfma_f32_16x16x32_bf16 v[132:135], a[204:207], v[68:71], v[224:227]
v_exp_f32 v95, v95
v_mfma_f32_16x16x32_bf16 v[132:135], a[200:203], v[64:67], v[132:135]
ds_read_b128 a[152:155], v3 offset:17408
v_cvt_pk_bf16_f32 v202, v124, v125
v_mfma_f32_16x16x32_bf16 v[132:135], a[196:199], v[60:63], v[132:135]
v_exp_f32 v96, v96
v_mfma_f32_16x16x32_bf16 v[132:135], a[192:195], v[56:59], v[132:135]
ds_read_b128 a[156:159], v3 offset:25600
v_cvt_pk_bf16_f32 v203, v126, v127
v_mfma_f32_16x16x32_bf16 v[116:119], a[192:195], v[40:43], v[220:223]
v_exp_f32 v97, v97
v_mfma_f32_16x16x32_bf16 v[116:119], a[196:199], v[44:47], v[116:119]
v_exp_f32 v98, v98
v_mfma_f32_16x16x32_bf16 v[116:119], a[200:203], v[48:51], v[116:119]
v_exp_f32 v99, v99
v_mfma_f32_16x16x32_bf16 v[116:119], a[204:207], v[52:55], v[116:119]
ds_read_b128 a[160:163], v3 offset:18432
v_cvt_pk_bf16_f32 v178, v108, v109
v_mfma_f32_16x16x32_bf16 v[100:103], a[204:207], v[36:39], v[216:219]
v_exp_f32 v112, v112
v_mfma_f32_16x16x32_bf16 v[100:103], a[200:203], v[32:35], v[100:103]
ds_read_b128 a[164:167], v3 offset:26624
v_cvt_pk_bf16_f32 v179, v110, v111
v_mfma_f32_16x16x32_bf16 v[100:103], a[196:199], v[28:31], v[100:103]
v_exp_f32 v113, v113
v_mfma_f32_16x16x32_bf16 v[100:103], a[192:195], v[24:27], v[100:103]
v_exp_f32 v114, v114
v_mfma_f32_16x16x32_bf16 a[128:131], a[244:247], v[152:155], a[128:131]
v_exp_f32 v115, v115
v_mfma_f32_16x16x32_bf16 a[128:131], a[244:247], v[156:159], a[128:131]
v_exp_f32 v128, v128
v_mfma_f32_16x16x32_bf16 a[132:135], a[244:247], v[160:163], a[132:135]
buffer_load_dwordx4 v16, s[32:35], s64 offen offset:2048 sc1 lds
v_mfma_f32_16x16x32_bf16 a[132:135], a[244:247], v[164:167], a[132:135]
ds_read_b128 a[168:171], v3 offset:19456
v_cvt_pk_bf16_f32 v170, v92, v93
v_mfma_f32_16x16x32_bf16 a[136:139], a[244:247], v[184:187], a[136:139]
ds_read_b128 a[172:175], v3 offset:27648
v_cvt_pk_bf16_f32 v171, v94, v95
v_mfma_f32_16x16x32_bf16 a[136:139], a[244:247], v[188:191], a[136:139]
v_exp_f32 v129, v129
v_mfma_f32_16x16x32_bf16 a[140:143], a[244:247], v[192:195], a[140:143]
v_exp_f32 v130, v130
v_mfma_f32_16x16x32_bf16 a[140:143], a[244:247], v[196:199], a[140:143]
s_waitcnt lgkmcnt(2)
v_exp_f32 v131, v131
v_mfma_f32_16x16x32_bf16 a[0:3], a[144:147], v[152:155], a[0:3]
v_exp_f32 v144, v144
v_mfma_f32_16x16x32_bf16 a[0:3], a[148:151], v[156:159], a[0:3]
ds_read_b128 a[176:179], v3 offset:20480
v_cvt_pk_bf16_f32 v172, v96, v97
v_mfma_f32_16x16x32_bf16 a[32:35], a[148:151], v[164:167], a[32:35]
ds_read_b128 a[180:183], v3 offset:28672
v_cvt_pk_bf16_f32 v173, v98, v99
v_mfma_f32_16x16x32_bf16 a[32:35], a[144:147], v[160:163], a[32:35]
v_exp_f32 v145, v145
v_mfma_f32_16x16x32_bf16 a[64:67], a[144:147], v[184:187], a[64:67]
ds_read_b128 a[184:187], v3 offset:21504
v_xor_b32 v2, 0x8000, v2
v_mfma_f32_16x16x32_bf16 a[64:67], a[148:151], v[188:191], a[64:67]
ds_read_b128 a[188:191], v3 offset:29696
v_cvt_pk_bf16_f32 v180, v112, v113
v_mfma_f32_16x16x32_bf16 a[96:99], a[148:151], v[196:199], a[96:99]
ds_read_b128 a[192:195], v3 offset:22528
v_cvt_pk_bf16_f32 v181, v114, v115
v_mfma_f32_16x16x32_bf16 a[96:99], a[144:147], v[192:195], a[96:99]
v_exp_f32 v146, v146
v_mfma_f32_16x16x32_bf16 a[100:103], a[152:155], v[192:195], a[100:103]
v_exp_f32 v147, v147
v_mfma_f32_16x16x32_bf16 a[100:103], a[156:159], v[196:199], a[100:103]
ds_read_b128 a[196:199], v3 offset:30720
v_cvt_pk_bf16_f32 v204, v128, v129
v_mfma_f32_16x16x32_bf16 a[68:71], a[156:159], v[188:191], a[68:71]
buffer_load_dwordx4 v16, s[32:35], s64 offen offset:3072 sc1 lds
v_mfma_f32_16x16x32_bf16 a[68:71], a[152:155], v[184:187], a[68:71]
v_exp_f32 v148, v148
v_mfma_f32_16x16x32_bf16 a[36:39], a[152:155], v[160:163], a[36:39]
v_exp_f32 v149, v149
v_mfma_f32_16x16x32_bf16 a[36:39], a[156:159], v[164:167], a[36:39]
ds_read_b128 a[200:203], v3 offset:23552
v_cvt_pk_bf16_f32 v205, v130, v131
v_mfma_f32_16x16x32_bf16 a[4:7], a[156:159], v[156:159], a[4:7]
v_exp_f32 v150, v150
v_mfma_f32_16x16x32_bf16 a[4:7], a[152:155], v[152:155], a[4:7]
v_exp_f32 v151, v151
v_mfma_f32_16x16x32_bf16 a[8:11], a[160:163], v[152:155], a[8:11]
v_exp_f32 v132, v132
v_mfma_f32_16x16x32_bf16 a[8:11], a[164:167], v[156:159], a[8:11]
ds_read_b128 a[204:207], v3 offset:31744
v_cvt_pk_bf16_f32 v212, v144, v145
v_mfma_f32_16x16x32_bf16 a[40:43], a[164:167], v[164:167], a[40:43]
v_exp_f32 v133, v133
v_mfma_f32_16x16x32_bf16 a[40:43], a[160:163], v[160:163], a[40:43]
v_exp_f32 v134, v134
v_mfma_f32_16x16x32_bf16 a[72:75], a[160:163], v[184:187], a[72:75]
v_exp_f32 v135, v135
v_mfma_f32_16x16x32_bf16 a[72:75], a[164:167], v[188:191], a[72:75]
v_exp_f32 v116, v116
v_mfma_f32_16x16x32_bf16 a[104:107], a[164:167], v[196:199], a[104:107]
v_exp_f32 v117, v117
v_mfma_f32_16x16x32_bf16 a[104:107], a[160:163], v[192:195], a[104:107]
s_waitcnt lgkmcnt(0)
v_exp_f32 v118, v118
v_mfma_f32_16x16x32_bf16 a[108:111], a[168:171], v[192:195], a[108:111]
v_exp_f32 v119, v119
v_mfma_f32_16x16x32_bf16 a[108:111], a[172:175], v[196:199], a[108:111]
v_exp_f32 v100, v100
v_mfma_f32_16x16x32_bf16 a[76:79], a[172:175], v[188:191], a[76:79]
v_exp_f32 v101, v101
v_mfma_f32_16x16x32_bf16 a[76:79], a[168:171], v[184:187], a[76:79]
v_exp_f32 v102, v102
v_mfma_f32_16x16x32_bf16 a[44:47], a[168:171], v[160:163], a[44:47]
s_waitcnt vmcnt(8)
s_barrier
v_mfma_f32_16x16x32_bf16 a[44:47], a[172:175], v[164:167], a[44:47]
s_xor_b32 s71, s71, 49152
ds_read_b128 a[144:147], v2 offset:0
v_cvt_pk_bf16_f32 v213, v146, v147
v_mfma_f32_16x16x32_bf16 a[12:15], a[172:175], v[156:159], a[12:15]
s_add_u32 s70, s70, 32768
ds_read_b128 a[148:151], v2 offset:1024
v_cvt_pk_bf16_f32 v214, v148, v149
v_mfma_f32_16x16x32_bf16 a[12:15], a[168:171], v[152:155], a[12:15]
s_mov_b32 m0, s71
ds_read_b128 a[152:155], v2 offset:2048
v_cvt_pk_bf16_f32 v215, v150, v151
v_mfma_f32_16x16x32_bf16 a[16:19], a[176:179], v[152:155], a[16:19]
buffer_load_dwordx4 v16, s[32:35], s70 offen offset:0 sc1 lds
v_mfma_f32_16x16x32_bf16 a[16:19], a[180:183], v[156:159], a[16:19]
s_add_u32 s17, s78, L_DD-L_pc
ds_read_b128 a[156:159], v2 offset:3072
v_cvt_pk_bf16_f32 v206, v132, v133
v_mfma_f32_16x16x32_bf16 a[48:51], a[180:183], v[164:167], a[48:51]
buffer_load_dword a252, v16, s[88:91], s17 offen
v_mfma_f32_16x16x32_bf16 a[48:51], a[176:179], v[160:163], a[48:51]
v_exp_f32 v103, v103
v_mfma_f32_16x16x32_bf16 a[80:83], a[176:179], v[184:187], a[80:83]
s_add_u32 s17, s78, L_DD-L_pc+4096
ds_read_b128 a[160:163], v2 offset:4096
v_cvt_pk_bf16_f32 v207, v134, v135
v_mfma_f32_16x16x32_bf16 a[80:83], a[180:183], v[188:191], a[80:83]
buffer_load_dword a252, v16, s[88:91], s17 offen
v_mfma_f32_16x16x32_bf16 a[112:115], a[180:183], v[196:199], a[112:115]
ds_read_b128 a[164:167], v2 offset:5120
v_cvt_pk_bf16_f32 v182, v116, v117
v_mfma_f32_16x16x32_bf16 a[112:115], a[176:179], v[192:195], a[112:115]
ds_read_b128 a[168:171], v2 offset:6144
v_xor_b32 v3, 0x8000, v3
v_mfma_f32_16x16x32_bf16 a[116:119], a[184:187], v[192:195], a[116:119]
ds_read_b128 a[172:175], v2 offset:7168
v_cvt_pk_bf16_f32 v183, v118, v119
v_mfma_f32_16x16x32_bf16 a[116:119], a[188:191], v[196:199], a[116:119]
v_cvt_pk_bf16_f32 v174, v100, v101
v_cvt_pk_bf16_f32 v175, v102, v103
v_mfma_f32_16x16x32_bf16 a[84:87], a[188:191], v[188:191], a[84:87]
v_mfma_f32_16x16x32_bf16 a[84:87], a[184:187], v[184:187], a[84:87]
v_mfma_f32_16x16x32_bf16 a[52:55], a[184:187], v[160:163], a[52:55]
v_mfma_f32_16x16x32_bf16 a[52:55], a[188:191], v[164:167], a[52:55]
v_mfma_f32_16x16x32_bf16 a[20:23], a[188:191], v[156:159], a[20:23]
v_mfma_f32_16x16x32_bf16 a[20:23], a[184:187], v[152:155], a[20:23]
v_mfma_f32_16x16x32_bf16 a[24:27], a[192:195], v[152:155], a[24:27]
buffer_load_dwordx4 v16, s[32:35], s70 offen offset:1024 sc1 lds
v_mfma_f32_16x16x32_bf16 a[24:27], a[196:199], v[156:159], a[24:27]
v_mfma_f32_16x16x32_bf16 a[56:59], a[196:199], v[164:167], a[56:59]
v_mfma_f32_16x16x32_bf16 a[56:59], a[192:195], v[160:163], a[56:59]
v_mfma_f32_16x16x32_bf16 a[88:91], a[192:195], v[184:187], a[88:91]
v_mfma_f32_16x16x32_bf16 a[88:91], a[196:199], v[188:191], a[88:91]
s_sub_u32 s72, s72, 1
v_mfma_f32_16x16x32_bf16 a[120:123], a[196:199], v[196:199], a[120:123]
v_mfma_f32_16x16x32_bf16 a[120:123], a[192:195], v[192:195], a[120:123]
v_mfma_f32_16x16x32_bf16 a[124:127], a[200:203], v[192:195], a[124:127]
v_mfma_f32_16x16x32_bf16 a[124:127], a[204:207], v[196:199], a[124:127]
s_cmp_lg_u32 s72, 0
v_mfma_f32_16x16x32_bf16 a[92:95], a[204:207], v[188:191], a[92:95]
v_mfma_f32_16x16x32_bf16 a[92:95], a[200:203], v[184:187], a[92:95]
v_mfma_f32_16x16x32_bf16 a[60:63], a[200:203], v[160:163], a[60:63]
v_mfma_f32_16x16x32_bf16 a[60:63], a[204:207], v[164:167], a[60:63]
v_mfma_f32_16x16x32_bf16 a[28:31], a[204:207], v[156:159], a[28:31]
v_mfma_f32_16x16x32_bf16 a[28:31], a[200:203], v[152:155], a[28:31]
s_cbranch_scc1 L_D
L_DD:
s_waitcnt lgkmcnt(7)
v_mfma_f32_16x16x32_bf16 v[104:107], a[144:147], v[40:43], v[220:223]
s_waitcnt lgkmcnt(6)
ds_read_b128 a[176:179], v2 offset:8192
v_cndmask_b32 v88, v216, v17, s[0:1]
v_mfma_f32_16x16x32_bf16 v[104:107], a[148:151], v[44:47], v[104:107]
s_waitcnt lgkmcnt(6)
ds_read_b128 a[180:183], v2 offset:9216
v_cndmask_b32 v89, v216, v17, s[4:5]
v_mfma_f32_16x16x32_bf16 v[104:107], a[152:155], v[48:51], v[104:107]
s_waitcnt lgkmcnt(6)
buffer_load_dwordx4 v16, s[32:35], s70 offen offset:2048 sc1 lds
v_mfma_f32_16x16x32_bf16 v[104:107], a[156:159], v[52:55], v[104:107]
ds_read_b128 a[184:187], v2 offset:10240
v_cndmask_b32 v90, v216, v17, s[6:7]
v_mfma_f32_16x16x32_bf16 v[120:123], a[156:159], v[68:71], v[224:227]
ds_read_b128 a[188:191], v2 offset:11264
v_cndmask_b32 v91, v216, v17, s[8:9]
v_mfma_f32_16x16x32_bf16 v[120:123], a[152:155], v[64:67], v[120:123]
ds_read_b128 a[192:195], v2 offset:12288
v_cndmask_b32 v92, v216, v17, s[10:11]
v_mfma_f32_16x16x32_bf16 v[120:123], a[148:151], v[60:63], v[120:123]
ds_read_b128 a[196:199], v2 offset:13312
v_cndmask_b32 v93, v216, v17, s[12:13]
v_mfma_f32_16x16x32_bf16 v[120:123], a[144:147], v[56:59], v[120:123]
ds_read_b128 a[200:203], v2 offset:14336
v_cndmask_b32 v94, v216, v17, s[18:19]
v_mfma_f32_16x16x32_bf16 v[136:139], a[144:147], v[72:75], v[228:231]
ds_read_b128 a[204:207], v2 offset:15360
v_cndmask_b32 v95, v216, v17, s[22:23]
v_mfma_f32_16x16x32_bf16 v[136:139], a[148:151], v[76:79], v[136:139]
v_cndmask_b32 v96, v216, v17, s[26:27]
v_cndmask_b32 v97, v216, v17, s[56:57]
v_mfma_f32_16x16x32_bf16 v[136:139], a[152:155], v[80:83], v[136:139]
v_exp_f32 v104, v104
v_mfma_f32_16x16x32_bf16 v[136:139], a[156:159], v[84:87], v[136:139]
v_exp_f32 v105, v105
v_mfma_f32_16x16x32_bf16 v[88:91], a[156:159], v[36:39], v[88:91]
v_exp_f32 v106, v106
v_mfma_f32_16x16x32_bf16 v[88:91], a[152:155], v[32:35], v[88:91]
v_exp_f32 v107, v107
v_mfma_f32_16x16x32_bf16 v[88:91], a[148:151], v[28:31], v[88:91]
v_exp_f32 v120, v120
v_mfma_f32_16x16x32_bf16 v[88:91], a[144:147], v[24:27], v[88:91]
s_waitcnt lgkmcnt(0)
v_exp_f32 v121, v121
v_mfma_f32_16x16x32_bf16 v[140:143], a[160:163], v[72:75], v[228:231]
v_exp_f32 v122, v122
v_mfma_f32_16x16x32_bf16 v[140:143], a[164:167], v[76:79], v[140:143]
v_exp_f32 v123, v123
v_mfma_f32_16x16x32_bf16 v[140:143], a[168:171], v[80:83], v[140:143]
buffer_load_dwordx4 v16, s[32:35], s70 offen offset:3072 sc1 lds
v_mfma_f32_16x16x32_bf16 v[140:143], a[172:175], v[84:87], v[140:143]
s_add_u32 m0, s86, 131072
v_cvt_pk_bf16_f32 v160, v104, v105
v_cvt_pk_bf16_f32 v161, v106, v107
v_mfma_f32_16x16x32_bf16 v[124:127], a[172:175], v[68:71], v[224:227]
s_add_u32 s64, s85, 0
v_exp_f32 v136, v136
v_mfma_f32_16x16x32_bf16 v[124:127], a[168:171], v[64:67], v[124:127]
buffer_load_dwordx4 v12, s[36:39], s64 offen lds
v_mfma_f32_16x16x32_bf16 v[124:127], a[164:167], v[60:63], v[124:127]
s_add_u32 m0, s86, 132096
v_exp_f32 v137, v137
v_mfma_f32_16x16x32_bf16 v[124:127], a[160:163], v[56:59], v[124:127]
s_add_u32 s64, s85, 8192
ds_read_b128 a[144:147], v3 offset:0
v_cndmask_b32 v98, v216, v17, s[58:59]
v_mfma_f32_16x16x32_bf16 v[108:111], a[160:163], v[40:43], v[220:223]
buffer_load_dwordx4 v13, s[36:39], s64 offen lds
v_mfma_f32_16x16x32_bf16 v[108:111], a[164:167], v[44:47], v[108:111]
ds_read_b128 a[148:151], v3 offset:8192
v_cndmask_b32 v99, v216, v17, s[60:61]
v_mfma_f32_16x16x32_bf16 v[108:111], a[168:171], v[48:51], v[108:111]
s_add_u32 m0, s86, 133120
v_exp_f32 v138, v138
v_mfma_f32_16x16x32_bf16 v[108:111], a[172:175], v[52:55], v[108:111]
s_add_u32 s64, s85, 16384
v_cvt_pk_bf16_f32 v184, v120, v121
v_cvt_pk_bf16_f32 v185, v122, v123
v_mfma_f32_16x16x32_bf16 v[92:95], a[172:175], v[36:39], v[92:95]
buffer_load_dwordx4 v12, s[36:39], s64 offen lds
v_mfma_f32_16x16x32_bf16 v[92:95], a[168:171], v[32:35], v[92:95]
s_add_u32 m0, s86, 134144
v_exp_f32 v139, v139
v_mfma_f32_16x16x32_bf16 v[92:95], a[164:167], v[28:31], v[92:95]
s_add_u32 s64, s85, 24576
v_exp_f32 v88, v88
v_mfma_f32_16x16x32_bf16 v[92:95], a[160:163], v[24:27], v[92:95]
buffer_load_dwordx4 v13, s[36:39], s64 offen lds
v_mfma_f32_16x16x32_bf16 v[96:99], a[176:179], v[24:27], v[96:99]
s_add_u32 m0, s71, 4096
v_exp_f32 v89, v89
v_mfma_f32_16x16x32_bf16 v[96:99], a[180:183], v[28:31], v[96:99]
s_add_u32 s64, s70, 4096
v_exp_f32 v90, v90
v_mfma_f32_16x16x32_bf16 v[96:99], a[184:187], v[32:35], v[96:99]
buffer_load_dwordx4 v16, s[32:35], s64 offen offset:0 sc1 lds
v_mfma_f32_16x16x32_bf16 v[96:99], a[188:191], v[36:39], v[96:99]
v_cvt_pk_bf16_f32 v192, v136, v137
v_cvt_pk_bf16_f32 v193, v138, v139
v_mfma_f32_16x16x32_bf16 v[112:115], a[188:191], v[52:55], v[220:223]
v_exp_f32 v91, v91
v_mfma_f32_16x16x32_bf16 v[112:115], a[184:187], v[48:51], v[112:115]
v_exp_f32 v140, v140
v_mfma_f32_16x16x32_bf16 v[112:115], a[180:183], v[44:47], v[112:115]
v_exp_f32 v141, v141
v_mfma_f32_16x16x32_bf16 v[112:115], a[176:179], v[40:43], v[112:115]
v_exp_f32 v142, v142
v_mfma_f32_16x16x32_bf16 v[128:131], a[176:179], v[56:59], v[224:227]
v_exp_f32 v143, v143
v_mfma_f32_16x16x32_bf16 v[128:131], a[180:183], v[60:63], v[128:131]
v_exp_f32 v124, v124
v_mfma_f32_16x16x32_bf16 v[128:131], a[184:187], v[64:67], v[128:131]
v_exp_f32 v125, v125
v_mfma_f32_16x16x32_bf16 v[128:131], a[188:191], v[68:71], v[128:131]
v_cvt_pk_bf16_f32 v152, v88, v89
v_cvt_pk_bf16_f32 v153, v90, v91
v_mfma_f32_16x16x32_bf16 v[144:147], a[188:191], v[84:87], v[228:231]
v_exp_f32 v126, v126
v_mfma_f32_16x16x32_bf16 v[144:147], a[184:187], v[80:83], v[144:147]
v_exp_f32 v127, v127
v_mfma_f32_16x16x32_bf16 v[144:147], a[180:183], v[76:79], v[144:147]
ds_read_b128 a[152:155], v3 offset:1024
v_cndmask_b32 v100, v216, v17, s[62:63]
v_mfma_f32_16x16x32_bf16 v[144:147], a[176:179], v[72:75], v[144:147]
ds_read_b128 a[156:159], v3 offset:9216
v_cndmask_b32 v101, v216, v17, s[48:49]
v_mfma_f32_16x16x32_bf16 v[148:151], a[192:195], v[72:75], v[228:231]
ds_read_b128 a[160:163], v3 offset:2048
v_cndmask_b32 v102, v216, v17, s[50:51]
v_mfma_f32_16x16x32_bf16 v[148:151], a[196:199], v[76:79], v[148:151]
ds_read_b128 a[164:167], v3 offset:10240
v_cndmask_b32 v103, v216, v17, s[100:101]
v_mfma_f32_16x16x32_bf16 v[148:151], a[200:203], v[80:83], v[148:151]
buffer_load_dwordx4 v16, s[32:35], s64 offen offset:1024 sc1 lds
v_mfma_f32_16x16x32_bf16 v[148:151], a[204:207], v[84:87], v[148:151]
v_cvt_pk_bf16_f32 v194, v140, v141
v_cvt_pk_bf16_f32 v195, v142, v143
v_mfma_f32_16x16x32_bf16 v[132:135], a[204:207], v[68:71], v[224:227]
v_exp_f32 v108, v108
v_mfma_f32_16x16x32_bf16 v[132:135], a[200:203], v[64:67], v[132:135]
v_exp_f32 v109, v109
v_mfma_f32_16x16x32_bf16 v[132:135], a[196:199], v[60:63], v[132:135]
v_exp_f32 v110, v110
v_mfma_f32_16x16x32_bf16 v[132:135], a[192:195], v[56:59], v[132:135]
v_exp_f32 v111, v111
v_mfma_f32_16x16x32_bf16 v[116:119], a[192:195], v[40:43], v[220:223]
v_exp_f32 v92, v92
v_mfma_f32_16x16x32_bf16 v[116:119], a[196:199], v[44:47], v[116:119]
v_exp_f32 v93, v93
v_mfma_f32_16x16x32_bf16 v[116:119], a[200:203], v[48:51], v[116:119]
v_exp_f32 v94, v94
v_mfma_f32_16x16x32_bf16 v[116:119], a[204:207], v[52:55], v[116:119]
v_cvt_pk_bf16_f32 v186, v124, v125
v_cvt_pk_bf16_f32 v187, v126, v127
v_mfma_f32_16x16x32_bf16 v[100:103], a[204:207], v[36:39], v[100:103]
v_exp_f32 v95, v95
v_mfma_f32_16x16x32_bf16 v[100:103], a[200:203], v[32:35], v[100:103]
v_exp_f32 v96, v96
v_mfma_f32_16x16x32_bf16 v[100:103], a[196:199], v[28:31], v[100:103]
v_exp_f32 v97, v97
v_mfma_f32_16x16x32_bf16 v[100:103], a[192:195], v[24:27], v[100:103]
v_exp_f32 v98, v98
v_mfma_f32_16x16x32_bf16 a[128:131], a[244:247], v[168:171], a[128:131]
v_exp_f32 v99, v99
v_mfma_f32_16x16x32_bf16 a[128:131], a[244:247], v[172:175], a[128:131]
v_exp_f32 v112, v112
v_mfma_f32_16x16x32_bf16 a[132:135], a[244:247], v[176:179], a[132:135]
buffer_load_dwordx4 v16, s[32:35], s64 offen offset:2048 sc1 lds
v_mfma_f32_16x16x32_bf16 a[132:135], a[244:247], v[180:183], a[132:135]
v_cvt_pk_bf16_f32 v162, v108, v109
v_cvt_pk_bf16_f32 v163, v110, v111
v_mfma_f32_16x16x32_bf16 a[136:139], a[244:247], v[200:203], a[136:139]
v_exp_f32 v113, v113
v_mfma_f32_16x16x32_bf16 a[136:139], a[244:247], v[204:207], a[136:139]
v_exp_f32 v114, v114
v_mfma_f32_16x16x32_bf16 a[140:143], a[244:247], v[208:211], a[140:143]
v_exp_f32 v115, v115
v_mfma_f32_16x16x32_bf16 a[140:143], a[244:247], v[212:215], a[140:143]
s_waitcnt lgkmcnt(0)
v_exp_f32 v128, v128
v_mfma_f32_16x16x32_bf16 a[0:3], a[144:147], v[168:171], a[0:3]
ds_read_b128 a[168:171], v3 offset:3072
v_cvt_pk_bf16_f32 v154, v92, v93
v_mfma_f32_16x16x32_bf16 a[0:3], a[148:151], v[172:175], a[0:3]
ds_read_b128 a[172:175], v3 offset:11264
v_cvt_pk_bf16_f32 v155, v94, v95
v_mfma_f32_16x16x32_bf16 a[32:35], a[148:151], v[180:183], a[32:35]
v_exp_f32 v129, v129
v_mfma_f32_16x16x32_bf16 a[32:35], a[144:147], v[176:179], a[32:35]
v_exp_f32 v130, v130
v_mfma_f32_16x16x32_bf16 a[64:67], a[144:147], v[200:203], a[64:67]
v_exp_f32 v131, v131
v_mfma_f32_16x16x32_bf16 a[64:67], a[148:151], v[204:207], a[64:67]
v_exp_f32 v144, v144
v_mfma_f32_16x16x32_bf16 a[96:99], a[148:151], v[212:215], a[96:99]
ds_read_b128 a[176:179], v3 offset:4096
v_cvt_pk_bf16_f32 v156, v96, v97
v_mfma_f32_16x16x32_bf16 a[96:99], a[144:147], v[208:211], a[96:99]
ds_read_b128 a[180:183], v3 offset:12288
v_cvt_pk_bf16_f32 v157, v98, v99
v_mfma_f32_16x16x32_bf16 a[100:103], a[152:155], v[208:211], a[100:103]
v_exp_f32 v145, v145
v_mfma_f32_16x16x32_bf16 a[100:103], a[156:159], v[212:215], a[100:103]
ds_read_b128 a[184:187], v3 offset:5120
v_cvt_pk_bf16_f32 v164, v112, v113
v_mfma_f32_16x16x32_bf16 a[68:71], a[156:159], v[204:207], a[68:71]
buffer_load_dwordx4 v16, s[32:35], s64 offen offset:3072 sc1 lds
v_mfma_f32_16x16x32_bf16 a[68:71], a[152:155], v[200:203], a[68:71]
s_add_u32 m0, s86, 135168
ds_read_b128 a[188:191], v3 offset:13312
v_cvt_pk_bf16_f32 v165, v114, v115
v_mfma_f32_16x16x32_bf16 a[36:39], a[152:155], v[176:179], a[36:39]
s_add_u32 s64, s85, 32768
ds_read_b128 a[192:195], v3 offset:6144
v_cvt_pk_bf16_f32 v188, v128, v129
v_mfma_f32_16x16x32_bf16 a[36:39], a[156:159], v[180:183], a[36:39]
buffer_load_dwordx4 v12, s[36:39], s64 offen lds
v_mfma_f32_16x16x32_bf16 a[4:7], a[156:159], v[172:175], a[4:7]
s_add_u32 m0, s86, 136192
ds_read_b128 a[196:199], v3 offset:14336
v_cvt_pk_bf16_f32 v189, v130, v131
v_mfma_f32_16x16x32_bf16 a[4:7], a[152:155], v[168:171], a[4:7]
s_add_u32 s64, s85, 40960
ds_read_b128 a[200:203], v3 offset:7168
v_cvt_pk_bf16_f32 v196, v144, v145
v_mfma_f32_16x16x32_bf16 a[8:11], a[160:163], v[168:171], a[8:11]
buffer_load_dwordx4 v13, s[36:39], s64 offen lds
v_mfma_f32_16x16x32_bf16 a[8:11], a[164:167], v[172:175], a[8:11]
s_add_u32 m0, s86, 137216
ds_read_b128 a[204:207], v3 offset:15360
v_mfma_f32_16x16x32_bf16 a[40:43], a[164:167], v[180:183], a[40:43]
s_add_u32 s64, s85, 49152
v_exp_f32 v146, v146
v_mfma_f32_16x16x32_bf16 a[40:43], a[160:163], v[176:179], a[40:43]
buffer_load_dwordx4 v12, s[36:39], s64 offen lds
v_mfma_f32_16x16x32_bf16 a[72:75], a[160:163], v[200:203], a[72:75]
s_add_u32 m0, s86, 138240
v_exp_f32 v147, v147
v_mfma_f32_16x16x32_bf16 a[72:75], a[164:167], v[204:207], a[72:75]
s_add_u32 s64, s85, 57344
v_exp_f32 v148, v148
v_mfma_f32_16x16x32_bf16 a[104:107], a[164:167], v[212:215], a[104:107]
buffer_load_dwordx4 v13, s[36:39], s64 offen lds
v_mfma_f32_16x16x32_bf16 a[104:107], a[160:163], v[208:211], a[104:107]
s_waitcnt lgkmcnt(0)
v_exp_f32 v149, v149
v_mfma_f32_16x16x32_bf16 a[108:111], a[168:171], v[208:211], a[108:111]
v_exp_f32 v150, v150
v_mfma_f32_16x16x32_bf16 a[108:111], a[172:175], v[212:215], a[108:111]
v_exp_f32 v151, v151
v_mfma_f32_16x16x32_bf16 a[76:79], a[172:175], v[204:207], a[76:79]
v_exp_f32 v132, v132
v_mfma_f32_16x16x32_bf16 a[76:79], a[168:171], v[200:203], a[76:79]
v_exp_f32 v133, v133
v_mfma_f32_16x16x32_bf16 a[44:47], a[168:171], v[176:179], a[44:47]
s_waitcnt vmcnt(16)
s_barrier
v_mfma_f32_16x16x32_bf16 a[44:47], a[172:175], v[180:183], a[44:47]
s_xor_b32 s71, s71, 16384
v_exp_f32 v134, v134
v_mfma_f32_16x16x32_bf16 a[12:15], a[172:175], v[172:175], a[12:15]
s_add_u32 s70, s70, 32768
v_exp_f32 v135, v135
v_mfma_f32_16x16x32_bf16 a[12:15], a[168:171], v[168:171], a[12:15]
s_mov_b32 m0, s71
v_exp_f32 v116, v116
v_mfma_f32_16x16x32_bf16 a[16:19], a[176:179], v[168:171], a[16:19]
buffer_load_dwordx4 v16, s[32:35], s70 offen offset:0 sc1 lds
v_mfma_f32_16x16x32_bf16 a[16:19], a[180:183], v[172:175], a[16:19]
v_exp_f32 v117, v117
v_mfma_f32_16x16x32_bf16 a[48:51], a[180:183], v[180:183], a[48:51]
v_exp_f32 v118, v118
v_mfma_f32_16x16x32_bf16 a[48:51], a[176:179], v[176:179], a[48:51]
v_exp_f32 v119, v119
v_mfma_f32_16x16x32_bf16 a[80:83], a[176:179], v[200:203], a[80:83]
v_exp_f32 v100, v100
v_mfma_f32_16x16x32_bf16 a[80:83], a[180:183], v[204:207], a[80:83]
v_exp_f32 v101, v101
v_mfma_f32_16x16x32_bf16 a[112:115], a[180:183], v[212:215], a[112:115]
v_cvt_pk_bf16_f32 v197, v146, v147
v_cvt_pk_bf16_f32 v198, v148, v149
v_mfma_f32_16x16x32_bf16 a[112:115], a[176:179], v[208:211], a[112:115]
ds_read_b128 a[144:147], v2 offset:16384
v_cvt_pk_bf16_f32 v199, v150, v151
v_mfma_f32_16x16x32_bf16 a[116:119], a[184:187], v[208:211], a[116:119]
ds_read_b128 a[148:151], v2 offset:17408
v_cvt_pk_bf16_f32 v190, v132, v133
v_mfma_f32_16x16x32_bf16 a[116:119], a[188:191], v[212:215], a[116:119]
v_exp_f32 v102, v102
v_mfma_f32_16x16x32_bf16 a[84:87], a[188:191], v[204:207], a[84:87]
ds_read_b128 a[152:155], v2 offset:18432
v_cvt_pk_bf16_f32 v191, v134, v135
v_mfma_f32_16x16x32_bf16 a[84:87], a[184:187], v[200:203], a[84:87]
ds_read_b128 a[156:159], v2 offset:19456
v_cvt_pk_bf16_f32 v166, v116, v117
v_mfma_f32_16x16x32_bf16 a[52:55], a[184:187], v[176:179], a[52:55]
v_exp_f32 v103, v103
v_mfma_f32_16x16x32_bf16 a[52:55], a[188:191], v[180:183], a[52:55]
ds_read_b128 a[160:163], v2 offset:20480
v_cvt_pk_bf16_f32 v167, v118, v119
v_mfma_f32_16x16x32_bf16 a[20:23], a[188:191], v[172:175], a[20:23]
ds_read_b128 a[164:167], v2 offset:21504
v_cvt_pk_bf16_f32 v158, v100, v101
v_mfma_f32_16x16x32_bf16 a[20:23], a[184:187], v[168:171], a[20:23]
ds_read_b128 a[168:171], v2 offset:22528
v_cvt_pk_bf16_f32 v159, v102, v103
v_mfma_f32_16x16x32_bf16 a[24:27], a[192:195], v[168:171], a[24:27]
buffer_load_dwordx4 v16, s[32:35], s70 offen offset:1024 sc1 lds
v_mfma_f32_16x16x32_bf16 a[24:27], a[196:199], v[172:175], a[24:27]
ds_read_b128 a[172:175], v2 offset:23552
v_cndmask_b32 v104, v220, v17, s[0:1]
v_mfma_f32_16x16x32_bf16 a[56:59], a[196:199], v[180:183], a[56:59]
v_cndmask_b32 v105, v220, v17, s[4:5]
v_cndmask_b32 v106, v220, v17, s[6:7]
v_mfma_f32_16x16x32_bf16 a[56:59], a[192:195], v[176:179], a[56:59]
v_cndmask_b32 v107, v220, v17, s[8:9]
v_cndmask_b32 v108, v220, v17, s[10:11]
v_mfma_f32_16x16x32_bf16 a[88:91], a[192:195], v[200:203], a[88:91]
v_cndmask_b32 v109, v220, v17, s[12:13]
v_cndmask_b32 v110, v220, v17, s[18:19]
v_mfma_f32_16x16x32_bf16 a[88:91], a[196:199], v[204:207], a[88:91]
v_cndmask_b32 v111, v220, v17, s[22:23]
v_cndmask_b32 v112, v220, v17, s[26:27]
v_mfma_f32_16x16x32_bf16 a[120:123], a[196:199], v[212:215], a[120:123]
v_cndmask_b32 v113, v220, v17, s[56:57]
v_cndmask_b32 v114, v220, v17, s[58:59]
v_mfma_f32_16x16x32_bf16 a[120:123], a[192:195], v[208:211], a[120:123]
v_cndmask_b32 v115, v220, v17, s[60:61]
v_cndmask_b32 v116, v220, v17, s[62:63]
v_mfma_f32_16x16x32_bf16 a[124:127], a[200:203], v[208:211], a[124:127]
v_cndmask_b32 v117, v220, v17, s[48:49]
v_cndmask_b32 v118, v220, v17, s[50:51]
v_mfma_f32_16x16x32_bf16 a[124:127], a[204:207], v[212:215], a[124:127]
s_add_u32 s17, s78, L_T-L_pc
v_cndmask_b32 v119, v220, v17, s[100:101]
v_mfma_f32_16x16x32_bf16 a[92:95], a[204:207], v[204:207], a[92:95]
buffer_load_dword a252, v16, s[88:91], s17 offen
v_mfma_f32_16x16x32_bf16 a[92:95], a[200:203], v[200:203], a[92:95]
v_mfma_f32_16x16x32_bf16 a[60:63], a[200:203], v[176:179], a[60:63]
s_add_u32 s17, s78, L_T-L_pc+4096
v_mfma_f32_16x16x32_bf16 a[60:63], a[204:207], v[180:183], a[60:63]
buffer_load_dword a252, v16, s[88:91], s17 offen
v_mfma_f32_16x16x32_bf16 a[28:31], a[204:207], v[172:175], a[28:31]
v_mfma_f32_16x16x32_bf16 a[28:31], a[200:203], v[168:171], a[28:31]
s_waitcnt lgkmcnt(0)
v_mfma_f32_16x16x32_bf16 v[120:123], a[144:147], v[56:59], v[224:227]
ds_read_b128 a[176:179], v2 offset:24576
v_mfma_f32_16x16x32_bf16 v[120:123], a[148:151], v[60:63], v[120:123]
ds_read_b128 a[180:183], v2 offset:25600
v_mfma_f32_16x16x32_bf16 v[120:123], a[152:155], v[64:67], v[120:123]
buffer_load_dwordx4 v16, s[32:35], s70 offen offset:2048 sc1 lds
v_mfma_f32_16x16x32_bf16 v[120:123], a[156:159], v[68:71], v[120:123]
s_add_u32 s17, s78, L_T1-L_pc
ds_read_b128 a[184:187], v2 offset:26624
v_mfma_f32_16x16x32_bf16 v[136:139], a[156:159], v[84:87], v[228:231]
buffer_load_dword a252, v16, s[88:91], s17 offen
v_mfma_f32_16x16x32_bf16 v[136:139], a[152:155], v[80:83], v[136:139]
ds_read_b128 a[188:191], v2 offset:27648
v_mfma_f32_16x16x32_bf16 v[136:139], a[148:151], v[76:79], v[136:139]
s_add_u32 s17, s78, L_T1-L_pc+4096
v_mfma_f32_16x16x32_bf16 v[136:139], a[144:147], v[72:75], v[136:139]
buffer_load_dword a252, v16, s[88:91], s17 offen
v_mfma_f32_16x16x32_bf16 v[104:107], a[144:147], v[40:43], v[104:107]
ds_read_b128 a[192:195], v2 offset:28672
v_mfma_f32_16x16x32_bf16 v[104:107], a[148:151], v[44:47], v[104:107]
v_mfma_f32_16x16x32_bf16 v[104:107], a[152:155], v[48:51], v[104:107]
v_exp_f32 v120, v120
v_mfma_f32_16x16x32_bf16 v[104:107], a[156:159], v[52:55], v[104:107]
v_exp_f32 v121, v121
v_mfma_f32_16x16x32_bf16 v[140:143], a[172:175], v[84:87], v[228:231]
v_exp_f32 v122, v122
v_mfma_f32_16x16x32_bf16 v[140:143], a[168:171], v[80:83], v[140:143]
v_exp_f32 v123, v123
v_mfma_f32_16x16x32_bf16 v[140:143], a[164:167], v[76:79], v[140:143]
v_exp_f32 v136, v136
v_mfma_f32_16x16x32_bf16 v[140:143], a[160:163], v[72:75], v[140:143]
v_exp_f32 v137, v137
v_mfma_f32_16x16x32_bf16 v[124:127], a[160:163], v[56:59], v[224:227]
buffer_load_dwordx4 v16, s[32:35], s70 offen offset:3072 sc1 lds
v_mfma_f32_16x16x32_bf16 v[124:127], a[164:167], v[60:63], v[124:127]
v_exp_f32 v138, v138
v_mfma_f32_16x16x32_bf16 v[124:127], a[168:171], v[64:67], v[124:127]
v_exp_f32 v139, v139
v_mfma_f32_16x16x32_bf16 v[124:127], a[172:175], v[68:71], v[124:127]
ds_read_b128 a[196:199], v2 offset:29696
v_cvt_pk_bf16_f32 v200, v120, v121
v_mfma_f32_16x16x32_bf16 v[108:111], a[172:175], v[52:55], v[108:111]
ds_read_b128 a[200:203], v2 offset:30720
v_cvt_pk_bf16_f32 v201, v122, v123
v_mfma_f32_16x16x32_bf16 v[108:111], a[168:171], v[48:51], v[108:111]
v_exp_f32 v104, v104
v_mfma_f32_16x16x32_bf16 v[108:111], a[164:167], v[44:47], v[108:111]
ds_read_b128 a[204:207], v2 offset:31744
v_cvt_pk_bf16_f32 v208, v136, v137
v_mfma_f32_16x16x32_bf16 v[108:111], a[160:163], v[40:43], v[108:111]
s_waitcnt lgkmcnt(3)
v_exp_f32 v105, v105
v_mfma_f32_16x16x32_bf16 v[112:115], a[176:179], v[40:43], v[112:115]
v_exp_f32 v106, v106
v_mfma_f32_16x16x32_bf16 v[112:115], a[180:183], v[44:47], v[112:115]
v_exp_f32 v107, v107
v_mfma_f32_16x16x32_bf16 v[112:115], a[184:187], v[48:51], v[112:115]
v_exp_f32 v140, v140
v_mfma_f32_16x16x32_bf16 v[112:115], a[188:191], v[52:55], v[112:115]
v_exp_f32 v141, v141
v_mfma_f32_16x16x32_bf16 v[128:131], a[188:191], v[68:71], v[224:227]
s_add_u32 m0, s71, 4096
v_exp_f32 v142, v142
v_mfma_f32_16x16x32_bf16 v[128:131], a[184:187], v[64:67], v[128:131]
s_add_u32 s64, s70, 4096
v_exp_f32 v143, v143
v_mfma_f32_16x16x32_bf16 v[128:131], a[180:183], v[60:63], v[128:131]
buffer_load_dwordx4 v16, s[32:35], s64 offen offset:0 sc1 lds
v_mfma_f32_16x16x32_bf16 v[128:131], a[176:179], v[56:59], v[128:131]
v_exp_f32 v124, v124
v_mfma_f32_16x16x32_bf16 v[144:147], a[176:179], v[72:75], v[228:231]
ds_read_b128 a[144:147], v3 offset:16384
v_cvt_pk_bf16_f32 v209, v138, v139
v_mfma_f32_16x16x32_bf16 v[144:147], a[180:183], v[76:79], v[144:147]
v_exp_f32 v125, v125
v_mfma_f32_16x16x32_bf16 v[144:147], a[184:187], v[80:83], v[144:147]
ds_read_b128 a[148:151], v3 offset:24576
v_cvt_pk_bf16_f32 v176, v104, v105
v_mfma_f32_16x16x32_bf16 v[144:147], a[188:191], v[84:87], v[144:147]
s_waitcnt lgkmcnt(2)
v_exp_f32 v126, v126
v_mfma_f32_16x16x32_bf16 v[148:151], a[204:207], v[84:87], v[228:231]
v_exp_f32 v127, v127
v_mfma_f32_16x16x32_bf16 v[148:151], a[200:203], v[80:83], v[148:151]
ds_read_b128 a[152:155], v3 offset:17408
v_cvt_pk_bf16_f32 v177, v106, v107
v_mfma_f32_16x16x32_bf16 v[148:151], a[196:199], v[76:79], v[148:151]
v_exp_f32 v108, v108
v_mfma_f32_16x16x32_bf16 v[148:151], a[192:195], v[72:75], v[148:151]
ds_read_b128 a[156:159], v3 offset:25600
v_cvt_pk_bf16_f32 v210, v140, v141
v_mfma_f32_16x16x32_bf16 v[132:135], a[192:195], v[56:59], v[224:227]
v_exp_f32 v109, v109
v_mfma_f32_16x16x32_bf16 v[132:135], a[196:199], v[60:63], v[132:135]
v_exp_f32 v110, v110
v_mfma_f32_16x16x32_bf16 v[132:135], a[200:203], v[64:67], v[132:135]
v_exp_f32 v111, v111
v_mfma_f32_16x16x32_bf16 v[132:135], a[204:207], v[68:71], v[132:135]
ds_read_b128 a[160:163], v3 offset:18432
v_cvt_pk_bf16_f32 v211, v142, v143
v_mfma_f32_16x16x32_bf16 v[116:119], a[204:207], v[52:55], v[116:119]
buffer_load_dwordx4 v16, s[32:35], s64 offen offset:1024 sc1 lds
v_mfma_f32_16x16x32_bf16 v[116:119], a[200:203], v[48:51], v[116:119]
v_exp_f32 v112, v112
v_mfma_f32_16x16x32_bf16 v[116:119], a[196:199], v[44:47], v[116:119]
ds_read_b128 a[164:167], v3 offset:26624
v_cvt_pk_bf16_f32 v202, v124, v125
v_mfma_f32_16x16x32_bf16 v[116:119], a[192:195], v[40:43], v[116:119]
v_exp_f32 v113, v113
v_mfma_f32_16x16x32_bf16 a[128:131], a[244:247], v[152:155], a[128:131]
v_exp_f32 v114, v114
v_mfma_f32_16x16x32_bf16 a[128:131], a[244:247], v[156:159], a[128:131]
v_exp_f32 v115, v115
v_mfma_f32_16x16x32_bf16 a[132:135], a[244:247], v[160:163], a[132:135]
ds_read_b128 a[168:171], v3 offset:19456
v_cvt_pk_bf16_f32 v203, v126, v127
v_mfma_f32_16x16x32_bf16 a[132:135], a[244:247], v[164:167], a[132:135]
ds_read_b128 a[172:175], v3 offset:27648
v_cvt_pk_bf16_f32 v178, v108, v109
v_mfma_f32_16x16x32_bf16 a[136:139], a[244:247], v[184:187], a[136:139]
v_exp_f32 v128, v128
v_mfma_f32_16x16x32_bf16 a[136:139], a[244:247], v[188:191], a[136:139]
v_exp_f32 v129, v129
v_mfma_f32_16x16x32_bf16 a[140:143], a[244:247], v[192:195], a[140:143]
v_exp_f32 v130, v130
v_mfma_f32_16x16x32_bf16 a[140:143], a[244:247], v[196:199], a[140:143]
s_waitcnt lgkmcnt(2)
ds_read_b128 a[176:179], v3 offset:20480
v_cvt_pk_bf16_f32 v179, v110, v111
v_mfma_f32_16x16x32_bf16 a[0:3], a[144:147], v[152:155], a[0:3]
v_exp_f32 v131, v131
v_mfma_f32_16x16x32_bf16 a[0:3], a[148:151], v[156:159], a[0:3]
ds_read_b128 a[180:183], v3 offset:28672
v_cvt_pk_bf16_f32 v180, v112, v113
v_mfma_f32_16x16x32_bf16 a[32:35], a[148:151], v[164:167], a[32:35]
buffer_load_dwordx4 v16, s[32:35], s64 offen offset:2048 sc1 lds
v_mfma_f32_16x16x32_bf16 a[32:35], a[144:147], v[160:163], a[32:35]
v_exp_f32 v144, v144
v_mfma_f32_16x16x32_bf16 a[64:67], a[144:147], v[184:187], a[64:67]
v_exp_f32 v145, v145
v_mfma_f32_16x16x32_bf16 a[64:67], a[148:151], v[188:191], a[64:67]
ds_read_b128 a[184:187], v3 offset:21504
v_xor_b32 v2, 0x8000, v2
v_mfma_f32_16x16x32_bf16 a[96:99], a[148:151], v[196:199], a[96:99]
v_exp_f32 v146, v146
v_mfma_f32_16x16x32_bf16 a[96:99], a[144:147], v[192:195], a[96:99]
ds_read_b128 a[188:191], v3 offset:29696
v_cvt_pk_bf16_f32 v181, v114, v115
v_mfma_f32_16x16x32_bf16 a[100:103], a[152:155], v[192:195], a[100:103]
v_exp_f32 v147, v147
v_mfma_f32_16x16x32_bf16 a[100:103], a[156:159], v[196:199], a[100:103]
v_exp_f32 v148, v148
v_mfma_f32_16x16x32_bf16 a[68:71], a[156:159], v[188:191], a[68:71]
v_exp_f32 v149, v149
v_mfma_f32_16x16x32_bf16 a[68:71], a[152:155], v[184:187], a[68:71]
ds_read_b128 a[192:195], v3 offset:22528
v_cvt_pk_bf16_f32 v204, v128, v129
v_mfma_f32_16x16x32_bf16 a[36:39], a[152:155], v[160:163], a[36:39]
v_exp_f32 v150, v150
v_mfma_f32_16x16x32_bf16 a[36:39], a[156:159], v[164:167], a[36:39]
v_exp_f32 v151, v151
v_mfma_f32_16x16x32_bf16 a[4:7], a[156:159], v[156:159], a[4:7]
v_exp_f32 v132, v132
v_mfma_f32_16x16x32_bf16 a[4:7], a[152:155], v[152:155], a[4:7]
ds_read_b128 a[196:199], v3 offset:30720
v_cvt_pk_bf16_f32 v205, v130, v131
v_mfma_f32_16x16x32_bf16 a[8:11], a[160:163], v[152:155], a[8:11]
buffer_load_dwordx4 v16, s[32:35], s64 offen offset:3072 sc1 lds
v_mfma_f32_16x16x32_bf16 a[8:11], a[164:167], v[156:159], a[8:11]
v_exp_f32 v133, v133
v_mfma_f32_16x16x32_bf16 a[40:43], a[164:167], v[164:167], a[40:43]
ds_read_b128 a[200:203], v3 offset:23552
v_cvt_pk_bf16_f32 v212, v144, v145
v_mfma_f32_16x16x32_bf16 a[40:43], a[160:163], v[160:163], a[40:43]
v_exp_f32 v134, v134
v_mfma_f32_16x16x32_bf16 a[72:75], a[160:163], v[184:187], a[72:75]
v_exp_f32 v135, v135
v_mfma_f32_16x16x32_bf16 a[72:75], a[164:167], v[188:191], a[72:75]
v_exp_f32 v116, v116
v_mfma_f32_16x16x32_bf16 a[104:107], a[164:167], v[196:199], a[104:107]
ds_read_b128 a[204:207], v3 offset:31744
v_cvt_pk_bf16_f32 v213, v146, v147
v_mfma_f32_16x16x32_bf16 a[104:107], a[160:163], v[192:195], a[104:107]
s_waitcnt lgkmcnt(2)
v_exp_f32 v117, v117
v_mfma_f32_16x16x32_bf16 a[108:111], a[168:171], v[192:195], a[108:111]
v_exp_f32 v118, v118
v_mfma_f32_16x16x32_bf16 a[108:111], a[172:175], v[196:199], a[108:111]
v_exp_f32 v119, v119
v_mfma_f32_16x16x32_bf16 a[76:79], a[172:175], v[188:191], a[76:79]
v_cvt_pk_bf16_f32 v214, v148, v149
v_cvt_pk_bf16_f32 v215, v150, v151
v_mfma_f32_16x16x32_bf16 a[76:79], a[168:171], v[184:187], a[76:79]
v_cvt_pk_bf16_f32 v206, v132, v133
v_cvt_pk_bf16_f32 v207, v134, v135
v_mfma_f32_16x16x32_bf16 a[44:47], a[168:171], v[160:163], a[44:47]
v_cvt_pk_bf16_f32 v182, v116, v117
v_cvt_pk_bf16_f32 v183, v118, v119
v_mfma_f32_16x16x32_bf16 a[44:47], a[172:175], v[164:167], a[44:47]
v_accvgpr_read_b32 v20, a128
v_max_f32 v1, v1, v20
v_mfma_f32_16x16x32_bf16 a[12:15], a[172:175], v[156:159], a[12:15]
v_rcp_f32 v20, v20
v_mfma_f32_16x16x32_bf16 a[12:15], a[168:171], v[152:155], a[12:15]
v_accvgpr_read_b32 v232, a0
v_accvgpr_read_b32 v233, a1
v_mfma_f32_16x16x32_bf16 a[16:19], a[176:179], v[152:155], a[16:19]
s_waitcnt vmcnt(16)
s_barrier
v_mfma_f32_16x16x32_bf16 a[16:19], a[180:183], v[156:159], a[16:19]
s_xor_b32 s71, s71, 49152
ds_read_b128 a[144:147], v2 offset:0
v_xor_b32 v3, 0x8000, v3
v_mfma_f32_16x16x32_bf16 a[48:51], a[180:183], v[164:167], a[48:51]
s_add_u32 s70, s70, 32768
ds_read_b128 a[148:151], v2 offset:1024
v_accvgpr_read_b32 v234, a2
v_mfma_f32_16x16x32_bf16 a[48:51], a[176:179], v[160:163], a[48:51]
s_mov_b32 m0, s71
ds_read_b128 a[152:155], v2 offset:2048
v_accvgpr_read_b32 v235, a3
v_mfma_f32_16x16x32_bf16 a[80:83], a[176:179], v[184:187], a[80:83]
buffer_load_dwordx4 v16, s[32:35], s70 offen offset:0 sc1 lds
v_mfma_f32_16x16x32_bf16 a[80:83], a[180:183], v[188:191], a[80:83]
ds_read_b128 a[156:159], v2 offset:3072
v_accvgpr_read_b32 v236, a4
v_mfma_f32_16x16x32_bf16 a[112:115], a[180:183], v[196:199], a[112:115]
ds_read_b128 a[160:163], v2 offset:4096
v_accvgpr_read_b32 v237, a5
v_mfma_f32_16x16x32_bf16 a[112:115], a[176:179], v[192:195], a[112:115]
ds_read_b128 a[164:167], v2 offset:5120
v_accvgpr_read_b32 v238, a6
v_mfma_f32_16x16x32_bf16 a[116:119], a[184:187], v[192:195], a[116:119]
ds_read_b128 a[168:171], v2 offset:6144
v_accvgpr_read_b32 v239, a7
v_mfma_f32_16x16x32_bf16 a[116:119], a[188:191], v[196:199], a[116:119]
ds_read_b128 a[172:175], v2 offset:7168
v_mul_f32 v20, v20, v4
v_mfma_f32_16x16x32_bf16 a[84:87], a[188:191], v[188:191], a[84:87]
v_mul_f32 v232, v232, v20
v_mul_f32 v233, v233, v20
v_mfma_f32_16x16x32_bf16 a[84:87], a[184:187], v[184:187], a[84:87]
v_mul_f32 v234, v234, v20
v_mul_f32 v235, v235, v20
v_mfma_f32_16x16x32_bf16 a[52:55], a[184:187], v[160:163], a[52:55]
v_mul_f32 v236, v236, v20
v_mul_f32 v237, v237, v20
v_mfma_f32_16x16x32_bf16 a[52:55], a[188:191], v[164:167], a[52:55]
v_mul_f32 v238, v238, v20
v_mul_f32 v239, v239, v20
v_mfma_f32_16x16x32_bf16 a[20:23], a[188:191], v[156:159], a[20:23]
v_cvt_pk_bf16_f32 v232, v232, v233
v_cvt_pk_bf16_f32 v233, v234, v235
v_mfma_f32_16x16x32_bf16 a[20:23], a[184:187], v[152:155], a[20:23]
v_cvt_pk_bf16_f32 v234, v236, v237
v_cvt_pk_bf16_f32 v235, v238, v239
v_mfma_f32_16x16x32_bf16 a[24:27], a[192:195], v[152:155], a[24:27]
s_add_u32 s77, s74, 0
buffer_store_dwordx4 v[232:235], v16, s[44:47], s77 offen sc1
v_mfma_f32_16x16x32_bf16 a[24:27], a[196:199], v[156:159], a[24:27]
v_accvgpr_read_b32 v240, a8
v_accvgpr_read_b32 v241, a9
v_mfma_f32_16x16x32_bf16 a[56:59], a[196:199], v[164:167], a[56:59]
buffer_load_dwordx4 v16, s[32:35], s70 offen offset:1024 sc1 lds
v_mfma_f32_16x16x32_bf16 a[56:59], a[192:195], v[160:163], a[56:59]
v_accvgpr_read_b32 v242, a10
v_accvgpr_read_b32 v243, a11
v_mfma_f32_16x16x32_bf16 a[88:91], a[192:195], v[184:187], a[88:91]
v_accvgpr_read_b32 v244, a12
v_accvgpr_read_b32 v245, a13
v_mfma_f32_16x16x32_bf16 a[88:91], a[196:199], v[188:191], a[88:91]
v_accvgpr_read_b32 v246, a14
v_accvgpr_read_b32 v247, a15
v_mfma_f32_16x16x32_bf16 a[120:123], a[196:199], v[196:199], a[120:123]
v_mul_f32 v240, v240, v20
v_mul_f32 v241, v241, v20
v_mfma_f32_16x16x32_bf16 a[120:123], a[192:195], v[192:195], a[120:123]
s_waitcnt lgkmcnt(0)
v_mul_f32 v242, v242, v20
v_mul_f32 v243, v243, v20
v_mfma_f32_16x16x32_bf16 a[124:127], a[200:203], v[192:195], a[124:127]
v_mul_f32 v244, v244, v20
v_mul_f32 v245, v245, v20
v_mfma_f32_16x16x32_bf16 a[124:127], a[204:207], v[196:199], a[124:127]
v_mul_f32 v246, v246, v20
v_mul_f32 v247, v247, v20
v_mfma_f32_16x16x32_bf16 a[92:95], a[204:207], v[188:191], a[92:95]
v_cvt_pk_bf16_f32 v240, v240, v241
v_cvt_pk_bf16_f32 v241, v242, v243
v_mfma_f32_16x16x32_bf16 a[92:95], a[200:203], v[184:187], a[92:95]
v_cvt_pk_bf16_f32 v242, v244, v245
v_cvt_pk_bf16_f32 v243, v246, v247
v_mfma_f32_16x16x32_bf16 a[60:63], a[200:203], v[160:163], a[60:63]
s_add_u32 s77, s74, 8192
buffer_store_dwordx4 v[240:243], v16, s[44:47], s77 offen sc1
v_mfma_f32_16x16x32_bf16 a[60:63], a[204:207], v[164:167], a[60:63]
v_accvgpr_read_b32 v232, a16
v_accvgpr_read_b32 v233, a17
v_mfma_f32_16x16x32_bf16 a[28:31], a[204:207], v[156:159], a[28:31]
v_accvgpr_read_b32 v234, a18
v_accvgpr_read_b32 v235, a19
v_mfma_f32_16x16x32_bf16 a[28:31], a[200:203], v[152:155], a[28:31]
v_accvgpr_read_b32 v236, a20
v_accvgpr_read_b32 v237, a21
v_accvgpr_read_b32 v238, a22
v_accvgpr_read_b32 v239, a23
v_mul_f32 v232, v232, v20
v_mul_f32 v233, v233, v20
v_mul_f32 v234, v234, v20
v_mul_f32 v235, v235, v20
v_mul_f32 v236, v236, v20
v_mul_f32 v237, v237, v20
v_mul_f32 v238, v238, v20
v_mul_f32 v239, v239, v20
v_cvt_pk_bf16_f32 v232, v232, v233
v_cvt_pk_bf16_f32 v233, v234, v235
v_cvt_pk_bf16_f32 v234, v236, v237
v_cvt_pk_bf16_f32 v235, v238, v239
s_add_u32 s77, s74, 16384
buffer_store_dwordx4 v[232:235], v16, s[44:47], s77 offen sc1
s_cmp_eq_u32 s3, 7
s_cbranch_scc1 L_T1
L_T:
s_waitcnt lgkmcnt(7)
v_mfma_f32_16x16x32_bf16 v[120:123], a[144:147], v[56:59], v[224:227]
s_waitcnt lgkmcnt(6)
ds_read_b128 a[176:179], v2 offset:8192
v_mfma_f32_16x16x32_bf16 v[120:123], a[148:151], v[60:63], v[120:123]
s_waitcnt lgkmcnt(6)
ds_read_b128 a[180:183], v2 offset:9216
v_mfma_f32_16x16x32_bf16 v[120:123], a[152:155], v[64:67], v[120:123]
s_waitcnt lgkmcnt(6)
buffer_load_dwordx4 v16, s[32:35], s70 offen offset:2048 sc1 lds
v_mfma_f32_16x16x32_bf16 v[120:123], a[156:159], v[68:71], v[120:123]
ds_read_b128 a[184:187], v2 offset:10240
v_mfma_f32_16x16x32_bf16 v[136:139], a[156:159], v[84:87], v[228:231]
ds_read_b128 a[188:191], v2 offset:11264
v_mfma_f32_16x16x32_bf16 v[136:139], a[152:155], v[80:83], v[136:139]
ds_read_b128 a[192:195], v2 offset:12288
v_mfma_f32_16x16x32_bf16 v[136:139], a[148:151], v[76:79], v[136:139]
v_mfma_f32_16x16x32_bf16 v[136:139], a[144:147], v[72:75], v[136:139]
s_waitcnt lgkmcnt(3)
ds_read_b128 a[196:199], v2 offset:13312
v_mfma_f32_16x16x32_bf16 v[140:143], a[160:163], v[72:75], v[228:231]
ds_read_b128 a[200:203], v2 offset:14336
v_accvgpr_read_b32 v240, a24
v_mfma_f32_16x16x32_bf16 v[140:143], a[164:167], v[76:79], v[140:143]
ds_read_b128 a[204:207], v2 offset:15360
v_accvgpr_read_b32 v241, a25
v_mfma_f32_16x16x32_bf16 v[140:143], a[168:171], v[80:83], v[140:143]
v_exp_f32 v120, v120
v_mfma_f32_16x16x32_bf16 v[140:143], a[172:175], v[84:87], v[140:143]
v_exp_f32 v121, v121
v_mfma_f32_16x16x32_bf16 v[124:127], a[172:175], v[68:71], v[224:227]
buffer_load_dwordx4 v16, s[32:35], s70 offen offset:3072 sc1 lds
v_mfma_f32_16x16x32_bf16 v[124:127], a[168:171], v[64:67], v[124:127]
v_exp_f32 v122, v122
v_mfma_f32_16x16x32_bf16 v[124:127], a[164:167], v[60:63], v[124:127]
v_exp_f32 v123, v123
v_mfma_f32_16x16x32_bf16 v[124:127], a[160:163], v[56:59], v[124:127]
v_exp_f32 v136, v136
v_mfma_f32_16x16x32_bf16 v[128:131], a[176:179], v[56:59], v[224:227]
v_exp_f32 v137, v137
v_mfma_f32_16x16x32_bf16 v[128:131], a[180:183], v[60:63], v[128:131]
s_waitcnt lgkmcnt(0)
v_exp_f32 v138, v138
v_mfma_f32_16x16x32_bf16 v[128:131], a[184:187], v[64:67], v[128:131]
v_exp_f32 v139, v139
v_mfma_f32_16x16x32_bf16 v[128:131], a[188:191], v[68:71], v[128:131]
s_add_u32 m0, s71, 4096
v_exp_f32 v140, v140
v_mfma_f32_16x16x32_bf16 v[144:147], a[188:191], v[84:87], v[228:231]
s_add_u32 s64, s70, 4096
v_cvt_pk_bf16_f32 v184, v120, v121
v_cvt_pk_bf16_f32 v185, v122, v123
v_mfma_f32_16x16x32_bf16 v[144:147], a[184:187], v[80:83], v[144:147]
buffer_load_dwordx4 v16, s[32:35], s64 offen offset:0 sc1 lds
v_mfma_f32_16x16x32_bf16 v[144:147], a[180:183], v[76:79], v[144:147]
ds_read_b128 a[144:147], v3 offset:0
v_cvt_pk_bf16_f32 v192, v136, v137
v_mfma_f32_16x16x32_bf16 v[144:147], a[176:179], v[72:75], v[144:147]
ds_read_b128 a[148:151], v3 offset:8192
v_cvt_pk_bf16_f32 v193, v138, v139
v_mfma_f32_16x16x32_bf16 v[148:151], a[192:195], v[72:75], v[228:231]
v_exp_f32 v141, v141
v_mfma_f32_16x16x32_bf16 v[148:151], a[196:199], v[76:79], v[148:151]
v_exp_f32 v142, v142
v_mfma_f32_16x16x32_bf16 v[148:151], a[200:203], v[80:83], v[148:151]
v_exp_f32 v143, v143
v_mfma_f32_16x16x32_bf16 v[148:151], a[204:207], v[84:87], v[148:151]
ds_read_b128 a[152:155], v3 offset:1024
v_cvt_pk_bf16_f32 v194, v140, v141
v_mfma_f32_16x16x32_bf16 v[132:135], a[204:207], v[68:71], v[224:227]
ds_read_b128 a[156:159], v3 offset:9216
v_accvgpr_read_b32 v242, a26
v_mfma_f32_16x16x32_bf16 v[132:135], a[200:203], v[64:67], v[132:135]
v_exp_f32 v124, v124
v_mfma_f32_16x16x32_bf16 v[132:135], a[196:199], v[60:63], v[132:135]
v_exp_f32 v125, v125
v_mfma_f32_16x16x32_bf16 v[132:135], a[192:195], v[56:59], v[132:135]
buffer_load_dwordx4 v16, s[32:35], s64 offen offset:1024 sc1 lds
v_mfma_f32_16x16x32_bf16 a[132:135], a[244:247], v[176:179], a[132:135]
ds_read_b128 a[160:163], v3 offset:2048
v_accvgpr_read_b32 v243, a27
v_mfma_f32_16x16x32_bf16 a[132:135], a[244:247], v[180:183], a[132:135]
ds_read_b128 a[164:167], v3 offset:10240
v_accvgpr_read_b32 v244, a28
v_mfma_f32_16x16x32_bf16 a[136:139], a[244:247], v[200:203], a[136:139]
ds_read_b128 a[168:171], v3 offset:3072
v_accvgpr_read_b32 v245, a29
v_mfma_f32_16x16x32_bf16 a[136:139], a[244:247], v[204:207], a[136:139]
ds_read_b128 a[172:175], v3 offset:11264
v_accvgpr_read_b32 v246, a30
v_mfma_f32_16x16x32_bf16 a[140:143], a[244:247], v[208:211], a[140:143]
ds_read_b128 a[176:179], v3 offset:4096
v_accvgpr_read_b32 v247, a31
v_mfma_f32_16x16x32_bf16 a[140:143], a[244:247], v[212:215], a[140:143]
s_waitcnt lgkmcnt(5)
ds_read_b128 a[180:183], v3 offset:12288
v_mul_f32 v240, v240, v20
v_mfma_f32_16x16x32_bf16 a[32:35], a[144:147], v[176:179], a[32:35]
ds_read_b128 a[184:187], v3 offset:5120
v_mul_f32 v241, v241, v20
v_mfma_f32_16x16x32_bf16 a[32:35], a[148:151], v[180:183], a[32:35]
ds_read_b128 a[188:191], v3 offset:13312
v_mul_f32 v242, v242, v20
v_mfma_f32_16x16x32_bf16 a[64:67], a[148:151], v[204:207], a[64:67]
ds_read_b128 a[192:195], v3 offset:6144
v_mul_f32 v243, v243, v20
v_mfma_f32_16x16x32_bf16 a[64:67], a[144:147], v[200:203], a[64:67]
ds_read_b128 a[196:199], v3 offset:14336
v_mul_f32 v244, v244, v20
v_mfma_f32_16x16x32_bf16 a[96:99], a[144:147], v[208:211], a[96:99]
ds_read_b128 a[200:203], v3 offset:7168
v_mul_f32 v245, v245, v20
v_mul_f32 v246, v246, v20
v_mul_f32 v247, v247, v20
v_cvt_pk_bf16_f32 v240, v240, v241
v_cvt_pk_bf16_f32 v241, v242, v243
v_cvt_pk_bf16_f32 v242, v244, v245
v_cvt_pk_bf16_f32 v243, v246, v247
s_add_u32 s77, s74, 24576
buffer_store_dwordx4 v[240:243], v16, s[44:47], s77 offen sc1
v_mfma_f32_16x16x32_bf16 a[96:99], a[148:151], v[212:215], a[96:99]
v_exp_f32 v126, v126
v_mfma_f32_16x16x32_bf16 a[100:103], a[156:159], v[212:215], a[100:103]
buffer_load_dwordx4 v16, s[32:35], s64 offen offset:2048 sc1 lds
v_cvt_pk_bf16_f32 v195, v142, v143
v_mfma_f32_16x16x32_bf16 a[100:103], a[152:155], v[208:211], a[100:103]
v_exp_f32 v127, v127
v_mfma_f32_16x16x32_bf16 a[68:71], a[152:155], v[200:203], a[68:71]
v_exp_f32 v128, v128
v_mfma_f32_16x16x32_bf16 a[68:71], a[156:159], v[204:207], a[68:71]
v_exp_f32 v129, v129
v_mfma_f32_16x16x32_bf16 a[36:39], a[156:159], v[180:183], a[36:39]
v_exp_f32 v130, v130
v_mfma_f32_16x16x32_bf16 a[36:39], a[152:155], v[176:179], a[36:39]
s_waitcnt lgkmcnt(0)
v_cvt_pk_bf16_f32 v186, v124, v125
v_cvt_pk_bf16_f32 v187, v126, v127
v_mfma_f32_16x16x32_bf16 a[40:43], a[160:163], v[176:179], a[40:43]
v_exp_f32 v131, v131
v_mfma_f32_16x16x32_bf16 a[40:43], a[164:167], v[180:183], a[40:43]
buffer_load_dwordx4 v16, s[32:35], s64 offen offset:3072 sc1 lds
v_mfma_f32_16x16x32_bf16 a[72:75], a[164:167], v[204:207], a[72:75]
v_exp_f32 v144, v144
v_mfma_f32_16x16x32_bf16 a[72:75], a[160:163], v[200:203], a[72:75]
v_exp_f32 v145, v145
v_mfma_f32_16x16x32_bf16 a[104:107], a[160:163], v[208:211], a[104:107]
v_exp_f32 v146, v146
v_mfma_f32_16x16x32_bf16 a[104:107], a[164:167], v[212:215], a[104:107]
ds_read_b128 a[204:207], v3 offset:15360
v_cvt_pk_bf16_f32 v188, v128, v129
v_mfma_f32_16x16x32_bf16 a[108:111], a[172:175], v[212:215], a[108:111]
v_exp_f32 v147, v147
v_mfma_f32_16x16x32_bf16 a[108:111], a[168:171], v[208:211], a[108:111]
v_exp_f32 v148, v148
v_mfma_f32_16x16x32_bf16 a[76:79], a[168:171], v[200:203], a[76:79]
v_exp_f32 v149, v149
v_mfma_f32_16x16x32_bf16 a[76:79], a[172:175], v[204:207], a[76:79]
v_exp_f32 v150, v150
v_mfma_f32_16x16x32_bf16 a[44:47], a[172:175], v[180:183], a[44:47]
v_exp_f32 v151, v151
v_mfma_f32_16x16x32_bf16 a[44:47], a[168:171], v[176:179], a[44:47]
v_exp_f32 v132, v132
v_mfma_f32_16x16x32_bf16 a[48:51], a[176:179], v[176:179], a[48:51]
v_exp_f32 v133, v133
v_mfma_f32_16x16x32_bf16 a[48:51], a[180:183], v[180:183], a[48:51]
s_waitcnt vmcnt(9)
s_barrier
v_cvt_pk_bf16_f32 v189, v130, v131
v_mfma_f32_16x16x32_bf16 a[80:83], a[180:183], v[204:207], a[80:83]
s_xor_b32 s71, s71, 16384
ds_read_b128 a[144:147], v2 offset:16384
v_cvt_pk_bf16_f32 v196, v144, v145
v_mfma_f32_16x16x32_bf16 a[80:83], a[176:179], v[200:203], a[80:83]
s_add_u32 s70, s70, 32768
v_exp_f32 v134, v134
v_mfma_f32_16x16x32_bf16 a[112:115], a[176:179], v[208:211], a[112:115]
s_mov_b32 m0, s71
ds_read_b128 a[148:151], v2 offset:17408
v_cvt_pk_bf16_f32 v197, v146, v147
v_mfma_f32_16x16x32_bf16 a[112:115], a[180:183], v[212:215], a[112:115]
buffer_load_dwordx4 v16, s[32:35], s70 offen offset:0 sc1 lds
v_mfma_f32_16x16x32_bf16 a[116:119], a[188:191], v[212:215], a[116:119]
ds_read_b128 a[152:155], v2 offset:18432
v_cvt_pk_bf16_f32 v198, v148, v149
v_mfma_f32_16x16x32_bf16 a[116:119], a[184:187], v[208:211], a[116:119]
ds_read_b128 a[156:159], v2 offset:19456
v_cvt_pk_bf16_f32 v199, v150, v151
v_mfma_f32_16x16x32_bf16 a[84:87], a[184:187], v[200:203], a[84:87]
v_exp_f32 v135, v135
v_mfma_f32_16x16x32_bf16 a[84:87], a[188:191], v[204:207], a[84:87]
ds_read_b128 a[160:163], v2 offset:20480
v_cvt_pk_bf16_f32 v190, v132, v133
v_mfma_f32_16x16x32_bf16 a[52:55], a[188:191], v[180:183], a[52:55]
ds_read_b128 a[164:167], v2 offset:21504
v_cvt_pk_bf16_f32 v191, v134, v135
v_mfma_f32_16x16x32_bf16 a[52:55], a[184:187], v[176:179], a[52:55]
ds_read_b128 a[168:171], v2 offset:22528
v_accvgpr_read_b32 v21, a132
v_mfma_f32_16x16x32_bf16 a[56:59], a[192:195], v[176:179], a[56:59]
ds_read_b128 a[172:175], v2 offset:23552
v_max_f32 v1, v1, v21
v_mfma_f32_16x16x32_bf16 a[56:59], a[196:199], v[180:183], a[56:59]
v_rcp_f32 v21, v21
v_mfma_f32_16x16x32_bf16 a[88:91], a[196:199], v[204:207], a[88:91]
buffer_load_dwordx4 v16, s[32:35], s70 offen offset:1024 sc1 lds
v_mfma_f32_16x16x32_bf16 a[88:91], a[192:195], v[200:203], a[88:91]
v_accvgpr_read_b32 v232, a32
v_accvgpr_read_b32 v233, a33
v_mfma_f32_16x16x32_bf16 a[120:123], a[192:195], v[208:211], a[120:123]
v_accvgpr_read_b32 v234, a34
v_accvgpr_read_b32 v235, a35
v_mfma_f32_16x16x32_bf16 a[120:123], a[196:199], v[212:215], a[120:123]
s_waitcnt lgkmcnt(1)
v_accvgpr_read_b32 v236, a36
v_accvgpr_read_b32 v237, a37
v_mfma_f32_16x16x32_bf16 a[124:127], a[204:207], v[212:215], a[124:127]
v_accvgpr_read_b32 v238, a38
v_accvgpr_read_b32 v239, a39
v_mfma_f32_16x16x32_bf16 a[124:127], a[200:203], v[208:211], a[124:127]
v_mul_f32 v21, v21, v6
v_mul_f32 v232, v232, v21
v_mfma_f32_16x16x32_bf16 a[92:95], a[200:203], v[200:203], a[92:95]
v_mul_f32 v233, v233, v21
v_mul_f32 v234, v234, v21
v_mfma_f32_16x16x32_bf16 a[92:95], a[204:207], v[204:207], a[92:95]
v_mul_f32 v235, v235, v21
v_mul_f32 v236, v236, v21
v_mfma_f32_16x16x32_bf16 a[60:63], a[204:207], v[180:183], a[60:63]
v_mul_f32 v237, v237, v21
v_mul_f32 v238, v238, v21
v_mfma_f32_16x16x32_bf16 a[60:63], a[200:203], v[176:179], a[60:63]
v_mul_f32 v239, v239, v21
v_cvt_pk_bf16_f32 v232, v232, v233
v_mfma_f32_16x16x32_bf16 v[120:123], a[144:147], v[56:59], v[224:227]
ds_read_b128 a[176:179], v2 offset:24576
ds_read_b128 a[180:183], v2 offset:25600
v_mfma_f32_16x16x32_bf16 v[120:123], a[148:151], v[60:63], v[120:123]
ds_read_b128 a[184:187], v2 offset:26624
v_cvt_pk_bf16_f32 v233, v234, v235
v_mfma_f32_16x16x32_bf16 v[120:123], a[152:155], v[64:67], v[120:123]
buffer_load_dwordx4 v16, s[32:35], s70 offen offset:2048 sc1 lds
v_mfma_f32_16x16x32_bf16 v[120:123], a[156:159], v[68:71], v[120:123]
ds_read_b128 a[188:191], v2 offset:27648
ds_read_b128 a[192:195], v2 offset:28672
v_mfma_f32_16x16x32_bf16 v[136:139], a[156:159], v[84:87], v[228:231]
ds_read_b128 a[196:199], v2 offset:29696
v_cvt_pk_bf16_f32 v234, v236, v237
v_mfma_f32_16x16x32_bf16 v[136:139], a[152:155], v[80:83], v[136:139]
buffer_load_dwordx4 v16, s[32:35], s70 offen offset:3072 sc1 lds
v_mfma_f32_16x16x32_bf16 v[136:139], a[148:151], v[76:79], v[136:139]
ds_read_b128 a[200:203], v2 offset:30720
ds_read_b128 a[204:207], v2 offset:31744
v_mfma_f32_16x16x32_bf16 v[136:139], a[144:147], v[72:75], v[136:139]
v_exp_f32 v120, v120
v_mfma_f32_16x16x32_bf16 v[140:143], a[160:163], v[72:75], v[228:231]
v_exp_f32 v121, v121
v_mfma_f32_16x16x32_bf16 v[140:143], a[164:167], v[76:79], v[140:143]
s_add_u32 m0, s71, 4096
v_exp_f32 v122, v122
v_mfma_f32_16x16x32_bf16 v[140:143], a[168:171], v[80:83], v[140:143]
s_waitcnt lgkmcnt(2)
v_cvt_pk_bf16_f32 v235, v238, v239
s_add_u32 s77, s74, 4096
buffer_store_dwordx4 v[232:235], v16, s[44:47], s77 offen sc1
v_accvgpr_read_b32 v240, a40
v_accvgpr_read_b32 v241, a41
v_accvgpr_read_b32 v242, a42
v_accvgpr_read_b32 v243, a43
v_accvgpr_read_b32 v244, a44
v_accvgpr_read_b32 v245, a45
v_accvgpr_read_b32 v246, a46
v_accvgpr_read_b32 v247, a47
v_mul_f32 v240, v240, v21
v_mul_f32 v241, v241, v21
v_mul_f32 v242, v242, v21
v_mul_f32 v243, v243, v21
v_mul_f32 v244, v244, v21
v_mul_f32 v245, v245, v21
v_mul_f32 v246, v246, v21
v_mul_f32 v247, v247, v21
v_cvt_pk_bf16_f32 v240, v240, v241
v_cvt_pk_bf16_f32 v241, v242, v243
v_cvt_pk_bf16_f32 v242, v244, v245
v_cvt_pk_bf16_f32 v243, v246, v247
s_add_u32 s77, s74, 12288
buffer_store_dwordx4 v[240:243], v16, s[44:47], s77 offen sc1
v_accvgpr_read_b32 v232, a48
v_accvgpr_read_b32 v233, a49
v_accvgpr_read_b32 v234, a50
v_accvgpr_read_b32 v235, a51
v_accvgpr_read_b32 v236, a52
v_accvgpr_read_b32 v237, a53
v_accvgpr_read_b32 v238, a54
v_accvgpr_read_b32 v239, a55
v_mul_f32 v232, v232, v21
v_mul_f32 v233, v233, v21
v_mul_f32 v234, v234, v21
v_mul_f32 v235, v235, v21
v_mul_f32 v236, v236, v21
v_mul_f32 v237, v237, v21
v_mul_f32 v238, v238, v21
v_mul_f32 v239, v239, v21
v_cvt_pk_bf16_f32 v232, v232, v233
v_cvt_pk_bf16_f32 v233, v234, v235
v_cvt_pk_bf16_f32 v234, v236, v237
v_cvt_pk_bf16_f32 v235, v238, v239
s_add_u32 s77, s74, 20480
buffer_store_dwordx4 v[232:235], v16, s[44:47], s77 offen sc1
v_accvgpr_read_b32 v240, a56
v_accvgpr_read_b32 v241, a57
v_accvgpr_read_b32 v242, a58
v_accvgpr_read_b32 v243, a59
v_accvgpr_read_b32 v244, a60
v_accvgpr_read_b32 v245, a61
v_accvgpr_read_b32 v246, a62
v_accvgpr_read_b32 v247, a63
v_mul_f32 v240, v240, v21
v_mul_f32 v241, v241, v21
v_mul_f32 v242, v242, v21
v_mul_f32 v243, v243, v21
v_mul_f32 v244, v244, v21
v_mul_f32 v245, v245, v21
v_mul_f32 v246, v246, v21
v_mul_f32 v247, v247, v21
v_cvt_pk_bf16_f32 v240, v240, v241
v_cvt_pk_bf16_f32 v241, v242, v243
v_cvt_pk_bf16_f32 v242, v244, v245
v_cvt_pk_bf16_f32 v243, v246, v247
s_add_u32 s77, s74, 28672
buffer_store_dwordx4 v[240:243], v16, s[44:47], s77 offen sc1
v_exp_f32 v123, v123
v_mfma_f32_16x16x32_bf16 v[140:143], a[172:175], v[84:87], v[140:143]
v_exp_f32 v136, v136
v_mfma_f32_16x16x32_bf16 v[124:127], a[172:175], v[68:71], v[224:227]
ds_read_b128 a[144:147], v3 offset:16384
v_cvt_pk_bf16_f32 v200, v120, v121
v_mfma_f32_16x16x32_bf16 v[124:127], a[168:171], v[64:67], v[124:127]
s_add_u32 s64, s70, 4096
v_exp_f32 v137, v137
v_mfma_f32_16x16x32_bf16 v[124:127], a[164:167], v[60:63], v[124:127]
ds_read_b128 a[148:151], v3 offset:24576
v_cvt_pk_bf16_f32 v201, v122, v123
v_mfma_f32_16x16x32_bf16 v[124:127], a[160:163], v[56:59], v[124:127]
v_exp_f32 v138, v138
v_mfma_f32_16x16x32_bf16 v[128:131], a[176:179], v[56:59], v[224:227]
ds_read_b128 a[152:155], v3 offset:17408
v_cvt_pk_bf16_f32 v208, v136, v137
v_mfma_f32_16x16x32_bf16 v[128:131], a[180:183], v[60:63], v[128:131]
v_exp_f32 v139, v139
v_mfma_f32_16x16x32_bf16 v[128:131], a[184:187], v[64:67], v[128:131]
ds_read_b128 a[156:159], v3 offset:25600
v_cvt_pk_bf16_f32 v209, v138, v139
v_mfma_f32_16x16x32_bf16 v[128:131], a[188:191], v[68:71], v[128:131]
v_exp_f32 v140, v140
v_mfma_f32_16x16x32_bf16 v[144:147], a[188:191], v[84:87], v[228:231]
buffer_load_dwordx4 v16, s[32:35], s64 offen offset:0 sc1 lds
v_mfma_f32_16x16x32_bf16 v[144:147], a[184:187], v[80:83], v[144:147]
v_exp_f32 v141, v141
v_mfma_f32_16x16x32_bf16 v[144:147], a[180:183], v[76:79], v[144:147]
ds_read_b128 a[160:163], v3 offset:18432
v_cvt_pk_bf16_f32 v210, v140, v141
v_mfma_f32_16x16x32_bf16 v[144:147], a[176:179], v[72:75], v[144:147]
v_exp_f32 v142, v142
v_mfma_f32_16x16x32_bf16 v[148:151], a[192:195], v[72:75], v[228:231]
ds_read_b128 a[164:167], v3 offset:26624
ds_read_b128 a[168:171], v3 offset:19456
v_mfma_f32_16x16x32_bf16 v[148:151], a[196:199], v[76:79], v[148:151]
s_waitcnt lgkmcnt(3)
v_exp_f32 v143, v143
v_mfma_f32_16x16x32_bf16 v[148:151], a[200:203], v[80:83], v[148:151]
ds_read_b128 a[172:175], v3 offset:27648
v_cvt_pk_bf16_f32 v211, v142, v143
v_mfma_f32_16x16x32_bf16 v[148:151], a[204:207], v[84:87], v[148:151]
v_exp_f32 v124, v124
v_mfma_f32_16x16x32_bf16 v[132:135], a[204:207], v[68:71], v[224:227]
buffer_load_dwordx4 v16, s[32:35], s64 offen offset:1024 sc1 lds
v_mfma_f32_16x16x32_bf16 v[132:135], a[200:203], v[64:67], v[132:135]
v_exp_f32 v125, v125
v_mfma_f32_16x16x32_bf16 v[132:135], a[196:199], v[60:63], v[132:135]
ds_read_b128 a[176:179], v3 offset:20480
v_cvt_pk_bf16_f32 v202, v124, v125
v_mfma_f32_16x16x32_bf16 v[132:135], a[192:195], v[56:59], v[132:135]
v_exp_f32 v126, v126
v_mfma_f32_16x16x32_bf16 a[136:139], a[244:247], v[184:187], a[136:139]
ds_read_b128 a[180:183], v3 offset:28672
ds_read_b128 a[184:187], v3 offset:21504
v_mfma_f32_16x16x32_bf16 a[136:139], a[244:247], v[188:191], a[136:139]
v_exp_f32 v127, v127
v_mfma_f32_16x16x32_bf16 a[140:143], a[244:247], v[192:195], a[140:143]
ds_read_b128 a[188:191], v3 offset:29696
v_cvt_pk_bf16_f32 v203, v126, v127
v_mfma_f32_16x16x32_bf16 a[140:143], a[244:247], v[196:199], a[140:143]
v_exp_f32 v128, v128
v_mfma_f32_16x16x32_bf16 a[64:67], a[144:147], v[184:187], a[64:67]
buffer_load_dwordx4 v16, s[32:35], s64 offen offset:2048 sc1 lds
v_mfma_f32_16x16x32_bf16 a[64:67], a[148:151], v[188:191], a[64:67]
v_exp_f32 v129, v129
v_mfma_f32_16x16x32_bf16 a[96:99], a[148:151], v[196:199], a[96:99]
ds_read_b128 a[192:195], v3 offset:22528
v_cvt_pk_bf16_f32 v204, v128, v129
v_mfma_f32_16x16x32_bf16 a[96:99], a[144:147], v[192:195], a[96:99]
v_exp_f32 v130, v130
v_mfma_f32_16x16x32_bf16 a[100:103], a[152:155], v[192:195], a[100:103]
ds_read_b128 a[196:199], v3 offset:30720
v_xor_b32 v2, 0x8000, v2
v_mfma_f32_16x16x32_bf16 a[100:103], a[156:159], v[196:199], a[100:103]
v_exp_f32 v131, v131
v_mfma_f32_16x16x32_bf16 a[68:71], a[156:159], v[188:191], a[68:71]
ds_read_b128 a[200:203], v3 offset:23552
v_cvt_pk_bf16_f32 v205, v130, v131
v_mfma_f32_16x16x32_bf16 a[68:71], a[152:155], v[184:187], a[68:71]
s_waitcnt lgkmcnt(3)
v_exp_f32 v144, v144
v_mfma_f32_16x16x32_bf16 a[72:75], a[160:163], v[184:187], a[72:75]
buffer_load_dwordx4 v16, s[32:35], s64 offen offset:3072 sc1 lds
v_mfma_f32_16x16x32_bf16 a[72:75], a[164:167], v[188:191], a[72:75]
s_xor_b32 s71, s71, 49152
v_exp_f32 v145, v145
v_mfma_f32_16x16x32_bf16 a[104:107], a[164:167], v[196:199], a[104:107]
ds_read_b128 a[204:207], v3 offset:31744
v_cvt_pk_bf16_f32 v212, v144, v145
v_mfma_f32_16x16x32_bf16 a[104:107], a[160:163], v[192:195], a[104:107]
v_exp_f32 v146, v146
v_mfma_f32_16x16x32_bf16 a[108:111], a[168:171], v[192:195], a[108:111]
s_waitcnt vmcnt(12)
s_barrier
v_mfma_f32_16x16x32_bf16 a[108:111], a[172:175], v[196:199], a[108:111]
s_add_u32 s70, s70, 32768
v_exp_f32 v147, v147
v_mfma_f32_16x16x32_bf16 a[76:79], a[172:175], v[188:191], a[76:79]
ds_read_b128 a[144:147], v2 offset:0
v_cvt_pk_bf16_f32 v213, v146, v147
v_mfma_f32_16x16x32_bf16 a[76:79], a[168:171], v[184:187], a[76:79]
v_exp_f32 v148, v148
v_mfma_f32_16x16x32_bf16 a[80:83], a[176:179], v[184:187], a[80:83]
ds_read_b128 a[148:151], v2 offset:1024
v_xor_b32 v3, 0x8000, v3
v_mfma_f32_16x16x32_bf16 a[80:83], a[180:183], v[188:191], a[80:83]
s_mov_b32 m0, s71
v_exp_f32 v149, v149
v_mfma_f32_16x16x32_bf16 a[112:115], a[180:183], v[196:199], a[112:115]
ds_read_b128 a[152:155], v2 offset:2048
v_cvt_pk_bf16_f32 v214, v148, v149
v_mfma_f32_16x16x32_bf16 a[112:115], a[176:179], v[192:195], a[112:115]
v_exp_f32 v150, v150
v_mfma_f32_16x16x32_bf16 a[116:119], a[184:187], v[192:195], a[116:119]
buffer_load_dwordx4 v16, s[32:35], s70 offen offset:0 sc1 lds
v_mfma_f32_16x16x32_bf16 a[116:119], a[188:191], v[196:199], a[116:119]
v_exp_f32 v151, v151
v_mfma_f32_16x16x32_bf16 a[84:87], a[188:191], v[188:191], a[84:87]
ds_read_b128 a[156:159], v2 offset:3072
v_cvt_pk_bf16_f32 v215, v150, v151
v_mfma_f32_16x16x32_bf16 a[84:87], a[184:187], v[184:187], a[84:87]
s_waitcnt lgkmcnt(2)
v_exp_f32 v132, v132
v_mfma_f32_16x16x32_bf16 a[88:91], a[192:195], v[184:187], a[88:91]
ds_read_b128 a[160:163], v2 offset:4096
v_mfma_f32_16x16x32_bf16 a[88:91], a[196:199], v[188:191], a[88:91]
v_exp_f32 v133, v133
v_mfma_f32_16x16x32_bf16 a[120:123], a[196:199], v[196:199], a[120:123]
ds_read_b128 a[164:167], v2 offset:5120
v_cvt_pk_bf16_f32 v206, v132, v133
v_mfma_f32_16x16x32_bf16 a[120:123], a[192:195], v[192:195], a[120:123]
v_exp_f32 v134, v134
v_mfma_f32_16x16x32_bf16 a[124:127], a[200:203], v[192:195], a[124:127]
buffer_load_dwordx4 v16, s[32:35], s70 offen offset:1024 sc1 lds
v_mfma_f32_16x16x32_bf16 a[124:127], a[204:207], v[196:199], a[124:127]
v_exp_f32 v135, v135
v_mfma_f32_16x16x32_bf16 a[92:95], a[204:207], v[188:191], a[92:95]
ds_read_b128 a[168:171], v2 offset:6144
v_cvt_pk_bf16_f32 v207, v134, v135
v_mfma_f32_16x16x32_bf16 a[92:95], a[200:203], v[184:187], a[92:95]
ds_read_b128 a[172:175], v2 offset:7168
s_lshl_b32 s72, s3, 1
s_sub_u32 s72, 13, s72
.p2align 3
L_S:
s_waitcnt lgkmcnt(7)
v_mfma_f32_16x16x32_bf16 v[120:123], a[144:147], v[56:59], v[224:227]
s_waitcnt lgkmcnt(6)
ds_read_b128 a[176:179], v2 offset:8192
ds_read_b128 a[180:183], v2 offset:9216
v_mfma_f32_16x16x32_bf16 v[120:123], a[148:151], v[60:63], v[120:123]
s_waitcnt lgkmcnt(7)
ds_read_b128 a[184:187], v2 offset:10240
v_mfma_f32_16x16x32_bf16 v[120:123], a[152:155], v[64:67], v[120:123]
s_waitcnt lgkmcnt(7)
buffer_load_dwordx4 v16, s[32:35], s70 offen offset:2048 sc1 lds
v_mfma_f32_16x16x32_bf16 v[120:123], a[156:159], v[68:71], v[120:123]
ds_read_b128 a[188:191], v2 offset:11264
ds_read_b128 a[192:195], v2 offset:12288
v_mfma_f32_16x16x32_bf16 v[136:139], a[156:159], v[84:87], v[228:231]
ds_read_b128 a[196:199], v2 offset:13312
v_mfma_f32_16x16x32_bf16 v[136:139], a[152:155], v[80:83], v[136:139]
buffer_load_dwordx4 v16, s[32:35], s70 offen offset:3072 sc1 lds
v_mfma_f32_16x16x32_bf16 v[136:139], a[148:151], v[76:79], v[136:139]
ds_read_b128 a[200:203], v2 offset:14336
ds_read_b128 a[204:207], v2 offset:15360
v_mfma_f32_16x16x32_bf16 v[136:139], a[144:147], v[72:75], v[136:139]
s_waitcnt lgkmcnt(5)
v_exp_f32 v120, v120
v_mfma_f32_16x16x32_bf16 v[140:143], a[160:163], v[72:75], v[228:231]
v_exp_f32 v121, v121
v_mfma_f32_16x16x32_bf16 v[140:143], a[164:167], v[76:79], v[140:143]
s_add_u32 m0, s71, 4096
v_exp_f32 v122, v122
v_mfma_f32_16x16x32_bf16 v[140:143], a[168:171], v[80:83], v[140:143]
v_exp_f32 v123, v123
v_mfma_f32_16x16x32_bf16 v[140:143], a[172:175], v[84:87], v[140:143]
v_exp_f32 v136, v136
v_mfma_f32_16x16x32_bf16 v[124:127], a[172:175], v[68:71], v[224:227]
ds_read_b128 a[144:147], v3 offset:0
v_cvt_pk_bf16_f32 v184, v120, v121
v_mfma_f32_16x16x32_bf16 v[124:127], a[168:171], v[64:67], v[124:127]
s_add_u32 s64, s70, 4096
v_exp_f32 v137, v137
v_mfma_f32_16x16x32_bf16 v[124:127], a[164:167], v[60:63], v[124:127]
ds_read_b128 a[148:151], v3 offset:8192
v_cvt_pk_bf16_f32 v185, v122, v123
v_mfma_f32_16x16x32_bf16 v[124:127], a[160:163], v[56:59], v[124:127]
v_exp_f32 v138, v138
v_mfma_f32_16x16x32_bf16 v[128:131], a[176:179], v[56:59], v[224:227]
ds_read_b128 a[152:155], v3 offset:1024
v_cvt_pk_bf16_f32 v192, v136, v137
v_mfma_f32_16x16x32_bf16 v[128:131], a[180:183], v[60:63], v[128:131]
v_exp_f32 v139, v139
v_mfma_f32_16x16x32_bf16 v[128:131], a[184:187], v[64:67], v[128:131]
s_waitcnt lgkmcnt(2)
ds_read_b128 a[156:159], v3 offset:9216
v_cvt_pk_bf16_f32 v193, v138, v139
v_mfma_f32_16x16x32_bf16 v[128:131], a[188:191], v[68:71], v[128:131]
v_exp_f32 v140, v140
v_mfma_f32_16x16x32_bf16 v[144:147], a[188:191], v[84:87], v[228:231]
buffer_load_dwordx4 v16, s[32:35], s64 offen offset:0 sc1 lds
v_mfma_f32_16x16x32_bf16 v[144:147], a[184:187], v[80:83], v[144:147]
v_exp_f32 v141, v141
v_mfma_f32_16x16x32_bf16 v[144:147], a[180:183], v[76:79], v[144:147]
ds_read_b128 a[160:163], v3 offset:2048
v_cvt_pk_bf16_f32 v194, v140, v141
v_mfma_f32_16x16x32_bf16 v[144:147], a[176:179], v[72:75], v[144:147]
v_exp_f32 v142, v142
v_mfma_f32_16x16x32_bf16 v[148:151], a[192:195], v[72:75], v[228:231]
ds_read_b128 a[164:167], v3 offset:10240
ds_read_b128 a[168:171], v3 offset:3072
v_mfma_f32_16x16x32_bf16 v[148:151], a[196:199], v[76:79], v[148:151]
v_exp_f32 v143, v143
v_mfma_f32_16x16x32_bf16 v[148:151], a[200:203], v[80:83], v[148:151]
ds_read_b128 a[172:175], v3 offset:11264
v_cvt_pk_bf16_f32 v195, v142, v143
v_mfma_f32_16x16x32_bf16 v[148:151], a[204:207], v[84:87], v[148:151]
v_exp_f32 v124, v124
v_mfma_f32_16x16x32_bf16 v[132:135], a[204:207], v[68:71], v[224:227]
buffer_load_dwordx4 v16, s[32:35], s64 offen offset:1024 sc1 lds
v_mfma_f32_16x16x32_bf16 v[132:135], a[200:203], v[64:67], v[132:135]
v_exp_f32 v125, v125
v_mfma_f32_16x16x32_bf16 v[132:135], a[196:199], v[60:63], v[132:135]
ds_read_b128 a[176:179], v3 offset:4096
v_cvt_pk_bf16_f32 v186, v124, v125
v_mfma_f32_16x16x32_bf16 v[132:135], a[192:195], v[56:59], v[132:135]
v_exp_f32 v126, v126
v_mfma_f32_16x16x32_bf16 a[136:139], a[244:247], v[200:203], a[136:139]
ds_read_b128 a[180:183], v3 offset:12288
ds_read_b128 a[184:187], v3 offset:5120
v_mfma_f32_16x16x32_bf16 a[136:139], a[244:247], v[204:207], a[136:139]
v_exp_f32 v127, v127
v_mfma_f32_16x16x32_bf16 a[140:143], a[244:247], v[208:211], a[140:143]
ds_read_b128 a[188:191], v3 offset:13312
v_cvt_pk_bf16_f32 v187, v126, v127
v_mfma_f32_16x16x32_bf16 a[140:143], a[244:247], v[212:215], a[140:143]
v_exp_f32 v128, v128
v_mfma_f32_16x16x32_bf16 a[64:67], a[144:147], v[200:203], a[64:67]
s_waitcnt lgkmcnt(3)
buffer_load_dwordx4 v16, s[32:35], s64 offen offset:2048 sc1 lds
v_mfma_f32_16x16x32_bf16 a[64:67], a[148:151], v[204:207], a[64:67]
v_exp_f32 v129, v129
v_mfma_f32_16x16x32_bf16 a[96:99], a[148:151], v[212:215], a[96:99]
ds_read_b128 a[192:195], v3 offset:6144
v_cvt_pk_bf16_f32 v188, v128, v129
v_mfma_f32_16x16x32_bf16 a[96:99], a[144:147], v[208:211], a[96:99]
v_exp_f32 v130, v130
v_mfma_f32_16x16x32_bf16 a[100:103], a[152:155], v[208:211], a[100:103]
ds_read_b128 a[196:199], v3 offset:14336
v_mfma_f32_16x16x32_bf16 a[100:103], a[156:159], v[212:215], a[100:103]
v_exp_f32 v131, v131
v_mfma_f32_16x16x32_bf16 a[68:71], a[156:159], v[204:207], a[68:71]
ds_read_b128 a[200:203], v3 offset:7168
v_cvt_pk_bf16_f32 v189, v130, v131
v_mfma_f32_16x16x32_bf16 a[68:71], a[152:155], v[200:203], a[68:71]
v_exp_f32 v144, v144
v_mfma_f32_16x16x32_bf16 a[72:75], a[160:163], v[200:203], a[72:75]
buffer_load_dwordx4 v16, s[32:35], s64 offen offset:3072 sc1 lds
v_mfma_f32_16x16x32_bf16 a[72:75], a[164:167], v[204:207], a[72:75]
s_xor_b32 s71, s71, 16384
v_exp_f32 v145, v145
v_mfma_f32_16x16x32_bf16 a[104:107], a[164:167], v[212:215], a[104:107]
ds_read_b128 a[204:207], v3 offset:15360
v_cvt_pk_bf16_f32 v196, v144, v145
v_mfma_f32_16x16x32_bf16 a[104:107], a[160:163], v[208:211], a[104:107]
v_exp_f32 v146, v146
v_mfma_f32_16x16x32_bf16 a[108:111], a[168:171], v[208:211], a[108:111]
s_waitcnt vmcnt(8)
s_barrier
v_mfma_f32_16x16x32_bf16 a[108:111], a[172:175], v[212:215], a[108:111]
s_add_u32 s70, s70, 32768
v_exp_f32 v147, v147
v_mfma_f32_16x16x32_bf16 a[76:79], a[172:175], v[204:207], a[76:79]
ds_read_b128 a[144:147], v2 offset:16384
v_cvt_pk_bf16_f32 v197, v146, v147
v_mfma_f32_16x16x32_bf16 a[76:79], a[168:171], v[200:203], a[76:79]
v_exp_f32 v148, v148
v_mfma_f32_16x16x32_bf16 a[80:83], a[176:179], v[200:203], a[80:83]
s_waitcnt lgkmcnt(1)
ds_read_b128 a[148:151], v2 offset:17408
v_mfma_f32_16x16x32_bf16 a[80:83], a[180:183], v[204:207], a[80:83]
s_mov_b32 m0, s71
v_exp_f32 v149, v149
v_mfma_f32_16x16x32_bf16 a[112:115], a[180:183], v[212:215], a[112:115]
ds_read_b128 a[152:155], v2 offset:18432
v_cvt_pk_bf16_f32 v198, v148, v149
v_mfma_f32_16x16x32_bf16 a[112:115], a[176:179], v[208:211], a[112:115]
v_exp_f32 v150, v150
v_mfma_f32_16x16x32_bf16 a[116:119], a[184:187], v[208:211], a[116:119]
buffer_load_dwordx4 v16, s[32:35], s70 offen offset:0 sc1 lds
v_mfma_f32_16x16x32_bf16 a[116:119], a[188:191], v[212:215], a[116:119]
v_exp_f32 v151, v151
v_mfma_f32_16x16x32_bf16 a[84:87], a[188:191], v[204:207], a[84:87]
ds_read_b128 a[156:159], v2 offset:19456
v_cvt_pk_bf16_f32 v199, v150, v151
v_mfma_f32_16x16x32_bf16 a[84:87], a[184:187], v[200:203], a[84:87]
v_exp_f32 v132, v132
v_mfma_f32_16x16x32_bf16 a[88:91], a[192:195], v[200:203], a[88:91]
ds_read_b128 a[160:163], v2 offset:20480
v_mfma_f32_16x16x32_bf16 a[88:91], a[196:199], v[204:207], a[88:91]
v_exp_f32 v133, v133
v_mfma_f32_16x16x32_bf16 a[120:123], a[196:199], v[212:215], a[120:123]
ds_read_b128 a[164:167], v2 offset:21504
v_cvt_pk_bf16_f32 v190, v132, v133
v_mfma_f32_16x16x32_bf16 a[120:123], a[192:195], v[208:211], a[120:123]
v_exp_f32 v134, v134
v_mfma_f32_16x16x32_bf16 a[124:127], a[200:203], v[208:211], a[124:127]
buffer_load_dwordx4 v16, s[32:35], s70 offen offset:1024 sc1 lds
v_mfma_f32_16x16x32_bf16 a[124:127], a[204:207], v[212:215], a[124:127]
v_exp_f32 v135, v135
v_mfma_f32_16x16x32_bf16 a[92:95], a[204:207], v[204:207], a[92:95]
ds_read_b128 a[168:171], v2 offset:22528
v_cvt_pk_bf16_f32 v191, v134, v135
v_mfma_f32_16x16x32_bf16 a[92:95], a[200:203], v[200:203], a[92:95]
s_waitcnt lgkmcnt(2)
ds_read_b128 a[172:175], v2 offset:23552
v_mfma_f32_16x16x32_bf16 v[120:123], a[144:147], v[56:59], v[224:227]
ds_read_b128 a[176:179], v2 offset:24576
ds_read_b128 a[180:183], v2 offset:25600
v_mfma_f32_16x16x32_bf16 v[120:123], a[148:151], v[60:63], v[120:123]
ds_read_b128 a[184:187], v2 offset:26624
v_mfma_f32_16x16x32_bf16 v[120:123], a[152:155], v[64:67], v[120:123]
buffer_load_dwordx4 v16, s[32:35], s70 offen offset:2048 sc1 lds
v_mfma_f32_16x16x32_bf16 v[120:123], a[156:159], v[68:71], v[120:123]
ds_read_b128 a[188:191], v2 offset:27648
ds_read_b128 a[192:195], v2 offset:28672
v_mfma_f32_16x16x32_bf16 v[136:139], a[156:159], v[84:87], v[228:231]
ds_read_b128 a[196:199], v2 offset:29696
v_mfma_f32_16x16x32_bf16 v[136:139], a[152:155], v[80:83], v[136:139]
buffer_load_dwordx4 v16, s[32:35], s70 offen offset:3072 sc1 lds
v_mfma_f32_16x16x32_bf16 v[136:139], a[148:151], v[76:79], v[136:139]
ds_read_b128 a[200:203], v2 offset:30720
ds_read_b128 a[204:207], v2 offset:31744
v_mfma_f32_16x16x32_bf16 v[136:139], a[144:147], v[72:75], v[136:139]
v_exp_f32 v120, v120
v_mfma_f32_16x16x32_bf16 v[140:143], a[160:163], v[72:75], v[228:231]
s_waitcnt lgkmcnt(5)
v_exp_f32 v121, v121
v_mfma_f32_16x16x32_bf16 v[140:143], a[164:167], v[76:79], v[140:143]
s_add_u32 m0, s71, 4096
v_exp_f32 v122, v122
v_mfma_f32_16x16x32_bf16 v[140:143], a[168:171], v[80:83], v[140:143]
v_exp_f32 v123, v123
v_mfma_f32_16x16x32_bf16 v[140:143], a[172:175], v[84:87], v[140:143]
v_exp_f32 v136, v136
v_mfma_f32_16x16x32_bf16 v[124:127], a[172:175], v[68:71], v[224:227]
ds_read_b128 a[144:147], v3 offset:16384
v_cvt_pk_bf16_f32 v200, v120, v121
v_mfma_f32_16x16x32_bf16 v[124:127], a[168:171], v[64:67], v[124:127]
s_add_u32 s64, s70, 4096
v_exp_f32 v137, v137
v_mfma_f32_16x16x32_bf16 v[124:127], a[164:167], v[60:63], v[124:127]
ds_read_b128 a[148:151], v3 offset:24576
v_cvt_pk_bf16_f32 v201, v122, v123
v_mfma_f32_16x16x32_bf16 v[124:127], a[160:163], v[56:59], v[124:127]
v_exp_f32 v138, v138
v_mfma_f32_16x16x32_bf16 v[128:131], a[176:179], v[56:59], v[224:227]
ds_read_b128 a[152:155], v3 offset:17408
v_cvt_pk_bf16_f32 v208, v136, v137
v_mfma_f32_16x16x32_bf16 v[128:131], a[180:183], v[60:63], v[128:131]
v_exp_f32 v139, v139
v_mfma_f32_16x16x32_bf16 v[128:131], a[184:187], v[64:67], v[128:131]
s_waitcnt lgkmcnt(2)
ds_read_b128 a[156:159], v3 offset:25600
v_cvt_pk_bf16_f32 v209, v138, v139
v_mfma_f32_16x16x32_bf16 v[128:131], a[188:191], v[68:71], v[128:131]
v_exp_f32 v140, v140
v_mfma_f32_16x16x32_bf16 v[144:147], a[188:191], v[84:87], v[228:231]
buffer_load_dwordx4 v16, s[32:35], s64 offen offset:0 sc1 lds
v_mfma_f32_16x16x32_bf16 v[144:147], a[184:187], v[80:83], v[144:147]
v_exp_f32 v141, v141
v_mfma_f32_16x16x32_bf16 v[144:147], a[180:183], v[76:79], v[144:147]
ds_read_b128 a[160:163], v3 offset:18432
v_cvt_pk_bf16_f32 v210, v140, v141
v_mfma_f32_16x16x32_bf16 v[144:147], a[176:179], v[72:75], v[144:147]
v_exp_f32 v142, v142
v_mfma_f32_16x16x32_bf16 v[148:151], a[192:195], v[72:75], v[228:231]
ds_read_b128 a[164:167], v3 offset:26624
ds_read_b128 a[168:171], v3 offset:19456
v_mfma_f32_16x16x32_bf16 v[148:151], a[196:199], v[76:79], v[148:151]
v_exp_f32 v143, v143
v_mfma_f32_16x16x32_bf16 v[148:151], a[200:203], v[80:83], v[148:151]
ds_read_b128 a[172:175], v3 offset:27648
v_cvt_pk_bf16_f32 v211, v142, v143
v_mfma_f32_16x16x32_bf16 v[148:151], a[204:207], v[84:87], v[148:151]
v_exp_f32 v124, v124
v_mfma_f32_16x16x32_bf16 v[132:135], a[204:207], v[68:71], v[224:227]
buffer_load_dwordx4 v16, s[32:35], s64 offen offset:1024 sc1 lds
v_mfma_f32_16x16x32_bf16 v[132:135], a[200:203], v[64:67], v[132:135]
v_exp_f32 v125, v125
v_mfma_f32_16x16x32_bf16 v[132:135], a[196:199], v[60:63], v[132:135]
ds_read_b128 a[176:179], v3 offset:20480
v_cvt_pk_bf16_f32 v202, v124, v125
v_mfma_f32_16x16x32_bf16 v[132:135], a[192:195], v[56:59], v[132:135]
v_exp_f32 v126, v126
v_mfma_f32_16x16x32_bf16 a[136:139], a[244:247], v[184:187], a[136:139]
ds_read_b128 a[180:183], v3 offset:28672
ds_read_b128 a[184:187], v3 offset:21504
v_mfma_f32_16x16x32_bf16 a[136:139], a[244:247], v[188:191], a[136:139]
v_exp_f32 v127, v127
v_mfma_f32_16x16x32_bf16 a[140:143], a[244:247], v[192:195], a[140:143]
ds_read_b128 a[188:191], v3 offset:29696
v_cvt_pk_bf16_f32 v203, v126, v127
v_mfma_f32_16x16x32_bf16 a[140:143], a[244:247], v[196:199], a[140:143]
v_exp_f32 v128, v128
v_mfma_f32_16x16x32_bf16 a[64:67], a[144:147], v[184:187], a[64:67]
s_waitcnt lgkmcnt(3)
buffer_load_dwordx4 v16, s[32:35], s64 offen offset:2048 sc1 lds
v_mfma_f32_16x16x32_bf16 a[64:67], a[148:151], v[188:191], a[64:67]
v_exp_f32 v129, v129
v_mfma_f32_16x16x32_bf16 a[96:99], a[148:151], v[196:199], a[96:99]
ds_read_b128 a[192:195], v3 offset:22528
v_cvt_pk_bf16_f32 v204, v128, v129
v_mfma_f32_16x16x32_bf16 a[96:99], a[144:147], v[192:195], a[96:99]
v_exp_f32 v130, v130
v_mfma_f32_16x16x32_bf16 a[100:103], a[152:155], v[192:195], a[100:103]
ds_read_b128 a[196:199], v3 offset:30720
v_xor_b32 v2, 0x8000, v2
v_mfma_f32_16x16x32_bf16 a[100:103], a[156:159], v[196:199], a[100:103]
v_exp_f32 v131, v131
v_mfma_f32_16x16x32_bf16 a[68:71], a[156:159], v[188:191], a[68:71]
ds_read_b128 a[200:203], v3 offset:23552
v_cvt_pk_bf16_f32 v205, v130, v131
v_mfma_f32_16x16x32_bf16 a[68:71], a[152:155], v[184:187], a[68:71]
v_exp_f32 v144, v144
v_mfma_f32_16x16x32_bf16 a[72:75], a[160:163], v[184:187], a[72:75]
buffer_load_dwordx4 v16, s[32:35], s64 offen offset:3072 sc1 lds
v_mfma_f32_16x16x32_bf16 a[72:75], a[164:167], v[188:191], a[72:75]
s_xor_b32 s71, s71, 49152
v_exp_f32 v145, v145
v_mfma_f32_16x16x32_bf16 a[104:107], a[164:167], v[196:199], a[104:107]
ds_read_b128 a[204:207], v3 offset:31744
v_cvt_pk_bf16_f32 v212, v144, v145
v_mfma_f32_16x16x32_bf16 a[104:107], a[160:163], v[192:195], a[104:107]
v_exp_f32 v146, v146
v_mfma_f32_16x16x32_bf16 a[108:111], a[168:171], v[192:195], a[108:111]
s_waitcnt vmcnt(8)
s_barrier
v_mfma_f32_16x16x32_bf16 a[108:111], a[172:175], v[196:199], a[108:111]
s_add_u32 s70, s70, 32768
v_exp_f32 v147, v147
v_mfma_f32_16x16x32_bf16 a[76:79], a[172:175], v[188:191], a[76:79]
ds_read_b128 a[144:147], v2 offset:0
v_cvt_pk_bf16_f32 v213, v146, v147
v_mfma_f32_16x16x32_bf16 a[76:79], a[168:171], v[184:187], a[76:79]
v_exp_f32 v148, v148
v_mfma_f32_16x16x32_bf16 a[80:83], a[176:179], v[184:187], a[80:83]
s_waitcnt lgkmcnt(1)
ds_read_b128 a[148:151], v2 offset:1024
v_xor_b32 v3, 0x8000, v3
v_mfma_f32_16x16x32_bf16 a[80:83], a[180:183], v[188:191], a[80:83]
s_mov_b32 m0, s71
v_exp_f32 v149, v149
v_mfma_f32_16x16x32_bf16 a[112:115], a[180:183], v[196:199], a[112:115]
ds_read_b128 a[152:155], v2 offset:2048
v_cvt_pk_bf16_f32 v214, v148, v149
v_mfma_f32_16x16x32_bf16 a[112:115], a[176:179], v[192:195], a[112:115]
v_exp_f32 v150, v150
v_mfma_f32_16x16x32_bf16 a[116:119], a[184:187], v[192:195], a[116:119]
buffer_load_dwordx4 v16, s[32:35], s70 offen offset:0 sc1 lds
v_mfma_f32_16x16x32_bf16 a[116:119], a[188:191], v[196:199], a[116:119]
s_sub_u32 s72, s72, 1
v_exp_f32 v151, v151
v_mfma_f32_16x16x32_bf16 a[84:87], a[188:191], v[188:191], a[84:87]
ds_read_b128 a[156:159], v2 offset:3072
v_cvt_pk_bf16_f32 v215, v150, v151
v_mfma_f32_16x16x32_bf16 a[84:87], a[184:187], v[184:187], a[84:87]
v_exp_f32 v132, v132
v_mfma_f32_16x16x32_bf16 a[88:91], a[192:195], v[184:187], a[88:91]
ds_read_b128 a[160:163], v2 offset:4096
v_mfma_f32_16x16x32_bf16 a[88:91], a[196:199], v[188:191], a[88:91]
s_cmp_lg_u32 s72, 0
v_exp_f32 v133, v133
v_mfma_f32_16x16x32_bf16 a[120:123], a[196:199], v[196:199], a[120:123]
ds_read_b128 a[164:167], v2 offset:5120
v_cvt_pk_bf16_f32 v206, v132, v133
v_mfma_f32_16x16x32_bf16 a[120:123], a[192:195], v[192:195], a[120:123]
v_exp_f32 v134, v134
v_mfma_f32_16x16x32_bf16 a[124:127], a[200:203], v[192:195], a[124:127]
buffer_load_dwordx4 v16, s[32:35], s70 offen offset:1024 sc1 lds
v_mfma_f32_16x16x32_bf16 a[124:127], a[204:207], v[196:199], a[124:127]
v_exp_f32 v135, v135
v_mfma_f32_16x16x32_bf16 a[92:95], a[204:207], v[188:191], a[92:95]
ds_read_b128 a[168:171], v2 offset:6144
v_cvt_pk_bf16_f32 v207, v134, v135
v_mfma_f32_16x16x32_bf16 a[92:95], a[200:203], v[184:187], a[92:95]
ds_read_b128 a[172:175], v2 offset:7168
s_cbranch_scc1 L_S
buffer_load_dword v19, off, s[52:55], s80 sc1
s_add_u32 s17, s78, L_TAIL-L_pc
buffer_load_dword a252, v16, s[88:91], s17 offen
s_add_u32 s17, s78, L_TAIL-L_pc+4096
buffer_load_dword a252, v16, s[88:91], s17 offen
s_add_u32 s17, s78, L_p5f0-L_pc
buffer_load_dword a252, v16, s[88:91], s17 offen
s_add_u32 s17, s78, L_p5f0-L_pc+4096
buffer_load_dword a252, v16, s[88:91], s17 offen
s_waitcnt lgkmcnt(7)
v_mfma_f32_16x16x32_bf16 v[136:139], a[144:147], v[72:75], v[228:231]
s_waitcnt lgkmcnt(6)
ds_read_b128 a[176:179], v2 offset:8192
ds_read_b128 a[180:183], v2 offset:9216
v_mfma_f32_16x16x32_bf16 v[136:139], a[148:151], v[76:79], v[136:139]
s_waitcnt lgkmcnt(7)
ds_read_b128 a[184:187], v2 offset:10240
v_cndmask_b32 v120, v224, v17, s[0:1]
v_cndmask_b32 v121, v224, v17, s[4:5]
v_cndmask_b32 v122, v224, v17, s[6:7]
v_cndmask_b32 v123, v224, v17, s[8:9]
v_mfma_f32_16x16x32_bf16 v[136:139], a[152:155], v[80:83], v[136:139]
s_waitcnt lgkmcnt(7)
buffer_load_dwordx4 v16, s[32:35], s70 offen offset:2048 sc1 lds
v_mfma_f32_16x16x32_bf16 v[136:139], a[156:159], v[84:87], v[136:139]
ds_read_b128 a[188:191], v2 offset:11264
ds_read_b128 a[192:195], v2 offset:12288
v_mfma_f32_16x16x32_bf16 v[120:123], a[156:159], v[68:71], v[120:123]
ds_read_b128 a[196:199], v2 offset:13312
v_cndmask_b32 v124, v224, v17, s[10:11]
v_mfma_f32_16x16x32_bf16 v[120:123], a[152:155], v[64:67], v[120:123]
buffer_load_dwordx4 v16, s[32:35], s70 offen offset:3072 sc1 lds
v_mfma_f32_16x16x32_bf16 v[120:123], a[148:151], v[60:63], v[120:123]
ds_read_b128 a[200:203], v2 offset:14336
ds_read_b128 a[204:207], v2 offset:15360
v_mfma_f32_16x16x32_bf16 v[120:123], a[144:147], v[56:59], v[120:123]
s_waitcnt lgkmcnt(5)
v_exp_f32 v136, v136
v_mfma_f32_16x16x32_bf16 v[140:143], a[160:163], v[72:75], v[228:231]
v_exp_f32 v137, v137
v_mfma_f32_16x16x32_bf16 v[140:143], a[164:167], v[76:79], v[140:143]
s_add_u32 m0, s71, 4096
v_cndmask_b32 v125, v224, v17, s[12:13]
v_cndmask_b32 v126, v224, v17, s[18:19]
v_cndmask_b32 v127, v224, v17, s[22:23]
v_exp_f32 v138, v138
v_mfma_f32_16x16x32_bf16 v[140:143], a[168:171], v[80:83], v[140:143]
v_exp_f32 v139, v139
v_mfma_f32_16x16x32_bf16 v[140:143], a[172:175], v[84:87], v[140:143]
v_exp_f32 v120, v120
v_mfma_f32_16x16x32_bf16 v[124:127], a[172:175], v[68:71], v[124:127]
ds_read_b128 a[144:147], v3 offset:0
v_cvt_pk_bf16_f32 v192, v136, v137
v_mfma_f32_16x16x32_bf16 v[124:127], a[168:171], v[64:67], v[124:127]
s_add_u32 s64, s70, 4096
v_cndmask_b32 v128, v224, v17, s[26:27]
v_cndmask_b32 v129, v224, v17, s[56:57]
v_cndmask_b32 v130, v224, v17, s[58:59]
v_cndmask_b32 v131, v224, v17, s[60:61]
v_exp_f32 v121, v121
v_mfma_f32_16x16x32_bf16 v[124:127], a[164:167], v[60:63], v[124:127]
s_mul_i32 s69, s83, 8
ds_read_b128 a[148:151], v3 offset:8192
v_cvt_pk_bf16_f32 v193, v138, v139
v_mfma_f32_16x16x32_bf16 v[124:127], a[160:163], v[56:59], v[124:127]
s_sub_u32 s69, 36, s69
v_exp_f32 v122, v122
v_mfma_f32_16x16x32_bf16 v[128:131], a[176:179], v[56:59], v[128:131]
ds_read_b128 a[152:155], v3 offset:1024
v_cvt_pk_bf16_f32 v184, v120, v121
v_mfma_f32_16x16x32_bf16 v[128:131], a[180:183], v[60:63], v[128:131]
v_exp_f32 v123, v123
v_mfma_f32_16x16x32_bf16 v[128:131], a[184:187], v[64:67], v[128:131]
s_waitcnt lgkmcnt(2)
ds_read_b128 a[156:159], v3 offset:9216
v_cvt_pk_bf16_f32 v185, v122, v123
v_mfma_f32_16x16x32_bf16 v[128:131], a[188:191], v[68:71], v[128:131]
v_exp_f32 v140, v140
v_mfma_f32_16x16x32_bf16 v[144:147], a[188:191], v[84:87], v[228:231]
buffer_load_dwordx4 v16, s[32:35], s64 offen offset:0 sc1 lds
v_mfma_f32_16x16x32_bf16 v[144:147], a[184:187], v[80:83], v[144:147]
v_exp_f32 v141, v141
v_mfma_f32_16x16x32_bf16 v[144:147], a[180:183], v[76:79], v[144:147]
ds_read_b128 a[160:163], v3 offset:2048
v_cvt_pk_bf16_f32 v194, v140, v141
v_mfma_f32_16x16x32_bf16 v[144:147], a[176:179], v[72:75], v[144:147]
v_exp_f32 v142, v142
v_mfma_f32_16x16x32_bf16 v[148:151], a[192:195], v[72:75], v[228:231]
ds_read_b128 a[164:167], v3 offset:10240
ds_read_b128 a[168:171], v3 offset:3072
v_mfma_f32_16x16x32_bf16 v[148:151], a[196:199], v[76:79], v[148:151]
v_cndmask_b32 v132, v224, v17, s[62:63]
v_cndmask_b32 v133, v224, v17, s[48:49]
v_cndmask_b32 v134, v224, v17, s[50:51]
v_cndmask_b32 v135, v224, v17, s[100:101]
v_exp_f32 v143, v143
v_mfma_f32_16x16x32_bf16 v[148:151], a[200:203], v[80:83], v[148:151]
ds_read_b128 a[172:175], v3 offset:11264
v_cvt_pk_bf16_f32 v195, v142, v143
v_mfma_f32_16x16x32_bf16 v[148:151], a[204:207], v[84:87], v[148:151]
v_exp_f32 v124, v124
v_mfma_f32_16x16x32_bf16 v[132:135], a[204:207], v[68:71], v[132:135]
buffer_load_dwordx4 v16, s[32:35], s64 offen offset:1024 sc1 lds
v_mfma_f32_16x16x32_bf16 v[132:135], a[200:203], v[64:67], v[132:135]
v_exp_f32 v125, v125
v_mfma_f32_16x16x32_bf16 v[132:135], a[196:199], v[60:63], v[132:135]
ds_read_b128 a[176:179], v3 offset:4096
v_cvt_pk_bf16_f32 v186, v124, v125
v_mfma_f32_16x16x32_bf16 v[132:135], a[192:195], v[56:59], v[132:135]
v_exp_f32 v126, v126
v_mfma_f32_16x16x32_bf16 a[136:139], a[244:247], v[200:203], a[136:139]
ds_read_b128 a[180:183], v3 offset:12288
ds_read_b128 a[184:187], v3 offset:5120
v_mfma_f32_16x16x32_bf16 a[136:139], a[244:247], v[204:207], a[136:139]
v_exp_f32 v127, v127
v_mfma_f32_16x16x32_bf16 a[140:143], a[244:247], v[208:211], a[140:143]
ds_read_b128 a[188:191], v3 offset:13312
v_cvt_pk_bf16_f32 v187, v126, v127
v_mfma_f32_16x16x32_bf16 a[140:143], a[244:247], v[212:215], a[140:143]
v_exp_f32 v128, v128
v_mfma_f32_16x16x32_bf16 a[64:67], a[144:147], v[200:203], a[64:67]
s_waitcnt lgkmcnt(3)
buffer_load_dwordx4 v16, s[32:35], s64 offen offset:2048 sc1 lds
v_mfma_f32_16x16x32_bf16 a[64:67], a[148:151], v[204:207], a[64:67]
v_exp_f32 v129, v129
v_mfma_f32_16x16x32_bf16 a[96:99], a[148:151], v[212:215], a[96:99]
ds_read_b128 a[192:195], v3 offset:6144
v_cvt_pk_bf16_f32 v188, v128, v129
v_mfma_f32_16x16x32_bf16 a[96:99], a[144:147], v[208:211], a[96:99]
v_exp_f32 v130, v130
v_mfma_f32_16x16x32_bf16 a[100:103], a[152:155], v[208:211], a[100:103]
ds_read_b128 a[196:199], v3 offset:14336
v_mfma_f32_16x16x32_bf16 a[100:103], a[156:159], v[212:215], a[100:103]
v_exp_f32 v131, v131
v_mfma_f32_16x16x32_bf16 a[68:71], a[156:159], v[204:207], a[68:71]
ds_read_b128 a[200:203], v3 offset:7168
v_cvt_pk_bf16_f32 v189, v130, v131
v_mfma_f32_16x16x32_bf16 a[68:71], a[152:155], v[200:203], a[68:71]
v_exp_f32 v144, v144
v_mfma_f32_16x16x32_bf16 a[72:75], a[160:163], v[200:203], a[72:75]
buffer_load_dwordx4 v16, s[32:35], s64 offen offset:3072 sc1 lds
v_mfma_f32_16x16x32_bf16 a[72:75], a[164:167], v[204:207], a[72:75]
v_exp_f32 v145, v145
v_mfma_f32_16x16x32_bf16 a[104:107], a[164:167], v[212:215], a[104:107]
ds_read_b128 a[204:207], v3 offset:15360
v_cvt_pk_bf16_f32 v196, v144, v145
v_mfma_f32_16x16x32_bf16 a[104:107], a[160:163], v[208:211], a[104:107]
v_exp_f32 v146, v146
v_mfma_f32_16x16x32_bf16 a[108:111], a[168:171], v[208:211], a[108:111]
s_waitcnt vmcnt(13)
s_barrier
v_mfma_f32_16x16x32_bf16 a[108:111], a[172:175], v[212:215], a[108:111]
v_exp_f32 v147, v147
v_mfma_f32_16x16x32_bf16 a[76:79], a[172:175], v[204:207], a[76:79]
ds_read_b128 a[144:147], v2 offset:16384
v_cvt_pk_bf16_f32 v197, v146, v147
v_mfma_f32_16x16x32_bf16 a[76:79], a[168:171], v[200:203], a[76:79]
v_exp_f32 v148, v148
v_mfma_f32_16x16x32_bf16 a[80:83], a[176:179], v[200:203], a[80:83]
s_waitcnt vmcnt(10)
v_readfirstlane_b32 vcc_lo, v19
s_nop 0
s_cmp_lt_u32 vcc_lo, s69
s_cbranch_scc1 L_spin_8
L_spinbk_9:
ds_read_b128 a[148:151], v2 offset:17408
s_waitcnt lgkmcnt(2)
v_mfma_f32_16x16x32_bf16 a[80:83], a[180:183], v[204:207], a[80:83]
v_exp_f32 v149, v149
v_mfma_f32_16x16x32_bf16 a[112:115], a[180:183], v[212:215], a[112:115]
ds_read_b128 a[152:155], v2 offset:18432
v_cvt_pk_bf16_f32 v198, v148, v149
v_mfma_f32_16x16x32_bf16 a[112:115], a[176:179], v[208:211], a[112:115]
v_exp_f32 v150, v150
v_mfma_f32_16x16x32_bf16 a[116:119], a[184:187], v[208:211], a[116:119]
v_cndmask_b32 v136, v228, v17, s[0:1]
v_cndmask_b32 v137, v228, v17, s[4:5]
v_mfma_f32_16x16x32_bf16 a[116:119], a[188:191], v[212:215], a[116:119]
v_exp_f32 v151, v151
v_mfma_f32_16x16x32_bf16 a[84:87], a[188:191], v[204:207], a[84:87]
ds_read_b128 a[156:159], v2 offset:19456
v_cvt_pk_bf16_f32 v199, v150, v151
v_mfma_f32_16x16x32_bf16 a[84:87], a[184:187], v[200:203], a[84:87]
v_exp_f32 v132, v132
v_mfma_f32_16x16x32_bf16 a[88:91], a[192:195], v[200:203], a[88:91]
ds_read_b128 a[160:163], v2 offset:20480
v_cndmask_b32 v138, v228, v17, s[6:7]
v_mfma_f32_16x16x32_bf16 a[88:91], a[196:199], v[204:207], a[88:91]
v_exp_f32 v133, v133
v_mfma_f32_16x16x32_bf16 a[120:123], a[196:199], v[212:215], a[120:123]
ds_read_b128 a[164:167], v2 offset:21504
v_cvt_pk_bf16_f32 v190, v132, v133
v_mfma_f32_16x16x32_bf16 a[120:123], a[192:195], v[208:211], a[120:123]
v_exp_f32 v134, v134
v_mfma_f32_16x16x32_bf16 a[124:127], a[200:203], v[208:211], a[124:127]
v_cndmask_b32 v139, v228, v17, s[8:9]
v_cndmask_b32 v140, v228, v17, s[10:11]
v_mfma_f32_16x16x32_bf16 a[124:127], a[204:207], v[212:215], a[124:127]
v_exp_f32 v135, v135
v_mfma_f32_16x16x32_bf16 a[92:95], a[204:207], v[204:207], a[92:95]
ds_read_b128 a[168:171], v2 offset:22528
v_cvt_pk_bf16_f32 v191, v134, v135
v_mfma_f32_16x16x32_bf16 a[92:95], a[200:203], v[200:203], a[92:95]
s_waitcnt lgkmcnt(2)
ds_read_b128 a[172:175], v2 offset:23552
v_cndmask_b32 v141, v228, v17, s[12:13]
v_mfma_f32_16x16x32_bf16 v[136:139], a[144:147], v[72:75], v[136:139]
ds_read_b128 a[176:179], v2 offset:24576
v_cndmask_b32 v142, v228, v17, s[18:19]
v_mfma_f32_16x16x32_bf16 v[136:139], a[148:151], v[76:79], v[136:139]
ds_read_b128 a[180:183], v2 offset:25600
v_cndmask_b32 v143, v228, v17, s[22:23]
v_mfma_f32_16x16x32_bf16 v[136:139], a[152:155], v[80:83], v[136:139]
ds_read_b128 a[184:187], v2 offset:26624
v_cndmask_b32 v144, v228, v17, s[26:27]
v_mfma_f32_16x16x32_bf16 v[136:139], a[156:159], v[84:87], v[136:139]
s_waitcnt lgkmcnt(3)
ds_read_b128 a[188:191], v2 offset:27648
v_cndmask_b32 v145, v228, v17, s[56:57]
v_mfma_f32_16x16x32_bf16 v[140:143], a[172:175], v[84:87], v[140:143]
ds_read_b128 a[192:195], v2 offset:28672
ds_read_b128 a[196:199], v2 offset:29696
ds_read_b128 a[200:203], v2 offset:30720
ds_read_b128 a[204:207], v2 offset:31744
v_mfma_f32_16x16x32_bf16 v[140:143], a[168:171], v[80:83], v[140:143]
ds_read_b128 a[144:147], v3 offset:16384
v_cndmask_b32 v146, v228, v17, s[58:59]
v_cndmask_b32 v147, v228, v17, s[60:61]
v_mfma_f32_16x16x32_bf16 v[140:143], a[164:167], v[76:79], v[140:143]
ds_read_b128 a[148:151], v3 offset:24576
v_cndmask_b32 v148, v228, v17, s[62:63]
v_mfma_f32_16x16x32_bf16 v[140:143], a[160:163], v[72:75], v[140:143]
s_waitcnt lgkmcnt(8)
ds_read_b128 a[152:155], v3 offset:17408
v_cndmask_b32 v149, v228, v17, s[48:49]
v_mfma_f32_16x16x32_bf16 v[144:147], a[176:179], v[72:75], v[144:147]
ds_read_b128 a[156:159], v3 offset:25600
v_cndmask_b32 v150, v228, v17, s[50:51]
v_mfma_f32_16x16x32_bf16 v[144:147], a[180:183], v[76:79], v[144:147]
s_waitcnt lgkmcnt(8)
ds_read_b128 a[160:163], v3 offset:18432
v_cndmask_b32 v151, v228, v17, s[100:101]
v_mfma_f32_16x16x32_bf16 v[144:147], a[184:187], v[80:83], v[144:147]
v_exp_f32 v136, v136
v_mfma_f32_16x16x32_bf16 v[144:147], a[188:191], v[84:87], v[144:147]
s_waitcnt lgkmcnt(4)
v_exp_f32 v137, v137
v_mfma_f32_16x16x32_bf16 v[148:151], a[204:207], v[84:87], v[148:151]
v_exp_f32 v138, v138
v_mfma_f32_16x16x32_bf16 v[148:151], a[200:203], v[80:83], v[148:151]
s_add_u32 s65, s84, 0
v_exp_f32 v139, v139
v_mfma_f32_16x16x32_bf16 v[148:151], a[196:199], v[76:79], v[148:151]
buffer_load_dwordx4 a[208:211], v14, s[44:47], s65 offen offset:0 sc1
v_mfma_f32_16x16x32_bf16 v[148:151], a[192:195], v[72:75], v[148:151]
ds_read_b128 a[164:167], v3 offset:26624
v_cvt_pk_bf16_f32 v208, v136, v137
v_mfma_f32_16x16x32_bf16 a[136:139], a[244:247], v[184:187], a[136:139]
v_exp_f32 v140, v140
v_mfma_f32_16x16x32_bf16 a[136:139], a[244:247], v[188:191], a[136:139]
buffer_load_dwordx4 a[216:219], v14, s[44:47], s65 offen offset:1024 sc1
v_mfma_f32_16x16x32_bf16 a[140:143], a[244:247], v[192:195], a[140:143]
v_exp_f32 v141, v141
v_mfma_f32_16x16x32_bf16 a[140:143], a[244:247], v[196:199], a[140:143]
ds_read_b128 a[168:171], v3 offset:19456
v_cvt_pk_bf16_f32 v209, v138, v139
v_mfma_f32_16x16x32_bf16 a[64:67], a[144:147], v[184:187], a[64:67]
s_waitcnt lgkmcnt(2)
buffer_load_dwordx4 a[224:227], v15, s[44:47], s65 offen offset:0 sc1
v_mfma_f32_16x16x32_bf16 a[64:67], a[148:151], v[188:191], a[64:67]
ds_read_b128 a[172:175], v3 offset:27648
v_cvt_pk_bf16_f32 v210, v140, v141
v_mfma_f32_16x16x32_bf16 a[96:99], a[148:151], v[196:199], a[96:99]
v_exp_f32 v142, v142
v_mfma_f32_16x16x32_bf16 a[96:99], a[144:147], v[192:195], a[96:99]
buffer_load_dwordx4 a[232:235], v15, s[44:47], s65 offen offset:1024 sc1
v_mfma_f32_16x16x32_bf16 a[100:103], a[152:155], v[192:195], a[100:103]
s_add_u32 s65, s84, 8192
ds_read_b128 a[176:179], v3 offset:20480
v_xor_b32 v2, 0x8000, v2
v_mfma_f32_16x16x32_bf16 a[100:103], a[156:159], v[196:199], a[100:103]
buffer_load_dwordx4 a[212:215], v14, s[44:47], s65 offen offset:0 sc1
v_mfma_f32_16x16x32_bf16 a[68:71], a[156:159], v[188:191], a[68:71]
v_exp_f32 v143, v143
v_mfma_f32_16x16x32_bf16 a[68:71], a[152:155], v[184:187], a[68:71]
ds_read_b128 a[180:183], v3 offset:28672
v_cvt_pk_bf16_f32 v211, v142, v143
v_mfma_f32_16x16x32_bf16 a[72:75], a[160:163], v[184:187], a[72:75]
s_waitcnt lgkmcnt(2)
buffer_load_dwordx4 a[220:223], v14, s[44:47], s65 offen offset:1024 sc1
v_mfma_f32_16x16x32_bf16 a[72:75], a[164:167], v[188:191], a[72:75]
v_exp_f32 v144, v144
v_mfma_f32_16x16x32_bf16 a[104:107], a[164:167], v[196:199], a[104:107]
ds_read_b128 a[184:187], v3 offset:21504
v_accvgpr_read_b32 v22, a136
v_mfma_f32_16x16x32_bf16 a[104:107], a[160:163], v[192:195], a[104:107]
buffer_load_dwordx4 a[228:231], v15, s[44:47], s65 offen offset:0 sc1
v_mfma_f32_16x16x32_bf16 a[108:111], a[168:171], v[192:195], a[108:111]
ds_read_b128 a[188:191], v3 offset:29696
v_max_f32 v1, v1, v22
v_mfma_f32_16x16x32_bf16 a[108:111], a[172:175], v[196:199], a[108:111]
v_exp_f32 v145, v145
v_mfma_f32_16x16x32_bf16 a[76:79], a[172:175], v[188:191], a[76:79]
buffer_load_dwordx4 a[236:239], v15, s[44:47], s65 offen offset:1024 sc1
v_mfma_f32_16x16x32_bf16 a[76:79], a[168:171], v[184:187], a[76:79]
s_waitcnt lgkmcnt(2)
v_exp_f32 v146, v146
v_mfma_f32_16x16x32_bf16 a[80:83], a[176:179], v[184:187], a[80:83]
s_add_u32 s65, s84, 32768
ds_read_b128 a[192:195], v3 offset:22528
v_cvt_pk_bf16_f32 v212, v144, v145
v_mfma_f32_16x16x32_bf16 a[80:83], a[180:183], v[188:191], a[80:83]
buffer_load_dwordx4 v[152:155], v14, s[44:47], s65 offen offset:0 sc1
ds_read_b128 a[196:199], v3 offset:30720
ds_read_b128 a[200:203], v3 offset:23552
ds_read_b128 a[204:207], v3 offset:31744
v_mfma_f32_16x16x32_bf16 a[112:115], a[180:183], v[196:199], a[112:115]
s_waitcnt vmcnt(9)
s_barrier
v_xor_b32 v3, 0x8000, v3
v_mfma_f32_16x16x32_bf16 a[112:115], a[176:179], v[192:195], a[112:115]
s_waitcnt lgkmcnt(4)
buffer_load_dwordx4 v[160:163], v14, s[44:47], s65 offen offset:1024 sc1
v_exp_f32 v147, v147
v_mfma_f32_16x16x32_bf16 a[116:119], a[184:187], v[192:195], a[116:119]
v_exp_f32 v148, v148
v_mfma_f32_16x16x32_bf16 a[116:119], a[188:191], v[196:199], a[116:119]
buffer_load_dwordx4 v[168:171], v15, s[44:47], s65 offen offset:0 sc1
v_mfma_f32_16x16x32_bf16 a[84:87], a[188:191], v[188:191], a[84:87]
v_exp_f32 v149, v149
v_mfma_f32_16x16x32_bf16 a[84:87], a[184:187], v[184:187], a[84:87]
s_waitcnt lgkmcnt(0)
buffer_load_dwordx4 v[176:179], v15, s[44:47], s65 offen offset:1024 sc1
v_mfma_f32_16x16x32_bf16 a[88:91], a[192:195], v[184:187], a[88:91]
s_add_u32 s65, s84, 40960
ds_read_b128 a[144:147], v3 offset:0
v_cvt_pk_bf16_f32 v213, v146, v147
v_mfma_f32_16x16x32_bf16 a[88:91], a[196:199], v[188:191], a[88:91]
buffer_load_dwordx4 v[156:159], v14, s[44:47], s65 offen offset:0 sc1
v_mfma_f32_16x16x32_bf16 a[120:123], a[196:199], v[196:199], a[120:123]
v_exp_f32 v150, v150
v_mfma_f32_16x16x32_bf16 a[120:123], a[192:195], v[192:195], a[120:123]
buffer_load_dwordx4 v[164:167], v14, s[44:47], s65 offen offset:1024 sc1
ds_read_b128 a[148:151], v3 offset:8192
v_mfma_f32_16x16x32_bf16 a[124:127], a[200:203], v[192:195], a[124:127]
ds_read_b128 a[152:155], v3 offset:1024
v_cvt_pk_bf16_f32 v214, v148, v149
v_mfma_f32_16x16x32_bf16 a[124:127], a[204:207], v[196:199], a[124:127]
buffer_load_dwordx4 v[172:175], v15, s[44:47], s65 offen offset:0 sc1
ds_read_b128 a[156:159], v3 offset:9216
v_mfma_f32_16x16x32_bf16 a[92:95], a[204:207], v[188:191], a[92:95]
v_exp_f32 v151, v151
v_mfma_f32_16x16x32_bf16 a[92:95], a[200:203], v[184:187], a[92:95]
buffer_load_dwordx4 v[180:183], v15, s[44:47], s65 offen offset:1024 sc1
ds_read_b128 a[160:163], v3 offset:2048
ds_read_b128 a[164:167], v3 offset:10240
ds_read_b128 a[168:171], v3 offset:3072
ds_read_b128 a[172:175], v3 offset:11264
v_cvt_pk_bf16_f32 v215, v150, v151
v_rcp_f32 v22, v22
v_accvgpr_read_b32 v232, a64
v_accvgpr_read_b32 v233, a65
v_accvgpr_read_b32 v234, a66
v_accvgpr_read_b32 v235, a67
v_accvgpr_read_b32 v236, a68
v_accvgpr_read_b32 v237, a69
v_accvgpr_read_b32 v238, a70
v_accvgpr_read_b32 v239, a71
v_mul_f32 v22, v22, v8
v_mul_f32 v232, v232, v22
v_mul_f32 v233, v233, v22
v_mul_f32 v234, v234, v22
v_mul_f32 v235, v235, v22
v_mul_f32 v236, v236, v22
v_mul_f32 v237, v237, v22
v_mul_f32 v238, v238, v22
v_mul_f32 v239, v239, v22
v_cvt_pk_bf16_f32 v232, v232, v233
v_cvt_pk_bf16_f32 v233, v234, v235
v_cvt_pk_bf16_f32 v234, v236, v237
v_cvt_pk_bf16_f32 v235, v238, v239
s_add_u32 s77, s75, 0
buffer_store_dwordx4 v[232:235], v16, s[44:47], s77 offen sc1
L_TAIL:
ds_read_b128 a[176:179], v3 offset:4096
ds_read_b128 a[180:183], v3 offset:12288
ds_read_b128 a[184:187], v3 offset:5120
ds_read_b128 a[188:191], v3 offset:13312
v_mfma_f32_16x16x32_bf16 a[140:143], a[244:247], v[208:211], a[140:143]
ds_read_b128 a[192:195], v3 offset:6144
ds_read_b128 a[196:199], v3 offset:14336
v_mfma_f32_16x16x32_bf16 a[140:143], a[244:247], v[212:215], a[140:143]
s_waitcnt lgkmcnt(13)
s_add_u32 m0, s86, 32768
ds_read_b128 a[200:203], v3 offset:7168
ds_read_b128 a[204:207], v3 offset:15360
v_mfma_f32_16x16x32_bf16 a[96:99], a[144:147], v[208:211], a[96:99]
s_waitcnt lgkmcnt(14)
s_add_u32 s64, s85, 262144
v_accvgpr_read_b32 v240, a72
v_accvgpr_read_b32 v241, a73
v_mfma_f32_16x16x32_bf16 a[96:99], a[148:151], v[212:215], a[96:99]
s_waitcnt lgkmcnt(12)
buffer_load_dwordx4 v12, s[36:39], s64 offen lds
v_mfma_f32_16x16x32_bf16 a[100:103], a[156:159], v[212:215], a[100:103]
s_add_u32 m0, s86, 33792
s_add_u32 s64, s85, 270336
v_accvgpr_read_b32 v242, a74
v_accvgpr_read_b32 v243, a75
v_mfma_f32_16x16x32_bf16 a[100:103], a[152:155], v[208:211], a[100:103]
s_waitcnt lgkmcnt(11)
buffer_load_dwordx4 v13, s[36:39], s64 offen lds
v_mfma_f32_16x16x32_bf16 a[104:107], a[160:163], v[208:211], a[104:107]
s_waitcnt lgkmcnt(10)
s_add_u32 m0, s86, 34816
s_add_u32 s64, s85, 278528
v_accvgpr_read_b32 v244, a76
v_accvgpr_read_b32 v245, a77
v_mfma_f32_16x16x32_bf16 a[104:107], a[164:167], v[212:215], a[104:107]
s_waitcnt lgkmcnt(8)
buffer_load_dwordx4 v12, s[36:39], s64 offen lds
v_mfma_f32_16x16x32_bf16 a[108:111], a[172:175], v[212:215], a[108:111]
s_add_u32 m0, s86, 35840
s_add_u32 s64, s85, 286720
v_accvgpr_read_b32 v246, a78
v_accvgpr_read_b32 v247, a79
v_mfma_f32_16x16x32_bf16 a[108:111], a[168:171], v[208:211], a[108:111]
s_waitcnt lgkmcnt(7)
buffer_load_dwordx4 v13, s[36:39], s64 offen lds
v_mfma_f32_16x16x32_bf16 a[112:115], a[176:179], v[208:211], a[112:115]
s_waitcnt lgkmcnt(6)
s_add_u32 m0, s86, 36864
s_add_u32 s64, s85, 294912
v_mul_f32 v240, v240, v22
v_mul_f32 v241, v241, v22
v_mfma_f32_16x16x32_bf16 a[112:115], a[180:183], v[212:215], a[112:115]
s_waitcnt lgkmcnt(4)
buffer_load_dwordx4 v12, s[36:39], s64 offen lds
v_mfma_f32_16x16x32_bf16 a[116:119], a[188:191], v[212:215], a[116:119]
s_add_u32 m0, s86, 37888
s_add_u32 s64, s85, 303104
v_mul_f32 v242, v242, v22
v_mul_f32 v243, v243, v22
v_mfma_f32_16x16x32_bf16 a[116:119], a[184:187], v[208:211], a[116:119]
s_waitcnt lgkmcnt(3)
buffer_load_dwordx4 v13, s[36:39], s64 offen lds
v_mfma_f32_16x16x32_bf16 a[120:123], a[192:195], v[208:211], a[120:123]
s_waitcnt lgkmcnt(2)
s_add_u32 m0, s86, 38912
s_add_u32 s64, s85, 311296
v_mul_f32 v244, v244, v22
v_mul_f32 v245, v245, v22
v_mfma_f32_16x16x32_bf16 a[120:123], a[196:199], v[212:215], a[120:123]
s_waitcnt lgkmcnt(0)
buffer_load_dwordx4 v12, s[36:39], s64 offen lds
v_mfma_f32_16x16x32_bf16 a[124:127], a[204:207], v[212:215], a[124:127]
s_add_u32 m0, s86, 39936
s_add_u32 s64, s85, 319488
v_mul_f32 v246, v246, v22
v_mul_f32 v247, v247, v22
v_mfma_f32_16x16x32_bf16 a[124:127], a[200:203], v[208:211], a[124:127]
buffer_load_dwordx4 v13, s[36:39], s64 offen lds
v_cvt_pk_bf16_f32 v240, v240, v241
v_cvt_pk_bf16_f32 v241, v242, v243
v_cvt_pk_bf16_f32 v242, v244, v245
v_cvt_pk_bf16_f32 v243, v246, v247
s_add_u32 s77, s75, 8192
buffer_store_dwordx4 v[240:243], v16, s[44:47], s77 offen sc1
v_accvgpr_read_b32 v23, a140
v_max_f32 v1, v1, v23
v_rcp_f32 v23, v23
s_mov_b32 s66, 0x5d800000
v_cmp_le_f32 vcc, s66, v1
s_lshl_b32 s67, s30, 2
s_cmp_lg_u64 vcc, 0
s_cselect_b32 s66, 1, 0
v_mov_b32 v248, s67
v_mov_b32 v249, s66
ds_write_b32 v248, v249
v_accvgpr_read_b32 v232, a80
v_accvgpr_read_b32 v233, a81
v_accvgpr_read_b32 v234, a82
v_accvgpr_read_b32 v235, a83
v_accvgpr_read_b32 v236, a84
v_accvgpr_read_b32 v237, a85
v_accvgpr_read_b32 v238, a86
v_accvgpr_read_b32 v239, a87
v_pk_mul_f32 v[232:233], v[232:233], v[22:23] op_sel_hi:[1,0]
v_pk_mul_f32 v[234:235], v[234:235], v[22:23] op_sel_hi:[1,0]
v_pk_mul_f32 v[236:237], v[236:237], v[22:23] op_sel_hi:[1,0]
v_pk_mul_f32 v[238:239], v[238:239], v[22:23] op_sel_hi:[1,0]
v_cvt_pk_bf16_f32 v232, v232, v233
v_cvt_pk_bf16_f32 v233, v234, v235
v_cvt_pk_bf16_f32 v234, v236, v237
v_cvt_pk_bf16_f32 v235, v238, v239
s_add_u32 s77, s75, 16384
buffer_store_dwordx4 v[232:235], v16, s[44:47], s77 offen sc1
v_accvgpr_read_b32 v240, a88
v_accvgpr_read_b32 v241, a89
v_accvgpr_read_b32 v242, a90
v_accvgpr_read_b32 v243, a91
v_accvgpr_read_b32 v244, a92
v_accvgpr_read_b32 v245, a93
v_accvgpr_read_b32 v246, a94
v_accvgpr_read_b32 v247, a95
v_pk_mul_f32 v[240:241], v[240:241], v[22:23] op_sel_hi:[1,0]
v_pk_mul_f32 v[242:243], v[242:243], v[22:23] op_sel_hi:[1,0]
v_pk_mul_f32 v[244:245], v[244:245], v[22:23] op_sel_hi:[1,0]
v_pk_mul_f32 v[246:247], v[246:247], v[22:23] op_sel_hi:[1,0]
v_cvt_pk_bf16_f32 v240, v240, v241
v_cvt_pk_bf16_f32 v241, v242, v243
v_cvt_pk_bf16_f32 v242, v244, v245
v_cvt_pk_bf16_f32 v243, v246, v247
s_add_u32 s77, s75, 24576
buffer_store_dwordx4 v[240:243], v16, s[44:47], s77 offen sc1
v_accvgpr_read_b32 v232, a96
v_accvgpr_read_b32 v233, a97
v_accvgpr_read_b32 v234, a98
v_accvgpr_read_b32 v235, a99
v_accvgpr_read_b32 v236, a100
v_accvgpr_read_b32 v237, a101
v_accvgpr_read_b32 v238, a102
v_accvgpr_read_b32 v239, a103
v_mul_f32 v23, v23, v10
v_pk_mul_f32 v[232:233], v[232:233], v[22:23] op_sel:[0,1]
v_pk_mul_f32 v[234:235], v[234:235], v[22:23] op_sel:[0,1]
v_pk_mul_f32 v[236:237], v[236:237], v[22:23] op_sel:[0,1]
v_pk_mul_f32 v[238:239], v[238:239], v[22:23] op_sel:[0,1]
v_cvt_pk_bf16_f32 v232, v232, v233
v_cvt_pk_bf16_f32 v233, v234, v235
v_cvt_pk_bf16_f32 v234, v236, v237
v_cvt_pk_bf16_f32 v235, v238, v239
s_add_u32 s77, s75, 4096
buffer_store_dwordx4 v[232:235], v16, s[44:47], s77 offen sc1
v_accvgpr_read_b32 v240, a104
v_accvgpr_read_b32 v241, a105
v_accvgpr_read_b32 v242, a106
v_accvgpr_read_b32 v243, a107
v_accvgpr_read_b32 v244, a108
v_accvgpr_read_b32 v245, a109
v_accvgpr_read_b32 v246, a110
v_accvgpr_read_b32 v247, a111
v_pk_mul_f32 v[240:241], v[240:241], v[22:23] op_sel:[0,1]
v_pk_mul_f32 v[242:243], v[242:243], v[22:23] op_sel:[0,1]
v_pk_mul_f32 v[244:245], v[244:245], v[22:23] op_sel:[0,1]
v_pk_mul_f32 v[246:247], v[246:247], v[22:23] op_sel:[0,1]
v_cvt_pk_bf16_f32 v240, v240, v241
v_cvt_pk_bf16_f32 v241, v242, v243
v_cvt_pk_bf16_f32 v242, v244, v245
v_cvt_pk_bf16_f32 v243, v246, v247
s_add_u32 s77, s75, 12288
buffer_store_dwordx4 v[240:243], v16, s[44:47], s77 offen sc1
v_accvgpr_read_b32 v232, a112
v_accvgpr_read_b32 v233, a113
v_accvgpr_read_b32 v234, a114
v_accvgpr_read_b32 v235, a115
v_accvgpr_read_b32 v236, a116
v_accvgpr_read_b32 v237, a117
v_accvgpr_read_b32 v238, a118
v_accvgpr_read_b32 v239, a119
v_pk_mul_f32 v[232:233], v[232:233], v[22:23] op_sel:[0,1]
v_pk_mul_f32 v[234:235], v[234:235], v[22:23] op_sel:[0,1]
v_pk_mul_f32 v[236:237], v[236:237], v[22:23] op_sel:[0,1]
v_pk_mul_f32 v[238:239], v[238:239], v[22:23] op_sel:[0,1]
v_cvt_pk_bf16_f32 v232, v232, v233
v_cvt_pk_bf16_f32 v233, v234, v235
v_cvt_pk_bf16_f32 v234, v236, v237
v_cvt_pk_bf16_f32 v235, v238, v239
s_add_u32 s77, s75, 20480
buffer_store_dwordx4 v[232:235], v16, s[44:47], s77 offen sc1
v_accvgpr_read_b32 v240, a120
v_accvgpr_read_b32 v241, a121
v_accvgpr_read_b32 v242, a122
v_accvgpr_read_b32 v243, a123
v_accvgpr_read_b32 v244, a124
v_accvgpr_read_b32 v245, a125
v_accvgpr_read_b32 v246, a126
v_accvgpr_read_b32 v247, a127
v_pk_mul_f32 v[240:241], v[240:241], v[22:23] op_sel:[0,1]
v_pk_mul_f32 v[242:243], v[242:243], v[22:23] op_sel:[0,1]
v_pk_mul_f32 v[244:245], v[244:245], v[22:23] op_sel:[0,1]
v_pk_mul_f32 v[246:247], v[246:247], v[22:23] op_sel:[0,1]
v_cvt_pk_bf16_f32 v240, v240, v241
v_cvt_pk_bf16_f32 v241, v242, v243
v_cvt_pk_bf16_f32 v242, v244, v245
v_cvt_pk_bf16_f32 v243, v246, v247
s_add_u32 s77, s75, 28672
buffer_store_dwordx4 v[240:243], v16, s[44:47], s77 offen sc1
v_mov_b32 v248, 0
s_waitcnt lgkmcnt(0)
s_barrier
ds_read_b128 v[248:251], v248
v_xor_b32 v188, 128, v18
v_xor_b32 v189, 160, v18
v_xor_b32 v190, 192, v18
ds_read_b64_tr_b16 a[144:145], v188 offset:32768
ds_read_b64_tr_b16 a[146:147], v188 offset:36864
ds_read_b64_tr_b16 a[148:149], v188 offset:40960
ds_read_b64_tr_b16 a[150:151], v188 offset:45056
ds_read_b64_tr_b16 a[152:153], v189 offset:32768
ds_read_b64_tr_b16 a[154:155], v189 offset:36864
ds_read_b64_tr_b16 a[156:157], v189 offset:40960
ds_read_b64_tr_b16 a[158:159], v189 offset:45056
ds_read_b64_tr_b16 a[160:161], v190 offset:32768
ds_read_b64_tr_b16 a[162:163], v190 offset:36864
ds_read_b64_tr_b16 a[164:165], v190 offset:40960
ds_read_b64_tr_b16 a[166:167], v190 offset:45056
v_xor_b32 v191, 224, v18
v_xor_b32 v184, 0, v18
v_xor_b32 v185, 32, v18
v_xor_b32 v186, 64, v18
v_xor_b32 v187, 96, v18
s_waitcnt lgkmcnt(12)
v_or3_b32 v248, v248, v249, v250
v_or_b32 v248, v248, v251
s_nop 0
v_readfirstlane_b32 s66, v248
s_nop 0
s_cmp_gt_u32 s66, s73
s_cbranch_scc1 L_fallback_11
s_cmp_eq_u32 s83, 0
s_cbranch_scc1 L_p5f0
s_waitcnt lgkmcnt(10)
s_waitcnt vmcnt(28)
v_mfma_f32_16x16x32_bf16 v[136:139], a[144:147], a[232:235], 0
s_waitcnt vmcnt(24)
s_waitcnt lgkmcnt(8)
s_add_u32 m0, s86, 98304
ds_read_b64_tr_b16 a[168:169], v191 offset:32768
v_xor_b32 v192, 0x10000, v184
v_mfma_f32_16x16x32_bf16 v[136:139], a[148:151], a[236:239], v[136:139]
s_add_u32 s64, s85, 524288
ds_read_b64_tr_b16 a[170:171], v191 offset:36864
v_xor_b32 v193, 0x10000, v185
v_mfma_f32_16x16x32_bf16 v[104:107], a[148:151], a[228:231], 0
buffer_load_dwordx4 v12, s[36:39], s64 offen lds
v_mfma_f32_16x16x32_bf16 v[104:107], a[144:147], a[224:227], v[104:107]
s_add_u32 m0, s86, 99328
s_add_u32 s64, s85, 532480
ds_read_b64_tr_b16 a[172:173], v191 offset:40960
v_xor_b32 v194, 0x10000, v186
v_mfma_f32_16x16x32_bf16 v[72:75], a[144:147], a[216:219], 0
s_and_b32 s71, s31, 4
buffer_load_dwordx4 v13, s[36:39], s64 offen lds
v_mfma_f32_16x16x32_bf16 v[72:75], a[148:151], a[220:223], v[72:75]
s_lshl_b32 s71, s71, 5
s_add_u32 s71, s71, s79
s_add_u32 m0, s86, 100352
s_add_u32 s64, s85, 540672
ds_read_b64_tr_b16 a[174:175], v191 offset:45056
v_mfma_f32_16x16x32_bf16 v[40:43], a[148:151], a[212:215], 0
s_add_u32 s71, s71, 4096
buffer_load_dwordx4 v12, s[36:39], s64 offen lds
v_mfma_f32_16x16x32_bf16 v[40:43], a[144:147], a[208:211], v[40:43]
s_waitcnt lgkmcnt(4)
s_add_u32 s72, s80, 4096
s_add_u32 m0, s86, 101376
s_add_u32 s64, s85, 548864
ds_read_b64_tr_b16 a[176:177], v184 offset:32768
v_xor_b32 v195, 0x10000, v187
v_mfma_f32_16x16x32_bf16 v[44:47], a[152:155], a[208:211], 0
buffer_load_dwordx4 v13, s[36:39], s64 offen lds
v_mfma_f32_16x16x32_bf16 v[44:47], a[156:159], a[212:215], v[44:47]
s_add_u32 m0, s86, 102400
ds_read_b64_tr_b16 a[178:179], v184 offset:36864
v_xor_b32 v196, 0x10000, v188
v_mfma_f32_16x16x32_bf16 v[76:79], a[156:159], a[220:223], 0
s_add_u32 s64, s85, 557056
ds_read_b64_tr_b16 a[180:181], v184 offset:40960
v_xor_b32 v197, 0x10000, v189
v_mfma_f32_16x16x32_bf16 v[76:79], a[152:155], a[216:219], v[76:79]
buffer_load_dwordx4 v12, s[36:39], s64 offen lds
v_mfma_f32_16x16x32_bf16 v[108:111], a[152:155], a[224:227], 0
s_add_u32 m0, s86, 103424
s_add_u32 s64, s85, 565248
ds_read_b64_tr_b16 a[182:183], v184 offset:45056
v_xor_b32 v198, 0x10000, v190
v_mfma_f32_16x16x32_bf16 v[108:111], a[156:159], a[228:231], v[108:111]
buffer_load_dwordx4 v13, s[36:39], s64 offen lds
v_mfma_f32_16x16x32_bf16 v[140:143], a[156:159], a[236:239], 0
s_add_u32 m0, s86, 104448
s_add_u32 s64, s85, 573440
ds_read_b64_tr_b16 a[184:185], v185 offset:32768
v_xor_b32 v199, 0x10000, v191
v_mfma_f32_16x16x32_bf16 v[140:143], a[152:155], a[232:235], v[140:143]
buffer_load_dwordx4 v12, s[36:39], s64 offen lds
v_mfma_f32_16x16x32_bf16 v[144:147], a[160:163], a[232:235], 0
s_add_u32 m0, s86, 105472
ds_read_b64_tr_b16 a[186:187], v185 offset:36864
v_mfma_f32_16x16x32_bf16 v[144:147], a[164:167], a[236:239], v[144:147]
s_add_u32 s64, s85, 581632
ds_read_b64_tr_b16 a[188:189], v185 offset:40960
v_mfma_f32_16x16x32_bf16 v[112:115], a[164:167], a[228:231], 0
buffer_load_dwordx4 v13, s[36:39], s64 offen lds
v_mfma_f32_16x16x32_bf16 v[112:115], a[160:163], a[224:227], v[112:115]
s_add_u32 s65, s84, 65536
ds_read_b64_tr_b16 a[190:191], v185 offset:45056
v_mfma_f32_16x16x32_bf16 v[80:83], a[160:163], a[216:219], 0
buffer_load_dwordx4 a[32:35], v14, s[44:47], s65 offen offset:0 sc1
v_mfma_f32_16x16x32_bf16 v[80:83], a[164:167], a[220:223], v[80:83]
ds_read_b64_tr_b16 a[192:193], v186 offset:32768
v_mfma_f32_16x16x32_bf16 v[48:51], a[164:167], a[212:215], 0
buffer_load_dwordx4 a[40:43], v14, s[44:47], s65 offen offset:1024 sc1
v_mfma_f32_16x16x32_bf16 v[48:51], a[160:163], a[208:211], v[48:51]
s_waitcnt lgkmcnt(4)
ds_read_b64_tr_b16 a[194:195], v186 offset:36864
v_mfma_f32_16x16x32_bf16 v[52:55], a[168:171], a[208:211], 0
ds_read_b64_tr_b16 a[196:197], v186 offset:40960
v_mfma_f32_16x16x32_bf16 v[52:55], a[172:175], a[212:215], v[52:55]
buffer_load_dwordx4 a[48:51], v15, s[44:47], s65 offen offset:0 sc1
v_mfma_f32_16x16x32_bf16 v[84:87], a[172:175], a[220:223], 0
ds_read_b64_tr_b16 a[198:199], v186 offset:45056
v_mfma_f32_16x16x32_bf16 v[84:87], a[168:171], a[216:219], v[84:87]
buffer_load_dwordx4 a[56:59], v15, s[44:47], s65 offen offset:1024 sc1
v_mfma_f32_16x16x32_bf16 v[116:119], a[168:171], a[224:227], 0
s_add_u32 s65, s84, 73728
ds_read_b64_tr_b16 a[200:201], v187 offset:32768
v_mfma_f32_16x16x32_bf16 v[116:119], a[172:175], a[228:231], v[116:119]
buffer_load_dwordx4 a[36:39], v14, s[44:47], s65 offen offset:0 sc1
v_mfma_f32_16x16x32_bf16 v[148:151], a[172:175], a[236:239], 0
ds_read_b64_tr_b16 a[202:203], v187 offset:36864
v_mfma_f32_16x16x32_bf16 v[148:151], a[168:171], a[232:235], v[148:151]
ds_read_b64_tr_b16 a[204:205], v187 offset:40960
v_mfma_f32_16x16x32_bf16 v[120:123], a[176:179], a[232:235], 0
buffer_load_dwordx4 a[44:47], v14, s[44:47], s65 offen offset:1024 sc1
v_mfma_f32_16x16x32_bf16 v[120:123], a[180:183], a[236:239], v[120:123]
ds_read_b64_tr_b16 a[206:207], v187 offset:45056
v_mfma_f32_16x16x32_bf16 v[88:91], a[180:183], a[228:231], 0
buffer_load_dwordx4 a[52:55], v15, s[44:47], s65 offen offset:0 sc1
v_mfma_f32_16x16x32_bf16 v[88:91], a[176:179], a[224:227], v[88:91]
v_mfma_f32_16x16x32_bf16 v[56:59], a[176:179], a[216:219], 0
buffer_load_dwordx4 a[60:63], v15, s[44:47], s65 offen offset:1024 sc1
v_mfma_f32_16x16x32_bf16 v[56:59], a[180:183], a[220:223], v[56:59]
v_mfma_f32_16x16x32_bf16 v[24:27], a[180:183], a[212:215], 0
v_mfma_f32_16x16x32_bf16 v[24:27], a[176:179], a[208:211], v[24:27]
s_waitcnt lgkmcnt(1)
buffer_load_dword v19, off, s[52:55], s72 sc1
v_mfma_f32_16x16x32_bf16 v[28:31], a[184:187], a[208:211], 0
s_add_u32 s85, s85, 2883584
s_waitcnt vmcnt(24) lgkmcnt(0)
s_barrier
v_mfma_f32_16x16x32_bf16 v[28:31], a[188:191], a[212:215], v[28:31]
ds_read_b64_tr_b16 a[144:145], v196 offset:0
v_mfma_f32_16x16x32_bf16 v[60:63], a[188:191], a[220:223], 0
ds_read_b64_tr_b16 a[146:147], v196 offset:4096
v_mfma_f32_16x16x32_bf16 v[60:63], a[184:187], a[216:219], v[60:63]
s_add_u32 m0, s86, 131072
ds_read_b64_tr_b16 a[148:149], v196 offset:8192
v_mfma_f32_16x16x32_bf16 v[92:95], a[184:187], a[224:227], 0
s_add_u32 s64, s85, 0
ds_read_b64_tr_b16 a[150:151], v196 offset:12288
v_mfma_f32_16x16x32_bf16 v[92:95], a[188:191], a[228:231], v[92:95]
buffer_load_dwordx4 v12, s[40:43], s64 offen lds
v_mfma_f32_16x16x32_bf16 v[124:127], a[188:191], a[236:239], 0
s_add_u32 m0, s86, 132096
ds_read_b64_tr_b16 a[152:153], v197 offset:0
v_mfma_f32_16x16x32_bf16 v[124:127], a[184:187], a[232:235], v[124:127]
s_add_u32 s64, s85, 8192
ds_read_b64_tr_b16 a[154:155], v197 offset:4096
v_mfma_f32_16x16x32_bf16 v[128:131], a[192:195], a[232:235], 0
buffer_load_dwordx4 v13, s[40:43], s64 offen lds
v_mfma_f32_16x16x32_bf16 v[128:131], a[196:199], a[236:239], v[128:131]
ds_read_b64_tr_b16 a[156:157], v197 offset:8192
v_mfma_f32_16x16x32_bf16 v[96:99], a[196:199], a[228:231], 0
s_add_u32 m0, s86, 133120
ds_read_b64_tr_b16 a[158:159], v197 offset:12288
v_mfma_f32_16x16x32_bf16 v[96:99], a[192:195], a[224:227], v[96:99]
s_add_u32 s64, s85, 16384
ds_read_b64_tr_b16 a[160:161], v198 offset:0
v_mfma_f32_16x16x32_bf16 v[64:67], a[192:195], a[216:219], 0
buffer_load_dwordx4 v12, s[40:43], s64 offen lds
v_mfma_f32_16x16x32_bf16 v[64:67], a[196:199], a[220:223], v[64:67]
ds_read_b64_tr_b16 a[162:163], v198 offset:4096
v_mfma_f32_16x16x32_bf16 v[32:35], a[196:199], a[212:215], 0
s_add_u32 m0, s86, 134144
ds_read_b64_tr_b16 a[164:165], v198 offset:8192
v_mfma_f32_16x16x32_bf16 v[32:35], a[192:195], a[208:211], v[32:35]
s_add_u32 s64, s85, 24576
ds_read_b64_tr_b16 a[166:167], v198 offset:12288
v_mfma_f32_16x16x32_bf16 v[36:39], a[200:203], a[208:211], 0
buffer_load_dwordx4 v13, s[40:43], s64 offen lds
v_mfma_f32_16x16x32_bf16 v[36:39], a[204:207], a[212:215], v[36:39]
v_mfma_f32_16x16x32_bf16 v[68:71], a[204:207], a[220:223], 0
s_add_u32 m0, s86, 135168
v_mfma_f32_16x16x32_bf16 v[68:71], a[200:203], a[216:219], v[68:71]
s_add_u32 s64, s85, 32768
v_mfma_f32_16x16x32_bf16 v[100:103], a[200:203], a[224:227], 0
buffer_load_dwordx4 v12, s[40:43], s64 offen lds
v_mfma_f32_16x16x32_bf16 v[100:103], a[204:207], a[228:231], v[100:103]
v_mfma_f32_16x16x32_bf16 v[132:135], a[204:207], a[236:239], 0
v_mfma_f32_16x16x32_bf16 v[132:135], a[200:203], a[232:235], v[132:135]
s_waitcnt lgkmcnt(0)
v_mfma_f32_16x16x32_bf16 v[136:139], a[144:147], v[176:179], v[136:139]
s_waitcnt vmcnt(5)
v_readfirstlane_b32 vcc_lo, v19
s_nop 0
s_cmp_lt_u32 vcc_lo, 8
s_cbranch_scc1 L_spin_2016
L_spinbk_2017:
s_sub_u32 s84, s84, 688128
v_mfma_f32_16x16x32_bf16 v[136:139], a[148:151], v[180:183], v[136:139]
s_add_u32 m0, s86, 136192
s_add_u32 s64, s85, 40960
ds_read_b64_tr_b16 a[168:169], v199 offset:0
v_mfma_f32_16x16x32_bf16 v[104:107], a[148:151], v[172:175], v[104:107]
buffer_load_dwordx4 v13, s[40:43], s64 offen lds
v_mfma_f32_16x16x32_bf16 v[104:107], a[144:147], v[168:171], v[104:107]
s_add_u32 m0, s86, 137216
ds_read_b64_tr_b16 a[170:171], v199 offset:4096
v_mfma_f32_16x16x32_bf16 v[72:75], a[144:147], v[160:163], v[72:75]
s_add_u32 s64, s85, 49152
ds_read_b64_tr_b16 a[172:173], v199 offset:8192
v_mfma_f32_16x16x32_bf16 v[72:75], a[148:151], v[164:167], v[72:75]
buffer_load_dwordx4 v12, s[40:43], s64 offen lds
v_mfma_f32_16x16x32_bf16 v[40:43], a[148:151], v[156:159], v[40:43]
s_add_u32 m0, s86, 138240
ds_read_b64_tr_b16 a[174:175], v199 offset:12288
v_mfma_f32_16x16x32_bf16 v[40:43], a[144:147], v[152:155], v[40:43]
s_add_u32 s64, s85, 57344
ds_read_b64_tr_b16 a[176:177], v192 offset:0
v_mfma_f32_16x16x32_bf16 v[44:47], a[152:155], v[152:155], v[44:47]
buffer_load_dwordx4 v13, s[40:43], s64 offen lds
v_mfma_f32_16x16x32_bf16 v[44:47], a[156:159], v[156:159], v[44:47]
ds_read_b64_tr_b16 a[178:179], v192 offset:4096
v_mfma_f32_16x16x32_bf16 v[76:79], a[156:159], v[164:167], v[76:79]
ds_read_b64_tr_b16 a[180:181], v192 offset:8192
v_mfma_f32_16x16x32_bf16 v[76:79], a[152:155], v[160:163], v[76:79]
s_add_u32 s65, s84, 0
ds_read_b64_tr_b16 a[182:183], v192 offset:12288
v_mfma_f32_16x16x32_bf16 v[108:111], a[152:155], v[168:171], v[108:111]
buffer_load_dwordx4 a[208:211], v14, s[44:47], s65 offen offset:0 sc1
v_mfma_f32_16x16x32_bf16 v[108:111], a[156:159], v[172:175], v[108:111]
ds_read_b64_tr_b16 a[184:185], v193 offset:0
v_mfma_f32_16x16x32_bf16 v[140:143], a[156:159], v[180:183], v[140:143]
ds_read_b64_tr_b16 a[186:187], v193 offset:4096
v_mfma_f32_16x16x32_bf16 v[140:143], a[152:155], v[176:179], v[140:143]
buffer_load_dwordx4 a[216:219], v14, s[44:47], s65 offen offset:1024 sc1
v_mfma_f32_16x16x32_bf16 v[144:147], a[160:163], v[176:179], v[144:147]
ds_read_b64_tr_b16 a[188:189], v193 offset:8192
v_mfma_f32_16x16x32_bf16 v[144:147], a[164:167], v[180:183], v[144:147]
ds_read_b64_tr_b16 a[190:191], v193 offset:12288
v_mfma_f32_16x16x32_bf16 v[112:115], a[164:167], v[172:175], v[112:115]
s_add_u32 s17, s78, L_p5loop-L_pc+0
buffer_load_dwordx4 a[224:227], v15, s[44:47], s65 offen offset:0 sc1
v_mfma_f32_16x16x32_bf16 v[112:115], a[160:163], v[168:171], v[112:115]
buffer_load_dword a252, v16, s[88:91], s17 offen
v_mfma_f32_16x16x32_bf16 v[80:83], a[160:163], v[160:163], v[80:83]
ds_read_b64_tr_b16 a[192:193], v194 offset:0
v_mfma_f32_16x16x32_bf16 v[80:83], a[164:167], v[164:167], v[80:83]
ds_read_b64_tr_b16 a[194:195], v194 offset:4096
v_mfma_f32_16x16x32_bf16 v[48:51], a[164:167], v[156:159], v[48:51]
buffer_load_dwordx4 a[232:235], v15, s[44:47], s65 offen offset:1024 sc1
v_mfma_f32_16x16x32_bf16 v[48:51], a[160:163], v[152:155], v[48:51]
s_waitcnt lgkmcnt(4)
ds_read_b64_tr_b16 a[196:197], v194 offset:8192
v_mfma_f32_16x16x32_bf16 v[52:55], a[168:171], v[152:155], v[52:55]
s_add_u32 s65, s84, 8192
ds_read_b64_tr_b16 a[198:199], v194 offset:12288
v_mfma_f32_16x16x32_bf16 v[52:55], a[172:175], v[156:159], v[52:55]
s_add_u32 s17, s78, L_p5loop-L_pc+4096
buffer_load_dwordx4 a[212:215], v14, s[44:47], s65 offen offset:0 sc1
v_mfma_f32_16x16x32_bf16 v[84:87], a[172:175], v[164:167], v[84:87]
buffer_load_dword a252, v16, s[88:91], s17 offen
v_mfma_f32_16x16x32_bf16 v[84:87], a[168:171], v[160:163], v[84:87]
ds_read_b64_tr_b16 a[200:201], v195 offset:0
v_mfma_f32_16x16x32_bf16 v[116:119], a[168:171], v[168:171], v[116:119]
s_lshl_b32 s66, s30, 30
buffer_load_dwordx4 a[220:223], v14, s[44:47], s65 offen offset:1024 sc1
v_mfma_f32_16x16x32_bf16 v[116:119], a[172:175], v[172:175], v[116:119]
ds_read_b64_tr_b16 a[202:203], v195 offset:4096
v_lshl_add_u32 v1, v0, 24, s66
v_mfma_f32_16x16x32_bf16 v[148:151], a[172:175], v[180:183], v[148:151]
ds_read_b64_tr_b16 a[204:205], v195 offset:8192
v_mfma_f32_16x16x32_bf16 v[148:151], a[168:171], v[176:179], v[148:151]
ds_read_b64_tr_b16 a[206:207], v195 offset:12288
v_mfma_f32_16x16x32_bf16 v[120:123], a[176:179], v[176:179], v[120:123]
s_add_u32 s17, s78, L_p5loop-L_pc+8192
buffer_load_dwordx4 a[228:231], v15, s[44:47], s65 offen offset:0 sc1
v_mfma_f32_16x16x32_bf16 v[120:123], a[180:183], v[180:183], v[120:123]
buffer_load_dword a252, v16, s[88:91], s17 offen
v_mfma_f32_16x16x32_bf16 v[88:91], a[180:183], v[172:175], v[88:91]
v_mfma_f32_16x16x32_bf16 v[88:91], a[176:179], v[168:171], v[88:91]
buffer_load_dwordx4 a[236:239], v15, s[44:47], s65 offen offset:1024 sc1
v_mfma_f32_16x16x32_bf16 v[56:59], a[176:179], v[160:163], v[56:59]
v_mfma_f32_16x16x32_bf16 v[56:59], a[180:183], v[164:167], v[56:59]
v_mfma_f32_16x16x32_bf16 v[24:27], a[180:183], v[156:159], v[24:27]
v_mfma_f32_16x16x32_bf16 v[24:27], a[176:179], v[152:155], v[24:27]
v_mfma_f32_16x16x32_bf16 v[28:31], a[184:187], v[152:155], v[28:31]
s_waitcnt lgkmcnt(0)
s_barrier
v_mfma_f32_16x16x32_bf16 v[28:31], a[188:191], v[156:159], v[28:31]
s_mov_b64 exec, 1
buffer_atomic_add a251, v1, s[52:55], s71 offen offset:0 sc1
s_mov_b64 exec, -1
v_mfma_f32_16x16x32_bf16 v[60:63], a[188:191], v[164:167], v[60:63]
ds_read_b64_tr_b16 a[144:145], v188 offset:0
v_mfma_f32_16x16x32_bf16 v[60:63], a[184:187], v[160:163], v[60:63]
s_add_u32 m0, s86, 32768
ds_read_b64_tr_b16 a[146:147], v188 offset:4096
v_mfma_f32_16x16x32_bf16 v[92:95], a[184:187], v[168:171], v[92:95]
s_add_u32 s64, s85, 262144
ds_read_b64_tr_b16 a[148:149], v188 offset:8192
v_mfma_f32_16x16x32_bf16 v[92:95], a[188:191], v[172:175], v[92:95]
buffer_load_dwordx4 v12, s[40:43], s64 offen lds
v_mfma_f32_16x16x32_bf16 v[124:127], a[188:191], v[180:183], v[124:127]
s_add_u32 m0, s86, 33792
ds_read_b64_tr_b16 a[150:151], v188 offset:12288
v_mfma_f32_16x16x32_bf16 v[124:127], a[184:187], v[176:179], v[124:127]
s_add_u32 s64, s85, 270336
ds_read_b64_tr_b16 a[152:153], v189 offset:0
v_mfma_f32_16x16x32_bf16 v[128:131], a[192:195], v[176:179], v[128:131]
buffer_load_dwordx4 v13, s[40:43], s64 offen lds
v_mfma_f32_16x16x32_bf16 v[128:131], a[196:199], v[180:183], v[128:131]
ds_read_b64_tr_b16 a[154:155], v189 offset:4096
v_mfma_f32_16x16x32_bf16 v[96:99], a[196:199], v[172:175], v[96:99]
s_add_u32 m0, s86, 34816
ds_read_b64_tr_b16 a[156:157], v189 offset:8192
v_mfma_f32_16x16x32_bf16 v[96:99], a[192:195], v[168:171], v[96:99]
s_add_u32 s64, s85, 278528
ds_read_b64_tr_b16 a[158:159], v189 offset:12288
v_mfma_f32_16x16x32_bf16 v[64:67], a[192:195], v[160:163], v[64:67]
buffer_load_dwordx4 v12, s[40:43], s64 offen lds
v_mfma_f32_16x16x32_bf16 v[64:67], a[196:199], v[164:167], v[64:67]
ds_read_b64_tr_b16 a[160:161], v190 offset:0
v_mfma_f32_16x16x32_bf16 v[32:35], a[196:199], v[156:159], v[32:35]
s_add_u32 m0, s86, 35840
ds_read_b64_tr_b16 a[162:163], v190 offset:4096
v_mfma_f32_16x16x32_bf16 v[32:35], a[192:195], v[152:155], v[32:35]
s_add_u32 s64, s85, 286720
ds_read_b64_tr_b16 a[164:165], v190 offset:8192
v_mfma_f32_16x16x32_bf16 v[36:39], a[200:203], v[152:155], v[36:39]
buffer_load_dwordx4 v13, s[40:43], s64 offen lds
v_mfma_f32_16x16x32_bf16 v[36:39], a[204:207], v[156:159], v[36:39]
ds_read_b64_tr_b16 a[166:167], v190 offset:12288
v_mfma_f32_16x16x32_bf16 v[68:71], a[204:207], v[164:167], v[68:71]
s_add_u32 m0, s86, 36864
v_mfma_f32_16x16x32_bf16 v[68:71], a[200:203], v[160:163], v[68:71]
s_add_u32 s64, s85, 294912
v_mfma_f32_16x16x32_bf16 v[100:103], a[200:203], v[168:171], v[100:103]
buffer_load_dwordx4 v12, s[40:43], s64 offen lds
v_mfma_f32_16x16x32_bf16 v[100:103], a[204:207], v[172:175], v[100:103]
v_mfma_f32_16x16x32_bf16 v[132:135], a[204:207], v[180:183], v[132:135]
v_mfma_f32_16x16x32_bf16 v[132:135], a[200:203], v[176:179], v[132:135]
s_waitcnt lgkmcnt(1)
v_mfma_f32_16x16x32_bf16 v[136:139], a[144:147], a[56:59], v[136:139]
s_add_u32 m0, s86, 37888
ds_read_b64_tr_b16 a[168:169], v191 offset:0
v_mfma_f32_16x16x32_bf16 v[136:139], a[148:151], a[60:63], v[136:139]
s_add_u32 s64, s85, 303104
ds_read_b64_tr_b16 a[170:171], v191 offset:4096
v_mfma_f32_16x16x32_bf16 v[104:107], a[148:151], a[52:55], v[104:107]
buffer_load_dwordx4 v13, s[40:43], s64 offen lds
v_mfma_f32_16x16x32_bf16 v[104:107], a[144:147], a[48:51], v[104:107]
s_add_u32 m0, s86, 38912
ds_read_b64_tr_b16 a[172:173], v191 offset:8192
v_mfma_f32_16x16x32_bf16 v[72:75], a[144:147], a[40:43], v[72:75]
s_add_u32 s64, s85, 311296
ds_read_b64_tr_b16 a[174:175], v191 offset:12288
v_mfma_f32_16x16x32_bf16 v[72:75], a[148:151], a[44:47], v[72:75]
buffer_load_dwordx4 v12, s[40:43], s64 offen lds
v_mfma_f32_16x16x32_bf16 v[40:43], a[148:151], a[36:39], v[40:43]
s_add_u32 m0, s86, 39936
ds_read_b64_tr_b16 a[176:177], v184 offset:0
v_mfma_f32_16x16x32_bf16 v[40:43], a[144:147], a[32:35], v[40:43]
s_add_u32 s64, s85, 319488
ds_read_b64_tr_b16 a[178:179], v184 offset:4096
v_mfma_f32_16x16x32_bf16 v[44:47], a[152:155], a[32:35], v[44:47]
buffer_load_dwordx4 v13, s[40:43], s64 offen lds
v_mfma_f32_16x16x32_bf16 v[44:47], a[156:159], a[36:39], v[44:47]
ds_read_b64_tr_b16 a[180:181], v184 offset:8192
v_mfma_f32_16x16x32_bf16 v[76:79], a[156:159], a[44:47], v[76:79]
ds_read_b64_tr_b16 a[182:183], v184 offset:12288
v_mfma_f32_16x16x32_bf16 v[76:79], a[152:155], a[40:43], v[76:79]
s_add_u32 s65, s84, 32768
ds_read_b64_tr_b16 a[184:185], v185 offset:0
v_mfma_f32_16x16x32_bf16 v[108:111], a[152:155], a[48:51], v[108:111]
buffer_load_dwordx4 v[152:155], v14, s[44:47], s65 offen offset:0 sc1
v_mfma_f32_16x16x32_bf16 v[108:111], a[156:159], a[52:55], v[108:111]
ds_read_b64_tr_b16 a[186:187], v185 offset:4096
v_mfma_f32_16x16x32_bf16 v[140:143], a[156:159], a[60:63], v[140:143]
ds_read_b64_tr_b16 a[188:189], v185 offset:8192
v_mfma_f32_16x16x32_bf16 v[140:143], a[152:155], a[56:59], v[140:143]
buffer_load_dwordx4 v[160:163], v14, s[44:47], s65 offen offset:1024 sc1
v_mfma_f32_16x16x32_bf16 v[144:147], a[160:163], a[56:59], v[144:147]
s_waitcnt lgkmcnt(5)
ds_read_b64_tr_b16 a[190:191], v185 offset:12288
v_mfma_f32_16x16x32_bf16 v[144:147], a[164:167], a[60:63], v[144:147]
v_mfma_f32_16x16x32_bf16 v[112:115], a[164:167], a[52:55], v[112:115]
buffer_load_dwordx4 v[168:171], v15, s[44:47], s65 offen offset:0 sc1
v_mfma_f32_16x16x32_bf16 v[112:115], a[160:163], a[48:51], v[112:115]
ds_read_b64_tr_b16 a[192:193], v186 offset:0
v_mfma_f32_16x16x32_bf16 v[80:83], a[160:163], a[40:43], v[80:83]
ds_read_b64_tr_b16 a[194:195], v186 offset:4096
v_mfma_f32_16x16x32_bf16 v[80:83], a[164:167], a[44:47], v[80:83]
ds_read_b64_tr_b16 a[196:197], v186 offset:8192
v_mfma_f32_16x16x32_bf16 v[48:51], a[164:167], a[36:39], v[48:51]
buffer_load_dwordx4 v[176:179], v15, s[44:47], s65 offen offset:1024 sc1
v_mfma_f32_16x16x32_bf16 v[48:51], a[160:163], a[32:35], v[48:51]
ds_read_b64_tr_b16 a[198:199], v186 offset:12288
v_mfma_f32_16x16x32_bf16 v[52:55], a[168:171], a[32:35], v[52:55]
s_add_u32 s65, s84, 40960
v_mfma_f32_16x16x32_bf16 v[52:55], a[172:175], a[36:39], v[52:55]
buffer_load_dwordx4 v[156:159], v14, s[44:47], s65 offen offset:0 sc1
v_mfma_f32_16x16x32_bf16 v[84:87], a[172:175], a[44:47], v[84:87]
ds_read_b64_tr_b16 a[200:201], v187 offset:0
v_mfma_f32_16x16x32_bf16 v[84:87], a[168:171], a[40:43], v[84:87]
ds_read_b64_tr_b16 a[202:203], v187 offset:4096
v_mfma_f32_16x16x32_bf16 v[116:119], a[168:171], a[48:51], v[116:119]
buffer_load_dwordx4 v[164:167], v14, s[44:47], s65 offen offset:1024 sc1
v_mfma_f32_16x16x32_bf16 v[116:119], a[172:175], a[52:55], v[116:119]
ds_read_b64_tr_b16 a[204:205], v187 offset:8192
v_mfma_f32_16x16x32_bf16 v[148:151], a[172:175], a[60:63], v[148:151]
ds_read_b64_tr_b16 a[206:207], v187 offset:12288
v_mfma_f32_16x16x32_bf16 v[148:151], a[168:171], a[56:59], v[148:151]
v_mfma_f32_16x16x32_bf16 v[120:123], a[176:179], a[56:59], v[120:123]
s_waitcnt lgkmcnt(4)
buffer_load_dwordx4 v[172:175], v15, s[44:47], s65 offen offset:0 sc1
v_mfma_f32_16x16x32_bf16 v[120:123], a[180:183], a[60:63], v[120:123]
v_mfma_f32_16x16x32_bf16 v[88:91], a[180:183], a[52:55], v[88:91]
v_mfma_f32_16x16x32_bf16 v[88:91], a[176:179], a[48:51], v[88:91]
buffer_load_dwordx4 v[180:183], v15, s[44:47], s65 offen offset:1024 sc1
v_mfma_f32_16x16x32_bf16 v[56:59], a[176:179], a[40:43], v[56:59]
v_mfma_f32_16x16x32_bf16 v[56:59], a[180:183], a[44:47], v[56:59]
v_mfma_f32_16x16x32_bf16 v[24:27], a[180:183], a[36:39], v[24:27]
v_mfma_f32_16x16x32_bf16 v[24:27], a[176:179], a[32:35], v[24:27]
v_mfma_f32_16x16x32_bf16 v[28:31], a[184:187], a[32:35], v[28:31]
s_waitcnt vmcnt(28)
s_barrier
v_mfma_f32_16x16x32_bf16 v[28:31], a[188:191], a[36:39], v[28:31]
ds_read_b64_tr_b16 a[144:145], v188 offset:32768
v_mfma_f32_16x16x32_bf16 v[60:63], a[188:191], a[44:47], v[60:63]
ds_read_b64_tr_b16 a[146:147], v188 offset:36864
v_mfma_f32_16x16x32_bf16 v[60:63], a[184:187], a[40:43], v[60:63]
s_add_u32 m0, s86, 65536
ds_read_b64_tr_b16 a[148:149], v188 offset:40960
v_mfma_f32_16x16x32_bf16 v[92:95], a[184:187], a[48:51], v[92:95]
s_add_u32 s64, s85, 524288
ds_read_b64_tr_b16 a[150:151], v188 offset:45056
v_mfma_f32_16x16x32_bf16 v[92:95], a[188:191], a[52:55], v[92:95]
buffer_load_dwordx4 v12, s[40:43], s64 offen lds
v_mfma_f32_16x16x32_bf16 v[124:127], a[188:191], a[60:63], v[124:127]
s_add_u32 m0, s86, 66560
ds_read_b64_tr_b16 a[152:153], v189 offset:32768
v_mfma_f32_16x16x32_bf16 v[124:127], a[184:187], a[56:59], v[124:127]
s_add_u32 s64, s85, 532480
ds_read_b64_tr_b16 a[154:155], v189 offset:36864
v_mfma_f32_16x16x32_bf16 v[128:131], a[192:195], a[56:59], v[128:131]
buffer_load_dwordx4 v13, s[40:43], s64 offen lds
v_mfma_f32_16x16x32_bf16 v[128:131], a[196:199], a[60:63], v[128:131]
ds_read_b64_tr_b16 a[156:157], v189 offset:40960
v_mfma_f32_16x16x32_bf16 v[96:99], a[196:199], a[52:55], v[96:99]
s_add_u32 m0, s86, 67584
ds_read_b64_tr_b16 a[158:159], v189 offset:45056
v_mfma_f32_16x16x32_bf16 v[96:99], a[192:195], a[48:51], v[96:99]
s_add_u32 s64, s85, 540672
ds_read_b64_tr_b16 a[160:161], v190 offset:32768
v_mfma_f32_16x16x32_bf16 v[64:67], a[192:195], a[40:43], v[64:67]
buffer_load_dwordx4 v12, s[40:43], s64 offen lds
v_mfma_f32_16x16x32_bf16 v[64:67], a[196:199], a[44:47], v[64:67]
ds_read_b64_tr_b16 a[162:163], v190 offset:36864
v_mfma_f32_16x16x32_bf16 v[32:35], a[196:199], a[36:39], v[32:35]
s_add_u32 m0, s86, 68608
ds_read_b64_tr_b16 a[164:165], v190 offset:40960
v_mfma_f32_16x16x32_bf16 v[32:35], a[192:195], a[32:35], v[32:35]
s_waitcnt lgkmcnt(5)
s_add_u32 s64, s85, 548864
ds_read_b64_tr_b16 a[166:167], v190 offset:45056
v_mfma_f32_16x16x32_bf16 v[36:39], a[200:203], a[32:35], v[36:39]
buffer_load_dwordx4 v13, s[40:43], s64 offen lds
v_mfma_f32_16x16x32_bf16 v[36:39], a[204:207], a[36:39], v[36:39]
v_mfma_f32_16x16x32_bf16 v[68:71], a[204:207], a[44:47], v[68:71]
s_add_u32 m0, s86, 69632
v_mfma_f32_16x16x32_bf16 v[68:71], a[200:203], a[40:43], v[68:71]
s_add_u32 s64, s85, 557056
v_mfma_f32_16x16x32_bf16 v[100:103], a[200:203], a[48:51], v[100:103]
buffer_load_dwordx4 v12, s[40:43], s64 offen lds
v_mfma_f32_16x16x32_bf16 v[100:103], a[204:207], a[52:55], v[100:103]
s_mov_b32 s70, 3
s_mov_b32 s73, 2
v_mfma_f32_16x16x32_bf16 v[132:135], a[204:207], a[60:63], v[132:135]
v_mfma_f32_16x16x32_bf16 v[132:135], a[200:203], a[56:59], v[132:135]
L_p5join:
.p2align 3
L_p5loop:
s_waitcnt lgkmcnt(10)
s_waitcnt vmcnt(19)
v_mfma_f32_16x16x32_bf16 v[136:139], a[144:147], a[232:235], v[136:139]
s_waitcnt vmcnt(15)
s_waitcnt lgkmcnt(8)
s_add_u32 m0, s86, 70656
s_add_u32 s64, s85, 565248
ds_read_b64_tr_b16 a[168:169], v191 offset:32768
v_mfma_f32_16x16x32_bf16 v[136:139], a[148:151], a[236:239], v[136:139]
buffer_load_dwordx4 v13, s[40:43], s64 offen lds
v_mfma_f32_16x16x32_bf16 v[104:107], a[148:151], a[228:231], v[104:107]
s_add_u32 m0, s86, 71680
ds_read_b64_tr_b16 a[170:171], v191 offset:36864
v_mfma_f32_16x16x32_bf16 v[104:107], a[144:147], a[224:227], v[104:107]
s_add_u32 s64, s85, 573440
ds_read_b64_tr_b16 a[172:173], v191 offset:40960
v_mfma_f32_16x16x32_bf16 v[72:75], a[144:147], a[216:219], v[72:75]
buffer_load_dwordx4 v12, s[40:43], s64 offen lds
v_mfma_f32_16x16x32_bf16 v[72:75], a[148:151], a[220:223], v[72:75]
s_add_u32 m0, s86, 72704
ds_read_b64_tr_b16 a[174:175], v191 offset:45056
v_mfma_f32_16x16x32_bf16 v[40:43], a[148:151], a[212:215], v[40:43]
s_add_u32 s64, s85, 581632
ds_read_b64_tr_b16 a[176:177], v184 offset:32768
v_mfma_f32_16x16x32_bf16 v[40:43], a[144:147], a[208:211], v[40:43]
s_waitcnt lgkmcnt(5)
buffer_load_dwordx4 v13, s[40:43], s64 offen lds
v_mfma_f32_16x16x32_bf16 v[44:47], a[152:155], a[208:211], v[44:47]
ds_read_b64_tr_b16 a[178:179], v184 offset:36864
v_mfma_f32_16x16x32_bf16 v[44:47], a[156:159], a[212:215], v[44:47]
ds_read_b64_tr_b16 a[180:181], v184 offset:40960
v_mfma_f32_16x16x32_bf16 v[76:79], a[156:159], a[220:223], v[76:79]
s_add_u32 s65, s84, 65536
ds_read_b64_tr_b16 a[182:183], v184 offset:45056
v_mfma_f32_16x16x32_bf16 v[76:79], a[152:155], a[216:219], v[76:79]
buffer_load_dwordx4 a[0:3], v14, s[44:47], s65 offen offset:0 sc1
v_mfma_f32_16x16x32_bf16 v[108:111], a[152:155], a[224:227], v[108:111]
ds_read_b64_tr_b16 a[184:185], v185 offset:32768
v_mfma_f32_16x16x32_bf16 v[108:111], a[156:159], a[228:231], v[108:111]
ds_read_b64_tr_b16 a[186:187], v185 offset:36864
v_mfma_f32_16x16x32_bf16 v[140:143], a[156:159], a[236:239], v[140:143]
buffer_load_dwordx4 a[8:11], v14, s[44:47], s65 offen offset:1024 sc1
v_mfma_f32_16x16x32_bf16 v[140:143], a[152:155], a[232:235], v[140:143]
ds_read_b64_tr_b16 a[188:189], v185 offset:40960
v_mfma_f32_16x16x32_bf16 v[144:147], a[160:163], a[232:235], v[144:147]
ds_read_b64_tr_b16 a[190:191], v185 offset:45056
v_mfma_f32_16x16x32_bf16 v[144:147], a[164:167], a[236:239], v[144:147]
v_mfma_f32_16x16x32_bf16 v[112:115], a[164:167], a[228:231], v[112:115]
buffer_load_dwordx4 a[16:19], v15, s[44:47], s65 offen offset:0 sc1
v_mfma_f32_16x16x32_bf16 v[112:115], a[160:163], a[224:227], v[112:115]
ds_read_b64_tr_b16 a[192:193], v186 offset:32768
v_mfma_f32_16x16x32_bf16 v[80:83], a[160:163], a[216:219], v[80:83]
ds_read_b64_tr_b16 a[194:195], v186 offset:36864
v_mfma_f32_16x16x32_bf16 v[80:83], a[164:167], a[220:223], v[80:83]
buffer_load_dwordx4 a[24:27], v15, s[44:47], s65 offen offset:1024 sc1
v_mfma_f32_16x16x32_bf16 v[48:51], a[164:167], a[212:215], v[48:51]
ds_read_b64_tr_b16 a[196:197], v186 offset:40960
v_mfma_f32_16x16x32_bf16 v[48:51], a[160:163], a[208:211], v[48:51]
s_waitcnt lgkmcnt(4)
ds_read_b64_tr_b16 a[198:199], v186 offset:45056
v_mfma_f32_16x16x32_bf16 v[52:55], a[168:171], a[208:211], v[52:55]
s_add_u32 s65, s84, 73728
v_mfma_f32_16x16x32_bf16 v[52:55], a[172:175], a[212:215], v[52:55]
buffer_load_dwordx4 a[4:7], v14, s[44:47], s65 offen offset:0 sc1
v_mfma_f32_16x16x32_bf16 v[84:87], a[172:175], a[220:223], v[84:87]
ds_read_b64_tr_b16 a[200:201], v187 offset:32768
v_mfma_f32_16x16x32_bf16 v[84:87], a[168:171], a[216:219], v[84:87]
ds_read_b64_tr_b16 a[202:203], v187 offset:36864
v_mfma_f32_16x16x32_bf16 v[116:119], a[168:171], a[224:227], v[116:119]
buffer_load_dwordx4 a[12:15], v14, s[44:47], s65 offen offset:1024 sc1
v_mfma_f32_16x16x32_bf16 v[116:119], a[172:175], a[228:231], v[116:119]
ds_read_b64_tr_b16 a[204:205], v187 offset:40960
v_mfma_f32_16x16x32_bf16 v[148:151], a[172:175], a[236:239], v[148:151]
ds_read_b64_tr_b16 a[206:207], v187 offset:45056
v_mfma_f32_16x16x32_bf16 v[148:151], a[168:171], a[232:235], v[148:151]
v_mfma_f32_16x16x32_bf16 v[120:123], a[176:179], a[232:235], v[120:123]
buffer_load_dwordx4 a[20:23], v15, s[44:47], s65 offen offset:0 sc1
v_mfma_f32_16x16x32_bf16 v[120:123], a[180:183], a[236:239], v[120:123]
v_mfma_f32_16x16x32_bf16 v[88:91], a[180:183], a[228:231], v[88:91]
v_mfma_f32_16x16x32_bf16 v[88:91], a[176:179], a[224:227], v[88:91]
buffer_load_dwordx4 a[28:31], v15, s[44:47], s65 offen offset:1024 sc1
v_mfma_f32_16x16x32_bf16 v[56:59], a[176:179], a[216:219], v[56:59]
v_mfma_f32_16x16x32_bf16 v[56:59], a[180:183], a[220:223], v[56:59]
v_mfma_f32_16x16x32_bf16 v[24:27], a[180:183], a[212:215], v[24:27]
v_mfma_f32_16x16x32_bf16 v[24:27], a[176:179], a[208:211], v[24:27]
v_mfma_f32_16x16x32_bf16 v[28:31], a[184:187], a[208:211], v[28:31]
s_waitcnt vmcnt(24)
s_barrier
s_waitcnt lgkmcnt(0)
v_mfma_f32_16x16x32_bf16 v[28:31], a[188:191], a[212:215], v[28:31]
s_add_u32 m0, s86, 98304
ds_read_b64_tr_b16 a[144:145], v196 offset:0
v_mfma_f32_16x16x32_bf16 v[60:63], a[188:191], a[220:223], v[60:63]
s_add_u32 s64, s85, 786432
ds_read_b64_tr_b16 a[146:147], v196 offset:4096
v_mfma_f32_16x16x32_bf16 v[60:63], a[184:187], a[216:219], v[60:63]
buffer_load_dwordx4 v12, s[40:43], s64 offen lds
v_mfma_f32_16x16x32_bf16 v[92:95], a[184:187], a[224:227], v[92:95]
ds_read_b64_tr_b16 a[148:149], v196 offset:8192
v_mfma_f32_16x16x32_bf16 v[92:95], a[188:191], a[228:231], v[92:95]
s_add_u32 m0, s86, 99328
ds_read_b64_tr_b16 a[150:151], v196 offset:12288
v_mfma_f32_16x16x32_bf16 v[124:127], a[188:191], a[236:239], v[124:127]
s_add_u32 s64, s85, 794624
ds_read_b64_tr_b16 a[152:153], v197 offset:0
v_mfma_f32_16x16x32_bf16 v[124:127], a[184:187], a[232:235], v[124:127]
buffer_load_dwordx4 v13, s[40:43], s64 offen lds
v_mfma_f32_16x16x32_bf16 v[128:131], a[192:195], a[232:235], v[128:131]
ds_read_b64_tr_b16 a[154:155], v197 offset:4096
v_mfma_f32_16x16x32_bf16 v[128:131], a[196:199], a[236:239], v[128:131]
s_add_u32 m0, s86, 100352
ds_read_b64_tr_b16 a[156:157], v197 offset:8192
v_mfma_f32_16x16x32_bf16 v[96:99], a[196:199], a[228:231], v[96:99]
s_add_u32 s64, s85, 802816
ds_read_b64_tr_b16 a[158:159], v197 offset:12288
v_mfma_f32_16x16x32_bf16 v[96:99], a[192:195], a[224:227], v[96:99]
buffer_load_dwordx4 v12, s[40:43], s64 offen lds
v_mfma_f32_16x16x32_bf16 v[64:67], a[192:195], a[216:219], v[64:67]
ds_read_b64_tr_b16 a[160:161], v198 offset:0
v_mfma_f32_16x16x32_bf16 v[64:67], a[196:199], a[220:223], v[64:67]
s_add_u32 m0, s86, 101376
ds_read_b64_tr_b16 a[162:163], v198 offset:4096
v_mfma_f32_16x16x32_bf16 v[32:35], a[196:199], a[212:215], v[32:35]
s_add_u32 s64, s85, 811008
ds_read_b64_tr_b16 a[164:165], v198 offset:8192
v_mfma_f32_16x16x32_bf16 v[32:35], a[192:195], a[208:211], v[32:35]
buffer_load_dwordx4 v13, s[40:43], s64 offen lds
v_mfma_f32_16x16x32_bf16 v[36:39], a[200:203], a[208:211], v[36:39]
ds_read_b64_tr_b16 a[166:167], v198 offset:12288
v_mfma_f32_16x16x32_bf16 v[36:39], a[204:207], a[212:215], v[36:39]
s_add_u32 m0, s86, 102400
v_mfma_f32_16x16x32_bf16 v[68:71], a[204:207], a[220:223], v[68:71]
s_add_u32 s64, s85, 819200
v_mfma_f32_16x16x32_bf16 v[68:71], a[200:203], a[216:219], v[68:71]
buffer_load_dwordx4 v12, s[40:43], s64 offen lds
v_mfma_f32_16x16x32_bf16 v[100:103], a[200:203], a[224:227], v[100:103]
v_mfma_f32_16x16x32_bf16 v[100:103], a[204:207], a[228:231], v[100:103]
v_mfma_f32_16x16x32_bf16 v[132:135], a[204:207], a[236:239], v[132:135]
v_mfma_f32_16x16x32_bf16 v[132:135], a[200:203], a[232:235], v[132:135]
s_waitcnt vmcnt(25)
s_waitcnt lgkmcnt(1)
s_add_u32 m0, s86, 103424
buffer_load_dword v19, off, s[52:55], s72 offset:128 sc1
v_mfma_f32_16x16x32_bf16 v[136:139], a[144:147], v[176:179], v[136:139]
s_waitcnt vmcnt(22)
s_add_u32 s64, s85, 827392
ds_read_b64_tr_b16 a[168:169], v199 offset:0
v_mfma_f32_16x16x32_bf16 v[136:139], a[148:151], v[180:183], v[136:139]
buffer_load_dwordx4 v13, s[40:43], s64 offen lds
v_mfma_f32_16x16x32_bf16 v[104:107], a[148:151], v[172:175], v[104:107]
s_add_u32 m0, s86, 104448
ds_read_b64_tr_b16 a[170:171], v199 offset:4096
v_mfma_f32_16x16x32_bf16 v[104:107], a[144:147], v[168:171], v[104:107]
s_add_u32 s64, s85, 835584
ds_read_b64_tr_b16 a[172:173], v199 offset:8192
v_mfma_f32_16x16x32_bf16 v[72:75], a[144:147], v[160:163], v[72:75]
buffer_load_dwordx4 v12, s[40:43], s64 offen lds
v_mfma_f32_16x16x32_bf16 v[72:75], a[148:151], v[164:167], v[72:75]
s_add_u32 m0, s86, 105472
ds_read_b64_tr_b16 a[174:175], v199 offset:12288
v_mfma_f32_16x16x32_bf16 v[40:43], a[148:151], v[156:159], v[40:43]
s_add_u32 s64, s85, 843776
ds_read_b64_tr_b16 a[176:177], v192 offset:0
v_mfma_f32_16x16x32_bf16 v[40:43], a[144:147], v[152:155], v[40:43]
buffer_load_dwordx4 v13, s[40:43], s64 offen lds
v_mfma_f32_16x16x32_bf16 v[44:47], a[152:155], v[152:155], v[44:47]
ds_read_b64_tr_b16 a[178:179], v192 offset:4096
v_mfma_f32_16x16x32_bf16 v[44:47], a[156:159], v[156:159], v[44:47]
ds_read_b64_tr_b16 a[180:181], v192 offset:8192
v_mfma_f32_16x16x32_bf16 v[76:79], a[156:159], v[164:167], v[76:79]
s_add_u32 s65, s84, 98304
ds_read_b64_tr_b16 a[182:183], v192 offset:12288
v_mfma_f32_16x16x32_bf16 v[76:79], a[152:155], v[160:163], v[76:79]
buffer_load_dwordx4 a[32:35], v14, s[44:47], s65 offen offset:0 sc1
v_mfma_f32_16x16x32_bf16 v[108:111], a[152:155], v[168:171], v[108:111]
ds_read_b64_tr_b16 a[184:185], v193 offset:0
v_mfma_f32_16x16x32_bf16 v[108:111], a[156:159], v[172:175], v[108:111]
ds_read_b64_tr_b16 a[186:187], v193 offset:4096
v_mfma_f32_16x16x32_bf16 v[140:143], a[156:159], v[180:183], v[140:143]
buffer_load_dwordx4 a[40:43], v14, s[44:47], s65 offen offset:1024 sc1
v_mfma_f32_16x16x32_bf16 v[140:143], a[152:155], v[176:179], v[140:143]
ds_read_b64_tr_b16 a[188:189], v193 offset:8192
v_mfma_f32_16x16x32_bf16 v[144:147], a[160:163], v[176:179], v[144:147]
s_waitcnt lgkmcnt(5)
s_lshl_b32 s75, s73, 20
s_add_u32 s85, s85, s75
ds_read_b64_tr_b16 a[190:191], v193 offset:12288
v_mfma_f32_16x16x32_bf16 v[144:147], a[164:167], v[180:183], v[144:147]
s_lshr_b32 s74, s73, 28
s_and_b32 s74, s74, 8
v_mfma_f32_16x16x32_bf16 v[112:115], a[164:167], v[172:175], v[112:115]
buffer_load_dwordx4 a[48:51], v15, s[44:47], s65 offen offset:0 sc1
v_mfma_f32_16x16x32_bf16 v[112:115], a[160:163], v[168:171], v[112:115]
ds_read_b64_tr_b16 a[192:193], v194 offset:0
v_mfma_f32_16x16x32_bf16 v[80:83], a[160:163], v[160:163], v[80:83]
ds_read_b64_tr_b16 a[194:195], v194 offset:4096
v_mfma_f32_16x16x32_bf16 v[80:83], a[164:167], v[164:167], v[80:83]
buffer_load_dwordx4 a[56:59], v15, s[44:47], s65 offen offset:1024 sc1
v_mfma_f32_16x16x32_bf16 v[48:51], a[164:167], v[156:159], v[48:51]
ds_read_b64_tr_b16 a[196:197], v194 offset:8192
v_mfma_f32_16x16x32_bf16 v[48:51], a[160:163], v[152:155], v[48:51]
ds_read_b64_tr_b16 a[198:199], v194 offset:12288
v_mfma_f32_16x16x32_bf16 v[52:55], a[168:171], v[152:155], v[52:55]
s_add_u32 s65, s84, 106496
v_mfma_f32_16x16x32_bf16 v[52:55], a[172:175], v[156:159], v[52:55]
buffer_load_dwordx4 a[36:39], v14, s[44:47], s65 offen offset:0 sc1
v_mfma_f32_16x16x32_bf16 v[84:87], a[172:175], v[164:167], v[84:87]
ds_read_b64_tr_b16 a[200:201], v195 offset:0
v_mfma_f32_16x16x32_bf16 v[84:87], a[168:171], v[160:163], v[84:87]
ds_read_b64_tr_b16 a[202:203], v195 offset:4096
v_mfma_f32_16x16x32_bf16 v[116:119], a[168:171], v[168:171], v[116:119]
buffer_load_dwordx4 a[44:47], v14, s[44:47], s65 offen offset:1024 sc1
v_mfma_f32_16x16x32_bf16 v[116:119], a[172:175], v[172:175], v[116:119]
ds_read_b64_tr_b16 a[204:205], v195 offset:8192
v_mfma_f32_16x16x32_bf16 v[148:151], a[172:175], v[180:183], v[148:151]
ds_read_b64_tr_b16 a[206:207], v195 offset:12288
v_mfma_f32_16x16x32_bf16 v[148:151], a[168:171], v[176:179], v[148:151]
v_mfma_f32_16x16x32_bf16 v[120:123], a[176:179], v[176:179], v[120:123]
s_waitcnt lgkmcnt(4)
buffer_load_dwordx4 a[52:55], v15, s[44:47], s65 offen offset:0 sc1
v_mfma_f32_16x16x32_bf16 v[120:123], a[180:183], v[180:183], v[120:123]
v_mfma_f32_16x16x32_bf16 v[88:91], a[180:183], v[172:175], v[88:91]
v_mfma_f32_16x16x32_bf16 v[88:91], a[176:179], v[168:171], v[88:91]
buffer_load_dwordx4 a[60:63], v15, s[44:47], s65 offen offset:1024 sc1
v_mfma_f32_16x16x32_bf16 v[56:59], a[176:179], v[160:163], v[56:59]
v_mfma_f32_16x16x32_bf16 v[56:59], a[180:183], v[164:167], v[56:59]
v_mfma_f32_16x16x32_bf16 v[24:27], a[180:183], v[156:159], v[24:27]
v_mfma_f32_16x16x32_bf16 v[24:27], a[176:179], v[152:155], v[24:27]
v_mfma_f32_16x16x32_bf16 v[28:31], a[184:187], v[152:155], v[28:31]
s_waitcnt vmcnt(25)
s_barrier
v_mfma_f32_16x16x32_bf16 v[28:31], a[188:191], v[156:159], v[28:31]
s_add_u32 m0, s86, 131072
ds_read_b64_tr_b16 a[144:145], v196 offset:32768
v_mfma_f32_16x16x32_bf16 v[60:63], a[188:191], v[164:167], v[60:63]
s_add_u32 s64, s85, 0
ds_read_b64_tr_b16 a[146:147], v196 offset:36864
v_mfma_f32_16x16x32_bf16 v[60:63], a[184:187], v[160:163], v[60:63]
buffer_load_dwordx4 v12, s[40:43], s64 offen lds
v_mfma_f32_16x16x32_bf16 v[92:95], a[184:187], v[168:171], v[92:95]
s_lshl_b32 s75, s73, 17
s_add_u32 s84, s84, s75
ds_read_b64_tr_b16 a[148:149], v196 offset:40960
v_mfma_f32_16x16x32_bf16 v[92:95], a[188:191], v[172:175], v[92:95]
s_add_u32 m0, s86, 132096
ds_read_b64_tr_b16 a[150:151], v196 offset:45056
v_mfma_f32_16x16x32_bf16 v[124:127], a[188:191], v[180:183], v[124:127]
s_add_u32 s64, s85, 8192
ds_read_b64_tr_b16 a[152:153], v197 offset:32768
v_mfma_f32_16x16x32_bf16 v[124:127], a[184:187], v[176:179], v[124:127]
buffer_load_dwordx4 v13, s[40:43], s64 offen lds
v_mfma_f32_16x16x32_bf16 v[128:131], a[192:195], v[176:179], v[128:131]
ds_read_b64_tr_b16 a[154:155], v197 offset:36864
v_mfma_f32_16x16x32_bf16 v[128:131], a[196:199], v[180:183], v[128:131]
s_add_u32 m0, s86, 133120
ds_read_b64_tr_b16 a[156:157], v197 offset:40960
v_mfma_f32_16x16x32_bf16 v[96:99], a[196:199], v[172:175], v[96:99]
s_add_u32 s64, s85, 16384
ds_read_b64_tr_b16 a[158:159], v197 offset:45056
v_mfma_f32_16x16x32_bf16 v[96:99], a[192:195], v[168:171], v[96:99]
buffer_load_dwordx4 v12, s[40:43], s64 offen lds
v_mfma_f32_16x16x32_bf16 v[64:67], a[192:195], v[160:163], v[64:67]
ds_read_b64_tr_b16 a[160:161], v198 offset:32768
v_mfma_f32_16x16x32_bf16 v[64:67], a[196:199], v[164:167], v[64:67]
s_add_u32 m0, s86, 134144
ds_read_b64_tr_b16 a[162:163], v198 offset:36864
v_mfma_f32_16x16x32_bf16 v[32:35], a[196:199], v[156:159], v[32:35]
s_add_u32 s64, s85, 24576
ds_read_b64_tr_b16 a[164:165], v198 offset:40960
v_mfma_f32_16x16x32_bf16 v[32:35], a[192:195], v[152:155], v[32:35]
s_waitcnt lgkmcnt(6)
buffer_load_dwordx4 v13, s[40:43], s64 offen lds
v_mfma_f32_16x16x32_bf16 v[36:39], a[200:203], v[152:155], v[36:39]
ds_read_b64_tr_b16 a[166:167], v198 offset:45056
v_mfma_f32_16x16x32_bf16 v[36:39], a[204:207], v[156:159], v[36:39]
s_add_u32 m0, s86, 135168
v_mfma_f32_16x16x32_bf16 v[68:71], a[204:207], v[164:167], v[68:71]
s_add_u32 s64, s85, 32768
v_mfma_f32_16x16x32_bf16 v[68:71], a[200:203], v[160:163], v[68:71]
buffer_load_dwordx4 v12, s[40:43], s64 offen lds
v_mfma_f32_16x16x32_bf16 v[100:103], a[200:203], v[168:171], v[100:103]
v_mfma_f32_16x16x32_bf16 v[100:103], a[204:207], v[172:175], v[100:103]
v_mfma_f32_16x16x32_bf16 v[132:135], a[204:207], v[180:183], v[132:135]
v_mfma_f32_16x16x32_bf16 v[132:135], a[200:203], v[176:179], v[132:135]
s_waitcnt vmcnt(26)
v_mfma_f32_16x16x32_bf16 v[136:139], a[144:147], a[24:27], v[136:139]
s_waitcnt vmcnt(16)
v_readfirstlane_b32 vcc_lo, v19
s_nop 0
s_cmp_lt_u32 vcc_lo, s74
s_cbranch_scc1 L_spin_4022
L_spinbk_4023:
v_mfma_f32_16x16x32_bf16 v[136:139], a[148:151], a[28:31], v[136:139]
s_add_u32 m0, s86, 136192
ds_read_b64_tr_b16 a[168:169], v199 offset:32768
v_mfma_f32_16x16x32_bf16 v[104:107], a[148:151], a[20:23], v[104:107]
s_add_u32 s64, s85, 40960
ds_read_b64_tr_b16 a[170:171], v199 offset:36864
v_mfma_f32_16x16x32_bf16 v[104:107], a[144:147], a[16:19], v[104:107]
buffer_load_dwordx4 v13, s[40:43], s64 offen lds
v_mfma_f32_16x16x32_bf16 v[72:75], a[144:147], a[8:11], v[72:75]
s_add_u32 m0, s86, 137216
ds_read_b64_tr_b16 a[172:173], v199 offset:40960
v_mfma_f32_16x16x32_bf16 v[72:75], a[148:151], a[12:15], v[72:75]
s_add_u32 s64, s85, 49152
ds_read_b64_tr_b16 a[174:175], v199 offset:45056
v_mfma_f32_16x16x32_bf16 v[40:43], a[148:151], a[4:7], v[40:43]
buffer_load_dwordx4 v12, s[40:43], s64 offen lds
v_mfma_f32_16x16x32_bf16 v[40:43], a[144:147], a[0:3], v[40:43]
s_waitcnt lgkmcnt(4)
s_add_u32 m0, s86, 138240
ds_read_b64_tr_b16 a[176:177], v192 offset:32768
v_mfma_f32_16x16x32_bf16 v[44:47], a[152:155], a[0:3], v[44:47]
s_add_u32 s64, s85, 57344
ds_read_b64_tr_b16 a[178:179], v192 offset:36864
v_mfma_f32_16x16x32_bf16 v[44:47], a[156:159], a[4:7], v[44:47]
buffer_load_dwordx4 v13, s[40:43], s64 offen lds
v_mfma_f32_16x16x32_bf16 v[76:79], a[156:159], a[12:15], v[76:79]
ds_read_b64_tr_b16 a[180:181], v192 offset:40960
v_mfma_f32_16x16x32_bf16 v[76:79], a[152:155], a[8:11], v[76:79]
s_add_u32 s65, s84, 0
ds_read_b64_tr_b16 a[182:183], v192 offset:45056
v_mfma_f32_16x16x32_bf16 v[108:111], a[152:155], a[16:19], v[108:111]
buffer_load_dwordx4 a[208:211], v14, s[44:47], s65 offen offset:0 sc1
v_mfma_f32_16x16x32_bf16 v[108:111], a[156:159], a[20:23], v[108:111]
ds_read_b64_tr_b16 a[184:185], v193 offset:32768
v_mfma_f32_16x16x32_bf16 v[140:143], a[156:159], a[28:31], v[140:143]
ds_read_b64_tr_b16 a[186:187], v193 offset:36864
v_mfma_f32_16x16x32_bf16 v[140:143], a[152:155], a[24:27], v[140:143]
ds_read_b64_tr_b16 a[188:189], v193 offset:40960
v_mfma_f32_16x16x32_bf16 v[144:147], a[160:163], a[24:27], v[144:147]
buffer_load_dwordx4 a[216:219], v14, s[44:47], s65 offen offset:1024 sc1
v_mfma_f32_16x16x32_bf16 v[144:147], a[164:167], a[28:31], v[144:147]
ds_read_b64_tr_b16 a[190:191], v193 offset:45056
v_mfma_f32_16x16x32_bf16 v[112:115], a[164:167], a[20:23], v[112:115]
ds_read_b64_tr_b16 a[192:193], v194 offset:32768
v_mfma_f32_16x16x32_bf16 v[112:115], a[160:163], a[16:19], v[112:115]
buffer_load_dwordx4 a[224:227], v15, s[44:47], s65 offen offset:0 sc1
v_mfma_f32_16x16x32_bf16 v[80:83], a[160:163], a[8:11], v[80:83]
ds_read_b64_tr_b16 a[194:195], v194 offset:36864
v_mfma_f32_16x16x32_bf16 v[80:83], a[164:167], a[12:15], v[80:83]
ds_read_b64_tr_b16 a[196:197], v194 offset:40960
v_mfma_f32_16x16x32_bf16 v[48:51], a[164:167], a[4:7], v[48:51]
buffer_load_dwordx4 a[232:235], v15, s[44:47], s65 offen offset:1024 sc1
v_mfma_f32_16x16x32_bf16 v[48:51], a[160:163], a[0:3], v[48:51]
s_waitcnt lgkmcnt(4)
ds_read_b64_tr_b16 a[198:199], v194 offset:45056
v_mfma_f32_16x16x32_bf16 v[52:55], a[168:171], a[0:3], v[52:55]
s_add_u32 s65, s84, 8192
v_mfma_f32_16x16x32_bf16 v[52:55], a[172:175], a[4:7], v[52:55]
buffer_load_dwordx4 a[212:215], v14, s[44:47], s65 offen offset:0 sc1
v_mfma_f32_16x16x32_bf16 v[84:87], a[172:175], a[12:15], v[84:87]
ds_read_b64_tr_b16 a[200:201], v195 offset:32768
v_mfma_f32_16x16x32_bf16 v[84:87], a[168:171], a[8:11], v[84:87]
ds_read_b64_tr_b16 a[202:203], v195 offset:36864
v_mfma_f32_16x16x32_bf16 v[116:119], a[168:171], a[16:19], v[116:119]
ds_read_b64_tr_b16 a[204:205], v195 offset:40960
v_mfma_f32_16x16x32_bf16 v[116:119], a[172:175], a[20:23], v[116:119]
buffer_load_dwordx4 a[220:223], v14, s[44:47], s65 offen offset:1024 sc1
v_mfma_f32_16x16x32_bf16 v[148:151], a[172:175], a[28:31], v[148:151]
ds_read_b64_tr_b16 a[206:207], v195 offset:45056
v_mfma_f32_16x16x32_bf16 v[148:151], a[168:171], a[24:27], v[148:151]
v_mfma_f32_16x16x32_bf16 v[120:123], a[176:179], a[24:27], v[120:123]
buffer_load_dwordx4 a[228:231], v15, s[44:47], s65 offen offset:0 sc1
v_mfma_f32_16x16x32_bf16 v[120:123], a[180:183], a[28:31], v[120:123]
v_mfma_f32_16x16x32_bf16 v[88:91], a[180:183], a[20:23], v[88:91]
v_mfma_f32_16x16x32_bf16 v[88:91], a[176:179], a[16:19], v[88:91]
buffer_load_dwordx4 a[236:239], v15, s[44:47], s65 offen offset:1024 sc1
v_mfma_f32_16x16x32_bf16 v[56:59], a[176:179], a[8:11], v[56:59]
v_mfma_f32_16x16x32_bf16 v[56:59], a[180:183], a[12:15], v[56:59]
v_mfma_f32_16x16x32_bf16 v[24:27], a[180:183], a[4:7], v[24:27]
v_mfma_f32_16x16x32_bf16 v[24:27], a[176:179], a[0:3], v[24:27]
v_mfma_f32_16x16x32_bf16 v[28:31], a[184:187], a[0:3], v[28:31]
s_waitcnt vmcnt(24)
s_barrier
s_waitcnt lgkmcnt(0)
v_mfma_f32_16x16x32_bf16 v[28:31], a[188:191], a[4:7], v[28:31]
s_add_u32 m0, s86, 32768
ds_read_b64_tr_b16 a[144:145], v188 offset:0
v_mfma_f32_16x16x32_bf16 v[60:63], a[188:191], a[12:15], v[60:63]
s_add_u32 s64, s85, 262144
ds_read_b64_tr_b16 a[146:147], v188 offset:4096
v_mfma_f32_16x16x32_bf16 v[60:63], a[184:187], a[8:11], v[60:63]
buffer_load_dwordx4 v12, s[40:43], s64 offen lds
v_mfma_f32_16x16x32_bf16 v[92:95], a[184:187], a[16:19], v[92:95]
ds_read_b64_tr_b16 a[148:149], v188 offset:8192
v_mfma_f32_16x16x32_bf16 v[92:95], a[188:191], a[20:23], v[92:95]
s_add_u32 m0, s86, 33792
ds_read_b64_tr_b16 a[150:151], v188 offset:12288
v_mfma_f32_16x16x32_bf16 v[124:127], a[188:191], a[28:31], v[124:127]
s_add_u32 s64, s85, 270336
ds_read_b64_tr_b16 a[152:153], v189 offset:0
v_mfma_f32_16x16x32_bf16 v[124:127], a[184:187], a[24:27], v[124:127]
buffer_load_dwordx4 v13, s[40:43], s64 offen lds
v_mfma_f32_16x16x32_bf16 v[128:131], a[192:195], a[24:27], v[128:131]
ds_read_b64_tr_b16 a[154:155], v189 offset:4096
v_mfma_f32_16x16x32_bf16 v[128:131], a[196:199], a[28:31], v[128:131]
s_add_u32 m0, s86, 34816
ds_read_b64_tr_b16 a[156:157], v189 offset:8192
v_mfma_f32_16x16x32_bf16 v[96:99], a[196:199], a[20:23], v[96:99]
s_add_u32 s64, s85, 278528
ds_read_b64_tr_b16 a[158:159], v189 offset:12288
v_mfma_f32_16x16x32_bf16 v[96:99], a[192:195], a[16:19], v[96:99]
buffer_load_dwordx4 v12, s[40:43], s64 offen lds
v_mfma_f32_16x16x32_bf16 v[64:67], a[192:195], a[8:11], v[64:67]
ds_read_b64_tr_b16 a[160:161], v190 offset:0
v_mfma_f32_16x16x32_bf16 v[64:67], a[196:199], a[12:15], v[64:67]
s_add_u32 m0, s86, 35840
ds_read_b64_tr_b16 a[162:163], v190 offset:4096
v_mfma_f32_16x16x32_bf16 v[32:35], a[196:199], a[4:7], v[32:35]
s_add_u32 s64, s85, 286720
ds_read_b64_tr_b16 a[164:165], v190 offset:8192
v_mfma_f32_16x16x32_bf16 v[32:35], a[192:195], a[0:3], v[32:35]
buffer_load_dwordx4 v13, s[40:43], s64 offen lds
v_mfma_f32_16x16x32_bf16 v[36:39], a[200:203], a[0:3], v[36:39]
ds_read_b64_tr_b16 a[166:167], v190 offset:12288
v_mfma_f32_16x16x32_bf16 v[36:39], a[204:207], a[4:7], v[36:39]
s_add_u32 m0, s86, 36864
v_mfma_f32_16x16x32_bf16 v[68:71], a[204:207], a[12:15], v[68:71]
s_add_u32 s64, s85, 294912
v_mfma_f32_16x16x32_bf16 v[68:71], a[200:203], a[8:11], v[68:71]
buffer_load_dwordx4 v12, s[40:43], s64 offen lds
v_mfma_f32_16x16x32_bf16 v[100:103], a[200:203], a[16:19], v[100:103]
v_mfma_f32_16x16x32_bf16 v[100:103], a[204:207], a[20:23], v[100:103]
v_mfma_f32_16x16x32_bf16 v[132:135], a[204:207], a[28:31], v[132:135]
v_mfma_f32_16x16x32_bf16 v[132:135], a[200:203], a[24:27], v[132:135]
s_waitcnt vmcnt(25)
s_waitcnt lgkmcnt(1)
s_add_u32 m0, s86, 37888
v_mfma_f32_16x16x32_bf16 v[136:139], a[144:147], a[56:59], v[136:139]
s_waitcnt vmcnt(21)
s_add_u32 s64, s85, 303104
ds_read_b64_tr_b16 a[168:169], v191 offset:0
v_mfma_f32_16x16x32_bf16 v[136:139], a[148:151], a[60:63], v[136:139]
buffer_load_dwordx4 v13, s[40:43], s64 offen lds
v_mfma_f32_16x16x32_bf16 v[104:107], a[148:151], a[52:55], v[104:107]
s_add_u32 m0, s86, 38912
ds_read_b64_tr_b16 a[170:171], v191 offset:4096
v_mfma_f32_16x16x32_bf16 v[104:107], a[144:147], a[48:51], v[104:107]
s_add_u32 s64, s85, 311296
ds_read_b64_tr_b16 a[172:173], v191 offset:8192
v_mfma_f32_16x16x32_bf16 v[72:75], a[144:147], a[40:43], v[72:75]
buffer_load_dwordx4 v12, s[40:43], s64 offen lds
v_mfma_f32_16x16x32_bf16 v[72:75], a[148:151], a[44:47], v[72:75]
s_add_u32 m0, s86, 39936
ds_read_b64_tr_b16 a[174:175], v191 offset:12288
v_mfma_f32_16x16x32_bf16 v[40:43], a[148:151], a[36:39], v[40:43]
s_add_u32 s64, s85, 319488
ds_read_b64_tr_b16 a[176:177], v184 offset:0
v_mfma_f32_16x16x32_bf16 v[40:43], a[144:147], a[32:35], v[40:43]
buffer_load_dwordx4 v13, s[40:43], s64 offen lds
v_mfma_f32_16x16x32_bf16 v[44:47], a[152:155], a[32:35], v[44:47]
ds_read_b64_tr_b16 a[178:179], v184 offset:4096
v_mfma_f32_16x16x32_bf16 v[44:47], a[156:159], a[36:39], v[44:47]
ds_read_b64_tr_b16 a[180:181], v184 offset:8192
v_mfma_f32_16x16x32_bf16 v[76:79], a[156:159], a[44:47], v[76:79]
s_add_u32 s65, s84, 32768
ds_read_b64_tr_b16 a[182:183], v184 offset:12288
v_mfma_f32_16x16x32_bf16 v[76:79], a[152:155], a[40:43], v[76:79]
buffer_load_dwordx4 v[152:155], v14, s[44:47], s65 offen offset:0 sc1
v_mfma_f32_16x16x32_bf16 v[108:111], a[152:155], a[48:51], v[108:111]
ds_read_b64_tr_b16 a[184:185], v185 offset:0
v_mfma_f32_16x16x32_bf16 v[108:111], a[156:159], a[52:55], v[108:111]
ds_read_b64_tr_b16 a[186:187], v185 offset:4096
v_mfma_f32_16x16x32_bf16 v[140:143], a[156:159], a[60:63], v[140:143]
buffer_load_dwordx4 v[160:163], v14, s[44:47], s65 offen offset:1024 sc1
v_mfma_f32_16x16x32_bf16 v[140:143], a[152:155], a[56:59], v[140:143]
ds_read_b64_tr_b16 a[188:189], v185 offset:8192
v_mfma_f32_16x16x32_bf16 v[144:147], a[160:163], a[56:59], v[144:147]
s_waitcnt lgkmcnt(5)
ds_read_b64_tr_b16 a[190:191], v185 offset:12288
v_mfma_f32_16x16x32_bf16 v[144:147], a[164:167], a[60:63], v[144:147]
v_mfma_f32_16x16x32_bf16 v[112:115], a[164:167], a[52:55], v[112:115]
buffer_load_dwordx4 v[168:171], v15, s[44:47], s65 offen offset:0 sc1
v_mfma_f32_16x16x32_bf16 v[112:115], a[160:163], a[48:51], v[112:115]
ds_read_b64_tr_b16 a[192:193], v186 offset:0
v_mfma_f32_16x16x32_bf16 v[80:83], a[160:163], a[40:43], v[80:83]
ds_read_b64_tr_b16 a[194:195], v186 offset:4096
v_mfma_f32_16x16x32_bf16 v[80:83], a[164:167], a[44:47], v[80:83]
buffer_load_dwordx4 v[176:179], v15, s[44:47], s65 offen offset:1024 sc1
v_mfma_f32_16x16x32_bf16 v[48:51], a[164:167], a[36:39], v[48:51]
ds_read_b64_tr_b16 a[196:197], v186 offset:8192
v_mfma_f32_16x16x32_bf16 v[48:51], a[160:163], a[32:35], v[48:51]
ds_read_b64_tr_b16 a[198:199], v186 offset:12288
v_mfma_f32_16x16x32_bf16 v[52:55], a[168:171], a[32:35], v[52:55]
s_add_u32 s65, s84, 40960
v_mfma_f32_16x16x32_bf16 v[52:55], a[172:175], a[36:39], v[52:55]
buffer_load_dwordx4 v[156:159], v14, s[44:47], s65 offen offset:0 sc1
v_mfma_f32_16x16x32_bf16 v[84:87], a[172:175], a[44:47], v[84:87]
ds_read_b64_tr_b16 a[200:201], v187 offset:0
v_mfma_f32_16x16x32_bf16 v[84:87], a[168:171], a[40:43], v[84:87]
ds_read_b64_tr_b16 a[202:203], v187 offset:4096
v_mfma_f32_16x16x32_bf16 v[116:119], a[168:171], a[48:51], v[116:119]
buffer_load_dwordx4 v[164:167], v14, s[44:47], s65 offen offset:1024 sc1
v_mfma_f32_16x16x32_bf16 v[116:119], a[172:175], a[52:55], v[116:119]
ds_read_b64_tr_b16 a[204:205], v187 offset:8192
v_mfma_f32_16x16x32_bf16 v[148:151], a[172:175], a[60:63], v[148:151]
ds_read_b64_tr_b16 a[206:207], v187 offset:12288
v_mfma_f32_16x16x32_bf16 v[148:151], a[168:171], a[56:59], v[148:151]
v_mfma_f32_16x16x32_bf16 v[120:123], a[176:179], a[56:59], v[120:123]
s_waitcnt lgkmcnt(4)
buffer_load_dwordx4 v[172:175], v15, s[44:47], s65 offen offset:0 sc1
v_mfma_f32_16x16x32_bf16 v[120:123], a[180:183], a[60:63], v[120:123]
v_mfma_f32_16x16x32_bf16 v[88:91], a[180:183], a[52:55], v[88:91]
v_mfma_f32_16x16x32_bf16 v[88:91], a[176:179], a[48:51], v[88:91]
buffer_load_dwordx4 v[180:183], v15, s[44:47], s65 offen offset:1024 sc1
v_mfma_f32_16x16x32_bf16 v[56:59], a[176:179], a[40:43], v[56:59]
v_mfma_f32_16x16x32_bf16 v[56:59], a[180:183], a[44:47], v[56:59]
v_mfma_f32_16x16x32_bf16 v[24:27], a[180:183], a[36:39], v[24:27]
v_mfma_f32_16x16x32_bf16 v[24:27], a[176:179], a[32:35], v[24:27]
v_mfma_f32_16x16x32_bf16 v[28:31], a[184:187], a[32:35], v[28:31]
s_waitcnt vmcnt(24)
s_barrier
v_mfma_f32_16x16x32_bf16 v[28:31], a[188:191], a[36:39], v[28:31]
s_add_u32 m0, s86, 65536
ds_read_b64_tr_b16 a[144:145], v188 offset:32768
v_mfma_f32_16x16x32_bf16 v[60:63], a[188:191], a[44:47], v[60:63]
s_add_u32 s64, s85, 524288
ds_read_b64_tr_b16 a[146:147], v188 offset:36864
v_mfma_f32_16x16x32_bf16 v[60:63], a[184:187], a[40:43], v[60:63]
buffer_load_dwordx4 v12, s[40:43], s64 offen lds
v_mfma_f32_16x16x32_bf16 v[92:95], a[184:187], a[48:51], v[92:95]
ds_read_b64_tr_b16 a[148:149], v188 offset:40960
v_mfma_f32_16x16x32_bf16 v[92:95], a[188:191], a[52:55], v[92:95]
s_add_u32 m0, s86, 66560
ds_read_b64_tr_b16 a[150:151], v188 offset:45056
v_mfma_f32_16x16x32_bf16 v[124:127], a[188:191], a[60:63], v[124:127]
s_add_u32 s64, s85, 532480
ds_read_b64_tr_b16 a[152:153], v189 offset:32768
v_mfma_f32_16x16x32_bf16 v[124:127], a[184:187], a[56:59], v[124:127]
buffer_load_dwordx4 v13, s[40:43], s64 offen lds
v_mfma_f32_16x16x32_bf16 v[128:131], a[192:195], a[56:59], v[128:131]
ds_read_b64_tr_b16 a[154:155], v189 offset:36864
v_mfma_f32_16x16x32_bf16 v[128:131], a[196:199], a[60:63], v[128:131]
s_add_u32 m0, s86, 67584
ds_read_b64_tr_b16 a[156:157], v189 offset:40960
v_mfma_f32_16x16x32_bf16 v[96:99], a[196:199], a[52:55], v[96:99]
s_add_u32 s64, s85, 540672
ds_read_b64_tr_b16 a[158:159], v189 offset:45056
v_mfma_f32_16x16x32_bf16 v[96:99], a[192:195], a[48:51], v[96:99]
buffer_load_dwordx4 v12, s[40:43], s64 offen lds
v_mfma_f32_16x16x32_bf16 v[64:67], a[192:195], a[40:43], v[64:67]
ds_read_b64_tr_b16 a[160:161], v190 offset:32768
v_mfma_f32_16x16x32_bf16 v[64:67], a[196:199], a[44:47], v[64:67]
s_add_u32 m0, s86, 68608
ds_read_b64_tr_b16 a[162:163], v190 offset:36864
v_mfma_f32_16x16x32_bf16 v[32:35], a[196:199], a[36:39], v[32:35]
s_add_u32 s64, s85, 548864
ds_read_b64_tr_b16 a[164:165], v190 offset:40960
v_mfma_f32_16x16x32_bf16 v[32:35], a[192:195], a[32:35], v[32:35]
s_waitcnt lgkmcnt(6)
buffer_load_dwordx4 v13, s[40:43], s64 offen lds
v_mfma_f32_16x16x32_bf16 v[36:39], a[200:203], a[32:35], v[36:39]
ds_read_b64_tr_b16 a[166:167], v190 offset:45056
v_mfma_f32_16x16x32_bf16 v[36:39], a[204:207], a[36:39], v[36:39]
s_add_u32 m0, s86, 69632
v_mfma_f32_16x16x32_bf16 v[68:71], a[204:207], a[44:47], v[68:71]
s_add_u32 s64, s85, 557056
v_mfma_f32_16x16x32_bf16 v[68:71], a[200:203], a[40:43], v[68:71]
buffer_load_dwordx4 v12, s[40:43], s64 offen lds
v_mfma_f32_16x16x32_bf16 v[100:103], a[200:203], a[48:51], v[100:103]
s_sub_u32 s73, 1, s73
s_sub_u32 s70, s70, 1
s_cmp_lg_u32 s70, 0
v_mfma_f32_16x16x32_bf16 v[100:103], a[204:207], a[52:55], v[100:103]
v_mfma_f32_16x16x32_bf16 v[132:135], a[204:207], a[60:63], v[132:135]
v_mfma_f32_16x16x32_bf16 v[132:135], a[200:203], a[56:59], v[132:135]
s_cbranch_scc1 L_p5loop
s_waitcnt lgkmcnt(10)
s_waitcnt vmcnt(25)
v_mfma_f32_16x16x32_bf16 v[136:139], a[144:147], a[232:235], v[136:139]
s_waitcnt vmcnt(21)
s_waitcnt lgkmcnt(8)
s_add_u32 m0, s86, 70656
s_add_u32 s64, s85, 565248
ds_read_b64_tr_b16 a[168:169], v191 offset:32768
v_mfma_f32_16x16x32_bf16 v[136:139], a[148:151], a[236:239], v[136:139]
buffer_load_dwordx4 v13, s[40:43], s64 offen lds
v_mfma_f32_16x16x32_bf16 v[104:107], a[148:151], a[228:231], v[104:107]
s_add_u32 m0, s86, 71680
ds_read_b64_tr_b16 a[170:171], v191 offset:36864
v_mfma_f32_16x16x32_bf16 v[104:107], a[144:147], a[224:227], v[104:107]
s_add_u32 s64, s85, 573440
ds_read_b64_tr_b16 a[172:173], v191 offset:40960
v_mfma_f32_16x16x32_bf16 v[72:75], a[144:147], a[216:219], v[72:75]
buffer_load_dwordx4 v12, s[40:43], s64 offen lds
v_mfma_f32_16x16x32_bf16 v[72:75], a[148:151], a[220:223], v[72:75]
s_add_u32 m0, s86, 72704
ds_read_b64_tr_b16 a[174:175], v191 offset:45056
v_mfma_f32_16x16x32_bf16 v[40:43], a[148:151], a[212:215], v[40:43]
s_add_u32 s64, s85, 581632
ds_read_b64_tr_b16 a[176:177], v184 offset:32768
v_mfma_f32_16x16x32_bf16 v[40:43], a[144:147], a[208:211], v[40:43]
s_waitcnt lgkmcnt(5)
buffer_load_dwordx4 v13, s[40:43], s64 offen lds
v_mfma_f32_16x16x32_bf16 v[44:47], a[152:155], a[208:211], v[44:47]
ds_read_b64_tr_b16 a[178:179], v184 offset:36864
v_mfma_f32_16x16x32_bf16 v[44:47], a[156:159], a[212:215], v[44:47]
ds_read_b64_tr_b16 a[180:181], v184 offset:40960
v_mfma_f32_16x16x32_bf16 v[76:79], a[156:159], a[220:223], v[76:79]
s_add_u32 s65, s84, 65536
ds_read_b64_tr_b16 a[182:183], v184 offset:45056
v_mfma_f32_16x16x32_bf16 v[76:79], a[152:155], a[216:219], v[76:79]
buffer_load_dwordx4 a[0:3], v14, s[44:47], s65 offen offset:0 sc1
v_mfma_f32_16x16x32_bf16 v[108:111], a[152:155], a[224:227], v[108:111]
ds_read_b64_tr_b16 a[184:185], v185 offset:32768
v_mfma_f32_16x16x32_bf16 v[108:111], a[156:159], a[228:231], v[108:111]
ds_read_b64_tr_b16 a[186:187], v185 offset:36864
v_mfma_f32_16x16x32_bf16 v[140:143], a[156:159], a[236:239], v[140:143]
buffer_load_dwordx4 a[8:11], v14, s[44:47], s65 offen offset:1024 sc1
v_mfma_f32_16x16x32_bf16 v[140:143], a[152:155], a[232:235], v[140:143]
ds_read_b64_tr_b16 a[188:189], v185 offset:40960
v_mfma_f32_16x16x32_bf16 v[144:147], a[160:163], a[232:235], v[144:147]
ds_read_b64_tr_b16 a[190:191], v185 offset:45056
v_mfma_f32_16x16x32_bf16 v[144:147], a[164:167], a[236:239], v[144:147]
v_mfma_f32_16x16x32_bf16 v[112:115], a[164:167], a[228:231], v[112:115]
buffer_load_dwordx4 a[16:19], v15, s[44:47], s65 offen offset:0 sc1
v_mfma_f32_16x16x32_bf16 v[112:115], a[160:163], a[224:227], v[112:115]
ds_read_b64_tr_b16 a[192:193], v186 offset:32768
v_mfma_f32_16x16x32_bf16 v[80:83], a[160:163], a[216:219], v[80:83]
ds_read_b64_tr_b16 a[194:195], v186 offset:36864
v_mfma_f32_16x16x32_bf16 v[80:83], a[164:167], a[220:223], v[80:83]
buffer_load_dwordx4 a[24:27], v15, s[44:47], s65 offen offset:1024 sc1
v_mfma_f32_16x16x32_bf16 v[48:51], a[164:167], a[212:215], v[48:51]
ds_read_b64_tr_b16 a[196:197], v186 offset:40960
v_mfma_f32_16x16x32_bf16 v[48:51], a[160:163], a[208:211], v[48:51]
s_waitcnt lgkmcnt(4)
ds_read_b64_tr_b16 a[198:199], v186 offset:45056
v_mfma_f32_16x16x32_bf16 v[52:55], a[168:171], a[208:211], v[52:55]
s_add_u32 s65, s84, 73728
v_mfma_f32_16x16x32_bf16 v[52:55], a[172:175], a[212:215], v[52:55]
buffer_load_dwordx4 a[4:7], v14, s[44:47], s65 offen offset:0 sc1
v_mfma_f32_16x16x32_bf16 v[84:87], a[172:175], a[220:223], v[84:87]
ds_read_b64_tr_b16 a[200:201], v187 offset:32768
v_mfma_f32_16x16x32_bf16 v[84:87], a[168:171], a[216:219], v[84:87]
ds_read_b64_tr_b16 a[202:203], v187 offset:36864
v_mfma_f32_16x16x32_bf16 v[116:119], a[168:171], a[224:227], v[116:119]
buffer_load_dwordx4 a[12:15], v14, s[44:47], s65 offen offset:1024 sc1
v_mfma_f32_16x16x32_bf16 v[116:119], a[172:175], a[228:231], v[116:119]
ds_read_b64_tr_b16 a[204:205], v187 offset:40960
v_mfma_f32_16x16x32_bf16 v[148:151], a[172:175], a[236:239], v[148:151]
ds_read_b64_tr_b16 a[206:207], v187 offset:45056
v_mfma_f32_16x16x32_bf16 v[148:151], a[168:171], a[232:235], v[148:151]
v_mfma_f32_16x16x32_bf16 v[120:123], a[176:179], a[232:235], v[120:123]
buffer_load_dwordx4 a[20:23], v15, s[44:47], s65 offen offset:0 sc1
v_mfma_f32_16x16x32_bf16 v[120:123], a[180:183], a[236:239], v[120:123]
v_mfma_f32_16x16x32_bf16 v[88:91], a[180:183], a[228:231], v[88:91]
v_mfma_f32_16x16x32_bf16 v[88:91], a[176:179], a[224:227], v[88:91]
buffer_load_dwordx4 a[28:31], v15, s[44:47], s65 offen offset:1024 sc1
v_mfma_f32_16x16x32_bf16 v[56:59], a[176:179], a[216:219], v[56:59]
v_mfma_f32_16x16x32_bf16 v[56:59], a[180:183], a[220:223], v[56:59]
v_mfma_f32_16x16x32_bf16 v[24:27], a[180:183], a[212:215], v[24:27]
v_mfma_f32_16x16x32_bf16 v[24:27], a[176:179], a[208:211], v[24:27]
v_mfma_f32_16x16x32_bf16 v[28:31], a[184:187], a[208:211], v[28:31]
s_waitcnt vmcnt(24)
s_barrier
s_waitcnt lgkmcnt(0)
v_mfma_f32_16x16x32_bf16 v[28:31], a[188:191], a[212:215], v[28:31]
s_add_u32 m0, s86, 98304
ds_read_b64_tr_b16 a[144:145], v196 offset:0
v_mfma_f32_16x16x32_bf16 v[60:63], a[188:191], a[220:223], v[60:63]
s_add_u32 s64, s85, 786432
ds_read_b64_tr_b16 a[146:147], v196 offset:4096
v_mfma_f32_16x16x32_bf16 v[60:63], a[184:187], a[216:219], v[60:63]
buffer_load_dwordx4 v12, s[40:43], s64 offen lds
v_mfma_f32_16x16x32_bf16 v[92:95], a[184:187], a[224:227], v[92:95]
ds_read_b64_tr_b16 a[148:149], v196 offset:8192
v_mfma_f32_16x16x32_bf16 v[92:95], a[188:191], a[228:231], v[92:95]
s_add_u32 m0, s86, 99328
ds_read_b64_tr_b16 a[150:151], v196 offset:12288
v_mfma_f32_16x16x32_bf16 v[124:127], a[188:191], a[236:239], v[124:127]
s_add_u32 s64, s85, 794624
ds_read_b64_tr_b16 a[152:153], v197 offset:0
v_mfma_f32_16x16x32_bf16 v[124:127], a[184:187], a[232:235], v[124:127]
buffer_load_dwordx4 v13, s[40:43], s64 offen lds
v_mfma_f32_16x16x32_bf16 v[128:131], a[192:195], a[232:235], v[128:131]
ds_read_b64_tr_b16 a[154:155], v197 offset:4096
v_mfma_f32_16x16x32_bf16 v[128:131], a[196:199], a[236:239], v[128:131]
s_add_u32 m0, s86, 100352
ds_read_b64_tr_b16 a[156:157], v197 offset:8192
v_mfma_f32_16x16x32_bf16 v[96:99], a[196:199], a[228:231], v[96:99]
s_add_u32 s64, s85, 802816
ds_read_b64_tr_b16 a[158:159], v197 offset:12288
v_mfma_f32_16x16x32_bf16 v[96:99], a[192:195], a[224:227], v[96:99]
buffer_load_dwordx4 v12, s[40:43], s64 offen lds
v_mfma_f32_16x16x32_bf16 v[64:67], a[192:195], a[216:219], v[64:67]
ds_read_b64_tr_b16 a[160:161], v198 offset:0
v_mfma_f32_16x16x32_bf16 v[64:67], a[196:199], a[220:223], v[64:67]
s_add_u32 m0, s86, 101376
ds_read_b64_tr_b16 a[162:163], v198 offset:4096
v_mfma_f32_16x16x32_bf16 v[32:35], a[196:199], a[212:215], v[32:35]
s_add_u32 s64, s85, 811008
ds_read_b64_tr_b16 a[164:165], v198 offset:8192
v_mfma_f32_16x16x32_bf16 v[32:35], a[192:195], a[208:211], v[32:35]
buffer_load_dwordx4 v13, s[40:43], s64 offen lds
v_mfma_f32_16x16x32_bf16 v[36:39], a[200:203], a[208:211], v[36:39]
ds_read_b64_tr_b16 a[166:167], v198 offset:12288
v_mfma_f32_16x16x32_bf16 v[36:39], a[204:207], a[212:215], v[36:39]
s_add_u32 m0, s86, 102400
v_mfma_f32_16x16x32_bf16 v[68:71], a[204:207], a[220:223], v[68:71]
s_add_u32 s64, s85, 819200
v_mfma_f32_16x16x32_bf16 v[68:71], a[200:203], a[216:219], v[68:71]
buffer_load_dwordx4 v12, s[40:43], s64 offen lds
v_mfma_f32_16x16x32_bf16 v[100:103], a[200:203], a[224:227], v[100:103]
v_mfma_f32_16x16x32_bf16 v[100:103], a[204:207], a[228:231], v[100:103]
v_mfma_f32_16x16x32_bf16 v[132:135], a[204:207], a[236:239], v[132:135]
v_mfma_f32_16x16x32_bf16 v[132:135], a[200:203], a[232:235], v[132:135]
s_waitcnt vmcnt(25)
s_waitcnt lgkmcnt(1)
s_add_u32 m0, s86, 103424
v_mfma_f32_16x16x32_bf16 v[136:139], a[144:147], v[176:179], v[136:139]
s_waitcnt vmcnt(21)
s_add_u32 s64, s85, 827392
ds_read_b64_tr_b16 a[168:169], v199 offset:0
v_mfma_f32_16x16x32_bf16 v[136:139], a[148:151], v[180:183], v[136:139]
buffer_load_dwordx4 v13, s[40:43], s64 offen lds
v_mfma_f32_16x16x32_bf16 v[104:107], a[148:151], v[172:175], v[104:107]
s_add_u32 m0, s86, 104448
ds_read_b64_tr_b16 a[170:171], v199 offset:4096
v_mfma_f32_16x16x32_bf16 v[104:107], a[144:147], v[168:171], v[104:107]
s_add_u32 s64, s85, 835584
ds_read_b64_tr_b16 a[172:173], v199 offset:8192
v_mfma_f32_16x16x32_bf16 v[72:75], a[144:147], v[160:163], v[72:75]
buffer_load_dwordx4 v12, s[40:43], s64 offen lds
v_mfma_f32_16x16x32_bf16 v[72:75], a[148:151], v[164:167], v[72:75]
s_add_u32 m0, s86, 105472
ds_read_b64_tr_b16 a[174:175], v199 offset:12288
v_mfma_f32_16x16x32_bf16 v[40:43], a[148:151], v[156:159], v[40:43]
s_add_u32 s64, s85, 843776
ds_read_b64_tr_b16 a[176:177], v192 offset:0
v_mfma_f32_16x16x32_bf16 v[40:43], a[144:147], v[152:155], v[40:43]
buffer_load_dwordx4 v13, s[40:43], s64 offen lds
v_mfma_f32_16x16x32_bf16 v[44:47], a[152:155], v[152:155], v[44:47]
ds_read_b64_tr_b16 a[178:179], v192 offset:4096
v_mfma_f32_16x16x32_bf16 v[44:47], a[156:159], v[156:159], v[44:47]
ds_read_b64_tr_b16 a[180:181], v192 offset:8192
v_mfma_f32_16x16x32_bf16 v[76:79], a[156:159], v[164:167], v[76:79]
s_add_u32 s65, s84, 98304
ds_read_b64_tr_b16 a[182:183], v192 offset:12288
v_mfma_f32_16x16x32_bf16 v[76:79], a[152:155], v[160:163], v[76:79]
buffer_load_dwordx4 a[32:35], v14, s[44:47], s65 offen offset:0 sc1
v_mfma_f32_16x16x32_bf16 v[108:111], a[152:155], v[168:171], v[108:111]
ds_read_b64_tr_b16 a[184:185], v193 offset:0
v_mfma_f32_16x16x32_bf16 v[108:111], a[156:159], v[172:175], v[108:111]
ds_read_b64_tr_b16 a[186:187], v193 offset:4096
v_mfma_f32_16x16x32_bf16 v[140:143], a[156:159], v[180:183], v[140:143]
buffer_load_dwordx4 a[40:43], v14, s[44:47], s65 offen offset:1024 sc1
v_mfma_f32_16x16x32_bf16 v[140:143], a[152:155], v[176:179], v[140:143]
ds_read_b64_tr_b16 a[188:189], v193 offset:8192
v_mfma_f32_16x16x32_bf16 v[144:147], a[160:163], v[176:179], v[144:147]
s_waitcnt lgkmcnt(5)
ds_read_b64_tr_b16 a[190:191], v193 offset:12288
v_mfma_f32_16x16x32_bf16 v[144:147], a[164:167], v[180:183], v[144:147]
v_mfma_f32_16x16x32_bf16 v[112:115], a[164:167], v[172:175], v[112:115]
buffer_load_dwordx4 a[48:51], v15, s[44:47], s65 offen offset:0 sc1
v_mfma_f32_16x16x32_bf16 v[112:115], a[160:163], v[168:171], v[112:115]
ds_read_b64_tr_b16 a[192:193], v194 offset:0
v_mfma_f32_16x16x32_bf16 v[80:83], a[160:163], v[160:163], v[80:83]
ds_read_b64_tr_b16 a[194:195], v194 offset:4096
v_mfma_f32_16x16x32_bf16 v[80:83], a[164:167], v[164:167], v[80:83]
buffer_load_dwordx4 a[56:59], v15, s[44:47], s65 offen offset:1024 sc1
v_mfma_f32_16x16x32_bf16 v[48:51], a[164:167], v[156:159], v[48:51]
ds_read_b64_tr_b16 a[196:197], v194 offset:8192
v_mfma_f32_16x16x32_bf16 v[48:51], a[160:163], v[152:155], v[48:51]
ds_read_b64_tr_b16 a[198:199], v194 offset:12288
v_mfma_f32_16x16x32_bf16 v[52:55], a[168:171], v[152:155], v[52:55]
s_add_u32 s65, s84, 106496
v_mfma_f32_16x16x32_bf16 v[52:55], a[172:175], v[156:159], v[52:55]
buffer_load_dwordx4 a[36:39], v14, s[44:47], s65 offen offset:0 sc1
v_mfma_f32_16x16x32_bf16 v[84:87], a[172:175], v[164:167], v[84:87]
ds_read_b64_tr_b16 a[200:201], v195 offset:0
v_mfma_f32_16x16x32_bf16 v[84:87], a[168:171], v[160:163], v[84:87]
ds_read_b64_tr_b16 a[202:203], v195 offset:4096
v_mfma_f32_16x16x32_bf16 v[116:119], a[168:171], v[168:171], v[116:119]
buffer_load_dwordx4 a[44:47], v14, s[44:47], s65 offen offset:1024 sc1
v_mfma_f32_16x16x32_bf16 v[116:119], a[172:175], v[172:175], v[116:119]
ds_read_b64_tr_b16 a[204:205], v195 offset:8192
v_mfma_f32_16x16x32_bf16 v[148:151], a[172:175], v[180:183], v[148:151]
ds_read_b64_tr_b16 a[206:207], v195 offset:12288
v_mfma_f32_16x16x32_bf16 v[148:151], a[168:171], v[176:179], v[148:151]
v_mfma_f32_16x16x32_bf16 v[120:123], a[176:179], v[176:179], v[120:123]
s_waitcnt lgkmcnt(4)
buffer_load_dwordx4 a[52:55], v15, s[44:47], s65 offen offset:0 sc1
v_mfma_f32_16x16x32_bf16 v[120:123], a[180:183], v[180:183], v[120:123]
v_mfma_f32_16x16x32_bf16 v[88:91], a[180:183], v[172:175], v[88:91]
v_mfma_f32_16x16x32_bf16 v[88:91], a[176:179], v[168:171], v[88:91]
buffer_load_dwordx4 a[60:63], v15, s[44:47], s65 offen offset:1024 sc1
v_mfma_f32_16x16x32_bf16 v[56:59], a[176:179], v[160:163], v[56:59]
v_mfma_f32_16x16x32_bf16 v[56:59], a[180:183], v[164:167], v[56:59]
v_mfma_f32_16x16x32_bf16 v[24:27], a[180:183], v[156:159], v[24:27]
v_mfma_f32_16x16x32_bf16 v[24:27], a[176:179], v[152:155], v[24:27]
v_mfma_f32_16x16x32_bf16 v[28:31], a[184:187], v[152:155], v[28:31]
s_waitcnt vmcnt(24)
s_barrier
v_mfma_f32_16x16x32_bf16 v[28:31], a[188:191], v[156:159], v[28:31]
ds_read_b64_tr_b16 a[144:145], v196 offset:32768
v_mfma_f32_16x16x32_bf16 v[60:63], a[188:191], v[164:167], v[60:63]
ds_read_b64_tr_b16 a[146:147], v196 offset:36864
v_mfma_f32_16x16x32_bf16 v[60:63], a[184:187], v[160:163], v[60:63]
ds_read_b64_tr_b16 a[148:149], v196 offset:40960
v_mfma_f32_16x16x32_bf16 v[92:95], a[184:187], v[168:171], v[92:95]
s_xor_b32 s66, s2, 1
s_lshl2_add_u32 s66, s66, s30
ds_read_b64_tr_b16 a[150:151], v196 offset:45056
v_mfma_f32_16x16x32_bf16 v[92:95], a[188:191], v[172:175], v[92:95]
s_lshl_b32 s73, s66, 12
s_add_u32 s73, s73, 67108864
ds_read_b64_tr_b16 a[152:153], v197 offset:32768
v_mfma_f32_16x16x32_bf16 v[124:127], a[188:191], v[180:183], v[124:127]
s_lshl2_add_u32 s66, s2, s30
s_lshl_b32 s75, s66, 12
ds_read_b64_tr_b16 a[154:155], v197 offset:36864
v_mfma_f32_16x16x32_bf16 v[124:127], a[184:187], v[176:179], v[124:127]
s_add_u32 s75, s75, 67108864
s_lshl_b32 s77, s82, 18
ds_read_b64_tr_b16 a[156:157], v197 offset:40960
v_mfma_f32_16x16x32_bf16 v[128:131], a[192:195], v[176:179], v[128:131]
s_lshl_b32 s66, s30, 16
s_add_u32 s77, s77, s66
ds_read_b64_tr_b16 a[158:159], v197 offset:45056
v_mfma_f32_16x16x32_bf16 v[128:131], a[196:199], v[180:183], v[128:131]
s_add_u32 s77, s77, s87
s_lshl_b32 s66, s83, 7
ds_read_b64_tr_b16 a[160:161], v198 offset:32768
v_mfma_f32_16x16x32_bf16 v[96:99], a[196:199], v[172:175], v[96:99]
s_add_u32 s77, s77, s66
ds_read_b64_tr_b16 a[162:163], v198 offset:36864
v_lshlrev_b32 v1, 24, v0
v_mfma_f32_16x16x32_bf16 v[96:99], a[192:195], v[168:171], v[96:99]
ds_read_b64_tr_b16 a[164:165], v198 offset:40960
v_and_b32 v8, 7, v0
v_mfma_f32_16x16x32_bf16 v[64:67], a[192:195], v[160:163], v[64:67]
ds_read_b64_tr_b16 a[166:167], v198 offset:45056
v_lshlrev_b32 v8, 11, v8
v_mfma_f32_16x16x32_bf16 v[64:67], a[196:199], v[164:167], v[64:67]
v_bfe_u32 v10, v0, 3, 1
v_lshl_add_u32 v8, v10, 6, v8
v_mfma_f32_16x16x32_bf16 v[32:35], a[196:199], v[156:159], v[32:35]
v_bfe_u32 v10, v0, 4, 1
v_lshl_add_u32 v8, v10, 5, v8
v_mfma_f32_16x16x32_bf16 v[32:35], a[192:195], v[152:155], v[32:35]
s_waitcnt lgkmcnt(5)
v_lshrrev_b32 v10, 5, v0
v_lshl_add_u32 v8, v10, 4, v8
v_mfma_f32_16x16x32_bf16 v[36:39], a[200:203], v[152:155], v[36:39]
v_add_u32 v2, s86, v16
v_xor_b32 v3, 0x2000, v2
v_mfma_f32_16x16x32_bf16 v[36:39], a[204:207], v[156:159], v[36:39]
v_mov_b32 v232, 0
v_mov_b32 v233, 0
v_mfma_f32_16x16x32_bf16 v[68:71], a[204:207], v[164:167], v[68:71]
v_mov_b32 v236, 0
v_mov_b32 v237, 0
v_mfma_f32_16x16x32_bf16 v[68:71], a[200:203], v[160:163], v[68:71]
v_and_b32 v9, 1, v0
v_lshlrev_b32 v9, 4, v9
v_mfma_f32_16x16x32_bf16 v[100:103], a[200:203], v[168:171], v[100:103]
v_mov_b32 v10, 0x3f80
v_lshlrev_b32 v9, v9, v10
v_mfma_f32_16x16x32_bf16 v[100:103], a[204:207], v[172:175], v[100:103]
v_lshrrev_b32 v10, 4, v0
v_lshlrev_b32 v10, 1, v10
v_mfma_f32_16x16x32_bf16 v[132:135], a[204:207], v[180:183], v[132:135]
v_bfe_u32 v11, v0, 1, 3
v_xor_b32 v10, v10, v11
v_mfma_f32_16x16x32_bf16 v[132:135], a[200:203], v[176:179], v[132:135]
s_waitcnt vmcnt(20)
v_subrev_u32 v11, 1, v10
v_ashrrev_i32 v11, 31, v11
v_mfma_f32_16x16x32_bf16 v[136:139], a[144:147], a[24:27], v[136:139]
s_waitcnt vmcnt(16)
ds_read_b64_tr_b16 a[168:169], v199 offset:32768
v_and_b32 v234, v11, v9
v_mfma_f32_16x16x32_bf16 v[136:139], a[148:151], a[28:31], v[136:139]
ds_read_b64_tr_b16 a[170:171], v199 offset:36864
v_xor_b32 v10, 1, v10
v_mfma_f32_16x16x32_bf16 v[104:107], a[148:151], a[20:23], v[104:107]
ds_read_b64_tr_b16 a[172:173], v199 offset:40960
v_subrev_u32 v11, 1, v10
v_mfma_f32_16x16x32_bf16 v[104:107], a[144:147], a[16:19], v[104:107]
ds_read_b64_tr_b16 a[174:175], v199 offset:45056
v_ashrrev_i32 v11, 31, v11
v_mfma_f32_16x16x32_bf16 v[72:75], a[144:147], a[8:11], v[72:75]
v_and_b32 v235, v11, v9
v_mfma_f32_16x16x32_bf16 v[72:75], a[148:151], a[12:15], v[72:75]
s_mov_b32 s48, s24
s_mov_b32 s49, s25
s_mov_b32 s50, 4194304
v_mfma_f32_16x16x32_bf16 v[40:43], a[148:151], a[4:7], v[40:43]
s_mov_b32 s51, 0x20000
s_waitcnt vmcnt(8)
s_barrier
v_mfma_f32_16x16x32_bf16 v[40:43], a[144:147], a[0:3], v[40:43]
ds_read_b64_tr_b16 a[176:177], v188 offset:0
v_mfma_f32_16x16x32_bf16 v[44:47], a[152:155], a[0:3], v[44:47]
s_waitcnt lgkmcnt(4)
ds_read_b64_tr_b16 a[178:179], v188 offset:4096
v_mfma_f32_16x16x32_bf16 v[44:47], a[156:159], a[4:7], v[44:47]
ds_read_b64_tr_b16 a[180:181], v188 offset:8192
v_mfma_f32_16x16x32_bf16 v[76:79], a[156:159], a[12:15], v[76:79]
ds_read_b64_tr_b16 a[182:183], v188 offset:12288
v_mfma_f32_16x16x32_bf16 v[76:79], a[152:155], a[8:11], v[76:79]
ds_read_b64_tr_b16 a[184:185], v189 offset:0
v_mfma_f32_16x16x32_bf16 v[108:111], a[152:155], a[16:19], v[108:111]
ds_read_b64_tr_b16 a[186:187], v189 offset:4096
v_mfma_f32_16x16x32_bf16 v[108:111], a[156:159], a[20:23], v[108:111]
ds_read_b64_tr_b16 a[188:189], v189 offset:8192
v_mfma_f32_16x16x32_bf16 v[140:143], a[156:159], a[28:31], v[140:143]
ds_read_b64_tr_b16 a[190:191], v189 offset:12288
v_mfma_f32_16x16x32_bf16 v[140:143], a[152:155], a[24:27], v[140:143]
v_mfma_f32_16x16x32_bf16 v[144:147], a[160:163], a[24:27], v[144:147]
v_mfma_f32_16x16x32_bf16 v[144:147], a[164:167], a[28:31], v[144:147]
v_mfma_f32_16x16x32_bf16 v[112:115], a[164:167], a[20:23], v[112:115]
ds_read_b64_tr_b16 a[192:193], v190 offset:0
v_mfma_f32_16x16x32_bf16 v[112:115], a[160:163], a[16:19], v[112:115]
ds_read_b64_tr_b16 a[194:195], v190 offset:4096
v_mfma_f32_16x16x32_bf16 v[80:83], a[160:163], a[8:11], v[80:83]
ds_read_b64_tr_b16 a[196:197], v190 offset:8192
v_mfma_f32_16x16x32_bf16 v[80:83], a[164:167], a[12:15], v[80:83]
ds_read_b64_tr_b16 a[198:199], v190 offset:12288
v_mfma_f32_16x16x32_bf16 v[48:51], a[164:167], a[4:7], v[48:51]
v_mfma_f32_16x16x32_bf16 v[48:51], a[160:163], a[0:3], v[48:51]
s_waitcnt lgkmcnt(4)
v_mfma_f32_16x16x32_bf16 v[52:55], a[168:171], a[0:3], v[52:55]
v_mfma_f32_16x16x32_bf16 v[52:55], a[172:175], a[4:7], v[52:55]
v_mfma_f32_16x16x32_bf16 v[84:87], a[172:175], a[12:15], v[84:87]
ds_read_b64_tr_b16 a[200:201], v191 offset:0
v_mfma_f32_16x16x32_bf16 v[84:87], a[168:171], a[8:11], v[84:87]
ds_read_b64_tr_b16 a[202:203], v191 offset:4096
v_mfma_f32_16x16x32_bf16 v[116:119], a[168:171], a[16:19], v[116:119]
ds_read_b64_tr_b16 a[204:205], v191 offset:8192
v_mfma_f32_16x16x32_bf16 v[116:119], a[172:175], a[20:23], v[116:119]
ds_read_b64_tr_b16 a[206:207], v191 offset:12288
v_mfma_f32_16x16x32_bf16 v[148:151], a[172:175], a[28:31], v[148:151]
v_mfma_f32_16x16x32_bf16 v[148:151], a[168:171], a[24:27], v[148:151]
s_waitcnt vmcnt(4)
v_mfma_f32_16x16x32_bf16 v[136:139], a[176:179], a[56:59], v[136:139]
s_waitcnt vmcnt(0)
v_mfma_f32_16x16x32_bf16 v[136:139], a[180:183], a[60:63], v[136:139]
v_mfma_f32_16x16x32_bf16 v[104:107], a[180:183], a[52:55], v[104:107]
ds_read_b64_tr_b16 a[144:145], v192 offset:32768
v_mfma_f32_16x16x32_bf16 v[104:107], a[176:179], a[48:51], v[104:107]
ds_read_b64_tr_b16 a[146:147], v192 offset:36864
v_mfma_f32_16x16x32_bf16 v[72:75], a[176:179], a[40:43], v[72:75]
ds_read_b64_tr_b16 a[148:149], v192 offset:40960
v_mfma_f32_16x16x32_bf16 v[72:75], a[180:183], a[44:47], v[72:75]
ds_read_b64_tr_b16 a[150:151], v192 offset:45056
v_mfma_f32_16x16x32_bf16 v[40:43], a[180:183], a[36:39], v[40:43]
v_mfma_f32_16x16x32_bf16 v[40:43], a[176:179], a[32:35], v[40:43]
v_mfma_f32_16x16x32_bf16 v[44:47], a[184:187], a[32:35], v[44:47]
ds_write_b128 v3, v[136:139] offset:4096
v_mfma_f32_16x16x32_bf16 v[44:47], a[188:191], a[36:39], v[44:47]
v_mfma_f32_16x16x32_bf16 v[76:79], a[188:191], a[44:47], v[76:79]
ds_write_b128 v3, v[104:107] offset:0
v_mfma_f32_16x16x32_bf16 v[76:79], a[184:187], a[40:43], v[76:79]
ds_read_b64_tr_b16 a[152:153], v193 offset:32768
v_mfma_f32_16x16x32_bf16 v[108:111], a[184:187], a[48:51], v[108:111]
ds_read_b64_tr_b16 a[154:155], v193 offset:36864
v_mfma_f32_16x16x32_bf16 v[108:111], a[188:191], a[52:55], v[108:111]
ds_read_b64_tr_b16 a[156:157], v193 offset:40960
v_mfma_f32_16x16x32_bf16 v[140:143], a[188:191], a[60:63], v[140:143]
ds_read_b64_tr_b16 a[158:159], v193 offset:45056
v_mfma_f32_16x16x32_bf16 v[140:143], a[184:187], a[56:59], v[140:143]
s_waitcnt lgkmcnt(6)
v_mfma_f32_16x16x32_bf16 v[144:147], a[192:195], a[56:59], v[144:147]
v_mfma_f32_16x16x32_bf16 v[144:147], a[196:199], a[60:63], v[144:147]
v_mfma_f32_16x16x32_bf16 v[112:115], a[196:199], a[52:55], v[112:115]
ds_read_b64_tr_b16 a[160:161], v194 offset:32768
v_mfma_f32_16x16x32_bf16 v[112:115], a[192:195], a[48:51], v[112:115]
ds_read_b64_tr_b16 a[162:163], v194 offset:36864
v_mfma_f32_16x16x32_bf16 v[80:83], a[192:195], a[40:43], v[80:83]
ds_write_b128 v3, v[108:111] offset:1024
v_mfma_f32_16x16x32_bf16 v[80:83], a[196:199], a[44:47], v[80:83]
ds_read_b64_tr_b16 a[164:165], v194 offset:40960
v_mfma_f32_16x16x32_bf16 v[48:51], a[196:199], a[36:39], v[48:51]
ds_write_b128 v3, v[140:143] offset:5120
v_mfma_f32_16x16x32_bf16 v[48:51], a[192:195], a[32:35], v[48:51]
ds_read_b64_tr_b16 a[166:167], v194 offset:45056
v_mfma_f32_16x16x32_bf16 v[52:55], a[200:203], a[32:35], v[52:55]
ds_write_b128 v3, v[144:147] offset:6144
v_mfma_f32_16x16x32_bf16 v[52:55], a[204:207], a[36:39], v[52:55]
v_mfma_f32_16x16x32_bf16 v[84:87], a[204:207], a[44:47], v[84:87]
ds_write_b128 v3, v[112:115] offset:2048
v_mfma_f32_16x16x32_bf16 v[84:87], a[200:203], a[40:43], v[84:87]
ds_read_b64_tr_b16 a[168:169], v195 offset:32768
v_mfma_f32_16x16x32_bf16 v[116:119], a[200:203], a[48:51], v[116:119]
ds_read_b64_tr_b16 a[170:171], v195 offset:36864
v_mfma_f32_16x16x32_bf16 v[116:119], a[204:207], a[52:55], v[116:119]
ds_read_b64_tr_b16 a[172:173], v195 offset:40960
v_mfma_f32_16x16x32_bf16 v[148:151], a[204:207], a[60:63], v[148:151]
ds_read_b64_tr_b16 a[174:175], v195 offset:45056
v_mfma_f32_16x16x32_bf16 v[148:151], a[200:203], a[56:59], v[148:151]
v_mfma_f32_16x16x32_bf16 v[120:123], a[144:147], a[24:27], v[120:123]
v_mfma_f32_16x16x32_bf16 v[120:123], a[148:151], a[28:31], v[120:123]
v_mfma_f32_16x16x32_bf16 v[88:91], a[148:151], a[20:23], v[88:91]
ds_read_b64_tr_b16 a[176:177], v184 offset:0
v_mfma_f32_16x16x32_bf16 v[88:91], a[144:147], a[16:19], v[88:91]
ds_read_b64_tr_b16 a[178:179], v184 offset:4096
v_mfma_f32_16x16x32_bf16 v[56:59], a[144:147], a[8:11], v[56:59]
ds_write_b128 v3, v[116:119] offset:3072
v_mfma_f32_16x16x32_bf16 v[56:59], a[148:151], a[12:15], v[56:59]
ds_read_b64_tr_b16 a[180:181], v184 offset:8192
v_mfma_f32_16x16x32_bf16 v[24:27], a[148:151], a[4:7], v[24:27]
ds_write_b128 v3, v[148:151] offset:7168
v_mfma_f32_16x16x32_bf16 v[24:27], a[144:147], a[0:3], v[24:27]
s_waitcnt lgkmcnt(5)
ds_read_b64_tr_b16 a[182:183], v184 offset:12288
v_mfma_f32_16x16x32_bf16 v[28:31], a[152:155], a[0:3], v[28:31]
v_mfma_f32_16x16x32_bf16 v[28:31], a[156:159], a[4:7], v[28:31]
s_waitcnt lgkmcnt(0)
s_barrier
v_mfma_f32_16x16x32_bf16 v[60:63], a[156:159], a[12:15], v[60:63]
ds_read_b128 v[200:203], v2 offset:0
ds_read_b128 v[204:207], v2 offset:1024
v_mfma_f32_16x16x32_bf16 v[60:63], a[152:155], a[8:11], v[60:63]
ds_read_b128 v[208:211], v2 offset:2048
ds_read_b128 v[212:215], v2 offset:3072
v_mfma_f32_16x16x32_bf16 v[92:95], a[152:155], a[16:19], v[92:95]
ds_read_b128 v[216:219], v2 offset:4096
ds_read_b128 v[220:223], v2 offset:5120
v_mfma_f32_16x16x32_bf16 v[92:95], a[156:159], a[20:23], v[92:95]
ds_read_b128 v[224:227], v2 offset:6144
ds_read_b128 v[228:231], v2 offset:7168
v_mfma_f32_16x16x32_bf16 v[124:127], a[156:159], a[28:31], v[124:127]
ds_read_b64_tr_b16 a[184:185], v185 offset:0
v_mfma_f32_16x16x32_bf16 v[124:127], a[152:155], a[24:27], v[124:127]
ds_read_b64_tr_b16 a[186:187], v185 offset:4096
v_mfma_f32_16x16x32_bf16 v[128:131], a[160:163], a[24:27], v[128:131]
ds_read_b64_tr_b16 a[188:189], v185 offset:8192
v_mfma_f32_16x16x32_bf16 v[128:131], a[164:167], a[28:31], v[128:131]
ds_read_b64_tr_b16 a[190:191], v185 offset:12288
v_mfma_f32_16x16x32_bf16 v[96:99], a[164:167], a[20:23], v[96:99]
s_waitcnt lgkmcnt(10)
ds_read_b64_tr_b16 a[192:193], v186 offset:0
v_add_f32 v200, v200, v40
v_mfma_f32_16x16x32_bf16 v[96:99], a[160:163], a[16:19], v[96:99]
ds_read_b64_tr_b16 a[194:195], v186 offset:4096
v_add_f32 v201, v201, v41
v_mfma_f32_16x16x32_bf16 v[64:67], a[160:163], a[8:11], v[64:67]
ds_read_b64_tr_b16 a[196:197], v186 offset:8192
v_add_f32 v202, v202, v42
v_mfma_f32_16x16x32_bf16 v[64:67], a[164:167], a[12:15], v[64:67]
ds_read_b64_tr_b16 a[198:199], v186 offset:12288
v_add_f32 v203, v203, v43
v_mfma_f32_16x16x32_bf16 v[32:35], a[164:167], a[4:7], v[32:35]
v_add_f32 v204, v204, v44
v_add_f32 v205, v205, v45
v_mfma_f32_16x16x32_bf16 v[32:35], a[160:163], a[0:3], v[32:35]
v_add_f32 v206, v206, v46
v_add_f32 v207, v207, v47
v_mfma_f32_16x16x32_bf16 v[36:39], a[168:171], a[0:3], v[36:39]
v_cvt_pk_bf16_f32 v200, v200, v201
v_cvt_pk_bf16_f32 v201, v202, v203
v_mfma_f32_16x16x32_bf16 v[36:39], a[172:175], a[4:7], v[36:39]
v_cvt_pk_bf16_f32 v202, v204, v205
v_cvt_pk_bf16_f32 v203, v206, v207
v_mfma_f32_16x16x32_bf16 v[68:71], a[172:175], a[12:15], v[68:71]
buffer_store_dwordx4 v[200:203], v16, s[44:47], s73 offen offset:0 sc1
v_mfma_f32_16x16x32_bf16 v[68:71], a[168:171], a[8:11], v[68:71]
s_waitcnt lgkmcnt(2)
ds_read_b64_tr_b16 a[200:201], v187 offset:0
v_add_f32 v208, v208, v48
v_mfma_f32_16x16x32_bf16 v[100:103], a[168:171], a[16:19], v[100:103]
ds_read_b64_tr_b16 a[202:203], v187 offset:4096
v_add_f32 v209, v209, v49
v_mfma_f32_16x16x32_bf16 v[100:103], a[172:175], a[20:23], v[100:103]
ds_read_b64_tr_b16 a[204:205], v187 offset:8192
v_add_f32 v210, v210, v50
v_mfma_f32_16x16x32_bf16 v[132:135], a[172:175], a[28:31], v[132:135]
ds_read_b64_tr_b16 a[206:207], v187 offset:12288
v_add_f32 v211, v211, v51
v_mfma_f32_16x16x32_bf16 v[132:135], a[168:171], a[24:27], v[132:135]
v_add_f32 v212, v212, v52
v_add_f32 v213, v213, v53
v_mfma_f32_16x16x32_bf16 v[120:123], a[176:179], a[56:59], v[120:123]
v_add_f32 v214, v214, v54
v_add_f32 v215, v215, v55
v_mfma_f32_16x16x32_bf16 v[120:123], a[180:183], a[60:63], v[120:123]
v_cvt_pk_bf16_f32 v208, v208, v209
v_cvt_pk_bf16_f32 v209, v210, v211
v_cvt_pk_bf16_f32 v210, v212, v213
v_cvt_pk_bf16_f32 v211, v214, v215
v_mfma_f32_16x16x32_bf16 v[88:91], a[180:183], a[52:55], v[88:91]
buffer_store_dwordx4 v[208:211], v16, s[44:47], s73 offen offset:1024 sc1
v_mfma_f32_16x16x32_bf16 v[88:91], a[176:179], a[48:51], v[88:91]
v_add_f32 v216, v216, v72
v_add_f32 v217, v217, v73
v_mfma_f32_16x16x32_bf16 v[56:59], a[176:179], a[40:43], v[56:59]
v_add_f32 v218, v218, v74
v_add_f32 v219, v219, v75
v_mfma_f32_16x16x32_bf16 v[56:59], a[180:183], a[44:47], v[56:59]
v_add_f32 v220, v220, v76
v_add_f32 v221, v221, v77
v_mfma_f32_16x16x32_bf16 v[24:27], a[180:183], a[36:39], v[24:27]
v_add_f32 v222, v222, v78
v_add_f32 v223, v223, v79
v_mfma_f32_16x16x32_bf16 v[24:27], a[176:179], a[32:35], v[24:27]
v_cvt_pk_bf16_f32 v216, v216, v217
v_cvt_pk_bf16_f32 v217, v218, v219
v_mfma_f32_16x16x32_bf16 v[28:31], a[184:187], a[32:35], v[28:31]
v_cvt_pk_bf16_f32 v218, v220, v221
v_cvt_pk_bf16_f32 v219, v222, v223
v_mfma_f32_16x16x32_bf16 v[28:31], a[188:191], a[36:39], v[28:31]
buffer_store_dwordx4 v[216:219], v16, s[44:47], s73 offen offset:2048 sc1
v_mfma_f32_16x16x32_bf16 v[60:63], a[188:191], a[44:47], v[60:63]
v_add_f32 v224, v224, v80
v_add_f32 v225, v225, v81
v_mfma_f32_16x16x32_bf16 v[60:63], a[184:187], a[40:43], v[60:63]
v_add_f32 v226, v226, v82
v_add_f32 v227, v227, v83
v_mfma_f32_16x16x32_bf16 v[92:95], a[184:187], a[48:51], v[92:95]
v_add_f32 v228, v228, v84
v_add_f32 v229, v229, v85
v_mfma_f32_16x16x32_bf16 v[92:95], a[188:191], a[52:55], v[92:95]
v_add_f32 v230, v230, v86
v_add_f32 v231, v231, v87
v_mfma_f32_16x16x32_bf16 v[124:127], a[188:191], a[60:63], v[124:127]
v_cvt_pk_bf16_f32 v224, v224, v225
v_cvt_pk_bf16_f32 v225, v226, v227
v_mfma_f32_16x16x32_bf16 v[124:127], a[184:187], a[56:59], v[124:127]
v_cvt_pk_bf16_f32 v226, v228, v229
v_cvt_pk_bf16_f32 v227, v230, v231
v_mfma_f32_16x16x32_bf16 v[128:131], a[192:195], a[56:59], v[128:131]
s_waitcnt lgkmcnt(0)
buffer_store_dwordx4 v[224:227], v16, s[44:47], s73 offen offset:3072 sc1
v_mfma_f32_16x16x32_bf16 v[128:131], a[196:199], a[60:63], v[128:131]
ds_write_b128 v3, v[120:123] offset:36864
v_mfma_f32_16x16x32_bf16 v[96:99], a[196:199], a[52:55], v[96:99]
ds_write_b128 v3, v[88:91] offset:32768
v_mfma_f32_16x16x32_bf16 v[96:99], a[192:195], a[48:51], v[96:99]
v_mfma_f32_16x16x32_bf16 v[64:67], a[192:195], a[40:43], v[64:67]
ds_write_b128 v3, v[92:95] offset:33792
v_mfma_f32_16x16x32_bf16 v[64:67], a[196:199], a[44:47], v[64:67]
v_mfma_f32_16x16x32_bf16 v[32:35], a[196:199], a[36:39], v[32:35]
ds_write_b128 v3, v[124:127] offset:37888
v_mfma_f32_16x16x32_bf16 v[32:35], a[192:195], a[32:35], v[32:35]
v_mfma_f32_16x16x32_bf16 v[36:39], a[200:203], a[32:35], v[36:39]
ds_write_b128 v3, v[128:131] offset:38912
v_mfma_f32_16x16x32_bf16 v[36:39], a[204:207], a[36:39], v[36:39]
v_mfma_f32_16x16x32_bf16 v[68:71], a[204:207], a[44:47], v[68:71]
ds_write_b128 v3, v[96:99] offset:34816
v_mfma_f32_16x16x32_bf16 v[68:71], a[200:203], a[40:43], v[68:71]
v_mfma_f32_16x16x32_bf16 v[100:103], a[200:203], a[48:51], v[100:103]
v_mfma_f32_16x16x32_bf16 v[100:103], a[204:207], a[52:55], v[100:103]
v_mfma_f32_16x16x32_bf16 v[132:135], a[204:207], a[60:63], v[132:135]
v_mfma_f32_16x16x32_bf16 v[132:135], a[200:203], a[56:59], v[132:135]
buffer_load_dwordx4 v[152:155], v16, s[44:47], s75 offen offset:0 sc1
buffer_load_dwordx4 v[156:159], v16, s[44:47], s75 offen offset:1024 sc1
buffer_load_dwordx4 v[160:163], v16, s[44:47], s75 offen offset:2048 sc1
buffer_load_dwordx4 v[164:167], v16, s[44:47], s75 offen offset:3072 sc1
s_nop 3
ds_write_b128 v3, v[100:103] offset:35840
ds_write_b128 v3, v[132:135] offset:39936
s_mov_b32 s72, 0x20000
s_waitcnt lgkmcnt(0)
s_barrier
ds_read_b128 v[88:91], v2 offset:32768
ds_read_b128 v[92:95], v2 offset:33792
ds_read_b128 v[96:99], v2 offset:34816
ds_read_b128 v[100:103], v2 offset:35840
ds_read_b128 v[120:123], v2 offset:36864
ds_read_b128 v[124:127], v2 offset:37888
ds_read_b128 v[128:131], v2 offset:38912
ds_read_b128 v[132:135], v2 offset:39936
s_waitcnt lgkmcnt(7)
v_add_f32 v24, v24, v88
v_add_f32 v25, v25, v89
v_add_f32 v26, v26, v90
v_add_f32 v27, v27, v91
s_waitcnt lgkmcnt(6)
v_add_f32 v28, v28, v92
v_add_f32 v29, v29, v93
v_add_f32 v30, v30, v94
v_add_f32 v31, v31, v95
s_waitcnt lgkmcnt(5)
v_add_f32 v32, v32, v96
v_add_f32 v33, v33, v97
v_add_f32 v34, v34, v98
v_add_f32 v35, v35, v99
s_waitcnt lgkmcnt(4)
v_add_f32 v36, v36, v100
v_add_f32 v37, v37, v101
v_add_f32 v38, v38, v102
v_add_f32 v39, v39, v103
s_waitcnt lgkmcnt(3)
v_add_f32 v56, v56, v120
v_add_f32 v57, v57, v121
v_add_f32 v58, v58, v122
v_add_f32 v59, v59, v123
s_waitcnt lgkmcnt(2)
v_add_f32 v60, v60, v124
v_add_f32 v61, v61, v125
v_add_f32 v62, v62, v126
v_add_f32 v63, v63, v127
s_waitcnt lgkmcnt(1)
v_add_f32 v64, v64, v128
v_add_f32 v65, v65, v129
v_add_f32 v66, v66, v130
v_add_f32 v67, v67, v131
s_waitcnt lgkmcnt(0)
v_add_f32 v68, v68, v132
v_add_f32 v69, v69, v133
v_add_f32 v70, v70, v134
v_add_f32 v71, v71, v135
L_xchk:
s_waitcnt vmcnt(0)
v_max3_u32 v9, v152, v153, v154
v_max3_u32 v9, v9, v155, v156
v_max3_u32 v9, v9, v157, v158
v_max3_u32 v9, v9, v159, v160
v_max3_u32 v9, v9, v161, v162
v_max3_u32 v9, v9, v163, v164
v_max3_u32 v9, v9, v165, v166
v_max_u32 v9, v9, v167
v_cmp_eq_u32 vcc, -1, v9
s_cbranch_vccnz L_xretry
L_xgo:
v_mfma_f32_16x16x32_bf16 v[24:27], v[234:237], v[152:155], v[24:27]
v_mfma_f32_16x16x32_bf16 v[28:31], v[232:235], v[152:155], v[28:31]
v_mfma_f32_16x16x32_bf16 v[32:35], v[234:237], v[156:159], v[32:35]
v_mfma_f32_16x16x32_bf16 v[36:39], v[232:235], v[156:159], v[36:39]
v_mfma_f32_16x16x32_bf16 v[56:59], v[234:237], v[160:163], v[56:59]
v_mfma_f32_16x16x32_bf16 v[60:63], v[232:235], v[160:163], v[60:63]
v_mfma_f32_16x16x32_bf16 v[64:67], v[234:237], v[164:167], v[64:67]
v_mfma_f32_16x16x32_bf16 v[68:71], v[232:235], v[164:167], v[68:71]
s_nop 1
v_cvt_pk_bf16_f32 v24, v24, v25
v_cvt_pk_bf16_f32 v25, v26, v27
v_cvt_pk_bf16_f32 v26, v28, v29
v_cvt_pk_bf16_f32 v27, v30, v31
v_cvt_pk_bf16_f32 v32, v32, v33
v_cvt_pk_bf16_f32 v33, v34, v35
v_cvt_pk_bf16_f32 v34, v36, v37
v_cvt_pk_bf16_f32 v35, v38, v39
v_permlane16_swap_b32 v24, v26
v_permlane16_swap_b32 v25, v27
v_permlane16_swap_b32 v32, v34
v_permlane16_swap_b32 v33, v35
v_mov_b32 v28, v24
v_mov_b32 v29, v25
v_mov_b32 v30, v26
v_mov_b32 v31, v27
v_mov_b32_dpp v24, v32 row_ror:8 row_mask:0xf bank_mask:0xc
v_mov_b32_dpp v25, v33 row_ror:8 row_mask:0xf bank_mask:0xc
v_mov_b32_dpp v26, v34 row_ror:8 row_mask:0xf bank_mask:0xc
v_mov_b32_dpp v27, v35 row_ror:8 row_mask:0xf bank_mask:0xc
v_mov_b32_dpp v32, v28 row_ror:8 row_mask:0xf bank_mask:0x3
v_mov_b32_dpp v33, v29 row_ror:8 row_mask:0xf bank_mask:0x3
v_mov_b32_dpp v34, v30 row_ror:8 row_mask:0xf bank_mask:0x3
v_mov_b32_dpp v35, v31 row_ror:8 row_mask:0xf bank_mask:0x3
buffer_store_dwordx4 v[24:27], v8, s[48:51], s77 offen sc1
s_add_u32 s77, s77, 16384
buffer_store_dwordx4 v[32:35], v8, s[48:51], s77 offen sc1
s_add_u32 s77, s77, 16384
v_cvt_pk_bf16_f32 v56, v56, v57
v_cvt_pk_bf16_f32 v57, v58, v59
v_cvt_pk_bf16_f32 v58, v60, v61
v_cvt_pk_bf16_f32 v59, v62, v63
v_cvt_pk_bf16_f32 v64, v64, v65
v_cvt_pk_bf16_f32 v65, v66, v67
v_cvt_pk_bf16_f32 v66, v68, v69
v_cvt_pk_bf16_f32 v67, v70, v71
v_permlane16_swap_b32 v56, v58
v_permlane16_swap_b32 v57, v59
v_permlane16_swap_b32 v64, v66
v_permlane16_swap_b32 v65, v67
v_mov_b32 v60, v56
v_mov_b32 v61, v57
v_mov_b32 v62, v58
v_mov_b32 v63, v59
v_mov_b32_dpp v56, v64 row_ror:8 row_mask:0xf bank_mask:0xc
v_mov_b32_dpp v57, v65 row_ror:8 row_mask:0xf bank_mask:0xc
v_mov_b32_dpp v58, v66 row_ror:8 row_mask:0xf bank_mask:0xc
v_mov_b32_dpp v59, v67 row_ror:8 row_mask:0xf bank_mask:0xc
v_mov_b32_dpp v64, v60 row_ror:8 row_mask:0xf bank_mask:0x3
v_mov_b32_dpp v65, v61 row_ror:8 row_mask:0xf bank_mask:0x3
v_mov_b32_dpp v66, v62 row_ror:8 row_mask:0xf bank_mask:0x3
v_mov_b32_dpp v67, v63 row_ror:8 row_mask:0xf bank_mask:0x3
buffer_store_dwordx4 v[56:59], v8, s[48:51], s77 offen sc1
s_add_u32 s77, s77, 16384
buffer_store_dwordx4 v[64:67], v8, s[48:51], s77 offen sc1
s_add_u32 s77, s77, 16384
L_end:
s_endpgm
L_spin_1:
s_mov_b32 vcc_hi, 0x80000
L_spinlp_3:
s_sleep 1
buffer_load_dword v1, off, s[52:55], s78 offset:0 sc1
s_waitcnt vmcnt(0)
v_readfirstlane_b32 vcc_lo, v1
s_sub_u32 vcc_hi, vcc_hi, 1
s_cbranch_scc1 L_spinbk_2
s_cmp_lt_u32 vcc_lo, s81
s_cbranch_scc1 L_spinlp_3
s_branch L_spinbk_2
L_spin_4:
s_mov_b32 vcc_hi, 0x80000
L_spinlp_6:
s_sleep 1
buffer_load_dword v1, off, s[52:55], s70 offset:0 sc1
s_waitcnt vmcnt(0)
v_readfirstlane_b32 vcc_lo, v1
s_sub_u32 vcc_hi, vcc_hi, 1
s_cbranch_scc1 L_spinbk_5
s_cmp_lt_u32 vcc_lo, s81
s_cbranch_scc1 L_spinlp_6
s_branch L_spinbk_5
L_hretry:
s_sub_u32 s72, s72, 1
s_cbranch_scc1 L_hgo
buffer_load_dwordx4 v[88:91], v16, s[44:47], s77 offen sc1
s_waitcnt vmcnt(0)
s_branch L_hchk
L_spin_8:
s_mov_b32 vcc_hi, 0x80000
L_spinlp_10:
s_sleep 1
buffer_load_dword v19, off, s[52:55], s80 offset:0 sc1
s_waitcnt vmcnt(0)
v_readfirstlane_b32 vcc_lo, v19
s_sub_u32 vcc_hi, vcc_hi, 1
s_cbranch_scc1 L_spinbk_9
s_cmp_lt_u32 vcc_lo, s69
s_cbranch_scc1 L_spinlp_10
s_branch L_spinbk_9
L_spin_1012:
s_mov_b32 vcc_hi, 0x80000
L_spinlp_1014:
s_sleep 1
buffer_load_dword v19, off, s[52:55], s80 offset:0 sc1
s_waitcnt vmcnt(0)
v_readfirstlane_b32 vcc_lo, v19
s_sub_u32 vcc_hi, vcc_hi, 1
s_cbranch_scc1 L_spinbk_1013
s_cmp_lt_u32 vcc_lo, s69
s_cbranch_scc1 L_spinlp_1014
s_branch L_spinbk_1013
L_F1:
ds_read_b128 a[144:147], v2 offset:0
ds_read_b128 a[148:151], v2 offset:1024
ds_read_b128 a[152:155], v2 offset:2048
ds_read_b128 a[156:159], v2 offset:3072
ds_read_b128 a[160:163], v2 offset:4096
ds_read_b128 a[164:167], v2 offset:5120
ds_read_b128 a[168:171], v2 offset:6144
ds_read_b128 a[172:175], v2 offset:7168
s_mov_b32 m0, s71
s_nop 0
buffer_load_dwordx4 v16, s[32:35], s70 offen offset:0 sc1 lds
buffer_load_dwordx4 v16, s[32:35], s70 offen offset:1024 sc1 lds
s_waitcnt lgkmcnt(7)
v_mfma_f32_16x16x32_bf16 v[104:107], a[144:147], v[40:43], 0
s_waitcnt lgkmcnt(6)
ds_read_b128 a[176:179], v2 offset:8192
v_cndmask_b32 v88, 0, v17, s[0:1]
v_mfma_f32_16x16x32_bf16 v[104:107], a[148:151], v[44:47], v[104:107]
s_waitcnt lgkmcnt(6)
ds_read_b128 a[180:183], v2 offset:9216
v_cndmask_b32 v89, 0, v17, s[4:5]
v_mfma_f32_16x16x32_bf16 v[104:107], a[152:155], v[48:51], v[104:107]
s_waitcnt lgkmcnt(6)
buffer_load_dwordx4 v16, s[32:35], s70 offen offset:2048 sc1 lds
v_mfma_f32_16x16x32_bf16 v[104:107], a[156:159], v[52:55], v[104:107]
ds_read_b128 a[184:187], v2 offset:10240
v_cndmask_b32 v90, 0, v17, s[6:7]
v_mfma_f32_16x16x32_bf16 v[120:123], a[156:159], v[68:71], 0
ds_read_b128 a[188:191], v2 offset:11264
v_cndmask_b32 v91, 0, v17, s[8:9]
v_mfma_f32_16x16x32_bf16 v[120:123], a[152:155], v[64:67], v[120:123]
ds_read_b128 a[192:195], v2 offset:12288
ds_read_b128 a[196:199], v2 offset:13312
v_mfma_f32_16x16x32_bf16 v[120:123], a[148:151], v[60:63], v[120:123]
ds_read_b128 a[200:203], v2 offset:14336
v_mfma_f32_16x16x32_bf16 v[120:123], a[144:147], v[56:59], v[120:123]
ds_read_b128 a[204:207], v2 offset:15360
v_mfma_f32_16x16x32_bf16 v[136:139], a[144:147], v[72:75], 0
v_mfma_f32_16x16x32_bf16 v[136:139], a[148:151], v[76:79], v[136:139]
buffer_load_dwordx4 v16, s[32:35], s70 offen offset:3072 sc1 lds
v_mfma_f32_16x16x32_bf16 v[136:139], a[152:155], v[80:83], v[136:139]
v_mfma_f32_16x16x32_bf16 v[136:139], a[156:159], v[84:87], v[136:139]
v_mfma_f32_16x16x32_bf16 v[88:91], a[156:159], v[36:39], v[88:91]
v_mfma_f32_16x16x32_bf16 v[88:91], a[152:155], v[32:35], v[88:91]
v_mfma_f32_16x16x32_bf16 v[88:91], a[148:151], v[28:31], v[88:91]
v_mfma_f32_16x16x32_bf16 v[88:91], a[144:147], v[24:27], v[88:91]
s_waitcnt lgkmcnt(0)
s_nop 1
v_max3_f32 v21, v104, v105, v106
v_max_f32 v21, v21, v107
v_max3_f32 v22, v120, v121, v122
v_max_f32 v22, v22, v123
v_max3_f32 v23, v136, v137, v138
v_max_f32 v23, v23, v139
v_max3_f32 v20, v88, v89, v90
v_max_f32 v20, v20, v91
v_mov_b32 v248, v20
v_mov_b32 v249, v21
v_mov_b32 v250, v22
v_mov_b32 v251, v23
v_permlane16_swap_b32 v248, v20
v_permlane16_swap_b32 v249, v21
v_permlane16_swap_b32 v250, v22
v_permlane16_swap_b32 v251, v23
v_max_f32 v20, v20, v248
v_max_f32 v21, v21, v249
v_max_f32 v22, v22, v250
v_max_f32 v23, v23, v251
v_mov_b32 v248, v20
v_mov_b32 v249, v21
v_mov_b32 v250, v22
v_mov_b32 v251, v23
v_permlane32_swap_b32 v248, v20
v_permlane32_swap_b32 v249, v21
v_permlane32_swap_b32 v250, v22
v_permlane32_swap_b32 v251, v23
v_max_f32 v20, v20, v248
v_max_f32 v21, v21, v249
v_max_f32 v22, v22, v250
v_max_f32 v23, v23, v251
s_cmp_eq_u32 s73, 0
s_cselect_b64 vcc, 0, -1
v_cndmask_b32 v20, v20, v252, vcc
v_cndmask_b32 v21, v21, v253, vcc
v_cndmask_b32 v22, v22, v254, vcc
v_cndmask_b32 v23, v23, v255, vcc
v_sub_f32 v228, 0, v23
v_sub_f32 v229, 0, v23
v_sub_f32 v230, 0, v23
v_sub_f32 v231, 0, v23
v_sub_f32 v224, 0, v22
v_sub_f32 v225, 0, v22
v_sub_f32 v226, 0, v22
v_sub_f32 v227, 0, v22
v_sub_f32 v220, 0, v21
v_sub_f32 v221, 0, v21
v_sub_f32 v222, 0, v21
v_sub_f32 v223, 0, v21
v_sub_f32 v216, 0, v20
v_sub_f32 v217, 0, v20
v_sub_f32 v218, 0, v20
v_sub_f32 v219, 0, v20
v_mfma_f32_16x16x32_bf16 v[140:143], a[160:163], v[72:75], v[228:231]
s_add_u32 m0, s71, 4096
v_add_f32 v104, v104, v220
v_add_f32 v105, v105, v220
v_mfma_f32_16x16x32_bf16 v[140:143], a[164:167], v[76:79], v[140:143]
v_add_f32 v106, v106, v220
v_add_f32 v107, v107, v220
v_exp_f32 v104, v104
v_mfma_f32_16x16x32_bf16 v[140:143], a[168:171], v[80:83], v[140:143]
s_add_u32 s64, s70, 4096
v_exp_f32 v105, v105
v_mfma_f32_16x16x32_bf16 v[140:143], a[172:175], v[84:87], v[140:143]
buffer_load_dwordx4 v16, s[32:35], s64 offen offset:0 sc1 lds
v_mfma_f32_16x16x32_bf16 v[124:127], a[172:175], v[68:71], v[224:227]
v_exp_f32 v106, v106
v_mfma_f32_16x16x32_bf16 v[124:127], a[168:171], v[64:67], v[124:127]
v_exp_f32 v107, v107
v_mfma_f32_16x16x32_bf16 v[124:127], a[164:167], v[60:63], v[124:127]
v_add_f32 v120, v120, v224
v_add_f32 v121, v121, v224
v_add_f32 v122, v122, v224
v_add_f32 v123, v123, v224
v_exp_f32 v120, v120
v_mfma_f32_16x16x32_bf16 v[124:127], a[160:163], v[56:59], v[124:127]
v_exp_f32 v121, v121
v_mfma_f32_16x16x32_bf16 v[108:111], a[160:163], v[40:43], v[220:223]
v_exp_f32 v122, v122
v_mfma_f32_16x16x32_bf16 v[108:111], a[164:167], v[44:47], v[108:111]
v_cndmask_b32 v92, v216, v17, s[10:11]
v_cndmask_b32 v93, v216, v17, s[12:13]
v_cndmask_b32 v94, v216, v17, s[18:19]
v_cndmask_b32 v95, v216, v17, s[22:23]
v_mfma_f32_16x16x32_bf16 v[108:111], a[168:171], v[48:51], v[108:111]
buffer_load_dwordx4 v16, s[32:35], s64 offen offset:1024 sc1 lds
v_cvt_pk_bf16_f32 v160, v104, v105
v_mfma_f32_16x16x32_bf16 v[108:111], a[172:175], v[52:55], v[108:111]
v_exp_f32 v123, v123
v_mfma_f32_16x16x32_bf16 v[92:95], a[172:175], v[36:39], v[92:95]
v_add_f32 v136, v136, v228
v_add_f32 v137, v137, v228
v_add_f32 v138, v138, v228
v_add_f32 v139, v139, v228
v_exp_f32 v136, v136
v_mfma_f32_16x16x32_bf16 v[92:95], a[168:171], v[32:35], v[92:95]
v_cvt_pk_bf16_f32 v161, v106, v107
v_exp_f32 v137, v137
v_cndmask_b32 v96, v216, v17, s[26:27]
v_cndmask_b32 v97, v216, v17, s[56:57]
v_cndmask_b32 v98, v216, v17, s[58:59]
v_cndmask_b32 v99, v216, v17, s[60:61]
v_mfma_f32_16x16x32_bf16 v[92:95], a[164:167], v[28:31], v[92:95]
v_exp_f32 v138, v138
v_mfma_f32_16x16x32_bf16 v[92:95], a[160:163], v[24:27], v[92:95]
v_exp_f32 v139, v139
v_mfma_f32_16x16x32_bf16 v[96:99], a[176:179], v[24:27], v[96:99]
v_cvt_pk_bf16_f32 v184, v120, v121
v_add_f32 v88, v88, v216
v_mfma_f32_16x16x32_bf16 v[96:99], a[180:183], v[28:31], v[96:99]
buffer_load_dwordx4 v16, s[32:35], s64 offen offset:2048 sc1 lds
v_add_f32 v89, v89, v216
v_add_f32 v90, v90, v216
v_add_f32 v91, v91, v216
v_exp_f32 v88, v88
v_mfma_f32_16x16x32_bf16 v[96:99], a[184:187], v[32:35], v[96:99]
v_exp_f32 v89, v89
v_mfma_f32_16x16x32_bf16 v[96:99], a[188:191], v[36:39], v[96:99]
v_cvt_pk_bf16_f32 v185, v122, v123
v_cvt_pk_bf16_f32 v192, v136, v137
v_mfma_f32_16x16x32_bf16 v[112:115], a[188:191], v[52:55], v[220:223]
v_exp_f32 v90, v90
v_mfma_f32_16x16x32_bf16 v[112:115], a[184:187], v[48:51], v[112:115]
v_exp_f32 v91, v91
v_mfma_f32_16x16x32_bf16 v[112:115], a[180:183], v[44:47], v[112:115]
v_exp_f32 v140, v140
v_mfma_f32_16x16x32_bf16 v[112:115], a[176:179], v[40:43], v[112:115]
v_exp_f32 v141, v141
v_mfma_f32_16x16x32_bf16 v[128:131], a[176:179], v[56:59], v[224:227]
buffer_load_dwordx4 v16, s[32:35], s64 offen offset:3072 sc1 lds
v_cvt_pk_bf16_f32 v193, v138, v139
v_mfma_f32_16x16x32_bf16 v[128:131], a[180:183], v[60:63], v[128:131]
v_exp_f32 v142, v142
v_mfma_f32_16x16x32_bf16 v[128:131], a[184:187], v[64:67], v[128:131]
v_exp_f32 v143, v143
v_mfma_f32_16x16x32_bf16 v[128:131], a[188:191], v[68:71], v[128:131]
v_cvt_pk_bf16_f32 v152, v88, v89
v_cvt_pk_bf16_f32 v153, v90, v91
v_mfma_f32_16x16x32_bf16 v[144:147], a[188:191], v[84:87], v[228:231]
v_exp_f32 v124, v124
v_mfma_f32_16x16x32_bf16 v[144:147], a[184:187], v[80:83], v[144:147]
v_exp_f32 v125, v125
v_mfma_f32_16x16x32_bf16 v[144:147], a[180:183], v[76:79], v[144:147]
s_waitcnt vmcnt(8)
s_barrier
v_mfma_f32_16x16x32_bf16 v[144:147], a[176:179], v[72:75], v[144:147]
v_exp_f32 v126, v126
v_mfma_f32_16x16x32_bf16 v[148:151], a[192:195], v[72:75], v[228:231]
v_cvt_pk_bf16_f32 v194, v140, v141
v_cvt_pk_bf16_f32 v195, v142, v143
v_mfma_f32_16x16x32_bf16 v[148:151], a[196:199], v[76:79], v[148:151]
v_exp_f32 v127, v127
v_mfma_f32_16x16x32_bf16 v[148:151], a[200:203], v[80:83], v[148:151]
s_xor_b32 s71, s71, 16384
v_exp_f32 v108, v108
v_mfma_f32_16x16x32_bf16 v[148:151], a[204:207], v[84:87], v[148:151]
s_add_u32 s70, s70, 32768
v_exp_f32 v109, v109
v_mfma_f32_16x16x32_bf16 v[132:135], a[204:207], v[68:71], v[224:227]
s_mov_b32 m0, s71
v_exp_f32 v110, v110
v_mfma_f32_16x16x32_bf16 v[132:135], a[200:203], v[64:67], v[132:135]
buffer_load_dwordx4 v16, s[32:35], s70 offen offset:0 sc1 lds
v_mfma_f32_16x16x32_bf16 v[132:135], a[196:199], v[60:63], v[132:135]
v_cvt_pk_bf16_f32 v186, v124, v125
v_exp_f32 v111, v111
v_mfma_f32_16x16x32_bf16 v[132:135], a[192:195], v[56:59], v[132:135]
v_exp_f32 v92, v92
v_mfma_f32_16x16x32_bf16 v[116:119], a[192:195], v[40:43], v[220:223]
ds_read_b128 a[144:147], v2 offset:16384
v_cndmask_b32 v100, v216, v17, s[62:63]
v_mfma_f32_16x16x32_bf16 v[116:119], a[196:199], v[44:47], v[116:119]
ds_read_b128 a[148:151], v2 offset:17408
v_cndmask_b32 v101, v216, v17, s[48:49]
v_cndmask_b32 v102, v216, v17, s[50:51]
v_cndmask_b32 v103, v216, v17, s[100:101]
v_cvt_pk_bf16_f32 v187, v126, v127
v_exp_f32 v93, v93
v_mfma_f32_16x16x32_bf16 v[116:119], a[200:203], v[48:51], v[116:119]
v_exp_f32 v94, v94
v_mfma_f32_16x16x32_bf16 v[116:119], a[204:207], v[52:55], v[116:119]
ds_read_b128 a[152:155], v2 offset:18432
v_cvt_pk_bf16_f32 v162, v108, v109
v_mfma_f32_16x16x32_bf16 v[100:103], a[204:207], v[36:39], v[100:103]
buffer_load_dwordx4 v16, s[32:35], s70 offen offset:1024 sc1 lds
v_exp_f32 v95, v95
v_mfma_f32_16x16x32_bf16 v[100:103], a[200:203], v[32:35], v[100:103]
ds_read_b128 a[156:159], v2 offset:19456
v_exp_f32 v96, v96
v_mfma_f32_16x16x32_bf16 v[100:103], a[196:199], v[28:31], v[100:103]
v_cvt_pk_bf16_f32 v163, v110, v111
v_exp_f32 v97, v97
v_mfma_f32_16x16x32_bf16 v[100:103], a[192:195], v[24:27], v[100:103]
s_waitcnt lgkmcnt(2)
ds_read_b128 a[160:163], v2 offset:20480
ds_read_b128 a[164:167], v2 offset:21504
ds_read_b128 a[168:171], v2 offset:22528
ds_read_b128 a[172:175], v2 offset:23552
v_mfma_f32_16x16x32_bf16 v[120:123], a[144:147], v[56:59], v[224:227]
v_exp_f32 v98, v98
v_mfma_f32_16x16x32_bf16 v[120:123], a[148:151], v[60:63], v[120:123]
s_waitcnt lgkmcnt(5)
v_cvt_pk_bf16_f32 v154, v92, v93
v_exp_f32 v99, v99
v_mfma_f32_16x16x32_bf16 v[120:123], a[152:155], v[64:67], v[120:123]
s_waitcnt lgkmcnt(4)
v_exp_f32 v112, v112
v_mfma_f32_16x16x32_bf16 v[120:123], a[156:159], v[68:71], v[120:123]
v_exp_f32 v113, v113
v_mfma_f32_16x16x32_bf16 v[136:139], a[156:159], v[84:87], v[228:231]
v_cvt_pk_bf16_f32 v155, v94, v95
v_cndmask_b32 v104, v220, v17, s[0:1]
v_mfma_f32_16x16x32_bf16 v[136:139], a[152:155], v[80:83], v[136:139]
ds_read_b128 a[176:179], v2 offset:24576
buffer_load_dwordx4 v16, s[32:35], s70 offen offset:2048 sc1 lds
v_cndmask_b32 v105, v220, v17, s[4:5]
v_cndmask_b32 v106, v220, v17, s[6:7]
v_cndmask_b32 v107, v220, v17, s[8:9]
v_exp_f32 v114, v114
v_mfma_f32_16x16x32_bf16 v[136:139], a[148:151], v[76:79], v[136:139]
v_cvt_pk_bf16_f32 v156, v96, v97
v_cvt_pk_bf16_f32 v157, v98, v99
v_mfma_f32_16x16x32_bf16 v[136:139], a[144:147], v[72:75], v[136:139]
v_exp_f32 v115, v115
v_mfma_f32_16x16x32_bf16 v[104:107], a[144:147], v[40:43], v[104:107]
v_exp_f32 v128, v128
v_mfma_f32_16x16x32_bf16 v[104:107], a[148:151], v[44:47], v[104:107]
v_exp_f32 v129, v129
v_mfma_f32_16x16x32_bf16 v[104:107], a[152:155], v[48:51], v[104:107]
v_exp_f32 v130, v130
v_mfma_f32_16x16x32_bf16 v[104:107], a[156:159], v[52:55], v[104:107]
s_waitcnt lgkmcnt(0)
v_exp_f32 v131, v131
v_mfma_f32_16x16x32_bf16 v[140:143], a[172:175], v[84:87], v[228:231]
v_cvt_pk_bf16_f32 v164, v112, v113
v_cvt_pk_bf16_f32 v165, v114, v115
v_mfma_f32_16x16x32_bf16 v[140:143], a[168:171], v[80:83], v[140:143]
v_exp_f32 v144, v144
v_mfma_f32_16x16x32_bf16 v[140:143], a[164:167], v[76:79], v[140:143]
v_exp_f32 v145, v145
v_mfma_f32_16x16x32_bf16 v[140:143], a[160:163], v[72:75], v[140:143]
v_exp_f32 v146, v146
v_mfma_f32_16x16x32_bf16 v[124:127], a[160:163], v[56:59], v[224:227]
ds_read_b128 a[180:183], v2 offset:25600
v_cndmask_b32 v108, v220, v17, s[10:11]
v_mfma_f32_16x16x32_bf16 v[124:127], a[164:167], v[60:63], v[124:127]
ds_read_b128 a[184:187], v2 offset:26624
v_cndmask_b32 v109, v220, v17, s[12:13]
v_cndmask_b32 v110, v220, v17, s[18:19]
v_cndmask_b32 v111, v220, v17, s[22:23]
v_cvt_pk_bf16_f32 v188, v128, v129
v_mfma_f32_16x16x32_bf16 v[124:127], a[168:171], v[64:67], v[124:127]
buffer_load_dwordx4 v16, s[32:35], s70 offen offset:3072 sc1 lds
v_exp_f32 v147, v147
v_mfma_f32_16x16x32_bf16 v[124:127], a[172:175], v[68:71], v[124:127]
s_add_u32 m0, s86, 131072
ds_read_b128 a[188:191], v2 offset:27648
v_exp_f32 v148, v148
v_mfma_f32_16x16x32_bf16 v[108:111], a[172:175], v[52:55], v[108:111]
s_add_u32 s64, s85, 0
v_cvt_pk_bf16_f32 v189, v130, v131
v_exp_f32 v149, v149
v_mfma_f32_16x16x32_bf16 v[108:111], a[168:171], v[48:51], v[108:111]
ds_read_b128 a[192:195], v2 offset:28672
buffer_load_dwordx4 v12, s[36:39], s64 offen lds
v_cndmask_b32 v112, v220, v17, s[26:27]
v_cndmask_b32 v113, v220, v17, s[56:57]
v_cndmask_b32 v114, v220, v17, s[58:59]
v_cndmask_b32 v115, v220, v17, s[60:61]
v_mfma_f32_16x16x32_bf16 v[108:111], a[164:167], v[44:47], v[108:111]
s_add_u32 m0, s86, 132096
v_exp_f32 v150, v150
v_mfma_f32_16x16x32_bf16 v[108:111], a[160:163], v[40:43], v[108:111]
s_add_u32 s64, s85, 8192
v_cvt_pk_bf16_f32 v196, v144, v145
v_exp_f32 v151, v151
v_mfma_f32_16x16x32_bf16 v[112:115], a[176:179], v[40:43], v[112:115]
s_waitcnt lgkmcnt(2)
buffer_load_dwordx4 v13, s[36:39], s64 offen lds
v_exp_f32 v132, v132
v_mfma_f32_16x16x32_bf16 v[112:115], a[180:183], v[44:47], v[112:115]
s_add_u32 m0, s86, 133120
v_exp_f32 v133, v133
v_mfma_f32_16x16x32_bf16 v[112:115], a[184:187], v[48:51], v[112:115]
s_waitcnt lgkmcnt(1)
s_add_u32 s64, s85, 16384
v_cvt_pk_bf16_f32 v197, v146, v147
v_cvt_pk_bf16_f32 v198, v148, v149
v_mfma_f32_16x16x32_bf16 v[112:115], a[188:191], v[52:55], v[112:115]
buffer_load_dwordx4 v12, s[36:39], s64 offen lds
v_exp_f32 v134, v134
v_mfma_f32_16x16x32_bf16 v[128:131], a[188:191], v[68:71], v[224:227]
s_add_u32 m0, s86, 134144
ds_read_b128 a[196:199], v2 offset:29696
ds_read_b128 a[200:203], v2 offset:30720
ds_read_b128 a[204:207], v2 offset:31744
v_mfma_f32_16x16x32_bf16 v[128:131], a[184:187], v[64:67], v[128:131]
s_add_u32 s64, s85, 24576
v_exp_f32 v135, v135
v_mfma_f32_16x16x32_bf16 v[128:131], a[180:183], v[60:63], v[128:131]
buffer_load_dwordx4 v13, s[36:39], s64 offen lds
v_exp_f32 v116, v116
v_mfma_f32_16x16x32_bf16 v[128:131], a[176:179], v[56:59], v[128:131]
s_add_u32 m0, s71, 4096
v_cvt_pk_bf16_f32 v199, v150, v151
v_exp_f32 v117, v117
v_mfma_f32_16x16x32_bf16 v[144:147], a[176:179], v[72:75], v[228:231]
s_add_u32 s64, s70, 4096
v_exp_f32 v118, v118
v_mfma_f32_16x16x32_bf16 v[144:147], a[180:183], v[76:79], v[144:147]
buffer_load_dwordx4 v16, s[32:35], s64 offen offset:0 sc1 lds
v_mfma_f32_16x16x32_bf16 v[144:147], a[184:187], v[80:83], v[144:147]
v_cvt_pk_bf16_f32 v190, v132, v133
v_exp_f32 v119, v119
v_mfma_f32_16x16x32_bf16 v[144:147], a[188:191], v[84:87], v[144:147]
s_waitcnt lgkmcnt(0)
v_exp_f32 v100, v100
v_mfma_f32_16x16x32_bf16 v[148:151], a[204:207], v[84:87], v[228:231]
v_exp_f32 v101, v101
v_mfma_f32_16x16x32_bf16 v[148:151], a[200:203], v[80:83], v[148:151]
v_cvt_pk_bf16_f32 v191, v134, v135
v_cvt_pk_bf16_f32 v166, v116, v117
v_cvt_pk_bf16_f32 v167, v118, v119
v_mfma_f32_16x16x32_bf16 v[148:151], a[196:199], v[76:79], v[148:151]
v_exp_f32 v102, v102
v_mfma_f32_16x16x32_bf16 v[148:151], a[192:195], v[72:75], v[148:151]
v_exp_f32 v103, v103
v_mfma_f32_16x16x32_bf16 v[132:135], a[192:195], v[56:59], v[224:227]
s_lshl_b32 s66, s30, 30
ds_read_b128 a[144:147], v3 offset:16384
v_cndmask_b32 v116, v220, v17, s[62:63]
v_mfma_f32_16x16x32_bf16 v[132:135], a[196:199], v[60:63], v[132:135]
ds_read_b128 a[148:151], v3 offset:24576
v_cndmask_b32 v117, v220, v17, s[48:49]
v_cndmask_b32 v118, v220, v17, s[50:51]
v_cndmask_b32 v119, v220, v17, s[100:101]
v_exp_f32 v120, v120
v_mfma_f32_16x16x32_bf16 v[132:135], a[200:203], v[64:67], v[132:135]
v_exp_f32 v121, v121
v_mfma_f32_16x16x32_bf16 v[132:135], a[204:207], v[68:71], v[132:135]
v_exp_f32 v122, v122
v_mfma_f32_16x16x32_bf16 v[116:119], a[204:207], v[52:55], v[116:119]
v_exp_f32 v123, v123
v_mfma_f32_16x16x32_bf16 v[116:119], a[200:203], v[48:51], v[116:119]
v_cvt_pk_bf16_f32 v158, v100, v101
v_cvt_pk_bf16_f32 v159, v102, v103
v_mfma_f32_16x16x32_bf16 v[116:119], a[196:199], v[44:47], v[116:119]
buffer_load_dwordx4 v16, s[32:35], s64 offen offset:1024 sc1 lds
v_mfma_f32_16x16x32_bf16 v[116:119], a[192:195], v[40:43], v[116:119]
v_exp_f32 v136, v136
v_mfma_f32_16x16x32_bf16 a[128:131], a[244:247], v[152:155], 0
v_exp_f32 v137, v137
v_mfma_f32_16x16x32_bf16 a[128:131], a[244:247], v[156:159], a[128:131]
v_exp_f32 v138, v138
v_mfma_f32_16x16x32_bf16 a[132:135], a[244:247], v[160:163], 0
v_exp_f32 v139, v139
v_mfma_f32_16x16x32_bf16 a[132:135], a[244:247], v[164:167], a[132:135]
v_cvt_pk_bf16_f32 v200, v120, v121
v_cvt_pk_bf16_f32 v201, v122, v123
v_mfma_f32_16x16x32_bf16 a[136:139], a[244:247], v[184:187], 0
v_exp_f32 v104, v104
v_mfma_f32_16x16x32_bf16 a[136:139], a[244:247], v[188:191], a[136:139]
v_exp_f32 v105, v105
v_mfma_f32_16x16x32_bf16 a[140:143], a[244:247], v[192:195], 0
ds_read_b128 a[152:155], v3 offset:17408
v_cvt_pk_bf16_f32 v208, v136, v137
v_mfma_f32_16x16x32_bf16 a[140:143], a[244:247], v[196:199], a[140:143]
s_waitcnt lgkmcnt(1)
v_exp_f32 v106, v106
v_mfma_f32_16x16x32_bf16 a[0:3], a[144:147], v[152:155], 0
ds_read_b128 a[156:159], v3 offset:25600
v_cvt_pk_bf16_f32 v209, v138, v139
v_mfma_f32_16x16x32_bf16 a[0:3], a[148:151], v[156:159], a[0:3]
v_exp_f32 v107, v107
v_mfma_f32_16x16x32_bf16 a[32:35], a[148:151], v[164:167], 0
v_exp_f32 v140, v140
v_mfma_f32_16x16x32_bf16 a[32:35], a[144:147], v[160:163], a[32:35]
buffer_load_dwordx4 v16, s[32:35], s64 offen offset:2048 sc1 lds
v_mfma_f32_16x16x32_bf16 a[64:67], a[144:147], v[184:187], 0
v_exp_f32 v141, v141
v_mfma_f32_16x16x32_bf16 a[64:67], a[148:151], v[188:191], a[64:67]
v_exp_f32 v142, v142
v_mfma_f32_16x16x32_bf16 a[96:99], a[148:151], v[196:199], 0
ds_read_b128 a[160:163], v3 offset:18432
v_cvt_pk_bf16_f32 v176, v104, v105
v_mfma_f32_16x16x32_bf16 a[96:99], a[144:147], v[192:195], a[96:99]
s_waitcnt lgkmcnt(1)
ds_read_b128 a[164:167], v3 offset:26624
v_cvt_pk_bf16_f32 v177, v106, v107
v_mfma_f32_16x16x32_bf16 a[100:103], a[152:155], v[192:195], 0
v_exp_f32 v143, v143
v_mfma_f32_16x16x32_bf16 a[100:103], a[156:159], v[196:199], a[100:103]
v_exp_f32 v124, v124
v_mfma_f32_16x16x32_bf16 a[68:71], a[156:159], v[188:191], 0
v_exp_f32 v125, v125
v_mfma_f32_16x16x32_bf16 a[68:71], a[152:155], v[184:187], a[68:71]
v_exp_f32 v126, v126
v_mfma_f32_16x16x32_bf16 a[36:39], a[152:155], v[160:163], 0
v_exp_f32 v127, v127
v_mfma_f32_16x16x32_bf16 a[36:39], a[156:159], v[164:167], a[36:39]
ds_read_b128 a[168:171], v3 offset:19456
v_cvt_pk_bf16_f32 v210, v140, v141
v_mfma_f32_16x16x32_bf16 a[4:7], a[156:159], v[156:159], 0
ds_read_b128 a[172:175], v3 offset:27648
v_cvt_pk_bf16_f32 v211, v142, v143
v_mfma_f32_16x16x32_bf16 a[4:7], a[152:155], v[152:155], a[4:7]
s_waitcnt lgkmcnt(2)
v_exp_f32 v108, v108
v_mfma_f32_16x16x32_bf16 a[8:11], a[160:163], v[152:155], 0
v_exp_f32 v109, v109
v_mfma_f32_16x16x32_bf16 a[8:11], a[164:167], v[156:159], a[8:11]
buffer_load_dwordx4 v16, s[32:35], s64 offen offset:3072 sc1 lds
v_mfma_f32_16x16x32_bf16 a[40:43], a[164:167], v[164:167], 0
v_exp_f32 v110, v110
v_mfma_f32_16x16x32_bf16 a[40:43], a[160:163], v[160:163], a[40:43]
v_exp_f32 v111, v111
v_mfma_f32_16x16x32_bf16 a[72:75], a[160:163], v[184:187], 0
v_exp_f32 v112, v112
v_mfma_f32_16x16x32_bf16 a[72:75], a[164:167], v[188:191], a[72:75]
v_cvt_pk_bf16_f32 v202, v124, v125
v_cvt_pk_bf16_f32 v203, v126, v127
v_mfma_f32_16x16x32_bf16 a[104:107], a[164:167], v[196:199], 0
ds_read_b128 a[176:179], v3 offset:20480
v_cvt_pk_bf16_f32 v178, v108, v109
v_mfma_f32_16x16x32_bf16 a[104:107], a[160:163], v[192:195], a[104:107]
s_waitcnt lgkmcnt(1)
ds_read_b128 a[180:183], v3 offset:28672
v_xor_b32 v2, 0x8000, v2
v_mfma_f32_16x16x32_bf16 a[108:111], a[168:171], v[192:195], 0
s_add_u32 m0, s86, 135168
v_exp_f32 v113, v113
v_mfma_f32_16x16x32_bf16 a[108:111], a[172:175], v[196:199], a[108:111]
s_add_u32 s64, s85, 32768
v_exp_f32 v114, v114
v_mfma_f32_16x16x32_bf16 a[76:79], a[172:175], v[188:191], 0
buffer_load_dwordx4 v12, s[36:39], s64 offen lds
v_mfma_f32_16x16x32_bf16 a[76:79], a[168:171], v[184:187], a[76:79]
s_add_u32 m0, s86, 136192
v_exp_f32 v115, v115
v_mfma_f32_16x16x32_bf16 a[44:47], a[168:171], v[160:163], 0
s_add_u32 s64, s85, 40960
v_exp_f32 v128, v128
v_mfma_f32_16x16x32_bf16 a[44:47], a[172:175], v[164:167], a[44:47]
buffer_load_dwordx4 v13, s[36:39], s64 offen lds
v_mfma_f32_16x16x32_bf16 a[12:15], a[172:175], v[156:159], 0
ds_read_b128 a[184:187], v3 offset:21504
v_cvt_pk_bf16_f32 v179, v110, v111
v_mfma_f32_16x16x32_bf16 a[12:15], a[168:171], v[152:155], a[12:15]
s_waitcnt lgkmcnt(1)
s_add_u32 m0, s86, 137216
ds_read_b128 a[188:191], v3 offset:29696
ds_read_b128 a[192:195], v3 offset:22528
ds_read_b128 a[196:199], v3 offset:30720
ds_read_b128 a[200:203], v3 offset:23552
ds_read_b128 a[204:207], v3 offset:31744
v_mfma_f32_16x16x32_bf16 a[16:19], a[176:179], v[152:155], 0
s_waitcnt vmcnt(14)
s_barrier
s_add_u32 s64, s85, 49152
v_exp_f32 v129, v129
v_mfma_f32_16x16x32_bf16 a[16:19], a[180:183], v[156:159], a[16:19]
buffer_load_dwordx4 v12, s[36:39], s64 offen lds
v_mfma_f32_16x16x32_bf16 a[48:51], a[180:183], v[164:167], 0
s_add_u32 m0, s86, 138240
v_cvt_pk_bf16_f32 v180, v112, v113
v_exp_f32 v130, v130
v_mfma_f32_16x16x32_bf16 a[48:51], a[176:179], v[160:163], a[48:51]
s_add_u32 s64, s85, 57344
v_exp_f32 v131, v131
v_mfma_f32_16x16x32_bf16 a[80:83], a[176:179], v[184:187], 0
buffer_load_dwordx4 v13, s[36:39], s64 offen lds
v_mfma_f32_16x16x32_bf16 a[80:83], a[180:183], v[188:191], a[80:83]
v_cvt_pk_bf16_f32 v181, v114, v115
v_exp_f32 v144, v144
v_mfma_f32_16x16x32_bf16 a[112:115], a[180:183], v[196:199], 0
s_xor_b32 s71, s71, 49152
s_add_u32 s70, s70, 32768
s_mov_b32 m0, s71
v_exp_f32 v145, v145
v_mfma_f32_16x16x32_bf16 a[112:115], a[176:179], v[192:195], a[112:115]
s_waitcnt lgkmcnt(0)
buffer_load_dwordx4 v16, s[32:35], s70 offen offset:0 sc1 lds
v_mfma_f32_16x16x32_bf16 a[116:119], a[184:187], v[192:195], 0
v_cvt_pk_bf16_f32 v204, v128, v129
v_exp_f32 v146, v146
v_mfma_f32_16x16x32_bf16 a[116:119], a[188:191], v[196:199], a[116:119]
v_exp_f32 v147, v147
v_mfma_f32_16x16x32_bf16 a[84:87], a[188:191], v[188:191], 0
v_exp_f32 v148, v148
v_mfma_f32_16x16x32_bf16 a[84:87], a[184:187], v[184:187], a[84:87]
v_exp_f32 v149, v149
v_mfma_f32_16x16x32_bf16 a[52:55], a[184:187], v[160:163], 0
v_cvt_pk_bf16_f32 v205, v130, v131
v_cvt_pk_bf16_f32 v212, v144, v145
v_mfma_f32_16x16x32_bf16 a[52:55], a[188:191], v[164:167], a[52:55]
v_exp_f32 v150, v150
v_mfma_f32_16x16x32_bf16 a[20:23], a[188:191], v[156:159], 0
ds_read_b128 a[144:147], v2 offset:0
v_lshl_add_u32 v19, v0, 24, s66
v_mfma_f32_16x16x32_bf16 a[20:23], a[184:187], v[152:155], a[20:23]
s_lshr_b32 s67, s31, 4
v_exp_f32 v151, v151
v_mfma_f32_16x16x32_bf16 a[24:27], a[192:195], v[152:155], 0
s_lshl1_add_u32 s67, s3, s67
v_exp_f32 v132, v132
v_mfma_f32_16x16x32_bf16 a[24:27], a[196:199], v[156:159], a[24:27]
s_lshl_b32 s79, s67, 8
v_exp_f32 v133, v133
v_mfma_f32_16x16x32_bf16 a[56:59], a[196:199], v[164:167], 0
s_add_u32 s79, s79, 8192
v_cvt_pk_bf16_f32 v213, v146, v147
v_cvt_pk_bf16_f32 v214, v148, v149
v_mfma_f32_16x16x32_bf16 a[56:59], a[192:195], v[160:163], a[56:59]
s_add_u32 s69, s31, 12
v_exp_f32 v134, v134
v_mfma_f32_16x16x32_bf16 a[88:91], a[192:195], v[184:187], 0
s_lshr_b32 s69, s69, 5
buffer_load_dwordx4 v16, s[32:35], s70 offen offset:1024 sc1 lds
v_mfma_f32_16x16x32_bf16 a[88:91], a[196:199], v[188:191], a[88:91]
s_lshl1_add_u32 s69, s3, s69
v_exp_f32 v135, v135
v_mfma_f32_16x16x32_bf16 a[120:123], a[196:199], v[196:199], 0
s_lshl_b32 s69, s69, 8
v_exp_f32 v116, v116
v_mfma_f32_16x16x32_bf16 a[120:123], a[192:195], v[192:195], a[120:123]
s_add_u32 s69, s69, 8192
v_exp_f32 v117, v117
v_mfma_f32_16x16x32_bf16 a[124:127], a[200:203], v[192:195], 0
s_lshl_b32 s67, s73, 16
s_add_u32 s17, s78, L_T-L_pc+0
ds_read_b128 a[148:151], v2 offset:1024
v_cvt_pk_bf16_f32 v215, v150, v151
v_mfma_f32_16x16x32_bf16 a[124:127], a[204:207], v[196:199], a[124:127]
s_xor_b32 s68, s80, 256
buffer_load_dword a252, v16, s[88:91], s17 offen
v_mfma_f32_16x16x32_bf16 a[92:95], a[204:207], v[188:191], 0
s_add_u32 s68, s68, s67
v_exp_f32 v118, v118
v_mfma_f32_16x16x32_bf16 a[92:95], a[200:203], v[184:187], a[92:95]
s_add_u32 s67, s67, s69
ds_read_b128 a[152:155], v2 offset:2048
v_cvt_pk_bf16_f32 v206, v132, v133
v_mfma_f32_16x16x32_bf16 a[60:63], a[200:203], v[160:163], 0
ds_read_b128 a[156:159], v2 offset:3072
v_cvt_pk_bf16_f32 v207, v134, v135
v_mfma_f32_16x16x32_bf16 a[60:63], a[204:207], v[164:167], a[60:63]
s_mov_b64 exec, 1
buffer_atomic_add a251, v19, s[52:55], s67 offen offset:0 sc1
buffer_atomic_add a251, v19, s[52:55], s68 offen offset:0 sc1
s_mov_b64 exec, -1
v_mfma_f32_16x16x32_bf16 a[28:31], a[204:207], v[156:159], 0
s_add_u32 s17, s78, L_T-L_pc+4096
v_exp_f32 v119, v119
v_mfma_f32_16x16x32_bf16 a[28:31], a[200:203], v[152:155], a[28:31]
ds_read_b128 a[160:163], v2 offset:4096
buffer_load_dword a252, v16, s[88:91], s17 offen
ds_read_b128 a[164:167], v2 offset:5120
ds_read_b128 a[168:171], v2 offset:6144
ds_read_b128 a[172:175], v2 offset:7168
v_mul_u32_u24 v19, 52, v0
v_cvt_pk_bf16_f32 v182, v116, v117
v_cvt_pk_bf16_f32 v183, v118, v119
v_xor_b32 v3, 0x8000, v3
v_accvgpr_read_b32 v20, a128
v_max_f32 v1, v1, v20
v_rcp_f32 v20, v20
v_accvgpr_read_b32 v232, a0
v_accvgpr_read_b32 v233, a1
v_accvgpr_read_b32 v234, a2
v_accvgpr_read_b32 v235, a3
v_accvgpr_read_b32 v236, a4
v_accvgpr_read_b32 v237, a5
v_accvgpr_read_b32 v238, a6
v_accvgpr_read_b32 v239, a7
v_mul_f32 v20, v20, v4
v_mul_f32 v232, v232, v20
v_mul_f32 v233, v233, v20
v_mul_f32 v234, v234, v20
v_mul_f32 v235, v235, v20
v_mul_f32 v236, v236, v20
v_mul_f32 v237, v237, v20
v_mul_f32 v238, v238, v20
v_mul_f32 v239, v239, v20
v_cvt_pk_bf16_f32 v232, v232, v233
v_cvt_pk_bf16_f32 v233, v234, v235
v_cvt_pk_bf16_f32 v234, v236, v237
v_cvt_pk_bf16_f32 v235, v238, v239
s_add_u32 s77, s74, 0
buffer_store_dwordx4 v[232:235], v16, s[44:47], s77 offen sc1
v_accvgpr_read_b32 v240, a8
v_accvgpr_read_b32 v241, a9
v_accvgpr_read_b32 v242, a10
v_accvgpr_read_b32 v243, a11
v_accvgpr_read_b32 v244, a12
v_accvgpr_read_b32 v245, a13
v_accvgpr_read_b32 v246, a14
v_accvgpr_read_b32 v247, a15
v_mul_f32 v240, v240, v20
v_mul_f32 v241, v241, v20
v_mul_f32 v242, v242, v20
v_mul_f32 v243, v243, v20
v_mul_f32 v244, v244, v20
v_mul_f32 v245, v245, v20
v_mul_f32 v246, v246, v20
v_mul_f32 v247, v247, v20
v_cvt_pk_bf16_f32 v240, v240, v241
v_cvt_pk_bf16_f32 v241, v242, v243
v_cvt_pk_bf16_f32 v242, v244, v245
v_cvt_pk_bf16_f32 v243, v246, v247
s_add_u32 s77, s74, 8192
buffer_store_dwordx4 v[240:243], v16, s[44:47], s77 offen sc1
v_accvgpr_read_b32 v232, a16
v_accvgpr_read_b32 v233, a17
v_accvgpr_read_b32 v234, a18
v_accvgpr_read_b32 v235, a19
v_accvgpr_read_b32 v236, a20
v_accvgpr_read_b32 v237, a21
v_accvgpr_read_b32 v238, a22
v_accvgpr_read_b32 v239, a23
v_mul_f32 v232, v232, v20
v_mul_f32 v233, v233, v20
v_mul_f32 v234, v234, v20
v_mul_f32 v235, v235, v20
v_mul_f32 v236, v236, v20
v_mul_f32 v237, v237, v20
v_mul_f32 v238, v238, v20
v_mul_f32 v239, v239, v20
v_cvt_pk_bf16_f32 v232, v232, v233
v_cvt_pk_bf16_f32 v233, v234, v235
v_cvt_pk_bf16_f32 v234, v236, v237
v_cvt_pk_bf16_f32 v235, v238, v239
s_add_u32 s77, s74, 16384
buffer_store_dwordx4 v[232:235], v16, s[44:47], s77 offen sc1
s_branch L_T
L_T1:
buffer_load_dword v19, off, s[52:55], s80 sc1
s_add_u32 s17, s78, L_TAIL-L_pc
buffer_load_dword a252, v16, s[88:91], s17 offen
s_add_u32 s17, s78, L_TAIL-L_pc+4096
buffer_load_dword a252, v16, s[88:91], s17 offen
s_add_u32 s17, s78, L_p5f0-L_pc
buffer_load_dword a252, v16, s[88:91], s17 offen
s_add_u32 s17, s78, L_p5f0-L_pc+4096
buffer_load_dword a252, v16, s[88:91], s17 offen
s_waitcnt lgkmcnt(7)
v_mfma_f32_16x16x32_bf16 v[136:139], a[144:147], v[72:75], v[228:231]
s_waitcnt lgkmcnt(6)
ds_read_b128 a[176:179], v2 offset:8192
v_cndmask_b32 v120, v224, v17, s[0:1]
v_mfma_f32_16x16x32_bf16 v[136:139], a[148:151], v[76:79], v[136:139]
s_waitcnt lgkmcnt(6)
ds_read_b128 a[180:183], v2 offset:9216
v_cndmask_b32 v121, v224, v17, s[4:5]
v_cndmask_b32 v122, v224, v17, s[6:7]
v_cndmask_b32 v123, v224, v17, s[8:9]
v_mfma_f32_16x16x32_bf16 v[136:139], a[152:155], v[80:83], v[136:139]
s_waitcnt lgkmcnt(6)
buffer_load_dwordx4 v16, s[32:35], s70 offen offset:2048 sc1 lds
v_mfma_f32_16x16x32_bf16 v[136:139], a[156:159], v[84:87], v[136:139]
ds_read_b128 a[184:187], v2 offset:10240
v_cndmask_b32 v124, v224, v17, s[10:11]
v_mfma_f32_16x16x32_bf16 v[120:123], a[156:159], v[68:71], v[120:123]
ds_read_b128 a[188:191], v2 offset:11264
v_cndmask_b32 v125, v224, v17, s[12:13]
v_mfma_f32_16x16x32_bf16 v[120:123], a[152:155], v[64:67], v[120:123]
ds_read_b128 a[192:195], v2 offset:12288
v_cndmask_b32 v126, v224, v17, s[18:19]
v_mfma_f32_16x16x32_bf16 v[120:123], a[148:151], v[60:63], v[120:123]
ds_read_b128 a[196:199], v2 offset:13312
v_cndmask_b32 v127, v224, v17, s[22:23]
v_mfma_f32_16x16x32_bf16 v[120:123], a[144:147], v[56:59], v[120:123]
s_waitcnt lgkmcnt(4)
ds_read_b128 a[200:203], v2 offset:14336
v_cndmask_b32 v128, v224, v17, s[26:27]
v_mfma_f32_16x16x32_bf16 v[140:143], a[160:163], v[72:75], v[228:231]
ds_read_b128 a[204:207], v2 offset:15360
v_cndmask_b32 v129, v224, v17, s[56:57]
v_mfma_f32_16x16x32_bf16 v[140:143], a[164:167], v[76:79], v[140:143]
ds_read_b128 a[144:147], v3 offset:0
v_cndmask_b32 v130, v224, v17, s[58:59]
v_mfma_f32_16x16x32_bf16 v[140:143], a[168:171], v[80:83], v[140:143]
v_exp_f32 v136, v136
v_mfma_f32_16x16x32_bf16 v[140:143], a[172:175], v[84:87], v[140:143]
v_exp_f32 v137, v137
v_mfma_f32_16x16x32_bf16 v[124:127], a[172:175], v[68:71], v[124:127]
ds_read_b128 a[148:151], v3 offset:8192
v_cndmask_b32 v131, v224, v17, s[60:61]
v_mfma_f32_16x16x32_bf16 v[124:127], a[168:171], v[64:67], v[124:127]
buffer_load_dwordx4 v16, s[32:35], s70 offen offset:3072 sc1 lds
v_mfma_f32_16x16x32_bf16 v[124:127], a[164:167], v[60:63], v[124:127]
s_mul_i32 s69, s83, 8
v_exp_f32 v138, v138
v_mfma_f32_16x16x32_bf16 v[124:127], a[160:163], v[56:59], v[124:127]
s_sub_u32 s69, 36, s69
v_exp_f32 v139, v139
v_mfma_f32_16x16x32_bf16 v[128:131], a[176:179], v[56:59], v[128:131]
v_exp_f32 v120, v120
v_mfma_f32_16x16x32_bf16 v[128:131], a[180:183], v[60:63], v[128:131]
s_waitcnt lgkmcnt(1)
v_exp_f32 v121, v121
v_mfma_f32_16x16x32_bf16 v[128:131], a[184:187], v[64:67], v[128:131]
v_exp_f32 v122, v122
v_mfma_f32_16x16x32_bf16 v[128:131], a[188:191], v[68:71], v[128:131]
s_add_u32 m0, s71, 4096
ds_read_b128 a[152:155], v3 offset:1024
v_cndmask_b32 v132, v224, v17, s[62:63]
v_mfma_f32_16x16x32_bf16 v[144:147], a[188:191], v[84:87], v[228:231]
s_add_u32 s64, s70, 4096
v_cvt_pk_bf16_f32 v192, v136, v137
v_cndmask_b32 v133, v224, v17, s[48:49]
v_mfma_f32_16x16x32_bf16 v[144:147], a[184:187], v[80:83], v[144:147]
buffer_load_dwordx4 v16, s[32:35], s64 offen offset:0 sc1 lds
v_mfma_f32_16x16x32_bf16 v[144:147], a[180:183], v[76:79], v[144:147]
ds_read_b128 a[156:159], v3 offset:9216
v_cndmask_b32 v134, v224, v17, s[50:51]
v_mfma_f32_16x16x32_bf16 v[144:147], a[176:179], v[72:75], v[144:147]
ds_read_b128 a[160:163], v3 offset:2048
v_cndmask_b32 v135, v224, v17, s[100:101]
v_mfma_f32_16x16x32_bf16 v[148:151], a[192:195], v[72:75], v[228:231]
v_exp_f32 v123, v123
v_mfma_f32_16x16x32_bf16 v[148:151], a[196:199], v[76:79], v[148:151]
v_cvt_pk_bf16_f32 v193, v138, v139
v_cvt_pk_bf16_f32 v184, v120, v121
v_mfma_f32_16x16x32_bf16 v[148:151], a[200:203], v[80:83], v[148:151]
v_exp_f32 v140, v140
v_mfma_f32_16x16x32_bf16 v[148:151], a[204:207], v[84:87], v[148:151]
v_exp_f32 v141, v141
v_mfma_f32_16x16x32_bf16 v[132:135], a[204:207], v[68:71], v[132:135]
v_exp_f32 v142, v142
v_mfma_f32_16x16x32_bf16 v[132:135], a[200:203], v[64:67], v[132:135]
v_exp_f32 v143, v143
v_mfma_f32_16x16x32_bf16 v[132:135], a[196:199], v[60:63], v[132:135]
v_exp_f32 v124, v124
v_mfma_f32_16x16x32_bf16 v[132:135], a[192:195], v[56:59], v[132:135]
buffer_load_dwordx4 v16, s[32:35], s64 offen offset:1024 sc1 lds
v_mfma_f32_16x16x32_bf16 a[132:135], a[244:247], v[176:179], a[132:135]
v_exp_f32 v125, v125
v_mfma_f32_16x16x32_bf16 a[132:135], a[244:247], v[180:183], a[132:135]
ds_read_b128 a[164:167], v3 offset:10240
v_accvgpr_read_b32 v240, a24
v_mfma_f32_16x16x32_bf16 a[136:139], a[244:247], v[200:203], a[136:139]
ds_read_b128 a[168:171], v3 offset:3072
v_accvgpr_read_b32 v241, a25
v_mfma_f32_16x16x32_bf16 a[136:139], a[244:247], v[204:207], a[136:139]
v_cvt_pk_bf16_f32 v185, v122, v123
v_cvt_pk_bf16_f32 v194, v140, v141
v_mfma_f32_16x16x32_bf16 a[140:143], a[244:247], v[208:211], a[140:143]
ds_read_b128 a[172:175], v3 offset:11264
v_accvgpr_read_b32 v242, a26
v_mfma_f32_16x16x32_bf16 a[140:143], a[244:247], v[212:215], a[140:143]
ds_read_b128 a[176:179], v3 offset:4096
v_accvgpr_read_b32 v243, a27
v_mfma_f32_16x16x32_bf16 a[32:35], a[144:147], v[176:179], a[32:35]
s_waitcnt lgkmcnt(4)
ds_read_b128 a[180:183], v3 offset:12288
v_accvgpr_read_b32 v244, a28
v_mfma_f32_16x16x32_bf16 a[32:35], a[148:151], v[180:183], a[32:35]
ds_read_b128 a[184:187], v3 offset:5120
v_accvgpr_read_b32 v245, a29
v_mfma_f32_16x16x32_bf16 a[64:67], a[148:151], v[204:207], a[64:67]
ds_read_b128 a[188:191], v3 offset:13312
v_accvgpr_read_b32 v246, a30
v_mfma_f32_16x16x32_bf16 a[64:67], a[144:147], v[200:203], a[64:67]
ds_read_b128 a[192:195], v3 offset:6144
v_accvgpr_read_b32 v247, a31
v_mfma_f32_16x16x32_bf16 a[96:99], a[144:147], v[208:211], a[96:99]
ds_read_b128 a[196:199], v3 offset:14336
v_mul_f32 v240, v240, v20
v_mul_f32 v241, v241, v20
v_mul_f32 v242, v242, v20
v_mul_f32 v243, v243, v20
v_mul_f32 v244, v244, v20
v_mul_f32 v245, v245, v20
v_mul_f32 v246, v246, v20
v_mul_f32 v247, v247, v20
v_cvt_pk_bf16_f32 v240, v240, v241
v_cvt_pk_bf16_f32 v241, v242, v243
v_cvt_pk_bf16_f32 v242, v244, v245
v_cvt_pk_bf16_f32 v243, v246, v247
s_add_u32 s77, s74, 24576
buffer_store_dwordx4 v[240:243], v16, s[44:47], s77 offen sc1
v_mfma_f32_16x16x32_bf16 a[96:99], a[148:151], v[212:215], a[96:99]
v_exp_f32 v126, v126
v_mfma_f32_16x16x32_bf16 a[100:103], a[156:159], v[212:215], a[100:103]
buffer_load_dwordx4 v16, s[32:35], s64 offen offset:2048 sc1 lds
v_cvt_pk_bf16_f32 v195, v142, v143
v_mfma_f32_16x16x32_bf16 a[100:103], a[152:155], v[208:211], a[100:103]
v_exp_f32 v127, v127
v_mfma_f32_16x16x32_bf16 a[68:71], a[152:155], v[200:203], a[68:71]
v_exp_f32 v128, v128
v_mfma_f32_16x16x32_bf16 a[68:71], a[156:159], v[204:207], a[68:71]
v_exp_f32 v129, v129
v_mfma_f32_16x16x32_bf16 a[36:39], a[156:159], v[180:183], a[36:39]
v_exp_f32 v130, v130
v_mfma_f32_16x16x32_bf16 a[36:39], a[152:155], v[176:179], a[36:39]
v_cvt_pk_bf16_f32 v186, v124, v125
v_cvt_pk_bf16_f32 v187, v126, v127
v_mfma_f32_16x16x32_bf16 a[40:43], a[160:163], v[176:179], a[40:43]
s_waitcnt lgkmcnt(0)
v_exp_f32 v131, v131
v_mfma_f32_16x16x32_bf16 a[40:43], a[164:167], v[180:183], a[40:43]
buffer_load_dwordx4 v16, s[32:35], s64 offen offset:3072 sc1 lds
v_mfma_f32_16x16x32_bf16 a[72:75], a[164:167], v[204:207], a[72:75]
v_exp_f32 v144, v144
v_mfma_f32_16x16x32_bf16 a[72:75], a[160:163], v[200:203], a[72:75]
v_exp_f32 v145, v145
v_mfma_f32_16x16x32_bf16 a[104:107], a[160:163], v[208:211], a[104:107]
v_exp_f32 v146, v146
v_mfma_f32_16x16x32_bf16 a[104:107], a[164:167], v[212:215], a[104:107]
ds_read_b128 a[200:203], v3 offset:7168
v_cvt_pk_bf16_f32 v188, v128, v129
v_mfma_f32_16x16x32_bf16 a[108:111], a[172:175], v[212:215], a[108:111]
ds_read_b128 a[204:207], v3 offset:15360
v_cvt_pk_bf16_f32 v189, v130, v131
v_mfma_f32_16x16x32_bf16 a[108:111], a[168:171], v[208:211], a[108:111]
v_exp_f32 v147, v147
v_mfma_f32_16x16x32_bf16 a[76:79], a[168:171], v[200:203], a[76:79]
v_exp_f32 v148, v148
v_mfma_f32_16x16x32_bf16 a[76:79], a[172:175], v[204:207], a[76:79]
v_exp_f32 v149, v149
v_mfma_f32_16x16x32_bf16 a[44:47], a[172:175], v[180:183], a[44:47]
v_exp_f32 v150, v150
v_mfma_f32_16x16x32_bf16 a[44:47], a[168:171], v[176:179], a[44:47]
v_exp_f32 v151, v151
v_mfma_f32_16x16x32_bf16 a[48:51], a[176:179], v[176:179], a[48:51]
v_exp_f32 v132, v132
v_mfma_f32_16x16x32_bf16 a[48:51], a[180:183], v[180:183], a[48:51]
s_waitcnt vmcnt(14)
s_barrier
v_mfma_f32_16x16x32_bf16 a[80:83], a[180:183], v[204:207], a[80:83]
v_exp_f32 v133, v133
v_mfma_f32_16x16x32_bf16 a[80:83], a[176:179], v[200:203], a[80:83]
ds_read_b128 a[144:147], v2 offset:16384
v_cvt_pk_bf16_f32 v196, v144, v145
v_mfma_f32_16x16x32_bf16 a[112:115], a[176:179], v[208:211], a[112:115]
v_exp_f32 v134, v134
v_mfma_f32_16x16x32_bf16 a[112:115], a[180:183], v[212:215], a[112:115]
ds_read_b128 a[148:151], v2 offset:17408
v_cvt_pk_bf16_f32 v197, v146, v147
v_mfma_f32_16x16x32_bf16 a[116:119], a[188:191], v[212:215], a[116:119]
ds_read_b128 a[152:155], v2 offset:18432
v_cvt_pk_bf16_f32 v198, v148, v149
v_mfma_f32_16x16x32_bf16 a[116:119], a[184:187], v[208:211], a[116:119]
ds_read_b128 a[156:159], v2 offset:19456
v_cvt_pk_bf16_f32 v199, v150, v151
v_mfma_f32_16x16x32_bf16 a[84:87], a[184:187], v[200:203], a[84:87]
s_waitcnt vmcnt(11)
v_readfirstlane_b32 vcc_lo, v19
s_nop 0
s_cmp_lt_u32 vcc_lo, s69
s_cbranch_scc1 L_spin_1012
L_spinbk_1013:
v_mfma_f32_16x16x32_bf16 a[84:87], a[188:191], v[204:207], a[84:87]
ds_read_b128 a[160:163], v2 offset:20480
v_cndmask_b32 v136, v228, v17, s[0:1]
v_mfma_f32_16x16x32_bf16 a[52:55], a[188:191], v[180:183], a[52:55]
ds_read_b128 a[164:167], v2 offset:21504
v_cndmask_b32 v137, v228, v17, s[4:5]
v_mfma_f32_16x16x32_bf16 a[52:55], a[184:187], v[176:179], a[52:55]
ds_read_b128 a[168:171], v2 offset:22528
v_cndmask_b32 v138, v228, v17, s[6:7]
v_mfma_f32_16x16x32_bf16 a[56:59], a[192:195], v[176:179], a[56:59]
ds_read_b128 a[172:175], v2 offset:23552
v_cndmask_b32 v139, v228, v17, s[8:9]
v_mfma_f32_16x16x32_bf16 a[56:59], a[196:199], v[180:183], a[56:59]
v_exp_f32 v135, v135
v_mfma_f32_16x16x32_bf16 a[88:91], a[196:199], v[204:207], a[88:91]
v_cndmask_b32 v140, v228, v17, s[10:11]
v_cvt_pk_bf16_f32 v190, v132, v133
v_mfma_f32_16x16x32_bf16 a[88:91], a[192:195], v[200:203], a[88:91]
v_cndmask_b32 v141, v228, v17, s[12:13]
v_cvt_pk_bf16_f32 v191, v134, v135
v_mfma_f32_16x16x32_bf16 a[120:123], a[192:195], v[208:211], a[120:123]
v_cndmask_b32 v142, v228, v17, s[18:19]
v_cndmask_b32 v143, v228, v17, s[22:23]
v_mfma_f32_16x16x32_bf16 a[120:123], a[196:199], v[212:215], a[120:123]
s_waitcnt lgkmcnt(1)
v_cndmask_b32 v144, v228, v17, s[26:27]
v_cndmask_b32 v145, v228, v17, s[56:57]
v_mfma_f32_16x16x32_bf16 a[124:127], a[204:207], v[212:215], a[124:127]
v_cndmask_b32 v146, v228, v17, s[58:59]
v_cndmask_b32 v147, v228, v17, s[60:61]
v_mfma_f32_16x16x32_bf16 a[124:127], a[200:203], v[208:211], a[124:127]
v_cndmask_b32 v148, v228, v17, s[62:63]
v_cndmask_b32 v149, v228, v17, s[48:49]
v_mfma_f32_16x16x32_bf16 a[92:95], a[200:203], v[200:203], a[92:95]
v_cndmask_b32 v150, v228, v17, s[50:51]
v_cndmask_b32 v151, v228, v17, s[100:101]
v_mfma_f32_16x16x32_bf16 a[92:95], a[204:207], v[204:207], a[92:95]
v_accvgpr_read_b32 v21, a132
v_max_f32 v1, v1, v21
v_mfma_f32_16x16x32_bf16 a[60:63], a[204:207], v[180:183], a[60:63]
v_rcp_f32 v21, v21
v_mfma_f32_16x16x32_bf16 a[60:63], a[200:203], v[176:179], a[60:63]
v_accvgpr_read_b32 v232, a32
v_accvgpr_read_b32 v233, a33
v_mfma_f32_16x16x32_bf16 v[136:139], a[144:147], v[72:75], v[136:139]
ds_read_b128 a[176:179], v2 offset:24576
v_accvgpr_read_b32 v234, a34
v_mfma_f32_16x16x32_bf16 v[136:139], a[148:151], v[76:79], v[136:139]
ds_read_b128 a[180:183], v2 offset:25600
v_accvgpr_read_b32 v235, a35
v_mfma_f32_16x16x32_bf16 v[136:139], a[152:155], v[80:83], v[136:139]
ds_read_b128 a[184:187], v2 offset:26624
v_accvgpr_read_b32 v236, a36
v_mfma_f32_16x16x32_bf16 v[136:139], a[156:159], v[84:87], v[136:139]
s_waitcnt lgkmcnt(3)
ds_read_b128 a[188:191], v2 offset:27648
v_accvgpr_read_b32 v237, a37
v_mfma_f32_16x16x32_bf16 v[140:143], a[172:175], v[84:87], v[140:143]
ds_read_b128 a[192:195], v2 offset:28672
ds_read_b128 a[196:199], v2 offset:29696
ds_read_b128 a[200:203], v2 offset:30720
ds_read_b128 a[204:207], v2 offset:31744
v_mfma_f32_16x16x32_bf16 v[140:143], a[168:171], v[80:83], v[140:143]
ds_read_b128 a[144:147], v3 offset:16384
v_accvgpr_read_b32 v238, a38
v_mfma_f32_16x16x32_bf16 v[140:143], a[164:167], v[76:79], v[140:143]
ds_read_b128 a[148:151], v3 offset:24576
v_accvgpr_read_b32 v239, a39
v_mfma_f32_16x16x32_bf16 v[140:143], a[160:163], v[72:75], v[140:143]
s_waitcnt lgkmcnt(8)
ds_read_b128 a[152:155], v3 offset:17408
v_mul_f32 v21, v21, v6
v_mfma_f32_16x16x32_bf16 v[144:147], a[176:179], v[72:75], v[144:147]
ds_read_b128 a[156:159], v3 offset:25600
v_mul_f32 v232, v232, v21
v_mfma_f32_16x16x32_bf16 v[144:147], a[180:183], v[76:79], v[144:147]
s_waitcnt lgkmcnt(8)
ds_read_b128 a[160:163], v3 offset:18432
v_mul_f32 v233, v233, v21
v_mfma_f32_16x16x32_bf16 v[144:147], a[184:187], v[80:83], v[144:147]
ds_read_b128 a[164:167], v3 offset:26624
v_mul_f32 v234, v234, v21
v_mul_f32 v235, v235, v21
v_mul_f32 v236, v236, v21
v_mul_f32 v237, v237, v21
v_mul_f32 v238, v238, v21
v_mul_f32 v239, v239, v21
v_cvt_pk_bf16_f32 v232, v232, v233
v_cvt_pk_bf16_f32 v233, v234, v235
v_cvt_pk_bf16_f32 v234, v236, v237
v_cvt_pk_bf16_f32 v235, v238, v239
s_add_u32 s77, s74, 4096
buffer_store_dwordx4 v[232:235], v16, s[44:47], s77 offen sc1
v_accvgpr_read_b32 v240, a40
v_accvgpr_read_b32 v241, a41
v_accvgpr_read_b32 v242, a42
v_accvgpr_read_b32 v243, a43
v_accvgpr_read_b32 v244, a44
v_accvgpr_read_b32 v245, a45
v_accvgpr_read_b32 v246, a46
v_accvgpr_read_b32 v247, a47
v_mul_f32 v240, v240, v21
v_mul_f32 v241, v241, v21
v_mul_f32 v242, v242, v21
v_mul_f32 v243, v243, v21
v_mul_f32 v244, v244, v21
v_mul_f32 v245, v245, v21
v_mul_f32 v246, v246, v21
v_mul_f32 v247, v247, v21
v_cvt_pk_bf16_f32 v240, v240, v241
v_cvt_pk_bf16_f32 v241, v242, v243
v_cvt_pk_bf16_f32 v242, v244, v245
v_cvt_pk_bf16_f32 v243, v246, v247
s_add_u32 s77, s74, 12288
buffer_store_dwordx4 v[240:243], v16, s[44:47], s77 offen sc1
v_accvgpr_read_b32 v232, a48
v_accvgpr_read_b32 v233, a49
v_accvgpr_read_b32 v234, a50
v_accvgpr_read_b32 v235, a51
v_accvgpr_read_b32 v236, a52
v_accvgpr_read_b32 v237, a53
v_accvgpr_read_b32 v238, a54
v_accvgpr_read_b32 v239, a55
v_mul_f32 v232, v232, v21
v_mul_f32 v233, v233, v21
v_mul_f32 v234, v234, v21
v_mul_f32 v235, v235, v21
v_mul_f32 v236, v236, v21
v_mul_f32 v237, v237, v21
v_mul_f32 v238, v238, v21
v_mul_f32 v239, v239, v21
v_cvt_pk_bf16_f32 v232, v232, v233
v_cvt_pk_bf16_f32 v233, v234, v235
v_cvt_pk_bf16_f32 v234, v236, v237
v_cvt_pk_bf16_f32 v235, v238, v239
s_add_u32 s77, s74, 20480
buffer_store_dwordx4 v[232:235], v16, s[44:47], s77 offen sc1
v_accvgpr_read_b32 v240, a56
v_accvgpr_read_b32 v241, a57
v_accvgpr_read_b32 v242, a58
v_accvgpr_read_b32 v243, a59
v_accvgpr_read_b32 v244, a60
v_accvgpr_read_b32 v245, a61
v_accvgpr_read_b32 v246, a62
v_accvgpr_read_b32 v247, a63
v_mul_f32 v240, v240, v21
v_mul_f32 v241, v241, v21
v_mul_f32 v242, v242, v21
v_mul_f32 v243, v243, v21
v_mul_f32 v244, v244, v21
v_mul_f32 v245, v245, v21
v_mul_f32 v246, v246, v21
v_mul_f32 v247, v247, v21
v_cvt_pk_bf16_f32 v240, v240, v241
v_cvt_pk_bf16_f32 v241, v242, v243
v_cvt_pk_bf16_f32 v242, v244, v245
v_cvt_pk_bf16_f32 v243, v246, v247
s_add_u32 s77, s74, 28672
buffer_store_dwordx4 v[240:243], v16, s[44:47], s77 offen sc1
v_exp_f32 v136, v136
v_mfma_f32_16x16x32_bf16 v[144:147], a[188:191], v[84:87], v[144:147]
s_waitcnt lgkmcnt(5)
v_exp_f32 v137, v137
v_mfma_f32_16x16x32_bf16 v[148:151], a[204:207], v[84:87], v[148:151]
v_exp_f32 v138, v138
v_mfma_f32_16x16x32_bf16 v[148:151], a[200:203], v[80:83], v[148:151]
s_add_u32 s65, s84, 0
v_exp_f32 v139, v139
v_mfma_f32_16x16x32_bf16 v[148:151], a[196:199], v[76:79], v[148:151]
buffer_load_dwordx4 a[208:211], v14, s[44:47], s65 offen offset:0 sc1
v_mfma_f32_16x16x32_bf16 v[148:151], a[192:195], v[72:75], v[148:151]
v_exp_f32 v140, v140
v_mfma_f32_16x16x32_bf16 a[136:139], a[244:247], v[184:187], a[136:139]
buffer_load_dwordx4 a[216:219], v14, s[44:47], s65 offen offset:1024 sc1
v_mfma_f32_16x16x32_bf16 a[136:139], a[244:247], v[188:191], a[136:139]
v_exp_f32 v141, v141
v_mfma_f32_16x16x32_bf16 a[140:143], a[244:247], v[192:195], a[140:143]
ds_read_b128 a[168:171], v3 offset:19456
v_cvt_pk_bf16_f32 v208, v136, v137
v_mfma_f32_16x16x32_bf16 a[140:143], a[244:247], v[196:199], a[140:143]
buffer_load_dwordx4 a[224:227], v15, s[44:47], s65 offen offset:0 sc1
v_mfma_f32_16x16x32_bf16 a[64:67], a[144:147], v[184:187], a[64:67]
s_waitcnt lgkmcnt(1)
ds_read_b128 a[172:175], v3 offset:27648
v_cvt_pk_bf16_f32 v209, v138, v139
v_mfma_f32_16x16x32_bf16 a[64:67], a[148:151], v[188:191], a[64:67]
v_exp_f32 v142, v142
v_mfma_f32_16x16x32_bf16 a[96:99], a[148:151], v[196:199], a[96:99]
buffer_load_dwordx4 a[232:235], v15, s[44:47], s65 offen offset:1024 sc1
v_mfma_f32_16x16x32_bf16 a[96:99], a[144:147], v[192:195], a[96:99]
s_add_u32 s65, s84, 8192
ds_read_b128 a[176:179], v3 offset:20480
v_cvt_pk_bf16_f32 v210, v140, v141
v_mfma_f32_16x16x32_bf16 a[100:103], a[152:155], v[192:195], a[100:103]
buffer_load_dwordx4 a[212:215], v14, s[44:47], s65 offen offset:0 sc1
v_mfma_f32_16x16x32_bf16 a[100:103], a[156:159], v[196:199], a[100:103]
v_exp_f32 v143, v143
v_mfma_f32_16x16x32_bf16 a[68:71], a[156:159], v[188:191], a[68:71]
ds_read_b128 a[180:183], v3 offset:28672
v_xor_b32 v2, 0x8000, v2
v_mfma_f32_16x16x32_bf16 a[68:71], a[152:155], v[184:187], a[68:71]
buffer_load_dwordx4 a[220:223], v14, s[44:47], s65 offen offset:1024 sc1
v_mfma_f32_16x16x32_bf16 a[72:75], a[160:163], v[184:187], a[72:75]
v_exp_f32 v144, v144
v_mfma_f32_16x16x32_bf16 a[72:75], a[164:167], v[188:191], a[72:75]
ds_read_b128 a[184:187], v3 offset:21504
v_cvt_pk_bf16_f32 v211, v142, v143
v_mfma_f32_16x16x32_bf16 a[104:107], a[164:167], v[196:199], a[104:107]
buffer_load_dwordx4 a[228:231], v15, s[44:47], s65 offen offset:0 sc1
v_mfma_f32_16x16x32_bf16 a[104:107], a[160:163], v[192:195], a[104:107]
s_waitcnt lgkmcnt(2)
ds_read_b128 a[188:191], v3 offset:29696
v_accvgpr_read_b32 v22, a136
v_mfma_f32_16x16x32_bf16 a[108:111], a[168:171], v[192:195], a[108:111]
v_exp_f32 v145, v145
v_mfma_f32_16x16x32_bf16 a[108:111], a[172:175], v[196:199], a[108:111]
buffer_load_dwordx4 a[236:239], v15, s[44:47], s65 offen offset:1024 sc1
v_mfma_f32_16x16x32_bf16 a[76:79], a[172:175], v[188:191], a[76:79]
v_exp_f32 v146, v146
v_mfma_f32_16x16x32_bf16 a[76:79], a[168:171], v[184:187], a[76:79]
s_add_u32 s65, s84, 32768
ds_read_b128 a[192:195], v3 offset:22528
v_cvt_pk_bf16_f32 v212, v144, v145
v_mfma_f32_16x16x32_bf16 a[80:83], a[176:179], v[184:187], a[80:83]
s_waitcnt lgkmcnt(2)
buffer_load_dwordx4 v[152:155], v14, s[44:47], s65 offen offset:0 sc1
v_mfma_f32_16x16x32_bf16 a[80:83], a[180:183], v[188:191], a[80:83]
ds_read_b128 a[196:199], v3 offset:30720
ds_read_b128 a[200:203], v3 offset:23552
ds_read_b128 a[204:207], v3 offset:31744
v_mfma_f32_16x16x32_bf16 a[112:115], a[180:183], v[196:199], a[112:115]
s_waitcnt vmcnt(13)
s_barrier
v_xor_b32 v3, 0x8000, v3
v_mfma_f32_16x16x32_bf16 a[112:115], a[176:179], v[192:195], a[112:115]
buffer_load_dwordx4 v[160:163], v14, s[44:47], s65 offen offset:1024 sc1
v_exp_f32 v147, v147
v_mfma_f32_16x16x32_bf16 a[116:119], a[184:187], v[192:195], a[116:119]
s_waitcnt lgkmcnt(4)
v_exp_f32 v148, v148
v_mfma_f32_16x16x32_bf16 a[116:119], a[188:191], v[196:199], a[116:119]
buffer_load_dwordx4 v[168:171], v15, s[44:47], s65 offen offset:0 sc1
v_mfma_f32_16x16x32_bf16 a[84:87], a[188:191], v[188:191], a[84:87]
v_exp_f32 v149, v149
v_mfma_f32_16x16x32_bf16 a[84:87], a[184:187], v[184:187], a[84:87]
s_waitcnt lgkmcnt(0)
buffer_load_dwordx4 v[176:179], v15, s[44:47], s65 offen offset:1024 sc1
v_mfma_f32_16x16x32_bf16 a[88:91], a[192:195], v[184:187], a[88:91]
s_add_u32 s65, s84, 40960
ds_read_b128 a[144:147], v3 offset:0
v_cvt_pk_bf16_f32 v213, v146, v147
v_mfma_f32_16x16x32_bf16 a[88:91], a[196:199], v[188:191], a[88:91]
buffer_load_dwordx4 v[156:159], v14, s[44:47], s65 offen offset:0 sc1
v_mfma_f32_16x16x32_bf16 a[120:123], a[196:199], v[196:199], a[120:123]
v_exp_f32 v150, v150
v_mfma_f32_16x16x32_bf16 a[120:123], a[192:195], v[192:195], a[120:123]
buffer_load_dwordx4 v[164:167], v14, s[44:47], s65 offen offset:1024 sc1
ds_read_b128 a[148:151], v3 offset:8192
v_mfma_f32_16x16x32_bf16 a[124:127], a[200:203], v[192:195], a[124:127]
ds_read_b128 a[152:155], v3 offset:1024
v_cvt_pk_bf16_f32 v214, v148, v149
v_mfma_f32_16x16x32_bf16 a[124:127], a[204:207], v[196:199], a[124:127]
buffer_load_dwordx4 v[172:175], v15, s[44:47], s65 offen offset:0 sc1
ds_read_b128 a[156:159], v3 offset:9216
v_mfma_f32_16x16x32_bf16 a[92:95], a[204:207], v[188:191], a[92:95]
v_exp_f32 v151, v151
v_mfma_f32_16x16x32_bf16 a[92:95], a[200:203], v[184:187], a[92:95]
buffer_load_dwordx4 v[180:183], v15, s[44:47], s65 offen offset:1024 sc1
ds_read_b128 a[160:163], v3 offset:2048
ds_read_b128 a[164:167], v3 offset:10240
ds_read_b128 a[168:171], v3 offset:3072
ds_read_b128 a[172:175], v3 offset:11264
v_cvt_pk_bf16_f32 v215, v150, v151
v_max_f32 v1, v1, v22
v_rcp_f32 v22, v22
v_accvgpr_read_b32 v232, a64
v_accvgpr_read_b32 v233, a65
v_accvgpr_read_b32 v234, a66
v_accvgpr_read_b32 v235, a67
v_accvgpr_read_b32 v236, a68
v_accvgpr_read_b32 v237, a69
v_accvgpr_read_b32 v238, a70
v_accvgpr_read_b32 v239, a71
v_mul_f32 v22, v22, v8
v_mul_f32 v232, v232, v22
v_mul_f32 v233, v233, v22
v_mul_f32 v234, v234, v22
v_mul_f32 v235, v235, v22
v_mul_f32 v236, v236, v22
v_mul_f32 v237, v237, v22
v_mul_f32 v238, v238, v22
v_mul_f32 v239, v239, v22
v_cvt_pk_bf16_f32 v232, v232, v233
v_cvt_pk_bf16_f32 v233, v234, v235
v_cvt_pk_bf16_f32 v234, v236, v237
v_cvt_pk_bf16_f32 v235, v238, v239
s_add_u32 s77, s75, 0
buffer_store_dwordx4 v[232:235], v16, s[44:47], s77 offen sc1
s_branch L_TAIL
L_fallback_11:
s_waitcnt vmcnt(0) lgkmcnt(0)
s_barrier
s_mov_b32 s73, 1
s_mov_b32 s81, 0
v_and_b32 v232, 15, v0
v_lshrrev_b32 v233, 4, v0
v_lshlrev_b32 v233, 2, v233
v_sub_u32 v232, v232, v233
s_lshl_b32 s66, s30, 4
v_add_u32 v232, s66, v232
s_lshl_b32 s66, s16, 7
v_add_u32 v234, s66, v232
s_lshl_b32 s66, s3, 7
v_add_u32 v232, s66, v232
v_add_u32 v233, 64, v232
v_add_u32 v235, 64, v234
s_mov_b32 m0, s76
s_lshl_b32 s64, s30, 14
s_nop 0
buffer_load_dwordx4 v16, s[32:35], s64 offen offset:0 sc1 lds
s_nop 0
buffer_load_dwordx4 v16, s[32:35], s64 offen offset:1024 sc1 lds
s_nop 0
buffer_load_dwordx4 v16, s[32:35], s64 offen offset:2048 sc1 lds
s_nop 0
buffer_load_dwordx4 v16, s[32:35], s64 offen offset:3072 sc1 lds
s_add_u32 m0, s76, 4096
s_add_u32 s64, s64, 4096
s_nop 0
buffer_load_dwordx4 v16, s[32:35], s64 offen offset:0 sc1 lds
s_nop 0
buffer_load_dwordx4 v16, s[32:35], s64 offen offset:1024 sc1 lds
s_nop 0
buffer_load_dwordx4 v16, s[32:35], s64 offen offset:2048 sc1 lds
s_nop 0
buffer_load_dwordx4 v16, s[32:35], s64 offen offset:3072 sc1 lds
s_lshr_b32 s64, s76, 1
s_add_u32 m0, s64, 81920
s_and_b32 s71, s64, 8192
s_add_u32 s64, s64, s71
s_add_u32 s64, s64, 8192
s_nop 0
buffer_load_dwordx4 v16, s[32:35], s64 offen offset:0 sc1 lds
s_nop 0
buffer_load_dwordx4 v16, s[32:35], s64 offen offset:1024 sc1 lds
s_nop 0
buffer_load_dwordx4 v16, s[32:35], s64 offen offset:2048 sc1 lds
s_nop 0
buffer_load_dwordx4 v16, s[32:35], s64 offen offset:3072 sc1 lds
v_mov_b32 v20, 0xff800000
v_mov_b32 v21, 0xff800000
v_mov_b32 v22, 0xff800000
v_mov_b32 v23, 0xff800000
L_fbl_1015:
buffer_load_dwordx4 a[144:147], v16, s[32:35], s81 offen offset:0 sc1
buffer_load_dwordx4 a[148:151], v16, s[32:35], s81 offen offset:1024 sc1
buffer_load_dwordx4 a[152:155], v16, s[32:35], s81 offen offset:2048 sc1
buffer_load_dwordx4 a[156:159], v16, s[32:35], s81 offen offset:3072 sc1
s_add_u32 s64, s81, 4096
buffer_load_dwordx4 a[160:163], v16, s[32:35], s64 offen offset:0 sc1
buffer_load_dwordx4 a[164:167], v16, s[32:35], s64 offen offset:1024 sc1
buffer_load_dwordx4 a[168:171], v16, s[32:35], s64 offen offset:2048 sc1
buffer_load_dwordx4 a[172:175], v16, s[32:35], s64 offen offset:3072 sc1
v_subrev_u32 v88, 0, v232
v_ashrrev_i32 v88, 31, v88
v_and_b32 v88, 0xff800000, v88
v_subrev_u32 v89, 1, v232
v_ashrrev_i32 v89, 31, v89
v_and_b32 v89, 0xff800000, v89
v_subrev_u32 v90, 2, v232
v_ashrrev_i32 v90, 31, v90
v_and_b32 v90, 0xff800000, v90
v_subrev_u32 v91, 3, v232
v_ashrrev_i32 v91, 31, v91
v_and_b32 v91, 0xff800000, v91
v_subrev_u32 v92, 16, v232
v_ashrrev_i32 v92, 31, v92
v_and_b32 v92, 0xff800000, v92
v_subrev_u32 v93, 17, v232
v_ashrrev_i32 v93, 31, v93
v_and_b32 v93, 0xff800000, v93
v_subrev_u32 v94, 18, v232
v_ashrrev_i32 v94, 31, v94
v_and_b32 v94, 0xff800000, v94
v_subrev_u32 v95, 19, v232
v_ashrrev_i32 v95, 31, v95
v_and_b32 v95, 0xff800000, v95
v_subrev_u32 v232, 32, v232
v_subrev_u32 v104, 0, v233
v_ashrrev_i32 v104, 31, v104
v_and_b32 v104, 0xff800000, v104
v_subrev_u32 v105, 1, v233
v_ashrrev_i32 v105, 31, v105
v_and_b32 v105, 0xff800000, v105
v_subrev_u32 v106, 2, v233
v_ashrrev_i32 v106, 31, v106
v_and_b32 v106, 0xff800000, v106
v_subrev_u32 v107, 3, v233
v_ashrrev_i32 v107, 31, v107
v_and_b32 v107, 0xff800000, v107
v_subrev_u32 v108, 16, v233
v_ashrrev_i32 v108, 31, v108
v_and_b32 v108, 0xff800000, v108
v_subrev_u32 v109, 17, v233
v_ashrrev_i32 v109, 31, v109
v_and_b32 v109, 0xff800000, v109
v_subrev_u32 v110, 18, v233
v_ashrrev_i32 v110, 31, v110
v_and_b32 v110, 0xff800000, v110
v_subrev_u32 v111, 19, v233
v_ashrrev_i32 v111, 31, v111
v_and_b32 v111, 0xff800000, v111
v_subrev_u32 v233, 32, v233
v_subrev_u32 v120, 0, v234
v_ashrrev_i32 v120, 31, v120
v_and_b32 v120, 0xff800000, v120
v_subrev_u32 v121, 1, v234
v_ashrrev_i32 v121, 31, v121
v_and_b32 v121, 0xff800000, v121
v_subrev_u32 v122, 2, v234
v_ashrrev_i32 v122, 31, v122
v_and_b32 v122, 0xff800000, v122
v_subrev_u32 v123, 3, v234
v_ashrrev_i32 v123, 31, v123
v_and_b32 v123, 0xff800000, v123
v_subrev_u32 v124, 16, v234
v_ashrrev_i32 v124, 31, v124
v_and_b32 v124, 0xff800000, v124
v_subrev_u32 v125, 17, v234
v_ashrrev_i32 v125, 31, v125
v_and_b32 v125, 0xff800000, v125
v_subrev_u32 v126, 18, v234
v_ashrrev_i32 v126, 31, v126
v_and_b32 v126, 0xff800000, v126
v_subrev_u32 v127, 19, v234
v_ashrrev_i32 v127, 31, v127
v_and_b32 v127, 0xff800000, v127
v_subrev_u32 v234, 32, v234
v_subrev_u32 v136, 0, v235
v_ashrrev_i32 v136, 31, v136
v_and_b32 v136, 0xff800000, v136
v_subrev_u32 v137, 1, v235
v_ashrrev_i32 v137, 31, v137
v_and_b32 v137, 0xff800000, v137
v_subrev_u32 v138, 2, v235
v_ashrrev_i32 v138, 31, v138
v_and_b32 v138, 0xff800000, v138
v_subrev_u32 v139, 3, v235
v_ashrrev_i32 v139, 31, v139
v_and_b32 v139, 0xff800000, v139
v_subrev_u32 v140, 16, v235
v_ashrrev_i32 v140, 31, v140
v_and_b32 v140, 0xff800000, v140
v_subrev_u32 v141, 17, v235
v_ashrrev_i32 v141, 31, v141
v_and_b32 v141, 0xff800000, v141
v_subrev_u32 v142, 18, v235
v_ashrrev_i32 v142, 31, v142
v_and_b32 v142, 0xff800000, v142
v_subrev_u32 v143, 19, v235
v_ashrrev_i32 v143, 31, v143
v_and_b32 v143, 0xff800000, v143
v_subrev_u32 v235, 32, v235
s_waitcnt vmcnt(0)
v_mfma_f32_16x16x32_bf16 v[88:91], a[144:147], v[24:27], v[88:91]
v_mfma_f32_16x16x32_bf16 v[104:107], a[144:147], v[40:43], v[104:107]
v_mfma_f32_16x16x32_bf16 v[120:123], a[144:147], v[56:59], v[120:123]
v_mfma_f32_16x16x32_bf16 v[136:139], a[144:147], v[72:75], v[136:139]
v_mfma_f32_16x16x32_bf16 v[88:91], a[148:151], v[28:31], v[88:91]
v_mfma_f32_16x16x32_bf16 v[104:107], a[148:151], v[44:47], v[104:107]
v_mfma_f32_16x16x32_bf16 v[120:123], a[148:151], v[60:63], v[120:123]
v_mfma_f32_16x16x32_bf16 v[136:139], a[148:151], v[76:79], v[136:139]
v_mfma_f32_16x16x32_bf16 v[88:91], a[152:155], v[32:35], v[88:91]
v_mfma_f32_16x16x32_bf16 v[104:107], a[152:155], v[48:51], v[104:107]
v_mfma_f32_16x16x32_bf16 v[120:123], a[152:155], v[64:67], v[120:123]
v_mfma_f32_16x16x32_bf16 v[136:139], a[152:155], v[80:83], v[136:139]
v_mfma_f32_16x16x32_bf16 v[88:91], a[156:159], v[36:39], v[88:91]
v_mfma_f32_16x16x32_bf16 v[104:107], a[156:159], v[52:55], v[104:107]
v_mfma_f32_16x16x32_bf16 v[120:123], a[156:159], v[68:71], v[120:123]
v_mfma_f32_16x16x32_bf16 v[136:139], a[156:159], v[84:87], v[136:139]
v_mfma_f32_16x16x32_bf16 v[92:95], a[160:163], v[24:27], v[92:95]
v_mfma_f32_16x16x32_bf16 v[108:111], a[160:163], v[40:43], v[108:111]
v_mfma_f32_16x16x32_bf16 v[124:127], a[160:163], v[56:59], v[124:127]
v_mfma_f32_16x16x32_bf16 v[140:143], a[160:163], v[72:75], v[140:143]
v_mfma_f32_16x16x32_bf16 v[92:95], a[164:167], v[28:31], v[92:95]
v_mfma_f32_16x16x32_bf16 v[108:111], a[164:167], v[44:47], v[108:111]
v_mfma_f32_16x16x32_bf16 v[124:127], a[164:167], v[60:63], v[124:127]
v_mfma_f32_16x16x32_bf16 v[140:143], a[164:167], v[76:79], v[140:143]
v_mfma_f32_16x16x32_bf16 v[92:95], a[168:171], v[32:35], v[92:95]
v_mfma_f32_16x16x32_bf16 v[108:111], a[168:171], v[48:51], v[108:111]
v_mfma_f32_16x16x32_bf16 v[124:127], a[168:171], v[64:67], v[124:127]
v_mfma_f32_16x16x32_bf16 v[140:143], a[168:171], v[80:83], v[140:143]
v_mfma_f32_16x16x32_bf16 v[92:95], a[172:175], v[36:39], v[92:95]
v_mfma_f32_16x16x32_bf16 v[108:111], a[172:175], v[52:55], v[108:111]
v_mfma_f32_16x16x32_bf16 v[124:127], a[172:175], v[68:71], v[124:127]
v_mfma_f32_16x16x32_bf16 v[140:143], a[172:175], v[84:87], v[140:143]
s_nop 7
v_max3_f32 v20, v20, v88, v89
v_max3_f32 v20, v20, v90, v91
v_max3_f32 v20, v20, v92, v93
v_max3_f32 v20, v20, v94, v95
v_max3_f32 v21, v21, v104, v105
v_max3_f32 v21, v21, v106, v107
v_max3_f32 v21, v21, v108, v109
v_max3_f32 v21, v21, v110, v111
v_max3_f32 v22, v22, v120, v121
v_max3_f32 v22, v22, v122, v123
v_max3_f32 v22, v22, v124, v125
v_max3_f32 v22, v22, v126, v127
v_max3_f32 v23, v23, v136, v137
v_max3_f32 v23, v23, v138, v139
v_max3_f32 v23, v23, v140, v141
v_max3_f32 v23, v23, v142, v143
s_add_u32 s81, s81, 16384
s_cmp_lt_u32 s81, s34
s_cbranch_scc1 L_fbl_1015
v_mov_b32 v248, v20
v_mov_b32 v249, v21
v_mov_b32 v250, v22
v_mov_b32 v251, v23
v_permlane16_swap_b32 v248, v20
v_permlane16_swap_b32 v249, v21
v_permlane16_swap_b32 v250, v22
v_permlane16_swap_b32 v251, v23
v_max_f32 v20, v20, v248
v_max_f32 v21, v21, v249
v_max_f32 v22, v22, v250
v_max_f32 v23, v23, v251
v_mov_b32 v248, v20
v_mov_b32 v249, v21
v_mov_b32 v250, v22
v_mov_b32 v251, v23
v_permlane32_swap_b32 v248, v20
v_permlane32_swap_b32 v249, v21
v_permlane32_swap_b32 v250, v22
v_permlane32_swap_b32 v251, v23
v_max_f32 v20, v20, v248
v_max_f32 v21, v21, v249
v_max_f32 v22, v22, v250
v_max_f32 v23, v23, v251
v_mov_b32 v252, v20
v_mov_b32 v253, v21
v_mov_b32 v254, v22
v_mov_b32 v255, v23
s_and_b32 s70, s30, 1
s_lshr_b32 s67, s30, 1
s_lshl3_add_u32 s71, s67, s70
s_add_u32 s71, s71, 4
s_lshl_b32 s71, s71, 13
s_lshl_b32 s70, s70, 14
s_mul_i32 s67, s67, 24576
s_sub_u32 s70, s70, s67
s_add_u32 s70, s70, 65536
s_branch L_attstart_7
L_spin_2016:
s_mov_b32 vcc_hi, 0x80000
L_spinlp_2018:
s_sleep 1
buffer_load_dword v19, off, s[52:55], s72 offset:0 sc1
s_waitcnt vmcnt(0)
v_readfirstlane_b32 vcc_lo, v19
s_sub_u32 vcc_hi, vcc_hi, 1
s_cbranch_scc1 L_spinbk_2017
s_cmp_lt_u32 vcc_lo, 8
s_cbranch_scc1 L_spinlp_2018
s_branch L_spinbk_2017
L_spin_3019:
s_mov_b32 vcc_hi, 0x80000
L_spinlp_3021:
s_sleep 1
buffer_load_dword v19, off, s[52:55], s72 offset:0 sc1
s_waitcnt vmcnt(0)
v_readfirstlane_b32 vcc_lo, v19
s_sub_u32 vcc_hi, vcc_hi, 1
s_cbranch_scc1 L_spinbk_3020
s_cmp_lt_u32 vcc_lo, 8
s_cbranch_scc1 L_spinlp_3021
s_branch L_spinbk_3020
L_p5f0:
s_waitcnt lgkmcnt(10)
s_waitcnt vmcnt(28)
v_mfma_f32_16x16x32_bf16 v[136:139], a[144:147], a[232:235], 0
s_waitcnt vmcnt(24)
s_waitcnt lgkmcnt(8)
s_add_u32 m0, s86, 65536
ds_read_b64_tr_b16 a[168:169], v191 offset:32768
v_xor_b32 v192, 0x10000, v184
v_mfma_f32_16x16x32_bf16 v[136:139], a[148:151], a[236:239], v[136:139]
s_add_u32 s64, s85, 524288
ds_read_b64_tr_b16 a[170:171], v191 offset:36864
v_xor_b32 v193, 0x10000, v185
v_mfma_f32_16x16x32_bf16 v[104:107], a[148:151], a[228:231], 0
buffer_load_dwordx4 v12, s[36:39], s64 offen lds
v_mfma_f32_16x16x32_bf16 v[104:107], a[144:147], a[224:227], v[104:107]
s_add_u32 m0, s86, 66560
s_add_u32 s64, s85, 532480
ds_read_b64_tr_b16 a[172:173], v191 offset:40960
v_xor_b32 v194, 0x10000, v186
v_mfma_f32_16x16x32_bf16 v[72:75], a[144:147], a[216:219], 0
s_and_b32 s71, s31, 4
buffer_load_dwordx4 v13, s[36:39], s64 offen lds
v_mfma_f32_16x16x32_bf16 v[72:75], a[148:151], a[220:223], v[72:75]
s_lshl_b32 s71, s71, 5
s_add_u32 s71, s71, s79
s_add_u32 m0, s86, 67584
s_add_u32 s64, s85, 540672
ds_read_b64_tr_b16 a[174:175], v191 offset:45056
v_mfma_f32_16x16x32_bf16 v[40:43], a[148:151], a[212:215], 0
s_add_u32 s71, s71, 4096
buffer_load_dwordx4 v12, s[36:39], s64 offen lds
v_mfma_f32_16x16x32_bf16 v[40:43], a[144:147], a[208:211], v[40:43]
s_waitcnt lgkmcnt(4)
s_add_u32 s72, s80, 4096
s_add_u32 m0, s86, 68608
s_add_u32 s64, s85, 548864
ds_read_b64_tr_b16 a[176:177], v184 offset:32768
v_xor_b32 v195, 0x10000, v187
v_mfma_f32_16x16x32_bf16 v[44:47], a[152:155], a[208:211], 0
buffer_load_dwordx4 v13, s[36:39], s64 offen lds
v_mfma_f32_16x16x32_bf16 v[44:47], a[156:159], a[212:215], v[44:47]
s_add_u32 m0, s86, 69632
ds_read_b64_tr_b16 a[178:179], v184 offset:36864
v_xor_b32 v196, 0x10000, v188
v_mfma_f32_16x16x32_bf16 v[76:79], a[156:159], a[220:223], 0
s_add_u32 s64, s85, 557056
ds_read_b64_tr_b16 a[180:181], v184 offset:40960
v_xor_b32 v197, 0x10000, v189
v_mfma_f32_16x16x32_bf16 v[76:79], a[152:155], a[216:219], v[76:79]
buffer_load_dwordx4 v12, s[36:39], s64 offen lds
v_mfma_f32_16x16x32_bf16 v[108:111], a[152:155], a[224:227], 0
s_add_u32 m0, s86, 70656
s_add_u32 s64, s85, 565248
ds_read_b64_tr_b16 a[182:183], v184 offset:45056
v_xor_b32 v198, 0x10000, v190
v_mfma_f32_16x16x32_bf16 v[108:111], a[156:159], a[228:231], v[108:111]
buffer_load_dwordx4 v13, s[36:39], s64 offen lds
v_mfma_f32_16x16x32_bf16 v[140:143], a[156:159], a[236:239], 0
s_add_u32 m0, s86, 71680
s_add_u32 s64, s85, 573440
ds_read_b64_tr_b16 a[184:185], v185 offset:32768
v_xor_b32 v199, 0x10000, v191
v_mfma_f32_16x16x32_bf16 v[140:143], a[152:155], a[232:235], v[140:143]
buffer_load_dwordx4 v12, s[36:39], s64 offen lds
v_mfma_f32_16x16x32_bf16 v[144:147], a[160:163], a[232:235], 0
s_add_u32 m0, s86, 72704
ds_read_b64_tr_b16 a[186:187], v185 offset:36864
v_mfma_f32_16x16x32_bf16 v[144:147], a[164:167], a[236:239], v[144:147]
s_add_u32 s64, s85, 581632
ds_read_b64_tr_b16 a[188:189], v185 offset:40960
v_mfma_f32_16x16x32_bf16 v[112:115], a[164:167], a[228:231], 0
buffer_load_dwordx4 v13, s[36:39], s64 offen lds
v_mfma_f32_16x16x32_bf16 v[112:115], a[160:163], a[224:227], v[112:115]
s_add_u32 s65, s84, 65536
ds_read_b64_tr_b16 a[190:191], v185 offset:45056
v_mfma_f32_16x16x32_bf16 v[80:83], a[160:163], a[216:219], 0
buffer_load_dwordx4 a[0:3], v14, s[44:47], s65 offen offset:0 sc1
v_mfma_f32_16x16x32_bf16 v[80:83], a[164:167], a[220:223], v[80:83]
ds_read_b64_tr_b16 a[192:193], v186 offset:32768
v_mfma_f32_16x16x32_bf16 v[48:51], a[164:167], a[212:215], 0
buffer_load_dwordx4 a[8:11], v14, s[44:47], s65 offen offset:1024 sc1
v_mfma_f32_16x16x32_bf16 v[48:51], a[160:163], a[208:211], v[48:51]
s_waitcnt lgkmcnt(4)
ds_read_b64_tr_b16 a[194:195], v186 offset:36864
v_mfma_f32_16x16x32_bf16 v[52:55], a[168:171], a[208:211], 0
ds_read_b64_tr_b16 a[196:197], v186 offset:40960
v_mfma_f32_16x16x32_bf16 v[52:55], a[172:175], a[212:215], v[52:55]
buffer_load_dwordx4 a[16:19], v15, s[44:47], s65 offen offset:0 sc1
v_mfma_f32_16x16x32_bf16 v[84:87], a[172:175], a[220:223], 0
ds_read_b64_tr_b16 a[198:199], v186 offset:45056
v_mfma_f32_16x16x32_bf16 v[84:87], a[168:171], a[216:219], v[84:87]
buffer_load_dwordx4 a[24:27], v15, s[44:47], s65 offen offset:1024 sc1
v_mfma_f32_16x16x32_bf16 v[116:119], a[168:171], a[224:227], 0
s_add_u32 s65, s84, 73728
ds_read_b64_tr_b16 a[200:201], v187 offset:32768
v_mfma_f32_16x16x32_bf16 v[116:119], a[172:175], a[228:231], v[116:119]
buffer_load_dwordx4 a[4:7], v14, s[44:47], s65 offen offset:0 sc1
v_mfma_f32_16x16x32_bf16 v[148:151], a[172:175], a[236:239], 0
ds_read_b64_tr_b16 a[202:203], v187 offset:36864
v_mfma_f32_16x16x32_bf16 v[148:151], a[168:171], a[232:235], v[148:151]
ds_read_b64_tr_b16 a[204:205], v187 offset:40960
v_mfma_f32_16x16x32_bf16 v[120:123], a[176:179], a[232:235], 0
buffer_load_dwordx4 a[12:15], v14, s[44:47], s65 offen offset:1024 sc1
v_mfma_f32_16x16x32_bf16 v[120:123], a[180:183], a[236:239], v[120:123]
ds_read_b64_tr_b16 a[206:207], v187 offset:45056
v_mfma_f32_16x16x32_bf16 v[88:91], a[180:183], a[228:231], 0
buffer_load_dwordx4 a[20:23], v15, s[44:47], s65 offen offset:0 sc1
v_mfma_f32_16x16x32_bf16 v[88:91], a[176:179], a[224:227], v[88:91]
v_mfma_f32_16x16x32_bf16 v[56:59], a[176:179], a[216:219], 0
buffer_load_dwordx4 a[28:31], v15, s[44:47], s65 offen offset:1024 sc1
v_mfma_f32_16x16x32_bf16 v[56:59], a[180:183], a[220:223], v[56:59]
v_mfma_f32_16x16x32_bf16 v[24:27], a[180:183], a[212:215], 0
v_mfma_f32_16x16x32_bf16 v[24:27], a[176:179], a[208:211], v[24:27]
s_waitcnt lgkmcnt(1)
v_mfma_f32_16x16x32_bf16 v[28:31], a[184:187], a[208:211], 0
s_waitcnt vmcnt(23)
s_barrier
v_mfma_f32_16x16x32_bf16 v[28:31], a[188:191], a[212:215], v[28:31]
ds_read_b64_tr_b16 a[144:145], v196 offset:0
v_mfma_f32_16x16x32_bf16 v[60:63], a[188:191], a[220:223], 0
ds_read_b64_tr_b16 a[146:147], v196 offset:4096
v_mfma_f32_16x16x32_bf16 v[60:63], a[184:187], a[216:219], v[60:63]
s_add_u32 m0, s86, 0
ds_read_b64_tr_b16 a[148:149], v196 offset:8192
v_mfma_f32_16x16x32_bf16 v[92:95], a[184:187], a[224:227], 0
s_add_u32 s64, s85, 786432
ds_read_b64_tr_b16 a[150:151], v196 offset:12288
v_mfma_f32_16x16x32_bf16 v[92:95], a[188:191], a[228:231], v[92:95]
buffer_load_dwordx4 v12, s[36:39], s64 offen lds
v_mfma_f32_16x16x32_bf16 v[124:127], a[188:191], a[236:239], 0
s_add_u32 m0, s86, 1024
ds_read_b64_tr_b16 a[152:153], v197 offset:0
v_mfma_f32_16x16x32_bf16 v[124:127], a[184:187], a[232:235], v[124:127]
s_add_u32 s64, s85, 794624
ds_read_b64_tr_b16 a[154:155], v197 offset:4096
v_mfma_f32_16x16x32_bf16 v[128:131], a[192:195], a[232:235], 0
buffer_load_dwordx4 v13, s[36:39], s64 offen lds
v_mfma_f32_16x16x32_bf16 v[128:131], a[196:199], a[236:239], v[128:131]
ds_read_b64_tr_b16 a[156:157], v197 offset:8192
v_mfma_f32_16x16x32_bf16 v[96:99], a[196:199], a[228:231], 0
s_add_u32 m0, s86, 2048
ds_read_b64_tr_b16 a[158:159], v197 offset:12288
v_mfma_f32_16x16x32_bf16 v[96:99], a[192:195], a[224:227], v[96:99]
s_add_u32 s64, s85, 802816
ds_read_b64_tr_b16 a[160:161], v198 offset:0
v_mfma_f32_16x16x32_bf16 v[64:67], a[192:195], a[216:219], 0
buffer_load_dwordx4 v12, s[36:39], s64 offen lds
v_mfma_f32_16x16x32_bf16 v[64:67], a[196:199], a[220:223], v[64:67]
ds_read_b64_tr_b16 a[162:163], v198 offset:4096
v_mfma_f32_16x16x32_bf16 v[32:35], a[196:199], a[212:215], 0
s_add_u32 m0, s86, 3072
ds_read_b64_tr_b16 a[164:165], v198 offset:8192
v_mfma_f32_16x16x32_bf16 v[32:35], a[192:195], a[208:211], v[32:35]
s_add_u32 s64, s85, 811008
ds_read_b64_tr_b16 a[166:167], v198 offset:12288
v_mfma_f32_16x16x32_bf16 v[36:39], a[200:203], a[208:211], 0
s_waitcnt lgkmcnt(6)
buffer_load_dwordx4 v13, s[36:39], s64 offen lds
v_mfma_f32_16x16x32_bf16 v[36:39], a[204:207], a[212:215], v[36:39]
v_mfma_f32_16x16x32_bf16 v[68:71], a[204:207], a[220:223], 0
s_add_u32 m0, s86, 4096
v_mfma_f32_16x16x32_bf16 v[68:71], a[200:203], a[216:219], v[68:71]
s_add_u32 s64, s85, 819200
v_mfma_f32_16x16x32_bf16 v[100:103], a[200:203], a[224:227], 0
buffer_load_dwordx4 v12, s[36:39], s64 offen lds
v_mfma_f32_16x16x32_bf16 v[100:103], a[204:207], a[228:231], v[100:103]
v_mfma_f32_16x16x32_bf16 v[132:135], a[204:207], a[236:239], 0
v_mfma_f32_16x16x32_bf16 v[132:135], a[200:203], a[232:235], v[132:135]
v_mfma_f32_16x16x32_bf16 v[136:139], a[144:147], v[176:179], v[136:139]
s_add_u32 m0, s86, 5120
ds_read_b64_tr_b16 a[168:169], v199 offset:0
v_xor_b32 v200, 0x18000, v184
v_mfma_f32_16x16x32_bf16 v[136:139], a[148:151], v[180:183], v[136:139]
s_add_u32 s64, s85, 827392
ds_read_b64_tr_b16 a[170:171], v199 offset:4096
v_xor_b32 v201, 0x18000, v185
v_mfma_f32_16x16x32_bf16 v[104:107], a[148:151], v[172:175], v[104:107]
buffer_load_dwordx4 v13, s[36:39], s64 offen lds
v_mfma_f32_16x16x32_bf16 v[104:107], a[144:147], v[168:171], v[104:107]
s_add_u32 m0, s86, 6144
ds_read_b64_tr_b16 a[172:173], v199 offset:8192
v_xor_b32 v202, 0x18000, v186
v_mfma_f32_16x16x32_bf16 v[72:75], a[144:147], v[160:163], v[72:75]
s_add_u32 s64, s85, 835584
ds_read_b64_tr_b16 a[174:175], v199 offset:12288
v_xor_b32 v203, 0x18000, v187
v_mfma_f32_16x16x32_bf16 v[72:75], a[148:151], v[164:167], v[72:75]
buffer_load_dwordx4 v12, s[36:39], s64 offen lds
v_mfma_f32_16x16x32_bf16 v[40:43], a[148:151], v[156:159], v[40:43]
s_add_u32 m0, s86, 7168
ds_read_b64_tr_b16 a[176:177], v192 offset:0
v_xor_b32 v204, 0x18000, v188
v_mfma_f32_16x16x32_bf16 v[40:43], a[144:147], v[152:155], v[40:43]
s_add_u32 s64, s85, 843776
ds_read_b64_tr_b16 a[178:179], v192 offset:4096
v_xor_b32 v205, 0x18000, v189
v_mfma_f32_16x16x32_bf16 v[44:47], a[152:155], v[152:155], v[44:47]
s_waitcnt lgkmcnt(5)
buffer_load_dwordx4 v13, s[36:39], s64 offen lds
v_mfma_f32_16x16x32_bf16 v[44:47], a[156:159], v[156:159], v[44:47]
ds_read_b64_tr_b16 a[180:181], v192 offset:8192
v_xor_b32 v206, 0x18000, v190
v_mfma_f32_16x16x32_bf16 v[76:79], a[156:159], v[164:167], v[76:79]
ds_read_b64_tr_b16 a[182:183], v192 offset:12288
v_xor_b32 v207, 0x18000, v191
v_mfma_f32_16x16x32_bf16 v[76:79], a[152:155], v[160:163], v[76:79]
s_add_u32 s65, s84, 98304
ds_read_b64_tr_b16 a[184:185], v193 offset:0
v_mfma_f32_16x16x32_bf16 v[108:111], a[152:155], v[168:171], v[108:111]
buffer_load_dwordx4 a[64:67], v14, s[44:47], s65 offen offset:0 sc1
v_mfma_f32_16x16x32_bf16 v[108:111], a[156:159], v[172:175], v[108:111]
ds_read_b64_tr_b16 a[186:187], v193 offset:4096
v_mfma_f32_16x16x32_bf16 v[140:143], a[156:159], v[180:183], v[140:143]
ds_read_b64_tr_b16 a[188:189], v193 offset:8192
v_mfma_f32_16x16x32_bf16 v[140:143], a[152:155], v[176:179], v[140:143]
buffer_load_dwordx4 a[72:75], v14, s[44:47], s65 offen offset:1024 sc1
v_mfma_f32_16x16x32_bf16 v[144:147], a[160:163], v[176:179], v[144:147]
ds_read_b64_tr_b16 a[190:191], v193 offset:12288
v_mfma_f32_16x16x32_bf16 v[144:147], a[164:167], v[180:183], v[144:147]
v_mfma_f32_16x16x32_bf16 v[112:115], a[164:167], v[172:175], v[112:115]
buffer_load_dwordx4 a[80:83], v15, s[44:47], s65 offen offset:0 sc1
v_mfma_f32_16x16x32_bf16 v[112:115], a[160:163], v[168:171], v[112:115]
ds_read_b64_tr_b16 a[192:193], v194 offset:0
v_mfma_f32_16x16x32_bf16 v[80:83], a[160:163], v[160:163], v[80:83]
ds_read_b64_tr_b16 a[194:195], v194 offset:4096
v_mfma_f32_16x16x32_bf16 v[80:83], a[164:167], v[164:167], v[80:83]
ds_read_b64_tr_b16 a[196:197], v194 offset:8192
v_mfma_f32_16x16x32_bf16 v[48:51], a[164:167], v[156:159], v[48:51]
buffer_load_dwordx4 a[88:91], v15, s[44:47], s65 offen offset:1024 sc1
v_mfma_f32_16x16x32_bf16 v[48:51], a[160:163], v[152:155], v[48:51]
s_waitcnt lgkmcnt(4)
ds_read_b64_tr_b16 a[198:199], v194 offset:12288
v_mfma_f32_16x16x32_bf16 v[52:55], a[168:171], v[152:155], v[52:55]
s_add_u32 s65, s84, 106496
v_mfma_f32_16x16x32_bf16 v[52:55], a[172:175], v[156:159], v[52:55]
buffer_load_dwordx4 a[68:71], v14, s[44:47], s65 offen offset:0 sc1
v_mfma_f32_16x16x32_bf16 v[84:87], a[172:175], v[164:167], v[84:87]
ds_read_b64_tr_b16 a[200:201], v195 offset:0
v_mfma_f32_16x16x32_bf16 v[84:87], a[168:171], v[160:163], v[84:87]
ds_read_b64_tr_b16 a[202:203], v195 offset:4096
v_mfma_f32_16x16x32_bf16 v[116:119], a[168:171], v[168:171], v[116:119]
s_lshl_b32 s66, s30, 30
buffer_load_dwordx4 a[76:79], v14, s[44:47], s65 offen offset:1024 sc1
v_mfma_f32_16x16x32_bf16 v[116:119], a[172:175], v[172:175], v[116:119]
ds_read_b64_tr_b16 a[204:205], v195 offset:8192
v_lshl_add_u32 v1, v0, 24, s66
v_mfma_f32_16x16x32_bf16 v[148:151], a[172:175], v[180:183], v[148:151]
ds_read_b64_tr_b16 a[206:207], v195 offset:12288
v_mfma_f32_16x16x32_bf16 v[148:151], a[168:171], v[176:179], v[148:151]
v_mfma_f32_16x16x32_bf16 v[120:123], a[176:179], v[176:179], v[120:123]
buffer_load_dwordx4 a[84:87], v15, s[44:47], s65 offen offset:0 sc1
v_mfma_f32_16x16x32_bf16 v[120:123], a[180:183], v[180:183], v[120:123]
v_mfma_f32_16x16x32_bf16 v[88:91], a[180:183], v[172:175], v[88:91]
v_mfma_f32_16x16x32_bf16 v[88:91], a[176:179], v[168:171], v[88:91]
buffer_load_dwordx4 a[92:95], v15, s[44:47], s65 offen offset:1024 sc1
v_mfma_f32_16x16x32_bf16 v[56:59], a[176:179], v[160:163], v[56:59]
v_mfma_f32_16x16x32_bf16 v[56:59], a[180:183], v[164:167], v[56:59]
v_mfma_f32_16x16x32_bf16 v[24:27], a[180:183], v[156:159], v[24:27]
v_mfma_f32_16x16x32_bf16 v[24:27], a[176:179], v[152:155], v[24:27]
v_mfma_f32_16x16x32_bf16 v[28:31], a[184:187], v[152:155], v[28:31]
s_waitcnt vmcnt(24)
s_barrier
s_waitcnt lgkmcnt(0)
v_mfma_f32_16x16x32_bf16 v[28:31], a[188:191], v[156:159], v[28:31]
s_mov_b64 exec, 1
buffer_atomic_add a251, v1, s[52:55], s71 offen offset:0 sc1
s_mov_b64 exec, -1
v_mfma_f32_16x16x32_bf16 v[60:63], a[188:191], v[164:167], v[60:63]
ds_read_b64_tr_b16 a[144:145], v196 offset:32768
v_mfma_f32_16x16x32_bf16 v[60:63], a[184:187], v[160:163], v[60:63]
s_add_u32 m0, s86, 98304
ds_read_b64_tr_b16 a[146:147], v196 offset:36864
v_mfma_f32_16x16x32_bf16 v[92:95], a[184:187], v[168:171], v[92:95]
s_add_u32 s64, s85, 1048576
ds_read_b64_tr_b16 a[148:149], v196 offset:40960
v_mfma_f32_16x16x32_bf16 v[92:95], a[188:191], v[172:175], v[92:95]
buffer_load_dwordx4 v12, s[36:39], s64 offen lds
v_mfma_f32_16x16x32_bf16 v[124:127], a[188:191], v[180:183], v[124:127]
s_add_u32 m0, s86, 99328
ds_read_b64_tr_b16 a[150:151], v196 offset:45056
v_mfma_f32_16x16x32_bf16 v[124:127], a[184:187], v[176:179], v[124:127]
s_add_u32 s64, s85, 1056768
ds_read_b64_tr_b16 a[152:153], v197 offset:32768
v_mfma_f32_16x16x32_bf16 v[128:131], a[192:195], v[176:179], v[128:131]
buffer_load_dwordx4 v13, s[36:39], s64 offen lds
v_mfma_f32_16x16x32_bf16 v[128:131], a[196:199], v[180:183], v[128:131]
ds_read_b64_tr_b16 a[154:155], v197 offset:36864
v_mfma_f32_16x16x32_bf16 v[96:99], a[196:199], v[172:175], v[96:99]
s_add_u32 m0, s86, 100352
ds_read_b64_tr_b16 a[156:157], v197 offset:40960
v_mfma_f32_16x16x32_bf16 v[96:99], a[192:195], v[168:171], v[96:99]
s_add_u32 s64, s85, 1064960
ds_read_b64_tr_b16 a[158:159], v197 offset:45056
v_mfma_f32_16x16x32_bf16 v[64:67], a[192:195], v[160:163], v[64:67]
buffer_load_dwordx4 v12, s[36:39], s64 offen lds
v_mfma_f32_16x16x32_bf16 v[64:67], a[196:199], v[164:167], v[64:67]
ds_read_b64_tr_b16 a[160:161], v198 offset:32768
v_mfma_f32_16x16x32_bf16 v[32:35], a[196:199], v[156:159], v[32:35]
s_add_u32 m0, s86, 101376
ds_read_b64_tr_b16 a[162:163], v198 offset:36864
v_mfma_f32_16x16x32_bf16 v[32:35], a[192:195], v[152:155], v[32:35]
s_add_u32 s64, s85, 1073152
ds_read_b64_tr_b16 a[164:165], v198 offset:40960
v_mfma_f32_16x16x32_bf16 v[36:39], a[200:203], v[152:155], v[36:39]
buffer_load_dwordx4 v13, s[36:39], s64 offen lds
v_mfma_f32_16x16x32_bf16 v[36:39], a[204:207], v[156:159], v[36:39]
ds_read_b64_tr_b16 a[166:167], v198 offset:45056
v_mfma_f32_16x16x32_bf16 v[68:71], a[204:207], v[164:167], v[68:71]
s_add_u32 m0, s86, 102400
v_mfma_f32_16x16x32_bf16 v[68:71], a[200:203], v[160:163], v[68:71]
s_add_u32 s64, s85, 1081344
v_mfma_f32_16x16x32_bf16 v[100:103], a[200:203], v[168:171], v[100:103]
buffer_load_dwordx4 v12, s[36:39], s64 offen lds
v_mfma_f32_16x16x32_bf16 v[100:103], a[204:207], v[172:175], v[100:103]
v_mfma_f32_16x16x32_bf16 v[132:135], a[204:207], v[180:183], v[132:135]
v_mfma_f32_16x16x32_bf16 v[132:135], a[200:203], v[176:179], v[132:135]
s_waitcnt vmcnt(26)
s_waitcnt lgkmcnt(1)
v_mfma_f32_16x16x32_bf16 v[136:139], a[144:147], a[24:27], v[136:139]
s_waitcnt vmcnt(22)
s_add_u32 m0, s86, 103424
ds_read_b64_tr_b16 a[168:169], v199 offset:32768
v_mfma_f32_16x16x32_bf16 v[136:139], a[148:151], a[28:31], v[136:139]
s_add_u32 s64, s85, 1089536
ds_read_b64_tr_b16 a[170:171], v199 offset:36864
v_mfma_f32_16x16x32_bf16 v[104:107], a[148:151], a[20:23], v[104:107]
buffer_load_dwordx4 v13, s[36:39], s64 offen lds
v_mfma_f32_16x16x32_bf16 v[104:107], a[144:147], a[16:19], v[104:107]
s_add_u32 m0, s86, 104448
ds_read_b64_tr_b16 a[172:173], v199 offset:40960
v_mfma_f32_16x16x32_bf16 v[72:75], a[144:147], a[8:11], v[72:75]
s_add_u32 s64, s85, 1097728
ds_read_b64_tr_b16 a[174:175], v199 offset:45056
v_mfma_f32_16x16x32_bf16 v[72:75], a[148:151], a[12:15], v[72:75]
buffer_load_dwordx4 v12, s[36:39], s64 offen lds
v_mfma_f32_16x16x32_bf16 v[40:43], a[148:151], a[4:7], v[40:43]
s_add_u32 m0, s86, 105472
ds_read_b64_tr_b16 a[176:177], v192 offset:32768
v_mfma_f32_16x16x32_bf16 v[40:43], a[144:147], a[0:3], v[40:43]
s_add_u32 s64, s85, 1105920
ds_read_b64_tr_b16 a[178:179], v192 offset:36864
v_mfma_f32_16x16x32_bf16 v[44:47], a[152:155], a[0:3], v[44:47]
buffer_load_dwordx4 v13, s[36:39], s64 offen lds
v_mfma_f32_16x16x32_bf16 v[44:47], a[156:159], a[4:7], v[44:47]
ds_read_b64_tr_b16 a[180:181], v192 offset:40960
v_mfma_f32_16x16x32_bf16 v[76:79], a[156:159], a[12:15], v[76:79]
ds_read_b64_tr_b16 a[182:183], v192 offset:45056
v_mfma_f32_16x16x32_bf16 v[76:79], a[152:155], a[8:11], v[76:79]
s_add_u32 s65, s84, 131072
ds_read_b64_tr_b16 a[184:185], v193 offset:32768
v_mfma_f32_16x16x32_bf16 v[108:111], a[152:155], a[16:19], v[108:111]
buffer_load_dwordx4 a[32:35], v14, s[44:47], s65 offen offset:0 sc1
v_mfma_f32_16x16x32_bf16 v[108:111], a[156:159], a[20:23], v[108:111]
ds_read_b64_tr_b16 a[186:187], v193 offset:36864
v_mfma_f32_16x16x32_bf16 v[140:143], a[156:159], a[28:31], v[140:143]
ds_read_b64_tr_b16 a[188:189], v193 offset:40960
v_mfma_f32_16x16x32_bf16 v[140:143], a[152:155], a[24:27], v[140:143]
buffer_load_dwordx4 a[40:43], v14, s[44:47], s65 offen offset:1024 sc1
v_mfma_f32_16x16x32_bf16 v[144:147], a[160:163], a[24:27], v[144:147]
s_waitcnt lgkmcnt(5)
ds_read_b64_tr_b16 a[190:191], v193 offset:45056
v_mfma_f32_16x16x32_bf16 v[144:147], a[164:167], a[28:31], v[144:147]
v_mfma_f32_16x16x32_bf16 v[112:115], a[164:167], a[20:23], v[112:115]
buffer_load_dwordx4 a[48:51], v15, s[44:47], s65 offen offset:0 sc1
v_mfma_f32_16x16x32_bf16 v[112:115], a[160:163], a[16:19], v[112:115]
ds_read_b64_tr_b16 a[192:193], v194 offset:32768
v_mfma_f32_16x16x32_bf16 v[80:83], a[160:163], a[8:11], v[80:83]
ds_read_b64_tr_b16 a[194:195], v194 offset:36864
v_mfma_f32_16x16x32_bf16 v[80:83], a[164:167], a[12:15], v[80:83]
ds_read_b64_tr_b16 a[196:197], v194 offset:40960
v_mfma_f32_16x16x32_bf16 v[48:51], a[164:167], a[4:7], v[48:51]
buffer_load_dwordx4 a[56:59], v15, s[44:47], s65 offen offset:1024 sc1
v_mfma_f32_16x16x32_bf16 v[48:51], a[160:163], a[0:3], v[48:51]
ds_read_b64_tr_b16 a[198:199], v194 offset:45056
v_mfma_f32_16x16x32_bf16 v[52:55], a[168:171], a[0:3], v[52:55]
s_add_u32 s65, s84, 139264
v_mfma_f32_16x16x32_bf16 v[52:55], a[172:175], a[4:7], v[52:55]
buffer_load_dwordx4 a[36:39], v14, s[44:47], s65 offen offset:0 sc1
v_mfma_f32_16x16x32_bf16 v[84:87], a[172:175], a[12:15], v[84:87]
ds_read_b64_tr_b16 a[200:201], v195 offset:32768
v_mfma_f32_16x16x32_bf16 v[84:87], a[168:171], a[8:11], v[84:87]
ds_read_b64_tr_b16 a[202:203], v195 offset:36864
v_mfma_f32_16x16x32_bf16 v[116:119], a[168:171], a[16:19], v[116:119]
buffer_load_dwordx4 a[44:47], v14, s[44:47], s65 offen offset:1024 sc1
v_mfma_f32_16x16x32_bf16 v[116:119], a[172:175], a[20:23], v[116:119]
ds_read_b64_tr_b16 a[204:205], v195 offset:40960
v_mfma_f32_16x16x32_bf16 v[148:151], a[172:175], a[28:31], v[148:151]
ds_read_b64_tr_b16 a[206:207], v195 offset:45056
v_mfma_f32_16x16x32_bf16 v[148:151], a[168:171], a[24:27], v[148:151]
v_mfma_f32_16x16x32_bf16 v[120:123], a[176:179], a[24:27], v[120:123]
s_waitcnt lgkmcnt(4)
buffer_load_dwordx4 a[52:55], v15, s[44:47], s65 offen offset:0 sc1
v_mfma_f32_16x16x32_bf16 v[120:123], a[180:183], a[28:31], v[120:123]
v_mfma_f32_16x16x32_bf16 v[88:91], a[180:183], a[20:23], v[88:91]
v_mfma_f32_16x16x32_bf16 v[88:91], a[176:179], a[16:19], v[88:91]
buffer_load_dwordx4 a[60:63], v15, s[44:47], s65 offen offset:1024 sc1
v_mfma_f32_16x16x32_bf16 v[56:59], a[176:179], a[8:11], v[56:59]
v_mfma_f32_16x16x32_bf16 v[56:59], a[180:183], a[12:15], v[56:59]
v_mfma_f32_16x16x32_bf16 v[24:27], a[180:183], a[4:7], v[24:27]
v_mfma_f32_16x16x32_bf16 v[24:27], a[176:179], a[0:3], v[24:27]
v_mfma_f32_16x16x32_bf16 v[28:31], a[184:187], a[0:3], v[28:31]
s_waitcnt vmcnt(25)
s_barrier
v_mfma_f32_16x16x32_bf16 v[28:31], a[188:191], a[4:7], v[28:31]
ds_read_b64_tr_b16 a[144:145], v204 offset:0
v_mfma_f32_16x16x32_bf16 v[60:63], a[188:191], a[12:15], v[60:63]
ds_read_b64_tr_b16 a[146:147], v204 offset:4096
v_mfma_f32_16x16x32_bf16 v[60:63], a[184:187], a[8:11], v[60:63]
s_add_u32 m0, s86, 131072
ds_read_b64_tr_b16 a[148:149], v204 offset:8192
v_mfma_f32_16x16x32_bf16 v[92:95], a[184:187], a[16:19], v[92:95]
s_add_u32 s64, s85, 0
ds_read_b64_tr_b16 a[150:151], v204 offset:12288
v_mfma_f32_16x16x32_bf16 v[92:95], a[188:191], a[20:23], v[92:95]
buffer_load_dwordx4 v12, s[40:43], s64 offen lds
v_mfma_f32_16x16x32_bf16 v[124:127], a[188:191], a[28:31], v[124:127]
s_add_u32 m0, s86, 132096
ds_read_b64_tr_b16 a[152:153], v205 offset:0
v_mfma_f32_16x16x32_bf16 v[124:127], a[184:187], a[24:27], v[124:127]
s_add_u32 s64, s85, 8192
ds_read_b64_tr_b16 a[154:155], v205 offset:4096
v_mfma_f32_16x16x32_bf16 v[128:131], a[192:195], a[24:27], v[128:131]
buffer_load_dwordx4 v13, s[40:43], s64 offen lds
v_mfma_f32_16x16x32_bf16 v[128:131], a[196:199], a[28:31], v[128:131]
ds_read_b64_tr_b16 a[156:157], v205 offset:8192
v_mfma_f32_16x16x32_bf16 v[96:99], a[196:199], a[20:23], v[96:99]
s_add_u32 m0, s86, 133120
ds_read_b64_tr_b16 a[158:159], v205 offset:12288
v_mfma_f32_16x16x32_bf16 v[96:99], a[192:195], a[16:19], v[96:99]
s_add_u32 s64, s85, 16384
ds_read_b64_tr_b16 a[160:161], v206 offset:0
v_mfma_f32_16x16x32_bf16 v[64:67], a[192:195], a[8:11], v[64:67]
buffer_load_dwordx4 v12, s[40:43], s64 offen lds
v_mfma_f32_16x16x32_bf16 v[64:67], a[196:199], a[12:15], v[64:67]
ds_read_b64_tr_b16 a[162:163], v206 offset:4096
v_mfma_f32_16x16x32_bf16 v[32:35], a[196:199], a[4:7], v[32:35]
s_add_u32 m0, s86, 134144
ds_read_b64_tr_b16 a[164:165], v206 offset:8192
v_mfma_f32_16x16x32_bf16 v[32:35], a[192:195], a[0:3], v[32:35]
s_waitcnt lgkmcnt(5)
s_add_u32 s64, s85, 24576
ds_read_b64_tr_b16 a[166:167], v206 offset:12288
v_mfma_f32_16x16x32_bf16 v[36:39], a[200:203], a[0:3], v[36:39]
buffer_load_dwordx4 v13, s[40:43], s64 offen lds
v_mfma_f32_16x16x32_bf16 v[36:39], a[204:207], a[4:7], v[36:39]
v_mfma_f32_16x16x32_bf16 v[68:71], a[204:207], a[12:15], v[68:71]
s_add_u32 m0, s86, 135168
v_mfma_f32_16x16x32_bf16 v[68:71], a[200:203], a[8:11], v[68:71]
s_add_u32 s64, s85, 32768
v_mfma_f32_16x16x32_bf16 v[100:103], a[200:203], a[16:19], v[100:103]
buffer_load_dwordx4 v12, s[40:43], s64 offen lds
v_mfma_f32_16x16x32_bf16 v[100:103], a[204:207], a[20:23], v[100:103]
v_mfma_f32_16x16x32_bf16 v[132:135], a[204:207], a[28:31], v[132:135]
v_mfma_f32_16x16x32_bf16 v[132:135], a[200:203], a[24:27], v[132:135]
s_waitcnt vmcnt(26)
v_mfma_f32_16x16x32_bf16 v[136:139], a[144:147], a[88:91], v[136:139]
s_waitcnt vmcnt(22)
s_add_u32 m0, s86, 136192
ds_read_b64_tr_b16 a[168:169], v207 offset:0
v_mfma_f32_16x16x32_bf16 v[136:139], a[148:151], a[92:95], v[136:139]
s_add_u32 s64, s85, 40960
ds_read_b64_tr_b16 a[170:171], v207 offset:4096
v_mfma_f32_16x16x32_bf16 v[104:107], a[148:151], a[84:87], v[104:107]
buffer_load_dwordx4 v13, s[40:43], s64 offen lds
v_mfma_f32_16x16x32_bf16 v[104:107], a[144:147], a[80:83], v[104:107]
ds_read_b64_tr_b16 a[172:173], v207 offset:8192
v_mfma_f32_16x16x32_bf16 v[72:75], a[144:147], a[72:75], v[72:75]
ds_read_b64_tr_b16 a[174:175], v207 offset:12288
v_mfma_f32_16x16x32_bf16 v[72:75], a[148:151], a[76:79], v[72:75]
ds_read_b64_tr_b16 a[176:177], v200 offset:0
v_mfma_f32_16x16x32_bf16 v[40:43], a[148:151], a[68:71], v[40:43]
ds_read_b64_tr_b16 a[178:179], v200 offset:4096
v_mfma_f32_16x16x32_bf16 v[40:43], a[144:147], a[64:67], v[40:43]
ds_read_b64_tr_b16 a[180:181], v200 offset:8192
v_mfma_f32_16x16x32_bf16 v[44:47], a[152:155], a[64:67], v[44:47]
s_waitcnt lgkmcnt(6)
s_add_u32 m0, s86, 137216
ds_read_b64_tr_b16 a[182:183], v200 offset:12288
v_mfma_f32_16x16x32_bf16 v[44:47], a[156:159], a[68:71], v[44:47]
s_add_u32 s64, s85, 49152
v_mfma_f32_16x16x32_bf16 v[76:79], a[156:159], a[76:79], v[76:79]
buffer_load_dwordx4 v12, s[40:43], s64 offen lds
v_mfma_f32_16x16x32_bf16 v[76:79], a[152:155], a[72:75], v[76:79]
ds_read_b64_tr_b16 a[184:185], v201 offset:0
v_mfma_f32_16x16x32_bf16 v[108:111], a[152:155], a[80:83], v[108:111]
ds_read_b64_tr_b16 a[186:187], v201 offset:4096
v_mfma_f32_16x16x32_bf16 v[108:111], a[156:159], a[84:87], v[108:111]
ds_read_b64_tr_b16 a[188:189], v201 offset:8192
v_mfma_f32_16x16x32_bf16 v[140:143], a[156:159], a[92:95], v[140:143]
ds_read_b64_tr_b16 a[190:191], v201 offset:12288
v_mfma_f32_16x16x32_bf16 v[140:143], a[152:155], a[88:91], v[140:143]
v_mfma_f32_16x16x32_bf16 v[144:147], a[160:163], a[88:91], v[144:147]
v_mfma_f32_16x16x32_bf16 v[144:147], a[164:167], a[92:95], v[144:147]
s_add_u32 m0, s86, 138240
s_add_u32 s17, s78, L_p5loop-L_pc+0
v_mfma_f32_16x16x32_bf16 v[112:115], a[164:167], a[84:87], v[112:115]
s_add_u32 s64, s85, 57344
buffer_load_dword a252, v16, s[88:91], s17 offen
v_mfma_f32_16x16x32_bf16 v[112:115], a[160:163], a[80:83], v[112:115]
buffer_load_dwordx4 v13, s[40:43], s64 offen lds
v_mfma_f32_16x16x32_bf16 v[80:83], a[160:163], a[72:75], v[80:83]
s_add_u32 s17, s78, L_p5loop-L_pc+4096
ds_read_b64_tr_b16 a[192:193], v202 offset:0
v_mfma_f32_16x16x32_bf16 v[80:83], a[164:167], a[76:79], v[80:83]
buffer_load_dword a252, v16, s[88:91], s17 offen
v_mfma_f32_16x16x32_bf16 v[48:51], a[164:167], a[68:71], v[48:51]
ds_read_b64_tr_b16 a[194:195], v202 offset:4096
v_mfma_f32_16x16x32_bf16 v[48:51], a[160:163], a[64:67], v[48:51]
s_waitcnt lgkmcnt(2)
s_add_u32 s17, s78, L_p5loop-L_pc+8192
ds_read_b64_tr_b16 a[196:197], v202 offset:8192
v_mfma_f32_16x16x32_bf16 v[52:55], a[168:171], a[64:67], v[52:55]
buffer_load_dword a252, v16, s[88:91], s17 offen
v_mfma_f32_16x16x32_bf16 v[52:55], a[172:175], a[68:71], v[52:55]
ds_read_b64_tr_b16 a[198:199], v202 offset:12288
v_mfma_f32_16x16x32_bf16 v[84:87], a[172:175], a[76:79], v[84:87]
ds_read_b64_tr_b16 a[200:201], v203 offset:0
v_mfma_f32_16x16x32_bf16 v[84:87], a[168:171], a[72:75], v[84:87]
ds_read_b64_tr_b16 a[202:203], v203 offset:4096
v_mfma_f32_16x16x32_bf16 v[116:119], a[168:171], a[80:83], v[116:119]
ds_read_b64_tr_b16 a[204:205], v203 offset:8192
v_mfma_f32_16x16x32_bf16 v[116:119], a[172:175], a[84:87], v[116:119]
ds_read_b64_tr_b16 a[206:207], v203 offset:12288
v_mfma_f32_16x16x32_bf16 v[148:151], a[172:175], a[92:95], v[148:151]
buffer_load_dword v19, off, s[52:55], s72 sc1
v_mfma_f32_16x16x32_bf16 v[148:151], a[168:171], a[88:91], v[148:151]
v_mfma_f32_16x16x32_bf16 v[120:123], a[176:179], a[88:91], v[120:123]
v_mfma_f32_16x16x32_bf16 v[120:123], a[180:183], a[92:95], v[120:123]
v_mfma_f32_16x16x32_bf16 v[88:91], a[180:183], a[84:87], v[88:91]
v_mfma_f32_16x16x32_bf16 v[88:91], a[176:179], a[80:83], v[88:91]
v_mfma_f32_16x16x32_bf16 v[56:59], a[176:179], a[72:75], v[56:59]
v_mfma_f32_16x16x32_bf16 v[56:59], a[180:183], a[76:79], v[56:59]
v_mfma_f32_16x16x32_bf16 v[24:27], a[180:183], a[68:71], v[24:27]
v_mfma_f32_16x16x32_bf16 v[24:27], a[176:179], a[64:67], v[24:27]
v_mfma_f32_16x16x32_bf16 v[28:31], a[184:187], a[64:67], v[28:31]
s_waitcnt vmcnt(20)
s_barrier
v_mfma_f32_16x16x32_bf16 v[28:31], a[188:191], a[68:71], v[28:31]
ds_read_b64_tr_b16 a[144:145], v188 offset:0
v_mfma_f32_16x16x32_bf16 v[60:63], a[188:191], a[76:79], v[60:63]
ds_read_b64_tr_b16 a[146:147], v188 offset:4096
v_mfma_f32_16x16x32_bf16 v[60:63], a[184:187], a[72:75], v[60:63]
s_add_u32 m0, s86, 32768
ds_read_b64_tr_b16 a[148:149], v188 offset:8192
v_mfma_f32_16x16x32_bf16 v[92:95], a[184:187], a[80:83], v[92:95]
s_add_u32 s64, s85, 262144
ds_read_b64_tr_b16 a[150:151], v188 offset:12288
v_mfma_f32_16x16x32_bf16 v[92:95], a[188:191], a[84:87], v[92:95]
buffer_load_dwordx4 v12, s[40:43], s64 offen lds
v_mfma_f32_16x16x32_bf16 v[124:127], a[188:191], a[92:95], v[124:127]
s_add_u32 m0, s86, 33792
ds_read_b64_tr_b16 a[152:153], v189 offset:0
v_mfma_f32_16x16x32_bf16 v[124:127], a[184:187], a[88:91], v[124:127]
s_waitcnt lgkmcnt(5)
s_add_u32 s64, s85, 270336
ds_read_b64_tr_b16 a[154:155], v189 offset:4096
v_mfma_f32_16x16x32_bf16 v[128:131], a[192:195], a[88:91], v[128:131]
buffer_load_dwordx4 v13, s[40:43], s64 offen lds
v_mfma_f32_16x16x32_bf16 v[128:131], a[196:199], a[92:95], v[128:131]
s_add_u32 m0, s86, 34816
ds_read_b64_tr_b16 a[156:157], v189 offset:8192
v_mfma_f32_16x16x32_bf16 v[96:99], a[196:199], a[84:87], v[96:99]
s_add_u32 s64, s85, 278528
ds_read_b64_tr_b16 a[158:159], v189 offset:12288
v_mfma_f32_16x16x32_bf16 v[96:99], a[192:195], a[80:83], v[96:99]
buffer_load_dwordx4 v12, s[40:43], s64 offen lds
v_mfma_f32_16x16x32_bf16 v[64:67], a[192:195], a[72:75], v[64:67]
s_add_u32 m0, s86, 35840
ds_read_b64_tr_b16 a[160:161], v190 offset:0
v_mfma_f32_16x16x32_bf16 v[64:67], a[196:199], a[76:79], v[64:67]
s_add_u32 s64, s85, 286720
ds_read_b64_tr_b16 a[162:163], v190 offset:4096
v_mfma_f32_16x16x32_bf16 v[32:35], a[196:199], a[68:71], v[32:35]
buffer_load_dwordx4 v13, s[40:43], s64 offen lds
v_mfma_f32_16x16x32_bf16 v[32:35], a[192:195], a[64:67], v[32:35]
s_add_u32 m0, s86, 36864
ds_read_b64_tr_b16 a[164:165], v190 offset:8192
v_mfma_f32_16x16x32_bf16 v[36:39], a[200:203], a[64:67], v[36:39]
s_add_u32 s64, s85, 294912
ds_read_b64_tr_b16 a[166:167], v190 offset:12288
v_mfma_f32_16x16x32_bf16 v[36:39], a[204:207], a[68:71], v[36:39]
buffer_load_dwordx4 v12, s[40:43], s64 offen lds
v_mfma_f32_16x16x32_bf16 v[68:71], a[204:207], a[76:79], v[68:71]
s_add_u32 m0, s86, 37888
v_mfma_f32_16x16x32_bf16 v[68:71], a[200:203], a[72:75], v[68:71]
s_add_u32 s64, s85, 303104
v_mfma_f32_16x16x32_bf16 v[100:103], a[200:203], a[80:83], v[100:103]
buffer_load_dwordx4 v13, s[40:43], s64 offen lds
v_mfma_f32_16x16x32_bf16 v[100:103], a[204:207], a[84:87], v[100:103]
v_mfma_f32_16x16x32_bf16 v[132:135], a[204:207], a[92:95], v[132:135]
v_mfma_f32_16x16x32_bf16 v[132:135], a[200:203], a[88:91], v[132:135]
s_waitcnt vmcnt(22)
s_waitcnt lgkmcnt(1)
v_mfma_f32_16x16x32_bf16 v[136:139], a[144:147], a[56:59], v[136:139]
s_waitcnt vmcnt(6)
v_readfirstlane_b32 vcc_lo, v19
s_nop 0
s_cmp_lt_u32 vcc_lo, 8
s_cbranch_scc1 L_spin_3019
L_spinbk_3020:
s_sub_u32 s84, s84, 1048576
v_mfma_f32_16x16x32_bf16 v[136:139], a[148:151], a[60:63], v[136:139]
s_add_u32 s65, s84, 0
ds_read_b64_tr_b16 a[168:169], v191 offset:0
v_mfma_f32_16x16x32_bf16 v[104:107], a[148:151], a[52:55], v[104:107]
buffer_load_dwordx4 a[208:211], v14, s[44:47], s65 offen offset:0 sc1
v_mfma_f32_16x16x32_bf16 v[104:107], a[144:147], a[48:51], v[104:107]
ds_read_b64_tr_b16 a[170:171], v191 offset:4096
v_mfma_f32_16x16x32_bf16 v[72:75], a[144:147], a[40:43], v[72:75]
buffer_load_dwordx4 a[216:219], v14, s[44:47], s65 offen offset:1024 sc1
v_mfma_f32_16x16x32_bf16 v[72:75], a[148:151], a[44:47], v[72:75]
ds_read_b64_tr_b16 a[172:173], v191 offset:8192
v_mfma_f32_16x16x32_bf16 v[40:43], a[148:151], a[36:39], v[40:43]
buffer_load_dwordx4 a[224:227], v15, s[44:47], s65 offen offset:0 sc1
v_mfma_f32_16x16x32_bf16 v[40:43], a[144:147], a[32:35], v[40:43]
ds_read_b64_tr_b16 a[174:175], v191 offset:12288
v_mfma_f32_16x16x32_bf16 v[44:47], a[152:155], a[32:35], v[44:47]
buffer_load_dwordx4 a[232:235], v15, s[44:47], s65 offen offset:1024 sc1
v_mfma_f32_16x16x32_bf16 v[44:47], a[156:159], a[36:39], v[44:47]
s_add_u32 s65, s84, 8192
ds_read_b64_tr_b16 a[176:177], v184 offset:0
v_mfma_f32_16x16x32_bf16 v[76:79], a[156:159], a[44:47], v[76:79]
buffer_load_dwordx4 a[212:215], v14, s[44:47], s65 offen offset:0 sc1
v_mfma_f32_16x16x32_bf16 v[76:79], a[152:155], a[40:43], v[76:79]
ds_read_b64_tr_b16 a[178:179], v184 offset:4096
v_mfma_f32_16x16x32_bf16 v[108:111], a[152:155], a[48:51], v[108:111]
buffer_load_dwordx4 a[220:223], v14, s[44:47], s65 offen offset:1024 sc1
v_mfma_f32_16x16x32_bf16 v[108:111], a[156:159], a[52:55], v[108:111]
ds_read_b64_tr_b16 a[180:181], v184 offset:8192
v_mfma_f32_16x16x32_bf16 v[140:143], a[156:159], a[60:63], v[140:143]
buffer_load_dwordx4 a[228:231], v15, s[44:47], s65 offen offset:0 sc1
v_mfma_f32_16x16x32_bf16 v[140:143], a[152:155], a[56:59], v[140:143]
ds_read_b64_tr_b16 a[182:183], v184 offset:12288
v_mfma_f32_16x16x32_bf16 v[144:147], a[160:163], a[56:59], v[144:147]
s_waitcnt lgkmcnt(4)
buffer_load_dwordx4 a[236:239], v15, s[44:47], s65 offen offset:1024 sc1
v_mfma_f32_16x16x32_bf16 v[144:147], a[164:167], a[60:63], v[144:147]
s_add_u32 m0, s86, 38912
s_add_u32 s64, s85, 311296
ds_read_b64_tr_b16 a[184:185], v185 offset:0
v_mfma_f32_16x16x32_bf16 v[112:115], a[164:167], a[52:55], v[112:115]
buffer_load_dwordx4 v12, s[40:43], s64 offen lds
v_mfma_f32_16x16x32_bf16 v[112:115], a[160:163], a[48:51], v[112:115]
s_add_u32 m0, s86, 39936
s_add_u32 s64, s85, 319488
ds_read_b64_tr_b16 a[186:187], v185 offset:4096
v_mfma_f32_16x16x32_bf16 v[80:83], a[160:163], a[40:43], v[80:83]
buffer_load_dwordx4 v13, s[40:43], s64 offen lds
v_mfma_f32_16x16x32_bf16 v[80:83], a[164:167], a[44:47], v[80:83]
s_add_u32 s65, s84, 32768
ds_read_b64_tr_b16 a[188:189], v185 offset:8192
v_mfma_f32_16x16x32_bf16 v[48:51], a[164:167], a[36:39], v[48:51]
buffer_load_dwordx4 v[152:155], v14, s[44:47], s65 offen offset:0 sc1
v_mfma_f32_16x16x32_bf16 v[48:51], a[160:163], a[32:35], v[48:51]
ds_read_b64_tr_b16 a[190:191], v185 offset:12288
v_mfma_f32_16x16x32_bf16 v[52:55], a[168:171], a[32:35], v[52:55]
buffer_load_dwordx4 v[160:163], v14, s[44:47], s65 offen offset:1024 sc1
v_mfma_f32_16x16x32_bf16 v[52:55], a[172:175], a[36:39], v[52:55]
ds_read_b64_tr_b16 a[192:193], v186 offset:0
v_mfma_f32_16x16x32_bf16 v[84:87], a[172:175], a[44:47], v[84:87]
buffer_load_dwordx4 v[168:171], v15, s[44:47], s65 offen offset:0 sc1
v_mfma_f32_16x16x32_bf16 v[84:87], a[168:171], a[40:43], v[84:87]
ds_read_b64_tr_b16 a[194:195], v186 offset:4096
v_mfma_f32_16x16x32_bf16 v[116:119], a[168:171], a[48:51], v[116:119]
buffer_load_dwordx4 v[176:179], v15, s[44:47], s65 offen offset:1024 sc1
v_mfma_f32_16x16x32_bf16 v[116:119], a[172:175], a[52:55], v[116:119]
s_add_u32 s65, s84, 40960
ds_read_b64_tr_b16 a[196:197], v186 offset:8192
v_mfma_f32_16x16x32_bf16 v[148:151], a[172:175], a[60:63], v[148:151]
buffer_load_dwordx4 v[156:159], v14, s[44:47], s65 offen offset:0 sc1
v_mfma_f32_16x16x32_bf16 v[148:151], a[168:171], a[56:59], v[148:151]
s_waitcnt lgkmcnt(3)
ds_read_b64_tr_b16 a[198:199], v186 offset:12288
v_mfma_f32_16x16x32_bf16 v[120:123], a[176:179], a[56:59], v[120:123]
buffer_load_dwordx4 v[164:167], v14, s[44:47], s65 offen offset:1024 sc1
v_mfma_f32_16x16x32_bf16 v[120:123], a[180:183], a[60:63], v[120:123]
ds_read_b64_tr_b16 a[200:201], v187 offset:0
v_mfma_f32_16x16x32_bf16 v[88:91], a[180:183], a[52:55], v[88:91]
buffer_load_dwordx4 v[172:175], v15, s[44:47], s65 offen offset:0 sc1
v_mfma_f32_16x16x32_bf16 v[88:91], a[176:179], a[48:51], v[88:91]
ds_read_b64_tr_b16 a[202:203], v187 offset:4096
v_mfma_f32_16x16x32_bf16 v[56:59], a[176:179], a[40:43], v[56:59]
buffer_load_dwordx4 v[180:183], v15, s[44:47], s65 offen offset:1024 sc1
v_mfma_f32_16x16x32_bf16 v[56:59], a[180:183], a[44:47], v[56:59]
ds_read_b64_tr_b16 a[204:205], v187 offset:8192
v_mfma_f32_16x16x32_bf16 v[24:27], a[180:183], a[36:39], v[24:27]
ds_read_b64_tr_b16 a[206:207], v187 offset:12288
v_mfma_f32_16x16x32_bf16 v[24:27], a[176:179], a[32:35], v[24:27]
v_mfma_f32_16x16x32_bf16 v[28:31], a[184:187], a[32:35], v[28:31]
s_barrier
v_mfma_f32_16x16x32_bf16 v[28:31], a[188:191], a[36:39], v[28:31]
ds_read_b64_tr_b16 a[144:145], v188 offset:32768
v_mfma_f32_16x16x32_bf16 v[60:63], a[188:191], a[44:47], v[60:63]
ds_read_b64_tr_b16 a[146:147], v188 offset:36864
v_mfma_f32_16x16x32_bf16 v[60:63], a[184:187], a[40:43], v[60:63]
s_add_u32 m0, s86, 65536
ds_read_b64_tr_b16 a[148:149], v188 offset:40960
v_mfma_f32_16x16x32_bf16 v[92:95], a[184:187], a[48:51], v[92:95]
s_add_u32 s64, s85, 524288
ds_read_b64_tr_b16 a[150:151], v188 offset:45056
v_mfma_f32_16x16x32_bf16 v[92:95], a[188:191], a[52:55], v[92:95]
buffer_load_dwordx4 v12, s[40:43], s64 offen lds
v_mfma_f32_16x16x32_bf16 v[124:127], a[188:191], a[60:63], v[124:127]
s_add_u32 m0, s86, 66560
ds_read_b64_tr_b16 a[152:153], v189 offset:32768
v_mfma_f32_16x16x32_bf16 v[124:127], a[184:187], a[56:59], v[124:127]
s_waitcnt lgkmcnt(5)
s_add_u32 s64, s85, 532480
ds_read_b64_tr_b16 a[154:155], v189 offset:36864
v_mfma_f32_16x16x32_bf16 v[128:131], a[192:195], a[56:59], v[128:131]
buffer_load_dwordx4 v13, s[40:43], s64 offen lds
v_mfma_f32_16x16x32_bf16 v[128:131], a[196:199], a[60:63], v[128:131]
ds_read_b64_tr_b16 a[156:157], v189 offset:40960
v_mfma_f32_16x16x32_bf16 v[96:99], a[196:199], a[52:55], v[96:99]
s_add_u32 m0, s86, 67584
ds_read_b64_tr_b16 a[158:159], v189 offset:45056
v_mfma_f32_16x16x32_bf16 v[96:99], a[192:195], a[48:51], v[96:99]
s_add_u32 s64, s85, 540672
ds_read_b64_tr_b16 a[160:161], v190 offset:32768
v_mfma_f32_16x16x32_bf16 v[64:67], a[192:195], a[40:43], v[64:67]
buffer_load_dwordx4 v12, s[40:43], s64 offen lds
v_mfma_f32_16x16x32_bf16 v[64:67], a[196:199], a[44:47], v[64:67]
ds_read_b64_tr_b16 a[162:163], v190 offset:36864
v_mfma_f32_16x16x32_bf16 v[32:35], a[196:199], a[36:39], v[32:35]
s_add_u32 m0, s86, 68608
ds_read_b64_tr_b16 a[164:165], v190 offset:40960
v_mfma_f32_16x16x32_bf16 v[32:35], a[192:195], a[32:35], v[32:35]
s_add_u32 s64, s85, 548864
ds_read_b64_tr_b16 a[166:167], v190 offset:45056
v_mfma_f32_16x16x32_bf16 v[36:39], a[200:203], a[32:35], v[36:39]
buffer_load_dwordx4 v13, s[40:43], s64 offen lds
v_mfma_f32_16x16x32_bf16 v[36:39], a[204:207], a[36:39], v[36:39]
v_mfma_f32_16x16x32_bf16 v[68:71], a[204:207], a[44:47], v[68:71]
s_add_u32 m0, s86, 69632
v_mfma_f32_16x16x32_bf16 v[68:71], a[200:203], a[40:43], v[68:71]
s_add_u32 s64, s85, 557056
v_mfma_f32_16x16x32_bf16 v[100:103], a[200:203], a[48:51], v[100:103]
buffer_load_dwordx4 v12, s[40:43], s64 offen lds
v_mfma_f32_16x16x32_bf16 v[100:103], a[204:207], a[52:55], v[100:103]
s_mov_b32 s70, 3
s_mov_b32 s73, 2
v_mfma_f32_16x16x32_bf16 v[132:135], a[204:207], a[60:63], v[132:135]
v_mfma_f32_16x16x32_bf16 v[132:135], a[200:203], a[56:59], v[132:135]
s_branch L_p5join
L_spin_4022:
s_mov_b32 vcc_hi, 0x80000
L_spinlp_4024:
s_sleep 1
buffer_load_dword v19, off, s[52:55], s72 offset:128 sc1
s_waitcnt vmcnt(0)
v_readfirstlane_b32 vcc_lo, v19
s_sub_u32 vcc_hi, vcc_hi, 1
s_cbranch_scc1 L_spinbk_4023
s_cmp_lt_u32 vcc_lo, s74
s_cbranch_scc1 L_spinlp_4024
s_branch L_spinbk_4023
L_xretry:
s_sub_u32 s72, s72, 1
s_cbranch_scc1 L_xgo
buffer_load_dwordx4 v[152:155], v16, s[44:47], s75 offen offset:0 sc1
buffer_load_dwordx4 v[156:159], v16, s[44:47], s75 offen offset:1024 sc1
buffer_load_dwordx4 v[160:163], v16, s[44:47], s75 offen offset:2048 sc1
buffer_load_dwordx4 v[164:167], v16, s[44:47], s75 offen offset:3072 sc1
s_branch L_xchk
L_codeend:
.section .rodata,"a"
.p2align 6
.amdhsa_kernel gated_mix__compressed_kv_cla__sliding_local_dilated__prompt_kernel
  .amdhsa_next_free_vgpr 512
  .amdhsa_next_free_sgpr 102
  .amdhsa_accum_offset 256
  .amdhsa_group_segment_fixed_size 0
  .amdhsa_kernarg_size 104
  .amdhsa_user_sgpr_count 2
  .amdhsa_user_sgpr_kernarg_segment_ptr 1
  .amdhsa_system_sgpr_workgroup_id_x 1
.end_amdhsa_kernel
```

```asm
; @launch grid=(256,1,1) block=(256,1,1) lds=163840
.amdgcn_target "amdgcn-amd-amdhsa--gfx950"
.text
.globl gated_mix__compressed_kv_cla__sliding_local_dilated__prompt_kernel
.p2align 8
.type gated_mix__compressed_kv_cla__sliding_local_dilated__prompt_kernel,@function
gated_mix__compressed_kv_cla__sliding_local_dilated__prompt_kernel:
s_cmp_ge_u32 s2, 256
s_cbranch_scc1 L_end
s_load_dwordx16 s[4:19], s[0:1], 0
s_load_dwordx8 s[20:27], s[0:1], 64
s_load_dwordx2 s[28:29], s[0:1], 96
s_getpc_b64 s[88:89]
L_pc:
v_lshrrev_b32 v1, 6, v0
s_lshr_b32 s67, s2, 3
v_lshl_add_u32 v24, s67, 2, v1
s_mov_b32 s90, L_codeend-L_pc
s_mov_b32 s91, 0x20000
v_and_b32 v25, 7, v0
v_lshlrev_b32 v25, 7, v25
v_lshl_add_u32 v24, v24, 10, v25
buffer_load_dword a252, v24, s[88:91], 0 offen
v_and_b32 v0, 63, v0
v_readfirstlane_b32 s30, v1
v_lshrrev_b32 v24, 3, v0
v_lshrrev_b32 v25, 4, v0
v_and_b32 v26, 7, v0
v_xor_b32 v26, v26, v25
v_lshlrev_b32 v26, 4, v26
v_lshl_add_u32 v12, v24, 10, v26
v_xor_b32 v13, 64, v12
v_bfe_u32 v26, v0, 1, 3
v_xor_b32 v26, v26, v25
v_lshlrev_b32 v26, 5, v26
v_and_b32 v24, 1, v0
v_lshl_add_u32 v26, v24, 4, v26
v_lshl_add_u32 v14, v25, 13, v26
v_xor_b32 v15, 128, v14
s_and_b32 s66, s2, 7
s_and_b32 s68, s67, 3
s_lshl2_add_u32 s31, s66, s68
s_cmp_eq_u32 s68, 0
s_cselect_b32 s90, s90, 0
s_lshr_b32 s3, s67, 2
s_lshl2_add_u32 s80, s67, s30
s_lshl_b32 s70, s3, 18
s_lshl_b32 s66, s30, 16
s_add_u32 s70, s70, s66
s_lshl_b32 s71, s30, 17
s_lshl_b32 s66, s31, 8
s_add_u32 s71, s71, s66
s_lshl_b32 s76, s30, 13
s_lshl_b32 s77, s30, 12
s_lshl_b32 s78, s30, 10
s_waitcnt lgkmcnt(0)
s_mov_b32 s32, s6
s_mov_b32 s33, s7
s_mov_b32 s34, 2097152
s_mov_b32 s35, 0x20000
s_mov_b32 s36, s10
s_mov_b32 s37, s11
s_mov_b32 s38, 4194304
s_mov_b32 s39, 0x20000
s_mov_b32 s40, s12
s_mov_b32 s41, s13
s_mov_b32 s42, 4194304
s_mov_b32 s43, 0x20000
s_add_u32 m0, s76, 0
s_add_u32 s64, s70, 0
buffer_load_dwordx4 v12, s[32:35], s64 offen lds
s_add_u32 m0, s76, 1024
s_add_u32 s64, s70, 8192
buffer_load_dwordx4 v13, s[32:35], s64 offen lds
s_add_u32 m0, s76, 2048
s_add_u32 s64, s70, 16384
buffer_load_dwordx4 v12, s[32:35], s64 offen lds
s_add_u32 m0, s76, 3072
s_add_u32 s64, s70, 24576
buffer_load_dwordx4 v13, s[32:35], s64 offen lds
s_add_u32 m0, s77, 65536
s_add_u32 s64, s71, 0
buffer_load_dwordx4 v14, s[36:39], s64 offen lds
s_add_u32 m0, s77, 66560
s_add_u32 s64, s71, 32768
buffer_load_dwordx4 v14, s[36:39], s64 offen lds
s_add_u32 m0, s77, 67584
s_add_u32 s64, s71, 65536
buffer_load_dwordx4 v15, s[36:39], s64 offen lds
s_add_u32 m0, s77, 68608
s_add_u32 s64, s71, 98304
buffer_load_dwordx4 v15, s[36:39], s64 offen lds
s_mov_b32 s44, s28
s_mov_b32 s45, s29
s_mov_b32 s46, 134217728
s_mov_b32 s47, 0x20000
s_mov_b32 s48, s4
s_mov_b32 s49, s5
s_mov_b32 s50, 4194304
s_mov_b32 s51, 0x20000
s_mov_b32 s52, s26
s_mov_b32 s53, s27
s_mov_b32 s54, 256
s_mov_b32 s55, 0x20000
s_mov_b32 s56, s8
s_mov_b32 s57, s9
s_mov_b32 s58, 8388608
s_mov_b32 s59, 0x20000
s_mov_b32 s60, s18
s_mov_b32 s61, s19
s_mov_b32 s62, 6291456
s_mov_b32 s63, 0x20000
v_accvgpr_write_b32 a251, 1
v_and_b32 v24, 15, v0
v_lshrrev_b32 v26, 1, v24
v_xor_b32 v26, v26, v25
v_lshlrev_b32 v26, 4, v26
v_lshl_add_u32 v26, v24, 7, v26
v_add_u32 v2, s76, v26
v_xor_b32 v3, 64, v2
v_bfe_u32 v24, v0, 2, 2
v_lshl_add_u32 v27, v25, 3, v24
v_and_b32 v1, 3, v0
v_cmp_eq_u32 vcc, 0, v1
v_lshlrev_b32 v1, 3, v1
v_lshl_add_u32 v26, v27, 8, v1
v_add_u32 v26, 65536, v26
v_and_b32 v1, 1, v25
v_lshl_add_u32 v24, v1, 2, v24
v_lshlrev_b32 v16, 4, v0
v_mov_b32 v28, 0x3f803f80
v_cndmask_b32 v28, 0, v28, vcc
v_accvgpr_write_b32 a244, v28
v_accvgpr_write_b32 a245, v28
v_accvgpr_write_b32 a246, v28
v_accvgpr_write_b32 a247, v28
v_xor_b32 v1, 0, v24
v_lshl_add_u32 v4, v1, 5, v26
v_xor_b32 v1, 1, v24
v_lshl_add_u32 v5, v1, 5, v26
v_xor_b32 v1, 2, v24
v_lshl_add_u32 v6, v1, 5, v26
v_xor_b32 v1, 3, v24
v_lshl_add_u32 v7, v1, 5, v26
v_xor_b32 v1, 4, v24
v_lshl_add_u32 v8, v1, 5, v26
v_xor_b32 v1, 5, v24
v_lshl_add_u32 v9, v1, 5, v26
v_xor_b32 v1, 6, v24
v_lshl_add_u32 v10, v1, 5, v26
v_xor_b32 v1, 7, v24
v_lshl_add_u32 v11, v1, 5, v26
s_sub_u32 s16, 15, s3
s_lshl_b32 s72, s3, 18
s_lshl_b32 s73, s16, 18
s_cmp_lt_u32 s30, 2
s_cselect_b32 s67, s3, s16
s_lshl4_add_u32 s74, s31, s67
s_and_b32 s66, s30, 1
s_lshl1_add_u32 s74, s74, s66
s_lshl_b32 s74, s74, 10
s_add_u32 s74, s74, 60817408
s_lshl_b32 s66, s30, 15
s_add_u32 s72, s72, s66
s_add_u32 s73, s73, s66
s_mul_i32 s75, s30, 98304
s_lshl_b32 s66, s31, 6
s_add_u32 s75, s75, s66
s_lshl_b32 s79, s31, 20
s_lshl_b32 s66, s3, 17
s_add_u32 s79, s79, s66
s_lshl_b32 s66, s30, 15
s_add_u32 s79, s79, s66
v_bfe_u32 v23, v0, 1, 1
v_lshrrev_b32 v1, 5, v0
v_xor_b32 v23, v23, v1
v_lshlrev_b32 v23, 5, v23
v_and_b32 v1, 1, v0
v_lshl_add_u32 v23, v1, 4, v23
v_lshrrev_b32 v1, 2, v0
v_mul_u32_u24 v1, 6144, v1
v_add_u32 v23, v1, v23
s_lshl_b32 s81, s80, 13
s_and_b32 s67, s2, 7
s_lshl_b32 s82, s67, 8
s_add_u32 s82, s82, s81
s_lshl_b32 s67, s67, 10
s_add_u32 s81, s81, s67
s_add_u32 s83, s81, 1048576
v_mul_u32_u24 v1, 1792, v25
v_add_u32 v1, v1, v16
s_lshl_b32 s68, s2, 3
s_lshl1_add_u32 s68, s30, s68
v_lshrrev_b32 v18, 5, v0
v_add_u32 v18, s68, v18
v_and_b32 v19, 31, v0
v_lshlrev_b32 v19, 4, v19
v_lshl_add_u32 v18, v18, 11, v19
v_mov_b32 v21, 0
v_min_u32 v20, 1, v0
v_lshlrev_b32 v20, 30, v20
v_accvgpr_write_b32 a240, -1
v_accvgpr_write_b32 a241, -1
v_accvgpr_write_b32 a242, -1
v_accvgpr_write_b32 a243, -1
s_lshr_b32 s69, s2, 7
s_or_b32 s69, s69, s30
s_lshl_b32 s69, s69, 21
s_add_u32 s69, s69, s2
s_lshl_b32 s69, s69, 7
s_add_u32 s69, s69, 59768832
s_add_u32 m0, s76, 4096
s_add_u32 s64, s70, 32768
buffer_load_dwordx4 v12, s[32:35], s64 offen lds
s_add_u32 m0, s76, 5120
s_add_u32 s64, s70, 40960
buffer_load_dwordx4 v13, s[32:35], s64 offen lds
s_add_u32 m0, s76, 6144
s_add_u32 s64, s70, 49152
buffer_load_dwordx4 v12, s[32:35], s64 offen lds
s_add_u32 m0, s76, 7168
s_add_u32 s64, s70, 57344
buffer_load_dwordx4 v13, s[32:35], s64 offen lds
s_add_u32 m0, s77, 81920
s_add_u32 s64, s71, 0
buffer_load_dwordx4 v14, s[40:43], s64 offen lds
s_add_u32 m0, s77, 82944
s_add_u32 s64, s71, 32768
buffer_load_dwordx4 v14, s[40:43], s64 offen lds
s_add_u32 m0, s77, 83968
s_add_u32 s64, s71, 65536
buffer_load_dwordx4 v15, s[40:43], s64 offen lds
s_add_u32 m0, s77, 84992
s_add_u32 s64, s71, 98304
buffer_load_dwordx4 v15, s[40:43], s64 offen lds
s_waitcnt vmcnt(8)
s_barrier
ds_read_b128 a[0:3], v2 offset:0
ds_read_b128 a[4:7], v3 offset:0
ds_read_b64_tr_b16 a[176:177], v4 offset:0
ds_read_b64_tr_b16 a[178:179], v4 offset:1024
ds_read_b64_tr_b16 a[180:181], v4 offset:8192
ds_read_b64_tr_b16 a[182:183], v4 offset:9216
ds_read_b128 a[8:11], v2 offset:2048
ds_read_b128 a[12:15], v3 offset:2048
ds_read_b64_tr_b16 a[184:185], v5 offset:0
ds_read_b64_tr_b16 a[186:187], v5 offset:1024
ds_read_b64_tr_b16 a[188:189], v5 offset:8192
ds_read_b64_tr_b16 a[190:191], v5 offset:9216
ds_read_b64_tr_b16 a[88:89], v6 offset:0
ds_read_b64_tr_b16 a[90:91], v6 offset:1024
ds_read_b64_tr_b16 a[92:93], v6 offset:8192
ds_read_b64_tr_b16 a[94:95], v6 offset:9216
s_waitcnt lgkmcnt(12)
v_mfma_f32_16x16x32_bf16 v[184:187], a[176:179], a[0:3], 0
s_waitcnt lgkmcnt(10)
s_add_u32 m0, s77, 98304
ds_read_b64_tr_b16 a[96:97], v7 offset:0
v_mfma_f32_16x16x32_bf16 v[184:187], a[180:183], a[4:7], v[184:187]
s_waitcnt lgkmcnt(9)
s_add_u32 s64, s71, 524288
ds_read_b64_tr_b16 a[98:99], v7 offset:1024
v_mfma_f32_16x16x32_bf16 v[192:195], a[180:183], a[12:15], 0
buffer_load_dwordx4 v14, s[36:39], s64 offen lds
v_mfma_f32_16x16x32_bf16 v[192:195], a[176:179], a[8:11], v[192:195]
s_waitcnt lgkmcnt(8)
ds_read_b64_tr_b16 a[100:101], v7 offset:8192
v_mfma_f32_16x16x32_bf16 v[196:199], a[184:187], a[8:11], 0
s_waitcnt lgkmcnt(7)
s_add_u32 m0, s77, 99328
ds_read_b64_tr_b16 a[102:103], v7 offset:9216
v_mfma_f32_16x16x32_bf16 v[196:199], a[188:191], a[12:15], v[196:199]
s_add_u32 s64, s71, 557056
ds_read_b64_tr_b16 a[104:105], v8 offset:0
v_mfma_f32_16x16x32_bf16 v[188:191], a[188:191], a[4:7], 0
buffer_load_dwordx4 v14, s[36:39], s64 offen lds
v_mfma_f32_16x16x32_bf16 v[188:191], a[184:187], a[0:3], v[188:191]
s_waitcnt lgkmcnt(7)
ds_read_b64_tr_b16 a[106:107], v8 offset:1024
v_mfma_f32_16x16x32_bf16 v[216:219], a[88:91], a[0:3], 0
s_waitcnt lgkmcnt(6)
s_add_u32 m0, s77, 100352
ds_read_b64_tr_b16 a[108:109], v8 offset:8192
v_mfma_f32_16x16x32_bf16 v[216:219], a[92:95], a[4:7], v[216:219]
s_add_u32 s64, s71, 589824
ds_read_b64_tr_b16 a[110:111], v8 offset:9216
v_mfma_f32_16x16x32_bf16 v[224:227], a[92:95], a[12:15], 0
buffer_load_dwordx4 v15, s[36:39], s64 offen lds
v_mfma_f32_16x16x32_bf16 v[224:227], a[88:91], a[8:11], v[224:227]
s_waitcnt lgkmcnt(6)
ds_read_b64_tr_b16 a[112:113], v9 offset:0
v_mfma_f32_16x16x32_bf16 v[228:231], a[96:99], a[8:11], 0
s_waitcnt lgkmcnt(5)
ds_read_b64_tr_b16 a[114:115], v9 offset:1024
v_mfma_f32_16x16x32_bf16 v[228:231], a[100:103], a[12:15], v[228:231]
s_add_u32 m0, s77, 101376
ds_read_b64_tr_b16 a[116:117], v9 offset:8192
v_mfma_f32_16x16x32_bf16 v[220:223], a[100:103], a[4:7], 0
s_add_u32 s64, s71, 622592
ds_read_b64_tr_b16 a[118:119], v9 offset:9216
v_mfma_f32_16x16x32_bf16 v[220:223], a[96:99], a[0:3], v[220:223]
s_waitcnt lgkmcnt(6)
buffer_load_dwordx4 v15, s[36:39], s64 offen lds
v_mfma_f32_16x16x32_bf16 v[152:155], a[104:107], a[0:3], 0
s_waitcnt lgkmcnt(4)
ds_read_b64_tr_b16 a[72:73], v10 offset:0
v_mfma_f32_16x16x32_bf16 v[152:155], a[108:111], a[4:7], v[152:155]
s_add_u32 m0, s77, 114688
ds_read_b64_tr_b16 a[74:75], v10 offset:1024
v_mfma_f32_16x16x32_bf16 v[160:163], a[108:111], a[12:15], 0
s_add_u32 s64, s71, 524288
ds_read_b64_tr_b16 a[76:77], v10 offset:8192
ds_read_b64_tr_b16 a[78:79], v10 offset:9216
v_mfma_f32_16x16x32_bf16 v[160:163], a[104:107], a[8:11], v[160:163]
s_waitcnt lgkmcnt(6)
buffer_load_dwordx4 v14, s[40:43], s64 offen lds
v_mfma_f32_16x16x32_bf16 v[164:167], a[112:115], a[8:11], 0
s_waitcnt lgkmcnt(4)
s_add_u32 m0, s77, 115712
ds_read_b64_tr_b16 a[80:81], v11 offset:0
v_mfma_f32_16x16x32_bf16 v[164:167], a[116:119], a[12:15], v[164:167]
s_add_u32 s64, s71, 557056
ds_read_b64_tr_b16 a[82:83], v11 offset:1024
v_mfma_f32_16x16x32_bf16 v[156:159], a[116:119], a[4:7], 0
ds_read_b64_tr_b16 a[84:85], v11 offset:8192
ds_read_b64_tr_b16 a[86:87], v11 offset:9216
s_waitcnt vmcnt(9)
v_mfma_f32_16x16x32_bf16 v[156:159], a[112:115], a[0:3], v[156:159]
s_waitcnt lgkmcnt(6)
buffer_load_dwordx4 v14, s[40:43], s64 offen lds
v_mfma_f32_16x16x32_bf16 v[24:27], a[72:75], a[0:3], 0
s_waitcnt lgkmcnt(4)
s_add_u32 m0, s77, 116736
ds_read_b128 a[16:19], v2 offset:4096
ds_read_b128 a[20:23], v3 offset:4096
v_mfma_f32_16x16x32_bf16 v[24:27], a[76:79], a[4:7], v[24:27]
s_add_u32 s64, s71, 589824
ds_read_b128 a[24:27], v2 offset:6144
ds_read_b128 a[28:31], v3 offset:6144
v_mfma_f32_16x16x32_bf16 v[40:43], a[76:79], a[12:15], 0
s_add_u32 s17, s78, .-L_pc+6144
buffer_load_dwordx4 v15, s[40:43], s64 offen lds
v_mfma_f32_16x16x32_bf16 v[40:43], a[72:75], a[8:11], v[40:43]
s_waitcnt lgkmcnt(6)
buffer_load_dword a252, v16, s[88:91], s17 offen
v_mfma_f32_16x16x32_bf16 v[104:107], a[80:83], a[8:11], 0
s_waitcnt lgkmcnt(4)
s_add_u32 m0, s77, 117760
v_mfma_f32_16x16x32_bf16 v[104:107], a[84:87], a[12:15], v[104:107]
s_add_u32 s64, s71, 622592
v_mfma_f32_16x16x32_bf16 v[88:91], a[84:87], a[4:7], 0
buffer_load_dwordx4 v15, s[40:43], s64 offen lds
v_mfma_f32_16x16x32_bf16 v[88:91], a[80:83], a[0:3], v[88:91]
s_waitcnt lgkmcnt(3)
v_mfma_f32_16x16x32_bf16 v[232:235], a[88:91], a[16:19], 0
s_waitcnt lgkmcnt(2)
v_mfma_f32_16x16x32_bf16 v[232:235], a[92:95], a[20:23], v[232:235]
s_waitcnt lgkmcnt(0)
s_add_u32 m0, s76, 32768
v_mfma_f32_16x16x32_bf16 v[240:243], a[92:95], a[28:31], 0
s_add_u32 s64, s70, 128
v_mfma_f32_16x16x32_bf16 v[240:243], a[88:91], a[24:27], v[240:243]
buffer_load_dwordx4 v12, s[32:35], s64 offen lds
v_mfma_f32_16x16x32_bf16 v[244:247], a[96:99], a[24:27], 0
s_add_u32 m0, s76, 33792
v_mfma_f32_16x16x32_bf16 v[244:247], a[100:103], a[28:31], v[244:247]
s_add_u32 s64, s70, 8320
v_mfma_f32_16x16x32_bf16 v[236:239], a[100:103], a[20:23], 0
s_waitcnt vmcnt(10)
s_barrier
v_mfma_f32_16x16x32_bf16 v[236:239], a[96:99], a[16:19], v[236:239]
buffer_load_dwordx4 v13, s[32:35], s64 offen lds
v_mfma_f32_16x16x32_bf16 v[168:171], a[104:107], a[16:19], 0
ds_read_b64_tr_b16 a[88:89], v4 offset:16384
v_mfma_f32_16x16x32_bf16 v[168:171], a[108:111], a[20:23], v[168:171]
s_add_u32 m0, s76, 34816
ds_read_b64_tr_b16 a[90:91], v4 offset:17408
v_mfma_f32_16x16x32_bf16 v[176:179], a[108:111], a[28:31], 0
s_add_u32 s64, s70, 16512
ds_read_b64_tr_b16 a[92:93], v4 offset:24576
v_mfma_f32_16x16x32_bf16 v[176:179], a[104:107], a[24:27], v[176:179]
buffer_load_dwordx4 v12, s[32:35], s64 offen lds
v_mfma_f32_16x16x32_bf16 v[180:183], a[112:115], a[24:27], 0
ds_read_b64_tr_b16 a[94:95], v4 offset:25600
v_mfma_f32_16x16x32_bf16 v[180:183], a[116:119], a[28:31], v[180:183]
s_add_u32 m0, s76, 35840
ds_read_b64_tr_b16 a[96:97], v5 offset:16384
v_mfma_f32_16x16x32_bf16 v[172:175], a[116:119], a[20:23], 0
s_add_u32 s64, s70, 24704
ds_read_b64_tr_b16 a[98:99], v5 offset:17408
v_mfma_f32_16x16x32_bf16 v[172:175], a[112:115], a[16:19], v[172:175]
buffer_load_dwordx4 v13, s[32:35], s64 offen lds
v_mfma_f32_16x16x32_bf16 v[56:59], a[72:75], a[16:19], 0
ds_read_b64_tr_b16 a[100:101], v5 offset:24576
v_mfma_f32_16x16x32_bf16 v[56:59], a[76:79], a[20:23], v[56:59]
s_add_u32 m0, s76, 36864
ds_read_b64_tr_b16 a[102:103], v5 offset:25600
v_mfma_f32_16x16x32_bf16 v[72:75], a[76:79], a[28:31], 0
s_add_u32 s64, s70, 32896
ds_read_b64_tr_b16 a[104:105], v6 offset:16384
v_mfma_f32_16x16x32_bf16 v[72:75], a[72:75], a[24:27], v[72:75]
buffer_load_dwordx4 v12, s[32:35], s64 offen lds
v_mfma_f32_16x16x32_bf16 v[136:139], a[80:83], a[24:27], 0
ds_read_b64_tr_b16 a[106:107], v6 offset:17408
v_mfma_f32_16x16x32_bf16 v[136:139], a[84:87], a[28:31], v[136:139]
s_add_u32 m0, s76, 37888
ds_read_b64_tr_b16 a[108:109], v6 offset:24576
v_mfma_f32_16x16x32_bf16 v[120:123], a[84:87], a[20:23], 0
s_add_u32 s64, s70, 41088
ds_read_b64_tr_b16 a[110:111], v6 offset:25600
v_mfma_f32_16x16x32_bf16 v[120:123], a[80:83], a[16:19], v[120:123]
buffer_load_dwordx4 v13, s[32:35], s64 offen lds
v_mfma_f32_16x16x32_bf16 v[200:203], a[176:179], a[16:19], 0
ds_read_b64_tr_b16 a[112:113], v7 offset:16384
v_mfma_f32_16x16x32_bf16 v[200:203], a[180:183], a[20:23], v[200:203]
s_add_u32 m0, s76, 38912
ds_read_b64_tr_b16 a[114:115], v7 offset:17408
v_mfma_f32_16x16x32_bf16 v[208:211], a[180:183], a[28:31], 0
s_add_u32 s64, s70, 49280
ds_read_b64_tr_b16 a[116:117], v7 offset:24576
v_mfma_f32_16x16x32_bf16 v[208:211], a[176:179], a[24:27], v[208:211]
buffer_load_dwordx4 v12, s[32:35], s64 offen lds
v_mfma_f32_16x16x32_bf16 v[212:215], a[184:187], a[24:27], 0
ds_read_b64_tr_b16 a[118:119], v7 offset:25600
v_mfma_f32_16x16x32_bf16 v[212:215], a[188:191], a[28:31], v[212:215]
s_add_u32 m0, s76, 39936
ds_read_b64_tr_b16 a[72:73], v8 offset:16384
v_mfma_f32_16x16x32_bf16 v[204:207], a[188:191], a[20:23], 0
s_add_u32 s64, s70, 57472
ds_read_b64_tr_b16 a[74:75], v8 offset:17408
v_mfma_f32_16x16x32_bf16 v[204:207], a[184:187], a[16:19], v[204:207]
s_waitcnt lgkmcnt(7)
buffer_load_dwordx4 v13, s[32:35], s64 offen lds
v_mfma_f32_16x16x32_bf16 v[28:31], a[0:3], a[88:91], 0
ds_read_b64_tr_b16 a[76:77], v8 offset:24576
v_mfma_f32_16x16x32_bf16 v[28:31], a[4:7], a[92:95], v[28:31]
ds_read_b64_tr_b16 a[78:79], v8 offset:25600
v_mfma_f32_16x16x32_bf16 v[44:47], a[12:15], a[92:95], 0
ds_read_b64_tr_b16 a[80:81], v9 offset:16384
v_mfma_f32_16x16x32_bf16 v[44:47], a[8:11], a[88:91], v[44:47]
ds_read_b64_tr_b16 a[82:83], v9 offset:17408
v_mfma_f32_16x16x32_bf16 v[60:63], a[16:19], a[88:91], 0
s_add_u32 m0, s77, 131072
ds_read_b64_tr_b16 a[84:85], v9 offset:24576
v_mfma_f32_16x16x32_bf16 v[60:63], a[20:23], a[92:95], v[60:63]
s_add_u32 s64, s71, 1048576
ds_read_b64_tr_b16 a[86:87], v9 offset:25600
v_mfma_f32_16x16x32_bf16 v[76:79], a[28:31], a[92:95], 0
buffer_load_dwordx4 v14, s[36:39], s64 offen lds
v_mfma_f32_16x16x32_bf16 v[76:79], a[24:27], a[88:91], v[76:79]
s_add_u32 m0, s77, 132096
ds_read_b64_tr_b16 a[88:89], v10 offset:16384
v_mfma_f32_16x16x32_bf16 v[140:143], a[24:27], a[96:99], 0
s_add_u32 s64, s71, 1081344
ds_read_b64_tr_b16 a[90:91], v10 offset:17408
v_mfma_f32_16x16x32_bf16 v[140:143], a[28:31], a[100:103], v[140:143]
buffer_load_dwordx4 v14, s[36:39], s64 offen lds
v_mfma_f32_16x16x32_bf16 v[124:127], a[20:23], a[100:103], 0
ds_read_b64_tr_b16 a[92:93], v10 offset:24576
v_mfma_f32_16x16x32_bf16 v[124:127], a[16:19], a[96:99], v[124:127]
s_add_u32 m0, s77, 133120
ds_read_b64_tr_b16 a[94:95], v10 offset:25600
v_mfma_f32_16x16x32_bf16 v[108:111], a[8:11], a[96:99], 0
s_add_u32 s64, s71, 1114112
v_mfma_f32_16x16x32_bf16 v[108:111], a[12:15], a[100:103], v[108:111]
buffer_load_dwordx4 v15, s[36:39], s64 offen lds
v_mfma_f32_16x16x32_bf16 v[92:95], a[4:7], a[100:103], 0
v_mfma_f32_16x16x32_bf16 v[92:95], a[0:3], a[96:99], v[92:95]
s_add_u32 m0, s77, 134144
ds_read_b64_tr_b16 a[96:97], v11 offset:16384
v_mfma_f32_16x16x32_bf16 v[32:35], a[0:3], a[104:107], 0
s_waitcnt lgkmcnt(5)
s_add_u32 s64, s71, 1146880
ds_read_b64_tr_b16 a[98:99], v11 offset:17408
v_mfma_f32_16x16x32_bf16 v[32:35], a[4:7], a[108:111], v[32:35]
buffer_load_dwordx4 v15, s[36:39], s64 offen lds
v_mfma_f32_16x16x32_bf16 v[48:51], a[12:15], a[108:111], 0
ds_read_b64_tr_b16 a[100:101], v11 offset:24576
v_mfma_f32_16x16x32_bf16 v[48:51], a[8:11], a[104:107], v[48:51]
s_add_u32 m0, s77, 147456
ds_read_b64_tr_b16 a[102:103], v11 offset:25600
v_mfma_f32_16x16x32_bf16 v[64:67], a[16:19], a[104:107], 0
s_add_u32 s64, s71, 1048576
v_mfma_f32_16x16x32_bf16 v[64:67], a[20:23], a[108:111], v[64:67]
buffer_load_dwordx4 v14, s[40:43], s64 offen lds
v_mfma_f32_16x16x32_bf16 v[80:83], a[28:31], a[108:111], 0
s_add_u32 m0, s77, 148480
v_mfma_f32_16x16x32_bf16 v[80:83], a[24:27], a[104:107], v[80:83]
s_add_u32 s64, s71, 1081344
v_mfma_f32_16x16x32_bf16 v[144:147], a[24:27], a[112:115], 0
buffer_load_dwordx4 v14, s[40:43], s64 offen lds
v_mfma_f32_16x16x32_bf16 v[144:147], a[28:31], a[116:119], v[144:147]
v_mfma_f32_16x16x32_bf16 v[128:131], a[20:23], a[116:119], 0
s_add_u32 m0, s77, 149504
v_mfma_f32_16x16x32_bf16 v[128:131], a[16:19], a[112:115], v[128:131]
s_add_u32 s64, s71, 1114112
v_mfma_f32_16x16x32_bf16 v[112:115], a[8:11], a[112:115], 0
buffer_load_dwordx4 v15, s[40:43], s64 offen lds
v_mfma_f32_16x16x32_bf16 v[112:115], a[12:15], a[116:119], v[112:115]
v_mfma_f32_16x16x32_bf16 v[96:99], a[4:7], a[116:119], 0
s_add_u32 m0, s77, 150528
v_mfma_f32_16x16x32_bf16 v[96:99], a[0:3], a[112:115], v[96:99]
s_add_u32 s64, s71, 1146880
v_mfma_f32_16x16x32_bf16 v[36:39], a[0:3], a[72:75], 0
buffer_load_dwordx4 v15, s[40:43], s64 offen lds
v_mfma_f32_16x16x32_bf16 v[36:39], a[4:7], a[76:79], v[36:39]
s_add_u32 m0, s76, 0
v_mfma_f32_16x16x32_bf16 v[52:55], a[12:15], a[76:79], 0
s_waitcnt vmcnt(16) lgkmcnt(0)
s_barrier
v_mfma_f32_16x16x32_bf16 v[52:55], a[8:11], a[72:75], v[52:55]
s_add_u32 s64, s70, 256
ds_read_b64_tr_b16 a[104:105], v4 offset:32768
v_mfma_f32_16x16x32_bf16 v[68:71], a[16:19], a[72:75], 0
buffer_load_dwordx4 v12, s[32:35], s64 offen lds
v_mfma_f32_16x16x32_bf16 v[68:71], a[20:23], a[76:79], v[68:71]
s_add_u32 m0, s76, 1024
global_load_dwordx4 a[144:147], v18, s[4:5] offset:0
v_mfma_f32_16x16x32_bf16 v[84:87], a[28:31], a[76:79], 0
s_add_u32 s64, s70, 8448
ds_read_b64_tr_b16 a[106:107], v4 offset:33792
v_mfma_f32_16x16x32_bf16 v[84:87], a[24:27], a[72:75], v[84:87]
buffer_load_dwordx4 v13, s[32:35], s64 offen lds
v_mfma_f32_16x16x32_bf16 v[148:151], a[24:27], a[80:83], 0
ds_read_b64_tr_b16 a[108:109], v4 offset:40960
v_mfma_f32_16x16x32_bf16 v[148:151], a[28:31], a[84:87], v[148:151]
s_add_u32 m0, s76, 2048
ds_read_b64_tr_b16 a[110:111], v4 offset:41984
v_mfma_f32_16x16x32_bf16 v[132:135], a[20:23], a[84:87], 0
s_waitcnt vmcnt(11)
s_add_u32 s64, s70, 16640
ds_read_b128 a[32:35], v2 offset:32768
v_mfma_f32_16x16x32_bf16 v[132:135], a[16:19], a[80:83], v[132:135]
buffer_load_dwordx4 v12, s[32:35], s64 offen lds
v_mfma_f32_16x16x32_bf16 v[116:119], a[8:11], a[80:83], 0
ds_read_b128 a[36:39], v3 offset:32768
v_mfma_f32_16x16x32_bf16 v[116:119], a[12:15], a[84:87], v[116:119]
s_add_u32 m0, s76, 3072
ds_read_b128 a[40:43], v2 offset:34816
v_mfma_f32_16x16x32_bf16 v[100:103], a[4:7], a[84:87], 0
s_add_u32 s64, s70, 24832
ds_read_b128 a[44:47], v3 offset:34816
v_mfma_f32_16x16x32_bf16 v[100:103], a[0:3], a[80:83], v[100:103]
buffer_load_dwordx4 v13, s[32:35], s64 offen lds
v_mfma_f32_16x16x32_bf16 v[248:251], a[0:3], a[88:91], 0
ds_read_b128 a[48:51], v2 offset:36864
v_mfma_f32_16x16x32_bf16 v[248:251], a[4:7], a[92:95], v[248:251]
s_add_u32 m0, s76, 4096
ds_read_b128 a[52:55], v3 offset:36864
v_mfma_f32_16x16x32_bf16 v[252:255], a[12:15], a[92:95], 0
s_add_u32 s64, s70, 33024
ds_read_b128 a[56:59], v2 offset:38912
v_mfma_f32_16x16x32_bf16 v[252:255], a[8:11], a[88:91], v[252:255]
buffer_load_dwordx4 v12, s[32:35], s64 offen lds
v_mfma_f32_16x16x32_bf16 a[120:123], a[16:19], a[88:91], 0
s_add_u32 m0, s76, 5120
ds_read_b128 a[60:63], v3 offset:38912
v_mfma_f32_16x16x32_bf16 a[120:123], a[20:23], a[92:95], a[120:123]
s_add_u32 s64, s70, 41216
ds_read_b64_tr_b16 a[112:113], v5 offset:32768
v_mfma_f32_16x16x32_bf16 a[124:127], a[28:31], a[92:95], 0
buffer_load_dwordx4 v13, s[32:35], s64 offen lds
v_mfma_f32_16x16x32_bf16 a[124:127], a[24:27], a[88:91], a[124:127]
ds_read_b64_tr_b16 a[114:115], v5 offset:33792
v_mfma_f32_16x16x32_bf16 a[128:131], a[24:27], a[96:99], 0
s_add_u32 m0, s76, 6144
ds_read_b64_tr_b16 a[116:117], v5 offset:40960
v_mfma_f32_16x16x32_bf16 a[128:131], a[28:31], a[100:103], a[128:131]
s_add_u32 s64, s70, 49408
ds_read_b64_tr_b16 a[118:119], v5 offset:41984
v_mfma_f32_16x16x32_bf16 a[132:135], a[20:23], a[100:103], 0
buffer_load_dwordx4 v12, s[32:35], s64 offen lds
v_mfma_f32_16x16x32_bf16 a[132:135], a[16:19], a[96:99], a[132:135]
global_load_dwordx4 a[160:163], v19, s[22:23] offset:0
v_mfma_f32_16x16x32_bf16 a[136:139], a[8:11], a[96:99], 0
s_add_u32 m0, s76, 7168
ds_read_b64_tr_b16 a[72:73], v6 offset:32768
v_mfma_f32_16x16x32_bf16 a[136:139], a[12:15], a[100:103], a[136:139]
s_add_u32 s64, s70, 57600
ds_read_b64_tr_b16 a[74:75], v6 offset:33792
v_mfma_f32_16x16x32_bf16 a[140:143], a[4:7], a[100:103], 0
buffer_load_dwordx4 v13, s[32:35], s64 offen lds
v_mfma_f32_16x16x32_bf16 a[140:143], a[0:3], a[96:99], a[140:143]
s_waitcnt lgkmcnt(5)
ds_read_b64_tr_b16 a[76:77], v6 offset:40960
v_mfma_f32_16x16x32_bf16 v[184:187], a[104:107], a[32:35], v[184:187]
ds_read_b64_tr_b16 a[78:79], v6 offset:41984
v_mfma_f32_16x16x32_bf16 v[184:187], a[108:111], a[36:39], v[184:187]
ds_read_b64_tr_b16 a[80:81], v7 offset:32768
v_mfma_f32_16x16x32_bf16 v[192:195], a[108:111], a[44:47], v[192:195]
s_add_u32 m0, s77, 65536
ds_read_b64_tr_b16 a[82:83], v7 offset:33792
v_mfma_f32_16x16x32_bf16 v[192:195], a[104:107], a[40:43], v[192:195]
s_add_u32 s64, s71, 1572864
ds_read_b64_tr_b16 a[84:85], v7 offset:40960
v_mfma_f32_16x16x32_bf16 v[200:203], a[104:107], a[48:51], v[200:203]
buffer_load_dwordx4 v14, s[36:39], s64 offen lds
v_mfma_f32_16x16x32_bf16 v[200:203], a[108:111], a[52:55], v[200:203]
ds_read_b64_tr_b16 a[86:87], v7 offset:41984
v_mfma_f32_16x16x32_bf16 v[208:211], a[108:111], a[60:63], v[208:211]
s_add_u32 m0, s77, 66560
ds_read_b64_tr_b16 a[88:89], v8 offset:32768
v_mfma_f32_16x16x32_bf16 v[208:211], a[104:107], a[56:59], v[208:211]
s_waitcnt lgkmcnt(7)
s_add_u32 s64, s71, 1605632
ds_read_b64_tr_b16 a[90:91], v8 offset:33792
v_mfma_f32_16x16x32_bf16 v[212:215], a[112:115], a[56:59], v[212:215]
buffer_load_dwordx4 v14, s[36:39], s64 offen lds
v_mfma_f32_16x16x32_bf16 v[212:215], a[116:119], a[60:63], v[212:215]
ds_read_b64_tr_b16 a[92:93], v8 offset:40960
v_mfma_f32_16x16x32_bf16 v[204:207], a[116:119], a[52:55], v[204:207]
s_add_u32 m0, s77, 67584
ds_read_b64_tr_b16 a[94:95], v8 offset:41984
v_mfma_f32_16x16x32_bf16 v[204:207], a[112:115], a[48:51], v[204:207]
s_add_u32 s64, s71, 1638400
ds_read_b64_tr_b16 a[96:97], v9 offset:32768
v_mfma_f32_16x16x32_bf16 v[196:199], a[112:115], a[40:43], v[196:199]
buffer_load_dwordx4 v15, s[36:39], s64 offen lds
v_mfma_f32_16x16x32_bf16 v[196:199], a[116:119], a[44:47], v[196:199]
ds_read_b64_tr_b16 a[98:99], v9 offset:33792
v_mfma_f32_16x16x32_bf16 v[188:191], a[116:119], a[36:39], v[188:191]
s_add_u32 m0, s77, 68608
ds_read_b64_tr_b16 a[100:101], v9 offset:40960
v_mfma_f32_16x16x32_bf16 v[188:191], a[112:115], a[32:35], v[188:191]
s_add_u32 s64, s71, 1671168
ds_read_b64_tr_b16 a[102:103], v9 offset:41984
v_mfma_f32_16x16x32_bf16 v[216:219], a[72:75], a[32:35], v[216:219]
s_waitcnt lgkmcnt(7)
buffer_load_dwordx4 v15, s[36:39], s64 offen lds
v_mfma_f32_16x16x32_bf16 v[216:219], a[76:79], a[36:39], v[216:219]
global_load_dwordx4 a[148:151], v18, s[4:5] offset:512
v_mfma_f32_16x16x32_bf16 v[224:227], a[76:79], a[44:47], v[224:227]
ds_read_b64_tr_b16 a[104:105], v10 offset:32768
v_mfma_f32_16x16x32_bf16 v[224:227], a[72:75], a[40:43], v[224:227]
s_add_u32 m0, s77, 81920
ds_read_b64_tr_b16 a[106:107], v10 offset:33792
v_mfma_f32_16x16x32_bf16 v[232:235], a[72:75], a[48:51], v[232:235]
s_add_u32 s64, s71, 1572864
ds_read_b64_tr_b16 a[108:109], v10 offset:40960
v_mfma_f32_16x16x32_bf16 v[232:235], a[76:79], a[52:55], v[232:235]
buffer_load_dwordx4 v14, s[40:43], s64 offen lds
v_mfma_f32_16x16x32_bf16 v[240:243], a[76:79], a[60:63], v[240:243]
ds_read_b64_tr_b16 a[110:111], v10 offset:41984
v_mfma_f32_16x16x32_bf16 v[240:243], a[72:75], a[56:59], v[240:243]
s_add_u32 m0, s77, 82944
ds_read_b64_tr_b16 a[112:113], v11 offset:32768
v_mfma_f32_16x16x32_bf16 v[244:247], a[80:83], a[56:59], v[244:247]
s_add_u32 s64, s71, 1605632
ds_read_b64_tr_b16 a[114:115], v11 offset:33792
v_mfma_f32_16x16x32_bf16 v[244:247], a[84:87], a[60:63], v[244:247]
buffer_load_dwordx4 v14, s[40:43], s64 offen lds
v_mfma_f32_16x16x32_bf16 v[236:239], a[84:87], a[52:55], v[236:239]
ds_read_b64_tr_b16 a[116:117], v11 offset:40960
v_mfma_f32_16x16x32_bf16 v[236:239], a[80:83], a[48:51], v[236:239]
s_add_u32 m0, s77, 83968
ds_read_b64_tr_b16 a[118:119], v11 offset:41984
v_mfma_f32_16x16x32_bf16 v[228:231], a[80:83], a[40:43], v[228:231]
s_add_u32 s64, s71, 1638400
ds_read_b64_tr_b16 a[72:73], v4 offset:49152
v_mfma_f32_16x16x32_bf16 v[228:231], a[84:87], a[44:47], v[228:231]
buffer_load_dwordx4 v15, s[40:43], s64 offen lds
v_mfma_f32_16x16x32_bf16 v[220:223], a[84:87], a[36:39], v[220:223]
ds_read_b64_tr_b16 a[74:75], v4 offset:50176
v_mfma_f32_16x16x32_bf16 v[220:223], a[80:83], a[32:35], v[220:223]
s_waitcnt lgkmcnt(7)
s_add_u32 m0, s77, 84992
ds_read_b64_tr_b16 a[76:77], v4 offset:57344
v_mfma_f32_16x16x32_bf16 v[152:155], a[88:91], a[32:35], v[152:155]
s_add_u32 s64, s71, 1671168
ds_read_b64_tr_b16 a[78:79], v4 offset:58368
v_mfma_f32_16x16x32_bf16 v[152:155], a[92:95], a[36:39], v[152:155]
buffer_load_dwordx4 v15, s[40:43], s64 offen lds
v_mfma_f32_16x16x32_bf16 v[160:163], a[92:95], a[44:47], v[160:163]
ds_read_b64_tr_b16 a[80:81], v5 offset:49152
v_mfma_f32_16x16x32_bf16 v[160:163], a[88:91], a[40:43], v[160:163]
ds_read_b64_tr_b16 a[82:83], v5 offset:50176
v_mfma_f32_16x16x32_bf16 v[168:171], a[88:91], a[48:51], v[168:171]
ds_read_b64_tr_b16 a[84:85], v5 offset:57344
v_mfma_f32_16x16x32_bf16 v[168:171], a[92:95], a[52:55], v[168:171]
ds_read_b64_tr_b16 a[86:87], v5 offset:58368
v_mfma_f32_16x16x32_bf16 v[176:179], a[92:95], a[60:63], v[176:179]
s_add_u32 m0, s76, 32768
global_load_dwordx4 a[164:167], v19, s[22:23] offset:512
v_mfma_f32_16x16x32_bf16 v[176:179], a[88:91], a[56:59], v[176:179]
s_add_u32 s64, s70, 384
ds_read_b64_tr_b16 a[88:89], v6 offset:49152
v_mfma_f32_16x16x32_bf16 v[180:183], a[96:99], a[56:59], v[180:183]
buffer_load_dwordx4 v12, s[32:35], s64 offen lds
v_mfma_f32_16x16x32_bf16 v[180:183], a[100:103], a[60:63], v[180:183]
ds_read_b64_tr_b16 a[90:91], v6 offset:50176
v_mfma_f32_16x16x32_bf16 v[172:175], a[100:103], a[52:55], v[172:175]
ds_read_b64_tr_b16 a[92:93], v6 offset:57344
v_mfma_f32_16x16x32_bf16 v[172:175], a[96:99], a[48:51], v[172:175]
ds_read_b64_tr_b16 a[94:95], v6 offset:58368
v_mfma_f32_16x16x32_bf16 v[164:167], a[96:99], a[40:43], v[164:167]
v_mfma_f32_16x16x32_bf16 v[164:167], a[100:103], a[44:47], v[164:167]
s_add_u32 m0, s76, 33792
v_mfma_f32_16x16x32_bf16 v[156:159], a[100:103], a[36:39], v[156:159]
s_add_u32 s64, s70, 8576
v_mfma_f32_16x16x32_bf16 v[156:159], a[96:99], a[32:35], v[156:159]
buffer_load_dwordx4 v13, s[32:35], s64 offen lds
v_mfma_f32_16x16x32_bf16 v[24:27], a[104:107], a[32:35], v[24:27]
s_waitcnt lgkmcnt(4)
ds_read_b64_tr_b16 a[96:97], v7 offset:49152
v_mfma_f32_16x16x32_bf16 v[24:27], a[108:111], a[36:39], v[24:27]
ds_read_b64_tr_b16 a[98:99], v7 offset:50176
v_mfma_f32_16x16x32_bf16 v[40:43], a[108:111], a[44:47], v[40:43]
ds_read_b64_tr_b16 a[100:101], v7 offset:57344
v_mfma_f32_16x16x32_bf16 v[40:43], a[104:107], a[40:43], v[40:43]
ds_read_b64_tr_b16 a[102:103], v7 offset:58368
v_mfma_f32_16x16x32_bf16 v[56:59], a[104:107], a[48:51], v[56:59]
s_add_u32 m0, s76, 34816
v_mfma_f32_16x16x32_bf16 v[56:59], a[108:111], a[52:55], v[56:59]
s_add_u32 s64, s70, 16768
v_mfma_f32_16x16x32_bf16 v[72:75], a[108:111], a[60:63], v[72:75]
s_waitcnt vmcnt(12)
buffer_load_dwordx4 v12, s[32:35], s64 offen lds
v_mfma_f32_16x16x32_bf16 v[72:75], a[104:107], a[56:59], v[72:75]
ds_read_b64_tr_b16 a[104:105], v8 offset:49152
v_mfma_f32_16x16x32_bf16 v[136:139], a[112:115], a[56:59], v[136:139]
ds_read_b64_tr_b16 a[106:107], v8 offset:50176
v_mfma_f32_16x16x32_bf16 v[136:139], a[116:119], a[60:63], v[136:139]
ds_read_b64_tr_b16 a[108:109], v8 offset:57344
v_add_u32 v4, 0x8000, v4
v_mfma_f32_16x16x32_bf16 v[120:123], a[116:119], a[52:55], v[120:123]
ds_read_b64_tr_b16 a[110:111], v8 offset:58368
v_mfma_f32_16x16x32_bf16 v[120:123], a[112:115], a[48:51], v[120:123]
s_add_u32 m0, s76, 35840
ds_read_b128 a[0:3], v2 offset:0
v_mfma_f32_16x16x32_bf16 v[104:107], a[112:115], a[40:43], v[104:107]
s_add_u32 s64, s70, 24960
global_load_dwordx4 a[152:155], v18, s[4:5] offset:1024
v_mfma_f32_16x16x32_bf16 v[104:107], a[116:119], a[44:47], v[104:107]
buffer_load_dwordx4 v13, s[32:35], s64 offen lds
v_mfma_f32_16x16x32_bf16 v[88:91], a[116:119], a[36:39], v[88:91]
ds_read_b128 a[4:7], v3 offset:0
v_mfma_f32_16x16x32_bf16 v[88:91], a[112:115], a[32:35], v[88:91]
ds_read_b128 a[8:11], v2 offset:2048
v_mfma_f32_16x16x32_bf16 v[28:31], a[32:35], a[72:75], v[28:31]
ds_read_b128 a[12:15], v3 offset:2048
v_mfma_f32_16x16x32_bf16 v[28:31], a[36:39], a[76:79], v[28:31]
ds_read_b128 a[16:19], v2 offset:4096
v_add_u32 v5, 0x8000, v5
v_mfma_f32_16x16x32_bf16 v[44:47], a[44:47], a[76:79], v[44:47]
s_add_u32 m0, s76, 36864
ds_read_b128 a[20:23], v3 offset:4096
v_mfma_f32_16x16x32_bf16 v[44:47], a[40:43], a[72:75], v[44:47]
s_add_u32 s64, s70, 33152
ds_read_b128 a[24:27], v2 offset:6144
v_mfma_f32_16x16x32_bf16 v[60:63], a[48:51], a[72:75], v[60:63]
buffer_load_dwordx4 v12, s[32:35], s64 offen lds
v_mfma_f32_16x16x32_bf16 v[60:63], a[52:55], a[76:79], v[60:63]
ds_read_b128 a[28:31], v3 offset:6144
v_mfma_f32_16x16x32_bf16 v[76:79], a[60:63], a[76:79], v[76:79]
ds_read_b64_tr_b16 a[112:113], v9 offset:49152
v_mfma_f32_16x16x32_bf16 v[76:79], a[56:59], a[72:75], v[76:79]
ds_read_b64_tr_b16 a[114:115], v9 offset:50176
v_mfma_f32_16x16x32_bf16 v[140:143], a[56:59], a[80:83], v[140:143]
ds_read_b64_tr_b16 a[116:117], v9 offset:57344
v_mfma_f32_16x16x32_bf16 v[140:143], a[60:63], a[84:87], v[140:143]
s_add_u32 m0, s76, 37888
ds_read_b64_tr_b16 a[118:119], v9 offset:58368
v_add_u32 v6, 0x8000, v6
v_mfma_f32_16x16x32_bf16 v[124:127], a[52:55], a[84:87], v[124:127]
s_add_u32 s64, s70, 41344
ds_read_b64_tr_b16 a[72:73], v10 offset:49152
v_mfma_f32_16x16x32_bf16 v[124:127], a[48:51], a[80:83], v[124:127]
buffer_load_dwordx4 v13, s[32:35], s64 offen lds
v_mfma_f32_16x16x32_bf16 v[108:111], a[40:43], a[80:83], v[108:111]
ds_read_b64_tr_b16 a[74:75], v10 offset:50176
v_mfma_f32_16x16x32_bf16 v[108:111], a[44:47], a[84:87], v[108:111]
ds_read_b64_tr_b16 a[76:77], v10 offset:57344
v_mfma_f32_16x16x32_bf16 v[92:95], a[36:39], a[84:87], v[92:95]
ds_read_b64_tr_b16 a[78:79], v10 offset:58368
v_mfma_f32_16x16x32_bf16 v[92:95], a[32:35], a[80:83], v[92:95]
s_waitcnt lgkmcnt(8)
ds_read_b64_tr_b16 a[80:81], v11 offset:49152
v_mfma_f32_16x16x32_bf16 v[32:35], a[32:35], a[88:91], v[32:35]
s_add_u32 m0, s76, 38912
ds_read_b64_tr_b16 a[82:83], v11 offset:50176
v_mfma_f32_16x16x32_bf16 v[32:35], a[36:39], a[92:95], v[32:35]
s_add_u32 s64, s70, 49536
ds_read_b64_tr_b16 a[84:85], v11 offset:57344
v_add_u32 v7, 0x8000, v7
v_mfma_f32_16x16x32_bf16 v[48:51], a[44:47], a[92:95], v[48:51]
buffer_load_dwordx4 v12, s[32:35], s64 offen lds
v_mfma_f32_16x16x32_bf16 v[48:51], a[40:43], a[88:91], v[48:51]
global_load_dwordx4 a[168:171], v19, s[22:23] offset:1024
v_mfma_f32_16x16x32_bf16 v[64:67], a[48:51], a[88:91], v[64:67]
ds_read_b64_tr_b16 a[86:87], v11 offset:58368
v_mfma_f32_16x16x32_bf16 v[64:67], a[52:55], a[92:95], v[64:67]
v_mfma_f32_16x16x32_bf16 v[80:83], a[60:63], a[92:95], v[80:83]
v_mfma_f32_16x16x32_bf16 v[80:83], a[56:59], a[88:91], v[80:83]
s_add_u32 m0, s76, 39936
v_mfma_f32_16x16x32_bf16 v[144:147], a[56:59], a[96:99], v[144:147]
s_add_u32 s64, s70, 57728
v_mfma_f32_16x16x32_bf16 v[144:147], a[60:63], a[100:103], v[144:147]
buffer_load_dwordx4 v13, s[32:35], s64 offen lds
v_mfma_f32_16x16x32_bf16 v[128:131], a[52:55], a[100:103], v[128:131]
v_add_u32 v8, 0x8000, v8
v_mfma_f32_16x16x32_bf16 v[128:131], a[48:51], a[96:99], v[128:131]
v_mfma_f32_16x16x32_bf16 v[112:115], a[40:43], a[96:99], v[112:115]
v_mfma_f32_16x16x32_bf16 v[112:115], a[44:47], a[100:103], v[112:115]
v_mfma_f32_16x16x32_bf16 v[96:99], a[36:39], a[100:103], v[96:99]
v_add_u32 v9, 0x8000, v9
v_add_u32 v10, 0x8000, v10
v_mfma_f32_16x16x32_bf16 v[96:99], a[32:35], a[96:99], v[96:99]
v_add_u32 v11, 0x8000, v11
v_mfma_f32_16x16x32_bf16 v[36:39], a[32:35], a[104:107], v[36:39]
v_mfma_f32_16x16x32_bf16 v[36:39], a[36:39], a[108:111], v[36:39]
v_mfma_f32_16x16x32_bf16 v[52:55], a[44:47], a[108:111], v[52:55]
s_waitcnt lgkmcnt(0)
s_barrier
v_mfma_f32_16x16x32_bf16 v[52:55], a[40:43], a[104:107], v[52:55]
s_add_u32 m0, s77, 98304
ds_read_b64_tr_b16 a[88:89], v4 offset:32768
v_mfma_f32_16x16x32_bf16 v[68:71], a[48:51], a[104:107], v[68:71]
s_add_u32 s64, s71, 2097152
ds_read_b64_tr_b16 a[90:91], v4 offset:33792
v_mfma_f32_16x16x32_bf16 v[68:71], a[52:55], a[108:111], v[68:71]
buffer_load_dwordx4 v14, s[36:39], s64 offen lds
v_mfma_f32_16x16x32_bf16 v[84:87], a[60:63], a[108:111], v[84:87]
ds_read_b64_tr_b16 a[92:93], v4 offset:40960
v_mfma_f32_16x16x32_bf16 v[84:87], a[56:59], a[104:107], v[84:87]
ds_read_b64_tr_b16 a[94:95], v4 offset:41984
v_mfma_f32_16x16x32_bf16 v[148:151], a[56:59], a[112:115], v[148:151]
global_load_dwordx4 a[156:159], v18, s[4:5] offset:1536
v_mfma_f32_16x16x32_bf16 v[148:151], a[60:63], a[116:119], v[148:151]
ds_read_b64_tr_b16 a[96:97], v5 offset:32768
v_mfma_f32_16x16x32_bf16 v[132:135], a[52:55], a[116:119], v[132:135]
ds_read_b64_tr_b16 a[98:99], v5 offset:33792
v_mfma_f32_16x16x32_bf16 v[132:135], a[48:51], a[112:115], v[132:135]
s_add_u32 m0, s77, 99328
ds_read_b64_tr_b16 a[100:101], v5 offset:40960
v_mfma_f32_16x16x32_bf16 v[116:119], a[40:43], a[112:115], v[116:119]
s_add_u32 s64, s71, 2129920
ds_read_b64_tr_b16 a[102:103], v5 offset:41984
v_mfma_f32_16x16x32_bf16 v[116:119], a[44:47], a[116:119], v[116:119]
buffer_load_dwordx4 v14, s[36:39], s64 offen lds
v_mfma_f32_16x16x32_bf16 v[100:103], a[36:39], a[116:119], v[100:103]
ds_read_b64_tr_b16 a[104:105], v6 offset:32768
v_mfma_f32_16x16x32_bf16 v[100:103], a[32:35], a[112:115], v[100:103]
ds_read_b64_tr_b16 a[106:107], v6 offset:33792
v_mfma_f32_16x16x32_bf16 v[248:251], a[32:35], a[72:75], v[248:251]
ds_read_b64_tr_b16 a[108:109], v6 offset:40960
v_mfma_f32_16x16x32_bf16 v[248:251], a[36:39], a[76:79], v[248:251]
ds_read_b64_tr_b16 a[110:111], v6 offset:41984
v_mfma_f32_16x16x32_bf16 v[252:255], a[44:47], a[76:79], v[252:255]
ds_read_b64_tr_b16 a[112:113], v7 offset:32768
v_mfma_f32_16x16x32_bf16 v[252:255], a[40:43], a[72:75], v[252:255]
s_add_u32 m0, s77, 100352
ds_read_b64_tr_b16 a[114:115], v7 offset:33792
v_mfma_f32_16x16x32_bf16 a[120:123], a[48:51], a[72:75], a[120:123]
s_add_u32 s64, s71, 2162688
ds_read_b64_tr_b16 a[116:117], v7 offset:40960
v_mfma_f32_16x16x32_bf16 a[120:123], a[52:55], a[76:79], a[120:123]
buffer_load_dwordx4 v15, s[36:39], s64 offen lds
v_mfma_f32_16x16x32_bf16 a[124:127], a[60:63], a[76:79], a[124:127]
ds_read_b64_tr_b16 a[118:119], v7 offset:41984
v_mfma_f32_16x16x32_bf16 a[124:127], a[56:59], a[72:75], a[124:127]
ds_read_b64_tr_b16 a[72:73], v8 offset:32768
v_mfma_f32_16x16x32_bf16 a[128:131], a[56:59], a[80:83], a[128:131]
ds_read_b64_tr_b16 a[74:75], v8 offset:33792
v_mfma_f32_16x16x32_bf16 a[128:131], a[60:63], a[84:87], a[128:131]
ds_read_b64_tr_b16 a[76:77], v8 offset:40960
v_mfma_f32_16x16x32_bf16 a[132:135], a[52:55], a[84:87], a[132:135]
ds_read_b64_tr_b16 a[78:79], v8 offset:41984
v_mfma_f32_16x16x32_bf16 a[132:135], a[48:51], a[80:83], a[132:135]
s_add_u32 m0, s77, 101376
v_mfma_f32_16x16x32_bf16 a[136:139], a[40:43], a[80:83], a[136:139]
s_add_u32 s64, s71, 2195456
v_mfma_f32_16x16x32_bf16 a[136:139], a[44:47], a[84:87], a[136:139]
buffer_load_dwordx4 v15, s[36:39], s64 offen lds
v_mfma_f32_16x16x32_bf16 a[140:143], a[36:39], a[84:87], a[140:143]
global_load_dwordx4 a[172:175], v19, s[22:23] offset:1536
v_mfma_f32_16x16x32_bf16 a[140:143], a[32:35], a[80:83], a[140:143]
s_waitcnt lgkmcnt(5)
ds_read_b64_tr_b16 a[80:81], v9 offset:32768
v_mfma_f32_16x16x32_bf16 v[184:187], a[88:91], a[0:3], v[184:187]
ds_read_b64_tr_b16 a[82:83], v9 offset:33792
v_mfma_f32_16x16x32_bf16 v[184:187], a[92:95], a[4:7], v[184:187]
ds_read_b64_tr_b16 a[84:85], v9 offset:40960
v_mfma_f32_16x16x32_bf16 v[192:195], a[92:95], a[12:15], v[192:195]
ds_read_b64_tr_b16 a[86:87], v9 offset:41984
v_mfma_f32_16x16x32_bf16 v[192:195], a[88:91], a[8:11], v[192:195]
s_add_u32 m0, s77, 114688
s_add_u32 s17, s78, .-L_pc+6144
v_mfma_f32_16x16x32_bf16 v[200:203], a[88:91], a[16:19], v[200:203]
s_add_u32 s64, s71, 2097152
buffer_load_dword a252, v16, s[88:91], s17 offen
v_mfma_f32_16x16x32_bf16 v[200:203], a[92:95], a[20:23], v[200:203]
buffer_load_dwordx4 v14, s[40:43], s64 offen lds
v_mfma_f32_16x16x32_bf16 v[208:211], a[92:95], a[28:31], v[208:211]
v_mfma_f32_16x16x32_bf16 v[208:211], a[88:91], a[24:27], v[208:211]
ds_read_b64_tr_b16 a[88:89], v10 offset:32768
v_mfma_f32_16x16x32_bf16 v[212:215], a[96:99], a[24:27], v[212:215]
ds_read_b64_tr_b16 a[90:91], v10 offset:33792
v_mfma_f32_16x16x32_bf16 v[212:215], a[100:103], a[28:31], v[212:215]
ds_read_b64_tr_b16 a[92:93], v10 offset:40960
v_mfma_f32_16x16x32_bf16 v[204:207], a[100:103], a[20:23], v[204:207]
ds_read_b64_tr_b16 a[94:95], v10 offset:41984
v_mfma_f32_16x16x32_bf16 v[204:207], a[96:99], a[16:19], v[204:207]
s_add_u32 m0, s77, 115712
v_mfma_f32_16x16x32_bf16 v[196:199], a[96:99], a[8:11], v[196:199]
s_add_u32 s64, s71, 2129920
v_mfma_f32_16x16x32_bf16 v[196:199], a[100:103], a[12:15], v[196:199]
buffer_load_dwordx4 v14, s[40:43], s64 offen lds
v_mfma_f32_16x16x32_bf16 v[188:191], a[100:103], a[4:7], v[188:191]
v_mfma_f32_16x16x32_bf16 v[188:191], a[96:99], a[0:3], v[188:191]
ds_read_b64_tr_b16 a[96:97], v11 offset:32768
v_mfma_f32_16x16x32_bf16 v[216:219], a[104:107], a[0:3], v[216:219]
ds_read_b64_tr_b16 a[98:99], v11 offset:33792
v_mfma_f32_16x16x32_bf16 v[216:219], a[108:111], a[4:7], v[216:219]
ds_read_b64_tr_b16 a[100:101], v11 offset:40960
v_mfma_f32_16x16x32_bf16 v[224:227], a[108:111], a[12:15], v[224:227]
ds_read_b64_tr_b16 a[102:103], v11 offset:41984
v_mfma_f32_16x16x32_bf16 v[224:227], a[104:107], a[8:11], v[224:227]
s_add_u32 m0, s77, 116736
v_mfma_f32_16x16x32_bf16 v[232:235], a[104:107], a[16:19], v[232:235]
s_add_u32 s64, s71, 2162688
buffer_store_dword v21, v20, s[44:47], s69 offen sc1
v_mfma_f32_16x16x32_bf16 v[232:235], a[108:111], a[20:23], v[232:235]
buffer_load_dwordx4 v15, s[40:43], s64 offen lds
v_mfma_f32_16x16x32_bf16 v[240:243], a[108:111], a[28:31], v[240:243]
v_mfma_f32_16x16x32_bf16 v[240:243], a[104:107], a[24:27], v[240:243]
ds_read_b64_tr_b16 a[104:105], v4 offset:49152
v_mfma_f32_16x16x32_bf16 v[244:247], a[112:115], a[24:27], v[244:247]
s_waitcnt lgkmcnt(5)
buffer_load_dword a252, v16, s[56:59], s81 offen
v_mfma_f32_16x16x32_bf16 v[244:247], a[116:119], a[28:31], v[244:247]
ds_read_b64_tr_b16 a[106:107], v4 offset:50176
v_mfma_f32_16x16x32_bf16 v[236:239], a[116:119], a[20:23], v[236:239]
ds_read_b64_tr_b16 a[108:109], v4 offset:57344
v_mfma_f32_16x16x32_bf16 v[236:239], a[112:115], a[16:19], v[236:239]
s_add_u32 m0, s77, 117760
ds_read_b64_tr_b16 a[110:111], v4 offset:58368
v_mfma_f32_16x16x32_bf16 v[228:231], a[112:115], a[8:11], v[228:231]
s_add_u32 s64, s71, 2195456
v_mfma_f32_16x16x32_bf16 v[228:231], a[116:119], a[12:15], v[228:231]
buffer_load_dwordx4 v15, s[40:43], s64 offen lds
v_mfma_f32_16x16x32_bf16 v[220:223], a[116:119], a[4:7], v[220:223]
v_mfma_f32_16x16x32_bf16 v[220:223], a[112:115], a[0:3], v[220:223]
ds_read_b64_tr_b16 a[112:113], v5 offset:49152
v_mfma_f32_16x16x32_bf16 v[152:155], a[72:75], a[0:3], v[152:155]
ds_read_b64_tr_b16 a[114:115], v5 offset:50176
v_mfma_f32_16x16x32_bf16 v[152:155], a[76:79], a[4:7], v[152:155]
ds_read_b64_tr_b16 a[116:117], v5 offset:57344
v_mfma_f32_16x16x32_bf16 v[160:163], a[76:79], a[12:15], v[160:163]
ds_read_b64_tr_b16 a[118:119], v5 offset:58368
v_mfma_f32_16x16x32_bf16 v[160:163], a[72:75], a[8:11], v[160:163]
v_mfma_f32_16x16x32_bf16 v[168:171], a[72:75], a[16:19], v[168:171]
v_mfma_f32_16x16x32_bf16 v[168:171], a[76:79], a[20:23], v[168:171]
v_mfma_f32_16x16x32_bf16 v[176:179], a[76:79], a[28:31], v[176:179]
s_add_u32 m0, s76, 0
v_mfma_f32_16x16x32_bf16 v[176:179], a[72:75], a[24:27], v[176:179]
s_add_u32 s64, s70, 512
ds_read_b64_tr_b16 a[72:73], v6 offset:49152
v_mfma_f32_16x16x32_bf16 v[180:183], a[80:83], a[24:27], v[180:183]
buffer_load_dwordx4 v12, s[32:35], s64 offen lds
v_mfma_f32_16x16x32_bf16 v[180:183], a[84:87], a[28:31], v[180:183]
ds_read_b64_tr_b16 a[74:75], v6 offset:50176
v_mfma_f32_16x16x32_bf16 v[172:175], a[84:87], a[20:23], v[172:175]
ds_read_b64_tr_b16 a[76:77], v6 offset:57344
v_mfma_f32_16x16x32_bf16 v[172:175], a[80:83], a[16:19], v[172:175]
ds_read_b64_tr_b16 a[78:79], v6 offset:58368
v_mfma_f32_16x16x32_bf16 v[164:167], a[80:83], a[8:11], v[164:167]
v_mfma_f32_16x16x32_bf16 v[164:167], a[84:87], a[12:15], v[164:167]
s_add_u32 m0, s76, 1024
v_mfma_f32_16x16x32_bf16 v[156:159], a[84:87], a[4:7], v[156:159]
s_add_u32 s64, s70, 8704
v_mfma_f32_16x16x32_bf16 v[156:159], a[80:83], a[0:3], v[156:159]
buffer_load_dwordx4 v13, s[32:35], s64 offen lds
v_mfma_f32_16x16x32_bf16 v[24:27], a[88:91], a[0:3], v[24:27]
ds_read_b64_tr_b16 a[80:81], v7 offset:49152
v_mfma_f32_16x16x32_bf16 v[24:27], a[92:95], a[4:7], v[24:27]
ds_read_b64_tr_b16 a[82:83], v7 offset:50176
v_mfma_f32_16x16x32_bf16 v[40:43], a[92:95], a[12:15], v[40:43]
ds_read_b64_tr_b16 a[84:85], v7 offset:57344
v_mfma_f32_16x16x32_bf16 v[40:43], a[88:91], a[8:11], v[40:43]
ds_read_b64_tr_b16 a[86:87], v7 offset:58368
v_mfma_f32_16x16x32_bf16 v[56:59], a[88:91], a[16:19], v[56:59]
s_add_u32 m0, s76, 2048
v_mfma_f32_16x16x32_bf16 v[56:59], a[92:95], a[20:23], v[56:59]
s_add_u32 s64, s70, 16896
v_mfma_f32_16x16x32_bf16 v[72:75], a[92:95], a[28:31], v[72:75]
s_waitcnt vmcnt(15)
buffer_load_dwordx4 v12, s[32:35], s64 offen lds
v_mfma_f32_16x16x32_bf16 v[72:75], a[88:91], a[24:27], v[72:75]
s_waitcnt lgkmcnt(4)
ds_read_b64_tr_b16 a[88:89], v8 offset:49152
v_mfma_f32_16x16x32_bf16 v[136:139], a[96:99], a[24:27], v[136:139]
buffer_load_dword a252, v1, s[60:63], s82 offen
v_mfma_f32_16x16x32_bf16 v[136:139], a[100:103], a[28:31], v[136:139]
ds_read_b64_tr_b16 a[90:91], v8 offset:50176
v_subrev_u32 v4, 0x8000, v4
v_mfma_f32_16x16x32_bf16 v[120:123], a[100:103], a[20:23], v[120:123]
ds_read_b64_tr_b16 a[92:93], v8 offset:57344
v_mfma_f32_16x16x32_bf16 v[120:123], a[96:99], a[16:19], v[120:123]
s_add_u32 m0, s76, 3072
ds_read_b64_tr_b16 a[94:95], v8 offset:58368
v_mfma_f32_16x16x32_bf16 v[104:107], a[96:99], a[8:11], v[104:107]
s_add_u32 s64, s70, 25088
ds_read_b128 a[32:35], v2 offset:32768
v_mfma_f32_16x16x32_bf16 v[104:107], a[100:103], a[12:15], v[104:107]
buffer_load_dwordx4 v13, s[32:35], s64 offen lds
v_mfma_f32_16x16x32_bf16 v[88:91], a[100:103], a[4:7], v[88:91]
ds_read_b128 a[36:39], v3 offset:32768
v_mfma_f32_16x16x32_bf16 v[88:91], a[96:99], a[0:3], v[88:91]
ds_read_b128 a[40:43], v2 offset:34816
v_mfma_f32_16x16x32_bf16 v[28:31], a[0:3], a[104:107], v[28:31]
ds_read_b128 a[44:47], v3 offset:34816
v_mfma_f32_16x16x32_bf16 v[28:31], a[4:7], a[108:111], v[28:31]
ds_read_b128 a[48:51], v2 offset:36864
v_subrev_u32 v5, 0x8000, v5
v_mfma_f32_16x16x32_bf16 v[44:47], a[12:15], a[108:111], v[44:47]
s_add_u32 m0, s76, 4096
ds_read_b128 a[52:55], v3 offset:36864
v_mfma_f32_16x16x32_bf16 v[44:47], a[8:11], a[104:107], v[44:47]
s_add_u32 s64, s70, 33280
ds_read_b128 a[56:59], v2 offset:38912
v_mfma_f32_16x16x32_bf16 v[60:63], a[16:19], a[104:107], v[60:63]
buffer_load_dwordx4 v12, s[32:35], s64 offen lds
v_mfma_f32_16x16x32_bf16 v[60:63], a[20:23], a[108:111], v[60:63]
ds_read_b128 a[60:63], v3 offset:38912
v_mfma_f32_16x16x32_bf16 v[76:79], a[28:31], a[108:111], v[76:79]
ds_read_b64_tr_b16 a[96:97], v9 offset:49152
v_mfma_f32_16x16x32_bf16 v[76:79], a[24:27], a[104:107], v[76:79]
ds_read_b64_tr_b16 a[98:99], v9 offset:50176
v_mfma_f32_16x16x32_bf16 v[140:143], a[24:27], a[112:115], v[140:143]
ds_read_b64_tr_b16 a[100:101], v9 offset:57344
v_mfma_f32_16x16x32_bf16 v[140:143], a[28:31], a[116:119], v[140:143]
s_add_u32 m0, s76, 5120
ds_read_b64_tr_b16 a[102:103], v9 offset:58368
v_subrev_u32 v6, 0x8000, v6
v_mfma_f32_16x16x32_bf16 v[124:127], a[20:23], a[116:119], v[124:127]
s_add_u32 s64, s70, 41472
ds_read_b64_tr_b16 a[104:105], v10 offset:49152
v_mfma_f32_16x16x32_bf16 v[124:127], a[16:19], a[112:115], v[124:127]
buffer_load_dwordx4 v13, s[32:35], s64 offen lds
v_mfma_f32_16x16x32_bf16 v[108:111], a[8:11], a[112:115], v[108:111]
ds_read_b64_tr_b16 a[106:107], v10 offset:50176
v_mfma_f32_16x16x32_bf16 v[108:111], a[12:15], a[116:119], v[108:111]
ds_read_b64_tr_b16 a[108:109], v10 offset:57344
v_mfma_f32_16x16x32_bf16 v[92:95], a[4:7], a[116:119], v[92:95]
ds_read_b64_tr_b16 a[110:111], v10 offset:58368
v_mfma_f32_16x16x32_bf16 v[92:95], a[0:3], a[112:115], v[92:95]
ds_read_b64_tr_b16 a[112:113], v11 offset:49152
v_mfma_f32_16x16x32_bf16 v[32:35], a[0:3], a[72:75], v[32:35]
s_add_u32 m0, s76, 6144
ds_read_b64_tr_b16 a[114:115], v11 offset:50176
v_mfma_f32_16x16x32_bf16 v[32:35], a[4:7], a[76:79], v[32:35]
s_add_u32 s64, s70, 49664
ds_read_b64_tr_b16 a[116:117], v11 offset:57344
v_subrev_u32 v7, 0x8000, v7
v_mfma_f32_16x16x32_bf16 v[48:51], a[12:15], a[76:79], v[48:51]
buffer_load_dwordx4 v12, s[32:35], s64 offen lds
v_mfma_f32_16x16x32_bf16 v[48:51], a[8:11], a[72:75], v[48:51]
ds_read_b64_tr_b16 a[118:119], v11 offset:58368
v_mfma_f32_16x16x32_bf16 v[64:67], a[16:19], a[72:75], v[64:67]
v_mfma_f32_16x16x32_bf16 v[64:67], a[20:23], a[76:79], v[64:67]
v_mfma_f32_16x16x32_bf16 v[80:83], a[28:31], a[76:79], v[80:83]
v_mfma_f32_16x16x32_bf16 v[80:83], a[24:27], a[72:75], v[80:83]
s_waitcnt lgkmcnt(5)
s_add_u32 m0, s76, 7168
s_add_u32 s81, s81, 1048576
v_mfma_f32_16x16x32_bf16 v[144:147], a[24:27], a[80:83], v[144:147]
s_add_u32 s64, s70, 57856
buffer_load_dword a252, v16, s[56:59], s81 offen
v_mfma_f32_16x16x32_bf16 v[144:147], a[28:31], a[84:87], v[144:147]
buffer_load_dwordx4 v13, s[32:35], s64 offen lds
v_mfma_f32_16x16x32_bf16 v[128:131], a[20:23], a[84:87], v[128:131]
v_subrev_u32 v8, 0x8000, v8
v_mfma_f32_16x16x32_bf16 v[128:131], a[16:19], a[80:83], v[128:131]
v_mfma_f32_16x16x32_bf16 v[112:115], a[8:11], a[80:83], v[112:115]
v_mfma_f32_16x16x32_bf16 v[112:115], a[12:15], a[84:87], v[112:115]
v_mfma_f32_16x16x32_bf16 v[96:99], a[4:7], a[84:87], v[96:99]
v_subrev_u32 v9, 0x8000, v9
v_subrev_u32 v10, 0x8000, v10
v_mfma_f32_16x16x32_bf16 v[96:99], a[0:3], a[80:83], v[96:99]
v_subrev_u32 v11, 0x8000, v11
v_mfma_f32_16x16x32_bf16 v[36:39], a[0:3], a[88:91], v[36:39]
v_mfma_f32_16x16x32_bf16 v[36:39], a[4:7], a[92:95], v[36:39]
v_mfma_f32_16x16x32_bf16 v[52:55], a[12:15], a[92:95], v[52:55]
s_waitcnt lgkmcnt(0)
s_barrier
v_mfma_f32_16x16x32_bf16 v[52:55], a[8:11], a[88:91], v[52:55]
s_add_u32 m0, s77, 131072
ds_read_b64_tr_b16 a[72:73], v4 offset:0
v_mfma_f32_16x16x32_bf16 v[68:71], a[16:19], a[88:91], v[68:71]
s_add_u32 s64, s71, 2621440
ds_read_b64_tr_b16 a[74:75], v4 offset:1024
v_mfma_f32_16x16x32_bf16 v[68:71], a[20:23], a[92:95], v[68:71]
buffer_load_dwordx4 v14, s[36:39], s64 offen lds
v_mfma_f32_16x16x32_bf16 v[84:87], a[28:31], a[92:95], v[84:87]
ds_read_b64_tr_b16 a[76:77], v4 offset:8192
v_mfma_f32_16x16x32_bf16 v[84:87], a[24:27], a[88:91], v[84:87]
ds_read_b64_tr_b16 a[78:79], v4 offset:9216
v_mfma_f32_16x16x32_bf16 v[148:151], a[24:27], a[96:99], v[148:151]
ds_read_b64_tr_b16 a[80:81], v5 offset:0
v_mfma_f32_16x16x32_bf16 v[148:151], a[28:31], a[100:103], v[148:151]
ds_read_b64_tr_b16 a[82:83], v5 offset:1024
v_mfma_f32_16x16x32_bf16 v[132:135], a[20:23], a[100:103], v[132:135]
ds_read_b64_tr_b16 a[84:85], v5 offset:8192
v_mfma_f32_16x16x32_bf16 v[132:135], a[16:19], a[96:99], v[132:135]
s_add_u32 m0, s77, 132096
ds_read_b64_tr_b16 a[86:87], v5 offset:9216
v_mfma_f32_16x16x32_bf16 v[116:119], a[8:11], a[96:99], v[116:119]
s_add_u32 s64, s71, 2654208
ds_read_b64_tr_b16 a[88:89], v6 offset:0
v_mfma_f32_16x16x32_bf16 v[116:119], a[12:15], a[100:103], v[116:119]
buffer_load_dwordx4 v14, s[36:39], s64 offen lds
v_mfma_f32_16x16x32_bf16 v[100:103], a[4:7], a[100:103], v[100:103]
ds_read_b64_tr_b16 a[90:91], v6 offset:1024
v_mfma_f32_16x16x32_bf16 v[100:103], a[0:3], a[96:99], v[100:103]
ds_read_b64_tr_b16 a[92:93], v6 offset:8192
v_mfma_f32_16x16x32_bf16 v[248:251], a[0:3], a[104:107], v[248:251]
ds_read_b64_tr_b16 a[94:95], v6 offset:9216
v_mfma_f32_16x16x32_bf16 v[248:251], a[4:7], a[108:111], v[248:251]
ds_read_b64_tr_b16 a[96:97], v7 offset:0
v_mfma_f32_16x16x32_bf16 v[252:255], a[12:15], a[108:111], v[252:255]
ds_read_b64_tr_b16 a[98:99], v7 offset:1024
v_mfma_f32_16x16x32_bf16 v[252:255], a[8:11], a[104:107], v[252:255]
s_add_u32 m0, s77, 133120
ds_read_b64_tr_b16 a[100:101], v7 offset:8192
v_mfma_f32_16x16x32_bf16 a[120:123], a[16:19], a[104:107], a[120:123]
s_add_u32 s64, s71, 2686976
ds_read_b64_tr_b16 a[102:103], v7 offset:9216
v_mfma_f32_16x16x32_bf16 a[120:123], a[20:23], a[108:111], a[120:123]
buffer_load_dwordx4 v15, s[36:39], s64 offen lds
v_mfma_f32_16x16x32_bf16 a[124:127], a[28:31], a[108:111], a[124:127]
v_mfma_f32_16x16x32_bf16 a[124:127], a[24:27], a[104:107], a[124:127]
s_add_u32 s82, s82, 1048576
ds_read_b64_tr_b16 a[104:105], v8 offset:0
v_mfma_f32_16x16x32_bf16 a[128:131], a[24:27], a[112:115], a[128:131]
buffer_load_dword a252, v1, s[60:63], s82 offen
v_mfma_f32_16x16x32_bf16 a[128:131], a[28:31], a[116:119], a[128:131]
ds_read_b64_tr_b16 a[106:107], v8 offset:1024
v_mfma_f32_16x16x32_bf16 a[132:135], a[20:23], a[116:119], a[132:135]
ds_read_b64_tr_b16 a[108:109], v8 offset:8192
v_mfma_f32_16x16x32_bf16 a[132:135], a[16:19], a[112:115], a[132:135]
s_add_u32 m0, s77, 134144
ds_read_b64_tr_b16 a[110:111], v8 offset:9216
v_mfma_f32_16x16x32_bf16 a[136:139], a[8:11], a[112:115], a[136:139]
s_add_u32 s64, s71, 2719744
v_mfma_f32_16x16x32_bf16 a[136:139], a[12:15], a[116:119], a[136:139]
buffer_load_dwordx4 v15, s[36:39], s64 offen lds
v_mfma_f32_16x16x32_bf16 a[140:143], a[4:7], a[116:119], a[140:143]
v_mfma_f32_16x16x32_bf16 a[140:143], a[0:3], a[112:115], a[140:143]
s_waitcnt lgkmcnt(4)
ds_read_b64_tr_b16 a[112:113], v9 offset:0
v_mfma_f32_16x16x32_bf16 v[184:187], a[72:75], a[32:35], v[184:187]
ds_read_b64_tr_b16 a[114:115], v9 offset:1024
v_mov_b32 v17, 0
v_mfma_f32_16x16x32_bf16 v[184:187], a[76:79], a[36:39], v[184:187]
ds_read_b64_tr_b16 a[116:117], v9 offset:8192
v_accvgpr_read_b32 v19, a144
v_mfma_f32_16x16x32_bf16 v[192:195], a[76:79], a[44:47], v[192:195]
ds_read_b64_tr_b16 a[118:119], v9 offset:9216
v_accvgpr_read_b32 v21, a160
v_mfma_f32_16x16x32_bf16 v[192:195], a[72:75], a[40:43], v[192:195]
s_add_u32 m0, s77, 147456
v_lshlrev_b32 v18, 16, v19
v_and_b32 v19, 0xffff0000, v19
v_mfma_f32_16x16x32_bf16 v[200:203], a[72:75], a[48:51], v[200:203]
s_add_u32 s64, s71, 2621440
v_lshlrev_b32 v20, 16, v21
v_and_b32 v21, 0xffff0000, v21
v_mfma_f32_16x16x32_bf16 v[200:203], a[76:79], a[52:55], v[200:203]
buffer_load_dwordx4 v14, s[40:43], s64 offen lds
v_mfma_f32_16x16x32_bf16 v[208:211], a[76:79], a[60:63], v[208:211]
v_mul_f32 v18, v18, v20
v_mul_f32 v19, v19, v21
v_mfma_f32_16x16x32_bf16 v[208:211], a[72:75], a[56:59], v[208:211]
ds_read_b64_tr_b16 a[72:73], v10 offset:0
v_cvt_pk_bf16_f32 v18, v18, v19
v_mfma_f32_16x16x32_bf16 v[212:215], a[80:83], a[56:59], v[212:215]
ds_read_b64_tr_b16 a[74:75], v10 offset:1024
v_lshlrev_b32 v19, 16, v18
v_mfma_f32_16x16x32_bf16 v[212:215], a[84:87], a[60:63], v[212:215]
ds_read_b64_tr_b16 a[76:77], v10 offset:8192
v_and_b32 v18, 0xffff0000, v18
v_mfma_f32_16x16x32_bf16 v[204:207], a[84:87], a[52:55], v[204:207]
ds_read_b64_tr_b16 a[78:79], v10 offset:9216
v_add_f32 v17, v17, v19
v_mfma_f32_16x16x32_bf16 v[204:207], a[80:83], a[48:51], v[204:207]
s_add_u32 m0, s77, 148480
v_add_f32 v17, v17, v18
v_accvgpr_read_b32 v19, a145
v_mfma_f32_16x16x32_bf16 v[196:199], a[80:83], a[40:43], v[196:199]
s_add_u32 s64, s71, 2654208
v_accvgpr_read_b32 v21, a161
v_lshlrev_b32 v18, 16, v19
v_mfma_f32_16x16x32_bf16 v[196:199], a[84:87], a[44:47], v[196:199]
buffer_load_dwordx4 v14, s[40:43], s64 offen lds
v_mfma_f32_16x16x32_bf16 v[188:191], a[84:87], a[36:39], v[188:191]
v_and_b32 v19, 0xffff0000, v19
v_lshlrev_b32 v20, 16, v21
v_mfma_f32_16x16x32_bf16 v[188:191], a[80:83], a[32:35], v[188:191]
ds_read_b64_tr_b16 a[80:81], v11 offset:0
v_and_b32 v21, 0xffff0000, v21
v_mfma_f32_16x16x32_bf16 v[216:219], a[88:91], a[32:35], v[216:219]
ds_read_b64_tr_b16 a[82:83], v11 offset:1024
v_mul_f32 v18, v18, v20
v_mfma_f32_16x16x32_bf16 v[216:219], a[92:95], a[36:39], v[216:219]
ds_read_b64_tr_b16 a[84:85], v11 offset:8192
v_mul_f32 v19, v19, v21
v_mfma_f32_16x16x32_bf16 v[224:227], a[92:95], a[44:47], v[224:227]
ds_read_b64_tr_b16 a[86:87], v11 offset:9216
v_cvt_pk_bf16_f32 v18, v18, v19
v_mfma_f32_16x16x32_bf16 v[224:227], a[88:91], a[40:43], v[224:227]
s_add_u32 m0, s77, 149504
v_lshlrev_b32 v19, 16, v18
v_and_b32 v18, 0xffff0000, v18
v_mfma_f32_16x16x32_bf16 v[232:235], a[88:91], a[48:51], v[232:235]
s_add_u32 s64, s71, 2686976
v_add_f32 v17, v17, v19
v_add_f32 v17, v17, v18
v_mfma_f32_16x16x32_bf16 v[232:235], a[92:95], a[52:55], v[232:235]
buffer_load_dwordx4 v15, s[40:43], s64 offen lds
v_mfma_f32_16x16x32_bf16 v[240:243], a[92:95], a[60:63], v[240:243]
v_accvgpr_read_b32 v19, a146
v_accvgpr_read_b32 v21, a162
v_mfma_f32_16x16x32_bf16 v[240:243], a[88:91], a[56:59], v[240:243]
s_add_u32 s81, s81, 1048576
ds_read_b64_tr_b16 a[88:89], v4 offset:16384
v_lshlrev_b32 v18, 16, v19
v_mfma_f32_16x16x32_bf16 v[244:247], a[96:99], a[56:59], v[244:247]
buffer_load_dword a252, v16, s[56:59], s81 offen
v_mfma_f32_16x16x32_bf16 v[244:247], a[100:103], a[60:63], v[244:247]
ds_read_b64_tr_b16 a[90:91], v4 offset:17408
v_and_b32 v19, 0xffff0000, v19
v_mfma_f32_16x16x32_bf16 v[236:239], a[100:103], a[52:55], v[236:239]
ds_read_b64_tr_b16 a[92:93], v4 offset:24576
v_lshlrev_b32 v20, 16, v21
v_mfma_f32_16x16x32_bf16 v[236:239], a[96:99], a[48:51], v[236:239]
s_add_u32 m0, s77, 150528
ds_read_b64_tr_b16 a[94:95], v4 offset:25600
v_and_b32 v21, 0xffff0000, v21
v_mfma_f32_16x16x32_bf16 v[228:231], a[96:99], a[40:43], v[228:231]
s_add_u32 s64, s71, 2719744
v_mul_f32 v18, v18, v20
v_mul_f32 v19, v19, v21
v_mfma_f32_16x16x32_bf16 v[228:231], a[100:103], a[44:47], v[228:231]
buffer_load_dwordx4 v15, s[40:43], s64 offen lds
v_mfma_f32_16x16x32_bf16 v[220:223], a[100:103], a[36:39], v[220:223]
v_cvt_pk_bf16_f32 v18, v18, v19
v_lshlrev_b32 v19, 16, v18
v_mfma_f32_16x16x32_bf16 v[220:223], a[96:99], a[32:35], v[220:223]
s_waitcnt lgkmcnt(4)
ds_read_b64_tr_b16 a[96:97], v5 offset:16384
v_and_b32 v18, 0xffff0000, v18
v_mfma_f32_16x16x32_bf16 v[152:155], a[104:107], a[32:35], v[152:155]
ds_read_b64_tr_b16 a[98:99], v5 offset:17408
v_add_f32 v17, v17, v19
v_mfma_f32_16x16x32_bf16 v[152:155], a[108:111], a[36:39], v[152:155]
ds_read_b64_tr_b16 a[100:101], v5 offset:24576
v_add_f32 v17, v17, v18
v_mfma_f32_16x16x32_bf16 v[160:163], a[108:111], a[44:47], v[160:163]
ds_read_b64_tr_b16 a[102:103], v5 offset:25600
v_accvgpr_read_b32 v19, a147
v_mfma_f32_16x16x32_bf16 v[160:163], a[104:107], a[40:43], v[160:163]
v_accvgpr_read_b32 v21, a163
v_lshlrev_b32 v18, 16, v19
v_mfma_f32_16x16x32_bf16 v[168:171], a[104:107], a[48:51], v[168:171]
v_and_b32 v19, 0xffff0000, v19
v_lshlrev_b32 v20, 16, v21
v_mfma_f32_16x16x32_bf16 v[168:171], a[108:111], a[52:55], v[168:171]
v_and_b32 v21, 0xffff0000, v21
v_mul_f32 v18, v18, v20
v_mfma_f32_16x16x32_bf16 v[176:179], a[108:111], a[60:63], v[176:179]
s_add_u32 m0, s76, 32768
v_mul_f32 v19, v19, v21
v_cvt_pk_bf16_f32 v18, v18, v19
v_mfma_f32_16x16x32_bf16 v[176:179], a[104:107], a[56:59], v[176:179]
s_add_u32 s64, s70, 640
ds_read_b64_tr_b16 a[104:105], v6 offset:16384
v_lshlrev_b32 v19, 16, v18
v_mfma_f32_16x16x32_bf16 v[180:183], a[112:115], a[56:59], v[180:183]
buffer_load_dwordx4 v12, s[32:35], s64 offen lds
v_mfma_f32_16x16x32_bf16 v[180:183], a[116:119], a[60:63], v[180:183]
ds_read_b64_tr_b16 a[106:107], v6 offset:17408
v_and_b32 v18, 0xffff0000, v18
v_mfma_f32_16x16x32_bf16 v[172:175], a[116:119], a[52:55], v[172:175]
ds_read_b64_tr_b16 a[108:109], v6 offset:24576
v_add_f32 v17, v17, v19
v_mfma_f32_16x16x32_bf16 v[172:175], a[112:115], a[48:51], v[172:175]
ds_read_b64_tr_b16 a[110:111], v6 offset:25600
v_add_f32 v17, v17, v18
v_mfma_f32_16x16x32_bf16 v[164:167], a[112:115], a[40:43], v[164:167]
v_accvgpr_read_b32 v19, a148
v_accvgpr_read_b32 v21, a164
v_mfma_f32_16x16x32_bf16 v[164:167], a[116:119], a[44:47], v[164:167]
s_add_u32 m0, s76, 33792
v_lshlrev_b32 v18, 16, v19
v_and_b32 v19, 0xffff0000, v19
v_mfma_f32_16x16x32_bf16 v[156:159], a[116:119], a[36:39], v[156:159]
s_add_u32 s64, s70, 8832
v_lshlrev_b32 v20, 16, v21
v_and_b32 v21, 0xffff0000, v21
v_mfma_f32_16x16x32_bf16 v[156:159], a[112:115], a[32:35], v[156:159]
buffer_load_dwordx4 v13, s[32:35], s64 offen lds
v_mfma_f32_16x16x32_bf16 v[24:27], a[72:75], a[32:35], v[24:27]
ds_read_b64_tr_b16 a[112:113], v7 offset:16384
v_mul_f32 v18, v18, v20
v_mfma_f32_16x16x32_bf16 v[24:27], a[76:79], a[36:39], v[24:27]
ds_read_b64_tr_b16 a[114:115], v7 offset:17408
v_mul_f32 v19, v19, v21
v_mfma_f32_16x16x32_bf16 v[40:43], a[76:79], a[44:47], v[40:43]
ds_read_b64_tr_b16 a[116:117], v7 offset:24576
v_cvt_pk_bf16_f32 v18, v18, v19
v_mfma_f32_16x16x32_bf16 v[40:43], a[72:75], a[40:43], v[40:43]
ds_read_b64_tr_b16 a[118:119], v7 offset:25600
v_lshlrev_b32 v19, 16, v18
v_mfma_f32_16x16x32_bf16 v[56:59], a[72:75], a[48:51], v[56:59]
s_add_u32 m0, s76, 34816
v_and_b32 v18, 0xffff0000, v18
v_add_f32 v17, v17, v19
v_mfma_f32_16x16x32_bf16 v[56:59], a[76:79], a[52:55], v[56:59]
s_add_u32 s64, s70, 17024
v_add_f32 v17, v17, v18
v_accvgpr_read_b32 v19, a149
v_mfma_f32_16x16x32_bf16 v[72:75], a[76:79], a[60:63], v[72:75]
s_waitcnt vmcnt(12)
buffer_load_dwordx4 v12, s[32:35], s64 offen lds
v_mfma_f32_16x16x32_bf16 v[72:75], a[72:75], a[56:59], v[72:75]
s_add_u32 s81, s81, 1048576
ds_read_b64_tr_b16 a[72:73], v8 offset:16384
v_accvgpr_read_b32 v21, a165
v_mfma_f32_16x16x32_bf16 v[136:139], a[80:83], a[56:59], v[136:139]
buffer_load_dword a252, v16, s[56:59], s81 offen
v_mfma_f32_16x16x32_bf16 v[136:139], a[84:87], a[60:63], v[136:139]
ds_read_b64_tr_b16 a[74:75], v8 offset:17408
v_lshlrev_b32 v18, 16, v19
v_mfma_f32_16x16x32_bf16 v[120:123], a[84:87], a[52:55], v[120:123]
ds_read_b64_tr_b16 a[76:77], v8 offset:24576
v_and_b32 v19, 0xffff0000, v19
v_mfma_f32_16x16x32_bf16 v[120:123], a[80:83], a[48:51], v[120:123]
s_add_u32 m0, s76, 35840
ds_read_b64_tr_b16 a[78:79], v8 offset:25600
v_lshlrev_b32 v20, 16, v21
v_mfma_f32_16x16x32_bf16 v[104:107], a[80:83], a[40:43], v[104:107]
s_add_u32 s64, s70, 25216
ds_read_b128 a[0:3], v2 offset:0
v_and_b32 v21, 0xffff0000, v21
v_mfma_f32_16x16x32_bf16 v[104:107], a[84:87], a[44:47], v[104:107]
buffer_load_dwordx4 v13, s[32:35], s64 offen lds
v_mfma_f32_16x16x32_bf16 v[88:91], a[84:87], a[36:39], v[88:91]
ds_read_b128 a[4:7], v3 offset:0
v_mul_f32 v18, v18, v20
v_mfma_f32_16x16x32_bf16 v[88:91], a[80:83], a[32:35], v[88:91]
s_waitcnt lgkmcnt(6)
ds_read_b128 a[8:11], v2 offset:2048
v_mul_f32 v19, v19, v21
v_mfma_f32_16x16x32_bf16 v[28:31], a[32:35], a[88:91], v[28:31]
ds_read_b128 a[12:15], v3 offset:2048
v_cvt_pk_bf16_f32 v18, v18, v19
v_mfma_f32_16x16x32_bf16 v[28:31], a[36:39], a[92:95], v[28:31]
ds_read_b128 a[16:19], v2 offset:4096
v_lshlrev_b32 v19, 16, v18
v_mfma_f32_16x16x32_bf16 v[44:47], a[44:47], a[92:95], v[44:47]
s_add_u32 m0, s76, 36864
ds_read_b128 a[20:23], v3 offset:4096
v_and_b32 v18, 0xffff0000, v18
v_mfma_f32_16x16x32_bf16 v[44:47], a[40:43], a[88:91], v[44:47]
s_add_u32 s64, s70, 33408
ds_read_b128 a[24:27], v2 offset:6144
v_add_f32 v17, v17, v19
v_mfma_f32_16x16x32_bf16 v[60:63], a[48:51], a[88:91], v[60:63]
buffer_load_dwordx4 v12, s[32:35], s64 offen lds
v_mfma_f32_16x16x32_bf16 v[60:63], a[52:55], a[92:95], v[60:63]
ds_read_b128 a[28:31], v3 offset:6144
v_add_f32 v17, v17, v18
v_mfma_f32_16x16x32_bf16 v[76:79], a[60:63], a[92:95], v[76:79]
ds_read_b64_tr_b16 a[80:81], v9 offset:16384
v_accvgpr_read_b32 v19, a150
v_mfma_f32_16x16x32_bf16 v[76:79], a[56:59], a[88:91], v[76:79]
ds_read_b64_tr_b16 a[82:83], v9 offset:17408
v_accvgpr_read_b32 v21, a166
v_mfma_f32_16x16x32_bf16 v[140:143], a[56:59], a[96:99], v[140:143]
ds_read_b64_tr_b16 a[84:85], v9 offset:24576
v_lshlrev_b32 v18, 16, v19
v_mfma_f32_16x16x32_bf16 v[140:143], a[60:63], a[100:103], v[140:143]
s_add_u32 m0, s76, 37888
ds_read_b64_tr_b16 a[86:87], v9 offset:25600
v_and_b32 v19, 0xffff0000, v19
v_mfma_f32_16x16x32_bf16 v[124:127], a[52:55], a[100:103], v[124:127]
s_add_u32 s64, s70, 41600
ds_read_b64_tr_b16 a[88:89], v10 offset:16384
v_lshlrev_b32 v20, 16, v21
v_mfma_f32_16x16x32_bf16 v[124:127], a[48:51], a[96:99], v[124:127]
buffer_load_dwordx4 v13, s[32:35], s64 offen lds
v_mfma_f32_16x16x32_bf16 v[108:111], a[40:43], a[96:99], v[108:111]
ds_read_b64_tr_b16 a[90:91], v10 offset:17408
v_and_b32 v21, 0xffff0000, v21
v_mfma_f32_16x16x32_bf16 v[108:111], a[44:47], a[100:103], v[108:111]
ds_read_b64_tr_b16 a[92:93], v10 offset:24576
v_mul_f32 v18, v18, v20
v_mfma_f32_16x16x32_bf16 v[92:95], a[36:39], a[100:103], v[92:95]
ds_read_b64_tr_b16 a[94:95], v10 offset:25600
v_mul_f32 v19, v19, v21
v_mfma_f32_16x16x32_bf16 v[92:95], a[32:35], a[96:99], v[92:95]
ds_read_b64_tr_b16 a[96:97], v11 offset:16384
v_cvt_pk_bf16_f32 v18, v18, v19
v_mfma_f32_16x16x32_bf16 v[32:35], a[32:35], a[104:107], v[32:35]
s_add_u32 m0, s76, 38912
ds_read_b64_tr_b16 a[98:99], v11 offset:17408
v_lshlrev_b32 v19, 16, v18
v_mfma_f32_16x16x32_bf16 v[32:35], a[36:39], a[108:111], v[32:35]
s_add_u32 s64, s70, 49792
ds_read_b64_tr_b16 a[100:101], v11 offset:24576
v_and_b32 v18, 0xffff0000, v18
v_mfma_f32_16x16x32_bf16 v[48:51], a[44:47], a[108:111], v[48:51]
buffer_load_dwordx4 v12, s[32:35], s64 offen lds
v_mfma_f32_16x16x32_bf16 v[48:51], a[40:43], a[104:107], v[48:51]
ds_read_b64_tr_b16 a[102:103], v11 offset:25600
v_add_f32 v17, v17, v19
v_mfma_f32_16x16x32_bf16 v[64:67], a[48:51], a[104:107], v[64:67]
v_add_f32 v17, v17, v18
v_accvgpr_read_b32 v19, a151
v_mfma_f32_16x16x32_bf16 v[64:67], a[52:55], a[108:111], v[64:67]
v_accvgpr_read_b32 v21, a167
v_lshlrev_b32 v18, 16, v19
v_mfma_f32_16x16x32_bf16 v[80:83], a[60:63], a[108:111], v[80:83]
s_add_u32 s82, s82, 1048576
v_and_b32 v19, 0xffff0000, v19
v_lshlrev_b32 v20, 16, v21
v_mfma_f32_16x16x32_bf16 v[80:83], a[56:59], a[104:107], v[80:83]
s_add_u32 m0, s76, 39936
v_and_b32 v21, 0xffff0000, v21
v_mul_f32 v18, v18, v20
v_mfma_f32_16x16x32_bf16 v[144:147], a[56:59], a[112:115], v[144:147]
s_add_u32 s64, s70, 57984
buffer_load_dword a252, v1, s[60:63], s82 offen
v_mfma_f32_16x16x32_bf16 v[144:147], a[60:63], a[116:119], v[144:147]
buffer_load_dwordx4 v13, s[32:35], s64 offen lds
v_mfma_f32_16x16x32_bf16 v[128:131], a[52:55], a[116:119], v[128:131]
v_mul_f32 v19, v19, v21
v_cvt_pk_bf16_f32 v18, v18, v19
v_mfma_f32_16x16x32_bf16 v[128:131], a[48:51], a[112:115], v[128:131]
v_lshlrev_b32 v19, 16, v18
v_and_b32 v18, 0xffff0000, v18
v_mfma_f32_16x16x32_bf16 v[112:115], a[40:43], a[112:115], v[112:115]
v_add_f32 v17, v17, v19
v_add_f32 v17, v17, v18
v_mfma_f32_16x16x32_bf16 v[112:115], a[44:47], a[116:119], v[112:115]
v_accvgpr_read_b32 v19, a152
v_accvgpr_read_b32 v21, a168
v_mfma_f32_16x16x32_bf16 v[96:99], a[36:39], a[116:119], v[96:99]
v_lshlrev_b32 v18, 16, v19
v_and_b32 v19, 0xffff0000, v19
v_mfma_f32_16x16x32_bf16 v[96:99], a[32:35], a[112:115], v[96:99]
s_waitcnt lgkmcnt(0)
v_lshlrev_b32 v20, 16, v21
v_and_b32 v21, 0xffff0000, v21
v_mfma_f32_16x16x32_bf16 v[36:39], a[32:35], a[72:75], v[36:39]
v_mul_f32 v18, v18, v20
v_mul_f32 v19, v19, v21
v_mfma_f32_16x16x32_bf16 v[36:39], a[36:39], a[76:79], v[36:39]
v_cvt_pk_bf16_f32 v18, v18, v19
v_lshlrev_b32 v19, 16, v18
v_mfma_f32_16x16x32_bf16 v[52:55], a[44:47], a[76:79], v[52:55]
s_waitcnt lgkmcnt(0)
s_barrier
v_mfma_f32_16x16x32_bf16 v[52:55], a[40:43], a[72:75], v[52:55]
s_add_u32 m0, s77, 65536
ds_read_b64_tr_b16 a[104:105], v4 offset:32768
v_and_b32 v18, 0xffff0000, v18
v_mfma_f32_16x16x32_bf16 v[68:71], a[48:51], a[72:75], v[68:71]
s_add_u32 s64, s71, 3145728
ds_read_b64_tr_b16 a[106:107], v4 offset:33792
v_add_f32 v17, v17, v19
v_mfma_f32_16x16x32_bf16 v[68:71], a[52:55], a[76:79], v[68:71]
buffer_load_dwordx4 v14, s[36:39], s64 offen lds
v_mfma_f32_16x16x32_bf16 v[84:87], a[60:63], a[76:79], v[84:87]
ds_read_b64_tr_b16 a[108:109], v4 offset:40960
v_add_f32 v17, v17, v18
v_mfma_f32_16x16x32_bf16 v[84:87], a[56:59], a[72:75], v[84:87]
ds_read_b64_tr_b16 a[110:111], v4 offset:41984
v_accvgpr_read_b32 v19, a153
v_mfma_f32_16x16x32_bf16 v[148:151], a[56:59], a[80:83], v[148:151]
ds_read_b64_tr_b16 a[112:113], v5 offset:32768
v_accvgpr_read_b32 v21, a169
v_mfma_f32_16x16x32_bf16 v[148:151], a[60:63], a[84:87], v[148:151]
ds_read_b64_tr_b16 a[114:115], v5 offset:33792
v_lshlrev_b32 v18, 16, v19
v_mfma_f32_16x16x32_bf16 v[132:135], a[52:55], a[84:87], v[132:135]
ds_read_b64_tr_b16 a[116:117], v5 offset:40960
v_and_b32 v19, 0xffff0000, v19
v_mfma_f32_16x16x32_bf16 v[132:135], a[48:51], a[80:83], v[132:135]
s_add_u32 m0, s77, 66560
ds_read_b64_tr_b16 a[118:119], v5 offset:41984
v_lshlrev_b32 v20, 16, v21
v_mfma_f32_16x16x32_bf16 v[116:119], a[40:43], a[80:83], v[116:119]
s_add_u32 s64, s71, 3178496
ds_read_b64_tr_b16 a[72:73], v6 offset:32768
v_and_b32 v21, 0xffff0000, v21
v_mfma_f32_16x16x32_bf16 v[116:119], a[44:47], a[84:87], v[116:119]
buffer_load_dwordx4 v14, s[36:39], s64 offen lds
v_mfma_f32_16x16x32_bf16 v[100:103], a[36:39], a[84:87], v[100:103]
ds_read_b64_tr_b16 a[74:75], v6 offset:33792
v_mul_f32 v18, v18, v20
v_mfma_f32_16x16x32_bf16 v[100:103], a[32:35], a[80:83], v[100:103]
ds_read_b64_tr_b16 a[76:77], v6 offset:40960
v_mul_f32 v19, v19, v21
v_mfma_f32_16x16x32_bf16 v[248:251], a[32:35], a[88:91], v[248:251]
ds_read_b64_tr_b16 a[78:79], v6 offset:41984
v_cvt_pk_bf16_f32 v18, v18, v19
v_mfma_f32_16x16x32_bf16 v[248:251], a[36:39], a[92:95], v[248:251]
ds_read_b64_tr_b16 a[80:81], v7 offset:32768
v_lshlrev_b32 v19, 16, v18
v_mfma_f32_16x16x32_bf16 v[252:255], a[44:47], a[92:95], v[252:255]
ds_read_b64_tr_b16 a[82:83], v7 offset:33792
v_and_b32 v18, 0xffff0000, v18
v_mfma_f32_16x16x32_bf16 v[252:255], a[40:43], a[88:91], v[252:255]
s_add_u32 m0, s77, 67584
ds_read_b64_tr_b16 a[84:85], v7 offset:40960
v_add_f32 v17, v17, v19
v_mfma_f32_16x16x32_bf16 a[120:123], a[48:51], a[88:91], a[120:123]
s_add_u32 s64, s71, 3211264
ds_read_b64_tr_b16 a[86:87], v7 offset:41984
v_add_f32 v17, v17, v18
v_mfma_f32_16x16x32_bf16 a[120:123], a[52:55], a[92:95], a[120:123]
buffer_load_dwordx4 v15, s[36:39], s64 offen lds
v_mfma_f32_16x16x32_bf16 a[124:127], a[60:63], a[92:95], a[124:127]
v_accvgpr_read_b32 v19, a154
v_accvgpr_read_b32 v21, a170
v_mfma_f32_16x16x32_bf16 a[124:127], a[56:59], a[88:91], a[124:127]
s_add_u32 s81, s81, 1048576
ds_read_b64_tr_b16 a[88:89], v8 offset:32768
v_lshlrev_b32 v18, 16, v19
v_mfma_f32_16x16x32_bf16 a[128:131], a[56:59], a[96:99], a[128:131]
buffer_load_dword a252, v16, s[56:59], s81 offen
v_mfma_f32_16x16x32_bf16 a[128:131], a[60:63], a[100:103], a[128:131]
ds_read_b64_tr_b16 a[90:91], v8 offset:33792
v_and_b32 v19, 0xffff0000, v19
v_mfma_f32_16x16x32_bf16 a[132:135], a[52:55], a[100:103], a[132:135]
ds_read_b64_tr_b16 a[92:93], v8 offset:40960
v_lshlrev_b32 v20, 16, v21
v_mfma_f32_16x16x32_bf16 a[132:135], a[48:51], a[96:99], a[132:135]
s_add_u32 m0, s77, 68608
ds_read_b64_tr_b16 a[94:95], v8 offset:41984
v_and_b32 v21, 0xffff0000, v21
v_mfma_f32_16x16x32_bf16 a[136:139], a[40:43], a[96:99], a[136:139]
s_add_u32 s64, s71, 3244032
v_mul_f32 v18, v18, v20
v_mul_f32 v19, v19, v21
v_mfma_f32_16x16x32_bf16 a[136:139], a[44:47], a[100:103], a[136:139]
buffer_load_dwordx4 v15, s[36:39], s64 offen lds
v_mfma_f32_16x16x32_bf16 a[140:143], a[36:39], a[100:103], a[140:143]
v_cvt_pk_bf16_f32 v18, v18, v19
v_lshlrev_b32 v19, 16, v18
v_mfma_f32_16x16x32_bf16 a[140:143], a[32:35], a[96:99], a[140:143]
s_waitcnt lgkmcnt(4)
ds_read_b64_tr_b16 a[96:97], v9 offset:32768
v_and_b32 v18, 0xffff0000, v18
v_mfma_f32_16x16x32_bf16 v[184:187], a[104:107], a[0:3], v[184:187]
ds_read_b64_tr_b16 a[98:99], v9 offset:33792
v_add_f32 v17, v17, v19
v_mfma_f32_16x16x32_bf16 v[184:187], a[108:111], a[4:7], v[184:187]
ds_read_b64_tr_b16 a[100:101], v9 offset:40960
v_add_f32 v17, v17, v18
v_mfma_f32_16x16x32_bf16 v[192:195], a[108:111], a[12:15], v[192:195]
s_add_u32 s17, s78, .-L_pc+6144
ds_read_b64_tr_b16 a[102:103], v9 offset:41984
v_accvgpr_read_b32 v19, a155
v_mfma_f32_16x16x32_bf16 v[192:195], a[104:107], a[8:11], v[192:195]
s_add_u32 m0, s77, 81920
v_accvgpr_read_b32 v21, a171
v_lshlrev_b32 v18, 16, v19
v_mfma_f32_16x16x32_bf16 v[200:203], a[104:107], a[16:19], v[200:203]
s_add_u32 s64, s71, 3145728
buffer_load_dword a252, v16, s[88:91], s17 offen
v_mfma_f32_16x16x32_bf16 v[200:203], a[108:111], a[20:23], v[200:203]
buffer_load_dwordx4 v14, s[40:43], s64 offen lds
v_mfma_f32_16x16x32_bf16 v[208:211], a[108:111], a[28:31], v[208:211]
v_and_b32 v19, 0xffff0000, v19
v_lshlrev_b32 v20, 16, v21
v_mfma_f32_16x16x32_bf16 v[208:211], a[104:107], a[24:27], v[208:211]
ds_read_b64_tr_b16 a[104:105], v10 offset:32768
v_and_b32 v21, 0xffff0000, v21
v_mfma_f32_16x16x32_bf16 v[212:215], a[112:115], a[24:27], v[212:215]
ds_read_b64_tr_b16 a[106:107], v10 offset:33792
v_mul_f32 v18, v18, v20
v_mfma_f32_16x16x32_bf16 v[212:215], a[116:119], a[28:31], v[212:215]
ds_read_b64_tr_b16 a[108:109], v10 offset:40960
v_mul_f32 v19, v19, v21
v_mfma_f32_16x16x32_bf16 v[204:207], a[116:119], a[20:23], v[204:207]
ds_read_b64_tr_b16 a[110:111], v10 offset:41984
v_cvt_pk_bf16_f32 v18, v18, v19
v_mfma_f32_16x16x32_bf16 v[204:207], a[112:115], a[16:19], v[204:207]
s_add_u32 m0, s77, 82944
v_lshlrev_b32 v19, 16, v18
v_and_b32 v18, 0xffff0000, v18
v_mfma_f32_16x16x32_bf16 v[196:199], a[112:115], a[8:11], v[196:199]
s_add_u32 s64, s71, 3178496
v_add_f32 v17, v17, v19
v_add_f32 v17, v17, v18
v_mfma_f32_16x16x32_bf16 v[196:199], a[116:119], a[12:15], v[196:199]
buffer_load_dwordx4 v14, s[40:43], s64 offen lds
v_mfma_f32_16x16x32_bf16 v[188:191], a[116:119], a[4:7], v[188:191]
v_accvgpr_read_b32 v19, a156
v_accvgpr_read_b32 v21, a172
v_mfma_f32_16x16x32_bf16 v[188:191], a[112:115], a[0:3], v[188:191]
ds_read_b64_tr_b16 a[112:113], v11 offset:32768
v_lshlrev_b32 v18, 16, v19
v_mfma_f32_16x16x32_bf16 v[216:219], a[72:75], a[0:3], v[216:219]
ds_read_b64_tr_b16 a[114:115], v11 offset:33792
v_and_b32 v19, 0xffff0000, v19
v_mfma_f32_16x16x32_bf16 v[216:219], a[76:79], a[4:7], v[216:219]
ds_read_b64_tr_b16 a[116:117], v11 offset:40960
v_lshlrev_b32 v20, 16, v21
v_mfma_f32_16x16x32_bf16 v[224:227], a[76:79], a[12:15], v[224:227]
ds_read_b64_tr_b16 a[118:119], v11 offset:41984
v_and_b32 v21, 0xffff0000, v21
v_mfma_f32_16x16x32_bf16 v[224:227], a[72:75], a[8:11], v[224:227]
s_add_u32 m0, s77, 83968
v_mul_f32 v18, v18, v20
v_mul_f32 v19, v19, v21
v_mfma_f32_16x16x32_bf16 v[232:235], a[72:75], a[16:19], v[232:235]
s_add_u32 s64, s71, 3211264
v_cvt_pk_bf16_f32 v18, v18, v19
v_lshlrev_b32 v19, 16, v18
v_mfma_f32_16x16x32_bf16 v[232:235], a[76:79], a[20:23], v[232:235]
buffer_load_dwordx4 v15, s[40:43], s64 offen lds
v_mfma_f32_16x16x32_bf16 v[240:243], a[76:79], a[28:31], v[240:243]
v_and_b32 v18, 0xffff0000, v18
v_add_f32 v17, v17, v19
v_mfma_f32_16x16x32_bf16 v[240:243], a[72:75], a[24:27], v[240:243]
s_add_u32 s82, s82, 1048576
ds_read_b64_tr_b16 a[72:73], v4 offset:49152
v_add_f32 v17, v17, v18
v_mfma_f32_16x16x32_bf16 v[244:247], a[80:83], a[24:27], v[244:247]
buffer_load_dword a252, v1, s[60:63], s82 offen
v_mfma_f32_16x16x32_bf16 v[244:247], a[84:87], a[28:31], v[244:247]
ds_read_b64_tr_b16 a[74:75], v4 offset:50176
v_accvgpr_read_b32 v19, a157
v_mfma_f32_16x16x32_bf16 v[236:239], a[84:87], a[20:23], v[236:239]
ds_read_b64_tr_b16 a[76:77], v4 offset:57344
v_accvgpr_read_b32 v21, a173
v_mfma_f32_16x16x32_bf16 v[236:239], a[80:83], a[16:19], v[236:239]
s_add_u32 m0, s77, 84992
ds_read_b64_tr_b16 a[78:79], v4 offset:58368
v_lshlrev_b32 v18, 16, v19
v_mfma_f32_16x16x32_bf16 v[228:231], a[80:83], a[8:11], v[228:231]
s_add_u32 s64, s71, 3244032
v_and_b32 v19, 0xffff0000, v19
v_lshlrev_b32 v20, 16, v21
v_mfma_f32_16x16x32_bf16 v[228:231], a[84:87], a[12:15], v[228:231]
buffer_load_dwordx4 v15, s[40:43], s64 offen lds
v_mfma_f32_16x16x32_bf16 v[220:223], a[84:87], a[4:7], v[220:223]
v_and_b32 v21, 0xffff0000, v21
v_mul_f32 v18, v18, v20
v_mfma_f32_16x16x32_bf16 v[220:223], a[80:83], a[0:3], v[220:223]
s_waitcnt lgkmcnt(4)
ds_read_b64_tr_b16 a[80:81], v5 offset:49152
v_mul_f32 v19, v19, v21
v_mfma_f32_16x16x32_bf16 v[152:155], a[88:91], a[0:3], v[152:155]
ds_read_b64_tr_b16 a[82:83], v5 offset:50176
v_cvt_pk_bf16_f32 v18, v18, v19
v_mfma_f32_16x16x32_bf16 v[152:155], a[92:95], a[4:7], v[152:155]
ds_read_b64_tr_b16 a[84:85], v5 offset:57344
v_lshlrev_b32 v19, 16, v18
v_mfma_f32_16x16x32_bf16 v[160:163], a[92:95], a[12:15], v[160:163]
ds_read_b64_tr_b16 a[86:87], v5 offset:58368
v_and_b32 v18, 0xffff0000, v18
v_mfma_f32_16x16x32_bf16 v[160:163], a[88:91], a[8:11], v[160:163]
v_add_f32 v17, v17, v19
v_add_f32 v17, v17, v18
v_mfma_f32_16x16x32_bf16 v[168:171], a[88:91], a[16:19], v[168:171]
v_accvgpr_read_b32 v19, a158
v_accvgpr_read_b32 v21, a174
v_mfma_f32_16x16x32_bf16 v[168:171], a[92:95], a[20:23], v[168:171]
v_lshlrev_b32 v18, 16, v19
v_and_b32 v19, 0xffff0000, v19
v_mfma_f32_16x16x32_bf16 v[176:179], a[92:95], a[28:31], v[176:179]
s_add_u32 m0, s76, 0
v_lshlrev_b32 v20, 16, v21
v_and_b32 v21, 0xffff0000, v21
v_mfma_f32_16x16x32_bf16 v[176:179], a[88:91], a[24:27], v[176:179]
s_add_u32 s64, s70, 768
ds_read_b64_tr_b16 a[88:89], v6 offset:49152
v_mul_f32 v18, v18, v20
v_mfma_f32_16x16x32_bf16 v[180:183], a[96:99], a[24:27], v[180:183]
buffer_load_dwordx4 v12, s[32:35], s64 offen lds
v_mfma_f32_16x16x32_bf16 v[180:183], a[100:103], a[28:31], v[180:183]
ds_read_b64_tr_b16 a[90:91], v6 offset:50176
v_mul_f32 v19, v19, v21
v_mfma_f32_16x16x32_bf16 v[172:175], a[100:103], a[20:23], v[172:175]
ds_read_b64_tr_b16 a[92:93], v6 offset:57344
v_cvt_pk_bf16_f32 v18, v18, v19
v_mfma_f32_16x16x32_bf16 v[172:175], a[96:99], a[16:19], v[172:175]
ds_read_b64_tr_b16 a[94:95], v6 offset:58368
v_lshlrev_b32 v19, 16, v18
v_mfma_f32_16x16x32_bf16 v[164:167], a[96:99], a[8:11], v[164:167]
v_and_b32 v18, 0xffff0000, v18
v_add_f32 v17, v17, v19
v_mfma_f32_16x16x32_bf16 v[164:167], a[100:103], a[12:15], v[164:167]
s_add_u32 m0, s76, 1024
v_add_f32 v17, v17, v18
v_accvgpr_read_b32 v19, a159
v_mfma_f32_16x16x32_bf16 v[156:159], a[100:103], a[4:7], v[156:159]
s_add_u32 s64, s70, 8960
v_accvgpr_read_b32 v21, a175
v_lshlrev_b32 v18, 16, v19
v_mfma_f32_16x16x32_bf16 v[156:159], a[96:99], a[0:3], v[156:159]
buffer_load_dwordx4 v13, s[32:35], s64 offen lds
v_mfma_f32_16x16x32_bf16 v[24:27], a[104:107], a[0:3], v[24:27]
ds_read_b64_tr_b16 a[96:97], v7 offset:49152
v_and_b32 v19, 0xffff0000, v19
v_mfma_f32_16x16x32_bf16 v[24:27], a[108:111], a[4:7], v[24:27]
ds_read_b64_tr_b16 a[98:99], v7 offset:50176
v_lshlrev_b32 v20, 16, v21
v_mfma_f32_16x16x32_bf16 v[40:43], a[108:111], a[12:15], v[40:43]
ds_read_b64_tr_b16 a[100:101], v7 offset:57344
v_and_b32 v21, 0xffff0000, v21
v_mfma_f32_16x16x32_bf16 v[40:43], a[104:107], a[8:11], v[40:43]
ds_read_b64_tr_b16 a[102:103], v7 offset:58368
v_mul_f32 v18, v18, v20
v_mfma_f32_16x16x32_bf16 v[56:59], a[104:107], a[16:19], v[56:59]
s_add_u32 m0, s76, 2048
v_mul_f32 v19, v19, v21
v_cvt_pk_bf16_f32 v18, v18, v19
v_mfma_f32_16x16x32_bf16 v[56:59], a[108:111], a[20:23], v[56:59]
s_add_u32 s64, s70, 17152
v_lshlrev_b32 v19, 16, v18
v_and_b32 v18, 0xffff0000, v18
v_mfma_f32_16x16x32_bf16 v[72:75], a[108:111], a[28:31], v[72:75]
s_waitcnt vmcnt(13)
buffer_load_dwordx4 v12, s[32:35], s64 offen lds
v_mfma_f32_16x16x32_bf16 v[72:75], a[104:107], a[24:27], v[72:75]
s_add_u32 s81, s81, 1048576
ds_read_b64_tr_b16 a[104:105], v8 offset:49152
v_add_f32 v17, v17, v19
v_mfma_f32_16x16x32_bf16 v[136:139], a[112:115], a[24:27], v[136:139]
buffer_load_dword a252, v16, s[56:59], s81 offen
v_mfma_f32_16x16x32_bf16 v[136:139], a[116:119], a[28:31], v[136:139]
ds_read_b64_tr_b16 a[106:107], v8 offset:50176
v_add_u32 v4, 0x8000, v4
v_mfma_f32_16x16x32_bf16 v[120:123], a[116:119], a[20:23], v[120:123]
ds_read_b64_tr_b16 a[108:109], v8 offset:57344
v_add_f32 v17, v17, v18
v_mfma_f32_16x16x32_bf16 v[120:123], a[112:115], a[16:19], v[120:123]
s_add_u32 m0, s76, 3072
ds_read_b64_tr_b16 a[110:111], v8 offset:58368
v_mfma_f32_16x16x32_bf16 v[104:107], a[112:115], a[8:11], v[104:107]
s_add_u32 s64, s70, 25344
ds_read_b128 a[32:35], v2 offset:32768
v_add_f32_dpp v17, v17, v17 row_ror:8 row_mask:0xf bank_mask:0xf
v_mfma_f32_16x16x32_bf16 v[104:107], a[116:119], a[12:15], v[104:107]
buffer_load_dwordx4 v13, s[32:35], s64 offen lds
v_mfma_f32_16x16x32_bf16 v[88:91], a[116:119], a[4:7], v[88:91]
ds_read_b128 a[36:39], v3 offset:32768
v_add_f32_dpp v17, v17, v17 row_ror:4 row_mask:0xf bank_mask:0xf
v_mfma_f32_16x16x32_bf16 v[88:91], a[112:115], a[0:3], v[88:91]
s_waitcnt lgkmcnt(6)
ds_read_b128 a[40:43], v2 offset:34816
v_mfma_f32_16x16x32_bf16 v[28:31], a[0:3], a[72:75], v[28:31]
ds_read_b128 a[44:47], v3 offset:34816
v_add_f32_dpp v17, v17, v17 row_ror:2 row_mask:0xf bank_mask:0xf
v_mfma_f32_16x16x32_bf16 v[28:31], a[4:7], a[76:79], v[28:31]
ds_read_b128 a[48:51], v2 offset:36864
v_add_u32 v5, 0x8000, v5
v_mfma_f32_16x16x32_bf16 v[44:47], a[12:15], a[76:79], v[44:47]
s_add_u32 m0, s76, 4096
ds_read_b128 a[52:55], v3 offset:36864
v_add_f32_dpp v17, v17, v17 row_ror:1 row_mask:0xf bank_mask:0xf
v_mfma_f32_16x16x32_bf16 v[44:47], a[8:11], a[72:75], v[44:47]
s_add_u32 s64, s70, 33536
ds_read_b128 a[56:59], v2 offset:38912
v_mov_b32 v18, v17
v_mfma_f32_16x16x32_bf16 v[60:63], a[16:19], a[72:75], v[60:63]
buffer_load_dwordx4 v12, s[32:35], s64 offen lds
v_mfma_f32_16x16x32_bf16 v[60:63], a[20:23], a[76:79], v[60:63]
ds_read_b128 a[60:63], v3 offset:38912
v_permlane16_swap_b32 v18, v17
v_mfma_f32_16x16x32_bf16 v[76:79], a[28:31], a[76:79], v[76:79]
ds_read_b64_tr_b16 a[112:113], v9 offset:49152
v_add_f32 v17, v17, v18
v_mfma_f32_16x16x32_bf16 v[76:79], a[24:27], a[72:75], v[76:79]
ds_read_b64_tr_b16 a[114:115], v9 offset:50176
v_cvt_pk_bf16_f32 v17, v17, v17
v_mfma_f32_16x16x32_bf16 v[140:143], a[24:27], a[80:83], v[140:143]
ds_read_b64_tr_b16 a[116:117], v9 offset:57344
v_and_b32 v17, 0xffff0000, v17
v_mfma_f32_16x16x32_bf16 v[140:143], a[28:31], a[84:87], v[140:143]
s_add_u32 m0, s76, 5120
ds_read_b64_tr_b16 a[118:119], v9 offset:58368
v_add_u32 v6, 0x8000, v6
v_mfma_f32_16x16x32_bf16 v[124:127], a[20:23], a[84:87], v[124:127]
s_add_u32 s64, s70, 41728
ds_read_b64_tr_b16 a[72:73], v10 offset:49152
v_mul_f32 v17, 0xbfb8aa3b, v17
v_mfma_f32_16x16x32_bf16 v[124:127], a[16:19], a[80:83], v[124:127]
buffer_load_dwordx4 v13, s[32:35], s64 offen lds
v_mfma_f32_16x16x32_bf16 v[108:111], a[8:11], a[80:83], v[108:111]
ds_read_b64_tr_b16 a[74:75], v10 offset:50176
v_mfma_f32_16x16x32_bf16 v[108:111], a[12:15], a[84:87], v[108:111]
ds_read_b64_tr_b16 a[76:77], v10 offset:57344
v_mfma_f32_16x16x32_bf16 v[92:95], a[4:7], a[84:87], v[92:95]
ds_read_b64_tr_b16 a[78:79], v10 offset:58368
v_mfma_f32_16x16x32_bf16 v[92:95], a[0:3], a[80:83], v[92:95]
ds_read_b64_tr_b16 a[80:81], v11 offset:49152
v_mfma_f32_16x16x32_bf16 v[32:35], a[0:3], a[88:91], v[32:35]
s_add_u32 m0, s76, 6144
ds_read_b64_tr_b16 a[82:83], v11 offset:50176
v_mfma_f32_16x16x32_bf16 v[32:35], a[4:7], a[92:95], v[32:35]
s_add_u32 s64, s70, 49920
ds_read_b64_tr_b16 a[84:85], v11 offset:57344
v_add_u32 v7, 0x8000, v7
v_mfma_f32_16x16x32_bf16 v[48:51], a[12:15], a[92:95], v[48:51]
buffer_load_dwordx4 v12, s[32:35], s64 offen lds
v_mfma_f32_16x16x32_bf16 v[48:51], a[8:11], a[88:91], v[48:51]
ds_read_b64_tr_b16 a[86:87], v11 offset:58368
v_mfma_f32_16x16x32_bf16 v[64:67], a[16:19], a[88:91], v[64:67]
v_exp_f32 v17, v17
v_mfma_f32_16x16x32_bf16 v[64:67], a[20:23], a[92:95], v[64:67]
v_add_f32 v17, 1.0, v17
v_mfma_f32_16x16x32_bf16 v[80:83], a[28:31], a[92:95], v[80:83]
v_rcp_f32 v17, v17
v_mfma_f32_16x16x32_bf16 v[80:83], a[24:27], a[88:91], v[80:83]
s_add_u32 m0, s76, 7168
s_add_u32 s81, s81, 1048576
v_cvt_pk_bf16_f32 v18, v17, v17
v_mfma_f32_16x16x32_bf16 v[144:147], a[24:27], a[96:99], v[144:147]
s_add_u32 s64, s70, 58112
buffer_load_dword a252, v16, s[56:59], s81 offen
v_mfma_f32_16x16x32_bf16 v[144:147], a[28:31], a[100:103], v[144:147]
buffer_load_dwordx4 v13, s[32:35], s64 offen lds
v_mfma_f32_16x16x32_bf16 v[128:131], a[20:23], a[100:103], v[128:131]
v_add_u32 v8, 0x8000, v8
v_and_b32 v18, 0xffff0000, v18
v_mfma_f32_16x16x32_bf16 v[128:131], a[16:19], a[96:99], v[128:131]
v_sub_f32 v19, 1.0, v18
v_mfma_f32_16x16x32_bf16 v[112:115], a[8:11], a[96:99], v[112:115]
v_cvt_pk_bf16_f32 v19, v19, v19
v_mfma_f32_16x16x32_bf16 v[112:115], a[12:15], a[100:103], v[112:115]
v_and_b32 v19, 0xffff0000, v19
v_mfma_f32_16x16x32_bf16 v[96:99], a[4:7], a[100:103], v[96:99]
v_add_u32 v9, 0x8000, v9
v_add_u32 v10, 0x8000, v10
v_mfma_f32_16x16x32_bf16 v[96:99], a[0:3], a[96:99], v[96:99]
s_waitcnt lgkmcnt(0)
v_add_u32 v11, 0x8000, v11
v_and_b32 v20, 31, v0
v_mfma_f32_16x16x32_bf16 v[36:39], a[0:3], a[104:107], v[36:39]
v_lshlrev_b32 v20, 27, v20
v_mfma_f32_16x16x32_bf16 v[36:39], a[4:7], a[108:111], v[36:39]
v_lshrrev_b32 v21, 2, v0
v_mfma_f32_16x16x32_bf16 v[52:55], a[12:15], a[108:111], v[52:55]
s_waitcnt lgkmcnt(0)
s_barrier
v_mfma_f32_16x16x32_bf16 v[52:55], a[8:11], a[104:107], v[52:55]
s_add_u32 m0, s77, 98304
ds_read_b64_tr_b16 a[88:89], v4 offset:32768
v_add_u32 v20, v20, v21
v_mfma_f32_16x16x32_bf16 v[68:71], a[16:19], a[104:107], v[68:71]
s_add_u32 s64, s71, 3670016
ds_read_b64_tr_b16 a[90:91], v4 offset:33792
v_mfma_f32_16x16x32_bf16 v[68:71], a[20:23], a[108:111], v[68:71]
buffer_load_dwordx4 v14, s[36:39], s64 offen lds
v_mfma_f32_16x16x32_bf16 v[84:87], a[28:31], a[108:111], v[84:87]
ds_read_b64_tr_b16 a[92:93], v4 offset:40960
v_mfma_f32_16x16x32_bf16 v[84:87], a[24:27], a[104:107], v[84:87]
ds_read_b64_tr_b16 a[94:95], v4 offset:41984
v_mfma_f32_16x16x32_bf16 v[148:151], a[24:27], a[112:115], v[148:151]
ds_read_b64_tr_b16 a[96:97], v5 offset:32768
v_mfma_f32_16x16x32_bf16 v[148:151], a[28:31], a[116:119], v[148:151]
ds_read_b64_tr_b16 a[98:99], v5 offset:33792
v_mfma_f32_16x16x32_bf16 v[132:135], a[20:23], a[116:119], v[132:135]
ds_read_b64_tr_b16 a[100:101], v5 offset:40960
v_mfma_f32_16x16x32_bf16 v[132:135], a[16:19], a[112:115], v[132:135]
s_add_u32 m0, s77, 99328
ds_read_b64_tr_b16 a[102:103], v5 offset:41984
v_mfma_f32_16x16x32_bf16 v[116:119], a[8:11], a[112:115], v[116:119]
s_add_u32 s64, s71, 3702784
ds_read_b64_tr_b16 a[104:105], v6 offset:32768
v_mfma_f32_16x16x32_bf16 v[116:119], a[12:15], a[116:119], v[116:119]
buffer_load_dwordx4 v14, s[36:39], s64 offen lds
v_mfma_f32_16x16x32_bf16 v[100:103], a[4:7], a[116:119], v[100:103]
ds_read_b64_tr_b16 a[106:107], v6 offset:33792
v_mfma_f32_16x16x32_bf16 v[100:103], a[0:3], a[112:115], v[100:103]
ds_read_b64_tr_b16 a[108:109], v6 offset:40960
v_mfma_f32_16x16x32_bf16 v[248:251], a[0:3], a[72:75], v[248:251]
ds_read_b64_tr_b16 a[110:111], v6 offset:41984
v_mfma_f32_16x16x32_bf16 v[248:251], a[4:7], a[76:79], v[248:251]
ds_read_b64_tr_b16 a[112:113], v7 offset:32768
v_mfma_f32_16x16x32_bf16 v[252:255], a[12:15], a[76:79], v[252:255]
ds_read_b64_tr_b16 a[114:115], v7 offset:33792
v_mfma_f32_16x16x32_bf16 v[252:255], a[8:11], a[72:75], v[252:255]
s_add_u32 m0, s77, 100352
ds_read_b64_tr_b16 a[116:117], v7 offset:40960
v_mfma_f32_16x16x32_bf16 a[120:123], a[16:19], a[72:75], a[120:123]
s_add_u32 s64, s71, 3735552
s_lshl2_add_u32 s65, s2, s30
ds_read_b64_tr_b16 a[118:119], v7 offset:41984
v_mfma_f32_16x16x32_bf16 a[120:123], a[20:23], a[76:79], a[120:123]
s_lshl4_add_u32 s65, s65, 58720256
buffer_load_dwordx4 v15, s[36:39], s64 offen lds
v_mfma_f32_16x16x32_bf16 a[124:127], a[28:31], a[76:79], a[124:127]
buffer_store_dwordx2 v[18:19], v20, s[44:47], s65 offen sc1
v_mfma_f32_16x16x32_bf16 a[124:127], a[24:27], a[72:75], a[124:127]
s_add_u32 s82, s82, 1048576
ds_read_b64_tr_b16 a[72:73], v8 offset:32768
v_lshrrev_b32 v21, 4, v0
v_mfma_f32_16x16x32_bf16 a[128:131], a[24:27], a[80:83], a[128:131]
buffer_load_dword a252, v1, s[60:63], s82 offen
v_mfma_f32_16x16x32_bf16 a[128:131], a[28:31], a[84:87], a[128:131]
ds_read_b64_tr_b16 a[74:75], v8 offset:33792
v_bfe_u32 v19, v0, 2, 2
v_mfma_f32_16x16x32_bf16 a[132:135], a[20:23], a[84:87], a[132:135]
ds_read_b64_tr_b16 a[76:77], v8 offset:40960
v_lshl_add_u32 v19, v21, 3, v19
v_mfma_f32_16x16x32_bf16 a[132:135], a[16:19], a[80:83], a[132:135]
s_add_u32 m0, s77, 101376
ds_read_b64_tr_b16 a[78:79], v8 offset:41984
v_lshlrev_b32 v19, 6, v19
v_mfma_f32_16x16x32_bf16 a[136:139], a[8:11], a[80:83], a[136:139]
s_add_u32 s64, s71, 3768320
v_and_b32 v21, 1, v21
v_mfma_f32_16x16x32_bf16 a[136:139], a[12:15], a[84:87], a[136:139]
buffer_load_dwordx4 v15, s[36:39], s64 offen lds
v_mfma_f32_16x16x32_bf16 a[140:143], a[4:7], a[84:87], a[140:143]
v_lshl_add_u32 v19, v21, 5, v19
v_mfma_f32_16x16x32_bf16 a[140:143], a[0:3], a[80:83], a[140:143]
s_waitcnt lgkmcnt(4)
ds_read_b64_tr_b16 a[80:81], v9 offset:32768
v_and_b32 v21, 3, v0
v_mfma_f32_16x16x32_bf16 v[184:187], a[88:91], a[32:35], v[184:187]
ds_read_b64_tr_b16 a[82:83], v9 offset:33792
v_lshl_add_u32 v19, v21, 3, v19
v_mfma_f32_16x16x32_bf16 v[184:187], a[92:95], a[36:39], v[184:187]
ds_read_b64_tr_b16 a[84:85], v9 offset:40960
v_add_u32 v19, 114688, v19
v_mfma_f32_16x16x32_bf16 v[192:195], a[92:95], a[44:47], v[192:195]
ds_read_b64_tr_b16 a[86:87], v9 offset:41984
v_xor_b32 v20, 32, v19
v_mfma_f32_16x16x32_bf16 v[192:195], a[88:91], a[40:43], v[192:195]
s_add_u32 m0, s77, 114688
v_mfma_f32_16x16x32_bf16 v[200:203], a[88:91], a[48:51], v[200:203]
s_add_u32 s64, s71, 3670016
v_mfma_f32_16x16x32_bf16 v[200:203], a[92:95], a[52:55], v[200:203]
buffer_load_dwordx4 v14, s[40:43], s64 offen lds
v_mfma_f32_16x16x32_bf16 v[208:211], a[92:95], a[60:63], v[208:211]
v_mfma_f32_16x16x32_bf16 v[208:211], a[88:91], a[56:59], v[208:211]
ds_read_b64_tr_b16 a[88:89], v10 offset:32768
v_mfma_f32_16x16x32_bf16 v[212:215], a[96:99], a[56:59], v[212:215]
ds_read_b64_tr_b16 a[90:91], v10 offset:33792
v_mfma_f32_16x16x32_bf16 v[212:215], a[100:103], a[60:63], v[212:215]
ds_read_b64_tr_b16 a[92:93], v10 offset:40960
v_mfma_f32_16x16x32_bf16 v[204:207], a[100:103], a[52:55], v[204:207]
ds_read_b64_tr_b16 a[94:95], v10 offset:41984
v_mfma_f32_16x16x32_bf16 v[204:207], a[96:99], a[48:51], v[204:207]
s_add_u32 m0, s77, 115712
v_mfma_f32_16x16x32_bf16 v[196:199], a[96:99], a[40:43], v[196:199]
s_add_u32 s64, s71, 3702784
v_mfma_f32_16x16x32_bf16 v[196:199], a[100:103], a[44:47], v[196:199]
buffer_load_dwordx4 v14, s[40:43], s64 offen lds
v_mfma_f32_16x16x32_bf16 v[188:191], a[100:103], a[36:39], v[188:191]
v_mfma_f32_16x16x32_bf16 v[188:191], a[96:99], a[32:35], v[188:191]
ds_read_b64_tr_b16 a[96:97], v11 offset:32768
v_mfma_f32_16x16x32_bf16 v[216:219], a[104:107], a[32:35], v[216:219]
ds_read_b64_tr_b16 a[98:99], v11 offset:33792
v_mfma_f32_16x16x32_bf16 v[216:219], a[108:111], a[36:39], v[216:219]
ds_read_b64_tr_b16 a[100:101], v11 offset:40960
v_mfma_f32_16x16x32_bf16 v[224:227], a[108:111], a[44:47], v[224:227]
ds_read_b64_tr_b16 a[102:103], v11 offset:41984
v_mfma_f32_16x16x32_bf16 v[224:227], a[104:107], a[40:43], v[224:227]
s_add_u32 m0, s77, 116736
v_mfma_f32_16x16x32_bf16 v[232:235], a[104:107], a[48:51], v[232:235]
s_add_u32 s64, s71, 3735552
v_mfma_f32_16x16x32_bf16 v[232:235], a[108:111], a[52:55], v[232:235]
buffer_load_dwordx4 v15, s[40:43], s64 offen lds
v_mfma_f32_16x16x32_bf16 v[240:243], a[108:111], a[60:63], v[240:243]
v_mfma_f32_16x16x32_bf16 v[240:243], a[104:107], a[56:59], v[240:243]
s_add_u32 s81, s81, 1048576
ds_read_b64_tr_b16 a[104:105], v4 offset:49152
v_mfma_f32_16x16x32_bf16 v[244:247], a[112:115], a[56:59], v[244:247]
buffer_load_dword a252, v16, s[56:59], s81 offen
v_mfma_f32_16x16x32_bf16 v[244:247], a[116:119], a[60:63], v[244:247]
ds_read_b64_tr_b16 a[106:107], v4 offset:50176
v_mfma_f32_16x16x32_bf16 v[236:239], a[116:119], a[52:55], v[236:239]
ds_read_b64_tr_b16 a[108:109], v4 offset:57344
v_mfma_f32_16x16x32_bf16 v[236:239], a[112:115], a[48:51], v[236:239]
s_add_u32 m0, s77, 117760
ds_read_b64_tr_b16 a[110:111], v4 offset:58368
v_mfma_f32_16x16x32_bf16 v[228:231], a[112:115], a[40:43], v[228:231]
s_add_u32 s64, s71, 3768320
v_mfma_f32_16x16x32_bf16 v[228:231], a[116:119], a[44:47], v[228:231]
buffer_load_dwordx4 v15, s[40:43], s64 offen lds
v_mfma_f32_16x16x32_bf16 v[220:223], a[116:119], a[36:39], v[220:223]
v_mfma_f32_16x16x32_bf16 v[220:223], a[112:115], a[32:35], v[220:223]
s_waitcnt lgkmcnt(4)
ds_read_b64_tr_b16 a[112:113], v5 offset:49152
v_mfma_f32_16x16x32_bf16 v[152:155], a[72:75], a[32:35], v[152:155]
ds_read_b64_tr_b16 a[114:115], v5 offset:50176
v_mfma_f32_16x16x32_bf16 v[152:155], a[76:79], a[36:39], v[152:155]
ds_read_b64_tr_b16 a[116:117], v5 offset:57344
v_mfma_f32_16x16x32_bf16 v[160:163], a[76:79], a[44:47], v[160:163]
ds_read_b64_tr_b16 a[118:119], v5 offset:58368
v_mfma_f32_16x16x32_bf16 v[160:163], a[72:75], a[40:43], v[160:163]
v_mfma_f32_16x16x32_bf16 v[168:171], a[72:75], a[48:51], v[168:171]
v_mfma_f32_16x16x32_bf16 v[168:171], a[76:79], a[52:55], v[168:171]
v_mfma_f32_16x16x32_bf16 v[176:179], a[76:79], a[60:63], v[176:179]
s_add_u32 m0, s76, 32768
v_mfma_f32_16x16x32_bf16 v[176:179], a[72:75], a[56:59], v[176:179]
s_add_u32 s64, s70, 896
ds_read_b64_tr_b16 a[72:73], v6 offset:49152
v_mfma_f32_16x16x32_bf16 v[180:183], a[80:83], a[56:59], v[180:183]
buffer_load_dwordx4 v12, s[32:35], s64 offen lds
v_mfma_f32_16x16x32_bf16 v[180:183], a[84:87], a[60:63], v[180:183]
ds_read_b64_tr_b16 a[74:75], v6 offset:50176
v_mfma_f32_16x16x32_bf16 v[172:175], a[84:87], a[52:55], v[172:175]
ds_read_b64_tr_b16 a[76:77], v6 offset:57344
v_mfma_f32_16x16x32_bf16 v[172:175], a[80:83], a[48:51], v[172:175]
ds_read_b64_tr_b16 a[78:79], v6 offset:58368
v_mfma_f32_16x16x32_bf16 v[164:167], a[80:83], a[40:43], v[164:167]
v_mfma_f32_16x16x32_bf16 v[164:167], a[84:87], a[44:47], v[164:167]
s_add_u32 m0, s76, 33792
v_mfma_f32_16x16x32_bf16 v[156:159], a[84:87], a[36:39], v[156:159]
s_add_u32 s64, s70, 9088
v_mfma_f32_16x16x32_bf16 v[156:159], a[80:83], a[32:35], v[156:159]
buffer_load_dwordx4 v13, s[32:35], s64 offen lds
v_mfma_f32_16x16x32_bf16 v[24:27], a[88:91], a[32:35], v[24:27]
ds_read_b64_tr_b16 a[80:81], v7 offset:49152
v_mfma_f32_16x16x32_bf16 v[24:27], a[92:95], a[36:39], v[24:27]
ds_read_b64_tr_b16 a[82:83], v7 offset:50176
v_mfma_f32_16x16x32_bf16 v[40:43], a[92:95], a[44:47], v[40:43]
ds_read_b64_tr_b16 a[84:85], v7 offset:57344
v_mfma_f32_16x16x32_bf16 v[40:43], a[88:91], a[40:43], v[40:43]
ds_read_b64_tr_b16 a[86:87], v7 offset:58368
v_mfma_f32_16x16x32_bf16 v[56:59], a[88:91], a[48:51], v[56:59]
s_add_u32 m0, s76, 34816
v_mfma_f32_16x16x32_bf16 v[56:59], a[92:95], a[52:55], v[56:59]
s_add_u32 s64, s70, 17280
v_mfma_f32_16x16x32_bf16 v[72:75], a[92:95], a[60:63], v[72:75]
s_waitcnt vmcnt(13)
buffer_load_dwordx4 v12, s[32:35], s64 offen lds
v_mfma_f32_16x16x32_bf16 v[72:75], a[88:91], a[56:59], v[72:75]
s_add_u32 s82, s82, 1048576
ds_read_b64_tr_b16 a[88:89], v8 offset:49152
v_mfma_f32_16x16x32_bf16 v[136:139], a[96:99], a[56:59], v[136:139]
buffer_load_dword a252, v1, s[60:63], s82 offen
v_mfma_f32_16x16x32_bf16 v[136:139], a[100:103], a[60:63], v[136:139]
ds_read_b64_tr_b16 a[90:91], v8 offset:50176
v_subrev_u32 v4, 0x8000, v4
v_mfma_f32_16x16x32_bf16 v[120:123], a[100:103], a[52:55], v[120:123]
ds_read_b64_tr_b16 a[92:93], v8 offset:57344
v_mfma_f32_16x16x32_bf16 v[120:123], a[96:99], a[48:51], v[120:123]
s_add_u32 m0, s76, 35840
ds_read_b64_tr_b16 a[94:95], v8 offset:58368
v_mfma_f32_16x16x32_bf16 v[104:107], a[96:99], a[40:43], v[104:107]
s_add_u32 s64, s70, 25472
ds_read_b128 a[0:3], v2 offset:0
v_mfma_f32_16x16x32_bf16 v[104:107], a[100:103], a[44:47], v[104:107]
buffer_load_dwordx4 v13, s[32:35], s64 offen lds
v_mfma_f32_16x16x32_bf16 v[88:91], a[100:103], a[36:39], v[88:91]
ds_read_b128 a[4:7], v3 offset:0
v_mfma_f32_16x16x32_bf16 v[88:91], a[96:99], a[32:35], v[88:91]
s_waitcnt lgkmcnt(6)
ds_read_b128 a[8:11], v2 offset:2048
v_mfma_f32_16x16x32_bf16 v[28:31], a[32:35], a[104:107], v[28:31]
ds_read_b128 a[12:15], v3 offset:2048
v_mfma_f32_16x16x32_bf16 v[28:31], a[36:39], a[108:111], v[28:31]
ds_read_b128 a[16:19], v2 offset:4096
v_subrev_u32 v5, 0x8000, v5
v_mfma_f32_16x16x32_bf16 v[44:47], a[44:47], a[108:111], v[44:47]
s_add_u32 m0, s76, 36864
ds_read_b128 a[20:23], v3 offset:4096
v_mfma_f32_16x16x32_bf16 v[44:47], a[40:43], a[104:107], v[44:47]
s_add_u32 s64, s70, 33664
ds_read_b128 a[24:27], v2 offset:6144
v_mfma_f32_16x16x32_bf16 v[60:63], a[48:51], a[104:107], v[60:63]
buffer_load_dwordx4 v12, s[32:35], s64 offen lds
v_mfma_f32_16x16x32_bf16 v[60:63], a[52:55], a[108:111], v[60:63]
ds_read_b128 a[28:31], v3 offset:6144
v_mfma_f32_16x16x32_bf16 v[76:79], a[60:63], a[108:111], v[76:79]
ds_read_b64_tr_b16 a[96:97], v9 offset:49152
v_mfma_f32_16x16x32_bf16 v[76:79], a[56:59], a[104:107], v[76:79]
ds_read_b64_tr_b16 a[98:99], v9 offset:50176
v_mfma_f32_16x16x32_bf16 v[140:143], a[56:59], a[112:115], v[140:143]
ds_read_b64_tr_b16 a[100:101], v9 offset:57344
v_mfma_f32_16x16x32_bf16 v[140:143], a[60:63], a[116:119], v[140:143]
s_add_u32 m0, s76, 37888
ds_read_b64_tr_b16 a[102:103], v9 offset:58368
v_subrev_u32 v6, 0x8000, v6
v_mfma_f32_16x16x32_bf16 v[124:127], a[52:55], a[116:119], v[124:127]
s_add_u32 s64, s70, 41856
ds_read_b64_tr_b16 a[104:105], v10 offset:49152
v_mfma_f32_16x16x32_bf16 v[124:127], a[48:51], a[112:115], v[124:127]
buffer_load_dwordx4 v13, s[32:35], s64 offen lds
v_mfma_f32_16x16x32_bf16 v[108:111], a[40:43], a[112:115], v[108:111]
ds_read_b64_tr_b16 a[106:107], v10 offset:50176
v_mfma_f32_16x16x32_bf16 v[108:111], a[44:47], a[116:119], v[108:111]
ds_read_b64_tr_b16 a[108:109], v10 offset:57344
v_mfma_f32_16x16x32_bf16 v[92:95], a[36:39], a[116:119], v[92:95]
ds_read_b64_tr_b16 a[110:111], v10 offset:58368
v_mfma_f32_16x16x32_bf16 v[92:95], a[32:35], a[112:115], v[92:95]
ds_read_b64_tr_b16 a[112:113], v11 offset:49152
v_mfma_f32_16x16x32_bf16 v[32:35], a[32:35], a[72:75], v[32:35]
s_add_u32 m0, s76, 38912
ds_read_b64_tr_b16 a[114:115], v11 offset:50176
v_mfma_f32_16x16x32_bf16 v[32:35], a[36:39], a[76:79], v[32:35]
s_add_u32 s64, s70, 50048
ds_read_b64_tr_b16 a[116:117], v11 offset:57344
v_subrev_u32 v7, 0x8000, v7
v_mfma_f32_16x16x32_bf16 v[48:51], a[44:47], a[76:79], v[48:51]
buffer_load_dwordx4 v12, s[32:35], s64 offen lds
v_mfma_f32_16x16x32_bf16 v[48:51], a[40:43], a[72:75], v[48:51]
ds_read_b64_tr_b16 a[118:119], v11 offset:58368
v_mfma_f32_16x16x32_bf16 v[64:67], a[48:51], a[72:75], v[64:67]
v_mfma_f32_16x16x32_bf16 v[64:67], a[52:55], a[76:79], v[64:67]
v_mfma_f32_16x16x32_bf16 v[80:83], a[60:63], a[76:79], v[80:83]
v_mfma_f32_16x16x32_bf16 v[80:83], a[56:59], a[72:75], v[80:83]
s_add_u32 m0, s76, 39936
v_mfma_f32_16x16x32_bf16 v[144:147], a[56:59], a[80:83], v[144:147]
s_add_u32 s64, s70, 58240
v_mfma_f32_16x16x32_bf16 v[144:147], a[60:63], a[84:87], v[144:147]
buffer_load_dwordx4 v13, s[32:35], s64 offen lds
v_mfma_f32_16x16x32_bf16 v[128:131], a[52:55], a[84:87], v[128:131]
v_subrev_u32 v8, 0x8000, v8
v_mfma_f32_16x16x32_bf16 v[128:131], a[48:51], a[80:83], v[128:131]
v_mfma_f32_16x16x32_bf16 v[112:115], a[40:43], a[80:83], v[112:115]
v_mfma_f32_16x16x32_bf16 v[112:115], a[44:47], a[84:87], v[112:115]
v_mfma_f32_16x16x32_bf16 v[96:99], a[36:39], a[84:87], v[96:99]
v_subrev_u32 v9, 0x8000, v9
v_subrev_u32 v10, 0x8000, v10
v_mfma_f32_16x16x32_bf16 v[96:99], a[32:35], a[80:83], v[96:99]
s_waitcnt lgkmcnt(0)
v_subrev_u32 v11, 0x8000, v11
v_mfma_f32_16x16x32_bf16 v[36:39], a[32:35], a[88:91], v[36:39]
v_mfma_f32_16x16x32_bf16 v[36:39], a[36:39], a[92:95], v[36:39]
v_mfma_f32_16x16x32_bf16 v[52:55], a[44:47], a[92:95], v[52:55]
s_waitcnt lgkmcnt(0)
s_barrier
v_mfma_f32_16x16x32_bf16 v[52:55], a[40:43], a[88:91], v[52:55]
s_add_u32 m0, s77, 131072
ds_read_b64_tr_b16 a[72:73], v4 offset:0
v_mfma_f32_16x16x32_bf16 v[68:71], a[48:51], a[88:91], v[68:71]
s_add_u32 s64, s71, 0
ds_read_b64_tr_b16 a[74:75], v4 offset:1024
v_mfma_f32_16x16x32_bf16 v[68:71], a[52:55], a[92:95], v[68:71]
buffer_load_dwordx4 v14, s[56:59], s64 offen lds
v_mfma_f32_16x16x32_bf16 v[84:87], a[60:63], a[92:95], v[84:87]
ds_read_b64_tr_b16 a[76:77], v4 offset:8192
v_mfma_f32_16x16x32_bf16 v[84:87], a[56:59], a[88:91], v[84:87]
ds_read_b64_tr_b16 a[78:79], v4 offset:9216
v_mfma_f32_16x16x32_bf16 v[148:151], a[56:59], a[96:99], v[148:151]
ds_read_b64_tr_b16 a[80:81], v5 offset:0
v_lshrrev_b32 v13, 3, v0
v_mfma_f32_16x16x32_bf16 v[148:151], a[60:63], a[100:103], v[148:151]
ds_read_b64_tr_b16 a[82:83], v5 offset:1024
v_lshl_add_u32 v12, v13, 10, v12
v_mfma_f32_16x16x32_bf16 v[132:135], a[52:55], a[100:103], v[132:135]
ds_read_b64_tr_b16 a[84:85], v5 offset:8192
v_xor_b32 v13, 64, v12
v_mfma_f32_16x16x32_bf16 v[132:135], a[48:51], a[96:99], v[132:135]
ds_read_b64_tr_b16 a[86:87], v5 offset:9216
v_mfma_f32_16x16x32_bf16 v[116:119], a[40:43], a[96:99], v[116:119]
s_add_u32 m0, s78, 147456
ds_read_b64_tr_b16 a[88:89], v6 offset:0
v_mfma_f32_16x16x32_bf16 v[116:119], a[44:47], a[100:103], v[116:119]
s_add_u32 s64, s75, 0
ds_read_b64_tr_b16 a[90:91], v6 offset:1024
v_mfma_f32_16x16x32_bf16 v[100:103], a[36:39], a[100:103], v[100:103]
buffer_load_dwordx4 v23, s[60:63], s64 offen lds
v_mfma_f32_16x16x32_bf16 v[100:103], a[32:35], a[96:99], v[100:103]
ds_read_b64_tr_b16 a[92:93], v6 offset:8192
v_mfma_f32_16x16x32_bf16 v[248:251], a[32:35], a[104:107], v[248:251]
ds_read_b64_tr_b16 a[94:95], v6 offset:9216
v_mfma_f32_16x16x32_bf16 v[248:251], a[36:39], a[108:111], v[248:251]
ds_read_b64_tr_b16 a[96:97], v7 offset:0
v_mfma_f32_16x16x32_bf16 v[252:255], a[44:47], a[108:111], v[252:255]
ds_read_b64_tr_b16 a[98:99], v7 offset:1024
v_mfma_f32_16x16x32_bf16 v[252:255], a[40:43], a[104:107], v[252:255]
ds_read_b64_tr_b16 a[100:101], v7 offset:8192
v_mfma_f32_16x16x32_bf16 a[120:123], a[48:51], a[104:107], a[120:123]
ds_read_b64_tr_b16 a[102:103], v7 offset:9216
v_mfma_f32_16x16x32_bf16 a[120:123], a[52:55], a[108:111], a[120:123]
s_add_u32 m0, s77, 132096
v_mfma_f32_16x16x32_bf16 a[124:127], a[60:63], a[108:111], a[124:127]
s_add_u32 s64, s71, 32768
v_mfma_f32_16x16x32_bf16 a[124:127], a[56:59], a[104:107], a[124:127]
buffer_load_dwordx4 v14, s[56:59], s64 offen lds
v_mfma_f32_16x16x32_bf16 a[128:131], a[56:59], a[112:115], a[128:131]
ds_read_b64_tr_b16 a[104:105], v8 offset:0
v_mfma_f32_16x16x32_bf16 a[128:131], a[60:63], a[116:119], a[128:131]
ds_read_b64_tr_b16 a[106:107], v8 offset:1024
v_mfma_f32_16x16x32_bf16 a[132:135], a[52:55], a[116:119], a[132:135]
ds_read_b64_tr_b16 a[108:109], v8 offset:8192
v_mfma_f32_16x16x32_bf16 a[132:135], a[48:51], a[112:115], a[132:135]
ds_read_b64_tr_b16 a[110:111], v8 offset:9216
v_mfma_f32_16x16x32_bf16 a[136:139], a[40:43], a[112:115], a[136:139]
v_mfma_f32_16x16x32_bf16 a[136:139], a[44:47], a[116:119], a[136:139]
v_mfma_f32_16x16x32_bf16 a[140:143], a[36:39], a[116:119], a[140:143]
s_add_u32 m0, s78, 151552
v_mfma_f32_16x16x32_bf16 a[140:143], a[32:35], a[112:115], a[140:143]
s_waitcnt lgkmcnt(4)
s_add_u32 s64, s75, 2048
ds_read_b64_tr_b16 a[112:113], v9 offset:0
v_mfma_f32_16x16x32_bf16 v[184:187], a[72:75], a[0:3], v[184:187]
buffer_load_dwordx4 v23, s[60:63], s64 offen lds
v_mfma_f32_16x16x32_bf16 v[184:187], a[76:79], a[4:7], v[184:187]
ds_read_b64_tr_b16 a[114:115], v9 offset:1024
v_mfma_f32_16x16x32_bf16 v[192:195], a[76:79], a[12:15], v[192:195]
ds_read_b64_tr_b16 a[116:117], v9 offset:8192
v_mfma_f32_16x16x32_bf16 v[192:195], a[72:75], a[8:11], v[192:195]
s_add_u32 s17, s78, .-L_pc+6144
ds_read_b64_tr_b16 a[118:119], v9 offset:9216
v_mfma_f32_16x16x32_bf16 v[200:203], a[72:75], a[16:19], v[200:203]
buffer_load_dword a252, v16, s[88:91], s17 offen
v_mfma_f32_16x16x32_bf16 v[200:203], a[76:79], a[20:23], v[200:203]
v_mfma_f32_16x16x32_bf16 v[208:211], a[76:79], a[28:31], v[208:211]
v_mfma_f32_16x16x32_bf16 v[208:211], a[72:75], a[24:27], v[208:211]
ds_read_b64_tr_b16 a[72:73], v10 offset:0
v_mfma_f32_16x16x32_bf16 v[212:215], a[80:83], a[24:27], v[212:215]
s_add_u32 m0, s77, 133120
ds_read_b64_tr_b16 a[74:75], v10 offset:1024
v_mfma_f32_16x16x32_bf16 v[212:215], a[84:87], a[28:31], v[212:215]
s_add_u32 s64, s71, 65536
ds_read_b64_tr_b16 a[76:77], v10 offset:8192
v_mfma_f32_16x16x32_bf16 v[204:207], a[84:87], a[20:23], v[204:207]
buffer_load_dwordx4 v15, s[56:59], s64 offen lds
v_mfma_f32_16x16x32_bf16 v[204:207], a[80:83], a[16:19], v[204:207]
ds_read_b64_tr_b16 a[78:79], v10 offset:9216
v_mfma_f32_16x16x32_bf16 v[196:199], a[80:83], a[8:11], v[196:199]
v_mfma_f32_16x16x32_bf16 v[196:199], a[84:87], a[12:15], v[196:199]
v_mfma_f32_16x16x32_bf16 v[188:191], a[84:87], a[4:7], v[188:191]
v_mfma_f32_16x16x32_bf16 v[188:191], a[80:83], a[0:3], v[188:191]
ds_read_b64_tr_b16 a[80:81], v11 offset:0
v_mfma_f32_16x16x32_bf16 v[216:219], a[88:91], a[0:3], v[216:219]
ds_read_b64_tr_b16 a[82:83], v11 offset:1024
v_mfma_f32_16x16x32_bf16 v[216:219], a[92:95], a[4:7], v[216:219]
s_add_u32 m0, s78, 155648
ds_read_b64_tr_b16 a[84:85], v11 offset:8192
v_mfma_f32_16x16x32_bf16 v[224:227], a[92:95], a[12:15], v[224:227]
s_add_u32 s64, s75, 4096
ds_read_b64_tr_b16 a[86:87], v11 offset:9216
v_mfma_f32_16x16x32_bf16 v[224:227], a[88:91], a[8:11], v[224:227]
buffer_load_dwordx4 v23, s[60:63], s64 offen lds
v_mfma_f32_16x16x32_bf16 v[232:235], a[88:91], a[16:19], v[232:235]
v_mfma_f32_16x16x32_bf16 v[232:235], a[92:95], a[20:23], v[232:235]
v_mfma_f32_16x16x32_bf16 v[240:243], a[92:95], a[28:31], v[240:243]
v_mfma_f32_16x16x32_bf16 v[240:243], a[88:91], a[24:27], v[240:243]
ds_read_b64_tr_b16 a[88:89], v4 offset:16384
v_mfma_f32_16x16x32_bf16 v[244:247], a[96:99], a[24:27], v[244:247]
ds_read_b64_tr_b16 a[90:91], v4 offset:17408
v_mfma_f32_16x16x32_bf16 v[244:247], a[100:103], a[28:31], v[244:247]
ds_read_b64_tr_b16 a[92:93], v4 offset:24576
v_mfma_f32_16x16x32_bf16 v[236:239], a[100:103], a[20:23], v[236:239]
s_add_u32 m0, s77, 134144
ds_read_b64_tr_b16 a[94:95], v4 offset:25600
v_mfma_f32_16x16x32_bf16 v[236:239], a[96:99], a[16:19], v[236:239]
s_add_u32 s64, s71, 98304
v_mfma_f32_16x16x32_bf16 v[228:231], a[96:99], a[8:11], v[228:231]
buffer_load_dwordx4 v15, s[56:59], s64 offen lds
v_mfma_f32_16x16x32_bf16 v[228:231], a[100:103], a[12:15], v[228:231]
v_mfma_f32_16x16x32_bf16 v[220:223], a[100:103], a[4:7], v[220:223]
v_mfma_f32_16x16x32_bf16 v[220:223], a[96:99], a[0:3], v[220:223]
s_waitcnt lgkmcnt(4)
ds_read_b64_tr_b16 a[96:97], v5 offset:16384
v_mfma_f32_16x16x32_bf16 v[152:155], a[104:107], a[0:3], v[152:155]
ds_read_b64_tr_b16 a[98:99], v5 offset:17408
v_mfma_f32_16x16x32_bf16 v[152:155], a[108:111], a[4:7], v[152:155]
ds_read_b64_tr_b16 a[100:101], v5 offset:24576
v_mfma_f32_16x16x32_bf16 v[160:163], a[108:111], a[12:15], v[160:163]
ds_read_b64_tr_b16 a[102:103], v5 offset:25600
v_mfma_f32_16x16x32_bf16 v[160:163], a[104:107], a[8:11], v[160:163]
v_mfma_f32_16x16x32_bf16 v[168:171], a[104:107], a[16:19], v[168:171]
v_mfma_f32_16x16x32_bf16 v[168:171], a[108:111], a[20:23], v[168:171]
v_mfma_f32_16x16x32_bf16 v[176:179], a[108:111], a[28:31], v[176:179]
s_add_u32 m0, s76, 0
v_mfma_f32_16x16x32_bf16 v[176:179], a[104:107], a[24:27], v[176:179]
s_add_u32 s64, s72, 0
ds_read_b64_tr_b16 a[104:105], v6 offset:16384
v_mfma_f32_16x16x32_bf16 v[180:183], a[112:115], a[24:27], v[180:183]
buffer_load_dwordx4 v12, s[48:51], s64 offen lds
v_mfma_f32_16x16x32_bf16 v[180:183], a[116:119], a[28:31], v[180:183]
ds_read_b64_tr_b16 a[106:107], v6 offset:17408
v_mfma_f32_16x16x32_bf16 v[172:175], a[116:119], a[20:23], v[172:175]
ds_read_b64_tr_b16 a[108:109], v6 offset:24576
v_mfma_f32_16x16x32_bf16 v[172:175], a[112:115], a[16:19], v[172:175]
ds_read_b64_tr_b16 a[110:111], v6 offset:25600
v_mfma_f32_16x16x32_bf16 v[164:167], a[112:115], a[8:11], v[164:167]
v_mfma_f32_16x16x32_bf16 v[164:167], a[116:119], a[12:15], v[164:167]
s_add_u32 m0, s76, 1024
v_mfma_f32_16x16x32_bf16 v[156:159], a[116:119], a[4:7], v[156:159]
s_add_u32 s64, s72, 16384
v_mfma_f32_16x16x32_bf16 v[156:159], a[112:115], a[0:3], v[156:159]
buffer_load_dwordx4 v13, s[48:51], s64 offen lds
v_mfma_f32_16x16x32_bf16 v[24:27], a[72:75], a[0:3], v[24:27]
ds_read_b64_tr_b16 a[112:113], v7 offset:16384
v_mfma_f32_16x16x32_bf16 v[24:27], a[76:79], a[4:7], v[24:27]
ds_read_b64_tr_b16 a[114:115], v7 offset:17408
v_mfma_f32_16x16x32_bf16 v[40:43], a[76:79], a[12:15], v[40:43]
ds_read_b64_tr_b16 a[116:117], v7 offset:24576
v_mfma_f32_16x16x32_bf16 v[40:43], a[72:75], a[8:11], v[40:43]
ds_read_b64_tr_b16 a[118:119], v7 offset:25600
v_mfma_f32_16x16x32_bf16 v[56:59], a[72:75], a[16:19], v[56:59]
s_add_u32 m0, s76, 2048
v_mfma_f32_16x16x32_bf16 v[56:59], a[76:79], a[20:23], v[56:59]
s_add_u32 s64, s72, 131072
v_mfma_f32_16x16x32_bf16 v[72:75], a[76:79], a[28:31], v[72:75]
s_waitcnt vmcnt(10)
buffer_load_dwordx4 v12, s[48:51], s64 offen lds
v_mfma_f32_16x16x32_bf16 v[72:75], a[72:75], a[24:27], v[72:75]
ds_read_b64_tr_b16 a[72:73], v8 offset:16384
v_mfma_f32_16x16x32_bf16 v[136:139], a[80:83], a[24:27], v[136:139]
ds_read_b64_tr_b16 a[74:75], v8 offset:17408
v_mfma_f32_16x16x32_bf16 v[136:139], a[84:87], a[28:31], v[136:139]
ds_read_b64_tr_b16 a[76:77], v8 offset:24576
v_mfma_f32_16x16x32_bf16 v[120:123], a[84:87], a[20:23], v[120:123]
ds_read_b64_tr_b16 a[78:79], v8 offset:25600
v_mfma_f32_16x16x32_bf16 v[120:123], a[80:83], a[16:19], v[120:123]
s_add_u32 m0, s76, 3072
ds_read_b128 a[32:35], v2 offset:32768
v_mfma_f32_16x16x32_bf16 v[104:107], a[80:83], a[8:11], v[104:107]
s_add_u32 s64, s72, 147456
ds_read_b128 a[36:39], v3 offset:32768
v_mfma_f32_16x16x32_bf16 v[104:107], a[84:87], a[12:15], v[104:107]
buffer_load_dwordx4 v13, s[48:51], s64 offen lds
v_mfma_f32_16x16x32_bf16 v[88:91], a[84:87], a[4:7], v[88:91]
ds_read_b128 a[40:43], v2 offset:34816
v_mfma_f32_16x16x32_bf16 v[88:91], a[80:83], a[0:3], v[88:91]
s_waitcnt lgkmcnt(7)
ds_read_b128 a[44:47], v3 offset:34816
v_mfma_f32_16x16x32_bf16 v[28:31], a[0:3], a[88:91], v[28:31]
ds_read_b128 a[48:51], v2 offset:36864
v_mfma_f32_16x16x32_bf16 v[28:31], a[4:7], a[92:95], v[28:31]
ds_read_b128 a[52:55], v3 offset:36864
v_mfma_f32_16x16x32_bf16 v[44:47], a[12:15], a[92:95], v[44:47]
s_add_u32 m0, s76, 4096
ds_read_b128 a[56:59], v2 offset:38912
v_mfma_f32_16x16x32_bf16 v[44:47], a[8:11], a[88:91], v[44:47]
s_add_u32 s64, s73, 0
ds_read_b128 a[60:63], v3 offset:38912
v_mfma_f32_16x16x32_bf16 v[60:63], a[16:19], a[88:91], v[60:63]
buffer_load_dwordx4 v12, s[48:51], s64 offen lds
v_mfma_f32_16x16x32_bf16 v[60:63], a[20:23], a[92:95], v[60:63]
ds_read_b64_tr_b16 a[80:81], v9 offset:16384
v_mfma_f32_16x16x32_bf16 v[76:79], a[28:31], a[92:95], v[76:79]
ds_read_b64_tr_b16 a[82:83], v9 offset:17408
v_mfma_f32_16x16x32_bf16 v[76:79], a[24:27], a[88:91], v[76:79]
ds_read_b64_tr_b16 a[84:85], v9 offset:24576
v_mfma_f32_16x16x32_bf16 v[140:143], a[24:27], a[96:99], v[140:143]
ds_read_b64_tr_b16 a[86:87], v9 offset:25600
v_mfma_f32_16x16x32_bf16 v[140:143], a[28:31], a[100:103], v[140:143]
s_add_u32 m0, s76, 5120
ds_read_b64_tr_b16 a[88:89], v10 offset:16384
v_mfma_f32_16x16x32_bf16 v[124:127], a[20:23], a[100:103], v[124:127]
s_add_u32 s64, s73, 16384
ds_read_b64_tr_b16 a[90:91], v10 offset:17408
v_mfma_f32_16x16x32_bf16 v[124:127], a[16:19], a[96:99], v[124:127]
buffer_load_dwordx4 v13, s[48:51], s64 offen lds
v_mfma_f32_16x16x32_bf16 v[108:111], a[8:11], a[96:99], v[108:111]
ds_read_b64_tr_b16 a[92:93], v10 offset:24576
v_mfma_f32_16x16x32_bf16 v[108:111], a[12:15], a[100:103], v[108:111]
ds_read_b64_tr_b16 a[94:95], v10 offset:25600
v_mfma_f32_16x16x32_bf16 v[92:95], a[4:7], a[100:103], v[92:95]
v_mfma_f32_16x16x32_bf16 v[92:95], a[0:3], a[96:99], v[92:95]
ds_read_b64_tr_b16 a[96:97], v11 offset:16384
v_mfma_f32_16x16x32_bf16 v[32:35], a[0:3], a[104:107], v[32:35]
s_add_u32 m0, s76, 6144
ds_read_b64_tr_b16 a[98:99], v11 offset:17408
v_mfma_f32_16x16x32_bf16 v[32:35], a[4:7], a[108:111], v[32:35]
s_add_u32 s64, s73, 131072
ds_read_b64_tr_b16 a[100:101], v11 offset:24576
v_mfma_f32_16x16x32_bf16 v[48:51], a[12:15], a[108:111], v[48:51]
buffer_load_dwordx4 v12, s[48:51], s64 offen lds
v_mfma_f32_16x16x32_bf16 v[48:51], a[8:11], a[104:107], v[48:51]
ds_read_b64_tr_b16 a[102:103], v11 offset:25600
v_mfma_f32_16x16x32_bf16 v[64:67], a[16:19], a[104:107], v[64:67]
v_mfma_f32_16x16x32_bf16 v[64:67], a[20:23], a[108:111], v[64:67]
v_mfma_f32_16x16x32_bf16 v[80:83], a[28:31], a[108:111], v[80:83]
v_mfma_f32_16x16x32_bf16 v[80:83], a[24:27], a[104:107], v[80:83]
s_add_u32 m0, s76, 7168
v_mfma_f32_16x16x32_bf16 v[144:147], a[24:27], a[112:115], v[144:147]
s_add_u32 s64, s73, 147456
v_mfma_f32_16x16x32_bf16 v[144:147], a[28:31], a[116:119], v[144:147]
buffer_load_dwordx4 v13, s[48:51], s64 offen lds
v_mfma_f32_16x16x32_bf16 v[128:131], a[20:23], a[116:119], v[128:131]
v_mfma_f32_16x16x32_bf16 v[128:131], a[16:19], a[112:115], v[128:131]
v_mfma_f32_16x16x32_bf16 v[112:115], a[8:11], a[112:115], v[112:115]
v_mfma_f32_16x16x32_bf16 v[112:115], a[12:15], a[116:119], v[112:115]
v_mfma_f32_16x16x32_bf16 v[96:99], a[4:7], a[116:119], v[96:99]
v_mfma_f32_16x16x32_bf16 v[96:99], a[0:3], a[112:115], v[96:99]
s_waitcnt lgkmcnt(0)
v_mfma_f32_16x16x32_bf16 v[36:39], a[0:3], a[72:75], v[36:39]
v_mfma_f32_16x16x32_bf16 v[36:39], a[4:7], a[76:79], v[36:39]
v_mfma_f32_16x16x32_bf16 v[52:55], a[12:15], a[76:79], v[52:55]
s_waitcnt lgkmcnt(0)
s_barrier
v_mfma_f32_16x16x32_bf16 v[52:55], a[8:11], a[72:75], v[52:55]
s_add_u32 m0, s77, 65536
ds_read_b64_tr_b16 a[104:105], v4 offset:32768
v_mfma_f32_16x16x32_bf16 v[68:71], a[16:19], a[72:75], v[68:71]
s_add_u32 s64, s71, 524288
ds_read_b64_tr_b16 a[106:107], v4 offset:33792
v_mfma_f32_16x16x32_bf16 v[68:71], a[20:23], a[76:79], v[68:71]
buffer_load_dwordx4 v14, s[56:59], s64 offen lds
v_mfma_f32_16x16x32_bf16 v[84:87], a[28:31], a[76:79], v[84:87]
ds_read_b64_tr_b16 a[108:109], v4 offset:40960
v_mfma_f32_16x16x32_bf16 v[84:87], a[24:27], a[72:75], v[84:87]
ds_read_b64_tr_b16 a[110:111], v4 offset:41984
v_mfma_f32_16x16x32_bf16 v[148:151], a[24:27], a[80:83], v[148:151]
ds_read_b64_tr_b16 a[112:113], v5 offset:32768
v_mfma_f32_16x16x32_bf16 v[148:151], a[28:31], a[84:87], v[148:151]
ds_read_b64_tr_b16 a[114:115], v5 offset:33792
v_mfma_f32_16x16x32_bf16 v[132:135], a[20:23], a[84:87], v[132:135]
ds_read_b64_tr_b16 a[116:117], v5 offset:40960
v_mfma_f32_16x16x32_bf16 v[132:135], a[16:19], a[80:83], v[132:135]
ds_read_b64_tr_b16 a[118:119], v5 offset:41984
v_mfma_f32_16x16x32_bf16 v[116:119], a[8:11], a[80:83], v[116:119]
s_add_u32 m0, s78, 81920
ds_read_b64_tr_b16 a[72:73], v6 offset:32768
v_mfma_f32_16x16x32_bf16 v[116:119], a[12:15], a[84:87], v[116:119]
s_add_u32 s64, s75, 393216
ds_read_b64_tr_b16 a[74:75], v6 offset:33792
v_mfma_f32_16x16x32_bf16 v[100:103], a[4:7], a[84:87], v[100:103]
buffer_load_dwordx4 v23, s[60:63], s64 offen lds
v_mfma_f32_16x16x32_bf16 v[100:103], a[0:3], a[80:83], v[100:103]
ds_read_b64_tr_b16 a[76:77], v6 offset:40960
v_mfma_f32_16x16x32_bf16 v[248:251], a[0:3], a[88:91], v[248:251]
ds_read_b64_tr_b16 a[78:79], v6 offset:41984
v_mfma_f32_16x16x32_bf16 v[248:251], a[4:7], a[92:95], v[248:251]
ds_read_b64_tr_b16 a[80:81], v7 offset:32768
v_mfma_f32_16x16x32_bf16 v[252:255], a[12:15], a[92:95], v[252:255]
ds_read_b64_tr_b16 a[82:83], v7 offset:33792
v_mfma_f32_16x16x32_bf16 v[252:255], a[8:11], a[88:91], v[252:255]
ds_read_b64_tr_b16 a[84:85], v7 offset:40960
v_mfma_f32_16x16x32_bf16 a[120:123], a[16:19], a[88:91], a[120:123]
ds_read_b64_tr_b16 a[86:87], v7 offset:41984
v_mfma_f32_16x16x32_bf16 a[120:123], a[20:23], a[92:95], a[120:123]
s_add_u32 m0, s77, 66560
v_mfma_f32_16x16x32_bf16 a[124:127], a[28:31], a[92:95], a[124:127]
s_add_u32 s64, s71, 557056
v_mfma_f32_16x16x32_bf16 a[124:127], a[24:27], a[88:91], a[124:127]
buffer_load_dwordx4 v14, s[56:59], s64 offen lds
v_mfma_f32_16x16x32_bf16 a[128:131], a[24:27], a[96:99], a[128:131]
ds_read_b64_tr_b16 a[88:89], v8 offset:32768
v_mfma_f32_16x16x32_bf16 a[128:131], a[28:31], a[100:103], a[128:131]
ds_read_b64_tr_b16 a[90:91], v8 offset:33792
v_mfma_f32_16x16x32_bf16 a[132:135], a[20:23], a[100:103], a[132:135]
ds_read_b64_tr_b16 a[92:93], v8 offset:40960
v_mfma_f32_16x16x32_bf16 a[132:135], a[16:19], a[96:99], a[132:135]
ds_read_b64_tr_b16 a[94:95], v8 offset:41984
v_mfma_f32_16x16x32_bf16 a[136:139], a[8:11], a[96:99], a[136:139]
v_mfma_f32_16x16x32_bf16 a[136:139], a[12:15], a[100:103], a[136:139]
v_mfma_f32_16x16x32_bf16 a[140:143], a[4:7], a[100:103], a[140:143]
s_add_u32 m0, s78, 86016
v_mfma_f32_16x16x32_bf16 a[140:143], a[0:3], a[96:99], a[140:143]
s_waitcnt lgkmcnt(4)
s_add_u32 s64, s75, 395264
ds_read_b64_tr_b16 a[96:97], v9 offset:32768
v_mfma_f32_16x16x32_bf16 v[184:187], a[104:107], a[32:35], v[184:187]
s_lshl_b32 s66, s30, 30
buffer_load_dwordx4 v23, s[60:63], s64 offen lds
v_mfma_f32_16x16x32_bf16 v[184:187], a[108:111], a[36:39], v[184:187]
ds_read_b64_tr_b16 a[98:99], v9 offset:33792
v_lshl_add_u32 v1, v0, 24, s66
v_mfma_f32_16x16x32_bf16 v[192:195], a[108:111], a[44:47], v[192:195]
s_lshr_b32 s66, s3, 1
ds_read_b64_tr_b16 a[100:101], v9 offset:40960
v_mfma_f32_16x16x32_bf16 v[192:195], a[104:107], a[40:43], v[192:195]
s_lshl_b32 s66, s66, 12
ds_read_b64_tr_b16 a[102:103], v9 offset:41984
v_mfma_f32_16x16x32_bf16 v[200:203], a[104:107], a[48:51], v[200:203]
v_mfma_f32_16x16x32_bf16 v[200:203], a[108:111], a[52:55], v[200:203]
v_mfma_f32_16x16x32_bf16 v[208:211], a[108:111], a[60:63], v[208:211]
v_mfma_f32_16x16x32_bf16 v[208:211], a[104:107], a[56:59], v[208:211]
ds_read_b64_tr_b16 a[104:105], v10 offset:32768
v_mfma_f32_16x16x32_bf16 v[212:215], a[112:115], a[56:59], v[212:215]
s_add_u32 m0, s77, 67584
ds_read_b64_tr_b16 a[106:107], v10 offset:33792
v_mfma_f32_16x16x32_bf16 v[212:215], a[116:119], a[60:63], v[212:215]
s_add_u32 s64, s71, 589824
ds_read_b64_tr_b16 a[108:109], v10 offset:40960
v_mfma_f32_16x16x32_bf16 v[204:207], a[116:119], a[52:55], v[204:207]
buffer_load_dwordx4 v15, s[56:59], s64 offen lds
v_mfma_f32_16x16x32_bf16 v[204:207], a[112:115], a[48:51], v[204:207]
ds_read_b64_tr_b16 a[110:111], v10 offset:41984
v_mfma_f32_16x16x32_bf16 v[196:199], a[112:115], a[40:43], v[196:199]
v_mfma_f32_16x16x32_bf16 v[196:199], a[116:119], a[44:47], v[196:199]
v_mfma_f32_16x16x32_bf16 v[188:191], a[116:119], a[36:39], v[188:191]
v_mfma_f32_16x16x32_bf16 v[188:191], a[112:115], a[32:35], v[188:191]
s_add_u32 s67, s79, 20480
ds_read_b64_tr_b16 a[112:113], v11 offset:32768
v_mfma_f32_16x16x32_bf16 v[216:219], a[72:75], a[32:35], v[216:219]
ds_read_b64_tr_b16 a[114:115], v11 offset:33792
v_mfma_f32_16x16x32_bf16 v[216:219], a[76:79], a[36:39], v[216:219]
s_add_u32 m0, s78, 90112
ds_read_b64_tr_b16 a[116:117], v11 offset:40960
v_cvt_pk_bf16_f32 v215, v214, v215
v_mfma_f32_16x16x32_bf16 v[224:227], a[76:79], a[44:47], v[224:227]
s_add_u32 s64, s75, 397312
ds_read_b64_tr_b16 a[118:119], v11 offset:41984
v_cvt_pk_bf16_f32 v214, v212, v213
v_mfma_f32_16x16x32_bf16 v[224:227], a[72:75], a[40:43], v[224:227]
buffer_load_dwordx4 v23, s[60:63], s64 offen lds
v_mfma_f32_16x16x32_bf16 v[232:235], a[72:75], a[48:51], v[232:235]
v_cvt_pk_bf16_f32 v212, v208, v209
v_cvt_pk_bf16_f32 v213, v210, v211
v_mfma_f32_16x16x32_bf16 v[232:235], a[76:79], a[52:55], v[232:235]
buffer_store_dwordx4 v[212:215], v16, s[44:47], s67 offen sc1
v_mfma_f32_16x16x32_bf16 v[240:243], a[76:79], a[60:63], v[240:243]
v_cvt_pk_bf16_f32 v207, v206, v207
v_cvt_pk_bf16_f32 v206, v204, v205
v_mfma_f32_16x16x32_bf16 v[240:243], a[72:75], a[56:59], v[240:243]
ds_read_b64_tr_b16 a[72:73], v4 offset:49152
v_cvt_pk_bf16_f32 v204, v200, v201
v_mfma_f32_16x16x32_bf16 v[244:247], a[80:83], a[56:59], v[244:247]
ds_read_b64_tr_b16 a[74:75], v4 offset:50176
v_cvt_pk_bf16_f32 v205, v202, v203
v_mfma_f32_16x16x32_bf16 v[244:247], a[84:87], a[60:63], v[244:247]
ds_read_b64_tr_b16 a[76:77], v4 offset:57344
v_accvgpr_write_b32 a144, v204
v_mfma_f32_16x16x32_bf16 v[236:239], a[84:87], a[52:55], v[236:239]
s_add_u32 m0, s77, 68608
ds_read_b64_tr_b16 a[78:79], v4 offset:58368
v_accvgpr_write_b32 a145, v205
v_mfma_f32_16x16x32_bf16 v[236:239], a[80:83], a[48:51], v[236:239]
s_add_u32 s64, s71, 622592
v_accvgpr_write_b32 a146, v206
v_accvgpr_write_b32 a147, v207
v_mfma_f32_16x16x32_bf16 v[228:231], a[80:83], a[40:43], v[228:231]
buffer_load_dwordx4 v15, s[56:59], s64 offen lds
v_mfma_f32_16x16x32_bf16 v[228:231], a[84:87], a[44:47], v[228:231]
v_cvt_pk_bf16_f32 v199, v198, v199
v_cvt_pk_bf16_f32 v198, v196, v197
v_mfma_f32_16x16x32_bf16 v[220:223], a[84:87], a[36:39], v[220:223]
v_cvt_pk_bf16_f32 v196, v192, v193
v_cvt_pk_bf16_f32 v197, v194, v195
v_mfma_f32_16x16x32_bf16 v[220:223], a[80:83], a[32:35], v[220:223]
s_waitcnt lgkmcnt(4)
ds_read_b64_tr_b16 a[80:81], v5 offset:49152
v_accvgpr_write_b32 a148, v196
v_mfma_f32_16x16x32_bf16 v[152:155], a[88:91], a[32:35], v[152:155]
ds_read_b64_tr_b16 a[82:83], v5 offset:50176
v_accvgpr_write_b32 a149, v197
v_mfma_f32_16x16x32_bf16 v[152:155], a[92:95], a[36:39], v[152:155]
ds_read_b64_tr_b16 a[84:85], v5 offset:57344
v_accvgpr_write_b32 a150, v198
v_mfma_f32_16x16x32_bf16 v[160:163], a[92:95], a[44:47], v[160:163]
ds_read_b64_tr_b16 a[86:87], v5 offset:58368
v_accvgpr_write_b32 a151, v199
v_mfma_f32_16x16x32_bf16 v[160:163], a[88:91], a[40:43], v[160:163]
v_cvt_pk_bf16_f32 v191, v190, v191
v_cvt_pk_bf16_f32 v190, v188, v189
v_mfma_f32_16x16x32_bf16 v[168:171], a[88:91], a[48:51], v[168:171]
v_cvt_pk_bf16_f32 v188, v184, v185
v_cvt_pk_bf16_f32 v189, v186, v187
v_mfma_f32_16x16x32_bf16 v[168:171], a[92:95], a[52:55], v[168:171]
v_accvgpr_write_b32 a152, v188
v_accvgpr_write_b32 a153, v189
v_mfma_f32_16x16x32_bf16 v[176:179], a[92:95], a[60:63], v[176:179]
s_add_u32 m0, s76, 32768
v_accvgpr_write_b32 a154, v190
v_accvgpr_write_b32 a155, v191
v_mfma_f32_16x16x32_bf16 v[176:179], a[88:91], a[56:59], v[176:179]
s_add_u32 s67, s79, 21504
s_add_u32 s64, s72, 128
ds_read_b64_tr_b16 a[88:89], v6 offset:49152
v_cvt_pk_bf16_f32 v247, v246, v247
v_mfma_f32_16x16x32_bf16 v[180:183], a[96:99], a[56:59], v[180:183]
buffer_load_dwordx4 v12, s[48:51], s64 offen lds
v_mfma_f32_16x16x32_bf16 v[180:183], a[100:103], a[60:63], v[180:183]
ds_read_b64_tr_b16 a[90:91], v6 offset:50176
v_cvt_pk_bf16_f32 v246, v244, v245
v_mfma_f32_16x16x32_bf16 v[172:175], a[100:103], a[52:55], v[172:175]
ds_read_b64_tr_b16 a[92:93], v6 offset:57344
v_cvt_pk_bf16_f32 v244, v240, v241
v_mfma_f32_16x16x32_bf16 v[172:175], a[96:99], a[48:51], v[172:175]
ds_read_b64_tr_b16 a[94:95], v6 offset:58368
v_cvt_pk_bf16_f32 v245, v242, v243
v_mfma_f32_16x16x32_bf16 v[164:167], a[96:99], a[40:43], v[164:167]
buffer_store_dwordx4 v[244:247], v16, s[44:47], s67 offen sc1
v_mfma_f32_16x16x32_bf16 v[164:167], a[100:103], a[44:47], v[164:167]
s_add_u32 m0, s76, 33792
v_cvt_pk_bf16_f32 v239, v238, v239
v_cvt_pk_bf16_f32 v238, v236, v237
v_mfma_f32_16x16x32_bf16 v[156:159], a[100:103], a[36:39], v[156:159]
s_add_u32 s64, s72, 16512
v_cvt_pk_bf16_f32 v236, v232, v233
v_cvt_pk_bf16_f32 v237, v234, v235
v_mfma_f32_16x16x32_bf16 v[156:159], a[96:99], a[32:35], v[156:159]
buffer_load_dwordx4 v13, s[48:51], s64 offen lds
v_mfma_f32_16x16x32_bf16 v[24:27], a[104:107], a[32:35], v[24:27]
ds_read_b64_tr_b16 a[96:97], v7 offset:49152
v_accvgpr_write_b32 a156, v236
v_mfma_f32_16x16x32_bf16 v[24:27], a[108:111], a[36:39], v[24:27]
ds_read_b64_tr_b16 a[98:99], v7 offset:50176
v_accvgpr_write_b32 a157, v237
v_mfma_f32_16x16x32_bf16 v[40:43], a[108:111], a[44:47], v[40:43]
ds_read_b64_tr_b16 a[100:101], v7 offset:57344
v_accvgpr_write_b32 a158, v238
v_mfma_f32_16x16x32_bf16 v[40:43], a[104:107], a[40:43], v[40:43]
ds_read_b64_tr_b16 a[102:103], v7 offset:58368
v_accvgpr_write_b32 a159, v239
v_mfma_f32_16x16x32_bf16 v[56:59], a[104:107], a[48:51], v[56:59]
s_add_u32 m0, s76, 34816
v_cvt_pk_bf16_f32 v231, v230, v231
v_cvt_pk_bf16_f32 v230, v228, v229
v_mfma_f32_16x16x32_bf16 v[56:59], a[108:111], a[52:55], v[56:59]
s_add_u32 s64, s72, 131200
v_cvt_pk_bf16_f32 v228, v224, v225
v_cvt_pk_bf16_f32 v229, v226, v227
v_mfma_f32_16x16x32_bf16 v[72:75], a[108:111], a[60:63], v[72:75]
s_waitcnt vmcnt(11)
buffer_load_dwordx4 v12, s[48:51], s64 offen lds
v_mfma_f32_16x16x32_bf16 v[72:75], a[104:107], a[56:59], v[72:75]
ds_read_b64_tr_b16 a[104:105], v8 offset:49152
v_accvgpr_write_b32 a160, v228
v_mfma_f32_16x16x32_bf16 v[136:139], a[112:115], a[56:59], v[136:139]
ds_read_b64_tr_b16 a[106:107], v8 offset:50176
v_accvgpr_write_b32 a161, v229
v_mfma_f32_16x16x32_bf16 v[136:139], a[116:119], a[60:63], v[136:139]
ds_read_b64_tr_b16 a[108:109], v8 offset:57344
v_add_u32 v4, 0x8000, v4
v_mfma_f32_16x16x32_bf16 v[120:123], a[116:119], a[52:55], v[120:123]
ds_read_b64_tr_b16 a[110:111], v8 offset:58368
v_accvgpr_write_b32 a162, v230
v_mfma_f32_16x16x32_bf16 v[120:123], a[112:115], a[48:51], v[120:123]
s_add_u32 m0, s76, 35840
ds_read_b128 a[0:3], v2 offset:0
v_accvgpr_write_b32 a163, v231
v_mfma_f32_16x16x32_bf16 v[104:107], a[112:115], a[40:43], v[104:107]
s_add_u32 s64, s72, 147584
ds_read_b128 a[4:7], v3 offset:0
v_cvt_pk_bf16_f32 v223, v222, v223
v_mfma_f32_16x16x32_bf16 v[104:107], a[116:119], a[44:47], v[104:107]
buffer_load_dwordx4 v13, s[48:51], s64 offen lds
v_mfma_f32_16x16x32_bf16 v[88:91], a[116:119], a[36:39], v[88:91]
ds_read_b128 a[8:11], v2 offset:2048
v_cvt_pk_bf16_f32 v222, v220, v221
v_mfma_f32_16x16x32_bf16 v[88:91], a[112:115], a[32:35], v[88:91]
s_waitcnt lgkmcnt(7)
ds_read_b128 a[12:15], v3 offset:2048
v_cvt_pk_bf16_f32 v220, v216, v217
v_mfma_f32_16x16x32_bf16 v[28:31], a[32:35], a[72:75], v[28:31]
ds_read_b128 a[16:19], v2 offset:4096
v_cvt_pk_bf16_f32 v221, v218, v219
v_mfma_f32_16x16x32_bf16 v[28:31], a[36:39], a[76:79], v[28:31]
ds_read_b128 a[20:23], v3 offset:4096
v_add_u32 v5, 0x8000, v5
v_mfma_f32_16x16x32_bf16 v[44:47], a[44:47], a[76:79], v[44:47]
s_add_u32 m0, s76, 36864
ds_read_b128 a[24:27], v2 offset:6144
v_accvgpr_write_b32 a164, v220
v_mfma_f32_16x16x32_bf16 v[44:47], a[40:43], a[72:75], v[44:47]
s_add_u32 s64, s73, 128
ds_read_b128 a[28:31], v3 offset:6144
v_accvgpr_write_b32 a165, v221
v_mfma_f32_16x16x32_bf16 v[60:63], a[48:51], a[72:75], v[60:63]
buffer_load_dwordx4 v12, s[48:51], s64 offen lds
v_mfma_f32_16x16x32_bf16 v[60:63], a[52:55], a[76:79], v[60:63]
ds_read_b64_tr_b16 a[112:113], v9 offset:49152
v_accvgpr_write_b32 a166, v222
v_mfma_f32_16x16x32_bf16 v[76:79], a[60:63], a[76:79], v[76:79]
ds_read_b64_tr_b16 a[114:115], v9 offset:50176
v_accvgpr_write_b32 a167, v223
v_mfma_f32_16x16x32_bf16 v[76:79], a[56:59], a[72:75], v[76:79]
s_add_u32 s67, s79, 22528
ds_read_b64_tr_b16 a[116:117], v9 offset:57344
v_cvt_pk_bf16_f32 v183, v182, v183
v_mfma_f32_16x16x32_bf16 v[140:143], a[56:59], a[80:83], v[140:143]
ds_read_b64_tr_b16 a[118:119], v9 offset:58368
v_cvt_pk_bf16_f32 v182, v180, v181
v_mfma_f32_16x16x32_bf16 v[140:143], a[60:63], a[84:87], v[140:143]
s_add_u32 m0, s76, 37888
ds_read_b64_tr_b16 a[72:73], v10 offset:49152
v_add_u32 v6, 0x8000, v6
v_mfma_f32_16x16x32_bf16 v[124:127], a[52:55], a[84:87], v[124:127]
s_add_u32 s64, s73, 16512
ds_read_b64_tr_b16 a[74:75], v10 offset:50176
v_cvt_pk_bf16_f32 v180, v176, v177
v_mfma_f32_16x16x32_bf16 v[124:127], a[48:51], a[80:83], v[124:127]
buffer_load_dwordx4 v13, s[48:51], s64 offen lds
v_mfma_f32_16x16x32_bf16 v[108:111], a[40:43], a[80:83], v[108:111]
ds_read_b64_tr_b16 a[76:77], v10 offset:57344
v_cvt_pk_bf16_f32 v181, v178, v179
v_mfma_f32_16x16x32_bf16 v[108:111], a[44:47], a[84:87], v[108:111]
ds_read_b64_tr_b16 a[78:79], v10 offset:58368
v_mfma_f32_16x16x32_bf16 v[92:95], a[36:39], a[84:87], v[92:95]
buffer_store_dwordx4 v[180:183], v16, s[44:47], s67 offen sc1
v_mfma_f32_16x16x32_bf16 v[92:95], a[32:35], a[80:83], v[92:95]
ds_read_b64_tr_b16 a[80:81], v11 offset:49152
v_cvt_pk_bf16_f32 v175, v174, v175
v_mfma_f32_16x16x32_bf16 v[32:35], a[32:35], a[88:91], v[32:35]
s_add_u32 m0, s76, 38912
ds_read_b64_tr_b16 a[82:83], v11 offset:50176
v_cvt_pk_bf16_f32 v174, v172, v173
v_mfma_f32_16x16x32_bf16 v[32:35], a[36:39], a[92:95], v[32:35]
s_add_u32 s64, s73, 131200
ds_read_b64_tr_b16 a[84:85], v11 offset:57344
v_add_u32 v7, 0x8000, v7
v_mfma_f32_16x16x32_bf16 v[48:51], a[44:47], a[92:95], v[48:51]
buffer_load_dwordx4 v12, s[48:51], s64 offen lds
v_mfma_f32_16x16x32_bf16 v[48:51], a[40:43], a[88:91], v[48:51]
ds_read_b64_tr_b16 a[86:87], v11 offset:58368
v_cvt_pk_bf16_f32 v172, v168, v169
v_mfma_f32_16x16x32_bf16 v[64:67], a[48:51], a[88:91], v[64:67]
v_cvt_pk_bf16_f32 v173, v170, v171
v_accvgpr_write_b32 a168, v172
v_mfma_f32_16x16x32_bf16 v[64:67], a[52:55], a[92:95], v[64:67]
v_accvgpr_write_b32 a169, v173
v_accvgpr_write_b32 a170, v174
v_mfma_f32_16x16x32_bf16 v[80:83], a[60:63], a[92:95], v[80:83]
v_accvgpr_write_b32 a171, v175
v_cvt_pk_bf16_f32 v167, v166, v167
v_mfma_f32_16x16x32_bf16 v[80:83], a[56:59], a[88:91], v[80:83]
s_add_u32 m0, s76, 39936
v_cvt_pk_bf16_f32 v166, v164, v165
v_cvt_pk_bf16_f32 v164, v160, v161
v_mfma_f32_16x16x32_bf16 v[144:147], a[56:59], a[96:99], v[144:147]
s_add_u32 s64, s73, 147584
v_cvt_pk_bf16_f32 v165, v162, v163
v_accvgpr_write_b32 a172, v164
v_mfma_f32_16x16x32_bf16 v[144:147], a[60:63], a[100:103], v[144:147]
buffer_load_dwordx4 v13, s[48:51], s64 offen lds
v_mfma_f32_16x16x32_bf16 v[128:131], a[52:55], a[100:103], v[128:131]
v_add_u32 v8, 0x8000, v8
v_accvgpr_write_b32 a173, v165
v_mfma_f32_16x16x32_bf16 v[128:131], a[48:51], a[96:99], v[128:131]
v_accvgpr_write_b32 a174, v166
v_accvgpr_write_b32 a175, v167
v_mfma_f32_16x16x32_bf16 v[112:115], a[40:43], a[96:99], v[112:115]
v_cvt_pk_bf16_f32 v159, v158, v159
v_cvt_pk_bf16_f32 v158, v156, v157
v_mfma_f32_16x16x32_bf16 v[112:115], a[44:47], a[100:103], v[112:115]
v_cvt_pk_bf16_f32 v156, v152, v153
v_cvt_pk_bf16_f32 v157, v154, v155
v_mfma_f32_16x16x32_bf16 v[96:99], a[36:39], a[100:103], v[96:99]
v_add_u32 v9, 0x8000, v9
v_add_u32 v10, 0x8000, v10
v_mfma_f32_16x16x32_bf16 v[96:99], a[32:35], a[96:99], v[96:99]
s_waitcnt lgkmcnt(0)
v_add_u32 v11, 0x8000, v11
v_accvgpr_write_b32 a176, v156
v_mfma_f32_16x16x32_bf16 v[36:39], a[32:35], a[104:107], v[36:39]
v_accvgpr_write_b32 a177, v157
v_accvgpr_write_b32 a178, v158
v_mfma_f32_16x16x32_bf16 v[36:39], a[36:39], a[108:111], v[36:39]
v_accvgpr_write_b32 a179, v159
v_mfma_f32_16x16x32_bf16 v[52:55], a[44:47], a[108:111], v[52:55]
s_add_u32 s67, s79, 23552
s_waitcnt lgkmcnt(0)
s_barrier
v_mfma_f32_16x16x32_bf16 v[52:55], a[40:43], a[104:107], v[52:55]
s_add_u32 m0, s77, 98304
ds_read_b64_tr_b16 a[88:89], v19 offset:36864
v_cvt_pk_bf16_f32 v139, v138, v139
v_mfma_f32_16x16x32_bf16 v[68:71], a[48:51], a[104:107], v[68:71]
s_add_u32 s64, s71, 1048576
ds_read_b64_tr_b16 a[90:91], v19 offset:37120
v_cvt_pk_bf16_f32 v138, v136, v137
v_mfma_f32_16x16x32_bf16 v[68:71], a[52:55], a[108:111], v[68:71]
buffer_load_dwordx4 v14, s[56:59], s64 offen lds
v_mfma_f32_16x16x32_bf16 v[84:87], a[60:63], a[108:111], v[84:87]
ds_read_b64_tr_b16 a[92:93], v19 offset:38912
v_cvt_pk_bf16_f32 v136, v72, v73
v_mfma_f32_16x16x32_bf16 v[84:87], a[56:59], a[104:107], v[84:87]
ds_read_b64_tr_b16 a[94:95], v19 offset:39168
v_cvt_pk_bf16_f32 v137, v74, v75
v_mfma_f32_16x16x32_bf16 v[148:151], a[56:59], a[112:115], v[148:151]
ds_read_b64_tr_b16 a[96:97], v20 offset:36864
v_mfma_f32_16x16x32_bf16 v[148:151], a[60:63], a[116:119], v[148:151]
ds_read_b64_tr_b16 a[98:99], v20 offset:37120
v_mfma_f32_16x16x32_bf16 v[132:135], a[52:55], a[116:119], v[132:135]
ds_read_b64_tr_b16 a[100:101], v20 offset:38912
v_mfma_f32_16x16x32_bf16 v[132:135], a[48:51], a[112:115], v[132:135]
ds_read_b64_tr_b16 a[102:103], v20 offset:39168
v_mfma_f32_16x16x32_bf16 v[116:119], a[40:43], a[112:115], v[116:119]
s_add_u32 m0, s78, 114688
ds_read_b64_tr_b16 a[104:105], v19 offset:40960
v_mfma_f32_16x16x32_bf16 v[116:119], a[44:47], a[116:119], v[116:119]
s_add_u32 s64, s75, 786432
ds_read_b64_tr_b16 a[106:107], v19 offset:41216
v_mfma_f32_16x16x32_bf16 v[100:103], a[36:39], a[116:119], v[100:103]
buffer_load_dwordx4 v23, s[60:63], s64 offen lds
v_mfma_f32_16x16x32_bf16 v[100:103], a[32:35], a[112:115], v[100:103]
ds_read_b64_tr_b16 a[108:109], v19 offset:43008
v_mfma_f32_16x16x32_bf16 v[248:251], a[32:35], a[72:75], v[248:251]
ds_read_b64_tr_b16 a[110:111], v19 offset:43264
v_mfma_f32_16x16x32_bf16 v[248:251], a[36:39], a[76:79], v[248:251]
ds_read_b64_tr_b16 a[112:113], v20 offset:40960
v_mfma_f32_16x16x32_bf16 v[252:255], a[44:47], a[76:79], v[252:255]
ds_read_b64_tr_b16 a[114:115], v20 offset:41216
v_mfma_f32_16x16x32_bf16 v[252:255], a[40:43], a[72:75], v[252:255]
ds_read_b64_tr_b16 a[116:117], v20 offset:43008
v_mfma_f32_16x16x32_bf16 a[120:123], a[48:51], a[72:75], a[120:123]
ds_read_b64_tr_b16 a[118:119], v20 offset:43264
v_mfma_f32_16x16x32_bf16 a[120:123], a[52:55], a[76:79], a[120:123]
s_add_u32 m0, s77, 99328
buffer_store_dwordx4 v[136:139], v16, s[44:47], s67 offen sc1
v_mfma_f32_16x16x32_bf16 a[124:127], a[60:63], a[76:79], a[124:127]
s_add_u32 s64, s71, 1081344
v_cvt_pk_bf16_f32 v123, v122, v123
v_cvt_pk_bf16_f32 v122, v120, v121
v_mfma_f32_16x16x32_bf16 a[124:127], a[56:59], a[72:75], a[124:127]
buffer_load_dwordx4 v14, s[56:59], s64 offen lds
v_mfma_f32_16x16x32_bf16 a[128:131], a[56:59], a[80:83], a[128:131]
ds_read_b64_tr_b16 a[72:73], v19 offset:32768
v_cvt_pk_bf16_f32 v120, v56, v57
v_mfma_f32_16x16x32_bf16 a[128:131], a[60:63], a[84:87], a[128:131]
ds_read_b64_tr_b16 a[74:75], v19 offset:33024
v_cvt_pk_bf16_f32 v121, v58, v59
v_mfma_f32_16x16x32_bf16 a[132:135], a[52:55], a[84:87], a[132:135]
ds_read_b64_tr_b16 a[76:77], v19 offset:34816
v_accvgpr_write_b32 a180, v120
v_mfma_f32_16x16x32_bf16 a[132:135], a[48:51], a[80:83], a[132:135]
ds_read_b64_tr_b16 a[78:79], v19 offset:35072
v_accvgpr_write_b32 a181, v121
v_mfma_f32_16x16x32_bf16 a[136:139], a[40:43], a[80:83], a[136:139]
v_accvgpr_write_b32 a182, v122
v_accvgpr_write_b32 a183, v123
v_mfma_f32_16x16x32_bf16 a[136:139], a[44:47], a[84:87], a[136:139]
v_cvt_pk_bf16_f32 v107, v106, v107
v_cvt_pk_bf16_f32 v106, v104, v105
v_mfma_f32_16x16x32_bf16 a[140:143], a[36:39], a[84:87], a[140:143]
s_add_u32 m0, s78, 118784
v_cvt_pk_bf16_f32 v104, v40, v41
v_cvt_pk_bf16_f32 v105, v42, v43
v_mfma_f32_16x16x32_bf16 a[140:143], a[32:35], a[80:83], a[140:143]
s_waitcnt lgkmcnt(4)
s_add_u32 s64, s75, 788480
ds_read_b64_tr_b16 a[80:81], v20 offset:32768
v_accvgpr_write_b32 a184, v104
v_mfma_f32_16x16x32_bf16 v[184:187], a[88:91], a[0:3], 0
buffer_load_dwordx4 v23, s[60:63], s64 offen lds
v_mfma_f32_16x16x32_bf16 v[184:187], a[92:95], a[4:7], v[184:187]
ds_read_b64_tr_b16 a[82:83], v20 offset:33024
v_accvgpr_write_b32 a185, v105
v_mfma_f32_16x16x32_bf16 v[192:195], a[92:95], a[12:15], 0
ds_read_b64_tr_b16 a[84:85], v20 offset:34816
v_accvgpr_write_b32 a186, v106
v_mfma_f32_16x16x32_bf16 v[192:195], a[88:91], a[8:11], v[192:195]
s_add_u32 s17, s78, .-L_pc+6144
ds_read_b64_tr_b16 a[86:87], v20 offset:35072
v_accvgpr_write_b32 a187, v107
v_mfma_f32_16x16x32_bf16 v[200:203], a[88:91], a[16:19], 0
buffer_load_dword a252, v16, s[88:91], s17 offen
v_mfma_f32_16x16x32_bf16 v[200:203], a[92:95], a[20:23], v[200:203]
v_cvt_pk_bf16_f32 v91, v90, v91
v_cvt_pk_bf16_f32 v90, v88, v89
v_mfma_f32_16x16x32_bf16 v[208:211], a[92:95], a[28:31], 0
v_cvt_pk_bf16_f32 v88, v24, v25
v_cvt_pk_bf16_f32 v89, v26, v27
v_mfma_f32_16x16x32_bf16 v[208:211], a[88:91], a[24:27], v[208:211]
ds_read_b64_tr_b16 a[88:89], v4 offset:32768
v_accvgpr_write_b32 a188, v88
v_mfma_f32_16x16x32_bf16 v[212:215], a[96:99], a[24:27], 0
s_add_u32 m0, s77, 100352
ds_read_b64_tr_b16 a[90:91], v4 offset:33792
v_accvgpr_write_b32 a189, v89
v_mfma_f32_16x16x32_bf16 v[212:215], a[100:103], a[28:31], v[212:215]
s_add_u32 s64, s71, 1114112
ds_read_b64_tr_b16 a[92:93], v4 offset:40960
v_accvgpr_write_b32 a190, v90
v_mfma_f32_16x16x32_bf16 v[204:207], a[100:103], a[20:23], 0
buffer_load_dwordx4 v15, s[56:59], s64 offen lds
v_mfma_f32_16x16x32_bf16 v[204:207], a[96:99], a[16:19], v[204:207]
ds_read_b64_tr_b16 a[94:95], v4 offset:41984
v_accvgpr_write_b32 a191, v91
v_mfma_f32_16x16x32_bf16 v[196:199], a[96:99], a[8:11], 0
s_add_u32 s67, s79, 8192
v_cvt_pk_bf16_f32 v47, v46, v47
v_cvt_pk_bf16_f32 v46, v44, v45
v_mfma_f32_16x16x32_bf16 v[196:199], a[100:103], a[12:15], v[196:199]
v_cvt_pk_bf16_f32 v44, v28, v29
v_cvt_pk_bf16_f32 v45, v30, v31
v_mfma_f32_16x16x32_bf16 v[188:191], a[100:103], a[4:7], 0
buffer_store_dwordx4 v[44:47], v16, s[44:47], s67 offen sc1
v_mfma_f32_16x16x32_bf16 v[188:191], a[96:99], a[0:3], v[188:191]
ds_read_b64_tr_b16 a[96:97], v5 offset:32768
v_cvt_pk_bf16_f32 v79, v78, v79
v_mfma_f32_16x16x32_bf16 v[216:219], a[0:3], a[104:107], 0
ds_read_b64_tr_b16 a[98:99], v5 offset:33792
v_cvt_pk_bf16_f32 v78, v76, v77
v_mfma_f32_16x16x32_bf16 v[216:219], a[4:7], a[108:111], v[216:219]
s_add_u32 m0, s78, 122880
ds_read_b64_tr_b16 a[100:101], v5 offset:40960
v_cvt_pk_bf16_f32 v76, v60, v61
v_mfma_f32_16x16x32_bf16 v[224:227], a[12:15], a[108:111], 0
s_add_u32 s64, s75, 790528
ds_read_b64_tr_b16 a[102:103], v5 offset:41984
v_cvt_pk_bf16_f32 v77, v62, v63
v_mfma_f32_16x16x32_bf16 v[224:227], a[8:11], a[104:107], v[224:227]
buffer_load_dwordx4 v23, s[60:63], s64 offen lds
v_mfma_f32_16x16x32_bf16 v[232:235], a[16:19], a[104:107], 0
v_accvgpr_write_b32 a192, v76
v_accvgpr_write_b32 a193, v77
v_mfma_f32_16x16x32_bf16 v[232:235], a[20:23], a[108:111], v[232:235]
v_accvgpr_write_b32 a194, v78
v_accvgpr_write_b32 a195, v79
v_mfma_f32_16x16x32_bf16 v[240:243], a[28:31], a[108:111], 0
v_cvt_pk_bf16_f32 v124, v124, v125
v_cvt_pk_bf16_f32 v125, v126, v127
v_mfma_f32_16x16x32_bf16 v[240:243], a[24:27], a[104:107], v[240:243]
ds_read_b64_tr_b16 a[104:105], v6 offset:32768
v_cvt_pk_bf16_f32 v126, v140, v141
v_mfma_f32_16x16x32_bf16 v[244:247], a[24:27], a[112:115], 0
ds_read_b64_tr_b16 a[106:107], v6 offset:33792
v_cvt_pk_bf16_f32 v127, v142, v143
v_mfma_f32_16x16x32_bf16 v[244:247], a[28:31], a[116:119], v[244:247]
ds_read_b64_tr_b16 a[108:109], v6 offset:40960
v_accvgpr_write_b32 a196, v124
v_mfma_f32_16x16x32_bf16 v[236:239], a[20:23], a[116:119], 0
s_add_u32 m0, s77, 101376
ds_read_b64_tr_b16 a[110:111], v6 offset:41984
v_accvgpr_write_b32 a197, v125
v_mfma_f32_16x16x32_bf16 v[236:239], a[16:19], a[112:115], v[236:239]
s_add_u32 s64, s71, 1146880
v_accvgpr_write_b32 a198, v126
v_accvgpr_write_b32 a199, v127
v_mfma_f32_16x16x32_bf16 v[228:231], a[8:11], a[112:115], 0
buffer_load_dwordx4 v15, s[56:59], s64 offen lds
v_mfma_f32_16x16x32_bf16 v[228:231], a[12:15], a[116:119], v[228:231]
v_cvt_pk_bf16_f32 v92, v92, v93
v_cvt_pk_bf16_f32 v93, v94, v95
v_mfma_f32_16x16x32_bf16 v[220:223], a[4:7], a[116:119], 0
v_cvt_pk_bf16_f32 v94, v108, v109
v_cvt_pk_bf16_f32 v95, v110, v111
v_mfma_f32_16x16x32_bf16 v[220:223], a[0:3], a[112:115], v[220:223]
s_waitcnt lgkmcnt(4)
ds_read_b64_tr_b16 a[112:113], v7 offset:32768
v_accvgpr_write_b32 a200, v92
v_mfma_f32_16x16x32_bf16 v[152:155], a[72:75], a[0:3], 0
ds_read_b64_tr_b16 a[114:115], v7 offset:33792
v_accvgpr_write_b32 a201, v93
v_mfma_f32_16x16x32_bf16 v[152:155], a[76:79], a[4:7], v[152:155]
ds_read_b64_tr_b16 a[116:117], v7 offset:40960
v_accvgpr_write_b32 a202, v94
v_mfma_f32_16x16x32_bf16 v[160:163], a[76:79], a[12:15], 0
ds_read_b64_tr_b16 a[118:119], v7 offset:41984
v_accvgpr_write_b32 a203, v95
v_mfma_f32_16x16x32_bf16 v[160:163], a[72:75], a[8:11], v[160:163]
s_add_u32 s67, s79, 10240
v_cvt_pk_bf16_f32 v51, v50, v51
v_cvt_pk_bf16_f32 v50, v48, v49
v_mfma_f32_16x16x32_bf16 v[168:171], a[72:75], a[16:19], 0
v_cvt_pk_bf16_f32 v48, v32, v33
v_cvt_pk_bf16_f32 v49, v34, v35
v_mfma_f32_16x16x32_bf16 v[168:171], a[76:79], a[20:23], v[168:171]
buffer_store_dwordx4 v[48:51], v16, s[44:47], s67 offen sc1
v_mfma_f32_16x16x32_bf16 v[176:179], a[76:79], a[28:31], 0
s_add_u32 m0, s76, 0
v_subrev_u32 v19, 0x8000, v19
v_subrev_u32 v20, 0x8000, v20
v_mfma_f32_16x16x32_bf16 v[176:179], a[72:75], a[24:27], v[176:179]
s_add_u32 s64, s72, 256
ds_read_b64_tr_b16 a[72:73], v8 offset:32768
v_cvt_pk_bf16_f32 v83, v82, v83
v_mfma_f32_16x16x32_bf16 v[180:183], a[80:83], a[24:27], 0
buffer_load_dwordx4 v12, s[48:51], s64 offen lds
v_mfma_f32_16x16x32_bf16 v[180:183], a[84:87], a[28:31], v[180:183]
ds_read_b64_tr_b16 a[74:75], v8 offset:33792
v_subrev_u32 v4, 0x8000, v4
v_mfma_f32_16x16x32_bf16 v[172:175], a[84:87], a[20:23], 0
ds_read_b64_tr_b16 a[76:77], v8 offset:40960
v_cvt_pk_bf16_f32 v82, v80, v81
v_mfma_f32_16x16x32_bf16 v[172:175], a[80:83], a[16:19], v[172:175]
s_add_u32 m0, s76, 1024
ds_read_b64_tr_b16 a[78:79], v8 offset:41984
v_cvt_pk_bf16_f32 v80, v64, v65
v_mfma_f32_16x16x32_bf16 v[164:167], a[80:83], a[8:11], 0
s_add_u32 s64, s72, 16640
v_cvt_pk_bf16_f32 v81, v66, v67
v_accvgpr_write_b32 a204, v80
v_mfma_f32_16x16x32_bf16 v[164:167], a[84:87], a[12:15], v[164:167]
buffer_load_dwordx4 v13, s[48:51], s64 offen lds
v_mfma_f32_16x16x32_bf16 v[156:159], a[84:87], a[4:7], 0
v_accvgpr_write_b32 a205, v81
v_accvgpr_write_b32 a206, v82
v_mfma_f32_16x16x32_bf16 v[156:159], a[80:83], a[0:3], v[156:159]
ds_read_b64_tr_b16 a[80:81], v9 offset:32768
v_accvgpr_write_b32 a207, v83
v_mfma_f32_16x16x32_bf16 v[24:27], a[88:91], a[0:3], 0
s_add_u32 m0, s76, 2048
ds_read_b64_tr_b16 a[82:83], v9 offset:33792
v_cvt_pk_bf16_f32 v128, v128, v129
v_mfma_f32_16x16x32_bf16 v[24:27], a[92:95], a[4:7], v[24:27]
s_add_u32 s64, s72, 131328
ds_read_b64_tr_b16 a[84:85], v9 offset:40960
v_subrev_u32 v5, 0x8000, v5
v_mfma_f32_16x16x32_bf16 v[40:43], a[92:95], a[12:15], 0
buffer_load_dwordx4 v12, s[48:51], s64 offen lds
v_mfma_f32_16x16x32_bf16 v[40:43], a[88:91], a[8:11], v[40:43]
ds_read_b64_tr_b16 a[86:87], v9 offset:41984
v_cvt_pk_bf16_f32 v129, v130, v131
v_mfma_f32_16x16x32_bf16 v[56:59], a[88:91], a[16:19], 0
s_add_u32 m0, s76, 3072
v_cvt_pk_bf16_f32 v130, v144, v145
v_cvt_pk_bf16_f32 v131, v146, v147
v_mfma_f32_16x16x32_bf16 v[56:59], a[92:95], a[20:23], v[56:59]
s_add_u32 s64, s72, 147712
v_accvgpr_write_b32 a208, v128
v_accvgpr_write_b32 a209, v129
v_mfma_f32_16x16x32_bf16 v[72:75], a[92:95], a[28:31], 0
s_waitcnt vmcnt(14)
ds_read_b128 a[32:35], v2 offset:32768
v_accvgpr_write_b32 a210, v130
v_mfma_f32_16x16x32_bf16 v[72:75], a[88:91], a[24:27], v[72:75]
buffer_load_dwordx4 v13, s[48:51], s64 offen lds
v_mfma_f32_16x16x32_bf16 v[136:139], a[96:99], a[24:27], 0
ds_read_b128 a[36:39], v3 offset:32768
v_accvgpr_write_b32 a211, v131
v_mfma_f32_16x16x32_bf16 v[136:139], a[100:103], a[28:31], v[136:139]
ds_read_b128 a[40:43], v2 offset:34816
v_subrev_u32 v6, 0x8000, v6
v_mfma_f32_16x16x32_bf16 v[120:123], a[100:103], a[20:23], 0
s_add_u32 m0, s76, 4096
ds_read_b128 a[44:47], v3 offset:34816
v_cvt_pk_bf16_f32 v96, v96, v97
v_mfma_f32_16x16x32_bf16 v[120:123], a[96:99], a[16:19], v[120:123]
s_add_u32 s64, s73, 256
ds_read_b128 a[48:51], v2 offset:36864
v_cvt_pk_bf16_f32 v97, v98, v99
v_mfma_f32_16x16x32_bf16 v[104:107], a[96:99], a[8:11], 0
buffer_load_dwordx4 v12, s[48:51], s64 offen lds
v_mfma_f32_16x16x32_bf16 v[104:107], a[100:103], a[12:15], v[104:107]
ds_read_b128 a[52:55], v3 offset:36864
v_cvt_pk_bf16_f32 v98, v112, v113
v_mfma_f32_16x16x32_bf16 v[88:91], a[100:103], a[4:7], 0
ds_read_b128 a[56:59], v2 offset:38912
v_cvt_pk_bf16_f32 v99, v114, v115
v_mfma_f32_16x16x32_bf16 v[88:91], a[96:99], a[0:3], v[88:91]
s_waitcnt lgkmcnt(7)
s_add_u32 m0, s76, 5120
ds_read_b128 a[60:63], v3 offset:38912
v_accvgpr_write_b32 a212, v96
v_mfma_f32_16x16x32_bf16 v[28:31], a[104:107], a[0:3], 0
s_add_u32 s64, s73, 16640
ds_read_b64_tr_b16 a[88:89], v10 offset:32768
v_accvgpr_write_b32 a213, v97
v_mfma_f32_16x16x32_bf16 v[28:31], a[108:111], a[4:7], v[28:31]
buffer_load_dwordx4 v13, s[48:51], s64 offen lds
v_mfma_f32_16x16x32_bf16 v[44:47], a[108:111], a[12:15], 0
ds_read_b64_tr_b16 a[90:91], v10 offset:33792
v_subrev_u32 v7, 0x8000, v7
v_mfma_f32_16x16x32_bf16 v[44:47], a[104:107], a[8:11], v[44:47]
s_add_u32 m0, s76, 6144
ds_read_b64_tr_b16 a[92:93], v10 offset:40960
v_accvgpr_write_b32 a214, v98
v_mfma_f32_16x16x32_bf16 v[60:63], a[104:107], a[16:19], 0
s_add_u32 s64, s73, 131328
ds_read_b64_tr_b16 a[94:95], v10 offset:41984
v_accvgpr_write_b32 a215, v99
v_mfma_f32_16x16x32_bf16 v[60:63], a[108:111], a[20:23], v[60:63]
s_add_u32 s67, s79, 12288
ds_read_b64_tr_b16 a[96:97], v11 offset:32768
v_cvt_pk_bf16_f32 v55, v54, v55
v_mfma_f32_16x16x32_bf16 v[76:79], a[108:111], a[28:31], 0
buffer_load_dwordx4 v12, s[48:51], s64 offen lds
v_mfma_f32_16x16x32_bf16 v[76:79], a[104:107], a[24:27], v[76:79]
ds_read_b64_tr_b16 a[98:99], v11 offset:33792
v_cvt_pk_bf16_f32 v54, v52, v53
v_mfma_f32_16x16x32_bf16 v[140:143], a[112:115], a[24:27], 0
ds_read_b64_tr_b16 a[100:101], v11 offset:40960
v_cvt_pk_bf16_f32 v52, v36, v37
v_mfma_f32_16x16x32_bf16 v[140:143], a[116:119], a[28:31], v[140:143]
s_add_u32 m0, s76, 7168
ds_read_b64_tr_b16 a[102:103], v11 offset:41984
v_subrev_u32 v8, 0x8000, v8
v_mfma_f32_16x16x32_bf16 v[124:127], a[116:119], a[20:23], 0
s_add_u32 s64, s73, 147712
v_cvt_pk_bf16_f32 v53, v38, v39
v_mfma_f32_16x16x32_bf16 v[124:127], a[112:115], a[16:19], v[124:127]
buffer_load_dwordx4 v13, s[48:51], s64 offen lds
v_mfma_f32_16x16x32_bf16 v[108:111], a[112:115], a[8:11], 0
buffer_store_dwordx4 v[52:55], v16, s[44:47], s67 offen sc1
v_mfma_f32_16x16x32_bf16 v[108:111], a[116:119], a[12:15], v[108:111]
v_cvt_pk_bf16_f32 v87, v86, v87
v_cvt_pk_bf16_f32 v86, v84, v85
v_mfma_f32_16x16x32_bf16 v[92:95], a[116:119], a[4:7], 0
v_subrev_u32 v9, 0x8000, v9
v_subrev_u32 v10, 0x8000, v10
v_mfma_f32_16x16x32_bf16 v[92:95], a[112:115], a[0:3], v[92:95]
v_subrev_u32 v11, 0x8000, v11
v_cvt_pk_bf16_f32 v84, v68, v69
v_mfma_f32_16x16x32_bf16 v[32:35], a[72:75], a[0:3], 0
v_cvt_pk_bf16_f32 v85, v70, v71
v_accvgpr_write_b32 a216, v84
v_mfma_f32_16x16x32_bf16 v[32:35], a[76:79], a[4:7], v[32:35]
v_accvgpr_write_b32 a217, v85
v_accvgpr_write_b32 a218, v86
v_mfma_f32_16x16x32_bf16 v[48:51], a[76:79], a[12:15], 0
s_waitcnt lgkmcnt(0)
s_barrier
v_mfma_f32_16x16x32_bf16 v[48:51], a[72:75], a[8:11], v[48:51]
s_add_u32 m0, s77, 131072
ds_read_b64_tr_b16 a[104:105], v19 offset:4096
v_accvgpr_write_b32 a219, v87
v_mfma_f32_16x16x32_bf16 v[64:67], a[72:75], a[16:19], 0
s_add_u32 s64, s71, 1572864
ds_read_b64_tr_b16 a[106:107], v19 offset:4352
v_cvt_pk_bf16_f32 v132, v132, v133
v_mfma_f32_16x16x32_bf16 v[64:67], a[76:79], a[20:23], v[64:67]
buffer_load_dwordx4 v14, s[56:59], s64 offen lds
v_mfma_f32_16x16x32_bf16 v[80:83], a[76:79], a[28:31], 0
ds_read_b64_tr_b16 a[108:109], v19 offset:6144
v_cvt_pk_bf16_f32 v133, v134, v135
v_mfma_f32_16x16x32_bf16 v[80:83], a[72:75], a[24:27], v[80:83]
ds_read_b64_tr_b16 a[110:111], v19 offset:6400
v_cvt_pk_bf16_f32 v134, v148, v149
v_mfma_f32_16x16x32_bf16 v[144:147], a[80:83], a[24:27], 0
ds_read_b64_tr_b16 a[112:113], v20 offset:4096
v_cvt_pk_bf16_f32 v135, v150, v151
v_mfma_f32_16x16x32_bf16 v[144:147], a[84:87], a[28:31], v[144:147]
ds_read_b64_tr_b16 a[114:115], v20 offset:4352
v_accvgpr_write_b32 a220, v132
v_mfma_f32_16x16x32_bf16 v[128:131], a[84:87], a[20:23], 0
ds_read_b64_tr_b16 a[116:117], v20 offset:6144
v_accvgpr_write_b32 a221, v133
v_mfma_f32_16x16x32_bf16 v[128:131], a[80:83], a[16:19], v[128:131]
ds_read_b64_tr_b16 a[118:119], v20 offset:6400
v_accvgpr_write_b32 a222, v134
v_mfma_f32_16x16x32_bf16 v[112:115], a[80:83], a[8:11], 0
s_add_u32 m0, s78, 147456
ds_read_b64_tr_b16 a[72:73], v19 offset:8192
v_accvgpr_write_b32 a223, v135
v_mfma_f32_16x16x32_bf16 v[112:115], a[84:87], a[12:15], v[112:115]
s_add_u32 s64, s75, 1179648
ds_read_b64_tr_b16 a[74:75], v19 offset:8448
v_cvt_pk_bf16_f32 v100, v100, v101
v_mfma_f32_16x16x32_bf16 v[96:99], a[84:87], a[4:7], 0
buffer_load_dwordx4 v23, s[60:63], s64 offen lds
v_mfma_f32_16x16x32_bf16 v[96:99], a[80:83], a[0:3], v[96:99]
ds_read_b64_tr_b16 a[76:77], v19 offset:10240
v_cvt_pk_bf16_f32 v101, v102, v103
v_mfma_f32_16x16x32_bf16 v[36:39], a[88:91], a[0:3], 0
ds_read_b64_tr_b16 a[78:79], v19 offset:10496
v_cvt_pk_bf16_f32 v102, v116, v117
v_mfma_f32_16x16x32_bf16 v[36:39], a[92:95], a[4:7], v[36:39]
ds_read_b64_tr_b16 a[80:81], v20 offset:8192
v_cvt_pk_bf16_f32 v103, v118, v119
v_mfma_f32_16x16x32_bf16 v[52:55], a[92:95], a[12:15], 0
ds_read_b64_tr_b16 a[82:83], v20 offset:8448
v_accvgpr_write_b32 a224, v100
v_mfma_f32_16x16x32_bf16 v[52:55], a[88:91], a[8:11], v[52:55]
ds_read_b64_tr_b16 a[84:85], v20 offset:10240
v_accvgpr_write_b32 a225, v101
v_mfma_f32_16x16x32_bf16 v[68:71], a[88:91], a[16:19], 0
s_add_u32 m0, s77, 132096
ds_read_b64_tr_b16 a[86:87], v20 offset:10496
v_accvgpr_write_b32 a226, v102
v_mfma_f32_16x16x32_bf16 v[68:71], a[92:95], a[20:23], v[68:71]
s_add_u32 s64, s71, 1605632
s_xor_b32 s68, s66, 0
v_accvgpr_write_b32 a227, v103
v_mfma_f32_16x16x32_bf16 v[84:87], a[92:95], a[28:31], 0
s_add_u32 s67, s79, 14336
s_mov_b64 exec, 1
buffer_atomic_add a251, v1, s[52:55], s68 offen offset:0 sc1
s_mov_b64 exec, -1
v_mfma_f32_16x16x32_bf16 v[84:87], a[88:91], a[24:27], v[84:87]
buffer_load_dwordx4 v14, s[56:59], s64 offen lds
v_mfma_f32_16x16x32_bf16 v[148:151], a[96:99], a[24:27], 0
ds_read_b64_tr_b16 a[88:89], v19 offset:0
v_cvt_pk_bf16_f32 v255, v254, v255
v_mfma_f32_16x16x32_bf16 v[148:151], a[100:103], a[28:31], v[148:151]
ds_read_b64_tr_b16 a[90:91], v19 offset:256
v_cvt_pk_bf16_f32 v254, v252, v253
v_mfma_f32_16x16x32_bf16 v[132:135], a[100:103], a[20:23], 0
ds_read_b64_tr_b16 a[92:93], v19 offset:2048
v_cvt_pk_bf16_f32 v252, v248, v249
v_mfma_f32_16x16x32_bf16 v[132:135], a[96:99], a[16:19], v[132:135]
s_add_u32 s65, s79, 16384
ds_read_b64_tr_b16 a[94:95], v19 offset:2304
v_cvt_pk_bf16_f32 v253, v250, v251
v_mfma_f32_16x16x32_bf16 v[116:119], a[96:99], a[8:11], 0
buffer_store_dwordx4 a[144:147], v16, s[44:47], s65 offen sc1
v_mfma_f32_16x16x32_bf16 v[116:119], a[100:103], a[12:15], v[116:119]
buffer_store_dwordx4 v[252:255], v16, s[44:47], s67 offen sc1
v_mfma_f32_16x16x32_bf16 v[100:103], a[100:103], a[4:7], 0
s_add_u32 m0, s78, 151552
v_mfma_f32_16x16x32_bf16 v[100:103], a[96:99], a[0:3], v[100:103]
s_waitcnt lgkmcnt(4)
s_add_u32 s64, s75, 1181696
ds_read_b64_tr_b16 a[96:97], v20 offset:0
v_accvgpr_read_b32 v248, a120
v_mfma_f32_16x16x32_bf16 v[184:187], a[104:107], a[32:35], v[184:187]
buffer_load_dwordx4 v23, s[60:63], s64 offen lds
v_mfma_f32_16x16x32_bf16 v[184:187], a[108:111], a[36:39], v[184:187]
ds_read_b64_tr_b16 a[98:99], v20 offset:256
v_accvgpr_read_b32 v249, a121
v_mfma_f32_16x16x32_bf16 v[192:195], a[108:111], a[44:47], v[192:195]
ds_read_b64_tr_b16 a[100:101], v20 offset:2048
v_accvgpr_read_b32 v250, a122
v_mfma_f32_16x16x32_bf16 v[192:195], a[104:107], a[40:43], v[192:195]
ds_read_b64_tr_b16 a[102:103], v20 offset:2304
v_accvgpr_read_b32 v251, a123
v_mfma_f32_16x16x32_bf16 v[200:203], a[104:107], a[48:51], v[200:203]
v_accvgpr_read_b32 v252, a124
v_accvgpr_read_b32 v253, a125
v_mfma_f32_16x16x32_bf16 v[200:203], a[108:111], a[52:55], v[200:203]
v_accvgpr_read_b32 v254, a126
v_accvgpr_read_b32 v255, a127
v_mfma_f32_16x16x32_bf16 v[208:211], a[108:111], a[60:63], v[208:211]
v_cvt_pk_bf16_f32 v255, v254, v255
v_cvt_pk_bf16_f32 v254, v252, v253
v_mfma_f32_16x16x32_bf16 v[208:211], a[104:107], a[56:59], v[208:211]
ds_read_b64_tr_b16 a[104:105], v4 offset:0
v_cvt_pk_bf16_f32 v252, v248, v249
v_mfma_f32_16x16x32_bf16 v[212:215], a[112:115], a[56:59], v[212:215]
s_add_u32 m0, s77, 133120
ds_read_b64_tr_b16 a[106:107], v4 offset:1024
v_cvt_pk_bf16_f32 v253, v250, v251
v_mfma_f32_16x16x32_bf16 v[212:215], a[116:119], a[60:63], v[212:215]
s_add_u32 s64, s71, 1638400
ds_read_b64_tr_b16 a[108:109], v4 offset:8192
v_accvgpr_write_b32 a228, v252
v_mfma_f32_16x16x32_bf16 v[204:207], a[116:119], a[52:55], v[204:207]
buffer_load_dwordx4 v15, s[56:59], s64 offen lds
v_mfma_f32_16x16x32_bf16 v[204:207], a[112:115], a[48:51], v[204:207]
ds_read_b64_tr_b16 a[110:111], v4 offset:9216
v_accvgpr_write_b32 a229, v253
v_mfma_f32_16x16x32_bf16 v[196:199], a[112:115], a[40:43], v[196:199]
v_accvgpr_write_b32 a230, v254
v_accvgpr_write_b32 a231, v255
v_mfma_f32_16x16x32_bf16 v[196:199], a[116:119], a[44:47], v[196:199]
v_mfma_f32_16x16x32_bf16 v[188:191], a[116:119], a[36:39], v[188:191]
v_accvgpr_read_b32 v248, a132
v_accvgpr_read_b32 v249, a133
v_mfma_f32_16x16x32_bf16 v[188:191], a[112:115], a[32:35], v[188:191]
ds_read_b64_tr_b16 a[112:113], v5 offset:0
v_accvgpr_read_b32 v250, a134
v_mfma_f32_16x16x32_bf16 v[216:219], a[32:35], a[72:75], v[216:219]
ds_read_b64_tr_b16 a[114:115], v5 offset:1024
v_accvgpr_read_b32 v251, a135
v_mfma_f32_16x16x32_bf16 v[216:219], a[36:39], a[76:79], v[216:219]
s_add_u32 m0, s78, 155648
ds_read_b64_tr_b16 a[116:117], v5 offset:8192
v_accvgpr_read_b32 v252, a128
v_mfma_f32_16x16x32_bf16 v[224:227], a[44:47], a[76:79], v[224:227]
s_add_u32 s64, s75, 1183744
ds_read_b64_tr_b16 a[118:119], v5 offset:9216
v_accvgpr_read_b32 v253, a129
v_mfma_f32_16x16x32_bf16 v[224:227], a[40:43], a[72:75], v[224:227]
buffer_load_dwordx4 v23, s[60:63], s64 offen lds
v_mfma_f32_16x16x32_bf16 v[232:235], a[48:51], a[72:75], v[232:235]
v_accvgpr_read_b32 v254, a130
v_accvgpr_read_b32 v255, a131
v_mfma_f32_16x16x32_bf16 v[232:235], a[52:55], a[76:79], v[232:235]
v_cvt_pk_bf16_f32 v255, v254, v255
v_cvt_pk_bf16_f32 v254, v252, v253
v_mfma_f32_16x16x32_bf16 v[240:243], a[60:63], a[76:79], v[240:243]
v_cvt_pk_bf16_f32 v252, v248, v249
v_cvt_pk_bf16_f32 v253, v250, v251
v_mfma_f32_16x16x32_bf16 v[240:243], a[56:59], a[72:75], v[240:243]
ds_read_b64_tr_b16 a[72:73], v6 offset:0
v_accvgpr_write_b32 a232, v252
v_mfma_f32_16x16x32_bf16 v[244:247], a[56:59], a[80:83], v[244:247]
ds_read_b64_tr_b16 a[74:75], v6 offset:1024
v_accvgpr_write_b32 a233, v253
v_mfma_f32_16x16x32_bf16 v[244:247], a[60:63], a[84:87], v[244:247]
ds_read_b64_tr_b16 a[76:77], v6 offset:8192
v_accvgpr_write_b32 a234, v254
v_mfma_f32_16x16x32_bf16 v[236:239], a[52:55], a[84:87], v[236:239]
s_add_u32 m0, s77, 134144
ds_read_b64_tr_b16 a[78:79], v6 offset:9216
v_accvgpr_write_b32 a235, v255
v_mfma_f32_16x16x32_bf16 v[236:239], a[48:51], a[80:83], v[236:239]
s_add_u32 s64, s71, 1671168
v_mfma_f32_16x16x32_bf16 v[228:231], a[40:43], a[80:83], v[228:231]
buffer_load_dwordx4 v15, s[56:59], s64 offen lds
v_mfma_f32_16x16x32_bf16 v[228:231], a[44:47], a[84:87], v[228:231]
v_accvgpr_read_b32 v248, a140
v_accvgpr_read_b32 v249, a141
v_mfma_f32_16x16x32_bf16 v[220:223], a[36:39], a[84:87], v[220:223]
v_accvgpr_read_b32 v250, a142
v_accvgpr_read_b32 v251, a143
v_mfma_f32_16x16x32_bf16 v[220:223], a[32:35], a[80:83], v[220:223]
s_waitcnt lgkmcnt(4)
ds_read_b64_tr_b16 a[80:81], v7 offset:0
v_accvgpr_read_b32 v252, a136
v_mfma_f32_16x16x32_bf16 v[152:155], a[88:91], a[32:35], v[152:155]
ds_read_b64_tr_b16 a[82:83], v7 offset:1024
v_accvgpr_read_b32 v253, a137
v_mfma_f32_16x16x32_bf16 v[152:155], a[92:95], a[36:39], v[152:155]
ds_read_b64_tr_b16 a[84:85], v7 offset:8192
v_accvgpr_read_b32 v254, a138
v_mfma_f32_16x16x32_bf16 v[160:163], a[92:95], a[44:47], v[160:163]
ds_read_b64_tr_b16 a[86:87], v7 offset:9216
v_accvgpr_read_b32 v255, a139
v_mfma_f32_16x16x32_bf16 v[160:163], a[88:91], a[40:43], v[160:163]
v_cvt_pk_bf16_f32 v255, v254, v255
v_cvt_pk_bf16_f32 v254, v252, v253
v_mfma_f32_16x16x32_bf16 v[168:171], a[88:91], a[48:51], v[168:171]
v_cvt_pk_bf16_f32 v252, v248, v249
v_cvt_pk_bf16_f32 v253, v250, v251
v_mfma_f32_16x16x32_bf16 v[168:171], a[92:95], a[52:55], v[168:171]
v_accvgpr_write_b32 a236, v252
v_accvgpr_write_b32 a237, v253
v_mfma_f32_16x16x32_bf16 v[176:179], a[92:95], a[60:63], v[176:179]
s_add_u32 m0, s76, 32768
v_accvgpr_write_b32 a238, v254
v_accvgpr_write_b32 a239, v255
v_mfma_f32_16x16x32_bf16 v[176:179], a[88:91], a[56:59], v[176:179]
s_add_u32 s64, s72, 384
ds_read_b64_tr_b16 a[88:89], v8 offset:0
v_mfma_f32_16x16x32_bf16 v[180:183], a[96:99], a[56:59], v[180:183]
buffer_load_dwordx4 v12, s[48:51], s64 offen lds
v_mfma_f32_16x16x32_bf16 v[180:183], a[100:103], a[60:63], v[180:183]
ds_read_b64_tr_b16 a[90:91], v8 offset:1024
v_mfma_f32_16x16x32_bf16 v[172:175], a[100:103], a[52:55], v[172:175]
ds_read_b64_tr_b16 a[92:93], v8 offset:8192
v_mfma_f32_16x16x32_bf16 v[172:175], a[96:99], a[48:51], v[172:175]
s_add_u32 m0, s76, 33792
ds_read_b64_tr_b16 a[94:95], v8 offset:9216
v_mfma_f32_16x16x32_bf16 v[164:167], a[96:99], a[40:43], v[164:167]
s_add_u32 s64, s72, 16768
v_mfma_f32_16x16x32_bf16 v[164:167], a[100:103], a[44:47], v[164:167]
s_add_u32 s65, s79, 4096
buffer_load_dwordx4 v13, s[48:51], s64 offen lds
v_mfma_f32_16x16x32_bf16 v[156:159], a[100:103], a[36:39], v[156:159]
buffer_store_dwordx4 a[148:151], v16, s[44:47], s65 offen sc1
v_mfma_f32_16x16x32_bf16 v[156:159], a[96:99], a[32:35], v[156:159]
ds_read_b64_tr_b16 a[96:97], v9 offset:0
v_mfma_f32_16x16x32_bf16 v[24:27], a[104:107], a[32:35], v[24:27]
s_add_u32 m0, s76, 34816
ds_read_b64_tr_b16 a[98:99], v9 offset:1024
v_mfma_f32_16x16x32_bf16 v[24:27], a[108:111], a[36:39], v[24:27]
s_add_u32 s64, s72, 131456
ds_read_b64_tr_b16 a[100:101], v9 offset:8192
v_mfma_f32_16x16x32_bf16 v[40:43], a[108:111], a[44:47], v[40:43]
buffer_load_dwordx4 v12, s[48:51], s64 offen lds
v_mfma_f32_16x16x32_bf16 v[40:43], a[104:107], a[40:43], v[40:43]
ds_read_b64_tr_b16 a[102:103], v9 offset:9216
v_mfma_f32_16x16x32_bf16 v[56:59], a[104:107], a[48:51], v[56:59]
v_mfma_f32_16x16x32_bf16 v[56:59], a[108:111], a[52:55], v[56:59]
s_add_u32 m0, s76, 35840
v_mfma_f32_16x16x32_bf16 v[72:75], a[108:111], a[60:63], v[72:75]
s_waitcnt vmcnt(15)
s_add_u32 s64, s72, 147840
ds_read_b128 a[0:3], v2 offset:0
v_mfma_f32_16x16x32_bf16 v[72:75], a[104:107], a[56:59], v[72:75]
buffer_load_dwordx4 v13, s[48:51], s64 offen lds
v_mfma_f32_16x16x32_bf16 v[136:139], a[112:115], a[56:59], v[136:139]
ds_read_b128 a[4:7], v3 offset:0
v_mfma_f32_16x16x32_bf16 v[136:139], a[116:119], a[60:63], v[136:139]
ds_read_b128 a[8:11], v2 offset:2048
v_mfma_f32_16x16x32_bf16 v[120:123], a[116:119], a[52:55], v[120:123]
s_add_u32 m0, s76, 36864
ds_read_b128 a[12:15], v3 offset:2048
v_mfma_f32_16x16x32_bf16 v[120:123], a[112:115], a[48:51], v[120:123]
s_add_u32 s64, s73, 384
ds_read_b128 a[16:19], v2 offset:4096
v_mfma_f32_16x16x32_bf16 v[104:107], a[112:115], a[40:43], v[104:107]
buffer_load_dwordx4 v12, s[48:51], s64 offen lds
v_mfma_f32_16x16x32_bf16 v[104:107], a[116:119], a[44:47], v[104:107]
ds_read_b128 a[20:23], v3 offset:4096
v_mfma_f32_16x16x32_bf16 v[88:91], a[116:119], a[36:39], v[88:91]
ds_read_b128 a[24:27], v2 offset:6144
v_mfma_f32_16x16x32_bf16 v[88:91], a[112:115], a[32:35], v[88:91]
s_waitcnt lgkmcnt(7)
s_add_u32 m0, s76, 37888
ds_read_b128 a[28:31], v3 offset:6144
v_mfma_f32_16x16x32_bf16 v[28:31], a[72:75], a[32:35], v[28:31]
s_add_u32 s64, s73, 16768
ds_read_b64_tr_b16 a[104:105], v10 offset:0
v_mfma_f32_16x16x32_bf16 v[28:31], a[76:79], a[36:39], v[28:31]
buffer_load_dwordx4 v13, s[48:51], s64 offen lds
v_mfma_f32_16x16x32_bf16 v[44:47], a[76:79], a[44:47], v[44:47]
ds_read_b64_tr_b16 a[106:107], v10 offset:1024
v_mfma_f32_16x16x32_bf16 v[44:47], a[72:75], a[40:43], v[44:47]
ds_read_b64_tr_b16 a[108:109], v10 offset:8192
v_mfma_f32_16x16x32_bf16 v[60:63], a[72:75], a[48:51], v[60:63]
s_add_u32 m0, s76, 38912
ds_read_b64_tr_b16 a[110:111], v10 offset:9216
v_mfma_f32_16x16x32_bf16 v[60:63], a[76:79], a[52:55], v[60:63]
s_add_u32 s64, s73, 131456
ds_read_b64_tr_b16 a[112:113], v11 offset:0
v_mfma_f32_16x16x32_bf16 v[76:79], a[76:79], a[60:63], v[76:79]
buffer_load_dwordx4 v12, s[48:51], s64 offen lds
v_mfma_f32_16x16x32_bf16 v[76:79], a[72:75], a[56:59], v[76:79]
ds_read_b64_tr_b16 a[114:115], v11 offset:1024
v_mfma_f32_16x16x32_bf16 v[140:143], a[80:83], a[56:59], v[140:143]
ds_read_b64_tr_b16 a[116:117], v11 offset:8192
v_mfma_f32_16x16x32_bf16 v[140:143], a[84:87], a[60:63], v[140:143]
s_add_u32 m0, s76, 39936
ds_read_b64_tr_b16 a[118:119], v11 offset:9216
v_mfma_f32_16x16x32_bf16 v[124:127], a[84:87], a[52:55], v[124:127]
s_add_u32 s64, s73, 147840
v_mfma_f32_16x16x32_bf16 v[124:127], a[80:83], a[48:51], v[124:127]
buffer_load_dwordx4 v13, s[48:51], s64 offen lds
v_mfma_f32_16x16x32_bf16 v[108:111], a[80:83], a[40:43], v[108:111]
v_mfma_f32_16x16x32_bf16 v[108:111], a[84:87], a[44:47], v[108:111]
v_mfma_f32_16x16x32_bf16 v[92:95], a[84:87], a[36:39], v[92:95]
v_mfma_f32_16x16x32_bf16 v[92:95], a[80:83], a[32:35], v[92:95]
v_mfma_f32_16x16x32_bf16 v[32:35], a[88:91], a[32:35], v[32:35]
v_mfma_f32_16x16x32_bf16 v[32:35], a[92:95], a[36:39], v[32:35]
v_mfma_f32_16x16x32_bf16 v[48:51], a[92:95], a[44:47], v[48:51]
s_waitcnt lgkmcnt(0)
s_barrier
v_mfma_f32_16x16x32_bf16 v[48:51], a[88:91], a[40:43], v[48:51]
s_add_u32 m0, s77, 65536
ds_read_b64_tr_b16 a[72:73], v19 offset:36864
v_mfma_f32_16x16x32_bf16 v[64:67], a[88:91], a[48:51], v[64:67]
s_add_u32 s64, s71, 2097152
ds_read_b64_tr_b16 a[74:75], v19 offset:37120
v_mfma_f32_16x16x32_bf16 v[64:67], a[92:95], a[52:55], v[64:67]
buffer_load_dwordx4 v14, s[56:59], s64 offen lds
v_mfma_f32_16x16x32_bf16 v[80:83], a[92:95], a[60:63], v[80:83]
ds_read_b64_tr_b16 a[76:77], v19 offset:38912
v_mfma_f32_16x16x32_bf16 v[80:83], a[88:91], a[56:59], v[80:83]
ds_read_b64_tr_b16 a[78:79], v19 offset:39168
v_mfma_f32_16x16x32_bf16 v[144:147], a[96:99], a[56:59], v[144:147]
ds_read_b64_tr_b16 a[80:81], v20 offset:36864
v_mfma_f32_16x16x32_bf16 v[144:147], a[100:103], a[60:63], v[144:147]
ds_read_b64_tr_b16 a[82:83], v20 offset:37120
v_mfma_f32_16x16x32_bf16 v[128:131], a[100:103], a[52:55], v[128:131]
ds_read_b64_tr_b16 a[84:85], v20 offset:38912
v_mfma_f32_16x16x32_bf16 v[128:131], a[96:99], a[48:51], v[128:131]
ds_read_b64_tr_b16 a[86:87], v20 offset:39168
v_mfma_f32_16x16x32_bf16 v[112:115], a[96:99], a[40:43], v[112:115]
s_add_u32 m0, s78, 81920
ds_read_b64_tr_b16 a[88:89], v19 offset:40960
v_mfma_f32_16x16x32_bf16 v[112:115], a[100:103], a[44:47], v[112:115]
s_add_u32 s64, s75, 1572864
ds_read_b64_tr_b16 a[90:91], v19 offset:41216
v_mfma_f32_16x16x32_bf16 v[96:99], a[100:103], a[36:39], v[96:99]
s_add_u32 s65, s79, 0
buffer_load_dwordx4 v23, s[60:63], s64 offen lds
v_mfma_f32_16x16x32_bf16 v[96:99], a[96:99], a[32:35], v[96:99]
buffer_store_dwordx4 a[152:155], v16, s[44:47], s65 offen sc1
v_mfma_f32_16x16x32_bf16 v[36:39], a[104:107], a[32:35], v[36:39]
ds_read_b64_tr_b16 a[92:93], v19 offset:43008
v_mfma_f32_16x16x32_bf16 v[36:39], a[108:111], a[36:39], v[36:39]
ds_read_b64_tr_b16 a[94:95], v19 offset:43264
v_mfma_f32_16x16x32_bf16 v[52:55], a[108:111], a[44:47], v[52:55]
ds_read_b64_tr_b16 a[96:97], v20 offset:40960
v_mfma_f32_16x16x32_bf16 v[52:55], a[104:107], a[40:43], v[52:55]
ds_read_b64_tr_b16 a[98:99], v20 offset:41216
v_mfma_f32_16x16x32_bf16 v[68:71], a[104:107], a[48:51], v[68:71]
s_add_u32 m0, s77, 66560
ds_read_b64_tr_b16 a[100:101], v20 offset:43008
v_mfma_f32_16x16x32_bf16 v[68:71], a[108:111], a[52:55], v[68:71]
s_add_u32 s64, s71, 2129920
s_xor_b32 s68, s66, 4096
ds_read_b64_tr_b16 a[102:103], v20 offset:43264
v_mfma_f32_16x16x32_bf16 v[84:87], a[108:111], a[60:63], v[84:87]
s_mov_b64 exec, 1
buffer_atomic_add a251, v1, s[52:55], s68 offen offset:0 sc1
s_mov_b64 exec, -1
v_mfma_f32_16x16x32_bf16 v[84:87], a[104:107], a[56:59], v[84:87]
buffer_load_dwordx4 v14, s[56:59], s64 offen lds
v_mfma_f32_16x16x32_bf16 v[148:151], a[112:115], a[56:59], v[148:151]
ds_read_b64_tr_b16 a[104:105], v19 offset:32768
v_mfma_f32_16x16x32_bf16 v[148:151], a[116:119], a[60:63], v[148:151]
ds_read_b64_tr_b16 a[106:107], v19 offset:33024
v_mfma_f32_16x16x32_bf16 v[132:135], a[116:119], a[52:55], v[132:135]
ds_read_b64_tr_b16 a[108:109], v19 offset:34816
v_mfma_f32_16x16x32_bf16 v[132:135], a[112:115], a[48:51], v[132:135]
ds_read_b64_tr_b16 a[110:111], v19 offset:35072
v_mfma_f32_16x16x32_bf16 v[116:119], a[112:115], a[40:43], v[116:119]
v_mfma_f32_16x16x32_bf16 v[116:119], a[116:119], a[44:47], v[116:119]
v_mfma_f32_16x16x32_bf16 v[100:103], a[116:119], a[36:39], v[100:103]
s_add_u32 m0, s78, 86016
v_mfma_f32_16x16x32_bf16 v[100:103], a[112:115], a[32:35], v[100:103]
s_waitcnt lgkmcnt(4)
s_add_u32 s64, s75, 1574912
ds_read_b64_tr_b16 a[112:113], v20 offset:32768
v_mfma_f32_16x16x32_bf16 v[184:187], a[72:75], a[0:3], v[184:187]
buffer_load_dwordx4 v23, s[60:63], s64 offen lds
v_mfma_f32_16x16x32_bf16 v[184:187], a[76:79], a[4:7], v[184:187]
ds_read_b64_tr_b16 a[114:115], v20 offset:33024
v_mfma_f32_16x16x32_bf16 v[192:195], a[76:79], a[12:15], v[192:195]
ds_read_b64_tr_b16 a[116:117], v20 offset:34816
v_mfma_f32_16x16x32_bf16 v[192:195], a[72:75], a[8:11], v[192:195]
s_add_u32 s17, s78, .-L_pc+6144
ds_read_b64_tr_b16 a[118:119], v20 offset:35072
v_mfma_f32_16x16x32_bf16 v[200:203], a[72:75], a[16:19], v[200:203]
buffer_load_dword a252, v16, s[88:91], s17 offen
v_mfma_f32_16x16x32_bf16 v[200:203], a[76:79], a[20:23], v[200:203]
v_mfma_f32_16x16x32_bf16 v[208:211], a[76:79], a[28:31], v[208:211]
v_mfma_f32_16x16x32_bf16 v[208:211], a[72:75], a[24:27], v[208:211]
ds_read_b64_tr_b16 a[72:73], v4 offset:32768
v_mfma_f32_16x16x32_bf16 v[212:215], a[80:83], a[24:27], v[212:215]
s_add_u32 m0, s77, 67584
ds_read_b64_tr_b16 a[74:75], v4 offset:33792
v_mfma_f32_16x16x32_bf16 v[212:215], a[84:87], a[28:31], v[212:215]
s_add_u32 s64, s71, 2162688
ds_read_b64_tr_b16 a[76:77], v4 offset:40960
v_mfma_f32_16x16x32_bf16 v[204:207], a[84:87], a[20:23], v[204:207]
buffer_load_dwordx4 v15, s[56:59], s64 offen lds
v_mfma_f32_16x16x32_bf16 v[204:207], a[80:83], a[16:19], v[204:207]
ds_read_b64_tr_b16 a[78:79], v4 offset:41984
v_mfma_f32_16x16x32_bf16 v[196:199], a[80:83], a[8:11], v[196:199]
v_mfma_f32_16x16x32_bf16 v[196:199], a[84:87], a[12:15], v[196:199]
v_mfma_f32_16x16x32_bf16 v[188:191], a[84:87], a[4:7], v[188:191]
v_mfma_f32_16x16x32_bf16 v[188:191], a[80:83], a[0:3], v[188:191]
ds_read_b64_tr_b16 a[80:81], v5 offset:32768
v_mfma_f32_16x16x32_bf16 v[216:219], a[0:3], a[88:91], v[216:219]
ds_read_b64_tr_b16 a[82:83], v5 offset:33792
v_mfma_f32_16x16x32_bf16 v[216:219], a[4:7], a[92:95], v[216:219]
s_add_u32 m0, s78, 90112
ds_read_b64_tr_b16 a[84:85], v5 offset:40960
v_mfma_f32_16x16x32_bf16 v[224:227], a[12:15], a[92:95], v[224:227]
s_add_u32 s64, s75, 1576960
ds_read_b64_tr_b16 a[86:87], v5 offset:41984
v_mfma_f32_16x16x32_bf16 v[224:227], a[8:11], a[88:91], v[224:227]
buffer_load_dwordx4 v23, s[60:63], s64 offen lds
v_mfma_f32_16x16x32_bf16 v[232:235], a[16:19], a[88:91], v[232:235]
v_mfma_f32_16x16x32_bf16 v[232:235], a[20:23], a[92:95], v[232:235]
v_mfma_f32_16x16x32_bf16 v[240:243], a[28:31], a[92:95], v[240:243]
v_mfma_f32_16x16x32_bf16 v[240:243], a[24:27], a[88:91], v[240:243]
ds_read_b64_tr_b16 a[88:89], v6 offset:32768
v_mfma_f32_16x16x32_bf16 v[244:247], a[24:27], a[96:99], v[244:247]
ds_read_b64_tr_b16 a[90:91], v6 offset:33792
v_mfma_f32_16x16x32_bf16 v[244:247], a[28:31], a[100:103], v[244:247]
ds_read_b64_tr_b16 a[92:93], v6 offset:40960
v_add_u32 v19, 0x8000, v19
v_mfma_f32_16x16x32_bf16 v[236:239], a[20:23], a[100:103], v[236:239]
s_add_u32 m0, s77, 68608
ds_read_b64_tr_b16 a[94:95], v6 offset:41984
v_mfma_f32_16x16x32_bf16 v[236:239], a[16:19], a[96:99], v[236:239]
s_add_u32 s64, s71, 2195456
v_mfma_f32_16x16x32_bf16 v[228:231], a[8:11], a[96:99], v[228:231]
buffer_load_dwordx4 v15, s[56:59], s64 offen lds
v_mfma_f32_16x16x32_bf16 v[228:231], a[12:15], a[100:103], v[228:231]
v_mfma_f32_16x16x32_bf16 v[220:223], a[4:7], a[100:103], v[220:223]
v_mfma_f32_16x16x32_bf16 v[220:223], a[0:3], a[96:99], v[220:223]
s_waitcnt lgkmcnt(4)
s_add_u32 s65, s79, 17408
ds_read_b64_tr_b16 a[96:97], v7 offset:32768
v_mfma_f32_16x16x32_bf16 v[152:155], a[104:107], a[0:3], v[152:155]
buffer_store_dwordx4 a[156:159], v16, s[44:47], s65 offen sc1
v_mfma_f32_16x16x32_bf16 v[152:155], a[108:111], a[4:7], v[152:155]
ds_read_b64_tr_b16 a[98:99], v7 offset:33792
v_add_u32 v20, 0x8000, v20
v_mfma_f32_16x16x32_bf16 v[160:163], a[108:111], a[12:15], v[160:163]
ds_read_b64_tr_b16 a[100:101], v7 offset:40960
v_mfma_f32_16x16x32_bf16 v[160:163], a[104:107], a[8:11], v[160:163]
ds_read_b64_tr_b16 a[102:103], v7 offset:41984
v_mfma_f32_16x16x32_bf16 v[168:171], a[104:107], a[16:19], v[168:171]
v_mfma_f32_16x16x32_bf16 v[168:171], a[108:111], a[20:23], v[168:171]
v_mfma_f32_16x16x32_bf16 v[176:179], a[108:111], a[28:31], v[176:179]
s_add_u32 m0, s76, 0
v_mfma_f32_16x16x32_bf16 v[176:179], a[104:107], a[24:27], v[176:179]
s_add_u32 s64, s72, 512
ds_read_b64_tr_b16 a[104:105], v8 offset:32768
v_mfma_f32_16x16x32_bf16 v[180:183], a[112:115], a[24:27], v[180:183]
buffer_load_dwordx4 v12, s[48:51], s64 offen lds
v_mfma_f32_16x16x32_bf16 v[180:183], a[116:119], a[28:31], v[180:183]
ds_read_b64_tr_b16 a[106:107], v8 offset:33792
v_add_u32 v4, 0x8000, v4
v_mfma_f32_16x16x32_bf16 v[172:175], a[116:119], a[20:23], v[172:175]
ds_read_b64_tr_b16 a[108:109], v8 offset:40960
v_mfma_f32_16x16x32_bf16 v[172:175], a[112:115], a[16:19], v[172:175]
s_add_u32 m0, s76, 1024
ds_read_b64_tr_b16 a[110:111], v8 offset:41984
v_mfma_f32_16x16x32_bf16 v[164:167], a[112:115], a[8:11], v[164:167]
s_add_u32 s64, s72, 16896
v_mfma_f32_16x16x32_bf16 v[164:167], a[116:119], a[12:15], v[164:167]
buffer_load_dwordx4 v13, s[48:51], s64 offen lds
v_mfma_f32_16x16x32_bf16 v[156:159], a[116:119], a[4:7], v[156:159]
v_mfma_f32_16x16x32_bf16 v[156:159], a[112:115], a[0:3], v[156:159]
ds_read_b64_tr_b16 a[112:113], v9 offset:32768
v_mfma_f32_16x16x32_bf16 v[24:27], a[72:75], a[0:3], v[24:27]
s_add_u32 m0, s76, 2048
ds_read_b64_tr_b16 a[114:115], v9 offset:33792
v_mfma_f32_16x16x32_bf16 v[24:27], a[76:79], a[4:7], v[24:27]
s_add_u32 s64, s72, 131584
ds_read_b64_tr_b16 a[116:117], v9 offset:40960
v_add_u32 v5, 0x8000, v5
v_mfma_f32_16x16x32_bf16 v[40:43], a[76:79], a[12:15], v[40:43]
buffer_load_dwordx4 v12, s[48:51], s64 offen lds
v_mfma_f32_16x16x32_bf16 v[40:43], a[72:75], a[8:11], v[40:43]
ds_read_b64_tr_b16 a[118:119], v9 offset:41984
v_mfma_f32_16x16x32_bf16 v[56:59], a[72:75], a[16:19], v[56:59]
v_mfma_f32_16x16x32_bf16 v[56:59], a[76:79], a[20:23], v[56:59]
s_add_u32 m0, s76, 3072
v_mfma_f32_16x16x32_bf16 v[72:75], a[76:79], a[28:31], v[72:75]
s_waitcnt vmcnt(14)
s_add_u32 s64, s72, 147968
ds_read_b128 a[32:35], v2 offset:32768
v_mfma_f32_16x16x32_bf16 v[72:75], a[72:75], a[24:27], v[72:75]
buffer_load_dwordx4 v13, s[48:51], s64 offen lds
v_mfma_f32_16x16x32_bf16 v[136:139], a[80:83], a[24:27], v[136:139]
ds_read_b128 a[36:39], v3 offset:32768
v_mfma_f32_16x16x32_bf16 v[136:139], a[84:87], a[28:31], v[136:139]
ds_read_b128 a[40:43], v2 offset:34816
v_add_u32 v6, 0x8000, v6
v_mfma_f32_16x16x32_bf16 v[120:123], a[84:87], a[20:23], v[120:123]
s_add_u32 m0, s76, 4096
ds_read_b128 a[44:47], v3 offset:34816
v_mfma_f32_16x16x32_bf16 v[120:123], a[80:83], a[16:19], v[120:123]
s_add_u32 s64, s73, 512
ds_read_b128 a[48:51], v2 offset:36864
v_mfma_f32_16x16x32_bf16 v[104:107], a[80:83], a[8:11], v[104:107]
buffer_load_dwordx4 v12, s[48:51], s64 offen lds
v_mfma_f32_16x16x32_bf16 v[104:107], a[84:87], a[12:15], v[104:107]
ds_read_b128 a[52:55], v3 offset:36864
v_mfma_f32_16x16x32_bf16 v[88:91], a[84:87], a[4:7], v[88:91]
ds_read_b128 a[56:59], v2 offset:38912
v_mfma_f32_16x16x32_bf16 v[88:91], a[80:83], a[0:3], v[88:91]
s_waitcnt lgkmcnt(7)
s_add_u32 m0, s76, 5120
ds_read_b128 a[60:63], v3 offset:38912
v_mfma_f32_16x16x32_bf16 v[28:31], a[88:91], a[0:3], v[28:31]
s_add_u32 s64, s73, 16896
ds_read_b64_tr_b16 a[72:73], v10 offset:32768
v_mfma_f32_16x16x32_bf16 v[28:31], a[92:95], a[4:7], v[28:31]
buffer_load_dwordx4 v13, s[48:51], s64 offen lds
v_mfma_f32_16x16x32_bf16 v[44:47], a[92:95], a[12:15], v[44:47]
ds_read_b64_tr_b16 a[74:75], v10 offset:33792
v_add_u32 v7, 0x8000, v7
v_mfma_f32_16x16x32_bf16 v[44:47], a[88:91], a[8:11], v[44:47]
ds_read_b64_tr_b16 a[76:77], v10 offset:40960
v_mfma_f32_16x16x32_bf16 v[60:63], a[88:91], a[16:19], v[60:63]
s_add_u32 m0, s76, 6144
ds_read_b64_tr_b16 a[78:79], v10 offset:41984
v_mfma_f32_16x16x32_bf16 v[60:63], a[92:95], a[20:23], v[60:63]
s_add_u32 s64, s73, 131584
ds_read_b64_tr_b16 a[80:81], v11 offset:32768
v_mfma_f32_16x16x32_bf16 v[76:79], a[92:95], a[28:31], v[76:79]
buffer_load_dwordx4 v12, s[48:51], s64 offen lds
v_mfma_f32_16x16x32_bf16 v[76:79], a[88:91], a[24:27], v[76:79]
ds_read_b64_tr_b16 a[82:83], v11 offset:33792
v_mfma_f32_16x16x32_bf16 v[140:143], a[96:99], a[24:27], v[140:143]
ds_read_b64_tr_b16 a[84:85], v11 offset:40960
v_mfma_f32_16x16x32_bf16 v[140:143], a[100:103], a[28:31], v[140:143]
s_add_u32 m0, s76, 7168
ds_read_b64_tr_b16 a[86:87], v11 offset:41984
v_add_u32 v8, 0x8000, v8
v_mfma_f32_16x16x32_bf16 v[124:127], a[100:103], a[20:23], v[124:127]
s_add_u32 s64, s73, 147968
v_mfma_f32_16x16x32_bf16 v[124:127], a[96:99], a[16:19], v[124:127]
buffer_load_dwordx4 v13, s[48:51], s64 offen lds
v_mfma_f32_16x16x32_bf16 v[108:111], a[96:99], a[8:11], v[108:111]
v_mfma_f32_16x16x32_bf16 v[108:111], a[100:103], a[12:15], v[108:111]
v_mfma_f32_16x16x32_bf16 v[92:95], a[100:103], a[4:7], v[92:95]
v_add_u32 v9, 0x8000, v9
v_add_u32 v10, 0x8000, v10
v_mfma_f32_16x16x32_bf16 v[92:95], a[96:99], a[0:3], v[92:95]
v_add_u32 v11, 0x8000, v11
v_mfma_f32_16x16x32_bf16 v[32:35], a[104:107], a[0:3], v[32:35]
s_add_u32 s65, s79, 5120
v_mfma_f32_16x16x32_bf16 v[32:35], a[108:111], a[4:7], v[32:35]
buffer_store_dwordx4 a[160:163], v16, s[44:47], s65 offen sc1
v_mfma_f32_16x16x32_bf16 v[48:51], a[108:111], a[12:15], v[48:51]
s_waitcnt lgkmcnt(0)
s_barrier
v_mfma_f32_16x16x32_bf16 v[48:51], a[104:107], a[8:11], v[48:51]
s_add_u32 m0, s77, 98304
ds_read_b64_tr_b16 a[88:89], v19 offset:36864
v_mfma_f32_16x16x32_bf16 v[64:67], a[104:107], a[16:19], v[64:67]
s_add_u32 s64, s71, 2621440
ds_read_b64_tr_b16 a[90:91], v19 offset:37120
v_mfma_f32_16x16x32_bf16 v[64:67], a[108:111], a[20:23], v[64:67]
buffer_load_dwordx4 v14, s[56:59], s64 offen lds
v_mfma_f32_16x16x32_bf16 v[80:83], a[108:111], a[28:31], v[80:83]
ds_read_b64_tr_b16 a[92:93], v19 offset:38912
v_mfma_f32_16x16x32_bf16 v[80:83], a[104:107], a[24:27], v[80:83]
ds_read_b64_tr_b16 a[94:95], v19 offset:39168
v_mfma_f32_16x16x32_bf16 v[144:147], a[112:115], a[24:27], v[144:147]
ds_read_b64_tr_b16 a[96:97], v20 offset:36864
v_mfma_f32_16x16x32_bf16 v[144:147], a[116:119], a[28:31], v[144:147]
ds_read_b64_tr_b16 a[98:99], v20 offset:37120
v_mfma_f32_16x16x32_bf16 v[128:131], a[116:119], a[20:23], v[128:131]
ds_read_b64_tr_b16 a[100:101], v20 offset:38912
v_mfma_f32_16x16x32_bf16 v[128:131], a[112:115], a[16:19], v[128:131]
ds_read_b64_tr_b16 a[102:103], v20 offset:39168
v_mfma_f32_16x16x32_bf16 v[112:115], a[112:115], a[8:11], v[112:115]
s_add_u32 m0, s78, 114688
ds_read_b64_tr_b16 a[104:105], v19 offset:40960
v_mfma_f32_16x16x32_bf16 v[112:115], a[116:119], a[12:15], v[112:115]
s_add_u32 s64, s75, 1966080
ds_read_b64_tr_b16 a[106:107], v19 offset:41216
v_mfma_f32_16x16x32_bf16 v[96:99], a[116:119], a[4:7], v[96:99]
buffer_load_dwordx4 v23, s[60:63], s64 offen lds
v_mfma_f32_16x16x32_bf16 v[96:99], a[112:115], a[0:3], v[96:99]
ds_read_b64_tr_b16 a[108:109], v19 offset:43008
v_mfma_f32_16x16x32_bf16 v[36:39], a[72:75], a[0:3], v[36:39]
ds_read_b64_tr_b16 a[110:111], v19 offset:43264
v_mfma_f32_16x16x32_bf16 v[36:39], a[76:79], a[4:7], v[36:39]
ds_read_b64_tr_b16 a[112:113], v20 offset:40960
v_mfma_f32_16x16x32_bf16 v[52:55], a[76:79], a[12:15], v[52:55]
ds_read_b64_tr_b16 a[114:115], v20 offset:41216
v_mfma_f32_16x16x32_bf16 v[52:55], a[72:75], a[8:11], v[52:55]
ds_read_b64_tr_b16 a[116:117], v20 offset:43008
v_mfma_f32_16x16x32_bf16 v[68:71], a[72:75], a[16:19], v[68:71]
s_add_u32 m0, s77, 99328
ds_read_b64_tr_b16 a[118:119], v20 offset:43264
v_mfma_f32_16x16x32_bf16 v[68:71], a[76:79], a[20:23], v[68:71]
s_add_u32 s64, s71, 2654208
s_xor_b32 s68, s66, 8192
v_mfma_f32_16x16x32_bf16 v[84:87], a[76:79], a[28:31], v[84:87]
s_mov_b64 exec, 1
buffer_atomic_add a251, v1, s[52:55], s68 offen offset:0 sc1
s_mov_b64 exec, -1
v_mfma_f32_16x16x32_bf16 v[84:87], a[72:75], a[24:27], v[84:87]
buffer_load_dwordx4 v14, s[56:59], s64 offen lds
v_mfma_f32_16x16x32_bf16 v[148:151], a[80:83], a[24:27], v[148:151]
ds_read_b64_tr_b16 a[72:73], v19 offset:32768
v_mfma_f32_16x16x32_bf16 v[148:151], a[84:87], a[28:31], v[148:151]
ds_read_b64_tr_b16 a[74:75], v19 offset:33024
v_mfma_f32_16x16x32_bf16 v[132:135], a[84:87], a[20:23], v[132:135]
ds_read_b64_tr_b16 a[76:77], v19 offset:34816
v_mfma_f32_16x16x32_bf16 v[132:135], a[80:83], a[16:19], v[132:135]
ds_read_b64_tr_b16 a[78:79], v19 offset:35072
v_mfma_f32_16x16x32_bf16 v[116:119], a[80:83], a[8:11], v[116:119]
v_mfma_f32_16x16x32_bf16 v[116:119], a[84:87], a[12:15], v[116:119]
v_mfma_f32_16x16x32_bf16 v[100:103], a[84:87], a[4:7], v[100:103]
s_add_u32 m0, s78, 118784
v_mfma_f32_16x16x32_bf16 v[100:103], a[80:83], a[0:3], v[100:103]
s_waitcnt lgkmcnt(4)
s_add_u32 s64, s75, 1968128
ds_read_b64_tr_b16 a[80:81], v20 offset:32768
v_mfma_f32_16x16x32_bf16 v[184:187], a[88:91], a[32:35], v[184:187]
buffer_load_dwordx4 v23, s[60:63], s64 offen lds
v_mfma_f32_16x16x32_bf16 v[184:187], a[92:95], a[36:39], v[184:187]
ds_read_b64_tr_b16 a[82:83], v20 offset:33024
v_mfma_f32_16x16x32_bf16 v[192:195], a[92:95], a[44:47], v[192:195]
ds_read_b64_tr_b16 a[84:85], v20 offset:34816
v_mfma_f32_16x16x32_bf16 v[192:195], a[88:91], a[40:43], v[192:195]
ds_read_b64_tr_b16 a[86:87], v20 offset:35072
v_mfma_f32_16x16x32_bf16 v[200:203], a[88:91], a[48:51], v[200:203]
v_mfma_f32_16x16x32_bf16 v[200:203], a[92:95], a[52:55], v[200:203]
v_mfma_f32_16x16x32_bf16 v[208:211], a[92:95], a[60:63], v[208:211]
v_mfma_f32_16x16x32_bf16 v[208:211], a[88:91], a[56:59], v[208:211]
ds_read_b64_tr_b16 a[88:89], v4 offset:32768
v_mfma_f32_16x16x32_bf16 v[212:215], a[96:99], a[56:59], v[212:215]
s_add_u32 m0, s77, 100352
ds_read_b64_tr_b16 a[90:91], v4 offset:33792
v_mfma_f32_16x16x32_bf16 v[212:215], a[100:103], a[60:63], v[212:215]
s_add_u32 s64, s71, 2686976
ds_read_b64_tr_b16 a[92:93], v4 offset:40960
v_mfma_f32_16x16x32_bf16 v[204:207], a[100:103], a[52:55], v[204:207]
buffer_load_dwordx4 v15, s[56:59], s64 offen lds
v_mfma_f32_16x16x32_bf16 v[204:207], a[96:99], a[48:51], v[204:207]
ds_read_b64_tr_b16 a[94:95], v4 offset:41984
v_mfma_f32_16x16x32_bf16 v[196:199], a[96:99], a[40:43], v[196:199]
v_mfma_f32_16x16x32_bf16 v[196:199], a[100:103], a[44:47], v[196:199]
v_mfma_f32_16x16x32_bf16 v[188:191], a[100:103], a[36:39], v[188:191]
v_mfma_f32_16x16x32_bf16 v[188:191], a[96:99], a[32:35], v[188:191]
ds_read_b64_tr_b16 a[96:97], v5 offset:32768
v_mfma_f32_16x16x32_bf16 v[216:219], a[32:35], a[104:107], v[216:219]
ds_read_b64_tr_b16 a[98:99], v5 offset:33792
v_mfma_f32_16x16x32_bf16 v[216:219], a[36:39], a[108:111], v[216:219]
s_add_u32 m0, s78, 122880
ds_read_b64_tr_b16 a[100:101], v5 offset:40960
v_mfma_f32_16x16x32_bf16 v[224:227], a[44:47], a[108:111], v[224:227]
s_add_u32 s64, s75, 1970176
ds_read_b64_tr_b16 a[102:103], v5 offset:41984
v_mfma_f32_16x16x32_bf16 v[224:227], a[40:43], a[104:107], v[224:227]
s_add_u32 s65, s79, 1024
buffer_load_dwordx4 v23, s[60:63], s64 offen lds
v_mfma_f32_16x16x32_bf16 v[232:235], a[48:51], a[104:107], v[232:235]
buffer_store_dwordx4 a[164:167], v16, s[44:47], s65 offen sc1
v_mfma_f32_16x16x32_bf16 v[232:235], a[52:55], a[108:111], v[232:235]
v_mfma_f32_16x16x32_bf16 v[240:243], a[60:63], a[108:111], v[240:243]
v_mfma_f32_16x16x32_bf16 v[240:243], a[56:59], a[104:107], v[240:243]
ds_read_b64_tr_b16 a[104:105], v6 offset:32768
v_mfma_f32_16x16x32_bf16 v[244:247], a[56:59], a[112:115], v[244:247]
ds_read_b64_tr_b16 a[106:107], v6 offset:33792
v_mfma_f32_16x16x32_bf16 v[244:247], a[60:63], a[116:119], v[244:247]
ds_read_b64_tr_b16 a[108:109], v6 offset:40960
v_subrev_u32 v19, 0x8000, v19
v_mfma_f32_16x16x32_bf16 v[236:239], a[52:55], a[116:119], v[236:239]
s_add_u32 m0, s77, 101376
ds_read_b64_tr_b16 a[110:111], v6 offset:41984
v_mfma_f32_16x16x32_bf16 v[236:239], a[48:51], a[112:115], v[236:239]
s_add_u32 s64, s71, 2719744
v_mfma_f32_16x16x32_bf16 v[228:231], a[40:43], a[112:115], v[228:231]
buffer_load_dwordx4 v15, s[56:59], s64 offen lds
v_mfma_f32_16x16x32_bf16 v[228:231], a[44:47], a[116:119], v[228:231]
v_mfma_f32_16x16x32_bf16 v[220:223], a[36:39], a[116:119], v[220:223]
v_mfma_f32_16x16x32_bf16 v[220:223], a[32:35], a[112:115], v[220:223]
s_waitcnt lgkmcnt(4)
ds_read_b64_tr_b16 a[112:113], v7 offset:32768
v_mfma_f32_16x16x32_bf16 v[152:155], a[72:75], a[32:35], v[152:155]
ds_read_b64_tr_b16 a[114:115], v7 offset:33792
v_mfma_f32_16x16x32_bf16 v[152:155], a[76:79], a[36:39], v[152:155]
ds_read_b64_tr_b16 a[116:117], v7 offset:40960
v_subrev_u32 v20, 0x8000, v20
v_mfma_f32_16x16x32_bf16 v[160:163], a[76:79], a[44:47], v[160:163]
ds_read_b64_tr_b16 a[118:119], v7 offset:41984
v_mfma_f32_16x16x32_bf16 v[160:163], a[72:75], a[40:43], v[160:163]
v_mfma_f32_16x16x32_bf16 v[168:171], a[72:75], a[48:51], v[168:171]
v_mfma_f32_16x16x32_bf16 v[168:171], a[76:79], a[52:55], v[168:171]
v_mfma_f32_16x16x32_bf16 v[176:179], a[76:79], a[60:63], v[176:179]
s_add_u32 m0, s76, 32768
v_mfma_f32_16x16x32_bf16 v[176:179], a[72:75], a[56:59], v[176:179]
s_add_u32 s64, s72, 640
ds_read_b64_tr_b16 a[72:73], v8 offset:32768
v_mfma_f32_16x16x32_bf16 v[180:183], a[80:83], a[56:59], v[180:183]
buffer_load_dwordx4 v12, s[48:51], s64 offen lds
v_mfma_f32_16x16x32_bf16 v[180:183], a[84:87], a[60:63], v[180:183]
ds_read_b64_tr_b16 a[74:75], v8 offset:33792
v_subrev_u32 v4, 0x8000, v4
v_mfma_f32_16x16x32_bf16 v[172:175], a[84:87], a[52:55], v[172:175]
ds_read_b64_tr_b16 a[76:77], v8 offset:40960
v_mfma_f32_16x16x32_bf16 v[172:175], a[80:83], a[48:51], v[172:175]
s_add_u32 m0, s76, 33792
ds_read_b64_tr_b16 a[78:79], v8 offset:41984
v_mfma_f32_16x16x32_bf16 v[164:167], a[80:83], a[40:43], v[164:167]
s_add_u32 s64, s72, 17024
v_mfma_f32_16x16x32_bf16 v[164:167], a[84:87], a[44:47], v[164:167]
buffer_load_dwordx4 v13, s[48:51], s64 offen lds
v_mfma_f32_16x16x32_bf16 v[156:159], a[84:87], a[36:39], v[156:159]
v_mfma_f32_16x16x32_bf16 v[156:159], a[80:83], a[32:35], v[156:159]
ds_read_b64_tr_b16 a[80:81], v9 offset:32768
v_mfma_f32_16x16x32_bf16 v[24:27], a[88:91], a[32:35], v[24:27]
s_add_u32 m0, s76, 34816
ds_read_b64_tr_b16 a[82:83], v9 offset:33792
v_mfma_f32_16x16x32_bf16 v[24:27], a[92:95], a[36:39], v[24:27]
s_add_u32 s64, s72, 131712
ds_read_b64_tr_b16 a[84:85], v9 offset:40960
v_subrev_u32 v5, 0x8000, v5
v_mfma_f32_16x16x32_bf16 v[40:43], a[92:95], a[44:47], v[40:43]
buffer_load_dwordx4 v12, s[48:51], s64 offen lds
v_mfma_f32_16x16x32_bf16 v[40:43], a[88:91], a[40:43], v[40:43]
ds_read_b64_tr_b16 a[86:87], v9 offset:41984
v_mfma_f32_16x16x32_bf16 v[56:59], a[88:91], a[48:51], v[56:59]
v_mfma_f32_16x16x32_bf16 v[56:59], a[92:95], a[52:55], v[56:59]
s_add_u32 m0, s76, 35840
v_mfma_f32_16x16x32_bf16 v[72:75], a[92:95], a[60:63], v[72:75]
s_waitcnt vmcnt(13)
s_add_u32 s64, s72, 148096
ds_read_b128 a[0:3], v2 offset:0
v_mfma_f32_16x16x32_bf16 v[72:75], a[88:91], a[56:59], v[72:75]
buffer_load_dwordx4 v13, s[48:51], s64 offen lds
v_mfma_f32_16x16x32_bf16 v[136:139], a[96:99], a[56:59], v[136:139]
ds_read_b128 a[4:7], v3 offset:0
v_mfma_f32_16x16x32_bf16 v[136:139], a[100:103], a[60:63], v[136:139]
ds_read_b128 a[8:11], v2 offset:2048
v_subrev_u32 v6, 0x8000, v6
v_mfma_f32_16x16x32_bf16 v[120:123], a[100:103], a[52:55], v[120:123]
s_add_u32 m0, s76, 36864
ds_read_b128 a[12:15], v3 offset:2048
v_mfma_f32_16x16x32_bf16 v[120:123], a[96:99], a[48:51], v[120:123]
s_add_u32 s64, s73, 640
ds_read_b128 a[16:19], v2 offset:4096
v_mfma_f32_16x16x32_bf16 v[104:107], a[96:99], a[40:43], v[104:107]
buffer_load_dwordx4 v12, s[48:51], s64 offen lds
v_mfma_f32_16x16x32_bf16 v[104:107], a[100:103], a[44:47], v[104:107]
ds_read_b128 a[20:23], v3 offset:4096
v_mfma_f32_16x16x32_bf16 v[88:91], a[100:103], a[36:39], v[88:91]
ds_read_b128 a[24:27], v2 offset:6144
v_mfma_f32_16x16x32_bf16 v[88:91], a[96:99], a[32:35], v[88:91]
s_waitcnt lgkmcnt(7)
s_add_u32 m0, s76, 37888
ds_read_b128 a[28:31], v3 offset:6144
v_mfma_f32_16x16x32_bf16 v[28:31], a[104:107], a[32:35], v[28:31]
s_add_u32 s64, s73, 17024
ds_read_b64_tr_b16 a[88:89], v10 offset:32768
v_mfma_f32_16x16x32_bf16 v[28:31], a[108:111], a[36:39], v[28:31]
buffer_load_dwordx4 v13, s[48:51], s64 offen lds
v_mfma_f32_16x16x32_bf16 v[44:47], a[108:111], a[44:47], v[44:47]
ds_read_b64_tr_b16 a[90:91], v10 offset:33792
v_subrev_u32 v7, 0x8000, v7
v_mfma_f32_16x16x32_bf16 v[44:47], a[104:107], a[40:43], v[44:47]
s_add_u32 s65, s79, 18432
ds_read_b64_tr_b16 a[92:93], v10 offset:40960
v_mfma_f32_16x16x32_bf16 v[60:63], a[104:107], a[48:51], v[60:63]
s_add_u32 m0, s76, 38912
buffer_store_dwordx4 a[168:171], v16, s[44:47], s65 offen sc1
v_mfma_f32_16x16x32_bf16 v[60:63], a[108:111], a[52:55], v[60:63]
s_add_u32 s64, s73, 131712
ds_read_b64_tr_b16 a[94:95], v10 offset:41984
v_mfma_f32_16x16x32_bf16 v[76:79], a[108:111], a[60:63], v[76:79]
buffer_load_dwordx4 v12, s[48:51], s64 offen lds
v_mfma_f32_16x16x32_bf16 v[76:79], a[104:107], a[56:59], v[76:79]
ds_read_b64_tr_b16 a[96:97], v11 offset:32768
v_mfma_f32_16x16x32_bf16 v[140:143], a[112:115], a[56:59], v[140:143]
ds_read_b64_tr_b16 a[98:99], v11 offset:33792
v_mfma_f32_16x16x32_bf16 v[140:143], a[116:119], a[60:63], v[140:143]
s_add_u32 m0, s76, 39936
ds_read_b64_tr_b16 a[100:101], v11 offset:40960
v_subrev_u32 v8, 0x8000, v8
v_mfma_f32_16x16x32_bf16 v[124:127], a[116:119], a[52:55], v[124:127]
s_add_u32 s64, s73, 148096
ds_read_b64_tr_b16 a[102:103], v11 offset:41984
v_mfma_f32_16x16x32_bf16 v[124:127], a[112:115], a[48:51], v[124:127]
buffer_load_dwordx4 v13, s[48:51], s64 offen lds
v_mfma_f32_16x16x32_bf16 v[108:111], a[112:115], a[40:43], v[108:111]
v_mfma_f32_16x16x32_bf16 v[108:111], a[116:119], a[44:47], v[108:111]
v_mfma_f32_16x16x32_bf16 v[92:95], a[116:119], a[36:39], v[92:95]
v_subrev_u32 v9, 0x8000, v9
v_subrev_u32 v10, 0x8000, v10
v_mfma_f32_16x16x32_bf16 v[92:95], a[112:115], a[32:35], v[92:95]
v_subrev_u32 v11, 0x8000, v11
v_mfma_f32_16x16x32_bf16 v[32:35], a[72:75], a[32:35], v[32:35]
v_mfma_f32_16x16x32_bf16 v[32:35], a[76:79], a[36:39], v[32:35]
v_mfma_f32_16x16x32_bf16 v[48:51], a[76:79], a[44:47], v[48:51]
s_waitcnt lgkmcnt(0)
s_barrier
v_mfma_f32_16x16x32_bf16 v[48:51], a[72:75], a[40:43], v[48:51]
s_add_u32 m0, s77, 131072
ds_read_b64_tr_b16 a[104:105], v19 offset:4096
v_mfma_f32_16x16x32_bf16 v[64:67], a[72:75], a[48:51], v[64:67]
s_add_u32 s64, s71, 3145728
ds_read_b64_tr_b16 a[106:107], v19 offset:4352
v_mfma_f32_16x16x32_bf16 v[64:67], a[76:79], a[52:55], v[64:67]
buffer_load_dwordx4 v14, s[56:59], s64 offen lds
v_mfma_f32_16x16x32_bf16 v[80:83], a[76:79], a[60:63], v[80:83]
ds_read_b64_tr_b16 a[108:109], v19 offset:6144
v_mfma_f32_16x16x32_bf16 v[80:83], a[72:75], a[56:59], v[80:83]
ds_read_b64_tr_b16 a[110:111], v19 offset:6400
v_mfma_f32_16x16x32_bf16 v[144:147], a[80:83], a[56:59], v[144:147]
ds_read_b64_tr_b16 a[112:113], v20 offset:4096
v_mfma_f32_16x16x32_bf16 v[144:147], a[84:87], a[60:63], v[144:147]
ds_read_b64_tr_b16 a[114:115], v20 offset:4352
v_mfma_f32_16x16x32_bf16 v[128:131], a[84:87], a[52:55], v[128:131]
ds_read_b64_tr_b16 a[116:117], v20 offset:6144
v_mfma_f32_16x16x32_bf16 v[128:131], a[80:83], a[48:51], v[128:131]
ds_read_b64_tr_b16 a[118:119], v20 offset:6400
v_mfma_f32_16x16x32_bf16 v[112:115], a[80:83], a[40:43], v[112:115]
s_add_u32 m0, s78, 147456
ds_read_b64_tr_b16 a[72:73], v19 offset:8192
v_mfma_f32_16x16x32_bf16 v[112:115], a[84:87], a[44:47], v[112:115]
s_add_u32 s64, s75, 2359296
ds_read_b64_tr_b16 a[74:75], v19 offset:8448
v_mfma_f32_16x16x32_bf16 v[96:99], a[84:87], a[36:39], v[96:99]
buffer_load_dwordx4 v23, s[60:63], s64 offen lds
v_mfma_f32_16x16x32_bf16 v[96:99], a[80:83], a[32:35], v[96:99]
ds_read_b64_tr_b16 a[76:77], v19 offset:10240
v_mfma_f32_16x16x32_bf16 v[36:39], a[88:91], a[32:35], v[36:39]
ds_read_b64_tr_b16 a[78:79], v19 offset:10496
v_mfma_f32_16x16x32_bf16 v[36:39], a[92:95], a[36:39], v[36:39]
ds_read_b64_tr_b16 a[80:81], v20 offset:8192
v_mfma_f32_16x16x32_bf16 v[52:55], a[92:95], a[44:47], v[52:55]
ds_read_b64_tr_b16 a[82:83], v20 offset:8448
v_mfma_f32_16x16x32_bf16 v[52:55], a[88:91], a[40:43], v[52:55]
ds_read_b64_tr_b16 a[84:85], v20 offset:10240
v_mfma_f32_16x16x32_bf16 v[68:71], a[88:91], a[48:51], v[68:71]
s_add_u32 m0, s77, 132096
ds_read_b64_tr_b16 a[86:87], v20 offset:10496
v_mfma_f32_16x16x32_bf16 v[68:71], a[92:95], a[52:55], v[68:71]
s_add_u32 s64, s71, 3178496
s_xor_b32 s68, s66, 12288
v_mfma_f32_16x16x32_bf16 v[84:87], a[92:95], a[60:63], v[84:87]
s_mov_b64 exec, 1
buffer_atomic_add a251, v1, s[52:55], s68 offen offset:0 sc1
s_mov_b64 exec, -1
v_mfma_f32_16x16x32_bf16 v[84:87], a[88:91], a[56:59], v[84:87]
buffer_load_dwordx4 v14, s[56:59], s64 offen lds
v_mfma_f32_16x16x32_bf16 v[148:151], a[96:99], a[56:59], v[148:151]
ds_read_b64_tr_b16 a[88:89], v19 offset:0
v_mfma_f32_16x16x32_bf16 v[148:151], a[100:103], a[60:63], v[148:151]
ds_read_b64_tr_b16 a[90:91], v19 offset:256
v_mfma_f32_16x16x32_bf16 v[132:135], a[100:103], a[52:55], v[132:135]
ds_read_b64_tr_b16 a[92:93], v19 offset:2048
v_mfma_f32_16x16x32_bf16 v[132:135], a[96:99], a[48:51], v[132:135]
ds_read_b64_tr_b16 a[94:95], v19 offset:2304
v_mfma_f32_16x16x32_bf16 v[116:119], a[96:99], a[40:43], v[116:119]
v_mfma_f32_16x16x32_bf16 v[116:119], a[100:103], a[44:47], v[116:119]
v_mfma_f32_16x16x32_bf16 v[100:103], a[100:103], a[36:39], v[100:103]
s_add_u32 m0, s78, 151552
v_mfma_f32_16x16x32_bf16 v[100:103], a[96:99], a[32:35], v[100:103]
s_waitcnt lgkmcnt(4)
s_add_u32 s64, s75, 2361344
ds_read_b64_tr_b16 a[96:97], v20 offset:0
v_mfma_f32_16x16x32_bf16 v[184:187], a[104:107], a[0:3], v[184:187]
s_mov_b32 s36, s20
buffer_load_dwordx4 v23, s[60:63], s64 offen lds
v_mfma_f32_16x16x32_bf16 v[184:187], a[108:111], a[4:7], v[184:187]
s_mov_b32 s37, s21
ds_read_b64_tr_b16 a[98:99], v20 offset:256
v_mfma_f32_16x16x32_bf16 v[192:195], a[108:111], a[12:15], v[192:195]
s_mov_b32 s38, 2097152
s_add_u32 s17, s78, .-L_pc+6144
ds_read_b64_tr_b16 a[100:101], v20 offset:2048
v_mfma_f32_16x16x32_bf16 v[192:195], a[104:107], a[8:11], v[192:195]
s_mov_b32 s40, s14
s_add_u32 s65, s79, 6144
ds_read_b64_tr_b16 a[102:103], v20 offset:2304
v_mfma_f32_16x16x32_bf16 v[200:203], a[104:107], a[16:19], v[200:203]
s_mov_b32 s41, s15
buffer_load_dword a252, v16, s[88:91], s17 offen
v_mfma_f32_16x16x32_bf16 v[200:203], a[108:111], a[20:23], v[200:203]
s_mov_b32 s42, 8388608
buffer_store_dwordx4 a[172:175], v16, s[44:47], s65 offen sc1
v_mfma_f32_16x16x32_bf16 v[208:211], a[108:111], a[28:31], v[208:211]
v_mfma_f32_16x16x32_bf16 v[208:211], a[104:107], a[24:27], v[208:211]
ds_read_b64_tr_b16 a[104:105], v4 offset:0
v_mfma_f32_16x16x32_bf16 v[212:215], a[112:115], a[24:27], v[212:215]
s_add_u32 m0, s77, 133120
ds_read_b64_tr_b16 a[106:107], v4 offset:1024
v_mfma_f32_16x16x32_bf16 v[212:215], a[116:119], a[28:31], v[212:215]
s_add_u32 s64, s71, 3211264
ds_read_b64_tr_b16 a[108:109], v4 offset:8192
v_mfma_f32_16x16x32_bf16 v[204:207], a[116:119], a[20:23], v[204:207]
buffer_load_dwordx4 v15, s[56:59], s64 offen lds
v_mfma_f32_16x16x32_bf16 v[204:207], a[112:115], a[16:19], v[204:207]
ds_read_b64_tr_b16 a[110:111], v4 offset:9216
v_mfma_f32_16x16x32_bf16 v[196:199], a[112:115], a[8:11], v[196:199]
v_mfma_f32_16x16x32_bf16 v[196:199], a[116:119], a[12:15], v[196:199]
v_mfma_f32_16x16x32_bf16 v[188:191], a[116:119], a[4:7], v[188:191]
v_mfma_f32_16x16x32_bf16 v[188:191], a[112:115], a[0:3], v[188:191]
ds_read_b64_tr_b16 a[112:113], v5 offset:0
v_mfma_f32_16x16x32_bf16 v[216:219], a[0:3], a[72:75], v[216:219]
ds_read_b64_tr_b16 a[114:115], v5 offset:1024
v_mfma_f32_16x16x32_bf16 v[216:219], a[4:7], a[76:79], v[216:219]
s_add_u32 m0, s78, 155648
ds_read_b64_tr_b16 a[116:117], v5 offset:8192
v_mfma_f32_16x16x32_bf16 v[224:227], a[12:15], a[76:79], v[224:227]
s_add_u32 s64, s75, 2363392
ds_read_b64_tr_b16 a[118:119], v5 offset:9216
v_mfma_f32_16x16x32_bf16 v[224:227], a[8:11], a[72:75], v[224:227]
buffer_load_dwordx4 v23, s[60:63], s64 offen lds
v_mfma_f32_16x16x32_bf16 v[232:235], a[16:19], a[72:75], v[232:235]
v_mfma_f32_16x16x32_bf16 v[232:235], a[20:23], a[76:79], v[232:235]
v_mfma_f32_16x16x32_bf16 v[240:243], a[28:31], a[76:79], v[240:243]
v_mfma_f32_16x16x32_bf16 v[240:243], a[24:27], a[72:75], v[240:243]
ds_read_b64_tr_b16 a[72:73], v6 offset:0
v_mfma_f32_16x16x32_bf16 v[244:247], a[24:27], a[80:83], v[244:247]
ds_read_b64_tr_b16 a[74:75], v6 offset:1024
v_mfma_f32_16x16x32_bf16 v[244:247], a[28:31], a[84:87], v[244:247]
ds_read_b64_tr_b16 a[76:77], v6 offset:8192
v_mfma_f32_16x16x32_bf16 v[236:239], a[20:23], a[84:87], v[236:239]
s_add_u32 m0, s77, 134144
ds_read_b64_tr_b16 a[78:79], v6 offset:9216
v_mfma_f32_16x16x32_bf16 v[236:239], a[16:19], a[80:83], v[236:239]
s_add_u32 s64, s71, 3244032
v_mfma_f32_16x16x32_bf16 v[228:231], a[8:11], a[80:83], v[228:231]
buffer_load_dwordx4 v15, s[56:59], s64 offen lds
v_mfma_f32_16x16x32_bf16 v[228:231], a[12:15], a[84:87], v[228:231]
v_mfma_f32_16x16x32_bf16 v[220:223], a[4:7], a[84:87], v[220:223]
v_mfma_f32_16x16x32_bf16 v[220:223], a[0:3], a[80:83], v[220:223]
s_waitcnt lgkmcnt(4)
ds_read_b64_tr_b16 a[80:81], v7 offset:0
v_mfma_f32_16x16x32_bf16 v[152:155], a[88:91], a[0:3], v[152:155]
ds_read_b64_tr_b16 a[82:83], v7 offset:1024
v_mfma_f32_16x16x32_bf16 v[152:155], a[92:95], a[4:7], v[152:155]
ds_read_b64_tr_b16 a[84:85], v7 offset:8192
v_mfma_f32_16x16x32_bf16 v[160:163], a[92:95], a[12:15], v[160:163]
ds_read_b64_tr_b16 a[86:87], v7 offset:9216
v_mfma_f32_16x16x32_bf16 v[160:163], a[88:91], a[8:11], v[160:163]
v_mfma_f32_16x16x32_bf16 v[168:171], a[88:91], a[16:19], v[168:171]
v_mfma_f32_16x16x32_bf16 v[168:171], a[92:95], a[20:23], v[168:171]
v_mfma_f32_16x16x32_bf16 v[176:179], a[92:95], a[28:31], v[176:179]
s_add_u32 m0, s76, 0
v_mfma_f32_16x16x32_bf16 v[176:179], a[88:91], a[24:27], v[176:179]
s_add_u32 s64, s72, 768
ds_read_b64_tr_b16 a[88:89], v8 offset:0
v_mfma_f32_16x16x32_bf16 v[180:183], a[96:99], a[24:27], v[180:183]
buffer_load_dwordx4 v12, s[48:51], s64 offen lds
v_mfma_f32_16x16x32_bf16 v[180:183], a[100:103], a[28:31], v[180:183]
ds_read_b64_tr_b16 a[90:91], v8 offset:1024
v_mfma_f32_16x16x32_bf16 v[172:175], a[100:103], a[20:23], v[172:175]
ds_read_b64_tr_b16 a[92:93], v8 offset:8192
v_mfma_f32_16x16x32_bf16 v[172:175], a[96:99], a[16:19], v[172:175]
s_add_u32 m0, s76, 1024
ds_read_b64_tr_b16 a[94:95], v8 offset:9216
v_mfma_f32_16x16x32_bf16 v[164:167], a[96:99], a[8:11], v[164:167]
s_add_u32 s64, s72, 17152
v_mfma_f32_16x16x32_bf16 v[164:167], a[100:103], a[12:15], v[164:167]
buffer_load_dwordx4 v13, s[48:51], s64 offen lds
v_mfma_f32_16x16x32_bf16 v[156:159], a[100:103], a[4:7], v[156:159]
v_mfma_f32_16x16x32_bf16 v[156:159], a[96:99], a[0:3], v[156:159]
ds_read_b64_tr_b16 a[96:97], v9 offset:0
v_mfma_f32_16x16x32_bf16 v[24:27], a[104:107], a[0:3], v[24:27]
s_add_u32 m0, s76, 2048
ds_read_b64_tr_b16 a[98:99], v9 offset:1024
v_mfma_f32_16x16x32_bf16 v[24:27], a[108:111], a[4:7], v[24:27]
s_add_u32 s64, s72, 131840
ds_read_b64_tr_b16 a[100:101], v9 offset:8192
v_mfma_f32_16x16x32_bf16 v[40:43], a[108:111], a[12:15], v[40:43]
buffer_load_dwordx4 v12, s[48:51], s64 offen lds
v_mfma_f32_16x16x32_bf16 v[40:43], a[104:107], a[8:11], v[40:43]
ds_read_b64_tr_b16 a[102:103], v9 offset:9216
v_mfma_f32_16x16x32_bf16 v[56:59], a[104:107], a[16:19], v[56:59]
v_mfma_f32_16x16x32_bf16 v[56:59], a[108:111], a[20:23], v[56:59]
s_add_u32 m0, s76, 3072
v_mfma_f32_16x16x32_bf16 v[72:75], a[108:111], a[28:31], v[72:75]
s_waitcnt vmcnt(13)
s_add_u32 s64, s72, 148224
ds_read_b128 a[32:35], v2 offset:32768
v_mfma_f32_16x16x32_bf16 v[72:75], a[104:107], a[24:27], v[72:75]
s_add_u32 s65, s79, 2048
buffer_load_dwordx4 v13, s[48:51], s64 offen lds
v_mfma_f32_16x16x32_bf16 v[136:139], a[112:115], a[24:27], v[136:139]
buffer_store_dwordx4 a[176:179], v16, s[44:47], s65 offen sc1
v_mfma_f32_16x16x32_bf16 v[136:139], a[116:119], a[28:31], v[136:139]
ds_read_b128 a[36:39], v3 offset:32768
v_mfma_f32_16x16x32_bf16 v[120:123], a[116:119], a[20:23], v[120:123]
s_add_u32 m0, s76, 4096
ds_read_b128 a[40:43], v2 offset:34816
v_mfma_f32_16x16x32_bf16 v[120:123], a[112:115], a[16:19], v[120:123]
s_add_u32 s64, s73, 768
ds_read_b128 a[44:47], v3 offset:34816
v_mfma_f32_16x16x32_bf16 v[104:107], a[112:115], a[8:11], v[104:107]
buffer_load_dwordx4 v12, s[48:51], s64 offen lds
v_mfma_f32_16x16x32_bf16 v[104:107], a[116:119], a[12:15], v[104:107]
ds_read_b128 a[48:51], v2 offset:36864
v_mfma_f32_16x16x32_bf16 v[88:91], a[116:119], a[4:7], v[88:91]
ds_read_b128 a[52:55], v3 offset:36864
v_mfma_f32_16x16x32_bf16 v[88:91], a[112:115], a[0:3], v[88:91]
s_waitcnt lgkmcnt(6)
s_add_u32 m0, s76, 5120
ds_read_b128 a[56:59], v2 offset:38912
v_mfma_f32_16x16x32_bf16 v[28:31], a[72:75], a[0:3], v[28:31]
s_add_u32 s64, s73, 17152
ds_read_b128 a[60:63], v3 offset:38912
v_mfma_f32_16x16x32_bf16 v[28:31], a[76:79], a[4:7], v[28:31]
buffer_load_dwordx4 v13, s[48:51], s64 offen lds
v_mfma_f32_16x16x32_bf16 v[44:47], a[76:79], a[12:15], v[44:47]
ds_read_b64_tr_b16 a[104:105], v10 offset:0
v_mfma_f32_16x16x32_bf16 v[44:47], a[72:75], a[8:11], v[44:47]
ds_read_b64_tr_b16 a[106:107], v10 offset:1024
v_mfma_f32_16x16x32_bf16 v[60:63], a[72:75], a[16:19], v[60:63]
s_add_u32 m0, s76, 6144
ds_read_b64_tr_b16 a[108:109], v10 offset:8192
v_mfma_f32_16x16x32_bf16 v[60:63], a[76:79], a[20:23], v[60:63]
s_add_u32 s64, s73, 131840
ds_read_b64_tr_b16 a[110:111], v10 offset:9216
v_mfma_f32_16x16x32_bf16 v[76:79], a[76:79], a[28:31], v[76:79]
buffer_load_dwordx4 v12, s[48:51], s64 offen lds
v_mfma_f32_16x16x32_bf16 v[76:79], a[72:75], a[24:27], v[76:79]
ds_read_b64_tr_b16 a[112:113], v11 offset:0
v_mfma_f32_16x16x32_bf16 v[140:143], a[80:83], a[24:27], v[140:143]
ds_read_b64_tr_b16 a[114:115], v11 offset:1024
v_mfma_f32_16x16x32_bf16 v[140:143], a[84:87], a[28:31], v[140:143]
s_add_u32 m0, s76, 7168
ds_read_b64_tr_b16 a[116:117], v11 offset:8192
v_mfma_f32_16x16x32_bf16 v[124:127], a[84:87], a[20:23], v[124:127]
s_add_u32 s64, s73, 148224
ds_read_b64_tr_b16 a[118:119], v11 offset:9216
v_mfma_f32_16x16x32_bf16 v[124:127], a[80:83], a[16:19], v[124:127]
buffer_load_dwordx4 v13, s[48:51], s64 offen lds
v_mfma_f32_16x16x32_bf16 v[108:111], a[80:83], a[8:11], v[108:111]
v_mfma_f32_16x16x32_bf16 v[108:111], a[84:87], a[12:15], v[108:111]
v_mfma_f32_16x16x32_bf16 v[92:95], a[84:87], a[4:7], v[92:95]
v_mfma_f32_16x16x32_bf16 v[92:95], a[80:83], a[0:3], v[92:95]
v_mfma_f32_16x16x32_bf16 v[32:35], a[88:91], a[0:3], v[32:35]
v_mfma_f32_16x16x32_bf16 v[32:35], a[92:95], a[4:7], v[32:35]
v_mfma_f32_16x16x32_bf16 v[48:51], a[92:95], a[12:15], v[48:51]
s_waitcnt lgkmcnt(0)
s_barrier
v_mfma_f32_16x16x32_bf16 v[48:51], a[88:91], a[8:11], v[48:51]
s_add_u32 m0, s77, 65536
ds_read_b64_tr_b16 a[72:73], v19 offset:36864
v_mfma_f32_16x16x32_bf16 v[64:67], a[88:91], a[16:19], v[64:67]
s_add_u32 s64, s71, 3670016
ds_read_b64_tr_b16 a[74:75], v19 offset:37120
v_mfma_f32_16x16x32_bf16 v[64:67], a[92:95], a[20:23], v[64:67]
buffer_load_dwordx4 v14, s[56:59], s64 offen lds
v_mfma_f32_16x16x32_bf16 v[80:83], a[92:95], a[28:31], v[80:83]
ds_read_b64_tr_b16 a[76:77], v19 offset:38912
v_mfma_f32_16x16x32_bf16 v[80:83], a[88:91], a[24:27], v[80:83]
ds_read_b64_tr_b16 a[78:79], v19 offset:39168
v_mfma_f32_16x16x32_bf16 v[144:147], a[96:99], a[24:27], v[144:147]
ds_read_b64_tr_b16 a[80:81], v20 offset:36864
v_mfma_f32_16x16x32_bf16 v[144:147], a[100:103], a[28:31], v[144:147]
ds_read_b64_tr_b16 a[82:83], v20 offset:37120
v_mfma_f32_16x16x32_bf16 v[128:131], a[100:103], a[20:23], v[128:131]
ds_read_b64_tr_b16 a[84:85], v20 offset:38912
v_mfma_f32_16x16x32_bf16 v[128:131], a[96:99], a[16:19], v[128:131]
ds_read_b64_tr_b16 a[86:87], v20 offset:39168
v_mfma_f32_16x16x32_bf16 v[112:115], a[96:99], a[8:11], v[112:115]
s_add_u32 m0, s78, 81920
ds_read_b64_tr_b16 a[88:89], v19 offset:40960
v_mfma_f32_16x16x32_bf16 v[112:115], a[100:103], a[12:15], v[112:115]
s_add_u32 s64, s75, 2752512
ds_read_b64_tr_b16 a[90:91], v19 offset:41216
v_mfma_f32_16x16x32_bf16 v[96:99], a[100:103], a[4:7], v[96:99]
buffer_load_dwordx4 v23, s[60:63], s64 offen lds
v_mfma_f32_16x16x32_bf16 v[96:99], a[96:99], a[0:3], v[96:99]
ds_read_b64_tr_b16 a[92:93], v19 offset:43008
v_mfma_f32_16x16x32_bf16 v[36:39], a[104:107], a[0:3], v[36:39]
ds_read_b64_tr_b16 a[94:95], v19 offset:43264
v_mfma_f32_16x16x32_bf16 v[36:39], a[108:111], a[4:7], v[36:39]
ds_read_b64_tr_b16 a[96:97], v20 offset:40960
v_mfma_f32_16x16x32_bf16 v[52:55], a[108:111], a[12:15], v[52:55]
ds_read_b64_tr_b16 a[98:99], v20 offset:41216
v_mfma_f32_16x16x32_bf16 v[52:55], a[104:107], a[8:11], v[52:55]
ds_read_b64_tr_b16 a[100:101], v20 offset:43008
v_mfma_f32_16x16x32_bf16 v[68:71], a[104:107], a[16:19], v[68:71]
ds_read_b64_tr_b16 a[102:103], v20 offset:43264
v_mfma_f32_16x16x32_bf16 v[68:71], a[108:111], a[20:23], v[68:71]
s_add_u32 m0, s77, 66560
v_mfma_f32_16x16x32_bf16 v[84:87], a[108:111], a[28:31], v[84:87]
s_add_u32 s64, s71, 3702784
v_mfma_f32_16x16x32_bf16 v[84:87], a[104:107], a[24:27], v[84:87]
s_add_u32 s65, s79, 19456
buffer_load_dwordx4 v14, s[56:59], s64 offen lds
v_mfma_f32_16x16x32_bf16 v[148:151], a[112:115], a[24:27], v[148:151]
buffer_store_dwordx4 a[180:183], v16, s[44:47], s65 offen sc1
v_mfma_f32_16x16x32_bf16 v[148:151], a[116:119], a[28:31], v[148:151]
ds_read_b64_tr_b16 a[104:105], v19 offset:32768
v_mfma_f32_16x16x32_bf16 v[132:135], a[116:119], a[20:23], v[132:135]
ds_read_b64_tr_b16 a[106:107], v19 offset:33024
v_mfma_f32_16x16x32_bf16 v[132:135], a[112:115], a[16:19], v[132:135]
ds_read_b64_tr_b16 a[108:109], v19 offset:34816
v_mfma_f32_16x16x32_bf16 v[116:119], a[112:115], a[8:11], v[116:119]
ds_read_b64_tr_b16 a[110:111], v19 offset:35072
v_mfma_f32_16x16x32_bf16 v[116:119], a[116:119], a[12:15], v[116:119]
v_mfma_f32_16x16x32_bf16 v[100:103], a[116:119], a[4:7], v[100:103]
s_add_u32 m0, s78, 86016
v_mfma_f32_16x16x32_bf16 v[100:103], a[112:115], a[0:3], v[100:103]
s_waitcnt lgkmcnt(4)
s_add_u32 s64, s75, 2754560
ds_read_b64_tr_b16 a[112:113], v20 offset:32768
v_mfma_f32_16x16x32_bf16 v[184:187], a[72:75], a[32:35], v[184:187]
buffer_load_dwordx4 v23, s[60:63], s64 offen lds
v_mfma_f32_16x16x32_bf16 v[184:187], a[76:79], a[36:39], v[184:187]
ds_read_b64_tr_b16 a[114:115], v20 offset:33024
v_mfma_f32_16x16x32_bf16 v[192:195], a[76:79], a[44:47], v[192:195]
ds_read_b64_tr_b16 a[116:117], v20 offset:34816
v_mfma_f32_16x16x32_bf16 v[192:195], a[72:75], a[40:43], v[192:195]
ds_read_b64_tr_b16 a[118:119], v20 offset:35072
v_mfma_f32_16x16x32_bf16 v[200:203], a[72:75], a[48:51], v[200:203]
v_mfma_f32_16x16x32_bf16 v[200:203], a[76:79], a[52:55], v[200:203]
v_mfma_f32_16x16x32_bf16 v[208:211], a[76:79], a[60:63], v[208:211]
v_mfma_f32_16x16x32_bf16 v[208:211], a[72:75], a[56:59], v[208:211]
ds_read_b64_tr_b16 a[72:73], v4 offset:32768
v_mfma_f32_16x16x32_bf16 v[212:215], a[80:83], a[56:59], v[212:215]
s_add_u32 m0, s77, 67584
ds_read_b64_tr_b16 a[74:75], v4 offset:33792
v_mfma_f32_16x16x32_bf16 v[212:215], a[84:87], a[60:63], v[212:215]
s_add_u32 s64, s71, 3735552
ds_read_b64_tr_b16 a[76:77], v4 offset:40960
v_mfma_f32_16x16x32_bf16 v[204:207], a[84:87], a[52:55], v[204:207]
buffer_load_dwordx4 v15, s[56:59], s64 offen lds
v_mfma_f32_16x16x32_bf16 v[204:207], a[80:83], a[48:51], v[204:207]
ds_read_b64_tr_b16 a[78:79], v4 offset:41984
v_mfma_f32_16x16x32_bf16 v[196:199], a[80:83], a[40:43], v[196:199]
v_mfma_f32_16x16x32_bf16 v[196:199], a[84:87], a[44:47], v[196:199]
v_mfma_f32_16x16x32_bf16 v[188:191], a[84:87], a[36:39], v[188:191]
v_mfma_f32_16x16x32_bf16 v[188:191], a[80:83], a[32:35], v[188:191]
ds_read_b64_tr_b16 a[80:81], v5 offset:32768
v_mfma_f32_16x16x32_bf16 v[216:219], a[32:35], a[88:91], v[216:219]
ds_read_b64_tr_b16 a[82:83], v5 offset:33792
v_mfma_f32_16x16x32_bf16 v[216:219], a[36:39], a[92:95], v[216:219]
s_add_u32 m0, s78, 90112
ds_read_b64_tr_b16 a[84:85], v5 offset:40960
v_mfma_f32_16x16x32_bf16 v[224:227], a[44:47], a[92:95], v[224:227]
s_add_u32 s64, s75, 2756608
ds_read_b64_tr_b16 a[86:87], v5 offset:41984
v_mfma_f32_16x16x32_bf16 v[224:227], a[40:43], a[88:91], v[224:227]
buffer_load_dwordx4 v23, s[60:63], s64 offen lds
v_mfma_f32_16x16x32_bf16 v[232:235], a[48:51], a[88:91], v[232:235]
v_mfma_f32_16x16x32_bf16 v[232:235], a[52:55], a[92:95], v[232:235]
v_mfma_f32_16x16x32_bf16 v[240:243], a[60:63], a[92:95], v[240:243]
v_mfma_f32_16x16x32_bf16 v[240:243], a[56:59], a[88:91], v[240:243]
ds_read_b64_tr_b16 a[88:89], v6 offset:32768
v_mfma_f32_16x16x32_bf16 v[244:247], a[56:59], a[96:99], v[244:247]
ds_read_b64_tr_b16 a[90:91], v6 offset:33792
v_mfma_f32_16x16x32_bf16 v[244:247], a[60:63], a[100:103], v[244:247]
ds_read_b64_tr_b16 a[92:93], v6 offset:40960
v_add_u32 v19, 0x8000, v19
v_mfma_f32_16x16x32_bf16 v[236:239], a[52:55], a[100:103], v[236:239]
s_add_u32 m0, s77, 68608
ds_read_b64_tr_b16 a[94:95], v6 offset:41984
v_mfma_f32_16x16x32_bf16 v[236:239], a[48:51], a[96:99], v[236:239]
s_add_u32 s64, s71, 3768320
v_mfma_f32_16x16x32_bf16 v[228:231], a[40:43], a[96:99], v[228:231]
buffer_load_dwordx4 v15, s[56:59], s64 offen lds
v_mfma_f32_16x16x32_bf16 v[228:231], a[44:47], a[100:103], v[228:231]
v_mfma_f32_16x16x32_bf16 v[220:223], a[36:39], a[100:103], v[220:223]
v_mfma_f32_16x16x32_bf16 v[220:223], a[32:35], a[96:99], v[220:223]
s_waitcnt lgkmcnt(4)
ds_read_b64_tr_b16 a[96:97], v7 offset:32768
v_mfma_f32_16x16x32_bf16 v[152:155], a[104:107], a[32:35], v[152:155]
ds_read_b64_tr_b16 a[98:99], v7 offset:33792
v_mfma_f32_16x16x32_bf16 v[152:155], a[108:111], a[36:39], v[152:155]
ds_read_b64_tr_b16 a[100:101], v7 offset:40960
v_add_u32 v20, 0x8000, v20
v_mfma_f32_16x16x32_bf16 v[160:163], a[108:111], a[44:47], v[160:163]
ds_read_b64_tr_b16 a[102:103], v7 offset:41984
v_mfma_f32_16x16x32_bf16 v[160:163], a[104:107], a[40:43], v[160:163]
v_mfma_f32_16x16x32_bf16 v[168:171], a[104:107], a[48:51], v[168:171]
v_mfma_f32_16x16x32_bf16 v[168:171], a[108:111], a[52:55], v[168:171]
v_mfma_f32_16x16x32_bf16 v[176:179], a[108:111], a[60:63], v[176:179]
s_add_u32 m0, s76, 32768
v_mfma_f32_16x16x32_bf16 v[176:179], a[104:107], a[56:59], v[176:179]
s_add_u32 s64, s72, 896
ds_read_b64_tr_b16 a[104:105], v8 offset:32768
v_mfma_f32_16x16x32_bf16 v[180:183], a[112:115], a[56:59], v[180:183]
buffer_load_dwordx4 v12, s[48:51], s64 offen lds
v_mfma_f32_16x16x32_bf16 v[180:183], a[116:119], a[60:63], v[180:183]
s_add_u32 s65, s79, 7168
ds_read_b64_tr_b16 a[106:107], v8 offset:33792
v_add_u32 v4, 0x8000, v4
v_mfma_f32_16x16x32_bf16 v[172:175], a[116:119], a[52:55], v[172:175]
buffer_store_dwordx4 a[184:187], v16, s[44:47], s65 offen sc1
v_mfma_f32_16x16x32_bf16 v[172:175], a[112:115], a[48:51], v[172:175]
s_add_u32 m0, s76, 33792
ds_read_b64_tr_b16 a[108:109], v8 offset:40960
v_mfma_f32_16x16x32_bf16 v[164:167], a[112:115], a[40:43], v[164:167]
s_add_u32 s64, s72, 17280
ds_read_b64_tr_b16 a[110:111], v8 offset:41984
v_mfma_f32_16x16x32_bf16 v[164:167], a[116:119], a[44:47], v[164:167]
buffer_load_dwordx4 v13, s[48:51], s64 offen lds
v_mfma_f32_16x16x32_bf16 v[156:159], a[116:119], a[36:39], v[156:159]
v_mfma_f32_16x16x32_bf16 v[156:159], a[112:115], a[32:35], v[156:159]
ds_read_b64_tr_b16 a[112:113], v9 offset:32768
v_mfma_f32_16x16x32_bf16 v[24:27], a[72:75], a[32:35], v[24:27]
s_add_u32 m0, s76, 34816
ds_read_b64_tr_b16 a[114:115], v9 offset:33792
v_mfma_f32_16x16x32_bf16 v[24:27], a[76:79], a[36:39], v[24:27]
s_add_u32 s64, s72, 131968
ds_read_b64_tr_b16 a[116:117], v9 offset:40960
v_add_u32 v5, 0x8000, v5
v_mfma_f32_16x16x32_bf16 v[40:43], a[76:79], a[44:47], v[40:43]
buffer_load_dwordx4 v12, s[48:51], s64 offen lds
v_mfma_f32_16x16x32_bf16 v[40:43], a[72:75], a[40:43], v[40:43]
ds_read_b64_tr_b16 a[118:119], v9 offset:41984
v_mfma_f32_16x16x32_bf16 v[56:59], a[72:75], a[48:51], v[56:59]
v_mfma_f32_16x16x32_bf16 v[56:59], a[76:79], a[52:55], v[56:59]
s_add_u32 m0, s76, 35840
v_mfma_f32_16x16x32_bf16 v[72:75], a[76:79], a[60:63], v[72:75]
s_waitcnt vmcnt(12)
s_add_u32 s64, s72, 148352
ds_read_b128 a[0:3], v2 offset:0
v_mfma_f32_16x16x32_bf16 v[72:75], a[72:75], a[56:59], v[72:75]
buffer_load_dwordx4 v13, s[48:51], s64 offen lds
v_mfma_f32_16x16x32_bf16 v[136:139], a[80:83], a[56:59], v[136:139]
ds_read_b128 a[4:7], v3 offset:0
v_mfma_f32_16x16x32_bf16 v[136:139], a[84:87], a[60:63], v[136:139]
ds_read_b128 a[8:11], v2 offset:2048
v_add_u32 v6, 0x8000, v6
v_mfma_f32_16x16x32_bf16 v[120:123], a[84:87], a[52:55], v[120:123]
s_add_u32 m0, s76, 36864
ds_read_b128 a[12:15], v3 offset:2048
v_mfma_f32_16x16x32_bf16 v[120:123], a[80:83], a[48:51], v[120:123]
s_add_u32 s64, s73, 896
ds_read_b128 a[16:19], v2 offset:4096
v_mfma_f32_16x16x32_bf16 v[104:107], a[80:83], a[40:43], v[104:107]
buffer_load_dwordx4 v12, s[48:51], s64 offen lds
v_mfma_f32_16x16x32_bf16 v[104:107], a[84:87], a[44:47], v[104:107]
ds_read_b128 a[20:23], v3 offset:4096
v_mfma_f32_16x16x32_bf16 v[88:91], a[84:87], a[36:39], v[88:91]
ds_read_b128 a[24:27], v2 offset:6144
v_mfma_f32_16x16x32_bf16 v[88:91], a[80:83], a[32:35], v[88:91]
s_waitcnt lgkmcnt(7)
s_add_u32 m0, s76, 37888
ds_read_b128 a[28:31], v3 offset:6144
v_mfma_f32_16x16x32_bf16 v[28:31], a[88:91], a[32:35], v[28:31]
s_add_u32 s64, s73, 17280
ds_read_b64_tr_b16 a[72:73], v10 offset:32768
v_mfma_f32_16x16x32_bf16 v[28:31], a[92:95], a[36:39], v[28:31]
buffer_load_dwordx4 v13, s[48:51], s64 offen lds
v_mfma_f32_16x16x32_bf16 v[44:47], a[92:95], a[44:47], v[44:47]
ds_read_b64_tr_b16 a[74:75], v10 offset:33792
v_add_u32 v7, 0x8000, v7
v_mfma_f32_16x16x32_bf16 v[44:47], a[88:91], a[40:43], v[44:47]
ds_read_b64_tr_b16 a[76:77], v10 offset:40960
v_mfma_f32_16x16x32_bf16 v[60:63], a[88:91], a[48:51], v[60:63]
s_add_u32 m0, s76, 38912
ds_read_b64_tr_b16 a[78:79], v10 offset:41984
v_mfma_f32_16x16x32_bf16 v[60:63], a[92:95], a[52:55], v[60:63]
s_add_u32 s64, s73, 131968
ds_read_b64_tr_b16 a[80:81], v11 offset:32768
v_mfma_f32_16x16x32_bf16 v[76:79], a[92:95], a[60:63], v[76:79]
buffer_load_dwordx4 v12, s[48:51], s64 offen lds
v_mfma_f32_16x16x32_bf16 v[76:79], a[88:91], a[56:59], v[76:79]
ds_read_b64_tr_b16 a[82:83], v11 offset:33792
v_mfma_f32_16x16x32_bf16 v[140:143], a[96:99], a[56:59], v[140:143]
ds_read_b64_tr_b16 a[84:85], v11 offset:40960
v_mfma_f32_16x16x32_bf16 v[140:143], a[100:103], a[60:63], v[140:143]
s_add_u32 m0, s76, 39936
ds_read_b64_tr_b16 a[86:87], v11 offset:41984
v_add_u32 v8, 0x8000, v8
v_mfma_f32_16x16x32_bf16 v[124:127], a[100:103], a[52:55], v[124:127]
s_add_u32 s64, s73, 148352
v_mfma_f32_16x16x32_bf16 v[124:127], a[96:99], a[48:51], v[124:127]
buffer_load_dwordx4 v13, s[48:51], s64 offen lds
v_mfma_f32_16x16x32_bf16 v[108:111], a[96:99], a[40:43], v[108:111]
v_mfma_f32_16x16x32_bf16 v[108:111], a[100:103], a[44:47], v[108:111]
v_mfma_f32_16x16x32_bf16 v[92:95], a[100:103], a[36:39], v[92:95]
v_add_u32 v9, 0x8000, v9
v_add_u32 v10, 0x8000, v10
v_mfma_f32_16x16x32_bf16 v[92:95], a[96:99], a[32:35], v[92:95]
v_add_u32 v11, 0x8000, v11
v_mfma_f32_16x16x32_bf16 v[32:35], a[104:107], a[32:35], v[32:35]
v_mfma_f32_16x16x32_bf16 v[32:35], a[108:111], a[36:39], v[32:35]
v_mfma_f32_16x16x32_bf16 v[48:51], a[108:111], a[44:47], v[48:51]
s_waitcnt lgkmcnt(0)
s_barrier
v_mfma_f32_16x16x32_bf16 v[48:51], a[104:107], a[40:43], v[48:51]
s_add_u32 m0, s77, 98304
ds_read_b64_tr_b16 a[88:89], v19 offset:36864
v_mfma_f32_16x16x32_bf16 v[64:67], a[104:107], a[48:51], v[64:67]
s_add_u32 s64, s71, 4194304
ds_read_b64_tr_b16 a[90:91], v19 offset:37120
v_mfma_f32_16x16x32_bf16 v[64:67], a[108:111], a[52:55], v[64:67]
buffer_load_dwordx4 v14, s[56:59], s64 offen lds
v_mfma_f32_16x16x32_bf16 v[80:83], a[108:111], a[60:63], v[80:83]
ds_read_b64_tr_b16 a[92:93], v19 offset:38912
v_mfma_f32_16x16x32_bf16 v[80:83], a[104:107], a[56:59], v[80:83]
ds_read_b64_tr_b16 a[94:95], v19 offset:39168
v_mfma_f32_16x16x32_bf16 v[144:147], a[112:115], a[56:59], v[144:147]
ds_read_b64_tr_b16 a[96:97], v20 offset:36864
v_mfma_f32_16x16x32_bf16 v[144:147], a[116:119], a[60:63], v[144:147]
ds_read_b64_tr_b16 a[98:99], v20 offset:37120
v_mfma_f32_16x16x32_bf16 v[128:131], a[116:119], a[52:55], v[128:131]
s_add_u32 s65, s79, 3072
ds_read_b64_tr_b16 a[100:101], v20 offset:38912
v_mfma_f32_16x16x32_bf16 v[128:131], a[112:115], a[48:51], v[128:131]
buffer_store_dwordx4 a[188:191], v16, s[44:47], s65 offen sc1
v_mfma_f32_16x16x32_bf16 v[112:115], a[112:115], a[40:43], v[112:115]
s_add_u32 m0, s78, 114688
ds_read_b64_tr_b16 a[102:103], v20 offset:39168
v_mfma_f32_16x16x32_bf16 v[112:115], a[116:119], a[44:47], v[112:115]
s_add_u32 s64, s75, 3145728
ds_read_b64_tr_b16 a[104:105], v19 offset:40960
v_mfma_f32_16x16x32_bf16 v[96:99], a[116:119], a[36:39], v[96:99]
buffer_load_dwordx4 v23, s[60:63], s64 offen lds
v_mfma_f32_16x16x32_bf16 v[96:99], a[112:115], a[32:35], v[96:99]
ds_read_b64_tr_b16 a[106:107], v19 offset:41216
v_mfma_f32_16x16x32_bf16 v[36:39], a[72:75], a[32:35], v[36:39]
ds_read_b64_tr_b16 a[108:109], v19 offset:43008
v_mfma_f32_16x16x32_bf16 v[36:39], a[76:79], a[36:39], v[36:39]
ds_read_b64_tr_b16 a[110:111], v19 offset:43264
v_mfma_f32_16x16x32_bf16 v[52:55], a[76:79], a[44:47], v[52:55]
ds_read_b64_tr_b16 a[112:113], v20 offset:40960
v_mfma_f32_16x16x32_bf16 v[52:55], a[72:75], a[40:43], v[52:55]
ds_read_b64_tr_b16 a[114:115], v20 offset:41216
v_mfma_f32_16x16x32_bf16 v[68:71], a[72:75], a[48:51], v[68:71]
ds_read_b64_tr_b16 a[116:117], v20 offset:43008
v_mfma_f32_16x16x32_bf16 v[68:71], a[76:79], a[52:55], v[68:71]
s_add_u32 m0, s77, 99328
ds_read_b64_tr_b16 a[118:119], v20 offset:43264
v_mfma_f32_16x16x32_bf16 v[84:87], a[76:79], a[60:63], v[84:87]
s_add_u32 s64, s71, 4227072
v_mfma_f32_16x16x32_bf16 v[84:87], a[72:75], a[56:59], v[84:87]
buffer_load_dwordx4 v14, s[56:59], s64 offen lds
v_mfma_f32_16x16x32_bf16 v[148:151], a[80:83], a[56:59], v[148:151]
ds_read_b64_tr_b16 a[72:73], v19 offset:32768
v_mfma_f32_16x16x32_bf16 v[148:151], a[84:87], a[60:63], v[148:151]
ds_read_b64_tr_b16 a[74:75], v19 offset:33024
v_mfma_f32_16x16x32_bf16 v[132:135], a[84:87], a[52:55], v[132:135]
ds_read_b64_tr_b16 a[76:77], v19 offset:34816
v_mfma_f32_16x16x32_bf16 v[132:135], a[80:83], a[48:51], v[132:135]
ds_read_b64_tr_b16 a[78:79], v19 offset:35072
v_mfma_f32_16x16x32_bf16 v[116:119], a[80:83], a[40:43], v[116:119]
v_mfma_f32_16x16x32_bf16 v[116:119], a[84:87], a[44:47], v[116:119]
v_mfma_f32_16x16x32_bf16 v[100:103], a[84:87], a[36:39], v[100:103]
s_add_u32 m0, s78, 118784
v_mfma_f32_16x16x32_bf16 v[100:103], a[80:83], a[32:35], v[100:103]
s_waitcnt lgkmcnt(4)
s_add_u32 s64, s75, 3147776
ds_read_b64_tr_b16 a[80:81], v20 offset:32768
v_mfma_f32_16x16x32_bf16 v[184:187], a[88:91], a[0:3], v[184:187]
buffer_load_dwordx4 v23, s[60:63], s64 offen lds
v_mfma_f32_16x16x32_bf16 v[184:187], a[92:95], a[4:7], v[184:187]
ds_read_b64_tr_b16 a[82:83], v20 offset:33024
v_mfma_f32_16x16x32_bf16 v[192:195], a[92:95], a[12:15], v[192:195]
ds_read_b64_tr_b16 a[84:85], v20 offset:34816
v_mfma_f32_16x16x32_bf16 v[192:195], a[88:91], a[8:11], v[192:195]
s_add_u32 s17, s78, .-L_pc+6144
ds_read_b64_tr_b16 a[86:87], v20 offset:35072
v_mfma_f32_16x16x32_bf16 v[200:203], a[88:91], a[16:19], v[200:203]
buffer_load_dword a252, v16, s[88:91], s17 offen
v_mfma_f32_16x16x32_bf16 v[200:203], a[92:95], a[20:23], v[200:203]
v_mfma_f32_16x16x32_bf16 v[208:211], a[92:95], a[28:31], v[208:211]
v_mfma_f32_16x16x32_bf16 v[208:211], a[88:91], a[24:27], v[208:211]
ds_read_b64_tr_b16 a[88:89], v4 offset:32768
v_mfma_f32_16x16x32_bf16 v[212:215], a[96:99], a[24:27], v[212:215]
s_add_u32 m0, s77, 100352
ds_read_b64_tr_b16 a[90:91], v4 offset:33792
v_mfma_f32_16x16x32_bf16 v[212:215], a[100:103], a[28:31], v[212:215]
s_add_u32 s64, s71, 4259840
ds_read_b64_tr_b16 a[92:93], v4 offset:40960
v_mfma_f32_16x16x32_bf16 v[204:207], a[100:103], a[20:23], v[204:207]
buffer_load_dwordx4 v15, s[56:59], s64 offen lds
v_mfma_f32_16x16x32_bf16 v[204:207], a[96:99], a[16:19], v[204:207]
ds_read_b64_tr_b16 a[94:95], v4 offset:41984
v_mfma_f32_16x16x32_bf16 v[196:199], a[96:99], a[8:11], v[196:199]
v_mfma_f32_16x16x32_bf16 v[196:199], a[100:103], a[12:15], v[196:199]
v_mfma_f32_16x16x32_bf16 v[188:191], a[100:103], a[4:7], v[188:191]
v_mfma_f32_16x16x32_bf16 v[188:191], a[96:99], a[0:3], v[188:191]
ds_read_b64_tr_b16 a[96:97], v5 offset:32768
v_mfma_f32_16x16x32_bf16 v[216:219], a[0:3], a[104:107], v[216:219]
ds_read_b64_tr_b16 a[98:99], v5 offset:33792
v_mfma_f32_16x16x32_bf16 v[216:219], a[4:7], a[108:111], v[216:219]
s_add_u32 m0, s78, 122880
ds_read_b64_tr_b16 a[100:101], v5 offset:40960
v_mfma_f32_16x16x32_bf16 v[224:227], a[12:15], a[108:111], v[224:227]
s_add_u32 s64, s75, 3149824
ds_read_b64_tr_b16 a[102:103], v5 offset:41984
v_mfma_f32_16x16x32_bf16 v[224:227], a[8:11], a[104:107], v[224:227]
buffer_load_dwordx4 v23, s[60:63], s64 offen lds
v_mfma_f32_16x16x32_bf16 v[232:235], a[16:19], a[104:107], v[232:235]
v_mfma_f32_16x16x32_bf16 v[232:235], a[20:23], a[108:111], v[232:235]
v_mfma_f32_16x16x32_bf16 v[240:243], a[28:31], a[108:111], v[240:243]
v_mfma_f32_16x16x32_bf16 v[240:243], a[24:27], a[104:107], v[240:243]
ds_read_b64_tr_b16 a[104:105], v6 offset:32768
v_mfma_f32_16x16x32_bf16 v[244:247], a[24:27], a[112:115], v[244:247]
ds_read_b64_tr_b16 a[106:107], v6 offset:33792
v_mfma_f32_16x16x32_bf16 v[244:247], a[28:31], a[116:119], v[244:247]
ds_read_b64_tr_b16 a[108:109], v6 offset:40960
v_subrev_u32 v19, 0x8000, v19
v_mfma_f32_16x16x32_bf16 v[236:239], a[20:23], a[116:119], v[236:239]
s_add_u32 m0, s77, 101376
ds_read_b64_tr_b16 a[110:111], v6 offset:41984
v_mfma_f32_16x16x32_bf16 v[236:239], a[16:19], a[112:115], v[236:239]
s_add_u32 s64, s71, 4292608
v_mfma_f32_16x16x32_bf16 v[228:231], a[8:11], a[112:115], v[228:231]
s_add_u32 s65, s79, 24576
buffer_load_dwordx4 v15, s[56:59], s64 offen lds
v_mfma_f32_16x16x32_bf16 v[228:231], a[12:15], a[116:119], v[228:231]
buffer_store_dwordx4 a[192:195], v16, s[44:47], s65 offen sc1
v_mfma_f32_16x16x32_bf16 v[220:223], a[4:7], a[116:119], v[220:223]
v_mfma_f32_16x16x32_bf16 v[220:223], a[0:3], a[112:115], v[220:223]
s_waitcnt lgkmcnt(4)
ds_read_b64_tr_b16 a[112:113], v7 offset:32768
v_mfma_f32_16x16x32_bf16 v[152:155], a[72:75], a[0:3], v[152:155]
ds_read_b64_tr_b16 a[114:115], v7 offset:33792
v_mfma_f32_16x16x32_bf16 v[152:155], a[76:79], a[4:7], v[152:155]
ds_read_b64_tr_b16 a[116:117], v7 offset:40960
v_subrev_u32 v20, 0x8000, v20
v_mfma_f32_16x16x32_bf16 v[160:163], a[76:79], a[12:15], v[160:163]
ds_read_b64_tr_b16 a[118:119], v7 offset:41984
v_mfma_f32_16x16x32_bf16 v[160:163], a[72:75], a[8:11], v[160:163]
v_mfma_f32_16x16x32_bf16 v[168:171], a[72:75], a[16:19], v[168:171]
v_mfma_f32_16x16x32_bf16 v[168:171], a[76:79], a[20:23], v[168:171]
v_mfma_f32_16x16x32_bf16 v[176:179], a[76:79], a[28:31], v[176:179]
s_add_u32 m0, s76, 0
v_mfma_f32_16x16x32_bf16 v[176:179], a[72:75], a[24:27], v[176:179]
s_add_u32 s64, s72, 1024
ds_read_b64_tr_b16 a[72:73], v8 offset:32768
v_mfma_f32_16x16x32_bf16 v[180:183], a[80:83], a[24:27], v[180:183]
buffer_load_dwordx4 v12, s[48:51], s64 offen lds
v_mfma_f32_16x16x32_bf16 v[180:183], a[84:87], a[28:31], v[180:183]
ds_read_b64_tr_b16 a[74:75], v8 offset:33792
v_subrev_u32 v4, 0x8000, v4
v_mfma_f32_16x16x32_bf16 v[172:175], a[84:87], a[20:23], v[172:175]
ds_read_b64_tr_b16 a[76:77], v8 offset:40960
v_mfma_f32_16x16x32_bf16 v[172:175], a[80:83], a[16:19], v[172:175]
s_add_u32 m0, s76, 1024
ds_read_b64_tr_b16 a[78:79], v8 offset:41984
v_mfma_f32_16x16x32_bf16 v[164:167], a[80:83], a[8:11], v[164:167]
s_add_u32 s64, s72, 17408
v_mfma_f32_16x16x32_bf16 v[164:167], a[84:87], a[12:15], v[164:167]
buffer_load_dwordx4 v13, s[48:51], s64 offen lds
v_mfma_f32_16x16x32_bf16 v[156:159], a[84:87], a[4:7], v[156:159]
v_mfma_f32_16x16x32_bf16 v[156:159], a[80:83], a[0:3], v[156:159]
ds_read_b64_tr_b16 a[80:81], v9 offset:32768
v_mfma_f32_16x16x32_bf16 v[24:27], a[88:91], a[0:3], v[24:27]
s_add_u32 m0, s76, 2048
ds_read_b64_tr_b16 a[82:83], v9 offset:33792
v_mfma_f32_16x16x32_bf16 v[24:27], a[92:95], a[4:7], v[24:27]
s_add_u32 s64, s72, 132096
ds_read_b64_tr_b16 a[84:85], v9 offset:40960
v_subrev_u32 v5, 0x8000, v5
v_mfma_f32_16x16x32_bf16 v[40:43], a[92:95], a[12:15], v[40:43]
buffer_load_dwordx4 v12, s[48:51], s64 offen lds
v_mfma_f32_16x16x32_bf16 v[40:43], a[88:91], a[8:11], v[40:43]
ds_read_b64_tr_b16 a[86:87], v9 offset:41984
v_mfma_f32_16x16x32_bf16 v[56:59], a[88:91], a[16:19], v[56:59]
v_mfma_f32_16x16x32_bf16 v[56:59], a[92:95], a[20:23], v[56:59]
s_add_u32 m0, s76, 3072
v_mfma_f32_16x16x32_bf16 v[72:75], a[92:95], a[28:31], v[72:75]
s_waitcnt vmcnt(13)
s_add_u32 s64, s72, 148480
ds_read_b128 a[32:35], v2 offset:32768
v_mfma_f32_16x16x32_bf16 v[72:75], a[88:91], a[24:27], v[72:75]
buffer_load_dwordx4 v13, s[48:51], s64 offen lds
v_mfma_f32_16x16x32_bf16 v[136:139], a[96:99], a[24:27], v[136:139]
ds_read_b128 a[36:39], v3 offset:32768
v_mfma_f32_16x16x32_bf16 v[136:139], a[100:103], a[28:31], v[136:139]
ds_read_b128 a[40:43], v2 offset:34816
v_subrev_u32 v6, 0x8000, v6
v_mfma_f32_16x16x32_bf16 v[120:123], a[100:103], a[20:23], v[120:123]
s_add_u32 m0, s76, 4096
ds_read_b128 a[44:47], v3 offset:34816
v_mfma_f32_16x16x32_bf16 v[120:123], a[96:99], a[16:19], v[120:123]
s_add_u32 s64, s73, 1024
ds_read_b128 a[48:51], v2 offset:36864
v_mfma_f32_16x16x32_bf16 v[104:107], a[96:99], a[8:11], v[104:107]
buffer_load_dwordx4 v12, s[48:51], s64 offen lds
v_mfma_f32_16x16x32_bf16 v[104:107], a[100:103], a[12:15], v[104:107]
ds_read_b128 a[52:55], v3 offset:36864
v_mfma_f32_16x16x32_bf16 v[88:91], a[100:103], a[4:7], v[88:91]
ds_read_b128 a[56:59], v2 offset:38912
v_mfma_f32_16x16x32_bf16 v[88:91], a[96:99], a[0:3], v[88:91]
s_waitcnt lgkmcnt(7)
s_add_u32 m0, s76, 5120
ds_read_b128 a[60:63], v3 offset:38912
v_mfma_f32_16x16x32_bf16 v[28:31], a[104:107], a[0:3], v[28:31]
s_add_u32 s64, s73, 17408
ds_read_b64_tr_b16 a[88:89], v10 offset:32768
v_mfma_f32_16x16x32_bf16 v[28:31], a[108:111], a[4:7], v[28:31]
buffer_load_dwordx4 v13, s[48:51], s64 offen lds
v_mfma_f32_16x16x32_bf16 v[44:47], a[108:111], a[12:15], v[44:47]
ds_read_b64_tr_b16 a[90:91], v10 offset:33792
v_subrev_u32 v7, 0x8000, v7
v_mfma_f32_16x16x32_bf16 v[44:47], a[104:107], a[8:11], v[44:47]
ds_read_b64_tr_b16 a[92:93], v10 offset:40960
v_mfma_f32_16x16x32_bf16 v[60:63], a[104:107], a[16:19], v[60:63]
s_add_u32 m0, s76, 6144
ds_read_b64_tr_b16 a[94:95], v10 offset:41984
v_mfma_f32_16x16x32_bf16 v[60:63], a[108:111], a[20:23], v[60:63]
s_add_u32 s64, s73, 132096
ds_read_b64_tr_b16 a[96:97], v11 offset:32768
v_mfma_f32_16x16x32_bf16 v[76:79], a[108:111], a[28:31], v[76:79]
buffer_load_dwordx4 v12, s[48:51], s64 offen lds
v_mfma_f32_16x16x32_bf16 v[76:79], a[104:107], a[24:27], v[76:79]
ds_read_b64_tr_b16 a[98:99], v11 offset:33792
v_mfma_f32_16x16x32_bf16 v[140:143], a[112:115], a[24:27], v[140:143]
ds_read_b64_tr_b16 a[100:101], v11 offset:40960
v_mfma_f32_16x16x32_bf16 v[140:143], a[116:119], a[28:31], v[140:143]
s_add_u32 m0, s76, 7168
ds_read_b64_tr_b16 a[102:103], v11 offset:41984
v_subrev_u32 v8, 0x8000, v8
v_mfma_f32_16x16x32_bf16 v[124:127], a[116:119], a[20:23], v[124:127]
s_add_u32 s64, s73, 148480
v_mfma_f32_16x16x32_bf16 v[124:127], a[112:115], a[16:19], v[124:127]
buffer_load_dwordx4 v13, s[48:51], s64 offen lds
v_mfma_f32_16x16x32_bf16 v[108:111], a[112:115], a[8:11], v[108:111]
v_mfma_f32_16x16x32_bf16 v[108:111], a[116:119], a[12:15], v[108:111]
v_mfma_f32_16x16x32_bf16 v[92:95], a[116:119], a[4:7], v[92:95]
v_subrev_u32 v9, 0x8000, v9
v_subrev_u32 v10, 0x8000, v10
v_mfma_f32_16x16x32_bf16 v[92:95], a[112:115], a[0:3], v[92:95]
s_add_u32 s65, s79, 25600
v_subrev_u32 v11, 0x8000, v11
v_mfma_f32_16x16x32_bf16 v[32:35], a[72:75], a[0:3], v[32:35]
buffer_store_dwordx4 a[196:199], v16, s[44:47], s65 offen sc1
v_mfma_f32_16x16x32_bf16 v[32:35], a[76:79], a[4:7], v[32:35]
v_mfma_f32_16x16x32_bf16 v[48:51], a[76:79], a[12:15], v[48:51]
s_waitcnt lgkmcnt(0)
s_barrier
v_mfma_f32_16x16x32_bf16 v[48:51], a[72:75], a[8:11], v[48:51]
s_add_u32 m0, s77, 131072
ds_read_b64_tr_b16 a[104:105], v19 offset:4096
v_mfma_f32_16x16x32_bf16 v[64:67], a[72:75], a[16:19], v[64:67]
s_add_u32 s64, s71, 4718592
ds_read_b64_tr_b16 a[106:107], v19 offset:4352
v_mfma_f32_16x16x32_bf16 v[64:67], a[76:79], a[20:23], v[64:67]
buffer_load_dwordx4 v14, s[56:59], s64 offen lds
v_mfma_f32_16x16x32_bf16 v[80:83], a[76:79], a[28:31], v[80:83]
ds_read_b64_tr_b16 a[108:109], v19 offset:6144
v_mfma_f32_16x16x32_bf16 v[80:83], a[72:75], a[24:27], v[80:83]
ds_read_b64_tr_b16 a[110:111], v19 offset:6400
v_mfma_f32_16x16x32_bf16 v[144:147], a[80:83], a[24:27], v[144:147]
ds_read_b64_tr_b16 a[112:113], v20 offset:4096
v_mfma_f32_16x16x32_bf16 v[144:147], a[84:87], a[28:31], v[144:147]
ds_read_b64_tr_b16 a[114:115], v20 offset:4352
v_mfma_f32_16x16x32_bf16 v[128:131], a[84:87], a[20:23], v[128:131]
ds_read_b64_tr_b16 a[116:117], v20 offset:6144
v_mfma_f32_16x16x32_bf16 v[128:131], a[80:83], a[16:19], v[128:131]
ds_read_b64_tr_b16 a[118:119], v20 offset:6400
v_mfma_f32_16x16x32_bf16 v[112:115], a[80:83], a[8:11], v[112:115]
s_add_u32 m0, s78, 147456
ds_read_b64_tr_b16 a[72:73], v19 offset:8192
v_mfma_f32_16x16x32_bf16 v[112:115], a[84:87], a[12:15], v[112:115]
s_add_u32 s64, s75, 3538944
ds_read_b64_tr_b16 a[74:75], v19 offset:8448
v_mfma_f32_16x16x32_bf16 v[96:99], a[84:87], a[4:7], v[96:99]
buffer_load_dwordx4 v23, s[60:63], s64 offen lds
v_mfma_f32_16x16x32_bf16 v[96:99], a[80:83], a[0:3], v[96:99]
ds_read_b64_tr_b16 a[76:77], v19 offset:10240
v_mfma_f32_16x16x32_bf16 v[36:39], a[88:91], a[0:3], v[36:39]
ds_read_b64_tr_b16 a[78:79], v19 offset:10496
v_mfma_f32_16x16x32_bf16 v[36:39], a[92:95], a[4:7], v[36:39]
ds_read_b64_tr_b16 a[80:81], v20 offset:8192
v_mfma_f32_16x16x32_bf16 v[52:55], a[92:95], a[12:15], v[52:55]
ds_read_b64_tr_b16 a[82:83], v20 offset:8448
v_mfma_f32_16x16x32_bf16 v[52:55], a[88:91], a[8:11], v[52:55]
ds_read_b64_tr_b16 a[84:85], v20 offset:10240
v_mfma_f32_16x16x32_bf16 v[68:71], a[88:91], a[16:19], v[68:71]
ds_read_b64_tr_b16 a[86:87], v20 offset:10496
v_mfma_f32_16x16x32_bf16 v[68:71], a[92:95], a[20:23], v[68:71]
s_add_u32 m0, s77, 132096
v_mfma_f32_16x16x32_bf16 v[84:87], a[92:95], a[28:31], v[84:87]
s_add_u32 s64, s71, 4751360
v_mfma_f32_16x16x32_bf16 v[84:87], a[88:91], a[24:27], v[84:87]
buffer_load_dwordx4 v14, s[56:59], s64 offen lds
v_mfma_f32_16x16x32_bf16 v[148:151], a[96:99], a[24:27], v[148:151]
ds_read_b64_tr_b16 a[88:89], v19 offset:0
v_mfma_f32_16x16x32_bf16 v[148:151], a[100:103], a[28:31], v[148:151]
ds_read_b64_tr_b16 a[90:91], v19 offset:256
v_mfma_f32_16x16x32_bf16 v[132:135], a[100:103], a[20:23], v[132:135]
ds_read_b64_tr_b16 a[92:93], v19 offset:2048
v_mfma_f32_16x16x32_bf16 v[132:135], a[96:99], a[16:19], v[132:135]
ds_read_b64_tr_b16 a[94:95], v19 offset:2304
v_mfma_f32_16x16x32_bf16 v[116:119], a[96:99], a[8:11], v[116:119]
v_mfma_f32_16x16x32_bf16 v[116:119], a[100:103], a[12:15], v[116:119]
v_mfma_f32_16x16x32_bf16 v[100:103], a[100:103], a[4:7], v[100:103]
s_add_u32 m0, s78, 151552
v_mfma_f32_16x16x32_bf16 v[100:103], a[96:99], a[0:3], v[100:103]
s_waitcnt lgkmcnt(4)
s_add_u32 s64, s75, 3540992
ds_read_b64_tr_b16 a[96:97], v20 offset:0
v_mfma_f32_16x16x32_bf16 v[184:187], a[104:107], a[32:35], v[184:187]
buffer_load_dwordx4 v23, s[60:63], s64 offen lds
v_mfma_f32_16x16x32_bf16 v[184:187], a[108:111], a[36:39], v[184:187]
ds_read_b64_tr_b16 a[98:99], v20 offset:256
v_mfma_f32_16x16x32_bf16 v[192:195], a[108:111], a[44:47], v[192:195]
ds_read_b64_tr_b16 a[100:101], v20 offset:2048
v_mfma_f32_16x16x32_bf16 v[192:195], a[104:107], a[40:43], v[192:195]
ds_read_b64_tr_b16 a[102:103], v20 offset:2304
v_mfma_f32_16x16x32_bf16 v[200:203], a[104:107], a[48:51], v[200:203]
v_mfma_f32_16x16x32_bf16 v[200:203], a[108:111], a[52:55], v[200:203]
v_mfma_f32_16x16x32_bf16 v[208:211], a[108:111], a[60:63], v[208:211]
v_mfma_f32_16x16x32_bf16 v[208:211], a[104:107], a[56:59], v[208:211]
ds_read_b64_tr_b16 a[104:105], v4 offset:0
v_mfma_f32_16x16x32_bf16 v[212:215], a[112:115], a[56:59], v[212:215]
s_add_u32 m0, s77, 133120
ds_read_b64_tr_b16 a[106:107], v4 offset:1024
v_mfma_f32_16x16x32_bf16 v[212:215], a[116:119], a[60:63], v[212:215]
s_add_u32 s64, s71, 4784128
ds_read_b64_tr_b16 a[108:109], v4 offset:8192
v_mfma_f32_16x16x32_bf16 v[204:207], a[116:119], a[52:55], v[204:207]
buffer_load_dwordx4 v15, s[56:59], s64 offen lds
v_mfma_f32_16x16x32_bf16 v[204:207], a[112:115], a[48:51], v[204:207]
ds_read_b64_tr_b16 a[110:111], v4 offset:9216
v_mfma_f32_16x16x32_bf16 v[196:199], a[112:115], a[40:43], v[196:199]
v_mfma_f32_16x16x32_bf16 v[196:199], a[116:119], a[44:47], v[196:199]
v_mfma_f32_16x16x32_bf16 v[188:191], a[116:119], a[36:39], v[188:191]
s_add_u32 s65, s79, 9216
v_mfma_f32_16x16x32_bf16 v[188:191], a[112:115], a[32:35], v[188:191]
buffer_store_dwordx4 a[200:203], v16, s[44:47], s65 offen sc1
v_mfma_f32_16x16x32_bf16 v[216:219], a[32:35], a[72:75], v[216:219]
ds_read_b64_tr_b16 a[112:113], v5 offset:0
v_mfma_f32_16x16x32_bf16 v[216:219], a[36:39], a[76:79], v[216:219]
s_add_u32 m0, s78, 155648
ds_read_b64_tr_b16 a[114:115], v5 offset:1024
v_mfma_f32_16x16x32_bf16 v[224:227], a[44:47], a[76:79], v[224:227]
s_add_u32 s64, s75, 3543040
ds_read_b64_tr_b16 a[116:117], v5 offset:8192
v_mfma_f32_16x16x32_bf16 v[224:227], a[40:43], a[72:75], v[224:227]
buffer_load_dwordx4 v23, s[60:63], s64 offen lds
v_mfma_f32_16x16x32_bf16 v[232:235], a[48:51], a[72:75], v[232:235]
ds_read_b64_tr_b16 a[118:119], v5 offset:9216
v_mfma_f32_16x16x32_bf16 v[232:235], a[52:55], a[76:79], v[232:235]
v_mfma_f32_16x16x32_bf16 v[240:243], a[60:63], a[76:79], v[240:243]
v_mfma_f32_16x16x32_bf16 v[240:243], a[56:59], a[72:75], v[240:243]
ds_read_b64_tr_b16 a[72:73], v6 offset:0
v_mfma_f32_16x16x32_bf16 v[244:247], a[56:59], a[80:83], v[244:247]
ds_read_b64_tr_b16 a[74:75], v6 offset:1024
v_mfma_f32_16x16x32_bf16 v[244:247], a[60:63], a[84:87], v[244:247]
ds_read_b64_tr_b16 a[76:77], v6 offset:8192
v_mfma_f32_16x16x32_bf16 v[236:239], a[52:55], a[84:87], v[236:239]
s_add_u32 m0, s77, 134144
ds_read_b64_tr_b16 a[78:79], v6 offset:9216
v_mfma_f32_16x16x32_bf16 v[236:239], a[48:51], a[80:83], v[236:239]
s_add_u32 s64, s71, 4816896
v_mfma_f32_16x16x32_bf16 v[228:231], a[40:43], a[80:83], v[228:231]
buffer_load_dwordx4 v15, s[56:59], s64 offen lds
v_mfma_f32_16x16x32_bf16 v[228:231], a[44:47], a[84:87], v[228:231]
v_mfma_f32_16x16x32_bf16 v[220:223], a[36:39], a[84:87], v[220:223]
v_mfma_f32_16x16x32_bf16 v[220:223], a[32:35], a[80:83], v[220:223]
s_waitcnt lgkmcnt(4)
ds_read_b64_tr_b16 a[80:81], v7 offset:0
v_mfma_f32_16x16x32_bf16 v[152:155], a[88:91], a[32:35], v[152:155]
ds_read_b64_tr_b16 a[82:83], v7 offset:1024
v_mfma_f32_16x16x32_bf16 v[152:155], a[92:95], a[36:39], v[152:155]
ds_read_b64_tr_b16 a[84:85], v7 offset:8192
v_mfma_f32_16x16x32_bf16 v[160:163], a[92:95], a[44:47], v[160:163]
ds_read_b64_tr_b16 a[86:87], v7 offset:9216
v_mfma_f32_16x16x32_bf16 v[160:163], a[88:91], a[40:43], v[160:163]
v_mfma_f32_16x16x32_bf16 v[168:171], a[88:91], a[48:51], v[168:171]
v_mfma_f32_16x16x32_bf16 v[168:171], a[92:95], a[52:55], v[168:171]
v_mfma_f32_16x16x32_bf16 v[176:179], a[92:95], a[60:63], v[176:179]
s_add_u32 m0, s76, 32768
v_mfma_f32_16x16x32_bf16 v[176:179], a[88:91], a[56:59], v[176:179]
s_add_u32 s64, s72, 1152
ds_read_b64_tr_b16 a[88:89], v8 offset:0
v_mfma_f32_16x16x32_bf16 v[180:183], a[96:99], a[56:59], v[180:183]
buffer_load_dwordx4 v12, s[48:51], s64 offen lds
v_mfma_f32_16x16x32_bf16 v[180:183], a[100:103], a[60:63], v[180:183]
ds_read_b64_tr_b16 a[90:91], v8 offset:1024
v_mfma_f32_16x16x32_bf16 v[172:175], a[100:103], a[52:55], v[172:175]
ds_read_b64_tr_b16 a[92:93], v8 offset:8192
v_mfma_f32_16x16x32_bf16 v[172:175], a[96:99], a[48:51], v[172:175]
s_add_u32 m0, s76, 33792
ds_read_b64_tr_b16 a[94:95], v8 offset:9216
v_mfma_f32_16x16x32_bf16 v[164:167], a[96:99], a[40:43], v[164:167]
s_add_u32 s64, s72, 17536
v_mfma_f32_16x16x32_bf16 v[164:167], a[100:103], a[44:47], v[164:167]
buffer_load_dwordx4 v13, s[48:51], s64 offen lds
v_mfma_f32_16x16x32_bf16 v[156:159], a[100:103], a[36:39], v[156:159]
v_mfma_f32_16x16x32_bf16 v[156:159], a[96:99], a[32:35], v[156:159]
ds_read_b64_tr_b16 a[96:97], v9 offset:0
v_mfma_f32_16x16x32_bf16 v[24:27], a[104:107], a[32:35], v[24:27]
s_add_u32 m0, s76, 34816
ds_read_b64_tr_b16 a[98:99], v9 offset:1024
v_mfma_f32_16x16x32_bf16 v[24:27], a[108:111], a[36:39], v[24:27]
s_add_u32 s64, s72, 132224
ds_read_b64_tr_b16 a[100:101], v9 offset:8192
v_mfma_f32_16x16x32_bf16 v[40:43], a[108:111], a[44:47], v[40:43]
buffer_load_dwordx4 v12, s[48:51], s64 offen lds
v_mfma_f32_16x16x32_bf16 v[40:43], a[104:107], a[40:43], v[40:43]
ds_read_b64_tr_b16 a[102:103], v9 offset:9216
v_mfma_f32_16x16x32_bf16 v[56:59], a[104:107], a[48:51], v[56:59]
v_mfma_f32_16x16x32_bf16 v[56:59], a[108:111], a[52:55], v[56:59]
s_add_u32 m0, s76, 35840
v_mfma_f32_16x16x32_bf16 v[72:75], a[108:111], a[60:63], v[72:75]
s_waitcnt vmcnt(12)
s_add_u32 s64, s72, 148608
ds_read_b128 a[0:3], v2 offset:0
v_mfma_f32_16x16x32_bf16 v[72:75], a[104:107], a[56:59], v[72:75]
buffer_load_dwordx4 v13, s[48:51], s64 offen lds
v_mfma_f32_16x16x32_bf16 v[136:139], a[112:115], a[56:59], v[136:139]
ds_read_b128 a[4:7], v3 offset:0
v_mfma_f32_16x16x32_bf16 v[136:139], a[116:119], a[60:63], v[136:139]
ds_read_b128 a[8:11], v2 offset:2048
v_mfma_f32_16x16x32_bf16 v[120:123], a[116:119], a[52:55], v[120:123]
s_add_u32 m0, s76, 36864
ds_read_b128 a[12:15], v3 offset:2048
v_mfma_f32_16x16x32_bf16 v[120:123], a[112:115], a[48:51], v[120:123]
s_add_u32 s64, s73, 1152
ds_read_b128 a[16:19], v2 offset:4096
v_mfma_f32_16x16x32_bf16 v[104:107], a[112:115], a[40:43], v[104:107]
buffer_load_dwordx4 v12, s[48:51], s64 offen lds
v_mfma_f32_16x16x32_bf16 v[104:107], a[116:119], a[44:47], v[104:107]
ds_read_b128 a[20:23], v3 offset:4096
v_mfma_f32_16x16x32_bf16 v[88:91], a[116:119], a[36:39], v[88:91]
ds_read_b128 a[24:27], v2 offset:6144
v_mfma_f32_16x16x32_bf16 v[88:91], a[112:115], a[32:35], v[88:91]
s_waitcnt lgkmcnt(7)
s_add_u32 m0, s76, 37888
ds_read_b128 a[28:31], v3 offset:6144
v_mfma_f32_16x16x32_bf16 v[28:31], a[72:75], a[32:35], v[28:31]
s_add_u32 s64, s73, 17536
ds_read_b64_tr_b16 a[104:105], v10 offset:0
v_mfma_f32_16x16x32_bf16 v[28:31], a[76:79], a[36:39], v[28:31]
s_add_u32 s65, s79, 26624
buffer_load_dwordx4 v13, s[48:51], s64 offen lds
v_mfma_f32_16x16x32_bf16 v[44:47], a[76:79], a[44:47], v[44:47]
buffer_store_dwordx4 a[204:207], v16, s[44:47], s65 offen sc1
v_mfma_f32_16x16x32_bf16 v[44:47], a[72:75], a[40:43], v[44:47]
ds_read_b64_tr_b16 a[106:107], v10 offset:1024
v_mfma_f32_16x16x32_bf16 v[60:63], a[72:75], a[48:51], v[60:63]
s_add_u32 m0, s76, 38912
ds_read_b64_tr_b16 a[108:109], v10 offset:8192
v_mfma_f32_16x16x32_bf16 v[60:63], a[76:79], a[52:55], v[60:63]
s_add_u32 s64, s73, 132224
ds_read_b64_tr_b16 a[110:111], v10 offset:9216
v_mfma_f32_16x16x32_bf16 v[76:79], a[76:79], a[60:63], v[76:79]
buffer_load_dwordx4 v12, s[48:51], s64 offen lds
v_mfma_f32_16x16x32_bf16 v[76:79], a[72:75], a[56:59], v[76:79]
ds_read_b64_tr_b16 a[112:113], v11 offset:0
v_mfma_f32_16x16x32_bf16 v[140:143], a[80:83], a[56:59], v[140:143]
ds_read_b64_tr_b16 a[114:115], v11 offset:1024
v_mfma_f32_16x16x32_bf16 v[140:143], a[84:87], a[60:63], v[140:143]
s_add_u32 m0, s76, 39936
ds_read_b64_tr_b16 a[116:117], v11 offset:8192
v_mfma_f32_16x16x32_bf16 v[124:127], a[84:87], a[52:55], v[124:127]
s_add_u32 s64, s73, 148608
ds_read_b64_tr_b16 a[118:119], v11 offset:9216
v_mfma_f32_16x16x32_bf16 v[124:127], a[80:83], a[48:51], v[124:127]
buffer_load_dwordx4 v13, s[48:51], s64 offen lds
v_mfma_f32_16x16x32_bf16 v[108:111], a[80:83], a[40:43], v[108:111]
v_mfma_f32_16x16x32_bf16 v[108:111], a[84:87], a[44:47], v[108:111]
v_mfma_f32_16x16x32_bf16 v[92:95], a[84:87], a[36:39], v[92:95]
v_mfma_f32_16x16x32_bf16 v[92:95], a[80:83], a[32:35], v[92:95]
v_mfma_f32_16x16x32_bf16 v[32:35], a[88:91], a[32:35], v[32:35]
v_mfma_f32_16x16x32_bf16 v[32:35], a[92:95], a[36:39], v[32:35]
v_mfma_f32_16x16x32_bf16 v[48:51], a[92:95], a[44:47], v[48:51]
s_waitcnt lgkmcnt(0)
s_barrier
v_mfma_f32_16x16x32_bf16 v[48:51], a[88:91], a[40:43], v[48:51]
s_add_u32 m0, s77, 65536
ds_read_b64_tr_b16 a[72:73], v19 offset:36864
v_mfma_f32_16x16x32_bf16 v[64:67], a[88:91], a[48:51], v[64:67]
s_add_u32 s64, s71, 5242880
ds_read_b64_tr_b16 a[74:75], v19 offset:37120
v_mfma_f32_16x16x32_bf16 v[64:67], a[92:95], a[52:55], v[64:67]
buffer_load_dwordx4 v14, s[56:59], s64 offen lds
v_mfma_f32_16x16x32_bf16 v[80:83], a[92:95], a[60:63], v[80:83]
ds_read_b64_tr_b16 a[76:77], v19 offset:38912
v_mfma_f32_16x16x32_bf16 v[80:83], a[88:91], a[56:59], v[80:83]
ds_read_b64_tr_b16 a[78:79], v19 offset:39168
v_mfma_f32_16x16x32_bf16 v[144:147], a[96:99], a[56:59], v[144:147]
ds_read_b64_tr_b16 a[80:81], v20 offset:36864
v_mfma_f32_16x16x32_bf16 v[144:147], a[100:103], a[60:63], v[144:147]
ds_read_b64_tr_b16 a[82:83], v20 offset:37120
v_mfma_f32_16x16x32_bf16 v[128:131], a[100:103], a[52:55], v[128:131]
ds_read_b64_tr_b16 a[84:85], v20 offset:38912
v_mfma_f32_16x16x32_bf16 v[128:131], a[96:99], a[48:51], v[128:131]
ds_read_b64_tr_b16 a[86:87], v20 offset:39168
v_mfma_f32_16x16x32_bf16 v[112:115], a[96:99], a[40:43], v[112:115]
s_add_u32 m0, s78, 81920
ds_read_b64_tr_b16 a[88:89], v19 offset:40960
v_mfma_f32_16x16x32_bf16 v[112:115], a[100:103], a[44:47], v[112:115]
s_add_u32 s64, s75, 3932160
ds_read_b64_tr_b16 a[90:91], v19 offset:41216
v_mfma_f32_16x16x32_bf16 v[96:99], a[100:103], a[36:39], v[96:99]
buffer_load_dwordx4 v23, s[60:63], s64 offen lds
v_mfma_f32_16x16x32_bf16 v[96:99], a[96:99], a[32:35], v[96:99]
ds_read_b64_tr_b16 a[92:93], v19 offset:43008
v_mfma_f32_16x16x32_bf16 v[36:39], a[104:107], a[32:35], v[36:39]
ds_read_b64_tr_b16 a[94:95], v19 offset:43264
v_mfma_f32_16x16x32_bf16 v[36:39], a[108:111], a[36:39], v[36:39]
ds_read_b64_tr_b16 a[96:97], v20 offset:40960
v_mfma_f32_16x16x32_bf16 v[52:55], a[108:111], a[44:47], v[52:55]
ds_read_b64_tr_b16 a[98:99], v20 offset:41216
v_mfma_f32_16x16x32_bf16 v[52:55], a[104:107], a[40:43], v[52:55]
ds_read_b64_tr_b16 a[100:101], v20 offset:43008
v_mfma_f32_16x16x32_bf16 v[68:71], a[104:107], a[48:51], v[68:71]
ds_read_b64_tr_b16 a[102:103], v20 offset:43264
v_mfma_f32_16x16x32_bf16 v[68:71], a[108:111], a[52:55], v[68:71]
s_add_u32 m0, s77, 66560
v_mfma_f32_16x16x32_bf16 v[84:87], a[108:111], a[60:63], v[84:87]
s_add_u32 s64, s71, 5275648
v_mfma_f32_16x16x32_bf16 v[84:87], a[104:107], a[56:59], v[84:87]
buffer_load_dwordx4 v14, s[56:59], s64 offen lds
v_mfma_f32_16x16x32_bf16 v[148:151], a[112:115], a[56:59], v[148:151]
ds_read_b64_tr_b16 a[104:105], v19 offset:32768
v_mfma_f32_16x16x32_bf16 v[148:151], a[116:119], a[60:63], v[148:151]
ds_read_b64_tr_b16 a[106:107], v19 offset:33024
v_mfma_f32_16x16x32_bf16 v[132:135], a[116:119], a[52:55], v[132:135]
ds_read_b64_tr_b16 a[108:109], v19 offset:34816
v_mfma_f32_16x16x32_bf16 v[132:135], a[112:115], a[48:51], v[132:135]
ds_read_b64_tr_b16 a[110:111], v19 offset:35072
v_mfma_f32_16x16x32_bf16 v[116:119], a[112:115], a[40:43], v[116:119]
v_mfma_f32_16x16x32_bf16 v[116:119], a[116:119], a[44:47], v[116:119]
v_mfma_f32_16x16x32_bf16 v[100:103], a[116:119], a[36:39], v[100:103]
s_add_u32 m0, s78, 86016
v_mfma_f32_16x16x32_bf16 v[100:103], a[112:115], a[32:35], v[100:103]
s_waitcnt lgkmcnt(4)
s_add_u32 s64, s75, 3934208
ds_read_b64_tr_b16 a[112:113], v20 offset:32768
v_mfma_f32_16x16x32_bf16 v[184:187], a[72:75], a[0:3], v[184:187]
buffer_load_dwordx4 v23, s[60:63], s64 offen lds
v_mfma_f32_16x16x32_bf16 v[184:187], a[76:79], a[4:7], v[184:187]
s_add_u32 s65, s79, 27648
ds_read_b64_tr_b16 a[114:115], v20 offset:33024
v_mfma_f32_16x16x32_bf16 v[192:195], a[76:79], a[12:15], v[192:195]
buffer_store_dwordx4 a[208:211], v16, s[44:47], s65 offen sc1
v_mfma_f32_16x16x32_bf16 v[192:195], a[72:75], a[8:11], v[192:195]
s_add_u32 s17, s78, .-L_pc+6144
ds_read_b64_tr_b16 a[116:117], v20 offset:34816
v_mfma_f32_16x16x32_bf16 v[200:203], a[72:75], a[16:19], v[200:203]
buffer_load_dword a252, v16, s[88:91], s17 offen
v_mfma_f32_16x16x32_bf16 v[200:203], a[76:79], a[20:23], v[200:203]
ds_read_b64_tr_b16 a[118:119], v20 offset:35072
v_mfma_f32_16x16x32_bf16 v[208:211], a[76:79], a[28:31], v[208:211]
v_mfma_f32_16x16x32_bf16 v[208:211], a[72:75], a[24:27], v[208:211]
ds_read_b64_tr_b16 a[72:73], v4 offset:32768
v_mfma_f32_16x16x32_bf16 v[212:215], a[80:83], a[24:27], v[212:215]
s_add_u32 m0, s77, 67584
ds_read_b64_tr_b16 a[74:75], v4 offset:33792
v_mfma_f32_16x16x32_bf16 v[212:215], a[84:87], a[28:31], v[212:215]
s_add_u32 s64, s71, 5308416
ds_read_b64_tr_b16 a[76:77], v4 offset:40960
v_mfma_f32_16x16x32_bf16 v[204:207], a[84:87], a[20:23], v[204:207]
buffer_load_dwordx4 v15, s[56:59], s64 offen lds
v_mfma_f32_16x16x32_bf16 v[204:207], a[80:83], a[16:19], v[204:207]
ds_read_b64_tr_b16 a[78:79], v4 offset:41984
v_mfma_f32_16x16x32_bf16 v[196:199], a[80:83], a[8:11], v[196:199]
v_mfma_f32_16x16x32_bf16 v[196:199], a[84:87], a[12:15], v[196:199]
v_mfma_f32_16x16x32_bf16 v[188:191], a[84:87], a[4:7], v[188:191]
v_mfma_f32_16x16x32_bf16 v[188:191], a[80:83], a[0:3], v[188:191]
ds_read_b64_tr_b16 a[80:81], v5 offset:32768
v_mfma_f32_16x16x32_bf16 v[216:219], a[0:3], a[88:91], v[216:219]
ds_read_b64_tr_b16 a[82:83], v5 offset:33792
v_mfma_f32_16x16x32_bf16 v[216:219], a[4:7], a[92:95], v[216:219]
s_add_u32 m0, s78, 90112
ds_read_b64_tr_b16 a[84:85], v5 offset:40960
v_mfma_f32_16x16x32_bf16 v[224:227], a[12:15], a[92:95], v[224:227]
s_add_u32 s64, s75, 3936256
ds_read_b64_tr_b16 a[86:87], v5 offset:41984
v_mfma_f32_16x16x32_bf16 v[224:227], a[8:11], a[88:91], v[224:227]
buffer_load_dwordx4 v23, s[60:63], s64 offen lds
v_mfma_f32_16x16x32_bf16 v[232:235], a[16:19], a[88:91], v[232:235]
v_mfma_f32_16x16x32_bf16 v[232:235], a[20:23], a[92:95], v[232:235]
v_mfma_f32_16x16x32_bf16 v[240:243], a[28:31], a[92:95], v[240:243]
v_mfma_f32_16x16x32_bf16 v[240:243], a[24:27], a[88:91], v[240:243]
ds_read_b64_tr_b16 a[88:89], v6 offset:32768
v_mfma_f32_16x16x32_bf16 v[244:247], a[24:27], a[96:99], v[244:247]
ds_read_b64_tr_b16 a[90:91], v6 offset:33792
v_mfma_f32_16x16x32_bf16 v[244:247], a[28:31], a[100:103], v[244:247]
ds_read_b64_tr_b16 a[92:93], v6 offset:40960
v_add_u32 v19, 0x8000, v19
v_mfma_f32_16x16x32_bf16 v[236:239], a[20:23], a[100:103], v[236:239]
s_add_u32 m0, s77, 68608
ds_read_b64_tr_b16 a[94:95], v6 offset:41984
v_mfma_f32_16x16x32_bf16 v[236:239], a[16:19], a[96:99], v[236:239]
s_add_u32 s64, s71, 5341184
v_mfma_f32_16x16x32_bf16 v[228:231], a[8:11], a[96:99], v[228:231]
buffer_load_dwordx4 v15, s[56:59], s64 offen lds
v_mfma_f32_16x16x32_bf16 v[228:231], a[12:15], a[100:103], v[228:231]
v_mfma_f32_16x16x32_bf16 v[220:223], a[4:7], a[100:103], v[220:223]
v_mfma_f32_16x16x32_bf16 v[220:223], a[0:3], a[96:99], v[220:223]
s_waitcnt lgkmcnt(4)
ds_read_b64_tr_b16 a[96:97], v7 offset:32768
v_mfma_f32_16x16x32_bf16 v[152:155], a[104:107], a[0:3], v[152:155]
ds_read_b64_tr_b16 a[98:99], v7 offset:33792
v_mfma_f32_16x16x32_bf16 v[152:155], a[108:111], a[4:7], v[152:155]
ds_read_b64_tr_b16 a[100:101], v7 offset:40960
v_add_u32 v20, 0x8000, v20
v_mfma_f32_16x16x32_bf16 v[160:163], a[108:111], a[12:15], v[160:163]
ds_read_b64_tr_b16 a[102:103], v7 offset:41984
v_mfma_f32_16x16x32_bf16 v[160:163], a[104:107], a[8:11], v[160:163]
v_mfma_f32_16x16x32_bf16 v[168:171], a[104:107], a[16:19], v[168:171]
v_mfma_f32_16x16x32_bf16 v[168:171], a[108:111], a[20:23], v[168:171]
v_mfma_f32_16x16x32_bf16 v[176:179], a[108:111], a[28:31], v[176:179]
s_add_u32 m0, s76, 0
v_mfma_f32_16x16x32_bf16 v[176:179], a[104:107], a[24:27], v[176:179]
s_add_u32 s64, s72, 1280
ds_read_b64_tr_b16 a[104:105], v8 offset:32768
v_mfma_f32_16x16x32_bf16 v[180:183], a[112:115], a[24:27], v[180:183]
buffer_load_dwordx4 v12, s[48:51], s64 offen lds
v_mfma_f32_16x16x32_bf16 v[180:183], a[116:119], a[28:31], v[180:183]
ds_read_b64_tr_b16 a[106:107], v8 offset:33792
v_add_u32 v4, 0x8000, v4
v_mfma_f32_16x16x32_bf16 v[172:175], a[116:119], a[20:23], v[172:175]
ds_read_b64_tr_b16 a[108:109], v8 offset:40960
v_mfma_f32_16x16x32_bf16 v[172:175], a[112:115], a[16:19], v[172:175]
s_add_u32 m0, s76, 1024
ds_read_b64_tr_b16 a[110:111], v8 offset:41984
v_mfma_f32_16x16x32_bf16 v[164:167], a[112:115], a[8:11], v[164:167]
s_add_u32 s64, s72, 17664
v_mfma_f32_16x16x32_bf16 v[164:167], a[116:119], a[12:15], v[164:167]
buffer_load_dwordx4 v13, s[48:51], s64 offen lds
v_mfma_f32_16x16x32_bf16 v[156:159], a[116:119], a[4:7], v[156:159]
v_mfma_f32_16x16x32_bf16 v[156:159], a[112:115], a[0:3], v[156:159]
ds_read_b64_tr_b16 a[112:113], v9 offset:32768
v_mfma_f32_16x16x32_bf16 v[24:27], a[72:75], a[0:3], v[24:27]
s_add_u32 m0, s76, 2048
ds_read_b64_tr_b16 a[114:115], v9 offset:33792
v_mfma_f32_16x16x32_bf16 v[24:27], a[76:79], a[4:7], v[24:27]
s_add_u32 s64, s72, 132352
ds_read_b64_tr_b16 a[116:117], v9 offset:40960
v_add_u32 v5, 0x8000, v5
v_mfma_f32_16x16x32_bf16 v[40:43], a[76:79], a[12:15], v[40:43]
buffer_load_dwordx4 v12, s[48:51], s64 offen lds
v_mfma_f32_16x16x32_bf16 v[40:43], a[72:75], a[8:11], v[40:43]
s_add_u32 s65, s79, 11264
ds_read_b64_tr_b16 a[118:119], v9 offset:41984
v_mfma_f32_16x16x32_bf16 v[56:59], a[72:75], a[16:19], v[56:59]
buffer_store_dwordx4 a[212:215], v16, s[44:47], s65 offen sc1
v_mfma_f32_16x16x32_bf16 v[56:59], a[76:79], a[20:23], v[56:59]
s_add_u32 m0, s76, 3072
v_mfma_f32_16x16x32_bf16 v[72:75], a[76:79], a[28:31], v[72:75]
s_waitcnt vmcnt(13)
s_add_u32 s64, s72, 148736
ds_read_b128 a[32:35], v2 offset:32768
v_mfma_f32_16x16x32_bf16 v[72:75], a[72:75], a[24:27], v[72:75]
buffer_load_dwordx4 v13, s[48:51], s64 offen lds
v_mfma_f32_16x16x32_bf16 v[136:139], a[80:83], a[24:27], v[136:139]
ds_read_b128 a[36:39], v3 offset:32768
v_mfma_f32_16x16x32_bf16 v[136:139], a[84:87], a[28:31], v[136:139]
ds_read_b128 a[40:43], v2 offset:34816
v_add_u32 v6, 0x8000, v6
v_mfma_f32_16x16x32_bf16 v[120:123], a[84:87], a[20:23], v[120:123]
s_add_u32 m0, s76, 4096
ds_read_b128 a[44:47], v3 offset:34816
v_mfma_f32_16x16x32_bf16 v[120:123], a[80:83], a[16:19], v[120:123]
s_add_u32 s64, s73, 1280
ds_read_b128 a[48:51], v2 offset:36864
v_mfma_f32_16x16x32_bf16 v[104:107], a[80:83], a[8:11], v[104:107]
buffer_load_dwordx4 v12, s[48:51], s64 offen lds
v_mfma_f32_16x16x32_bf16 v[104:107], a[84:87], a[12:15], v[104:107]
ds_read_b128 a[52:55], v3 offset:36864
v_mfma_f32_16x16x32_bf16 v[88:91], a[84:87], a[4:7], v[88:91]
ds_read_b128 a[56:59], v2 offset:38912
v_mfma_f32_16x16x32_bf16 v[88:91], a[80:83], a[0:3], v[88:91]
s_waitcnt lgkmcnt(7)
s_add_u32 m0, s76, 5120
ds_read_b128 a[60:63], v3 offset:38912
v_mfma_f32_16x16x32_bf16 v[28:31], a[88:91], a[0:3], v[28:31]
s_add_u32 s64, s73, 17664
ds_read_b64_tr_b16 a[72:73], v10 offset:32768
v_mfma_f32_16x16x32_bf16 v[28:31], a[92:95], a[4:7], v[28:31]
buffer_load_dwordx4 v13, s[48:51], s64 offen lds
v_mfma_f32_16x16x32_bf16 v[44:47], a[92:95], a[12:15], v[44:47]
ds_read_b64_tr_b16 a[74:75], v10 offset:33792
v_add_u32 v7, 0x8000, v7
v_mfma_f32_16x16x32_bf16 v[44:47], a[88:91], a[8:11], v[44:47]
ds_read_b64_tr_b16 a[76:77], v10 offset:40960
v_mfma_f32_16x16x32_bf16 v[60:63], a[88:91], a[16:19], v[60:63]
s_add_u32 m0, s76, 6144
ds_read_b64_tr_b16 a[78:79], v10 offset:41984
v_mfma_f32_16x16x32_bf16 v[60:63], a[92:95], a[20:23], v[60:63]
s_add_u32 s64, s73, 132352
ds_read_b64_tr_b16 a[80:81], v11 offset:32768
v_mfma_f32_16x16x32_bf16 v[76:79], a[92:95], a[28:31], v[76:79]
buffer_load_dwordx4 v12, s[48:51], s64 offen lds
v_mfma_f32_16x16x32_bf16 v[76:79], a[88:91], a[24:27], v[76:79]
ds_read_b64_tr_b16 a[82:83], v11 offset:33792
v_mfma_f32_16x16x32_bf16 v[140:143], a[96:99], a[24:27], v[140:143]
ds_read_b64_tr_b16 a[84:85], v11 offset:40960
v_mfma_f32_16x16x32_bf16 v[140:143], a[100:103], a[28:31], v[140:143]
s_add_u32 m0, s76, 7168
ds_read_b64_tr_b16 a[86:87], v11 offset:41984
v_add_u32 v8, 0x8000, v8
v_mfma_f32_16x16x32_bf16 v[124:127], a[100:103], a[20:23], v[124:127]
s_add_u32 s64, s73, 148736
v_mfma_f32_16x16x32_bf16 v[124:127], a[96:99], a[16:19], v[124:127]
buffer_load_dwordx4 v13, s[48:51], s64 offen lds
v_mfma_f32_16x16x32_bf16 v[108:111], a[96:99], a[8:11], v[108:111]
v_mfma_f32_16x16x32_bf16 v[108:111], a[100:103], a[12:15], v[108:111]
v_mfma_f32_16x16x32_bf16 v[92:95], a[100:103], a[4:7], v[92:95]
v_add_u32 v9, 0x8000, v9
v_add_u32 v10, 0x8000, v10
v_mfma_f32_16x16x32_bf16 v[92:95], a[96:99], a[0:3], v[92:95]
v_add_u32 v11, 0x8000, v11
v_mfma_f32_16x16x32_bf16 v[32:35], a[104:107], a[0:3], v[32:35]
v_mfma_f32_16x16x32_bf16 v[32:35], a[108:111], a[4:7], v[32:35]
v_mfma_f32_16x16x32_bf16 v[48:51], a[108:111], a[12:15], v[48:51]
s_waitcnt lgkmcnt(0)
s_barrier
v_mfma_f32_16x16x32_bf16 v[48:51], a[104:107], a[8:11], v[48:51]
s_add_u32 m0, s77, 98304
ds_read_b64_tr_b16 a[88:89], v19 offset:36864
v_mfma_f32_16x16x32_bf16 v[64:67], a[104:107], a[16:19], v[64:67]
s_add_u32 s64, s71, 5767168
ds_read_b64_tr_b16 a[90:91], v19 offset:37120
v_mfma_f32_16x16x32_bf16 v[64:67], a[108:111], a[20:23], v[64:67]
buffer_load_dwordx4 v14, s[56:59], s64 offen lds
v_mfma_f32_16x16x32_bf16 v[80:83], a[108:111], a[28:31], v[80:83]
ds_read_b64_tr_b16 a[92:93], v19 offset:38912
v_mfma_f32_16x16x32_bf16 v[80:83], a[104:107], a[24:27], v[80:83]
ds_read_b64_tr_b16 a[94:95], v19 offset:39168
v_mfma_f32_16x16x32_bf16 v[144:147], a[112:115], a[24:27], v[144:147]
ds_read_b64_tr_b16 a[96:97], v20 offset:36864
v_mfma_f32_16x16x32_bf16 v[144:147], a[116:119], a[28:31], v[144:147]
ds_read_b64_tr_b16 a[98:99], v20 offset:37120
v_mfma_f32_16x16x32_bf16 v[128:131], a[116:119], a[20:23], v[128:131]
ds_read_b64_tr_b16 a[100:101], v20 offset:38912
v_mfma_f32_16x16x32_bf16 v[128:131], a[112:115], a[16:19], v[128:131]
ds_read_b64_tr_b16 a[102:103], v20 offset:39168
v_mfma_f32_16x16x32_bf16 v[112:115], a[112:115], a[8:11], v[112:115]
s_add_u32 m0, s78, 114688
ds_read_b64_tr_b16 a[104:105], v19 offset:40960
v_mfma_f32_16x16x32_bf16 v[112:115], a[116:119], a[12:15], v[112:115]
s_add_u32 s64, s75, 4325376
ds_read_b64_tr_b16 a[106:107], v19 offset:41216
v_mfma_f32_16x16x32_bf16 v[96:99], a[116:119], a[4:7], v[96:99]
buffer_load_dwordx4 v23, s[60:63], s64 offen lds
v_mfma_f32_16x16x32_bf16 v[96:99], a[112:115], a[0:3], v[96:99]
ds_read_b64_tr_b16 a[108:109], v19 offset:43008
v_mfma_f32_16x16x32_bf16 v[36:39], a[72:75], a[0:3], v[36:39]
ds_read_b64_tr_b16 a[110:111], v19 offset:43264
v_mfma_f32_16x16x32_bf16 v[36:39], a[76:79], a[4:7], v[36:39]
ds_read_b64_tr_b16 a[112:113], v20 offset:40960
v_mfma_f32_16x16x32_bf16 v[52:55], a[76:79], a[12:15], v[52:55]
ds_read_b64_tr_b16 a[114:115], v20 offset:41216
v_mfma_f32_16x16x32_bf16 v[52:55], a[72:75], a[8:11], v[52:55]
ds_read_b64_tr_b16 a[116:117], v20 offset:43008
v_mfma_f32_16x16x32_bf16 v[68:71], a[72:75], a[16:19], v[68:71]
s_add_u32 s65, s79, 28672
ds_read_b64_tr_b16 a[118:119], v20 offset:43264
v_mfma_f32_16x16x32_bf16 v[68:71], a[76:79], a[20:23], v[68:71]
s_add_u32 m0, s77, 99328
buffer_store_dwordx4 a[216:219], v16, s[44:47], s65 offen sc1
v_mfma_f32_16x16x32_bf16 v[84:87], a[76:79], a[28:31], v[84:87]
s_add_u32 s64, s71, 5799936
v_mfma_f32_16x16x32_bf16 v[84:87], a[72:75], a[24:27], v[84:87]
buffer_load_dwordx4 v14, s[56:59], s64 offen lds
v_mfma_f32_16x16x32_bf16 v[148:151], a[80:83], a[24:27], v[148:151]
ds_read_b64_tr_b16 a[72:73], v19 offset:32768
v_mfma_f32_16x16x32_bf16 v[148:151], a[84:87], a[28:31], v[148:151]
ds_read_b64_tr_b16 a[74:75], v19 offset:33024
v_mfma_f32_16x16x32_bf16 v[132:135], a[84:87], a[20:23], v[132:135]
ds_read_b64_tr_b16 a[76:77], v19 offset:34816
v_mfma_f32_16x16x32_bf16 v[132:135], a[80:83], a[16:19], v[132:135]
ds_read_b64_tr_b16 a[78:79], v19 offset:35072
v_mfma_f32_16x16x32_bf16 v[116:119], a[80:83], a[8:11], v[116:119]
v_mfma_f32_16x16x32_bf16 v[116:119], a[84:87], a[12:15], v[116:119]
v_mfma_f32_16x16x32_bf16 v[100:103], a[84:87], a[4:7], v[100:103]
s_add_u32 m0, s78, 118784
v_mfma_f32_16x16x32_bf16 v[100:103], a[80:83], a[0:3], v[100:103]
s_waitcnt lgkmcnt(4)
s_add_u32 s64, s75, 4327424
ds_read_b64_tr_b16 a[80:81], v20 offset:32768
v_mfma_f32_16x16x32_bf16 v[184:187], a[88:91], a[32:35], v[184:187]
buffer_load_dwordx4 v23, s[60:63], s64 offen lds
v_mfma_f32_16x16x32_bf16 v[184:187], a[92:95], a[36:39], v[184:187]
ds_read_b64_tr_b16 a[82:83], v20 offset:33024
v_mfma_f32_16x16x32_bf16 v[192:195], a[92:95], a[44:47], v[192:195]
ds_read_b64_tr_b16 a[84:85], v20 offset:34816
v_mfma_f32_16x16x32_bf16 v[192:195], a[88:91], a[40:43], v[192:195]
ds_read_b64_tr_b16 a[86:87], v20 offset:35072
v_mfma_f32_16x16x32_bf16 v[200:203], a[88:91], a[48:51], v[200:203]
s_cmp_eq_u32 s30, 0
s_cselect_b32 s81, 256, 0
v_mfma_f32_16x16x32_bf16 v[200:203], a[92:95], a[52:55], v[200:203]
v_mfma_f32_16x16x32_bf16 v[208:211], a[92:95], a[60:63], v[208:211]
v_mfma_f32_16x16x32_bf16 v[208:211], a[88:91], a[56:59], v[208:211]
ds_read_b64_tr_b16 a[88:89], v4 offset:32768
v_mfma_f32_16x16x32_bf16 v[212:215], a[96:99], a[56:59], v[212:215]
s_add_u32 m0, s77, 100352
ds_read_b64_tr_b16 a[90:91], v4 offset:33792
v_mfma_f32_16x16x32_bf16 v[212:215], a[100:103], a[60:63], v[212:215]
s_add_u32 s64, s71, 5832704
ds_read_b64_tr_b16 a[92:93], v4 offset:40960
v_mfma_f32_16x16x32_bf16 v[204:207], a[100:103], a[52:55], v[204:207]
buffer_load_dwordx4 v15, s[56:59], s64 offen lds
v_mfma_f32_16x16x32_bf16 v[204:207], a[96:99], a[48:51], v[204:207]
ds_read_b64_tr_b16 a[94:95], v4 offset:41984
v_mfma_f32_16x16x32_bf16 v[196:199], a[96:99], a[40:43], v[196:199]
v_mfma_f32_16x16x32_bf16 v[196:199], a[100:103], a[44:47], v[196:199]
v_mfma_f32_16x16x32_bf16 v[188:191], a[100:103], a[36:39], v[188:191]
v_mfma_f32_16x16x32_bf16 v[188:191], a[96:99], a[32:35], v[188:191]
ds_read_b64_tr_b16 a[96:97], v5 offset:32768
v_mfma_f32_16x16x32_bf16 v[216:219], a[32:35], a[104:107], v[216:219]
ds_read_b64_tr_b16 a[98:99], v5 offset:33792
v_mfma_f32_16x16x32_bf16 v[216:219], a[36:39], a[108:111], v[216:219]
s_add_u32 m0, s78, 122880
ds_read_b64_tr_b16 a[100:101], v5 offset:40960
v_mfma_f32_16x16x32_bf16 v[224:227], a[44:47], a[108:111], v[224:227]
s_add_u32 s64, s75, 4329472
ds_read_b64_tr_b16 a[102:103], v5 offset:41984
v_mfma_f32_16x16x32_bf16 v[224:227], a[40:43], a[104:107], v[224:227]
buffer_load_dwordx4 v23, s[60:63], s64 offen lds
v_mfma_f32_16x16x32_bf16 v[232:235], a[48:51], a[104:107], v[232:235]
v_mfma_f32_16x16x32_bf16 v[232:235], a[52:55], a[108:111], v[232:235]
v_mfma_f32_16x16x32_bf16 v[240:243], a[60:63], a[108:111], v[240:243]
v_mfma_f32_16x16x32_bf16 v[240:243], a[56:59], a[104:107], v[240:243]
ds_read_b64_tr_b16 a[104:105], v6 offset:32768
v_mfma_f32_16x16x32_bf16 v[244:247], a[56:59], a[112:115], v[244:247]
ds_read_b64_tr_b16 a[106:107], v6 offset:33792
v_mfma_f32_16x16x32_bf16 v[244:247], a[60:63], a[116:119], v[244:247]
ds_read_b64_tr_b16 a[108:109], v6 offset:40960
v_subrev_u32 v19, 0x8000, v19
v_mfma_f32_16x16x32_bf16 v[236:239], a[52:55], a[116:119], v[236:239]
s_add_u32 m0, s77, 101376
ds_read_b64_tr_b16 a[110:111], v6 offset:41984
v_mfma_f32_16x16x32_bf16 v[236:239], a[48:51], a[112:115], v[236:239]
s_add_u32 s64, s71, 5865472
v_mfma_f32_16x16x32_bf16 v[228:231], a[40:43], a[112:115], v[228:231]
buffer_load_dwordx4 v15, s[56:59], s64 offen lds
v_mfma_f32_16x16x32_bf16 v[228:231], a[44:47], a[116:119], v[228:231]
v_mfma_f32_16x16x32_bf16 v[220:223], a[36:39], a[116:119], v[220:223]
v_mfma_f32_16x16x32_bf16 v[220:223], a[32:35], a[112:115], v[220:223]
s_waitcnt lgkmcnt(4)
ds_read_b64_tr_b16 a[112:113], v7 offset:32768
v_mfma_f32_16x16x32_bf16 v[152:155], a[72:75], a[32:35], v[152:155]
ds_read_b64_tr_b16 a[114:115], v7 offset:33792
v_mfma_f32_16x16x32_bf16 v[152:155], a[76:79], a[36:39], v[152:155]
ds_read_b64_tr_b16 a[116:117], v7 offset:40960
v_subrev_u32 v20, 0x8000, v20
v_mfma_f32_16x16x32_bf16 v[160:163], a[76:79], a[44:47], v[160:163]
ds_read_b64_tr_b16 a[118:119], v7 offset:41984
v_mfma_f32_16x16x32_bf16 v[160:163], a[72:75], a[40:43], v[160:163]
v_mfma_f32_16x16x32_bf16 v[168:171], a[72:75], a[48:51], v[168:171]
v_mfma_f32_16x16x32_bf16 v[168:171], a[76:79], a[52:55], v[168:171]
s_add_u32 s65, s79, 29696
v_mfma_f32_16x16x32_bf16 v[176:179], a[76:79], a[60:63], v[176:179]
s_add_u32 m0, s76, 32768
buffer_store_dwordx4 a[220:223], v16, s[44:47], s65 offen sc1
v_mfma_f32_16x16x32_bf16 v[176:179], a[72:75], a[56:59], v[176:179]
s_add_u32 s64, s72, 1408
ds_read_b64_tr_b16 a[72:73], v8 offset:32768
v_mfma_f32_16x16x32_bf16 v[180:183], a[80:83], a[56:59], v[180:183]
buffer_load_dwordx4 v12, s[48:51], s64 offen lds
v_mfma_f32_16x16x32_bf16 v[180:183], a[84:87], a[60:63], v[180:183]
ds_read_b64_tr_b16 a[74:75], v8 offset:33792
v_subrev_u32 v4, 0x8000, v4
v_mfma_f32_16x16x32_bf16 v[172:175], a[84:87], a[52:55], v[172:175]
ds_read_b64_tr_b16 a[76:77], v8 offset:40960
v_mfma_f32_16x16x32_bf16 v[172:175], a[80:83], a[48:51], v[172:175]
s_add_u32 m0, s76, 33792
ds_read_b64_tr_b16 a[78:79], v8 offset:41984
v_mfma_f32_16x16x32_bf16 v[164:167], a[80:83], a[40:43], v[164:167]
s_add_u32 s64, s72, 17792
v_mfma_f32_16x16x32_bf16 v[164:167], a[84:87], a[44:47], v[164:167]
buffer_load_dwordx4 v13, s[48:51], s64 offen lds
v_mfma_f32_16x16x32_bf16 v[156:159], a[84:87], a[36:39], v[156:159]
v_mfma_f32_16x16x32_bf16 v[156:159], a[80:83], a[32:35], v[156:159]
ds_read_b64_tr_b16 a[80:81], v9 offset:32768
v_mfma_f32_16x16x32_bf16 v[24:27], a[88:91], a[32:35], v[24:27]
s_add_u32 m0, s76, 34816
ds_read_b64_tr_b16 a[82:83], v9 offset:33792
v_mfma_f32_16x16x32_bf16 v[24:27], a[92:95], a[36:39], v[24:27]
s_add_u32 s64, s72, 132480
ds_read_b64_tr_b16 a[84:85], v9 offset:40960
v_subrev_u32 v5, 0x8000, v5
v_mfma_f32_16x16x32_bf16 v[40:43], a[92:95], a[44:47], v[40:43]
buffer_load_dwordx4 v12, s[48:51], s64 offen lds
v_mfma_f32_16x16x32_bf16 v[40:43], a[88:91], a[40:43], v[40:43]
ds_read_b64_tr_b16 a[86:87], v9 offset:41984
v_mfma_f32_16x16x32_bf16 v[56:59], a[88:91], a[48:51], v[56:59]
v_mfma_f32_16x16x32_bf16 v[56:59], a[92:95], a[52:55], v[56:59]
s_add_u32 m0, s76, 35840
v_mfma_f32_16x16x32_bf16 v[72:75], a[92:95], a[60:63], v[72:75]
s_waitcnt vmcnt(12)
s_add_u32 s64, s72, 148864
ds_read_b128 a[0:3], v2 offset:0
v_mfma_f32_16x16x32_bf16 v[72:75], a[88:91], a[56:59], v[72:75]
buffer_load_dwordx4 v13, s[48:51], s64 offen lds
v_mfma_f32_16x16x32_bf16 v[136:139], a[96:99], a[56:59], v[136:139]
ds_read_b128 a[4:7], v3 offset:0
v_mfma_f32_16x16x32_bf16 v[136:139], a[100:103], a[60:63], v[136:139]
ds_read_b128 a[8:11], v2 offset:2048
v_subrev_u32 v6, 0x8000, v6
v_mfma_f32_16x16x32_bf16 v[120:123], a[100:103], a[52:55], v[120:123]
s_add_u32 m0, s76, 36864
ds_read_b128 a[12:15], v3 offset:2048
v_mfma_f32_16x16x32_bf16 v[120:123], a[96:99], a[48:51], v[120:123]
s_add_u32 s64, s73, 1408
ds_read_b128 a[16:19], v2 offset:4096
v_mfma_f32_16x16x32_bf16 v[104:107], a[96:99], a[40:43], v[104:107]
buffer_load_dwordx4 v12, s[48:51], s64 offen lds
v_mfma_f32_16x16x32_bf16 v[104:107], a[100:103], a[44:47], v[104:107]
ds_read_b128 a[20:23], v3 offset:4096
v_mfma_f32_16x16x32_bf16 v[88:91], a[100:103], a[36:39], v[88:91]
ds_read_b128 a[24:27], v2 offset:6144
v_mfma_f32_16x16x32_bf16 v[88:91], a[96:99], a[32:35], v[88:91]
s_waitcnt lgkmcnt(7)
s_add_u32 m0, s76, 37888
ds_read_b128 a[28:31], v3 offset:6144
v_mfma_f32_16x16x32_bf16 v[28:31], a[104:107], a[32:35], v[28:31]
s_add_u32 s64, s73, 17792
ds_read_b64_tr_b16 a[88:89], v10 offset:32768
v_mfma_f32_16x16x32_bf16 v[28:31], a[108:111], a[36:39], v[28:31]
buffer_load_dwordx4 v13, s[48:51], s64 offen lds
v_mfma_f32_16x16x32_bf16 v[44:47], a[108:111], a[44:47], v[44:47]
ds_read_b64_tr_b16 a[90:91], v10 offset:33792
v_subrev_u32 v7, 0x8000, v7
v_mfma_f32_16x16x32_bf16 v[44:47], a[104:107], a[40:43], v[44:47]
ds_read_b64_tr_b16 a[92:93], v10 offset:40960
v_mfma_f32_16x16x32_bf16 v[60:63], a[104:107], a[48:51], v[60:63]
s_add_u32 m0, s76, 38912
buffer_load_dword v1, off, s[52:55], s78 sc1
v_mfma_f32_16x16x32_bf16 v[60:63], a[108:111], a[52:55], v[60:63]
s_add_u32 s64, s73, 132480
ds_read_b64_tr_b16 a[94:95], v10 offset:41984
v_mfma_f32_16x16x32_bf16 v[76:79], a[108:111], a[60:63], v[76:79]
buffer_load_dwordx4 v12, s[48:51], s64 offen lds
v_mfma_f32_16x16x32_bf16 v[76:79], a[104:107], a[56:59], v[76:79]
ds_read_b64_tr_b16 a[96:97], v11 offset:32768
v_mfma_f32_16x16x32_bf16 v[140:143], a[112:115], a[56:59], v[140:143]
ds_read_b64_tr_b16 a[98:99], v11 offset:33792
v_mfma_f32_16x16x32_bf16 v[140:143], a[116:119], a[60:63], v[140:143]
s_add_u32 m0, s76, 39936
ds_read_b64_tr_b16 a[100:101], v11 offset:40960
v_subrev_u32 v8, 0x8000, v8
v_mfma_f32_16x16x32_bf16 v[124:127], a[116:119], a[52:55], v[124:127]
s_add_u32 s64, s73, 148864
ds_read_b64_tr_b16 a[102:103], v11 offset:41984
v_mfma_f32_16x16x32_bf16 v[124:127], a[112:115], a[48:51], v[124:127]
buffer_load_dwordx4 v13, s[48:51], s64 offen lds
v_mfma_f32_16x16x32_bf16 v[108:111], a[112:115], a[40:43], v[108:111]
v_mfma_f32_16x16x32_bf16 v[108:111], a[116:119], a[44:47], v[108:111]
v_mfma_f32_16x16x32_bf16 v[92:95], a[116:119], a[36:39], v[92:95]
v_subrev_u32 v9, 0x8000, v9
v_subrev_u32 v10, 0x8000, v10
v_mfma_f32_16x16x32_bf16 v[92:95], a[112:115], a[32:35], v[92:95]
v_subrev_u32 v11, 0x8000, v11
v_mfma_f32_16x16x32_bf16 v[32:35], a[72:75], a[32:35], v[32:35]
v_mfma_f32_16x16x32_bf16 v[32:35], a[76:79], a[36:39], v[32:35]
v_mfma_f32_16x16x32_bf16 v[48:51], a[76:79], a[44:47], v[48:51]
s_waitcnt lgkmcnt(0)
s_barrier
v_mfma_f32_16x16x32_bf16 v[48:51], a[72:75], a[40:43], v[48:51]
s_add_u32 m0, s77, 131072
ds_read_b64_tr_b16 a[104:105], v19 offset:4096
v_mfma_f32_16x16x32_bf16 v[64:67], a[72:75], a[48:51], v[64:67]
s_add_u32 s64, s71, 6291456
ds_read_b64_tr_b16 a[106:107], v19 offset:4352
v_mfma_f32_16x16x32_bf16 v[64:67], a[76:79], a[52:55], v[64:67]
buffer_load_dwordx4 v14, s[56:59], s64 offen lds
v_mfma_f32_16x16x32_bf16 v[80:83], a[76:79], a[60:63], v[80:83]
ds_read_b64_tr_b16 a[108:109], v19 offset:6144
v_mfma_f32_16x16x32_bf16 v[80:83], a[72:75], a[56:59], v[80:83]
s_add_u32 s65, s79, 13312
ds_read_b64_tr_b16 a[110:111], v19 offset:6400
v_mfma_f32_16x16x32_bf16 v[144:147], a[80:83], a[56:59], v[144:147]
buffer_store_dwordx4 a[224:227], v16, s[44:47], s65 offen sc1
v_mfma_f32_16x16x32_bf16 v[144:147], a[84:87], a[60:63], v[144:147]
ds_read_b64_tr_b16 a[112:113], v20 offset:4096
v_mfma_f32_16x16x32_bf16 v[128:131], a[84:87], a[52:55], v[128:131]
ds_read_b64_tr_b16 a[114:115], v20 offset:4352
v_mfma_f32_16x16x32_bf16 v[128:131], a[80:83], a[48:51], v[128:131]
ds_read_b64_tr_b16 a[116:117], v20 offset:6144
v_mfma_f32_16x16x32_bf16 v[112:115], a[80:83], a[40:43], v[112:115]
s_add_u32 m0, s78, 147456
ds_read_b64_tr_b16 a[118:119], v20 offset:6400
v_mfma_f32_16x16x32_bf16 v[112:115], a[84:87], a[44:47], v[112:115]
s_add_u32 s64, s75, 4718592
ds_read_b64_tr_b16 a[72:73], v19 offset:8192
v_mfma_f32_16x16x32_bf16 v[96:99], a[84:87], a[36:39], v[96:99]
buffer_load_dwordx4 v23, s[60:63], s64 offen lds
v_mfma_f32_16x16x32_bf16 v[96:99], a[80:83], a[32:35], v[96:99]
ds_read_b64_tr_b16 a[74:75], v19 offset:8448
v_mfma_f32_16x16x32_bf16 v[36:39], a[88:91], a[32:35], v[36:39]
ds_read_b64_tr_b16 a[76:77], v19 offset:10240
v_mfma_f32_16x16x32_bf16 v[36:39], a[92:95], a[36:39], v[36:39]
ds_read_b64_tr_b16 a[78:79], v19 offset:10496
v_mfma_f32_16x16x32_bf16 v[52:55], a[92:95], a[44:47], v[52:55]
ds_read_b64_tr_b16 a[80:81], v20 offset:8192
v_mfma_f32_16x16x32_bf16 v[52:55], a[88:91], a[40:43], v[52:55]
ds_read_b64_tr_b16 a[82:83], v20 offset:8448
v_mfma_f32_16x16x32_bf16 v[68:71], a[88:91], a[48:51], v[68:71]
ds_read_b64_tr_b16 a[84:85], v20 offset:10240
v_mfma_f32_16x16x32_bf16 v[68:71], a[92:95], a[52:55], v[68:71]
s_add_u32 m0, s77, 132096
ds_read_b64_tr_b16 a[86:87], v20 offset:10496
v_mfma_f32_16x16x32_bf16 v[84:87], a[92:95], a[60:63], v[84:87]
s_add_u32 s64, s71, 6324224
v_mfma_f32_16x16x32_bf16 v[84:87], a[88:91], a[56:59], v[84:87]
buffer_load_dwordx4 v14, s[56:59], s64 offen lds
v_mfma_f32_16x16x32_bf16 v[148:151], a[96:99], a[56:59], v[148:151]
ds_read_b64_tr_b16 a[88:89], v19 offset:0
v_mfma_f32_16x16x32_bf16 v[148:151], a[100:103], a[60:63], v[148:151]
ds_read_b64_tr_b16 a[90:91], v19 offset:256
v_mfma_f32_16x16x32_bf16 v[132:135], a[100:103], a[52:55], v[132:135]
ds_read_b64_tr_b16 a[92:93], v19 offset:2048
v_mfma_f32_16x16x32_bf16 v[132:135], a[96:99], a[48:51], v[132:135]
ds_read_b64_tr_b16 a[94:95], v19 offset:2304
v_mfma_f32_16x16x32_bf16 v[116:119], a[96:99], a[40:43], v[116:119]
v_mfma_f32_16x16x32_bf16 v[116:119], a[100:103], a[44:47], v[116:119]
v_mfma_f32_16x16x32_bf16 v[100:103], a[100:103], a[36:39], v[100:103]
s_add_u32 m0, s78, 151552
v_mfma_f32_16x16x32_bf16 v[100:103], a[96:99], a[32:35], v[100:103]
s_waitcnt lgkmcnt(4)
s_add_u32 s64, s75, 4720640
ds_read_b64_tr_b16 a[96:97], v20 offset:0
v_mfma_f32_16x16x32_bf16 v[184:187], a[104:107], a[0:3], v[184:187]
buffer_load_dwordx4 v23, s[60:63], s64 offen lds
v_mfma_f32_16x16x32_bf16 v[184:187], a[108:111], a[4:7], v[184:187]
ds_read_b64_tr_b16 a[98:99], v20 offset:256
v_mfma_f32_16x16x32_bf16 v[192:195], a[108:111], a[12:15], v[192:195]
ds_read_b64_tr_b16 a[100:101], v20 offset:2048
v_mfma_f32_16x16x32_bf16 v[192:195], a[104:107], a[8:11], v[192:195]
s_add_u32 s17, s78, .-L_pc+6144
ds_read_b64_tr_b16 a[102:103], v20 offset:2304
v_mfma_f32_16x16x32_bf16 v[200:203], a[104:107], a[16:19], v[200:203]
buffer_load_dword a252, v16, s[88:91], s17 offen
v_mfma_f32_16x16x32_bf16 v[200:203], a[108:111], a[20:23], v[200:203]
v_mfma_f32_16x16x32_bf16 v[208:211], a[108:111], a[28:31], v[208:211]
v_mfma_f32_16x16x32_bf16 v[208:211], a[104:107], a[24:27], v[208:211]
ds_read_b64_tr_b16 a[104:105], v4 offset:0
v_mfma_f32_16x16x32_bf16 v[212:215], a[112:115], a[24:27], v[212:215]
s_add_u32 m0, s77, 133120
ds_read_b64_tr_b16 a[106:107], v4 offset:1024
v_mfma_f32_16x16x32_bf16 v[212:215], a[116:119], a[28:31], v[212:215]
s_add_u32 s64, s71, 6356992
ds_read_b64_tr_b16 a[108:109], v4 offset:8192
v_mfma_f32_16x16x32_bf16 v[204:207], a[116:119], a[20:23], v[204:207]
buffer_load_dwordx4 v15, s[56:59], s64 offen lds
v_mfma_f32_16x16x32_bf16 v[204:207], a[112:115], a[16:19], v[204:207]
ds_read_b64_tr_b16 a[110:111], v4 offset:9216
v_mfma_f32_16x16x32_bf16 v[196:199], a[112:115], a[8:11], v[196:199]
v_mfma_f32_16x16x32_bf16 v[196:199], a[116:119], a[12:15], v[196:199]
v_mfma_f32_16x16x32_bf16 v[188:191], a[116:119], a[4:7], v[188:191]
v_mfma_f32_16x16x32_bf16 v[188:191], a[112:115], a[0:3], v[188:191]
ds_read_b64_tr_b16 a[112:113], v5 offset:0
v_mfma_f32_16x16x32_bf16 v[216:219], a[0:3], a[72:75], v[216:219]
ds_read_b64_tr_b16 a[114:115], v5 offset:1024
v_mfma_f32_16x16x32_bf16 v[216:219], a[4:7], a[76:79], v[216:219]
s_add_u32 m0, s78, 155648
ds_read_b64_tr_b16 a[116:117], v5 offset:8192
v_mfma_f32_16x16x32_bf16 v[224:227], a[12:15], a[76:79], v[224:227]
s_add_u32 s64, s75, 4722688
ds_read_b64_tr_b16 a[118:119], v5 offset:9216
v_mfma_f32_16x16x32_bf16 v[224:227], a[8:11], a[72:75], v[224:227]
buffer_load_dwordx4 v23, s[60:63], s64 offen lds
v_mfma_f32_16x16x32_bf16 v[232:235], a[16:19], a[72:75], v[232:235]
v_mfma_f32_16x16x32_bf16 v[232:235], a[20:23], a[76:79], v[232:235]
v_mfma_f32_16x16x32_bf16 v[240:243], a[28:31], a[76:79], v[240:243]
v_mfma_f32_16x16x32_bf16 v[240:243], a[24:27], a[72:75], v[240:243]
ds_read_b64_tr_b16 a[72:73], v6 offset:0
v_mfma_f32_16x16x32_bf16 v[244:247], a[24:27], a[80:83], v[244:247]
s_add_u32 s65, s79, 30720
ds_read_b64_tr_b16 a[74:75], v6 offset:1024
v_mfma_f32_16x16x32_bf16 v[244:247], a[28:31], a[84:87], v[244:247]
buffer_store_dwordx4 a[228:231], v16, s[44:47], s65 offen sc1
v_mfma_f32_16x16x32_bf16 v[236:239], a[20:23], a[84:87], v[236:239]
s_add_u32 m0, s77, 134144
ds_read_b64_tr_b16 a[76:77], v6 offset:8192
v_mfma_f32_16x16x32_bf16 v[236:239], a[16:19], a[80:83], v[236:239]
s_add_u32 s64, s71, 6389760
ds_read_b64_tr_b16 a[78:79], v6 offset:9216
v_mfma_f32_16x16x32_bf16 v[228:231], a[8:11], a[80:83], v[228:231]
buffer_load_dwordx4 v15, s[56:59], s64 offen lds
v_mfma_f32_16x16x32_bf16 v[228:231], a[12:15], a[84:87], v[228:231]
v_mfma_f32_16x16x32_bf16 v[220:223], a[4:7], a[84:87], v[220:223]
v_mfma_f32_16x16x32_bf16 v[220:223], a[0:3], a[80:83], v[220:223]
s_waitcnt lgkmcnt(4)
ds_read_b64_tr_b16 a[80:81], v7 offset:0
v_mfma_f32_16x16x32_bf16 v[152:155], a[88:91], a[0:3], v[152:155]
ds_read_b64_tr_b16 a[82:83], v7 offset:1024
v_mfma_f32_16x16x32_bf16 v[152:155], a[92:95], a[4:7], v[152:155]
ds_read_b64_tr_b16 a[84:85], v7 offset:8192
v_mfma_f32_16x16x32_bf16 v[160:163], a[92:95], a[12:15], v[160:163]
ds_read_b64_tr_b16 a[86:87], v7 offset:9216
v_mfma_f32_16x16x32_bf16 v[160:163], a[88:91], a[8:11], v[160:163]
v_mfma_f32_16x16x32_bf16 v[168:171], a[88:91], a[16:19], v[168:171]
v_mfma_f32_16x16x32_bf16 v[168:171], a[92:95], a[20:23], v[168:171]
v_mfma_f32_16x16x32_bf16 v[176:179], a[92:95], a[28:31], v[176:179]
s_add_u32 m0, s76, 0
v_mfma_f32_16x16x32_bf16 v[176:179], a[88:91], a[24:27], v[176:179]
s_add_u32 s64, s72, 1536
ds_read_b64_tr_b16 a[88:89], v8 offset:0
v_mfma_f32_16x16x32_bf16 v[180:183], a[96:99], a[24:27], v[180:183]
buffer_load_dwordx4 v12, s[48:51], s64 offen lds
v_mfma_f32_16x16x32_bf16 v[180:183], a[100:103], a[28:31], v[180:183]
ds_read_b64_tr_b16 a[90:91], v8 offset:1024
v_mfma_f32_16x16x32_bf16 v[172:175], a[100:103], a[20:23], v[172:175]
ds_read_b64_tr_b16 a[92:93], v8 offset:8192
v_mfma_f32_16x16x32_bf16 v[172:175], a[96:99], a[16:19], v[172:175]
s_add_u32 m0, s76, 1024
ds_read_b64_tr_b16 a[94:95], v8 offset:9216
v_mfma_f32_16x16x32_bf16 v[164:167], a[96:99], a[8:11], v[164:167]
s_add_u32 s64, s72, 17920
v_mfma_f32_16x16x32_bf16 v[164:167], a[100:103], a[12:15], v[164:167]
buffer_load_dwordx4 v13, s[48:51], s64 offen lds
v_mfma_f32_16x16x32_bf16 v[156:159], a[100:103], a[4:7], v[156:159]
v_mfma_f32_16x16x32_bf16 v[156:159], a[96:99], a[0:3], v[156:159]
ds_read_b64_tr_b16 a[96:97], v9 offset:0
v_mfma_f32_16x16x32_bf16 v[24:27], a[104:107], a[0:3], v[24:27]
s_add_u32 m0, s76, 2048
ds_read_b64_tr_b16 a[98:99], v9 offset:1024
v_mfma_f32_16x16x32_bf16 v[24:27], a[108:111], a[4:7], v[24:27]
s_add_u32 s64, s72, 132608
ds_read_b64_tr_b16 a[100:101], v9 offset:8192
v_mfma_f32_16x16x32_bf16 v[40:43], a[108:111], a[12:15], v[40:43]
buffer_load_dwordx4 v12, s[48:51], s64 offen lds
v_mfma_f32_16x16x32_bf16 v[40:43], a[104:107], a[8:11], v[40:43]
ds_read_b64_tr_b16 a[102:103], v9 offset:9216
v_mfma_f32_16x16x32_bf16 v[56:59], a[104:107], a[16:19], v[56:59]
v_mfma_f32_16x16x32_bf16 v[56:59], a[108:111], a[20:23], v[56:59]
s_add_u32 m0, s76, 3072
v_mfma_f32_16x16x32_bf16 v[72:75], a[108:111], a[28:31], v[72:75]
s_waitcnt vmcnt(13)
s_add_u32 s64, s72, 148992
ds_read_b128 a[32:35], v2 offset:32768
v_mfma_f32_16x16x32_bf16 v[72:75], a[104:107], a[24:27], v[72:75]
buffer_load_dwordx4 v13, s[48:51], s64 offen lds
v_mfma_f32_16x16x32_bf16 v[136:139], a[112:115], a[24:27], v[136:139]
ds_read_b128 a[36:39], v3 offset:32768
v_mfma_f32_16x16x32_bf16 v[136:139], a[116:119], a[28:31], v[136:139]
ds_read_b128 a[40:43], v2 offset:34816
v_mfma_f32_16x16x32_bf16 v[120:123], a[116:119], a[20:23], v[120:123]
s_add_u32 m0, s76, 4096
ds_read_b128 a[44:47], v3 offset:34816
v_mfma_f32_16x16x32_bf16 v[120:123], a[112:115], a[16:19], v[120:123]
s_add_u32 s64, s73, 1536
ds_read_b128 a[48:51], v2 offset:36864
v_mfma_f32_16x16x32_bf16 v[104:107], a[112:115], a[8:11], v[104:107]
buffer_load_dwordx4 v12, s[48:51], s64 offen lds
v_mfma_f32_16x16x32_bf16 v[104:107], a[116:119], a[12:15], v[104:107]
ds_read_b128 a[52:55], v3 offset:36864
v_mfma_f32_16x16x32_bf16 v[88:91], a[116:119], a[4:7], v[88:91]
ds_read_b128 a[56:59], v2 offset:38912
v_mfma_f32_16x16x32_bf16 v[88:91], a[112:115], a[0:3], v[88:91]
s_waitcnt lgkmcnt(7)
s_add_u32 m0, s76, 5120
ds_read_b128 a[60:63], v3 offset:38912
v_mfma_f32_16x16x32_bf16 v[28:31], a[72:75], a[0:3], v[28:31]
s_add_u32 s64, s73, 17920
ds_read_b64_tr_b16 a[104:105], v10 offset:0
v_mfma_f32_16x16x32_bf16 v[28:31], a[76:79], a[4:7], v[28:31]
buffer_load_dwordx4 v13, s[48:51], s64 offen lds
v_mfma_f32_16x16x32_bf16 v[44:47], a[76:79], a[12:15], v[44:47]
ds_read_b64_tr_b16 a[106:107], v10 offset:1024
v_mfma_f32_16x16x32_bf16 v[44:47], a[72:75], a[8:11], v[44:47]
ds_read_b64_tr_b16 a[108:109], v10 offset:8192
v_mfma_f32_16x16x32_bf16 v[60:63], a[72:75], a[16:19], v[60:63]
s_add_u32 m0, s76, 6144
ds_read_b64_tr_b16 a[110:111], v10 offset:9216
v_mfma_f32_16x16x32_bf16 v[60:63], a[76:79], a[20:23], v[60:63]
s_add_u32 s64, s73, 132608
ds_read_b64_tr_b16 a[112:113], v11 offset:0
v_mfma_f32_16x16x32_bf16 v[76:79], a[76:79], a[28:31], v[76:79]
buffer_load_dwordx4 v12, s[48:51], s64 offen lds
v_mfma_f32_16x16x32_bf16 v[76:79], a[72:75], a[24:27], v[76:79]
ds_read_b64_tr_b16 a[114:115], v11 offset:1024
v_mfma_f32_16x16x32_bf16 v[140:143], a[80:83], a[24:27], v[140:143]
s_add_u32 m0, s76, 7168
ds_read_b64_tr_b16 a[116:117], v11 offset:8192
v_mfma_f32_16x16x32_bf16 v[140:143], a[84:87], a[28:31], v[140:143]
s_add_u32 s64, s73, 148992
ds_read_b64_tr_b16 a[118:119], v11 offset:9216
v_mfma_f32_16x16x32_bf16 v[124:127], a[84:87], a[20:23], v[124:127]
v_readfirstlane_b32 vcc_lo, v1
s_nop 0
s_cmp_lt_u32 vcc_lo, s81
s_cbranch_scc1 L_spin_1
L_spinbk_2:
v_mfma_f32_16x16x32_bf16 v[124:127], a[80:83], a[16:19], v[124:127]
s_add_u32 s65, s79, 31744
buffer_load_dwordx4 v13, s[48:51], s64 offen lds
v_mfma_f32_16x16x32_bf16 v[108:111], a[80:83], a[8:11], v[108:111]
buffer_store_dwordx4 a[232:235], v16, s[44:47], s65 offen sc1
v_mfma_f32_16x16x32_bf16 v[108:111], a[84:87], a[12:15], v[108:111]
v_mfma_f32_16x16x32_bf16 v[92:95], a[84:87], a[4:7], v[92:95]
s_add_u32 s52, s28, 59768832
s_addc_u32 s53, s29, 0
s_mov_b32 s54, 16384
v_mfma_f32_16x16x32_bf16 v[92:95], a[80:83], a[0:3], v[92:95]
v_mfma_f32_16x16x32_bf16 v[32:35], a[88:91], a[0:3], v[32:35]
v_mfma_f32_16x16x32_bf16 v[32:35], a[92:95], a[4:7], v[32:35]
v_mfma_f32_16x16x32_bf16 v[48:51], a[92:95], a[12:15], v[48:51]
s_waitcnt lgkmcnt(0)
s_barrier
v_mfma_f32_16x16x32_bf16 v[48:51], a[88:91], a[8:11], v[48:51]
s_add_u32 m0, s77, 65536
ds_read_b64_tr_b16 a[72:73], v19 offset:36864
v_mfma_f32_16x16x32_bf16 v[64:67], a[88:91], a[16:19], v[64:67]
s_add_u32 s64, s71, 6815744
ds_read_b64_tr_b16 a[74:75], v19 offset:37120
v_mfma_f32_16x16x32_bf16 v[64:67], a[92:95], a[20:23], v[64:67]
buffer_load_dwordx4 v14, s[56:59], s64 offen lds
v_mfma_f32_16x16x32_bf16 v[80:83], a[92:95], a[28:31], v[80:83]
ds_read_b64_tr_b16 a[76:77], v19 offset:38912
v_mfma_f32_16x16x32_bf16 v[80:83], a[88:91], a[24:27], v[80:83]
ds_read_b64_tr_b16 a[78:79], v19 offset:39168
v_mfma_f32_16x16x32_bf16 v[144:147], a[96:99], a[24:27], v[144:147]
ds_read_b64_tr_b16 a[80:81], v20 offset:36864
v_mfma_f32_16x16x32_bf16 v[144:147], a[100:103], a[28:31], v[144:147]
ds_read_b64_tr_b16 a[82:83], v20 offset:37120
v_mfma_f32_16x16x32_bf16 v[128:131], a[100:103], a[20:23], v[128:131]
ds_read_b64_tr_b16 a[84:85], v20 offset:38912
v_mfma_f32_16x16x32_bf16 v[128:131], a[96:99], a[16:19], v[128:131]
ds_read_b64_tr_b16 a[86:87], v20 offset:39168
v_mfma_f32_16x16x32_bf16 v[112:115], a[96:99], a[8:11], v[112:115]
s_add_u32 m0, s78, 81920
ds_read_b64_tr_b16 a[88:89], v19 offset:40960
v_mfma_f32_16x16x32_bf16 v[112:115], a[100:103], a[12:15], v[112:115]
s_add_u32 s64, s75, 5111808
ds_read_b64_tr_b16 a[90:91], v19 offset:41216
v_mfma_f32_16x16x32_bf16 v[96:99], a[100:103], a[4:7], v[96:99]
buffer_load_dwordx4 v23, s[60:63], s64 offen lds
v_mfma_f32_16x16x32_bf16 v[96:99], a[96:99], a[0:3], v[96:99]
ds_read_b64_tr_b16 a[92:93], v19 offset:43008
v_mfma_f32_16x16x32_bf16 v[36:39], a[104:107], a[0:3], v[36:39]
ds_read_b64_tr_b16 a[94:95], v19 offset:43264
v_mfma_f32_16x16x32_bf16 v[36:39], a[108:111], a[4:7], v[36:39]
ds_read_b64_tr_b16 a[96:97], v20 offset:40960
v_mfma_f32_16x16x32_bf16 v[52:55], a[108:111], a[12:15], v[52:55]
ds_read_b64_tr_b16 a[98:99], v20 offset:41216
v_mfma_f32_16x16x32_bf16 v[52:55], a[104:107], a[8:11], v[52:55]
ds_read_b64_tr_b16 a[100:101], v20 offset:43008
v_mfma_f32_16x16x32_bf16 v[68:71], a[104:107], a[16:19], v[68:71]
ds_read_b64_tr_b16 a[102:103], v20 offset:43264
v_mfma_f32_16x16x32_bf16 v[68:71], a[108:111], a[20:23], v[68:71]
s_add_u32 m0, s77, 66560
v_mfma_f32_16x16x32_bf16 v[84:87], a[108:111], a[28:31], v[84:87]
s_add_u32 s64, s71, 6848512
v_mfma_f32_16x16x32_bf16 v[84:87], a[104:107], a[24:27], v[84:87]
buffer_load_dwordx4 v14, s[56:59], s64 offen lds
v_mfma_f32_16x16x32_bf16 v[148:151], a[112:115], a[24:27], v[148:151]
ds_read_b64_tr_b16 a[104:105], v19 offset:32768
v_mfma_f32_16x16x32_bf16 v[148:151], a[116:119], a[28:31], v[148:151]
ds_read_b64_tr_b16 a[106:107], v19 offset:33024
v_mfma_f32_16x16x32_bf16 v[132:135], a[116:119], a[20:23], v[132:135]
ds_read_b64_tr_b16 a[108:109], v19 offset:34816
v_mfma_f32_16x16x32_bf16 v[132:135], a[112:115], a[16:19], v[132:135]
ds_read_b64_tr_b16 a[110:111], v19 offset:35072
v_mfma_f32_16x16x32_bf16 v[116:119], a[112:115], a[8:11], v[116:119]
v_mfma_f32_16x16x32_bf16 v[116:119], a[116:119], a[12:15], v[116:119]
v_mfma_f32_16x16x32_bf16 v[100:103], a[116:119], a[4:7], v[100:103]
s_add_u32 m0, s78, 86016
v_mfma_f32_16x16x32_bf16 v[100:103], a[112:115], a[0:3], v[100:103]
s_waitcnt lgkmcnt(4)
s_add_u32 s64, s75, 5113856
ds_read_b64_tr_b16 a[112:113], v20 offset:32768
v_mfma_f32_16x16x32_bf16 v[184:187], a[72:75], a[32:35], v[184:187]
buffer_load_dwordx4 v23, s[60:63], s64 offen lds
v_mfma_f32_16x16x32_bf16 v[184:187], a[76:79], a[36:39], v[184:187]
ds_read_b64_tr_b16 a[114:115], v20 offset:33024
v_mfma_f32_16x16x32_bf16 v[192:195], a[76:79], a[44:47], v[192:195]
ds_read_b64_tr_b16 a[116:117], v20 offset:34816
v_mfma_f32_16x16x32_bf16 v[192:195], a[72:75], a[40:43], v[192:195]
ds_read_b64_tr_b16 a[118:119], v20 offset:35072
v_mfma_f32_16x16x32_bf16 v[200:203], a[72:75], a[48:51], v[200:203]
v_mfma_f32_16x16x32_bf16 v[200:203], a[76:79], a[52:55], v[200:203]
v_mfma_f32_16x16x32_bf16 v[208:211], a[76:79], a[60:63], v[208:211]
v_mfma_f32_16x16x32_bf16 v[208:211], a[72:75], a[56:59], v[208:211]
ds_read_b64_tr_b16 a[72:73], v4 offset:32768
v_mfma_f32_16x16x32_bf16 v[212:215], a[80:83], a[56:59], v[212:215]
s_add_u32 m0, s77, 67584
ds_read_b64_tr_b16 a[74:75], v4 offset:33792
v_mfma_f32_16x16x32_bf16 v[212:215], a[84:87], a[60:63], v[212:215]
s_add_u32 s64, s71, 6881280
ds_read_b64_tr_b16 a[76:77], v4 offset:40960
v_mfma_f32_16x16x32_bf16 v[204:207], a[84:87], a[52:55], v[204:207]
buffer_load_dwordx4 v15, s[56:59], s64 offen lds
v_mfma_f32_16x16x32_bf16 v[204:207], a[80:83], a[48:51], v[204:207]
s_add_u32 s65, s79, 15360
ds_read_b64_tr_b16 a[78:79], v4 offset:41984
v_mfma_f32_16x16x32_bf16 v[196:199], a[80:83], a[40:43], v[196:199]
buffer_store_dwordx4 a[236:239], v16, s[44:47], s65 offen sc1
v_mfma_f32_16x16x32_bf16 v[196:199], a[84:87], a[44:47], v[196:199]
v_mfma_f32_16x16x32_bf16 v[188:191], a[84:87], a[36:39], v[188:191]
v_mfma_f32_16x16x32_bf16 v[188:191], a[80:83], a[32:35], v[188:191]
ds_read_b64_tr_b16 a[80:81], v5 offset:32768
v_mfma_f32_16x16x32_bf16 v[216:219], a[32:35], a[88:91], v[216:219]
ds_read_b64_tr_b16 a[82:83], v5 offset:33792
v_mfma_f32_16x16x32_bf16 v[216:219], a[36:39], a[92:95], v[216:219]
s_add_u32 m0, s78, 90112
ds_read_b64_tr_b16 a[84:85], v5 offset:40960
v_mfma_f32_16x16x32_bf16 v[224:227], a[44:47], a[92:95], v[224:227]
s_add_u32 s64, s75, 5115904
ds_read_b64_tr_b16 a[86:87], v5 offset:41984
v_mfma_f32_16x16x32_bf16 v[224:227], a[40:43], a[88:91], v[224:227]
buffer_load_dwordx4 v23, s[60:63], s64 offen lds
v_mfma_f32_16x16x32_bf16 v[232:235], a[48:51], a[88:91], v[232:235]
v_mfma_f32_16x16x32_bf16 v[232:235], a[52:55], a[92:95], v[232:235]
v_mfma_f32_16x16x32_bf16 v[240:243], a[60:63], a[92:95], v[240:243]
v_mfma_f32_16x16x32_bf16 v[240:243], a[56:59], a[88:91], v[240:243]
ds_read_b64_tr_b16 a[88:89], v6 offset:32768
v_mfma_f32_16x16x32_bf16 v[244:247], a[56:59], a[96:99], v[244:247]
ds_read_b64_tr_b16 a[90:91], v6 offset:33792
v_mfma_f32_16x16x32_bf16 v[244:247], a[60:63], a[100:103], v[244:247]
ds_read_b64_tr_b16 a[92:93], v6 offset:40960
v_add_u32 v19, 0x8000, v19
v_mfma_f32_16x16x32_bf16 v[236:239], a[52:55], a[100:103], v[236:239]
s_add_u32 m0, s77, 68608
ds_read_b64_tr_b16 a[94:95], v6 offset:41984
v_mfma_f32_16x16x32_bf16 v[236:239], a[48:51], a[96:99], v[236:239]
s_add_u32 s64, s71, 6914048
v_mfma_f32_16x16x32_bf16 v[228:231], a[40:43], a[96:99], v[228:231]
buffer_load_dwordx4 v15, s[56:59], s64 offen lds
v_mfma_f32_16x16x32_bf16 v[228:231], a[44:47], a[100:103], v[228:231]
v_mfma_f32_16x16x32_bf16 v[220:223], a[36:39], a[100:103], v[220:223]
v_mfma_f32_16x16x32_bf16 v[220:223], a[32:35], a[96:99], v[220:223]
s_waitcnt lgkmcnt(4)
ds_read_b64_tr_b16 a[96:97], v7 offset:32768
v_mfma_f32_16x16x32_bf16 v[152:155], a[104:107], a[32:35], v[152:155]
ds_read_b64_tr_b16 a[98:99], v7 offset:33792
v_mfma_f32_16x16x32_bf16 v[152:155], a[108:111], a[36:39], v[152:155]
ds_read_b64_tr_b16 a[100:101], v7 offset:40960
v_add_u32 v20, 0x8000, v20
v_mfma_f32_16x16x32_bf16 v[160:163], a[108:111], a[44:47], v[160:163]
ds_read_b64_tr_b16 a[102:103], v7 offset:41984
v_mfma_f32_16x16x32_bf16 v[160:163], a[104:107], a[40:43], v[160:163]
v_mfma_f32_16x16x32_bf16 v[168:171], a[104:107], a[48:51], v[168:171]
v_mfma_f32_16x16x32_bf16 v[168:171], a[108:111], a[52:55], v[168:171]
v_mfma_f32_16x16x32_bf16 v[176:179], a[108:111], a[60:63], v[176:179]
s_add_u32 m0, s76, 32768
v_mfma_f32_16x16x32_bf16 v[176:179], a[104:107], a[56:59], v[176:179]
s_add_u32 s64, s72, 1664
ds_read_b64_tr_b16 a[104:105], v8 offset:32768
v_mfma_f32_16x16x32_bf16 v[180:183], a[112:115], a[56:59], v[180:183]
buffer_load_dwordx4 v12, s[48:51], s64 offen lds
v_mfma_f32_16x16x32_bf16 v[180:183], a[116:119], a[60:63], v[180:183]
ds_read_b64_tr_b16 a[106:107], v8 offset:33792
v_add_u32 v4, 0x8000, v4
v_mfma_f32_16x16x32_bf16 v[172:175], a[116:119], a[52:55], v[172:175]
ds_read_b64_tr_b16 a[108:109], v8 offset:40960
v_mfma_f32_16x16x32_bf16 v[172:175], a[112:115], a[48:51], v[172:175]
s_add_u32 m0, s76, 33792
ds_read_b64_tr_b16 a[110:111], v8 offset:41984
v_mfma_f32_16x16x32_bf16 v[164:167], a[112:115], a[40:43], v[164:167]
s_add_u32 s64, s72, 18048
v_mfma_f32_16x16x32_bf16 v[164:167], a[116:119], a[44:47], v[164:167]
buffer_load_dwordx4 v13, s[48:51], s64 offen lds
v_mfma_f32_16x16x32_bf16 v[156:159], a[116:119], a[36:39], v[156:159]
v_mfma_f32_16x16x32_bf16 v[156:159], a[112:115], a[32:35], v[156:159]
ds_read_b64_tr_b16 a[112:113], v9 offset:32768
v_mfma_f32_16x16x32_bf16 v[24:27], a[72:75], a[32:35], v[24:27]
s_add_u32 m0, s76, 34816
ds_read_b64_tr_b16 a[114:115], v9 offset:33792
v_mfma_f32_16x16x32_bf16 v[24:27], a[76:79], a[36:39], v[24:27]
s_add_u32 s64, s72, 132736
ds_read_b64_tr_b16 a[116:117], v9 offset:40960
v_add_u32 v5, 0x8000, v5
v_mfma_f32_16x16x32_bf16 v[40:43], a[76:79], a[44:47], v[40:43]
buffer_load_dwordx4 v12, s[48:51], s64 offen lds
v_mfma_f32_16x16x32_bf16 v[40:43], a[72:75], a[40:43], v[40:43]
ds_read_b64_tr_b16 a[118:119], v9 offset:41984
v_mfma_f32_16x16x32_bf16 v[56:59], a[72:75], a[48:51], v[56:59]
v_mfma_f32_16x16x32_bf16 v[56:59], a[76:79], a[52:55], v[56:59]
s_add_u32 m0, s76, 35840
v_mfma_f32_16x16x32_bf16 v[72:75], a[76:79], a[60:63], v[72:75]
s_waitcnt vmcnt(12)
s_add_u32 s64, s72, 149120
ds_read_b128 a[0:3], v2 offset:0
v_mfma_f32_16x16x32_bf16 v[72:75], a[72:75], a[56:59], v[72:75]
buffer_load_dwordx4 v13, s[48:51], s64 offen lds
v_mfma_f32_16x16x32_bf16 v[136:139], a[80:83], a[56:59], v[136:139]
ds_read_b128 a[4:7], v3 offset:0
v_mfma_f32_16x16x32_bf16 v[136:139], a[84:87], a[60:63], v[136:139]
ds_read_b128 a[8:11], v2 offset:2048
v_add_u32 v6, 0x8000, v6
v_mfma_f32_16x16x32_bf16 v[120:123], a[84:87], a[52:55], v[120:123]
s_add_u32 m0, s76, 36864
ds_read_b128 a[12:15], v3 offset:2048
v_mfma_f32_16x16x32_bf16 v[120:123], a[80:83], a[48:51], v[120:123]
s_add_u32 s64, s73, 1664
ds_read_b128 a[16:19], v2 offset:4096
v_mfma_f32_16x16x32_bf16 v[104:107], a[80:83], a[40:43], v[104:107]
buffer_load_dwordx4 v12, s[48:51], s64 offen lds
v_mfma_f32_16x16x32_bf16 v[104:107], a[84:87], a[44:47], v[104:107]
ds_read_b128 a[20:23], v3 offset:4096
v_mfma_f32_16x16x32_bf16 v[88:91], a[84:87], a[36:39], v[88:91]
buffer_store_dwordx4 a[240:243], v16, s[44:47], s74 offen sc1
v_mfma_f32_16x16x32_bf16 v[88:91], a[80:83], a[32:35], v[88:91]
s_waitcnt lgkmcnt(6)
s_add_u32 m0, s76, 37888
ds_read_b128 a[24:27], v2 offset:6144
v_mfma_f32_16x16x32_bf16 v[28:31], a[88:91], a[32:35], v[28:31]
s_add_u32 s64, s73, 18048
ds_read_b128 a[28:31], v3 offset:6144
v_mfma_f32_16x16x32_bf16 v[28:31], a[92:95], a[36:39], v[28:31]
buffer_load_dwordx4 v13, s[48:51], s64 offen lds
v_mfma_f32_16x16x32_bf16 v[44:47], a[92:95], a[44:47], v[44:47]
ds_read_b64_tr_b16 a[72:73], v10 offset:32768
v_add_u32 v7, 0x8000, v7
v_mfma_f32_16x16x32_bf16 v[44:47], a[88:91], a[40:43], v[44:47]
ds_read_b64_tr_b16 a[74:75], v10 offset:33792
v_mfma_f32_16x16x32_bf16 v[60:63], a[88:91], a[48:51], v[60:63]
s_add_u32 m0, s76, 38912
ds_read_b64_tr_b16 a[76:77], v10 offset:40960
v_mfma_f32_16x16x32_bf16 v[60:63], a[92:95], a[52:55], v[60:63]
s_add_u32 s64, s73, 132736
ds_read_b64_tr_b16 a[78:79], v10 offset:41984
v_mfma_f32_16x16x32_bf16 v[76:79], a[92:95], a[60:63], v[76:79]
buffer_load_dwordx4 v12, s[48:51], s64 offen lds
v_mfma_f32_16x16x32_bf16 v[76:79], a[88:91], a[56:59], v[76:79]
ds_read_b64_tr_b16 a[80:81], v11 offset:32768
v_mfma_f32_16x16x32_bf16 v[140:143], a[96:99], a[56:59], v[140:143]
ds_read_b64_tr_b16 a[82:83], v11 offset:33792
v_mfma_f32_16x16x32_bf16 v[140:143], a[100:103], a[60:63], v[140:143]
s_add_u32 m0, s76, 39936
ds_read_b64_tr_b16 a[84:85], v11 offset:40960
v_add_u32 v8, 0x8000, v8
v_mfma_f32_16x16x32_bf16 v[124:127], a[100:103], a[52:55], v[124:127]
s_add_u32 s64, s73, 149120
ds_read_b64_tr_b16 a[86:87], v11 offset:41984
v_mfma_f32_16x16x32_bf16 v[124:127], a[96:99], a[48:51], v[124:127]
buffer_load_dwordx4 v13, s[48:51], s64 offen lds
v_mfma_f32_16x16x32_bf16 v[108:111], a[96:99], a[40:43], v[108:111]
v_mfma_f32_16x16x32_bf16 v[108:111], a[100:103], a[44:47], v[108:111]
v_mfma_f32_16x16x32_bf16 v[92:95], a[100:103], a[36:39], v[92:95]
v_add_u32 v9, 0x8000, v9
v_add_u32 v10, 0x8000, v10
v_mfma_f32_16x16x32_bf16 v[92:95], a[96:99], a[32:35], v[92:95]
v_add_u32 v11, 0x8000, v11
v_mfma_f32_16x16x32_bf16 v[32:35], a[104:107], a[32:35], v[32:35]
v_mfma_f32_16x16x32_bf16 v[32:35], a[108:111], a[36:39], v[32:35]
v_mfma_f32_16x16x32_bf16 v[48:51], a[108:111], a[44:47], v[48:51]
s_waitcnt lgkmcnt(0)
s_barrier
v_mfma_f32_16x16x32_bf16 v[48:51], a[104:107], a[40:43], v[48:51]
s_add_u32 m0, s77, 98304
ds_read_b64_tr_b16 a[88:89], v19 offset:36864
v_mfma_f32_16x16x32_bf16 v[64:67], a[104:107], a[48:51], v[64:67]
s_add_u32 s64, s71, 7340032
ds_read_b64_tr_b16 a[90:91], v19 offset:37120
v_mfma_f32_16x16x32_bf16 v[64:67], a[108:111], a[52:55], v[64:67]
buffer_load_dwordx4 v14, s[56:59], s64 offen lds
v_mfma_f32_16x16x32_bf16 v[80:83], a[108:111], a[60:63], v[80:83]
ds_read_b64_tr_b16 a[92:93], v19 offset:38912
v_mfma_f32_16x16x32_bf16 v[80:83], a[104:107], a[56:59], v[80:83]
ds_read_b64_tr_b16 a[94:95], v19 offset:39168
v_mfma_f32_16x16x32_bf16 v[144:147], a[112:115], a[56:59], v[144:147]
ds_read_b64_tr_b16 a[96:97], v20 offset:36864
v_mfma_f32_16x16x32_bf16 v[144:147], a[116:119], a[60:63], v[144:147]
ds_read_b64_tr_b16 a[98:99], v20 offset:37120
v_mfma_f32_16x16x32_bf16 v[128:131], a[116:119], a[52:55], v[128:131]
ds_read_b64_tr_b16 a[100:101], v20 offset:38912
v_mfma_f32_16x16x32_bf16 v[128:131], a[112:115], a[48:51], v[128:131]
ds_read_b64_tr_b16 a[102:103], v20 offset:39168
v_mfma_f32_16x16x32_bf16 v[112:115], a[112:115], a[40:43], v[112:115]
s_add_u32 m0, s78, 114688
ds_read_b64_tr_b16 a[104:105], v19 offset:40960
v_mfma_f32_16x16x32_bf16 v[112:115], a[116:119], a[44:47], v[112:115]
s_add_u32 s64, s75, 5505024
ds_read_b64_tr_b16 a[106:107], v19 offset:41216
v_mfma_f32_16x16x32_bf16 v[96:99], a[116:119], a[36:39], v[96:99]
buffer_load_dwordx4 v23, s[60:63], s64 offen lds
v_mfma_f32_16x16x32_bf16 v[96:99], a[112:115], a[32:35], v[96:99]
ds_read_b64_tr_b16 a[108:109], v19 offset:43008
v_mfma_f32_16x16x32_bf16 v[36:39], a[72:75], a[32:35], v[36:39]
ds_read_b64_tr_b16 a[110:111], v19 offset:43264
v_mfma_f32_16x16x32_bf16 v[36:39], a[76:79], a[36:39], v[36:39]
ds_read_b64_tr_b16 a[112:113], v20 offset:40960
v_mfma_f32_16x16x32_bf16 v[52:55], a[76:79], a[44:47], v[52:55]
ds_read_b64_tr_b16 a[114:115], v20 offset:41216
v_mfma_f32_16x16x32_bf16 v[52:55], a[72:75], a[40:43], v[52:55]
ds_read_b64_tr_b16 a[116:117], v20 offset:43008
v_mfma_f32_16x16x32_bf16 v[68:71], a[72:75], a[48:51], v[68:71]
ds_read_b64_tr_b16 a[118:119], v20 offset:43264
v_mfma_f32_16x16x32_bf16 v[68:71], a[76:79], a[52:55], v[68:71]
s_add_u32 m0, s77, 99328
v_mfma_f32_16x16x32_bf16 v[84:87], a[76:79], a[60:63], v[84:87]
s_add_u32 s64, s71, 7372800
v_mfma_f32_16x16x32_bf16 v[84:87], a[72:75], a[56:59], v[84:87]
buffer_load_dwordx4 v14, s[56:59], s64 offen lds
v_mfma_f32_16x16x32_bf16 v[148:151], a[80:83], a[56:59], v[148:151]
ds_read_b64_tr_b16 a[72:73], v19 offset:32768
v_mfma_f32_16x16x32_bf16 v[148:151], a[84:87], a[60:63], v[148:151]
ds_read_b64_tr_b16 a[74:75], v19 offset:33024
v_mfma_f32_16x16x32_bf16 v[132:135], a[84:87], a[52:55], v[132:135]
ds_read_b64_tr_b16 a[76:77], v19 offset:34816
v_mfma_f32_16x16x32_bf16 v[132:135], a[80:83], a[48:51], v[132:135]
ds_read_b64_tr_b16 a[78:79], v19 offset:35072
v_mfma_f32_16x16x32_bf16 v[116:119], a[80:83], a[40:43], v[116:119]
v_mfma_f32_16x16x32_bf16 v[116:119], a[84:87], a[44:47], v[116:119]
v_mfma_f32_16x16x32_bf16 v[100:103], a[84:87], a[36:39], v[100:103]
s_add_u32 m0, s78, 118784
v_mfma_f32_16x16x32_bf16 v[100:103], a[80:83], a[32:35], v[100:103]
s_waitcnt lgkmcnt(4)
s_add_u32 s64, s75, 5507072
ds_read_b64_tr_b16 a[80:81], v20 offset:32768
v_mfma_f32_16x16x32_bf16 v[184:187], a[88:91], a[0:3], v[184:187]
s_lshl_b32 s66, s30, 30
buffer_load_dwordx4 v23, s[60:63], s64 offen lds
v_mfma_f32_16x16x32_bf16 v[184:187], a[92:95], a[4:7], v[184:187]
ds_read_b64_tr_b16 a[82:83], v20 offset:33024
v_lshl_add_u32 v1, v0, 24, s66
v_mfma_f32_16x16x32_bf16 v[192:195], a[92:95], a[12:15], v[192:195]
s_lshl_b32 s70, s31, 8
ds_read_b64_tr_b16 a[84:85], v20 offset:34816
v_mfma_f32_16x16x32_bf16 v[192:195], a[88:91], a[8:11], v[192:195]
s_add_u32 s17, s78, .-L_pc+6144
ds_read_b64_tr_b16 a[86:87], v20 offset:35072
v_mfma_f32_16x16x32_bf16 v[200:203], a[88:91], a[16:19], v[200:203]
buffer_load_dword a252, v16, s[88:91], s17 offen
v_mfma_f32_16x16x32_bf16 v[200:203], a[92:95], a[20:23], v[200:203]
v_mfma_f32_16x16x32_bf16 v[208:211], a[92:95], a[28:31], v[208:211]
v_mfma_f32_16x16x32_bf16 v[208:211], a[88:91], a[24:27], v[208:211]
ds_read_b64_tr_b16 a[88:89], v4 offset:32768
v_mfma_f32_16x16x32_bf16 v[212:215], a[96:99], a[24:27], v[212:215]
s_add_u32 m0, s77, 100352
ds_read_b64_tr_b16 a[90:91], v4 offset:33792
v_mfma_f32_16x16x32_bf16 v[212:215], a[100:103], a[28:31], v[212:215]
s_add_u32 s64, s71, 7405568
ds_read_b64_tr_b16 a[92:93], v4 offset:40960
v_mfma_f32_16x16x32_bf16 v[204:207], a[100:103], a[20:23], v[204:207]
buffer_load_dwordx4 v15, s[56:59], s64 offen lds
v_mfma_f32_16x16x32_bf16 v[204:207], a[96:99], a[16:19], v[204:207]
ds_read_b64_tr_b16 a[94:95], v4 offset:41984
v_mfma_f32_16x16x32_bf16 v[196:199], a[96:99], a[8:11], v[196:199]
v_mfma_f32_16x16x32_bf16 v[196:199], a[100:103], a[12:15], v[196:199]
v_mfma_f32_16x16x32_bf16 v[188:191], a[100:103], a[4:7], v[188:191]
v_mfma_f32_16x16x32_bf16 v[188:191], a[96:99], a[0:3], v[188:191]
ds_read_b64_tr_b16 a[96:97], v5 offset:32768
v_mfma_f32_16x16x32_bf16 v[216:219], a[0:3], a[104:107], v[216:219]
ds_read_b64_tr_b16 a[98:99], v5 offset:33792
v_mfma_f32_16x16x32_bf16 v[216:219], a[4:7], a[108:111], v[216:219]
s_add_u32 m0, s78, 122880
ds_read_b64_tr_b16 a[100:101], v5 offset:40960
v_mfma_f32_16x16x32_bf16 v[224:227], a[12:15], a[108:111], v[224:227]
s_add_u32 s64, s75, 5509120
ds_read_b64_tr_b16 a[102:103], v5 offset:41984
v_mfma_f32_16x16x32_bf16 v[224:227], a[8:11], a[104:107], v[224:227]
buffer_load_dwordx4 v23, s[60:63], s64 offen lds
v_mfma_f32_16x16x32_bf16 v[232:235], a[16:19], a[104:107], v[232:235]
v_mfma_f32_16x16x32_bf16 v[232:235], a[20:23], a[108:111], v[232:235]
v_mfma_f32_16x16x32_bf16 v[240:243], a[28:31], a[108:111], v[240:243]
v_mfma_f32_16x16x32_bf16 v[240:243], a[24:27], a[104:107], v[240:243]
ds_read_b64_tr_b16 a[104:105], v6 offset:32768
v_mfma_f32_16x16x32_bf16 v[244:247], a[24:27], a[112:115], v[244:247]
ds_read_b64_tr_b16 a[106:107], v6 offset:33792
v_mfma_f32_16x16x32_bf16 v[244:247], a[28:31], a[116:119], v[244:247]
ds_read_b64_tr_b16 a[108:109], v6 offset:40960
v_subrev_u32 v19, 0x8000, v19
v_mfma_f32_16x16x32_bf16 v[236:239], a[20:23], a[116:119], v[236:239]
s_add_u32 m0, s77, 101376
ds_read_b64_tr_b16 a[110:111], v6 offset:41984
v_mfma_f32_16x16x32_bf16 v[236:239], a[16:19], a[112:115], v[236:239]
s_add_u32 s64, s71, 7438336
v_mfma_f32_16x16x32_bf16 v[228:231], a[8:11], a[112:115], v[228:231]
buffer_load_dwordx4 v15, s[56:59], s64 offen lds
v_mfma_f32_16x16x32_bf16 v[228:231], a[12:15], a[116:119], v[228:231]
v_mfma_f32_16x16x32_bf16 v[220:223], a[4:7], a[116:119], v[220:223]
v_mfma_f32_16x16x32_bf16 v[220:223], a[0:3], a[112:115], v[220:223]
s_waitcnt lgkmcnt(4)
ds_read_b64_tr_b16 a[112:113], v7 offset:32768
v_mfma_f32_16x16x32_bf16 v[152:155], a[72:75], a[0:3], v[152:155]
ds_read_b64_tr_b16 a[114:115], v7 offset:33792
v_mfma_f32_16x16x32_bf16 v[152:155], a[76:79], a[4:7], v[152:155]
ds_read_b64_tr_b16 a[116:117], v7 offset:40960
v_subrev_u32 v20, 0x8000, v20
v_mfma_f32_16x16x32_bf16 v[160:163], a[76:79], a[12:15], v[160:163]
ds_read_b64_tr_b16 a[118:119], v7 offset:41984
v_mfma_f32_16x16x32_bf16 v[160:163], a[72:75], a[8:11], v[160:163]
v_mfma_f32_16x16x32_bf16 v[168:171], a[72:75], a[16:19], v[168:171]
v_mfma_f32_16x16x32_bf16 v[168:171], a[76:79], a[20:23], v[168:171]
v_mfma_f32_16x16x32_bf16 v[176:179], a[76:79], a[28:31], v[176:179]
s_add_u32 m0, s76, 0
v_mfma_f32_16x16x32_bf16 v[176:179], a[72:75], a[24:27], v[176:179]
s_add_u32 s64, s72, 1792
ds_read_b64_tr_b16 a[72:73], v8 offset:32768
v_mfma_f32_16x16x32_bf16 v[180:183], a[80:83], a[24:27], v[180:183]
buffer_load_dwordx4 v12, s[48:51], s64 offen lds
v_mfma_f32_16x16x32_bf16 v[180:183], a[84:87], a[28:31], v[180:183]
ds_read_b64_tr_b16 a[74:75], v8 offset:33792
v_subrev_u32 v4, 0x8000, v4
v_mfma_f32_16x16x32_bf16 v[172:175], a[84:87], a[20:23], v[172:175]
ds_read_b64_tr_b16 a[76:77], v8 offset:40960
v_mfma_f32_16x16x32_bf16 v[172:175], a[80:83], a[16:19], v[172:175]
s_add_u32 m0, s76, 1024
ds_read_b64_tr_b16 a[78:79], v8 offset:41984
v_mfma_f32_16x16x32_bf16 v[164:167], a[80:83], a[8:11], v[164:167]
s_add_u32 s64, s72, 18176
v_mfma_f32_16x16x32_bf16 v[164:167], a[84:87], a[12:15], v[164:167]
buffer_load_dwordx4 v13, s[48:51], s64 offen lds
v_mfma_f32_16x16x32_bf16 v[156:159], a[84:87], a[4:7], v[156:159]
v_mfma_f32_16x16x32_bf16 v[156:159], a[80:83], a[0:3], v[156:159]
ds_read_b64_tr_b16 a[80:81], v9 offset:32768
v_mfma_f32_16x16x32_bf16 v[24:27], a[88:91], a[0:3], v[24:27]
s_add_u32 m0, s76, 2048
ds_read_b64_tr_b16 a[82:83], v9 offset:33792
v_mfma_f32_16x16x32_bf16 v[24:27], a[92:95], a[4:7], v[24:27]
s_add_u32 s64, s72, 132864
ds_read_b64_tr_b16 a[84:85], v9 offset:40960
v_subrev_u32 v5, 0x8000, v5
v_mfma_f32_16x16x32_bf16 v[40:43], a[92:95], a[12:15], v[40:43]
buffer_load_dwordx4 v12, s[48:51], s64 offen lds
v_mfma_f32_16x16x32_bf16 v[40:43], a[88:91], a[8:11], v[40:43]
ds_read_b64_tr_b16 a[86:87], v9 offset:41984
v_mfma_f32_16x16x32_bf16 v[56:59], a[88:91], a[16:19], v[56:59]
v_mfma_f32_16x16x32_bf16 v[56:59], a[92:95], a[20:23], v[56:59]
s_add_u32 m0, s76, 3072
v_mfma_f32_16x16x32_bf16 v[72:75], a[92:95], a[28:31], v[72:75]
s_waitcnt vmcnt(11)
s_add_u32 s64, s72, 149248
ds_read_b128 a[32:35], v2 offset:32768
v_mfma_f32_16x16x32_bf16 v[72:75], a[88:91], a[24:27], v[72:75]
buffer_load_dwordx4 v13, s[48:51], s64 offen lds
v_mfma_f32_16x16x32_bf16 v[136:139], a[96:99], a[24:27], v[136:139]
ds_read_b128 a[36:39], v3 offset:32768
v_mfma_f32_16x16x32_bf16 v[136:139], a[100:103], a[28:31], v[136:139]
ds_read_b128 a[40:43], v2 offset:34816
v_subrev_u32 v6, 0x8000, v6
v_mfma_f32_16x16x32_bf16 v[120:123], a[100:103], a[20:23], v[120:123]
s_add_u32 m0, s76, 4096
ds_read_b128 a[44:47], v3 offset:34816
v_mfma_f32_16x16x32_bf16 v[120:123], a[96:99], a[16:19], v[120:123]
s_add_u32 s64, s73, 1792
ds_read_b128 a[48:51], v2 offset:36864
v_mfma_f32_16x16x32_bf16 v[104:107], a[96:99], a[8:11], v[104:107]
buffer_load_dwordx4 v12, s[48:51], s64 offen lds
v_mfma_f32_16x16x32_bf16 v[104:107], a[100:103], a[12:15], v[104:107]
ds_read_b128 a[52:55], v3 offset:36864
v_mfma_f32_16x16x32_bf16 v[88:91], a[100:103], a[4:7], v[88:91]
ds_read_b128 a[56:59], v2 offset:38912
v_mfma_f32_16x16x32_bf16 v[88:91], a[96:99], a[0:3], v[88:91]
s_waitcnt lgkmcnt(7)
s_add_u32 m0, s76, 5120
ds_read_b128 a[60:63], v3 offset:38912
v_mfma_f32_16x16x32_bf16 v[28:31], a[104:107], a[0:3], v[28:31]
s_add_u32 s64, s73, 18176
ds_read_b64_tr_b16 a[88:89], v10 offset:32768
v_mfma_f32_16x16x32_bf16 v[28:31], a[108:111], a[4:7], v[28:31]
buffer_load_dwordx4 v13, s[48:51], s64 offen lds
v_mfma_f32_16x16x32_bf16 v[44:47], a[108:111], a[12:15], v[44:47]
ds_read_b64_tr_b16 a[90:91], v10 offset:33792
v_subrev_u32 v7, 0x8000, v7
v_mfma_f32_16x16x32_bf16 v[44:47], a[104:107], a[8:11], v[44:47]
ds_read_b64_tr_b16 a[92:93], v10 offset:40960
v_mfma_f32_16x16x32_bf16 v[60:63], a[104:107], a[16:19], v[60:63]
s_add_u32 m0, s76, 6144
ds_read_b64_tr_b16 a[94:95], v10 offset:41984
v_mfma_f32_16x16x32_bf16 v[60:63], a[108:111], a[20:23], v[60:63]
s_add_u32 s64, s73, 132864
ds_read_b64_tr_b16 a[96:97], v11 offset:32768
v_mfma_f32_16x16x32_bf16 v[76:79], a[108:111], a[28:31], v[76:79]
buffer_load_dwordx4 v12, s[48:51], s64 offen lds
v_mfma_f32_16x16x32_bf16 v[76:79], a[104:107], a[24:27], v[76:79]
ds_read_b64_tr_b16 a[98:99], v11 offset:33792
v_mfma_f32_16x16x32_bf16 v[140:143], a[112:115], a[24:27], v[140:143]
ds_read_b64_tr_b16 a[100:101], v11 offset:40960
v_mfma_f32_16x16x32_bf16 v[140:143], a[116:119], a[28:31], v[140:143]
s_add_u32 m0, s76, 7168
ds_read_b64_tr_b16 a[102:103], v11 offset:41984
v_subrev_u32 v8, 0x8000, v8
v_mfma_f32_16x16x32_bf16 v[124:127], a[116:119], a[20:23], v[124:127]
s_add_u32 s64, s73, 149248
v_mfma_f32_16x16x32_bf16 v[124:127], a[112:115], a[16:19], v[124:127]
buffer_load_dwordx4 v13, s[48:51], s64 offen lds
v_mfma_f32_16x16x32_bf16 v[108:111], a[112:115], a[8:11], v[108:111]
v_mfma_f32_16x16x32_bf16 v[108:111], a[116:119], a[12:15], v[108:111]
v_mfma_f32_16x16x32_bf16 v[92:95], a[116:119], a[4:7], v[92:95]
v_subrev_u32 v9, 0x8000, v9
v_subrev_u32 v10, 0x8000, v10
v_mfma_f32_16x16x32_bf16 v[92:95], a[112:115], a[0:3], v[92:95]
v_subrev_u32 v11, 0x8000, v11
v_mfma_f32_16x16x32_bf16 v[32:35], a[72:75], a[0:3], v[32:35]
v_mfma_f32_16x16x32_bf16 v[32:35], a[76:79], a[4:7], v[32:35]
v_mfma_f32_16x16x32_bf16 v[48:51], a[76:79], a[12:15], v[48:51]
s_waitcnt lgkmcnt(0)
s_barrier
v_mfma_f32_16x16x32_bf16 v[48:51], a[72:75], a[8:11], v[48:51]
s_mov_b64 exec, 1
buffer_atomic_add a251, v1, s[52:55], s70 offen offset:0 sc1
s_mov_b64 exec, -1
s_add_u32 m0, s77, 131072
v_mfma_f32_16x16x32_bf16 v[64:67], a[72:75], a[16:19], v[64:67]
s_lshl4_add_u32 s70, s78, s70
s_add_u32 s64, s71, 7864320
ds_read_b64_tr_b16 a[104:105], v19 offset:4096
v_mfma_f32_16x16x32_bf16 v[64:67], a[76:79], a[20:23], v[64:67]
s_lshr_b32 s81, s81, 5
buffer_load_dwordx4 v14, s[56:59], s64 offen lds
v_mfma_f32_16x16x32_bf16 v[80:83], a[76:79], a[28:31], v[80:83]
ds_read_b64_tr_b16 a[106:107], v19 offset:4352
v_mfma_f32_16x16x32_bf16 v[80:83], a[72:75], a[24:27], v[80:83]
ds_read_b64_tr_b16 a[108:109], v19 offset:6144
v_mfma_f32_16x16x32_bf16 v[144:147], a[80:83], a[24:27], v[144:147]
ds_read_b64_tr_b16 a[110:111], v19 offset:6400
v_mfma_f32_16x16x32_bf16 v[144:147], a[84:87], a[28:31], v[144:147]
ds_read_b64_tr_b16 a[112:113], v20 offset:4096
v_mfma_f32_16x16x32_bf16 v[128:131], a[84:87], a[20:23], v[128:131]
ds_read_b64_tr_b16 a[114:115], v20 offset:4352
v_mfma_f32_16x16x32_bf16 v[128:131], a[80:83], a[16:19], v[128:131]
ds_read_b64_tr_b16 a[116:117], v20 offset:6144
v_mfma_f32_16x16x32_bf16 v[112:115], a[80:83], a[8:11], v[112:115]
s_add_u32 m0, s78, 147456
ds_read_b64_tr_b16 a[118:119], v20 offset:6400
v_mfma_f32_16x16x32_bf16 v[112:115], a[84:87], a[12:15], v[112:115]
s_add_u32 s64, s75, 5898240
ds_read_b64_tr_b16 a[72:73], v19 offset:8192
v_mfma_f32_16x16x32_bf16 v[96:99], a[84:87], a[4:7], v[96:99]
buffer_load_dwordx4 v23, s[60:63], s64 offen lds
v_mfma_f32_16x16x32_bf16 v[96:99], a[80:83], a[0:3], v[96:99]
ds_read_b64_tr_b16 a[74:75], v19 offset:8448
v_mfma_f32_16x16x32_bf16 v[36:39], a[88:91], a[0:3], v[36:39]
ds_read_b64_tr_b16 a[76:77], v19 offset:10240
v_mfma_f32_16x16x32_bf16 v[36:39], a[92:95], a[4:7], v[36:39]
ds_read_b64_tr_b16 a[78:79], v19 offset:10496
v_mfma_f32_16x16x32_bf16 v[52:55], a[92:95], a[12:15], v[52:55]
ds_read_b64_tr_b16 a[80:81], v20 offset:8192
v_mfma_f32_16x16x32_bf16 v[52:55], a[88:91], a[8:11], v[52:55]
ds_read_b64_tr_b16 a[82:83], v20 offset:8448
v_mfma_f32_16x16x32_bf16 v[68:71], a[88:91], a[16:19], v[68:71]
ds_read_b64_tr_b16 a[84:85], v20 offset:10240
v_mfma_f32_16x16x32_bf16 v[68:71], a[92:95], a[20:23], v[68:71]
s_add_u32 m0, s77, 132096
ds_read_b64_tr_b16 a[86:87], v20 offset:10496
v_mfma_f32_16x16x32_bf16 v[84:87], a[92:95], a[28:31], v[84:87]
s_add_u32 s64, s71, 7897088
v_mfma_f32_16x16x32_bf16 v[84:87], a[88:91], a[24:27], v[84:87]
buffer_load_dwordx4 v14, s[56:59], s64 offen lds
v_mfma_f32_16x16x32_bf16 v[148:151], a[96:99], a[24:27], v[148:151]
ds_read_b64_tr_b16 a[88:89], v19 offset:0
v_mfma_f32_16x16x32_bf16 v[148:151], a[100:103], a[28:31], v[148:151]
ds_read_b64_tr_b16 a[90:91], v19 offset:256
v_mfma_f32_16x16x32_bf16 v[132:135], a[100:103], a[20:23], v[132:135]
ds_read_b64_tr_b16 a[92:93], v19 offset:2048
v_mfma_f32_16x16x32_bf16 v[132:135], a[96:99], a[16:19], v[132:135]
ds_read_b64_tr_b16 a[94:95], v19 offset:2304
v_mfma_f32_16x16x32_bf16 v[116:119], a[96:99], a[8:11], v[116:119]
v_mfma_f32_16x16x32_bf16 v[116:119], a[100:103], a[12:15], v[116:119]
v_mfma_f32_16x16x32_bf16 v[100:103], a[100:103], a[4:7], v[100:103]
s_add_u32 m0, s78, 151552
v_mfma_f32_16x16x32_bf16 v[100:103], a[96:99], a[0:3], v[100:103]
s_waitcnt lgkmcnt(4)
s_add_u32 s64, s75, 5900288
ds_read_b64_tr_b16 a[96:97], v20 offset:0
v_mfma_f32_16x16x32_bf16 v[184:187], a[104:107], a[32:35], v[184:187]
buffer_load_dwordx4 v23, s[60:63], s64 offen lds
v_mfma_f32_16x16x32_bf16 v[184:187], a[108:111], a[36:39], v[184:187]
ds_read_b64_tr_b16 a[98:99], v20 offset:256
v_and_b32 v22, 15, v0
v_mfma_f32_16x16x32_bf16 v[192:195], a[108:111], a[44:47], v[192:195]
ds_read_b64_tr_b16 a[100:101], v20 offset:2048
v_lshlrev_b32 v22, 3, v22
v_mfma_f32_16x16x32_bf16 v[192:195], a[104:107], a[40:43], v[192:195]
s_lshl_b32 s85, s30, 7
s_add_u32 s85, s85, 58720256
ds_read_b64_tr_b16 a[102:103], v20 offset:2304
v_mfma_f32_16x16x32_bf16 v[200:203], a[104:107], a[48:51], v[200:203]
s_lshl_b32 s86, s3, 10
s_add_u32 s86, s86, s85
s_lshl_b32 s87, s16, 10
s_lshl_b32 s68, s31, 20
s_add_u32 s32, s28, s68
s_addc_u32 s33, s29, 0
v_mfma_f32_16x16x32_bf16 v[200:203], a[108:111], a[52:55], v[200:203]
s_add_u32 s87, s87, s85
s_add_u32 s68, s16, 1
s_lshl_b32 s34, s68, 16
v_mfma_f32_16x16x32_bf16 v[208:211], a[108:111], a[60:63], v[208:211]
v_mfma_f32_16x16x32_bf16 v[208:211], a[104:107], a[56:59], v[208:211]
ds_read_b64_tr_b16 a[104:105], v4 offset:0
v_mfma_f32_16x16x32_bf16 v[212:215], a[112:115], a[56:59], v[212:215]
s_add_u32 m0, s77, 133120
ds_read_b64_tr_b16 a[106:107], v4 offset:1024
v_mfma_f32_16x16x32_bf16 v[212:215], a[116:119], a[60:63], v[212:215]
s_add_u32 s64, s71, 7929856
ds_read_b64_tr_b16 a[108:109], v4 offset:8192
v_mfma_f32_16x16x32_bf16 v[204:207], a[116:119], a[52:55], v[204:207]
buffer_load_dwordx4 v15, s[56:59], s64 offen lds
v_mfma_f32_16x16x32_bf16 v[204:207], a[112:115], a[48:51], v[204:207]
ds_read_b64_tr_b16 a[110:111], v4 offset:9216
v_mfma_f32_16x16x32_bf16 v[196:199], a[112:115], a[40:43], v[196:199]
v_mfma_f32_16x16x32_bf16 v[196:199], a[116:119], a[44:47], v[196:199]
v_mfma_f32_16x16x32_bf16 v[188:191], a[116:119], a[36:39], v[188:191]
v_mfma_f32_16x16x32_bf16 v[188:191], a[112:115], a[32:35], v[188:191]
ds_read_b64_tr_b16 a[112:113], v5 offset:0
v_mfma_f32_16x16x32_bf16 v[216:219], a[32:35], a[72:75], v[216:219]
ds_read_b64_tr_b16 a[114:115], v5 offset:1024
v_mfma_f32_16x16x32_bf16 v[216:219], a[36:39], a[76:79], v[216:219]
s_add_u32 m0, s78, 155648
ds_read_b64_tr_b16 a[116:117], v5 offset:8192
v_mfma_f32_16x16x32_bf16 v[224:227], a[44:47], a[76:79], v[224:227]
s_add_u32 s64, s75, 5902336
ds_read_b64_tr_b16 a[118:119], v5 offset:9216
v_mfma_f32_16x16x32_bf16 v[224:227], a[40:43], a[72:75], v[224:227]
buffer_load_dwordx4 v23, s[60:63], s64 offen lds
v_mfma_f32_16x16x32_bf16 v[232:235], a[48:51], a[72:75], v[232:235]
v_mfma_f32_16x16x32_bf16 v[232:235], a[52:55], a[76:79], v[232:235]
v_mfma_f32_16x16x32_bf16 v[240:243], a[60:63], a[76:79], v[240:243]
v_mfma_f32_16x16x32_bf16 v[240:243], a[56:59], a[72:75], v[240:243]
ds_read_b64_tr_b16 a[72:73], v6 offset:0
v_mfma_f32_16x16x32_bf16 v[244:247], a[56:59], a[80:83], v[244:247]
ds_read_b64_tr_b16 a[74:75], v6 offset:1024
v_mfma_f32_16x16x32_bf16 v[244:247], a[60:63], a[84:87], v[244:247]
ds_read_b64_tr_b16 a[76:77], v6 offset:8192
v_mfma_f32_16x16x32_bf16 v[236:239], a[52:55], a[84:87], v[236:239]
s_add_u32 m0, s77, 134144
ds_read_b64_tr_b16 a[78:79], v6 offset:9216
v_mfma_f32_16x16x32_bf16 v[236:239], a[48:51], a[80:83], v[236:239]
s_add_u32 s64, s71, 7962624
v_mfma_f32_16x16x32_bf16 v[228:231], a[40:43], a[80:83], v[228:231]
buffer_load_dwordx4 v15, s[56:59], s64 offen lds
v_mfma_f32_16x16x32_bf16 v[228:231], a[44:47], a[84:87], v[228:231]
v_mfma_f32_16x16x32_bf16 v[220:223], a[36:39], a[84:87], v[220:223]
v_mfma_f32_16x16x32_bf16 v[220:223], a[32:35], a[80:83], v[220:223]
s_waitcnt lgkmcnt(4)
ds_read_b64_tr_b16 a[80:81], v7 offset:0
v_mfma_f32_16x16x32_bf16 v[152:155], a[88:91], a[32:35], v[152:155]
ds_read_b64_tr_b16 a[82:83], v7 offset:1024
v_mfma_f32_16x16x32_bf16 v[152:155], a[92:95], a[36:39], v[152:155]
ds_read_b64_tr_b16 a[84:85], v7 offset:8192
v_mfma_f32_16x16x32_bf16 v[160:163], a[92:95], a[44:47], v[160:163]
ds_read_b64_tr_b16 a[86:87], v7 offset:9216
v_mfma_f32_16x16x32_bf16 v[160:163], a[88:91], a[40:43], v[160:163]
v_mfma_f32_16x16x32_bf16 v[168:171], a[88:91], a[48:51], v[168:171]
v_mfma_f32_16x16x32_bf16 v[168:171], a[92:95], a[52:55], v[168:171]
v_mfma_f32_16x16x32_bf16 v[176:179], a[92:95], a[60:63], v[176:179]
s_add_u32 m0, s76, 32768
v_mfma_f32_16x16x32_bf16 v[176:179], a[88:91], a[56:59], v[176:179]
s_add_u32 s64, s72, 1920
ds_read_b64_tr_b16 a[88:89], v8 offset:0
v_mfma_f32_16x16x32_bf16 v[180:183], a[96:99], a[56:59], v[180:183]
buffer_load_dwordx4 v12, s[48:51], s64 offen lds
v_mfma_f32_16x16x32_bf16 v[180:183], a[100:103], a[60:63], v[180:183]
ds_read_b64_tr_b16 a[90:91], v8 offset:1024
v_mfma_f32_16x16x32_bf16 v[172:175], a[100:103], a[52:55], v[172:175]
ds_read_b64_tr_b16 a[92:93], v8 offset:8192
v_mfma_f32_16x16x32_bf16 v[172:175], a[96:99], a[48:51], v[172:175]
s_add_u32 m0, s76, 33792
ds_read_b64_tr_b16 a[94:95], v8 offset:9216
v_mfma_f32_16x16x32_bf16 v[164:167], a[96:99], a[40:43], v[164:167]
s_add_u32 s64, s72, 18304
v_mfma_f32_16x16x32_bf16 v[164:167], a[100:103], a[44:47], v[164:167]
buffer_load_dwordx4 v13, s[48:51], s64 offen lds
v_mfma_f32_16x16x32_bf16 v[156:159], a[100:103], a[36:39], v[156:159]
v_mfma_f32_16x16x32_bf16 v[156:159], a[96:99], a[32:35], v[156:159]
ds_read_b64_tr_b16 a[96:97], v9 offset:0
v_mfma_f32_16x16x32_bf16 v[24:27], a[104:107], a[32:35], v[24:27]
s_add_u32 m0, s76, 34816
ds_read_b64_tr_b16 a[98:99], v9 offset:1024
v_mfma_f32_16x16x32_bf16 v[24:27], a[108:111], a[36:39], v[24:27]
s_add_u32 s64, s72, 132992
ds_read_b64_tr_b16 a[100:101], v9 offset:8192
v_mfma_f32_16x16x32_bf16 v[40:43], a[108:111], a[44:47], v[40:43]
buffer_load_dwordx4 v12, s[48:51], s64 offen lds
v_mfma_f32_16x16x32_bf16 v[40:43], a[104:107], a[40:43], v[40:43]
ds_read_b64_tr_b16 a[102:103], v9 offset:9216
v_mfma_f32_16x16x32_bf16 v[56:59], a[104:107], a[48:51], v[56:59]
v_mfma_f32_16x16x32_bf16 v[56:59], a[108:111], a[52:55], v[56:59]
s_add_u32 m0, s76, 35840
v_mfma_f32_16x16x32_bf16 v[72:75], a[108:111], a[60:63], v[72:75]
s_waitcnt vmcnt(11)
s_add_u32 s64, s72, 149376
ds_read_b128 a[0:3], v2 offset:0
v_mfma_f32_16x16x32_bf16 v[72:75], a[104:107], a[56:59], v[72:75]
buffer_load_dwordx4 v13, s[48:51], s64 offen lds
v_mfma_f32_16x16x32_bf16 v[136:139], a[112:115], a[56:59], v[136:139]
ds_read_b128 a[4:7], v3 offset:0
v_mfma_f32_16x16x32_bf16 v[136:139], a[116:119], a[60:63], v[136:139]
ds_read_b128 a[8:11], v2 offset:2048
v_mfma_f32_16x16x32_bf16 v[120:123], a[116:119], a[52:55], v[120:123]
s_add_u32 m0, s76, 36864
ds_read_b128 a[12:15], v3 offset:2048
v_mfma_f32_16x16x32_bf16 v[120:123], a[112:115], a[48:51], v[120:123]
s_add_u32 s64, s73, 1920
ds_read_b128 a[16:19], v2 offset:4096
v_mfma_f32_16x16x32_bf16 v[104:107], a[112:115], a[40:43], v[104:107]
buffer_load_dwordx4 v12, s[48:51], s64 offen lds
v_mfma_f32_16x16x32_bf16 v[104:107], a[116:119], a[44:47], v[104:107]
ds_read_b128 a[20:23], v3 offset:4096
v_mfma_f32_16x16x32_bf16 v[88:91], a[116:119], a[36:39], v[88:91]
ds_read_b128 a[24:27], v2 offset:6144
v_mfma_f32_16x16x32_bf16 v[88:91], a[112:115], a[32:35], v[88:91]
s_waitcnt lgkmcnt(7)
s_add_u32 m0, s76, 37888
ds_read_b128 a[28:31], v3 offset:6144
v_mfma_f32_16x16x32_bf16 v[28:31], a[72:75], a[32:35], v[28:31]
s_add_u32 s64, s73, 18304
ds_read_b64_tr_b16 a[104:105], v10 offset:0
v_mfma_f32_16x16x32_bf16 v[28:31], a[76:79], a[36:39], v[28:31]
buffer_load_dwordx4 v13, s[48:51], s64 offen lds
v_mfma_f32_16x16x32_bf16 v[44:47], a[76:79], a[44:47], v[44:47]
ds_read_b64_tr_b16 a[106:107], v10 offset:1024
v_mfma_f32_16x16x32_bf16 v[44:47], a[72:75], a[40:43], v[44:47]
ds_read_b64_tr_b16 a[108:109], v10 offset:8192
v_mfma_f32_16x16x32_bf16 v[60:63], a[72:75], a[48:51], v[60:63]
s_add_u32 m0, s76, 38912
buffer_load_dword v1, off, s[52:55], s70 sc1
v_mfma_f32_16x16x32_bf16 v[60:63], a[76:79], a[52:55], v[60:63]
s_add_u32 s64, s73, 132992
ds_read_b64_tr_b16 a[110:111], v10 offset:9216
v_mfma_f32_16x16x32_bf16 v[76:79], a[76:79], a[60:63], v[76:79]
buffer_load_dwordx4 v12, s[48:51], s64 offen lds
v_mfma_f32_16x16x32_bf16 v[76:79], a[72:75], a[56:59], v[76:79]
ds_read_b64_tr_b16 a[112:113], v11 offset:0
v_mfma_f32_16x16x32_bf16 v[140:143], a[80:83], a[56:59], v[140:143]
ds_read_b64_tr_b16 a[114:115], v11 offset:1024
v_mfma_f32_16x16x32_bf16 v[140:143], a[84:87], a[60:63], v[140:143]
s_add_u32 m0, s76, 39936
ds_read_b64_tr_b16 a[116:117], v11 offset:8192
v_mfma_f32_16x16x32_bf16 v[124:127], a[84:87], a[52:55], v[124:127]
s_add_u32 s64, s73, 149376
ds_read_b64_tr_b16 a[118:119], v11 offset:9216
v_mfma_f32_16x16x32_bf16 v[124:127], a[80:83], a[48:51], v[124:127]
buffer_load_dwordx4 v13, s[48:51], s64 offen lds
v_mfma_f32_16x16x32_bf16 v[108:111], a[80:83], a[40:43], v[108:111]
v_mfma_f32_16x16x32_bf16 v[108:111], a[84:87], a[44:47], v[108:111]
v_mfma_f32_16x16x32_bf16 v[92:95], a[84:87], a[36:39], v[92:95]
buffer_load_dwordx2 a[64:65], v22, s[44:47], s86 offen offset:0 sc1
v_mfma_f32_16x16x32_bf16 v[92:95], a[80:83], a[32:35], v[92:95]
buffer_load_dwordx2 a[66:67], v22, s[44:47], s86 offen offset:512 sc1
v_mfma_f32_16x16x32_bf16 v[32:35], a[88:91], a[32:35], v[32:35]
buffer_load_dwordx2 a[68:69], v22, s[44:47], s87 offen offset:0 sc1
v_mfma_f32_16x16x32_bf16 v[32:35], a[92:95], a[36:39], v[32:35]
buffer_load_dwordx2 a[70:71], v22, s[44:47], s87 offen offset:512 sc1
v_mfma_f32_16x16x32_bf16 v[48:51], a[92:95], a[44:47], v[48:51]
s_waitcnt lgkmcnt(0)
s_barrier
v_mfma_f32_16x16x32_bf16 v[48:51], a[88:91], a[40:43], v[48:51]
ds_read_b64_tr_b16 a[72:73], v19 offset:36864
v_mfma_f32_16x16x32_bf16 v[64:67], a[88:91], a[48:51], v[64:67]
s_lshl2_add_u32 s72, s2, s30
ds_read_b64_tr_b16 a[74:75], v19 offset:37120
v_mfma_f32_16x16x32_bf16 v[64:67], a[92:95], a[52:55], v[64:67]
s_lshl_b32 s72, s72, 12
ds_read_b64_tr_b16 a[76:77], v19 offset:38912
v_mfma_f32_16x16x32_bf16 v[80:83], a[92:95], a[60:63], v[80:83]
s_add_u32 s72, s72, 67108864
ds_read_b64_tr_b16 a[78:79], v19 offset:39168
v_mfma_f32_16x16x32_bf16 v[80:83], a[88:91], a[56:59], v[80:83]
ds_read_b64_tr_b16 a[80:81], v20 offset:36864
v_mfma_f32_16x16x32_bf16 v[144:147], a[96:99], a[56:59], v[144:147]
ds_read_b64_tr_b16 a[82:83], v20 offset:37120
v_mfma_f32_16x16x32_bf16 v[144:147], a[100:103], a[60:63], v[144:147]
ds_read_b64_tr_b16 a[84:85], v20 offset:38912
v_mfma_f32_16x16x32_bf16 v[128:131], a[100:103], a[52:55], v[128:131]
ds_read_b64_tr_b16 a[86:87], v20 offset:39168
v_mfma_f32_16x16x32_bf16 v[128:131], a[96:99], a[48:51], v[128:131]
ds_read_b64_tr_b16 a[88:89], v19 offset:40960
v_mfma_f32_16x16x32_bf16 v[112:115], a[96:99], a[40:43], v[112:115]
ds_read_b64_tr_b16 a[90:91], v19 offset:41216
v_mfma_f32_16x16x32_bf16 v[112:115], a[100:103], a[44:47], v[112:115]
ds_read_b64_tr_b16 a[92:93], v19 offset:43008
v_mfma_f32_16x16x32_bf16 v[96:99], a[100:103], a[36:39], v[96:99]
ds_read_b64_tr_b16 a[94:95], v19 offset:43264
v_mfma_f32_16x16x32_bf16 v[96:99], a[96:99], a[32:35], v[96:99]
ds_read_b64_tr_b16 a[96:97], v20 offset:40960
v_mfma_f32_16x16x32_bf16 v[36:39], a[104:107], a[32:35], v[36:39]
buffer_store_dwordx4 a[240:243], v16, s[44:47], s72 offen offset:0 sc1
v_mfma_f32_16x16x32_bf16 v[36:39], a[108:111], a[36:39], v[36:39]
ds_read_b64_tr_b16 a[98:99], v20 offset:41216
v_mfma_f32_16x16x32_bf16 v[52:55], a[108:111], a[44:47], v[52:55]
ds_read_b64_tr_b16 a[100:101], v20 offset:43008
v_mfma_f32_16x16x32_bf16 v[52:55], a[104:107], a[40:43], v[52:55]
ds_read_b64_tr_b16 a[102:103], v20 offset:43264
v_mfma_f32_16x16x32_bf16 v[68:71], a[104:107], a[48:51], v[68:71]
v_mfma_f32_16x16x32_bf16 v[68:71], a[108:111], a[52:55], v[68:71]
v_mfma_f32_16x16x32_bf16 v[84:87], a[108:111], a[60:63], v[84:87]
v_mfma_f32_16x16x32_bf16 v[84:87], a[104:107], a[56:59], v[84:87]
ds_read_b64_tr_b16 a[104:105], v19 offset:32768
v_mfma_f32_16x16x32_bf16 v[148:151], a[112:115], a[56:59], v[148:151]
ds_read_b64_tr_b16 a[106:107], v19 offset:33024
v_mfma_f32_16x16x32_bf16 v[148:151], a[116:119], a[60:63], v[148:151]
ds_read_b64_tr_b16 a[108:109], v19 offset:34816
v_mfma_f32_16x16x32_bf16 v[132:135], a[116:119], a[52:55], v[132:135]
ds_read_b64_tr_b16 a[110:111], v19 offset:35072
v_mfma_f32_16x16x32_bf16 v[132:135], a[112:115], a[48:51], v[132:135]
v_mfma_f32_16x16x32_bf16 v[116:119], a[112:115], a[40:43], v[116:119]
v_mfma_f32_16x16x32_bf16 v[116:119], a[116:119], a[44:47], v[116:119]
v_mfma_f32_16x16x32_bf16 v[100:103], a[116:119], a[36:39], v[100:103]
buffer_store_dwordx4 a[240:243], v16, s[44:47], s72 offen offset:1024 sc1
v_mfma_f32_16x16x32_bf16 v[100:103], a[112:115], a[32:35], v[100:103]
s_waitcnt lgkmcnt(4)
ds_read_b64_tr_b16 a[112:113], v20 offset:32768
v_mfma_f32_16x16x32_bf16 v[184:187], a[72:75], a[0:3], v[184:187]
ds_read_b64_tr_b16 a[114:115], v20 offset:33024
v_and_b32 v12, 15, v0
v_mfma_f32_16x16x32_bf16 v[184:187], a[76:79], a[4:7], v[184:187]
ds_read_b64_tr_b16 a[116:117], v20 offset:34816
v_lshrrev_b32 v13, 4, v0
v_mfma_f32_16x16x32_bf16 v[192:195], a[76:79], a[12:15], v[192:195]
ds_read_b64_tr_b16 a[118:119], v20 offset:35072
v_lshlrev_b32 v13, 2, v13
v_mfma_f32_16x16x32_bf16 v[192:195], a[72:75], a[8:11], v[192:195]
v_sub_u32 v12, v12, v13
v_mfma_f32_16x16x32_bf16 v[200:203], a[72:75], a[16:19], v[200:203]
s_lshl_b32 s66, s30, 4
v_mfma_f32_16x16x32_bf16 v[200:203], a[76:79], a[20:23], v[200:203]
v_add_u32 v13, s66, v12
v_cmp_gt_i32 s[0:1], 0, v13
v_mfma_f32_16x16x32_bf16 v[208:211], a[76:79], a[28:31], v[208:211]
v_cmp_gt_i32 s[4:5], 1, v13
v_cmp_gt_i32 s[6:7], 2, v13
v_mfma_f32_16x16x32_bf16 v[208:211], a[72:75], a[24:27], v[208:211]
ds_read_b64_tr_b16 a[72:73], v4 offset:32768
v_cmp_gt_i32 s[8:9], 3, v13
v_mfma_f32_16x16x32_bf16 v[212:215], a[80:83], a[24:27], v[212:215]
ds_read_b64_tr_b16 a[74:75], v4 offset:33792
v_cmp_gt_i32 s[10:11], 16, v13
v_mfma_f32_16x16x32_bf16 v[212:215], a[84:87], a[28:31], v[212:215]
ds_read_b64_tr_b16 a[76:77], v4 offset:40960
v_cmp_gt_i32 s[12:13], 17, v13
v_mfma_f32_16x16x32_bf16 v[204:207], a[84:87], a[20:23], v[204:207]
ds_read_b64_tr_b16 a[78:79], v4 offset:41984
v_cmp_gt_i32 s[18:19], 18, v13
v_mfma_f32_16x16x32_bf16 v[204:207], a[80:83], a[16:19], v[204:207]
v_cmp_gt_i32 s[22:23], 19, v13
v_cmp_gt_i32 s[26:27], 32, v13
v_mfma_f32_16x16x32_bf16 v[196:199], a[80:83], a[8:11], v[196:199]
buffer_store_dwordx4 a[240:243], v16, s[44:47], s72 offen offset:2048 sc1
v_mfma_f32_16x16x32_bf16 v[196:199], a[84:87], a[12:15], v[196:199]
v_cmp_gt_i32 s[56:57], 33, v13
v_cmp_gt_i32 s[58:59], 34, v13
v_mfma_f32_16x16x32_bf16 v[188:191], a[84:87], a[4:7], v[188:191]
v_cmp_gt_i32 s[60:61], 35, v13
v_cmp_gt_i32 s[62:63], 48, v13
v_mfma_f32_16x16x32_bf16 v[188:191], a[80:83], a[0:3], v[188:191]
ds_read_b64_tr_b16 a[80:81], v5 offset:32768
v_cmp_gt_i32 s[48:49], 49, v13
v_mfma_f32_16x16x32_bf16 v[216:219], a[0:3], a[88:91], v[216:219]
ds_read_b64_tr_b16 a[82:83], v5 offset:33792
v_cmp_gt_i32 s[50:51], 50, v13
v_mfma_f32_16x16x32_bf16 v[216:219], a[4:7], a[92:95], v[216:219]
ds_read_b64_tr_b16 a[84:85], v5 offset:40960
v_cmp_gt_i32 s[100:101], 51, v13
v_mfma_f32_16x16x32_bf16 v[224:227], a[12:15], a[92:95], v[224:227]
ds_read_b64_tr_b16 a[86:87], v5 offset:41984
v_subrev_u32 v17, 0, v12
v_mfma_f32_16x16x32_bf16 v[224:227], a[8:11], a[88:91], v[224:227]
v_lshlrev_b32 v18, 31, v17
v_or_b32 v21, v17, v18
v_mfma_f32_16x16x32_bf16 v[232:235], a[16:19], a[88:91], v[232:235]
v_ashrrev_i32 v21, 31, v21
v_and_b32 v248, 0xff800000, v21
v_mfma_f32_16x16x32_bf16 v[232:235], a[20:23], a[92:95], v[232:235]
v_not_b32 v17, v17
v_or_b32 v21, v17, v18
v_mfma_f32_16x16x32_bf16 v[240:243], a[28:31], a[92:95], v[240:243]
v_ashrrev_i32 v21, 31, v21
v_and_b32 v252, 0xff800000, v21
v_mfma_f32_16x16x32_bf16 v[240:243], a[24:27], a[88:91], v[240:243]
ds_read_b64_tr_b16 a[88:89], v6 offset:32768
v_subrev_u32 v17, 1, v12
v_mfma_f32_16x16x32_bf16 v[244:247], a[24:27], a[96:99], v[244:247]
ds_read_b64_tr_b16 a[90:91], v6 offset:33792
v_lshlrev_b32 v18, 31, v17
v_mfma_f32_16x16x32_bf16 v[244:247], a[28:31], a[100:103], v[244:247]
ds_read_b64_tr_b16 a[92:93], v6 offset:40960
v_add_u32 v19, 0x8000, v19
v_mfma_f32_16x16x32_bf16 v[236:239], a[20:23], a[100:103], v[236:239]
buffer_store_dwordx4 a[240:243], v16, s[44:47], s72 offen offset:3072 sc1
v_mfma_f32_16x16x32_bf16 v[236:239], a[16:19], a[96:99], v[236:239]
ds_read_b64_tr_b16 a[94:95], v6 offset:41984
v_or_b32 v21, v17, v18
v_mfma_f32_16x16x32_bf16 v[228:231], a[8:11], a[96:99], v[228:231]
v_ashrrev_i32 v21, 31, v21
v_and_b32 v249, 0xff800000, v21
v_mfma_f32_16x16x32_bf16 v[228:231], a[12:15], a[100:103], v[228:231]
v_not_b32 v17, v17
v_or_b32 v21, v17, v18
v_mfma_f32_16x16x32_bf16 v[220:223], a[4:7], a[100:103], v[220:223]
v_ashrrev_i32 v21, 31, v21
v_and_b32 v253, 0xff800000, v21
v_mfma_f32_16x16x32_bf16 v[220:223], a[0:3], a[96:99], v[220:223]
s_waitcnt lgkmcnt(4)
ds_read_b64_tr_b16 a[96:97], v7 offset:32768
v_subrev_u32 v17, 2, v12
v_mfma_f32_16x16x32_bf16 v[152:155], a[104:107], a[0:3], v[152:155]
ds_read_b64_tr_b16 a[98:99], v7 offset:33792
v_lshlrev_b32 v18, 31, v17
v_mfma_f32_16x16x32_bf16 v[152:155], a[108:111], a[4:7], v[152:155]
ds_read_b64_tr_b16 a[100:101], v7 offset:40960
v_add_u32 v20, 0x8000, v20
v_mfma_f32_16x16x32_bf16 v[160:163], a[108:111], a[12:15], v[160:163]
ds_read_b64_tr_b16 a[102:103], v7 offset:41984
v_or_b32 v21, v17, v18
v_mfma_f32_16x16x32_bf16 v[160:163], a[104:107], a[8:11], v[160:163]
v_ashrrev_i32 v21, 31, v21
v_and_b32 v250, 0xff800000, v21
v_mfma_f32_16x16x32_bf16 v[168:171], a[104:107], a[16:19], v[168:171]
v_not_b32 v17, v17
v_or_b32 v21, v17, v18
v_mfma_f32_16x16x32_bf16 v[168:171], a[108:111], a[20:23], v[168:171]
v_ashrrev_i32 v21, 31, v21
v_and_b32 v254, 0xff800000, v21
v_mfma_f32_16x16x32_bf16 v[176:179], a[108:111], a[28:31], v[176:179]
v_subrev_u32 v17, 3, v12
v_lshlrev_b32 v18, 31, v17
v_mfma_f32_16x16x32_bf16 v[176:179], a[104:107], a[24:27], v[176:179]
ds_read_b64_tr_b16 a[104:105], v8 offset:32768
v_or_b32 v21, v17, v18
v_mfma_f32_16x16x32_bf16 v[180:183], a[112:115], a[24:27], v[180:183]
ds_read_b64_tr_b16 a[106:107], v8 offset:33792
v_ashrrev_i32 v21, 31, v21
v_mfma_f32_16x16x32_bf16 v[180:183], a[116:119], a[28:31], v[180:183]
ds_read_b64_tr_b16 a[108:109], v8 offset:40960
v_add_u32 v4, 0x8000, v4
v_mfma_f32_16x16x32_bf16 v[172:175], a[116:119], a[20:23], v[172:175]
ds_read_b64_tr_b16 a[110:111], v8 offset:41984
v_and_b32 v251, 0xff800000, v21
v_mfma_f32_16x16x32_bf16 v[172:175], a[112:115], a[16:19], v[172:175]
v_not_b32 v17, v17
v_or_b32 v21, v17, v18
v_mfma_f32_16x16x32_bf16 v[164:167], a[112:115], a[8:11], v[164:167]
s_add_u32 s17, s78, .-L_pc+6144
v_ashrrev_i32 v21, 31, v21
v_and_b32 v255, 0xff800000, v21
v_mfma_f32_16x16x32_bf16 v[164:167], a[116:119], a[12:15], v[164:167]
s_and_b32 s66, s2, 7
s_lshr_b32 s67, s2, 3
s_and_b32 s83, s66, 1
v_mfma_f32_16x16x32_bf16 v[156:159], a[116:119], a[4:7], v[156:159]
s_and_b32 s68, s66, 2
s_and_b32 s69, s67, 7
s_lshl2_add_u32 s82, s68, s69
v_mfma_f32_16x16x32_bf16 v[156:159], a[112:115], a[0:3], v[156:159]
s_and_b32 s68, s66, 4
s_lshr_b32 s69, s67, 3
ds_read_b64_tr_b16 a[112:113], v9 offset:32768
v_mfma_f32_16x16x32_bf16 v[24:27], a[72:75], a[0:3], v[24:27]
s_xor_b32 s69, s69, 0
s_add_u32 s87, s68, s69
ds_read_b64_tr_b16 a[114:115], v9 offset:33792
v_mfma_f32_16x16x32_bf16 v[24:27], a[76:79], a[4:7], v[24:27]
s_lshl_b32 s87, s87, 8
ds_read_b64_tr_b16 a[116:117], v9 offset:40960
v_add_u32 v5, 0x8000, v5
v_mfma_f32_16x16x32_bf16 v[40:43], a[76:79], a[12:15], v[40:43]
s_lshl_b32 s86, s30, 13
buffer_load_dword a252, v16, s[88:91], s17 offen
v_mfma_f32_16x16x32_bf16 v[40:43], a[72:75], a[8:11], v[40:43]
s_lshl_b32 s85, s30, 16
s_add_u32 s85, s85, s87
ds_read_b64_tr_b16 a[118:119], v9 offset:41984
v_mfma_f32_16x16x32_bf16 v[56:59], a[72:75], a[16:19], v[56:59]
s_mul_i32 s66, s83, 1310720
s_add_u32 s85, s85, s66
s_mul_i32 s84, s82, 1310720
v_mfma_f32_16x16x32_bf16 v[56:59], a[76:79], a[20:23], v[56:59]
s_and_b32 s66, s30, 1
s_lshl_b32 s66, s66, 14
s_add_u32 s84, s84, s66
v_mfma_f32_16x16x32_bf16 v[72:75], a[76:79], a[28:31], v[72:75]
s_waitcnt vmcnt(9)
s_mul_i32 s66, s83, 163840
ds_read_b128 a[32:35], v2 offset:32768
v_mfma_f32_16x16x32_bf16 v[72:75], a[72:75], a[24:27], v[72:75]
s_add_u32 s84, s84, s66
s_add_u32 s84, s84, 34603008
s_add_u32 s17, s78, .-L_pc+9984
ds_read_b128 a[36:39], v3 offset:32768
v_mfma_f32_16x16x32_bf16 v[136:139], a[80:83], a[24:27], v[136:139]
s_sub_u32 s66, 15, s82
buffer_load_dword a252, v16, s[88:91], s17 offen
v_mfma_f32_16x16x32_bf16 v[136:139], a[84:87], a[28:31], v[136:139]
s_min_u32 s66, s66, s82
ds_read_b128 a[40:43], v2 offset:34816
v_add_u32 v6, 0x8000, v6
v_mfma_f32_16x16x32_bf16 v[120:123], a[84:87], a[20:23], v[120:123]
s_lshl1_add_u32 s66, s66, s83
s_lshl_b32 s80, s66, 8
ds_read_b128 a[44:47], v3 offset:34816
v_mfma_f32_16x16x32_bf16 v[120:123], a[80:83], a[16:19], v[120:123]
s_add_u32 s80, s80, 8192
s_and_b32 s67, s30, 1
ds_read_b128 a[48:51], v2 offset:36864
v_mfma_f32_16x16x32_bf16 v[104:107], a[80:83], a[8:11], v[104:107]
s_lshl_b32 s67, s67, 7
s_add_u32 s67, s67, s83
ds_read_b128 a[52:55], v3 offset:36864
v_mfma_f32_16x16x32_bf16 v[104:107], a[84:87], a[12:15], v[104:107]
s_lshl_b32 s67, s67, 7
s_add_u32 s67, s67, 98304
ds_read_b128 a[56:59], v2 offset:38912
v_mfma_f32_16x16x32_bf16 v[88:91], a[84:87], a[4:7], v[88:91]
s_lshl_b32 s66, s30, 11
ds_read_b128 a[60:63], v3 offset:38912
v_lshrrev_b32 v14, 4, v0
v_mfma_f32_16x16x32_bf16 v[88:91], a[80:83], a[0:3], v[88:91]
s_waitcnt lgkmcnt(8)
ds_read_b64_tr_b16 a[72:73], v10 offset:32768
v_bfe_u32 v12, v0, 1, 3
v_mfma_f32_16x16x32_bf16 v[28:31], a[88:91], a[0:3], v[28:31]
ds_read_b64_tr_b16 a[74:75], v10 offset:33792
v_xor_b32 v12, v12, v14
v_mfma_f32_16x16x32_bf16 v[28:31], a[92:95], a[4:7], v[28:31]
ds_read_b64_tr_b16 a[76:77], v10 offset:40960
v_add_u32 v7, 0x8000, v7
v_mfma_f32_16x16x32_bf16 v[44:47], a[92:95], a[12:15], v[44:47]
ds_read_b64_tr_b16 a[78:79], v10 offset:41984
v_lshlrev_b32 v12, 5, v12
v_mfma_f32_16x16x32_bf16 v[44:47], a[88:91], a[8:11], v[44:47]
ds_read_b64_tr_b16 a[80:81], v11 offset:32768
v_lshl_add_u32 v12, v14, 11, v12
v_mfma_f32_16x16x32_bf16 v[60:63], a[88:91], a[16:19], v[60:63]
ds_read_b64_tr_b16 a[82:83], v11 offset:33792
v_and_b32 v14, 1, v0
v_mfma_f32_16x16x32_bf16 v[60:63], a[92:95], a[20:23], v[60:63]
ds_read_b64_tr_b16 a[84:85], v11 offset:40960
v_lshl_add_u32 v12, v14, 4, v12
v_mfma_f32_16x16x32_bf16 v[76:79], a[92:95], a[28:31], v[76:79]
s_add_u32 s17, s78, .-L_pc+13824
ds_read_b64_tr_b16 a[86:87], v11 offset:41984
v_xor_b32 v13, 128, v12
v_mfma_f32_16x16x32_bf16 v[76:79], a[88:91], a[24:27], v[76:79]
buffer_load_dword a252, v16, s[88:91], s17 offen
v_mfma_f32_16x16x32_bf16 v[140:143], a[96:99], a[24:27], v[140:143]
v_readfirstlane_b32 vcc_lo, v1
s_nop 0
s_cmp_lt_u32 vcc_lo, s81
s_cbranch_scc1 L_spin_4
L_spinbk_5:
v_mfma_f32_16x16x32_bf16 v[140:143], a[100:103], a[28:31], v[140:143]
s_add_u32 s17, s78, L_F1-L_pc
v_add_u32 v8, 0x8000, v8
v_lshrrev_b32 v14, 4, v0
v_mfma_f32_16x16x32_bf16 v[124:127], a[100:103], a[20:23], v[124:127]
buffer_load_dword a252, v16, s[88:91], s17 offen
v_mfma_f32_16x16x32_bf16 v[124:127], a[96:99], a[16:19], v[124:127]
v_bfe_u32 v18, v0, 2, 2
v_lshl_add_u32 v14, v14, 2, v18
v_mfma_f32_16x16x32_bf16 v[108:111], a[96:99], a[8:11], v[108:111]
s_add_u32 s17, s78, L_F1-L_pc+4096
v_and_b32 v18, 3, v0
v_lshlrev_b32 v18, 3, v18
v_mfma_f32_16x16x32_bf16 v[108:111], a[100:103], a[12:15], v[108:111]
buffer_load_dword a252, v16, s[88:91], s17 offen
v_mfma_f32_16x16x32_bf16 v[92:95], a[100:103], a[4:7], v[92:95]
v_add_u32 v9, 0x8000, v9
v_add_u32 v10, 0x8000, v10
v_mfma_f32_16x16x32_bf16 v[92:95], a[96:99], a[0:3], v[92:95]
v_add_u32 v11, 0x8000, v11
v_lshl_add_u32 v18, v14, 8, v18
v_mfma_f32_16x16x32_bf16 v[32:35], a[104:107], a[0:3], v[32:35]
v_and_b32 v14, 7, v14
v_lshl_add_u32 v18, v14, 5, v18
v_mfma_f32_16x16x32_bf16 v[32:35], a[108:111], a[4:7], v[32:35]
v_xor_b32 v18, s67, v18
v_add_u32 v14, s66, v16
v_mfma_f32_16x16x32_bf16 v[48:51], a[108:111], a[12:15], v[48:51]
s_waitcnt lgkmcnt(0)
s_barrier
v_mfma_f32_16x16x32_bf16 v[48:51], a[104:107], a[8:11], v[48:51]
ds_read_b64_tr_b16 a[88:89], v19 offset:36864
v_xor_b32 v15, 0x800, v14
v_mfma_f32_16x16x32_bf16 v[64:67], a[104:107], a[16:19], v[64:67]
s_lshr_b32 s66, s30, 1
s_lshl_b32 s66, s66, 16
ds_read_b64_tr_b16 a[90:91], v19 offset:37120
v_mfma_f32_16x16x32_bf16 v[64:67], a[108:111], a[20:23], v[64:67]
s_and_b32 s67, s30, 1
s_lshl_b32 s67, s67, 10
s_mov_b32 m0, s76
ds_read_b64_tr_b16 a[92:93], v19 offset:38912
v_mfma_f32_16x16x32_bf16 v[80:83], a[108:111], a[28:31], v[80:83]
s_add_u32 s66, s66, s67
s_add_u32 s66, s66, 32768
s_lshl_b32 s64, s30, 14
ds_read_b64_tr_b16 a[94:95], v19 offset:39168
v_mfma_f32_16x16x32_bf16 v[80:83], a[104:107], a[24:27], v[80:83]
buffer_load_dwordx4 v16, s[32:35], s64 offen offset:0 sc1 lds
v_mfma_f32_16x16x32_bf16 v[144:147], a[112:115], a[24:27], v[144:147]
ds_read_b64_tr_b16 a[96:97], v20 offset:36864
v_add_u32 v17, s66, v16
v_mfma_f32_16x16x32_bf16 v[144:147], a[116:119], a[28:31], v[144:147]
ds_read_b64_tr_b16 a[98:99], v20 offset:37120
v_lshlrev_b32 v21, 5, v0
v_mfma_f32_16x16x32_bf16 v[128:131], a[116:119], a[20:23], v[128:131]
s_lshl2_add_u32 s73, s2, s30
s_lshl_b32 s73, s73, 11
s_lshl_b32 s66, s30, 11
v_mfma_f32_16x16x32_bf16 v[128:131], a[112:115], a[16:19], v[128:131]
s_add_u32 s66, s66, 32768
buffer_load_dwordx4 v16, s[32:35], s64 offen offset:1024 sc1 lds
v_mfma_f32_16x16x32_bf16 v[112:115], a[112:115], a[8:11], v[112:115]
ds_read_b64_tr_b16 a[100:101], v20 offset:38912
v_add_u32 v2, s66, v16
v_mfma_f32_16x16x32_bf16 v[112:115], a[116:119], a[12:15], v[112:115]
ds_read_b64_tr_b16 a[102:103], v20 offset:39168
v_add_u32 v3, 0x10000, v2
v_mfma_f32_16x16x32_bf16 v[96:99], a[116:119], a[4:7], v[96:99]
ds_read_b64_tr_b16 a[104:105], v19 offset:40960
v_mfma_f32_16x16x32_bf16 v[96:99], a[112:115], a[0:3], v[96:99]
buffer_load_dwordx4 v16, s[32:35], s64 offen offset:2048 sc1 lds
v_mfma_f32_16x16x32_bf16 v[36:39], a[72:75], a[0:3], v[36:39]
ds_read_b64_tr_b16 a[106:107], v19 offset:41216
v_mfma_f32_16x16x32_bf16 v[36:39], a[76:79], a[4:7], v[36:39]
ds_read_b64_tr_b16 a[108:109], v19 offset:43008
v_mfma_f32_16x16x32_bf16 v[52:55], a[76:79], a[12:15], v[52:55]
ds_read_b64_tr_b16 a[110:111], v19 offset:43264
v_mfma_f32_16x16x32_bf16 v[52:55], a[72:75], a[8:11], v[52:55]
buffer_load_dwordx4 v16, s[32:35], s64 offen offset:3072 sc1 lds
v_mfma_f32_16x16x32_bf16 v[68:71], a[72:75], a[16:19], v[68:71]
ds_read_b64_tr_b16 a[112:113], v20 offset:40960
v_mfma_f32_16x16x32_bf16 v[68:71], a[76:79], a[20:23], v[68:71]
s_add_u32 m0, s76, 4096
ds_read_b64_tr_b16 a[114:115], v20 offset:41216
v_mfma_f32_16x16x32_bf16 v[84:87], a[76:79], a[28:31], v[84:87]
s_add_u32 s64, s64, 4096
ds_read_b64_tr_b16 a[116:117], v20 offset:43008
v_mfma_f32_16x16x32_bf16 v[84:87], a[72:75], a[24:27], v[84:87]
buffer_load_dwordx4 v16, s[32:35], s64 offen offset:0 sc1 lds
v_mfma_f32_16x16x32_bf16 v[148:151], a[80:83], a[24:27], v[148:151]
ds_read_b64_tr_b16 a[118:119], v20 offset:43264
v_mfma_f32_16x16x32_bf16 v[148:151], a[84:87], a[28:31], v[148:151]
ds_read_b64_tr_b16 a[72:73], v19 offset:32768
v_mfma_f32_16x16x32_bf16 v[132:135], a[84:87], a[20:23], v[132:135]
ds_read_b64_tr_b16 a[74:75], v19 offset:33024
v_mfma_f32_16x16x32_bf16 v[132:135], a[80:83], a[16:19], v[132:135]
buffer_load_dwordx4 v16, s[32:35], s64 offen offset:1024 sc1 lds
v_mfma_f32_16x16x32_bf16 v[116:119], a[80:83], a[8:11], v[116:119]
ds_read_b64_tr_b16 a[76:77], v19 offset:34816
v_mfma_f32_16x16x32_bf16 v[116:119], a[84:87], a[12:15], v[116:119]
ds_read_b64_tr_b16 a[78:79], v19 offset:35072
v_mfma_f32_16x16x32_bf16 v[100:103], a[84:87], a[4:7], v[100:103]
v_mfma_f32_16x16x32_bf16 v[100:103], a[80:83], a[0:3], v[100:103]
s_waitcnt lgkmcnt(6)
buffer_load_dwordx4 v16, s[32:35], s64 offen offset:2048 sc1 lds
v_mfma_f32_16x16x32_bf16 v[184:187], a[88:91], a[32:35], v[184:187]
ds_read_b64_tr_b16 a[80:81], v20 offset:32768
v_bfe_u32 v1, v0, 1, 1
v_mfma_f32_16x16x32_bf16 v[184:187], a[92:95], a[36:39], v[184:187]
ds_read_b64_tr_b16 a[82:83], v20 offset:33024
v_subrev_u32 v1, 1, v1
v_mfma_f32_16x16x32_bf16 v[192:195], a[92:95], a[44:47], v[192:195]
ds_read_b64_tr_b16 a[84:85], v20 offset:34816
v_and_b32 v1, 0x3f803f80, v1
v_mfma_f32_16x16x32_bf16 v[192:195], a[88:91], a[40:43], v[192:195]
buffer_load_dwordx4 v16, s[32:35], s64 offen offset:3072 sc1 lds
v_mfma_f32_16x16x32_bf16 v[200:203], a[88:91], a[48:51], v[200:203]
ds_read_b64_tr_b16 a[86:87], v20 offset:35072
v_accvgpr_write_b32 a240, v1
v_mfma_f32_16x16x32_bf16 v[200:203], a[92:95], a[52:55], v[200:203]
v_accvgpr_write_b32 a241, v1
v_accvgpr_write_b32 a242, v1
v_mfma_f32_16x16x32_bf16 v[208:211], a[92:95], a[60:63], v[208:211]
s_lshr_b32 s64, s76, 1
s_add_u32 m0, s64, 81920
s_and_b32 s71, s64, 8192
s_add_u32 s64, s64, s71
s_add_u32 s64, s64, 8192
v_accvgpr_write_b32 a243, v1
v_mfma_f32_16x16x32_bf16 v[208:211], a[88:91], a[56:59], v[208:211]
buffer_load_dwordx4 v16, s[32:35], s64 offen offset:0 sc1 lds
v_mfma_f32_16x16x32_bf16 v[212:215], a[96:99], a[56:59], v[212:215]
ds_read_b64_tr_b16 a[88:89], v4 offset:32768
v_mfma_f32_16x16x32_bf16 v[212:215], a[100:103], a[60:63], v[212:215]
ds_read_b64_tr_b16 a[90:91], v4 offset:33792
v_mfma_f32_16x16x32_bf16 v[204:207], a[100:103], a[52:55], v[204:207]
ds_read_b64_tr_b16 a[92:93], v4 offset:40960
v_mfma_f32_16x16x32_bf16 v[204:207], a[96:99], a[48:51], v[204:207]
buffer_load_dwordx4 v16, s[32:35], s64 offen offset:1024 sc1 lds
v_mfma_f32_16x16x32_bf16 v[196:199], a[96:99], a[40:43], v[196:199]
ds_read_b64_tr_b16 a[94:95], v4 offset:41984
v_mfma_f32_16x16x32_bf16 v[196:199], a[100:103], a[44:47], v[196:199]
s_or_b32 s66, s3, s30
s_cmp_eq_u32 s66, 0
s_cselect_b32 s66, 0xff800000, 0
v_mfma_f32_16x16x32_bf16 v[188:191], a[100:103], a[36:39], v[188:191]
s_and_b32 s67, s74, 0x7800
s_cselect_b32 s67, 0, 0x70000000
s_add_u32 s77, s74, s67
v_mfma_f32_16x16x32_bf16 v[188:191], a[96:99], a[32:35], v[188:191]
s_sub_u32 s77, s77, 2048
buffer_load_dwordx4 v16, s[32:35], s64 offen offset:2048 sc1 lds
v_mfma_f32_16x16x32_bf16 v[216:219], a[32:35], a[104:107], v[216:219]
s_mov_b32 s68, 0x3e0293ee
ds_read_b64_tr_b16 a[96:97], v5 offset:32768
v_mfma_f32_16x16x32_bf16 v[216:219], a[36:39], a[108:111], v[216:219]
s_mov_b32 s69, s68
ds_read_b64_tr_b16 a[98:99], v5 offset:33792
v_cvt_pk_bf16_f32 v208, v208, v209
v_mfma_f32_16x16x32_bf16 v[224:227], a[44:47], a[108:111], v[224:227]
ds_read_b64_tr_b16 a[100:101], v5 offset:40960
v_cvt_pk_bf16_f32 v209, v210, v211
v_mfma_f32_16x16x32_bf16 v[224:227], a[40:43], a[104:107], v[224:227]
buffer_load_dwordx4 v16, s[32:35], s64 offen offset:3072 sc1 lds
v_mfma_f32_16x16x32_bf16 v[232:235], a[48:51], a[104:107], v[232:235]
ds_read_b64_tr_b16 a[102:103], v5 offset:41984
v_cvt_pk_bf16_f32 v210, v212, v213
v_mfma_f32_16x16x32_bf16 v[232:235], a[52:55], a[108:111], v[232:235]
v_cvt_pk_bf16_f32 v211, v214, v215
v_mfma_f32_16x16x32_bf16 v[240:243], a[60:63], a[108:111], v[240:243]
ds_write_b128 v3, v[208:211] offset:10240
v_mfma_f32_16x16x32_bf16 v[240:243], a[56:59], a[104:107], v[240:243]
ds_read_b64_tr_b16 a[104:105], v6 offset:32768
v_cvt_pk_bf16_f32 v200, v200, v201
v_mfma_f32_16x16x32_bf16 v[244:247], a[56:59], a[112:115], v[244:247]
s_waitcnt lgkmcnt(6)
ds_read_b64_tr_b16 a[106:107], v6 offset:33792
v_cvt_pk_bf16_f32 v201, v202, v203
v_mfma_f32_16x16x32_bf16 v[244:247], a[60:63], a[116:119], v[244:247]
ds_read_b64_tr_b16 a[108:109], v6 offset:40960
v_cvt_pk_bf16_f32 v202, v204, v205
v_mfma_f32_16x16x32_bf16 v[236:239], a[52:55], a[116:119], v[236:239]
ds_read_b64_tr_b16 a[110:111], v6 offset:41984
v_cvt_pk_bf16_f32 v203, v206, v207
v_mfma_f32_16x16x32_bf16 v[236:239], a[48:51], a[112:115], v[236:239]
ds_write_b128 v3, v[200:203] offset:2048
v_mfma_f32_16x16x32_bf16 v[228:231], a[40:43], a[112:115], v[228:231]
v_cvt_pk_bf16_f32 v192, v192, v193
v_cvt_pk_bf16_f32 v193, v194, v195
v_mfma_f32_16x16x32_bf16 v[228:231], a[44:47], a[116:119], v[228:231]
v_cvt_pk_bf16_f32 v194, v196, v197
v_cvt_pk_bf16_f32 v195, v198, v199
v_mfma_f32_16x16x32_bf16 v[220:223], a[36:39], a[116:119], v[220:223]
ds_write_b128 v2, v[192:195] offset:10240
v_mfma_f32_16x16x32_bf16 v[220:223], a[32:35], a[112:115], v[220:223]
ds_read_b64_tr_b16 a[112:113], v7 offset:32768
v_cvt_pk_bf16_f32 v184, v184, v185
v_mfma_f32_16x16x32_bf16 v[152:155], a[72:75], a[32:35], v[152:155]
ds_read_b64_tr_b16 a[114:115], v7 offset:33792
v_cvt_pk_bf16_f32 v185, v186, v187
v_mfma_f32_16x16x32_bf16 v[152:155], a[76:79], a[36:39], v[152:155]
ds_read_b64_tr_b16 a[116:117], v7 offset:40960
v_cvt_pk_bf16_f32 v186, v188, v189
v_mfma_f32_16x16x32_bf16 v[160:163], a[76:79], a[44:47], v[160:163]
ds_read_b64_tr_b16 a[118:119], v7 offset:41984
v_cvt_pk_bf16_f32 v187, v190, v191
v_mfma_f32_16x16x32_bf16 v[160:163], a[72:75], a[40:43], v[160:163]
ds_write_b128 v2, v[184:187] offset:2048
v_mfma_f32_16x16x32_bf16 v[168:171], a[72:75], a[48:51], v[168:171]
v_cvt_pk_bf16_f32 v219, v218, v219
v_cvt_pk_bf16_f32 v218, v216, v217
v_mfma_f32_16x16x32_bf16 v[168:171], a[76:79], a[52:55], v[168:171]
ds_write_b64 v2, v[218:219] offset:3072
v_mfma_f32_16x16x32_bf16 v[176:179], a[76:79], a[60:63], v[176:179]
buffer_load_dword a252, v21, s[36:39], s73 offen
v_mfma_f32_16x16x32_bf16 v[176:179], a[72:75], a[56:59], v[176:179]
ds_read_b64_tr_b16 a[72:73], v8 offset:32768
v_cvt_pk_bf16_f32 v227, v226, v227
v_mfma_f32_16x16x32_bf16 v[180:183], a[80:83], a[56:59], v[180:183]
ds_read_b64_tr_b16 a[74:75], v8 offset:33792
v_cvt_pk_bf16_f32 v226, v224, v225
v_mfma_f32_16x16x32_bf16 v[180:183], a[84:87], a[60:63], v[180:183]
ds_write_b64 v2, v[226:227] offset:11264
v_mfma_f32_16x16x32_bf16 v[172:175], a[84:87], a[52:55], v[172:175]
ds_read_b64_tr_b16 a[76:77], v8 offset:40960
v_cvt_pk_bf16_f32 v235, v234, v235
v_mfma_f32_16x16x32_bf16 v[172:175], a[80:83], a[48:51], v[172:175]
ds_read_b64_tr_b16 a[78:79], v8 offset:41984
v_cvt_pk_bf16_f32 v234, v232, v233
v_mfma_f32_16x16x32_bf16 v[164:167], a[80:83], a[40:43], v[164:167]
ds_write_b64 v3, v[234:235] offset:3072
v_mfma_f32_16x16x32_bf16 v[164:167], a[84:87], a[44:47], v[164:167]
v_cvt_pk_bf16_f32 v243, v242, v243
v_cvt_pk_bf16_f32 v242, v240, v241
v_mfma_f32_16x16x32_bf16 v[156:159], a[84:87], a[36:39], v[156:159]
ds_write_b64 v3, v[242:243] offset:11264
v_mfma_f32_16x16x32_bf16 v[156:159], a[80:83], a[32:35], v[156:159]
ds_read_b64_tr_b16 a[80:81], v9 offset:32768
v_cvt_pk_bf16_f32 v247, v246, v247
v_mfma_f32_16x16x32_bf16 v[24:27], a[88:91], a[32:35], v[24:27]
ds_read_b64_tr_b16 a[82:83], v9 offset:33792
v_cvt_pk_bf16_f32 v246, v244, v245
v_mfma_f32_16x16x32_bf16 v[24:27], a[92:95], a[36:39], v[24:27]
ds_write_b64 v3, v[246:247] offset:11272
v_mfma_f32_16x16x32_bf16 v[40:43], a[92:95], a[44:47], v[40:43]
ds_read_b64_tr_b16 a[84:85], v9 offset:40960
v_cvt_pk_bf16_f32 v239, v238, v239
v_cvt_pk_bf16_f32 v238, v236, v237
v_mfma_f32_16x16x32_bf16 v[40:43], a[88:91], a[40:43], v[40:43]
ds_write_b64 v3, v[238:239] offset:3080
v_mfma_f32_16x16x32_bf16 v[56:59], a[88:91], a[48:51], v[56:59]
ds_read_b64_tr_b16 a[86:87], v9 offset:41984
v_cvt_pk_bf16_f32 v231, v230, v231
v_cvt_pk_bf16_f32 v230, v228, v229
v_mfma_f32_16x16x32_bf16 v[56:59], a[92:95], a[52:55], v[56:59]
ds_write_b64 v2, v[230:231] offset:11272
v_mfma_f32_16x16x32_bf16 v[72:75], a[92:95], a[60:63], v[72:75]
v_cvt_pk_bf16_f32 v223, v222, v223
v_cvt_pk_bf16_f32 v222, v220, v221
v_mfma_f32_16x16x32_bf16 v[72:75], a[88:91], a[56:59], v[72:75]
s_waitcnt lgkmcnt(8)
ds_write_b64 v2, v[222:223] offset:3080
v_mfma_f32_16x16x32_bf16 v[136:139], a[96:99], a[56:59], v[136:139]
ds_read_b64_tr_b16 a[88:89], v10 offset:32768
v_cvt_pk_bf16_f32 v176, v176, v177
v_mfma_f32_16x16x32_bf16 v[136:139], a[100:103], a[60:63], v[136:139]
s_waitcnt lgkmcnt(0)
s_barrier
v_mfma_f32_16x16x32_bf16 v[120:123], a[100:103], a[52:55], v[120:123]
ds_read_b128 a[16:19], v17 offset:16384
v_cvt_pk_bf16_f32 v177, v178, v179
v_mfma_f32_16x16x32_bf16 v[120:123], a[96:99], a[48:51], v[120:123]
ds_read_b64_tr_b16 a[90:91], v10 offset:33792
v_cvt_pk_bf16_f32 v178, v180, v181
v_mfma_f32_16x16x32_bf16 v[104:107], a[96:99], a[40:43], v[104:107]
ds_read_b64_tr_b16 a[92:93], v10 offset:40960
v_cvt_pk_bf16_f32 v179, v182, v183
v_mfma_f32_16x16x32_bf16 v[104:107], a[100:103], a[44:47], v[104:107]
ds_read_b64_tr_b16 a[94:95], v10 offset:41984
v_cvt_pk_bf16_f32 v168, v168, v169
v_mfma_f32_16x16x32_bf16 v[88:91], a[100:103], a[36:39], v[88:91]
v_cvt_pk_bf16_f32 v169, v170, v171
v_cvt_pk_bf16_f32 v170, v172, v173
v_mfma_f32_16x16x32_bf16 v[88:91], a[96:99], a[32:35], v[88:91]
ds_read_b64_tr_b16 a[96:97], v11 offset:32768
v_cvt_pk_bf16_f32 v171, v174, v175
v_mfma_f32_16x16x32_bf16 v[28:31], a[104:107], a[32:35], v[28:31]
s_waitcnt lgkmcnt(4)
buffer_store_dwordx4 a[16:19], v16, s[44:47], s74 offen sc1
v_mfma_f32_16x16x32_bf16 v[28:31], a[108:111], a[36:39], v[28:31]
ds_read_b64_tr_b16 a[98:99], v11 offset:33792
v_cvt_pk_bf16_f32 v160, v160, v161
v_mfma_f32_16x16x32_bf16 v[44:47], a[108:111], a[44:47], v[44:47]
ds_read_b64_tr_b16 a[100:101], v11 offset:40960
v_cvt_pk_bf16_f32 v161, v162, v163
v_mfma_f32_16x16x32_bf16 v[44:47], a[104:107], a[40:43], v[44:47]
s_sub_u32 s81, s3, 1
ds_read_b64_tr_b16 a[102:103], v11 offset:41984
v_cvt_pk_bf16_f32 v162, v164, v165
v_mfma_f32_16x16x32_bf16 v[60:63], a[104:107], a[48:51], v[60:63]
s_sub_u32 s67, s3, 2
ds_read_b128 a[4:7], v2 offset:8192
v_cvt_pk_bf16_f32 v163, v166, v167
v_mfma_f32_16x16x32_bf16 v[60:63], a[108:111], a[52:55], v[60:63]
s_mul_i32 s81, s81, s67
ds_read_b128 a[12:15], v3 offset:8192
v_cvt_pk_bf16_f32 v152, v152, v153
v_mfma_f32_16x16x32_bf16 v[76:79], a[108:111], a[60:63], v[76:79]
s_lshl4_add_u32 s81, s81, s31
ds_read_b64 v[224:225], v2 offset:9216
v_cvt_pk_bf16_f32 v153, v154, v155
v_mfma_f32_16x16x32_bf16 v[76:79], a[104:107], a[56:59], v[76:79]
s_lshl2_add_u32 s81, s81, s30
ds_read_b64 v[228:229], v2 offset:9224
v_cvt_pk_bf16_f32 v154, v156, v157
v_mfma_f32_16x16x32_bf16 v[140:143], a[112:115], a[56:59], v[140:143]
s_mul_i32 s81, s81, 3328
ds_read_b64 v[240:241], v3 offset:9216
v_cvt_pk_bf16_f32 v155, v158, v159
v_mfma_f32_16x16x32_bf16 v[140:143], a[116:119], a[60:63], v[140:143]
s_mov_b32 s73, 0
ds_read_b64 v[244:245], v3 offset:9224
v_or_b32 v20, s66, v252
v_mfma_f32_16x16x32_bf16 v[124:127], a[116:119], a[52:55], v[124:127]
s_mov_b32 s72, 0x20000
v_or_b32 v21, s66, v253
v_or_b32 v22, s66, v254
v_mfma_f32_16x16x32_bf16 v[124:127], a[112:115], a[48:51], v[124:127]
s_lshl_b32 s67, s31, 15
v_or_b32 v23, s66, v255
v_mfma_f32_16x16x32_bf16 v[108:111], a[112:115], a[40:43], v[108:111]
s_add_u32 s67, s67, s78
s_mov_b32 s66, 0x3e8293ee
v_mul_f32 v72, s68, v72
v_mfma_f32_16x16x32_bf16 v[108:111], a[116:119], a[44:47], v[108:111]
s_add_u32 s67, s67, 33554432
v_mul_f32 v73, s68, v73
v_mul_f32 v74, s68, v74
v_mfma_f32_16x16x32_bf16 v[92:95], a[116:119], a[36:39], v[92:95]
s_mul_i32 s74, s3, 1310720
v_mul_f32 v75, s68, v75
v_mul_f32 v136, s68, v136
v_mfma_f32_16x16x32_bf16 v[92:95], a[112:115], a[32:35], v[92:95]
s_add_u32 s74, s74, s67
v_mul_f32 v137, s68, v137
v_mul_f32 v138, s68, v138
v_mfma_f32_16x16x32_bf16 v[32:35], a[72:75], a[32:35], v[32:35]
s_mul_i32 s75, s16, 1310720
v_mul_f32 v139, s68, v139
v_cvt_pk_bf16_f32 v72, v72, v73
v_mfma_f32_16x16x32_bf16 v[32:35], a[76:79], a[36:39], v[32:35]
s_add_u32 s75, s75, s67
v_cvt_pk_bf16_f32 v73, v74, v75
v_cvt_pk_bf16_f32 v74, v136, v137
v_mfma_f32_16x16x32_bf16 v[48:51], a[76:79], a[44:47], v[48:51]
s_mul_i32 s67, s31, 24576
v_cvt_pk_bf16_f32 v75, v138, v139
v_mul_f32 v56, s68, v56
v_mfma_f32_16x16x32_bf16 v[48:51], a[72:75], a[40:43], v[48:51]
s_sub_u32 s67, 1052672, s67
v_mul_f32 v57, s68, v57
v_mul_f32 v58, s68, v58
v_mfma_f32_16x16x32_bf16 v[64:67], a[72:75], a[48:51], v[64:67]
s_add_u32 s64, s74, s67
v_mul_f32 v59, s68, v59
v_mul_f32 v120, s68, v120
v_mfma_f32_16x16x32_bf16 v[64:67], a[76:79], a[52:55], v[64:67]
s_add_u32 s65, s75, s67
v_mul_f32 v121, s68, v121
v_mul_f32 v122, s68, v122
v_mfma_f32_16x16x32_bf16 v[80:83], a[76:79], a[60:63], v[80:83]
s_and_b32 s70, s30, 1
v_mul_f32 v123, s68, v123
v_cvt_pk_bf16_f32 v56, v56, v57
v_mfma_f32_16x16x32_bf16 v[80:83], a[72:75], a[56:59], v[80:83]
s_lshr_b32 s67, s30, 1
v_cvt_pk_bf16_f32 v57, v58, v59
v_cvt_pk_bf16_f32 v58, v120, v121
v_mfma_f32_16x16x32_bf16 v[144:147], a[80:83], a[56:59], v[144:147]
s_lshl3_add_u32 s71, s67, s70
v_cvt_pk_bf16_f32 v59, v122, v123
v_mul_f32 v40, s68, v40
v_mfma_f32_16x16x32_bf16 v[144:147], a[84:87], a[60:63], v[144:147]
s_add_u32 s71, s71, 4
v_mul_f32 v41, s68, v41
v_mul_f32 v42, s68, v42
v_mfma_f32_16x16x32_bf16 v[128:131], a[84:87], a[52:55], v[128:131]
s_lshl_b32 s71, s71, 13
v_mul_f32 v43, s68, v43
v_mul_f32 v104, s68, v104
v_mfma_f32_16x16x32_bf16 v[128:131], a[80:83], a[48:51], v[128:131]
s_lshl_b32 s70, s70, 14
v_mul_f32 v105, s68, v105
v_mul_f32 v106, s68, v106
v_mfma_f32_16x16x32_bf16 v[112:115], a[80:83], a[40:43], v[112:115]
s_mul_i32 s67, s67, 24576
v_mul_f32 v107, s68, v107
v_cvt_pk_bf16_f32 v40, v40, v41
v_mfma_f32_16x16x32_bf16 v[112:115], a[84:87], a[44:47], v[112:115]
s_sub_u32 s70, s70, s67
v_cvt_pk_bf16_f32 v41, v42, v43
v_cvt_pk_bf16_f32 v42, v104, v105
v_mfma_f32_16x16x32_bf16 v[96:99], a[84:87], a[36:39], v[96:99]
s_add_u32 s70, s70, 65536
v_cvt_pk_bf16_f32 v43, v106, v107
v_mul_f32 v24, s68, v24
v_mfma_f32_16x16x32_bf16 v[96:99], a[80:83], a[32:35], v[96:99]
s_waitcnt lgkmcnt(0)
v_mul_f32 v25, s68, v25
v_mul_f32 v26, s68, v26
v_mfma_f32_16x16x32_bf16 v[36:39], a[88:91], a[32:35], v[36:39]
v_mul_f32 v27, s68, v27
v_mul_f32 v88, s68, v88
v_mfma_f32_16x16x32_bf16 v[36:39], a[92:95], a[36:39], v[36:39]
v_mul_f32 v89, s68, v89
v_mul_f32 v90, s68, v90
v_mfma_f32_16x16x32_bf16 v[52:55], a[92:95], a[44:47], v[52:55]
v_mul_f32 v91, s68, v91
v_cvt_pk_bf16_f32 v24, v24, v25
v_mfma_f32_16x16x32_bf16 v[52:55], a[88:91], a[40:43], v[52:55]
v_cvt_pk_bf16_f32 v25, v26, v27
v_cvt_pk_bf16_f32 v26, v88, v89
v_mfma_f32_16x16x32_bf16 v[68:71], a[88:91], a[48:51], v[68:71]
v_cvt_pk_bf16_f32 v27, v90, v91
v_mul_f32 v76, s68, v76
v_mfma_f32_16x16x32_bf16 v[68:71], a[92:95], a[52:55], v[68:71]
v_mul_f32 v77, s68, v77
v_mul_f32 v78, s68, v78
v_mfma_f32_16x16x32_bf16 v[84:87], a[92:95], a[60:63], v[84:87]
v_mul_f32 v79, s68, v79
v_mul_f32 v140, s68, v140
v_mfma_f32_16x16x32_bf16 v[84:87], a[88:91], a[56:59], v[84:87]
v_mul_f32 v141, s68, v141
v_mul_f32 v142, s68, v142
v_mfma_f32_16x16x32_bf16 v[148:151], a[96:99], a[56:59], v[148:151]
v_mul_f32 v143, s68, v143
v_cvt_pk_bf16_f32 v76, v76, v77
v_mfma_f32_16x16x32_bf16 v[148:151], a[100:103], a[60:63], v[148:151]
v_cvt_pk_bf16_f32 v77, v78, v79
v_cvt_pk_bf16_f32 v78, v140, v141
v_mfma_f32_16x16x32_bf16 v[132:135], a[100:103], a[52:55], v[132:135]
v_cvt_pk_bf16_f32 v79, v142, v143
v_mul_f32 v60, s68, v60
v_mfma_f32_16x16x32_bf16 v[132:135], a[96:99], a[48:51], v[132:135]
v_mul_f32 v61, s68, v61
v_mul_f32 v62, s68, v62
v_mfma_f32_16x16x32_bf16 v[116:119], a[96:99], a[40:43], v[116:119]
v_mul_f32 v63, s68, v63
v_mul_f32 v124, s68, v124
v_mfma_f32_16x16x32_bf16 v[116:119], a[100:103], a[44:47], v[116:119]
v_mul_f32 v125, s68, v125
v_mul_f32 v126, s68, v126
v_mfma_f32_16x16x32_bf16 v[100:103], a[100:103], a[36:39], v[100:103]
v_mul_f32 v127, s68, v127
v_cvt_pk_bf16_f32 v60, v60, v61
v_mfma_f32_16x16x32_bf16 v[100:103], a[96:99], a[32:35], v[100:103]
v_cvt_pk_bf16_f32 v61, v62, v63
v_cvt_pk_bf16_f32 v62, v124, v125
v_cvt_pk_bf16_f32 v63, v126, v127
buffer_load_dwordx4 v[88:91], v16, s[44:47], s77 offen sc1
v_mfma_f32_16x16x32_bf16 v[196:199], v[192:195], v[160:163], v[248:251]
v_mfma_f32_16x16x32_bf16 v[212:215], v[208:211], v[176:179], v[248:251]
v_mfma_f32_16x16x32_bf16 v[164:167], a[4:7], v[160:163], v[252:255]
v_mfma_f32_16x16x32_bf16 v[180:183], a[12:15], v[176:179], v[252:255]
s_waitcnt vmcnt(24)
s_waitcnt vmcnt(25)
s_waitcnt vmcnt(26)
s_waitcnt vmcnt(27)
v_accvgpr_read_b32 v4, a64
v_accvgpr_read_b32 v5, a65
v_accvgpr_read_b32 v6, a66
v_accvgpr_read_b32 v7, a67
v_accvgpr_read_b32 v8, a68
v_accvgpr_read_b32 v9, a69
v_accvgpr_read_b32 v10, a70
v_accvgpr_read_b32 v11, a71
v_max3_f32 v121, v196, v197, v198
v_max3_f32 v121, v121, v199, v164
v_max3_f32 v121, v121, v165, v166
v_max_f32 v121, v121, v167
v_max3_f32 v123, v212, v213, v214
v_max3_f32 v123, v123, v215, v180
v_max3_f32 v123, v123, v181, v182
v_max_f32 v123, v123, v183
v_mov_b32 v105, v121
v_mov_b32 v107, v123
v_pk_mul_f32 v[28:29], v[28:29], s[68:69]
v_permlane16_swap_b32 v105, v121
v_permlane16_swap_b32 v107, v123
v_max_f32 v121, v121, v105
v_max_f32 v123, v123, v107
v_mov_b32 v105, v121
v_mov_b32 v107, v123
v_pk_mul_f32 v[30:31], v[30:31], s[68:69]
v_permlane32_swap_b32 v105, v121
v_permlane32_swap_b32 v107, v123
v_max_f32 v121, v121, v105
v_max_f32 v123, v123, v107
v_mul_f32 v121, s66, v121
v_mul_f32 v123, s66, v123
v_fma_f32 v164, v164, s66, -v121
v_fma_f32 v165, v165, s66, -v121
v_fma_f32 v166, v166, s66, -v121
v_fma_f32 v167, v167, s66, -v121
v_fma_f32 v196, v196, s66, -v121
v_fma_f32 v197, v197, s66, -v121
v_fma_f32 v198, v198, s66, -v121
v_fma_f32 v199, v199, s66, -v121
v_exp_f32 v164, v164
v_exp_f32 v165, v165
v_exp_f32 v166, v166
v_exp_f32 v167, v167
v_exp_f32 v196, v196
v_exp_f32 v197, v197
v_exp_f32 v198, v198
v_exp_f32 v199, v199
v_cvt_pk_bf16_f32 v164, v164, v165
v_cvt_pk_bf16_f32 v165, v166, v167
v_cvt_pk_bf16_f32 v166, v196, v197
v_cvt_pk_bf16_f32 v167, v198, v199
v_pk_mul_f32 v[92:93], v[92:93], s[68:69]
v_pk_mul_f32 v[94:95], v[94:95], s[68:69]
v_mfma_f32_16x16x32_bf16 v[196:199], a[244:247], v[164:167], 0
v_mfma_f32_16x16x32_bf16 v[160:163], v[224:227], v[164:167], 0
v_mfma_f32_16x16x32_bf16 v[192:195], v[228:231], v[164:167], 0
v_fma_f32 v180, v180, s66, -v123
v_fma_f32 v181, v181, s66, -v123
v_fma_f32 v182, v182, s66, -v123
v_fma_f32 v183, v183, s66, -v123
v_fma_f32 v212, v212, s66, -v123
v_fma_f32 v213, v213, s66, -v123
v_fma_f32 v214, v214, s66, -v123
v_fma_f32 v215, v215, s66, -v123
v_exp_f32 v180, v180
v_exp_f32 v181, v181
v_exp_f32 v182, v182
v_exp_f32 v183, v183
v_exp_f32 v212, v212
v_exp_f32 v213, v213
v_exp_f32 v214, v214
v_exp_f32 v215, v215
v_cvt_pk_bf16_f32 v180, v180, v181
v_cvt_pk_bf16_f32 v181, v182, v183
v_cvt_pk_bf16_f32 v182, v212, v213
v_cvt_pk_bf16_f32 v183, v214, v215
v_cvt_pk_bf16_f32 v28, v28, v29
v_cvt_pk_bf16_f32 v29, v30, v31
v_mfma_f32_16x16x32_bf16 v[212:215], a[244:247], v[180:183], 0
v_mfma_f32_16x16x32_bf16 v[176:179], v[240:243], v[180:183], 0
v_mfma_f32_16x16x32_bf16 v[208:211], v[244:247], v[180:183], 0
v_cvt_pk_bf16_f32 v30, v92, v93
v_cvt_pk_bf16_f32 v31, v94, v95
v_pk_mul_f32 v[44:45], v[44:45], s[68:69]
v_pk_mul_f32 v[46:47], v[46:47], s[68:69]
v_pk_mul_f32 v[108:109], v[108:109], s[68:69]
v_pk_mul_f32 v[110:111], v[110:111], s[68:69]
v_rcp_f32 v121, v196
v_rcp_f32 v123, v212
v_mul_f32 v121, v121, v7
v_mul_f32 v123, v123, v11
v_mul_f32 v160, v160, v121
v_mul_f32 v161, v161, v121
v_mul_f32 v162, v162, v121
v_mul_f32 v163, v163, v121
v_mul_f32 v192, v192, v121
v_mul_f32 v193, v193, v121
v_mul_f32 v194, v194, v121
v_mul_f32 v195, v195, v121
v_cvt_pk_bf16_f32 v160, v160, v161
v_cvt_pk_bf16_f32 v161, v162, v163
v_cvt_pk_bf16_f32 v162, v192, v193
v_cvt_pk_bf16_f32 v163, v194, v195
buffer_store_dwordx4 v[160:163], v16, s[44:47], s64 offen sc1
v_mul_f32 v176, v176, v123
v_mul_f32 v177, v177, v123
v_mul_f32 v178, v178, v123
v_mul_f32 v179, v179, v123
v_mul_f32 v208, v208, v123
v_mul_f32 v209, v209, v123
v_mul_f32 v210, v210, v123
v_mul_f32 v211, v211, v123
v_cvt_pk_bf16_f32 v176, v176, v177
v_cvt_pk_bf16_f32 v177, v178, v179
v_cvt_pk_bf16_f32 v178, v208, v209
v_cvt_pk_bf16_f32 v179, v210, v211
buffer_store_dwordx4 v[176:179], v16, s[44:47], s65 offen sc1
v_cvt_pk_bf16_f32 v44, v44, v45
v_cvt_pk_bf16_f32 v45, v46, v47
v_cvt_pk_bf16_f32 v46, v108, v109
v_cvt_pk_bf16_f32 v47, v110, v111
v_pk_mul_f32 v[32:33], v[32:33], s[68:69]
v_pk_mul_f32 v[34:35], v[34:35], s[68:69]
v_pk_mul_f32 v[96:97], v[96:97], s[68:69]
v_pk_mul_f32 v[98:99], v[98:99], s[68:69]
v_cvt_pk_bf16_f32 v32, v32, v33
v_cvt_pk_bf16_f32 v33, v34, v35
v_cvt_pk_bf16_f32 v34, v96, v97
v_cvt_pk_bf16_f32 v35, v98, v99
v_pk_mul_f32 v[48:49], v[48:49], s[68:69]
v_pk_mul_f32 v[50:51], v[50:51], s[68:69]
v_pk_mul_f32 v[112:113], v[112:113], s[68:69]
v_pk_mul_f32 v[114:115], v[114:115], s[68:69]
v_cvt_pk_bf16_f32 v48, v48, v49
v_cvt_pk_bf16_f32 v49, v50, v51
v_cvt_pk_bf16_f32 v50, v112, v113
v_cvt_pk_bf16_f32 v51, v114, v115
v_pk_mul_f32 v[64:65], v[64:65], s[68:69]
v_pk_mul_f32 v[66:67], v[66:67], s[68:69]
v_pk_mul_f32 v[128:129], v[128:129], s[68:69]
v_pk_mul_f32 v[130:131], v[130:131], s[68:69]
s_waitcnt vmcnt(2)
L_hchk:
v_max3_u32 v1, v88, v89, v90
v_max_u32 v1, v1, v91
v_cmp_eq_u32 vcc, -1, v1
s_cbranch_vccnz L_hretry
L_hgo:
ds_write_b128 v17, v[88:91]
s_sub_u32 s64, s64, 4096
s_sub_u32 s65, s65, 4096
v_cvt_pk_bf16_f32 v64, v64, v65
v_cvt_pk_bf16_f32 v65, v66, v67
v_cvt_pk_bf16_f32 v66, v128, v129
v_cvt_pk_bf16_f32 v67, v130, v131
v_pk_mul_f32 v[80:81], v[80:81], s[68:69]
v_pk_mul_f32 v[82:83], v[82:83], s[68:69]
v_pk_mul_f32 v[144:145], v[144:145], s[68:69]
v_pk_mul_f32 v[146:147], v[146:147], s[68:69]
s_waitcnt lgkmcnt(0)
s_barrier
ds_read_b128 a[0:3], v2 offset:0
ds_read_b128 a[8:11], v3 offset:0
ds_read_b64 v[216:217], v2 offset:1024
ds_read_b64 v[220:221], v2 offset:1032
ds_read_b64 v[232:233], v3 offset:1024
ds_read_b64 v[236:237], v3 offset:1032
v_cvt_pk_bf16_f32 v80, v80, v81
v_cvt_pk_bf16_f32 v81, v82, v83
v_cvt_pk_bf16_f32 v82, v144, v145
v_cvt_pk_bf16_f32 v83, v146, v147
v_pk_mul_f32 v[36:37], v[36:37], s[68:69]
v_pk_mul_f32 v[38:39], v[38:39], s[68:69]
v_pk_mul_f32 v[100:101], v[100:101], s[68:69]
v_pk_mul_f32 v[102:103], v[102:103], s[68:69]
v_cvt_pk_bf16_f32 v36, v36, v37
v_cvt_pk_bf16_f32 v37, v38, v39
v_cvt_pk_bf16_f32 v38, v100, v101
v_cvt_pk_bf16_f32 v39, v102, v103
v_pk_mul_f32 v[52:53], v[52:53], s[68:69]
v_pk_mul_f32 v[54:55], v[54:55], s[68:69]
v_pk_mul_f32 v[116:117], v[116:117], s[68:69]
v_pk_mul_f32 v[118:119], v[118:119], s[68:69]
v_mfma_f32_16x16x32_bf16 v[188:191], v[184:187], v[152:155], v[248:251]
v_mfma_f32_16x16x32_bf16 v[204:207], v[200:203], v[168:171], v[248:251]
s_waitcnt lgkmcnt(5)
v_mfma_f32_16x16x32_bf16 v[156:159], a[0:3], v[152:155], v[20:23]
s_waitcnt lgkmcnt(4)
v_mfma_f32_16x16x32_bf16 v[172:175], a[8:11], v[168:171], v[252:255]
v_cvt_pk_bf16_f32 v52, v52, v53
v_cvt_pk_bf16_f32 v53, v54, v55
v_cvt_pk_bf16_f32 v54, v116, v117
v_cvt_pk_bf16_f32 v55, v118, v119
v_pk_mul_f32 v[68:69], v[68:69], s[68:69]
v_pk_mul_f32 v[70:71], v[70:71], s[68:69]
v_pk_mul_f32 v[132:133], v[132:133], s[68:69]
v_pk_mul_f32 v[134:135], v[134:135], s[68:69]
v_max3_f32 v120, v188, v189, v190
v_max3_f32 v120, v120, v191, v156
v_max3_f32 v120, v120, v157, v158
v_max_f32 v120, v120, v159
v_max3_f32 v122, v204, v205, v206
v_max3_f32 v122, v122, v207, v172
v_max3_f32 v122, v122, v173, v174
v_max_f32 v122, v122, v175
v_mov_b32 v104, v120
v_mov_b32 v106, v122
v_cvt_pk_bf16_f32 v68, v68, v69
v_permlane16_swap_b32 v104, v120
v_permlane16_swap_b32 v106, v122
v_max_f32 v120, v120, v104
v_max_f32 v122, v122, v106
v_mov_b32 v104, v120
v_mov_b32 v106, v122
v_cvt_pk_bf16_f32 v69, v70, v71
v_permlane32_swap_b32 v104, v120
v_permlane32_swap_b32 v106, v122
v_max_f32 v120, v120, v104
v_max_f32 v122, v122, v106
v_mul_f32 v120, s66, v120
v_mul_f32 v122, s66, v122
v_fma_f32 v156, v156, s66, -v120
v_fma_f32 v157, v157, s66, -v120
v_fma_f32 v158, v158, s66, -v120
v_fma_f32 v159, v159, s66, -v120
v_fma_f32 v188, v188, s66, -v120
v_fma_f32 v189, v189, s66, -v120
v_fma_f32 v190, v190, s66, -v120
v_fma_f32 v191, v191, s66, -v120
v_exp_f32 v156, v156
v_exp_f32 v157, v157
v_exp_f32 v158, v158
v_exp_f32 v159, v159
v_exp_f32 v188, v188
v_exp_f32 v189, v189
v_exp_f32 v190, v190
v_exp_f32 v191, v191
v_cvt_pk_bf16_f32 v156, v156, v157
v_cvt_pk_bf16_f32 v157, v158, v159
v_cvt_pk_bf16_f32 v158, v188, v189
v_cvt_pk_bf16_f32 v159, v190, v191
v_cvt_pk_bf16_f32 v70, v132, v133
v_cvt_pk_bf16_f32 v71, v134, v135
v_mfma_f32_16x16x32_bf16 v[188:191], a[244:247], v[156:159], 0
s_waitcnt lgkmcnt(3)
v_mfma_f32_16x16x32_bf16 v[152:155], v[216:219], v[156:159], 0
s_waitcnt lgkmcnt(2)
v_mfma_f32_16x16x32_bf16 v[184:187], v[220:223], v[156:159], 0
v_fma_f32 v172, v172, s66, -v122
v_fma_f32 v173, v173, s66, -v122
v_fma_f32 v174, v174, s66, -v122
v_fma_f32 v175, v175, s66, -v122
v_fma_f32 v204, v204, s66, -v122
v_fma_f32 v205, v205, s66, -v122
v_fma_f32 v206, v206, s66, -v122
v_fma_f32 v207, v207, s66, -v122
v_exp_f32 v172, v172
v_exp_f32 v173, v173
v_exp_f32 v174, v174
v_exp_f32 v175, v175
v_exp_f32 v204, v204
v_exp_f32 v205, v205
v_exp_f32 v206, v206
v_exp_f32 v207, v207
v_cvt_pk_bf16_f32 v172, v172, v173
v_cvt_pk_bf16_f32 v173, v174, v175
v_cvt_pk_bf16_f32 v174, v204, v205
v_cvt_pk_bf16_f32 v175, v206, v207
v_pk_mul_f32 v[84:85], v[84:85], s[68:69]
v_pk_mul_f32 v[86:87], v[86:87], s[68:69]
v_mfma_f32_16x16x32_bf16 v[204:207], a[244:247], v[172:175], 0
s_waitcnt lgkmcnt(1)
v_mfma_f32_16x16x32_bf16 v[168:171], v[232:235], v[172:175], 0
s_waitcnt lgkmcnt(0)
v_mfma_f32_16x16x32_bf16 v[200:203], v[236:239], v[172:175], 0
v_pk_mul_f32 v[148:149], v[148:149], s[68:69]
v_pk_mul_f32 v[150:151], v[150:151], s[68:69]
v_cvt_pk_bf16_f32 v84, v84, v85
v_cvt_pk_bf16_f32 v85, v86, v87
v_cvt_pk_bf16_f32 v86, v148, v149
v_cvt_pk_bf16_f32 v87, v150, v151
v_rcp_f32 v120, v188
v_rcp_f32 v122, v204
v_mul_f32 v120, v120, v5
v_mul_f32 v122, v122, v9
v_mul_f32 v152, v152, v120
v_mul_f32 v153, v153, v120
v_mul_f32 v154, v154, v120
v_mul_f32 v155, v155, v120
v_mul_f32 v184, v184, v120
v_mul_f32 v185, v185, v120
v_mul_f32 v186, v186, v120
v_mul_f32 v187, v187, v120
v_cvt_pk_bf16_f32 v152, v152, v153
v_cvt_pk_bf16_f32 v153, v154, v155
v_cvt_pk_bf16_f32 v154, v184, v185
v_cvt_pk_bf16_f32 v155, v186, v187
buffer_store_dwordx4 v[152:155], v16, s[44:47], s64 offen sc1
v_mul_f32 v168, v168, v122
v_mul_f32 v169, v169, v122
v_mul_f32 v170, v170, v122
v_mul_f32 v171, v171, v122
v_mul_f32 v200, v200, v122
v_mul_f32 v201, v201, v122
v_mul_f32 v202, v202, v122
v_mul_f32 v203, v203, v122
v_cvt_pk_bf16_f32 v168, v168, v169
v_cvt_pk_bf16_f32 v169, v170, v171
v_cvt_pk_bf16_f32 v170, v200, v201
v_cvt_pk_bf16_f32 v171, v202, v203
buffer_store_dwordx4 v[168:171], v16, s[44:47], s65 offen sc1
v_mov_b32 v17, 0xff800000
v_and_b32 v5, 1, v0
v_mul_u32_u24 v5, 0xaaaa, v5
v_add_u32 v5, 0x4444, v5
v_lshl_or_b32 v5, v5, 16, v5
L_attstart_7:
v_mov_b32 v2, v16
v_add_u32 v3, 0x10000, v16
v_mov_b32 v1, 0
s_waitcnt lgkmcnt(0)
s_barrier
s_cmp_eq_u32 s3, 0
s_cbranch_scc1 L_F1
ds_read_b128 a[144:147], v2 offset:0
ds_read_b128 a[148:151], v2 offset:1024
ds_read_b128 a[152:155], v2 offset:2048
ds_read_b128 a[156:159], v2 offset:3072
ds_read_b128 a[160:163], v2 offset:4096
ds_read_b128 a[164:167], v2 offset:5120
ds_read_b128 a[168:171], v2 offset:6144
ds_read_b128 a[172:175], v2 offset:7168
s_mov_b32 m0, s71
s_nop 0
buffer_load_dwordx4 v16, s[32:35], s70 offen offset:0 sc1 lds
buffer_load_dwordx4 v16, s[32:35], s70 offen offset:1024 sc1 lds
s_waitcnt lgkmcnt(7)
v_mfma_f32_16x16x32_bf16 v[88:91], a[144:147], v[24:27], 0
s_waitcnt lgkmcnt(6)
ds_read_b128 a[176:179], v2 offset:8192
v_accvgpr_write_b32 a128, 0
v_mfma_f32_16x16x32_bf16 v[88:91], a[148:151], v[28:31], v[88:91]
s_waitcnt lgkmcnt(6)
ds_read_b128 a[180:183], v2 offset:9216
v_accvgpr_write_b32 a129, 0
v_mfma_f32_16x16x32_bf16 v[88:91], a[152:155], v[32:35], v[88:91]
s_waitcnt lgkmcnt(6)
buffer_load_dwordx4 v16, s[32:35], s70 offen offset:2048 sc1 lds
v_mfma_f32_16x16x32_bf16 v[88:91], a[156:159], v[36:39], v[88:91]
ds_read_b128 a[184:187], v2 offset:10240
v_accvgpr_write_b32 a130, 0
v_mfma_f32_16x16x32_bf16 v[104:107], a[156:159], v[52:55], 0
ds_read_b128 a[188:191], v2 offset:11264
v_accvgpr_write_b32 a131, 0
v_mfma_f32_16x16x32_bf16 v[104:107], a[152:155], v[48:51], v[104:107]
ds_read_b128 a[192:195], v2 offset:12288
v_accvgpr_write_b32 a132, 0
v_mfma_f32_16x16x32_bf16 v[104:107], a[148:151], v[44:47], v[104:107]
ds_read_b128 a[196:199], v2 offset:13312
v_accvgpr_write_b32 a133, 0
v_mfma_f32_16x16x32_bf16 v[104:107], a[144:147], v[40:43], v[104:107]
ds_read_b128 a[200:203], v2 offset:14336
v_accvgpr_write_b32 a134, 0
v_mfma_f32_16x16x32_bf16 v[120:123], a[144:147], v[56:59], 0
ds_read_b128 a[204:207], v2 offset:15360
v_accvgpr_write_b32 a135, 0
v_mfma_f32_16x16x32_bf16 v[120:123], a[148:151], v[60:63], v[120:123]
buffer_load_dwordx4 v16, s[32:35], s70 offen offset:3072 sc1 lds
v_mfma_f32_16x16x32_bf16 v[120:123], a[152:155], v[64:67], v[120:123]
v_accvgpr_write_b32 a136, 0
v_accvgpr_write_b32 a137, 0
v_mfma_f32_16x16x32_bf16 v[120:123], a[156:159], v[68:71], v[120:123]
v_accvgpr_write_b32 a138, 0
v_accvgpr_write_b32 a139, 0
v_mfma_f32_16x16x32_bf16 v[136:139], a[156:159], v[84:87], 0
v_accvgpr_write_b32 a140, 0
v_accvgpr_write_b32 a141, 0
v_mfma_f32_16x16x32_bf16 v[136:139], a[152:155], v[80:83], v[136:139]
v_accvgpr_write_b32 a142, 0
v_accvgpr_write_b32 a143, 0
v_mfma_f32_16x16x32_bf16 v[136:139], a[148:151], v[76:79], v[136:139]
v_mfma_f32_16x16x32_bf16 v[136:139], a[144:147], v[72:75], v[136:139]
s_waitcnt lgkmcnt(0)
s_nop 1
v_max3_f32 v20, v88, v89, v90
v_max_f32 v20, v20, v91
v_max3_f32 v21, v104, v105, v106
v_max_f32 v21, v21, v107
v_max3_f32 v22, v120, v121, v122
v_max_f32 v22, v22, v123
v_max3_f32 v23, v136, v137, v138
v_max_f32 v23, v23, v139
v_mov_b32 v248, v20
v_mov_b32 v249, v21
v_mov_b32 v250, v22
v_mov_b32 v251, v23
v_permlane16_swap_b32 v248, v20
v_permlane16_swap_b32 v249, v21
v_permlane16_swap_b32 v250, v22
v_permlane16_swap_b32 v251, v23
v_max_f32 v20, v20, v248
v_max_f32 v21, v21, v249
v_max_f32 v22, v22, v250
v_max_f32 v23, v23, v251
v_mov_b32 v248, v20
v_mov_b32 v249, v21
v_mov_b32 v250, v22
v_mov_b32 v251, v23
v_permlane32_swap_b32 v248, v20
v_permlane32_swap_b32 v249, v21
v_permlane32_swap_b32 v250, v22
v_permlane32_swap_b32 v251, v23
v_max_f32 v20, v20, v248
v_max_f32 v21, v21, v249
v_max_f32 v22, v22, v250
v_max_f32 v23, v23, v251
s_cmp_eq_u32 s73, 0
s_cselect_b64 vcc, 0, -1
v_cndmask_b32 v20, v20, v252, vcc
v_cndmask_b32 v21, v21, v253, vcc
v_cndmask_b32 v22, v22, v254, vcc
v_cndmask_b32 v23, v23, v255, vcc
v_sub_f32 v228, 0, v23
v_sub_f32 v229, 0, v23
v_sub_f32 v230, 0, v23
v_sub_f32 v231, 0, v23
v_sub_f32 v224, 0, v22
v_sub_f32 v225, 0, v22
v_sub_f32 v226, 0, v22
v_sub_f32 v227, 0, v22
v_sub_f32 v220, 0, v21
v_sub_f32 v221, 0, v21
v_sub_f32 v222, 0, v21
v_sub_f32 v223, 0, v21
v_sub_f32 v216, 0, v20
v_sub_f32 v217, 0, v20
v_sub_f32 v218, 0, v20
v_sub_f32 v219, 0, v20
v_mfma_f32_16x16x32_bf16 v[140:143], a[160:163], v[72:75], v[228:231]
s_add_u32 m0, s71, 4096
v_add_f32 v88, v88, v216
v_add_f32 v89, v89, v216
v_mfma_f32_16x16x32_bf16 v[140:143], a[164:167], v[76:79], v[140:143]
v_add_f32 v90, v90, v216
v_add_f32 v91, v91, v216
v_exp_f32 v88, v88
v_mfma_f32_16x16x32_bf16 v[140:143], a[168:171], v[80:83], v[140:143]
s_add_u32 s64, s70, 4096
v_exp_f32 v89, v89
v_mfma_f32_16x16x32_bf16 v[140:143], a[172:175], v[84:87], v[140:143]
buffer_load_dwordx4 v16, s[32:35], s64 offen offset:0 sc1 lds
v_mfma_f32_16x16x32_bf16 v[124:127], a[172:175], v[68:71], v[224:227]
v_exp_f32 v90, v90
v_mfma_f32_16x16x32_bf16 v[124:127], a[168:171], v[64:67], v[124:127]
v_exp_f32 v91, v91
v_mfma_f32_16x16x32_bf16 v[124:127], a[164:167], v[60:63], v[124:127]
v_add_f32 v104, v104, v220
v_add_f32 v105, v105, v220
v_add_f32 v106, v106, v220
v_add_f32 v107, v107, v220
v_exp_f32 v104, v104
v_mfma_f32_16x16x32_bf16 v[124:127], a[160:163], v[56:59], v[124:127]
v_exp_f32 v105, v105
v_mfma_f32_16x16x32_bf16 v[108:111], a[160:163], v[40:43], v[220:223]
v_exp_f32 v106, v106
v_mfma_f32_16x16x32_bf16 v[108:111], a[164:167], v[44:47], v[108:111]
buffer_load_dwordx4 v16, s[32:35], s64 offen offset:1024 sc1 lds
v_mfma_f32_16x16x32_bf16 v[108:111], a[168:171], v[48:51], v[108:111]
v_cvt_pk_bf16_f32 v152, v88, v89
v_add_f32 v120, v120, v224
v_mfma_f32_16x16x32_bf16 v[108:111], a[172:175], v[52:55], v[108:111]
v_exp_f32 v107, v107
v_mfma_f32_16x16x32_bf16 v[92:95], a[172:175], v[36:39], v[216:219]
v_add_f32 v121, v121, v224
v_add_f32 v122, v122, v224
v_add_f32 v123, v123, v224
v_exp_f32 v120, v120
v_mfma_f32_16x16x32_bf16 v[92:95], a[168:171], v[32:35], v[92:95]
v_cvt_pk_bf16_f32 v153, v90, v91
v_exp_f32 v121, v121
v_mfma_f32_16x16x32_bf16 v[92:95], a[164:167], v[28:31], v[92:95]
v_exp_f32 v122, v122
v_mfma_f32_16x16x32_bf16 v[92:95], a[160:163], v[24:27], v[92:95]
v_exp_f32 v123, v123
v_mfma_f32_16x16x32_bf16 v[96:99], a[176:179], v[24:27], v[216:219]
v_cvt_pk_bf16_f32 v160, v104, v105
v_add_f32 v136, v136, v228
v_mfma_f32_16x16x32_bf16 v[96:99], a[180:183], v[28:31], v[96:99]
buffer_load_dwordx4 v16, s[32:35], s64 offen offset:2048 sc1 lds
v_add_f32 v137, v137, v228
v_add_f32 v138, v138, v228
v_add_f32 v139, v139, v228
v_exp_f32 v136, v136
v_mfma_f32_16x16x32_bf16 v[96:99], a[184:187], v[32:35], v[96:99]
v_exp_f32 v137, v137
v_mfma_f32_16x16x32_bf16 v[96:99], a[188:191], v[36:39], v[96:99]
v_cvt_pk_bf16_f32 v161, v106, v107
v_cvt_pk_bf16_f32 v184, v120, v121
v_mfma_f32_16x16x32_bf16 v[112:115], a[188:191], v[52:55], v[220:223]
v_exp_f32 v138, v138
v_mfma_f32_16x16x32_bf16 v[112:115], a[184:187], v[48:51], v[112:115]
v_exp_f32 v139, v139
v_mfma_f32_16x16x32_bf16 v[112:115], a[180:183], v[44:47], v[112:115]
v_exp_f32 v140, v140
v_mfma_f32_16x16x32_bf16 v[112:115], a[176:179], v[40:43], v[112:115]
v_exp_f32 v141, v141
v_mfma_f32_16x16x32_bf16 v[128:131], a[176:179], v[56:59], v[224:227]
buffer_load_dwordx4 v16, s[32:35], s64 offen offset:3072 sc1 lds
v_cvt_pk_bf16_f32 v185, v122, v123
v_mfma_f32_16x16x32_bf16 v[128:131], a[180:183], v[60:63], v[128:131]
v_exp_f32 v142, v142
v_mfma_f32_16x16x32_bf16 v[128:131], a[184:187], v[64:67], v[128:131]
v_exp_f32 v143, v143
v_mfma_f32_16x16x32_bf16 v[128:131], a[188:191], v[68:71], v[128:131]
v_cvt_pk_bf16_f32 v192, v136, v137
v_cvt_pk_bf16_f32 v193, v138, v139
v_mfma_f32_16x16x32_bf16 v[144:147], a[188:191], v[84:87], v[228:231]
v_exp_f32 v124, v124
v_mfma_f32_16x16x32_bf16 v[144:147], a[184:187], v[80:83], v[144:147]
v_exp_f32 v125, v125
v_mfma_f32_16x16x32_bf16 v[144:147], a[180:183], v[76:79], v[144:147]
s_waitcnt vmcnt(8)
s_barrier
v_mfma_f32_16x16x32_bf16 v[144:147], a[176:179], v[72:75], v[144:147]
v_exp_f32 v126, v126
v_mfma_f32_16x16x32_bf16 v[148:151], a[192:195], v[72:75], v[228:231]
v_cvt_pk_bf16_f32 v194, v140, v141
v_cvt_pk_bf16_f32 v195, v142, v143
v_mfma_f32_16x16x32_bf16 v[148:151], a[196:199], v[76:79], v[148:151]
v_exp_f32 v127, v127
v_mfma_f32_16x16x32_bf16 v[148:151], a[200:203], v[80:83], v[148:151]
s_xor_b32 s71, s71, 16384
v_exp_f32 v108, v108
v_mfma_f32_16x16x32_bf16 v[148:151], a[204:207], v[84:87], v[148:151]
s_add_u32 s70, s70, 32768
v_exp_f32 v109, v109
v_mfma_f32_16x16x32_bf16 v[132:135], a[204:207], v[68:71], v[224:227]
s_mov_b32 m0, s71
v_exp_f32 v110, v110
v_mfma_f32_16x16x32_bf16 v[132:135], a[200:203], v[64:67], v[132:135]
buffer_load_dwordx4 v16, s[32:35], s70 offen offset:0 sc1 lds
v_mfma_f32_16x16x32_bf16 v[132:135], a[196:199], v[60:63], v[132:135]
v_cvt_pk_bf16_f32 v186, v124, v125
v_exp_f32 v111, v111
v_mfma_f32_16x16x32_bf16 v[132:135], a[192:195], v[56:59], v[132:135]
v_exp_f32 v92, v92
v_mfma_f32_16x16x32_bf16 v[116:119], a[192:195], v[40:43], v[220:223]
v_exp_f32 v93, v93
v_mfma_f32_16x16x32_bf16 v[116:119], a[196:199], v[44:47], v[116:119]
ds_read_b128 a[144:147], v2 offset:16384
v_cvt_pk_bf16_f32 v187, v126, v127
v_mfma_f32_16x16x32_bf16 v[116:119], a[200:203], v[48:51], v[116:119]
v_exp_f32 v94, v94
v_mfma_f32_16x16x32_bf16 v[116:119], a[204:207], v[52:55], v[116:119]
ds_read_b128 a[148:151], v2 offset:17408
v_cvt_pk_bf16_f32 v162, v108, v109
v_mfma_f32_16x16x32_bf16 v[100:103], a[204:207], v[36:39], v[216:219]
ds_read_b128 a[152:155], v2 offset:18432
buffer_load_dwordx4 v16, s[32:35], s70 offen offset:1024 sc1 lds
v_exp_f32 v95, v95
v_mfma_f32_16x16x32_bf16 v[100:103], a[200:203], v[32:35], v[100:103]
ds_read_b128 a[156:159], v2 offset:19456
v_exp_f32 v96, v96
v_mfma_f32_16x16x32_bf16 v[100:103], a[196:199], v[28:31], v[100:103]
v_cvt_pk_bf16_f32 v163, v110, v111
v_exp_f32 v97, v97
v_mfma_f32_16x16x32_bf16 v[100:103], a[192:195], v[24:27], v[100:103]
s_waitcnt lgkmcnt(3)
ds_read_b128 a[160:163], v2 offset:20480
ds_read_b128 a[164:167], v2 offset:21504
ds_read_b128 a[168:171], v2 offset:22528
ds_read_b128 a[172:175], v2 offset:23552
v_mfma_f32_16x16x32_bf16 v[88:91], a[144:147], v[24:27], v[216:219]
s_waitcnt lgkmcnt(6)
v_exp_f32 v98, v98
v_mfma_f32_16x16x32_bf16 v[88:91], a[148:151], v[28:31], v[88:91]
s_waitcnt lgkmcnt(5)
v_cvt_pk_bf16_f32 v154, v92, v93
v_exp_f32 v99, v99
v_mfma_f32_16x16x32_bf16 v[88:91], a[152:155], v[32:35], v[88:91]
s_waitcnt lgkmcnt(4)
v_exp_f32 v112, v112
v_mfma_f32_16x16x32_bf16 v[88:91], a[156:159], v[36:39], v[88:91]
v_exp_f32 v113, v113
v_mfma_f32_16x16x32_bf16 v[104:107], a[156:159], v[52:55], v[220:223]
v_cvt_pk_bf16_f32 v155, v94, v95
v_cvt_pk_bf16_f32 v156, v96, v97
v_mfma_f32_16x16x32_bf16 v[104:107], a[152:155], v[48:51], v[104:107]
buffer_load_dwordx4 v16, s[32:35], s70 offen offset:2048 sc1 lds
v_exp_f32 v114, v114
v_mfma_f32_16x16x32_bf16 v[104:107], a[148:151], v[44:47], v[104:107]
v_exp_f32 v115, v115
v_mfma_f32_16x16x32_bf16 v[104:107], a[144:147], v[40:43], v[104:107]
v_exp_f32 v128, v128
v_mfma_f32_16x16x32_bf16 v[120:123], a[144:147], v[56:59], v[224:227]
v_exp_f32 v129, v129
v_mfma_f32_16x16x32_bf16 v[120:123], a[148:151], v[60:63], v[120:123]
v_cvt_pk_bf16_f32 v157, v98, v99
v_cvt_pk_bf16_f32 v164, v112, v113
v_mfma_f32_16x16x32_bf16 v[120:123], a[152:155], v[64:67], v[120:123]
v_exp_f32 v130, v130
v_mfma_f32_16x16x32_bf16 v[120:123], a[156:159], v[68:71], v[120:123]
v_exp_f32 v131, v131
v_mfma_f32_16x16x32_bf16 v[136:139], a[156:159], v[84:87], v[228:231]
v_exp_f32 v144, v144
v_mfma_f32_16x16x32_bf16 v[136:139], a[152:155], v[80:83], v[136:139]
v_exp_f32 v145, v145
v_mfma_f32_16x16x32_bf16 v[136:139], a[148:151], v[76:79], v[136:139]
v_exp_f32 v146, v146
v_mfma_f32_16x16x32_bf16 v[136:139], a[144:147], v[72:75], v[136:139]
s_waitcnt lgkmcnt(0)
v_cvt_pk_bf16_f32 v165, v114, v115
v_cvt_pk_bf16_f32 v188, v128, v129
v_mfma_f32_16x16x32_bf16 v[140:143], a[160:163], v[72:75], v[228:231]
v_exp_f32 v147, v147
v_mfma_f32_16x16x32_bf16 v[140:143], a[164:167], v[76:79], v[140:143]
v_exp_f32 v148, v148
v_mfma_f32_16x16x32_bf16 v[140:143], a[168:171], v[80:83], v[140:143]
v_exp_f32 v149, v149
v_mfma_f32_16x16x32_bf16 v[140:143], a[172:175], v[84:87], v[140:143]
buffer_load_dwordx4 v16, s[32:35], s70 offen offset:3072 sc1 lds
v_mfma_f32_16x16x32_bf16 v[124:127], a[172:175], v[68:71], v[224:227]
v_cvt_pk_bf16_f32 v189, v130, v131
v_cvt_pk_bf16_f32 v196, v144, v145
v_mfma_f32_16x16x32_bf16 v[124:127], a[168:171], v[64:67], v[124:127]
v_exp_f32 v150, v150
v_mfma_f32_16x16x32_bf16 v[124:127], a[164:167], v[60:63], v[124:127]
v_exp_f32 v151, v151
v_mfma_f32_16x16x32_bf16 v[124:127], a[160:163], v[56:59], v[124:127]
v_exp_f32 v132, v132
v_mfma_f32_16x16x32_bf16 v[108:111], a[160:163], v[40:43], v[220:223]
ds_read_b128 a[176:179], v2 offset:24576
v_cvt_pk_bf16_f32 v197, v146, v147
v_mfma_f32_16x16x32_bf16 v[108:111], a[164:167], v[44:47], v[108:111]
ds_read_b128 a[180:183], v2 offset:25600
v_cvt_pk_bf16_f32 v198, v148, v149
v_mfma_f32_16x16x32_bf16 v[108:111], a[168:171], v[48:51], v[108:111]
ds_read_b128 a[184:187], v2 offset:26624
v_exp_f32 v133, v133
v_mfma_f32_16x16x32_bf16 v[108:111], a[172:175], v[52:55], v[108:111]
ds_read_b128 a[188:191], v2 offset:27648
v_exp_f32 v134, v134
v_mfma_f32_16x16x32_bf16 v[92:95], a[172:175], v[36:39], v[216:219]
v_exp_f32 v135, v135
v_mfma_f32_16x16x32_bf16 v[92:95], a[168:171], v[32:35], v[92:95]
v_exp_f32 v116, v116
v_mfma_f32_16x16x32_bf16 v[92:95], a[164:167], v[28:31], v[92:95]
v_exp_f32 v117, v117
v_mfma_f32_16x16x32_bf16 v[92:95], a[160:163], v[24:27], v[92:95]
s_waitcnt lgkmcnt(2)
v_cvt_pk_bf16_f32 v199, v150, v151
v_cvt_pk_bf16_f32 v190, v132, v133
v_mfma_f32_16x16x32_bf16 v[96:99], a[176:179], v[24:27], v[216:219]
v_exp_f32 v118, v118
v_mfma_f32_16x16x32_bf16 v[96:99], a[180:183], v[28:31], v[96:99]
s_waitcnt lgkmcnt(0)
s_add_u32 m0, s71, 4096
v_exp_f32 v119, v119
v_mfma_f32_16x16x32_bf16 v[96:99], a[184:187], v[32:35], v[96:99]
s_add_u32 s64, s70, 4096
v_exp_f32 v100, v100
v_mfma_f32_16x16x32_bf16 v[96:99], a[188:191], v[36:39], v[96:99]
buffer_load_dwordx4 v16, s[32:35], s64 offen offset:0 sc1 lds
v_mfma_f32_16x16x32_bf16 v[112:115], a[188:191], v[52:55], v[220:223]
v_exp_f32 v101, v101
v_mfma_f32_16x16x32_bf16 v[112:115], a[184:187], v[48:51], v[112:115]
v_cvt_pk_bf16_f32 v191, v134, v135
v_cvt_pk_bf16_f32 v166, v116, v117
v_mfma_f32_16x16x32_bf16 v[112:115], a[180:183], v[44:47], v[112:115]
v_exp_f32 v102, v102
v_mfma_f32_16x16x32_bf16 v[112:115], a[176:179], v[40:43], v[112:115]
v_exp_f32 v103, v103
v_mfma_f32_16x16x32_bf16 v[128:131], a[176:179], v[56:59], v[224:227]
s_lshl_b32 s66, s30, 30
ds_read_b128 a[192:195], v2 offset:28672
v_cvt_pk_bf16_f32 v167, v118, v119
v_mfma_f32_16x16x32_bf16 v[128:131], a[180:183], v[60:63], v[128:131]
ds_read_b128 a[196:199], v2 offset:29696
v_exp_f32 v88, v88
v_mfma_f32_16x16x32_bf16 v[128:131], a[184:187], v[64:67], v[128:131]
ds_read_b128 a[200:203], v2 offset:30720
v_exp_f32 v89, v89
v_mfma_f32_16x16x32_bf16 v[128:131], a[188:191], v[68:71], v[128:131]
ds_read_b128 a[204:207], v2 offset:31744
v_cvt_pk_bf16_f32 v158, v100, v101
v_mfma_f32_16x16x32_bf16 v[144:147], a[188:191], v[84:87], v[228:231]
v_exp_f32 v90, v90
v_mfma_f32_16x16x32_bf16 v[144:147], a[184:187], v[80:83], v[144:147]
v_exp_f32 v91, v91
v_mfma_f32_16x16x32_bf16 v[144:147], a[180:183], v[76:79], v[144:147]
v_exp_f32 v104, v104
v_mfma_f32_16x16x32_bf16 v[144:147], a[176:179], v[72:75], v[144:147]
s_waitcnt lgkmcnt(2)
v_exp_f32 v105, v105
v_mfma_f32_16x16x32_bf16 v[148:151], a[192:195], v[72:75], v[228:231]
v_cvt_pk_bf16_f32 v159, v102, v103
v_cvt_pk_bf16_f32 v168, v88, v89
v_mfma_f32_16x16x32_bf16 v[148:151], a[196:199], v[76:79], v[148:151]
s_waitcnt lgkmcnt(0)
v_exp_f32 v106, v106
v_mfma_f32_16x16x32_bf16 v[148:151], a[200:203], v[80:83], v[148:151]
v_exp_f32 v107, v107
v_mfma_f32_16x16x32_bf16 v[148:151], a[204:207], v[84:87], v[148:151]
buffer_load_dwordx4 v16, s[32:35], s64 offen offset:1024 sc1 lds
v_mfma_f32_16x16x32_bf16 v[132:135], a[204:207], v[68:71], v[224:227]
v_exp_f32 v120, v120
v_mfma_f32_16x16x32_bf16 v[132:135], a[200:203], v[64:67], v[132:135]
v_cvt_pk_bf16_f32 v169, v90, v91
v_cvt_pk_bf16_f32 v176, v104, v105
v_mfma_f32_16x16x32_bf16 v[132:135], a[196:199], v[60:63], v[132:135]
v_exp_f32 v121, v121
v_mfma_f32_16x16x32_bf16 v[132:135], a[192:195], v[56:59], v[132:135]
v_exp_f32 v122, v122
v_mfma_f32_16x16x32_bf16 v[116:119], a[192:195], v[40:43], v[220:223]
v_exp_f32 v123, v123
v_mfma_f32_16x16x32_bf16 v[116:119], a[196:199], v[44:47], v[116:119]
v_exp_f32 v136, v136
v_mfma_f32_16x16x32_bf16 v[116:119], a[200:203], v[48:51], v[116:119]
v_exp_f32 v137, v137
v_mfma_f32_16x16x32_bf16 v[116:119], a[204:207], v[52:55], v[116:119]
ds_read_b128 a[144:147], v3 offset:16384
v_cvt_pk_bf16_f32 v177, v106, v107
v_mfma_f32_16x16x32_bf16 v[100:103], a[204:207], v[36:39], v[216:219]
v_exp_f32 v138, v138
v_mfma_f32_16x16x32_bf16 v[100:103], a[200:203], v[32:35], v[100:103]
ds_read_b128 a[148:151], v3 offset:24576
v_cvt_pk_bf16_f32 v200, v120, v121
v_mfma_f32_16x16x32_bf16 v[100:103], a[196:199], v[28:31], v[100:103]
v_exp_f32 v139, v139
v_mfma_f32_16x16x32_bf16 v[100:103], a[192:195], v[24:27], v[100:103]
v_exp_f32 v140, v140
v_smfmac_f32_16x16x64_bf16 a[128:131], a[240:243], v[152:159], v5
v_cvt_pk_bf16_f32 v201, v122, v123
v_smfmac_f32_16x16x64_bf16 a[132:135], a[240:243], v[160:167], v5
v_exp_f32 v141, v141
v_smfmac_f32_16x16x64_bf16 a[136:139], a[240:243], v[184:191], v5
v_exp_f32 v142, v142
v_smfmac_f32_16x16x64_bf16 a[140:143], a[240:243], v[192:199], v5
s_waitcnt lgkmcnt(0)
buffer_load_dwordx4 v16, s[32:35], s64 offen offset:2048 sc1 lds
v_cvt_pk_bf16_f32 v208, v136, v137
v_mfma_f32_16x16x32_bf16 a[0:3], a[144:147], v[152:155], 0
ds_read_b128 a[152:155], v3 offset:17408
v_exp_f32 v143, v143
v_mfma_f32_16x16x32_bf16 a[0:3], a[148:151], v[156:159], a[0:3]
ds_read_b128 a[156:159], v3 offset:25600
v_exp_f32 v124, v124
v_mfma_f32_16x16x32_bf16 a[32:35], a[148:151], v[164:167], 0
v_cvt_pk_bf16_f32 v209, v138, v139
v_exp_f32 v125, v125
v_mfma_f32_16x16x32_bf16 a[32:35], a[144:147], v[160:163], a[32:35]
v_exp_f32 v126, v126
v_mfma_f32_16x16x32_bf16 a[64:67], a[144:147], v[184:187], 0
v_exp_f32 v127, v127
v_mfma_f32_16x16x32_bf16 a[64:67], a[148:151], v[188:191], a[64:67]
v_cvt_pk_bf16_f32 v210, v140, v141
v_cvt_pk_bf16_f32 v211, v142, v143
v_mfma_f32_16x16x32_bf16 a[96:99], a[148:151], v[196:199], 0
v_exp_f32 v108, v108
v_mfma_f32_16x16x32_bf16 a[96:99], a[144:147], v[192:195], a[96:99]
s_waitcnt lgkmcnt(0)
v_exp_f32 v109, v109
v_mfma_f32_16x16x32_bf16 a[100:103], a[152:155], v[192:195], 0
ds_read_b128 a[160:163], v3 offset:18432
v_cvt_pk_bf16_f32 v202, v124, v125
v_mfma_f32_16x16x32_bf16 a[100:103], a[156:159], v[196:199], a[100:103]
ds_read_b128 a[164:167], v3 offset:26624
v_exp_f32 v110, v110
v_mfma_f32_16x16x32_bf16 a[68:71], a[156:159], v[188:191], 0
v_exp_f32 v111, v111
v_mfma_f32_16x16x32_bf16 a[68:71], a[152:155], v[184:187], a[68:71]
v_exp_f32 v92, v92
v_mfma_f32_16x16x32_bf16 a[36:39], a[152:155], v[160:163], 0
v_exp_f32 v93, v93
v_mfma_f32_16x16x32_bf16 a[36:39], a[156:159], v[164:167], a[36:39]
v_cvt_pk_bf16_f32 v203, v126, v127
v_cvt_pk_bf16_f32 v178, v108, v109
v_mfma_f32_16x16x32_bf16 a[4:7], a[156:159], v[156:159], 0
buffer_load_dwordx4 v16, s[32:35], s64 offen offset:3072 sc1 lds
v_mfma_f32_16x16x32_bf16 a[4:7], a[152:155], v[152:155], a[4:7]
s_waitcnt lgkmcnt(0)
v_exp_f32 v94, v94
v_mfma_f32_16x16x32_bf16 a[8:11], a[160:163], v[152:155], 0
ds_read_b128 a[168:171], v3 offset:19456
v_cvt_pk_bf16_f32 v179, v110, v111
v_mfma_f32_16x16x32_bf16 a[8:11], a[164:167], v[156:159], a[8:11]
ds_read_b128 a[172:175], v3 offset:27648
v_exp_f32 v95, v95
v_mfma_f32_16x16x32_bf16 a[40:43], a[164:167], v[164:167], 0
v_exp_f32 v96, v96
v_mfma_f32_16x16x32_bf16 a[40:43], a[160:163], v[160:163], a[40:43]
v_exp_f32 v97, v97
v_mfma_f32_16x16x32_bf16 a[72:75], a[160:163], v[184:187], 0
v_exp_f32 v98, v98
v_mfma_f32_16x16x32_bf16 a[72:75], a[164:167], v[188:191], a[72:75]
v_exp_f32 v99, v99
v_mfma_f32_16x16x32_bf16 a[104:107], a[164:167], v[196:199], 0
ds_read_b128 a[176:179], v3 offset:20480
v_cvt_pk_bf16_f32 v170, v92, v93
v_mfma_f32_16x16x32_bf16 a[104:107], a[160:163], v[192:195], a[104:107]
s_waitcnt lgkmcnt(1)
v_exp_f32 v112, v112
v_mfma_f32_16x16x32_bf16 a[108:111], a[168:171], v[192:195], 0
v_exp_f32 v113, v113
v_mfma_f32_16x16x32_bf16 a[108:111], a[172:175], v[196:199], a[108:111]
ds_read_b128 a[180:183], v3 offset:28672
v_cvt_pk_bf16_f32 v171, v94, v95
v_mfma_f32_16x16x32_bf16 a[76:79], a[172:175], v[188:191], 0
v_exp_f32 v114, v114
v_mfma_f32_16x16x32_bf16 a[76:79], a[168:171], v[184:187], a[76:79]
v_cvt_pk_bf16_f32 v172, v96, v97
v_xor_b32 v2, 0x8000, v2
v_mfma_f32_16x16x32_bf16 a[44:47], a[168:171], v[160:163], 0
ds_read_b128 a[184:187], v3 offset:21504
ds_read_b128 a[188:191], v3 offset:29696
ds_read_b128 a[192:195], v3 offset:22528
ds_read_b128 a[196:199], v3 offset:30720
ds_read_b128 a[200:203], v3 offset:23552
ds_read_b128 a[204:207], v3 offset:31744
v_exp_f32 v115, v115
v_mfma_f32_16x16x32_bf16 a[44:47], a[172:175], v[164:167], a[44:47]
s_waitcnt vmcnt(8)
s_barrier
v_exp_f32 v128, v128
v_mfma_f32_16x16x32_bf16 a[12:15], a[172:175], v[156:159], 0
v_cvt_pk_bf16_f32 v173, v98, v99
v_cvt_pk_bf16_f32 v180, v112, v113
v_mfma_f32_16x16x32_bf16 a[12:15], a[168:171], v[152:155], a[12:15]
s_waitcnt lgkmcnt(6)
v_exp_f32 v129, v129
v_mfma_f32_16x16x32_bf16 a[16:19], a[176:179], v[152:155], 0
v_exp_f32 v130, v130
v_mfma_f32_16x16x32_bf16 a[16:19], a[180:183], v[156:159], a[16:19]
s_xor_b32 s71, s71, 49152
v_exp_f32 v131, v131
v_mfma_f32_16x16x32_bf16 a[48:51], a[180:183], v[164:167], 0
s_add_u32 s70, s70, 32768
v_exp_f32 v144, v144
v_mfma_f32_16x16x32_bf16 a[48:51], a[176:179], v[160:163], a[48:51]
s_mov_b32 m0, s71
v_exp_f32 v145, v145
v_mfma_f32_16x16x32_bf16 a[80:83], a[176:179], v[184:187], 0
buffer_load_dwordx4 v16, s[32:35], s70 offen offset:0 sc1 lds
v_cvt_pk_bf16_f32 v181, v114, v115
v_mfma_f32_16x16x32_bf16 a[80:83], a[180:183], v[188:191], a[80:83]
v_exp_f32 v146, v146
v_mfma_f32_16x16x32_bf16 a[112:115], a[180:183], v[196:199], 0
v_exp_f32 v147, v147
v_mfma_f32_16x16x32_bf16 a[112:115], a[176:179], v[192:195], a[112:115]
s_waitcnt lgkmcnt(0)
v_cvt_pk_bf16_f32 v204, v128, v129
v_cvt_pk_bf16_f32 v205, v130, v131
v_mfma_f32_16x16x32_bf16 a[116:119], a[184:187], v[192:195], 0
v_exp_f32 v148, v148
v_mfma_f32_16x16x32_bf16 a[116:119], a[188:191], v[196:199], a[116:119]
v_exp_f32 v149, v149
v_mfma_f32_16x16x32_bf16 a[84:87], a[188:191], v[188:191], 0
v_exp_f32 v150, v150
v_mfma_f32_16x16x32_bf16 a[84:87], a[184:187], v[184:187], a[84:87]
v_exp_f32 v151, v151
v_mfma_f32_16x16x32_bf16 a[52:55], a[184:187], v[160:163], 0
v_cvt_pk_bf16_f32 v212, v144, v145
v_cvt_pk_bf16_f32 v213, v146, v147
v_mfma_f32_16x16x32_bf16 a[52:55], a[188:191], v[164:167], a[52:55]
v_exp_f32 v132, v132
v_mfma_f32_16x16x32_bf16 a[20:23], a[188:191], v[156:159], 0
v_exp_f32 v133, v133
v_mfma_f32_16x16x32_bf16 a[20:23], a[184:187], v[152:155], a[20:23]
ds_read_b128 a[144:147], v2 offset:0
v_lshl_add_u32 v19, v0, 24, s66
v_mfma_f32_16x16x32_bf16 a[24:27], a[192:195], v[152:155], 0
s_lshr_b32 s67, s31, 4
v_exp_f32 v134, v134
v_mfma_f32_16x16x32_bf16 a[24:27], a[196:199], v[156:159], a[24:27]
s_lshl1_add_u32 s67, s3, s67
v_exp_f32 v135, v135
v_mfma_f32_16x16x32_bf16 a[56:59], a[196:199], v[164:167], 0
s_lshl_b32 s79, s67, 8
v_cvt_pk_bf16_f32 v214, v148, v149
v_cvt_pk_bf16_f32 v215, v150, v151
v_mfma_f32_16x16x32_bf16 a[56:59], a[192:195], v[160:163], a[56:59]
s_add_u32 s79, s79, 8192
buffer_load_dwordx4 v16, s[32:35], s70 offen offset:1024 sc1 lds
v_mfma_f32_16x16x32_bf16 a[88:91], a[192:195], v[184:187], 0
s_add_u32 s69, s31, 12
v_exp_f32 v116, v116
v_mfma_f32_16x16x32_bf16 a[88:91], a[196:199], v[188:191], a[88:91]
s_lshr_b32 s69, s69, 5
v_exp_f32 v117, v117
v_mfma_f32_16x16x32_bf16 a[120:123], a[196:199], v[196:199], 0
s_lshl1_add_u32 s69, s3, s69
v_exp_f32 v118, v118
v_mfma_f32_16x16x32_bf16 a[120:123], a[192:195], v[192:195], a[120:123]
s_lshl_b32 s69, s69, 8
v_cvt_pk_bf16_f32 v206, v132, v133
v_cvt_pk_bf16_f32 v207, v134, v135
v_mfma_f32_16x16x32_bf16 a[124:127], a[200:203], v[192:195], 0
s_add_u32 s69, s69, 8192
s_add_u32 s17, s78, L_D-L_pc+0
v_exp_f32 v119, v119
v_mfma_f32_16x16x32_bf16 a[124:127], a[204:207], v[196:199], a[124:127]
buffer_load_dword a252, v16, s[88:91], s17 offen
v_exp_f32 v100, v100
v_mfma_f32_16x16x32_bf16 a[92:95], a[204:207], v[188:191], 0
s_lshl_b32 s67, s73, 16
v_exp_f32 v101, v101
v_mfma_f32_16x16x32_bf16 a[92:95], a[200:203], v[184:187], a[92:95]
s_xor_b32 s68, s80, 256
s_add_u32 s17, s78, L_D-L_pc+4096
ds_read_b128 a[148:151], v2 offset:1024
v_cvt_pk_bf16_f32 v182, v116, v117
v_mfma_f32_16x16x32_bf16 a[60:63], a[200:203], v[160:163], 0
s_add_u32 s68, s68, s67
buffer_load_dword a252, v16, s[88:91], s17 offen
ds_read_b128 a[152:155], v2 offset:2048
v_exp_f32 v102, v102
v_mfma_f32_16x16x32_bf16 a[60:63], a[204:207], v[164:167], a[60:63]
s_add_u32 s67, s67, s69
ds_read_b128 a[156:159], v2 offset:3072
v_cvt_pk_bf16_f32 v183, v118, v119
v_mfma_f32_16x16x32_bf16 a[28:31], a[204:207], v[156:159], 0
s_mov_b64 exec, 1
buffer_atomic_add a251, v19, s[52:55], s67 offen offset:0 sc1
buffer_atomic_add a251, v19, s[52:55], s68 offen offset:0 sc1
s_mov_b64 exec, -1
s_add_u32 s17, s78, L_D-L_pc+8192
v_exp_f32 v103, v103
v_mfma_f32_16x16x32_bf16 a[28:31], a[200:203], v[152:155], a[28:31]
ds_read_b128 a[160:163], v2 offset:4096
buffer_load_dword a252, v16, s[88:91], s17 offen
ds_read_b128 a[164:167], v2 offset:5120
ds_read_b128 a[168:171], v2 offset:6144
ds_read_b128 a[172:175], v2 offset:7168
v_mul_u32_u24 v19, 52, v0
v_cvt_pk_bf16_f32 v174, v100, v101
v_cvt_pk_bf16_f32 v175, v102, v103
v_xor_b32 v3, 0x8000, v3
s_sub_u32 s72, s3, 1
s_cmp_eq_u32 s72, 0
s_cbranch_scc1 L_DD
.p2align 3
L_D:
s_waitcnt lgkmcnt(7)
v_mfma_f32_16x16x32_bf16 v[88:91], a[144:147], v[24:27], v[216:219]
s_waitcnt lgkmcnt(6)
ds_read_b128 a[176:179], v2 offset:8192
v_mfma_f32_16x16x32_bf16 v[88:91], a[148:151], v[28:31], v[88:91]
s_waitcnt lgkmcnt(6)
ds_read_b128 a[180:183], v2 offset:9216
v_mfma_f32_16x16x32_bf16 v[88:91], a[152:155], v[32:35], v[88:91]
s_waitcnt lgkmcnt(6)
buffer_load_dwordx4 v16, s[32:35], s70 offen offset:2048 sc1 lds
v_mfma_f32_16x16x32_bf16 v[88:91], a[156:159], v[36:39], v[88:91]
ds_read_b128 a[184:187], v2 offset:10240
v_mfma_f32_16x16x32_bf16 v[104:107], a[156:159], v[52:55], v[220:223]
v_mfma_f32_16x16x32_bf16 v[104:107], a[152:155], v[48:51], v[104:107]
buffer_load_dword a252, v19, s[40:43], s81 offen
v_mfma_f32_16x16x32_bf16 v[104:107], a[148:151], v[44:47], v[104:107]
ds_read_b128 a[188:191], v2 offset:11264
v_mfma_f32_16x16x32_bf16 v[104:107], a[144:147], v[40:43], v[104:107]
v_mfma_f32_16x16x32_bf16 v[120:123], a[144:147], v[56:59], v[224:227]
v_mfma_f32_16x16x32_bf16 v[120:123], a[148:151], v[60:63], v[120:123]
v_mfma_f32_16x16x32_bf16 v[120:123], a[152:155], v[64:67], v[120:123]
v_exp_f32 v88, v88
v_mfma_f32_16x16x32_bf16 v[120:123], a[156:159], v[68:71], v[120:123]
v_exp_f32 v89, v89
v_mfma_f32_16x16x32_bf16 v[136:139], a[156:159], v[84:87], v[228:231]
v_exp_f32 v90, v90
v_mfma_f32_16x16x32_bf16 v[136:139], a[152:155], v[80:83], v[136:139]
v_exp_f32 v91, v91
v_mfma_f32_16x16x32_bf16 v[136:139], a[148:151], v[76:79], v[136:139]
v_exp_f32 v104, v104
v_mfma_f32_16x16x32_bf16 v[136:139], a[144:147], v[72:75], v[136:139]
s_waitcnt lgkmcnt(0)
s_add_u32 s81, s81, 425984
v_exp_f32 v105, v105
v_mfma_f32_16x16x32_bf16 v[140:143], a[160:163], v[72:75], v[228:231]
v_exp_f32 v106, v106
v_mfma_f32_16x16x32_bf16 v[140:143], a[164:167], v[76:79], v[140:143]
buffer_load_dwordx4 v16, s[32:35], s70 offen offset:3072 sc1 lds
v_mfma_f32_16x16x32_bf16 v[140:143], a[168:171], v[80:83], v[140:143]
v_exp_f32 v107, v107
v_mfma_f32_16x16x32_bf16 v[140:143], a[172:175], v[84:87], v[140:143]
v_cvt_pk_bf16_f32 v152, v88, v89
v_cvt_pk_bf16_f32 v153, v90, v91
v_mfma_f32_16x16x32_bf16 v[124:127], a[172:175], v[68:71], v[224:227]
v_exp_f32 v120, v120
v_mfma_f32_16x16x32_bf16 v[124:127], a[168:171], v[64:67], v[124:127]
v_exp_f32 v121, v121
v_mfma_f32_16x16x32_bf16 v[124:127], a[164:167], v[60:63], v[124:127]
v_exp_f32 v122, v122
v_mfma_f32_16x16x32_bf16 v[124:127], a[160:163], v[56:59], v[124:127]
v_exp_f32 v123, v123
v_mfma_f32_16x16x32_bf16 v[108:111], a[160:163], v[40:43], v[220:223]
v_exp_f32 v136, v136
v_mfma_f32_16x16x32_bf16 v[108:111], a[164:167], v[44:47], v[108:111]
v_exp_f32 v137, v137
v_mfma_f32_16x16x32_bf16 v[108:111], a[168:171], v[48:51], v[108:111]
v_exp_f32 v138, v138
v_mfma_f32_16x16x32_bf16 v[108:111], a[172:175], v[52:55], v[108:111]
v_cvt_pk_bf16_f32 v160, v104, v105
v_cvt_pk_bf16_f32 v161, v106, v107
v_mfma_f32_16x16x32_bf16 v[92:95], a[172:175], v[36:39], v[216:219]
v_exp_f32 v139, v139
v_mfma_f32_16x16x32_bf16 v[92:95], a[168:171], v[32:35], v[92:95]
ds_read_b128 a[192:195], v2 offset:12288
v_cvt_pk_bf16_f32 v184, v120, v121
v_mfma_f32_16x16x32_bf16 v[92:95], a[164:167], v[28:31], v[92:95]
v_exp_f32 v140, v140
v_mfma_f32_16x16x32_bf16 v[92:95], a[160:163], v[24:27], v[92:95]
s_add_u32 m0, s71, 4096
ds_read_b128 a[196:199], v2 offset:13312
v_cvt_pk_bf16_f32 v185, v122, v123
v_mfma_f32_16x16x32_bf16 v[96:99], a[176:179], v[24:27], v[216:219]
s_add_u32 s64, s70, 4096
ds_read_b128 a[200:203], v2 offset:14336
v_cvt_pk_bf16_f32 v192, v136, v137
v_mfma_f32_16x16x32_bf16 v[96:99], a[180:183], v[28:31], v[96:99]
buffer_load_dwordx4 v16, s[32:35], s64 offen offset:0 sc1 lds
v_mfma_f32_16x16x32_bf16 v[96:99], a[184:187], v[32:35], v[96:99]
v_exp_f32 v141, v141
v_mfma_f32_16x16x32_bf16 v[96:99], a[188:191], v[36:39], v[96:99]
ds_read_b128 a[204:207], v2 offset:15360
v_cvt_pk_bf16_f32 v193, v138, v139
v_mfma_f32_16x16x32_bf16 v[112:115], a[188:191], v[52:55], v[220:223]
v_exp_f32 v142, v142
v_mfma_f32_16x16x32_bf16 v[112:115], a[184:187], v[48:51], v[112:115]
v_exp_f32 v143, v143
v_mfma_f32_16x16x32_bf16 v[112:115], a[180:183], v[44:47], v[112:115]
v_exp_f32 v124, v124
v_mfma_f32_16x16x32_bf16 v[112:115], a[176:179], v[40:43], v[112:115]
v_exp_f32 v125, v125
v_mfma_f32_16x16x32_bf16 v[128:131], a[176:179], v[56:59], v[224:227]
v_exp_f32 v126, v126
v_mfma_f32_16x16x32_bf16 v[128:131], a[180:183], v[60:63], v[128:131]
v_exp_f32 v127, v127
v_mfma_f32_16x16x32_bf16 v[128:131], a[184:187], v[64:67], v[128:131]
v_exp_f32 v108, v108
v_mfma_f32_16x16x32_bf16 v[128:131], a[188:191], v[68:71], v[128:131]
v_exp_f32 v109, v109
v_mfma_f32_16x16x32_bf16 v[144:147], a[188:191], v[84:87], v[228:231]
v_exp_f32 v110, v110
v_mfma_f32_16x16x32_bf16 v[144:147], a[184:187], v[80:83], v[144:147]
ds_read_b128 a[144:147], v3 offset:0
v_cvt_pk_bf16_f32 v194, v140, v141
v_mfma_f32_16x16x32_bf16 v[144:147], a[180:183], v[76:79], v[144:147]
ds_read_b128 a[148:151], v3 offset:8192
v_cvt_pk_bf16_f32 v195, v142, v143
v_mfma_f32_16x16x32_bf16 v[144:147], a[176:179], v[72:75], v[144:147]
s_waitcnt lgkmcnt(2)
v_exp_f32 v111, v111
v_mfma_f32_16x16x32_bf16 v[148:151], a[192:195], v[72:75], v[228:231]
buffer_load_dwordx4 v16, s[32:35], s64 offen offset:1024 sc1 lds
v_mfma_f32_16x16x32_bf16 v[148:151], a[196:199], v[76:79], v[148:151]
v_exp_f32 v92, v92
v_mfma_f32_16x16x32_bf16 v[148:151], a[200:203], v[80:83], v[148:151]
v_exp_f32 v93, v93
v_mfma_f32_16x16x32_bf16 v[148:151], a[204:207], v[84:87], v[148:151]
v_exp_f32 v94, v94
v_mfma_f32_16x16x32_bf16 v[132:135], a[204:207], v[68:71], v[224:227]
ds_read_b128 a[152:155], v3 offset:1024
v_cvt_pk_bf16_f32 v186, v124, v125
v_mfma_f32_16x16x32_bf16 v[132:135], a[200:203], v[64:67], v[132:135]
ds_read_b128 a[156:159], v3 offset:9216
v_cvt_pk_bf16_f32 v187, v126, v127
v_mfma_f32_16x16x32_bf16 v[132:135], a[196:199], v[60:63], v[132:135]
v_exp_f32 v95, v95
v_mfma_f32_16x16x32_bf16 v[132:135], a[192:195], v[56:59], v[132:135]
v_exp_f32 v96, v96
v_mfma_f32_16x16x32_bf16 v[116:119], a[192:195], v[40:43], v[220:223]
v_exp_f32 v97, v97
v_mfma_f32_16x16x32_bf16 v[116:119], a[196:199], v[44:47], v[116:119]
v_exp_f32 v98, v98
v_mfma_f32_16x16x32_bf16 v[116:119], a[200:203], v[48:51], v[116:119]
ds_read_b128 a[160:163], v3 offset:2048
v_cvt_pk_bf16_f32 v162, v108, v109
v_mfma_f32_16x16x32_bf16 v[116:119], a[204:207], v[52:55], v[116:119]
v_exp_f32 v99, v99
v_mfma_f32_16x16x32_bf16 v[100:103], a[204:207], v[36:39], v[216:219]
ds_read_b128 a[164:167], v3 offset:10240
v_cvt_pk_bf16_f32 v163, v110, v111
v_mfma_f32_16x16x32_bf16 v[100:103], a[200:203], v[32:35], v[100:103]
v_exp_f32 v112, v112
v_mfma_f32_16x16x32_bf16 v[100:103], a[196:199], v[28:31], v[100:103]
v_exp_f32 v113, v113
v_mfma_f32_16x16x32_bf16 v[100:103], a[192:195], v[24:27], v[100:103]
v_exp_f32 v114, v114
v_smfmac_f32_16x16x64_bf16 a[128:131], a[240:243], v[168:175], v5
ds_read_b128 a[168:171], v3 offset:3072
v_smfmac_f32_16x16x64_bf16 a[132:135], a[240:243], v[176:183], v5
ds_read_b128 a[172:175], v3 offset:11264
v_smfmac_f32_16x16x64_bf16 a[136:139], a[240:243], v[200:207], v5
ds_read_b128 a[176:179], v3 offset:4096
v_smfmac_f32_16x16x64_bf16 a[140:143], a[240:243], v[208:215], v5
s_waitcnt lgkmcnt(3)
buffer_load_dwordx4 v16, s[32:35], s64 offen offset:2048 sc1 lds
v_mfma_f32_16x16x32_bf16 a[0:3], a[144:147], v[168:171], a[0:3]
v_exp_f32 v115, v115
v_mfma_f32_16x16x32_bf16 a[0:3], a[148:151], v[172:175], a[0:3]
v_exp_f32 v128, v128
v_mfma_f32_16x16x32_bf16 a[32:35], a[148:151], v[180:183], a[32:35]
v_exp_f32 v129, v129
v_mfma_f32_16x16x32_bf16 a[32:35], a[144:147], v[176:179], a[32:35]
v_exp_f32 v130, v130
v_mfma_f32_16x16x32_bf16 a[64:67], a[144:147], v[200:203], a[64:67]
v_exp_f32 v131, v131
v_mfma_f32_16x16x32_bf16 a[64:67], a[148:151], v[204:207], a[64:67]
v_cvt_pk_bf16_f32 v154, v92, v93
v_cvt_pk_bf16_f32 v155, v94, v95
v_mfma_f32_16x16x32_bf16 a[96:99], a[148:151], v[212:215], a[96:99]
v_exp_f32 v144, v144
v_mfma_f32_16x16x32_bf16 a[96:99], a[144:147], v[208:211], a[96:99]
ds_read_b128 a[180:183], v3 offset:12288
v_cvt_pk_bf16_f32 v156, v96, v97
v_mfma_f32_16x16x32_bf16 a[100:103], a[152:155], v[208:211], a[100:103]
v_exp_f32 v145, v145
v_mfma_f32_16x16x32_bf16 a[100:103], a[156:159], v[212:215], a[100:103]
ds_read_b128 a[184:187], v3 offset:5120
v_cvt_pk_bf16_f32 v157, v98, v99
v_mfma_f32_16x16x32_bf16 a[68:71], a[156:159], v[204:207], a[68:71]
ds_read_b128 a[188:191], v3 offset:13312
v_cvt_pk_bf16_f32 v164, v112, v113
v_mfma_f32_16x16x32_bf16 a[68:71], a[152:155], v[200:203], a[68:71]
buffer_load_dwordx4 v16, s[32:35], s64 offen offset:3072 sc1 lds
v_mfma_f32_16x16x32_bf16 a[36:39], a[152:155], v[176:179], a[36:39]
ds_read_b128 a[192:195], v3 offset:6144
v_cvt_pk_bf16_f32 v165, v114, v115
v_mfma_f32_16x16x32_bf16 a[36:39], a[156:159], v[180:183], a[36:39]
ds_read_b128 a[196:199], v3 offset:14336
v_cvt_pk_bf16_f32 v188, v128, v129
v_mfma_f32_16x16x32_bf16 a[4:7], a[156:159], v[172:175], a[4:7]
ds_read_b128 a[200:203], v3 offset:7168
v_cvt_pk_bf16_f32 v189, v130, v131
v_mfma_f32_16x16x32_bf16 a[4:7], a[152:155], v[168:171], a[4:7]
v_exp_f32 v146, v146
v_mfma_f32_16x16x32_bf16 a[8:11], a[160:163], v[168:171], a[8:11]
v_exp_f32 v147, v147
v_mfma_f32_16x16x32_bf16 a[8:11], a[164:167], v[172:175], a[8:11]
v_exp_f32 v148, v148
v_mfma_f32_16x16x32_bf16 a[40:43], a[164:167], v[180:183], a[40:43]
ds_read_b128 a[204:207], v3 offset:15360
v_cvt_pk_bf16_f32 v196, v144, v145
v_mfma_f32_16x16x32_bf16 a[40:43], a[160:163], v[176:179], a[40:43]
v_exp_f32 v149, v149
v_mfma_f32_16x16x32_bf16 a[72:75], a[160:163], v[200:203], a[72:75]
v_exp_f32 v150, v150
v_mfma_f32_16x16x32_bf16 a[72:75], a[164:167], v[204:207], a[72:75]
v_exp_f32 v151, v151
v_mfma_f32_16x16x32_bf16 a[104:107], a[164:167], v[212:215], a[104:107]
v_exp_f32 v132, v132
v_mfma_f32_16x16x32_bf16 a[104:107], a[160:163], v[208:211], a[104:107]
s_waitcnt lgkmcnt(1)
v_exp_f32 v133, v133
v_mfma_f32_16x16x32_bf16 a[108:111], a[168:171], v[208:211], a[108:111]
v_exp_f32 v134, v134
v_mfma_f32_16x16x32_bf16 a[108:111], a[172:175], v[212:215], a[108:111]
v_exp_f32 v135, v135
v_mfma_f32_16x16x32_bf16 a[76:79], a[172:175], v[204:207], a[76:79]
v_exp_f32 v116, v116
v_mfma_f32_16x16x32_bf16 a[76:79], a[168:171], v[200:203], a[76:79]
v_exp_f32 v117, v117
v_mfma_f32_16x16x32_bf16 a[44:47], a[168:171], v[176:179], a[44:47]
v_exp_f32 v118, v118
v_mfma_f32_16x16x32_bf16 a[44:47], a[172:175], v[180:183], a[44:47]
s_waitcnt vmcnt(9)
s_barrier
v_mfma_f32_16x16x32_bf16 a[12:15], a[172:175], v[172:175], a[12:15]
s_xor_b32 s71, s71, 16384
v_exp_f32 v119, v119
v_mfma_f32_16x16x32_bf16 a[12:15], a[168:171], v[168:171], a[12:15]
s_add_u32 s70, s70, 32768
v_exp_f32 v100, v100
v_mfma_f32_16x16x32_bf16 a[16:19], a[176:179], v[168:171], a[16:19]
s_mov_b32 m0, s71
v_exp_f32 v101, v101
v_mfma_f32_16x16x32_bf16 a[16:19], a[180:183], v[172:175], a[16:19]
buffer_load_dwordx4 v16, s[32:35], s70 offen offset:0 sc1 lds
v_mfma_f32_16x16x32_bf16 a[48:51], a[180:183], v[180:183], a[48:51]
ds_read_b128 a[144:147], v2 offset:16384
v_cvt_pk_bf16_f32 v197, v146, v147
v_mfma_f32_16x16x32_bf16 a[48:51], a[176:179], v[176:179], a[48:51]
ds_read_b128 a[148:151], v2 offset:17408
v_cvt_pk_bf16_f32 v198, v148, v149
v_mfma_f32_16x16x32_bf16 a[80:83], a[176:179], v[200:203], a[80:83]
v_exp_f32 v102, v102
v_mfma_f32_16x16x32_bf16 a[80:83], a[180:183], v[204:207], a[80:83]
ds_read_b128 a[152:155], v2 offset:18432
v_cvt_pk_bf16_f32 v199, v150, v151
v_mfma_f32_16x16x32_bf16 a[112:115], a[180:183], v[212:215], a[112:115]
ds_read_b128 a[156:159], v2 offset:19456
v_cvt_pk_bf16_f32 v190, v132, v133
v_mfma_f32_16x16x32_bf16 a[112:115], a[176:179], v[208:211], a[112:115]
v_exp_f32 v103, v103
v_mfma_f32_16x16x32_bf16 a[116:119], a[184:187], v[208:211], a[116:119]
ds_read_b128 a[160:163], v2 offset:20480
v_cvt_pk_bf16_f32 v191, v134, v135
v_mfma_f32_16x16x32_bf16 a[116:119], a[188:191], v[212:215], a[116:119]
ds_read_b128 a[164:167], v2 offset:21504
v_cvt_pk_bf16_f32 v166, v116, v117
v_mfma_f32_16x16x32_bf16 a[84:87], a[188:191], v[204:207], a[84:87]
ds_read_b128 a[168:171], v2 offset:22528
v_cvt_pk_bf16_f32 v167, v118, v119
v_mfma_f32_16x16x32_bf16 a[84:87], a[184:187], v[200:203], a[84:87]
ds_read_b128 a[172:175], v2 offset:23552
v_cvt_pk_bf16_f32 v158, v100, v101
v_mfma_f32_16x16x32_bf16 a[52:55], a[184:187], v[176:179], a[52:55]
v_cvt_pk_bf16_f32 v159, v102, v103
v_mfma_f32_16x16x32_bf16 a[52:55], a[188:191], v[180:183], a[52:55]
v_mfma_f32_16x16x32_bf16 a[20:23], a[188:191], v[172:175], a[20:23]
v_mfma_f32_16x16x32_bf16 a[20:23], a[184:187], v[168:171], a[20:23]
v_mfma_f32_16x16x32_bf16 a[24:27], a[192:195], v[168:171], a[24:27]
buffer_load_dwordx4 v16, s[32:35], s70 offen offset:1024 sc1 lds
v_mfma_f32_16x16x32_bf16 a[24:27], a[196:199], v[172:175], a[24:27]
v_mfma_f32_16x16x32_bf16 a[56:59], a[196:199], v[180:183], a[56:59]
v_mfma_f32_16x16x32_bf16 a[56:59], a[192:195], v[176:179], a[56:59]
v_mfma_f32_16x16x32_bf16 a[88:91], a[192:195], v[200:203], a[88:91]
v_mfma_f32_16x16x32_bf16 a[88:91], a[196:199], v[204:207], a[88:91]
v_mfma_f32_16x16x32_bf16 a[120:123], a[196:199], v[212:215], a[120:123]
v_mfma_f32_16x16x32_bf16 a[120:123], a[192:195], v[208:211], a[120:123]
v_mfma_f32_16x16x32_bf16 a[124:127], a[200:203], v[208:211], a[124:127]
s_waitcnt lgkmcnt(0)
v_mfma_f32_16x16x32_bf16 a[124:127], a[204:207], v[212:215], a[124:127]
v_mfma_f32_16x16x32_bf16 a[92:95], a[204:207], v[204:207], a[92:95]
v_mfma_f32_16x16x32_bf16 a[92:95], a[200:203], v[200:203], a[92:95]
v_mfma_f32_16x16x32_bf16 a[60:63], a[200:203], v[176:179], a[60:63]
v_mfma_f32_16x16x32_bf16 a[60:63], a[204:207], v[180:183], a[60:63]
v_mfma_f32_16x16x32_bf16 a[28:31], a[204:207], v[172:175], a[28:31]
v_mfma_f32_16x16x32_bf16 a[28:31], a[200:203], v[168:171], a[28:31]
v_mfma_f32_16x16x32_bf16 v[88:91], a[144:147], v[24:27], v[216:219]
ds_read_b128 a[176:179], v2 offset:24576
v_mfma_f32_16x16x32_bf16 v[88:91], a[148:151], v[28:31], v[88:91]
ds_read_b128 a[180:183], v2 offset:25600
v_mfma_f32_16x16x32_bf16 v[88:91], a[152:155], v[32:35], v[88:91]
buffer_load_dwordx4 v16, s[32:35], s70 offen offset:2048 sc1 lds
v_mfma_f32_16x16x32_bf16 v[88:91], a[156:159], v[36:39], v[88:91]
ds_read_b128 a[184:187], v2 offset:26624
v_mfma_f32_16x16x32_bf16 v[104:107], a[156:159], v[52:55], v[220:223]
v_mfma_f32_16x16x32_bf16 v[104:107], a[152:155], v[48:51], v[104:107]
v_mfma_f32_16x16x32_bf16 v[104:107], a[148:151], v[44:47], v[104:107]
ds_read_b128 a[188:191], v2 offset:27648
v_mfma_f32_16x16x32_bf16 v[104:107], a[144:147], v[40:43], v[104:107]
v_mfma_f32_16x16x32_bf16 v[120:123], a[144:147], v[56:59], v[224:227]
v_mfma_f32_16x16x32_bf16 v[120:123], a[148:151], v[60:63], v[120:123]
v_mfma_f32_16x16x32_bf16 v[120:123], a[152:155], v[64:67], v[120:123]
v_exp_f32 v88, v88
v_mfma_f32_16x16x32_bf16 v[120:123], a[156:159], v[68:71], v[120:123]
v_exp_f32 v89, v89
v_mfma_f32_16x16x32_bf16 v[136:139], a[156:159], v[84:87], v[228:231]
v_exp_f32 v90, v90
v_mfma_f32_16x16x32_bf16 v[136:139], a[152:155], v[80:83], v[136:139]
v_exp_f32 v91, v91
v_mfma_f32_16x16x32_bf16 v[136:139], a[148:151], v[76:79], v[136:139]
v_exp_f32 v104, v104
v_mfma_f32_16x16x32_bf16 v[136:139], a[144:147], v[72:75], v[136:139]
v_exp_f32 v105, v105
v_mfma_f32_16x16x32_bf16 v[140:143], a[160:163], v[72:75], v[228:231]
v_exp_f32 v106, v106
v_mfma_f32_16x16x32_bf16 v[140:143], a[164:167], v[76:79], v[140:143]
buffer_load_dwordx4 v16, s[32:35], s70 offen offset:3072 sc1 lds
v_mfma_f32_16x16x32_bf16 v[140:143], a[168:171], v[80:83], v[140:143]
v_exp_f32 v107, v107
v_mfma_f32_16x16x32_bf16 v[140:143], a[172:175], v[84:87], v[140:143]
v_cvt_pk_bf16_f32 v168, v88, v89
v_cvt_pk_bf16_f32 v169, v90, v91
v_mfma_f32_16x16x32_bf16 v[124:127], a[172:175], v[68:71], v[224:227]
v_exp_f32 v120, v120
v_mfma_f32_16x16x32_bf16 v[124:127], a[168:171], v[64:67], v[124:127]
v_exp_f32 v121, v121
v_mfma_f32_16x16x32_bf16 v[124:127], a[164:167], v[60:63], v[124:127]
v_exp_f32 v122, v122
v_mfma_f32_16x16x32_bf16 v[124:127], a[160:163], v[56:59], v[124:127]
v_exp_f32 v123, v123
v_mfma_f32_16x16x32_bf16 v[108:111], a[160:163], v[40:43], v[220:223]
v_exp_f32 v136, v136
v_mfma_f32_16x16x32_bf16 v[108:111], a[164:167], v[44:47], v[108:111]
v_exp_f32 v137, v137
v_mfma_f32_16x16x32_bf16 v[108:111], a[168:171], v[48:51], v[108:111]
v_exp_f32 v138, v138
v_mfma_f32_16x16x32_bf16 v[108:111], a[172:175], v[52:55], v[108:111]
v_cvt_pk_bf16_f32 v176, v104, v105
v_cvt_pk_bf16_f32 v177, v106, v107
v_mfma_f32_16x16x32_bf16 v[92:95], a[172:175], v[36:39], v[216:219]
v_exp_f32 v139, v139
v_mfma_f32_16x16x32_bf16 v[92:95], a[168:171], v[32:35], v[92:95]
ds_read_b128 a[192:195], v2 offset:28672
v_cvt_pk_bf16_f32 v200, v120, v121
v_mfma_f32_16x16x32_bf16 v[92:95], a[164:167], v[28:31], v[92:95]
v_exp_f32 v140, v140
v_mfma_f32_16x16x32_bf16 v[92:95], a[160:163], v[24:27], v[92:95]
s_waitcnt lgkmcnt(1)
s_add_u32 m0, s71, 4096
ds_read_b128 a[196:199], v2 offset:29696
v_cvt_pk_bf16_f32 v201, v122, v123
v_mfma_f32_16x16x32_bf16 v[96:99], a[176:179], v[24:27], v[216:219]
s_add_u32 s64, s70, 4096
ds_read_b128 a[200:203], v2 offset:30720
v_cvt_pk_bf16_f32 v208, v136, v137
v_mfma_f32_16x16x32_bf16 v[96:99], a[180:183], v[28:31], v[96:99]
buffer_load_dwordx4 v16, s[32:35], s64 offen offset:0 sc1 lds
v_mfma_f32_16x16x32_bf16 v[96:99], a[184:187], v[32:35], v[96:99]
v_exp_f32 v141, v141
v_mfma_f32_16x16x32_bf16 v[96:99], a[188:191], v[36:39], v[96:99]
ds_read_b128 a[204:207], v2 offset:31744
v_cvt_pk_bf16_f32 v209, v138, v139
v_mfma_f32_16x16x32_bf16 v[112:115], a[188:191], v[52:55], v[220:223]
v_exp_f32 v142, v142
v_mfma_f32_16x16x32_bf16 v[112:115], a[184:187], v[48:51], v[112:115]
v_exp_f32 v143, v143
v_mfma_f32_16x16x32_bf16 v[112:115], a[180:183], v[44:47], v[112:115]
v_exp_f32 v124, v124
v_mfma_f32_16x16x32_bf16 v[112:115], a[176:179], v[40:43], v[112:115]
v_exp_f32 v125, v125
v_mfma_f32_16x16x32_bf16 v[128:131], a[176:179], v[56:59], v[224:227]
v_exp_f32 v126, v126
v_mfma_f32_16x16x32_bf16 v[128:131], a[180:183], v[60:63], v[128:131]
v_exp_f32 v127, v127
v_mfma_f32_16x16x32_bf16 v[128:131], a[184:187], v[64:67], v[128:131]
v_exp_f32 v108, v108
v_mfma_f32_16x16x32_bf16 v[128:131], a[188:191], v[68:71], v[128:131]
v_exp_f32 v109, v109
v_mfma_f32_16x16x32_bf16 v[144:147], a[188:191], v[84:87], v[228:231]
v_exp_f32 v110, v110
v_mfma_f32_16x16x32_bf16 v[144:147], a[184:187], v[80:83], v[144:147]
ds_read_b128 a[144:147], v3 offset:16384
v_cvt_pk_bf16_f32 v210, v140, v141
v_mfma_f32_16x16x32_bf16 v[144:147], a[180:183], v[76:79], v[144:147]
ds_read_b128 a[148:151], v3 offset:24576
v_cvt_pk_bf16_f32 v211, v142, v143
v_mfma_f32_16x16x32_bf16 v[144:147], a[176:179], v[72:75], v[144:147]
s_waitcnt lgkmcnt(2)
v_exp_f32 v111, v111
v_mfma_f32_16x16x32_bf16 v[148:151], a[192:195], v[72:75], v[228:231]
buffer_load_dwordx4 v16, s[32:35], s64 offen offset:1024 sc1 lds
v_mfma_f32_16x16x32_bf16 v[148:151], a[196:199], v[76:79], v[148:151]
v_exp_f32 v92, v92
v_mfma_f32_16x16x32_bf16 v[148:151], a[200:203], v[80:83], v[148:151]
v_exp_f32 v93, v93
v_mfma_f32_16x16x32_bf16 v[148:151], a[204:207], v[84:87], v[148:151]
v_exp_f32 v94, v94
v_mfma_f32_16x16x32_bf16 v[132:135], a[204:207], v[68:71], v[224:227]
ds_read_b128 a[152:155], v3 offset:17408
v_cvt_pk_bf16_f32 v202, v124, v125
v_mfma_f32_16x16x32_bf16 v[132:135], a[200:203], v[64:67], v[132:135]
ds_read_b128 a[156:159], v3 offset:25600
v_cvt_pk_bf16_f32 v203, v126, v127
v_mfma_f32_16x16x32_bf16 v[132:135], a[196:199], v[60:63], v[132:135]
v_exp_f32 v95, v95
v_mfma_f32_16x16x32_bf16 v[132:135], a[192:195], v[56:59], v[132:135]
v_exp_f32 v96, v96
v_mfma_f32_16x16x32_bf16 v[116:119], a[192:195], v[40:43], v[220:223]
v_exp_f32 v97, v97
v_mfma_f32_16x16x32_bf16 v[116:119], a[196:199], v[44:47], v[116:119]
v_exp_f32 v98, v98
v_mfma_f32_16x16x32_bf16 v[116:119], a[200:203], v[48:51], v[116:119]
ds_read_b128 a[160:163], v3 offset:18432
v_cvt_pk_bf16_f32 v178, v108, v109
v_mfma_f32_16x16x32_bf16 v[116:119], a[204:207], v[52:55], v[116:119]
v_exp_f32 v99, v99
v_mfma_f32_16x16x32_bf16 v[100:103], a[204:207], v[36:39], v[216:219]
ds_read_b128 a[164:167], v3 offset:26624
v_cvt_pk_bf16_f32 v179, v110, v111
v_mfma_f32_16x16x32_bf16 v[100:103], a[200:203], v[32:35], v[100:103]
v_exp_f32 v112, v112
v_mfma_f32_16x16x32_bf16 v[100:103], a[196:199], v[28:31], v[100:103]
v_exp_f32 v113, v113
v_mfma_f32_16x16x32_bf16 v[100:103], a[192:195], v[24:27], v[100:103]
v_exp_f32 v114, v114
v_smfmac_f32_16x16x64_bf16 a[128:131], a[240:243], v[152:159], v5
ds_read_b128 a[168:171], v3 offset:19456
v_smfmac_f32_16x16x64_bf16 a[132:135], a[240:243], v[160:167], v5
ds_read_b128 a[172:175], v3 offset:27648
v_smfmac_f32_16x16x64_bf16 a[136:139], a[240:243], v[184:191], v5
ds_read_b128 a[176:179], v3 offset:20480
v_smfmac_f32_16x16x64_bf16 a[140:143], a[240:243], v[192:199], v5
s_waitcnt lgkmcnt(3)
buffer_load_dwordx4 v16, s[32:35], s64 offen offset:2048 sc1 lds
v_mfma_f32_16x16x32_bf16 a[0:3], a[144:147], v[152:155], a[0:3]
v_exp_f32 v115, v115
v_mfma_f32_16x16x32_bf16 a[0:3], a[148:151], v[156:159], a[0:3]
v_exp_f32 v128, v128
v_mfma_f32_16x16x32_bf16 a[32:35], a[148:151], v[164:167], a[32:35]
v_exp_f32 v129, v129
v_mfma_f32_16x16x32_bf16 a[32:35], a[144:147], v[160:163], a[32:35]
v_exp_f32 v130, v130
v_mfma_f32_16x16x32_bf16 a[64:67], a[144:147], v[184:187], a[64:67]
v_exp_f32 v131, v131
v_mfma_f32_16x16x32_bf16 a[64:67], a[148:151], v[188:191], a[64:67]
v_cvt_pk_bf16_f32 v170, v92, v93
v_cvt_pk_bf16_f32 v171, v94, v95
v_mfma_f32_16x16x32_bf16 a[96:99], a[148:151], v[196:199], a[96:99]
v_exp_f32 v144, v144
v_mfma_f32_16x16x32_bf16 a[96:99], a[144:147], v[192:195], a[96:99]
ds_read_b128 a[180:183], v3 offset:28672
v_cvt_pk_bf16_f32 v172, v96, v97
v_mfma_f32_16x16x32_bf16 a[100:103], a[152:155], v[192:195], a[100:103]
v_exp_f32 v145, v145
v_mfma_f32_16x16x32_bf16 a[100:103], a[156:159], v[196:199], a[100:103]
ds_read_b128 a[184:187], v3 offset:21504
v_xor_b32 v2, 0x8000, v2
v_mfma_f32_16x16x32_bf16 a[68:71], a[156:159], v[188:191], a[68:71]
ds_read_b128 a[188:191], v3 offset:29696
v_cvt_pk_bf16_f32 v173, v98, v99
v_mfma_f32_16x16x32_bf16 a[68:71], a[152:155], v[184:187], a[68:71]
buffer_load_dwordx4 v16, s[32:35], s64 offen offset:3072 sc1 lds
v_mfma_f32_16x16x32_bf16 a[36:39], a[152:155], v[160:163], a[36:39]
ds_read_b128 a[192:195], v3 offset:22528
v_cvt_pk_bf16_f32 v180, v112, v113
v_mfma_f32_16x16x32_bf16 a[36:39], a[156:159], v[164:167], a[36:39]
ds_read_b128 a[196:199], v3 offset:30720
v_cvt_pk_bf16_f32 v181, v114, v115
v_mfma_f32_16x16x32_bf16 a[4:7], a[156:159], v[156:159], a[4:7]
ds_read_b128 a[200:203], v3 offset:23552
v_cvt_pk_bf16_f32 v204, v128, v129
v_mfma_f32_16x16x32_bf16 a[4:7], a[152:155], v[152:155], a[4:7]
v_exp_f32 v146, v146
v_mfma_f32_16x16x32_bf16 a[8:11], a[160:163], v[152:155], a[8:11]
v_exp_f32 v147, v147
v_mfma_f32_16x16x32_bf16 a[8:11], a[164:167], v[156:159], a[8:11]
v_exp_f32 v148, v148
v_mfma_f32_16x16x32_bf16 a[40:43], a[164:167], v[164:167], a[40:43]
ds_read_b128 a[204:207], v3 offset:31744
v_cvt_pk_bf16_f32 v205, v130, v131
v_mfma_f32_16x16x32_bf16 a[40:43], a[160:163], v[160:163], a[40:43]
v_exp_f32 v149, v149
v_mfma_f32_16x16x32_bf16 a[72:75], a[160:163], v[184:187], a[72:75]
v_exp_f32 v150, v150
v_mfma_f32_16x16x32_bf16 a[72:75], a[164:167], v[188:191], a[72:75]
v_exp_f32 v151, v151
v_mfma_f32_16x16x32_bf16 a[104:107], a[164:167], v[196:199], a[104:107]
v_exp_f32 v132, v132
v_mfma_f32_16x16x32_bf16 a[104:107], a[160:163], v[192:195], a[104:107]
s_waitcnt lgkmcnt(1)
v_exp_f32 v133, v133
v_mfma_f32_16x16x32_bf16 a[108:111], a[168:171], v[192:195], a[108:111]
v_exp_f32 v134, v134
v_mfma_f32_16x16x32_bf16 a[108:111], a[172:175], v[196:199], a[108:111]
v_exp_f32 v135, v135
v_mfma_f32_16x16x32_bf16 a[76:79], a[172:175], v[188:191], a[76:79]
v_exp_f32 v116, v116
v_mfma_f32_16x16x32_bf16 a[76:79], a[168:171], v[184:187], a[76:79]
v_exp_f32 v117, v117
v_mfma_f32_16x16x32_bf16 a[44:47], a[168:171], v[160:163], a[44:47]
v_exp_f32 v118, v118
v_mfma_f32_16x16x32_bf16 a[44:47], a[172:175], v[164:167], a[44:47]
s_waitcnt vmcnt(8)
s_barrier
v_mfma_f32_16x16x32_bf16 a[12:15], a[172:175], v[156:159], a[12:15]
s_xor_b32 s71, s71, 49152
v_exp_f32 v119, v119
v_mfma_f32_16x16x32_bf16 a[12:15], a[168:171], v[152:155], a[12:15]
s_add_u32 s70, s70, 32768
v_exp_f32 v100, v100
v_mfma_f32_16x16x32_bf16 a[16:19], a[176:179], v[152:155], a[16:19]
s_mov_b32 m0, s71
v_exp_f32 v101, v101
v_mfma_f32_16x16x32_bf16 a[16:19], a[180:183], v[156:159], a[16:19]
s_add_u32 s17, s78, L_DD-L_pc
buffer_load_dwordx4 v16, s[32:35], s70 offen offset:0 sc1 lds
v_mfma_f32_16x16x32_bf16 a[48:51], a[180:183], v[164:167], a[48:51]
buffer_load_dword a252, v16, s[88:91], s17 offen
v_mfma_f32_16x16x32_bf16 a[48:51], a[176:179], v[160:163], a[48:51]
v_cvt_pk_bf16_f32 v212, v144, v145
v_cvt_pk_bf16_f32 v213, v146, v147
v_mfma_f32_16x16x32_bf16 a[80:83], a[176:179], v[184:187], a[80:83]
s_add_u32 s17, s78, L_DD-L_pc+4096
ds_read_b128 a[144:147], v2 offset:0
v_cvt_pk_bf16_f32 v214, v148, v149
v_mfma_f32_16x16x32_bf16 a[80:83], a[180:183], v[188:191], a[80:83]
buffer_load_dword a252, v16, s[88:91], s17 offen
v_mfma_f32_16x16x32_bf16 a[112:115], a[180:183], v[196:199], a[112:115]
ds_read_b128 a[148:151], v2 offset:1024
v_cvt_pk_bf16_f32 v215, v150, v151
v_mfma_f32_16x16x32_bf16 a[112:115], a[176:179], v[192:195], a[112:115]
v_exp_f32 v102, v102
v_mfma_f32_16x16x32_bf16 a[116:119], a[184:187], v[192:195], a[116:119]
ds_read_b128 a[152:155], v2 offset:2048
v_cvt_pk_bf16_f32 v206, v132, v133
v_mfma_f32_16x16x32_bf16 a[116:119], a[188:191], v[196:199], a[116:119]
ds_read_b128 a[156:159], v2 offset:3072
v_cvt_pk_bf16_f32 v207, v134, v135
v_mfma_f32_16x16x32_bf16 a[84:87], a[188:191], v[188:191], a[84:87]
v_exp_f32 v103, v103
v_mfma_f32_16x16x32_bf16 a[84:87], a[184:187], v[184:187], a[84:87]
ds_read_b128 a[160:163], v2 offset:4096
v_cvt_pk_bf16_f32 v182, v116, v117
v_mfma_f32_16x16x32_bf16 a[52:55], a[184:187], v[160:163], a[52:55]
ds_read_b128 a[164:167], v2 offset:5120
v_cvt_pk_bf16_f32 v183, v118, v119
v_mfma_f32_16x16x32_bf16 a[52:55], a[188:191], v[164:167], a[52:55]
ds_read_b128 a[168:171], v2 offset:6144
v_xor_b32 v3, 0x8000, v3
v_mfma_f32_16x16x32_bf16 a[20:23], a[188:191], v[156:159], a[20:23]
ds_read_b128 a[172:175], v2 offset:7168
v_cvt_pk_bf16_f32 v174, v100, v101
v_mfma_f32_16x16x32_bf16 a[20:23], a[184:187], v[152:155], a[20:23]
v_cvt_pk_bf16_f32 v175, v102, v103
v_mfma_f32_16x16x32_bf16 a[24:27], a[192:195], v[152:155], a[24:27]
buffer_load_dwordx4 v16, s[32:35], s70 offen offset:1024 sc1 lds
v_mfma_f32_16x16x32_bf16 a[24:27], a[196:199], v[156:159], a[24:27]
v_mfma_f32_16x16x32_bf16 a[56:59], a[196:199], v[164:167], a[56:59]
v_mfma_f32_16x16x32_bf16 a[56:59], a[192:195], v[160:163], a[56:59]
v_mfma_f32_16x16x32_bf16 a[88:91], a[192:195], v[184:187], a[88:91]
v_mfma_f32_16x16x32_bf16 a[88:91], a[196:199], v[188:191], a[88:91]
v_mfma_f32_16x16x32_bf16 a[120:123], a[196:199], v[196:199], a[120:123]
s_sub_u32 s72, s72, 1
v_mfma_f32_16x16x32_bf16 a[120:123], a[192:195], v[192:195], a[120:123]
v_mfma_f32_16x16x32_bf16 a[124:127], a[200:203], v[192:195], a[124:127]
s_waitcnt lgkmcnt(0)
v_mfma_f32_16x16x32_bf16 a[124:127], a[204:207], v[196:199], a[124:127]
v_mfma_f32_16x16x32_bf16 a[92:95], a[204:207], v[188:191], a[92:95]
s_cmp_lg_u32 s72, 0
v_mfma_f32_16x16x32_bf16 a[92:95], a[200:203], v[184:187], a[92:95]
v_mfma_f32_16x16x32_bf16 a[60:63], a[200:203], v[160:163], a[60:63]
v_mfma_f32_16x16x32_bf16 a[60:63], a[204:207], v[164:167], a[60:63]
v_mfma_f32_16x16x32_bf16 a[28:31], a[204:207], v[156:159], a[28:31]
v_mfma_f32_16x16x32_bf16 a[28:31], a[200:203], v[152:155], a[28:31]
s_cbranch_scc1 L_D
L_DD:
s_waitcnt lgkmcnt(7)
v_mfma_f32_16x16x32_bf16 v[104:107], a[144:147], v[40:43], v[220:223]
s_waitcnt lgkmcnt(6)
ds_read_b128 a[176:179], v2 offset:8192
v_cndmask_b32 v88, v216, v17, s[0:1]
v_mfma_f32_16x16x32_bf16 v[104:107], a[148:151], v[44:47], v[104:107]
s_waitcnt lgkmcnt(6)
ds_read_b128 a[180:183], v2 offset:9216
v_cndmask_b32 v89, v216, v17, s[4:5]
v_mfma_f32_16x16x32_bf16 v[104:107], a[152:155], v[48:51], v[104:107]
s_waitcnt lgkmcnt(6)
buffer_load_dwordx4 v16, s[32:35], s70 offen offset:2048 sc1 lds
v_mfma_f32_16x16x32_bf16 v[104:107], a[156:159], v[52:55], v[104:107]
ds_read_b128 a[184:187], v2 offset:10240
v_cndmask_b32 v90, v216, v17, s[6:7]
v_mfma_f32_16x16x32_bf16 v[120:123], a[156:159], v[68:71], v[224:227]
ds_read_b128 a[188:191], v2 offset:11264
v_cndmask_b32 v91, v216, v17, s[8:9]
v_mfma_f32_16x16x32_bf16 v[120:123], a[152:155], v[64:67], v[120:123]
ds_read_b128 a[192:195], v2 offset:12288
v_cndmask_b32 v92, v216, v17, s[10:11]
v_mfma_f32_16x16x32_bf16 v[120:123], a[148:151], v[60:63], v[120:123]
ds_read_b128 a[196:199], v2 offset:13312
v_cndmask_b32 v93, v216, v17, s[12:13]
v_mfma_f32_16x16x32_bf16 v[120:123], a[144:147], v[56:59], v[120:123]
ds_read_b128 a[200:203], v2 offset:14336
v_cndmask_b32 v94, v216, v17, s[18:19]
v_mfma_f32_16x16x32_bf16 v[136:139], a[144:147], v[72:75], v[228:231]
ds_read_b128 a[204:207], v2 offset:15360
v_cndmask_b32 v95, v216, v17, s[22:23]
v_mfma_f32_16x16x32_bf16 v[136:139], a[148:151], v[76:79], v[136:139]
v_cndmask_b32 v96, v216, v17, s[26:27]
v_cndmask_b32 v97, v216, v17, s[56:57]
v_mfma_f32_16x16x32_bf16 v[136:139], a[152:155], v[80:83], v[136:139]
v_exp_f32 v104, v104
v_mfma_f32_16x16x32_bf16 v[136:139], a[156:159], v[84:87], v[136:139]
v_exp_f32 v105, v105
v_mfma_f32_16x16x32_bf16 v[88:91], a[156:159], v[36:39], v[88:91]
v_exp_f32 v106, v106
v_mfma_f32_16x16x32_bf16 v[88:91], a[152:155], v[32:35], v[88:91]
v_exp_f32 v107, v107
v_mfma_f32_16x16x32_bf16 v[88:91], a[148:151], v[28:31], v[88:91]
v_exp_f32 v120, v120
v_mfma_f32_16x16x32_bf16 v[88:91], a[144:147], v[24:27], v[88:91]
s_waitcnt lgkmcnt(0)
v_exp_f32 v121, v121
v_mfma_f32_16x16x32_bf16 v[140:143], a[160:163], v[72:75], v[228:231]
v_exp_f32 v122, v122
v_mfma_f32_16x16x32_bf16 v[140:143], a[164:167], v[76:79], v[140:143]
buffer_load_dwordx4 v16, s[32:35], s70 offen offset:3072 sc1 lds
v_mfma_f32_16x16x32_bf16 v[140:143], a[168:171], v[80:83], v[140:143]
s_add_u32 m0, s86, 131072
v_exp_f32 v123, v123
v_mfma_f32_16x16x32_bf16 v[140:143], a[172:175], v[84:87], v[140:143]
s_add_u32 s64, s85, 0
v_cvt_pk_bf16_f32 v160, v104, v105
v_cvt_pk_bf16_f32 v161, v106, v107
v_mfma_f32_16x16x32_bf16 v[124:127], a[172:175], v[68:71], v[224:227]
buffer_load_dwordx4 v12, s[36:39], s64 offen lds
v_mfma_f32_16x16x32_bf16 v[124:127], a[168:171], v[64:67], v[124:127]
s_add_u32 m0, s86, 132096
v_exp_f32 v136, v136
v_mfma_f32_16x16x32_bf16 v[124:127], a[164:167], v[60:63], v[124:127]
s_add_u32 s64, s85, 8192
v_exp_f32 v137, v137
v_mfma_f32_16x16x32_bf16 v[124:127], a[160:163], v[56:59], v[124:127]
buffer_load_dwordx4 v13, s[36:39], s64 offen lds
v_mfma_f32_16x16x32_bf16 v[108:111], a[160:163], v[40:43], v[220:223]
v_exp_f32 v138, v138
v_mfma_f32_16x16x32_bf16 v[108:111], a[164:167], v[44:47], v[108:111]
ds_read_b128 a[144:147], v3 offset:0
v_cndmask_b32 v98, v216, v17, s[58:59]
v_mfma_f32_16x16x32_bf16 v[108:111], a[168:171], v[48:51], v[108:111]
s_add_u32 m0, s86, 133120
ds_read_b128 a[148:151], v3 offset:8192
v_cndmask_b32 v99, v216, v17, s[60:61]
v_mfma_f32_16x16x32_bf16 v[108:111], a[172:175], v[52:55], v[108:111]
s_add_u32 s64, s85, 16384
v_cvt_pk_bf16_f32 v184, v120, v121
v_cvt_pk_bf16_f32 v185, v122, v123
v_mfma_f32_16x16x32_bf16 v[92:95], a[172:175], v[36:39], v[92:95]
buffer_load_dwordx4 v12, s[36:39], s64 offen lds
v_mfma_f32_16x16x32_bf16 v[92:95], a[168:171], v[32:35], v[92:95]
s_add_u32 m0, s86, 134144
v_exp_f32 v139, v139
v_mfma_f32_16x16x32_bf16 v[92:95], a[164:167], v[28:31], v[92:95]
s_add_u32 s64, s85, 24576
v_exp_f32 v88, v88
v_mfma_f32_16x16x32_bf16 v[92:95], a[160:163], v[24:27], v[92:95]
buffer_load_dwordx4 v13, s[36:39], s64 offen lds
v_mfma_f32_16x16x32_bf16 v[96:99], a[176:179], v[24:27], v[96:99]
s_add_u32 m0, s71, 4096
v_exp_f32 v89, v89
v_mfma_f32_16x16x32_bf16 v[96:99], a[180:183], v[28:31], v[96:99]
s_add_u32 s64, s70, 4096
v_exp_f32 v90, v90
v_mfma_f32_16x16x32_bf16 v[96:99], a[184:187], v[32:35], v[96:99]
buffer_load_dwordx4 v16, s[32:35], s64 offen offset:0 sc1 lds
v_mfma_f32_16x16x32_bf16 v[96:99], a[188:191], v[36:39], v[96:99]
v_cvt_pk_bf16_f32 v192, v136, v137
v_cvt_pk_bf16_f32 v193, v138, v139
v_mfma_f32_16x16x32_bf16 v[112:115], a[188:191], v[52:55], v[220:223]
v_exp_f32 v91, v91
v_mfma_f32_16x16x32_bf16 v[112:115], a[184:187], v[48:51], v[112:115]
v_exp_f32 v140, v140
v_mfma_f32_16x16x32_bf16 v[112:115], a[180:183], v[44:47], v[112:115]
v_exp_f32 v141, v141
v_mfma_f32_16x16x32_bf16 v[112:115], a[176:179], v[40:43], v[112:115]
v_exp_f32 v142, v142
v_mfma_f32_16x16x32_bf16 v[128:131], a[176:179], v[56:59], v[224:227]
v_exp_f32 v143, v143
v_mfma_f32_16x16x32_bf16 v[128:131], a[180:183], v[60:63], v[128:131]
v_exp_f32 v124, v124
v_mfma_f32_16x16x32_bf16 v[128:131], a[184:187], v[64:67], v[128:131]
v_cvt_pk_bf16_f32 v152, v88, v89
v_cvt_pk_bf16_f32 v153, v90, v91
v_mfma_f32_16x16x32_bf16 v[128:131], a[188:191], v[68:71], v[128:131]
v_exp_f32 v125, v125
v_mfma_f32_16x16x32_bf16 v[144:147], a[188:191], v[84:87], v[228:231]
v_exp_f32 v126, v126
v_mfma_f32_16x16x32_bf16 v[144:147], a[184:187], v[80:83], v[144:147]
v_exp_f32 v127, v127
v_mfma_f32_16x16x32_bf16 v[144:147], a[180:183], v[76:79], v[144:147]
v_exp_f32 v108, v108
v_mfma_f32_16x16x32_bf16 v[144:147], a[176:179], v[72:75], v[144:147]
ds_read_b128 a[152:155], v3 offset:1024
v_cndmask_b32 v100, v216, v17, s[62:63]
v_mfma_f32_16x16x32_bf16 v[148:151], a[192:195], v[72:75], v[228:231]
buffer_load_dwordx4 v16, s[32:35], s64 offen offset:1024 sc1 lds
v_mfma_f32_16x16x32_bf16 v[148:151], a[196:199], v[76:79], v[148:151]
ds_read_b128 a[156:159], v3 offset:9216
v_cndmask_b32 v101, v216, v17, s[48:49]
v_mfma_f32_16x16x32_bf16 v[148:151], a[200:203], v[80:83], v[148:151]
v_cvt_pk_bf16_f32 v194, v140, v141
v_cvt_pk_bf16_f32 v195, v142, v143
v_mfma_f32_16x16x32_bf16 v[148:151], a[204:207], v[84:87], v[148:151]
ds_read_b128 a[160:163], v3 offset:2048
v_cndmask_b32 v102, v216, v17, s[50:51]
v_mfma_f32_16x16x32_bf16 v[132:135], a[204:207], v[68:71], v[224:227]
ds_read_b128 a[164:167], v3 offset:10240
v_cndmask_b32 v103, v216, v17, s[100:101]
v_mfma_f32_16x16x32_bf16 v[132:135], a[200:203], v[64:67], v[132:135]
v_exp_f32 v109, v109
v_mfma_f32_16x16x32_bf16 v[132:135], a[196:199], v[60:63], v[132:135]
v_exp_f32 v110, v110
v_mfma_f32_16x16x32_bf16 v[132:135], a[192:195], v[56:59], v[132:135]
v_exp_f32 v111, v111
v_mfma_f32_16x16x32_bf16 v[116:119], a[192:195], v[40:43], v[220:223]
v_exp_f32 v92, v92
v_mfma_f32_16x16x32_bf16 v[116:119], a[196:199], v[44:47], v[116:119]
v_cvt_pk_bf16_f32 v186, v124, v125
v_cvt_pk_bf16_f32 v187, v126, v127
v_mfma_f32_16x16x32_bf16 v[116:119], a[200:203], v[48:51], v[116:119]
v_exp_f32 v93, v93
v_mfma_f32_16x16x32_bf16 v[116:119], a[204:207], v[52:55], v[116:119]
v_exp_f32 v94, v94
v_mfma_f32_16x16x32_bf16 v[100:103], a[204:207], v[36:39], v[100:103]
v_exp_f32 v95, v95
v_mfma_f32_16x16x32_bf16 v[100:103], a[200:203], v[32:35], v[100:103]
v_exp_f32 v96, v96
v_mfma_f32_16x16x32_bf16 v[100:103], a[196:199], v[28:31], v[100:103]
v_exp_f32 v97, v97
v_mfma_f32_16x16x32_bf16 v[100:103], a[192:195], v[24:27], v[100:103]
v_exp_f32 v98, v98
v_smfmac_f32_16x16x64_bf16 a[128:131], a[240:243], v[168:175], v5
ds_read_b128 a[168:171], v3 offset:3072
v_smfmac_f32_16x16x64_bf16 a[132:135], a[240:243], v[176:183], v5
v_cvt_pk_bf16_f32 v162, v108, v109
v_smfmac_f32_16x16x64_bf16 a[136:139], a[240:243], v[200:207], v5
ds_read_b128 a[172:175], v3 offset:11264
v_smfmac_f32_16x16x64_bf16 a[140:143], a[240:243], v[208:215], v5
s_waitcnt lgkmcnt(2)
buffer_load_dwordx4 v16, s[32:35], s64 offen offset:2048 sc1 lds
v_mfma_f32_16x16x32_bf16 a[0:3], a[144:147], v[168:171], a[0:3]
v_exp_f32 v99, v99
v_mfma_f32_16x16x32_bf16 a[0:3], a[148:151], v[172:175], a[0:3]
v_cvt_pk_bf16_f32 v163, v110, v111
v_cvt_pk_bf16_f32 v154, v92, v93
v_mfma_f32_16x16x32_bf16 a[32:35], a[148:151], v[180:183], a[32:35]
v_exp_f32 v112, v112
v_mfma_f32_16x16x32_bf16 a[32:35], a[144:147], v[176:179], a[32:35]
v_exp_f32 v113, v113
v_mfma_f32_16x16x32_bf16 a[64:67], a[144:147], v[200:203], a[64:67]
v_exp_f32 v114, v114
v_mfma_f32_16x16x32_bf16 a[64:67], a[148:151], v[204:207], a[64:67]
v_exp_f32 v115, v115
v_mfma_f32_16x16x32_bf16 a[96:99], a[148:151], v[212:215], a[96:99]
v_exp_f32 v128, v128
v_mfma_f32_16x16x32_bf16 a[96:99], a[144:147], v[208:211], a[96:99]
v_exp_f32 v129, v129
v_mfma_f32_16x16x32_bf16 a[100:103], a[152:155], v[208:211], a[100:103]
v_exp_f32 v130, v130
v_mfma_f32_16x16x32_bf16 a[100:103], a[156:159], v[212:215], a[100:103]
v_cvt_pk_bf16_f32 v155, v94, v95
v_cvt_pk_bf16_f32 v156, v96, v97
v_mfma_f32_16x16x32_bf16 a[68:71], a[156:159], v[204:207], a[68:71]
v_exp_f32 v131, v131
v_mfma_f32_16x16x32_bf16 a[68:71], a[152:155], v[200:203], a[68:71]
buffer_load_dwordx4 v16, s[32:35], s64 offen offset:3072 sc1 lds
v_mfma_f32_16x16x32_bf16 a[36:39], a[152:155], v[176:179], a[36:39]
s_add_u32 m0, s86, 135168
ds_read_b128 a[176:179], v3 offset:4096
v_cvt_pk_bf16_f32 v157, v98, v99
v_mfma_f32_16x16x32_bf16 a[36:39], a[156:159], v[180:183], a[36:39]
s_add_u32 s64, s85, 32768
v_exp_f32 v144, v144
v_mfma_f32_16x16x32_bf16 a[4:7], a[156:159], v[172:175], a[4:7]
buffer_load_dwordx4 v12, s[36:39], s64 offen lds
v_mfma_f32_16x16x32_bf16 a[4:7], a[152:155], v[168:171], a[4:7]
s_add_u32 m0, s86, 136192
ds_read_b128 a[180:183], v3 offset:12288
v_cvt_pk_bf16_f32 v164, v112, v113
v_mfma_f32_16x16x32_bf16 a[8:11], a[160:163], v[168:171], a[8:11]
s_add_u32 s64, s85, 40960
v_exp_f32 v145, v145
v_mfma_f32_16x16x32_bf16 a[8:11], a[164:167], v[172:175], a[8:11]
buffer_load_dwordx4 v13, s[36:39], s64 offen lds
v_mfma_f32_16x16x32_bf16 a[40:43], a[164:167], v[180:183], a[40:43]
ds_read_b128 a[184:187], v3 offset:5120
v_cvt_pk_bf16_f32 v165, v114, v115
v_mfma_f32_16x16x32_bf16 a[40:43], a[160:163], v[176:179], a[40:43]
ds_read_b128 a[188:191], v3 offset:13312
v_cvt_pk_bf16_f32 v188, v128, v129
v_mfma_f32_16x16x32_bf16 a[72:75], a[160:163], v[200:203], a[72:75]
ds_read_b128 a[192:195], v3 offset:6144
v_cvt_pk_bf16_f32 v189, v130, v131
v_mfma_f32_16x16x32_bf16 a[72:75], a[164:167], v[204:207], a[72:75]
ds_read_b128 a[196:199], v3 offset:14336
v_cvt_pk_bf16_f32 v196, v144, v145
v_mfma_f32_16x16x32_bf16 a[104:107], a[164:167], v[212:215], a[104:107]
ds_read_b128 a[200:203], v3 offset:7168
v_mfma_f32_16x16x32_bf16 a[104:107], a[160:163], v[208:211], a[104:107]
s_waitcnt lgkmcnt(5)
s_add_u32 m0, s86, 137216
ds_read_b128 a[204:207], v3 offset:15360
v_mfma_f32_16x16x32_bf16 a[108:111], a[168:171], v[208:211], a[108:111]
s_add_u32 s64, s85, 49152
v_exp_f32 v146, v146
v_mfma_f32_16x16x32_bf16 a[108:111], a[172:175], v[212:215], a[108:111]
buffer_load_dwordx4 v12, s[36:39], s64 offen lds
v_mfma_f32_16x16x32_bf16 a[76:79], a[172:175], v[204:207], a[76:79]
s_add_u32 m0, s86, 138240
v_exp_f32 v147, v147
v_mfma_f32_16x16x32_bf16 a[76:79], a[168:171], v[200:203], a[76:79]
s_add_u32 s64, s85, 57344
v_exp_f32 v148, v148
v_mfma_f32_16x16x32_bf16 a[44:47], a[168:171], v[176:179], a[44:47]
buffer_load_dwordx4 v13, s[36:39], s64 offen lds
v_mfma_f32_16x16x32_bf16 a[44:47], a[172:175], v[180:183], a[44:47]
s_waitcnt vmcnt(16)
s_barrier
v_mfma_f32_16x16x32_bf16 a[12:15], a[172:175], v[172:175], a[12:15]
s_xor_b32 s71, s71, 16384
v_exp_f32 v149, v149
v_mfma_f32_16x16x32_bf16 a[12:15], a[168:171], v[168:171], a[12:15]
s_add_u32 s70, s70, 32768
v_exp_f32 v150, v150
v_mfma_f32_16x16x32_bf16 a[16:19], a[176:179], v[168:171], a[16:19]
s_mov_b32 m0, s71
v_exp_f32 v151, v151
v_mfma_f32_16x16x32_bf16 a[16:19], a[180:183], v[172:175], a[16:19]
buffer_load_dwordx4 v16, s[32:35], s70 offen offset:0 sc1 lds
v_mfma_f32_16x16x32_bf16 a[48:51], a[180:183], v[180:183], a[48:51]
v_exp_f32 v132, v132
v_mfma_f32_16x16x32_bf16 a[48:51], a[176:179], v[176:179], a[48:51]
v_exp_f32 v133, v133
v_mfma_f32_16x16x32_bf16 a[80:83], a[176:179], v[200:203], a[80:83]
v_exp_f32 v134, v134
v_mfma_f32_16x16x32_bf16 a[80:83], a[180:183], v[204:207], a[80:83]
v_exp_f32 v135, v135
v_mfma_f32_16x16x32_bf16 a[112:115], a[180:183], v[212:215], a[112:115]
v_exp_f32 v116, v116
v_mfma_f32_16x16x32_bf16 a[112:115], a[176:179], v[208:211], a[112:115]
s_waitcnt lgkmcnt(0)
v_cvt_pk_bf16_f32 v197, v146, v147
v_cvt_pk_bf16_f32 v198, v148, v149
v_mfma_f32_16x16x32_bf16 a[116:119], a[184:187], v[208:211], a[116:119]
v_exp_f32 v117, v117
v_mfma_f32_16x16x32_bf16 a[116:119], a[188:191], v[212:215], a[116:119]
v_exp_f32 v118, v118
v_mfma_f32_16x16x32_bf16 a[84:87], a[188:191], v[204:207], a[84:87]
v_exp_f32 v119, v119
v_mfma_f32_16x16x32_bf16 a[84:87], a[184:187], v[200:203], a[84:87]
v_exp_f32 v100, v100
v_mfma_f32_16x16x32_bf16 a[52:55], a[184:187], v[176:179], a[52:55]
v_exp_f32 v101, v101
v_mfma_f32_16x16x32_bf16 a[52:55], a[188:191], v[180:183], a[52:55]
ds_read_b128 a[144:147], v2 offset:16384
v_cvt_pk_bf16_f32 v199, v150, v151
v_mfma_f32_16x16x32_bf16 a[20:23], a[188:191], v[172:175], a[20:23]
ds_read_b128 a[148:151], v2 offset:17408
v_cvt_pk_bf16_f32 v190, v132, v133
v_mfma_f32_16x16x32_bf16 a[20:23], a[184:187], v[168:171], a[20:23]
v_exp_f32 v102, v102
v_mfma_f32_16x16x32_bf16 a[24:27], a[192:195], v[168:171], a[24:27]
buffer_load_dwordx4 v16, s[32:35], s70 offen offset:1024 sc1 lds
v_mfma_f32_16x16x32_bf16 a[24:27], a[196:199], v[172:175], a[24:27]
ds_read_b128 a[152:155], v2 offset:18432
v_cvt_pk_bf16_f32 v191, v134, v135
v_mfma_f32_16x16x32_bf16 a[56:59], a[196:199], v[180:183], a[56:59]
ds_read_b128 a[156:159], v2 offset:19456
v_cvt_pk_bf16_f32 v166, v116, v117
v_mfma_f32_16x16x32_bf16 a[56:59], a[192:195], v[176:179], a[56:59]
v_exp_f32 v103, v103
v_mfma_f32_16x16x32_bf16 a[88:91], a[192:195], v[200:203], a[88:91]
ds_read_b128 a[160:163], v2 offset:20480
v_cvt_pk_bf16_f32 v167, v118, v119
v_mfma_f32_16x16x32_bf16 a[88:91], a[196:199], v[204:207], a[88:91]
ds_read_b128 a[164:167], v2 offset:21504
v_cvt_pk_bf16_f32 v158, v100, v101
v_mfma_f32_16x16x32_bf16 a[120:123], a[196:199], v[212:215], a[120:123]
ds_read_b128 a[168:171], v2 offset:22528
v_cvt_pk_bf16_f32 v159, v102, v103
v_mfma_f32_16x16x32_bf16 a[120:123], a[192:195], v[208:211], a[120:123]
ds_read_b128 a[172:175], v2 offset:23552
v_cndmask_b32 v104, v220, v17, s[0:1]
v_mfma_f32_16x16x32_bf16 a[124:127], a[200:203], v[208:211], a[124:127]
v_cndmask_b32 v105, v220, v17, s[4:5]
v_cndmask_b32 v106, v220, v17, s[6:7]
v_mfma_f32_16x16x32_bf16 a[124:127], a[204:207], v[212:215], a[124:127]
v_cndmask_b32 v107, v220, v17, s[8:9]
v_cndmask_b32 v108, v220, v17, s[10:11]
v_mfma_f32_16x16x32_bf16 a[92:95], a[204:207], v[204:207], a[92:95]
v_cndmask_b32 v109, v220, v17, s[12:13]
v_cndmask_b32 v110, v220, v17, s[18:19]
v_mfma_f32_16x16x32_bf16 a[92:95], a[200:203], v[200:203], a[92:95]
v_cndmask_b32 v111, v220, v17, s[22:23]
v_cndmask_b32 v112, v220, v17, s[26:27]
v_mfma_f32_16x16x32_bf16 a[60:63], a[200:203], v[176:179], a[60:63]
v_cndmask_b32 v113, v220, v17, s[56:57]
v_cndmask_b32 v114, v220, v17, s[58:59]
v_mfma_f32_16x16x32_bf16 a[60:63], a[204:207], v[180:183], a[60:63]
v_cndmask_b32 v115, v220, v17, s[60:61]
v_cndmask_b32 v116, v220, v17, s[62:63]
v_mfma_f32_16x16x32_bf16 a[28:31], a[204:207], v[172:175], a[28:31]
v_cndmask_b32 v117, v220, v17, s[48:49]
v_cndmask_b32 v118, v220, v17, s[50:51]
v_mfma_f32_16x16x32_bf16 a[28:31], a[200:203], v[168:171], a[28:31]
s_waitcnt lgkmcnt(0)
v_cndmask_b32 v119, v220, v17, s[100:101]
v_mfma_f32_16x16x32_bf16 v[120:123], a[144:147], v[56:59], v[224:227]
ds_read_b128 a[176:179], v2 offset:24576
v_mfma_f32_16x16x32_bf16 v[120:123], a[148:151], v[60:63], v[120:123]
ds_read_b128 a[180:183], v2 offset:25600
v_mfma_f32_16x16x32_bf16 v[120:123], a[152:155], v[64:67], v[120:123]
buffer_load_dwordx4 v16, s[32:35], s70 offen offset:2048 sc1 lds
v_mfma_f32_16x16x32_bf16 v[120:123], a[156:159], v[68:71], v[120:123]
ds_read_b128 a[184:187], v2 offset:26624
v_mfma_f32_16x16x32_bf16 v[136:139], a[156:159], v[84:87], v[228:231]
s_add_u32 s17, s78, L_T-L_pc
ds_read_b128 a[188:191], v2 offset:27648
v_mfma_f32_16x16x32_bf16 v[136:139], a[152:155], v[80:83], v[136:139]
buffer_load_dword a252, v16, s[88:91], s17 offen
v_mfma_f32_16x16x32_bf16 v[136:139], a[148:151], v[76:79], v[136:139]
v_mfma_f32_16x16x32_bf16 v[136:139], a[144:147], v[72:75], v[136:139]
v_mfma_f32_16x16x32_bf16 v[104:107], a[144:147], v[40:43], v[104:107]
s_add_u32 s17, s78, L_T-L_pc+4096
ds_read_b128 a[192:195], v2 offset:28672
v_mfma_f32_16x16x32_bf16 v[104:107], a[148:151], v[44:47], v[104:107]
buffer_load_dword a252, v16, s[88:91], s17 offen
v_mfma_f32_16x16x32_bf16 v[104:107], a[152:155], v[48:51], v[104:107]
v_exp_f32 v120, v120
v_mfma_f32_16x16x32_bf16 v[104:107], a[156:159], v[52:55], v[104:107]
v_exp_f32 v121, v121
v_mfma_f32_16x16x32_bf16 v[140:143], a[172:175], v[84:87], v[228:231]
v_exp_f32 v122, v122
v_mfma_f32_16x16x32_bf16 v[140:143], a[168:171], v[80:83], v[140:143]
v_exp_f32 v123, v123
v_mfma_f32_16x16x32_bf16 v[140:143], a[164:167], v[76:79], v[140:143]
v_exp_f32 v136, v136
v_mfma_f32_16x16x32_bf16 v[140:143], a[160:163], v[72:75], v[140:143]
buffer_load_dwordx4 v16, s[32:35], s70 offen offset:3072 sc1 lds
v_mfma_f32_16x16x32_bf16 v[124:127], a[160:163], v[56:59], v[224:227]
v_exp_f32 v137, v137
v_mfma_f32_16x16x32_bf16 v[124:127], a[164:167], v[60:63], v[124:127]
v_exp_f32 v138, v138
v_mfma_f32_16x16x32_bf16 v[124:127], a[168:171], v[64:67], v[124:127]
v_exp_f32 v139, v139
v_mfma_f32_16x16x32_bf16 v[124:127], a[172:175], v[68:71], v[124:127]
v_exp_f32 v104, v104
v_mfma_f32_16x16x32_bf16 v[108:111], a[172:175], v[52:55], v[108:111]
v_cvt_pk_bf16_f32 v200, v120, v121
v_cvt_pk_bf16_f32 v201, v122, v123
v_mfma_f32_16x16x32_bf16 v[108:111], a[168:171], v[48:51], v[108:111]
ds_read_b128 a[196:199], v2 offset:29696
v_cvt_pk_bf16_f32 v208, v136, v137
v_mfma_f32_16x16x32_bf16 v[108:111], a[164:167], v[44:47], v[108:111]
ds_read_b128 a[200:203], v2 offset:30720
v_cvt_pk_bf16_f32 v209, v138, v139
v_mfma_f32_16x16x32_bf16 v[108:111], a[160:163], v[40:43], v[108:111]
s_waitcnt lgkmcnt(2)
ds_read_b128 a[204:207], v2 offset:31744
v_mfma_f32_16x16x32_bf16 v[112:115], a[176:179], v[40:43], v[112:115]
v_exp_f32 v105, v105
v_mfma_f32_16x16x32_bf16 v[112:115], a[180:183], v[44:47], v[112:115]
v_exp_f32 v106, v106
v_mfma_f32_16x16x32_bf16 v[112:115], a[184:187], v[48:51], v[112:115]
v_exp_f32 v107, v107
v_mfma_f32_16x16x32_bf16 v[112:115], a[188:191], v[52:55], v[112:115]
s_add_u32 m0, s71, 4096
v_exp_f32 v140, v140
v_mfma_f32_16x16x32_bf16 v[128:131], a[188:191], v[68:71], v[224:227]
s_add_u32 s64, s70, 4096
v_exp_f32 v141, v141
v_mfma_f32_16x16x32_bf16 v[128:131], a[184:187], v[64:67], v[128:131]
buffer_load_dwordx4 v16, s[32:35], s64 offen offset:0 sc1 lds
v_mfma_f32_16x16x32_bf16 v[128:131], a[180:183], v[60:63], v[128:131]
v_exp_f32 v142, v142
v_mfma_f32_16x16x32_bf16 v[128:131], a[176:179], v[56:59], v[128:131]
v_exp_f32 v143, v143
v_mfma_f32_16x16x32_bf16 v[144:147], a[176:179], v[72:75], v[228:231]
ds_read_b128 a[144:147], v3 offset:16384
v_cvt_pk_bf16_f32 v176, v104, v105
v_mfma_f32_16x16x32_bf16 v[144:147], a[180:183], v[76:79], v[144:147]
ds_read_b128 a[148:151], v3 offset:24576
v_cvt_pk_bf16_f32 v177, v106, v107
v_mfma_f32_16x16x32_bf16 v[144:147], a[184:187], v[80:83], v[144:147]
v_exp_f32 v124, v124
v_mfma_f32_16x16x32_bf16 v[144:147], a[188:191], v[84:87], v[144:147]
s_waitcnt lgkmcnt(2)
v_exp_f32 v125, v125
v_mfma_f32_16x16x32_bf16 v[148:151], a[204:207], v[84:87], v[228:231]
v_exp_f32 v126, v126
v_mfma_f32_16x16x32_bf16 v[148:151], a[200:203], v[80:83], v[148:151]
v_exp_f32 v127, v127
v_mfma_f32_16x16x32_bf16 v[148:151], a[196:199], v[76:79], v[148:151]
ds_read_b128 a[152:155], v3 offset:17408
v_cvt_pk_bf16_f32 v210, v140, v141
v_mfma_f32_16x16x32_bf16 v[148:151], a[192:195], v[72:75], v[148:151]
ds_read_b128 a[156:159], v3 offset:25600
v_cvt_pk_bf16_f32 v211, v142, v143
v_mfma_f32_16x16x32_bf16 v[132:135], a[192:195], v[56:59], v[224:227]
v_exp_f32 v108, v108
v_mfma_f32_16x16x32_bf16 v[132:135], a[196:199], v[60:63], v[132:135]
v_exp_f32 v109, v109
v_mfma_f32_16x16x32_bf16 v[132:135], a[200:203], v[64:67], v[132:135]
buffer_load_dwordx4 v16, s[32:35], s64 offen offset:1024 sc1 lds
v_mfma_f32_16x16x32_bf16 v[132:135], a[204:207], v[68:71], v[132:135]
v_exp_f32 v110, v110
v_mfma_f32_16x16x32_bf16 v[116:119], a[204:207], v[52:55], v[116:119]
ds_read_b128 a[160:163], v3 offset:18432
v_cvt_pk_bf16_f32 v202, v124, v125
v_mfma_f32_16x16x32_bf16 v[116:119], a[200:203], v[48:51], v[116:119]
v_exp_f32 v111, v111
v_mfma_f32_16x16x32_bf16 v[116:119], a[196:199], v[44:47], v[116:119]
ds_read_b128 a[164:167], v3 offset:26624
v_cvt_pk_bf16_f32 v203, v126, v127
v_mfma_f32_16x16x32_bf16 v[116:119], a[192:195], v[40:43], v[116:119]
v_exp_f32 v112, v112
v_smfmac_f32_16x16x64_bf16 a[128:131], a[240:243], v[152:159], v5
ds_read_b128 a[168:171], v3 offset:19456
v_smfmac_f32_16x16x64_bf16 a[132:135], a[240:243], v[160:167], v5
ds_read_b128 a[172:175], v3 offset:27648
v_smfmac_f32_16x16x64_bf16 a[136:139], a[240:243], v[184:191], v5
ds_read_b128 a[176:179], v3 offset:20480
v_smfmac_f32_16x16x64_bf16 a[140:143], a[240:243], v[192:199], v5
s_waitcnt lgkmcnt(4)
ds_read_b128 a[180:183], v3 offset:28672
v_xor_b32 v2, 0x8000, v2
v_mfma_f32_16x16x32_bf16 a[0:3], a[144:147], v[152:155], a[0:3]
v_exp_f32 v113, v113
v_mfma_f32_16x16x32_bf16 a[0:3], a[148:151], v[156:159], a[0:3]
v_exp_f32 v114, v114
v_mfma_f32_16x16x32_bf16 a[32:35], a[148:151], v[164:167], a[32:35]
v_exp_f32 v115, v115
v_mfma_f32_16x16x32_bf16 a[32:35], a[144:147], v[160:163], a[32:35]
v_exp_f32 v128, v128
v_mfma_f32_16x16x32_bf16 a[64:67], a[144:147], v[184:187], a[64:67]
buffer_load_dwordx4 v16, s[32:35], s64 offen offset:2048 sc1 lds
v_mfma_f32_16x16x32_bf16 a[64:67], a[148:151], v[188:191], a[64:67]
v_exp_f32 v129, v129
v_mfma_f32_16x16x32_bf16 a[96:99], a[148:151], v[196:199], a[96:99]
v_exp_f32 v130, v130
v_mfma_f32_16x16x32_bf16 a[96:99], a[144:147], v[192:195], a[96:99]
v_exp_f32 v131, v131
v_mfma_f32_16x16x32_bf16 a[100:103], a[152:155], v[192:195], a[100:103]
v_exp_f32 v144, v144
v_mfma_f32_16x16x32_bf16 a[100:103], a[156:159], v[196:199], a[100:103]
v_exp_f32 v145, v145
v_mfma_f32_16x16x32_bf16 a[68:71], a[156:159], v[188:191], a[68:71]
ds_read_b128 a[184:187], v3 offset:21504
v_cvt_pk_bf16_f32 v178, v108, v109
v_mfma_f32_16x16x32_bf16 a[68:71], a[152:155], v[184:187], a[68:71]
ds_read_b128 a[188:191], v3 offset:29696
v_cvt_pk_bf16_f32 v179, v110, v111
v_mfma_f32_16x16x32_bf16 a[36:39], a[152:155], v[160:163], a[36:39]
ds_read_b128 a[192:195], v3 offset:22528
v_cvt_pk_bf16_f32 v180, v112, v113
v_mfma_f32_16x16x32_bf16 a[36:39], a[156:159], v[164:167], a[36:39]
v_exp_f32 v146, v146
v_mfma_f32_16x16x32_bf16 a[4:7], a[156:159], v[156:159], a[4:7]
v_exp_f32 v147, v147
v_mfma_f32_16x16x32_bf16 a[4:7], a[152:155], v[152:155], a[4:7]
v_exp_f32 v148, v148
v_mfma_f32_16x16x32_bf16 a[8:11], a[160:163], v[152:155], a[8:11]
s_waitcnt lgkmcnt(2)
ds_read_b128 a[196:199], v3 offset:30720
v_cvt_pk_bf16_f32 v181, v114, v115
v_mfma_f32_16x16x32_bf16 a[8:11], a[164:167], v[156:159], a[8:11]
buffer_load_dwordx4 v16, s[32:35], s64 offen offset:3072 sc1 lds
v_mfma_f32_16x16x32_bf16 a[40:43], a[164:167], v[164:167], a[40:43]
v_exp_f32 v149, v149
v_mfma_f32_16x16x32_bf16 a[40:43], a[160:163], v[160:163], a[40:43]
ds_read_b128 a[200:203], v3 offset:23552
v_cvt_pk_bf16_f32 v204, v128, v129
v_mfma_f32_16x16x32_bf16 a[72:75], a[160:163], v[184:187], a[72:75]
v_exp_f32 v150, v150
v_mfma_f32_16x16x32_bf16 a[72:75], a[164:167], v[188:191], a[72:75]
v_exp_f32 v151, v151
v_mfma_f32_16x16x32_bf16 a[104:107], a[164:167], v[196:199], a[104:107]
v_exp_f32 v132, v132
v_mfma_f32_16x16x32_bf16 a[104:107], a[160:163], v[192:195], a[104:107]
ds_read_b128 a[204:207], v3 offset:31744
v_cvt_pk_bf16_f32 v205, v130, v131
v_mfma_f32_16x16x32_bf16 a[108:111], a[168:171], v[192:195], a[108:111]
v_exp_f32 v133, v133
v_mfma_f32_16x16x32_bf16 a[108:111], a[172:175], v[196:199], a[108:111]
v_exp_f32 v134, v134
v_mfma_f32_16x16x32_bf16 a[76:79], a[172:175], v[188:191], a[76:79]
v_exp_f32 v135, v135
v_mfma_f32_16x16x32_bf16 a[76:79], a[168:171], v[184:187], a[76:79]
v_exp_f32 v116, v116
v_mfma_f32_16x16x32_bf16 a[44:47], a[168:171], v[160:163], a[44:47]
v_exp_f32 v117, v117
v_mfma_f32_16x16x32_bf16 a[44:47], a[172:175], v[164:167], a[44:47]
s_add_u32 s17, s78, L_T1-L_pc
v_exp_f32 v118, v118
v_mfma_f32_16x16x32_bf16 a[12:15], a[172:175], v[156:159], a[12:15]
buffer_load_dword a252, v16, s[88:91], s17 offen
v_mfma_f32_16x16x32_bf16 a[12:15], a[168:171], v[152:155], a[12:15]
v_exp_f32 v119, v119
v_mfma_f32_16x16x32_bf16 a[16:19], a[176:179], v[152:155], a[16:19]
v_cvt_pk_bf16_f32 v212, v144, v145
v_cvt_pk_bf16_f32 v213, v146, v147
v_mfma_f32_16x16x32_bf16 a[16:19], a[180:183], v[156:159], a[16:19]
s_waitcnt vmcnt(15)
s_barrier
v_mfma_f32_16x16x32_bf16 a[48:51], a[180:183], v[164:167], a[48:51]
s_xor_b32 s71, s71, 49152
ds_read_b128 a[144:147], v2 offset:0
v_cvt_pk_bf16_f32 v214, v148, v149
v_mfma_f32_16x16x32_bf16 a[48:51], a[176:179], v[160:163], a[48:51]
s_add_u32 s70, s70, 32768
ds_read_b128 a[148:151], v2 offset:1024
v_cvt_pk_bf16_f32 v215, v150, v151
v_mfma_f32_16x16x32_bf16 a[80:83], a[176:179], v[184:187], a[80:83]
s_mov_b32 m0, s71
ds_read_b128 a[152:155], v2 offset:2048
v_cvt_pk_bf16_f32 v206, v132, v133
v_mfma_f32_16x16x32_bf16 a[80:83], a[180:183], v[188:191], a[80:83]
buffer_load_dwordx4 v16, s[32:35], s70 offen offset:0 sc1 lds
v_mfma_f32_16x16x32_bf16 a[112:115], a[180:183], v[196:199], a[112:115]
s_add_u32 s17, s78, L_T1-L_pc+4096
ds_read_b128 a[156:159], v2 offset:3072
v_cvt_pk_bf16_f32 v207, v134, v135
v_mfma_f32_16x16x32_bf16 a[112:115], a[176:179], v[192:195], a[112:115]
buffer_load_dword a252, v16, s[88:91], s17 offen
v_mfma_f32_16x16x32_bf16 a[116:119], a[184:187], v[192:195], a[116:119]
s_waitcnt lgkmcnt(3)
ds_read_b128 a[160:163], v2 offset:4096
v_cvt_pk_bf16_f32 v182, v116, v117
v_mfma_f32_16x16x32_bf16 a[116:119], a[188:191], v[196:199], a[116:119]
ds_read_b128 a[164:167], v2 offset:5120
v_cvt_pk_bf16_f32 v183, v118, v119
v_mfma_f32_16x16x32_bf16 a[84:87], a[188:191], v[188:191], a[84:87]
ds_read_b128 a[168:171], v2 offset:6144
v_xor_b32 v3, 0x8000, v3
v_mfma_f32_16x16x32_bf16 a[84:87], a[184:187], v[184:187], a[84:87]
ds_read_b128 a[172:175], v2 offset:7168
v_accvgpr_read_b32 v20, a128
v_mfma_f32_16x16x32_bf16 a[52:55], a[184:187], v[160:163], a[52:55]
v_accvgpr_read_b32 v248, a129
v_add_f32 v20, v20, v248
v_mfma_f32_16x16x32_bf16 a[52:55], a[188:191], v[164:167], a[52:55]
v_max_f32 v1, v1, v20
v_mfma_f32_16x16x32_bf16 a[20:23], a[188:191], v[156:159], a[20:23]
v_rcp_f32 v20, v20
v_mfma_f32_16x16x32_bf16 a[20:23], a[184:187], v[152:155], a[20:23]
v_accvgpr_read_b32 v232, a0
v_accvgpr_read_b32 v233, a1
v_mfma_f32_16x16x32_bf16 a[24:27], a[192:195], v[152:155], a[24:27]
v_accvgpr_read_b32 v234, a2
v_accvgpr_read_b32 v235, a3
v_mfma_f32_16x16x32_bf16 a[24:27], a[196:199], v[156:159], a[24:27]
v_accvgpr_read_b32 v236, a4
v_accvgpr_read_b32 v237, a5
v_mfma_f32_16x16x32_bf16 a[56:59], a[196:199], v[164:167], a[56:59]
buffer_load_dwordx4 v16, s[32:35], s70 offen offset:1024 sc1 lds
v_mfma_f32_16x16x32_bf16 a[56:59], a[192:195], v[160:163], a[56:59]
v_accvgpr_read_b32 v238, a6
v_accvgpr_read_b32 v239, a7
v_mfma_f32_16x16x32_bf16 a[88:91], a[192:195], v[184:187], a[88:91]
v_mul_f32 v20, v20, v4
v_mul_f32 v232, v232, v20
v_mfma_f32_16x16x32_bf16 a[88:91], a[196:199], v[188:191], a[88:91]
v_mul_f32 v233, v233, v20
v_mul_f32 v234, v234, v20
v_mfma_f32_16x16x32_bf16 a[120:123], a[196:199], v[196:199], a[120:123]
v_mul_f32 v235, v235, v20
v_mul_f32 v236, v236, v20
v_mfma_f32_16x16x32_bf16 a[120:123], a[192:195], v[192:195], a[120:123]
v_mul_f32 v237, v237, v20
v_mul_f32 v238, v238, v20
v_mfma_f32_16x16x32_bf16 a[124:127], a[200:203], v[192:195], a[124:127]
v_mul_f32 v239, v239, v20
v_cvt_pk_bf16_f32 v232, v232, v233
v_mfma_f32_16x16x32_bf16 a[124:127], a[204:207], v[196:199], a[124:127]
v_cvt_pk_bf16_f32 v233, v234, v235
v_cvt_pk_bf16_f32 v234, v236, v237
v_mfma_f32_16x16x32_bf16 a[92:95], a[204:207], v[188:191], a[92:95]
v_cvt_pk_bf16_f32 v235, v238, v239
v_mfma_f32_16x16x32_bf16 a[92:95], a[200:203], v[184:187], a[92:95]
s_add_u32 s77, s74, 0
buffer_store_dwordx4 v[232:235], v16, s[44:47], s77 offen sc1
v_mfma_f32_16x16x32_bf16 a[60:63], a[200:203], v[160:163], a[60:63]
v_accvgpr_read_b32 v240, a8
v_accvgpr_read_b32 v241, a9
v_mfma_f32_16x16x32_bf16 a[60:63], a[204:207], v[164:167], a[60:63]
v_accvgpr_read_b32 v242, a10
v_accvgpr_read_b32 v243, a11
v_mfma_f32_16x16x32_bf16 a[28:31], a[204:207], v[156:159], a[28:31]
v_accvgpr_read_b32 v244, a12
v_accvgpr_read_b32 v245, a13
v_mfma_f32_16x16x32_bf16 a[28:31], a[200:203], v[152:155], a[28:31]
v_accvgpr_read_b32 v246, a14
v_accvgpr_read_b32 v247, a15
v_mul_f32 v240, v240, v20
v_mul_f32 v241, v241, v20
v_mul_f32 v242, v242, v20
v_mul_f32 v243, v243, v20
v_mul_f32 v244, v244, v20
v_mul_f32 v245, v245, v20
v_mul_f32 v246, v246, v20
v_mul_f32 v247, v247, v20
v_cvt_pk_bf16_f32 v240, v240, v241
v_cvt_pk_bf16_f32 v241, v242, v243
v_cvt_pk_bf16_f32 v242, v244, v245
v_cvt_pk_bf16_f32 v243, v246, v247
s_add_u32 s77, s74, 8192
buffer_store_dwordx4 v[240:243], v16, s[44:47], s77 offen sc1
v_accvgpr_read_b32 v232, a16
v_accvgpr_read_b32 v233, a17
v_accvgpr_read_b32 v234, a18
v_accvgpr_read_b32 v235, a19
v_accvgpr_read_b32 v236, a20
v_accvgpr_read_b32 v237, a21
v_accvgpr_read_b32 v238, a22
v_accvgpr_read_b32 v239, a23
v_mul_f32 v232, v232, v20
v_mul_f32 v233, v233, v20
v_mul_f32 v234, v234, v20
v_mul_f32 v235, v235, v20
v_mul_f32 v236, v236, v20
v_mul_f32 v237, v237, v20
v_mul_f32 v238, v238, v20
v_mul_f32 v239, v239, v20
v_cvt_pk_bf16_f32 v232, v232, v233
v_cvt_pk_bf16_f32 v233, v234, v235
v_cvt_pk_bf16_f32 v234, v236, v237
v_cvt_pk_bf16_f32 v235, v238, v239
s_add_u32 s77, s74, 16384
buffer_store_dwordx4 v[232:235], v16, s[44:47], s77 offen sc1
s_cmp_eq_u32 s3, 7
s_cbranch_scc1 L_T1
L_T:
s_waitcnt lgkmcnt(7)
v_mfma_f32_16x16x32_bf16 v[120:123], a[144:147], v[56:59], v[224:227]
s_waitcnt lgkmcnt(6)
ds_read_b128 a[176:179], v2 offset:8192
v_mfma_f32_16x16x32_bf16 v[120:123], a[148:151], v[60:63], v[120:123]
s_waitcnt lgkmcnt(6)
ds_read_b128 a[180:183], v2 offset:9216
v_mfma_f32_16x16x32_bf16 v[120:123], a[152:155], v[64:67], v[120:123]
s_waitcnt lgkmcnt(6)
buffer_load_dwordx4 v16, s[32:35], s70 offen offset:2048 sc1 lds
v_mfma_f32_16x16x32_bf16 v[120:123], a[156:159], v[68:71], v[120:123]
ds_read_b128 a[184:187], v2 offset:10240
v_mfma_f32_16x16x32_bf16 v[136:139], a[156:159], v[84:87], v[228:231]
ds_read_b128 a[188:191], v2 offset:11264
v_mfma_f32_16x16x32_bf16 v[136:139], a[152:155], v[80:83], v[136:139]
ds_read_b128 a[192:195], v2 offset:12288
v_mfma_f32_16x16x32_bf16 v[136:139], a[148:151], v[76:79], v[136:139]
ds_read_b128 a[196:199], v2 offset:13312
v_mfma_f32_16x16x32_bf16 v[136:139], a[144:147], v[72:75], v[136:139]
s_waitcnt lgkmcnt(4)
v_mfma_f32_16x16x32_bf16 v[140:143], a[160:163], v[72:75], v[228:231]
ds_read_b128 a[200:203], v2 offset:14336
v_accvgpr_read_b32 v240, a24
v_mfma_f32_16x16x32_bf16 v[140:143], a[164:167], v[76:79], v[140:143]
ds_read_b128 a[204:207], v2 offset:15360
v_accvgpr_read_b32 v241, a25
v_mfma_f32_16x16x32_bf16 v[140:143], a[168:171], v[80:83], v[140:143]
v_exp_f32 v120, v120
v_mfma_f32_16x16x32_bf16 v[140:143], a[172:175], v[84:87], v[140:143]
v_exp_f32 v121, v121
v_mfma_f32_16x16x32_bf16 v[124:127], a[172:175], v[68:71], v[224:227]
v_exp_f32 v122, v122
v_mfma_f32_16x16x32_bf16 v[124:127], a[168:171], v[64:67], v[124:127]
buffer_load_dwordx4 v16, s[32:35], s70 offen offset:3072 sc1 lds
v_mfma_f32_16x16x32_bf16 v[124:127], a[164:167], v[60:63], v[124:127]
v_exp_f32 v123, v123
v_mfma_f32_16x16x32_bf16 v[124:127], a[160:163], v[56:59], v[124:127]
v_exp_f32 v136, v136
v_mfma_f32_16x16x32_bf16 v[128:131], a[176:179], v[56:59], v[224:227]
v_exp_f32 v137, v137
v_mfma_f32_16x16x32_bf16 v[128:131], a[180:183], v[60:63], v[128:131]
s_waitcnt lgkmcnt(0)
v_exp_f32 v138, v138
v_mfma_f32_16x16x32_bf16 v[128:131], a[184:187], v[64:67], v[128:131]
v_exp_f32 v139, v139
v_mfma_f32_16x16x32_bf16 v[128:131], a[188:191], v[68:71], v[128:131]
s_add_u32 m0, s71, 4096
ds_read_b128 a[144:147], v3 offset:0
v_cvt_pk_bf16_f32 v184, v120, v121
v_mfma_f32_16x16x32_bf16 v[144:147], a[188:191], v[84:87], v[228:231]
s_add_u32 s64, s70, 4096
ds_read_b128 a[148:151], v3 offset:8192
v_cvt_pk_bf16_f32 v185, v122, v123
v_mfma_f32_16x16x32_bf16 v[144:147], a[184:187], v[80:83], v[144:147]
buffer_load_dwordx4 v16, s[32:35], s64 offen offset:0 sc1 lds
v_mfma_f32_16x16x32_bf16 v[144:147], a[180:183], v[76:79], v[144:147]
v_exp_f32 v140, v140
v_mfma_f32_16x16x32_bf16 v[144:147], a[176:179], v[72:75], v[144:147]
v_exp_f32 v141, v141
v_mfma_f32_16x16x32_bf16 v[148:151], a[192:195], v[72:75], v[228:231]
v_exp_f32 v142, v142
v_mfma_f32_16x16x32_bf16 v[148:151], a[196:199], v[76:79], v[148:151]
ds_read_b128 a[152:155], v3 offset:1024
v_cvt_pk_bf16_f32 v192, v136, v137
v_mfma_f32_16x16x32_bf16 v[148:151], a[200:203], v[80:83], v[148:151]
ds_read_b128 a[156:159], v3 offset:9216
v_cvt_pk_bf16_f32 v193, v138, v139
v_mfma_f32_16x16x32_bf16 v[148:151], a[204:207], v[84:87], v[148:151]
v_exp_f32 v143, v143
v_mfma_f32_16x16x32_bf16 v[132:135], a[204:207], v[68:71], v[224:227]
v_exp_f32 v124, v124
v_mfma_f32_16x16x32_bf16 v[132:135], a[200:203], v[64:67], v[132:135]
v_exp_f32 v125, v125
v_mfma_f32_16x16x32_bf16 v[132:135], a[196:199], v[60:63], v[132:135]
buffer_load_dwordx4 v16, s[32:35], s64 offen offset:1024 sc1 lds
v_mfma_f32_16x16x32_bf16 v[132:135], a[192:195], v[56:59], v[132:135]
ds_read_b128 a[160:163], v3 offset:2048
v_cvt_pk_bf16_f32 v194, v140, v141
v_smfmac_f32_16x16x64_bf16 a[132:135], a[240:243], v[176:183], v5
ds_read_b128 a[164:167], v3 offset:10240
v_smfmac_f32_16x16x64_bf16 a[136:139], a[240:243], v[200:207], v5
ds_read_b128 a[168:171], v3 offset:3072
v_accvgpr_read_b32 v242, a26
v_smfmac_f32_16x16x64_bf16 a[140:143], a[240:243], v[208:215], v5
s_waitcnt lgkmcnt(3)
ds_read_b128 a[172:175], v3 offset:11264
v_accvgpr_read_b32 v243, a27
v_mfma_f32_16x16x32_bf16 a[32:35], a[144:147], v[176:179], a[32:35]
ds_read_b128 a[176:179], v3 offset:4096
v_accvgpr_read_b32 v244, a28
v_mfma_f32_16x16x32_bf16 a[32:35], a[148:151], v[180:183], a[32:35]
ds_read_b128 a[180:183], v3 offset:12288
v_accvgpr_read_b32 v245, a29
v_mfma_f32_16x16x32_bf16 a[64:67], a[148:151], v[204:207], a[64:67]
ds_read_b128 a[184:187], v3 offset:5120
v_accvgpr_read_b32 v246, a30
v_mfma_f32_16x16x32_bf16 a[64:67], a[144:147], v[200:203], a[64:67]
ds_read_b128 a[188:191], v3 offset:13312
v_accvgpr_read_b32 v247, a31
v_mfma_f32_16x16x32_bf16 a[96:99], a[144:147], v[208:211], a[96:99]
ds_read_b128 a[192:195], v3 offset:6144
v_mul_f32 v240, v240, v20
v_mfma_f32_16x16x32_bf16 a[96:99], a[148:151], v[212:215], a[96:99]
ds_read_b128 a[196:199], v3 offset:14336
v_mul_f32 v241, v241, v20
v_mfma_f32_16x16x32_bf16 a[100:103], a[156:159], v[212:215], a[100:103]
ds_read_b128 a[200:203], v3 offset:7168
v_mul_f32 v242, v242, v20
v_mfma_f32_16x16x32_bf16 a[100:103], a[152:155], v[208:211], a[100:103]
ds_read_b128 a[204:207], v3 offset:15360
v_mul_f32 v243, v243, v20
v_mul_f32 v244, v244, v20
v_mul_f32 v245, v245, v20
v_mul_f32 v246, v246, v20
v_mul_f32 v247, v247, v20
v_cvt_pk_bf16_f32 v240, v240, v241
v_cvt_pk_bf16_f32 v241, v242, v243
v_cvt_pk_bf16_f32 v242, v244, v245
v_cvt_pk_bf16_f32 v243, v246, v247
s_add_u32 s77, s74, 24576
buffer_store_dwordx4 v[240:243], v16, s[44:47], s77 offen sc1
v_exp_f32 v126, v126
v_mfma_f32_16x16x32_bf16 a[68:71], a[152:155], v[200:203], a[68:71]
buffer_load_dwordx4 v16, s[32:35], s64 offen offset:2048 sc1 lds
v_cvt_pk_bf16_f32 v195, v142, v143
v_mfma_f32_16x16x32_bf16 a[68:71], a[156:159], v[204:207], a[68:71]
v_exp_f32 v127, v127
v_mfma_f32_16x16x32_bf16 a[36:39], a[156:159], v[180:183], a[36:39]
v_exp_f32 v128, v128
v_mfma_f32_16x16x32_bf16 a[36:39], a[152:155], v[176:179], a[36:39]
s_waitcnt lgkmcnt(2)
v_exp_f32 v129, v129
v_mfma_f32_16x16x32_bf16 a[40:43], a[160:163], v[176:179], a[40:43]
v_cvt_pk_bf16_f32 v186, v124, v125
v_cvt_pk_bf16_f32 v187, v126, v127
v_mfma_f32_16x16x32_bf16 a[40:43], a[164:167], v[180:183], a[40:43]
v_exp_f32 v130, v130
v_mfma_f32_16x16x32_bf16 a[72:75], a[164:167], v[204:207], a[72:75]
buffer_load_dwordx4 v16, s[32:35], s64 offen offset:3072 sc1 lds
v_mfma_f32_16x16x32_bf16 a[72:75], a[160:163], v[200:203], a[72:75]
v_exp_f32 v131, v131
v_mfma_f32_16x16x32_bf16 a[104:107], a[160:163], v[208:211], a[104:107]
v_exp_f32 v144, v144
v_mfma_f32_16x16x32_bf16 a[104:107], a[164:167], v[212:215], a[104:107]
v_exp_f32 v145, v145
v_mfma_f32_16x16x32_bf16 a[108:111], a[172:175], v[212:215], a[108:111]
v_exp_f32 v146, v146
v_mfma_f32_16x16x32_bf16 a[108:111], a[168:171], v[208:211], a[108:111]
v_exp_f32 v147, v147
v_mfma_f32_16x16x32_bf16 a[76:79], a[168:171], v[200:203], a[76:79]
v_exp_f32 v148, v148
v_mfma_f32_16x16x32_bf16 a[76:79], a[172:175], v[204:207], a[76:79]
v_exp_f32 v149, v149
v_mfma_f32_16x16x32_bf16 a[44:47], a[172:175], v[180:183], a[44:47]
v_cvt_pk_bf16_f32 v188, v128, v129
v_cvt_pk_bf16_f32 v189, v130, v131
v_mfma_f32_16x16x32_bf16 a[44:47], a[168:171], v[176:179], a[44:47]
v_exp_f32 v150, v150
v_mfma_f32_16x16x32_bf16 a[48:51], a[176:179], v[176:179], a[48:51]
v_exp_f32 v151, v151
v_mfma_f32_16x16x32_bf16 a[48:51], a[180:183], v[180:183], a[48:51]
v_exp_f32 v132, v132
v_mfma_f32_16x16x32_bf16 a[80:83], a[180:183], v[204:207], a[80:83]
s_waitcnt vmcnt(9)
s_barrier
v_mfma_f32_16x16x32_bf16 a[80:83], a[176:179], v[200:203], a[80:83]
s_xor_b32 s71, s71, 16384
v_exp_f32 v133, v133
v_mfma_f32_16x16x32_bf16 a[112:115], a[176:179], v[208:211], a[112:115]
s_add_u32 s70, s70, 32768
ds_read_b128 a[144:147], v2 offset:16384
v_cvt_pk_bf16_f32 v196, v144, v145
v_mfma_f32_16x16x32_bf16 a[112:115], a[180:183], v[212:215], a[112:115]
s_mov_b32 m0, s71
v_exp_f32 v134, v134
v_mfma_f32_16x16x32_bf16 a[116:119], a[188:191], v[212:215], a[116:119]
buffer_load_dwordx4 v16, s[32:35], s70 offen offset:0 sc1 lds
v_mfma_f32_16x16x32_bf16 a[116:119], a[184:187], v[208:211], a[116:119]
ds_read_b128 a[148:151], v2 offset:17408
v_cvt_pk_bf16_f32 v197, v146, v147
v_mfma_f32_16x16x32_bf16 a[84:87], a[184:187], v[200:203], a[84:87]
ds_read_b128 a[152:155], v2 offset:18432
v_cvt_pk_bf16_f32 v198, v148, v149
v_mfma_f32_16x16x32_bf16 a[84:87], a[188:191], v[204:207], a[84:87]
ds_read_b128 a[156:159], v2 offset:19456
v_cvt_pk_bf16_f32 v199, v150, v151
v_mfma_f32_16x16x32_bf16 a[52:55], a[188:191], v[180:183], a[52:55]
v_exp_f32 v135, v135
v_mfma_f32_16x16x32_bf16 a[52:55], a[184:187], v[176:179], a[52:55]
ds_read_b128 a[160:163], v2 offset:20480
v_cvt_pk_bf16_f32 v190, v132, v133
v_mfma_f32_16x16x32_bf16 a[56:59], a[192:195], v[176:179], a[56:59]
ds_read_b128 a[164:167], v2 offset:21504
v_cvt_pk_bf16_f32 v191, v134, v135
v_mfma_f32_16x16x32_bf16 a[56:59], a[196:199], v[180:183], a[56:59]
ds_read_b128 a[168:171], v2 offset:22528
v_accvgpr_read_b32 v21, a132
v_mfma_f32_16x16x32_bf16 a[88:91], a[196:199], v[204:207], a[88:91]
ds_read_b128 a[172:175], v2 offset:23552
v_accvgpr_read_b32 v248, a133
v_mfma_f32_16x16x32_bf16 a[88:91], a[192:195], v[200:203], a[88:91]
buffer_load_dwordx4 v16, s[32:35], s70 offen offset:1024 sc1 lds
v_mfma_f32_16x16x32_bf16 a[120:123], a[192:195], v[208:211], a[120:123]
v_add_f32 v21, v21, v248
v_max_f32 v1, v1, v21
v_mfma_f32_16x16x32_bf16 a[120:123], a[196:199], v[212:215], a[120:123]
s_waitcnt lgkmcnt(3)
v_rcp_f32 v21, v21
v_mfma_f32_16x16x32_bf16 a[124:127], a[204:207], v[212:215], a[124:127]
v_accvgpr_read_b32 v232, a32
v_accvgpr_read_b32 v233, a33
v_mfma_f32_16x16x32_bf16 a[124:127], a[200:203], v[208:211], a[124:127]
v_accvgpr_read_b32 v234, a34
v_accvgpr_read_b32 v235, a35
v_mfma_f32_16x16x32_bf16 a[92:95], a[200:203], v[200:203], a[92:95]
v_accvgpr_read_b32 v236, a36
v_accvgpr_read_b32 v237, a37
v_mfma_f32_16x16x32_bf16 a[92:95], a[204:207], v[204:207], a[92:95]
v_accvgpr_read_b32 v238, a38
v_accvgpr_read_b32 v239, a39
v_mfma_f32_16x16x32_bf16 a[60:63], a[204:207], v[180:183], a[60:63]
v_mul_f32 v21, v21, v6
v_mul_f32 v232, v232, v21
v_mfma_f32_16x16x32_bf16 a[60:63], a[200:203], v[176:179], a[60:63]
v_mul_f32 v233, v233, v21
v_mul_f32 v234, v234, v21
v_mfma_f32_16x16x32_bf16 v[120:123], a[144:147], v[56:59], v[224:227]
ds_read_b128 a[176:179], v2 offset:24576
ds_read_b128 a[180:183], v2 offset:25600
v_mfma_f32_16x16x32_bf16 v[120:123], a[148:151], v[60:63], v[120:123]
buffer_load_dwordx4 v16, s[32:35], s70 offen offset:2048 sc1 lds
v_mfma_f32_16x16x32_bf16 v[120:123], a[152:155], v[64:67], v[120:123]
s_add_u32 s64, s70, 4096
ds_read_b128 a[184:187], v2 offset:26624
ds_read_b128 a[188:191], v2 offset:27648
v_mfma_f32_16x16x32_bf16 v[120:123], a[156:159], v[68:71], v[120:123]
buffer_load_dwordx4 v16, s[32:35], s70 offen offset:3072 sc1 lds
v_mfma_f32_16x16x32_bf16 v[136:139], a[156:159], v[84:87], v[228:231]
s_add_u32 m0, s71, 4096
ds_read_b128 a[192:195], v2 offset:28672
ds_read_b128 a[196:199], v2 offset:29696
v_mfma_f32_16x16x32_bf16 v[136:139], a[152:155], v[80:83], v[136:139]
buffer_load_dwordx4 v16, s[32:35], s64 offen offset:0 sc1 lds
v_mfma_f32_16x16x32_bf16 v[136:139], a[148:151], v[76:79], v[136:139]
ds_read_b128 a[200:203], v2 offset:30720
ds_read_b128 a[204:207], v2 offset:31744
v_mfma_f32_16x16x32_bf16 v[136:139], a[144:147], v[72:75], v[136:139]
v_exp_f32 v120, v120
v_mfma_f32_16x16x32_bf16 v[140:143], a[160:163], v[72:75], v[228:231]
s_waitcnt lgkmcnt(4)
v_exp_f32 v121, v121
v_mfma_f32_16x16x32_bf16 v[140:143], a[164:167], v[76:79], v[140:143]
v_exp_f32 v122, v122
v_mfma_f32_16x16x32_bf16 v[140:143], a[168:171], v[80:83], v[140:143]
v_mul_f32 v235, v235, v21
v_mul_f32 v236, v236, v21
v_mul_f32 v237, v237, v21
v_mul_f32 v238, v238, v21
v_mul_f32 v239, v239, v21
v_cvt_pk_bf16_f32 v232, v232, v233
v_cvt_pk_bf16_f32 v233, v234, v235
v_cvt_pk_bf16_f32 v234, v236, v237
v_cvt_pk_bf16_f32 v235, v238, v239
s_add_u32 s77, s74, 4096
buffer_store_dwordx4 v[232:235], v16, s[44:47], s77 offen sc1
v_accvgpr_read_b32 v240, a40
v_accvgpr_read_b32 v241, a41
v_accvgpr_read_b32 v242, a42
v_accvgpr_read_b32 v243, a43
v_accvgpr_read_b32 v244, a44
v_accvgpr_read_b32 v245, a45
v_accvgpr_read_b32 v246, a46
v_accvgpr_read_b32 v247, a47
v_mul_f32 v240, v240, v21
v_mul_f32 v241, v241, v21
v_mul_f32 v242, v242, v21
v_mul_f32 v243, v243, v21
v_mul_f32 v244, v244, v21
v_mul_f32 v245, v245, v21
v_mul_f32 v246, v246, v21
v_mul_f32 v247, v247, v21
v_cvt_pk_bf16_f32 v240, v240, v241
v_cvt_pk_bf16_f32 v241, v242, v243
v_cvt_pk_bf16_f32 v242, v244, v245
v_cvt_pk_bf16_f32 v243, v246, v247
s_add_u32 s77, s74, 12288
buffer_store_dwordx4 v[240:243], v16, s[44:47], s77 offen sc1
v_accvgpr_read_b32 v232, a48
v_accvgpr_read_b32 v233, a49
v_accvgpr_read_b32 v234, a50
v_accvgpr_read_b32 v235, a51
v_accvgpr_read_b32 v236, a52
v_accvgpr_read_b32 v237, a53
v_accvgpr_read_b32 v238, a54
v_accvgpr_read_b32 v239, a55
v_mul_f32 v232, v232, v21
v_mul_f32 v233, v233, v21
v_mul_f32 v234, v234, v21
v_mul_f32 v235, v235, v21
v_mul_f32 v236, v236, v21
v_mul_f32 v237, v237, v21
v_mul_f32 v238, v238, v21
v_mul_f32 v239, v239, v21
v_cvt_pk_bf16_f32 v232, v232, v233
v_cvt_pk_bf16_f32 v233, v234, v235
v_cvt_pk_bf16_f32 v234, v236, v237
v_cvt_pk_bf16_f32 v235, v238, v239
s_add_u32 s77, s74, 20480
buffer_store_dwordx4 v[232:235], v16, s[44:47], s77 offen sc1
v_accvgpr_read_b32 v240, a56
v_accvgpr_read_b32 v241, a57
v_accvgpr_read_b32 v242, a58
v_accvgpr_read_b32 v243, a59
v_accvgpr_read_b32 v244, a60
v_accvgpr_read_b32 v245, a61
v_accvgpr_read_b32 v246, a62
v_accvgpr_read_b32 v247, a63
v_mul_f32 v240, v240, v21
v_mul_f32 v241, v241, v21
v_mul_f32 v242, v242, v21
v_mul_f32 v243, v243, v21
v_mul_f32 v244, v244, v21
v_mul_f32 v245, v245, v21
v_mul_f32 v246, v246, v21
v_mul_f32 v247, v247, v21
v_cvt_pk_bf16_f32 v240, v240, v241
v_cvt_pk_bf16_f32 v241, v242, v243
v_cvt_pk_bf16_f32 v242, v244, v245
v_cvt_pk_bf16_f32 v243, v246, v247
s_add_u32 s77, s74, 28672
buffer_store_dwordx4 v[240:243], v16, s[44:47], s77 offen sc1
v_exp_f32 v123, v123
v_mfma_f32_16x16x32_bf16 v[140:143], a[172:175], v[84:87], v[140:143]
v_exp_f32 v136, v136
v_mfma_f32_16x16x32_bf16 v[124:127], a[172:175], v[68:71], v[224:227]
ds_read_b128 a[144:147], v3 offset:16384
v_cvt_pk_bf16_f32 v200, v120, v121
v_mfma_f32_16x16x32_bf16 v[124:127], a[168:171], v[64:67], v[124:127]
v_exp_f32 v137, v137
v_mfma_f32_16x16x32_bf16 v[124:127], a[164:167], v[60:63], v[124:127]
ds_read_b128 a[148:151], v3 offset:24576
v_cvt_pk_bf16_f32 v201, v122, v123
v_mfma_f32_16x16x32_bf16 v[124:127], a[160:163], v[56:59], v[124:127]
v_exp_f32 v138, v138
v_mfma_f32_16x16x32_bf16 v[128:131], a[176:179], v[56:59], v[224:227]
ds_read_b128 a[152:155], v3 offset:17408
v_cvt_pk_bf16_f32 v208, v136, v137
v_mfma_f32_16x16x32_bf16 v[128:131], a[180:183], v[60:63], v[128:131]
v_exp_f32 v139, v139
v_mfma_f32_16x16x32_bf16 v[128:131], a[184:187], v[64:67], v[128:131]
ds_read_b128 a[156:159], v3 offset:25600
v_cvt_pk_bf16_f32 v209, v138, v139
v_mfma_f32_16x16x32_bf16 v[128:131], a[188:191], v[68:71], v[128:131]
v_exp_f32 v140, v140
v_mfma_f32_16x16x32_bf16 v[144:147], a[188:191], v[84:87], v[228:231]
buffer_load_dwordx4 v16, s[32:35], s64 offen offset:1024 sc1 lds
v_mfma_f32_16x16x32_bf16 v[144:147], a[184:187], v[80:83], v[144:147]
v_exp_f32 v141, v141
v_mfma_f32_16x16x32_bf16 v[144:147], a[180:183], v[76:79], v[144:147]
ds_read_b128 a[160:163], v3 offset:18432
v_cvt_pk_bf16_f32 v210, v140, v141
v_mfma_f32_16x16x32_bf16 v[144:147], a[176:179], v[72:75], v[144:147]
s_waitcnt lgkmcnt(2)
v_exp_f32 v142, v142
v_mfma_f32_16x16x32_bf16 v[148:151], a[192:195], v[72:75], v[228:231]
ds_read_b128 a[164:167], v3 offset:26624
ds_read_b128 a[168:171], v3 offset:19456
v_mfma_f32_16x16x32_bf16 v[148:151], a[196:199], v[76:79], v[148:151]
v_exp_f32 v143, v143
v_mfma_f32_16x16x32_bf16 v[148:151], a[200:203], v[80:83], v[148:151]
ds_read_b128 a[172:175], v3 offset:27648
v_cvt_pk_bf16_f32 v211, v142, v143
v_mfma_f32_16x16x32_bf16 v[148:151], a[204:207], v[84:87], v[148:151]
v_exp_f32 v124, v124
v_mfma_f32_16x16x32_bf16 v[132:135], a[204:207], v[68:71], v[224:227]
ds_read_b128 a[176:179], v3 offset:20480
buffer_load_dwordx4 v16, s[32:35], s64 offen offset:2048 sc1 lds
v_mfma_f32_16x16x32_bf16 v[132:135], a[200:203], v[64:67], v[132:135]
v_exp_f32 v125, v125
v_mfma_f32_16x16x32_bf16 v[132:135], a[196:199], v[60:63], v[132:135]
ds_read_b128 a[180:183], v3 offset:28672
v_cvt_pk_bf16_f32 v202, v124, v125
v_mfma_f32_16x16x32_bf16 v[132:135], a[192:195], v[56:59], v[132:135]
v_exp_f32 v126, v126
v_smfmac_f32_16x16x64_bf16 a[136:139], a[240:243], v[184:191], v5
ds_read_b128 a[184:187], v3 offset:21504
v_smfmac_f32_16x16x64_bf16 a[140:143], a[240:243], v[192:199], v5
ds_read_b128 a[188:191], v3 offset:29696
v_mfma_f32_16x16x32_bf16 a[64:67], a[144:147], v[184:187], a[64:67]
v_exp_f32 v127, v127
v_mfma_f32_16x16x32_bf16 a[64:67], a[148:151], v[188:191], a[64:67]
v_exp_f32 v128, v128
v_mfma_f32_16x16x32_bf16 a[96:99], a[148:151], v[196:199], a[96:99]
v_exp_f32 v129, v129
v_mfma_f32_16x16x32_bf16 a[96:99], a[144:147], v[192:195], a[96:99]
ds_read_b128 a[192:195], v3 offset:22528
v_cvt_pk_bf16_f32 v203, v126, v127
v_mfma_f32_16x16x32_bf16 a[100:103], a[152:155], v[192:195], a[100:103]
s_waitcnt lgkmcnt(2)
v_exp_f32 v130, v130
v_mfma_f32_16x16x32_bf16 a[100:103], a[156:159], v[196:199], a[100:103]
ds_read_b128 a[196:199], v3 offset:30720
v_cvt_pk_bf16_f32 v204, v128, v129
v_mfma_f32_16x16x32_bf16 a[68:71], a[156:159], v[188:191], a[68:71]
v_exp_f32 v131, v131
v_mfma_f32_16x16x32_bf16 a[68:71], a[152:155], v[184:187], a[68:71]
ds_read_b128 a[200:203], v3 offset:23552
v_cvt_pk_bf16_f32 v205, v130, v131
v_mfma_f32_16x16x32_bf16 a[72:75], a[160:163], v[184:187], a[72:75]
v_exp_f32 v144, v144
v_mfma_f32_16x16x32_bf16 a[72:75], a[164:167], v[188:191], a[72:75]
buffer_load_dwordx4 v16, s[32:35], s64 offen offset:3072 sc1 lds
v_mfma_f32_16x16x32_bf16 a[104:107], a[164:167], v[196:199], a[104:107]
s_xor_b32 s71, s71, 49152
v_exp_f32 v145, v145
v_mfma_f32_16x16x32_bf16 a[104:107], a[160:163], v[192:195], a[104:107]
ds_read_b128 a[204:207], v3 offset:31744
v_cvt_pk_bf16_f32 v212, v144, v145
v_mfma_f32_16x16x32_bf16 a[108:111], a[168:171], v[192:195], a[108:111]
s_add_u32 s70, s70, 32768
v_xor_b32 v2, 0x8000, v2
v_exp_f32 v146, v146
v_mfma_f32_16x16x32_bf16 a[108:111], a[172:175], v[196:199], a[108:111]
s_waitcnt vmcnt(12)
s_barrier
v_mfma_f32_16x16x32_bf16 a[76:79], a[172:175], v[188:191], a[76:79]
s_mov_b32 m0, s71
v_exp_f32 v147, v147
v_mfma_f32_16x16x32_bf16 a[76:79], a[168:171], v[184:187], a[76:79]
ds_read_b128 a[144:147], v2 offset:0
v_cvt_pk_bf16_f32 v213, v146, v147
v_mfma_f32_16x16x32_bf16 a[80:83], a[176:179], v[184:187], a[80:83]
v_exp_f32 v148, v148
v_mfma_f32_16x16x32_bf16 a[80:83], a[180:183], v[188:191], a[80:83]
ds_read_b128 a[148:151], v2 offset:1024
ds_read_b128 a[152:155], v2 offset:2048
v_mfma_f32_16x16x32_bf16 a[112:115], a[180:183], v[196:199], a[112:115]
v_exp_f32 v149, v149
v_mfma_f32_16x16x32_bf16 a[112:115], a[176:179], v[192:195], a[112:115]
ds_read_b128 a[156:159], v2 offset:3072
v_cvt_pk_bf16_f32 v214, v148, v149
v_mfma_f32_16x16x32_bf16 a[116:119], a[184:187], v[192:195], a[116:119]
s_waitcnt lgkmcnt(4)
v_exp_f32 v150, v150
v_mfma_f32_16x16x32_bf16 a[116:119], a[188:191], v[196:199], a[116:119]
buffer_load_dwordx4 v16, s[32:35], s70 offen offset:0 sc1 lds
v_mfma_f32_16x16x32_bf16 a[84:87], a[188:191], v[188:191], a[84:87]
v_exp_f32 v151, v151
v_mfma_f32_16x16x32_bf16 a[84:87], a[184:187], v[184:187], a[84:87]
ds_read_b128 a[160:163], v2 offset:4096
v_cvt_pk_bf16_f32 v215, v150, v151
v_mfma_f32_16x16x32_bf16 a[88:91], a[192:195], v[184:187], a[88:91]
v_exp_f32 v132, v132
v_mfma_f32_16x16x32_bf16 a[88:91], a[196:199], v[188:191], a[88:91]
ds_read_b128 a[164:167], v2 offset:5120
v_xor_b32 v3, 0x8000, v3
v_mfma_f32_16x16x32_bf16 a[120:123], a[196:199], v[196:199], a[120:123]
v_exp_f32 v133, v133
v_mfma_f32_16x16x32_bf16 a[120:123], a[192:195], v[192:195], a[120:123]
ds_read_b128 a[168:171], v2 offset:6144
v_cvt_pk_bf16_f32 v206, v132, v133
v_mfma_f32_16x16x32_bf16 a[124:127], a[200:203], v[192:195], a[124:127]
v_exp_f32 v134, v134
v_mfma_f32_16x16x32_bf16 a[124:127], a[204:207], v[196:199], a[124:127]
buffer_load_dwordx4 v16, s[32:35], s70 offen offset:1024 sc1 lds
v_mfma_f32_16x16x32_bf16 a[92:95], a[204:207], v[188:191], a[92:95]
v_exp_f32 v135, v135
v_mfma_f32_16x16x32_bf16 a[92:95], a[200:203], v[184:187], a[92:95]
ds_read_b128 a[172:175], v2 offset:7168
v_cvt_pk_bf16_f32 v207, v134, v135
s_lshl_b32 s72, s3, 1
s_sub_u32 s72, 13, s72
.p2align 3
L_S:
s_waitcnt lgkmcnt(7)
v_mfma_f32_16x16x32_bf16 v[120:123], a[144:147], v[56:59], v[224:227]
s_waitcnt lgkmcnt(6)
ds_read_b128 a[176:179], v2 offset:8192
ds_read_b128 a[180:183], v2 offset:9216
v_mfma_f32_16x16x32_bf16 v[120:123], a[148:151], v[60:63], v[120:123]
s_waitcnt lgkmcnt(7)
buffer_load_dwordx4 v16, s[32:35], s70 offen offset:2048 sc1 lds
v_mfma_f32_16x16x32_bf16 v[120:123], a[152:155], v[64:67], v[120:123]
s_waitcnt lgkmcnt(6)
s_add_u32 s64, s70, 4096
ds_read_b128 a[184:187], v2 offset:10240
ds_read_b128 a[188:191], v2 offset:11264
v_mfma_f32_16x16x32_bf16 v[120:123], a[156:159], v[68:71], v[120:123]
buffer_load_dwordx4 v16, s[32:35], s70 offen offset:3072 sc1 lds
v_mfma_f32_16x16x32_bf16 v[136:139], a[156:159], v[84:87], v[228:231]
s_add_u32 m0, s71, 4096
ds_read_b128 a[192:195], v2 offset:12288
ds_read_b128 a[196:199], v2 offset:13312
v_mfma_f32_16x16x32_bf16 v[136:139], a[152:155], v[80:83], v[136:139]
buffer_load_dwordx4 v16, s[32:35], s64 offen offset:0 sc1 lds
v_mfma_f32_16x16x32_bf16 v[136:139], a[148:151], v[76:79], v[136:139]
ds_read_b128 a[200:203], v2 offset:14336
ds_read_b128 a[204:207], v2 offset:15360
v_mfma_f32_16x16x32_bf16 v[136:139], a[144:147], v[72:75], v[136:139]
s_waitcnt lgkmcnt(6)
v_exp_f32 v120, v120
v_mfma_f32_16x16x32_bf16 v[140:143], a[160:163], v[72:75], v[228:231]
v_exp_f32 v121, v121
v_mfma_f32_16x16x32_bf16 v[140:143], a[164:167], v[76:79], v[140:143]
v_exp_f32 v122, v122
v_mfma_f32_16x16x32_bf16 v[140:143], a[168:171], v[80:83], v[140:143]
v_exp_f32 v123, v123
v_mfma_f32_16x16x32_bf16 v[140:143], a[172:175], v[84:87], v[140:143]
v_exp_f32 v136, v136
v_mfma_f32_16x16x32_bf16 v[124:127], a[172:175], v[68:71], v[224:227]
ds_read_b128 a[144:147], v3 offset:0
v_cvt_pk_bf16_f32 v184, v120, v121
v_mfma_f32_16x16x32_bf16 v[124:127], a[168:171], v[64:67], v[124:127]
v_exp_f32 v137, v137
v_mfma_f32_16x16x32_bf16 v[124:127], a[164:167], v[60:63], v[124:127]
ds_read_b128 a[148:151], v3 offset:8192
v_cvt_pk_bf16_f32 v185, v122, v123
v_mfma_f32_16x16x32_bf16 v[124:127], a[160:163], v[56:59], v[124:127]
v_exp_f32 v138, v138
v_mfma_f32_16x16x32_bf16 v[128:131], a[176:179], v[56:59], v[224:227]
ds_read_b128 a[152:155], v3 offset:1024
v_cvt_pk_bf16_f32 v192, v136, v137
v_mfma_f32_16x16x32_bf16 v[128:131], a[180:183], v[60:63], v[128:131]
s_waitcnt lgkmcnt(3)
v_exp_f32 v139, v139
v_mfma_f32_16x16x32_bf16 v[128:131], a[184:187], v[64:67], v[128:131]
ds_read_b128 a[156:159], v3 offset:9216
v_cvt_pk_bf16_f32 v193, v138, v139
v_mfma_f32_16x16x32_bf16 v[128:131], a[188:191], v[68:71], v[128:131]
v_exp_f32 v140, v140
v_mfma_f32_16x16x32_bf16 v[144:147], a[188:191], v[84:87], v[228:231]
buffer_load_dwordx4 v16, s[32:35], s64 offen offset:1024 sc1 lds
v_mfma_f32_16x16x32_bf16 v[144:147], a[184:187], v[80:83], v[144:147]
v_exp_f32 v141, v141
v_mfma_f32_16x16x32_bf16 v[144:147], a[180:183], v[76:79], v[144:147]
ds_read_b128 a[160:163], v3 offset:2048
v_cvt_pk_bf16_f32 v194, v140, v141
v_mfma_f32_16x16x32_bf16 v[144:147], a[176:179], v[72:75], v[144:147]
v_exp_f32 v142, v142
v_mfma_f32_16x16x32_bf16 v[148:151], a[192:195], v[72:75], v[228:231]
ds_read_b128 a[164:167], v3 offset:10240
ds_read_b128 a[168:171], v3 offset:3072
v_mfma_f32_16x16x32_bf16 v[148:151], a[196:199], v[76:79], v[148:151]
v_exp_f32 v143, v143
v_mfma_f32_16x16x32_bf16 v[148:151], a[200:203], v[80:83], v[148:151]
ds_read_b128 a[172:175], v3 offset:11264
v_cvt_pk_bf16_f32 v195, v142, v143
v_mfma_f32_16x16x32_bf16 v[148:151], a[204:207], v[84:87], v[148:151]
v_exp_f32 v124, v124
v_mfma_f32_16x16x32_bf16 v[132:135], a[204:207], v[68:71], v[224:227]
ds_read_b128 a[176:179], v3 offset:4096
buffer_load_dwordx4 v16, s[32:35], s64 offen offset:2048 sc1 lds
v_mfma_f32_16x16x32_bf16 v[132:135], a[200:203], v[64:67], v[132:135]
v_exp_f32 v125, v125
v_mfma_f32_16x16x32_bf16 v[132:135], a[196:199], v[60:63], v[132:135]
ds_read_b128 a[180:183], v3 offset:12288
v_cvt_pk_bf16_f32 v186, v124, v125
v_mfma_f32_16x16x32_bf16 v[132:135], a[192:195], v[56:59], v[132:135]
v_exp_f32 v126, v126
v_smfmac_f32_16x16x64_bf16 a[136:139], a[240:243], v[200:207], v5
ds_read_b128 a[184:187], v3 offset:5120
v_smfmac_f32_16x16x64_bf16 a[140:143], a[240:243], v[208:215], v5
s_waitcnt lgkmcnt(3)
ds_read_b128 a[188:191], v3 offset:13312
v_mfma_f32_16x16x32_bf16 a[64:67], a[144:147], v[200:203], a[64:67]
v_exp_f32 v127, v127
v_mfma_f32_16x16x32_bf16 a[64:67], a[148:151], v[204:207], a[64:67]
v_exp_f32 v128, v128
v_mfma_f32_16x16x32_bf16 a[96:99], a[148:151], v[212:215], a[96:99]
v_exp_f32 v129, v129
v_mfma_f32_16x16x32_bf16 a[96:99], a[144:147], v[208:211], a[96:99]
ds_read_b128 a[192:195], v3 offset:6144
v_cvt_pk_bf16_f32 v187, v126, v127
v_mfma_f32_16x16x32_bf16 a[100:103], a[152:155], v[208:211], a[100:103]
v_exp_f32 v130, v130
v_mfma_f32_16x16x32_bf16 a[100:103], a[156:159], v[212:215], a[100:103]
ds_read_b128 a[196:199], v3 offset:14336
v_cvt_pk_bf16_f32 v188, v128, v129
v_mfma_f32_16x16x32_bf16 a[68:71], a[156:159], v[204:207], a[68:71]
v_exp_f32 v131, v131
v_mfma_f32_16x16x32_bf16 a[68:71], a[152:155], v[200:203], a[68:71]
ds_read_b128 a[200:203], v3 offset:7168
v_cvt_pk_bf16_f32 v189, v130, v131
v_mfma_f32_16x16x32_bf16 a[72:75], a[160:163], v[200:203], a[72:75]
v_exp_f32 v144, v144
v_mfma_f32_16x16x32_bf16 a[72:75], a[164:167], v[204:207], a[72:75]
buffer_load_dwordx4 v16, s[32:35], s64 offen offset:3072 sc1 lds
v_mfma_f32_16x16x32_bf16 a[104:107], a[164:167], v[212:215], a[104:107]
s_xor_b32 s71, s71, 16384
v_exp_f32 v145, v145
v_mfma_f32_16x16x32_bf16 a[104:107], a[160:163], v[208:211], a[104:107]
ds_read_b128 a[204:207], v3 offset:15360
v_cvt_pk_bf16_f32 v196, v144, v145
v_mfma_f32_16x16x32_bf16 a[108:111], a[168:171], v[208:211], a[108:111]
s_add_u32 s70, s70, 32768
v_exp_f32 v146, v146
v_mfma_f32_16x16x32_bf16 a[108:111], a[172:175], v[212:215], a[108:111]
s_waitcnt vmcnt(8)
s_barrier
v_mfma_f32_16x16x32_bf16 a[76:79], a[172:175], v[204:207], a[76:79]
s_mov_b32 m0, s71
v_exp_f32 v147, v147
v_mfma_f32_16x16x32_bf16 a[76:79], a[168:171], v[200:203], a[76:79]
s_waitcnt lgkmcnt(1)
ds_read_b128 a[144:147], v2 offset:16384
v_cvt_pk_bf16_f32 v197, v146, v147
v_mfma_f32_16x16x32_bf16 a[80:83], a[176:179], v[200:203], a[80:83]
v_exp_f32 v148, v148
v_mfma_f32_16x16x32_bf16 a[80:83], a[180:183], v[204:207], a[80:83]
ds_read_b128 a[148:151], v2 offset:17408
ds_read_b128 a[152:155], v2 offset:18432
v_mfma_f32_16x16x32_bf16 a[112:115], a[180:183], v[212:215], a[112:115]
v_exp_f32 v149, v149
v_mfma_f32_16x16x32_bf16 a[112:115], a[176:179], v[208:211], a[112:115]
ds_read_b128 a[156:159], v2 offset:19456
v_cvt_pk_bf16_f32 v198, v148, v149
v_mfma_f32_16x16x32_bf16 a[116:119], a[184:187], v[208:211], a[116:119]
v_exp_f32 v150, v150
v_mfma_f32_16x16x32_bf16 a[116:119], a[188:191], v[212:215], a[116:119]
buffer_load_dwordx4 v16, s[32:35], s70 offen offset:0 sc1 lds
v_mfma_f32_16x16x32_bf16 a[84:87], a[188:191], v[204:207], a[84:87]
v_exp_f32 v151, v151
v_mfma_f32_16x16x32_bf16 a[84:87], a[184:187], v[200:203], a[84:87]
ds_read_b128 a[160:163], v2 offset:20480
v_cvt_pk_bf16_f32 v199, v150, v151
v_mfma_f32_16x16x32_bf16 a[88:91], a[192:195], v[200:203], a[88:91]
v_exp_f32 v132, v132
v_mfma_f32_16x16x32_bf16 a[88:91], a[196:199], v[204:207], a[88:91]
ds_read_b128 a[164:167], v2 offset:21504
v_mfma_f32_16x16x32_bf16 a[120:123], a[196:199], v[212:215], a[120:123]
v_exp_f32 v133, v133
v_mfma_f32_16x16x32_bf16 a[120:123], a[192:195], v[208:211], a[120:123]
ds_read_b128 a[168:171], v2 offset:22528
v_cvt_pk_bf16_f32 v190, v132, v133
v_mfma_f32_16x16x32_bf16 a[124:127], a[200:203], v[208:211], a[124:127]
s_waitcnt lgkmcnt(3)
v_exp_f32 v134, v134
v_mfma_f32_16x16x32_bf16 a[124:127], a[204:207], v[212:215], a[124:127]
buffer_load_dwordx4 v16, s[32:35], s70 offen offset:1024 sc1 lds
v_mfma_f32_16x16x32_bf16 a[92:95], a[204:207], v[204:207], a[92:95]
v_exp_f32 v135, v135
v_mfma_f32_16x16x32_bf16 a[92:95], a[200:203], v[200:203], a[92:95]
ds_read_b128 a[172:175], v2 offset:23552
v_cvt_pk_bf16_f32 v191, v134, v135
v_mfma_f32_16x16x32_bf16 v[120:123], a[144:147], v[56:59], v[224:227]
ds_read_b128 a[176:179], v2 offset:24576
ds_read_b128 a[180:183], v2 offset:25600
v_mfma_f32_16x16x32_bf16 v[120:123], a[148:151], v[60:63], v[120:123]
buffer_load_dwordx4 v16, s[32:35], s70 offen offset:2048 sc1 lds
v_mfma_f32_16x16x32_bf16 v[120:123], a[152:155], v[64:67], v[120:123]
s_add_u32 s64, s70, 4096
ds_read_b128 a[184:187], v2 offset:26624
ds_read_b128 a[188:191], v2 offset:27648
v_mfma_f32_16x16x32_bf16 v[120:123], a[156:159], v[68:71], v[120:123]
buffer_load_dwordx4 v16, s[32:35], s70 offen offset:3072 sc1 lds
v_mfma_f32_16x16x32_bf16 v[136:139], a[156:159], v[84:87], v[228:231]
s_add_u32 m0, s71, 4096
ds_read_b128 a[192:195], v2 offset:28672
ds_read_b128 a[196:199], v2 offset:29696
v_mfma_f32_16x16x32_bf16 v[136:139], a[152:155], v[80:83], v[136:139]
buffer_load_dwordx4 v16, s[32:35], s64 offen offset:0 sc1 lds
v_mfma_f32_16x16x32_bf16 v[136:139], a[148:151], v[76:79], v[136:139]
ds_read_b128 a[200:203], v2 offset:30720
ds_read_b128 a[204:207], v2 offset:31744
v_mfma_f32_16x16x32_bf16 v[136:139], a[144:147], v[72:75], v[136:139]
s_waitcnt lgkmcnt(6)
v_exp_f32 v120, v120
v_mfma_f32_16x16x32_bf16 v[140:143], a[160:163], v[72:75], v[228:231]
v_exp_f32 v121, v121
v_mfma_f32_16x16x32_bf16 v[140:143], a[164:167], v[76:79], v[140:143]
v_exp_f32 v122, v122
v_mfma_f32_16x16x32_bf16 v[140:143], a[168:171], v[80:83], v[140:143]
v_exp_f32 v123, v123
v_mfma_f32_16x16x32_bf16 v[140:143], a[172:175], v[84:87], v[140:143]
v_exp_f32 v136, v136
v_mfma_f32_16x16x32_bf16 v[124:127], a[172:175], v[68:71], v[224:227]
ds_read_b128 a[144:147], v3 offset:16384
v_cvt_pk_bf16_f32 v200, v120, v121
v_mfma_f32_16x16x32_bf16 v[124:127], a[168:171], v[64:67], v[124:127]
v_exp_f32 v137, v137
v_mfma_f32_16x16x32_bf16 v[124:127], a[164:167], v[60:63], v[124:127]
ds_read_b128 a[148:151], v3 offset:24576
v_cvt_pk_bf16_f32 v201, v122, v123
v_mfma_f32_16x16x32_bf16 v[124:127], a[160:163], v[56:59], v[124:127]
v_exp_f32 v138, v138
v_mfma_f32_16x16x32_bf16 v[128:131], a[176:179], v[56:59], v[224:227]
ds_read_b128 a[152:155], v3 offset:17408
v_cvt_pk_bf16_f32 v208, v136, v137
v_mfma_f32_16x16x32_bf16 v[128:131], a[180:183], v[60:63], v[128:131]
s_waitcnt lgkmcnt(3)
v_exp_f32 v139, v139
v_mfma_f32_16x16x32_bf16 v[128:131], a[184:187], v[64:67], v[128:131]
ds_read_b128 a[156:159], v3 offset:25600
v_cvt_pk_bf16_f32 v209, v138, v139
v_mfma_f32_16x16x32_bf16 v[128:131], a[188:191], v[68:71], v[128:131]
v_exp_f32 v140, v140
v_mfma_f32_16x16x32_bf16 v[144:147], a[188:191], v[84:87], v[228:231]
buffer_load_dwordx4 v16, s[32:35], s64 offen offset:1024 sc1 lds
v_mfma_f32_16x16x32_bf16 v[144:147], a[184:187], v[80:83], v[144:147]
v_exp_f32 v141, v141
v_mfma_f32_16x16x32_bf16 v[144:147], a[180:183], v[76:79], v[144:147]
ds_read_b128 a[160:163], v3 offset:18432
v_cvt_pk_bf16_f32 v210, v140, v141
v_mfma_f32_16x16x32_bf16 v[144:147], a[176:179], v[72:75], v[144:147]
v_exp_f32 v142, v142
v_mfma_f32_16x16x32_bf16 v[148:151], a[192:195], v[72:75], v[228:231]
ds_read_b128 a[164:167], v3 offset:26624
ds_read_b128 a[168:171], v3 offset:19456
v_mfma_f32_16x16x32_bf16 v[148:151], a[196:199], v[76:79], v[148:151]
v_exp_f32 v143, v143
v_mfma_f32_16x16x32_bf16 v[148:151], a[200:203], v[80:83], v[148:151]
ds_read_b128 a[172:175], v3 offset:27648
v_cvt_pk_bf16_f32 v211, v142, v143
v_mfma_f32_16x16x32_bf16 v[148:151], a[204:207], v[84:87], v[148:151]
v_exp_f32 v124, v124
v_mfma_f32_16x16x32_bf16 v[132:135], a[204:207], v[68:71], v[224:227]
ds_read_b128 a[176:179], v3 offset:20480
buffer_load_dwordx4 v16, s[32:35], s64 offen offset:2048 sc1 lds
v_mfma_f32_16x16x32_bf16 v[132:135], a[200:203], v[64:67], v[132:135]
v_exp_f32 v125, v125
v_mfma_f32_16x16x32_bf16 v[132:135], a[196:199], v[60:63], v[132:135]
ds_read_b128 a[180:183], v3 offset:28672
v_cvt_pk_bf16_f32 v202, v124, v125
v_mfma_f32_16x16x32_bf16 v[132:135], a[192:195], v[56:59], v[132:135]
v_exp_f32 v126, v126
v_smfmac_f32_16x16x64_bf16 a[136:139], a[240:243], v[184:191], v5
ds_read_b128 a[184:187], v3 offset:21504
v_smfmac_f32_16x16x64_bf16 a[140:143], a[240:243], v[192:199], v5
s_waitcnt lgkmcnt(3)
ds_read_b128 a[188:191], v3 offset:29696
v_mfma_f32_16x16x32_bf16 a[64:67], a[144:147], v[184:187], a[64:67]
v_exp_f32 v127, v127
v_mfma_f32_16x16x32_bf16 a[64:67], a[148:151], v[188:191], a[64:67]
v_exp_f32 v128, v128
v_mfma_f32_16x16x32_bf16 a[96:99], a[148:151], v[196:199], a[96:99]
v_exp_f32 v129, v129
v_mfma_f32_16x16x32_bf16 a[96:99], a[144:147], v[192:195], a[96:99]
ds_read_b128 a[192:195], v3 offset:22528
v_cvt_pk_bf16_f32 v203, v126, v127
v_mfma_f32_16x16x32_bf16 a[100:103], a[152:155], v[192:195], a[100:103]
v_exp_f32 v130, v130
v_mfma_f32_16x16x32_bf16 a[100:103], a[156:159], v[196:199], a[100:103]
ds_read_b128 a[196:199], v3 offset:30720
v_cvt_pk_bf16_f32 v204, v128, v129
v_mfma_f32_16x16x32_bf16 a[68:71], a[156:159], v[188:191], a[68:71]
v_exp_f32 v131, v131
v_mfma_f32_16x16x32_bf16 a[68:71], a[152:155], v[184:187], a[68:71]
ds_read_b128 a[200:203], v3 offset:23552
v_cvt_pk_bf16_f32 v205, v130, v131
v_mfma_f32_16x16x32_bf16 a[72:75], a[160:163], v[184:187], a[72:75]
v_exp_f32 v144, v144
v_mfma_f32_16x16x32_bf16 a[72:75], a[164:167], v[188:191], a[72:75]
buffer_load_dwordx4 v16, s[32:35], s64 offen offset:3072 sc1 lds
v_mfma_f32_16x16x32_bf16 a[104:107], a[164:167], v[196:199], a[104:107]
s_xor_b32 s71, s71, 49152
v_exp_f32 v145, v145
v_mfma_f32_16x16x32_bf16 a[104:107], a[160:163], v[192:195], a[104:107]
ds_read_b128 a[204:207], v3 offset:31744
v_cvt_pk_bf16_f32 v212, v144, v145
v_mfma_f32_16x16x32_bf16 a[108:111], a[168:171], v[192:195], a[108:111]
s_add_u32 s70, s70, 32768
v_xor_b32 v2, 0x8000, v2
v_exp_f32 v146, v146
v_mfma_f32_16x16x32_bf16 a[108:111], a[172:175], v[196:199], a[108:111]
s_waitcnt vmcnt(8)
s_barrier
v_mfma_f32_16x16x32_bf16 a[76:79], a[172:175], v[188:191], a[76:79]
s_mov_b32 m0, s71
v_exp_f32 v147, v147
v_mfma_f32_16x16x32_bf16 a[76:79], a[168:171], v[184:187], a[76:79]
s_waitcnt lgkmcnt(1)
ds_read_b128 a[144:147], v2 offset:0
v_cvt_pk_bf16_f32 v213, v146, v147
v_mfma_f32_16x16x32_bf16 a[80:83], a[176:179], v[184:187], a[80:83]
v_exp_f32 v148, v148
v_mfma_f32_16x16x32_bf16 a[80:83], a[180:183], v[188:191], a[80:83]
ds_read_b128 a[148:151], v2 offset:1024
ds_read_b128 a[152:155], v2 offset:2048
v_mfma_f32_16x16x32_bf16 a[112:115], a[180:183], v[196:199], a[112:115]
v_exp_f32 v149, v149
v_mfma_f32_16x16x32_bf16 a[112:115], a[176:179], v[192:195], a[112:115]
ds_read_b128 a[156:159], v2 offset:3072
v_cvt_pk_bf16_f32 v214, v148, v149
v_mfma_f32_16x16x32_bf16 a[116:119], a[184:187], v[192:195], a[116:119]
v_exp_f32 v150, v150
v_mfma_f32_16x16x32_bf16 a[116:119], a[188:191], v[196:199], a[116:119]
buffer_load_dwordx4 v16, s[32:35], s70 offen offset:0 sc1 lds
v_mfma_f32_16x16x32_bf16 a[84:87], a[188:191], v[188:191], a[84:87]
s_sub_u32 s72, s72, 1
v_exp_f32 v151, v151
v_mfma_f32_16x16x32_bf16 a[84:87], a[184:187], v[184:187], a[84:87]
ds_read_b128 a[160:163], v2 offset:4096
v_cvt_pk_bf16_f32 v215, v150, v151
v_mfma_f32_16x16x32_bf16 a[88:91], a[192:195], v[184:187], a[88:91]
v_exp_f32 v132, v132
v_mfma_f32_16x16x32_bf16 a[88:91], a[196:199], v[188:191], a[88:91]
ds_read_b128 a[164:167], v2 offset:5120
v_xor_b32 v3, 0x8000, v3
v_mfma_f32_16x16x32_bf16 a[120:123], a[196:199], v[196:199], a[120:123]
s_cmp_lg_u32 s72, 0
v_exp_f32 v133, v133
v_mfma_f32_16x16x32_bf16 a[120:123], a[192:195], v[192:195], a[120:123]
ds_read_b128 a[168:171], v2 offset:6144
v_cvt_pk_bf16_f32 v206, v132, v133
v_mfma_f32_16x16x32_bf16 a[124:127], a[200:203], v[192:195], a[124:127]
s_waitcnt lgkmcnt(3)
v_exp_f32 v134, v134
v_mfma_f32_16x16x32_bf16 a[124:127], a[204:207], v[196:199], a[124:127]
buffer_load_dwordx4 v16, s[32:35], s70 offen offset:1024 sc1 lds
v_mfma_f32_16x16x32_bf16 a[92:95], a[204:207], v[188:191], a[92:95]
v_exp_f32 v135, v135
v_mfma_f32_16x16x32_bf16 a[92:95], a[200:203], v[184:187], a[92:95]
ds_read_b128 a[172:175], v2 offset:7168
v_cvt_pk_bf16_f32 v207, v134, v135
s_cbranch_scc1 L_S
buffer_load_dword v19, off, s[52:55], s80 sc1
s_add_u32 s17, s78, L_TAIL-L_pc
buffer_load_dword a252, v16, s[88:91], s17 offen
s_add_u32 s17, s78, L_TAIL-L_pc+4096
buffer_load_dword a252, v16, s[88:91], s17 offen
s_add_u32 s17, s78, L_p5f0-L_pc
buffer_load_dword a252, v16, s[88:91], s17 offen
s_add_u32 s17, s78, L_p5f0-L_pc+4096
buffer_load_dword a252, v16, s[88:91], s17 offen
s_waitcnt lgkmcnt(7)
v_mfma_f32_16x16x32_bf16 v[136:139], a[144:147], v[72:75], v[228:231]
s_waitcnt lgkmcnt(6)
ds_read_b128 a[176:179], v2 offset:8192
ds_read_b128 a[180:183], v2 offset:9216
v_mfma_f32_16x16x32_bf16 v[136:139], a[148:151], v[76:79], v[136:139]
s_waitcnt lgkmcnt(7)
buffer_load_dwordx4 v16, s[32:35], s70 offen offset:2048 sc1 lds
v_cndmask_b32 v120, v224, v17, s[0:1]
v_cndmask_b32 v121, v224, v17, s[4:5]
v_cndmask_b32 v122, v224, v17, s[6:7]
v_cndmask_b32 v123, v224, v17, s[8:9]
v_mfma_f32_16x16x32_bf16 v[136:139], a[152:155], v[80:83], v[136:139]
s_waitcnt lgkmcnt(6)
s_add_u32 s64, s70, 4096
ds_read_b128 a[184:187], v2 offset:10240
ds_read_b128 a[188:191], v2 offset:11264
v_mfma_f32_16x16x32_bf16 v[136:139], a[156:159], v[84:87], v[136:139]
buffer_load_dwordx4 v16, s[32:35], s70 offen offset:3072 sc1 lds
v_mfma_f32_16x16x32_bf16 v[120:123], a[156:159], v[68:71], v[120:123]
s_add_u32 m0, s71, 4096
ds_read_b128 a[192:195], v2 offset:12288
ds_read_b128 a[196:199], v2 offset:13312
v_mfma_f32_16x16x32_bf16 v[120:123], a[152:155], v[64:67], v[120:123]
buffer_load_dwordx4 v16, s[32:35], s64 offen offset:0 sc1 lds
v_mfma_f32_16x16x32_bf16 v[120:123], a[148:151], v[60:63], v[120:123]
ds_read_b128 a[200:203], v2 offset:14336
ds_read_b128 a[204:207], v2 offset:15360
v_mfma_f32_16x16x32_bf16 v[120:123], a[144:147], v[56:59], v[120:123]
s_waitcnt lgkmcnt(6)
v_exp_f32 v136, v136
v_mfma_f32_16x16x32_bf16 v[140:143], a[160:163], v[72:75], v[228:231]
v_exp_f32 v137, v137
v_mfma_f32_16x16x32_bf16 v[140:143], a[164:167], v[76:79], v[140:143]
v_cndmask_b32 v124, v224, v17, s[10:11]
v_cndmask_b32 v125, v224, v17, s[12:13]
v_cndmask_b32 v126, v224, v17, s[18:19]
v_cndmask_b32 v127, v224, v17, s[22:23]
v_exp_f32 v138, v138
v_mfma_f32_16x16x32_bf16 v[140:143], a[168:171], v[80:83], v[140:143]
v_exp_f32 v139, v139
v_mfma_f32_16x16x32_bf16 v[140:143], a[172:175], v[84:87], v[140:143]
v_exp_f32 v120, v120
v_mfma_f32_16x16x32_bf16 v[124:127], a[172:175], v[68:71], v[124:127]
ds_read_b128 a[144:147], v3 offset:0
v_cvt_pk_bf16_f32 v192, v136, v137
v_mfma_f32_16x16x32_bf16 v[124:127], a[168:171], v[64:67], v[124:127]
v_cndmask_b32 v128, v224, v17, s[26:27]
v_cndmask_b32 v129, v224, v17, s[56:57]
v_cndmask_b32 v130, v224, v17, s[58:59]
v_cndmask_b32 v131, v224, v17, s[60:61]
v_exp_f32 v121, v121
v_mfma_f32_16x16x32_bf16 v[124:127], a[164:167], v[60:63], v[124:127]
s_mul_i32 s69, s83, 8
ds_read_b128 a[148:151], v3 offset:8192
v_cvt_pk_bf16_f32 v193, v138, v139
v_mfma_f32_16x16x32_bf16 v[124:127], a[160:163], v[56:59], v[124:127]
s_sub_u32 s69, 36, s69
v_exp_f32 v122, v122
v_mfma_f32_16x16x32_bf16 v[128:131], a[176:179], v[56:59], v[128:131]
ds_read_b128 a[152:155], v3 offset:1024
v_cvt_pk_bf16_f32 v184, v120, v121
v_mfma_f32_16x16x32_bf16 v[128:131], a[180:183], v[60:63], v[128:131]
s_waitcnt lgkmcnt(3)
v_exp_f32 v123, v123
v_mfma_f32_16x16x32_bf16 v[128:131], a[184:187], v[64:67], v[128:131]
ds_read_b128 a[156:159], v3 offset:9216
v_cvt_pk_bf16_f32 v185, v122, v123
v_mfma_f32_16x16x32_bf16 v[128:131], a[188:191], v[68:71], v[128:131]
v_exp_f32 v140, v140
v_mfma_f32_16x16x32_bf16 v[144:147], a[188:191], v[84:87], v[228:231]
buffer_load_dwordx4 v16, s[32:35], s64 offen offset:1024 sc1 lds
v_mfma_f32_16x16x32_bf16 v[144:147], a[184:187], v[80:83], v[144:147]
v_exp_f32 v141, v141
v_mfma_f32_16x16x32_bf16 v[144:147], a[180:183], v[76:79], v[144:147]
ds_read_b128 a[160:163], v3 offset:2048
v_cvt_pk_bf16_f32 v194, v140, v141
v_mfma_f32_16x16x32_bf16 v[144:147], a[176:179], v[72:75], v[144:147]
v_exp_f32 v142, v142
v_mfma_f32_16x16x32_bf16 v[148:151], a[192:195], v[72:75], v[228:231]
ds_read_b128 a[164:167], v3 offset:10240
ds_read_b128 a[168:171], v3 offset:3072
v_mfma_f32_16x16x32_bf16 v[148:151], a[196:199], v[76:79], v[148:151]
v_cndmask_b32 v132, v224, v17, s[62:63]
v_cndmask_b32 v133, v224, v17, s[48:49]
v_cndmask_b32 v134, v224, v17, s[50:51]
v_cndmask_b32 v135, v224, v17, s[100:101]
v_exp_f32 v143, v143
v_mfma_f32_16x16x32_bf16 v[148:151], a[200:203], v[80:83], v[148:151]
ds_read_b128 a[172:175], v3 offset:11264
v_cvt_pk_bf16_f32 v195, v142, v143
v_mfma_f32_16x16x32_bf16 v[148:151], a[204:207], v[84:87], v[148:151]
v_exp_f32 v124, v124
v_mfma_f32_16x16x32_bf16 v[132:135], a[204:207], v[68:71], v[132:135]
ds_read_b128 a[176:179], v3 offset:4096
buffer_load_dwordx4 v16, s[32:35], s64 offen offset:2048 sc1 lds
v_mfma_f32_16x16x32_bf16 v[132:135], a[200:203], v[64:67], v[132:135]
v_exp_f32 v125, v125
v_mfma_f32_16x16x32_bf16 v[132:135], a[196:199], v[60:63], v[132:135]
ds_read_b128 a[180:183], v3 offset:12288
v_cvt_pk_bf16_f32 v186, v124, v125
v_mfma_f32_16x16x32_bf16 v[132:135], a[192:195], v[56:59], v[132:135]
v_exp_f32 v126, v126
v_smfmac_f32_16x16x64_bf16 a[136:139], a[240:243], v[200:207], v5
ds_read_b128 a[184:187], v3 offset:5120
v_smfmac_f32_16x16x64_bf16 a[140:143], a[240:243], v[208:215], v5
s_waitcnt lgkmcnt(3)
ds_read_b128 a[188:191], v3 offset:13312
v_mfma_f32_16x16x32_bf16 a[64:67], a[144:147], v[200:203], a[64:67]
v_exp_f32 v127, v127
v_mfma_f32_16x16x32_bf16 a[64:67], a[148:151], v[204:207], a[64:67]
v_exp_f32 v128, v128
v_mfma_f32_16x16x32_bf16 a[96:99], a[148:151], v[212:215], a[96:99]
v_exp_f32 v129, v129
v_mfma_f32_16x16x32_bf16 a[96:99], a[144:147], v[208:211], a[96:99]
ds_read_b128 a[192:195], v3 offset:6144
v_cvt_pk_bf16_f32 v187, v126, v127
v_mfma_f32_16x16x32_bf16 a[100:103], a[152:155], v[208:211], a[100:103]
v_exp_f32 v130, v130
v_mfma_f32_16x16x32_bf16 a[100:103], a[156:159], v[212:215], a[100:103]
ds_read_b128 a[196:199], v3 offset:14336
v_cvt_pk_bf16_f32 v188, v128, v129
v_mfma_f32_16x16x32_bf16 a[68:71], a[156:159], v[204:207], a[68:71]
v_exp_f32 v131, v131
v_mfma_f32_16x16x32_bf16 a[68:71], a[152:155], v[200:203], a[68:71]
ds_read_b128 a[200:203], v3 offset:7168
v_cvt_pk_bf16_f32 v189, v130, v131
v_mfma_f32_16x16x32_bf16 a[72:75], a[160:163], v[200:203], a[72:75]
v_exp_f32 v144, v144
v_mfma_f32_16x16x32_bf16 a[72:75], a[164:167], v[204:207], a[72:75]
buffer_load_dwordx4 v16, s[32:35], s64 offen offset:3072 sc1 lds
v_mfma_f32_16x16x32_bf16 a[104:107], a[164:167], v[212:215], a[104:107]
v_exp_f32 v145, v145
v_mfma_f32_16x16x32_bf16 a[104:107], a[160:163], v[208:211], a[104:107]
ds_read_b128 a[204:207], v3 offset:15360
v_cvt_pk_bf16_f32 v196, v144, v145
v_mfma_f32_16x16x32_bf16 a[108:111], a[168:171], v[208:211], a[108:111]
v_exp_f32 v146, v146
v_mfma_f32_16x16x32_bf16 a[108:111], a[172:175], v[212:215], a[108:111]
s_waitcnt vmcnt(13)
s_barrier
v_mfma_f32_16x16x32_bf16 a[76:79], a[172:175], v[204:207], a[76:79]
v_exp_f32 v147, v147
v_mfma_f32_16x16x32_bf16 a[76:79], a[168:171], v[200:203], a[76:79]
s_waitcnt lgkmcnt(1)
ds_read_b128 a[144:147], v2 offset:16384
v_cvt_pk_bf16_f32 v197, v146, v147
v_mfma_f32_16x16x32_bf16 a[80:83], a[176:179], v[200:203], a[80:83]
s_waitcnt vmcnt(10)
v_readfirstlane_b32 vcc_lo, v19
s_nop 0
s_cmp_lt_u32 vcc_lo, s69
s_cbranch_scc1 L_spin_8
L_spinbk_9:
v_exp_f32 v148, v148
v_mfma_f32_16x16x32_bf16 a[80:83], a[180:183], v[204:207], a[80:83]
ds_read_b128 a[148:151], v2 offset:17408
ds_read_b128 a[152:155], v2 offset:18432
v_mfma_f32_16x16x32_bf16 a[112:115], a[180:183], v[212:215], a[112:115]
v_exp_f32 v149, v149
v_mfma_f32_16x16x32_bf16 a[112:115], a[176:179], v[208:211], a[112:115]
ds_read_b128 a[156:159], v2 offset:19456
v_cvt_pk_bf16_f32 v198, v148, v149
v_mfma_f32_16x16x32_bf16 a[116:119], a[184:187], v[208:211], a[116:119]
v_exp_f32 v150, v150
v_mfma_f32_16x16x32_bf16 a[116:119], a[188:191], v[212:215], a[116:119]
v_cndmask_b32 v136, v228, v17, s[0:1]
v_cndmask_b32 v137, v228, v17, s[4:5]
v_mfma_f32_16x16x32_bf16 a[84:87], a[188:191], v[204:207], a[84:87]
v_exp_f32 v151, v151
v_mfma_f32_16x16x32_bf16 a[84:87], a[184:187], v[200:203], a[84:87]
ds_read_b128 a[160:163], v2 offset:20480
v_cvt_pk_bf16_f32 v199, v150, v151
v_mfma_f32_16x16x32_bf16 a[88:91], a[192:195], v[200:203], a[88:91]
v_exp_f32 v132, v132
v_mfma_f32_16x16x32_bf16 a[88:91], a[196:199], v[204:207], a[88:91]
ds_read_b128 a[164:167], v2 offset:21504
v_cndmask_b32 v138, v228, v17, s[6:7]
v_mfma_f32_16x16x32_bf16 a[120:123], a[196:199], v[212:215], a[120:123]
v_exp_f32 v133, v133
v_mfma_f32_16x16x32_bf16 a[120:123], a[192:195], v[208:211], a[120:123]
ds_read_b128 a[168:171], v2 offset:22528
v_cvt_pk_bf16_f32 v190, v132, v133
v_mfma_f32_16x16x32_bf16 a[124:127], a[200:203], v[208:211], a[124:127]
s_waitcnt lgkmcnt(3)
v_exp_f32 v134, v134
v_mfma_f32_16x16x32_bf16 a[124:127], a[204:207], v[212:215], a[124:127]
v_cndmask_b32 v139, v228, v17, s[8:9]
v_cndmask_b32 v140, v228, v17, s[10:11]
v_mfma_f32_16x16x32_bf16 a[92:95], a[204:207], v[204:207], a[92:95]
v_exp_f32 v135, v135
v_mfma_f32_16x16x32_bf16 a[92:95], a[200:203], v[200:203], a[92:95]
ds_read_b128 a[172:175], v2 offset:23552
v_cvt_pk_bf16_f32 v191, v134, v135
v_mfma_f32_16x16x32_bf16 v[136:139], a[144:147], v[72:75], v[136:139]
ds_read_b128 a[176:179], v2 offset:24576
v_cndmask_b32 v141, v228, v17, s[12:13]
v_mfma_f32_16x16x32_bf16 v[136:139], a[148:151], v[76:79], v[136:139]
ds_read_b128 a[180:183], v2 offset:25600
v_cndmask_b32 v142, v228, v17, s[18:19]
v_cndmask_b32 v143, v228, v17, s[22:23]
v_mfma_f32_16x16x32_bf16 v[136:139], a[152:155], v[80:83], v[136:139]
ds_read_b128 a[184:187], v2 offset:26624
v_cndmask_b32 v144, v228, v17, s[26:27]
v_mfma_f32_16x16x32_bf16 v[136:139], a[156:159], v[84:87], v[136:139]
s_waitcnt lgkmcnt(3)
ds_read_b128 a[188:191], v2 offset:27648
v_cndmask_b32 v145, v228, v17, s[56:57]
v_mfma_f32_16x16x32_bf16 v[140:143], a[172:175], v[84:87], v[140:143]
ds_read_b128 a[192:195], v2 offset:28672
ds_read_b128 a[196:199], v2 offset:29696
ds_read_b128 a[200:203], v2 offset:30720
ds_read_b128 a[204:207], v2 offset:31744
v_mfma_f32_16x16x32_bf16 v[140:143], a[168:171], v[80:83], v[140:143]
ds_read_b128 a[144:147], v3 offset:16384
v_cndmask_b32 v146, v228, v17, s[58:59]
v_cndmask_b32 v147, v228, v17, s[60:61]
v_mfma_f32_16x16x32_bf16 v[140:143], a[164:167], v[76:79], v[140:143]
ds_read_b128 a[148:151], v3 offset:24576
v_cndmask_b32 v148, v228, v17, s[62:63]
v_mfma_f32_16x16x32_bf16 v[140:143], a[160:163], v[72:75], v[140:143]
s_waitcnt lgkmcnt(8)
ds_read_b128 a[152:155], v3 offset:17408
v_cndmask_b32 v149, v228, v17, s[48:49]
v_mfma_f32_16x16x32_bf16 v[144:147], a[176:179], v[72:75], v[144:147]
ds_read_b128 a[156:159], v3 offset:25600
v_cndmask_b32 v150, v228, v17, s[50:51]
v_mfma_f32_16x16x32_bf16 v[144:147], a[180:183], v[76:79], v[144:147]
s_waitcnt lgkmcnt(8)
ds_read_b128 a[160:163], v3 offset:18432
v_cndmask_b32 v151, v228, v17, s[100:101]
v_mfma_f32_16x16x32_bf16 v[144:147], a[184:187], v[80:83], v[144:147]
v_exp_f32 v136, v136
v_mfma_f32_16x16x32_bf16 v[144:147], a[188:191], v[84:87], v[144:147]
s_waitcnt lgkmcnt(4)
v_exp_f32 v137, v137
v_mfma_f32_16x16x32_bf16 v[148:151], a[204:207], v[84:87], v[148:151]
v_exp_f32 v138, v138
v_mfma_f32_16x16x32_bf16 v[148:151], a[200:203], v[80:83], v[148:151]
s_add_u32 s65, s84, 0
v_exp_f32 v139, v139
v_mfma_f32_16x16x32_bf16 v[148:151], a[196:199], v[76:79], v[148:151]
buffer_load_dwordx4 a[208:211], v14, s[44:47], s65 offen offset:0 sc1
v_mfma_f32_16x16x32_bf16 v[148:151], a[192:195], v[72:75], v[148:151]
ds_read_b128 a[164:167], v3 offset:26624
v_cvt_pk_bf16_f32 v208, v136, v137
v_smfmac_f32_16x16x64_bf16 a[136:139], a[240:243], v[184:191], v5
ds_read_b128 a[168:171], v3 offset:19456
v_smfmac_f32_16x16x64_bf16 a[140:143], a[240:243], v[192:199], v5
ds_read_b128 a[172:175], v3 offset:27648
v_mfma_f32_16x16x32_bf16 a[64:67], a[144:147], v[184:187], a[64:67]
s_waitcnt lgkmcnt(3)
v_exp_f32 v140, v140
v_mfma_f32_16x16x32_bf16 a[64:67], a[148:151], v[188:191], a[64:67]
buffer_load_dwordx4 a[216:219], v14, s[44:47], s65 offen offset:1024 sc1
v_mfma_f32_16x16x32_bf16 a[96:99], a[148:151], v[196:199], a[96:99]
v_exp_f32 v141, v141
v_mfma_f32_16x16x32_bf16 a[96:99], a[144:147], v[192:195], a[96:99]
buffer_load_dwordx4 a[224:227], v15, s[44:47], s65 offen offset:0 sc1
v_mfma_f32_16x16x32_bf16 a[100:103], a[152:155], v[192:195], a[100:103]
v_exp_f32 v142, v142
v_mfma_f32_16x16x32_bf16 a[100:103], a[156:159], v[196:199], a[100:103]
buffer_load_dwordx4 a[232:235], v15, s[44:47], s65 offen offset:1024 sc1
v_mfma_f32_16x16x32_bf16 a[68:71], a[156:159], v[188:191], a[68:71]
s_add_u32 s65, s84, 8192
ds_read_b128 a[176:179], v3 offset:20480
v_cvt_pk_bf16_f32 v209, v138, v139
v_mfma_f32_16x16x32_bf16 a[68:71], a[152:155], v[184:187], a[68:71]
buffer_load_dwordx4 a[212:215], v14, s[44:47], s65 offen offset:0 sc1
v_mfma_f32_16x16x32_bf16 a[72:75], a[160:163], v[184:187], a[72:75]
s_waitcnt lgkmcnt(1)
ds_read_b128 a[180:183], v3 offset:28672
v_cvt_pk_bf16_f32 v210, v140, v141
v_mfma_f32_16x16x32_bf16 a[72:75], a[164:167], v[188:191], a[72:75]
v_exp_f32 v143, v143
v_mfma_f32_16x16x32_bf16 a[104:107], a[164:167], v[196:199], a[104:107]
buffer_load_dwordx4 a[220:223], v14, s[44:47], s65 offen offset:1024 sc1
v_mfma_f32_16x16x32_bf16 a[104:107], a[160:163], v[192:195], a[104:107]
v_exp_f32 v144, v144
v_mfma_f32_16x16x32_bf16 a[108:111], a[168:171], v[192:195], a[108:111]
ds_read_b128 a[184:187], v3 offset:21504
v_xor_b32 v2, 0x8000, v2
v_mfma_f32_16x16x32_bf16 a[108:111], a[172:175], v[196:199], a[108:111]
buffer_load_dwordx4 a[228:231], v15, s[44:47], s65 offen offset:0 sc1
ds_read_b128 a[188:191], v3 offset:29696
v_mfma_f32_16x16x32_bf16 a[76:79], a[172:175], v[188:191], a[76:79]
v_exp_f32 v145, v145
v_mfma_f32_16x16x32_bf16 a[76:79], a[168:171], v[184:187], a[76:79]
s_waitcnt lgkmcnt(2)
buffer_load_dwordx4 a[236:239], v15, s[44:47], s65 offen offset:1024 sc1
v_mfma_f32_16x16x32_bf16 a[80:83], a[176:179], v[184:187], a[80:83]
s_add_u32 s65, s84, 32768
ds_read_b128 a[192:195], v3 offset:22528
v_cvt_pk_bf16_f32 v211, v142, v143
v_mfma_f32_16x16x32_bf16 a[80:83], a[180:183], v[188:191], a[80:83]
buffer_load_dwordx4 v[152:155], v14, s[44:47], s65 offen offset:0 sc1
ds_read_b128 a[196:199], v3 offset:30720
v_exp_f32 v146, v146
v_mfma_f32_16x16x32_bf16 a[112:115], a[180:183], v[196:199], a[112:115]
ds_read_b128 a[200:203], v3 offset:23552
ds_read_b128 a[204:207], v3 offset:31744
v_mfma_f32_16x16x32_bf16 a[112:115], a[176:179], v[192:195], a[112:115]
s_waitcnt vmcnt(9)
s_barrier
v_xor_b32 v3, 0x8000, v3
buffer_load_dwordx4 v[160:163], v14, s[44:47], s65 offen offset:1024 sc1
s_waitcnt lgkmcnt(4)
v_mfma_f32_16x16x32_bf16 a[116:119], a[184:187], v[192:195], a[116:119]
v_exp_f32 v147, v147
v_mfma_f32_16x16x32_bf16 a[116:119], a[188:191], v[196:199], a[116:119]
buffer_load_dwordx4 v[168:171], v15, s[44:47], s65 offen offset:0 sc1
v_mfma_f32_16x16x32_bf16 a[84:87], a[188:191], v[188:191], a[84:87]
v_exp_f32 v148, v148
v_mfma_f32_16x16x32_bf16 a[84:87], a[184:187], v[184:187], a[84:87]
s_waitcnt lgkmcnt(2)
buffer_load_dwordx4 v[176:179], v15, s[44:47], s65 offen offset:1024 sc1
v_cvt_pk_bf16_f32 v212, v144, v145
v_mfma_f32_16x16x32_bf16 a[88:91], a[192:195], v[184:187], a[88:91]
s_add_u32 s65, s84, 40960
v_exp_f32 v149, v149
v_mfma_f32_16x16x32_bf16 a[88:91], a[196:199], v[188:191], a[88:91]
buffer_load_dwordx4 v[156:159], v14, s[44:47], s65 offen offset:0 sc1
v_mfma_f32_16x16x32_bf16 a[120:123], a[196:199], v[196:199], a[120:123]
ds_read_b128 a[144:147], v3 offset:0
v_cvt_pk_bf16_f32 v213, v146, v147
v_mfma_f32_16x16x32_bf16 a[120:123], a[192:195], v[192:195], a[120:123]
s_waitcnt lgkmcnt(1)
buffer_load_dwordx4 v[164:167], v14, s[44:47], s65 offen offset:1024 sc1
ds_read_b128 a[148:151], v3 offset:8192
v_exp_f32 v150, v150
v_mfma_f32_16x16x32_bf16 a[124:127], a[200:203], v[192:195], a[124:127]
ds_read_b128 a[152:155], v3 offset:1024
v_cvt_pk_bf16_f32 v214, v148, v149
v_mfma_f32_16x16x32_bf16 a[124:127], a[204:207], v[196:199], a[124:127]
buffer_load_dwordx4 v[172:175], v15, s[44:47], s65 offen offset:0 sc1
ds_read_b128 a[156:159], v3 offset:9216
v_mfma_f32_16x16x32_bf16 a[92:95], a[204:207], v[188:191], a[92:95]
v_exp_f32 v151, v151
v_mfma_f32_16x16x32_bf16 a[92:95], a[200:203], v[184:187], a[92:95]
buffer_load_dwordx4 v[180:183], v15, s[44:47], s65 offen offset:1024 sc1
ds_read_b128 a[160:163], v3 offset:2048
ds_read_b128 a[164:167], v3 offset:10240
ds_read_b128 a[168:171], v3 offset:3072
ds_read_b128 a[172:175], v3 offset:11264
v_cvt_pk_bf16_f32 v215, v150, v151
v_accvgpr_read_b32 v22, a136
v_accvgpr_read_b32 v248, a137
v_add_f32 v22, v22, v248
v_max_f32 v1, v1, v22
v_rcp_f32 v22, v22
v_accvgpr_read_b32 v232, a64
v_accvgpr_read_b32 v233, a65
v_accvgpr_read_b32 v234, a66
v_accvgpr_read_b32 v235, a67
v_accvgpr_read_b32 v236, a68
v_accvgpr_read_b32 v237, a69
v_accvgpr_read_b32 v238, a70
v_accvgpr_read_b32 v239, a71
v_mul_f32 v22, v22, v8
v_mul_f32 v232, v232, v22
v_mul_f32 v233, v233, v22
v_mul_f32 v234, v234, v22
v_mul_f32 v235, v235, v22
v_mul_f32 v236, v236, v22
v_mul_f32 v237, v237, v22
v_mul_f32 v238, v238, v22
v_mul_f32 v239, v239, v22
v_cvt_pk_bf16_f32 v232, v232, v233
v_cvt_pk_bf16_f32 v233, v234, v235
v_cvt_pk_bf16_f32 v234, v236, v237
v_cvt_pk_bf16_f32 v235, v238, v239
s_add_u32 s77, s75, 0
buffer_store_dwordx4 v[232:235], v16, s[44:47], s77 offen sc1
L_TAIL:
ds_read_b128 a[176:179], v3 offset:4096
ds_read_b128 a[180:183], v3 offset:12288
ds_read_b128 a[184:187], v3 offset:5120
ds_read_b128 a[188:191], v3 offset:13312
v_smfmac_f32_16x16x64_bf16 a[140:143], a[240:243], v[208:215], v5
s_waitcnt lgkmcnt(11)
s_add_u32 m0, s86, 32768
s_add_u32 s64, s85, 262144
ds_read_b128 a[192:195], v3 offset:6144
v_mfma_f32_16x16x32_bf16 a[96:99], a[144:147], v[208:211], a[96:99]
s_waitcnt lgkmcnt(11)
ds_read_b128 a[196:199], v3 offset:14336
ds_read_b128 a[200:203], v3 offset:7168
ds_read_b128 a[204:207], v3 offset:15360
v_mfma_f32_16x16x32_bf16 a[96:99], a[148:151], v[212:215], a[96:99]
s_waitcnt lgkmcnt(12)
buffer_load_dwordx4 v12, s[36:39], s64 offen lds
v_mfma_f32_16x16x32_bf16 a[100:103], a[156:159], v[212:215], a[100:103]
s_add_u32 m0, s86, 33792
s_add_u32 s64, s85, 270336
v_accvgpr_read_b32 v240, a72
v_accvgpr_read_b32 v241, a73
v_mfma_f32_16x16x32_bf16 a[100:103], a[152:155], v[208:211], a[100:103]
s_waitcnt lgkmcnt(11)
buffer_load_dwordx4 v13, s[36:39], s64 offen lds
v_mfma_f32_16x16x32_bf16 a[104:107], a[160:163], v[208:211], a[104:107]
s_waitcnt lgkmcnt(10)
s_add_u32 m0, s86, 34816
s_add_u32 s64, s85, 278528
v_accvgpr_read_b32 v242, a74
v_accvgpr_read_b32 v243, a75
v_mfma_f32_16x16x32_bf16 a[104:107], a[164:167], v[212:215], a[104:107]
s_waitcnt lgkmcnt(8)
buffer_load_dwordx4 v12, s[36:39], s64 offen lds
v_mfma_f32_16x16x32_bf16 a[108:111], a[172:175], v[212:215], a[108:111]
s_add_u32 m0, s86, 35840
s_add_u32 s64, s85, 286720
v_accvgpr_read_b32 v244, a76
v_accvgpr_read_b32 v245, a77
v_mfma_f32_16x16x32_bf16 a[108:111], a[168:171], v[208:211], a[108:111]
s_waitcnt lgkmcnt(7)
buffer_load_dwordx4 v13, s[36:39], s64 offen lds
v_mfma_f32_16x16x32_bf16 a[112:115], a[176:179], v[208:211], a[112:115]
s_waitcnt lgkmcnt(6)
s_add_u32 m0, s86, 36864
s_add_u32 s64, s85, 294912
v_accvgpr_read_b32 v246, a78
v_accvgpr_read_b32 v247, a79
v_mfma_f32_16x16x32_bf16 a[112:115], a[180:183], v[212:215], a[112:115]
s_waitcnt lgkmcnt(4)
buffer_load_dwordx4 v12, s[36:39], s64 offen lds
v_mfma_f32_16x16x32_bf16 a[116:119], a[188:191], v[212:215], a[116:119]
s_add_u32 m0, s86, 37888
s_add_u32 s64, s85, 303104
v_mul_f32 v240, v240, v22
v_mul_f32 v241, v241, v22
v_mfma_f32_16x16x32_bf16 a[116:119], a[184:187], v[208:211], a[116:119]
s_waitcnt lgkmcnt(3)
buffer_load_dwordx4 v13, s[36:39], s64 offen lds
v_mfma_f32_16x16x32_bf16 a[120:123], a[192:195], v[208:211], a[120:123]
s_waitcnt lgkmcnt(2)
s_add_u32 m0, s86, 38912
s_add_u32 s64, s85, 311296
v_mul_f32 v242, v242, v22
v_mul_f32 v243, v243, v22
v_mfma_f32_16x16x32_bf16 a[120:123], a[196:199], v[212:215], a[120:123]
s_waitcnt lgkmcnt(0)
buffer_load_dwordx4 v12, s[36:39], s64 offen lds
v_mfma_f32_16x16x32_bf16 a[124:127], a[204:207], v[212:215], a[124:127]
s_add_u32 m0, s86, 39936
s_add_u32 s64, s85, 319488
v_mul_f32 v244, v244, v22
v_mul_f32 v245, v245, v22
v_mfma_f32_16x16x32_bf16 a[124:127], a[200:203], v[208:211], a[124:127]
buffer_load_dwordx4 v13, s[36:39], s64 offen lds
v_mul_f32 v246, v246, v22
v_mul_f32 v247, v247, v22
v_cvt_pk_bf16_f32 v240, v240, v241
v_cvt_pk_bf16_f32 v241, v242, v243
v_cvt_pk_bf16_f32 v242, v244, v245
v_cvt_pk_bf16_f32 v243, v246, v247
s_add_u32 s77, s75, 8192
buffer_store_dwordx4 v[240:243], v16, s[44:47], s77 offen sc1
v_accvgpr_read_b32 v23, a140
v_accvgpr_read_b32 v248, a141
v_add_f32 v23, v23, v248
v_max_f32 v1, v1, v23
v_rcp_f32 v23, v23
s_mov_b32 s66, 0x5d800000
v_cmp_le_f32 vcc, s66, v1
s_lshl_b32 s67, s30, 2
s_cmp_lg_u64 vcc, 0
s_cselect_b32 s66, 1, 0
v_mov_b32 v248, s67
v_mov_b32 v249, s66
ds_write_b32 v248, v249
v_accvgpr_read_b32 v232, a80
v_accvgpr_read_b32 v233, a81
v_accvgpr_read_b32 v234, a82
v_accvgpr_read_b32 v235, a83
v_accvgpr_read_b32 v236, a84
v_accvgpr_read_b32 v237, a85
v_accvgpr_read_b32 v238, a86
v_accvgpr_read_b32 v239, a87
v_pk_mul_f32 v[232:233], v[232:233], v[22:23] op_sel_hi:[1,0]
v_pk_mul_f32 v[234:235], v[234:235], v[22:23] op_sel_hi:[1,0]
v_pk_mul_f32 v[236:237], v[236:237], v[22:23] op_sel_hi:[1,0]
v_pk_mul_f32 v[238:239], v[238:239], v[22:23] op_sel_hi:[1,0]
v_cvt_pk_bf16_f32 v232, v232, v233
v_cvt_pk_bf16_f32 v233, v234, v235
v_cvt_pk_bf16_f32 v234, v236, v237
v_cvt_pk_bf16_f32 v235, v238, v239
s_add_u32 s77, s75, 16384
buffer_store_dwordx4 v[232:235], v16, s[44:47], s77 offen sc1
v_accvgpr_read_b32 v240, a88
v_accvgpr_read_b32 v241, a89
v_accvgpr_read_b32 v242, a90
v_accvgpr_read_b32 v243, a91
v_accvgpr_read_b32 v244, a92
v_accvgpr_read_b32 v245, a93
v_accvgpr_read_b32 v246, a94
v_accvgpr_read_b32 v247, a95
v_pk_mul_f32 v[240:241], v[240:241], v[22:23] op_sel_hi:[1,0]
v_pk_mul_f32 v[242:243], v[242:243], v[22:23] op_sel_hi:[1,0]
v_pk_mul_f32 v[244:245], v[244:245], v[22:23] op_sel_hi:[1,0]
v_pk_mul_f32 v[246:247], v[246:247], v[22:23] op_sel_hi:[1,0]
v_cvt_pk_bf16_f32 v240, v240, v241
v_cvt_pk_bf16_f32 v241, v242, v243
v_cvt_pk_bf16_f32 v242, v244, v245
v_cvt_pk_bf16_f32 v243, v246, v247
s_add_u32 s77, s75, 24576
buffer_store_dwordx4 v[240:243], v16, s[44:47], s77 offen sc1
v_accvgpr_read_b32 v232, a96
v_accvgpr_read_b32 v233, a97
v_accvgpr_read_b32 v234, a98
v_accvgpr_read_b32 v235, a99
v_accvgpr_read_b32 v236, a100
v_accvgpr_read_b32 v237, a101
v_accvgpr_read_b32 v238, a102
v_accvgpr_read_b32 v239, a103
v_mul_f32 v23, v23, v10
v_pk_mul_f32 v[232:233], v[232:233], v[22:23] op_sel:[0,1]
v_pk_mul_f32 v[234:235], v[234:235], v[22:23] op_sel:[0,1]
v_pk_mul_f32 v[236:237], v[236:237], v[22:23] op_sel:[0,1]
v_pk_mul_f32 v[238:239], v[238:239], v[22:23] op_sel:[0,1]
v_cvt_pk_bf16_f32 v232, v232, v233
v_cvt_pk_bf16_f32 v233, v234, v235
v_cvt_pk_bf16_f32 v234, v236, v237
v_cvt_pk_bf16_f32 v235, v238, v239
s_add_u32 s77, s75, 4096
buffer_store_dwordx4 v[232:235], v16, s[44:47], s77 offen sc1
v_accvgpr_read_b32 v240, a104
v_accvgpr_read_b32 v241, a105
v_accvgpr_read_b32 v242, a106
v_accvgpr_read_b32 v243, a107
v_accvgpr_read_b32 v244, a108
v_accvgpr_read_b32 v245, a109
v_accvgpr_read_b32 v246, a110
v_accvgpr_read_b32 v247, a111
v_pk_mul_f32 v[240:241], v[240:241], v[22:23] op_sel:[0,1]
v_pk_mul_f32 v[242:243], v[242:243], v[22:23] op_sel:[0,1]
v_pk_mul_f32 v[244:245], v[244:245], v[22:23] op_sel:[0,1]
v_pk_mul_f32 v[246:247], v[246:247], v[22:23] op_sel:[0,1]
v_cvt_pk_bf16_f32 v240, v240, v241
v_cvt_pk_bf16_f32 v241, v242, v243
v_cvt_pk_bf16_f32 v242, v244, v245
v_cvt_pk_bf16_f32 v243, v246, v247
s_add_u32 s77, s75, 12288
buffer_store_dwordx4 v[240:243], v16, s[44:47], s77 offen sc1
v_accvgpr_read_b32 v232, a112
v_accvgpr_read_b32 v233, a113
v_accvgpr_read_b32 v234, a114
v_accvgpr_read_b32 v235, a115
v_accvgpr_read_b32 v236, a116
v_accvgpr_read_b32 v237, a117
v_accvgpr_read_b32 v238, a118
v_accvgpr_read_b32 v239, a119
v_pk_mul_f32 v[232:233], v[232:233], v[22:23] op_sel:[0,1]
v_pk_mul_f32 v[234:235], v[234:235], v[22:23] op_sel:[0,1]
v_pk_mul_f32 v[236:237], v[236:237], v[22:23] op_sel:[0,1]
v_pk_mul_f32 v[238:239], v[238:239], v[22:23] op_sel:[0,1]
v_cvt_pk_bf16_f32 v232, v232, v233
v_cvt_pk_bf16_f32 v233, v234, v235
v_cvt_pk_bf16_f32 v234, v236, v237
v_cvt_pk_bf16_f32 v235, v238, v239
s_add_u32 s77, s75, 20480
buffer_store_dwordx4 v[232:235], v16, s[44:47], s77 offen sc1
v_accvgpr_read_b32 v240, a120
v_accvgpr_read_b32 v241, a121
v_accvgpr_read_b32 v242, a122
v_accvgpr_read_b32 v243, a123
v_accvgpr_read_b32 v244, a124
v_accvgpr_read_b32 v245, a125
v_accvgpr_read_b32 v246, a126
v_accvgpr_read_b32 v247, a127
v_pk_mul_f32 v[240:241], v[240:241], v[22:23] op_sel:[0,1]
v_pk_mul_f32 v[242:243], v[242:243], v[22:23] op_sel:[0,1]
v_pk_mul_f32 v[244:245], v[244:245], v[22:23] op_sel:[0,1]
v_pk_mul_f32 v[246:247], v[246:247], v[22:23] op_sel:[0,1]
v_cvt_pk_bf16_f32 v240, v240, v241
v_cvt_pk_bf16_f32 v241, v242, v243
v_cvt_pk_bf16_f32 v242, v244, v245
v_cvt_pk_bf16_f32 v243, v246, v247
s_add_u32 s77, s75, 28672
buffer_store_dwordx4 v[240:243], v16, s[44:47], s77 offen sc1
v_mov_b32 v248, 0
s_waitcnt lgkmcnt(0)
s_barrier
ds_read_b128 v[248:251], v248
v_xor_b32 v188, 128, v18
v_xor_b32 v189, 160, v18
v_xor_b32 v190, 192, v18
ds_read_b64_tr_b16 a[144:145], v188 offset:32768
ds_read_b64_tr_b16 a[146:147], v188 offset:36864
ds_read_b64_tr_b16 a[148:149], v188 offset:40960
ds_read_b64_tr_b16 a[150:151], v188 offset:45056
ds_read_b64_tr_b16 a[152:153], v189 offset:32768
ds_read_b64_tr_b16 a[154:155], v189 offset:36864
ds_read_b64_tr_b16 a[156:157], v189 offset:40960
ds_read_b64_tr_b16 a[158:159], v189 offset:45056
ds_read_b64_tr_b16 a[160:161], v190 offset:32768
ds_read_b64_tr_b16 a[162:163], v190 offset:36864
ds_read_b64_tr_b16 a[164:165], v190 offset:40960
ds_read_b64_tr_b16 a[166:167], v190 offset:45056
v_xor_b32 v191, 224, v18
v_xor_b32 v184, 0, v18
v_xor_b32 v185, 32, v18
v_xor_b32 v186, 64, v18
v_xor_b32 v187, 96, v18
s_waitcnt lgkmcnt(12)
v_or3_b32 v248, v248, v249, v250
v_or_b32 v248, v248, v251
s_nop 0
v_readfirstlane_b32 s66, v248
s_nop 0
s_cmp_gt_u32 s66, s73
s_cbranch_scc1 L_fallback_11
s_cmp_eq_u32 s83, 0
s_cbranch_scc1 L_p5f0
s_waitcnt lgkmcnt(10)
s_waitcnt vmcnt(28)
v_mfma_f32_16x16x32_bf16 v[136:139], a[144:147], a[232:235], 0
s_waitcnt vmcnt(24)
s_waitcnt lgkmcnt(8)
s_add_u32 m0, s86, 98304
ds_read_b64_tr_b16 a[168:169], v191 offset:32768
v_xor_b32 v192, 0x10000, v184
v_mfma_f32_16x16x32_bf16 v[136:139], a[148:151], a[236:239], v[136:139]
s_add_u32 s64, s85, 524288
ds_read_b64_tr_b16 a[170:171], v191 offset:36864
v_xor_b32 v193, 0x10000, v185
v_mfma_f32_16x16x32_bf16 v[104:107], a[148:151], a[228:231], 0
buffer_load_dwordx4 v12, s[36:39], s64 offen lds
v_mfma_f32_16x16x32_bf16 v[104:107], a[144:147], a[224:227], v[104:107]
s_add_u32 m0, s86, 99328
s_add_u32 s64, s85, 532480
ds_read_b64_tr_b16 a[172:173], v191 offset:40960
v_xor_b32 v194, 0x10000, v186
v_mfma_f32_16x16x32_bf16 v[72:75], a[144:147], a[216:219], 0
s_and_b32 s71, s31, 4
buffer_load_dwordx4 v13, s[36:39], s64 offen lds
v_mfma_f32_16x16x32_bf16 v[72:75], a[148:151], a[220:223], v[72:75]
s_lshl_b32 s71, s71, 5
s_add_u32 s71, s71, s79
s_add_u32 m0, s86, 100352
s_add_u32 s64, s85, 540672
ds_read_b64_tr_b16 a[174:175], v191 offset:45056
v_mfma_f32_16x16x32_bf16 v[40:43], a[148:151], a[212:215], 0
s_add_u32 s71, s71, 4096
buffer_load_dwordx4 v12, s[36:39], s64 offen lds
v_mfma_f32_16x16x32_bf16 v[40:43], a[144:147], a[208:211], v[40:43]
s_waitcnt lgkmcnt(4)
s_add_u32 s72, s80, 4096
s_add_u32 m0, s86, 101376
s_add_u32 s64, s85, 548864
ds_read_b64_tr_b16 a[176:177], v184 offset:32768
v_xor_b32 v195, 0x10000, v187
v_mfma_f32_16x16x32_bf16 v[44:47], a[152:155], a[208:211], 0
buffer_load_dwordx4 v13, s[36:39], s64 offen lds
v_mfma_f32_16x16x32_bf16 v[44:47], a[156:159], a[212:215], v[44:47]
s_add_u32 m0, s86, 102400
ds_read_b64_tr_b16 a[178:179], v184 offset:36864
v_xor_b32 v196, 0x10000, v188
v_mfma_f32_16x16x32_bf16 v[76:79], a[156:159], a[220:223], 0
s_add_u32 s64, s85, 557056
ds_read_b64_tr_b16 a[180:181], v184 offset:40960
v_xor_b32 v197, 0x10000, v189
v_mfma_f32_16x16x32_bf16 v[76:79], a[152:155], a[216:219], v[76:79]
buffer_load_dwordx4 v12, s[36:39], s64 offen lds
v_mfma_f32_16x16x32_bf16 v[108:111], a[152:155], a[224:227], 0
s_add_u32 m0, s86, 103424
s_add_u32 s64, s85, 565248
ds_read_b64_tr_b16 a[182:183], v184 offset:45056
v_xor_b32 v198, 0x10000, v190
v_mfma_f32_16x16x32_bf16 v[108:111], a[156:159], a[228:231], v[108:111]
buffer_load_dwordx4 v13, s[36:39], s64 offen lds
v_mfma_f32_16x16x32_bf16 v[140:143], a[156:159], a[236:239], 0
s_add_u32 m0, s86, 104448
s_add_u32 s64, s85, 573440
ds_read_b64_tr_b16 a[184:185], v185 offset:32768
v_xor_b32 v199, 0x10000, v191
v_mfma_f32_16x16x32_bf16 v[140:143], a[152:155], a[232:235], v[140:143]
buffer_load_dwordx4 v12, s[36:39], s64 offen lds
v_mfma_f32_16x16x32_bf16 v[144:147], a[160:163], a[232:235], 0
s_add_u32 m0, s86, 105472
ds_read_b64_tr_b16 a[186:187], v185 offset:36864
v_mfma_f32_16x16x32_bf16 v[144:147], a[164:167], a[236:239], v[144:147]
s_add_u32 s64, s85, 581632
ds_read_b64_tr_b16 a[188:189], v185 offset:40960
v_mfma_f32_16x16x32_bf16 v[112:115], a[164:167], a[228:231], 0
buffer_load_dwordx4 v13, s[36:39], s64 offen lds
v_mfma_f32_16x16x32_bf16 v[112:115], a[160:163], a[224:227], v[112:115]
s_add_u32 s65, s84, 65536
ds_read_b64_tr_b16 a[190:191], v185 offset:45056
v_mfma_f32_16x16x32_bf16 v[80:83], a[160:163], a[216:219], 0
buffer_load_dwordx4 a[32:35], v14, s[44:47], s65 offen offset:0 sc1
v_mfma_f32_16x16x32_bf16 v[80:83], a[164:167], a[220:223], v[80:83]
ds_read_b64_tr_b16 a[192:193], v186 offset:32768
v_mfma_f32_16x16x32_bf16 v[48:51], a[164:167], a[212:215], 0
buffer_load_dwordx4 a[40:43], v14, s[44:47], s65 offen offset:1024 sc1
v_mfma_f32_16x16x32_bf16 v[48:51], a[160:163], a[208:211], v[48:51]
s_waitcnt lgkmcnt(4)
ds_read_b64_tr_b16 a[194:195], v186 offset:36864
v_mfma_f32_16x16x32_bf16 v[52:55], a[168:171], a[208:211], 0
ds_read_b64_tr_b16 a[196:197], v186 offset:40960
v_mfma_f32_16x16x32_bf16 v[52:55], a[172:175], a[212:215], v[52:55]
buffer_load_dwordx4 a[48:51], v15, s[44:47], s65 offen offset:0 sc1
v_mfma_f32_16x16x32_bf16 v[84:87], a[172:175], a[220:223], 0
ds_read_b64_tr_b16 a[198:199], v186 offset:45056
v_mfma_f32_16x16x32_bf16 v[84:87], a[168:171], a[216:219], v[84:87]
buffer_load_dwordx4 a[56:59], v15, s[44:47], s65 offen offset:1024 sc1
v_mfma_f32_16x16x32_bf16 v[116:119], a[168:171], a[224:227], 0
s_add_u32 s65, s84, 73728
ds_read_b64_tr_b16 a[200:201], v187 offset:32768
v_mfma_f32_16x16x32_bf16 v[116:119], a[172:175], a[228:231], v[116:119]
buffer_load_dwordx4 a[36:39], v14, s[44:47], s65 offen offset:0 sc1
v_mfma_f32_16x16x32_bf16 v[148:151], a[172:175], a[236:239], 0
ds_read_b64_tr_b16 a[202:203], v187 offset:36864
v_mfma_f32_16x16x32_bf16 v[148:151], a[168:171], a[232:235], v[148:151]
ds_read_b64_tr_b16 a[204:205], v187 offset:40960
v_mfma_f32_16x16x32_bf16 v[120:123], a[176:179], a[232:235], 0
buffer_load_dwordx4 a[44:47], v14, s[44:47], s65 offen offset:1024 sc1
v_mfma_f32_16x16x32_bf16 v[120:123], a[180:183], a[236:239], v[120:123]
ds_read_b64_tr_b16 a[206:207], v187 offset:45056
v_mfma_f32_16x16x32_bf16 v[88:91], a[180:183], a[228:231], 0
buffer_load_dwordx4 a[52:55], v15, s[44:47], s65 offen offset:0 sc1
v_mfma_f32_16x16x32_bf16 v[88:91], a[176:179], a[224:227], v[88:91]
v_mfma_f32_16x16x32_bf16 v[56:59], a[176:179], a[216:219], 0
buffer_load_dwordx4 a[60:63], v15, s[44:47], s65 offen offset:1024 sc1
v_mfma_f32_16x16x32_bf16 v[56:59], a[180:183], a[220:223], v[56:59]
v_mfma_f32_16x16x32_bf16 v[24:27], a[180:183], a[212:215], 0
v_mfma_f32_16x16x32_bf16 v[24:27], a[176:179], a[208:211], v[24:27]
s_waitcnt lgkmcnt(1)
buffer_load_dword v19, off, s[52:55], s72 sc1
v_mfma_f32_16x16x32_bf16 v[28:31], a[184:187], a[208:211], 0
s_add_u32 s85, s85, 2883584
s_waitcnt vmcnt(24) lgkmcnt(0)
s_barrier
v_mfma_f32_16x16x32_bf16 v[28:31], a[188:191], a[212:215], v[28:31]
ds_read_b64_tr_b16 a[144:145], v196 offset:0
v_mfma_f32_16x16x32_bf16 v[60:63], a[188:191], a[220:223], 0
ds_read_b64_tr_b16 a[146:147], v196 offset:4096
v_mfma_f32_16x16x32_bf16 v[60:63], a[184:187], a[216:219], v[60:63]
s_add_u32 m0, s86, 131072
ds_read_b64_tr_b16 a[148:149], v196 offset:8192
v_mfma_f32_16x16x32_bf16 v[92:95], a[184:187], a[224:227], 0
s_add_u32 s64, s85, 0
ds_read_b64_tr_b16 a[150:151], v196 offset:12288
v_mfma_f32_16x16x32_bf16 v[92:95], a[188:191], a[228:231], v[92:95]
buffer_load_dwordx4 v12, s[40:43], s64 offen lds
v_mfma_f32_16x16x32_bf16 v[124:127], a[188:191], a[236:239], 0
s_add_u32 m0, s86, 132096
ds_read_b64_tr_b16 a[152:153], v197 offset:0
v_mfma_f32_16x16x32_bf16 v[124:127], a[184:187], a[232:235], v[124:127]
s_add_u32 s64, s85, 8192
ds_read_b64_tr_b16 a[154:155], v197 offset:4096
v_mfma_f32_16x16x32_bf16 v[128:131], a[192:195], a[232:235], 0
buffer_load_dwordx4 v13, s[40:43], s64 offen lds
v_mfma_f32_16x16x32_bf16 v[128:131], a[196:199], a[236:239], v[128:131]
ds_read_b64_tr_b16 a[156:157], v197 offset:8192
v_mfma_f32_16x16x32_bf16 v[96:99], a[196:199], a[228:231], 0
s_add_u32 m0, s86, 133120
ds_read_b64_tr_b16 a[158:159], v197 offset:12288
v_mfma_f32_16x16x32_bf16 v[96:99], a[192:195], a[224:227], v[96:99]
s_add_u32 s64, s85, 16384
ds_read_b64_tr_b16 a[160:161], v198 offset:0
v_mfma_f32_16x16x32_bf16 v[64:67], a[192:195], a[216:219], 0
buffer_load_dwordx4 v12, s[40:43], s64 offen lds
v_mfma_f32_16x16x32_bf16 v[64:67], a[196:199], a[220:223], v[64:67]
ds_read_b64_tr_b16 a[162:163], v198 offset:4096
v_mfma_f32_16x16x32_bf16 v[32:35], a[196:199], a[212:215], 0
s_add_u32 m0, s86, 134144
ds_read_b64_tr_b16 a[164:165], v198 offset:8192
v_mfma_f32_16x16x32_bf16 v[32:35], a[192:195], a[208:211], v[32:35]
s_add_u32 s64, s85, 24576
ds_read_b64_tr_b16 a[166:167], v198 offset:12288
v_mfma_f32_16x16x32_bf16 v[36:39], a[200:203], a[208:211], 0
buffer_load_dwordx4 v13, s[40:43], s64 offen lds
v_mfma_f32_16x16x32_bf16 v[36:39], a[204:207], a[212:215], v[36:39]
v_mfma_f32_16x16x32_bf16 v[68:71], a[204:207], a[220:223], 0
s_add_u32 m0, s86, 135168
v_mfma_f32_16x16x32_bf16 v[68:71], a[200:203], a[216:219], v[68:71]
s_add_u32 s64, s85, 32768
v_mfma_f32_16x16x32_bf16 v[100:103], a[200:203], a[224:227], 0
buffer_load_dwordx4 v12, s[40:43], s64 offen lds
v_mfma_f32_16x16x32_bf16 v[100:103], a[204:207], a[228:231], v[100:103]
v_mfma_f32_16x16x32_bf16 v[132:135], a[204:207], a[236:239], 0
v_mfma_f32_16x16x32_bf16 v[132:135], a[200:203], a[232:235], v[132:135]
s_waitcnt lgkmcnt(0)
v_mfma_f32_16x16x32_bf16 v[136:139], a[144:147], v[176:179], v[136:139]
s_waitcnt vmcnt(5)
v_readfirstlane_b32 vcc_lo, v19
s_nop 0
s_cmp_lt_u32 vcc_lo, 8
s_cbranch_scc1 L_spin_2016
L_spinbk_2017:
s_sub_u32 s84, s84, 688128
v_mfma_f32_16x16x32_bf16 v[136:139], a[148:151], v[180:183], v[136:139]
s_add_u32 m0, s86, 136192
s_add_u32 s64, s85, 40960
ds_read_b64_tr_b16 a[168:169], v199 offset:0
v_mfma_f32_16x16x32_bf16 v[104:107], a[148:151], v[172:175], v[104:107]
buffer_load_dwordx4 v13, s[40:43], s64 offen lds
v_mfma_f32_16x16x32_bf16 v[104:107], a[144:147], v[168:171], v[104:107]
s_add_u32 m0, s86, 137216
ds_read_b64_tr_b16 a[170:171], v199 offset:4096
v_mfma_f32_16x16x32_bf16 v[72:75], a[144:147], v[160:163], v[72:75]
s_add_u32 s64, s85, 49152
ds_read_b64_tr_b16 a[172:173], v199 offset:8192
v_mfma_f32_16x16x32_bf16 v[72:75], a[148:151], v[164:167], v[72:75]
buffer_load_dwordx4 v12, s[40:43], s64 offen lds
v_mfma_f32_16x16x32_bf16 v[40:43], a[148:151], v[156:159], v[40:43]
s_add_u32 m0, s86, 138240
ds_read_b64_tr_b16 a[174:175], v199 offset:12288
v_mfma_f32_16x16x32_bf16 v[40:43], a[144:147], v[152:155], v[40:43]
s_add_u32 s64, s85, 57344
ds_read_b64_tr_b16 a[176:177], v192 offset:0
v_mfma_f32_16x16x32_bf16 v[44:47], a[152:155], v[152:155], v[44:47]
buffer_load_dwordx4 v13, s[40:43], s64 offen lds
v_mfma_f32_16x16x32_bf16 v[44:47], a[156:159], v[156:159], v[44:47]
ds_read_b64_tr_b16 a[178:179], v192 offset:4096
v_mfma_f32_16x16x32_bf16 v[76:79], a[156:159], v[164:167], v[76:79]
ds_read_b64_tr_b16 a[180:181], v192 offset:8192
v_mfma_f32_16x16x32_bf16 v[76:79], a[152:155], v[160:163], v[76:79]
s_add_u32 s65, s84, 0
ds_read_b64_tr_b16 a[182:183], v192 offset:12288
v_mfma_f32_16x16x32_bf16 v[108:111], a[152:155], v[168:171], v[108:111]
buffer_load_dwordx4 a[208:211], v14, s[44:47], s65 offen offset:0 sc1
v_mfma_f32_16x16x32_bf16 v[108:111], a[156:159], v[172:175], v[108:111]
ds_read_b64_tr_b16 a[184:185], v193 offset:0
v_mfma_f32_16x16x32_bf16 v[140:143], a[156:159], v[180:183], v[140:143]
ds_read_b64_tr_b16 a[186:187], v193 offset:4096
v_mfma_f32_16x16x32_bf16 v[140:143], a[152:155], v[176:179], v[140:143]
buffer_load_dwordx4 a[216:219], v14, s[44:47], s65 offen offset:1024 sc1
v_mfma_f32_16x16x32_bf16 v[144:147], a[160:163], v[176:179], v[144:147]
ds_read_b64_tr_b16 a[188:189], v193 offset:8192
v_mfma_f32_16x16x32_bf16 v[144:147], a[164:167], v[180:183], v[144:147]
ds_read_b64_tr_b16 a[190:191], v193 offset:12288
v_mfma_f32_16x16x32_bf16 v[112:115], a[164:167], v[172:175], v[112:115]
s_add_u32 s17, s78, L_p5loop-L_pc+0
buffer_load_dwordx4 a[224:227], v15, s[44:47], s65 offen offset:0 sc1
v_mfma_f32_16x16x32_bf16 v[112:115], a[160:163], v[168:171], v[112:115]
buffer_load_dword a252, v16, s[88:91], s17 offen
v_mfma_f32_16x16x32_bf16 v[80:83], a[160:163], v[160:163], v[80:83]
ds_read_b64_tr_b16 a[192:193], v194 offset:0
v_mfma_f32_16x16x32_bf16 v[80:83], a[164:167], v[164:167], v[80:83]
ds_read_b64_tr_b16 a[194:195], v194 offset:4096
v_mfma_f32_16x16x32_bf16 v[48:51], a[164:167], v[156:159], v[48:51]
buffer_load_dwordx4 a[232:235], v15, s[44:47], s65 offen offset:1024 sc1
v_mfma_f32_16x16x32_bf16 v[48:51], a[160:163], v[152:155], v[48:51]
s_waitcnt lgkmcnt(4)
ds_read_b64_tr_b16 a[196:197], v194 offset:8192
v_mfma_f32_16x16x32_bf16 v[52:55], a[168:171], v[152:155], v[52:55]
s_add_u32 s65, s84, 8192
ds_read_b64_tr_b16 a[198:199], v194 offset:12288
v_mfma_f32_16x16x32_bf16 v[52:55], a[172:175], v[156:159], v[52:55]
s_add_u32 s17, s78, L_p5loop-L_pc+4096
buffer_load_dwordx4 a[212:215], v14, s[44:47], s65 offen offset:0 sc1
v_mfma_f32_16x16x32_bf16 v[84:87], a[172:175], v[164:167], v[84:87]
buffer_load_dword a252, v16, s[88:91], s17 offen
v_mfma_f32_16x16x32_bf16 v[84:87], a[168:171], v[160:163], v[84:87]
ds_read_b64_tr_b16 a[200:201], v195 offset:0
v_mfma_f32_16x16x32_bf16 v[116:119], a[168:171], v[168:171], v[116:119]
s_lshl_b32 s66, s30, 30
buffer_load_dwordx4 a[220:223], v14, s[44:47], s65 offen offset:1024 sc1
v_mfma_f32_16x16x32_bf16 v[116:119], a[172:175], v[172:175], v[116:119]
ds_read_b64_tr_b16 a[202:203], v195 offset:4096
v_lshl_add_u32 v1, v0, 24, s66
v_mfma_f32_16x16x32_bf16 v[148:151], a[172:175], v[180:183], v[148:151]
ds_read_b64_tr_b16 a[204:205], v195 offset:8192
v_mfma_f32_16x16x32_bf16 v[148:151], a[168:171], v[176:179], v[148:151]
ds_read_b64_tr_b16 a[206:207], v195 offset:12288
v_mfma_f32_16x16x32_bf16 v[120:123], a[176:179], v[176:179], v[120:123]
s_add_u32 s17, s78, L_p5loop-L_pc+8192
buffer_load_dwordx4 a[228:231], v15, s[44:47], s65 offen offset:0 sc1
v_mfma_f32_16x16x32_bf16 v[120:123], a[180:183], v[180:183], v[120:123]
buffer_load_dword a252, v16, s[88:91], s17 offen
v_mfma_f32_16x16x32_bf16 v[88:91], a[180:183], v[172:175], v[88:91]
v_mfma_f32_16x16x32_bf16 v[88:91], a[176:179], v[168:171], v[88:91]
buffer_load_dwordx4 a[236:239], v15, s[44:47], s65 offen offset:1024 sc1
v_mfma_f32_16x16x32_bf16 v[56:59], a[176:179], v[160:163], v[56:59]
v_mfma_f32_16x16x32_bf16 v[56:59], a[180:183], v[164:167], v[56:59]
v_mfma_f32_16x16x32_bf16 v[24:27], a[180:183], v[156:159], v[24:27]
v_mfma_f32_16x16x32_bf16 v[24:27], a[176:179], v[152:155], v[24:27]
v_mfma_f32_16x16x32_bf16 v[28:31], a[184:187], v[152:155], v[28:31]
s_waitcnt lgkmcnt(0)
s_barrier
v_mfma_f32_16x16x32_bf16 v[28:31], a[188:191], v[156:159], v[28:31]
s_mov_b64 exec, 1
buffer_atomic_add a251, v1, s[52:55], s71 offen offset:0 sc1
s_mov_b64 exec, -1
v_mfma_f32_16x16x32_bf16 v[60:63], a[188:191], v[164:167], v[60:63]
ds_read_b64_tr_b16 a[144:145], v188 offset:0
v_mfma_f32_16x16x32_bf16 v[60:63], a[184:187], v[160:163], v[60:63]
s_add_u32 m0, s86, 32768
ds_read_b64_tr_b16 a[146:147], v188 offset:4096
v_mfma_f32_16x16x32_bf16 v[92:95], a[184:187], v[168:171], v[92:95]
s_add_u32 s64, s85, 262144
ds_read_b64_tr_b16 a[148:149], v188 offset:8192
v_mfma_f32_16x16x32_bf16 v[92:95], a[188:191], v[172:175], v[92:95]
buffer_load_dwordx4 v12, s[40:43], s64 offen lds
v_mfma_f32_16x16x32_bf16 v[124:127], a[188:191], v[180:183], v[124:127]
s_add_u32 m0, s86, 33792
ds_read_b64_tr_b16 a[150:151], v188 offset:12288
v_mfma_f32_16x16x32_bf16 v[124:127], a[184:187], v[176:179], v[124:127]
s_add_u32 s64, s85, 270336
ds_read_b64_tr_b16 a[152:153], v189 offset:0
v_mfma_f32_16x16x32_bf16 v[128:131], a[192:195], v[176:179], v[128:131]
buffer_load_dwordx4 v13, s[40:43], s64 offen lds
v_mfma_f32_16x16x32_bf16 v[128:131], a[196:199], v[180:183], v[128:131]
ds_read_b64_tr_b16 a[154:155], v189 offset:4096
v_mfma_f32_16x16x32_bf16 v[96:99], a[196:199], v[172:175], v[96:99]
s_add_u32 m0, s86, 34816
ds_read_b64_tr_b16 a[156:157], v189 offset:8192
v_mfma_f32_16x16x32_bf16 v[96:99], a[192:195], v[168:171], v[96:99]
s_add_u32 s64, s85, 278528
ds_read_b64_tr_b16 a[158:159], v189 offset:12288
v_mfma_f32_16x16x32_bf16 v[64:67], a[192:195], v[160:163], v[64:67]
buffer_load_dwordx4 v12, s[40:43], s64 offen lds
v_mfma_f32_16x16x32_bf16 v[64:67], a[196:199], v[164:167], v[64:67]
ds_read_b64_tr_b16 a[160:161], v190 offset:0
v_mfma_f32_16x16x32_bf16 v[32:35], a[196:199], v[156:159], v[32:35]
s_add_u32 m0, s86, 35840
ds_read_b64_tr_b16 a[162:163], v190 offset:4096
v_mfma_f32_16x16x32_bf16 v[32:35], a[192:195], v[152:155], v[32:35]
s_add_u32 s64, s85, 286720
ds_read_b64_tr_b16 a[164:165], v190 offset:8192
v_mfma_f32_16x16x32_bf16 v[36:39], a[200:203], v[152:155], v[36:39]
buffer_load_dwordx4 v13, s[40:43], s64 offen lds
v_mfma_f32_16x16x32_bf16 v[36:39], a[204:207], v[156:159], v[36:39]
ds_read_b64_tr_b16 a[166:167], v190 offset:12288
v_mfma_f32_16x16x32_bf16 v[68:71], a[204:207], v[164:167], v[68:71]
s_add_u32 m0, s86, 36864
v_mfma_f32_16x16x32_bf16 v[68:71], a[200:203], v[160:163], v[68:71]
s_add_u32 s64, s85, 294912
v_mfma_f32_16x16x32_bf16 v[100:103], a[200:203], v[168:171], v[100:103]
buffer_load_dwordx4 v12, s[40:43], s64 offen lds
v_mfma_f32_16x16x32_bf16 v[100:103], a[204:207], v[172:175], v[100:103]
v_mfma_f32_16x16x32_bf16 v[132:135], a[204:207], v[180:183], v[132:135]
v_mfma_f32_16x16x32_bf16 v[132:135], a[200:203], v[176:179], v[132:135]
s_waitcnt lgkmcnt(1)
v_mfma_f32_16x16x32_bf16 v[136:139], a[144:147], a[56:59], v[136:139]
s_add_u32 m0, s86, 37888
ds_read_b64_tr_b16 a[168:169], v191 offset:0
v_mfma_f32_16x16x32_bf16 v[136:139], a[148:151], a[60:63], v[136:139]
s_add_u32 s64, s85, 303104
ds_read_b64_tr_b16 a[170:171], v191 offset:4096
v_mfma_f32_16x16x32_bf16 v[104:107], a[148:151], a[52:55], v[104:107]
buffer_load_dwordx4 v13, s[40:43], s64 offen lds
v_mfma_f32_16x16x32_bf16 v[104:107], a[144:147], a[48:51], v[104:107]
s_add_u32 m0, s86, 38912
ds_read_b64_tr_b16 a[172:173], v191 offset:8192
v_mfma_f32_16x16x32_bf16 v[72:75], a[144:147], a[40:43], v[72:75]
s_add_u32 s64, s85, 311296
ds_read_b64_tr_b16 a[174:175], v191 offset:12288
v_mfma_f32_16x16x32_bf16 v[72:75], a[148:151], a[44:47], v[72:75]
buffer_load_dwordx4 v12, s[40:43], s64 offen lds
v_mfma_f32_16x16x32_bf16 v[40:43], a[148:151], a[36:39], v[40:43]
s_add_u32 m0, s86, 39936
ds_read_b64_tr_b16 a[176:177], v184 offset:0
v_mfma_f32_16x16x32_bf16 v[40:43], a[144:147], a[32:35], v[40:43]
s_add_u32 s64, s85, 319488
ds_read_b64_tr_b16 a[178:179], v184 offset:4096
v_mfma_f32_16x16x32_bf16 v[44:47], a[152:155], a[32:35], v[44:47]
buffer_load_dwordx4 v13, s[40:43], s64 offen lds
v_mfma_f32_16x16x32_bf16 v[44:47], a[156:159], a[36:39], v[44:47]
ds_read_b64_tr_b16 a[180:181], v184 offset:8192
v_mfma_f32_16x16x32_bf16 v[76:79], a[156:159], a[44:47], v[76:79]
ds_read_b64_tr_b16 a[182:183], v184 offset:12288
v_mfma_f32_16x16x32_bf16 v[76:79], a[152:155], a[40:43], v[76:79]
s_add_u32 s65, s84, 32768
ds_read_b64_tr_b16 a[184:185], v185 offset:0
v_mfma_f32_16x16x32_bf16 v[108:111], a[152:155], a[48:51], v[108:111]
buffer_load_dwordx4 v[152:155], v14, s[44:47], s65 offen offset:0 sc1
v_mfma_f32_16x16x32_bf16 v[108:111], a[156:159], a[52:55], v[108:111]
ds_read_b64_tr_b16 a[186:187], v185 offset:4096
v_mfma_f32_16x16x32_bf16 v[140:143], a[156:159], a[60:63], v[140:143]
ds_read_b64_tr_b16 a[188:189], v185 offset:8192
v_mfma_f32_16x16x32_bf16 v[140:143], a[152:155], a[56:59], v[140:143]
buffer_load_dwordx4 v[160:163], v14, s[44:47], s65 offen offset:1024 sc1
v_mfma_f32_16x16x32_bf16 v[144:147], a[160:163], a[56:59], v[144:147]
s_waitcnt lgkmcnt(5)
ds_read_b64_tr_b16 a[190:191], v185 offset:12288
v_mfma_f32_16x16x32_bf16 v[144:147], a[164:167], a[60:63], v[144:147]
v_mfma_f32_16x16x32_bf16 v[112:115], a[164:167], a[52:55], v[112:115]
buffer_load_dwordx4 v[168:171], v15, s[44:47], s65 offen offset:0 sc1
v_mfma_f32_16x16x32_bf16 v[112:115], a[160:163], a[48:51], v[112:115]
ds_read_b64_tr_b16 a[192:193], v186 offset:0
v_mfma_f32_16x16x32_bf16 v[80:83], a[160:163], a[40:43], v[80:83]
ds_read_b64_tr_b16 a[194:195], v186 offset:4096
v_mfma_f32_16x16x32_bf16 v[80:83], a[164:167], a[44:47], v[80:83]
ds_read_b64_tr_b16 a[196:197], v186 offset:8192
v_mfma_f32_16x16x32_bf16 v[48:51], a[164:167], a[36:39], v[48:51]
buffer_load_dwordx4 v[176:179], v15, s[44:47], s65 offen offset:1024 sc1
v_mfma_f32_16x16x32_bf16 v[48:51], a[160:163], a[32:35], v[48:51]
ds_read_b64_tr_b16 a[198:199], v186 offset:12288
v_mfma_f32_16x16x32_bf16 v[52:55], a[168:171], a[32:35], v[52:55]
s_add_u32 s65, s84, 40960
v_mfma_f32_16x16x32_bf16 v[52:55], a[172:175], a[36:39], v[52:55]
buffer_load_dwordx4 v[156:159], v14, s[44:47], s65 offen offset:0 sc1
v_mfma_f32_16x16x32_bf16 v[84:87], a[172:175], a[44:47], v[84:87]
ds_read_b64_tr_b16 a[200:201], v187 offset:0
v_mfma_f32_16x16x32_bf16 v[84:87], a[168:171], a[40:43], v[84:87]
ds_read_b64_tr_b16 a[202:203], v187 offset:4096
v_mfma_f32_16x16x32_bf16 v[116:119], a[168:171], a[48:51], v[116:119]
buffer_load_dwordx4 v[164:167], v14, s[44:47], s65 offen offset:1024 sc1
v_mfma_f32_16x16x32_bf16 v[116:119], a[172:175], a[52:55], v[116:119]
ds_read_b64_tr_b16 a[204:205], v187 offset:8192
v_mfma_f32_16x16x32_bf16 v[148:151], a[172:175], a[60:63], v[148:151]
ds_read_b64_tr_b16 a[206:207], v187 offset:12288
v_mfma_f32_16x16x32_bf16 v[148:151], a[168:171], a[56:59], v[148:151]
v_mfma_f32_16x16x32_bf16 v[120:123], a[176:179], a[56:59], v[120:123]
s_waitcnt lgkmcnt(4)
buffer_load_dwordx4 v[172:175], v15, s[44:47], s65 offen offset:0 sc1
v_mfma_f32_16x16x32_bf16 v[120:123], a[180:183], a[60:63], v[120:123]
v_mfma_f32_16x16x32_bf16 v[88:91], a[180:183], a[52:55], v[88:91]
v_mfma_f32_16x16x32_bf16 v[88:91], a[176:179], a[48:51], v[88:91]
buffer_load_dwordx4 v[180:183], v15, s[44:47], s65 offen offset:1024 sc1
v_mfma_f32_16x16x32_bf16 v[56:59], a[176:179], a[40:43], v[56:59]
v_mfma_f32_16x16x32_bf16 v[56:59], a[180:183], a[44:47], v[56:59]
v_mfma_f32_16x16x32_bf16 v[24:27], a[180:183], a[36:39], v[24:27]
v_mfma_f32_16x16x32_bf16 v[24:27], a[176:179], a[32:35], v[24:27]
v_mfma_f32_16x16x32_bf16 v[28:31], a[184:187], a[32:35], v[28:31]
s_waitcnt vmcnt(28)
s_barrier
v_mfma_f32_16x16x32_bf16 v[28:31], a[188:191], a[36:39], v[28:31]
ds_read_b64_tr_b16 a[144:145], v188 offset:32768
v_mfma_f32_16x16x32_bf16 v[60:63], a[188:191], a[44:47], v[60:63]
ds_read_b64_tr_b16 a[146:147], v188 offset:36864
v_mfma_f32_16x16x32_bf16 v[60:63], a[184:187], a[40:43], v[60:63]
s_add_u32 m0, s86, 65536
ds_read_b64_tr_b16 a[148:149], v188 offset:40960
v_mfma_f32_16x16x32_bf16 v[92:95], a[184:187], a[48:51], v[92:95]
s_add_u32 s64, s85, 524288
ds_read_b64_tr_b16 a[150:151], v188 offset:45056
v_mfma_f32_16x16x32_bf16 v[92:95], a[188:191], a[52:55], v[92:95]
buffer_load_dwordx4 v12, s[40:43], s64 offen lds
v_mfma_f32_16x16x32_bf16 v[124:127], a[188:191], a[60:63], v[124:127]
s_add_u32 m0, s86, 66560
ds_read_b64_tr_b16 a[152:153], v189 offset:32768
v_mfma_f32_16x16x32_bf16 v[124:127], a[184:187], a[56:59], v[124:127]
s_add_u32 s64, s85, 532480
ds_read_b64_tr_b16 a[154:155], v189 offset:36864
v_mfma_f32_16x16x32_bf16 v[128:131], a[192:195], a[56:59], v[128:131]
buffer_load_dwordx4 v13, s[40:43], s64 offen lds
v_mfma_f32_16x16x32_bf16 v[128:131], a[196:199], a[60:63], v[128:131]
ds_read_b64_tr_b16 a[156:157], v189 offset:40960
v_mfma_f32_16x16x32_bf16 v[96:99], a[196:199], a[52:55], v[96:99]
s_add_u32 m0, s86, 67584
ds_read_b64_tr_b16 a[158:159], v189 offset:45056
v_mfma_f32_16x16x32_bf16 v[96:99], a[192:195], a[48:51], v[96:99]
s_add_u32 s64, s85, 540672
ds_read_b64_tr_b16 a[160:161], v190 offset:32768
v_mfma_f32_16x16x32_bf16 v[64:67], a[192:195], a[40:43], v[64:67]
buffer_load_dwordx4 v12, s[40:43], s64 offen lds
v_mfma_f32_16x16x32_bf16 v[64:67], a[196:199], a[44:47], v[64:67]
ds_read_b64_tr_b16 a[162:163], v190 offset:36864
v_mfma_f32_16x16x32_bf16 v[32:35], a[196:199], a[36:39], v[32:35]
s_add_u32 m0, s86, 68608
ds_read_b64_tr_b16 a[164:165], v190 offset:40960
v_mfma_f32_16x16x32_bf16 v[32:35], a[192:195], a[32:35], v[32:35]
s_waitcnt lgkmcnt(5)
s_add_u32 s64, s85, 548864
ds_read_b64_tr_b16 a[166:167], v190 offset:45056
v_mfma_f32_16x16x32_bf16 v[36:39], a[200:203], a[32:35], v[36:39]
buffer_load_dwordx4 v13, s[40:43], s64 offen lds
v_mfma_f32_16x16x32_bf16 v[36:39], a[204:207], a[36:39], v[36:39]
v_mfma_f32_16x16x32_bf16 v[68:71], a[204:207], a[44:47], v[68:71]
s_add_u32 m0, s86, 69632
v_mfma_f32_16x16x32_bf16 v[68:71], a[200:203], a[40:43], v[68:71]
s_add_u32 s64, s85, 557056
v_mfma_f32_16x16x32_bf16 v[100:103], a[200:203], a[48:51], v[100:103]
buffer_load_dwordx4 v12, s[40:43], s64 offen lds
v_mfma_f32_16x16x32_bf16 v[100:103], a[204:207], a[52:55], v[100:103]
s_mov_b32 s70, 3
s_mov_b32 s73, 2
v_mfma_f32_16x16x32_bf16 v[132:135], a[204:207], a[60:63], v[132:135]
v_mfma_f32_16x16x32_bf16 v[132:135], a[200:203], a[56:59], v[132:135]
L_p5join:
.p2align 3
L_p5loop:
s_waitcnt lgkmcnt(10)
s_waitcnt vmcnt(19)
v_mfma_f32_16x16x32_bf16 v[136:139], a[144:147], a[232:235], v[136:139]
s_waitcnt vmcnt(15)
s_waitcnt lgkmcnt(8)
s_add_u32 m0, s86, 70656
s_add_u32 s64, s85, 565248
ds_read_b64_tr_b16 a[168:169], v191 offset:32768
v_mfma_f32_16x16x32_bf16 v[136:139], a[148:151], a[236:239], v[136:139]
buffer_load_dwordx4 v13, s[40:43], s64 offen lds
v_mfma_f32_16x16x32_bf16 v[104:107], a[148:151], a[228:231], v[104:107]
s_add_u32 m0, s86, 71680
ds_read_b64_tr_b16 a[170:171], v191 offset:36864
v_mfma_f32_16x16x32_bf16 v[104:107], a[144:147], a[224:227], v[104:107]
s_add_u32 s64, s85, 573440
ds_read_b64_tr_b16 a[172:173], v191 offset:40960
v_mfma_f32_16x16x32_bf16 v[72:75], a[144:147], a[216:219], v[72:75]
buffer_load_dwordx4 v12, s[40:43], s64 offen lds
v_mfma_f32_16x16x32_bf16 v[72:75], a[148:151], a[220:223], v[72:75]
s_add_u32 m0, s86, 72704
ds_read_b64_tr_b16 a[174:175], v191 offset:45056
v_mfma_f32_16x16x32_bf16 v[40:43], a[148:151], a[212:215], v[40:43]
s_add_u32 s64, s85, 581632
ds_read_b64_tr_b16 a[176:177], v184 offset:32768
v_mfma_f32_16x16x32_bf16 v[40:43], a[144:147], a[208:211], v[40:43]
s_waitcnt lgkmcnt(5)
buffer_load_dwordx4 v13, s[40:43], s64 offen lds
v_mfma_f32_16x16x32_bf16 v[44:47], a[152:155], a[208:211], v[44:47]
ds_read_b64_tr_b16 a[178:179], v184 offset:36864
v_mfma_f32_16x16x32_bf16 v[44:47], a[156:159], a[212:215], v[44:47]
ds_read_b64_tr_b16 a[180:181], v184 offset:40960
v_mfma_f32_16x16x32_bf16 v[76:79], a[156:159], a[220:223], v[76:79]
s_add_u32 s65, s84, 65536
ds_read_b64_tr_b16 a[182:183], v184 offset:45056
v_mfma_f32_16x16x32_bf16 v[76:79], a[152:155], a[216:219], v[76:79]
buffer_load_dwordx4 a[0:3], v14, s[44:47], s65 offen offset:0 sc1
v_mfma_f32_16x16x32_bf16 v[108:111], a[152:155], a[224:227], v[108:111]
ds_read_b64_tr_b16 a[184:185], v185 offset:32768
v_mfma_f32_16x16x32_bf16 v[108:111], a[156:159], a[228:231], v[108:111]
ds_read_b64_tr_b16 a[186:187], v185 offset:36864
v_mfma_f32_16x16x32_bf16 v[140:143], a[156:159], a[236:239], v[140:143]
buffer_load_dwordx4 a[8:11], v14, s[44:47], s65 offen offset:1024 sc1
v_mfma_f32_16x16x32_bf16 v[140:143], a[152:155], a[232:235], v[140:143]
ds_read_b64_tr_b16 a[188:189], v185 offset:40960
v_mfma_f32_16x16x32_bf16 v[144:147], a[160:163], a[232:235], v[144:147]
ds_read_b64_tr_b16 a[190:191], v185 offset:45056
v_mfma_f32_16x16x32_bf16 v[144:147], a[164:167], a[236:239], v[144:147]
v_mfma_f32_16x16x32_bf16 v[112:115], a[164:167], a[228:231], v[112:115]
buffer_load_dwordx4 a[16:19], v15, s[44:47], s65 offen offset:0 sc1
v_mfma_f32_16x16x32_bf16 v[112:115], a[160:163], a[224:227], v[112:115]
ds_read_b64_tr_b16 a[192:193], v186 offset:32768
v_mfma_f32_16x16x32_bf16 v[80:83], a[160:163], a[216:219], v[80:83]
ds_read_b64_tr_b16 a[194:195], v186 offset:36864
v_mfma_f32_16x16x32_bf16 v[80:83], a[164:167], a[220:223], v[80:83]
buffer_load_dwordx4 a[24:27], v15, s[44:47], s65 offen offset:1024 sc1
v_mfma_f32_16x16x32_bf16 v[48:51], a[164:167], a[212:215], v[48:51]
ds_read_b64_tr_b16 a[196:197], v186 offset:40960
v_mfma_f32_16x16x32_bf16 v[48:51], a[160:163], a[208:211], v[48:51]
s_waitcnt lgkmcnt(4)
ds_read_b64_tr_b16 a[198:199], v186 offset:45056
v_mfma_f32_16x16x32_bf16 v[52:55], a[168:171], a[208:211], v[52:55]
s_add_u32 s65, s84, 73728
v_mfma_f32_16x16x32_bf16 v[52:55], a[172:175], a[212:215], v[52:55]
buffer_load_dwordx4 a[4:7], v14, s[44:47], s65 offen offset:0 sc1
v_mfma_f32_16x16x32_bf16 v[84:87], a[172:175], a[220:223], v[84:87]
ds_read_b64_tr_b16 a[200:201], v187 offset:32768
v_mfma_f32_16x16x32_bf16 v[84:87], a[168:171], a[216:219], v[84:87]
ds_read_b64_tr_b16 a[202:203], v187 offset:36864
v_mfma_f32_16x16x32_bf16 v[116:119], a[168:171], a[224:227], v[116:119]
buffer_load_dwordx4 a[12:15], v14, s[44:47], s65 offen offset:1024 sc1
v_mfma_f32_16x16x32_bf16 v[116:119], a[172:175], a[228:231], v[116:119]
ds_read_b64_tr_b16 a[204:205], v187 offset:40960
v_mfma_f32_16x16x32_bf16 v[148:151], a[172:175], a[236:239], v[148:151]
ds_read_b64_tr_b16 a[206:207], v187 offset:45056
v_mfma_f32_16x16x32_bf16 v[148:151], a[168:171], a[232:235], v[148:151]
v_mfma_f32_16x16x32_bf16 v[120:123], a[176:179], a[232:235], v[120:123]
buffer_load_dwordx4 a[20:23], v15, s[44:47], s65 offen offset:0 sc1
v_mfma_f32_16x16x32_bf16 v[120:123], a[180:183], a[236:239], v[120:123]
v_mfma_f32_16x16x32_bf16 v[88:91], a[180:183], a[228:231], v[88:91]
v_mfma_f32_16x16x32_bf16 v[88:91], a[176:179], a[224:227], v[88:91]
buffer_load_dwordx4 a[28:31], v15, s[44:47], s65 offen offset:1024 sc1
v_mfma_f32_16x16x32_bf16 v[56:59], a[176:179], a[216:219], v[56:59]
v_mfma_f32_16x16x32_bf16 v[56:59], a[180:183], a[220:223], v[56:59]
v_mfma_f32_16x16x32_bf16 v[24:27], a[180:183], a[212:215], v[24:27]
v_mfma_f32_16x16x32_bf16 v[24:27], a[176:179], a[208:211], v[24:27]
v_mfma_f32_16x16x32_bf16 v[28:31], a[184:187], a[208:211], v[28:31]
s_waitcnt vmcnt(24)
s_barrier
s_waitcnt lgkmcnt(0)
v_mfma_f32_16x16x32_bf16 v[28:31], a[188:191], a[212:215], v[28:31]
s_add_u32 m0, s86, 98304
ds_read_b64_tr_b16 a[144:145], v196 offset:0
v_mfma_f32_16x16x32_bf16 v[60:63], a[188:191], a[220:223], v[60:63]
s_add_u32 s64, s85, 786432
ds_read_b64_tr_b16 a[146:147], v196 offset:4096
v_mfma_f32_16x16x32_bf16 v[60:63], a[184:187], a[216:219], v[60:63]
buffer_load_dwordx4 v12, s[40:43], s64 offen lds
v_mfma_f32_16x16x32_bf16 v[92:95], a[184:187], a[224:227], v[92:95]
ds_read_b64_tr_b16 a[148:149], v196 offset:8192
v_mfma_f32_16x16x32_bf16 v[92:95], a[188:191], a[228:231], v[92:95]
s_add_u32 m0, s86, 99328
ds_read_b64_tr_b16 a[150:151], v196 offset:12288
v_mfma_f32_16x16x32_bf16 v[124:127], a[188:191], a[236:239], v[124:127]
s_add_u32 s64, s85, 794624
ds_read_b64_tr_b16 a[152:153], v197 offset:0
v_mfma_f32_16x16x32_bf16 v[124:127], a[184:187], a[232:235], v[124:127]
buffer_load_dwordx4 v13, s[40:43], s64 offen lds
v_mfma_f32_16x16x32_bf16 v[128:131], a[192:195], a[232:235], v[128:131]
ds_read_b64_tr_b16 a[154:155], v197 offset:4096
v_mfma_f32_16x16x32_bf16 v[128:131], a[196:199], a[236:239], v[128:131]
s_add_u32 m0, s86, 100352
ds_read_b64_tr_b16 a[156:157], v197 offset:8192
v_mfma_f32_16x16x32_bf16 v[96:99], a[196:199], a[228:231], v[96:99]
s_add_u32 s64, s85, 802816
ds_read_b64_tr_b16 a[158:159], v197 offset:12288
v_mfma_f32_16x16x32_bf16 v[96:99], a[192:195], a[224:227], v[96:99]
buffer_load_dwordx4 v12, s[40:43], s64 offen lds
v_mfma_f32_16x16x32_bf16 v[64:67], a[192:195], a[216:219], v[64:67]
ds_read_b64_tr_b16 a[160:161], v198 offset:0
v_mfma_f32_16x16x32_bf16 v[64:67], a[196:199], a[220:223], v[64:67]
s_add_u32 m0, s86, 101376
ds_read_b64_tr_b16 a[162:163], v198 offset:4096
v_mfma_f32_16x16x32_bf16 v[32:35], a[196:199], a[212:215], v[32:35]
s_add_u32 s64, s85, 811008
ds_read_b64_tr_b16 a[164:165], v198 offset:8192
v_mfma_f32_16x16x32_bf16 v[32:35], a[192:195], a[208:211], v[32:35]
buffer_load_dwordx4 v13, s[40:43], s64 offen lds
v_mfma_f32_16x16x32_bf16 v[36:39], a[200:203], a[208:211], v[36:39]
ds_read_b64_tr_b16 a[166:167], v198 offset:12288
v_mfma_f32_16x16x32_bf16 v[36:39], a[204:207], a[212:215], v[36:39]
s_add_u32 m0, s86, 102400
v_mfma_f32_16x16x32_bf16 v[68:71], a[204:207], a[220:223], v[68:71]
s_add_u32 s64, s85, 819200
v_mfma_f32_16x16x32_bf16 v[68:71], a[200:203], a[216:219], v[68:71]
buffer_load_dwordx4 v12, s[40:43], s64 offen lds
v_mfma_f32_16x16x32_bf16 v[100:103], a[200:203], a[224:227], v[100:103]
v_mfma_f32_16x16x32_bf16 v[100:103], a[204:207], a[228:231], v[100:103]
v_mfma_f32_16x16x32_bf16 v[132:135], a[204:207], a[236:239], v[132:135]
v_mfma_f32_16x16x32_bf16 v[132:135], a[200:203], a[232:235], v[132:135]
s_waitcnt vmcnt(25)
s_waitcnt lgkmcnt(1)
s_add_u32 m0, s86, 103424
buffer_load_dword v19, off, s[52:55], s72 offset:128 sc1
v_mfma_f32_16x16x32_bf16 v[136:139], a[144:147], v[176:179], v[136:139]
s_waitcnt vmcnt(22)
s_add_u32 s64, s85, 827392
ds_read_b64_tr_b16 a[168:169], v199 offset:0
v_mfma_f32_16x16x32_bf16 v[136:139], a[148:151], v[180:183], v[136:139]
buffer_load_dwordx4 v13, s[40:43], s64 offen lds
v_mfma_f32_16x16x32_bf16 v[104:107], a[148:151], v[172:175], v[104:107]
s_add_u32 m0, s86, 104448
ds_read_b64_tr_b16 a[170:171], v199 offset:4096
v_mfma_f32_16x16x32_bf16 v[104:107], a[144:147], v[168:171], v[104:107]
s_add_u32 s64, s85, 835584
ds_read_b64_tr_b16 a[172:173], v199 offset:8192
v_mfma_f32_16x16x32_bf16 v[72:75], a[144:147], v[160:163], v[72:75]
buffer_load_dwordx4 v12, s[40:43], s64 offen lds
v_mfma_f32_16x16x32_bf16 v[72:75], a[148:151], v[164:167], v[72:75]
s_add_u32 m0, s86, 105472
ds_read_b64_tr_b16 a[174:175], v199 offset:12288
v_mfma_f32_16x16x32_bf16 v[40:43], a[148:151], v[156:159], v[40:43]
s_add_u32 s64, s85, 843776
ds_read_b64_tr_b16 a[176:177], v192 offset:0
v_mfma_f32_16x16x32_bf16 v[40:43], a[144:147], v[152:155], v[40:43]
buffer_load_dwordx4 v13, s[40:43], s64 offen lds
v_mfma_f32_16x16x32_bf16 v[44:47], a[152:155], v[152:155], v[44:47]
ds_read_b64_tr_b16 a[178:179], v192 offset:4096
v_mfma_f32_16x16x32_bf16 v[44:47], a[156:159], v[156:159], v[44:47]
ds_read_b64_tr_b16 a[180:181], v192 offset:8192
v_mfma_f32_16x16x32_bf16 v[76:79], a[156:159], v[164:167], v[76:79]
s_add_u32 s65, s84, 98304
ds_read_b64_tr_b16 a[182:183], v192 offset:12288
v_mfma_f32_16x16x32_bf16 v[76:79], a[152:155], v[160:163], v[76:79]
buffer_load_dwordx4 a[32:35], v14, s[44:47], s65 offen offset:0 sc1
v_mfma_f32_16x16x32_bf16 v[108:111], a[152:155], v[168:171], v[108:111]
ds_read_b64_tr_b16 a[184:185], v193 offset:0
v_mfma_f32_16x16x32_bf16 v[108:111], a[156:159], v[172:175], v[108:111]
ds_read_b64_tr_b16 a[186:187], v193 offset:4096
v_mfma_f32_16x16x32_bf16 v[140:143], a[156:159], v[180:183], v[140:143]
buffer_load_dwordx4 a[40:43], v14, s[44:47], s65 offen offset:1024 sc1
v_mfma_f32_16x16x32_bf16 v[140:143], a[152:155], v[176:179], v[140:143]
ds_read_b64_tr_b16 a[188:189], v193 offset:8192
v_mfma_f32_16x16x32_bf16 v[144:147], a[160:163], v[176:179], v[144:147]
s_waitcnt lgkmcnt(5)
s_lshl_b32 s75, s73, 20
s_add_u32 s85, s85, s75
ds_read_b64_tr_b16 a[190:191], v193 offset:12288
v_mfma_f32_16x16x32_bf16 v[144:147], a[164:167], v[180:183], v[144:147]
s_lshr_b32 s74, s73, 28
s_and_b32 s74, s74, 8
v_mfma_f32_16x16x32_bf16 v[112:115], a[164:167], v[172:175], v[112:115]
buffer_load_dwordx4 a[48:51], v15, s[44:47], s65 offen offset:0 sc1
v_mfma_f32_16x16x32_bf16 v[112:115], a[160:163], v[168:171], v[112:115]
ds_read_b64_tr_b16 a[192:193], v194 offset:0
v_mfma_f32_16x16x32_bf16 v[80:83], a[160:163], v[160:163], v[80:83]
ds_read_b64_tr_b16 a[194:195], v194 offset:4096
v_mfma_f32_16x16x32_bf16 v[80:83], a[164:167], v[164:167], v[80:83]
buffer_load_dwordx4 a[56:59], v15, s[44:47], s65 offen offset:1024 sc1
v_mfma_f32_16x16x32_bf16 v[48:51], a[164:167], v[156:159], v[48:51]
ds_read_b64_tr_b16 a[196:197], v194 offset:8192
v_mfma_f32_16x16x32_bf16 v[48:51], a[160:163], v[152:155], v[48:51]
ds_read_b64_tr_b16 a[198:199], v194 offset:12288
v_mfma_f32_16x16x32_bf16 v[52:55], a[168:171], v[152:155], v[52:55]
s_add_u32 s65, s84, 106496
v_mfma_f32_16x16x32_bf16 v[52:55], a[172:175], v[156:159], v[52:55]
buffer_load_dwordx4 a[36:39], v14, s[44:47], s65 offen offset:0 sc1
v_mfma_f32_16x16x32_bf16 v[84:87], a[172:175], v[164:167], v[84:87]
ds_read_b64_tr_b16 a[200:201], v195 offset:0
v_mfma_f32_16x16x32_bf16 v[84:87], a[168:171], v[160:163], v[84:87]
ds_read_b64_tr_b16 a[202:203], v195 offset:4096
v_mfma_f32_16x16x32_bf16 v[116:119], a[168:171], v[168:171], v[116:119]
buffer_load_dwordx4 a[44:47], v14, s[44:47], s65 offen offset:1024 sc1
v_mfma_f32_16x16x32_bf16 v[116:119], a[172:175], v[172:175], v[116:119]
ds_read_b64_tr_b16 a[204:205], v195 offset:8192
v_mfma_f32_16x16x32_bf16 v[148:151], a[172:175], v[180:183], v[148:151]
ds_read_b64_tr_b16 a[206:207], v195 offset:12288
v_mfma_f32_16x16x32_bf16 v[148:151], a[168:171], v[176:179], v[148:151]
v_mfma_f32_16x16x32_bf16 v[120:123], a[176:179], v[176:179], v[120:123]
s_waitcnt lgkmcnt(4)
buffer_load_dwordx4 a[52:55], v15, s[44:47], s65 offen offset:0 sc1
v_mfma_f32_16x16x32_bf16 v[120:123], a[180:183], v[180:183], v[120:123]
v_mfma_f32_16x16x32_bf16 v[88:91], a[180:183], v[172:175], v[88:91]
v_mfma_f32_16x16x32_bf16 v[88:91], a[176:179], v[168:171], v[88:91]
buffer_load_dwordx4 a[60:63], v15, s[44:47], s65 offen offset:1024 sc1
v_mfma_f32_16x16x32_bf16 v[56:59], a[176:179], v[160:163], v[56:59]
v_mfma_f32_16x16x32_bf16 v[56:59], a[180:183], v[164:167], v[56:59]
v_mfma_f32_16x16x32_bf16 v[24:27], a[180:183], v[156:159], v[24:27]
v_mfma_f32_16x16x32_bf16 v[24:27], a[176:179], v[152:155], v[24:27]
v_mfma_f32_16x16x32_bf16 v[28:31], a[184:187], v[152:155], v[28:31]
s_waitcnt vmcnt(25)
s_barrier
v_mfma_f32_16x16x32_bf16 v[28:31], a[188:191], v[156:159], v[28:31]
s_add_u32 m0, s86, 131072
ds_read_b64_tr_b16 a[144:145], v196 offset:32768
v_mfma_f32_16x16x32_bf16 v[60:63], a[188:191], v[164:167], v[60:63]
s_add_u32 s64, s85, 0
ds_read_b64_tr_b16 a[146:147], v196 offset:36864
v_mfma_f32_16x16x32_bf16 v[60:63], a[184:187], v[160:163], v[60:63]
buffer_load_dwordx4 v12, s[40:43], s64 offen lds
v_mfma_f32_16x16x32_bf16 v[92:95], a[184:187], v[168:171], v[92:95]
s_lshl_b32 s75, s73, 17
s_add_u32 s84, s84, s75
ds_read_b64_tr_b16 a[148:149], v196 offset:40960
v_mfma_f32_16x16x32_bf16 v[92:95], a[188:191], v[172:175], v[92:95]
s_add_u32 m0, s86, 132096
ds_read_b64_tr_b16 a[150:151], v196 offset:45056
v_mfma_f32_16x16x32_bf16 v[124:127], a[188:191], v[180:183], v[124:127]
s_add_u32 s64, s85, 8192
ds_read_b64_tr_b16 a[152:153], v197 offset:32768
v_mfma_f32_16x16x32_bf16 v[124:127], a[184:187], v[176:179], v[124:127]
buffer_load_dwordx4 v13, s[40:43], s64 offen lds
v_mfma_f32_16x16x32_bf16 v[128:131], a[192:195], v[176:179], v[128:131]
ds_read_b64_tr_b16 a[154:155], v197 offset:36864
v_mfma_f32_16x16x32_bf16 v[128:131], a[196:199], v[180:183], v[128:131]
s_add_u32 m0, s86, 133120
ds_read_b64_tr_b16 a[156:157], v197 offset:40960
v_mfma_f32_16x16x32_bf16 v[96:99], a[196:199], v[172:175], v[96:99]
s_add_u32 s64, s85, 16384
ds_read_b64_tr_b16 a[158:159], v197 offset:45056
v_mfma_f32_16x16x32_bf16 v[96:99], a[192:195], v[168:171], v[96:99]
buffer_load_dwordx4 v12, s[40:43], s64 offen lds
v_mfma_f32_16x16x32_bf16 v[64:67], a[192:195], v[160:163], v[64:67]
ds_read_b64_tr_b16 a[160:161], v198 offset:32768
v_mfma_f32_16x16x32_bf16 v[64:67], a[196:199], v[164:167], v[64:67]
s_add_u32 m0, s86, 134144
ds_read_b64_tr_b16 a[162:163], v198 offset:36864
v_mfma_f32_16x16x32_bf16 v[32:35], a[196:199], v[156:159], v[32:35]
s_add_u32 s64, s85, 24576
ds_read_b64_tr_b16 a[164:165], v198 offset:40960
v_mfma_f32_16x16x32_bf16 v[32:35], a[192:195], v[152:155], v[32:35]
s_waitcnt lgkmcnt(6)
buffer_load_dwordx4 v13, s[40:43], s64 offen lds
v_mfma_f32_16x16x32_bf16 v[36:39], a[200:203], v[152:155], v[36:39]
ds_read_b64_tr_b16 a[166:167], v198 offset:45056
v_mfma_f32_16x16x32_bf16 v[36:39], a[204:207], v[156:159], v[36:39]
s_add_u32 m0, s86, 135168
v_mfma_f32_16x16x32_bf16 v[68:71], a[204:207], v[164:167], v[68:71]
s_add_u32 s64, s85, 32768
v_mfma_f32_16x16x32_bf16 v[68:71], a[200:203], v[160:163], v[68:71]
buffer_load_dwordx4 v12, s[40:43], s64 offen lds
v_mfma_f32_16x16x32_bf16 v[100:103], a[200:203], v[168:171], v[100:103]
v_mfma_f32_16x16x32_bf16 v[100:103], a[204:207], v[172:175], v[100:103]
v_mfma_f32_16x16x32_bf16 v[132:135], a[204:207], v[180:183], v[132:135]
v_mfma_f32_16x16x32_bf16 v[132:135], a[200:203], v[176:179], v[132:135]
s_waitcnt vmcnt(26)
v_mfma_f32_16x16x32_bf16 v[136:139], a[144:147], a[24:27], v[136:139]
s_waitcnt vmcnt(16)
v_readfirstlane_b32 vcc_lo, v19
s_nop 0
s_cmp_lt_u32 vcc_lo, s74
s_cbranch_scc1 L_spin_4022
L_spinbk_4023:
v_mfma_f32_16x16x32_bf16 v[136:139], a[148:151], a[28:31], v[136:139]
s_add_u32 m0, s86, 136192
ds_read_b64_tr_b16 a[168:169], v199 offset:32768
v_mfma_f32_16x16x32_bf16 v[104:107], a[148:151], a[20:23], v[104:107]
s_add_u32 s64, s85, 40960
ds_read_b64_tr_b16 a[170:171], v199 offset:36864
v_mfma_f32_16x16x32_bf16 v[104:107], a[144:147], a[16:19], v[104:107]
buffer_load_dwordx4 v13, s[40:43], s64 offen lds
v_mfma_f32_16x16x32_bf16 v[72:75], a[144:147], a[8:11], v[72:75]
s_add_u32 m0, s86, 137216
ds_read_b64_tr_b16 a[172:173], v199 offset:40960
v_mfma_f32_16x16x32_bf16 v[72:75], a[148:151], a[12:15], v[72:75]
s_add_u32 s64, s85, 49152
ds_read_b64_tr_b16 a[174:175], v199 offset:45056
v_mfma_f32_16x16x32_bf16 v[40:43], a[148:151], a[4:7], v[40:43]
buffer_load_dwordx4 v12, s[40:43], s64 offen lds
v_mfma_f32_16x16x32_bf16 v[40:43], a[144:147], a[0:3], v[40:43]
s_waitcnt lgkmcnt(4)
s_add_u32 m0, s86, 138240
ds_read_b64_tr_b16 a[176:177], v192 offset:32768
v_mfma_f32_16x16x32_bf16 v[44:47], a[152:155], a[0:3], v[44:47]
s_add_u32 s64, s85, 57344
ds_read_b64_tr_b16 a[178:179], v192 offset:36864
v_mfma_f32_16x16x32_bf16 v[44:47], a[156:159], a[4:7], v[44:47]
buffer_load_dwordx4 v13, s[40:43], s64 offen lds
v_mfma_f32_16x16x32_bf16 v[76:79], a[156:159], a[12:15], v[76:79]
ds_read_b64_tr_b16 a[180:181], v192 offset:40960
v_mfma_f32_16x16x32_bf16 v[76:79], a[152:155], a[8:11], v[76:79]
s_add_u32 s65, s84, 0
ds_read_b64_tr_b16 a[182:183], v192 offset:45056
v_mfma_f32_16x16x32_bf16 v[108:111], a[152:155], a[16:19], v[108:111]
buffer_load_dwordx4 a[208:211], v14, s[44:47], s65 offen offset:0 sc1
v_mfma_f32_16x16x32_bf16 v[108:111], a[156:159], a[20:23], v[108:111]
ds_read_b64_tr_b16 a[184:185], v193 offset:32768
v_mfma_f32_16x16x32_bf16 v[140:143], a[156:159], a[28:31], v[140:143]
ds_read_b64_tr_b16 a[186:187], v193 offset:36864
v_mfma_f32_16x16x32_bf16 v[140:143], a[152:155], a[24:27], v[140:143]
ds_read_b64_tr_b16 a[188:189], v193 offset:40960
v_mfma_f32_16x16x32_bf16 v[144:147], a[160:163], a[24:27], v[144:147]
buffer_load_dwordx4 a[216:219], v14, s[44:47], s65 offen offset:1024 sc1
v_mfma_f32_16x16x32_bf16 v[144:147], a[164:167], a[28:31], v[144:147]
ds_read_b64_tr_b16 a[190:191], v193 offset:45056
v_mfma_f32_16x16x32_bf16 v[112:115], a[164:167], a[20:23], v[112:115]
ds_read_b64_tr_b16 a[192:193], v194 offset:32768
v_mfma_f32_16x16x32_bf16 v[112:115], a[160:163], a[16:19], v[112:115]
buffer_load_dwordx4 a[224:227], v15, s[44:47], s65 offen offset:0 sc1
v_mfma_f32_16x16x32_bf16 v[80:83], a[160:163], a[8:11], v[80:83]
ds_read_b64_tr_b16 a[194:195], v194 offset:36864
v_mfma_f32_16x16x32_bf16 v[80:83], a[164:167], a[12:15], v[80:83]
ds_read_b64_tr_b16 a[196:197], v194 offset:40960
v_mfma_f32_16x16x32_bf16 v[48:51], a[164:167], a[4:7], v[48:51]
buffer_load_dwordx4 a[232:235], v15, s[44:47], s65 offen offset:1024 sc1
v_mfma_f32_16x16x32_bf16 v[48:51], a[160:163], a[0:3], v[48:51]
s_waitcnt lgkmcnt(4)
ds_read_b64_tr_b16 a[198:199], v194 offset:45056
v_mfma_f32_16x16x32_bf16 v[52:55], a[168:171], a[0:3], v[52:55]
s_add_u32 s65, s84, 8192
v_mfma_f32_16x16x32_bf16 v[52:55], a[172:175], a[4:7], v[52:55]
buffer_load_dwordx4 a[212:215], v14, s[44:47], s65 offen offset:0 sc1
v_mfma_f32_16x16x32_bf16 v[84:87], a[172:175], a[12:15], v[84:87]
ds_read_b64_tr_b16 a[200:201], v195 offset:32768
v_mfma_f32_16x16x32_bf16 v[84:87], a[168:171], a[8:11], v[84:87]
ds_read_b64_tr_b16 a[202:203], v195 offset:36864
v_mfma_f32_16x16x32_bf16 v[116:119], a[168:171], a[16:19], v[116:119]
ds_read_b64_tr_b16 a[204:205], v195 offset:40960
v_mfma_f32_16x16x32_bf16 v[116:119], a[172:175], a[20:23], v[116:119]
buffer_load_dwordx4 a[220:223], v14, s[44:47], s65 offen offset:1024 sc1
v_mfma_f32_16x16x32_bf16 v[148:151], a[172:175], a[28:31], v[148:151]
ds_read_b64_tr_b16 a[206:207], v195 offset:45056
v_mfma_f32_16x16x32_bf16 v[148:151], a[168:171], a[24:27], v[148:151]
v_mfma_f32_16x16x32_bf16 v[120:123], a[176:179], a[24:27], v[120:123]
buffer_load_dwordx4 a[228:231], v15, s[44:47], s65 offen offset:0 sc1
v_mfma_f32_16x16x32_bf16 v[120:123], a[180:183], a[28:31], v[120:123]
v_mfma_f32_16x16x32_bf16 v[88:91], a[180:183], a[20:23], v[88:91]
v_mfma_f32_16x16x32_bf16 v[88:91], a[176:179], a[16:19], v[88:91]
buffer_load_dwordx4 a[236:239], v15, s[44:47], s65 offen offset:1024 sc1
v_mfma_f32_16x16x32_bf16 v[56:59], a[176:179], a[8:11], v[56:59]
v_mfma_f32_16x16x32_bf16 v[56:59], a[180:183], a[12:15], v[56:59]
v_mfma_f32_16x16x32_bf16 v[24:27], a[180:183], a[4:7], v[24:27]
v_mfma_f32_16x16x32_bf16 v[24:27], a[176:179], a[0:3], v[24:27]
v_mfma_f32_16x16x32_bf16 v[28:31], a[184:187], a[0:3], v[28:31]
s_waitcnt vmcnt(24)
s_barrier
s_waitcnt lgkmcnt(0)
v_mfma_f32_16x16x32_bf16 v[28:31], a[188:191], a[4:7], v[28:31]
s_add_u32 m0, s86, 32768
ds_read_b64_tr_b16 a[144:145], v188 offset:0
v_mfma_f32_16x16x32_bf16 v[60:63], a[188:191], a[12:15], v[60:63]
s_add_u32 s64, s85, 262144
ds_read_b64_tr_b16 a[146:147], v188 offset:4096
v_mfma_f32_16x16x32_bf16 v[60:63], a[184:187], a[8:11], v[60:63]
buffer_load_dwordx4 v12, s[40:43], s64 offen lds
v_mfma_f32_16x16x32_bf16 v[92:95], a[184:187], a[16:19], v[92:95]
ds_read_b64_tr_b16 a[148:149], v188 offset:8192
v_mfma_f32_16x16x32_bf16 v[92:95], a[188:191], a[20:23], v[92:95]
s_add_u32 m0, s86, 33792
ds_read_b64_tr_b16 a[150:151], v188 offset:12288
v_mfma_f32_16x16x32_bf16 v[124:127], a[188:191], a[28:31], v[124:127]
s_add_u32 s64, s85, 270336
ds_read_b64_tr_b16 a[152:153], v189 offset:0
v_mfma_f32_16x16x32_bf16 v[124:127], a[184:187], a[24:27], v[124:127]
buffer_load_dwordx4 v13, s[40:43], s64 offen lds
v_mfma_f32_16x16x32_bf16 v[128:131], a[192:195], a[24:27], v[128:131]
ds_read_b64_tr_b16 a[154:155], v189 offset:4096
v_mfma_f32_16x16x32_bf16 v[128:131], a[196:199], a[28:31], v[128:131]
s_add_u32 m0, s86, 34816
ds_read_b64_tr_b16 a[156:157], v189 offset:8192
v_mfma_f32_16x16x32_bf16 v[96:99], a[196:199], a[20:23], v[96:99]
s_add_u32 s64, s85, 278528
ds_read_b64_tr_b16 a[158:159], v189 offset:12288
v_mfma_f32_16x16x32_bf16 v[96:99], a[192:195], a[16:19], v[96:99]
buffer_load_dwordx4 v12, s[40:43], s64 offen lds
v_mfma_f32_16x16x32_bf16 v[64:67], a[192:195], a[8:11], v[64:67]
ds_read_b64_tr_b16 a[160:161], v190 offset:0
v_mfma_f32_16x16x32_bf16 v[64:67], a[196:199], a[12:15], v[64:67]
s_add_u32 m0, s86, 35840
ds_read_b64_tr_b16 a[162:163], v190 offset:4096
v_mfma_f32_16x16x32_bf16 v[32:35], a[196:199], a[4:7], v[32:35]
s_add_u32 s64, s85, 286720
ds_read_b64_tr_b16 a[164:165], v190 offset:8192
v_mfma_f32_16x16x32_bf16 v[32:35], a[192:195], a[0:3], v[32:35]
buffer_load_dwordx4 v13, s[40:43], s64 offen lds
v_mfma_f32_16x16x32_bf16 v[36:39], a[200:203], a[0:3], v[36:39]
ds_read_b64_tr_b16 a[166:167], v190 offset:12288
v_mfma_f32_16x16x32_bf16 v[36:39], a[204:207], a[4:7], v[36:39]
s_add_u32 m0, s86, 36864
v_mfma_f32_16x16x32_bf16 v[68:71], a[204:207], a[12:15], v[68:71]
s_add_u32 s64, s85, 294912
v_mfma_f32_16x16x32_bf16 v[68:71], a[200:203], a[8:11], v[68:71]
buffer_load_dwordx4 v12, s[40:43], s64 offen lds
v_mfma_f32_16x16x32_bf16 v[100:103], a[200:203], a[16:19], v[100:103]
v_mfma_f32_16x16x32_bf16 v[100:103], a[204:207], a[20:23], v[100:103]
v_mfma_f32_16x16x32_bf16 v[132:135], a[204:207], a[28:31], v[132:135]
v_mfma_f32_16x16x32_bf16 v[132:135], a[200:203], a[24:27], v[132:135]
s_waitcnt vmcnt(25)
s_waitcnt lgkmcnt(1)
s_add_u32 m0, s86, 37888
v_mfma_f32_16x16x32_bf16 v[136:139], a[144:147], a[56:59], v[136:139]
s_waitcnt vmcnt(21)
s_add_u32 s64, s85, 303104
ds_read_b64_tr_b16 a[168:169], v191 offset:0
v_mfma_f32_16x16x32_bf16 v[136:139], a[148:151], a[60:63], v[136:139]
buffer_load_dwordx4 v13, s[40:43], s64 offen lds
v_mfma_f32_16x16x32_bf16 v[104:107], a[148:151], a[52:55], v[104:107]
s_add_u32 m0, s86, 38912
ds_read_b64_tr_b16 a[170:171], v191 offset:4096
v_mfma_f32_16x16x32_bf16 v[104:107], a[144:147], a[48:51], v[104:107]
s_add_u32 s64, s85, 311296
ds_read_b64_tr_b16 a[172:173], v191 offset:8192
v_mfma_f32_16x16x32_bf16 v[72:75], a[144:147], a[40:43], v[72:75]
buffer_load_dwordx4 v12, s[40:43], s64 offen lds
v_mfma_f32_16x16x32_bf16 v[72:75], a[148:151], a[44:47], v[72:75]
s_add_u32 m0, s86, 39936
ds_read_b64_tr_b16 a[174:175], v191 offset:12288
v_mfma_f32_16x16x32_bf16 v[40:43], a[148:151], a[36:39], v[40:43]
s_add_u32 s64, s85, 319488
ds_read_b64_tr_b16 a[176:177], v184 offset:0
v_mfma_f32_16x16x32_bf16 v[40:43], a[144:147], a[32:35], v[40:43]
buffer_load_dwordx4 v13, s[40:43], s64 offen lds
v_mfma_f32_16x16x32_bf16 v[44:47], a[152:155], a[32:35], v[44:47]
ds_read_b64_tr_b16 a[178:179], v184 offset:4096
v_mfma_f32_16x16x32_bf16 v[44:47], a[156:159], a[36:39], v[44:47]
ds_read_b64_tr_b16 a[180:181], v184 offset:8192
v_mfma_f32_16x16x32_bf16 v[76:79], a[156:159], a[44:47], v[76:79]
s_add_u32 s65, s84, 32768
ds_read_b64_tr_b16 a[182:183], v184 offset:12288
v_mfma_f32_16x16x32_bf16 v[76:79], a[152:155], a[40:43], v[76:79]
buffer_load_dwordx4 v[152:155], v14, s[44:47], s65 offen offset:0 sc1
v_mfma_f32_16x16x32_bf16 v[108:111], a[152:155], a[48:51], v[108:111]
ds_read_b64_tr_b16 a[184:185], v185 offset:0
v_mfma_f32_16x16x32_bf16 v[108:111], a[156:159], a[52:55], v[108:111]
ds_read_b64_tr_b16 a[186:187], v185 offset:4096
v_mfma_f32_16x16x32_bf16 v[140:143], a[156:159], a[60:63], v[140:143]
buffer_load_dwordx4 v[160:163], v14, s[44:47], s65 offen offset:1024 sc1
v_mfma_f32_16x16x32_bf16 v[140:143], a[152:155], a[56:59], v[140:143]
ds_read_b64_tr_b16 a[188:189], v185 offset:8192
v_mfma_f32_16x16x32_bf16 v[144:147], a[160:163], a[56:59], v[144:147]
s_waitcnt lgkmcnt(5)
ds_read_b64_tr_b16 a[190:191], v185 offset:12288
v_mfma_f32_16x16x32_bf16 v[144:147], a[164:167], a[60:63], v[144:147]
v_mfma_f32_16x16x32_bf16 v[112:115], a[164:167], a[52:55], v[112:115]
buffer_load_dwordx4 v[168:171], v15, s[44:47], s65 offen offset:0 sc1
v_mfma_f32_16x16x32_bf16 v[112:115], a[160:163], a[48:51], v[112:115]
ds_read_b64_tr_b16 a[192:193], v186 offset:0
v_mfma_f32_16x16x32_bf16 v[80:83], a[160:163], a[40:43], v[80:83]
ds_read_b64_tr_b16 a[194:195], v186 offset:4096
v_mfma_f32_16x16x32_bf16 v[80:83], a[164:167], a[44:47], v[80:83]
buffer_load_dwordx4 v[176:179], v15, s[44:47], s65 offen offset:1024 sc1
v_mfma_f32_16x16x32_bf16 v[48:51], a[164:167], a[36:39], v[48:51]
ds_read_b64_tr_b16 a[196:197], v186 offset:8192
v_mfma_f32_16x16x32_bf16 v[48:51], a[160:163], a[32:35], v[48:51]
ds_read_b64_tr_b16 a[198:199], v186 offset:12288
v_mfma_f32_16x16x32_bf16 v[52:55], a[168:171], a[32:35], v[52:55]
s_add_u32 s65, s84, 40960
v_mfma_f32_16x16x32_bf16 v[52:55], a[172:175], a[36:39], v[52:55]
buffer_load_dwordx4 v[156:159], v14, s[44:47], s65 offen offset:0 sc1
v_mfma_f32_16x16x32_bf16 v[84:87], a[172:175], a[44:47], v[84:87]
ds_read_b64_tr_b16 a[200:201], v187 offset:0
v_mfma_f32_16x16x32_bf16 v[84:87], a[168:171], a[40:43], v[84:87]
ds_read_b64_tr_b16 a[202:203], v187 offset:4096
v_mfma_f32_16x16x32_bf16 v[116:119], a[168:171], a[48:51], v[116:119]
buffer_load_dwordx4 v[164:167], v14, s[44:47], s65 offen offset:1024 sc1
v_mfma_f32_16x16x32_bf16 v[116:119], a[172:175], a[52:55], v[116:119]
ds_read_b64_tr_b16 a[204:205], v187 offset:8192
v_mfma_f32_16x16x32_bf16 v[148:151], a[172:175], a[60:63], v[148:151]
ds_read_b64_tr_b16 a[206:207], v187 offset:12288
v_mfma_f32_16x16x32_bf16 v[148:151], a[168:171], a[56:59], v[148:151]
v_mfma_f32_16x16x32_bf16 v[120:123], a[176:179], a[56:59], v[120:123]
s_waitcnt lgkmcnt(4)
buffer_load_dwordx4 v[172:175], v15, s[44:47], s65 offen offset:0 sc1
v_mfma_f32_16x16x32_bf16 v[120:123], a[180:183], a[60:63], v[120:123]
v_mfma_f32_16x16x32_bf16 v[88:91], a[180:183], a[52:55], v[88:91]
v_mfma_f32_16x16x32_bf16 v[88:91], a[176:179], a[48:51], v[88:91]
buffer_load_dwordx4 v[180:183], v15, s[44:47], s65 offen offset:1024 sc1
v_mfma_f32_16x16x32_bf16 v[56:59], a[176:179], a[40:43], v[56:59]
v_mfma_f32_16x16x32_bf16 v[56:59], a[180:183], a[44:47], v[56:59]
v_mfma_f32_16x16x32_bf16 v[24:27], a[180:183], a[36:39], v[24:27]
v_mfma_f32_16x16x32_bf16 v[24:27], a[176:179], a[32:35], v[24:27]
v_mfma_f32_16x16x32_bf16 v[28:31], a[184:187], a[32:35], v[28:31]
s_waitcnt vmcnt(24)
s_barrier
v_mfma_f32_16x16x32_bf16 v[28:31], a[188:191], a[36:39], v[28:31]
s_add_u32 m0, s86, 65536
ds_read_b64_tr_b16 a[144:145], v188 offset:32768
v_mfma_f32_16x16x32_bf16 v[60:63], a[188:191], a[44:47], v[60:63]
s_add_u32 s64, s85, 524288
ds_read_b64_tr_b16 a[146:147], v188 offset:36864
v_mfma_f32_16x16x32_bf16 v[60:63], a[184:187], a[40:43], v[60:63]
buffer_load_dwordx4 v12, s[40:43], s64 offen lds
v_mfma_f32_16x16x32_bf16 v[92:95], a[184:187], a[48:51], v[92:95]
ds_read_b64_tr_b16 a[148:149], v188 offset:40960
v_mfma_f32_16x16x32_bf16 v[92:95], a[188:191], a[52:55], v[92:95]
s_add_u32 m0, s86, 66560
ds_read_b64_tr_b16 a[150:151], v188 offset:45056
v_mfma_f32_16x16x32_bf16 v[124:127], a[188:191], a[60:63], v[124:127]
s_add_u32 s64, s85, 532480
ds_read_b64_tr_b16 a[152:153], v189 offset:32768
v_mfma_f32_16x16x32_bf16 v[124:127], a[184:187], a[56:59], v[124:127]
buffer_load_dwordx4 v13, s[40:43], s64 offen lds
v_mfma_f32_16x16x32_bf16 v[128:131], a[192:195], a[56:59], v[128:131]
ds_read_b64_tr_b16 a[154:155], v189 offset:36864
v_mfma_f32_16x16x32_bf16 v[128:131], a[196:199], a[60:63], v[128:131]
s_add_u32 m0, s86, 67584
ds_read_b64_tr_b16 a[156:157], v189 offset:40960
v_mfma_f32_16x16x32_bf16 v[96:99], a[196:199], a[52:55], v[96:99]
s_add_u32 s64, s85, 540672
ds_read_b64_tr_b16 a[158:159], v189 offset:45056
v_mfma_f32_16x16x32_bf16 v[96:99], a[192:195], a[48:51], v[96:99]
buffer_load_dwordx4 v12, s[40:43], s64 offen lds
v_mfma_f32_16x16x32_bf16 v[64:67], a[192:195], a[40:43], v[64:67]
ds_read_b64_tr_b16 a[160:161], v190 offset:32768
v_mfma_f32_16x16x32_bf16 v[64:67], a[196:199], a[44:47], v[64:67]
s_add_u32 m0, s86, 68608
ds_read_b64_tr_b16 a[162:163], v190 offset:36864
v_mfma_f32_16x16x32_bf16 v[32:35], a[196:199], a[36:39], v[32:35]
s_add_u32 s64, s85, 548864
ds_read_b64_tr_b16 a[164:165], v190 offset:40960
v_mfma_f32_16x16x32_bf16 v[32:35], a[192:195], a[32:35], v[32:35]
s_waitcnt lgkmcnt(6)
buffer_load_dwordx4 v13, s[40:43], s64 offen lds
v_mfma_f32_16x16x32_bf16 v[36:39], a[200:203], a[32:35], v[36:39]
ds_read_b64_tr_b16 a[166:167], v190 offset:45056
v_mfma_f32_16x16x32_bf16 v[36:39], a[204:207], a[36:39], v[36:39]
s_add_u32 m0, s86, 69632
v_mfma_f32_16x16x32_bf16 v[68:71], a[204:207], a[44:47], v[68:71]
s_add_u32 s64, s85, 557056
v_mfma_f32_16x16x32_bf16 v[68:71], a[200:203], a[40:43], v[68:71]
buffer_load_dwordx4 v12, s[40:43], s64 offen lds
v_mfma_f32_16x16x32_bf16 v[100:103], a[200:203], a[48:51], v[100:103]
s_sub_u32 s73, 1, s73
s_sub_u32 s70, s70, 1
s_cmp_lg_u32 s70, 0
v_mfma_f32_16x16x32_bf16 v[100:103], a[204:207], a[52:55], v[100:103]
v_mfma_f32_16x16x32_bf16 v[132:135], a[204:207], a[60:63], v[132:135]
v_mfma_f32_16x16x32_bf16 v[132:135], a[200:203], a[56:59], v[132:135]
s_cbranch_scc1 L_p5loop
s_waitcnt lgkmcnt(10)
s_waitcnt vmcnt(25)
v_mfma_f32_16x16x32_bf16 v[136:139], a[144:147], a[232:235], v[136:139]
s_waitcnt vmcnt(21)
s_waitcnt lgkmcnt(8)
s_add_u32 m0, s86, 70656
s_add_u32 s64, s85, 565248
ds_read_b64_tr_b16 a[168:169], v191 offset:32768
v_mfma_f32_16x16x32_bf16 v[136:139], a[148:151], a[236:239], v[136:139]
buffer_load_dwordx4 v13, s[40:43], s64 offen lds
v_mfma_f32_16x16x32_bf16 v[104:107], a[148:151], a[228:231], v[104:107]
s_add_u32 m0, s86, 71680
ds_read_b64_tr_b16 a[170:171], v191 offset:36864
v_mfma_f32_16x16x32_bf16 v[104:107], a[144:147], a[224:227], v[104:107]
s_add_u32 s64, s85, 573440
ds_read_b64_tr_b16 a[172:173], v191 offset:40960
v_mfma_f32_16x16x32_bf16 v[72:75], a[144:147], a[216:219], v[72:75]
buffer_load_dwordx4 v12, s[40:43], s64 offen lds
v_mfma_f32_16x16x32_bf16 v[72:75], a[148:151], a[220:223], v[72:75]
s_add_u32 m0, s86, 72704
ds_read_b64_tr_b16 a[174:175], v191 offset:45056
v_mfma_f32_16x16x32_bf16 v[40:43], a[148:151], a[212:215], v[40:43]
s_add_u32 s64, s85, 581632
ds_read_b64_tr_b16 a[176:177], v184 offset:32768
v_mfma_f32_16x16x32_bf16 v[40:43], a[144:147], a[208:211], v[40:43]
s_waitcnt lgkmcnt(5)
buffer_load_dwordx4 v13, s[40:43], s64 offen lds
v_mfma_f32_16x16x32_bf16 v[44:47], a[152:155], a[208:211], v[44:47]
ds_read_b64_tr_b16 a[178:179], v184 offset:36864
v_mfma_f32_16x16x32_bf16 v[44:47], a[156:159], a[212:215], v[44:47]
ds_read_b64_tr_b16 a[180:181], v184 offset:40960
v_mfma_f32_16x16x32_bf16 v[76:79], a[156:159], a[220:223], v[76:79]
s_add_u32 s65, s84, 65536
ds_read_b64_tr_b16 a[182:183], v184 offset:45056
v_mfma_f32_16x16x32_bf16 v[76:79], a[152:155], a[216:219], v[76:79]
buffer_load_dwordx4 a[0:3], v14, s[44:47], s65 offen offset:0 sc1
v_mfma_f32_16x16x32_bf16 v[108:111], a[152:155], a[224:227], v[108:111]
ds_read_b64_tr_b16 a[184:185], v185 offset:32768
v_mfma_f32_16x16x32_bf16 v[108:111], a[156:159], a[228:231], v[108:111]
ds_read_b64_tr_b16 a[186:187], v185 offset:36864
v_mfma_f32_16x16x32_bf16 v[140:143], a[156:159], a[236:239], v[140:143]
buffer_load_dwordx4 a[8:11], v14, s[44:47], s65 offen offset:1024 sc1
v_mfma_f32_16x16x32_bf16 v[140:143], a[152:155], a[232:235], v[140:143]
ds_read_b64_tr_b16 a[188:189], v185 offset:40960
v_mfma_f32_16x16x32_bf16 v[144:147], a[160:163], a[232:235], v[144:147]
ds_read_b64_tr_b16 a[190:191], v185 offset:45056
v_mfma_f32_16x16x32_bf16 v[144:147], a[164:167], a[236:239], v[144:147]
v_mfma_f32_16x16x32_bf16 v[112:115], a[164:167], a[228:231], v[112:115]
buffer_load_dwordx4 a[16:19], v15, s[44:47], s65 offen offset:0 sc1
v_mfma_f32_16x16x32_bf16 v[112:115], a[160:163], a[224:227], v[112:115]
ds_read_b64_tr_b16 a[192:193], v186 offset:32768
v_mfma_f32_16x16x32_bf16 v[80:83], a[160:163], a[216:219], v[80:83]
ds_read_b64_tr_b16 a[194:195], v186 offset:36864
v_mfma_f32_16x16x32_bf16 v[80:83], a[164:167], a[220:223], v[80:83]
buffer_load_dwordx4 a[24:27], v15, s[44:47], s65 offen offset:1024 sc1
v_mfma_f32_16x16x32_bf16 v[48:51], a[164:167], a[212:215], v[48:51]
ds_read_b64_tr_b16 a[196:197], v186 offset:40960
v_mfma_f32_16x16x32_bf16 v[48:51], a[160:163], a[208:211], v[48:51]
s_waitcnt lgkmcnt(4)
ds_read_b64_tr_b16 a[198:199], v186 offset:45056
v_mfma_f32_16x16x32_bf16 v[52:55], a[168:171], a[208:211], v[52:55]
s_add_u32 s65, s84, 73728
v_mfma_f32_16x16x32_bf16 v[52:55], a[172:175], a[212:215], v[52:55]
buffer_load_dwordx4 a[4:7], v14, s[44:47], s65 offen offset:0 sc1
v_mfma_f32_16x16x32_bf16 v[84:87], a[172:175], a[220:223], v[84:87]
ds_read_b64_tr_b16 a[200:201], v187 offset:32768
v_mfma_f32_16x16x32_bf16 v[84:87], a[168:171], a[216:219], v[84:87]
ds_read_b64_tr_b16 a[202:203], v187 offset:36864
v_mfma_f32_16x16x32_bf16 v[116:119], a[168:171], a[224:227], v[116:119]
buffer_load_dwordx4 a[12:15], v14, s[44:47], s65 offen offset:1024 sc1
v_mfma_f32_16x16x32_bf16 v[116:119], a[172:175], a[228:231], v[116:119]
ds_read_b64_tr_b16 a[204:205], v187 offset:40960
v_mfma_f32_16x16x32_bf16 v[148:151], a[172:175], a[236:239], v[148:151]
ds_read_b64_tr_b16 a[206:207], v187 offset:45056
v_mfma_f32_16x16x32_bf16 v[148:151], a[168:171], a[232:235], v[148:151]
v_mfma_f32_16x16x32_bf16 v[120:123], a[176:179], a[232:235], v[120:123]
buffer_load_dwordx4 a[20:23], v15, s[44:47], s65 offen offset:0 sc1
v_mfma_f32_16x16x32_bf16 v[120:123], a[180:183], a[236:239], v[120:123]
v_mfma_f32_16x16x32_bf16 v[88:91], a[180:183], a[228:231], v[88:91]
v_mfma_f32_16x16x32_bf16 v[88:91], a[176:179], a[224:227], v[88:91]
buffer_load_dwordx4 a[28:31], v15, s[44:47], s65 offen offset:1024 sc1
v_mfma_f32_16x16x32_bf16 v[56:59], a[176:179], a[216:219], v[56:59]
v_mfma_f32_16x16x32_bf16 v[56:59], a[180:183], a[220:223], v[56:59]
v_mfma_f32_16x16x32_bf16 v[24:27], a[180:183], a[212:215], v[24:27]
v_mfma_f32_16x16x32_bf16 v[24:27], a[176:179], a[208:211], v[24:27]
v_mfma_f32_16x16x32_bf16 v[28:31], a[184:187], a[208:211], v[28:31]
s_waitcnt vmcnt(24)
s_barrier
s_waitcnt lgkmcnt(0)
v_mfma_f32_16x16x32_bf16 v[28:31], a[188:191], a[212:215], v[28:31]
s_add_u32 m0, s86, 98304
ds_read_b64_tr_b16 a[144:145], v196 offset:0
v_mfma_f32_16x16x32_bf16 v[60:63], a[188:191], a[220:223], v[60:63]
s_add_u32 s64, s85, 786432
ds_read_b64_tr_b16 a[146:147], v196 offset:4096
v_mfma_f32_16x16x32_bf16 v[60:63], a[184:187], a[216:219], v[60:63]
buffer_load_dwordx4 v12, s[40:43], s64 offen lds
v_mfma_f32_16x16x32_bf16 v[92:95], a[184:187], a[224:227], v[92:95]
ds_read_b64_tr_b16 a[148:149], v196 offset:8192
v_mfma_f32_16x16x32_bf16 v[92:95], a[188:191], a[228:231], v[92:95]
s_add_u32 m0, s86, 99328
ds_read_b64_tr_b16 a[150:151], v196 offset:12288
v_mfma_f32_16x16x32_bf16 v[124:127], a[188:191], a[236:239], v[124:127]
s_add_u32 s64, s85, 794624
ds_read_b64_tr_b16 a[152:153], v197 offset:0
v_mfma_f32_16x16x32_bf16 v[124:127], a[184:187], a[232:235], v[124:127]
buffer_load_dwordx4 v13, s[40:43], s64 offen lds
v_mfma_f32_16x16x32_bf16 v[128:131], a[192:195], a[232:235], v[128:131]
ds_read_b64_tr_b16 a[154:155], v197 offset:4096
v_mfma_f32_16x16x32_bf16 v[128:131], a[196:199], a[236:239], v[128:131]
s_add_u32 m0, s86, 100352
ds_read_b64_tr_b16 a[156:157], v197 offset:8192
v_mfma_f32_16x16x32_bf16 v[96:99], a[196:199], a[228:231], v[96:99]
s_add_u32 s64, s85, 802816
ds_read_b64_tr_b16 a[158:159], v197 offset:12288
v_mfma_f32_16x16x32_bf16 v[96:99], a[192:195], a[224:227], v[96:99]
buffer_load_dwordx4 v12, s[40:43], s64 offen lds
v_mfma_f32_16x16x32_bf16 v[64:67], a[192:195], a[216:219], v[64:67]
ds_read_b64_tr_b16 a[160:161], v198 offset:0
v_mfma_f32_16x16x32_bf16 v[64:67], a[196:199], a[220:223], v[64:67]
s_add_u32 m0, s86, 101376
ds_read_b64_tr_b16 a[162:163], v198 offset:4096
v_mfma_f32_16x16x32_bf16 v[32:35], a[196:199], a[212:215], v[32:35]
s_add_u32 s64, s85, 811008
ds_read_b64_tr_b16 a[164:165], v198 offset:8192
v_mfma_f32_16x16x32_bf16 v[32:35], a[192:195], a[208:211], v[32:35]
buffer_load_dwordx4 v13, s[40:43], s64 offen lds
v_mfma_f32_16x16x32_bf16 v[36:39], a[200:203], a[208:211], v[36:39]
ds_read_b64_tr_b16 a[166:167], v198 offset:12288
v_mfma_f32_16x16x32_bf16 v[36:39], a[204:207], a[212:215], v[36:39]
s_add_u32 m0, s86, 102400
v_mfma_f32_16x16x32_bf16 v[68:71], a[204:207], a[220:223], v[68:71]
s_add_u32 s64, s85, 819200
v_mfma_f32_16x16x32_bf16 v[68:71], a[200:203], a[216:219], v[68:71]
buffer_load_dwordx4 v12, s[40:43], s64 offen lds
v_mfma_f32_16x16x32_bf16 v[100:103], a[200:203], a[224:227], v[100:103]
v_mfma_f32_16x16x32_bf16 v[100:103], a[204:207], a[228:231], v[100:103]
v_mfma_f32_16x16x32_bf16 v[132:135], a[204:207], a[236:239], v[132:135]
v_mfma_f32_16x16x32_bf16 v[132:135], a[200:203], a[232:235], v[132:135]
s_waitcnt vmcnt(25)
s_waitcnt lgkmcnt(1)
s_add_u32 m0, s86, 103424
v_mfma_f32_16x16x32_bf16 v[136:139], a[144:147], v[176:179], v[136:139]
s_waitcnt vmcnt(21)
s_add_u32 s64, s85, 827392
ds_read_b64_tr_b16 a[168:169], v199 offset:0
v_mfma_f32_16x16x32_bf16 v[136:139], a[148:151], v[180:183], v[136:139]
buffer_load_dwordx4 v13, s[40:43], s64 offen lds
v_mfma_f32_16x16x32_bf16 v[104:107], a[148:151], v[172:175], v[104:107]
s_add_u32 m0, s86, 104448
ds_read_b64_tr_b16 a[170:171], v199 offset:4096
v_mfma_f32_16x16x32_bf16 v[104:107], a[144:147], v[168:171], v[104:107]
s_add_u32 s64, s85, 835584
ds_read_b64_tr_b16 a[172:173], v199 offset:8192
v_mfma_f32_16x16x32_bf16 v[72:75], a[144:147], v[160:163], v[72:75]
buffer_load_dwordx4 v12, s[40:43], s64 offen lds
v_mfma_f32_16x16x32_bf16 v[72:75], a[148:151], v[164:167], v[72:75]
s_add_u32 m0, s86, 105472
ds_read_b64_tr_b16 a[174:175], v199 offset:12288
v_mfma_f32_16x16x32_bf16 v[40:43], a[148:151], v[156:159], v[40:43]
s_add_u32 s64, s85, 843776
ds_read_b64_tr_b16 a[176:177], v192 offset:0
v_mfma_f32_16x16x32_bf16 v[40:43], a[144:147], v[152:155], v[40:43]
buffer_load_dwordx4 v13, s[40:43], s64 offen lds
v_mfma_f32_16x16x32_bf16 v[44:47], a[152:155], v[152:155], v[44:47]
ds_read_b64_tr_b16 a[178:179], v192 offset:4096
v_mfma_f32_16x16x32_bf16 v[44:47], a[156:159], v[156:159], v[44:47]
ds_read_b64_tr_b16 a[180:181], v192 offset:8192
v_mfma_f32_16x16x32_bf16 v[76:79], a[156:159], v[164:167], v[76:79]
s_add_u32 s65, s84, 98304
ds_read_b64_tr_b16 a[182:183], v192 offset:12288
v_mfma_f32_16x16x32_bf16 v[76:79], a[152:155], v[160:163], v[76:79]
buffer_load_dwordx4 a[32:35], v14, s[44:47], s65 offen offset:0 sc1
v_mfma_f32_16x16x32_bf16 v[108:111], a[152:155], v[168:171], v[108:111]
ds_read_b64_tr_b16 a[184:185], v193 offset:0
v_mfma_f32_16x16x32_bf16 v[108:111], a[156:159], v[172:175], v[108:111]
ds_read_b64_tr_b16 a[186:187], v193 offset:4096
v_mfma_f32_16x16x32_bf16 v[140:143], a[156:159], v[180:183], v[140:143]
buffer_load_dwordx4 a[40:43], v14, s[44:47], s65 offen offset:1024 sc1
v_mfma_f32_16x16x32_bf16 v[140:143], a[152:155], v[176:179], v[140:143]
ds_read_b64_tr_b16 a[188:189], v193 offset:8192
v_mfma_f32_16x16x32_bf16 v[144:147], a[160:163], v[176:179], v[144:147]
s_waitcnt lgkmcnt(5)
ds_read_b64_tr_b16 a[190:191], v193 offset:12288
v_mfma_f32_16x16x32_bf16 v[144:147], a[164:167], v[180:183], v[144:147]
v_mfma_f32_16x16x32_bf16 v[112:115], a[164:167], v[172:175], v[112:115]
buffer_load_dwordx4 a[48:51], v15, s[44:47], s65 offen offset:0 sc1
v_mfma_f32_16x16x32_bf16 v[112:115], a[160:163], v[168:171], v[112:115]
ds_read_b64_tr_b16 a[192:193], v194 offset:0
v_mfma_f32_16x16x32_bf16 v[80:83], a[160:163], v[160:163], v[80:83]
ds_read_b64_tr_b16 a[194:195], v194 offset:4096
v_mfma_f32_16x16x32_bf16 v[80:83], a[164:167], v[164:167], v[80:83]
buffer_load_dwordx4 a[56:59], v15, s[44:47], s65 offen offset:1024 sc1
v_mfma_f32_16x16x32_bf16 v[48:51], a[164:167], v[156:159], v[48:51]
ds_read_b64_tr_b16 a[196:197], v194 offset:8192
v_mfma_f32_16x16x32_bf16 v[48:51], a[160:163], v[152:155], v[48:51]
ds_read_b64_tr_b16 a[198:199], v194 offset:12288
v_mfma_f32_16x16x32_bf16 v[52:55], a[168:171], v[152:155], v[52:55]
s_add_u32 s65, s84, 106496
v_mfma_f32_16x16x32_bf16 v[52:55], a[172:175], v[156:159], v[52:55]
buffer_load_dwordx4 a[36:39], v14, s[44:47], s65 offen offset:0 sc1
v_mfma_f32_16x16x32_bf16 v[84:87], a[172:175], v[164:167], v[84:87]
ds_read_b64_tr_b16 a[200:201], v195 offset:0
v_mfma_f32_16x16x32_bf16 v[84:87], a[168:171], v[160:163], v[84:87]
ds_read_b64_tr_b16 a[202:203], v195 offset:4096
v_mfma_f32_16x16x32_bf16 v[116:119], a[168:171], v[168:171], v[116:119]
buffer_load_dwordx4 a[44:47], v14, s[44:47], s65 offen offset:1024 sc1
v_mfma_f32_16x16x32_bf16 v[116:119], a[172:175], v[172:175], v[116:119]
ds_read_b64_tr_b16 a[204:205], v195 offset:8192
v_mfma_f32_16x16x32_bf16 v[148:151], a[172:175], v[180:183], v[148:151]
ds_read_b64_tr_b16 a[206:207], v195 offset:12288
v_mfma_f32_16x16x32_bf16 v[148:151], a[168:171], v[176:179], v[148:151]
v_mfma_f32_16x16x32_bf16 v[120:123], a[176:179], v[176:179], v[120:123]
s_waitcnt lgkmcnt(4)
buffer_load_dwordx4 a[52:55], v15, s[44:47], s65 offen offset:0 sc1
v_mfma_f32_16x16x32_bf16 v[120:123], a[180:183], v[180:183], v[120:123]
v_mfma_f32_16x16x32_bf16 v[88:91], a[180:183], v[172:175], v[88:91]
v_mfma_f32_16x16x32_bf16 v[88:91], a[176:179], v[168:171], v[88:91]
buffer_load_dwordx4 a[60:63], v15, s[44:47], s65 offen offset:1024 sc1
v_mfma_f32_16x16x32_bf16 v[56:59], a[176:179], v[160:163], v[56:59]
v_mfma_f32_16x16x32_bf16 v[56:59], a[180:183], v[164:167], v[56:59]
v_mfma_f32_16x16x32_bf16 v[24:27], a[180:183], v[156:159], v[24:27]
v_mfma_f32_16x16x32_bf16 v[24:27], a[176:179], v[152:155], v[24:27]
v_mfma_f32_16x16x32_bf16 v[28:31], a[184:187], v[152:155], v[28:31]
s_waitcnt vmcnt(24)
s_barrier
v_mfma_f32_16x16x32_bf16 v[28:31], a[188:191], v[156:159], v[28:31]
ds_read_b64_tr_b16 a[144:145], v196 offset:32768
v_mfma_f32_16x16x32_bf16 v[60:63], a[188:191], v[164:167], v[60:63]
ds_read_b64_tr_b16 a[146:147], v196 offset:36864
v_mfma_f32_16x16x32_bf16 v[60:63], a[184:187], v[160:163], v[60:63]
ds_read_b64_tr_b16 a[148:149], v196 offset:40960
v_mfma_f32_16x16x32_bf16 v[92:95], a[184:187], v[168:171], v[92:95]
s_xor_b32 s66, s2, 1
s_lshl2_add_u32 s66, s66, s30
ds_read_b64_tr_b16 a[150:151], v196 offset:45056
v_mfma_f32_16x16x32_bf16 v[92:95], a[188:191], v[172:175], v[92:95]
s_lshl_b32 s73, s66, 12
s_add_u32 s73, s73, 67108864
ds_read_b64_tr_b16 a[152:153], v197 offset:32768
v_mfma_f32_16x16x32_bf16 v[124:127], a[188:191], v[180:183], v[124:127]
s_lshl2_add_u32 s66, s2, s30
s_lshl_b32 s75, s66, 12
ds_read_b64_tr_b16 a[154:155], v197 offset:36864
v_mfma_f32_16x16x32_bf16 v[124:127], a[184:187], v[176:179], v[124:127]
s_add_u32 s75, s75, 67108864
s_lshl_b32 s77, s82, 18
ds_read_b64_tr_b16 a[156:157], v197 offset:40960
v_mfma_f32_16x16x32_bf16 v[128:131], a[192:195], v[176:179], v[128:131]
s_lshl_b32 s66, s30, 16
s_add_u32 s77, s77, s66
ds_read_b64_tr_b16 a[158:159], v197 offset:45056
v_mfma_f32_16x16x32_bf16 v[128:131], a[196:199], v[180:183], v[128:131]
s_add_u32 s77, s77, s87
s_lshl_b32 s66, s83, 7
ds_read_b64_tr_b16 a[160:161], v198 offset:32768
v_mfma_f32_16x16x32_bf16 v[96:99], a[196:199], v[172:175], v[96:99]
s_add_u32 s77, s77, s66
ds_read_b64_tr_b16 a[162:163], v198 offset:36864
v_lshlrev_b32 v1, 24, v0
v_mfma_f32_16x16x32_bf16 v[96:99], a[192:195], v[168:171], v[96:99]
ds_read_b64_tr_b16 a[164:165], v198 offset:40960
v_and_b32 v8, 7, v0
v_mfma_f32_16x16x32_bf16 v[64:67], a[192:195], v[160:163], v[64:67]
ds_read_b64_tr_b16 a[166:167], v198 offset:45056
v_lshlrev_b32 v8, 11, v8
v_mfma_f32_16x16x32_bf16 v[64:67], a[196:199], v[164:167], v[64:67]
v_bfe_u32 v10, v0, 3, 1
v_lshl_add_u32 v8, v10, 6, v8
v_mfma_f32_16x16x32_bf16 v[32:35], a[196:199], v[156:159], v[32:35]
v_bfe_u32 v10, v0, 4, 1
v_lshl_add_u32 v8, v10, 5, v8
v_mfma_f32_16x16x32_bf16 v[32:35], a[192:195], v[152:155], v[32:35]
s_waitcnt lgkmcnt(5)
v_lshrrev_b32 v10, 5, v0
v_lshl_add_u32 v8, v10, 4, v8
v_mfma_f32_16x16x32_bf16 v[36:39], a[200:203], v[152:155], v[36:39]
v_add_u32 v2, s86, v16
v_xor_b32 v3, 0x2000, v2
v_mfma_f32_16x16x32_bf16 v[36:39], a[204:207], v[156:159], v[36:39]
v_mov_b32 v232, 0
v_mov_b32 v233, 0
v_mfma_f32_16x16x32_bf16 v[68:71], a[204:207], v[164:167], v[68:71]
v_mov_b32 v236, 0
v_mov_b32 v237, 0
v_mfma_f32_16x16x32_bf16 v[68:71], a[200:203], v[160:163], v[68:71]
v_and_b32 v9, 1, v0
v_lshlrev_b32 v9, 4, v9
v_mfma_f32_16x16x32_bf16 v[100:103], a[200:203], v[168:171], v[100:103]
v_mov_b32 v10, 0x3f80
v_lshlrev_b32 v9, v9, v10
v_mfma_f32_16x16x32_bf16 v[100:103], a[204:207], v[172:175], v[100:103]
v_lshrrev_b32 v10, 4, v0
v_lshlrev_b32 v10, 1, v10
v_mfma_f32_16x16x32_bf16 v[132:135], a[204:207], v[180:183], v[132:135]
v_bfe_u32 v11, v0, 1, 3
v_xor_b32 v10, v10, v11
v_mfma_f32_16x16x32_bf16 v[132:135], a[200:203], v[176:179], v[132:135]
s_waitcnt vmcnt(20)
v_subrev_u32 v11, 1, v10
v_ashrrev_i32 v11, 31, v11
v_mfma_f32_16x16x32_bf16 v[136:139], a[144:147], a[24:27], v[136:139]
s_waitcnt vmcnt(16)
ds_read_b64_tr_b16 a[168:169], v199 offset:32768
v_and_b32 v234, v11, v9
v_mfma_f32_16x16x32_bf16 v[136:139], a[148:151], a[28:31], v[136:139]
ds_read_b64_tr_b16 a[170:171], v199 offset:36864
v_xor_b32 v10, 1, v10
v_mfma_f32_16x16x32_bf16 v[104:107], a[148:151], a[20:23], v[104:107]
ds_read_b64_tr_b16 a[172:173], v199 offset:40960
v_subrev_u32 v11, 1, v10
v_mfma_f32_16x16x32_bf16 v[104:107], a[144:147], a[16:19], v[104:107]
ds_read_b64_tr_b16 a[174:175], v199 offset:45056
v_ashrrev_i32 v11, 31, v11
v_mfma_f32_16x16x32_bf16 v[72:75], a[144:147], a[8:11], v[72:75]
v_and_b32 v235, v11, v9
v_mfma_f32_16x16x32_bf16 v[72:75], a[148:151], a[12:15], v[72:75]
s_mov_b32 s48, s24
s_mov_b32 s49, s25
s_mov_b32 s50, 4194304
v_mfma_f32_16x16x32_bf16 v[40:43], a[148:151], a[4:7], v[40:43]
s_mov_b32 s51, 0x20000
s_waitcnt vmcnt(8)
s_barrier
v_mfma_f32_16x16x32_bf16 v[40:43], a[144:147], a[0:3], v[40:43]
ds_read_b64_tr_b16 a[176:177], v188 offset:0
v_mfma_f32_16x16x32_bf16 v[44:47], a[152:155], a[0:3], v[44:47]
s_waitcnt lgkmcnt(4)
ds_read_b64_tr_b16 a[178:179], v188 offset:4096
v_mfma_f32_16x16x32_bf16 v[44:47], a[156:159], a[4:7], v[44:47]
ds_read_b64_tr_b16 a[180:181], v188 offset:8192
v_mfma_f32_16x16x32_bf16 v[76:79], a[156:159], a[12:15], v[76:79]
ds_read_b64_tr_b16 a[182:183], v188 offset:12288
v_mfma_f32_16x16x32_bf16 v[76:79], a[152:155], a[8:11], v[76:79]
ds_read_b64_tr_b16 a[184:185], v189 offset:0
v_mfma_f32_16x16x32_bf16 v[108:111], a[152:155], a[16:19], v[108:111]
ds_read_b64_tr_b16 a[186:187], v189 offset:4096
v_mfma_f32_16x16x32_bf16 v[108:111], a[156:159], a[20:23], v[108:111]
ds_read_b64_tr_b16 a[188:189], v189 offset:8192
v_mfma_f32_16x16x32_bf16 v[140:143], a[156:159], a[28:31], v[140:143]
ds_read_b64_tr_b16 a[190:191], v189 offset:12288
v_mfma_f32_16x16x32_bf16 v[140:143], a[152:155], a[24:27], v[140:143]
v_mfma_f32_16x16x32_bf16 v[144:147], a[160:163], a[24:27], v[144:147]
v_mfma_f32_16x16x32_bf16 v[144:147], a[164:167], a[28:31], v[144:147]
v_mfma_f32_16x16x32_bf16 v[112:115], a[164:167], a[20:23], v[112:115]
ds_read_b64_tr_b16 a[192:193], v190 offset:0
v_mfma_f32_16x16x32_bf16 v[112:115], a[160:163], a[16:19], v[112:115]
ds_read_b64_tr_b16 a[194:195], v190 offset:4096
v_mfma_f32_16x16x32_bf16 v[80:83], a[160:163], a[8:11], v[80:83]
ds_read_b64_tr_b16 a[196:197], v190 offset:8192
v_mfma_f32_16x16x32_bf16 v[80:83], a[164:167], a[12:15], v[80:83]
ds_read_b64_tr_b16 a[198:199], v190 offset:12288
v_mfma_f32_16x16x32_bf16 v[48:51], a[164:167], a[4:7], v[48:51]
v_mfma_f32_16x16x32_bf16 v[48:51], a[160:163], a[0:3], v[48:51]
s_waitcnt lgkmcnt(4)
v_mfma_f32_16x16x32_bf16 v[52:55], a[168:171], a[0:3], v[52:55]
v_mfma_f32_16x16x32_bf16 v[52:55], a[172:175], a[4:7], v[52:55]
v_mfma_f32_16x16x32_bf16 v[84:87], a[172:175], a[12:15], v[84:87]
ds_read_b64_tr_b16 a[200:201], v191 offset:0
v_mfma_f32_16x16x32_bf16 v[84:87], a[168:171], a[8:11], v[84:87]
ds_read_b64_tr_b16 a[202:203], v191 offset:4096
v_mfma_f32_16x16x32_bf16 v[116:119], a[168:171], a[16:19], v[116:119]
ds_read_b64_tr_b16 a[204:205], v191 offset:8192
v_mfma_f32_16x16x32_bf16 v[116:119], a[172:175], a[20:23], v[116:119]
ds_read_b64_tr_b16 a[206:207], v191 offset:12288
v_mfma_f32_16x16x32_bf16 v[148:151], a[172:175], a[28:31], v[148:151]
v_mfma_f32_16x16x32_bf16 v[148:151], a[168:171], a[24:27], v[148:151]
s_waitcnt vmcnt(4)
v_mfma_f32_16x16x32_bf16 v[136:139], a[176:179], a[56:59], v[136:139]
s_waitcnt vmcnt(0)
v_mfma_f32_16x16x32_bf16 v[136:139], a[180:183], a[60:63], v[136:139]
v_mfma_f32_16x16x32_bf16 v[104:107], a[180:183], a[52:55], v[104:107]
ds_read_b64_tr_b16 a[144:145], v192 offset:32768
v_mfma_f32_16x16x32_bf16 v[104:107], a[176:179], a[48:51], v[104:107]
ds_read_b64_tr_b16 a[146:147], v192 offset:36864
v_mfma_f32_16x16x32_bf16 v[72:75], a[176:179], a[40:43], v[72:75]
ds_read_b64_tr_b16 a[148:149], v192 offset:40960
v_mfma_f32_16x16x32_bf16 v[72:75], a[180:183], a[44:47], v[72:75]
ds_read_b64_tr_b16 a[150:151], v192 offset:45056
v_mfma_f32_16x16x32_bf16 v[40:43], a[180:183], a[36:39], v[40:43]
v_mfma_f32_16x16x32_bf16 v[40:43], a[176:179], a[32:35], v[40:43]
v_mfma_f32_16x16x32_bf16 v[44:47], a[184:187], a[32:35], v[44:47]
ds_write_b128 v3, v[136:139] offset:4096
v_mfma_f32_16x16x32_bf16 v[44:47], a[188:191], a[36:39], v[44:47]
v_mfma_f32_16x16x32_bf16 v[76:79], a[188:191], a[44:47], v[76:79]
ds_write_b128 v3, v[104:107] offset:0
v_mfma_f32_16x16x32_bf16 v[76:79], a[184:187], a[40:43], v[76:79]
ds_read_b64_tr_b16 a[152:153], v193 offset:32768
v_mfma_f32_16x16x32_bf16 v[108:111], a[184:187], a[48:51], v[108:111]
ds_read_b64_tr_b16 a[154:155], v193 offset:36864
v_mfma_f32_16x16x32_bf16 v[108:111], a[188:191], a[52:55], v[108:111]
ds_read_b64_tr_b16 a[156:157], v193 offset:40960
v_mfma_f32_16x16x32_bf16 v[140:143], a[188:191], a[60:63], v[140:143]
ds_read_b64_tr_b16 a[158:159], v193 offset:45056
v_mfma_f32_16x16x32_bf16 v[140:143], a[184:187], a[56:59], v[140:143]
s_waitcnt lgkmcnt(6)
v_mfma_f32_16x16x32_bf16 v[144:147], a[192:195], a[56:59], v[144:147]
v_mfma_f32_16x16x32_bf16 v[144:147], a[196:199], a[60:63], v[144:147]
v_mfma_f32_16x16x32_bf16 v[112:115], a[196:199], a[52:55], v[112:115]
ds_read_b64_tr_b16 a[160:161], v194 offset:32768
v_mfma_f32_16x16x32_bf16 v[112:115], a[192:195], a[48:51], v[112:115]
ds_read_b64_tr_b16 a[162:163], v194 offset:36864
v_mfma_f32_16x16x32_bf16 v[80:83], a[192:195], a[40:43], v[80:83]
ds_write_b128 v3, v[108:111] offset:1024
v_mfma_f32_16x16x32_bf16 v[80:83], a[196:199], a[44:47], v[80:83]
ds_read_b64_tr_b16 a[164:165], v194 offset:40960
v_mfma_f32_16x16x32_bf16 v[48:51], a[196:199], a[36:39], v[48:51]
ds_write_b128 v3, v[140:143] offset:5120
v_mfma_f32_16x16x32_bf16 v[48:51], a[192:195], a[32:35], v[48:51]
ds_read_b64_tr_b16 a[166:167], v194 offset:45056
v_mfma_f32_16x16x32_bf16 v[52:55], a[200:203], a[32:35], v[52:55]
ds_write_b128 v3, v[144:147] offset:6144
v_mfma_f32_16x16x32_bf16 v[52:55], a[204:207], a[36:39], v[52:55]
v_mfma_f32_16x16x32_bf16 v[84:87], a[204:207], a[44:47], v[84:87]
ds_write_b128 v3, v[112:115] offset:2048
v_mfma_f32_16x16x32_bf16 v[84:87], a[200:203], a[40:43], v[84:87]
ds_read_b64_tr_b16 a[168:169], v195 offset:32768
v_mfma_f32_16x16x32_bf16 v[116:119], a[200:203], a[48:51], v[116:119]
ds_read_b64_tr_b16 a[170:171], v195 offset:36864
v_mfma_f32_16x16x32_bf16 v[116:119], a[204:207], a[52:55], v[116:119]
ds_read_b64_tr_b16 a[172:173], v195 offset:40960
v_mfma_f32_16x16x32_bf16 v[148:151], a[204:207], a[60:63], v[148:151]
ds_read_b64_tr_b16 a[174:175], v195 offset:45056
v_mfma_f32_16x16x32_bf16 v[148:151], a[200:203], a[56:59], v[148:151]
v_mfma_f32_16x16x32_bf16 v[120:123], a[144:147], a[24:27], v[120:123]
v_mfma_f32_16x16x32_bf16 v[120:123], a[148:151], a[28:31], v[120:123]
v_mfma_f32_16x16x32_bf16 v[88:91], a[148:151], a[20:23], v[88:91]
ds_read_b64_tr_b16 a[176:177], v184 offset:0
v_mfma_f32_16x16x32_bf16 v[88:91], a[144:147], a[16:19], v[88:91]
ds_read_b64_tr_b16 a[178:179], v184 offset:4096
v_mfma_f32_16x16x32_bf16 v[56:59], a[144:147], a[8:11], v[56:59]
ds_write_b128 v3, v[116:119] offset:3072
v_mfma_f32_16x16x32_bf16 v[56:59], a[148:151], a[12:15], v[56:59]
ds_read_b64_tr_b16 a[180:181], v184 offset:8192
v_mfma_f32_16x16x32_bf16 v[24:27], a[148:151], a[4:7], v[24:27]
ds_write_b128 v3, v[148:151] offset:7168
v_mfma_f32_16x16x32_bf16 v[24:27], a[144:147], a[0:3], v[24:27]
s_waitcnt lgkmcnt(5)
ds_read_b64_tr_b16 a[182:183], v184 offset:12288
v_mfma_f32_16x16x32_bf16 v[28:31], a[152:155], a[0:3], v[28:31]
v_mfma_f32_16x16x32_bf16 v[28:31], a[156:159], a[4:7], v[28:31]
s_waitcnt lgkmcnt(0)
s_barrier
v_mfma_f32_16x16x32_bf16 v[60:63], a[156:159], a[12:15], v[60:63]
ds_read_b128 v[200:203], v2 offset:0
ds_read_b128 v[204:207], v2 offset:1024
v_mfma_f32_16x16x32_bf16 v[60:63], a[152:155], a[8:11], v[60:63]
ds_read_b128 v[208:211], v2 offset:2048
ds_read_b128 v[212:215], v2 offset:3072
v_mfma_f32_16x16x32_bf16 v[92:95], a[152:155], a[16:19], v[92:95]
ds_read_b128 v[216:219], v2 offset:4096
ds_read_b128 v[220:223], v2 offset:5120
v_mfma_f32_16x16x32_bf16 v[92:95], a[156:159], a[20:23], v[92:95]
ds_read_b128 v[224:227], v2 offset:6144
ds_read_b128 v[228:231], v2 offset:7168
v_mfma_f32_16x16x32_bf16 v[124:127], a[156:159], a[28:31], v[124:127]
ds_read_b64_tr_b16 a[184:185], v185 offset:0
v_mfma_f32_16x16x32_bf16 v[124:127], a[152:155], a[24:27], v[124:127]
ds_read_b64_tr_b16 a[186:187], v185 offset:4096
v_mfma_f32_16x16x32_bf16 v[128:131], a[160:163], a[24:27], v[128:131]
ds_read_b64_tr_b16 a[188:189], v185 offset:8192
v_mfma_f32_16x16x32_bf16 v[128:131], a[164:167], a[28:31], v[128:131]
ds_read_b64_tr_b16 a[190:191], v185 offset:12288
v_mfma_f32_16x16x32_bf16 v[96:99], a[164:167], a[20:23], v[96:99]
s_waitcnt lgkmcnt(10)
ds_read_b64_tr_b16 a[192:193], v186 offset:0
v_add_f32 v200, v200, v40
v_mfma_f32_16x16x32_bf16 v[96:99], a[160:163], a[16:19], v[96:99]
ds_read_b64_tr_b16 a[194:195], v186 offset:4096
v_add_f32 v201, v201, v41
v_mfma_f32_16x16x32_bf16 v[64:67], a[160:163], a[8:11], v[64:67]
ds_read_b64_tr_b16 a[196:197], v186 offset:8192
v_add_f32 v202, v202, v42
v_mfma_f32_16x16x32_bf16 v[64:67], a[164:167], a[12:15], v[64:67]
ds_read_b64_tr_b16 a[198:199], v186 offset:12288
v_add_f32 v203, v203, v43
v_mfma_f32_16x16x32_bf16 v[32:35], a[164:167], a[4:7], v[32:35]
v_add_f32 v204, v204, v44
v_add_f32 v205, v205, v45
v_mfma_f32_16x16x32_bf16 v[32:35], a[160:163], a[0:3], v[32:35]
v_add_f32 v206, v206, v46
v_add_f32 v207, v207, v47
v_mfma_f32_16x16x32_bf16 v[36:39], a[168:171], a[0:3], v[36:39]
v_cvt_pk_bf16_f32 v200, v200, v201
v_cvt_pk_bf16_f32 v201, v202, v203
v_mfma_f32_16x16x32_bf16 v[36:39], a[172:175], a[4:7], v[36:39]
v_cvt_pk_bf16_f32 v202, v204, v205
v_cvt_pk_bf16_f32 v203, v206, v207
v_mfma_f32_16x16x32_bf16 v[68:71], a[172:175], a[12:15], v[68:71]
buffer_store_dwordx4 v[200:203], v16, s[44:47], s73 offen offset:0 sc1
v_mfma_f32_16x16x32_bf16 v[68:71], a[168:171], a[8:11], v[68:71]
s_waitcnt lgkmcnt(2)
ds_read_b64_tr_b16 a[200:201], v187 offset:0
v_add_f32 v208, v208, v48
v_mfma_f32_16x16x32_bf16 v[100:103], a[168:171], a[16:19], v[100:103]
ds_read_b64_tr_b16 a[202:203], v187 offset:4096
v_add_f32 v209, v209, v49
v_mfma_f32_16x16x32_bf16 v[100:103], a[172:175], a[20:23], v[100:103]
ds_read_b64_tr_b16 a[204:205], v187 offset:8192
v_add_f32 v210, v210, v50
v_mfma_f32_16x16x32_bf16 v[132:135], a[172:175], a[28:31], v[132:135]
ds_read_b64_tr_b16 a[206:207], v187 offset:12288
v_add_f32 v211, v211, v51
v_mfma_f32_16x16x32_bf16 v[132:135], a[168:171], a[24:27], v[132:135]
v_add_f32 v212, v212, v52
v_add_f32 v213, v213, v53
v_mfma_f32_16x16x32_bf16 v[120:123], a[176:179], a[56:59], v[120:123]
v_add_f32 v214, v214, v54
v_add_f32 v215, v215, v55
v_mfma_f32_16x16x32_bf16 v[120:123], a[180:183], a[60:63], v[120:123]
v_cvt_pk_bf16_f32 v208, v208, v209
v_cvt_pk_bf16_f32 v209, v210, v211
v_cvt_pk_bf16_f32 v210, v212, v213
v_cvt_pk_bf16_f32 v211, v214, v215
v_mfma_f32_16x16x32_bf16 v[88:91], a[180:183], a[52:55], v[88:91]
buffer_store_dwordx4 v[208:211], v16, s[44:47], s73 offen offset:1024 sc1
v_mfma_f32_16x16x32_bf16 v[88:91], a[176:179], a[48:51], v[88:91]
v_add_f32 v216, v216, v72
v_add_f32 v217, v217, v73
v_mfma_f32_16x16x32_bf16 v[56:59], a[176:179], a[40:43], v[56:59]
v_add_f32 v218, v218, v74
v_add_f32 v219, v219, v75
v_mfma_f32_16x16x32_bf16 v[56:59], a[180:183], a[44:47], v[56:59]
v_add_f32 v220, v220, v76
v_add_f32 v221, v221, v77
v_mfma_f32_16x16x32_bf16 v[24:27], a[180:183], a[36:39], v[24:27]
v_add_f32 v222, v222, v78
v_add_f32 v223, v223, v79
v_mfma_f32_16x16x32_bf16 v[24:27], a[176:179], a[32:35], v[24:27]
v_cvt_pk_bf16_f32 v216, v216, v217
v_cvt_pk_bf16_f32 v217, v218, v219
v_mfma_f32_16x16x32_bf16 v[28:31], a[184:187], a[32:35], v[28:31]
v_cvt_pk_bf16_f32 v218, v220, v221
v_cvt_pk_bf16_f32 v219, v222, v223
v_mfma_f32_16x16x32_bf16 v[28:31], a[188:191], a[36:39], v[28:31]
buffer_store_dwordx4 v[216:219], v16, s[44:47], s73 offen offset:2048 sc1
v_mfma_f32_16x16x32_bf16 v[60:63], a[188:191], a[44:47], v[60:63]
v_add_f32 v224, v224, v80
v_add_f32 v225, v225, v81
v_mfma_f32_16x16x32_bf16 v[60:63], a[184:187], a[40:43], v[60:63]
v_add_f32 v226, v226, v82
v_add_f32 v227, v227, v83
v_mfma_f32_16x16x32_bf16 v[92:95], a[184:187], a[48:51], v[92:95]
v_add_f32 v228, v228, v84
v_add_f32 v229, v229, v85
v_mfma_f32_16x16x32_bf16 v[92:95], a[188:191], a[52:55], v[92:95]
v_add_f32 v230, v230, v86
v_add_f32 v231, v231, v87
v_mfma_f32_16x16x32_bf16 v[124:127], a[188:191], a[60:63], v[124:127]
v_cvt_pk_bf16_f32 v224, v224, v225
v_cvt_pk_bf16_f32 v225, v226, v227
v_mfma_f32_16x16x32_bf16 v[124:127], a[184:187], a[56:59], v[124:127]
v_cvt_pk_bf16_f32 v226, v228, v229
v_cvt_pk_bf16_f32 v227, v230, v231
v_mfma_f32_16x16x32_bf16 v[128:131], a[192:195], a[56:59], v[128:131]
s_waitcnt lgkmcnt(0)
buffer_store_dwordx4 v[224:227], v16, s[44:47], s73 offen offset:3072 sc1
v_mfma_f32_16x16x32_bf16 v[128:131], a[196:199], a[60:63], v[128:131]
ds_write_b128 v3, v[120:123] offset:36864
v_mfma_f32_16x16x32_bf16 v[96:99], a[196:199], a[52:55], v[96:99]
ds_write_b128 v3, v[88:91] offset:32768
v_mfma_f32_16x16x32_bf16 v[96:99], a[192:195], a[48:51], v[96:99]
v_mfma_f32_16x16x32_bf16 v[64:67], a[192:195], a[40:43], v[64:67]
ds_write_b128 v3, v[92:95] offset:33792
v_mfma_f32_16x16x32_bf16 v[64:67], a[196:199], a[44:47], v[64:67]
v_mfma_f32_16x16x32_bf16 v[32:35], a[196:199], a[36:39], v[32:35]
ds_write_b128 v3, v[124:127] offset:37888
v_mfma_f32_16x16x32_bf16 v[32:35], a[192:195], a[32:35], v[32:35]
v_mfma_f32_16x16x32_bf16 v[36:39], a[200:203], a[32:35], v[36:39]
ds_write_b128 v3, v[128:131] offset:38912
v_mfma_f32_16x16x32_bf16 v[36:39], a[204:207], a[36:39], v[36:39]
v_mfma_f32_16x16x32_bf16 v[68:71], a[204:207], a[44:47], v[68:71]
ds_write_b128 v3, v[96:99] offset:34816
v_mfma_f32_16x16x32_bf16 v[68:71], a[200:203], a[40:43], v[68:71]
v_mfma_f32_16x16x32_bf16 v[100:103], a[200:203], a[48:51], v[100:103]
v_mfma_f32_16x16x32_bf16 v[100:103], a[204:207], a[52:55], v[100:103]
v_mfma_f32_16x16x32_bf16 v[132:135], a[204:207], a[60:63], v[132:135]
v_mfma_f32_16x16x32_bf16 v[132:135], a[200:203], a[56:59], v[132:135]
buffer_load_dwordx4 v[152:155], v16, s[44:47], s75 offen offset:0 sc1
buffer_load_dwordx4 v[156:159], v16, s[44:47], s75 offen offset:1024 sc1
buffer_load_dwordx4 v[160:163], v16, s[44:47], s75 offen offset:2048 sc1
buffer_load_dwordx4 v[164:167], v16, s[44:47], s75 offen offset:3072 sc1
s_nop 3
ds_write_b128 v3, v[100:103] offset:35840
ds_write_b128 v3, v[132:135] offset:39936
s_mov_b32 s72, 0x20000
s_waitcnt lgkmcnt(0)
s_barrier
ds_read_b128 v[88:91], v2 offset:32768
ds_read_b128 v[92:95], v2 offset:33792
ds_read_b128 v[96:99], v2 offset:34816
ds_read_b128 v[100:103], v2 offset:35840
ds_read_b128 v[120:123], v2 offset:36864
ds_read_b128 v[124:127], v2 offset:37888
ds_read_b128 v[128:131], v2 offset:38912
ds_read_b128 v[132:135], v2 offset:39936
s_waitcnt lgkmcnt(7)
v_add_f32 v24, v24, v88
v_add_f32 v25, v25, v89
v_add_f32 v26, v26, v90
v_add_f32 v27, v27, v91
s_waitcnt lgkmcnt(6)
v_add_f32 v28, v28, v92
v_add_f32 v29, v29, v93
v_add_f32 v30, v30, v94
v_add_f32 v31, v31, v95
s_waitcnt lgkmcnt(5)
v_add_f32 v32, v32, v96
v_add_f32 v33, v33, v97
v_add_f32 v34, v34, v98
v_add_f32 v35, v35, v99
s_waitcnt lgkmcnt(4)
v_add_f32 v36, v36, v100
v_add_f32 v37, v37, v101
v_add_f32 v38, v38, v102
v_add_f32 v39, v39, v103
s_waitcnt lgkmcnt(3)
v_add_f32 v56, v56, v120
v_add_f32 v57, v57, v121
v_add_f32 v58, v58, v122
v_add_f32 v59, v59, v123
s_waitcnt lgkmcnt(2)
v_add_f32 v60, v60, v124
v_add_f32 v61, v61, v125
v_add_f32 v62, v62, v126
v_add_f32 v63, v63, v127
s_waitcnt lgkmcnt(1)
v_add_f32 v64, v64, v128
v_add_f32 v65, v65, v129
v_add_f32 v66, v66, v130
v_add_f32 v67, v67, v131
s_waitcnt lgkmcnt(0)
v_add_f32 v68, v68, v132
v_add_f32 v69, v69, v133
v_add_f32 v70, v70, v134
v_add_f32 v71, v71, v135
L_xchk:
s_waitcnt vmcnt(0)
v_max3_u32 v9, v152, v153, v154
v_max3_u32 v9, v9, v155, v156
v_max3_u32 v9, v9, v157, v158
v_max3_u32 v9, v9, v159, v160
v_max3_u32 v9, v9, v161, v162
v_max3_u32 v9, v9, v163, v164
v_max3_u32 v9, v9, v165, v166
v_max_u32 v9, v9, v167
v_cmp_eq_u32 vcc, -1, v9
s_cbranch_vccnz L_xretry
L_xgo:
v_mfma_f32_16x16x32_bf16 v[24:27], v[234:237], v[152:155], v[24:27]
v_mfma_f32_16x16x32_bf16 v[28:31], v[232:235], v[152:155], v[28:31]
v_mfma_f32_16x16x32_bf16 v[32:35], v[234:237], v[156:159], v[32:35]
v_mfma_f32_16x16x32_bf16 v[36:39], v[232:235], v[156:159], v[36:39]
v_mfma_f32_16x16x32_bf16 v[56:59], v[234:237], v[160:163], v[56:59]
v_mfma_f32_16x16x32_bf16 v[60:63], v[232:235], v[160:163], v[60:63]
v_mfma_f32_16x16x32_bf16 v[64:67], v[234:237], v[164:167], v[64:67]
v_mfma_f32_16x16x32_bf16 v[68:71], v[232:235], v[164:167], v[68:71]
s_nop 1
v_cvt_pk_bf16_f32 v24, v24, v25
v_cvt_pk_bf16_f32 v25, v26, v27
v_cvt_pk_bf16_f32 v26, v28, v29
v_cvt_pk_bf16_f32 v27, v30, v31
v_cvt_pk_bf16_f32 v32, v32, v33
v_cvt_pk_bf16_f32 v33, v34, v35
v_cvt_pk_bf16_f32 v34, v36, v37
v_cvt_pk_bf16_f32 v35, v38, v39
v_permlane16_swap_b32 v24, v26
v_permlane16_swap_b32 v25, v27
v_permlane16_swap_b32 v32, v34
v_permlane16_swap_b32 v33, v35
v_mov_b32 v28, v24
v_mov_b32 v29, v25
v_mov_b32 v30, v26
v_mov_b32 v31, v27
v_mov_b32_dpp v24, v32 row_ror:8 row_mask:0xf bank_mask:0xc
v_mov_b32_dpp v25, v33 row_ror:8 row_mask:0xf bank_mask:0xc
v_mov_b32_dpp v26, v34 row_ror:8 row_mask:0xf bank_mask:0xc
v_mov_b32_dpp v27, v35 row_ror:8 row_mask:0xf bank_mask:0xc
v_mov_b32_dpp v32, v28 row_ror:8 row_mask:0xf bank_mask:0x3
v_mov_b32_dpp v33, v29 row_ror:8 row_mask:0xf bank_mask:0x3
v_mov_b32_dpp v34, v30 row_ror:8 row_mask:0xf bank_mask:0x3
v_mov_b32_dpp v35, v31 row_ror:8 row_mask:0xf bank_mask:0x3
buffer_store_dwordx4 v[24:27], v8, s[48:51], s77 offen sc1
s_add_u32 s77, s77, 16384
buffer_store_dwordx4 v[32:35], v8, s[48:51], s77 offen sc1
s_add_u32 s77, s77, 16384
v_cvt_pk_bf16_f32 v56, v56, v57
v_cvt_pk_bf16_f32 v57, v58, v59
v_cvt_pk_bf16_f32 v58, v60, v61
v_cvt_pk_bf16_f32 v59, v62, v63
v_cvt_pk_bf16_f32 v64, v64, v65
v_cvt_pk_bf16_f32 v65, v66, v67
v_cvt_pk_bf16_f32 v66, v68, v69
v_cvt_pk_bf16_f32 v67, v70, v71
v_permlane16_swap_b32 v56, v58
v_permlane16_swap_b32 v57, v59
v_permlane16_swap_b32 v64, v66
v_permlane16_swap_b32 v65, v67
v_mov_b32 v60, v56
v_mov_b32 v61, v57
v_mov_b32 v62, v58
v_mov_b32 v63, v59
v_mov_b32_dpp v56, v64 row_ror:8 row_mask:0xf bank_mask:0xc
v_mov_b32_dpp v57, v65 row_ror:8 row_mask:0xf bank_mask:0xc
v_mov_b32_dpp v58, v66 row_ror:8 row_mask:0xf bank_mask:0xc
v_mov_b32_dpp v59, v67 row_ror:8 row_mask:0xf bank_mask:0xc
v_mov_b32_dpp v64, v60 row_ror:8 row_mask:0xf bank_mask:0x3
v_mov_b32_dpp v65, v61 row_ror:8 row_mask:0xf bank_mask:0x3
v_mov_b32_dpp v66, v62 row_ror:8 row_mask:0xf bank_mask:0x3
v_mov_b32_dpp v67, v63 row_ror:8 row_mask:0xf bank_mask:0x3
buffer_store_dwordx4 v[56:59], v8, s[48:51], s77 offen sc1
s_add_u32 s77, s77, 16384
buffer_store_dwordx4 v[64:67], v8, s[48:51], s77 offen sc1
s_add_u32 s77, s77, 16384
L_end:
s_endpgm
L_spin_1:
s_mov_b32 vcc_hi, 0x80000
L_spinlp_3:
s_sleep 1
buffer_load_dword v1, off, s[52:55], s78 offset:0 sc1
s_waitcnt vmcnt(0)
v_readfirstlane_b32 vcc_lo, v1
s_sub_u32 vcc_hi, vcc_hi, 1
s_cbranch_scc1 L_spinbk_2
s_cmp_lt_u32 vcc_lo, s81
s_cbranch_scc1 L_spinlp_3
s_branch L_spinbk_2
L_spin_4:
s_mov_b32 vcc_hi, 0x80000
L_spinlp_6:
s_sleep 1
buffer_load_dword v1, off, s[52:55], s70 offset:0 sc1
s_waitcnt vmcnt(0)
v_readfirstlane_b32 vcc_lo, v1
s_sub_u32 vcc_hi, vcc_hi, 1
s_cbranch_scc1 L_spinbk_5
s_cmp_lt_u32 vcc_lo, s81
s_cbranch_scc1 L_spinlp_6
s_branch L_spinbk_5
L_hretry:
s_sub_u32 s72, s72, 1
s_cbranch_scc1 L_hgo
buffer_load_dwordx4 v[88:91], v16, s[44:47], s77 offen sc1
s_waitcnt vmcnt(0)
s_branch L_hchk
L_spin_8:
s_mov_b32 vcc_hi, 0x80000
L_spinlp_10:
s_sleep 1
buffer_load_dword v19, off, s[52:55], s80 offset:0 sc1
s_waitcnt vmcnt(0)
v_readfirstlane_b32 vcc_lo, v19
s_sub_u32 vcc_hi, vcc_hi, 1
s_cbranch_scc1 L_spinbk_9
s_cmp_lt_u32 vcc_lo, s69
s_cbranch_scc1 L_spinlp_10
s_branch L_spinbk_9
L_spin_1012:
s_mov_b32 vcc_hi, 0x80000
L_spinlp_1014:
s_sleep 1
buffer_load_dword v19, off, s[52:55], s80 offset:0 sc1
s_waitcnt vmcnt(0)
v_readfirstlane_b32 vcc_lo, v19
s_sub_u32 vcc_hi, vcc_hi, 1
s_cbranch_scc1 L_spinbk_1013
s_cmp_lt_u32 vcc_lo, s69
s_cbranch_scc1 L_spinlp_1014
s_branch L_spinbk_1013
L_F1:
ds_read_b128 a[144:147], v2 offset:0
ds_read_b128 a[148:151], v2 offset:1024
ds_read_b128 a[152:155], v2 offset:2048
ds_read_b128 a[156:159], v2 offset:3072
ds_read_b128 a[160:163], v2 offset:4096
ds_read_b128 a[164:167], v2 offset:5120
ds_read_b128 a[168:171], v2 offset:6144
ds_read_b128 a[172:175], v2 offset:7168
s_mov_b32 m0, s71
s_nop 0
buffer_load_dwordx4 v16, s[32:35], s70 offen offset:0 sc1 lds
buffer_load_dwordx4 v16, s[32:35], s70 offen offset:1024 sc1 lds
s_waitcnt lgkmcnt(7)
v_mfma_f32_16x16x32_bf16 v[104:107], a[144:147], v[40:43], 0
s_waitcnt lgkmcnt(6)
ds_read_b128 a[176:179], v2 offset:8192
v_cndmask_b32 v88, 0, v17, s[0:1]
v_mfma_f32_16x16x32_bf16 v[104:107], a[148:151], v[44:47], v[104:107]
s_waitcnt lgkmcnt(6)
ds_read_b128 a[180:183], v2 offset:9216
v_cndmask_b32 v89, 0, v17, s[4:5]
v_mfma_f32_16x16x32_bf16 v[104:107], a[152:155], v[48:51], v[104:107]
s_waitcnt lgkmcnt(6)
buffer_load_dwordx4 v16, s[32:35], s70 offen offset:2048 sc1 lds
v_mfma_f32_16x16x32_bf16 v[104:107], a[156:159], v[52:55], v[104:107]
ds_read_b128 a[184:187], v2 offset:10240
v_cndmask_b32 v90, 0, v17, s[6:7]
v_mfma_f32_16x16x32_bf16 v[120:123], a[156:159], v[68:71], 0
ds_read_b128 a[188:191], v2 offset:11264
v_cndmask_b32 v91, 0, v17, s[8:9]
v_mfma_f32_16x16x32_bf16 v[120:123], a[152:155], v[64:67], v[120:123]
ds_read_b128 a[192:195], v2 offset:12288
v_accvgpr_write_b32 a128, 0
v_mfma_f32_16x16x32_bf16 v[120:123], a[148:151], v[60:63], v[120:123]
ds_read_b128 a[196:199], v2 offset:13312
v_accvgpr_write_b32 a129, 0
v_mfma_f32_16x16x32_bf16 v[120:123], a[144:147], v[56:59], v[120:123]
ds_read_b128 a[200:203], v2 offset:14336
v_accvgpr_write_b32 a130, 0
v_mfma_f32_16x16x32_bf16 v[136:139], a[144:147], v[72:75], 0
ds_read_b128 a[204:207], v2 offset:15360
v_accvgpr_write_b32 a131, 0
v_mfma_f32_16x16x32_bf16 v[136:139], a[148:151], v[76:79], v[136:139]
buffer_load_dwordx4 v16, s[32:35], s70 offen offset:3072 sc1 lds
v_mfma_f32_16x16x32_bf16 v[136:139], a[152:155], v[80:83], v[136:139]
v_accvgpr_write_b32 a132, 0
v_accvgpr_write_b32 a133, 0
v_mfma_f32_16x16x32_bf16 v[136:139], a[156:159], v[84:87], v[136:139]
v_accvgpr_write_b32 a134, 0
v_accvgpr_write_b32 a135, 0
v_mfma_f32_16x16x32_bf16 v[88:91], a[156:159], v[36:39], v[88:91]
v_accvgpr_write_b32 a136, 0
v_accvgpr_write_b32 a137, 0
v_mfma_f32_16x16x32_bf16 v[88:91], a[152:155], v[32:35], v[88:91]
v_accvgpr_write_b32 a138, 0
v_accvgpr_write_b32 a139, 0
v_mfma_f32_16x16x32_bf16 v[88:91], a[148:151], v[28:31], v[88:91]
v_accvgpr_write_b32 a140, 0
v_accvgpr_write_b32 a141, 0
v_mfma_f32_16x16x32_bf16 v[88:91], a[144:147], v[24:27], v[88:91]
s_waitcnt lgkmcnt(0)
s_nop 1
v_max3_f32 v21, v104, v105, v106
v_max_f32 v21, v21, v107
v_max3_f32 v22, v120, v121, v122
v_max_f32 v22, v22, v123
v_max3_f32 v23, v136, v137, v138
v_max_f32 v23, v23, v139
v_max3_f32 v20, v88, v89, v90
v_max_f32 v20, v20, v91
v_mov_b32 v248, v20
v_mov_b32 v249, v21
v_mov_b32 v250, v22
v_mov_b32 v251, v23
v_permlane16_swap_b32 v248, v20
v_permlane16_swap_b32 v249, v21
v_permlane16_swap_b32 v250, v22
v_permlane16_swap_b32 v251, v23
v_max_f32 v20, v20, v248
v_max_f32 v21, v21, v249
v_max_f32 v22, v22, v250
v_max_f32 v23, v23, v251
v_mov_b32 v248, v20
v_mov_b32 v249, v21
v_mov_b32 v250, v22
v_mov_b32 v251, v23
v_permlane32_swap_b32 v248, v20
v_permlane32_swap_b32 v249, v21
v_permlane32_swap_b32 v250, v22
v_permlane32_swap_b32 v251, v23
v_max_f32 v20, v20, v248
v_max_f32 v21, v21, v249
v_max_f32 v22, v22, v250
v_max_f32 v23, v23, v251
s_cmp_eq_u32 s73, 0
s_cselect_b64 vcc, 0, -1
v_cndmask_b32 v20, v20, v252, vcc
v_cndmask_b32 v21, v21, v253, vcc
v_cndmask_b32 v22, v22, v254, vcc
v_cndmask_b32 v23, v23, v255, vcc
v_sub_f32 v228, 0, v23
v_sub_f32 v229, 0, v23
v_sub_f32 v230, 0, v23
v_sub_f32 v231, 0, v23
v_sub_f32 v224, 0, v22
v_sub_f32 v225, 0, v22
v_sub_f32 v226, 0, v22
v_sub_f32 v227, 0, v22
v_sub_f32 v220, 0, v21
v_sub_f32 v221, 0, v21
v_sub_f32 v222, 0, v21
v_sub_f32 v223, 0, v21
v_sub_f32 v216, 0, v20
v_sub_f32 v217, 0, v20
v_sub_f32 v218, 0, v20
v_sub_f32 v219, 0, v20
v_mfma_f32_16x16x32_bf16 v[140:143], a[160:163], v[72:75], v[228:231]
s_add_u32 m0, s71, 4096
v_add_f32 v104, v104, v220
v_add_f32 v105, v105, v220
v_mfma_f32_16x16x32_bf16 v[140:143], a[164:167], v[76:79], v[140:143]
v_add_f32 v106, v106, v220
v_add_f32 v107, v107, v220
v_exp_f32 v104, v104
v_mfma_f32_16x16x32_bf16 v[140:143], a[168:171], v[80:83], v[140:143]
s_add_u32 s64, s70, 4096
v_exp_f32 v105, v105
v_mfma_f32_16x16x32_bf16 v[140:143], a[172:175], v[84:87], v[140:143]
buffer_load_dwordx4 v16, s[32:35], s64 offen offset:0 sc1 lds
v_mfma_f32_16x16x32_bf16 v[124:127], a[172:175], v[68:71], v[224:227]
v_exp_f32 v106, v106
v_mfma_f32_16x16x32_bf16 v[124:127], a[168:171], v[64:67], v[124:127]
v_exp_f32 v107, v107
v_mfma_f32_16x16x32_bf16 v[124:127], a[164:167], v[60:63], v[124:127]
v_add_f32 v120, v120, v224
v_add_f32 v121, v121, v224
v_add_f32 v122, v122, v224
v_add_f32 v123, v123, v224
v_exp_f32 v120, v120
v_mfma_f32_16x16x32_bf16 v[124:127], a[160:163], v[56:59], v[124:127]
v_exp_f32 v121, v121
v_mfma_f32_16x16x32_bf16 v[108:111], a[160:163], v[40:43], v[220:223]
v_exp_f32 v122, v122
v_mfma_f32_16x16x32_bf16 v[108:111], a[164:167], v[44:47], v[108:111]
v_cndmask_b32 v92, v216, v17, s[10:11]
v_cndmask_b32 v93, v216, v17, s[12:13]
v_cndmask_b32 v94, v216, v17, s[18:19]
v_cndmask_b32 v95, v216, v17, s[22:23]
v_mfma_f32_16x16x32_bf16 v[108:111], a[168:171], v[48:51], v[108:111]
buffer_load_dwordx4 v16, s[32:35], s64 offen offset:1024 sc1 lds
v_cvt_pk_bf16_f32 v160, v104, v105
v_mfma_f32_16x16x32_bf16 v[108:111], a[172:175], v[52:55], v[108:111]
v_exp_f32 v123, v123
v_mfma_f32_16x16x32_bf16 v[92:95], a[172:175], v[36:39], v[92:95]
v_add_f32 v136, v136, v228
v_add_f32 v137, v137, v228
v_add_f32 v138, v138, v228
v_add_f32 v139, v139, v228
v_exp_f32 v136, v136
v_mfma_f32_16x16x32_bf16 v[92:95], a[168:171], v[32:35], v[92:95]
v_cvt_pk_bf16_f32 v161, v106, v107
v_exp_f32 v137, v137
v_cndmask_b32 v96, v216, v17, s[26:27]
v_cndmask_b32 v97, v216, v17, s[56:57]
v_cndmask_b32 v98, v216, v17, s[58:59]
v_cndmask_b32 v99, v216, v17, s[60:61]
v_mfma_f32_16x16x32_bf16 v[92:95], a[164:167], v[28:31], v[92:95]
v_exp_f32 v138, v138
v_mfma_f32_16x16x32_bf16 v[92:95], a[160:163], v[24:27], v[92:95]
v_exp_f32 v139, v139
v_mfma_f32_16x16x32_bf16 v[96:99], a[176:179], v[24:27], v[96:99]
v_cvt_pk_bf16_f32 v184, v120, v121
v_add_f32 v88, v88, v216
v_mfma_f32_16x16x32_bf16 v[96:99], a[180:183], v[28:31], v[96:99]
buffer_load_dwordx4 v16, s[32:35], s64 offen offset:2048 sc1 lds
v_add_f32 v89, v89, v216
v_add_f32 v90, v90, v216
v_add_f32 v91, v91, v216
v_exp_f32 v88, v88
v_mfma_f32_16x16x32_bf16 v[96:99], a[184:187], v[32:35], v[96:99]
v_exp_f32 v89, v89
v_mfma_f32_16x16x32_bf16 v[96:99], a[188:191], v[36:39], v[96:99]
v_cvt_pk_bf16_f32 v185, v122, v123
v_cvt_pk_bf16_f32 v192, v136, v137
v_mfma_f32_16x16x32_bf16 v[112:115], a[188:191], v[52:55], v[220:223]
v_exp_f32 v90, v90
v_mfma_f32_16x16x32_bf16 v[112:115], a[184:187], v[48:51], v[112:115]
v_exp_f32 v91, v91
v_mfma_f32_16x16x32_bf16 v[112:115], a[180:183], v[44:47], v[112:115]
v_exp_f32 v140, v140
v_mfma_f32_16x16x32_bf16 v[112:115], a[176:179], v[40:43], v[112:115]
v_exp_f32 v141, v141
v_mfma_f32_16x16x32_bf16 v[128:131], a[176:179], v[56:59], v[224:227]
buffer_load_dwordx4 v16, s[32:35], s64 offen offset:3072 sc1 lds
v_cvt_pk_bf16_f32 v193, v138, v139
v_mfma_f32_16x16x32_bf16 v[128:131], a[180:183], v[60:63], v[128:131]
v_exp_f32 v142, v142
v_mfma_f32_16x16x32_bf16 v[128:131], a[184:187], v[64:67], v[128:131]
v_exp_f32 v143, v143
v_mfma_f32_16x16x32_bf16 v[128:131], a[188:191], v[68:71], v[128:131]
v_cvt_pk_bf16_f32 v152, v88, v89
v_cvt_pk_bf16_f32 v153, v90, v91
v_mfma_f32_16x16x32_bf16 v[144:147], a[188:191], v[84:87], v[228:231]
v_exp_f32 v124, v124
v_mfma_f32_16x16x32_bf16 v[144:147], a[184:187], v[80:83], v[144:147]
v_exp_f32 v125, v125
v_mfma_f32_16x16x32_bf16 v[144:147], a[180:183], v[76:79], v[144:147]
s_waitcnt vmcnt(8)
s_barrier
v_mfma_f32_16x16x32_bf16 v[144:147], a[176:179], v[72:75], v[144:147]
v_exp_f32 v126, v126
v_mfma_f32_16x16x32_bf16 v[148:151], a[192:195], v[72:75], v[228:231]
v_cvt_pk_bf16_f32 v194, v140, v141
v_cvt_pk_bf16_f32 v195, v142, v143
v_mfma_f32_16x16x32_bf16 v[148:151], a[196:199], v[76:79], v[148:151]
v_exp_f32 v127, v127
v_mfma_f32_16x16x32_bf16 v[148:151], a[200:203], v[80:83], v[148:151]
s_xor_b32 s71, s71, 16384
v_exp_f32 v108, v108
v_mfma_f32_16x16x32_bf16 v[148:151], a[204:207], v[84:87], v[148:151]
s_add_u32 s70, s70, 32768
v_exp_f32 v109, v109
v_mfma_f32_16x16x32_bf16 v[132:135], a[204:207], v[68:71], v[224:227]
s_mov_b32 m0, s71
v_exp_f32 v110, v110
v_mfma_f32_16x16x32_bf16 v[132:135], a[200:203], v[64:67], v[132:135]
buffer_load_dwordx4 v16, s[32:35], s70 offen offset:0 sc1 lds
v_mfma_f32_16x16x32_bf16 v[132:135], a[196:199], v[60:63], v[132:135]
v_cvt_pk_bf16_f32 v186, v124, v125
v_exp_f32 v111, v111
v_mfma_f32_16x16x32_bf16 v[132:135], a[192:195], v[56:59], v[132:135]
v_exp_f32 v92, v92
v_mfma_f32_16x16x32_bf16 v[116:119], a[192:195], v[40:43], v[220:223]
ds_read_b128 a[144:147], v2 offset:16384
v_cndmask_b32 v100, v216, v17, s[62:63]
v_mfma_f32_16x16x32_bf16 v[116:119], a[196:199], v[44:47], v[116:119]
ds_read_b128 a[148:151], v2 offset:17408
v_cndmask_b32 v101, v216, v17, s[48:49]
v_cndmask_b32 v102, v216, v17, s[50:51]
v_cndmask_b32 v103, v216, v17, s[100:101]
v_cvt_pk_bf16_f32 v187, v126, v127
v_exp_f32 v93, v93
v_mfma_f32_16x16x32_bf16 v[116:119], a[200:203], v[48:51], v[116:119]
v_exp_f32 v94, v94
v_mfma_f32_16x16x32_bf16 v[116:119], a[204:207], v[52:55], v[116:119]
ds_read_b128 a[152:155], v2 offset:18432
v_cvt_pk_bf16_f32 v162, v108, v109
v_mfma_f32_16x16x32_bf16 v[100:103], a[204:207], v[36:39], v[100:103]
buffer_load_dwordx4 v16, s[32:35], s70 offen offset:1024 sc1 lds
v_exp_f32 v95, v95
v_mfma_f32_16x16x32_bf16 v[100:103], a[200:203], v[32:35], v[100:103]
ds_read_b128 a[156:159], v2 offset:19456
v_exp_f32 v96, v96
v_mfma_f32_16x16x32_bf16 v[100:103], a[196:199], v[28:31], v[100:103]
v_cvt_pk_bf16_f32 v163, v110, v111
v_exp_f32 v97, v97
v_mfma_f32_16x16x32_bf16 v[100:103], a[192:195], v[24:27], v[100:103]
s_waitcnt lgkmcnt(2)
ds_read_b128 a[160:163], v2 offset:20480
ds_read_b128 a[164:167], v2 offset:21504
ds_read_b128 a[168:171], v2 offset:22528
ds_read_b128 a[172:175], v2 offset:23552
v_mfma_f32_16x16x32_bf16 v[120:123], a[144:147], v[56:59], v[224:227]
v_exp_f32 v98, v98
v_mfma_f32_16x16x32_bf16 v[120:123], a[148:151], v[60:63], v[120:123]
s_waitcnt lgkmcnt(5)
v_cvt_pk_bf16_f32 v154, v92, v93
v_exp_f32 v99, v99
v_mfma_f32_16x16x32_bf16 v[120:123], a[152:155], v[64:67], v[120:123]
s_waitcnt lgkmcnt(4)
v_exp_f32 v112, v112
v_mfma_f32_16x16x32_bf16 v[120:123], a[156:159], v[68:71], v[120:123]
v_exp_f32 v113, v113
v_mfma_f32_16x16x32_bf16 v[136:139], a[156:159], v[84:87], v[228:231]
v_cvt_pk_bf16_f32 v155, v94, v95
v_cndmask_b32 v104, v220, v17, s[0:1]
v_mfma_f32_16x16x32_bf16 v[136:139], a[152:155], v[80:83], v[136:139]
ds_read_b128 a[176:179], v2 offset:24576
buffer_load_dwordx4 v16, s[32:35], s70 offen offset:2048 sc1 lds
v_cndmask_b32 v105, v220, v17, s[4:5]
v_cndmask_b32 v106, v220, v17, s[6:7]
v_cndmask_b32 v107, v220, v17, s[8:9]
v_exp_f32 v114, v114
v_mfma_f32_16x16x32_bf16 v[136:139], a[148:151], v[76:79], v[136:139]
v_cvt_pk_bf16_f32 v156, v96, v97
v_cvt_pk_bf16_f32 v157, v98, v99
v_mfma_f32_16x16x32_bf16 v[136:139], a[144:147], v[72:75], v[136:139]
v_exp_f32 v115, v115
v_mfma_f32_16x16x32_bf16 v[104:107], a[144:147], v[40:43], v[104:107]
v_exp_f32 v128, v128
v_mfma_f32_16x16x32_bf16 v[104:107], a[148:151], v[44:47], v[104:107]
v_exp_f32 v129, v129
v_mfma_f32_16x16x32_bf16 v[104:107], a[152:155], v[48:51], v[104:107]
v_exp_f32 v130, v130
v_mfma_f32_16x16x32_bf16 v[104:107], a[156:159], v[52:55], v[104:107]
s_waitcnt lgkmcnt(0)
v_exp_f32 v131, v131
v_mfma_f32_16x16x32_bf16 v[140:143], a[172:175], v[84:87], v[228:231]
v_cvt_pk_bf16_f32 v164, v112, v113
v_cvt_pk_bf16_f32 v165, v114, v115
v_mfma_f32_16x16x32_bf16 v[140:143], a[168:171], v[80:83], v[140:143]
v_exp_f32 v144, v144
v_mfma_f32_16x16x32_bf16 v[140:143], a[164:167], v[76:79], v[140:143]
v_exp_f32 v145, v145
v_mfma_f32_16x16x32_bf16 v[140:143], a[160:163], v[72:75], v[140:143]
v_exp_f32 v146, v146
v_mfma_f32_16x16x32_bf16 v[124:127], a[160:163], v[56:59], v[224:227]
ds_read_b128 a[180:183], v2 offset:25600
v_cndmask_b32 v108, v220, v17, s[10:11]
v_mfma_f32_16x16x32_bf16 v[124:127], a[164:167], v[60:63], v[124:127]
ds_read_b128 a[184:187], v2 offset:26624
buffer_load_dwordx4 v16, s[32:35], s70 offen offset:3072 sc1 lds
v_cndmask_b32 v109, v220, v17, s[12:13]
v_cndmask_b32 v110, v220, v17, s[18:19]
v_cndmask_b32 v111, v220, v17, s[22:23]
v_cvt_pk_bf16_f32 v188, v128, v129
v_mfma_f32_16x16x32_bf16 v[124:127], a[168:171], v[64:67], v[124:127]
s_add_u32 m0, s86, 131072
v_exp_f32 v147, v147
v_mfma_f32_16x16x32_bf16 v[124:127], a[172:175], v[68:71], v[124:127]
s_add_u32 s64, s85, 0
ds_read_b128 a[188:191], v2 offset:27648
v_exp_f32 v148, v148
v_mfma_f32_16x16x32_bf16 v[108:111], a[172:175], v[52:55], v[108:111]
buffer_load_dwordx4 v12, s[36:39], s64 offen lds
v_cvt_pk_bf16_f32 v189, v130, v131
v_exp_f32 v149, v149
v_mfma_f32_16x16x32_bf16 v[108:111], a[168:171], v[48:51], v[108:111]
s_add_u32 m0, s86, 132096
ds_read_b128 a[192:195], v2 offset:28672
v_cndmask_b32 v112, v220, v17, s[26:27]
v_cndmask_b32 v113, v220, v17, s[56:57]
v_cndmask_b32 v114, v220, v17, s[58:59]
v_cndmask_b32 v115, v220, v17, s[60:61]
v_mfma_f32_16x16x32_bf16 v[108:111], a[164:167], v[44:47], v[108:111]
s_add_u32 s64, s85, 8192
v_exp_f32 v150, v150
v_mfma_f32_16x16x32_bf16 v[108:111], a[160:163], v[40:43], v[108:111]
buffer_load_dwordx4 v13, s[36:39], s64 offen lds
v_cvt_pk_bf16_f32 v196, v144, v145
v_exp_f32 v151, v151
v_mfma_f32_16x16x32_bf16 v[112:115], a[176:179], v[40:43], v[112:115]
s_waitcnt lgkmcnt(2)
s_add_u32 m0, s86, 133120
v_exp_f32 v132, v132
v_mfma_f32_16x16x32_bf16 v[112:115], a[180:183], v[44:47], v[112:115]
s_add_u32 s64, s85, 16384
v_exp_f32 v133, v133
v_mfma_f32_16x16x32_bf16 v[112:115], a[184:187], v[48:51], v[112:115]
s_waitcnt lgkmcnt(1)
buffer_load_dwordx4 v12, s[36:39], s64 offen lds
v_cvt_pk_bf16_f32 v197, v146, v147
v_mfma_f32_16x16x32_bf16 v[112:115], a[188:191], v[52:55], v[112:115]
s_add_u32 m0, s86, 134144
v_exp_f32 v134, v134
v_mfma_f32_16x16x32_bf16 v[128:131], a[188:191], v[68:71], v[224:227]
s_add_u32 s64, s85, 24576
ds_read_b128 a[196:199], v2 offset:29696
ds_read_b128 a[200:203], v2 offset:30720
ds_read_b128 a[204:207], v2 offset:31744
v_cvt_pk_bf16_f32 v198, v148, v149
v_mfma_f32_16x16x32_bf16 v[128:131], a[184:187], v[64:67], v[128:131]
buffer_load_dwordx4 v13, s[36:39], s64 offen lds
v_exp_f32 v135, v135
v_mfma_f32_16x16x32_bf16 v[128:131], a[180:183], v[60:63], v[128:131]
s_add_u32 m0, s71, 4096
v_exp_f32 v116, v116
v_mfma_f32_16x16x32_bf16 v[128:131], a[176:179], v[56:59], v[128:131]
s_add_u32 s64, s70, 4096
v_cvt_pk_bf16_f32 v199, v150, v151
v_exp_f32 v117, v117
v_mfma_f32_16x16x32_bf16 v[144:147], a[176:179], v[72:75], v[228:231]
buffer_load_dwordx4 v16, s[32:35], s64 offen offset:0 sc1 lds
v_mfma_f32_16x16x32_bf16 v[144:147], a[180:183], v[76:79], v[144:147]
v_exp_f32 v118, v118
v_mfma_f32_16x16x32_bf16 v[144:147], a[184:187], v[80:83], v[144:147]
v_cvt_pk_bf16_f32 v190, v132, v133
v_exp_f32 v119, v119
v_mfma_f32_16x16x32_bf16 v[144:147], a[188:191], v[84:87], v[144:147]
s_waitcnt lgkmcnt(0)
v_exp_f32 v100, v100
v_mfma_f32_16x16x32_bf16 v[148:151], a[204:207], v[84:87], v[228:231]
v_exp_f32 v101, v101
v_mfma_f32_16x16x32_bf16 v[148:151], a[200:203], v[80:83], v[148:151]
v_cvt_pk_bf16_f32 v191, v134, v135
v_cvt_pk_bf16_f32 v166, v116, v117
v_cvt_pk_bf16_f32 v167, v118, v119
v_mfma_f32_16x16x32_bf16 v[148:151], a[196:199], v[76:79], v[148:151]
v_exp_f32 v102, v102
v_mfma_f32_16x16x32_bf16 v[148:151], a[192:195], v[72:75], v[148:151]
v_exp_f32 v103, v103
v_mfma_f32_16x16x32_bf16 v[132:135], a[192:195], v[56:59], v[224:227]
s_lshl_b32 s66, s30, 30
ds_read_b128 a[144:147], v3 offset:16384
v_cndmask_b32 v116, v220, v17, s[62:63]
v_mfma_f32_16x16x32_bf16 v[132:135], a[196:199], v[60:63], v[132:135]
ds_read_b128 a[148:151], v3 offset:24576
v_cndmask_b32 v117, v220, v17, s[48:49]
v_cndmask_b32 v118, v220, v17, s[50:51]
v_cndmask_b32 v119, v220, v17, s[100:101]
v_exp_f32 v120, v120
v_mfma_f32_16x16x32_bf16 v[132:135], a[200:203], v[64:67], v[132:135]
v_exp_f32 v121, v121
v_mfma_f32_16x16x32_bf16 v[132:135], a[204:207], v[68:71], v[132:135]
v_exp_f32 v122, v122
v_mfma_f32_16x16x32_bf16 v[116:119], a[204:207], v[52:55], v[116:119]
ds_read_b128 a[152:155], v3 offset:17408
v_accvgpr_write_b32 a142, 0
v_mfma_f32_16x16x32_bf16 v[116:119], a[200:203], v[48:51], v[116:119]
ds_read_b128 a[156:159], v3 offset:25600
buffer_load_dwordx4 v16, s[32:35], s64 offen offset:1024 sc1 lds
v_accvgpr_write_b32 a143, 0
v_cvt_pk_bf16_f32 v158, v100, v101
v_cvt_pk_bf16_f32 v159, v102, v103
v_mfma_f32_16x16x32_bf16 v[116:119], a[196:199], v[44:47], v[116:119]
v_exp_f32 v123, v123
v_mfma_f32_16x16x32_bf16 v[116:119], a[192:195], v[40:43], v[116:119]
v_exp_f32 v136, v136
v_smfmac_f32_16x16x64_bf16 a[128:131], a[240:243], v[152:159], v5
ds_read_b128 a[160:163], v3 offset:18432
v_smfmac_f32_16x16x64_bf16 a[132:135], a[240:243], v[160:167], v5
v_exp_f32 v137, v137
v_smfmac_f32_16x16x64_bf16 a[136:139], a[240:243], v[184:191], v5
v_exp_f32 v138, v138
v_smfmac_f32_16x16x64_bf16 a[140:143], a[240:243], v[192:199], v5
s_waitcnt lgkmcnt(1)
v_cvt_pk_bf16_f32 v200, v120, v121
v_mfma_f32_16x16x32_bf16 a[0:3], a[144:147], v[152:155], 0
v_exp_f32 v139, v139
v_mfma_f32_16x16x32_bf16 a[0:3], a[148:151], v[156:159], a[0:3]
v_exp_f32 v104, v104
v_mfma_f32_16x16x32_bf16 a[32:35], a[148:151], v[164:167], 0
v_cvt_pk_bf16_f32 v201, v122, v123
v_cvt_pk_bf16_f32 v208, v136, v137
v_mfma_f32_16x16x32_bf16 a[32:35], a[144:147], v[160:163], a[32:35]
v_exp_f32 v105, v105
v_mfma_f32_16x16x32_bf16 a[64:67], a[144:147], v[184:187], 0
v_exp_f32 v106, v106
v_mfma_f32_16x16x32_bf16 a[64:67], a[148:151], v[188:191], a[64:67]
v_exp_f32 v107, v107
v_mfma_f32_16x16x32_bf16 a[96:99], a[148:151], v[196:199], 0
buffer_load_dwordx4 v16, s[32:35], s64 offen offset:2048 sc1 lds
v_mfma_f32_16x16x32_bf16 a[96:99], a[144:147], v[192:195], a[96:99]
v_exp_f32 v140, v140
v_mfma_f32_16x16x32_bf16 a[100:103], a[152:155], v[192:195], 0
ds_read_b128 a[164:167], v3 offset:26624
v_cvt_pk_bf16_f32 v209, v138, v139
v_mfma_f32_16x16x32_bf16 a[100:103], a[156:159], v[196:199], a[100:103]
v_exp_f32 v141, v141
v_mfma_f32_16x16x32_bf16 a[68:71], a[156:159], v[188:191], 0
v_exp_f32 v142, v142
v_mfma_f32_16x16x32_bf16 a[68:71], a[152:155], v[184:187], a[68:71]
v_cvt_pk_bf16_f32 v176, v104, v105
v_cvt_pk_bf16_f32 v177, v106, v107
v_mfma_f32_16x16x32_bf16 a[36:39], a[152:155], v[160:163], 0
v_exp_f32 v143, v143
v_mfma_f32_16x16x32_bf16 a[36:39], a[156:159], v[164:167], a[36:39]
v_exp_f32 v124, v124
v_mfma_f32_16x16x32_bf16 a[4:7], a[156:159], v[156:159], 0
v_exp_f32 v125, v125
v_mfma_f32_16x16x32_bf16 a[4:7], a[152:155], v[152:155], a[4:7]
s_waitcnt lgkmcnt(0)
ds_read_b128 a[168:171], v3 offset:19456
v_cvt_pk_bf16_f32 v210, v140, v141
v_mfma_f32_16x16x32_bf16 a[8:11], a[160:163], v[152:155], 0
v_exp_f32 v126, v126
v_mfma_f32_16x16x32_bf16 a[8:11], a[164:167], v[156:159], a[8:11]
ds_read_b128 a[172:175], v3 offset:27648
v_cvt_pk_bf16_f32 v211, v142, v143
v_mfma_f32_16x16x32_bf16 a[40:43], a[164:167], v[164:167], 0
v_exp_f32 v127, v127
v_mfma_f32_16x16x32_bf16 a[40:43], a[160:163], v[160:163], a[40:43]
v_exp_f32 v108, v108
v_mfma_f32_16x16x32_bf16 a[72:75], a[160:163], v[184:187], 0
buffer_load_dwordx4 v16, s[32:35], s64 offen offset:3072 sc1 lds
v_mfma_f32_16x16x32_bf16 a[72:75], a[164:167], v[188:191], a[72:75]
v_exp_f32 v109, v109
v_mfma_f32_16x16x32_bf16 a[104:107], a[164:167], v[196:199], 0
v_exp_f32 v110, v110
v_mfma_f32_16x16x32_bf16 a[104:107], a[160:163], v[192:195], a[104:107]
s_waitcnt lgkmcnt(0)
ds_read_b128 a[176:179], v3 offset:20480
v_cvt_pk_bf16_f32 v202, v124, v125
v_mfma_f32_16x16x32_bf16 a[108:111], a[168:171], v[192:195], 0
v_exp_f32 v111, v111
v_mfma_f32_16x16x32_bf16 a[108:111], a[172:175], v[196:199], a[108:111]
ds_read_b128 a[180:183], v3 offset:28672
v_cvt_pk_bf16_f32 v203, v126, v127
v_mfma_f32_16x16x32_bf16 a[76:79], a[172:175], v[188:191], 0
s_add_u32 m0, s86, 135168
v_exp_f32 v112, v112
v_mfma_f32_16x16x32_bf16 a[76:79], a[168:171], v[184:187], a[76:79]
s_add_u32 s64, s85, 32768
v_exp_f32 v113, v113
v_mfma_f32_16x16x32_bf16 a[44:47], a[168:171], v[160:163], 0
buffer_load_dwordx4 v12, s[36:39], s64 offen lds
v_mfma_f32_16x16x32_bf16 a[44:47], a[172:175], v[164:167], a[44:47]
s_add_u32 m0, s86, 136192
v_cvt_pk_bf16_f32 v178, v108, v109
v_exp_f32 v114, v114
v_mfma_f32_16x16x32_bf16 a[12:15], a[172:175], v[156:159], 0
s_add_u32 s64, s85, 40960
v_exp_f32 v115, v115
v_mfma_f32_16x16x32_bf16 a[12:15], a[168:171], v[152:155], a[12:15]
s_waitcnt lgkmcnt(0)
buffer_load_dwordx4 v13, s[36:39], s64 offen lds
v_mfma_f32_16x16x32_bf16 a[16:19], a[176:179], v[152:155], 0
s_add_u32 m0, s86, 137216
ds_read_b128 a[184:187], v3 offset:21504
ds_read_b128 a[188:191], v3 offset:29696
ds_read_b128 a[192:195], v3 offset:22528
ds_read_b128 a[196:199], v3 offset:30720
ds_read_b128 a[200:203], v3 offset:23552
ds_read_b128 a[204:207], v3 offset:31744
v_xor_b32 v2, 0x8000, v2
v_exp_f32 v128, v128
v_mfma_f32_16x16x32_bf16 a[16:19], a[180:183], v[156:159], a[16:19]
s_waitcnt vmcnt(14)
s_barrier
s_add_u32 s64, s85, 49152
v_cvt_pk_bf16_f32 v179, v110, v111
v_mfma_f32_16x16x32_bf16 a[48:51], a[180:183], v[164:167], 0
buffer_load_dwordx4 v12, s[36:39], s64 offen lds
v_exp_f32 v129, v129
v_mfma_f32_16x16x32_bf16 a[48:51], a[176:179], v[160:163], a[48:51]
s_add_u32 m0, s86, 138240
v_exp_f32 v130, v130
v_mfma_f32_16x16x32_bf16 a[80:83], a[176:179], v[184:187], 0
s_add_u32 s64, s85, 57344
v_cvt_pk_bf16_f32 v180, v112, v113
v_cvt_pk_bf16_f32 v181, v114, v115
v_mfma_f32_16x16x32_bf16 a[80:83], a[180:183], v[188:191], a[80:83]
buffer_load_dwordx4 v13, s[36:39], s64 offen lds
v_exp_f32 v131, v131
v_mfma_f32_16x16x32_bf16 a[112:115], a[180:183], v[196:199], 0
v_exp_f32 v144, v144
v_mfma_f32_16x16x32_bf16 a[112:115], a[176:179], v[192:195], a[112:115]
s_waitcnt lgkmcnt(0)
s_xor_b32 s71, s71, 49152
s_add_u32 s70, s70, 32768
s_mov_b32 m0, s71
v_exp_f32 v145, v145
v_mfma_f32_16x16x32_bf16 a[116:119], a[184:187], v[192:195], 0
buffer_load_dwordx4 v16, s[32:35], s70 offen offset:0 sc1 lds
v_mfma_f32_16x16x32_bf16 a[116:119], a[188:191], v[196:199], a[116:119]
v_exp_f32 v146, v146
v_mfma_f32_16x16x32_bf16 a[84:87], a[188:191], v[188:191], 0
v_cvt_pk_bf16_f32 v204, v128, v129
v_cvt_pk_bf16_f32 v205, v130, v131
v_mfma_f32_16x16x32_bf16 a[84:87], a[184:187], v[184:187], a[84:87]
v_exp_f32 v147, v147
v_mfma_f32_16x16x32_bf16 a[52:55], a[184:187], v[160:163], 0
v_exp_f32 v148, v148
v_mfma_f32_16x16x32_bf16 a[52:55], a[188:191], v[164:167], a[52:55]
v_exp_f32 v149, v149
v_mfma_f32_16x16x32_bf16 a[20:23], a[188:191], v[156:159], 0
ds_read_b128 a[144:147], v2 offset:0
v_lshl_add_u32 v19, v0, 24, s66
v_mfma_f32_16x16x32_bf16 a[20:23], a[184:187], v[152:155], a[20:23]
s_lshr_b32 s67, s31, 4
v_exp_f32 v150, v150
v_mfma_f32_16x16x32_bf16 a[24:27], a[192:195], v[152:155], 0
s_lshl1_add_u32 s67, s3, s67
v_cvt_pk_bf16_f32 v212, v144, v145
v_cvt_pk_bf16_f32 v213, v146, v147
v_mfma_f32_16x16x32_bf16 a[24:27], a[196:199], v[156:159], a[24:27]
s_lshl_b32 s79, s67, 8
v_exp_f32 v151, v151
v_mfma_f32_16x16x32_bf16 a[56:59], a[196:199], v[164:167], 0
s_add_u32 s79, s79, 8192
v_exp_f32 v132, v132
v_mfma_f32_16x16x32_bf16 a[56:59], a[192:195], v[160:163], a[56:59]
s_add_u32 s69, s31, 12
v_exp_f32 v133, v133
v_mfma_f32_16x16x32_bf16 a[88:91], a[192:195], v[184:187], 0
s_lshr_b32 s69, s69, 5
buffer_load_dwordx4 v16, s[32:35], s70 offen offset:1024 sc1 lds
v_mfma_f32_16x16x32_bf16 a[88:91], a[196:199], v[188:191], a[88:91]
s_lshl1_add_u32 s69, s3, s69
v_exp_f32 v134, v134
v_mfma_f32_16x16x32_bf16 a[120:123], a[196:199], v[196:199], 0
s_lshl_b32 s69, s69, 8
v_cvt_pk_bf16_f32 v214, v148, v149
v_cvt_pk_bf16_f32 v215, v150, v151
v_mfma_f32_16x16x32_bf16 a[120:123], a[192:195], v[192:195], a[120:123]
s_add_u32 s69, s69, 8192
v_exp_f32 v135, v135
v_mfma_f32_16x16x32_bf16 a[124:127], a[200:203], v[192:195], 0
s_lshl_b32 s67, s73, 16
v_exp_f32 v116, v116
v_mfma_f32_16x16x32_bf16 a[124:127], a[204:207], v[196:199], a[124:127]
s_xor_b32 s68, s80, 256
v_exp_f32 v117, v117
v_mfma_f32_16x16x32_bf16 a[92:95], a[204:207], v[188:191], 0
s_add_u32 s68, s68, s67
s_add_u32 s17, s78, L_T-L_pc+0
ds_read_b128 a[148:151], v2 offset:1024
v_cvt_pk_bf16_f32 v206, v132, v133
v_mfma_f32_16x16x32_bf16 a[92:95], a[200:203], v[184:187], a[92:95]
s_add_u32 s67, s67, s69
buffer_load_dword a252, v16, s[88:91], s17 offen
v_mfma_f32_16x16x32_bf16 a[60:63], a[200:203], v[160:163], 0
ds_read_b128 a[152:155], v2 offset:2048
v_exp_f32 v118, v118
v_mfma_f32_16x16x32_bf16 a[60:63], a[204:207], v[164:167], a[60:63]
s_add_u32 s17, s78, L_T-L_pc+4096
ds_read_b128 a[156:159], v2 offset:3072
v_cvt_pk_bf16_f32 v207, v134, v135
v_mfma_f32_16x16x32_bf16 a[28:31], a[204:207], v[156:159], 0
s_mov_b64 exec, 1
buffer_atomic_add a251, v19, s[52:55], s67 offen offset:0 sc1
buffer_atomic_add a251, v19, s[52:55], s68 offen offset:0 sc1
s_mov_b64 exec, -1
v_exp_f32 v119, v119
v_mfma_f32_16x16x32_bf16 a[28:31], a[200:203], v[152:155], a[28:31]
ds_read_b128 a[160:163], v2 offset:4096
buffer_load_dword a252, v16, s[88:91], s17 offen
ds_read_b128 a[164:167], v2 offset:5120
ds_read_b128 a[168:171], v2 offset:6144
ds_read_b128 a[172:175], v2 offset:7168
v_mul_u32_u24 v19, 52, v0
v_cvt_pk_bf16_f32 v182, v116, v117
v_cvt_pk_bf16_f32 v183, v118, v119
v_xor_b32 v3, 0x8000, v3
v_accvgpr_read_b32 v20, a128
v_accvgpr_read_b32 v248, a129
v_add_f32 v20, v20, v248
v_max_f32 v1, v1, v20
v_rcp_f32 v20, v20
v_accvgpr_read_b32 v232, a0
v_accvgpr_read_b32 v233, a1
v_accvgpr_read_b32 v234, a2
v_accvgpr_read_b32 v235, a3
v_accvgpr_read_b32 v236, a4
v_accvgpr_read_b32 v237, a5
v_accvgpr_read_b32 v238, a6
v_accvgpr_read_b32 v239, a7
v_mul_f32 v20, v20, v4
v_mul_f32 v232, v232, v20
v_mul_f32 v233, v233, v20
v_mul_f32 v234, v234, v20
v_mul_f32 v235, v235, v20
v_mul_f32 v236, v236, v20
v_mul_f32 v237, v237, v20
v_mul_f32 v238, v238, v20
v_mul_f32 v239, v239, v20
v_cvt_pk_bf16_f32 v232, v232, v233
v_cvt_pk_bf16_f32 v233, v234, v235
v_cvt_pk_bf16_f32 v234, v236, v237
v_cvt_pk_bf16_f32 v235, v238, v239
s_add_u32 s77, s74, 0
buffer_store_dwordx4 v[232:235], v16, s[44:47], s77 offen sc1
v_accvgpr_read_b32 v240, a8
v_accvgpr_read_b32 v241, a9
v_accvgpr_read_b32 v242, a10
v_accvgpr_read_b32 v243, a11
v_accvgpr_read_b32 v244, a12
v_accvgpr_read_b32 v245, a13
v_accvgpr_read_b32 v246, a14
v_accvgpr_read_b32 v247, a15
v_mul_f32 v240, v240, v20
v_mul_f32 v241, v241, v20
v_mul_f32 v242, v242, v20
v_mul_f32 v243, v243, v20
v_mul_f32 v244, v244, v20
v_mul_f32 v245, v245, v20
v_mul_f32 v246, v246, v20
v_mul_f32 v247, v247, v20
v_cvt_pk_bf16_f32 v240, v240, v241
v_cvt_pk_bf16_f32 v241, v242, v243
v_cvt_pk_bf16_f32 v242, v244, v245
v_cvt_pk_bf16_f32 v243, v246, v247
s_add_u32 s77, s74, 8192
buffer_store_dwordx4 v[240:243], v16, s[44:47], s77 offen sc1
v_accvgpr_read_b32 v232, a16
v_accvgpr_read_b32 v233, a17
v_accvgpr_read_b32 v234, a18
v_accvgpr_read_b32 v235, a19
v_accvgpr_read_b32 v236, a20
v_accvgpr_read_b32 v237, a21
v_accvgpr_read_b32 v238, a22
v_accvgpr_read_b32 v239, a23
v_mul_f32 v232, v232, v20
v_mul_f32 v233, v233, v20
v_mul_f32 v234, v234, v20
v_mul_f32 v235, v235, v20
v_mul_f32 v236, v236, v20
v_mul_f32 v237, v237, v20
v_mul_f32 v238, v238, v20
v_mul_f32 v239, v239, v20
v_cvt_pk_bf16_f32 v232, v232, v233
v_cvt_pk_bf16_f32 v233, v234, v235
v_cvt_pk_bf16_f32 v234, v236, v237
v_cvt_pk_bf16_f32 v235, v238, v239
s_add_u32 s77, s74, 16384
buffer_store_dwordx4 v[232:235], v16, s[44:47], s77 offen sc1
s_branch L_T
L_T1:
buffer_load_dword v19, off, s[52:55], s80 sc1
s_add_u32 s17, s78, L_TAIL-L_pc
buffer_load_dword a252, v16, s[88:91], s17 offen
s_add_u32 s17, s78, L_TAIL-L_pc+4096
buffer_load_dword a252, v16, s[88:91], s17 offen
s_add_u32 s17, s78, L_p5f0-L_pc
buffer_load_dword a252, v16, s[88:91], s17 offen
s_add_u32 s17, s78, L_p5f0-L_pc+4096
buffer_load_dword a252, v16, s[88:91], s17 offen
s_waitcnt lgkmcnt(7)
v_mfma_f32_16x16x32_bf16 v[136:139], a[144:147], v[72:75], v[228:231]
s_waitcnt lgkmcnt(6)
ds_read_b128 a[176:179], v2 offset:8192
v_cndmask_b32 v120, v224, v17, s[0:1]
v_mfma_f32_16x16x32_bf16 v[136:139], a[148:151], v[76:79], v[136:139]
s_waitcnt lgkmcnt(6)
ds_read_b128 a[180:183], v2 offset:9216
v_cndmask_b32 v121, v224, v17, s[4:5]
v_cndmask_b32 v122, v224, v17, s[6:7]
v_cndmask_b32 v123, v224, v17, s[8:9]
v_mfma_f32_16x16x32_bf16 v[136:139], a[152:155], v[80:83], v[136:139]
s_waitcnt lgkmcnt(6)
buffer_load_dwordx4 v16, s[32:35], s70 offen offset:2048 sc1 lds
v_mfma_f32_16x16x32_bf16 v[136:139], a[156:159], v[84:87], v[136:139]
ds_read_b128 a[184:187], v2 offset:10240
v_cndmask_b32 v124, v224, v17, s[10:11]
v_mfma_f32_16x16x32_bf16 v[120:123], a[156:159], v[68:71], v[120:123]
ds_read_b128 a[188:191], v2 offset:11264
v_cndmask_b32 v125, v224, v17, s[12:13]
v_mfma_f32_16x16x32_bf16 v[120:123], a[152:155], v[64:67], v[120:123]
ds_read_b128 a[192:195], v2 offset:12288
v_cndmask_b32 v126, v224, v17, s[18:19]
v_mfma_f32_16x16x32_bf16 v[120:123], a[148:151], v[60:63], v[120:123]
ds_read_b128 a[196:199], v2 offset:13312
v_cndmask_b32 v127, v224, v17, s[22:23]
v_mfma_f32_16x16x32_bf16 v[120:123], a[144:147], v[56:59], v[120:123]
s_waitcnt lgkmcnt(4)
ds_read_b128 a[200:203], v2 offset:14336
v_cndmask_b32 v128, v224, v17, s[26:27]
v_mfma_f32_16x16x32_bf16 v[140:143], a[160:163], v[72:75], v[228:231]
ds_read_b128 a[204:207], v2 offset:15360
v_cndmask_b32 v129, v224, v17, s[56:57]
v_mfma_f32_16x16x32_bf16 v[140:143], a[164:167], v[76:79], v[140:143]
ds_read_b128 a[144:147], v3 offset:0
v_cndmask_b32 v130, v224, v17, s[58:59]
v_mfma_f32_16x16x32_bf16 v[140:143], a[168:171], v[80:83], v[140:143]
v_exp_f32 v136, v136
v_mfma_f32_16x16x32_bf16 v[140:143], a[172:175], v[84:87], v[140:143]
v_exp_f32 v137, v137
v_mfma_f32_16x16x32_bf16 v[124:127], a[172:175], v[68:71], v[124:127]
ds_read_b128 a[148:151], v3 offset:8192
v_cndmask_b32 v131, v224, v17, s[60:61]
v_mfma_f32_16x16x32_bf16 v[124:127], a[168:171], v[64:67], v[124:127]
v_exp_f32 v138, v138
v_mfma_f32_16x16x32_bf16 v[124:127], a[164:167], v[60:63], v[124:127]
s_mul_i32 s69, s83, 8
buffer_load_dwordx4 v16, s[32:35], s70 offen offset:3072 sc1 lds
v_mfma_f32_16x16x32_bf16 v[124:127], a[160:163], v[56:59], v[124:127]
s_sub_u32 s69, 36, s69
v_exp_f32 v139, v139
v_mfma_f32_16x16x32_bf16 v[128:131], a[176:179], v[56:59], v[128:131]
v_exp_f32 v120, v120
v_mfma_f32_16x16x32_bf16 v[128:131], a[180:183], v[60:63], v[128:131]
s_waitcnt lgkmcnt(1)
v_exp_f32 v121, v121
v_mfma_f32_16x16x32_bf16 v[128:131], a[184:187], v[64:67], v[128:131]
v_exp_f32 v122, v122
v_mfma_f32_16x16x32_bf16 v[128:131], a[188:191], v[68:71], v[128:131]
s_add_u32 m0, s71, 4096
ds_read_b128 a[152:155], v3 offset:1024
v_cndmask_b32 v132, v224, v17, s[62:63]
v_mfma_f32_16x16x32_bf16 v[144:147], a[188:191], v[84:87], v[228:231]
s_add_u32 s64, s70, 4096
v_cvt_pk_bf16_f32 v192, v136, v137
v_cndmask_b32 v133, v224, v17, s[48:49]
v_mfma_f32_16x16x32_bf16 v[144:147], a[184:187], v[80:83], v[144:147]
buffer_load_dwordx4 v16, s[32:35], s64 offen offset:0 sc1 lds
v_mfma_f32_16x16x32_bf16 v[144:147], a[180:183], v[76:79], v[144:147]
ds_read_b128 a[156:159], v3 offset:9216
v_cndmask_b32 v134, v224, v17, s[50:51]
v_mfma_f32_16x16x32_bf16 v[144:147], a[176:179], v[72:75], v[144:147]
ds_read_b128 a[160:163], v3 offset:2048
v_cndmask_b32 v135, v224, v17, s[100:101]
v_mfma_f32_16x16x32_bf16 v[148:151], a[192:195], v[72:75], v[228:231]
v_exp_f32 v123, v123
v_mfma_f32_16x16x32_bf16 v[148:151], a[196:199], v[76:79], v[148:151]
v_cvt_pk_bf16_f32 v193, v138, v139
v_cvt_pk_bf16_f32 v184, v120, v121
v_mfma_f32_16x16x32_bf16 v[148:151], a[200:203], v[80:83], v[148:151]
v_exp_f32 v140, v140
v_mfma_f32_16x16x32_bf16 v[148:151], a[204:207], v[84:87], v[148:151]
v_exp_f32 v141, v141
v_mfma_f32_16x16x32_bf16 v[132:135], a[204:207], v[68:71], v[132:135]
v_exp_f32 v142, v142
v_mfma_f32_16x16x32_bf16 v[132:135], a[200:203], v[64:67], v[132:135]
v_exp_f32 v143, v143
v_mfma_f32_16x16x32_bf16 v[132:135], a[196:199], v[60:63], v[132:135]
buffer_load_dwordx4 v16, s[32:35], s64 offen offset:1024 sc1 lds
v_mfma_f32_16x16x32_bf16 v[132:135], a[192:195], v[56:59], v[132:135]
v_exp_f32 v124, v124
v_smfmac_f32_16x16x64_bf16 a[132:135], a[240:243], v[176:183], v5
ds_read_b128 a[164:167], v3 offset:10240
v_smfmac_f32_16x16x64_bf16 a[136:139], a[240:243], v[200:207], v5
ds_read_b128 a[168:171], v3 offset:3072
v_accvgpr_read_b32 v240, a24
v_smfmac_f32_16x16x64_bf16 a[140:143], a[240:243], v[208:215], v5
v_cvt_pk_bf16_f32 v185, v122, v123
v_mfma_f32_16x16x32_bf16 a[32:35], a[144:147], v[176:179], a[32:35]
s_waitcnt lgkmcnt(2)
v_exp_f32 v125, v125
v_mfma_f32_16x16x32_bf16 a[32:35], a[148:151], v[180:183], a[32:35]
ds_read_b128 a[172:175], v3 offset:11264
v_accvgpr_read_b32 v241, a25
v_mfma_f32_16x16x32_bf16 a[64:67], a[148:151], v[204:207], a[64:67]
ds_read_b128 a[176:179], v3 offset:4096
v_accvgpr_read_b32 v242, a26
v_mfma_f32_16x16x32_bf16 a[64:67], a[144:147], v[200:203], a[64:67]
v_cvt_pk_bf16_f32 v194, v140, v141
v_accvgpr_read_b32 v243, a27
v_mfma_f32_16x16x32_bf16 a[96:99], a[144:147], v[208:211], a[96:99]
ds_read_b128 a[180:183], v3 offset:12288
v_accvgpr_read_b32 v244, a28
v_mfma_f32_16x16x32_bf16 a[96:99], a[148:151], v[212:215], a[96:99]
ds_read_b128 a[184:187], v3 offset:5120
v_accvgpr_read_b32 v245, a29
v_mfma_f32_16x16x32_bf16 a[100:103], a[156:159], v[212:215], a[100:103]
ds_read_b128 a[188:191], v3 offset:13312
v_accvgpr_read_b32 v246, a30
v_mfma_f32_16x16x32_bf16 a[100:103], a[152:155], v[208:211], a[100:103]
ds_read_b128 a[192:195], v3 offset:6144
v_accvgpr_read_b32 v247, a31
v_mul_f32 v240, v240, v20
v_mul_f32 v241, v241, v20
v_mul_f32 v242, v242, v20
v_mul_f32 v243, v243, v20
v_mul_f32 v244, v244, v20
v_mul_f32 v245, v245, v20
v_mul_f32 v246, v246, v20
v_mul_f32 v247, v247, v20
v_cvt_pk_bf16_f32 v240, v240, v241
v_cvt_pk_bf16_f32 v241, v242, v243
v_cvt_pk_bf16_f32 v242, v244, v245
v_cvt_pk_bf16_f32 v243, v246, v247
s_add_u32 s77, s74, 24576
buffer_store_dwordx4 v[240:243], v16, s[44:47], s77 offen sc1
v_exp_f32 v126, v126
v_mfma_f32_16x16x32_bf16 a[68:71], a[152:155], v[200:203], a[68:71]
buffer_load_dwordx4 v16, s[32:35], s64 offen offset:2048 sc1 lds
v_cvt_pk_bf16_f32 v195, v142, v143
v_mfma_f32_16x16x32_bf16 a[68:71], a[156:159], v[204:207], a[68:71]
v_exp_f32 v127, v127
v_mfma_f32_16x16x32_bf16 a[36:39], a[156:159], v[180:183], a[36:39]
v_exp_f32 v128, v128
v_mfma_f32_16x16x32_bf16 a[36:39], a[152:155], v[176:179], a[36:39]
v_exp_f32 v129, v129
v_mfma_f32_16x16x32_bf16 a[40:43], a[160:163], v[176:179], a[40:43]
s_waitcnt lgkmcnt(1)
v_cvt_pk_bf16_f32 v186, v124, v125
v_cvt_pk_bf16_f32 v187, v126, v127
v_mfma_f32_16x16x32_bf16 a[40:43], a[164:167], v[180:183], a[40:43]
v_exp_f32 v130, v130
v_mfma_f32_16x16x32_bf16 a[72:75], a[164:167], v[204:207], a[72:75]
buffer_load_dwordx4 v16, s[32:35], s64 offen offset:3072 sc1 lds
v_mfma_f32_16x16x32_bf16 a[72:75], a[160:163], v[200:203], a[72:75]
v_exp_f32 v131, v131
v_mfma_f32_16x16x32_bf16 a[104:107], a[160:163], v[208:211], a[104:107]
v_exp_f32 v144, v144
v_mfma_f32_16x16x32_bf16 a[104:107], a[164:167], v[212:215], a[104:107]
v_exp_f32 v145, v145
v_mfma_f32_16x16x32_bf16 a[108:111], a[172:175], v[212:215], a[108:111]
v_exp_f32 v146, v146
v_mfma_f32_16x16x32_bf16 a[108:111], a[168:171], v[208:211], a[108:111]
ds_read_b128 a[196:199], v3 offset:14336
v_cvt_pk_bf16_f32 v188, v128, v129
v_mfma_f32_16x16x32_bf16 a[76:79], a[168:171], v[200:203], a[76:79]
ds_read_b128 a[200:203], v3 offset:7168
v_cvt_pk_bf16_f32 v189, v130, v131
v_mfma_f32_16x16x32_bf16 a[76:79], a[172:175], v[204:207], a[76:79]
ds_read_b128 a[204:207], v3 offset:15360
v_cvt_pk_bf16_f32 v196, v144, v145
v_mfma_f32_16x16x32_bf16 a[44:47], a[172:175], v[180:183], a[44:47]
v_exp_f32 v147, v147
v_mfma_f32_16x16x32_bf16 a[44:47], a[168:171], v[176:179], a[44:47]
v_exp_f32 v148, v148
v_mfma_f32_16x16x32_bf16 a[48:51], a[176:179], v[176:179], a[48:51]
v_exp_f32 v149, v149
v_mfma_f32_16x16x32_bf16 a[48:51], a[180:183], v[180:183], a[48:51]
v_exp_f32 v150, v150
v_mfma_f32_16x16x32_bf16 a[80:83], a[180:183], v[204:207], a[80:83]
s_waitcnt vmcnt(14)
s_barrier
v_mfma_f32_16x16x32_bf16 a[80:83], a[176:179], v[200:203], a[80:83]
v_exp_f32 v151, v151
v_mfma_f32_16x16x32_bf16 a[112:115], a[176:179], v[208:211], a[112:115]
v_exp_f32 v132, v132
v_mfma_f32_16x16x32_bf16 a[112:115], a[180:183], v[212:215], a[112:115]
v_exp_f32 v133, v133
v_mfma_f32_16x16x32_bf16 a[116:119], a[188:191], v[212:215], a[116:119]
ds_read_b128 a[144:147], v2 offset:16384
v_cvt_pk_bf16_f32 v197, v146, v147
v_mfma_f32_16x16x32_bf16 a[116:119], a[184:187], v[208:211], a[116:119]
v_exp_f32 v134, v134
v_mfma_f32_16x16x32_bf16 a[84:87], a[184:187], v[200:203], a[84:87]
s_waitcnt vmcnt(11)
v_readfirstlane_b32 vcc_lo, v19
s_nop 0
s_cmp_lt_u32 vcc_lo, s69
s_cbranch_scc1 L_spin_1012
L_spinbk_1013:
v_mfma_f32_16x16x32_bf16 a[84:87], a[188:191], v[204:207], a[84:87]
ds_read_b128 a[148:151], v2 offset:17408
v_cvt_pk_bf16_f32 v198, v148, v149
v_mfma_f32_16x16x32_bf16 a[52:55], a[188:191], v[180:183], a[52:55]
ds_read_b128 a[152:155], v2 offset:18432
v_cvt_pk_bf16_f32 v199, v150, v151
v_mfma_f32_16x16x32_bf16 a[52:55], a[184:187], v[176:179], a[52:55]
s_waitcnt lgkmcnt(3)
ds_read_b128 a[156:159], v2 offset:19456
v_cndmask_b32 v136, v228, v17, s[0:1]
v_mfma_f32_16x16x32_bf16 a[56:59], a[192:195], v[176:179], a[56:59]
ds_read_b128 a[160:163], v2 offset:20480
v_cndmask_b32 v137, v228, v17, s[4:5]
v_mfma_f32_16x16x32_bf16 a[56:59], a[196:199], v[180:183], a[56:59]
ds_read_b128 a[164:167], v2 offset:21504
v_cndmask_b32 v138, v228, v17, s[6:7]
v_mfma_f32_16x16x32_bf16 a[88:91], a[196:199], v[204:207], a[88:91]
ds_read_b128 a[168:171], v2 offset:22528
v_cndmask_b32 v139, v228, v17, s[8:9]
v_mfma_f32_16x16x32_bf16 a[88:91], a[192:195], v[200:203], a[88:91]
v_exp_f32 v135, v135
v_mfma_f32_16x16x32_bf16 a[120:123], a[192:195], v[208:211], a[120:123]
ds_read_b128 a[172:175], v2 offset:23552
v_cvt_pk_bf16_f32 v190, v132, v133
v_mfma_f32_16x16x32_bf16 a[120:123], a[196:199], v[212:215], a[120:123]
v_cndmask_b32 v140, v228, v17, s[10:11]
v_cvt_pk_bf16_f32 v191, v134, v135
v_mfma_f32_16x16x32_bf16 a[124:127], a[204:207], v[212:215], a[124:127]
v_cndmask_b32 v141, v228, v17, s[12:13]
v_cndmask_b32 v142, v228, v17, s[18:19]
v_mfma_f32_16x16x32_bf16 a[124:127], a[200:203], v[208:211], a[124:127]
v_cndmask_b32 v143, v228, v17, s[22:23]
v_cndmask_b32 v144, v228, v17, s[26:27]
v_mfma_f32_16x16x32_bf16 a[92:95], a[200:203], v[200:203], a[92:95]
v_cndmask_b32 v145, v228, v17, s[56:57]
v_cndmask_b32 v146, v228, v17, s[58:59]
v_mfma_f32_16x16x32_bf16 a[92:95], a[204:207], v[204:207], a[92:95]
v_cndmask_b32 v147, v228, v17, s[60:61]
v_cndmask_b32 v148, v228, v17, s[62:63]
v_mfma_f32_16x16x32_bf16 a[60:63], a[204:207], v[180:183], a[60:63]
v_cndmask_b32 v149, v228, v17, s[48:49]
v_cndmask_b32 v150, v228, v17, s[50:51]
v_mfma_f32_16x16x32_bf16 a[60:63], a[200:203], v[176:179], a[60:63]
s_waitcnt lgkmcnt(0)
v_cndmask_b32 v151, v228, v17, s[100:101]
v_accvgpr_read_b32 v21, a132
v_mfma_f32_16x16x32_bf16 v[136:139], a[144:147], v[72:75], v[136:139]
ds_read_b128 a[176:179], v2 offset:24576
v_accvgpr_read_b32 v248, a133
v_mfma_f32_16x16x32_bf16 v[136:139], a[148:151], v[76:79], v[136:139]
ds_read_b128 a[180:183], v2 offset:25600
v_add_f32 v21, v21, v248
v_mfma_f32_16x16x32_bf16 v[136:139], a[152:155], v[80:83], v[136:139]
ds_read_b128 a[184:187], v2 offset:26624
v_max_f32 v1, v1, v21
v_mfma_f32_16x16x32_bf16 v[136:139], a[156:159], v[84:87], v[136:139]
ds_read_b128 a[188:191], v2 offset:27648
ds_read_b128 a[192:195], v2 offset:28672
v_mfma_f32_16x16x32_bf16 v[140:143], a[172:175], v[84:87], v[140:143]
ds_read_b128 a[196:199], v2 offset:29696
ds_read_b128 a[200:203], v2 offset:30720
ds_read_b128 a[204:207], v2 offset:31744
v_mfma_f32_16x16x32_bf16 v[140:143], a[168:171], v[80:83], v[140:143]
v_rcp_f32 v21, v21
v_mfma_f32_16x16x32_bf16 v[140:143], a[164:167], v[76:79], v[140:143]
ds_read_b128 a[144:147], v3 offset:16384
v_accvgpr_read_b32 v232, a32
v_mfma_f32_16x16x32_bf16 v[140:143], a[160:163], v[72:75], v[140:143]
s_waitcnt lgkmcnt(7)
ds_read_b128 a[148:151], v3 offset:24576
v_accvgpr_read_b32 v233, a33
v_mfma_f32_16x16x32_bf16 v[144:147], a[176:179], v[72:75], v[144:147]
ds_read_b128 a[152:155], v3 offset:17408
v_accvgpr_read_b32 v234, a34
v_mfma_f32_16x16x32_bf16 v[144:147], a[180:183], v[76:79], v[144:147]
s_waitcnt lgkmcnt(6)
ds_read_b128 a[156:159], v3 offset:25600
v_accvgpr_read_b32 v235, a35
v_mfma_f32_16x16x32_bf16 v[144:147], a[184:187], v[80:83], v[144:147]
ds_read_b128 a[160:163], v3 offset:18432
v_accvgpr_read_b32 v236, a36
v_accvgpr_read_b32 v237, a37
v_accvgpr_read_b32 v238, a38
v_accvgpr_read_b32 v239, a39
v_mul_f32 v21, v21, v6
v_mul_f32 v232, v232, v21
v_mul_f32 v233, v233, v21
v_mul_f32 v234, v234, v21
v_mul_f32 v235, v235, v21
v_mul_f32 v236, v236, v21
v_mul_f32 v237, v237, v21
v_mul_f32 v238, v238, v21
v_mul_f32 v239, v239, v21
v_cvt_pk_bf16_f32 v232, v232, v233
v_cvt_pk_bf16_f32 v233, v234, v235
v_cvt_pk_bf16_f32 v234, v236, v237
v_cvt_pk_bf16_f32 v235, v238, v239
s_add_u32 s77, s74, 4096
buffer_store_dwordx4 v[232:235], v16, s[44:47], s77 offen sc1
v_accvgpr_read_b32 v240, a40
v_accvgpr_read_b32 v241, a41
v_accvgpr_read_b32 v242, a42
v_accvgpr_read_b32 v243, a43
v_accvgpr_read_b32 v244, a44
v_accvgpr_read_b32 v245, a45
v_accvgpr_read_b32 v246, a46
v_accvgpr_read_b32 v247, a47
v_mul_f32 v240, v240, v21
v_mul_f32 v241, v241, v21
v_mul_f32 v242, v242, v21
v_mul_f32 v243, v243, v21
v_mul_f32 v244, v244, v21
v_mul_f32 v245, v245, v21
v_mul_f32 v246, v246, v21
v_mul_f32 v247, v247, v21
v_cvt_pk_bf16_f32 v240, v240, v241
v_cvt_pk_bf16_f32 v241, v242, v243
v_cvt_pk_bf16_f32 v242, v244, v245
v_cvt_pk_bf16_f32 v243, v246, v247
s_add_u32 s77, s74, 12288
buffer_store_dwordx4 v[240:243], v16, s[44:47], s77 offen sc1
v_accvgpr_read_b32 v232, a48
v_accvgpr_read_b32 v233, a49
v_accvgpr_read_b32 v234, a50
v_accvgpr_read_b32 v235, a51
v_accvgpr_read_b32 v236, a52
v_accvgpr_read_b32 v237, a53
v_accvgpr_read_b32 v238, a54
v_accvgpr_read_b32 v239, a55
v_mul_f32 v232, v232, v21
v_mul_f32 v233, v233, v21
v_mul_f32 v234, v234, v21
v_mul_f32 v235, v235, v21
v_mul_f32 v236, v236, v21
v_mul_f32 v237, v237, v21
v_mul_f32 v238, v238, v21
v_mul_f32 v239, v239, v21
v_cvt_pk_bf16_f32 v232, v232, v233
v_cvt_pk_bf16_f32 v233, v234, v235
v_cvt_pk_bf16_f32 v234, v236, v237
v_cvt_pk_bf16_f32 v235, v238, v239
s_add_u32 s77, s74, 20480
buffer_store_dwordx4 v[232:235], v16, s[44:47], s77 offen sc1
v_accvgpr_read_b32 v240, a56
v_accvgpr_read_b32 v241, a57
v_accvgpr_read_b32 v242, a58
v_accvgpr_read_b32 v243, a59
v_accvgpr_read_b32 v244, a60
v_accvgpr_read_b32 v245, a61
v_accvgpr_read_b32 v246, a62
v_accvgpr_read_b32 v247, a63
v_mul_f32 v240, v240, v21
v_mul_f32 v241, v241, v21
v_mul_f32 v242, v242, v21
v_mul_f32 v243, v243, v21
v_mul_f32 v244, v244, v21
v_mul_f32 v245, v245, v21
v_mul_f32 v246, v246, v21
v_mul_f32 v247, v247, v21
v_cvt_pk_bf16_f32 v240, v240, v241
v_cvt_pk_bf16_f32 v241, v242, v243
v_cvt_pk_bf16_f32 v242, v244, v245
v_cvt_pk_bf16_f32 v243, v246, v247
s_add_u32 s77, s74, 28672
buffer_store_dwordx4 v[240:243], v16, s[44:47], s77 offen sc1
v_exp_f32 v136, v136
v_mfma_f32_16x16x32_bf16 v[144:147], a[188:191], v[84:87], v[144:147]
s_waitcnt lgkmcnt(5)
v_exp_f32 v137, v137
v_mfma_f32_16x16x32_bf16 v[148:151], a[204:207], v[84:87], v[148:151]
v_exp_f32 v138, v138
v_mfma_f32_16x16x32_bf16 v[148:151], a[200:203], v[80:83], v[148:151]
s_add_u32 s65, s84, 0
v_exp_f32 v139, v139
v_mfma_f32_16x16x32_bf16 v[148:151], a[196:199], v[76:79], v[148:151]
buffer_load_dwordx4 a[208:211], v14, s[44:47], s65 offen offset:0 sc1
v_mfma_f32_16x16x32_bf16 v[148:151], a[192:195], v[72:75], v[148:151]
ds_read_b128 a[164:167], v3 offset:26624
v_cvt_pk_bf16_f32 v208, v136, v137
v_smfmac_f32_16x16x64_bf16 a[136:139], a[240:243], v[184:191], v5
ds_read_b128 a[168:171], v3 offset:19456
v_smfmac_f32_16x16x64_bf16 a[140:143], a[240:243], v[192:199], v5
s_waitcnt lgkmcnt(2)
ds_read_b128 a[172:175], v3 offset:27648
v_mfma_f32_16x16x32_bf16 a[64:67], a[144:147], v[184:187], a[64:67]
v_exp_f32 v140, v140
v_mfma_f32_16x16x32_bf16 a[64:67], a[148:151], v[188:191], a[64:67]
buffer_load_dwordx4 a[216:219], v14, s[44:47], s65 offen offset:1024 sc1
v_mfma_f32_16x16x32_bf16 a[96:99], a[148:151], v[196:199], a[96:99]
v_exp_f32 v141, v141
v_mfma_f32_16x16x32_bf16 a[96:99], a[144:147], v[192:195], a[96:99]
buffer_load_dwordx4 a[224:227], v15, s[44:47], s65 offen offset:0 sc1
v_mfma_f32_16x16x32_bf16 a[100:103], a[152:155], v[192:195], a[100:103]
v_exp_f32 v142, v142
v_mfma_f32_16x16x32_bf16 a[100:103], a[156:159], v[196:199], a[100:103]
buffer_load_dwordx4 a[232:235], v15, s[44:47], s65 offen offset:1024 sc1
v_mfma_f32_16x16x32_bf16 a[68:71], a[156:159], v[188:191], a[68:71]
s_add_u32 s65, s84, 8192
ds_read_b128 a[176:179], v3 offset:20480
v_cvt_pk_bf16_f32 v209, v138, v139
v_mfma_f32_16x16x32_bf16 a[68:71], a[152:155], v[184:187], a[68:71]
buffer_load_dwordx4 a[212:215], v14, s[44:47], s65 offen offset:0 sc1
v_mfma_f32_16x16x32_bf16 a[72:75], a[160:163], v[184:187], a[72:75]
s_waitcnt lgkmcnt(1)
ds_read_b128 a[180:183], v3 offset:28672
v_cvt_pk_bf16_f32 v210, v140, v141
v_mfma_f32_16x16x32_bf16 a[72:75], a[164:167], v[188:191], a[72:75]
v_exp_f32 v143, v143
v_mfma_f32_16x16x32_bf16 a[104:107], a[164:167], v[196:199], a[104:107]
buffer_load_dwordx4 a[220:223], v14, s[44:47], s65 offen offset:1024 sc1
v_mfma_f32_16x16x32_bf16 a[104:107], a[160:163], v[192:195], a[104:107]
v_exp_f32 v144, v144
v_mfma_f32_16x16x32_bf16 a[108:111], a[168:171], v[192:195], a[108:111]
ds_read_b128 a[184:187], v3 offset:21504
v_xor_b32 v2, 0x8000, v2
v_mfma_f32_16x16x32_bf16 a[108:111], a[172:175], v[196:199], a[108:111]
buffer_load_dwordx4 a[228:231], v15, s[44:47], s65 offen offset:0 sc1
ds_read_b128 a[188:191], v3 offset:29696
v_mfma_f32_16x16x32_bf16 a[76:79], a[172:175], v[188:191], a[76:79]
v_exp_f32 v145, v145
v_mfma_f32_16x16x32_bf16 a[76:79], a[168:171], v[184:187], a[76:79]
s_waitcnt lgkmcnt(2)
buffer_load_dwordx4 a[236:239], v15, s[44:47], s65 offen offset:1024 sc1
v_mfma_f32_16x16x32_bf16 a[80:83], a[176:179], v[184:187], a[80:83]
s_add_u32 s65, s84, 32768
ds_read_b128 a[192:195], v3 offset:22528
v_cvt_pk_bf16_f32 v211, v142, v143
v_mfma_f32_16x16x32_bf16 a[80:83], a[180:183], v[188:191], a[80:83]
buffer_load_dwordx4 v[152:155], v14, s[44:47], s65 offen offset:0 sc1
ds_read_b128 a[196:199], v3 offset:30720
v_exp_f32 v146, v146
v_mfma_f32_16x16x32_bf16 a[112:115], a[180:183], v[196:199], a[112:115]
ds_read_b128 a[200:203], v3 offset:23552
ds_read_b128 a[204:207], v3 offset:31744
v_mfma_f32_16x16x32_bf16 a[112:115], a[176:179], v[192:195], a[112:115]
s_waitcnt vmcnt(13)
s_barrier
v_xor_b32 v3, 0x8000, v3
buffer_load_dwordx4 v[160:163], v14, s[44:47], s65 offen offset:1024 sc1
s_waitcnt lgkmcnt(4)
v_mfma_f32_16x16x32_bf16 a[116:119], a[184:187], v[192:195], a[116:119]
v_exp_f32 v147, v147
v_mfma_f32_16x16x32_bf16 a[116:119], a[188:191], v[196:199], a[116:119]
buffer_load_dwordx4 v[168:171], v15, s[44:47], s65 offen offset:0 sc1
v_mfma_f32_16x16x32_bf16 a[84:87], a[188:191], v[188:191], a[84:87]
v_exp_f32 v148, v148
v_mfma_f32_16x16x32_bf16 a[84:87], a[184:187], v[184:187], a[84:87]
s_waitcnt lgkmcnt(2)
buffer_load_dwordx4 v[176:179], v15, s[44:47], s65 offen offset:1024 sc1
v_cvt_pk_bf16_f32 v212, v144, v145
v_mfma_f32_16x16x32_bf16 a[88:91], a[192:195], v[184:187], a[88:91]
s_add_u32 s65, s84, 40960
v_exp_f32 v149, v149
v_mfma_f32_16x16x32_bf16 a[88:91], a[196:199], v[188:191], a[88:91]
buffer_load_dwordx4 v[156:159], v14, s[44:47], s65 offen offset:0 sc1
v_mfma_f32_16x16x32_bf16 a[120:123], a[196:199], v[196:199], a[120:123]
ds_read_b128 a[144:147], v3 offset:0
v_cvt_pk_bf16_f32 v213, v146, v147
v_mfma_f32_16x16x32_bf16 a[120:123], a[192:195], v[192:195], a[120:123]
s_waitcnt lgkmcnt(1)
buffer_load_dwordx4 v[164:167], v14, s[44:47], s65 offen offset:1024 sc1
ds_read_b128 a[148:151], v3 offset:8192
v_exp_f32 v150, v150
v_mfma_f32_16x16x32_bf16 a[124:127], a[200:203], v[192:195], a[124:127]
ds_read_b128 a[152:155], v3 offset:1024
v_cvt_pk_bf16_f32 v214, v148, v149
v_mfma_f32_16x16x32_bf16 a[124:127], a[204:207], v[196:199], a[124:127]
buffer_load_dwordx4 v[172:175], v15, s[44:47], s65 offen offset:0 sc1
ds_read_b128 a[156:159], v3 offset:9216
v_mfma_f32_16x16x32_bf16 a[92:95], a[204:207], v[188:191], a[92:95]
v_exp_f32 v151, v151
v_mfma_f32_16x16x32_bf16 a[92:95], a[200:203], v[184:187], a[92:95]
buffer_load_dwordx4 v[180:183], v15, s[44:47], s65 offen offset:1024 sc1
ds_read_b128 a[160:163], v3 offset:2048
ds_read_b128 a[164:167], v3 offset:10240
ds_read_b128 a[168:171], v3 offset:3072
ds_read_b128 a[172:175], v3 offset:11264
v_cvt_pk_bf16_f32 v215, v150, v151
v_accvgpr_read_b32 v22, a136
v_accvgpr_read_b32 v248, a137
v_add_f32 v22, v22, v248
v_max_f32 v1, v1, v22
v_rcp_f32 v22, v22
v_accvgpr_read_b32 v232, a64
v_accvgpr_read_b32 v233, a65
v_accvgpr_read_b32 v234, a66
v_accvgpr_read_b32 v235, a67
v_accvgpr_read_b32 v236, a68
v_accvgpr_read_b32 v237, a69
v_accvgpr_read_b32 v238, a70
v_accvgpr_read_b32 v239, a71
v_mul_f32 v22, v22, v8
v_mul_f32 v232, v232, v22
v_mul_f32 v233, v233, v22
v_mul_f32 v234, v234, v22
v_mul_f32 v235, v235, v22
v_mul_f32 v236, v236, v22
v_mul_f32 v237, v237, v22
v_mul_f32 v238, v238, v22
v_mul_f32 v239, v239, v22
v_cvt_pk_bf16_f32 v232, v232, v233
v_cvt_pk_bf16_f32 v233, v234, v235
v_cvt_pk_bf16_f32 v234, v236, v237
v_cvt_pk_bf16_f32 v235, v238, v239
s_add_u32 s77, s75, 0
buffer_store_dwordx4 v[232:235], v16, s[44:47], s77 offen sc1
s_branch L_TAIL
L_fallback_11:
s_waitcnt vmcnt(0) lgkmcnt(0)
s_barrier
s_mov_b32 s73, 1
s_mov_b32 s81, 0
v_and_b32 v232, 15, v0
v_lshrrev_b32 v233, 4, v0
v_lshlrev_b32 v233, 2, v233
v_sub_u32 v232, v232, v233
s_lshl_b32 s66, s30, 4
v_add_u32 v232, s66, v232
s_lshl_b32 s66, s16, 7
v_add_u32 v234, s66, v232
s_lshl_b32 s66, s3, 7
v_add_u32 v232, s66, v232
v_add_u32 v233, 64, v232
v_add_u32 v235, 64, v234
s_mov_b32 m0, s76
s_lshl_b32 s64, s30, 14
s_nop 0
buffer_load_dwordx4 v16, s[32:35], s64 offen offset:0 sc1 lds
s_nop 0
buffer_load_dwordx4 v16, s[32:35], s64 offen offset:1024 sc1 lds
s_nop 0
buffer_load_dwordx4 v16, s[32:35], s64 offen offset:2048 sc1 lds
s_nop 0
buffer_load_dwordx4 v16, s[32:35], s64 offen offset:3072 sc1 lds
s_add_u32 m0, s76, 4096
s_add_u32 s64, s64, 4096
s_nop 0
buffer_load_dwordx4 v16, s[32:35], s64 offen offset:0 sc1 lds
s_nop 0
buffer_load_dwordx4 v16, s[32:35], s64 offen offset:1024 sc1 lds
s_nop 0
buffer_load_dwordx4 v16, s[32:35], s64 offen offset:2048 sc1 lds
s_nop 0
buffer_load_dwordx4 v16, s[32:35], s64 offen offset:3072 sc1 lds
s_lshr_b32 s64, s76, 1
s_add_u32 m0, s64, 81920
s_and_b32 s71, s64, 8192
s_add_u32 s64, s64, s71
s_add_u32 s64, s64, 8192
s_nop 0
buffer_load_dwordx4 v16, s[32:35], s64 offen offset:0 sc1 lds
s_nop 0
buffer_load_dwordx4 v16, s[32:35], s64 offen offset:1024 sc1 lds
s_nop 0
buffer_load_dwordx4 v16, s[32:35], s64 offen offset:2048 sc1 lds
s_nop 0
buffer_load_dwordx4 v16, s[32:35], s64 offen offset:3072 sc1 lds
v_mov_b32 v20, 0xff800000
v_mov_b32 v21, 0xff800000
v_mov_b32 v22, 0xff800000
v_mov_b32 v23, 0xff800000
L_fbl_1015:
buffer_load_dwordx4 a[144:147], v16, s[32:35], s81 offen offset:0 sc1
buffer_load_dwordx4 a[148:151], v16, s[32:35], s81 offen offset:1024 sc1
buffer_load_dwordx4 a[152:155], v16, s[32:35], s81 offen offset:2048 sc1
buffer_load_dwordx4 a[156:159], v16, s[32:35], s81 offen offset:3072 sc1
s_add_u32 s64, s81, 4096
buffer_load_dwordx4 a[160:163], v16, s[32:35], s64 offen offset:0 sc1
buffer_load_dwordx4 a[164:167], v16, s[32:35], s64 offen offset:1024 sc1
buffer_load_dwordx4 a[168:171], v16, s[32:35], s64 offen offset:2048 sc1
buffer_load_dwordx4 a[172:175], v16, s[32:35], s64 offen offset:3072 sc1
v_subrev_u32 v88, 0, v232
v_ashrrev_i32 v88, 31, v88
v_and_b32 v88, 0xff800000, v88
v_subrev_u32 v89, 1, v232
v_ashrrev_i32 v89, 31, v89
v_and_b32 v89, 0xff800000, v89
v_subrev_u32 v90, 2, v232
v_ashrrev_i32 v90, 31, v90
v_and_b32 v90, 0xff800000, v90
v_subrev_u32 v91, 3, v232
v_ashrrev_i32 v91, 31, v91
v_and_b32 v91, 0xff800000, v91
v_subrev_u32 v92, 16, v232
v_ashrrev_i32 v92, 31, v92
v_and_b32 v92, 0xff800000, v92
v_subrev_u32 v93, 17, v232
v_ashrrev_i32 v93, 31, v93
v_and_b32 v93, 0xff800000, v93
v_subrev_u32 v94, 18, v232
v_ashrrev_i32 v94, 31, v94
v_and_b32 v94, 0xff800000, v94
v_subrev_u32 v95, 19, v232
v_ashrrev_i32 v95, 31, v95
v_and_b32 v95, 0xff800000, v95
v_subrev_u32 v232, 32, v232
v_subrev_u32 v104, 0, v233
v_ashrrev_i32 v104, 31, v104
v_and_b32 v104, 0xff800000, v104
v_subrev_u32 v105, 1, v233
v_ashrrev_i32 v105, 31, v105
v_and_b32 v105, 0xff800000, v105
v_subrev_u32 v106, 2, v233
v_ashrrev_i32 v106, 31, v106
v_and_b32 v106, 0xff800000, v106
v_subrev_u32 v107, 3, v233
v_ashrrev_i32 v107, 31, v107
v_and_b32 v107, 0xff800000, v107
v_subrev_u32 v108, 16, v233
v_ashrrev_i32 v108, 31, v108
v_and_b32 v108, 0xff800000, v108
v_subrev_u32 v109, 17, v233
v_ashrrev_i32 v109, 31, v109
v_and_b32 v109, 0xff800000, v109
v_subrev_u32 v110, 18, v233
v_ashrrev_i32 v110, 31, v110
v_and_b32 v110, 0xff800000, v110
v_subrev_u32 v111, 19, v233
v_ashrrev_i32 v111, 31, v111
v_and_b32 v111, 0xff800000, v111
v_subrev_u32 v233, 32, v233
v_subrev_u32 v120, 0, v234
v_ashrrev_i32 v120, 31, v120
v_and_b32 v120, 0xff800000, v120
v_subrev_u32 v121, 1, v234
v_ashrrev_i32 v121, 31, v121
v_and_b32 v121, 0xff800000, v121
v_subrev_u32 v122, 2, v234
v_ashrrev_i32 v122, 31, v122
v_and_b32 v122, 0xff800000, v122
v_subrev_u32 v123, 3, v234
v_ashrrev_i32 v123, 31, v123
v_and_b32 v123, 0xff800000, v123
v_subrev_u32 v124, 16, v234
v_ashrrev_i32 v124, 31, v124
v_and_b32 v124, 0xff800000, v124
v_subrev_u32 v125, 17, v234
v_ashrrev_i32 v125, 31, v125
v_and_b32 v125, 0xff800000, v125
v_subrev_u32 v126, 18, v234
v_ashrrev_i32 v126, 31, v126
v_and_b32 v126, 0xff800000, v126
v_subrev_u32 v127, 19, v234
v_ashrrev_i32 v127, 31, v127
v_and_b32 v127, 0xff800000, v127
v_subrev_u32 v234, 32, v234
v_subrev_u32 v136, 0, v235
v_ashrrev_i32 v136, 31, v136
v_and_b32 v136, 0xff800000, v136
v_subrev_u32 v137, 1, v235
v_ashrrev_i32 v137, 31, v137
v_and_b32 v137, 0xff800000, v137
v_subrev_u32 v138, 2, v235
v_ashrrev_i32 v138, 31, v138
v_and_b32 v138, 0xff800000, v138
v_subrev_u32 v139, 3, v235
v_ashrrev_i32 v139, 31, v139
v_and_b32 v139, 0xff800000, v139
v_subrev_u32 v140, 16, v235
v_ashrrev_i32 v140, 31, v140
v_and_b32 v140, 0xff800000, v140
v_subrev_u32 v141, 17, v235
v_ashrrev_i32 v141, 31, v141
v_and_b32 v141, 0xff800000, v141
v_subrev_u32 v142, 18, v235
v_ashrrev_i32 v142, 31, v142
v_and_b32 v142, 0xff800000, v142
v_subrev_u32 v143, 19, v235
v_ashrrev_i32 v143, 31, v143
v_and_b32 v143, 0xff800000, v143
v_subrev_u32 v235, 32, v235
s_waitcnt vmcnt(0)
v_mfma_f32_16x16x32_bf16 v[88:91], a[144:147], v[24:27], v[88:91]
v_mfma_f32_16x16x32_bf16 v[104:107], a[144:147], v[40:43], v[104:107]
v_mfma_f32_16x16x32_bf16 v[120:123], a[144:147], v[56:59], v[120:123]
v_mfma_f32_16x16x32_bf16 v[136:139], a[144:147], v[72:75], v[136:139]
v_mfma_f32_16x16x32_bf16 v[88:91], a[148:151], v[28:31], v[88:91]
v_mfma_f32_16x16x32_bf16 v[104:107], a[148:151], v[44:47], v[104:107]
v_mfma_f32_16x16x32_bf16 v[120:123], a[148:151], v[60:63], v[120:123]
v_mfma_f32_16x16x32_bf16 v[136:139], a[148:151], v[76:79], v[136:139]
v_mfma_f32_16x16x32_bf16 v[88:91], a[152:155], v[32:35], v[88:91]
v_mfma_f32_16x16x32_bf16 v[104:107], a[152:155], v[48:51], v[104:107]
v_mfma_f32_16x16x32_bf16 v[120:123], a[152:155], v[64:67], v[120:123]
v_mfma_f32_16x16x32_bf16 v[136:139], a[152:155], v[80:83], v[136:139]
v_mfma_f32_16x16x32_bf16 v[88:91], a[156:159], v[36:39], v[88:91]
v_mfma_f32_16x16x32_bf16 v[104:107], a[156:159], v[52:55], v[104:107]
v_mfma_f32_16x16x32_bf16 v[120:123], a[156:159], v[68:71], v[120:123]
v_mfma_f32_16x16x32_bf16 v[136:139], a[156:159], v[84:87], v[136:139]
v_mfma_f32_16x16x32_bf16 v[92:95], a[160:163], v[24:27], v[92:95]
v_mfma_f32_16x16x32_bf16 v[108:111], a[160:163], v[40:43], v[108:111]
v_mfma_f32_16x16x32_bf16 v[124:127], a[160:163], v[56:59], v[124:127]
v_mfma_f32_16x16x32_bf16 v[140:143], a[160:163], v[72:75], v[140:143]
v_mfma_f32_16x16x32_bf16 v[92:95], a[164:167], v[28:31], v[92:95]
v_mfma_f32_16x16x32_bf16 v[108:111], a[164:167], v[44:47], v[108:111]
v_mfma_f32_16x16x32_bf16 v[124:127], a[164:167], v[60:63], v[124:127]
v_mfma_f32_16x16x32_bf16 v[140:143], a[164:167], v[76:79], v[140:143]
v_mfma_f32_16x16x32_bf16 v[92:95], a[168:171], v[32:35], v[92:95]
v_mfma_f32_16x16x32_bf16 v[108:111], a[168:171], v[48:51], v[108:111]
v_mfma_f32_16x16x32_bf16 v[124:127], a[168:171], v[64:67], v[124:127]
v_mfma_f32_16x16x32_bf16 v[140:143], a[168:171], v[80:83], v[140:143]
v_mfma_f32_16x16x32_bf16 v[92:95], a[172:175], v[36:39], v[92:95]
v_mfma_f32_16x16x32_bf16 v[108:111], a[172:175], v[52:55], v[108:111]
v_mfma_f32_16x16x32_bf16 v[124:127], a[172:175], v[68:71], v[124:127]
v_mfma_f32_16x16x32_bf16 v[140:143], a[172:175], v[84:87], v[140:143]
s_nop 7
v_max3_f32 v20, v20, v88, v89
v_max3_f32 v20, v20, v90, v91
v_max3_f32 v20, v20, v92, v93
v_max3_f32 v20, v20, v94, v95
v_max3_f32 v21, v21, v104, v105
v_max3_f32 v21, v21, v106, v107
v_max3_f32 v21, v21, v108, v109
v_max3_f32 v21, v21, v110, v111
v_max3_f32 v22, v22, v120, v121
v_max3_f32 v22, v22, v122, v123
v_max3_f32 v22, v22, v124, v125
v_max3_f32 v22, v22, v126, v127
v_max3_f32 v23, v23, v136, v137
v_max3_f32 v23, v23, v138, v139
v_max3_f32 v23, v23, v140, v141
v_max3_f32 v23, v23, v142, v143
s_add_u32 s81, s81, 16384
s_cmp_lt_u32 s81, s34
s_cbranch_scc1 L_fbl_1015
v_mov_b32 v248, v20
v_mov_b32 v249, v21
v_mov_b32 v250, v22
v_mov_b32 v251, v23
v_permlane16_swap_b32 v248, v20
v_permlane16_swap_b32 v249, v21
v_permlane16_swap_b32 v250, v22
v_permlane16_swap_b32 v251, v23
v_max_f32 v20, v20, v248
v_max_f32 v21, v21, v249
v_max_f32 v22, v22, v250
v_max_f32 v23, v23, v251
v_mov_b32 v248, v20
v_mov_b32 v249, v21
v_mov_b32 v250, v22
v_mov_b32 v251, v23
v_permlane32_swap_b32 v248, v20
v_permlane32_swap_b32 v249, v21
v_permlane32_swap_b32 v250, v22
v_permlane32_swap_b32 v251, v23
v_max_f32 v20, v20, v248
v_max_f32 v21, v21, v249
v_max_f32 v22, v22, v250
v_max_f32 v23, v23, v251
v_mov_b32 v252, v20
v_mov_b32 v253, v21
v_mov_b32 v254, v22
v_mov_b32 v255, v23
s_and_b32 s70, s30, 1
s_lshr_b32 s67, s30, 1
s_lshl3_add_u32 s71, s67, s70
s_add_u32 s71, s71, 4
s_lshl_b32 s71, s71, 13
s_lshl_b32 s70, s70, 14
s_mul_i32 s67, s67, 24576
s_sub_u32 s70, s70, s67
s_add_u32 s70, s70, 65536
s_branch L_attstart_7
L_spin_2016:
s_mov_b32 vcc_hi, 0x80000
L_spinlp_2018:
s_sleep 1
buffer_load_dword v19, off, s[52:55], s72 offset:0 sc1
s_waitcnt vmcnt(0)
v_readfirstlane_b32 vcc_lo, v19
s_sub_u32 vcc_hi, vcc_hi, 1
s_cbranch_scc1 L_spinbk_2017
s_cmp_lt_u32 vcc_lo, 8
s_cbranch_scc1 L_spinlp_2018
s_branch L_spinbk_2017
L_spin_3019:
s_mov_b32 vcc_hi, 0x80000
L_spinlp_3021:
s_sleep 1
buffer_load_dword v19, off, s[52:55], s72 offset:0 sc1
s_waitcnt vmcnt(0)
v_readfirstlane_b32 vcc_lo, v19
s_sub_u32 vcc_hi, vcc_hi, 1
s_cbranch_scc1 L_spinbk_3020
s_cmp_lt_u32 vcc_lo, 8
s_cbranch_scc1 L_spinlp_3021
s_branch L_spinbk_3020
L_p5f0:
s_waitcnt lgkmcnt(10)
s_waitcnt vmcnt(28)
v_mfma_f32_16x16x32_bf16 v[136:139], a[144:147], a[232:235], 0
s_waitcnt vmcnt(24)
s_waitcnt lgkmcnt(8)
s_add_u32 m0, s86, 65536
ds_read_b64_tr_b16 a[168:169], v191 offset:32768
v_xor_b32 v192, 0x10000, v184
v_mfma_f32_16x16x32_bf16 v[136:139], a[148:151], a[236:239], v[136:139]
s_add_u32 s64, s85, 524288
ds_read_b64_tr_b16 a[170:171], v191 offset:36864
v_xor_b32 v193, 0x10000, v185
v_mfma_f32_16x16x32_bf16 v[104:107], a[148:151], a[228:231], 0
buffer_load_dwordx4 v12, s[36:39], s64 offen lds
v_mfma_f32_16x16x32_bf16 v[104:107], a[144:147], a[224:227], v[104:107]
s_add_u32 m0, s86, 66560
s_add_u32 s64, s85, 532480
ds_read_b64_tr_b16 a[172:173], v191 offset:40960
v_xor_b32 v194, 0x10000, v186
v_mfma_f32_16x16x32_bf16 v[72:75], a[144:147], a[216:219], 0
s_and_b32 s71, s31, 4
buffer_load_dwordx4 v13, s[36:39], s64 offen lds
v_mfma_f32_16x16x32_bf16 v[72:75], a[148:151], a[220:223], v[72:75]
s_lshl_b32 s71, s71, 5
s_add_u32 s71, s71, s79
s_add_u32 m0, s86, 67584
s_add_u32 s64, s85, 540672
ds_read_b64_tr_b16 a[174:175], v191 offset:45056
v_mfma_f32_16x16x32_bf16 v[40:43], a[148:151], a[212:215], 0
s_add_u32 s71, s71, 4096
buffer_load_dwordx4 v12, s[36:39], s64 offen lds
v_mfma_f32_16x16x32_bf16 v[40:43], a[144:147], a[208:211], v[40:43]
s_waitcnt lgkmcnt(4)
s_add_u32 s72, s80, 4096
s_add_u32 m0, s86, 68608
s_add_u32 s64, s85, 548864
ds_read_b64_tr_b16 a[176:177], v184 offset:32768
v_xor_b32 v195, 0x10000, v187
v_mfma_f32_16x16x32_bf16 v[44:47], a[152:155], a[208:211], 0
buffer_load_dwordx4 v13, s[36:39], s64 offen lds
v_mfma_f32_16x16x32_bf16 v[44:47], a[156:159], a[212:215], v[44:47]
s_add_u32 m0, s86, 69632
ds_read_b64_tr_b16 a[178:179], v184 offset:36864
v_xor_b32 v196, 0x10000, v188
v_mfma_f32_16x16x32_bf16 v[76:79], a[156:159], a[220:223], 0
s_add_u32 s64, s85, 557056
ds_read_b64_tr_b16 a[180:181], v184 offset:40960
v_xor_b32 v197, 0x10000, v189
v_mfma_f32_16x16x32_bf16 v[76:79], a[152:155], a[216:219], v[76:79]
buffer_load_dwordx4 v12, s[36:39], s64 offen lds
v_mfma_f32_16x16x32_bf16 v[108:111], a[152:155], a[224:227], 0
s_add_u32 m0, s86, 70656
s_add_u32 s64, s85, 565248
ds_read_b64_tr_b16 a[182:183], v184 offset:45056
v_xor_b32 v198, 0x10000, v190
v_mfma_f32_16x16x32_bf16 v[108:111], a[156:159], a[228:231], v[108:111]
buffer_load_dwordx4 v13, s[36:39], s64 offen lds
v_mfma_f32_16x16x32_bf16 v[140:143], a[156:159], a[236:239], 0
s_add_u32 m0, s86, 71680
s_add_u32 s64, s85, 573440
ds_read_b64_tr_b16 a[184:185], v185 offset:32768
v_xor_b32 v199, 0x10000, v191
v_mfma_f32_16x16x32_bf16 v[140:143], a[152:155], a[232:235], v[140:143]
buffer_load_dwordx4 v12, s[36:39], s64 offen lds
v_mfma_f32_16x16x32_bf16 v[144:147], a[160:163], a[232:235], 0
s_add_u32 m0, s86, 72704
ds_read_b64_tr_b16 a[186:187], v185 offset:36864
v_mfma_f32_16x16x32_bf16 v[144:147], a[164:167], a[236:239], v[144:147]
s_add_u32 s64, s85, 581632
ds_read_b64_tr_b16 a[188:189], v185 offset:40960
v_mfma_f32_16x16x32_bf16 v[112:115], a[164:167], a[228:231], 0
buffer_load_dwordx4 v13, s[36:39], s64 offen lds
v_mfma_f32_16x16x32_bf16 v[112:115], a[160:163], a[224:227], v[112:115]
s_add_u32 s65, s84, 65536
ds_read_b64_tr_b16 a[190:191], v185 offset:45056
v_mfma_f32_16x16x32_bf16 v[80:83], a[160:163], a[216:219], 0
buffer_load_dwordx4 a[0:3], v14, s[44:47], s65 offen offset:0 sc1
v_mfma_f32_16x16x32_bf16 v[80:83], a[164:167], a[220:223], v[80:83]
ds_read_b64_tr_b16 a[192:193], v186 offset:32768
v_mfma_f32_16x16x32_bf16 v[48:51], a[164:167], a[212:215], 0
buffer_load_dwordx4 a[8:11], v14, s[44:47], s65 offen offset:1024 sc1
v_mfma_f32_16x16x32_bf16 v[48:51], a[160:163], a[208:211], v[48:51]
s_waitcnt lgkmcnt(4)
ds_read_b64_tr_b16 a[194:195], v186 offset:36864
v_mfma_f32_16x16x32_bf16 v[52:55], a[168:171], a[208:211], 0
ds_read_b64_tr_b16 a[196:197], v186 offset:40960
v_mfma_f32_16x16x32_bf16 v[52:55], a[172:175], a[212:215], v[52:55]
buffer_load_dwordx4 a[16:19], v15, s[44:47], s65 offen offset:0 sc1
v_mfma_f32_16x16x32_bf16 v[84:87], a[172:175], a[220:223], 0
ds_read_b64_tr_b16 a[198:199], v186 offset:45056
v_mfma_f32_16x16x32_bf16 v[84:87], a[168:171], a[216:219], v[84:87]
buffer_load_dwordx4 a[24:27], v15, s[44:47], s65 offen offset:1024 sc1
v_mfma_f32_16x16x32_bf16 v[116:119], a[168:171], a[224:227], 0
s_add_u32 s65, s84, 73728
ds_read_b64_tr_b16 a[200:201], v187 offset:32768
v_mfma_f32_16x16x32_bf16 v[116:119], a[172:175], a[228:231], v[116:119]
buffer_load_dwordx4 a[4:7], v14, s[44:47], s65 offen offset:0 sc1
v_mfma_f32_16x16x32_bf16 v[148:151], a[172:175], a[236:239], 0
ds_read_b64_tr_b16 a[202:203], v187 offset:36864
v_mfma_f32_16x16x32_bf16 v[148:151], a[168:171], a[232:235], v[148:151]
ds_read_b64_tr_b16 a[204:205], v187 offset:40960
v_mfma_f32_16x16x32_bf16 v[120:123], a[176:179], a[232:235], 0
buffer_load_dwordx4 a[12:15], v14, s[44:47], s65 offen offset:1024 sc1
v_mfma_f32_16x16x32_bf16 v[120:123], a[180:183], a[236:239], v[120:123]
ds_read_b64_tr_b16 a[206:207], v187 offset:45056
v_mfma_f32_16x16x32_bf16 v[88:91], a[180:183], a[228:231], 0
buffer_load_dwordx4 a[20:23], v15, s[44:47], s65 offen offset:0 sc1
v_mfma_f32_16x16x32_bf16 v[88:91], a[176:179], a[224:227], v[88:91]
v_mfma_f32_16x16x32_bf16 v[56:59], a[176:179], a[216:219], 0
buffer_load_dwordx4 a[28:31], v15, s[44:47], s65 offen offset:1024 sc1
v_mfma_f32_16x16x32_bf16 v[56:59], a[180:183], a[220:223], v[56:59]
v_mfma_f32_16x16x32_bf16 v[24:27], a[180:183], a[212:215], 0
v_mfma_f32_16x16x32_bf16 v[24:27], a[176:179], a[208:211], v[24:27]
s_waitcnt lgkmcnt(1)
v_mfma_f32_16x16x32_bf16 v[28:31], a[184:187], a[208:211], 0
s_waitcnt vmcnt(23)
s_barrier
v_mfma_f32_16x16x32_bf16 v[28:31], a[188:191], a[212:215], v[28:31]
ds_read_b64_tr_b16 a[144:145], v196 offset:0
v_mfma_f32_16x16x32_bf16 v[60:63], a[188:191], a[220:223], 0
ds_read_b64_tr_b16 a[146:147], v196 offset:4096
v_mfma_f32_16x16x32_bf16 v[60:63], a[184:187], a[216:219], v[60:63]
s_add_u32 m0, s86, 0
ds_read_b64_tr_b16 a[148:149], v196 offset:8192
v_mfma_f32_16x16x32_bf16 v[92:95], a[184:187], a[224:227], 0
s_add_u32 s64, s85, 786432
ds_read_b64_tr_b16 a[150:151], v196 offset:12288
v_mfma_f32_16x16x32_bf16 v[92:95], a[188:191], a[228:231], v[92:95]
buffer_load_dwordx4 v12, s[36:39], s64 offen lds
v_mfma_f32_16x16x32_bf16 v[124:127], a[188:191], a[236:239], 0
s_add_u32 m0, s86, 1024
ds_read_b64_tr_b16 a[152:153], v197 offset:0
v_mfma_f32_16x16x32_bf16 v[124:127], a[184:187], a[232:235], v[124:127]
s_add_u32 s64, s85, 794624
ds_read_b64_tr_b16 a[154:155], v197 offset:4096
v_mfma_f32_16x16x32_bf16 v[128:131], a[192:195], a[232:235], 0
buffer_load_dwordx4 v13, s[36:39], s64 offen lds
v_mfma_f32_16x16x32_bf16 v[128:131], a[196:199], a[236:239], v[128:131]
ds_read_b64_tr_b16 a[156:157], v197 offset:8192
v_mfma_f32_16x16x32_bf16 v[96:99], a[196:199], a[228:231], 0
s_add_u32 m0, s86, 2048
ds_read_b64_tr_b16 a[158:159], v197 offset:12288
v_mfma_f32_16x16x32_bf16 v[96:99], a[192:195], a[224:227], v[96:99]
s_add_u32 s64, s85, 802816
ds_read_b64_tr_b16 a[160:161], v198 offset:0
v_mfma_f32_16x16x32_bf16 v[64:67], a[192:195], a[216:219], 0
buffer_load_dwordx4 v12, s[36:39], s64 offen lds
v_mfma_f32_16x16x32_bf16 v[64:67], a[196:199], a[220:223], v[64:67]
ds_read_b64_tr_b16 a[162:163], v198 offset:4096
v_mfma_f32_16x16x32_bf16 v[32:35], a[196:199], a[212:215], 0
s_add_u32 m0, s86, 3072
ds_read_b64_tr_b16 a[164:165], v198 offset:8192
v_mfma_f32_16x16x32_bf16 v[32:35], a[192:195], a[208:211], v[32:35]
s_add_u32 s64, s85, 811008
ds_read_b64_tr_b16 a[166:167], v198 offset:12288
v_mfma_f32_16x16x32_bf16 v[36:39], a[200:203], a[208:211], 0
s_waitcnt lgkmcnt(6)
buffer_load_dwordx4 v13, s[36:39], s64 offen lds
v_mfma_f32_16x16x32_bf16 v[36:39], a[204:207], a[212:215], v[36:39]
v_mfma_f32_16x16x32_bf16 v[68:71], a[204:207], a[220:223], 0
s_add_u32 m0, s86, 4096
v_mfma_f32_16x16x32_bf16 v[68:71], a[200:203], a[216:219], v[68:71]
s_add_u32 s64, s85, 819200
v_mfma_f32_16x16x32_bf16 v[100:103], a[200:203], a[224:227], 0
buffer_load_dwordx4 v12, s[36:39], s64 offen lds
v_mfma_f32_16x16x32_bf16 v[100:103], a[204:207], a[228:231], v[100:103]
v_mfma_f32_16x16x32_bf16 v[132:135], a[204:207], a[236:239], 0
v_mfma_f32_16x16x32_bf16 v[132:135], a[200:203], a[232:235], v[132:135]
v_mfma_f32_16x16x32_bf16 v[136:139], a[144:147], v[176:179], v[136:139]
s_add_u32 m0, s86, 5120
ds_read_b64_tr_b16 a[168:169], v199 offset:0
v_xor_b32 v200, 0x18000, v184
v_mfma_f32_16x16x32_bf16 v[136:139], a[148:151], v[180:183], v[136:139]
s_add_u32 s64, s85, 827392
ds_read_b64_tr_b16 a[170:171], v199 offset:4096
v_xor_b32 v201, 0x18000, v185
v_mfma_f32_16x16x32_bf16 v[104:107], a[148:151], v[172:175], v[104:107]
buffer_load_dwordx4 v13, s[36:39], s64 offen lds
v_mfma_f32_16x16x32_bf16 v[104:107], a[144:147], v[168:171], v[104:107]
s_add_u32 m0, s86, 6144
ds_read_b64_tr_b16 a[172:173], v199 offset:8192
v_xor_b32 v202, 0x18000, v186
v_mfma_f32_16x16x32_bf16 v[72:75], a[144:147], v[160:163], v[72:75]
s_add_u32 s64, s85, 835584
ds_read_b64_tr_b16 a[174:175], v199 offset:12288
v_xor_b32 v203, 0x18000, v187
v_mfma_f32_16x16x32_bf16 v[72:75], a[148:151], v[164:167], v[72:75]
buffer_load_dwordx4 v12, s[36:39], s64 offen lds
v_mfma_f32_16x16x32_bf16 v[40:43], a[148:151], v[156:159], v[40:43]
s_add_u32 m0, s86, 7168
ds_read_b64_tr_b16 a[176:177], v192 offset:0
v_xor_b32 v204, 0x18000, v188
v_mfma_f32_16x16x32_bf16 v[40:43], a[144:147], v[152:155], v[40:43]
s_add_u32 s64, s85, 843776
ds_read_b64_tr_b16 a[178:179], v192 offset:4096
v_xor_b32 v205, 0x18000, v189
v_mfma_f32_16x16x32_bf16 v[44:47], a[152:155], v[152:155], v[44:47]
s_waitcnt lgkmcnt(5)
buffer_load_dwordx4 v13, s[36:39], s64 offen lds
v_mfma_f32_16x16x32_bf16 v[44:47], a[156:159], v[156:159], v[44:47]
ds_read_b64_tr_b16 a[180:181], v192 offset:8192
v_xor_b32 v206, 0x18000, v190
v_mfma_f32_16x16x32_bf16 v[76:79], a[156:159], v[164:167], v[76:79]
ds_read_b64_tr_b16 a[182:183], v192 offset:12288
v_xor_b32 v207, 0x18000, v191
v_mfma_f32_16x16x32_bf16 v[76:79], a[152:155], v[160:163], v[76:79]
s_add_u32 s65, s84, 98304
ds_read_b64_tr_b16 a[184:185], v193 offset:0
v_mfma_f32_16x16x32_bf16 v[108:111], a[152:155], v[168:171], v[108:111]
buffer_load_dwordx4 a[64:67], v14, s[44:47], s65 offen offset:0 sc1
v_mfma_f32_16x16x32_bf16 v[108:111], a[156:159], v[172:175], v[108:111]
ds_read_b64_tr_b16 a[186:187], v193 offset:4096
v_mfma_f32_16x16x32_bf16 v[140:143], a[156:159], v[180:183], v[140:143]
ds_read_b64_tr_b16 a[188:189], v193 offset:8192
v_mfma_f32_16x16x32_bf16 v[140:143], a[152:155], v[176:179], v[140:143]
buffer_load_dwordx4 a[72:75], v14, s[44:47], s65 offen offset:1024 sc1
v_mfma_f32_16x16x32_bf16 v[144:147], a[160:163], v[176:179], v[144:147]
ds_read_b64_tr_b16 a[190:191], v193 offset:12288
v_mfma_f32_16x16x32_bf16 v[144:147], a[164:167], v[180:183], v[144:147]
v_mfma_f32_16x16x32_bf16 v[112:115], a[164:167], v[172:175], v[112:115]
buffer_load_dwordx4 a[80:83], v15, s[44:47], s65 offen offset:0 sc1
v_mfma_f32_16x16x32_bf16 v[112:115], a[160:163], v[168:171], v[112:115]
ds_read_b64_tr_b16 a[192:193], v194 offset:0
v_mfma_f32_16x16x32_bf16 v[80:83], a[160:163], v[160:163], v[80:83]
ds_read_b64_tr_b16 a[194:195], v194 offset:4096
v_mfma_f32_16x16x32_bf16 v[80:83], a[164:167], v[164:167], v[80:83]
ds_read_b64_tr_b16 a[196:197], v194 offset:8192
v_mfma_f32_16x16x32_bf16 v[48:51], a[164:167], v[156:159], v[48:51]
buffer_load_dwordx4 a[88:91], v15, s[44:47], s65 offen offset:1024 sc1
v_mfma_f32_16x16x32_bf16 v[48:51], a[160:163], v[152:155], v[48:51]
s_waitcnt lgkmcnt(4)
ds_read_b64_tr_b16 a[198:199], v194 offset:12288
v_mfma_f32_16x16x32_bf16 v[52:55], a[168:171], v[152:155], v[52:55]
s_add_u32 s65, s84, 106496
v_mfma_f32_16x16x32_bf16 v[52:55], a[172:175], v[156:159], v[52:55]
buffer_load_dwordx4 a[68:71], v14, s[44:47], s65 offen offset:0 sc1
v_mfma_f32_16x16x32_bf16 v[84:87], a[172:175], v[164:167], v[84:87]
ds_read_b64_tr_b16 a[200:201], v195 offset:0
v_mfma_f32_16x16x32_bf16 v[84:87], a[168:171], v[160:163], v[84:87]
ds_read_b64_tr_b16 a[202:203], v195 offset:4096
v_mfma_f32_16x16x32_bf16 v[116:119], a[168:171], v[168:171], v[116:119]
s_lshl_b32 s66, s30, 30
buffer_load_dwordx4 a[76:79], v14, s[44:47], s65 offen offset:1024 sc1
v_mfma_f32_16x16x32_bf16 v[116:119], a[172:175], v[172:175], v[116:119]
ds_read_b64_tr_b16 a[204:205], v195 offset:8192
v_lshl_add_u32 v1, v0, 24, s66
v_mfma_f32_16x16x32_bf16 v[148:151], a[172:175], v[180:183], v[148:151]
ds_read_b64_tr_b16 a[206:207], v195 offset:12288
v_mfma_f32_16x16x32_bf16 v[148:151], a[168:171], v[176:179], v[148:151]
v_mfma_f32_16x16x32_bf16 v[120:123], a[176:179], v[176:179], v[120:123]
buffer_load_dwordx4 a[84:87], v15, s[44:47], s65 offen offset:0 sc1
v_mfma_f32_16x16x32_bf16 v[120:123], a[180:183], v[180:183], v[120:123]
v_mfma_f32_16x16x32_bf16 v[88:91], a[180:183], v[172:175], v[88:91]
v_mfma_f32_16x16x32_bf16 v[88:91], a[176:179], v[168:171], v[88:91]
buffer_load_dwordx4 a[92:95], v15, s[44:47], s65 offen offset:1024 sc1
v_mfma_f32_16x16x32_bf16 v[56:59], a[176:179], v[160:163], v[56:59]
v_mfma_f32_16x16x32_bf16 v[56:59], a[180:183], v[164:167], v[56:59]
v_mfma_f32_16x16x32_bf16 v[24:27], a[180:183], v[156:159], v[24:27]
v_mfma_f32_16x16x32_bf16 v[24:27], a[176:179], v[152:155], v[24:27]
v_mfma_f32_16x16x32_bf16 v[28:31], a[184:187], v[152:155], v[28:31]
s_waitcnt vmcnt(24)
s_barrier
s_waitcnt lgkmcnt(0)
v_mfma_f32_16x16x32_bf16 v[28:31], a[188:191], v[156:159], v[28:31]
s_mov_b64 exec, 1
buffer_atomic_add a251, v1, s[52:55], s71 offen offset:0 sc1
s_mov_b64 exec, -1
v_mfma_f32_16x16x32_bf16 v[60:63], a[188:191], v[164:167], v[60:63]
ds_read_b64_tr_b16 a[144:145], v196 offset:32768
v_mfma_f32_16x16x32_bf16 v[60:63], a[184:187], v[160:163], v[60:63]
s_add_u32 m0, s86, 98304
ds_read_b64_tr_b16 a[146:147], v196 offset:36864
v_mfma_f32_16x16x32_bf16 v[92:95], a[184:187], v[168:171], v[92:95]
s_add_u32 s64, s85, 1048576
ds_read_b64_tr_b16 a[148:149], v196 offset:40960
v_mfma_f32_16x16x32_bf16 v[92:95], a[188:191], v[172:175], v[92:95]
buffer_load_dwordx4 v12, s[36:39], s64 offen lds
v_mfma_f32_16x16x32_bf16 v[124:127], a[188:191], v[180:183], v[124:127]
s_add_u32 m0, s86, 99328
ds_read_b64_tr_b16 a[150:151], v196 offset:45056
v_mfma_f32_16x16x32_bf16 v[124:127], a[184:187], v[176:179], v[124:127]
s_add_u32 s64, s85, 1056768
ds_read_b64_tr_b16 a[152:153], v197 offset:32768
v_mfma_f32_16x16x32_bf16 v[128:131], a[192:195], v[176:179], v[128:131]
buffer_load_dwordx4 v13, s[36:39], s64 offen lds
v_mfma_f32_16x16x32_bf16 v[128:131], a[196:199], v[180:183], v[128:131]
ds_read_b64_tr_b16 a[154:155], v197 offset:36864
v_mfma_f32_16x16x32_bf16 v[96:99], a[196:199], v[172:175], v[96:99]
s_add_u32 m0, s86, 100352
ds_read_b64_tr_b16 a[156:157], v197 offset:40960
v_mfma_f32_16x16x32_bf16 v[96:99], a[192:195], v[168:171], v[96:99]
s_add_u32 s64, s85, 1064960
ds_read_b64_tr_b16 a[158:159], v197 offset:45056
v_mfma_f32_16x16x32_bf16 v[64:67], a[192:195], v[160:163], v[64:67]
buffer_load_dwordx4 v12, s[36:39], s64 offen lds
v_mfma_f32_16x16x32_bf16 v[64:67], a[196:199], v[164:167], v[64:67]
ds_read_b64_tr_b16 a[160:161], v198 offset:32768
v_mfma_f32_16x16x32_bf16 v[32:35], a[196:199], v[156:159], v[32:35]
s_add_u32 m0, s86, 101376
ds_read_b64_tr_b16 a[162:163], v198 offset:36864
v_mfma_f32_16x16x32_bf16 v[32:35], a[192:195], v[152:155], v[32:35]
s_add_u32 s64, s85, 1073152
ds_read_b64_tr_b16 a[164:165], v198 offset:40960
v_mfma_f32_16x16x32_bf16 v[36:39], a[200:203], v[152:155], v[36:39]
buffer_load_dwordx4 v13, s[36:39], s64 offen lds
v_mfma_f32_16x16x32_bf16 v[36:39], a[204:207], v[156:159], v[36:39]
ds_read_b64_tr_b16 a[166:167], v198 offset:45056
v_mfma_f32_16x16x32_bf16 v[68:71], a[204:207], v[164:167], v[68:71]
s_add_u32 m0, s86, 102400
v_mfma_f32_16x16x32_bf16 v[68:71], a[200:203], v[160:163], v[68:71]
s_add_u32 s64, s85, 1081344
v_mfma_f32_16x16x32_bf16 v[100:103], a[200:203], v[168:171], v[100:103]
buffer_load_dwordx4 v12, s[36:39], s64 offen lds
v_mfma_f32_16x16x32_bf16 v[100:103], a[204:207], v[172:175], v[100:103]
v_mfma_f32_16x16x32_bf16 v[132:135], a[204:207], v[180:183], v[132:135]
v_mfma_f32_16x16x32_bf16 v[132:135], a[200:203], v[176:179], v[132:135]
s_waitcnt vmcnt(26)
s_waitcnt lgkmcnt(1)
v_mfma_f32_16x16x32_bf16 v[136:139], a[144:147], a[24:27], v[136:139]
s_waitcnt vmcnt(22)
s_add_u32 m0, s86, 103424
ds_read_b64_tr_b16 a[168:169], v199 offset:32768
v_mfma_f32_16x16x32_bf16 v[136:139], a[148:151], a[28:31], v[136:139]
s_add_u32 s64, s85, 1089536
ds_read_b64_tr_b16 a[170:171], v199 offset:36864
v_mfma_f32_16x16x32_bf16 v[104:107], a[148:151], a[20:23], v[104:107]
buffer_load_dwordx4 v13, s[36:39], s64 offen lds
v_mfma_f32_16x16x32_bf16 v[104:107], a[144:147], a[16:19], v[104:107]
s_add_u32 m0, s86, 104448
ds_read_b64_tr_b16 a[172:173], v199 offset:40960
v_mfma_f32_16x16x32_bf16 v[72:75], a[144:147], a[8:11], v[72:75]
s_add_u32 s64, s85, 1097728
ds_read_b64_tr_b16 a[174:175], v199 offset:45056
v_mfma_f32_16x16x32_bf16 v[72:75], a[148:151], a[12:15], v[72:75]
buffer_load_dwordx4 v12, s[36:39], s64 offen lds
v_mfma_f32_16x16x32_bf16 v[40:43], a[148:151], a[4:7], v[40:43]
s_add_u32 m0, s86, 105472
ds_read_b64_tr_b16 a[176:177], v192 offset:32768
v_mfma_f32_16x16x32_bf16 v[40:43], a[144:147], a[0:3], v[40:43]
s_add_u32 s64, s85, 1105920
ds_read_b64_tr_b16 a[178:179], v192 offset:36864
v_mfma_f32_16x16x32_bf16 v[44:47], a[152:155], a[0:3], v[44:47]
buffer_load_dwordx4 v13, s[36:39], s64 offen lds
v_mfma_f32_16x16x32_bf16 v[44:47], a[156:159], a[4:7], v[44:47]
ds_read_b64_tr_b16 a[180:181], v192 offset:40960
v_mfma_f32_16x16x32_bf16 v[76:79], a[156:159], a[12:15], v[76:79]
ds_read_b64_tr_b16 a[182:183], v192 offset:45056
v_mfma_f32_16x16x32_bf16 v[76:79], a[152:155], a[8:11], v[76:79]
s_add_u32 s65, s84, 131072
ds_read_b64_tr_b16 a[184:185], v193 offset:32768
v_mfma_f32_16x16x32_bf16 v[108:111], a[152:155], a[16:19], v[108:111]
buffer_load_dwordx4 a[32:35], v14, s[44:47], s65 offen offset:0 sc1
v_mfma_f32_16x16x32_bf16 v[108:111], a[156:159], a[20:23], v[108:111]
ds_read_b64_tr_b16 a[186:187], v193 offset:36864
v_mfma_f32_16x16x32_bf16 v[140:143], a[156:159], a[28:31], v[140:143]
ds_read_b64_tr_b16 a[188:189], v193 offset:40960
v_mfma_f32_16x16x32_bf16 v[140:143], a[152:155], a[24:27], v[140:143]
buffer_load_dwordx4 a[40:43], v14, s[44:47], s65 offen offset:1024 sc1
v_mfma_f32_16x16x32_bf16 v[144:147], a[160:163], a[24:27], v[144:147]
s_waitcnt lgkmcnt(5)
ds_read_b64_tr_b16 a[190:191], v193 offset:45056
v_mfma_f32_16x16x32_bf16 v[144:147], a[164:167], a[28:31], v[144:147]
v_mfma_f32_16x16x32_bf16 v[112:115], a[164:167], a[20:23], v[112:115]
buffer_load_dwordx4 a[48:51], v15, s[44:47], s65 offen offset:0 sc1
v_mfma_f32_16x16x32_bf16 v[112:115], a[160:163], a[16:19], v[112:115]
ds_read_b64_tr_b16 a[192:193], v194 offset:32768
v_mfma_f32_16x16x32_bf16 v[80:83], a[160:163], a[8:11], v[80:83]
ds_read_b64_tr_b16 a[194:195], v194 offset:36864
v_mfma_f32_16x16x32_bf16 v[80:83], a[164:167], a[12:15], v[80:83]
ds_read_b64_tr_b16 a[196:197], v194 offset:40960
v_mfma_f32_16x16x32_bf16 v[48:51], a[164:167], a[4:7], v[48:51]
buffer_load_dwordx4 a[56:59], v15, s[44:47], s65 offen offset:1024 sc1
v_mfma_f32_16x16x32_bf16 v[48:51], a[160:163], a[0:3], v[48:51]
ds_read_b64_tr_b16 a[198:199], v194 offset:45056
v_mfma_f32_16x16x32_bf16 v[52:55], a[168:171], a[0:3], v[52:55]
s_add_u32 s65, s84, 139264
v_mfma_f32_16x16x32_bf16 v[52:55], a[172:175], a[4:7], v[52:55]
buffer_load_dwordx4 a[36:39], v14, s[44:47], s65 offen offset:0 sc1
v_mfma_f32_16x16x32_bf16 v[84:87], a[172:175], a[12:15], v[84:87]
ds_read_b64_tr_b16 a[200:201], v195 offset:32768
v_mfma_f32_16x16x32_bf16 v[84:87], a[168:171], a[8:11], v[84:87]
ds_read_b64_tr_b16 a[202:203], v195 offset:36864
v_mfma_f32_16x16x32_bf16 v[116:119], a[168:171], a[16:19], v[116:119]
buffer_load_dwordx4 a[44:47], v14, s[44:47], s65 offen offset:1024 sc1
v_mfma_f32_16x16x32_bf16 v[116:119], a[172:175], a[20:23], v[116:119]
ds_read_b64_tr_b16 a[204:205], v195 offset:40960
v_mfma_f32_16x16x32_bf16 v[148:151], a[172:175], a[28:31], v[148:151]
ds_read_b64_tr_b16 a[206:207], v195 offset:45056
v_mfma_f32_16x16x32_bf16 v[148:151], a[168:171], a[24:27], v[148:151]
v_mfma_f32_16x16x32_bf16 v[120:123], a[176:179], a[24:27], v[120:123]
s_waitcnt lgkmcnt(4)
buffer_load_dwordx4 a[52:55], v15, s[44:47], s65 offen offset:0 sc1
v_mfma_f32_16x16x32_bf16 v[120:123], a[180:183], a[28:31], v[120:123]
v_mfma_f32_16x16x32_bf16 v[88:91], a[180:183], a[20:23], v[88:91]
v_mfma_f32_16x16x32_bf16 v[88:91], a[176:179], a[16:19], v[88:91]
buffer_load_dwordx4 a[60:63], v15, s[44:47], s65 offen offset:1024 sc1
v_mfma_f32_16x16x32_bf16 v[56:59], a[176:179], a[8:11], v[56:59]
v_mfma_f32_16x16x32_bf16 v[56:59], a[180:183], a[12:15], v[56:59]
v_mfma_f32_16x16x32_bf16 v[24:27], a[180:183], a[4:7], v[24:27]
v_mfma_f32_16x16x32_bf16 v[24:27], a[176:179], a[0:3], v[24:27]
v_mfma_f32_16x16x32_bf16 v[28:31], a[184:187], a[0:3], v[28:31]
s_waitcnt vmcnt(25)
s_barrier
v_mfma_f32_16x16x32_bf16 v[28:31], a[188:191], a[4:7], v[28:31]
ds_read_b64_tr_b16 a[144:145], v204 offset:0
v_mfma_f32_16x16x32_bf16 v[60:63], a[188:191], a[12:15], v[60:63]
ds_read_b64_tr_b16 a[146:147], v204 offset:4096
v_mfma_f32_16x16x32_bf16 v[60:63], a[184:187], a[8:11], v[60:63]
s_add_u32 m0, s86, 131072
ds_read_b64_tr_b16 a[148:149], v204 offset:8192
v_mfma_f32_16x16x32_bf16 v[92:95], a[184:187], a[16:19], v[92:95]
s_add_u32 s64, s85, 0
ds_read_b64_tr_b16 a[150:151], v204 offset:12288
v_mfma_f32_16x16x32_bf16 v[92:95], a[188:191], a[20:23], v[92:95]
buffer_load_dwordx4 v12, s[40:43], s64 offen lds
v_mfma_f32_16x16x32_bf16 v[124:127], a[188:191], a[28:31], v[124:127]
s_add_u32 m0, s86, 132096
ds_read_b64_tr_b16 a[152:153], v205 offset:0
v_mfma_f32_16x16x32_bf16 v[124:127], a[184:187], a[24:27], v[124:127]
s_add_u32 s64, s85, 8192
ds_read_b64_tr_b16 a[154:155], v205 offset:4096
v_mfma_f32_16x16x32_bf16 v[128:131], a[192:195], a[24:27], v[128:131]
buffer_load_dwordx4 v13, s[40:43], s64 offen lds
v_mfma_f32_16x16x32_bf16 v[128:131], a[196:199], a[28:31], v[128:131]
ds_read_b64_tr_b16 a[156:157], v205 offset:8192
v_mfma_f32_16x16x32_bf16 v[96:99], a[196:199], a[20:23], v[96:99]
s_add_u32 m0, s86, 133120
ds_read_b64_tr_b16 a[158:159], v205 offset:12288
v_mfma_f32_16x16x32_bf16 v[96:99], a[192:195], a[16:19], v[96:99]
s_add_u32 s64, s85, 16384
ds_read_b64_tr_b16 a[160:161], v206 offset:0
v_mfma_f32_16x16x32_bf16 v[64:67], a[192:195], a[8:11], v[64:67]
buffer_load_dwordx4 v12, s[40:43], s64 offen lds
v_mfma_f32_16x16x32_bf16 v[64:67], a[196:199], a[12:15], v[64:67]
ds_read_b64_tr_b16 a[162:163], v206 offset:4096
v_mfma_f32_16x16x32_bf16 v[32:35], a[196:199], a[4:7], v[32:35]
s_add_u32 m0, s86, 134144
ds_read_b64_tr_b16 a[164:165], v206 offset:8192
v_mfma_f32_16x16x32_bf16 v[32:35], a[192:195], a[0:3], v[32:35]
s_waitcnt lgkmcnt(5)
s_add_u32 s64, s85, 24576
ds_read_b64_tr_b16 a[166:167], v206 offset:12288
v_mfma_f32_16x16x32_bf16 v[36:39], a[200:203], a[0:3], v[36:39]
buffer_load_dwordx4 v13, s[40:43], s64 offen lds
v_mfma_f32_16x16x32_bf16 v[36:39], a[204:207], a[4:7], v[36:39]
v_mfma_f32_16x16x32_bf16 v[68:71], a[204:207], a[12:15], v[68:71]
s_add_u32 m0, s86, 135168
v_mfma_f32_16x16x32_bf16 v[68:71], a[200:203], a[8:11], v[68:71]
s_add_u32 s64, s85, 32768
v_mfma_f32_16x16x32_bf16 v[100:103], a[200:203], a[16:19], v[100:103]
buffer_load_dwordx4 v12, s[40:43], s64 offen lds
v_mfma_f32_16x16x32_bf16 v[100:103], a[204:207], a[20:23], v[100:103]
v_mfma_f32_16x16x32_bf16 v[132:135], a[204:207], a[28:31], v[132:135]
v_mfma_f32_16x16x32_bf16 v[132:135], a[200:203], a[24:27], v[132:135]
s_waitcnt vmcnt(26)
v_mfma_f32_16x16x32_bf16 v[136:139], a[144:147], a[88:91], v[136:139]
s_waitcnt vmcnt(22)
s_add_u32 m0, s86, 136192
ds_read_b64_tr_b16 a[168:169], v207 offset:0
v_mfma_f32_16x16x32_bf16 v[136:139], a[148:151], a[92:95], v[136:139]
s_add_u32 s64, s85, 40960
ds_read_b64_tr_b16 a[170:171], v207 offset:4096
v_mfma_f32_16x16x32_bf16 v[104:107], a[148:151], a[84:87], v[104:107]
buffer_load_dwordx4 v13, s[40:43], s64 offen lds
v_mfma_f32_16x16x32_bf16 v[104:107], a[144:147], a[80:83], v[104:107]
ds_read_b64_tr_b16 a[172:173], v207 offset:8192
v_mfma_f32_16x16x32_bf16 v[72:75], a[144:147], a[72:75], v[72:75]
ds_read_b64_tr_b16 a[174:175], v207 offset:12288
v_mfma_f32_16x16x32_bf16 v[72:75], a[148:151], a[76:79], v[72:75]
ds_read_b64_tr_b16 a[176:177], v200 offset:0
v_mfma_f32_16x16x32_bf16 v[40:43], a[148:151], a[68:71], v[40:43]
ds_read_b64_tr_b16 a[178:179], v200 offset:4096
v_mfma_f32_16x16x32_bf16 v[40:43], a[144:147], a[64:67], v[40:43]
ds_read_b64_tr_b16 a[180:181], v200 offset:8192
v_mfma_f32_16x16x32_bf16 v[44:47], a[152:155], a[64:67], v[44:47]
s_waitcnt lgkmcnt(6)
s_add_u32 m0, s86, 137216
ds_read_b64_tr_b16 a[182:183], v200 offset:12288
v_mfma_f32_16x16x32_bf16 v[44:47], a[156:159], a[68:71], v[44:47]
s_add_u32 s64, s85, 49152
v_mfma_f32_16x16x32_bf16 v[76:79], a[156:159], a[76:79], v[76:79]
buffer_load_dwordx4 v12, s[40:43], s64 offen lds
v_mfma_f32_16x16x32_bf16 v[76:79], a[152:155], a[72:75], v[76:79]
ds_read_b64_tr_b16 a[184:185], v201 offset:0
v_mfma_f32_16x16x32_bf16 v[108:111], a[152:155], a[80:83], v[108:111]
ds_read_b64_tr_b16 a[186:187], v201 offset:4096
v_mfma_f32_16x16x32_bf16 v[108:111], a[156:159], a[84:87], v[108:111]
ds_read_b64_tr_b16 a[188:189], v201 offset:8192
v_mfma_f32_16x16x32_bf16 v[140:143], a[156:159], a[92:95], v[140:143]
ds_read_b64_tr_b16 a[190:191], v201 offset:12288
v_mfma_f32_16x16x32_bf16 v[140:143], a[152:155], a[88:91], v[140:143]
v_mfma_f32_16x16x32_bf16 v[144:147], a[160:163], a[88:91], v[144:147]
v_mfma_f32_16x16x32_bf16 v[144:147], a[164:167], a[92:95], v[144:147]
s_add_u32 m0, s86, 138240
s_add_u32 s17, s78, L_p5loop-L_pc+0
v_mfma_f32_16x16x32_bf16 v[112:115], a[164:167], a[84:87], v[112:115]
s_add_u32 s64, s85, 57344
buffer_load_dword a252, v16, s[88:91], s17 offen
v_mfma_f32_16x16x32_bf16 v[112:115], a[160:163], a[80:83], v[112:115]
buffer_load_dwordx4 v13, s[40:43], s64 offen lds
v_mfma_f32_16x16x32_bf16 v[80:83], a[160:163], a[72:75], v[80:83]
s_add_u32 s17, s78, L_p5loop-L_pc+4096
ds_read_b64_tr_b16 a[192:193], v202 offset:0
v_mfma_f32_16x16x32_bf16 v[80:83], a[164:167], a[76:79], v[80:83]
buffer_load_dword a252, v16, s[88:91], s17 offen
v_mfma_f32_16x16x32_bf16 v[48:51], a[164:167], a[68:71], v[48:51]
ds_read_b64_tr_b16 a[194:195], v202 offset:4096
v_mfma_f32_16x16x32_bf16 v[48:51], a[160:163], a[64:67], v[48:51]
s_waitcnt lgkmcnt(2)
s_add_u32 s17, s78, L_p5loop-L_pc+8192
ds_read_b64_tr_b16 a[196:197], v202 offset:8192
v_mfma_f32_16x16x32_bf16 v[52:55], a[168:171], a[64:67], v[52:55]
buffer_load_dword a252, v16, s[88:91], s17 offen
v_mfma_f32_16x16x32_bf16 v[52:55], a[172:175], a[68:71], v[52:55]
ds_read_b64_tr_b16 a[198:199], v202 offset:12288
v_mfma_f32_16x16x32_bf16 v[84:87], a[172:175], a[76:79], v[84:87]
ds_read_b64_tr_b16 a[200:201], v203 offset:0
v_mfma_f32_16x16x32_bf16 v[84:87], a[168:171], a[72:75], v[84:87]
ds_read_b64_tr_b16 a[202:203], v203 offset:4096
v_mfma_f32_16x16x32_bf16 v[116:119], a[168:171], a[80:83], v[116:119]
ds_read_b64_tr_b16 a[204:205], v203 offset:8192
v_mfma_f32_16x16x32_bf16 v[116:119], a[172:175], a[84:87], v[116:119]
ds_read_b64_tr_b16 a[206:207], v203 offset:12288
v_mfma_f32_16x16x32_bf16 v[148:151], a[172:175], a[92:95], v[148:151]
buffer_load_dword v19, off, s[52:55], s72 sc1
v_mfma_f32_16x16x32_bf16 v[148:151], a[168:171], a[88:91], v[148:151]
v_mfma_f32_16x16x32_bf16 v[120:123], a[176:179], a[88:91], v[120:123]
v_mfma_f32_16x16x32_bf16 v[120:123], a[180:183], a[92:95], v[120:123]
v_mfma_f32_16x16x32_bf16 v[88:91], a[180:183], a[84:87], v[88:91]
v_mfma_f32_16x16x32_bf16 v[88:91], a[176:179], a[80:83], v[88:91]
v_mfma_f32_16x16x32_bf16 v[56:59], a[176:179], a[72:75], v[56:59]
v_mfma_f32_16x16x32_bf16 v[56:59], a[180:183], a[76:79], v[56:59]
v_mfma_f32_16x16x32_bf16 v[24:27], a[180:183], a[68:71], v[24:27]
v_mfma_f32_16x16x32_bf16 v[24:27], a[176:179], a[64:67], v[24:27]
v_mfma_f32_16x16x32_bf16 v[28:31], a[184:187], a[64:67], v[28:31]
s_waitcnt vmcnt(20)
s_barrier
v_mfma_f32_16x16x32_bf16 v[28:31], a[188:191], a[68:71], v[28:31]
ds_read_b64_tr_b16 a[144:145], v188 offset:0
v_mfma_f32_16x16x32_bf16 v[60:63], a[188:191], a[76:79], v[60:63]
ds_read_b64_tr_b16 a[146:147], v188 offset:4096
v_mfma_f32_16x16x32_bf16 v[60:63], a[184:187], a[72:75], v[60:63]
s_add_u32 m0, s86, 32768
ds_read_b64_tr_b16 a[148:149], v188 offset:8192
v_mfma_f32_16x16x32_bf16 v[92:95], a[184:187], a[80:83], v[92:95]
s_add_u32 s64, s85, 262144
ds_read_b64_tr_b16 a[150:151], v188 offset:12288
v_mfma_f32_16x16x32_bf16 v[92:95], a[188:191], a[84:87], v[92:95]
buffer_load_dwordx4 v12, s[40:43], s64 offen lds
v_mfma_f32_16x16x32_bf16 v[124:127], a[188:191], a[92:95], v[124:127]
s_add_u32 m0, s86, 33792
ds_read_b64_tr_b16 a[152:153], v189 offset:0
v_mfma_f32_16x16x32_bf16 v[124:127], a[184:187], a[88:91], v[124:127]
s_waitcnt lgkmcnt(5)
s_add_u32 s64, s85, 270336
ds_read_b64_tr_b16 a[154:155], v189 offset:4096
v_mfma_f32_16x16x32_bf16 v[128:131], a[192:195], a[88:91], v[128:131]
buffer_load_dwordx4 v13, s[40:43], s64 offen lds
v_mfma_f32_16x16x32_bf16 v[128:131], a[196:199], a[92:95], v[128:131]
s_add_u32 m0, s86, 34816
ds_read_b64_tr_b16 a[156:157], v189 offset:8192
v_mfma_f32_16x16x32_bf16 v[96:99], a[196:199], a[84:87], v[96:99]
s_add_u32 s64, s85, 278528
ds_read_b64_tr_b16 a[158:159], v189 offset:12288
v_mfma_f32_16x16x32_bf16 v[96:99], a[192:195], a[80:83], v[96:99]
buffer_load_dwordx4 v12, s[40:43], s64 offen lds
v_mfma_f32_16x16x32_bf16 v[64:67], a[192:195], a[72:75], v[64:67]
s_add_u32 m0, s86, 35840
ds_read_b64_tr_b16 a[160:161], v190 offset:0
v_mfma_f32_16x16x32_bf16 v[64:67], a[196:199], a[76:79], v[64:67]
s_add_u32 s64, s85, 286720
ds_read_b64_tr_b16 a[162:163], v190 offset:4096
v_mfma_f32_16x16x32_bf16 v[32:35], a[196:199], a[68:71], v[32:35]
buffer_load_dwordx4 v13, s[40:43], s64 offen lds
v_mfma_f32_16x16x32_bf16 v[32:35], a[192:195], a[64:67], v[32:35]
s_add_u32 m0, s86, 36864
ds_read_b64_tr_b16 a[164:165], v190 offset:8192
v_mfma_f32_16x16x32_bf16 v[36:39], a[200:203], a[64:67], v[36:39]
s_add_u32 s64, s85, 294912
ds_read_b64_tr_b16 a[166:167], v190 offset:12288
v_mfma_f32_16x16x32_bf16 v[36:39], a[204:207], a[68:71], v[36:39]
buffer_load_dwordx4 v12, s[40:43], s64 offen lds
v_mfma_f32_16x16x32_bf16 v[68:71], a[204:207], a[76:79], v[68:71]
s_add_u32 m0, s86, 37888
v_mfma_f32_16x16x32_bf16 v[68:71], a[200:203], a[72:75], v[68:71]
s_add_u32 s64, s85, 303104
v_mfma_f32_16x16x32_bf16 v[100:103], a[200:203], a[80:83], v[100:103]
buffer_load_dwordx4 v13, s[40:43], s64 offen lds
v_mfma_f32_16x16x32_bf16 v[100:103], a[204:207], a[84:87], v[100:103]
v_mfma_f32_16x16x32_bf16 v[132:135], a[204:207], a[92:95], v[132:135]
v_mfma_f32_16x16x32_bf16 v[132:135], a[200:203], a[88:91], v[132:135]
s_waitcnt vmcnt(22)
s_waitcnt lgkmcnt(1)
v_mfma_f32_16x16x32_bf16 v[136:139], a[144:147], a[56:59], v[136:139]
s_waitcnt vmcnt(6)
v_readfirstlane_b32 vcc_lo, v19
s_nop 0
s_cmp_lt_u32 vcc_lo, 8
s_cbranch_scc1 L_spin_3019
L_spinbk_3020:
s_sub_u32 s84, s84, 1048576
v_mfma_f32_16x16x32_bf16 v[136:139], a[148:151], a[60:63], v[136:139]
s_add_u32 s65, s84, 0
ds_read_b64_tr_b16 a[168:169], v191 offset:0
v_mfma_f32_16x16x32_bf16 v[104:107], a[148:151], a[52:55], v[104:107]
buffer_load_dwordx4 a[208:211], v14, s[44:47], s65 offen offset:0 sc1
v_mfma_f32_16x16x32_bf16 v[104:107], a[144:147], a[48:51], v[104:107]
ds_read_b64_tr_b16 a[170:171], v191 offset:4096
v_mfma_f32_16x16x32_bf16 v[72:75], a[144:147], a[40:43], v[72:75]
buffer_load_dwordx4 a[216:219], v14, s[44:47], s65 offen offset:1024 sc1
v_mfma_f32_16x16x32_bf16 v[72:75], a[148:151], a[44:47], v[72:75]
ds_read_b64_tr_b16 a[172:173], v191 offset:8192
v_mfma_f32_16x16x32_bf16 v[40:43], a[148:151], a[36:39], v[40:43]
buffer_load_dwordx4 a[224:227], v15, s[44:47], s65 offen offset:0 sc1
v_mfma_f32_16x16x32_bf16 v[40:43], a[144:147], a[32:35], v[40:43]
ds_read_b64_tr_b16 a[174:175], v191 offset:12288
v_mfma_f32_16x16x32_bf16 v[44:47], a[152:155], a[32:35], v[44:47]
buffer_load_dwordx4 a[232:235], v15, s[44:47], s65 offen offset:1024 sc1
v_mfma_f32_16x16x32_bf16 v[44:47], a[156:159], a[36:39], v[44:47]
s_add_u32 s65, s84, 8192
ds_read_b64_tr_b16 a[176:177], v184 offset:0
v_mfma_f32_16x16x32_bf16 v[76:79], a[156:159], a[44:47], v[76:79]
buffer_load_dwordx4 a[212:215], v14, s[44:47], s65 offen offset:0 sc1
v_mfma_f32_16x16x32_bf16 v[76:79], a[152:155], a[40:43], v[76:79]
ds_read_b64_tr_b16 a[178:179], v184 offset:4096
v_mfma_f32_16x16x32_bf16 v[108:111], a[152:155], a[48:51], v[108:111]
buffer_load_dwordx4 a[220:223], v14, s[44:47], s65 offen offset:1024 sc1
v_mfma_f32_16x16x32_bf16 v[108:111], a[156:159], a[52:55], v[108:111]
ds_read_b64_tr_b16 a[180:181], v184 offset:8192
v_mfma_f32_16x16x32_bf16 v[140:143], a[156:159], a[60:63], v[140:143]
buffer_load_dwordx4 a[228:231], v15, s[44:47], s65 offen offset:0 sc1
v_mfma_f32_16x16x32_bf16 v[140:143], a[152:155], a[56:59], v[140:143]
ds_read_b64_tr_b16 a[182:183], v184 offset:12288
v_mfma_f32_16x16x32_bf16 v[144:147], a[160:163], a[56:59], v[144:147]
s_waitcnt lgkmcnt(4)
buffer_load_dwordx4 a[236:239], v15, s[44:47], s65 offen offset:1024 sc1
v_mfma_f32_16x16x32_bf16 v[144:147], a[164:167], a[60:63], v[144:147]
s_add_u32 m0, s86, 38912
s_add_u32 s64, s85, 311296
ds_read_b64_tr_b16 a[184:185], v185 offset:0
v_mfma_f32_16x16x32_bf16 v[112:115], a[164:167], a[52:55], v[112:115]
buffer_load_dwordx4 v12, s[40:43], s64 offen lds
v_mfma_f32_16x16x32_bf16 v[112:115], a[160:163], a[48:51], v[112:115]
s_add_u32 m0, s86, 39936
s_add_u32 s64, s85, 319488
ds_read_b64_tr_b16 a[186:187], v185 offset:4096
v_mfma_f32_16x16x32_bf16 v[80:83], a[160:163], a[40:43], v[80:83]
buffer_load_dwordx4 v13, s[40:43], s64 offen lds
v_mfma_f32_16x16x32_bf16 v[80:83], a[164:167], a[44:47], v[80:83]
s_add_u32 s65, s84, 32768
ds_read_b64_tr_b16 a[188:189], v185 offset:8192
v_mfma_f32_16x16x32_bf16 v[48:51], a[164:167], a[36:39], v[48:51]
buffer_load_dwordx4 v[152:155], v14, s[44:47], s65 offen offset:0 sc1
v_mfma_f32_16x16x32_bf16 v[48:51], a[160:163], a[32:35], v[48:51]
ds_read_b64_tr_b16 a[190:191], v185 offset:12288
v_mfma_f32_16x16x32_bf16 v[52:55], a[168:171], a[32:35], v[52:55]
buffer_load_dwordx4 v[160:163], v14, s[44:47], s65 offen offset:1024 sc1
v_mfma_f32_16x16x32_bf16 v[52:55], a[172:175], a[36:39], v[52:55]
ds_read_b64_tr_b16 a[192:193], v186 offset:0
v_mfma_f32_16x16x32_bf16 v[84:87], a[172:175], a[44:47], v[84:87]
buffer_load_dwordx4 v[168:171], v15, s[44:47], s65 offen offset:0 sc1
v_mfma_f32_16x16x32_bf16 v[84:87], a[168:171], a[40:43], v[84:87]
ds_read_b64_tr_b16 a[194:195], v186 offset:4096
v_mfma_f32_16x16x32_bf16 v[116:119], a[168:171], a[48:51], v[116:119]
buffer_load_dwordx4 v[176:179], v15, s[44:47], s65 offen offset:1024 sc1
v_mfma_f32_16x16x32_bf16 v[116:119], a[172:175], a[52:55], v[116:119]
s_add_u32 s65, s84, 40960
ds_read_b64_tr_b16 a[196:197], v186 offset:8192
v_mfma_f32_16x16x32_bf16 v[148:151], a[172:175], a[60:63], v[148:151]
buffer_load_dwordx4 v[156:159], v14, s[44:47], s65 offen offset:0 sc1
v_mfma_f32_16x16x32_bf16 v[148:151], a[168:171], a[56:59], v[148:151]
s_waitcnt lgkmcnt(3)
ds_read_b64_tr_b16 a[198:199], v186 offset:12288
v_mfma_f32_16x16x32_bf16 v[120:123], a[176:179], a[56:59], v[120:123]
buffer_load_dwordx4 v[164:167], v14, s[44:47], s65 offen offset:1024 sc1
v_mfma_f32_16x16x32_bf16 v[120:123], a[180:183], a[60:63], v[120:123]
ds_read_b64_tr_b16 a[200:201], v187 offset:0
v_mfma_f32_16x16x32_bf16 v[88:91], a[180:183], a[52:55], v[88:91]
buffer_load_dwordx4 v[172:175], v15, s[44:47], s65 offen offset:0 sc1
v_mfma_f32_16x16x32_bf16 v[88:91], a[176:179], a[48:51], v[88:91]
ds_read_b64_tr_b16 a[202:203], v187 offset:4096
v_mfma_f32_16x16x32_bf16 v[56:59], a[176:179], a[40:43], v[56:59]
buffer_load_dwordx4 v[180:183], v15, s[44:47], s65 offen offset:1024 sc1
v_mfma_f32_16x16x32_bf16 v[56:59], a[180:183], a[44:47], v[56:59]
ds_read_b64_tr_b16 a[204:205], v187 offset:8192
v_mfma_f32_16x16x32_bf16 v[24:27], a[180:183], a[36:39], v[24:27]
ds_read_b64_tr_b16 a[206:207], v187 offset:12288
v_mfma_f32_16x16x32_bf16 v[24:27], a[176:179], a[32:35], v[24:27]
v_mfma_f32_16x16x32_bf16 v[28:31], a[184:187], a[32:35], v[28:31]
s_barrier
v_mfma_f32_16x16x32_bf16 v[28:31], a[188:191], a[36:39], v[28:31]
ds_read_b64_tr_b16 a[144:145], v188 offset:32768
v_mfma_f32_16x16x32_bf16 v[60:63], a[188:191], a[44:47], v[60:63]
ds_read_b64_tr_b16 a[146:147], v188 offset:36864
v_mfma_f32_16x16x32_bf16 v[60:63], a[184:187], a[40:43], v[60:63]
s_add_u32 m0, s86, 65536
ds_read_b64_tr_b16 a[148:149], v188 offset:40960
v_mfma_f32_16x16x32_bf16 v[92:95], a[184:187], a[48:51], v[92:95]
s_add_u32 s64, s85, 524288
ds_read_b64_tr_b16 a[150:151], v188 offset:45056
v_mfma_f32_16x16x32_bf16 v[92:95], a[188:191], a[52:55], v[92:95]
buffer_load_dwordx4 v12, s[40:43], s64 offen lds
v_mfma_f32_16x16x32_bf16 v[124:127], a[188:191], a[60:63], v[124:127]
s_add_u32 m0, s86, 66560
ds_read_b64_tr_b16 a[152:153], v189 offset:32768
v_mfma_f32_16x16x32_bf16 v[124:127], a[184:187], a[56:59], v[124:127]
s_waitcnt lgkmcnt(5)
s_add_u32 s64, s85, 532480
ds_read_b64_tr_b16 a[154:155], v189 offset:36864
v_mfma_f32_16x16x32_bf16 v[128:131], a[192:195], a[56:59], v[128:131]
buffer_load_dwordx4 v13, s[40:43], s64 offen lds
v_mfma_f32_16x16x32_bf16 v[128:131], a[196:199], a[60:63], v[128:131]
ds_read_b64_tr_b16 a[156:157], v189 offset:40960
v_mfma_f32_16x16x32_bf16 v[96:99], a[196:199], a[52:55], v[96:99]
s_add_u32 m0, s86, 67584
ds_read_b64_tr_b16 a[158:159], v189 offset:45056
v_mfma_f32_16x16x32_bf16 v[96:99], a[192:195], a[48:51], v[96:99]
s_add_u32 s64, s85, 540672
ds_read_b64_tr_b16 a[160:161], v190 offset:32768
v_mfma_f32_16x16x32_bf16 v[64:67], a[192:195], a[40:43], v[64:67]
buffer_load_dwordx4 v12, s[40:43], s64 offen lds
v_mfma_f32_16x16x32_bf16 v[64:67], a[196:199], a[44:47], v[64:67]
ds_read_b64_tr_b16 a[162:163], v190 offset:36864
v_mfma_f32_16x16x32_bf16 v[32:35], a[196:199], a[36:39], v[32:35]
s_add_u32 m0, s86, 68608
ds_read_b64_tr_b16 a[164:165], v190 offset:40960
v_mfma_f32_16x16x32_bf16 v[32:35], a[192:195], a[32:35], v[32:35]
s_add_u32 s64, s85, 548864
ds_read_b64_tr_b16 a[166:167], v190 offset:45056
v_mfma_f32_16x16x32_bf16 v[36:39], a[200:203], a[32:35], v[36:39]
buffer_load_dwordx4 v13, s[40:43], s64 offen lds
v_mfma_f32_16x16x32_bf16 v[36:39], a[204:207], a[36:39], v[36:39]
v_mfma_f32_16x16x32_bf16 v[68:71], a[204:207], a[44:47], v[68:71]
s_add_u32 m0, s86, 69632
v_mfma_f32_16x16x32_bf16 v[68:71], a[200:203], a[40:43], v[68:71]
s_add_u32 s64, s85, 557056
v_mfma_f32_16x16x32_bf16 v[100:103], a[200:203], a[48:51], v[100:103]
buffer_load_dwordx4 v12, s[40:43], s64 offen lds
v_mfma_f32_16x16x32_bf16 v[100:103], a[204:207], a[52:55], v[100:103]
s_mov_b32 s70, 3
s_mov_b32 s73, 2
v_mfma_f32_16x16x32_bf16 v[132:135], a[204:207], a[60:63], v[132:135]
v_mfma_f32_16x16x32_bf16 v[132:135], a[200:203], a[56:59], v[132:135]
s_branch L_p5join
L_spin_4022:
s_mov_b32 vcc_hi, 0x80000
L_spinlp_4024:
s_sleep 1
buffer_load_dword v19, off, s[52:55], s72 offset:128 sc1
s_waitcnt vmcnt(0)
v_readfirstlane_b32 vcc_lo, v19
s_sub_u32 vcc_hi, vcc_hi, 1
s_cbranch_scc1 L_spinbk_4023
s_cmp_lt_u32 vcc_lo, s74
s_cbranch_scc1 L_spinlp_4024
s_branch L_spinbk_4023
L_xretry:
s_sub_u32 s72, s72, 1
s_cbranch_scc1 L_xgo
buffer_load_dwordx4 v[152:155], v16, s[44:47], s75 offen offset:0 sc1
buffer_load_dwordx4 v[156:159], v16, s[44:47], s75 offen offset:1024 sc1
buffer_load_dwordx4 v[160:163], v16, s[44:47], s75 offen offset:2048 sc1
buffer_load_dwordx4 v[164:167], v16, s[44:47], s75 offen offset:3072 sc1
s_branch L_xchk
L_codeend:
.section .rodata,"a"
.p2align 6
.amdhsa_kernel gated_mix__compressed_kv_cla__sliding_local_dilated__prompt_kernel
  .amdhsa_next_free_vgpr 512
  .amdhsa_next_free_sgpr 102
  .amdhsa_accum_offset 256
  .amdhsa_group_segment_fixed_size 0
  .amdhsa_kernarg_size 104
  .amdhsa_user_sgpr_count 2
  .amdhsa_user_sgpr_kernarg_segment_ptr 1
  .amdhsa_system_sgpr_workgroup_id_x 1
.end_amdhsa_kernel
```

```asm
; @launch grid=(256,1,1) block=(256,1,1) lds=163840
.amdgcn_target "amdgcn-amd-amdhsa--gfx950"
.text
.globl gated_mix__compressed_kv_cla__sliding_local_dilated__prompt_kernel
.p2align 8
.type gated_mix__compressed_kv_cla__sliding_local_dilated__prompt_kernel,@function
gated_mix__compressed_kv_cla__sliding_local_dilated__prompt_kernel:
s_cmp_ge_u32 s2, 256
s_cbranch_scc1 L_end
s_load_dwordx16 s[4:19], s[0:1], 0
s_load_dwordx8 s[20:27], s[0:1], 64
s_load_dwordx2 s[28:29], s[0:1], 96
s_getpc_b64 s[88:89]
L_pc:
v_lshrrev_b32 v1, 6, v0
s_lshr_b32 s67, s2, 3
v_lshl_add_u32 v24, s67, 2, v1
s_mov_b32 s90, L_codeend-L_pc
s_mov_b32 s91, 0x20000
v_and_b32 v25, 7, v0
v_lshlrev_b32 v25, 7, v25
v_lshl_add_u32 v24, v24, 10, v25
buffer_load_dword a252, v24, s[88:91], 0 offen
v_and_b32 v0, 63, v0
v_readfirstlane_b32 s30, v1
v_lshrrev_b32 v24, 3, v0
v_lshrrev_b32 v25, 4, v0
v_and_b32 v26, 7, v0
v_xor_b32 v26, v26, v25
v_lshlrev_b32 v26, 4, v26
v_lshl_add_u32 v12, v24, 10, v26
v_xor_b32 v13, 64, v12
v_bfe_u32 v26, v0, 1, 3
v_xor_b32 v26, v26, v25
v_lshlrev_b32 v26, 5, v26
v_and_b32 v24, 1, v0
v_lshl_add_u32 v26, v24, 4, v26
v_lshl_add_u32 v14, v25, 13, v26
v_xor_b32 v15, 128, v14
s_and_b32 s66, s2, 7
s_and_b32 s68, s67, 3
s_lshl2_add_u32 s31, s66, s68
s_cmp_eq_u32 s68, 0
s_cselect_b32 s90, s90, 0
s_lshr_b32 s3, s67, 2
s_lshl2_add_u32 s80, s67, s30
s_lshl_b32 s70, s3, 18
s_lshl_b32 s66, s30, 16
s_add_u32 s70, s70, s66
s_lshl_b32 s71, s30, 17
s_lshl_b32 s66, s31, 8
s_add_u32 s71, s71, s66
s_lshl_b32 s76, s30, 13
s_lshl_b32 s77, s30, 12
s_lshl_b32 s78, s30, 10
s_waitcnt lgkmcnt(0)
s_mov_b32 s32, s6
s_mov_b32 s33, s7
s_mov_b32 s34, 2097152
s_mov_b32 s35, 0x20000
s_mov_b32 s36, s10
s_mov_b32 s37, s11
s_mov_b32 s38, 4194304
s_mov_b32 s39, 0x20000
s_mov_b32 s40, s12
s_mov_b32 s41, s13
s_mov_b32 s42, 4194304
s_mov_b32 s43, 0x20000
s_add_u32 m0, s76, 0
s_add_u32 s64, s70, 0
buffer_load_dwordx4 v12, s[32:35], s64 offen lds
s_add_u32 m0, s76, 1024
s_add_u32 s64, s70, 8192
buffer_load_dwordx4 v13, s[32:35], s64 offen lds
s_add_u32 m0, s76, 2048
s_add_u32 s64, s70, 16384
buffer_load_dwordx4 v12, s[32:35], s64 offen lds
s_add_u32 m0, s76, 3072
s_add_u32 s64, s70, 24576
buffer_load_dwordx4 v13, s[32:35], s64 offen lds
s_add_u32 m0, s77, 65536
s_add_u32 s64, s71, 0
buffer_load_dwordx4 v14, s[36:39], s64 offen lds
s_add_u32 m0, s77, 66560
s_add_u32 s64, s71, 32768
buffer_load_dwordx4 v14, s[36:39], s64 offen lds
s_add_u32 m0, s77, 67584
s_add_u32 s64, s71, 65536
buffer_load_dwordx4 v15, s[36:39], s64 offen lds
s_add_u32 m0, s77, 68608
s_add_u32 s64, s71, 98304
buffer_load_dwordx4 v15, s[36:39], s64 offen lds
s_mov_b32 s44, s28
s_mov_b32 s45, s29
s_mov_b32 s46, 134217728
s_mov_b32 s47, 0x20000
s_mov_b32 s48, s4
s_mov_b32 s49, s5
s_mov_b32 s50, 4194304
s_mov_b32 s51, 0x20000
s_mov_b32 s52, s26
s_mov_b32 s53, s27
s_mov_b32 s54, 256
s_mov_b32 s55, 0x20000
s_mov_b32 s56, s8
s_mov_b32 s57, s9
s_mov_b32 s58, 8388608
s_mov_b32 s59, 0x20000
s_mov_b32 s60, s18
s_mov_b32 s61, s19
s_mov_b32 s62, 6291456
s_mov_b32 s63, 0x20000
v_accvgpr_write_b32 a251, 1
v_and_b32 v24, 15, v0
v_lshrrev_b32 v26, 1, v24
v_xor_b32 v26, v26, v25
v_lshlrev_b32 v26, 4, v26
v_lshl_add_u32 v26, v24, 7, v26
v_add_u32 v2, s76, v26
v_xor_b32 v3, 64, v2
v_bfe_u32 v24, v0, 2, 2
v_lshl_add_u32 v27, v25, 3, v24
v_and_b32 v1, 3, v0
v_cmp_eq_u32 vcc, 0, v1
v_lshlrev_b32 v1, 3, v1
v_lshl_add_u32 v26, v27, 8, v1
v_add_u32 v26, 65536, v26
v_and_b32 v1, 1, v25
v_lshl_add_u32 v24, v1, 2, v24
v_lshlrev_b32 v16, 4, v0
v_mov_b32 v28, 0x3f803f80
v_cndmask_b32 v28, 0, v28, vcc
v_accvgpr_write_b32 a244, v28
v_accvgpr_write_b32 a245, v28
v_accvgpr_write_b32 a246, v28
v_accvgpr_write_b32 a247, v28
v_xor_b32 v1, 0, v24
v_lshl_add_u32 v4, v1, 5, v26
v_xor_b32 v1, 1, v24
v_lshl_add_u32 v5, v1, 5, v26
v_xor_b32 v1, 2, v24
v_lshl_add_u32 v6, v1, 5, v26
v_xor_b32 v1, 3, v24
v_lshl_add_u32 v7, v1, 5, v26
v_xor_b32 v1, 4, v24
v_lshl_add_u32 v8, v1, 5, v26
v_xor_b32 v1, 5, v24
v_lshl_add_u32 v9, v1, 5, v26
v_xor_b32 v1, 6, v24
v_lshl_add_u32 v10, v1, 5, v26
v_xor_b32 v1, 7, v24
v_lshl_add_u32 v11, v1, 5, v26
s_sub_u32 s16, 15, s3
s_lshl_b32 s72, s3, 18
s_lshl_b32 s73, s16, 18
s_cmp_lt_u32 s30, 2
s_cselect_b32 s67, s3, s16
s_lshl4_add_u32 s74, s31, s67
s_and_b32 s66, s30, 1
s_lshl1_add_u32 s74, s74, s66
s_lshl_b32 s74, s74, 10
s_add_u32 s74, s74, 60817408
s_lshl_b32 s66, s30, 15
s_add_u32 s72, s72, s66
s_add_u32 s73, s73, s66
s_mul_i32 s75, s30, 98304
s_lshl_b32 s66, s31, 6
s_add_u32 s75, s75, s66
s_lshl_b32 s79, s31, 20
s_lshl_b32 s66, s3, 17
s_add_u32 s79, s79, s66
s_lshl_b32 s66, s30, 15
s_add_u32 s79, s79, s66
v_bfe_u32 v23, v0, 1, 1
v_lshrrev_b32 v1, 5, v0
v_xor_b32 v23, v23, v1
v_lshlrev_b32 v23, 5, v23
v_and_b32 v1, 1, v0
v_lshl_add_u32 v23, v1, 4, v23
v_lshrrev_b32 v1, 2, v0
v_mul_u32_u24 v1, 6144, v1
v_add_u32 v23, v1, v23
s_lshl_b32 s81, s80, 13
s_and_b32 s67, s2, 7
s_lshl_b32 s82, s67, 8
s_add_u32 s82, s82, s81
s_lshl_b32 s67, s67, 10
s_add_u32 s81, s81, s67
s_add_u32 s83, s81, 1048576
v_mul_u32_u24 v1, 1792, v25
v_add_u32 v1, v1, v16
s_lshl_b32 s68, s2, 3
s_lshl1_add_u32 s68, s30, s68
v_lshrrev_b32 v18, 5, v0
v_add_u32 v18, s68, v18
v_and_b32 v19, 31, v0
v_lshlrev_b32 v19, 4, v19
v_lshl_add_u32 v18, v18, 11, v19
v_mov_b32 v21, 0
v_min_u32 v20, 1, v0
v_lshlrev_b32 v20, 30, v20
v_accvgpr_write_b32 a240, -1
v_accvgpr_write_b32 a241, -1
v_accvgpr_write_b32 a242, -1
v_accvgpr_write_b32 a243, -1
s_lshr_b32 s69, s2, 7
s_or_b32 s69, s69, s30
s_lshl_b32 s69, s69, 21
s_add_u32 s69, s69, s2
s_lshl_b32 s69, s69, 7
s_add_u32 s69, s69, 59768832
s_add_u32 m0, s76, 4096
s_add_u32 s64, s70, 32768
buffer_load_dwordx4 v12, s[32:35], s64 offen lds
s_add_u32 m0, s76, 5120
s_add_u32 s64, s70, 40960
buffer_load_dwordx4 v13, s[32:35], s64 offen lds
s_add_u32 m0, s76, 6144
s_add_u32 s64, s70, 49152
buffer_load_dwordx4 v12, s[32:35], s64 offen lds
s_add_u32 m0, s76, 7168
s_add_u32 s64, s70, 57344
buffer_load_dwordx4 v13, s[32:35], s64 offen lds
s_add_u32 m0, s77, 81920
s_add_u32 s64, s71, 0
buffer_load_dwordx4 v14, s[40:43], s64 offen lds
s_add_u32 m0, s77, 82944
s_add_u32 s64, s71, 32768
buffer_load_dwordx4 v14, s[40:43], s64 offen lds
s_add_u32 m0, s77, 83968
s_add_u32 s64, s71, 65536
buffer_load_dwordx4 v15, s[40:43], s64 offen lds
s_add_u32 m0, s77, 84992
s_add_u32 s64, s71, 98304
buffer_load_dwordx4 v15, s[40:43], s64 offen lds
s_waitcnt vmcnt(8)
s_barrier
ds_read_b128 a[0:3], v2 offset:0
ds_read_b128 a[4:7], v3 offset:0
ds_read_b64_tr_b16 a[176:177], v4 offset:0
ds_read_b64_tr_b16 a[178:179], v4 offset:1024
ds_read_b64_tr_b16 a[180:181], v4 offset:8192
ds_read_b64_tr_b16 a[182:183], v4 offset:9216
ds_read_b128 a[8:11], v2 offset:2048
ds_read_b128 a[12:15], v3 offset:2048
ds_read_b64_tr_b16 a[184:185], v5 offset:0
ds_read_b64_tr_b16 a[186:187], v5 offset:1024
ds_read_b64_tr_b16 a[188:189], v5 offset:8192
ds_read_b64_tr_b16 a[190:191], v5 offset:9216
ds_read_b64_tr_b16 a[88:89], v6 offset:0
ds_read_b64_tr_b16 a[90:91], v6 offset:1024
ds_read_b64_tr_b16 a[92:93], v6 offset:8192
ds_read_b64_tr_b16 a[94:95], v6 offset:9216
s_waitcnt lgkmcnt(12)
v_mfma_f32_16x16x32_bf16 v[184:187], a[176:179], a[0:3], 0
s_waitcnt lgkmcnt(10)
s_add_u32 m0, s77, 98304
ds_read_b64_tr_b16 a[96:97], v7 offset:0
v_mfma_f32_16x16x32_bf16 v[184:187], a[180:183], a[4:7], v[184:187]
s_waitcnt lgkmcnt(9)
s_add_u32 s64, s71, 524288
ds_read_b64_tr_b16 a[98:99], v7 offset:1024
v_mfma_f32_16x16x32_bf16 v[192:195], a[180:183], a[12:15], 0
buffer_load_dwordx4 v14, s[36:39], s64 offen lds
v_mfma_f32_16x16x32_bf16 v[192:195], a[176:179], a[8:11], v[192:195]
s_waitcnt lgkmcnt(8)
ds_read_b64_tr_b16 a[100:101], v7 offset:8192
v_mfma_f32_16x16x32_bf16 v[196:199], a[184:187], a[8:11], 0
s_waitcnt lgkmcnt(7)
s_add_u32 m0, s77, 99328
ds_read_b64_tr_b16 a[102:103], v7 offset:9216
v_mfma_f32_16x16x32_bf16 v[196:199], a[188:191], a[12:15], v[196:199]
s_add_u32 s64, s71, 557056
ds_read_b64_tr_b16 a[104:105], v8 offset:0
v_mfma_f32_16x16x32_bf16 v[188:191], a[188:191], a[4:7], 0
buffer_load_dwordx4 v14, s[36:39], s64 offen lds
v_mfma_f32_16x16x32_bf16 v[188:191], a[184:187], a[0:3], v[188:191]
s_waitcnt lgkmcnt(7)
ds_read_b64_tr_b16 a[106:107], v8 offset:1024
v_mfma_f32_16x16x32_bf16 v[216:219], a[88:91], a[0:3], 0
s_waitcnt lgkmcnt(6)
s_add_u32 m0, s77, 100352
ds_read_b64_tr_b16 a[108:109], v8 offset:8192
v_mfma_f32_16x16x32_bf16 v[216:219], a[92:95], a[4:7], v[216:219]
s_add_u32 s64, s71, 589824
ds_read_b64_tr_b16 a[110:111], v8 offset:9216
v_mfma_f32_16x16x32_bf16 v[224:227], a[92:95], a[12:15], 0
buffer_load_dwordx4 v15, s[36:39], s64 offen lds
v_mfma_f32_16x16x32_bf16 v[224:227], a[88:91], a[8:11], v[224:227]
s_waitcnt lgkmcnt(6)
ds_read_b64_tr_b16 a[112:113], v9 offset:0
v_mfma_f32_16x16x32_bf16 v[228:231], a[96:99], a[8:11], 0
s_waitcnt lgkmcnt(5)
ds_read_b64_tr_b16 a[114:115], v9 offset:1024
v_mfma_f32_16x16x32_bf16 v[228:231], a[100:103], a[12:15], v[228:231]
s_add_u32 m0, s77, 101376
ds_read_b64_tr_b16 a[116:117], v9 offset:8192
v_mfma_f32_16x16x32_bf16 v[220:223], a[100:103], a[4:7], 0
s_add_u32 s64, s71, 622592
ds_read_b64_tr_b16 a[118:119], v9 offset:9216
v_mfma_f32_16x16x32_bf16 v[220:223], a[96:99], a[0:3], v[220:223]
s_waitcnt lgkmcnt(6)
buffer_load_dwordx4 v15, s[36:39], s64 offen lds
v_mfma_f32_16x16x32_bf16 v[152:155], a[104:107], a[0:3], 0
s_waitcnt lgkmcnt(4)
ds_read_b64_tr_b16 a[72:73], v10 offset:0
v_mfma_f32_16x16x32_bf16 v[152:155], a[108:111], a[4:7], v[152:155]
s_add_u32 m0, s77, 114688
ds_read_b64_tr_b16 a[74:75], v10 offset:1024
v_mfma_f32_16x16x32_bf16 v[160:163], a[108:111], a[12:15], 0
s_add_u32 s64, s71, 524288
ds_read_b64_tr_b16 a[76:77], v10 offset:8192
ds_read_b64_tr_b16 a[78:79], v10 offset:9216
v_mfma_f32_16x16x32_bf16 v[160:163], a[104:107], a[8:11], v[160:163]
s_waitcnt lgkmcnt(6)
buffer_load_dwordx4 v14, s[40:43], s64 offen lds
v_mfma_f32_16x16x32_bf16 v[164:167], a[112:115], a[8:11], 0
s_waitcnt lgkmcnt(4)
s_add_u32 m0, s77, 115712
ds_read_b64_tr_b16 a[80:81], v11 offset:0
v_mfma_f32_16x16x32_bf16 v[164:167], a[116:119], a[12:15], v[164:167]
s_add_u32 s64, s71, 557056
ds_read_b64_tr_b16 a[82:83], v11 offset:1024
v_mfma_f32_16x16x32_bf16 v[156:159], a[116:119], a[4:7], 0
ds_read_b64_tr_b16 a[84:85], v11 offset:8192
ds_read_b64_tr_b16 a[86:87], v11 offset:9216
s_waitcnt vmcnt(9)
v_mfma_f32_16x16x32_bf16 v[156:159], a[112:115], a[0:3], v[156:159]
s_waitcnt lgkmcnt(6)
buffer_load_dwordx4 v14, s[40:43], s64 offen lds
v_mfma_f32_16x16x32_bf16 v[24:27], a[72:75], a[0:3], 0
s_waitcnt lgkmcnt(4)
s_add_u32 m0, s77, 116736
ds_read_b128 a[16:19], v2 offset:4096
ds_read_b128 a[20:23], v3 offset:4096
v_mfma_f32_16x16x32_bf16 v[24:27], a[76:79], a[4:7], v[24:27]
s_add_u32 s64, s71, 589824
ds_read_b128 a[24:27], v2 offset:6144
ds_read_b128 a[28:31], v3 offset:6144
v_mfma_f32_16x16x32_bf16 v[40:43], a[76:79], a[12:15], 0
s_add_u32 s17, s78, .-L_pc+6144
buffer_load_dwordx4 v15, s[40:43], s64 offen lds
v_mfma_f32_16x16x32_bf16 v[40:43], a[72:75], a[8:11], v[40:43]
s_waitcnt lgkmcnt(6)
buffer_load_dword a252, v16, s[88:91], s17 offen
v_mfma_f32_16x16x32_bf16 v[104:107], a[80:83], a[8:11], 0
s_waitcnt lgkmcnt(4)
s_add_u32 m0, s77, 117760
v_mfma_f32_16x16x32_bf16 v[104:107], a[84:87], a[12:15], v[104:107]
s_add_u32 s64, s71, 622592
v_mfma_f32_16x16x32_bf16 v[88:91], a[84:87], a[4:7], 0
buffer_load_dwordx4 v15, s[40:43], s64 offen lds
v_mfma_f32_16x16x32_bf16 v[88:91], a[80:83], a[0:3], v[88:91]
s_waitcnt lgkmcnt(3)
v_mfma_f32_16x16x32_bf16 v[232:235], a[88:91], a[16:19], 0
s_waitcnt lgkmcnt(2)
v_mfma_f32_16x16x32_bf16 v[232:235], a[92:95], a[20:23], v[232:235]
s_waitcnt lgkmcnt(0)
s_add_u32 m0, s76, 32768
v_mfma_f32_16x16x32_bf16 v[240:243], a[92:95], a[28:31], 0
s_add_u32 s64, s70, 128
v_mfma_f32_16x16x32_bf16 v[240:243], a[88:91], a[24:27], v[240:243]
buffer_load_dwordx4 v12, s[32:35], s64 offen lds
v_mfma_f32_16x16x32_bf16 v[244:247], a[96:99], a[24:27], 0
s_add_u32 m0, s76, 33792
v_mfma_f32_16x16x32_bf16 v[244:247], a[100:103], a[28:31], v[244:247]
s_add_u32 s64, s70, 8320
v_mfma_f32_16x16x32_bf16 v[236:239], a[100:103], a[20:23], 0
s_waitcnt vmcnt(10)
s_barrier
v_mfma_f32_16x16x32_bf16 v[236:239], a[96:99], a[16:19], v[236:239]
buffer_load_dwordx4 v13, s[32:35], s64 offen lds
v_mfma_f32_16x16x32_bf16 v[168:171], a[104:107], a[16:19], 0
ds_read_b64_tr_b16 a[88:89], v4 offset:16384
v_mfma_f32_16x16x32_bf16 v[168:171], a[108:111], a[20:23], v[168:171]
s_add_u32 m0, s76, 34816
ds_read_b64_tr_b16 a[90:91], v4 offset:17408
v_mfma_f32_16x16x32_bf16 v[176:179], a[108:111], a[28:31], 0
s_add_u32 s64, s70, 16512
ds_read_b64_tr_b16 a[92:93], v4 offset:24576
v_mfma_f32_16x16x32_bf16 v[176:179], a[104:107], a[24:27], v[176:179]
buffer_load_dwordx4 v12, s[32:35], s64 offen lds
v_mfma_f32_16x16x32_bf16 v[180:183], a[112:115], a[24:27], 0
ds_read_b64_tr_b16 a[94:95], v4 offset:25600
v_mfma_f32_16x16x32_bf16 v[180:183], a[116:119], a[28:31], v[180:183]
s_add_u32 m0, s76, 35840
ds_read_b64_tr_b16 a[96:97], v5 offset:16384
v_mfma_f32_16x16x32_bf16 v[172:175], a[116:119], a[20:23], 0
s_add_u32 s64, s70, 24704
ds_read_b64_tr_b16 a[98:99], v5 offset:17408
v_mfma_f32_16x16x32_bf16 v[172:175], a[112:115], a[16:19], v[172:175]
buffer_load_dwordx4 v13, s[32:35], s64 offen lds
v_mfma_f32_16x16x32_bf16 v[56:59], a[72:75], a[16:19], 0
ds_read_b64_tr_b16 a[100:101], v5 offset:24576
v_mfma_f32_16x16x32_bf16 v[56:59], a[76:79], a[20:23], v[56:59]
s_add_u32 m0, s76, 36864
ds_read_b64_tr_b16 a[102:103], v5 offset:25600
v_mfma_f32_16x16x32_bf16 v[72:75], a[76:79], a[28:31], 0
s_add_u32 s64, s70, 32896
ds_read_b64_tr_b16 a[104:105], v6 offset:16384
v_mfma_f32_16x16x32_bf16 v[72:75], a[72:75], a[24:27], v[72:75]
buffer_load_dwordx4 v12, s[32:35], s64 offen lds
v_mfma_f32_16x16x32_bf16 v[136:139], a[80:83], a[24:27], 0
ds_read_b64_tr_b16 a[106:107], v6 offset:17408
v_mfma_f32_16x16x32_bf16 v[136:139], a[84:87], a[28:31], v[136:139]
s_add_u32 m0, s76, 37888
ds_read_b64_tr_b16 a[108:109], v6 offset:24576
v_mfma_f32_16x16x32_bf16 v[120:123], a[84:87], a[20:23], 0
s_add_u32 s64, s70, 41088
ds_read_b64_tr_b16 a[110:111], v6 offset:25600
v_mfma_f32_16x16x32_bf16 v[120:123], a[80:83], a[16:19], v[120:123]
buffer_load_dwordx4 v13, s[32:35], s64 offen lds
v_mfma_f32_16x16x32_bf16 v[200:203], a[176:179], a[16:19], 0
ds_read_b64_tr_b16 a[112:113], v7 offset:16384
v_mfma_f32_16x16x32_bf16 v[200:203], a[180:183], a[20:23], v[200:203]
s_add_u32 m0, s76, 38912
ds_read_b64_tr_b16 a[114:115], v7 offset:17408
v_mfma_f32_16x16x32_bf16 v[208:211], a[180:183], a[28:31], 0
s_add_u32 s64, s70, 49280
ds_read_b64_tr_b16 a[116:117], v7 offset:24576
v_mfma_f32_16x16x32_bf16 v[208:211], a[176:179], a[24:27], v[208:211]
buffer_load_dwordx4 v12, s[32:35], s64 offen lds
v_mfma_f32_16x16x32_bf16 v[212:215], a[184:187], a[24:27], 0
ds_read_b64_tr_b16 a[118:119], v7 offset:25600
v_mfma_f32_16x16x32_bf16 v[212:215], a[188:191], a[28:31], v[212:215]
s_add_u32 m0, s76, 39936
ds_read_b64_tr_b16 a[72:73], v8 offset:16384
v_mfma_f32_16x16x32_bf16 v[204:207], a[188:191], a[20:23], 0
s_add_u32 s64, s70, 57472
ds_read_b64_tr_b16 a[74:75], v8 offset:17408
v_mfma_f32_16x16x32_bf16 v[204:207], a[184:187], a[16:19], v[204:207]
s_waitcnt lgkmcnt(7)
buffer_load_dwordx4 v13, s[32:35], s64 offen lds
v_mfma_f32_16x16x32_bf16 v[28:31], a[0:3], a[88:91], 0
ds_read_b64_tr_b16 a[76:77], v8 offset:24576
v_mfma_f32_16x16x32_bf16 v[28:31], a[4:7], a[92:95], v[28:31]
ds_read_b64_tr_b16 a[78:79], v8 offset:25600
v_mfma_f32_16x16x32_bf16 v[44:47], a[12:15], a[92:95], 0
ds_read_b64_tr_b16 a[80:81], v9 offset:16384
v_mfma_f32_16x16x32_bf16 v[44:47], a[8:11], a[88:91], v[44:47]
ds_read_b64_tr_b16 a[82:83], v9 offset:17408
v_mfma_f32_16x16x32_bf16 v[60:63], a[16:19], a[88:91], 0
s_add_u32 m0, s77, 131072
ds_read_b64_tr_b16 a[84:85], v9 offset:24576
v_mfma_f32_16x16x32_bf16 v[60:63], a[20:23], a[92:95], v[60:63]
s_add_u32 s64, s71, 1048576
ds_read_b64_tr_b16 a[86:87], v9 offset:25600
v_mfma_f32_16x16x32_bf16 v[76:79], a[28:31], a[92:95], 0
buffer_load_dwordx4 v14, s[36:39], s64 offen lds
v_mfma_f32_16x16x32_bf16 v[76:79], a[24:27], a[88:91], v[76:79]
s_add_u32 m0, s77, 132096
ds_read_b64_tr_b16 a[88:89], v10 offset:16384
v_mfma_f32_16x16x32_bf16 v[140:143], a[24:27], a[96:99], 0
s_add_u32 s64, s71, 1081344
ds_read_b64_tr_b16 a[90:91], v10 offset:17408
v_mfma_f32_16x16x32_bf16 v[140:143], a[28:31], a[100:103], v[140:143]
buffer_load_dwordx4 v14, s[36:39], s64 offen lds
v_mfma_f32_16x16x32_bf16 v[124:127], a[20:23], a[100:103], 0
ds_read_b64_tr_b16 a[92:93], v10 offset:24576
v_mfma_f32_16x16x32_bf16 v[124:127], a[16:19], a[96:99], v[124:127]
s_add_u32 m0, s77, 133120
ds_read_b64_tr_b16 a[94:95], v10 offset:25600
v_mfma_f32_16x16x32_bf16 v[108:111], a[8:11], a[96:99], 0
s_add_u32 s64, s71, 1114112
v_mfma_f32_16x16x32_bf16 v[108:111], a[12:15], a[100:103], v[108:111]
buffer_load_dwordx4 v15, s[36:39], s64 offen lds
v_mfma_f32_16x16x32_bf16 v[92:95], a[4:7], a[100:103], 0
v_mfma_f32_16x16x32_bf16 v[92:95], a[0:3], a[96:99], v[92:95]
s_add_u32 m0, s77, 134144
ds_read_b64_tr_b16 a[96:97], v11 offset:16384
v_mfma_f32_16x16x32_bf16 v[32:35], a[0:3], a[104:107], 0
s_waitcnt lgkmcnt(5)
s_add_u32 s64, s71, 1146880
ds_read_b64_tr_b16 a[98:99], v11 offset:17408
v_mfma_f32_16x16x32_bf16 v[32:35], a[4:7], a[108:111], v[32:35]
buffer_load_dwordx4 v15, s[36:39], s64 offen lds
v_mfma_f32_16x16x32_bf16 v[48:51], a[12:15], a[108:111], 0
ds_read_b64_tr_b16 a[100:101], v11 offset:24576
v_mfma_f32_16x16x32_bf16 v[48:51], a[8:11], a[104:107], v[48:51]
s_add_u32 m0, s77, 147456
ds_read_b64_tr_b16 a[102:103], v11 offset:25600
v_mfma_f32_16x16x32_bf16 v[64:67], a[16:19], a[104:107], 0
s_add_u32 s64, s71, 1048576
v_mfma_f32_16x16x32_bf16 v[64:67], a[20:23], a[108:111], v[64:67]
buffer_load_dwordx4 v14, s[40:43], s64 offen lds
v_mfma_f32_16x16x32_bf16 v[80:83], a[28:31], a[108:111], 0
s_add_u32 m0, s77, 148480
v_mfma_f32_16x16x32_bf16 v[80:83], a[24:27], a[104:107], v[80:83]
s_add_u32 s64, s71, 1081344
v_mfma_f32_16x16x32_bf16 v[144:147], a[24:27], a[112:115], 0
buffer_load_dwordx4 v14, s[40:43], s64 offen lds
v_mfma_f32_16x16x32_bf16 v[144:147], a[28:31], a[116:119], v[144:147]
v_mfma_f32_16x16x32_bf16 v[128:131], a[20:23], a[116:119], 0
s_add_u32 m0, s77, 149504
v_mfma_f32_16x16x32_bf16 v[128:131], a[16:19], a[112:115], v[128:131]
s_add_u32 s64, s71, 1114112
v_mfma_f32_16x16x32_bf16 v[112:115], a[8:11], a[112:115], 0
buffer_load_dwordx4 v15, s[40:43], s64 offen lds
v_mfma_f32_16x16x32_bf16 v[112:115], a[12:15], a[116:119], v[112:115]
v_mfma_f32_16x16x32_bf16 v[96:99], a[4:7], a[116:119], 0
s_add_u32 m0, s77, 150528
v_mfma_f32_16x16x32_bf16 v[96:99], a[0:3], a[112:115], v[96:99]
s_add_u32 s64, s71, 1146880
v_mfma_f32_16x16x32_bf16 v[36:39], a[0:3], a[72:75], 0
buffer_load_dwordx4 v15, s[40:43], s64 offen lds
v_mfma_f32_16x16x32_bf16 v[36:39], a[4:7], a[76:79], v[36:39]
s_add_u32 m0, s76, 0
v_mfma_f32_16x16x32_bf16 v[52:55], a[12:15], a[76:79], 0
s_waitcnt vmcnt(16) lgkmcnt(0)
s_barrier
v_mfma_f32_16x16x32_bf16 v[52:55], a[8:11], a[72:75], v[52:55]
s_add_u32 s64, s70, 256
ds_read_b64_tr_b16 a[104:105], v4 offset:32768
v_mfma_f32_16x16x32_bf16 v[68:71], a[16:19], a[72:75], 0
buffer_load_dwordx4 v12, s[32:35], s64 offen lds
v_mfma_f32_16x16x32_bf16 v[68:71], a[20:23], a[76:79], v[68:71]
s_add_u32 m0, s76, 1024
global_load_dwordx4 a[144:147], v18, s[4:5] offset:0
v_mfma_f32_16x16x32_bf16 v[84:87], a[28:31], a[76:79], 0
s_add_u32 s64, s70, 8448
ds_read_b64_tr_b16 a[106:107], v4 offset:33792
v_mfma_f32_16x16x32_bf16 v[84:87], a[24:27], a[72:75], v[84:87]
buffer_load_dwordx4 v13, s[32:35], s64 offen lds
v_mfma_f32_16x16x32_bf16 v[148:151], a[24:27], a[80:83], 0
ds_read_b64_tr_b16 a[108:109], v4 offset:40960
v_mfma_f32_16x16x32_bf16 v[148:151], a[28:31], a[84:87], v[148:151]
s_add_u32 m0, s76, 2048
ds_read_b64_tr_b16 a[110:111], v4 offset:41984
v_mfma_f32_16x16x32_bf16 v[132:135], a[20:23], a[84:87], 0
s_waitcnt vmcnt(11)
s_add_u32 s64, s70, 16640
ds_read_b128 a[32:35], v2 offset:32768
v_mfma_f32_16x16x32_bf16 v[132:135], a[16:19], a[80:83], v[132:135]
buffer_load_dwordx4 v12, s[32:35], s64 offen lds
v_mfma_f32_16x16x32_bf16 v[116:119], a[8:11], a[80:83], 0
ds_read_b128 a[36:39], v3 offset:32768
v_mfma_f32_16x16x32_bf16 v[116:119], a[12:15], a[84:87], v[116:119]
s_add_u32 m0, s76, 3072
ds_read_b128 a[40:43], v2 offset:34816
v_mfma_f32_16x16x32_bf16 v[100:103], a[4:7], a[84:87], 0
s_add_u32 s64, s70, 24832
ds_read_b128 a[44:47], v3 offset:34816
v_mfma_f32_16x16x32_bf16 v[100:103], a[0:3], a[80:83], v[100:103]
buffer_load_dwordx4 v13, s[32:35], s64 offen lds
v_mfma_f32_16x16x32_bf16 v[248:251], a[0:3], a[88:91], 0
ds_read_b128 a[48:51], v2 offset:36864
v_mfma_f32_16x16x32_bf16 v[248:251], a[4:7], a[92:95], v[248:251]
s_add_u32 m0, s76, 4096
ds_read_b128 a[52:55], v3 offset:36864
v_mfma_f32_16x16x32_bf16 v[252:255], a[12:15], a[92:95], 0
s_add_u32 s64, s70, 33024
ds_read_b128 a[56:59], v2 offset:38912
v_mfma_f32_16x16x32_bf16 v[252:255], a[8:11], a[88:91], v[252:255]
buffer_load_dwordx4 v12, s[32:35], s64 offen lds
v_mfma_f32_16x16x32_bf16 a[120:123], a[16:19], a[88:91], 0
s_add_u32 m0, s76, 5120
ds_read_b128 a[60:63], v3 offset:38912
v_mfma_f32_16x16x32_bf16 a[120:123], a[20:23], a[92:95], a[120:123]
s_add_u32 s64, s70, 41216
ds_read_b64_tr_b16 a[112:113], v5 offset:32768
v_mfma_f32_16x16x32_bf16 a[124:127], a[28:31], a[92:95], 0
buffer_load_dwordx4 v13, s[32:35], s64 offen lds
v_mfma_f32_16x16x32_bf16 a[124:127], a[24:27], a[88:91], a[124:127]
ds_read_b64_tr_b16 a[114:115], v5 offset:33792
v_mfma_f32_16x16x32_bf16 a[128:131], a[24:27], a[96:99], 0
s_add_u32 m0, s76, 6144
ds_read_b64_tr_b16 a[116:117], v5 offset:40960
v_mfma_f32_16x16x32_bf16 a[128:131], a[28:31], a[100:103], a[128:131]
s_add_u32 s64, s70, 49408
ds_read_b64_tr_b16 a[118:119], v5 offset:41984
v_mfma_f32_16x16x32_bf16 a[132:135], a[20:23], a[100:103], 0
buffer_load_dwordx4 v12, s[32:35], s64 offen lds
v_mfma_f32_16x16x32_bf16 a[132:135], a[16:19], a[96:99], a[132:135]
global_load_dwordx4 a[160:163], v19, s[22:23] offset:0
v_mfma_f32_16x16x32_bf16 a[136:139], a[8:11], a[96:99], 0
s_add_u32 m0, s76, 7168
ds_read_b64_tr_b16 a[72:73], v6 offset:32768
v_mfma_f32_16x16x32_bf16 a[136:139], a[12:15], a[100:103], a[136:139]
s_add_u32 s64, s70, 57600
ds_read_b64_tr_b16 a[74:75], v6 offset:33792
v_mfma_f32_16x16x32_bf16 a[140:143], a[4:7], a[100:103], 0
buffer_load_dwordx4 v13, s[32:35], s64 offen lds
v_mfma_f32_16x16x32_bf16 a[140:143], a[0:3], a[96:99], a[140:143]
s_waitcnt lgkmcnt(5)
ds_read_b64_tr_b16 a[76:77], v6 offset:40960
v_mfma_f32_16x16x32_bf16 v[184:187], a[104:107], a[32:35], v[184:187]
ds_read_b64_tr_b16 a[78:79], v6 offset:41984
v_mfma_f32_16x16x32_bf16 v[184:187], a[108:111], a[36:39], v[184:187]
ds_read_b64_tr_b16 a[80:81], v7 offset:32768
v_mfma_f32_16x16x32_bf16 v[192:195], a[108:111], a[44:47], v[192:195]
s_add_u32 m0, s77, 65536
ds_read_b64_tr_b16 a[82:83], v7 offset:33792
v_mfma_f32_16x16x32_bf16 v[192:195], a[104:107], a[40:43], v[192:195]
s_add_u32 s64, s71, 1572864
ds_read_b64_tr_b16 a[84:85], v7 offset:40960
v_mfma_f32_16x16x32_bf16 v[200:203], a[104:107], a[48:51], v[200:203]
buffer_load_dwordx4 v14, s[36:39], s64 offen lds
v_mfma_f32_16x16x32_bf16 v[200:203], a[108:111], a[52:55], v[200:203]
ds_read_b64_tr_b16 a[86:87], v7 offset:41984
v_mfma_f32_16x16x32_bf16 v[208:211], a[108:111], a[60:63], v[208:211]
s_add_u32 m0, s77, 66560
ds_read_b64_tr_b16 a[88:89], v8 offset:32768
v_mfma_f32_16x16x32_bf16 v[208:211], a[104:107], a[56:59], v[208:211]
s_waitcnt lgkmcnt(7)
s_add_u32 s64, s71, 1605632
ds_read_b64_tr_b16 a[90:91], v8 offset:33792
v_mfma_f32_16x16x32_bf16 v[212:215], a[112:115], a[56:59], v[212:215]
buffer_load_dwordx4 v14, s[36:39], s64 offen lds
v_mfma_f32_16x16x32_bf16 v[212:215], a[116:119], a[60:63], v[212:215]
ds_read_b64_tr_b16 a[92:93], v8 offset:40960
v_mfma_f32_16x16x32_bf16 v[204:207], a[116:119], a[52:55], v[204:207]
s_add_u32 m0, s77, 67584
ds_read_b64_tr_b16 a[94:95], v8 offset:41984
v_mfma_f32_16x16x32_bf16 v[204:207], a[112:115], a[48:51], v[204:207]
s_add_u32 s64, s71, 1638400
ds_read_b64_tr_b16 a[96:97], v9 offset:32768
v_mfma_f32_16x16x32_bf16 v[196:199], a[112:115], a[40:43], v[196:199]
buffer_load_dwordx4 v15, s[36:39], s64 offen lds
v_mfma_f32_16x16x32_bf16 v[196:199], a[116:119], a[44:47], v[196:199]
ds_read_b64_tr_b16 a[98:99], v9 offset:33792
v_mfma_f32_16x16x32_bf16 v[188:191], a[116:119], a[36:39], v[188:191]
s_add_u32 m0, s77, 68608
ds_read_b64_tr_b16 a[100:101], v9 offset:40960
v_mfma_f32_16x16x32_bf16 v[188:191], a[112:115], a[32:35], v[188:191]
s_add_u32 s64, s71, 1671168
ds_read_b64_tr_b16 a[102:103], v9 offset:41984
v_mfma_f32_16x16x32_bf16 v[216:219], a[72:75], a[32:35], v[216:219]
s_waitcnt lgkmcnt(7)
buffer_load_dwordx4 v15, s[36:39], s64 offen lds
v_mfma_f32_16x16x32_bf16 v[216:219], a[76:79], a[36:39], v[216:219]
global_load_dwordx4 a[148:151], v18, s[4:5] offset:512
v_mfma_f32_16x16x32_bf16 v[224:227], a[76:79], a[44:47], v[224:227]
ds_read_b64_tr_b16 a[104:105], v10 offset:32768
v_mfma_f32_16x16x32_bf16 v[224:227], a[72:75], a[40:43], v[224:227]
s_add_u32 m0, s77, 81920
ds_read_b64_tr_b16 a[106:107], v10 offset:33792
v_mfma_f32_16x16x32_bf16 v[232:235], a[72:75], a[48:51], v[232:235]
s_add_u32 s64, s71, 1572864
ds_read_b64_tr_b16 a[108:109], v10 offset:40960
v_mfma_f32_16x16x32_bf16 v[232:235], a[76:79], a[52:55], v[232:235]
buffer_load_dwordx4 v14, s[40:43], s64 offen lds
v_mfma_f32_16x16x32_bf16 v[240:243], a[76:79], a[60:63], v[240:243]
ds_read_b64_tr_b16 a[110:111], v10 offset:41984
v_mfma_f32_16x16x32_bf16 v[240:243], a[72:75], a[56:59], v[240:243]
s_add_u32 m0, s77, 82944
ds_read_b64_tr_b16 a[112:113], v11 offset:32768
v_mfma_f32_16x16x32_bf16 v[244:247], a[80:83], a[56:59], v[244:247]
s_add_u32 s64, s71, 1605632
ds_read_b64_tr_b16 a[114:115], v11 offset:33792
v_mfma_f32_16x16x32_bf16 v[244:247], a[84:87], a[60:63], v[244:247]
buffer_load_dwordx4 v14, s[40:43], s64 offen lds
v_mfma_f32_16x16x32_bf16 v[236:239], a[84:87], a[52:55], v[236:239]
ds_read_b64_tr_b16 a[116:117], v11 offset:40960
v_mfma_f32_16x16x32_bf16 v[236:239], a[80:83], a[48:51], v[236:239]
s_add_u32 m0, s77, 83968
ds_read_b64_tr_b16 a[118:119], v11 offset:41984
v_mfma_f32_16x16x32_bf16 v[228:231], a[80:83], a[40:43], v[228:231]
s_add_u32 s64, s71, 1638400
ds_read_b64_tr_b16 a[72:73], v4 offset:49152
v_mfma_f32_16x16x32_bf16 v[228:231], a[84:87], a[44:47], v[228:231]
buffer_load_dwordx4 v15, s[40:43], s64 offen lds
v_mfma_f32_16x16x32_bf16 v[220:223], a[84:87], a[36:39], v[220:223]
ds_read_b64_tr_b16 a[74:75], v4 offset:50176
v_mfma_f32_16x16x32_bf16 v[220:223], a[80:83], a[32:35], v[220:223]
s_waitcnt lgkmcnt(7)
s_add_u32 m0, s77, 84992
ds_read_b64_tr_b16 a[76:77], v4 offset:57344
v_mfma_f32_16x16x32_bf16 v[152:155], a[88:91], a[32:35], v[152:155]
s_add_u32 s64, s71, 1671168
ds_read_b64_tr_b16 a[78:79], v4 offset:58368
v_mfma_f32_16x16x32_bf16 v[152:155], a[92:95], a[36:39], v[152:155]
buffer_load_dwordx4 v15, s[40:43], s64 offen lds
v_mfma_f32_16x16x32_bf16 v[160:163], a[92:95], a[44:47], v[160:163]
ds_read_b64_tr_b16 a[80:81], v5 offset:49152
v_mfma_f32_16x16x32_bf16 v[160:163], a[88:91], a[40:43], v[160:163]
ds_read_b64_tr_b16 a[82:83], v5 offset:50176
v_mfma_f32_16x16x32_bf16 v[168:171], a[88:91], a[48:51], v[168:171]
ds_read_b64_tr_b16 a[84:85], v5 offset:57344
v_mfma_f32_16x16x32_bf16 v[168:171], a[92:95], a[52:55], v[168:171]
ds_read_b64_tr_b16 a[86:87], v5 offset:58368
v_mfma_f32_16x16x32_bf16 v[176:179], a[92:95], a[60:63], v[176:179]
s_add_u32 m0, s76, 32768
global_load_dwordx4 a[164:167], v19, s[22:23] offset:512
v_mfma_f32_16x16x32_bf16 v[176:179], a[88:91], a[56:59], v[176:179]
s_add_u32 s64, s70, 384
ds_read_b64_tr_b16 a[88:89], v6 offset:49152
v_mfma_f32_16x16x32_bf16 v[180:183], a[96:99], a[56:59], v[180:183]
buffer_load_dwordx4 v12, s[32:35], s64 offen lds
v_mfma_f32_16x16x32_bf16 v[180:183], a[100:103], a[60:63], v[180:183]
ds_read_b64_tr_b16 a[90:91], v6 offset:50176
v_mfma_f32_16x16x32_bf16 v[172:175], a[100:103], a[52:55], v[172:175]
ds_read_b64_tr_b16 a[92:93], v6 offset:57344
v_mfma_f32_16x16x32_bf16 v[172:175], a[96:99], a[48:51], v[172:175]
ds_read_b64_tr_b16 a[94:95], v6 offset:58368
v_mfma_f32_16x16x32_bf16 v[164:167], a[96:99], a[40:43], v[164:167]
v_mfma_f32_16x16x32_bf16 v[164:167], a[100:103], a[44:47], v[164:167]
s_add_u32 m0, s76, 33792
v_mfma_f32_16x16x32_bf16 v[156:159], a[100:103], a[36:39], v[156:159]
s_add_u32 s64, s70, 8576
v_mfma_f32_16x16x32_bf16 v[156:159], a[96:99], a[32:35], v[156:159]
buffer_load_dwordx4 v13, s[32:35], s64 offen lds
v_mfma_f32_16x16x32_bf16 v[24:27], a[104:107], a[32:35], v[24:27]
s_waitcnt lgkmcnt(4)
ds_read_b64_tr_b16 a[96:97], v7 offset:49152
v_mfma_f32_16x16x32_bf16 v[24:27], a[108:111], a[36:39], v[24:27]
ds_read_b64_tr_b16 a[98:99], v7 offset:50176
v_mfma_f32_16x16x32_bf16 v[40:43], a[108:111], a[44:47], v[40:43]
ds_read_b64_tr_b16 a[100:101], v7 offset:57344
v_mfma_f32_16x16x32_bf16 v[40:43], a[104:107], a[40:43], v[40:43]
ds_read_b64_tr_b16 a[102:103], v7 offset:58368
v_mfma_f32_16x16x32_bf16 v[56:59], a[104:107], a[48:51], v[56:59]
s_add_u32 m0, s76, 34816
v_mfma_f32_16x16x32_bf16 v[56:59], a[108:111], a[52:55], v[56:59]
s_add_u32 s64, s70, 16768
v_mfma_f32_16x16x32_bf16 v[72:75], a[108:111], a[60:63], v[72:75]
s_waitcnt vmcnt(12)
buffer_load_dwordx4 v12, s[32:35], s64 offen lds
v_mfma_f32_16x16x32_bf16 v[72:75], a[104:107], a[56:59], v[72:75]
ds_read_b64_tr_b16 a[104:105], v8 offset:49152
v_mfma_f32_16x16x32_bf16 v[136:139], a[112:115], a[56:59], v[136:139]
ds_read_b64_tr_b16 a[106:107], v8 offset:50176
v_mfma_f32_16x16x32_bf16 v[136:139], a[116:119], a[60:63], v[136:139]
ds_read_b64_tr_b16 a[108:109], v8 offset:57344
v_add_u32 v4, 0x8000, v4
v_mfma_f32_16x16x32_bf16 v[120:123], a[116:119], a[52:55], v[120:123]
ds_read_b64_tr_b16 a[110:111], v8 offset:58368
v_mfma_f32_16x16x32_bf16 v[120:123], a[112:115], a[48:51], v[120:123]
s_add_u32 m0, s76, 35840
ds_read_b128 a[0:3], v2 offset:0
v_mfma_f32_16x16x32_bf16 v[104:107], a[112:115], a[40:43], v[104:107]
s_add_u32 s64, s70, 24960
global_load_dwordx4 a[152:155], v18, s[4:5] offset:1024
v_mfma_f32_16x16x32_bf16 v[104:107], a[116:119], a[44:47], v[104:107]
buffer_load_dwordx4 v13, s[32:35], s64 offen lds
v_mfma_f32_16x16x32_bf16 v[88:91], a[116:119], a[36:39], v[88:91]
ds_read_b128 a[4:7], v3 offset:0
v_mfma_f32_16x16x32_bf16 v[88:91], a[112:115], a[32:35], v[88:91]
ds_read_b128 a[8:11], v2 offset:2048
v_mfma_f32_16x16x32_bf16 v[28:31], a[32:35], a[72:75], v[28:31]
ds_read_b128 a[12:15], v3 offset:2048
v_mfma_f32_16x16x32_bf16 v[28:31], a[36:39], a[76:79], v[28:31]
ds_read_b128 a[16:19], v2 offset:4096
v_add_u32 v5, 0x8000, v5
v_mfma_f32_16x16x32_bf16 v[44:47], a[44:47], a[76:79], v[44:47]
s_add_u32 m0, s76, 36864
ds_read_b128 a[20:23], v3 offset:4096
v_mfma_f32_16x16x32_bf16 v[44:47], a[40:43], a[72:75], v[44:47]
s_add_u32 s64, s70, 33152
ds_read_b128 a[24:27], v2 offset:6144
v_mfma_f32_16x16x32_bf16 v[60:63], a[48:51], a[72:75], v[60:63]
buffer_load_dwordx4 v12, s[32:35], s64 offen lds
v_mfma_f32_16x16x32_bf16 v[60:63], a[52:55], a[76:79], v[60:63]
ds_read_b128 a[28:31], v3 offset:6144
v_mfma_f32_16x16x32_bf16 v[76:79], a[60:63], a[76:79], v[76:79]
ds_read_b64_tr_b16 a[112:113], v9 offset:49152
v_mfma_f32_16x16x32_bf16 v[76:79], a[56:59], a[72:75], v[76:79]
ds_read_b64_tr_b16 a[114:115], v9 offset:50176
v_mfma_f32_16x16x32_bf16 v[140:143], a[56:59], a[80:83], v[140:143]
ds_read_b64_tr_b16 a[116:117], v9 offset:57344
v_mfma_f32_16x16x32_bf16 v[140:143], a[60:63], a[84:87], v[140:143]
s_add_u32 m0, s76, 37888
ds_read_b64_tr_b16 a[118:119], v9 offset:58368
v_add_u32 v6, 0x8000, v6
v_mfma_f32_16x16x32_bf16 v[124:127], a[52:55], a[84:87], v[124:127]
s_add_u32 s64, s70, 41344
ds_read_b64_tr_b16 a[72:73], v10 offset:49152
v_mfma_f32_16x16x32_bf16 v[124:127], a[48:51], a[80:83], v[124:127]
buffer_load_dwordx4 v13, s[32:35], s64 offen lds
v_mfma_f32_16x16x32_bf16 v[108:111], a[40:43], a[80:83], v[108:111]
ds_read_b64_tr_b16 a[74:75], v10 offset:50176
v_mfma_f32_16x16x32_bf16 v[108:111], a[44:47], a[84:87], v[108:111]
ds_read_b64_tr_b16 a[76:77], v10 offset:57344
v_mfma_f32_16x16x32_bf16 v[92:95], a[36:39], a[84:87], v[92:95]
ds_read_b64_tr_b16 a[78:79], v10 offset:58368
v_mfma_f32_16x16x32_bf16 v[92:95], a[32:35], a[80:83], v[92:95]
s_waitcnt lgkmcnt(8)
ds_read_b64_tr_b16 a[80:81], v11 offset:49152
v_mfma_f32_16x16x32_bf16 v[32:35], a[32:35], a[88:91], v[32:35]
s_add_u32 m0, s76, 38912
ds_read_b64_tr_b16 a[82:83], v11 offset:50176
v_mfma_f32_16x16x32_bf16 v[32:35], a[36:39], a[92:95], v[32:35]
s_add_u32 s64, s70, 49536
ds_read_b64_tr_b16 a[84:85], v11 offset:57344
v_add_u32 v7, 0x8000, v7
v_mfma_f32_16x16x32_bf16 v[48:51], a[44:47], a[92:95], v[48:51]
buffer_load_dwordx4 v12, s[32:35], s64 offen lds
v_mfma_f32_16x16x32_bf16 v[48:51], a[40:43], a[88:91], v[48:51]
global_load_dwordx4 a[168:171], v19, s[22:23] offset:1024
v_mfma_f32_16x16x32_bf16 v[64:67], a[48:51], a[88:91], v[64:67]
ds_read_b64_tr_b16 a[86:87], v11 offset:58368
v_mfma_f32_16x16x32_bf16 v[64:67], a[52:55], a[92:95], v[64:67]
v_mfma_f32_16x16x32_bf16 v[80:83], a[60:63], a[92:95], v[80:83]
v_mfma_f32_16x16x32_bf16 v[80:83], a[56:59], a[88:91], v[80:83]
s_add_u32 m0, s76, 39936
v_mfma_f32_16x16x32_bf16 v[144:147], a[56:59], a[96:99], v[144:147]
s_add_u32 s64, s70, 57728
v_mfma_f32_16x16x32_bf16 v[144:147], a[60:63], a[100:103], v[144:147]
buffer_load_dwordx4 v13, s[32:35], s64 offen lds
v_mfma_f32_16x16x32_bf16 v[128:131], a[52:55], a[100:103], v[128:131]
v_add_u32 v8, 0x8000, v8
v_mfma_f32_16x16x32_bf16 v[128:131], a[48:51], a[96:99], v[128:131]
v_mfma_f32_16x16x32_bf16 v[112:115], a[40:43], a[96:99], v[112:115]
v_mfma_f32_16x16x32_bf16 v[112:115], a[44:47], a[100:103], v[112:115]
v_mfma_f32_16x16x32_bf16 v[96:99], a[36:39], a[100:103], v[96:99]
v_add_u32 v9, 0x8000, v9
v_add_u32 v10, 0x8000, v10
v_mfma_f32_16x16x32_bf16 v[96:99], a[32:35], a[96:99], v[96:99]
v_add_u32 v11, 0x8000, v11
v_mfma_f32_16x16x32_bf16 v[36:39], a[32:35], a[104:107], v[36:39]
v_mfma_f32_16x16x32_bf16 v[36:39], a[36:39], a[108:111], v[36:39]
v_mfma_f32_16x16x32_bf16 v[52:55], a[44:47], a[108:111], v[52:55]
s_waitcnt lgkmcnt(0)
s_barrier
v_mfma_f32_16x16x32_bf16 v[52:55], a[40:43], a[104:107], v[52:55]
s_add_u32 m0, s77, 98304
ds_read_b64_tr_b16 a[88:89], v4 offset:32768
v_mfma_f32_16x16x32_bf16 v[68:71], a[48:51], a[104:107], v[68:71]
s_add_u32 s64, s71, 2097152
ds_read_b64_tr_b16 a[90:91], v4 offset:33792
v_mfma_f32_16x16x32_bf16 v[68:71], a[52:55], a[108:111], v[68:71]
buffer_load_dwordx4 v14, s[36:39], s64 offen lds
v_mfma_f32_16x16x32_bf16 v[84:87], a[60:63], a[108:111], v[84:87]
ds_read_b64_tr_b16 a[92:93], v4 offset:40960
v_mfma_f32_16x16x32_bf16 v[84:87], a[56:59], a[104:107], v[84:87]
ds_read_b64_tr_b16 a[94:95], v4 offset:41984
v_mfma_f32_16x16x32_bf16 v[148:151], a[56:59], a[112:115], v[148:151]
global_load_dwordx4 a[156:159], v18, s[4:5] offset:1536
v_mfma_f32_16x16x32_bf16 v[148:151], a[60:63], a[116:119], v[148:151]
ds_read_b64_tr_b16 a[96:97], v5 offset:32768
v_mfma_f32_16x16x32_bf16 v[132:135], a[52:55], a[116:119], v[132:135]
ds_read_b64_tr_b16 a[98:99], v5 offset:33792
v_mfma_f32_16x16x32_bf16 v[132:135], a[48:51], a[112:115], v[132:135]
s_add_u32 m0, s77, 99328
ds_read_b64_tr_b16 a[100:101], v5 offset:40960
v_mfma_f32_16x16x32_bf16 v[116:119], a[40:43], a[112:115], v[116:119]
s_add_u32 s64, s71, 2129920
ds_read_b64_tr_b16 a[102:103], v5 offset:41984
v_mfma_f32_16x16x32_bf16 v[116:119], a[44:47], a[116:119], v[116:119]
buffer_load_dwordx4 v14, s[36:39], s64 offen lds
v_mfma_f32_16x16x32_bf16 v[100:103], a[36:39], a[116:119], v[100:103]
ds_read_b64_tr_b16 a[104:105], v6 offset:32768
v_mfma_f32_16x16x32_bf16 v[100:103], a[32:35], a[112:115], v[100:103]
ds_read_b64_tr_b16 a[106:107], v6 offset:33792
v_mfma_f32_16x16x32_bf16 v[248:251], a[32:35], a[72:75], v[248:251]
ds_read_b64_tr_b16 a[108:109], v6 offset:40960
v_mfma_f32_16x16x32_bf16 v[248:251], a[36:39], a[76:79], v[248:251]
ds_read_b64_tr_b16 a[110:111], v6 offset:41984
v_mfma_f32_16x16x32_bf16 v[252:255], a[44:47], a[76:79], v[252:255]
ds_read_b64_tr_b16 a[112:113], v7 offset:32768
v_mfma_f32_16x16x32_bf16 v[252:255], a[40:43], a[72:75], v[252:255]
s_add_u32 m0, s77, 100352
ds_read_b64_tr_b16 a[114:115], v7 offset:33792
v_mfma_f32_16x16x32_bf16 a[120:123], a[48:51], a[72:75], a[120:123]
s_add_u32 s64, s71, 2162688
ds_read_b64_tr_b16 a[116:117], v7 offset:40960
v_mfma_f32_16x16x32_bf16 a[120:123], a[52:55], a[76:79], a[120:123]
buffer_load_dwordx4 v15, s[36:39], s64 offen lds
v_mfma_f32_16x16x32_bf16 a[124:127], a[60:63], a[76:79], a[124:127]
ds_read_b64_tr_b16 a[118:119], v7 offset:41984
v_mfma_f32_16x16x32_bf16 a[124:127], a[56:59], a[72:75], a[124:127]
ds_read_b64_tr_b16 a[72:73], v8 offset:32768
v_mfma_f32_16x16x32_bf16 a[128:131], a[56:59], a[80:83], a[128:131]
ds_read_b64_tr_b16 a[74:75], v8 offset:33792
v_mfma_f32_16x16x32_bf16 a[128:131], a[60:63], a[84:87], a[128:131]
ds_read_b64_tr_b16 a[76:77], v8 offset:40960
v_mfma_f32_16x16x32_bf16 a[132:135], a[52:55], a[84:87], a[132:135]
ds_read_b64_tr_b16 a[78:79], v8 offset:41984
v_mfma_f32_16x16x32_bf16 a[132:135], a[48:51], a[80:83], a[132:135]
s_add_u32 m0, s77, 101376
v_mfma_f32_16x16x32_bf16 a[136:139], a[40:43], a[80:83], a[136:139]
s_add_u32 s64, s71, 2195456
v_mfma_f32_16x16x32_bf16 a[136:139], a[44:47], a[84:87], a[136:139]
buffer_load_dwordx4 v15, s[36:39], s64 offen lds
v_mfma_f32_16x16x32_bf16 a[140:143], a[36:39], a[84:87], a[140:143]
global_load_dwordx4 a[172:175], v19, s[22:23] offset:1536
v_mfma_f32_16x16x32_bf16 a[140:143], a[32:35], a[80:83], a[140:143]
s_waitcnt lgkmcnt(5)
ds_read_b64_tr_b16 a[80:81], v9 offset:32768
v_mfma_f32_16x16x32_bf16 v[184:187], a[88:91], a[0:3], v[184:187]
ds_read_b64_tr_b16 a[82:83], v9 offset:33792
v_mfma_f32_16x16x32_bf16 v[184:187], a[92:95], a[4:7], v[184:187]
ds_read_b64_tr_b16 a[84:85], v9 offset:40960
v_mfma_f32_16x16x32_bf16 v[192:195], a[92:95], a[12:15], v[192:195]
ds_read_b64_tr_b16 a[86:87], v9 offset:41984
v_mfma_f32_16x16x32_bf16 v[192:195], a[88:91], a[8:11], v[192:195]
s_add_u32 m0, s77, 114688
s_add_u32 s17, s78, .-L_pc+6144
v_mfma_f32_16x16x32_bf16 v[200:203], a[88:91], a[16:19], v[200:203]
s_add_u32 s64, s71, 2097152
buffer_load_dword a252, v16, s[88:91], s17 offen
v_mfma_f32_16x16x32_bf16 v[200:203], a[92:95], a[20:23], v[200:203]
buffer_load_dwordx4 v14, s[40:43], s64 offen lds
v_mfma_f32_16x16x32_bf16 v[208:211], a[92:95], a[28:31], v[208:211]
v_mfma_f32_16x16x32_bf16 v[208:211], a[88:91], a[24:27], v[208:211]
ds_read_b64_tr_b16 a[88:89], v10 offset:32768
v_mfma_f32_16x16x32_bf16 v[212:215], a[96:99], a[24:27], v[212:215]
ds_read_b64_tr_b16 a[90:91], v10 offset:33792
v_mfma_f32_16x16x32_bf16 v[212:215], a[100:103], a[28:31], v[212:215]
ds_read_b64_tr_b16 a[92:93], v10 offset:40960
v_mfma_f32_16x16x32_bf16 v[204:207], a[100:103], a[20:23], v[204:207]
ds_read_b64_tr_b16 a[94:95], v10 offset:41984
v_mfma_f32_16x16x32_bf16 v[204:207], a[96:99], a[16:19], v[204:207]
s_add_u32 m0, s77, 115712
v_mfma_f32_16x16x32_bf16 v[196:199], a[96:99], a[8:11], v[196:199]
s_add_u32 s64, s71, 2129920
v_mfma_f32_16x16x32_bf16 v[196:199], a[100:103], a[12:15], v[196:199]
buffer_load_dwordx4 v14, s[40:43], s64 offen lds
v_mfma_f32_16x16x32_bf16 v[188:191], a[100:103], a[4:7], v[188:191]
v_mfma_f32_16x16x32_bf16 v[188:191], a[96:99], a[0:3], v[188:191]
ds_read_b64_tr_b16 a[96:97], v11 offset:32768
v_mfma_f32_16x16x32_bf16 v[216:219], a[104:107], a[0:3], v[216:219]
ds_read_b64_tr_b16 a[98:99], v11 offset:33792
v_mfma_f32_16x16x32_bf16 v[216:219], a[108:111], a[4:7], v[216:219]
ds_read_b64_tr_b16 a[100:101], v11 offset:40960
v_mfma_f32_16x16x32_bf16 v[224:227], a[108:111], a[12:15], v[224:227]
ds_read_b64_tr_b16 a[102:103], v11 offset:41984
v_mfma_f32_16x16x32_bf16 v[224:227], a[104:107], a[8:11], v[224:227]
s_add_u32 m0, s77, 116736
v_mfma_f32_16x16x32_bf16 v[232:235], a[104:107], a[16:19], v[232:235]
s_add_u32 s64, s71, 2162688
buffer_store_dword v21, v20, s[44:47], s69 offen sc1
v_mfma_f32_16x16x32_bf16 v[232:235], a[108:111], a[20:23], v[232:235]
buffer_load_dwordx4 v15, s[40:43], s64 offen lds
v_mfma_f32_16x16x32_bf16 v[240:243], a[108:111], a[28:31], v[240:243]
v_mfma_f32_16x16x32_bf16 v[240:243], a[104:107], a[24:27], v[240:243]
ds_read_b64_tr_b16 a[104:105], v4 offset:49152
v_mfma_f32_16x16x32_bf16 v[244:247], a[112:115], a[24:27], v[244:247]
s_waitcnt lgkmcnt(5)
buffer_load_dword a252, v16, s[56:59], s81 offen
v_mfma_f32_16x16x32_bf16 v[244:247], a[116:119], a[28:31], v[244:247]
ds_read_b64_tr_b16 a[106:107], v4 offset:50176
v_mfma_f32_16x16x32_bf16 v[236:239], a[116:119], a[20:23], v[236:239]
ds_read_b64_tr_b16 a[108:109], v4 offset:57344
v_mfma_f32_16x16x32_bf16 v[236:239], a[112:115], a[16:19], v[236:239]
s_add_u32 m0, s77, 117760
ds_read_b64_tr_b16 a[110:111], v4 offset:58368
v_mfma_f32_16x16x32_bf16 v[228:231], a[112:115], a[8:11], v[228:231]
s_add_u32 s64, s71, 2195456
v_mfma_f32_16x16x32_bf16 v[228:231], a[116:119], a[12:15], v[228:231]
buffer_load_dwordx4 v15, s[40:43], s64 offen lds
v_mfma_f32_16x16x32_bf16 v[220:223], a[116:119], a[4:7], v[220:223]
v_mfma_f32_16x16x32_bf16 v[220:223], a[112:115], a[0:3], v[220:223]
ds_read_b64_tr_b16 a[112:113], v5 offset:49152
v_mfma_f32_16x16x32_bf16 v[152:155], a[72:75], a[0:3], v[152:155]
ds_read_b64_tr_b16 a[114:115], v5 offset:50176
v_mfma_f32_16x16x32_bf16 v[152:155], a[76:79], a[4:7], v[152:155]
ds_read_b64_tr_b16 a[116:117], v5 offset:57344
v_mfma_f32_16x16x32_bf16 v[160:163], a[76:79], a[12:15], v[160:163]
ds_read_b64_tr_b16 a[118:119], v5 offset:58368
v_mfma_f32_16x16x32_bf16 v[160:163], a[72:75], a[8:11], v[160:163]
v_mfma_f32_16x16x32_bf16 v[168:171], a[72:75], a[16:19], v[168:171]
v_mfma_f32_16x16x32_bf16 v[168:171], a[76:79], a[20:23], v[168:171]
v_mfma_f32_16x16x32_bf16 v[176:179], a[76:79], a[28:31], v[176:179]
s_add_u32 m0, s76, 0
v_mfma_f32_16x16x32_bf16 v[176:179], a[72:75], a[24:27], v[176:179]
s_add_u32 s64, s70, 512
ds_read_b64_tr_b16 a[72:73], v6 offset:49152
v_mfma_f32_16x16x32_bf16 v[180:183], a[80:83], a[24:27], v[180:183]
buffer_load_dwordx4 v12, s[32:35], s64 offen lds
v_mfma_f32_16x16x32_bf16 v[180:183], a[84:87], a[28:31], v[180:183]
ds_read_b64_tr_b16 a[74:75], v6 offset:50176
v_mfma_f32_16x16x32_bf16 v[172:175], a[84:87], a[20:23], v[172:175]
ds_read_b64_tr_b16 a[76:77], v6 offset:57344
v_mfma_f32_16x16x32_bf16 v[172:175], a[80:83], a[16:19], v[172:175]
ds_read_b64_tr_b16 a[78:79], v6 offset:58368
v_mfma_f32_16x16x32_bf16 v[164:167], a[80:83], a[8:11], v[164:167]
v_mfma_f32_16x16x32_bf16 v[164:167], a[84:87], a[12:15], v[164:167]
s_add_u32 m0, s76, 1024
v_mfma_f32_16x16x32_bf16 v[156:159], a[84:87], a[4:7], v[156:159]
s_add_u32 s64, s70, 8704
v_mfma_f32_16x16x32_bf16 v[156:159], a[80:83], a[0:3], v[156:159]
buffer_load_dwordx4 v13, s[32:35], s64 offen lds
v_mfma_f32_16x16x32_bf16 v[24:27], a[88:91], a[0:3], v[24:27]
ds_read_b64_tr_b16 a[80:81], v7 offset:49152
v_mfma_f32_16x16x32_bf16 v[24:27], a[92:95], a[4:7], v[24:27]
ds_read_b64_tr_b16 a[82:83], v7 offset:50176
v_mfma_f32_16x16x32_bf16 v[40:43], a[92:95], a[12:15], v[40:43]
ds_read_b64_tr_b16 a[84:85], v7 offset:57344
v_mfma_f32_16x16x32_bf16 v[40:43], a[88:91], a[8:11], v[40:43]
ds_read_b64_tr_b16 a[86:87], v7 offset:58368
v_mfma_f32_16x16x32_bf16 v[56:59], a[88:91], a[16:19], v[56:59]
s_add_u32 m0, s76, 2048
v_mfma_f32_16x16x32_bf16 v[56:59], a[92:95], a[20:23], v[56:59]
s_add_u32 s64, s70, 16896
v_mfma_f32_16x16x32_bf16 v[72:75], a[92:95], a[28:31], v[72:75]
s_waitcnt vmcnt(15)
buffer_load_dwordx4 v12, s[32:35], s64 offen lds
v_mfma_f32_16x16x32_bf16 v[72:75], a[88:91], a[24:27], v[72:75]
s_waitcnt lgkmcnt(4)
ds_read_b64_tr_b16 a[88:89], v8 offset:49152
v_mfma_f32_16x16x32_bf16 v[136:139], a[96:99], a[24:27], v[136:139]
buffer_load_dword a252, v1, s[60:63], s82 offen
v_mfma_f32_16x16x32_bf16 v[136:139], a[100:103], a[28:31], v[136:139]
ds_read_b64_tr_b16 a[90:91], v8 offset:50176
v_subrev_u32 v4, 0x8000, v4
v_mfma_f32_16x16x32_bf16 v[120:123], a[100:103], a[20:23], v[120:123]
ds_read_b64_tr_b16 a[92:93], v8 offset:57344
v_mfma_f32_16x16x32_bf16 v[120:123], a[96:99], a[16:19], v[120:123]
s_add_u32 m0, s76, 3072
ds_read_b64_tr_b16 a[94:95], v8 offset:58368
v_mfma_f32_16x16x32_bf16 v[104:107], a[96:99], a[8:11], v[104:107]
s_add_u32 s64, s70, 25088
ds_read_b128 a[32:35], v2 offset:32768
v_mfma_f32_16x16x32_bf16 v[104:107], a[100:103], a[12:15], v[104:107]
buffer_load_dwordx4 v13, s[32:35], s64 offen lds
v_mfma_f32_16x16x32_bf16 v[88:91], a[100:103], a[4:7], v[88:91]
ds_read_b128 a[36:39], v3 offset:32768
v_mfma_f32_16x16x32_bf16 v[88:91], a[96:99], a[0:3], v[88:91]
ds_read_b128 a[40:43], v2 offset:34816
v_mfma_f32_16x16x32_bf16 v[28:31], a[0:3], a[104:107], v[28:31]
ds_read_b128 a[44:47], v3 offset:34816
v_mfma_f32_16x16x32_bf16 v[28:31], a[4:7], a[108:111], v[28:31]
ds_read_b128 a[48:51], v2 offset:36864
v_subrev_u32 v5, 0x8000, v5
v_mfma_f32_16x16x32_bf16 v[44:47], a[12:15], a[108:111], v[44:47]
s_add_u32 m0, s76, 4096
ds_read_b128 a[52:55], v3 offset:36864
v_mfma_f32_16x16x32_bf16 v[44:47], a[8:11], a[104:107], v[44:47]
s_add_u32 s64, s70, 33280
ds_read_b128 a[56:59], v2 offset:38912
v_mfma_f32_16x16x32_bf16 v[60:63], a[16:19], a[104:107], v[60:63]
buffer_load_dwordx4 v12, s[32:35], s64 offen lds
v_mfma_f32_16x16x32_bf16 v[60:63], a[20:23], a[108:111], v[60:63]
ds_read_b128 a[60:63], v3 offset:38912
v_mfma_f32_16x16x32_bf16 v[76:79], a[28:31], a[108:111], v[76:79]
ds_read_b64_tr_b16 a[96:97], v9 offset:49152
v_mfma_f32_16x16x32_bf16 v[76:79], a[24:27], a[104:107], v[76:79]
ds_read_b64_tr_b16 a[98:99], v9 offset:50176
v_mfma_f32_16x16x32_bf16 v[140:143], a[24:27], a[112:115], v[140:143]
ds_read_b64_tr_b16 a[100:101], v9 offset:57344
v_mfma_f32_16x16x32_bf16 v[140:143], a[28:31], a[116:119], v[140:143]
s_add_u32 m0, s76, 5120
ds_read_b64_tr_b16 a[102:103], v9 offset:58368
v_subrev_u32 v6, 0x8000, v6
v_mfma_f32_16x16x32_bf16 v[124:127], a[20:23], a[116:119], v[124:127]
s_add_u32 s64, s70, 41472
ds_read_b64_tr_b16 a[104:105], v10 offset:49152
v_mfma_f32_16x16x32_bf16 v[124:127], a[16:19], a[112:115], v[124:127]
buffer_load_dwordx4 v13, s[32:35], s64 offen lds
v_mfma_f32_16x16x32_bf16 v[108:111], a[8:11], a[112:115], v[108:111]
ds_read_b64_tr_b16 a[106:107], v10 offset:50176
v_mfma_f32_16x16x32_bf16 v[108:111], a[12:15], a[116:119], v[108:111]
ds_read_b64_tr_b16 a[108:109], v10 offset:57344
v_mfma_f32_16x16x32_bf16 v[92:95], a[4:7], a[116:119], v[92:95]
ds_read_b64_tr_b16 a[110:111], v10 offset:58368
v_mfma_f32_16x16x32_bf16 v[92:95], a[0:3], a[112:115], v[92:95]
ds_read_b64_tr_b16 a[112:113], v11 offset:49152
v_mfma_f32_16x16x32_bf16 v[32:35], a[0:3], a[72:75], v[32:35]
s_add_u32 m0, s76, 6144
ds_read_b64_tr_b16 a[114:115], v11 offset:50176
v_mfma_f32_16x16x32_bf16 v[32:35], a[4:7], a[76:79], v[32:35]
s_add_u32 s64, s70, 49664
ds_read_b64_tr_b16 a[116:117], v11 offset:57344
v_subrev_u32 v7, 0x8000, v7
v_mfma_f32_16x16x32_bf16 v[48:51], a[12:15], a[76:79], v[48:51]
buffer_load_dwordx4 v12, s[32:35], s64 offen lds
v_mfma_f32_16x16x32_bf16 v[48:51], a[8:11], a[72:75], v[48:51]
ds_read_b64_tr_b16 a[118:119], v11 offset:58368
v_mfma_f32_16x16x32_bf16 v[64:67], a[16:19], a[72:75], v[64:67]
v_mfma_f32_16x16x32_bf16 v[64:67], a[20:23], a[76:79], v[64:67]
v_mfma_f32_16x16x32_bf16 v[80:83], a[28:31], a[76:79], v[80:83]
v_mfma_f32_16x16x32_bf16 v[80:83], a[24:27], a[72:75], v[80:83]
s_waitcnt lgkmcnt(5)
s_add_u32 m0, s76, 7168
s_add_u32 s81, s81, 1048576
v_mfma_f32_16x16x32_bf16 v[144:147], a[24:27], a[80:83], v[144:147]
s_add_u32 s64, s70, 57856
buffer_load_dword a252, v16, s[56:59], s81 offen
v_mfma_f32_16x16x32_bf16 v[144:147], a[28:31], a[84:87], v[144:147]
buffer_load_dwordx4 v13, s[32:35], s64 offen lds
v_mfma_f32_16x16x32_bf16 v[128:131], a[20:23], a[84:87], v[128:131]
v_subrev_u32 v8, 0x8000, v8
v_mfma_f32_16x16x32_bf16 v[128:131], a[16:19], a[80:83], v[128:131]
v_mfma_f32_16x16x32_bf16 v[112:115], a[8:11], a[80:83], v[112:115]
v_mfma_f32_16x16x32_bf16 v[112:115], a[12:15], a[84:87], v[112:115]
v_mfma_f32_16x16x32_bf16 v[96:99], a[4:7], a[84:87], v[96:99]
v_subrev_u32 v9, 0x8000, v9
v_subrev_u32 v10, 0x8000, v10
v_mfma_f32_16x16x32_bf16 v[96:99], a[0:3], a[80:83], v[96:99]
v_subrev_u32 v11, 0x8000, v11
v_mfma_f32_16x16x32_bf16 v[36:39], a[0:3], a[88:91], v[36:39]
v_mfma_f32_16x16x32_bf16 v[36:39], a[4:7], a[92:95], v[36:39]
v_mfma_f32_16x16x32_bf16 v[52:55], a[12:15], a[92:95], v[52:55]
s_waitcnt lgkmcnt(0)
s_barrier
v_mfma_f32_16x16x32_bf16 v[52:55], a[8:11], a[88:91], v[52:55]
s_add_u32 m0, s77, 131072
ds_read_b64_tr_b16 a[72:73], v4 offset:0
v_mfma_f32_16x16x32_bf16 v[68:71], a[16:19], a[88:91], v[68:71]
s_add_u32 s64, s71, 2621440
ds_read_b64_tr_b16 a[74:75], v4 offset:1024
v_mfma_f32_16x16x32_bf16 v[68:71], a[20:23], a[92:95], v[68:71]
buffer_load_dwordx4 v14, s[36:39], s64 offen lds
v_mfma_f32_16x16x32_bf16 v[84:87], a[28:31], a[92:95], v[84:87]
ds_read_b64_tr_b16 a[76:77], v4 offset:8192
v_mfma_f32_16x16x32_bf16 v[84:87], a[24:27], a[88:91], v[84:87]
ds_read_b64_tr_b16 a[78:79], v4 offset:9216
v_mfma_f32_16x16x32_bf16 v[148:151], a[24:27], a[96:99], v[148:151]
ds_read_b64_tr_b16 a[80:81], v5 offset:0
v_mfma_f32_16x16x32_bf16 v[148:151], a[28:31], a[100:103], v[148:151]
ds_read_b64_tr_b16 a[82:83], v5 offset:1024
v_mfma_f32_16x16x32_bf16 v[132:135], a[20:23], a[100:103], v[132:135]
ds_read_b64_tr_b16 a[84:85], v5 offset:8192
v_mfma_f32_16x16x32_bf16 v[132:135], a[16:19], a[96:99], v[132:135]
s_add_u32 m0, s77, 132096
ds_read_b64_tr_b16 a[86:87], v5 offset:9216
v_mfma_f32_16x16x32_bf16 v[116:119], a[8:11], a[96:99], v[116:119]
s_add_u32 s64, s71, 2654208
ds_read_b64_tr_b16 a[88:89], v6 offset:0
v_mfma_f32_16x16x32_bf16 v[116:119], a[12:15], a[100:103], v[116:119]
buffer_load_dwordx4 v14, s[36:39], s64 offen lds
v_mfma_f32_16x16x32_bf16 v[100:103], a[4:7], a[100:103], v[100:103]
ds_read_b64_tr_b16 a[90:91], v6 offset:1024
v_mfma_f32_16x16x32_bf16 v[100:103], a[0:3], a[96:99], v[100:103]
ds_read_b64_tr_b16 a[92:93], v6 offset:8192
v_mfma_f32_16x16x32_bf16 v[248:251], a[0:3], a[104:107], v[248:251]
ds_read_b64_tr_b16 a[94:95], v6 offset:9216
v_mfma_f32_16x16x32_bf16 v[248:251], a[4:7], a[108:111], v[248:251]
ds_read_b64_tr_b16 a[96:97], v7 offset:0
v_mfma_f32_16x16x32_bf16 v[252:255], a[12:15], a[108:111], v[252:255]
ds_read_b64_tr_b16 a[98:99], v7 offset:1024
v_mfma_f32_16x16x32_bf16 v[252:255], a[8:11], a[104:107], v[252:255]
s_add_u32 m0, s77, 133120
ds_read_b64_tr_b16 a[100:101], v7 offset:8192
v_mfma_f32_16x16x32_bf16 a[120:123], a[16:19], a[104:107], a[120:123]
s_add_u32 s64, s71, 2686976
ds_read_b64_tr_b16 a[102:103], v7 offset:9216
v_mfma_f32_16x16x32_bf16 a[120:123], a[20:23], a[108:111], a[120:123]
buffer_load_dwordx4 v15, s[36:39], s64 offen lds
v_mfma_f32_16x16x32_bf16 a[124:127], a[28:31], a[108:111], a[124:127]
v_mfma_f32_16x16x32_bf16 a[124:127], a[24:27], a[104:107], a[124:127]
s_add_u32 s82, s82, 1048576
ds_read_b64_tr_b16 a[104:105], v8 offset:0
v_mfma_f32_16x16x32_bf16 a[128:131], a[24:27], a[112:115], a[128:131]
buffer_load_dword a252, v1, s[60:63], s82 offen
v_mfma_f32_16x16x32_bf16 a[128:131], a[28:31], a[116:119], a[128:131]
ds_read_b64_tr_b16 a[106:107], v8 offset:1024
v_mfma_f32_16x16x32_bf16 a[132:135], a[20:23], a[116:119], a[132:135]
ds_read_b64_tr_b16 a[108:109], v8 offset:8192
v_mfma_f32_16x16x32_bf16 a[132:135], a[16:19], a[112:115], a[132:135]
s_add_u32 m0, s77, 134144
ds_read_b64_tr_b16 a[110:111], v8 offset:9216
v_mfma_f32_16x16x32_bf16 a[136:139], a[8:11], a[112:115], a[136:139]
s_add_u32 s64, s71, 2719744
v_mfma_f32_16x16x32_bf16 a[136:139], a[12:15], a[116:119], a[136:139]
buffer_load_dwordx4 v15, s[36:39], s64 offen lds
v_mfma_f32_16x16x32_bf16 a[140:143], a[4:7], a[116:119], a[140:143]
v_mfma_f32_16x16x32_bf16 a[140:143], a[0:3], a[112:115], a[140:143]
s_waitcnt lgkmcnt(4)
ds_read_b64_tr_b16 a[112:113], v9 offset:0
v_mfma_f32_16x16x32_bf16 v[184:187], a[72:75], a[32:35], v[184:187]
ds_read_b64_tr_b16 a[114:115], v9 offset:1024
v_mov_b32 v17, 0
v_mfma_f32_16x16x32_bf16 v[184:187], a[76:79], a[36:39], v[184:187]
ds_read_b64_tr_b16 a[116:117], v9 offset:8192
v_accvgpr_read_b32 v19, a144
v_mfma_f32_16x16x32_bf16 v[192:195], a[76:79], a[44:47], v[192:195]
ds_read_b64_tr_b16 a[118:119], v9 offset:9216
v_accvgpr_read_b32 v21, a160
v_mfma_f32_16x16x32_bf16 v[192:195], a[72:75], a[40:43], v[192:195]
s_add_u32 m0, s77, 147456
v_lshlrev_b32 v18, 16, v19
v_and_b32 v19, 0xffff0000, v19
v_mfma_f32_16x16x32_bf16 v[200:203], a[72:75], a[48:51], v[200:203]
s_add_u32 s64, s71, 2621440
v_lshlrev_b32 v20, 16, v21
v_and_b32 v21, 0xffff0000, v21
v_mfma_f32_16x16x32_bf16 v[200:203], a[76:79], a[52:55], v[200:203]
buffer_load_dwordx4 v14, s[40:43], s64 offen lds
v_mfma_f32_16x16x32_bf16 v[208:211], a[76:79], a[60:63], v[208:211]
v_mul_f32 v18, v18, v20
v_mul_f32 v19, v19, v21
v_mfma_f32_16x16x32_bf16 v[208:211], a[72:75], a[56:59], v[208:211]
ds_read_b64_tr_b16 a[72:73], v10 offset:0
v_cvt_pk_bf16_f32 v18, v18, v19
v_mfma_f32_16x16x32_bf16 v[212:215], a[80:83], a[56:59], v[212:215]
ds_read_b64_tr_b16 a[74:75], v10 offset:1024
v_lshlrev_b32 v19, 16, v18
v_mfma_f32_16x16x32_bf16 v[212:215], a[84:87], a[60:63], v[212:215]
ds_read_b64_tr_b16 a[76:77], v10 offset:8192
v_and_b32 v18, 0xffff0000, v18
v_mfma_f32_16x16x32_bf16 v[204:207], a[84:87], a[52:55], v[204:207]
ds_read_b64_tr_b16 a[78:79], v10 offset:9216
v_add_f32 v17, v17, v19
v_mfma_f32_16x16x32_bf16 v[204:207], a[80:83], a[48:51], v[204:207]
s_add_u32 m0, s77, 148480
v_add_f32 v17, v17, v18
v_accvgpr_read_b32 v19, a145
v_mfma_f32_16x16x32_bf16 v[196:199], a[80:83], a[40:43], v[196:199]
s_add_u32 s64, s71, 2654208
v_accvgpr_read_b32 v21, a161
v_lshlrev_b32 v18, 16, v19
v_mfma_f32_16x16x32_bf16 v[196:199], a[84:87], a[44:47], v[196:199]
buffer_load_dwordx4 v14, s[40:43], s64 offen lds
v_mfma_f32_16x16x32_bf16 v[188:191], a[84:87], a[36:39], v[188:191]
v_and_b32 v19, 0xffff0000, v19
v_lshlrev_b32 v20, 16, v21
v_mfma_f32_16x16x32_bf16 v[188:191], a[80:83], a[32:35], v[188:191]
ds_read_b64_tr_b16 a[80:81], v11 offset:0
v_and_b32 v21, 0xffff0000, v21
v_mfma_f32_16x16x32_bf16 v[216:219], a[88:91], a[32:35], v[216:219]
ds_read_b64_tr_b16 a[82:83], v11 offset:1024
v_mul_f32 v18, v18, v20
v_mfma_f32_16x16x32_bf16 v[216:219], a[92:95], a[36:39], v[216:219]
ds_read_b64_tr_b16 a[84:85], v11 offset:8192
v_mul_f32 v19, v19, v21
v_mfma_f32_16x16x32_bf16 v[224:227], a[92:95], a[44:47], v[224:227]
ds_read_b64_tr_b16 a[86:87], v11 offset:9216
v_cvt_pk_bf16_f32 v18, v18, v19
v_mfma_f32_16x16x32_bf16 v[224:227], a[88:91], a[40:43], v[224:227]
s_add_u32 m0, s77, 149504
v_lshlrev_b32 v19, 16, v18
v_and_b32 v18, 0xffff0000, v18
v_mfma_f32_16x16x32_bf16 v[232:235], a[88:91], a[48:51], v[232:235]
s_add_u32 s64, s71, 2686976
v_add_f32 v17, v17, v19
v_add_f32 v17, v17, v18
v_mfma_f32_16x16x32_bf16 v[232:235], a[92:95], a[52:55], v[232:235]
buffer_load_dwordx4 v15, s[40:43], s64 offen lds
v_mfma_f32_16x16x32_bf16 v[240:243], a[92:95], a[60:63], v[240:243]
v_accvgpr_read_b32 v19, a146
v_accvgpr_read_b32 v21, a162
v_mfma_f32_16x16x32_bf16 v[240:243], a[88:91], a[56:59], v[240:243]
s_add_u32 s81, s81, 1048576
ds_read_b64_tr_b16 a[88:89], v4 offset:16384
v_lshlrev_b32 v18, 16, v19
v_mfma_f32_16x16x32_bf16 v[244:247], a[96:99], a[56:59], v[244:247]
buffer_load_dword a252, v16, s[56:59], s81 offen
v_mfma_f32_16x16x32_bf16 v[244:247], a[100:103], a[60:63], v[244:247]
ds_read_b64_tr_b16 a[90:91], v4 offset:17408
v_and_b32 v19, 0xffff0000, v19
v_mfma_f32_16x16x32_bf16 v[236:239], a[100:103], a[52:55], v[236:239]
ds_read_b64_tr_b16 a[92:93], v4 offset:24576
v_lshlrev_b32 v20, 16, v21
v_mfma_f32_16x16x32_bf16 v[236:239], a[96:99], a[48:51], v[236:239]
s_add_u32 m0, s77, 150528
ds_read_b64_tr_b16 a[94:95], v4 offset:25600
v_and_b32 v21, 0xffff0000, v21
v_mfma_f32_16x16x32_bf16 v[228:231], a[96:99], a[40:43], v[228:231]
s_add_u32 s64, s71, 2719744
v_mul_f32 v18, v18, v20
v_mul_f32 v19, v19, v21
v_mfma_f32_16x16x32_bf16 v[228:231], a[100:103], a[44:47], v[228:231]
buffer_load_dwordx4 v15, s[40:43], s64 offen lds
v_mfma_f32_16x16x32_bf16 v[220:223], a[100:103], a[36:39], v[220:223]
v_cvt_pk_bf16_f32 v18, v18, v19
v_lshlrev_b32 v19, 16, v18
v_mfma_f32_16x16x32_bf16 v[220:223], a[96:99], a[32:35], v[220:223]
s_waitcnt lgkmcnt(4)
ds_read_b64_tr_b16 a[96:97], v5 offset:16384
v_and_b32 v18, 0xffff0000, v18
v_mfma_f32_16x16x32_bf16 v[152:155], a[104:107], a[32:35], v[152:155]
ds_read_b64_tr_b16 a[98:99], v5 offset:17408
v_add_f32 v17, v17, v19
v_mfma_f32_16x16x32_bf16 v[152:155], a[108:111], a[36:39], v[152:155]
ds_read_b64_tr_b16 a[100:101], v5 offset:24576
v_add_f32 v17, v17, v18
v_mfma_f32_16x16x32_bf16 v[160:163], a[108:111], a[44:47], v[160:163]
ds_read_b64_tr_b16 a[102:103], v5 offset:25600
v_accvgpr_read_b32 v19, a147
v_mfma_f32_16x16x32_bf16 v[160:163], a[104:107], a[40:43], v[160:163]
v_accvgpr_read_b32 v21, a163
v_lshlrev_b32 v18, 16, v19
v_mfma_f32_16x16x32_bf16 v[168:171], a[104:107], a[48:51], v[168:171]
v_and_b32 v19, 0xffff0000, v19
v_lshlrev_b32 v20, 16, v21
v_mfma_f32_16x16x32_bf16 v[168:171], a[108:111], a[52:55], v[168:171]
v_and_b32 v21, 0xffff0000, v21
v_mul_f32 v18, v18, v20
v_mfma_f32_16x16x32_bf16 v[176:179], a[108:111], a[60:63], v[176:179]
s_add_u32 m0, s76, 32768
v_mul_f32 v19, v19, v21
v_cvt_pk_bf16_f32 v18, v18, v19
v_mfma_f32_16x16x32_bf16 v[176:179], a[104:107], a[56:59], v[176:179]
s_add_u32 s64, s70, 640
ds_read_b64_tr_b16 a[104:105], v6 offset:16384
v_lshlrev_b32 v19, 16, v18
v_mfma_f32_16x16x32_bf16 v[180:183], a[112:115], a[56:59], v[180:183]
buffer_load_dwordx4 v12, s[32:35], s64 offen lds
v_mfma_f32_16x16x32_bf16 v[180:183], a[116:119], a[60:63], v[180:183]
ds_read_b64_tr_b16 a[106:107], v6 offset:17408
v_and_b32 v18, 0xffff0000, v18
v_mfma_f32_16x16x32_bf16 v[172:175], a[116:119], a[52:55], v[172:175]
ds_read_b64_tr_b16 a[108:109], v6 offset:24576
v_add_f32 v17, v17, v19
v_mfma_f32_16x16x32_bf16 v[172:175], a[112:115], a[48:51], v[172:175]
ds_read_b64_tr_b16 a[110:111], v6 offset:25600
v_add_f32 v17, v17, v18
v_mfma_f32_16x16x32_bf16 v[164:167], a[112:115], a[40:43], v[164:167]
v_accvgpr_read_b32 v19, a148
v_accvgpr_read_b32 v21, a164
v_mfma_f32_16x16x32_bf16 v[164:167], a[116:119], a[44:47], v[164:167]
s_add_u32 m0, s76, 33792
v_lshlrev_b32 v18, 16, v19
v_and_b32 v19, 0xffff0000, v19
v_mfma_f32_16x16x32_bf16 v[156:159], a[116:119], a[36:39], v[156:159]
s_add_u32 s64, s70, 8832
v_lshlrev_b32 v20, 16, v21
v_and_b32 v21, 0xffff0000, v21
v_mfma_f32_16x16x32_bf16 v[156:159], a[112:115], a[32:35], v[156:159]
buffer_load_dwordx4 v13, s[32:35], s64 offen lds
v_mfma_f32_16x16x32_bf16 v[24:27], a[72:75], a[32:35], v[24:27]
ds_read_b64_tr_b16 a[112:113], v7 offset:16384
v_mul_f32 v18, v18, v20
v_mfma_f32_16x16x32_bf16 v[24:27], a[76:79], a[36:39], v[24:27]
ds_read_b64_tr_b16 a[114:115], v7 offset:17408
v_mul_f32 v19, v19, v21
v_mfma_f32_16x16x32_bf16 v[40:43], a[76:79], a[44:47], v[40:43]
ds_read_b64_tr_b16 a[116:117], v7 offset:24576
v_cvt_pk_bf16_f32 v18, v18, v19
v_mfma_f32_16x16x32_bf16 v[40:43], a[72:75], a[40:43], v[40:43]
ds_read_b64_tr_b16 a[118:119], v7 offset:25600
v_lshlrev_b32 v19, 16, v18
v_mfma_f32_16x16x32_bf16 v[56:59], a[72:75], a[48:51], v[56:59]
s_add_u32 m0, s76, 34816
v_and_b32 v18, 0xffff0000, v18
v_add_f32 v17, v17, v19
v_mfma_f32_16x16x32_bf16 v[56:59], a[76:79], a[52:55], v[56:59]
s_add_u32 s64, s70, 17024
v_add_f32 v17, v17, v18
v_accvgpr_read_b32 v19, a149
v_mfma_f32_16x16x32_bf16 v[72:75], a[76:79], a[60:63], v[72:75]
s_waitcnt vmcnt(12)
buffer_load_dwordx4 v12, s[32:35], s64 offen lds
v_mfma_f32_16x16x32_bf16 v[72:75], a[72:75], a[56:59], v[72:75]
s_add_u32 s81, s81, 1048576
ds_read_b64_tr_b16 a[72:73], v8 offset:16384
v_accvgpr_read_b32 v21, a165
v_mfma_f32_16x16x32_bf16 v[136:139], a[80:83], a[56:59], v[136:139]
buffer_load_dword a252, v16, s[56:59], s81 offen
v_mfma_f32_16x16x32_bf16 v[136:139], a[84:87], a[60:63], v[136:139]
ds_read_b64_tr_b16 a[74:75], v8 offset:17408
v_lshlrev_b32 v18, 16, v19
v_mfma_f32_16x16x32_bf16 v[120:123], a[84:87], a[52:55], v[120:123]
ds_read_b64_tr_b16 a[76:77], v8 offset:24576
v_and_b32 v19, 0xffff0000, v19
v_mfma_f32_16x16x32_bf16 v[120:123], a[80:83], a[48:51], v[120:123]
s_add_u32 m0, s76, 35840
ds_read_b64_tr_b16 a[78:79], v8 offset:25600
v_lshlrev_b32 v20, 16, v21
v_mfma_f32_16x16x32_bf16 v[104:107], a[80:83], a[40:43], v[104:107]
s_add_u32 s64, s70, 25216
ds_read_b128 a[0:3], v2 offset:0
v_and_b32 v21, 0xffff0000, v21
v_mfma_f32_16x16x32_bf16 v[104:107], a[84:87], a[44:47], v[104:107]
buffer_load_dwordx4 v13, s[32:35], s64 offen lds
v_mfma_f32_16x16x32_bf16 v[88:91], a[84:87], a[36:39], v[88:91]
ds_read_b128 a[4:7], v3 offset:0
v_mul_f32 v18, v18, v20
v_mfma_f32_16x16x32_bf16 v[88:91], a[80:83], a[32:35], v[88:91]
s_waitcnt lgkmcnt(6)
ds_read_b128 a[8:11], v2 offset:2048
v_mul_f32 v19, v19, v21
v_mfma_f32_16x16x32_bf16 v[28:31], a[32:35], a[88:91], v[28:31]
ds_read_b128 a[12:15], v3 offset:2048
v_cvt_pk_bf16_f32 v18, v18, v19
v_mfma_f32_16x16x32_bf16 v[28:31], a[36:39], a[92:95], v[28:31]
ds_read_b128 a[16:19], v2 offset:4096
v_lshlrev_b32 v19, 16, v18
v_mfma_f32_16x16x32_bf16 v[44:47], a[44:47], a[92:95], v[44:47]
s_add_u32 m0, s76, 36864
ds_read_b128 a[20:23], v3 offset:4096
v_and_b32 v18, 0xffff0000, v18
v_mfma_f32_16x16x32_bf16 v[44:47], a[40:43], a[88:91], v[44:47]
s_add_u32 s64, s70, 33408
ds_read_b128 a[24:27], v2 offset:6144
v_add_f32 v17, v17, v19
v_mfma_f32_16x16x32_bf16 v[60:63], a[48:51], a[88:91], v[60:63]
buffer_load_dwordx4 v12, s[32:35], s64 offen lds
v_mfma_f32_16x16x32_bf16 v[60:63], a[52:55], a[92:95], v[60:63]
ds_read_b128 a[28:31], v3 offset:6144
v_add_f32 v17, v17, v18
v_mfma_f32_16x16x32_bf16 v[76:79], a[60:63], a[92:95], v[76:79]
ds_read_b64_tr_b16 a[80:81], v9 offset:16384
v_accvgpr_read_b32 v19, a150
v_mfma_f32_16x16x32_bf16 v[76:79], a[56:59], a[88:91], v[76:79]
ds_read_b64_tr_b16 a[82:83], v9 offset:17408
v_accvgpr_read_b32 v21, a166
v_mfma_f32_16x16x32_bf16 v[140:143], a[56:59], a[96:99], v[140:143]
ds_read_b64_tr_b16 a[84:85], v9 offset:24576
v_lshlrev_b32 v18, 16, v19
v_mfma_f32_16x16x32_bf16 v[140:143], a[60:63], a[100:103], v[140:143]
s_add_u32 m0, s76, 37888
ds_read_b64_tr_b16 a[86:87], v9 offset:25600
v_and_b32 v19, 0xffff0000, v19
v_mfma_f32_16x16x32_bf16 v[124:127], a[52:55], a[100:103], v[124:127]
s_add_u32 s64, s70, 41600
ds_read_b64_tr_b16 a[88:89], v10 offset:16384
v_lshlrev_b32 v20, 16, v21
v_mfma_f32_16x16x32_bf16 v[124:127], a[48:51], a[96:99], v[124:127]
buffer_load_dwordx4 v13, s[32:35], s64 offen lds
v_mfma_f32_16x16x32_bf16 v[108:111], a[40:43], a[96:99], v[108:111]
ds_read_b64_tr_b16 a[90:91], v10 offset:17408
v_and_b32 v21, 0xffff0000, v21
v_mfma_f32_16x16x32_bf16 v[108:111], a[44:47], a[100:103], v[108:111]
ds_read_b64_tr_b16 a[92:93], v10 offset:24576
v_mul_f32 v18, v18, v20
v_mfma_f32_16x16x32_bf16 v[92:95], a[36:39], a[100:103], v[92:95]
ds_read_b64_tr_b16 a[94:95], v10 offset:25600
v_mul_f32 v19, v19, v21
v_mfma_f32_16x16x32_bf16 v[92:95], a[32:35], a[96:99], v[92:95]
ds_read_b64_tr_b16 a[96:97], v11 offset:16384
v_cvt_pk_bf16_f32 v18, v18, v19
v_mfma_f32_16x16x32_bf16 v[32:35], a[32:35], a[104:107], v[32:35]
s_add_u32 m0, s76, 38912
ds_read_b64_tr_b16 a[98:99], v11 offset:17408
v_lshlrev_b32 v19, 16, v18
v_mfma_f32_16x16x32_bf16 v[32:35], a[36:39], a[108:111], v[32:35]
s_add_u32 s64, s70, 49792
ds_read_b64_tr_b16 a[100:101], v11 offset:24576
v_and_b32 v18, 0xffff0000, v18
v_mfma_f32_16x16x32_bf16 v[48:51], a[44:47], a[108:111], v[48:51]
buffer_load_dwordx4 v12, s[32:35], s64 offen lds
v_mfma_f32_16x16x32_bf16 v[48:51], a[40:43], a[104:107], v[48:51]
ds_read_b64_tr_b16 a[102:103], v11 offset:25600
v_add_f32 v17, v17, v19
v_mfma_f32_16x16x32_bf16 v[64:67], a[48:51], a[104:107], v[64:67]
v_add_f32 v17, v17, v18
v_accvgpr_read_b32 v19, a151
v_mfma_f32_16x16x32_bf16 v[64:67], a[52:55], a[108:111], v[64:67]
v_accvgpr_read_b32 v21, a167
v_lshlrev_b32 v18, 16, v19
v_mfma_f32_16x16x32_bf16 v[80:83], a[60:63], a[108:111], v[80:83]
s_add_u32 s82, s82, 1048576
v_and_b32 v19, 0xffff0000, v19
v_lshlrev_b32 v20, 16, v21
v_mfma_f32_16x16x32_bf16 v[80:83], a[56:59], a[104:107], v[80:83]
s_add_u32 m0, s76, 39936
v_and_b32 v21, 0xffff0000, v21
v_mul_f32 v18, v18, v20
v_mfma_f32_16x16x32_bf16 v[144:147], a[56:59], a[112:115], v[144:147]
s_add_u32 s64, s70, 57984
buffer_load_dword a252, v1, s[60:63], s82 offen
v_mfma_f32_16x16x32_bf16 v[144:147], a[60:63], a[116:119], v[144:147]
buffer_load_dwordx4 v13, s[32:35], s64 offen lds
v_mfma_f32_16x16x32_bf16 v[128:131], a[52:55], a[116:119], v[128:131]
v_mul_f32 v19, v19, v21
v_cvt_pk_bf16_f32 v18, v18, v19
v_mfma_f32_16x16x32_bf16 v[128:131], a[48:51], a[112:115], v[128:131]
v_lshlrev_b32 v19, 16, v18
v_and_b32 v18, 0xffff0000, v18
v_mfma_f32_16x16x32_bf16 v[112:115], a[40:43], a[112:115], v[112:115]
v_add_f32 v17, v17, v19
v_add_f32 v17, v17, v18
v_mfma_f32_16x16x32_bf16 v[112:115], a[44:47], a[116:119], v[112:115]
v_accvgpr_read_b32 v19, a152
v_accvgpr_read_b32 v21, a168
v_mfma_f32_16x16x32_bf16 v[96:99], a[36:39], a[116:119], v[96:99]
v_lshlrev_b32 v18, 16, v19
v_and_b32 v19, 0xffff0000, v19
v_mfma_f32_16x16x32_bf16 v[96:99], a[32:35], a[112:115], v[96:99]
s_waitcnt lgkmcnt(0)
v_lshlrev_b32 v20, 16, v21
v_and_b32 v21, 0xffff0000, v21
v_mfma_f32_16x16x32_bf16 v[36:39], a[32:35], a[72:75], v[36:39]
v_mul_f32 v18, v18, v20
v_mul_f32 v19, v19, v21
v_mfma_f32_16x16x32_bf16 v[36:39], a[36:39], a[76:79], v[36:39]
v_cvt_pk_bf16_f32 v18, v18, v19
v_lshlrev_b32 v19, 16, v18
v_mfma_f32_16x16x32_bf16 v[52:55], a[44:47], a[76:79], v[52:55]
s_waitcnt lgkmcnt(0)
s_barrier
v_mfma_f32_16x16x32_bf16 v[52:55], a[40:43], a[72:75], v[52:55]
s_add_u32 m0, s77, 65536
ds_read_b64_tr_b16 a[104:105], v4 offset:32768
v_and_b32 v18, 0xffff0000, v18
v_mfma_f32_16x16x32_bf16 v[68:71], a[48:51], a[72:75], v[68:71]
s_add_u32 s64, s71, 3145728
ds_read_b64_tr_b16 a[106:107], v4 offset:33792
v_add_f32 v17, v17, v19
v_mfma_f32_16x16x32_bf16 v[68:71], a[52:55], a[76:79], v[68:71]
buffer_load_dwordx4 v14, s[36:39], s64 offen lds
v_mfma_f32_16x16x32_bf16 v[84:87], a[60:63], a[76:79], v[84:87]
ds_read_b64_tr_b16 a[108:109], v4 offset:40960
v_add_f32 v17, v17, v18
v_mfma_f32_16x16x32_bf16 v[84:87], a[56:59], a[72:75], v[84:87]
ds_read_b64_tr_b16 a[110:111], v4 offset:41984
v_accvgpr_read_b32 v19, a153
v_mfma_f32_16x16x32_bf16 v[148:151], a[56:59], a[80:83], v[148:151]
ds_read_b64_tr_b16 a[112:113], v5 offset:32768
v_accvgpr_read_b32 v21, a169
v_mfma_f32_16x16x32_bf16 v[148:151], a[60:63], a[84:87], v[148:151]
ds_read_b64_tr_b16 a[114:115], v5 offset:33792
v_lshlrev_b32 v18, 16, v19
v_mfma_f32_16x16x32_bf16 v[132:135], a[52:55], a[84:87], v[132:135]
ds_read_b64_tr_b16 a[116:117], v5 offset:40960
v_and_b32 v19, 0xffff0000, v19
v_mfma_f32_16x16x32_bf16 v[132:135], a[48:51], a[80:83], v[132:135]
s_add_u32 m0, s77, 66560
ds_read_b64_tr_b16 a[118:119], v5 offset:41984
v_lshlrev_b32 v20, 16, v21
v_mfma_f32_16x16x32_bf16 v[116:119], a[40:43], a[80:83], v[116:119]
s_add_u32 s64, s71, 3178496
ds_read_b64_tr_b16 a[72:73], v6 offset:32768
v_and_b32 v21, 0xffff0000, v21
v_mfma_f32_16x16x32_bf16 v[116:119], a[44:47], a[84:87], v[116:119]
buffer_load_dwordx4 v14, s[36:39], s64 offen lds
v_mfma_f32_16x16x32_bf16 v[100:103], a[36:39], a[84:87], v[100:103]
ds_read_b64_tr_b16 a[74:75], v6 offset:33792
v_mul_f32 v18, v18, v20
v_mfma_f32_16x16x32_bf16 v[100:103], a[32:35], a[80:83], v[100:103]
ds_read_b64_tr_b16 a[76:77], v6 offset:40960
v_mul_f32 v19, v19, v21
v_mfma_f32_16x16x32_bf16 v[248:251], a[32:35], a[88:91], v[248:251]
ds_read_b64_tr_b16 a[78:79], v6 offset:41984
v_cvt_pk_bf16_f32 v18, v18, v19
v_mfma_f32_16x16x32_bf16 v[248:251], a[36:39], a[92:95], v[248:251]
ds_read_b64_tr_b16 a[80:81], v7 offset:32768
v_lshlrev_b32 v19, 16, v18
v_mfma_f32_16x16x32_bf16 v[252:255], a[44:47], a[92:95], v[252:255]
ds_read_b64_tr_b16 a[82:83], v7 offset:33792
v_and_b32 v18, 0xffff0000, v18
v_mfma_f32_16x16x32_bf16 v[252:255], a[40:43], a[88:91], v[252:255]
s_add_u32 m0, s77, 67584
ds_read_b64_tr_b16 a[84:85], v7 offset:40960
v_add_f32 v17, v17, v19
v_mfma_f32_16x16x32_bf16 a[120:123], a[48:51], a[88:91], a[120:123]
s_add_u32 s64, s71, 3211264
ds_read_b64_tr_b16 a[86:87], v7 offset:41984
v_add_f32 v17, v17, v18
v_mfma_f32_16x16x32_bf16 a[120:123], a[52:55], a[92:95], a[120:123]
buffer_load_dwordx4 v15, s[36:39], s64 offen lds
v_mfma_f32_16x16x32_bf16 a[124:127], a[60:63], a[92:95], a[124:127]
v_accvgpr_read_b32 v19, a154
v_accvgpr_read_b32 v21, a170
v_mfma_f32_16x16x32_bf16 a[124:127], a[56:59], a[88:91], a[124:127]
s_add_u32 s81, s81, 1048576
ds_read_b64_tr_b16 a[88:89], v8 offset:32768
v_lshlrev_b32 v18, 16, v19
v_mfma_f32_16x16x32_bf16 a[128:131], a[56:59], a[96:99], a[128:131]
buffer_load_dword a252, v16, s[56:59], s81 offen
v_mfma_f32_16x16x32_bf16 a[128:131], a[60:63], a[100:103], a[128:131]
ds_read_b64_tr_b16 a[90:91], v8 offset:33792
v_and_b32 v19, 0xffff0000, v19
v_mfma_f32_16x16x32_bf16 a[132:135], a[52:55], a[100:103], a[132:135]
ds_read_b64_tr_b16 a[92:93], v8 offset:40960
v_lshlrev_b32 v20, 16, v21
v_mfma_f32_16x16x32_bf16 a[132:135], a[48:51], a[96:99], a[132:135]
s_add_u32 m0, s77, 68608
ds_read_b64_tr_b16 a[94:95], v8 offset:41984
v_and_b32 v21, 0xffff0000, v21
v_mfma_f32_16x16x32_bf16 a[136:139], a[40:43], a[96:99], a[136:139]
s_add_u32 s64, s71, 3244032
v_mul_f32 v18, v18, v20
v_mul_f32 v19, v19, v21
v_mfma_f32_16x16x32_bf16 a[136:139], a[44:47], a[100:103], a[136:139]
buffer_load_dwordx4 v15, s[36:39], s64 offen lds
v_mfma_f32_16x16x32_bf16 a[140:143], a[36:39], a[100:103], a[140:143]
v_cvt_pk_bf16_f32 v18, v18, v19
v_lshlrev_b32 v19, 16, v18
v_mfma_f32_16x16x32_bf16 a[140:143], a[32:35], a[96:99], a[140:143]
s_waitcnt lgkmcnt(4)
ds_read_b64_tr_b16 a[96:97], v9 offset:32768
v_and_b32 v18, 0xffff0000, v18
v_mfma_f32_16x16x32_bf16 v[184:187], a[104:107], a[0:3], v[184:187]
ds_read_b64_tr_b16 a[98:99], v9 offset:33792
v_add_f32 v17, v17, v19
v_mfma_f32_16x16x32_bf16 v[184:187], a[108:111], a[4:7], v[184:187]
ds_read_b64_tr_b16 a[100:101], v9 offset:40960
v_add_f32 v17, v17, v18
v_mfma_f32_16x16x32_bf16 v[192:195], a[108:111], a[12:15], v[192:195]
s_add_u32 s17, s78, .-L_pc+6144
ds_read_b64_tr_b16 a[102:103], v9 offset:41984
v_accvgpr_read_b32 v19, a155
v_mfma_f32_16x16x32_bf16 v[192:195], a[104:107], a[8:11], v[192:195]
s_add_u32 m0, s77, 81920
v_accvgpr_read_b32 v21, a171
v_lshlrev_b32 v18, 16, v19
v_mfma_f32_16x16x32_bf16 v[200:203], a[104:107], a[16:19], v[200:203]
s_add_u32 s64, s71, 3145728
buffer_load_dword a252, v16, s[88:91], s17 offen
v_mfma_f32_16x16x32_bf16 v[200:203], a[108:111], a[20:23], v[200:203]
buffer_load_dwordx4 v14, s[40:43], s64 offen lds
v_mfma_f32_16x16x32_bf16 v[208:211], a[108:111], a[28:31], v[208:211]
v_and_b32 v19, 0xffff0000, v19
v_lshlrev_b32 v20, 16, v21
v_mfma_f32_16x16x32_bf16 v[208:211], a[104:107], a[24:27], v[208:211]
ds_read_b64_tr_b16 a[104:105], v10 offset:32768
v_and_b32 v21, 0xffff0000, v21
v_mfma_f32_16x16x32_bf16 v[212:215], a[112:115], a[24:27], v[212:215]
ds_read_b64_tr_b16 a[106:107], v10 offset:33792
v_mul_f32 v18, v18, v20
v_mfma_f32_16x16x32_bf16 v[212:215], a[116:119], a[28:31], v[212:215]
ds_read_b64_tr_b16 a[108:109], v10 offset:40960
v_mul_f32 v19, v19, v21
v_mfma_f32_16x16x32_bf16 v[204:207], a[116:119], a[20:23], v[204:207]
ds_read_b64_tr_b16 a[110:111], v10 offset:41984
v_cvt_pk_bf16_f32 v18, v18, v19
v_mfma_f32_16x16x32_bf16 v[204:207], a[112:115], a[16:19], v[204:207]
s_add_u32 m0, s77, 82944
v_lshlrev_b32 v19, 16, v18
v_and_b32 v18, 0xffff0000, v18
v_mfma_f32_16x16x32_bf16 v[196:199], a[112:115], a[8:11], v[196:199]
s_add_u32 s64, s71, 3178496
v_add_f32 v17, v17, v19
v_add_f32 v17, v17, v18
v_mfma_f32_16x16x32_bf16 v[196:199], a[116:119], a[12:15], v[196:199]
buffer_load_dwordx4 v14, s[40:43], s64 offen lds
v_mfma_f32_16x16x32_bf16 v[188:191], a[116:119], a[4:7], v[188:191]
v_accvgpr_read_b32 v19, a156
v_accvgpr_read_b32 v21, a172
v_mfma_f32_16x16x32_bf16 v[188:191], a[112:115], a[0:3], v[188:191]
ds_read_b64_tr_b16 a[112:113], v11 offset:32768
v_lshlrev_b32 v18, 16, v19
v_mfma_f32_16x16x32_bf16 v[216:219], a[72:75], a[0:3], v[216:219]
ds_read_b64_tr_b16 a[114:115], v11 offset:33792
v_and_b32 v19, 0xffff0000, v19
v_mfma_f32_16x16x32_bf16 v[216:219], a[76:79], a[4:7], v[216:219]
ds_read_b64_tr_b16 a[116:117], v11 offset:40960
v_lshlrev_b32 v20, 16, v21
v_mfma_f32_16x16x32_bf16 v[224:227], a[76:79], a[12:15], v[224:227]
ds_read_b64_tr_b16 a[118:119], v11 offset:41984
v_and_b32 v21, 0xffff0000, v21
v_mfma_f32_16x16x32_bf16 v[224:227], a[72:75], a[8:11], v[224:227]
s_add_u32 m0, s77, 83968
v_mul_f32 v18, v18, v20
v_mul_f32 v19, v19, v21
v_mfma_f32_16x16x32_bf16 v[232:235], a[72:75], a[16:19], v[232:235]
s_add_u32 s64, s71, 3211264
v_cvt_pk_bf16_f32 v18, v18, v19
v_lshlrev_b32 v19, 16, v18
v_mfma_f32_16x16x32_bf16 v[232:235], a[76:79], a[20:23], v[232:235]
buffer_load_dwordx4 v15, s[40:43], s64 offen lds
v_mfma_f32_16x16x32_bf16 v[240:243], a[76:79], a[28:31], v[240:243]
v_and_b32 v18, 0xffff0000, v18
v_add_f32 v17, v17, v19
v_mfma_f32_16x16x32_bf16 v[240:243], a[72:75], a[24:27], v[240:243]
s_add_u32 s82, s82, 1048576
ds_read_b64_tr_b16 a[72:73], v4 offset:49152
v_add_f32 v17, v17, v18
v_mfma_f32_16x16x32_bf16 v[244:247], a[80:83], a[24:27], v[244:247]
buffer_load_dword a252, v1, s[60:63], s82 offen
v_mfma_f32_16x16x32_bf16 v[244:247], a[84:87], a[28:31], v[244:247]
ds_read_b64_tr_b16 a[74:75], v4 offset:50176
v_accvgpr_read_b32 v19, a157
v_mfma_f32_16x16x32_bf16 v[236:239], a[84:87], a[20:23], v[236:239]
ds_read_b64_tr_b16 a[76:77], v4 offset:57344
v_accvgpr_read_b32 v21, a173
v_mfma_f32_16x16x32_bf16 v[236:239], a[80:83], a[16:19], v[236:239]
s_add_u32 m0, s77, 84992
ds_read_b64_tr_b16 a[78:79], v4 offset:58368
v_lshlrev_b32 v18, 16, v19
v_mfma_f32_16x16x32_bf16 v[228:231], a[80:83], a[8:11], v[228:231]
s_add_u32 s64, s71, 3244032
v_and_b32 v19, 0xffff0000, v19
v_lshlrev_b32 v20, 16, v21
v_mfma_f32_16x16x32_bf16 v[228:231], a[84:87], a[12:15], v[228:231]
buffer_load_dwordx4 v15, s[40:43], s64 offen lds
v_mfma_f32_16x16x32_bf16 v[220:223], a[84:87], a[4:7], v[220:223]
v_and_b32 v21, 0xffff0000, v21
v_mul_f32 v18, v18, v20
v_mfma_f32_16x16x32_bf16 v[220:223], a[80:83], a[0:3], v[220:223]
s_waitcnt lgkmcnt(4)
ds_read_b64_tr_b16 a[80:81], v5 offset:49152
v_mul_f32 v19, v19, v21
v_mfma_f32_16x16x32_bf16 v[152:155], a[88:91], a[0:3], v[152:155]
ds_read_b64_tr_b16 a[82:83], v5 offset:50176
v_cvt_pk_bf16_f32 v18, v18, v19
v_mfma_f32_16x16x32_bf16 v[152:155], a[92:95], a[4:7], v[152:155]
ds_read_b64_tr_b16 a[84:85], v5 offset:57344
v_lshlrev_b32 v19, 16, v18
v_mfma_f32_16x16x32_bf16 v[160:163], a[92:95], a[12:15], v[160:163]
ds_read_b64_tr_b16 a[86:87], v5 offset:58368
v_and_b32 v18, 0xffff0000, v18
v_mfma_f32_16x16x32_bf16 v[160:163], a[88:91], a[8:11], v[160:163]
v_add_f32 v17, v17, v19
v_add_f32 v17, v17, v18
v_mfma_f32_16x16x32_bf16 v[168:171], a[88:91], a[16:19], v[168:171]
v_accvgpr_read_b32 v19, a158
v_accvgpr_read_b32 v21, a174
v_mfma_f32_16x16x32_bf16 v[168:171], a[92:95], a[20:23], v[168:171]
v_lshlrev_b32 v18, 16, v19
v_and_b32 v19, 0xffff0000, v19
v_mfma_f32_16x16x32_bf16 v[176:179], a[92:95], a[28:31], v[176:179]
s_add_u32 m0, s76, 0
v_lshlrev_b32 v20, 16, v21
v_and_b32 v21, 0xffff0000, v21
v_mfma_f32_16x16x32_bf16 v[176:179], a[88:91], a[24:27], v[176:179]
s_add_u32 s64, s70, 768
ds_read_b64_tr_b16 a[88:89], v6 offset:49152
v_mul_f32 v18, v18, v20
v_mfma_f32_16x16x32_bf16 v[180:183], a[96:99], a[24:27], v[180:183]
buffer_load_dwordx4 v12, s[32:35], s64 offen lds
v_mfma_f32_16x16x32_bf16 v[180:183], a[100:103], a[28:31], v[180:183]
ds_read_b64_tr_b16 a[90:91], v6 offset:50176
v_mul_f32 v19, v19, v21
v_mfma_f32_16x16x32_bf16 v[172:175], a[100:103], a[20:23], v[172:175]
ds_read_b64_tr_b16 a[92:93], v6 offset:57344
v_cvt_pk_bf16_f32 v18, v18, v19
v_mfma_f32_16x16x32_bf16 v[172:175], a[96:99], a[16:19], v[172:175]
ds_read_b64_tr_b16 a[94:95], v6 offset:58368
v_lshlrev_b32 v19, 16, v18
v_mfma_f32_16x16x32_bf16 v[164:167], a[96:99], a[8:11], v[164:167]
v_and_b32 v18, 0xffff0000, v18
v_add_f32 v17, v17, v19
v_mfma_f32_16x16x32_bf16 v[164:167], a[100:103], a[12:15], v[164:167]
s_add_u32 m0, s76, 1024
v_add_f32 v17, v17, v18
v_accvgpr_read_b32 v19, a159
v_mfma_f32_16x16x32_bf16 v[156:159], a[100:103], a[4:7], v[156:159]
s_add_u32 s64, s70, 8960
v_accvgpr_read_b32 v21, a175
v_lshlrev_b32 v18, 16, v19
v_mfma_f32_16x16x32_bf16 v[156:159], a[96:99], a[0:3], v[156:159]
buffer_load_dwordx4 v13, s[32:35], s64 offen lds
v_mfma_f32_16x16x32_bf16 v[24:27], a[104:107], a[0:3], v[24:27]
ds_read_b64_tr_b16 a[96:97], v7 offset:49152
v_and_b32 v19, 0xffff0000, v19
v_mfma_f32_16x16x32_bf16 v[24:27], a[108:111], a[4:7], v[24:27]
ds_read_b64_tr_b16 a[98:99], v7 offset:50176
v_lshlrev_b32 v20, 16, v21
v_mfma_f32_16x16x32_bf16 v[40:43], a[108:111], a[12:15], v[40:43]
ds_read_b64_tr_b16 a[100:101], v7 offset:57344
v_and_b32 v21, 0xffff0000, v21
v_mfma_f32_16x16x32_bf16 v[40:43], a[104:107], a[8:11], v[40:43]
ds_read_b64_tr_b16 a[102:103], v7 offset:58368
v_mul_f32 v18, v18, v20
v_mfma_f32_16x16x32_bf16 v[56:59], a[104:107], a[16:19], v[56:59]
s_add_u32 m0, s76, 2048
v_mul_f32 v19, v19, v21
v_cvt_pk_bf16_f32 v18, v18, v19
v_mfma_f32_16x16x32_bf16 v[56:59], a[108:111], a[20:23], v[56:59]
s_add_u32 s64, s70, 17152
v_lshlrev_b32 v19, 16, v18
v_and_b32 v18, 0xffff0000, v18
v_mfma_f32_16x16x32_bf16 v[72:75], a[108:111], a[28:31], v[72:75]
s_waitcnt vmcnt(13)
buffer_load_dwordx4 v12, s[32:35], s64 offen lds
v_mfma_f32_16x16x32_bf16 v[72:75], a[104:107], a[24:27], v[72:75]
s_add_u32 s81, s81, 1048576
ds_read_b64_tr_b16 a[104:105], v8 offset:49152
v_add_f32 v17, v17, v19
v_mfma_f32_16x16x32_bf16 v[136:139], a[112:115], a[24:27], v[136:139]
buffer_load_dword a252, v16, s[56:59], s81 offen
v_mfma_f32_16x16x32_bf16 v[136:139], a[116:119], a[28:31], v[136:139]
ds_read_b64_tr_b16 a[106:107], v8 offset:50176
v_add_u32 v4, 0x8000, v4
v_mfma_f32_16x16x32_bf16 v[120:123], a[116:119], a[20:23], v[120:123]
ds_read_b64_tr_b16 a[108:109], v8 offset:57344
v_add_f32 v17, v17, v18
v_mfma_f32_16x16x32_bf16 v[120:123], a[112:115], a[16:19], v[120:123]
s_add_u32 m0, s76, 3072
ds_read_b64_tr_b16 a[110:111], v8 offset:58368
v_mfma_f32_16x16x32_bf16 v[104:107], a[112:115], a[8:11], v[104:107]
s_add_u32 s64, s70, 25344
ds_read_b128 a[32:35], v2 offset:32768
v_add_f32_dpp v17, v17, v17 row_ror:8 row_mask:0xf bank_mask:0xf
v_mfma_f32_16x16x32_bf16 v[104:107], a[116:119], a[12:15], v[104:107]
buffer_load_dwordx4 v13, s[32:35], s64 offen lds
v_mfma_f32_16x16x32_bf16 v[88:91], a[116:119], a[4:7], v[88:91]
ds_read_b128 a[36:39], v3 offset:32768
v_add_f32_dpp v17, v17, v17 row_ror:4 row_mask:0xf bank_mask:0xf
v_mfma_f32_16x16x32_bf16 v[88:91], a[112:115], a[0:3], v[88:91]
s_waitcnt lgkmcnt(6)
ds_read_b128 a[40:43], v2 offset:34816
v_mfma_f32_16x16x32_bf16 v[28:31], a[0:3], a[72:75], v[28:31]
ds_read_b128 a[44:47], v3 offset:34816
v_add_f32_dpp v17, v17, v17 row_ror:2 row_mask:0xf bank_mask:0xf
v_mfma_f32_16x16x32_bf16 v[28:31], a[4:7], a[76:79], v[28:31]
ds_read_b128 a[48:51], v2 offset:36864
v_add_u32 v5, 0x8000, v5
v_mfma_f32_16x16x32_bf16 v[44:47], a[12:15], a[76:79], v[44:47]
s_add_u32 m0, s76, 4096
ds_read_b128 a[52:55], v3 offset:36864
v_add_f32_dpp v17, v17, v17 row_ror:1 row_mask:0xf bank_mask:0xf
v_mfma_f32_16x16x32_bf16 v[44:47], a[8:11], a[72:75], v[44:47]
s_add_u32 s64, s70, 33536
ds_read_b128 a[56:59], v2 offset:38912
v_mov_b32 v18, v17
v_mfma_f32_16x16x32_bf16 v[60:63], a[16:19], a[72:75], v[60:63]
buffer_load_dwordx4 v12, s[32:35], s64 offen lds
v_mfma_f32_16x16x32_bf16 v[60:63], a[20:23], a[76:79], v[60:63]
ds_read_b128 a[60:63], v3 offset:38912
v_permlane16_swap_b32 v18, v17
v_mfma_f32_16x16x32_bf16 v[76:79], a[28:31], a[76:79], v[76:79]
ds_read_b64_tr_b16 a[112:113], v9 offset:49152
v_add_f32 v17, v17, v18
v_mfma_f32_16x16x32_bf16 v[76:79], a[24:27], a[72:75], v[76:79]
ds_read_b64_tr_b16 a[114:115], v9 offset:50176
v_cvt_pk_bf16_f32 v17, v17, v17
v_mfma_f32_16x16x32_bf16 v[140:143], a[24:27], a[80:83], v[140:143]
ds_read_b64_tr_b16 a[116:117], v9 offset:57344
v_and_b32 v17, 0xffff0000, v17
v_mfma_f32_16x16x32_bf16 v[140:143], a[28:31], a[84:87], v[140:143]
s_add_u32 m0, s76, 5120
ds_read_b64_tr_b16 a[118:119], v9 offset:58368
v_add_u32 v6, 0x8000, v6
v_mfma_f32_16x16x32_bf16 v[124:127], a[20:23], a[84:87], v[124:127]
s_add_u32 s64, s70, 41728
ds_read_b64_tr_b16 a[72:73], v10 offset:49152
v_mul_f32 v17, 0xbfb8aa3b, v17
v_mfma_f32_16x16x32_bf16 v[124:127], a[16:19], a[80:83], v[124:127]
buffer_load_dwordx4 v13, s[32:35], s64 offen lds
v_mfma_f32_16x16x32_bf16 v[108:111], a[8:11], a[80:83], v[108:111]
ds_read_b64_tr_b16 a[74:75], v10 offset:50176
v_mfma_f32_16x16x32_bf16 v[108:111], a[12:15], a[84:87], v[108:111]
ds_read_b64_tr_b16 a[76:77], v10 offset:57344
v_mfma_f32_16x16x32_bf16 v[92:95], a[4:7], a[84:87], v[92:95]
ds_read_b64_tr_b16 a[78:79], v10 offset:58368
v_mfma_f32_16x16x32_bf16 v[92:95], a[0:3], a[80:83], v[92:95]
ds_read_b64_tr_b16 a[80:81], v11 offset:49152
v_mfma_f32_16x16x32_bf16 v[32:35], a[0:3], a[88:91], v[32:35]
s_add_u32 m0, s76, 6144
ds_read_b64_tr_b16 a[82:83], v11 offset:50176
v_mfma_f32_16x16x32_bf16 v[32:35], a[4:7], a[92:95], v[32:35]
s_add_u32 s64, s70, 49920
ds_read_b64_tr_b16 a[84:85], v11 offset:57344
v_add_u32 v7, 0x8000, v7
v_mfma_f32_16x16x32_bf16 v[48:51], a[12:15], a[92:95], v[48:51]
buffer_load_dwordx4 v12, s[32:35], s64 offen lds
v_mfma_f32_16x16x32_bf16 v[48:51], a[8:11], a[88:91], v[48:51]
ds_read_b64_tr_b16 a[86:87], v11 offset:58368
v_mfma_f32_16x16x32_bf16 v[64:67], a[16:19], a[88:91], v[64:67]
v_exp_f32 v17, v17
v_mfma_f32_16x16x32_bf16 v[64:67], a[20:23], a[92:95], v[64:67]
v_add_f32 v17, 1.0, v17
v_mfma_f32_16x16x32_bf16 v[80:83], a[28:31], a[92:95], v[80:83]
v_rcp_f32 v17, v17
v_mfma_f32_16x16x32_bf16 v[80:83], a[24:27], a[88:91], v[80:83]
s_add_u32 m0, s76, 7168
s_add_u32 s81, s81, 1048576
v_cvt_pk_bf16_f32 v18, v17, v17
v_mfma_f32_16x16x32_bf16 v[144:147], a[24:27], a[96:99], v[144:147]
s_add_u32 s64, s70, 58112
buffer_load_dword a252, v16, s[56:59], s81 offen
v_mfma_f32_16x16x32_bf16 v[144:147], a[28:31], a[100:103], v[144:147]
buffer_load_dwordx4 v13, s[32:35], s64 offen lds
v_mfma_f32_16x16x32_bf16 v[128:131], a[20:23], a[100:103], v[128:131]
v_add_u32 v8, 0x8000, v8
v_and_b32 v18, 0xffff0000, v18
v_mfma_f32_16x16x32_bf16 v[128:131], a[16:19], a[96:99], v[128:131]
v_sub_f32 v19, 1.0, v18
v_mfma_f32_16x16x32_bf16 v[112:115], a[8:11], a[96:99], v[112:115]
v_cvt_pk_bf16_f32 v19, v19, v19
v_mfma_f32_16x16x32_bf16 v[112:115], a[12:15], a[100:103], v[112:115]
v_and_b32 v19, 0xffff0000, v19
v_mfma_f32_16x16x32_bf16 v[96:99], a[4:7], a[100:103], v[96:99]
v_add_u32 v9, 0x8000, v9
v_add_u32 v10, 0x8000, v10
v_mfma_f32_16x16x32_bf16 v[96:99], a[0:3], a[96:99], v[96:99]
s_waitcnt lgkmcnt(0)
v_add_u32 v11, 0x8000, v11
v_and_b32 v20, 31, v0
v_mfma_f32_16x16x32_bf16 v[36:39], a[0:3], a[104:107], v[36:39]
v_lshlrev_b32 v20, 27, v20
v_mfma_f32_16x16x32_bf16 v[36:39], a[4:7], a[108:111], v[36:39]
v_lshrrev_b32 v21, 2, v0
v_mfma_f32_16x16x32_bf16 v[52:55], a[12:15], a[108:111], v[52:55]
s_waitcnt lgkmcnt(0)
s_barrier
v_mfma_f32_16x16x32_bf16 v[52:55], a[8:11], a[104:107], v[52:55]
s_add_u32 m0, s77, 98304
ds_read_b64_tr_b16 a[88:89], v4 offset:32768
v_add_u32 v20, v20, v21
v_mfma_f32_16x16x32_bf16 v[68:71], a[16:19], a[104:107], v[68:71]
s_add_u32 s64, s71, 3670016
ds_read_b64_tr_b16 a[90:91], v4 offset:33792
v_mfma_f32_16x16x32_bf16 v[68:71], a[20:23], a[108:111], v[68:71]
buffer_load_dwordx4 v14, s[36:39], s64 offen lds
v_mfma_f32_16x16x32_bf16 v[84:87], a[28:31], a[108:111], v[84:87]
ds_read_b64_tr_b16 a[92:93], v4 offset:40960
v_mfma_f32_16x16x32_bf16 v[84:87], a[24:27], a[104:107], v[84:87]
ds_read_b64_tr_b16 a[94:95], v4 offset:41984
v_mfma_f32_16x16x32_bf16 v[148:151], a[24:27], a[112:115], v[148:151]
ds_read_b64_tr_b16 a[96:97], v5 offset:32768
v_mfma_f32_16x16x32_bf16 v[148:151], a[28:31], a[116:119], v[148:151]
ds_read_b64_tr_b16 a[98:99], v5 offset:33792
v_mfma_f32_16x16x32_bf16 v[132:135], a[20:23], a[116:119], v[132:135]
ds_read_b64_tr_b16 a[100:101], v5 offset:40960
v_mfma_f32_16x16x32_bf16 v[132:135], a[16:19], a[112:115], v[132:135]
s_add_u32 m0, s77, 99328
ds_read_b64_tr_b16 a[102:103], v5 offset:41984
v_mfma_f32_16x16x32_bf16 v[116:119], a[8:11], a[112:115], v[116:119]
s_add_u32 s64, s71, 3702784
ds_read_b64_tr_b16 a[104:105], v6 offset:32768
v_mfma_f32_16x16x32_bf16 v[116:119], a[12:15], a[116:119], v[116:119]
buffer_load_dwordx4 v14, s[36:39], s64 offen lds
v_mfma_f32_16x16x32_bf16 v[100:103], a[4:7], a[116:119], v[100:103]
ds_read_b64_tr_b16 a[106:107], v6 offset:33792
v_mfma_f32_16x16x32_bf16 v[100:103], a[0:3], a[112:115], v[100:103]
ds_read_b64_tr_b16 a[108:109], v6 offset:40960
v_mfma_f32_16x16x32_bf16 v[248:251], a[0:3], a[72:75], v[248:251]
ds_read_b64_tr_b16 a[110:111], v6 offset:41984
v_mfma_f32_16x16x32_bf16 v[248:251], a[4:7], a[76:79], v[248:251]
ds_read_b64_tr_b16 a[112:113], v7 offset:32768
v_mfma_f32_16x16x32_bf16 v[252:255], a[12:15], a[76:79], v[252:255]
ds_read_b64_tr_b16 a[114:115], v7 offset:33792
v_mfma_f32_16x16x32_bf16 v[252:255], a[8:11], a[72:75], v[252:255]
s_add_u32 m0, s77, 100352
ds_read_b64_tr_b16 a[116:117], v7 offset:40960
v_mfma_f32_16x16x32_bf16 a[120:123], a[16:19], a[72:75], a[120:123]
s_add_u32 s64, s71, 3735552
s_lshl2_add_u32 s65, s2, s30
ds_read_b64_tr_b16 a[118:119], v7 offset:41984
v_mfma_f32_16x16x32_bf16 a[120:123], a[20:23], a[76:79], a[120:123]
s_lshl4_add_u32 s65, s65, 58720256
buffer_load_dwordx4 v15, s[36:39], s64 offen lds
v_mfma_f32_16x16x32_bf16 a[124:127], a[28:31], a[76:79], a[124:127]
buffer_store_dwordx2 v[18:19], v20, s[44:47], s65 offen sc1
v_mfma_f32_16x16x32_bf16 a[124:127], a[24:27], a[72:75], a[124:127]
s_add_u32 s82, s82, 1048576
ds_read_b64_tr_b16 a[72:73], v8 offset:32768
v_lshrrev_b32 v21, 4, v0
v_mfma_f32_16x16x32_bf16 a[128:131], a[24:27], a[80:83], a[128:131]
buffer_load_dword a252, v1, s[60:63], s82 offen
v_mfma_f32_16x16x32_bf16 a[128:131], a[28:31], a[84:87], a[128:131]
ds_read_b64_tr_b16 a[74:75], v8 offset:33792
v_bfe_u32 v19, v0, 2, 2
v_mfma_f32_16x16x32_bf16 a[132:135], a[20:23], a[84:87], a[132:135]
ds_read_b64_tr_b16 a[76:77], v8 offset:40960
v_lshl_add_u32 v19, v21, 3, v19
v_mfma_f32_16x16x32_bf16 a[132:135], a[16:19], a[80:83], a[132:135]
s_add_u32 m0, s77, 101376
ds_read_b64_tr_b16 a[78:79], v8 offset:41984
v_lshlrev_b32 v19, 6, v19
v_mfma_f32_16x16x32_bf16 a[136:139], a[8:11], a[80:83], a[136:139]
s_add_u32 s64, s71, 3768320
v_and_b32 v21, 1, v21
v_mfma_f32_16x16x32_bf16 a[136:139], a[12:15], a[84:87], a[136:139]
buffer_load_dwordx4 v15, s[36:39], s64 offen lds
v_mfma_f32_16x16x32_bf16 a[140:143], a[4:7], a[84:87], a[140:143]
v_lshl_add_u32 v19, v21, 5, v19
v_mfma_f32_16x16x32_bf16 a[140:143], a[0:3], a[80:83], a[140:143]
s_waitcnt lgkmcnt(4)
ds_read_b64_tr_b16 a[80:81], v9 offset:32768
v_and_b32 v21, 3, v0
v_mfma_f32_16x16x32_bf16 v[184:187], a[88:91], a[32:35], v[184:187]
ds_read_b64_tr_b16 a[82:83], v9 offset:33792
v_lshl_add_u32 v19, v21, 3, v19
v_mfma_f32_16x16x32_bf16 v[184:187], a[92:95], a[36:39], v[184:187]
ds_read_b64_tr_b16 a[84:85], v9 offset:40960
v_add_u32 v19, 114688, v19
v_mfma_f32_16x16x32_bf16 v[192:195], a[92:95], a[44:47], v[192:195]
ds_read_b64_tr_b16 a[86:87], v9 offset:41984
v_xor_b32 v20, 32, v19
v_mfma_f32_16x16x32_bf16 v[192:195], a[88:91], a[40:43], v[192:195]
s_add_u32 m0, s77, 114688
v_mfma_f32_16x16x32_bf16 v[200:203], a[88:91], a[48:51], v[200:203]
s_add_u32 s64, s71, 3670016
v_mfma_f32_16x16x32_bf16 v[200:203], a[92:95], a[52:55], v[200:203]
buffer_load_dwordx4 v14, s[40:43], s64 offen lds
v_mfma_f32_16x16x32_bf16 v[208:211], a[92:95], a[60:63], v[208:211]
v_mfma_f32_16x16x32_bf16 v[208:211], a[88:91], a[56:59], v[208:211]
ds_read_b64_tr_b16 a[88:89], v10 offset:32768
v_mfma_f32_16x16x32_bf16 v[212:215], a[96:99], a[56:59], v[212:215]
ds_read_b64_tr_b16 a[90:91], v10 offset:33792
v_mfma_f32_16x16x32_bf16 v[212:215], a[100:103], a[60:63], v[212:215]
ds_read_b64_tr_b16 a[92:93], v10 offset:40960
v_mfma_f32_16x16x32_bf16 v[204:207], a[100:103], a[52:55], v[204:207]
ds_read_b64_tr_b16 a[94:95], v10 offset:41984
v_mfma_f32_16x16x32_bf16 v[204:207], a[96:99], a[48:51], v[204:207]
s_add_u32 m0, s77, 115712
v_mfma_f32_16x16x32_bf16 v[196:199], a[96:99], a[40:43], v[196:199]
s_add_u32 s64, s71, 3702784
v_mfma_f32_16x16x32_bf16 v[196:199], a[100:103], a[44:47], v[196:199]
buffer_load_dwordx4 v14, s[40:43], s64 offen lds
v_mfma_f32_16x16x32_bf16 v[188:191], a[100:103], a[36:39], v[188:191]
v_mfma_f32_16x16x32_bf16 v[188:191], a[96:99], a[32:35], v[188:191]
ds_read_b64_tr_b16 a[96:97], v11 offset:32768
v_mfma_f32_16x16x32_bf16 v[216:219], a[104:107], a[32:35], v[216:219]
ds_read_b64_tr_b16 a[98:99], v11 offset:33792
v_mfma_f32_16x16x32_bf16 v[216:219], a[108:111], a[36:39], v[216:219]
ds_read_b64_tr_b16 a[100:101], v11 offset:40960
v_mfma_f32_16x16x32_bf16 v[224:227], a[108:111], a[44:47], v[224:227]
ds_read_b64_tr_b16 a[102:103], v11 offset:41984
v_mfma_f32_16x16x32_bf16 v[224:227], a[104:107], a[40:43], v[224:227]
s_add_u32 m0, s77, 116736
v_mfma_f32_16x16x32_bf16 v[232:235], a[104:107], a[48:51], v[232:235]
s_add_u32 s64, s71, 3735552
v_mfma_f32_16x16x32_bf16 v[232:235], a[108:111], a[52:55], v[232:235]
buffer_load_dwordx4 v15, s[40:43], s64 offen lds
v_mfma_f32_16x16x32_bf16 v[240:243], a[108:111], a[60:63], v[240:243]
v_mfma_f32_16x16x32_bf16 v[240:243], a[104:107], a[56:59], v[240:243]
s_add_u32 s81, s81, 1048576
ds_read_b64_tr_b16 a[104:105], v4 offset:49152
v_mfma_f32_16x16x32_bf16 v[244:247], a[112:115], a[56:59], v[244:247]
buffer_load_dword a252, v16, s[56:59], s81 offen
v_mfma_f32_16x16x32_bf16 v[244:247], a[116:119], a[60:63], v[244:247]
ds_read_b64_tr_b16 a[106:107], v4 offset:50176
v_mfma_f32_16x16x32_bf16 v[236:239], a[116:119], a[52:55], v[236:239]
ds_read_b64_tr_b16 a[108:109], v4 offset:57344
v_mfma_f32_16x16x32_bf16 v[236:239], a[112:115], a[48:51], v[236:239]
s_add_u32 m0, s77, 117760
ds_read_b64_tr_b16 a[110:111], v4 offset:58368
v_mfma_f32_16x16x32_bf16 v[228:231], a[112:115], a[40:43], v[228:231]
s_add_u32 s64, s71, 3768320
v_mfma_f32_16x16x32_bf16 v[228:231], a[116:119], a[44:47], v[228:231]
buffer_load_dwordx4 v15, s[40:43], s64 offen lds
v_mfma_f32_16x16x32_bf16 v[220:223], a[116:119], a[36:39], v[220:223]
v_mfma_f32_16x16x32_bf16 v[220:223], a[112:115], a[32:35], v[220:223]
s_waitcnt lgkmcnt(4)
ds_read_b64_tr_b16 a[112:113], v5 offset:49152
v_mfma_f32_16x16x32_bf16 v[152:155], a[72:75], a[32:35], v[152:155]
ds_read_b64_tr_b16 a[114:115], v5 offset:50176
v_mfma_f32_16x16x32_bf16 v[152:155], a[76:79], a[36:39], v[152:155]
ds_read_b64_tr_b16 a[116:117], v5 offset:57344
v_mfma_f32_16x16x32_bf16 v[160:163], a[76:79], a[44:47], v[160:163]
ds_read_b64_tr_b16 a[118:119], v5 offset:58368
v_mfma_f32_16x16x32_bf16 v[160:163], a[72:75], a[40:43], v[160:163]
v_mfma_f32_16x16x32_bf16 v[168:171], a[72:75], a[48:51], v[168:171]
v_mfma_f32_16x16x32_bf16 v[168:171], a[76:79], a[52:55], v[168:171]
v_mfma_f32_16x16x32_bf16 v[176:179], a[76:79], a[60:63], v[176:179]
s_add_u32 m0, s76, 32768
v_mfma_f32_16x16x32_bf16 v[176:179], a[72:75], a[56:59], v[176:179]
s_add_u32 s64, s70, 896
ds_read_b64_tr_b16 a[72:73], v6 offset:49152
v_mfma_f32_16x16x32_bf16 v[180:183], a[80:83], a[56:59], v[180:183]
buffer_load_dwordx4 v12, s[32:35], s64 offen lds
v_mfma_f32_16x16x32_bf16 v[180:183], a[84:87], a[60:63], v[180:183]
ds_read_b64_tr_b16 a[74:75], v6 offset:50176
v_mfma_f32_16x16x32_bf16 v[172:175], a[84:87], a[52:55], v[172:175]
ds_read_b64_tr_b16 a[76:77], v6 offset:57344
v_mfma_f32_16x16x32_bf16 v[172:175], a[80:83], a[48:51], v[172:175]
ds_read_b64_tr_b16 a[78:79], v6 offset:58368
v_mfma_f32_16x16x32_bf16 v[164:167], a[80:83], a[40:43], v[164:167]
v_mfma_f32_16x16x32_bf16 v[164:167], a[84:87], a[44:47], v[164:167]
s_add_u32 m0, s76, 33792
v_mfma_f32_16x16x32_bf16 v[156:159], a[84:87], a[36:39], v[156:159]
s_add_u32 s64, s70, 9088
v_mfma_f32_16x16x32_bf16 v[156:159], a[80:83], a[32:35], v[156:159]
buffer_load_dwordx4 v13, s[32:35], s64 offen lds
v_mfma_f32_16x16x32_bf16 v[24:27], a[88:91], a[32:35], v[24:27]
ds_read_b64_tr_b16 a[80:81], v7 offset:49152
v_mfma_f32_16x16x32_bf16 v[24:27], a[92:95], a[36:39], v[24:27]
ds_read_b64_tr_b16 a[82:83], v7 offset:50176
v_mfma_f32_16x16x32_bf16 v[40:43], a[92:95], a[44:47], v[40:43]
ds_read_b64_tr_b16 a[84:85], v7 offset:57344
v_mfma_f32_16x16x32_bf16 v[40:43], a[88:91], a[40:43], v[40:43]
ds_read_b64_tr_b16 a[86:87], v7 offset:58368
v_mfma_f32_16x16x32_bf16 v[56:59], a[88:91], a[48:51], v[56:59]
s_add_u32 m0, s76, 34816
v_mfma_f32_16x16x32_bf16 v[56:59], a[92:95], a[52:55], v[56:59]
s_add_u32 s64, s70, 17280
v_mfma_f32_16x16x32_bf16 v[72:75], a[92:95], a[60:63], v[72:75]
s_waitcnt vmcnt(13)
buffer_load_dwordx4 v12, s[32:35], s64 offen lds
v_mfma_f32_16x16x32_bf16 v[72:75], a[88:91], a[56:59], v[72:75]
s_add_u32 s82, s82, 1048576
ds_read_b64_tr_b16 a[88:89], v8 offset:49152
v_mfma_f32_16x16x32_bf16 v[136:139], a[96:99], a[56:59], v[136:139]
buffer_load_dword a252, v1, s[60:63], s82 offen
v_mfma_f32_16x16x32_bf16 v[136:139], a[100:103], a[60:63], v[136:139]
ds_read_b64_tr_b16 a[90:91], v8 offset:50176
v_subrev_u32 v4, 0x8000, v4
v_mfma_f32_16x16x32_bf16 v[120:123], a[100:103], a[52:55], v[120:123]
ds_read_b64_tr_b16 a[92:93], v8 offset:57344
v_mfma_f32_16x16x32_bf16 v[120:123], a[96:99], a[48:51], v[120:123]
s_add_u32 m0, s76, 35840
ds_read_b64_tr_b16 a[94:95], v8 offset:58368
v_mfma_f32_16x16x32_bf16 v[104:107], a[96:99], a[40:43], v[104:107]
s_add_u32 s64, s70, 25472
ds_read_b128 a[0:3], v2 offset:0
v_mfma_f32_16x16x32_bf16 v[104:107], a[100:103], a[44:47], v[104:107]
buffer_load_dwordx4 v13, s[32:35], s64 offen lds
v_mfma_f32_16x16x32_bf16 v[88:91], a[100:103], a[36:39], v[88:91]
ds_read_b128 a[4:7], v3 offset:0
v_mfma_f32_16x16x32_bf16 v[88:91], a[96:99], a[32:35], v[88:91]
s_waitcnt lgkmcnt(6)
ds_read_b128 a[8:11], v2 offset:2048
v_mfma_f32_16x16x32_bf16 v[28:31], a[32:35], a[104:107], v[28:31]
ds_read_b128 a[12:15], v3 offset:2048
v_mfma_f32_16x16x32_bf16 v[28:31], a[36:39], a[108:111], v[28:31]
ds_read_b128 a[16:19], v2 offset:4096
v_subrev_u32 v5, 0x8000, v5
v_mfma_f32_16x16x32_bf16 v[44:47], a[44:47], a[108:111], v[44:47]
s_add_u32 m0, s76, 36864
ds_read_b128 a[20:23], v3 offset:4096
v_mfma_f32_16x16x32_bf16 v[44:47], a[40:43], a[104:107], v[44:47]
s_add_u32 s64, s70, 33664
ds_read_b128 a[24:27], v2 offset:6144
v_mfma_f32_16x16x32_bf16 v[60:63], a[48:51], a[104:107], v[60:63]
buffer_load_dwordx4 v12, s[32:35], s64 offen lds
v_mfma_f32_16x16x32_bf16 v[60:63], a[52:55], a[108:111], v[60:63]
ds_read_b128 a[28:31], v3 offset:6144
v_mfma_f32_16x16x32_bf16 v[76:79], a[60:63], a[108:111], v[76:79]
ds_read_b64_tr_b16 a[96:97], v9 offset:49152
v_mfma_f32_16x16x32_bf16 v[76:79], a[56:59], a[104:107], v[76:79]
ds_read_b64_tr_b16 a[98:99], v9 offset:50176
v_mfma_f32_16x16x32_bf16 v[140:143], a[56:59], a[112:115], v[140:143]
ds_read_b64_tr_b16 a[100:101], v9 offset:57344
v_mfma_f32_16x16x32_bf16 v[140:143], a[60:63], a[116:119], v[140:143]
s_add_u32 m0, s76, 37888
ds_read_b64_tr_b16 a[102:103], v9 offset:58368
v_subrev_u32 v6, 0x8000, v6
v_mfma_f32_16x16x32_bf16 v[124:127], a[52:55], a[116:119], v[124:127]
s_add_u32 s64, s70, 41856
ds_read_b64_tr_b16 a[104:105], v10 offset:49152
v_mfma_f32_16x16x32_bf16 v[124:127], a[48:51], a[112:115], v[124:127]
buffer_load_dwordx4 v13, s[32:35], s64 offen lds
v_mfma_f32_16x16x32_bf16 v[108:111], a[40:43], a[112:115], v[108:111]
ds_read_b64_tr_b16 a[106:107], v10 offset:50176
v_mfma_f32_16x16x32_bf16 v[108:111], a[44:47], a[116:119], v[108:111]
ds_read_b64_tr_b16 a[108:109], v10 offset:57344
v_mfma_f32_16x16x32_bf16 v[92:95], a[36:39], a[116:119], v[92:95]
ds_read_b64_tr_b16 a[110:111], v10 offset:58368
v_mfma_f32_16x16x32_bf16 v[92:95], a[32:35], a[112:115], v[92:95]
ds_read_b64_tr_b16 a[112:113], v11 offset:49152
v_mfma_f32_16x16x32_bf16 v[32:35], a[32:35], a[72:75], v[32:35]
s_add_u32 m0, s76, 38912
ds_read_b64_tr_b16 a[114:115], v11 offset:50176
v_mfma_f32_16x16x32_bf16 v[32:35], a[36:39], a[76:79], v[32:35]
s_add_u32 s64, s70, 50048
ds_read_b64_tr_b16 a[116:117], v11 offset:57344
v_subrev_u32 v7, 0x8000, v7
v_mfma_f32_16x16x32_bf16 v[48:51], a[44:47], a[76:79], v[48:51]
buffer_load_dwordx4 v12, s[32:35], s64 offen lds
v_mfma_f32_16x16x32_bf16 v[48:51], a[40:43], a[72:75], v[48:51]
ds_read_b64_tr_b16 a[118:119], v11 offset:58368
v_mfma_f32_16x16x32_bf16 v[64:67], a[48:51], a[72:75], v[64:67]
v_mfma_f32_16x16x32_bf16 v[64:67], a[52:55], a[76:79], v[64:67]
v_mfma_f32_16x16x32_bf16 v[80:83], a[60:63], a[76:79], v[80:83]
v_mfma_f32_16x16x32_bf16 v[80:83], a[56:59], a[72:75], v[80:83]
s_add_u32 m0, s76, 39936
v_mfma_f32_16x16x32_bf16 v[144:147], a[56:59], a[80:83], v[144:147]
s_add_u32 s64, s70, 58240
v_mfma_f32_16x16x32_bf16 v[144:147], a[60:63], a[84:87], v[144:147]
buffer_load_dwordx4 v13, s[32:35], s64 offen lds
v_mfma_f32_16x16x32_bf16 v[128:131], a[52:55], a[84:87], v[128:131]
v_subrev_u32 v8, 0x8000, v8
v_mfma_f32_16x16x32_bf16 v[128:131], a[48:51], a[80:83], v[128:131]
v_mfma_f32_16x16x32_bf16 v[112:115], a[40:43], a[80:83], v[112:115]
v_mfma_f32_16x16x32_bf16 v[112:115], a[44:47], a[84:87], v[112:115]
v_mfma_f32_16x16x32_bf16 v[96:99], a[36:39], a[84:87], v[96:99]
v_subrev_u32 v9, 0x8000, v9
v_subrev_u32 v10, 0x8000, v10
v_mfma_f32_16x16x32_bf16 v[96:99], a[32:35], a[80:83], v[96:99]
s_waitcnt lgkmcnt(0)
v_subrev_u32 v11, 0x8000, v11
v_mfma_f32_16x16x32_bf16 v[36:39], a[32:35], a[88:91], v[36:39]
v_mfma_f32_16x16x32_bf16 v[36:39], a[36:39], a[92:95], v[36:39]
v_mfma_f32_16x16x32_bf16 v[52:55], a[44:47], a[92:95], v[52:55]
s_waitcnt lgkmcnt(0)
s_barrier
v_mfma_f32_16x16x32_bf16 v[52:55], a[40:43], a[88:91], v[52:55]
s_add_u32 m0, s77, 131072
ds_read_b64_tr_b16 a[72:73], v4 offset:0
v_mfma_f32_16x16x32_bf16 v[68:71], a[48:51], a[88:91], v[68:71]
s_add_u32 s64, s71, 0
ds_read_b64_tr_b16 a[74:75], v4 offset:1024
v_mfma_f32_16x16x32_bf16 v[68:71], a[52:55], a[92:95], v[68:71]
buffer_load_dwordx4 v14, s[56:59], s64 offen lds
v_mfma_f32_16x16x32_bf16 v[84:87], a[60:63], a[92:95], v[84:87]
ds_read_b64_tr_b16 a[76:77], v4 offset:8192
v_mfma_f32_16x16x32_bf16 v[84:87], a[56:59], a[88:91], v[84:87]
ds_read_b64_tr_b16 a[78:79], v4 offset:9216
v_mfma_f32_16x16x32_bf16 v[148:151], a[56:59], a[96:99], v[148:151]
ds_read_b64_tr_b16 a[80:81], v5 offset:0
v_lshrrev_b32 v13, 3, v0
v_mfma_f32_16x16x32_bf16 v[148:151], a[60:63], a[100:103], v[148:151]
ds_read_b64_tr_b16 a[82:83], v5 offset:1024
v_lshl_add_u32 v12, v13, 10, v12
v_mfma_f32_16x16x32_bf16 v[132:135], a[52:55], a[100:103], v[132:135]
ds_read_b64_tr_b16 a[84:85], v5 offset:8192
v_xor_b32 v13, 64, v12
v_mfma_f32_16x16x32_bf16 v[132:135], a[48:51], a[96:99], v[132:135]
ds_read_b64_tr_b16 a[86:87], v5 offset:9216
v_mfma_f32_16x16x32_bf16 v[116:119], a[40:43], a[96:99], v[116:119]
s_add_u32 m0, s78, 147456
ds_read_b64_tr_b16 a[88:89], v6 offset:0
v_mfma_f32_16x16x32_bf16 v[116:119], a[44:47], a[100:103], v[116:119]
s_add_u32 s64, s75, 0
ds_read_b64_tr_b16 a[90:91], v6 offset:1024
v_mfma_f32_16x16x32_bf16 v[100:103], a[36:39], a[100:103], v[100:103]
buffer_load_dwordx4 v23, s[60:63], s64 offen lds
v_mfma_f32_16x16x32_bf16 v[100:103], a[32:35], a[96:99], v[100:103]
ds_read_b64_tr_b16 a[92:93], v6 offset:8192
v_mfma_f32_16x16x32_bf16 v[248:251], a[32:35], a[104:107], v[248:251]
ds_read_b64_tr_b16 a[94:95], v6 offset:9216
v_mfma_f32_16x16x32_bf16 v[248:251], a[36:39], a[108:111], v[248:251]
ds_read_b64_tr_b16 a[96:97], v7 offset:0
v_mfma_f32_16x16x32_bf16 v[252:255], a[44:47], a[108:111], v[252:255]
ds_read_b64_tr_b16 a[98:99], v7 offset:1024
v_mfma_f32_16x16x32_bf16 v[252:255], a[40:43], a[104:107], v[252:255]
ds_read_b64_tr_b16 a[100:101], v7 offset:8192
v_mfma_f32_16x16x32_bf16 a[120:123], a[48:51], a[104:107], a[120:123]
ds_read_b64_tr_b16 a[102:103], v7 offset:9216
v_mfma_f32_16x16x32_bf16 a[120:123], a[52:55], a[108:111], a[120:123]
s_add_u32 m0, s77, 132096
v_mfma_f32_16x16x32_bf16 a[124:127], a[60:63], a[108:111], a[124:127]
s_add_u32 s64, s71, 32768
v_mfma_f32_16x16x32_bf16 a[124:127], a[56:59], a[104:107], a[124:127]
buffer_load_dwordx4 v14, s[56:59], s64 offen lds
v_mfma_f32_16x16x32_bf16 a[128:131], a[56:59], a[112:115], a[128:131]
ds_read_b64_tr_b16 a[104:105], v8 offset:0
v_mfma_f32_16x16x32_bf16 a[128:131], a[60:63], a[116:119], a[128:131]
ds_read_b64_tr_b16 a[106:107], v8 offset:1024
v_mfma_f32_16x16x32_bf16 a[132:135], a[52:55], a[116:119], a[132:135]
ds_read_b64_tr_b16 a[108:109], v8 offset:8192
v_mfma_f32_16x16x32_bf16 a[132:135], a[48:51], a[112:115], a[132:135]
ds_read_b64_tr_b16 a[110:111], v8 offset:9216
v_mfma_f32_16x16x32_bf16 a[136:139], a[40:43], a[112:115], a[136:139]
v_mfma_f32_16x16x32_bf16 a[136:139], a[44:47], a[116:119], a[136:139]
v_mfma_f32_16x16x32_bf16 a[140:143], a[36:39], a[116:119], a[140:143]
s_add_u32 m0, s78, 151552
v_mfma_f32_16x16x32_bf16 a[140:143], a[32:35], a[112:115], a[140:143]
s_waitcnt lgkmcnt(4)
s_add_u32 s64, s75, 2048
ds_read_b64_tr_b16 a[112:113], v9 offset:0
v_mfma_f32_16x16x32_bf16 v[184:187], a[72:75], a[0:3], v[184:187]
buffer_load_dwordx4 v23, s[60:63], s64 offen lds
v_mfma_f32_16x16x32_bf16 v[184:187], a[76:79], a[4:7], v[184:187]
ds_read_b64_tr_b16 a[114:115], v9 offset:1024
v_mfma_f32_16x16x32_bf16 v[192:195], a[76:79], a[12:15], v[192:195]
ds_read_b64_tr_b16 a[116:117], v9 offset:8192
v_mfma_f32_16x16x32_bf16 v[192:195], a[72:75], a[8:11], v[192:195]
s_add_u32 s17, s78, .-L_pc+6144
ds_read_b64_tr_b16 a[118:119], v9 offset:9216
v_mfma_f32_16x16x32_bf16 v[200:203], a[72:75], a[16:19], v[200:203]
buffer_load_dword a252, v16, s[88:91], s17 offen
v_mfma_f32_16x16x32_bf16 v[200:203], a[76:79], a[20:23], v[200:203]
v_mfma_f32_16x16x32_bf16 v[208:211], a[76:79], a[28:31], v[208:211]
v_mfma_f32_16x16x32_bf16 v[208:211], a[72:75], a[24:27], v[208:211]
ds_read_b64_tr_b16 a[72:73], v10 offset:0
v_mfma_f32_16x16x32_bf16 v[212:215], a[80:83], a[24:27], v[212:215]
s_add_u32 m0, s77, 133120
ds_read_b64_tr_b16 a[74:75], v10 offset:1024
v_mfma_f32_16x16x32_bf16 v[212:215], a[84:87], a[28:31], v[212:215]
s_add_u32 s64, s71, 65536
ds_read_b64_tr_b16 a[76:77], v10 offset:8192
v_mfma_f32_16x16x32_bf16 v[204:207], a[84:87], a[20:23], v[204:207]
buffer_load_dwordx4 v15, s[56:59], s64 offen lds
v_mfma_f32_16x16x32_bf16 v[204:207], a[80:83], a[16:19], v[204:207]
ds_read_b64_tr_b16 a[78:79], v10 offset:9216
v_mfma_f32_16x16x32_bf16 v[196:199], a[80:83], a[8:11], v[196:199]
v_mfma_f32_16x16x32_bf16 v[196:199], a[84:87], a[12:15], v[196:199]
v_mfma_f32_16x16x32_bf16 v[188:191], a[84:87], a[4:7], v[188:191]
v_mfma_f32_16x16x32_bf16 v[188:191], a[80:83], a[0:3], v[188:191]
ds_read_b64_tr_b16 a[80:81], v11 offset:0
v_mfma_f32_16x16x32_bf16 v[216:219], a[88:91], a[0:3], v[216:219]
ds_read_b64_tr_b16 a[82:83], v11 offset:1024
v_mfma_f32_16x16x32_bf16 v[216:219], a[92:95], a[4:7], v[216:219]
s_add_u32 m0, s78, 155648
ds_read_b64_tr_b16 a[84:85], v11 offset:8192
v_mfma_f32_16x16x32_bf16 v[224:227], a[92:95], a[12:15], v[224:227]
s_add_u32 s64, s75, 4096
ds_read_b64_tr_b16 a[86:87], v11 offset:9216
v_mfma_f32_16x16x32_bf16 v[224:227], a[88:91], a[8:11], v[224:227]
buffer_load_dwordx4 v23, s[60:63], s64 offen lds
v_mfma_f32_16x16x32_bf16 v[232:235], a[88:91], a[16:19], v[232:235]
v_mfma_f32_16x16x32_bf16 v[232:235], a[92:95], a[20:23], v[232:235]
v_mfma_f32_16x16x32_bf16 v[240:243], a[92:95], a[28:31], v[240:243]
v_mfma_f32_16x16x32_bf16 v[240:243], a[88:91], a[24:27], v[240:243]
ds_read_b64_tr_b16 a[88:89], v4 offset:16384
v_mfma_f32_16x16x32_bf16 v[244:247], a[96:99], a[24:27], v[244:247]
ds_read_b64_tr_b16 a[90:91], v4 offset:17408
v_mfma_f32_16x16x32_bf16 v[244:247], a[100:103], a[28:31], v[244:247]
ds_read_b64_tr_b16 a[92:93], v4 offset:24576
v_mfma_f32_16x16x32_bf16 v[236:239], a[100:103], a[20:23], v[236:239]
s_add_u32 m0, s77, 134144
ds_read_b64_tr_b16 a[94:95], v4 offset:25600
v_mfma_f32_16x16x32_bf16 v[236:239], a[96:99], a[16:19], v[236:239]
s_add_u32 s64, s71, 98304
v_mfma_f32_16x16x32_bf16 v[228:231], a[96:99], a[8:11], v[228:231]
buffer_load_dwordx4 v15, s[56:59], s64 offen lds
v_mfma_f32_16x16x32_bf16 v[228:231], a[100:103], a[12:15], v[228:231]
v_mfma_f32_16x16x32_bf16 v[220:223], a[100:103], a[4:7], v[220:223]
v_mfma_f32_16x16x32_bf16 v[220:223], a[96:99], a[0:3], v[220:223]
s_waitcnt lgkmcnt(4)
ds_read_b64_tr_b16 a[96:97], v5 offset:16384
v_mfma_f32_16x16x32_bf16 v[152:155], a[104:107], a[0:3], v[152:155]
ds_read_b64_tr_b16 a[98:99], v5 offset:17408
v_mfma_f32_16x16x32_bf16 v[152:155], a[108:111], a[4:7], v[152:155]
ds_read_b64_tr_b16 a[100:101], v5 offset:24576
v_mfma_f32_16x16x32_bf16 v[160:163], a[108:111], a[12:15], v[160:163]
ds_read_b64_tr_b16 a[102:103], v5 offset:25600
v_mfma_f32_16x16x32_bf16 v[160:163], a[104:107], a[8:11], v[160:163]
v_mfma_f32_16x16x32_bf16 v[168:171], a[104:107], a[16:19], v[168:171]
v_mfma_f32_16x16x32_bf16 v[168:171], a[108:111], a[20:23], v[168:171]
v_mfma_f32_16x16x32_bf16 v[176:179], a[108:111], a[28:31], v[176:179]
s_add_u32 m0, s76, 0
v_mfma_f32_16x16x32_bf16 v[176:179], a[104:107], a[24:27], v[176:179]
s_add_u32 s64, s72, 0
ds_read_b64_tr_b16 a[104:105], v6 offset:16384
v_mfma_f32_16x16x32_bf16 v[180:183], a[112:115], a[24:27], v[180:183]
buffer_load_dwordx4 v12, s[48:51], s64 offen lds
v_mfma_f32_16x16x32_bf16 v[180:183], a[116:119], a[28:31], v[180:183]
ds_read_b64_tr_b16 a[106:107], v6 offset:17408
v_mfma_f32_16x16x32_bf16 v[172:175], a[116:119], a[20:23], v[172:175]
ds_read_b64_tr_b16 a[108:109], v6 offset:24576
v_mfma_f32_16x16x32_bf16 v[172:175], a[112:115], a[16:19], v[172:175]
ds_read_b64_tr_b16 a[110:111], v6 offset:25600
v_mfma_f32_16x16x32_bf16 v[164:167], a[112:115], a[8:11], v[164:167]
v_mfma_f32_16x16x32_bf16 v[164:167], a[116:119], a[12:15], v[164:167]
s_add_u32 m0, s76, 1024
v_mfma_f32_16x16x32_bf16 v[156:159], a[116:119], a[4:7], v[156:159]
s_add_u32 s64, s72, 16384
v_mfma_f32_16x16x32_bf16 v[156:159], a[112:115], a[0:3], v[156:159]
buffer_load_dwordx4 v13, s[48:51], s64 offen lds
v_mfma_f32_16x16x32_bf16 v[24:27], a[72:75], a[0:3], v[24:27]
ds_read_b64_tr_b16 a[112:113], v7 offset:16384
v_mfma_f32_16x16x32_bf16 v[24:27], a[76:79], a[4:7], v[24:27]
ds_read_b64_tr_b16 a[114:115], v7 offset:17408
v_mfma_f32_16x16x32_bf16 v[40:43], a[76:79], a[12:15], v[40:43]
ds_read_b64_tr_b16 a[116:117], v7 offset:24576
v_mfma_f32_16x16x32_bf16 v[40:43], a[72:75], a[8:11], v[40:43]
ds_read_b64_tr_b16 a[118:119], v7 offset:25600
v_mfma_f32_16x16x32_bf16 v[56:59], a[72:75], a[16:19], v[56:59]
s_add_u32 m0, s76, 2048
v_mfma_f32_16x16x32_bf16 v[56:59], a[76:79], a[20:23], v[56:59]
s_add_u32 s64, s72, 131072
v_mfma_f32_16x16x32_bf16 v[72:75], a[76:79], a[28:31], v[72:75]
s_waitcnt vmcnt(10)
buffer_load_dwordx4 v12, s[48:51], s64 offen lds
v_mfma_f32_16x16x32_bf16 v[72:75], a[72:75], a[24:27], v[72:75]
ds_read_b64_tr_b16 a[72:73], v8 offset:16384
v_mfma_f32_16x16x32_bf16 v[136:139], a[80:83], a[24:27], v[136:139]
ds_read_b64_tr_b16 a[74:75], v8 offset:17408
v_mfma_f32_16x16x32_bf16 v[136:139], a[84:87], a[28:31], v[136:139]
ds_read_b64_tr_b16 a[76:77], v8 offset:24576
v_mfma_f32_16x16x32_bf16 v[120:123], a[84:87], a[20:23], v[120:123]
ds_read_b64_tr_b16 a[78:79], v8 offset:25600
v_mfma_f32_16x16x32_bf16 v[120:123], a[80:83], a[16:19], v[120:123]
s_add_u32 m0, s76, 3072
ds_read_b128 a[32:35], v2 offset:32768
v_mfma_f32_16x16x32_bf16 v[104:107], a[80:83], a[8:11], v[104:107]
s_add_u32 s64, s72, 147456
ds_read_b128 a[36:39], v3 offset:32768
v_mfma_f32_16x16x32_bf16 v[104:107], a[84:87], a[12:15], v[104:107]
buffer_load_dwordx4 v13, s[48:51], s64 offen lds
v_mfma_f32_16x16x32_bf16 v[88:91], a[84:87], a[4:7], v[88:91]
ds_read_b128 a[40:43], v2 offset:34816
v_mfma_f32_16x16x32_bf16 v[88:91], a[80:83], a[0:3], v[88:91]
s_waitcnt lgkmcnt(7)
ds_read_b128 a[44:47], v3 offset:34816
v_mfma_f32_16x16x32_bf16 v[28:31], a[0:3], a[88:91], v[28:31]
ds_read_b128 a[48:51], v2 offset:36864
v_mfma_f32_16x16x32_bf16 v[28:31], a[4:7], a[92:95], v[28:31]
ds_read_b128 a[52:55], v3 offset:36864
v_mfma_f32_16x16x32_bf16 v[44:47], a[12:15], a[92:95], v[44:47]
s_add_u32 m0, s76, 4096
ds_read_b128 a[56:59], v2 offset:38912
v_mfma_f32_16x16x32_bf16 v[44:47], a[8:11], a[88:91], v[44:47]
s_add_u32 s64, s73, 0
ds_read_b128 a[60:63], v3 offset:38912
v_mfma_f32_16x16x32_bf16 v[60:63], a[16:19], a[88:91], v[60:63]
buffer_load_dwordx4 v12, s[48:51], s64 offen lds
v_mfma_f32_16x16x32_bf16 v[60:63], a[20:23], a[92:95], v[60:63]
ds_read_b64_tr_b16 a[80:81], v9 offset:16384
v_mfma_f32_16x16x32_bf16 v[76:79], a[28:31], a[92:95], v[76:79]
ds_read_b64_tr_b16 a[82:83], v9 offset:17408
v_mfma_f32_16x16x32_bf16 v[76:79], a[24:27], a[88:91], v[76:79]
ds_read_b64_tr_b16 a[84:85], v9 offset:24576
v_mfma_f32_16x16x32_bf16 v[140:143], a[24:27], a[96:99], v[140:143]
ds_read_b64_tr_b16 a[86:87], v9 offset:25600
v_mfma_f32_16x16x32_bf16 v[140:143], a[28:31], a[100:103], v[140:143]
s_add_u32 m0, s76, 5120
ds_read_b64_tr_b16 a[88:89], v10 offset:16384
v_mfma_f32_16x16x32_bf16 v[124:127], a[20:23], a[100:103], v[124:127]
s_add_u32 s64, s73, 16384
ds_read_b64_tr_b16 a[90:91], v10 offset:17408
v_mfma_f32_16x16x32_bf16 v[124:127], a[16:19], a[96:99], v[124:127]
buffer_load_dwordx4 v13, s[48:51], s64 offen lds
v_mfma_f32_16x16x32_bf16 v[108:111], a[8:11], a[96:99], v[108:111]
ds_read_b64_tr_b16 a[92:93], v10 offset:24576
v_mfma_f32_16x16x32_bf16 v[108:111], a[12:15], a[100:103], v[108:111]
ds_read_b64_tr_b16 a[94:95], v10 offset:25600
v_mfma_f32_16x16x32_bf16 v[92:95], a[4:7], a[100:103], v[92:95]
v_mfma_f32_16x16x32_bf16 v[92:95], a[0:3], a[96:99], v[92:95]
ds_read_b64_tr_b16 a[96:97], v11 offset:16384
v_mfma_f32_16x16x32_bf16 v[32:35], a[0:3], a[104:107], v[32:35]
s_add_u32 m0, s76, 6144
ds_read_b64_tr_b16 a[98:99], v11 offset:17408
v_mfma_f32_16x16x32_bf16 v[32:35], a[4:7], a[108:111], v[32:35]
s_add_u32 s64, s73, 131072
ds_read_b64_tr_b16 a[100:101], v11 offset:24576
v_mfma_f32_16x16x32_bf16 v[48:51], a[12:15], a[108:111], v[48:51]
buffer_load_dwordx4 v12, s[48:51], s64 offen lds
v_mfma_f32_16x16x32_bf16 v[48:51], a[8:11], a[104:107], v[48:51]
ds_read_b64_tr_b16 a[102:103], v11 offset:25600
v_mfma_f32_16x16x32_bf16 v[64:67], a[16:19], a[104:107], v[64:67]
v_mfma_f32_16x16x32_bf16 v[64:67], a[20:23], a[108:111], v[64:67]
v_mfma_f32_16x16x32_bf16 v[80:83], a[28:31], a[108:111], v[80:83]
v_mfma_f32_16x16x32_bf16 v[80:83], a[24:27], a[104:107], v[80:83]
s_add_u32 m0, s76, 7168
v_mfma_f32_16x16x32_bf16 v[144:147], a[24:27], a[112:115], v[144:147]
s_add_u32 s64, s73, 147456
v_mfma_f32_16x16x32_bf16 v[144:147], a[28:31], a[116:119], v[144:147]
buffer_load_dwordx4 v13, s[48:51], s64 offen lds
v_mfma_f32_16x16x32_bf16 v[128:131], a[20:23], a[116:119], v[128:131]
v_mfma_f32_16x16x32_bf16 v[128:131], a[16:19], a[112:115], v[128:131]
v_mfma_f32_16x16x32_bf16 v[112:115], a[8:11], a[112:115], v[112:115]
v_mfma_f32_16x16x32_bf16 v[112:115], a[12:15], a[116:119], v[112:115]
v_mfma_f32_16x16x32_bf16 v[96:99], a[4:7], a[116:119], v[96:99]
v_mfma_f32_16x16x32_bf16 v[96:99], a[0:3], a[112:115], v[96:99]
s_waitcnt lgkmcnt(0)
v_mfma_f32_16x16x32_bf16 v[36:39], a[0:3], a[72:75], v[36:39]
v_mfma_f32_16x16x32_bf16 v[36:39], a[4:7], a[76:79], v[36:39]
v_mfma_f32_16x16x32_bf16 v[52:55], a[12:15], a[76:79], v[52:55]
s_waitcnt lgkmcnt(0)
s_barrier
v_mfma_f32_16x16x32_bf16 v[52:55], a[8:11], a[72:75], v[52:55]
s_add_u32 m0, s77, 65536
ds_read_b64_tr_b16 a[104:105], v4 offset:32768
v_mfma_f32_16x16x32_bf16 v[68:71], a[16:19], a[72:75], v[68:71]
s_add_u32 s64, s71, 524288
ds_read_b64_tr_b16 a[106:107], v4 offset:33792
v_mfma_f32_16x16x32_bf16 v[68:71], a[20:23], a[76:79], v[68:71]
buffer_load_dwordx4 v14, s[56:59], s64 offen lds
v_mfma_f32_16x16x32_bf16 v[84:87], a[28:31], a[76:79], v[84:87]
ds_read_b64_tr_b16 a[108:109], v4 offset:40960
v_mfma_f32_16x16x32_bf16 v[84:87], a[24:27], a[72:75], v[84:87]
ds_read_b64_tr_b16 a[110:111], v4 offset:41984
v_mfma_f32_16x16x32_bf16 v[148:151], a[24:27], a[80:83], v[148:151]
ds_read_b64_tr_b16 a[112:113], v5 offset:32768
v_mfma_f32_16x16x32_bf16 v[148:151], a[28:31], a[84:87], v[148:151]
ds_read_b64_tr_b16 a[114:115], v5 offset:33792
v_mfma_f32_16x16x32_bf16 v[132:135], a[20:23], a[84:87], v[132:135]
ds_read_b64_tr_b16 a[116:117], v5 offset:40960
v_mfma_f32_16x16x32_bf16 v[132:135], a[16:19], a[80:83], v[132:135]
ds_read_b64_tr_b16 a[118:119], v5 offset:41984
v_mfma_f32_16x16x32_bf16 v[116:119], a[8:11], a[80:83], v[116:119]
s_add_u32 m0, s78, 81920
ds_read_b64_tr_b16 a[72:73], v6 offset:32768
v_mfma_f32_16x16x32_bf16 v[116:119], a[12:15], a[84:87], v[116:119]
s_add_u32 s64, s75, 393216
ds_read_b64_tr_b16 a[74:75], v6 offset:33792
v_mfma_f32_16x16x32_bf16 v[100:103], a[4:7], a[84:87], v[100:103]
buffer_load_dwordx4 v23, s[60:63], s64 offen lds
v_mfma_f32_16x16x32_bf16 v[100:103], a[0:3], a[80:83], v[100:103]
ds_read_b64_tr_b16 a[76:77], v6 offset:40960
v_mfma_f32_16x16x32_bf16 v[248:251], a[0:3], a[88:91], v[248:251]
ds_read_b64_tr_b16 a[78:79], v6 offset:41984
v_mfma_f32_16x16x32_bf16 v[248:251], a[4:7], a[92:95], v[248:251]
ds_read_b64_tr_b16 a[80:81], v7 offset:32768
v_mfma_f32_16x16x32_bf16 v[252:255], a[12:15], a[92:95], v[252:255]
ds_read_b64_tr_b16 a[82:83], v7 offset:33792
v_mfma_f32_16x16x32_bf16 v[252:255], a[8:11], a[88:91], v[252:255]
ds_read_b64_tr_b16 a[84:85], v7 offset:40960
v_mfma_f32_16x16x32_bf16 a[120:123], a[16:19], a[88:91], a[120:123]
ds_read_b64_tr_b16 a[86:87], v7 offset:41984
v_mfma_f32_16x16x32_bf16 a[120:123], a[20:23], a[92:95], a[120:123]
s_add_u32 m0, s77, 66560
v_mfma_f32_16x16x32_bf16 a[124:127], a[28:31], a[92:95], a[124:127]
s_add_u32 s64, s71, 557056
v_mfma_f32_16x16x32_bf16 a[124:127], a[24:27], a[88:91], a[124:127]
buffer_load_dwordx4 v14, s[56:59], s64 offen lds
v_mfma_f32_16x16x32_bf16 a[128:131], a[24:27], a[96:99], a[128:131]
ds_read_b64_tr_b16 a[88:89], v8 offset:32768
v_mfma_f32_16x16x32_bf16 a[128:131], a[28:31], a[100:103], a[128:131]
ds_read_b64_tr_b16 a[90:91], v8 offset:33792
v_mfma_f32_16x16x32_bf16 a[132:135], a[20:23], a[100:103], a[132:135]
ds_read_b64_tr_b16 a[92:93], v8 offset:40960
v_mfma_f32_16x16x32_bf16 a[132:135], a[16:19], a[96:99], a[132:135]
ds_read_b64_tr_b16 a[94:95], v8 offset:41984
v_mfma_f32_16x16x32_bf16 a[136:139], a[8:11], a[96:99], a[136:139]
v_mfma_f32_16x16x32_bf16 a[136:139], a[12:15], a[100:103], a[136:139]
v_mfma_f32_16x16x32_bf16 a[140:143], a[4:7], a[100:103], a[140:143]
s_add_u32 m0, s78, 86016
v_mfma_f32_16x16x32_bf16 a[140:143], a[0:3], a[96:99], a[140:143]
s_waitcnt lgkmcnt(4)
s_add_u32 s64, s75, 395264
ds_read_b64_tr_b16 a[96:97], v9 offset:32768
v_mfma_f32_16x16x32_bf16 v[184:187], a[104:107], a[32:35], v[184:187]
s_lshl_b32 s66, s30, 30
buffer_load_dwordx4 v23, s[60:63], s64 offen lds
v_mfma_f32_16x16x32_bf16 v[184:187], a[108:111], a[36:39], v[184:187]
ds_read_b64_tr_b16 a[98:99], v9 offset:33792
v_lshl_add_u32 v1, v0, 24, s66
v_mfma_f32_16x16x32_bf16 v[192:195], a[108:111], a[44:47], v[192:195]
s_lshr_b32 s66, s3, 1
ds_read_b64_tr_b16 a[100:101], v9 offset:40960
v_mfma_f32_16x16x32_bf16 v[192:195], a[104:107], a[40:43], v[192:195]
s_lshl_b32 s66, s66, 12
ds_read_b64_tr_b16 a[102:103], v9 offset:41984
v_mfma_f32_16x16x32_bf16 v[200:203], a[104:107], a[48:51], v[200:203]
v_mfma_f32_16x16x32_bf16 v[200:203], a[108:111], a[52:55], v[200:203]
v_mfma_f32_16x16x32_bf16 v[208:211], a[108:111], a[60:63], v[208:211]
v_mfma_f32_16x16x32_bf16 v[208:211], a[104:107], a[56:59], v[208:211]
ds_read_b64_tr_b16 a[104:105], v10 offset:32768
v_mfma_f32_16x16x32_bf16 v[212:215], a[112:115], a[56:59], v[212:215]
s_add_u32 m0, s77, 67584
ds_read_b64_tr_b16 a[106:107], v10 offset:33792
v_mfma_f32_16x16x32_bf16 v[212:215], a[116:119], a[60:63], v[212:215]
s_add_u32 s64, s71, 589824
ds_read_b64_tr_b16 a[108:109], v10 offset:40960
v_mfma_f32_16x16x32_bf16 v[204:207], a[116:119], a[52:55], v[204:207]
buffer_load_dwordx4 v15, s[56:59], s64 offen lds
v_mfma_f32_16x16x32_bf16 v[204:207], a[112:115], a[48:51], v[204:207]
ds_read_b64_tr_b16 a[110:111], v10 offset:41984
v_mfma_f32_16x16x32_bf16 v[196:199], a[112:115], a[40:43], v[196:199]
v_mfma_f32_16x16x32_bf16 v[196:199], a[116:119], a[44:47], v[196:199]
v_mfma_f32_16x16x32_bf16 v[188:191], a[116:119], a[36:39], v[188:191]
v_mfma_f32_16x16x32_bf16 v[188:191], a[112:115], a[32:35], v[188:191]
s_add_u32 s67, s79, 20480
ds_read_b64_tr_b16 a[112:113], v11 offset:32768
v_mfma_f32_16x16x32_bf16 v[216:219], a[72:75], a[32:35], v[216:219]
ds_read_b64_tr_b16 a[114:115], v11 offset:33792
v_mfma_f32_16x16x32_bf16 v[216:219], a[76:79], a[36:39], v[216:219]
s_add_u32 m0, s78, 90112
ds_read_b64_tr_b16 a[116:117], v11 offset:40960
v_cvt_pk_bf16_f32 v215, v214, v215
v_mfma_f32_16x16x32_bf16 v[224:227], a[76:79], a[44:47], v[224:227]
s_add_u32 s64, s75, 397312
ds_read_b64_tr_b16 a[118:119], v11 offset:41984
v_cvt_pk_bf16_f32 v214, v212, v213
v_mfma_f32_16x16x32_bf16 v[224:227], a[72:75], a[40:43], v[224:227]
buffer_load_dwordx4 v23, s[60:63], s64 offen lds
v_mfma_f32_16x16x32_bf16 v[232:235], a[72:75], a[48:51], v[232:235]
v_cvt_pk_bf16_f32 v212, v208, v209
v_cvt_pk_bf16_f32 v213, v210, v211
v_mfma_f32_16x16x32_bf16 v[232:235], a[76:79], a[52:55], v[232:235]
buffer_store_dwordx4 v[212:215], v16, s[44:47], s67 offen sc1
v_mfma_f32_16x16x32_bf16 v[240:243], a[76:79], a[60:63], v[240:243]
v_cvt_pk_bf16_f32 v207, v206, v207
v_cvt_pk_bf16_f32 v206, v204, v205
v_mfma_f32_16x16x32_bf16 v[240:243], a[72:75], a[56:59], v[240:243]
ds_read_b64_tr_b16 a[72:73], v4 offset:49152
v_cvt_pk_bf16_f32 v204, v200, v201
v_mfma_f32_16x16x32_bf16 v[244:247], a[80:83], a[56:59], v[244:247]
ds_read_b64_tr_b16 a[74:75], v4 offset:50176
v_cvt_pk_bf16_f32 v205, v202, v203
v_mfma_f32_16x16x32_bf16 v[244:247], a[84:87], a[60:63], v[244:247]
ds_read_b64_tr_b16 a[76:77], v4 offset:57344
v_accvgpr_write_b32 a144, v204
v_mfma_f32_16x16x32_bf16 v[236:239], a[84:87], a[52:55], v[236:239]
s_add_u32 m0, s77, 68608
ds_read_b64_tr_b16 a[78:79], v4 offset:58368
v_accvgpr_write_b32 a145, v205
v_mfma_f32_16x16x32_bf16 v[236:239], a[80:83], a[48:51], v[236:239]
s_add_u32 s64, s71, 622592
v_accvgpr_write_b32 a146, v206
v_accvgpr_write_b32 a147, v207
v_mfma_f32_16x16x32_bf16 v[228:231], a[80:83], a[40:43], v[228:231]
buffer_load_dwordx4 v15, s[56:59], s64 offen lds
v_mfma_f32_16x16x32_bf16 v[228:231], a[84:87], a[44:47], v[228:231]
v_cvt_pk_bf16_f32 v199, v198, v199
v_cvt_pk_bf16_f32 v198, v196, v197
v_mfma_f32_16x16x32_bf16 v[220:223], a[84:87], a[36:39], v[220:223]
v_cvt_pk_bf16_f32 v196, v192, v193
v_cvt_pk_bf16_f32 v197, v194, v195
v_mfma_f32_16x16x32_bf16 v[220:223], a[80:83], a[32:35], v[220:223]
s_waitcnt lgkmcnt(4)
ds_read_b64_tr_b16 a[80:81], v5 offset:49152
v_accvgpr_write_b32 a148, v196
v_mfma_f32_16x16x32_bf16 v[152:155], a[88:91], a[32:35], v[152:155]
ds_read_b64_tr_b16 a[82:83], v5 offset:50176
v_accvgpr_write_b32 a149, v197
v_mfma_f32_16x16x32_bf16 v[152:155], a[92:95], a[36:39], v[152:155]
ds_read_b64_tr_b16 a[84:85], v5 offset:57344
v_accvgpr_write_b32 a150, v198
v_mfma_f32_16x16x32_bf16 v[160:163], a[92:95], a[44:47], v[160:163]
ds_read_b64_tr_b16 a[86:87], v5 offset:58368
v_accvgpr_write_b32 a151, v199
v_mfma_f32_16x16x32_bf16 v[160:163], a[88:91], a[40:43], v[160:163]
v_cvt_pk_bf16_f32 v191, v190, v191
v_cvt_pk_bf16_f32 v190, v188, v189
v_mfma_f32_16x16x32_bf16 v[168:171], a[88:91], a[48:51], v[168:171]
v_cvt_pk_bf16_f32 v188, v184, v185
v_cvt_pk_bf16_f32 v189, v186, v187
v_mfma_f32_16x16x32_bf16 v[168:171], a[92:95], a[52:55], v[168:171]
v_accvgpr_write_b32 a152, v188
v_accvgpr_write_b32 a153, v189
v_mfma_f32_16x16x32_bf16 v[176:179], a[92:95], a[60:63], v[176:179]
s_add_u32 m0, s76, 32768
v_accvgpr_write_b32 a154, v190
v_accvgpr_write_b32 a155, v191
v_mfma_f32_16x16x32_bf16 v[176:179], a[88:91], a[56:59], v[176:179]
s_add_u32 s67, s79, 21504
s_add_u32 s64, s72, 128
ds_read_b64_tr_b16 a[88:89], v6 offset:49152
v_cvt_pk_bf16_f32 v247, v246, v247
v_mfma_f32_16x16x32_bf16 v[180:183], a[96:99], a[56:59], v[180:183]
buffer_load_dwordx4 v12, s[48:51], s64 offen lds
v_mfma_f32_16x16x32_bf16 v[180:183], a[100:103], a[60:63], v[180:183]
ds_read_b64_tr_b16 a[90:91], v6 offset:50176
v_cvt_pk_bf16_f32 v246, v244, v245
v_mfma_f32_16x16x32_bf16 v[172:175], a[100:103], a[52:55], v[172:175]
ds_read_b64_tr_b16 a[92:93], v6 offset:57344
v_cvt_pk_bf16_f32 v244, v240, v241
v_mfma_f32_16x16x32_bf16 v[172:175], a[96:99], a[48:51], v[172:175]
ds_read_b64_tr_b16 a[94:95], v6 offset:58368
v_cvt_pk_bf16_f32 v245, v242, v243
v_mfma_f32_16x16x32_bf16 v[164:167], a[96:99], a[40:43], v[164:167]
buffer_store_dwordx4 v[244:247], v16, s[44:47], s67 offen sc1
v_mfma_f32_16x16x32_bf16 v[164:167], a[100:103], a[44:47], v[164:167]
s_add_u32 m0, s76, 33792
v_cvt_pk_bf16_f32 v239, v238, v239
v_cvt_pk_bf16_f32 v238, v236, v237
v_mfma_f32_16x16x32_bf16 v[156:159], a[100:103], a[36:39], v[156:159]
s_add_u32 s64, s72, 16512
v_cvt_pk_bf16_f32 v236, v232, v233
v_cvt_pk_bf16_f32 v237, v234, v235
v_mfma_f32_16x16x32_bf16 v[156:159], a[96:99], a[32:35], v[156:159]
buffer_load_dwordx4 v13, s[48:51], s64 offen lds
v_mfma_f32_16x16x32_bf16 v[24:27], a[104:107], a[32:35], v[24:27]
ds_read_b64_tr_b16 a[96:97], v7 offset:49152
v_accvgpr_write_b32 a156, v236
v_mfma_f32_16x16x32_bf16 v[24:27], a[108:111], a[36:39], v[24:27]
ds_read_b64_tr_b16 a[98:99], v7 offset:50176
v_accvgpr_write_b32 a157, v237
v_mfma_f32_16x16x32_bf16 v[40:43], a[108:111], a[44:47], v[40:43]
ds_read_b64_tr_b16 a[100:101], v7 offset:57344
v_accvgpr_write_b32 a158, v238
v_mfma_f32_16x16x32_bf16 v[40:43], a[104:107], a[40:43], v[40:43]
ds_read_b64_tr_b16 a[102:103], v7 offset:58368
v_accvgpr_write_b32 a159, v239
v_mfma_f32_16x16x32_bf16 v[56:59], a[104:107], a[48:51], v[56:59]
s_add_u32 m0, s76, 34816
v_cvt_pk_bf16_f32 v231, v230, v231
v_cvt_pk_bf16_f32 v230, v228, v229
v_mfma_f32_16x16x32_bf16 v[56:59], a[108:111], a[52:55], v[56:59]
s_add_u32 s64, s72, 131200
v_cvt_pk_bf16_f32 v228, v224, v225
v_cvt_pk_bf16_f32 v229, v226, v227
v_mfma_f32_16x16x32_bf16 v[72:75], a[108:111], a[60:63], v[72:75]
s_waitcnt vmcnt(11)
buffer_load_dwordx4 v12, s[48:51], s64 offen lds
v_mfma_f32_16x16x32_bf16 v[72:75], a[104:107], a[56:59], v[72:75]
ds_read_b64_tr_b16 a[104:105], v8 offset:49152
v_accvgpr_write_b32 a160, v228
v_mfma_f32_16x16x32_bf16 v[136:139], a[112:115], a[56:59], v[136:139]
ds_read_b64_tr_b16 a[106:107], v8 offset:50176
v_accvgpr_write_b32 a161, v229
v_mfma_f32_16x16x32_bf16 v[136:139], a[116:119], a[60:63], v[136:139]
ds_read_b64_tr_b16 a[108:109], v8 offset:57344
v_add_u32 v4, 0x8000, v4
v_mfma_f32_16x16x32_bf16 v[120:123], a[116:119], a[52:55], v[120:123]
ds_read_b64_tr_b16 a[110:111], v8 offset:58368
v_accvgpr_write_b32 a162, v230
v_mfma_f32_16x16x32_bf16 v[120:123], a[112:115], a[48:51], v[120:123]
s_add_u32 m0, s76, 35840
ds_read_b128 a[0:3], v2 offset:0
v_accvgpr_write_b32 a163, v231
v_mfma_f32_16x16x32_bf16 v[104:107], a[112:115], a[40:43], v[104:107]
s_add_u32 s64, s72, 147584
ds_read_b128 a[4:7], v3 offset:0
v_cvt_pk_bf16_f32 v223, v222, v223
v_mfma_f32_16x16x32_bf16 v[104:107], a[116:119], a[44:47], v[104:107]
buffer_load_dwordx4 v13, s[48:51], s64 offen lds
v_mfma_f32_16x16x32_bf16 v[88:91], a[116:119], a[36:39], v[88:91]
ds_read_b128 a[8:11], v2 offset:2048
v_cvt_pk_bf16_f32 v222, v220, v221
v_mfma_f32_16x16x32_bf16 v[88:91], a[112:115], a[32:35], v[88:91]
s_waitcnt lgkmcnt(7)
ds_read_b128 a[12:15], v3 offset:2048
v_cvt_pk_bf16_f32 v220, v216, v217
v_mfma_f32_16x16x32_bf16 v[28:31], a[32:35], a[72:75], v[28:31]
ds_read_b128 a[16:19], v2 offset:4096
v_cvt_pk_bf16_f32 v221, v218, v219
v_mfma_f32_16x16x32_bf16 v[28:31], a[36:39], a[76:79], v[28:31]
ds_read_b128 a[20:23], v3 offset:4096
v_add_u32 v5, 0x8000, v5
v_mfma_f32_16x16x32_bf16 v[44:47], a[44:47], a[76:79], v[44:47]
s_add_u32 m0, s76, 36864
ds_read_b128 a[24:27], v2 offset:6144
v_accvgpr_write_b32 a164, v220
v_mfma_f32_16x16x32_bf16 v[44:47], a[40:43], a[72:75], v[44:47]
s_add_u32 s64, s73, 128
ds_read_b128 a[28:31], v3 offset:6144
v_accvgpr_write_b32 a165, v221
v_mfma_f32_16x16x32_bf16 v[60:63], a[48:51], a[72:75], v[60:63]
buffer_load_dwordx4 v12, s[48:51], s64 offen lds
v_mfma_f32_16x16x32_bf16 v[60:63], a[52:55], a[76:79], v[60:63]
ds_read_b64_tr_b16 a[112:113], v9 offset:49152
v_accvgpr_write_b32 a166, v222
v_mfma_f32_16x16x32_bf16 v[76:79], a[60:63], a[76:79], v[76:79]
ds_read_b64_tr_b16 a[114:115], v9 offset:50176
v_accvgpr_write_b32 a167, v223
v_mfma_f32_16x16x32_bf16 v[76:79], a[56:59], a[72:75], v[76:79]
s_add_u32 s67, s79, 22528
ds_read_b64_tr_b16 a[116:117], v9 offset:57344
v_cvt_pk_bf16_f32 v183, v182, v183
v_mfma_f32_16x16x32_bf16 v[140:143], a[56:59], a[80:83], v[140:143]
ds_read_b64_tr_b16 a[118:119], v9 offset:58368
v_cvt_pk_bf16_f32 v182, v180, v181
v_mfma_f32_16x16x32_bf16 v[140:143], a[60:63], a[84:87], v[140:143]
s_add_u32 m0, s76, 37888
ds_read_b64_tr_b16 a[72:73], v10 offset:49152
v_add_u32 v6, 0x8000, v6
v_mfma_f32_16x16x32_bf16 v[124:127], a[52:55], a[84:87], v[124:127]
s_add_u32 s64, s73, 16512
ds_read_b64_tr_b16 a[74:75], v10 offset:50176
v_cvt_pk_bf16_f32 v180, v176, v177
v_mfma_f32_16x16x32_bf16 v[124:127], a[48:51], a[80:83], v[124:127]
buffer_load_dwordx4 v13, s[48:51], s64 offen lds
v_mfma_f32_16x16x32_bf16 v[108:111], a[40:43], a[80:83], v[108:111]
ds_read_b64_tr_b16 a[76:77], v10 offset:57344
v_cvt_pk_bf16_f32 v181, v178, v179
v_mfma_f32_16x16x32_bf16 v[108:111], a[44:47], a[84:87], v[108:111]
ds_read_b64_tr_b16 a[78:79], v10 offset:58368
v_mfma_f32_16x16x32_bf16 v[92:95], a[36:39], a[84:87], v[92:95]
buffer_store_dwordx4 v[180:183], v16, s[44:47], s67 offen sc1
v_mfma_f32_16x16x32_bf16 v[92:95], a[32:35], a[80:83], v[92:95]
ds_read_b64_tr_b16 a[80:81], v11 offset:49152
v_cvt_pk_bf16_f32 v175, v174, v175
v_mfma_f32_16x16x32_bf16 v[32:35], a[32:35], a[88:91], v[32:35]
s_add_u32 m0, s76, 38912
ds_read_b64_tr_b16 a[82:83], v11 offset:50176
v_cvt_pk_bf16_f32 v174, v172, v173
v_mfma_f32_16x16x32_bf16 v[32:35], a[36:39], a[92:95], v[32:35]
s_add_u32 s64, s73, 131200
ds_read_b64_tr_b16 a[84:85], v11 offset:57344
v_add_u32 v7, 0x8000, v7
v_mfma_f32_16x16x32_bf16 v[48:51], a[44:47], a[92:95], v[48:51]
buffer_load_dwordx4 v12, s[48:51], s64 offen lds
v_mfma_f32_16x16x32_bf16 v[48:51], a[40:43], a[88:91], v[48:51]
ds_read_b64_tr_b16 a[86:87], v11 offset:58368
v_cvt_pk_bf16_f32 v172, v168, v169
v_mfma_f32_16x16x32_bf16 v[64:67], a[48:51], a[88:91], v[64:67]
v_cvt_pk_bf16_f32 v173, v170, v171
v_accvgpr_write_b32 a168, v172
v_mfma_f32_16x16x32_bf16 v[64:67], a[52:55], a[92:95], v[64:67]
v_accvgpr_write_b32 a169, v173
v_accvgpr_write_b32 a170, v174
v_mfma_f32_16x16x32_bf16 v[80:83], a[60:63], a[92:95], v[80:83]
v_accvgpr_write_b32 a171, v175
v_cvt_pk_bf16_f32 v167, v166, v167
v_mfma_f32_16x16x32_bf16 v[80:83], a[56:59], a[88:91], v[80:83]
s_add_u32 m0, s76, 39936
v_cvt_pk_bf16_f32 v166, v164, v165
v_cvt_pk_bf16_f32 v164, v160, v161
v_mfma_f32_16x16x32_bf16 v[144:147], a[56:59], a[96:99], v[144:147]
s_add_u32 s64, s73, 147584
v_cvt_pk_bf16_f32 v165, v162, v163
v_accvgpr_write_b32 a172, v164
v_mfma_f32_16x16x32_bf16 v[144:147], a[60:63], a[100:103], v[144:147]
buffer_load_dwordx4 v13, s[48:51], s64 offen lds
v_mfma_f32_16x16x32_bf16 v[128:131], a[52:55], a[100:103], v[128:131]
v_add_u32 v8, 0x8000, v8
v_accvgpr_write_b32 a173, v165
v_mfma_f32_16x16x32_bf16 v[128:131], a[48:51], a[96:99], v[128:131]
v_accvgpr_write_b32 a174, v166
v_accvgpr_write_b32 a175, v167
v_mfma_f32_16x16x32_bf16 v[112:115], a[40:43], a[96:99], v[112:115]
v_cvt_pk_bf16_f32 v159, v158, v159
v_cvt_pk_bf16_f32 v158, v156, v157
v_mfma_f32_16x16x32_bf16 v[112:115], a[44:47], a[100:103], v[112:115]
v_cvt_pk_bf16_f32 v156, v152, v153
v_cvt_pk_bf16_f32 v157, v154, v155
v_mfma_f32_16x16x32_bf16 v[96:99], a[36:39], a[100:103], v[96:99]
v_add_u32 v9, 0x8000, v9
v_add_u32 v10, 0x8000, v10
v_mfma_f32_16x16x32_bf16 v[96:99], a[32:35], a[96:99], v[96:99]
s_waitcnt lgkmcnt(0)
v_add_u32 v11, 0x8000, v11
v_accvgpr_write_b32 a176, v156
v_mfma_f32_16x16x32_bf16 v[36:39], a[32:35], a[104:107], v[36:39]
v_accvgpr_write_b32 a177, v157
v_accvgpr_write_b32 a178, v158
v_mfma_f32_16x16x32_bf16 v[36:39], a[36:39], a[108:111], v[36:39]
v_accvgpr_write_b32 a179, v159
v_mfma_f32_16x16x32_bf16 v[52:55], a[44:47], a[108:111], v[52:55]
s_add_u32 s67, s79, 23552
s_waitcnt lgkmcnt(0)
s_barrier
v_mfma_f32_16x16x32_bf16 v[52:55], a[40:43], a[104:107], v[52:55]
s_add_u32 m0, s77, 98304
ds_read_b64_tr_b16 a[88:89], v19 offset:36864
v_cvt_pk_bf16_f32 v139, v138, v139
v_mfma_f32_16x16x32_bf16 v[68:71], a[48:51], a[104:107], v[68:71]
s_add_u32 s64, s71, 1048576
ds_read_b64_tr_b16 a[90:91], v19 offset:37120
v_cvt_pk_bf16_f32 v138, v136, v137
v_mfma_f32_16x16x32_bf16 v[68:71], a[52:55], a[108:111], v[68:71]
buffer_load_dwordx4 v14, s[56:59], s64 offen lds
v_mfma_f32_16x16x32_bf16 v[84:87], a[60:63], a[108:111], v[84:87]
ds_read_b64_tr_b16 a[92:93], v19 offset:38912
v_cvt_pk_bf16_f32 v136, v72, v73
v_mfma_f32_16x16x32_bf16 v[84:87], a[56:59], a[104:107], v[84:87]
ds_read_b64_tr_b16 a[94:95], v19 offset:39168
v_cvt_pk_bf16_f32 v137, v74, v75
v_mfma_f32_16x16x32_bf16 v[148:151], a[56:59], a[112:115], v[148:151]
ds_read_b64_tr_b16 a[96:97], v20 offset:36864
v_mfma_f32_16x16x32_bf16 v[148:151], a[60:63], a[116:119], v[148:151]
ds_read_b64_tr_b16 a[98:99], v20 offset:37120
v_mfma_f32_16x16x32_bf16 v[132:135], a[52:55], a[116:119], v[132:135]
ds_read_b64_tr_b16 a[100:101], v20 offset:38912
v_mfma_f32_16x16x32_bf16 v[132:135], a[48:51], a[112:115], v[132:135]
ds_read_b64_tr_b16 a[102:103], v20 offset:39168
v_mfma_f32_16x16x32_bf16 v[116:119], a[40:43], a[112:115], v[116:119]
s_add_u32 m0, s78, 114688
ds_read_b64_tr_b16 a[104:105], v19 offset:40960
v_mfma_f32_16x16x32_bf16 v[116:119], a[44:47], a[116:119], v[116:119]
s_add_u32 s64, s75, 786432
ds_read_b64_tr_b16 a[106:107], v19 offset:41216
v_mfma_f32_16x16x32_bf16 v[100:103], a[36:39], a[116:119], v[100:103]
buffer_load_dwordx4 v23, s[60:63], s64 offen lds
v_mfma_f32_16x16x32_bf16 v[100:103], a[32:35], a[112:115], v[100:103]
ds_read_b64_tr_b16 a[108:109], v19 offset:43008
v_mfma_f32_16x16x32_bf16 v[248:251], a[32:35], a[72:75], v[248:251]
ds_read_b64_tr_b16 a[110:111], v19 offset:43264
v_mfma_f32_16x16x32_bf16 v[248:251], a[36:39], a[76:79], v[248:251]
ds_read_b64_tr_b16 a[112:113], v20 offset:40960
v_mfma_f32_16x16x32_bf16 v[252:255], a[44:47], a[76:79], v[252:255]
ds_read_b64_tr_b16 a[114:115], v20 offset:41216
v_mfma_f32_16x16x32_bf16 v[252:255], a[40:43], a[72:75], v[252:255]
ds_read_b64_tr_b16 a[116:117], v20 offset:43008
v_mfma_f32_16x16x32_bf16 a[120:123], a[48:51], a[72:75], a[120:123]
ds_read_b64_tr_b16 a[118:119], v20 offset:43264
v_mfma_f32_16x16x32_bf16 a[120:123], a[52:55], a[76:79], a[120:123]
s_add_u32 m0, s77, 99328
buffer_store_dwordx4 v[136:139], v16, s[44:47], s67 offen sc1
v_mfma_f32_16x16x32_bf16 a[124:127], a[60:63], a[76:79], a[124:127]
s_add_u32 s64, s71, 1081344
v_cvt_pk_bf16_f32 v123, v122, v123
v_cvt_pk_bf16_f32 v122, v120, v121
v_mfma_f32_16x16x32_bf16 a[124:127], a[56:59], a[72:75], a[124:127]
buffer_load_dwordx4 v14, s[56:59], s64 offen lds
v_mfma_f32_16x16x32_bf16 a[128:131], a[56:59], a[80:83], a[128:131]
ds_read_b64_tr_b16 a[72:73], v19 offset:32768
v_cvt_pk_bf16_f32 v120, v56, v57
v_mfma_f32_16x16x32_bf16 a[128:131], a[60:63], a[84:87], a[128:131]
ds_read_b64_tr_b16 a[74:75], v19 offset:33024
v_cvt_pk_bf16_f32 v121, v58, v59
v_mfma_f32_16x16x32_bf16 a[132:135], a[52:55], a[84:87], a[132:135]
ds_read_b64_tr_b16 a[76:77], v19 offset:34816
v_accvgpr_write_b32 a180, v120
v_mfma_f32_16x16x32_bf16 a[132:135], a[48:51], a[80:83], a[132:135]
ds_read_b64_tr_b16 a[78:79], v19 offset:35072
v_accvgpr_write_b32 a181, v121
v_mfma_f32_16x16x32_bf16 a[136:139], a[40:43], a[80:83], a[136:139]
v_accvgpr_write_b32 a182, v122
v_accvgpr_write_b32 a183, v123
v_mfma_f32_16x16x32_bf16 a[136:139], a[44:47], a[84:87], a[136:139]
v_cvt_pk_bf16_f32 v107, v106, v107
v_cvt_pk_bf16_f32 v106, v104, v105
v_mfma_f32_16x16x32_bf16 a[140:143], a[36:39], a[84:87], a[140:143]
s_add_u32 m0, s78, 118784
v_cvt_pk_bf16_f32 v104, v40, v41
v_cvt_pk_bf16_f32 v105, v42, v43
v_mfma_f32_16x16x32_bf16 a[140:143], a[32:35], a[80:83], a[140:143]
s_waitcnt lgkmcnt(4)
s_add_u32 s64, s75, 788480
ds_read_b64_tr_b16 a[80:81], v20 offset:32768
v_accvgpr_write_b32 a184, v104
v_mfma_f32_16x16x32_bf16 v[184:187], a[88:91], a[0:3], 0
buffer_load_dwordx4 v23, s[60:63], s64 offen lds
v_mfma_f32_16x16x32_bf16 v[184:187], a[92:95], a[4:7], v[184:187]
ds_read_b64_tr_b16 a[82:83], v20 offset:33024
v_accvgpr_write_b32 a185, v105
v_mfma_f32_16x16x32_bf16 v[192:195], a[92:95], a[12:15], 0
ds_read_b64_tr_b16 a[84:85], v20 offset:34816
v_accvgpr_write_b32 a186, v106
v_mfma_f32_16x16x32_bf16 v[192:195], a[88:91], a[8:11], v[192:195]
s_add_u32 s17, s78, .-L_pc+6144
ds_read_b64_tr_b16 a[86:87], v20 offset:35072
v_accvgpr_write_b32 a187, v107
v_mfma_f32_16x16x32_bf16 v[200:203], a[88:91], a[16:19], 0
buffer_load_dword a252, v16, s[88:91], s17 offen
v_mfma_f32_16x16x32_bf16 v[200:203], a[92:95], a[20:23], v[200:203]
v_cvt_pk_bf16_f32 v91, v90, v91
v_cvt_pk_bf16_f32 v90, v88, v89
v_mfma_f32_16x16x32_bf16 v[208:211], a[92:95], a[28:31], 0
v_cvt_pk_bf16_f32 v88, v24, v25
v_cvt_pk_bf16_f32 v89, v26, v27
v_mfma_f32_16x16x32_bf16 v[208:211], a[88:91], a[24:27], v[208:211]
ds_read_b64_tr_b16 a[88:89], v4 offset:32768
v_accvgpr_write_b32 a188, v88
v_mfma_f32_16x16x32_bf16 v[212:215], a[96:99], a[24:27], 0
s_add_u32 m0, s77, 100352
ds_read_b64_tr_b16 a[90:91], v4 offset:33792
v_accvgpr_write_b32 a189, v89
v_mfma_f32_16x16x32_bf16 v[212:215], a[100:103], a[28:31], v[212:215]
s_add_u32 s64, s71, 1114112
ds_read_b64_tr_b16 a[92:93], v4 offset:40960
v_accvgpr_write_b32 a190, v90
v_mfma_f32_16x16x32_bf16 v[204:207], a[100:103], a[20:23], 0
buffer_load_dwordx4 v15, s[56:59], s64 offen lds
v_mfma_f32_16x16x32_bf16 v[204:207], a[96:99], a[16:19], v[204:207]
ds_read_b64_tr_b16 a[94:95], v4 offset:41984
v_accvgpr_write_b32 a191, v91
v_mfma_f32_16x16x32_bf16 v[196:199], a[96:99], a[8:11], 0
s_add_u32 s67, s79, 8192
v_cvt_pk_bf16_f32 v47, v46, v47
v_cvt_pk_bf16_f32 v46, v44, v45
v_mfma_f32_16x16x32_bf16 v[196:199], a[100:103], a[12:15], v[196:199]
v_cvt_pk_bf16_f32 v44, v28, v29
v_cvt_pk_bf16_f32 v45, v30, v31
v_mfma_f32_16x16x32_bf16 v[188:191], a[100:103], a[4:7], 0
buffer_store_dwordx4 v[44:47], v16, s[44:47], s67 offen sc1
v_mfma_f32_16x16x32_bf16 v[188:191], a[96:99], a[0:3], v[188:191]
ds_read_b64_tr_b16 a[96:97], v5 offset:32768
v_cvt_pk_bf16_f32 v79, v78, v79
v_mfma_f32_16x16x32_bf16 v[216:219], a[0:3], a[104:107], 0
ds_read_b64_tr_b16 a[98:99], v5 offset:33792
v_cvt_pk_bf16_f32 v78, v76, v77
v_mfma_f32_16x16x32_bf16 v[216:219], a[4:7], a[108:111], v[216:219]
s_add_u32 m0, s78, 122880
ds_read_b64_tr_b16 a[100:101], v5 offset:40960
v_cvt_pk_bf16_f32 v76, v60, v61
v_mfma_f32_16x16x32_bf16 v[224:227], a[12:15], a[108:111], 0
s_add_u32 s64, s75, 790528
ds_read_b64_tr_b16 a[102:103], v5 offset:41984
v_cvt_pk_bf16_f32 v77, v62, v63
v_mfma_f32_16x16x32_bf16 v[224:227], a[8:11], a[104:107], v[224:227]
buffer_load_dwordx4 v23, s[60:63], s64 offen lds
v_mfma_f32_16x16x32_bf16 v[232:235], a[16:19], a[104:107], 0
v_accvgpr_write_b32 a192, v76
v_accvgpr_write_b32 a193, v77
v_mfma_f32_16x16x32_bf16 v[232:235], a[20:23], a[108:111], v[232:235]
v_accvgpr_write_b32 a194, v78
v_accvgpr_write_b32 a195, v79
v_mfma_f32_16x16x32_bf16 v[240:243], a[28:31], a[108:111], 0
v_cvt_pk_bf16_f32 v124, v124, v125
v_cvt_pk_bf16_f32 v125, v126, v127
v_mfma_f32_16x16x32_bf16 v[240:243], a[24:27], a[104:107], v[240:243]
ds_read_b64_tr_b16 a[104:105], v6 offset:32768
v_cvt_pk_bf16_f32 v126, v140, v141
v_mfma_f32_16x16x32_bf16 v[244:247], a[24:27], a[112:115], 0
ds_read_b64_tr_b16 a[106:107], v6 offset:33792
v_cvt_pk_bf16_f32 v127, v142, v143
v_mfma_f32_16x16x32_bf16 v[244:247], a[28:31], a[116:119], v[244:247]
ds_read_b64_tr_b16 a[108:109], v6 offset:40960
v_accvgpr_write_b32 a196, v124
v_mfma_f32_16x16x32_bf16 v[236:239], a[20:23], a[116:119], 0
s_add_u32 m0, s77, 101376
ds_read_b64_tr_b16 a[110:111], v6 offset:41984
v_accvgpr_write_b32 a197, v125
v_mfma_f32_16x16x32_bf16 v[236:239], a[16:19], a[112:115], v[236:239]
s_add_u32 s64, s71, 1146880
v_accvgpr_write_b32 a198, v126
v_accvgpr_write_b32 a199, v127
v_mfma_f32_16x16x32_bf16 v[228:231], a[8:11], a[112:115], 0
buffer_load_dwordx4 v15, s[56:59], s64 offen lds
v_mfma_f32_16x16x32_bf16 v[228:231], a[12:15], a[116:119], v[228:231]
v_cvt_pk_bf16_f32 v92, v92, v93
v_cvt_pk_bf16_f32 v93, v94, v95
v_mfma_f32_16x16x32_bf16 v[220:223], a[4:7], a[116:119], 0
v_cvt_pk_bf16_f32 v94, v108, v109
v_cvt_pk_bf16_f32 v95, v110, v111
v_mfma_f32_16x16x32_bf16 v[220:223], a[0:3], a[112:115], v[220:223]
s_waitcnt lgkmcnt(4)
ds_read_b64_tr_b16 a[112:113], v7 offset:32768
v_accvgpr_write_b32 a200, v92
v_mfma_f32_16x16x32_bf16 v[152:155], a[72:75], a[0:3], 0
ds_read_b64_tr_b16 a[114:115], v7 offset:33792
v_accvgpr_write_b32 a201, v93
v_mfma_f32_16x16x32_bf16 v[152:155], a[76:79], a[4:7], v[152:155]
ds_read_b64_tr_b16 a[116:117], v7 offset:40960
v_accvgpr_write_b32 a202, v94
v_mfma_f32_16x16x32_bf16 v[160:163], a[76:79], a[12:15], 0
ds_read_b64_tr_b16 a[118:119], v7 offset:41984
v_accvgpr_write_b32 a203, v95
v_mfma_f32_16x16x32_bf16 v[160:163], a[72:75], a[8:11], v[160:163]
s_add_u32 s67, s79, 10240
v_cvt_pk_bf16_f32 v51, v50, v51
v_cvt_pk_bf16_f32 v50, v48, v49
v_mfma_f32_16x16x32_bf16 v[168:171], a[72:75], a[16:19], 0
v_cvt_pk_bf16_f32 v48, v32, v33
v_cvt_pk_bf16_f32 v49, v34, v35
v_mfma_f32_16x16x32_bf16 v[168:171], a[76:79], a[20:23], v[168:171]
buffer_store_dwordx4 v[48:51], v16, s[44:47], s67 offen sc1
v_mfma_f32_16x16x32_bf16 v[176:179], a[76:79], a[28:31], 0
s_add_u32 m0, s76, 0
v_subrev_u32 v19, 0x8000, v19
v_subrev_u32 v20, 0x8000, v20
v_mfma_f32_16x16x32_bf16 v[176:179], a[72:75], a[24:27], v[176:179]
s_add_u32 s64, s72, 256
ds_read_b64_tr_b16 a[72:73], v8 offset:32768
v_cvt_pk_bf16_f32 v83, v82, v83
v_mfma_f32_16x16x32_bf16 v[180:183], a[80:83], a[24:27], 0
buffer_load_dwordx4 v12, s[48:51], s64 offen lds
v_mfma_f32_16x16x32_bf16 v[180:183], a[84:87], a[28:31], v[180:183]
ds_read_b64_tr_b16 a[74:75], v8 offset:33792
v_subrev_u32 v4, 0x8000, v4
v_mfma_f32_16x16x32_bf16 v[172:175], a[84:87], a[20:23], 0
ds_read_b64_tr_b16 a[76:77], v8 offset:40960
v_cvt_pk_bf16_f32 v82, v80, v81
v_mfma_f32_16x16x32_bf16 v[172:175], a[80:83], a[16:19], v[172:175]
s_add_u32 m0, s76, 1024
ds_read_b64_tr_b16 a[78:79], v8 offset:41984
v_cvt_pk_bf16_f32 v80, v64, v65
v_mfma_f32_16x16x32_bf16 v[164:167], a[80:83], a[8:11], 0
s_add_u32 s64, s72, 16640
v_cvt_pk_bf16_f32 v81, v66, v67
v_accvgpr_write_b32 a204, v80
v_mfma_f32_16x16x32_bf16 v[164:167], a[84:87], a[12:15], v[164:167]
buffer_load_dwordx4 v13, s[48:51], s64 offen lds
v_mfma_f32_16x16x32_bf16 v[156:159], a[84:87], a[4:7], 0
v_accvgpr_write_b32 a205, v81
v_accvgpr_write_b32 a206, v82
v_mfma_f32_16x16x32_bf16 v[156:159], a[80:83], a[0:3], v[156:159]
ds_read_b64_tr_b16 a[80:81], v9 offset:32768
v_accvgpr_write_b32 a207, v83
v_mfma_f32_16x16x32_bf16 v[24:27], a[88:91], a[0:3], 0
s_add_u32 m0, s76, 2048
ds_read_b64_tr_b16 a[82:83], v9 offset:33792
v_cvt_pk_bf16_f32 v128, v128, v129
v_mfma_f32_16x16x32_bf16 v[24:27], a[92:95], a[4:7], v[24:27]
s_add_u32 s64, s72, 131328
ds_read_b64_tr_b16 a[84:85], v9 offset:40960
v_subrev_u32 v5, 0x8000, v5
v_mfma_f32_16x16x32_bf16 v[40:43], a[92:95], a[12:15], 0
buffer_load_dwordx4 v12, s[48:51], s64 offen lds
v_mfma_f32_16x16x32_bf16 v[40:43], a[88:91], a[8:11], v[40:43]
ds_read_b64_tr_b16 a[86:87], v9 offset:41984
v_cvt_pk_bf16_f32 v129, v130, v131
v_mfma_f32_16x16x32_bf16 v[56:59], a[88:91], a[16:19], 0
s_add_u32 m0, s76, 3072
v_cvt_pk_bf16_f32 v130, v144, v145
v_cvt_pk_bf16_f32 v131, v146, v147
v_mfma_f32_16x16x32_bf16 v[56:59], a[92:95], a[20:23], v[56:59]
s_add_u32 s64, s72, 147712
v_accvgpr_write_b32 a208, v128
v_accvgpr_write_b32 a209, v129
v_mfma_f32_16x16x32_bf16 v[72:75], a[92:95], a[28:31], 0
s_waitcnt vmcnt(14)
ds_read_b128 a[32:35], v2 offset:32768
v_accvgpr_write_b32 a210, v130
v_mfma_f32_16x16x32_bf16 v[72:75], a[88:91], a[24:27], v[72:75]
buffer_load_dwordx4 v13, s[48:51], s64 offen lds
v_mfma_f32_16x16x32_bf16 v[136:139], a[96:99], a[24:27], 0
ds_read_b128 a[36:39], v3 offset:32768
v_accvgpr_write_b32 a211, v131
v_mfma_f32_16x16x32_bf16 v[136:139], a[100:103], a[28:31], v[136:139]
ds_read_b128 a[40:43], v2 offset:34816
v_subrev_u32 v6, 0x8000, v6
v_mfma_f32_16x16x32_bf16 v[120:123], a[100:103], a[20:23], 0
s_add_u32 m0, s76, 4096
ds_read_b128 a[44:47], v3 offset:34816
v_cvt_pk_bf16_f32 v96, v96, v97
v_mfma_f32_16x16x32_bf16 v[120:123], a[96:99], a[16:19], v[120:123]
s_add_u32 s64, s73, 256
ds_read_b128 a[48:51], v2 offset:36864
v_cvt_pk_bf16_f32 v97, v98, v99
v_mfma_f32_16x16x32_bf16 v[104:107], a[96:99], a[8:11], 0
buffer_load_dwordx4 v12, s[48:51], s64 offen lds
v_mfma_f32_16x16x32_bf16 v[104:107], a[100:103], a[12:15], v[104:107]
ds_read_b128 a[52:55], v3 offset:36864
v_cvt_pk_bf16_f32 v98, v112, v113
v_mfma_f32_16x16x32_bf16 v[88:91], a[100:103], a[4:7], 0
ds_read_b128 a[56:59], v2 offset:38912
v_cvt_pk_bf16_f32 v99, v114, v115
v_mfma_f32_16x16x32_bf16 v[88:91], a[96:99], a[0:3], v[88:91]
s_waitcnt lgkmcnt(7)
s_add_u32 m0, s76, 5120
ds_read_b128 a[60:63], v3 offset:38912
v_accvgpr_write_b32 a212, v96
v_mfma_f32_16x16x32_bf16 v[28:31], a[104:107], a[0:3], 0
s_add_u32 s64, s73, 16640
ds_read_b64_tr_b16 a[88:89], v10 offset:32768
v_accvgpr_write_b32 a213, v97
v_mfma_f32_16x16x32_bf16 v[28:31], a[108:111], a[4:7], v[28:31]
buffer_load_dwordx4 v13, s[48:51], s64 offen lds
v_mfma_f32_16x16x32_bf16 v[44:47], a[108:111], a[12:15], 0
ds_read_b64_tr_b16 a[90:91], v10 offset:33792
v_subrev_u32 v7, 0x8000, v7
v_mfma_f32_16x16x32_bf16 v[44:47], a[104:107], a[8:11], v[44:47]
s_add_u32 m0, s76, 6144
ds_read_b64_tr_b16 a[92:93], v10 offset:40960
v_accvgpr_write_b32 a214, v98
v_mfma_f32_16x16x32_bf16 v[60:63], a[104:107], a[16:19], 0
s_add_u32 s64, s73, 131328
ds_read_b64_tr_b16 a[94:95], v10 offset:41984
v_accvgpr_write_b32 a215, v99
v_mfma_f32_16x16x32_bf16 v[60:63], a[108:111], a[20:23], v[60:63]
s_add_u32 s67, s79, 12288
ds_read_b64_tr_b16 a[96:97], v11 offset:32768
v_cvt_pk_bf16_f32 v55, v54, v55
v_mfma_f32_16x16x32_bf16 v[76:79], a[108:111], a[28:31], 0
buffer_load_dwordx4 v12, s[48:51], s64 offen lds
v_mfma_f32_16x16x32_bf16 v[76:79], a[104:107], a[24:27], v[76:79]
ds_read_b64_tr_b16 a[98:99], v11 offset:33792
v_cvt_pk_bf16_f32 v54, v52, v53
v_mfma_f32_16x16x32_bf16 v[140:143], a[112:115], a[24:27], 0
ds_read_b64_tr_b16 a[100:101], v11 offset:40960
v_cvt_pk_bf16_f32 v52, v36, v37
v_mfma_f32_16x16x32_bf16 v[140:143], a[116:119], a[28:31], v[140:143]
s_add_u32 m0, s76, 7168
ds_read_b64_tr_b16 a[102:103], v11 offset:41984
v_subrev_u32 v8, 0x8000, v8
v_mfma_f32_16x16x32_bf16 v[124:127], a[116:119], a[20:23], 0
s_add_u32 s64, s73, 147712
v_cvt_pk_bf16_f32 v53, v38, v39
v_mfma_f32_16x16x32_bf16 v[124:127], a[112:115], a[16:19], v[124:127]
buffer_load_dwordx4 v13, s[48:51], s64 offen lds
v_mfma_f32_16x16x32_bf16 v[108:111], a[112:115], a[8:11], 0
buffer_store_dwordx4 v[52:55], v16, s[44:47], s67 offen sc1
v_mfma_f32_16x16x32_bf16 v[108:111], a[116:119], a[12:15], v[108:111]
v_cvt_pk_bf16_f32 v87, v86, v87
v_cvt_pk_bf16_f32 v86, v84, v85
v_mfma_f32_16x16x32_bf16 v[92:95], a[116:119], a[4:7], 0
v_subrev_u32 v9, 0x8000, v9
v_subrev_u32 v10, 0x8000, v10
v_mfma_f32_16x16x32_bf16 v[92:95], a[112:115], a[0:3], v[92:95]
v_subrev_u32 v11, 0x8000, v11
v_cvt_pk_bf16_f32 v84, v68, v69
v_mfma_f32_16x16x32_bf16 v[32:35], a[72:75], a[0:3], 0
v_cvt_pk_bf16_f32 v85, v70, v71
v_accvgpr_write_b32 a216, v84
v_mfma_f32_16x16x32_bf16 v[32:35], a[76:79], a[4:7], v[32:35]
v_accvgpr_write_b32 a217, v85
v_accvgpr_write_b32 a218, v86
v_mfma_f32_16x16x32_bf16 v[48:51], a[76:79], a[12:15], 0
s_waitcnt lgkmcnt(0)
s_barrier
v_mfma_f32_16x16x32_bf16 v[48:51], a[72:75], a[8:11], v[48:51]
s_add_u32 m0, s77, 131072
ds_read_b64_tr_b16 a[104:105], v19 offset:4096
v_accvgpr_write_b32 a219, v87
v_mfma_f32_16x16x32_bf16 v[64:67], a[72:75], a[16:19], 0
s_add_u32 s64, s71, 1572864
ds_read_b64_tr_b16 a[106:107], v19 offset:4352
v_cvt_pk_bf16_f32 v132, v132, v133
v_mfma_f32_16x16x32_bf16 v[64:67], a[76:79], a[20:23], v[64:67]
buffer_load_dwordx4 v14, s[56:59], s64 offen lds
v_mfma_f32_16x16x32_bf16 v[80:83], a[76:79], a[28:31], 0
ds_read_b64_tr_b16 a[108:109], v19 offset:6144
v_cvt_pk_bf16_f32 v133, v134, v135
v_mfma_f32_16x16x32_bf16 v[80:83], a[72:75], a[24:27], v[80:83]
ds_read_b64_tr_b16 a[110:111], v19 offset:6400
v_cvt_pk_bf16_f32 v134, v148, v149
v_mfma_f32_16x16x32_bf16 v[144:147], a[80:83], a[24:27], 0
ds_read_b64_tr_b16 a[112:113], v20 offset:4096
v_cvt_pk_bf16_f32 v135, v150, v151
v_mfma_f32_16x16x32_bf16 v[144:147], a[84:87], a[28:31], v[144:147]
ds_read_b64_tr_b16 a[114:115], v20 offset:4352
v_accvgpr_write_b32 a220, v132
v_mfma_f32_16x16x32_bf16 v[128:131], a[84:87], a[20:23], 0
ds_read_b64_tr_b16 a[116:117], v20 offset:6144
v_accvgpr_write_b32 a221, v133
v_mfma_f32_16x16x32_bf16 v[128:131], a[80:83], a[16:19], v[128:131]
ds_read_b64_tr_b16 a[118:119], v20 offset:6400
v_accvgpr_write_b32 a222, v134
v_mfma_f32_16x16x32_bf16 v[112:115], a[80:83], a[8:11], 0
s_add_u32 m0, s78, 147456
ds_read_b64_tr_b16 a[72:73], v19 offset:8192
v_accvgpr_write_b32 a223, v135
v_mfma_f32_16x16x32_bf16 v[112:115], a[84:87], a[12:15], v[112:115]
s_add_u32 s64, s75, 1179648
ds_read_b64_tr_b16 a[74:75], v19 offset:8448
v_cvt_pk_bf16_f32 v100, v100, v101
v_mfma_f32_16x16x32_bf16 v[96:99], a[84:87], a[4:7], 0
buffer_load_dwordx4 v23, s[60:63], s64 offen lds
v_mfma_f32_16x16x32_bf16 v[96:99], a[80:83], a[0:3], v[96:99]
ds_read_b64_tr_b16 a[76:77], v19 offset:10240
v_cvt_pk_bf16_f32 v101, v102, v103
v_mfma_f32_16x16x32_bf16 v[36:39], a[88:91], a[0:3], 0
ds_read_b64_tr_b16 a[78:79], v19 offset:10496
v_cvt_pk_bf16_f32 v102, v116, v117
v_mfma_f32_16x16x32_bf16 v[36:39], a[92:95], a[4:7], v[36:39]
ds_read_b64_tr_b16 a[80:81], v20 offset:8192
v_cvt_pk_bf16_f32 v103, v118, v119
v_mfma_f32_16x16x32_bf16 v[52:55], a[92:95], a[12:15], 0
ds_read_b64_tr_b16 a[82:83], v20 offset:8448
v_accvgpr_write_b32 a224, v100
v_mfma_f32_16x16x32_bf16 v[52:55], a[88:91], a[8:11], v[52:55]
ds_read_b64_tr_b16 a[84:85], v20 offset:10240
v_accvgpr_write_b32 a225, v101
v_mfma_f32_16x16x32_bf16 v[68:71], a[88:91], a[16:19], 0
s_add_u32 m0, s77, 132096
ds_read_b64_tr_b16 a[86:87], v20 offset:10496
v_accvgpr_write_b32 a226, v102
v_mfma_f32_16x16x32_bf16 v[68:71], a[92:95], a[20:23], v[68:71]
s_add_u32 s64, s71, 1605632
s_xor_b32 s68, s66, 0
v_accvgpr_write_b32 a227, v103
v_mfma_f32_16x16x32_bf16 v[84:87], a[92:95], a[28:31], 0
s_add_u32 s67, s79, 14336
s_mov_b64 exec, 1
buffer_atomic_add a251, v1, s[52:55], s68 offen offset:0 sc1
s_mov_b64 exec, -1
v_mfma_f32_16x16x32_bf16 v[84:87], a[88:91], a[24:27], v[84:87]
buffer_load_dwordx4 v14, s[56:59], s64 offen lds
v_mfma_f32_16x16x32_bf16 v[148:151], a[96:99], a[24:27], 0
ds_read_b64_tr_b16 a[88:89], v19 offset:0
v_cvt_pk_bf16_f32 v255, v254, v255
v_mfma_f32_16x16x32_bf16 v[148:151], a[100:103], a[28:31], v[148:151]
ds_read_b64_tr_b16 a[90:91], v19 offset:256
v_cvt_pk_bf16_f32 v254, v252, v253
v_mfma_f32_16x16x32_bf16 v[132:135], a[100:103], a[20:23], 0
ds_read_b64_tr_b16 a[92:93], v19 offset:2048
v_cvt_pk_bf16_f32 v252, v248, v249
v_mfma_f32_16x16x32_bf16 v[132:135], a[96:99], a[16:19], v[132:135]
s_add_u32 s65, s79, 16384
ds_read_b64_tr_b16 a[94:95], v19 offset:2304
v_cvt_pk_bf16_f32 v253, v250, v251
v_mfma_f32_16x16x32_bf16 v[116:119], a[96:99], a[8:11], 0
buffer_store_dwordx4 a[144:147], v16, s[44:47], s65 offen sc1
v_mfma_f32_16x16x32_bf16 v[116:119], a[100:103], a[12:15], v[116:119]
buffer_store_dwordx4 v[252:255], v16, s[44:47], s67 offen sc1
v_mfma_f32_16x16x32_bf16 v[100:103], a[100:103], a[4:7], 0
s_add_u32 m0, s78, 151552
v_mfma_f32_16x16x32_bf16 v[100:103], a[96:99], a[0:3], v[100:103]
s_waitcnt lgkmcnt(4)
s_add_u32 s64, s75, 1181696
ds_read_b64_tr_b16 a[96:97], v20 offset:0
v_accvgpr_read_b32 v248, a120
v_mfma_f32_16x16x32_bf16 v[184:187], a[104:107], a[32:35], v[184:187]
buffer_load_dwordx4 v23, s[60:63], s64 offen lds
v_mfma_f32_16x16x32_bf16 v[184:187], a[108:111], a[36:39], v[184:187]
ds_read_b64_tr_b16 a[98:99], v20 offset:256
v_accvgpr_read_b32 v249, a121
v_mfma_f32_16x16x32_bf16 v[192:195], a[108:111], a[44:47], v[192:195]
ds_read_b64_tr_b16 a[100:101], v20 offset:2048
v_accvgpr_read_b32 v250, a122
v_mfma_f32_16x16x32_bf16 v[192:195], a[104:107], a[40:43], v[192:195]
ds_read_b64_tr_b16 a[102:103], v20 offset:2304
v_accvgpr_read_b32 v251, a123
v_mfma_f32_16x16x32_bf16 v[200:203], a[104:107], a[48:51], v[200:203]
v_accvgpr_read_b32 v252, a124
v_accvgpr_read_b32 v253, a125
v_mfma_f32_16x16x32_bf16 v[200:203], a[108:111], a[52:55], v[200:203]
v_accvgpr_read_b32 v254, a126
v_accvgpr_read_b32 v255, a127
v_mfma_f32_16x16x32_bf16 v[208:211], a[108:111], a[60:63], v[208:211]
v_cvt_pk_bf16_f32 v255, v254, v255
v_cvt_pk_bf16_f32 v254, v252, v253
v_mfma_f32_16x16x32_bf16 v[208:211], a[104:107], a[56:59], v[208:211]
ds_read_b64_tr_b16 a[104:105], v4 offset:0
v_cvt_pk_bf16_f32 v252, v248, v249
v_mfma_f32_16x16x32_bf16 v[212:215], a[112:115], a[56:59], v[212:215]
s_add_u32 m0, s77, 133120
ds_read_b64_tr_b16 a[106:107], v4 offset:1024
v_cvt_pk_bf16_f32 v253, v250, v251
v_mfma_f32_16x16x32_bf16 v[212:215], a[116:119], a[60:63], v[212:215]
s_add_u32 s64, s71, 1638400
ds_read_b64_tr_b16 a[108:109], v4 offset:8192
v_accvgpr_write_b32 a228, v252
v_mfma_f32_16x16x32_bf16 v[204:207], a[116:119], a[52:55], v[204:207]
buffer_load_dwordx4 v15, s[56:59], s64 offen lds
v_mfma_f32_16x16x32_bf16 v[204:207], a[112:115], a[48:51], v[204:207]
ds_read_b64_tr_b16 a[110:111], v4 offset:9216
v_accvgpr_write_b32 a229, v253
v_mfma_f32_16x16x32_bf16 v[196:199], a[112:115], a[40:43], v[196:199]
v_accvgpr_write_b32 a230, v254
v_accvgpr_write_b32 a231, v255
v_mfma_f32_16x16x32_bf16 v[196:199], a[116:119], a[44:47], v[196:199]
v_mfma_f32_16x16x32_bf16 v[188:191], a[116:119], a[36:39], v[188:191]
v_accvgpr_read_b32 v248, a132
v_accvgpr_read_b32 v249, a133
v_mfma_f32_16x16x32_bf16 v[188:191], a[112:115], a[32:35], v[188:191]
ds_read_b64_tr_b16 a[112:113], v5 offset:0
v_accvgpr_read_b32 v250, a134
v_mfma_f32_16x16x32_bf16 v[216:219], a[32:35], a[72:75], v[216:219]
ds_read_b64_tr_b16 a[114:115], v5 offset:1024
v_accvgpr_read_b32 v251, a135
v_mfma_f32_16x16x32_bf16 v[216:219], a[36:39], a[76:79], v[216:219]
s_add_u32 m0, s78, 155648
ds_read_b64_tr_b16 a[116:117], v5 offset:8192
v_accvgpr_read_b32 v252, a128
v_mfma_f32_16x16x32_bf16 v[224:227], a[44:47], a[76:79], v[224:227]
s_add_u32 s64, s75, 1183744
ds_read_b64_tr_b16 a[118:119], v5 offset:9216
v_accvgpr_read_b32 v253, a129
v_mfma_f32_16x16x32_bf16 v[224:227], a[40:43], a[72:75], v[224:227]
buffer_load_dwordx4 v23, s[60:63], s64 offen lds
v_mfma_f32_16x16x32_bf16 v[232:235], a[48:51], a[72:75], v[232:235]
v_accvgpr_read_b32 v254, a130
v_accvgpr_read_b32 v255, a131
v_mfma_f32_16x16x32_bf16 v[232:235], a[52:55], a[76:79], v[232:235]
v_cvt_pk_bf16_f32 v255, v254, v255
v_cvt_pk_bf16_f32 v254, v252, v253
v_mfma_f32_16x16x32_bf16 v[240:243], a[60:63], a[76:79], v[240:243]
v_cvt_pk_bf16_f32 v252, v248, v249
v_cvt_pk_bf16_f32 v253, v250, v251
v_mfma_f32_16x16x32_bf16 v[240:243], a[56:59], a[72:75], v[240:243]
ds_read_b64_tr_b16 a[72:73], v6 offset:0
v_accvgpr_write_b32 a232, v252
v_mfma_f32_16x16x32_bf16 v[244:247], a[56:59], a[80:83], v[244:247]
ds_read_b64_tr_b16 a[74:75], v6 offset:1024
v_accvgpr_write_b32 a233, v253
v_mfma_f32_16x16x32_bf16 v[244:247], a[60:63], a[84:87], v[244:247]
ds_read_b64_tr_b16 a[76:77], v6 offset:8192
v_accvgpr_write_b32 a234, v254
v_mfma_f32_16x16x32_bf16 v[236:239], a[52:55], a[84:87], v[236:239]
s_add_u32 m0, s77, 134144
ds_read_b64_tr_b16 a[78:79], v6 offset:9216
v_accvgpr_write_b32 a235, v255
v_mfma_f32_16x16x32_bf16 v[236:239], a[48:51], a[80:83], v[236:239]
s_add_u32 s64, s71, 1671168
v_mfma_f32_16x16x32_bf16 v[228:231], a[40:43], a[80:83], v[228:231]
buffer_load_dwordx4 v15, s[56:59], s64 offen lds
v_mfma_f32_16x16x32_bf16 v[228:231], a[44:47], a[84:87], v[228:231]
v_accvgpr_read_b32 v248, a140
v_accvgpr_read_b32 v249, a141
v_mfma_f32_16x16x32_bf16 v[220:223], a[36:39], a[84:87], v[220:223]
v_accvgpr_read_b32 v250, a142
v_accvgpr_read_b32 v251, a143
v_mfma_f32_16x16x32_bf16 v[220:223], a[32:35], a[80:83], v[220:223]
s_waitcnt lgkmcnt(4)
ds_read_b64_tr_b16 a[80:81], v7 offset:0
v_accvgpr_read_b32 v252, a136
v_mfma_f32_16x16x32_bf16 v[152:155], a[88:91], a[32:35], v[152:155]
ds_read_b64_tr_b16 a[82:83], v7 offset:1024
v_accvgpr_read_b32 v253, a137
v_mfma_f32_16x16x32_bf16 v[152:155], a[92:95], a[36:39], v[152:155]
ds_read_b64_tr_b16 a[84:85], v7 offset:8192
v_accvgpr_read_b32 v254, a138
v_mfma_f32_16x16x32_bf16 v[160:163], a[92:95], a[44:47], v[160:163]
ds_read_b64_tr_b16 a[86:87], v7 offset:9216
v_accvgpr_read_b32 v255, a139
v_mfma_f32_16x16x32_bf16 v[160:163], a[88:91], a[40:43], v[160:163]
v_cvt_pk_bf16_f32 v255, v254, v255
v_cvt_pk_bf16_f32 v254, v252, v253
v_mfma_f32_16x16x32_bf16 v[168:171], a[88:91], a[48:51], v[168:171]
v_cvt_pk_bf16_f32 v252, v248, v249
v_cvt_pk_bf16_f32 v253, v250, v251
v_mfma_f32_16x16x32_bf16 v[168:171], a[92:95], a[52:55], v[168:171]
v_accvgpr_write_b32 a236, v252
v_accvgpr_write_b32 a237, v253
v_mfma_f32_16x16x32_bf16 v[176:179], a[92:95], a[60:63], v[176:179]
s_add_u32 m0, s76, 32768
v_accvgpr_write_b32 a238, v254
v_accvgpr_write_b32 a239, v255
v_mfma_f32_16x16x32_bf16 v[176:179], a[88:91], a[56:59], v[176:179]
s_add_u32 s64, s72, 384
ds_read_b64_tr_b16 a[88:89], v8 offset:0
v_mfma_f32_16x16x32_bf16 v[180:183], a[96:99], a[56:59], v[180:183]
buffer_load_dwordx4 v12, s[48:51], s64 offen lds
v_mfma_f32_16x16x32_bf16 v[180:183], a[100:103], a[60:63], v[180:183]
ds_read_b64_tr_b16 a[90:91], v8 offset:1024
v_mfma_f32_16x16x32_bf16 v[172:175], a[100:103], a[52:55], v[172:175]
ds_read_b64_tr_b16 a[92:93], v8 offset:8192
v_mfma_f32_16x16x32_bf16 v[172:175], a[96:99], a[48:51], v[172:175]
s_add_u32 m0, s76, 33792
ds_read_b64_tr_b16 a[94:95], v8 offset:9216
v_mfma_f32_16x16x32_bf16 v[164:167], a[96:99], a[40:43], v[164:167]
s_add_u32 s64, s72, 16768
v_mfma_f32_16x16x32_bf16 v[164:167], a[100:103], a[44:47], v[164:167]
s_add_u32 s65, s79, 4096
buffer_load_dwordx4 v13, s[48:51], s64 offen lds
v_mfma_f32_16x16x32_bf16 v[156:159], a[100:103], a[36:39], v[156:159]
buffer_store_dwordx4 a[148:151], v16, s[44:47], s65 offen sc1
v_mfma_f32_16x16x32_bf16 v[156:159], a[96:99], a[32:35], v[156:159]
ds_read_b64_tr_b16 a[96:97], v9 offset:0
v_mfma_f32_16x16x32_bf16 v[24:27], a[104:107], a[32:35], v[24:27]
s_add_u32 m0, s76, 34816
ds_read_b64_tr_b16 a[98:99], v9 offset:1024
v_mfma_f32_16x16x32_bf16 v[24:27], a[108:111], a[36:39], v[24:27]
s_add_u32 s64, s72, 131456
ds_read_b64_tr_b16 a[100:101], v9 offset:8192
v_mfma_f32_16x16x32_bf16 v[40:43], a[108:111], a[44:47], v[40:43]
buffer_load_dwordx4 v12, s[48:51], s64 offen lds
v_mfma_f32_16x16x32_bf16 v[40:43], a[104:107], a[40:43], v[40:43]
ds_read_b64_tr_b16 a[102:103], v9 offset:9216
v_mfma_f32_16x16x32_bf16 v[56:59], a[104:107], a[48:51], v[56:59]
v_mfma_f32_16x16x32_bf16 v[56:59], a[108:111], a[52:55], v[56:59]
s_add_u32 m0, s76, 35840
v_mfma_f32_16x16x32_bf16 v[72:75], a[108:111], a[60:63], v[72:75]
s_waitcnt vmcnt(15)
s_add_u32 s64, s72, 147840
ds_read_b128 a[0:3], v2 offset:0
v_mfma_f32_16x16x32_bf16 v[72:75], a[104:107], a[56:59], v[72:75]
buffer_load_dwordx4 v13, s[48:51], s64 offen lds
v_mfma_f32_16x16x32_bf16 v[136:139], a[112:115], a[56:59], v[136:139]
ds_read_b128 a[4:7], v3 offset:0
v_mfma_f32_16x16x32_bf16 v[136:139], a[116:119], a[60:63], v[136:139]
ds_read_b128 a[8:11], v2 offset:2048
v_mfma_f32_16x16x32_bf16 v[120:123], a[116:119], a[52:55], v[120:123]
s_add_u32 m0, s76, 36864
ds_read_b128 a[12:15], v3 offset:2048
v_mfma_f32_16x16x32_bf16 v[120:123], a[112:115], a[48:51], v[120:123]
s_add_u32 s64, s73, 384
ds_read_b128 a[16:19], v2 offset:4096
v_mfma_f32_16x16x32_bf16 v[104:107], a[112:115], a[40:43], v[104:107]
buffer_load_dwordx4 v12, s[48:51], s64 offen lds
v_mfma_f32_16x16x32_bf16 v[104:107], a[116:119], a[44:47], v[104:107]
ds_read_b128 a[20:23], v3 offset:4096
v_mfma_f32_16x16x32_bf16 v[88:91], a[116:119], a[36:39], v[88:91]
ds_read_b128 a[24:27], v2 offset:6144
v_mfma_f32_16x16x32_bf16 v[88:91], a[112:115], a[32:35], v[88:91]
s_waitcnt lgkmcnt(7)
s_add_u32 m0, s76, 37888
ds_read_b128 a[28:31], v3 offset:6144
v_mfma_f32_16x16x32_bf16 v[28:31], a[72:75], a[32:35], v[28:31]
s_add_u32 s64, s73, 16768
ds_read_b64_tr_b16 a[104:105], v10 offset:0
v_mfma_f32_16x16x32_bf16 v[28:31], a[76:79], a[36:39], v[28:31]
buffer_load_dwordx4 v13, s[48:51], s64 offen lds
v_mfma_f32_16x16x32_bf16 v[44:47], a[76:79], a[44:47], v[44:47]
ds_read_b64_tr_b16 a[106:107], v10 offset:1024
v_mfma_f32_16x16x32_bf16 v[44:47], a[72:75], a[40:43], v[44:47]
ds_read_b64_tr_b16 a[108:109], v10 offset:8192
v_mfma_f32_16x16x32_bf16 v[60:63], a[72:75], a[48:51], v[60:63]
s_add_u32 m0, s76, 38912
ds_read_b64_tr_b16 a[110:111], v10 offset:9216
v_mfma_f32_16x16x32_bf16 v[60:63], a[76:79], a[52:55], v[60:63]
s_add_u32 s64, s73, 131456
ds_read_b64_tr_b16 a[112:113], v11 offset:0
v_mfma_f32_16x16x32_bf16 v[76:79], a[76:79], a[60:63], v[76:79]
buffer_load_dwordx4 v12, s[48:51], s64 offen lds
v_mfma_f32_16x16x32_bf16 v[76:79], a[72:75], a[56:59], v[76:79]
ds_read_b64_tr_b16 a[114:115], v11 offset:1024
v_mfma_f32_16x16x32_bf16 v[140:143], a[80:83], a[56:59], v[140:143]
ds_read_b64_tr_b16 a[116:117], v11 offset:8192
v_mfma_f32_16x16x32_bf16 v[140:143], a[84:87], a[60:63], v[140:143]
s_add_u32 m0, s76, 39936
ds_read_b64_tr_b16 a[118:119], v11 offset:9216
v_mfma_f32_16x16x32_bf16 v[124:127], a[84:87], a[52:55], v[124:127]
s_add_u32 s64, s73, 147840
v_mfma_f32_16x16x32_bf16 v[124:127], a[80:83], a[48:51], v[124:127]
buffer_load_dwordx4 v13, s[48:51], s64 offen lds
v_mfma_f32_16x16x32_bf16 v[108:111], a[80:83], a[40:43], v[108:111]
v_mfma_f32_16x16x32_bf16 v[108:111], a[84:87], a[44:47], v[108:111]
v_mfma_f32_16x16x32_bf16 v[92:95], a[84:87], a[36:39], v[92:95]
v_mfma_f32_16x16x32_bf16 v[92:95], a[80:83], a[32:35], v[92:95]
v_mfma_f32_16x16x32_bf16 v[32:35], a[88:91], a[32:35], v[32:35]
v_mfma_f32_16x16x32_bf16 v[32:35], a[92:95], a[36:39], v[32:35]
v_mfma_f32_16x16x32_bf16 v[48:51], a[92:95], a[44:47], v[48:51]
s_waitcnt lgkmcnt(0)
s_barrier
v_mfma_f32_16x16x32_bf16 v[48:51], a[88:91], a[40:43], v[48:51]
s_add_u32 m0, s77, 65536
ds_read_b64_tr_b16 a[72:73], v19 offset:36864
v_mfma_f32_16x16x32_bf16 v[64:67], a[88:91], a[48:51], v[64:67]
s_add_u32 s64, s71, 2097152
ds_read_b64_tr_b16 a[74:75], v19 offset:37120
v_mfma_f32_16x16x32_bf16 v[64:67], a[92:95], a[52:55], v[64:67]
buffer_load_dwordx4 v14, s[56:59], s64 offen lds
v_mfma_f32_16x16x32_bf16 v[80:83], a[92:95], a[60:63], v[80:83]
ds_read_b64_tr_b16 a[76:77], v19 offset:38912
v_mfma_f32_16x16x32_bf16 v[80:83], a[88:91], a[56:59], v[80:83]
ds_read_b64_tr_b16 a[78:79], v19 offset:39168
v_mfma_f32_16x16x32_bf16 v[144:147], a[96:99], a[56:59], v[144:147]
ds_read_b64_tr_b16 a[80:81], v20 offset:36864
v_mfma_f32_16x16x32_bf16 v[144:147], a[100:103], a[60:63], v[144:147]
ds_read_b64_tr_b16 a[82:83], v20 offset:37120
v_mfma_f32_16x16x32_bf16 v[128:131], a[100:103], a[52:55], v[128:131]
ds_read_b64_tr_b16 a[84:85], v20 offset:38912
v_mfma_f32_16x16x32_bf16 v[128:131], a[96:99], a[48:51], v[128:131]
ds_read_b64_tr_b16 a[86:87], v20 offset:39168
v_mfma_f32_16x16x32_bf16 v[112:115], a[96:99], a[40:43], v[112:115]
s_add_u32 m0, s78, 81920
ds_read_b64_tr_b16 a[88:89], v19 offset:40960
v_mfma_f32_16x16x32_bf16 v[112:115], a[100:103], a[44:47], v[112:115]
s_add_u32 s64, s75, 1572864
ds_read_b64_tr_b16 a[90:91], v19 offset:41216
v_mfma_f32_16x16x32_bf16 v[96:99], a[100:103], a[36:39], v[96:99]
s_add_u32 s65, s79, 0
buffer_load_dwordx4 v23, s[60:63], s64 offen lds
v_mfma_f32_16x16x32_bf16 v[96:99], a[96:99], a[32:35], v[96:99]
buffer_store_dwordx4 a[152:155], v16, s[44:47], s65 offen sc1
v_mfma_f32_16x16x32_bf16 v[36:39], a[104:107], a[32:35], v[36:39]
ds_read_b64_tr_b16 a[92:93], v19 offset:43008
v_mfma_f32_16x16x32_bf16 v[36:39], a[108:111], a[36:39], v[36:39]
ds_read_b64_tr_b16 a[94:95], v19 offset:43264
v_mfma_f32_16x16x32_bf16 v[52:55], a[108:111], a[44:47], v[52:55]
ds_read_b64_tr_b16 a[96:97], v20 offset:40960
v_mfma_f32_16x16x32_bf16 v[52:55], a[104:107], a[40:43], v[52:55]
ds_read_b64_tr_b16 a[98:99], v20 offset:41216
v_mfma_f32_16x16x32_bf16 v[68:71], a[104:107], a[48:51], v[68:71]
s_add_u32 m0, s77, 66560
ds_read_b64_tr_b16 a[100:101], v20 offset:43008
v_mfma_f32_16x16x32_bf16 v[68:71], a[108:111], a[52:55], v[68:71]
s_add_u32 s64, s71, 2129920
s_xor_b32 s68, s66, 4096
ds_read_b64_tr_b16 a[102:103], v20 offset:43264
v_mfma_f32_16x16x32_bf16 v[84:87], a[108:111], a[60:63], v[84:87]
s_mov_b64 exec, 1
buffer_atomic_add a251, v1, s[52:55], s68 offen offset:0 sc1
s_mov_b64 exec, -1
v_mfma_f32_16x16x32_bf16 v[84:87], a[104:107], a[56:59], v[84:87]
buffer_load_dwordx4 v14, s[56:59], s64 offen lds
v_mfma_f32_16x16x32_bf16 v[148:151], a[112:115], a[56:59], v[148:151]
ds_read_b64_tr_b16 a[104:105], v19 offset:32768
v_mfma_f32_16x16x32_bf16 v[148:151], a[116:119], a[60:63], v[148:151]
ds_read_b64_tr_b16 a[106:107], v19 offset:33024
v_mfma_f32_16x16x32_bf16 v[132:135], a[116:119], a[52:55], v[132:135]
ds_read_b64_tr_b16 a[108:109], v19 offset:34816
v_mfma_f32_16x16x32_bf16 v[132:135], a[112:115], a[48:51], v[132:135]
ds_read_b64_tr_b16 a[110:111], v19 offset:35072
v_mfma_f32_16x16x32_bf16 v[116:119], a[112:115], a[40:43], v[116:119]
v_mfma_f32_16x16x32_bf16 v[116:119], a[116:119], a[44:47], v[116:119]
v_mfma_f32_16x16x32_bf16 v[100:103], a[116:119], a[36:39], v[100:103]
s_add_u32 m0, s78, 86016
v_mfma_f32_16x16x32_bf16 v[100:103], a[112:115], a[32:35], v[100:103]
s_waitcnt lgkmcnt(4)
s_add_u32 s64, s75, 1574912
ds_read_b64_tr_b16 a[112:113], v20 offset:32768
v_mfma_f32_16x16x32_bf16 v[184:187], a[72:75], a[0:3], v[184:187]
buffer_load_dwordx4 v23, s[60:63], s64 offen lds
v_mfma_f32_16x16x32_bf16 v[184:187], a[76:79], a[4:7], v[184:187]
ds_read_b64_tr_b16 a[114:115], v20 offset:33024
v_mfma_f32_16x16x32_bf16 v[192:195], a[76:79], a[12:15], v[192:195]
ds_read_b64_tr_b16 a[116:117], v20 offset:34816
v_mfma_f32_16x16x32_bf16 v[192:195], a[72:75], a[8:11], v[192:195]
s_add_u32 s17, s78, .-L_pc+6144
ds_read_b64_tr_b16 a[118:119], v20 offset:35072
v_mfma_f32_16x16x32_bf16 v[200:203], a[72:75], a[16:19], v[200:203]
buffer_load_dword a252, v16, s[88:91], s17 offen
v_mfma_f32_16x16x32_bf16 v[200:203], a[76:79], a[20:23], v[200:203]
v_mfma_f32_16x16x32_bf16 v[208:211], a[76:79], a[28:31], v[208:211]
v_mfma_f32_16x16x32_bf16 v[208:211], a[72:75], a[24:27], v[208:211]
ds_read_b64_tr_b16 a[72:73], v4 offset:32768
v_mfma_f32_16x16x32_bf16 v[212:215], a[80:83], a[24:27], v[212:215]
s_add_u32 m0, s77, 67584
ds_read_b64_tr_b16 a[74:75], v4 offset:33792
v_mfma_f32_16x16x32_bf16 v[212:215], a[84:87], a[28:31], v[212:215]
s_add_u32 s64, s71, 2162688
ds_read_b64_tr_b16 a[76:77], v4 offset:40960
v_mfma_f32_16x16x32_bf16 v[204:207], a[84:87], a[20:23], v[204:207]
buffer_load_dwordx4 v15, s[56:59], s64 offen lds
v_mfma_f32_16x16x32_bf16 v[204:207], a[80:83], a[16:19], v[204:207]
ds_read_b64_tr_b16 a[78:79], v4 offset:41984
v_mfma_f32_16x16x32_bf16 v[196:199], a[80:83], a[8:11], v[196:199]
v_mfma_f32_16x16x32_bf16 v[196:199], a[84:87], a[12:15], v[196:199]
v_mfma_f32_16x16x32_bf16 v[188:191], a[84:87], a[4:7], v[188:191]
v_mfma_f32_16x16x32_bf16 v[188:191], a[80:83], a[0:3], v[188:191]
ds_read_b64_tr_b16 a[80:81], v5 offset:32768
v_mfma_f32_16x16x32_bf16 v[216:219], a[0:3], a[88:91], v[216:219]
ds_read_b64_tr_b16 a[82:83], v5 offset:33792
v_mfma_f32_16x16x32_bf16 v[216:219], a[4:7], a[92:95], v[216:219]
s_add_u32 m0, s78, 90112
ds_read_b64_tr_b16 a[84:85], v5 offset:40960
v_mfma_f32_16x16x32_bf16 v[224:227], a[12:15], a[92:95], v[224:227]
s_add_u32 s64, s75, 1576960
ds_read_b64_tr_b16 a[86:87], v5 offset:41984
v_mfma_f32_16x16x32_bf16 v[224:227], a[8:11], a[88:91], v[224:227]
buffer_load_dwordx4 v23, s[60:63], s64 offen lds
v_mfma_f32_16x16x32_bf16 v[232:235], a[16:19], a[88:91], v[232:235]
v_mfma_f32_16x16x32_bf16 v[232:235], a[20:23], a[92:95], v[232:235]
v_mfma_f32_16x16x32_bf16 v[240:243], a[28:31], a[92:95], v[240:243]
v_mfma_f32_16x16x32_bf16 v[240:243], a[24:27], a[88:91], v[240:243]
ds_read_b64_tr_b16 a[88:89], v6 offset:32768
v_mfma_f32_16x16x32_bf16 v[244:247], a[24:27], a[96:99], v[244:247]
ds_read_b64_tr_b16 a[90:91], v6 offset:33792
v_mfma_f32_16x16x32_bf16 v[244:247], a[28:31], a[100:103], v[244:247]
ds_read_b64_tr_b16 a[92:93], v6 offset:40960
v_add_u32 v19, 0x8000, v19
v_mfma_f32_16x16x32_bf16 v[236:239], a[20:23], a[100:103], v[236:239]
s_add_u32 m0, s77, 68608
ds_read_b64_tr_b16 a[94:95], v6 offset:41984
v_mfma_f32_16x16x32_bf16 v[236:239], a[16:19], a[96:99], v[236:239]
s_add_u32 s64, s71, 2195456
v_mfma_f32_16x16x32_bf16 v[228:231], a[8:11], a[96:99], v[228:231]
buffer_load_dwordx4 v15, s[56:59], s64 offen lds
v_mfma_f32_16x16x32_bf16 v[228:231], a[12:15], a[100:103], v[228:231]
v_mfma_f32_16x16x32_bf16 v[220:223], a[4:7], a[100:103], v[220:223]
v_mfma_f32_16x16x32_bf16 v[220:223], a[0:3], a[96:99], v[220:223]
s_waitcnt lgkmcnt(4)
s_add_u32 s65, s79, 17408
ds_read_b64_tr_b16 a[96:97], v7 offset:32768
v_mfma_f32_16x16x32_bf16 v[152:155], a[104:107], a[0:3], v[152:155]
buffer_store_dwordx4 a[156:159], v16, s[44:47], s65 offen sc1
v_mfma_f32_16x16x32_bf16 v[152:155], a[108:111], a[4:7], v[152:155]
ds_read_b64_tr_b16 a[98:99], v7 offset:33792
v_add_u32 v20, 0x8000, v20
v_mfma_f32_16x16x32_bf16 v[160:163], a[108:111], a[12:15], v[160:163]
ds_read_b64_tr_b16 a[100:101], v7 offset:40960
v_mfma_f32_16x16x32_bf16 v[160:163], a[104:107], a[8:11], v[160:163]
ds_read_b64_tr_b16 a[102:103], v7 offset:41984
v_mfma_f32_16x16x32_bf16 v[168:171], a[104:107], a[16:19], v[168:171]
v_mfma_f32_16x16x32_bf16 v[168:171], a[108:111], a[20:23], v[168:171]
v_mfma_f32_16x16x32_bf16 v[176:179], a[108:111], a[28:31], v[176:179]
s_add_u32 m0, s76, 0
v_mfma_f32_16x16x32_bf16 v[176:179], a[104:107], a[24:27], v[176:179]
s_add_u32 s64, s72, 512
ds_read_b64_tr_b16 a[104:105], v8 offset:32768
v_mfma_f32_16x16x32_bf16 v[180:183], a[112:115], a[24:27], v[180:183]
buffer_load_dwordx4 v12, s[48:51], s64 offen lds
v_mfma_f32_16x16x32_bf16 v[180:183], a[116:119], a[28:31], v[180:183]
ds_read_b64_tr_b16 a[106:107], v8 offset:33792
v_add_u32 v4, 0x8000, v4
v_mfma_f32_16x16x32_bf16 v[172:175], a[116:119], a[20:23], v[172:175]
ds_read_b64_tr_b16 a[108:109], v8 offset:40960
v_mfma_f32_16x16x32_bf16 v[172:175], a[112:115], a[16:19], v[172:175]
s_add_u32 m0, s76, 1024
ds_read_b64_tr_b16 a[110:111], v8 offset:41984
v_mfma_f32_16x16x32_bf16 v[164:167], a[112:115], a[8:11], v[164:167]
s_add_u32 s64, s72, 16896
v_mfma_f32_16x16x32_bf16 v[164:167], a[116:119], a[12:15], v[164:167]
buffer_load_dwordx4 v13, s[48:51], s64 offen lds
v_mfma_f32_16x16x32_bf16 v[156:159], a[116:119], a[4:7], v[156:159]
v_mfma_f32_16x16x32_bf16 v[156:159], a[112:115], a[0:3], v[156:159]
ds_read_b64_tr_b16 a[112:113], v9 offset:32768
v_mfma_f32_16x16x32_bf16 v[24:27], a[72:75], a[0:3], v[24:27]
s_add_u32 m0, s76, 2048
ds_read_b64_tr_b16 a[114:115], v9 offset:33792
v_mfma_f32_16x16x32_bf16 v[24:27], a[76:79], a[4:7], v[24:27]
s_add_u32 s64, s72, 131584
ds_read_b64_tr_b16 a[116:117], v9 offset:40960
v_add_u32 v5, 0x8000, v5
v_mfma_f32_16x16x32_bf16 v[40:43], a[76:79], a[12:15], v[40:43]
buffer_load_dwordx4 v12, s[48:51], s64 offen lds
v_mfma_f32_16x16x32_bf16 v[40:43], a[72:75], a[8:11], v[40:43]
ds_read_b64_tr_b16 a[118:119], v9 offset:41984
v_mfma_f32_16x16x32_bf16 v[56:59], a[72:75], a[16:19], v[56:59]
v_mfma_f32_16x16x32_bf16 v[56:59], a[76:79], a[20:23], v[56:59]
s_add_u32 m0, s76, 3072
v_mfma_f32_16x16x32_bf16 v[72:75], a[76:79], a[28:31], v[72:75]
s_waitcnt vmcnt(14)
s_add_u32 s64, s72, 147968
ds_read_b128 a[32:35], v2 offset:32768
v_mfma_f32_16x16x32_bf16 v[72:75], a[72:75], a[24:27], v[72:75]
buffer_load_dwordx4 v13, s[48:51], s64 offen lds
v_mfma_f32_16x16x32_bf16 v[136:139], a[80:83], a[24:27], v[136:139]
ds_read_b128 a[36:39], v3 offset:32768
v_mfma_f32_16x16x32_bf16 v[136:139], a[84:87], a[28:31], v[136:139]
ds_read_b128 a[40:43], v2 offset:34816
v_add_u32 v6, 0x8000, v6
v_mfma_f32_16x16x32_bf16 v[120:123], a[84:87], a[20:23], v[120:123]
s_add_u32 m0, s76, 4096
ds_read_b128 a[44:47], v3 offset:34816
v_mfma_f32_16x16x32_bf16 v[120:123], a[80:83], a[16:19], v[120:123]
s_add_u32 s64, s73, 512
ds_read_b128 a[48:51], v2 offset:36864
v_mfma_f32_16x16x32_bf16 v[104:107], a[80:83], a[8:11], v[104:107]
buffer_load_dwordx4 v12, s[48:51], s64 offen lds
v_mfma_f32_16x16x32_bf16 v[104:107], a[84:87], a[12:15], v[104:107]
ds_read_b128 a[52:55], v3 offset:36864
v_mfma_f32_16x16x32_bf16 v[88:91], a[84:87], a[4:7], v[88:91]
ds_read_b128 a[56:59], v2 offset:38912
v_mfma_f32_16x16x32_bf16 v[88:91], a[80:83], a[0:3], v[88:91]
s_waitcnt lgkmcnt(7)
s_add_u32 m0, s76, 5120
ds_read_b128 a[60:63], v3 offset:38912
v_mfma_f32_16x16x32_bf16 v[28:31], a[88:91], a[0:3], v[28:31]
s_add_u32 s64, s73, 16896
ds_read_b64_tr_b16 a[72:73], v10 offset:32768
v_mfma_f32_16x16x32_bf16 v[28:31], a[92:95], a[4:7], v[28:31]
buffer_load_dwordx4 v13, s[48:51], s64 offen lds
v_mfma_f32_16x16x32_bf16 v[44:47], a[92:95], a[12:15], v[44:47]
ds_read_b64_tr_b16 a[74:75], v10 offset:33792
v_add_u32 v7, 0x8000, v7
v_mfma_f32_16x16x32_bf16 v[44:47], a[88:91], a[8:11], v[44:47]
ds_read_b64_tr_b16 a[76:77], v10 offset:40960
v_mfma_f32_16x16x32_bf16 v[60:63], a[88:91], a[16:19], v[60:63]
s_add_u32 m0, s76, 6144
ds_read_b64_tr_b16 a[78:79], v10 offset:41984
v_mfma_f32_16x16x32_bf16 v[60:63], a[92:95], a[20:23], v[60:63]
s_add_u32 s64, s73, 131584
ds_read_b64_tr_b16 a[80:81], v11 offset:32768
v_mfma_f32_16x16x32_bf16 v[76:79], a[92:95], a[28:31], v[76:79]
buffer_load_dwordx4 v12, s[48:51], s64 offen lds
v_mfma_f32_16x16x32_bf16 v[76:79], a[88:91], a[24:27], v[76:79]
ds_read_b64_tr_b16 a[82:83], v11 offset:33792
v_mfma_f32_16x16x32_bf16 v[140:143], a[96:99], a[24:27], v[140:143]
ds_read_b64_tr_b16 a[84:85], v11 offset:40960
v_mfma_f32_16x16x32_bf16 v[140:143], a[100:103], a[28:31], v[140:143]
s_add_u32 m0, s76, 7168
ds_read_b64_tr_b16 a[86:87], v11 offset:41984
v_add_u32 v8, 0x8000, v8
v_mfma_f32_16x16x32_bf16 v[124:127], a[100:103], a[20:23], v[124:127]
s_add_u32 s64, s73, 147968
v_mfma_f32_16x16x32_bf16 v[124:127], a[96:99], a[16:19], v[124:127]
buffer_load_dwordx4 v13, s[48:51], s64 offen lds
v_mfma_f32_16x16x32_bf16 v[108:111], a[96:99], a[8:11], v[108:111]
v_mfma_f32_16x16x32_bf16 v[108:111], a[100:103], a[12:15], v[108:111]
v_mfma_f32_16x16x32_bf16 v[92:95], a[100:103], a[4:7], v[92:95]
v_add_u32 v9, 0x8000, v9
v_add_u32 v10, 0x8000, v10
v_mfma_f32_16x16x32_bf16 v[92:95], a[96:99], a[0:3], v[92:95]
v_add_u32 v11, 0x8000, v11
v_mfma_f32_16x16x32_bf16 v[32:35], a[104:107], a[0:3], v[32:35]
s_add_u32 s65, s79, 5120
v_mfma_f32_16x16x32_bf16 v[32:35], a[108:111], a[4:7], v[32:35]
buffer_store_dwordx4 a[160:163], v16, s[44:47], s65 offen sc1
v_mfma_f32_16x16x32_bf16 v[48:51], a[108:111], a[12:15], v[48:51]
s_waitcnt lgkmcnt(0)
s_barrier
v_mfma_f32_16x16x32_bf16 v[48:51], a[104:107], a[8:11], v[48:51]
s_add_u32 m0, s77, 98304
ds_read_b64_tr_b16 a[88:89], v19 offset:36864
v_mfma_f32_16x16x32_bf16 v[64:67], a[104:107], a[16:19], v[64:67]
s_add_u32 s64, s71, 2621440
ds_read_b64_tr_b16 a[90:91], v19 offset:37120
v_mfma_f32_16x16x32_bf16 v[64:67], a[108:111], a[20:23], v[64:67]
buffer_load_dwordx4 v14, s[56:59], s64 offen lds
v_mfma_f32_16x16x32_bf16 v[80:83], a[108:111], a[28:31], v[80:83]
ds_read_b64_tr_b16 a[92:93], v19 offset:38912
v_mfma_f32_16x16x32_bf16 v[80:83], a[104:107], a[24:27], v[80:83]
ds_read_b64_tr_b16 a[94:95], v19 offset:39168
v_mfma_f32_16x16x32_bf16 v[144:147], a[112:115], a[24:27], v[144:147]
ds_read_b64_tr_b16 a[96:97], v20 offset:36864
v_mfma_f32_16x16x32_bf16 v[144:147], a[116:119], a[28:31], v[144:147]
ds_read_b64_tr_b16 a[98:99], v20 offset:37120
v_mfma_f32_16x16x32_bf16 v[128:131], a[116:119], a[20:23], v[128:131]
ds_read_b64_tr_b16 a[100:101], v20 offset:38912
v_mfma_f32_16x16x32_bf16 v[128:131], a[112:115], a[16:19], v[128:131]
ds_read_b64_tr_b16 a[102:103], v20 offset:39168
v_mfma_f32_16x16x32_bf16 v[112:115], a[112:115], a[8:11], v[112:115]
s_add_u32 m0, s78, 114688
ds_read_b64_tr_b16 a[104:105], v19 offset:40960
v_mfma_f32_16x16x32_bf16 v[112:115], a[116:119], a[12:15], v[112:115]
s_add_u32 s64, s75, 1966080
ds_read_b64_tr_b16 a[106:107], v19 offset:41216
v_mfma_f32_16x16x32_bf16 v[96:99], a[116:119], a[4:7], v[96:99]
buffer_load_dwordx4 v23, s[60:63], s64 offen lds
v_mfma_f32_16x16x32_bf16 v[96:99], a[112:115], a[0:3], v[96:99]
ds_read_b64_tr_b16 a[108:109], v19 offset:43008
v_mfma_f32_16x16x32_bf16 v[36:39], a[72:75], a[0:3], v[36:39]
ds_read_b64_tr_b16 a[110:111], v19 offset:43264
v_mfma_f32_16x16x32_bf16 v[36:39], a[76:79], a[4:7], v[36:39]
ds_read_b64_tr_b16 a[112:113], v20 offset:40960
v_mfma_f32_16x16x32_bf16 v[52:55], a[76:79], a[12:15], v[52:55]
ds_read_b64_tr_b16 a[114:115], v20 offset:41216
v_mfma_f32_16x16x32_bf16 v[52:55], a[72:75], a[8:11], v[52:55]
ds_read_b64_tr_b16 a[116:117], v20 offset:43008
v_mfma_f32_16x16x32_bf16 v[68:71], a[72:75], a[16:19], v[68:71]
s_add_u32 m0, s77, 99328
ds_read_b64_tr_b16 a[118:119], v20 offset:43264
v_mfma_f32_16x16x32_bf16 v[68:71], a[76:79], a[20:23], v[68:71]
s_add_u32 s64, s71, 2654208
s_xor_b32 s68, s66, 8192
v_mfma_f32_16x16x32_bf16 v[84:87], a[76:79], a[28:31], v[84:87]
s_mov_b64 exec, 1
buffer_atomic_add a251, v1, s[52:55], s68 offen offset:0 sc1
s_mov_b64 exec, -1
v_mfma_f32_16x16x32_bf16 v[84:87], a[72:75], a[24:27], v[84:87]
buffer_load_dwordx4 v14, s[56:59], s64 offen lds
v_mfma_f32_16x16x32_bf16 v[148:151], a[80:83], a[24:27], v[148:151]
ds_read_b64_tr_b16 a[72:73], v19 offset:32768
v_mfma_f32_16x16x32_bf16 v[148:151], a[84:87], a[28:31], v[148:151]
ds_read_b64_tr_b16 a[74:75], v19 offset:33024
v_mfma_f32_16x16x32_bf16 v[132:135], a[84:87], a[20:23], v[132:135]
ds_read_b64_tr_b16 a[76:77], v19 offset:34816
v_mfma_f32_16x16x32_bf16 v[132:135], a[80:83], a[16:19], v[132:135]
ds_read_b64_tr_b16 a[78:79], v19 offset:35072
v_mfma_f32_16x16x32_bf16 v[116:119], a[80:83], a[8:11], v[116:119]
v_mfma_f32_16x16x32_bf16 v[116:119], a[84:87], a[12:15], v[116:119]
v_mfma_f32_16x16x32_bf16 v[100:103], a[84:87], a[4:7], v[100:103]
s_add_u32 m0, s78, 118784
v_mfma_f32_16x16x32_bf16 v[100:103], a[80:83], a[0:3], v[100:103]
s_waitcnt lgkmcnt(4)
s_add_u32 s64, s75, 1968128
ds_read_b64_tr_b16 a[80:81], v20 offset:32768
v_mfma_f32_16x16x32_bf16 v[184:187], a[88:91], a[32:35], v[184:187]
buffer_load_dwordx4 v23, s[60:63], s64 offen lds
v_mfma_f32_16x16x32_bf16 v[184:187], a[92:95], a[36:39], v[184:187]
ds_read_b64_tr_b16 a[82:83], v20 offset:33024
v_mfma_f32_16x16x32_bf16 v[192:195], a[92:95], a[44:47], v[192:195]
ds_read_b64_tr_b16 a[84:85], v20 offset:34816
v_mfma_f32_16x16x32_bf16 v[192:195], a[88:91], a[40:43], v[192:195]
ds_read_b64_tr_b16 a[86:87], v20 offset:35072
v_mfma_f32_16x16x32_bf16 v[200:203], a[88:91], a[48:51], v[200:203]
v_mfma_f32_16x16x32_bf16 v[200:203], a[92:95], a[52:55], v[200:203]
v_mfma_f32_16x16x32_bf16 v[208:211], a[92:95], a[60:63], v[208:211]
v_mfma_f32_16x16x32_bf16 v[208:211], a[88:91], a[56:59], v[208:211]
ds_read_b64_tr_b16 a[88:89], v4 offset:32768
v_mfma_f32_16x16x32_bf16 v[212:215], a[96:99], a[56:59], v[212:215]
s_add_u32 m0, s77, 100352
ds_read_b64_tr_b16 a[90:91], v4 offset:33792
v_mfma_f32_16x16x32_bf16 v[212:215], a[100:103], a[60:63], v[212:215]
s_add_u32 s64, s71, 2686976
ds_read_b64_tr_b16 a[92:93], v4 offset:40960
v_mfma_f32_16x16x32_bf16 v[204:207], a[100:103], a[52:55], v[204:207]
buffer_load_dwordx4 v15, s[56:59], s64 offen lds
v_mfma_f32_16x16x32_bf16 v[204:207], a[96:99], a[48:51], v[204:207]
ds_read_b64_tr_b16 a[94:95], v4 offset:41984
v_mfma_f32_16x16x32_bf16 v[196:199], a[96:99], a[40:43], v[196:199]
v_mfma_f32_16x16x32_bf16 v[196:199], a[100:103], a[44:47], v[196:199]
v_mfma_f32_16x16x32_bf16 v[188:191], a[100:103], a[36:39], v[188:191]
v_mfma_f32_16x16x32_bf16 v[188:191], a[96:99], a[32:35], v[188:191]
ds_read_b64_tr_b16 a[96:97], v5 offset:32768
v_mfma_f32_16x16x32_bf16 v[216:219], a[32:35], a[104:107], v[216:219]
ds_read_b64_tr_b16 a[98:99], v5 offset:33792
v_mfma_f32_16x16x32_bf16 v[216:219], a[36:39], a[108:111], v[216:219]
s_add_u32 m0, s78, 122880
ds_read_b64_tr_b16 a[100:101], v5 offset:40960
v_mfma_f32_16x16x32_bf16 v[224:227], a[44:47], a[108:111], v[224:227]
s_add_u32 s64, s75, 1970176
ds_read_b64_tr_b16 a[102:103], v5 offset:41984
v_mfma_f32_16x16x32_bf16 v[224:227], a[40:43], a[104:107], v[224:227]
s_add_u32 s65, s79, 1024
buffer_load_dwordx4 v23, s[60:63], s64 offen lds
v_mfma_f32_16x16x32_bf16 v[232:235], a[48:51], a[104:107], v[232:235]
buffer_store_dwordx4 a[164:167], v16, s[44:47], s65 offen sc1
v_mfma_f32_16x16x32_bf16 v[232:235], a[52:55], a[108:111], v[232:235]
v_mfma_f32_16x16x32_bf16 v[240:243], a[60:63], a[108:111], v[240:243]
v_mfma_f32_16x16x32_bf16 v[240:243], a[56:59], a[104:107], v[240:243]
ds_read_b64_tr_b16 a[104:105], v6 offset:32768
v_mfma_f32_16x16x32_bf16 v[244:247], a[56:59], a[112:115], v[244:247]
ds_read_b64_tr_b16 a[106:107], v6 offset:33792
v_mfma_f32_16x16x32_bf16 v[244:247], a[60:63], a[116:119], v[244:247]
ds_read_b64_tr_b16 a[108:109], v6 offset:40960
v_subrev_u32 v19, 0x8000, v19
v_mfma_f32_16x16x32_bf16 v[236:239], a[52:55], a[116:119], v[236:239]
s_add_u32 m0, s77, 101376
ds_read_b64_tr_b16 a[110:111], v6 offset:41984
v_mfma_f32_16x16x32_bf16 v[236:239], a[48:51], a[112:115], v[236:239]
s_add_u32 s64, s71, 2719744
v_mfma_f32_16x16x32_bf16 v[228:231], a[40:43], a[112:115], v[228:231]
buffer_load_dwordx4 v15, s[56:59], s64 offen lds
v_mfma_f32_16x16x32_bf16 v[228:231], a[44:47], a[116:119], v[228:231]
v_mfma_f32_16x16x32_bf16 v[220:223], a[36:39], a[116:119], v[220:223]
v_mfma_f32_16x16x32_bf16 v[220:223], a[32:35], a[112:115], v[220:223]
s_waitcnt lgkmcnt(4)
ds_read_b64_tr_b16 a[112:113], v7 offset:32768
v_mfma_f32_16x16x32_bf16 v[152:155], a[72:75], a[32:35], v[152:155]
ds_read_b64_tr_b16 a[114:115], v7 offset:33792
v_mfma_f32_16x16x32_bf16 v[152:155], a[76:79], a[36:39], v[152:155]
ds_read_b64_tr_b16 a[116:117], v7 offset:40960
v_subrev_u32 v20, 0x8000, v20
v_mfma_f32_16x16x32_bf16 v[160:163], a[76:79], a[44:47], v[160:163]
ds_read_b64_tr_b16 a[118:119], v7 offset:41984
v_mfma_f32_16x16x32_bf16 v[160:163], a[72:75], a[40:43], v[160:163]
v_mfma_f32_16x16x32_bf16 v[168:171], a[72:75], a[48:51], v[168:171]
v_mfma_f32_16x16x32_bf16 v[168:171], a[76:79], a[52:55], v[168:171]
v_mfma_f32_16x16x32_bf16 v[176:179], a[76:79], a[60:63], v[176:179]
s_add_u32 m0, s76, 32768
v_mfma_f32_16x16x32_bf16 v[176:179], a[72:75], a[56:59], v[176:179]
s_add_u32 s64, s72, 640
ds_read_b64_tr_b16 a[72:73], v8 offset:32768
v_mfma_f32_16x16x32_bf16 v[180:183], a[80:83], a[56:59], v[180:183]
buffer_load_dwordx4 v12, s[48:51], s64 offen lds
v_mfma_f32_16x16x32_bf16 v[180:183], a[84:87], a[60:63], v[180:183]
ds_read_b64_tr_b16 a[74:75], v8 offset:33792
v_subrev_u32 v4, 0x8000, v4
v_mfma_f32_16x16x32_bf16 v[172:175], a[84:87], a[52:55], v[172:175]
ds_read_b64_tr_b16 a[76:77], v8 offset:40960
v_mfma_f32_16x16x32_bf16 v[172:175], a[80:83], a[48:51], v[172:175]
s_add_u32 m0, s76, 33792
ds_read_b64_tr_b16 a[78:79], v8 offset:41984
v_mfma_f32_16x16x32_bf16 v[164:167], a[80:83], a[40:43], v[164:167]
s_add_u32 s64, s72, 17024
v_mfma_f32_16x16x32_bf16 v[164:167], a[84:87], a[44:47], v[164:167]
buffer_load_dwordx4 v13, s[48:51], s64 offen lds
v_mfma_f32_16x16x32_bf16 v[156:159], a[84:87], a[36:39], v[156:159]
v_mfma_f32_16x16x32_bf16 v[156:159], a[80:83], a[32:35], v[156:159]
ds_read_b64_tr_b16 a[80:81], v9 offset:32768
v_mfma_f32_16x16x32_bf16 v[24:27], a[88:91], a[32:35], v[24:27]
s_add_u32 m0, s76, 34816
ds_read_b64_tr_b16 a[82:83], v9 offset:33792
v_mfma_f32_16x16x32_bf16 v[24:27], a[92:95], a[36:39], v[24:27]
s_add_u32 s64, s72, 131712
ds_read_b64_tr_b16 a[84:85], v9 offset:40960
v_subrev_u32 v5, 0x8000, v5
v_mfma_f32_16x16x32_bf16 v[40:43], a[92:95], a[44:47], v[40:43]
buffer_load_dwordx4 v12, s[48:51], s64 offen lds
v_mfma_f32_16x16x32_bf16 v[40:43], a[88:91], a[40:43], v[40:43]
ds_read_b64_tr_b16 a[86:87], v9 offset:41984
v_mfma_f32_16x16x32_bf16 v[56:59], a[88:91], a[48:51], v[56:59]
v_mfma_f32_16x16x32_bf16 v[56:59], a[92:95], a[52:55], v[56:59]
s_add_u32 m0, s76, 35840
v_mfma_f32_16x16x32_bf16 v[72:75], a[92:95], a[60:63], v[72:75]
s_waitcnt vmcnt(13)
s_add_u32 s64, s72, 148096
ds_read_b128 a[0:3], v2 offset:0
v_mfma_f32_16x16x32_bf16 v[72:75], a[88:91], a[56:59], v[72:75]
buffer_load_dwordx4 v13, s[48:51], s64 offen lds
v_mfma_f32_16x16x32_bf16 v[136:139], a[96:99], a[56:59], v[136:139]
ds_read_b128 a[4:7], v3 offset:0
v_mfma_f32_16x16x32_bf16 v[136:139], a[100:103], a[60:63], v[136:139]
ds_read_b128 a[8:11], v2 offset:2048
v_subrev_u32 v6, 0x8000, v6
v_mfma_f32_16x16x32_bf16 v[120:123], a[100:103], a[52:55], v[120:123]
s_add_u32 m0, s76, 36864
ds_read_b128 a[12:15], v3 offset:2048
v_mfma_f32_16x16x32_bf16 v[120:123], a[96:99], a[48:51], v[120:123]
s_add_u32 s64, s73, 640
ds_read_b128 a[16:19], v2 offset:4096
v_mfma_f32_16x16x32_bf16 v[104:107], a[96:99], a[40:43], v[104:107]
buffer_load_dwordx4 v12, s[48:51], s64 offen lds
v_mfma_f32_16x16x32_bf16 v[104:107], a[100:103], a[44:47], v[104:107]
ds_read_b128 a[20:23], v3 offset:4096
v_mfma_f32_16x16x32_bf16 v[88:91], a[100:103], a[36:39], v[88:91]
ds_read_b128 a[24:27], v2 offset:6144
v_mfma_f32_16x16x32_bf16 v[88:91], a[96:99], a[32:35], v[88:91]
s_waitcnt lgkmcnt(7)
s_add_u32 m0, s76, 37888
ds_read_b128 a[28:31], v3 offset:6144
v_mfma_f32_16x16x32_bf16 v[28:31], a[104:107], a[32:35], v[28:31]
s_add_u32 s64, s73, 17024
ds_read_b64_tr_b16 a[88:89], v10 offset:32768
v_mfma_f32_16x16x32_bf16 v[28:31], a[108:111], a[36:39], v[28:31]
buffer_load_dwordx4 v13, s[48:51], s64 offen lds
v_mfma_f32_16x16x32_bf16 v[44:47], a[108:111], a[44:47], v[44:47]
ds_read_b64_tr_b16 a[90:91], v10 offset:33792
v_subrev_u32 v7, 0x8000, v7
v_mfma_f32_16x16x32_bf16 v[44:47], a[104:107], a[40:43], v[44:47]
s_add_u32 s65, s79, 18432
ds_read_b64_tr_b16 a[92:93], v10 offset:40960
v_mfma_f32_16x16x32_bf16 v[60:63], a[104:107], a[48:51], v[60:63]
s_add_u32 m0, s76, 38912
buffer_store_dwordx4 a[168:171], v16, s[44:47], s65 offen sc1
v_mfma_f32_16x16x32_bf16 v[60:63], a[108:111], a[52:55], v[60:63]
s_add_u32 s64, s73, 131712
ds_read_b64_tr_b16 a[94:95], v10 offset:41984
v_mfma_f32_16x16x32_bf16 v[76:79], a[108:111], a[60:63], v[76:79]
buffer_load_dwordx4 v12, s[48:51], s64 offen lds
v_mfma_f32_16x16x32_bf16 v[76:79], a[104:107], a[56:59], v[76:79]
ds_read_b64_tr_b16 a[96:97], v11 offset:32768
v_mfma_f32_16x16x32_bf16 v[140:143], a[112:115], a[56:59], v[140:143]
ds_read_b64_tr_b16 a[98:99], v11 offset:33792
v_mfma_f32_16x16x32_bf16 v[140:143], a[116:119], a[60:63], v[140:143]
s_add_u32 m0, s76, 39936
ds_read_b64_tr_b16 a[100:101], v11 offset:40960
v_subrev_u32 v8, 0x8000, v8
v_mfma_f32_16x16x32_bf16 v[124:127], a[116:119], a[52:55], v[124:127]
s_add_u32 s64, s73, 148096
ds_read_b64_tr_b16 a[102:103], v11 offset:41984
v_mfma_f32_16x16x32_bf16 v[124:127], a[112:115], a[48:51], v[124:127]
buffer_load_dwordx4 v13, s[48:51], s64 offen lds
v_mfma_f32_16x16x32_bf16 v[108:111], a[112:115], a[40:43], v[108:111]
v_mfma_f32_16x16x32_bf16 v[108:111], a[116:119], a[44:47], v[108:111]
v_mfma_f32_16x16x32_bf16 v[92:95], a[116:119], a[36:39], v[92:95]
v_subrev_u32 v9, 0x8000, v9
v_subrev_u32 v10, 0x8000, v10
v_mfma_f32_16x16x32_bf16 v[92:95], a[112:115], a[32:35], v[92:95]
v_subrev_u32 v11, 0x8000, v11
v_mfma_f32_16x16x32_bf16 v[32:35], a[72:75], a[32:35], v[32:35]
v_mfma_f32_16x16x32_bf16 v[32:35], a[76:79], a[36:39], v[32:35]
v_mfma_f32_16x16x32_bf16 v[48:51], a[76:79], a[44:47], v[48:51]
s_waitcnt lgkmcnt(0)
s_barrier
v_mfma_f32_16x16x32_bf16 v[48:51], a[72:75], a[40:43], v[48:51]
s_add_u32 m0, s77, 131072
ds_read_b64_tr_b16 a[104:105], v19 offset:4096
v_mfma_f32_16x16x32_bf16 v[64:67], a[72:75], a[48:51], v[64:67]
s_add_u32 s64, s71, 3145728
ds_read_b64_tr_b16 a[106:107], v19 offset:4352
v_mfma_f32_16x16x32_bf16 v[64:67], a[76:79], a[52:55], v[64:67]
buffer_load_dwordx4 v14, s[56:59], s64 offen lds
v_mfma_f32_16x16x32_bf16 v[80:83], a[76:79], a[60:63], v[80:83]
ds_read_b64_tr_b16 a[108:109], v19 offset:6144
v_mfma_f32_16x16x32_bf16 v[80:83], a[72:75], a[56:59], v[80:83]
ds_read_b64_tr_b16 a[110:111], v19 offset:6400
v_mfma_f32_16x16x32_bf16 v[144:147], a[80:83], a[56:59], v[144:147]
ds_read_b64_tr_b16 a[112:113], v20 offset:4096
v_mfma_f32_16x16x32_bf16 v[144:147], a[84:87], a[60:63], v[144:147]
ds_read_b64_tr_b16 a[114:115], v20 offset:4352
v_mfma_f32_16x16x32_bf16 v[128:131], a[84:87], a[52:55], v[128:131]
ds_read_b64_tr_b16 a[116:117], v20 offset:6144
v_mfma_f32_16x16x32_bf16 v[128:131], a[80:83], a[48:51], v[128:131]
ds_read_b64_tr_b16 a[118:119], v20 offset:6400
v_mfma_f32_16x16x32_bf16 v[112:115], a[80:83], a[40:43], v[112:115]
s_add_u32 m0, s78, 147456
ds_read_b64_tr_b16 a[72:73], v19 offset:8192
v_mfma_f32_16x16x32_bf16 v[112:115], a[84:87], a[44:47], v[112:115]
s_add_u32 s64, s75, 2359296
ds_read_b64_tr_b16 a[74:75], v19 offset:8448
v_mfma_f32_16x16x32_bf16 v[96:99], a[84:87], a[36:39], v[96:99]
buffer_load_dwordx4 v23, s[60:63], s64 offen lds
v_mfma_f32_16x16x32_bf16 v[96:99], a[80:83], a[32:35], v[96:99]
ds_read_b64_tr_b16 a[76:77], v19 offset:10240
v_mfma_f32_16x16x32_bf16 v[36:39], a[88:91], a[32:35], v[36:39]
ds_read_b64_tr_b16 a[78:79], v19 offset:10496
v_mfma_f32_16x16x32_bf16 v[36:39], a[92:95], a[36:39], v[36:39]
ds_read_b64_tr_b16 a[80:81], v20 offset:8192
v_mfma_f32_16x16x32_bf16 v[52:55], a[92:95], a[44:47], v[52:55]
ds_read_b64_tr_b16 a[82:83], v20 offset:8448
v_mfma_f32_16x16x32_bf16 v[52:55], a[88:91], a[40:43], v[52:55]
ds_read_b64_tr_b16 a[84:85], v20 offset:10240
v_mfma_f32_16x16x32_bf16 v[68:71], a[88:91], a[48:51], v[68:71]
s_add_u32 m0, s77, 132096
ds_read_b64_tr_b16 a[86:87], v20 offset:10496
v_mfma_f32_16x16x32_bf16 v[68:71], a[92:95], a[52:55], v[68:71]
s_add_u32 s64, s71, 3178496
s_xor_b32 s68, s66, 12288
v_mfma_f32_16x16x32_bf16 v[84:87], a[92:95], a[60:63], v[84:87]
s_mov_b64 exec, 1
buffer_atomic_add a251, v1, s[52:55], s68 offen offset:0 sc1
s_mov_b64 exec, -1
v_mfma_f32_16x16x32_bf16 v[84:87], a[88:91], a[56:59], v[84:87]
buffer_load_dwordx4 v14, s[56:59], s64 offen lds
v_mfma_f32_16x16x32_bf16 v[148:151], a[96:99], a[56:59], v[148:151]
ds_read_b64_tr_b16 a[88:89], v19 offset:0
v_mfma_f32_16x16x32_bf16 v[148:151], a[100:103], a[60:63], v[148:151]
ds_read_b64_tr_b16 a[90:91], v19 offset:256
v_mfma_f32_16x16x32_bf16 v[132:135], a[100:103], a[52:55], v[132:135]
ds_read_b64_tr_b16 a[92:93], v19 offset:2048
v_mfma_f32_16x16x32_bf16 v[132:135], a[96:99], a[48:51], v[132:135]
ds_read_b64_tr_b16 a[94:95], v19 offset:2304
v_mfma_f32_16x16x32_bf16 v[116:119], a[96:99], a[40:43], v[116:119]
v_mfma_f32_16x16x32_bf16 v[116:119], a[100:103], a[44:47], v[116:119]
v_mfma_f32_16x16x32_bf16 v[100:103], a[100:103], a[36:39], v[100:103]
s_add_u32 m0, s78, 151552
v_mfma_f32_16x16x32_bf16 v[100:103], a[96:99], a[32:35], v[100:103]
s_waitcnt lgkmcnt(4)
s_add_u32 s64, s75, 2361344
ds_read_b64_tr_b16 a[96:97], v20 offset:0
v_mfma_f32_16x16x32_bf16 v[184:187], a[104:107], a[0:3], v[184:187]
s_mov_b32 s36, s20
buffer_load_dwordx4 v23, s[60:63], s64 offen lds
v_mfma_f32_16x16x32_bf16 v[184:187], a[108:111], a[4:7], v[184:187]
s_mov_b32 s37, s21
ds_read_b64_tr_b16 a[98:99], v20 offset:256
v_mfma_f32_16x16x32_bf16 v[192:195], a[108:111], a[12:15], v[192:195]
s_mov_b32 s38, 2097152
s_add_u32 s17, s78, .-L_pc+6144
ds_read_b64_tr_b16 a[100:101], v20 offset:2048
v_mfma_f32_16x16x32_bf16 v[192:195], a[104:107], a[8:11], v[192:195]
s_mov_b32 s40, s14
s_add_u32 s65, s79, 6144
ds_read_b64_tr_b16 a[102:103], v20 offset:2304
v_mfma_f32_16x16x32_bf16 v[200:203], a[104:107], a[16:19], v[200:203]
s_mov_b32 s41, s15
buffer_load_dword a252, v16, s[88:91], s17 offen
v_mfma_f32_16x16x32_bf16 v[200:203], a[108:111], a[20:23], v[200:203]
s_mov_b32 s42, 8388608
buffer_store_dwordx4 a[172:175], v16, s[44:47], s65 offen sc1
v_mfma_f32_16x16x32_bf16 v[208:211], a[108:111], a[28:31], v[208:211]
v_mfma_f32_16x16x32_bf16 v[208:211], a[104:107], a[24:27], v[208:211]
ds_read_b64_tr_b16 a[104:105], v4 offset:0
v_mfma_f32_16x16x32_bf16 v[212:215], a[112:115], a[24:27], v[212:215]
s_add_u32 m0, s77, 133120
ds_read_b64_tr_b16 a[106:107], v4 offset:1024
v_mfma_f32_16x16x32_bf16 v[212:215], a[116:119], a[28:31], v[212:215]
s_add_u32 s64, s71, 3211264
ds_read_b64_tr_b16 a[108:109], v4 offset:8192
v_mfma_f32_16x16x32_bf16 v[204:207], a[116:119], a[20:23], v[204:207]
buffer_load_dwordx4 v15, s[56:59], s64 offen lds
v_mfma_f32_16x16x32_bf16 v[204:207], a[112:115], a[16:19], v[204:207]
ds_read_b64_tr_b16 a[110:111], v4 offset:9216
v_mfma_f32_16x16x32_bf16 v[196:199], a[112:115], a[8:11], v[196:199]
v_mfma_f32_16x16x32_bf16 v[196:199], a[116:119], a[12:15], v[196:199]
v_mfma_f32_16x16x32_bf16 v[188:191], a[116:119], a[4:7], v[188:191]
v_mfma_f32_16x16x32_bf16 v[188:191], a[112:115], a[0:3], v[188:191]
ds_read_b64_tr_b16 a[112:113], v5 offset:0
v_mfma_f32_16x16x32_bf16 v[216:219], a[0:3], a[72:75], v[216:219]
ds_read_b64_tr_b16 a[114:115], v5 offset:1024
v_mfma_f32_16x16x32_bf16 v[216:219], a[4:7], a[76:79], v[216:219]
s_add_u32 m0, s78, 155648
ds_read_b64_tr_b16 a[116:117], v5 offset:8192
v_mfma_f32_16x16x32_bf16 v[224:227], a[12:15], a[76:79], v[224:227]
s_add_u32 s64, s75, 2363392
ds_read_b64_tr_b16 a[118:119], v5 offset:9216
v_mfma_f32_16x16x32_bf16 v[224:227], a[8:11], a[72:75], v[224:227]
buffer_load_dwordx4 v23, s[60:63], s64 offen lds
v_mfma_f32_16x16x32_bf16 v[232:235], a[16:19], a[72:75], v[232:235]
v_mfma_f32_16x16x32_bf16 v[232:235], a[20:23], a[76:79], v[232:235]
v_mfma_f32_16x16x32_bf16 v[240:243], a[28:31], a[76:79], v[240:243]
v_mfma_f32_16x16x32_bf16 v[240:243], a[24:27], a[72:75], v[240:243]
ds_read_b64_tr_b16 a[72:73], v6 offset:0
v_mfma_f32_16x16x32_bf16 v[244:247], a[24:27], a[80:83], v[244:247]
ds_read_b64_tr_b16 a[74:75], v6 offset:1024
v_mfma_f32_16x16x32_bf16 v[244:247], a[28:31], a[84:87], v[244:247]
ds_read_b64_tr_b16 a[76:77], v6 offset:8192
v_mfma_f32_16x16x32_bf16 v[236:239], a[20:23], a[84:87], v[236:239]
s_add_u32 m0, s77, 134144
ds_read_b64_tr_b16 a[78:79], v6 offset:9216
v_mfma_f32_16x16x32_bf16 v[236:239], a[16:19], a[80:83], v[236:239]
s_add_u32 s64, s71, 3244032
v_mfma_f32_16x16x32_bf16 v[228:231], a[8:11], a[80:83], v[228:231]
buffer_load_dwordx4 v15, s[56:59], s64 offen lds
v_mfma_f32_16x16x32_bf16 v[228:231], a[12:15], a[84:87], v[228:231]
v_mfma_f32_16x16x32_bf16 v[220:223], a[4:7], a[84:87], v[220:223]
v_mfma_f32_16x16x32_bf16 v[220:223], a[0:3], a[80:83], v[220:223]
s_waitcnt lgkmcnt(4)
ds_read_b64_tr_b16 a[80:81], v7 offset:0
v_mfma_f32_16x16x32_bf16 v[152:155], a[88:91], a[0:3], v[152:155]
ds_read_b64_tr_b16 a[82:83], v7 offset:1024
v_mfma_f32_16x16x32_bf16 v[152:155], a[92:95], a[4:7], v[152:155]
ds_read_b64_tr_b16 a[84:85], v7 offset:8192
v_mfma_f32_16x16x32_bf16 v[160:163], a[92:95], a[12:15], v[160:163]
ds_read_b64_tr_b16 a[86:87], v7 offset:9216
v_mfma_f32_16x16x32_bf16 v[160:163], a[88:91], a[8:11], v[160:163]
v_mfma_f32_16x16x32_bf16 v[168:171], a[88:91], a[16:19], v[168:171]
v_mfma_f32_16x16x32_bf16 v[168:171], a[92:95], a[20:23], v[168:171]
v_mfma_f32_16x16x32_bf16 v[176:179], a[92:95], a[28:31], v[176:179]
s_add_u32 m0, s76, 0
v_mfma_f32_16x16x32_bf16 v[176:179], a[88:91], a[24:27], v[176:179]
s_add_u32 s64, s72, 768
ds_read_b64_tr_b16 a[88:89], v8 offset:0
v_mfma_f32_16x16x32_bf16 v[180:183], a[96:99], a[24:27], v[180:183]
buffer_load_dwordx4 v12, s[48:51], s64 offen lds
v_mfma_f32_16x16x32_bf16 v[180:183], a[100:103], a[28:31], v[180:183]
ds_read_b64_tr_b16 a[90:91], v8 offset:1024
v_mfma_f32_16x16x32_bf16 v[172:175], a[100:103], a[20:23], v[172:175]
ds_read_b64_tr_b16 a[92:93], v8 offset:8192
v_mfma_f32_16x16x32_bf16 v[172:175], a[96:99], a[16:19], v[172:175]
s_add_u32 m0, s76, 1024
ds_read_b64_tr_b16 a[94:95], v8 offset:9216
v_mfma_f32_16x16x32_bf16 v[164:167], a[96:99], a[8:11], v[164:167]
s_add_u32 s64, s72, 17152
v_mfma_f32_16x16x32_bf16 v[164:167], a[100:103], a[12:15], v[164:167]
buffer_load_dwordx4 v13, s[48:51], s64 offen lds
v_mfma_f32_16x16x32_bf16 v[156:159], a[100:103], a[4:7], v[156:159]
v_mfma_f32_16x16x32_bf16 v[156:159], a[96:99], a[0:3], v[156:159]
ds_read_b64_tr_b16 a[96:97], v9 offset:0
v_mfma_f32_16x16x32_bf16 v[24:27], a[104:107], a[0:3], v[24:27]
s_add_u32 m0, s76, 2048
ds_read_b64_tr_b16 a[98:99], v9 offset:1024
v_mfma_f32_16x16x32_bf16 v[24:27], a[108:111], a[4:7], v[24:27]
s_add_u32 s64, s72, 131840
ds_read_b64_tr_b16 a[100:101], v9 offset:8192
v_mfma_f32_16x16x32_bf16 v[40:43], a[108:111], a[12:15], v[40:43]
buffer_load_dwordx4 v12, s[48:51], s64 offen lds
v_mfma_f32_16x16x32_bf16 v[40:43], a[104:107], a[8:11], v[40:43]
ds_read_b64_tr_b16 a[102:103], v9 offset:9216
v_mfma_f32_16x16x32_bf16 v[56:59], a[104:107], a[16:19], v[56:59]
v_mfma_f32_16x16x32_bf16 v[56:59], a[108:111], a[20:23], v[56:59]
s_add_u32 m0, s76, 3072
v_mfma_f32_16x16x32_bf16 v[72:75], a[108:111], a[28:31], v[72:75]
s_waitcnt vmcnt(13)
s_add_u32 s64, s72, 148224
ds_read_b128 a[32:35], v2 offset:32768
v_mfma_f32_16x16x32_bf16 v[72:75], a[104:107], a[24:27], v[72:75]
s_add_u32 s65, s79, 2048
buffer_load_dwordx4 v13, s[48:51], s64 offen lds
v_mfma_f32_16x16x32_bf16 v[136:139], a[112:115], a[24:27], v[136:139]
buffer_store_dwordx4 a[176:179], v16, s[44:47], s65 offen sc1
v_mfma_f32_16x16x32_bf16 v[136:139], a[116:119], a[28:31], v[136:139]
ds_read_b128 a[36:39], v3 offset:32768
v_mfma_f32_16x16x32_bf16 v[120:123], a[116:119], a[20:23], v[120:123]
s_add_u32 m0, s76, 4096
ds_read_b128 a[40:43], v2 offset:34816
v_mfma_f32_16x16x32_bf16 v[120:123], a[112:115], a[16:19], v[120:123]
s_add_u32 s64, s73, 768
ds_read_b128 a[44:47], v3 offset:34816
v_mfma_f32_16x16x32_bf16 v[104:107], a[112:115], a[8:11], v[104:107]
buffer_load_dwordx4 v12, s[48:51], s64 offen lds
v_mfma_f32_16x16x32_bf16 v[104:107], a[116:119], a[12:15], v[104:107]
ds_read_b128 a[48:51], v2 offset:36864
v_mfma_f32_16x16x32_bf16 v[88:91], a[116:119], a[4:7], v[88:91]
ds_read_b128 a[52:55], v3 offset:36864
v_mfma_f32_16x16x32_bf16 v[88:91], a[112:115], a[0:3], v[88:91]
s_waitcnt lgkmcnt(6)
s_add_u32 m0, s76, 5120
ds_read_b128 a[56:59], v2 offset:38912
v_mfma_f32_16x16x32_bf16 v[28:31], a[72:75], a[0:3], v[28:31]
s_add_u32 s64, s73, 17152
ds_read_b128 a[60:63], v3 offset:38912
v_mfma_f32_16x16x32_bf16 v[28:31], a[76:79], a[4:7], v[28:31]
buffer_load_dwordx4 v13, s[48:51], s64 offen lds
v_mfma_f32_16x16x32_bf16 v[44:47], a[76:79], a[12:15], v[44:47]
ds_read_b64_tr_b16 a[104:105], v10 offset:0
v_mfma_f32_16x16x32_bf16 v[44:47], a[72:75], a[8:11], v[44:47]
ds_read_b64_tr_b16 a[106:107], v10 offset:1024
v_mfma_f32_16x16x32_bf16 v[60:63], a[72:75], a[16:19], v[60:63]
s_add_u32 m0, s76, 6144
ds_read_b64_tr_b16 a[108:109], v10 offset:8192
v_mfma_f32_16x16x32_bf16 v[60:63], a[76:79], a[20:23], v[60:63]
s_add_u32 s64, s73, 131840
ds_read_b64_tr_b16 a[110:111], v10 offset:9216
v_mfma_f32_16x16x32_bf16 v[76:79], a[76:79], a[28:31], v[76:79]
buffer_load_dwordx4 v12, s[48:51], s64 offen lds
v_mfma_f32_16x16x32_bf16 v[76:79], a[72:75], a[24:27], v[76:79]
ds_read_b64_tr_b16 a[112:113], v11 offset:0
v_mfma_f32_16x16x32_bf16 v[140:143], a[80:83], a[24:27], v[140:143]
ds_read_b64_tr_b16 a[114:115], v11 offset:1024
v_mfma_f32_16x16x32_bf16 v[140:143], a[84:87], a[28:31], v[140:143]
s_add_u32 m0, s76, 7168
ds_read_b64_tr_b16 a[116:117], v11 offset:8192
v_mfma_f32_16x16x32_bf16 v[124:127], a[84:87], a[20:23], v[124:127]
s_add_u32 s64, s73, 148224
ds_read_b64_tr_b16 a[118:119], v11 offset:9216
v_mfma_f32_16x16x32_bf16 v[124:127], a[80:83], a[16:19], v[124:127]
buffer_load_dwordx4 v13, s[48:51], s64 offen lds
v_mfma_f32_16x16x32_bf16 v[108:111], a[80:83], a[8:11], v[108:111]
v_mfma_f32_16x16x32_bf16 v[108:111], a[84:87], a[12:15], v[108:111]
v_mfma_f32_16x16x32_bf16 v[92:95], a[84:87], a[4:7], v[92:95]
v_mfma_f32_16x16x32_bf16 v[92:95], a[80:83], a[0:3], v[92:95]
v_mfma_f32_16x16x32_bf16 v[32:35], a[88:91], a[0:3], v[32:35]
v_mfma_f32_16x16x32_bf16 v[32:35], a[92:95], a[4:7], v[32:35]
v_mfma_f32_16x16x32_bf16 v[48:51], a[92:95], a[12:15], v[48:51]
s_waitcnt lgkmcnt(0)
s_barrier
v_mfma_f32_16x16x32_bf16 v[48:51], a[88:91], a[8:11], v[48:51]
s_add_u32 m0, s77, 65536
ds_read_b64_tr_b16 a[72:73], v19 offset:36864
v_mfma_f32_16x16x32_bf16 v[64:67], a[88:91], a[16:19], v[64:67]
s_add_u32 s64, s71, 3670016
ds_read_b64_tr_b16 a[74:75], v19 offset:37120
v_mfma_f32_16x16x32_bf16 v[64:67], a[92:95], a[20:23], v[64:67]
buffer_load_dwordx4 v14, s[56:59], s64 offen lds
v_mfma_f32_16x16x32_bf16 v[80:83], a[92:95], a[28:31], v[80:83]
ds_read_b64_tr_b16 a[76:77], v19 offset:38912
v_mfma_f32_16x16x32_bf16 v[80:83], a[88:91], a[24:27], v[80:83]
ds_read_b64_tr_b16 a[78:79], v19 offset:39168
v_mfma_f32_16x16x32_bf16 v[144:147], a[96:99], a[24:27], v[144:147]
ds_read_b64_tr_b16 a[80:81], v20 offset:36864
v_mfma_f32_16x16x32_bf16 v[144:147], a[100:103], a[28:31], v[144:147]
ds_read_b64_tr_b16 a[82:83], v20 offset:37120
v_mfma_f32_16x16x32_bf16 v[128:131], a[100:103], a[20:23], v[128:131]
ds_read_b64_tr_b16 a[84:85], v20 offset:38912
v_mfma_f32_16x16x32_bf16 v[128:131], a[96:99], a[16:19], v[128:131]
ds_read_b64_tr_b16 a[86:87], v20 offset:39168
v_mfma_f32_16x16x32_bf16 v[112:115], a[96:99], a[8:11], v[112:115]
s_add_u32 m0, s78, 81920
ds_read_b64_tr_b16 a[88:89], v19 offset:40960
v_mfma_f32_16x16x32_bf16 v[112:115], a[100:103], a[12:15], v[112:115]
s_add_u32 s64, s75, 2752512
ds_read_b64_tr_b16 a[90:91], v19 offset:41216
v_mfma_f32_16x16x32_bf16 v[96:99], a[100:103], a[4:7], v[96:99]
buffer_load_dwordx4 v23, s[60:63], s64 offen lds
v_mfma_f32_16x16x32_bf16 v[96:99], a[96:99], a[0:3], v[96:99]
ds_read_b64_tr_b16 a[92:93], v19 offset:43008
v_mfma_f32_16x16x32_bf16 v[36:39], a[104:107], a[0:3], v[36:39]
ds_read_b64_tr_b16 a[94:95], v19 offset:43264
v_mfma_f32_16x16x32_bf16 v[36:39], a[108:111], a[4:7], v[36:39]
ds_read_b64_tr_b16 a[96:97], v20 offset:40960
v_mfma_f32_16x16x32_bf16 v[52:55], a[108:111], a[12:15], v[52:55]
ds_read_b64_tr_b16 a[98:99], v20 offset:41216
v_mfma_f32_16x16x32_bf16 v[52:55], a[104:107], a[8:11], v[52:55]
ds_read_b64_tr_b16 a[100:101], v20 offset:43008
v_mfma_f32_16x16x32_bf16 v[68:71], a[104:107], a[16:19], v[68:71]
ds_read_b64_tr_b16 a[102:103], v20 offset:43264
v_mfma_f32_16x16x32_bf16 v[68:71], a[108:111], a[20:23], v[68:71]
s_add_u32 m0, s77, 66560
v_mfma_f32_16x16x32_bf16 v[84:87], a[108:111], a[28:31], v[84:87]
s_add_u32 s64, s71, 3702784
v_mfma_f32_16x16x32_bf16 v[84:87], a[104:107], a[24:27], v[84:87]
s_add_u32 s65, s79, 19456
buffer_load_dwordx4 v14, s[56:59], s64 offen lds
v_mfma_f32_16x16x32_bf16 v[148:151], a[112:115], a[24:27], v[148:151]
buffer_store_dwordx4 a[180:183], v16, s[44:47], s65 offen sc1
v_mfma_f32_16x16x32_bf16 v[148:151], a[116:119], a[28:31], v[148:151]
ds_read_b64_tr_b16 a[104:105], v19 offset:32768
v_mfma_f32_16x16x32_bf16 v[132:135], a[116:119], a[20:23], v[132:135]
ds_read_b64_tr_b16 a[106:107], v19 offset:33024
v_mfma_f32_16x16x32_bf16 v[132:135], a[112:115], a[16:19], v[132:135]
ds_read_b64_tr_b16 a[108:109], v19 offset:34816
v_mfma_f32_16x16x32_bf16 v[116:119], a[112:115], a[8:11], v[116:119]
ds_read_b64_tr_b16 a[110:111], v19 offset:35072
v_mfma_f32_16x16x32_bf16 v[116:119], a[116:119], a[12:15], v[116:119]
v_mfma_f32_16x16x32_bf16 v[100:103], a[116:119], a[4:7], v[100:103]
s_add_u32 m0, s78, 86016
v_mfma_f32_16x16x32_bf16 v[100:103], a[112:115], a[0:3], v[100:103]
s_waitcnt lgkmcnt(4)
s_add_u32 s64, s75, 2754560
ds_read_b64_tr_b16 a[112:113], v20 offset:32768
v_mfma_f32_16x16x32_bf16 v[184:187], a[72:75], a[32:35], v[184:187]
buffer_load_dwordx4 v23, s[60:63], s64 offen lds
v_mfma_f32_16x16x32_bf16 v[184:187], a[76:79], a[36:39], v[184:187]
ds_read_b64_tr_b16 a[114:115], v20 offset:33024
v_mfma_f32_16x16x32_bf16 v[192:195], a[76:79], a[44:47], v[192:195]
ds_read_b64_tr_b16 a[116:117], v20 offset:34816
v_mfma_f32_16x16x32_bf16 v[192:195], a[72:75], a[40:43], v[192:195]
ds_read_b64_tr_b16 a[118:119], v20 offset:35072
v_mfma_f32_16x16x32_bf16 v[200:203], a[72:75], a[48:51], v[200:203]
v_mfma_f32_16x16x32_bf16 v[200:203], a[76:79], a[52:55], v[200:203]
v_mfma_f32_16x16x32_bf16 v[208:211], a[76:79], a[60:63], v[208:211]
v_mfma_f32_16x16x32_bf16 v[208:211], a[72:75], a[56:59], v[208:211]
ds_read_b64_tr_b16 a[72:73], v4 offset:32768
v_mfma_f32_16x16x32_bf16 v[212:215], a[80:83], a[56:59], v[212:215]
s_add_u32 m0, s77, 67584
ds_read_b64_tr_b16 a[74:75], v4 offset:33792
v_mfma_f32_16x16x32_bf16 v[212:215], a[84:87], a[60:63], v[212:215]
s_add_u32 s64, s71, 3735552
ds_read_b64_tr_b16 a[76:77], v4 offset:40960
v_mfma_f32_16x16x32_bf16 v[204:207], a[84:87], a[52:55], v[204:207]
buffer_load_dwordx4 v15, s[56:59], s64 offen lds
v_mfma_f32_16x16x32_bf16 v[204:207], a[80:83], a[48:51], v[204:207]
ds_read_b64_tr_b16 a[78:79], v4 offset:41984
v_mfma_f32_16x16x32_bf16 v[196:199], a[80:83], a[40:43], v[196:199]
v_mfma_f32_16x16x32_bf16 v[196:199], a[84:87], a[44:47], v[196:199]
v_mfma_f32_16x16x32_bf16 v[188:191], a[84:87], a[36:39], v[188:191]
v_mfma_f32_16x16x32_bf16 v[188:191], a[80:83], a[32:35], v[188:191]
ds_read_b64_tr_b16 a[80:81], v5 offset:32768
v_mfma_f32_16x16x32_bf16 v[216:219], a[32:35], a[88:91], v[216:219]
ds_read_b64_tr_b16 a[82:83], v5 offset:33792
v_mfma_f32_16x16x32_bf16 v[216:219], a[36:39], a[92:95], v[216:219]
s_add_u32 m0, s78, 90112
ds_read_b64_tr_b16 a[84:85], v5 offset:40960
v_mfma_f32_16x16x32_bf16 v[224:227], a[44:47], a[92:95], v[224:227]
s_add_u32 s64, s75, 2756608
ds_read_b64_tr_b16 a[86:87], v5 offset:41984
v_mfma_f32_16x16x32_bf16 v[224:227], a[40:43], a[88:91], v[224:227]
buffer_load_dwordx4 v23, s[60:63], s64 offen lds
v_mfma_f32_16x16x32_bf16 v[232:235], a[48:51], a[88:91], v[232:235]
v_mfma_f32_16x16x32_bf16 v[232:235], a[52:55], a[92:95], v[232:235]
v_mfma_f32_16x16x32_bf16 v[240:243], a[60:63], a[92:95], v[240:243]
v_mfma_f32_16x16x32_bf16 v[240:243], a[56:59], a[88:91], v[240:243]
ds_read_b64_tr_b16 a[88:89], v6 offset:32768
v_mfma_f32_16x16x32_bf16 v[244:247], a[56:59], a[96:99], v[244:247]
ds_read_b64_tr_b16 a[90:91], v6 offset:33792
v_mfma_f32_16x16x32_bf16 v[244:247], a[60:63], a[100:103], v[244:247]
ds_read_b64_tr_b16 a[92:93], v6 offset:40960
v_add_u32 v19, 0x8000, v19
v_mfma_f32_16x16x32_bf16 v[236:239], a[52:55], a[100:103], v[236:239]
s_add_u32 m0, s77, 68608
ds_read_b64_tr_b16 a[94:95], v6 offset:41984
v_mfma_f32_16x16x32_bf16 v[236:239], a[48:51], a[96:99], v[236:239]
s_add_u32 s64, s71, 3768320
v_mfma_f32_16x16x32_bf16 v[228:231], a[40:43], a[96:99], v[228:231]
buffer_load_dwordx4 v15, s[56:59], s64 offen lds
v_mfma_f32_16x16x32_bf16 v[228:231], a[44:47], a[100:103], v[228:231]
v_mfma_f32_16x16x32_bf16 v[220:223], a[36:39], a[100:103], v[220:223]
v_mfma_f32_16x16x32_bf16 v[220:223], a[32:35], a[96:99], v[220:223]
s_waitcnt lgkmcnt(4)
ds_read_b64_tr_b16 a[96:97], v7 offset:32768
v_mfma_f32_16x16x32_bf16 v[152:155], a[104:107], a[32:35], v[152:155]
ds_read_b64_tr_b16 a[98:99], v7 offset:33792
v_mfma_f32_16x16x32_bf16 v[152:155], a[108:111], a[36:39], v[152:155]
ds_read_b64_tr_b16 a[100:101], v7 offset:40960
v_add_u32 v20, 0x8000, v20
v_mfma_f32_16x16x32_bf16 v[160:163], a[108:111], a[44:47], v[160:163]
ds_read_b64_tr_b16 a[102:103], v7 offset:41984
v_mfma_f32_16x16x32_bf16 v[160:163], a[104:107], a[40:43], v[160:163]
v_mfma_f32_16x16x32_bf16 v[168:171], a[104:107], a[48:51], v[168:171]
v_mfma_f32_16x16x32_bf16 v[168:171], a[108:111], a[52:55], v[168:171]
v_mfma_f32_16x16x32_bf16 v[176:179], a[108:111], a[60:63], v[176:179]
s_add_u32 m0, s76, 32768
v_mfma_f32_16x16x32_bf16 v[176:179], a[104:107], a[56:59], v[176:179]
s_add_u32 s64, s72, 896
ds_read_b64_tr_b16 a[104:105], v8 offset:32768
v_mfma_f32_16x16x32_bf16 v[180:183], a[112:115], a[56:59], v[180:183]
buffer_load_dwordx4 v12, s[48:51], s64 offen lds
v_mfma_f32_16x16x32_bf16 v[180:183], a[116:119], a[60:63], v[180:183]
s_add_u32 s65, s79, 7168
ds_read_b64_tr_b16 a[106:107], v8 offset:33792
v_add_u32 v4, 0x8000, v4
v_mfma_f32_16x16x32_bf16 v[172:175], a[116:119], a[52:55], v[172:175]
buffer_store_dwordx4 a[184:187], v16, s[44:47], s65 offen sc1
v_mfma_f32_16x16x32_bf16 v[172:175], a[112:115], a[48:51], v[172:175]
s_add_u32 m0, s76, 33792
ds_read_b64_tr_b16 a[108:109], v8 offset:40960
v_mfma_f32_16x16x32_bf16 v[164:167], a[112:115], a[40:43], v[164:167]
s_add_u32 s64, s72, 17280
ds_read_b64_tr_b16 a[110:111], v8 offset:41984
v_mfma_f32_16x16x32_bf16 v[164:167], a[116:119], a[44:47], v[164:167]
buffer_load_dwordx4 v13, s[48:51], s64 offen lds
v_mfma_f32_16x16x32_bf16 v[156:159], a[116:119], a[36:39], v[156:159]
v_mfma_f32_16x16x32_bf16 v[156:159], a[112:115], a[32:35], v[156:159]
ds_read_b64_tr_b16 a[112:113], v9 offset:32768
v_mfma_f32_16x16x32_bf16 v[24:27], a[72:75], a[32:35], v[24:27]
s_add_u32 m0, s76, 34816
ds_read_b64_tr_b16 a[114:115], v9 offset:33792
v_mfma_f32_16x16x32_bf16 v[24:27], a[76:79], a[36:39], v[24:27]
s_add_u32 s64, s72, 131968
ds_read_b64_tr_b16 a[116:117], v9 offset:40960
v_add_u32 v5, 0x8000, v5
v_mfma_f32_16x16x32_bf16 v[40:43], a[76:79], a[44:47], v[40:43]
buffer_load_dwordx4 v12, s[48:51], s64 offen lds
v_mfma_f32_16x16x32_bf16 v[40:43], a[72:75], a[40:43], v[40:43]
ds_read_b64_tr_b16 a[118:119], v9 offset:41984
v_mfma_f32_16x16x32_bf16 v[56:59], a[72:75], a[48:51], v[56:59]
v_mfma_f32_16x16x32_bf16 v[56:59], a[76:79], a[52:55], v[56:59]
s_add_u32 m0, s76, 35840
v_mfma_f32_16x16x32_bf16 v[72:75], a[76:79], a[60:63], v[72:75]
s_waitcnt vmcnt(12)
s_add_u32 s64, s72, 148352
ds_read_b128 a[0:3], v2 offset:0
v_mfma_f32_16x16x32_bf16 v[72:75], a[72:75], a[56:59], v[72:75]
buffer_load_dwordx4 v13, s[48:51], s64 offen lds
v_mfma_f32_16x16x32_bf16 v[136:139], a[80:83], a[56:59], v[136:139]
ds_read_b128 a[4:7], v3 offset:0
v_mfma_f32_16x16x32_bf16 v[136:139], a[84:87], a[60:63], v[136:139]
ds_read_b128 a[8:11], v2 offset:2048
v_add_u32 v6, 0x8000, v6
v_mfma_f32_16x16x32_bf16 v[120:123], a[84:87], a[52:55], v[120:123]
s_add_u32 m0, s76, 36864
ds_read_b128 a[12:15], v3 offset:2048
v_mfma_f32_16x16x32_bf16 v[120:123], a[80:83], a[48:51], v[120:123]
s_add_u32 s64, s73, 896
ds_read_b128 a[16:19], v2 offset:4096
v_mfma_f32_16x16x32_bf16 v[104:107], a[80:83], a[40:43], v[104:107]
buffer_load_dwordx4 v12, s[48:51], s64 offen lds
v_mfma_f32_16x16x32_bf16 v[104:107], a[84:87], a[44:47], v[104:107]
ds_read_b128 a[20:23], v3 offset:4096
v_mfma_f32_16x16x32_bf16 v[88:91], a[84:87], a[36:39], v[88:91]
ds_read_b128 a[24:27], v2 offset:6144
v_mfma_f32_16x16x32_bf16 v[88:91], a[80:83], a[32:35], v[88:91]
s_waitcnt lgkmcnt(7)
s_add_u32 m0, s76, 37888
ds_read_b128 a[28:31], v3 offset:6144
v_mfma_f32_16x16x32_bf16 v[28:31], a[88:91], a[32:35], v[28:31]
s_add_u32 s64, s73, 17280
ds_read_b64_tr_b16 a[72:73], v10 offset:32768
v_mfma_f32_16x16x32_bf16 v[28:31], a[92:95], a[36:39], v[28:31]
buffer_load_dwordx4 v13, s[48:51], s64 offen lds
v_mfma_f32_16x16x32_bf16 v[44:47], a[92:95], a[44:47], v[44:47]
ds_read_b64_tr_b16 a[74:75], v10 offset:33792
v_add_u32 v7, 0x8000, v7
v_mfma_f32_16x16x32_bf16 v[44:47], a[88:91], a[40:43], v[44:47]
ds_read_b64_tr_b16 a[76:77], v10 offset:40960
v_mfma_f32_16x16x32_bf16 v[60:63], a[88:91], a[48:51], v[60:63]
s_add_u32 m0, s76, 38912
ds_read_b64_tr_b16 a[78:79], v10 offset:41984
v_mfma_f32_16x16x32_bf16 v[60:63], a[92:95], a[52:55], v[60:63]
s_add_u32 s64, s73, 131968
ds_read_b64_tr_b16 a[80:81], v11 offset:32768
v_mfma_f32_16x16x32_bf16 v[76:79], a[92:95], a[60:63], v[76:79]
buffer_load_dwordx4 v12, s[48:51], s64 offen lds
v_mfma_f32_16x16x32_bf16 v[76:79], a[88:91], a[56:59], v[76:79]
ds_read_b64_tr_b16 a[82:83], v11 offset:33792
v_mfma_f32_16x16x32_bf16 v[140:143], a[96:99], a[56:59], v[140:143]
ds_read_b64_tr_b16 a[84:85], v11 offset:40960
v_mfma_f32_16x16x32_bf16 v[140:143], a[100:103], a[60:63], v[140:143]
s_add_u32 m0, s76, 39936
ds_read_b64_tr_b16 a[86:87], v11 offset:41984
v_add_u32 v8, 0x8000, v8
v_mfma_f32_16x16x32_bf16 v[124:127], a[100:103], a[52:55], v[124:127]
s_add_u32 s64, s73, 148352
v_mfma_f32_16x16x32_bf16 v[124:127], a[96:99], a[48:51], v[124:127]
buffer_load_dwordx4 v13, s[48:51], s64 offen lds
v_mfma_f32_16x16x32_bf16 v[108:111], a[96:99], a[40:43], v[108:111]
v_mfma_f32_16x16x32_bf16 v[108:111], a[100:103], a[44:47], v[108:111]
v_mfma_f32_16x16x32_bf16 v[92:95], a[100:103], a[36:39], v[92:95]
v_add_u32 v9, 0x8000, v9
v_add_u32 v10, 0x8000, v10
v_mfma_f32_16x16x32_bf16 v[92:95], a[96:99], a[32:35], v[92:95]
v_add_u32 v11, 0x8000, v11
v_mfma_f32_16x16x32_bf16 v[32:35], a[104:107], a[32:35], v[32:35]
v_mfma_f32_16x16x32_bf16 v[32:35], a[108:111], a[36:39], v[32:35]
v_mfma_f32_16x16x32_bf16 v[48:51], a[108:111], a[44:47], v[48:51]
s_waitcnt lgkmcnt(0)
s_barrier
v_mfma_f32_16x16x32_bf16 v[48:51], a[104:107], a[40:43], v[48:51]
s_add_u32 m0, s77, 98304
ds_read_b64_tr_b16 a[88:89], v19 offset:36864
v_mfma_f32_16x16x32_bf16 v[64:67], a[104:107], a[48:51], v[64:67]
s_add_u32 s64, s71, 4194304
ds_read_b64_tr_b16 a[90:91], v19 offset:37120
v_mfma_f32_16x16x32_bf16 v[64:67], a[108:111], a[52:55], v[64:67]
buffer_load_dwordx4 v14, s[56:59], s64 offen lds
v_mfma_f32_16x16x32_bf16 v[80:83], a[108:111], a[60:63], v[80:83]
ds_read_b64_tr_b16 a[92:93], v19 offset:38912
v_mfma_f32_16x16x32_bf16 v[80:83], a[104:107], a[56:59], v[80:83]
ds_read_b64_tr_b16 a[94:95], v19 offset:39168
v_mfma_f32_16x16x32_bf16 v[144:147], a[112:115], a[56:59], v[144:147]
ds_read_b64_tr_b16 a[96:97], v20 offset:36864
v_mfma_f32_16x16x32_bf16 v[144:147], a[116:119], a[60:63], v[144:147]
ds_read_b64_tr_b16 a[98:99], v20 offset:37120
v_mfma_f32_16x16x32_bf16 v[128:131], a[116:119], a[52:55], v[128:131]
s_add_u32 s65, s79, 3072
ds_read_b64_tr_b16 a[100:101], v20 offset:38912
v_mfma_f32_16x16x32_bf16 v[128:131], a[112:115], a[48:51], v[128:131]
buffer_store_dwordx4 a[188:191], v16, s[44:47], s65 offen sc1
v_mfma_f32_16x16x32_bf16 v[112:115], a[112:115], a[40:43], v[112:115]
s_add_u32 m0, s78, 114688
ds_read_b64_tr_b16 a[102:103], v20 offset:39168
v_mfma_f32_16x16x32_bf16 v[112:115], a[116:119], a[44:47], v[112:115]
s_add_u32 s64, s75, 3145728
ds_read_b64_tr_b16 a[104:105], v19 offset:40960
v_mfma_f32_16x16x32_bf16 v[96:99], a[116:119], a[36:39], v[96:99]
buffer_load_dwordx4 v23, s[60:63], s64 offen lds
v_mfma_f32_16x16x32_bf16 v[96:99], a[112:115], a[32:35], v[96:99]
ds_read_b64_tr_b16 a[106:107], v19 offset:41216
v_mfma_f32_16x16x32_bf16 v[36:39], a[72:75], a[32:35], v[36:39]
ds_read_b64_tr_b16 a[108:109], v19 offset:43008
v_mfma_f32_16x16x32_bf16 v[36:39], a[76:79], a[36:39], v[36:39]
ds_read_b64_tr_b16 a[110:111], v19 offset:43264
v_mfma_f32_16x16x32_bf16 v[52:55], a[76:79], a[44:47], v[52:55]
ds_read_b64_tr_b16 a[112:113], v20 offset:40960
v_mfma_f32_16x16x32_bf16 v[52:55], a[72:75], a[40:43], v[52:55]
ds_read_b64_tr_b16 a[114:115], v20 offset:41216
v_mfma_f32_16x16x32_bf16 v[68:71], a[72:75], a[48:51], v[68:71]
ds_read_b64_tr_b16 a[116:117], v20 offset:43008
v_mfma_f32_16x16x32_bf16 v[68:71], a[76:79], a[52:55], v[68:71]
s_add_u32 m0, s77, 99328
ds_read_b64_tr_b16 a[118:119], v20 offset:43264
v_mfma_f32_16x16x32_bf16 v[84:87], a[76:79], a[60:63], v[84:87]
s_add_u32 s64, s71, 4227072
v_mfma_f32_16x16x32_bf16 v[84:87], a[72:75], a[56:59], v[84:87]
buffer_load_dwordx4 v14, s[56:59], s64 offen lds
v_mfma_f32_16x16x32_bf16 v[148:151], a[80:83], a[56:59], v[148:151]
ds_read_b64_tr_b16 a[72:73], v19 offset:32768
v_mfma_f32_16x16x32_bf16 v[148:151], a[84:87], a[60:63], v[148:151]
ds_read_b64_tr_b16 a[74:75], v19 offset:33024
v_mfma_f32_16x16x32_bf16 v[132:135], a[84:87], a[52:55], v[132:135]
ds_read_b64_tr_b16 a[76:77], v19 offset:34816
v_mfma_f32_16x16x32_bf16 v[132:135], a[80:83], a[48:51], v[132:135]
ds_read_b64_tr_b16 a[78:79], v19 offset:35072
v_mfma_f32_16x16x32_bf16 v[116:119], a[80:83], a[40:43], v[116:119]
v_mfma_f32_16x16x32_bf16 v[116:119], a[84:87], a[44:47], v[116:119]
v_mfma_f32_16x16x32_bf16 v[100:103], a[84:87], a[36:39], v[100:103]
s_add_u32 m0, s78, 118784
v_mfma_f32_16x16x32_bf16 v[100:103], a[80:83], a[32:35], v[100:103]
s_waitcnt lgkmcnt(4)
s_add_u32 s64, s75, 3147776
ds_read_b64_tr_b16 a[80:81], v20 offset:32768
v_mfma_f32_16x16x32_bf16 v[184:187], a[88:91], a[0:3], v[184:187]
buffer_load_dwordx4 v23, s[60:63], s64 offen lds
v_mfma_f32_16x16x32_bf16 v[184:187], a[92:95], a[4:7], v[184:187]
ds_read_b64_tr_b16 a[82:83], v20 offset:33024
v_mfma_f32_16x16x32_bf16 v[192:195], a[92:95], a[12:15], v[192:195]
ds_read_b64_tr_b16 a[84:85], v20 offset:34816
v_mfma_f32_16x16x32_bf16 v[192:195], a[88:91], a[8:11], v[192:195]
s_add_u32 s17, s78, .-L_pc+6144
ds_read_b64_tr_b16 a[86:87], v20 offset:35072
v_mfma_f32_16x16x32_bf16 v[200:203], a[88:91], a[16:19], v[200:203]
buffer_load_dword a252, v16, s[88:91], s17 offen
v_mfma_f32_16x16x32_bf16 v[200:203], a[92:95], a[20:23], v[200:203]
v_mfma_f32_16x16x32_bf16 v[208:211], a[92:95], a[28:31], v[208:211]
v_mfma_f32_16x16x32_bf16 v[208:211], a[88:91], a[24:27], v[208:211]
ds_read_b64_tr_b16 a[88:89], v4 offset:32768
v_mfma_f32_16x16x32_bf16 v[212:215], a[96:99], a[24:27], v[212:215]
s_add_u32 m0, s77, 100352
ds_read_b64_tr_b16 a[90:91], v4 offset:33792
v_mfma_f32_16x16x32_bf16 v[212:215], a[100:103], a[28:31], v[212:215]
s_add_u32 s64, s71, 4259840
ds_read_b64_tr_b16 a[92:93], v4 offset:40960
v_mfma_f32_16x16x32_bf16 v[204:207], a[100:103], a[20:23], v[204:207]
buffer_load_dwordx4 v15, s[56:59], s64 offen lds
v_mfma_f32_16x16x32_bf16 v[204:207], a[96:99], a[16:19], v[204:207]
ds_read_b64_tr_b16 a[94:95], v4 offset:41984
v_mfma_f32_16x16x32_bf16 v[196:199], a[96:99], a[8:11], v[196:199]
v_mfma_f32_16x16x32_bf16 v[196:199], a[100:103], a[12:15], v[196:199]
v_mfma_f32_16x16x32_bf16 v[188:191], a[100:103], a[4:7], v[188:191]
v_mfma_f32_16x16x32_bf16 v[188:191], a[96:99], a[0:3], v[188:191]
ds_read_b64_tr_b16 a[96:97], v5 offset:32768
v_mfma_f32_16x16x32_bf16 v[216:219], a[0:3], a[104:107], v[216:219]
ds_read_b64_tr_b16 a[98:99], v5 offset:33792
v_mfma_f32_16x16x32_bf16 v[216:219], a[4:7], a[108:111], v[216:219]
s_add_u32 m0, s78, 122880
ds_read_b64_tr_b16 a[100:101], v5 offset:40960
v_mfma_f32_16x16x32_bf16 v[224:227], a[12:15], a[108:111], v[224:227]
s_add_u32 s64, s75, 3149824
ds_read_b64_tr_b16 a[102:103], v5 offset:41984
v_mfma_f32_16x16x32_bf16 v[224:227], a[8:11], a[104:107], v[224:227]
buffer_load_dwordx4 v23, s[60:63], s64 offen lds
v_mfma_f32_16x16x32_bf16 v[232:235], a[16:19], a[104:107], v[232:235]
v_mfma_f32_16x16x32_bf16 v[232:235], a[20:23], a[108:111], v[232:235]
v_mfma_f32_16x16x32_bf16 v[240:243], a[28:31], a[108:111], v[240:243]
v_mfma_f32_16x16x32_bf16 v[240:243], a[24:27], a[104:107], v[240:243]
ds_read_b64_tr_b16 a[104:105], v6 offset:32768
v_mfma_f32_16x16x32_bf16 v[244:247], a[24:27], a[112:115], v[244:247]
ds_read_b64_tr_b16 a[106:107], v6 offset:33792
v_mfma_f32_16x16x32_bf16 v[244:247], a[28:31], a[116:119], v[244:247]
ds_read_b64_tr_b16 a[108:109], v6 offset:40960
v_subrev_u32 v19, 0x8000, v19
v_mfma_f32_16x16x32_bf16 v[236:239], a[20:23], a[116:119], v[236:239]
s_add_u32 m0, s77, 101376
ds_read_b64_tr_b16 a[110:111], v6 offset:41984
v_mfma_f32_16x16x32_bf16 v[236:239], a[16:19], a[112:115], v[236:239]
s_add_u32 s64, s71, 4292608
v_mfma_f32_16x16x32_bf16 v[228:231], a[8:11], a[112:115], v[228:231]
s_add_u32 s65, s79, 24576
buffer_load_dwordx4 v15, s[56:59], s64 offen lds
v_mfma_f32_16x16x32_bf16 v[228:231], a[12:15], a[116:119], v[228:231]
buffer_store_dwordx4 a[192:195], v16, s[44:47], s65 offen sc1
v_mfma_f32_16x16x32_bf16 v[220:223], a[4:7], a[116:119], v[220:223]
v_mfma_f32_16x16x32_bf16 v[220:223], a[0:3], a[112:115], v[220:223]
s_waitcnt lgkmcnt(4)
ds_read_b64_tr_b16 a[112:113], v7 offset:32768
v_mfma_f32_16x16x32_bf16 v[152:155], a[72:75], a[0:3], v[152:155]
ds_read_b64_tr_b16 a[114:115], v7 offset:33792
v_mfma_f32_16x16x32_bf16 v[152:155], a[76:79], a[4:7], v[152:155]
ds_read_b64_tr_b16 a[116:117], v7 offset:40960
v_subrev_u32 v20, 0x8000, v20
v_mfma_f32_16x16x32_bf16 v[160:163], a[76:79], a[12:15], v[160:163]
ds_read_b64_tr_b16 a[118:119], v7 offset:41984
v_mfma_f32_16x16x32_bf16 v[160:163], a[72:75], a[8:11], v[160:163]
v_mfma_f32_16x16x32_bf16 v[168:171], a[72:75], a[16:19], v[168:171]
v_mfma_f32_16x16x32_bf16 v[168:171], a[76:79], a[20:23], v[168:171]
v_mfma_f32_16x16x32_bf16 v[176:179], a[76:79], a[28:31], v[176:179]
s_add_u32 m0, s76, 0
v_mfma_f32_16x16x32_bf16 v[176:179], a[72:75], a[24:27], v[176:179]
s_add_u32 s64, s72, 1024
ds_read_b64_tr_b16 a[72:73], v8 offset:32768
v_mfma_f32_16x16x32_bf16 v[180:183], a[80:83], a[24:27], v[180:183]
buffer_load_dwordx4 v12, s[48:51], s64 offen lds
v_mfma_f32_16x16x32_bf16 v[180:183], a[84:87], a[28:31], v[180:183]
ds_read_b64_tr_b16 a[74:75], v8 offset:33792
v_subrev_u32 v4, 0x8000, v4
v_mfma_f32_16x16x32_bf16 v[172:175], a[84:87], a[20:23], v[172:175]
ds_read_b64_tr_b16 a[76:77], v8 offset:40960
v_mfma_f32_16x16x32_bf16 v[172:175], a[80:83], a[16:19], v[172:175]
s_add_u32 m0, s76, 1024
ds_read_b64_tr_b16 a[78:79], v8 offset:41984
v_mfma_f32_16x16x32_bf16 v[164:167], a[80:83], a[8:11], v[164:167]
s_add_u32 s64, s72, 17408
v_mfma_f32_16x16x32_bf16 v[164:167], a[84:87], a[12:15], v[164:167]
buffer_load_dwordx4 v13, s[48:51], s64 offen lds
v_mfma_f32_16x16x32_bf16 v[156:159], a[84:87], a[4:7], v[156:159]
v_mfma_f32_16x16x32_bf16 v[156:159], a[80:83], a[0:3], v[156:159]
ds_read_b64_tr_b16 a[80:81], v9 offset:32768
v_mfma_f32_16x16x32_bf16 v[24:27], a[88:91], a[0:3], v[24:27]
s_add_u32 m0, s76, 2048
ds_read_b64_tr_b16 a[82:83], v9 offset:33792
v_mfma_f32_16x16x32_bf16 v[24:27], a[92:95], a[4:7], v[24:27]
s_add_u32 s64, s72, 132096
ds_read_b64_tr_b16 a[84:85], v9 offset:40960
v_subrev_u32 v5, 0x8000, v5
v_mfma_f32_16x16x32_bf16 v[40:43], a[92:95], a[12:15], v[40:43]
buffer_load_dwordx4 v12, s[48:51], s64 offen lds
v_mfma_f32_16x16x32_bf16 v[40:43], a[88:91], a[8:11], v[40:43]
ds_read_b64_tr_b16 a[86:87], v9 offset:41984
v_mfma_f32_16x16x32_bf16 v[56:59], a[88:91], a[16:19], v[56:59]
v_mfma_f32_16x16x32_bf16 v[56:59], a[92:95], a[20:23], v[56:59]
s_add_u32 m0, s76, 3072
v_mfma_f32_16x16x32_bf16 v[72:75], a[92:95], a[28:31], v[72:75]
s_waitcnt vmcnt(13)
s_add_u32 s64, s72, 148480
ds_read_b128 a[32:35], v2 offset:32768
v_mfma_f32_16x16x32_bf16 v[72:75], a[88:91], a[24:27], v[72:75]
buffer_load_dwordx4 v13, s[48:51], s64 offen lds
v_mfma_f32_16x16x32_bf16 v[136:139], a[96:99], a[24:27], v[136:139]
ds_read_b128 a[36:39], v3 offset:32768
v_mfma_f32_16x16x32_bf16 v[136:139], a[100:103], a[28:31], v[136:139]
ds_read_b128 a[40:43], v2 offset:34816
v_subrev_u32 v6, 0x8000, v6
v_mfma_f32_16x16x32_bf16 v[120:123], a[100:103], a[20:23], v[120:123]
s_add_u32 m0, s76, 4096
ds_read_b128 a[44:47], v3 offset:34816
v_mfma_f32_16x16x32_bf16 v[120:123], a[96:99], a[16:19], v[120:123]
s_add_u32 s64, s73, 1024
ds_read_b128 a[48:51], v2 offset:36864
v_mfma_f32_16x16x32_bf16 v[104:107], a[96:99], a[8:11], v[104:107]
buffer_load_dwordx4 v12, s[48:51], s64 offen lds
v_mfma_f32_16x16x32_bf16 v[104:107], a[100:103], a[12:15], v[104:107]
ds_read_b128 a[52:55], v3 offset:36864
v_mfma_f32_16x16x32_bf16 v[88:91], a[100:103], a[4:7], v[88:91]
ds_read_b128 a[56:59], v2 offset:38912
v_mfma_f32_16x16x32_bf16 v[88:91], a[96:99], a[0:3], v[88:91]
s_waitcnt lgkmcnt(7)
s_add_u32 m0, s76, 5120
ds_read_b128 a[60:63], v3 offset:38912
v_mfma_f32_16x16x32_bf16 v[28:31], a[104:107], a[0:3], v[28:31]
s_add_u32 s64, s73, 17408
ds_read_b64_tr_b16 a[88:89], v10 offset:32768
v_mfma_f32_16x16x32_bf16 v[28:31], a[108:111], a[4:7], v[28:31]
buffer_load_dwordx4 v13, s[48:51], s64 offen lds
v_mfma_f32_16x16x32_bf16 v[44:47], a[108:111], a[12:15], v[44:47]
ds_read_b64_tr_b16 a[90:91], v10 offset:33792
v_subrev_u32 v7, 0x8000, v7
v_mfma_f32_16x16x32_bf16 v[44:47], a[104:107], a[8:11], v[44:47]
ds_read_b64_tr_b16 a[92:93], v10 offset:40960
v_mfma_f32_16x16x32_bf16 v[60:63], a[104:107], a[16:19], v[60:63]
s_add_u32 m0, s76, 6144
ds_read_b64_tr_b16 a[94:95], v10 offset:41984
v_mfma_f32_16x16x32_bf16 v[60:63], a[108:111], a[20:23], v[60:63]
s_add_u32 s64, s73, 132096
ds_read_b64_tr_b16 a[96:97], v11 offset:32768
v_mfma_f32_16x16x32_bf16 v[76:79], a[108:111], a[28:31], v[76:79]
buffer_load_dwordx4 v12, s[48:51], s64 offen lds
v_mfma_f32_16x16x32_bf16 v[76:79], a[104:107], a[24:27], v[76:79]
ds_read_b64_tr_b16 a[98:99], v11 offset:33792
v_mfma_f32_16x16x32_bf16 v[140:143], a[112:115], a[24:27], v[140:143]
ds_read_b64_tr_b16 a[100:101], v11 offset:40960
v_mfma_f32_16x16x32_bf16 v[140:143], a[116:119], a[28:31], v[140:143]
s_add_u32 m0, s76, 7168
ds_read_b64_tr_b16 a[102:103], v11 offset:41984
v_subrev_u32 v8, 0x8000, v8
v_mfma_f32_16x16x32_bf16 v[124:127], a[116:119], a[20:23], v[124:127]
s_add_u32 s64, s73, 148480
v_mfma_f32_16x16x32_bf16 v[124:127], a[112:115], a[16:19], v[124:127]
buffer_load_dwordx4 v13, s[48:51], s64 offen lds
v_mfma_f32_16x16x32_bf16 v[108:111], a[112:115], a[8:11], v[108:111]
v_mfma_f32_16x16x32_bf16 v[108:111], a[116:119], a[12:15], v[108:111]
v_mfma_f32_16x16x32_bf16 v[92:95], a[116:119], a[4:7], v[92:95]
v_subrev_u32 v9, 0x8000, v9
v_subrev_u32 v10, 0x8000, v10
v_mfma_f32_16x16x32_bf16 v[92:95], a[112:115], a[0:3], v[92:95]
s_add_u32 s65, s79, 25600
v_subrev_u32 v11, 0x8000, v11
v_mfma_f32_16x16x32_bf16 v[32:35], a[72:75], a[0:3], v[32:35]
buffer_store_dwordx4 a[196:199], v16, s[44:47], s65 offen sc1
v_mfma_f32_16x16x32_bf16 v[32:35], a[76:79], a[4:7], v[32:35]
v_mfma_f32_16x16x32_bf16 v[48:51], a[76:79], a[12:15], v[48:51]
s_waitcnt lgkmcnt(0)
s_barrier
v_mfma_f32_16x16x32_bf16 v[48:51], a[72:75], a[8:11], v[48:51]
s_add_u32 m0, s77, 131072
ds_read_b64_tr_b16 a[104:105], v19 offset:4096
v_mfma_f32_16x16x32_bf16 v[64:67], a[72:75], a[16:19], v[64:67]
s_add_u32 s64, s71, 4718592
ds_read_b64_tr_b16 a[106:107], v19 offset:4352
v_mfma_f32_16x16x32_bf16 v[64:67], a[76:79], a[20:23], v[64:67]
buffer_load_dwordx4 v14, s[56:59], s64 offen lds
v_mfma_f32_16x16x32_bf16 v[80:83], a[76:79], a[28:31], v[80:83]
ds_read_b64_tr_b16 a[108:109], v19 offset:6144
v_mfma_f32_16x16x32_bf16 v[80:83], a[72:75], a[24:27], v[80:83]
ds_read_b64_tr_b16 a[110:111], v19 offset:6400
v_mfma_f32_16x16x32_bf16 v[144:147], a[80:83], a[24:27], v[144:147]
ds_read_b64_tr_b16 a[112:113], v20 offset:4096
v_mfma_f32_16x16x32_bf16 v[144:147], a[84:87], a[28:31], v[144:147]
ds_read_b64_tr_b16 a[114:115], v20 offset:4352
v_mfma_f32_16x16x32_bf16 v[128:131], a[84:87], a[20:23], v[128:131]
ds_read_b64_tr_b16 a[116:117], v20 offset:6144
v_mfma_f32_16x16x32_bf16 v[128:131], a[80:83], a[16:19], v[128:131]
ds_read_b64_tr_b16 a[118:119], v20 offset:6400
v_mfma_f32_16x16x32_bf16 v[112:115], a[80:83], a[8:11], v[112:115]
s_add_u32 m0, s78, 147456
ds_read_b64_tr_b16 a[72:73], v19 offset:8192
v_mfma_f32_16x16x32_bf16 v[112:115], a[84:87], a[12:15], v[112:115]
s_add_u32 s64, s75, 3538944
ds_read_b64_tr_b16 a[74:75], v19 offset:8448
v_mfma_f32_16x16x32_bf16 v[96:99], a[84:87], a[4:7], v[96:99]
buffer_load_dwordx4 v23, s[60:63], s64 offen lds
v_mfma_f32_16x16x32_bf16 v[96:99], a[80:83], a[0:3], v[96:99]
ds_read_b64_tr_b16 a[76:77], v19 offset:10240
v_mfma_f32_16x16x32_bf16 v[36:39], a[88:91], a[0:3], v[36:39]
ds_read_b64_tr_b16 a[78:79], v19 offset:10496
v_mfma_f32_16x16x32_bf16 v[36:39], a[92:95], a[4:7], v[36:39]
ds_read_b64_tr_b16 a[80:81], v20 offset:8192
v_mfma_f32_16x16x32_bf16 v[52:55], a[92:95], a[12:15], v[52:55]
ds_read_b64_tr_b16 a[82:83], v20 offset:8448
v_mfma_f32_16x16x32_bf16 v[52:55], a[88:91], a[8:11], v[52:55]
ds_read_b64_tr_b16 a[84:85], v20 offset:10240
v_mfma_f32_16x16x32_bf16 v[68:71], a[88:91], a[16:19], v[68:71]
ds_read_b64_tr_b16 a[86:87], v20 offset:10496
v_mfma_f32_16x16x32_bf16 v[68:71], a[92:95], a[20:23], v[68:71]
s_add_u32 m0, s77, 132096
v_mfma_f32_16x16x32_bf16 v[84:87], a[92:95], a[28:31], v[84:87]
s_add_u32 s64, s71, 4751360
v_mfma_f32_16x16x32_bf16 v[84:87], a[88:91], a[24:27], v[84:87]
buffer_load_dwordx4 v14, s[56:59], s64 offen lds
v_mfma_f32_16x16x32_bf16 v[148:151], a[96:99], a[24:27], v[148:151]
ds_read_b64_tr_b16 a[88:89], v19 offset:0
v_mfma_f32_16x16x32_bf16 v[148:151], a[100:103], a[28:31], v[148:151]
ds_read_b64_tr_b16 a[90:91], v19 offset:256
v_mfma_f32_16x16x32_bf16 v[132:135], a[100:103], a[20:23], v[132:135]
ds_read_b64_tr_b16 a[92:93], v19 offset:2048
v_mfma_f32_16x16x32_bf16 v[132:135], a[96:99], a[16:19], v[132:135]
ds_read_b64_tr_b16 a[94:95], v19 offset:2304
v_mfma_f32_16x16x32_bf16 v[116:119], a[96:99], a[8:11], v[116:119]
v_mfma_f32_16x16x32_bf16 v[116:119], a[100:103], a[12:15], v[116:119]
v_mfma_f32_16x16x32_bf16 v[100:103], a[100:103], a[4:7], v[100:103]
s_add_u32 m0, s78, 151552
v_mfma_f32_16x16x32_bf16 v[100:103], a[96:99], a[0:3], v[100:103]
s_waitcnt lgkmcnt(4)
s_add_u32 s64, s75, 3540992
ds_read_b64_tr_b16 a[96:97], v20 offset:0
v_mfma_f32_16x16x32_bf16 v[184:187], a[104:107], a[32:35], v[184:187]
buffer_load_dwordx4 v23, s[60:63], s64 offen lds
v_mfma_f32_16x16x32_bf16 v[184:187], a[108:111], a[36:39], v[184:187]
ds_read_b64_tr_b16 a[98:99], v20 offset:256
v_mfma_f32_16x16x32_bf16 v[192:195], a[108:111], a[44:47], v[192:195]
ds_read_b64_tr_b16 a[100:101], v20 offset:2048
v_mfma_f32_16x16x32_bf16 v[192:195], a[104:107], a[40:43], v[192:195]
ds_read_b64_tr_b16 a[102:103], v20 offset:2304
v_mfma_f32_16x16x32_bf16 v[200:203], a[104:107], a[48:51], v[200:203]
v_mfma_f32_16x16x32_bf16 v[200:203], a[108:111], a[52:55], v[200:203]
v_mfma_f32_16x16x32_bf16 v[208:211], a[108:111], a[60:63], v[208:211]
v_mfma_f32_16x16x32_bf16 v[208:211], a[104:107], a[56:59], v[208:211]
ds_read_b64_tr_b16 a[104:105], v4 offset:0
v_mfma_f32_16x16x32_bf16 v[212:215], a[112:115], a[56:59], v[212:215]
s_add_u32 m0, s77, 133120
ds_read_b64_tr_b16 a[106:107], v4 offset:1024
v_mfma_f32_16x16x32_bf16 v[212:215], a[116:119], a[60:63], v[212:215]
s_add_u32 s64, s71, 4784128
ds_read_b64_tr_b16 a[108:109], v4 offset:8192
v_mfma_f32_16x16x32_bf16 v[204:207], a[116:119], a[52:55], v[204:207]
buffer_load_dwordx4 v15, s[56:59], s64 offen lds
v_mfma_f32_16x16x32_bf16 v[204:207], a[112:115], a[48:51], v[204:207]
ds_read_b64_tr_b16 a[110:111], v4 offset:9216
v_mfma_f32_16x16x32_bf16 v[196:199], a[112:115], a[40:43], v[196:199]
v_mfma_f32_16x16x32_bf16 v[196:199], a[116:119], a[44:47], v[196:199]
v_mfma_f32_16x16x32_bf16 v[188:191], a[116:119], a[36:39], v[188:191]
s_add_u32 s65, s79, 9216
v_mfma_f32_16x16x32_bf16 v[188:191], a[112:115], a[32:35], v[188:191]
buffer_store_dwordx4 a[200:203], v16, s[44:47], s65 offen sc1
v_mfma_f32_16x16x32_bf16 v[216:219], a[32:35], a[72:75], v[216:219]
ds_read_b64_tr_b16 a[112:113], v5 offset:0
v_mfma_f32_16x16x32_bf16 v[216:219], a[36:39], a[76:79], v[216:219]
s_add_u32 m0, s78, 155648
ds_read_b64_tr_b16 a[114:115], v5 offset:1024
v_mfma_f32_16x16x32_bf16 v[224:227], a[44:47], a[76:79], v[224:227]
s_add_u32 s64, s75, 3543040
ds_read_b64_tr_b16 a[116:117], v5 offset:8192
v_mfma_f32_16x16x32_bf16 v[224:227], a[40:43], a[72:75], v[224:227]
buffer_load_dwordx4 v23, s[60:63], s64 offen lds
v_mfma_f32_16x16x32_bf16 v[232:235], a[48:51], a[72:75], v[232:235]
ds_read_b64_tr_b16 a[118:119], v5 offset:9216
v_mfma_f32_16x16x32_bf16 v[232:235], a[52:55], a[76:79], v[232:235]
v_mfma_f32_16x16x32_bf16 v[240:243], a[60:63], a[76:79], v[240:243]
v_mfma_f32_16x16x32_bf16 v[240:243], a[56:59], a[72:75], v[240:243]
ds_read_b64_tr_b16 a[72:73], v6 offset:0
v_mfma_f32_16x16x32_bf16 v[244:247], a[56:59], a[80:83], v[244:247]
ds_read_b64_tr_b16 a[74:75], v6 offset:1024
v_mfma_f32_16x16x32_bf16 v[244:247], a[60:63], a[84:87], v[244:247]
ds_read_b64_tr_b16 a[76:77], v6 offset:8192
v_mfma_f32_16x16x32_bf16 v[236:239], a[52:55], a[84:87], v[236:239]
s_add_u32 m0, s77, 134144
ds_read_b64_tr_b16 a[78:79], v6 offset:9216
v_mfma_f32_16x16x32_bf16 v[236:239], a[48:51], a[80:83], v[236:239]
s_add_u32 s64, s71, 4816896
v_mfma_f32_16x16x32_bf16 v[228:231], a[40:43], a[80:83], v[228:231]
buffer_load_dwordx4 v15, s[56:59], s64 offen lds
v_mfma_f32_16x16x32_bf16 v[228:231], a[44:47], a[84:87], v[228:231]
v_mfma_f32_16x16x32_bf16 v[220:223], a[36:39], a[84:87], v[220:223]
v_mfma_f32_16x16x32_bf16 v[220:223], a[32:35], a[80:83], v[220:223]
s_waitcnt lgkmcnt(4)
ds_read_b64_tr_b16 a[80:81], v7 offset:0
v_mfma_f32_16x16x32_bf16 v[152:155], a[88:91], a[32:35], v[152:155]
ds_read_b64_tr_b16 a[82:83], v7 offset:1024
v_mfma_f32_16x16x32_bf16 v[152:155], a[92:95], a[36:39], v[152:155]
ds_read_b64_tr_b16 a[84:85], v7 offset:8192
v_mfma_f32_16x16x32_bf16 v[160:163], a[92:95], a[44:47], v[160:163]
ds_read_b64_tr_b16 a[86:87], v7 offset:9216
v_mfma_f32_16x16x32_bf16 v[160:163], a[88:91], a[40:43], v[160:163]
v_mfma_f32_16x16x32_bf16 v[168:171], a[88:91], a[48:51], v[168:171]
v_mfma_f32_16x16x32_bf16 v[168:171], a[92:95], a[52:55], v[168:171]
v_mfma_f32_16x16x32_bf16 v[176:179], a[92:95], a[60:63], v[176:179]
s_add_u32 m0, s76, 32768
v_mfma_f32_16x16x32_bf16 v[176:179], a[88:91], a[56:59], v[176:179]
s_add_u32 s64, s72, 1152
ds_read_b64_tr_b16 a[88:89], v8 offset:0
v_mfma_f32_16x16x32_bf16 v[180:183], a[96:99], a[56:59], v[180:183]
buffer_load_dwordx4 v12, s[48:51], s64 offen lds
v_mfma_f32_16x16x32_bf16 v[180:183], a[100:103], a[60:63], v[180:183]
ds_read_b64_tr_b16 a[90:91], v8 offset:1024
v_mfma_f32_16x16x32_bf16 v[172:175], a[100:103], a[52:55], v[172:175]
ds_read_b64_tr_b16 a[92:93], v8 offset:8192
v_mfma_f32_16x16x32_bf16 v[172:175], a[96:99], a[48:51], v[172:175]
s_add_u32 m0, s76, 33792
ds_read_b64_tr_b16 a[94:95], v8 offset:9216
v_mfma_f32_16x16x32_bf16 v[164:167], a[96:99], a[40:43], v[164:167]
s_add_u32 s64, s72, 17536
v_mfma_f32_16x16x32_bf16 v[164:167], a[100:103], a[44:47], v[164:167]
buffer_load_dwordx4 v13, s[48:51], s64 offen lds
v_mfma_f32_16x16x32_bf16 v[156:159], a[100:103], a[36:39], v[156:159]
v_mfma_f32_16x16x32_bf16 v[156:159], a[96:99], a[32:35], v[156:159]
ds_read_b64_tr_b16 a[96:97], v9 offset:0
v_mfma_f32_16x16x32_bf16 v[24:27], a[104:107], a[32:35], v[24:27]
s_add_u32 m0, s76, 34816
ds_read_b64_tr_b16 a[98:99], v9 offset:1024
v_mfma_f32_16x16x32_bf16 v[24:27], a[108:111], a[36:39], v[24:27]
s_add_u32 s64, s72, 132224
ds_read_b64_tr_b16 a[100:101], v9 offset:8192
v_mfma_f32_16x16x32_bf16 v[40:43], a[108:111], a[44:47], v[40:43]
buffer_load_dwordx4 v12, s[48:51], s64 offen lds
v_mfma_f32_16x16x32_bf16 v[40:43], a[104:107], a[40:43], v[40:43]
ds_read_b64_tr_b16 a[102:103], v9 offset:9216
v_mfma_f32_16x16x32_bf16 v[56:59], a[104:107], a[48:51], v[56:59]
v_mfma_f32_16x16x32_bf16 v[56:59], a[108:111], a[52:55], v[56:59]
s_add_u32 m0, s76, 35840
v_mfma_f32_16x16x32_bf16 v[72:75], a[108:111], a[60:63], v[72:75]
s_waitcnt vmcnt(12)
s_add_u32 s64, s72, 148608
ds_read_b128 a[0:3], v2 offset:0
v_mfma_f32_16x16x32_bf16 v[72:75], a[104:107], a[56:59], v[72:75]
buffer_load_dwordx4 v13, s[48:51], s64 offen lds
v_mfma_f32_16x16x32_bf16 v[136:139], a[112:115], a[56:59], v[136:139]
ds_read_b128 a[4:7], v3 offset:0
v_mfma_f32_16x16x32_bf16 v[136:139], a[116:119], a[60:63], v[136:139]
ds_read_b128 a[8:11], v2 offset:2048
v_mfma_f32_16x16x32_bf16 v[120:123], a[116:119], a[52:55], v[120:123]
s_add_u32 m0, s76, 36864
ds_read_b128 a[12:15], v3 offset:2048
v_mfma_f32_16x16x32_bf16 v[120:123], a[112:115], a[48:51], v[120:123]
s_add_u32 s64, s73, 1152
ds_read_b128 a[16:19], v2 offset:4096
v_mfma_f32_16x16x32_bf16 v[104:107], a[112:115], a[40:43], v[104:107]
buffer_load_dwordx4 v12, s[48:51], s64 offen lds
v_mfma_f32_16x16x32_bf16 v[104:107], a[116:119], a[44:47], v[104:107]
ds_read_b128 a[20:23], v3 offset:4096
v_mfma_f32_16x16x32_bf16 v[88:91], a[116:119], a[36:39], v[88:91]
ds_read_b128 a[24:27], v2 offset:6144
v_mfma_f32_16x16x32_bf16 v[88:91], a[112:115], a[32:35], v[88:91]
s_waitcnt lgkmcnt(7)
s_add_u32 m0, s76, 37888
ds_read_b128 a[28:31], v3 offset:6144
v_mfma_f32_16x16x32_bf16 v[28:31], a[72:75], a[32:35], v[28:31]
s_add_u32 s64, s73, 17536
ds_read_b64_tr_b16 a[104:105], v10 offset:0
v_mfma_f32_16x16x32_bf16 v[28:31], a[76:79], a[36:39], v[28:31]
s_add_u32 s65, s79, 26624
buffer_load_dwordx4 v13, s[48:51], s64 offen lds
v_mfma_f32_16x16x32_bf16 v[44:47], a[76:79], a[44:47], v[44:47]
buffer_store_dwordx4 a[204:207], v16, s[44:47], s65 offen sc1
v_mfma_f32_16x16x32_bf16 v[44:47], a[72:75], a[40:43], v[44:47]
ds_read_b64_tr_b16 a[106:107], v10 offset:1024
v_mfma_f32_16x16x32_bf16 v[60:63], a[72:75], a[48:51], v[60:63]
s_add_u32 m0, s76, 38912
ds_read_b64_tr_b16 a[108:109], v10 offset:8192
v_mfma_f32_16x16x32_bf16 v[60:63], a[76:79], a[52:55], v[60:63]
s_add_u32 s64, s73, 132224
ds_read_b64_tr_b16 a[110:111], v10 offset:9216
v_mfma_f32_16x16x32_bf16 v[76:79], a[76:79], a[60:63], v[76:79]
buffer_load_dwordx4 v12, s[48:51], s64 offen lds
v_mfma_f32_16x16x32_bf16 v[76:79], a[72:75], a[56:59], v[76:79]
ds_read_b64_tr_b16 a[112:113], v11 offset:0
v_mfma_f32_16x16x32_bf16 v[140:143], a[80:83], a[56:59], v[140:143]
ds_read_b64_tr_b16 a[114:115], v11 offset:1024
v_mfma_f32_16x16x32_bf16 v[140:143], a[84:87], a[60:63], v[140:143]
s_add_u32 m0, s76, 39936
ds_read_b64_tr_b16 a[116:117], v11 offset:8192
v_mfma_f32_16x16x32_bf16 v[124:127], a[84:87], a[52:55], v[124:127]
s_add_u32 s64, s73, 148608
ds_read_b64_tr_b16 a[118:119], v11 offset:9216
v_mfma_f32_16x16x32_bf16 v[124:127], a[80:83], a[48:51], v[124:127]
buffer_load_dwordx4 v13, s[48:51], s64 offen lds
v_mfma_f32_16x16x32_bf16 v[108:111], a[80:83], a[40:43], v[108:111]
v_mfma_f32_16x16x32_bf16 v[108:111], a[84:87], a[44:47], v[108:111]
v_mfma_f32_16x16x32_bf16 v[92:95], a[84:87], a[36:39], v[92:95]
v_mfma_f32_16x16x32_bf16 v[92:95], a[80:83], a[32:35], v[92:95]
v_mfma_f32_16x16x32_bf16 v[32:35], a[88:91], a[32:35], v[32:35]
v_mfma_f32_16x16x32_bf16 v[32:35], a[92:95], a[36:39], v[32:35]
v_mfma_f32_16x16x32_bf16 v[48:51], a[92:95], a[44:47], v[48:51]
s_waitcnt lgkmcnt(0)
s_barrier
v_mfma_f32_16x16x32_bf16 v[48:51], a[88:91], a[40:43], v[48:51]
s_add_u32 m0, s77, 65536
ds_read_b64_tr_b16 a[72:73], v19 offset:36864
v_mfma_f32_16x16x32_bf16 v[64:67], a[88:91], a[48:51], v[64:67]
s_add_u32 s64, s71, 5242880
ds_read_b64_tr_b16 a[74:75], v19 offset:37120
v_mfma_f32_16x16x32_bf16 v[64:67], a[92:95], a[52:55], v[64:67]
buffer_load_dwordx4 v14, s[56:59], s64 offen lds
v_mfma_f32_16x16x32_bf16 v[80:83], a[92:95], a[60:63], v[80:83]
ds_read_b64_tr_b16 a[76:77], v19 offset:38912
v_mfma_f32_16x16x32_bf16 v[80:83], a[88:91], a[56:59], v[80:83]
ds_read_b64_tr_b16 a[78:79], v19 offset:39168
v_mfma_f32_16x16x32_bf16 v[144:147], a[96:99], a[56:59], v[144:147]
ds_read_b64_tr_b16 a[80:81], v20 offset:36864
v_mfma_f32_16x16x32_bf16 v[144:147], a[100:103], a[60:63], v[144:147]
ds_read_b64_tr_b16 a[82:83], v20 offset:37120
v_mfma_f32_16x16x32_bf16 v[128:131], a[100:103], a[52:55], v[128:131]
ds_read_b64_tr_b16 a[84:85], v20 offset:38912
v_mfma_f32_16x16x32_bf16 v[128:131], a[96:99], a[48:51], v[128:131]
ds_read_b64_tr_b16 a[86:87], v20 offset:39168
v_mfma_f32_16x16x32_bf16 v[112:115], a[96:99], a[40:43], v[112:115]
s_add_u32 m0, s78, 81920
ds_read_b64_tr_b16 a[88:89], v19 offset:40960
v_mfma_f32_16x16x32_bf16 v[112:115], a[100:103], a[44:47], v[112:115]
s_add_u32 s64, s75, 3932160
ds_read_b64_tr_b16 a[90:91], v19 offset:41216
v_mfma_f32_16x16x32_bf16 v[96:99], a[100:103], a[36:39], v[96:99]
buffer_load_dwordx4 v23, s[60:63], s64 offen lds
v_mfma_f32_16x16x32_bf16 v[96:99], a[96:99], a[32:35], v[96:99]
ds_read_b64_tr_b16 a[92:93], v19 offset:43008
v_mfma_f32_16x16x32_bf16 v[36:39], a[104:107], a[32:35], v[36:39]
ds_read_b64_tr_b16 a[94:95], v19 offset:43264
v_mfma_f32_16x16x32_bf16 v[36:39], a[108:111], a[36:39], v[36:39]
ds_read_b64_tr_b16 a[96:97], v20 offset:40960
v_mfma_f32_16x16x32_bf16 v[52:55], a[108:111], a[44:47], v[52:55]
ds_read_b64_tr_b16 a[98:99], v20 offset:41216
v_mfma_f32_16x16x32_bf16 v[52:55], a[104:107], a[40:43], v[52:55]
ds_read_b64_tr_b16 a[100:101], v20 offset:43008
v_mfma_f32_16x16x32_bf16 v[68:71], a[104:107], a[48:51], v[68:71]
ds_read_b64_tr_b16 a[102:103], v20 offset:43264
v_mfma_f32_16x16x32_bf16 v[68:71], a[108:111], a[52:55], v[68:71]
s_add_u32 m0, s77, 66560
v_mfma_f32_16x16x32_bf16 v[84:87], a[108:111], a[60:63], v[84:87]
s_add_u32 s64, s71, 5275648
v_mfma_f32_16x16x32_bf16 v[84:87], a[104:107], a[56:59], v[84:87]
buffer_load_dwordx4 v14, s[56:59], s64 offen lds
v_mfma_f32_16x16x32_bf16 v[148:151], a[112:115], a[56:59], v[148:151]
ds_read_b64_tr_b16 a[104:105], v19 offset:32768
v_mfma_f32_16x16x32_bf16 v[148:151], a[116:119], a[60:63], v[148:151]
ds_read_b64_tr_b16 a[106:107], v19 offset:33024
v_mfma_f32_16x16x32_bf16 v[132:135], a[116:119], a[52:55], v[132:135]
ds_read_b64_tr_b16 a[108:109], v19 offset:34816
v_mfma_f32_16x16x32_bf16 v[132:135], a[112:115], a[48:51], v[132:135]
ds_read_b64_tr_b16 a[110:111], v19 offset:35072
v_mfma_f32_16x16x32_bf16 v[116:119], a[112:115], a[40:43], v[116:119]
v_mfma_f32_16x16x32_bf16 v[116:119], a[116:119], a[44:47], v[116:119]
v_mfma_f32_16x16x32_bf16 v[100:103], a[116:119], a[36:39], v[100:103]
s_add_u32 m0, s78, 86016
v_mfma_f32_16x16x32_bf16 v[100:103], a[112:115], a[32:35], v[100:103]
s_waitcnt lgkmcnt(4)
s_add_u32 s64, s75, 3934208
ds_read_b64_tr_b16 a[112:113], v20 offset:32768
v_mfma_f32_16x16x32_bf16 v[184:187], a[72:75], a[0:3], v[184:187]
buffer_load_dwordx4 v23, s[60:63], s64 offen lds
v_mfma_f32_16x16x32_bf16 v[184:187], a[76:79], a[4:7], v[184:187]
s_add_u32 s65, s79, 27648
ds_read_b64_tr_b16 a[114:115], v20 offset:33024
v_mfma_f32_16x16x32_bf16 v[192:195], a[76:79], a[12:15], v[192:195]
buffer_store_dwordx4 a[208:211], v16, s[44:47], s65 offen sc1
v_mfma_f32_16x16x32_bf16 v[192:195], a[72:75], a[8:11], v[192:195]
s_add_u32 s17, s78, .-L_pc+6144
ds_read_b64_tr_b16 a[116:117], v20 offset:34816
v_mfma_f32_16x16x32_bf16 v[200:203], a[72:75], a[16:19], v[200:203]
buffer_load_dword a252, v16, s[88:91], s17 offen
v_mfma_f32_16x16x32_bf16 v[200:203], a[76:79], a[20:23], v[200:203]
ds_read_b64_tr_b16 a[118:119], v20 offset:35072
v_mfma_f32_16x16x32_bf16 v[208:211], a[76:79], a[28:31], v[208:211]
v_mfma_f32_16x16x32_bf16 v[208:211], a[72:75], a[24:27], v[208:211]
ds_read_b64_tr_b16 a[72:73], v4 offset:32768
v_mfma_f32_16x16x32_bf16 v[212:215], a[80:83], a[24:27], v[212:215]
s_add_u32 m0, s77, 67584
ds_read_b64_tr_b16 a[74:75], v4 offset:33792
v_mfma_f32_16x16x32_bf16 v[212:215], a[84:87], a[28:31], v[212:215]
s_add_u32 s64, s71, 5308416
ds_read_b64_tr_b16 a[76:77], v4 offset:40960
v_mfma_f32_16x16x32_bf16 v[204:207], a[84:87], a[20:23], v[204:207]
buffer_load_dwordx4 v15, s[56:59], s64 offen lds
v_mfma_f32_16x16x32_bf16 v[204:207], a[80:83], a[16:19], v[204:207]
ds_read_b64_tr_b16 a[78:79], v4 offset:41984
v_mfma_f32_16x16x32_bf16 v[196:199], a[80:83], a[8:11], v[196:199]
v_mfma_f32_16x16x32_bf16 v[196:199], a[84:87], a[12:15], v[196:199]
v_mfma_f32_16x16x32_bf16 v[188:191], a[84:87], a[4:7], v[188:191]
v_mfma_f32_16x16x32_bf16 v[188:191], a[80:83], a[0:3], v[188:191]
ds_read_b64_tr_b16 a[80:81], v5 offset:32768
v_mfma_f32_16x16x32_bf16 v[216:219], a[0:3], a[88:91], v[216:219]
ds_read_b64_tr_b16 a[82:83], v5 offset:33792
v_mfma_f32_16x16x32_bf16 v[216:219], a[4:7], a[92:95], v[216:219]
s_add_u32 m0, s78, 90112
ds_read_b64_tr_b16 a[84:85], v5 offset:40960
v_mfma_f32_16x16x32_bf16 v[224:227], a[12:15], a[92:95], v[224:227]
s_add_u32 s64, s75, 3936256
ds_read_b64_tr_b16 a[86:87], v5 offset:41984
v_mfma_f32_16x16x32_bf16 v[224:227], a[8:11], a[88:91], v[224:227]
buffer_load_dwordx4 v23, s[60:63], s64 offen lds
v_mfma_f32_16x16x32_bf16 v[232:235], a[16:19], a[88:91], v[232:235]
v_mfma_f32_16x16x32_bf16 v[232:235], a[20:23], a[92:95], v[232:235]
v_mfma_f32_16x16x32_bf16 v[240:243], a[28:31], a[92:95], v[240:243]
v_mfma_f32_16x16x32_bf16 v[240:243], a[24:27], a[88:91], v[240:243]
ds_read_b64_tr_b16 a[88:89], v6 offset:32768
v_mfma_f32_16x16x32_bf16 v[244:247], a[24:27], a[96:99], v[244:247]
ds_read_b64_tr_b16 a[90:91], v6 offset:33792
v_mfma_f32_16x16x32_bf16 v[244:247], a[28:31], a[100:103], v[244:247]
ds_read_b64_tr_b16 a[92:93], v6 offset:40960
v_add_u32 v19, 0x8000, v19
v_mfma_f32_16x16x32_bf16 v[236:239], a[20:23], a[100:103], v[236:239]
s_add_u32 m0, s77, 68608
ds_read_b64_tr_b16 a[94:95], v6 offset:41984
v_mfma_f32_16x16x32_bf16 v[236:239], a[16:19], a[96:99], v[236:239]
s_add_u32 s64, s71, 5341184
v_mfma_f32_16x16x32_bf16 v[228:231], a[8:11], a[96:99], v[228:231]
buffer_load_dwordx4 v15, s[56:59], s64 offen lds
v_mfma_f32_16x16x32_bf16 v[228:231], a[12:15], a[100:103], v[228:231]
v_mfma_f32_16x16x32_bf16 v[220:223], a[4:7], a[100:103], v[220:223]
v_mfma_f32_16x16x32_bf16 v[220:223], a[0:3], a[96:99], v[220:223]
s_waitcnt lgkmcnt(4)
ds_read_b64_tr_b16 a[96:97], v7 offset:32768
v_mfma_f32_16x16x32_bf16 v[152:155], a[104:107], a[0:3], v[152:155]
ds_read_b64_tr_b16 a[98:99], v7 offset:33792
v_mfma_f32_16x16x32_bf16 v[152:155], a[108:111], a[4:7], v[152:155]
ds_read_b64_tr_b16 a[100:101], v7 offset:40960
v_add_u32 v20, 0x8000, v20
v_mfma_f32_16x16x32_bf16 v[160:163], a[108:111], a[12:15], v[160:163]
ds_read_b64_tr_b16 a[102:103], v7 offset:41984
v_mfma_f32_16x16x32_bf16 v[160:163], a[104:107], a[8:11], v[160:163]
v_mfma_f32_16x16x32_bf16 v[168:171], a[104:107], a[16:19], v[168:171]
v_mfma_f32_16x16x32_bf16 v[168:171], a[108:111], a[20:23], v[168:171]
v_mfma_f32_16x16x32_bf16 v[176:179], a[108:111], a[28:31], v[176:179]
s_add_u32 m0, s76, 0
v_mfma_f32_16x16x32_bf16 v[176:179], a[104:107], a[24:27], v[176:179]
s_add_u32 s64, s72, 1280
ds_read_b64_tr_b16 a[104:105], v8 offset:32768
v_mfma_f32_16x16x32_bf16 v[180:183], a[112:115], a[24:27], v[180:183]
buffer_load_dwordx4 v12, s[48:51], s64 offen lds
v_mfma_f32_16x16x32_bf16 v[180:183], a[116:119], a[28:31], v[180:183]
ds_read_b64_tr_b16 a[106:107], v8 offset:33792
v_add_u32 v4, 0x8000, v4
v_mfma_f32_16x16x32_bf16 v[172:175], a[116:119], a[20:23], v[172:175]
ds_read_b64_tr_b16 a[108:109], v8 offset:40960
v_mfma_f32_16x16x32_bf16 v[172:175], a[112:115], a[16:19], v[172:175]
s_add_u32 m0, s76, 1024
ds_read_b64_tr_b16 a[110:111], v8 offset:41984
v_mfma_f32_16x16x32_bf16 v[164:167], a[112:115], a[8:11], v[164:167]
s_add_u32 s64, s72, 17664
v_mfma_f32_16x16x32_bf16 v[164:167], a[116:119], a[12:15], v[164:167]
buffer_load_dwordx4 v13, s[48:51], s64 offen lds
v_mfma_f32_16x16x32_bf16 v[156:159], a[116:119], a[4:7], v[156:159]
v_mfma_f32_16x16x32_bf16 v[156:159], a[112:115], a[0:3], v[156:159]
ds_read_b64_tr_b16 a[112:113], v9 offset:32768
v_mfma_f32_16x16x32_bf16 v[24:27], a[72:75], a[0:3], v[24:27]
s_add_u32 m0, s76, 2048
ds_read_b64_tr_b16 a[114:115], v9 offset:33792
v_mfma_f32_16x16x32_bf16 v[24:27], a[76:79], a[4:7], v[24:27]
s_add_u32 s64, s72, 132352
ds_read_b64_tr_b16 a[116:117], v9 offset:40960
v_add_u32 v5, 0x8000, v5
v_mfma_f32_16x16x32_bf16 v[40:43], a[76:79], a[12:15], v[40:43]
buffer_load_dwordx4 v12, s[48:51], s64 offen lds
v_mfma_f32_16x16x32_bf16 v[40:43], a[72:75], a[8:11], v[40:43]
s_add_u32 s65, s79, 11264
ds_read_b64_tr_b16 a[118:119], v9 offset:41984
v_mfma_f32_16x16x32_bf16 v[56:59], a[72:75], a[16:19], v[56:59]
buffer_store_dwordx4 a[212:215], v16, s[44:47], s65 offen sc1
v_mfma_f32_16x16x32_bf16 v[56:59], a[76:79], a[20:23], v[56:59]
s_add_u32 m0, s76, 3072
v_mfma_f32_16x16x32_bf16 v[72:75], a[76:79], a[28:31], v[72:75]
s_waitcnt vmcnt(13)
s_add_u32 s64, s72, 148736
ds_read_b128 a[32:35], v2 offset:32768
v_mfma_f32_16x16x32_bf16 v[72:75], a[72:75], a[24:27], v[72:75]
buffer_load_dwordx4 v13, s[48:51], s64 offen lds
v_mfma_f32_16x16x32_bf16 v[136:139], a[80:83], a[24:27], v[136:139]
ds_read_b128 a[36:39], v3 offset:32768
v_mfma_f32_16x16x32_bf16 v[136:139], a[84:87], a[28:31], v[136:139]
ds_read_b128 a[40:43], v2 offset:34816
v_add_u32 v6, 0x8000, v6
v_mfma_f32_16x16x32_bf16 v[120:123], a[84:87], a[20:23], v[120:123]
s_add_u32 m0, s76, 4096
ds_read_b128 a[44:47], v3 offset:34816
v_mfma_f32_16x16x32_bf16 v[120:123], a[80:83], a[16:19], v[120:123]
s_add_u32 s64, s73, 1280
ds_read_b128 a[48:51], v2 offset:36864
v_mfma_f32_16x16x32_bf16 v[104:107], a[80:83], a[8:11], v[104:107]
buffer_load_dwordx4 v12, s[48:51], s64 offen lds
v_mfma_f32_16x16x32_bf16 v[104:107], a[84:87], a[12:15], v[104:107]
ds_read_b128 a[52:55], v3 offset:36864
v_mfma_f32_16x16x32_bf16 v[88:91], a[84:87], a[4:7], v[88:91]
ds_read_b128 a[56:59], v2 offset:38912
v_mfma_f32_16x16x32_bf16 v[88:91], a[80:83], a[0:3], v[88:91]
s_waitcnt lgkmcnt(7)
s_add_u32 m0, s76, 5120
ds_read_b128 a[60:63], v3 offset:38912
v_mfma_f32_16x16x32_bf16 v[28:31], a[88:91], a[0:3], v[28:31]
s_add_u32 s64, s73, 17664
ds_read_b64_tr_b16 a[72:73], v10 offset:32768
v_mfma_f32_16x16x32_bf16 v[28:31], a[92:95], a[4:7], v[28:31]
buffer_load_dwordx4 v13, s[48:51], s64 offen lds
v_mfma_f32_16x16x32_bf16 v[44:47], a[92:95], a[12:15], v[44:47]
ds_read_b64_tr_b16 a[74:75], v10 offset:33792
v_add_u32 v7, 0x8000, v7
v_mfma_f32_16x16x32_bf16 v[44:47], a[88:91], a[8:11], v[44:47]
ds_read_b64_tr_b16 a[76:77], v10 offset:40960
v_mfma_f32_16x16x32_bf16 v[60:63], a[88:91], a[16:19], v[60:63]
s_add_u32 m0, s76, 6144
ds_read_b64_tr_b16 a[78:79], v10 offset:41984
v_mfma_f32_16x16x32_bf16 v[60:63], a[92:95], a[20:23], v[60:63]
s_add_u32 s64, s73, 132352
ds_read_b64_tr_b16 a[80:81], v11 offset:32768
v_mfma_f32_16x16x32_bf16 v[76:79], a[92:95], a[28:31], v[76:79]
buffer_load_dwordx4 v12, s[48:51], s64 offen lds
v_mfma_f32_16x16x32_bf16 v[76:79], a[88:91], a[24:27], v[76:79]
ds_read_b64_tr_b16 a[82:83], v11 offset:33792
v_mfma_f32_16x16x32_bf16 v[140:143], a[96:99], a[24:27], v[140:143]
ds_read_b64_tr_b16 a[84:85], v11 offset:40960
v_mfma_f32_16x16x32_bf16 v[140:143], a[100:103], a[28:31], v[140:143]
s_add_u32 m0, s76, 7168
ds_read_b64_tr_b16 a[86:87], v11 offset:41984
v_add_u32 v8, 0x8000, v8
v_mfma_f32_16x16x32_bf16 v[124:127], a[100:103], a[20:23], v[124:127]
s_add_u32 s64, s73, 148736
v_mfma_f32_16x16x32_bf16 v[124:127], a[96:99], a[16:19], v[124:127]
buffer_load_dwordx4 v13, s[48:51], s64 offen lds
v_mfma_f32_16x16x32_bf16 v[108:111], a[96:99], a[8:11], v[108:111]
v_mfma_f32_16x16x32_bf16 v[108:111], a[100:103], a[12:15], v[108:111]
v_mfma_f32_16x16x32_bf16 v[92:95], a[100:103], a[4:7], v[92:95]
v_add_u32 v9, 0x8000, v9
v_add_u32 v10, 0x8000, v10
v_mfma_f32_16x16x32_bf16 v[92:95], a[96:99], a[0:3], v[92:95]
v_add_u32 v11, 0x8000, v11
v_mfma_f32_16x16x32_bf16 v[32:35], a[104:107], a[0:3], v[32:35]
v_mfma_f32_16x16x32_bf16 v[32:35], a[108:111], a[4:7], v[32:35]
v_mfma_f32_16x16x32_bf16 v[48:51], a[108:111], a[12:15], v[48:51]
s_waitcnt lgkmcnt(0)
s_barrier
v_mfma_f32_16x16x32_bf16 v[48:51], a[104:107], a[8:11], v[48:51]
s_add_u32 m0, s77, 98304
ds_read_b64_tr_b16 a[88:89], v19 offset:36864
v_mfma_f32_16x16x32_bf16 v[64:67], a[104:107], a[16:19], v[64:67]
s_add_u32 s64, s71, 5767168
ds_read_b64_tr_b16 a[90:91], v19 offset:37120
v_mfma_f32_16x16x32_bf16 v[64:67], a[108:111], a[20:23], v[64:67]
buffer_load_dwordx4 v14, s[56:59], s64 offen lds
v_mfma_f32_16x16x32_bf16 v[80:83], a[108:111], a[28:31], v[80:83]
ds_read_b64_tr_b16 a[92:93], v19 offset:38912
v_mfma_f32_16x16x32_bf16 v[80:83], a[104:107], a[24:27], v[80:83]
ds_read_b64_tr_b16 a[94:95], v19 offset:39168
v_mfma_f32_16x16x32_bf16 v[144:147], a[112:115], a[24:27], v[144:147]
ds_read_b64_tr_b16 a[96:97], v20 offset:36864
v_mfma_f32_16x16x32_bf16 v[144:147], a[116:119], a[28:31], v[144:147]
ds_read_b64_tr_b16 a[98:99], v20 offset:37120
v_mfma_f32_16x16x32_bf16 v[128:131], a[116:119], a[20:23], v[128:131]
ds_read_b64_tr_b16 a[100:101], v20 offset:38912
v_mfma_f32_16x16x32_bf16 v[128:131], a[112:115], a[16:19], v[128:131]
ds_read_b64_tr_b16 a[102:103], v20 offset:39168
v_mfma_f32_16x16x32_bf16 v[112:115], a[112:115], a[8:11], v[112:115]
s_add_u32 m0, s78, 114688
ds_read_b64_tr_b16 a[104:105], v19 offset:40960
v_mfma_f32_16x16x32_bf16 v[112:115], a[116:119], a[12:15], v[112:115]
s_add_u32 s64, s75, 4325376
ds_read_b64_tr_b16 a[106:107], v19 offset:41216
v_mfma_f32_16x16x32_bf16 v[96:99], a[116:119], a[4:7], v[96:99]
buffer_load_dwordx4 v23, s[60:63], s64 offen lds
v_mfma_f32_16x16x32_bf16 v[96:99], a[112:115], a[0:3], v[96:99]
ds_read_b64_tr_b16 a[108:109], v19 offset:43008
v_mfma_f32_16x16x32_bf16 v[36:39], a[72:75], a[0:3], v[36:39]
ds_read_b64_tr_b16 a[110:111], v19 offset:43264
v_mfma_f32_16x16x32_bf16 v[36:39], a[76:79], a[4:7], v[36:39]
ds_read_b64_tr_b16 a[112:113], v20 offset:40960
v_mfma_f32_16x16x32_bf16 v[52:55], a[76:79], a[12:15], v[52:55]
ds_read_b64_tr_b16 a[114:115], v20 offset:41216
v_mfma_f32_16x16x32_bf16 v[52:55], a[72:75], a[8:11], v[52:55]
ds_read_b64_tr_b16 a[116:117], v20 offset:43008
v_mfma_f32_16x16x32_bf16 v[68:71], a[72:75], a[16:19], v[68:71]
s_add_u32 s65, s79, 28672
ds_read_b64_tr_b16 a[118:119], v20 offset:43264
v_mfma_f32_16x16x32_bf16 v[68:71], a[76:79], a[20:23], v[68:71]
s_add_u32 m0, s77, 99328
buffer_store_dwordx4 a[216:219], v16, s[44:47], s65 offen sc1
v_mfma_f32_16x16x32_bf16 v[84:87], a[76:79], a[28:31], v[84:87]
s_add_u32 s64, s71, 5799936
v_mfma_f32_16x16x32_bf16 v[84:87], a[72:75], a[24:27], v[84:87]
buffer_load_dwordx4 v14, s[56:59], s64 offen lds
v_mfma_f32_16x16x32_bf16 v[148:151], a[80:83], a[24:27], v[148:151]
ds_read_b64_tr_b16 a[72:73], v19 offset:32768
v_mfma_f32_16x16x32_bf16 v[148:151], a[84:87], a[28:31], v[148:151]
ds_read_b64_tr_b16 a[74:75], v19 offset:33024
v_mfma_f32_16x16x32_bf16 v[132:135], a[84:87], a[20:23], v[132:135]
ds_read_b64_tr_b16 a[76:77], v19 offset:34816
v_mfma_f32_16x16x32_bf16 v[132:135], a[80:83], a[16:19], v[132:135]
ds_read_b64_tr_b16 a[78:79], v19 offset:35072
v_mfma_f32_16x16x32_bf16 v[116:119], a[80:83], a[8:11], v[116:119]
v_mfma_f32_16x16x32_bf16 v[116:119], a[84:87], a[12:15], v[116:119]
v_mfma_f32_16x16x32_bf16 v[100:103], a[84:87], a[4:7], v[100:103]
s_add_u32 m0, s78, 118784
v_mfma_f32_16x16x32_bf16 v[100:103], a[80:83], a[0:3], v[100:103]
s_waitcnt lgkmcnt(4)
s_add_u32 s64, s75, 4327424
ds_read_b64_tr_b16 a[80:81], v20 offset:32768
v_mfma_f32_16x16x32_bf16 v[184:187], a[88:91], a[32:35], v[184:187]
buffer_load_dwordx4 v23, s[60:63], s64 offen lds
v_mfma_f32_16x16x32_bf16 v[184:187], a[92:95], a[36:39], v[184:187]
ds_read_b64_tr_b16 a[82:83], v20 offset:33024
v_mfma_f32_16x16x32_bf16 v[192:195], a[92:95], a[44:47], v[192:195]
ds_read_b64_tr_b16 a[84:85], v20 offset:34816
v_mfma_f32_16x16x32_bf16 v[192:195], a[88:91], a[40:43], v[192:195]
ds_read_b64_tr_b16 a[86:87], v20 offset:35072
v_mfma_f32_16x16x32_bf16 v[200:203], a[88:91], a[48:51], v[200:203]
s_cmp_eq_u32 s30, 0
s_cselect_b32 s81, 256, 0
v_mfma_f32_16x16x32_bf16 v[200:203], a[92:95], a[52:55], v[200:203]
v_mfma_f32_16x16x32_bf16 v[208:211], a[92:95], a[60:63], v[208:211]
v_mfma_f32_16x16x32_bf16 v[208:211], a[88:91], a[56:59], v[208:211]
ds_read_b64_tr_b16 a[88:89], v4 offset:32768
v_mfma_f32_16x16x32_bf16 v[212:215], a[96:99], a[56:59], v[212:215]
s_add_u32 m0, s77, 100352
ds_read_b64_tr_b16 a[90:91], v4 offset:33792
v_mfma_f32_16x16x32_bf16 v[212:215], a[100:103], a[60:63], v[212:215]
s_add_u32 s64, s71, 5832704
ds_read_b64_tr_b16 a[92:93], v4 offset:40960
v_mfma_f32_16x16x32_bf16 v[204:207], a[100:103], a[52:55], v[204:207]
buffer_load_dwordx4 v15, s[56:59], s64 offen lds
v_mfma_f32_16x16x32_bf16 v[204:207], a[96:99], a[48:51], v[204:207]
ds_read_b64_tr_b16 a[94:95], v4 offset:41984
v_mfma_f32_16x16x32_bf16 v[196:199], a[96:99], a[40:43], v[196:199]
v_mfma_f32_16x16x32_bf16 v[196:199], a[100:103], a[44:47], v[196:199]
v_mfma_f32_16x16x32_bf16 v[188:191], a[100:103], a[36:39], v[188:191]
v_mfma_f32_16x16x32_bf16 v[188:191], a[96:99], a[32:35], v[188:191]
ds_read_b64_tr_b16 a[96:97], v5 offset:32768
v_mfma_f32_16x16x32_bf16 v[216:219], a[32:35], a[104:107], v[216:219]
ds_read_b64_tr_b16 a[98:99], v5 offset:33792
v_mfma_f32_16x16x32_bf16 v[216:219], a[36:39], a[108:111], v[216:219]
s_add_u32 m0, s78, 122880
ds_read_b64_tr_b16 a[100:101], v5 offset:40960
v_mfma_f32_16x16x32_bf16 v[224:227], a[44:47], a[108:111], v[224:227]
s_add_u32 s64, s75, 4329472
ds_read_b64_tr_b16 a[102:103], v5 offset:41984
v_mfma_f32_16x16x32_bf16 v[224:227], a[40:43], a[104:107], v[224:227]
buffer_load_dwordx4 v23, s[60:63], s64 offen lds
v_mfma_f32_16x16x32_bf16 v[232:235], a[48:51], a[104:107], v[232:235]
v_mfma_f32_16x16x32_bf16 v[232:235], a[52:55], a[108:111], v[232:235]
v_mfma_f32_16x16x32_bf16 v[240:243], a[60:63], a[108:111], v[240:243]
v_mfma_f32_16x16x32_bf16 v[240:243], a[56:59], a[104:107], v[240:243]
ds_read_b64_tr_b16 a[104:105], v6 offset:32768
v_mfma_f32_16x16x32_bf16 v[244:247], a[56:59], a[112:115], v[244:247]
ds_read_b64_tr_b16 a[106:107], v6 offset:33792
v_mfma_f32_16x16x32_bf16 v[244:247], a[60:63], a[116:119], v[244:247]
ds_read_b64_tr_b16 a[108:109], v6 offset:40960
v_subrev_u32 v19, 0x8000, v19
v_mfma_f32_16x16x32_bf16 v[236:239], a[52:55], a[116:119], v[236:239]
s_add_u32 m0, s77, 101376
ds_read_b64_tr_b16 a[110:111], v6 offset:41984
v_mfma_f32_16x16x32_bf16 v[236:239], a[48:51], a[112:115], v[236:239]
s_add_u32 s64, s71, 5865472
v_mfma_f32_16x16x32_bf16 v[228:231], a[40:43], a[112:115], v[228:231]
buffer_load_dwordx4 v15, s[56:59], s64 offen lds
v_mfma_f32_16x16x32_bf16 v[228:231], a[44:47], a[116:119], v[228:231]
v_mfma_f32_16x16x32_bf16 v[220:223], a[36:39], a[116:119], v[220:223]
v_mfma_f32_16x16x32_bf16 v[220:223], a[32:35], a[112:115], v[220:223]
s_waitcnt lgkmcnt(4)
ds_read_b64_tr_b16 a[112:113], v7 offset:32768
v_mfma_f32_16x16x32_bf16 v[152:155], a[72:75], a[32:35], v[152:155]
ds_read_b64_tr_b16 a[114:115], v7 offset:33792
v_mfma_f32_16x16x32_bf16 v[152:155], a[76:79], a[36:39], v[152:155]
ds_read_b64_tr_b16 a[116:117], v7 offset:40960
v_subrev_u32 v20, 0x8000, v20
v_mfma_f32_16x16x32_bf16 v[160:163], a[76:79], a[44:47], v[160:163]
ds_read_b64_tr_b16 a[118:119], v7 offset:41984
v_mfma_f32_16x16x32_bf16 v[160:163], a[72:75], a[40:43], v[160:163]
v_mfma_f32_16x16x32_bf16 v[168:171], a[72:75], a[48:51], v[168:171]
v_mfma_f32_16x16x32_bf16 v[168:171], a[76:79], a[52:55], v[168:171]
s_add_u32 s65, s79, 29696
v_mfma_f32_16x16x32_bf16 v[176:179], a[76:79], a[60:63], v[176:179]
s_add_u32 m0, s76, 32768
buffer_store_dwordx4 a[220:223], v16, s[44:47], s65 offen sc1
v_mfma_f32_16x16x32_bf16 v[176:179], a[72:75], a[56:59], v[176:179]
s_add_u32 s64, s72, 1408
ds_read_b64_tr_b16 a[72:73], v8 offset:32768
v_mfma_f32_16x16x32_bf16 v[180:183], a[80:83], a[56:59], v[180:183]
buffer_load_dwordx4 v12, s[48:51], s64 offen lds
v_mfma_f32_16x16x32_bf16 v[180:183], a[84:87], a[60:63], v[180:183]
ds_read_b64_tr_b16 a[74:75], v8 offset:33792
v_subrev_u32 v4, 0x8000, v4
v_mfma_f32_16x16x32_bf16 v[172:175], a[84:87], a[52:55], v[172:175]
ds_read_b64_tr_b16 a[76:77], v8 offset:40960
v_mfma_f32_16x16x32_bf16 v[172:175], a[80:83], a[48:51], v[172:175]
s_add_u32 m0, s76, 33792
ds_read_b64_tr_b16 a[78:79], v8 offset:41984
v_mfma_f32_16x16x32_bf16 v[164:167], a[80:83], a[40:43], v[164:167]
s_add_u32 s64, s72, 17792
v_mfma_f32_16x16x32_bf16 v[164:167], a[84:87], a[44:47], v[164:167]
buffer_load_dwordx4 v13, s[48:51], s64 offen lds
v_mfma_f32_16x16x32_bf16 v[156:159], a[84:87], a[36:39], v[156:159]
v_mfma_f32_16x16x32_bf16 v[156:159], a[80:83], a[32:35], v[156:159]
ds_read_b64_tr_b16 a[80:81], v9 offset:32768
v_mfma_f32_16x16x32_bf16 v[24:27], a[88:91], a[32:35], v[24:27]
s_add_u32 m0, s76, 34816
ds_read_b64_tr_b16 a[82:83], v9 offset:33792
v_mfma_f32_16x16x32_bf16 v[24:27], a[92:95], a[36:39], v[24:27]
s_add_u32 s64, s72, 132480
ds_read_b64_tr_b16 a[84:85], v9 offset:40960
v_subrev_u32 v5, 0x8000, v5
v_mfma_f32_16x16x32_bf16 v[40:43], a[92:95], a[44:47], v[40:43]
buffer_load_dwordx4 v12, s[48:51], s64 offen lds
v_mfma_f32_16x16x32_bf16 v[40:43], a[88:91], a[40:43], v[40:43]
ds_read_b64_tr_b16 a[86:87], v9 offset:41984
v_mfma_f32_16x16x32_bf16 v[56:59], a[88:91], a[48:51], v[56:59]
v_mfma_f32_16x16x32_bf16 v[56:59], a[92:95], a[52:55], v[56:59]
s_add_u32 m0, s76, 35840
v_mfma_f32_16x16x32_bf16 v[72:75], a[92:95], a[60:63], v[72:75]
s_waitcnt vmcnt(12)
s_add_u32 s64, s72, 148864
ds_read_b128 a[0:3], v2 offset:0
v_mfma_f32_16x16x32_bf16 v[72:75], a[88:91], a[56:59], v[72:75]
buffer_load_dwordx4 v13, s[48:51], s64 offen lds
v_mfma_f32_16x16x32_bf16 v[136:139], a[96:99], a[56:59], v[136:139]
ds_read_b128 a[4:7], v3 offset:0
v_mfma_f32_16x16x32_bf16 v[136:139], a[100:103], a[60:63], v[136:139]
ds_read_b128 a[8:11], v2 offset:2048
v_subrev_u32 v6, 0x8000, v6
v_mfma_f32_16x16x32_bf16 v[120:123], a[100:103], a[52:55], v[120:123]
s_add_u32 m0, s76, 36864
ds_read_b128 a[12:15], v3 offset:2048
v_mfma_f32_16x16x32_bf16 v[120:123], a[96:99], a[48:51], v[120:123]
s_add_u32 s64, s73, 1408
ds_read_b128 a[16:19], v2 offset:4096
v_mfma_f32_16x16x32_bf16 v[104:107], a[96:99], a[40:43], v[104:107]
buffer_load_dwordx4 v12, s[48:51], s64 offen lds
v_mfma_f32_16x16x32_bf16 v[104:107], a[100:103], a[44:47], v[104:107]
ds_read_b128 a[20:23], v3 offset:4096
v_mfma_f32_16x16x32_bf16 v[88:91], a[100:103], a[36:39], v[88:91]
ds_read_b128 a[24:27], v2 offset:6144
v_mfma_f32_16x16x32_bf16 v[88:91], a[96:99], a[32:35], v[88:91]
s_waitcnt lgkmcnt(7)
s_add_u32 m0, s76, 37888
ds_read_b128 a[28:31], v3 offset:6144
v_mfma_f32_16x16x32_bf16 v[28:31], a[104:107], a[32:35], v[28:31]
s_add_u32 s64, s73, 17792
ds_read_b64_tr_b16 a[88:89], v10 offset:32768
v_mfma_f32_16x16x32_bf16 v[28:31], a[108:111], a[36:39], v[28:31]
buffer_load_dwordx4 v13, s[48:51], s64 offen lds
v_mfma_f32_16x16x32_bf16 v[44:47], a[108:111], a[44:47], v[44:47]
ds_read_b64_tr_b16 a[90:91], v10 offset:33792
v_subrev_u32 v7, 0x8000, v7
v_mfma_f32_16x16x32_bf16 v[44:47], a[104:107], a[40:43], v[44:47]
ds_read_b64_tr_b16 a[92:93], v10 offset:40960
v_mfma_f32_16x16x32_bf16 v[60:63], a[104:107], a[48:51], v[60:63]
s_add_u32 m0, s76, 38912
buffer_load_dword v1, off, s[52:55], s78 sc1
v_mfma_f32_16x16x32_bf16 v[60:63], a[108:111], a[52:55], v[60:63]
s_add_u32 s64, s73, 132480
ds_read_b64_tr_b16 a[94:95], v10 offset:41984
v_mfma_f32_16x16x32_bf16 v[76:79], a[108:111], a[60:63], v[76:79]
buffer_load_dwordx4 v12, s[48:51], s64 offen lds
v_mfma_f32_16x16x32_bf16 v[76:79], a[104:107], a[56:59], v[76:79]
ds_read_b64_tr_b16 a[96:97], v11 offset:32768
v_mfma_f32_16x16x32_bf16 v[140:143], a[112:115], a[56:59], v[140:143]
ds_read_b64_tr_b16 a[98:99], v11 offset:33792
v_mfma_f32_16x16x32_bf16 v[140:143], a[116:119], a[60:63], v[140:143]
s_add_u32 m0, s76, 39936
ds_read_b64_tr_b16 a[100:101], v11 offset:40960
v_subrev_u32 v8, 0x8000, v8
v_mfma_f32_16x16x32_bf16 v[124:127], a[116:119], a[52:55], v[124:127]
s_add_u32 s64, s73, 148864
ds_read_b64_tr_b16 a[102:103], v11 offset:41984
v_mfma_f32_16x16x32_bf16 v[124:127], a[112:115], a[48:51], v[124:127]
buffer_load_dwordx4 v13, s[48:51], s64 offen lds
v_mfma_f32_16x16x32_bf16 v[108:111], a[112:115], a[40:43], v[108:111]
v_mfma_f32_16x16x32_bf16 v[108:111], a[116:119], a[44:47], v[108:111]
v_mfma_f32_16x16x32_bf16 v[92:95], a[116:119], a[36:39], v[92:95]
v_subrev_u32 v9, 0x8000, v9
v_subrev_u32 v10, 0x8000, v10
v_mfma_f32_16x16x32_bf16 v[92:95], a[112:115], a[32:35], v[92:95]
v_subrev_u32 v11, 0x8000, v11
v_mfma_f32_16x16x32_bf16 v[32:35], a[72:75], a[32:35], v[32:35]
v_mfma_f32_16x16x32_bf16 v[32:35], a[76:79], a[36:39], v[32:35]
v_mfma_f32_16x16x32_bf16 v[48:51], a[76:79], a[44:47], v[48:51]
s_waitcnt lgkmcnt(0)
s_barrier
v_mfma_f32_16x16x32_bf16 v[48:51], a[72:75], a[40:43], v[48:51]
s_add_u32 m0, s77, 131072
ds_read_b64_tr_b16 a[104:105], v19 offset:4096
v_mfma_f32_16x16x32_bf16 v[64:67], a[72:75], a[48:51], v[64:67]
s_add_u32 s64, s71, 6291456
ds_read_b64_tr_b16 a[106:107], v19 offset:4352
v_mfma_f32_16x16x32_bf16 v[64:67], a[76:79], a[52:55], v[64:67]
buffer_load_dwordx4 v14, s[56:59], s64 offen lds
v_mfma_f32_16x16x32_bf16 v[80:83], a[76:79], a[60:63], v[80:83]
ds_read_b64_tr_b16 a[108:109], v19 offset:6144
v_mfma_f32_16x16x32_bf16 v[80:83], a[72:75], a[56:59], v[80:83]
s_add_u32 s65, s79, 13312
ds_read_b64_tr_b16 a[110:111], v19 offset:6400
v_mfma_f32_16x16x32_bf16 v[144:147], a[80:83], a[56:59], v[144:147]
buffer_store_dwordx4 a[224:227], v16, s[44:47], s65 offen sc1
v_mfma_f32_16x16x32_bf16 v[144:147], a[84:87], a[60:63], v[144:147]
ds_read_b64_tr_b16 a[112:113], v20 offset:4096
v_mfma_f32_16x16x32_bf16 v[128:131], a[84:87], a[52:55], v[128:131]
ds_read_b64_tr_b16 a[114:115], v20 offset:4352
v_mfma_f32_16x16x32_bf16 v[128:131], a[80:83], a[48:51], v[128:131]
ds_read_b64_tr_b16 a[116:117], v20 offset:6144
v_mfma_f32_16x16x32_bf16 v[112:115], a[80:83], a[40:43], v[112:115]
s_add_u32 m0, s78, 147456
ds_read_b64_tr_b16 a[118:119], v20 offset:6400
v_mfma_f32_16x16x32_bf16 v[112:115], a[84:87], a[44:47], v[112:115]
s_add_u32 s64, s75, 4718592
ds_read_b64_tr_b16 a[72:73], v19 offset:8192
v_mfma_f32_16x16x32_bf16 v[96:99], a[84:87], a[36:39], v[96:99]
buffer_load_dwordx4 v23, s[60:63], s64 offen lds
v_mfma_f32_16x16x32_bf16 v[96:99], a[80:83], a[32:35], v[96:99]
ds_read_b64_tr_b16 a[74:75], v19 offset:8448
v_mfma_f32_16x16x32_bf16 v[36:39], a[88:91], a[32:35], v[36:39]
ds_read_b64_tr_b16 a[76:77], v19 offset:10240
v_mfma_f32_16x16x32_bf16 v[36:39], a[92:95], a[36:39], v[36:39]
ds_read_b64_tr_b16 a[78:79], v19 offset:10496
v_mfma_f32_16x16x32_bf16 v[52:55], a[92:95], a[44:47], v[52:55]
ds_read_b64_tr_b16 a[80:81], v20 offset:8192
v_mfma_f32_16x16x32_bf16 v[52:55], a[88:91], a[40:43], v[52:55]
ds_read_b64_tr_b16 a[82:83], v20 offset:8448
v_mfma_f32_16x16x32_bf16 v[68:71], a[88:91], a[48:51], v[68:71]
ds_read_b64_tr_b16 a[84:85], v20 offset:10240
v_mfma_f32_16x16x32_bf16 v[68:71], a[92:95], a[52:55], v[68:71]
s_add_u32 m0, s77, 132096
ds_read_b64_tr_b16 a[86:87], v20 offset:10496
v_mfma_f32_16x16x32_bf16 v[84:87], a[92:95], a[60:63], v[84:87]
s_add_u32 s64, s71, 6324224
v_mfma_f32_16x16x32_bf16 v[84:87], a[88:91], a[56:59], v[84:87]
buffer_load_dwordx4 v14, s[56:59], s64 offen lds
v_mfma_f32_16x16x32_bf16 v[148:151], a[96:99], a[56:59], v[148:151]
ds_read_b64_tr_b16 a[88:89], v19 offset:0
v_mfma_f32_16x16x32_bf16 v[148:151], a[100:103], a[60:63], v[148:151]
ds_read_b64_tr_b16 a[90:91], v19 offset:256
v_mfma_f32_16x16x32_bf16 v[132:135], a[100:103], a[52:55], v[132:135]
ds_read_b64_tr_b16 a[92:93], v19 offset:2048
v_mfma_f32_16x16x32_bf16 v[132:135], a[96:99], a[48:51], v[132:135]
ds_read_b64_tr_b16 a[94:95], v19 offset:2304
v_mfma_f32_16x16x32_bf16 v[116:119], a[96:99], a[40:43], v[116:119]
v_mfma_f32_16x16x32_bf16 v[116:119], a[100:103], a[44:47], v[116:119]
v_mfma_f32_16x16x32_bf16 v[100:103], a[100:103], a[36:39], v[100:103]
s_add_u32 m0, s78, 151552
v_mfma_f32_16x16x32_bf16 v[100:103], a[96:99], a[32:35], v[100:103]
s_waitcnt lgkmcnt(4)
s_add_u32 s64, s75, 4720640
ds_read_b64_tr_b16 a[96:97], v20 offset:0
v_mfma_f32_16x16x32_bf16 v[184:187], a[104:107], a[0:3], v[184:187]
buffer_load_dwordx4 v23, s[60:63], s64 offen lds
v_mfma_f32_16x16x32_bf16 v[184:187], a[108:111], a[4:7], v[184:187]
ds_read_b64_tr_b16 a[98:99], v20 offset:256
v_mfma_f32_16x16x32_bf16 v[192:195], a[108:111], a[12:15], v[192:195]
ds_read_b64_tr_b16 a[100:101], v20 offset:2048
v_mfma_f32_16x16x32_bf16 v[192:195], a[104:107], a[8:11], v[192:195]
s_add_u32 s17, s78, .-L_pc+6144
ds_read_b64_tr_b16 a[102:103], v20 offset:2304
v_mfma_f32_16x16x32_bf16 v[200:203], a[104:107], a[16:19], v[200:203]
buffer_load_dword a252, v16, s[88:91], s17 offen
v_mfma_f32_16x16x32_bf16 v[200:203], a[108:111], a[20:23], v[200:203]
v_mfma_f32_16x16x32_bf16 v[208:211], a[108:111], a[28:31], v[208:211]
v_mfma_f32_16x16x32_bf16 v[208:211], a[104:107], a[24:27], v[208:211]
ds_read_b64_tr_b16 a[104:105], v4 offset:0
v_mfma_f32_16x16x32_bf16 v[212:215], a[112:115], a[24:27], v[212:215]
s_add_u32 m0, s77, 133120
ds_read_b64_tr_b16 a[106:107], v4 offset:1024
v_mfma_f32_16x16x32_bf16 v[212:215], a[116:119], a[28:31], v[212:215]
s_add_u32 s64, s71, 6356992
ds_read_b64_tr_b16 a[108:109], v4 offset:8192
v_mfma_f32_16x16x32_bf16 v[204:207], a[116:119], a[20:23], v[204:207]
buffer_load_dwordx4 v15, s[56:59], s64 offen lds
v_mfma_f32_16x16x32_bf16 v[204:207], a[112:115], a[16:19], v[204:207]
ds_read_b64_tr_b16 a[110:111], v4 offset:9216
v_mfma_f32_16x16x32_bf16 v[196:199], a[112:115], a[8:11], v[196:199]
v_mfma_f32_16x16x32_bf16 v[196:199], a[116:119], a[12:15], v[196:199]
v_mfma_f32_16x16x32_bf16 v[188:191], a[116:119], a[4:7], v[188:191]
v_mfma_f32_16x16x32_bf16 v[188:191], a[112:115], a[0:3], v[188:191]
ds_read_b64_tr_b16 a[112:113], v5 offset:0
v_mfma_f32_16x16x32_bf16 v[216:219], a[0:3], a[72:75], v[216:219]
ds_read_b64_tr_b16 a[114:115], v5 offset:1024
v_mfma_f32_16x16x32_bf16 v[216:219], a[4:7], a[76:79], v[216:219]
s_add_u32 m0, s78, 155648
ds_read_b64_tr_b16 a[116:117], v5 offset:8192
v_mfma_f32_16x16x32_bf16 v[224:227], a[12:15], a[76:79], v[224:227]
s_add_u32 s64, s75, 4722688
ds_read_b64_tr_b16 a[118:119], v5 offset:9216
v_mfma_f32_16x16x32_bf16 v[224:227], a[8:11], a[72:75], v[224:227]
buffer_load_dwordx4 v23, s[60:63], s64 offen lds
v_mfma_f32_16x16x32_bf16 v[232:235], a[16:19], a[72:75], v[232:235]
v_mfma_f32_16x16x32_bf16 v[232:235], a[20:23], a[76:79], v[232:235]
v_mfma_f32_16x16x32_bf16 v[240:243], a[28:31], a[76:79], v[240:243]
v_mfma_f32_16x16x32_bf16 v[240:243], a[24:27], a[72:75], v[240:243]
ds_read_b64_tr_b16 a[72:73], v6 offset:0
v_mfma_f32_16x16x32_bf16 v[244:247], a[24:27], a[80:83], v[244:247]
s_add_u32 s65, s79, 30720
ds_read_b64_tr_b16 a[74:75], v6 offset:1024
v_mfma_f32_16x16x32_bf16 v[244:247], a[28:31], a[84:87], v[244:247]
buffer_store_dwordx4 a[228:231], v16, s[44:47], s65 offen sc1
v_mfma_f32_16x16x32_bf16 v[236:239], a[20:23], a[84:87], v[236:239]
s_add_u32 m0, s77, 134144
ds_read_b64_tr_b16 a[76:77], v6 offset:8192
v_mfma_f32_16x16x32_bf16 v[236:239], a[16:19], a[80:83], v[236:239]
s_add_u32 s64, s71, 6389760
ds_read_b64_tr_b16 a[78:79], v6 offset:9216
v_mfma_f32_16x16x32_bf16 v[228:231], a[8:11], a[80:83], v[228:231]
buffer_load_dwordx4 v15, s[56:59], s64 offen lds
v_mfma_f32_16x16x32_bf16 v[228:231], a[12:15], a[84:87], v[228:231]
v_mfma_f32_16x16x32_bf16 v[220:223], a[4:7], a[84:87], v[220:223]
v_mfma_f32_16x16x32_bf16 v[220:223], a[0:3], a[80:83], v[220:223]
s_waitcnt lgkmcnt(4)
ds_read_b64_tr_b16 a[80:81], v7 offset:0
v_mfma_f32_16x16x32_bf16 v[152:155], a[88:91], a[0:3], v[152:155]
ds_read_b64_tr_b16 a[82:83], v7 offset:1024
v_mfma_f32_16x16x32_bf16 v[152:155], a[92:95], a[4:7], v[152:155]
ds_read_b64_tr_b16 a[84:85], v7 offset:8192
v_mfma_f32_16x16x32_bf16 v[160:163], a[92:95], a[12:15], v[160:163]
ds_read_b64_tr_b16 a[86:87], v7 offset:9216
v_mfma_f32_16x16x32_bf16 v[160:163], a[88:91], a[8:11], v[160:163]
v_mfma_f32_16x16x32_bf16 v[168:171], a[88:91], a[16:19], v[168:171]
v_mfma_f32_16x16x32_bf16 v[168:171], a[92:95], a[20:23], v[168:171]
v_mfma_f32_16x16x32_bf16 v[176:179], a[92:95], a[28:31], v[176:179]
s_add_u32 m0, s76, 0
v_mfma_f32_16x16x32_bf16 v[176:179], a[88:91], a[24:27], v[176:179]
s_add_u32 s64, s72, 1536
ds_read_b64_tr_b16 a[88:89], v8 offset:0
v_mfma_f32_16x16x32_bf16 v[180:183], a[96:99], a[24:27], v[180:183]
buffer_load_dwordx4 v12, s[48:51], s64 offen lds
v_mfma_f32_16x16x32_bf16 v[180:183], a[100:103], a[28:31], v[180:183]
ds_read_b64_tr_b16 a[90:91], v8 offset:1024
v_mfma_f32_16x16x32_bf16 v[172:175], a[100:103], a[20:23], v[172:175]
ds_read_b64_tr_b16 a[92:93], v8 offset:8192
v_mfma_f32_16x16x32_bf16 v[172:175], a[96:99], a[16:19], v[172:175]
s_add_u32 m0, s76, 1024
ds_read_b64_tr_b16 a[94:95], v8 offset:9216
v_mfma_f32_16x16x32_bf16 v[164:167], a[96:99], a[8:11], v[164:167]
s_add_u32 s64, s72, 17920
v_mfma_f32_16x16x32_bf16 v[164:167], a[100:103], a[12:15], v[164:167]
buffer_load_dwordx4 v13, s[48:51], s64 offen lds
v_mfma_f32_16x16x32_bf16 v[156:159], a[100:103], a[4:7], v[156:159]
v_mfma_f32_16x16x32_bf16 v[156:159], a[96:99], a[0:3], v[156:159]
ds_read_b64_tr_b16 a[96:97], v9 offset:0
v_mfma_f32_16x16x32_bf16 v[24:27], a[104:107], a[0:3], v[24:27]
s_add_u32 m0, s76, 2048
ds_read_b64_tr_b16 a[98:99], v9 offset:1024
v_mfma_f32_16x16x32_bf16 v[24:27], a[108:111], a[4:7], v[24:27]
s_add_u32 s64, s72, 132608
ds_read_b64_tr_b16 a[100:101], v9 offset:8192
v_mfma_f32_16x16x32_bf16 v[40:43], a[108:111], a[12:15], v[40:43]
buffer_load_dwordx4 v12, s[48:51], s64 offen lds
v_mfma_f32_16x16x32_bf16 v[40:43], a[104:107], a[8:11], v[40:43]
ds_read_b64_tr_b16 a[102:103], v9 offset:9216
v_mfma_f32_16x16x32_bf16 v[56:59], a[104:107], a[16:19], v[56:59]
v_mfma_f32_16x16x32_bf16 v[56:59], a[108:111], a[20:23], v[56:59]
s_add_u32 m0, s76, 3072
v_mfma_f32_16x16x32_bf16 v[72:75], a[108:111], a[28:31], v[72:75]
s_waitcnt vmcnt(13)
s_add_u32 s64, s72, 148992
ds_read_b128 a[32:35], v2 offset:32768
v_mfma_f32_16x16x32_bf16 v[72:75], a[104:107], a[24:27], v[72:75]
buffer_load_dwordx4 v13, s[48:51], s64 offen lds
v_mfma_f32_16x16x32_bf16 v[136:139], a[112:115], a[24:27], v[136:139]
ds_read_b128 a[36:39], v3 offset:32768
v_mfma_f32_16x16x32_bf16 v[136:139], a[116:119], a[28:31], v[136:139]
ds_read_b128 a[40:43], v2 offset:34816
v_mfma_f32_16x16x32_bf16 v[120:123], a[116:119], a[20:23], v[120:123]
s_add_u32 m0, s76, 4096
ds_read_b128 a[44:47], v3 offset:34816
v_mfma_f32_16x16x32_bf16 v[120:123], a[112:115], a[16:19], v[120:123]
s_add_u32 s64, s73, 1536
ds_read_b128 a[48:51], v2 offset:36864
v_mfma_f32_16x16x32_bf16 v[104:107], a[112:115], a[8:11], v[104:107]
buffer_load_dwordx4 v12, s[48:51], s64 offen lds
v_mfma_f32_16x16x32_bf16 v[104:107], a[116:119], a[12:15], v[104:107]
ds_read_b128 a[52:55], v3 offset:36864
v_mfma_f32_16x16x32_bf16 v[88:91], a[116:119], a[4:7], v[88:91]
ds_read_b128 a[56:59], v2 offset:38912
v_mfma_f32_16x16x32_bf16 v[88:91], a[112:115], a[0:3], v[88:91]
s_waitcnt lgkmcnt(7)
s_add_u32 m0, s76, 5120
ds_read_b128 a[60:63], v3 offset:38912
v_mfma_f32_16x16x32_bf16 v[28:31], a[72:75], a[0:3], v[28:31]
s_add_u32 s64, s73, 17920
ds_read_b64_tr_b16 a[104:105], v10 offset:0
v_mfma_f32_16x16x32_bf16 v[28:31], a[76:79], a[4:7], v[28:31]
buffer_load_dwordx4 v13, s[48:51], s64 offen lds
v_mfma_f32_16x16x32_bf16 v[44:47], a[76:79], a[12:15], v[44:47]
ds_read_b64_tr_b16 a[106:107], v10 offset:1024
v_mfma_f32_16x16x32_bf16 v[44:47], a[72:75], a[8:11], v[44:47]
ds_read_b64_tr_b16 a[108:109], v10 offset:8192
v_mfma_f32_16x16x32_bf16 v[60:63], a[72:75], a[16:19], v[60:63]
s_add_u32 m0, s76, 6144
ds_read_b64_tr_b16 a[110:111], v10 offset:9216
v_mfma_f32_16x16x32_bf16 v[60:63], a[76:79], a[20:23], v[60:63]
s_add_u32 s64, s73, 132608
ds_read_b64_tr_b16 a[112:113], v11 offset:0
v_mfma_f32_16x16x32_bf16 v[76:79], a[76:79], a[28:31], v[76:79]
buffer_load_dwordx4 v12, s[48:51], s64 offen lds
v_mfma_f32_16x16x32_bf16 v[76:79], a[72:75], a[24:27], v[76:79]
ds_read_b64_tr_b16 a[114:115], v11 offset:1024
v_mfma_f32_16x16x32_bf16 v[140:143], a[80:83], a[24:27], v[140:143]
s_add_u32 m0, s76, 7168
ds_read_b64_tr_b16 a[116:117], v11 offset:8192
v_mfma_f32_16x16x32_bf16 v[140:143], a[84:87], a[28:31], v[140:143]
s_add_u32 s64, s73, 148992
ds_read_b64_tr_b16 a[118:119], v11 offset:9216
v_mfma_f32_16x16x32_bf16 v[124:127], a[84:87], a[20:23], v[124:127]
v_readfirstlane_b32 vcc_lo, v1
s_nop 0
s_cmp_lt_u32 vcc_lo, s81
s_cbranch_scc1 L_spin_1
L_spinbk_2:
v_mfma_f32_16x16x32_bf16 v[124:127], a[80:83], a[16:19], v[124:127]
s_add_u32 s65, s79, 31744
buffer_load_dwordx4 v13, s[48:51], s64 offen lds
v_mfma_f32_16x16x32_bf16 v[108:111], a[80:83], a[8:11], v[108:111]
buffer_store_dwordx4 a[232:235], v16, s[44:47], s65 offen sc1
v_mfma_f32_16x16x32_bf16 v[108:111], a[84:87], a[12:15], v[108:111]
v_mfma_f32_16x16x32_bf16 v[92:95], a[84:87], a[4:7], v[92:95]
s_add_u32 s52, s28, 59768832
s_addc_u32 s53, s29, 0
s_mov_b32 s54, 16384
v_mfma_f32_16x16x32_bf16 v[92:95], a[80:83], a[0:3], v[92:95]
v_mfma_f32_16x16x32_bf16 v[32:35], a[88:91], a[0:3], v[32:35]
v_mfma_f32_16x16x32_bf16 v[32:35], a[92:95], a[4:7], v[32:35]
v_mfma_f32_16x16x32_bf16 v[48:51], a[92:95], a[12:15], v[48:51]
s_waitcnt lgkmcnt(0)
s_barrier
v_mfma_f32_16x16x32_bf16 v[48:51], a[88:91], a[8:11], v[48:51]
s_add_u32 m0, s77, 65536
ds_read_b64_tr_b16 a[72:73], v19 offset:36864
v_mfma_f32_16x16x32_bf16 v[64:67], a[88:91], a[16:19], v[64:67]
s_add_u32 s64, s71, 6815744
ds_read_b64_tr_b16 a[74:75], v19 offset:37120
v_mfma_f32_16x16x32_bf16 v[64:67], a[92:95], a[20:23], v[64:67]
buffer_load_dwordx4 v14, s[56:59], s64 offen lds
v_mfma_f32_16x16x32_bf16 v[80:83], a[92:95], a[28:31], v[80:83]
ds_read_b64_tr_b16 a[76:77], v19 offset:38912
v_mfma_f32_16x16x32_bf16 v[80:83], a[88:91], a[24:27], v[80:83]
ds_read_b64_tr_b16 a[78:79], v19 offset:39168
v_mfma_f32_16x16x32_bf16 v[144:147], a[96:99], a[24:27], v[144:147]
ds_read_b64_tr_b16 a[80:81], v20 offset:36864
v_mfma_f32_16x16x32_bf16 v[144:147], a[100:103], a[28:31], v[144:147]
ds_read_b64_tr_b16 a[82:83], v20 offset:37120
v_mfma_f32_16x16x32_bf16 v[128:131], a[100:103], a[20:23], v[128:131]
ds_read_b64_tr_b16 a[84:85], v20 offset:38912
v_mfma_f32_16x16x32_bf16 v[128:131], a[96:99], a[16:19], v[128:131]
ds_read_b64_tr_b16 a[86:87], v20 offset:39168
v_mfma_f32_16x16x32_bf16 v[112:115], a[96:99], a[8:11], v[112:115]
s_add_u32 m0, s78, 81920
ds_read_b64_tr_b16 a[88:89], v19 offset:40960
v_mfma_f32_16x16x32_bf16 v[112:115], a[100:103], a[12:15], v[112:115]
s_add_u32 s64, s75, 5111808
ds_read_b64_tr_b16 a[90:91], v19 offset:41216
v_mfma_f32_16x16x32_bf16 v[96:99], a[100:103], a[4:7], v[96:99]
buffer_load_dwordx4 v23, s[60:63], s64 offen lds
v_mfma_f32_16x16x32_bf16 v[96:99], a[96:99], a[0:3], v[96:99]
ds_read_b64_tr_b16 a[92:93], v19 offset:43008
v_mfma_f32_16x16x32_bf16 v[36:39], a[104:107], a[0:3], v[36:39]
ds_read_b64_tr_b16 a[94:95], v19 offset:43264
v_mfma_f32_16x16x32_bf16 v[36:39], a[108:111], a[4:7], v[36:39]
ds_read_b64_tr_b16 a[96:97], v20 offset:40960
v_mfma_f32_16x16x32_bf16 v[52:55], a[108:111], a[12:15], v[52:55]
ds_read_b64_tr_b16 a[98:99], v20 offset:41216
v_mfma_f32_16x16x32_bf16 v[52:55], a[104:107], a[8:11], v[52:55]
ds_read_b64_tr_b16 a[100:101], v20 offset:43008
v_mfma_f32_16x16x32_bf16 v[68:71], a[104:107], a[16:19], v[68:71]
ds_read_b64_tr_b16 a[102:103], v20 offset:43264
v_mfma_f32_16x16x32_bf16 v[68:71], a[108:111], a[20:23], v[68:71]
s_add_u32 m0, s77, 66560
v_mfma_f32_16x16x32_bf16 v[84:87], a[108:111], a[28:31], v[84:87]
s_add_u32 s64, s71, 6848512
v_mfma_f32_16x16x32_bf16 v[84:87], a[104:107], a[24:27], v[84:87]
buffer_load_dwordx4 v14, s[56:59], s64 offen lds
v_mfma_f32_16x16x32_bf16 v[148:151], a[112:115], a[24:27], v[148:151]
ds_read_b64_tr_b16 a[104:105], v19 offset:32768
v_mfma_f32_16x16x32_bf16 v[148:151], a[116:119], a[28:31], v[148:151]
ds_read_b64_tr_b16 a[106:107], v19 offset:33024
v_mfma_f32_16x16x32_bf16 v[132:135], a[116:119], a[20:23], v[132:135]
ds_read_b64_tr_b16 a[108:109], v19 offset:34816
v_mfma_f32_16x16x32_bf16 v[132:135], a[112:115], a[16:19], v[132:135]
ds_read_b64_tr_b16 a[110:111], v19 offset:35072
v_mfma_f32_16x16x32_bf16 v[116:119], a[112:115], a[8:11], v[116:119]
v_mfma_f32_16x16x32_bf16 v[116:119], a[116:119], a[12:15], v[116:119]
v_mfma_f32_16x16x32_bf16 v[100:103], a[116:119], a[4:7], v[100:103]
s_add_u32 m0, s78, 86016
v_mfma_f32_16x16x32_bf16 v[100:103], a[112:115], a[0:3], v[100:103]
s_waitcnt lgkmcnt(4)
s_add_u32 s64, s75, 5113856
ds_read_b64_tr_b16 a[112:113], v20 offset:32768
v_mfma_f32_16x16x32_bf16 v[184:187], a[72:75], a[32:35], v[184:187]
buffer_load_dwordx4 v23, s[60:63], s64 offen lds
v_mfma_f32_16x16x32_bf16 v[184:187], a[76:79], a[36:39], v[184:187]
ds_read_b64_tr_b16 a[114:115], v20 offset:33024
v_mfma_f32_16x16x32_bf16 v[192:195], a[76:79], a[44:47], v[192:195]
ds_read_b64_tr_b16 a[116:117], v20 offset:34816
v_mfma_f32_16x16x32_bf16 v[192:195], a[72:75], a[40:43], v[192:195]
ds_read_b64_tr_b16 a[118:119], v20 offset:35072
v_mfma_f32_16x16x32_bf16 v[200:203], a[72:75], a[48:51], v[200:203]
v_mfma_f32_16x16x32_bf16 v[200:203], a[76:79], a[52:55], v[200:203]
v_mfma_f32_16x16x32_bf16 v[208:211], a[76:79], a[60:63], v[208:211]
v_mfma_f32_16x16x32_bf16 v[208:211], a[72:75], a[56:59], v[208:211]
ds_read_b64_tr_b16 a[72:73], v4 offset:32768
v_mfma_f32_16x16x32_bf16 v[212:215], a[80:83], a[56:59], v[212:215]
s_add_u32 m0, s77, 67584
ds_read_b64_tr_b16 a[74:75], v4 offset:33792
v_mfma_f32_16x16x32_bf16 v[212:215], a[84:87], a[60:63], v[212:215]
s_add_u32 s64, s71, 6881280
ds_read_b64_tr_b16 a[76:77], v4 offset:40960
v_mfma_f32_16x16x32_bf16 v[204:207], a[84:87], a[52:55], v[204:207]
buffer_load_dwordx4 v15, s[56:59], s64 offen lds
v_mfma_f32_16x16x32_bf16 v[204:207], a[80:83], a[48:51], v[204:207]
s_add_u32 s65, s79, 15360
ds_read_b64_tr_b16 a[78:79], v4 offset:41984
v_mfma_f32_16x16x32_bf16 v[196:199], a[80:83], a[40:43], v[196:199]
buffer_store_dwordx4 a[236:239], v16, s[44:47], s65 offen sc1
v_mfma_f32_16x16x32_bf16 v[196:199], a[84:87], a[44:47], v[196:199]
v_mfma_f32_16x16x32_bf16 v[188:191], a[84:87], a[36:39], v[188:191]
v_mfma_f32_16x16x32_bf16 v[188:191], a[80:83], a[32:35], v[188:191]
ds_read_b64_tr_b16 a[80:81], v5 offset:32768
v_mfma_f32_16x16x32_bf16 v[216:219], a[32:35], a[88:91], v[216:219]
ds_read_b64_tr_b16 a[82:83], v5 offset:33792
v_mfma_f32_16x16x32_bf16 v[216:219], a[36:39], a[92:95], v[216:219]
s_add_u32 m0, s78, 90112
ds_read_b64_tr_b16 a[84:85], v5 offset:40960
v_mfma_f32_16x16x32_bf16 v[224:227], a[44:47], a[92:95], v[224:227]
s_add_u32 s64, s75, 5115904
ds_read_b64_tr_b16 a[86:87], v5 offset:41984
v_mfma_f32_16x16x32_bf16 v[224:227], a[40:43], a[88:91], v[224:227]
buffer_load_dwordx4 v23, s[60:63], s64 offen lds
v_mfma_f32_16x16x32_bf16 v[232:235], a[48:51], a[88:91], v[232:235]
v_mfma_f32_16x16x32_bf16 v[232:235], a[52:55], a[92:95], v[232:235]
v_mfma_f32_16x16x32_bf16 v[240:243], a[60:63], a[92:95], v[240:243]
v_mfma_f32_16x16x32_bf16 v[240:243], a[56:59], a[88:91], v[240:243]
ds_read_b64_tr_b16 a[88:89], v6 offset:32768
v_mfma_f32_16x16x32_bf16 v[244:247], a[56:59], a[96:99], v[244:247]
ds_read_b64_tr_b16 a[90:91], v6 offset:33792
v_mfma_f32_16x16x32_bf16 v[244:247], a[60:63], a[100:103], v[244:247]
ds_read_b64_tr_b16 a[92:93], v6 offset:40960
v_add_u32 v19, 0x8000, v19
v_mfma_f32_16x16x32_bf16 v[236:239], a[52:55], a[100:103], v[236:239]
s_add_u32 m0, s77, 68608
ds_read_b64_tr_b16 a[94:95], v6 offset:41984
v_mfma_f32_16x16x32_bf16 v[236:239], a[48:51], a[96:99], v[236:239]
s_add_u32 s64, s71, 6914048
v_mfma_f32_16x16x32_bf16 v[228:231], a[40:43], a[96:99], v[228:231]
buffer_load_dwordx4 v15, s[56:59], s64 offen lds
v_mfma_f32_16x16x32_bf16 v[228:231], a[44:47], a[100:103], v[228:231]
v_mfma_f32_16x16x32_bf16 v[220:223], a[36:39], a[100:103], v[220:223]
v_mfma_f32_16x16x32_bf16 v[220:223], a[32:35], a[96:99], v[220:223]
s_waitcnt lgkmcnt(4)
ds_read_b64_tr_b16 a[96:97], v7 offset:32768
v_mfma_f32_16x16x32_bf16 v[152:155], a[104:107], a[32:35], v[152:155]
ds_read_b64_tr_b16 a[98:99], v7 offset:33792
v_mfma_f32_16x16x32_bf16 v[152:155], a[108:111], a[36:39], v[152:155]
ds_read_b64_tr_b16 a[100:101], v7 offset:40960
v_add_u32 v20, 0x8000, v20
v_mfma_f32_16x16x32_bf16 v[160:163], a[108:111], a[44:47], v[160:163]
ds_read_b64_tr_b16 a[102:103], v7 offset:41984
v_mfma_f32_16x16x32_bf16 v[160:163], a[104:107], a[40:43], v[160:163]
v_mfma_f32_16x16x32_bf16 v[168:171], a[104:107], a[48:51], v[168:171]
v_mfma_f32_16x16x32_bf16 v[168:171], a[108:111], a[52:55], v[168:171]
v_mfma_f32_16x16x32_bf16 v[176:179], a[108:111], a[60:63], v[176:179]
s_add_u32 m0, s76, 32768
v_mfma_f32_16x16x32_bf16 v[176:179], a[104:107], a[56:59], v[176:179]
s_add_u32 s64, s72, 1664
ds_read_b64_tr_b16 a[104:105], v8 offset:32768
v_mfma_f32_16x16x32_bf16 v[180:183], a[112:115], a[56:59], v[180:183]
buffer_load_dwordx4 v12, s[48:51], s64 offen lds
v_mfma_f32_16x16x32_bf16 v[180:183], a[116:119], a[60:63], v[180:183]
ds_read_b64_tr_b16 a[106:107], v8 offset:33792
v_add_u32 v4, 0x8000, v4
v_mfma_f32_16x16x32_bf16 v[172:175], a[116:119], a[52:55], v[172:175]
ds_read_b64_tr_b16 a[108:109], v8 offset:40960
v_mfma_f32_16x16x32_bf16 v[172:175], a[112:115], a[48:51], v[172:175]
s_add_u32 m0, s76, 33792
ds_read_b64_tr_b16 a[110:111], v8 offset:41984
v_mfma_f32_16x16x32_bf16 v[164:167], a[112:115], a[40:43], v[164:167]
s_add_u32 s64, s72, 18048
v_mfma_f32_16x16x32_bf16 v[164:167], a[116:119], a[44:47], v[164:167]
buffer_load_dwordx4 v13, s[48:51], s64 offen lds
v_mfma_f32_16x16x32_bf16 v[156:159], a[116:119], a[36:39], v[156:159]
v_mfma_f32_16x16x32_bf16 v[156:159], a[112:115], a[32:35], v[156:159]
ds_read_b64_tr_b16 a[112:113], v9 offset:32768
v_mfma_f32_16x16x32_bf16 v[24:27], a[72:75], a[32:35], v[24:27]
s_add_u32 m0, s76, 34816
ds_read_b64_tr_b16 a[114:115], v9 offset:33792
v_mfma_f32_16x16x32_bf16 v[24:27], a[76:79], a[36:39], v[24:27]
s_add_u32 s64, s72, 132736
ds_read_b64_tr_b16 a[116:117], v9 offset:40960
v_add_u32 v5, 0x8000, v5
v_mfma_f32_16x16x32_bf16 v[40:43], a[76:79], a[44:47], v[40:43]
buffer_load_dwordx4 v12, s[48:51], s64 offen lds
v_mfma_f32_16x16x32_bf16 v[40:43], a[72:75], a[40:43], v[40:43]
ds_read_b64_tr_b16 a[118:119], v9 offset:41984
v_mfma_f32_16x16x32_bf16 v[56:59], a[72:75], a[48:51], v[56:59]
v_mfma_f32_16x16x32_bf16 v[56:59], a[76:79], a[52:55], v[56:59]
s_add_u32 m0, s76, 35840
v_mfma_f32_16x16x32_bf16 v[72:75], a[76:79], a[60:63], v[72:75]
s_waitcnt vmcnt(12)
s_add_u32 s64, s72, 149120
ds_read_b128 a[0:3], v2 offset:0
v_mfma_f32_16x16x32_bf16 v[72:75], a[72:75], a[56:59], v[72:75]
buffer_load_dwordx4 v13, s[48:51], s64 offen lds
v_mfma_f32_16x16x32_bf16 v[136:139], a[80:83], a[56:59], v[136:139]
ds_read_b128 a[4:7], v3 offset:0
v_mfma_f32_16x16x32_bf16 v[136:139], a[84:87], a[60:63], v[136:139]
ds_read_b128 a[8:11], v2 offset:2048
v_add_u32 v6, 0x8000, v6
v_mfma_f32_16x16x32_bf16 v[120:123], a[84:87], a[52:55], v[120:123]
s_add_u32 m0, s76, 36864
ds_read_b128 a[12:15], v3 offset:2048
v_mfma_f32_16x16x32_bf16 v[120:123], a[80:83], a[48:51], v[120:123]
s_add_u32 s64, s73, 1664
ds_read_b128 a[16:19], v2 offset:4096
v_mfma_f32_16x16x32_bf16 v[104:107], a[80:83], a[40:43], v[104:107]
buffer_load_dwordx4 v12, s[48:51], s64 offen lds
v_mfma_f32_16x16x32_bf16 v[104:107], a[84:87], a[44:47], v[104:107]
ds_read_b128 a[20:23], v3 offset:4096
v_mfma_f32_16x16x32_bf16 v[88:91], a[84:87], a[36:39], v[88:91]
buffer_store_dwordx4 a[240:243], v16, s[44:47], s74 offen sc1
v_mfma_f32_16x16x32_bf16 v[88:91], a[80:83], a[32:35], v[88:91]
s_waitcnt lgkmcnt(6)
s_add_u32 m0, s76, 37888
ds_read_b128 a[24:27], v2 offset:6144
v_mfma_f32_16x16x32_bf16 v[28:31], a[88:91], a[32:35], v[28:31]
s_add_u32 s64, s73, 18048
ds_read_b128 a[28:31], v3 offset:6144
v_mfma_f32_16x16x32_bf16 v[28:31], a[92:95], a[36:39], v[28:31]
buffer_load_dwordx4 v13, s[48:51], s64 offen lds
v_mfma_f32_16x16x32_bf16 v[44:47], a[92:95], a[44:47], v[44:47]
ds_read_b64_tr_b16 a[72:73], v10 offset:32768
v_add_u32 v7, 0x8000, v7
v_mfma_f32_16x16x32_bf16 v[44:47], a[88:91], a[40:43], v[44:47]
ds_read_b64_tr_b16 a[74:75], v10 offset:33792
v_mfma_f32_16x16x32_bf16 v[60:63], a[88:91], a[48:51], v[60:63]
s_add_u32 m0, s76, 38912
ds_read_b64_tr_b16 a[76:77], v10 offset:40960
v_mfma_f32_16x16x32_bf16 v[60:63], a[92:95], a[52:55], v[60:63]
s_add_u32 s64, s73, 132736
ds_read_b64_tr_b16 a[78:79], v10 offset:41984
v_mfma_f32_16x16x32_bf16 v[76:79], a[92:95], a[60:63], v[76:79]
buffer_load_dwordx4 v12, s[48:51], s64 offen lds
v_mfma_f32_16x16x32_bf16 v[76:79], a[88:91], a[56:59], v[76:79]
ds_read_b64_tr_b16 a[80:81], v11 offset:32768
v_mfma_f32_16x16x32_bf16 v[140:143], a[96:99], a[56:59], v[140:143]
ds_read_b64_tr_b16 a[82:83], v11 offset:33792
v_mfma_f32_16x16x32_bf16 v[140:143], a[100:103], a[60:63], v[140:143]
s_add_u32 m0, s76, 39936
ds_read_b64_tr_b16 a[84:85], v11 offset:40960
v_add_u32 v8, 0x8000, v8
v_mfma_f32_16x16x32_bf16 v[124:127], a[100:103], a[52:55], v[124:127]
s_add_u32 s64, s73, 149120
ds_read_b64_tr_b16 a[86:87], v11 offset:41984
v_mfma_f32_16x16x32_bf16 v[124:127], a[96:99], a[48:51], v[124:127]
buffer_load_dwordx4 v13, s[48:51], s64 offen lds
v_mfma_f32_16x16x32_bf16 v[108:111], a[96:99], a[40:43], v[108:111]
v_mfma_f32_16x16x32_bf16 v[108:111], a[100:103], a[44:47], v[108:111]
v_mfma_f32_16x16x32_bf16 v[92:95], a[100:103], a[36:39], v[92:95]
v_add_u32 v9, 0x8000, v9
v_add_u32 v10, 0x8000, v10
v_mfma_f32_16x16x32_bf16 v[92:95], a[96:99], a[32:35], v[92:95]
v_add_u32 v11, 0x8000, v11
v_mfma_f32_16x16x32_bf16 v[32:35], a[104:107], a[32:35], v[32:35]
v_mfma_f32_16x16x32_bf16 v[32:35], a[108:111], a[36:39], v[32:35]
v_mfma_f32_16x16x32_bf16 v[48:51], a[108:111], a[44:47], v[48:51]
s_waitcnt lgkmcnt(0)
s_barrier
v_mfma_f32_16x16x32_bf16 v[48:51], a[104:107], a[40:43], v[48:51]
s_add_u32 m0, s77, 98304
ds_read_b64_tr_b16 a[88:89], v19 offset:36864
v_mfma_f32_16x16x32_bf16 v[64:67], a[104:107], a[48:51], v[64:67]
s_add_u32 s64, s71, 7340032
ds_read_b64_tr_b16 a[90:91], v19 offset:37120
v_mfma_f32_16x16x32_bf16 v[64:67], a[108:111], a[52:55], v[64:67]
buffer_load_dwordx4 v14, s[56:59], s64 offen lds
v_mfma_f32_16x16x32_bf16 v[80:83], a[108:111], a[60:63], v[80:83]
ds_read_b64_tr_b16 a[92:93], v19 offset:38912
v_mfma_f32_16x16x32_bf16 v[80:83], a[104:107], a[56:59], v[80:83]
ds_read_b64_tr_b16 a[94:95], v19 offset:39168
v_mfma_f32_16x16x32_bf16 v[144:147], a[112:115], a[56:59], v[144:147]
ds_read_b64_tr_b16 a[96:97], v20 offset:36864
v_mfma_f32_16x16x32_bf16 v[144:147], a[116:119], a[60:63], v[144:147]
ds_read_b64_tr_b16 a[98:99], v20 offset:37120
v_mfma_f32_16x16x32_bf16 v[128:131], a[116:119], a[52:55], v[128:131]
ds_read_b64_tr_b16 a[100:101], v20 offset:38912
v_mfma_f32_16x16x32_bf16 v[128:131], a[112:115], a[48:51], v[128:131]
ds_read_b64_tr_b16 a[102:103], v20 offset:39168
v_mfma_f32_16x16x32_bf16 v[112:115], a[112:115], a[40:43], v[112:115]
s_add_u32 m0, s78, 114688
ds_read_b64_tr_b16 a[104:105], v19 offset:40960
v_mfma_f32_16x16x32_bf16 v[112:115], a[116:119], a[44:47], v[112:115]
s_add_u32 s64, s75, 5505024
ds_read_b64_tr_b16 a[106:107], v19 offset:41216
v_mfma_f32_16x16x32_bf16 v[96:99], a[116:119], a[36:39], v[96:99]
buffer_load_dwordx4 v23, s[60:63], s64 offen lds
v_mfma_f32_16x16x32_bf16 v[96:99], a[112:115], a[32:35], v[96:99]
ds_read_b64_tr_b16 a[108:109], v19 offset:43008
v_mfma_f32_16x16x32_bf16 v[36:39], a[72:75], a[32:35], v[36:39]
ds_read_b64_tr_b16 a[110:111], v19 offset:43264
v_mfma_f32_16x16x32_bf16 v[36:39], a[76:79], a[36:39], v[36:39]
ds_read_b64_tr_b16 a[112:113], v20 offset:40960
v_mfma_f32_16x16x32_bf16 v[52:55], a[76:79], a[44:47], v[52:55]
ds_read_b64_tr_b16 a[114:115], v20 offset:41216
v_mfma_f32_16x16x32_bf16 v[52:55], a[72:75], a[40:43], v[52:55]
ds_read_b64_tr_b16 a[116:117], v20 offset:43008
v_mfma_f32_16x16x32_bf16 v[68:71], a[72:75], a[48:51], v[68:71]
ds_read_b64_tr_b16 a[118:119], v20 offset:43264
v_mfma_f32_16x16x32_bf16 v[68:71], a[76:79], a[52:55], v[68:71]
s_add_u32 m0, s77, 99328
v_mfma_f32_16x16x32_bf16 v[84:87], a[76:79], a[60:63], v[84:87]
s_add_u32 s64, s71, 7372800
v_mfma_f32_16x16x32_bf16 v[84:87], a[72:75], a[56:59], v[84:87]
buffer_load_dwordx4 v14, s[56:59], s64 offen lds
v_mfma_f32_16x16x32_bf16 v[148:151], a[80:83], a[56:59], v[148:151]
ds_read_b64_tr_b16 a[72:73], v19 offset:32768
v_mfma_f32_16x16x32_bf16 v[148:151], a[84:87], a[60:63], v[148:151]
ds_read_b64_tr_b16 a[74:75], v19 offset:33024
v_mfma_f32_16x16x32_bf16 v[132:135], a[84:87], a[52:55], v[132:135]
ds_read_b64_tr_b16 a[76:77], v19 offset:34816
v_mfma_f32_16x16x32_bf16 v[132:135], a[80:83], a[48:51], v[132:135]
ds_read_b64_tr_b16 a[78:79], v19 offset:35072
v_mfma_f32_16x16x32_bf16 v[116:119], a[80:83], a[40:43], v[116:119]
v_mfma_f32_16x16x32_bf16 v[116:119], a[84:87], a[44:47], v[116:119]
v_mfma_f32_16x16x32_bf16 v[100:103], a[84:87], a[36:39], v[100:103]
s_add_u32 m0, s78, 118784
v_mfma_f32_16x16x32_bf16 v[100:103], a[80:83], a[32:35], v[100:103]
s_waitcnt lgkmcnt(4)
s_add_u32 s64, s75, 5507072
ds_read_b64_tr_b16 a[80:81], v20 offset:32768
v_mfma_f32_16x16x32_bf16 v[184:187], a[88:91], a[0:3], v[184:187]
s_lshl_b32 s66, s30, 30
buffer_load_dwordx4 v23, s[60:63], s64 offen lds
v_mfma_f32_16x16x32_bf16 v[184:187], a[92:95], a[4:7], v[184:187]
ds_read_b64_tr_b16 a[82:83], v20 offset:33024
v_lshl_add_u32 v1, v0, 24, s66
v_mfma_f32_16x16x32_bf16 v[192:195], a[92:95], a[12:15], v[192:195]
s_lshl_b32 s70, s31, 8
ds_read_b64_tr_b16 a[84:85], v20 offset:34816
v_mfma_f32_16x16x32_bf16 v[192:195], a[88:91], a[8:11], v[192:195]
s_add_u32 s17, s78, .-L_pc+6144
ds_read_b64_tr_b16 a[86:87], v20 offset:35072
v_mfma_f32_16x16x32_bf16 v[200:203], a[88:91], a[16:19], v[200:203]
buffer_load_dword a252, v16, s[88:91], s17 offen
v_mfma_f32_16x16x32_bf16 v[200:203], a[92:95], a[20:23], v[200:203]
v_mfma_f32_16x16x32_bf16 v[208:211], a[92:95], a[28:31], v[208:211]
v_mfma_f32_16x16x32_bf16 v[208:211], a[88:91], a[24:27], v[208:211]
ds_read_b64_tr_b16 a[88:89], v4 offset:32768
v_mfma_f32_16x16x32_bf16 v[212:215], a[96:99], a[24:27], v[212:215]
s_add_u32 m0, s77, 100352
ds_read_b64_tr_b16 a[90:91], v4 offset:33792
v_mfma_f32_16x16x32_bf16 v[212:215], a[100:103], a[28:31], v[212:215]
s_add_u32 s64, s71, 7405568
ds_read_b64_tr_b16 a[92:93], v4 offset:40960
v_mfma_f32_16x16x32_bf16 v[204:207], a[100:103], a[20:23], v[204:207]
buffer_load_dwordx4 v15, s[56:59], s64 offen lds
v_mfma_f32_16x16x32_bf16 v[204:207], a[96:99], a[16:19], v[204:207]
ds_read_b64_tr_b16 a[94:95], v4 offset:41984
v_mfma_f32_16x16x32_bf16 v[196:199], a[96:99], a[8:11], v[196:199]
v_mfma_f32_16x16x32_bf16 v[196:199], a[100:103], a[12:15], v[196:199]
v_mfma_f32_16x16x32_bf16 v[188:191], a[100:103], a[4:7], v[188:191]
v_mfma_f32_16x16x32_bf16 v[188:191], a[96:99], a[0:3], v[188:191]
ds_read_b64_tr_b16 a[96:97], v5 offset:32768
v_mfma_f32_16x16x32_bf16 v[216:219], a[0:3], a[104:107], v[216:219]
ds_read_b64_tr_b16 a[98:99], v5 offset:33792
v_mfma_f32_16x16x32_bf16 v[216:219], a[4:7], a[108:111], v[216:219]
s_add_u32 m0, s78, 122880
ds_read_b64_tr_b16 a[100:101], v5 offset:40960
v_mfma_f32_16x16x32_bf16 v[224:227], a[12:15], a[108:111], v[224:227]
s_add_u32 s64, s75, 5509120
ds_read_b64_tr_b16 a[102:103], v5 offset:41984
v_mfma_f32_16x16x32_bf16 v[224:227], a[8:11], a[104:107], v[224:227]
buffer_load_dwordx4 v23, s[60:63], s64 offen lds
v_mfma_f32_16x16x32_bf16 v[232:235], a[16:19], a[104:107], v[232:235]
v_mfma_f32_16x16x32_bf16 v[232:235], a[20:23], a[108:111], v[232:235]
v_mfma_f32_16x16x32_bf16 v[240:243], a[28:31], a[108:111], v[240:243]
v_mfma_f32_16x16x32_bf16 v[240:243], a[24:27], a[104:107], v[240:243]
ds_read_b64_tr_b16 a[104:105], v6 offset:32768
v_mfma_f32_16x16x32_bf16 v[244:247], a[24:27], a[112:115], v[244:247]
ds_read_b64_tr_b16 a[106:107], v6 offset:33792
v_mfma_f32_16x16x32_bf16 v[244:247], a[28:31], a[116:119], v[244:247]
ds_read_b64_tr_b16 a[108:109], v6 offset:40960
v_subrev_u32 v19, 0x8000, v19
v_mfma_f32_16x16x32_bf16 v[236:239], a[20:23], a[116:119], v[236:239]
s_add_u32 m0, s77, 101376
ds_read_b64_tr_b16 a[110:111], v6 offset:41984
v_mfma_f32_16x16x32_bf16 v[236:239], a[16:19], a[112:115], v[236:239]
s_add_u32 s64, s71, 7438336
v_mfma_f32_16x16x32_bf16 v[228:231], a[8:11], a[112:115], v[228:231]
buffer_load_dwordx4 v15, s[56:59], s64 offen lds
v_mfma_f32_16x16x32_bf16 v[228:231], a[12:15], a[116:119], v[228:231]
v_mfma_f32_16x16x32_bf16 v[220:223], a[4:7], a[116:119], v[220:223]
v_mfma_f32_16x16x32_bf16 v[220:223], a[0:3], a[112:115], v[220:223]
s_waitcnt lgkmcnt(4)
ds_read_b64_tr_b16 a[112:113], v7 offset:32768
v_mfma_f32_16x16x32_bf16 v[152:155], a[72:75], a[0:3], v[152:155]
ds_read_b64_tr_b16 a[114:115], v7 offset:33792
v_mfma_f32_16x16x32_bf16 v[152:155], a[76:79], a[4:7], v[152:155]
ds_read_b64_tr_b16 a[116:117], v7 offset:40960
v_subrev_u32 v20, 0x8000, v20
v_mfma_f32_16x16x32_bf16 v[160:163], a[76:79], a[12:15], v[160:163]
ds_read_b64_tr_b16 a[118:119], v7 offset:41984
v_mfma_f32_16x16x32_bf16 v[160:163], a[72:75], a[8:11], v[160:163]
v_mfma_f32_16x16x32_bf16 v[168:171], a[72:75], a[16:19], v[168:171]
v_mfma_f32_16x16x32_bf16 v[168:171], a[76:79], a[20:23], v[168:171]
v_mfma_f32_16x16x32_bf16 v[176:179], a[76:79], a[28:31], v[176:179]
s_add_u32 m0, s76, 0
v_mfma_f32_16x16x32_bf16 v[176:179], a[72:75], a[24:27], v[176:179]
s_add_u32 s64, s72, 1792
ds_read_b64_tr_b16 a[72:73], v8 offset:32768
v_mfma_f32_16x16x32_bf16 v[180:183], a[80:83], a[24:27], v[180:183]
buffer_load_dwordx4 v12, s[48:51], s64 offen lds
v_mfma_f32_16x16x32_bf16 v[180:183], a[84:87], a[28:31], v[180:183]
ds_read_b64_tr_b16 a[74:75], v8 offset:33792
v_subrev_u32 v4, 0x8000, v4
v_mfma_f32_16x16x32_bf16 v[172:175], a[84:87], a[20:23], v[172:175]
ds_read_b64_tr_b16 a[76:77], v8 offset:40960
v_mfma_f32_16x16x32_bf16 v[172:175], a[80:83], a[16:19], v[172:175]
s_add_u32 m0, s76, 1024
ds_read_b64_tr_b16 a[78:79], v8 offset:41984
v_mfma_f32_16x16x32_bf16 v[164:167], a[80:83], a[8:11], v[164:167]
s_add_u32 s64, s72, 18176
v_mfma_f32_16x16x32_bf16 v[164:167], a[84:87], a[12:15], v[164:167]
buffer_load_dwordx4 v13, s[48:51], s64 offen lds
v_mfma_f32_16x16x32_bf16 v[156:159], a[84:87], a[4:7], v[156:159]
v_mfma_f32_16x16x32_bf16 v[156:159], a[80:83], a[0:3], v[156:159]
ds_read_b64_tr_b16 a[80:81], v9 offset:32768
v_mfma_f32_16x16x32_bf16 v[24:27], a[88:91], a[0:3], v[24:27]
s_add_u32 m0, s76, 2048
ds_read_b64_tr_b16 a[82:83], v9 offset:33792
v_mfma_f32_16x16x32_bf16 v[24:27], a[92:95], a[4:7], v[24:27]
s_add_u32 s64, s72, 132864
ds_read_b64_tr_b16 a[84:85], v9 offset:40960
v_subrev_u32 v5, 0x8000, v5
v_mfma_f32_16x16x32_bf16 v[40:43], a[92:95], a[12:15], v[40:43]
buffer_load_dwordx4 v12, s[48:51], s64 offen lds
v_mfma_f32_16x16x32_bf16 v[40:43], a[88:91], a[8:11], v[40:43]
ds_read_b64_tr_b16 a[86:87], v9 offset:41984
v_mfma_f32_16x16x32_bf16 v[56:59], a[88:91], a[16:19], v[56:59]
v_mfma_f32_16x16x32_bf16 v[56:59], a[92:95], a[20:23], v[56:59]
s_add_u32 m0, s76, 3072
v_mfma_f32_16x16x32_bf16 v[72:75], a[92:95], a[28:31], v[72:75]
s_waitcnt vmcnt(11)
s_add_u32 s64, s72, 149248
ds_read_b128 a[32:35], v2 offset:32768
v_mfma_f32_16x16x32_bf16 v[72:75], a[88:91], a[24:27], v[72:75]
buffer_load_dwordx4 v13, s[48:51], s64 offen lds
v_mfma_f32_16x16x32_bf16 v[136:139], a[96:99], a[24:27], v[136:139]
ds_read_b128 a[36:39], v3 offset:32768
v_mfma_f32_16x16x32_bf16 v[136:139], a[100:103], a[28:31], v[136:139]
ds_read_b128 a[40:43], v2 offset:34816
v_subrev_u32 v6, 0x8000, v6
v_mfma_f32_16x16x32_bf16 v[120:123], a[100:103], a[20:23], v[120:123]
s_add_u32 m0, s76, 4096
ds_read_b128 a[44:47], v3 offset:34816
v_mfma_f32_16x16x32_bf16 v[120:123], a[96:99], a[16:19], v[120:123]
s_add_u32 s64, s73, 1792
ds_read_b128 a[48:51], v2 offset:36864
v_mfma_f32_16x16x32_bf16 v[104:107], a[96:99], a[8:11], v[104:107]
buffer_load_dwordx4 v12, s[48:51], s64 offen lds
v_mfma_f32_16x16x32_bf16 v[104:107], a[100:103], a[12:15], v[104:107]
ds_read_b128 a[52:55], v3 offset:36864
v_mfma_f32_16x16x32_bf16 v[88:91], a[100:103], a[4:7], v[88:91]
ds_read_b128 a[56:59], v2 offset:38912
v_mfma_f32_16x16x32_bf16 v[88:91], a[96:99], a[0:3], v[88:91]
s_waitcnt lgkmcnt(7)
s_add_u32 m0, s76, 5120
ds_read_b128 a[60:63], v3 offset:38912
v_mfma_f32_16x16x32_bf16 v[28:31], a[104:107], a[0:3], v[28:31]
s_add_u32 s64, s73, 18176
ds_read_b64_tr_b16 a[88:89], v10 offset:32768
v_mfma_f32_16x16x32_bf16 v[28:31], a[108:111], a[4:7], v[28:31]
buffer_load_dwordx4 v13, s[48:51], s64 offen lds
v_mfma_f32_16x16x32_bf16 v[44:47], a[108:111], a[12:15], v[44:47]
ds_read_b64_tr_b16 a[90:91], v10 offset:33792
v_subrev_u32 v7, 0x8000, v7
v_mfma_f32_16x16x32_bf16 v[44:47], a[104:107], a[8:11], v[44:47]
ds_read_b64_tr_b16 a[92:93], v10 offset:40960
v_mfma_f32_16x16x32_bf16 v[60:63], a[104:107], a[16:19], v[60:63]
s_add_u32 m0, s76, 6144
ds_read_b64_tr_b16 a[94:95], v10 offset:41984
v_mfma_f32_16x16x32_bf16 v[60:63], a[108:111], a[20:23], v[60:63]
s_add_u32 s64, s73, 132864
ds_read_b64_tr_b16 a[96:97], v11 offset:32768
v_mfma_f32_16x16x32_bf16 v[76:79], a[108:111], a[28:31], v[76:79]
buffer_load_dwordx4 v12, s[48:51], s64 offen lds
v_mfma_f32_16x16x32_bf16 v[76:79], a[104:107], a[24:27], v[76:79]
ds_read_b64_tr_b16 a[98:99], v11 offset:33792
v_mfma_f32_16x16x32_bf16 v[140:143], a[112:115], a[24:27], v[140:143]
ds_read_b64_tr_b16 a[100:101], v11 offset:40960
v_mfma_f32_16x16x32_bf16 v[140:143], a[116:119], a[28:31], v[140:143]
s_add_u32 m0, s76, 7168
ds_read_b64_tr_b16 a[102:103], v11 offset:41984
v_subrev_u32 v8, 0x8000, v8
v_mfma_f32_16x16x32_bf16 v[124:127], a[116:119], a[20:23], v[124:127]
s_add_u32 s64, s73, 149248
v_mfma_f32_16x16x32_bf16 v[124:127], a[112:115], a[16:19], v[124:127]
buffer_load_dwordx4 v13, s[48:51], s64 offen lds
v_mfma_f32_16x16x32_bf16 v[108:111], a[112:115], a[8:11], v[108:111]
v_mfma_f32_16x16x32_bf16 v[108:111], a[116:119], a[12:15], v[108:111]
v_mfma_f32_16x16x32_bf16 v[92:95], a[116:119], a[4:7], v[92:95]
v_subrev_u32 v9, 0x8000, v9
v_subrev_u32 v10, 0x8000, v10
v_mfma_f32_16x16x32_bf16 v[92:95], a[112:115], a[0:3], v[92:95]
v_subrev_u32 v11, 0x8000, v11
v_mfma_f32_16x16x32_bf16 v[32:35], a[72:75], a[0:3], v[32:35]
v_mfma_f32_16x16x32_bf16 v[32:35], a[76:79], a[4:7], v[32:35]
v_mfma_f32_16x16x32_bf16 v[48:51], a[76:79], a[12:15], v[48:51]
s_waitcnt lgkmcnt(0)
s_barrier
v_mfma_f32_16x16x32_bf16 v[48:51], a[72:75], a[8:11], v[48:51]
s_mov_b64 exec, 1
buffer_atomic_add a251, v1, s[52:55], s70 offen offset:0 sc1
s_mov_b64 exec, -1
s_add_u32 m0, s77, 131072
v_mfma_f32_16x16x32_bf16 v[64:67], a[72:75], a[16:19], v[64:67]
s_lshl4_add_u32 s70, s78, s70
s_add_u32 s64, s71, 7864320
ds_read_b64_tr_b16 a[104:105], v19 offset:4096
v_mfma_f32_16x16x32_bf16 v[64:67], a[76:79], a[20:23], v[64:67]
s_lshr_b32 s81, s81, 5
buffer_load_dwordx4 v14, s[56:59], s64 offen lds
v_mfma_f32_16x16x32_bf16 v[80:83], a[76:79], a[28:31], v[80:83]
ds_read_b64_tr_b16 a[106:107], v19 offset:4352
v_mfma_f32_16x16x32_bf16 v[80:83], a[72:75], a[24:27], v[80:83]
ds_read_b64_tr_b16 a[108:109], v19 offset:6144
v_mfma_f32_16x16x32_bf16 v[144:147], a[80:83], a[24:27], v[144:147]
ds_read_b64_tr_b16 a[110:111], v19 offset:6400
v_mfma_f32_16x16x32_bf16 v[144:147], a[84:87], a[28:31], v[144:147]
ds_read_b64_tr_b16 a[112:113], v20 offset:4096
v_mfma_f32_16x16x32_bf16 v[128:131], a[84:87], a[20:23], v[128:131]
ds_read_b64_tr_b16 a[114:115], v20 offset:4352
v_mfma_f32_16x16x32_bf16 v[128:131], a[80:83], a[16:19], v[128:131]
ds_read_b64_tr_b16 a[116:117], v20 offset:6144
v_mfma_f32_16x16x32_bf16 v[112:115], a[80:83], a[8:11], v[112:115]
s_add_u32 m0, s78, 147456
ds_read_b64_tr_b16 a[118:119], v20 offset:6400
v_mfma_f32_16x16x32_bf16 v[112:115], a[84:87], a[12:15], v[112:115]
s_add_u32 s64, s75, 5898240
ds_read_b64_tr_b16 a[72:73], v19 offset:8192
v_mfma_f32_16x16x32_bf16 v[96:99], a[84:87], a[4:7], v[96:99]
buffer_load_dwordx4 v23, s[60:63], s64 offen lds
v_mfma_f32_16x16x32_bf16 v[96:99], a[80:83], a[0:3], v[96:99]
ds_read_b64_tr_b16 a[74:75], v19 offset:8448
v_mfma_f32_16x16x32_bf16 v[36:39], a[88:91], a[0:3], v[36:39]
ds_read_b64_tr_b16 a[76:77], v19 offset:10240
v_mfma_f32_16x16x32_bf16 v[36:39], a[92:95], a[4:7], v[36:39]
ds_read_b64_tr_b16 a[78:79], v19 offset:10496
v_mfma_f32_16x16x32_bf16 v[52:55], a[92:95], a[12:15], v[52:55]
ds_read_b64_tr_b16 a[80:81], v20 offset:8192
v_mfma_f32_16x16x32_bf16 v[52:55], a[88:91], a[8:11], v[52:55]
ds_read_b64_tr_b16 a[82:83], v20 offset:8448
v_mfma_f32_16x16x32_bf16 v[68:71], a[88:91], a[16:19], v[68:71]
ds_read_b64_tr_b16 a[84:85], v20 offset:10240
v_mfma_f32_16x16x32_bf16 v[68:71], a[92:95], a[20:23], v[68:71]
s_add_u32 m0, s77, 132096
ds_read_b64_tr_b16 a[86:87], v20 offset:10496
v_mfma_f32_16x16x32_bf16 v[84:87], a[92:95], a[28:31], v[84:87]
s_add_u32 s64, s71, 7897088
v_mfma_f32_16x16x32_bf16 v[84:87], a[88:91], a[24:27], v[84:87]
buffer_load_dwordx4 v14, s[56:59], s64 offen lds
v_mfma_f32_16x16x32_bf16 v[148:151], a[96:99], a[24:27], v[148:151]
ds_read_b64_tr_b16 a[88:89], v19 offset:0
v_mfma_f32_16x16x32_bf16 v[148:151], a[100:103], a[28:31], v[148:151]
ds_read_b64_tr_b16 a[90:91], v19 offset:256
v_mfma_f32_16x16x32_bf16 v[132:135], a[100:103], a[20:23], v[132:135]
ds_read_b64_tr_b16 a[92:93], v19 offset:2048
v_mfma_f32_16x16x32_bf16 v[132:135], a[96:99], a[16:19], v[132:135]
ds_read_b64_tr_b16 a[94:95], v19 offset:2304
v_mfma_f32_16x16x32_bf16 v[116:119], a[96:99], a[8:11], v[116:119]
v_mfma_f32_16x16x32_bf16 v[116:119], a[100:103], a[12:15], v[116:119]
v_mfma_f32_16x16x32_bf16 v[100:103], a[100:103], a[4:7], v[100:103]
s_add_u32 m0, s78, 151552
v_mfma_f32_16x16x32_bf16 v[100:103], a[96:99], a[0:3], v[100:103]
s_waitcnt lgkmcnt(4)
s_add_u32 s64, s75, 5900288
ds_read_b64_tr_b16 a[96:97], v20 offset:0
v_mfma_f32_16x16x32_bf16 v[184:187], a[104:107], a[32:35], v[184:187]
buffer_load_dwordx4 v23, s[60:63], s64 offen lds
v_mfma_f32_16x16x32_bf16 v[184:187], a[108:111], a[36:39], v[184:187]
ds_read_b64_tr_b16 a[98:99], v20 offset:256
v_and_b32 v22, 15, v0
v_mfma_f32_16x16x32_bf16 v[192:195], a[108:111], a[44:47], v[192:195]
ds_read_b64_tr_b16 a[100:101], v20 offset:2048
v_lshlrev_b32 v22, 3, v22
v_mfma_f32_16x16x32_bf16 v[192:195], a[104:107], a[40:43], v[192:195]
s_lshl_b32 s85, s30, 7
s_add_u32 s85, s85, 58720256
ds_read_b64_tr_b16 a[102:103], v20 offset:2304
v_mfma_f32_16x16x32_bf16 v[200:203], a[104:107], a[48:51], v[200:203]
s_lshl_b32 s86, s3, 10
s_add_u32 s86, s86, s85
s_lshl_b32 s87, s16, 10
s_lshl_b32 s68, s31, 20
s_add_u32 s32, s28, s68
s_addc_u32 s33, s29, 0
v_mfma_f32_16x16x32_bf16 v[200:203], a[108:111], a[52:55], v[200:203]
s_add_u32 s87, s87, s85
s_add_u32 s68, s16, 1
s_lshl_b32 s34, s68, 16
v_mfma_f32_16x16x32_bf16 v[208:211], a[108:111], a[60:63], v[208:211]
v_mfma_f32_16x16x32_bf16 v[208:211], a[104:107], a[56:59], v[208:211]
ds_read_b64_tr_b16 a[104:105], v4 offset:0
v_mfma_f32_16x16x32_bf16 v[212:215], a[112:115], a[56:59], v[212:215]
s_add_u32 m0, s77, 133120
ds_read_b64_tr_b16 a[106:107], v4 offset:1024
v_mfma_f32_16x16x32_bf16 v[212:215], a[116:119], a[60:63], v[212:215]
s_add_u32 s64, s71, 7929856
ds_read_b64_tr_b16 a[108:109], v4 offset:8192
v_mfma_f32_16x16x32_bf16 v[204:207], a[116:119], a[52:55], v[204:207]
buffer_load_dwordx4 v15, s[56:59], s64 offen lds
v_mfma_f32_16x16x32_bf16 v[204:207], a[112:115], a[48:51], v[204:207]
ds_read_b64_tr_b16 a[110:111], v4 offset:9216
v_mfma_f32_16x16x32_bf16 v[196:199], a[112:115], a[40:43], v[196:199]
v_mfma_f32_16x16x32_bf16 v[196:199], a[116:119], a[44:47], v[196:199]
v_mfma_f32_16x16x32_bf16 v[188:191], a[116:119], a[36:39], v[188:191]
v_mfma_f32_16x16x32_bf16 v[188:191], a[112:115], a[32:35], v[188:191]
ds_read_b64_tr_b16 a[112:113], v5 offset:0
v_mfma_f32_16x16x32_bf16 v[216:219], a[32:35], a[72:75], v[216:219]
ds_read_b64_tr_b16 a[114:115], v5 offset:1024
v_mfma_f32_16x16x32_bf16 v[216:219], a[36:39], a[76:79], v[216:219]
s_add_u32 m0, s78, 155648
ds_read_b64_tr_b16 a[116:117], v5 offset:8192
v_mfma_f32_16x16x32_bf16 v[224:227], a[44:47], a[76:79], v[224:227]
s_add_u32 s64, s75, 5902336
ds_read_b64_tr_b16 a[118:119], v5 offset:9216
v_mfma_f32_16x16x32_bf16 v[224:227], a[40:43], a[72:75], v[224:227]
buffer_load_dwordx4 v23, s[60:63], s64 offen lds
v_mfma_f32_16x16x32_bf16 v[232:235], a[48:51], a[72:75], v[232:235]
v_mfma_f32_16x16x32_bf16 v[232:235], a[52:55], a[76:79], v[232:235]
v_mfma_f32_16x16x32_bf16 v[240:243], a[60:63], a[76:79], v[240:243]
v_mfma_f32_16x16x32_bf16 v[240:243], a[56:59], a[72:75], v[240:243]
ds_read_b64_tr_b16 a[72:73], v6 offset:0
v_mfma_f32_16x16x32_bf16 v[244:247], a[56:59], a[80:83], v[244:247]
ds_read_b64_tr_b16 a[74:75], v6 offset:1024
v_mfma_f32_16x16x32_bf16 v[244:247], a[60:63], a[84:87], v[244:247]
ds_read_b64_tr_b16 a[76:77], v6 offset:8192
v_mfma_f32_16x16x32_bf16 v[236:239], a[52:55], a[84:87], v[236:239]
s_add_u32 m0, s77, 134144
ds_read_b64_tr_b16 a[78:79], v6 offset:9216
v_mfma_f32_16x16x32_bf16 v[236:239], a[48:51], a[80:83], v[236:239]
s_add_u32 s64, s71, 7962624
v_mfma_f32_16x16x32_bf16 v[228:231], a[40:43], a[80:83], v[228:231]
buffer_load_dwordx4 v15, s[56:59], s64 offen lds
v_mfma_f32_16x16x32_bf16 v[228:231], a[44:47], a[84:87], v[228:231]
v_mfma_f32_16x16x32_bf16 v[220:223], a[36:39], a[84:87], v[220:223]
v_mfma_f32_16x16x32_bf16 v[220:223], a[32:35], a[80:83], v[220:223]
s_waitcnt lgkmcnt(4)
ds_read_b64_tr_b16 a[80:81], v7 offset:0
v_mfma_f32_16x16x32_bf16 v[152:155], a[88:91], a[32:35], v[152:155]
ds_read_b64_tr_b16 a[82:83], v7 offset:1024
v_mfma_f32_16x16x32_bf16 v[152:155], a[92:95], a[36:39], v[152:155]
ds_read_b64_tr_b16 a[84:85], v7 offset:8192
v_mfma_f32_16x16x32_bf16 v[160:163], a[92:95], a[44:47], v[160:163]
ds_read_b64_tr_b16 a[86:87], v7 offset:9216
v_mfma_f32_16x16x32_bf16 v[160:163], a[88:91], a[40:43], v[160:163]
v_mfma_f32_16x16x32_bf16 v[168:171], a[88:91], a[48:51], v[168:171]
v_mfma_f32_16x16x32_bf16 v[168:171], a[92:95], a[52:55], v[168:171]
v_mfma_f32_16x16x32_bf16 v[176:179], a[92:95], a[60:63], v[176:179]
s_add_u32 m0, s76, 32768
v_mfma_f32_16x16x32_bf16 v[176:179], a[88:91], a[56:59], v[176:179]
s_add_u32 s64, s72, 1920
ds_read_b64_tr_b16 a[88:89], v8 offset:0
v_mfma_f32_16x16x32_bf16 v[180:183], a[96:99], a[56:59], v[180:183]
buffer_load_dwordx4 v12, s[48:51], s64 offen lds
v_mfma_f32_16x16x32_bf16 v[180:183], a[100:103], a[60:63], v[180:183]
ds_read_b64_tr_b16 a[90:91], v8 offset:1024
v_mfma_f32_16x16x32_bf16 v[172:175], a[100:103], a[52:55], v[172:175]
ds_read_b64_tr_b16 a[92:93], v8 offset:8192
v_mfma_f32_16x16x32_bf16 v[172:175], a[96:99], a[48:51], v[172:175]
s_add_u32 m0, s76, 33792
ds_read_b64_tr_b16 a[94:95], v8 offset:9216
v_mfma_f32_16x16x32_bf16 v[164:167], a[96:99], a[40:43], v[164:167]
s_add_u32 s64, s72, 18304
v_mfma_f32_16x16x32_bf16 v[164:167], a[100:103], a[44:47], v[164:167]
buffer_load_dwordx4 v13, s[48:51], s64 offen lds
v_mfma_f32_16x16x32_bf16 v[156:159], a[100:103], a[36:39], v[156:159]
v_mfma_f32_16x16x32_bf16 v[156:159], a[96:99], a[32:35], v[156:159]
ds_read_b64_tr_b16 a[96:97], v9 offset:0
v_mfma_f32_16x16x32_bf16 v[24:27], a[104:107], a[32:35], v[24:27]
s_add_u32 m0, s76, 34816
ds_read_b64_tr_b16 a[98:99], v9 offset:1024
v_mfma_f32_16x16x32_bf16 v[24:27], a[108:111], a[36:39], v[24:27]
s_add_u32 s64, s72, 132992
ds_read_b64_tr_b16 a[100:101], v9 offset:8192
v_mfma_f32_16x16x32_bf16 v[40:43], a[108:111], a[44:47], v[40:43]
buffer_load_dwordx4 v12, s[48:51], s64 offen lds
v_mfma_f32_16x16x32_bf16 v[40:43], a[104:107], a[40:43], v[40:43]
ds_read_b64_tr_b16 a[102:103], v9 offset:9216
v_mfma_f32_16x16x32_bf16 v[56:59], a[104:107], a[48:51], v[56:59]
v_mfma_f32_16x16x32_bf16 v[56:59], a[108:111], a[52:55], v[56:59]
s_add_u32 m0, s76, 35840
v_mfma_f32_16x16x32_bf16 v[72:75], a[108:111], a[60:63], v[72:75]
s_waitcnt vmcnt(11)
s_add_u32 s64, s72, 149376
ds_read_b128 a[0:3], v2 offset:0
v_mfma_f32_16x16x32_bf16 v[72:75], a[104:107], a[56:59], v[72:75]
buffer_load_dwordx4 v13, s[48:51], s64 offen lds
v_mfma_f32_16x16x32_bf16 v[136:139], a[112:115], a[56:59], v[136:139]
ds_read_b128 a[4:7], v3 offset:0
v_mfma_f32_16x16x32_bf16 v[136:139], a[116:119], a[60:63], v[136:139]
ds_read_b128 a[8:11], v2 offset:2048
v_mfma_f32_16x16x32_bf16 v[120:123], a[116:119], a[52:55], v[120:123]
s_add_u32 m0, s76, 36864
ds_read_b128 a[12:15], v3 offset:2048
v_mfma_f32_16x16x32_bf16 v[120:123], a[112:115], a[48:51], v[120:123]
s_add_u32 s64, s73, 1920
ds_read_b128 a[16:19], v2 offset:4096
v_mfma_f32_16x16x32_bf16 v[104:107], a[112:115], a[40:43], v[104:107]
buffer_load_dwordx4 v12, s[48:51], s64 offen lds
v_mfma_f32_16x16x32_bf16 v[104:107], a[116:119], a[44:47], v[104:107]
ds_read_b128 a[20:23], v3 offset:4096
v_mfma_f32_16x16x32_bf16 v[88:91], a[116:119], a[36:39], v[88:91]
ds_read_b128 a[24:27], v2 offset:6144
v_mfma_f32_16x16x32_bf16 v[88:91], a[112:115], a[32:35], v[88:91]
s_waitcnt lgkmcnt(7)
s_add_u32 m0, s76, 37888
ds_read_b128 a[28:31], v3 offset:6144
v_mfma_f32_16x16x32_bf16 v[28:31], a[72:75], a[32:35], v[28:31]
s_add_u32 s64, s73, 18304
ds_read_b64_tr_b16 a[104:105], v10 offset:0
v_mfma_f32_16x16x32_bf16 v[28:31], a[76:79], a[36:39], v[28:31]
buffer_load_dwordx4 v13, s[48:51], s64 offen lds
v_mfma_f32_16x16x32_bf16 v[44:47], a[76:79], a[44:47], v[44:47]
ds_read_b64_tr_b16 a[106:107], v10 offset:1024
v_mfma_f32_16x16x32_bf16 v[44:47], a[72:75], a[40:43], v[44:47]
ds_read_b64_tr_b16 a[108:109], v10 offset:8192
v_mfma_f32_16x16x32_bf16 v[60:63], a[72:75], a[48:51], v[60:63]
s_add_u32 m0, s76, 38912
buffer_load_dword v1, off, s[52:55], s70 sc1
v_mfma_f32_16x16x32_bf16 v[60:63], a[76:79], a[52:55], v[60:63]
s_add_u32 s64, s73, 132992
ds_read_b64_tr_b16 a[110:111], v10 offset:9216
v_mfma_f32_16x16x32_bf16 v[76:79], a[76:79], a[60:63], v[76:79]
buffer_load_dwordx4 v12, s[48:51], s64 offen lds
v_mfma_f32_16x16x32_bf16 v[76:79], a[72:75], a[56:59], v[76:79]
ds_read_b64_tr_b16 a[112:113], v11 offset:0
v_mfma_f32_16x16x32_bf16 v[140:143], a[80:83], a[56:59], v[140:143]
ds_read_b64_tr_b16 a[114:115], v11 offset:1024
v_mfma_f32_16x16x32_bf16 v[140:143], a[84:87], a[60:63], v[140:143]
s_add_u32 m0, s76, 39936
ds_read_b64_tr_b16 a[116:117], v11 offset:8192
v_mfma_f32_16x16x32_bf16 v[124:127], a[84:87], a[52:55], v[124:127]
s_add_u32 s64, s73, 149376
ds_read_b64_tr_b16 a[118:119], v11 offset:9216
v_mfma_f32_16x16x32_bf16 v[124:127], a[80:83], a[48:51], v[124:127]
buffer_load_dwordx4 v13, s[48:51], s64 offen lds
v_mfma_f32_16x16x32_bf16 v[108:111], a[80:83], a[40:43], v[108:111]
v_mfma_f32_16x16x32_bf16 v[108:111], a[84:87], a[44:47], v[108:111]
v_mfma_f32_16x16x32_bf16 v[92:95], a[84:87], a[36:39], v[92:95]
buffer_load_dwordx2 a[64:65], v22, s[44:47], s86 offen offset:0 sc1
v_mfma_f32_16x16x32_bf16 v[92:95], a[80:83], a[32:35], v[92:95]
buffer_load_dwordx2 a[66:67], v22, s[44:47], s86 offen offset:512 sc1
v_mfma_f32_16x16x32_bf16 v[32:35], a[88:91], a[32:35], v[32:35]
buffer_load_dwordx2 a[68:69], v22, s[44:47], s87 offen offset:0 sc1
v_mfma_f32_16x16x32_bf16 v[32:35], a[92:95], a[36:39], v[32:35]
buffer_load_dwordx2 a[70:71], v22, s[44:47], s87 offen offset:512 sc1
v_mfma_f32_16x16x32_bf16 v[48:51], a[92:95], a[44:47], v[48:51]
s_waitcnt lgkmcnt(0)
s_barrier
v_mfma_f32_16x16x32_bf16 v[48:51], a[88:91], a[40:43], v[48:51]
ds_read_b64_tr_b16 a[72:73], v19 offset:36864
v_mfma_f32_16x16x32_bf16 v[64:67], a[88:91], a[48:51], v[64:67]
s_lshl2_add_u32 s72, s2, s30
ds_read_b64_tr_b16 a[74:75], v19 offset:37120
v_mfma_f32_16x16x32_bf16 v[64:67], a[92:95], a[52:55], v[64:67]
s_lshl_b32 s72, s72, 12
ds_read_b64_tr_b16 a[76:77], v19 offset:38912
v_mfma_f32_16x16x32_bf16 v[80:83], a[92:95], a[60:63], v[80:83]
s_add_u32 s72, s72, 67108864
ds_read_b64_tr_b16 a[78:79], v19 offset:39168
v_mfma_f32_16x16x32_bf16 v[80:83], a[88:91], a[56:59], v[80:83]
ds_read_b64_tr_b16 a[80:81], v20 offset:36864
v_mfma_f32_16x16x32_bf16 v[144:147], a[96:99], a[56:59], v[144:147]
ds_read_b64_tr_b16 a[82:83], v20 offset:37120
v_mfma_f32_16x16x32_bf16 v[144:147], a[100:103], a[60:63], v[144:147]
ds_read_b64_tr_b16 a[84:85], v20 offset:38912
v_mfma_f32_16x16x32_bf16 v[128:131], a[100:103], a[52:55], v[128:131]
ds_read_b64_tr_b16 a[86:87], v20 offset:39168
v_mfma_f32_16x16x32_bf16 v[128:131], a[96:99], a[48:51], v[128:131]
ds_read_b64_tr_b16 a[88:89], v19 offset:40960
v_mfma_f32_16x16x32_bf16 v[112:115], a[96:99], a[40:43], v[112:115]
ds_read_b64_tr_b16 a[90:91], v19 offset:41216
v_mfma_f32_16x16x32_bf16 v[112:115], a[100:103], a[44:47], v[112:115]
ds_read_b64_tr_b16 a[92:93], v19 offset:43008
v_mfma_f32_16x16x32_bf16 v[96:99], a[100:103], a[36:39], v[96:99]
ds_read_b64_tr_b16 a[94:95], v19 offset:43264
v_mfma_f32_16x16x32_bf16 v[96:99], a[96:99], a[32:35], v[96:99]
ds_read_b64_tr_b16 a[96:97], v20 offset:40960
v_mfma_f32_16x16x32_bf16 v[36:39], a[104:107], a[32:35], v[36:39]
buffer_store_dwordx4 a[240:243], v16, s[44:47], s72 offen offset:0 sc1
v_mfma_f32_16x16x32_bf16 v[36:39], a[108:111], a[36:39], v[36:39]
ds_read_b64_tr_b16 a[98:99], v20 offset:41216
v_mfma_f32_16x16x32_bf16 v[52:55], a[108:111], a[44:47], v[52:55]
ds_read_b64_tr_b16 a[100:101], v20 offset:43008
v_mfma_f32_16x16x32_bf16 v[52:55], a[104:107], a[40:43], v[52:55]
ds_read_b64_tr_b16 a[102:103], v20 offset:43264
v_mfma_f32_16x16x32_bf16 v[68:71], a[104:107], a[48:51], v[68:71]
v_mfma_f32_16x16x32_bf16 v[68:71], a[108:111], a[52:55], v[68:71]
v_mfma_f32_16x16x32_bf16 v[84:87], a[108:111], a[60:63], v[84:87]
v_mfma_f32_16x16x32_bf16 v[84:87], a[104:107], a[56:59], v[84:87]
ds_read_b64_tr_b16 a[104:105], v19 offset:32768
v_mfma_f32_16x16x32_bf16 v[148:151], a[112:115], a[56:59], v[148:151]
ds_read_b64_tr_b16 a[106:107], v19 offset:33024
v_mfma_f32_16x16x32_bf16 v[148:151], a[116:119], a[60:63], v[148:151]
ds_read_b64_tr_b16 a[108:109], v19 offset:34816
v_mfma_f32_16x16x32_bf16 v[132:135], a[116:119], a[52:55], v[132:135]
ds_read_b64_tr_b16 a[110:111], v19 offset:35072
v_mfma_f32_16x16x32_bf16 v[132:135], a[112:115], a[48:51], v[132:135]
v_mfma_f32_16x16x32_bf16 v[116:119], a[112:115], a[40:43], v[116:119]
v_mfma_f32_16x16x32_bf16 v[116:119], a[116:119], a[44:47], v[116:119]
v_mfma_f32_16x16x32_bf16 v[100:103], a[116:119], a[36:39], v[100:103]
buffer_store_dwordx4 a[240:243], v16, s[44:47], s72 offen offset:1024 sc1
v_mfma_f32_16x16x32_bf16 v[100:103], a[112:115], a[32:35], v[100:103]
s_waitcnt lgkmcnt(4)
ds_read_b64_tr_b16 a[112:113], v20 offset:32768
v_mfma_f32_16x16x32_bf16 v[184:187], a[72:75], a[0:3], v[184:187]
ds_read_b64_tr_b16 a[114:115], v20 offset:33024
v_and_b32 v12, 15, v0
v_mfma_f32_16x16x32_bf16 v[184:187], a[76:79], a[4:7], v[184:187]
ds_read_b64_tr_b16 a[116:117], v20 offset:34816
v_lshrrev_b32 v13, 4, v0
v_mfma_f32_16x16x32_bf16 v[192:195], a[76:79], a[12:15], v[192:195]
ds_read_b64_tr_b16 a[118:119], v20 offset:35072
v_lshlrev_b32 v13, 2, v13
v_mfma_f32_16x16x32_bf16 v[192:195], a[72:75], a[8:11], v[192:195]
v_sub_u32 v12, v12, v13
v_mfma_f32_16x16x32_bf16 v[200:203], a[72:75], a[16:19], v[200:203]
s_lshl_b32 s66, s30, 4
v_mfma_f32_16x16x32_bf16 v[200:203], a[76:79], a[20:23], v[200:203]
v_add_u32 v13, s66, v12
v_cmp_gt_i32 s[0:1], 0, v13
v_mfma_f32_16x16x32_bf16 v[208:211], a[76:79], a[28:31], v[208:211]
v_cmp_gt_i32 s[4:5], 1, v13
v_cmp_gt_i32 s[6:7], 2, v13
v_mfma_f32_16x16x32_bf16 v[208:211], a[72:75], a[24:27], v[208:211]
ds_read_b64_tr_b16 a[72:73], v4 offset:32768
v_cmp_gt_i32 s[8:9], 3, v13
v_mfma_f32_16x16x32_bf16 v[212:215], a[80:83], a[24:27], v[212:215]
ds_read_b64_tr_b16 a[74:75], v4 offset:33792
v_cmp_gt_i32 s[10:11], 16, v13
v_mfma_f32_16x16x32_bf16 v[212:215], a[84:87], a[28:31], v[212:215]
ds_read_b64_tr_b16 a[76:77], v4 offset:40960
v_cmp_gt_i32 s[12:13], 17, v13
v_mfma_f32_16x16x32_bf16 v[204:207], a[84:87], a[20:23], v[204:207]
ds_read_b64_tr_b16 a[78:79], v4 offset:41984
v_cmp_gt_i32 s[18:19], 18, v13
v_mfma_f32_16x16x32_bf16 v[204:207], a[80:83], a[16:19], v[204:207]
v_cmp_gt_i32 s[22:23], 19, v13
v_cmp_gt_i32 s[26:27], 32, v13
v_mfma_f32_16x16x32_bf16 v[196:199], a[80:83], a[8:11], v[196:199]
buffer_store_dwordx4 a[240:243], v16, s[44:47], s72 offen offset:2048 sc1
v_mfma_f32_16x16x32_bf16 v[196:199], a[84:87], a[12:15], v[196:199]
v_cmp_gt_i32 s[56:57], 33, v13
v_cmp_gt_i32 s[58:59], 34, v13
v_mfma_f32_16x16x32_bf16 v[188:191], a[84:87], a[4:7], v[188:191]
v_cmp_gt_i32 s[60:61], 35, v13
v_cmp_gt_i32 s[62:63], 48, v13
v_mfma_f32_16x16x32_bf16 v[188:191], a[80:83], a[0:3], v[188:191]
ds_read_b64_tr_b16 a[80:81], v5 offset:32768
v_cmp_gt_i32 s[48:49], 49, v13
v_mfma_f32_16x16x32_bf16 v[216:219], a[0:3], a[88:91], v[216:219]
ds_read_b64_tr_b16 a[82:83], v5 offset:33792
v_cmp_gt_i32 s[50:51], 50, v13
v_mfma_f32_16x16x32_bf16 v[216:219], a[4:7], a[92:95], v[216:219]
ds_read_b64_tr_b16 a[84:85], v5 offset:40960
v_cmp_gt_i32 s[100:101], 51, v13
v_mfma_f32_16x16x32_bf16 v[224:227], a[12:15], a[92:95], v[224:227]
ds_read_b64_tr_b16 a[86:87], v5 offset:41984
v_subrev_u32 v17, 0, v12
v_mfma_f32_16x16x32_bf16 v[224:227], a[8:11], a[88:91], v[224:227]
v_lshlrev_b32 v18, 31, v17
v_or_b32 v21, v17, v18
v_mfma_f32_16x16x32_bf16 v[232:235], a[16:19], a[88:91], v[232:235]
v_ashrrev_i32 v21, 31, v21
v_and_b32 v248, 0xff800000, v21
v_mfma_f32_16x16x32_bf16 v[232:235], a[20:23], a[92:95], v[232:235]
v_not_b32 v17, v17
v_or_b32 v21, v17, v18
v_mfma_f32_16x16x32_bf16 v[240:243], a[28:31], a[92:95], v[240:243]
v_ashrrev_i32 v21, 31, v21
v_and_b32 v252, 0xff800000, v21
v_mfma_f32_16x16x32_bf16 v[240:243], a[24:27], a[88:91], v[240:243]
ds_read_b64_tr_b16 a[88:89], v6 offset:32768
v_subrev_u32 v17, 1, v12
v_mfma_f32_16x16x32_bf16 v[244:247], a[24:27], a[96:99], v[244:247]
ds_read_b64_tr_b16 a[90:91], v6 offset:33792
v_lshlrev_b32 v18, 31, v17
v_mfma_f32_16x16x32_bf16 v[244:247], a[28:31], a[100:103], v[244:247]
ds_read_b64_tr_b16 a[92:93], v6 offset:40960
v_add_u32 v19, 0x8000, v19
v_mfma_f32_16x16x32_bf16 v[236:239], a[20:23], a[100:103], v[236:239]
buffer_store_dwordx4 a[240:243], v16, s[44:47], s72 offen offset:3072 sc1
v_mfma_f32_16x16x32_bf16 v[236:239], a[16:19], a[96:99], v[236:239]
ds_read_b64_tr_b16 a[94:95], v6 offset:41984
v_or_b32 v21, v17, v18
v_mfma_f32_16x16x32_bf16 v[228:231], a[8:11], a[96:99], v[228:231]
v_ashrrev_i32 v21, 31, v21
v_and_b32 v249, 0xff800000, v21
v_mfma_f32_16x16x32_bf16 v[228:231], a[12:15], a[100:103], v[228:231]
v_not_b32 v17, v17
v_or_b32 v21, v17, v18
v_mfma_f32_16x16x32_bf16 v[220:223], a[4:7], a[100:103], v[220:223]
v_ashrrev_i32 v21, 31, v21
v_and_b32 v253, 0xff800000, v21
v_mfma_f32_16x16x32_bf16 v[220:223], a[0:3], a[96:99], v[220:223]
s_waitcnt lgkmcnt(4)
ds_read_b64_tr_b16 a[96:97], v7 offset:32768
v_subrev_u32 v17, 2, v12
v_mfma_f32_16x16x32_bf16 v[152:155], a[104:107], a[0:3], v[152:155]
ds_read_b64_tr_b16 a[98:99], v7 offset:33792
v_lshlrev_b32 v18, 31, v17
v_mfma_f32_16x16x32_bf16 v[152:155], a[108:111], a[4:7], v[152:155]
ds_read_b64_tr_b16 a[100:101], v7 offset:40960
v_add_u32 v20, 0x8000, v20
v_mfma_f32_16x16x32_bf16 v[160:163], a[108:111], a[12:15], v[160:163]
ds_read_b64_tr_b16 a[102:103], v7 offset:41984
v_or_b32 v21, v17, v18
v_mfma_f32_16x16x32_bf16 v[160:163], a[104:107], a[8:11], v[160:163]
v_ashrrev_i32 v21, 31, v21
v_and_b32 v250, 0xff800000, v21
v_mfma_f32_16x16x32_bf16 v[168:171], a[104:107], a[16:19], v[168:171]
v_not_b32 v17, v17
v_or_b32 v21, v17, v18
v_mfma_f32_16x16x32_bf16 v[168:171], a[108:111], a[20:23], v[168:171]
v_ashrrev_i32 v21, 31, v21
v_and_b32 v254, 0xff800000, v21
v_mfma_f32_16x16x32_bf16 v[176:179], a[108:111], a[28:31], v[176:179]
v_subrev_u32 v17, 3, v12
v_lshlrev_b32 v18, 31, v17
v_mfma_f32_16x16x32_bf16 v[176:179], a[104:107], a[24:27], v[176:179]
ds_read_b64_tr_b16 a[104:105], v8 offset:32768
v_or_b32 v21, v17, v18
v_mfma_f32_16x16x32_bf16 v[180:183], a[112:115], a[24:27], v[180:183]
ds_read_b64_tr_b16 a[106:107], v8 offset:33792
v_ashrrev_i32 v21, 31, v21
v_mfma_f32_16x16x32_bf16 v[180:183], a[116:119], a[28:31], v[180:183]
ds_read_b64_tr_b16 a[108:109], v8 offset:40960
v_add_u32 v4, 0x8000, v4
v_mfma_f32_16x16x32_bf16 v[172:175], a[116:119], a[20:23], v[172:175]
ds_read_b64_tr_b16 a[110:111], v8 offset:41984
v_and_b32 v251, 0xff800000, v21
v_mfma_f32_16x16x32_bf16 v[172:175], a[112:115], a[16:19], v[172:175]
v_not_b32 v17, v17
v_or_b32 v21, v17, v18
v_mfma_f32_16x16x32_bf16 v[164:167], a[112:115], a[8:11], v[164:167]
s_add_u32 s17, s78, .-L_pc+6144
v_ashrrev_i32 v21, 31, v21
v_and_b32 v255, 0xff800000, v21
v_mfma_f32_16x16x32_bf16 v[164:167], a[116:119], a[12:15], v[164:167]
s_and_b32 s66, s2, 7
s_lshr_b32 s67, s2, 3
s_and_b32 s83, s66, 1
v_mfma_f32_16x16x32_bf16 v[156:159], a[116:119], a[4:7], v[156:159]
s_and_b32 s68, s66, 2
s_and_b32 s69, s67, 7
s_lshl2_add_u32 s82, s68, s69
v_mfma_f32_16x16x32_bf16 v[156:159], a[112:115], a[0:3], v[156:159]
s_and_b32 s68, s66, 4
s_lshr_b32 s69, s67, 3
ds_read_b64_tr_b16 a[112:113], v9 offset:32768
v_mfma_f32_16x16x32_bf16 v[24:27], a[72:75], a[0:3], v[24:27]
s_xor_b32 s69, s69, 0
s_add_u32 s87, s68, s69
ds_read_b64_tr_b16 a[114:115], v9 offset:33792
v_mfma_f32_16x16x32_bf16 v[24:27], a[76:79], a[4:7], v[24:27]
s_lshl_b32 s87, s87, 8
ds_read_b64_tr_b16 a[116:117], v9 offset:40960
v_add_u32 v5, 0x8000, v5
v_mfma_f32_16x16x32_bf16 v[40:43], a[76:79], a[12:15], v[40:43]
s_lshl_b32 s86, s30, 13
buffer_load_dword a252, v16, s[88:91], s17 offen
v_mfma_f32_16x16x32_bf16 v[40:43], a[72:75], a[8:11], v[40:43]
s_lshl_b32 s85, s30, 16
s_add_u32 s85, s85, s87
ds_read_b64_tr_b16 a[118:119], v9 offset:41984
v_mfma_f32_16x16x32_bf16 v[56:59], a[72:75], a[16:19], v[56:59]
s_mul_i32 s66, s83, 1310720
s_add_u32 s85, s85, s66
s_mul_i32 s84, s82, 1310720
v_mfma_f32_16x16x32_bf16 v[56:59], a[76:79], a[20:23], v[56:59]
s_and_b32 s66, s30, 1
s_lshl_b32 s66, s66, 14
s_add_u32 s84, s84, s66
v_mfma_f32_16x16x32_bf16 v[72:75], a[76:79], a[28:31], v[72:75]
s_waitcnt vmcnt(9)
s_mul_i32 s66, s83, 163840
ds_read_b128 a[32:35], v2 offset:32768
v_mfma_f32_16x16x32_bf16 v[72:75], a[72:75], a[24:27], v[72:75]
s_add_u32 s84, s84, s66
s_add_u32 s84, s84, 34603008
s_add_u32 s17, s78, .-L_pc+9984
ds_read_b128 a[36:39], v3 offset:32768
v_mfma_f32_16x16x32_bf16 v[136:139], a[80:83], a[24:27], v[136:139]
s_sub_u32 s66, 15, s82
buffer_load_dword a252, v16, s[88:91], s17 offen
v_mfma_f32_16x16x32_bf16 v[136:139], a[84:87], a[28:31], v[136:139]
s_min_u32 s66, s66, s82
ds_read_b128 a[40:43], v2 offset:34816
v_add_u32 v6, 0x8000, v6
v_mfma_f32_16x16x32_bf16 v[120:123], a[84:87], a[20:23], v[120:123]
s_lshl1_add_u32 s66, s66, s83
s_lshl_b32 s80, s66, 8
ds_read_b128 a[44:47], v3 offset:34816
v_mfma_f32_16x16x32_bf16 v[120:123], a[80:83], a[16:19], v[120:123]
s_add_u32 s80, s80, 8192
s_and_b32 s67, s30, 1
ds_read_b128 a[48:51], v2 offset:36864
v_mfma_f32_16x16x32_bf16 v[104:107], a[80:83], a[8:11], v[104:107]
s_lshl_b32 s67, s67, 7
s_add_u32 s67, s67, s83
ds_read_b128 a[52:55], v3 offset:36864
v_mfma_f32_16x16x32_bf16 v[104:107], a[84:87], a[12:15], v[104:107]
s_lshl_b32 s67, s67, 7
s_add_u32 s67, s67, 98304
ds_read_b128 a[56:59], v2 offset:38912
v_mfma_f32_16x16x32_bf16 v[88:91], a[84:87], a[4:7], v[88:91]
s_lshl_b32 s66, s30, 11
ds_read_b128 a[60:63], v3 offset:38912
v_lshrrev_b32 v14, 4, v0
v_mfma_f32_16x16x32_bf16 v[88:91], a[80:83], a[0:3], v[88:91]
s_waitcnt lgkmcnt(8)
ds_read_b64_tr_b16 a[72:73], v10 offset:32768
v_bfe_u32 v12, v0, 1, 3
v_mfma_f32_16x16x32_bf16 v[28:31], a[88:91], a[0:3], v[28:31]
ds_read_b64_tr_b16 a[74:75], v10 offset:33792
v_xor_b32 v12, v12, v14
v_mfma_f32_16x16x32_bf16 v[28:31], a[92:95], a[4:7], v[28:31]
ds_read_b64_tr_b16 a[76:77], v10 offset:40960
v_add_u32 v7, 0x8000, v7
v_mfma_f32_16x16x32_bf16 v[44:47], a[92:95], a[12:15], v[44:47]
ds_read_b64_tr_b16 a[78:79], v10 offset:41984
v_lshlrev_b32 v12, 5, v12
v_mfma_f32_16x16x32_bf16 v[44:47], a[88:91], a[8:11], v[44:47]
ds_read_b64_tr_b16 a[80:81], v11 offset:32768
v_lshl_add_u32 v12, v14, 11, v12
v_mfma_f32_16x16x32_bf16 v[60:63], a[88:91], a[16:19], v[60:63]
ds_read_b64_tr_b16 a[82:83], v11 offset:33792
v_and_b32 v14, 1, v0
v_mfma_f32_16x16x32_bf16 v[60:63], a[92:95], a[20:23], v[60:63]
ds_read_b64_tr_b16 a[84:85], v11 offset:40960
v_lshl_add_u32 v12, v14, 4, v12
v_mfma_f32_16x16x32_bf16 v[76:79], a[92:95], a[28:31], v[76:79]
s_add_u32 s17, s78, .-L_pc+13824
ds_read_b64_tr_b16 a[86:87], v11 offset:41984
v_xor_b32 v13, 128, v12
v_mfma_f32_16x16x32_bf16 v[76:79], a[88:91], a[24:27], v[76:79]
buffer_load_dword a252, v16, s[88:91], s17 offen
v_mfma_f32_16x16x32_bf16 v[140:143], a[96:99], a[24:27], v[140:143]
v_readfirstlane_b32 vcc_lo, v1
s_nop 0
s_cmp_lt_u32 vcc_lo, s81
s_cbranch_scc1 L_spin_4
L_spinbk_5:
v_mfma_f32_16x16x32_bf16 v[140:143], a[100:103], a[28:31], v[140:143]
s_add_u32 s17, s78, L_F1-L_pc
v_add_u32 v8, 0x8000, v8
v_lshrrev_b32 v14, 4, v0
v_mfma_f32_16x16x32_bf16 v[124:127], a[100:103], a[20:23], v[124:127]
buffer_load_dword a252, v16, s[88:91], s17 offen
v_mfma_f32_16x16x32_bf16 v[124:127], a[96:99], a[16:19], v[124:127]
v_bfe_u32 v18, v0, 2, 2
v_lshl_add_u32 v14, v14, 2, v18
v_mfma_f32_16x16x32_bf16 v[108:111], a[96:99], a[8:11], v[108:111]
s_add_u32 s17, s78, L_F1-L_pc+4096
v_and_b32 v18, 3, v0
v_lshlrev_b32 v18, 3, v18
v_mfma_f32_16x16x32_bf16 v[108:111], a[100:103], a[12:15], v[108:111]
buffer_load_dword a252, v16, s[88:91], s17 offen
v_mfma_f32_16x16x32_bf16 v[92:95], a[100:103], a[4:7], v[92:95]
v_add_u32 v9, 0x8000, v9
v_add_u32 v10, 0x8000, v10
v_mfma_f32_16x16x32_bf16 v[92:95], a[96:99], a[0:3], v[92:95]
v_add_u32 v11, 0x8000, v11
v_lshl_add_u32 v18, v14, 8, v18
v_mfma_f32_16x16x32_bf16 v[32:35], a[104:107], a[0:3], v[32:35]
v_and_b32 v14, 7, v14
v_lshl_add_u32 v18, v14, 5, v18
v_mfma_f32_16x16x32_bf16 v[32:35], a[108:111], a[4:7], v[32:35]
v_xor_b32 v18, s67, v18
v_add_u32 v14, s66, v16
v_mfma_f32_16x16x32_bf16 v[48:51], a[108:111], a[12:15], v[48:51]
s_waitcnt lgkmcnt(0)
s_barrier
v_mfma_f32_16x16x32_bf16 v[48:51], a[104:107], a[8:11], v[48:51]
ds_read_b64_tr_b16 a[88:89], v19 offset:36864
v_xor_b32 v15, 0x800, v14
v_mfma_f32_16x16x32_bf16 v[64:67], a[104:107], a[16:19], v[64:67]
s_lshr_b32 s66, s30, 1
s_lshl_b32 s66, s66, 16
ds_read_b64_tr_b16 a[90:91], v19 offset:37120
v_mfma_f32_16x16x32_bf16 v[64:67], a[108:111], a[20:23], v[64:67]
s_and_b32 s67, s30, 1
s_lshl_b32 s67, s67, 10
s_mov_b32 m0, s76
ds_read_b64_tr_b16 a[92:93], v19 offset:38912
v_mfma_f32_16x16x32_bf16 v[80:83], a[108:111], a[28:31], v[80:83]
s_add_u32 s66, s66, s67
s_add_u32 s66, s66, 32768
s_lshl_b32 s64, s30, 14
ds_read_b64_tr_b16 a[94:95], v19 offset:39168
v_mfma_f32_16x16x32_bf16 v[80:83], a[104:107], a[24:27], v[80:83]
buffer_load_dwordx4 v16, s[32:35], s64 offen offset:0 sc1 lds
v_mfma_f32_16x16x32_bf16 v[144:147], a[112:115], a[24:27], v[144:147]
ds_read_b64_tr_b16 a[96:97], v20 offset:36864
v_add_u32 v17, s66, v16
v_mfma_f32_16x16x32_bf16 v[144:147], a[116:119], a[28:31], v[144:147]
ds_read_b64_tr_b16 a[98:99], v20 offset:37120
v_lshlrev_b32 v21, 5, v0
v_mfma_f32_16x16x32_bf16 v[128:131], a[116:119], a[20:23], v[128:131]
s_lshl2_add_u32 s73, s2, s30
s_lshl_b32 s73, s73, 11
s_lshl_b32 s66, s30, 11
v_mfma_f32_16x16x32_bf16 v[128:131], a[112:115], a[16:19], v[128:131]
s_add_u32 s66, s66, 32768
buffer_load_dwordx4 v16, s[32:35], s64 offen offset:1024 sc1 lds
v_mfma_f32_16x16x32_bf16 v[112:115], a[112:115], a[8:11], v[112:115]
ds_read_b64_tr_b16 a[100:101], v20 offset:38912
v_add_u32 v2, s66, v16
v_mfma_f32_16x16x32_bf16 v[112:115], a[116:119], a[12:15], v[112:115]
ds_read_b64_tr_b16 a[102:103], v20 offset:39168
v_add_u32 v3, 0x10000, v2
v_mfma_f32_16x16x32_bf16 v[96:99], a[116:119], a[4:7], v[96:99]
ds_read_b64_tr_b16 a[104:105], v19 offset:40960
v_mfma_f32_16x16x32_bf16 v[96:99], a[112:115], a[0:3], v[96:99]
buffer_load_dwordx4 v16, s[32:35], s64 offen offset:2048 sc1 lds
v_mfma_f32_16x16x32_bf16 v[36:39], a[72:75], a[0:3], v[36:39]
ds_read_b64_tr_b16 a[106:107], v19 offset:41216
v_mfma_f32_16x16x32_bf16 v[36:39], a[76:79], a[4:7], v[36:39]
ds_read_b64_tr_b16 a[108:109], v19 offset:43008
v_mfma_f32_16x16x32_bf16 v[52:55], a[76:79], a[12:15], v[52:55]
ds_read_b64_tr_b16 a[110:111], v19 offset:43264
v_mfma_f32_16x16x32_bf16 v[52:55], a[72:75], a[8:11], v[52:55]
buffer_load_dwordx4 v16, s[32:35], s64 offen offset:3072 sc1 lds
v_mfma_f32_16x16x32_bf16 v[68:71], a[72:75], a[16:19], v[68:71]
ds_read_b64_tr_b16 a[112:113], v20 offset:40960
v_mfma_f32_16x16x32_bf16 v[68:71], a[76:79], a[20:23], v[68:71]
s_add_u32 m0, s76, 4096
ds_read_b64_tr_b16 a[114:115], v20 offset:41216
v_mfma_f32_16x16x32_bf16 v[84:87], a[76:79], a[28:31], v[84:87]
s_add_u32 s64, s64, 4096
ds_read_b64_tr_b16 a[116:117], v20 offset:43008
v_mfma_f32_16x16x32_bf16 v[84:87], a[72:75], a[24:27], v[84:87]
buffer_load_dwordx4 v16, s[32:35], s64 offen offset:0 sc1 lds
v_mfma_f32_16x16x32_bf16 v[148:151], a[80:83], a[24:27], v[148:151]
ds_read_b64_tr_b16 a[118:119], v20 offset:43264
v_mfma_f32_16x16x32_bf16 v[148:151], a[84:87], a[28:31], v[148:151]
ds_read_b64_tr_b16 a[72:73], v19 offset:32768
v_mfma_f32_16x16x32_bf16 v[132:135], a[84:87], a[20:23], v[132:135]
ds_read_b64_tr_b16 a[74:75], v19 offset:33024
v_mfma_f32_16x16x32_bf16 v[132:135], a[80:83], a[16:19], v[132:135]
buffer_load_dwordx4 v16, s[32:35], s64 offen offset:1024 sc1 lds
v_mfma_f32_16x16x32_bf16 v[116:119], a[80:83], a[8:11], v[116:119]
ds_read_b64_tr_b16 a[76:77], v19 offset:34816
v_mfma_f32_16x16x32_bf16 v[116:119], a[84:87], a[12:15], v[116:119]
ds_read_b64_tr_b16 a[78:79], v19 offset:35072
v_mfma_f32_16x16x32_bf16 v[100:103], a[84:87], a[4:7], v[100:103]
v_mfma_f32_16x16x32_bf16 v[100:103], a[80:83], a[0:3], v[100:103]
s_waitcnt lgkmcnt(6)
buffer_load_dwordx4 v16, s[32:35], s64 offen offset:2048 sc1 lds
v_mfma_f32_16x16x32_bf16 v[184:187], a[88:91], a[32:35], v[184:187]
ds_read_b64_tr_b16 a[80:81], v20 offset:32768
v_bfe_u32 v1, v0, 1, 1
v_mfma_f32_16x16x32_bf16 v[184:187], a[92:95], a[36:39], v[184:187]
ds_read_b64_tr_b16 a[82:83], v20 offset:33024
v_subrev_u32 v1, 1, v1
v_mfma_f32_16x16x32_bf16 v[192:195], a[92:95], a[44:47], v[192:195]
ds_read_b64_tr_b16 a[84:85], v20 offset:34816
v_and_b32 v1, 0x3f803f80, v1
v_mfma_f32_16x16x32_bf16 v[192:195], a[88:91], a[40:43], v[192:195]
buffer_load_dwordx4 v16, s[32:35], s64 offen offset:3072 sc1 lds
v_mfma_f32_16x16x32_bf16 v[200:203], a[88:91], a[48:51], v[200:203]
ds_read_b64_tr_b16 a[86:87], v20 offset:35072
v_accvgpr_write_b32 a240, v1
v_mfma_f32_16x16x32_bf16 v[200:203], a[92:95], a[52:55], v[200:203]
v_accvgpr_write_b32 a241, v1
v_accvgpr_write_b32 a242, v1
v_mfma_f32_16x16x32_bf16 v[208:211], a[92:95], a[60:63], v[208:211]
s_lshr_b32 s64, s76, 1
s_add_u32 m0, s64, 81920
s_and_b32 s71, s64, 8192
s_add_u32 s64, s64, s71
s_add_u32 s64, s64, 8192
v_accvgpr_write_b32 a243, v1
v_mfma_f32_16x16x32_bf16 v[208:211], a[88:91], a[56:59], v[208:211]
buffer_load_dwordx4 v16, s[32:35], s64 offen offset:0 sc1 lds
v_mfma_f32_16x16x32_bf16 v[212:215], a[96:99], a[56:59], v[212:215]
ds_read_b64_tr_b16 a[88:89], v4 offset:32768
v_mfma_f32_16x16x32_bf16 v[212:215], a[100:103], a[60:63], v[212:215]
ds_read_b64_tr_b16 a[90:91], v4 offset:33792
v_mfma_f32_16x16x32_bf16 v[204:207], a[100:103], a[52:55], v[204:207]
ds_read_b64_tr_b16 a[92:93], v4 offset:40960
v_mfma_f32_16x16x32_bf16 v[204:207], a[96:99], a[48:51], v[204:207]
buffer_load_dwordx4 v16, s[32:35], s64 offen offset:1024 sc1 lds
v_mfma_f32_16x16x32_bf16 v[196:199], a[96:99], a[40:43], v[196:199]
ds_read_b64_tr_b16 a[94:95], v4 offset:41984
v_mfma_f32_16x16x32_bf16 v[196:199], a[100:103], a[44:47], v[196:199]
s_or_b32 s66, s3, s30
s_cmp_eq_u32 s66, 0
s_cselect_b32 s66, 0xff800000, 0
v_mfma_f32_16x16x32_bf16 v[188:191], a[100:103], a[36:39], v[188:191]
s_and_b32 s67, s74, 0x7800
s_cselect_b32 s67, 0, 0x70000000
s_add_u32 s77, s74, s67
v_mfma_f32_16x16x32_bf16 v[188:191], a[96:99], a[32:35], v[188:191]
s_sub_u32 s77, s77, 2048
buffer_load_dwordx4 v16, s[32:35], s64 offen offset:2048 sc1 lds
v_mfma_f32_16x16x32_bf16 v[216:219], a[32:35], a[104:107], v[216:219]
s_mov_b32 s68, 0x3e0293ee
ds_read_b64_tr_b16 a[96:97], v5 offset:32768
v_mfma_f32_16x16x32_bf16 v[216:219], a[36:39], a[108:111], v[216:219]
s_mov_b32 s69, s68
ds_read_b64_tr_b16 a[98:99], v5 offset:33792
v_cvt_pk_bf16_f32 v208, v208, v209
v_mfma_f32_16x16x32_bf16 v[224:227], a[44:47], a[108:111], v[224:227]
ds_read_b64_tr_b16 a[100:101], v5 offset:40960
v_cvt_pk_bf16_f32 v209, v210, v211
v_mfma_f32_16x16x32_bf16 v[224:227], a[40:43], a[104:107], v[224:227]
buffer_load_dwordx4 v16, s[32:35], s64 offen offset:3072 sc1 lds
v_mfma_f32_16x16x32_bf16 v[232:235], a[48:51], a[104:107], v[232:235]
ds_read_b64_tr_b16 a[102:103], v5 offset:41984
v_cvt_pk_bf16_f32 v210, v212, v213
v_mfma_f32_16x16x32_bf16 v[232:235], a[52:55], a[108:111], v[232:235]
v_cvt_pk_bf16_f32 v211, v214, v215
v_mfma_f32_16x16x32_bf16 v[240:243], a[60:63], a[108:111], v[240:243]
ds_write_b128 v3, v[208:211] offset:10240
v_mfma_f32_16x16x32_bf16 v[240:243], a[56:59], a[104:107], v[240:243]
ds_read_b64_tr_b16 a[104:105], v6 offset:32768
v_cvt_pk_bf16_f32 v200, v200, v201
v_mfma_f32_16x16x32_bf16 v[244:247], a[56:59], a[112:115], v[244:247]
s_waitcnt lgkmcnt(6)
ds_read_b64_tr_b16 a[106:107], v6 offset:33792
v_cvt_pk_bf16_f32 v201, v202, v203
v_mfma_f32_16x16x32_bf16 v[244:247], a[60:63], a[116:119], v[244:247]
ds_read_b64_tr_b16 a[108:109], v6 offset:40960
v_cvt_pk_bf16_f32 v202, v204, v205
v_mfma_f32_16x16x32_bf16 v[236:239], a[52:55], a[116:119], v[236:239]
ds_read_b64_tr_b16 a[110:111], v6 offset:41984
v_cvt_pk_bf16_f32 v203, v206, v207
v_mfma_f32_16x16x32_bf16 v[236:239], a[48:51], a[112:115], v[236:239]
ds_write_b128 v3, v[200:203] offset:2048
v_mfma_f32_16x16x32_bf16 v[228:231], a[40:43], a[112:115], v[228:231]
v_cvt_pk_bf16_f32 v192, v192, v193
v_cvt_pk_bf16_f32 v193, v194, v195
v_mfma_f32_16x16x32_bf16 v[228:231], a[44:47], a[116:119], v[228:231]
v_cvt_pk_bf16_f32 v194, v196, v197
v_cvt_pk_bf16_f32 v195, v198, v199
v_mfma_f32_16x16x32_bf16 v[220:223], a[36:39], a[116:119], v[220:223]
ds_write_b128 v2, v[192:195] offset:10240
v_mfma_f32_16x16x32_bf16 v[220:223], a[32:35], a[112:115], v[220:223]
ds_read_b64_tr_b16 a[112:113], v7 offset:32768
v_cvt_pk_bf16_f32 v184, v184, v185
v_mfma_f32_16x16x32_bf16 v[152:155], a[72:75], a[32:35], v[152:155]
ds_read_b64_tr_b16 a[114:115], v7 offset:33792
v_cvt_pk_bf16_f32 v185, v186, v187
v_mfma_f32_16x16x32_bf16 v[152:155], a[76:79], a[36:39], v[152:155]
ds_read_b64_tr_b16 a[116:117], v7 offset:40960
v_cvt_pk_bf16_f32 v186, v188, v189
v_mfma_f32_16x16x32_bf16 v[160:163], a[76:79], a[44:47], v[160:163]
ds_read_b64_tr_b16 a[118:119], v7 offset:41984
v_cvt_pk_bf16_f32 v187, v190, v191
v_mfma_f32_16x16x32_bf16 v[160:163], a[72:75], a[40:43], v[160:163]
ds_write_b128 v2, v[184:187] offset:2048
v_mfma_f32_16x16x32_bf16 v[168:171], a[72:75], a[48:51], v[168:171]
v_cvt_pk_bf16_f32 v219, v218, v219
v_cvt_pk_bf16_f32 v218, v216, v217
v_mfma_f32_16x16x32_bf16 v[168:171], a[76:79], a[52:55], v[168:171]
ds_write_b64 v2, v[218:219] offset:3072
v_mfma_f32_16x16x32_bf16 v[176:179], a[76:79], a[60:63], v[176:179]
buffer_load_dword a252, v21, s[36:39], s73 offen
v_mfma_f32_16x16x32_bf16 v[176:179], a[72:75], a[56:59], v[176:179]
ds_read_b64_tr_b16 a[72:73], v8 offset:32768
v_cvt_pk_bf16_f32 v227, v226, v227
v_mfma_f32_16x16x32_bf16 v[180:183], a[80:83], a[56:59], v[180:183]
ds_read_b64_tr_b16 a[74:75], v8 offset:33792
v_cvt_pk_bf16_f32 v226, v224, v225
v_mfma_f32_16x16x32_bf16 v[180:183], a[84:87], a[60:63], v[180:183]
ds_write_b64 v2, v[226:227] offset:11264
v_mfma_f32_16x16x32_bf16 v[172:175], a[84:87], a[52:55], v[172:175]
ds_read_b64_tr_b16 a[76:77], v8 offset:40960
v_cvt_pk_bf16_f32 v235, v234, v235
v_mfma_f32_16x16x32_bf16 v[172:175], a[80:83], a[48:51], v[172:175]
ds_read_b64_tr_b16 a[78:79], v8 offset:41984
v_cvt_pk_bf16_f32 v234, v232, v233
v_mfma_f32_16x16x32_bf16 v[164:167], a[80:83], a[40:43], v[164:167]
ds_write_b64 v3, v[234:235] offset:3072
v_mfma_f32_16x16x32_bf16 v[164:167], a[84:87], a[44:47], v[164:167]
v_cvt_pk_bf16_f32 v243, v242, v243
v_cvt_pk_bf16_f32 v242, v240, v241
v_mfma_f32_16x16x32_bf16 v[156:159], a[84:87], a[36:39], v[156:159]
ds_write_b64 v3, v[242:243] offset:11264
v_mfma_f32_16x16x32_bf16 v[156:159], a[80:83], a[32:35], v[156:159]
ds_read_b64_tr_b16 a[80:81], v9 offset:32768
v_cvt_pk_bf16_f32 v247, v246, v247
v_mfma_f32_16x16x32_bf16 v[24:27], a[88:91], a[32:35], v[24:27]
ds_read_b64_tr_b16 a[82:83], v9 offset:33792
v_cvt_pk_bf16_f32 v246, v244, v245
v_mfma_f32_16x16x32_bf16 v[24:27], a[92:95], a[36:39], v[24:27]
ds_write_b64 v3, v[246:247] offset:11272
v_mfma_f32_16x16x32_bf16 v[40:43], a[92:95], a[44:47], v[40:43]
ds_read_b64_tr_b16 a[84:85], v9 offset:40960
v_cvt_pk_bf16_f32 v239, v238, v239
v_cvt_pk_bf16_f32 v238, v236, v237
v_mfma_f32_16x16x32_bf16 v[40:43], a[88:91], a[40:43], v[40:43]
ds_write_b64 v3, v[238:239] offset:3080
v_mfma_f32_16x16x32_bf16 v[56:59], a[88:91], a[48:51], v[56:59]
ds_read_b64_tr_b16 a[86:87], v9 offset:41984
v_cvt_pk_bf16_f32 v231, v230, v231
v_cvt_pk_bf16_f32 v230, v228, v229
v_mfma_f32_16x16x32_bf16 v[56:59], a[92:95], a[52:55], v[56:59]
ds_write_b64 v2, v[230:231] offset:11272
v_mfma_f32_16x16x32_bf16 v[72:75], a[92:95], a[60:63], v[72:75]
v_cvt_pk_bf16_f32 v223, v222, v223
v_cvt_pk_bf16_f32 v222, v220, v221
v_mfma_f32_16x16x32_bf16 v[72:75], a[88:91], a[56:59], v[72:75]
s_waitcnt lgkmcnt(8)
ds_write_b64 v2, v[222:223] offset:3080
v_mfma_f32_16x16x32_bf16 v[136:139], a[96:99], a[56:59], v[136:139]
ds_read_b64_tr_b16 a[88:89], v10 offset:32768
v_cvt_pk_bf16_f32 v176, v176, v177
v_mfma_f32_16x16x32_bf16 v[136:139], a[100:103], a[60:63], v[136:139]
s_waitcnt lgkmcnt(0)
s_barrier
v_mfma_f32_16x16x32_bf16 v[120:123], a[100:103], a[52:55], v[120:123]
ds_read_b128 a[16:19], v17 offset:16384
v_cvt_pk_bf16_f32 v177, v178, v179
v_mfma_f32_16x16x32_bf16 v[120:123], a[96:99], a[48:51], v[120:123]
ds_read_b64_tr_b16 a[90:91], v10 offset:33792
v_cvt_pk_bf16_f32 v178, v180, v181
v_mfma_f32_16x16x32_bf16 v[104:107], a[96:99], a[40:43], v[104:107]
ds_read_b64_tr_b16 a[92:93], v10 offset:40960
v_cvt_pk_bf16_f32 v179, v182, v183
v_mfma_f32_16x16x32_bf16 v[104:107], a[100:103], a[44:47], v[104:107]
ds_read_b64_tr_b16 a[94:95], v10 offset:41984
v_cvt_pk_bf16_f32 v168, v168, v169
v_mfma_f32_16x16x32_bf16 v[88:91], a[100:103], a[36:39], v[88:91]
v_cvt_pk_bf16_f32 v169, v170, v171
v_cvt_pk_bf16_f32 v170, v172, v173
v_mfma_f32_16x16x32_bf16 v[88:91], a[96:99], a[32:35], v[88:91]
ds_read_b64_tr_b16 a[96:97], v11 offset:32768
v_cvt_pk_bf16_f32 v171, v174, v175
v_mfma_f32_16x16x32_bf16 v[28:31], a[104:107], a[32:35], v[28:31]
s_waitcnt lgkmcnt(4)
buffer_store_dwordx4 a[16:19], v16, s[44:47], s74 offen sc1
v_mfma_f32_16x16x32_bf16 v[28:31], a[108:111], a[36:39], v[28:31]
ds_read_b64_tr_b16 a[98:99], v11 offset:33792
v_cvt_pk_bf16_f32 v160, v160, v161
v_mfma_f32_16x16x32_bf16 v[44:47], a[108:111], a[44:47], v[44:47]
ds_read_b64_tr_b16 a[100:101], v11 offset:40960
v_cvt_pk_bf16_f32 v161, v162, v163
v_mfma_f32_16x16x32_bf16 v[44:47], a[104:107], a[40:43], v[44:47]
s_sub_u32 s81, s3, 1
ds_read_b64_tr_b16 a[102:103], v11 offset:41984
v_cvt_pk_bf16_f32 v162, v164, v165
v_mfma_f32_16x16x32_bf16 v[60:63], a[104:107], a[48:51], v[60:63]
s_sub_u32 s67, s3, 2
ds_read_b128 a[4:7], v2 offset:8192
v_cvt_pk_bf16_f32 v163, v166, v167
v_mfma_f32_16x16x32_bf16 v[60:63], a[108:111], a[52:55], v[60:63]
s_mul_i32 s81, s81, s67
ds_read_b128 a[12:15], v3 offset:8192
v_cvt_pk_bf16_f32 v152, v152, v153
v_mfma_f32_16x16x32_bf16 v[76:79], a[108:111], a[60:63], v[76:79]
s_lshl4_add_u32 s81, s81, s31
ds_read_b64 v[224:225], v2 offset:9216
v_cvt_pk_bf16_f32 v153, v154, v155
v_mfma_f32_16x16x32_bf16 v[76:79], a[104:107], a[56:59], v[76:79]
s_lshl2_add_u32 s81, s81, s30
ds_read_b64 v[228:229], v2 offset:9224
v_cvt_pk_bf16_f32 v154, v156, v157
v_mfma_f32_16x16x32_bf16 v[140:143], a[112:115], a[56:59], v[140:143]
s_mul_i32 s81, s81, 3328
ds_read_b64 v[240:241], v3 offset:9216
v_cvt_pk_bf16_f32 v155, v158, v159
v_mfma_f32_16x16x32_bf16 v[140:143], a[116:119], a[60:63], v[140:143]
s_mov_b32 s73, 0
ds_read_b64 v[244:245], v3 offset:9224
v_or_b32 v20, s66, v252
v_mfma_f32_16x16x32_bf16 v[124:127], a[116:119], a[52:55], v[124:127]
s_mov_b32 s72, 0x20000
v_or_b32 v21, s66, v253
v_or_b32 v22, s66, v254
v_mfma_f32_16x16x32_bf16 v[124:127], a[112:115], a[48:51], v[124:127]
s_lshl_b32 s67, s31, 15
v_or_b32 v23, s66, v255
v_mfma_f32_16x16x32_bf16 v[108:111], a[112:115], a[40:43], v[108:111]
s_add_u32 s67, s67, s78
s_mov_b32 s66, 0x3e8293ee
v_mul_f32 v72, s68, v72
v_mfma_f32_16x16x32_bf16 v[108:111], a[116:119], a[44:47], v[108:111]
s_add_u32 s67, s67, 33554432
v_mul_f32 v73, s68, v73
v_mul_f32 v74, s68, v74
v_mfma_f32_16x16x32_bf16 v[92:95], a[116:119], a[36:39], v[92:95]
s_mul_i32 s74, s3, 1310720
v_mul_f32 v75, s68, v75
v_mul_f32 v136, s68, v136
v_mfma_f32_16x16x32_bf16 v[92:95], a[112:115], a[32:35], v[92:95]
s_add_u32 s74, s74, s67
v_mul_f32 v137, s68, v137
v_mul_f32 v138, s68, v138
v_mfma_f32_16x16x32_bf16 v[32:35], a[72:75], a[32:35], v[32:35]
s_mul_i32 s75, s16, 1310720
v_mul_f32 v139, s68, v139
v_cvt_pk_bf16_f32 v72, v72, v73
v_mfma_f32_16x16x32_bf16 v[32:35], a[76:79], a[36:39], v[32:35]
s_add_u32 s75, s75, s67
v_cvt_pk_bf16_f32 v73, v74, v75
v_cvt_pk_bf16_f32 v74, v136, v137
v_mfma_f32_16x16x32_bf16 v[48:51], a[76:79], a[44:47], v[48:51]
s_mul_i32 s67, s31, 24576
v_cvt_pk_bf16_f32 v75, v138, v139
v_mul_f32 v56, s68, v56
v_mfma_f32_16x16x32_bf16 v[48:51], a[72:75], a[40:43], v[48:51]
s_sub_u32 s67, 1052672, s67
v_mul_f32 v57, s68, v57
v_mul_f32 v58, s68, v58
v_mfma_f32_16x16x32_bf16 v[64:67], a[72:75], a[48:51], v[64:67]
s_add_u32 s64, s74, s67
v_mul_f32 v59, s68, v59
v_mul_f32 v120, s68, v120
v_mfma_f32_16x16x32_bf16 v[64:67], a[76:79], a[52:55], v[64:67]
s_add_u32 s65, s75, s67
v_mul_f32 v121, s68, v121
v_mul_f32 v122, s68, v122
v_mfma_f32_16x16x32_bf16 v[80:83], a[76:79], a[60:63], v[80:83]
s_and_b32 s70, s30, 1
v_mul_f32 v123, s68, v123
v_cvt_pk_bf16_f32 v56, v56, v57
v_mfma_f32_16x16x32_bf16 v[80:83], a[72:75], a[56:59], v[80:83]
s_lshr_b32 s67, s30, 1
v_cvt_pk_bf16_f32 v57, v58, v59
v_cvt_pk_bf16_f32 v58, v120, v121
v_mfma_f32_16x16x32_bf16 v[144:147], a[80:83], a[56:59], v[144:147]
s_lshl3_add_u32 s71, s67, s70
v_cvt_pk_bf16_f32 v59, v122, v123
v_mul_f32 v40, s68, v40
v_mfma_f32_16x16x32_bf16 v[144:147], a[84:87], a[60:63], v[144:147]
s_add_u32 s71, s71, 4
v_mul_f32 v41, s68, v41
v_mul_f32 v42, s68, v42
v_mfma_f32_16x16x32_bf16 v[128:131], a[84:87], a[52:55], v[128:131]
s_lshl_b32 s71, s71, 13
v_mul_f32 v43, s68, v43
v_mul_f32 v104, s68, v104
v_mfma_f32_16x16x32_bf16 v[128:131], a[80:83], a[48:51], v[128:131]
s_lshl_b32 s70, s70, 14
v_mul_f32 v105, s68, v105
v_mul_f32 v106, s68, v106
v_mfma_f32_16x16x32_bf16 v[112:115], a[80:83], a[40:43], v[112:115]
s_mul_i32 s67, s67, 24576
v_mul_f32 v107, s68, v107
v_cvt_pk_bf16_f32 v40, v40, v41
v_mfma_f32_16x16x32_bf16 v[112:115], a[84:87], a[44:47], v[112:115]
s_sub_u32 s70, s70, s67
v_cvt_pk_bf16_f32 v41, v42, v43
v_cvt_pk_bf16_f32 v42, v104, v105
v_mfma_f32_16x16x32_bf16 v[96:99], a[84:87], a[36:39], v[96:99]
s_add_u32 s70, s70, 65536
v_cvt_pk_bf16_f32 v43, v106, v107
v_mul_f32 v24, s68, v24
v_mfma_f32_16x16x32_bf16 v[96:99], a[80:83], a[32:35], v[96:99]
s_waitcnt lgkmcnt(0)
v_mul_f32 v25, s68, v25
v_mul_f32 v26, s68, v26
v_mfma_f32_16x16x32_bf16 v[36:39], a[88:91], a[32:35], v[36:39]
v_mul_f32 v27, s68, v27
v_mul_f32 v88, s68, v88
v_mfma_f32_16x16x32_bf16 v[36:39], a[92:95], a[36:39], v[36:39]
v_mul_f32 v89, s68, v89
v_mul_f32 v90, s68, v90
v_mfma_f32_16x16x32_bf16 v[52:55], a[92:95], a[44:47], v[52:55]
v_mul_f32 v91, s68, v91
v_cvt_pk_bf16_f32 v24, v24, v25
v_mfma_f32_16x16x32_bf16 v[52:55], a[88:91], a[40:43], v[52:55]
v_cvt_pk_bf16_f32 v25, v26, v27
v_cvt_pk_bf16_f32 v26, v88, v89
v_mfma_f32_16x16x32_bf16 v[68:71], a[88:91], a[48:51], v[68:71]
v_cvt_pk_bf16_f32 v27, v90, v91
v_mul_f32 v76, s68, v76
v_mfma_f32_16x16x32_bf16 v[68:71], a[92:95], a[52:55], v[68:71]
v_mul_f32 v77, s68, v77
v_mul_f32 v78, s68, v78
v_mfma_f32_16x16x32_bf16 v[84:87], a[92:95], a[60:63], v[84:87]
v_mul_f32 v79, s68, v79
v_mul_f32 v140, s68, v140
v_mfma_f32_16x16x32_bf16 v[84:87], a[88:91], a[56:59], v[84:87]
v_mul_f32 v141, s68, v141
v_mul_f32 v142, s68, v142
v_mfma_f32_16x16x32_bf16 v[148:151], a[96:99], a[56:59], v[148:151]
v_mul_f32 v143, s68, v143
v_cvt_pk_bf16_f32 v76, v76, v77
v_mfma_f32_16x16x32_bf16 v[148:151], a[100:103], a[60:63], v[148:151]
v_cvt_pk_bf16_f32 v77, v78, v79
v_cvt_pk_bf16_f32 v78, v140, v141
v_mfma_f32_16x16x32_bf16 v[132:135], a[100:103], a[52:55], v[132:135]
v_cvt_pk_bf16_f32 v79, v142, v143
v_mul_f32 v60, s68, v60
v_mfma_f32_16x16x32_bf16 v[132:135], a[96:99], a[48:51], v[132:135]
v_mul_f32 v61, s68, v61
v_mul_f32 v62, s68, v62
v_mfma_f32_16x16x32_bf16 v[116:119], a[96:99], a[40:43], v[116:119]
v_mul_f32 v63, s68, v63
v_mul_f32 v124, s68, v124
v_mfma_f32_16x16x32_bf16 v[116:119], a[100:103], a[44:47], v[116:119]
v_mul_f32 v125, s68, v125
v_mul_f32 v126, s68, v126
v_mfma_f32_16x16x32_bf16 v[100:103], a[100:103], a[36:39], v[100:103]
v_mul_f32 v127, s68, v127
v_cvt_pk_bf16_f32 v60, v60, v61
v_mfma_f32_16x16x32_bf16 v[100:103], a[96:99], a[32:35], v[100:103]
v_cvt_pk_bf16_f32 v61, v62, v63
v_cvt_pk_bf16_f32 v62, v124, v125
v_cvt_pk_bf16_f32 v63, v126, v127
buffer_load_dwordx4 v[88:91], v16, s[44:47], s77 offen sc1
v_mfma_f32_16x16x32_bf16 v[196:199], v[192:195], v[160:163], v[248:251]
v_mfma_f32_16x16x32_bf16 v[212:215], v[208:211], v[176:179], v[248:251]
v_mfma_f32_16x16x32_bf16 v[164:167], a[4:7], v[160:163], v[252:255]
v_mfma_f32_16x16x32_bf16 v[180:183], a[12:15], v[176:179], v[252:255]
s_waitcnt vmcnt(24)
s_waitcnt vmcnt(25)
s_waitcnt vmcnt(26)
s_waitcnt vmcnt(27)
v_accvgpr_read_b32 v4, a64
v_accvgpr_read_b32 v5, a65
v_accvgpr_read_b32 v6, a66
v_accvgpr_read_b32 v7, a67
v_accvgpr_read_b32 v8, a68
v_accvgpr_read_b32 v9, a69
v_accvgpr_read_b32 v10, a70
v_accvgpr_read_b32 v11, a71
v_max3_f32 v121, v196, v197, v198
v_max3_f32 v121, v121, v199, v164
v_max3_f32 v121, v121, v165, v166
v_max_f32 v121, v121, v167
v_max3_f32 v123, v212, v213, v214
v_max3_f32 v123, v123, v215, v180
v_max3_f32 v123, v123, v181, v182
v_max_f32 v123, v123, v183
v_mov_b32 v105, v121
v_mov_b32 v107, v123
v_pk_mul_f32 v[28:29], v[28:29], s[68:69]
v_permlane16_swap_b32 v105, v121
v_permlane16_swap_b32 v107, v123
v_max_f32 v121, v121, v105
v_max_f32 v123, v123, v107
v_mov_b32 v105, v121
v_mov_b32 v107, v123
v_pk_mul_f32 v[30:31], v[30:31], s[68:69]
v_permlane32_swap_b32 v105, v121
v_permlane32_swap_b32 v107, v123
v_max_f32 v121, v121, v105
v_max_f32 v123, v123, v107
v_mul_f32 v121, s66, v121
v_mul_f32 v123, s66, v123
v_fma_f32 v164, v164, s66, -v121
v_fma_f32 v165, v165, s66, -v121
v_fma_f32 v166, v166, s66, -v121
v_fma_f32 v167, v167, s66, -v121
v_fma_f32 v196, v196, s66, -v121
v_fma_f32 v197, v197, s66, -v121
v_fma_f32 v198, v198, s66, -v121
v_fma_f32 v199, v199, s66, -v121
v_exp_f32 v164, v164
v_exp_f32 v165, v165
v_exp_f32 v166, v166
v_exp_f32 v167, v167
v_exp_f32 v196, v196
v_exp_f32 v197, v197
v_exp_f32 v198, v198
v_exp_f32 v199, v199
v_cvt_pk_bf16_f32 v164, v164, v165
v_cvt_pk_bf16_f32 v165, v166, v167
v_cvt_pk_bf16_f32 v166, v196, v197
v_cvt_pk_bf16_f32 v167, v198, v199
v_pk_mul_f32 v[92:93], v[92:93], s[68:69]
v_pk_mul_f32 v[94:95], v[94:95], s[68:69]
v_mfma_f32_16x16x32_bf16 v[196:199], a[244:247], v[164:167], 0
v_mfma_f32_16x16x32_bf16 v[160:163], v[224:227], v[164:167], 0
v_mfma_f32_16x16x32_bf16 v[192:195], v[228:231], v[164:167], 0
v_fma_f32 v180, v180, s66, -v123
v_fma_f32 v181, v181, s66, -v123
v_fma_f32 v182, v182, s66, -v123
v_fma_f32 v183, v183, s66, -v123
v_fma_f32 v212, v212, s66, -v123
v_fma_f32 v213, v213, s66, -v123
v_fma_f32 v214, v214, s66, -v123
v_fma_f32 v215, v215, s66, -v123
v_exp_f32 v180, v180
v_exp_f32 v181, v181
v_exp_f32 v182, v182
v_exp_f32 v183, v183
v_exp_f32 v212, v212
v_exp_f32 v213, v213
v_exp_f32 v214, v214
v_exp_f32 v215, v215
v_cvt_pk_bf16_f32 v180, v180, v181
v_cvt_pk_bf16_f32 v181, v182, v183
v_cvt_pk_bf16_f32 v182, v212, v213
v_cvt_pk_bf16_f32 v183, v214, v215
v_cvt_pk_bf16_f32 v28, v28, v29
v_cvt_pk_bf16_f32 v29, v30, v31
v_mfma_f32_16x16x32_bf16 v[212:215], a[244:247], v[180:183], 0
v_mfma_f32_16x16x32_bf16 v[176:179], v[240:243], v[180:183], 0
v_mfma_f32_16x16x32_bf16 v[208:211], v[244:247], v[180:183], 0
v_cvt_pk_bf16_f32 v30, v92, v93
v_cvt_pk_bf16_f32 v31, v94, v95
v_pk_mul_f32 v[44:45], v[44:45], s[68:69]
v_pk_mul_f32 v[46:47], v[46:47], s[68:69]
v_pk_mul_f32 v[108:109], v[108:109], s[68:69]
v_pk_mul_f32 v[110:111], v[110:111], s[68:69]
v_rcp_f32 v121, v196
v_rcp_f32 v123, v212
v_mul_f32 v121, v121, v7
v_mul_f32 v123, v123, v11
v_mul_f32 v160, v160, v121
v_mul_f32 v161, v161, v121
v_mul_f32 v162, v162, v121
v_mul_f32 v163, v163, v121
v_mul_f32 v192, v192, v121
v_mul_f32 v193, v193, v121
v_mul_f32 v194, v194, v121
v_mul_f32 v195, v195, v121
v_cvt_pk_bf16_f32 v160, v160, v161
v_cvt_pk_bf16_f32 v161, v162, v163
v_cvt_pk_bf16_f32 v162, v192, v193
v_cvt_pk_bf16_f32 v163, v194, v195
buffer_store_dwordx4 v[160:163], v16, s[44:47], s64 offen sc1
v_mul_f32 v176, v176, v123
v_mul_f32 v177, v177, v123
v_mul_f32 v178, v178, v123
v_mul_f32 v179, v179, v123
v_mul_f32 v208, v208, v123
v_mul_f32 v209, v209, v123
v_mul_f32 v210, v210, v123
v_mul_f32 v211, v211, v123
v_cvt_pk_bf16_f32 v176, v176, v177
v_cvt_pk_bf16_f32 v177, v178, v179
v_cvt_pk_bf16_f32 v178, v208, v209
v_cvt_pk_bf16_f32 v179, v210, v211
buffer_store_dwordx4 v[176:179], v16, s[44:47], s65 offen sc1
v_cvt_pk_bf16_f32 v44, v44, v45
v_cvt_pk_bf16_f32 v45, v46, v47
v_cvt_pk_bf16_f32 v46, v108, v109
v_cvt_pk_bf16_f32 v47, v110, v111
v_pk_mul_f32 v[32:33], v[32:33], s[68:69]
v_pk_mul_f32 v[34:35], v[34:35], s[68:69]
v_pk_mul_f32 v[96:97], v[96:97], s[68:69]
v_pk_mul_f32 v[98:99], v[98:99], s[68:69]
v_cvt_pk_bf16_f32 v32, v32, v33
v_cvt_pk_bf16_f32 v33, v34, v35
v_cvt_pk_bf16_f32 v34, v96, v97
v_cvt_pk_bf16_f32 v35, v98, v99
v_pk_mul_f32 v[48:49], v[48:49], s[68:69]
v_pk_mul_f32 v[50:51], v[50:51], s[68:69]
v_pk_mul_f32 v[112:113], v[112:113], s[68:69]
v_pk_mul_f32 v[114:115], v[114:115], s[68:69]
v_cvt_pk_bf16_f32 v48, v48, v49
v_cvt_pk_bf16_f32 v49, v50, v51
v_cvt_pk_bf16_f32 v50, v112, v113
v_cvt_pk_bf16_f32 v51, v114, v115
v_pk_mul_f32 v[64:65], v[64:65], s[68:69]
v_pk_mul_f32 v[66:67], v[66:67], s[68:69]
v_pk_mul_f32 v[128:129], v[128:129], s[68:69]
v_pk_mul_f32 v[130:131], v[130:131], s[68:69]
s_waitcnt vmcnt(2)
L_hchk:
v_max3_u32 v1, v88, v89, v90
v_max_u32 v1, v1, v91
v_cmp_eq_u32 vcc, -1, v1
s_cbranch_vccnz L_hretry
L_hgo:
ds_write_b128 v17, v[88:91]
s_sub_u32 s64, s64, 4096
s_sub_u32 s65, s65, 4096
v_cvt_pk_bf16_f32 v64, v64, v65
v_cvt_pk_bf16_f32 v65, v66, v67
v_cvt_pk_bf16_f32 v66, v128, v129
v_cvt_pk_bf16_f32 v67, v130, v131
v_pk_mul_f32 v[80:81], v[80:81], s[68:69]
v_pk_mul_f32 v[82:83], v[82:83], s[68:69]
v_pk_mul_f32 v[144:145], v[144:145], s[68:69]
v_pk_mul_f32 v[146:147], v[146:147], s[68:69]
s_waitcnt lgkmcnt(0)
s_barrier
ds_read_b128 a[0:3], v2 offset:0
ds_read_b128 a[8:11], v3 offset:0
ds_read_b64 v[216:217], v2 offset:1024
ds_read_b64 v[220:221], v2 offset:1032
ds_read_b64 v[232:233], v3 offset:1024
ds_read_b64 v[236:237], v3 offset:1032
v_cvt_pk_bf16_f32 v80, v80, v81
v_cvt_pk_bf16_f32 v81, v82, v83
v_cvt_pk_bf16_f32 v82, v144, v145
v_cvt_pk_bf16_f32 v83, v146, v147
v_pk_mul_f32 v[36:37], v[36:37], s[68:69]
v_pk_mul_f32 v[38:39], v[38:39], s[68:69]
v_pk_mul_f32 v[100:101], v[100:101], s[68:69]
v_pk_mul_f32 v[102:103], v[102:103], s[68:69]
v_cvt_pk_bf16_f32 v36, v36, v37
v_cvt_pk_bf16_f32 v37, v38, v39
v_cvt_pk_bf16_f32 v38, v100, v101
v_cvt_pk_bf16_f32 v39, v102, v103
v_pk_mul_f32 v[52:53], v[52:53], s[68:69]
v_pk_mul_f32 v[54:55], v[54:55], s[68:69]
v_pk_mul_f32 v[116:117], v[116:117], s[68:69]
v_pk_mul_f32 v[118:119], v[118:119], s[68:69]
v_mfma_f32_16x16x32_bf16 v[188:191], v[184:187], v[152:155], v[248:251]
v_mfma_f32_16x16x32_bf16 v[204:207], v[200:203], v[168:171], v[248:251]
s_waitcnt lgkmcnt(5)
v_mfma_f32_16x16x32_bf16 v[156:159], a[0:3], v[152:155], v[20:23]
s_waitcnt lgkmcnt(4)
v_mfma_f32_16x16x32_bf16 v[172:175], a[8:11], v[168:171], v[252:255]
v_cvt_pk_bf16_f32 v52, v52, v53
v_cvt_pk_bf16_f32 v53, v54, v55
v_cvt_pk_bf16_f32 v54, v116, v117
v_cvt_pk_bf16_f32 v55, v118, v119
v_pk_mul_f32 v[68:69], v[68:69], s[68:69]
v_pk_mul_f32 v[70:71], v[70:71], s[68:69]
v_pk_mul_f32 v[132:133], v[132:133], s[68:69]
v_pk_mul_f32 v[134:135], v[134:135], s[68:69]
v_max3_f32 v120, v188, v189, v190
v_max3_f32 v120, v120, v191, v156
v_max3_f32 v120, v120, v157, v158
v_max_f32 v120, v120, v159
v_max3_f32 v122, v204, v205, v206
v_max3_f32 v122, v122, v207, v172
v_max3_f32 v122, v122, v173, v174
v_max_f32 v122, v122, v175
v_mov_b32 v104, v120
v_mov_b32 v106, v122
v_cvt_pk_bf16_f32 v68, v68, v69
v_permlane16_swap_b32 v104, v120
v_permlane16_swap_b32 v106, v122
v_max_f32 v120, v120, v104
v_max_f32 v122, v122, v106
v_mov_b32 v104, v120
v_mov_b32 v106, v122
v_cvt_pk_bf16_f32 v69, v70, v71
v_permlane32_swap_b32 v104, v120
v_permlane32_swap_b32 v106, v122
v_max_f32 v120, v120, v104
v_max_f32 v122, v122, v106
v_mul_f32 v120, s66, v120
v_mul_f32 v122, s66, v122
v_fma_f32 v156, v156, s66, -v120
v_fma_f32 v157, v157, s66, -v120
v_fma_f32 v158, v158, s66, -v120
v_fma_f32 v159, v159, s66, -v120
v_fma_f32 v188, v188, s66, -v120
v_fma_f32 v189, v189, s66, -v120
v_fma_f32 v190, v190, s66, -v120
v_fma_f32 v191, v191, s66, -v120
v_exp_f32 v156, v156
v_exp_f32 v157, v157
v_exp_f32 v158, v158
v_exp_f32 v159, v159
v_exp_f32 v188, v188
v_exp_f32 v189, v189
v_exp_f32 v190, v190
v_exp_f32 v191, v191
v_cvt_pk_bf16_f32 v156, v156, v157
v_cvt_pk_bf16_f32 v157, v158, v159
v_cvt_pk_bf16_f32 v158, v188, v189
v_cvt_pk_bf16_f32 v159, v190, v191
v_cvt_pk_bf16_f32 v70, v132, v133
v_cvt_pk_bf16_f32 v71, v134, v135
v_mfma_f32_16x16x32_bf16 v[188:191], a[244:247], v[156:159], 0
s_waitcnt lgkmcnt(3)
v_mfma_f32_16x16x32_bf16 v[152:155], v[216:219], v[156:159], 0
s_waitcnt lgkmcnt(2)
v_mfma_f32_16x16x32_bf16 v[184:187], v[220:223], v[156:159], 0
v_fma_f32 v172, v172, s66, -v122
v_fma_f32 v173, v173, s66, -v122
v_fma_f32 v174, v174, s66, -v122
v_fma_f32 v175, v175, s66, -v122
v_fma_f32 v204, v204, s66, -v122
v_fma_f32 v205, v205, s66, -v122
v_fma_f32 v206, v206, s66, -v122
v_fma_f32 v207, v207, s66, -v122
v_exp_f32 v172, v172
v_exp_f32 v173, v173
v_exp_f32 v174, v174
v_exp_f32 v175, v175
v_exp_f32 v204, v204
v_exp_f32 v205, v205
v_exp_f32 v206, v206
v_exp_f32 v207, v207
v_cvt_pk_bf16_f32 v172, v172, v173
v_cvt_pk_bf16_f32 v173, v174, v175
v_cvt_pk_bf16_f32 v174, v204, v205
v_cvt_pk_bf16_f32 v175, v206, v207
v_pk_mul_f32 v[84:85], v[84:85], s[68:69]
v_pk_mul_f32 v[86:87], v[86:87], s[68:69]
v_mfma_f32_16x16x32_bf16 v[204:207], a[244:247], v[172:175], 0
s_waitcnt lgkmcnt(1)
v_mfma_f32_16x16x32_bf16 v[168:171], v[232:235], v[172:175], 0
s_waitcnt lgkmcnt(0)
v_mfma_f32_16x16x32_bf16 v[200:203], v[236:239], v[172:175], 0
v_pk_mul_f32 v[148:149], v[148:149], s[68:69]
v_pk_mul_f32 v[150:151], v[150:151], s[68:69]
v_cvt_pk_bf16_f32 v84, v84, v85
v_cvt_pk_bf16_f32 v85, v86, v87
v_cvt_pk_bf16_f32 v86, v148, v149
v_cvt_pk_bf16_f32 v87, v150, v151
v_rcp_f32 v120, v188
v_rcp_f32 v122, v204
v_mul_f32 v120, v120, v5
v_mul_f32 v122, v122, v9
v_mul_f32 v152, v152, v120
v_mul_f32 v153, v153, v120
v_mul_f32 v154, v154, v120
v_mul_f32 v155, v155, v120
v_mul_f32 v184, v184, v120
v_mul_f32 v185, v185, v120
v_mul_f32 v186, v186, v120
v_mul_f32 v187, v187, v120
v_cvt_pk_bf16_f32 v152, v152, v153
v_cvt_pk_bf16_f32 v153, v154, v155
v_cvt_pk_bf16_f32 v154, v184, v185
v_cvt_pk_bf16_f32 v155, v186, v187
buffer_store_dwordx4 v[152:155], v16, s[44:47], s64 offen sc1
v_mul_f32 v168, v168, v122
v_mul_f32 v169, v169, v122
v_mul_f32 v170, v170, v122
v_mul_f32 v171, v171, v122
v_mul_f32 v200, v200, v122
v_mul_f32 v201, v201, v122
v_mul_f32 v202, v202, v122
v_mul_f32 v203, v203, v122
v_cvt_pk_bf16_f32 v168, v168, v169
v_cvt_pk_bf16_f32 v169, v170, v171
v_cvt_pk_bf16_f32 v170, v200, v201
v_cvt_pk_bf16_f32 v171, v202, v203
buffer_store_dwordx4 v[168:171], v16, s[44:47], s65 offen sc1
v_mov_b32 v17, 0xff800000
v_and_b32 v5, 1, v0
v_mul_u32_u24 v5, 0xaaaa, v5
v_add_u32 v5, 0x4444, v5
v_lshl_or_b32 v5, v5, 16, v5
L_attstart_7:
v_mov_b32 v2, v16
v_add_u32 v3, 0x10000, v16
v_mov_b32 v1, 0
s_waitcnt lgkmcnt(0)
s_barrier
s_cmp_eq_u32 s3, 0
s_cbranch_scc1 L_F1
ds_read_b128 a[144:147], v2 offset:0
ds_read_b128 a[148:151], v2 offset:1024
ds_read_b128 a[152:155], v2 offset:2048
ds_read_b128 a[156:159], v2 offset:3072
ds_read_b128 a[160:163], v2 offset:4096
ds_read_b128 a[164:167], v2 offset:5120
ds_read_b128 a[168:171], v2 offset:6144
ds_read_b128 a[172:175], v2 offset:7168
s_mov_b32 m0, s71
s_nop 0
buffer_load_dwordx4 v16, s[32:35], s70 offen offset:0 sc1 lds
buffer_load_dwordx4 v16, s[32:35], s70 offen offset:1024 sc1 lds
s_waitcnt lgkmcnt(7)
v_mfma_f32_16x16x32_bf16 v[88:91], a[144:147], v[24:27], 0
s_waitcnt lgkmcnt(6)
ds_read_b128 a[176:179], v2 offset:8192
v_accvgpr_write_b32 a128, 0
v_mfma_f32_16x16x32_bf16 v[88:91], a[148:151], v[28:31], v[88:91]
s_waitcnt lgkmcnt(6)
ds_read_b128 a[180:183], v2 offset:9216
v_accvgpr_write_b32 a129, 0
v_mfma_f32_16x16x32_bf16 v[88:91], a[152:155], v[32:35], v[88:91]
s_waitcnt lgkmcnt(6)
buffer_load_dwordx4 v16, s[32:35], s70 offen offset:2048 sc1 lds
v_mfma_f32_16x16x32_bf16 v[88:91], a[156:159], v[36:39], v[88:91]
ds_read_b128 a[184:187], v2 offset:10240
v_accvgpr_write_b32 a130, 0
v_mfma_f32_16x16x32_bf16 v[104:107], a[156:159], v[52:55], 0
ds_read_b128 a[188:191], v2 offset:11264
v_accvgpr_write_b32 a131, 0
v_mfma_f32_16x16x32_bf16 v[104:107], a[152:155], v[48:51], v[104:107]
ds_read_b128 a[192:195], v2 offset:12288
v_accvgpr_write_b32 a132, 0
v_mfma_f32_16x16x32_bf16 v[104:107], a[148:151], v[44:47], v[104:107]
ds_read_b128 a[196:199], v2 offset:13312
v_accvgpr_write_b32 a133, 0
v_mfma_f32_16x16x32_bf16 v[104:107], a[144:147], v[40:43], v[104:107]
ds_read_b128 a[200:203], v2 offset:14336
v_accvgpr_write_b32 a134, 0
v_mfma_f32_16x16x32_bf16 v[120:123], a[144:147], v[56:59], 0
ds_read_b128 a[204:207], v2 offset:15360
v_accvgpr_write_b32 a135, 0
v_mfma_f32_16x16x32_bf16 v[120:123], a[148:151], v[60:63], v[120:123]
buffer_load_dwordx4 v16, s[32:35], s70 offen offset:3072 sc1 lds
v_mfma_f32_16x16x32_bf16 v[120:123], a[152:155], v[64:67], v[120:123]
v_accvgpr_write_b32 a136, 0
v_accvgpr_write_b32 a137, 0
v_mfma_f32_16x16x32_bf16 v[120:123], a[156:159], v[68:71], v[120:123]
v_accvgpr_write_b32 a138, 0
v_accvgpr_write_b32 a139, 0
v_mfma_f32_16x16x32_bf16 v[136:139], a[156:159], v[84:87], 0
v_accvgpr_write_b32 a140, 0
v_accvgpr_write_b32 a141, 0
v_mfma_f32_16x16x32_bf16 v[136:139], a[152:155], v[80:83], v[136:139]
v_accvgpr_write_b32 a142, 0
v_accvgpr_write_b32 a143, 0
v_mfma_f32_16x16x32_bf16 v[136:139], a[148:151], v[76:79], v[136:139]
v_mfma_f32_16x16x32_bf16 v[136:139], a[144:147], v[72:75], v[136:139]
s_waitcnt lgkmcnt(0)
s_nop 1
v_max3_f32 v20, v88, v89, v90
v_max_f32 v20, v20, v91
v_max3_f32 v21, v104, v105, v106
v_max_f32 v21, v21, v107
v_max3_f32 v22, v120, v121, v122
v_max_f32 v22, v22, v123
v_max3_f32 v23, v136, v137, v138
v_max_f32 v23, v23, v139
v_mov_b32 v248, v20
v_mov_b32 v249, v21
v_mov_b32 v250, v22
v_mov_b32 v251, v23
v_permlane16_swap_b32 v248, v20
v_permlane16_swap_b32 v249, v21
v_permlane16_swap_b32 v250, v22
v_permlane16_swap_b32 v251, v23
v_max_f32 v20, v20, v248
v_max_f32 v21, v21, v249
v_max_f32 v22, v22, v250
v_max_f32 v23, v23, v251
v_mov_b32 v248, v20
v_mov_b32 v249, v21
v_mov_b32 v250, v22
v_mov_b32 v251, v23
v_permlane32_swap_b32 v248, v20
v_permlane32_swap_b32 v249, v21
v_permlane32_swap_b32 v250, v22
v_permlane32_swap_b32 v251, v23
v_max_f32 v20, v20, v248
v_max_f32 v21, v21, v249
v_max_f32 v22, v22, v250
v_max_f32 v23, v23, v251
s_cmp_eq_u32 s73, 0
s_cselect_b64 vcc, 0, -1
v_cndmask_b32 v20, v20, v252, vcc
v_cndmask_b32 v21, v21, v253, vcc
v_cndmask_b32 v22, v22, v254, vcc
v_cndmask_b32 v23, v23, v255, vcc
v_sub_f32 v228, 0, v23
v_sub_f32 v229, 0, v23
v_sub_f32 v230, 0, v23
v_sub_f32 v231, 0, v23
v_sub_f32 v224, 0, v22
v_sub_f32 v225, 0, v22
v_sub_f32 v226, 0, v22
v_sub_f32 v227, 0, v22
v_sub_f32 v220, 0, v21
v_sub_f32 v221, 0, v21
v_sub_f32 v222, 0, v21
v_sub_f32 v223, 0, v21
v_sub_f32 v216, 0, v20
v_sub_f32 v217, 0, v20
v_sub_f32 v218, 0, v20
v_sub_f32 v219, 0, v20
v_mfma_f32_16x16x32_bf16 v[140:143], a[160:163], v[72:75], v[228:231]
s_add_u32 m0, s71, 4096
v_add_f32 v88, v88, v216
v_add_f32 v89, v89, v216
v_mfma_f32_16x16x32_bf16 v[140:143], a[164:167], v[76:79], v[140:143]
v_add_f32 v90, v90, v216
v_add_f32 v91, v91, v216
v_exp_f32 v88, v88
v_mfma_f32_16x16x32_bf16 v[140:143], a[168:171], v[80:83], v[140:143]
s_add_u32 s64, s70, 4096
v_exp_f32 v89, v89
v_mfma_f32_16x16x32_bf16 v[140:143], a[172:175], v[84:87], v[140:143]
buffer_load_dwordx4 v16, s[32:35], s64 offen offset:0 sc1 lds
v_mfma_f32_16x16x32_bf16 v[124:127], a[172:175], v[68:71], v[224:227]
v_exp_f32 v90, v90
v_mfma_f32_16x16x32_bf16 v[124:127], a[168:171], v[64:67], v[124:127]
v_exp_f32 v91, v91
v_mfma_f32_16x16x32_bf16 v[124:127], a[164:167], v[60:63], v[124:127]
v_add_f32 v104, v104, v220
v_add_f32 v105, v105, v220
v_add_f32 v106, v106, v220
v_add_f32 v107, v107, v220
v_exp_f32 v104, v104
v_mfma_f32_16x16x32_bf16 v[124:127], a[160:163], v[56:59], v[124:127]
v_exp_f32 v105, v105
v_mfma_f32_16x16x32_bf16 v[108:111], a[160:163], v[40:43], v[220:223]
v_exp_f32 v106, v106
v_mfma_f32_16x16x32_bf16 v[108:111], a[164:167], v[44:47], v[108:111]
buffer_load_dwordx4 v16, s[32:35], s64 offen offset:1024 sc1 lds
v_mfma_f32_16x16x32_bf16 v[108:111], a[168:171], v[48:51], v[108:111]
v_cvt_pk_bf16_f32 v152, v88, v89
v_add_f32 v120, v120, v224
v_mfma_f32_16x16x32_bf16 v[108:111], a[172:175], v[52:55], v[108:111]
v_exp_f32 v107, v107
v_mfma_f32_16x16x32_bf16 v[92:95], a[172:175], v[36:39], v[216:219]
v_add_f32 v121, v121, v224
v_add_f32 v122, v122, v224
v_add_f32 v123, v123, v224
v_exp_f32 v120, v120
v_mfma_f32_16x16x32_bf16 v[92:95], a[168:171], v[32:35], v[92:95]
v_cvt_pk_bf16_f32 v153, v90, v91
v_exp_f32 v121, v121
v_mfma_f32_16x16x32_bf16 v[92:95], a[164:167], v[28:31], v[92:95]
v_exp_f32 v122, v122
v_mfma_f32_16x16x32_bf16 v[92:95], a[160:163], v[24:27], v[92:95]
v_exp_f32 v123, v123
v_mfma_f32_16x16x32_bf16 v[96:99], a[176:179], v[24:27], v[216:219]
v_cvt_pk_bf16_f32 v160, v104, v105
v_add_f32 v136, v136, v228
v_mfma_f32_16x16x32_bf16 v[96:99], a[180:183], v[28:31], v[96:99]
buffer_load_dwordx4 v16, s[32:35], s64 offen offset:2048 sc1 lds
v_add_f32 v137, v137, v228
v_add_f32 v138, v138, v228
v_add_f32 v139, v139, v228
v_exp_f32 v136, v136
v_mfma_f32_16x16x32_bf16 v[96:99], a[184:187], v[32:35], v[96:99]
v_exp_f32 v137, v137
v_mfma_f32_16x16x32_bf16 v[96:99], a[188:191], v[36:39], v[96:99]
v_cvt_pk_bf16_f32 v161, v106, v107
v_cvt_pk_bf16_f32 v184, v120, v121
v_mfma_f32_16x16x32_bf16 v[112:115], a[188:191], v[52:55], v[220:223]
v_exp_f32 v138, v138
v_mfma_f32_16x16x32_bf16 v[112:115], a[184:187], v[48:51], v[112:115]
v_exp_f32 v139, v139
v_mfma_f32_16x16x32_bf16 v[112:115], a[180:183], v[44:47], v[112:115]
v_exp_f32 v140, v140
v_mfma_f32_16x16x32_bf16 v[112:115], a[176:179], v[40:43], v[112:115]
v_exp_f32 v141, v141
v_mfma_f32_16x16x32_bf16 v[128:131], a[176:179], v[56:59], v[224:227]
buffer_load_dwordx4 v16, s[32:35], s64 offen offset:3072 sc1 lds
v_cvt_pk_bf16_f32 v185, v122, v123
v_mfma_f32_16x16x32_bf16 v[128:131], a[180:183], v[60:63], v[128:131]
v_exp_f32 v142, v142
v_mfma_f32_16x16x32_bf16 v[128:131], a[184:187], v[64:67], v[128:131]
v_exp_f32 v143, v143
v_mfma_f32_16x16x32_bf16 v[128:131], a[188:191], v[68:71], v[128:131]
v_cvt_pk_bf16_f32 v192, v136, v137
v_cvt_pk_bf16_f32 v193, v138, v139
v_mfma_f32_16x16x32_bf16 v[144:147], a[188:191], v[84:87], v[228:231]
v_exp_f32 v124, v124
v_mfma_f32_16x16x32_bf16 v[144:147], a[184:187], v[80:83], v[144:147]
v_exp_f32 v125, v125
v_mfma_f32_16x16x32_bf16 v[144:147], a[180:183], v[76:79], v[144:147]
s_waitcnt vmcnt(8)
s_barrier
v_mfma_f32_16x16x32_bf16 v[144:147], a[176:179], v[72:75], v[144:147]
v_exp_f32 v126, v126
v_mfma_f32_16x16x32_bf16 v[148:151], a[192:195], v[72:75], v[228:231]
v_cvt_pk_bf16_f32 v194, v140, v141
v_cvt_pk_bf16_f32 v195, v142, v143
v_mfma_f32_16x16x32_bf16 v[148:151], a[196:199], v[76:79], v[148:151]
v_exp_f32 v127, v127
v_mfma_f32_16x16x32_bf16 v[148:151], a[200:203], v[80:83], v[148:151]
s_xor_b32 s71, s71, 16384
v_exp_f32 v108, v108
v_mfma_f32_16x16x32_bf16 v[148:151], a[204:207], v[84:87], v[148:151]
s_add_u32 s70, s70, 32768
v_exp_f32 v109, v109
v_mfma_f32_16x16x32_bf16 v[132:135], a[204:207], v[68:71], v[224:227]
s_mov_b32 m0, s71
v_exp_f32 v110, v110
v_mfma_f32_16x16x32_bf16 v[132:135], a[200:203], v[64:67], v[132:135]
buffer_load_dwordx4 v16, s[32:35], s70 offen offset:0 sc1 lds
v_mfma_f32_16x16x32_bf16 v[132:135], a[196:199], v[60:63], v[132:135]
v_cvt_pk_bf16_f32 v186, v124, v125
v_exp_f32 v111, v111
v_mfma_f32_16x16x32_bf16 v[132:135], a[192:195], v[56:59], v[132:135]
v_exp_f32 v92, v92
v_mfma_f32_16x16x32_bf16 v[116:119], a[192:195], v[40:43], v[220:223]
v_exp_f32 v93, v93
v_mfma_f32_16x16x32_bf16 v[116:119], a[196:199], v[44:47], v[116:119]
ds_read_b128 a[144:147], v2 offset:16384
v_cvt_pk_bf16_f32 v187, v126, v127
v_mfma_f32_16x16x32_bf16 v[116:119], a[200:203], v[48:51], v[116:119]
v_exp_f32 v94, v94
v_mfma_f32_16x16x32_bf16 v[116:119], a[204:207], v[52:55], v[116:119]
ds_read_b128 a[148:151], v2 offset:17408
v_cvt_pk_bf16_f32 v162, v108, v109
v_mfma_f32_16x16x32_bf16 v[100:103], a[204:207], v[36:39], v[216:219]
ds_read_b128 a[152:155], v2 offset:18432
buffer_load_dwordx4 v16, s[32:35], s70 offen offset:1024 sc1 lds
v_exp_f32 v95, v95
v_mfma_f32_16x16x32_bf16 v[100:103], a[200:203], v[32:35], v[100:103]
ds_read_b128 a[156:159], v2 offset:19456
v_exp_f32 v96, v96
v_mfma_f32_16x16x32_bf16 v[100:103], a[196:199], v[28:31], v[100:103]
v_cvt_pk_bf16_f32 v163, v110, v111
v_exp_f32 v97, v97
v_mfma_f32_16x16x32_bf16 v[100:103], a[192:195], v[24:27], v[100:103]
s_waitcnt lgkmcnt(3)
ds_read_b128 a[160:163], v2 offset:20480
ds_read_b128 a[164:167], v2 offset:21504
ds_read_b128 a[168:171], v2 offset:22528
ds_read_b128 a[172:175], v2 offset:23552
v_mfma_f32_16x16x32_bf16 v[88:91], a[144:147], v[24:27], v[216:219]
s_waitcnt lgkmcnt(6)
v_exp_f32 v98, v98
v_mfma_f32_16x16x32_bf16 v[88:91], a[148:151], v[28:31], v[88:91]
s_waitcnt lgkmcnt(5)
v_cvt_pk_bf16_f32 v154, v92, v93
v_exp_f32 v99, v99
v_mfma_f32_16x16x32_bf16 v[88:91], a[152:155], v[32:35], v[88:91]
s_waitcnt lgkmcnt(4)
v_exp_f32 v112, v112
v_mfma_f32_16x16x32_bf16 v[88:91], a[156:159], v[36:39], v[88:91]
v_exp_f32 v113, v113
v_mfma_f32_16x16x32_bf16 v[104:107], a[156:159], v[52:55], v[220:223]
v_cvt_pk_bf16_f32 v155, v94, v95
v_cvt_pk_bf16_f32 v156, v96, v97
v_mfma_f32_16x16x32_bf16 v[104:107], a[152:155], v[48:51], v[104:107]
buffer_load_dwordx4 v16, s[32:35], s70 offen offset:2048 sc1 lds
v_exp_f32 v114, v114
v_mfma_f32_16x16x32_bf16 v[104:107], a[148:151], v[44:47], v[104:107]
v_exp_f32 v115, v115
v_mfma_f32_16x16x32_bf16 v[104:107], a[144:147], v[40:43], v[104:107]
v_exp_f32 v128, v128
v_mfma_f32_16x16x32_bf16 v[120:123], a[144:147], v[56:59], v[224:227]
v_exp_f32 v129, v129
v_mfma_f32_16x16x32_bf16 v[120:123], a[148:151], v[60:63], v[120:123]
v_cvt_pk_bf16_f32 v157, v98, v99
v_cvt_pk_bf16_f32 v164, v112, v113
v_mfma_f32_16x16x32_bf16 v[120:123], a[152:155], v[64:67], v[120:123]
v_exp_f32 v130, v130
v_mfma_f32_16x16x32_bf16 v[120:123], a[156:159], v[68:71], v[120:123]
v_exp_f32 v131, v131
v_mfma_f32_16x16x32_bf16 v[136:139], a[156:159], v[84:87], v[228:231]
v_exp_f32 v144, v144
v_mfma_f32_16x16x32_bf16 v[136:139], a[152:155], v[80:83], v[136:139]
v_exp_f32 v145, v145
v_mfma_f32_16x16x32_bf16 v[136:139], a[148:151], v[76:79], v[136:139]
v_exp_f32 v146, v146
v_mfma_f32_16x16x32_bf16 v[136:139], a[144:147], v[72:75], v[136:139]
s_waitcnt lgkmcnt(0)
v_cvt_pk_bf16_f32 v165, v114, v115
v_cvt_pk_bf16_f32 v188, v128, v129
v_mfma_f32_16x16x32_bf16 v[140:143], a[160:163], v[72:75], v[228:231]
v_exp_f32 v147, v147
v_mfma_f32_16x16x32_bf16 v[140:143], a[164:167], v[76:79], v[140:143]
v_exp_f32 v148, v148
v_mfma_f32_16x16x32_bf16 v[140:143], a[168:171], v[80:83], v[140:143]
v_exp_f32 v149, v149
v_mfma_f32_16x16x32_bf16 v[140:143], a[172:175], v[84:87], v[140:143]
buffer_load_dwordx4 v16, s[32:35], s70 offen offset:3072 sc1 lds
v_mfma_f32_16x16x32_bf16 v[124:127], a[172:175], v[68:71], v[224:227]
v_cvt_pk_bf16_f32 v189, v130, v131
v_cvt_pk_bf16_f32 v196, v144, v145
v_mfma_f32_16x16x32_bf16 v[124:127], a[168:171], v[64:67], v[124:127]
v_exp_f32 v150, v150
v_mfma_f32_16x16x32_bf16 v[124:127], a[164:167], v[60:63], v[124:127]
v_exp_f32 v151, v151
v_mfma_f32_16x16x32_bf16 v[124:127], a[160:163], v[56:59], v[124:127]
v_exp_f32 v132, v132
v_mfma_f32_16x16x32_bf16 v[108:111], a[160:163], v[40:43], v[220:223]
ds_read_b128 a[176:179], v2 offset:24576
v_cvt_pk_bf16_f32 v197, v146, v147
v_mfma_f32_16x16x32_bf16 v[108:111], a[164:167], v[44:47], v[108:111]
ds_read_b128 a[180:183], v2 offset:25600
v_cvt_pk_bf16_f32 v198, v148, v149
v_mfma_f32_16x16x32_bf16 v[108:111], a[168:171], v[48:51], v[108:111]
ds_read_b128 a[184:187], v2 offset:26624
v_exp_f32 v133, v133
v_mfma_f32_16x16x32_bf16 v[108:111], a[172:175], v[52:55], v[108:111]
ds_read_b128 a[188:191], v2 offset:27648
v_exp_f32 v134, v134
v_mfma_f32_16x16x32_bf16 v[92:95], a[172:175], v[36:39], v[216:219]
v_exp_f32 v135, v135
v_mfma_f32_16x16x32_bf16 v[92:95], a[168:171], v[32:35], v[92:95]
v_exp_f32 v116, v116
v_mfma_f32_16x16x32_bf16 v[92:95], a[164:167], v[28:31], v[92:95]
v_exp_f32 v117, v117
v_mfma_f32_16x16x32_bf16 v[92:95], a[160:163], v[24:27], v[92:95]
s_waitcnt lgkmcnt(2)
v_cvt_pk_bf16_f32 v199, v150, v151
v_cvt_pk_bf16_f32 v190, v132, v133
v_mfma_f32_16x16x32_bf16 v[96:99], a[176:179], v[24:27], v[216:219]
v_exp_f32 v118, v118
v_mfma_f32_16x16x32_bf16 v[96:99], a[180:183], v[28:31], v[96:99]
s_waitcnt lgkmcnt(0)
s_add_u32 m0, s71, 4096
v_exp_f32 v119, v119
v_mfma_f32_16x16x32_bf16 v[96:99], a[184:187], v[32:35], v[96:99]
s_add_u32 s64, s70, 4096
v_exp_f32 v100, v100
v_mfma_f32_16x16x32_bf16 v[96:99], a[188:191], v[36:39], v[96:99]
buffer_load_dwordx4 v16, s[32:35], s64 offen offset:0 sc1 lds
v_mfma_f32_16x16x32_bf16 v[112:115], a[188:191], v[52:55], v[220:223]
v_exp_f32 v101, v101
v_mfma_f32_16x16x32_bf16 v[112:115], a[184:187], v[48:51], v[112:115]
v_cvt_pk_bf16_f32 v191, v134, v135
v_cvt_pk_bf16_f32 v166, v116, v117
v_mfma_f32_16x16x32_bf16 v[112:115], a[180:183], v[44:47], v[112:115]
v_exp_f32 v102, v102
v_mfma_f32_16x16x32_bf16 v[112:115], a[176:179], v[40:43], v[112:115]
v_exp_f32 v103, v103
v_mfma_f32_16x16x32_bf16 v[128:131], a[176:179], v[56:59], v[224:227]
s_lshl_b32 s66, s30, 30
ds_read_b128 a[192:195], v2 offset:28672
v_cvt_pk_bf16_f32 v167, v118, v119
v_mfma_f32_16x16x32_bf16 v[128:131], a[180:183], v[60:63], v[128:131]
ds_read_b128 a[196:199], v2 offset:29696
v_exp_f32 v88, v88
v_mfma_f32_16x16x32_bf16 v[128:131], a[184:187], v[64:67], v[128:131]
ds_read_b128 a[200:203], v2 offset:30720
v_exp_f32 v89, v89
v_mfma_f32_16x16x32_bf16 v[128:131], a[188:191], v[68:71], v[128:131]
ds_read_b128 a[204:207], v2 offset:31744
v_cvt_pk_bf16_f32 v158, v100, v101
v_mfma_f32_16x16x32_bf16 v[144:147], a[188:191], v[84:87], v[228:231]
v_exp_f32 v90, v90
v_mfma_f32_16x16x32_bf16 v[144:147], a[184:187], v[80:83], v[144:147]
v_exp_f32 v91, v91
v_mfma_f32_16x16x32_bf16 v[144:147], a[180:183], v[76:79], v[144:147]
v_exp_f32 v104, v104
v_mfma_f32_16x16x32_bf16 v[144:147], a[176:179], v[72:75], v[144:147]
s_waitcnt lgkmcnt(2)
v_exp_f32 v105, v105
v_mfma_f32_16x16x32_bf16 v[148:151], a[192:195], v[72:75], v[228:231]
v_cvt_pk_bf16_f32 v159, v102, v103
v_cvt_pk_bf16_f32 v168, v88, v89
v_mfma_f32_16x16x32_bf16 v[148:151], a[196:199], v[76:79], v[148:151]
s_waitcnt lgkmcnt(0)
v_exp_f32 v106, v106
v_mfma_f32_16x16x32_bf16 v[148:151], a[200:203], v[80:83], v[148:151]
v_exp_f32 v107, v107
v_mfma_f32_16x16x32_bf16 v[148:151], a[204:207], v[84:87], v[148:151]
buffer_load_dwordx4 v16, s[32:35], s64 offen offset:1024 sc1 lds
v_mfma_f32_16x16x32_bf16 v[132:135], a[204:207], v[68:71], v[224:227]
v_exp_f32 v120, v120
v_mfma_f32_16x16x32_bf16 v[132:135], a[200:203], v[64:67], v[132:135]
v_cvt_pk_bf16_f32 v169, v90, v91
v_cvt_pk_bf16_f32 v176, v104, v105
v_mfma_f32_16x16x32_bf16 v[132:135], a[196:199], v[60:63], v[132:135]
v_exp_f32 v121, v121
v_mfma_f32_16x16x32_bf16 v[132:135], a[192:195], v[56:59], v[132:135]
v_exp_f32 v122, v122
v_mfma_f32_16x16x32_bf16 v[116:119], a[192:195], v[40:43], v[220:223]
v_exp_f32 v123, v123
v_mfma_f32_16x16x32_bf16 v[116:119], a[196:199], v[44:47], v[116:119]
v_exp_f32 v136, v136
v_mfma_f32_16x16x32_bf16 v[116:119], a[200:203], v[48:51], v[116:119]
v_exp_f32 v137, v137
v_mfma_f32_16x16x32_bf16 v[116:119], a[204:207], v[52:55], v[116:119]
ds_read_b128 a[144:147], v3 offset:16384
v_cvt_pk_bf16_f32 v177, v106, v107
v_mfma_f32_16x16x32_bf16 v[100:103], a[204:207], v[36:39], v[216:219]
v_exp_f32 v138, v138
v_mfma_f32_16x16x32_bf16 v[100:103], a[200:203], v[32:35], v[100:103]
ds_read_b128 a[148:151], v3 offset:24576
v_cvt_pk_bf16_f32 v200, v120, v121
v_mfma_f32_16x16x32_bf16 v[100:103], a[196:199], v[28:31], v[100:103]
v_exp_f32 v139, v139
v_mfma_f32_16x16x32_bf16 v[100:103], a[192:195], v[24:27], v[100:103]
v_exp_f32 v140, v140
v_smfmac_f32_16x16x64_bf16 a[128:131], a[240:243], v[152:159], v5
v_cvt_pk_bf16_f32 v201, v122, v123
v_smfmac_f32_16x16x64_bf16 a[132:135], a[240:243], v[160:167], v5
v_exp_f32 v141, v141
v_smfmac_f32_16x16x64_bf16 a[136:139], a[240:243], v[184:191], v5
v_exp_f32 v142, v142
v_smfmac_f32_16x16x64_bf16 a[140:143], a[240:243], v[192:199], v5
s_waitcnt lgkmcnt(0)
buffer_load_dwordx4 v16, s[32:35], s64 offen offset:2048 sc1 lds
v_cvt_pk_bf16_f32 v208, v136, v137
v_mfma_f32_16x16x32_bf16 a[0:3], a[144:147], v[152:155], 0
ds_read_b128 a[152:155], v3 offset:17408
v_exp_f32 v143, v143
v_mfma_f32_16x16x32_bf16 a[0:3], a[148:151], v[156:159], a[0:3]
ds_read_b128 a[156:159], v3 offset:25600
v_exp_f32 v124, v124
v_mfma_f32_16x16x32_bf16 a[32:35], a[148:151], v[164:167], 0
v_cvt_pk_bf16_f32 v209, v138, v139
v_exp_f32 v125, v125
v_mfma_f32_16x16x32_bf16 a[32:35], a[144:147], v[160:163], a[32:35]
v_exp_f32 v126, v126
v_mfma_f32_16x16x32_bf16 a[64:67], a[144:147], v[184:187], 0
v_exp_f32 v127, v127
v_mfma_f32_16x16x32_bf16 a[64:67], a[148:151], v[188:191], a[64:67]
v_cvt_pk_bf16_f32 v210, v140, v141
v_cvt_pk_bf16_f32 v211, v142, v143
v_mfma_f32_16x16x32_bf16 a[96:99], a[148:151], v[196:199], 0
v_exp_f32 v108, v108
v_mfma_f32_16x16x32_bf16 a[96:99], a[144:147], v[192:195], a[96:99]
s_waitcnt lgkmcnt(0)
v_exp_f32 v109, v109
v_mfma_f32_16x16x32_bf16 a[100:103], a[152:155], v[192:195], 0
ds_read_b128 a[160:163], v3 offset:18432
v_cvt_pk_bf16_f32 v202, v124, v125
v_mfma_f32_16x16x32_bf16 a[100:103], a[156:159], v[196:199], a[100:103]
ds_read_b128 a[164:167], v3 offset:26624
v_exp_f32 v110, v110
v_mfma_f32_16x16x32_bf16 a[68:71], a[156:159], v[188:191], 0
v_exp_f32 v111, v111
v_mfma_f32_16x16x32_bf16 a[68:71], a[152:155], v[184:187], a[68:71]
v_exp_f32 v92, v92
v_mfma_f32_16x16x32_bf16 a[36:39], a[152:155], v[160:163], 0
v_exp_f32 v93, v93
v_mfma_f32_16x16x32_bf16 a[36:39], a[156:159], v[164:167], a[36:39]
v_cvt_pk_bf16_f32 v203, v126, v127
v_cvt_pk_bf16_f32 v178, v108, v109
v_mfma_f32_16x16x32_bf16 a[4:7], a[156:159], v[156:159], 0
buffer_load_dwordx4 v16, s[32:35], s64 offen offset:3072 sc1 lds
v_mfma_f32_16x16x32_bf16 a[4:7], a[152:155], v[152:155], a[4:7]
s_waitcnt lgkmcnt(0)
v_exp_f32 v94, v94
v_mfma_f32_16x16x32_bf16 a[8:11], a[160:163], v[152:155], 0
ds_read_b128 a[168:171], v3 offset:19456
v_cvt_pk_bf16_f32 v179, v110, v111
v_mfma_f32_16x16x32_bf16 a[8:11], a[164:167], v[156:159], a[8:11]
ds_read_b128 a[172:175], v3 offset:27648
v_exp_f32 v95, v95
v_mfma_f32_16x16x32_bf16 a[40:43], a[164:167], v[164:167], 0
v_exp_f32 v96, v96
v_mfma_f32_16x16x32_bf16 a[40:43], a[160:163], v[160:163], a[40:43]
v_exp_f32 v97, v97
v_mfma_f32_16x16x32_bf16 a[72:75], a[160:163], v[184:187], 0
v_exp_f32 v98, v98
v_mfma_f32_16x16x32_bf16 a[72:75], a[164:167], v[188:191], a[72:75]
v_exp_f32 v99, v99
v_mfma_f32_16x16x32_bf16 a[104:107], a[164:167], v[196:199], 0
ds_read_b128 a[176:179], v3 offset:20480
v_cvt_pk_bf16_f32 v170, v92, v93
v_mfma_f32_16x16x32_bf16 a[104:107], a[160:163], v[192:195], a[104:107]
s_waitcnt lgkmcnt(1)
v_exp_f32 v112, v112
v_mfma_f32_16x16x32_bf16 a[108:111], a[168:171], v[192:195], 0
v_exp_f32 v113, v113
v_mfma_f32_16x16x32_bf16 a[108:111], a[172:175], v[196:199], a[108:111]
ds_read_b128 a[180:183], v3 offset:28672
v_cvt_pk_bf16_f32 v171, v94, v95
v_mfma_f32_16x16x32_bf16 a[76:79], a[172:175], v[188:191], 0
v_exp_f32 v114, v114
v_mfma_f32_16x16x32_bf16 a[76:79], a[168:171], v[184:187], a[76:79]
v_cvt_pk_bf16_f32 v172, v96, v97
v_xor_b32 v2, 0x8000, v2
v_mfma_f32_16x16x32_bf16 a[44:47], a[168:171], v[160:163], 0
ds_read_b128 a[184:187], v3 offset:21504
ds_read_b128 a[188:191], v3 offset:29696
ds_read_b128 a[192:195], v3 offset:22528
ds_read_b128 a[196:199], v3 offset:30720
ds_read_b128 a[200:203], v3 offset:23552
ds_read_b128 a[204:207], v3 offset:31744
v_exp_f32 v115, v115
v_mfma_f32_16x16x32_bf16 a[44:47], a[172:175], v[164:167], a[44:47]
s_waitcnt vmcnt(8)
s_barrier
v_exp_f32 v128, v128
v_mfma_f32_16x16x32_bf16 a[12:15], a[172:175], v[156:159], 0
v_cvt_pk_bf16_f32 v173, v98, v99
v_cvt_pk_bf16_f32 v180, v112, v113
v_mfma_f32_16x16x32_bf16 a[12:15], a[168:171], v[152:155], a[12:15]
s_waitcnt lgkmcnt(6)
v_exp_f32 v129, v129
v_mfma_f32_16x16x32_bf16 a[16:19], a[176:179], v[152:155], 0
v_exp_f32 v130, v130
v_mfma_f32_16x16x32_bf16 a[16:19], a[180:183], v[156:159], a[16:19]
s_xor_b32 s71, s71, 49152
v_exp_f32 v131, v131
v_mfma_f32_16x16x32_bf16 a[48:51], a[180:183], v[164:167], 0
s_add_u32 s70, s70, 32768
v_exp_f32 v144, v144
v_mfma_f32_16x16x32_bf16 a[48:51], a[176:179], v[160:163], a[48:51]
s_mov_b32 m0, s71
v_exp_f32 v145, v145
v_mfma_f32_16x16x32_bf16 a[80:83], a[176:179], v[184:187], 0
buffer_load_dwordx4 v16, s[32:35], s70 offen offset:0 sc1 lds
v_cvt_pk_bf16_f32 v181, v114, v115
v_mfma_f32_16x16x32_bf16 a[80:83], a[180:183], v[188:191], a[80:83]
v_exp_f32 v146, v146
v_mfma_f32_16x16x32_bf16 a[112:115], a[180:183], v[196:199], 0
v_exp_f32 v147, v147
v_mfma_f32_16x16x32_bf16 a[112:115], a[176:179], v[192:195], a[112:115]
s_waitcnt lgkmcnt(0)
v_cvt_pk_bf16_f32 v204, v128, v129
v_cvt_pk_bf16_f32 v205, v130, v131
v_mfma_f32_16x16x32_bf16 a[116:119], a[184:187], v[192:195], 0
v_exp_f32 v148, v148
v_mfma_f32_16x16x32_bf16 a[116:119], a[188:191], v[196:199], a[116:119]
v_exp_f32 v149, v149
v_mfma_f32_16x16x32_bf16 a[84:87], a[188:191], v[188:191], 0
v_exp_f32 v150, v150
v_mfma_f32_16x16x32_bf16 a[84:87], a[184:187], v[184:187], a[84:87]
v_exp_f32 v151, v151
v_mfma_f32_16x16x32_bf16 a[52:55], a[184:187], v[160:163], 0
v_cvt_pk_bf16_f32 v212, v144, v145
v_cvt_pk_bf16_f32 v213, v146, v147
v_mfma_f32_16x16x32_bf16 a[52:55], a[188:191], v[164:167], a[52:55]
v_exp_f32 v132, v132
v_mfma_f32_16x16x32_bf16 a[20:23], a[188:191], v[156:159], 0
v_exp_f32 v133, v133
v_mfma_f32_16x16x32_bf16 a[20:23], a[184:187], v[152:155], a[20:23]
ds_read_b128 a[144:147], v2 offset:0
v_lshl_add_u32 v19, v0, 24, s66
v_mfma_f32_16x16x32_bf16 a[24:27], a[192:195], v[152:155], 0
s_lshr_b32 s67, s31, 4
v_exp_f32 v134, v134
v_mfma_f32_16x16x32_bf16 a[24:27], a[196:199], v[156:159], a[24:27]
s_lshl1_add_u32 s67, s3, s67
v_exp_f32 v135, v135
v_mfma_f32_16x16x32_bf16 a[56:59], a[196:199], v[164:167], 0
s_lshl_b32 s79, s67, 8
v_cvt_pk_bf16_f32 v214, v148, v149
v_cvt_pk_bf16_f32 v215, v150, v151
v_mfma_f32_16x16x32_bf16 a[56:59], a[192:195], v[160:163], a[56:59]
s_add_u32 s79, s79, 8192
buffer_load_dwordx4 v16, s[32:35], s70 offen offset:1024 sc1 lds
v_mfma_f32_16x16x32_bf16 a[88:91], a[192:195], v[184:187], 0
s_add_u32 s69, s31, 12
v_exp_f32 v116, v116
v_mfma_f32_16x16x32_bf16 a[88:91], a[196:199], v[188:191], a[88:91]
s_lshr_b32 s69, s69, 5
v_exp_f32 v117, v117
v_mfma_f32_16x16x32_bf16 a[120:123], a[196:199], v[196:199], 0
s_lshl1_add_u32 s69, s3, s69
v_exp_f32 v118, v118
v_mfma_f32_16x16x32_bf16 a[120:123], a[192:195], v[192:195], a[120:123]
s_lshl_b32 s69, s69, 8
v_cvt_pk_bf16_f32 v206, v132, v133
v_cvt_pk_bf16_f32 v207, v134, v135
v_mfma_f32_16x16x32_bf16 a[124:127], a[200:203], v[192:195], 0
s_add_u32 s69, s69, 8192
s_add_u32 s17, s78, L_D-L_pc+0
v_exp_f32 v119, v119
v_mfma_f32_16x16x32_bf16 a[124:127], a[204:207], v[196:199], a[124:127]
buffer_load_dword a252, v16, s[88:91], s17 offen
v_exp_f32 v100, v100
v_mfma_f32_16x16x32_bf16 a[92:95], a[204:207], v[188:191], 0
s_lshl_b32 s67, s73, 16
v_exp_f32 v101, v101
v_mfma_f32_16x16x32_bf16 a[92:95], a[200:203], v[184:187], a[92:95]
s_xor_b32 s68, s80, 256
s_add_u32 s17, s78, L_D-L_pc+4096
ds_read_b128 a[148:151], v2 offset:1024
v_cvt_pk_bf16_f32 v182, v116, v117
v_mfma_f32_16x16x32_bf16 a[60:63], a[200:203], v[160:163], 0
s_add_u32 s68, s68, s67
buffer_load_dword a252, v16, s[88:91], s17 offen
ds_read_b128 a[152:155], v2 offset:2048
v_exp_f32 v102, v102
v_mfma_f32_16x16x32_bf16 a[60:63], a[204:207], v[164:167], a[60:63]
s_add_u32 s67, s67, s69
ds_read_b128 a[156:159], v2 offset:3072
v_cvt_pk_bf16_f32 v183, v118, v119
v_mfma_f32_16x16x32_bf16 a[28:31], a[204:207], v[156:159], 0
s_mov_b64 exec, 1
buffer_atomic_add a251, v19, s[52:55], s67 offen offset:0 sc1
buffer_atomic_add a251, v19, s[52:55], s68 offen offset:0 sc1
s_mov_b64 exec, -1
s_add_u32 s17, s78, L_D-L_pc+8192
v_exp_f32 v103, v103
v_mfma_f32_16x16x32_bf16 a[28:31], a[200:203], v[152:155], a[28:31]
ds_read_b128 a[160:163], v2 offset:4096
buffer_load_dword a252, v16, s[88:91], s17 offen
ds_read_b128 a[164:167], v2 offset:5120
ds_read_b128 a[168:171], v2 offset:6144
ds_read_b128 a[172:175], v2 offset:7168
v_mul_u32_u24 v19, 52, v0
v_cvt_pk_bf16_f32 v174, v100, v101
v_cvt_pk_bf16_f32 v175, v102, v103
v_xor_b32 v3, 0x8000, v3
s_sub_u32 s72, s3, 1
s_cmp_eq_u32 s72, 0
s_cbranch_scc1 L_DD
.p2align 3
L_D:
s_waitcnt lgkmcnt(7)
v_mfma_f32_16x16x32_bf16 v[88:91], a[144:147], v[24:27], v[216:219]
s_waitcnt lgkmcnt(6)
ds_read_b128 a[176:179], v2 offset:8192
v_mfma_f32_16x16x32_bf16 v[88:91], a[148:151], v[28:31], v[88:91]
s_waitcnt lgkmcnt(6)
ds_read_b128 a[180:183], v2 offset:9216
v_mfma_f32_16x16x32_bf16 v[88:91], a[152:155], v[32:35], v[88:91]
s_waitcnt lgkmcnt(6)
buffer_load_dwordx4 v16, s[32:35], s70 offen offset:2048 sc1 lds
v_mfma_f32_16x16x32_bf16 v[88:91], a[156:159], v[36:39], v[88:91]
ds_read_b128 a[184:187], v2 offset:10240
v_mfma_f32_16x16x32_bf16 v[104:107], a[156:159], v[52:55], v[220:223]
v_mfma_f32_16x16x32_bf16 v[104:107], a[152:155], v[48:51], v[104:107]
buffer_load_dword a252, v19, s[40:43], s81 offen
v_mfma_f32_16x16x32_bf16 v[104:107], a[148:151], v[44:47], v[104:107]
ds_read_b128 a[188:191], v2 offset:11264
v_mfma_f32_16x16x32_bf16 v[104:107], a[144:147], v[40:43], v[104:107]
v_mfma_f32_16x16x32_bf16 v[120:123], a[144:147], v[56:59], v[224:227]
v_mfma_f32_16x16x32_bf16 v[120:123], a[148:151], v[60:63], v[120:123]
v_mfma_f32_16x16x32_bf16 v[120:123], a[152:155], v[64:67], v[120:123]
v_exp_f32 v88, v88
v_mfma_f32_16x16x32_bf16 v[120:123], a[156:159], v[68:71], v[120:123]
v_exp_f32 v89, v89
v_mfma_f32_16x16x32_bf16 v[136:139], a[156:159], v[84:87], v[228:231]
v_exp_f32 v90, v90
v_mfma_f32_16x16x32_bf16 v[136:139], a[152:155], v[80:83], v[136:139]
v_exp_f32 v91, v91
v_mfma_f32_16x16x32_bf16 v[136:139], a[148:151], v[76:79], v[136:139]
v_exp_f32 v104, v104
v_mfma_f32_16x16x32_bf16 v[136:139], a[144:147], v[72:75], v[136:139]
s_waitcnt lgkmcnt(0)
s_add_u32 s81, s81, 425984
v_exp_f32 v105, v105
v_mfma_f32_16x16x32_bf16 v[140:143], a[160:163], v[72:75], v[228:231]
v_exp_f32 v106, v106
v_mfma_f32_16x16x32_bf16 v[140:143], a[164:167], v[76:79], v[140:143]
buffer_load_dwordx4 v16, s[32:35], s70 offen offset:3072 sc1 lds
v_mfma_f32_16x16x32_bf16 v[140:143], a[168:171], v[80:83], v[140:143]
v_exp_f32 v107, v107
v_mfma_f32_16x16x32_bf16 v[140:143], a[172:175], v[84:87], v[140:143]
v_cvt_pk_bf16_f32 v152, v88, v89
v_cvt_pk_bf16_f32 v153, v90, v91
v_mfma_f32_16x16x32_bf16 v[124:127], a[172:175], v[68:71], v[224:227]
v_exp_f32 v120, v120
v_mfma_f32_16x16x32_bf16 v[124:127], a[168:171], v[64:67], v[124:127]
v_exp_f32 v121, v121
v_mfma_f32_16x16x32_bf16 v[124:127], a[164:167], v[60:63], v[124:127]
v_exp_f32 v122, v122
v_mfma_f32_16x16x32_bf16 v[124:127], a[160:163], v[56:59], v[124:127]
v_exp_f32 v123, v123
v_mfma_f32_16x16x32_bf16 v[108:111], a[160:163], v[40:43], v[220:223]
v_exp_f32 v136, v136
v_mfma_f32_16x16x32_bf16 v[108:111], a[164:167], v[44:47], v[108:111]
v_exp_f32 v137, v137
v_mfma_f32_16x16x32_bf16 v[108:111], a[168:171], v[48:51], v[108:111]
v_exp_f32 v138, v138
v_mfma_f32_16x16x32_bf16 v[108:111], a[172:175], v[52:55], v[108:111]
v_cvt_pk_bf16_f32 v160, v104, v105
v_cvt_pk_bf16_f32 v161, v106, v107
v_mfma_f32_16x16x32_bf16 v[92:95], a[172:175], v[36:39], v[216:219]
v_exp_f32 v139, v139
v_mfma_f32_16x16x32_bf16 v[92:95], a[168:171], v[32:35], v[92:95]
ds_read_b128 a[192:195], v2 offset:12288
v_cvt_pk_bf16_f32 v184, v120, v121
v_mfma_f32_16x16x32_bf16 v[92:95], a[164:167], v[28:31], v[92:95]
v_exp_f32 v140, v140
v_mfma_f32_16x16x32_bf16 v[92:95], a[160:163], v[24:27], v[92:95]
s_add_u32 m0, s71, 4096
ds_read_b128 a[196:199], v2 offset:13312
v_cvt_pk_bf16_f32 v185, v122, v123
v_mfma_f32_16x16x32_bf16 v[96:99], a[176:179], v[24:27], v[216:219]
s_add_u32 s64, s70, 4096
ds_read_b128 a[200:203], v2 offset:14336
v_cvt_pk_bf16_f32 v192, v136, v137
v_mfma_f32_16x16x32_bf16 v[96:99], a[180:183], v[28:31], v[96:99]
buffer_load_dwordx4 v16, s[32:35], s64 offen offset:0 sc1 lds
v_mfma_f32_16x16x32_bf16 v[96:99], a[184:187], v[32:35], v[96:99]
v_exp_f32 v141, v141
v_mfma_f32_16x16x32_bf16 v[96:99], a[188:191], v[36:39], v[96:99]
ds_read_b128 a[204:207], v2 offset:15360
v_cvt_pk_bf16_f32 v193, v138, v139
v_mfma_f32_16x16x32_bf16 v[112:115], a[188:191], v[52:55], v[220:223]
v_exp_f32 v142, v142
v_mfma_f32_16x16x32_bf16 v[112:115], a[184:187], v[48:51], v[112:115]
v_exp_f32 v143, v143
v_mfma_f32_16x16x32_bf16 v[112:115], a[180:183], v[44:47], v[112:115]
v_exp_f32 v124, v124
v_mfma_f32_16x16x32_bf16 v[112:115], a[176:179], v[40:43], v[112:115]
v_exp_f32 v125, v125
v_mfma_f32_16x16x32_bf16 v[128:131], a[176:179], v[56:59], v[224:227]
v_exp_f32 v126, v126
v_mfma_f32_16x16x32_bf16 v[128:131], a[180:183], v[60:63], v[128:131]
v_exp_f32 v127, v127
v_mfma_f32_16x16x32_bf16 v[128:131], a[184:187], v[64:67], v[128:131]
v_exp_f32 v108, v108
v_mfma_f32_16x16x32_bf16 v[128:131], a[188:191], v[68:71], v[128:131]
v_exp_f32 v109, v109
v_mfma_f32_16x16x32_bf16 v[144:147], a[188:191], v[84:87], v[228:231]
v_exp_f32 v110, v110
v_mfma_f32_16x16x32_bf16 v[144:147], a[184:187], v[80:83], v[144:147]
ds_read_b128 a[144:147], v3 offset:0
v_cvt_pk_bf16_f32 v194, v140, v141
v_mfma_f32_16x16x32_bf16 v[144:147], a[180:183], v[76:79], v[144:147]
ds_read_b128 a[148:151], v3 offset:8192
v_cvt_pk_bf16_f32 v195, v142, v143
v_mfma_f32_16x16x32_bf16 v[144:147], a[176:179], v[72:75], v[144:147]
s_waitcnt lgkmcnt(2)
v_exp_f32 v111, v111
v_mfma_f32_16x16x32_bf16 v[148:151], a[192:195], v[72:75], v[228:231]
buffer_load_dwordx4 v16, s[32:35], s64 offen offset:1024 sc1 lds
v_mfma_f32_16x16x32_bf16 v[148:151], a[196:199], v[76:79], v[148:151]
v_exp_f32 v92, v92
v_mfma_f32_16x16x32_bf16 v[148:151], a[200:203], v[80:83], v[148:151]
v_exp_f32 v93, v93
v_mfma_f32_16x16x32_bf16 v[148:151], a[204:207], v[84:87], v[148:151]
v_exp_f32 v94, v94
v_mfma_f32_16x16x32_bf16 v[132:135], a[204:207], v[68:71], v[224:227]
ds_read_b128 a[152:155], v3 offset:1024
v_cvt_pk_bf16_f32 v186, v124, v125
v_mfma_f32_16x16x32_bf16 v[132:135], a[200:203], v[64:67], v[132:135]
ds_read_b128 a[156:159], v3 offset:9216
v_cvt_pk_bf16_f32 v187, v126, v127
v_mfma_f32_16x16x32_bf16 v[132:135], a[196:199], v[60:63], v[132:135]
v_exp_f32 v95, v95
v_mfma_f32_16x16x32_bf16 v[132:135], a[192:195], v[56:59], v[132:135]
v_exp_f32 v96, v96
v_mfma_f32_16x16x32_bf16 v[116:119], a[192:195], v[40:43], v[220:223]
v_exp_f32 v97, v97
v_mfma_f32_16x16x32_bf16 v[116:119], a[196:199], v[44:47], v[116:119]
v_exp_f32 v98, v98
v_mfma_f32_16x16x32_bf16 v[116:119], a[200:203], v[48:51], v[116:119]
ds_read_b128 a[160:163], v3 offset:2048
v_cvt_pk_bf16_f32 v162, v108, v109
v_mfma_f32_16x16x32_bf16 v[116:119], a[204:207], v[52:55], v[116:119]
v_exp_f32 v99, v99
v_mfma_f32_16x16x32_bf16 v[100:103], a[204:207], v[36:39], v[216:219]
ds_read_b128 a[164:167], v3 offset:10240
v_cvt_pk_bf16_f32 v163, v110, v111
v_mfma_f32_16x16x32_bf16 v[100:103], a[200:203], v[32:35], v[100:103]
v_exp_f32 v112, v112
v_mfma_f32_16x16x32_bf16 v[100:103], a[196:199], v[28:31], v[100:103]
v_exp_f32 v113, v113
v_mfma_f32_16x16x32_bf16 v[100:103], a[192:195], v[24:27], v[100:103]
v_exp_f32 v114, v114
v_smfmac_f32_16x16x64_bf16 a[128:131], a[240:243], v[168:175], v5
ds_read_b128 a[168:171], v3 offset:3072
v_smfmac_f32_16x16x64_bf16 a[132:135], a[240:243], v[176:183], v5
ds_read_b128 a[172:175], v3 offset:11264
v_smfmac_f32_16x16x64_bf16 a[136:139], a[240:243], v[200:207], v5
ds_read_b128 a[176:179], v3 offset:4096
v_smfmac_f32_16x16x64_bf16 a[140:143], a[240:243], v[208:215], v5
s_waitcnt lgkmcnt(3)
buffer_load_dwordx4 v16, s[32:35], s64 offen offset:2048 sc1 lds
v_mfma_f32_16x16x32_bf16 a[0:3], a[144:147], v[168:171], a[0:3]
v_exp_f32 v115, v115
v_mfma_f32_16x16x32_bf16 a[0:3], a[148:151], v[172:175], a[0:3]
v_exp_f32 v128, v128
v_mfma_f32_16x16x32_bf16 a[32:35], a[148:151], v[180:183], a[32:35]
v_exp_f32 v129, v129
v_mfma_f32_16x16x32_bf16 a[32:35], a[144:147], v[176:179], a[32:35]
v_exp_f32 v130, v130
v_mfma_f32_16x16x32_bf16 a[64:67], a[144:147], v[200:203], a[64:67]
v_exp_f32 v131, v131
v_mfma_f32_16x16x32_bf16 a[64:67], a[148:151], v[204:207], a[64:67]
v_cvt_pk_bf16_f32 v154, v92, v93
v_cvt_pk_bf16_f32 v155, v94, v95
v_mfma_f32_16x16x32_bf16 a[96:99], a[148:151], v[212:215], a[96:99]
v_exp_f32 v144, v144
v_mfma_f32_16x16x32_bf16 a[96:99], a[144:147], v[208:211], a[96:99]
ds_read_b128 a[180:183], v3 offset:12288
v_cvt_pk_bf16_f32 v156, v96, v97
v_mfma_f32_16x16x32_bf16 a[100:103], a[152:155], v[208:211], a[100:103]
v_exp_f32 v145, v145
v_mfma_f32_16x16x32_bf16 a[100:103], a[156:159], v[212:215], a[100:103]
ds_read_b128 a[184:187], v3 offset:5120
v_cvt_pk_bf16_f32 v157, v98, v99
v_mfma_f32_16x16x32_bf16 a[68:71], a[156:159], v[204:207], a[68:71]
ds_read_b128 a[188:191], v3 offset:13312
v_cvt_pk_bf16_f32 v164, v112, v113
v_mfma_f32_16x16x32_bf16 a[68:71], a[152:155], v[200:203], a[68:71]
buffer_load_dwordx4 v16, s[32:35], s64 offen offset:3072 sc1 lds
v_mfma_f32_16x16x32_bf16 a[36:39], a[152:155], v[176:179], a[36:39]
ds_read_b128 a[192:195], v3 offset:6144
v_cvt_pk_bf16_f32 v165, v114, v115
v_mfma_f32_16x16x32_bf16 a[36:39], a[156:159], v[180:183], a[36:39]
ds_read_b128 a[196:199], v3 offset:14336
v_cvt_pk_bf16_f32 v188, v128, v129
v_mfma_f32_16x16x32_bf16 a[4:7], a[156:159], v[172:175], a[4:7]
ds_read_b128 a[200:203], v3 offset:7168
v_cvt_pk_bf16_f32 v189, v130, v131
v_mfma_f32_16x16x32_bf16 a[4:7], a[152:155], v[168:171], a[4:7]
v_exp_f32 v146, v146
v_mfma_f32_16x16x32_bf16 a[8:11], a[160:163], v[168:171], a[8:11]
v_exp_f32 v147, v147
v_mfma_f32_16x16x32_bf16 a[8:11], a[164:167], v[172:175], a[8:11]
v_exp_f32 v148, v148
v_mfma_f32_16x16x32_bf16 a[40:43], a[164:167], v[180:183], a[40:43]
ds_read_b128 a[204:207], v3 offset:15360
v_cvt_pk_bf16_f32 v196, v144, v145
v_mfma_f32_16x16x32_bf16 a[40:43], a[160:163], v[176:179], a[40:43]
v_exp_f32 v149, v149
v_mfma_f32_16x16x32_bf16 a[72:75], a[160:163], v[200:203], a[72:75]
v_exp_f32 v150, v150
v_mfma_f32_16x16x32_bf16 a[72:75], a[164:167], v[204:207], a[72:75]
v_exp_f32 v151, v151
v_mfma_f32_16x16x32_bf16 a[104:107], a[164:167], v[212:215], a[104:107]
v_exp_f32 v132, v132
v_mfma_f32_16x16x32_bf16 a[104:107], a[160:163], v[208:211], a[104:107]
s_waitcnt lgkmcnt(1)
v_exp_f32 v133, v133
v_mfma_f32_16x16x32_bf16 a[108:111], a[168:171], v[208:211], a[108:111]
v_exp_f32 v134, v134
v_mfma_f32_16x16x32_bf16 a[108:111], a[172:175], v[212:215], a[108:111]
v_exp_f32 v135, v135
v_mfma_f32_16x16x32_bf16 a[76:79], a[172:175], v[204:207], a[76:79]
v_exp_f32 v116, v116
v_mfma_f32_16x16x32_bf16 a[76:79], a[168:171], v[200:203], a[76:79]
v_exp_f32 v117, v117
v_mfma_f32_16x16x32_bf16 a[44:47], a[168:171], v[176:179], a[44:47]
v_exp_f32 v118, v118
v_mfma_f32_16x16x32_bf16 a[44:47], a[172:175], v[180:183], a[44:47]
s_waitcnt vmcnt(9)
s_barrier
v_mfma_f32_16x16x32_bf16 a[12:15], a[172:175], v[172:175], a[12:15]
s_xor_b32 s71, s71, 16384
v_exp_f32 v119, v119
v_mfma_f32_16x16x32_bf16 a[12:15], a[168:171], v[168:171], a[12:15]
s_add_u32 s70, s70, 32768
v_exp_f32 v100, v100
v_mfma_f32_16x16x32_bf16 a[16:19], a[176:179], v[168:171], a[16:19]
s_mov_b32 m0, s71
v_exp_f32 v101, v101
v_mfma_f32_16x16x32_bf16 a[16:19], a[180:183], v[172:175], a[16:19]
buffer_load_dwordx4 v16, s[32:35], s70 offen offset:0 sc1 lds
v_mfma_f32_16x16x32_bf16 a[48:51], a[180:183], v[180:183], a[48:51]
ds_read_b128 a[144:147], v2 offset:16384
v_cvt_pk_bf16_f32 v197, v146, v147
v_mfma_f32_16x16x32_bf16 a[48:51], a[176:179], v[176:179], a[48:51]
ds_read_b128 a[148:151], v2 offset:17408
v_cvt_pk_bf16_f32 v198, v148, v149
v_mfma_f32_16x16x32_bf16 a[80:83], a[176:179], v[200:203], a[80:83]
v_exp_f32 v102, v102
v_mfma_f32_16x16x32_bf16 a[80:83], a[180:183], v[204:207], a[80:83]
ds_read_b128 a[152:155], v2 offset:18432
v_cvt_pk_bf16_f32 v199, v150, v151
v_mfma_f32_16x16x32_bf16 a[112:115], a[180:183], v[212:215], a[112:115]
ds_read_b128 a[156:159], v2 offset:19456
v_cvt_pk_bf16_f32 v190, v132, v133
v_mfma_f32_16x16x32_bf16 a[112:115], a[176:179], v[208:211], a[112:115]
v_exp_f32 v103, v103
v_mfma_f32_16x16x32_bf16 a[116:119], a[184:187], v[208:211], a[116:119]
ds_read_b128 a[160:163], v2 offset:20480
v_cvt_pk_bf16_f32 v191, v134, v135
v_mfma_f32_16x16x32_bf16 a[116:119], a[188:191], v[212:215], a[116:119]
ds_read_b128 a[164:167], v2 offset:21504
v_cvt_pk_bf16_f32 v166, v116, v117
v_mfma_f32_16x16x32_bf16 a[84:87], a[188:191], v[204:207], a[84:87]
ds_read_b128 a[168:171], v2 offset:22528
v_cvt_pk_bf16_f32 v167, v118, v119
v_mfma_f32_16x16x32_bf16 a[84:87], a[184:187], v[200:203], a[84:87]
ds_read_b128 a[172:175], v2 offset:23552
v_cvt_pk_bf16_f32 v158, v100, v101
v_mfma_f32_16x16x32_bf16 a[52:55], a[184:187], v[176:179], a[52:55]
v_cvt_pk_bf16_f32 v159, v102, v103
v_mfma_f32_16x16x32_bf16 a[52:55], a[188:191], v[180:183], a[52:55]
v_mfma_f32_16x16x32_bf16 a[20:23], a[188:191], v[172:175], a[20:23]
v_mfma_f32_16x16x32_bf16 a[20:23], a[184:187], v[168:171], a[20:23]
v_mfma_f32_16x16x32_bf16 a[24:27], a[192:195], v[168:171], a[24:27]
buffer_load_dwordx4 v16, s[32:35], s70 offen offset:1024 sc1 lds
v_mfma_f32_16x16x32_bf16 a[24:27], a[196:199], v[172:175], a[24:27]
v_mfma_f32_16x16x32_bf16 a[56:59], a[196:199], v[180:183], a[56:59]
v_mfma_f32_16x16x32_bf16 a[56:59], a[192:195], v[176:179], a[56:59]
v_mfma_f32_16x16x32_bf16 a[88:91], a[192:195], v[200:203], a[88:91]
v_mfma_f32_16x16x32_bf16 a[88:91], a[196:199], v[204:207], a[88:91]
v_mfma_f32_16x16x32_bf16 a[120:123], a[196:199], v[212:215], a[120:123]
v_mfma_f32_16x16x32_bf16 a[120:123], a[192:195], v[208:211], a[120:123]
v_mfma_f32_16x16x32_bf16 a[124:127], a[200:203], v[208:211], a[124:127]
s_waitcnt lgkmcnt(0)
v_mfma_f32_16x16x32_bf16 a[124:127], a[204:207], v[212:215], a[124:127]
v_mfma_f32_16x16x32_bf16 a[92:95], a[204:207], v[204:207], a[92:95]
v_mfma_f32_16x16x32_bf16 a[92:95], a[200:203], v[200:203], a[92:95]
v_mfma_f32_16x16x32_bf16 a[60:63], a[200:203], v[176:179], a[60:63]
v_mfma_f32_16x16x32_bf16 a[60:63], a[204:207], v[180:183], a[60:63]
v_mfma_f32_16x16x32_bf16 a[28:31], a[204:207], v[172:175], a[28:31]
v_mfma_f32_16x16x32_bf16 a[28:31], a[200:203], v[168:171], a[28:31]
v_mfma_f32_16x16x32_bf16 v[88:91], a[144:147], v[24:27], v[216:219]
ds_read_b128 a[176:179], v2 offset:24576
v_mfma_f32_16x16x32_bf16 v[88:91], a[148:151], v[28:31], v[88:91]
ds_read_b128 a[180:183], v2 offset:25600
v_mfma_f32_16x16x32_bf16 v[88:91], a[152:155], v[32:35], v[88:91]
buffer_load_dwordx4 v16, s[32:35], s70 offen offset:2048 sc1 lds
v_mfma_f32_16x16x32_bf16 v[88:91], a[156:159], v[36:39], v[88:91]
ds_read_b128 a[184:187], v2 offset:26624
v_mfma_f32_16x16x32_bf16 v[104:107], a[156:159], v[52:55], v[220:223]
v_mfma_f32_16x16x32_bf16 v[104:107], a[152:155], v[48:51], v[104:107]
v_mfma_f32_16x16x32_bf16 v[104:107], a[148:151], v[44:47], v[104:107]
ds_read_b128 a[188:191], v2 offset:27648
v_mfma_f32_16x16x32_bf16 v[104:107], a[144:147], v[40:43], v[104:107]
v_mfma_f32_16x16x32_bf16 v[120:123], a[144:147], v[56:59], v[224:227]
v_mfma_f32_16x16x32_bf16 v[120:123], a[148:151], v[60:63], v[120:123]
v_mfma_f32_16x16x32_bf16 v[120:123], a[152:155], v[64:67], v[120:123]
v_exp_f32 v88, v88
v_mfma_f32_16x16x32_bf16 v[120:123], a[156:159], v[68:71], v[120:123]
v_exp_f32 v89, v89
v_mfma_f32_16x16x32_bf16 v[136:139], a[156:159], v[84:87], v[228:231]
v_exp_f32 v90, v90
v_mfma_f32_16x16x32_bf16 v[136:139], a[152:155], v[80:83], v[136:139]
v_exp_f32 v91, v91
v_mfma_f32_16x16x32_bf16 v[136:139], a[148:151], v[76:79], v[136:139]
v_exp_f32 v104, v104
v_mfma_f32_16x16x32_bf16 v[136:139], a[144:147], v[72:75], v[136:139]
v_exp_f32 v105, v105
v_mfma_f32_16x16x32_bf16 v[140:143], a[160:163], v[72:75], v[228:231]
v_exp_f32 v106, v106
v_mfma_f32_16x16x32_bf16 v[140:143], a[164:167], v[76:79], v[140:143]
buffer_load_dwordx4 v16, s[32:35], s70 offen offset:3072 sc1 lds
v_mfma_f32_16x16x32_bf16 v[140:143], a[168:171], v[80:83], v[140:143]
v_exp_f32 v107, v107
v_mfma_f32_16x16x32_bf16 v[140:143], a[172:175], v[84:87], v[140:143]
v_cvt_pk_bf16_f32 v168, v88, v89
v_cvt_pk_bf16_f32 v169, v90, v91
v_mfma_f32_16x16x32_bf16 v[124:127], a[172:175], v[68:71], v[224:227]
v_exp_f32 v120, v120
v_mfma_f32_16x16x32_bf16 v[124:127], a[168:171], v[64:67], v[124:127]
v_exp_f32 v121, v121
v_mfma_f32_16x16x32_bf16 v[124:127], a[164:167], v[60:63], v[124:127]
v_exp_f32 v122, v122
v_mfma_f32_16x16x32_bf16 v[124:127], a[160:163], v[56:59], v[124:127]
v_exp_f32 v123, v123
v_mfma_f32_16x16x32_bf16 v[108:111], a[160:163], v[40:43], v[220:223]
v_exp_f32 v136, v136
v_mfma_f32_16x16x32_bf16 v[108:111], a[164:167], v[44:47], v[108:111]
v_exp_f32 v137, v137
v_mfma_f32_16x16x32_bf16 v[108:111], a[168:171], v[48:51], v[108:111]
v_exp_f32 v138, v138
v_mfma_f32_16x16x32_bf16 v[108:111], a[172:175], v[52:55], v[108:111]
v_cvt_pk_bf16_f32 v176, v104, v105
v_cvt_pk_bf16_f32 v177, v106, v107
v_mfma_f32_16x16x32_bf16 v[92:95], a[172:175], v[36:39], v[216:219]
v_exp_f32 v139, v139
v_mfma_f32_16x16x32_bf16 v[92:95], a[168:171], v[32:35], v[92:95]
ds_read_b128 a[192:195], v2 offset:28672
v_cvt_pk_bf16_f32 v200, v120, v121
v_mfma_f32_16x16x32_bf16 v[92:95], a[164:167], v[28:31], v[92:95]
v_exp_f32 v140, v140
v_mfma_f32_16x16x32_bf16 v[92:95], a[160:163], v[24:27], v[92:95]
s_waitcnt lgkmcnt(1)
s_add_u32 m0, s71, 4096
ds_read_b128 a[196:199], v2 offset:29696
v_cvt_pk_bf16_f32 v201, v122, v123
v_mfma_f32_16x16x32_bf16 v[96:99], a[176:179], v[24:27], v[216:219]
s_add_u32 s64, s70, 4096
ds_read_b128 a[200:203], v2 offset:30720
v_cvt_pk_bf16_f32 v208, v136, v137
v_mfma_f32_16x16x32_bf16 v[96:99], a[180:183], v[28:31], v[96:99]
buffer_load_dwordx4 v16, s[32:35], s64 offen offset:0 sc1 lds
v_mfma_f32_16x16x32_bf16 v[96:99], a[184:187], v[32:35], v[96:99]
v_exp_f32 v141, v141
v_mfma_f32_16x16x32_bf16 v[96:99], a[188:191], v[36:39], v[96:99]
ds_read_b128 a[204:207], v2 offset:31744
v_cvt_pk_bf16_f32 v209, v138, v139
v_mfma_f32_16x16x32_bf16 v[112:115], a[188:191], v[52:55], v[220:223]
v_exp_f32 v142, v142
v_mfma_f32_16x16x32_bf16 v[112:115], a[184:187], v[48:51], v[112:115]
v_exp_f32 v143, v143
v_mfma_f32_16x16x32_bf16 v[112:115], a[180:183], v[44:47], v[112:115]
v_exp_f32 v124, v124
v_mfma_f32_16x16x32_bf16 v[112:115], a[176:179], v[40:43], v[112:115]
v_exp_f32 v125, v125
v_mfma_f32_16x16x32_bf16 v[128:131], a[176:179], v[56:59], v[224:227]
v_exp_f32 v126, v126
v_mfma_f32_16x16x32_bf16 v[128:131], a[180:183], v[60:63], v[128:131]
v_exp_f32 v127, v127
v_mfma_f32_16x16x32_bf16 v[128:131], a[184:187], v[64:67], v[128:131]
v_exp_f32 v108, v108
v_mfma_f32_16x16x32_bf16 v[128:131], a[188:191], v[68:71], v[128:131]
v_exp_f32 v109, v109
v_mfma_f32_16x16x32_bf16 v[144:147], a[188:191], v[84:87], v[228:231]
v_exp_f32 v110, v110
v_mfma_f32_16x16x32_bf16 v[144:147], a[184:187], v[80:83], v[144:147]
ds_read_b128 a[144:147], v3 offset:16384
v_cvt_pk_bf16_f32 v210, v140, v141
v_mfma_f32_16x16x32_bf16 v[144:147], a[180:183], v[76:79], v[144:147]
ds_read_b128 a[148:151], v3 offset:24576
v_cvt_pk_bf16_f32 v211, v142, v143
v_mfma_f32_16x16x32_bf16 v[144:147], a[176:179], v[72:75], v[144:147]
s_waitcnt lgkmcnt(2)
v_exp_f32 v111, v111
v_mfma_f32_16x16x32_bf16 v[148:151], a[192:195], v[72:75], v[228:231]
buffer_load_dwordx4 v16, s[32:35], s64 offen offset:1024 sc1 lds
v_mfma_f32_16x16x32_bf16 v[148:151], a[196:199], v[76:79], v[148:151]
v_exp_f32 v92, v92
v_mfma_f32_16x16x32_bf16 v[148:151], a[200:203], v[80:83], v[148:151]
v_exp_f32 v93, v93
v_mfma_f32_16x16x32_bf16 v[148:151], a[204:207], v[84:87], v[148:151]
v_exp_f32 v94, v94
v_mfma_f32_16x16x32_bf16 v[132:135], a[204:207], v[68:71], v[224:227]
ds_read_b128 a[152:155], v3 offset:17408
v_cvt_pk_bf16_f32 v202, v124, v125
v_mfma_f32_16x16x32_bf16 v[132:135], a[200:203], v[64:67], v[132:135]
ds_read_b128 a[156:159], v3 offset:25600
v_cvt_pk_bf16_f32 v203, v126, v127
v_mfma_f32_16x16x32_bf16 v[132:135], a[196:199], v[60:63], v[132:135]
v_exp_f32 v95, v95
v_mfma_f32_16x16x32_bf16 v[132:135], a[192:195], v[56:59], v[132:135]
v_exp_f32 v96, v96
v_mfma_f32_16x16x32_bf16 v[116:119], a[192:195], v[40:43], v[220:223]
v_exp_f32 v97, v97
v_mfma_f32_16x16x32_bf16 v[116:119], a[196:199], v[44:47], v[116:119]
v_exp_f32 v98, v98
v_mfma_f32_16x16x32_bf16 v[116:119], a[200:203], v[48:51], v[116:119]
ds_read_b128 a[160:163], v3 offset:18432
v_cvt_pk_bf16_f32 v178, v108, v109
v_mfma_f32_16x16x32_bf16 v[116:119], a[204:207], v[52:55], v[116:119]
v_exp_f32 v99, v99
v_mfma_f32_16x16x32_bf16 v[100:103], a[204:207], v[36:39], v[216:219]
ds_read_b128 a[164:167], v3 offset:26624
v_cvt_pk_bf16_f32 v179, v110, v111
v_mfma_f32_16x16x32_bf16 v[100:103], a[200:203], v[32:35], v[100:103]
v_exp_f32 v112, v112
v_mfma_f32_16x16x32_bf16 v[100:103], a[196:199], v[28:31], v[100:103]
v_exp_f32 v113, v113
v_mfma_f32_16x16x32_bf16 v[100:103], a[192:195], v[24:27], v[100:103]
v_exp_f32 v114, v114
v_smfmac_f32_16x16x64_bf16 a[128:131], a[240:243], v[152:159], v5
ds_read_b128 a[168:171], v3 offset:19456
v_smfmac_f32_16x16x64_bf16 a[132:135], a[240:243], v[160:167], v5
ds_read_b128 a[172:175], v3 offset:27648
v_smfmac_f32_16x16x64_bf16 a[136:139], a[240:243], v[184:191], v5
ds_read_b128 a[176:179], v3 offset:20480
v_smfmac_f32_16x16x64_bf16 a[140:143], a[240:243], v[192:199], v5
s_waitcnt lgkmcnt(3)
buffer_load_dwordx4 v16, s[32:35], s64 offen offset:2048 sc1 lds
v_mfma_f32_16x16x32_bf16 a[0:3], a[144:147], v[152:155], a[0:3]
v_exp_f32 v115, v115
v_mfma_f32_16x16x32_bf16 a[0:3], a[148:151], v[156:159], a[0:3]
v_exp_f32 v128, v128
v_mfma_f32_16x16x32_bf16 a[32:35], a[148:151], v[164:167], a[32:35]
v_exp_f32 v129, v129
v_mfma_f32_16x16x32_bf16 a[32:35], a[144:147], v[160:163], a[32:35]
v_exp_f32 v130, v130
v_mfma_f32_16x16x32_bf16 a[64:67], a[144:147], v[184:187], a[64:67]
v_exp_f32 v131, v131
v_mfma_f32_16x16x32_bf16 a[64:67], a[148:151], v[188:191], a[64:67]
v_cvt_pk_bf16_f32 v170, v92, v93
v_cvt_pk_bf16_f32 v171, v94, v95
v_mfma_f32_16x16x32_bf16 a[96:99], a[148:151], v[196:199], a[96:99]
v_exp_f32 v144, v144
v_mfma_f32_16x16x32_bf16 a[96:99], a[144:147], v[192:195], a[96:99]
ds_read_b128 a[180:183], v3 offset:28672
v_cvt_pk_bf16_f32 v172, v96, v97
v_mfma_f32_16x16x32_bf16 a[100:103], a[152:155], v[192:195], a[100:103]
v_exp_f32 v145, v145
v_mfma_f32_16x16x32_bf16 a[100:103], a[156:159], v[196:199], a[100:103]
ds_read_b128 a[184:187], v3 offset:21504
v_xor_b32 v2, 0x8000, v2
v_mfma_f32_16x16x32_bf16 a[68:71], a[156:159], v[188:191], a[68:71]
ds_read_b128 a[188:191], v3 offset:29696
v_cvt_pk_bf16_f32 v173, v98, v99
v_mfma_f32_16x16x32_bf16 a[68:71], a[152:155], v[184:187], a[68:71]
buffer_load_dwordx4 v16, s[32:35], s64 offen offset:3072 sc1 lds
v_mfma_f32_16x16x32_bf16 a[36:39], a[152:155], v[160:163], a[36:39]
ds_read_b128 a[192:195], v3 offset:22528
v_cvt_pk_bf16_f32 v180, v112, v113
v_mfma_f32_16x16x32_bf16 a[36:39], a[156:159], v[164:167], a[36:39]
ds_read_b128 a[196:199], v3 offset:30720
v_cvt_pk_bf16_f32 v181, v114, v115
v_mfma_f32_16x16x32_bf16 a[4:7], a[156:159], v[156:159], a[4:7]
ds_read_b128 a[200:203], v3 offset:23552
v_cvt_pk_bf16_f32 v204, v128, v129
v_mfma_f32_16x16x32_bf16 a[4:7], a[152:155], v[152:155], a[4:7]
v_exp_f32 v146, v146
v_mfma_f32_16x16x32_bf16 a[8:11], a[160:163], v[152:155], a[8:11]
v_exp_f32 v147, v147
v_mfma_f32_16x16x32_bf16 a[8:11], a[164:167], v[156:159], a[8:11]
v_exp_f32 v148, v148
v_mfma_f32_16x16x32_bf16 a[40:43], a[164:167], v[164:167], a[40:43]
ds_read_b128 a[204:207], v3 offset:31744
v_cvt_pk_bf16_f32 v205, v130, v131
v_mfma_f32_16x16x32_bf16 a[40:43], a[160:163], v[160:163], a[40:43]
v_exp_f32 v149, v149
v_mfma_f32_16x16x32_bf16 a[72:75], a[160:163], v[184:187], a[72:75]
v_exp_f32 v150, v150
v_mfma_f32_16x16x32_bf16 a[72:75], a[164:167], v[188:191], a[72:75]
v_exp_f32 v151, v151
v_mfma_f32_16x16x32_bf16 a[104:107], a[164:167], v[196:199], a[104:107]
v_exp_f32 v132, v132
v_mfma_f32_16x16x32_bf16 a[104:107], a[160:163], v[192:195], a[104:107]
s_waitcnt lgkmcnt(1)
v_exp_f32 v133, v133
v_mfma_f32_16x16x32_bf16 a[108:111], a[168:171], v[192:195], a[108:111]
v_exp_f32 v134, v134
v_mfma_f32_16x16x32_bf16 a[108:111], a[172:175], v[196:199], a[108:111]
v_exp_f32 v135, v135
v_mfma_f32_16x16x32_bf16 a[76:79], a[172:175], v[188:191], a[76:79]
v_exp_f32 v116, v116
v_mfma_f32_16x16x32_bf16 a[76:79], a[168:171], v[184:187], a[76:79]
v_exp_f32 v117, v117
v_mfma_f32_16x16x32_bf16 a[44:47], a[168:171], v[160:163], a[44:47]
v_exp_f32 v118, v118
v_mfma_f32_16x16x32_bf16 a[44:47], a[172:175], v[164:167], a[44:47]
s_waitcnt vmcnt(8)
s_barrier
v_mfma_f32_16x16x32_bf16 a[12:15], a[172:175], v[156:159], a[12:15]
s_xor_b32 s71, s71, 49152
v_exp_f32 v119, v119
v_mfma_f32_16x16x32_bf16 a[12:15], a[168:171], v[152:155], a[12:15]
s_add_u32 s70, s70, 32768
v_exp_f32 v100, v100
v_mfma_f32_16x16x32_bf16 a[16:19], a[176:179], v[152:155], a[16:19]
s_mov_b32 m0, s71
v_exp_f32 v101, v101
v_mfma_f32_16x16x32_bf16 a[16:19], a[180:183], v[156:159], a[16:19]
s_add_u32 s17, s78, L_DD-L_pc
buffer_load_dwordx4 v16, s[32:35], s70 offen offset:0 sc1 lds
v_mfma_f32_16x16x32_bf16 a[48:51], a[180:183], v[164:167], a[48:51]
buffer_load_dword a252, v16, s[88:91], s17 offen
v_mfma_f32_16x16x32_bf16 a[48:51], a[176:179], v[160:163], a[48:51]
v_cvt_pk_bf16_f32 v212, v144, v145
v_cvt_pk_bf16_f32 v213, v146, v147
v_mfma_f32_16x16x32_bf16 a[80:83], a[176:179], v[184:187], a[80:83]
s_add_u32 s17, s78, L_DD-L_pc+4096
ds_read_b128 a[144:147], v2 offset:0
v_cvt_pk_bf16_f32 v214, v148, v149
v_mfma_f32_16x16x32_bf16 a[80:83], a[180:183], v[188:191], a[80:83]
buffer_load_dword a252, v16, s[88:91], s17 offen
v_mfma_f32_16x16x32_bf16 a[112:115], a[180:183], v[196:199], a[112:115]
ds_read_b128 a[148:151], v2 offset:1024
v_cvt_pk_bf16_f32 v215, v150, v151
v_mfma_f32_16x16x32_bf16 a[112:115], a[176:179], v[192:195], a[112:115]
v_exp_f32 v102, v102
v_mfma_f32_16x16x32_bf16 a[116:119], a[184:187], v[192:195], a[116:119]
ds_read_b128 a[152:155], v2 offset:2048
v_cvt_pk_bf16_f32 v206, v132, v133
v_mfma_f32_16x16x32_bf16 a[116:119], a[188:191], v[196:199], a[116:119]
ds_read_b128 a[156:159], v2 offset:3072
v_cvt_pk_bf16_f32 v207, v134, v135
v_mfma_f32_16x16x32_bf16 a[84:87], a[188:191], v[188:191], a[84:87]
v_exp_f32 v103, v103
v_mfma_f32_16x16x32_bf16 a[84:87], a[184:187], v[184:187], a[84:87]
ds_read_b128 a[160:163], v2 offset:4096
v_cvt_pk_bf16_f32 v182, v116, v117
v_mfma_f32_16x16x32_bf16 a[52:55], a[184:187], v[160:163], a[52:55]
ds_read_b128 a[164:167], v2 offset:5120
v_cvt_pk_bf16_f32 v183, v118, v119
v_mfma_f32_16x16x32_bf16 a[52:55], a[188:191], v[164:167], a[52:55]
ds_read_b128 a[168:171], v2 offset:6144
v_xor_b32 v3, 0x8000, v3
v_mfma_f32_16x16x32_bf16 a[20:23], a[188:191], v[156:159], a[20:23]
ds_read_b128 a[172:175], v2 offset:7168
v_cvt_pk_bf16_f32 v174, v100, v101
v_mfma_f32_16x16x32_bf16 a[20:23], a[184:187], v[152:155], a[20:23]
v_cvt_pk_bf16_f32 v175, v102, v103
v_mfma_f32_16x16x32_bf16 a[24:27], a[192:195], v[152:155], a[24:27]
buffer_load_dwordx4 v16, s[32:35], s70 offen offset:1024 sc1 lds
v_mfma_f32_16x16x32_bf16 a[24:27], a[196:199], v[156:159], a[24:27]
v_mfma_f32_16x16x32_bf16 a[56:59], a[196:199], v[164:167], a[56:59]
v_mfma_f32_16x16x32_bf16 a[56:59], a[192:195], v[160:163], a[56:59]
v_mfma_f32_16x16x32_bf16 a[88:91], a[192:195], v[184:187], a[88:91]
v_mfma_f32_16x16x32_bf16 a[88:91], a[196:199], v[188:191], a[88:91]
v_mfma_f32_16x16x32_bf16 a[120:123], a[196:199], v[196:199], a[120:123]
s_sub_u32 s72, s72, 1
v_mfma_f32_16x16x32_bf16 a[120:123], a[192:195], v[192:195], a[120:123]
v_mfma_f32_16x16x32_bf16 a[124:127], a[200:203], v[192:195], a[124:127]
s_waitcnt lgkmcnt(0)
v_mfma_f32_16x16x32_bf16 a[124:127], a[204:207], v[196:199], a[124:127]
v_mfma_f32_16x16x32_bf16 a[92:95], a[204:207], v[188:191], a[92:95]
s_cmp_lg_u32 s72, 0
v_mfma_f32_16x16x32_bf16 a[92:95], a[200:203], v[184:187], a[92:95]
v_mfma_f32_16x16x32_bf16 a[60:63], a[200:203], v[160:163], a[60:63]
v_mfma_f32_16x16x32_bf16 a[60:63], a[204:207], v[164:167], a[60:63]
v_mfma_f32_16x16x32_bf16 a[28:31], a[204:207], v[156:159], a[28:31]
v_mfma_f32_16x16x32_bf16 a[28:31], a[200:203], v[152:155], a[28:31]
s_cbranch_scc1 L_D
L_DD:
s_waitcnt lgkmcnt(7)
v_mfma_f32_16x16x32_bf16 v[104:107], a[144:147], v[40:43], v[220:223]
s_waitcnt lgkmcnt(6)
ds_read_b128 a[176:179], v2 offset:8192
v_cndmask_b32 v88, v216, v17, s[0:1]
v_mfma_f32_16x16x32_bf16 v[104:107], a[148:151], v[44:47], v[104:107]
s_waitcnt lgkmcnt(6)
ds_read_b128 a[180:183], v2 offset:9216
v_cndmask_b32 v89, v216, v17, s[4:5]
v_mfma_f32_16x16x32_bf16 v[104:107], a[152:155], v[48:51], v[104:107]
s_waitcnt lgkmcnt(6)
buffer_load_dwordx4 v16, s[32:35], s70 offen offset:2048 sc1 lds
v_mfma_f32_16x16x32_bf16 v[104:107], a[156:159], v[52:55], v[104:107]
ds_read_b128 a[184:187], v2 offset:10240
v_cndmask_b32 v90, v216, v17, s[6:7]
v_mfma_f32_16x16x32_bf16 v[120:123], a[156:159], v[68:71], v[224:227]
ds_read_b128 a[188:191], v2 offset:11264
v_cndmask_b32 v91, v216, v17, s[8:9]
v_mfma_f32_16x16x32_bf16 v[120:123], a[152:155], v[64:67], v[120:123]
ds_read_b128 a[192:195], v2 offset:12288
v_cndmask_b32 v92, v216, v17, s[10:11]
v_mfma_f32_16x16x32_bf16 v[120:123], a[148:151], v[60:63], v[120:123]
ds_read_b128 a[196:199], v2 offset:13312
v_cndmask_b32 v93, v216, v17, s[12:13]
v_mfma_f32_16x16x32_bf16 v[120:123], a[144:147], v[56:59], v[120:123]
ds_read_b128 a[200:203], v2 offset:14336
v_cndmask_b32 v94, v216, v17, s[18:19]
v_mfma_f32_16x16x32_bf16 v[136:139], a[144:147], v[72:75], v[228:231]
ds_read_b128 a[204:207], v2 offset:15360
v_cndmask_b32 v95, v216, v17, s[22:23]
v_mfma_f32_16x16x32_bf16 v[136:139], a[148:151], v[76:79], v[136:139]
v_cndmask_b32 v96, v216, v17, s[26:27]
v_cndmask_b32 v97, v216, v17, s[56:57]
v_mfma_f32_16x16x32_bf16 v[136:139], a[152:155], v[80:83], v[136:139]
v_exp_f32 v104, v104
v_mfma_f32_16x16x32_bf16 v[136:139], a[156:159], v[84:87], v[136:139]
v_exp_f32 v105, v105
v_mfma_f32_16x16x32_bf16 v[88:91], a[156:159], v[36:39], v[88:91]
v_exp_f32 v106, v106
v_mfma_f32_16x16x32_bf16 v[88:91], a[152:155], v[32:35], v[88:91]
v_exp_f32 v107, v107
v_mfma_f32_16x16x32_bf16 v[88:91], a[148:151], v[28:31], v[88:91]
v_exp_f32 v120, v120
v_mfma_f32_16x16x32_bf16 v[88:91], a[144:147], v[24:27], v[88:91]
s_waitcnt lgkmcnt(0)
v_exp_f32 v121, v121
v_mfma_f32_16x16x32_bf16 v[140:143], a[160:163], v[72:75], v[228:231]
v_exp_f32 v122, v122
v_mfma_f32_16x16x32_bf16 v[140:143], a[164:167], v[76:79], v[140:143]
buffer_load_dwordx4 v16, s[32:35], s70 offen offset:3072 sc1 lds
v_mfma_f32_16x16x32_bf16 v[140:143], a[168:171], v[80:83], v[140:143]
s_add_u32 m0, s86, 131072
v_exp_f32 v123, v123
v_mfma_f32_16x16x32_bf16 v[140:143], a[172:175], v[84:87], v[140:143]
s_add_u32 s64, s85, 0
v_cvt_pk_bf16_f32 v160, v104, v105
v_cvt_pk_bf16_f32 v161, v106, v107
v_mfma_f32_16x16x32_bf16 v[124:127], a[172:175], v[68:71], v[224:227]
buffer_load_dwordx4 v12, s[36:39], s64 offen lds
v_mfma_f32_16x16x32_bf16 v[124:127], a[168:171], v[64:67], v[124:127]
s_add_u32 m0, s86, 132096
v_exp_f32 v136, v136
v_mfma_f32_16x16x32_bf16 v[124:127], a[164:167], v[60:63], v[124:127]
s_add_u32 s64, s85, 8192
v_exp_f32 v137, v137
v_mfma_f32_16x16x32_bf16 v[124:127], a[160:163], v[56:59], v[124:127]
buffer_load_dwordx4 v13, s[36:39], s64 offen lds
v_mfma_f32_16x16x32_bf16 v[108:111], a[160:163], v[40:43], v[220:223]
v_exp_f32 v138, v138
v_mfma_f32_16x16x32_bf16 v[108:111], a[164:167], v[44:47], v[108:111]
ds_read_b128 a[144:147], v3 offset:0
v_cndmask_b32 v98, v216, v17, s[58:59]
v_mfma_f32_16x16x32_bf16 v[108:111], a[168:171], v[48:51], v[108:111]
s_add_u32 m0, s86, 133120
ds_read_b128 a[148:151], v3 offset:8192
v_cndmask_b32 v99, v216, v17, s[60:61]
v_mfma_f32_16x16x32_bf16 v[108:111], a[172:175], v[52:55], v[108:111]
s_add_u32 s64, s85, 16384
v_cvt_pk_bf16_f32 v184, v120, v121
v_cvt_pk_bf16_f32 v185, v122, v123
v_mfma_f32_16x16x32_bf16 v[92:95], a[172:175], v[36:39], v[92:95]
buffer_load_dwordx4 v12, s[36:39], s64 offen lds
v_mfma_f32_16x16x32_bf16 v[92:95], a[168:171], v[32:35], v[92:95]
s_add_u32 m0, s86, 134144
v_exp_f32 v139, v139
v_mfma_f32_16x16x32_bf16 v[92:95], a[164:167], v[28:31], v[92:95]
s_add_u32 s64, s85, 24576
v_exp_f32 v88, v88
v_mfma_f32_16x16x32_bf16 v[92:95], a[160:163], v[24:27], v[92:95]
buffer_load_dwordx4 v13, s[36:39], s64 offen lds
v_mfma_f32_16x16x32_bf16 v[96:99], a[176:179], v[24:27], v[96:99]
s_add_u32 m0, s71, 4096
v_exp_f32 v89, v89
v_mfma_f32_16x16x32_bf16 v[96:99], a[180:183], v[28:31], v[96:99]
s_add_u32 s64, s70, 4096
v_exp_f32 v90, v90
v_mfma_f32_16x16x32_bf16 v[96:99], a[184:187], v[32:35], v[96:99]
buffer_load_dwordx4 v16, s[32:35], s64 offen offset:0 sc1 lds
v_mfma_f32_16x16x32_bf16 v[96:99], a[188:191], v[36:39], v[96:99]
v_cvt_pk_bf16_f32 v192, v136, v137
v_cvt_pk_bf16_f32 v193, v138, v139
v_mfma_f32_16x16x32_bf16 v[112:115], a[188:191], v[52:55], v[220:223]
v_exp_f32 v91, v91
v_mfma_f32_16x16x32_bf16 v[112:115], a[184:187], v[48:51], v[112:115]
v_exp_f32 v140, v140
v_mfma_f32_16x16x32_bf16 v[112:115], a[180:183], v[44:47], v[112:115]
v_exp_f32 v141, v141
v_mfma_f32_16x16x32_bf16 v[112:115], a[176:179], v[40:43], v[112:115]
v_exp_f32 v142, v142
v_mfma_f32_16x16x32_bf16 v[128:131], a[176:179], v[56:59], v[224:227]
v_exp_f32 v143, v143
v_mfma_f32_16x16x32_bf16 v[128:131], a[180:183], v[60:63], v[128:131]
v_exp_f32 v124, v124
v_mfma_f32_16x16x32_bf16 v[128:131], a[184:187], v[64:67], v[128:131]
v_cvt_pk_bf16_f32 v152, v88, v89
v_cvt_pk_bf16_f32 v153, v90, v91
v_mfma_f32_16x16x32_bf16 v[128:131], a[188:191], v[68:71], v[128:131]
v_exp_f32 v125, v125
v_mfma_f32_16x16x32_bf16 v[144:147], a[188:191], v[84:87], v[228:231]
v_exp_f32 v126, v126
v_mfma_f32_16x16x32_bf16 v[144:147], a[184:187], v[80:83], v[144:147]
v_exp_f32 v127, v127
v_mfma_f32_16x16x32_bf16 v[144:147], a[180:183], v[76:79], v[144:147]
v_exp_f32 v108, v108
v_mfma_f32_16x16x32_bf16 v[144:147], a[176:179], v[72:75], v[144:147]
ds_read_b128 a[152:155], v3 offset:1024
v_cndmask_b32 v100, v216, v17, s[62:63]
v_mfma_f32_16x16x32_bf16 v[148:151], a[192:195], v[72:75], v[228:231]
buffer_load_dwordx4 v16, s[32:35], s64 offen offset:1024 sc1 lds
v_mfma_f32_16x16x32_bf16 v[148:151], a[196:199], v[76:79], v[148:151]
ds_read_b128 a[156:159], v3 offset:9216
v_cndmask_b32 v101, v216, v17, s[48:49]
v_mfma_f32_16x16x32_bf16 v[148:151], a[200:203], v[80:83], v[148:151]
v_cvt_pk_bf16_f32 v194, v140, v141
v_cvt_pk_bf16_f32 v195, v142, v143
v_mfma_f32_16x16x32_bf16 v[148:151], a[204:207], v[84:87], v[148:151]
ds_read_b128 a[160:163], v3 offset:2048
v_cndmask_b32 v102, v216, v17, s[50:51]
v_mfma_f32_16x16x32_bf16 v[132:135], a[204:207], v[68:71], v[224:227]
ds_read_b128 a[164:167], v3 offset:10240
v_cndmask_b32 v103, v216, v17, s[100:101]
v_mfma_f32_16x16x32_bf16 v[132:135], a[200:203], v[64:67], v[132:135]
v_exp_f32 v109, v109
v_mfma_f32_16x16x32_bf16 v[132:135], a[196:199], v[60:63], v[132:135]
v_exp_f32 v110, v110
v_mfma_f32_16x16x32_bf16 v[132:135], a[192:195], v[56:59], v[132:135]
v_exp_f32 v111, v111
v_mfma_f32_16x16x32_bf16 v[116:119], a[192:195], v[40:43], v[220:223]
v_exp_f32 v92, v92
v_mfma_f32_16x16x32_bf16 v[116:119], a[196:199], v[44:47], v[116:119]
v_cvt_pk_bf16_f32 v186, v124, v125
v_cvt_pk_bf16_f32 v187, v126, v127
v_mfma_f32_16x16x32_bf16 v[116:119], a[200:203], v[48:51], v[116:119]
v_exp_f32 v93, v93
v_mfma_f32_16x16x32_bf16 v[116:119], a[204:207], v[52:55], v[116:119]
v_exp_f32 v94, v94
v_mfma_f32_16x16x32_bf16 v[100:103], a[204:207], v[36:39], v[100:103]
v_exp_f32 v95, v95
v_mfma_f32_16x16x32_bf16 v[100:103], a[200:203], v[32:35], v[100:103]
v_exp_f32 v96, v96
v_mfma_f32_16x16x32_bf16 v[100:103], a[196:199], v[28:31], v[100:103]
v_exp_f32 v97, v97
v_mfma_f32_16x16x32_bf16 v[100:103], a[192:195], v[24:27], v[100:103]
v_exp_f32 v98, v98
v_smfmac_f32_16x16x64_bf16 a[128:131], a[240:243], v[168:175], v5
ds_read_b128 a[168:171], v3 offset:3072
v_smfmac_f32_16x16x64_bf16 a[132:135], a[240:243], v[176:183], v5
v_cvt_pk_bf16_f32 v162, v108, v109
v_smfmac_f32_16x16x64_bf16 a[136:139], a[240:243], v[200:207], v5
ds_read_b128 a[172:175], v3 offset:11264
v_smfmac_f32_16x16x64_bf16 a[140:143], a[240:243], v[208:215], v5
s_waitcnt lgkmcnt(2)
buffer_load_dwordx4 v16, s[32:35], s64 offen offset:2048 sc1 lds
v_mfma_f32_16x16x32_bf16 a[0:3], a[144:147], v[168:171], a[0:3]
v_exp_f32 v99, v99
v_mfma_f32_16x16x32_bf16 a[0:3], a[148:151], v[172:175], a[0:3]
v_cvt_pk_bf16_f32 v163, v110, v111
v_cvt_pk_bf16_f32 v154, v92, v93
v_mfma_f32_16x16x32_bf16 a[32:35], a[148:151], v[180:183], a[32:35]
v_exp_f32 v112, v112
v_mfma_f32_16x16x32_bf16 a[32:35], a[144:147], v[176:179], a[32:35]
v_exp_f32 v113, v113
v_mfma_f32_16x16x32_bf16 a[64:67], a[144:147], v[200:203], a[64:67]
v_exp_f32 v114, v114
v_mfma_f32_16x16x32_bf16 a[64:67], a[148:151], v[204:207], a[64:67]
v_exp_f32 v115, v115
v_mfma_f32_16x16x32_bf16 a[96:99], a[148:151], v[212:215], a[96:99]
v_exp_f32 v128, v128
v_mfma_f32_16x16x32_bf16 a[96:99], a[144:147], v[208:211], a[96:99]
v_exp_f32 v129, v129
v_mfma_f32_16x16x32_bf16 a[100:103], a[152:155], v[208:211], a[100:103]
v_exp_f32 v130, v130
v_mfma_f32_16x16x32_bf16 a[100:103], a[156:159], v[212:215], a[100:103]
v_cvt_pk_bf16_f32 v155, v94, v95
v_cvt_pk_bf16_f32 v156, v96, v97
v_mfma_f32_16x16x32_bf16 a[68:71], a[156:159], v[204:207], a[68:71]
v_exp_f32 v131, v131
v_mfma_f32_16x16x32_bf16 a[68:71], a[152:155], v[200:203], a[68:71]
buffer_load_dwordx4 v16, s[32:35], s64 offen offset:3072 sc1 lds
v_mfma_f32_16x16x32_bf16 a[36:39], a[152:155], v[176:179], a[36:39]
s_add_u32 m0, s86, 135168
ds_read_b128 a[176:179], v3 offset:4096
v_cvt_pk_bf16_f32 v157, v98, v99
v_mfma_f32_16x16x32_bf16 a[36:39], a[156:159], v[180:183], a[36:39]
s_add_u32 s64, s85, 32768
v_exp_f32 v144, v144
v_mfma_f32_16x16x32_bf16 a[4:7], a[156:159], v[172:175], a[4:7]
buffer_load_dwordx4 v12, s[36:39], s64 offen lds
v_mfma_f32_16x16x32_bf16 a[4:7], a[152:155], v[168:171], a[4:7]
s_add_u32 m0, s86, 136192
ds_read_b128 a[180:183], v3 offset:12288
v_cvt_pk_bf16_f32 v164, v112, v113
v_mfma_f32_16x16x32_bf16 a[8:11], a[160:163], v[168:171], a[8:11]
s_add_u32 s64, s85, 40960
v_exp_f32 v145, v145
v_mfma_f32_16x16x32_bf16 a[8:11], a[164:167], v[172:175], a[8:11]
buffer_load_dwordx4 v13, s[36:39], s64 offen lds
v_mfma_f32_16x16x32_bf16 a[40:43], a[164:167], v[180:183], a[40:43]
ds_read_b128 a[184:187], v3 offset:5120
v_cvt_pk_bf16_f32 v165, v114, v115
v_mfma_f32_16x16x32_bf16 a[40:43], a[160:163], v[176:179], a[40:43]
ds_read_b128 a[188:191], v3 offset:13312
v_cvt_pk_bf16_f32 v188, v128, v129
v_mfma_f32_16x16x32_bf16 a[72:75], a[160:163], v[200:203], a[72:75]
ds_read_b128 a[192:195], v3 offset:6144
v_cvt_pk_bf16_f32 v189, v130, v131
v_mfma_f32_16x16x32_bf16 a[72:75], a[164:167], v[204:207], a[72:75]
ds_read_b128 a[196:199], v3 offset:14336
v_cvt_pk_bf16_f32 v196, v144, v145
v_mfma_f32_16x16x32_bf16 a[104:107], a[164:167], v[212:215], a[104:107]
ds_read_b128 a[200:203], v3 offset:7168
v_mfma_f32_16x16x32_bf16 a[104:107], a[160:163], v[208:211], a[104:107]
s_waitcnt lgkmcnt(5)
s_add_u32 m0, s86, 137216
ds_read_b128 a[204:207], v3 offset:15360
v_mfma_f32_16x16x32_bf16 a[108:111], a[168:171], v[208:211], a[108:111]
s_add_u32 s64, s85, 49152
v_exp_f32 v146, v146
v_mfma_f32_16x16x32_bf16 a[108:111], a[172:175], v[212:215], a[108:111]
buffer_load_dwordx4 v12, s[36:39], s64 offen lds
v_mfma_f32_16x16x32_bf16 a[76:79], a[172:175], v[204:207], a[76:79]
s_add_u32 m0, s86, 138240
v_exp_f32 v147, v147
v_mfma_f32_16x16x32_bf16 a[76:79], a[168:171], v[200:203], a[76:79]
s_add_u32 s64, s85, 57344
v_exp_f32 v148, v148
v_mfma_f32_16x16x32_bf16 a[44:47], a[168:171], v[176:179], a[44:47]
buffer_load_dwordx4 v13, s[36:39], s64 offen lds
v_mfma_f32_16x16x32_bf16 a[44:47], a[172:175], v[180:183], a[44:47]
s_waitcnt vmcnt(16)
s_barrier
v_mfma_f32_16x16x32_bf16 a[12:15], a[172:175], v[172:175], a[12:15]
s_xor_b32 s71, s71, 16384
v_exp_f32 v149, v149
v_mfma_f32_16x16x32_bf16 a[12:15], a[168:171], v[168:171], a[12:15]
s_add_u32 s70, s70, 32768
v_exp_f32 v150, v150
v_mfma_f32_16x16x32_bf16 a[16:19], a[176:179], v[168:171], a[16:19]
s_mov_b32 m0, s71
v_exp_f32 v151, v151
v_mfma_f32_16x16x32_bf16 a[16:19], a[180:183], v[172:175], a[16:19]
buffer_load_dwordx4 v16, s[32:35], s70 offen offset:0 sc1 lds
v_mfma_f32_16x16x32_bf16 a[48:51], a[180:183], v[180:183], a[48:51]
v_exp_f32 v132, v132
v_mfma_f32_16x16x32_bf16 a[48:51], a[176:179], v[176:179], a[48:51]
v_exp_f32 v133, v133
v_mfma_f32_16x16x32_bf16 a[80:83], a[176:179], v[200:203], a[80:83]
v_exp_f32 v134, v134
v_mfma_f32_16x16x32_bf16 a[80:83], a[180:183], v[204:207], a[80:83]
v_exp_f32 v135, v135
v_mfma_f32_16x16x32_bf16 a[112:115], a[180:183], v[212:215], a[112:115]
v_exp_f32 v116, v116
v_mfma_f32_16x16x32_bf16 a[112:115], a[176:179], v[208:211], a[112:115]
s_waitcnt lgkmcnt(0)
v_cvt_pk_bf16_f32 v197, v146, v147
v_cvt_pk_bf16_f32 v198, v148, v149
v_mfma_f32_16x16x32_bf16 a[116:119], a[184:187], v[208:211], a[116:119]
v_exp_f32 v117, v117
v_mfma_f32_16x16x32_bf16 a[116:119], a[188:191], v[212:215], a[116:119]
v_exp_f32 v118, v118
v_mfma_f32_16x16x32_bf16 a[84:87], a[188:191], v[204:207], a[84:87]
v_exp_f32 v119, v119
v_mfma_f32_16x16x32_bf16 a[84:87], a[184:187], v[200:203], a[84:87]
v_exp_f32 v100, v100
v_mfma_f32_16x16x32_bf16 a[52:55], a[184:187], v[176:179], a[52:55]
v_exp_f32 v101, v101
v_mfma_f32_16x16x32_bf16 a[52:55], a[188:191], v[180:183], a[52:55]
ds_read_b128 a[144:147], v2 offset:16384
v_cvt_pk_bf16_f32 v199, v150, v151
v_mfma_f32_16x16x32_bf16 a[20:23], a[188:191], v[172:175], a[20:23]
ds_read_b128 a[148:151], v2 offset:17408
v_cvt_pk_bf16_f32 v190, v132, v133
v_mfma_f32_16x16x32_bf16 a[20:23], a[184:187], v[168:171], a[20:23]
v_exp_f32 v102, v102
v_mfma_f32_16x16x32_bf16 a[24:27], a[192:195], v[168:171], a[24:27]
buffer_load_dwordx4 v16, s[32:35], s70 offen offset:1024 sc1 lds
v_mfma_f32_16x16x32_bf16 a[24:27], a[196:199], v[172:175], a[24:27]
ds_read_b128 a[152:155], v2 offset:18432
v_cvt_pk_bf16_f32 v191, v134, v135
v_mfma_f32_16x16x32_bf16 a[56:59], a[196:199], v[180:183], a[56:59]
ds_read_b128 a[156:159], v2 offset:19456
v_cvt_pk_bf16_f32 v166, v116, v117
v_mfma_f32_16x16x32_bf16 a[56:59], a[192:195], v[176:179], a[56:59]
v_exp_f32 v103, v103
v_mfma_f32_16x16x32_bf16 a[88:91], a[192:195], v[200:203], a[88:91]
ds_read_b128 a[160:163], v2 offset:20480
v_cvt_pk_bf16_f32 v167, v118, v119
v_mfma_f32_16x16x32_bf16 a[88:91], a[196:199], v[204:207], a[88:91]
ds_read_b128 a[164:167], v2 offset:21504
v_cvt_pk_bf16_f32 v158, v100, v101
v_mfma_f32_16x16x32_bf16 a[120:123], a[196:199], v[212:215], a[120:123]
ds_read_b128 a[168:171], v2 offset:22528
v_cvt_pk_bf16_f32 v159, v102, v103
v_mfma_f32_16x16x32_bf16 a[120:123], a[192:195], v[208:211], a[120:123]
ds_read_b128 a[172:175], v2 offset:23552
v_cndmask_b32 v104, v220, v17, s[0:1]
v_mfma_f32_16x16x32_bf16 a[124:127], a[200:203], v[208:211], a[124:127]
v_cndmask_b32 v105, v220, v17, s[4:5]
v_cndmask_b32 v106, v220, v17, s[6:7]
v_mfma_f32_16x16x32_bf16 a[124:127], a[204:207], v[212:215], a[124:127]
v_cndmask_b32 v107, v220, v17, s[8:9]
v_cndmask_b32 v108, v220, v17, s[10:11]
v_mfma_f32_16x16x32_bf16 a[92:95], a[204:207], v[204:207], a[92:95]
v_cndmask_b32 v109, v220, v17, s[12:13]
v_cndmask_b32 v110, v220, v17, s[18:19]
v_mfma_f32_16x16x32_bf16 a[92:95], a[200:203], v[200:203], a[92:95]
v_cndmask_b32 v111, v220, v17, s[22:23]
v_cndmask_b32 v112, v220, v17, s[26:27]
v_mfma_f32_16x16x32_bf16 a[60:63], a[200:203], v[176:179], a[60:63]
v_cndmask_b32 v113, v220, v17, s[56:57]
v_cndmask_b32 v114, v220, v17, s[58:59]
v_mfma_f32_16x16x32_bf16 a[60:63], a[204:207], v[180:183], a[60:63]
v_cndmask_b32 v115, v220, v17, s[60:61]
v_cndmask_b32 v116, v220, v17, s[62:63]
v_mfma_f32_16x16x32_bf16 a[28:31], a[204:207], v[172:175], a[28:31]
v_cndmask_b32 v117, v220, v17, s[48:49]
v_cndmask_b32 v118, v220, v17, s[50:51]
v_mfma_f32_16x16x32_bf16 a[28:31], a[200:203], v[168:171], a[28:31]
s_waitcnt lgkmcnt(0)
v_cndmask_b32 v119, v220, v17, s[100:101]
v_mfma_f32_16x16x32_bf16 v[120:123], a[144:147], v[56:59], v[224:227]
ds_read_b128 a[176:179], v2 offset:24576
v_mfma_f32_16x16x32_bf16 v[120:123], a[148:151], v[60:63], v[120:123]
ds_read_b128 a[180:183], v2 offset:25600
v_mfma_f32_16x16x32_bf16 v[120:123], a[152:155], v[64:67], v[120:123]
buffer_load_dwordx4 v16, s[32:35], s70 offen offset:2048 sc1 lds
v_mfma_f32_16x16x32_bf16 v[120:123], a[156:159], v[68:71], v[120:123]
ds_read_b128 a[184:187], v2 offset:26624
v_mfma_f32_16x16x32_bf16 v[136:139], a[156:159], v[84:87], v[228:231]
s_add_u32 s17, s78, L_T-L_pc
ds_read_b128 a[188:191], v2 offset:27648
v_mfma_f32_16x16x32_bf16 v[136:139], a[152:155], v[80:83], v[136:139]
buffer_load_dword a252, v16, s[88:91], s17 offen
v_mfma_f32_16x16x32_bf16 v[136:139], a[148:151], v[76:79], v[136:139]
v_mfma_f32_16x16x32_bf16 v[136:139], a[144:147], v[72:75], v[136:139]
v_mfma_f32_16x16x32_bf16 v[104:107], a[144:147], v[40:43], v[104:107]
s_add_u32 s17, s78, L_T-L_pc+4096
ds_read_b128 a[192:195], v2 offset:28672
v_mfma_f32_16x16x32_bf16 v[104:107], a[148:151], v[44:47], v[104:107]
buffer_load_dword a252, v16, s[88:91], s17 offen
v_mfma_f32_16x16x32_bf16 v[104:107], a[152:155], v[48:51], v[104:107]
v_exp_f32 v120, v120
v_mfma_f32_16x16x32_bf16 v[104:107], a[156:159], v[52:55], v[104:107]
v_exp_f32 v121, v121
v_mfma_f32_16x16x32_bf16 v[140:143], a[172:175], v[84:87], v[228:231]
v_exp_f32 v122, v122
v_mfma_f32_16x16x32_bf16 v[140:143], a[168:171], v[80:83], v[140:143]
v_exp_f32 v123, v123
v_mfma_f32_16x16x32_bf16 v[140:143], a[164:167], v[76:79], v[140:143]
v_exp_f32 v136, v136
v_mfma_f32_16x16x32_bf16 v[140:143], a[160:163], v[72:75], v[140:143]
buffer_load_dwordx4 v16, s[32:35], s70 offen offset:3072 sc1 lds
v_mfma_f32_16x16x32_bf16 v[124:127], a[160:163], v[56:59], v[224:227]
v_exp_f32 v137, v137
v_mfma_f32_16x16x32_bf16 v[124:127], a[164:167], v[60:63], v[124:127]
v_exp_f32 v138, v138
v_mfma_f32_16x16x32_bf16 v[124:127], a[168:171], v[64:67], v[124:127]
v_exp_f32 v139, v139
v_mfma_f32_16x16x32_bf16 v[124:127], a[172:175], v[68:71], v[124:127]
v_exp_f32 v104, v104
v_mfma_f32_16x16x32_bf16 v[108:111], a[172:175], v[52:55], v[108:111]
v_cvt_pk_bf16_f32 v200, v120, v121
v_cvt_pk_bf16_f32 v201, v122, v123
v_mfma_f32_16x16x32_bf16 v[108:111], a[168:171], v[48:51], v[108:111]
ds_read_b128 a[196:199], v2 offset:29696
v_cvt_pk_bf16_f32 v208, v136, v137
v_mfma_f32_16x16x32_bf16 v[108:111], a[164:167], v[44:47], v[108:111]
ds_read_b128 a[200:203], v2 offset:30720
v_cvt_pk_bf16_f32 v209, v138, v139
v_mfma_f32_16x16x32_bf16 v[108:111], a[160:163], v[40:43], v[108:111]
s_waitcnt lgkmcnt(2)
ds_read_b128 a[204:207], v2 offset:31744
v_mfma_f32_16x16x32_bf16 v[112:115], a[176:179], v[40:43], v[112:115]
v_exp_f32 v105, v105
v_mfma_f32_16x16x32_bf16 v[112:115], a[180:183], v[44:47], v[112:115]
v_exp_f32 v106, v106
v_mfma_f32_16x16x32_bf16 v[112:115], a[184:187], v[48:51], v[112:115]
v_exp_f32 v107, v107
v_mfma_f32_16x16x32_bf16 v[112:115], a[188:191], v[52:55], v[112:115]
s_add_u32 m0, s71, 4096
v_exp_f32 v140, v140
v_mfma_f32_16x16x32_bf16 v[128:131], a[188:191], v[68:71], v[224:227]
s_add_u32 s64, s70, 4096
v_exp_f32 v141, v141
v_mfma_f32_16x16x32_bf16 v[128:131], a[184:187], v[64:67], v[128:131]
buffer_load_dwordx4 v16, s[32:35], s64 offen offset:0 sc1 lds
v_mfma_f32_16x16x32_bf16 v[128:131], a[180:183], v[60:63], v[128:131]
v_exp_f32 v142, v142
v_mfma_f32_16x16x32_bf16 v[128:131], a[176:179], v[56:59], v[128:131]
v_exp_f32 v143, v143
v_mfma_f32_16x16x32_bf16 v[144:147], a[176:179], v[72:75], v[228:231]
ds_read_b128 a[144:147], v3 offset:16384
v_cvt_pk_bf16_f32 v176, v104, v105
v_mfma_f32_16x16x32_bf16 v[144:147], a[180:183], v[76:79], v[144:147]
ds_read_b128 a[148:151], v3 offset:24576
v_cvt_pk_bf16_f32 v177, v106, v107
v_mfma_f32_16x16x32_bf16 v[144:147], a[184:187], v[80:83], v[144:147]
v_exp_f32 v124, v124
v_mfma_f32_16x16x32_bf16 v[144:147], a[188:191], v[84:87], v[144:147]
s_waitcnt lgkmcnt(2)
v_exp_f32 v125, v125
v_mfma_f32_16x16x32_bf16 v[148:151], a[204:207], v[84:87], v[228:231]
v_exp_f32 v126, v126
v_mfma_f32_16x16x32_bf16 v[148:151], a[200:203], v[80:83], v[148:151]
v_exp_f32 v127, v127
v_mfma_f32_16x16x32_bf16 v[148:151], a[196:199], v[76:79], v[148:151]
ds_read_b128 a[152:155], v3 offset:17408
v_cvt_pk_bf16_f32 v210, v140, v141
v_mfma_f32_16x16x32_bf16 v[148:151], a[192:195], v[72:75], v[148:151]
ds_read_b128 a[156:159], v3 offset:25600
v_cvt_pk_bf16_f32 v211, v142, v143
v_mfma_f32_16x16x32_bf16 v[132:135], a[192:195], v[56:59], v[224:227]
v_exp_f32 v108, v108
v_mfma_f32_16x16x32_bf16 v[132:135], a[196:199], v[60:63], v[132:135]
v_exp_f32 v109, v109
v_mfma_f32_16x16x32_bf16 v[132:135], a[200:203], v[64:67], v[132:135]
buffer_load_dwordx4 v16, s[32:35], s64 offen offset:1024 sc1 lds
v_mfma_f32_16x16x32_bf16 v[132:135], a[204:207], v[68:71], v[132:135]
v_exp_f32 v110, v110
v_mfma_f32_16x16x32_bf16 v[116:119], a[204:207], v[52:55], v[116:119]
ds_read_b128 a[160:163], v3 offset:18432
v_cvt_pk_bf16_f32 v202, v124, v125
v_mfma_f32_16x16x32_bf16 v[116:119], a[200:203], v[48:51], v[116:119]
v_exp_f32 v111, v111
v_mfma_f32_16x16x32_bf16 v[116:119], a[196:199], v[44:47], v[116:119]
ds_read_b128 a[164:167], v3 offset:26624
v_cvt_pk_bf16_f32 v203, v126, v127
v_mfma_f32_16x16x32_bf16 v[116:119], a[192:195], v[40:43], v[116:119]
v_exp_f32 v112, v112
v_smfmac_f32_16x16x64_bf16 a[128:131], a[240:243], v[152:159], v5
ds_read_b128 a[168:171], v3 offset:19456
v_smfmac_f32_16x16x64_bf16 a[132:135], a[240:243], v[160:167], v5
ds_read_b128 a[172:175], v3 offset:27648
v_smfmac_f32_16x16x64_bf16 a[136:139], a[240:243], v[184:191], v5
ds_read_b128 a[176:179], v3 offset:20480
v_smfmac_f32_16x16x64_bf16 a[140:143], a[240:243], v[192:199], v5
s_waitcnt lgkmcnt(4)
ds_read_b128 a[180:183], v3 offset:28672
v_xor_b32 v2, 0x8000, v2
v_mfma_f32_16x16x32_bf16 a[0:3], a[144:147], v[152:155], a[0:3]
v_exp_f32 v113, v113
v_mfma_f32_16x16x32_bf16 a[0:3], a[148:151], v[156:159], a[0:3]
v_exp_f32 v114, v114
v_mfma_f32_16x16x32_bf16 a[32:35], a[148:151], v[164:167], a[32:35]
v_exp_f32 v115, v115
v_mfma_f32_16x16x32_bf16 a[32:35], a[144:147], v[160:163], a[32:35]
v_exp_f32 v128, v128
v_mfma_f32_16x16x32_bf16 a[64:67], a[144:147], v[184:187], a[64:67]
buffer_load_dwordx4 v16, s[32:35], s64 offen offset:2048 sc1 lds
v_mfma_f32_16x16x32_bf16 a[64:67], a[148:151], v[188:191], a[64:67]
v_exp_f32 v129, v129
v_mfma_f32_16x16x32_bf16 a[96:99], a[148:151], v[196:199], a[96:99]
v_exp_f32 v130, v130
v_mfma_f32_16x16x32_bf16 a[96:99], a[144:147], v[192:195], a[96:99]
v_exp_f32 v131, v131
v_mfma_f32_16x16x32_bf16 a[100:103], a[152:155], v[192:195], a[100:103]
v_exp_f32 v144, v144
v_mfma_f32_16x16x32_bf16 a[100:103], a[156:159], v[196:199], a[100:103]
v_exp_f32 v145, v145
v_mfma_f32_16x16x32_bf16 a[68:71], a[156:159], v[188:191], a[68:71]
ds_read_b128 a[184:187], v3 offset:21504
v_cvt_pk_bf16_f32 v178, v108, v109
v_mfma_f32_16x16x32_bf16 a[68:71], a[152:155], v[184:187], a[68:71]
ds_read_b128 a[188:191], v3 offset:29696
v_cvt_pk_bf16_f32 v179, v110, v111
v_mfma_f32_16x16x32_bf16 a[36:39], a[152:155], v[160:163], a[36:39]
ds_read_b128 a[192:195], v3 offset:22528
v_cvt_pk_bf16_f32 v180, v112, v113
v_mfma_f32_16x16x32_bf16 a[36:39], a[156:159], v[164:167], a[36:39]
v_exp_f32 v146, v146
v_mfma_f32_16x16x32_bf16 a[4:7], a[156:159], v[156:159], a[4:7]
v_exp_f32 v147, v147
v_mfma_f32_16x16x32_bf16 a[4:7], a[152:155], v[152:155], a[4:7]
v_exp_f32 v148, v148
v_mfma_f32_16x16x32_bf16 a[8:11], a[160:163], v[152:155], a[8:11]
s_waitcnt lgkmcnt(2)
ds_read_b128 a[196:199], v3 offset:30720
v_cvt_pk_bf16_f32 v181, v114, v115
v_mfma_f32_16x16x32_bf16 a[8:11], a[164:167], v[156:159], a[8:11]
buffer_load_dwordx4 v16, s[32:35], s64 offen offset:3072 sc1 lds
v_mfma_f32_16x16x32_bf16 a[40:43], a[164:167], v[164:167], a[40:43]
v_exp_f32 v149, v149
v_mfma_f32_16x16x32_bf16 a[40:43], a[160:163], v[160:163], a[40:43]
ds_read_b128 a[200:203], v3 offset:23552
v_cvt_pk_bf16_f32 v204, v128, v129
v_mfma_f32_16x16x32_bf16 a[72:75], a[160:163], v[184:187], a[72:75]
v_exp_f32 v150, v150
v_mfma_f32_16x16x32_bf16 a[72:75], a[164:167], v[188:191], a[72:75]
v_exp_f32 v151, v151
v_mfma_f32_16x16x32_bf16 a[104:107], a[164:167], v[196:199], a[104:107]
v_exp_f32 v132, v132
v_mfma_f32_16x16x32_bf16 a[104:107], a[160:163], v[192:195], a[104:107]
ds_read_b128 a[204:207], v3 offset:31744
v_cvt_pk_bf16_f32 v205, v130, v131
v_mfma_f32_16x16x32_bf16 a[108:111], a[168:171], v[192:195], a[108:111]
v_exp_f32 v133, v133
v_mfma_f32_16x16x32_bf16 a[108:111], a[172:175], v[196:199], a[108:111]
v_exp_f32 v134, v134
v_mfma_f32_16x16x32_bf16 a[76:79], a[172:175], v[188:191], a[76:79]
v_exp_f32 v135, v135
v_mfma_f32_16x16x32_bf16 a[76:79], a[168:171], v[184:187], a[76:79]
v_exp_f32 v116, v116
v_mfma_f32_16x16x32_bf16 a[44:47], a[168:171], v[160:163], a[44:47]
v_exp_f32 v117, v117
v_mfma_f32_16x16x32_bf16 a[44:47], a[172:175], v[164:167], a[44:47]
s_add_u32 s17, s78, L_T1-L_pc
v_exp_f32 v118, v118
v_mfma_f32_16x16x32_bf16 a[12:15], a[172:175], v[156:159], a[12:15]
buffer_load_dword a252, v16, s[88:91], s17 offen
v_mfma_f32_16x16x32_bf16 a[12:15], a[168:171], v[152:155], a[12:15]
v_exp_f32 v119, v119
v_mfma_f32_16x16x32_bf16 a[16:19], a[176:179], v[152:155], a[16:19]
v_cvt_pk_bf16_f32 v212, v144, v145
v_cvt_pk_bf16_f32 v213, v146, v147
v_mfma_f32_16x16x32_bf16 a[16:19], a[180:183], v[156:159], a[16:19]
s_waitcnt vmcnt(15)
s_barrier
v_mfma_f32_16x16x32_bf16 a[48:51], a[180:183], v[164:167], a[48:51]
s_xor_b32 s71, s71, 49152
ds_read_b128 a[144:147], v2 offset:0
v_cvt_pk_bf16_f32 v214, v148, v149
v_mfma_f32_16x16x32_bf16 a[48:51], a[176:179], v[160:163], a[48:51]
s_add_u32 s70, s70, 32768
ds_read_b128 a[148:151], v2 offset:1024
v_cvt_pk_bf16_f32 v215, v150, v151
v_mfma_f32_16x16x32_bf16 a[80:83], a[176:179], v[184:187], a[80:83]
s_mov_b32 m0, s71
ds_read_b128 a[152:155], v2 offset:2048
v_cvt_pk_bf16_f32 v206, v132, v133
v_mfma_f32_16x16x32_bf16 a[80:83], a[180:183], v[188:191], a[80:83]
buffer_load_dwordx4 v16, s[32:35], s70 offen offset:0 sc1 lds
v_mfma_f32_16x16x32_bf16 a[112:115], a[180:183], v[196:199], a[112:115]
s_add_u32 s17, s78, L_T1-L_pc+4096
ds_read_b128 a[156:159], v2 offset:3072
v_cvt_pk_bf16_f32 v207, v134, v135
v_mfma_f32_16x16x32_bf16 a[112:115], a[176:179], v[192:195], a[112:115]
buffer_load_dword a252, v16, s[88:91], s17 offen
v_mfma_f32_16x16x32_bf16 a[116:119], a[184:187], v[192:195], a[116:119]
s_waitcnt lgkmcnt(3)
ds_read_b128 a[160:163], v2 offset:4096
v_cvt_pk_bf16_f32 v182, v116, v117
v_mfma_f32_16x16x32_bf16 a[116:119], a[188:191], v[196:199], a[116:119]
ds_read_b128 a[164:167], v2 offset:5120
v_cvt_pk_bf16_f32 v183, v118, v119
v_mfma_f32_16x16x32_bf16 a[84:87], a[188:191], v[188:191], a[84:87]
ds_read_b128 a[168:171], v2 offset:6144
v_xor_b32 v3, 0x8000, v3
v_mfma_f32_16x16x32_bf16 a[84:87], a[184:187], v[184:187], a[84:87]
ds_read_b128 a[172:175], v2 offset:7168
v_accvgpr_read_b32 v20, a128
v_mfma_f32_16x16x32_bf16 a[52:55], a[184:187], v[160:163], a[52:55]
v_accvgpr_read_b32 v248, a129
v_add_f32 v20, v20, v248
v_mfma_f32_16x16x32_bf16 a[52:55], a[188:191], v[164:167], a[52:55]
v_max_f32 v1, v1, v20
v_mfma_f32_16x16x32_bf16 a[20:23], a[188:191], v[156:159], a[20:23]
v_rcp_f32 v20, v20
v_mfma_f32_16x16x32_bf16 a[20:23], a[184:187], v[152:155], a[20:23]
v_accvgpr_read_b32 v232, a0
v_accvgpr_read_b32 v233, a1
v_mfma_f32_16x16x32_bf16 a[24:27], a[192:195], v[152:155], a[24:27]
v_accvgpr_read_b32 v234, a2
v_accvgpr_read_b32 v235, a3
v_mfma_f32_16x16x32_bf16 a[24:27], a[196:199], v[156:159], a[24:27]
v_accvgpr_read_b32 v236, a4
v_accvgpr_read_b32 v237, a5
v_mfma_f32_16x16x32_bf16 a[56:59], a[196:199], v[164:167], a[56:59]
buffer_load_dwordx4 v16, s[32:35], s70 offen offset:1024 sc1 lds
v_mfma_f32_16x16x32_bf16 a[56:59], a[192:195], v[160:163], a[56:59]
v_accvgpr_read_b32 v238, a6
v_accvgpr_read_b32 v239, a7
v_mfma_f32_16x16x32_bf16 a[88:91], a[192:195], v[184:187], a[88:91]
v_mul_f32 v20, v20, v4
v_mul_f32 v232, v232, v20
v_mfma_f32_16x16x32_bf16 a[88:91], a[196:199], v[188:191], a[88:91]
v_mul_f32 v233, v233, v20
v_mul_f32 v234, v234, v20
v_mfma_f32_16x16x32_bf16 a[120:123], a[196:199], v[196:199], a[120:123]
v_mul_f32 v235, v235, v20
v_mul_f32 v236, v236, v20
v_mfma_f32_16x16x32_bf16 a[120:123], a[192:195], v[192:195], a[120:123]
v_mul_f32 v237, v237, v20
v_mul_f32 v238, v238, v20
v_mfma_f32_16x16x32_bf16 a[124:127], a[200:203], v[192:195], a[124:127]
v_mul_f32 v239, v239, v20
v_cvt_pk_bf16_f32 v232, v232, v233
v_mfma_f32_16x16x32_bf16 a[124:127], a[204:207], v[196:199], a[124:127]
v_cvt_pk_bf16_f32 v233, v234, v235
v_cvt_pk_bf16_f32 v234, v236, v237
v_mfma_f32_16x16x32_bf16 a[92:95], a[204:207], v[188:191], a[92:95]
v_cvt_pk_bf16_f32 v235, v238, v239
v_mfma_f32_16x16x32_bf16 a[92:95], a[200:203], v[184:187], a[92:95]
s_add_u32 s77, s74, 0
buffer_store_dwordx4 v[232:235], v16, s[44:47], s77 offen sc1
v_mfma_f32_16x16x32_bf16 a[60:63], a[200:203], v[160:163], a[60:63]
v_accvgpr_read_b32 v240, a8
v_accvgpr_read_b32 v241, a9
v_mfma_f32_16x16x32_bf16 a[60:63], a[204:207], v[164:167], a[60:63]
v_accvgpr_read_b32 v242, a10
v_accvgpr_read_b32 v243, a11
v_mfma_f32_16x16x32_bf16 a[28:31], a[204:207], v[156:159], a[28:31]
v_accvgpr_read_b32 v244, a12
v_accvgpr_read_b32 v245, a13
v_mfma_f32_16x16x32_bf16 a[28:31], a[200:203], v[152:155], a[28:31]
v_accvgpr_read_b32 v246, a14
v_accvgpr_read_b32 v247, a15
v_mul_f32 v240, v240, v20
v_mul_f32 v241, v241, v20
v_mul_f32 v242, v242, v20
v_mul_f32 v243, v243, v20
v_mul_f32 v244, v244, v20
v_mul_f32 v245, v245, v20
v_mul_f32 v246, v246, v20
v_mul_f32 v247, v247, v20
v_cvt_pk_bf16_f32 v240, v240, v241
v_cvt_pk_bf16_f32 v241, v242, v243
v_cvt_pk_bf16_f32 v242, v244, v245
v_cvt_pk_bf16_f32 v243, v246, v247
s_add_u32 s77, s74, 8192
buffer_store_dwordx4 v[240:243], v16, s[44:47], s77 offen sc1
v_accvgpr_read_b32 v232, a16
v_accvgpr_read_b32 v233, a17
v_accvgpr_read_b32 v234, a18
v_accvgpr_read_b32 v235, a19
v_accvgpr_read_b32 v236, a20
v_accvgpr_read_b32 v237, a21
v_accvgpr_read_b32 v238, a22
v_accvgpr_read_b32 v239, a23
v_mul_f32 v232, v232, v20
v_mul_f32 v233, v233, v20
v_mul_f32 v234, v234, v20
v_mul_f32 v235, v235, v20
v_mul_f32 v236, v236, v20
v_mul_f32 v237, v237, v20
v_mul_f32 v238, v238, v20
v_mul_f32 v239, v239, v20
v_cvt_pk_bf16_f32 v232, v232, v233
v_cvt_pk_bf16_f32 v233, v234, v235
v_cvt_pk_bf16_f32 v234, v236, v237
v_cvt_pk_bf16_f32 v235, v238, v239
s_add_u32 s77, s74, 16384
buffer_store_dwordx4 v[232:235], v16, s[44:47], s77 offen sc1
s_cmp_eq_u32 s3, 7
s_cbranch_scc1 L_T1
L_T:
s_waitcnt lgkmcnt(7)
v_mfma_f32_16x16x32_bf16 v[120:123], a[144:147], v[56:59], v[224:227]
s_waitcnt lgkmcnt(6)
ds_read_b128 a[176:179], v2 offset:8192
v_mfma_f32_16x16x32_bf16 v[120:123], a[148:151], v[60:63], v[120:123]
s_waitcnt lgkmcnt(6)
ds_read_b128 a[180:183], v2 offset:9216
v_mfma_f32_16x16x32_bf16 v[120:123], a[152:155], v[64:67], v[120:123]
s_waitcnt lgkmcnt(6)
buffer_load_dwordx4 v16, s[32:35], s70 offen offset:2048 sc1 lds
v_mfma_f32_16x16x32_bf16 v[120:123], a[156:159], v[68:71], v[120:123]
ds_read_b128 a[184:187], v2 offset:10240
v_mfma_f32_16x16x32_bf16 v[136:139], a[156:159], v[84:87], v[228:231]
ds_read_b128 a[188:191], v2 offset:11264
v_mfma_f32_16x16x32_bf16 v[136:139], a[152:155], v[80:83], v[136:139]
ds_read_b128 a[192:195], v2 offset:12288
v_mfma_f32_16x16x32_bf16 v[136:139], a[148:151], v[76:79], v[136:139]
ds_read_b128 a[196:199], v2 offset:13312
v_mfma_f32_16x16x32_bf16 v[136:139], a[144:147], v[72:75], v[136:139]
s_waitcnt lgkmcnt(4)
v_mfma_f32_16x16x32_bf16 v[140:143], a[160:163], v[72:75], v[228:231]
ds_read_b128 a[200:203], v2 offset:14336
v_accvgpr_read_b32 v240, a24
v_mfma_f32_16x16x32_bf16 v[140:143], a[164:167], v[76:79], v[140:143]
ds_read_b128 a[204:207], v2 offset:15360
v_accvgpr_read_b32 v241, a25
v_mfma_f32_16x16x32_bf16 v[140:143], a[168:171], v[80:83], v[140:143]
v_exp_f32 v120, v120
v_mfma_f32_16x16x32_bf16 v[140:143], a[172:175], v[84:87], v[140:143]
v_exp_f32 v121, v121
v_mfma_f32_16x16x32_bf16 v[124:127], a[172:175], v[68:71], v[224:227]
v_exp_f32 v122, v122
v_mfma_f32_16x16x32_bf16 v[124:127], a[168:171], v[64:67], v[124:127]
buffer_load_dwordx4 v16, s[32:35], s70 offen offset:3072 sc1 lds
v_mfma_f32_16x16x32_bf16 v[124:127], a[164:167], v[60:63], v[124:127]
v_exp_f32 v123, v123
v_mfma_f32_16x16x32_bf16 v[124:127], a[160:163], v[56:59], v[124:127]
v_exp_f32 v136, v136
v_mfma_f32_16x16x32_bf16 v[128:131], a[176:179], v[56:59], v[224:227]
v_exp_f32 v137, v137
v_mfma_f32_16x16x32_bf16 v[128:131], a[180:183], v[60:63], v[128:131]
s_waitcnt lgkmcnt(0)
v_exp_f32 v138, v138
v_mfma_f32_16x16x32_bf16 v[128:131], a[184:187], v[64:67], v[128:131]
v_exp_f32 v139, v139
v_mfma_f32_16x16x32_bf16 v[128:131], a[188:191], v[68:71], v[128:131]
s_add_u32 m0, s71, 4096
ds_read_b128 a[144:147], v3 offset:0
v_cvt_pk_bf16_f32 v184, v120, v121
v_mfma_f32_16x16x32_bf16 v[144:147], a[188:191], v[84:87], v[228:231]
s_add_u32 s64, s70, 4096
ds_read_b128 a[148:151], v3 offset:8192
v_cvt_pk_bf16_f32 v185, v122, v123
v_mfma_f32_16x16x32_bf16 v[144:147], a[184:187], v[80:83], v[144:147]
buffer_load_dwordx4 v16, s[32:35], s64 offen offset:0 sc1 lds
v_mfma_f32_16x16x32_bf16 v[144:147], a[180:183], v[76:79], v[144:147]
v_exp_f32 v140, v140
v_mfma_f32_16x16x32_bf16 v[144:147], a[176:179], v[72:75], v[144:147]
v_exp_f32 v141, v141
v_mfma_f32_16x16x32_bf16 v[148:151], a[192:195], v[72:75], v[228:231]
v_exp_f32 v142, v142
v_mfma_f32_16x16x32_bf16 v[148:151], a[196:199], v[76:79], v[148:151]
ds_read_b128 a[152:155], v3 offset:1024
v_cvt_pk_bf16_f32 v192, v136, v137
v_mfma_f32_16x16x32_bf16 v[148:151], a[200:203], v[80:83], v[148:151]
ds_read_b128 a[156:159], v3 offset:9216
v_cvt_pk_bf16_f32 v193, v138, v139
v_mfma_f32_16x16x32_bf16 v[148:151], a[204:207], v[84:87], v[148:151]
v_exp_f32 v143, v143
v_mfma_f32_16x16x32_bf16 v[132:135], a[204:207], v[68:71], v[224:227]
v_exp_f32 v124, v124
v_mfma_f32_16x16x32_bf16 v[132:135], a[200:203], v[64:67], v[132:135]
v_exp_f32 v125, v125
v_mfma_f32_16x16x32_bf16 v[132:135], a[196:199], v[60:63], v[132:135]
buffer_load_dwordx4 v16, s[32:35], s64 offen offset:1024 sc1 lds
v_mfma_f32_16x16x32_bf16 v[132:135], a[192:195], v[56:59], v[132:135]
ds_read_b128 a[160:163], v3 offset:2048
v_cvt_pk_bf16_f32 v194, v140, v141
v_smfmac_f32_16x16x64_bf16 a[132:135], a[240:243], v[176:183], v5
ds_read_b128 a[164:167], v3 offset:10240
v_smfmac_f32_16x16x64_bf16 a[136:139], a[240:243], v[200:207], v5
ds_read_b128 a[168:171], v3 offset:3072
v_accvgpr_read_b32 v242, a26
v_smfmac_f32_16x16x64_bf16 a[140:143], a[240:243], v[208:215], v5
s_waitcnt lgkmcnt(3)
ds_read_b128 a[172:175], v3 offset:11264
v_accvgpr_read_b32 v243, a27
v_mfma_f32_16x16x32_bf16 a[32:35], a[144:147], v[176:179], a[32:35]
ds_read_b128 a[176:179], v3 offset:4096
v_accvgpr_read_b32 v244, a28
v_mfma_f32_16x16x32_bf16 a[32:35], a[148:151], v[180:183], a[32:35]
ds_read_b128 a[180:183], v3 offset:12288
v_accvgpr_read_b32 v245, a29
v_mfma_f32_16x16x32_bf16 a[64:67], a[148:151], v[204:207], a[64:67]
ds_read_b128 a[184:187], v3 offset:5120
v_accvgpr_read_b32 v246, a30
v_mfma_f32_16x16x32_bf16 a[64:67], a[144:147], v[200:203], a[64:67]
ds_read_b128 a[188:191], v3 offset:13312
v_accvgpr_read_b32 v247, a31
v_mfma_f32_16x16x32_bf16 a[96:99], a[144:147], v[208:211], a[96:99]
ds_read_b128 a[192:195], v3 offset:6144
v_mul_f32 v240, v240, v20
v_mfma_f32_16x16x32_bf16 a[96:99], a[148:151], v[212:215], a[96:99]
ds_read_b128 a[196:199], v3 offset:14336
v_mul_f32 v241, v241, v20
v_mfma_f32_16x16x32_bf16 a[100:103], a[156:159], v[212:215], a[100:103]
ds_read_b128 a[200:203], v3 offset:7168
v_mul_f32 v242, v242, v20
v_mfma_f32_16x16x32_bf16 a[100:103], a[152:155], v[208:211], a[100:103]
ds_read_b128 a[204:207], v3 offset:15360
v_mul_f32 v243, v243, v20
v_mul_f32 v244, v244, v20
v_mul_f32 v245, v245, v20
v_mul_f32 v246, v246, v20
v_mul_f32 v247, v247, v20
v_cvt_pk_bf16_f32 v240, v240, v241
v_cvt_pk_bf16_f32 v241, v242, v243
v_cvt_pk_bf16_f32 v242, v244, v245
v_cvt_pk_bf16_f32 v243, v246, v247
s_add_u32 s77, s74, 24576
buffer_store_dwordx4 v[240:243], v16, s[44:47], s77 offen sc1
v_exp_f32 v126, v126
v_mfma_f32_16x16x32_bf16 a[68:71], a[152:155], v[200:203], a[68:71]
buffer_load_dwordx4 v16, s[32:35], s64 offen offset:2048 sc1 lds
v_cvt_pk_bf16_f32 v195, v142, v143
v_mfma_f32_16x16x32_bf16 a[68:71], a[156:159], v[204:207], a[68:71]
v_exp_f32 v127, v127
v_mfma_f32_16x16x32_bf16 a[36:39], a[156:159], v[180:183], a[36:39]
v_exp_f32 v128, v128
v_mfma_f32_16x16x32_bf16 a[36:39], a[152:155], v[176:179], a[36:39]
s_waitcnt lgkmcnt(2)
v_exp_f32 v129, v129
v_mfma_f32_16x16x32_bf16 a[40:43], a[160:163], v[176:179], a[40:43]
v_cvt_pk_bf16_f32 v186, v124, v125
v_cvt_pk_bf16_f32 v187, v126, v127
v_mfma_f32_16x16x32_bf16 a[40:43], a[164:167], v[180:183], a[40:43]
v_exp_f32 v130, v130
v_mfma_f32_16x16x32_bf16 a[72:75], a[164:167], v[204:207], a[72:75]
buffer_load_dwordx4 v16, s[32:35], s64 offen offset:3072 sc1 lds
v_mfma_f32_16x16x32_bf16 a[72:75], a[160:163], v[200:203], a[72:75]
v_exp_f32 v131, v131
v_mfma_f32_16x16x32_bf16 a[104:107], a[160:163], v[208:211], a[104:107]
v_exp_f32 v144, v144
v_mfma_f32_16x16x32_bf16 a[104:107], a[164:167], v[212:215], a[104:107]
v_exp_f32 v145, v145
v_mfma_f32_16x16x32_bf16 a[108:111], a[172:175], v[212:215], a[108:111]
v_exp_f32 v146, v146
v_mfma_f32_16x16x32_bf16 a[108:111], a[168:171], v[208:211], a[108:111]
v_exp_f32 v147, v147
v_mfma_f32_16x16x32_bf16 a[76:79], a[168:171], v[200:203], a[76:79]
v_exp_f32 v148, v148
v_mfma_f32_16x16x32_bf16 a[76:79], a[172:175], v[204:207], a[76:79]
v_exp_f32 v149, v149
v_mfma_f32_16x16x32_bf16 a[44:47], a[172:175], v[180:183], a[44:47]
v_cvt_pk_bf16_f32 v188, v128, v129
v_cvt_pk_bf16_f32 v189, v130, v131
v_mfma_f32_16x16x32_bf16 a[44:47], a[168:171], v[176:179], a[44:47]
v_exp_f32 v150, v150
v_mfma_f32_16x16x32_bf16 a[48:51], a[176:179], v[176:179], a[48:51]
v_exp_f32 v151, v151
v_mfma_f32_16x16x32_bf16 a[48:51], a[180:183], v[180:183], a[48:51]
v_exp_f32 v132, v132
v_mfma_f32_16x16x32_bf16 a[80:83], a[180:183], v[204:207], a[80:83]
s_waitcnt vmcnt(9)
s_barrier
v_mfma_f32_16x16x32_bf16 a[80:83], a[176:179], v[200:203], a[80:83]
s_xor_b32 s71, s71, 16384
v_exp_f32 v133, v133
v_mfma_f32_16x16x32_bf16 a[112:115], a[176:179], v[208:211], a[112:115]
s_add_u32 s70, s70, 32768
ds_read_b128 a[144:147], v2 offset:16384
v_cvt_pk_bf16_f32 v196, v144, v145
v_mfma_f32_16x16x32_bf16 a[112:115], a[180:183], v[212:215], a[112:115]
s_mov_b32 m0, s71
v_exp_f32 v134, v134
v_mfma_f32_16x16x32_bf16 a[116:119], a[188:191], v[212:215], a[116:119]
buffer_load_dwordx4 v16, s[32:35], s70 offen offset:0 sc1 lds
v_mfma_f32_16x16x32_bf16 a[116:119], a[184:187], v[208:211], a[116:119]
ds_read_b128 a[148:151], v2 offset:17408
v_cvt_pk_bf16_f32 v197, v146, v147
v_mfma_f32_16x16x32_bf16 a[84:87], a[184:187], v[200:203], a[84:87]
ds_read_b128 a[152:155], v2 offset:18432
v_cvt_pk_bf16_f32 v198, v148, v149
v_mfma_f32_16x16x32_bf16 a[84:87], a[188:191], v[204:207], a[84:87]
ds_read_b128 a[156:159], v2 offset:19456
v_cvt_pk_bf16_f32 v199, v150, v151
v_mfma_f32_16x16x32_bf16 a[52:55], a[188:191], v[180:183], a[52:55]
v_exp_f32 v135, v135
v_mfma_f32_16x16x32_bf16 a[52:55], a[184:187], v[176:179], a[52:55]
ds_read_b128 a[160:163], v2 offset:20480
v_cvt_pk_bf16_f32 v190, v132, v133
v_mfma_f32_16x16x32_bf16 a[56:59], a[192:195], v[176:179], a[56:59]
ds_read_b128 a[164:167], v2 offset:21504
v_cvt_pk_bf16_f32 v191, v134, v135
v_mfma_f32_16x16x32_bf16 a[56:59], a[196:199], v[180:183], a[56:59]
ds_read_b128 a[168:171], v2 offset:22528
v_accvgpr_read_b32 v21, a132
v_mfma_f32_16x16x32_bf16 a[88:91], a[196:199], v[204:207], a[88:91]
ds_read_b128 a[172:175], v2 offset:23552
v_accvgpr_read_b32 v248, a133
v_mfma_f32_16x16x32_bf16 a[88:91], a[192:195], v[200:203], a[88:91]
buffer_load_dwordx4 v16, s[32:35], s70 offen offset:1024 sc1 lds
v_mfma_f32_16x16x32_bf16 a[120:123], a[192:195], v[208:211], a[120:123]
v_add_f32 v21, v21, v248
v_max_f32 v1, v1, v21
v_mfma_f32_16x16x32_bf16 a[120:123], a[196:199], v[212:215], a[120:123]
s_waitcnt lgkmcnt(3)
v_rcp_f32 v21, v21
v_mfma_f32_16x16x32_bf16 a[124:127], a[204:207], v[212:215], a[124:127]
v_accvgpr_read_b32 v232, a32
v_accvgpr_read_b32 v233, a33
v_mfma_f32_16x16x32_bf16 a[124:127], a[200:203], v[208:211], a[124:127]
v_accvgpr_read_b32 v234, a34
v_accvgpr_read_b32 v235, a35
v_mfma_f32_16x16x32_bf16 a[92:95], a[200:203], v[200:203], a[92:95]
v_accvgpr_read_b32 v236, a36
v_accvgpr_read_b32 v237, a37
v_mfma_f32_16x16x32_bf16 a[92:95], a[204:207], v[204:207], a[92:95]
v_accvgpr_read_b32 v238, a38
v_accvgpr_read_b32 v239, a39
v_mfma_f32_16x16x32_bf16 a[60:63], a[204:207], v[180:183], a[60:63]
v_mul_f32 v21, v21, v6
v_mul_f32 v232, v232, v21
v_mfma_f32_16x16x32_bf16 a[60:63], a[200:203], v[176:179], a[60:63]
v_mul_f32 v233, v233, v21
v_mul_f32 v234, v234, v21
v_mfma_f32_16x16x32_bf16 v[120:123], a[144:147], v[56:59], v[224:227]
ds_read_b128 a[176:179], v2 offset:24576
ds_read_b128 a[180:183], v2 offset:25600
v_mfma_f32_16x16x32_bf16 v[120:123], a[148:151], v[60:63], v[120:123]
buffer_load_dwordx4 v16, s[32:35], s70 offen offset:2048 sc1 lds
v_mfma_f32_16x16x32_bf16 v[120:123], a[152:155], v[64:67], v[120:123]
s_add_u32 s64, s70, 4096
ds_read_b128 a[184:187], v2 offset:26624
ds_read_b128 a[188:191], v2 offset:27648
v_mfma_f32_16x16x32_bf16 v[120:123], a[156:159], v[68:71], v[120:123]
buffer_load_dwordx4 v16, s[32:35], s70 offen offset:3072 sc1 lds
v_mfma_f32_16x16x32_bf16 v[136:139], a[156:159], v[84:87], v[228:231]
s_add_u32 m0, s71, 4096
ds_read_b128 a[192:195], v2 offset:28672
ds_read_b128 a[196:199], v2 offset:29696
v_mfma_f32_16x16x32_bf16 v[136:139], a[152:155], v[80:83], v[136:139]
buffer_load_dwordx4 v16, s[32:35], s64 offen offset:0 sc1 lds
v_mfma_f32_16x16x32_bf16 v[136:139], a[148:151], v[76:79], v[136:139]
ds_read_b128 a[200:203], v2 offset:30720
ds_read_b128 a[204:207], v2 offset:31744
v_mfma_f32_16x16x32_bf16 v[136:139], a[144:147], v[72:75], v[136:139]
v_exp_f32 v120, v120
v_mfma_f32_16x16x32_bf16 v[140:143], a[160:163], v[72:75], v[228:231]
s_waitcnt lgkmcnt(4)
v_exp_f32 v121, v121
v_mfma_f32_16x16x32_bf16 v[140:143], a[164:167], v[76:79], v[140:143]
v_exp_f32 v122, v122
v_mfma_f32_16x16x32_bf16 v[140:143], a[168:171], v[80:83], v[140:143]
v_mul_f32 v235, v235, v21
v_mul_f32 v236, v236, v21
v_mul_f32 v237, v237, v21
v_mul_f32 v238, v238, v21
v_mul_f32 v239, v239, v21
v_cvt_pk_bf16_f32 v232, v232, v233
v_cvt_pk_bf16_f32 v233, v234, v235
v_cvt_pk_bf16_f32 v234, v236, v237
v_cvt_pk_bf16_f32 v235, v238, v239
s_add_u32 s77, s74, 4096
buffer_store_dwordx4 v[232:235], v16, s[44:47], s77 offen sc1
v_accvgpr_read_b32 v240, a40
v_accvgpr_read_b32 v241, a41
v_accvgpr_read_b32 v242, a42
v_accvgpr_read_b32 v243, a43
v_accvgpr_read_b32 v244, a44
v_accvgpr_read_b32 v245, a45
v_accvgpr_read_b32 v246, a46
v_accvgpr_read_b32 v247, a47
v_mul_f32 v240, v240, v21
v_mul_f32 v241, v241, v21
v_mul_f32 v242, v242, v21
v_mul_f32 v243, v243, v21
v_mul_f32 v244, v244, v21
v_mul_f32 v245, v245, v21
v_mul_f32 v246, v246, v21
v_mul_f32 v247, v247, v21
v_cvt_pk_bf16_f32 v240, v240, v241
v_cvt_pk_bf16_f32 v241, v242, v243
v_cvt_pk_bf16_f32 v242, v244, v245
v_cvt_pk_bf16_f32 v243, v246, v247
s_add_u32 s77, s74, 12288
buffer_store_dwordx4 v[240:243], v16, s[44:47], s77 offen sc1
v_accvgpr_read_b32 v232, a48
v_accvgpr_read_b32 v233, a49
v_accvgpr_read_b32 v234, a50
v_accvgpr_read_b32 v235, a51
v_accvgpr_read_b32 v236, a52
v_accvgpr_read_b32 v237, a53
v_accvgpr_read_b32 v238, a54
v_accvgpr_read_b32 v239, a55
v_mul_f32 v232, v232, v21
v_mul_f32 v233, v233, v21
v_mul_f32 v234, v234, v21
v_mul_f32 v235, v235, v21
v_mul_f32 v236, v236, v21
v_mul_f32 v237, v237, v21
v_mul_f32 v238, v238, v21
v_mul_f32 v239, v239, v21
v_cvt_pk_bf16_f32 v232, v232, v233
v_cvt_pk_bf16_f32 v233, v234, v235
v_cvt_pk_bf16_f32 v234, v236, v237
v_cvt_pk_bf16_f32 v235, v238, v239
s_add_u32 s77, s74, 20480
buffer_store_dwordx4 v[232:235], v16, s[44:47], s77 offen sc1
v_accvgpr_read_b32 v240, a56
v_accvgpr_read_b32 v241, a57
v_accvgpr_read_b32 v242, a58
v_accvgpr_read_b32 v243, a59
v_accvgpr_read_b32 v244, a60
v_accvgpr_read_b32 v245, a61
v_accvgpr_read_b32 v246, a62
v_accvgpr_read_b32 v247, a63
v_mul_f32 v240, v240, v21
v_mul_f32 v241, v241, v21
v_mul_f32 v242, v242, v21
v_mul_f32 v243, v243, v21
v_mul_f32 v244, v244, v21
v_mul_f32 v245, v245, v21
v_mul_f32 v246, v246, v21
v_mul_f32 v247, v247, v21
v_cvt_pk_bf16_f32 v240, v240, v241
v_cvt_pk_bf16_f32 v241, v242, v243
v_cvt_pk_bf16_f32 v242, v244, v245
v_cvt_pk_bf16_f32 v243, v246, v247
s_add_u32 s77, s74, 28672
buffer_store_dwordx4 v[240:243], v16, s[44:47], s77 offen sc1
v_exp_f32 v123, v123
v_mfma_f32_16x16x32_bf16 v[140:143], a[172:175], v[84:87], v[140:143]
v_exp_f32 v136, v136
v_mfma_f32_16x16x32_bf16 v[124:127], a[172:175], v[68:71], v[224:227]
ds_read_b128 a[144:147], v3 offset:16384
v_cvt_pk_bf16_f32 v200, v120, v121
v_mfma_f32_16x16x32_bf16 v[124:127], a[168:171], v[64:67], v[124:127]
v_exp_f32 v137, v137
v_mfma_f32_16x16x32_bf16 v[124:127], a[164:167], v[60:63], v[124:127]
ds_read_b128 a[148:151], v3 offset:24576
v_cvt_pk_bf16_f32 v201, v122, v123
v_mfma_f32_16x16x32_bf16 v[124:127], a[160:163], v[56:59], v[124:127]
v_exp_f32 v138, v138
v_mfma_f32_16x16x32_bf16 v[128:131], a[176:179], v[56:59], v[224:227]
ds_read_b128 a[152:155], v3 offset:17408
v_cvt_pk_bf16_f32 v208, v136, v137
v_mfma_f32_16x16x32_bf16 v[128:131], a[180:183], v[60:63], v[128:131]
v_exp_f32 v139, v139
v_mfma_f32_16x16x32_bf16 v[128:131], a[184:187], v[64:67], v[128:131]
ds_read_b128 a[156:159], v3 offset:25600
v_cvt_pk_bf16_f32 v209, v138, v139
v_mfma_f32_16x16x32_bf16 v[128:131], a[188:191], v[68:71], v[128:131]
v_exp_f32 v140, v140
v_mfma_f32_16x16x32_bf16 v[144:147], a[188:191], v[84:87], v[228:231]
buffer_load_dwordx4 v16, s[32:35], s64 offen offset:1024 sc1 lds
v_mfma_f32_16x16x32_bf16 v[144:147], a[184:187], v[80:83], v[144:147]
v_exp_f32 v141, v141
v_mfma_f32_16x16x32_bf16 v[144:147], a[180:183], v[76:79], v[144:147]
ds_read_b128 a[160:163], v3 offset:18432
v_cvt_pk_bf16_f32 v210, v140, v141
v_mfma_f32_16x16x32_bf16 v[144:147], a[176:179], v[72:75], v[144:147]
s_waitcnt lgkmcnt(2)
v_exp_f32 v142, v142
v_mfma_f32_16x16x32_bf16 v[148:151], a[192:195], v[72:75], v[228:231]
ds_read_b128 a[164:167], v3 offset:26624
ds_read_b128 a[168:171], v3 offset:19456
v_mfma_f32_16x16x32_bf16 v[148:151], a[196:199], v[76:79], v[148:151]
v_exp_f32 v143, v143
v_mfma_f32_16x16x32_bf16 v[148:151], a[200:203], v[80:83], v[148:151]
ds_read_b128 a[172:175], v3 offset:27648
v_cvt_pk_bf16_f32 v211, v142, v143
v_mfma_f32_16x16x32_bf16 v[148:151], a[204:207], v[84:87], v[148:151]
v_exp_f32 v124, v124
v_mfma_f32_16x16x32_bf16 v[132:135], a[204:207], v[68:71], v[224:227]
ds_read_b128 a[176:179], v3 offset:20480
buffer_load_dwordx4 v16, s[32:35], s64 offen offset:2048 sc1 lds
v_mfma_f32_16x16x32_bf16 v[132:135], a[200:203], v[64:67], v[132:135]
v_exp_f32 v125, v125
v_mfma_f32_16x16x32_bf16 v[132:135], a[196:199], v[60:63], v[132:135]
ds_read_b128 a[180:183], v3 offset:28672
v_cvt_pk_bf16_f32 v202, v124, v125
v_mfma_f32_16x16x32_bf16 v[132:135], a[192:195], v[56:59], v[132:135]
v_exp_f32 v126, v126
v_smfmac_f32_16x16x64_bf16 a[136:139], a[240:243], v[184:191], v5
ds_read_b128 a[184:187], v3 offset:21504
v_smfmac_f32_16x16x64_bf16 a[140:143], a[240:243], v[192:199], v5
ds_read_b128 a[188:191], v3 offset:29696
v_mfma_f32_16x16x32_bf16 a[64:67], a[144:147], v[184:187], a[64:67]
v_exp_f32 v127, v127
v_mfma_f32_16x16x32_bf16 a[64:67], a[148:151], v[188:191], a[64:67]
v_exp_f32 v128, v128
v_mfma_f32_16x16x32_bf16 a[96:99], a[148:151], v[196:199], a[96:99]
v_exp_f32 v129, v129
v_mfma_f32_16x16x32_bf16 a[96:99], a[144:147], v[192:195], a[96:99]
ds_read_b128 a[192:195], v3 offset:22528
v_cvt_pk_bf16_f32 v203, v126, v127
v_mfma_f32_16x16x32_bf16 a[100:103], a[152:155], v[192:195], a[100:103]
s_waitcnt lgkmcnt(2)
v_exp_f32 v130, v130
v_mfma_f32_16x16x32_bf16 a[100:103], a[156:159], v[196:199], a[100:103]
ds_read_b128 a[196:199], v3 offset:30720
v_cvt_pk_bf16_f32 v204, v128, v129
v_mfma_f32_16x16x32_bf16 a[68:71], a[156:159], v[188:191], a[68:71]
v_exp_f32 v131, v131
v_mfma_f32_16x16x32_bf16 a[68:71], a[152:155], v[184:187], a[68:71]
ds_read_b128 a[200:203], v3 offset:23552
v_cvt_pk_bf16_f32 v205, v130, v131
v_mfma_f32_16x16x32_bf16 a[72:75], a[160:163], v[184:187], a[72:75]
v_exp_f32 v144, v144
v_mfma_f32_16x16x32_bf16 a[72:75], a[164:167], v[188:191], a[72:75]
buffer_load_dwordx4 v16, s[32:35], s64 offen offset:3072 sc1 lds
v_mfma_f32_16x16x32_bf16 a[104:107], a[164:167], v[196:199], a[104:107]
s_xor_b32 s71, s71, 49152
v_exp_f32 v145, v145
v_mfma_f32_16x16x32_bf16 a[104:107], a[160:163], v[192:195], a[104:107]
ds_read_b128 a[204:207], v3 offset:31744
v_cvt_pk_bf16_f32 v212, v144, v145
v_mfma_f32_16x16x32_bf16 a[108:111], a[168:171], v[192:195], a[108:111]
s_add_u32 s70, s70, 32768
v_xor_b32 v2, 0x8000, v2
v_exp_f32 v146, v146
v_mfma_f32_16x16x32_bf16 a[108:111], a[172:175], v[196:199], a[108:111]
s_waitcnt vmcnt(12)
s_barrier
v_mfma_f32_16x16x32_bf16 a[76:79], a[172:175], v[188:191], a[76:79]
s_mov_b32 m0, s71
v_exp_f32 v147, v147
v_mfma_f32_16x16x32_bf16 a[76:79], a[168:171], v[184:187], a[76:79]
ds_read_b128 a[144:147], v2 offset:0
v_cvt_pk_bf16_f32 v213, v146, v147
v_mfma_f32_16x16x32_bf16 a[80:83], a[176:179], v[184:187], a[80:83]
v_exp_f32 v148, v148
v_mfma_f32_16x16x32_bf16 a[80:83], a[180:183], v[188:191], a[80:83]
ds_read_b128 a[148:151], v2 offset:1024
ds_read_b128 a[152:155], v2 offset:2048
v_mfma_f32_16x16x32_bf16 a[112:115], a[180:183], v[196:199], a[112:115]
v_exp_f32 v149, v149
v_mfma_f32_16x16x32_bf16 a[112:115], a[176:179], v[192:195], a[112:115]
ds_read_b128 a[156:159], v2 offset:3072
v_cvt_pk_bf16_f32 v214, v148, v149
v_mfma_f32_16x16x32_bf16 a[116:119], a[184:187], v[192:195], a[116:119]
s_waitcnt lgkmcnt(4)
v_exp_f32 v150, v150
v_mfma_f32_16x16x32_bf16 a[116:119], a[188:191], v[196:199], a[116:119]
buffer_load_dwordx4 v16, s[32:35], s70 offen offset:0 sc1 lds
v_mfma_f32_16x16x32_bf16 a[84:87], a[188:191], v[188:191], a[84:87]
v_exp_f32 v151, v151
v_mfma_f32_16x16x32_bf16 a[84:87], a[184:187], v[184:187], a[84:87]
ds_read_b128 a[160:163], v2 offset:4096
v_cvt_pk_bf16_f32 v215, v150, v151
v_mfma_f32_16x16x32_bf16 a[88:91], a[192:195], v[184:187], a[88:91]
v_exp_f32 v132, v132
v_mfma_f32_16x16x32_bf16 a[88:91], a[196:199], v[188:191], a[88:91]
ds_read_b128 a[164:167], v2 offset:5120
v_xor_b32 v3, 0x8000, v3
v_mfma_f32_16x16x32_bf16 a[120:123], a[196:199], v[196:199], a[120:123]
v_exp_f32 v133, v133
v_mfma_f32_16x16x32_bf16 a[120:123], a[192:195], v[192:195], a[120:123]
ds_read_b128 a[168:171], v2 offset:6144
v_cvt_pk_bf16_f32 v206, v132, v133
v_mfma_f32_16x16x32_bf16 a[124:127], a[200:203], v[192:195], a[124:127]
v_exp_f32 v134, v134
v_mfma_f32_16x16x32_bf16 a[124:127], a[204:207], v[196:199], a[124:127]
buffer_load_dwordx4 v16, s[32:35], s70 offen offset:1024 sc1 lds
v_mfma_f32_16x16x32_bf16 a[92:95], a[204:207], v[188:191], a[92:95]
v_exp_f32 v135, v135
v_mfma_f32_16x16x32_bf16 a[92:95], a[200:203], v[184:187], a[92:95]
ds_read_b128 a[172:175], v2 offset:7168
v_cvt_pk_bf16_f32 v207, v134, v135
s_lshl_b32 s72, s3, 1
s_sub_u32 s72, 13, s72
.p2align 3
L_S:
s_waitcnt lgkmcnt(7)
v_mfma_f32_16x16x32_bf16 v[120:123], a[144:147], v[56:59], v[224:227]
s_waitcnt lgkmcnt(6)
ds_read_b128 a[176:179], v2 offset:8192
ds_read_b128 a[180:183], v2 offset:9216
v_mfma_f32_16x16x32_bf16 v[120:123], a[148:151], v[60:63], v[120:123]
s_waitcnt lgkmcnt(7)
buffer_load_dwordx4 v16, s[32:35], s70 offen offset:2048 sc1 lds
v_mfma_f32_16x16x32_bf16 v[120:123], a[152:155], v[64:67], v[120:123]
s_waitcnt lgkmcnt(6)
s_add_u32 s64, s70, 4096
ds_read_b128 a[184:187], v2 offset:10240
ds_read_b128 a[188:191], v2 offset:11264
v_mfma_f32_16x16x32_bf16 v[120:123], a[156:159], v[68:71], v[120:123]
buffer_load_dwordx4 v16, s[32:35], s70 offen offset:3072 sc1 lds
v_mfma_f32_16x16x32_bf16 v[136:139], a[156:159], v[84:87], v[228:231]
s_add_u32 m0, s71, 4096
ds_read_b128 a[192:195], v2 offset:12288
ds_read_b128 a[196:199], v2 offset:13312
v_mfma_f32_16x16x32_bf16 v[136:139], a[152:155], v[80:83], v[136:139]
buffer_load_dwordx4 v16, s[32:35], s64 offen offset:0 sc1 lds
v_mfma_f32_16x16x32_bf16 v[136:139], a[148:151], v[76:79], v[136:139]
ds_read_b128 a[200:203], v2 offset:14336
ds_read_b128 a[204:207], v2 offset:15360
v_mfma_f32_16x16x32_bf16 v[136:139], a[144:147], v[72:75], v[136:139]
s_waitcnt lgkmcnt(6)
v_exp_f32 v120, v120
v_mfma_f32_16x16x32_bf16 v[140:143], a[160:163], v[72:75], v[228:231]
v_exp_f32 v121, v121
v_mfma_f32_16x16x32_bf16 v[140:143], a[164:167], v[76:79], v[140:143]
v_exp_f32 v122, v122
v_mfma_f32_16x16x32_bf16 v[140:143], a[168:171], v[80:83], v[140:143]
v_exp_f32 v123, v123
v_mfma_f32_16x16x32_bf16 v[140:143], a[172:175], v[84:87], v[140:143]
v_exp_f32 v136, v136
v_mfma_f32_16x16x32_bf16 v[124:127], a[172:175], v[68:71], v[224:227]
ds_read_b128 a[144:147], v3 offset:0
v_cvt_pk_bf16_f32 v184, v120, v121
v_mfma_f32_16x16x32_bf16 v[124:127], a[168:171], v[64:67], v[124:127]
v_exp_f32 v137, v137
v_mfma_f32_16x16x32_bf16 v[124:127], a[164:167], v[60:63], v[124:127]
ds_read_b128 a[148:151], v3 offset:8192
v_cvt_pk_bf16_f32 v185, v122, v123
v_mfma_f32_16x16x32_bf16 v[124:127], a[160:163], v[56:59], v[124:127]
v_exp_f32 v138, v138
v_mfma_f32_16x16x32_bf16 v[128:131], a[176:179], v[56:59], v[224:227]
ds_read_b128 a[152:155], v3 offset:1024
v_cvt_pk_bf16_f32 v192, v136, v137
v_mfma_f32_16x16x32_bf16 v[128:131], a[180:183], v[60:63], v[128:131]
s_waitcnt lgkmcnt(3)
v_exp_f32 v139, v139
v_mfma_f32_16x16x32_bf16 v[128:131], a[184:187], v[64:67], v[128:131]
ds_read_b128 a[156:159], v3 offset:9216
v_cvt_pk_bf16_f32 v193, v138, v139
v_mfma_f32_16x16x32_bf16 v[128:131], a[188:191], v[68:71], v[128:131]
v_exp_f32 v140, v140
v_mfma_f32_16x16x32_bf16 v[144:147], a[188:191], v[84:87], v[228:231]
buffer_load_dwordx4 v16, s[32:35], s64 offen offset:1024 sc1 lds
v_mfma_f32_16x16x32_bf16 v[144:147], a[184:187], v[80:83], v[144:147]
v_exp_f32 v141, v141
v_mfma_f32_16x16x32_bf16 v[144:147], a[180:183], v[76:79], v[144:147]
ds_read_b128 a[160:163], v3 offset:2048
v_cvt_pk_bf16_f32 v194, v140, v141
v_mfma_f32_16x16x32_bf16 v[144:147], a[176:179], v[72:75], v[144:147]
v_exp_f32 v142, v142
v_mfma_f32_16x16x32_bf16 v[148:151], a[192:195], v[72:75], v[228:231]
ds_read_b128 a[164:167], v3 offset:10240
ds_read_b128 a[168:171], v3 offset:3072
v_mfma_f32_16x16x32_bf16 v[148:151], a[196:199], v[76:79], v[148:151]
v_exp_f32 v143, v143
v_mfma_f32_16x16x32_bf16 v[148:151], a[200:203], v[80:83], v[148:151]
ds_read_b128 a[172:175], v3 offset:11264
v_cvt_pk_bf16_f32 v195, v142, v143
v_mfma_f32_16x16x32_bf16 v[148:151], a[204:207], v[84:87], v[148:151]
v_exp_f32 v124, v124
v_mfma_f32_16x16x32_bf16 v[132:135], a[204:207], v[68:71], v[224:227]
ds_read_b128 a[176:179], v3 offset:4096
buffer_load_dwordx4 v16, s[32:35], s64 offen offset:2048 sc1 lds
v_mfma_f32_16x16x32_bf16 v[132:135], a[200:203], v[64:67], v[132:135]
v_exp_f32 v125, v125
v_mfma_f32_16x16x32_bf16 v[132:135], a[196:199], v[60:63], v[132:135]
ds_read_b128 a[180:183], v3 offset:12288
v_cvt_pk_bf16_f32 v186, v124, v125
v_mfma_f32_16x16x32_bf16 v[132:135], a[192:195], v[56:59], v[132:135]
v_exp_f32 v126, v126
v_smfmac_f32_16x16x64_bf16 a[136:139], a[240:243], v[200:207], v5
ds_read_b128 a[184:187], v3 offset:5120
v_smfmac_f32_16x16x64_bf16 a[140:143], a[240:243], v[208:215], v5
s_waitcnt lgkmcnt(3)
ds_read_b128 a[188:191], v3 offset:13312
v_mfma_f32_16x16x32_bf16 a[64:67], a[144:147], v[200:203], a[64:67]
v_exp_f32 v127, v127
v_mfma_f32_16x16x32_bf16 a[64:67], a[148:151], v[204:207], a[64:67]
v_exp_f32 v128, v128
v_mfma_f32_16x16x32_bf16 a[96:99], a[148:151], v[212:215], a[96:99]
v_exp_f32 v129, v129
v_mfma_f32_16x16x32_bf16 a[96:99], a[144:147], v[208:211], a[96:99]
ds_read_b128 a[192:195], v3 offset:6144
v_cvt_pk_bf16_f32 v187, v126, v127
v_mfma_f32_16x16x32_bf16 a[100:103], a[152:155], v[208:211], a[100:103]
v_exp_f32 v130, v130
v_mfma_f32_16x16x32_bf16 a[100:103], a[156:159], v[212:215], a[100:103]
ds_read_b128 a[196:199], v3 offset:14336
v_cvt_pk_bf16_f32 v188, v128, v129
v_mfma_f32_16x16x32_bf16 a[68:71], a[156:159], v[204:207], a[68:71]
v_exp_f32 v131, v131
v_mfma_f32_16x16x32_bf16 a[68:71], a[152:155], v[200:203], a[68:71]
ds_read_b128 a[200:203], v3 offset:7168
v_cvt_pk_bf16_f32 v189, v130, v131
v_mfma_f32_16x16x32_bf16 a[72:75], a[160:163], v[200:203], a[72:75]
v_exp_f32 v144, v144
v_mfma_f32_16x16x32_bf16 a[72:75], a[164:167], v[204:207], a[72:75]
buffer_load_dwordx4 v16, s[32:35], s64 offen offset:3072 sc1 lds
v_mfma_f32_16x16x32_bf16 a[104:107], a[164:167], v[212:215], a[104:107]
s_xor_b32 s71, s71, 16384
v_exp_f32 v145, v145
v_mfma_f32_16x16x32_bf16 a[104:107], a[160:163], v[208:211], a[104:107]
ds_read_b128 a[204:207], v3 offset:15360
v_cvt_pk_bf16_f32 v196, v144, v145
v_mfma_f32_16x16x32_bf16 a[108:111], a[168:171], v[208:211], a[108:111]
s_add_u32 s70, s70, 32768
v_exp_f32 v146, v146
v_mfma_f32_16x16x32_bf16 a[108:111], a[172:175], v[212:215], a[108:111]
s_waitcnt vmcnt(8)
s_barrier
v_mfma_f32_16x16x32_bf16 a[76:79], a[172:175], v[204:207], a[76:79]
s_mov_b32 m0, s71
v_exp_f32 v147, v147
v_mfma_f32_16x16x32_bf16 a[76:79], a[168:171], v[200:203], a[76:79]
s_waitcnt lgkmcnt(1)
ds_read_b128 a[144:147], v2 offset:16384
v_cvt_pk_bf16_f32 v197, v146, v147
v_mfma_f32_16x16x32_bf16 a[80:83], a[176:179], v[200:203], a[80:83]
v_exp_f32 v148, v148
v_mfma_f32_16x16x32_bf16 a[80:83], a[180:183], v[204:207], a[80:83]
ds_read_b128 a[148:151], v2 offset:17408
ds_read_b128 a[152:155], v2 offset:18432
v_mfma_f32_16x16x32_bf16 a[112:115], a[180:183], v[212:215], a[112:115]
v_exp_f32 v149, v149
v_mfma_f32_16x16x32_bf16 a[112:115], a[176:179], v[208:211], a[112:115]
ds_read_b128 a[156:159], v2 offset:19456
v_cvt_pk_bf16_f32 v198, v148, v149
v_mfma_f32_16x16x32_bf16 a[116:119], a[184:187], v[208:211], a[116:119]
v_exp_f32 v150, v150
v_mfma_f32_16x16x32_bf16 a[116:119], a[188:191], v[212:215], a[116:119]
buffer_load_dwordx4 v16, s[32:35], s70 offen offset:0 sc1 lds
v_mfma_f32_16x16x32_bf16 a[84:87], a[188:191], v[204:207], a[84:87]
v_exp_f32 v151, v151
v_mfma_f32_16x16x32_bf16 a[84:87], a[184:187], v[200:203], a[84:87]
ds_read_b128 a[160:163], v2 offset:20480
v_cvt_pk_bf16_f32 v199, v150, v151
v_mfma_f32_16x16x32_bf16 a[88:91], a[192:195], v[200:203], a[88:91]
v_exp_f32 v132, v132
v_mfma_f32_16x16x32_bf16 a[88:91], a[196:199], v[204:207], a[88:91]
ds_read_b128 a[164:167], v2 offset:21504
v_mfma_f32_16x16x32_bf16 a[120:123], a[196:199], v[212:215], a[120:123]
v_exp_f32 v133, v133
v_mfma_f32_16x16x32_bf16 a[120:123], a[192:195], v[208:211], a[120:123]
ds_read_b128 a[168:171], v2 offset:22528
v_cvt_pk_bf16_f32 v190, v132, v133
v_mfma_f32_16x16x32_bf16 a[124:127], a[200:203], v[208:211], a[124:127]
s_waitcnt lgkmcnt(3)
v_exp_f32 v134, v134
v_mfma_f32_16x16x32_bf16 a[124:127], a[204:207], v[212:215], a[124:127]
buffer_load_dwordx4 v16, s[32:35], s70 offen offset:1024 sc1 lds
v_mfma_f32_16x16x32_bf16 a[92:95], a[204:207], v[204:207], a[92:95]
v_exp_f32 v135, v135
v_mfma_f32_16x16x32_bf16 a[92:95], a[200:203], v[200:203], a[92:95]
ds_read_b128 a[172:175], v2 offset:23552
v_cvt_pk_bf16_f32 v191, v134, v135
v_mfma_f32_16x16x32_bf16 v[120:123], a[144:147], v[56:59], v[224:227]
ds_read_b128 a[176:179], v2 offset:24576
ds_read_b128 a[180:183], v2 offset:25600
v_mfma_f32_16x16x32_bf16 v[120:123], a[148:151], v[60:63], v[120:123]
buffer_load_dwordx4 v16, s[32:35], s70 offen offset:2048 sc1 lds
v_mfma_f32_16x16x32_bf16 v[120:123], a[152:155], v[64:67], v[120:123]
s_add_u32 s64, s70, 4096
ds_read_b128 a[184:187], v2 offset:26624
ds_read_b128 a[188:191], v2 offset:27648
v_mfma_f32_16x16x32_bf16 v[120:123], a[156:159], v[68:71], v[120:123]
buffer_load_dwordx4 v16, s[32:35], s70 offen offset:3072 sc1 lds
v_mfma_f32_16x16x32_bf16 v[136:139], a[156:159], v[84:87], v[228:231]
s_add_u32 m0, s71, 4096
ds_read_b128 a[192:195], v2 offset:28672
ds_read_b128 a[196:199], v2 offset:29696
v_mfma_f32_16x16x32_bf16 v[136:139], a[152:155], v[80:83], v[136:139]
buffer_load_dwordx4 v16, s[32:35], s64 offen offset:0 sc1 lds
v_mfma_f32_16x16x32_bf16 v[136:139], a[148:151], v[76:79], v[136:139]
ds_read_b128 a[200:203], v2 offset:30720
ds_read_b128 a[204:207], v2 offset:31744
v_mfma_f32_16x16x32_bf16 v[136:139], a[144:147], v[72:75], v[136:139]
s_waitcnt lgkmcnt(6)
v_exp_f32 v120, v120
v_mfma_f32_16x16x32_bf16 v[140:143], a[160:163], v[72:75], v[228:231]
v_exp_f32 v121, v121
v_mfma_f32_16x16x32_bf16 v[140:143], a[164:167], v[76:79], v[140:143]
v_exp_f32 v122, v122
v_mfma_f32_16x16x32_bf16 v[140:143], a[168:171], v[80:83], v[140:143]
v_exp_f32 v123, v123
v_mfma_f32_16x16x32_bf16 v[140:143], a[172:175], v[84:87], v[140:143]
v_exp_f32 v136, v136
v_mfma_f32_16x16x32_bf16 v[124:127], a[172:175], v[68:71], v[224:227]
ds_read_b128 a[144:147], v3 offset:16384
v_cvt_pk_bf16_f32 v200, v120, v121
v_mfma_f32_16x16x32_bf16 v[124:127], a[168:171], v[64:67], v[124:127]
v_exp_f32 v137, v137
v_mfma_f32_16x16x32_bf16 v[124:127], a[164:167], v[60:63], v[124:127]
ds_read_b128 a[148:151], v3 offset:24576
v_cvt_pk_bf16_f32 v201, v122, v123
v_mfma_f32_16x16x32_bf16 v[124:127], a[160:163], v[56:59], v[124:127]
v_exp_f32 v138, v138
v_mfma_f32_16x16x32_bf16 v[128:131], a[176:179], v[56:59], v[224:227]
ds_read_b128 a[152:155], v3 offset:17408
v_cvt_pk_bf16_f32 v208, v136, v137
v_mfma_f32_16x16x32_bf16 v[128:131], a[180:183], v[60:63], v[128:131]
s_waitcnt lgkmcnt(3)
v_exp_f32 v139, v139
v_mfma_f32_16x16x32_bf16 v[128:131], a[184:187], v[64:67], v[128:131]
ds_read_b128 a[156:159], v3 offset:25600
v_cvt_pk_bf16_f32 v209, v138, v139
v_mfma_f32_16x16x32_bf16 v[128:131], a[188:191], v[68:71], v[128:131]
v_exp_f32 v140, v140
v_mfma_f32_16x16x32_bf16 v[144:147], a[188:191], v[84:87], v[228:231]
buffer_load_dwordx4 v16, s[32:35], s64 offen offset:1024 sc1 lds
v_mfma_f32_16x16x32_bf16 v[144:147], a[184:187], v[80:83], v[144:147]
v_exp_f32 v141, v141
v_mfma_f32_16x16x32_bf16 v[144:147], a[180:183], v[76:79], v[144:147]
ds_read_b128 a[160:163], v3 offset:18432
v_cvt_pk_bf16_f32 v210, v140, v141
v_mfma_f32_16x16x32_bf16 v[144:147], a[176:179], v[72:75], v[144:147]
v_exp_f32 v142, v142
v_mfma_f32_16x16x32_bf16 v[148:151], a[192:195], v[72:75], v[228:231]
ds_read_b128 a[164:167], v3 offset:26624
ds_read_b128 a[168:171], v3 offset:19456
v_mfma_f32_16x16x32_bf16 v[148:151], a[196:199], v[76:79], v[148:151]
v_exp_f32 v143, v143
v_mfma_f32_16x16x32_bf16 v[148:151], a[200:203], v[80:83], v[148:151]
ds_read_b128 a[172:175], v3 offset:27648
v_cvt_pk_bf16_f32 v211, v142, v143
v_mfma_f32_16x16x32_bf16 v[148:151], a[204:207], v[84:87], v[148:151]
v_exp_f32 v124, v124
v_mfma_f32_16x16x32_bf16 v[132:135], a[204:207], v[68:71], v[224:227]
ds_read_b128 a[176:179], v3 offset:20480
buffer_load_dwordx4 v16, s[32:35], s64 offen offset:2048 sc1 lds
v_mfma_f32_16x16x32_bf16 v[132:135], a[200:203], v[64:67], v[132:135]
v_exp_f32 v125, v125
v_mfma_f32_16x16x32_bf16 v[132:135], a[196:199], v[60:63], v[132:135]
ds_read_b128 a[180:183], v3 offset:28672
v_cvt_pk_bf16_f32 v202, v124, v125
v_mfma_f32_16x16x32_bf16 v[132:135], a[192:195], v[56:59], v[132:135]
v_exp_f32 v126, v126
v_smfmac_f32_16x16x64_bf16 a[136:139], a[240:243], v[184:191], v5
ds_read_b128 a[184:187], v3 offset:21504
v_smfmac_f32_16x16x64_bf16 a[140:143], a[240:243], v[192:199], v5
s_waitcnt lgkmcnt(3)
ds_read_b128 a[188:191], v3 offset:29696
v_mfma_f32_16x16x32_bf16 a[64:67], a[144:147], v[184:187], a[64:67]
v_exp_f32 v127, v127
v_mfma_f32_16x16x32_bf16 a[64:67], a[148:151], v[188:191], a[64:67]
v_exp_f32 v128, v128
v_mfma_f32_16x16x32_bf16 a[96:99], a[148:151], v[196:199], a[96:99]
v_exp_f32 v129, v129
v_mfma_f32_16x16x32_bf16 a[96:99], a[144:147], v[192:195], a[96:99]
ds_read_b128 a[192:195], v3 offset:22528
v_cvt_pk_bf16_f32 v203, v126, v127
v_mfma_f32_16x16x32_bf16 a[100:103], a[152:155], v[192:195], a[100:103]
v_exp_f32 v130, v130
v_mfma_f32_16x16x32_bf16 a[100:103], a[156:159], v[196:199], a[100:103]
ds_read_b128 a[196:199], v3 offset:30720
v_cvt_pk_bf16_f32 v204, v128, v129
v_mfma_f32_16x16x32_bf16 a[68:71], a[156:159], v[188:191], a[68:71]
v_exp_f32 v131, v131
v_mfma_f32_16x16x32_bf16 a[68:71], a[152:155], v[184:187], a[68:71]
ds_read_b128 a[200:203], v3 offset:23552
v_cvt_pk_bf16_f32 v205, v130, v131
v_mfma_f32_16x16x32_bf16 a[72:75], a[160:163], v[184:187], a[72:75]
v_exp_f32 v144, v144
v_mfma_f32_16x16x32_bf16 a[72:75], a[164:167], v[188:191], a[72:75]
buffer_load_dwordx4 v16, s[32:35], s64 offen offset:3072 sc1 lds
v_mfma_f32_16x16x32_bf16 a[104:107], a[164:167], v[196:199], a[104:107]
s_xor_b32 s71, s71, 49152
v_exp_f32 v145, v145
v_mfma_f32_16x16x32_bf16 a[104:107], a[160:163], v[192:195], a[104:107]
ds_read_b128 a[204:207], v3 offset:31744
v_cvt_pk_bf16_f32 v212, v144, v145
v_mfma_f32_16x16x32_bf16 a[108:111], a[168:171], v[192:195], a[108:111]
s_add_u32 s70, s70, 32768
v_xor_b32 v2, 0x8000, v2
v_exp_f32 v146, v146
v_mfma_f32_16x16x32_bf16 a[108:111], a[172:175], v[196:199], a[108:111]
s_waitcnt vmcnt(8)
s_barrier
v_mfma_f32_16x16x32_bf16 a[76:79], a[172:175], v[188:191], a[76:79]
s_mov_b32 m0, s71
v_exp_f32 v147, v147
v_mfma_f32_16x16x32_bf16 a[76:79], a[168:171], v[184:187], a[76:79]
s_waitcnt lgkmcnt(1)
ds_read_b128 a[144:147], v2 offset:0
v_cvt_pk_bf16_f32 v213, v146, v147
v_mfma_f32_16x16x32_bf16 a[80:83], a[176:179], v[184:187], a[80:83]
v_exp_f32 v148, v148
v_mfma_f32_16x16x32_bf16 a[80:83], a[180:183], v[188:191], a[80:83]
ds_read_b128 a[148:151], v2 offset:1024
ds_read_b128 a[152:155], v2 offset:2048
v_mfma_f32_16x16x32_bf16 a[112:115], a[180:183], v[196:199], a[112:115]
v_exp_f32 v149, v149
v_mfma_f32_16x16x32_bf16 a[112:115], a[176:179], v[192:195], a[112:115]
ds_read_b128 a[156:159], v2 offset:3072
v_cvt_pk_bf16_f32 v214, v148, v149
v_mfma_f32_16x16x32_bf16 a[116:119], a[184:187], v[192:195], a[116:119]
v_exp_f32 v150, v150
v_mfma_f32_16x16x32_bf16 a[116:119], a[188:191], v[196:199], a[116:119]
buffer_load_dwordx4 v16, s[32:35], s70 offen offset:0 sc1 lds
v_mfma_f32_16x16x32_bf16 a[84:87], a[188:191], v[188:191], a[84:87]
s_sub_u32 s72, s72, 1
v_exp_f32 v151, v151
v_mfma_f32_16x16x32_bf16 a[84:87], a[184:187], v[184:187], a[84:87]
ds_read_b128 a[160:163], v2 offset:4096
v_cvt_pk_bf16_f32 v215, v150, v151
v_mfma_f32_16x16x32_bf16 a[88:91], a[192:195], v[184:187], a[88:91]
v_exp_f32 v132, v132
v_mfma_f32_16x16x32_bf16 a[88:91], a[196:199], v[188:191], a[88:91]
ds_read_b128 a[164:167], v2 offset:5120
v_xor_b32 v3, 0x8000, v3
v_mfma_f32_16x16x32_bf16 a[120:123], a[196:199], v[196:199], a[120:123]
s_cmp_lg_u32 s72, 0
v_exp_f32 v133, v133
v_mfma_f32_16x16x32_bf16 a[120:123], a[192:195], v[192:195], a[120:123]
ds_read_b128 a[168:171], v2 offset:6144
v_cvt_pk_bf16_f32 v206, v132, v133
v_mfma_f32_16x16x32_bf16 a[124:127], a[200:203], v[192:195], a[124:127]
s_waitcnt lgkmcnt(3)
v_exp_f32 v134, v134
v_mfma_f32_16x16x32_bf16 a[124:127], a[204:207], v[196:199], a[124:127]
buffer_load_dwordx4 v16, s[32:35], s70 offen offset:1024 sc1 lds
v_mfma_f32_16x16x32_bf16 a[92:95], a[204:207], v[188:191], a[92:95]
v_exp_f32 v135, v135
v_mfma_f32_16x16x32_bf16 a[92:95], a[200:203], v[184:187], a[92:95]
ds_read_b128 a[172:175], v2 offset:7168
v_cvt_pk_bf16_f32 v207, v134, v135
s_cbranch_scc1 L_S
L_SD:
buffer_load_dword v19, off, s[52:55], s80 sc1
s_add_u32 s17, s78, L_TAIL-L_pc
buffer_load_dword a252, v16, s[88:91], s17 offen
s_add_u32 s17, s78, L_TAIL-L_pc+4096
buffer_load_dword a252, v16, s[88:91], s17 offen
s_add_u32 s17, s78, L_p5f0-L_pc
buffer_load_dword a252, v16, s[88:91], s17 offen
s_add_u32 s17, s78, L_p5f0-L_pc+4096
buffer_load_dword a252, v16, s[88:91], s17 offen
s_waitcnt lgkmcnt(7)
v_mfma_f32_16x16x32_bf16 v[136:139], a[144:147], v[72:75], v[228:231]
s_waitcnt lgkmcnt(6)
ds_read_b128 a[176:179], v2 offset:8192
ds_read_b128 a[180:183], v2 offset:9216
v_mfma_f32_16x16x32_bf16 v[136:139], a[148:151], v[76:79], v[136:139]
s_waitcnt lgkmcnt(7)
buffer_load_dwordx4 v16, s[32:35], s70 offen offset:2048 sc1 lds
v_cndmask_b32 v120, v224, v17, s[0:1]
v_cndmask_b32 v121, v224, v17, s[4:5]
v_cndmask_b32 v122, v224, v17, s[6:7]
v_cndmask_b32 v123, v224, v17, s[8:9]
v_mfma_f32_16x16x32_bf16 v[136:139], a[152:155], v[80:83], v[136:139]
s_waitcnt lgkmcnt(6)
s_add_u32 s64, s70, 4096
ds_read_b128 a[184:187], v2 offset:10240
ds_read_b128 a[188:191], v2 offset:11264
v_mfma_f32_16x16x32_bf16 v[136:139], a[156:159], v[84:87], v[136:139]
buffer_load_dwordx4 v16, s[32:35], s70 offen offset:3072 sc1 lds
v_mfma_f32_16x16x32_bf16 v[120:123], a[156:159], v[68:71], v[120:123]
s_add_u32 m0, s71, 4096
ds_read_b128 a[192:195], v2 offset:12288
ds_read_b128 a[196:199], v2 offset:13312
v_mfma_f32_16x16x32_bf16 v[120:123], a[152:155], v[64:67], v[120:123]
buffer_load_dwordx4 v16, s[32:35], s64 offen offset:0 sc1 lds
v_mfma_f32_16x16x32_bf16 v[120:123], a[148:151], v[60:63], v[120:123]
ds_read_b128 a[200:203], v2 offset:14336
ds_read_b128 a[204:207], v2 offset:15360
v_mfma_f32_16x16x32_bf16 v[120:123], a[144:147], v[56:59], v[120:123]
s_waitcnt lgkmcnt(6)
v_exp_f32 v136, v136
v_mfma_f32_16x16x32_bf16 v[140:143], a[160:163], v[72:75], v[228:231]
v_exp_f32 v137, v137
v_mfma_f32_16x16x32_bf16 v[140:143], a[164:167], v[76:79], v[140:143]
v_cndmask_b32 v124, v224, v17, s[10:11]
v_cndmask_b32 v125, v224, v17, s[12:13]
v_cndmask_b32 v126, v224, v17, s[18:19]
v_cndmask_b32 v127, v224, v17, s[22:23]
v_exp_f32 v138, v138
v_mfma_f32_16x16x32_bf16 v[140:143], a[168:171], v[80:83], v[140:143]
v_exp_f32 v139, v139
v_mfma_f32_16x16x32_bf16 v[140:143], a[172:175], v[84:87], v[140:143]
v_exp_f32 v120, v120
v_mfma_f32_16x16x32_bf16 v[124:127], a[172:175], v[68:71], v[124:127]
ds_read_b128 a[144:147], v3 offset:0
v_cvt_pk_bf16_f32 v192, v136, v137
v_mfma_f32_16x16x32_bf16 v[124:127], a[168:171], v[64:67], v[124:127]
v_cndmask_b32 v128, v224, v17, s[26:27]
v_cndmask_b32 v129, v224, v17, s[56:57]
v_cndmask_b32 v130, v224, v17, s[58:59]
v_cndmask_b32 v131, v224, v17, s[60:61]
v_exp_f32 v121, v121
v_mfma_f32_16x16x32_bf16 v[124:127], a[164:167], v[60:63], v[124:127]
s_mul_i32 s69, s83, 8
ds_read_b128 a[148:151], v3 offset:8192
v_cvt_pk_bf16_f32 v193, v138, v139
v_mfma_f32_16x16x32_bf16 v[124:127], a[160:163], v[56:59], v[124:127]
s_sub_u32 s69, 36, s69
v_exp_f32 v122, v122
v_mfma_f32_16x16x32_bf16 v[128:131], a[176:179], v[56:59], v[128:131]
ds_read_b128 a[152:155], v3 offset:1024
v_cvt_pk_bf16_f32 v184, v120, v121
v_mfma_f32_16x16x32_bf16 v[128:131], a[180:183], v[60:63], v[128:131]
s_waitcnt lgkmcnt(3)
v_exp_f32 v123, v123
v_mfma_f32_16x16x32_bf16 v[128:131], a[184:187], v[64:67], v[128:131]
ds_read_b128 a[156:159], v3 offset:9216
v_cvt_pk_bf16_f32 v185, v122, v123
v_mfma_f32_16x16x32_bf16 v[128:131], a[188:191], v[68:71], v[128:131]
v_exp_f32 v140, v140
v_mfma_f32_16x16x32_bf16 v[144:147], a[188:191], v[84:87], v[228:231]
buffer_load_dwordx4 v16, s[32:35], s64 offen offset:1024 sc1 lds
v_mfma_f32_16x16x32_bf16 v[144:147], a[184:187], v[80:83], v[144:147]
v_exp_f32 v141, v141
v_mfma_f32_16x16x32_bf16 v[144:147], a[180:183], v[76:79], v[144:147]
ds_read_b128 a[160:163], v3 offset:2048
v_cvt_pk_bf16_f32 v194, v140, v141
v_mfma_f32_16x16x32_bf16 v[144:147], a[176:179], v[72:75], v[144:147]
v_exp_f32 v142, v142
v_mfma_f32_16x16x32_bf16 v[148:151], a[192:195], v[72:75], v[228:231]
ds_read_b128 a[164:167], v3 offset:10240
ds_read_b128 a[168:171], v3 offset:3072
v_mfma_f32_16x16x32_bf16 v[148:151], a[196:199], v[76:79], v[148:151]
v_cndmask_b32 v132, v224, v17, s[62:63]
v_cndmask_b32 v133, v224, v17, s[48:49]
v_cndmask_b32 v134, v224, v17, s[50:51]
v_cndmask_b32 v135, v224, v17, s[100:101]
v_exp_f32 v143, v143
v_mfma_f32_16x16x32_bf16 v[148:151], a[200:203], v[80:83], v[148:151]
ds_read_b128 a[172:175], v3 offset:11264
v_cvt_pk_bf16_f32 v195, v142, v143
v_mfma_f32_16x16x32_bf16 v[148:151], a[204:207], v[84:87], v[148:151]
v_exp_f32 v124, v124
v_mfma_f32_16x16x32_bf16 v[132:135], a[204:207], v[68:71], v[132:135]
ds_read_b128 a[176:179], v3 offset:4096
buffer_load_dwordx4 v16, s[32:35], s64 offen offset:2048 sc1 lds
v_mfma_f32_16x16x32_bf16 v[132:135], a[200:203], v[64:67], v[132:135]
v_exp_f32 v125, v125
v_mfma_f32_16x16x32_bf16 v[132:135], a[196:199], v[60:63], v[132:135]
ds_read_b128 a[180:183], v3 offset:12288
v_cvt_pk_bf16_f32 v186, v124, v125
v_mfma_f32_16x16x32_bf16 v[132:135], a[192:195], v[56:59], v[132:135]
v_exp_f32 v126, v126
v_smfmac_f32_16x16x64_bf16 a[136:139], a[240:243], v[200:207], v5
ds_read_b128 a[184:187], v3 offset:5120
v_smfmac_f32_16x16x64_bf16 a[140:143], a[240:243], v[208:215], v5
s_waitcnt lgkmcnt(3)
ds_read_b128 a[188:191], v3 offset:13312
v_mfma_f32_16x16x32_bf16 a[64:67], a[144:147], v[200:203], a[64:67]
v_exp_f32 v127, v127
v_mfma_f32_16x16x32_bf16 a[64:67], a[148:151], v[204:207], a[64:67]
v_exp_f32 v128, v128
v_mfma_f32_16x16x32_bf16 a[96:99], a[148:151], v[212:215], a[96:99]
v_exp_f32 v129, v129
v_mfma_f32_16x16x32_bf16 a[96:99], a[144:147], v[208:211], a[96:99]
ds_read_b128 a[192:195], v3 offset:6144
v_cvt_pk_bf16_f32 v187, v126, v127
v_mfma_f32_16x16x32_bf16 a[100:103], a[152:155], v[208:211], a[100:103]
v_exp_f32 v130, v130
v_mfma_f32_16x16x32_bf16 a[100:103], a[156:159], v[212:215], a[100:103]
ds_read_b128 a[196:199], v3 offset:14336
v_cvt_pk_bf16_f32 v188, v128, v129
v_mfma_f32_16x16x32_bf16 a[68:71], a[156:159], v[204:207], a[68:71]
v_exp_f32 v131, v131
v_mfma_f32_16x16x32_bf16 a[68:71], a[152:155], v[200:203], a[68:71]
ds_read_b128 a[200:203], v3 offset:7168
v_cvt_pk_bf16_f32 v189, v130, v131
v_mfma_f32_16x16x32_bf16 a[72:75], a[160:163], v[200:203], a[72:75]
v_exp_f32 v144, v144
v_mfma_f32_16x16x32_bf16 a[72:75], a[164:167], v[204:207], a[72:75]
buffer_load_dwordx4 v16, s[32:35], s64 offen offset:3072 sc1 lds
v_mfma_f32_16x16x32_bf16 a[104:107], a[164:167], v[212:215], a[104:107]
v_exp_f32 v145, v145
v_mfma_f32_16x16x32_bf16 a[104:107], a[160:163], v[208:211], a[104:107]
ds_read_b128 a[204:207], v3 offset:15360
v_cvt_pk_bf16_f32 v196, v144, v145
v_mfma_f32_16x16x32_bf16 a[108:111], a[168:171], v[208:211], a[108:111]
v_exp_f32 v146, v146
v_mfma_f32_16x16x32_bf16 a[108:111], a[172:175], v[212:215], a[108:111]
s_waitcnt vmcnt(13)
s_barrier
v_mfma_f32_16x16x32_bf16 a[76:79], a[172:175], v[204:207], a[76:79]
v_exp_f32 v147, v147
v_mfma_f32_16x16x32_bf16 a[76:79], a[168:171], v[200:203], a[76:79]
s_waitcnt lgkmcnt(1)
ds_read_b128 a[144:147], v2 offset:16384
v_cvt_pk_bf16_f32 v197, v146, v147
v_mfma_f32_16x16x32_bf16 a[80:83], a[176:179], v[200:203], a[80:83]
s_waitcnt vmcnt(10)
v_readfirstlane_b32 vcc_lo, v19
s_nop 0
s_cmp_lt_u32 vcc_lo, s69
s_cbranch_scc1 L_spin_8
L_spinbk_9:
v_exp_f32 v148, v148
v_mfma_f32_16x16x32_bf16 a[80:83], a[180:183], v[204:207], a[80:83]
ds_read_b128 a[148:151], v2 offset:17408
ds_read_b128 a[152:155], v2 offset:18432
v_mfma_f32_16x16x32_bf16 a[112:115], a[180:183], v[212:215], a[112:115]
v_exp_f32 v149, v149
v_mfma_f32_16x16x32_bf16 a[112:115], a[176:179], v[208:211], a[112:115]
ds_read_b128 a[156:159], v2 offset:19456
v_cvt_pk_bf16_f32 v198, v148, v149
v_mfma_f32_16x16x32_bf16 a[116:119], a[184:187], v[208:211], a[116:119]
v_exp_f32 v150, v150
v_mfma_f32_16x16x32_bf16 a[116:119], a[188:191], v[212:215], a[116:119]
v_cndmask_b32 v136, v228, v17, s[0:1]
v_cndmask_b32 v137, v228, v17, s[4:5]
v_mfma_f32_16x16x32_bf16 a[84:87], a[188:191], v[204:207], a[84:87]
v_exp_f32 v151, v151
v_mfma_f32_16x16x32_bf16 a[84:87], a[184:187], v[200:203], a[84:87]
ds_read_b128 a[160:163], v2 offset:20480
v_cvt_pk_bf16_f32 v199, v150, v151
v_mfma_f32_16x16x32_bf16 a[88:91], a[192:195], v[200:203], a[88:91]
v_exp_f32 v132, v132
v_mfma_f32_16x16x32_bf16 a[88:91], a[196:199], v[204:207], a[88:91]
ds_read_b128 a[164:167], v2 offset:21504
v_cndmask_b32 v138, v228, v17, s[6:7]
v_mfma_f32_16x16x32_bf16 a[120:123], a[196:199], v[212:215], a[120:123]
v_exp_f32 v133, v133
v_mfma_f32_16x16x32_bf16 a[120:123], a[192:195], v[208:211], a[120:123]
ds_read_b128 a[168:171], v2 offset:22528
v_cvt_pk_bf16_f32 v190, v132, v133
v_mfma_f32_16x16x32_bf16 a[124:127], a[200:203], v[208:211], a[124:127]
s_waitcnt lgkmcnt(3)
v_exp_f32 v134, v134
v_mfma_f32_16x16x32_bf16 a[124:127], a[204:207], v[212:215], a[124:127]
v_cndmask_b32 v139, v228, v17, s[8:9]
v_cndmask_b32 v140, v228, v17, s[10:11]
v_mfma_f32_16x16x32_bf16 a[92:95], a[204:207], v[204:207], a[92:95]
v_exp_f32 v135, v135
v_mfma_f32_16x16x32_bf16 a[92:95], a[200:203], v[200:203], a[92:95]
ds_read_b128 a[172:175], v2 offset:23552
v_cvt_pk_bf16_f32 v191, v134, v135
v_mfma_f32_16x16x32_bf16 v[136:139], a[144:147], v[72:75], v[136:139]
ds_read_b128 a[176:179], v2 offset:24576
v_cndmask_b32 v141, v228, v17, s[12:13]
v_mfma_f32_16x16x32_bf16 v[136:139], a[148:151], v[76:79], v[136:139]
ds_read_b128 a[180:183], v2 offset:25600
v_cndmask_b32 v142, v228, v17, s[18:19]
v_cndmask_b32 v143, v228, v17, s[22:23]
v_mfma_f32_16x16x32_bf16 v[136:139], a[152:155], v[80:83], v[136:139]
ds_read_b128 a[184:187], v2 offset:26624
v_cndmask_b32 v144, v228, v17, s[26:27]
v_mfma_f32_16x16x32_bf16 v[136:139], a[156:159], v[84:87], v[136:139]
s_waitcnt lgkmcnt(3)
ds_read_b128 a[188:191], v2 offset:27648
v_cndmask_b32 v145, v228, v17, s[56:57]
v_mfma_f32_16x16x32_bf16 v[140:143], a[172:175], v[84:87], v[140:143]
ds_read_b128 a[192:195], v2 offset:28672
ds_read_b128 a[196:199], v2 offset:29696
ds_read_b128 a[200:203], v2 offset:30720
ds_read_b128 a[204:207], v2 offset:31744
v_mfma_f32_16x16x32_bf16 v[140:143], a[168:171], v[80:83], v[140:143]
ds_read_b128 a[144:147], v3 offset:16384
v_cndmask_b32 v146, v228, v17, s[58:59]
v_cndmask_b32 v147, v228, v17, s[60:61]
v_mfma_f32_16x16x32_bf16 v[140:143], a[164:167], v[76:79], v[140:143]
ds_read_b128 a[148:151], v3 offset:24576
v_cndmask_b32 v148, v228, v17, s[62:63]
v_mfma_f32_16x16x32_bf16 v[140:143], a[160:163], v[72:75], v[140:143]
s_waitcnt lgkmcnt(8)
ds_read_b128 a[152:155], v3 offset:17408
v_cndmask_b32 v149, v228, v17, s[48:49]
v_mfma_f32_16x16x32_bf16 v[144:147], a[176:179], v[72:75], v[144:147]
ds_read_b128 a[156:159], v3 offset:25600
v_cndmask_b32 v150, v228, v17, s[50:51]
v_mfma_f32_16x16x32_bf16 v[144:147], a[180:183], v[76:79], v[144:147]
s_waitcnt lgkmcnt(8)
ds_read_b128 a[160:163], v3 offset:18432
v_cndmask_b32 v151, v228, v17, s[100:101]
v_mfma_f32_16x16x32_bf16 v[144:147], a[184:187], v[80:83], v[144:147]
v_exp_f32 v136, v136
v_mfma_f32_16x16x32_bf16 v[144:147], a[188:191], v[84:87], v[144:147]
s_waitcnt lgkmcnt(4)
v_exp_f32 v137, v137
v_mfma_f32_16x16x32_bf16 v[148:151], a[204:207], v[84:87], v[148:151]
v_exp_f32 v138, v138
v_mfma_f32_16x16x32_bf16 v[148:151], a[200:203], v[80:83], v[148:151]
s_add_u32 s65, s84, 0
v_exp_f32 v139, v139
v_mfma_f32_16x16x32_bf16 v[148:151], a[196:199], v[76:79], v[148:151]
buffer_load_dwordx4 a[208:211], v14, s[44:47], s65 offen offset:0 sc1
v_mfma_f32_16x16x32_bf16 v[148:151], a[192:195], v[72:75], v[148:151]
ds_read_b128 a[164:167], v3 offset:26624
v_cvt_pk_bf16_f32 v208, v136, v137
v_smfmac_f32_16x16x64_bf16 a[136:139], a[240:243], v[184:191], v5
ds_read_b128 a[168:171], v3 offset:19456
v_smfmac_f32_16x16x64_bf16 a[140:143], a[240:243], v[192:199], v5
ds_read_b128 a[172:175], v3 offset:27648
v_mfma_f32_16x16x32_bf16 a[64:67], a[144:147], v[184:187], a[64:67]
s_waitcnt lgkmcnt(3)
v_exp_f32 v140, v140
v_mfma_f32_16x16x32_bf16 a[64:67], a[148:151], v[188:191], a[64:67]
buffer_load_dwordx4 a[216:219], v14, s[44:47], s65 offen offset:1024 sc1
v_mfma_f32_16x16x32_bf16 a[96:99], a[148:151], v[196:199], a[96:99]
v_exp_f32 v141, v141
v_mfma_f32_16x16x32_bf16 a[96:99], a[144:147], v[192:195], a[96:99]
buffer_load_dwordx4 a[224:227], v15, s[44:47], s65 offen offset:0 sc1
v_mfma_f32_16x16x32_bf16 a[100:103], a[152:155], v[192:195], a[100:103]
v_exp_f32 v142, v142
v_mfma_f32_16x16x32_bf16 a[100:103], a[156:159], v[196:199], a[100:103]
buffer_load_dwordx4 a[232:235], v15, s[44:47], s65 offen offset:1024 sc1
v_mfma_f32_16x16x32_bf16 a[68:71], a[156:159], v[188:191], a[68:71]
s_add_u32 s65, s84, 8192
ds_read_b128 a[176:179], v3 offset:20480
v_cvt_pk_bf16_f32 v209, v138, v139
v_mfma_f32_16x16x32_bf16 a[68:71], a[152:155], v[184:187], a[68:71]
buffer_load_dwordx4 a[212:215], v14, s[44:47], s65 offen offset:0 sc1
v_mfma_f32_16x16x32_bf16 a[72:75], a[160:163], v[184:187], a[72:75]
s_waitcnt lgkmcnt(1)
ds_read_b128 a[180:183], v3 offset:28672
v_cvt_pk_bf16_f32 v210, v140, v141
v_mfma_f32_16x16x32_bf16 a[72:75], a[164:167], v[188:191], a[72:75]
v_exp_f32 v143, v143
v_mfma_f32_16x16x32_bf16 a[104:107], a[164:167], v[196:199], a[104:107]
buffer_load_dwordx4 a[220:223], v14, s[44:47], s65 offen offset:1024 sc1
v_mfma_f32_16x16x32_bf16 a[104:107], a[160:163], v[192:195], a[104:107]
v_exp_f32 v144, v144
v_mfma_f32_16x16x32_bf16 a[108:111], a[168:171], v[192:195], a[108:111]
ds_read_b128 a[184:187], v3 offset:21504
v_xor_b32 v2, 0x8000, v2
v_mfma_f32_16x16x32_bf16 a[108:111], a[172:175], v[196:199], a[108:111]
buffer_load_dwordx4 a[228:231], v15, s[44:47], s65 offen offset:0 sc1
ds_read_b128 a[188:191], v3 offset:29696
v_mfma_f32_16x16x32_bf16 a[76:79], a[172:175], v[188:191], a[76:79]
v_exp_f32 v145, v145
v_mfma_f32_16x16x32_bf16 a[76:79], a[168:171], v[184:187], a[76:79]
s_waitcnt lgkmcnt(2)
buffer_load_dwordx4 a[236:239], v15, s[44:47], s65 offen offset:1024 sc1
v_mfma_f32_16x16x32_bf16 a[80:83], a[176:179], v[184:187], a[80:83]
s_add_u32 s65, s84, 32768
ds_read_b128 a[192:195], v3 offset:22528
v_cvt_pk_bf16_f32 v211, v142, v143
v_mfma_f32_16x16x32_bf16 a[80:83], a[180:183], v[188:191], a[80:83]
buffer_load_dwordx4 v[152:155], v14, s[44:47], s65 offen offset:0 sc1
ds_read_b128 a[196:199], v3 offset:30720
v_exp_f32 v146, v146
v_mfma_f32_16x16x32_bf16 a[112:115], a[180:183], v[196:199], a[112:115]
ds_read_b128 a[200:203], v3 offset:23552
ds_read_b128 a[204:207], v3 offset:31744
v_mfma_f32_16x16x32_bf16 a[112:115], a[176:179], v[192:195], a[112:115]
s_waitcnt vmcnt(9)
s_barrier
v_xor_b32 v3, 0x8000, v3
buffer_load_dwordx4 v[160:163], v14, s[44:47], s65 offen offset:1024 sc1
s_waitcnt lgkmcnt(4)
v_mfma_f32_16x16x32_bf16 a[116:119], a[184:187], v[192:195], a[116:119]
v_exp_f32 v147, v147
v_mfma_f32_16x16x32_bf16 a[116:119], a[188:191], v[196:199], a[116:119]
buffer_load_dwordx4 v[168:171], v15, s[44:47], s65 offen offset:0 sc1
v_mfma_f32_16x16x32_bf16 a[84:87], a[188:191], v[188:191], a[84:87]
v_exp_f32 v148, v148
v_mfma_f32_16x16x32_bf16 a[84:87], a[184:187], v[184:187], a[84:87]
s_waitcnt lgkmcnt(2)
buffer_load_dwordx4 v[176:179], v15, s[44:47], s65 offen offset:1024 sc1
v_cvt_pk_bf16_f32 v212, v144, v145
v_mfma_f32_16x16x32_bf16 a[88:91], a[192:195], v[184:187], a[88:91]
s_add_u32 s65, s84, 40960
v_exp_f32 v149, v149
v_mfma_f32_16x16x32_bf16 a[88:91], a[196:199], v[188:191], a[88:91]
buffer_load_dwordx4 v[156:159], v14, s[44:47], s65 offen offset:0 sc1
v_mfma_f32_16x16x32_bf16 a[120:123], a[196:199], v[196:199], a[120:123]
ds_read_b128 a[144:147], v3 offset:0
v_cvt_pk_bf16_f32 v213, v146, v147
v_mfma_f32_16x16x32_bf16 a[120:123], a[192:195], v[192:195], a[120:123]
s_waitcnt lgkmcnt(1)
buffer_load_dwordx4 v[164:167], v14, s[44:47], s65 offen offset:1024 sc1
ds_read_b128 a[148:151], v3 offset:8192
v_exp_f32 v150, v150
v_mfma_f32_16x16x32_bf16 a[124:127], a[200:203], v[192:195], a[124:127]
ds_read_b128 a[152:155], v3 offset:1024
v_cvt_pk_bf16_f32 v214, v148, v149
v_mfma_f32_16x16x32_bf16 a[124:127], a[204:207], v[196:199], a[124:127]
buffer_load_dwordx4 v[172:175], v15, s[44:47], s65 offen offset:0 sc1
ds_read_b128 a[156:159], v3 offset:9216
v_mfma_f32_16x16x32_bf16 a[92:95], a[204:207], v[188:191], a[92:95]
v_exp_f32 v151, v151
v_mfma_f32_16x16x32_bf16 a[92:95], a[200:203], v[184:187], a[92:95]
buffer_load_dwordx4 v[180:183], v15, s[44:47], s65 offen offset:1024 sc1
ds_read_b128 a[160:163], v3 offset:2048
ds_read_b128 a[164:167], v3 offset:10240
ds_read_b128 a[168:171], v3 offset:3072
ds_read_b128 a[172:175], v3 offset:11264
v_cvt_pk_bf16_f32 v215, v150, v151
v_accvgpr_read_b32 v22, a136
v_accvgpr_read_b32 v248, a137
v_add_f32 v22, v22, v248
v_max_f32 v1, v1, v22
v_rcp_f32 v22, v22
v_accvgpr_read_b32 v232, a64
v_accvgpr_read_b32 v233, a65
v_accvgpr_read_b32 v234, a66
v_accvgpr_read_b32 v235, a67
v_accvgpr_read_b32 v236, a68
v_accvgpr_read_b32 v237, a69
v_accvgpr_read_b32 v238, a70
v_accvgpr_read_b32 v239, a71
v_mul_f32 v22, v22, v8
v_mul_f32 v232, v232, v22
v_mul_f32 v233, v233, v22
v_mul_f32 v234, v234, v22
v_mul_f32 v235, v235, v22
v_mul_f32 v236, v236, v22
v_mul_f32 v237, v237, v22
v_mul_f32 v238, v238, v22
v_mul_f32 v239, v239, v22
v_cvt_pk_bf16_f32 v232, v232, v233
v_cvt_pk_bf16_f32 v233, v234, v235
v_cvt_pk_bf16_f32 v234, v236, v237
v_cvt_pk_bf16_f32 v235, v238, v239
s_add_u32 s77, s75, 0
buffer_store_dwordx4 v[232:235], v16, s[44:47], s77 offen sc1
L_TAIL:
ds_read_b128 a[176:179], v3 offset:4096
ds_read_b128 a[180:183], v3 offset:12288
ds_read_b128 a[184:187], v3 offset:5120
ds_read_b128 a[188:191], v3 offset:13312
v_smfmac_f32_16x16x64_bf16 a[140:143], a[240:243], v[208:215], v5
s_waitcnt lgkmcnt(11)
s_add_u32 m0, s86, 32768
s_add_u32 s64, s85, 262144
ds_read_b128 a[192:195], v3 offset:6144
v_mfma_f32_16x16x32_bf16 a[96:99], a[144:147], v[208:211], a[96:99]
s_waitcnt lgkmcnt(11)
ds_read_b128 a[196:199], v3 offset:14336
ds_read_b128 a[200:203], v3 offset:7168
ds_read_b128 a[204:207], v3 offset:15360
v_mfma_f32_16x16x32_bf16 a[96:99], a[148:151], v[212:215], a[96:99]
s_waitcnt lgkmcnt(12)
buffer_load_dwordx4 v12, s[36:39], s64 offen lds
v_mfma_f32_16x16x32_bf16 a[100:103], a[156:159], v[212:215], a[100:103]
s_add_u32 m0, s86, 33792
s_add_u32 s64, s85, 270336
v_accvgpr_read_b32 v240, a72
v_accvgpr_read_b32 v241, a73
v_mfma_f32_16x16x32_bf16 a[100:103], a[152:155], v[208:211], a[100:103]
s_waitcnt lgkmcnt(11)
buffer_load_dwordx4 v13, s[36:39], s64 offen lds
v_mfma_f32_16x16x32_bf16 a[104:107], a[160:163], v[208:211], a[104:107]
s_waitcnt lgkmcnt(10)
s_add_u32 m0, s86, 34816
s_add_u32 s64, s85, 278528
v_accvgpr_read_b32 v242, a74
v_accvgpr_read_b32 v243, a75
v_mfma_f32_16x16x32_bf16 a[104:107], a[164:167], v[212:215], a[104:107]
s_waitcnt lgkmcnt(8)
buffer_load_dwordx4 v12, s[36:39], s64 offen lds
v_mfma_f32_16x16x32_bf16 a[108:111], a[172:175], v[212:215], a[108:111]
s_add_u32 m0, s86, 35840
s_add_u32 s64, s85, 286720
v_accvgpr_read_b32 v244, a76
v_accvgpr_read_b32 v245, a77
v_mfma_f32_16x16x32_bf16 a[108:111], a[168:171], v[208:211], a[108:111]
s_waitcnt lgkmcnt(7)
buffer_load_dwordx4 v13, s[36:39], s64 offen lds
v_mfma_f32_16x16x32_bf16 a[112:115], a[176:179], v[208:211], a[112:115]
s_waitcnt lgkmcnt(6)
s_add_u32 m0, s86, 36864
s_add_u32 s64, s85, 294912
v_accvgpr_read_b32 v246, a78
v_accvgpr_read_b32 v247, a79
v_mfma_f32_16x16x32_bf16 a[112:115], a[180:183], v[212:215], a[112:115]
s_waitcnt lgkmcnt(4)
buffer_load_dwordx4 v12, s[36:39], s64 offen lds
v_mfma_f32_16x16x32_bf16 a[116:119], a[188:191], v[212:215], a[116:119]
s_add_u32 m0, s86, 37888
s_add_u32 s64, s85, 303104
v_mul_f32 v240, v240, v22
v_mul_f32 v241, v241, v22
v_mfma_f32_16x16x32_bf16 a[116:119], a[184:187], v[208:211], a[116:119]
s_waitcnt lgkmcnt(3)
buffer_load_dwordx4 v13, s[36:39], s64 offen lds
v_mfma_f32_16x16x32_bf16 a[120:123], a[192:195], v[208:211], a[120:123]
s_waitcnt lgkmcnt(2)
s_add_u32 m0, s86, 38912
s_add_u32 s64, s85, 311296
v_mul_f32 v242, v242, v22
v_mul_f32 v243, v243, v22
v_mfma_f32_16x16x32_bf16 a[120:123], a[196:199], v[212:215], a[120:123]
s_waitcnt lgkmcnt(0)
buffer_load_dwordx4 v12, s[36:39], s64 offen lds
v_mfma_f32_16x16x32_bf16 a[124:127], a[204:207], v[212:215], a[124:127]
s_add_u32 m0, s86, 39936
s_add_u32 s64, s85, 319488
v_mul_f32 v244, v244, v22
v_mul_f32 v245, v245, v22
v_mfma_f32_16x16x32_bf16 a[124:127], a[200:203], v[208:211], a[124:127]
buffer_load_dwordx4 v13, s[36:39], s64 offen lds
v_mul_f32 v246, v246, v22
v_mul_f32 v247, v247, v22
v_cvt_pk_bf16_f32 v240, v240, v241
v_cvt_pk_bf16_f32 v241, v242, v243
v_cvt_pk_bf16_f32 v242, v244, v245
v_cvt_pk_bf16_f32 v243, v246, v247
s_add_u32 s77, s75, 8192
buffer_store_dwordx4 v[240:243], v16, s[44:47], s77 offen sc1
v_accvgpr_read_b32 v23, a140
v_accvgpr_read_b32 v248, a141
v_add_f32 v23, v23, v248
v_max_f32 v1, v1, v23
v_rcp_f32 v23, v23
s_mov_b32 s66, 0x5d800000
v_cmp_le_f32 vcc, s66, v1
s_lshl_b32 s67, s30, 2
s_cmp_lg_u64 vcc, 0
s_cselect_b32 s66, 1, 0
v_mov_b32 v248, s67
v_mov_b32 v249, s66
ds_write_b32 v248, v249
v_accvgpr_read_b32 v232, a80
v_accvgpr_read_b32 v233, a81
v_accvgpr_read_b32 v234, a82
v_accvgpr_read_b32 v235, a83
v_accvgpr_read_b32 v236, a84
v_accvgpr_read_b32 v237, a85
v_accvgpr_read_b32 v238, a86
v_accvgpr_read_b32 v239, a87
v_pk_mul_f32 v[232:233], v[232:233], v[22:23] op_sel_hi:[1,0]
v_pk_mul_f32 v[234:235], v[234:235], v[22:23] op_sel_hi:[1,0]
v_pk_mul_f32 v[236:237], v[236:237], v[22:23] op_sel_hi:[1,0]
v_pk_mul_f32 v[238:239], v[238:239], v[22:23] op_sel_hi:[1,0]
v_cvt_pk_bf16_f32 v232, v232, v233
v_cvt_pk_bf16_f32 v233, v234, v235
v_cvt_pk_bf16_f32 v234, v236, v237
v_cvt_pk_bf16_f32 v235, v238, v239
s_add_u32 s77, s75, 16384
buffer_store_dwordx4 v[232:235], v16, s[44:47], s77 offen sc1
v_accvgpr_read_b32 v240, a88
v_accvgpr_read_b32 v241, a89
v_accvgpr_read_b32 v242, a90
v_accvgpr_read_b32 v243, a91
v_accvgpr_read_b32 v244, a92
v_accvgpr_read_b32 v245, a93
v_accvgpr_read_b32 v246, a94
v_accvgpr_read_b32 v247, a95
v_pk_mul_f32 v[240:241], v[240:241], v[22:23] op_sel_hi:[1,0]
v_pk_mul_f32 v[242:243], v[242:243], v[22:23] op_sel_hi:[1,0]
v_pk_mul_f32 v[244:245], v[244:245], v[22:23] op_sel_hi:[1,0]
v_pk_mul_f32 v[246:247], v[246:247], v[22:23] op_sel_hi:[1,0]
v_cvt_pk_bf16_f32 v240, v240, v241
v_cvt_pk_bf16_f32 v241, v242, v243
v_cvt_pk_bf16_f32 v242, v244, v245
v_cvt_pk_bf16_f32 v243, v246, v247
s_add_u32 s77, s75, 24576
buffer_store_dwordx4 v[240:243], v16, s[44:47], s77 offen sc1
v_accvgpr_read_b32 v232, a96
v_accvgpr_read_b32 v233, a97
v_accvgpr_read_b32 v234, a98
v_accvgpr_read_b32 v235, a99
v_accvgpr_read_b32 v236, a100
v_accvgpr_read_b32 v237, a101
v_accvgpr_read_b32 v238, a102
v_accvgpr_read_b32 v239, a103
v_mul_f32 v23, v23, v10
v_pk_mul_f32 v[232:233], v[232:233], v[22:23] op_sel:[0,1]
v_pk_mul_f32 v[234:235], v[234:235], v[22:23] op_sel:[0,1]
v_pk_mul_f32 v[236:237], v[236:237], v[22:23] op_sel:[0,1]
v_pk_mul_f32 v[238:239], v[238:239], v[22:23] op_sel:[0,1]
v_cvt_pk_bf16_f32 v232, v232, v233
v_cvt_pk_bf16_f32 v233, v234, v235
v_cvt_pk_bf16_f32 v234, v236, v237
v_cvt_pk_bf16_f32 v235, v238, v239
s_add_u32 s77, s75, 4096
buffer_store_dwordx4 v[232:235], v16, s[44:47], s77 offen sc1
v_accvgpr_read_b32 v240, a104
v_accvgpr_read_b32 v241, a105
v_accvgpr_read_b32 v242, a106
v_accvgpr_read_b32 v243, a107
v_accvgpr_read_b32 v244, a108
v_accvgpr_read_b32 v245, a109
v_accvgpr_read_b32 v246, a110
v_accvgpr_read_b32 v247, a111
v_pk_mul_f32 v[240:241], v[240:241], v[22:23] op_sel:[0,1]
v_pk_mul_f32 v[242:243], v[242:243], v[22:23] op_sel:[0,1]
v_pk_mul_f32 v[244:245], v[244:245], v[22:23] op_sel:[0,1]
v_pk_mul_f32 v[246:247], v[246:247], v[22:23] op_sel:[0,1]
v_cvt_pk_bf16_f32 v240, v240, v241
v_cvt_pk_bf16_f32 v241, v242, v243
v_cvt_pk_bf16_f32 v242, v244, v245
v_cvt_pk_bf16_f32 v243, v246, v247
s_add_u32 s77, s75, 12288
buffer_store_dwordx4 v[240:243], v16, s[44:47], s77 offen sc1
v_accvgpr_read_b32 v232, a112
v_accvgpr_read_b32 v233, a113
v_accvgpr_read_b32 v234, a114
v_accvgpr_read_b32 v235, a115
v_accvgpr_read_b32 v236, a116
v_accvgpr_read_b32 v237, a117
v_accvgpr_read_b32 v238, a118
v_accvgpr_read_b32 v239, a119
v_pk_mul_f32 v[232:233], v[232:233], v[22:23] op_sel:[0,1]
v_pk_mul_f32 v[234:235], v[234:235], v[22:23] op_sel:[0,1]
v_pk_mul_f32 v[236:237], v[236:237], v[22:23] op_sel:[0,1]
v_pk_mul_f32 v[238:239], v[238:239], v[22:23] op_sel:[0,1]
v_cvt_pk_bf16_f32 v232, v232, v233
v_cvt_pk_bf16_f32 v233, v234, v235
v_cvt_pk_bf16_f32 v234, v236, v237
v_cvt_pk_bf16_f32 v235, v238, v239
s_add_u32 s77, s75, 20480
buffer_store_dwordx4 v[232:235], v16, s[44:47], s77 offen sc1
v_accvgpr_read_b32 v240, a120
v_accvgpr_read_b32 v241, a121
v_accvgpr_read_b32 v242, a122
v_accvgpr_read_b32 v243, a123
v_accvgpr_read_b32 v244, a124
v_accvgpr_read_b32 v245, a125
v_accvgpr_read_b32 v246, a126
v_accvgpr_read_b32 v247, a127
v_pk_mul_f32 v[240:241], v[240:241], v[22:23] op_sel:[0,1]
v_pk_mul_f32 v[242:243], v[242:243], v[22:23] op_sel:[0,1]
v_pk_mul_f32 v[244:245], v[244:245], v[22:23] op_sel:[0,1]
v_pk_mul_f32 v[246:247], v[246:247], v[22:23] op_sel:[0,1]
v_cvt_pk_bf16_f32 v240, v240, v241
v_cvt_pk_bf16_f32 v241, v242, v243
v_cvt_pk_bf16_f32 v242, v244, v245
v_cvt_pk_bf16_f32 v243, v246, v247
s_add_u32 s77, s75, 28672
buffer_store_dwordx4 v[240:243], v16, s[44:47], s77 offen sc1
v_mov_b32 v248, 0
s_waitcnt lgkmcnt(0)
s_barrier
ds_read_b128 v[248:251], v248
v_xor_b32 v188, 128, v18
v_xor_b32 v189, 160, v18
v_xor_b32 v190, 192, v18
ds_read_b64_tr_b16 a[144:145], v188 offset:32768
ds_read_b64_tr_b16 a[146:147], v188 offset:36864
ds_read_b64_tr_b16 a[148:149], v188 offset:40960
ds_read_b64_tr_b16 a[150:151], v188 offset:45056
ds_read_b64_tr_b16 a[152:153], v189 offset:32768
ds_read_b64_tr_b16 a[154:155], v189 offset:36864
ds_read_b64_tr_b16 a[156:157], v189 offset:40960
ds_read_b64_tr_b16 a[158:159], v189 offset:45056
ds_read_b64_tr_b16 a[160:161], v190 offset:32768
ds_read_b64_tr_b16 a[162:163], v190 offset:36864
ds_read_b64_tr_b16 a[164:165], v190 offset:40960
ds_read_b64_tr_b16 a[166:167], v190 offset:45056
v_xor_b32 v191, 224, v18
v_xor_b32 v184, 0, v18
v_xor_b32 v185, 32, v18
v_xor_b32 v186, 64, v18
v_xor_b32 v187, 96, v18
s_waitcnt lgkmcnt(12)
v_or3_b32 v248, v248, v249, v250
v_or_b32 v248, v248, v251
s_nop 0
v_readfirstlane_b32 s66, v248
s_nop 0
s_cmp_gt_u32 s66, s73
s_cbranch_scc1 L_fallback_11
s_cmp_eq_u32 s83, 0
s_cbranch_scc1 L_p5f0
s_waitcnt lgkmcnt(10)
s_waitcnt vmcnt(28)
v_mfma_f32_16x16x32_bf16 v[136:139], a[144:147], a[232:235], 0
s_waitcnt vmcnt(24)
s_waitcnt lgkmcnt(8)
s_add_u32 m0, s86, 98304
ds_read_b64_tr_b16 a[168:169], v191 offset:32768
v_xor_b32 v192, 0x10000, v184
v_mfma_f32_16x16x32_bf16 v[136:139], a[148:151], a[236:239], v[136:139]
s_add_u32 s64, s85, 524288
ds_read_b64_tr_b16 a[170:171], v191 offset:36864
v_xor_b32 v193, 0x10000, v185
v_mfma_f32_16x16x32_bf16 v[104:107], a[148:151], a[228:231], 0
buffer_load_dwordx4 v12, s[36:39], s64 offen lds
v_mfma_f32_16x16x32_bf16 v[104:107], a[144:147], a[224:227], v[104:107]
s_add_u32 m0, s86, 99328
s_add_u32 s64, s85, 532480
ds_read_b64_tr_b16 a[172:173], v191 offset:40960
v_xor_b32 v194, 0x10000, v186
v_mfma_f32_16x16x32_bf16 v[72:75], a[144:147], a[216:219], 0
s_and_b32 s71, s31, 4
buffer_load_dwordx4 v13, s[36:39], s64 offen lds
v_mfma_f32_16x16x32_bf16 v[72:75], a[148:151], a[220:223], v[72:75]
s_lshl_b32 s71, s71, 5
s_add_u32 s71, s71, s79
s_add_u32 m0, s86, 100352
s_add_u32 s64, s85, 540672
ds_read_b64_tr_b16 a[174:175], v191 offset:45056
v_mfma_f32_16x16x32_bf16 v[40:43], a[148:151], a[212:215], 0
s_add_u32 s71, s71, 4096
buffer_load_dwordx4 v12, s[36:39], s64 offen lds
v_mfma_f32_16x16x32_bf16 v[40:43], a[144:147], a[208:211], v[40:43]
s_waitcnt lgkmcnt(4)
s_add_u32 s72, s80, 4096
s_add_u32 m0, s86, 101376
s_add_u32 s64, s85, 548864
ds_read_b64_tr_b16 a[176:177], v184 offset:32768
v_xor_b32 v195, 0x10000, v187
v_mfma_f32_16x16x32_bf16 v[44:47], a[152:155], a[208:211], 0
buffer_load_dwordx4 v13, s[36:39], s64 offen lds
v_mfma_f32_16x16x32_bf16 v[44:47], a[156:159], a[212:215], v[44:47]
s_add_u32 m0, s86, 102400
ds_read_b64_tr_b16 a[178:179], v184 offset:36864
v_xor_b32 v196, 0x10000, v188
v_mfma_f32_16x16x32_bf16 v[76:79], a[156:159], a[220:223], 0
s_add_u32 s64, s85, 557056
ds_read_b64_tr_b16 a[180:181], v184 offset:40960
v_xor_b32 v197, 0x10000, v189
v_mfma_f32_16x16x32_bf16 v[76:79], a[152:155], a[216:219], v[76:79]
buffer_load_dwordx4 v12, s[36:39], s64 offen lds
v_mfma_f32_16x16x32_bf16 v[108:111], a[152:155], a[224:227], 0
s_add_u32 m0, s86, 103424
s_add_u32 s64, s85, 565248
ds_read_b64_tr_b16 a[182:183], v184 offset:45056
v_xor_b32 v198, 0x10000, v190
v_mfma_f32_16x16x32_bf16 v[108:111], a[156:159], a[228:231], v[108:111]
buffer_load_dwordx4 v13, s[36:39], s64 offen lds
v_mfma_f32_16x16x32_bf16 v[140:143], a[156:159], a[236:239], 0
s_add_u32 m0, s86, 104448
s_add_u32 s64, s85, 573440
ds_read_b64_tr_b16 a[184:185], v185 offset:32768
v_xor_b32 v199, 0x10000, v191
v_mfma_f32_16x16x32_bf16 v[140:143], a[152:155], a[232:235], v[140:143]
buffer_load_dwordx4 v12, s[36:39], s64 offen lds
v_mfma_f32_16x16x32_bf16 v[144:147], a[160:163], a[232:235], 0
s_add_u32 m0, s86, 105472
ds_read_b64_tr_b16 a[186:187], v185 offset:36864
v_mfma_f32_16x16x32_bf16 v[144:147], a[164:167], a[236:239], v[144:147]
s_add_u32 s64, s85, 581632
ds_read_b64_tr_b16 a[188:189], v185 offset:40960
v_mfma_f32_16x16x32_bf16 v[112:115], a[164:167], a[228:231], 0
buffer_load_dwordx4 v13, s[36:39], s64 offen lds
v_mfma_f32_16x16x32_bf16 v[112:115], a[160:163], a[224:227], v[112:115]
s_add_u32 s65, s84, 65536
ds_read_b64_tr_b16 a[190:191], v185 offset:45056
v_mfma_f32_16x16x32_bf16 v[80:83], a[160:163], a[216:219], 0
buffer_load_dwordx4 a[32:35], v14, s[44:47], s65 offen offset:0 sc1
v_mfma_f32_16x16x32_bf16 v[80:83], a[164:167], a[220:223], v[80:83]
ds_read_b64_tr_b16 a[192:193], v186 offset:32768
v_mfma_f32_16x16x32_bf16 v[48:51], a[164:167], a[212:215], 0
buffer_load_dwordx4 a[40:43], v14, s[44:47], s65 offen offset:1024 sc1
v_mfma_f32_16x16x32_bf16 v[48:51], a[160:163], a[208:211], v[48:51]
s_waitcnt lgkmcnt(4)
ds_read_b64_tr_b16 a[194:195], v186 offset:36864
v_mfma_f32_16x16x32_bf16 v[52:55], a[168:171], a[208:211], 0
ds_read_b64_tr_b16 a[196:197], v186 offset:40960
v_mfma_f32_16x16x32_bf16 v[52:55], a[172:175], a[212:215], v[52:55]
buffer_load_dwordx4 a[48:51], v15, s[44:47], s65 offen offset:0 sc1
v_mfma_f32_16x16x32_bf16 v[84:87], a[172:175], a[220:223], 0
ds_read_b64_tr_b16 a[198:199], v186 offset:45056
v_mfma_f32_16x16x32_bf16 v[84:87], a[168:171], a[216:219], v[84:87]
buffer_load_dwordx4 a[56:59], v15, s[44:47], s65 offen offset:1024 sc1
v_mfma_f32_16x16x32_bf16 v[116:119], a[168:171], a[224:227], 0
s_add_u32 s65, s84, 73728
ds_read_b64_tr_b16 a[200:201], v187 offset:32768
v_mfma_f32_16x16x32_bf16 v[116:119], a[172:175], a[228:231], v[116:119]
buffer_load_dwordx4 a[36:39], v14, s[44:47], s65 offen offset:0 sc1
v_mfma_f32_16x16x32_bf16 v[148:151], a[172:175], a[236:239], 0
ds_read_b64_tr_b16 a[202:203], v187 offset:36864
v_mfma_f32_16x16x32_bf16 v[148:151], a[168:171], a[232:235], v[148:151]
ds_read_b64_tr_b16 a[204:205], v187 offset:40960
v_mfma_f32_16x16x32_bf16 v[120:123], a[176:179], a[232:235], 0
buffer_load_dwordx4 a[44:47], v14, s[44:47], s65 offen offset:1024 sc1
v_mfma_f32_16x16x32_bf16 v[120:123], a[180:183], a[236:239], v[120:123]
ds_read_b64_tr_b16 a[206:207], v187 offset:45056
v_mfma_f32_16x16x32_bf16 v[88:91], a[180:183], a[228:231], 0
buffer_load_dwordx4 a[52:55], v15, s[44:47], s65 offen offset:0 sc1
v_mfma_f32_16x16x32_bf16 v[88:91], a[176:179], a[224:227], v[88:91]
v_mfma_f32_16x16x32_bf16 v[56:59], a[176:179], a[216:219], 0
buffer_load_dwordx4 a[60:63], v15, s[44:47], s65 offen offset:1024 sc1
v_mfma_f32_16x16x32_bf16 v[56:59], a[180:183], a[220:223], v[56:59]
v_mfma_f32_16x16x32_bf16 v[24:27], a[180:183], a[212:215], 0
v_mfma_f32_16x16x32_bf16 v[24:27], a[176:179], a[208:211], v[24:27]
s_waitcnt lgkmcnt(1)
buffer_load_dword v19, off, s[52:55], s72 sc1
v_mfma_f32_16x16x32_bf16 v[28:31], a[184:187], a[208:211], 0
s_add_u32 s85, s85, 2883584
s_waitcnt vmcnt(24) lgkmcnt(0)
s_barrier
v_mfma_f32_16x16x32_bf16 v[28:31], a[188:191], a[212:215], v[28:31]
ds_read_b64_tr_b16 a[144:145], v196 offset:0
v_mfma_f32_16x16x32_bf16 v[60:63], a[188:191], a[220:223], 0
ds_read_b64_tr_b16 a[146:147], v196 offset:4096
v_mfma_f32_16x16x32_bf16 v[60:63], a[184:187], a[216:219], v[60:63]
s_add_u32 m0, s86, 131072
ds_read_b64_tr_b16 a[148:149], v196 offset:8192
v_mfma_f32_16x16x32_bf16 v[92:95], a[184:187], a[224:227], 0
s_add_u32 s64, s85, 0
ds_read_b64_tr_b16 a[150:151], v196 offset:12288
v_mfma_f32_16x16x32_bf16 v[92:95], a[188:191], a[228:231], v[92:95]
buffer_load_dwordx4 v12, s[40:43], s64 offen lds
v_mfma_f32_16x16x32_bf16 v[124:127], a[188:191], a[236:239], 0
s_add_u32 m0, s86, 132096
ds_read_b64_tr_b16 a[152:153], v197 offset:0
v_mfma_f32_16x16x32_bf16 v[124:127], a[184:187], a[232:235], v[124:127]
s_add_u32 s64, s85, 8192
ds_read_b64_tr_b16 a[154:155], v197 offset:4096
v_mfma_f32_16x16x32_bf16 v[128:131], a[192:195], a[232:235], 0
buffer_load_dwordx4 v13, s[40:43], s64 offen lds
v_mfma_f32_16x16x32_bf16 v[128:131], a[196:199], a[236:239], v[128:131]
ds_read_b64_tr_b16 a[156:157], v197 offset:8192
v_mfma_f32_16x16x32_bf16 v[96:99], a[196:199], a[228:231], 0
s_add_u32 m0, s86, 133120
ds_read_b64_tr_b16 a[158:159], v197 offset:12288
v_mfma_f32_16x16x32_bf16 v[96:99], a[192:195], a[224:227], v[96:99]
s_add_u32 s64, s85, 16384
ds_read_b64_tr_b16 a[160:161], v198 offset:0
v_mfma_f32_16x16x32_bf16 v[64:67], a[192:195], a[216:219], 0
buffer_load_dwordx4 v12, s[40:43], s64 offen lds
v_mfma_f32_16x16x32_bf16 v[64:67], a[196:199], a[220:223], v[64:67]
ds_read_b64_tr_b16 a[162:163], v198 offset:4096
v_mfma_f32_16x16x32_bf16 v[32:35], a[196:199], a[212:215], 0
s_add_u32 m0, s86, 134144
ds_read_b64_tr_b16 a[164:165], v198 offset:8192
v_mfma_f32_16x16x32_bf16 v[32:35], a[192:195], a[208:211], v[32:35]
s_add_u32 s64, s85, 24576
ds_read_b64_tr_b16 a[166:167], v198 offset:12288
v_mfma_f32_16x16x32_bf16 v[36:39], a[200:203], a[208:211], 0
buffer_load_dwordx4 v13, s[40:43], s64 offen lds
v_mfma_f32_16x16x32_bf16 v[36:39], a[204:207], a[212:215], v[36:39]
v_mfma_f32_16x16x32_bf16 v[68:71], a[204:207], a[220:223], 0
s_add_u32 m0, s86, 135168
v_mfma_f32_16x16x32_bf16 v[68:71], a[200:203], a[216:219], v[68:71]
s_add_u32 s64, s85, 32768
v_mfma_f32_16x16x32_bf16 v[100:103], a[200:203], a[224:227], 0
buffer_load_dwordx4 v12, s[40:43], s64 offen lds
v_mfma_f32_16x16x32_bf16 v[100:103], a[204:207], a[228:231], v[100:103]
v_mfma_f32_16x16x32_bf16 v[132:135], a[204:207], a[236:239], 0
v_mfma_f32_16x16x32_bf16 v[132:135], a[200:203], a[232:235], v[132:135]
s_waitcnt lgkmcnt(0)
v_mfma_f32_16x16x32_bf16 v[136:139], a[144:147], v[176:179], v[136:139]
s_waitcnt vmcnt(5)
v_readfirstlane_b32 vcc_lo, v19
s_nop 0
s_cmp_lt_u32 vcc_lo, 8
s_cbranch_scc1 L_spin_2016
L_spinbk_2017:
s_sub_u32 s84, s84, 688128
v_mfma_f32_16x16x32_bf16 v[136:139], a[148:151], v[180:183], v[136:139]
s_add_u32 m0, s86, 136192
s_add_u32 s64, s85, 40960
ds_read_b64_tr_b16 a[168:169], v199 offset:0
v_mfma_f32_16x16x32_bf16 v[104:107], a[148:151], v[172:175], v[104:107]
buffer_load_dwordx4 v13, s[40:43], s64 offen lds
v_mfma_f32_16x16x32_bf16 v[104:107], a[144:147], v[168:171], v[104:107]
s_add_u32 m0, s86, 137216
ds_read_b64_tr_b16 a[170:171], v199 offset:4096
v_mfma_f32_16x16x32_bf16 v[72:75], a[144:147], v[160:163], v[72:75]
s_add_u32 s64, s85, 49152
ds_read_b64_tr_b16 a[172:173], v199 offset:8192
v_mfma_f32_16x16x32_bf16 v[72:75], a[148:151], v[164:167], v[72:75]
buffer_load_dwordx4 v12, s[40:43], s64 offen lds
v_mfma_f32_16x16x32_bf16 v[40:43], a[148:151], v[156:159], v[40:43]
s_add_u32 m0, s86, 138240
ds_read_b64_tr_b16 a[174:175], v199 offset:12288
v_mfma_f32_16x16x32_bf16 v[40:43], a[144:147], v[152:155], v[40:43]
s_add_u32 s64, s85, 57344
ds_read_b64_tr_b16 a[176:177], v192 offset:0
v_mfma_f32_16x16x32_bf16 v[44:47], a[152:155], v[152:155], v[44:47]
buffer_load_dwordx4 v13, s[40:43], s64 offen lds
v_mfma_f32_16x16x32_bf16 v[44:47], a[156:159], v[156:159], v[44:47]
ds_read_b64_tr_b16 a[178:179], v192 offset:4096
v_mfma_f32_16x16x32_bf16 v[76:79], a[156:159], v[164:167], v[76:79]
ds_read_b64_tr_b16 a[180:181], v192 offset:8192
v_mfma_f32_16x16x32_bf16 v[76:79], a[152:155], v[160:163], v[76:79]
s_add_u32 s65, s84, 0
ds_read_b64_tr_b16 a[182:183], v192 offset:12288
v_mfma_f32_16x16x32_bf16 v[108:111], a[152:155], v[168:171], v[108:111]
buffer_load_dwordx4 a[208:211], v14, s[44:47], s65 offen offset:0 sc1
v_mfma_f32_16x16x32_bf16 v[108:111], a[156:159], v[172:175], v[108:111]
ds_read_b64_tr_b16 a[184:185], v193 offset:0
v_mfma_f32_16x16x32_bf16 v[140:143], a[156:159], v[180:183], v[140:143]
ds_read_b64_tr_b16 a[186:187], v193 offset:4096
v_mfma_f32_16x16x32_bf16 v[140:143], a[152:155], v[176:179], v[140:143]
buffer_load_dwordx4 a[216:219], v14, s[44:47], s65 offen offset:1024 sc1
v_mfma_f32_16x16x32_bf16 v[144:147], a[160:163], v[176:179], v[144:147]
ds_read_b64_tr_b16 a[188:189], v193 offset:8192
v_mfma_f32_16x16x32_bf16 v[144:147], a[164:167], v[180:183], v[144:147]
ds_read_b64_tr_b16 a[190:191], v193 offset:12288
v_mfma_f32_16x16x32_bf16 v[112:115], a[164:167], v[172:175], v[112:115]
s_add_u32 s17, s78, L_p5loop-L_pc+0
buffer_load_dwordx4 a[224:227], v15, s[44:47], s65 offen offset:0 sc1
v_mfma_f32_16x16x32_bf16 v[112:115], a[160:163], v[168:171], v[112:115]
buffer_load_dword a252, v16, s[88:91], s17 offen
v_mfma_f32_16x16x32_bf16 v[80:83], a[160:163], v[160:163], v[80:83]
ds_read_b64_tr_b16 a[192:193], v194 offset:0
v_mfma_f32_16x16x32_bf16 v[80:83], a[164:167], v[164:167], v[80:83]
ds_read_b64_tr_b16 a[194:195], v194 offset:4096
v_mfma_f32_16x16x32_bf16 v[48:51], a[164:167], v[156:159], v[48:51]
buffer_load_dwordx4 a[232:235], v15, s[44:47], s65 offen offset:1024 sc1
v_mfma_f32_16x16x32_bf16 v[48:51], a[160:163], v[152:155], v[48:51]
s_waitcnt lgkmcnt(4)
ds_read_b64_tr_b16 a[196:197], v194 offset:8192
v_mfma_f32_16x16x32_bf16 v[52:55], a[168:171], v[152:155], v[52:55]
s_add_u32 s65, s84, 8192
ds_read_b64_tr_b16 a[198:199], v194 offset:12288
v_mfma_f32_16x16x32_bf16 v[52:55], a[172:175], v[156:159], v[52:55]
s_add_u32 s17, s78, L_p5loop-L_pc+4096
buffer_load_dwordx4 a[212:215], v14, s[44:47], s65 offen offset:0 sc1
v_mfma_f32_16x16x32_bf16 v[84:87], a[172:175], v[164:167], v[84:87]
buffer_load_dword a252, v16, s[88:91], s17 offen
v_mfma_f32_16x16x32_bf16 v[84:87], a[168:171], v[160:163], v[84:87]
ds_read_b64_tr_b16 a[200:201], v195 offset:0
v_mfma_f32_16x16x32_bf16 v[116:119], a[168:171], v[168:171], v[116:119]
s_lshl_b32 s66, s30, 30
buffer_load_dwordx4 a[220:223], v14, s[44:47], s65 offen offset:1024 sc1
v_mfma_f32_16x16x32_bf16 v[116:119], a[172:175], v[172:175], v[116:119]
ds_read_b64_tr_b16 a[202:203], v195 offset:4096
v_lshl_add_u32 v1, v0, 24, s66
v_mfma_f32_16x16x32_bf16 v[148:151], a[172:175], v[180:183], v[148:151]
ds_read_b64_tr_b16 a[204:205], v195 offset:8192
v_mfma_f32_16x16x32_bf16 v[148:151], a[168:171], v[176:179], v[148:151]
ds_read_b64_tr_b16 a[206:207], v195 offset:12288
v_mfma_f32_16x16x32_bf16 v[120:123], a[176:179], v[176:179], v[120:123]
s_add_u32 s17, s78, L_p5loop-L_pc+8192
buffer_load_dwordx4 a[228:231], v15, s[44:47], s65 offen offset:0 sc1
v_mfma_f32_16x16x32_bf16 v[120:123], a[180:183], v[180:183], v[120:123]
buffer_load_dword a252, v16, s[88:91], s17 offen
v_mfma_f32_16x16x32_bf16 v[88:91], a[180:183], v[172:175], v[88:91]
v_mfma_f32_16x16x32_bf16 v[88:91], a[176:179], v[168:171], v[88:91]
buffer_load_dwordx4 a[236:239], v15, s[44:47], s65 offen offset:1024 sc1
v_mfma_f32_16x16x32_bf16 v[56:59], a[176:179], v[160:163], v[56:59]
v_mfma_f32_16x16x32_bf16 v[56:59], a[180:183], v[164:167], v[56:59]
v_mfma_f32_16x16x32_bf16 v[24:27], a[180:183], v[156:159], v[24:27]
v_mfma_f32_16x16x32_bf16 v[24:27], a[176:179], v[152:155], v[24:27]
v_mfma_f32_16x16x32_bf16 v[28:31], a[184:187], v[152:155], v[28:31]
s_waitcnt lgkmcnt(0)
s_barrier
v_mfma_f32_16x16x32_bf16 v[28:31], a[188:191], v[156:159], v[28:31]
s_mov_b64 exec, 1
buffer_atomic_add a251, v1, s[52:55], s71 offen offset:0 sc1
s_mov_b64 exec, -1
v_mfma_f32_16x16x32_bf16 v[60:63], a[188:191], v[164:167], v[60:63]
ds_read_b64_tr_b16 a[144:145], v188 offset:0
v_mfma_f32_16x16x32_bf16 v[60:63], a[184:187], v[160:163], v[60:63]
s_add_u32 m0, s86, 32768
ds_read_b64_tr_b16 a[146:147], v188 offset:4096
v_mfma_f32_16x16x32_bf16 v[92:95], a[184:187], v[168:171], v[92:95]
s_add_u32 s64, s85, 262144
ds_read_b64_tr_b16 a[148:149], v188 offset:8192
v_mfma_f32_16x16x32_bf16 v[92:95], a[188:191], v[172:175], v[92:95]
buffer_load_dwordx4 v12, s[40:43], s64 offen lds
v_mfma_f32_16x16x32_bf16 v[124:127], a[188:191], v[180:183], v[124:127]
s_add_u32 m0, s86, 33792
ds_read_b64_tr_b16 a[150:151], v188 offset:12288
v_mfma_f32_16x16x32_bf16 v[124:127], a[184:187], v[176:179], v[124:127]
s_add_u32 s64, s85, 270336
ds_read_b64_tr_b16 a[152:153], v189 offset:0
v_mfma_f32_16x16x32_bf16 v[128:131], a[192:195], v[176:179], v[128:131]
buffer_load_dwordx4 v13, s[40:43], s64 offen lds
v_mfma_f32_16x16x32_bf16 v[128:131], a[196:199], v[180:183], v[128:131]
ds_read_b64_tr_b16 a[154:155], v189 offset:4096
v_mfma_f32_16x16x32_bf16 v[96:99], a[196:199], v[172:175], v[96:99]
s_add_u32 m0, s86, 34816
ds_read_b64_tr_b16 a[156:157], v189 offset:8192
v_mfma_f32_16x16x32_bf16 v[96:99], a[192:195], v[168:171], v[96:99]
s_add_u32 s64, s85, 278528
ds_read_b64_tr_b16 a[158:159], v189 offset:12288
v_mfma_f32_16x16x32_bf16 v[64:67], a[192:195], v[160:163], v[64:67]
buffer_load_dwordx4 v12, s[40:43], s64 offen lds
v_mfma_f32_16x16x32_bf16 v[64:67], a[196:199], v[164:167], v[64:67]
ds_read_b64_tr_b16 a[160:161], v190 offset:0
v_mfma_f32_16x16x32_bf16 v[32:35], a[196:199], v[156:159], v[32:35]
s_add_u32 m0, s86, 35840
ds_read_b64_tr_b16 a[162:163], v190 offset:4096
v_mfma_f32_16x16x32_bf16 v[32:35], a[192:195], v[152:155], v[32:35]
s_add_u32 s64, s85, 286720
ds_read_b64_tr_b16 a[164:165], v190 offset:8192
v_mfma_f32_16x16x32_bf16 v[36:39], a[200:203], v[152:155], v[36:39]
buffer_load_dwordx4 v13, s[40:43], s64 offen lds
v_mfma_f32_16x16x32_bf16 v[36:39], a[204:207], v[156:159], v[36:39]
ds_read_b64_tr_b16 a[166:167], v190 offset:12288
v_mfma_f32_16x16x32_bf16 v[68:71], a[204:207], v[164:167], v[68:71]
s_add_u32 m0, s86, 36864
v_mfma_f32_16x16x32_bf16 v[68:71], a[200:203], v[160:163], v[68:71]
s_add_u32 s64, s85, 294912
v_mfma_f32_16x16x32_bf16 v[100:103], a[200:203], v[168:171], v[100:103]
buffer_load_dwordx4 v12, s[40:43], s64 offen lds
v_mfma_f32_16x16x32_bf16 v[100:103], a[204:207], v[172:175], v[100:103]
v_mfma_f32_16x16x32_bf16 v[132:135], a[204:207], v[180:183], v[132:135]
v_mfma_f32_16x16x32_bf16 v[132:135], a[200:203], v[176:179], v[132:135]
s_waitcnt lgkmcnt(1)
v_mfma_f32_16x16x32_bf16 v[136:139], a[144:147], a[56:59], v[136:139]
s_add_u32 m0, s86, 37888
ds_read_b64_tr_b16 a[168:169], v191 offset:0
v_mfma_f32_16x16x32_bf16 v[136:139], a[148:151], a[60:63], v[136:139]
s_add_u32 s64, s85, 303104
ds_read_b64_tr_b16 a[170:171], v191 offset:4096
v_mfma_f32_16x16x32_bf16 v[104:107], a[148:151], a[52:55], v[104:107]
buffer_load_dwordx4 v13, s[40:43], s64 offen lds
v_mfma_f32_16x16x32_bf16 v[104:107], a[144:147], a[48:51], v[104:107]
s_add_u32 m0, s86, 38912
ds_read_b64_tr_b16 a[172:173], v191 offset:8192
v_mfma_f32_16x16x32_bf16 v[72:75], a[144:147], a[40:43], v[72:75]
s_add_u32 s64, s85, 311296
ds_read_b64_tr_b16 a[174:175], v191 offset:12288
v_mfma_f32_16x16x32_bf16 v[72:75], a[148:151], a[44:47], v[72:75]
buffer_load_dwordx4 v12, s[40:43], s64 offen lds
v_mfma_f32_16x16x32_bf16 v[40:43], a[148:151], a[36:39], v[40:43]
s_add_u32 m0, s86, 39936
ds_read_b64_tr_b16 a[176:177], v184 offset:0
v_mfma_f32_16x16x32_bf16 v[40:43], a[144:147], a[32:35], v[40:43]
s_add_u32 s64, s85, 319488
ds_read_b64_tr_b16 a[178:179], v184 offset:4096
v_mfma_f32_16x16x32_bf16 v[44:47], a[152:155], a[32:35], v[44:47]
buffer_load_dwordx4 v13, s[40:43], s64 offen lds
v_mfma_f32_16x16x32_bf16 v[44:47], a[156:159], a[36:39], v[44:47]
ds_read_b64_tr_b16 a[180:181], v184 offset:8192
v_mfma_f32_16x16x32_bf16 v[76:79], a[156:159], a[44:47], v[76:79]
ds_read_b64_tr_b16 a[182:183], v184 offset:12288
v_mfma_f32_16x16x32_bf16 v[76:79], a[152:155], a[40:43], v[76:79]
s_add_u32 s65, s84, 32768
ds_read_b64_tr_b16 a[184:185], v185 offset:0
v_mfma_f32_16x16x32_bf16 v[108:111], a[152:155], a[48:51], v[108:111]
buffer_load_dwordx4 v[152:155], v14, s[44:47], s65 offen offset:0 sc1
v_mfma_f32_16x16x32_bf16 v[108:111], a[156:159], a[52:55], v[108:111]
ds_read_b64_tr_b16 a[186:187], v185 offset:4096
v_mfma_f32_16x16x32_bf16 v[140:143], a[156:159], a[60:63], v[140:143]
ds_read_b64_tr_b16 a[188:189], v185 offset:8192
v_mfma_f32_16x16x32_bf16 v[140:143], a[152:155], a[56:59], v[140:143]
buffer_load_dwordx4 v[160:163], v14, s[44:47], s65 offen offset:1024 sc1
v_mfma_f32_16x16x32_bf16 v[144:147], a[160:163], a[56:59], v[144:147]
s_waitcnt lgkmcnt(5)
ds_read_b64_tr_b16 a[190:191], v185 offset:12288
v_mfma_f32_16x16x32_bf16 v[144:147], a[164:167], a[60:63], v[144:147]
v_mfma_f32_16x16x32_bf16 v[112:115], a[164:167], a[52:55], v[112:115]
buffer_load_dwordx4 v[168:171], v15, s[44:47], s65 offen offset:0 sc1
v_mfma_f32_16x16x32_bf16 v[112:115], a[160:163], a[48:51], v[112:115]
ds_read_b64_tr_b16 a[192:193], v186 offset:0
v_mfma_f32_16x16x32_bf16 v[80:83], a[160:163], a[40:43], v[80:83]
ds_read_b64_tr_b16 a[194:195], v186 offset:4096
v_mfma_f32_16x16x32_bf16 v[80:83], a[164:167], a[44:47], v[80:83]
ds_read_b64_tr_b16 a[196:197], v186 offset:8192
v_mfma_f32_16x16x32_bf16 v[48:51], a[164:167], a[36:39], v[48:51]
buffer_load_dwordx4 v[176:179], v15, s[44:47], s65 offen offset:1024 sc1
v_mfma_f32_16x16x32_bf16 v[48:51], a[160:163], a[32:35], v[48:51]
ds_read_b64_tr_b16 a[198:199], v186 offset:12288
v_mfma_f32_16x16x32_bf16 v[52:55], a[168:171], a[32:35], v[52:55]
s_add_u32 s65, s84, 40960
v_mfma_f32_16x16x32_bf16 v[52:55], a[172:175], a[36:39], v[52:55]
buffer_load_dwordx4 v[156:159], v14, s[44:47], s65 offen offset:0 sc1
v_mfma_f32_16x16x32_bf16 v[84:87], a[172:175], a[44:47], v[84:87]
ds_read_b64_tr_b16 a[200:201], v187 offset:0
v_mfma_f32_16x16x32_bf16 v[84:87], a[168:171], a[40:43], v[84:87]
ds_read_b64_tr_b16 a[202:203], v187 offset:4096
v_mfma_f32_16x16x32_bf16 v[116:119], a[168:171], a[48:51], v[116:119]
buffer_load_dwordx4 v[164:167], v14, s[44:47], s65 offen offset:1024 sc1
v_mfma_f32_16x16x32_bf16 v[116:119], a[172:175], a[52:55], v[116:119]
ds_read_b64_tr_b16 a[204:205], v187 offset:8192
v_mfma_f32_16x16x32_bf16 v[148:151], a[172:175], a[60:63], v[148:151]
ds_read_b64_tr_b16 a[206:207], v187 offset:12288
v_mfma_f32_16x16x32_bf16 v[148:151], a[168:171], a[56:59], v[148:151]
v_mfma_f32_16x16x32_bf16 v[120:123], a[176:179], a[56:59], v[120:123]
s_waitcnt lgkmcnt(4)
buffer_load_dwordx4 v[172:175], v15, s[44:47], s65 offen offset:0 sc1
v_mfma_f32_16x16x32_bf16 v[120:123], a[180:183], a[60:63], v[120:123]
v_mfma_f32_16x16x32_bf16 v[88:91], a[180:183], a[52:55], v[88:91]
v_mfma_f32_16x16x32_bf16 v[88:91], a[176:179], a[48:51], v[88:91]
buffer_load_dwordx4 v[180:183], v15, s[44:47], s65 offen offset:1024 sc1
v_mfma_f32_16x16x32_bf16 v[56:59], a[176:179], a[40:43], v[56:59]
v_mfma_f32_16x16x32_bf16 v[56:59], a[180:183], a[44:47], v[56:59]
v_mfma_f32_16x16x32_bf16 v[24:27], a[180:183], a[36:39], v[24:27]
v_mfma_f32_16x16x32_bf16 v[24:27], a[176:179], a[32:35], v[24:27]
v_mfma_f32_16x16x32_bf16 v[28:31], a[184:187], a[32:35], v[28:31]
s_waitcnt vmcnt(28)
s_barrier
v_mfma_f32_16x16x32_bf16 v[28:31], a[188:191], a[36:39], v[28:31]
ds_read_b64_tr_b16 a[144:145], v188 offset:32768
v_mfma_f32_16x16x32_bf16 v[60:63], a[188:191], a[44:47], v[60:63]
ds_read_b64_tr_b16 a[146:147], v188 offset:36864
v_mfma_f32_16x16x32_bf16 v[60:63], a[184:187], a[40:43], v[60:63]
s_add_u32 m0, s86, 65536
ds_read_b64_tr_b16 a[148:149], v188 offset:40960
v_mfma_f32_16x16x32_bf16 v[92:95], a[184:187], a[48:51], v[92:95]
s_add_u32 s64, s85, 524288
ds_read_b64_tr_b16 a[150:151], v188 offset:45056
v_mfma_f32_16x16x32_bf16 v[92:95], a[188:191], a[52:55], v[92:95]
buffer_load_dwordx4 v12, s[40:43], s64 offen lds
v_mfma_f32_16x16x32_bf16 v[124:127], a[188:191], a[60:63], v[124:127]
s_add_u32 m0, s86, 66560
ds_read_b64_tr_b16 a[152:153], v189 offset:32768
v_mfma_f32_16x16x32_bf16 v[124:127], a[184:187], a[56:59], v[124:127]
s_add_u32 s64, s85, 532480
ds_read_b64_tr_b16 a[154:155], v189 offset:36864
v_mfma_f32_16x16x32_bf16 v[128:131], a[192:195], a[56:59], v[128:131]
buffer_load_dwordx4 v13, s[40:43], s64 offen lds
v_mfma_f32_16x16x32_bf16 v[128:131], a[196:199], a[60:63], v[128:131]
ds_read_b64_tr_b16 a[156:157], v189 offset:40960
v_mfma_f32_16x16x32_bf16 v[96:99], a[196:199], a[52:55], v[96:99]
s_add_u32 m0, s86, 67584
ds_read_b64_tr_b16 a[158:159], v189 offset:45056
v_mfma_f32_16x16x32_bf16 v[96:99], a[192:195], a[48:51], v[96:99]
s_add_u32 s64, s85, 540672
ds_read_b64_tr_b16 a[160:161], v190 offset:32768
v_mfma_f32_16x16x32_bf16 v[64:67], a[192:195], a[40:43], v[64:67]
buffer_load_dwordx4 v12, s[40:43], s64 offen lds
v_mfma_f32_16x16x32_bf16 v[64:67], a[196:199], a[44:47], v[64:67]
ds_read_b64_tr_b16 a[162:163], v190 offset:36864
v_mfma_f32_16x16x32_bf16 v[32:35], a[196:199], a[36:39], v[32:35]
s_add_u32 m0, s86, 68608
ds_read_b64_tr_b16 a[164:165], v190 offset:40960
v_mfma_f32_16x16x32_bf16 v[32:35], a[192:195], a[32:35], v[32:35]
s_waitcnt lgkmcnt(5)
s_add_u32 s64, s85, 548864
ds_read_b64_tr_b16 a[166:167], v190 offset:45056
v_mfma_f32_16x16x32_bf16 v[36:39], a[200:203], a[32:35], v[36:39]
buffer_load_dwordx4 v13, s[40:43], s64 offen lds
v_mfma_f32_16x16x32_bf16 v[36:39], a[204:207], a[36:39], v[36:39]
v_mfma_f32_16x16x32_bf16 v[68:71], a[204:207], a[44:47], v[68:71]
s_add_u32 m0, s86, 69632
v_mfma_f32_16x16x32_bf16 v[68:71], a[200:203], a[40:43], v[68:71]
s_add_u32 s64, s85, 557056
v_mfma_f32_16x16x32_bf16 v[100:103], a[200:203], a[48:51], v[100:103]
buffer_load_dwordx4 v12, s[40:43], s64 offen lds
v_mfma_f32_16x16x32_bf16 v[100:103], a[204:207], a[52:55], v[100:103]
s_mov_b32 s70, 3
s_mov_b32 s73, 2
v_mfma_f32_16x16x32_bf16 v[132:135], a[204:207], a[60:63], v[132:135]
v_mfma_f32_16x16x32_bf16 v[132:135], a[200:203], a[56:59], v[132:135]
L_p5join:
.p2align 3
L_p5loop:
s_waitcnt lgkmcnt(10)
s_waitcnt vmcnt(19)
v_mfma_f32_16x16x32_bf16 v[136:139], a[144:147], a[232:235], v[136:139]
s_waitcnt vmcnt(15)
s_waitcnt lgkmcnt(8)
s_add_u32 m0, s86, 70656
s_add_u32 s64, s85, 565248
ds_read_b64_tr_b16 a[168:169], v191 offset:32768
v_mfma_f32_16x16x32_bf16 v[136:139], a[148:151], a[236:239], v[136:139]
buffer_load_dwordx4 v13, s[40:43], s64 offen lds
v_mfma_f32_16x16x32_bf16 v[104:107], a[148:151], a[228:231], v[104:107]
s_add_u32 m0, s86, 71680
ds_read_b64_tr_b16 a[170:171], v191 offset:36864
v_mfma_f32_16x16x32_bf16 v[104:107], a[144:147], a[224:227], v[104:107]
s_add_u32 s64, s85, 573440
ds_read_b64_tr_b16 a[172:173], v191 offset:40960
v_mfma_f32_16x16x32_bf16 v[72:75], a[144:147], a[216:219], v[72:75]
buffer_load_dwordx4 v12, s[40:43], s64 offen lds
v_mfma_f32_16x16x32_bf16 v[72:75], a[148:151], a[220:223], v[72:75]
s_add_u32 m0, s86, 72704
ds_read_b64_tr_b16 a[174:175], v191 offset:45056
v_mfma_f32_16x16x32_bf16 v[40:43], a[148:151], a[212:215], v[40:43]
s_add_u32 s64, s85, 581632
ds_read_b64_tr_b16 a[176:177], v184 offset:32768
v_mfma_f32_16x16x32_bf16 v[40:43], a[144:147], a[208:211], v[40:43]
s_waitcnt lgkmcnt(5)
buffer_load_dwordx4 v13, s[40:43], s64 offen lds
v_mfma_f32_16x16x32_bf16 v[44:47], a[152:155], a[208:211], v[44:47]
ds_read_b64_tr_b16 a[178:179], v184 offset:36864
v_mfma_f32_16x16x32_bf16 v[44:47], a[156:159], a[212:215], v[44:47]
ds_read_b64_tr_b16 a[180:181], v184 offset:40960
v_mfma_f32_16x16x32_bf16 v[76:79], a[156:159], a[220:223], v[76:79]
s_add_u32 s65, s84, 65536
ds_read_b64_tr_b16 a[182:183], v184 offset:45056
v_mfma_f32_16x16x32_bf16 v[76:79], a[152:155], a[216:219], v[76:79]
buffer_load_dwordx4 a[0:3], v14, s[44:47], s65 offen offset:0 sc1
v_mfma_f32_16x16x32_bf16 v[108:111], a[152:155], a[224:227], v[108:111]
ds_read_b64_tr_b16 a[184:185], v185 offset:32768
v_mfma_f32_16x16x32_bf16 v[108:111], a[156:159], a[228:231], v[108:111]
ds_read_b64_tr_b16 a[186:187], v185 offset:36864
v_mfma_f32_16x16x32_bf16 v[140:143], a[156:159], a[236:239], v[140:143]
buffer_load_dwordx4 a[8:11], v14, s[44:47], s65 offen offset:1024 sc1
v_mfma_f32_16x16x32_bf16 v[140:143], a[152:155], a[232:235], v[140:143]
ds_read_b64_tr_b16 a[188:189], v185 offset:40960
v_mfma_f32_16x16x32_bf16 v[144:147], a[160:163], a[232:235], v[144:147]
ds_read_b64_tr_b16 a[190:191], v185 offset:45056
v_mfma_f32_16x16x32_bf16 v[144:147], a[164:167], a[236:239], v[144:147]
v_mfma_f32_16x16x32_bf16 v[112:115], a[164:167], a[228:231], v[112:115]
buffer_load_dwordx4 a[16:19], v15, s[44:47], s65 offen offset:0 sc1
v_mfma_f32_16x16x32_bf16 v[112:115], a[160:163], a[224:227], v[112:115]
ds_read_b64_tr_b16 a[192:193], v186 offset:32768
v_mfma_f32_16x16x32_bf16 v[80:83], a[160:163], a[216:219], v[80:83]
ds_read_b64_tr_b16 a[194:195], v186 offset:36864
v_mfma_f32_16x16x32_bf16 v[80:83], a[164:167], a[220:223], v[80:83]
buffer_load_dwordx4 a[24:27], v15, s[44:47], s65 offen offset:1024 sc1
v_mfma_f32_16x16x32_bf16 v[48:51], a[164:167], a[212:215], v[48:51]
ds_read_b64_tr_b16 a[196:197], v186 offset:40960
v_mfma_f32_16x16x32_bf16 v[48:51], a[160:163], a[208:211], v[48:51]
s_waitcnt lgkmcnt(4)
ds_read_b64_tr_b16 a[198:199], v186 offset:45056
v_mfma_f32_16x16x32_bf16 v[52:55], a[168:171], a[208:211], v[52:55]
s_add_u32 s65, s84, 73728
v_mfma_f32_16x16x32_bf16 v[52:55], a[172:175], a[212:215], v[52:55]
buffer_load_dwordx4 a[4:7], v14, s[44:47], s65 offen offset:0 sc1
v_mfma_f32_16x16x32_bf16 v[84:87], a[172:175], a[220:223], v[84:87]
ds_read_b64_tr_b16 a[200:201], v187 offset:32768
v_mfma_f32_16x16x32_bf16 v[84:87], a[168:171], a[216:219], v[84:87]
ds_read_b64_tr_b16 a[202:203], v187 offset:36864
v_mfma_f32_16x16x32_bf16 v[116:119], a[168:171], a[224:227], v[116:119]
buffer_load_dwordx4 a[12:15], v14, s[44:47], s65 offen offset:1024 sc1
v_mfma_f32_16x16x32_bf16 v[116:119], a[172:175], a[228:231], v[116:119]
ds_read_b64_tr_b16 a[204:205], v187 offset:40960
v_mfma_f32_16x16x32_bf16 v[148:151], a[172:175], a[236:239], v[148:151]
ds_read_b64_tr_b16 a[206:207], v187 offset:45056
v_mfma_f32_16x16x32_bf16 v[148:151], a[168:171], a[232:235], v[148:151]
v_mfma_f32_16x16x32_bf16 v[120:123], a[176:179], a[232:235], v[120:123]
buffer_load_dwordx4 a[20:23], v15, s[44:47], s65 offen offset:0 sc1
v_mfma_f32_16x16x32_bf16 v[120:123], a[180:183], a[236:239], v[120:123]
v_mfma_f32_16x16x32_bf16 v[88:91], a[180:183], a[228:231], v[88:91]
v_mfma_f32_16x16x32_bf16 v[88:91], a[176:179], a[224:227], v[88:91]
buffer_load_dwordx4 a[28:31], v15, s[44:47], s65 offen offset:1024 sc1
v_mfma_f32_16x16x32_bf16 v[56:59], a[176:179], a[216:219], v[56:59]
v_mfma_f32_16x16x32_bf16 v[56:59], a[180:183], a[220:223], v[56:59]
v_mfma_f32_16x16x32_bf16 v[24:27], a[180:183], a[212:215], v[24:27]
v_mfma_f32_16x16x32_bf16 v[24:27], a[176:179], a[208:211], v[24:27]
v_mfma_f32_16x16x32_bf16 v[28:31], a[184:187], a[208:211], v[28:31]
s_waitcnt vmcnt(24)
s_barrier
s_waitcnt lgkmcnt(0)
v_mfma_f32_16x16x32_bf16 v[28:31], a[188:191], a[212:215], v[28:31]
s_add_u32 m0, s86, 98304
ds_read_b64_tr_b16 a[144:145], v196 offset:0
v_mfma_f32_16x16x32_bf16 v[60:63], a[188:191], a[220:223], v[60:63]
s_add_u32 s64, s85, 786432
ds_read_b64_tr_b16 a[146:147], v196 offset:4096
v_mfma_f32_16x16x32_bf16 v[60:63], a[184:187], a[216:219], v[60:63]
buffer_load_dwordx4 v12, s[40:43], s64 offen lds
v_mfma_f32_16x16x32_bf16 v[92:95], a[184:187], a[224:227], v[92:95]
ds_read_b64_tr_b16 a[148:149], v196 offset:8192
v_mfma_f32_16x16x32_bf16 v[92:95], a[188:191], a[228:231], v[92:95]
s_add_u32 m0, s86, 99328
ds_read_b64_tr_b16 a[150:151], v196 offset:12288
v_mfma_f32_16x16x32_bf16 v[124:127], a[188:191], a[236:239], v[124:127]
s_add_u32 s64, s85, 794624
ds_read_b64_tr_b16 a[152:153], v197 offset:0
v_mfma_f32_16x16x32_bf16 v[124:127], a[184:187], a[232:235], v[124:127]
buffer_load_dwordx4 v13, s[40:43], s64 offen lds
v_mfma_f32_16x16x32_bf16 v[128:131], a[192:195], a[232:235], v[128:131]
ds_read_b64_tr_b16 a[154:155], v197 offset:4096
v_mfma_f32_16x16x32_bf16 v[128:131], a[196:199], a[236:239], v[128:131]
s_add_u32 m0, s86, 100352
ds_read_b64_tr_b16 a[156:157], v197 offset:8192
v_mfma_f32_16x16x32_bf16 v[96:99], a[196:199], a[228:231], v[96:99]
s_add_u32 s64, s85, 802816
ds_read_b64_tr_b16 a[158:159], v197 offset:12288
v_mfma_f32_16x16x32_bf16 v[96:99], a[192:195], a[224:227], v[96:99]
buffer_load_dwordx4 v12, s[40:43], s64 offen lds
v_mfma_f32_16x16x32_bf16 v[64:67], a[192:195], a[216:219], v[64:67]
ds_read_b64_tr_b16 a[160:161], v198 offset:0
v_mfma_f32_16x16x32_bf16 v[64:67], a[196:199], a[220:223], v[64:67]
s_add_u32 m0, s86, 101376
ds_read_b64_tr_b16 a[162:163], v198 offset:4096
v_mfma_f32_16x16x32_bf16 v[32:35], a[196:199], a[212:215], v[32:35]
s_add_u32 s64, s85, 811008
ds_read_b64_tr_b16 a[164:165], v198 offset:8192
v_mfma_f32_16x16x32_bf16 v[32:35], a[192:195], a[208:211], v[32:35]
buffer_load_dwordx4 v13, s[40:43], s64 offen lds
v_mfma_f32_16x16x32_bf16 v[36:39], a[200:203], a[208:211], v[36:39]
ds_read_b64_tr_b16 a[166:167], v198 offset:12288
v_mfma_f32_16x16x32_bf16 v[36:39], a[204:207], a[212:215], v[36:39]
s_add_u32 m0, s86, 102400
v_mfma_f32_16x16x32_bf16 v[68:71], a[204:207], a[220:223], v[68:71]
s_add_u32 s64, s85, 819200
v_mfma_f32_16x16x32_bf16 v[68:71], a[200:203], a[216:219], v[68:71]
buffer_load_dwordx4 v12, s[40:43], s64 offen lds
v_mfma_f32_16x16x32_bf16 v[100:103], a[200:203], a[224:227], v[100:103]
v_mfma_f32_16x16x32_bf16 v[100:103], a[204:207], a[228:231], v[100:103]
v_mfma_f32_16x16x32_bf16 v[132:135], a[204:207], a[236:239], v[132:135]
v_mfma_f32_16x16x32_bf16 v[132:135], a[200:203], a[232:235], v[132:135]
s_waitcnt vmcnt(25)
s_waitcnt lgkmcnt(1)
s_add_u32 m0, s86, 103424
buffer_load_dword v19, off, s[52:55], s72 offset:128 sc1
v_mfma_f32_16x16x32_bf16 v[136:139], a[144:147], v[176:179], v[136:139]
s_waitcnt vmcnt(22)
s_add_u32 s64, s85, 827392
ds_read_b64_tr_b16 a[168:169], v199 offset:0
v_mfma_f32_16x16x32_bf16 v[136:139], a[148:151], v[180:183], v[136:139]
buffer_load_dwordx4 v13, s[40:43], s64 offen lds
v_mfma_f32_16x16x32_bf16 v[104:107], a[148:151], v[172:175], v[104:107]
s_add_u32 m0, s86, 104448
ds_read_b64_tr_b16 a[170:171], v199 offset:4096
v_mfma_f32_16x16x32_bf16 v[104:107], a[144:147], v[168:171], v[104:107]
s_add_u32 s64, s85, 835584
ds_read_b64_tr_b16 a[172:173], v199 offset:8192
v_mfma_f32_16x16x32_bf16 v[72:75], a[144:147], v[160:163], v[72:75]
buffer_load_dwordx4 v12, s[40:43], s64 offen lds
v_mfma_f32_16x16x32_bf16 v[72:75], a[148:151], v[164:167], v[72:75]
s_add_u32 m0, s86, 105472
ds_read_b64_tr_b16 a[174:175], v199 offset:12288
v_mfma_f32_16x16x32_bf16 v[40:43], a[148:151], v[156:159], v[40:43]
s_add_u32 s64, s85, 843776
ds_read_b64_tr_b16 a[176:177], v192 offset:0
v_mfma_f32_16x16x32_bf16 v[40:43], a[144:147], v[152:155], v[40:43]
buffer_load_dwordx4 v13, s[40:43], s64 offen lds
v_mfma_f32_16x16x32_bf16 v[44:47], a[152:155], v[152:155], v[44:47]
ds_read_b64_tr_b16 a[178:179], v192 offset:4096
v_mfma_f32_16x16x32_bf16 v[44:47], a[156:159], v[156:159], v[44:47]
ds_read_b64_tr_b16 a[180:181], v192 offset:8192
v_mfma_f32_16x16x32_bf16 v[76:79], a[156:159], v[164:167], v[76:79]
s_add_u32 s65, s84, 98304
ds_read_b64_tr_b16 a[182:183], v192 offset:12288
v_mfma_f32_16x16x32_bf16 v[76:79], a[152:155], v[160:163], v[76:79]
buffer_load_dwordx4 a[32:35], v14, s[44:47], s65 offen offset:0 sc1
v_mfma_f32_16x16x32_bf16 v[108:111], a[152:155], v[168:171], v[108:111]
ds_read_b64_tr_b16 a[184:185], v193 offset:0
v_mfma_f32_16x16x32_bf16 v[108:111], a[156:159], v[172:175], v[108:111]
ds_read_b64_tr_b16 a[186:187], v193 offset:4096
v_mfma_f32_16x16x32_bf16 v[140:143], a[156:159], v[180:183], v[140:143]
buffer_load_dwordx4 a[40:43], v14, s[44:47], s65 offen offset:1024 sc1
v_mfma_f32_16x16x32_bf16 v[140:143], a[152:155], v[176:179], v[140:143]
ds_read_b64_tr_b16 a[188:189], v193 offset:8192
v_mfma_f32_16x16x32_bf16 v[144:147], a[160:163], v[176:179], v[144:147]
s_waitcnt lgkmcnt(5)
s_lshl_b32 s75, s73, 20
s_add_u32 s85, s85, s75
ds_read_b64_tr_b16 a[190:191], v193 offset:12288
v_mfma_f32_16x16x32_bf16 v[144:147], a[164:167], v[180:183], v[144:147]
s_lshr_b32 s74, s73, 28
s_and_b32 s74, s74, 8
v_mfma_f32_16x16x32_bf16 v[112:115], a[164:167], v[172:175], v[112:115]
buffer_load_dwordx4 a[48:51], v15, s[44:47], s65 offen offset:0 sc1
v_mfma_f32_16x16x32_bf16 v[112:115], a[160:163], v[168:171], v[112:115]
ds_read_b64_tr_b16 a[192:193], v194 offset:0
v_mfma_f32_16x16x32_bf16 v[80:83], a[160:163], v[160:163], v[80:83]
ds_read_b64_tr_b16 a[194:195], v194 offset:4096
v_mfma_f32_16x16x32_bf16 v[80:83], a[164:167], v[164:167], v[80:83]
buffer_load_dwordx4 a[56:59], v15, s[44:47], s65 offen offset:1024 sc1
v_mfma_f32_16x16x32_bf16 v[48:51], a[164:167], v[156:159], v[48:51]
ds_read_b64_tr_b16 a[196:197], v194 offset:8192
v_mfma_f32_16x16x32_bf16 v[48:51], a[160:163], v[152:155], v[48:51]
ds_read_b64_tr_b16 a[198:199], v194 offset:12288
v_mfma_f32_16x16x32_bf16 v[52:55], a[168:171], v[152:155], v[52:55]
s_add_u32 s65, s84, 106496
v_mfma_f32_16x16x32_bf16 v[52:55], a[172:175], v[156:159], v[52:55]
buffer_load_dwordx4 a[36:39], v14, s[44:47], s65 offen offset:0 sc1
v_mfma_f32_16x16x32_bf16 v[84:87], a[172:175], v[164:167], v[84:87]
ds_read_b64_tr_b16 a[200:201], v195 offset:0
v_mfma_f32_16x16x32_bf16 v[84:87], a[168:171], v[160:163], v[84:87]
ds_read_b64_tr_b16 a[202:203], v195 offset:4096
v_mfma_f32_16x16x32_bf16 v[116:119], a[168:171], v[168:171], v[116:119]
buffer_load_dwordx4 a[44:47], v14, s[44:47], s65 offen offset:1024 sc1
v_mfma_f32_16x16x32_bf16 v[116:119], a[172:175], v[172:175], v[116:119]
ds_read_b64_tr_b16 a[204:205], v195 offset:8192
v_mfma_f32_16x16x32_bf16 v[148:151], a[172:175], v[180:183], v[148:151]
ds_read_b64_tr_b16 a[206:207], v195 offset:12288
v_mfma_f32_16x16x32_bf16 v[148:151], a[168:171], v[176:179], v[148:151]
v_mfma_f32_16x16x32_bf16 v[120:123], a[176:179], v[176:179], v[120:123]
s_waitcnt lgkmcnt(4)
buffer_load_dwordx4 a[52:55], v15, s[44:47], s65 offen offset:0 sc1
v_mfma_f32_16x16x32_bf16 v[120:123], a[180:183], v[180:183], v[120:123]
v_mfma_f32_16x16x32_bf16 v[88:91], a[180:183], v[172:175], v[88:91]
v_mfma_f32_16x16x32_bf16 v[88:91], a[176:179], v[168:171], v[88:91]
buffer_load_dwordx4 a[60:63], v15, s[44:47], s65 offen offset:1024 sc1
v_mfma_f32_16x16x32_bf16 v[56:59], a[176:179], v[160:163], v[56:59]
v_mfma_f32_16x16x32_bf16 v[56:59], a[180:183], v[164:167], v[56:59]
v_mfma_f32_16x16x32_bf16 v[24:27], a[180:183], v[156:159], v[24:27]
v_mfma_f32_16x16x32_bf16 v[24:27], a[176:179], v[152:155], v[24:27]
v_mfma_f32_16x16x32_bf16 v[28:31], a[184:187], v[152:155], v[28:31]
s_waitcnt vmcnt(25)
s_barrier
v_mfma_f32_16x16x32_bf16 v[28:31], a[188:191], v[156:159], v[28:31]
s_add_u32 m0, s86, 131072
ds_read_b64_tr_b16 a[144:145], v196 offset:32768
v_mfma_f32_16x16x32_bf16 v[60:63], a[188:191], v[164:167], v[60:63]
s_add_u32 s64, s85, 0
ds_read_b64_tr_b16 a[146:147], v196 offset:36864
v_mfma_f32_16x16x32_bf16 v[60:63], a[184:187], v[160:163], v[60:63]
buffer_load_dwordx4 v12, s[40:43], s64 offen lds
v_mfma_f32_16x16x32_bf16 v[92:95], a[184:187], v[168:171], v[92:95]
s_lshl_b32 s75, s73, 17
s_add_u32 s84, s84, s75
ds_read_b64_tr_b16 a[148:149], v196 offset:40960
v_mfma_f32_16x16x32_bf16 v[92:95], a[188:191], v[172:175], v[92:95]
s_add_u32 m0, s86, 132096
ds_read_b64_tr_b16 a[150:151], v196 offset:45056
v_mfma_f32_16x16x32_bf16 v[124:127], a[188:191], v[180:183], v[124:127]
s_add_u32 s64, s85, 8192
ds_read_b64_tr_b16 a[152:153], v197 offset:32768
v_mfma_f32_16x16x32_bf16 v[124:127], a[184:187], v[176:179], v[124:127]
buffer_load_dwordx4 v13, s[40:43], s64 offen lds
v_mfma_f32_16x16x32_bf16 v[128:131], a[192:195], v[176:179], v[128:131]
ds_read_b64_tr_b16 a[154:155], v197 offset:36864
v_mfma_f32_16x16x32_bf16 v[128:131], a[196:199], v[180:183], v[128:131]
s_add_u32 m0, s86, 133120
ds_read_b64_tr_b16 a[156:157], v197 offset:40960
v_mfma_f32_16x16x32_bf16 v[96:99], a[196:199], v[172:175], v[96:99]
s_add_u32 s64, s85, 16384
ds_read_b64_tr_b16 a[158:159], v197 offset:45056
v_mfma_f32_16x16x32_bf16 v[96:99], a[192:195], v[168:171], v[96:99]
buffer_load_dwordx4 v12, s[40:43], s64 offen lds
v_mfma_f32_16x16x32_bf16 v[64:67], a[192:195], v[160:163], v[64:67]
ds_read_b64_tr_b16 a[160:161], v198 offset:32768
v_mfma_f32_16x16x32_bf16 v[64:67], a[196:199], v[164:167], v[64:67]
s_add_u32 m0, s86, 134144
ds_read_b64_tr_b16 a[162:163], v198 offset:36864
v_mfma_f32_16x16x32_bf16 v[32:35], a[196:199], v[156:159], v[32:35]
s_add_u32 s64, s85, 24576
ds_read_b64_tr_b16 a[164:165], v198 offset:40960
v_mfma_f32_16x16x32_bf16 v[32:35], a[192:195], v[152:155], v[32:35]
s_waitcnt lgkmcnt(6)
buffer_load_dwordx4 v13, s[40:43], s64 offen lds
v_mfma_f32_16x16x32_bf16 v[36:39], a[200:203], v[152:155], v[36:39]
ds_read_b64_tr_b16 a[166:167], v198 offset:45056
v_mfma_f32_16x16x32_bf16 v[36:39], a[204:207], v[156:159], v[36:39]
s_add_u32 m0, s86, 135168
v_mfma_f32_16x16x32_bf16 v[68:71], a[204:207], v[164:167], v[68:71]
s_add_u32 s64, s85, 32768
v_mfma_f32_16x16x32_bf16 v[68:71], a[200:203], v[160:163], v[68:71]
buffer_load_dwordx4 v12, s[40:43], s64 offen lds
v_mfma_f32_16x16x32_bf16 v[100:103], a[200:203], v[168:171], v[100:103]
v_mfma_f32_16x16x32_bf16 v[100:103], a[204:207], v[172:175], v[100:103]
v_mfma_f32_16x16x32_bf16 v[132:135], a[204:207], v[180:183], v[132:135]
v_mfma_f32_16x16x32_bf16 v[132:135], a[200:203], v[176:179], v[132:135]
s_waitcnt vmcnt(26)
v_mfma_f32_16x16x32_bf16 v[136:139], a[144:147], a[24:27], v[136:139]
s_waitcnt vmcnt(16)
v_readfirstlane_b32 vcc_lo, v19
s_nop 0
s_cmp_lt_u32 vcc_lo, s74
s_cbranch_scc1 L_spin_4022
L_spinbk_4023:
v_mfma_f32_16x16x32_bf16 v[136:139], a[148:151], a[28:31], v[136:139]
s_add_u32 m0, s86, 136192
ds_read_b64_tr_b16 a[168:169], v199 offset:32768
v_mfma_f32_16x16x32_bf16 v[104:107], a[148:151], a[20:23], v[104:107]
s_add_u32 s64, s85, 40960
ds_read_b64_tr_b16 a[170:171], v199 offset:36864
v_mfma_f32_16x16x32_bf16 v[104:107], a[144:147], a[16:19], v[104:107]
buffer_load_dwordx4 v13, s[40:43], s64 offen lds
v_mfma_f32_16x16x32_bf16 v[72:75], a[144:147], a[8:11], v[72:75]
s_add_u32 m0, s86, 137216
ds_read_b64_tr_b16 a[172:173], v199 offset:40960
v_mfma_f32_16x16x32_bf16 v[72:75], a[148:151], a[12:15], v[72:75]
s_add_u32 s64, s85, 49152
ds_read_b64_tr_b16 a[174:175], v199 offset:45056
v_mfma_f32_16x16x32_bf16 v[40:43], a[148:151], a[4:7], v[40:43]
buffer_load_dwordx4 v12, s[40:43], s64 offen lds
v_mfma_f32_16x16x32_bf16 v[40:43], a[144:147], a[0:3], v[40:43]
s_waitcnt lgkmcnt(4)
s_add_u32 m0, s86, 138240
ds_read_b64_tr_b16 a[176:177], v192 offset:32768
v_mfma_f32_16x16x32_bf16 v[44:47], a[152:155], a[0:3], v[44:47]
s_add_u32 s64, s85, 57344
ds_read_b64_tr_b16 a[178:179], v192 offset:36864
v_mfma_f32_16x16x32_bf16 v[44:47], a[156:159], a[4:7], v[44:47]
buffer_load_dwordx4 v13, s[40:43], s64 offen lds
v_mfma_f32_16x16x32_bf16 v[76:79], a[156:159], a[12:15], v[76:79]
ds_read_b64_tr_b16 a[180:181], v192 offset:40960
v_mfma_f32_16x16x32_bf16 v[76:79], a[152:155], a[8:11], v[76:79]
s_add_u32 s65, s84, 0
ds_read_b64_tr_b16 a[182:183], v192 offset:45056
v_mfma_f32_16x16x32_bf16 v[108:111], a[152:155], a[16:19], v[108:111]
buffer_load_dwordx4 a[208:211], v14, s[44:47], s65 offen offset:0 sc1
v_mfma_f32_16x16x32_bf16 v[108:111], a[156:159], a[20:23], v[108:111]
ds_read_b64_tr_b16 a[184:185], v193 offset:32768
v_mfma_f32_16x16x32_bf16 v[140:143], a[156:159], a[28:31], v[140:143]
ds_read_b64_tr_b16 a[186:187], v193 offset:36864
v_mfma_f32_16x16x32_bf16 v[140:143], a[152:155], a[24:27], v[140:143]
ds_read_b64_tr_b16 a[188:189], v193 offset:40960
v_mfma_f32_16x16x32_bf16 v[144:147], a[160:163], a[24:27], v[144:147]
buffer_load_dwordx4 a[216:219], v14, s[44:47], s65 offen offset:1024 sc1
v_mfma_f32_16x16x32_bf16 v[144:147], a[164:167], a[28:31], v[144:147]
ds_read_b64_tr_b16 a[190:191], v193 offset:45056
v_mfma_f32_16x16x32_bf16 v[112:115], a[164:167], a[20:23], v[112:115]
ds_read_b64_tr_b16 a[192:193], v194 offset:32768
v_mfma_f32_16x16x32_bf16 v[112:115], a[160:163], a[16:19], v[112:115]
buffer_load_dwordx4 a[224:227], v15, s[44:47], s65 offen offset:0 sc1
v_mfma_f32_16x16x32_bf16 v[80:83], a[160:163], a[8:11], v[80:83]
ds_read_b64_tr_b16 a[194:195], v194 offset:36864
v_mfma_f32_16x16x32_bf16 v[80:83], a[164:167], a[12:15], v[80:83]
ds_read_b64_tr_b16 a[196:197], v194 offset:40960
v_mfma_f32_16x16x32_bf16 v[48:51], a[164:167], a[4:7], v[48:51]
buffer_load_dwordx4 a[232:235], v15, s[44:47], s65 offen offset:1024 sc1
v_mfma_f32_16x16x32_bf16 v[48:51], a[160:163], a[0:3], v[48:51]
s_waitcnt lgkmcnt(4)
ds_read_b64_tr_b16 a[198:199], v194 offset:45056
v_mfma_f32_16x16x32_bf16 v[52:55], a[168:171], a[0:3], v[52:55]
s_add_u32 s65, s84, 8192
v_mfma_f32_16x16x32_bf16 v[52:55], a[172:175], a[4:7], v[52:55]
buffer_load_dwordx4 a[212:215], v14, s[44:47], s65 offen offset:0 sc1
v_mfma_f32_16x16x32_bf16 v[84:87], a[172:175], a[12:15], v[84:87]
ds_read_b64_tr_b16 a[200:201], v195 offset:32768
v_mfma_f32_16x16x32_bf16 v[84:87], a[168:171], a[8:11], v[84:87]
ds_read_b64_tr_b16 a[202:203], v195 offset:36864
v_mfma_f32_16x16x32_bf16 v[116:119], a[168:171], a[16:19], v[116:119]
ds_read_b64_tr_b16 a[204:205], v195 offset:40960
v_mfma_f32_16x16x32_bf16 v[116:119], a[172:175], a[20:23], v[116:119]
buffer_load_dwordx4 a[220:223], v14, s[44:47], s65 offen offset:1024 sc1
v_mfma_f32_16x16x32_bf16 v[148:151], a[172:175], a[28:31], v[148:151]
ds_read_b64_tr_b16 a[206:207], v195 offset:45056
v_mfma_f32_16x16x32_bf16 v[148:151], a[168:171], a[24:27], v[148:151]
v_mfma_f32_16x16x32_bf16 v[120:123], a[176:179], a[24:27], v[120:123]
buffer_load_dwordx4 a[228:231], v15, s[44:47], s65 offen offset:0 sc1
v_mfma_f32_16x16x32_bf16 v[120:123], a[180:183], a[28:31], v[120:123]
v_mfma_f32_16x16x32_bf16 v[88:91], a[180:183], a[20:23], v[88:91]
v_mfma_f32_16x16x32_bf16 v[88:91], a[176:179], a[16:19], v[88:91]
buffer_load_dwordx4 a[236:239], v15, s[44:47], s65 offen offset:1024 sc1
v_mfma_f32_16x16x32_bf16 v[56:59], a[176:179], a[8:11], v[56:59]
v_mfma_f32_16x16x32_bf16 v[56:59], a[180:183], a[12:15], v[56:59]
v_mfma_f32_16x16x32_bf16 v[24:27], a[180:183], a[4:7], v[24:27]
v_mfma_f32_16x16x32_bf16 v[24:27], a[176:179], a[0:3], v[24:27]
v_mfma_f32_16x16x32_bf16 v[28:31], a[184:187], a[0:3], v[28:31]
s_waitcnt vmcnt(24)
s_barrier
s_waitcnt lgkmcnt(0)
v_mfma_f32_16x16x32_bf16 v[28:31], a[188:191], a[4:7], v[28:31]
s_add_u32 m0, s86, 32768
ds_read_b64_tr_b16 a[144:145], v188 offset:0
v_mfma_f32_16x16x32_bf16 v[60:63], a[188:191], a[12:15], v[60:63]
s_add_u32 s64, s85, 262144
ds_read_b64_tr_b16 a[146:147], v188 offset:4096
v_mfma_f32_16x16x32_bf16 v[60:63], a[184:187], a[8:11], v[60:63]
buffer_load_dwordx4 v12, s[40:43], s64 offen lds
v_mfma_f32_16x16x32_bf16 v[92:95], a[184:187], a[16:19], v[92:95]
ds_read_b64_tr_b16 a[148:149], v188 offset:8192
v_mfma_f32_16x16x32_bf16 v[92:95], a[188:191], a[20:23], v[92:95]
s_add_u32 m0, s86, 33792
ds_read_b64_tr_b16 a[150:151], v188 offset:12288
v_mfma_f32_16x16x32_bf16 v[124:127], a[188:191], a[28:31], v[124:127]
s_add_u32 s64, s85, 270336
ds_read_b64_tr_b16 a[152:153], v189 offset:0
v_mfma_f32_16x16x32_bf16 v[124:127], a[184:187], a[24:27], v[124:127]
buffer_load_dwordx4 v13, s[40:43], s64 offen lds
v_mfma_f32_16x16x32_bf16 v[128:131], a[192:195], a[24:27], v[128:131]
ds_read_b64_tr_b16 a[154:155], v189 offset:4096
v_mfma_f32_16x16x32_bf16 v[128:131], a[196:199], a[28:31], v[128:131]
s_add_u32 m0, s86, 34816
ds_read_b64_tr_b16 a[156:157], v189 offset:8192
v_mfma_f32_16x16x32_bf16 v[96:99], a[196:199], a[20:23], v[96:99]
s_add_u32 s64, s85, 278528
ds_read_b64_tr_b16 a[158:159], v189 offset:12288
v_mfma_f32_16x16x32_bf16 v[96:99], a[192:195], a[16:19], v[96:99]
buffer_load_dwordx4 v12, s[40:43], s64 offen lds
v_mfma_f32_16x16x32_bf16 v[64:67], a[192:195], a[8:11], v[64:67]
ds_read_b64_tr_b16 a[160:161], v190 offset:0
v_mfma_f32_16x16x32_bf16 v[64:67], a[196:199], a[12:15], v[64:67]
s_add_u32 m0, s86, 35840
ds_read_b64_tr_b16 a[162:163], v190 offset:4096
v_mfma_f32_16x16x32_bf16 v[32:35], a[196:199], a[4:7], v[32:35]
s_add_u32 s64, s85, 286720
ds_read_b64_tr_b16 a[164:165], v190 offset:8192
v_mfma_f32_16x16x32_bf16 v[32:35], a[192:195], a[0:3], v[32:35]
buffer_load_dwordx4 v13, s[40:43], s64 offen lds
v_mfma_f32_16x16x32_bf16 v[36:39], a[200:203], a[0:3], v[36:39]
ds_read_b64_tr_b16 a[166:167], v190 offset:12288
v_mfma_f32_16x16x32_bf16 v[36:39], a[204:207], a[4:7], v[36:39]
s_add_u32 m0, s86, 36864
v_mfma_f32_16x16x32_bf16 v[68:71], a[204:207], a[12:15], v[68:71]
s_add_u32 s64, s85, 294912
v_mfma_f32_16x16x32_bf16 v[68:71], a[200:203], a[8:11], v[68:71]
buffer_load_dwordx4 v12, s[40:43], s64 offen lds
v_mfma_f32_16x16x32_bf16 v[100:103], a[200:203], a[16:19], v[100:103]
v_mfma_f32_16x16x32_bf16 v[100:103], a[204:207], a[20:23], v[100:103]
v_mfma_f32_16x16x32_bf16 v[132:135], a[204:207], a[28:31], v[132:135]
v_mfma_f32_16x16x32_bf16 v[132:135], a[200:203], a[24:27], v[132:135]
s_waitcnt vmcnt(25)
s_waitcnt lgkmcnt(1)
s_add_u32 m0, s86, 37888
v_mfma_f32_16x16x32_bf16 v[136:139], a[144:147], a[56:59], v[136:139]
s_waitcnt vmcnt(21)
s_add_u32 s64, s85, 303104
ds_read_b64_tr_b16 a[168:169], v191 offset:0
v_mfma_f32_16x16x32_bf16 v[136:139], a[148:151], a[60:63], v[136:139]
buffer_load_dwordx4 v13, s[40:43], s64 offen lds
v_mfma_f32_16x16x32_bf16 v[104:107], a[148:151], a[52:55], v[104:107]
s_add_u32 m0, s86, 38912
ds_read_b64_tr_b16 a[170:171], v191 offset:4096
v_mfma_f32_16x16x32_bf16 v[104:107], a[144:147], a[48:51], v[104:107]
s_add_u32 s64, s85, 311296
ds_read_b64_tr_b16 a[172:173], v191 offset:8192
v_mfma_f32_16x16x32_bf16 v[72:75], a[144:147], a[40:43], v[72:75]
buffer_load_dwordx4 v12, s[40:43], s64 offen lds
v_mfma_f32_16x16x32_bf16 v[72:75], a[148:151], a[44:47], v[72:75]
s_add_u32 m0, s86, 39936
ds_read_b64_tr_b16 a[174:175], v191 offset:12288
v_mfma_f32_16x16x32_bf16 v[40:43], a[148:151], a[36:39], v[40:43]
s_add_u32 s64, s85, 319488
ds_read_b64_tr_b16 a[176:177], v184 offset:0
v_mfma_f32_16x16x32_bf16 v[40:43], a[144:147], a[32:35], v[40:43]
buffer_load_dwordx4 v13, s[40:43], s64 offen lds
v_mfma_f32_16x16x32_bf16 v[44:47], a[152:155], a[32:35], v[44:47]
ds_read_b64_tr_b16 a[178:179], v184 offset:4096
v_mfma_f32_16x16x32_bf16 v[44:47], a[156:159], a[36:39], v[44:47]
ds_read_b64_tr_b16 a[180:181], v184 offset:8192
v_mfma_f32_16x16x32_bf16 v[76:79], a[156:159], a[44:47], v[76:79]
s_add_u32 s65, s84, 32768
ds_read_b64_tr_b16 a[182:183], v184 offset:12288
v_mfma_f32_16x16x32_bf16 v[76:79], a[152:155], a[40:43], v[76:79]
buffer_load_dwordx4 v[152:155], v14, s[44:47], s65 offen offset:0 sc1
v_mfma_f32_16x16x32_bf16 v[108:111], a[152:155], a[48:51], v[108:111]
ds_read_b64_tr_b16 a[184:185], v185 offset:0
v_mfma_f32_16x16x32_bf16 v[108:111], a[156:159], a[52:55], v[108:111]
ds_read_b64_tr_b16 a[186:187], v185 offset:4096
v_mfma_f32_16x16x32_bf16 v[140:143], a[156:159], a[60:63], v[140:143]
buffer_load_dwordx4 v[160:163], v14, s[44:47], s65 offen offset:1024 sc1
v_mfma_f32_16x16x32_bf16 v[140:143], a[152:155], a[56:59], v[140:143]
ds_read_b64_tr_b16 a[188:189], v185 offset:8192
v_mfma_f32_16x16x32_bf16 v[144:147], a[160:163], a[56:59], v[144:147]
s_waitcnt lgkmcnt(5)
ds_read_b64_tr_b16 a[190:191], v185 offset:12288
v_mfma_f32_16x16x32_bf16 v[144:147], a[164:167], a[60:63], v[144:147]
v_mfma_f32_16x16x32_bf16 v[112:115], a[164:167], a[52:55], v[112:115]
buffer_load_dwordx4 v[168:171], v15, s[44:47], s65 offen offset:0 sc1
v_mfma_f32_16x16x32_bf16 v[112:115], a[160:163], a[48:51], v[112:115]
ds_read_b64_tr_b16 a[192:193], v186 offset:0
v_mfma_f32_16x16x32_bf16 v[80:83], a[160:163], a[40:43], v[80:83]
ds_read_b64_tr_b16 a[194:195], v186 offset:4096
v_mfma_f32_16x16x32_bf16 v[80:83], a[164:167], a[44:47], v[80:83]
buffer_load_dwordx4 v[176:179], v15, s[44:47], s65 offen offset:1024 sc1
v_mfma_f32_16x16x32_bf16 v[48:51], a[164:167], a[36:39], v[48:51]
ds_read_b64_tr_b16 a[196:197], v186 offset:8192
v_mfma_f32_16x16x32_bf16 v[48:51], a[160:163], a[32:35], v[48:51]
ds_read_b64_tr_b16 a[198:199], v186 offset:12288
v_mfma_f32_16x16x32_bf16 v[52:55], a[168:171], a[32:35], v[52:55]
s_add_u32 s65, s84, 40960
v_mfma_f32_16x16x32_bf16 v[52:55], a[172:175], a[36:39], v[52:55]
buffer_load_dwordx4 v[156:159], v14, s[44:47], s65 offen offset:0 sc1
v_mfma_f32_16x16x32_bf16 v[84:87], a[172:175], a[44:47], v[84:87]
ds_read_b64_tr_b16 a[200:201], v187 offset:0
v_mfma_f32_16x16x32_bf16 v[84:87], a[168:171], a[40:43], v[84:87]
ds_read_b64_tr_b16 a[202:203], v187 offset:4096
v_mfma_f32_16x16x32_bf16 v[116:119], a[168:171], a[48:51], v[116:119]
buffer_load_dwordx4 v[164:167], v14, s[44:47], s65 offen offset:1024 sc1
v_mfma_f32_16x16x32_bf16 v[116:119], a[172:175], a[52:55], v[116:119]
ds_read_b64_tr_b16 a[204:205], v187 offset:8192
v_mfma_f32_16x16x32_bf16 v[148:151], a[172:175], a[60:63], v[148:151]
ds_read_b64_tr_b16 a[206:207], v187 offset:12288
v_mfma_f32_16x16x32_bf16 v[148:151], a[168:171], a[56:59], v[148:151]
v_mfma_f32_16x16x32_bf16 v[120:123], a[176:179], a[56:59], v[120:123]
s_waitcnt lgkmcnt(4)
buffer_load_dwordx4 v[172:175], v15, s[44:47], s65 offen offset:0 sc1
v_mfma_f32_16x16x32_bf16 v[120:123], a[180:183], a[60:63], v[120:123]
v_mfma_f32_16x16x32_bf16 v[88:91], a[180:183], a[52:55], v[88:91]
v_mfma_f32_16x16x32_bf16 v[88:91], a[176:179], a[48:51], v[88:91]
buffer_load_dwordx4 v[180:183], v15, s[44:47], s65 offen offset:1024 sc1
v_mfma_f32_16x16x32_bf16 v[56:59], a[176:179], a[40:43], v[56:59]
v_mfma_f32_16x16x32_bf16 v[56:59], a[180:183], a[44:47], v[56:59]
v_mfma_f32_16x16x32_bf16 v[24:27], a[180:183], a[36:39], v[24:27]
v_mfma_f32_16x16x32_bf16 v[24:27], a[176:179], a[32:35], v[24:27]
v_mfma_f32_16x16x32_bf16 v[28:31], a[184:187], a[32:35], v[28:31]
s_waitcnt vmcnt(24)
s_barrier
v_mfma_f32_16x16x32_bf16 v[28:31], a[188:191], a[36:39], v[28:31]
s_add_u32 m0, s86, 65536
ds_read_b64_tr_b16 a[144:145], v188 offset:32768
v_mfma_f32_16x16x32_bf16 v[60:63], a[188:191], a[44:47], v[60:63]
s_add_u32 s64, s85, 524288
ds_read_b64_tr_b16 a[146:147], v188 offset:36864
v_mfma_f32_16x16x32_bf16 v[60:63], a[184:187], a[40:43], v[60:63]
buffer_load_dwordx4 v12, s[40:43], s64 offen lds
v_mfma_f32_16x16x32_bf16 v[92:95], a[184:187], a[48:51], v[92:95]
ds_read_b64_tr_b16 a[148:149], v188 offset:40960
v_mfma_f32_16x16x32_bf16 v[92:95], a[188:191], a[52:55], v[92:95]
s_add_u32 m0, s86, 66560
ds_read_b64_tr_b16 a[150:151], v188 offset:45056
v_mfma_f32_16x16x32_bf16 v[124:127], a[188:191], a[60:63], v[124:127]
s_add_u32 s64, s85, 532480
ds_read_b64_tr_b16 a[152:153], v189 offset:32768
v_mfma_f32_16x16x32_bf16 v[124:127], a[184:187], a[56:59], v[124:127]
buffer_load_dwordx4 v13, s[40:43], s64 offen lds
v_mfma_f32_16x16x32_bf16 v[128:131], a[192:195], a[56:59], v[128:131]
ds_read_b64_tr_b16 a[154:155], v189 offset:36864
v_mfma_f32_16x16x32_bf16 v[128:131], a[196:199], a[60:63], v[128:131]
s_add_u32 m0, s86, 67584
ds_read_b64_tr_b16 a[156:157], v189 offset:40960
v_mfma_f32_16x16x32_bf16 v[96:99], a[196:199], a[52:55], v[96:99]
s_add_u32 s64, s85, 540672
ds_read_b64_tr_b16 a[158:159], v189 offset:45056
v_mfma_f32_16x16x32_bf16 v[96:99], a[192:195], a[48:51], v[96:99]
buffer_load_dwordx4 v12, s[40:43], s64 offen lds
v_mfma_f32_16x16x32_bf16 v[64:67], a[192:195], a[40:43], v[64:67]
ds_read_b64_tr_b16 a[160:161], v190 offset:32768
v_mfma_f32_16x16x32_bf16 v[64:67], a[196:199], a[44:47], v[64:67]
s_add_u32 m0, s86, 68608
ds_read_b64_tr_b16 a[162:163], v190 offset:36864
v_mfma_f32_16x16x32_bf16 v[32:35], a[196:199], a[36:39], v[32:35]
s_add_u32 s64, s85, 548864
ds_read_b64_tr_b16 a[164:165], v190 offset:40960
v_mfma_f32_16x16x32_bf16 v[32:35], a[192:195], a[32:35], v[32:35]
s_waitcnt lgkmcnt(6)
buffer_load_dwordx4 v13, s[40:43], s64 offen lds
v_mfma_f32_16x16x32_bf16 v[36:39], a[200:203], a[32:35], v[36:39]
ds_read_b64_tr_b16 a[166:167], v190 offset:45056
v_mfma_f32_16x16x32_bf16 v[36:39], a[204:207], a[36:39], v[36:39]
s_add_u32 m0, s86, 69632
v_mfma_f32_16x16x32_bf16 v[68:71], a[204:207], a[44:47], v[68:71]
s_add_u32 s64, s85, 557056
v_mfma_f32_16x16x32_bf16 v[68:71], a[200:203], a[40:43], v[68:71]
buffer_load_dwordx4 v12, s[40:43], s64 offen lds
v_mfma_f32_16x16x32_bf16 v[100:103], a[200:203], a[48:51], v[100:103]
s_sub_u32 s73, 1, s73
s_sub_u32 s70, s70, 1
s_cmp_lg_u32 s70, 0
v_mfma_f32_16x16x32_bf16 v[100:103], a[204:207], a[52:55], v[100:103]
v_mfma_f32_16x16x32_bf16 v[132:135], a[204:207], a[60:63], v[132:135]
v_mfma_f32_16x16x32_bf16 v[132:135], a[200:203], a[56:59], v[132:135]
s_cbranch_scc1 L_p5loop
L_p5last:
s_waitcnt lgkmcnt(10)
s_waitcnt vmcnt(25)
v_mfma_f32_16x16x32_bf16 v[136:139], a[144:147], a[232:235], v[136:139]
s_waitcnt vmcnt(21)
s_waitcnt lgkmcnt(8)
s_add_u32 m0, s86, 70656
s_add_u32 s64, s85, 565248
ds_read_b64_tr_b16 a[168:169], v191 offset:32768
v_mfma_f32_16x16x32_bf16 v[136:139], a[148:151], a[236:239], v[136:139]
buffer_load_dwordx4 v13, s[40:43], s64 offen lds
v_mfma_f32_16x16x32_bf16 v[104:107], a[148:151], a[228:231], v[104:107]
s_add_u32 m0, s86, 71680
ds_read_b64_tr_b16 a[170:171], v191 offset:36864
v_mfma_f32_16x16x32_bf16 v[104:107], a[144:147], a[224:227], v[104:107]
s_add_u32 s64, s85, 573440
ds_read_b64_tr_b16 a[172:173], v191 offset:40960
v_mfma_f32_16x16x32_bf16 v[72:75], a[144:147], a[216:219], v[72:75]
buffer_load_dwordx4 v12, s[40:43], s64 offen lds
v_mfma_f32_16x16x32_bf16 v[72:75], a[148:151], a[220:223], v[72:75]
s_add_u32 m0, s86, 72704
ds_read_b64_tr_b16 a[174:175], v191 offset:45056
v_mfma_f32_16x16x32_bf16 v[40:43], a[148:151], a[212:215], v[40:43]
s_add_u32 s64, s85, 581632
ds_read_b64_tr_b16 a[176:177], v184 offset:32768
v_mfma_f32_16x16x32_bf16 v[40:43], a[144:147], a[208:211], v[40:43]
s_waitcnt lgkmcnt(5)
buffer_load_dwordx4 v13, s[40:43], s64 offen lds
v_mfma_f32_16x16x32_bf16 v[44:47], a[152:155], a[208:211], v[44:47]
ds_read_b64_tr_b16 a[178:179], v184 offset:36864
v_mfma_f32_16x16x32_bf16 v[44:47], a[156:159], a[212:215], v[44:47]
ds_read_b64_tr_b16 a[180:181], v184 offset:40960
v_mfma_f32_16x16x32_bf16 v[76:79], a[156:159], a[220:223], v[76:79]
s_add_u32 s65, s84, 65536
ds_read_b64_tr_b16 a[182:183], v184 offset:45056
v_mfma_f32_16x16x32_bf16 v[76:79], a[152:155], a[216:219], v[76:79]
buffer_load_dwordx4 a[0:3], v14, s[44:47], s65 offen offset:0 sc1
v_mfma_f32_16x16x32_bf16 v[108:111], a[152:155], a[224:227], v[108:111]
ds_read_b64_tr_b16 a[184:185], v185 offset:32768
v_mfma_f32_16x16x32_bf16 v[108:111], a[156:159], a[228:231], v[108:111]
ds_read_b64_tr_b16 a[186:187], v185 offset:36864
v_mfma_f32_16x16x32_bf16 v[140:143], a[156:159], a[236:239], v[140:143]
buffer_load_dwordx4 a[8:11], v14, s[44:47], s65 offen offset:1024 sc1
v_mfma_f32_16x16x32_bf16 v[140:143], a[152:155], a[232:235], v[140:143]
ds_read_b64_tr_b16 a[188:189], v185 offset:40960
v_mfma_f32_16x16x32_bf16 v[144:147], a[160:163], a[232:235], v[144:147]
ds_read_b64_tr_b16 a[190:191], v185 offset:45056
v_mfma_f32_16x16x32_bf16 v[144:147], a[164:167], a[236:239], v[144:147]
v_mfma_f32_16x16x32_bf16 v[112:115], a[164:167], a[228:231], v[112:115]
buffer_load_dwordx4 a[16:19], v15, s[44:47], s65 offen offset:0 sc1
v_mfma_f32_16x16x32_bf16 v[112:115], a[160:163], a[224:227], v[112:115]
ds_read_b64_tr_b16 a[192:193], v186 offset:32768
v_mfma_f32_16x16x32_bf16 v[80:83], a[160:163], a[216:219], v[80:83]
ds_read_b64_tr_b16 a[194:195], v186 offset:36864
v_mfma_f32_16x16x32_bf16 v[80:83], a[164:167], a[220:223], v[80:83]
buffer_load_dwordx4 a[24:27], v15, s[44:47], s65 offen offset:1024 sc1
v_mfma_f32_16x16x32_bf16 v[48:51], a[164:167], a[212:215], v[48:51]
ds_read_b64_tr_b16 a[196:197], v186 offset:40960
v_mfma_f32_16x16x32_bf16 v[48:51], a[160:163], a[208:211], v[48:51]
s_waitcnt lgkmcnt(4)
ds_read_b64_tr_b16 a[198:199], v186 offset:45056
v_mfma_f32_16x16x32_bf16 v[52:55], a[168:171], a[208:211], v[52:55]
s_add_u32 s65, s84, 73728
v_mfma_f32_16x16x32_bf16 v[52:55], a[172:175], a[212:215], v[52:55]
buffer_load_dwordx4 a[4:7], v14, s[44:47], s65 offen offset:0 sc1
v_mfma_f32_16x16x32_bf16 v[84:87], a[172:175], a[220:223], v[84:87]
ds_read_b64_tr_b16 a[200:201], v187 offset:32768
v_mfma_f32_16x16x32_bf16 v[84:87], a[168:171], a[216:219], v[84:87]
ds_read_b64_tr_b16 a[202:203], v187 offset:36864
v_mfma_f32_16x16x32_bf16 v[116:119], a[168:171], a[224:227], v[116:119]
buffer_load_dwordx4 a[12:15], v14, s[44:47], s65 offen offset:1024 sc1
v_mfma_f32_16x16x32_bf16 v[116:119], a[172:175], a[228:231], v[116:119]
ds_read_b64_tr_b16 a[204:205], v187 offset:40960
v_mfma_f32_16x16x32_bf16 v[148:151], a[172:175], a[236:239], v[148:151]
ds_read_b64_tr_b16 a[206:207], v187 offset:45056
v_mfma_f32_16x16x32_bf16 v[148:151], a[168:171], a[232:235], v[148:151]
v_mfma_f32_16x16x32_bf16 v[120:123], a[176:179], a[232:235], v[120:123]
buffer_load_dwordx4 a[20:23], v15, s[44:47], s65 offen offset:0 sc1
v_mfma_f32_16x16x32_bf16 v[120:123], a[180:183], a[236:239], v[120:123]
v_mfma_f32_16x16x32_bf16 v[88:91], a[180:183], a[228:231], v[88:91]
v_mfma_f32_16x16x32_bf16 v[88:91], a[176:179], a[224:227], v[88:91]
buffer_load_dwordx4 a[28:31], v15, s[44:47], s65 offen offset:1024 sc1
v_mfma_f32_16x16x32_bf16 v[56:59], a[176:179], a[216:219], v[56:59]
v_mfma_f32_16x16x32_bf16 v[56:59], a[180:183], a[220:223], v[56:59]
v_mfma_f32_16x16x32_bf16 v[24:27], a[180:183], a[212:215], v[24:27]
v_mfma_f32_16x16x32_bf16 v[24:27], a[176:179], a[208:211], v[24:27]
v_mfma_f32_16x16x32_bf16 v[28:31], a[184:187], a[208:211], v[28:31]
s_waitcnt vmcnt(24)
s_barrier
s_waitcnt lgkmcnt(0)
v_mfma_f32_16x16x32_bf16 v[28:31], a[188:191], a[212:215], v[28:31]
s_add_u32 m0, s86, 98304
ds_read_b64_tr_b16 a[144:145], v196 offset:0
v_mfma_f32_16x16x32_bf16 v[60:63], a[188:191], a[220:223], v[60:63]
s_add_u32 s64, s85, 786432
ds_read_b64_tr_b16 a[146:147], v196 offset:4096
v_mfma_f32_16x16x32_bf16 v[60:63], a[184:187], a[216:219], v[60:63]
buffer_load_dwordx4 v12, s[40:43], s64 offen lds
v_mfma_f32_16x16x32_bf16 v[92:95], a[184:187], a[224:227], v[92:95]
ds_read_b64_tr_b16 a[148:149], v196 offset:8192
v_mfma_f32_16x16x32_bf16 v[92:95], a[188:191], a[228:231], v[92:95]
s_add_u32 m0, s86, 99328
ds_read_b64_tr_b16 a[150:151], v196 offset:12288
v_mfma_f32_16x16x32_bf16 v[124:127], a[188:191], a[236:239], v[124:127]
s_add_u32 s64, s85, 794624
ds_read_b64_tr_b16 a[152:153], v197 offset:0
v_mfma_f32_16x16x32_bf16 v[124:127], a[184:187], a[232:235], v[124:127]
buffer_load_dwordx4 v13, s[40:43], s64 offen lds
v_mfma_f32_16x16x32_bf16 v[128:131], a[192:195], a[232:235], v[128:131]
ds_read_b64_tr_b16 a[154:155], v197 offset:4096
v_mfma_f32_16x16x32_bf16 v[128:131], a[196:199], a[236:239], v[128:131]
s_add_u32 m0, s86, 100352
ds_read_b64_tr_b16 a[156:157], v197 offset:8192
v_mfma_f32_16x16x32_bf16 v[96:99], a[196:199], a[228:231], v[96:99]
s_add_u32 s64, s85, 802816
ds_read_b64_tr_b16 a[158:159], v197 offset:12288
v_mfma_f32_16x16x32_bf16 v[96:99], a[192:195], a[224:227], v[96:99]
buffer_load_dwordx4 v12, s[40:43], s64 offen lds
v_mfma_f32_16x16x32_bf16 v[64:67], a[192:195], a[216:219], v[64:67]
ds_read_b64_tr_b16 a[160:161], v198 offset:0
v_mfma_f32_16x16x32_bf16 v[64:67], a[196:199], a[220:223], v[64:67]
s_add_u32 m0, s86, 101376
ds_read_b64_tr_b16 a[162:163], v198 offset:4096
v_mfma_f32_16x16x32_bf16 v[32:35], a[196:199], a[212:215], v[32:35]
s_add_u32 s64, s85, 811008
ds_read_b64_tr_b16 a[164:165], v198 offset:8192
v_mfma_f32_16x16x32_bf16 v[32:35], a[192:195], a[208:211], v[32:35]
buffer_load_dwordx4 v13, s[40:43], s64 offen lds
v_mfma_f32_16x16x32_bf16 v[36:39], a[200:203], a[208:211], v[36:39]
ds_read_b64_tr_b16 a[166:167], v198 offset:12288
v_mfma_f32_16x16x32_bf16 v[36:39], a[204:207], a[212:215], v[36:39]
s_add_u32 m0, s86, 102400
v_mfma_f32_16x16x32_bf16 v[68:71], a[204:207], a[220:223], v[68:71]
s_add_u32 s64, s85, 819200
v_mfma_f32_16x16x32_bf16 v[68:71], a[200:203], a[216:219], v[68:71]
buffer_load_dwordx4 v12, s[40:43], s64 offen lds
v_mfma_f32_16x16x32_bf16 v[100:103], a[200:203], a[224:227], v[100:103]
s_xor_b32 s66, s2, 1
s_lshl2_add_u32 s66, s66, s30
s_lshl_b32 s73, s66, 12
v_mfma_f32_16x16x32_bf16 v[100:103], a[204:207], a[228:231], v[100:103]
s_add_u32 s73, s73, 67108864
s_lshl2_add_u32 s66, s2, s30
s_lshl_b32 s75, s66, 12
v_mfma_f32_16x16x32_bf16 v[132:135], a[204:207], a[236:239], v[132:135]
s_add_u32 s75, s75, 67108864
s_lshl_b32 s77, s82, 18
s_lshl_b32 s66, s30, 16
v_mfma_f32_16x16x32_bf16 v[132:135], a[200:203], a[232:235], v[132:135]
s_waitcnt vmcnt(25)
s_waitcnt lgkmcnt(1)
s_add_u32 s77, s77, s66
s_add_u32 s77, s77, s87
s_lshl_b32 s66, s83, 7
s_add_u32 m0, s86, 103424
v_mfma_f32_16x16x32_bf16 v[136:139], a[144:147], v[176:179], v[136:139]
s_waitcnt vmcnt(21)
s_add_u32 s77, s77, s66
s_add_u32 s64, s85, 827392
ds_read_b64_tr_b16 a[168:169], v199 offset:0
v_lshlrev_b32 v1, 24, v0
v_mfma_f32_16x16x32_bf16 v[136:139], a[148:151], v[180:183], v[136:139]
buffer_load_dwordx4 v13, s[40:43], s64 offen lds
v_mfma_f32_16x16x32_bf16 v[104:107], a[148:151], v[172:175], v[104:107]
s_add_u32 m0, s86, 104448
ds_read_b64_tr_b16 a[170:171], v199 offset:4096
v_and_b32 v8, 7, v0
v_mfma_f32_16x16x32_bf16 v[104:107], a[144:147], v[168:171], v[104:107]
s_add_u32 s64, s85, 835584
ds_read_b64_tr_b16 a[172:173], v199 offset:8192
v_lshlrev_b32 v8, 11, v8
v_mfma_f32_16x16x32_bf16 v[72:75], a[144:147], v[160:163], v[72:75]
buffer_load_dwordx4 v12, s[40:43], s64 offen lds
v_mfma_f32_16x16x32_bf16 v[72:75], a[148:151], v[164:167], v[72:75]
s_add_u32 m0, s86, 105472
ds_read_b64_tr_b16 a[174:175], v199 offset:12288
v_bfe_u32 v10, v0, 3, 1
v_mfma_f32_16x16x32_bf16 v[40:43], a[148:151], v[156:159], v[40:43]
s_add_u32 s64, s85, 843776
ds_read_b64_tr_b16 a[176:177], v192 offset:0
v_lshl_add_u32 v8, v10, 6, v8
v_mfma_f32_16x16x32_bf16 v[40:43], a[144:147], v[152:155], v[40:43]
buffer_load_dwordx4 v13, s[40:43], s64 offen lds
v_mfma_f32_16x16x32_bf16 v[44:47], a[152:155], v[152:155], v[44:47]
ds_read_b64_tr_b16 a[178:179], v192 offset:4096
v_bfe_u32 v10, v0, 4, 1
v_mfma_f32_16x16x32_bf16 v[44:47], a[156:159], v[156:159], v[44:47]
ds_read_b64_tr_b16 a[180:181], v192 offset:8192
v_lshl_add_u32 v8, v10, 5, v8
v_mfma_f32_16x16x32_bf16 v[76:79], a[156:159], v[164:167], v[76:79]
s_add_u32 s65, s84, 98304
ds_read_b64_tr_b16 a[182:183], v192 offset:12288
v_lshrrev_b32 v10, 5, v0
v_mfma_f32_16x16x32_bf16 v[76:79], a[152:155], v[160:163], v[76:79]
buffer_load_dwordx4 a[32:35], v14, s[44:47], s65 offen offset:0 sc1
v_mfma_f32_16x16x32_bf16 v[108:111], a[152:155], v[168:171], v[108:111]
ds_read_b64_tr_b16 a[184:185], v193 offset:0
v_lshl_add_u32 v8, v10, 4, v8
v_mfma_f32_16x16x32_bf16 v[108:111], a[156:159], v[172:175], v[108:111]
ds_read_b64_tr_b16 a[186:187], v193 offset:4096
v_add_u32 v2, s86, v16
v_mfma_f32_16x16x32_bf16 v[140:143], a[156:159], v[180:183], v[140:143]
buffer_load_dwordx4 a[40:43], v14, s[44:47], s65 offen offset:1024 sc1
v_mfma_f32_16x16x32_bf16 v[140:143], a[152:155], v[176:179], v[140:143]
ds_read_b64_tr_b16 a[188:189], v193 offset:8192
v_xor_b32 v3, 0x2000, v2
v_mfma_f32_16x16x32_bf16 v[144:147], a[160:163], v[176:179], v[144:147]
s_waitcnt lgkmcnt(5)
ds_read_b64_tr_b16 a[190:191], v193 offset:12288
v_mov_b32 v232, 0
v_mfma_f32_16x16x32_bf16 v[144:147], a[164:167], v[180:183], v[144:147]
v_mov_b32 v233, 0
v_mov_b32 v236, 0
v_mfma_f32_16x16x32_bf16 v[112:115], a[164:167], v[172:175], v[112:115]
buffer_load_dwordx4 a[48:51], v15, s[44:47], s65 offen offset:0 sc1
v_mfma_f32_16x16x32_bf16 v[112:115], a[160:163], v[168:171], v[112:115]
ds_read_b64_tr_b16 a[192:193], v194 offset:0
v_mov_b32 v237, 0
v_mfma_f32_16x16x32_bf16 v[80:83], a[160:163], v[160:163], v[80:83]
ds_read_b64_tr_b16 a[194:195], v194 offset:4096
v_and_b32 v9, 1, v0
v_mfma_f32_16x16x32_bf16 v[80:83], a[164:167], v[164:167], v[80:83]
buffer_load_dwordx4 a[56:59], v15, s[44:47], s65 offen offset:1024 sc1
v_mfma_f32_16x16x32_bf16 v[48:51], a[164:167], v[156:159], v[48:51]
ds_read_b64_tr_b16 a[196:197], v194 offset:8192
v_lshlrev_b32 v9, 4, v9
v_mfma_f32_16x16x32_bf16 v[48:51], a[160:163], v[152:155], v[48:51]
ds_read_b64_tr_b16 a[198:199], v194 offset:12288
v_mov_b32 v10, 0x3f80
v_mfma_f32_16x16x32_bf16 v[52:55], a[168:171], v[152:155], v[52:55]
s_add_u32 s65, s84, 106496
v_lshlrev_b32 v9, v9, v10
v_lshrrev_b32 v10, 4, v0
v_mfma_f32_16x16x32_bf16 v[52:55], a[172:175], v[156:159], v[52:55]
buffer_load_dwordx4 a[36:39], v14, s[44:47], s65 offen offset:0 sc1
v_mfma_f32_16x16x32_bf16 v[84:87], a[172:175], v[164:167], v[84:87]
ds_read_b64_tr_b16 a[200:201], v195 offset:0
v_lshlrev_b32 v10, 1, v10
v_mfma_f32_16x16x32_bf16 v[84:87], a[168:171], v[160:163], v[84:87]
ds_read_b64_tr_b16 a[202:203], v195 offset:4096
v_bfe_u32 v11, v0, 1, 3
v_mfma_f32_16x16x32_bf16 v[116:119], a[168:171], v[168:171], v[116:119]
buffer_load_dwordx4 a[44:47], v14, s[44:47], s65 offen offset:1024 sc1
v_mfma_f32_16x16x32_bf16 v[116:119], a[172:175], v[172:175], v[116:119]
ds_read_b64_tr_b16 a[204:205], v195 offset:8192
v_xor_b32 v10, v10, v11
v_mfma_f32_16x16x32_bf16 v[148:151], a[172:175], v[180:183], v[148:151]
ds_read_b64_tr_b16 a[206:207], v195 offset:12288
v_subrev_u32 v11, 1, v10
v_mfma_f32_16x16x32_bf16 v[148:151], a[168:171], v[176:179], v[148:151]
v_ashrrev_i32 v11, 31, v11
v_and_b32 v234, v11, v9
v_mfma_f32_16x16x32_bf16 v[120:123], a[176:179], v[176:179], v[120:123]
s_waitcnt lgkmcnt(4)
buffer_load_dwordx4 a[52:55], v15, s[44:47], s65 offen offset:0 sc1
v_mfma_f32_16x16x32_bf16 v[120:123], a[180:183], v[180:183], v[120:123]
v_xor_b32 v10, 1, v10
v_subrev_u32 v11, 1, v10
v_mfma_f32_16x16x32_bf16 v[88:91], a[180:183], v[172:175], v[88:91]
v_ashrrev_i32 v11, 31, v11
v_and_b32 v235, v11, v9
v_mfma_f32_16x16x32_bf16 v[88:91], a[176:179], v[168:171], v[88:91]
s_mov_b32 s48, s24
buffer_load_dwordx4 a[60:63], v15, s[44:47], s65 offen offset:1024 sc1
v_mfma_f32_16x16x32_bf16 v[56:59], a[176:179], v[160:163], v[56:59]
s_mov_b32 s49, s25
s_mov_b32 s50, 4194304
s_mov_b32 s51, 0x20000
v_mfma_f32_16x16x32_bf16 v[56:59], a[180:183], v[164:167], v[56:59]
v_mfma_f32_16x16x32_bf16 v[24:27], a[180:183], v[156:159], v[24:27]
v_mfma_f32_16x16x32_bf16 v[24:27], a[176:179], v[152:155], v[24:27]
v_mfma_f32_16x16x32_bf16 v[28:31], a[184:187], v[152:155], v[28:31]
s_waitcnt vmcnt(24)
s_barrier
v_mfma_f32_16x16x32_bf16 v[28:31], a[188:191], v[156:159], v[28:31]
ds_read_b64_tr_b16 a[144:145], v196 offset:32768
v_mfma_f32_16x16x32_bf16 v[60:63], a[188:191], v[164:167], v[60:63]
ds_read_b64_tr_b16 a[146:147], v196 offset:36864
v_mfma_f32_16x16x32_bf16 v[60:63], a[184:187], v[160:163], v[60:63]
ds_read_b64_tr_b16 a[148:149], v196 offset:40960
v_mfma_f32_16x16x32_bf16 v[92:95], a[184:187], v[168:171], v[92:95]
ds_read_b64_tr_b16 a[150:151], v196 offset:45056
v_mfma_f32_16x16x32_bf16 v[92:95], a[188:191], v[172:175], v[92:95]
ds_read_b64_tr_b16 a[152:153], v197 offset:32768
v_mfma_f32_16x16x32_bf16 v[124:127], a[188:191], v[180:183], v[124:127]
ds_read_b64_tr_b16 a[154:155], v197 offset:36864
v_mfma_f32_16x16x32_bf16 v[124:127], a[184:187], v[176:179], v[124:127]
ds_read_b64_tr_b16 a[156:157], v197 offset:40960
v_mfma_f32_16x16x32_bf16 v[128:131], a[192:195], v[176:179], v[128:131]
ds_read_b64_tr_b16 a[158:159], v197 offset:45056
v_mfma_f32_16x16x32_bf16 v[128:131], a[196:199], v[180:183], v[128:131]
ds_read_b64_tr_b16 a[160:161], v198 offset:32768
v_mfma_f32_16x16x32_bf16 v[96:99], a[196:199], v[172:175], v[96:99]
ds_read_b64_tr_b16 a[162:163], v198 offset:36864
v_mfma_f32_16x16x32_bf16 v[96:99], a[192:195], v[168:171], v[96:99]
ds_read_b64_tr_b16 a[164:165], v198 offset:40960
v_mfma_f32_16x16x32_bf16 v[64:67], a[192:195], v[160:163], v[64:67]
ds_read_b64_tr_b16 a[166:167], v198 offset:45056
v_mfma_f32_16x16x32_bf16 v[64:67], a[196:199], v[164:167], v[64:67]
v_mfma_f32_16x16x32_bf16 v[32:35], a[196:199], v[156:159], v[32:35]
v_mfma_f32_16x16x32_bf16 v[32:35], a[192:195], v[152:155], v[32:35]
s_waitcnt lgkmcnt(5)
v_mfma_f32_16x16x32_bf16 v[36:39], a[200:203], v[152:155], v[36:39]
v_mfma_f32_16x16x32_bf16 v[36:39], a[204:207], v[156:159], v[36:39]
v_mfma_f32_16x16x32_bf16 v[68:71], a[204:207], v[164:167], v[68:71]
v_mfma_f32_16x16x32_bf16 v[68:71], a[200:203], v[160:163], v[68:71]
v_mfma_f32_16x16x32_bf16 v[100:103], a[200:203], v[168:171], v[100:103]
v_mfma_f32_16x16x32_bf16 v[100:103], a[204:207], v[172:175], v[100:103]
v_mfma_f32_16x16x32_bf16 v[132:135], a[204:207], v[180:183], v[132:135]
v_mfma_f32_16x16x32_bf16 v[132:135], a[200:203], v[176:179], v[132:135]
s_waitcnt vmcnt(20)
v_mfma_f32_16x16x32_bf16 v[136:139], a[144:147], a[24:27], v[136:139]
s_waitcnt vmcnt(16)
ds_read_b64_tr_b16 a[168:169], v199 offset:32768
v_mfma_f32_16x16x32_bf16 v[136:139], a[148:151], a[28:31], v[136:139]
ds_read_b64_tr_b16 a[170:171], v199 offset:36864
v_mfma_f32_16x16x32_bf16 v[104:107], a[148:151], a[20:23], v[104:107]
ds_read_b64_tr_b16 a[172:173], v199 offset:40960
v_mfma_f32_16x16x32_bf16 v[104:107], a[144:147], a[16:19], v[104:107]
ds_read_b64_tr_b16 a[174:175], v199 offset:45056
v_mfma_f32_16x16x32_bf16 v[72:75], a[144:147], a[8:11], v[72:75]
v_mfma_f32_16x16x32_bf16 v[72:75], a[148:151], a[12:15], v[72:75]
v_mfma_f32_16x16x32_bf16 v[40:43], a[148:151], a[4:7], v[40:43]
s_waitcnt vmcnt(8)
s_barrier
v_mfma_f32_16x16x32_bf16 v[40:43], a[144:147], a[0:3], v[40:43]
ds_read_b64_tr_b16 a[176:177], v188 offset:0
v_mfma_f32_16x16x32_bf16 v[44:47], a[152:155], a[0:3], v[44:47]
s_waitcnt lgkmcnt(4)
ds_read_b64_tr_b16 a[178:179], v188 offset:4096
v_mfma_f32_16x16x32_bf16 v[44:47], a[156:159], a[4:7], v[44:47]
ds_read_b64_tr_b16 a[180:181], v188 offset:8192
v_mfma_f32_16x16x32_bf16 v[76:79], a[156:159], a[12:15], v[76:79]
ds_read_b64_tr_b16 a[182:183], v188 offset:12288
v_mfma_f32_16x16x32_bf16 v[76:79], a[152:155], a[8:11], v[76:79]
ds_read_b64_tr_b16 a[184:185], v189 offset:0
v_mfma_f32_16x16x32_bf16 v[108:111], a[152:155], a[16:19], v[108:111]
ds_read_b64_tr_b16 a[186:187], v189 offset:4096
v_mfma_f32_16x16x32_bf16 v[108:111], a[156:159], a[20:23], v[108:111]
ds_read_b64_tr_b16 a[188:189], v189 offset:8192
v_mfma_f32_16x16x32_bf16 v[140:143], a[156:159], a[28:31], v[140:143]
ds_read_b64_tr_b16 a[190:191], v189 offset:12288
v_mfma_f32_16x16x32_bf16 v[140:143], a[152:155], a[24:27], v[140:143]
v_mfma_f32_16x16x32_bf16 v[144:147], a[160:163], a[24:27], v[144:147]
v_mfma_f32_16x16x32_bf16 v[144:147], a[164:167], a[28:31], v[144:147]
v_mfma_f32_16x16x32_bf16 v[112:115], a[164:167], a[20:23], v[112:115]
ds_read_b64_tr_b16 a[192:193], v190 offset:0
v_mfma_f32_16x16x32_bf16 v[112:115], a[160:163], a[16:19], v[112:115]
ds_read_b64_tr_b16 a[194:195], v190 offset:4096
v_mfma_f32_16x16x32_bf16 v[80:83], a[160:163], a[8:11], v[80:83]
ds_read_b64_tr_b16 a[196:197], v190 offset:8192
v_mfma_f32_16x16x32_bf16 v[80:83], a[164:167], a[12:15], v[80:83]
ds_read_b64_tr_b16 a[198:199], v190 offset:12288
v_mfma_f32_16x16x32_bf16 v[48:51], a[164:167], a[4:7], v[48:51]
v_mfma_f32_16x16x32_bf16 v[48:51], a[160:163], a[0:3], v[48:51]
s_waitcnt lgkmcnt(4)
v_mfma_f32_16x16x32_bf16 v[52:55], a[168:171], a[0:3], v[52:55]
v_mfma_f32_16x16x32_bf16 v[52:55], a[172:175], a[4:7], v[52:55]
v_mfma_f32_16x16x32_bf16 v[84:87], a[172:175], a[12:15], v[84:87]
ds_read_b64_tr_b16 a[200:201], v191 offset:0
v_mfma_f32_16x16x32_bf16 v[84:87], a[168:171], a[8:11], v[84:87]
ds_read_b64_tr_b16 a[202:203], v191 offset:4096
v_mfma_f32_16x16x32_bf16 v[116:119], a[168:171], a[16:19], v[116:119]
ds_read_b64_tr_b16 a[204:205], v191 offset:8192
v_mfma_f32_16x16x32_bf16 v[116:119], a[172:175], a[20:23], v[116:119]
ds_read_b64_tr_b16 a[206:207], v191 offset:12288
v_mfma_f32_16x16x32_bf16 v[148:151], a[172:175], a[28:31], v[148:151]
v_mfma_f32_16x16x32_bf16 v[148:151], a[168:171], a[24:27], v[148:151]
s_waitcnt vmcnt(4)
v_mfma_f32_16x16x32_bf16 v[136:139], a[176:179], a[56:59], v[136:139]
s_waitcnt vmcnt(0)
v_mfma_f32_16x16x32_bf16 v[136:139], a[180:183], a[60:63], v[136:139]
v_mfma_f32_16x16x32_bf16 v[104:107], a[180:183], a[52:55], v[104:107]
ds_read_b64_tr_b16 a[144:145], v192 offset:32768
v_mfma_f32_16x16x32_bf16 v[104:107], a[176:179], a[48:51], v[104:107]
ds_read_b64_tr_b16 a[146:147], v192 offset:36864
v_mfma_f32_16x16x32_bf16 v[72:75], a[176:179], a[40:43], v[72:75]
ds_read_b64_tr_b16 a[148:149], v192 offset:40960
v_mfma_f32_16x16x32_bf16 v[72:75], a[180:183], a[44:47], v[72:75]
ds_read_b64_tr_b16 a[150:151], v192 offset:45056
v_mfma_f32_16x16x32_bf16 v[40:43], a[180:183], a[36:39], v[40:43]
v_mfma_f32_16x16x32_bf16 v[40:43], a[176:179], a[32:35], v[40:43]
v_mfma_f32_16x16x32_bf16 v[44:47], a[184:187], a[32:35], v[44:47]
v_mfma_f32_16x16x32_bf16 v[44:47], a[188:191], a[36:39], v[44:47]
ds_write_b128 v3, v[136:139] offset:4096
v_mfma_f32_16x16x32_bf16 v[76:79], a[188:191], a[44:47], v[76:79]
ds_read_b64_tr_b16 a[152:153], v193 offset:32768
v_mfma_f32_16x16x32_bf16 v[76:79], a[184:187], a[40:43], v[76:79]
ds_write_b128 v3, v[104:107] offset:0
v_mfma_f32_16x16x32_bf16 v[108:111], a[184:187], a[48:51], v[108:111]
ds_read_b64_tr_b16 a[154:155], v193 offset:36864
v_mfma_f32_16x16x32_bf16 v[108:111], a[188:191], a[52:55], v[108:111]
ds_read_b64_tr_b16 a[156:157], v193 offset:40960
v_mfma_f32_16x16x32_bf16 v[140:143], a[188:191], a[60:63], v[140:143]
ds_read_b64_tr_b16 a[158:159], v193 offset:45056
v_mfma_f32_16x16x32_bf16 v[140:143], a[184:187], a[56:59], v[140:143]
s_waitcnt lgkmcnt(6)
v_mfma_f32_16x16x32_bf16 v[144:147], a[192:195], a[56:59], v[144:147]
v_mfma_f32_16x16x32_bf16 v[144:147], a[196:199], a[60:63], v[144:147]
v_mfma_f32_16x16x32_bf16 v[112:115], a[196:199], a[52:55], v[112:115]
ds_read_b64_tr_b16 a[160:161], v194 offset:32768
v_mfma_f32_16x16x32_bf16 v[112:115], a[192:195], a[48:51], v[112:115]
ds_read_b64_tr_b16 a[162:163], v194 offset:36864
v_mfma_f32_16x16x32_bf16 v[80:83], a[192:195], a[40:43], v[80:83]
ds_read_b64_tr_b16 a[164:165], v194 offset:40960
v_mfma_f32_16x16x32_bf16 v[80:83], a[196:199], a[44:47], v[80:83]
ds_write_b128 v3, v[108:111] offset:1024
v_mfma_f32_16x16x32_bf16 v[48:51], a[196:199], a[36:39], v[48:51]
ds_read_b64_tr_b16 a[166:167], v194 offset:45056
v_mfma_f32_16x16x32_bf16 v[48:51], a[192:195], a[32:35], v[48:51]
ds_write_b128 v3, v[140:143] offset:5120
v_mfma_f32_16x16x32_bf16 v[52:55], a[200:203], a[32:35], v[52:55]
v_mfma_f32_16x16x32_bf16 v[52:55], a[204:207], a[36:39], v[52:55]
ds_write_b128 v3, v[144:147] offset:6144
v_mfma_f32_16x16x32_bf16 v[84:87], a[204:207], a[44:47], v[84:87]
ds_read_b64_tr_b16 a[168:169], v195 offset:32768
v_mfma_f32_16x16x32_bf16 v[84:87], a[200:203], a[40:43], v[84:87]
ds_write_b128 v3, v[112:115] offset:2048
v_mfma_f32_16x16x32_bf16 v[116:119], a[200:203], a[48:51], v[116:119]
ds_read_b64_tr_b16 a[170:171], v195 offset:36864
v_mfma_f32_16x16x32_bf16 v[116:119], a[204:207], a[52:55], v[116:119]
ds_read_b64_tr_b16 a[172:173], v195 offset:40960
v_mfma_f32_16x16x32_bf16 v[148:151], a[204:207], a[60:63], v[148:151]
ds_read_b64_tr_b16 a[174:175], v195 offset:45056
v_mfma_f32_16x16x32_bf16 v[148:151], a[200:203], a[56:59], v[148:151]
v_mfma_f32_16x16x32_bf16 v[120:123], a[144:147], a[24:27], v[120:123]
v_mfma_f32_16x16x32_bf16 v[120:123], a[148:151], a[28:31], v[120:123]
v_mfma_f32_16x16x32_bf16 v[88:91], a[148:151], a[20:23], v[88:91]
ds_read_b64_tr_b16 a[176:177], v184 offset:0
v_mfma_f32_16x16x32_bf16 v[88:91], a[144:147], a[16:19], v[88:91]
ds_read_b64_tr_b16 a[178:179], v184 offset:4096
v_mfma_f32_16x16x32_bf16 v[56:59], a[144:147], a[8:11], v[56:59]
ds_read_b64_tr_b16 a[180:181], v184 offset:8192
v_mfma_f32_16x16x32_bf16 v[56:59], a[148:151], a[12:15], v[56:59]
ds_write_b128 v3, v[116:119] offset:3072
v_mfma_f32_16x16x32_bf16 v[24:27], a[148:151], a[4:7], v[24:27]
ds_read_b64_tr_b16 a[182:183], v184 offset:12288
v_mfma_f32_16x16x32_bf16 v[24:27], a[144:147], a[0:3], v[24:27]
s_waitcnt lgkmcnt(5)
ds_write_b128 v3, v[148:151] offset:7168
v_mfma_f32_16x16x32_bf16 v[28:31], a[152:155], a[0:3], v[28:31]
v_mfma_f32_16x16x32_bf16 v[28:31], a[156:159], a[4:7], v[28:31]
v_mfma_f32_16x16x32_bf16 v[60:63], a[156:159], a[12:15], v[60:63]
s_waitcnt lgkmcnt(0)
s_barrier
v_mfma_f32_16x16x32_bf16 v[60:63], a[152:155], a[8:11], v[60:63]
ds_read_b128 v[200:203], v2 offset:0
ds_read_b128 v[204:207], v2 offset:1024
v_mfma_f32_16x16x32_bf16 v[92:95], a[152:155], a[16:19], v[92:95]
ds_read_b128 v[208:211], v2 offset:2048
ds_read_b128 v[212:215], v2 offset:3072
v_mfma_f32_16x16x32_bf16 v[92:95], a[156:159], a[20:23], v[92:95]
ds_read_b128 v[216:219], v2 offset:4096
ds_read_b128 v[220:223], v2 offset:5120
v_mfma_f32_16x16x32_bf16 v[124:127], a[156:159], a[28:31], v[124:127]
ds_read_b128 v[224:227], v2 offset:6144
ds_read_b128 v[228:231], v2 offset:7168
v_mfma_f32_16x16x32_bf16 v[124:127], a[152:155], a[24:27], v[124:127]
ds_read_b64_tr_b16 a[184:185], v185 offset:0
v_mfma_f32_16x16x32_bf16 v[128:131], a[160:163], a[24:27], v[128:131]
ds_read_b64_tr_b16 a[186:187], v185 offset:4096
v_mfma_f32_16x16x32_bf16 v[128:131], a[164:167], a[28:31], v[128:131]
ds_read_b64_tr_b16 a[188:189], v185 offset:8192
v_mfma_f32_16x16x32_bf16 v[96:99], a[164:167], a[20:23], v[96:99]
s_waitcnt lgkmcnt(10)
ds_read_b64_tr_b16 a[190:191], v185 offset:12288
v_add_f32 v200, v200, v40
v_mfma_f32_16x16x32_bf16 v[96:99], a[160:163], a[16:19], v[96:99]
ds_read_b64_tr_b16 a[192:193], v186 offset:0
v_add_f32 v201, v201, v41
v_mfma_f32_16x16x32_bf16 v[64:67], a[160:163], a[8:11], v[64:67]
ds_read_b64_tr_b16 a[194:195], v186 offset:4096
v_add_f32 v202, v202, v42
v_mfma_f32_16x16x32_bf16 v[64:67], a[164:167], a[12:15], v[64:67]
ds_read_b64_tr_b16 a[196:197], v186 offset:8192
v_add_f32 v203, v203, v43
v_mfma_f32_16x16x32_bf16 v[32:35], a[164:167], a[4:7], v[32:35]
s_waitcnt lgkmcnt(7)
ds_read_b64_tr_b16 a[198:199], v186 offset:12288
v_add_f32 v204, v204, v44
v_mfma_f32_16x16x32_bf16 v[32:35], a[160:163], a[0:3], v[32:35]
v_add_f32 v205, v205, v45
v_add_f32 v206, v206, v46
v_mfma_f32_16x16x32_bf16 v[36:39], a[168:171], a[0:3], v[36:39]
v_add_f32 v207, v207, v47
v_cvt_pk_bf16_f32 v200, v200, v201
v_mfma_f32_16x16x32_bf16 v[36:39], a[172:175], a[4:7], v[36:39]
v_cvt_pk_bf16_f32 v201, v202, v203
v_cvt_pk_bf16_f32 v202, v204, v205
v_cvt_pk_bf16_f32 v203, v206, v207
v_mfma_f32_16x16x32_bf16 v[68:71], a[172:175], a[12:15], v[68:71]
buffer_store_dwordx4 v[200:203], v16, s[44:47], s73 offen offset:0 sc1
v_mfma_f32_16x16x32_bf16 v[68:71], a[168:171], a[8:11], v[68:71]
ds_read_b64_tr_b16 a[200:201], v187 offset:0
v_add_f32 v208, v208, v48
v_mfma_f32_16x16x32_bf16 v[100:103], a[168:171], a[16:19], v[100:103]
ds_read_b64_tr_b16 a[202:203], v187 offset:4096
v_add_f32 v209, v209, v49
v_mfma_f32_16x16x32_bf16 v[100:103], a[172:175], a[20:23], v[100:103]
ds_read_b64_tr_b16 a[204:205], v187 offset:8192
v_add_f32 v210, v210, v50
v_mfma_f32_16x16x32_bf16 v[132:135], a[172:175], a[28:31], v[132:135]
ds_read_b64_tr_b16 a[206:207], v187 offset:12288
v_add_f32 v211, v211, v51
v_mfma_f32_16x16x32_bf16 v[132:135], a[168:171], a[24:27], v[132:135]
v_add_f32 v212, v212, v52
v_add_f32 v213, v213, v53
v_mfma_f32_16x16x32_bf16 v[120:123], a[176:179], a[56:59], v[120:123]
v_add_f32 v214, v214, v54
v_add_f32 v215, v215, v55
v_mfma_f32_16x16x32_bf16 v[120:123], a[180:183], a[60:63], v[120:123]
v_cvt_pk_bf16_f32 v208, v208, v209
v_cvt_pk_bf16_f32 v209, v210, v211
v_cvt_pk_bf16_f32 v210, v212, v213
v_cvt_pk_bf16_f32 v211, v214, v215
v_mfma_f32_16x16x32_bf16 v[88:91], a[180:183], a[52:55], v[88:91]
buffer_store_dwordx4 v[208:211], v16, s[44:47], s73 offen offset:1024 sc1
v_mfma_f32_16x16x32_bf16 v[88:91], a[176:179], a[48:51], v[88:91]
v_add_f32 v216, v216, v72
v_add_f32 v217, v217, v73
v_mfma_f32_16x16x32_bf16 v[56:59], a[176:179], a[40:43], v[56:59]
v_add_f32 v218, v218, v74
v_add_f32 v219, v219, v75
v_mfma_f32_16x16x32_bf16 v[56:59], a[180:183], a[44:47], v[56:59]
v_add_f32 v220, v220, v76
v_add_f32 v221, v221, v77
v_mfma_f32_16x16x32_bf16 v[24:27], a[180:183], a[36:39], v[24:27]
v_add_f32 v222, v222, v78
v_add_f32 v223, v223, v79
v_mfma_f32_16x16x32_bf16 v[24:27], a[176:179], a[32:35], v[24:27]
s_waitcnt lgkmcnt(0)
v_cvt_pk_bf16_f32 v216, v216, v217
v_cvt_pk_bf16_f32 v217, v218, v219
v_mfma_f32_16x16x32_bf16 v[28:31], a[184:187], a[32:35], v[28:31]
v_cvt_pk_bf16_f32 v218, v220, v221
v_cvt_pk_bf16_f32 v219, v222, v223
v_mfma_f32_16x16x32_bf16 v[28:31], a[188:191], a[36:39], v[28:31]
buffer_store_dwordx4 v[216:219], v16, s[44:47], s73 offen offset:2048 sc1
v_mfma_f32_16x16x32_bf16 v[60:63], a[188:191], a[44:47], v[60:63]
v_add_f32 v224, v224, v80
v_add_f32 v225, v225, v81
v_mfma_f32_16x16x32_bf16 v[60:63], a[184:187], a[40:43], v[60:63]
v_add_f32 v226, v226, v82
v_add_f32 v227, v227, v83
v_mfma_f32_16x16x32_bf16 v[92:95], a[184:187], a[48:51], v[92:95]
v_add_f32 v228, v228, v84
v_add_f32 v229, v229, v85
v_mfma_f32_16x16x32_bf16 v[92:95], a[188:191], a[52:55], v[92:95]
v_add_f32 v230, v230, v86
v_add_f32 v231, v231, v87
v_mfma_f32_16x16x32_bf16 v[124:127], a[188:191], a[60:63], v[124:127]
v_cvt_pk_bf16_f32 v224, v224, v225
v_cvt_pk_bf16_f32 v225, v226, v227
v_mfma_f32_16x16x32_bf16 v[124:127], a[184:187], a[56:59], v[124:127]
v_cvt_pk_bf16_f32 v226, v228, v229
v_cvt_pk_bf16_f32 v227, v230, v231
v_mfma_f32_16x16x32_bf16 v[128:131], a[192:195], a[56:59], v[128:131]
buffer_store_dwordx4 v[224:227], v16, s[44:47], s73 offen offset:3072 sc1
v_mfma_f32_16x16x32_bf16 v[128:131], a[196:199], a[60:63], v[128:131]
ds_write_b128 v3, v[120:123] offset:36864
v_mfma_f32_16x16x32_bf16 v[96:99], a[196:199], a[52:55], v[96:99]
ds_write_b128 v3, v[88:91] offset:32768
v_mfma_f32_16x16x32_bf16 v[96:99], a[192:195], a[48:51], v[96:99]
v_mfma_f32_16x16x32_bf16 v[64:67], a[192:195], a[40:43], v[64:67]
v_mfma_f32_16x16x32_bf16 v[64:67], a[196:199], a[44:47], v[64:67]
ds_write_b128 v3, v[92:95] offset:33792
v_mfma_f32_16x16x32_bf16 v[32:35], a[196:199], a[36:39], v[32:35]
v_mfma_f32_16x16x32_bf16 v[32:35], a[192:195], a[32:35], v[32:35]
ds_write_b128 v3, v[124:127] offset:37888
v_mfma_f32_16x16x32_bf16 v[36:39], a[200:203], a[32:35], v[36:39]
v_mfma_f32_16x16x32_bf16 v[36:39], a[204:207], a[36:39], v[36:39]
ds_write_b128 v3, v[128:131] offset:38912
v_mfma_f32_16x16x32_bf16 v[68:71], a[204:207], a[44:47], v[68:71]
v_mfma_f32_16x16x32_bf16 v[68:71], a[200:203], a[40:43], v[68:71]
ds_write_b128 v3, v[96:99] offset:34816
v_mfma_f32_16x16x32_bf16 v[100:103], a[200:203], a[48:51], v[100:103]
v_mfma_f32_16x16x32_bf16 v[100:103], a[204:207], a[52:55], v[100:103]
v_mfma_f32_16x16x32_bf16 v[132:135], a[204:207], a[60:63], v[132:135]
v_mfma_f32_16x16x32_bf16 v[132:135], a[200:203], a[56:59], v[132:135]
buffer_load_dwordx4 v[152:155], v16, s[44:47], s75 offen offset:0 sc1
buffer_load_dwordx4 v[156:159], v16, s[44:47], s75 offen offset:1024 sc1
buffer_load_dwordx4 v[160:163], v16, s[44:47], s75 offen offset:2048 sc1
buffer_load_dwordx4 v[164:167], v16, s[44:47], s75 offen offset:3072 sc1
s_nop 3
ds_write_b128 v3, v[100:103] offset:35840
ds_write_b128 v3, v[132:135] offset:39936
s_mov_b32 s72, 0x20000
s_waitcnt lgkmcnt(0)
s_barrier
ds_read_b128 v[88:91], v2 offset:32768
ds_read_b128 v[92:95], v2 offset:33792
ds_read_b128 v[96:99], v2 offset:34816
ds_read_b128 v[100:103], v2 offset:35840
ds_read_b128 v[120:123], v2 offset:36864
ds_read_b128 v[124:127], v2 offset:37888
ds_read_b128 v[128:131], v2 offset:38912
ds_read_b128 v[132:135], v2 offset:39936
s_waitcnt lgkmcnt(7)
v_add_f32 v24, v24, v88
v_add_f32 v25, v25, v89
v_add_f32 v26, v26, v90
v_add_f32 v27, v27, v91
s_waitcnt lgkmcnt(6)
v_add_f32 v28, v28, v92
v_add_f32 v29, v29, v93
v_add_f32 v30, v30, v94
v_add_f32 v31, v31, v95
s_waitcnt lgkmcnt(5)
v_add_f32 v32, v32, v96
v_add_f32 v33, v33, v97
v_add_f32 v34, v34, v98
v_add_f32 v35, v35, v99
s_waitcnt lgkmcnt(4)
v_add_f32 v36, v36, v100
v_add_f32 v37, v37, v101
v_add_f32 v38, v38, v102
v_add_f32 v39, v39, v103
s_waitcnt lgkmcnt(3)
v_add_f32 v56, v56, v120
v_add_f32 v57, v57, v121
v_add_f32 v58, v58, v122
v_add_f32 v59, v59, v123
s_waitcnt lgkmcnt(2)
v_add_f32 v60, v60, v124
v_add_f32 v61, v61, v125
v_add_f32 v62, v62, v126
v_add_f32 v63, v63, v127
s_waitcnt lgkmcnt(1)
v_add_f32 v64, v64, v128
v_add_f32 v65, v65, v129
v_add_f32 v66, v66, v130
v_add_f32 v67, v67, v131
s_waitcnt lgkmcnt(0)
v_add_f32 v68, v68, v132
v_add_f32 v69, v69, v133
v_add_f32 v70, v70, v134
v_add_f32 v71, v71, v135
L_xchk:
s_waitcnt vmcnt(0)
v_max3_u32 v9, v152, v153, v154
v_max3_u32 v9, v9, v155, v156
v_max3_u32 v9, v9, v157, v158
v_max3_u32 v9, v9, v159, v160
v_max3_u32 v9, v9, v161, v162
v_max3_u32 v9, v9, v163, v164
v_max3_u32 v9, v9, v165, v166
v_max_u32 v9, v9, v167
v_cmp_eq_u32 vcc, -1, v9
s_cbranch_vccnz L_xretry
L_xgo:
v_mfma_f32_16x16x32_bf16 v[24:27], v[234:237], v[152:155], v[24:27]
v_mfma_f32_16x16x32_bf16 v[28:31], v[232:235], v[152:155], v[28:31]
v_mfma_f32_16x16x32_bf16 v[32:35], v[234:237], v[156:159], v[32:35]
v_mfma_f32_16x16x32_bf16 v[36:39], v[232:235], v[156:159], v[36:39]
v_mfma_f32_16x16x32_bf16 v[56:59], v[234:237], v[160:163], v[56:59]
v_mfma_f32_16x16x32_bf16 v[60:63], v[232:235], v[160:163], v[60:63]
v_mfma_f32_16x16x32_bf16 v[64:67], v[234:237], v[164:167], v[64:67]
v_mfma_f32_16x16x32_bf16 v[68:71], v[232:235], v[164:167], v[68:71]
s_nop 1
v_cvt_pk_bf16_f32 v24, v24, v25
v_cvt_pk_bf16_f32 v25, v26, v27
v_cvt_pk_bf16_f32 v26, v28, v29
v_cvt_pk_bf16_f32 v27, v30, v31
v_cvt_pk_bf16_f32 v32, v32, v33
v_cvt_pk_bf16_f32 v33, v34, v35
v_cvt_pk_bf16_f32 v34, v36, v37
v_cvt_pk_bf16_f32 v35, v38, v39
v_permlane16_swap_b32 v24, v26
v_permlane16_swap_b32 v25, v27
v_permlane16_swap_b32 v32, v34
v_permlane16_swap_b32 v33, v35
v_mov_b32 v28, v24
v_mov_b32 v29, v25
v_mov_b32 v30, v26
v_mov_b32 v31, v27
v_mov_b32_dpp v24, v32 row_ror:8 row_mask:0xf bank_mask:0xc
v_mov_b32_dpp v25, v33 row_ror:8 row_mask:0xf bank_mask:0xc
v_mov_b32_dpp v26, v34 row_ror:8 row_mask:0xf bank_mask:0xc
v_mov_b32_dpp v27, v35 row_ror:8 row_mask:0xf bank_mask:0xc
v_mov_b32_dpp v32, v28 row_ror:8 row_mask:0xf bank_mask:0x3
v_mov_b32_dpp v33, v29 row_ror:8 row_mask:0xf bank_mask:0x3
v_mov_b32_dpp v34, v30 row_ror:8 row_mask:0xf bank_mask:0x3
v_mov_b32_dpp v35, v31 row_ror:8 row_mask:0xf bank_mask:0x3
buffer_store_dwordx4 v[24:27], v8, s[48:51], s77 offen sc1
s_add_u32 s77, s77, 16384
buffer_store_dwordx4 v[32:35], v8, s[48:51], s77 offen sc1
s_add_u32 s77, s77, 16384
v_cvt_pk_bf16_f32 v56, v56, v57
v_cvt_pk_bf16_f32 v57, v58, v59
v_cvt_pk_bf16_f32 v58, v60, v61
v_cvt_pk_bf16_f32 v59, v62, v63
v_cvt_pk_bf16_f32 v64, v64, v65
v_cvt_pk_bf16_f32 v65, v66, v67
v_cvt_pk_bf16_f32 v66, v68, v69
v_cvt_pk_bf16_f32 v67, v70, v71
v_permlane16_swap_b32 v56, v58
v_permlane16_swap_b32 v57, v59
v_permlane16_swap_b32 v64, v66
v_permlane16_swap_b32 v65, v67
v_mov_b32 v60, v56
v_mov_b32 v61, v57
v_mov_b32 v62, v58
v_mov_b32 v63, v59
v_mov_b32_dpp v56, v64 row_ror:8 row_mask:0xf bank_mask:0xc
v_mov_b32_dpp v57, v65 row_ror:8 row_mask:0xf bank_mask:0xc
v_mov_b32_dpp v58, v66 row_ror:8 row_mask:0xf bank_mask:0xc
v_mov_b32_dpp v59, v67 row_ror:8 row_mask:0xf bank_mask:0xc
v_mov_b32_dpp v64, v60 row_ror:8 row_mask:0xf bank_mask:0x3
v_mov_b32_dpp v65, v61 row_ror:8 row_mask:0xf bank_mask:0x3
v_mov_b32_dpp v66, v62 row_ror:8 row_mask:0xf bank_mask:0x3
v_mov_b32_dpp v67, v63 row_ror:8 row_mask:0xf bank_mask:0x3
buffer_store_dwordx4 v[56:59], v8, s[48:51], s77 offen sc1
s_add_u32 s77, s77, 16384
buffer_store_dwordx4 v[64:67], v8, s[48:51], s77 offen sc1
s_add_u32 s77, s77, 16384
L_end:
s_endpgm
L_xretry:
s_sub_u32 s72, s72, 1
s_cbranch_scc1 L_xgo
buffer_load_dwordx4 v[152:155], v16, s[44:47], s75 offen offset:0 sc1
buffer_load_dwordx4 v[156:159], v16, s[44:47], s75 offen offset:1024 sc1
buffer_load_dwordx4 v[160:163], v16, s[44:47], s75 offen offset:2048 sc1
buffer_load_dwordx4 v[164:167], v16, s[44:47], s75 offen offset:3072 sc1
s_branch L_xchk
L_spin_1:
s_mov_b32 vcc_hi, 0x80000
L_spinlp_3:
s_sleep 1
buffer_load_dword v1, off, s[52:55], s78 offset:0 sc1
s_waitcnt vmcnt(0)
v_readfirstlane_b32 vcc_lo, v1
s_sub_u32 vcc_hi, vcc_hi, 1
s_cbranch_scc1 L_spinbk_2
s_cmp_lt_u32 vcc_lo, s81
s_cbranch_scc1 L_spinlp_3
s_branch L_spinbk_2
L_spin_4:
s_mov_b32 vcc_hi, 0x80000
L_spinlp_6:
s_sleep 1
buffer_load_dword v1, off, s[52:55], s70 offset:0 sc1
s_waitcnt vmcnt(0)
v_readfirstlane_b32 vcc_lo, v1
s_sub_u32 vcc_hi, vcc_hi, 1
s_cbranch_scc1 L_spinbk_5
s_cmp_lt_u32 vcc_lo, s81
s_cbranch_scc1 L_spinlp_6
s_branch L_spinbk_5
L_hretry:
s_sub_u32 s72, s72, 1
s_cbranch_scc1 L_hgo
buffer_load_dwordx4 v[88:91], v16, s[44:47], s77 offen sc1
s_waitcnt vmcnt(0)
s_branch L_hchk
L_spin_8:
s_mov_b32 vcc_hi, 0x80000
L_spinlp_10:
s_sleep 1
buffer_load_dword v19, off, s[52:55], s80 offset:0 sc1
s_waitcnt vmcnt(0)
v_readfirstlane_b32 vcc_lo, v19
s_sub_u32 vcc_hi, vcc_hi, 1
s_cbranch_scc1 L_spinbk_9
s_cmp_lt_u32 vcc_lo, s69
s_cbranch_scc1 L_spinlp_10
s_branch L_spinbk_9
L_spin_1012:
s_mov_b32 vcc_hi, 0x80000
L_spinlp_1014:
s_sleep 1
buffer_load_dword v19, off, s[52:55], s80 offset:0 sc1
s_waitcnt vmcnt(0)
v_readfirstlane_b32 vcc_lo, v19
s_sub_u32 vcc_hi, vcc_hi, 1
s_cbranch_scc1 L_spinbk_1013
s_cmp_lt_u32 vcc_lo, s69
s_cbranch_scc1 L_spinlp_1014
s_branch L_spinbk_1013
L_F1:
ds_read_b128 a[144:147], v2 offset:0
ds_read_b128 a[148:151], v2 offset:1024
ds_read_b128 a[152:155], v2 offset:2048
ds_read_b128 a[156:159], v2 offset:3072
ds_read_b128 a[160:163], v2 offset:4096
ds_read_b128 a[164:167], v2 offset:5120
ds_read_b128 a[168:171], v2 offset:6144
ds_read_b128 a[172:175], v2 offset:7168
s_mov_b32 m0, s71
s_nop 0
buffer_load_dwordx4 v16, s[32:35], s70 offen offset:0 sc1 lds
buffer_load_dwordx4 v16, s[32:35], s70 offen offset:1024 sc1 lds
s_waitcnt lgkmcnt(7)
v_mfma_f32_16x16x32_bf16 v[104:107], a[144:147], v[40:43], 0
s_waitcnt lgkmcnt(6)
ds_read_b128 a[176:179], v2 offset:8192
v_cndmask_b32 v88, 0, v17, s[0:1]
v_mfma_f32_16x16x32_bf16 v[104:107], a[148:151], v[44:47], v[104:107]
s_waitcnt lgkmcnt(6)
ds_read_b128 a[180:183], v2 offset:9216
v_cndmask_b32 v89, 0, v17, s[4:5]
v_mfma_f32_16x16x32_bf16 v[104:107], a[152:155], v[48:51], v[104:107]
s_waitcnt lgkmcnt(6)
buffer_load_dwordx4 v16, s[32:35], s70 offen offset:2048 sc1 lds
v_mfma_f32_16x16x32_bf16 v[104:107], a[156:159], v[52:55], v[104:107]
ds_read_b128 a[184:187], v2 offset:10240
v_cndmask_b32 v90, 0, v17, s[6:7]
v_mfma_f32_16x16x32_bf16 v[120:123], a[156:159], v[68:71], 0
ds_read_b128 a[188:191], v2 offset:11264
v_cndmask_b32 v91, 0, v17, s[8:9]
v_mfma_f32_16x16x32_bf16 v[120:123], a[152:155], v[64:67], v[120:123]
ds_read_b128 a[192:195], v2 offset:12288
v_accvgpr_write_b32 a128, 0
v_mfma_f32_16x16x32_bf16 v[120:123], a[148:151], v[60:63], v[120:123]
ds_read_b128 a[196:199], v2 offset:13312
v_accvgpr_write_b32 a129, 0
v_mfma_f32_16x16x32_bf16 v[120:123], a[144:147], v[56:59], v[120:123]
ds_read_b128 a[200:203], v2 offset:14336
v_accvgpr_write_b32 a130, 0
v_mfma_f32_16x16x32_bf16 v[136:139], a[144:147], v[72:75], 0
ds_read_b128 a[204:207], v2 offset:15360
v_accvgpr_write_b32 a131, 0
v_mfma_f32_16x16x32_bf16 v[136:139], a[148:151], v[76:79], v[136:139]
buffer_load_dwordx4 v16, s[32:35], s70 offen offset:3072 sc1 lds
v_mfma_f32_16x16x32_bf16 v[136:139], a[152:155], v[80:83], v[136:139]
v_accvgpr_write_b32 a132, 0
v_accvgpr_write_b32 a133, 0
v_mfma_f32_16x16x32_bf16 v[136:139], a[156:159], v[84:87], v[136:139]
v_accvgpr_write_b32 a134, 0
v_accvgpr_write_b32 a135, 0
v_mfma_f32_16x16x32_bf16 v[88:91], a[156:159], v[36:39], v[88:91]
v_accvgpr_write_b32 a136, 0
v_accvgpr_write_b32 a137, 0
v_mfma_f32_16x16x32_bf16 v[88:91], a[152:155], v[32:35], v[88:91]
v_accvgpr_write_b32 a138, 0
v_accvgpr_write_b32 a139, 0
v_mfma_f32_16x16x32_bf16 v[88:91], a[148:151], v[28:31], v[88:91]
v_accvgpr_write_b32 a140, 0
v_accvgpr_write_b32 a141, 0
v_mfma_f32_16x16x32_bf16 v[88:91], a[144:147], v[24:27], v[88:91]
s_waitcnt lgkmcnt(0)
s_nop 1
v_max3_f32 v21, v104, v105, v106
v_max_f32 v21, v21, v107
v_max3_f32 v22, v120, v121, v122
v_max_f32 v22, v22, v123
v_max3_f32 v23, v136, v137, v138
v_max_f32 v23, v23, v139
v_max3_f32 v20, v88, v89, v90
v_max_f32 v20, v20, v91
v_mov_b32 v248, v20
v_mov_b32 v249, v21
v_mov_b32 v250, v22
v_mov_b32 v251, v23
v_permlane16_swap_b32 v248, v20
v_permlane16_swap_b32 v249, v21
v_permlane16_swap_b32 v250, v22
v_permlane16_swap_b32 v251, v23
v_max_f32 v20, v20, v248
v_max_f32 v21, v21, v249
v_max_f32 v22, v22, v250
v_max_f32 v23, v23, v251
v_mov_b32 v248, v20
v_mov_b32 v249, v21
v_mov_b32 v250, v22
v_mov_b32 v251, v23
v_permlane32_swap_b32 v248, v20
v_permlane32_swap_b32 v249, v21
v_permlane32_swap_b32 v250, v22
v_permlane32_swap_b32 v251, v23
v_max_f32 v20, v20, v248
v_max_f32 v21, v21, v249
v_max_f32 v22, v22, v250
v_max_f32 v23, v23, v251
s_cmp_eq_u32 s73, 0
s_cselect_b64 vcc, 0, -1
v_cndmask_b32 v20, v20, v252, vcc
v_cndmask_b32 v21, v21, v253, vcc
v_cndmask_b32 v22, v22, v254, vcc
v_cndmask_b32 v23, v23, v255, vcc
v_sub_f32 v228, 0, v23
v_sub_f32 v229, 0, v23
v_sub_f32 v230, 0, v23
v_sub_f32 v231, 0, v23
v_sub_f32 v224, 0, v22
v_sub_f32 v225, 0, v22
v_sub_f32 v226, 0, v22
v_sub_f32 v227, 0, v22
v_sub_f32 v220, 0, v21
v_sub_f32 v221, 0, v21
v_sub_f32 v222, 0, v21
v_sub_f32 v223, 0, v21
v_sub_f32 v216, 0, v20
v_sub_f32 v217, 0, v20
v_sub_f32 v218, 0, v20
v_sub_f32 v219, 0, v20
v_mfma_f32_16x16x32_bf16 v[140:143], a[160:163], v[72:75], v[228:231]
s_add_u32 m0, s71, 4096
v_add_f32 v104, v104, v220
v_add_f32 v105, v105, v220
v_mfma_f32_16x16x32_bf16 v[140:143], a[164:167], v[76:79], v[140:143]
v_add_f32 v106, v106, v220
v_add_f32 v107, v107, v220
v_exp_f32 v104, v104
v_mfma_f32_16x16x32_bf16 v[140:143], a[168:171], v[80:83], v[140:143]
s_add_u32 s64, s70, 4096
v_exp_f32 v105, v105
v_mfma_f32_16x16x32_bf16 v[140:143], a[172:175], v[84:87], v[140:143]
buffer_load_dwordx4 v16, s[32:35], s64 offen offset:0 sc1 lds
v_mfma_f32_16x16x32_bf16 v[124:127], a[172:175], v[68:71], v[224:227]
v_exp_f32 v106, v106
v_mfma_f32_16x16x32_bf16 v[124:127], a[168:171], v[64:67], v[124:127]
v_exp_f32 v107, v107
v_mfma_f32_16x16x32_bf16 v[124:127], a[164:167], v[60:63], v[124:127]
v_add_f32 v120, v120, v224
v_add_f32 v121, v121, v224
v_add_f32 v122, v122, v224
v_add_f32 v123, v123, v224
v_exp_f32 v120, v120
v_mfma_f32_16x16x32_bf16 v[124:127], a[160:163], v[56:59], v[124:127]
v_exp_f32 v121, v121
v_mfma_f32_16x16x32_bf16 v[108:111], a[160:163], v[40:43], v[220:223]
v_exp_f32 v122, v122
v_mfma_f32_16x16x32_bf16 v[108:111], a[164:167], v[44:47], v[108:111]
v_cndmask_b32 v92, v216, v17, s[10:11]
v_cndmask_b32 v93, v216, v17, s[12:13]
v_cndmask_b32 v94, v216, v17, s[18:19]
v_cndmask_b32 v95, v216, v17, s[22:23]
v_mfma_f32_16x16x32_bf16 v[108:111], a[168:171], v[48:51], v[108:111]
buffer_load_dwordx4 v16, s[32:35], s64 offen offset:1024 sc1 lds
v_cvt_pk_bf16_f32 v160, v104, v105
v_mfma_f32_16x16x32_bf16 v[108:111], a[172:175], v[52:55], v[108:111]
v_exp_f32 v123, v123
v_mfma_f32_16x16x32_bf16 v[92:95], a[172:175], v[36:39], v[92:95]
v_add_f32 v136, v136, v228
v_add_f32 v137, v137, v228
v_add_f32 v138, v138, v228
v_add_f32 v139, v139, v228
v_exp_f32 v136, v136
v_mfma_f32_16x16x32_bf16 v[92:95], a[168:171], v[32:35], v[92:95]
v_cvt_pk_bf16_f32 v161, v106, v107
v_exp_f32 v137, v137
v_cndmask_b32 v96, v216, v17, s[26:27]
v_cndmask_b32 v97, v216, v17, s[56:57]
v_cndmask_b32 v98, v216, v17, s[58:59]
v_cndmask_b32 v99, v216, v17, s[60:61]
v_mfma_f32_16x16x32_bf16 v[92:95], a[164:167], v[28:31], v[92:95]
v_exp_f32 v138, v138
v_mfma_f32_16x16x32_bf16 v[92:95], a[160:163], v[24:27], v[92:95]
v_exp_f32 v139, v139
v_mfma_f32_16x16x32_bf16 v[96:99], a[176:179], v[24:27], v[96:99]
v_cvt_pk_bf16_f32 v184, v120, v121
v_add_f32 v88, v88, v216
v_mfma_f32_16x16x32_bf16 v[96:99], a[180:183], v[28:31], v[96:99]
buffer_load_dwordx4 v16, s[32:35], s64 offen offset:2048 sc1 lds
v_add_f32 v89, v89, v216
v_add_f32 v90, v90, v216
v_add_f32 v91, v91, v216
v_exp_f32 v88, v88
v_mfma_f32_16x16x32_bf16 v[96:99], a[184:187], v[32:35], v[96:99]
v_exp_f32 v89, v89
v_mfma_f32_16x16x32_bf16 v[96:99], a[188:191], v[36:39], v[96:99]
v_cvt_pk_bf16_f32 v185, v122, v123
v_cvt_pk_bf16_f32 v192, v136, v137
v_mfma_f32_16x16x32_bf16 v[112:115], a[188:191], v[52:55], v[220:223]
v_exp_f32 v90, v90
v_mfma_f32_16x16x32_bf16 v[112:115], a[184:187], v[48:51], v[112:115]
v_exp_f32 v91, v91
v_mfma_f32_16x16x32_bf16 v[112:115], a[180:183], v[44:47], v[112:115]
v_exp_f32 v140, v140
v_mfma_f32_16x16x32_bf16 v[112:115], a[176:179], v[40:43], v[112:115]
v_exp_f32 v141, v141
v_mfma_f32_16x16x32_bf16 v[128:131], a[176:179], v[56:59], v[224:227]
buffer_load_dwordx4 v16, s[32:35], s64 offen offset:3072 sc1 lds
v_cvt_pk_bf16_f32 v193, v138, v139
v_mfma_f32_16x16x32_bf16 v[128:131], a[180:183], v[60:63], v[128:131]
v_exp_f32 v142, v142
v_mfma_f32_16x16x32_bf16 v[128:131], a[184:187], v[64:67], v[128:131]
v_exp_f32 v143, v143
v_mfma_f32_16x16x32_bf16 v[128:131], a[188:191], v[68:71], v[128:131]
v_cvt_pk_bf16_f32 v152, v88, v89
v_cvt_pk_bf16_f32 v153, v90, v91
v_mfma_f32_16x16x32_bf16 v[144:147], a[188:191], v[84:87], v[228:231]
v_exp_f32 v124, v124
v_mfma_f32_16x16x32_bf16 v[144:147], a[184:187], v[80:83], v[144:147]
v_exp_f32 v125, v125
v_mfma_f32_16x16x32_bf16 v[144:147], a[180:183], v[76:79], v[144:147]
s_waitcnt vmcnt(8)
s_barrier
v_mfma_f32_16x16x32_bf16 v[144:147], a[176:179], v[72:75], v[144:147]
v_exp_f32 v126, v126
v_mfma_f32_16x16x32_bf16 v[148:151], a[192:195], v[72:75], v[228:231]
v_cvt_pk_bf16_f32 v194, v140, v141
v_cvt_pk_bf16_f32 v195, v142, v143
v_mfma_f32_16x16x32_bf16 v[148:151], a[196:199], v[76:79], v[148:151]
v_exp_f32 v127, v127
v_mfma_f32_16x16x32_bf16 v[148:151], a[200:203], v[80:83], v[148:151]
s_xor_b32 s71, s71, 16384
v_exp_f32 v108, v108
v_mfma_f32_16x16x32_bf16 v[148:151], a[204:207], v[84:87], v[148:151]
s_add_u32 s70, s70, 32768
v_exp_f32 v109, v109
v_mfma_f32_16x16x32_bf16 v[132:135], a[204:207], v[68:71], v[224:227]
s_mov_b32 m0, s71
v_exp_f32 v110, v110
v_mfma_f32_16x16x32_bf16 v[132:135], a[200:203], v[64:67], v[132:135]
buffer_load_dwordx4 v16, s[32:35], s70 offen offset:0 sc1 lds
v_mfma_f32_16x16x32_bf16 v[132:135], a[196:199], v[60:63], v[132:135]
v_cvt_pk_bf16_f32 v186, v124, v125
v_exp_f32 v111, v111
v_mfma_f32_16x16x32_bf16 v[132:135], a[192:195], v[56:59], v[132:135]
v_exp_f32 v92, v92
v_mfma_f32_16x16x32_bf16 v[116:119], a[192:195], v[40:43], v[220:223]
ds_read_b128 a[144:147], v2 offset:16384
v_cndmask_b32 v100, v216, v17, s[62:63]
v_mfma_f32_16x16x32_bf16 v[116:119], a[196:199], v[44:47], v[116:119]
ds_read_b128 a[148:151], v2 offset:17408
v_cndmask_b32 v101, v216, v17, s[48:49]
v_cndmask_b32 v102, v216, v17, s[50:51]
v_cndmask_b32 v103, v216, v17, s[100:101]
v_cvt_pk_bf16_f32 v187, v126, v127
v_exp_f32 v93, v93
v_mfma_f32_16x16x32_bf16 v[116:119], a[200:203], v[48:51], v[116:119]
v_exp_f32 v94, v94
v_mfma_f32_16x16x32_bf16 v[116:119], a[204:207], v[52:55], v[116:119]
ds_read_b128 a[152:155], v2 offset:18432
v_cvt_pk_bf16_f32 v162, v108, v109
v_mfma_f32_16x16x32_bf16 v[100:103], a[204:207], v[36:39], v[100:103]
buffer_load_dwordx4 v16, s[32:35], s70 offen offset:1024 sc1 lds
v_exp_f32 v95, v95
v_mfma_f32_16x16x32_bf16 v[100:103], a[200:203], v[32:35], v[100:103]
ds_read_b128 a[156:159], v2 offset:19456
v_exp_f32 v96, v96
v_mfma_f32_16x16x32_bf16 v[100:103], a[196:199], v[28:31], v[100:103]
v_cvt_pk_bf16_f32 v163, v110, v111
v_exp_f32 v97, v97
v_mfma_f32_16x16x32_bf16 v[100:103], a[192:195], v[24:27], v[100:103]
s_waitcnt lgkmcnt(2)
ds_read_b128 a[160:163], v2 offset:20480
ds_read_b128 a[164:167], v2 offset:21504
ds_read_b128 a[168:171], v2 offset:22528
ds_read_b128 a[172:175], v2 offset:23552
v_mfma_f32_16x16x32_bf16 v[120:123], a[144:147], v[56:59], v[224:227]
v_exp_f32 v98, v98
v_mfma_f32_16x16x32_bf16 v[120:123], a[148:151], v[60:63], v[120:123]
s_waitcnt lgkmcnt(5)
v_cvt_pk_bf16_f32 v154, v92, v93
v_exp_f32 v99, v99
v_mfma_f32_16x16x32_bf16 v[120:123], a[152:155], v[64:67], v[120:123]
s_waitcnt lgkmcnt(4)
v_exp_f32 v112, v112
v_mfma_f32_16x16x32_bf16 v[120:123], a[156:159], v[68:71], v[120:123]
v_exp_f32 v113, v113
v_mfma_f32_16x16x32_bf16 v[136:139], a[156:159], v[84:87], v[228:231]
v_cvt_pk_bf16_f32 v155, v94, v95
v_cndmask_b32 v104, v220, v17, s[0:1]
v_mfma_f32_16x16x32_bf16 v[136:139], a[152:155], v[80:83], v[136:139]
ds_read_b128 a[176:179], v2 offset:24576
buffer_load_dwordx4 v16, s[32:35], s70 offen offset:2048 sc1 lds
v_cndmask_b32 v105, v220, v17, s[4:5]
v_cndmask_b32 v106, v220, v17, s[6:7]
v_cndmask_b32 v107, v220, v17, s[8:9]
v_exp_f32 v114, v114
v_mfma_f32_16x16x32_bf16 v[136:139], a[148:151], v[76:79], v[136:139]
v_cvt_pk_bf16_f32 v156, v96, v97
v_cvt_pk_bf16_f32 v157, v98, v99
v_mfma_f32_16x16x32_bf16 v[136:139], a[144:147], v[72:75], v[136:139]
v_exp_f32 v115, v115
v_mfma_f32_16x16x32_bf16 v[104:107], a[144:147], v[40:43], v[104:107]
v_exp_f32 v128, v128
v_mfma_f32_16x16x32_bf16 v[104:107], a[148:151], v[44:47], v[104:107]
v_exp_f32 v129, v129
v_mfma_f32_16x16x32_bf16 v[104:107], a[152:155], v[48:51], v[104:107]
v_exp_f32 v130, v130
v_mfma_f32_16x16x32_bf16 v[104:107], a[156:159], v[52:55], v[104:107]
s_waitcnt lgkmcnt(0)
v_exp_f32 v131, v131
v_mfma_f32_16x16x32_bf16 v[140:143], a[172:175], v[84:87], v[228:231]
v_cvt_pk_bf16_f32 v164, v112, v113
v_cvt_pk_bf16_f32 v165, v114, v115
v_mfma_f32_16x16x32_bf16 v[140:143], a[168:171], v[80:83], v[140:143]
v_exp_f32 v144, v144
v_mfma_f32_16x16x32_bf16 v[140:143], a[164:167], v[76:79], v[140:143]
v_exp_f32 v145, v145
v_mfma_f32_16x16x32_bf16 v[140:143], a[160:163], v[72:75], v[140:143]
v_exp_f32 v146, v146
v_mfma_f32_16x16x32_bf16 v[124:127], a[160:163], v[56:59], v[224:227]
ds_read_b128 a[180:183], v2 offset:25600
v_cndmask_b32 v108, v220, v17, s[10:11]
v_mfma_f32_16x16x32_bf16 v[124:127], a[164:167], v[60:63], v[124:127]
ds_read_b128 a[184:187], v2 offset:26624
buffer_load_dwordx4 v16, s[32:35], s70 offen offset:3072 sc1 lds
v_cndmask_b32 v109, v220, v17, s[12:13]
v_cndmask_b32 v110, v220, v17, s[18:19]
v_cndmask_b32 v111, v220, v17, s[22:23]
v_cvt_pk_bf16_f32 v188, v128, v129
v_mfma_f32_16x16x32_bf16 v[124:127], a[168:171], v[64:67], v[124:127]
s_add_u32 m0, s86, 131072
v_exp_f32 v147, v147
v_mfma_f32_16x16x32_bf16 v[124:127], a[172:175], v[68:71], v[124:127]
s_add_u32 s64, s85, 0
ds_read_b128 a[188:191], v2 offset:27648
v_exp_f32 v148, v148
v_mfma_f32_16x16x32_bf16 v[108:111], a[172:175], v[52:55], v[108:111]
buffer_load_dwordx4 v12, s[36:39], s64 offen lds
v_cvt_pk_bf16_f32 v189, v130, v131
v_exp_f32 v149, v149
v_mfma_f32_16x16x32_bf16 v[108:111], a[168:171], v[48:51], v[108:111]
s_add_u32 m0, s86, 132096
ds_read_b128 a[192:195], v2 offset:28672
v_cndmask_b32 v112, v220, v17, s[26:27]
v_cndmask_b32 v113, v220, v17, s[56:57]
v_cndmask_b32 v114, v220, v17, s[58:59]
v_cndmask_b32 v115, v220, v17, s[60:61]
v_mfma_f32_16x16x32_bf16 v[108:111], a[164:167], v[44:47], v[108:111]
s_add_u32 s64, s85, 8192
v_exp_f32 v150, v150
v_mfma_f32_16x16x32_bf16 v[108:111], a[160:163], v[40:43], v[108:111]
buffer_load_dwordx4 v13, s[36:39], s64 offen lds
v_cvt_pk_bf16_f32 v196, v144, v145
v_exp_f32 v151, v151
v_mfma_f32_16x16x32_bf16 v[112:115], a[176:179], v[40:43], v[112:115]
s_waitcnt lgkmcnt(2)
s_add_u32 m0, s86, 133120
v_exp_f32 v132, v132
v_mfma_f32_16x16x32_bf16 v[112:115], a[180:183], v[44:47], v[112:115]
s_add_u32 s64, s85, 16384
v_exp_f32 v133, v133
v_mfma_f32_16x16x32_bf16 v[112:115], a[184:187], v[48:51], v[112:115]
s_waitcnt lgkmcnt(1)
buffer_load_dwordx4 v12, s[36:39], s64 offen lds
v_cvt_pk_bf16_f32 v197, v146, v147
v_mfma_f32_16x16x32_bf16 v[112:115], a[188:191], v[52:55], v[112:115]
s_add_u32 m0, s86, 134144
v_exp_f32 v134, v134
v_mfma_f32_16x16x32_bf16 v[128:131], a[188:191], v[68:71], v[224:227]
s_add_u32 s64, s85, 24576
ds_read_b128 a[196:199], v2 offset:29696
ds_read_b128 a[200:203], v2 offset:30720
ds_read_b128 a[204:207], v2 offset:31744
v_cvt_pk_bf16_f32 v198, v148, v149
v_mfma_f32_16x16x32_bf16 v[128:131], a[184:187], v[64:67], v[128:131]
buffer_load_dwordx4 v13, s[36:39], s64 offen lds
v_exp_f32 v135, v135
v_mfma_f32_16x16x32_bf16 v[128:131], a[180:183], v[60:63], v[128:131]
s_add_u32 m0, s71, 4096
v_exp_f32 v116, v116
v_mfma_f32_16x16x32_bf16 v[128:131], a[176:179], v[56:59], v[128:131]
s_add_u32 s64, s70, 4096
v_cvt_pk_bf16_f32 v199, v150, v151
v_exp_f32 v117, v117
v_mfma_f32_16x16x32_bf16 v[144:147], a[176:179], v[72:75], v[228:231]
buffer_load_dwordx4 v16, s[32:35], s64 offen offset:0 sc1 lds
v_mfma_f32_16x16x32_bf16 v[144:147], a[180:183], v[76:79], v[144:147]
v_exp_f32 v118, v118
v_mfma_f32_16x16x32_bf16 v[144:147], a[184:187], v[80:83], v[144:147]
v_cvt_pk_bf16_f32 v190, v132, v133
v_exp_f32 v119, v119
v_mfma_f32_16x16x32_bf16 v[144:147], a[188:191], v[84:87], v[144:147]
s_waitcnt lgkmcnt(0)
v_exp_f32 v100, v100
v_mfma_f32_16x16x32_bf16 v[148:151], a[204:207], v[84:87], v[228:231]
v_exp_f32 v101, v101
v_mfma_f32_16x16x32_bf16 v[148:151], a[200:203], v[80:83], v[148:151]
v_cvt_pk_bf16_f32 v191, v134, v135
v_cvt_pk_bf16_f32 v166, v116, v117
v_cvt_pk_bf16_f32 v167, v118, v119
v_mfma_f32_16x16x32_bf16 v[148:151], a[196:199], v[76:79], v[148:151]
v_exp_f32 v102, v102
v_mfma_f32_16x16x32_bf16 v[148:151], a[192:195], v[72:75], v[148:151]
v_exp_f32 v103, v103
v_mfma_f32_16x16x32_bf16 v[132:135], a[192:195], v[56:59], v[224:227]
s_lshl_b32 s66, s30, 30
ds_read_b128 a[144:147], v3 offset:16384
v_cndmask_b32 v116, v220, v17, s[62:63]
v_mfma_f32_16x16x32_bf16 v[132:135], a[196:199], v[60:63], v[132:135]
ds_read_b128 a[148:151], v3 offset:24576
v_cndmask_b32 v117, v220, v17, s[48:49]
v_cndmask_b32 v118, v220, v17, s[50:51]
v_cndmask_b32 v119, v220, v17, s[100:101]
v_exp_f32 v120, v120
v_mfma_f32_16x16x32_bf16 v[132:135], a[200:203], v[64:67], v[132:135]
v_exp_f32 v121, v121
v_mfma_f32_16x16x32_bf16 v[132:135], a[204:207], v[68:71], v[132:135]
v_exp_f32 v122, v122
v_mfma_f32_16x16x32_bf16 v[116:119], a[204:207], v[52:55], v[116:119]
ds_read_b128 a[152:155], v3 offset:17408
v_accvgpr_write_b32 a142, 0
v_mfma_f32_16x16x32_bf16 v[116:119], a[200:203], v[48:51], v[116:119]
ds_read_b128 a[156:159], v3 offset:25600
buffer_load_dwordx4 v16, s[32:35], s64 offen offset:1024 sc1 lds
v_accvgpr_write_b32 a143, 0
v_cvt_pk_bf16_f32 v158, v100, v101
v_cvt_pk_bf16_f32 v159, v102, v103
v_mfma_f32_16x16x32_bf16 v[116:119], a[196:199], v[44:47], v[116:119]
v_exp_f32 v123, v123
v_mfma_f32_16x16x32_bf16 v[116:119], a[192:195], v[40:43], v[116:119]
v_exp_f32 v136, v136
v_smfmac_f32_16x16x64_bf16 a[128:131], a[240:243], v[152:159], v5
ds_read_b128 a[160:163], v3 offset:18432
v_smfmac_f32_16x16x64_bf16 a[132:135], a[240:243], v[160:167], v5
v_exp_f32 v137, v137
v_smfmac_f32_16x16x64_bf16 a[136:139], a[240:243], v[184:191], v5
v_exp_f32 v138, v138
v_smfmac_f32_16x16x64_bf16 a[140:143], a[240:243], v[192:199], v5
s_waitcnt lgkmcnt(1)
v_cvt_pk_bf16_f32 v200, v120, v121
v_mfma_f32_16x16x32_bf16 a[0:3], a[144:147], v[152:155], 0
v_exp_f32 v139, v139
v_mfma_f32_16x16x32_bf16 a[0:3], a[148:151], v[156:159], a[0:3]
v_exp_f32 v104, v104
v_mfma_f32_16x16x32_bf16 a[32:35], a[148:151], v[164:167], 0
v_cvt_pk_bf16_f32 v201, v122, v123
v_cvt_pk_bf16_f32 v208, v136, v137
v_mfma_f32_16x16x32_bf16 a[32:35], a[144:147], v[160:163], a[32:35]
v_exp_f32 v105, v105
v_mfma_f32_16x16x32_bf16 a[64:67], a[144:147], v[184:187], 0
v_exp_f32 v106, v106
v_mfma_f32_16x16x32_bf16 a[64:67], a[148:151], v[188:191], a[64:67]
v_exp_f32 v107, v107
v_mfma_f32_16x16x32_bf16 a[96:99], a[148:151], v[196:199], 0
buffer_load_dwordx4 v16, s[32:35], s64 offen offset:2048 sc1 lds
v_mfma_f32_16x16x32_bf16 a[96:99], a[144:147], v[192:195], a[96:99]
v_exp_f32 v140, v140
v_mfma_f32_16x16x32_bf16 a[100:103], a[152:155], v[192:195], 0
ds_read_b128 a[164:167], v3 offset:26624
v_cvt_pk_bf16_f32 v209, v138, v139
v_mfma_f32_16x16x32_bf16 a[100:103], a[156:159], v[196:199], a[100:103]
v_exp_f32 v141, v141
v_mfma_f32_16x16x32_bf16 a[68:71], a[156:159], v[188:191], 0
v_exp_f32 v142, v142
v_mfma_f32_16x16x32_bf16 a[68:71], a[152:155], v[184:187], a[68:71]
v_cvt_pk_bf16_f32 v176, v104, v105
v_cvt_pk_bf16_f32 v177, v106, v107
v_mfma_f32_16x16x32_bf16 a[36:39], a[152:155], v[160:163], 0
v_exp_f32 v143, v143
v_mfma_f32_16x16x32_bf16 a[36:39], a[156:159], v[164:167], a[36:39]
v_exp_f32 v124, v124
v_mfma_f32_16x16x32_bf16 a[4:7], a[156:159], v[156:159], 0
v_exp_f32 v125, v125
v_mfma_f32_16x16x32_bf16 a[4:7], a[152:155], v[152:155], a[4:7]
s_waitcnt lgkmcnt(0)
ds_read_b128 a[168:171], v3 offset:19456
v_cvt_pk_bf16_f32 v210, v140, v141
v_mfma_f32_16x16x32_bf16 a[8:11], a[160:163], v[152:155], 0
v_exp_f32 v126, v126
v_mfma_f32_16x16x32_bf16 a[8:11], a[164:167], v[156:159], a[8:11]
ds_read_b128 a[172:175], v3 offset:27648
v_cvt_pk_bf16_f32 v211, v142, v143
v_mfma_f32_16x16x32_bf16 a[40:43], a[164:167], v[164:167], 0
v_exp_f32 v127, v127
v_mfma_f32_16x16x32_bf16 a[40:43], a[160:163], v[160:163], a[40:43]
v_exp_f32 v108, v108
v_mfma_f32_16x16x32_bf16 a[72:75], a[160:163], v[184:187], 0
buffer_load_dwordx4 v16, s[32:35], s64 offen offset:3072 sc1 lds
v_mfma_f32_16x16x32_bf16 a[72:75], a[164:167], v[188:191], a[72:75]
v_exp_f32 v109, v109
v_mfma_f32_16x16x32_bf16 a[104:107], a[164:167], v[196:199], 0
v_exp_f32 v110, v110
v_mfma_f32_16x16x32_bf16 a[104:107], a[160:163], v[192:195], a[104:107]
s_waitcnt lgkmcnt(0)
ds_read_b128 a[176:179], v3 offset:20480
v_cvt_pk_bf16_f32 v202, v124, v125
v_mfma_f32_16x16x32_bf16 a[108:111], a[168:171], v[192:195], 0
v_exp_f32 v111, v111
v_mfma_f32_16x16x32_bf16 a[108:111], a[172:175], v[196:199], a[108:111]
ds_read_b128 a[180:183], v3 offset:28672
v_cvt_pk_bf16_f32 v203, v126, v127
v_mfma_f32_16x16x32_bf16 a[76:79], a[172:175], v[188:191], 0
s_add_u32 m0, s86, 135168
v_exp_f32 v112, v112
v_mfma_f32_16x16x32_bf16 a[76:79], a[168:171], v[184:187], a[76:79]
s_add_u32 s64, s85, 32768
v_exp_f32 v113, v113
v_mfma_f32_16x16x32_bf16 a[44:47], a[168:171], v[160:163], 0
buffer_load_dwordx4 v12, s[36:39], s64 offen lds
v_mfma_f32_16x16x32_bf16 a[44:47], a[172:175], v[164:167], a[44:47]
s_add_u32 m0, s86, 136192
v_cvt_pk_bf16_f32 v178, v108, v109
v_exp_f32 v114, v114
v_mfma_f32_16x16x32_bf16 a[12:15], a[172:175], v[156:159], 0
s_add_u32 s64, s85, 40960
v_exp_f32 v115, v115
v_mfma_f32_16x16x32_bf16 a[12:15], a[168:171], v[152:155], a[12:15]
s_waitcnt lgkmcnt(0)
buffer_load_dwordx4 v13, s[36:39], s64 offen lds
v_mfma_f32_16x16x32_bf16 a[16:19], a[176:179], v[152:155], 0
s_add_u32 m0, s86, 137216
ds_read_b128 a[184:187], v3 offset:21504
ds_read_b128 a[188:191], v3 offset:29696
ds_read_b128 a[192:195], v3 offset:22528
ds_read_b128 a[196:199], v3 offset:30720
ds_read_b128 a[200:203], v3 offset:23552
ds_read_b128 a[204:207], v3 offset:31744
v_xor_b32 v2, 0x8000, v2
v_exp_f32 v128, v128
v_mfma_f32_16x16x32_bf16 a[16:19], a[180:183], v[156:159], a[16:19]
s_waitcnt vmcnt(14)
s_barrier
s_add_u32 s64, s85, 49152
v_cvt_pk_bf16_f32 v179, v110, v111
v_mfma_f32_16x16x32_bf16 a[48:51], a[180:183], v[164:167], 0
buffer_load_dwordx4 v12, s[36:39], s64 offen lds
v_exp_f32 v129, v129
v_mfma_f32_16x16x32_bf16 a[48:51], a[176:179], v[160:163], a[48:51]
s_add_u32 m0, s86, 138240
v_exp_f32 v130, v130
v_mfma_f32_16x16x32_bf16 a[80:83], a[176:179], v[184:187], 0
s_add_u32 s64, s85, 57344
v_cvt_pk_bf16_f32 v180, v112, v113
v_cvt_pk_bf16_f32 v181, v114, v115
v_mfma_f32_16x16x32_bf16 a[80:83], a[180:183], v[188:191], a[80:83]
buffer_load_dwordx4 v13, s[36:39], s64 offen lds
v_exp_f32 v131, v131
v_mfma_f32_16x16x32_bf16 a[112:115], a[180:183], v[196:199], 0
v_exp_f32 v144, v144
v_mfma_f32_16x16x32_bf16 a[112:115], a[176:179], v[192:195], a[112:115]
s_waitcnt lgkmcnt(0)
s_xor_b32 s71, s71, 49152
s_add_u32 s70, s70, 32768
s_mov_b32 m0, s71
v_exp_f32 v145, v145
v_mfma_f32_16x16x32_bf16 a[116:119], a[184:187], v[192:195], 0
buffer_load_dwordx4 v16, s[32:35], s70 offen offset:0 sc1 lds
v_mfma_f32_16x16x32_bf16 a[116:119], a[188:191], v[196:199], a[116:119]
v_exp_f32 v146, v146
v_mfma_f32_16x16x32_bf16 a[84:87], a[188:191], v[188:191], 0
v_cvt_pk_bf16_f32 v204, v128, v129
v_cvt_pk_bf16_f32 v205, v130, v131
v_mfma_f32_16x16x32_bf16 a[84:87], a[184:187], v[184:187], a[84:87]
v_exp_f32 v147, v147
v_mfma_f32_16x16x32_bf16 a[52:55], a[184:187], v[160:163], 0
v_exp_f32 v148, v148
v_mfma_f32_16x16x32_bf16 a[52:55], a[188:191], v[164:167], a[52:55]
v_exp_f32 v149, v149
v_mfma_f32_16x16x32_bf16 a[20:23], a[188:191], v[156:159], 0
ds_read_b128 a[144:147], v2 offset:0
v_lshl_add_u32 v19, v0, 24, s66
v_mfma_f32_16x16x32_bf16 a[20:23], a[184:187], v[152:155], a[20:23]
s_lshr_b32 s67, s31, 4
v_exp_f32 v150, v150
v_mfma_f32_16x16x32_bf16 a[24:27], a[192:195], v[152:155], 0
s_lshl1_add_u32 s67, s3, s67
v_cvt_pk_bf16_f32 v212, v144, v145
v_cvt_pk_bf16_f32 v213, v146, v147
v_mfma_f32_16x16x32_bf16 a[24:27], a[196:199], v[156:159], a[24:27]
s_lshl_b32 s79, s67, 8
v_exp_f32 v151, v151
v_mfma_f32_16x16x32_bf16 a[56:59], a[196:199], v[164:167], 0
s_add_u32 s79, s79, 8192
v_exp_f32 v132, v132
v_mfma_f32_16x16x32_bf16 a[56:59], a[192:195], v[160:163], a[56:59]
s_add_u32 s69, s31, 12
v_exp_f32 v133, v133
v_mfma_f32_16x16x32_bf16 a[88:91], a[192:195], v[184:187], 0
s_lshr_b32 s69, s69, 5
buffer_load_dwordx4 v16, s[32:35], s70 offen offset:1024 sc1 lds
v_mfma_f32_16x16x32_bf16 a[88:91], a[196:199], v[188:191], a[88:91]
s_lshl1_add_u32 s69, s3, s69
v_exp_f32 v134, v134
v_mfma_f32_16x16x32_bf16 a[120:123], a[196:199], v[196:199], 0
s_lshl_b32 s69, s69, 8
v_cvt_pk_bf16_f32 v214, v148, v149
v_cvt_pk_bf16_f32 v215, v150, v151
v_mfma_f32_16x16x32_bf16 a[120:123], a[192:195], v[192:195], a[120:123]
s_add_u32 s69, s69, 8192
v_exp_f32 v135, v135
v_mfma_f32_16x16x32_bf16 a[124:127], a[200:203], v[192:195], 0
s_lshl_b32 s67, s73, 16
v_exp_f32 v116, v116
v_mfma_f32_16x16x32_bf16 a[124:127], a[204:207], v[196:199], a[124:127]
s_xor_b32 s68, s80, 256
v_exp_f32 v117, v117
v_mfma_f32_16x16x32_bf16 a[92:95], a[204:207], v[188:191], 0
s_add_u32 s68, s68, s67
s_add_u32 s17, s78, L_T-L_pc+0
ds_read_b128 a[148:151], v2 offset:1024
v_cvt_pk_bf16_f32 v206, v132, v133
v_mfma_f32_16x16x32_bf16 a[92:95], a[200:203], v[184:187], a[92:95]
s_add_u32 s67, s67, s69
buffer_load_dword a252, v16, s[88:91], s17 offen
v_mfma_f32_16x16x32_bf16 a[60:63], a[200:203], v[160:163], 0
ds_read_b128 a[152:155], v2 offset:2048
v_exp_f32 v118, v118
v_mfma_f32_16x16x32_bf16 a[60:63], a[204:207], v[164:167], a[60:63]
s_add_u32 s17, s78, L_T-L_pc+4096
ds_read_b128 a[156:159], v2 offset:3072
v_cvt_pk_bf16_f32 v207, v134, v135
v_mfma_f32_16x16x32_bf16 a[28:31], a[204:207], v[156:159], 0
s_mov_b64 exec, 1
buffer_atomic_add a251, v19, s[52:55], s67 offen offset:0 sc1
buffer_atomic_add a251, v19, s[52:55], s68 offen offset:0 sc1
s_mov_b64 exec, -1
v_exp_f32 v119, v119
v_mfma_f32_16x16x32_bf16 a[28:31], a[200:203], v[152:155], a[28:31]
ds_read_b128 a[160:163], v2 offset:4096
buffer_load_dword a252, v16, s[88:91], s17 offen
ds_read_b128 a[164:167], v2 offset:5120
ds_read_b128 a[168:171], v2 offset:6144
ds_read_b128 a[172:175], v2 offset:7168
v_mul_u32_u24 v19, 52, v0
v_cvt_pk_bf16_f32 v182, v116, v117
v_cvt_pk_bf16_f32 v183, v118, v119
v_xor_b32 v3, 0x8000, v3
v_accvgpr_read_b32 v20, a128
v_accvgpr_read_b32 v248, a129
v_add_f32 v20, v20, v248
v_max_f32 v1, v1, v20
v_rcp_f32 v20, v20
v_accvgpr_read_b32 v232, a0
v_accvgpr_read_b32 v233, a1
v_accvgpr_read_b32 v234, a2
v_accvgpr_read_b32 v235, a3
v_accvgpr_read_b32 v236, a4
v_accvgpr_read_b32 v237, a5
v_accvgpr_read_b32 v238, a6
v_accvgpr_read_b32 v239, a7
v_mul_f32 v20, v20, v4
v_mul_f32 v232, v232, v20
v_mul_f32 v233, v233, v20
v_mul_f32 v234, v234, v20
v_mul_f32 v235, v235, v20
v_mul_f32 v236, v236, v20
v_mul_f32 v237, v237, v20
v_mul_f32 v238, v238, v20
v_mul_f32 v239, v239, v20
v_cvt_pk_bf16_f32 v232, v232, v233
v_cvt_pk_bf16_f32 v233, v234, v235
v_cvt_pk_bf16_f32 v234, v236, v237
v_cvt_pk_bf16_f32 v235, v238, v239
s_add_u32 s77, s74, 0
buffer_store_dwordx4 v[232:235], v16, s[44:47], s77 offen sc1
v_accvgpr_read_b32 v240, a8
v_accvgpr_read_b32 v241, a9
v_accvgpr_read_b32 v242, a10
v_accvgpr_read_b32 v243, a11
v_accvgpr_read_b32 v244, a12
v_accvgpr_read_b32 v245, a13
v_accvgpr_read_b32 v246, a14
v_accvgpr_read_b32 v247, a15
v_mul_f32 v240, v240, v20
v_mul_f32 v241, v241, v20
v_mul_f32 v242, v242, v20
v_mul_f32 v243, v243, v20
v_mul_f32 v244, v244, v20
v_mul_f32 v245, v245, v20
v_mul_f32 v246, v246, v20
v_mul_f32 v247, v247, v20
v_cvt_pk_bf16_f32 v240, v240, v241
v_cvt_pk_bf16_f32 v241, v242, v243
v_cvt_pk_bf16_f32 v242, v244, v245
v_cvt_pk_bf16_f32 v243, v246, v247
s_add_u32 s77, s74, 8192
buffer_store_dwordx4 v[240:243], v16, s[44:47], s77 offen sc1
v_accvgpr_read_b32 v232, a16
v_accvgpr_read_b32 v233, a17
v_accvgpr_read_b32 v234, a18
v_accvgpr_read_b32 v235, a19
v_accvgpr_read_b32 v236, a20
v_accvgpr_read_b32 v237, a21
v_accvgpr_read_b32 v238, a22
v_accvgpr_read_b32 v239, a23
v_mul_f32 v232, v232, v20
v_mul_f32 v233, v233, v20
v_mul_f32 v234, v234, v20
v_mul_f32 v235, v235, v20
v_mul_f32 v236, v236, v20
v_mul_f32 v237, v237, v20
v_mul_f32 v238, v238, v20
v_mul_f32 v239, v239, v20
v_cvt_pk_bf16_f32 v232, v232, v233
v_cvt_pk_bf16_f32 v233, v234, v235
v_cvt_pk_bf16_f32 v234, v236, v237
v_cvt_pk_bf16_f32 v235, v238, v239
s_add_u32 s77, s74, 16384
buffer_store_dwordx4 v[232:235], v16, s[44:47], s77 offen sc1
s_branch L_T
L_T1:
buffer_load_dword v19, off, s[52:55], s80 sc1
s_add_u32 s17, s78, L_TAIL-L_pc
buffer_load_dword a252, v16, s[88:91], s17 offen
s_add_u32 s17, s78, L_TAIL-L_pc+4096
buffer_load_dword a252, v16, s[88:91], s17 offen
s_add_u32 s17, s78, L_p5f0-L_pc
buffer_load_dword a252, v16, s[88:91], s17 offen
s_add_u32 s17, s78, L_p5f0-L_pc+4096
buffer_load_dword a252, v16, s[88:91], s17 offen
s_waitcnt lgkmcnt(7)
v_mfma_f32_16x16x32_bf16 v[136:139], a[144:147], v[72:75], v[228:231]
s_waitcnt lgkmcnt(6)
ds_read_b128 a[176:179], v2 offset:8192
v_cndmask_b32 v120, v224, v17, s[0:1]
v_mfma_f32_16x16x32_bf16 v[136:139], a[148:151], v[76:79], v[136:139]
s_waitcnt lgkmcnt(6)
ds_read_b128 a[180:183], v2 offset:9216
v_cndmask_b32 v121, v224, v17, s[4:5]
v_cndmask_b32 v122, v224, v17, s[6:7]
v_cndmask_b32 v123, v224, v17, s[8:9]
v_mfma_f32_16x16x32_bf16 v[136:139], a[152:155], v[80:83], v[136:139]
s_waitcnt lgkmcnt(6)
buffer_load_dwordx4 v16, s[32:35], s70 offen offset:2048 sc1 lds
v_mfma_f32_16x16x32_bf16 v[136:139], a[156:159], v[84:87], v[136:139]
ds_read_b128 a[184:187], v2 offset:10240
v_cndmask_b32 v124, v224, v17, s[10:11]
v_mfma_f32_16x16x32_bf16 v[120:123], a[156:159], v[68:71], v[120:123]
ds_read_b128 a[188:191], v2 offset:11264
v_cndmask_b32 v125, v224, v17, s[12:13]
v_mfma_f32_16x16x32_bf16 v[120:123], a[152:155], v[64:67], v[120:123]
ds_read_b128 a[192:195], v2 offset:12288
v_cndmask_b32 v126, v224, v17, s[18:19]
v_mfma_f32_16x16x32_bf16 v[120:123], a[148:151], v[60:63], v[120:123]
ds_read_b128 a[196:199], v2 offset:13312
v_cndmask_b32 v127, v224, v17, s[22:23]
v_mfma_f32_16x16x32_bf16 v[120:123], a[144:147], v[56:59], v[120:123]
s_waitcnt lgkmcnt(4)
ds_read_b128 a[200:203], v2 offset:14336
v_cndmask_b32 v128, v224, v17, s[26:27]
v_mfma_f32_16x16x32_bf16 v[140:143], a[160:163], v[72:75], v[228:231]
ds_read_b128 a[204:207], v2 offset:15360
v_cndmask_b32 v129, v224, v17, s[56:57]
v_mfma_f32_16x16x32_bf16 v[140:143], a[164:167], v[76:79], v[140:143]
ds_read_b128 a[144:147], v3 offset:0
v_cndmask_b32 v130, v224, v17, s[58:59]
v_mfma_f32_16x16x32_bf16 v[140:143], a[168:171], v[80:83], v[140:143]
v_exp_f32 v136, v136
v_mfma_f32_16x16x32_bf16 v[140:143], a[172:175], v[84:87], v[140:143]
v_exp_f32 v137, v137
v_mfma_f32_16x16x32_bf16 v[124:127], a[172:175], v[68:71], v[124:127]
ds_read_b128 a[148:151], v3 offset:8192
v_cndmask_b32 v131, v224, v17, s[60:61]
v_mfma_f32_16x16x32_bf16 v[124:127], a[168:171], v[64:67], v[124:127]
v_exp_f32 v138, v138
v_mfma_f32_16x16x32_bf16 v[124:127], a[164:167], v[60:63], v[124:127]
s_mul_i32 s69, s83, 8
buffer_load_dwordx4 v16, s[32:35], s70 offen offset:3072 sc1 lds
v_mfma_f32_16x16x32_bf16 v[124:127], a[160:163], v[56:59], v[124:127]
s_sub_u32 s69, 36, s69
v_exp_f32 v139, v139
v_mfma_f32_16x16x32_bf16 v[128:131], a[176:179], v[56:59], v[128:131]
v_exp_f32 v120, v120
v_mfma_f32_16x16x32_bf16 v[128:131], a[180:183], v[60:63], v[128:131]
s_waitcnt lgkmcnt(1)
v_exp_f32 v121, v121
v_mfma_f32_16x16x32_bf16 v[128:131], a[184:187], v[64:67], v[128:131]
v_exp_f32 v122, v122
v_mfma_f32_16x16x32_bf16 v[128:131], a[188:191], v[68:71], v[128:131]
s_add_u32 m0, s71, 4096
ds_read_b128 a[152:155], v3 offset:1024
v_cndmask_b32 v132, v224, v17, s[62:63]
v_mfma_f32_16x16x32_bf16 v[144:147], a[188:191], v[84:87], v[228:231]
s_add_u32 s64, s70, 4096
v_cvt_pk_bf16_f32 v192, v136, v137
v_cndmask_b32 v133, v224, v17, s[48:49]
v_mfma_f32_16x16x32_bf16 v[144:147], a[184:187], v[80:83], v[144:147]
buffer_load_dwordx4 v16, s[32:35], s64 offen offset:0 sc1 lds
v_mfma_f32_16x16x32_bf16 v[144:147], a[180:183], v[76:79], v[144:147]
ds_read_b128 a[156:159], v3 offset:9216
v_cndmask_b32 v134, v224, v17, s[50:51]
v_mfma_f32_16x16x32_bf16 v[144:147], a[176:179], v[72:75], v[144:147]
ds_read_b128 a[160:163], v3 offset:2048
v_cndmask_b32 v135, v224, v17, s[100:101]
v_mfma_f32_16x16x32_bf16 v[148:151], a[192:195], v[72:75], v[228:231]
v_exp_f32 v123, v123
v_mfma_f32_16x16x32_bf16 v[148:151], a[196:199], v[76:79], v[148:151]
v_cvt_pk_bf16_f32 v193, v138, v139
v_cvt_pk_bf16_f32 v184, v120, v121
v_mfma_f32_16x16x32_bf16 v[148:151], a[200:203], v[80:83], v[148:151]
v_exp_f32 v140, v140
v_mfma_f32_16x16x32_bf16 v[148:151], a[204:207], v[84:87], v[148:151]
v_exp_f32 v141, v141
v_mfma_f32_16x16x32_bf16 v[132:135], a[204:207], v[68:71], v[132:135]
v_exp_f32 v142, v142
v_mfma_f32_16x16x32_bf16 v[132:135], a[200:203], v[64:67], v[132:135]
v_exp_f32 v143, v143
v_mfma_f32_16x16x32_bf16 v[132:135], a[196:199], v[60:63], v[132:135]
buffer_load_dwordx4 v16, s[32:35], s64 offen offset:1024 sc1 lds
v_mfma_f32_16x16x32_bf16 v[132:135], a[192:195], v[56:59], v[132:135]
v_exp_f32 v124, v124
v_smfmac_f32_16x16x64_bf16 a[132:135], a[240:243], v[176:183], v5
ds_read_b128 a[164:167], v3 offset:10240
v_smfmac_f32_16x16x64_bf16 a[136:139], a[240:243], v[200:207], v5
ds_read_b128 a[168:171], v3 offset:3072
v_accvgpr_read_b32 v240, a24
v_smfmac_f32_16x16x64_bf16 a[140:143], a[240:243], v[208:215], v5
v_cvt_pk_bf16_f32 v185, v122, v123
v_mfma_f32_16x16x32_bf16 a[32:35], a[144:147], v[176:179], a[32:35]
s_waitcnt lgkmcnt(2)
v_exp_f32 v125, v125
v_mfma_f32_16x16x32_bf16 a[32:35], a[148:151], v[180:183], a[32:35]
ds_read_b128 a[172:175], v3 offset:11264
v_accvgpr_read_b32 v241, a25
v_mfma_f32_16x16x32_bf16 a[64:67], a[148:151], v[204:207], a[64:67]
ds_read_b128 a[176:179], v3 offset:4096
v_accvgpr_read_b32 v242, a26
v_mfma_f32_16x16x32_bf16 a[64:67], a[144:147], v[200:203], a[64:67]
v_cvt_pk_bf16_f32 v194, v140, v141
v_accvgpr_read_b32 v243, a27
v_mfma_f32_16x16x32_bf16 a[96:99], a[144:147], v[208:211], a[96:99]
ds_read_b128 a[180:183], v3 offset:12288
v_accvgpr_read_b32 v244, a28
v_mfma_f32_16x16x32_bf16 a[96:99], a[148:151], v[212:215], a[96:99]
ds_read_b128 a[184:187], v3 offset:5120
v_accvgpr_read_b32 v245, a29
v_mfma_f32_16x16x32_bf16 a[100:103], a[156:159], v[212:215], a[100:103]
ds_read_b128 a[188:191], v3 offset:13312
v_accvgpr_read_b32 v246, a30
v_mfma_f32_16x16x32_bf16 a[100:103], a[152:155], v[208:211], a[100:103]
ds_read_b128 a[192:195], v3 offset:6144
v_accvgpr_read_b32 v247, a31
v_mul_f32 v240, v240, v20
v_mul_f32 v241, v241, v20
v_mul_f32 v242, v242, v20
v_mul_f32 v243, v243, v20
v_mul_f32 v244, v244, v20
v_mul_f32 v245, v245, v20
v_mul_f32 v246, v246, v20
v_mul_f32 v247, v247, v20
v_cvt_pk_bf16_f32 v240, v240, v241
v_cvt_pk_bf16_f32 v241, v242, v243
v_cvt_pk_bf16_f32 v242, v244, v245
v_cvt_pk_bf16_f32 v243, v246, v247
s_add_u32 s77, s74, 24576
buffer_store_dwordx4 v[240:243], v16, s[44:47], s77 offen sc1
v_exp_f32 v126, v126
v_mfma_f32_16x16x32_bf16 a[68:71], a[152:155], v[200:203], a[68:71]
buffer_load_dwordx4 v16, s[32:35], s64 offen offset:2048 sc1 lds
v_cvt_pk_bf16_f32 v195, v142, v143
v_mfma_f32_16x16x32_bf16 a[68:71], a[156:159], v[204:207], a[68:71]
v_exp_f32 v127, v127
v_mfma_f32_16x16x32_bf16 a[36:39], a[156:159], v[180:183], a[36:39]
v_exp_f32 v128, v128
v_mfma_f32_16x16x32_bf16 a[36:39], a[152:155], v[176:179], a[36:39]
v_exp_f32 v129, v129
v_mfma_f32_16x16x32_bf16 a[40:43], a[160:163], v[176:179], a[40:43]
s_waitcnt lgkmcnt(1)
v_cvt_pk_bf16_f32 v186, v124, v125
v_cvt_pk_bf16_f32 v187, v126, v127
v_mfma_f32_16x16x32_bf16 a[40:43], a[164:167], v[180:183], a[40:43]
v_exp_f32 v130, v130
v_mfma_f32_16x16x32_bf16 a[72:75], a[164:167], v[204:207], a[72:75]
buffer_load_dwordx4 v16, s[32:35], s64 offen offset:3072 sc1 lds
v_mfma_f32_16x16x32_bf16 a[72:75], a[160:163], v[200:203], a[72:75]
v_exp_f32 v131, v131
v_mfma_f32_16x16x32_bf16 a[104:107], a[160:163], v[208:211], a[104:107]
v_exp_f32 v144, v144
v_mfma_f32_16x16x32_bf16 a[104:107], a[164:167], v[212:215], a[104:107]
v_exp_f32 v145, v145
v_mfma_f32_16x16x32_bf16 a[108:111], a[172:175], v[212:215], a[108:111]
v_exp_f32 v146, v146
v_mfma_f32_16x16x32_bf16 a[108:111], a[168:171], v[208:211], a[108:111]
ds_read_b128 a[196:199], v3 offset:14336
v_cvt_pk_bf16_f32 v188, v128, v129
v_mfma_f32_16x16x32_bf16 a[76:79], a[168:171], v[200:203], a[76:79]
ds_read_b128 a[200:203], v3 offset:7168
v_cvt_pk_bf16_f32 v189, v130, v131
v_mfma_f32_16x16x32_bf16 a[76:79], a[172:175], v[204:207], a[76:79]
ds_read_b128 a[204:207], v3 offset:15360
v_cvt_pk_bf16_f32 v196, v144, v145
v_mfma_f32_16x16x32_bf16 a[44:47], a[172:175], v[180:183], a[44:47]
v_exp_f32 v147, v147
v_mfma_f32_16x16x32_bf16 a[44:47], a[168:171], v[176:179], a[44:47]
v_exp_f32 v148, v148
v_mfma_f32_16x16x32_bf16 a[48:51], a[176:179], v[176:179], a[48:51]
v_exp_f32 v149, v149
v_mfma_f32_16x16x32_bf16 a[48:51], a[180:183], v[180:183], a[48:51]
v_exp_f32 v150, v150
v_mfma_f32_16x16x32_bf16 a[80:83], a[180:183], v[204:207], a[80:83]
s_waitcnt vmcnt(14)
s_barrier
v_mfma_f32_16x16x32_bf16 a[80:83], a[176:179], v[200:203], a[80:83]
v_exp_f32 v151, v151
v_mfma_f32_16x16x32_bf16 a[112:115], a[176:179], v[208:211], a[112:115]
v_exp_f32 v132, v132
v_mfma_f32_16x16x32_bf16 a[112:115], a[180:183], v[212:215], a[112:115]
v_exp_f32 v133, v133
v_mfma_f32_16x16x32_bf16 a[116:119], a[188:191], v[212:215], a[116:119]
ds_read_b128 a[144:147], v2 offset:16384
v_cvt_pk_bf16_f32 v197, v146, v147
v_mfma_f32_16x16x32_bf16 a[116:119], a[184:187], v[208:211], a[116:119]
v_exp_f32 v134, v134
v_mfma_f32_16x16x32_bf16 a[84:87], a[184:187], v[200:203], a[84:87]
s_waitcnt vmcnt(11)
v_readfirstlane_b32 vcc_lo, v19
s_nop 0
s_cmp_lt_u32 vcc_lo, s69
s_cbranch_scc1 L_spin_1012
L_spinbk_1013:
v_mfma_f32_16x16x32_bf16 a[84:87], a[188:191], v[204:207], a[84:87]
ds_read_b128 a[148:151], v2 offset:17408
v_cvt_pk_bf16_f32 v198, v148, v149
v_mfma_f32_16x16x32_bf16 a[52:55], a[188:191], v[180:183], a[52:55]
ds_read_b128 a[152:155], v2 offset:18432
v_cvt_pk_bf16_f32 v199, v150, v151
v_mfma_f32_16x16x32_bf16 a[52:55], a[184:187], v[176:179], a[52:55]
s_waitcnt lgkmcnt(3)
ds_read_b128 a[156:159], v2 offset:19456
v_cndmask_b32 v136, v228, v17, s[0:1]
v_mfma_f32_16x16x32_bf16 a[56:59], a[192:195], v[176:179], a[56:59]
ds_read_b128 a[160:163], v2 offset:20480
v_cndmask_b32 v137, v228, v17, s[4:5]
v_mfma_f32_16x16x32_bf16 a[56:59], a[196:199], v[180:183], a[56:59]
ds_read_b128 a[164:167], v2 offset:21504
v_cndmask_b32 v138, v228, v17, s[6:7]
v_mfma_f32_16x16x32_bf16 a[88:91], a[196:199], v[204:207], a[88:91]
ds_read_b128 a[168:171], v2 offset:22528
v_cndmask_b32 v139, v228, v17, s[8:9]
v_mfma_f32_16x16x32_bf16 a[88:91], a[192:195], v[200:203], a[88:91]
v_exp_f32 v135, v135
v_mfma_f32_16x16x32_bf16 a[120:123], a[192:195], v[208:211], a[120:123]
ds_read_b128 a[172:175], v2 offset:23552
v_cvt_pk_bf16_f32 v190, v132, v133
v_mfma_f32_16x16x32_bf16 a[120:123], a[196:199], v[212:215], a[120:123]
v_cndmask_b32 v140, v228, v17, s[10:11]
v_cvt_pk_bf16_f32 v191, v134, v135
v_mfma_f32_16x16x32_bf16 a[124:127], a[204:207], v[212:215], a[124:127]
v_cndmask_b32 v141, v228, v17, s[12:13]
v_cndmask_b32 v142, v228, v17, s[18:19]
v_mfma_f32_16x16x32_bf16 a[124:127], a[200:203], v[208:211], a[124:127]
v_cndmask_b32 v143, v228, v17, s[22:23]
v_cndmask_b32 v144, v228, v17, s[26:27]
v_mfma_f32_16x16x32_bf16 a[92:95], a[200:203], v[200:203], a[92:95]
v_cndmask_b32 v145, v228, v17, s[56:57]
v_cndmask_b32 v146, v228, v17, s[58:59]
v_mfma_f32_16x16x32_bf16 a[92:95], a[204:207], v[204:207], a[92:95]
v_cndmask_b32 v147, v228, v17, s[60:61]
v_cndmask_b32 v148, v228, v17, s[62:63]
v_mfma_f32_16x16x32_bf16 a[60:63], a[204:207], v[180:183], a[60:63]
v_cndmask_b32 v149, v228, v17, s[48:49]
v_cndmask_b32 v150, v228, v17, s[50:51]
v_mfma_f32_16x16x32_bf16 a[60:63], a[200:203], v[176:179], a[60:63]
s_waitcnt lgkmcnt(0)
v_cndmask_b32 v151, v228, v17, s[100:101]
v_accvgpr_read_b32 v21, a132
v_mfma_f32_16x16x32_bf16 v[136:139], a[144:147], v[72:75], v[136:139]
ds_read_b128 a[176:179], v2 offset:24576
v_accvgpr_read_b32 v248, a133
v_mfma_f32_16x16x32_bf16 v[136:139], a[148:151], v[76:79], v[136:139]
ds_read_b128 a[180:183], v2 offset:25600
v_add_f32 v21, v21, v248
v_mfma_f32_16x16x32_bf16 v[136:139], a[152:155], v[80:83], v[136:139]
ds_read_b128 a[184:187], v2 offset:26624
v_max_f32 v1, v1, v21
v_mfma_f32_16x16x32_bf16 v[136:139], a[156:159], v[84:87], v[136:139]
ds_read_b128 a[188:191], v2 offset:27648
ds_read_b128 a[192:195], v2 offset:28672
v_mfma_f32_16x16x32_bf16 v[140:143], a[172:175], v[84:87], v[140:143]
ds_read_b128 a[196:199], v2 offset:29696
ds_read_b128 a[200:203], v2 offset:30720
ds_read_b128 a[204:207], v2 offset:31744
v_mfma_f32_16x16x32_bf16 v[140:143], a[168:171], v[80:83], v[140:143]
v_rcp_f32 v21, v21
v_mfma_f32_16x16x32_bf16 v[140:143], a[164:167], v[76:79], v[140:143]
ds_read_b128 a[144:147], v3 offset:16384
v_accvgpr_read_b32 v232, a32
v_mfma_f32_16x16x32_bf16 v[140:143], a[160:163], v[72:75], v[140:143]
s_waitcnt lgkmcnt(7)
ds_read_b128 a[148:151], v3 offset:24576
v_accvgpr_read_b32 v233, a33
v_mfma_f32_16x16x32_bf16 v[144:147], a[176:179], v[72:75], v[144:147]
ds_read_b128 a[152:155], v3 offset:17408
v_accvgpr_read_b32 v234, a34
v_mfma_f32_16x16x32_bf16 v[144:147], a[180:183], v[76:79], v[144:147]
s_waitcnt lgkmcnt(6)
ds_read_b128 a[156:159], v3 offset:25600
v_accvgpr_read_b32 v235, a35
v_mfma_f32_16x16x32_bf16 v[144:147], a[184:187], v[80:83], v[144:147]
ds_read_b128 a[160:163], v3 offset:18432
v_accvgpr_read_b32 v236, a36
v_accvgpr_read_b32 v237, a37
v_accvgpr_read_b32 v238, a38
v_accvgpr_read_b32 v239, a39
v_mul_f32 v21, v21, v6
v_mul_f32 v232, v232, v21
v_mul_f32 v233, v233, v21
v_mul_f32 v234, v234, v21
v_mul_f32 v235, v235, v21
v_mul_f32 v236, v236, v21
v_mul_f32 v237, v237, v21
v_mul_f32 v238, v238, v21
v_mul_f32 v239, v239, v21
v_cvt_pk_bf16_f32 v232, v232, v233
v_cvt_pk_bf16_f32 v233, v234, v235
v_cvt_pk_bf16_f32 v234, v236, v237
v_cvt_pk_bf16_f32 v235, v238, v239
s_add_u32 s77, s74, 4096
buffer_store_dwordx4 v[232:235], v16, s[44:47], s77 offen sc1
v_accvgpr_read_b32 v240, a40
v_accvgpr_read_b32 v241, a41
v_accvgpr_read_b32 v242, a42
v_accvgpr_read_b32 v243, a43
v_accvgpr_read_b32 v244, a44
v_accvgpr_read_b32 v245, a45
v_accvgpr_read_b32 v246, a46
v_accvgpr_read_b32 v247, a47
v_mul_f32 v240, v240, v21
v_mul_f32 v241, v241, v21
v_mul_f32 v242, v242, v21
v_mul_f32 v243, v243, v21
v_mul_f32 v244, v244, v21
v_mul_f32 v245, v245, v21
v_mul_f32 v246, v246, v21
v_mul_f32 v247, v247, v21
v_cvt_pk_bf16_f32 v240, v240, v241
v_cvt_pk_bf16_f32 v241, v242, v243
v_cvt_pk_bf16_f32 v242, v244, v245
v_cvt_pk_bf16_f32 v243, v246, v247
s_add_u32 s77, s74, 12288
buffer_store_dwordx4 v[240:243], v16, s[44:47], s77 offen sc1
v_accvgpr_read_b32 v232, a48
v_accvgpr_read_b32 v233, a49
v_accvgpr_read_b32 v234, a50
v_accvgpr_read_b32 v235, a51
v_accvgpr_read_b32 v236, a52
v_accvgpr_read_b32 v237, a53
v_accvgpr_read_b32 v238, a54
v_accvgpr_read_b32 v239, a55
v_mul_f32 v232, v232, v21
v_mul_f32 v233, v233, v21
v_mul_f32 v234, v234, v21
v_mul_f32 v235, v235, v21
v_mul_f32 v236, v236, v21
v_mul_f32 v237, v237, v21
v_mul_f32 v238, v238, v21
v_mul_f32 v239, v239, v21
v_cvt_pk_bf16_f32 v232, v232, v233
v_cvt_pk_bf16_f32 v233, v234, v235
v_cvt_pk_bf16_f32 v234, v236, v237
v_cvt_pk_bf16_f32 v235, v238, v239
s_add_u32 s77, s74, 20480
buffer_store_dwordx4 v[232:235], v16, s[44:47], s77 offen sc1
v_accvgpr_read_b32 v240, a56
v_accvgpr_read_b32 v241, a57
v_accvgpr_read_b32 v242, a58
v_accvgpr_read_b32 v243, a59
v_accvgpr_read_b32 v244, a60
v_accvgpr_read_b32 v245, a61
v_accvgpr_read_b32 v246, a62
v_accvgpr_read_b32 v247, a63
v_mul_f32 v240, v240, v21
v_mul_f32 v241, v241, v21
v_mul_f32 v242, v242, v21
v_mul_f32 v243, v243, v21
v_mul_f32 v244, v244, v21
v_mul_f32 v245, v245, v21
v_mul_f32 v246, v246, v21
v_mul_f32 v247, v247, v21
v_cvt_pk_bf16_f32 v240, v240, v241
v_cvt_pk_bf16_f32 v241, v242, v243
v_cvt_pk_bf16_f32 v242, v244, v245
v_cvt_pk_bf16_f32 v243, v246, v247
s_add_u32 s77, s74, 28672
buffer_store_dwordx4 v[240:243], v16, s[44:47], s77 offen sc1
v_exp_f32 v136, v136
v_mfma_f32_16x16x32_bf16 v[144:147], a[188:191], v[84:87], v[144:147]
s_waitcnt lgkmcnt(5)
v_exp_f32 v137, v137
v_mfma_f32_16x16x32_bf16 v[148:151], a[204:207], v[84:87], v[148:151]
v_exp_f32 v138, v138
v_mfma_f32_16x16x32_bf16 v[148:151], a[200:203], v[80:83], v[148:151]
s_add_u32 s65, s84, 0
v_exp_f32 v139, v139
v_mfma_f32_16x16x32_bf16 v[148:151], a[196:199], v[76:79], v[148:151]
buffer_load_dwordx4 a[208:211], v14, s[44:47], s65 offen offset:0 sc1
v_mfma_f32_16x16x32_bf16 v[148:151], a[192:195], v[72:75], v[148:151]
ds_read_b128 a[164:167], v3 offset:26624
v_cvt_pk_bf16_f32 v208, v136, v137
v_smfmac_f32_16x16x64_bf16 a[136:139], a[240:243], v[184:191], v5
ds_read_b128 a[168:171], v3 offset:19456
v_smfmac_f32_16x16x64_bf16 a[140:143], a[240:243], v[192:199], v5
s_waitcnt lgkmcnt(2)
ds_read_b128 a[172:175], v3 offset:27648
v_mfma_f32_16x16x32_bf16 a[64:67], a[144:147], v[184:187], a[64:67]
v_exp_f32 v140, v140
v_mfma_f32_16x16x32_bf16 a[64:67], a[148:151], v[188:191], a[64:67]
buffer_load_dwordx4 a[216:219], v14, s[44:47], s65 offen offset:1024 sc1
v_mfma_f32_16x16x32_bf16 a[96:99], a[148:151], v[196:199], a[96:99]
v_exp_f32 v141, v141
v_mfma_f32_16x16x32_bf16 a[96:99], a[144:147], v[192:195], a[96:99]
buffer_load_dwordx4 a[224:227], v15, s[44:47], s65 offen offset:0 sc1
v_mfma_f32_16x16x32_bf16 a[100:103], a[152:155], v[192:195], a[100:103]
v_exp_f32 v142, v142
v_mfma_f32_16x16x32_bf16 a[100:103], a[156:159], v[196:199], a[100:103]
buffer_load_dwordx4 a[232:235], v15, s[44:47], s65 offen offset:1024 sc1
v_mfma_f32_16x16x32_bf16 a[68:71], a[156:159], v[188:191], a[68:71]
s_add_u32 s65, s84, 8192
ds_read_b128 a[176:179], v3 offset:20480
v_cvt_pk_bf16_f32 v209, v138, v139
v_mfma_f32_16x16x32_bf16 a[68:71], a[152:155], v[184:187], a[68:71]
buffer_load_dwordx4 a[212:215], v14, s[44:47], s65 offen offset:0 sc1
v_mfma_f32_16x16x32_bf16 a[72:75], a[160:163], v[184:187], a[72:75]
s_waitcnt lgkmcnt(1)
ds_read_b128 a[180:183], v3 offset:28672
v_cvt_pk_bf16_f32 v210, v140, v141
v_mfma_f32_16x16x32_bf16 a[72:75], a[164:167], v[188:191], a[72:75]
v_exp_f32 v143, v143
v_mfma_f32_16x16x32_bf16 a[104:107], a[164:167], v[196:199], a[104:107]
buffer_load_dwordx4 a[220:223], v14, s[44:47], s65 offen offset:1024 sc1
v_mfma_f32_16x16x32_bf16 a[104:107], a[160:163], v[192:195], a[104:107]
v_exp_f32 v144, v144
v_mfma_f32_16x16x32_bf16 a[108:111], a[168:171], v[192:195], a[108:111]
ds_read_b128 a[184:187], v3 offset:21504
v_xor_b32 v2, 0x8000, v2
v_mfma_f32_16x16x32_bf16 a[108:111], a[172:175], v[196:199], a[108:111]
buffer_load_dwordx4 a[228:231], v15, s[44:47], s65 offen offset:0 sc1
ds_read_b128 a[188:191], v3 offset:29696
v_mfma_f32_16x16x32_bf16 a[76:79], a[172:175], v[188:191], a[76:79]
v_exp_f32 v145, v145
v_mfma_f32_16x16x32_bf16 a[76:79], a[168:171], v[184:187], a[76:79]
s_waitcnt lgkmcnt(2)
buffer_load_dwordx4 a[236:239], v15, s[44:47], s65 offen offset:1024 sc1
v_mfma_f32_16x16x32_bf16 a[80:83], a[176:179], v[184:187], a[80:83]
s_add_u32 s65, s84, 32768
ds_read_b128 a[192:195], v3 offset:22528
v_cvt_pk_bf16_f32 v211, v142, v143
v_mfma_f32_16x16x32_bf16 a[80:83], a[180:183], v[188:191], a[80:83]
buffer_load_dwordx4 v[152:155], v14, s[44:47], s65 offen offset:0 sc1
ds_read_b128 a[196:199], v3 offset:30720
v_exp_f32 v146, v146
v_mfma_f32_16x16x32_bf16 a[112:115], a[180:183], v[196:199], a[112:115]
ds_read_b128 a[200:203], v3 offset:23552
ds_read_b128 a[204:207], v3 offset:31744
v_mfma_f32_16x16x32_bf16 a[112:115], a[176:179], v[192:195], a[112:115]
s_waitcnt vmcnt(13)
s_barrier
v_xor_b32 v3, 0x8000, v3
buffer_load_dwordx4 v[160:163], v14, s[44:47], s65 offen offset:1024 sc1
s_waitcnt lgkmcnt(4)
v_mfma_f32_16x16x32_bf16 a[116:119], a[184:187], v[192:195], a[116:119]
v_exp_f32 v147, v147
v_mfma_f32_16x16x32_bf16 a[116:119], a[188:191], v[196:199], a[116:119]
buffer_load_dwordx4 v[168:171], v15, s[44:47], s65 offen offset:0 sc1
v_mfma_f32_16x16x32_bf16 a[84:87], a[188:191], v[188:191], a[84:87]
v_exp_f32 v148, v148
v_mfma_f32_16x16x32_bf16 a[84:87], a[184:187], v[184:187], a[84:87]
s_waitcnt lgkmcnt(2)
buffer_load_dwordx4 v[176:179], v15, s[44:47], s65 offen offset:1024 sc1
v_cvt_pk_bf16_f32 v212, v144, v145
v_mfma_f32_16x16x32_bf16 a[88:91], a[192:195], v[184:187], a[88:91]
s_add_u32 s65, s84, 40960
v_exp_f32 v149, v149
v_mfma_f32_16x16x32_bf16 a[88:91], a[196:199], v[188:191], a[88:91]
buffer_load_dwordx4 v[156:159], v14, s[44:47], s65 offen offset:0 sc1
v_mfma_f32_16x16x32_bf16 a[120:123], a[196:199], v[196:199], a[120:123]
ds_read_b128 a[144:147], v3 offset:0
v_cvt_pk_bf16_f32 v213, v146, v147
v_mfma_f32_16x16x32_bf16 a[120:123], a[192:195], v[192:195], a[120:123]
s_waitcnt lgkmcnt(1)
buffer_load_dwordx4 v[164:167], v14, s[44:47], s65 offen offset:1024 sc1
ds_read_b128 a[148:151], v3 offset:8192
v_exp_f32 v150, v150
v_mfma_f32_16x16x32_bf16 a[124:127], a[200:203], v[192:195], a[124:127]
ds_read_b128 a[152:155], v3 offset:1024
v_cvt_pk_bf16_f32 v214, v148, v149
v_mfma_f32_16x16x32_bf16 a[124:127], a[204:207], v[196:199], a[124:127]
buffer_load_dwordx4 v[172:175], v15, s[44:47], s65 offen offset:0 sc1
ds_read_b128 a[156:159], v3 offset:9216
v_mfma_f32_16x16x32_bf16 a[92:95], a[204:207], v[188:191], a[92:95]
v_exp_f32 v151, v151
v_mfma_f32_16x16x32_bf16 a[92:95], a[200:203], v[184:187], a[92:95]
buffer_load_dwordx4 v[180:183], v15, s[44:47], s65 offen offset:1024 sc1
ds_read_b128 a[160:163], v3 offset:2048
ds_read_b128 a[164:167], v3 offset:10240
ds_read_b128 a[168:171], v3 offset:3072
ds_read_b128 a[172:175], v3 offset:11264
v_cvt_pk_bf16_f32 v215, v150, v151
v_accvgpr_read_b32 v22, a136
v_accvgpr_read_b32 v248, a137
v_add_f32 v22, v22, v248
v_max_f32 v1, v1, v22
v_rcp_f32 v22, v22
v_accvgpr_read_b32 v232, a64
v_accvgpr_read_b32 v233, a65
v_accvgpr_read_b32 v234, a66
v_accvgpr_read_b32 v235, a67
v_accvgpr_read_b32 v236, a68
v_accvgpr_read_b32 v237, a69
v_accvgpr_read_b32 v238, a70
v_accvgpr_read_b32 v239, a71
v_mul_f32 v22, v22, v8
v_mul_f32 v232, v232, v22
v_mul_f32 v233, v233, v22
v_mul_f32 v234, v234, v22
v_mul_f32 v235, v235, v22
v_mul_f32 v236, v236, v22
v_mul_f32 v237, v237, v22
v_mul_f32 v238, v238, v22
v_mul_f32 v239, v239, v22
v_cvt_pk_bf16_f32 v232, v232, v233
v_cvt_pk_bf16_f32 v233, v234, v235
v_cvt_pk_bf16_f32 v234, v236, v237
v_cvt_pk_bf16_f32 v235, v238, v239
s_add_u32 s77, s75, 0
buffer_store_dwordx4 v[232:235], v16, s[44:47], s77 offen sc1
s_branch L_TAIL
L_fallback_11:
s_waitcnt vmcnt(0) lgkmcnt(0)
s_barrier
s_mov_b32 s73, 1
s_mov_b32 s81, 0
v_and_b32 v232, 15, v0
v_lshrrev_b32 v233, 4, v0
v_lshlrev_b32 v233, 2, v233
v_sub_u32 v232, v232, v233
s_lshl_b32 s66, s30, 4
v_add_u32 v232, s66, v232
s_lshl_b32 s66, s16, 7
v_add_u32 v234, s66, v232
s_lshl_b32 s66, s3, 7
v_add_u32 v232, s66, v232
v_add_u32 v233, 64, v232
v_add_u32 v235, 64, v234
s_mov_b32 m0, s76
s_lshl_b32 s64, s30, 14
s_nop 0
buffer_load_dwordx4 v16, s[32:35], s64 offen offset:0 sc1 lds
s_nop 0
buffer_load_dwordx4 v16, s[32:35], s64 offen offset:1024 sc1 lds
s_nop 0
buffer_load_dwordx4 v16, s[32:35], s64 offen offset:2048 sc1 lds
s_nop 0
buffer_load_dwordx4 v16, s[32:35], s64 offen offset:3072 sc1 lds
s_add_u32 m0, s76, 4096
s_add_u32 s64, s64, 4096
s_nop 0
buffer_load_dwordx4 v16, s[32:35], s64 offen offset:0 sc1 lds
s_nop 0
buffer_load_dwordx4 v16, s[32:35], s64 offen offset:1024 sc1 lds
s_nop 0
buffer_load_dwordx4 v16, s[32:35], s64 offen offset:2048 sc1 lds
s_nop 0
buffer_load_dwordx4 v16, s[32:35], s64 offen offset:3072 sc1 lds
s_lshr_b32 s64, s76, 1
s_add_u32 m0, s64, 81920
s_and_b32 s71, s64, 8192
s_add_u32 s64, s64, s71
s_add_u32 s64, s64, 8192
s_nop 0
buffer_load_dwordx4 v16, s[32:35], s64 offen offset:0 sc1 lds
s_nop 0
buffer_load_dwordx4 v16, s[32:35], s64 offen offset:1024 sc1 lds
s_nop 0
buffer_load_dwordx4 v16, s[32:35], s64 offen offset:2048 sc1 lds
s_nop 0
buffer_load_dwordx4 v16, s[32:35], s64 offen offset:3072 sc1 lds
v_mov_b32 v20, 0xff800000
v_mov_b32 v21, 0xff800000
v_mov_b32 v22, 0xff800000
v_mov_b32 v23, 0xff800000
L_fbl_1015:
buffer_load_dwordx4 a[144:147], v16, s[32:35], s81 offen offset:0 sc1
buffer_load_dwordx4 a[148:151], v16, s[32:35], s81 offen offset:1024 sc1
buffer_load_dwordx4 a[152:155], v16, s[32:35], s81 offen offset:2048 sc1
buffer_load_dwordx4 a[156:159], v16, s[32:35], s81 offen offset:3072 sc1
s_add_u32 s64, s81, 4096
buffer_load_dwordx4 a[160:163], v16, s[32:35], s64 offen offset:0 sc1
buffer_load_dwordx4 a[164:167], v16, s[32:35], s64 offen offset:1024 sc1
buffer_load_dwordx4 a[168:171], v16, s[32:35], s64 offen offset:2048 sc1
buffer_load_dwordx4 a[172:175], v16, s[32:35], s64 offen offset:3072 sc1
v_subrev_u32 v88, 0, v232
v_ashrrev_i32 v88, 31, v88
v_and_b32 v88, 0xff800000, v88
v_subrev_u32 v89, 1, v232
v_ashrrev_i32 v89, 31, v89
v_and_b32 v89, 0xff800000, v89
v_subrev_u32 v90, 2, v232
v_ashrrev_i32 v90, 31, v90
v_and_b32 v90, 0xff800000, v90
v_subrev_u32 v91, 3, v232
v_ashrrev_i32 v91, 31, v91
v_and_b32 v91, 0xff800000, v91
v_subrev_u32 v92, 16, v232
v_ashrrev_i32 v92, 31, v92
v_and_b32 v92, 0xff800000, v92
v_subrev_u32 v93, 17, v232
v_ashrrev_i32 v93, 31, v93
v_and_b32 v93, 0xff800000, v93
v_subrev_u32 v94, 18, v232
v_ashrrev_i32 v94, 31, v94
v_and_b32 v94, 0xff800000, v94
v_subrev_u32 v95, 19, v232
v_ashrrev_i32 v95, 31, v95
v_and_b32 v95, 0xff800000, v95
v_subrev_u32 v232, 32, v232
v_subrev_u32 v104, 0, v233
v_ashrrev_i32 v104, 31, v104
v_and_b32 v104, 0xff800000, v104
v_subrev_u32 v105, 1, v233
v_ashrrev_i32 v105, 31, v105
v_and_b32 v105, 0xff800000, v105
v_subrev_u32 v106, 2, v233
v_ashrrev_i32 v106, 31, v106
v_and_b32 v106, 0xff800000, v106
v_subrev_u32 v107, 3, v233
v_ashrrev_i32 v107, 31, v107
v_and_b32 v107, 0xff800000, v107
v_subrev_u32 v108, 16, v233
v_ashrrev_i32 v108, 31, v108
v_and_b32 v108, 0xff800000, v108
v_subrev_u32 v109, 17, v233
v_ashrrev_i32 v109, 31, v109
v_and_b32 v109, 0xff800000, v109
v_subrev_u32 v110, 18, v233
v_ashrrev_i32 v110, 31, v110
v_and_b32 v110, 0xff800000, v110
v_subrev_u32 v111, 19, v233
v_ashrrev_i32 v111, 31, v111
v_and_b32 v111, 0xff800000, v111
v_subrev_u32 v233, 32, v233
v_subrev_u32 v120, 0, v234
v_ashrrev_i32 v120, 31, v120
v_and_b32 v120, 0xff800000, v120
v_subrev_u32 v121, 1, v234
v_ashrrev_i32 v121, 31, v121
v_and_b32 v121, 0xff800000, v121
v_subrev_u32 v122, 2, v234
v_ashrrev_i32 v122, 31, v122
v_and_b32 v122, 0xff800000, v122
v_subrev_u32 v123, 3, v234
v_ashrrev_i32 v123, 31, v123
v_and_b32 v123, 0xff800000, v123
v_subrev_u32 v124, 16, v234
v_ashrrev_i32 v124, 31, v124
v_and_b32 v124, 0xff800000, v124
v_subrev_u32 v125, 17, v234
v_ashrrev_i32 v125, 31, v125
v_and_b32 v125, 0xff800000, v125
v_subrev_u32 v126, 18, v234
v_ashrrev_i32 v126, 31, v126
v_and_b32 v126, 0xff800000, v126
v_subrev_u32 v127, 19, v234
v_ashrrev_i32 v127, 31, v127
v_and_b32 v127, 0xff800000, v127
v_subrev_u32 v234, 32, v234
v_subrev_u32 v136, 0, v235
v_ashrrev_i32 v136, 31, v136
v_and_b32 v136, 0xff800000, v136
v_subrev_u32 v137, 1, v235
v_ashrrev_i32 v137, 31, v137
v_and_b32 v137, 0xff800000, v137
v_subrev_u32 v138, 2, v235
v_ashrrev_i32 v138, 31, v138
v_and_b32 v138, 0xff800000, v138
v_subrev_u32 v139, 3, v235
v_ashrrev_i32 v139, 31, v139
v_and_b32 v139, 0xff800000, v139
v_subrev_u32 v140, 16, v235
v_ashrrev_i32 v140, 31, v140
v_and_b32 v140, 0xff800000, v140
v_subrev_u32 v141, 17, v235
v_ashrrev_i32 v141, 31, v141
v_and_b32 v141, 0xff800000, v141
v_subrev_u32 v142, 18, v235
v_ashrrev_i32 v142, 31, v142
v_and_b32 v142, 0xff800000, v142
v_subrev_u32 v143, 19, v235
v_ashrrev_i32 v143, 31, v143
v_and_b32 v143, 0xff800000, v143
v_subrev_u32 v235, 32, v235
s_waitcnt vmcnt(0)
v_mfma_f32_16x16x32_bf16 v[88:91], a[144:147], v[24:27], v[88:91]
v_mfma_f32_16x16x32_bf16 v[104:107], a[144:147], v[40:43], v[104:107]
v_mfma_f32_16x16x32_bf16 v[120:123], a[144:147], v[56:59], v[120:123]
v_mfma_f32_16x16x32_bf16 v[136:139], a[144:147], v[72:75], v[136:139]
v_mfma_f32_16x16x32_bf16 v[88:91], a[148:151], v[28:31], v[88:91]
v_mfma_f32_16x16x32_bf16 v[104:107], a[148:151], v[44:47], v[104:107]
v_mfma_f32_16x16x32_bf16 v[120:123], a[148:151], v[60:63], v[120:123]
v_mfma_f32_16x16x32_bf16 v[136:139], a[148:151], v[76:79], v[136:139]
v_mfma_f32_16x16x32_bf16 v[88:91], a[152:155], v[32:35], v[88:91]
v_mfma_f32_16x16x32_bf16 v[104:107], a[152:155], v[48:51], v[104:107]
v_mfma_f32_16x16x32_bf16 v[120:123], a[152:155], v[64:67], v[120:123]
v_mfma_f32_16x16x32_bf16 v[136:139], a[152:155], v[80:83], v[136:139]
v_mfma_f32_16x16x32_bf16 v[88:91], a[156:159], v[36:39], v[88:91]
v_mfma_f32_16x16x32_bf16 v[104:107], a[156:159], v[52:55], v[104:107]
v_mfma_f32_16x16x32_bf16 v[120:123], a[156:159], v[68:71], v[120:123]
v_mfma_f32_16x16x32_bf16 v[136:139], a[156:159], v[84:87], v[136:139]
v_mfma_f32_16x16x32_bf16 v[92:95], a[160:163], v[24:27], v[92:95]
v_mfma_f32_16x16x32_bf16 v[108:111], a[160:163], v[40:43], v[108:111]
v_mfma_f32_16x16x32_bf16 v[124:127], a[160:163], v[56:59], v[124:127]
v_mfma_f32_16x16x32_bf16 v[140:143], a[160:163], v[72:75], v[140:143]
v_mfma_f32_16x16x32_bf16 v[92:95], a[164:167], v[28:31], v[92:95]
v_mfma_f32_16x16x32_bf16 v[108:111], a[164:167], v[44:47], v[108:111]
v_mfma_f32_16x16x32_bf16 v[124:127], a[164:167], v[60:63], v[124:127]
v_mfma_f32_16x16x32_bf16 v[140:143], a[164:167], v[76:79], v[140:143]
v_mfma_f32_16x16x32_bf16 v[92:95], a[168:171], v[32:35], v[92:95]
v_mfma_f32_16x16x32_bf16 v[108:111], a[168:171], v[48:51], v[108:111]
v_mfma_f32_16x16x32_bf16 v[124:127], a[168:171], v[64:67], v[124:127]
v_mfma_f32_16x16x32_bf16 v[140:143], a[168:171], v[80:83], v[140:143]
v_mfma_f32_16x16x32_bf16 v[92:95], a[172:175], v[36:39], v[92:95]
v_mfma_f32_16x16x32_bf16 v[108:111], a[172:175], v[52:55], v[108:111]
v_mfma_f32_16x16x32_bf16 v[124:127], a[172:175], v[68:71], v[124:127]
v_mfma_f32_16x16x32_bf16 v[140:143], a[172:175], v[84:87], v[140:143]
s_nop 7
v_max3_f32 v20, v20, v88, v89
v_max3_f32 v20, v20, v90, v91
v_max3_f32 v20, v20, v92, v93
v_max3_f32 v20, v20, v94, v95
v_max3_f32 v21, v21, v104, v105
v_max3_f32 v21, v21, v106, v107
v_max3_f32 v21, v21, v108, v109
v_max3_f32 v21, v21, v110, v111
v_max3_f32 v22, v22, v120, v121
v_max3_f32 v22, v22, v122, v123
v_max3_f32 v22, v22, v124, v125
v_max3_f32 v22, v22, v126, v127
v_max3_f32 v23, v23, v136, v137
v_max3_f32 v23, v23, v138, v139
v_max3_f32 v23, v23, v140, v141
v_max3_f32 v23, v23, v142, v143
s_add_u32 s81, s81, 16384
s_cmp_lt_u32 s81, s34
s_cbranch_scc1 L_fbl_1015
v_mov_b32 v248, v20
v_mov_b32 v249, v21
v_mov_b32 v250, v22
v_mov_b32 v251, v23
v_permlane16_swap_b32 v248, v20
v_permlane16_swap_b32 v249, v21
v_permlane16_swap_b32 v250, v22
v_permlane16_swap_b32 v251, v23
v_max_f32 v20, v20, v248
v_max_f32 v21, v21, v249
v_max_f32 v22, v22, v250
v_max_f32 v23, v23, v251
v_mov_b32 v248, v20
v_mov_b32 v249, v21
v_mov_b32 v250, v22
v_mov_b32 v251, v23
v_permlane32_swap_b32 v248, v20
v_permlane32_swap_b32 v249, v21
v_permlane32_swap_b32 v250, v22
v_permlane32_swap_b32 v251, v23
v_max_f32 v20, v20, v248
v_max_f32 v21, v21, v249
v_max_f32 v22, v22, v250
v_max_f32 v23, v23, v251
v_mov_b32 v252, v20
v_mov_b32 v253, v21
v_mov_b32 v254, v22
v_mov_b32 v255, v23
s_and_b32 s70, s30, 1
s_lshr_b32 s67, s30, 1
s_lshl3_add_u32 s71, s67, s70
s_add_u32 s71, s71, 4
s_lshl_b32 s71, s71, 13
s_lshl_b32 s70, s70, 14
s_mul_i32 s67, s67, 24576
s_sub_u32 s70, s70, s67
s_add_u32 s70, s70, 65536
s_branch L_attstart_7
L_spin_2016:
s_mov_b32 vcc_hi, 0x80000
L_spinlp_2018:
s_sleep 1
buffer_load_dword v19, off, s[52:55], s72 offset:0 sc1
s_waitcnt vmcnt(0)
v_readfirstlane_b32 vcc_lo, v19
s_sub_u32 vcc_hi, vcc_hi, 1
s_cbranch_scc1 L_spinbk_2017
s_cmp_lt_u32 vcc_lo, 8
s_cbranch_scc1 L_spinlp_2018
s_branch L_spinbk_2017
L_spin_3019:
s_mov_b32 vcc_hi, 0x80000
L_spinlp_3021:
s_sleep 1
buffer_load_dword v19, off, s[52:55], s72 offset:0 sc1
s_waitcnt vmcnt(0)
v_readfirstlane_b32 vcc_lo, v19
s_sub_u32 vcc_hi, vcc_hi, 1
s_cbranch_scc1 L_spinbk_3020
s_cmp_lt_u32 vcc_lo, 8
s_cbranch_scc1 L_spinlp_3021
s_branch L_spinbk_3020
L_p5f0:
s_waitcnt lgkmcnt(10)
s_waitcnt vmcnt(28)
v_mfma_f32_16x16x32_bf16 v[136:139], a[144:147], a[232:235], 0
s_waitcnt vmcnt(24)
s_waitcnt lgkmcnt(8)
s_add_u32 m0, s86, 65536
ds_read_b64_tr_b16 a[168:169], v191 offset:32768
v_xor_b32 v192, 0x10000, v184
v_mfma_f32_16x16x32_bf16 v[136:139], a[148:151], a[236:239], v[136:139]
s_add_u32 s64, s85, 524288
ds_read_b64_tr_b16 a[170:171], v191 offset:36864
v_xor_b32 v193, 0x10000, v185
v_mfma_f32_16x16x32_bf16 v[104:107], a[148:151], a[228:231], 0
buffer_load_dwordx4 v12, s[36:39], s64 offen lds
v_mfma_f32_16x16x32_bf16 v[104:107], a[144:147], a[224:227], v[104:107]
s_add_u32 m0, s86, 66560
s_add_u32 s64, s85, 532480
ds_read_b64_tr_b16 a[172:173], v191 offset:40960
v_xor_b32 v194, 0x10000, v186
v_mfma_f32_16x16x32_bf16 v[72:75], a[144:147], a[216:219], 0
s_and_b32 s71, s31, 4
buffer_load_dwordx4 v13, s[36:39], s64 offen lds
v_mfma_f32_16x16x32_bf16 v[72:75], a[148:151], a[220:223], v[72:75]
s_lshl_b32 s71, s71, 5
s_add_u32 s71, s71, s79
s_add_u32 m0, s86, 67584
s_add_u32 s64, s85, 540672
ds_read_b64_tr_b16 a[174:175], v191 offset:45056
v_mfma_f32_16x16x32_bf16 v[40:43], a[148:151], a[212:215], 0
s_add_u32 s71, s71, 4096
buffer_load_dwordx4 v12, s[36:39], s64 offen lds
v_mfma_f32_16x16x32_bf16 v[40:43], a[144:147], a[208:211], v[40:43]
s_waitcnt lgkmcnt(4)
s_add_u32 s72, s80, 4096
s_add_u32 m0, s86, 68608
s_add_u32 s64, s85, 548864
ds_read_b64_tr_b16 a[176:177], v184 offset:32768
v_xor_b32 v195, 0x10000, v187
v_mfma_f32_16x16x32_bf16 v[44:47], a[152:155], a[208:211], 0
buffer_load_dwordx4 v13, s[36:39], s64 offen lds
v_mfma_f32_16x16x32_bf16 v[44:47], a[156:159], a[212:215], v[44:47]
s_add_u32 m0, s86, 69632
ds_read_b64_tr_b16 a[178:179], v184 offset:36864
v_xor_b32 v196, 0x10000, v188
v_mfma_f32_16x16x32_bf16 v[76:79], a[156:159], a[220:223], 0
s_add_u32 s64, s85, 557056
ds_read_b64_tr_b16 a[180:181], v184 offset:40960
v_xor_b32 v197, 0x10000, v189
v_mfma_f32_16x16x32_bf16 v[76:79], a[152:155], a[216:219], v[76:79]
buffer_load_dwordx4 v12, s[36:39], s64 offen lds
v_mfma_f32_16x16x32_bf16 v[108:111], a[152:155], a[224:227], 0
s_add_u32 m0, s86, 70656
s_add_u32 s64, s85, 565248
ds_read_b64_tr_b16 a[182:183], v184 offset:45056
v_xor_b32 v198, 0x10000, v190
v_mfma_f32_16x16x32_bf16 v[108:111], a[156:159], a[228:231], v[108:111]
buffer_load_dwordx4 v13, s[36:39], s64 offen lds
v_mfma_f32_16x16x32_bf16 v[140:143], a[156:159], a[236:239], 0
s_add_u32 m0, s86, 71680
s_add_u32 s64, s85, 573440
ds_read_b64_tr_b16 a[184:185], v185 offset:32768
v_xor_b32 v199, 0x10000, v191
v_mfma_f32_16x16x32_bf16 v[140:143], a[152:155], a[232:235], v[140:143]
buffer_load_dwordx4 v12, s[36:39], s64 offen lds
v_mfma_f32_16x16x32_bf16 v[144:147], a[160:163], a[232:235], 0
s_add_u32 m0, s86, 72704
ds_read_b64_tr_b16 a[186:187], v185 offset:36864
v_mfma_f32_16x16x32_bf16 v[144:147], a[164:167], a[236:239], v[144:147]
s_add_u32 s64, s85, 581632
ds_read_b64_tr_b16 a[188:189], v185 offset:40960
v_mfma_f32_16x16x32_bf16 v[112:115], a[164:167], a[228:231], 0
buffer_load_dwordx4 v13, s[36:39], s64 offen lds
v_mfma_f32_16x16x32_bf16 v[112:115], a[160:163], a[224:227], v[112:115]
s_add_u32 s65, s84, 65536
ds_read_b64_tr_b16 a[190:191], v185 offset:45056
v_mfma_f32_16x16x32_bf16 v[80:83], a[160:163], a[216:219], 0
buffer_load_dwordx4 a[0:3], v14, s[44:47], s65 offen offset:0 sc1
v_mfma_f32_16x16x32_bf16 v[80:83], a[164:167], a[220:223], v[80:83]
ds_read_b64_tr_b16 a[192:193], v186 offset:32768
v_mfma_f32_16x16x32_bf16 v[48:51], a[164:167], a[212:215], 0
buffer_load_dwordx4 a[8:11], v14, s[44:47], s65 offen offset:1024 sc1
v_mfma_f32_16x16x32_bf16 v[48:51], a[160:163], a[208:211], v[48:51]
s_waitcnt lgkmcnt(4)
ds_read_b64_tr_b16 a[194:195], v186 offset:36864
v_mfma_f32_16x16x32_bf16 v[52:55], a[168:171], a[208:211], 0
ds_read_b64_tr_b16 a[196:197], v186 offset:40960
v_mfma_f32_16x16x32_bf16 v[52:55], a[172:175], a[212:215], v[52:55]
buffer_load_dwordx4 a[16:19], v15, s[44:47], s65 offen offset:0 sc1
v_mfma_f32_16x16x32_bf16 v[84:87], a[172:175], a[220:223], 0
ds_read_b64_tr_b16 a[198:199], v186 offset:45056
v_mfma_f32_16x16x32_bf16 v[84:87], a[168:171], a[216:219], v[84:87]
buffer_load_dwordx4 a[24:27], v15, s[44:47], s65 offen offset:1024 sc1
v_mfma_f32_16x16x32_bf16 v[116:119], a[168:171], a[224:227], 0
s_add_u32 s65, s84, 73728
ds_read_b64_tr_b16 a[200:201], v187 offset:32768
v_mfma_f32_16x16x32_bf16 v[116:119], a[172:175], a[228:231], v[116:119]
buffer_load_dwordx4 a[4:7], v14, s[44:47], s65 offen offset:0 sc1
v_mfma_f32_16x16x32_bf16 v[148:151], a[172:175], a[236:239], 0
ds_read_b64_tr_b16 a[202:203], v187 offset:36864
v_mfma_f32_16x16x32_bf16 v[148:151], a[168:171], a[232:235], v[148:151]
ds_read_b64_tr_b16 a[204:205], v187 offset:40960
v_mfma_f32_16x16x32_bf16 v[120:123], a[176:179], a[232:235], 0
buffer_load_dwordx4 a[12:15], v14, s[44:47], s65 offen offset:1024 sc1
v_mfma_f32_16x16x32_bf16 v[120:123], a[180:183], a[236:239], v[120:123]
ds_read_b64_tr_b16 a[206:207], v187 offset:45056
v_mfma_f32_16x16x32_bf16 v[88:91], a[180:183], a[228:231], 0
buffer_load_dwordx4 a[20:23], v15, s[44:47], s65 offen offset:0 sc1
v_mfma_f32_16x16x32_bf16 v[88:91], a[176:179], a[224:227], v[88:91]
v_mfma_f32_16x16x32_bf16 v[56:59], a[176:179], a[216:219], 0
buffer_load_dwordx4 a[28:31], v15, s[44:47], s65 offen offset:1024 sc1
v_mfma_f32_16x16x32_bf16 v[56:59], a[180:183], a[220:223], v[56:59]
v_mfma_f32_16x16x32_bf16 v[24:27], a[180:183], a[212:215], 0
v_mfma_f32_16x16x32_bf16 v[24:27], a[176:179], a[208:211], v[24:27]
s_waitcnt lgkmcnt(1)
v_mfma_f32_16x16x32_bf16 v[28:31], a[184:187], a[208:211], 0
s_waitcnt vmcnt(23)
s_barrier
v_mfma_f32_16x16x32_bf16 v[28:31], a[188:191], a[212:215], v[28:31]
ds_read_b64_tr_b16 a[144:145], v196 offset:0
v_mfma_f32_16x16x32_bf16 v[60:63], a[188:191], a[220:223], 0
ds_read_b64_tr_b16 a[146:147], v196 offset:4096
v_mfma_f32_16x16x32_bf16 v[60:63], a[184:187], a[216:219], v[60:63]
s_add_u32 m0, s86, 0
ds_read_b64_tr_b16 a[148:149], v196 offset:8192
v_mfma_f32_16x16x32_bf16 v[92:95], a[184:187], a[224:227], 0
s_add_u32 s64, s85, 786432
ds_read_b64_tr_b16 a[150:151], v196 offset:12288
v_mfma_f32_16x16x32_bf16 v[92:95], a[188:191], a[228:231], v[92:95]
buffer_load_dwordx4 v12, s[36:39], s64 offen lds
v_mfma_f32_16x16x32_bf16 v[124:127], a[188:191], a[236:239], 0
s_add_u32 m0, s86, 1024
ds_read_b64_tr_b16 a[152:153], v197 offset:0
v_mfma_f32_16x16x32_bf16 v[124:127], a[184:187], a[232:235], v[124:127]
s_add_u32 s64, s85, 794624
ds_read_b64_tr_b16 a[154:155], v197 offset:4096
v_mfma_f32_16x16x32_bf16 v[128:131], a[192:195], a[232:235], 0
buffer_load_dwordx4 v13, s[36:39], s64 offen lds
v_mfma_f32_16x16x32_bf16 v[128:131], a[196:199], a[236:239], v[128:131]
ds_read_b64_tr_b16 a[156:157], v197 offset:8192
v_mfma_f32_16x16x32_bf16 v[96:99], a[196:199], a[228:231], 0
s_add_u32 m0, s86, 2048
ds_read_b64_tr_b16 a[158:159], v197 offset:12288
v_mfma_f32_16x16x32_bf16 v[96:99], a[192:195], a[224:227], v[96:99]
s_add_u32 s64, s85, 802816
ds_read_b64_tr_b16 a[160:161], v198 offset:0
v_mfma_f32_16x16x32_bf16 v[64:67], a[192:195], a[216:219], 0
buffer_load_dwordx4 v12, s[36:39], s64 offen lds
v_mfma_f32_16x16x32_bf16 v[64:67], a[196:199], a[220:223], v[64:67]
ds_read_b64_tr_b16 a[162:163], v198 offset:4096
v_mfma_f32_16x16x32_bf16 v[32:35], a[196:199], a[212:215], 0
s_add_u32 m0, s86, 3072
ds_read_b64_tr_b16 a[164:165], v198 offset:8192
v_mfma_f32_16x16x32_bf16 v[32:35], a[192:195], a[208:211], v[32:35]
s_add_u32 s64, s85, 811008
ds_read_b64_tr_b16 a[166:167], v198 offset:12288
v_mfma_f32_16x16x32_bf16 v[36:39], a[200:203], a[208:211], 0
s_waitcnt lgkmcnt(6)
buffer_load_dwordx4 v13, s[36:39], s64 offen lds
v_mfma_f32_16x16x32_bf16 v[36:39], a[204:207], a[212:215], v[36:39]
v_mfma_f32_16x16x32_bf16 v[68:71], a[204:207], a[220:223], 0
s_add_u32 m0, s86, 4096
v_mfma_f32_16x16x32_bf16 v[68:71], a[200:203], a[216:219], v[68:71]
s_add_u32 s64, s85, 819200
v_mfma_f32_16x16x32_bf16 v[100:103], a[200:203], a[224:227], 0
buffer_load_dwordx4 v12, s[36:39], s64 offen lds
v_mfma_f32_16x16x32_bf16 v[100:103], a[204:207], a[228:231], v[100:103]
v_mfma_f32_16x16x32_bf16 v[132:135], a[204:207], a[236:239], 0
v_mfma_f32_16x16x32_bf16 v[132:135], a[200:203], a[232:235], v[132:135]
v_mfma_f32_16x16x32_bf16 v[136:139], a[144:147], v[176:179], v[136:139]
s_add_u32 m0, s86, 5120
ds_read_b64_tr_b16 a[168:169], v199 offset:0
v_xor_b32 v200, 0x18000, v184
v_mfma_f32_16x16x32_bf16 v[136:139], a[148:151], v[180:183], v[136:139]
s_add_u32 s64, s85, 827392
ds_read_b64_tr_b16 a[170:171], v199 offset:4096
v_xor_b32 v201, 0x18000, v185
v_mfma_f32_16x16x32_bf16 v[104:107], a[148:151], v[172:175], v[104:107]
buffer_load_dwordx4 v13, s[36:39], s64 offen lds
v_mfma_f32_16x16x32_bf16 v[104:107], a[144:147], v[168:171], v[104:107]
s_add_u32 m0, s86, 6144
ds_read_b64_tr_b16 a[172:173], v199 offset:8192
v_xor_b32 v202, 0x18000, v186
v_mfma_f32_16x16x32_bf16 v[72:75], a[144:147], v[160:163], v[72:75]
s_add_u32 s64, s85, 835584
ds_read_b64_tr_b16 a[174:175], v199 offset:12288
v_xor_b32 v203, 0x18000, v187
v_mfma_f32_16x16x32_bf16 v[72:75], a[148:151], v[164:167], v[72:75]
buffer_load_dwordx4 v12, s[36:39], s64 offen lds
v_mfma_f32_16x16x32_bf16 v[40:43], a[148:151], v[156:159], v[40:43]
s_add_u32 m0, s86, 7168
ds_read_b64_tr_b16 a[176:177], v192 offset:0
v_xor_b32 v204, 0x18000, v188
v_mfma_f32_16x16x32_bf16 v[40:43], a[144:147], v[152:155], v[40:43]
s_add_u32 s64, s85, 843776
ds_read_b64_tr_b16 a[178:179], v192 offset:4096
v_xor_b32 v205, 0x18000, v189
v_mfma_f32_16x16x32_bf16 v[44:47], a[152:155], v[152:155], v[44:47]
s_waitcnt lgkmcnt(5)
buffer_load_dwordx4 v13, s[36:39], s64 offen lds
v_mfma_f32_16x16x32_bf16 v[44:47], a[156:159], v[156:159], v[44:47]
ds_read_b64_tr_b16 a[180:181], v192 offset:8192
v_xor_b32 v206, 0x18000, v190
v_mfma_f32_16x16x32_bf16 v[76:79], a[156:159], v[164:167], v[76:79]
ds_read_b64_tr_b16 a[182:183], v192 offset:12288
v_xor_b32 v207, 0x18000, v191
v_mfma_f32_16x16x32_bf16 v[76:79], a[152:155], v[160:163], v[76:79]
s_add_u32 s65, s84, 98304
ds_read_b64_tr_b16 a[184:185], v193 offset:0
v_mfma_f32_16x16x32_bf16 v[108:111], a[152:155], v[168:171], v[108:111]
buffer_load_dwordx4 a[64:67], v14, s[44:47], s65 offen offset:0 sc1
v_mfma_f32_16x16x32_bf16 v[108:111], a[156:159], v[172:175], v[108:111]
ds_read_b64_tr_b16 a[186:187], v193 offset:4096
v_mfma_f32_16x16x32_bf16 v[140:143], a[156:159], v[180:183], v[140:143]
ds_read_b64_tr_b16 a[188:189], v193 offset:8192
v_mfma_f32_16x16x32_bf16 v[140:143], a[152:155], v[176:179], v[140:143]
buffer_load_dwordx4 a[72:75], v14, s[44:47], s65 offen offset:1024 sc1
v_mfma_f32_16x16x32_bf16 v[144:147], a[160:163], v[176:179], v[144:147]
ds_read_b64_tr_b16 a[190:191], v193 offset:12288
v_mfma_f32_16x16x32_bf16 v[144:147], a[164:167], v[180:183], v[144:147]
v_mfma_f32_16x16x32_bf16 v[112:115], a[164:167], v[172:175], v[112:115]
buffer_load_dwordx4 a[80:83], v15, s[44:47], s65 offen offset:0 sc1
v_mfma_f32_16x16x32_bf16 v[112:115], a[160:163], v[168:171], v[112:115]
ds_read_b64_tr_b16 a[192:193], v194 offset:0
v_mfma_f32_16x16x32_bf16 v[80:83], a[160:163], v[160:163], v[80:83]
ds_read_b64_tr_b16 a[194:195], v194 offset:4096
v_mfma_f32_16x16x32_bf16 v[80:83], a[164:167], v[164:167], v[80:83]
ds_read_b64_tr_b16 a[196:197], v194 offset:8192
v_mfma_f32_16x16x32_bf16 v[48:51], a[164:167], v[156:159], v[48:51]
buffer_load_dwordx4 a[88:91], v15, s[44:47], s65 offen offset:1024 sc1
v_mfma_f32_16x16x32_bf16 v[48:51], a[160:163], v[152:155], v[48:51]
s_waitcnt lgkmcnt(4)
ds_read_b64_tr_b16 a[198:199], v194 offset:12288
v_mfma_f32_16x16x32_bf16 v[52:55], a[168:171], v[152:155], v[52:55]
s_add_u32 s65, s84, 106496
v_mfma_f32_16x16x32_bf16 v[52:55], a[172:175], v[156:159], v[52:55]
buffer_load_dwordx4 a[68:71], v14, s[44:47], s65 offen offset:0 sc1
v_mfma_f32_16x16x32_bf16 v[84:87], a[172:175], v[164:167], v[84:87]
ds_read_b64_tr_b16 a[200:201], v195 offset:0
v_mfma_f32_16x16x32_bf16 v[84:87], a[168:171], v[160:163], v[84:87]
ds_read_b64_tr_b16 a[202:203], v195 offset:4096
v_mfma_f32_16x16x32_bf16 v[116:119], a[168:171], v[168:171], v[116:119]
s_lshl_b32 s66, s30, 30
buffer_load_dwordx4 a[76:79], v14, s[44:47], s65 offen offset:1024 sc1
v_mfma_f32_16x16x32_bf16 v[116:119], a[172:175], v[172:175], v[116:119]
ds_read_b64_tr_b16 a[204:205], v195 offset:8192
v_lshl_add_u32 v1, v0, 24, s66
v_mfma_f32_16x16x32_bf16 v[148:151], a[172:175], v[180:183], v[148:151]
ds_read_b64_tr_b16 a[206:207], v195 offset:12288
v_mfma_f32_16x16x32_bf16 v[148:151], a[168:171], v[176:179], v[148:151]
v_mfma_f32_16x16x32_bf16 v[120:123], a[176:179], v[176:179], v[120:123]
buffer_load_dwordx4 a[84:87], v15, s[44:47], s65 offen offset:0 sc1
v_mfma_f32_16x16x32_bf16 v[120:123], a[180:183], v[180:183], v[120:123]
v_mfma_f32_16x16x32_bf16 v[88:91], a[180:183], v[172:175], v[88:91]
v_mfma_f32_16x16x32_bf16 v[88:91], a[176:179], v[168:171], v[88:91]
buffer_load_dwordx4 a[92:95], v15, s[44:47], s65 offen offset:1024 sc1
v_mfma_f32_16x16x32_bf16 v[56:59], a[176:179], v[160:163], v[56:59]
v_mfma_f32_16x16x32_bf16 v[56:59], a[180:183], v[164:167], v[56:59]
v_mfma_f32_16x16x32_bf16 v[24:27], a[180:183], v[156:159], v[24:27]
v_mfma_f32_16x16x32_bf16 v[24:27], a[176:179], v[152:155], v[24:27]
v_mfma_f32_16x16x32_bf16 v[28:31], a[184:187], v[152:155], v[28:31]
s_waitcnt vmcnt(24)
s_barrier
s_waitcnt lgkmcnt(0)
v_mfma_f32_16x16x32_bf16 v[28:31], a[188:191], v[156:159], v[28:31]
s_mov_b64 exec, 1
buffer_atomic_add a251, v1, s[52:55], s71 offen offset:0 sc1
s_mov_b64 exec, -1
v_mfma_f32_16x16x32_bf16 v[60:63], a[188:191], v[164:167], v[60:63]
ds_read_b64_tr_b16 a[144:145], v196 offset:32768
v_mfma_f32_16x16x32_bf16 v[60:63], a[184:187], v[160:163], v[60:63]
s_add_u32 m0, s86, 98304
ds_read_b64_tr_b16 a[146:147], v196 offset:36864
v_mfma_f32_16x16x32_bf16 v[92:95], a[184:187], v[168:171], v[92:95]
s_add_u32 s64, s85, 1048576
ds_read_b64_tr_b16 a[148:149], v196 offset:40960
v_mfma_f32_16x16x32_bf16 v[92:95], a[188:191], v[172:175], v[92:95]
buffer_load_dwordx4 v12, s[36:39], s64 offen lds
v_mfma_f32_16x16x32_bf16 v[124:127], a[188:191], v[180:183], v[124:127]
s_add_u32 m0, s86, 99328
ds_read_b64_tr_b16 a[150:151], v196 offset:45056
v_mfma_f32_16x16x32_bf16 v[124:127], a[184:187], v[176:179], v[124:127]
s_add_u32 s64, s85, 1056768
ds_read_b64_tr_b16 a[152:153], v197 offset:32768
v_mfma_f32_16x16x32_bf16 v[128:131], a[192:195], v[176:179], v[128:131]
buffer_load_dwordx4 v13, s[36:39], s64 offen lds
v_mfma_f32_16x16x32_bf16 v[128:131], a[196:199], v[180:183], v[128:131]
ds_read_b64_tr_b16 a[154:155], v197 offset:36864
v_mfma_f32_16x16x32_bf16 v[96:99], a[196:199], v[172:175], v[96:99]
s_add_u32 m0, s86, 100352
ds_read_b64_tr_b16 a[156:157], v197 offset:40960
v_mfma_f32_16x16x32_bf16 v[96:99], a[192:195], v[168:171], v[96:99]
s_add_u32 s64, s85, 1064960
ds_read_b64_tr_b16 a[158:159], v197 offset:45056
v_mfma_f32_16x16x32_bf16 v[64:67], a[192:195], v[160:163], v[64:67]
buffer_load_dwordx4 v12, s[36:39], s64 offen lds
v_mfma_f32_16x16x32_bf16 v[64:67], a[196:199], v[164:167], v[64:67]
ds_read_b64_tr_b16 a[160:161], v198 offset:32768
v_mfma_f32_16x16x32_bf16 v[32:35], a[196:199], v[156:159], v[32:35]
s_add_u32 m0, s86, 101376
ds_read_b64_tr_b16 a[162:163], v198 offset:36864
v_mfma_f32_16x16x32_bf16 v[32:35], a[192:195], v[152:155], v[32:35]
s_add_u32 s64, s85, 1073152
ds_read_b64_tr_b16 a[164:165], v198 offset:40960
v_mfma_f32_16x16x32_bf16 v[36:39], a[200:203], v[152:155], v[36:39]
buffer_load_dwordx4 v13, s[36:39], s64 offen lds
v_mfma_f32_16x16x32_bf16 v[36:39], a[204:207], v[156:159], v[36:39]
ds_read_b64_tr_b16 a[166:167], v198 offset:45056
v_mfma_f32_16x16x32_bf16 v[68:71], a[204:207], v[164:167], v[68:71]
s_add_u32 m0, s86, 102400
v_mfma_f32_16x16x32_bf16 v[68:71], a[200:203], v[160:163], v[68:71]
s_add_u32 s64, s85, 1081344
v_mfma_f32_16x16x32_bf16 v[100:103], a[200:203], v[168:171], v[100:103]
buffer_load_dwordx4 v12, s[36:39], s64 offen lds
v_mfma_f32_16x16x32_bf16 v[100:103], a[204:207], v[172:175], v[100:103]
v_mfma_f32_16x16x32_bf16 v[132:135], a[204:207], v[180:183], v[132:135]
v_mfma_f32_16x16x32_bf16 v[132:135], a[200:203], v[176:179], v[132:135]
s_waitcnt vmcnt(26)
s_waitcnt lgkmcnt(1)
v_mfma_f32_16x16x32_bf16 v[136:139], a[144:147], a[24:27], v[136:139]
s_waitcnt vmcnt(22)
s_add_u32 m0, s86, 103424
ds_read_b64_tr_b16 a[168:169], v199 offset:32768
v_mfma_f32_16x16x32_bf16 v[136:139], a[148:151], a[28:31], v[136:139]
s_add_u32 s64, s85, 1089536
ds_read_b64_tr_b16 a[170:171], v199 offset:36864
v_mfma_f32_16x16x32_bf16 v[104:107], a[148:151], a[20:23], v[104:107]
buffer_load_dwordx4 v13, s[36:39], s64 offen lds
v_mfma_f32_16x16x32_bf16 v[104:107], a[144:147], a[16:19], v[104:107]
s_add_u32 m0, s86, 104448
ds_read_b64_tr_b16 a[172:173], v199 offset:40960
v_mfma_f32_16x16x32_bf16 v[72:75], a[144:147], a[8:11], v[72:75]
s_add_u32 s64, s85, 1097728
ds_read_b64_tr_b16 a[174:175], v199 offset:45056
v_mfma_f32_16x16x32_bf16 v[72:75], a[148:151], a[12:15], v[72:75]
buffer_load_dwordx4 v12, s[36:39], s64 offen lds
v_mfma_f32_16x16x32_bf16 v[40:43], a[148:151], a[4:7], v[40:43]
s_add_u32 m0, s86, 105472
ds_read_b64_tr_b16 a[176:177], v192 offset:32768
v_mfma_f32_16x16x32_bf16 v[40:43], a[144:147], a[0:3], v[40:43]
s_add_u32 s64, s85, 1105920
ds_read_b64_tr_b16 a[178:179], v192 offset:36864
v_mfma_f32_16x16x32_bf16 v[44:47], a[152:155], a[0:3], v[44:47]
buffer_load_dwordx4 v13, s[36:39], s64 offen lds
v_mfma_f32_16x16x32_bf16 v[44:47], a[156:159], a[4:7], v[44:47]
ds_read_b64_tr_b16 a[180:181], v192 offset:40960
v_mfma_f32_16x16x32_bf16 v[76:79], a[156:159], a[12:15], v[76:79]
ds_read_b64_tr_b16 a[182:183], v192 offset:45056
v_mfma_f32_16x16x32_bf16 v[76:79], a[152:155], a[8:11], v[76:79]
s_add_u32 s65, s84, 131072
ds_read_b64_tr_b16 a[184:185], v193 offset:32768
v_mfma_f32_16x16x32_bf16 v[108:111], a[152:155], a[16:19], v[108:111]
buffer_load_dwordx4 a[32:35], v14, s[44:47], s65 offen offset:0 sc1
v_mfma_f32_16x16x32_bf16 v[108:111], a[156:159], a[20:23], v[108:111]
ds_read_b64_tr_b16 a[186:187], v193 offset:36864
v_mfma_f32_16x16x32_bf16 v[140:143], a[156:159], a[28:31], v[140:143]
ds_read_b64_tr_b16 a[188:189], v193 offset:40960
v_mfma_f32_16x16x32_bf16 v[140:143], a[152:155], a[24:27], v[140:143]
buffer_load_dwordx4 a[40:43], v14, s[44:47], s65 offen offset:1024 sc1
v_mfma_f32_16x16x32_bf16 v[144:147], a[160:163], a[24:27], v[144:147]
s_waitcnt lgkmcnt(5)
ds_read_b64_tr_b16 a[190:191], v193 offset:45056
v_mfma_f32_16x16x32_bf16 v[144:147], a[164:167], a[28:31], v[144:147]
v_mfma_f32_16x16x32_bf16 v[112:115], a[164:167], a[20:23], v[112:115]
buffer_load_dwordx4 a[48:51], v15, s[44:47], s65 offen offset:0 sc1
v_mfma_f32_16x16x32_bf16 v[112:115], a[160:163], a[16:19], v[112:115]
ds_read_b64_tr_b16 a[192:193], v194 offset:32768
v_mfma_f32_16x16x32_bf16 v[80:83], a[160:163], a[8:11], v[80:83]
ds_read_b64_tr_b16 a[194:195], v194 offset:36864
v_mfma_f32_16x16x32_bf16 v[80:83], a[164:167], a[12:15], v[80:83]
ds_read_b64_tr_b16 a[196:197], v194 offset:40960
v_mfma_f32_16x16x32_bf16 v[48:51], a[164:167], a[4:7], v[48:51]
buffer_load_dwordx4 a[56:59], v15, s[44:47], s65 offen offset:1024 sc1
v_mfma_f32_16x16x32_bf16 v[48:51], a[160:163], a[0:3], v[48:51]
ds_read_b64_tr_b16 a[198:199], v194 offset:45056
v_mfma_f32_16x16x32_bf16 v[52:55], a[168:171], a[0:3], v[52:55]
s_add_u32 s65, s84, 139264
v_mfma_f32_16x16x32_bf16 v[52:55], a[172:175], a[4:7], v[52:55]
buffer_load_dwordx4 a[36:39], v14, s[44:47], s65 offen offset:0 sc1
v_mfma_f32_16x16x32_bf16 v[84:87], a[172:175], a[12:15], v[84:87]
ds_read_b64_tr_b16 a[200:201], v195 offset:32768
v_mfma_f32_16x16x32_bf16 v[84:87], a[168:171], a[8:11], v[84:87]
ds_read_b64_tr_b16 a[202:203], v195 offset:36864
v_mfma_f32_16x16x32_bf16 v[116:119], a[168:171], a[16:19], v[116:119]
buffer_load_dwordx4 a[44:47], v14, s[44:47], s65 offen offset:1024 sc1
v_mfma_f32_16x16x32_bf16 v[116:119], a[172:175], a[20:23], v[116:119]
ds_read_b64_tr_b16 a[204:205], v195 offset:40960
v_mfma_f32_16x16x32_bf16 v[148:151], a[172:175], a[28:31], v[148:151]
ds_read_b64_tr_b16 a[206:207], v195 offset:45056
v_mfma_f32_16x16x32_bf16 v[148:151], a[168:171], a[24:27], v[148:151]
v_mfma_f32_16x16x32_bf16 v[120:123], a[176:179], a[24:27], v[120:123]
s_waitcnt lgkmcnt(4)
buffer_load_dwordx4 a[52:55], v15, s[44:47], s65 offen offset:0 sc1
v_mfma_f32_16x16x32_bf16 v[120:123], a[180:183], a[28:31], v[120:123]
v_mfma_f32_16x16x32_bf16 v[88:91], a[180:183], a[20:23], v[88:91]
v_mfma_f32_16x16x32_bf16 v[88:91], a[176:179], a[16:19], v[88:91]
buffer_load_dwordx4 a[60:63], v15, s[44:47], s65 offen offset:1024 sc1
v_mfma_f32_16x16x32_bf16 v[56:59], a[176:179], a[8:11], v[56:59]
v_mfma_f32_16x16x32_bf16 v[56:59], a[180:183], a[12:15], v[56:59]
v_mfma_f32_16x16x32_bf16 v[24:27], a[180:183], a[4:7], v[24:27]
v_mfma_f32_16x16x32_bf16 v[24:27], a[176:179], a[0:3], v[24:27]
v_mfma_f32_16x16x32_bf16 v[28:31], a[184:187], a[0:3], v[28:31]
s_waitcnt vmcnt(25)
s_barrier
v_mfma_f32_16x16x32_bf16 v[28:31], a[188:191], a[4:7], v[28:31]
ds_read_b64_tr_b16 a[144:145], v204 offset:0
v_mfma_f32_16x16x32_bf16 v[60:63], a[188:191], a[12:15], v[60:63]
ds_read_b64_tr_b16 a[146:147], v204 offset:4096
v_mfma_f32_16x16x32_bf16 v[60:63], a[184:187], a[8:11], v[60:63]
s_add_u32 m0, s86, 131072
ds_read_b64_tr_b16 a[148:149], v204 offset:8192
v_mfma_f32_16x16x32_bf16 v[92:95], a[184:187], a[16:19], v[92:95]
s_add_u32 s64, s85, 0
ds_read_b64_tr_b16 a[150:151], v204 offset:12288
v_mfma_f32_16x16x32_bf16 v[92:95], a[188:191], a[20:23], v[92:95]
buffer_load_dwordx4 v12, s[40:43], s64 offen lds
v_mfma_f32_16x16x32_bf16 v[124:127], a[188:191], a[28:31], v[124:127]
s_add_u32 m0, s86, 132096
ds_read_b64_tr_b16 a[152:153], v205 offset:0
v_mfma_f32_16x16x32_bf16 v[124:127], a[184:187], a[24:27], v[124:127]
s_add_u32 s64, s85, 8192
ds_read_b64_tr_b16 a[154:155], v205 offset:4096
v_mfma_f32_16x16x32_bf16 v[128:131], a[192:195], a[24:27], v[128:131]
buffer_load_dwordx4 v13, s[40:43], s64 offen lds
v_mfma_f32_16x16x32_bf16 v[128:131], a[196:199], a[28:31], v[128:131]
ds_read_b64_tr_b16 a[156:157], v205 offset:8192
v_mfma_f32_16x16x32_bf16 v[96:99], a[196:199], a[20:23], v[96:99]
s_add_u32 m0, s86, 133120
ds_read_b64_tr_b16 a[158:159], v205 offset:12288
v_mfma_f32_16x16x32_bf16 v[96:99], a[192:195], a[16:19], v[96:99]
s_add_u32 s64, s85, 16384
ds_read_b64_tr_b16 a[160:161], v206 offset:0
v_mfma_f32_16x16x32_bf16 v[64:67], a[192:195], a[8:11], v[64:67]
buffer_load_dwordx4 v12, s[40:43], s64 offen lds
v_mfma_f32_16x16x32_bf16 v[64:67], a[196:199], a[12:15], v[64:67]
ds_read_b64_tr_b16 a[162:163], v206 offset:4096
v_mfma_f32_16x16x32_bf16 v[32:35], a[196:199], a[4:7], v[32:35]
s_add_u32 m0, s86, 134144
ds_read_b64_tr_b16 a[164:165], v206 offset:8192
v_mfma_f32_16x16x32_bf16 v[32:35], a[192:195], a[0:3], v[32:35]
s_waitcnt lgkmcnt(5)
s_add_u32 s64, s85, 24576
ds_read_b64_tr_b16 a[166:167], v206 offset:12288
v_mfma_f32_16x16x32_bf16 v[36:39], a[200:203], a[0:3], v[36:39]
buffer_load_dwordx4 v13, s[40:43], s64 offen lds
v_mfma_f32_16x16x32_bf16 v[36:39], a[204:207], a[4:7], v[36:39]
v_mfma_f32_16x16x32_bf16 v[68:71], a[204:207], a[12:15], v[68:71]
s_add_u32 m0, s86, 135168
v_mfma_f32_16x16x32_bf16 v[68:71], a[200:203], a[8:11], v[68:71]
s_add_u32 s64, s85, 32768
v_mfma_f32_16x16x32_bf16 v[100:103], a[200:203], a[16:19], v[100:103]
buffer_load_dwordx4 v12, s[40:43], s64 offen lds
v_mfma_f32_16x16x32_bf16 v[100:103], a[204:207], a[20:23], v[100:103]
v_mfma_f32_16x16x32_bf16 v[132:135], a[204:207], a[28:31], v[132:135]
v_mfma_f32_16x16x32_bf16 v[132:135], a[200:203], a[24:27], v[132:135]
s_waitcnt vmcnt(26)
v_mfma_f32_16x16x32_bf16 v[136:139], a[144:147], a[88:91], v[136:139]
s_waitcnt vmcnt(22)
s_add_u32 m0, s86, 136192
ds_read_b64_tr_b16 a[168:169], v207 offset:0
v_mfma_f32_16x16x32_bf16 v[136:139], a[148:151], a[92:95], v[136:139]
s_add_u32 s64, s85, 40960
ds_read_b64_tr_b16 a[170:171], v207 offset:4096
v_mfma_f32_16x16x32_bf16 v[104:107], a[148:151], a[84:87], v[104:107]
buffer_load_dwordx4 v13, s[40:43], s64 offen lds
v_mfma_f32_16x16x32_bf16 v[104:107], a[144:147], a[80:83], v[104:107]
ds_read_b64_tr_b16 a[172:173], v207 offset:8192
v_mfma_f32_16x16x32_bf16 v[72:75], a[144:147], a[72:75], v[72:75]
ds_read_b64_tr_b16 a[174:175], v207 offset:12288
v_mfma_f32_16x16x32_bf16 v[72:75], a[148:151], a[76:79], v[72:75]
ds_read_b64_tr_b16 a[176:177], v200 offset:0
v_mfma_f32_16x16x32_bf16 v[40:43], a[148:151], a[68:71], v[40:43]
ds_read_b64_tr_b16 a[178:179], v200 offset:4096
v_mfma_f32_16x16x32_bf16 v[40:43], a[144:147], a[64:67], v[40:43]
ds_read_b64_tr_b16 a[180:181], v200 offset:8192
v_mfma_f32_16x16x32_bf16 v[44:47], a[152:155], a[64:67], v[44:47]
s_waitcnt lgkmcnt(6)
s_add_u32 m0, s86, 137216
ds_read_b64_tr_b16 a[182:183], v200 offset:12288
v_mfma_f32_16x16x32_bf16 v[44:47], a[156:159], a[68:71], v[44:47]
s_add_u32 s64, s85, 49152
v_mfma_f32_16x16x32_bf16 v[76:79], a[156:159], a[76:79], v[76:79]
buffer_load_dwordx4 v12, s[40:43], s64 offen lds
v_mfma_f32_16x16x32_bf16 v[76:79], a[152:155], a[72:75], v[76:79]
ds_read_b64_tr_b16 a[184:185], v201 offset:0
v_mfma_f32_16x16x32_bf16 v[108:111], a[152:155], a[80:83], v[108:111]
ds_read_b64_tr_b16 a[186:187], v201 offset:4096
v_mfma_f32_16x16x32_bf16 v[108:111], a[156:159], a[84:87], v[108:111]
ds_read_b64_tr_b16 a[188:189], v201 offset:8192
v_mfma_f32_16x16x32_bf16 v[140:143], a[156:159], a[92:95], v[140:143]
ds_read_b64_tr_b16 a[190:191], v201 offset:12288
v_mfma_f32_16x16x32_bf16 v[140:143], a[152:155], a[88:91], v[140:143]
v_mfma_f32_16x16x32_bf16 v[144:147], a[160:163], a[88:91], v[144:147]
v_mfma_f32_16x16x32_bf16 v[144:147], a[164:167], a[92:95], v[144:147]
s_add_u32 m0, s86, 138240
s_add_u32 s17, s78, L_p5loop-L_pc+0
v_mfma_f32_16x16x32_bf16 v[112:115], a[164:167], a[84:87], v[112:115]
s_add_u32 s64, s85, 57344
buffer_load_dword a252, v16, s[88:91], s17 offen
v_mfma_f32_16x16x32_bf16 v[112:115], a[160:163], a[80:83], v[112:115]
buffer_load_dwordx4 v13, s[40:43], s64 offen lds
v_mfma_f32_16x16x32_bf16 v[80:83], a[160:163], a[72:75], v[80:83]
s_add_u32 s17, s78, L_p5loop-L_pc+4096
ds_read_b64_tr_b16 a[192:193], v202 offset:0
v_mfma_f32_16x16x32_bf16 v[80:83], a[164:167], a[76:79], v[80:83]
buffer_load_dword a252, v16, s[88:91], s17 offen
v_mfma_f32_16x16x32_bf16 v[48:51], a[164:167], a[68:71], v[48:51]
ds_read_b64_tr_b16 a[194:195], v202 offset:4096
v_mfma_f32_16x16x32_bf16 v[48:51], a[160:163], a[64:67], v[48:51]
s_waitcnt lgkmcnt(2)
s_add_u32 s17, s78, L_p5loop-L_pc+8192
ds_read_b64_tr_b16 a[196:197], v202 offset:8192
v_mfma_f32_16x16x32_bf16 v[52:55], a[168:171], a[64:67], v[52:55]
buffer_load_dword a252, v16, s[88:91], s17 offen
v_mfma_f32_16x16x32_bf16 v[52:55], a[172:175], a[68:71], v[52:55]
ds_read_b64_tr_b16 a[198:199], v202 offset:12288
v_mfma_f32_16x16x32_bf16 v[84:87], a[172:175], a[76:79], v[84:87]
ds_read_b64_tr_b16 a[200:201], v203 offset:0
v_mfma_f32_16x16x32_bf16 v[84:87], a[168:171], a[72:75], v[84:87]
ds_read_b64_tr_b16 a[202:203], v203 offset:4096
v_mfma_f32_16x16x32_bf16 v[116:119], a[168:171], a[80:83], v[116:119]
ds_read_b64_tr_b16 a[204:205], v203 offset:8192
v_mfma_f32_16x16x32_bf16 v[116:119], a[172:175], a[84:87], v[116:119]
ds_read_b64_tr_b16 a[206:207], v203 offset:12288
v_mfma_f32_16x16x32_bf16 v[148:151], a[172:175], a[92:95], v[148:151]
buffer_load_dword v19, off, s[52:55], s72 sc1
v_mfma_f32_16x16x32_bf16 v[148:151], a[168:171], a[88:91], v[148:151]
v_mfma_f32_16x16x32_bf16 v[120:123], a[176:179], a[88:91], v[120:123]
v_mfma_f32_16x16x32_bf16 v[120:123], a[180:183], a[92:95], v[120:123]
v_mfma_f32_16x16x32_bf16 v[88:91], a[180:183], a[84:87], v[88:91]
v_mfma_f32_16x16x32_bf16 v[88:91], a[176:179], a[80:83], v[88:91]
v_mfma_f32_16x16x32_bf16 v[56:59], a[176:179], a[72:75], v[56:59]
v_mfma_f32_16x16x32_bf16 v[56:59], a[180:183], a[76:79], v[56:59]
v_mfma_f32_16x16x32_bf16 v[24:27], a[180:183], a[68:71], v[24:27]
v_mfma_f32_16x16x32_bf16 v[24:27], a[176:179], a[64:67], v[24:27]
v_mfma_f32_16x16x32_bf16 v[28:31], a[184:187], a[64:67], v[28:31]
s_waitcnt vmcnt(20)
s_barrier
v_mfma_f32_16x16x32_bf16 v[28:31], a[188:191], a[68:71], v[28:31]
ds_read_b64_tr_b16 a[144:145], v188 offset:0
v_mfma_f32_16x16x32_bf16 v[60:63], a[188:191], a[76:79], v[60:63]
ds_read_b64_tr_b16 a[146:147], v188 offset:4096
v_mfma_f32_16x16x32_bf16 v[60:63], a[184:187], a[72:75], v[60:63]
s_add_u32 m0, s86, 32768
ds_read_b64_tr_b16 a[148:149], v188 offset:8192
v_mfma_f32_16x16x32_bf16 v[92:95], a[184:187], a[80:83], v[92:95]
s_add_u32 s64, s85, 262144
ds_read_b64_tr_b16 a[150:151], v188 offset:12288
v_mfma_f32_16x16x32_bf16 v[92:95], a[188:191], a[84:87], v[92:95]
buffer_load_dwordx4 v12, s[40:43], s64 offen lds
v_mfma_f32_16x16x32_bf16 v[124:127], a[188:191], a[92:95], v[124:127]
s_add_u32 m0, s86, 33792
ds_read_b64_tr_b16 a[152:153], v189 offset:0
v_mfma_f32_16x16x32_bf16 v[124:127], a[184:187], a[88:91], v[124:127]
s_waitcnt lgkmcnt(5)
s_add_u32 s64, s85, 270336
ds_read_b64_tr_b16 a[154:155], v189 offset:4096
v_mfma_f32_16x16x32_bf16 v[128:131], a[192:195], a[88:91], v[128:131]
buffer_load_dwordx4 v13, s[40:43], s64 offen lds
v_mfma_f32_16x16x32_bf16 v[128:131], a[196:199], a[92:95], v[128:131]
s_add_u32 m0, s86, 34816
ds_read_b64_tr_b16 a[156:157], v189 offset:8192
v_mfma_f32_16x16x32_bf16 v[96:99], a[196:199], a[84:87], v[96:99]
s_add_u32 s64, s85, 278528
ds_read_b64_tr_b16 a[158:159], v189 offset:12288
v_mfma_f32_16x16x32_bf16 v[96:99], a[192:195], a[80:83], v[96:99]
buffer_load_dwordx4 v12, s[40:43], s64 offen lds
v_mfma_f32_16x16x32_bf16 v[64:67], a[192:195], a[72:75], v[64:67]
s_add_u32 m0, s86, 35840
ds_read_b64_tr_b16 a[160:161], v190 offset:0
v_mfma_f32_16x16x32_bf16 v[64:67], a[196:199], a[76:79], v[64:67]
s_add_u32 s64, s85, 286720
ds_read_b64_tr_b16 a[162:163], v190 offset:4096
v_mfma_f32_16x16x32_bf16 v[32:35], a[196:199], a[68:71], v[32:35]
buffer_load_dwordx4 v13, s[40:43], s64 offen lds
v_mfma_f32_16x16x32_bf16 v[32:35], a[192:195], a[64:67], v[32:35]
s_add_u32 m0, s86, 36864
ds_read_b64_tr_b16 a[164:165], v190 offset:8192
v_mfma_f32_16x16x32_bf16 v[36:39], a[200:203], a[64:67], v[36:39]
s_add_u32 s64, s85, 294912
ds_read_b64_tr_b16 a[166:167], v190 offset:12288
v_mfma_f32_16x16x32_bf16 v[36:39], a[204:207], a[68:71], v[36:39]
buffer_load_dwordx4 v12, s[40:43], s64 offen lds
v_mfma_f32_16x16x32_bf16 v[68:71], a[204:207], a[76:79], v[68:71]
s_add_u32 m0, s86, 37888
v_mfma_f32_16x16x32_bf16 v[68:71], a[200:203], a[72:75], v[68:71]
s_add_u32 s64, s85, 303104
v_mfma_f32_16x16x32_bf16 v[100:103], a[200:203], a[80:83], v[100:103]
buffer_load_dwordx4 v13, s[40:43], s64 offen lds
v_mfma_f32_16x16x32_bf16 v[100:103], a[204:207], a[84:87], v[100:103]
v_mfma_f32_16x16x32_bf16 v[132:135], a[204:207], a[92:95], v[132:135]
v_mfma_f32_16x16x32_bf16 v[132:135], a[200:203], a[88:91], v[132:135]
s_waitcnt vmcnt(22)
s_waitcnt lgkmcnt(1)
v_mfma_f32_16x16x32_bf16 v[136:139], a[144:147], a[56:59], v[136:139]
s_waitcnt vmcnt(6)
v_readfirstlane_b32 vcc_lo, v19
s_nop 0
s_cmp_lt_u32 vcc_lo, 8
s_cbranch_scc1 L_spin_3019
L_spinbk_3020:
s_sub_u32 s84, s84, 1048576
v_mfma_f32_16x16x32_bf16 v[136:139], a[148:151], a[60:63], v[136:139]
s_add_u32 s65, s84, 0
ds_read_b64_tr_b16 a[168:169], v191 offset:0
v_mfma_f32_16x16x32_bf16 v[104:107], a[148:151], a[52:55], v[104:107]
buffer_load_dwordx4 a[208:211], v14, s[44:47], s65 offen offset:0 sc1
v_mfma_f32_16x16x32_bf16 v[104:107], a[144:147], a[48:51], v[104:107]
ds_read_b64_tr_b16 a[170:171], v191 offset:4096
v_mfma_f32_16x16x32_bf16 v[72:75], a[144:147], a[40:43], v[72:75]
buffer_load_dwordx4 a[216:219], v14, s[44:47], s65 offen offset:1024 sc1
v_mfma_f32_16x16x32_bf16 v[72:75], a[148:151], a[44:47], v[72:75]
ds_read_b64_tr_b16 a[172:173], v191 offset:8192
v_mfma_f32_16x16x32_bf16 v[40:43], a[148:151], a[36:39], v[40:43]
buffer_load_dwordx4 a[224:227], v15, s[44:47], s65 offen offset:0 sc1
v_mfma_f32_16x16x32_bf16 v[40:43], a[144:147], a[32:35], v[40:43]
ds_read_b64_tr_b16 a[174:175], v191 offset:12288
v_mfma_f32_16x16x32_bf16 v[44:47], a[152:155], a[32:35], v[44:47]
buffer_load_dwordx4 a[232:235], v15, s[44:47], s65 offen offset:1024 sc1
v_mfma_f32_16x16x32_bf16 v[44:47], a[156:159], a[36:39], v[44:47]
s_add_u32 s65, s84, 8192
ds_read_b64_tr_b16 a[176:177], v184 offset:0
v_mfma_f32_16x16x32_bf16 v[76:79], a[156:159], a[44:47], v[76:79]
buffer_load_dwordx4 a[212:215], v14, s[44:47], s65 offen offset:0 sc1
v_mfma_f32_16x16x32_bf16 v[76:79], a[152:155], a[40:43], v[76:79]
ds_read_b64_tr_b16 a[178:179], v184 offset:4096
v_mfma_f32_16x16x32_bf16 v[108:111], a[152:155], a[48:51], v[108:111]
buffer_load_dwordx4 a[220:223], v14, s[44:47], s65 offen offset:1024 sc1
v_mfma_f32_16x16x32_bf16 v[108:111], a[156:159], a[52:55], v[108:111]
ds_read_b64_tr_b16 a[180:181], v184 offset:8192
v_mfma_f32_16x16x32_bf16 v[140:143], a[156:159], a[60:63], v[140:143]
buffer_load_dwordx4 a[228:231], v15, s[44:47], s65 offen offset:0 sc1
v_mfma_f32_16x16x32_bf16 v[140:143], a[152:155], a[56:59], v[140:143]
ds_read_b64_tr_b16 a[182:183], v184 offset:12288
v_mfma_f32_16x16x32_bf16 v[144:147], a[160:163], a[56:59], v[144:147]
s_waitcnt lgkmcnt(4)
buffer_load_dwordx4 a[236:239], v15, s[44:47], s65 offen offset:1024 sc1
v_mfma_f32_16x16x32_bf16 v[144:147], a[164:167], a[60:63], v[144:147]
s_add_u32 m0, s86, 38912
s_add_u32 s64, s85, 311296
ds_read_b64_tr_b16 a[184:185], v185 offset:0
v_mfma_f32_16x16x32_bf16 v[112:115], a[164:167], a[52:55], v[112:115]
buffer_load_dwordx4 v12, s[40:43], s64 offen lds
v_mfma_f32_16x16x32_bf16 v[112:115], a[160:163], a[48:51], v[112:115]
s_add_u32 m0, s86, 39936
s_add_u32 s64, s85, 319488
ds_read_b64_tr_b16 a[186:187], v185 offset:4096
v_mfma_f32_16x16x32_bf16 v[80:83], a[160:163], a[40:43], v[80:83]
buffer_load_dwordx4 v13, s[40:43], s64 offen lds
v_mfma_f32_16x16x32_bf16 v[80:83], a[164:167], a[44:47], v[80:83]
s_add_u32 s65, s84, 32768
ds_read_b64_tr_b16 a[188:189], v185 offset:8192
v_mfma_f32_16x16x32_bf16 v[48:51], a[164:167], a[36:39], v[48:51]
buffer_load_dwordx4 v[152:155], v14, s[44:47], s65 offen offset:0 sc1
v_mfma_f32_16x16x32_bf16 v[48:51], a[160:163], a[32:35], v[48:51]
ds_read_b64_tr_b16 a[190:191], v185 offset:12288
v_mfma_f32_16x16x32_bf16 v[52:55], a[168:171], a[32:35], v[52:55]
buffer_load_dwordx4 v[160:163], v14, s[44:47], s65 offen offset:1024 sc1
v_mfma_f32_16x16x32_bf16 v[52:55], a[172:175], a[36:39], v[52:55]
ds_read_b64_tr_b16 a[192:193], v186 offset:0
v_mfma_f32_16x16x32_bf16 v[84:87], a[172:175], a[44:47], v[84:87]
buffer_load_dwordx4 v[168:171], v15, s[44:47], s65 offen offset:0 sc1
v_mfma_f32_16x16x32_bf16 v[84:87], a[168:171], a[40:43], v[84:87]
ds_read_b64_tr_b16 a[194:195], v186 offset:4096
v_mfma_f32_16x16x32_bf16 v[116:119], a[168:171], a[48:51], v[116:119]
buffer_load_dwordx4 v[176:179], v15, s[44:47], s65 offen offset:1024 sc1
v_mfma_f32_16x16x32_bf16 v[116:119], a[172:175], a[52:55], v[116:119]
s_add_u32 s65, s84, 40960
ds_read_b64_tr_b16 a[196:197], v186 offset:8192
v_mfma_f32_16x16x32_bf16 v[148:151], a[172:175], a[60:63], v[148:151]
buffer_load_dwordx4 v[156:159], v14, s[44:47], s65 offen offset:0 sc1
v_mfma_f32_16x16x32_bf16 v[148:151], a[168:171], a[56:59], v[148:151]
s_waitcnt lgkmcnt(3)
ds_read_b64_tr_b16 a[198:199], v186 offset:12288
v_mfma_f32_16x16x32_bf16 v[120:123], a[176:179], a[56:59], v[120:123]
buffer_load_dwordx4 v[164:167], v14, s[44:47], s65 offen offset:1024 sc1
v_mfma_f32_16x16x32_bf16 v[120:123], a[180:183], a[60:63], v[120:123]
ds_read_b64_tr_b16 a[200:201], v187 offset:0
v_mfma_f32_16x16x32_bf16 v[88:91], a[180:183], a[52:55], v[88:91]
buffer_load_dwordx4 v[172:175], v15, s[44:47], s65 offen offset:0 sc1
v_mfma_f32_16x16x32_bf16 v[88:91], a[176:179], a[48:51], v[88:91]
ds_read_b64_tr_b16 a[202:203], v187 offset:4096
v_mfma_f32_16x16x32_bf16 v[56:59], a[176:179], a[40:43], v[56:59]
buffer_load_dwordx4 v[180:183], v15, s[44:47], s65 offen offset:1024 sc1
v_mfma_f32_16x16x32_bf16 v[56:59], a[180:183], a[44:47], v[56:59]
ds_read_b64_tr_b16 a[204:205], v187 offset:8192
v_mfma_f32_16x16x32_bf16 v[24:27], a[180:183], a[36:39], v[24:27]
ds_read_b64_tr_b16 a[206:207], v187 offset:12288
v_mfma_f32_16x16x32_bf16 v[24:27], a[176:179], a[32:35], v[24:27]
v_mfma_f32_16x16x32_bf16 v[28:31], a[184:187], a[32:35], v[28:31]
s_barrier
v_mfma_f32_16x16x32_bf16 v[28:31], a[188:191], a[36:39], v[28:31]
ds_read_b64_tr_b16 a[144:145], v188 offset:32768
v_mfma_f32_16x16x32_bf16 v[60:63], a[188:191], a[44:47], v[60:63]
ds_read_b64_tr_b16 a[146:147], v188 offset:36864
v_mfma_f32_16x16x32_bf16 v[60:63], a[184:187], a[40:43], v[60:63]
s_add_u32 m0, s86, 65536
ds_read_b64_tr_b16 a[148:149], v188 offset:40960
v_mfma_f32_16x16x32_bf16 v[92:95], a[184:187], a[48:51], v[92:95]
s_add_u32 s64, s85, 524288
ds_read_b64_tr_b16 a[150:151], v188 offset:45056
v_mfma_f32_16x16x32_bf16 v[92:95], a[188:191], a[52:55], v[92:95]
buffer_load_dwordx4 v12, s[40:43], s64 offen lds
v_mfma_f32_16x16x32_bf16 v[124:127], a[188:191], a[60:63], v[124:127]
s_add_u32 m0, s86, 66560
ds_read_b64_tr_b16 a[152:153], v189 offset:32768
v_mfma_f32_16x16x32_bf16 v[124:127], a[184:187], a[56:59], v[124:127]
s_waitcnt lgkmcnt(5)
s_add_u32 s64, s85, 532480
ds_read_b64_tr_b16 a[154:155], v189 offset:36864
v_mfma_f32_16x16x32_bf16 v[128:131], a[192:195], a[56:59], v[128:131]
buffer_load_dwordx4 v13, s[40:43], s64 offen lds
v_mfma_f32_16x16x32_bf16 v[128:131], a[196:199], a[60:63], v[128:131]
ds_read_b64_tr_b16 a[156:157], v189 offset:40960
v_mfma_f32_16x16x32_bf16 v[96:99], a[196:199], a[52:55], v[96:99]
s_add_u32 m0, s86, 67584
ds_read_b64_tr_b16 a[158:159], v189 offset:45056
v_mfma_f32_16x16x32_bf16 v[96:99], a[192:195], a[48:51], v[96:99]
s_add_u32 s64, s85, 540672
ds_read_b64_tr_b16 a[160:161], v190 offset:32768
v_mfma_f32_16x16x32_bf16 v[64:67], a[192:195], a[40:43], v[64:67]
buffer_load_dwordx4 v12, s[40:43], s64 offen lds
v_mfma_f32_16x16x32_bf16 v[64:67], a[196:199], a[44:47], v[64:67]
ds_read_b64_tr_b16 a[162:163], v190 offset:36864
v_mfma_f32_16x16x32_bf16 v[32:35], a[196:199], a[36:39], v[32:35]
s_add_u32 m0, s86, 68608
ds_read_b64_tr_b16 a[164:165], v190 offset:40960
v_mfma_f32_16x16x32_bf16 v[32:35], a[192:195], a[32:35], v[32:35]
s_add_u32 s64, s85, 548864
ds_read_b64_tr_b16 a[166:167], v190 offset:45056
v_mfma_f32_16x16x32_bf16 v[36:39], a[200:203], a[32:35], v[36:39]
buffer_load_dwordx4 v13, s[40:43], s64 offen lds
v_mfma_f32_16x16x32_bf16 v[36:39], a[204:207], a[36:39], v[36:39]
v_mfma_f32_16x16x32_bf16 v[68:71], a[204:207], a[44:47], v[68:71]
s_add_u32 m0, s86, 69632
v_mfma_f32_16x16x32_bf16 v[68:71], a[200:203], a[40:43], v[68:71]
s_add_u32 s64, s85, 557056
v_mfma_f32_16x16x32_bf16 v[100:103], a[200:203], a[48:51], v[100:103]
buffer_load_dwordx4 v12, s[40:43], s64 offen lds
v_mfma_f32_16x16x32_bf16 v[100:103], a[204:207], a[52:55], v[100:103]
s_mov_b32 s70, 3
s_mov_b32 s73, 2
v_mfma_f32_16x16x32_bf16 v[132:135], a[204:207], a[60:63], v[132:135]
v_mfma_f32_16x16x32_bf16 v[132:135], a[200:203], a[56:59], v[132:135]
s_branch L_p5join
L_spin_4022:
s_mov_b32 vcc_hi, 0x80000
L_spinlp_4024:
s_sleep 1
buffer_load_dword v19, off, s[52:55], s72 offset:128 sc1
s_waitcnt vmcnt(0)
v_readfirstlane_b32 vcc_lo, v19
s_sub_u32 vcc_hi, vcc_hi, 1
s_cbranch_scc1 L_spinbk_4023
s_cmp_lt_u32 vcc_lo, s74
s_cbranch_scc1 L_spinlp_4024
s_branch L_spinbk_4023
L_codeend:
.section .rodata,"a"
.p2align 6
.amdhsa_kernel gated_mix__compressed_kv_cla__sliding_local_dilated__prompt_kernel
  .amdhsa_next_free_vgpr 512
  .amdhsa_next_free_sgpr 102
  .amdhsa_accum_offset 256
  .amdhsa_group_segment_fixed_size 0
  .amdhsa_kernarg_size 104
  .amdhsa_user_sgpr_count 2
  .amdhsa_user_sgpr_kernarg_segment_ptr 1
  .amdhsa_system_sgpr_workgroup_id_x 1
.end_amdhsa_kernel
```

```asm
; @launch grid=(256,1,1) block=(256,1,1) lds=163840
.amdgcn_target "amdgcn-amd-amdhsa--gfx950"
.text
.globl gated_mix__compressed_kv_cla__sliding_local_dilated__prompt_kernel
.p2align 8
.type gated_mix__compressed_kv_cla__sliding_local_dilated__prompt_kernel,@function
gated_mix__compressed_kv_cla__sliding_local_dilated__prompt_kernel:
s_cmp_ge_u32 s2, 256
s_cbranch_scc1 L_end
s_load_dwordx16 s[4:19], s[0:1], 0
s_load_dwordx8 s[20:27], s[0:1], 64
s_load_dwordx2 s[28:29], s[0:1], 96
s_getpc_b64 s[88:89]
L_pc:
v_lshrrev_b32 v1, 6, v0
s_lshr_b32 s67, s2, 3
v_lshl_add_u32 v24, s67, 2, v1
s_mov_b32 s90, L_codeend-L_pc
s_mov_b32 s91, 0x20000
v_and_b32 v25, 7, v0
v_lshlrev_b32 v25, 7, v25
v_lshl_add_u32 v24, v24, 10, v25
buffer_load_dword a252, v24, s[88:91], 0 offen
v_and_b32 v0, 63, v0
v_readfirstlane_b32 s30, v1
v_lshrrev_b32 v24, 3, v0
v_lshrrev_b32 v25, 4, v0
v_and_b32 v26, 7, v0
v_xor_b32 v26, v26, v25
v_lshlrev_b32 v26, 4, v26
v_lshl_add_u32 v12, v24, 10, v26
v_xor_b32 v13, 64, v12
v_bfe_u32 v26, v0, 1, 3
v_xor_b32 v26, v26, v25
v_lshlrev_b32 v26, 5, v26
v_and_b32 v24, 1, v0
v_lshl_add_u32 v26, v24, 4, v26
v_lshl_add_u32 v14, v25, 13, v26
v_xor_b32 v15, 128, v14
s_and_b32 s66, s2, 7
s_and_b32 s68, s67, 3
s_lshl2_add_u32 s31, s66, s68
s_cmp_eq_u32 s68, 0
s_cselect_b32 s90, s90, 0
s_lshr_b32 s3, s67, 2
s_lshl2_add_u32 s80, s67, s30
s_lshl_b32 s70, s3, 18
s_lshl_b32 s66, s30, 16
s_add_u32 s70, s70, s66
s_lshl_b32 s71, s30, 17
s_lshl_b32 s66, s31, 8
s_add_u32 s71, s71, s66
s_lshl_b32 s76, s30, 13
s_lshl_b32 s77, s30, 12
s_lshl_b32 s78, s30, 10
s_waitcnt lgkmcnt(0)
s_mov_b32 s32, s6
s_mov_b32 s33, s7
s_mov_b32 s34, 2097152
s_mov_b32 s35, 0x20000
s_mov_b32 s36, s10
s_mov_b32 s37, s11
s_mov_b32 s38, 4194304
s_mov_b32 s39, 0x20000
s_mov_b32 s40, s12
s_mov_b32 s41, s13
s_mov_b32 s42, 4194304
s_mov_b32 s43, 0x20000
s_xor_b32 m0, s76, 0
s_xor_b32 s64, s70, 0
buffer_load_dwordx4 v12, s[32:35], s64 offen lds
s_xor_b32 m0, s76, 1024
s_xor_b32 s64, s70, 8192
buffer_load_dwordx4 v13, s[32:35], s64 offen lds
s_xor_b32 m0, s76, 2048
s_xor_b32 s64, s70, 16384
buffer_load_dwordx4 v12, s[32:35], s64 offen lds
s_xor_b32 m0, s76, 3072
s_xor_b32 s64, s70, 24576
buffer_load_dwordx4 v13, s[32:35], s64 offen lds
s_xor_b32 m0, s77, 65536
s_xor_b32 s64, s71, 0
buffer_load_dwordx4 v14, s[36:39], s64 offen lds
s_xor_b32 m0, s77, 66560
s_xor_b32 s64, s71, 32768
buffer_load_dwordx4 v14, s[36:39], s64 offen lds
s_xor_b32 m0, s77, 67584
s_xor_b32 s64, s71, 65536
buffer_load_dwordx4 v15, s[36:39], s64 offen lds
s_xor_b32 m0, s77, 68608
s_xor_b32 s64, s71, 98304
buffer_load_dwordx4 v15, s[36:39], s64 offen lds
s_mov_b32 s44, s28
s_mov_b32 s45, s29
s_mov_b32 s46, 134217728
s_mov_b32 s47, 0x20000
s_mov_b32 s48, s4
s_mov_b32 s49, s5
s_mov_b32 s50, 4194304
s_mov_b32 s51, 0x20000
s_mov_b32 s52, s26
s_mov_b32 s53, s27
s_mov_b32 s54, 256
s_mov_b32 s55, 0x20000
s_mov_b32 s56, s8
s_mov_b32 s57, s9
s_mov_b32 s58, 8388608
s_mov_b32 s59, 0x20000
s_mov_b32 s60, s18
s_mov_b32 s61, s19
s_mov_b32 s62, 6291456
s_mov_b32 s63, 0x20000
v_accvgpr_write_b32 a251, 1
v_and_b32 v24, 15, v0
v_lshrrev_b32 v26, 1, v24
v_xor_b32 v26, v26, v25
v_lshlrev_b32 v26, 4, v26
v_lshl_add_u32 v26, v24, 7, v26
v_add_u32 v2, s76, v26
v_xor_b32 v3, 64, v2
v_bfe_u32 v24, v0, 2, 2
v_lshl_add_u32 v27, v25, 3, v24
v_and_b32 v1, 3, v0
v_cmp_eq_u32 vcc, 0, v1
v_lshlrev_b32 v1, 3, v1
v_lshl_add_u32 v26, v27, 8, v1
v_add_u32 v26, 65536, v26
v_and_b32 v1, 1, v25
v_lshl_add_u32 v24, v1, 2, v24
v_lshlrev_b32 v16, 4, v0
v_mov_b32 v28, 0x3f803f80
v_cndmask_b32 v28, 0, v28, vcc
v_accvgpr_write_b32 a244, v28
v_accvgpr_write_b32 a245, v28
v_accvgpr_write_b32 a246, v28
v_accvgpr_write_b32 a247, v28
v_xor_b32 v1, 0, v24
v_lshl_add_u32 v4, v1, 5, v26
v_xor_b32 v1, 1, v24
v_lshl_add_u32 v5, v1, 5, v26
v_xor_b32 v1, 2, v24
v_lshl_add_u32 v6, v1, 5, v26
v_xor_b32 v1, 3, v24
v_lshl_add_u32 v7, v1, 5, v26
v_xor_b32 v1, 4, v24
v_lshl_add_u32 v8, v1, 5, v26
v_xor_b32 v1, 5, v24
v_lshl_add_u32 v9, v1, 5, v26
v_xor_b32 v1, 6, v24
v_lshl_add_u32 v10, v1, 5, v26
v_xor_b32 v1, 7, v24
v_lshl_add_u32 v11, v1, 5, v26
s_sub_u32 s16, 15, s3
s_lshl_b32 s72, s3, 18
s_lshl_b32 s73, s16, 18
s_cmp_lt_u32 s30, 2
s_cselect_b32 s67, s3, s16
s_lshl4_add_u32 s74, s31, s67
s_and_b32 s66, s30, 1
s_lshl1_add_u32 s74, s74, s66
s_lshl_b32 s74, s74, 10
s_add_u32 s74, s74, 60817408
s_lshl_b32 s66, s30, 15
s_add_u32 s72, s72, s66
s_add_u32 s73, s73, s66
s_mul_i32 s75, s30, 98304
s_lshl_b32 s66, s31, 6
s_add_u32 s75, s75, s66
s_lshl_b32 s79, s31, 20
s_lshl_b32 s66, s3, 17
s_add_u32 s79, s79, s66
s_lshl_b32 s66, s30, 15
s_add_u32 s79, s79, s66
v_bfe_u32 v23, v0, 1, 1
v_lshrrev_b32 v1, 5, v0
v_xor_b32 v23, v23, v1
v_lshlrev_b32 v23, 5, v23
v_and_b32 v1, 1, v0
v_lshl_add_u32 v23, v1, 4, v23
v_lshrrev_b32 v1, 2, v0
v_mul_u32_u24 v1, 6144, v1
v_add_u32 v23, v1, v23
s_lshl_b32 s81, s80, 13
s_and_b32 s67, s2, 7
s_lshl_b32 s82, s67, 8
s_add_u32 s82, s82, s81
s_lshl_b32 s67, s67, 10
s_add_u32 s81, s81, s67
s_add_u32 s83, s81, 1048576
v_mul_u32_u24 v1, 1792, v25
v_add_u32 v1, v1, v16
s_lshl_b32 s68, s2, 3
s_lshl1_add_u32 s68, s30, s68
v_lshrrev_b32 v18, 5, v0
v_add_u32 v18, s68, v18
v_and_b32 v19, 31, v0
v_lshlrev_b32 v19, 4, v19
v_lshl_add_u32 v18, v18, 11, v19
v_mov_b32 v21, 0
v_min_u32 v20, 1, v0
v_lshlrev_b32 v20, 30, v20
v_accvgpr_write_b32 a240, -1
v_accvgpr_write_b32 a241, -1
v_accvgpr_write_b32 a242, -1
v_accvgpr_write_b32 a243, -1
s_lshr_b32 s69, s2, 7
s_or_b32 s69, s69, s30
s_lshl_b32 s69, s69, 21
s_add_u32 s69, s69, s2
s_lshl_b32 s69, s69, 7
s_add_u32 s69, s69, 59768832
s_xor_b32 m0, s76, 4096
s_xor_b32 s64, s70, 32768
buffer_load_dwordx4 v12, s[32:35], s64 offen lds
s_xor_b32 m0, s76, 5120
s_xor_b32 s64, s70, 40960
buffer_load_dwordx4 v13, s[32:35], s64 offen lds
s_xor_b32 m0, s76, 6144
s_xor_b32 s64, s70, 49152
buffer_load_dwordx4 v12, s[32:35], s64 offen lds
s_xor_b32 m0, s76, 7168
s_xor_b32 s64, s70, 57344
buffer_load_dwordx4 v13, s[32:35], s64 offen lds
s_xor_b32 m0, s77, 81920
s_xor_b32 s64, s71, 0
buffer_load_dwordx4 v14, s[40:43], s64 offen lds
s_xor_b32 m0, s77, 82944
s_xor_b32 s64, s71, 32768
buffer_load_dwordx4 v14, s[40:43], s64 offen lds
s_xor_b32 m0, s77, 83968
s_xor_b32 s64, s71, 65536
buffer_load_dwordx4 v15, s[40:43], s64 offen lds
s_xor_b32 m0, s77, 84992
s_xor_b32 s64, s71, 98304
buffer_load_dwordx4 v15, s[40:43], s64 offen lds
s_and_b32 s66, s31, 3
s_lshl_b32 s67, s66, 11
s_add_u32 s84, s76, s67
s_lshl3_add_u32 s70, s67, s70
s_and_b32 s67, s66, 1
s_lshl_b32 s67, s67, 17
s_add_u32 s72, s72, s67
s_add_u32 s67, s73, s67
s_bitcmp1_b32 s66, 1
s_cselect_b32 s73, s72, s67
s_cselect_b32 s72, s67, s72
s_and_b32 s66, s3, 3
s_lshl_b32 s67, s66, 10
s_add_u32 s77, s77, s67
s_lshl_b32 s67, s66, 15
s_add_u32 s71, s71, s67
s_and_b32 s67, s66, 2
s_lshl_b32 s67, s67, 6
v_xor_b32 v14, s67, v14
v_xor_b32 v15, s67, v15
s_and_b32 s66, s3, 4
s_cselect_b64 s[36:37], s[12:13], s[10:11]
s_cselect_b64 s[40:41], s[10:11], s[12:13]
s_lshl_b32 s66, s66, 12
s_add_u32 s77, s77, s66
s_waitcnt vmcnt(8)
s_barrier
ds_read_b128 a[0:3], v2 offset:0
ds_read_b128 a[4:7], v3 offset:0
ds_read_b64_tr_b16 a[176:177], v4 offset:0
ds_read_b64_tr_b16 a[178:179], v4 offset:1024
ds_read_b64_tr_b16 a[180:181], v4 offset:8192
ds_read_b64_tr_b16 a[182:183], v4 offset:9216
ds_read_b128 a[8:11], v2 offset:2048
ds_read_b128 a[12:15], v3 offset:2048
ds_read_b64_tr_b16 a[184:185], v5 offset:0
ds_read_b64_tr_b16 a[186:187], v5 offset:1024
ds_read_b64_tr_b16 a[188:189], v5 offset:8192
ds_read_b64_tr_b16 a[190:191], v5 offset:9216
ds_read_b64_tr_b16 a[88:89], v6 offset:0
ds_read_b64_tr_b16 a[90:91], v6 offset:1024
ds_read_b64_tr_b16 a[92:93], v6 offset:8192
ds_read_b64_tr_b16 a[94:95], v6 offset:9216
s_waitcnt lgkmcnt(12)
v_mfma_f32_16x16x32_bf16 v[184:187], a[176:179], a[0:3], 0
s_waitcnt lgkmcnt(10)
s_xor_b32 m0, s77, 98304
ds_read_b64_tr_b16 a[96:97], v7 offset:0
v_mfma_f32_16x16x32_bf16 v[184:187], a[180:183], a[4:7], v[184:187]
s_waitcnt lgkmcnt(9)
s_xor_b32 s64, s71, 524288
ds_read_b64_tr_b16 a[98:99], v7 offset:1024
v_mfma_f32_16x16x32_bf16 v[192:195], a[180:183], a[12:15], 0
buffer_load_dwordx4 v14, s[36:39], s64 offen lds
v_mfma_f32_16x16x32_bf16 v[192:195], a[176:179], a[8:11], v[192:195]
s_waitcnt lgkmcnt(8)
ds_read_b64_tr_b16 a[100:101], v7 offset:8192
v_mfma_f32_16x16x32_bf16 v[196:199], a[184:187], a[8:11], 0
s_waitcnt lgkmcnt(7)
s_xor_b32 m0, s77, 99328
ds_read_b64_tr_b16 a[102:103], v7 offset:9216
v_mfma_f32_16x16x32_bf16 v[196:199], a[188:191], a[12:15], v[196:199]
s_xor_b32 s64, s71, 557056
ds_read_b64_tr_b16 a[104:105], v8 offset:0
v_mfma_f32_16x16x32_bf16 v[188:191], a[188:191], a[4:7], 0
buffer_load_dwordx4 v14, s[36:39], s64 offen lds
v_mfma_f32_16x16x32_bf16 v[188:191], a[184:187], a[0:3], v[188:191]
s_waitcnt lgkmcnt(7)
ds_read_b64_tr_b16 a[106:107], v8 offset:1024
v_mfma_f32_16x16x32_bf16 v[216:219], a[88:91], a[0:3], 0
s_waitcnt lgkmcnt(6)
s_xor_b32 m0, s77, 100352
ds_read_b64_tr_b16 a[108:109], v8 offset:8192
v_mfma_f32_16x16x32_bf16 v[216:219], a[92:95], a[4:7], v[216:219]
s_xor_b32 s64, s71, 589824
ds_read_b64_tr_b16 a[110:111], v8 offset:9216
v_mfma_f32_16x16x32_bf16 v[224:227], a[92:95], a[12:15], 0
buffer_load_dwordx4 v15, s[36:39], s64 offen lds
v_mfma_f32_16x16x32_bf16 v[224:227], a[88:91], a[8:11], v[224:227]
s_waitcnt lgkmcnt(6)
ds_read_b64_tr_b16 a[112:113], v9 offset:0
v_mfma_f32_16x16x32_bf16 v[228:231], a[96:99], a[8:11], 0
s_waitcnt lgkmcnt(5)
ds_read_b64_tr_b16 a[114:115], v9 offset:1024
v_mfma_f32_16x16x32_bf16 v[228:231], a[100:103], a[12:15], v[228:231]
s_xor_b32 m0, s77, 101376
ds_read_b64_tr_b16 a[116:117], v9 offset:8192
v_mfma_f32_16x16x32_bf16 v[220:223], a[100:103], a[4:7], 0
s_xor_b32 s64, s71, 622592
ds_read_b64_tr_b16 a[118:119], v9 offset:9216
v_mfma_f32_16x16x32_bf16 v[220:223], a[96:99], a[0:3], v[220:223]
s_waitcnt lgkmcnt(6)
buffer_load_dwordx4 v15, s[36:39], s64 offen lds
v_mfma_f32_16x16x32_bf16 v[152:155], a[104:107], a[0:3], 0
s_waitcnt lgkmcnt(4)
ds_read_b64_tr_b16 a[72:73], v10 offset:0
v_mfma_f32_16x16x32_bf16 v[152:155], a[108:111], a[4:7], v[152:155]
s_xor_b32 m0, s77, 114688
ds_read_b64_tr_b16 a[74:75], v10 offset:1024
v_mfma_f32_16x16x32_bf16 v[160:163], a[108:111], a[12:15], 0
s_xor_b32 s64, s71, 524288
ds_read_b64_tr_b16 a[76:77], v10 offset:8192
ds_read_b64_tr_b16 a[78:79], v10 offset:9216
v_mfma_f32_16x16x32_bf16 v[160:163], a[104:107], a[8:11], v[160:163]
s_waitcnt lgkmcnt(6)
buffer_load_dwordx4 v14, s[40:43], s64 offen lds
v_mfma_f32_16x16x32_bf16 v[164:167], a[112:115], a[8:11], 0
s_waitcnt lgkmcnt(4)
s_xor_b32 m0, s77, 115712
ds_read_b64_tr_b16 a[80:81], v11 offset:0
v_mfma_f32_16x16x32_bf16 v[164:167], a[116:119], a[12:15], v[164:167]
s_xor_b32 s64, s71, 557056
ds_read_b64_tr_b16 a[82:83], v11 offset:1024
v_mfma_f32_16x16x32_bf16 v[156:159], a[116:119], a[4:7], 0
ds_read_b64_tr_b16 a[84:85], v11 offset:8192
ds_read_b64_tr_b16 a[86:87], v11 offset:9216
s_waitcnt vmcnt(9)
v_mfma_f32_16x16x32_bf16 v[156:159], a[112:115], a[0:3], v[156:159]
s_waitcnt lgkmcnt(6)
buffer_load_dwordx4 v14, s[40:43], s64 offen lds
v_mfma_f32_16x16x32_bf16 v[24:27], a[72:75], a[0:3], 0
s_waitcnt lgkmcnt(4)
s_xor_b32 m0, s77, 116736
ds_read_b128 a[16:19], v2 offset:4096
ds_read_b128 a[20:23], v3 offset:4096
v_mfma_f32_16x16x32_bf16 v[24:27], a[76:79], a[4:7], v[24:27]
s_xor_b32 s64, s71, 589824
ds_read_b128 a[24:27], v2 offset:6144
ds_read_b128 a[28:31], v3 offset:6144
v_mfma_f32_16x16x32_bf16 v[40:43], a[76:79], a[12:15], 0
s_add_u32 s17, s78, .-L_pc+6144
buffer_load_dwordx4 v15, s[40:43], s64 offen lds
v_mfma_f32_16x16x32_bf16 v[40:43], a[72:75], a[8:11], v[40:43]
s_waitcnt lgkmcnt(6)
buffer_load_dword a252, v16, s[88:91], s17 offen
v_mfma_f32_16x16x32_bf16 v[104:107], a[80:83], a[8:11], 0
s_waitcnt lgkmcnt(4)
s_xor_b32 m0, s77, 117760
v_mfma_f32_16x16x32_bf16 v[104:107], a[84:87], a[12:15], v[104:107]
s_xor_b32 s64, s71, 622592
v_mfma_f32_16x16x32_bf16 v[88:91], a[84:87], a[4:7], 0
buffer_load_dwordx4 v15, s[40:43], s64 offen lds
v_mfma_f32_16x16x32_bf16 v[88:91], a[80:83], a[0:3], v[88:91]
s_waitcnt lgkmcnt(3)
v_mfma_f32_16x16x32_bf16 v[232:235], a[88:91], a[16:19], 0
s_waitcnt lgkmcnt(2)
v_mfma_f32_16x16x32_bf16 v[232:235], a[92:95], a[20:23], v[232:235]
s_waitcnt lgkmcnt(0)
s_xor_b32 m0, s84, 32768
v_mfma_f32_16x16x32_bf16 v[240:243], a[92:95], a[28:31], 0
s_xor_b32 s64, s70, 128
v_mfma_f32_16x16x32_bf16 v[240:243], a[88:91], a[24:27], v[240:243]
buffer_load_dwordx4 v12, s[32:35], s64 offen lds
v_mfma_f32_16x16x32_bf16 v[244:247], a[96:99], a[24:27], 0
s_xor_b32 m0, s84, 33792
v_mfma_f32_16x16x32_bf16 v[244:247], a[100:103], a[28:31], v[244:247]
s_xor_b32 s64, s70, 8320
v_mfma_f32_16x16x32_bf16 v[236:239], a[100:103], a[20:23], 0
s_waitcnt vmcnt(10)
s_barrier
v_mfma_f32_16x16x32_bf16 v[236:239], a[96:99], a[16:19], v[236:239]
buffer_load_dwordx4 v13, s[32:35], s64 offen lds
v_mfma_f32_16x16x32_bf16 v[168:171], a[104:107], a[16:19], 0
ds_read_b64_tr_b16 a[88:89], v4 offset:16384
v_mfma_f32_16x16x32_bf16 v[168:171], a[108:111], a[20:23], v[168:171]
s_xor_b32 m0, s84, 34816
ds_read_b64_tr_b16 a[90:91], v4 offset:17408
v_mfma_f32_16x16x32_bf16 v[176:179], a[108:111], a[28:31], 0
s_xor_b32 s64, s70, 16512
ds_read_b64_tr_b16 a[92:93], v4 offset:24576
v_mfma_f32_16x16x32_bf16 v[176:179], a[104:107], a[24:27], v[176:179]
buffer_load_dwordx4 v12, s[32:35], s64 offen lds
v_mfma_f32_16x16x32_bf16 v[180:183], a[112:115], a[24:27], 0
ds_read_b64_tr_b16 a[94:95], v4 offset:25600
v_mfma_f32_16x16x32_bf16 v[180:183], a[116:119], a[28:31], v[180:183]
s_xor_b32 m0, s84, 35840
ds_read_b64_tr_b16 a[96:97], v5 offset:16384
v_mfma_f32_16x16x32_bf16 v[172:175], a[116:119], a[20:23], 0
s_xor_b32 s64, s70, 24704
ds_read_b64_tr_b16 a[98:99], v5 offset:17408
v_mfma_f32_16x16x32_bf16 v[172:175], a[112:115], a[16:19], v[172:175]
buffer_load_dwordx4 v13, s[32:35], s64 offen lds
v_mfma_f32_16x16x32_bf16 v[56:59], a[72:75], a[16:19], 0
ds_read_b64_tr_b16 a[100:101], v5 offset:24576
v_mfma_f32_16x16x32_bf16 v[56:59], a[76:79], a[20:23], v[56:59]
s_xor_b32 m0, s84, 36864
ds_read_b64_tr_b16 a[102:103], v5 offset:25600
v_mfma_f32_16x16x32_bf16 v[72:75], a[76:79], a[28:31], 0
s_xor_b32 s64, s70, 32896
ds_read_b64_tr_b16 a[104:105], v6 offset:16384
v_mfma_f32_16x16x32_bf16 v[72:75], a[72:75], a[24:27], v[72:75]
buffer_load_dwordx4 v12, s[32:35], s64 offen lds
v_mfma_f32_16x16x32_bf16 v[136:139], a[80:83], a[24:27], 0
ds_read_b64_tr_b16 a[106:107], v6 offset:17408
v_mfma_f32_16x16x32_bf16 v[136:139], a[84:87], a[28:31], v[136:139]
s_xor_b32 m0, s84, 37888
ds_read_b64_tr_b16 a[108:109], v6 offset:24576
v_mfma_f32_16x16x32_bf16 v[120:123], a[84:87], a[20:23], 0
s_xor_b32 s64, s70, 41088
ds_read_b64_tr_b16 a[110:111], v6 offset:25600
v_mfma_f32_16x16x32_bf16 v[120:123], a[80:83], a[16:19], v[120:123]
buffer_load_dwordx4 v13, s[32:35], s64 offen lds
v_mfma_f32_16x16x32_bf16 v[200:203], a[176:179], a[16:19], 0
ds_read_b64_tr_b16 a[112:113], v7 offset:16384
v_mfma_f32_16x16x32_bf16 v[200:203], a[180:183], a[20:23], v[200:203]
s_xor_b32 m0, s84, 38912
ds_read_b64_tr_b16 a[114:115], v7 offset:17408
v_mfma_f32_16x16x32_bf16 v[208:211], a[180:183], a[28:31], 0
s_xor_b32 s64, s70, 49280
ds_read_b64_tr_b16 a[116:117], v7 offset:24576
v_mfma_f32_16x16x32_bf16 v[208:211], a[176:179], a[24:27], v[208:211]
buffer_load_dwordx4 v12, s[32:35], s64 offen lds
v_mfma_f32_16x16x32_bf16 v[212:215], a[184:187], a[24:27], 0
ds_read_b64_tr_b16 a[118:119], v7 offset:25600
v_mfma_f32_16x16x32_bf16 v[212:215], a[188:191], a[28:31], v[212:215]
s_xor_b32 m0, s84, 39936
ds_read_b64_tr_b16 a[72:73], v8 offset:16384
v_mfma_f32_16x16x32_bf16 v[204:207], a[188:191], a[20:23], 0
s_xor_b32 s64, s70, 57472
ds_read_b64_tr_b16 a[74:75], v8 offset:17408
v_mfma_f32_16x16x32_bf16 v[204:207], a[184:187], a[16:19], v[204:207]
s_waitcnt lgkmcnt(7)
buffer_load_dwordx4 v13, s[32:35], s64 offen lds
v_mfma_f32_16x16x32_bf16 v[28:31], a[0:3], a[88:91], 0
ds_read_b64_tr_b16 a[76:77], v8 offset:24576
v_mfma_f32_16x16x32_bf16 v[28:31], a[4:7], a[92:95], v[28:31]
ds_read_b64_tr_b16 a[78:79], v8 offset:25600
v_mfma_f32_16x16x32_bf16 v[44:47], a[12:15], a[92:95], 0
ds_read_b64_tr_b16 a[80:81], v9 offset:16384
v_mfma_f32_16x16x32_bf16 v[44:47], a[8:11], a[88:91], v[44:47]
ds_read_b64_tr_b16 a[82:83], v9 offset:17408
v_mfma_f32_16x16x32_bf16 v[60:63], a[16:19], a[88:91], 0
s_xor_b32 m0, s77, 131072
ds_read_b64_tr_b16 a[84:85], v9 offset:24576
v_mfma_f32_16x16x32_bf16 v[60:63], a[20:23], a[92:95], v[60:63]
s_xor_b32 s64, s71, 1048576
ds_read_b64_tr_b16 a[86:87], v9 offset:25600
v_mfma_f32_16x16x32_bf16 v[76:79], a[28:31], a[92:95], 0
buffer_load_dwordx4 v14, s[36:39], s64 offen lds
v_mfma_f32_16x16x32_bf16 v[76:79], a[24:27], a[88:91], v[76:79]
s_xor_b32 m0, s77, 132096
ds_read_b64_tr_b16 a[88:89], v10 offset:16384
v_mfma_f32_16x16x32_bf16 v[140:143], a[24:27], a[96:99], 0
s_xor_b32 s64, s71, 1081344
ds_read_b64_tr_b16 a[90:91], v10 offset:17408
v_mfma_f32_16x16x32_bf16 v[140:143], a[28:31], a[100:103], v[140:143]
buffer_load_dwordx4 v14, s[36:39], s64 offen lds
v_mfma_f32_16x16x32_bf16 v[124:127], a[20:23], a[100:103], 0
ds_read_b64_tr_b16 a[92:93], v10 offset:24576
v_mfma_f32_16x16x32_bf16 v[124:127], a[16:19], a[96:99], v[124:127]
s_xor_b32 m0, s77, 133120
ds_read_b64_tr_b16 a[94:95], v10 offset:25600
v_mfma_f32_16x16x32_bf16 v[108:111], a[8:11], a[96:99], 0
s_xor_b32 s64, s71, 1114112
v_mfma_f32_16x16x32_bf16 v[108:111], a[12:15], a[100:103], v[108:111]
buffer_load_dwordx4 v15, s[36:39], s64 offen lds
v_mfma_f32_16x16x32_bf16 v[92:95], a[4:7], a[100:103], 0
v_mfma_f32_16x16x32_bf16 v[92:95], a[0:3], a[96:99], v[92:95]
s_xor_b32 m0, s77, 134144
ds_read_b64_tr_b16 a[96:97], v11 offset:16384
v_mfma_f32_16x16x32_bf16 v[32:35], a[0:3], a[104:107], 0
s_waitcnt lgkmcnt(5)
s_xor_b32 s64, s71, 1146880
ds_read_b64_tr_b16 a[98:99], v11 offset:17408
v_mfma_f32_16x16x32_bf16 v[32:35], a[4:7], a[108:111], v[32:35]
buffer_load_dwordx4 v15, s[36:39], s64 offen lds
v_mfma_f32_16x16x32_bf16 v[48:51], a[12:15], a[108:111], 0
ds_read_b64_tr_b16 a[100:101], v11 offset:24576
v_mfma_f32_16x16x32_bf16 v[48:51], a[8:11], a[104:107], v[48:51]
s_xor_b32 m0, s77, 147456
ds_read_b64_tr_b16 a[102:103], v11 offset:25600
v_mfma_f32_16x16x32_bf16 v[64:67], a[16:19], a[104:107], 0
s_xor_b32 s64, s71, 1048576
v_mfma_f32_16x16x32_bf16 v[64:67], a[20:23], a[108:111], v[64:67]
buffer_load_dwordx4 v14, s[40:43], s64 offen lds
v_mfma_f32_16x16x32_bf16 v[80:83], a[28:31], a[108:111], 0
s_xor_b32 m0, s77, 148480
v_mfma_f32_16x16x32_bf16 v[80:83], a[24:27], a[104:107], v[80:83]
s_xor_b32 s64, s71, 1081344
v_mfma_f32_16x16x32_bf16 v[144:147], a[24:27], a[112:115], 0
buffer_load_dwordx4 v14, s[40:43], s64 offen lds
v_mfma_f32_16x16x32_bf16 v[144:147], a[28:31], a[116:119], v[144:147]
v_mfma_f32_16x16x32_bf16 v[128:131], a[20:23], a[116:119], 0
s_xor_b32 m0, s77, 149504
v_mfma_f32_16x16x32_bf16 v[128:131], a[16:19], a[112:115], v[128:131]
s_xor_b32 s64, s71, 1114112
v_mfma_f32_16x16x32_bf16 v[112:115], a[8:11], a[112:115], 0
buffer_load_dwordx4 v15, s[40:43], s64 offen lds
v_mfma_f32_16x16x32_bf16 v[112:115], a[12:15], a[116:119], v[112:115]
v_mfma_f32_16x16x32_bf16 v[96:99], a[4:7], a[116:119], 0
s_xor_b32 m0, s77, 150528
v_mfma_f32_16x16x32_bf16 v[96:99], a[0:3], a[112:115], v[96:99]
s_xor_b32 s64, s71, 1146880
v_mfma_f32_16x16x32_bf16 v[36:39], a[0:3], a[72:75], 0
buffer_load_dwordx4 v15, s[40:43], s64 offen lds
v_mfma_f32_16x16x32_bf16 v[36:39], a[4:7], a[76:79], v[36:39]
s_xor_b32 m0, s84, 0
v_mfma_f32_16x16x32_bf16 v[52:55], a[12:15], a[76:79], 0
s_waitcnt vmcnt(16) lgkmcnt(0)
s_barrier
v_mfma_f32_16x16x32_bf16 v[52:55], a[8:11], a[72:75], v[52:55]
s_xor_b32 s64, s70, 256
ds_read_b64_tr_b16 a[104:105], v4 offset:32768
v_mfma_f32_16x16x32_bf16 v[68:71], a[16:19], a[72:75], 0
buffer_load_dwordx4 v12, s[32:35], s64 offen lds
v_mfma_f32_16x16x32_bf16 v[68:71], a[20:23], a[76:79], v[68:71]
s_xor_b32 m0, s84, 1024
global_load_dwordx4 a[144:147], v18, s[4:5] offset:0
v_mfma_f32_16x16x32_bf16 v[84:87], a[28:31], a[76:79], 0
s_xor_b32 s64, s70, 8448
ds_read_b64_tr_b16 a[106:107], v4 offset:33792
v_mfma_f32_16x16x32_bf16 v[84:87], a[24:27], a[72:75], v[84:87]
buffer_load_dwordx4 v13, s[32:35], s64 offen lds
v_mfma_f32_16x16x32_bf16 v[148:151], a[24:27], a[80:83], 0
ds_read_b64_tr_b16 a[108:109], v4 offset:40960
v_mfma_f32_16x16x32_bf16 v[148:151], a[28:31], a[84:87], v[148:151]
s_xor_b32 m0, s84, 2048
ds_read_b64_tr_b16 a[110:111], v4 offset:41984
v_mfma_f32_16x16x32_bf16 v[132:135], a[20:23], a[84:87], 0
s_waitcnt vmcnt(11)
s_xor_b32 s64, s70, 16640
ds_read_b128 a[32:35], v2 offset:32768
v_mfma_f32_16x16x32_bf16 v[132:135], a[16:19], a[80:83], v[132:135]
buffer_load_dwordx4 v12, s[32:35], s64 offen lds
v_mfma_f32_16x16x32_bf16 v[116:119], a[8:11], a[80:83], 0
ds_read_b128 a[36:39], v3 offset:32768
v_mfma_f32_16x16x32_bf16 v[116:119], a[12:15], a[84:87], v[116:119]
s_xor_b32 m0, s84, 3072
ds_read_b128 a[40:43], v2 offset:34816
v_mfma_f32_16x16x32_bf16 v[100:103], a[4:7], a[84:87], 0
s_xor_b32 s64, s70, 24832
ds_read_b128 a[44:47], v3 offset:34816
v_mfma_f32_16x16x32_bf16 v[100:103], a[0:3], a[80:83], v[100:103]
buffer_load_dwordx4 v13, s[32:35], s64 offen lds
v_mfma_f32_16x16x32_bf16 v[248:251], a[0:3], a[88:91], 0
ds_read_b128 a[48:51], v2 offset:36864
v_mfma_f32_16x16x32_bf16 v[248:251], a[4:7], a[92:95], v[248:251]
s_xor_b32 m0, s84, 4096
ds_read_b128 a[52:55], v3 offset:36864
v_mfma_f32_16x16x32_bf16 v[252:255], a[12:15], a[92:95], 0
s_xor_b32 s64, s70, 33024
ds_read_b128 a[56:59], v2 offset:38912
v_mfma_f32_16x16x32_bf16 v[252:255], a[8:11], a[88:91], v[252:255]
buffer_load_dwordx4 v12, s[32:35], s64 offen lds
v_mfma_f32_16x16x32_bf16 a[120:123], a[16:19], a[88:91], 0
s_xor_b32 m0, s84, 5120
ds_read_b128 a[60:63], v3 offset:38912
v_mfma_f32_16x16x32_bf16 a[120:123], a[20:23], a[92:95], a[120:123]
s_xor_b32 s64, s70, 41216
ds_read_b64_tr_b16 a[112:113], v5 offset:32768
v_mfma_f32_16x16x32_bf16 a[124:127], a[28:31], a[92:95], 0
buffer_load_dwordx4 v13, s[32:35], s64 offen lds
v_mfma_f32_16x16x32_bf16 a[124:127], a[24:27], a[88:91], a[124:127]
ds_read_b64_tr_b16 a[114:115], v5 offset:33792
v_mfma_f32_16x16x32_bf16 a[128:131], a[24:27], a[96:99], 0
s_xor_b32 m0, s84, 6144
ds_read_b64_tr_b16 a[116:117], v5 offset:40960
v_mfma_f32_16x16x32_bf16 a[128:131], a[28:31], a[100:103], a[128:131]
s_xor_b32 s64, s70, 49408
ds_read_b64_tr_b16 a[118:119], v5 offset:41984
v_mfma_f32_16x16x32_bf16 a[132:135], a[20:23], a[100:103], 0
buffer_load_dwordx4 v12, s[32:35], s64 offen lds
v_mfma_f32_16x16x32_bf16 a[132:135], a[16:19], a[96:99], a[132:135]
global_load_dwordx4 a[160:163], v19, s[22:23] offset:0
v_mfma_f32_16x16x32_bf16 a[136:139], a[8:11], a[96:99], 0
s_xor_b32 m0, s84, 7168
ds_read_b64_tr_b16 a[72:73], v6 offset:32768
v_mfma_f32_16x16x32_bf16 a[136:139], a[12:15], a[100:103], a[136:139]
s_xor_b32 s64, s70, 57600
ds_read_b64_tr_b16 a[74:75], v6 offset:33792
v_mfma_f32_16x16x32_bf16 a[140:143], a[4:7], a[100:103], 0
buffer_load_dwordx4 v13, s[32:35], s64 offen lds
v_mfma_f32_16x16x32_bf16 a[140:143], a[0:3], a[96:99], a[140:143]
s_waitcnt lgkmcnt(5)
ds_read_b64_tr_b16 a[76:77], v6 offset:40960
v_mfma_f32_16x16x32_bf16 v[184:187], a[104:107], a[32:35], v[184:187]
ds_read_b64_tr_b16 a[78:79], v6 offset:41984
v_mfma_f32_16x16x32_bf16 v[184:187], a[108:111], a[36:39], v[184:187]
ds_read_b64_tr_b16 a[80:81], v7 offset:32768
v_mfma_f32_16x16x32_bf16 v[192:195], a[108:111], a[44:47], v[192:195]
s_xor_b32 m0, s77, 65536
ds_read_b64_tr_b16 a[82:83], v7 offset:33792
v_mfma_f32_16x16x32_bf16 v[192:195], a[104:107], a[40:43], v[192:195]
s_xor_b32 s64, s71, 1572864
ds_read_b64_tr_b16 a[84:85], v7 offset:40960
v_mfma_f32_16x16x32_bf16 v[200:203], a[104:107], a[48:51], v[200:203]
buffer_load_dwordx4 v14, s[36:39], s64 offen lds
v_mfma_f32_16x16x32_bf16 v[200:203], a[108:111], a[52:55], v[200:203]
ds_read_b64_tr_b16 a[86:87], v7 offset:41984
v_mfma_f32_16x16x32_bf16 v[208:211], a[108:111], a[60:63], v[208:211]
s_xor_b32 m0, s77, 66560
ds_read_b64_tr_b16 a[88:89], v8 offset:32768
v_mfma_f32_16x16x32_bf16 v[208:211], a[104:107], a[56:59], v[208:211]
s_waitcnt lgkmcnt(7)
s_xor_b32 s64, s71, 1605632
ds_read_b64_tr_b16 a[90:91], v8 offset:33792
v_mfma_f32_16x16x32_bf16 v[212:215], a[112:115], a[56:59], v[212:215]
buffer_load_dwordx4 v14, s[36:39], s64 offen lds
v_mfma_f32_16x16x32_bf16 v[212:215], a[116:119], a[60:63], v[212:215]
ds_read_b64_tr_b16 a[92:93], v8 offset:40960
v_mfma_f32_16x16x32_bf16 v[204:207], a[116:119], a[52:55], v[204:207]
s_xor_b32 m0, s77, 67584
ds_read_b64_tr_b16 a[94:95], v8 offset:41984
v_mfma_f32_16x16x32_bf16 v[204:207], a[112:115], a[48:51], v[204:207]
s_xor_b32 s64, s71, 1638400
ds_read_b64_tr_b16 a[96:97], v9 offset:32768
v_mfma_f32_16x16x32_bf16 v[196:199], a[112:115], a[40:43], v[196:199]
buffer_load_dwordx4 v15, s[36:39], s64 offen lds
v_mfma_f32_16x16x32_bf16 v[196:199], a[116:119], a[44:47], v[196:199]
ds_read_b64_tr_b16 a[98:99], v9 offset:33792
v_mfma_f32_16x16x32_bf16 v[188:191], a[116:119], a[36:39], v[188:191]
s_xor_b32 m0, s77, 68608
ds_read_b64_tr_b16 a[100:101], v9 offset:40960
v_mfma_f32_16x16x32_bf16 v[188:191], a[112:115], a[32:35], v[188:191]
s_xor_b32 s64, s71, 1671168
ds_read_b64_tr_b16 a[102:103], v9 offset:41984
v_mfma_f32_16x16x32_bf16 v[216:219], a[72:75], a[32:35], v[216:219]
s_waitcnt lgkmcnt(7)
buffer_load_dwordx4 v15, s[36:39], s64 offen lds
v_mfma_f32_16x16x32_bf16 v[216:219], a[76:79], a[36:39], v[216:219]
global_load_dwordx4 a[148:151], v18, s[4:5] offset:512
v_mfma_f32_16x16x32_bf16 v[224:227], a[76:79], a[44:47], v[224:227]
ds_read_b64_tr_b16 a[104:105], v10 offset:32768
v_mfma_f32_16x16x32_bf16 v[224:227], a[72:75], a[40:43], v[224:227]
s_xor_b32 m0, s77, 81920
ds_read_b64_tr_b16 a[106:107], v10 offset:33792
v_mfma_f32_16x16x32_bf16 v[232:235], a[72:75], a[48:51], v[232:235]
s_xor_b32 s64, s71, 1572864
ds_read_b64_tr_b16 a[108:109], v10 offset:40960
v_mfma_f32_16x16x32_bf16 v[232:235], a[76:79], a[52:55], v[232:235]
buffer_load_dwordx4 v14, s[40:43], s64 offen lds
v_mfma_f32_16x16x32_bf16 v[240:243], a[76:79], a[60:63], v[240:243]
ds_read_b64_tr_b16 a[110:111], v10 offset:41984
v_mfma_f32_16x16x32_bf16 v[240:243], a[72:75], a[56:59], v[240:243]
s_xor_b32 m0, s77, 82944
ds_read_b64_tr_b16 a[112:113], v11 offset:32768
v_mfma_f32_16x16x32_bf16 v[244:247], a[80:83], a[56:59], v[244:247]
s_xor_b32 s64, s71, 1605632
ds_read_b64_tr_b16 a[114:115], v11 offset:33792
v_mfma_f32_16x16x32_bf16 v[244:247], a[84:87], a[60:63], v[244:247]
buffer_load_dwordx4 v14, s[40:43], s64 offen lds
v_mfma_f32_16x16x32_bf16 v[236:239], a[84:87], a[52:55], v[236:239]
ds_read_b64_tr_b16 a[116:117], v11 offset:40960
v_mfma_f32_16x16x32_bf16 v[236:239], a[80:83], a[48:51], v[236:239]
s_xor_b32 m0, s77, 83968
ds_read_b64_tr_b16 a[118:119], v11 offset:41984
v_mfma_f32_16x16x32_bf16 v[228:231], a[80:83], a[40:43], v[228:231]
s_xor_b32 s64, s71, 1638400
ds_read_b64_tr_b16 a[72:73], v4 offset:49152
v_mfma_f32_16x16x32_bf16 v[228:231], a[84:87], a[44:47], v[228:231]
buffer_load_dwordx4 v15, s[40:43], s64 offen lds
v_mfma_f32_16x16x32_bf16 v[220:223], a[84:87], a[36:39], v[220:223]
ds_read_b64_tr_b16 a[74:75], v4 offset:50176
v_mfma_f32_16x16x32_bf16 v[220:223], a[80:83], a[32:35], v[220:223]
s_waitcnt lgkmcnt(7)
s_xor_b32 m0, s77, 84992
ds_read_b64_tr_b16 a[76:77], v4 offset:57344
v_mfma_f32_16x16x32_bf16 v[152:155], a[88:91], a[32:35], v[152:155]
s_xor_b32 s64, s71, 1671168
ds_read_b64_tr_b16 a[78:79], v4 offset:58368
v_mfma_f32_16x16x32_bf16 v[152:155], a[92:95], a[36:39], v[152:155]
buffer_load_dwordx4 v15, s[40:43], s64 offen lds
v_mfma_f32_16x16x32_bf16 v[160:163], a[92:95], a[44:47], v[160:163]
ds_read_b64_tr_b16 a[80:81], v5 offset:49152
v_mfma_f32_16x16x32_bf16 v[160:163], a[88:91], a[40:43], v[160:163]
ds_read_b64_tr_b16 a[82:83], v5 offset:50176
v_mfma_f32_16x16x32_bf16 v[168:171], a[88:91], a[48:51], v[168:171]
ds_read_b64_tr_b16 a[84:85], v5 offset:57344
v_mfma_f32_16x16x32_bf16 v[168:171], a[92:95], a[52:55], v[168:171]
ds_read_b64_tr_b16 a[86:87], v5 offset:58368
v_mfma_f32_16x16x32_bf16 v[176:179], a[92:95], a[60:63], v[176:179]
s_xor_b32 m0, s84, 32768
global_load_dwordx4 a[164:167], v19, s[22:23] offset:512
v_mfma_f32_16x16x32_bf16 v[176:179], a[88:91], a[56:59], v[176:179]
s_xor_b32 s64, s70, 384
ds_read_b64_tr_b16 a[88:89], v6 offset:49152
v_mfma_f32_16x16x32_bf16 v[180:183], a[96:99], a[56:59], v[180:183]
buffer_load_dwordx4 v12, s[32:35], s64 offen lds
v_mfma_f32_16x16x32_bf16 v[180:183], a[100:103], a[60:63], v[180:183]
ds_read_b64_tr_b16 a[90:91], v6 offset:50176
v_mfma_f32_16x16x32_bf16 v[172:175], a[100:103], a[52:55], v[172:175]
ds_read_b64_tr_b16 a[92:93], v6 offset:57344
v_mfma_f32_16x16x32_bf16 v[172:175], a[96:99], a[48:51], v[172:175]
ds_read_b64_tr_b16 a[94:95], v6 offset:58368
v_mfma_f32_16x16x32_bf16 v[164:167], a[96:99], a[40:43], v[164:167]
v_mfma_f32_16x16x32_bf16 v[164:167], a[100:103], a[44:47], v[164:167]
s_xor_b32 m0, s84, 33792
v_mfma_f32_16x16x32_bf16 v[156:159], a[100:103], a[36:39], v[156:159]
s_xor_b32 s64, s70, 8576
v_mfma_f32_16x16x32_bf16 v[156:159], a[96:99], a[32:35], v[156:159]
buffer_load_dwordx4 v13, s[32:35], s64 offen lds
v_mfma_f32_16x16x32_bf16 v[24:27], a[104:107], a[32:35], v[24:27]
s_waitcnt lgkmcnt(4)
ds_read_b64_tr_b16 a[96:97], v7 offset:49152
v_mfma_f32_16x16x32_bf16 v[24:27], a[108:111], a[36:39], v[24:27]
ds_read_b64_tr_b16 a[98:99], v7 offset:50176
v_mfma_f32_16x16x32_bf16 v[40:43], a[108:111], a[44:47], v[40:43]
ds_read_b64_tr_b16 a[100:101], v7 offset:57344
v_mfma_f32_16x16x32_bf16 v[40:43], a[104:107], a[40:43], v[40:43]
ds_read_b64_tr_b16 a[102:103], v7 offset:58368
v_mfma_f32_16x16x32_bf16 v[56:59], a[104:107], a[48:51], v[56:59]
s_xor_b32 m0, s84, 34816
v_mfma_f32_16x16x32_bf16 v[56:59], a[108:111], a[52:55], v[56:59]
s_xor_b32 s64, s70, 16768
v_mfma_f32_16x16x32_bf16 v[72:75], a[108:111], a[60:63], v[72:75]
s_waitcnt vmcnt(12)
buffer_load_dwordx4 v12, s[32:35], s64 offen lds
v_mfma_f32_16x16x32_bf16 v[72:75], a[104:107], a[56:59], v[72:75]
ds_read_b64_tr_b16 a[104:105], v8 offset:49152
v_mfma_f32_16x16x32_bf16 v[136:139], a[112:115], a[56:59], v[136:139]
ds_read_b64_tr_b16 a[106:107], v8 offset:50176
v_mfma_f32_16x16x32_bf16 v[136:139], a[116:119], a[60:63], v[136:139]
ds_read_b64_tr_b16 a[108:109], v8 offset:57344
v_add_u32 v4, 0x8000, v4
v_mfma_f32_16x16x32_bf16 v[120:123], a[116:119], a[52:55], v[120:123]
ds_read_b64_tr_b16 a[110:111], v8 offset:58368
v_mfma_f32_16x16x32_bf16 v[120:123], a[112:115], a[48:51], v[120:123]
s_xor_b32 m0, s84, 35840
ds_read_b128 a[0:3], v2 offset:0
v_mfma_f32_16x16x32_bf16 v[104:107], a[112:115], a[40:43], v[104:107]
s_xor_b32 s64, s70, 24960
global_load_dwordx4 a[152:155], v18, s[4:5] offset:1024
v_mfma_f32_16x16x32_bf16 v[104:107], a[116:119], a[44:47], v[104:107]
buffer_load_dwordx4 v13, s[32:35], s64 offen lds
v_mfma_f32_16x16x32_bf16 v[88:91], a[116:119], a[36:39], v[88:91]
ds_read_b128 a[4:7], v3 offset:0
v_mfma_f32_16x16x32_bf16 v[88:91], a[112:115], a[32:35], v[88:91]
ds_read_b128 a[8:11], v2 offset:2048
v_mfma_f32_16x16x32_bf16 v[28:31], a[32:35], a[72:75], v[28:31]
ds_read_b128 a[12:15], v3 offset:2048
v_mfma_f32_16x16x32_bf16 v[28:31], a[36:39], a[76:79], v[28:31]
ds_read_b128 a[16:19], v2 offset:4096
v_add_u32 v5, 0x8000, v5
v_mfma_f32_16x16x32_bf16 v[44:47], a[44:47], a[76:79], v[44:47]
s_xor_b32 m0, s84, 36864
ds_read_b128 a[20:23], v3 offset:4096
v_mfma_f32_16x16x32_bf16 v[44:47], a[40:43], a[72:75], v[44:47]
s_xor_b32 s64, s70, 33152
ds_read_b128 a[24:27], v2 offset:6144
v_mfma_f32_16x16x32_bf16 v[60:63], a[48:51], a[72:75], v[60:63]
buffer_load_dwordx4 v12, s[32:35], s64 offen lds
v_mfma_f32_16x16x32_bf16 v[60:63], a[52:55], a[76:79], v[60:63]
ds_read_b128 a[28:31], v3 offset:6144
v_mfma_f32_16x16x32_bf16 v[76:79], a[60:63], a[76:79], v[76:79]
ds_read_b64_tr_b16 a[112:113], v9 offset:49152
v_mfma_f32_16x16x32_bf16 v[76:79], a[56:59], a[72:75], v[76:79]
ds_read_b64_tr_b16 a[114:115], v9 offset:50176
v_mfma_f32_16x16x32_bf16 v[140:143], a[56:59], a[80:83], v[140:143]
ds_read_b64_tr_b16 a[116:117], v9 offset:57344
v_mfma_f32_16x16x32_bf16 v[140:143], a[60:63], a[84:87], v[140:143]
s_xor_b32 m0, s84, 37888
ds_read_b64_tr_b16 a[118:119], v9 offset:58368
v_add_u32 v6, 0x8000, v6
v_mfma_f32_16x16x32_bf16 v[124:127], a[52:55], a[84:87], v[124:127]
s_xor_b32 s64, s70, 41344
ds_read_b64_tr_b16 a[72:73], v10 offset:49152
v_mfma_f32_16x16x32_bf16 v[124:127], a[48:51], a[80:83], v[124:127]
buffer_load_dwordx4 v13, s[32:35], s64 offen lds
v_mfma_f32_16x16x32_bf16 v[108:111], a[40:43], a[80:83], v[108:111]
ds_read_b64_tr_b16 a[74:75], v10 offset:50176
v_mfma_f32_16x16x32_bf16 v[108:111], a[44:47], a[84:87], v[108:111]
ds_read_b64_tr_b16 a[76:77], v10 offset:57344
v_mfma_f32_16x16x32_bf16 v[92:95], a[36:39], a[84:87], v[92:95]
ds_read_b64_tr_b16 a[78:79], v10 offset:58368
v_mfma_f32_16x16x32_bf16 v[92:95], a[32:35], a[80:83], v[92:95]
s_waitcnt lgkmcnt(8)
ds_read_b64_tr_b16 a[80:81], v11 offset:49152
v_mfma_f32_16x16x32_bf16 v[32:35], a[32:35], a[88:91], v[32:35]
s_xor_b32 m0, s84, 38912
ds_read_b64_tr_b16 a[82:83], v11 offset:50176
v_mfma_f32_16x16x32_bf16 v[32:35], a[36:39], a[92:95], v[32:35]
s_xor_b32 s64, s70, 49536
ds_read_b64_tr_b16 a[84:85], v11 offset:57344
v_add_u32 v7, 0x8000, v7
v_mfma_f32_16x16x32_bf16 v[48:51], a[44:47], a[92:95], v[48:51]
buffer_load_dwordx4 v12, s[32:35], s64 offen lds
v_mfma_f32_16x16x32_bf16 v[48:51], a[40:43], a[88:91], v[48:51]
global_load_dwordx4 a[168:171], v19, s[22:23] offset:1024
v_mfma_f32_16x16x32_bf16 v[64:67], a[48:51], a[88:91], v[64:67]
ds_read_b64_tr_b16 a[86:87], v11 offset:58368
v_mfma_f32_16x16x32_bf16 v[64:67], a[52:55], a[92:95], v[64:67]
v_mfma_f32_16x16x32_bf16 v[80:83], a[60:63], a[92:95], v[80:83]
v_mfma_f32_16x16x32_bf16 v[80:83], a[56:59], a[88:91], v[80:83]
s_xor_b32 m0, s84, 39936
v_mfma_f32_16x16x32_bf16 v[144:147], a[56:59], a[96:99], v[144:147]
s_xor_b32 s64, s70, 57728
v_mfma_f32_16x16x32_bf16 v[144:147], a[60:63], a[100:103], v[144:147]
buffer_load_dwordx4 v13, s[32:35], s64 offen lds
v_mfma_f32_16x16x32_bf16 v[128:131], a[52:55], a[100:103], v[128:131]
v_add_u32 v8, 0x8000, v8
v_mfma_f32_16x16x32_bf16 v[128:131], a[48:51], a[96:99], v[128:131]
v_mfma_f32_16x16x32_bf16 v[112:115], a[40:43], a[96:99], v[112:115]
v_mfma_f32_16x16x32_bf16 v[112:115], a[44:47], a[100:103], v[112:115]
v_mfma_f32_16x16x32_bf16 v[96:99], a[36:39], a[100:103], v[96:99]
v_add_u32 v9, 0x8000, v9
v_add_u32 v10, 0x8000, v10
v_mfma_f32_16x16x32_bf16 v[96:99], a[32:35], a[96:99], v[96:99]
v_add_u32 v11, 0x8000, v11
v_mfma_f32_16x16x32_bf16 v[36:39], a[32:35], a[104:107], v[36:39]
v_mfma_f32_16x16x32_bf16 v[36:39], a[36:39], a[108:111], v[36:39]
v_mfma_f32_16x16x32_bf16 v[52:55], a[44:47], a[108:111], v[52:55]
s_waitcnt lgkmcnt(0)
s_barrier
v_mfma_f32_16x16x32_bf16 v[52:55], a[40:43], a[104:107], v[52:55]
s_xor_b32 m0, s77, 98304
ds_read_b64_tr_b16 a[88:89], v4 offset:32768
v_mfma_f32_16x16x32_bf16 v[68:71], a[48:51], a[104:107], v[68:71]
s_xor_b32 s64, s71, 2097152
ds_read_b64_tr_b16 a[90:91], v4 offset:33792
v_mfma_f32_16x16x32_bf16 v[68:71], a[52:55], a[108:111], v[68:71]
buffer_load_dwordx4 v14, s[36:39], s64 offen lds
v_mfma_f32_16x16x32_bf16 v[84:87], a[60:63], a[108:111], v[84:87]
ds_read_b64_tr_b16 a[92:93], v4 offset:40960
v_mfma_f32_16x16x32_bf16 v[84:87], a[56:59], a[104:107], v[84:87]
ds_read_b64_tr_b16 a[94:95], v4 offset:41984
v_mfma_f32_16x16x32_bf16 v[148:151], a[56:59], a[112:115], v[148:151]
global_load_dwordx4 a[156:159], v18, s[4:5] offset:1536
v_mfma_f32_16x16x32_bf16 v[148:151], a[60:63], a[116:119], v[148:151]
ds_read_b64_tr_b16 a[96:97], v5 offset:32768
v_mfma_f32_16x16x32_bf16 v[132:135], a[52:55], a[116:119], v[132:135]
ds_read_b64_tr_b16 a[98:99], v5 offset:33792
v_mfma_f32_16x16x32_bf16 v[132:135], a[48:51], a[112:115], v[132:135]
s_xor_b32 m0, s77, 99328
ds_read_b64_tr_b16 a[100:101], v5 offset:40960
v_mfma_f32_16x16x32_bf16 v[116:119], a[40:43], a[112:115], v[116:119]
s_xor_b32 s64, s71, 2129920
ds_read_b64_tr_b16 a[102:103], v5 offset:41984
v_mfma_f32_16x16x32_bf16 v[116:119], a[44:47], a[116:119], v[116:119]
buffer_load_dwordx4 v14, s[36:39], s64 offen lds
v_mfma_f32_16x16x32_bf16 v[100:103], a[36:39], a[116:119], v[100:103]
ds_read_b64_tr_b16 a[104:105], v6 offset:32768
v_mfma_f32_16x16x32_bf16 v[100:103], a[32:35], a[112:115], v[100:103]
ds_read_b64_tr_b16 a[106:107], v6 offset:33792
v_mfma_f32_16x16x32_bf16 v[248:251], a[32:35], a[72:75], v[248:251]
ds_read_b64_tr_b16 a[108:109], v6 offset:40960
v_mfma_f32_16x16x32_bf16 v[248:251], a[36:39], a[76:79], v[248:251]
ds_read_b64_tr_b16 a[110:111], v6 offset:41984
v_mfma_f32_16x16x32_bf16 v[252:255], a[44:47], a[76:79], v[252:255]
ds_read_b64_tr_b16 a[112:113], v7 offset:32768
v_mfma_f32_16x16x32_bf16 v[252:255], a[40:43], a[72:75], v[252:255]
s_xor_b32 m0, s77, 100352
ds_read_b64_tr_b16 a[114:115], v7 offset:33792
v_mfma_f32_16x16x32_bf16 a[120:123], a[48:51], a[72:75], a[120:123]
s_xor_b32 s64, s71, 2162688
ds_read_b64_tr_b16 a[116:117], v7 offset:40960
v_mfma_f32_16x16x32_bf16 a[120:123], a[52:55], a[76:79], a[120:123]
buffer_load_dwordx4 v15, s[36:39], s64 offen lds
v_mfma_f32_16x16x32_bf16 a[124:127], a[60:63], a[76:79], a[124:127]
ds_read_b64_tr_b16 a[118:119], v7 offset:41984
v_mfma_f32_16x16x32_bf16 a[124:127], a[56:59], a[72:75], a[124:127]
ds_read_b64_tr_b16 a[72:73], v8 offset:32768
v_mfma_f32_16x16x32_bf16 a[128:131], a[56:59], a[80:83], a[128:131]
ds_read_b64_tr_b16 a[74:75], v8 offset:33792
v_mfma_f32_16x16x32_bf16 a[128:131], a[60:63], a[84:87], a[128:131]
ds_read_b64_tr_b16 a[76:77], v8 offset:40960
v_mfma_f32_16x16x32_bf16 a[132:135], a[52:55], a[84:87], a[132:135]
ds_read_b64_tr_b16 a[78:79], v8 offset:41984
v_mfma_f32_16x16x32_bf16 a[132:135], a[48:51], a[80:83], a[132:135]
s_xor_b32 m0, s77, 101376
v_mfma_f32_16x16x32_bf16 a[136:139], a[40:43], a[80:83], a[136:139]
s_xor_b32 s64, s71, 2195456
v_mfma_f32_16x16x32_bf16 a[136:139], a[44:47], a[84:87], a[136:139]
buffer_load_dwordx4 v15, s[36:39], s64 offen lds
v_mfma_f32_16x16x32_bf16 a[140:143], a[36:39], a[84:87], a[140:143]
global_load_dwordx4 a[172:175], v19, s[22:23] offset:1536
v_mfma_f32_16x16x32_bf16 a[140:143], a[32:35], a[80:83], a[140:143]
s_waitcnt lgkmcnt(5)
ds_read_b64_tr_b16 a[80:81], v9 offset:32768
v_mfma_f32_16x16x32_bf16 v[184:187], a[88:91], a[0:3], v[184:187]
ds_read_b64_tr_b16 a[82:83], v9 offset:33792
v_mfma_f32_16x16x32_bf16 v[184:187], a[92:95], a[4:7], v[184:187]
ds_read_b64_tr_b16 a[84:85], v9 offset:40960
v_mfma_f32_16x16x32_bf16 v[192:195], a[92:95], a[12:15], v[192:195]
ds_read_b64_tr_b16 a[86:87], v9 offset:41984
v_mfma_f32_16x16x32_bf16 v[192:195], a[88:91], a[8:11], v[192:195]
s_xor_b32 m0, s77, 114688
s_add_u32 s17, s78, .-L_pc+6144
v_mfma_f32_16x16x32_bf16 v[200:203], a[88:91], a[16:19], v[200:203]
s_xor_b32 s64, s71, 2097152
buffer_load_dword a252, v16, s[88:91], s17 offen
v_mfma_f32_16x16x32_bf16 v[200:203], a[92:95], a[20:23], v[200:203]
buffer_load_dwordx4 v14, s[40:43], s64 offen lds
v_mfma_f32_16x16x32_bf16 v[208:211], a[92:95], a[28:31], v[208:211]
v_mfma_f32_16x16x32_bf16 v[208:211], a[88:91], a[24:27], v[208:211]
ds_read_b64_tr_b16 a[88:89], v10 offset:32768
v_mfma_f32_16x16x32_bf16 v[212:215], a[96:99], a[24:27], v[212:215]
ds_read_b64_tr_b16 a[90:91], v10 offset:33792
v_mfma_f32_16x16x32_bf16 v[212:215], a[100:103], a[28:31], v[212:215]
ds_read_b64_tr_b16 a[92:93], v10 offset:40960
v_mfma_f32_16x16x32_bf16 v[204:207], a[100:103], a[20:23], v[204:207]
ds_read_b64_tr_b16 a[94:95], v10 offset:41984
v_mfma_f32_16x16x32_bf16 v[204:207], a[96:99], a[16:19], v[204:207]
s_xor_b32 m0, s77, 115712
v_mfma_f32_16x16x32_bf16 v[196:199], a[96:99], a[8:11], v[196:199]
s_xor_b32 s64, s71, 2129920
v_mfma_f32_16x16x32_bf16 v[196:199], a[100:103], a[12:15], v[196:199]
buffer_load_dwordx4 v14, s[40:43], s64 offen lds
v_mfma_f32_16x16x32_bf16 v[188:191], a[100:103], a[4:7], v[188:191]
v_mfma_f32_16x16x32_bf16 v[188:191], a[96:99], a[0:3], v[188:191]
ds_read_b64_tr_b16 a[96:97], v11 offset:32768
v_mfma_f32_16x16x32_bf16 v[216:219], a[104:107], a[0:3], v[216:219]
ds_read_b64_tr_b16 a[98:99], v11 offset:33792
v_mfma_f32_16x16x32_bf16 v[216:219], a[108:111], a[4:7], v[216:219]
ds_read_b64_tr_b16 a[100:101], v11 offset:40960
v_mfma_f32_16x16x32_bf16 v[224:227], a[108:111], a[12:15], v[224:227]
ds_read_b64_tr_b16 a[102:103], v11 offset:41984
v_mfma_f32_16x16x32_bf16 v[224:227], a[104:107], a[8:11], v[224:227]
s_xor_b32 m0, s77, 116736
v_mfma_f32_16x16x32_bf16 v[232:235], a[104:107], a[16:19], v[232:235]
s_xor_b32 s64, s71, 2162688
buffer_store_dword v21, v20, s[44:47], s69 offen sc1
v_mfma_f32_16x16x32_bf16 v[232:235], a[108:111], a[20:23], v[232:235]
buffer_load_dwordx4 v15, s[40:43], s64 offen lds
v_mfma_f32_16x16x32_bf16 v[240:243], a[108:111], a[28:31], v[240:243]
v_mfma_f32_16x16x32_bf16 v[240:243], a[104:107], a[24:27], v[240:243]
ds_read_b64_tr_b16 a[104:105], v4 offset:49152
v_mfma_f32_16x16x32_bf16 v[244:247], a[112:115], a[24:27], v[244:247]
s_waitcnt lgkmcnt(5)
buffer_load_dword a252, v16, s[56:59], s81 offen
v_mfma_f32_16x16x32_bf16 v[244:247], a[116:119], a[28:31], v[244:247]
ds_read_b64_tr_b16 a[106:107], v4 offset:50176
v_mfma_f32_16x16x32_bf16 v[236:239], a[116:119], a[20:23], v[236:239]
ds_read_b64_tr_b16 a[108:109], v4 offset:57344
v_mfma_f32_16x16x32_bf16 v[236:239], a[112:115], a[16:19], v[236:239]
s_xor_b32 m0, s77, 117760
ds_read_b64_tr_b16 a[110:111], v4 offset:58368
v_mfma_f32_16x16x32_bf16 v[228:231], a[112:115], a[8:11], v[228:231]
s_xor_b32 s64, s71, 2195456
v_mfma_f32_16x16x32_bf16 v[228:231], a[116:119], a[12:15], v[228:231]
buffer_load_dwordx4 v15, s[40:43], s64 offen lds
v_mfma_f32_16x16x32_bf16 v[220:223], a[116:119], a[4:7], v[220:223]
v_mfma_f32_16x16x32_bf16 v[220:223], a[112:115], a[0:3], v[220:223]
ds_read_b64_tr_b16 a[112:113], v5 offset:49152
v_mfma_f32_16x16x32_bf16 v[152:155], a[72:75], a[0:3], v[152:155]
ds_read_b64_tr_b16 a[114:115], v5 offset:50176
v_mfma_f32_16x16x32_bf16 v[152:155], a[76:79], a[4:7], v[152:155]
ds_read_b64_tr_b16 a[116:117], v5 offset:57344
v_mfma_f32_16x16x32_bf16 v[160:163], a[76:79], a[12:15], v[160:163]
ds_read_b64_tr_b16 a[118:119], v5 offset:58368
v_mfma_f32_16x16x32_bf16 v[160:163], a[72:75], a[8:11], v[160:163]
v_mfma_f32_16x16x32_bf16 v[168:171], a[72:75], a[16:19], v[168:171]
v_mfma_f32_16x16x32_bf16 v[168:171], a[76:79], a[20:23], v[168:171]
v_mfma_f32_16x16x32_bf16 v[176:179], a[76:79], a[28:31], v[176:179]
s_xor_b32 m0, s84, 0
v_mfma_f32_16x16x32_bf16 v[176:179], a[72:75], a[24:27], v[176:179]
s_xor_b32 s64, s70, 512
ds_read_b64_tr_b16 a[72:73], v6 offset:49152
v_mfma_f32_16x16x32_bf16 v[180:183], a[80:83], a[24:27], v[180:183]
buffer_load_dwordx4 v12, s[32:35], s64 offen lds
v_mfma_f32_16x16x32_bf16 v[180:183], a[84:87], a[28:31], v[180:183]
ds_read_b64_tr_b16 a[74:75], v6 offset:50176
v_mfma_f32_16x16x32_bf16 v[172:175], a[84:87], a[20:23], v[172:175]
ds_read_b64_tr_b16 a[76:77], v6 offset:57344
v_mfma_f32_16x16x32_bf16 v[172:175], a[80:83], a[16:19], v[172:175]
ds_read_b64_tr_b16 a[78:79], v6 offset:58368
v_mfma_f32_16x16x32_bf16 v[164:167], a[80:83], a[8:11], v[164:167]
v_mfma_f32_16x16x32_bf16 v[164:167], a[84:87], a[12:15], v[164:167]
s_xor_b32 m0, s84, 1024
v_mfma_f32_16x16x32_bf16 v[156:159], a[84:87], a[4:7], v[156:159]
s_xor_b32 s64, s70, 8704
v_mfma_f32_16x16x32_bf16 v[156:159], a[80:83], a[0:3], v[156:159]
buffer_load_dwordx4 v13, s[32:35], s64 offen lds
v_mfma_f32_16x16x32_bf16 v[24:27], a[88:91], a[0:3], v[24:27]
ds_read_b64_tr_b16 a[80:81], v7 offset:49152
v_mfma_f32_16x16x32_bf16 v[24:27], a[92:95], a[4:7], v[24:27]
ds_read_b64_tr_b16 a[82:83], v7 offset:50176
v_mfma_f32_16x16x32_bf16 v[40:43], a[92:95], a[12:15], v[40:43]
ds_read_b64_tr_b16 a[84:85], v7 offset:57344
v_mfma_f32_16x16x32_bf16 v[40:43], a[88:91], a[8:11], v[40:43]
ds_read_b64_tr_b16 a[86:87], v7 offset:58368
v_mfma_f32_16x16x32_bf16 v[56:59], a[88:91], a[16:19], v[56:59]
s_xor_b32 m0, s84, 2048
v_mfma_f32_16x16x32_bf16 v[56:59], a[92:95], a[20:23], v[56:59]
s_xor_b32 s64, s70, 16896
v_mfma_f32_16x16x32_bf16 v[72:75], a[92:95], a[28:31], v[72:75]
s_waitcnt vmcnt(15)
buffer_load_dwordx4 v12, s[32:35], s64 offen lds
v_mfma_f32_16x16x32_bf16 v[72:75], a[88:91], a[24:27], v[72:75]
s_waitcnt lgkmcnt(4)
ds_read_b64_tr_b16 a[88:89], v8 offset:49152
v_mfma_f32_16x16x32_bf16 v[136:139], a[96:99], a[24:27], v[136:139]
buffer_load_dword a252, v1, s[60:63], s82 offen
v_mfma_f32_16x16x32_bf16 v[136:139], a[100:103], a[28:31], v[136:139]
ds_read_b64_tr_b16 a[90:91], v8 offset:50176
v_subrev_u32 v4, 0x8000, v4
v_mfma_f32_16x16x32_bf16 v[120:123], a[100:103], a[20:23], v[120:123]
ds_read_b64_tr_b16 a[92:93], v8 offset:57344
v_mfma_f32_16x16x32_bf16 v[120:123], a[96:99], a[16:19], v[120:123]
s_xor_b32 m0, s84, 3072
ds_read_b64_tr_b16 a[94:95], v8 offset:58368
v_mfma_f32_16x16x32_bf16 v[104:107], a[96:99], a[8:11], v[104:107]
s_xor_b32 s64, s70, 25088
ds_read_b128 a[32:35], v2 offset:32768
v_mfma_f32_16x16x32_bf16 v[104:107], a[100:103], a[12:15], v[104:107]
buffer_load_dwordx4 v13, s[32:35], s64 offen lds
v_mfma_f32_16x16x32_bf16 v[88:91], a[100:103], a[4:7], v[88:91]
ds_read_b128 a[36:39], v3 offset:32768
v_mfma_f32_16x16x32_bf16 v[88:91], a[96:99], a[0:3], v[88:91]
ds_read_b128 a[40:43], v2 offset:34816
v_mfma_f32_16x16x32_bf16 v[28:31], a[0:3], a[104:107], v[28:31]
ds_read_b128 a[44:47], v3 offset:34816
v_mfma_f32_16x16x32_bf16 v[28:31], a[4:7], a[108:111], v[28:31]
ds_read_b128 a[48:51], v2 offset:36864
v_subrev_u32 v5, 0x8000, v5
v_mfma_f32_16x16x32_bf16 v[44:47], a[12:15], a[108:111], v[44:47]
s_xor_b32 m0, s84, 4096
ds_read_b128 a[52:55], v3 offset:36864
v_mfma_f32_16x16x32_bf16 v[44:47], a[8:11], a[104:107], v[44:47]
s_xor_b32 s64, s70, 33280
ds_read_b128 a[56:59], v2 offset:38912
v_mfma_f32_16x16x32_bf16 v[60:63], a[16:19], a[104:107], v[60:63]
buffer_load_dwordx4 v12, s[32:35], s64 offen lds
v_mfma_f32_16x16x32_bf16 v[60:63], a[20:23], a[108:111], v[60:63]
ds_read_b128 a[60:63], v3 offset:38912
v_mfma_f32_16x16x32_bf16 v[76:79], a[28:31], a[108:111], v[76:79]
ds_read_b64_tr_b16 a[96:97], v9 offset:49152
v_mfma_f32_16x16x32_bf16 v[76:79], a[24:27], a[104:107], v[76:79]
ds_read_b64_tr_b16 a[98:99], v9 offset:50176
v_mfma_f32_16x16x32_bf16 v[140:143], a[24:27], a[112:115], v[140:143]
ds_read_b64_tr_b16 a[100:101], v9 offset:57344
v_mfma_f32_16x16x32_bf16 v[140:143], a[28:31], a[116:119], v[140:143]
s_xor_b32 m0, s84, 5120
ds_read_b64_tr_b16 a[102:103], v9 offset:58368
v_subrev_u32 v6, 0x8000, v6
v_mfma_f32_16x16x32_bf16 v[124:127], a[20:23], a[116:119], v[124:127]
s_xor_b32 s64, s70, 41472
ds_read_b64_tr_b16 a[104:105], v10 offset:49152
v_mfma_f32_16x16x32_bf16 v[124:127], a[16:19], a[112:115], v[124:127]
buffer_load_dwordx4 v13, s[32:35], s64 offen lds
v_mfma_f32_16x16x32_bf16 v[108:111], a[8:11], a[112:115], v[108:111]
ds_read_b64_tr_b16 a[106:107], v10 offset:50176
v_mfma_f32_16x16x32_bf16 v[108:111], a[12:15], a[116:119], v[108:111]
ds_read_b64_tr_b16 a[108:109], v10 offset:57344
v_mfma_f32_16x16x32_bf16 v[92:95], a[4:7], a[116:119], v[92:95]
ds_read_b64_tr_b16 a[110:111], v10 offset:58368
v_mfma_f32_16x16x32_bf16 v[92:95], a[0:3], a[112:115], v[92:95]
ds_read_b64_tr_b16 a[112:113], v11 offset:49152
v_mfma_f32_16x16x32_bf16 v[32:35], a[0:3], a[72:75], v[32:35]
s_xor_b32 m0, s84, 6144
ds_read_b64_tr_b16 a[114:115], v11 offset:50176
v_mfma_f32_16x16x32_bf16 v[32:35], a[4:7], a[76:79], v[32:35]
s_xor_b32 s64, s70, 49664
ds_read_b64_tr_b16 a[116:117], v11 offset:57344
v_subrev_u32 v7, 0x8000, v7
v_mfma_f32_16x16x32_bf16 v[48:51], a[12:15], a[76:79], v[48:51]
buffer_load_dwordx4 v12, s[32:35], s64 offen lds
v_mfma_f32_16x16x32_bf16 v[48:51], a[8:11], a[72:75], v[48:51]
ds_read_b64_tr_b16 a[118:119], v11 offset:58368
v_mfma_f32_16x16x32_bf16 v[64:67], a[16:19], a[72:75], v[64:67]
v_mfma_f32_16x16x32_bf16 v[64:67], a[20:23], a[76:79], v[64:67]
v_mfma_f32_16x16x32_bf16 v[80:83], a[28:31], a[76:79], v[80:83]
v_mfma_f32_16x16x32_bf16 v[80:83], a[24:27], a[72:75], v[80:83]
s_waitcnt lgkmcnt(5)
s_xor_b32 m0, s84, 7168
s_add_u32 s81, s81, 1048576
v_mfma_f32_16x16x32_bf16 v[144:147], a[24:27], a[80:83], v[144:147]
s_xor_b32 s64, s70, 57856
buffer_load_dword a252, v16, s[56:59], s81 offen
v_mfma_f32_16x16x32_bf16 v[144:147], a[28:31], a[84:87], v[144:147]
buffer_load_dwordx4 v13, s[32:35], s64 offen lds
v_mfma_f32_16x16x32_bf16 v[128:131], a[20:23], a[84:87], v[128:131]
v_subrev_u32 v8, 0x8000, v8
v_mfma_f32_16x16x32_bf16 v[128:131], a[16:19], a[80:83], v[128:131]
v_mfma_f32_16x16x32_bf16 v[112:115], a[8:11], a[80:83], v[112:115]
v_mfma_f32_16x16x32_bf16 v[112:115], a[12:15], a[84:87], v[112:115]
v_mfma_f32_16x16x32_bf16 v[96:99], a[4:7], a[84:87], v[96:99]
v_subrev_u32 v9, 0x8000, v9
v_subrev_u32 v10, 0x8000, v10
v_mfma_f32_16x16x32_bf16 v[96:99], a[0:3], a[80:83], v[96:99]
v_subrev_u32 v11, 0x8000, v11
v_mfma_f32_16x16x32_bf16 v[36:39], a[0:3], a[88:91], v[36:39]
v_mfma_f32_16x16x32_bf16 v[36:39], a[4:7], a[92:95], v[36:39]
v_mfma_f32_16x16x32_bf16 v[52:55], a[12:15], a[92:95], v[52:55]
s_waitcnt lgkmcnt(0)
s_barrier
v_mfma_f32_16x16x32_bf16 v[52:55], a[8:11], a[88:91], v[52:55]
s_xor_b32 m0, s77, 131072
ds_read_b64_tr_b16 a[72:73], v4 offset:0
v_mfma_f32_16x16x32_bf16 v[68:71], a[16:19], a[88:91], v[68:71]
s_xor_b32 s64, s71, 2621440
ds_read_b64_tr_b16 a[74:75], v4 offset:1024
v_mfma_f32_16x16x32_bf16 v[68:71], a[20:23], a[92:95], v[68:71]
buffer_load_dwordx4 v14, s[36:39], s64 offen lds
v_mfma_f32_16x16x32_bf16 v[84:87], a[28:31], a[92:95], v[84:87]
ds_read_b64_tr_b16 a[76:77], v4 offset:8192
v_mfma_f32_16x16x32_bf16 v[84:87], a[24:27], a[88:91], v[84:87]
ds_read_b64_tr_b16 a[78:79], v4 offset:9216
v_mfma_f32_16x16x32_bf16 v[148:151], a[24:27], a[96:99], v[148:151]
ds_read_b64_tr_b16 a[80:81], v5 offset:0
v_mfma_f32_16x16x32_bf16 v[148:151], a[28:31], a[100:103], v[148:151]
ds_read_b64_tr_b16 a[82:83], v5 offset:1024
v_mfma_f32_16x16x32_bf16 v[132:135], a[20:23], a[100:103], v[132:135]
ds_read_b64_tr_b16 a[84:85], v5 offset:8192
v_mfma_f32_16x16x32_bf16 v[132:135], a[16:19], a[96:99], v[132:135]
s_xor_b32 m0, s77, 132096
ds_read_b64_tr_b16 a[86:87], v5 offset:9216
v_mfma_f32_16x16x32_bf16 v[116:119], a[8:11], a[96:99], v[116:119]
s_xor_b32 s64, s71, 2654208
ds_read_b64_tr_b16 a[88:89], v6 offset:0
v_mfma_f32_16x16x32_bf16 v[116:119], a[12:15], a[100:103], v[116:119]
buffer_load_dwordx4 v14, s[36:39], s64 offen lds
v_mfma_f32_16x16x32_bf16 v[100:103], a[4:7], a[100:103], v[100:103]
ds_read_b64_tr_b16 a[90:91], v6 offset:1024
v_mfma_f32_16x16x32_bf16 v[100:103], a[0:3], a[96:99], v[100:103]
ds_read_b64_tr_b16 a[92:93], v6 offset:8192
v_mfma_f32_16x16x32_bf16 v[248:251], a[0:3], a[104:107], v[248:251]
ds_read_b64_tr_b16 a[94:95], v6 offset:9216
v_mfma_f32_16x16x32_bf16 v[248:251], a[4:7], a[108:111], v[248:251]
ds_read_b64_tr_b16 a[96:97], v7 offset:0
v_mfma_f32_16x16x32_bf16 v[252:255], a[12:15], a[108:111], v[252:255]
ds_read_b64_tr_b16 a[98:99], v7 offset:1024
v_mfma_f32_16x16x32_bf16 v[252:255], a[8:11], a[104:107], v[252:255]
s_xor_b32 m0, s77, 133120
ds_read_b64_tr_b16 a[100:101], v7 offset:8192
v_mfma_f32_16x16x32_bf16 a[120:123], a[16:19], a[104:107], a[120:123]
s_xor_b32 s64, s71, 2686976
ds_read_b64_tr_b16 a[102:103], v7 offset:9216
v_mfma_f32_16x16x32_bf16 a[120:123], a[20:23], a[108:111], a[120:123]
buffer_load_dwordx4 v15, s[36:39], s64 offen lds
v_mfma_f32_16x16x32_bf16 a[124:127], a[28:31], a[108:111], a[124:127]
v_mfma_f32_16x16x32_bf16 a[124:127], a[24:27], a[104:107], a[124:127]
s_add_u32 s82, s82, 1048576
ds_read_b64_tr_b16 a[104:105], v8 offset:0
v_mfma_f32_16x16x32_bf16 a[128:131], a[24:27], a[112:115], a[128:131]
buffer_load_dword a252, v1, s[60:63], s82 offen
v_mfma_f32_16x16x32_bf16 a[128:131], a[28:31], a[116:119], a[128:131]
ds_read_b64_tr_b16 a[106:107], v8 offset:1024
v_mfma_f32_16x16x32_bf16 a[132:135], a[20:23], a[116:119], a[132:135]
ds_read_b64_tr_b16 a[108:109], v8 offset:8192
v_mfma_f32_16x16x32_bf16 a[132:135], a[16:19], a[112:115], a[132:135]
s_xor_b32 m0, s77, 134144
ds_read_b64_tr_b16 a[110:111], v8 offset:9216
v_mfma_f32_16x16x32_bf16 a[136:139], a[8:11], a[112:115], a[136:139]
s_xor_b32 s64, s71, 2719744
v_mfma_f32_16x16x32_bf16 a[136:139], a[12:15], a[116:119], a[136:139]
buffer_load_dwordx4 v15, s[36:39], s64 offen lds
v_mfma_f32_16x16x32_bf16 a[140:143], a[4:7], a[116:119], a[140:143]
v_mfma_f32_16x16x32_bf16 a[140:143], a[0:3], a[112:115], a[140:143]
s_waitcnt lgkmcnt(4)
ds_read_b64_tr_b16 a[112:113], v9 offset:0
v_mfma_f32_16x16x32_bf16 v[184:187], a[72:75], a[32:35], v[184:187]
ds_read_b64_tr_b16 a[114:115], v9 offset:1024
v_mov_b32 v17, 0
v_mfma_f32_16x16x32_bf16 v[184:187], a[76:79], a[36:39], v[184:187]
ds_read_b64_tr_b16 a[116:117], v9 offset:8192
v_accvgpr_read_b32 v19, a144
v_mfma_f32_16x16x32_bf16 v[192:195], a[76:79], a[44:47], v[192:195]
ds_read_b64_tr_b16 a[118:119], v9 offset:9216
v_accvgpr_read_b32 v21, a160
v_mfma_f32_16x16x32_bf16 v[192:195], a[72:75], a[40:43], v[192:195]
s_xor_b32 m0, s77, 147456
v_lshlrev_b32 v18, 16, v19
v_and_b32 v19, 0xffff0000, v19
v_mfma_f32_16x16x32_bf16 v[200:203], a[72:75], a[48:51], v[200:203]
s_xor_b32 s64, s71, 2621440
v_lshlrev_b32 v20, 16, v21
v_and_b32 v21, 0xffff0000, v21
v_mfma_f32_16x16x32_bf16 v[200:203], a[76:79], a[52:55], v[200:203]
buffer_load_dwordx4 v14, s[40:43], s64 offen lds
v_mfma_f32_16x16x32_bf16 v[208:211], a[76:79], a[60:63], v[208:211]
v_mul_f32 v18, v18, v20
v_mul_f32 v19, v19, v21
v_mfma_f32_16x16x32_bf16 v[208:211], a[72:75], a[56:59], v[208:211]
ds_read_b64_tr_b16 a[72:73], v10 offset:0
v_cvt_pk_bf16_f32 v18, v18, v19
v_mfma_f32_16x16x32_bf16 v[212:215], a[80:83], a[56:59], v[212:215]
ds_read_b64_tr_b16 a[74:75], v10 offset:1024
v_lshlrev_b32 v19, 16, v18
v_mfma_f32_16x16x32_bf16 v[212:215], a[84:87], a[60:63], v[212:215]
ds_read_b64_tr_b16 a[76:77], v10 offset:8192
v_and_b32 v18, 0xffff0000, v18
v_mfma_f32_16x16x32_bf16 v[204:207], a[84:87], a[52:55], v[204:207]
ds_read_b64_tr_b16 a[78:79], v10 offset:9216
v_add_f32 v17, v17, v19
v_mfma_f32_16x16x32_bf16 v[204:207], a[80:83], a[48:51], v[204:207]
s_xor_b32 m0, s77, 148480
v_add_f32 v17, v17, v18
v_accvgpr_read_b32 v19, a145
v_mfma_f32_16x16x32_bf16 v[196:199], a[80:83], a[40:43], v[196:199]
s_xor_b32 s64, s71, 2654208
v_accvgpr_read_b32 v21, a161
v_lshlrev_b32 v18, 16, v19
v_mfma_f32_16x16x32_bf16 v[196:199], a[84:87], a[44:47], v[196:199]
buffer_load_dwordx4 v14, s[40:43], s64 offen lds
v_mfma_f32_16x16x32_bf16 v[188:191], a[84:87], a[36:39], v[188:191]
v_and_b32 v19, 0xffff0000, v19
v_lshlrev_b32 v20, 16, v21
v_mfma_f32_16x16x32_bf16 v[188:191], a[80:83], a[32:35], v[188:191]
ds_read_b64_tr_b16 a[80:81], v11 offset:0
v_and_b32 v21, 0xffff0000, v21
v_mfma_f32_16x16x32_bf16 v[216:219], a[88:91], a[32:35], v[216:219]
ds_read_b64_tr_b16 a[82:83], v11 offset:1024
v_mul_f32 v18, v18, v20
v_mfma_f32_16x16x32_bf16 v[216:219], a[92:95], a[36:39], v[216:219]
ds_read_b64_tr_b16 a[84:85], v11 offset:8192
v_mul_f32 v19, v19, v21
v_mfma_f32_16x16x32_bf16 v[224:227], a[92:95], a[44:47], v[224:227]
ds_read_b64_tr_b16 a[86:87], v11 offset:9216
v_cvt_pk_bf16_f32 v18, v18, v19
v_mfma_f32_16x16x32_bf16 v[224:227], a[88:91], a[40:43], v[224:227]
s_xor_b32 m0, s77, 149504
v_lshlrev_b32 v19, 16, v18
v_and_b32 v18, 0xffff0000, v18
v_mfma_f32_16x16x32_bf16 v[232:235], a[88:91], a[48:51], v[232:235]
s_xor_b32 s64, s71, 2686976
v_add_f32 v17, v17, v19
v_add_f32 v17, v17, v18
v_mfma_f32_16x16x32_bf16 v[232:235], a[92:95], a[52:55], v[232:235]
buffer_load_dwordx4 v15, s[40:43], s64 offen lds
v_mfma_f32_16x16x32_bf16 v[240:243], a[92:95], a[60:63], v[240:243]
v_accvgpr_read_b32 v19, a146
v_accvgpr_read_b32 v21, a162
v_mfma_f32_16x16x32_bf16 v[240:243], a[88:91], a[56:59], v[240:243]
s_add_u32 s81, s81, 1048576
ds_read_b64_tr_b16 a[88:89], v4 offset:16384
v_lshlrev_b32 v18, 16, v19
v_mfma_f32_16x16x32_bf16 v[244:247], a[96:99], a[56:59], v[244:247]
buffer_load_dword a252, v16, s[56:59], s81 offen
v_mfma_f32_16x16x32_bf16 v[244:247], a[100:103], a[60:63], v[244:247]
ds_read_b64_tr_b16 a[90:91], v4 offset:17408
v_and_b32 v19, 0xffff0000, v19
v_mfma_f32_16x16x32_bf16 v[236:239], a[100:103], a[52:55], v[236:239]
ds_read_b64_tr_b16 a[92:93], v4 offset:24576
v_lshlrev_b32 v20, 16, v21
v_mfma_f32_16x16x32_bf16 v[236:239], a[96:99], a[48:51], v[236:239]
s_xor_b32 m0, s77, 150528
ds_read_b64_tr_b16 a[94:95], v4 offset:25600
v_and_b32 v21, 0xffff0000, v21
v_mfma_f32_16x16x32_bf16 v[228:231], a[96:99], a[40:43], v[228:231]
s_xor_b32 s64, s71, 2719744
v_mul_f32 v18, v18, v20
v_mul_f32 v19, v19, v21
v_mfma_f32_16x16x32_bf16 v[228:231], a[100:103], a[44:47], v[228:231]
buffer_load_dwordx4 v15, s[40:43], s64 offen lds
v_mfma_f32_16x16x32_bf16 v[220:223], a[100:103], a[36:39], v[220:223]
v_cvt_pk_bf16_f32 v18, v18, v19
v_lshlrev_b32 v19, 16, v18
v_mfma_f32_16x16x32_bf16 v[220:223], a[96:99], a[32:35], v[220:223]
s_waitcnt lgkmcnt(4)
ds_read_b64_tr_b16 a[96:97], v5 offset:16384
v_and_b32 v18, 0xffff0000, v18
v_mfma_f32_16x16x32_bf16 v[152:155], a[104:107], a[32:35], v[152:155]
ds_read_b64_tr_b16 a[98:99], v5 offset:17408
v_add_f32 v17, v17, v19
v_mfma_f32_16x16x32_bf16 v[152:155], a[108:111], a[36:39], v[152:155]
ds_read_b64_tr_b16 a[100:101], v5 offset:24576
v_add_f32 v17, v17, v18
v_mfma_f32_16x16x32_bf16 v[160:163], a[108:111], a[44:47], v[160:163]
ds_read_b64_tr_b16 a[102:103], v5 offset:25600
v_accvgpr_read_b32 v19, a147
v_mfma_f32_16x16x32_bf16 v[160:163], a[104:107], a[40:43], v[160:163]
v_accvgpr_read_b32 v21, a163
v_lshlrev_b32 v18, 16, v19
v_mfma_f32_16x16x32_bf16 v[168:171], a[104:107], a[48:51], v[168:171]
v_and_b32 v19, 0xffff0000, v19
v_lshlrev_b32 v20, 16, v21
v_mfma_f32_16x16x32_bf16 v[168:171], a[108:111], a[52:55], v[168:171]
v_and_b32 v21, 0xffff0000, v21
v_mul_f32 v18, v18, v20
v_mfma_f32_16x16x32_bf16 v[176:179], a[108:111], a[60:63], v[176:179]
s_xor_b32 m0, s84, 32768
v_mul_f32 v19, v19, v21
v_cvt_pk_bf16_f32 v18, v18, v19
v_mfma_f32_16x16x32_bf16 v[176:179], a[104:107], a[56:59], v[176:179]
s_xor_b32 s64, s70, 640
ds_read_b64_tr_b16 a[104:105], v6 offset:16384
v_lshlrev_b32 v19, 16, v18
v_mfma_f32_16x16x32_bf16 v[180:183], a[112:115], a[56:59], v[180:183]
buffer_load_dwordx4 v12, s[32:35], s64 offen lds
v_mfma_f32_16x16x32_bf16 v[180:183], a[116:119], a[60:63], v[180:183]
ds_read_b64_tr_b16 a[106:107], v6 offset:17408
v_and_b32 v18, 0xffff0000, v18
v_mfma_f32_16x16x32_bf16 v[172:175], a[116:119], a[52:55], v[172:175]
ds_read_b64_tr_b16 a[108:109], v6 offset:24576
v_add_f32 v17, v17, v19
v_mfma_f32_16x16x32_bf16 v[172:175], a[112:115], a[48:51], v[172:175]
ds_read_b64_tr_b16 a[110:111], v6 offset:25600
v_add_f32 v17, v17, v18
v_mfma_f32_16x16x32_bf16 v[164:167], a[112:115], a[40:43], v[164:167]
v_accvgpr_read_b32 v19, a148
v_accvgpr_read_b32 v21, a164
v_mfma_f32_16x16x32_bf16 v[164:167], a[116:119], a[44:47], v[164:167]
s_xor_b32 m0, s84, 33792
v_lshlrev_b32 v18, 16, v19
v_and_b32 v19, 0xffff0000, v19
v_mfma_f32_16x16x32_bf16 v[156:159], a[116:119], a[36:39], v[156:159]
s_xor_b32 s64, s70, 8832
v_lshlrev_b32 v20, 16, v21
v_and_b32 v21, 0xffff0000, v21
v_mfma_f32_16x16x32_bf16 v[156:159], a[112:115], a[32:35], v[156:159]
buffer_load_dwordx4 v13, s[32:35], s64 offen lds
v_mfma_f32_16x16x32_bf16 v[24:27], a[72:75], a[32:35], v[24:27]
ds_read_b64_tr_b16 a[112:113], v7 offset:16384
v_mul_f32 v18, v18, v20
v_mfma_f32_16x16x32_bf16 v[24:27], a[76:79], a[36:39], v[24:27]
ds_read_b64_tr_b16 a[114:115], v7 offset:17408
v_mul_f32 v19, v19, v21
v_mfma_f32_16x16x32_bf16 v[40:43], a[76:79], a[44:47], v[40:43]
ds_read_b64_tr_b16 a[116:117], v7 offset:24576
v_cvt_pk_bf16_f32 v18, v18, v19
v_mfma_f32_16x16x32_bf16 v[40:43], a[72:75], a[40:43], v[40:43]
ds_read_b64_tr_b16 a[118:119], v7 offset:25600
v_lshlrev_b32 v19, 16, v18
v_mfma_f32_16x16x32_bf16 v[56:59], a[72:75], a[48:51], v[56:59]
s_xor_b32 m0, s84, 34816
v_and_b32 v18, 0xffff0000, v18
v_add_f32 v17, v17, v19
v_mfma_f32_16x16x32_bf16 v[56:59], a[76:79], a[52:55], v[56:59]
s_xor_b32 s64, s70, 17024
v_add_f32 v17, v17, v18
v_accvgpr_read_b32 v19, a149
v_mfma_f32_16x16x32_bf16 v[72:75], a[76:79], a[60:63], v[72:75]
s_waitcnt vmcnt(12)
buffer_load_dwordx4 v12, s[32:35], s64 offen lds
v_mfma_f32_16x16x32_bf16 v[72:75], a[72:75], a[56:59], v[72:75]
s_add_u32 s81, s81, 1048576
ds_read_b64_tr_b16 a[72:73], v8 offset:16384
v_accvgpr_read_b32 v21, a165
v_mfma_f32_16x16x32_bf16 v[136:139], a[80:83], a[56:59], v[136:139]
buffer_load_dword a252, v16, s[56:59], s81 offen
v_mfma_f32_16x16x32_bf16 v[136:139], a[84:87], a[60:63], v[136:139]
ds_read_b64_tr_b16 a[74:75], v8 offset:17408
v_lshlrev_b32 v18, 16, v19
v_mfma_f32_16x16x32_bf16 v[120:123], a[84:87], a[52:55], v[120:123]
ds_read_b64_tr_b16 a[76:77], v8 offset:24576
v_and_b32 v19, 0xffff0000, v19
v_mfma_f32_16x16x32_bf16 v[120:123], a[80:83], a[48:51], v[120:123]
s_xor_b32 m0, s84, 35840
ds_read_b64_tr_b16 a[78:79], v8 offset:25600
v_lshlrev_b32 v20, 16, v21
v_mfma_f32_16x16x32_bf16 v[104:107], a[80:83], a[40:43], v[104:107]
s_xor_b32 s64, s70, 25216
ds_read_b128 a[0:3], v2 offset:0
v_and_b32 v21, 0xffff0000, v21
v_mfma_f32_16x16x32_bf16 v[104:107], a[84:87], a[44:47], v[104:107]
buffer_load_dwordx4 v13, s[32:35], s64 offen lds
v_mfma_f32_16x16x32_bf16 v[88:91], a[84:87], a[36:39], v[88:91]
ds_read_b128 a[4:7], v3 offset:0
v_mul_f32 v18, v18, v20
v_mfma_f32_16x16x32_bf16 v[88:91], a[80:83], a[32:35], v[88:91]
s_waitcnt lgkmcnt(6)
ds_read_b128 a[8:11], v2 offset:2048
v_mul_f32 v19, v19, v21
v_mfma_f32_16x16x32_bf16 v[28:31], a[32:35], a[88:91], v[28:31]
ds_read_b128 a[12:15], v3 offset:2048
v_cvt_pk_bf16_f32 v18, v18, v19
v_mfma_f32_16x16x32_bf16 v[28:31], a[36:39], a[92:95], v[28:31]
ds_read_b128 a[16:19], v2 offset:4096
v_lshlrev_b32 v19, 16, v18
v_mfma_f32_16x16x32_bf16 v[44:47], a[44:47], a[92:95], v[44:47]
s_xor_b32 m0, s84, 36864
ds_read_b128 a[20:23], v3 offset:4096
v_and_b32 v18, 0xffff0000, v18
v_mfma_f32_16x16x32_bf16 v[44:47], a[40:43], a[88:91], v[44:47]
s_xor_b32 s64, s70, 33408
ds_read_b128 a[24:27], v2 offset:6144
v_add_f32 v17, v17, v19
v_mfma_f32_16x16x32_bf16 v[60:63], a[48:51], a[88:91], v[60:63]
buffer_load_dwordx4 v12, s[32:35], s64 offen lds
v_mfma_f32_16x16x32_bf16 v[60:63], a[52:55], a[92:95], v[60:63]
ds_read_b128 a[28:31], v3 offset:6144
v_add_f32 v17, v17, v18
v_mfma_f32_16x16x32_bf16 v[76:79], a[60:63], a[92:95], v[76:79]
ds_read_b64_tr_b16 a[80:81], v9 offset:16384
v_accvgpr_read_b32 v19, a150
v_mfma_f32_16x16x32_bf16 v[76:79], a[56:59], a[88:91], v[76:79]
ds_read_b64_tr_b16 a[82:83], v9 offset:17408
v_accvgpr_read_b32 v21, a166
v_mfma_f32_16x16x32_bf16 v[140:143], a[56:59], a[96:99], v[140:143]
ds_read_b64_tr_b16 a[84:85], v9 offset:24576
v_lshlrev_b32 v18, 16, v19
v_mfma_f32_16x16x32_bf16 v[140:143], a[60:63], a[100:103], v[140:143]
s_xor_b32 m0, s84, 37888
ds_read_b64_tr_b16 a[86:87], v9 offset:25600
v_and_b32 v19, 0xffff0000, v19
v_mfma_f32_16x16x32_bf16 v[124:127], a[52:55], a[100:103], v[124:127]
s_xor_b32 s64, s70, 41600
ds_read_b64_tr_b16 a[88:89], v10 offset:16384
v_lshlrev_b32 v20, 16, v21
v_mfma_f32_16x16x32_bf16 v[124:127], a[48:51], a[96:99], v[124:127]
buffer_load_dwordx4 v13, s[32:35], s64 offen lds
v_mfma_f32_16x16x32_bf16 v[108:111], a[40:43], a[96:99], v[108:111]
ds_read_b64_tr_b16 a[90:91], v10 offset:17408
v_and_b32 v21, 0xffff0000, v21
v_mfma_f32_16x16x32_bf16 v[108:111], a[44:47], a[100:103], v[108:111]
ds_read_b64_tr_b16 a[92:93], v10 offset:24576
v_mul_f32 v18, v18, v20
v_mfma_f32_16x16x32_bf16 v[92:95], a[36:39], a[100:103], v[92:95]
ds_read_b64_tr_b16 a[94:95], v10 offset:25600
v_mul_f32 v19, v19, v21
v_mfma_f32_16x16x32_bf16 v[92:95], a[32:35], a[96:99], v[92:95]
ds_read_b64_tr_b16 a[96:97], v11 offset:16384
v_cvt_pk_bf16_f32 v18, v18, v19
v_mfma_f32_16x16x32_bf16 v[32:35], a[32:35], a[104:107], v[32:35]
s_xor_b32 m0, s84, 38912
ds_read_b64_tr_b16 a[98:99], v11 offset:17408
v_lshlrev_b32 v19, 16, v18
v_mfma_f32_16x16x32_bf16 v[32:35], a[36:39], a[108:111], v[32:35]
s_xor_b32 s64, s70, 49792
ds_read_b64_tr_b16 a[100:101], v11 offset:24576
v_and_b32 v18, 0xffff0000, v18
v_mfma_f32_16x16x32_bf16 v[48:51], a[44:47], a[108:111], v[48:51]
buffer_load_dwordx4 v12, s[32:35], s64 offen lds
v_mfma_f32_16x16x32_bf16 v[48:51], a[40:43], a[104:107], v[48:51]
ds_read_b64_tr_b16 a[102:103], v11 offset:25600
v_add_f32 v17, v17, v19
v_mfma_f32_16x16x32_bf16 v[64:67], a[48:51], a[104:107], v[64:67]
v_add_f32 v17, v17, v18
v_accvgpr_read_b32 v19, a151
v_mfma_f32_16x16x32_bf16 v[64:67], a[52:55], a[108:111], v[64:67]
v_accvgpr_read_b32 v21, a167
v_lshlrev_b32 v18, 16, v19
v_mfma_f32_16x16x32_bf16 v[80:83], a[60:63], a[108:111], v[80:83]
s_add_u32 s82, s82, 1048576
v_and_b32 v19, 0xffff0000, v19
v_lshlrev_b32 v20, 16, v21
v_mfma_f32_16x16x32_bf16 v[80:83], a[56:59], a[104:107], v[80:83]
s_xor_b32 m0, s84, 39936
v_and_b32 v21, 0xffff0000, v21
v_mul_f32 v18, v18, v20
v_mfma_f32_16x16x32_bf16 v[144:147], a[56:59], a[112:115], v[144:147]
s_xor_b32 s64, s70, 57984
buffer_load_dword a252, v1, s[60:63], s82 offen
v_mfma_f32_16x16x32_bf16 v[144:147], a[60:63], a[116:119], v[144:147]
buffer_load_dwordx4 v13, s[32:35], s64 offen lds
v_mfma_f32_16x16x32_bf16 v[128:131], a[52:55], a[116:119], v[128:131]
v_mul_f32 v19, v19, v21
v_cvt_pk_bf16_f32 v18, v18, v19
v_mfma_f32_16x16x32_bf16 v[128:131], a[48:51], a[112:115], v[128:131]
v_lshlrev_b32 v19, 16, v18
v_and_b32 v18, 0xffff0000, v18
v_mfma_f32_16x16x32_bf16 v[112:115], a[40:43], a[112:115], v[112:115]
v_add_f32 v17, v17, v19
v_add_f32 v17, v17, v18
v_mfma_f32_16x16x32_bf16 v[112:115], a[44:47], a[116:119], v[112:115]
v_accvgpr_read_b32 v19, a152
v_accvgpr_read_b32 v21, a168
v_mfma_f32_16x16x32_bf16 v[96:99], a[36:39], a[116:119], v[96:99]
v_lshlrev_b32 v18, 16, v19
v_and_b32 v19, 0xffff0000, v19
v_mfma_f32_16x16x32_bf16 v[96:99], a[32:35], a[112:115], v[96:99]
s_waitcnt lgkmcnt(0)
v_lshlrev_b32 v20, 16, v21
v_and_b32 v21, 0xffff0000, v21
v_mfma_f32_16x16x32_bf16 v[36:39], a[32:35], a[72:75], v[36:39]
v_mul_f32 v18, v18, v20
v_mul_f32 v19, v19, v21
v_mfma_f32_16x16x32_bf16 v[36:39], a[36:39], a[76:79], v[36:39]
v_cvt_pk_bf16_f32 v18, v18, v19
v_lshlrev_b32 v19, 16, v18
v_mfma_f32_16x16x32_bf16 v[52:55], a[44:47], a[76:79], v[52:55]
s_waitcnt lgkmcnt(0)
s_barrier
v_mfma_f32_16x16x32_bf16 v[52:55], a[40:43], a[72:75], v[52:55]
s_xor_b32 m0, s77, 65536
ds_read_b64_tr_b16 a[104:105], v4 offset:32768
v_and_b32 v18, 0xffff0000, v18
v_mfma_f32_16x16x32_bf16 v[68:71], a[48:51], a[72:75], v[68:71]
s_xor_b32 s64, s71, 3145728
ds_read_b64_tr_b16 a[106:107], v4 offset:33792
v_add_f32 v17, v17, v19
v_mfma_f32_16x16x32_bf16 v[68:71], a[52:55], a[76:79], v[68:71]
buffer_load_dwordx4 v14, s[36:39], s64 offen lds
v_mfma_f32_16x16x32_bf16 v[84:87], a[60:63], a[76:79], v[84:87]
ds_read_b64_tr_b16 a[108:109], v4 offset:40960
v_add_f32 v17, v17, v18
v_mfma_f32_16x16x32_bf16 v[84:87], a[56:59], a[72:75], v[84:87]
ds_read_b64_tr_b16 a[110:111], v4 offset:41984
v_accvgpr_read_b32 v19, a153
v_mfma_f32_16x16x32_bf16 v[148:151], a[56:59], a[80:83], v[148:151]
ds_read_b64_tr_b16 a[112:113], v5 offset:32768
v_accvgpr_read_b32 v21, a169
v_mfma_f32_16x16x32_bf16 v[148:151], a[60:63], a[84:87], v[148:151]
ds_read_b64_tr_b16 a[114:115], v5 offset:33792
v_lshlrev_b32 v18, 16, v19
v_mfma_f32_16x16x32_bf16 v[132:135], a[52:55], a[84:87], v[132:135]
ds_read_b64_tr_b16 a[116:117], v5 offset:40960
v_and_b32 v19, 0xffff0000, v19
v_mfma_f32_16x16x32_bf16 v[132:135], a[48:51], a[80:83], v[132:135]
s_xor_b32 m0, s77, 66560
ds_read_b64_tr_b16 a[118:119], v5 offset:41984
v_lshlrev_b32 v20, 16, v21
v_mfma_f32_16x16x32_bf16 v[116:119], a[40:43], a[80:83], v[116:119]
s_xor_b32 s64, s71, 3178496
ds_read_b64_tr_b16 a[72:73], v6 offset:32768
v_and_b32 v21, 0xffff0000, v21
v_mfma_f32_16x16x32_bf16 v[116:119], a[44:47], a[84:87], v[116:119]
buffer_load_dwordx4 v14, s[36:39], s64 offen lds
v_mfma_f32_16x16x32_bf16 v[100:103], a[36:39], a[84:87], v[100:103]
ds_read_b64_tr_b16 a[74:75], v6 offset:33792
v_mul_f32 v18, v18, v20
v_mfma_f32_16x16x32_bf16 v[100:103], a[32:35], a[80:83], v[100:103]
ds_read_b64_tr_b16 a[76:77], v6 offset:40960
v_mul_f32 v19, v19, v21
v_mfma_f32_16x16x32_bf16 v[248:251], a[32:35], a[88:91], v[248:251]
ds_read_b64_tr_b16 a[78:79], v6 offset:41984
v_cvt_pk_bf16_f32 v18, v18, v19
v_mfma_f32_16x16x32_bf16 v[248:251], a[36:39], a[92:95], v[248:251]
ds_read_b64_tr_b16 a[80:81], v7 offset:32768
v_lshlrev_b32 v19, 16, v18
v_mfma_f32_16x16x32_bf16 v[252:255], a[44:47], a[92:95], v[252:255]
ds_read_b64_tr_b16 a[82:83], v7 offset:33792
v_and_b32 v18, 0xffff0000, v18
v_mfma_f32_16x16x32_bf16 v[252:255], a[40:43], a[88:91], v[252:255]
s_xor_b32 m0, s77, 67584
ds_read_b64_tr_b16 a[84:85], v7 offset:40960
v_add_f32 v17, v17, v19
v_mfma_f32_16x16x32_bf16 a[120:123], a[48:51], a[88:91], a[120:123]
s_xor_b32 s64, s71, 3211264
ds_read_b64_tr_b16 a[86:87], v7 offset:41984
v_add_f32 v17, v17, v18
v_mfma_f32_16x16x32_bf16 a[120:123], a[52:55], a[92:95], a[120:123]
buffer_load_dwordx4 v15, s[36:39], s64 offen lds
v_mfma_f32_16x16x32_bf16 a[124:127], a[60:63], a[92:95], a[124:127]
v_accvgpr_read_b32 v19, a154
v_accvgpr_read_b32 v21, a170
v_mfma_f32_16x16x32_bf16 a[124:127], a[56:59], a[88:91], a[124:127]
s_add_u32 s81, s81, 1048576
ds_read_b64_tr_b16 a[88:89], v8 offset:32768
v_lshlrev_b32 v18, 16, v19
v_mfma_f32_16x16x32_bf16 a[128:131], a[56:59], a[96:99], a[128:131]
buffer_load_dword a252, v16, s[56:59], s81 offen
v_mfma_f32_16x16x32_bf16 a[128:131], a[60:63], a[100:103], a[128:131]
ds_read_b64_tr_b16 a[90:91], v8 offset:33792
v_and_b32 v19, 0xffff0000, v19
v_mfma_f32_16x16x32_bf16 a[132:135], a[52:55], a[100:103], a[132:135]
ds_read_b64_tr_b16 a[92:93], v8 offset:40960
v_lshlrev_b32 v20, 16, v21
v_mfma_f32_16x16x32_bf16 a[132:135], a[48:51], a[96:99], a[132:135]
s_xor_b32 m0, s77, 68608
ds_read_b64_tr_b16 a[94:95], v8 offset:41984
v_and_b32 v21, 0xffff0000, v21
v_mfma_f32_16x16x32_bf16 a[136:139], a[40:43], a[96:99], a[136:139]
s_xor_b32 s64, s71, 3244032
v_mul_f32 v18, v18, v20
v_mul_f32 v19, v19, v21
v_mfma_f32_16x16x32_bf16 a[136:139], a[44:47], a[100:103], a[136:139]
buffer_load_dwordx4 v15, s[36:39], s64 offen lds
v_mfma_f32_16x16x32_bf16 a[140:143], a[36:39], a[100:103], a[140:143]
v_cvt_pk_bf16_f32 v18, v18, v19
v_lshlrev_b32 v19, 16, v18
v_mfma_f32_16x16x32_bf16 a[140:143], a[32:35], a[96:99], a[140:143]
s_waitcnt lgkmcnt(4)
ds_read_b64_tr_b16 a[96:97], v9 offset:32768
v_and_b32 v18, 0xffff0000, v18
v_mfma_f32_16x16x32_bf16 v[184:187], a[104:107], a[0:3], v[184:187]
ds_read_b64_tr_b16 a[98:99], v9 offset:33792
v_add_f32 v17, v17, v19
v_mfma_f32_16x16x32_bf16 v[184:187], a[108:111], a[4:7], v[184:187]
ds_read_b64_tr_b16 a[100:101], v9 offset:40960
v_add_f32 v17, v17, v18
v_mfma_f32_16x16x32_bf16 v[192:195], a[108:111], a[12:15], v[192:195]
s_add_u32 s17, s78, .-L_pc+6144
ds_read_b64_tr_b16 a[102:103], v9 offset:41984
v_accvgpr_read_b32 v19, a155
v_mfma_f32_16x16x32_bf16 v[192:195], a[104:107], a[8:11], v[192:195]
s_xor_b32 m0, s77, 81920
v_accvgpr_read_b32 v21, a171
v_lshlrev_b32 v18, 16, v19
v_mfma_f32_16x16x32_bf16 v[200:203], a[104:107], a[16:19], v[200:203]
s_xor_b32 s64, s71, 3145728
buffer_load_dword a252, v16, s[88:91], s17 offen
v_mfma_f32_16x16x32_bf16 v[200:203], a[108:111], a[20:23], v[200:203]
buffer_load_dwordx4 v14, s[40:43], s64 offen lds
v_mfma_f32_16x16x32_bf16 v[208:211], a[108:111], a[28:31], v[208:211]
v_and_b32 v19, 0xffff0000, v19
v_lshlrev_b32 v20, 16, v21
v_mfma_f32_16x16x32_bf16 v[208:211], a[104:107], a[24:27], v[208:211]
ds_read_b64_tr_b16 a[104:105], v10 offset:32768
v_and_b32 v21, 0xffff0000, v21
v_mfma_f32_16x16x32_bf16 v[212:215], a[112:115], a[24:27], v[212:215]
ds_read_b64_tr_b16 a[106:107], v10 offset:33792
v_mul_f32 v18, v18, v20
v_mfma_f32_16x16x32_bf16 v[212:215], a[116:119], a[28:31], v[212:215]
ds_read_b64_tr_b16 a[108:109], v10 offset:40960
v_mul_f32 v19, v19, v21
v_mfma_f32_16x16x32_bf16 v[204:207], a[116:119], a[20:23], v[204:207]
ds_read_b64_tr_b16 a[110:111], v10 offset:41984
v_cvt_pk_bf16_f32 v18, v18, v19
v_mfma_f32_16x16x32_bf16 v[204:207], a[112:115], a[16:19], v[204:207]
s_xor_b32 m0, s77, 82944
v_lshlrev_b32 v19, 16, v18
v_and_b32 v18, 0xffff0000, v18
v_mfma_f32_16x16x32_bf16 v[196:199], a[112:115], a[8:11], v[196:199]
s_xor_b32 s64, s71, 3178496
v_add_f32 v17, v17, v19
v_add_f32 v17, v17, v18
v_mfma_f32_16x16x32_bf16 v[196:199], a[116:119], a[12:15], v[196:199]
buffer_load_dwordx4 v14, s[40:43], s64 offen lds
v_mfma_f32_16x16x32_bf16 v[188:191], a[116:119], a[4:7], v[188:191]
v_accvgpr_read_b32 v19, a156
v_accvgpr_read_b32 v21, a172
v_mfma_f32_16x16x32_bf16 v[188:191], a[112:115], a[0:3], v[188:191]
ds_read_b64_tr_b16 a[112:113], v11 offset:32768
v_lshlrev_b32 v18, 16, v19
v_mfma_f32_16x16x32_bf16 v[216:219], a[72:75], a[0:3], v[216:219]
ds_read_b64_tr_b16 a[114:115], v11 offset:33792
v_and_b32 v19, 0xffff0000, v19
v_mfma_f32_16x16x32_bf16 v[216:219], a[76:79], a[4:7], v[216:219]
ds_read_b64_tr_b16 a[116:117], v11 offset:40960
v_lshlrev_b32 v20, 16, v21
v_mfma_f32_16x16x32_bf16 v[224:227], a[76:79], a[12:15], v[224:227]
ds_read_b64_tr_b16 a[118:119], v11 offset:41984
v_and_b32 v21, 0xffff0000, v21
v_mfma_f32_16x16x32_bf16 v[224:227], a[72:75], a[8:11], v[224:227]
s_xor_b32 m0, s77, 83968
v_mul_f32 v18, v18, v20
v_mul_f32 v19, v19, v21
v_mfma_f32_16x16x32_bf16 v[232:235], a[72:75], a[16:19], v[232:235]
s_xor_b32 s64, s71, 3211264
v_cvt_pk_bf16_f32 v18, v18, v19
v_lshlrev_b32 v19, 16, v18
v_mfma_f32_16x16x32_bf16 v[232:235], a[76:79], a[20:23], v[232:235]
buffer_load_dwordx4 v15, s[40:43], s64 offen lds
v_mfma_f32_16x16x32_bf16 v[240:243], a[76:79], a[28:31], v[240:243]
v_and_b32 v18, 0xffff0000, v18
v_add_f32 v17, v17, v19
v_mfma_f32_16x16x32_bf16 v[240:243], a[72:75], a[24:27], v[240:243]
s_add_u32 s82, s82, 1048576
ds_read_b64_tr_b16 a[72:73], v4 offset:49152
v_add_f32 v17, v17, v18
v_mfma_f32_16x16x32_bf16 v[244:247], a[80:83], a[24:27], v[244:247]
buffer_load_dword a252, v1, s[60:63], s82 offen
v_mfma_f32_16x16x32_bf16 v[244:247], a[84:87], a[28:31], v[244:247]
ds_read_b64_tr_b16 a[74:75], v4 offset:50176
v_accvgpr_read_b32 v19, a157
v_mfma_f32_16x16x32_bf16 v[236:239], a[84:87], a[20:23], v[236:239]
ds_read_b64_tr_b16 a[76:77], v4 offset:57344
v_accvgpr_read_b32 v21, a173
v_mfma_f32_16x16x32_bf16 v[236:239], a[80:83], a[16:19], v[236:239]
s_xor_b32 m0, s77, 84992
ds_read_b64_tr_b16 a[78:79], v4 offset:58368
v_lshlrev_b32 v18, 16, v19
v_mfma_f32_16x16x32_bf16 v[228:231], a[80:83], a[8:11], v[228:231]
s_xor_b32 s64, s71, 3244032
v_and_b32 v19, 0xffff0000, v19
v_lshlrev_b32 v20, 16, v21
v_mfma_f32_16x16x32_bf16 v[228:231], a[84:87], a[12:15], v[228:231]
buffer_load_dwordx4 v15, s[40:43], s64 offen lds
v_mfma_f32_16x16x32_bf16 v[220:223], a[84:87], a[4:7], v[220:223]
v_and_b32 v21, 0xffff0000, v21
v_mul_f32 v18, v18, v20
v_mfma_f32_16x16x32_bf16 v[220:223], a[80:83], a[0:3], v[220:223]
s_waitcnt lgkmcnt(4)
ds_read_b64_tr_b16 a[80:81], v5 offset:49152
v_mul_f32 v19, v19, v21
v_mfma_f32_16x16x32_bf16 v[152:155], a[88:91], a[0:3], v[152:155]
ds_read_b64_tr_b16 a[82:83], v5 offset:50176
v_cvt_pk_bf16_f32 v18, v18, v19
v_mfma_f32_16x16x32_bf16 v[152:155], a[92:95], a[4:7], v[152:155]
ds_read_b64_tr_b16 a[84:85], v5 offset:57344
v_lshlrev_b32 v19, 16, v18
v_mfma_f32_16x16x32_bf16 v[160:163], a[92:95], a[12:15], v[160:163]
ds_read_b64_tr_b16 a[86:87], v5 offset:58368
v_and_b32 v18, 0xffff0000, v18
v_mfma_f32_16x16x32_bf16 v[160:163], a[88:91], a[8:11], v[160:163]
v_add_f32 v17, v17, v19
v_add_f32 v17, v17, v18
v_mfma_f32_16x16x32_bf16 v[168:171], a[88:91], a[16:19], v[168:171]
v_accvgpr_read_b32 v19, a158
v_accvgpr_read_b32 v21, a174
v_mfma_f32_16x16x32_bf16 v[168:171], a[92:95], a[20:23], v[168:171]
v_lshlrev_b32 v18, 16, v19
v_and_b32 v19, 0xffff0000, v19
v_mfma_f32_16x16x32_bf16 v[176:179], a[92:95], a[28:31], v[176:179]
s_xor_b32 m0, s84, 0
v_lshlrev_b32 v20, 16, v21
v_and_b32 v21, 0xffff0000, v21
v_mfma_f32_16x16x32_bf16 v[176:179], a[88:91], a[24:27], v[176:179]
s_xor_b32 s64, s70, 768
ds_read_b64_tr_b16 a[88:89], v6 offset:49152
v_mul_f32 v18, v18, v20
v_mfma_f32_16x16x32_bf16 v[180:183], a[96:99], a[24:27], v[180:183]
buffer_load_dwordx4 v12, s[32:35], s64 offen lds
v_mfma_f32_16x16x32_bf16 v[180:183], a[100:103], a[28:31], v[180:183]
ds_read_b64_tr_b16 a[90:91], v6 offset:50176
v_mul_f32 v19, v19, v21
v_mfma_f32_16x16x32_bf16 v[172:175], a[100:103], a[20:23], v[172:175]
ds_read_b64_tr_b16 a[92:93], v6 offset:57344
v_cvt_pk_bf16_f32 v18, v18, v19
v_mfma_f32_16x16x32_bf16 v[172:175], a[96:99], a[16:19], v[172:175]
ds_read_b64_tr_b16 a[94:95], v6 offset:58368
v_lshlrev_b32 v19, 16, v18
v_mfma_f32_16x16x32_bf16 v[164:167], a[96:99], a[8:11], v[164:167]
v_and_b32 v18, 0xffff0000, v18
v_add_f32 v17, v17, v19
v_mfma_f32_16x16x32_bf16 v[164:167], a[100:103], a[12:15], v[164:167]
s_xor_b32 m0, s84, 1024
v_add_f32 v17, v17, v18
v_accvgpr_read_b32 v19, a159
v_mfma_f32_16x16x32_bf16 v[156:159], a[100:103], a[4:7], v[156:159]
s_xor_b32 s64, s70, 8960
v_accvgpr_read_b32 v21, a175
v_lshlrev_b32 v18, 16, v19
v_mfma_f32_16x16x32_bf16 v[156:159], a[96:99], a[0:3], v[156:159]
buffer_load_dwordx4 v13, s[32:35], s64 offen lds
v_mfma_f32_16x16x32_bf16 v[24:27], a[104:107], a[0:3], v[24:27]
ds_read_b64_tr_b16 a[96:97], v7 offset:49152
v_and_b32 v19, 0xffff0000, v19
v_mfma_f32_16x16x32_bf16 v[24:27], a[108:111], a[4:7], v[24:27]
ds_read_b64_tr_b16 a[98:99], v7 offset:50176
v_lshlrev_b32 v20, 16, v21
v_mfma_f32_16x16x32_bf16 v[40:43], a[108:111], a[12:15], v[40:43]
ds_read_b64_tr_b16 a[100:101], v7 offset:57344
v_and_b32 v21, 0xffff0000, v21
v_mfma_f32_16x16x32_bf16 v[40:43], a[104:107], a[8:11], v[40:43]
ds_read_b64_tr_b16 a[102:103], v7 offset:58368
v_mul_f32 v18, v18, v20
v_mfma_f32_16x16x32_bf16 v[56:59], a[104:107], a[16:19], v[56:59]
s_xor_b32 m0, s84, 2048
v_mul_f32 v19, v19, v21
v_cvt_pk_bf16_f32 v18, v18, v19
v_mfma_f32_16x16x32_bf16 v[56:59], a[108:111], a[20:23], v[56:59]
s_xor_b32 s64, s70, 17152
v_lshlrev_b32 v19, 16, v18
v_and_b32 v18, 0xffff0000, v18
v_mfma_f32_16x16x32_bf16 v[72:75], a[108:111], a[28:31], v[72:75]
s_waitcnt vmcnt(13)
buffer_load_dwordx4 v12, s[32:35], s64 offen lds
v_mfma_f32_16x16x32_bf16 v[72:75], a[104:107], a[24:27], v[72:75]
s_add_u32 s81, s81, 1048576
ds_read_b64_tr_b16 a[104:105], v8 offset:49152
v_add_f32 v17, v17, v19
v_mfma_f32_16x16x32_bf16 v[136:139], a[112:115], a[24:27], v[136:139]
buffer_load_dword a252, v16, s[56:59], s81 offen
v_mfma_f32_16x16x32_bf16 v[136:139], a[116:119], a[28:31], v[136:139]
ds_read_b64_tr_b16 a[106:107], v8 offset:50176
v_add_u32 v4, 0x8000, v4
v_mfma_f32_16x16x32_bf16 v[120:123], a[116:119], a[20:23], v[120:123]
ds_read_b64_tr_b16 a[108:109], v8 offset:57344
v_add_f32 v17, v17, v18
v_mfma_f32_16x16x32_bf16 v[120:123], a[112:115], a[16:19], v[120:123]
s_xor_b32 m0, s84, 3072
ds_read_b64_tr_b16 a[110:111], v8 offset:58368
v_mfma_f32_16x16x32_bf16 v[104:107], a[112:115], a[8:11], v[104:107]
s_xor_b32 s64, s70, 25344
ds_read_b128 a[32:35], v2 offset:32768
v_add_f32_dpp v17, v17, v17 row_ror:8 row_mask:0xf bank_mask:0xf
v_mfma_f32_16x16x32_bf16 v[104:107], a[116:119], a[12:15], v[104:107]
buffer_load_dwordx4 v13, s[32:35], s64 offen lds
v_mfma_f32_16x16x32_bf16 v[88:91], a[116:119], a[4:7], v[88:91]
ds_read_b128 a[36:39], v3 offset:32768
v_add_f32_dpp v17, v17, v17 row_ror:4 row_mask:0xf bank_mask:0xf
v_mfma_f32_16x16x32_bf16 v[88:91], a[112:115], a[0:3], v[88:91]
s_waitcnt lgkmcnt(6)
ds_read_b128 a[40:43], v2 offset:34816
v_mfma_f32_16x16x32_bf16 v[28:31], a[0:3], a[72:75], v[28:31]
ds_read_b128 a[44:47], v3 offset:34816
v_add_f32_dpp v17, v17, v17 row_ror:2 row_mask:0xf bank_mask:0xf
v_mfma_f32_16x16x32_bf16 v[28:31], a[4:7], a[76:79], v[28:31]
ds_read_b128 a[48:51], v2 offset:36864
v_add_u32 v5, 0x8000, v5
v_mfma_f32_16x16x32_bf16 v[44:47], a[12:15], a[76:79], v[44:47]
s_xor_b32 m0, s84, 4096
ds_read_b128 a[52:55], v3 offset:36864
v_add_f32_dpp v17, v17, v17 row_ror:1 row_mask:0xf bank_mask:0xf
v_mfma_f32_16x16x32_bf16 v[44:47], a[8:11], a[72:75], v[44:47]
s_xor_b32 s64, s70, 33536
ds_read_b128 a[56:59], v2 offset:38912
v_mov_b32 v18, v17
v_mfma_f32_16x16x32_bf16 v[60:63], a[16:19], a[72:75], v[60:63]
buffer_load_dwordx4 v12, s[32:35], s64 offen lds
v_mfma_f32_16x16x32_bf16 v[60:63], a[20:23], a[76:79], v[60:63]
ds_read_b128 a[60:63], v3 offset:38912
v_permlane16_swap_b32 v18, v17
v_mfma_f32_16x16x32_bf16 v[76:79], a[28:31], a[76:79], v[76:79]
ds_read_b64_tr_b16 a[112:113], v9 offset:49152
v_add_f32 v17, v17, v18
v_mfma_f32_16x16x32_bf16 v[76:79], a[24:27], a[72:75], v[76:79]
ds_read_b64_tr_b16 a[114:115], v9 offset:50176
v_cvt_pk_bf16_f32 v17, v17, v17
v_mfma_f32_16x16x32_bf16 v[140:143], a[24:27], a[80:83], v[140:143]
ds_read_b64_tr_b16 a[116:117], v9 offset:57344
v_and_b32 v17, 0xffff0000, v17
v_mfma_f32_16x16x32_bf16 v[140:143], a[28:31], a[84:87], v[140:143]
s_xor_b32 m0, s84, 5120
ds_read_b64_tr_b16 a[118:119], v9 offset:58368
v_add_u32 v6, 0x8000, v6
v_mfma_f32_16x16x32_bf16 v[124:127], a[20:23], a[84:87], v[124:127]
s_xor_b32 s64, s70, 41728
ds_read_b64_tr_b16 a[72:73], v10 offset:49152
v_mul_f32 v17, 0xbfb8aa3b, v17
v_mfma_f32_16x16x32_bf16 v[124:127], a[16:19], a[80:83], v[124:127]
buffer_load_dwordx4 v13, s[32:35], s64 offen lds
v_mfma_f32_16x16x32_bf16 v[108:111], a[8:11], a[80:83], v[108:111]
ds_read_b64_tr_b16 a[74:75], v10 offset:50176
v_mfma_f32_16x16x32_bf16 v[108:111], a[12:15], a[84:87], v[108:111]
ds_read_b64_tr_b16 a[76:77], v10 offset:57344
v_mfma_f32_16x16x32_bf16 v[92:95], a[4:7], a[84:87], v[92:95]
ds_read_b64_tr_b16 a[78:79], v10 offset:58368
v_mfma_f32_16x16x32_bf16 v[92:95], a[0:3], a[80:83], v[92:95]
ds_read_b64_tr_b16 a[80:81], v11 offset:49152
v_mfma_f32_16x16x32_bf16 v[32:35], a[0:3], a[88:91], v[32:35]
s_xor_b32 m0, s84, 6144
ds_read_b64_tr_b16 a[82:83], v11 offset:50176
v_mfma_f32_16x16x32_bf16 v[32:35], a[4:7], a[92:95], v[32:35]
s_xor_b32 s64, s70, 49920
ds_read_b64_tr_b16 a[84:85], v11 offset:57344
v_add_u32 v7, 0x8000, v7
v_mfma_f32_16x16x32_bf16 v[48:51], a[12:15], a[92:95], v[48:51]
buffer_load_dwordx4 v12, s[32:35], s64 offen lds
v_mfma_f32_16x16x32_bf16 v[48:51], a[8:11], a[88:91], v[48:51]
ds_read_b64_tr_b16 a[86:87], v11 offset:58368
v_mfma_f32_16x16x32_bf16 v[64:67], a[16:19], a[88:91], v[64:67]
v_exp_f32 v17, v17
v_mfma_f32_16x16x32_bf16 v[64:67], a[20:23], a[92:95], v[64:67]
v_add_f32 v17, 1.0, v17
v_mfma_f32_16x16x32_bf16 v[80:83], a[28:31], a[92:95], v[80:83]
v_rcp_f32 v17, v17
v_mfma_f32_16x16x32_bf16 v[80:83], a[24:27], a[88:91], v[80:83]
s_xor_b32 m0, s84, 7168
s_add_u32 s81, s81, 1048576
v_cvt_pk_bf16_f32 v18, v17, v17
v_mfma_f32_16x16x32_bf16 v[144:147], a[24:27], a[96:99], v[144:147]
s_xor_b32 s64, s70, 58112
buffer_load_dword a252, v16, s[56:59], s81 offen
v_mfma_f32_16x16x32_bf16 v[144:147], a[28:31], a[100:103], v[144:147]
buffer_load_dwordx4 v13, s[32:35], s64 offen lds
v_mfma_f32_16x16x32_bf16 v[128:131], a[20:23], a[100:103], v[128:131]
v_add_u32 v8, 0x8000, v8
v_and_b32 v18, 0xffff0000, v18
v_mfma_f32_16x16x32_bf16 v[128:131], a[16:19], a[96:99], v[128:131]
v_sub_f32 v19, 1.0, v18
v_mfma_f32_16x16x32_bf16 v[112:115], a[8:11], a[96:99], v[112:115]
v_cvt_pk_bf16_f32 v19, v19, v19
v_mfma_f32_16x16x32_bf16 v[112:115], a[12:15], a[100:103], v[112:115]
v_and_b32 v19, 0xffff0000, v19
v_mfma_f32_16x16x32_bf16 v[96:99], a[4:7], a[100:103], v[96:99]
v_add_u32 v9, 0x8000, v9
v_add_u32 v10, 0x8000, v10
v_mfma_f32_16x16x32_bf16 v[96:99], a[0:3], a[96:99], v[96:99]
s_waitcnt lgkmcnt(0)
v_add_u32 v11, 0x8000, v11
v_and_b32 v20, 31, v0
v_mfma_f32_16x16x32_bf16 v[36:39], a[0:3], a[104:107], v[36:39]
v_lshlrev_b32 v20, 27, v20
v_mfma_f32_16x16x32_bf16 v[36:39], a[4:7], a[108:111], v[36:39]
v_lshrrev_b32 v21, 2, v0
v_mfma_f32_16x16x32_bf16 v[52:55], a[12:15], a[108:111], v[52:55]
s_waitcnt lgkmcnt(0)
s_barrier
v_mfma_f32_16x16x32_bf16 v[52:55], a[8:11], a[104:107], v[52:55]
s_xor_b32 m0, s77, 98304
ds_read_b64_tr_b16 a[88:89], v4 offset:32768
v_add_u32 v20, v20, v21
v_mfma_f32_16x16x32_bf16 v[68:71], a[16:19], a[104:107], v[68:71]
s_xor_b32 s64, s71, 3670016
ds_read_b64_tr_b16 a[90:91], v4 offset:33792
v_mfma_f32_16x16x32_bf16 v[68:71], a[20:23], a[108:111], v[68:71]
buffer_load_dwordx4 v14, s[36:39], s64 offen lds
v_mfma_f32_16x16x32_bf16 v[84:87], a[28:31], a[108:111], v[84:87]
ds_read_b64_tr_b16 a[92:93], v4 offset:40960
v_mfma_f32_16x16x32_bf16 v[84:87], a[24:27], a[104:107], v[84:87]
ds_read_b64_tr_b16 a[94:95], v4 offset:41984
v_mfma_f32_16x16x32_bf16 v[148:151], a[24:27], a[112:115], v[148:151]
ds_read_b64_tr_b16 a[96:97], v5 offset:32768
v_mfma_f32_16x16x32_bf16 v[148:151], a[28:31], a[116:119], v[148:151]
ds_read_b64_tr_b16 a[98:99], v5 offset:33792
v_mfma_f32_16x16x32_bf16 v[132:135], a[20:23], a[116:119], v[132:135]
ds_read_b64_tr_b16 a[100:101], v5 offset:40960
v_mfma_f32_16x16x32_bf16 v[132:135], a[16:19], a[112:115], v[132:135]
s_xor_b32 m0, s77, 99328
ds_read_b64_tr_b16 a[102:103], v5 offset:41984
v_mfma_f32_16x16x32_bf16 v[116:119], a[8:11], a[112:115], v[116:119]
s_xor_b32 s64, s71, 3702784
ds_read_b64_tr_b16 a[104:105], v6 offset:32768
v_mfma_f32_16x16x32_bf16 v[116:119], a[12:15], a[116:119], v[116:119]
buffer_load_dwordx4 v14, s[36:39], s64 offen lds
v_mfma_f32_16x16x32_bf16 v[100:103], a[4:7], a[116:119], v[100:103]
ds_read_b64_tr_b16 a[106:107], v6 offset:33792
v_mfma_f32_16x16x32_bf16 v[100:103], a[0:3], a[112:115], v[100:103]
ds_read_b64_tr_b16 a[108:109], v6 offset:40960
v_mfma_f32_16x16x32_bf16 v[248:251], a[0:3], a[72:75], v[248:251]
ds_read_b64_tr_b16 a[110:111], v6 offset:41984
v_mfma_f32_16x16x32_bf16 v[248:251], a[4:7], a[76:79], v[248:251]
ds_read_b64_tr_b16 a[112:113], v7 offset:32768
v_mfma_f32_16x16x32_bf16 v[252:255], a[12:15], a[76:79], v[252:255]
ds_read_b64_tr_b16 a[114:115], v7 offset:33792
v_mfma_f32_16x16x32_bf16 v[252:255], a[8:11], a[72:75], v[252:255]
s_xor_b32 m0, s77, 100352
ds_read_b64_tr_b16 a[116:117], v7 offset:40960
v_mfma_f32_16x16x32_bf16 a[120:123], a[16:19], a[72:75], a[120:123]
s_xor_b32 s64, s71, 3735552
s_lshl2_add_u32 s65, s2, s30
ds_read_b64_tr_b16 a[118:119], v7 offset:41984
v_mfma_f32_16x16x32_bf16 a[120:123], a[20:23], a[76:79], a[120:123]
s_lshl4_add_u32 s65, s65, 58720256
buffer_load_dwordx4 v15, s[36:39], s64 offen lds
v_mfma_f32_16x16x32_bf16 a[124:127], a[28:31], a[76:79], a[124:127]
buffer_store_dwordx2 v[18:19], v20, s[44:47], s65 offen sc1
v_mfma_f32_16x16x32_bf16 a[124:127], a[24:27], a[72:75], a[124:127]
s_add_u32 s82, s82, 1048576
ds_read_b64_tr_b16 a[72:73], v8 offset:32768
v_lshrrev_b32 v21, 4, v0
v_mfma_f32_16x16x32_bf16 a[128:131], a[24:27], a[80:83], a[128:131]
buffer_load_dword a252, v1, s[60:63], s82 offen
v_mfma_f32_16x16x32_bf16 a[128:131], a[28:31], a[84:87], a[128:131]
ds_read_b64_tr_b16 a[74:75], v8 offset:33792
v_bfe_u32 v19, v0, 2, 2
v_mfma_f32_16x16x32_bf16 a[132:135], a[20:23], a[84:87], a[132:135]
ds_read_b64_tr_b16 a[76:77], v8 offset:40960
v_lshl_add_u32 v19, v21, 3, v19
v_mfma_f32_16x16x32_bf16 a[132:135], a[16:19], a[80:83], a[132:135]
s_xor_b32 m0, s77, 101376
ds_read_b64_tr_b16 a[78:79], v8 offset:41984
v_lshlrev_b32 v19, 6, v19
v_mfma_f32_16x16x32_bf16 a[136:139], a[8:11], a[80:83], a[136:139]
s_xor_b32 s64, s71, 3768320
v_and_b32 v21, 1, v21
v_mfma_f32_16x16x32_bf16 a[136:139], a[12:15], a[84:87], a[136:139]
buffer_load_dwordx4 v15, s[36:39], s64 offen lds
v_mfma_f32_16x16x32_bf16 a[140:143], a[4:7], a[84:87], a[140:143]
v_lshl_add_u32 v19, v21, 5, v19
v_mfma_f32_16x16x32_bf16 a[140:143], a[0:3], a[80:83], a[140:143]
s_waitcnt lgkmcnt(4)
ds_read_b64_tr_b16 a[80:81], v9 offset:32768
v_and_b32 v21, 3, v0
v_mfma_f32_16x16x32_bf16 v[184:187], a[88:91], a[32:35], v[184:187]
ds_read_b64_tr_b16 a[82:83], v9 offset:33792
v_lshl_add_u32 v19, v21, 3, v19
v_mfma_f32_16x16x32_bf16 v[184:187], a[92:95], a[36:39], v[184:187]
ds_read_b64_tr_b16 a[84:85], v9 offset:40960
v_add_u32 v19, 114688, v19
v_mfma_f32_16x16x32_bf16 v[192:195], a[92:95], a[44:47], v[192:195]
ds_read_b64_tr_b16 a[86:87], v9 offset:41984
v_xor_b32 v20, 32, v19
v_mfma_f32_16x16x32_bf16 v[192:195], a[88:91], a[40:43], v[192:195]
s_xor_b32 m0, s77, 114688
v_mfma_f32_16x16x32_bf16 v[200:203], a[88:91], a[48:51], v[200:203]
s_xor_b32 s64, s71, 3670016
v_mfma_f32_16x16x32_bf16 v[200:203], a[92:95], a[52:55], v[200:203]
buffer_load_dwordx4 v14, s[40:43], s64 offen lds
v_mfma_f32_16x16x32_bf16 v[208:211], a[92:95], a[60:63], v[208:211]
v_mfma_f32_16x16x32_bf16 v[208:211], a[88:91], a[56:59], v[208:211]
ds_read_b64_tr_b16 a[88:89], v10 offset:32768
v_mfma_f32_16x16x32_bf16 v[212:215], a[96:99], a[56:59], v[212:215]
ds_read_b64_tr_b16 a[90:91], v10 offset:33792
v_mfma_f32_16x16x32_bf16 v[212:215], a[100:103], a[60:63], v[212:215]
ds_read_b64_tr_b16 a[92:93], v10 offset:40960
v_mfma_f32_16x16x32_bf16 v[204:207], a[100:103], a[52:55], v[204:207]
ds_read_b64_tr_b16 a[94:95], v10 offset:41984
v_mfma_f32_16x16x32_bf16 v[204:207], a[96:99], a[48:51], v[204:207]
s_xor_b32 m0, s77, 115712
v_mfma_f32_16x16x32_bf16 v[196:199], a[96:99], a[40:43], v[196:199]
s_xor_b32 s64, s71, 3702784
v_mfma_f32_16x16x32_bf16 v[196:199], a[100:103], a[44:47], v[196:199]
buffer_load_dwordx4 v14, s[40:43], s64 offen lds
v_mfma_f32_16x16x32_bf16 v[188:191], a[100:103], a[36:39], v[188:191]
v_mfma_f32_16x16x32_bf16 v[188:191], a[96:99], a[32:35], v[188:191]
ds_read_b64_tr_b16 a[96:97], v11 offset:32768
v_mfma_f32_16x16x32_bf16 v[216:219], a[104:107], a[32:35], v[216:219]
ds_read_b64_tr_b16 a[98:99], v11 offset:33792
v_mfma_f32_16x16x32_bf16 v[216:219], a[108:111], a[36:39], v[216:219]
ds_read_b64_tr_b16 a[100:101], v11 offset:40960
v_mfma_f32_16x16x32_bf16 v[224:227], a[108:111], a[44:47], v[224:227]
ds_read_b64_tr_b16 a[102:103], v11 offset:41984
v_mfma_f32_16x16x32_bf16 v[224:227], a[104:107], a[40:43], v[224:227]
s_xor_b32 m0, s77, 116736
v_mfma_f32_16x16x32_bf16 v[232:235], a[104:107], a[48:51], v[232:235]
s_xor_b32 s64, s71, 3735552
v_mfma_f32_16x16x32_bf16 v[232:235], a[108:111], a[52:55], v[232:235]
buffer_load_dwordx4 v15, s[40:43], s64 offen lds
v_mfma_f32_16x16x32_bf16 v[240:243], a[108:111], a[60:63], v[240:243]
v_mfma_f32_16x16x32_bf16 v[240:243], a[104:107], a[56:59], v[240:243]
s_add_u32 s81, s81, 1048576
ds_read_b64_tr_b16 a[104:105], v4 offset:49152
v_mfma_f32_16x16x32_bf16 v[244:247], a[112:115], a[56:59], v[244:247]
buffer_load_dword a252, v16, s[56:59], s81 offen
v_mfma_f32_16x16x32_bf16 v[244:247], a[116:119], a[60:63], v[244:247]
ds_read_b64_tr_b16 a[106:107], v4 offset:50176
v_mfma_f32_16x16x32_bf16 v[236:239], a[116:119], a[52:55], v[236:239]
ds_read_b64_tr_b16 a[108:109], v4 offset:57344
v_mfma_f32_16x16x32_bf16 v[236:239], a[112:115], a[48:51], v[236:239]
s_xor_b32 m0, s77, 117760
ds_read_b64_tr_b16 a[110:111], v4 offset:58368
v_mfma_f32_16x16x32_bf16 v[228:231], a[112:115], a[40:43], v[228:231]
s_xor_b32 s64, s71, 3768320
v_mfma_f32_16x16x32_bf16 v[228:231], a[116:119], a[44:47], v[228:231]
buffer_load_dwordx4 v15, s[40:43], s64 offen lds
v_mfma_f32_16x16x32_bf16 v[220:223], a[116:119], a[36:39], v[220:223]
v_mfma_f32_16x16x32_bf16 v[220:223], a[112:115], a[32:35], v[220:223]
s_waitcnt lgkmcnt(4)
ds_read_b64_tr_b16 a[112:113], v5 offset:49152
v_mfma_f32_16x16x32_bf16 v[152:155], a[72:75], a[32:35], v[152:155]
ds_read_b64_tr_b16 a[114:115], v5 offset:50176
v_mfma_f32_16x16x32_bf16 v[152:155], a[76:79], a[36:39], v[152:155]
ds_read_b64_tr_b16 a[116:117], v5 offset:57344
v_mfma_f32_16x16x32_bf16 v[160:163], a[76:79], a[44:47], v[160:163]
ds_read_b64_tr_b16 a[118:119], v5 offset:58368
v_mfma_f32_16x16x32_bf16 v[160:163], a[72:75], a[40:43], v[160:163]
v_mfma_f32_16x16x32_bf16 v[168:171], a[72:75], a[48:51], v[168:171]
v_mfma_f32_16x16x32_bf16 v[168:171], a[76:79], a[52:55], v[168:171]
v_mfma_f32_16x16x32_bf16 v[176:179], a[76:79], a[60:63], v[176:179]
s_xor_b32 m0, s84, 32768
v_mfma_f32_16x16x32_bf16 v[176:179], a[72:75], a[56:59], v[176:179]
s_xor_b32 s64, s70, 896
ds_read_b64_tr_b16 a[72:73], v6 offset:49152
v_mfma_f32_16x16x32_bf16 v[180:183], a[80:83], a[56:59], v[180:183]
buffer_load_dwordx4 v12, s[32:35], s64 offen lds
v_mfma_f32_16x16x32_bf16 v[180:183], a[84:87], a[60:63], v[180:183]
ds_read_b64_tr_b16 a[74:75], v6 offset:50176
v_mfma_f32_16x16x32_bf16 v[172:175], a[84:87], a[52:55], v[172:175]
ds_read_b64_tr_b16 a[76:77], v6 offset:57344
v_mfma_f32_16x16x32_bf16 v[172:175], a[80:83], a[48:51], v[172:175]
ds_read_b64_tr_b16 a[78:79], v6 offset:58368
v_mfma_f32_16x16x32_bf16 v[164:167], a[80:83], a[40:43], v[164:167]
v_mfma_f32_16x16x32_bf16 v[164:167], a[84:87], a[44:47], v[164:167]
s_xor_b32 m0, s84, 33792
v_mfma_f32_16x16x32_bf16 v[156:159], a[84:87], a[36:39], v[156:159]
s_xor_b32 s64, s70, 9088
v_mfma_f32_16x16x32_bf16 v[156:159], a[80:83], a[32:35], v[156:159]
buffer_load_dwordx4 v13, s[32:35], s64 offen lds
v_mfma_f32_16x16x32_bf16 v[24:27], a[88:91], a[32:35], v[24:27]
ds_read_b64_tr_b16 a[80:81], v7 offset:49152
v_mfma_f32_16x16x32_bf16 v[24:27], a[92:95], a[36:39], v[24:27]
ds_read_b64_tr_b16 a[82:83], v7 offset:50176
v_mfma_f32_16x16x32_bf16 v[40:43], a[92:95], a[44:47], v[40:43]
ds_read_b64_tr_b16 a[84:85], v7 offset:57344
v_mfma_f32_16x16x32_bf16 v[40:43], a[88:91], a[40:43], v[40:43]
ds_read_b64_tr_b16 a[86:87], v7 offset:58368
v_mfma_f32_16x16x32_bf16 v[56:59], a[88:91], a[48:51], v[56:59]
s_xor_b32 m0, s84, 34816
v_mfma_f32_16x16x32_bf16 v[56:59], a[92:95], a[52:55], v[56:59]
s_xor_b32 s64, s70, 17280
v_mfma_f32_16x16x32_bf16 v[72:75], a[92:95], a[60:63], v[72:75]
s_waitcnt vmcnt(13)
buffer_load_dwordx4 v12, s[32:35], s64 offen lds
v_mfma_f32_16x16x32_bf16 v[72:75], a[88:91], a[56:59], v[72:75]
s_add_u32 s82, s82, 1048576
ds_read_b64_tr_b16 a[88:89], v8 offset:49152
v_mfma_f32_16x16x32_bf16 v[136:139], a[96:99], a[56:59], v[136:139]
buffer_load_dword a252, v1, s[60:63], s82 offen
v_mfma_f32_16x16x32_bf16 v[136:139], a[100:103], a[60:63], v[136:139]
ds_read_b64_tr_b16 a[90:91], v8 offset:50176
v_subrev_u32 v4, 0x8000, v4
v_mfma_f32_16x16x32_bf16 v[120:123], a[100:103], a[52:55], v[120:123]
ds_read_b64_tr_b16 a[92:93], v8 offset:57344
v_mfma_f32_16x16x32_bf16 v[120:123], a[96:99], a[48:51], v[120:123]
s_xor_b32 m0, s84, 35840
ds_read_b64_tr_b16 a[94:95], v8 offset:58368
v_mfma_f32_16x16x32_bf16 v[104:107], a[96:99], a[40:43], v[104:107]
s_xor_b32 s64, s70, 25472
ds_read_b128 a[0:3], v2 offset:0
v_mfma_f32_16x16x32_bf16 v[104:107], a[100:103], a[44:47], v[104:107]
buffer_load_dwordx4 v13, s[32:35], s64 offen lds
v_mfma_f32_16x16x32_bf16 v[88:91], a[100:103], a[36:39], v[88:91]
ds_read_b128 a[4:7], v3 offset:0
v_mfma_f32_16x16x32_bf16 v[88:91], a[96:99], a[32:35], v[88:91]
s_waitcnt lgkmcnt(6)
ds_read_b128 a[8:11], v2 offset:2048
v_mfma_f32_16x16x32_bf16 v[28:31], a[32:35], a[104:107], v[28:31]
ds_read_b128 a[12:15], v3 offset:2048
v_mfma_f32_16x16x32_bf16 v[28:31], a[36:39], a[108:111], v[28:31]
ds_read_b128 a[16:19], v2 offset:4096
v_subrev_u32 v5, 0x8000, v5
v_mfma_f32_16x16x32_bf16 v[44:47], a[44:47], a[108:111], v[44:47]
s_xor_b32 m0, s84, 36864
ds_read_b128 a[20:23], v3 offset:4096
v_mfma_f32_16x16x32_bf16 v[44:47], a[40:43], a[104:107], v[44:47]
s_xor_b32 s64, s70, 33664
ds_read_b128 a[24:27], v2 offset:6144
v_mfma_f32_16x16x32_bf16 v[60:63], a[48:51], a[104:107], v[60:63]
buffer_load_dwordx4 v12, s[32:35], s64 offen lds
v_mfma_f32_16x16x32_bf16 v[60:63], a[52:55], a[108:111], v[60:63]
ds_read_b128 a[28:31], v3 offset:6144
v_mfma_f32_16x16x32_bf16 v[76:79], a[60:63], a[108:111], v[76:79]
ds_read_b64_tr_b16 a[96:97], v9 offset:49152
v_mfma_f32_16x16x32_bf16 v[76:79], a[56:59], a[104:107], v[76:79]
ds_read_b64_tr_b16 a[98:99], v9 offset:50176
v_mfma_f32_16x16x32_bf16 v[140:143], a[56:59], a[112:115], v[140:143]
ds_read_b64_tr_b16 a[100:101], v9 offset:57344
v_mfma_f32_16x16x32_bf16 v[140:143], a[60:63], a[116:119], v[140:143]
s_xor_b32 m0, s84, 37888
ds_read_b64_tr_b16 a[102:103], v9 offset:58368
v_subrev_u32 v6, 0x8000, v6
v_mfma_f32_16x16x32_bf16 v[124:127], a[52:55], a[116:119], v[124:127]
s_xor_b32 s64, s70, 41856
ds_read_b64_tr_b16 a[104:105], v10 offset:49152
v_mfma_f32_16x16x32_bf16 v[124:127], a[48:51], a[112:115], v[124:127]
buffer_load_dwordx4 v13, s[32:35], s64 offen lds
v_mfma_f32_16x16x32_bf16 v[108:111], a[40:43], a[112:115], v[108:111]
ds_read_b64_tr_b16 a[106:107], v10 offset:50176
v_mfma_f32_16x16x32_bf16 v[108:111], a[44:47], a[116:119], v[108:111]
ds_read_b64_tr_b16 a[108:109], v10 offset:57344
v_mfma_f32_16x16x32_bf16 v[92:95], a[36:39], a[116:119], v[92:95]
ds_read_b64_tr_b16 a[110:111], v10 offset:58368
v_mfma_f32_16x16x32_bf16 v[92:95], a[32:35], a[112:115], v[92:95]
ds_read_b64_tr_b16 a[112:113], v11 offset:49152
v_mfma_f32_16x16x32_bf16 v[32:35], a[32:35], a[72:75], v[32:35]
s_xor_b32 m0, s84, 38912
ds_read_b64_tr_b16 a[114:115], v11 offset:50176
v_mfma_f32_16x16x32_bf16 v[32:35], a[36:39], a[76:79], v[32:35]
s_xor_b32 s64, s70, 50048
ds_read_b64_tr_b16 a[116:117], v11 offset:57344
v_subrev_u32 v7, 0x8000, v7
v_mfma_f32_16x16x32_bf16 v[48:51], a[44:47], a[76:79], v[48:51]
buffer_load_dwordx4 v12, s[32:35], s64 offen lds
v_mfma_f32_16x16x32_bf16 v[48:51], a[40:43], a[72:75], v[48:51]
ds_read_b64_tr_b16 a[118:119], v11 offset:58368
v_mfma_f32_16x16x32_bf16 v[64:67], a[48:51], a[72:75], v[64:67]
v_mfma_f32_16x16x32_bf16 v[64:67], a[52:55], a[76:79], v[64:67]
v_mfma_f32_16x16x32_bf16 v[80:83], a[60:63], a[76:79], v[80:83]
v_mfma_f32_16x16x32_bf16 v[80:83], a[56:59], a[72:75], v[80:83]
s_xor_b32 m0, s84, 39936
v_mfma_f32_16x16x32_bf16 v[144:147], a[56:59], a[80:83], v[144:147]
s_xor_b32 s64, s70, 58240
v_mfma_f32_16x16x32_bf16 v[144:147], a[60:63], a[84:87], v[144:147]
buffer_load_dwordx4 v13, s[32:35], s64 offen lds
v_mfma_f32_16x16x32_bf16 v[128:131], a[52:55], a[84:87], v[128:131]
v_subrev_u32 v8, 0x8000, v8
v_mfma_f32_16x16x32_bf16 v[128:131], a[48:51], a[80:83], v[128:131]
v_mfma_f32_16x16x32_bf16 v[112:115], a[40:43], a[80:83], v[112:115]
v_mfma_f32_16x16x32_bf16 v[112:115], a[44:47], a[84:87], v[112:115]
v_mfma_f32_16x16x32_bf16 v[96:99], a[36:39], a[84:87], v[96:99]
s_and_b32 s77, s77, 0x3fff
v_subrev_u32 v9, 0x8000, v9
v_subrev_u32 v10, 0x8000, v10
v_mfma_f32_16x16x32_bf16 v[96:99], a[32:35], a[80:83], v[96:99]
s_waitcnt lgkmcnt(0)
v_subrev_u32 v11, 0x8000, v11
v_mfma_f32_16x16x32_bf16 v[36:39], a[32:35], a[88:91], v[36:39]
v_mfma_f32_16x16x32_bf16 v[36:39], a[36:39], a[92:95], v[36:39]
v_mfma_f32_16x16x32_bf16 v[52:55], a[44:47], a[92:95], v[52:55]
s_waitcnt lgkmcnt(0)
s_barrier
v_mfma_f32_16x16x32_bf16 v[52:55], a[40:43], a[88:91], v[52:55]
s_xor_b32 m0, s77, 131072
ds_read_b64_tr_b16 a[72:73], v4 offset:0
v_mfma_f32_16x16x32_bf16 v[68:71], a[48:51], a[88:91], v[68:71]
s_xor_b32 s64, s71, 0
ds_read_b64_tr_b16 a[74:75], v4 offset:1024
v_mfma_f32_16x16x32_bf16 v[68:71], a[52:55], a[92:95], v[68:71]
buffer_load_dwordx4 v14, s[56:59], s64 offen lds
v_mfma_f32_16x16x32_bf16 v[84:87], a[60:63], a[92:95], v[84:87]
ds_read_b64_tr_b16 a[76:77], v4 offset:8192
v_mfma_f32_16x16x32_bf16 v[84:87], a[56:59], a[88:91], v[84:87]
ds_read_b64_tr_b16 a[78:79], v4 offset:9216
v_mfma_f32_16x16x32_bf16 v[148:151], a[56:59], a[96:99], v[148:151]
ds_read_b64_tr_b16 a[80:81], v5 offset:0
v_lshrrev_b32 v13, 3, v0
v_mfma_f32_16x16x32_bf16 v[148:151], a[60:63], a[100:103], v[148:151]
ds_read_b64_tr_b16 a[82:83], v5 offset:1024
v_lshl_add_u32 v12, v13, 10, v12
v_mfma_f32_16x16x32_bf16 v[132:135], a[52:55], a[100:103], v[132:135]
ds_read_b64_tr_b16 a[84:85], v5 offset:8192
v_xor_b32 v13, 64, v12
v_mfma_f32_16x16x32_bf16 v[132:135], a[48:51], a[96:99], v[132:135]
ds_read_b64_tr_b16 a[86:87], v5 offset:9216
v_mfma_f32_16x16x32_bf16 v[116:119], a[40:43], a[96:99], v[116:119]
s_add_u32 m0, s78, 147456
ds_read_b64_tr_b16 a[88:89], v6 offset:0
v_mfma_f32_16x16x32_bf16 v[116:119], a[44:47], a[100:103], v[116:119]
s_add_u32 s64, s75, 0
ds_read_b64_tr_b16 a[90:91], v6 offset:1024
v_mfma_f32_16x16x32_bf16 v[100:103], a[36:39], a[100:103], v[100:103]
buffer_load_dwordx4 v23, s[60:63], s64 offen lds
v_mfma_f32_16x16x32_bf16 v[100:103], a[32:35], a[96:99], v[100:103]
ds_read_b64_tr_b16 a[92:93], v6 offset:8192
v_mfma_f32_16x16x32_bf16 v[248:251], a[32:35], a[104:107], v[248:251]
ds_read_b64_tr_b16 a[94:95], v6 offset:9216
v_mfma_f32_16x16x32_bf16 v[248:251], a[36:39], a[108:111], v[248:251]
ds_read_b64_tr_b16 a[96:97], v7 offset:0
v_mfma_f32_16x16x32_bf16 v[252:255], a[44:47], a[108:111], v[252:255]
ds_read_b64_tr_b16 a[98:99], v7 offset:1024
v_mfma_f32_16x16x32_bf16 v[252:255], a[40:43], a[104:107], v[252:255]
ds_read_b64_tr_b16 a[100:101], v7 offset:8192
v_mfma_f32_16x16x32_bf16 a[120:123], a[48:51], a[104:107], a[120:123]
ds_read_b64_tr_b16 a[102:103], v7 offset:9216
v_mfma_f32_16x16x32_bf16 a[120:123], a[52:55], a[108:111], a[120:123]
s_xor_b32 m0, s77, 132096
v_mfma_f32_16x16x32_bf16 a[124:127], a[60:63], a[108:111], a[124:127]
s_xor_b32 s64, s71, 32768
v_mfma_f32_16x16x32_bf16 a[124:127], a[56:59], a[104:107], a[124:127]
buffer_load_dwordx4 v14, s[56:59], s64 offen lds
v_mfma_f32_16x16x32_bf16 a[128:131], a[56:59], a[112:115], a[128:131]
ds_read_b64_tr_b16 a[104:105], v8 offset:0
v_mfma_f32_16x16x32_bf16 a[128:131], a[60:63], a[116:119], a[128:131]
ds_read_b64_tr_b16 a[106:107], v8 offset:1024
v_mfma_f32_16x16x32_bf16 a[132:135], a[52:55], a[116:119], a[132:135]
ds_read_b64_tr_b16 a[108:109], v8 offset:8192
v_mfma_f32_16x16x32_bf16 a[132:135], a[48:51], a[112:115], a[132:135]
ds_read_b64_tr_b16 a[110:111], v8 offset:9216
v_mfma_f32_16x16x32_bf16 a[136:139], a[40:43], a[112:115], a[136:139]
v_mfma_f32_16x16x32_bf16 a[136:139], a[44:47], a[116:119], a[136:139]
v_mfma_f32_16x16x32_bf16 a[140:143], a[36:39], a[116:119], a[140:143]
s_add_u32 m0, s78, 151552
v_mfma_f32_16x16x32_bf16 a[140:143], a[32:35], a[112:115], a[140:143]
s_waitcnt lgkmcnt(4)
s_add_u32 s64, s75, 2048
ds_read_b64_tr_b16 a[112:113], v9 offset:0
v_mfma_f32_16x16x32_bf16 v[184:187], a[72:75], a[0:3], v[184:187]
buffer_load_dwordx4 v23, s[60:63], s64 offen lds
v_mfma_f32_16x16x32_bf16 v[184:187], a[76:79], a[4:7], v[184:187]
ds_read_b64_tr_b16 a[114:115], v9 offset:1024
v_mfma_f32_16x16x32_bf16 v[192:195], a[76:79], a[12:15], v[192:195]
ds_read_b64_tr_b16 a[116:117], v9 offset:8192
v_mfma_f32_16x16x32_bf16 v[192:195], a[72:75], a[8:11], v[192:195]
s_add_u32 s17, s78, .-L_pc+6144
ds_read_b64_tr_b16 a[118:119], v9 offset:9216
v_mfma_f32_16x16x32_bf16 v[200:203], a[72:75], a[16:19], v[200:203]
buffer_load_dword a252, v16, s[88:91], s17 offen
v_mfma_f32_16x16x32_bf16 v[200:203], a[76:79], a[20:23], v[200:203]
v_mfma_f32_16x16x32_bf16 v[208:211], a[76:79], a[28:31], v[208:211]
v_mfma_f32_16x16x32_bf16 v[208:211], a[72:75], a[24:27], v[208:211]
ds_read_b64_tr_b16 a[72:73], v10 offset:0
v_mfma_f32_16x16x32_bf16 v[212:215], a[80:83], a[24:27], v[212:215]
s_xor_b32 m0, s77, 133120
ds_read_b64_tr_b16 a[74:75], v10 offset:1024
v_mfma_f32_16x16x32_bf16 v[212:215], a[84:87], a[28:31], v[212:215]
s_xor_b32 s64, s71, 65536
ds_read_b64_tr_b16 a[76:77], v10 offset:8192
v_mfma_f32_16x16x32_bf16 v[204:207], a[84:87], a[20:23], v[204:207]
buffer_load_dwordx4 v15, s[56:59], s64 offen lds
v_mfma_f32_16x16x32_bf16 v[204:207], a[80:83], a[16:19], v[204:207]
ds_read_b64_tr_b16 a[78:79], v10 offset:9216
v_mfma_f32_16x16x32_bf16 v[196:199], a[80:83], a[8:11], v[196:199]
v_mfma_f32_16x16x32_bf16 v[196:199], a[84:87], a[12:15], v[196:199]
v_mfma_f32_16x16x32_bf16 v[188:191], a[84:87], a[4:7], v[188:191]
v_mfma_f32_16x16x32_bf16 v[188:191], a[80:83], a[0:3], v[188:191]
ds_read_b64_tr_b16 a[80:81], v11 offset:0
v_mfma_f32_16x16x32_bf16 v[216:219], a[88:91], a[0:3], v[216:219]
ds_read_b64_tr_b16 a[82:83], v11 offset:1024
v_mfma_f32_16x16x32_bf16 v[216:219], a[92:95], a[4:7], v[216:219]
s_add_u32 m0, s78, 155648
ds_read_b64_tr_b16 a[84:85], v11 offset:8192
v_mfma_f32_16x16x32_bf16 v[224:227], a[92:95], a[12:15], v[224:227]
s_add_u32 s64, s75, 4096
ds_read_b64_tr_b16 a[86:87], v11 offset:9216
v_mfma_f32_16x16x32_bf16 v[224:227], a[88:91], a[8:11], v[224:227]
buffer_load_dwordx4 v23, s[60:63], s64 offen lds
v_mfma_f32_16x16x32_bf16 v[232:235], a[88:91], a[16:19], v[232:235]
v_mfma_f32_16x16x32_bf16 v[232:235], a[92:95], a[20:23], v[232:235]
v_mfma_f32_16x16x32_bf16 v[240:243], a[92:95], a[28:31], v[240:243]
v_mfma_f32_16x16x32_bf16 v[240:243], a[88:91], a[24:27], v[240:243]
ds_read_b64_tr_b16 a[88:89], v4 offset:16384
v_mfma_f32_16x16x32_bf16 v[244:247], a[96:99], a[24:27], v[244:247]
ds_read_b64_tr_b16 a[90:91], v4 offset:17408
v_mfma_f32_16x16x32_bf16 v[244:247], a[100:103], a[28:31], v[244:247]
ds_read_b64_tr_b16 a[92:93], v4 offset:24576
v_mfma_f32_16x16x32_bf16 v[236:239], a[100:103], a[20:23], v[236:239]
s_xor_b32 m0, s77, 134144
ds_read_b64_tr_b16 a[94:95], v4 offset:25600
v_mfma_f32_16x16x32_bf16 v[236:239], a[96:99], a[16:19], v[236:239]
s_xor_b32 s64, s71, 98304
v_mfma_f32_16x16x32_bf16 v[228:231], a[96:99], a[8:11], v[228:231]
buffer_load_dwordx4 v15, s[56:59], s64 offen lds
v_mfma_f32_16x16x32_bf16 v[228:231], a[100:103], a[12:15], v[228:231]
v_mfma_f32_16x16x32_bf16 v[220:223], a[100:103], a[4:7], v[220:223]
v_mfma_f32_16x16x32_bf16 v[220:223], a[96:99], a[0:3], v[220:223]
s_waitcnt lgkmcnt(4)
ds_read_b64_tr_b16 a[96:97], v5 offset:16384
v_mfma_f32_16x16x32_bf16 v[152:155], a[104:107], a[0:3], v[152:155]
ds_read_b64_tr_b16 a[98:99], v5 offset:17408
v_mfma_f32_16x16x32_bf16 v[152:155], a[108:111], a[4:7], v[152:155]
ds_read_b64_tr_b16 a[100:101], v5 offset:24576
v_mfma_f32_16x16x32_bf16 v[160:163], a[108:111], a[12:15], v[160:163]
ds_read_b64_tr_b16 a[102:103], v5 offset:25600
v_mfma_f32_16x16x32_bf16 v[160:163], a[104:107], a[8:11], v[160:163]
v_mfma_f32_16x16x32_bf16 v[168:171], a[104:107], a[16:19], v[168:171]
v_mfma_f32_16x16x32_bf16 v[168:171], a[108:111], a[20:23], v[168:171]
v_mfma_f32_16x16x32_bf16 v[176:179], a[108:111], a[28:31], v[176:179]
s_xor_b32 m0, s84, 0
v_mfma_f32_16x16x32_bf16 v[176:179], a[104:107], a[24:27], v[176:179]
s_xor_b32 s64, s72, 0
ds_read_b64_tr_b16 a[104:105], v6 offset:16384
v_mfma_f32_16x16x32_bf16 v[180:183], a[112:115], a[24:27], v[180:183]
buffer_load_dwordx4 v12, s[48:51], s64 offen lds
v_mfma_f32_16x16x32_bf16 v[180:183], a[116:119], a[28:31], v[180:183]
ds_read_b64_tr_b16 a[106:107], v6 offset:17408
v_mfma_f32_16x16x32_bf16 v[172:175], a[116:119], a[20:23], v[172:175]
ds_read_b64_tr_b16 a[108:109], v6 offset:24576
v_mfma_f32_16x16x32_bf16 v[172:175], a[112:115], a[16:19], v[172:175]
ds_read_b64_tr_b16 a[110:111], v6 offset:25600
v_mfma_f32_16x16x32_bf16 v[164:167], a[112:115], a[8:11], v[164:167]
v_mfma_f32_16x16x32_bf16 v[164:167], a[116:119], a[12:15], v[164:167]
s_xor_b32 m0, s84, 1024
v_mfma_f32_16x16x32_bf16 v[156:159], a[116:119], a[4:7], v[156:159]
s_xor_b32 s64, s72, 16384
v_mfma_f32_16x16x32_bf16 v[156:159], a[112:115], a[0:3], v[156:159]
buffer_load_dwordx4 v13, s[48:51], s64 offen lds
v_mfma_f32_16x16x32_bf16 v[24:27], a[72:75], a[0:3], v[24:27]
ds_read_b64_tr_b16 a[112:113], v7 offset:16384
v_mfma_f32_16x16x32_bf16 v[24:27], a[76:79], a[4:7], v[24:27]
ds_read_b64_tr_b16 a[114:115], v7 offset:17408
v_mfma_f32_16x16x32_bf16 v[40:43], a[76:79], a[12:15], v[40:43]
ds_read_b64_tr_b16 a[116:117], v7 offset:24576
v_mfma_f32_16x16x32_bf16 v[40:43], a[72:75], a[8:11], v[40:43]
ds_read_b64_tr_b16 a[118:119], v7 offset:25600
v_mfma_f32_16x16x32_bf16 v[56:59], a[72:75], a[16:19], v[56:59]
s_xor_b32 m0, s84, 2048
v_mfma_f32_16x16x32_bf16 v[56:59], a[76:79], a[20:23], v[56:59]
s_xor_b32 s64, s72, 131072
v_mfma_f32_16x16x32_bf16 v[72:75], a[76:79], a[28:31], v[72:75]
s_waitcnt vmcnt(10)
buffer_load_dwordx4 v12, s[48:51], s64 offen lds
v_mfma_f32_16x16x32_bf16 v[72:75], a[72:75], a[24:27], v[72:75]
ds_read_b64_tr_b16 a[72:73], v8 offset:16384
v_mfma_f32_16x16x32_bf16 v[136:139], a[80:83], a[24:27], v[136:139]
ds_read_b64_tr_b16 a[74:75], v8 offset:17408
v_mfma_f32_16x16x32_bf16 v[136:139], a[84:87], a[28:31], v[136:139]
ds_read_b64_tr_b16 a[76:77], v8 offset:24576
v_mfma_f32_16x16x32_bf16 v[120:123], a[84:87], a[20:23], v[120:123]
ds_read_b64_tr_b16 a[78:79], v8 offset:25600
v_mfma_f32_16x16x32_bf16 v[120:123], a[80:83], a[16:19], v[120:123]
s_xor_b32 m0, s84, 3072
ds_read_b128 a[32:35], v2 offset:32768
v_mfma_f32_16x16x32_bf16 v[104:107], a[80:83], a[8:11], v[104:107]
s_xor_b32 s64, s72, 147456
ds_read_b128 a[36:39], v3 offset:32768
v_mfma_f32_16x16x32_bf16 v[104:107], a[84:87], a[12:15], v[104:107]
buffer_load_dwordx4 v13, s[48:51], s64 offen lds
v_mfma_f32_16x16x32_bf16 v[88:91], a[84:87], a[4:7], v[88:91]
ds_read_b128 a[40:43], v2 offset:34816
v_mfma_f32_16x16x32_bf16 v[88:91], a[80:83], a[0:3], v[88:91]
s_waitcnt lgkmcnt(7)
ds_read_b128 a[44:47], v3 offset:34816
v_mfma_f32_16x16x32_bf16 v[28:31], a[0:3], a[88:91], v[28:31]
ds_read_b128 a[48:51], v2 offset:36864
v_mfma_f32_16x16x32_bf16 v[28:31], a[4:7], a[92:95], v[28:31]
ds_read_b128 a[52:55], v3 offset:36864
v_mfma_f32_16x16x32_bf16 v[44:47], a[12:15], a[92:95], v[44:47]
s_xor_b32 m0, s84, 4096
ds_read_b128 a[56:59], v2 offset:38912
v_mfma_f32_16x16x32_bf16 v[44:47], a[8:11], a[88:91], v[44:47]
s_xor_b32 s64, s73, 0
ds_read_b128 a[60:63], v3 offset:38912
v_mfma_f32_16x16x32_bf16 v[60:63], a[16:19], a[88:91], v[60:63]
buffer_load_dwordx4 v12, s[48:51], s64 offen lds
v_mfma_f32_16x16x32_bf16 v[60:63], a[20:23], a[92:95], v[60:63]
ds_read_b64_tr_b16 a[80:81], v9 offset:16384
v_mfma_f32_16x16x32_bf16 v[76:79], a[28:31], a[92:95], v[76:79]
ds_read_b64_tr_b16 a[82:83], v9 offset:17408
v_mfma_f32_16x16x32_bf16 v[76:79], a[24:27], a[88:91], v[76:79]
ds_read_b64_tr_b16 a[84:85], v9 offset:24576
v_mfma_f32_16x16x32_bf16 v[140:143], a[24:27], a[96:99], v[140:143]
ds_read_b64_tr_b16 a[86:87], v9 offset:25600
v_mfma_f32_16x16x32_bf16 v[140:143], a[28:31], a[100:103], v[140:143]
s_xor_b32 m0, s84, 5120
ds_read_b64_tr_b16 a[88:89], v10 offset:16384
v_mfma_f32_16x16x32_bf16 v[124:127], a[20:23], a[100:103], v[124:127]
s_xor_b32 s64, s73, 16384
ds_read_b64_tr_b16 a[90:91], v10 offset:17408
v_mfma_f32_16x16x32_bf16 v[124:127], a[16:19], a[96:99], v[124:127]
buffer_load_dwordx4 v13, s[48:51], s64 offen lds
v_mfma_f32_16x16x32_bf16 v[108:111], a[8:11], a[96:99], v[108:111]
ds_read_b64_tr_b16 a[92:93], v10 offset:24576
v_mfma_f32_16x16x32_bf16 v[108:111], a[12:15], a[100:103], v[108:111]
ds_read_b64_tr_b16 a[94:95], v10 offset:25600
v_mfma_f32_16x16x32_bf16 v[92:95], a[4:7], a[100:103], v[92:95]
v_mfma_f32_16x16x32_bf16 v[92:95], a[0:3], a[96:99], v[92:95]
ds_read_b64_tr_b16 a[96:97], v11 offset:16384
v_mfma_f32_16x16x32_bf16 v[32:35], a[0:3], a[104:107], v[32:35]
s_xor_b32 m0, s84, 6144
ds_read_b64_tr_b16 a[98:99], v11 offset:17408
v_mfma_f32_16x16x32_bf16 v[32:35], a[4:7], a[108:111], v[32:35]
s_xor_b32 s64, s73, 131072
ds_read_b64_tr_b16 a[100:101], v11 offset:24576
v_mfma_f32_16x16x32_bf16 v[48:51], a[12:15], a[108:111], v[48:51]
buffer_load_dwordx4 v12, s[48:51], s64 offen lds
v_mfma_f32_16x16x32_bf16 v[48:51], a[8:11], a[104:107], v[48:51]
ds_read_b64_tr_b16 a[102:103], v11 offset:25600
v_mfma_f32_16x16x32_bf16 v[64:67], a[16:19], a[104:107], v[64:67]
v_mfma_f32_16x16x32_bf16 v[64:67], a[20:23], a[108:111], v[64:67]
v_mfma_f32_16x16x32_bf16 v[80:83], a[28:31], a[108:111], v[80:83]
v_mfma_f32_16x16x32_bf16 v[80:83], a[24:27], a[104:107], v[80:83]
s_xor_b32 m0, s84, 7168
v_mfma_f32_16x16x32_bf16 v[144:147], a[24:27], a[112:115], v[144:147]
s_xor_b32 s64, s73, 147456
v_mfma_f32_16x16x32_bf16 v[144:147], a[28:31], a[116:119], v[144:147]
buffer_load_dwordx4 v13, s[48:51], s64 offen lds
v_mfma_f32_16x16x32_bf16 v[128:131], a[20:23], a[116:119], v[128:131]
v_mfma_f32_16x16x32_bf16 v[128:131], a[16:19], a[112:115], v[128:131]
v_mfma_f32_16x16x32_bf16 v[112:115], a[8:11], a[112:115], v[112:115]
v_mfma_f32_16x16x32_bf16 v[112:115], a[12:15], a[116:119], v[112:115]
v_mfma_f32_16x16x32_bf16 v[96:99], a[4:7], a[116:119], v[96:99]
v_mfma_f32_16x16x32_bf16 v[96:99], a[0:3], a[112:115], v[96:99]
s_waitcnt lgkmcnt(0)
v_mfma_f32_16x16x32_bf16 v[36:39], a[0:3], a[72:75], v[36:39]
v_mfma_f32_16x16x32_bf16 v[36:39], a[4:7], a[76:79], v[36:39]
v_mfma_f32_16x16x32_bf16 v[52:55], a[12:15], a[76:79], v[52:55]
s_waitcnt lgkmcnt(0)
s_barrier
v_mfma_f32_16x16x32_bf16 v[52:55], a[8:11], a[72:75], v[52:55]
s_xor_b32 m0, s77, 65536
ds_read_b64_tr_b16 a[104:105], v4 offset:32768
v_mfma_f32_16x16x32_bf16 v[68:71], a[16:19], a[72:75], v[68:71]
s_xor_b32 s64, s71, 524288
ds_read_b64_tr_b16 a[106:107], v4 offset:33792
v_mfma_f32_16x16x32_bf16 v[68:71], a[20:23], a[76:79], v[68:71]
buffer_load_dwordx4 v14, s[56:59], s64 offen lds
v_mfma_f32_16x16x32_bf16 v[84:87], a[28:31], a[76:79], v[84:87]
ds_read_b64_tr_b16 a[108:109], v4 offset:40960
v_mfma_f32_16x16x32_bf16 v[84:87], a[24:27], a[72:75], v[84:87]
ds_read_b64_tr_b16 a[110:111], v4 offset:41984
v_mfma_f32_16x16x32_bf16 v[148:151], a[24:27], a[80:83], v[148:151]
ds_read_b64_tr_b16 a[112:113], v5 offset:32768
v_mfma_f32_16x16x32_bf16 v[148:151], a[28:31], a[84:87], v[148:151]
ds_read_b64_tr_b16 a[114:115], v5 offset:33792
v_mfma_f32_16x16x32_bf16 v[132:135], a[20:23], a[84:87], v[132:135]
ds_read_b64_tr_b16 a[116:117], v5 offset:40960
v_mfma_f32_16x16x32_bf16 v[132:135], a[16:19], a[80:83], v[132:135]
ds_read_b64_tr_b16 a[118:119], v5 offset:41984
v_mfma_f32_16x16x32_bf16 v[116:119], a[8:11], a[80:83], v[116:119]
s_add_u32 m0, s78, 81920
ds_read_b64_tr_b16 a[72:73], v6 offset:32768
v_mfma_f32_16x16x32_bf16 v[116:119], a[12:15], a[84:87], v[116:119]
s_add_u32 s64, s75, 393216
ds_read_b64_tr_b16 a[74:75], v6 offset:33792
v_mfma_f32_16x16x32_bf16 v[100:103], a[4:7], a[84:87], v[100:103]
buffer_load_dwordx4 v23, s[60:63], s64 offen lds
v_mfma_f32_16x16x32_bf16 v[100:103], a[0:3], a[80:83], v[100:103]
ds_read_b64_tr_b16 a[76:77], v6 offset:40960
v_mfma_f32_16x16x32_bf16 v[248:251], a[0:3], a[88:91], v[248:251]
ds_read_b64_tr_b16 a[78:79], v6 offset:41984
v_mfma_f32_16x16x32_bf16 v[248:251], a[4:7], a[92:95], v[248:251]
ds_read_b64_tr_b16 a[80:81], v7 offset:32768
v_mfma_f32_16x16x32_bf16 v[252:255], a[12:15], a[92:95], v[252:255]
ds_read_b64_tr_b16 a[82:83], v7 offset:33792
v_mfma_f32_16x16x32_bf16 v[252:255], a[8:11], a[88:91], v[252:255]
ds_read_b64_tr_b16 a[84:85], v7 offset:40960
v_mfma_f32_16x16x32_bf16 a[120:123], a[16:19], a[88:91], a[120:123]
ds_read_b64_tr_b16 a[86:87], v7 offset:41984
v_mfma_f32_16x16x32_bf16 a[120:123], a[20:23], a[92:95], a[120:123]
s_xor_b32 m0, s77, 66560
v_mfma_f32_16x16x32_bf16 a[124:127], a[28:31], a[92:95], a[124:127]
s_xor_b32 s64, s71, 557056
v_mfma_f32_16x16x32_bf16 a[124:127], a[24:27], a[88:91], a[124:127]
buffer_load_dwordx4 v14, s[56:59], s64 offen lds
v_mfma_f32_16x16x32_bf16 a[128:131], a[24:27], a[96:99], a[128:131]
ds_read_b64_tr_b16 a[88:89], v8 offset:32768
v_mfma_f32_16x16x32_bf16 a[128:131], a[28:31], a[100:103], a[128:131]
ds_read_b64_tr_b16 a[90:91], v8 offset:33792
v_mfma_f32_16x16x32_bf16 a[132:135], a[20:23], a[100:103], a[132:135]
ds_read_b64_tr_b16 a[92:93], v8 offset:40960
v_mfma_f32_16x16x32_bf16 a[132:135], a[16:19], a[96:99], a[132:135]
ds_read_b64_tr_b16 a[94:95], v8 offset:41984
v_mfma_f32_16x16x32_bf16 a[136:139], a[8:11], a[96:99], a[136:139]
v_mfma_f32_16x16x32_bf16 a[136:139], a[12:15], a[100:103], a[136:139]
v_mfma_f32_16x16x32_bf16 a[140:143], a[4:7], a[100:103], a[140:143]
s_add_u32 m0, s78, 86016
v_mfma_f32_16x16x32_bf16 a[140:143], a[0:3], a[96:99], a[140:143]
s_waitcnt lgkmcnt(4)
s_add_u32 s64, s75, 395264
ds_read_b64_tr_b16 a[96:97], v9 offset:32768
v_mfma_f32_16x16x32_bf16 v[184:187], a[104:107], a[32:35], v[184:187]
s_lshl_b32 s66, s30, 30
buffer_load_dwordx4 v23, s[60:63], s64 offen lds
v_mfma_f32_16x16x32_bf16 v[184:187], a[108:111], a[36:39], v[184:187]
ds_read_b64_tr_b16 a[98:99], v9 offset:33792
v_lshl_add_u32 v1, v0, 24, s66
v_mfma_f32_16x16x32_bf16 v[192:195], a[108:111], a[44:47], v[192:195]
s_lshr_b32 s66, s3, 1
ds_read_b64_tr_b16 a[100:101], v9 offset:40960
v_mfma_f32_16x16x32_bf16 v[192:195], a[104:107], a[40:43], v[192:195]
s_lshl_b32 s66, s66, 12
ds_read_b64_tr_b16 a[102:103], v9 offset:41984
v_mfma_f32_16x16x32_bf16 v[200:203], a[104:107], a[48:51], v[200:203]
v_mfma_f32_16x16x32_bf16 v[200:203], a[108:111], a[52:55], v[200:203]
v_mfma_f32_16x16x32_bf16 v[208:211], a[108:111], a[60:63], v[208:211]
v_mfma_f32_16x16x32_bf16 v[208:211], a[104:107], a[56:59], v[208:211]
ds_read_b64_tr_b16 a[104:105], v10 offset:32768
v_mfma_f32_16x16x32_bf16 v[212:215], a[112:115], a[56:59], v[212:215]
s_xor_b32 m0, s77, 67584
ds_read_b64_tr_b16 a[106:107], v10 offset:33792
v_mfma_f32_16x16x32_bf16 v[212:215], a[116:119], a[60:63], v[212:215]
s_xor_b32 s64, s71, 589824
ds_read_b64_tr_b16 a[108:109], v10 offset:40960
v_mfma_f32_16x16x32_bf16 v[204:207], a[116:119], a[52:55], v[204:207]
buffer_load_dwordx4 v15, s[56:59], s64 offen lds
v_mfma_f32_16x16x32_bf16 v[204:207], a[112:115], a[48:51], v[204:207]
ds_read_b64_tr_b16 a[110:111], v10 offset:41984
v_mfma_f32_16x16x32_bf16 v[196:199], a[112:115], a[40:43], v[196:199]
v_mfma_f32_16x16x32_bf16 v[196:199], a[116:119], a[44:47], v[196:199]
v_mfma_f32_16x16x32_bf16 v[188:191], a[116:119], a[36:39], v[188:191]
v_mfma_f32_16x16x32_bf16 v[188:191], a[112:115], a[32:35], v[188:191]
s_add_u32 s67, s79, 20480
ds_read_b64_tr_b16 a[112:113], v11 offset:32768
v_mfma_f32_16x16x32_bf16 v[216:219], a[72:75], a[32:35], v[216:219]
ds_read_b64_tr_b16 a[114:115], v11 offset:33792
v_mfma_f32_16x16x32_bf16 v[216:219], a[76:79], a[36:39], v[216:219]
s_add_u32 m0, s78, 90112
ds_read_b64_tr_b16 a[116:117], v11 offset:40960
v_cvt_pk_bf16_f32 v215, v214, v215
v_mfma_f32_16x16x32_bf16 v[224:227], a[76:79], a[44:47], v[224:227]
s_add_u32 s64, s75, 397312
ds_read_b64_tr_b16 a[118:119], v11 offset:41984
v_cvt_pk_bf16_f32 v214, v212, v213
v_mfma_f32_16x16x32_bf16 v[224:227], a[72:75], a[40:43], v[224:227]
buffer_load_dwordx4 v23, s[60:63], s64 offen lds
v_mfma_f32_16x16x32_bf16 v[232:235], a[72:75], a[48:51], v[232:235]
v_cvt_pk_bf16_f32 v212, v208, v209
v_cvt_pk_bf16_f32 v213, v210, v211
v_mfma_f32_16x16x32_bf16 v[232:235], a[76:79], a[52:55], v[232:235]
buffer_store_dwordx4 v[212:215], v16, s[44:47], s67 offen sc1
v_mfma_f32_16x16x32_bf16 v[240:243], a[76:79], a[60:63], v[240:243]
v_cvt_pk_bf16_f32 v207, v206, v207
v_cvt_pk_bf16_f32 v206, v204, v205
v_mfma_f32_16x16x32_bf16 v[240:243], a[72:75], a[56:59], v[240:243]
ds_read_b64_tr_b16 a[72:73], v4 offset:49152
v_cvt_pk_bf16_f32 v204, v200, v201
v_mfma_f32_16x16x32_bf16 v[244:247], a[80:83], a[56:59], v[244:247]
ds_read_b64_tr_b16 a[74:75], v4 offset:50176
v_cvt_pk_bf16_f32 v205, v202, v203
v_mfma_f32_16x16x32_bf16 v[244:247], a[84:87], a[60:63], v[244:247]
ds_read_b64_tr_b16 a[76:77], v4 offset:57344
v_accvgpr_write_b32 a144, v204
v_mfma_f32_16x16x32_bf16 v[236:239], a[84:87], a[52:55], v[236:239]
s_xor_b32 m0, s77, 68608
ds_read_b64_tr_b16 a[78:79], v4 offset:58368
v_accvgpr_write_b32 a145, v205
v_mfma_f32_16x16x32_bf16 v[236:239], a[80:83], a[48:51], v[236:239]
s_xor_b32 s64, s71, 622592
v_accvgpr_write_b32 a146, v206
v_accvgpr_write_b32 a147, v207
v_mfma_f32_16x16x32_bf16 v[228:231], a[80:83], a[40:43], v[228:231]
buffer_load_dwordx4 v15, s[56:59], s64 offen lds
v_mfma_f32_16x16x32_bf16 v[228:231], a[84:87], a[44:47], v[228:231]
v_cvt_pk_bf16_f32 v199, v198, v199
v_cvt_pk_bf16_f32 v198, v196, v197
v_mfma_f32_16x16x32_bf16 v[220:223], a[84:87], a[36:39], v[220:223]
v_cvt_pk_bf16_f32 v196, v192, v193
v_cvt_pk_bf16_f32 v197, v194, v195
v_mfma_f32_16x16x32_bf16 v[220:223], a[80:83], a[32:35], v[220:223]
s_waitcnt lgkmcnt(4)
ds_read_b64_tr_b16 a[80:81], v5 offset:49152
v_accvgpr_write_b32 a148, v196
v_mfma_f32_16x16x32_bf16 v[152:155], a[88:91], a[32:35], v[152:155]
ds_read_b64_tr_b16 a[82:83], v5 offset:50176
v_accvgpr_write_b32 a149, v197
v_mfma_f32_16x16x32_bf16 v[152:155], a[92:95], a[36:39], v[152:155]
ds_read_b64_tr_b16 a[84:85], v5 offset:57344
v_accvgpr_write_b32 a150, v198
v_mfma_f32_16x16x32_bf16 v[160:163], a[92:95], a[44:47], v[160:163]
ds_read_b64_tr_b16 a[86:87], v5 offset:58368
v_accvgpr_write_b32 a151, v199
v_mfma_f32_16x16x32_bf16 v[160:163], a[88:91], a[40:43], v[160:163]
v_cvt_pk_bf16_f32 v191, v190, v191
v_cvt_pk_bf16_f32 v190, v188, v189
v_mfma_f32_16x16x32_bf16 v[168:171], a[88:91], a[48:51], v[168:171]
v_cvt_pk_bf16_f32 v188, v184, v185
v_cvt_pk_bf16_f32 v189, v186, v187
v_mfma_f32_16x16x32_bf16 v[168:171], a[92:95], a[52:55], v[168:171]
v_accvgpr_write_b32 a152, v188
v_accvgpr_write_b32 a153, v189
v_mfma_f32_16x16x32_bf16 v[176:179], a[92:95], a[60:63], v[176:179]
s_xor_b32 m0, s84, 32768
v_accvgpr_write_b32 a154, v190
v_accvgpr_write_b32 a155, v191
v_mfma_f32_16x16x32_bf16 v[176:179], a[88:91], a[56:59], v[176:179]
s_add_u32 s67, s79, 21504
s_xor_b32 s64, s72, 128
ds_read_b64_tr_b16 a[88:89], v6 offset:49152
v_cvt_pk_bf16_f32 v247, v246, v247
v_mfma_f32_16x16x32_bf16 v[180:183], a[96:99], a[56:59], v[180:183]
buffer_load_dwordx4 v12, s[48:51], s64 offen lds
v_mfma_f32_16x16x32_bf16 v[180:183], a[100:103], a[60:63], v[180:183]
ds_read_b64_tr_b16 a[90:91], v6 offset:50176
v_cvt_pk_bf16_f32 v246, v244, v245
v_mfma_f32_16x16x32_bf16 v[172:175], a[100:103], a[52:55], v[172:175]
ds_read_b64_tr_b16 a[92:93], v6 offset:57344
v_cvt_pk_bf16_f32 v244, v240, v241
v_mfma_f32_16x16x32_bf16 v[172:175], a[96:99], a[48:51], v[172:175]
ds_read_b64_tr_b16 a[94:95], v6 offset:58368
v_cvt_pk_bf16_f32 v245, v242, v243
v_mfma_f32_16x16x32_bf16 v[164:167], a[96:99], a[40:43], v[164:167]
buffer_store_dwordx4 v[244:247], v16, s[44:47], s67 offen sc1
v_mfma_f32_16x16x32_bf16 v[164:167], a[100:103], a[44:47], v[164:167]
s_xor_b32 m0, s84, 33792
v_cvt_pk_bf16_f32 v239, v238, v239
v_cvt_pk_bf16_f32 v238, v236, v237
v_mfma_f32_16x16x32_bf16 v[156:159], a[100:103], a[36:39], v[156:159]
s_xor_b32 s64, s72, 16512
v_cvt_pk_bf16_f32 v236, v232, v233
v_cvt_pk_bf16_f32 v237, v234, v235
v_mfma_f32_16x16x32_bf16 v[156:159], a[96:99], a[32:35], v[156:159]
buffer_load_dwordx4 v13, s[48:51], s64 offen lds
v_mfma_f32_16x16x32_bf16 v[24:27], a[104:107], a[32:35], v[24:27]
ds_read_b64_tr_b16 a[96:97], v7 offset:49152
v_accvgpr_write_b32 a156, v236
v_mfma_f32_16x16x32_bf16 v[24:27], a[108:111], a[36:39], v[24:27]
ds_read_b64_tr_b16 a[98:99], v7 offset:50176
v_accvgpr_write_b32 a157, v237
v_mfma_f32_16x16x32_bf16 v[40:43], a[108:111], a[44:47], v[40:43]
ds_read_b64_tr_b16 a[100:101], v7 offset:57344
v_accvgpr_write_b32 a158, v238
v_mfma_f32_16x16x32_bf16 v[40:43], a[104:107], a[40:43], v[40:43]
ds_read_b64_tr_b16 a[102:103], v7 offset:58368
v_accvgpr_write_b32 a159, v239
v_mfma_f32_16x16x32_bf16 v[56:59], a[104:107], a[48:51], v[56:59]
s_xor_b32 m0, s84, 34816
v_cvt_pk_bf16_f32 v231, v230, v231
v_cvt_pk_bf16_f32 v230, v228, v229
v_mfma_f32_16x16x32_bf16 v[56:59], a[108:111], a[52:55], v[56:59]
s_xor_b32 s64, s72, 131200
v_cvt_pk_bf16_f32 v228, v224, v225
v_cvt_pk_bf16_f32 v229, v226, v227
v_mfma_f32_16x16x32_bf16 v[72:75], a[108:111], a[60:63], v[72:75]
s_waitcnt vmcnt(11)
buffer_load_dwordx4 v12, s[48:51], s64 offen lds
v_mfma_f32_16x16x32_bf16 v[72:75], a[104:107], a[56:59], v[72:75]
ds_read_b64_tr_b16 a[104:105], v8 offset:49152
v_accvgpr_write_b32 a160, v228
v_mfma_f32_16x16x32_bf16 v[136:139], a[112:115], a[56:59], v[136:139]
ds_read_b64_tr_b16 a[106:107], v8 offset:50176
v_accvgpr_write_b32 a161, v229
v_mfma_f32_16x16x32_bf16 v[136:139], a[116:119], a[60:63], v[136:139]
ds_read_b64_tr_b16 a[108:109], v8 offset:57344
v_add_u32 v4, 0x8000, v4
v_mfma_f32_16x16x32_bf16 v[120:123], a[116:119], a[52:55], v[120:123]
ds_read_b64_tr_b16 a[110:111], v8 offset:58368
v_accvgpr_write_b32 a162, v230
v_mfma_f32_16x16x32_bf16 v[120:123], a[112:115], a[48:51], v[120:123]
s_xor_b32 m0, s84, 35840
ds_read_b128 a[0:3], v2 offset:0
v_accvgpr_write_b32 a163, v231
v_mfma_f32_16x16x32_bf16 v[104:107], a[112:115], a[40:43], v[104:107]
s_xor_b32 s64, s72, 147584
ds_read_b128 a[4:7], v3 offset:0
v_cvt_pk_bf16_f32 v223, v222, v223
v_mfma_f32_16x16x32_bf16 v[104:107], a[116:119], a[44:47], v[104:107]
buffer_load_dwordx4 v13, s[48:51], s64 offen lds
v_mfma_f32_16x16x32_bf16 v[88:91], a[116:119], a[36:39], v[88:91]
ds_read_b128 a[8:11], v2 offset:2048
v_cvt_pk_bf16_f32 v222, v220, v221
v_mfma_f32_16x16x32_bf16 v[88:91], a[112:115], a[32:35], v[88:91]
s_waitcnt lgkmcnt(7)
ds_read_b128 a[12:15], v3 offset:2048
v_cvt_pk_bf16_f32 v220, v216, v217
v_mfma_f32_16x16x32_bf16 v[28:31], a[32:35], a[72:75], v[28:31]
ds_read_b128 a[16:19], v2 offset:4096
v_cvt_pk_bf16_f32 v221, v218, v219
v_mfma_f32_16x16x32_bf16 v[28:31], a[36:39], a[76:79], v[28:31]
ds_read_b128 a[20:23], v3 offset:4096
v_add_u32 v5, 0x8000, v5
v_mfma_f32_16x16x32_bf16 v[44:47], a[44:47], a[76:79], v[44:47]
s_xor_b32 m0, s84, 36864
ds_read_b128 a[24:27], v2 offset:6144
v_accvgpr_write_b32 a164, v220
v_mfma_f32_16x16x32_bf16 v[44:47], a[40:43], a[72:75], v[44:47]
s_xor_b32 s64, s73, 128
ds_read_b128 a[28:31], v3 offset:6144
v_accvgpr_write_b32 a165, v221
v_mfma_f32_16x16x32_bf16 v[60:63], a[48:51], a[72:75], v[60:63]
buffer_load_dwordx4 v12, s[48:51], s64 offen lds
v_mfma_f32_16x16x32_bf16 v[60:63], a[52:55], a[76:79], v[60:63]
ds_read_b64_tr_b16 a[112:113], v9 offset:49152
v_accvgpr_write_b32 a166, v222
v_mfma_f32_16x16x32_bf16 v[76:79], a[60:63], a[76:79], v[76:79]
ds_read_b64_tr_b16 a[114:115], v9 offset:50176
v_accvgpr_write_b32 a167, v223
v_mfma_f32_16x16x32_bf16 v[76:79], a[56:59], a[72:75], v[76:79]
s_add_u32 s67, s79, 22528
ds_read_b64_tr_b16 a[116:117], v9 offset:57344
v_cvt_pk_bf16_f32 v183, v182, v183
v_mfma_f32_16x16x32_bf16 v[140:143], a[56:59], a[80:83], v[140:143]
ds_read_b64_tr_b16 a[118:119], v9 offset:58368
v_cvt_pk_bf16_f32 v182, v180, v181
v_mfma_f32_16x16x32_bf16 v[140:143], a[60:63], a[84:87], v[140:143]
s_xor_b32 m0, s84, 37888
ds_read_b64_tr_b16 a[72:73], v10 offset:49152
v_add_u32 v6, 0x8000, v6
v_mfma_f32_16x16x32_bf16 v[124:127], a[52:55], a[84:87], v[124:127]
s_xor_b32 s64, s73, 16512
ds_read_b64_tr_b16 a[74:75], v10 offset:50176
v_cvt_pk_bf16_f32 v180, v176, v177
v_mfma_f32_16x16x32_bf16 v[124:127], a[48:51], a[80:83], v[124:127]
buffer_load_dwordx4 v13, s[48:51], s64 offen lds
v_mfma_f32_16x16x32_bf16 v[108:111], a[40:43], a[80:83], v[108:111]
ds_read_b64_tr_b16 a[76:77], v10 offset:57344
v_cvt_pk_bf16_f32 v181, v178, v179
v_mfma_f32_16x16x32_bf16 v[108:111], a[44:47], a[84:87], v[108:111]
ds_read_b64_tr_b16 a[78:79], v10 offset:58368
v_mfma_f32_16x16x32_bf16 v[92:95], a[36:39], a[84:87], v[92:95]
buffer_store_dwordx4 v[180:183], v16, s[44:47], s67 offen sc1
v_mfma_f32_16x16x32_bf16 v[92:95], a[32:35], a[80:83], v[92:95]
ds_read_b64_tr_b16 a[80:81], v11 offset:49152
v_cvt_pk_bf16_f32 v175, v174, v175
v_mfma_f32_16x16x32_bf16 v[32:35], a[32:35], a[88:91], v[32:35]
s_xor_b32 m0, s84, 38912
ds_read_b64_tr_b16 a[82:83], v11 offset:50176
v_cvt_pk_bf16_f32 v174, v172, v173
v_mfma_f32_16x16x32_bf16 v[32:35], a[36:39], a[92:95], v[32:35]
s_xor_b32 s64, s73, 131200
ds_read_b64_tr_b16 a[84:85], v11 offset:57344
v_add_u32 v7, 0x8000, v7
v_mfma_f32_16x16x32_bf16 v[48:51], a[44:47], a[92:95], v[48:51]
buffer_load_dwordx4 v12, s[48:51], s64 offen lds
v_mfma_f32_16x16x32_bf16 v[48:51], a[40:43], a[88:91], v[48:51]
ds_read_b64_tr_b16 a[86:87], v11 offset:58368
v_cvt_pk_bf16_f32 v172, v168, v169
v_mfma_f32_16x16x32_bf16 v[64:67], a[48:51], a[88:91], v[64:67]
v_cvt_pk_bf16_f32 v173, v170, v171
v_accvgpr_write_b32 a168, v172
v_mfma_f32_16x16x32_bf16 v[64:67], a[52:55], a[92:95], v[64:67]
v_accvgpr_write_b32 a169, v173
v_accvgpr_write_b32 a170, v174
v_mfma_f32_16x16x32_bf16 v[80:83], a[60:63], a[92:95], v[80:83]
v_accvgpr_write_b32 a171, v175
v_cvt_pk_bf16_f32 v167, v166, v167
v_mfma_f32_16x16x32_bf16 v[80:83], a[56:59], a[88:91], v[80:83]
s_xor_b32 m0, s84, 39936
v_cvt_pk_bf16_f32 v166, v164, v165
v_cvt_pk_bf16_f32 v164, v160, v161
v_mfma_f32_16x16x32_bf16 v[144:147], a[56:59], a[96:99], v[144:147]
s_xor_b32 s64, s73, 147584
v_cvt_pk_bf16_f32 v165, v162, v163
v_accvgpr_write_b32 a172, v164
v_mfma_f32_16x16x32_bf16 v[144:147], a[60:63], a[100:103], v[144:147]
buffer_load_dwordx4 v13, s[48:51], s64 offen lds
v_mfma_f32_16x16x32_bf16 v[128:131], a[52:55], a[100:103], v[128:131]
v_add_u32 v8, 0x8000, v8
v_accvgpr_write_b32 a173, v165
v_mfma_f32_16x16x32_bf16 v[128:131], a[48:51], a[96:99], v[128:131]
v_accvgpr_write_b32 a174, v166
v_accvgpr_write_b32 a175, v167
v_mfma_f32_16x16x32_bf16 v[112:115], a[40:43], a[96:99], v[112:115]
v_cvt_pk_bf16_f32 v159, v158, v159
v_cvt_pk_bf16_f32 v158, v156, v157
v_mfma_f32_16x16x32_bf16 v[112:115], a[44:47], a[100:103], v[112:115]
v_cvt_pk_bf16_f32 v156, v152, v153
v_cvt_pk_bf16_f32 v157, v154, v155
v_mfma_f32_16x16x32_bf16 v[96:99], a[36:39], a[100:103], v[96:99]
v_add_u32 v9, 0x8000, v9
v_add_u32 v10, 0x8000, v10
v_mfma_f32_16x16x32_bf16 v[96:99], a[32:35], a[96:99], v[96:99]
s_waitcnt lgkmcnt(0)
v_add_u32 v11, 0x8000, v11
v_accvgpr_write_b32 a176, v156
v_mfma_f32_16x16x32_bf16 v[36:39], a[32:35], a[104:107], v[36:39]
v_accvgpr_write_b32 a177, v157
v_accvgpr_write_b32 a178, v158
v_mfma_f32_16x16x32_bf16 v[36:39], a[36:39], a[108:111], v[36:39]
v_accvgpr_write_b32 a179, v159
v_mfma_f32_16x16x32_bf16 v[52:55], a[44:47], a[108:111], v[52:55]
s_add_u32 s67, s79, 23552
s_waitcnt lgkmcnt(0)
s_barrier
v_mfma_f32_16x16x32_bf16 v[52:55], a[40:43], a[104:107], v[52:55]
s_xor_b32 m0, s77, 98304
ds_read_b64_tr_b16 a[88:89], v19 offset:36864
v_cvt_pk_bf16_f32 v139, v138, v139
v_mfma_f32_16x16x32_bf16 v[68:71], a[48:51], a[104:107], v[68:71]
s_xor_b32 s64, s71, 1048576
ds_read_b64_tr_b16 a[90:91], v19 offset:37120
v_cvt_pk_bf16_f32 v138, v136, v137
v_mfma_f32_16x16x32_bf16 v[68:71], a[52:55], a[108:111], v[68:71]
buffer_load_dwordx4 v14, s[56:59], s64 offen lds
v_mfma_f32_16x16x32_bf16 v[84:87], a[60:63], a[108:111], v[84:87]
ds_read_b64_tr_b16 a[92:93], v19 offset:38912
v_cvt_pk_bf16_f32 v136, v72, v73
v_mfma_f32_16x16x32_bf16 v[84:87], a[56:59], a[104:107], v[84:87]
ds_read_b64_tr_b16 a[94:95], v19 offset:39168
v_cvt_pk_bf16_f32 v137, v74, v75
v_mfma_f32_16x16x32_bf16 v[148:151], a[56:59], a[112:115], v[148:151]
ds_read_b64_tr_b16 a[96:97], v20 offset:36864
v_mfma_f32_16x16x32_bf16 v[148:151], a[60:63], a[116:119], v[148:151]
ds_read_b64_tr_b16 a[98:99], v20 offset:37120
v_mfma_f32_16x16x32_bf16 v[132:135], a[52:55], a[116:119], v[132:135]
ds_read_b64_tr_b16 a[100:101], v20 offset:38912
v_mfma_f32_16x16x32_bf16 v[132:135], a[48:51], a[112:115], v[132:135]
ds_read_b64_tr_b16 a[102:103], v20 offset:39168
v_mfma_f32_16x16x32_bf16 v[116:119], a[40:43], a[112:115], v[116:119]
s_add_u32 m0, s78, 114688
ds_read_b64_tr_b16 a[104:105], v19 offset:40960
v_mfma_f32_16x16x32_bf16 v[116:119], a[44:47], a[116:119], v[116:119]
s_add_u32 s64, s75, 786432
ds_read_b64_tr_b16 a[106:107], v19 offset:41216
v_mfma_f32_16x16x32_bf16 v[100:103], a[36:39], a[116:119], v[100:103]
buffer_load_dwordx4 v23, s[60:63], s64 offen lds
v_mfma_f32_16x16x32_bf16 v[100:103], a[32:35], a[112:115], v[100:103]
ds_read_b64_tr_b16 a[108:109], v19 offset:43008
v_mfma_f32_16x16x32_bf16 v[248:251], a[32:35], a[72:75], v[248:251]
ds_read_b64_tr_b16 a[110:111], v19 offset:43264
v_mfma_f32_16x16x32_bf16 v[248:251], a[36:39], a[76:79], v[248:251]
ds_read_b64_tr_b16 a[112:113], v20 offset:40960
v_mfma_f32_16x16x32_bf16 v[252:255], a[44:47], a[76:79], v[252:255]
ds_read_b64_tr_b16 a[114:115], v20 offset:41216
v_mfma_f32_16x16x32_bf16 v[252:255], a[40:43], a[72:75], v[252:255]
ds_read_b64_tr_b16 a[116:117], v20 offset:43008
v_mfma_f32_16x16x32_bf16 a[120:123], a[48:51], a[72:75], a[120:123]
ds_read_b64_tr_b16 a[118:119], v20 offset:43264
v_mfma_f32_16x16x32_bf16 a[120:123], a[52:55], a[76:79], a[120:123]
s_xor_b32 m0, s77, 99328
buffer_store_dwordx4 v[136:139], v16, s[44:47], s67 offen sc1
v_mfma_f32_16x16x32_bf16 a[124:127], a[60:63], a[76:79], a[124:127]
s_xor_b32 s64, s71, 1081344
v_cvt_pk_bf16_f32 v123, v122, v123
v_cvt_pk_bf16_f32 v122, v120, v121
v_mfma_f32_16x16x32_bf16 a[124:127], a[56:59], a[72:75], a[124:127]
buffer_load_dwordx4 v14, s[56:59], s64 offen lds
v_mfma_f32_16x16x32_bf16 a[128:131], a[56:59], a[80:83], a[128:131]
ds_read_b64_tr_b16 a[72:73], v19 offset:32768
v_cvt_pk_bf16_f32 v120, v56, v57
v_mfma_f32_16x16x32_bf16 a[128:131], a[60:63], a[84:87], a[128:131]
ds_read_b64_tr_b16 a[74:75], v19 offset:33024
v_cvt_pk_bf16_f32 v121, v58, v59
v_mfma_f32_16x16x32_bf16 a[132:135], a[52:55], a[84:87], a[132:135]
ds_read_b64_tr_b16 a[76:77], v19 offset:34816
v_accvgpr_write_b32 a180, v120
v_mfma_f32_16x16x32_bf16 a[132:135], a[48:51], a[80:83], a[132:135]
ds_read_b64_tr_b16 a[78:79], v19 offset:35072
v_accvgpr_write_b32 a181, v121
v_mfma_f32_16x16x32_bf16 a[136:139], a[40:43], a[80:83], a[136:139]
v_accvgpr_write_b32 a182, v122
v_accvgpr_write_b32 a183, v123
v_mfma_f32_16x16x32_bf16 a[136:139], a[44:47], a[84:87], a[136:139]
v_cvt_pk_bf16_f32 v107, v106, v107
v_cvt_pk_bf16_f32 v106, v104, v105
v_mfma_f32_16x16x32_bf16 a[140:143], a[36:39], a[84:87], a[140:143]
s_add_u32 m0, s78, 118784
v_cvt_pk_bf16_f32 v104, v40, v41
v_cvt_pk_bf16_f32 v105, v42, v43
v_mfma_f32_16x16x32_bf16 a[140:143], a[32:35], a[80:83], a[140:143]
s_waitcnt lgkmcnt(4)
s_add_u32 s64, s75, 788480
ds_read_b64_tr_b16 a[80:81], v20 offset:32768
v_accvgpr_write_b32 a184, v104
v_mfma_f32_16x16x32_bf16 v[184:187], a[88:91], a[0:3], 0
buffer_load_dwordx4 v23, s[60:63], s64 offen lds
v_mfma_f32_16x16x32_bf16 v[184:187], a[92:95], a[4:7], v[184:187]
ds_read_b64_tr_b16 a[82:83], v20 offset:33024
v_accvgpr_write_b32 a185, v105
v_mfma_f32_16x16x32_bf16 v[192:195], a[92:95], a[12:15], 0
ds_read_b64_tr_b16 a[84:85], v20 offset:34816
v_accvgpr_write_b32 a186, v106
v_mfma_f32_16x16x32_bf16 v[192:195], a[88:91], a[8:11], v[192:195]
s_add_u32 s17, s78, .-L_pc+6144
ds_read_b64_tr_b16 a[86:87], v20 offset:35072
v_accvgpr_write_b32 a187, v107
v_mfma_f32_16x16x32_bf16 v[200:203], a[88:91], a[16:19], 0
buffer_load_dword a252, v16, s[88:91], s17 offen
v_mfma_f32_16x16x32_bf16 v[200:203], a[92:95], a[20:23], v[200:203]
v_cvt_pk_bf16_f32 v91, v90, v91
v_cvt_pk_bf16_f32 v90, v88, v89
v_mfma_f32_16x16x32_bf16 v[208:211], a[92:95], a[28:31], 0
v_cvt_pk_bf16_f32 v88, v24, v25
v_cvt_pk_bf16_f32 v89, v26, v27
v_mfma_f32_16x16x32_bf16 v[208:211], a[88:91], a[24:27], v[208:211]
ds_read_b64_tr_b16 a[88:89], v4 offset:32768
v_accvgpr_write_b32 a188, v88
v_mfma_f32_16x16x32_bf16 v[212:215], a[96:99], a[24:27], 0
s_xor_b32 m0, s77, 100352
ds_read_b64_tr_b16 a[90:91], v4 offset:33792
v_accvgpr_write_b32 a189, v89
v_mfma_f32_16x16x32_bf16 v[212:215], a[100:103], a[28:31], v[212:215]
s_xor_b32 s64, s71, 1114112
ds_read_b64_tr_b16 a[92:93], v4 offset:40960
v_accvgpr_write_b32 a190, v90
v_mfma_f32_16x16x32_bf16 v[204:207], a[100:103], a[20:23], 0
buffer_load_dwordx4 v15, s[56:59], s64 offen lds
v_mfma_f32_16x16x32_bf16 v[204:207], a[96:99], a[16:19], v[204:207]
ds_read_b64_tr_b16 a[94:95], v4 offset:41984
v_accvgpr_write_b32 a191, v91
v_mfma_f32_16x16x32_bf16 v[196:199], a[96:99], a[8:11], 0
s_add_u32 s67, s79, 8192
v_cvt_pk_bf16_f32 v47, v46, v47
v_cvt_pk_bf16_f32 v46, v44, v45
v_mfma_f32_16x16x32_bf16 v[196:199], a[100:103], a[12:15], v[196:199]
v_cvt_pk_bf16_f32 v44, v28, v29
v_cvt_pk_bf16_f32 v45, v30, v31
v_mfma_f32_16x16x32_bf16 v[188:191], a[100:103], a[4:7], 0
buffer_store_dwordx4 v[44:47], v16, s[44:47], s67 offen sc1
v_mfma_f32_16x16x32_bf16 v[188:191], a[96:99], a[0:3], v[188:191]
ds_read_b64_tr_b16 a[96:97], v5 offset:32768
v_cvt_pk_bf16_f32 v79, v78, v79
v_mfma_f32_16x16x32_bf16 v[216:219], a[0:3], a[104:107], 0
ds_read_b64_tr_b16 a[98:99], v5 offset:33792
v_cvt_pk_bf16_f32 v78, v76, v77
v_mfma_f32_16x16x32_bf16 v[216:219], a[4:7], a[108:111], v[216:219]
s_add_u32 m0, s78, 122880
ds_read_b64_tr_b16 a[100:101], v5 offset:40960
v_cvt_pk_bf16_f32 v76, v60, v61
v_mfma_f32_16x16x32_bf16 v[224:227], a[12:15], a[108:111], 0
s_add_u32 s64, s75, 790528
ds_read_b64_tr_b16 a[102:103], v5 offset:41984
v_cvt_pk_bf16_f32 v77, v62, v63
v_mfma_f32_16x16x32_bf16 v[224:227], a[8:11], a[104:107], v[224:227]
buffer_load_dwordx4 v23, s[60:63], s64 offen lds
v_mfma_f32_16x16x32_bf16 v[232:235], a[16:19], a[104:107], 0
v_accvgpr_write_b32 a192, v76
v_accvgpr_write_b32 a193, v77
v_mfma_f32_16x16x32_bf16 v[232:235], a[20:23], a[108:111], v[232:235]
v_accvgpr_write_b32 a194, v78
v_accvgpr_write_b32 a195, v79
v_mfma_f32_16x16x32_bf16 v[240:243], a[28:31], a[108:111], 0
v_cvt_pk_bf16_f32 v124, v124, v125
v_cvt_pk_bf16_f32 v125, v126, v127
v_mfma_f32_16x16x32_bf16 v[240:243], a[24:27], a[104:107], v[240:243]
ds_read_b64_tr_b16 a[104:105], v6 offset:32768
v_cvt_pk_bf16_f32 v126, v140, v141
v_mfma_f32_16x16x32_bf16 v[244:247], a[24:27], a[112:115], 0
ds_read_b64_tr_b16 a[106:107], v6 offset:33792
v_cvt_pk_bf16_f32 v127, v142, v143
v_mfma_f32_16x16x32_bf16 v[244:247], a[28:31], a[116:119], v[244:247]
ds_read_b64_tr_b16 a[108:109], v6 offset:40960
v_accvgpr_write_b32 a196, v124
v_mfma_f32_16x16x32_bf16 v[236:239], a[20:23], a[116:119], 0
s_xor_b32 m0, s77, 101376
ds_read_b64_tr_b16 a[110:111], v6 offset:41984
v_accvgpr_write_b32 a197, v125
v_mfma_f32_16x16x32_bf16 v[236:239], a[16:19], a[112:115], v[236:239]
s_xor_b32 s64, s71, 1146880
v_accvgpr_write_b32 a198, v126
v_accvgpr_write_b32 a199, v127
v_mfma_f32_16x16x32_bf16 v[228:231], a[8:11], a[112:115], 0
buffer_load_dwordx4 v15, s[56:59], s64 offen lds
v_mfma_f32_16x16x32_bf16 v[228:231], a[12:15], a[116:119], v[228:231]
v_cvt_pk_bf16_f32 v92, v92, v93
v_cvt_pk_bf16_f32 v93, v94, v95
v_mfma_f32_16x16x32_bf16 v[220:223], a[4:7], a[116:119], 0
v_cvt_pk_bf16_f32 v94, v108, v109
v_cvt_pk_bf16_f32 v95, v110, v111
v_mfma_f32_16x16x32_bf16 v[220:223], a[0:3], a[112:115], v[220:223]
s_waitcnt lgkmcnt(4)
ds_read_b64_tr_b16 a[112:113], v7 offset:32768
v_accvgpr_write_b32 a200, v92
v_mfma_f32_16x16x32_bf16 v[152:155], a[72:75], a[0:3], 0
ds_read_b64_tr_b16 a[114:115], v7 offset:33792
v_accvgpr_write_b32 a201, v93
v_mfma_f32_16x16x32_bf16 v[152:155], a[76:79], a[4:7], v[152:155]
ds_read_b64_tr_b16 a[116:117], v7 offset:40960
v_accvgpr_write_b32 a202, v94
v_mfma_f32_16x16x32_bf16 v[160:163], a[76:79], a[12:15], 0
ds_read_b64_tr_b16 a[118:119], v7 offset:41984
v_accvgpr_write_b32 a203, v95
v_mfma_f32_16x16x32_bf16 v[160:163], a[72:75], a[8:11], v[160:163]
s_add_u32 s67, s79, 10240
v_cvt_pk_bf16_f32 v51, v50, v51
v_cvt_pk_bf16_f32 v50, v48, v49
v_mfma_f32_16x16x32_bf16 v[168:171], a[72:75], a[16:19], 0
v_cvt_pk_bf16_f32 v48, v32, v33
v_cvt_pk_bf16_f32 v49, v34, v35
v_mfma_f32_16x16x32_bf16 v[168:171], a[76:79], a[20:23], v[168:171]
buffer_store_dwordx4 v[48:51], v16, s[44:47], s67 offen sc1
v_mfma_f32_16x16x32_bf16 v[176:179], a[76:79], a[28:31], 0
s_xor_b32 m0, s84, 0
v_subrev_u32 v19, 0x8000, v19
v_subrev_u32 v20, 0x8000, v20
v_mfma_f32_16x16x32_bf16 v[176:179], a[72:75], a[24:27], v[176:179]
s_xor_b32 s64, s72, 256
ds_read_b64_tr_b16 a[72:73], v8 offset:32768
v_cvt_pk_bf16_f32 v83, v82, v83
v_mfma_f32_16x16x32_bf16 v[180:183], a[80:83], a[24:27], 0
buffer_load_dwordx4 v12, s[48:51], s64 offen lds
v_mfma_f32_16x16x32_bf16 v[180:183], a[84:87], a[28:31], v[180:183]
ds_read_b64_tr_b16 a[74:75], v8 offset:33792
v_subrev_u32 v4, 0x8000, v4
v_mfma_f32_16x16x32_bf16 v[172:175], a[84:87], a[20:23], 0
ds_read_b64_tr_b16 a[76:77], v8 offset:40960
v_cvt_pk_bf16_f32 v82, v80, v81
v_mfma_f32_16x16x32_bf16 v[172:175], a[80:83], a[16:19], v[172:175]
s_xor_b32 m0, s84, 1024
ds_read_b64_tr_b16 a[78:79], v8 offset:41984
v_cvt_pk_bf16_f32 v80, v64, v65
v_mfma_f32_16x16x32_bf16 v[164:167], a[80:83], a[8:11], 0
s_xor_b32 s64, s72, 16640
v_cvt_pk_bf16_f32 v81, v66, v67
v_accvgpr_write_b32 a204, v80
v_mfma_f32_16x16x32_bf16 v[164:167], a[84:87], a[12:15], v[164:167]
buffer_load_dwordx4 v13, s[48:51], s64 offen lds
v_mfma_f32_16x16x32_bf16 v[156:159], a[84:87], a[4:7], 0
v_accvgpr_write_b32 a205, v81
v_accvgpr_write_b32 a206, v82
v_mfma_f32_16x16x32_bf16 v[156:159], a[80:83], a[0:3], v[156:159]
ds_read_b64_tr_b16 a[80:81], v9 offset:32768
v_accvgpr_write_b32 a207, v83
v_mfma_f32_16x16x32_bf16 v[24:27], a[88:91], a[0:3], 0
s_xor_b32 m0, s84, 2048
ds_read_b64_tr_b16 a[82:83], v9 offset:33792
v_cvt_pk_bf16_f32 v128, v128, v129
v_mfma_f32_16x16x32_bf16 v[24:27], a[92:95], a[4:7], v[24:27]
s_xor_b32 s64, s72, 131328
ds_read_b64_tr_b16 a[84:85], v9 offset:40960
v_subrev_u32 v5, 0x8000, v5
v_mfma_f32_16x16x32_bf16 v[40:43], a[92:95], a[12:15], 0
buffer_load_dwordx4 v12, s[48:51], s64 offen lds
v_mfma_f32_16x16x32_bf16 v[40:43], a[88:91], a[8:11], v[40:43]
ds_read_b64_tr_b16 a[86:87], v9 offset:41984
v_cvt_pk_bf16_f32 v129, v130, v131
v_mfma_f32_16x16x32_bf16 v[56:59], a[88:91], a[16:19], 0
s_xor_b32 m0, s84, 3072
v_cvt_pk_bf16_f32 v130, v144, v145
v_cvt_pk_bf16_f32 v131, v146, v147
v_mfma_f32_16x16x32_bf16 v[56:59], a[92:95], a[20:23], v[56:59]
s_xor_b32 s64, s72, 147712
v_accvgpr_write_b32 a208, v128
v_accvgpr_write_b32 a209, v129
v_mfma_f32_16x16x32_bf16 v[72:75], a[92:95], a[28:31], 0
s_waitcnt vmcnt(14)
ds_read_b128 a[32:35], v2 offset:32768
v_accvgpr_write_b32 a210, v130
v_mfma_f32_16x16x32_bf16 v[72:75], a[88:91], a[24:27], v[72:75]
buffer_load_dwordx4 v13, s[48:51], s64 offen lds
v_mfma_f32_16x16x32_bf16 v[136:139], a[96:99], a[24:27], 0
ds_read_b128 a[36:39], v3 offset:32768
v_accvgpr_write_b32 a211, v131
v_mfma_f32_16x16x32_bf16 v[136:139], a[100:103], a[28:31], v[136:139]
ds_read_b128 a[40:43], v2 offset:34816
v_subrev_u32 v6, 0x8000, v6
v_mfma_f32_16x16x32_bf16 v[120:123], a[100:103], a[20:23], 0
s_xor_b32 m0, s84, 4096
ds_read_b128 a[44:47], v3 offset:34816
v_cvt_pk_bf16_f32 v96, v96, v97
v_mfma_f32_16x16x32_bf16 v[120:123], a[96:99], a[16:19], v[120:123]
s_xor_b32 s64, s73, 256
ds_read_b128 a[48:51], v2 offset:36864
v_cvt_pk_bf16_f32 v97, v98, v99
v_mfma_f32_16x16x32_bf16 v[104:107], a[96:99], a[8:11], 0
buffer_load_dwordx4 v12, s[48:51], s64 offen lds
v_mfma_f32_16x16x32_bf16 v[104:107], a[100:103], a[12:15], v[104:107]
ds_read_b128 a[52:55], v3 offset:36864
v_cvt_pk_bf16_f32 v98, v112, v113
v_mfma_f32_16x16x32_bf16 v[88:91], a[100:103], a[4:7], 0
ds_read_b128 a[56:59], v2 offset:38912
v_cvt_pk_bf16_f32 v99, v114, v115
v_mfma_f32_16x16x32_bf16 v[88:91], a[96:99], a[0:3], v[88:91]
s_waitcnt lgkmcnt(7)
s_xor_b32 m0, s84, 5120
ds_read_b128 a[60:63], v3 offset:38912
v_accvgpr_write_b32 a212, v96
v_mfma_f32_16x16x32_bf16 v[28:31], a[104:107], a[0:3], 0
s_xor_b32 s64, s73, 16640
ds_read_b64_tr_b16 a[88:89], v10 offset:32768
v_accvgpr_write_b32 a213, v97
v_mfma_f32_16x16x32_bf16 v[28:31], a[108:111], a[4:7], v[28:31]
buffer_load_dwordx4 v13, s[48:51], s64 offen lds
v_mfma_f32_16x16x32_bf16 v[44:47], a[108:111], a[12:15], 0
ds_read_b64_tr_b16 a[90:91], v10 offset:33792
v_subrev_u32 v7, 0x8000, v7
v_mfma_f32_16x16x32_bf16 v[44:47], a[104:107], a[8:11], v[44:47]
s_xor_b32 m0, s84, 6144
ds_read_b64_tr_b16 a[92:93], v10 offset:40960
v_accvgpr_write_b32 a214, v98
v_mfma_f32_16x16x32_bf16 v[60:63], a[104:107], a[16:19], 0
s_xor_b32 s64, s73, 131328
ds_read_b64_tr_b16 a[94:95], v10 offset:41984
v_accvgpr_write_b32 a215, v99
v_mfma_f32_16x16x32_bf16 v[60:63], a[108:111], a[20:23], v[60:63]
s_add_u32 s67, s79, 12288
ds_read_b64_tr_b16 a[96:97], v11 offset:32768
v_cvt_pk_bf16_f32 v55, v54, v55
v_mfma_f32_16x16x32_bf16 v[76:79], a[108:111], a[28:31], 0
buffer_load_dwordx4 v12, s[48:51], s64 offen lds
v_mfma_f32_16x16x32_bf16 v[76:79], a[104:107], a[24:27], v[76:79]
ds_read_b64_tr_b16 a[98:99], v11 offset:33792
v_cvt_pk_bf16_f32 v54, v52, v53
v_mfma_f32_16x16x32_bf16 v[140:143], a[112:115], a[24:27], 0
ds_read_b64_tr_b16 a[100:101], v11 offset:40960
v_cvt_pk_bf16_f32 v52, v36, v37
v_mfma_f32_16x16x32_bf16 v[140:143], a[116:119], a[28:31], v[140:143]
s_xor_b32 m0, s84, 7168
ds_read_b64_tr_b16 a[102:103], v11 offset:41984
v_subrev_u32 v8, 0x8000, v8
v_mfma_f32_16x16x32_bf16 v[124:127], a[116:119], a[20:23], 0
s_xor_b32 s64, s73, 147712
v_cvt_pk_bf16_f32 v53, v38, v39
v_mfma_f32_16x16x32_bf16 v[124:127], a[112:115], a[16:19], v[124:127]
buffer_load_dwordx4 v13, s[48:51], s64 offen lds
v_mfma_f32_16x16x32_bf16 v[108:111], a[112:115], a[8:11], 0
buffer_store_dwordx4 v[52:55], v16, s[44:47], s67 offen sc1
v_mfma_f32_16x16x32_bf16 v[108:111], a[116:119], a[12:15], v[108:111]
v_cvt_pk_bf16_f32 v87, v86, v87
v_cvt_pk_bf16_f32 v86, v84, v85
v_mfma_f32_16x16x32_bf16 v[92:95], a[116:119], a[4:7], 0
v_subrev_u32 v9, 0x8000, v9
v_subrev_u32 v10, 0x8000, v10
v_mfma_f32_16x16x32_bf16 v[92:95], a[112:115], a[0:3], v[92:95]
v_subrev_u32 v11, 0x8000, v11
v_cvt_pk_bf16_f32 v84, v68, v69
v_mfma_f32_16x16x32_bf16 v[32:35], a[72:75], a[0:3], 0
v_cvt_pk_bf16_f32 v85, v70, v71
v_accvgpr_write_b32 a216, v84
v_mfma_f32_16x16x32_bf16 v[32:35], a[76:79], a[4:7], v[32:35]
v_accvgpr_write_b32 a217, v85
v_accvgpr_write_b32 a218, v86
v_mfma_f32_16x16x32_bf16 v[48:51], a[76:79], a[12:15], 0
s_waitcnt lgkmcnt(0)
s_barrier
v_mfma_f32_16x16x32_bf16 v[48:51], a[72:75], a[8:11], v[48:51]
s_xor_b32 m0, s77, 131072
ds_read_b64_tr_b16 a[104:105], v19 offset:4096
v_accvgpr_write_b32 a219, v87
v_mfma_f32_16x16x32_bf16 v[64:67], a[72:75], a[16:19], 0
s_xor_b32 s64, s71, 1572864
ds_read_b64_tr_b16 a[106:107], v19 offset:4352
v_cvt_pk_bf16_f32 v132, v132, v133
v_mfma_f32_16x16x32_bf16 v[64:67], a[76:79], a[20:23], v[64:67]
buffer_load_dwordx4 v14, s[56:59], s64 offen lds
v_mfma_f32_16x16x32_bf16 v[80:83], a[76:79], a[28:31], 0
ds_read_b64_tr_b16 a[108:109], v19 offset:6144
v_cvt_pk_bf16_f32 v133, v134, v135
v_mfma_f32_16x16x32_bf16 v[80:83], a[72:75], a[24:27], v[80:83]
ds_read_b64_tr_b16 a[110:111], v19 offset:6400
v_cvt_pk_bf16_f32 v134, v148, v149
v_mfma_f32_16x16x32_bf16 v[144:147], a[80:83], a[24:27], 0
ds_read_b64_tr_b16 a[112:113], v20 offset:4096
v_cvt_pk_bf16_f32 v135, v150, v151
v_mfma_f32_16x16x32_bf16 v[144:147], a[84:87], a[28:31], v[144:147]
ds_read_b64_tr_b16 a[114:115], v20 offset:4352
v_accvgpr_write_b32 a220, v132
v_mfma_f32_16x16x32_bf16 v[128:131], a[84:87], a[20:23], 0
ds_read_b64_tr_b16 a[116:117], v20 offset:6144
v_accvgpr_write_b32 a221, v133
v_mfma_f32_16x16x32_bf16 v[128:131], a[80:83], a[16:19], v[128:131]
ds_read_b64_tr_b16 a[118:119], v20 offset:6400
v_accvgpr_write_b32 a222, v134
v_mfma_f32_16x16x32_bf16 v[112:115], a[80:83], a[8:11], 0
s_add_u32 m0, s78, 147456
ds_read_b64_tr_b16 a[72:73], v19 offset:8192
v_accvgpr_write_b32 a223, v135
v_mfma_f32_16x16x32_bf16 v[112:115], a[84:87], a[12:15], v[112:115]
s_add_u32 s64, s75, 1179648
ds_read_b64_tr_b16 a[74:75], v19 offset:8448
v_cvt_pk_bf16_f32 v100, v100, v101
v_mfma_f32_16x16x32_bf16 v[96:99], a[84:87], a[4:7], 0
buffer_load_dwordx4 v23, s[60:63], s64 offen lds
v_mfma_f32_16x16x32_bf16 v[96:99], a[80:83], a[0:3], v[96:99]
ds_read_b64_tr_b16 a[76:77], v19 offset:10240
v_cvt_pk_bf16_f32 v101, v102, v103
v_mfma_f32_16x16x32_bf16 v[36:39], a[88:91], a[0:3], 0
ds_read_b64_tr_b16 a[78:79], v19 offset:10496
v_cvt_pk_bf16_f32 v102, v116, v117
v_mfma_f32_16x16x32_bf16 v[36:39], a[92:95], a[4:7], v[36:39]
ds_read_b64_tr_b16 a[80:81], v20 offset:8192
v_cvt_pk_bf16_f32 v103, v118, v119
v_mfma_f32_16x16x32_bf16 v[52:55], a[92:95], a[12:15], 0
ds_read_b64_tr_b16 a[82:83], v20 offset:8448
v_accvgpr_write_b32 a224, v100
v_mfma_f32_16x16x32_bf16 v[52:55], a[88:91], a[8:11], v[52:55]
ds_read_b64_tr_b16 a[84:85], v20 offset:10240
v_accvgpr_write_b32 a225, v101
v_mfma_f32_16x16x32_bf16 v[68:71], a[88:91], a[16:19], 0
s_xor_b32 m0, s77, 132096
ds_read_b64_tr_b16 a[86:87], v20 offset:10496
v_accvgpr_write_b32 a226, v102
v_mfma_f32_16x16x32_bf16 v[68:71], a[92:95], a[20:23], v[68:71]
s_xor_b32 s64, s71, 1605632
s_xor_b32 s68, s66, 0
v_accvgpr_write_b32 a227, v103
v_mfma_f32_16x16x32_bf16 v[84:87], a[92:95], a[28:31], 0
s_add_u32 s67, s79, 14336
s_mov_b64 exec, 1
buffer_atomic_add a251, v1, s[52:55], s68 offen offset:0 sc1
s_mov_b64 exec, -1
v_mfma_f32_16x16x32_bf16 v[84:87], a[88:91], a[24:27], v[84:87]
buffer_load_dwordx4 v14, s[56:59], s64 offen lds
v_mfma_f32_16x16x32_bf16 v[148:151], a[96:99], a[24:27], 0
ds_read_b64_tr_b16 a[88:89], v19 offset:0
v_cvt_pk_bf16_f32 v255, v254, v255
v_mfma_f32_16x16x32_bf16 v[148:151], a[100:103], a[28:31], v[148:151]
ds_read_b64_tr_b16 a[90:91], v19 offset:256
v_cvt_pk_bf16_f32 v254, v252, v253
v_mfma_f32_16x16x32_bf16 v[132:135], a[100:103], a[20:23], 0
ds_read_b64_tr_b16 a[92:93], v19 offset:2048
v_cvt_pk_bf16_f32 v252, v248, v249
v_mfma_f32_16x16x32_bf16 v[132:135], a[96:99], a[16:19], v[132:135]
s_add_u32 s65, s79, 16384
ds_read_b64_tr_b16 a[94:95], v19 offset:2304
v_cvt_pk_bf16_f32 v253, v250, v251
v_mfma_f32_16x16x32_bf16 v[116:119], a[96:99], a[8:11], 0
buffer_store_dwordx4 a[144:147], v16, s[44:47], s65 offen sc1
v_mfma_f32_16x16x32_bf16 v[116:119], a[100:103], a[12:15], v[116:119]
buffer_store_dwordx4 v[252:255], v16, s[44:47], s67 offen sc1
v_mfma_f32_16x16x32_bf16 v[100:103], a[100:103], a[4:7], 0
s_add_u32 m0, s78, 151552
v_mfma_f32_16x16x32_bf16 v[100:103], a[96:99], a[0:3], v[100:103]
s_waitcnt lgkmcnt(4)
s_add_u32 s64, s75, 1181696
ds_read_b64_tr_b16 a[96:97], v20 offset:0
v_accvgpr_read_b32 v248, a120
v_mfma_f32_16x16x32_bf16 v[184:187], a[104:107], a[32:35], v[184:187]
buffer_load_dwordx4 v23, s[60:63], s64 offen lds
v_mfma_f32_16x16x32_bf16 v[184:187], a[108:111], a[36:39], v[184:187]
ds_read_b64_tr_b16 a[98:99], v20 offset:256
v_accvgpr_read_b32 v249, a121
v_mfma_f32_16x16x32_bf16 v[192:195], a[108:111], a[44:47], v[192:195]
ds_read_b64_tr_b16 a[100:101], v20 offset:2048
v_accvgpr_read_b32 v250, a122
v_mfma_f32_16x16x32_bf16 v[192:195], a[104:107], a[40:43], v[192:195]
ds_read_b64_tr_b16 a[102:103], v20 offset:2304
v_accvgpr_read_b32 v251, a123
v_mfma_f32_16x16x32_bf16 v[200:203], a[104:107], a[48:51], v[200:203]
v_accvgpr_read_b32 v252, a124
v_accvgpr_read_b32 v253, a125
v_mfma_f32_16x16x32_bf16 v[200:203], a[108:111], a[52:55], v[200:203]
v_accvgpr_read_b32 v254, a126
v_accvgpr_read_b32 v255, a127
v_mfma_f32_16x16x32_bf16 v[208:211], a[108:111], a[60:63], v[208:211]
v_cvt_pk_bf16_f32 v255, v254, v255
v_cvt_pk_bf16_f32 v254, v252, v253
v_mfma_f32_16x16x32_bf16 v[208:211], a[104:107], a[56:59], v[208:211]
ds_read_b64_tr_b16 a[104:105], v4 offset:0
v_cvt_pk_bf16_f32 v252, v248, v249
v_mfma_f32_16x16x32_bf16 v[212:215], a[112:115], a[56:59], v[212:215]
s_xor_b32 m0, s77, 133120
ds_read_b64_tr_b16 a[106:107], v4 offset:1024
v_cvt_pk_bf16_f32 v253, v250, v251
v_mfma_f32_16x16x32_bf16 v[212:215], a[116:119], a[60:63], v[212:215]
s_xor_b32 s64, s71, 1638400
ds_read_b64_tr_b16 a[108:109], v4 offset:8192
v_accvgpr_write_b32 a228, v252
v_mfma_f32_16x16x32_bf16 v[204:207], a[116:119], a[52:55], v[204:207]
buffer_load_dwordx4 v15, s[56:59], s64 offen lds
v_mfma_f32_16x16x32_bf16 v[204:207], a[112:115], a[48:51], v[204:207]
ds_read_b64_tr_b16 a[110:111], v4 offset:9216
v_accvgpr_write_b32 a229, v253
v_mfma_f32_16x16x32_bf16 v[196:199], a[112:115], a[40:43], v[196:199]
v_accvgpr_write_b32 a230, v254
v_accvgpr_write_b32 a231, v255
v_mfma_f32_16x16x32_bf16 v[196:199], a[116:119], a[44:47], v[196:199]
v_mfma_f32_16x16x32_bf16 v[188:191], a[116:119], a[36:39], v[188:191]
v_accvgpr_read_b32 v248, a132
v_accvgpr_read_b32 v249, a133
v_mfma_f32_16x16x32_bf16 v[188:191], a[112:115], a[32:35], v[188:191]
ds_read_b64_tr_b16 a[112:113], v5 offset:0
v_accvgpr_read_b32 v250, a134
v_mfma_f32_16x16x32_bf16 v[216:219], a[32:35], a[72:75], v[216:219]
ds_read_b64_tr_b16 a[114:115], v5 offset:1024
v_accvgpr_read_b32 v251, a135
v_mfma_f32_16x16x32_bf16 v[216:219], a[36:39], a[76:79], v[216:219]
s_add_u32 m0, s78, 155648
ds_read_b64_tr_b16 a[116:117], v5 offset:8192
v_accvgpr_read_b32 v252, a128
v_mfma_f32_16x16x32_bf16 v[224:227], a[44:47], a[76:79], v[224:227]
s_add_u32 s64, s75, 1183744
ds_read_b64_tr_b16 a[118:119], v5 offset:9216
v_accvgpr_read_b32 v253, a129
v_mfma_f32_16x16x32_bf16 v[224:227], a[40:43], a[72:75], v[224:227]
buffer_load_dwordx4 v23, s[60:63], s64 offen lds
v_mfma_f32_16x16x32_bf16 v[232:235], a[48:51], a[72:75], v[232:235]
v_accvgpr_read_b32 v254, a130
v_accvgpr_read_b32 v255, a131
v_mfma_f32_16x16x32_bf16 v[232:235], a[52:55], a[76:79], v[232:235]
v_cvt_pk_bf16_f32 v255, v254, v255
v_cvt_pk_bf16_f32 v254, v252, v253
v_mfma_f32_16x16x32_bf16 v[240:243], a[60:63], a[76:79], v[240:243]
v_cvt_pk_bf16_f32 v252, v248, v249
v_cvt_pk_bf16_f32 v253, v250, v251
v_mfma_f32_16x16x32_bf16 v[240:243], a[56:59], a[72:75], v[240:243]
ds_read_b64_tr_b16 a[72:73], v6 offset:0
v_accvgpr_write_b32 a232, v252
v_mfma_f32_16x16x32_bf16 v[244:247], a[56:59], a[80:83], v[244:247]
ds_read_b64_tr_b16 a[74:75], v6 offset:1024
v_accvgpr_write_b32 a233, v253
v_mfma_f32_16x16x32_bf16 v[244:247], a[60:63], a[84:87], v[244:247]
ds_read_b64_tr_b16 a[76:77], v6 offset:8192
v_accvgpr_write_b32 a234, v254
v_mfma_f32_16x16x32_bf16 v[236:239], a[52:55], a[84:87], v[236:239]
s_xor_b32 m0, s77, 134144
ds_read_b64_tr_b16 a[78:79], v6 offset:9216
v_accvgpr_write_b32 a235, v255
v_mfma_f32_16x16x32_bf16 v[236:239], a[48:51], a[80:83], v[236:239]
s_xor_b32 s64, s71, 1671168
v_mfma_f32_16x16x32_bf16 v[228:231], a[40:43], a[80:83], v[228:231]
buffer_load_dwordx4 v15, s[56:59], s64 offen lds
v_mfma_f32_16x16x32_bf16 v[228:231], a[44:47], a[84:87], v[228:231]
v_accvgpr_read_b32 v248, a140
v_accvgpr_read_b32 v249, a141
v_mfma_f32_16x16x32_bf16 v[220:223], a[36:39], a[84:87], v[220:223]
v_accvgpr_read_b32 v250, a142
v_accvgpr_read_b32 v251, a143
v_mfma_f32_16x16x32_bf16 v[220:223], a[32:35], a[80:83], v[220:223]
s_waitcnt lgkmcnt(4)
ds_read_b64_tr_b16 a[80:81], v7 offset:0
v_accvgpr_read_b32 v252, a136
v_mfma_f32_16x16x32_bf16 v[152:155], a[88:91], a[32:35], v[152:155]
ds_read_b64_tr_b16 a[82:83], v7 offset:1024
v_accvgpr_read_b32 v253, a137
v_mfma_f32_16x16x32_bf16 v[152:155], a[92:95], a[36:39], v[152:155]
ds_read_b64_tr_b16 a[84:85], v7 offset:8192
v_accvgpr_read_b32 v254, a138
v_mfma_f32_16x16x32_bf16 v[160:163], a[92:95], a[44:47], v[160:163]
ds_read_b64_tr_b16 a[86:87], v7 offset:9216
v_accvgpr_read_b32 v255, a139
v_mfma_f32_16x16x32_bf16 v[160:163], a[88:91], a[40:43], v[160:163]
v_cvt_pk_bf16_f32 v255, v254, v255
v_cvt_pk_bf16_f32 v254, v252, v253
v_mfma_f32_16x16x32_bf16 v[168:171], a[88:91], a[48:51], v[168:171]
v_cvt_pk_bf16_f32 v252, v248, v249
v_cvt_pk_bf16_f32 v253, v250, v251
v_mfma_f32_16x16x32_bf16 v[168:171], a[92:95], a[52:55], v[168:171]
v_accvgpr_write_b32 a236, v252
v_accvgpr_write_b32 a237, v253
v_mfma_f32_16x16x32_bf16 v[176:179], a[92:95], a[60:63], v[176:179]
s_xor_b32 m0, s84, 32768
v_accvgpr_write_b32 a238, v254
v_accvgpr_write_b32 a239, v255
v_mfma_f32_16x16x32_bf16 v[176:179], a[88:91], a[56:59], v[176:179]
s_xor_b32 s64, s72, 384
ds_read_b64_tr_b16 a[88:89], v8 offset:0
v_mfma_f32_16x16x32_bf16 v[180:183], a[96:99], a[56:59], v[180:183]
buffer_load_dwordx4 v12, s[48:51], s64 offen lds
v_mfma_f32_16x16x32_bf16 v[180:183], a[100:103], a[60:63], v[180:183]
ds_read_b64_tr_b16 a[90:91], v8 offset:1024
v_mfma_f32_16x16x32_bf16 v[172:175], a[100:103], a[52:55], v[172:175]
ds_read_b64_tr_b16 a[92:93], v8 offset:8192
v_mfma_f32_16x16x32_bf16 v[172:175], a[96:99], a[48:51], v[172:175]
s_xor_b32 m0, s84, 33792
ds_read_b64_tr_b16 a[94:95], v8 offset:9216
v_mfma_f32_16x16x32_bf16 v[164:167], a[96:99], a[40:43], v[164:167]
s_xor_b32 s64, s72, 16768
v_mfma_f32_16x16x32_bf16 v[164:167], a[100:103], a[44:47], v[164:167]
s_add_u32 s65, s79, 4096
buffer_load_dwordx4 v13, s[48:51], s64 offen lds
v_mfma_f32_16x16x32_bf16 v[156:159], a[100:103], a[36:39], v[156:159]
buffer_store_dwordx4 a[148:151], v16, s[44:47], s65 offen sc1
v_mfma_f32_16x16x32_bf16 v[156:159], a[96:99], a[32:35], v[156:159]
ds_read_b64_tr_b16 a[96:97], v9 offset:0
v_mfma_f32_16x16x32_bf16 v[24:27], a[104:107], a[32:35], v[24:27]
s_xor_b32 m0, s84, 34816
ds_read_b64_tr_b16 a[98:99], v9 offset:1024
v_mfma_f32_16x16x32_bf16 v[24:27], a[108:111], a[36:39], v[24:27]
s_xor_b32 s64, s72, 131456
ds_read_b64_tr_b16 a[100:101], v9 offset:8192
v_mfma_f32_16x16x32_bf16 v[40:43], a[108:111], a[44:47], v[40:43]
buffer_load_dwordx4 v12, s[48:51], s64 offen lds
v_mfma_f32_16x16x32_bf16 v[40:43], a[104:107], a[40:43], v[40:43]
ds_read_b64_tr_b16 a[102:103], v9 offset:9216
v_mfma_f32_16x16x32_bf16 v[56:59], a[104:107], a[48:51], v[56:59]
v_mfma_f32_16x16x32_bf16 v[56:59], a[108:111], a[52:55], v[56:59]
s_xor_b32 m0, s84, 35840
v_mfma_f32_16x16x32_bf16 v[72:75], a[108:111], a[60:63], v[72:75]
s_waitcnt vmcnt(15)
s_xor_b32 s64, s72, 147840
ds_read_b128 a[0:3], v2 offset:0
v_mfma_f32_16x16x32_bf16 v[72:75], a[104:107], a[56:59], v[72:75]
buffer_load_dwordx4 v13, s[48:51], s64 offen lds
v_mfma_f32_16x16x32_bf16 v[136:139], a[112:115], a[56:59], v[136:139]
ds_read_b128 a[4:7], v3 offset:0
v_mfma_f32_16x16x32_bf16 v[136:139], a[116:119], a[60:63], v[136:139]
ds_read_b128 a[8:11], v2 offset:2048
v_mfma_f32_16x16x32_bf16 v[120:123], a[116:119], a[52:55], v[120:123]
s_xor_b32 m0, s84, 36864
ds_read_b128 a[12:15], v3 offset:2048
v_mfma_f32_16x16x32_bf16 v[120:123], a[112:115], a[48:51], v[120:123]
s_xor_b32 s64, s73, 384
ds_read_b128 a[16:19], v2 offset:4096
v_mfma_f32_16x16x32_bf16 v[104:107], a[112:115], a[40:43], v[104:107]
buffer_load_dwordx4 v12, s[48:51], s64 offen lds
v_mfma_f32_16x16x32_bf16 v[104:107], a[116:119], a[44:47], v[104:107]
ds_read_b128 a[20:23], v3 offset:4096
v_mfma_f32_16x16x32_bf16 v[88:91], a[116:119], a[36:39], v[88:91]
ds_read_b128 a[24:27], v2 offset:6144
v_mfma_f32_16x16x32_bf16 v[88:91], a[112:115], a[32:35], v[88:91]
s_waitcnt lgkmcnt(7)
s_xor_b32 m0, s84, 37888
ds_read_b128 a[28:31], v3 offset:6144
v_mfma_f32_16x16x32_bf16 v[28:31], a[72:75], a[32:35], v[28:31]
s_xor_b32 s64, s73, 16768
ds_read_b64_tr_b16 a[104:105], v10 offset:0
v_mfma_f32_16x16x32_bf16 v[28:31], a[76:79], a[36:39], v[28:31]
buffer_load_dwordx4 v13, s[48:51], s64 offen lds
v_mfma_f32_16x16x32_bf16 v[44:47], a[76:79], a[44:47], v[44:47]
ds_read_b64_tr_b16 a[106:107], v10 offset:1024
v_mfma_f32_16x16x32_bf16 v[44:47], a[72:75], a[40:43], v[44:47]
ds_read_b64_tr_b16 a[108:109], v10 offset:8192
v_mfma_f32_16x16x32_bf16 v[60:63], a[72:75], a[48:51], v[60:63]
s_xor_b32 m0, s84, 38912
ds_read_b64_tr_b16 a[110:111], v10 offset:9216
v_mfma_f32_16x16x32_bf16 v[60:63], a[76:79], a[52:55], v[60:63]
s_xor_b32 s64, s73, 131456
ds_read_b64_tr_b16 a[112:113], v11 offset:0
v_mfma_f32_16x16x32_bf16 v[76:79], a[76:79], a[60:63], v[76:79]
buffer_load_dwordx4 v12, s[48:51], s64 offen lds
v_mfma_f32_16x16x32_bf16 v[76:79], a[72:75], a[56:59], v[76:79]
ds_read_b64_tr_b16 a[114:115], v11 offset:1024
v_mfma_f32_16x16x32_bf16 v[140:143], a[80:83], a[56:59], v[140:143]
ds_read_b64_tr_b16 a[116:117], v11 offset:8192
v_mfma_f32_16x16x32_bf16 v[140:143], a[84:87], a[60:63], v[140:143]
s_xor_b32 m0, s84, 39936
ds_read_b64_tr_b16 a[118:119], v11 offset:9216
v_mfma_f32_16x16x32_bf16 v[124:127], a[84:87], a[52:55], v[124:127]
s_xor_b32 s64, s73, 147840
v_mfma_f32_16x16x32_bf16 v[124:127], a[80:83], a[48:51], v[124:127]
buffer_load_dwordx4 v13, s[48:51], s64 offen lds
v_mfma_f32_16x16x32_bf16 v[108:111], a[80:83], a[40:43], v[108:111]
v_mfma_f32_16x16x32_bf16 v[108:111], a[84:87], a[44:47], v[108:111]
v_mfma_f32_16x16x32_bf16 v[92:95], a[84:87], a[36:39], v[92:95]
v_mfma_f32_16x16x32_bf16 v[92:95], a[80:83], a[32:35], v[92:95]
v_mfma_f32_16x16x32_bf16 v[32:35], a[88:91], a[32:35], v[32:35]
v_mfma_f32_16x16x32_bf16 v[32:35], a[92:95], a[36:39], v[32:35]
v_mfma_f32_16x16x32_bf16 v[48:51], a[92:95], a[44:47], v[48:51]
s_waitcnt lgkmcnt(0)
s_barrier
v_mfma_f32_16x16x32_bf16 v[48:51], a[88:91], a[40:43], v[48:51]
s_xor_b32 m0, s77, 65536
ds_read_b64_tr_b16 a[72:73], v19 offset:36864
v_mfma_f32_16x16x32_bf16 v[64:67], a[88:91], a[48:51], v[64:67]
s_xor_b32 s64, s71, 2097152
ds_read_b64_tr_b16 a[74:75], v19 offset:37120
v_mfma_f32_16x16x32_bf16 v[64:67], a[92:95], a[52:55], v[64:67]
buffer_load_dwordx4 v14, s[56:59], s64 offen lds
v_mfma_f32_16x16x32_bf16 v[80:83], a[92:95], a[60:63], v[80:83]
ds_read_b64_tr_b16 a[76:77], v19 offset:38912
v_mfma_f32_16x16x32_bf16 v[80:83], a[88:91], a[56:59], v[80:83]
ds_read_b64_tr_b16 a[78:79], v19 offset:39168
v_mfma_f32_16x16x32_bf16 v[144:147], a[96:99], a[56:59], v[144:147]
ds_read_b64_tr_b16 a[80:81], v20 offset:36864
v_mfma_f32_16x16x32_bf16 v[144:147], a[100:103], a[60:63], v[144:147]
ds_read_b64_tr_b16 a[82:83], v20 offset:37120
v_mfma_f32_16x16x32_bf16 v[128:131], a[100:103], a[52:55], v[128:131]
ds_read_b64_tr_b16 a[84:85], v20 offset:38912
v_mfma_f32_16x16x32_bf16 v[128:131], a[96:99], a[48:51], v[128:131]
ds_read_b64_tr_b16 a[86:87], v20 offset:39168
v_mfma_f32_16x16x32_bf16 v[112:115], a[96:99], a[40:43], v[112:115]
s_add_u32 m0, s78, 81920
ds_read_b64_tr_b16 a[88:89], v19 offset:40960
v_mfma_f32_16x16x32_bf16 v[112:115], a[100:103], a[44:47], v[112:115]
s_add_u32 s64, s75, 1572864
ds_read_b64_tr_b16 a[90:91], v19 offset:41216
v_mfma_f32_16x16x32_bf16 v[96:99], a[100:103], a[36:39], v[96:99]
s_add_u32 s65, s79, 0
buffer_load_dwordx4 v23, s[60:63], s64 offen lds
v_mfma_f32_16x16x32_bf16 v[96:99], a[96:99], a[32:35], v[96:99]
buffer_store_dwordx4 a[152:155], v16, s[44:47], s65 offen sc1
v_mfma_f32_16x16x32_bf16 v[36:39], a[104:107], a[32:35], v[36:39]
ds_read_b64_tr_b16 a[92:93], v19 offset:43008
v_mfma_f32_16x16x32_bf16 v[36:39], a[108:111], a[36:39], v[36:39]
ds_read_b64_tr_b16 a[94:95], v19 offset:43264
v_mfma_f32_16x16x32_bf16 v[52:55], a[108:111], a[44:47], v[52:55]
ds_read_b64_tr_b16 a[96:97], v20 offset:40960
v_mfma_f32_16x16x32_bf16 v[52:55], a[104:107], a[40:43], v[52:55]
ds_read_b64_tr_b16 a[98:99], v20 offset:41216
v_mfma_f32_16x16x32_bf16 v[68:71], a[104:107], a[48:51], v[68:71]
s_xor_b32 m0, s77, 66560
ds_read_b64_tr_b16 a[100:101], v20 offset:43008
v_mfma_f32_16x16x32_bf16 v[68:71], a[108:111], a[52:55], v[68:71]
s_xor_b32 s64, s71, 2129920
s_xor_b32 s68, s66, 4096
ds_read_b64_tr_b16 a[102:103], v20 offset:43264
v_mfma_f32_16x16x32_bf16 v[84:87], a[108:111], a[60:63], v[84:87]
s_mov_b64 exec, 1
buffer_atomic_add a251, v1, s[52:55], s68 offen offset:0 sc1
s_mov_b64 exec, -1
v_mfma_f32_16x16x32_bf16 v[84:87], a[104:107], a[56:59], v[84:87]
buffer_load_dwordx4 v14, s[56:59], s64 offen lds
v_mfma_f32_16x16x32_bf16 v[148:151], a[112:115], a[56:59], v[148:151]
ds_read_b64_tr_b16 a[104:105], v19 offset:32768
v_mfma_f32_16x16x32_bf16 v[148:151], a[116:119], a[60:63], v[148:151]
ds_read_b64_tr_b16 a[106:107], v19 offset:33024
v_mfma_f32_16x16x32_bf16 v[132:135], a[116:119], a[52:55], v[132:135]
ds_read_b64_tr_b16 a[108:109], v19 offset:34816
v_mfma_f32_16x16x32_bf16 v[132:135], a[112:115], a[48:51], v[132:135]
ds_read_b64_tr_b16 a[110:111], v19 offset:35072
v_mfma_f32_16x16x32_bf16 v[116:119], a[112:115], a[40:43], v[116:119]
v_mfma_f32_16x16x32_bf16 v[116:119], a[116:119], a[44:47], v[116:119]
v_mfma_f32_16x16x32_bf16 v[100:103], a[116:119], a[36:39], v[100:103]
s_add_u32 m0, s78, 86016
v_mfma_f32_16x16x32_bf16 v[100:103], a[112:115], a[32:35], v[100:103]
s_waitcnt lgkmcnt(4)
s_add_u32 s64, s75, 1574912
ds_read_b64_tr_b16 a[112:113], v20 offset:32768
v_mfma_f32_16x16x32_bf16 v[184:187], a[72:75], a[0:3], v[184:187]
buffer_load_dwordx4 v23, s[60:63], s64 offen lds
v_mfma_f32_16x16x32_bf16 v[184:187], a[76:79], a[4:7], v[184:187]
ds_read_b64_tr_b16 a[114:115], v20 offset:33024
v_mfma_f32_16x16x32_bf16 v[192:195], a[76:79], a[12:15], v[192:195]
ds_read_b64_tr_b16 a[116:117], v20 offset:34816
v_mfma_f32_16x16x32_bf16 v[192:195], a[72:75], a[8:11], v[192:195]
s_add_u32 s17, s78, .-L_pc+6144
ds_read_b64_tr_b16 a[118:119], v20 offset:35072
v_mfma_f32_16x16x32_bf16 v[200:203], a[72:75], a[16:19], v[200:203]
buffer_load_dword a252, v16, s[88:91], s17 offen
v_mfma_f32_16x16x32_bf16 v[200:203], a[76:79], a[20:23], v[200:203]
v_mfma_f32_16x16x32_bf16 v[208:211], a[76:79], a[28:31], v[208:211]
v_mfma_f32_16x16x32_bf16 v[208:211], a[72:75], a[24:27], v[208:211]
ds_read_b64_tr_b16 a[72:73], v4 offset:32768
v_mfma_f32_16x16x32_bf16 v[212:215], a[80:83], a[24:27], v[212:215]
s_xor_b32 m0, s77, 67584
ds_read_b64_tr_b16 a[74:75], v4 offset:33792
v_mfma_f32_16x16x32_bf16 v[212:215], a[84:87], a[28:31], v[212:215]
s_xor_b32 s64, s71, 2162688
ds_read_b64_tr_b16 a[76:77], v4 offset:40960
v_mfma_f32_16x16x32_bf16 v[204:207], a[84:87], a[20:23], v[204:207]
buffer_load_dwordx4 v15, s[56:59], s64 offen lds
v_mfma_f32_16x16x32_bf16 v[204:207], a[80:83], a[16:19], v[204:207]
ds_read_b64_tr_b16 a[78:79], v4 offset:41984
v_mfma_f32_16x16x32_bf16 v[196:199], a[80:83], a[8:11], v[196:199]
v_mfma_f32_16x16x32_bf16 v[196:199], a[84:87], a[12:15], v[196:199]
v_mfma_f32_16x16x32_bf16 v[188:191], a[84:87], a[4:7], v[188:191]
v_mfma_f32_16x16x32_bf16 v[188:191], a[80:83], a[0:3], v[188:191]
ds_read_b64_tr_b16 a[80:81], v5 offset:32768
v_mfma_f32_16x16x32_bf16 v[216:219], a[0:3], a[88:91], v[216:219]
ds_read_b64_tr_b16 a[82:83], v5 offset:33792
v_mfma_f32_16x16x32_bf16 v[216:219], a[4:7], a[92:95], v[216:219]
s_add_u32 m0, s78, 90112
ds_read_b64_tr_b16 a[84:85], v5 offset:40960
v_mfma_f32_16x16x32_bf16 v[224:227], a[12:15], a[92:95], v[224:227]
s_add_u32 s64, s75, 1576960
ds_read_b64_tr_b16 a[86:87], v5 offset:41984
v_mfma_f32_16x16x32_bf16 v[224:227], a[8:11], a[88:91], v[224:227]
buffer_load_dwordx4 v23, s[60:63], s64 offen lds
v_mfma_f32_16x16x32_bf16 v[232:235], a[16:19], a[88:91], v[232:235]
v_mfma_f32_16x16x32_bf16 v[232:235], a[20:23], a[92:95], v[232:235]
v_mfma_f32_16x16x32_bf16 v[240:243], a[28:31], a[92:95], v[240:243]
v_mfma_f32_16x16x32_bf16 v[240:243], a[24:27], a[88:91], v[240:243]
ds_read_b64_tr_b16 a[88:89], v6 offset:32768
v_mfma_f32_16x16x32_bf16 v[244:247], a[24:27], a[96:99], v[244:247]
ds_read_b64_tr_b16 a[90:91], v6 offset:33792
v_mfma_f32_16x16x32_bf16 v[244:247], a[28:31], a[100:103], v[244:247]
ds_read_b64_tr_b16 a[92:93], v6 offset:40960
v_add_u32 v19, 0x8000, v19
v_mfma_f32_16x16x32_bf16 v[236:239], a[20:23], a[100:103], v[236:239]
s_xor_b32 m0, s77, 68608
ds_read_b64_tr_b16 a[94:95], v6 offset:41984
v_mfma_f32_16x16x32_bf16 v[236:239], a[16:19], a[96:99], v[236:239]
s_xor_b32 s64, s71, 2195456
v_mfma_f32_16x16x32_bf16 v[228:231], a[8:11], a[96:99], v[228:231]
buffer_load_dwordx4 v15, s[56:59], s64 offen lds
v_mfma_f32_16x16x32_bf16 v[228:231], a[12:15], a[100:103], v[228:231]
v_mfma_f32_16x16x32_bf16 v[220:223], a[4:7], a[100:103], v[220:223]
v_mfma_f32_16x16x32_bf16 v[220:223], a[0:3], a[96:99], v[220:223]
s_waitcnt lgkmcnt(4)
s_add_u32 s65, s79, 17408
ds_read_b64_tr_b16 a[96:97], v7 offset:32768
v_mfma_f32_16x16x32_bf16 v[152:155], a[104:107], a[0:3], v[152:155]
buffer_store_dwordx4 a[156:159], v16, s[44:47], s65 offen sc1
v_mfma_f32_16x16x32_bf16 v[152:155], a[108:111], a[4:7], v[152:155]
ds_read_b64_tr_b16 a[98:99], v7 offset:33792
v_add_u32 v20, 0x8000, v20
v_mfma_f32_16x16x32_bf16 v[160:163], a[108:111], a[12:15], v[160:163]
ds_read_b64_tr_b16 a[100:101], v7 offset:40960
v_mfma_f32_16x16x32_bf16 v[160:163], a[104:107], a[8:11], v[160:163]
ds_read_b64_tr_b16 a[102:103], v7 offset:41984
v_mfma_f32_16x16x32_bf16 v[168:171], a[104:107], a[16:19], v[168:171]
v_mfma_f32_16x16x32_bf16 v[168:171], a[108:111], a[20:23], v[168:171]
v_mfma_f32_16x16x32_bf16 v[176:179], a[108:111], a[28:31], v[176:179]
s_xor_b32 m0, s84, 0
v_mfma_f32_16x16x32_bf16 v[176:179], a[104:107], a[24:27], v[176:179]
s_xor_b32 s64, s72, 512
ds_read_b64_tr_b16 a[104:105], v8 offset:32768
v_mfma_f32_16x16x32_bf16 v[180:183], a[112:115], a[24:27], v[180:183]
buffer_load_dwordx4 v12, s[48:51], s64 offen lds
v_mfma_f32_16x16x32_bf16 v[180:183], a[116:119], a[28:31], v[180:183]
ds_read_b64_tr_b16 a[106:107], v8 offset:33792
v_add_u32 v4, 0x8000, v4
v_mfma_f32_16x16x32_bf16 v[172:175], a[116:119], a[20:23], v[172:175]
ds_read_b64_tr_b16 a[108:109], v8 offset:40960
v_mfma_f32_16x16x32_bf16 v[172:175], a[112:115], a[16:19], v[172:175]
s_xor_b32 m0, s84, 1024
ds_read_b64_tr_b16 a[110:111], v8 offset:41984
v_mfma_f32_16x16x32_bf16 v[164:167], a[112:115], a[8:11], v[164:167]
s_xor_b32 s64, s72, 16896
v_mfma_f32_16x16x32_bf16 v[164:167], a[116:119], a[12:15], v[164:167]
buffer_load_dwordx4 v13, s[48:51], s64 offen lds
v_mfma_f32_16x16x32_bf16 v[156:159], a[116:119], a[4:7], v[156:159]
v_mfma_f32_16x16x32_bf16 v[156:159], a[112:115], a[0:3], v[156:159]
ds_read_b64_tr_b16 a[112:113], v9 offset:32768
v_mfma_f32_16x16x32_bf16 v[24:27], a[72:75], a[0:3], v[24:27]
s_xor_b32 m0, s84, 2048
ds_read_b64_tr_b16 a[114:115], v9 offset:33792
v_mfma_f32_16x16x32_bf16 v[24:27], a[76:79], a[4:7], v[24:27]
s_xor_b32 s64, s72, 131584
ds_read_b64_tr_b16 a[116:117], v9 offset:40960
v_add_u32 v5, 0x8000, v5
v_mfma_f32_16x16x32_bf16 v[40:43], a[76:79], a[12:15], v[40:43]
buffer_load_dwordx4 v12, s[48:51], s64 offen lds
v_mfma_f32_16x16x32_bf16 v[40:43], a[72:75], a[8:11], v[40:43]
ds_read_b64_tr_b16 a[118:119], v9 offset:41984
v_mfma_f32_16x16x32_bf16 v[56:59], a[72:75], a[16:19], v[56:59]
v_mfma_f32_16x16x32_bf16 v[56:59], a[76:79], a[20:23], v[56:59]
s_xor_b32 m0, s84, 3072
v_mfma_f32_16x16x32_bf16 v[72:75], a[76:79], a[28:31], v[72:75]
s_waitcnt vmcnt(14)
s_xor_b32 s64, s72, 147968
ds_read_b128 a[32:35], v2 offset:32768
v_mfma_f32_16x16x32_bf16 v[72:75], a[72:75], a[24:27], v[72:75]
buffer_load_dwordx4 v13, s[48:51], s64 offen lds
v_mfma_f32_16x16x32_bf16 v[136:139], a[80:83], a[24:27], v[136:139]
ds_read_b128 a[36:39], v3 offset:32768
v_mfma_f32_16x16x32_bf16 v[136:139], a[84:87], a[28:31], v[136:139]
ds_read_b128 a[40:43], v2 offset:34816
v_add_u32 v6, 0x8000, v6
v_mfma_f32_16x16x32_bf16 v[120:123], a[84:87], a[20:23], v[120:123]
s_xor_b32 m0, s84, 4096
ds_read_b128 a[44:47], v3 offset:34816
v_mfma_f32_16x16x32_bf16 v[120:123], a[80:83], a[16:19], v[120:123]
s_xor_b32 s64, s73, 512
ds_read_b128 a[48:51], v2 offset:36864
v_mfma_f32_16x16x32_bf16 v[104:107], a[80:83], a[8:11], v[104:107]
buffer_load_dwordx4 v12, s[48:51], s64 offen lds
v_mfma_f32_16x16x32_bf16 v[104:107], a[84:87], a[12:15], v[104:107]
ds_read_b128 a[52:55], v3 offset:36864
v_mfma_f32_16x16x32_bf16 v[88:91], a[84:87], a[4:7], v[88:91]
ds_read_b128 a[56:59], v2 offset:38912
v_mfma_f32_16x16x32_bf16 v[88:91], a[80:83], a[0:3], v[88:91]
s_waitcnt lgkmcnt(7)
s_xor_b32 m0, s84, 5120
ds_read_b128 a[60:63], v3 offset:38912
v_mfma_f32_16x16x32_bf16 v[28:31], a[88:91], a[0:3], v[28:31]
s_xor_b32 s64, s73, 16896
ds_read_b64_tr_b16 a[72:73], v10 offset:32768
v_mfma_f32_16x16x32_bf16 v[28:31], a[92:95], a[4:7], v[28:31]
buffer_load_dwordx4 v13, s[48:51], s64 offen lds
v_mfma_f32_16x16x32_bf16 v[44:47], a[92:95], a[12:15], v[44:47]
ds_read_b64_tr_b16 a[74:75], v10 offset:33792
v_add_u32 v7, 0x8000, v7
v_mfma_f32_16x16x32_bf16 v[44:47], a[88:91], a[8:11], v[44:47]
ds_read_b64_tr_b16 a[76:77], v10 offset:40960
v_mfma_f32_16x16x32_bf16 v[60:63], a[88:91], a[16:19], v[60:63]
s_xor_b32 m0, s84, 6144
ds_read_b64_tr_b16 a[78:79], v10 offset:41984
v_mfma_f32_16x16x32_bf16 v[60:63], a[92:95], a[20:23], v[60:63]
s_xor_b32 s64, s73, 131584
ds_read_b64_tr_b16 a[80:81], v11 offset:32768
v_mfma_f32_16x16x32_bf16 v[76:79], a[92:95], a[28:31], v[76:79]
buffer_load_dwordx4 v12, s[48:51], s64 offen lds
v_mfma_f32_16x16x32_bf16 v[76:79], a[88:91], a[24:27], v[76:79]
ds_read_b64_tr_b16 a[82:83], v11 offset:33792
v_mfma_f32_16x16x32_bf16 v[140:143], a[96:99], a[24:27], v[140:143]
ds_read_b64_tr_b16 a[84:85], v11 offset:40960
v_mfma_f32_16x16x32_bf16 v[140:143], a[100:103], a[28:31], v[140:143]
s_xor_b32 m0, s84, 7168
ds_read_b64_tr_b16 a[86:87], v11 offset:41984
v_add_u32 v8, 0x8000, v8
v_mfma_f32_16x16x32_bf16 v[124:127], a[100:103], a[20:23], v[124:127]
s_xor_b32 s64, s73, 147968
v_mfma_f32_16x16x32_bf16 v[124:127], a[96:99], a[16:19], v[124:127]
buffer_load_dwordx4 v13, s[48:51], s64 offen lds
v_mfma_f32_16x16x32_bf16 v[108:111], a[96:99], a[8:11], v[108:111]
v_mfma_f32_16x16x32_bf16 v[108:111], a[100:103], a[12:15], v[108:111]
v_mfma_f32_16x16x32_bf16 v[92:95], a[100:103], a[4:7], v[92:95]
v_add_u32 v9, 0x8000, v9
v_add_u32 v10, 0x8000, v10
v_mfma_f32_16x16x32_bf16 v[92:95], a[96:99], a[0:3], v[92:95]
v_add_u32 v11, 0x8000, v11
v_mfma_f32_16x16x32_bf16 v[32:35], a[104:107], a[0:3], v[32:35]
s_add_u32 s65, s79, 5120
v_mfma_f32_16x16x32_bf16 v[32:35], a[108:111], a[4:7], v[32:35]
buffer_store_dwordx4 a[160:163], v16, s[44:47], s65 offen sc1
v_mfma_f32_16x16x32_bf16 v[48:51], a[108:111], a[12:15], v[48:51]
s_waitcnt lgkmcnt(0)
s_barrier
v_mfma_f32_16x16x32_bf16 v[48:51], a[104:107], a[8:11], v[48:51]
s_xor_b32 m0, s77, 98304
ds_read_b64_tr_b16 a[88:89], v19 offset:36864
v_mfma_f32_16x16x32_bf16 v[64:67], a[104:107], a[16:19], v[64:67]
s_xor_b32 s64, s71, 2621440
ds_read_b64_tr_b16 a[90:91], v19 offset:37120
v_mfma_f32_16x16x32_bf16 v[64:67], a[108:111], a[20:23], v[64:67]
buffer_load_dwordx4 v14, s[56:59], s64 offen lds
v_mfma_f32_16x16x32_bf16 v[80:83], a[108:111], a[28:31], v[80:83]
ds_read_b64_tr_b16 a[92:93], v19 offset:38912
v_mfma_f32_16x16x32_bf16 v[80:83], a[104:107], a[24:27], v[80:83]
ds_read_b64_tr_b16 a[94:95], v19 offset:39168
v_mfma_f32_16x16x32_bf16 v[144:147], a[112:115], a[24:27], v[144:147]
ds_read_b64_tr_b16 a[96:97], v20 offset:36864
v_mfma_f32_16x16x32_bf16 v[144:147], a[116:119], a[28:31], v[144:147]
ds_read_b64_tr_b16 a[98:99], v20 offset:37120
v_mfma_f32_16x16x32_bf16 v[128:131], a[116:119], a[20:23], v[128:131]
ds_read_b64_tr_b16 a[100:101], v20 offset:38912
v_mfma_f32_16x16x32_bf16 v[128:131], a[112:115], a[16:19], v[128:131]
ds_read_b64_tr_b16 a[102:103], v20 offset:39168
v_mfma_f32_16x16x32_bf16 v[112:115], a[112:115], a[8:11], v[112:115]
s_add_u32 m0, s78, 114688
ds_read_b64_tr_b16 a[104:105], v19 offset:40960
v_mfma_f32_16x16x32_bf16 v[112:115], a[116:119], a[12:15], v[112:115]
s_add_u32 s64, s75, 1966080
ds_read_b64_tr_b16 a[106:107], v19 offset:41216
v_mfma_f32_16x16x32_bf16 v[96:99], a[116:119], a[4:7], v[96:99]
buffer_load_dwordx4 v23, s[60:63], s64 offen lds
v_mfma_f32_16x16x32_bf16 v[96:99], a[112:115], a[0:3], v[96:99]
ds_read_b64_tr_b16 a[108:109], v19 offset:43008
v_mfma_f32_16x16x32_bf16 v[36:39], a[72:75], a[0:3], v[36:39]
ds_read_b64_tr_b16 a[110:111], v19 offset:43264
v_mfma_f32_16x16x32_bf16 v[36:39], a[76:79], a[4:7], v[36:39]
ds_read_b64_tr_b16 a[112:113], v20 offset:40960
v_mfma_f32_16x16x32_bf16 v[52:55], a[76:79], a[12:15], v[52:55]
ds_read_b64_tr_b16 a[114:115], v20 offset:41216
v_mfma_f32_16x16x32_bf16 v[52:55], a[72:75], a[8:11], v[52:55]
ds_read_b64_tr_b16 a[116:117], v20 offset:43008
v_mfma_f32_16x16x32_bf16 v[68:71], a[72:75], a[16:19], v[68:71]
s_xor_b32 m0, s77, 99328
ds_read_b64_tr_b16 a[118:119], v20 offset:43264
v_mfma_f32_16x16x32_bf16 v[68:71], a[76:79], a[20:23], v[68:71]
s_xor_b32 s64, s71, 2654208
s_xor_b32 s68, s66, 8192
v_mfma_f32_16x16x32_bf16 v[84:87], a[76:79], a[28:31], v[84:87]
s_mov_b64 exec, 1
buffer_atomic_add a251, v1, s[52:55], s68 offen offset:0 sc1
s_mov_b64 exec, -1
v_mfma_f32_16x16x32_bf16 v[84:87], a[72:75], a[24:27], v[84:87]
buffer_load_dwordx4 v14, s[56:59], s64 offen lds
v_mfma_f32_16x16x32_bf16 v[148:151], a[80:83], a[24:27], v[148:151]
ds_read_b64_tr_b16 a[72:73], v19 offset:32768
v_mfma_f32_16x16x32_bf16 v[148:151], a[84:87], a[28:31], v[148:151]
ds_read_b64_tr_b16 a[74:75], v19 offset:33024
v_mfma_f32_16x16x32_bf16 v[132:135], a[84:87], a[20:23], v[132:135]
ds_read_b64_tr_b16 a[76:77], v19 offset:34816
v_mfma_f32_16x16x32_bf16 v[132:135], a[80:83], a[16:19], v[132:135]
ds_read_b64_tr_b16 a[78:79], v19 offset:35072
v_mfma_f32_16x16x32_bf16 v[116:119], a[80:83], a[8:11], v[116:119]
v_mfma_f32_16x16x32_bf16 v[116:119], a[84:87], a[12:15], v[116:119]
v_mfma_f32_16x16x32_bf16 v[100:103], a[84:87], a[4:7], v[100:103]
s_add_u32 m0, s78, 118784
v_mfma_f32_16x16x32_bf16 v[100:103], a[80:83], a[0:3], v[100:103]
s_waitcnt lgkmcnt(4)
s_add_u32 s64, s75, 1968128
ds_read_b64_tr_b16 a[80:81], v20 offset:32768
v_mfma_f32_16x16x32_bf16 v[184:187], a[88:91], a[32:35], v[184:187]
buffer_load_dwordx4 v23, s[60:63], s64 offen lds
v_mfma_f32_16x16x32_bf16 v[184:187], a[92:95], a[36:39], v[184:187]
ds_read_b64_tr_b16 a[82:83], v20 offset:33024
v_mfma_f32_16x16x32_bf16 v[192:195], a[92:95], a[44:47], v[192:195]
ds_read_b64_tr_b16 a[84:85], v20 offset:34816
v_mfma_f32_16x16x32_bf16 v[192:195], a[88:91], a[40:43], v[192:195]
ds_read_b64_tr_b16 a[86:87], v20 offset:35072
v_mfma_f32_16x16x32_bf16 v[200:203], a[88:91], a[48:51], v[200:203]
v_mfma_f32_16x16x32_bf16 v[200:203], a[92:95], a[52:55], v[200:203]
v_mfma_f32_16x16x32_bf16 v[208:211], a[92:95], a[60:63], v[208:211]
v_mfma_f32_16x16x32_bf16 v[208:211], a[88:91], a[56:59], v[208:211]
ds_read_b64_tr_b16 a[88:89], v4 offset:32768
v_mfma_f32_16x16x32_bf16 v[212:215], a[96:99], a[56:59], v[212:215]
s_xor_b32 m0, s77, 100352
ds_read_b64_tr_b16 a[90:91], v4 offset:33792
v_mfma_f32_16x16x32_bf16 v[212:215], a[100:103], a[60:63], v[212:215]
s_xor_b32 s64, s71, 2686976
ds_read_b64_tr_b16 a[92:93], v4 offset:40960
v_mfma_f32_16x16x32_bf16 v[204:207], a[100:103], a[52:55], v[204:207]
buffer_load_dwordx4 v15, s[56:59], s64 offen lds
v_mfma_f32_16x16x32_bf16 v[204:207], a[96:99], a[48:51], v[204:207]
ds_read_b64_tr_b16 a[94:95], v4 offset:41984
v_mfma_f32_16x16x32_bf16 v[196:199], a[96:99], a[40:43], v[196:199]
v_mfma_f32_16x16x32_bf16 v[196:199], a[100:103], a[44:47], v[196:199]
v_mfma_f32_16x16x32_bf16 v[188:191], a[100:103], a[36:39], v[188:191]
v_mfma_f32_16x16x32_bf16 v[188:191], a[96:99], a[32:35], v[188:191]
ds_read_b64_tr_b16 a[96:97], v5 offset:32768
v_mfma_f32_16x16x32_bf16 v[216:219], a[32:35], a[104:107], v[216:219]
ds_read_b64_tr_b16 a[98:99], v5 offset:33792
v_mfma_f32_16x16x32_bf16 v[216:219], a[36:39], a[108:111], v[216:219]
s_add_u32 m0, s78, 122880
ds_read_b64_tr_b16 a[100:101], v5 offset:40960
v_mfma_f32_16x16x32_bf16 v[224:227], a[44:47], a[108:111], v[224:227]
s_add_u32 s64, s75, 1970176
ds_read_b64_tr_b16 a[102:103], v5 offset:41984
v_mfma_f32_16x16x32_bf16 v[224:227], a[40:43], a[104:107], v[224:227]
s_add_u32 s65, s79, 1024
buffer_load_dwordx4 v23, s[60:63], s64 offen lds
v_mfma_f32_16x16x32_bf16 v[232:235], a[48:51], a[104:107], v[232:235]
buffer_store_dwordx4 a[164:167], v16, s[44:47], s65 offen sc1
v_mfma_f32_16x16x32_bf16 v[232:235], a[52:55], a[108:111], v[232:235]
v_mfma_f32_16x16x32_bf16 v[240:243], a[60:63], a[108:111], v[240:243]
v_mfma_f32_16x16x32_bf16 v[240:243], a[56:59], a[104:107], v[240:243]
ds_read_b64_tr_b16 a[104:105], v6 offset:32768
v_mfma_f32_16x16x32_bf16 v[244:247], a[56:59], a[112:115], v[244:247]
ds_read_b64_tr_b16 a[106:107], v6 offset:33792
v_mfma_f32_16x16x32_bf16 v[244:247], a[60:63], a[116:119], v[244:247]
ds_read_b64_tr_b16 a[108:109], v6 offset:40960
v_subrev_u32 v19, 0x8000, v19
v_mfma_f32_16x16x32_bf16 v[236:239], a[52:55], a[116:119], v[236:239]
s_xor_b32 m0, s77, 101376
ds_read_b64_tr_b16 a[110:111], v6 offset:41984
v_mfma_f32_16x16x32_bf16 v[236:239], a[48:51], a[112:115], v[236:239]
s_xor_b32 s64, s71, 2719744
v_mfma_f32_16x16x32_bf16 v[228:231], a[40:43], a[112:115], v[228:231]
buffer_load_dwordx4 v15, s[56:59], s64 offen lds
v_mfma_f32_16x16x32_bf16 v[228:231], a[44:47], a[116:119], v[228:231]
v_mfma_f32_16x16x32_bf16 v[220:223], a[36:39], a[116:119], v[220:223]
v_mfma_f32_16x16x32_bf16 v[220:223], a[32:35], a[112:115], v[220:223]
s_waitcnt lgkmcnt(4)
ds_read_b64_tr_b16 a[112:113], v7 offset:32768
v_mfma_f32_16x16x32_bf16 v[152:155], a[72:75], a[32:35], v[152:155]
ds_read_b64_tr_b16 a[114:115], v7 offset:33792
v_mfma_f32_16x16x32_bf16 v[152:155], a[76:79], a[36:39], v[152:155]
ds_read_b64_tr_b16 a[116:117], v7 offset:40960
v_subrev_u32 v20, 0x8000, v20
v_mfma_f32_16x16x32_bf16 v[160:163], a[76:79], a[44:47], v[160:163]
ds_read_b64_tr_b16 a[118:119], v7 offset:41984
v_mfma_f32_16x16x32_bf16 v[160:163], a[72:75], a[40:43], v[160:163]
v_mfma_f32_16x16x32_bf16 v[168:171], a[72:75], a[48:51], v[168:171]
v_mfma_f32_16x16x32_bf16 v[168:171], a[76:79], a[52:55], v[168:171]
v_mfma_f32_16x16x32_bf16 v[176:179], a[76:79], a[60:63], v[176:179]
s_xor_b32 m0, s84, 32768
v_mfma_f32_16x16x32_bf16 v[176:179], a[72:75], a[56:59], v[176:179]
s_xor_b32 s64, s72, 640
ds_read_b64_tr_b16 a[72:73], v8 offset:32768
v_mfma_f32_16x16x32_bf16 v[180:183], a[80:83], a[56:59], v[180:183]
buffer_load_dwordx4 v12, s[48:51], s64 offen lds
v_mfma_f32_16x16x32_bf16 v[180:183], a[84:87], a[60:63], v[180:183]
ds_read_b64_tr_b16 a[74:75], v8 offset:33792
v_subrev_u32 v4, 0x8000, v4
v_mfma_f32_16x16x32_bf16 v[172:175], a[84:87], a[52:55], v[172:175]
ds_read_b64_tr_b16 a[76:77], v8 offset:40960
v_mfma_f32_16x16x32_bf16 v[172:175], a[80:83], a[48:51], v[172:175]
s_xor_b32 m0, s84, 33792
ds_read_b64_tr_b16 a[78:79], v8 offset:41984
v_mfma_f32_16x16x32_bf16 v[164:167], a[80:83], a[40:43], v[164:167]
s_xor_b32 s64, s72, 17024
v_mfma_f32_16x16x32_bf16 v[164:167], a[84:87], a[44:47], v[164:167]
buffer_load_dwordx4 v13, s[48:51], s64 offen lds
v_mfma_f32_16x16x32_bf16 v[156:159], a[84:87], a[36:39], v[156:159]
v_mfma_f32_16x16x32_bf16 v[156:159], a[80:83], a[32:35], v[156:159]
ds_read_b64_tr_b16 a[80:81], v9 offset:32768
v_mfma_f32_16x16x32_bf16 v[24:27], a[88:91], a[32:35], v[24:27]
s_xor_b32 m0, s84, 34816
ds_read_b64_tr_b16 a[82:83], v9 offset:33792
v_mfma_f32_16x16x32_bf16 v[24:27], a[92:95], a[36:39], v[24:27]
s_xor_b32 s64, s72, 131712
ds_read_b64_tr_b16 a[84:85], v9 offset:40960
v_subrev_u32 v5, 0x8000, v5
v_mfma_f32_16x16x32_bf16 v[40:43], a[92:95], a[44:47], v[40:43]
buffer_load_dwordx4 v12, s[48:51], s64 offen lds
v_mfma_f32_16x16x32_bf16 v[40:43], a[88:91], a[40:43], v[40:43]
ds_read_b64_tr_b16 a[86:87], v9 offset:41984
v_mfma_f32_16x16x32_bf16 v[56:59], a[88:91], a[48:51], v[56:59]
v_mfma_f32_16x16x32_bf16 v[56:59], a[92:95], a[52:55], v[56:59]
s_xor_b32 m0, s84, 35840
v_mfma_f32_16x16x32_bf16 v[72:75], a[92:95], a[60:63], v[72:75]
s_waitcnt vmcnt(13)
s_xor_b32 s64, s72, 148096
ds_read_b128 a[0:3], v2 offset:0
v_mfma_f32_16x16x32_bf16 v[72:75], a[88:91], a[56:59], v[72:75]
buffer_load_dwordx4 v13, s[48:51], s64 offen lds
v_mfma_f32_16x16x32_bf16 v[136:139], a[96:99], a[56:59], v[136:139]
ds_read_b128 a[4:7], v3 offset:0
v_mfma_f32_16x16x32_bf16 v[136:139], a[100:103], a[60:63], v[136:139]
ds_read_b128 a[8:11], v2 offset:2048
v_subrev_u32 v6, 0x8000, v6
v_mfma_f32_16x16x32_bf16 v[120:123], a[100:103], a[52:55], v[120:123]
s_xor_b32 m0, s84, 36864
ds_read_b128 a[12:15], v3 offset:2048
v_mfma_f32_16x16x32_bf16 v[120:123], a[96:99], a[48:51], v[120:123]
s_xor_b32 s64, s73, 640
ds_read_b128 a[16:19], v2 offset:4096
v_mfma_f32_16x16x32_bf16 v[104:107], a[96:99], a[40:43], v[104:107]
buffer_load_dwordx4 v12, s[48:51], s64 offen lds
v_mfma_f32_16x16x32_bf16 v[104:107], a[100:103], a[44:47], v[104:107]
ds_read_b128 a[20:23], v3 offset:4096
v_mfma_f32_16x16x32_bf16 v[88:91], a[100:103], a[36:39], v[88:91]
ds_read_b128 a[24:27], v2 offset:6144
v_mfma_f32_16x16x32_bf16 v[88:91], a[96:99], a[32:35], v[88:91]
s_waitcnt lgkmcnt(7)
s_xor_b32 m0, s84, 37888
ds_read_b128 a[28:31], v3 offset:6144
v_mfma_f32_16x16x32_bf16 v[28:31], a[104:107], a[32:35], v[28:31]
s_xor_b32 s64, s73, 17024
ds_read_b64_tr_b16 a[88:89], v10 offset:32768
v_mfma_f32_16x16x32_bf16 v[28:31], a[108:111], a[36:39], v[28:31]
buffer_load_dwordx4 v13, s[48:51], s64 offen lds
v_mfma_f32_16x16x32_bf16 v[44:47], a[108:111], a[44:47], v[44:47]
ds_read_b64_tr_b16 a[90:91], v10 offset:33792
v_subrev_u32 v7, 0x8000, v7
v_mfma_f32_16x16x32_bf16 v[44:47], a[104:107], a[40:43], v[44:47]
s_add_u32 s65, s79, 18432
ds_read_b64_tr_b16 a[92:93], v10 offset:40960
v_mfma_f32_16x16x32_bf16 v[60:63], a[104:107], a[48:51], v[60:63]
s_xor_b32 m0, s84, 38912
buffer_store_dwordx4 a[168:171], v16, s[44:47], s65 offen sc1
v_mfma_f32_16x16x32_bf16 v[60:63], a[108:111], a[52:55], v[60:63]
s_xor_b32 s64, s73, 131712
ds_read_b64_tr_b16 a[94:95], v10 offset:41984
v_mfma_f32_16x16x32_bf16 v[76:79], a[108:111], a[60:63], v[76:79]
buffer_load_dwordx4 v12, s[48:51], s64 offen lds
v_mfma_f32_16x16x32_bf16 v[76:79], a[104:107], a[56:59], v[76:79]
ds_read_b64_tr_b16 a[96:97], v11 offset:32768
v_mfma_f32_16x16x32_bf16 v[140:143], a[112:115], a[56:59], v[140:143]
ds_read_b64_tr_b16 a[98:99], v11 offset:33792
v_mfma_f32_16x16x32_bf16 v[140:143], a[116:119], a[60:63], v[140:143]
s_xor_b32 m0, s84, 39936
ds_read_b64_tr_b16 a[100:101], v11 offset:40960
v_subrev_u32 v8, 0x8000, v8
v_mfma_f32_16x16x32_bf16 v[124:127], a[116:119], a[52:55], v[124:127]
s_xor_b32 s64, s73, 148096
ds_read_b64_tr_b16 a[102:103], v11 offset:41984
v_mfma_f32_16x16x32_bf16 v[124:127], a[112:115], a[48:51], v[124:127]
buffer_load_dwordx4 v13, s[48:51], s64 offen lds
v_mfma_f32_16x16x32_bf16 v[108:111], a[112:115], a[40:43], v[108:111]
v_mfma_f32_16x16x32_bf16 v[108:111], a[116:119], a[44:47], v[108:111]
v_mfma_f32_16x16x32_bf16 v[92:95], a[116:119], a[36:39], v[92:95]
v_subrev_u32 v9, 0x8000, v9
v_subrev_u32 v10, 0x8000, v10
v_mfma_f32_16x16x32_bf16 v[92:95], a[112:115], a[32:35], v[92:95]
v_subrev_u32 v11, 0x8000, v11
v_mfma_f32_16x16x32_bf16 v[32:35], a[72:75], a[32:35], v[32:35]
v_mfma_f32_16x16x32_bf16 v[32:35], a[76:79], a[36:39], v[32:35]
v_mfma_f32_16x16x32_bf16 v[48:51], a[76:79], a[44:47], v[48:51]
s_waitcnt lgkmcnt(0)
s_barrier
v_mfma_f32_16x16x32_bf16 v[48:51], a[72:75], a[40:43], v[48:51]
s_xor_b32 m0, s77, 131072
ds_read_b64_tr_b16 a[104:105], v19 offset:4096
v_mfma_f32_16x16x32_bf16 v[64:67], a[72:75], a[48:51], v[64:67]
s_xor_b32 s64, s71, 3145728
ds_read_b64_tr_b16 a[106:107], v19 offset:4352
v_mfma_f32_16x16x32_bf16 v[64:67], a[76:79], a[52:55], v[64:67]
buffer_load_dwordx4 v14, s[56:59], s64 offen lds
v_mfma_f32_16x16x32_bf16 v[80:83], a[76:79], a[60:63], v[80:83]
ds_read_b64_tr_b16 a[108:109], v19 offset:6144
v_mfma_f32_16x16x32_bf16 v[80:83], a[72:75], a[56:59], v[80:83]
ds_read_b64_tr_b16 a[110:111], v19 offset:6400
v_mfma_f32_16x16x32_bf16 v[144:147], a[80:83], a[56:59], v[144:147]
ds_read_b64_tr_b16 a[112:113], v20 offset:4096
v_mfma_f32_16x16x32_bf16 v[144:147], a[84:87], a[60:63], v[144:147]
ds_read_b64_tr_b16 a[114:115], v20 offset:4352
v_mfma_f32_16x16x32_bf16 v[128:131], a[84:87], a[52:55], v[128:131]
ds_read_b64_tr_b16 a[116:117], v20 offset:6144
v_mfma_f32_16x16x32_bf16 v[128:131], a[80:83], a[48:51], v[128:131]
ds_read_b64_tr_b16 a[118:119], v20 offset:6400
v_mfma_f32_16x16x32_bf16 v[112:115], a[80:83], a[40:43], v[112:115]
s_add_u32 m0, s78, 147456
ds_read_b64_tr_b16 a[72:73], v19 offset:8192
v_mfma_f32_16x16x32_bf16 v[112:115], a[84:87], a[44:47], v[112:115]
s_add_u32 s64, s75, 2359296
ds_read_b64_tr_b16 a[74:75], v19 offset:8448
v_mfma_f32_16x16x32_bf16 v[96:99], a[84:87], a[36:39], v[96:99]
buffer_load_dwordx4 v23, s[60:63], s64 offen lds
v_mfma_f32_16x16x32_bf16 v[96:99], a[80:83], a[32:35], v[96:99]
ds_read_b64_tr_b16 a[76:77], v19 offset:10240
v_mfma_f32_16x16x32_bf16 v[36:39], a[88:91], a[32:35], v[36:39]
ds_read_b64_tr_b16 a[78:79], v19 offset:10496
v_mfma_f32_16x16x32_bf16 v[36:39], a[92:95], a[36:39], v[36:39]
ds_read_b64_tr_b16 a[80:81], v20 offset:8192
v_mfma_f32_16x16x32_bf16 v[52:55], a[92:95], a[44:47], v[52:55]
ds_read_b64_tr_b16 a[82:83], v20 offset:8448
v_mfma_f32_16x16x32_bf16 v[52:55], a[88:91], a[40:43], v[52:55]
ds_read_b64_tr_b16 a[84:85], v20 offset:10240
v_mfma_f32_16x16x32_bf16 v[68:71], a[88:91], a[48:51], v[68:71]
s_xor_b32 m0, s77, 132096
ds_read_b64_tr_b16 a[86:87], v20 offset:10496
v_mfma_f32_16x16x32_bf16 v[68:71], a[92:95], a[52:55], v[68:71]
s_xor_b32 s64, s71, 3178496
s_xor_b32 s68, s66, 12288
v_mfma_f32_16x16x32_bf16 v[84:87], a[92:95], a[60:63], v[84:87]
s_mov_b64 exec, 1
buffer_atomic_add a251, v1, s[52:55], s68 offen offset:0 sc1
s_mov_b64 exec, -1
v_mfma_f32_16x16x32_bf16 v[84:87], a[88:91], a[56:59], v[84:87]
buffer_load_dwordx4 v14, s[56:59], s64 offen lds
v_mfma_f32_16x16x32_bf16 v[148:151], a[96:99], a[56:59], v[148:151]
ds_read_b64_tr_b16 a[88:89], v19 offset:0
v_mfma_f32_16x16x32_bf16 v[148:151], a[100:103], a[60:63], v[148:151]
ds_read_b64_tr_b16 a[90:91], v19 offset:256
v_mfma_f32_16x16x32_bf16 v[132:135], a[100:103], a[52:55], v[132:135]
ds_read_b64_tr_b16 a[92:93], v19 offset:2048
v_mfma_f32_16x16x32_bf16 v[132:135], a[96:99], a[48:51], v[132:135]
ds_read_b64_tr_b16 a[94:95], v19 offset:2304
v_mfma_f32_16x16x32_bf16 v[116:119], a[96:99], a[40:43], v[116:119]
v_mfma_f32_16x16x32_bf16 v[116:119], a[100:103], a[44:47], v[116:119]
v_mfma_f32_16x16x32_bf16 v[100:103], a[100:103], a[36:39], v[100:103]
s_add_u32 m0, s78, 151552
v_mfma_f32_16x16x32_bf16 v[100:103], a[96:99], a[32:35], v[100:103]
s_waitcnt lgkmcnt(4)
s_add_u32 s64, s75, 2361344
ds_read_b64_tr_b16 a[96:97], v20 offset:0
v_mfma_f32_16x16x32_bf16 v[184:187], a[104:107], a[0:3], v[184:187]
s_mov_b32 s36, s20
buffer_load_dwordx4 v23, s[60:63], s64 offen lds
v_mfma_f32_16x16x32_bf16 v[184:187], a[108:111], a[4:7], v[184:187]
s_mov_b32 s37, s21
ds_read_b64_tr_b16 a[98:99], v20 offset:256
v_mfma_f32_16x16x32_bf16 v[192:195], a[108:111], a[12:15], v[192:195]
s_mov_b32 s38, 2097152
s_add_u32 s17, s78, .-L_pc+6144
ds_read_b64_tr_b16 a[100:101], v20 offset:2048
v_mfma_f32_16x16x32_bf16 v[192:195], a[104:107], a[8:11], v[192:195]
s_mov_b32 s40, s14
s_add_u32 s65, s79, 6144
ds_read_b64_tr_b16 a[102:103], v20 offset:2304
v_mfma_f32_16x16x32_bf16 v[200:203], a[104:107], a[16:19], v[200:203]
s_mov_b32 s41, s15
buffer_load_dword a252, v16, s[88:91], s17 offen
v_mfma_f32_16x16x32_bf16 v[200:203], a[108:111], a[20:23], v[200:203]
s_mov_b32 s42, 8388608
buffer_store_dwordx4 a[172:175], v16, s[44:47], s65 offen sc1
v_mfma_f32_16x16x32_bf16 v[208:211], a[108:111], a[28:31], v[208:211]
v_mfma_f32_16x16x32_bf16 v[208:211], a[104:107], a[24:27], v[208:211]
ds_read_b64_tr_b16 a[104:105], v4 offset:0
v_mfma_f32_16x16x32_bf16 v[212:215], a[112:115], a[24:27], v[212:215]
s_xor_b32 m0, s77, 133120
ds_read_b64_tr_b16 a[106:107], v4 offset:1024
v_mfma_f32_16x16x32_bf16 v[212:215], a[116:119], a[28:31], v[212:215]
s_xor_b32 s64, s71, 3211264
ds_read_b64_tr_b16 a[108:109], v4 offset:8192
v_mfma_f32_16x16x32_bf16 v[204:207], a[116:119], a[20:23], v[204:207]
buffer_load_dwordx4 v15, s[56:59], s64 offen lds
v_mfma_f32_16x16x32_bf16 v[204:207], a[112:115], a[16:19], v[204:207]
ds_read_b64_tr_b16 a[110:111], v4 offset:9216
v_mfma_f32_16x16x32_bf16 v[196:199], a[112:115], a[8:11], v[196:199]
v_mfma_f32_16x16x32_bf16 v[196:199], a[116:119], a[12:15], v[196:199]
v_mfma_f32_16x16x32_bf16 v[188:191], a[116:119], a[4:7], v[188:191]
v_mfma_f32_16x16x32_bf16 v[188:191], a[112:115], a[0:3], v[188:191]
ds_read_b64_tr_b16 a[112:113], v5 offset:0
v_mfma_f32_16x16x32_bf16 v[216:219], a[0:3], a[72:75], v[216:219]
ds_read_b64_tr_b16 a[114:115], v5 offset:1024
v_mfma_f32_16x16x32_bf16 v[216:219], a[4:7], a[76:79], v[216:219]
s_add_u32 m0, s78, 155648
ds_read_b64_tr_b16 a[116:117], v5 offset:8192
v_mfma_f32_16x16x32_bf16 v[224:227], a[12:15], a[76:79], v[224:227]
s_add_u32 s64, s75, 2363392
ds_read_b64_tr_b16 a[118:119], v5 offset:9216
v_mfma_f32_16x16x32_bf16 v[224:227], a[8:11], a[72:75], v[224:227]
buffer_load_dwordx4 v23, s[60:63], s64 offen lds
v_mfma_f32_16x16x32_bf16 v[232:235], a[16:19], a[72:75], v[232:235]
v_mfma_f32_16x16x32_bf16 v[232:235], a[20:23], a[76:79], v[232:235]
v_mfma_f32_16x16x32_bf16 v[240:243], a[28:31], a[76:79], v[240:243]
v_mfma_f32_16x16x32_bf16 v[240:243], a[24:27], a[72:75], v[240:243]
ds_read_b64_tr_b16 a[72:73], v6 offset:0
v_mfma_f32_16x16x32_bf16 v[244:247], a[24:27], a[80:83], v[244:247]
ds_read_b64_tr_b16 a[74:75], v6 offset:1024
v_mfma_f32_16x16x32_bf16 v[244:247], a[28:31], a[84:87], v[244:247]
ds_read_b64_tr_b16 a[76:77], v6 offset:8192
v_mfma_f32_16x16x32_bf16 v[236:239], a[20:23], a[84:87], v[236:239]
s_xor_b32 m0, s77, 134144
ds_read_b64_tr_b16 a[78:79], v6 offset:9216
v_mfma_f32_16x16x32_bf16 v[236:239], a[16:19], a[80:83], v[236:239]
s_xor_b32 s64, s71, 3244032
v_mfma_f32_16x16x32_bf16 v[228:231], a[8:11], a[80:83], v[228:231]
buffer_load_dwordx4 v15, s[56:59], s64 offen lds
v_mfma_f32_16x16x32_bf16 v[228:231], a[12:15], a[84:87], v[228:231]
v_mfma_f32_16x16x32_bf16 v[220:223], a[4:7], a[84:87], v[220:223]
v_mfma_f32_16x16x32_bf16 v[220:223], a[0:3], a[80:83], v[220:223]
s_waitcnt lgkmcnt(4)
ds_read_b64_tr_b16 a[80:81], v7 offset:0
v_mfma_f32_16x16x32_bf16 v[152:155], a[88:91], a[0:3], v[152:155]
ds_read_b64_tr_b16 a[82:83], v7 offset:1024
v_mfma_f32_16x16x32_bf16 v[152:155], a[92:95], a[4:7], v[152:155]
ds_read_b64_tr_b16 a[84:85], v7 offset:8192
v_mfma_f32_16x16x32_bf16 v[160:163], a[92:95], a[12:15], v[160:163]
ds_read_b64_tr_b16 a[86:87], v7 offset:9216
v_mfma_f32_16x16x32_bf16 v[160:163], a[88:91], a[8:11], v[160:163]
v_mfma_f32_16x16x32_bf16 v[168:171], a[88:91], a[16:19], v[168:171]
v_mfma_f32_16x16x32_bf16 v[168:171], a[92:95], a[20:23], v[168:171]
v_mfma_f32_16x16x32_bf16 v[176:179], a[92:95], a[28:31], v[176:179]
s_xor_b32 m0, s84, 0
v_mfma_f32_16x16x32_bf16 v[176:179], a[88:91], a[24:27], v[176:179]
s_xor_b32 s64, s72, 768
ds_read_b64_tr_b16 a[88:89], v8 offset:0
v_mfma_f32_16x16x32_bf16 v[180:183], a[96:99], a[24:27], v[180:183]
buffer_load_dwordx4 v12, s[48:51], s64 offen lds
v_mfma_f32_16x16x32_bf16 v[180:183], a[100:103], a[28:31], v[180:183]
ds_read_b64_tr_b16 a[90:91], v8 offset:1024
v_mfma_f32_16x16x32_bf16 v[172:175], a[100:103], a[20:23], v[172:175]
ds_read_b64_tr_b16 a[92:93], v8 offset:8192
v_mfma_f32_16x16x32_bf16 v[172:175], a[96:99], a[16:19], v[172:175]
s_xor_b32 m0, s84, 1024
ds_read_b64_tr_b16 a[94:95], v8 offset:9216
v_mfma_f32_16x16x32_bf16 v[164:167], a[96:99], a[8:11], v[164:167]
s_xor_b32 s64, s72, 17152
v_mfma_f32_16x16x32_bf16 v[164:167], a[100:103], a[12:15], v[164:167]
buffer_load_dwordx4 v13, s[48:51], s64 offen lds
v_mfma_f32_16x16x32_bf16 v[156:159], a[100:103], a[4:7], v[156:159]
v_mfma_f32_16x16x32_bf16 v[156:159], a[96:99], a[0:3], v[156:159]
ds_read_b64_tr_b16 a[96:97], v9 offset:0
v_mfma_f32_16x16x32_bf16 v[24:27], a[104:107], a[0:3], v[24:27]
s_xor_b32 m0, s84, 2048
ds_read_b64_tr_b16 a[98:99], v9 offset:1024
v_mfma_f32_16x16x32_bf16 v[24:27], a[108:111], a[4:7], v[24:27]
s_xor_b32 s64, s72, 131840
ds_read_b64_tr_b16 a[100:101], v9 offset:8192
v_mfma_f32_16x16x32_bf16 v[40:43], a[108:111], a[12:15], v[40:43]
buffer_load_dwordx4 v12, s[48:51], s64 offen lds
v_mfma_f32_16x16x32_bf16 v[40:43], a[104:107], a[8:11], v[40:43]
ds_read_b64_tr_b16 a[102:103], v9 offset:9216
v_mfma_f32_16x16x32_bf16 v[56:59], a[104:107], a[16:19], v[56:59]
v_mfma_f32_16x16x32_bf16 v[56:59], a[108:111], a[20:23], v[56:59]
s_xor_b32 m0, s84, 3072
v_mfma_f32_16x16x32_bf16 v[72:75], a[108:111], a[28:31], v[72:75]
s_waitcnt vmcnt(13)
s_xor_b32 s64, s72, 148224
ds_read_b128 a[32:35], v2 offset:32768
v_mfma_f32_16x16x32_bf16 v[72:75], a[104:107], a[24:27], v[72:75]
s_add_u32 s65, s79, 2048
buffer_load_dwordx4 v13, s[48:51], s64 offen lds
v_mfma_f32_16x16x32_bf16 v[136:139], a[112:115], a[24:27], v[136:139]
buffer_store_dwordx4 a[176:179], v16, s[44:47], s65 offen sc1
v_mfma_f32_16x16x32_bf16 v[136:139], a[116:119], a[28:31], v[136:139]
ds_read_b128 a[36:39], v3 offset:32768
v_mfma_f32_16x16x32_bf16 v[120:123], a[116:119], a[20:23], v[120:123]
s_xor_b32 m0, s84, 4096
ds_read_b128 a[40:43], v2 offset:34816
v_mfma_f32_16x16x32_bf16 v[120:123], a[112:115], a[16:19], v[120:123]
s_xor_b32 s64, s73, 768
ds_read_b128 a[44:47], v3 offset:34816
v_mfma_f32_16x16x32_bf16 v[104:107], a[112:115], a[8:11], v[104:107]
buffer_load_dwordx4 v12, s[48:51], s64 offen lds
v_mfma_f32_16x16x32_bf16 v[104:107], a[116:119], a[12:15], v[104:107]
ds_read_b128 a[48:51], v2 offset:36864
v_mfma_f32_16x16x32_bf16 v[88:91], a[116:119], a[4:7], v[88:91]
ds_read_b128 a[52:55], v3 offset:36864
v_mfma_f32_16x16x32_bf16 v[88:91], a[112:115], a[0:3], v[88:91]
s_waitcnt lgkmcnt(6)
s_xor_b32 m0, s84, 5120
ds_read_b128 a[56:59], v2 offset:38912
v_mfma_f32_16x16x32_bf16 v[28:31], a[72:75], a[0:3], v[28:31]
s_xor_b32 s64, s73, 17152
ds_read_b128 a[60:63], v3 offset:38912
v_mfma_f32_16x16x32_bf16 v[28:31], a[76:79], a[4:7], v[28:31]
buffer_load_dwordx4 v13, s[48:51], s64 offen lds
v_mfma_f32_16x16x32_bf16 v[44:47], a[76:79], a[12:15], v[44:47]
ds_read_b64_tr_b16 a[104:105], v10 offset:0
v_mfma_f32_16x16x32_bf16 v[44:47], a[72:75], a[8:11], v[44:47]
ds_read_b64_tr_b16 a[106:107], v10 offset:1024
v_mfma_f32_16x16x32_bf16 v[60:63], a[72:75], a[16:19], v[60:63]
s_xor_b32 m0, s84, 6144
ds_read_b64_tr_b16 a[108:109], v10 offset:8192
v_mfma_f32_16x16x32_bf16 v[60:63], a[76:79], a[20:23], v[60:63]
s_xor_b32 s64, s73, 131840
ds_read_b64_tr_b16 a[110:111], v10 offset:9216
v_mfma_f32_16x16x32_bf16 v[76:79], a[76:79], a[28:31], v[76:79]
buffer_load_dwordx4 v12, s[48:51], s64 offen lds
v_mfma_f32_16x16x32_bf16 v[76:79], a[72:75], a[24:27], v[76:79]
ds_read_b64_tr_b16 a[112:113], v11 offset:0
v_mfma_f32_16x16x32_bf16 v[140:143], a[80:83], a[24:27], v[140:143]
ds_read_b64_tr_b16 a[114:115], v11 offset:1024
v_mfma_f32_16x16x32_bf16 v[140:143], a[84:87], a[28:31], v[140:143]
s_xor_b32 m0, s84, 7168
ds_read_b64_tr_b16 a[116:117], v11 offset:8192
v_mfma_f32_16x16x32_bf16 v[124:127], a[84:87], a[20:23], v[124:127]
s_xor_b32 s64, s73, 148224
ds_read_b64_tr_b16 a[118:119], v11 offset:9216
v_mfma_f32_16x16x32_bf16 v[124:127], a[80:83], a[16:19], v[124:127]
buffer_load_dwordx4 v13, s[48:51], s64 offen lds
v_mfma_f32_16x16x32_bf16 v[108:111], a[80:83], a[8:11], v[108:111]
v_mfma_f32_16x16x32_bf16 v[108:111], a[84:87], a[12:15], v[108:111]
v_mfma_f32_16x16x32_bf16 v[92:95], a[84:87], a[4:7], v[92:95]
v_mfma_f32_16x16x32_bf16 v[92:95], a[80:83], a[0:3], v[92:95]
v_mfma_f32_16x16x32_bf16 v[32:35], a[88:91], a[0:3], v[32:35]
v_mfma_f32_16x16x32_bf16 v[32:35], a[92:95], a[4:7], v[32:35]
v_mfma_f32_16x16x32_bf16 v[48:51], a[92:95], a[12:15], v[48:51]
s_waitcnt lgkmcnt(0)
s_barrier
v_mfma_f32_16x16x32_bf16 v[48:51], a[88:91], a[8:11], v[48:51]
s_xor_b32 m0, s77, 65536
ds_read_b64_tr_b16 a[72:73], v19 offset:36864
v_mfma_f32_16x16x32_bf16 v[64:67], a[88:91], a[16:19], v[64:67]
s_xor_b32 s64, s71, 3670016
ds_read_b64_tr_b16 a[74:75], v19 offset:37120
v_mfma_f32_16x16x32_bf16 v[64:67], a[92:95], a[20:23], v[64:67]
buffer_load_dwordx4 v14, s[56:59], s64 offen lds
v_mfma_f32_16x16x32_bf16 v[80:83], a[92:95], a[28:31], v[80:83]
ds_read_b64_tr_b16 a[76:77], v19 offset:38912
v_mfma_f32_16x16x32_bf16 v[80:83], a[88:91], a[24:27], v[80:83]
ds_read_b64_tr_b16 a[78:79], v19 offset:39168
v_mfma_f32_16x16x32_bf16 v[144:147], a[96:99], a[24:27], v[144:147]
ds_read_b64_tr_b16 a[80:81], v20 offset:36864
v_mfma_f32_16x16x32_bf16 v[144:147], a[100:103], a[28:31], v[144:147]
ds_read_b64_tr_b16 a[82:83], v20 offset:37120
v_mfma_f32_16x16x32_bf16 v[128:131], a[100:103], a[20:23], v[128:131]
ds_read_b64_tr_b16 a[84:85], v20 offset:38912
v_mfma_f32_16x16x32_bf16 v[128:131], a[96:99], a[16:19], v[128:131]
ds_read_b64_tr_b16 a[86:87], v20 offset:39168
v_mfma_f32_16x16x32_bf16 v[112:115], a[96:99], a[8:11], v[112:115]
s_add_u32 m0, s78, 81920
ds_read_b64_tr_b16 a[88:89], v19 offset:40960
v_mfma_f32_16x16x32_bf16 v[112:115], a[100:103], a[12:15], v[112:115]
s_add_u32 s64, s75, 2752512
ds_read_b64_tr_b16 a[90:91], v19 offset:41216
v_mfma_f32_16x16x32_bf16 v[96:99], a[100:103], a[4:7], v[96:99]
buffer_load_dwordx4 v23, s[60:63], s64 offen lds
v_mfma_f32_16x16x32_bf16 v[96:99], a[96:99], a[0:3], v[96:99]
ds_read_b64_tr_b16 a[92:93], v19 offset:43008
v_mfma_f32_16x16x32_bf16 v[36:39], a[104:107], a[0:3], v[36:39]
ds_read_b64_tr_b16 a[94:95], v19 offset:43264
v_mfma_f32_16x16x32_bf16 v[36:39], a[108:111], a[4:7], v[36:39]
ds_read_b64_tr_b16 a[96:97], v20 offset:40960
v_mfma_f32_16x16x32_bf16 v[52:55], a[108:111], a[12:15], v[52:55]
ds_read_b64_tr_b16 a[98:99], v20 offset:41216
v_mfma_f32_16x16x32_bf16 v[52:55], a[104:107], a[8:11], v[52:55]
ds_read_b64_tr_b16 a[100:101], v20 offset:43008
v_mfma_f32_16x16x32_bf16 v[68:71], a[104:107], a[16:19], v[68:71]
ds_read_b64_tr_b16 a[102:103], v20 offset:43264
v_mfma_f32_16x16x32_bf16 v[68:71], a[108:111], a[20:23], v[68:71]
s_xor_b32 m0, s77, 66560
v_mfma_f32_16x16x32_bf16 v[84:87], a[108:111], a[28:31], v[84:87]
s_xor_b32 s64, s71, 3702784
v_mfma_f32_16x16x32_bf16 v[84:87], a[104:107], a[24:27], v[84:87]
s_add_u32 s65, s79, 19456
buffer_load_dwordx4 v14, s[56:59], s64 offen lds
v_mfma_f32_16x16x32_bf16 v[148:151], a[112:115], a[24:27], v[148:151]
buffer_store_dwordx4 a[180:183], v16, s[44:47], s65 offen sc1
v_mfma_f32_16x16x32_bf16 v[148:151], a[116:119], a[28:31], v[148:151]
ds_read_b64_tr_b16 a[104:105], v19 offset:32768
v_mfma_f32_16x16x32_bf16 v[132:135], a[116:119], a[20:23], v[132:135]
ds_read_b64_tr_b16 a[106:107], v19 offset:33024
v_mfma_f32_16x16x32_bf16 v[132:135], a[112:115], a[16:19], v[132:135]
ds_read_b64_tr_b16 a[108:109], v19 offset:34816
v_mfma_f32_16x16x32_bf16 v[116:119], a[112:115], a[8:11], v[116:119]
ds_read_b64_tr_b16 a[110:111], v19 offset:35072
v_mfma_f32_16x16x32_bf16 v[116:119], a[116:119], a[12:15], v[116:119]
v_mfma_f32_16x16x32_bf16 v[100:103], a[116:119], a[4:7], v[100:103]
s_add_u32 m0, s78, 86016
v_mfma_f32_16x16x32_bf16 v[100:103], a[112:115], a[0:3], v[100:103]
s_waitcnt lgkmcnt(4)
s_add_u32 s64, s75, 2754560
ds_read_b64_tr_b16 a[112:113], v20 offset:32768
v_mfma_f32_16x16x32_bf16 v[184:187], a[72:75], a[32:35], v[184:187]
buffer_load_dwordx4 v23, s[60:63], s64 offen lds
v_mfma_f32_16x16x32_bf16 v[184:187], a[76:79], a[36:39], v[184:187]
ds_read_b64_tr_b16 a[114:115], v20 offset:33024
v_mfma_f32_16x16x32_bf16 v[192:195], a[76:79], a[44:47], v[192:195]
ds_read_b64_tr_b16 a[116:117], v20 offset:34816
v_mfma_f32_16x16x32_bf16 v[192:195], a[72:75], a[40:43], v[192:195]
ds_read_b64_tr_b16 a[118:119], v20 offset:35072
v_mfma_f32_16x16x32_bf16 v[200:203], a[72:75], a[48:51], v[200:203]
v_mfma_f32_16x16x32_bf16 v[200:203], a[76:79], a[52:55], v[200:203]
v_mfma_f32_16x16x32_bf16 v[208:211], a[76:79], a[60:63], v[208:211]
v_mfma_f32_16x16x32_bf16 v[208:211], a[72:75], a[56:59], v[208:211]
ds_read_b64_tr_b16 a[72:73], v4 offset:32768
v_mfma_f32_16x16x32_bf16 v[212:215], a[80:83], a[56:59], v[212:215]
s_xor_b32 m0, s77, 67584
ds_read_b64_tr_b16 a[74:75], v4 offset:33792
v_mfma_f32_16x16x32_bf16 v[212:215], a[84:87], a[60:63], v[212:215]
s_xor_b32 s64, s71, 3735552
ds_read_b64_tr_b16 a[76:77], v4 offset:40960
v_mfma_f32_16x16x32_bf16 v[204:207], a[84:87], a[52:55], v[204:207]
buffer_load_dwordx4 v15, s[56:59], s64 offen lds
v_mfma_f32_16x16x32_bf16 v[204:207], a[80:83], a[48:51], v[204:207]
ds_read_b64_tr_b16 a[78:79], v4 offset:41984
v_mfma_f32_16x16x32_bf16 v[196:199], a[80:83], a[40:43], v[196:199]
v_mfma_f32_16x16x32_bf16 v[196:199], a[84:87], a[44:47], v[196:199]
v_mfma_f32_16x16x32_bf16 v[188:191], a[84:87], a[36:39], v[188:191]
v_mfma_f32_16x16x32_bf16 v[188:191], a[80:83], a[32:35], v[188:191]
ds_read_b64_tr_b16 a[80:81], v5 offset:32768
v_mfma_f32_16x16x32_bf16 v[216:219], a[32:35], a[88:91], v[216:219]
ds_read_b64_tr_b16 a[82:83], v5 offset:33792
v_mfma_f32_16x16x32_bf16 v[216:219], a[36:39], a[92:95], v[216:219]
s_add_u32 m0, s78, 90112
ds_read_b64_tr_b16 a[84:85], v5 offset:40960
v_mfma_f32_16x16x32_bf16 v[224:227], a[44:47], a[92:95], v[224:227]
s_add_u32 s64, s75, 2756608
ds_read_b64_tr_b16 a[86:87], v5 offset:41984
v_mfma_f32_16x16x32_bf16 v[224:227], a[40:43], a[88:91], v[224:227]
buffer_load_dwordx4 v23, s[60:63], s64 offen lds
v_mfma_f32_16x16x32_bf16 v[232:235], a[48:51], a[88:91], v[232:235]
v_mfma_f32_16x16x32_bf16 v[232:235], a[52:55], a[92:95], v[232:235]
v_mfma_f32_16x16x32_bf16 v[240:243], a[60:63], a[92:95], v[240:243]
v_mfma_f32_16x16x32_bf16 v[240:243], a[56:59], a[88:91], v[240:243]
ds_read_b64_tr_b16 a[88:89], v6 offset:32768
v_mfma_f32_16x16x32_bf16 v[244:247], a[56:59], a[96:99], v[244:247]
ds_read_b64_tr_b16 a[90:91], v6 offset:33792
v_mfma_f32_16x16x32_bf16 v[244:247], a[60:63], a[100:103], v[244:247]
ds_read_b64_tr_b16 a[92:93], v6 offset:40960
v_add_u32 v19, 0x8000, v19
v_mfma_f32_16x16x32_bf16 v[236:239], a[52:55], a[100:103], v[236:239]
s_xor_b32 m0, s77, 68608
ds_read_b64_tr_b16 a[94:95], v6 offset:41984
v_mfma_f32_16x16x32_bf16 v[236:239], a[48:51], a[96:99], v[236:239]
s_xor_b32 s64, s71, 3768320
v_mfma_f32_16x16x32_bf16 v[228:231], a[40:43], a[96:99], v[228:231]
buffer_load_dwordx4 v15, s[56:59], s64 offen lds
v_mfma_f32_16x16x32_bf16 v[228:231], a[44:47], a[100:103], v[228:231]
v_mfma_f32_16x16x32_bf16 v[220:223], a[36:39], a[100:103], v[220:223]
v_mfma_f32_16x16x32_bf16 v[220:223], a[32:35], a[96:99], v[220:223]
s_waitcnt lgkmcnt(4)
ds_read_b64_tr_b16 a[96:97], v7 offset:32768
v_mfma_f32_16x16x32_bf16 v[152:155], a[104:107], a[32:35], v[152:155]
ds_read_b64_tr_b16 a[98:99], v7 offset:33792
v_mfma_f32_16x16x32_bf16 v[152:155], a[108:111], a[36:39], v[152:155]
ds_read_b64_tr_b16 a[100:101], v7 offset:40960
v_add_u32 v20, 0x8000, v20
v_mfma_f32_16x16x32_bf16 v[160:163], a[108:111], a[44:47], v[160:163]
ds_read_b64_tr_b16 a[102:103], v7 offset:41984
v_mfma_f32_16x16x32_bf16 v[160:163], a[104:107], a[40:43], v[160:163]
v_mfma_f32_16x16x32_bf16 v[168:171], a[104:107], a[48:51], v[168:171]
v_mfma_f32_16x16x32_bf16 v[168:171], a[108:111], a[52:55], v[168:171]
v_mfma_f32_16x16x32_bf16 v[176:179], a[108:111], a[60:63], v[176:179]
s_xor_b32 m0, s84, 32768
v_mfma_f32_16x16x32_bf16 v[176:179], a[104:107], a[56:59], v[176:179]
s_xor_b32 s64, s72, 896
ds_read_b64_tr_b16 a[104:105], v8 offset:32768
v_mfma_f32_16x16x32_bf16 v[180:183], a[112:115], a[56:59], v[180:183]
buffer_load_dwordx4 v12, s[48:51], s64 offen lds
v_mfma_f32_16x16x32_bf16 v[180:183], a[116:119], a[60:63], v[180:183]
s_add_u32 s65, s79, 7168
ds_read_b64_tr_b16 a[106:107], v8 offset:33792
v_add_u32 v4, 0x8000, v4
v_mfma_f32_16x16x32_bf16 v[172:175], a[116:119], a[52:55], v[172:175]
buffer_store_dwordx4 a[184:187], v16, s[44:47], s65 offen sc1
v_mfma_f32_16x16x32_bf16 v[172:175], a[112:115], a[48:51], v[172:175]
s_xor_b32 m0, s84, 33792
ds_read_b64_tr_b16 a[108:109], v8 offset:40960
v_mfma_f32_16x16x32_bf16 v[164:167], a[112:115], a[40:43], v[164:167]
s_xor_b32 s64, s72, 17280
ds_read_b64_tr_b16 a[110:111], v8 offset:41984
v_mfma_f32_16x16x32_bf16 v[164:167], a[116:119], a[44:47], v[164:167]
buffer_load_dwordx4 v13, s[48:51], s64 offen lds
v_mfma_f32_16x16x32_bf16 v[156:159], a[116:119], a[36:39], v[156:159]
v_mfma_f32_16x16x32_bf16 v[156:159], a[112:115], a[32:35], v[156:159]
ds_read_b64_tr_b16 a[112:113], v9 offset:32768
v_mfma_f32_16x16x32_bf16 v[24:27], a[72:75], a[32:35], v[24:27]
s_xor_b32 m0, s84, 34816
ds_read_b64_tr_b16 a[114:115], v9 offset:33792
v_mfma_f32_16x16x32_bf16 v[24:27], a[76:79], a[36:39], v[24:27]
s_xor_b32 s64, s72, 131968
ds_read_b64_tr_b16 a[116:117], v9 offset:40960
v_add_u32 v5, 0x8000, v5
v_mfma_f32_16x16x32_bf16 v[40:43], a[76:79], a[44:47], v[40:43]
buffer_load_dwordx4 v12, s[48:51], s64 offen lds
v_mfma_f32_16x16x32_bf16 v[40:43], a[72:75], a[40:43], v[40:43]
ds_read_b64_tr_b16 a[118:119], v9 offset:41984
v_mfma_f32_16x16x32_bf16 v[56:59], a[72:75], a[48:51], v[56:59]
v_mfma_f32_16x16x32_bf16 v[56:59], a[76:79], a[52:55], v[56:59]
s_xor_b32 m0, s84, 35840
v_mfma_f32_16x16x32_bf16 v[72:75], a[76:79], a[60:63], v[72:75]
s_waitcnt vmcnt(12)
s_xor_b32 s64, s72, 148352
ds_read_b128 a[0:3], v2 offset:0
v_mfma_f32_16x16x32_bf16 v[72:75], a[72:75], a[56:59], v[72:75]
buffer_load_dwordx4 v13, s[48:51], s64 offen lds
v_mfma_f32_16x16x32_bf16 v[136:139], a[80:83], a[56:59], v[136:139]
ds_read_b128 a[4:7], v3 offset:0
v_mfma_f32_16x16x32_bf16 v[136:139], a[84:87], a[60:63], v[136:139]
ds_read_b128 a[8:11], v2 offset:2048
v_add_u32 v6, 0x8000, v6
v_mfma_f32_16x16x32_bf16 v[120:123], a[84:87], a[52:55], v[120:123]
s_xor_b32 m0, s84, 36864
ds_read_b128 a[12:15], v3 offset:2048
v_mfma_f32_16x16x32_bf16 v[120:123], a[80:83], a[48:51], v[120:123]
s_xor_b32 s64, s73, 896
ds_read_b128 a[16:19], v2 offset:4096
v_mfma_f32_16x16x32_bf16 v[104:107], a[80:83], a[40:43], v[104:107]
buffer_load_dwordx4 v12, s[48:51], s64 offen lds
v_mfma_f32_16x16x32_bf16 v[104:107], a[84:87], a[44:47], v[104:107]
ds_read_b128 a[20:23], v3 offset:4096
v_mfma_f32_16x16x32_bf16 v[88:91], a[84:87], a[36:39], v[88:91]
ds_read_b128 a[24:27], v2 offset:6144
v_mfma_f32_16x16x32_bf16 v[88:91], a[80:83], a[32:35], v[88:91]
s_waitcnt lgkmcnt(7)
s_xor_b32 m0, s84, 37888
ds_read_b128 a[28:31], v3 offset:6144
v_mfma_f32_16x16x32_bf16 v[28:31], a[88:91], a[32:35], v[28:31]
s_xor_b32 s64, s73, 17280
ds_read_b64_tr_b16 a[72:73], v10 offset:32768
v_mfma_f32_16x16x32_bf16 v[28:31], a[92:95], a[36:39], v[28:31]
buffer_load_dwordx4 v13, s[48:51], s64 offen lds
v_mfma_f32_16x16x32_bf16 v[44:47], a[92:95], a[44:47], v[44:47]
ds_read_b64_tr_b16 a[74:75], v10 offset:33792
v_add_u32 v7, 0x8000, v7
v_mfma_f32_16x16x32_bf16 v[44:47], a[88:91], a[40:43], v[44:47]
ds_read_b64_tr_b16 a[76:77], v10 offset:40960
v_mfma_f32_16x16x32_bf16 v[60:63], a[88:91], a[48:51], v[60:63]
s_xor_b32 m0, s84, 38912
ds_read_b64_tr_b16 a[78:79], v10 offset:41984
v_mfma_f32_16x16x32_bf16 v[60:63], a[92:95], a[52:55], v[60:63]
s_xor_b32 s64, s73, 131968
ds_read_b64_tr_b16 a[80:81], v11 offset:32768
v_mfma_f32_16x16x32_bf16 v[76:79], a[92:95], a[60:63], v[76:79]
buffer_load_dwordx4 v12, s[48:51], s64 offen lds
v_mfma_f32_16x16x32_bf16 v[76:79], a[88:91], a[56:59], v[76:79]
ds_read_b64_tr_b16 a[82:83], v11 offset:33792
v_mfma_f32_16x16x32_bf16 v[140:143], a[96:99], a[56:59], v[140:143]
ds_read_b64_tr_b16 a[84:85], v11 offset:40960
v_mfma_f32_16x16x32_bf16 v[140:143], a[100:103], a[60:63], v[140:143]
s_xor_b32 m0, s84, 39936
ds_read_b64_tr_b16 a[86:87], v11 offset:41984
v_add_u32 v8, 0x8000, v8
v_mfma_f32_16x16x32_bf16 v[124:127], a[100:103], a[52:55], v[124:127]
s_xor_b32 s64, s73, 148352
v_mfma_f32_16x16x32_bf16 v[124:127], a[96:99], a[48:51], v[124:127]
buffer_load_dwordx4 v13, s[48:51], s64 offen lds
v_mfma_f32_16x16x32_bf16 v[108:111], a[96:99], a[40:43], v[108:111]
v_mfma_f32_16x16x32_bf16 v[108:111], a[100:103], a[44:47], v[108:111]
v_mfma_f32_16x16x32_bf16 v[92:95], a[100:103], a[36:39], v[92:95]
v_add_u32 v9, 0x8000, v9
v_add_u32 v10, 0x8000, v10
v_mfma_f32_16x16x32_bf16 v[92:95], a[96:99], a[32:35], v[92:95]
v_add_u32 v11, 0x8000, v11
v_mfma_f32_16x16x32_bf16 v[32:35], a[104:107], a[32:35], v[32:35]
v_mfma_f32_16x16x32_bf16 v[32:35], a[108:111], a[36:39], v[32:35]
v_mfma_f32_16x16x32_bf16 v[48:51], a[108:111], a[44:47], v[48:51]
s_waitcnt lgkmcnt(0)
s_barrier
v_mfma_f32_16x16x32_bf16 v[48:51], a[104:107], a[40:43], v[48:51]
s_xor_b32 m0, s77, 98304
ds_read_b64_tr_b16 a[88:89], v19 offset:36864
v_mfma_f32_16x16x32_bf16 v[64:67], a[104:107], a[48:51], v[64:67]
s_xor_b32 s64, s71, 4194304
ds_read_b64_tr_b16 a[90:91], v19 offset:37120
v_mfma_f32_16x16x32_bf16 v[64:67], a[108:111], a[52:55], v[64:67]
buffer_load_dwordx4 v14, s[56:59], s64 offen lds
v_mfma_f32_16x16x32_bf16 v[80:83], a[108:111], a[60:63], v[80:83]
ds_read_b64_tr_b16 a[92:93], v19 offset:38912
v_mfma_f32_16x16x32_bf16 v[80:83], a[104:107], a[56:59], v[80:83]
ds_read_b64_tr_b16 a[94:95], v19 offset:39168
v_mfma_f32_16x16x32_bf16 v[144:147], a[112:115], a[56:59], v[144:147]
ds_read_b64_tr_b16 a[96:97], v20 offset:36864
v_mfma_f32_16x16x32_bf16 v[144:147], a[116:119], a[60:63], v[144:147]
ds_read_b64_tr_b16 a[98:99], v20 offset:37120
v_mfma_f32_16x16x32_bf16 v[128:131], a[116:119], a[52:55], v[128:131]
s_add_u32 s65, s79, 3072
ds_read_b64_tr_b16 a[100:101], v20 offset:38912
v_mfma_f32_16x16x32_bf16 v[128:131], a[112:115], a[48:51], v[128:131]
buffer_store_dwordx4 a[188:191], v16, s[44:47], s65 offen sc1
v_mfma_f32_16x16x32_bf16 v[112:115], a[112:115], a[40:43], v[112:115]
s_add_u32 m0, s78, 114688
ds_read_b64_tr_b16 a[102:103], v20 offset:39168
v_mfma_f32_16x16x32_bf16 v[112:115], a[116:119], a[44:47], v[112:115]
s_add_u32 s64, s75, 3145728
ds_read_b64_tr_b16 a[104:105], v19 offset:40960
v_mfma_f32_16x16x32_bf16 v[96:99], a[116:119], a[36:39], v[96:99]
buffer_load_dwordx4 v23, s[60:63], s64 offen lds
v_mfma_f32_16x16x32_bf16 v[96:99], a[112:115], a[32:35], v[96:99]
ds_read_b64_tr_b16 a[106:107], v19 offset:41216
v_mfma_f32_16x16x32_bf16 v[36:39], a[72:75], a[32:35], v[36:39]
ds_read_b64_tr_b16 a[108:109], v19 offset:43008
v_mfma_f32_16x16x32_bf16 v[36:39], a[76:79], a[36:39], v[36:39]
ds_read_b64_tr_b16 a[110:111], v19 offset:43264
v_mfma_f32_16x16x32_bf16 v[52:55], a[76:79], a[44:47], v[52:55]
ds_read_b64_tr_b16 a[112:113], v20 offset:40960
v_mfma_f32_16x16x32_bf16 v[52:55], a[72:75], a[40:43], v[52:55]
ds_read_b64_tr_b16 a[114:115], v20 offset:41216
v_mfma_f32_16x16x32_bf16 v[68:71], a[72:75], a[48:51], v[68:71]
ds_read_b64_tr_b16 a[116:117], v20 offset:43008
v_mfma_f32_16x16x32_bf16 v[68:71], a[76:79], a[52:55], v[68:71]
s_xor_b32 m0, s77, 99328
ds_read_b64_tr_b16 a[118:119], v20 offset:43264
v_mfma_f32_16x16x32_bf16 v[84:87], a[76:79], a[60:63], v[84:87]
s_xor_b32 s64, s71, 4227072
v_mfma_f32_16x16x32_bf16 v[84:87], a[72:75], a[56:59], v[84:87]
buffer_load_dwordx4 v14, s[56:59], s64 offen lds
v_mfma_f32_16x16x32_bf16 v[148:151], a[80:83], a[56:59], v[148:151]
ds_read_b64_tr_b16 a[72:73], v19 offset:32768
v_mfma_f32_16x16x32_bf16 v[148:151], a[84:87], a[60:63], v[148:151]
ds_read_b64_tr_b16 a[74:75], v19 offset:33024
v_mfma_f32_16x16x32_bf16 v[132:135], a[84:87], a[52:55], v[132:135]
ds_read_b64_tr_b16 a[76:77], v19 offset:34816
v_mfma_f32_16x16x32_bf16 v[132:135], a[80:83], a[48:51], v[132:135]
ds_read_b64_tr_b16 a[78:79], v19 offset:35072
v_mfma_f32_16x16x32_bf16 v[116:119], a[80:83], a[40:43], v[116:119]
v_mfma_f32_16x16x32_bf16 v[116:119], a[84:87], a[44:47], v[116:119]
v_mfma_f32_16x16x32_bf16 v[100:103], a[84:87], a[36:39], v[100:103]
s_add_u32 m0, s78, 118784
v_mfma_f32_16x16x32_bf16 v[100:103], a[80:83], a[32:35], v[100:103]
s_waitcnt lgkmcnt(4)
s_add_u32 s64, s75, 3147776
ds_read_b64_tr_b16 a[80:81], v20 offset:32768
v_mfma_f32_16x16x32_bf16 v[184:187], a[88:91], a[0:3], v[184:187]
buffer_load_dwordx4 v23, s[60:63], s64 offen lds
v_mfma_f32_16x16x32_bf16 v[184:187], a[92:95], a[4:7], v[184:187]
ds_read_b64_tr_b16 a[82:83], v20 offset:33024
v_mfma_f32_16x16x32_bf16 v[192:195], a[92:95], a[12:15], v[192:195]
ds_read_b64_tr_b16 a[84:85], v20 offset:34816
v_mfma_f32_16x16x32_bf16 v[192:195], a[88:91], a[8:11], v[192:195]
s_add_u32 s17, s78, .-L_pc+6144
ds_read_b64_tr_b16 a[86:87], v20 offset:35072
v_mfma_f32_16x16x32_bf16 v[200:203], a[88:91], a[16:19], v[200:203]
buffer_load_dword a252, v16, s[88:91], s17 offen
v_mfma_f32_16x16x32_bf16 v[200:203], a[92:95], a[20:23], v[200:203]
v_mfma_f32_16x16x32_bf16 v[208:211], a[92:95], a[28:31], v[208:211]
v_mfma_f32_16x16x32_bf16 v[208:211], a[88:91], a[24:27], v[208:211]
ds_read_b64_tr_b16 a[88:89], v4 offset:32768
v_mfma_f32_16x16x32_bf16 v[212:215], a[96:99], a[24:27], v[212:215]
s_xor_b32 m0, s77, 100352
ds_read_b64_tr_b16 a[90:91], v4 offset:33792
v_mfma_f32_16x16x32_bf16 v[212:215], a[100:103], a[28:31], v[212:215]
s_xor_b32 s64, s71, 4259840
ds_read_b64_tr_b16 a[92:93], v4 offset:40960
v_mfma_f32_16x16x32_bf16 v[204:207], a[100:103], a[20:23], v[204:207]
buffer_load_dwordx4 v15, s[56:59], s64 offen lds
v_mfma_f32_16x16x32_bf16 v[204:207], a[96:99], a[16:19], v[204:207]
ds_read_b64_tr_b16 a[94:95], v4 offset:41984
v_mfma_f32_16x16x32_bf16 v[196:199], a[96:99], a[8:11], v[196:199]
v_mfma_f32_16x16x32_bf16 v[196:199], a[100:103], a[12:15], v[196:199]
v_mfma_f32_16x16x32_bf16 v[188:191], a[100:103], a[4:7], v[188:191]
v_mfma_f32_16x16x32_bf16 v[188:191], a[96:99], a[0:3], v[188:191]
ds_read_b64_tr_b16 a[96:97], v5 offset:32768
v_mfma_f32_16x16x32_bf16 v[216:219], a[0:3], a[104:107], v[216:219]
ds_read_b64_tr_b16 a[98:99], v5 offset:33792
v_mfma_f32_16x16x32_bf16 v[216:219], a[4:7], a[108:111], v[216:219]
s_add_u32 m0, s78, 122880
ds_read_b64_tr_b16 a[100:101], v5 offset:40960
v_mfma_f32_16x16x32_bf16 v[224:227], a[12:15], a[108:111], v[224:227]
s_add_u32 s64, s75, 3149824
ds_read_b64_tr_b16 a[102:103], v5 offset:41984
v_mfma_f32_16x16x32_bf16 v[224:227], a[8:11], a[104:107], v[224:227]
buffer_load_dwordx4 v23, s[60:63], s64 offen lds
v_mfma_f32_16x16x32_bf16 v[232:235], a[16:19], a[104:107], v[232:235]
v_mfma_f32_16x16x32_bf16 v[232:235], a[20:23], a[108:111], v[232:235]
v_mfma_f32_16x16x32_bf16 v[240:243], a[28:31], a[108:111], v[240:243]
v_mfma_f32_16x16x32_bf16 v[240:243], a[24:27], a[104:107], v[240:243]
ds_read_b64_tr_b16 a[104:105], v6 offset:32768
v_mfma_f32_16x16x32_bf16 v[244:247], a[24:27], a[112:115], v[244:247]
ds_read_b64_tr_b16 a[106:107], v6 offset:33792
v_mfma_f32_16x16x32_bf16 v[244:247], a[28:31], a[116:119], v[244:247]
ds_read_b64_tr_b16 a[108:109], v6 offset:40960
v_subrev_u32 v19, 0x8000, v19
v_mfma_f32_16x16x32_bf16 v[236:239], a[20:23], a[116:119], v[236:239]
s_xor_b32 m0, s77, 101376
ds_read_b64_tr_b16 a[110:111], v6 offset:41984
v_mfma_f32_16x16x32_bf16 v[236:239], a[16:19], a[112:115], v[236:239]
s_xor_b32 s64, s71, 4292608
v_mfma_f32_16x16x32_bf16 v[228:231], a[8:11], a[112:115], v[228:231]
s_add_u32 s65, s79, 24576
buffer_load_dwordx4 v15, s[56:59], s64 offen lds
v_mfma_f32_16x16x32_bf16 v[228:231], a[12:15], a[116:119], v[228:231]
buffer_store_dwordx4 a[192:195], v16, s[44:47], s65 offen sc1
v_mfma_f32_16x16x32_bf16 v[220:223], a[4:7], a[116:119], v[220:223]
v_mfma_f32_16x16x32_bf16 v[220:223], a[0:3], a[112:115], v[220:223]
s_waitcnt lgkmcnt(4)
ds_read_b64_tr_b16 a[112:113], v7 offset:32768
v_mfma_f32_16x16x32_bf16 v[152:155], a[72:75], a[0:3], v[152:155]
ds_read_b64_tr_b16 a[114:115], v7 offset:33792
v_mfma_f32_16x16x32_bf16 v[152:155], a[76:79], a[4:7], v[152:155]
ds_read_b64_tr_b16 a[116:117], v7 offset:40960
v_subrev_u32 v20, 0x8000, v20
v_mfma_f32_16x16x32_bf16 v[160:163], a[76:79], a[12:15], v[160:163]
ds_read_b64_tr_b16 a[118:119], v7 offset:41984
v_mfma_f32_16x16x32_bf16 v[160:163], a[72:75], a[8:11], v[160:163]
v_mfma_f32_16x16x32_bf16 v[168:171], a[72:75], a[16:19], v[168:171]
v_mfma_f32_16x16x32_bf16 v[168:171], a[76:79], a[20:23], v[168:171]
v_mfma_f32_16x16x32_bf16 v[176:179], a[76:79], a[28:31], v[176:179]
s_xor_b32 m0, s84, 0
v_mfma_f32_16x16x32_bf16 v[176:179], a[72:75], a[24:27], v[176:179]
s_xor_b32 s64, s72, 1024
ds_read_b64_tr_b16 a[72:73], v8 offset:32768
v_mfma_f32_16x16x32_bf16 v[180:183], a[80:83], a[24:27], v[180:183]
buffer_load_dwordx4 v12, s[48:51], s64 offen lds
v_mfma_f32_16x16x32_bf16 v[180:183], a[84:87], a[28:31], v[180:183]
ds_read_b64_tr_b16 a[74:75], v8 offset:33792
v_subrev_u32 v4, 0x8000, v4
v_mfma_f32_16x16x32_bf16 v[172:175], a[84:87], a[20:23], v[172:175]
ds_read_b64_tr_b16 a[76:77], v8 offset:40960
v_mfma_f32_16x16x32_bf16 v[172:175], a[80:83], a[16:19], v[172:175]
s_xor_b32 m0, s84, 1024
ds_read_b64_tr_b16 a[78:79], v8 offset:41984
v_mfma_f32_16x16x32_bf16 v[164:167], a[80:83], a[8:11], v[164:167]
s_xor_b32 s64, s72, 17408
v_mfma_f32_16x16x32_bf16 v[164:167], a[84:87], a[12:15], v[164:167]
buffer_load_dwordx4 v13, s[48:51], s64 offen lds
v_mfma_f32_16x16x32_bf16 v[156:159], a[84:87], a[4:7], v[156:159]
v_mfma_f32_16x16x32_bf16 v[156:159], a[80:83], a[0:3], v[156:159]
ds_read_b64_tr_b16 a[80:81], v9 offset:32768
v_mfma_f32_16x16x32_bf16 v[24:27], a[88:91], a[0:3], v[24:27]
s_xor_b32 m0, s84, 2048
ds_read_b64_tr_b16 a[82:83], v9 offset:33792
v_mfma_f32_16x16x32_bf16 v[24:27], a[92:95], a[4:7], v[24:27]
s_xor_b32 s64, s72, 132096
ds_read_b64_tr_b16 a[84:85], v9 offset:40960
v_subrev_u32 v5, 0x8000, v5
v_mfma_f32_16x16x32_bf16 v[40:43], a[92:95], a[12:15], v[40:43]
buffer_load_dwordx4 v12, s[48:51], s64 offen lds
v_mfma_f32_16x16x32_bf16 v[40:43], a[88:91], a[8:11], v[40:43]
ds_read_b64_tr_b16 a[86:87], v9 offset:41984
v_mfma_f32_16x16x32_bf16 v[56:59], a[88:91], a[16:19], v[56:59]
v_mfma_f32_16x16x32_bf16 v[56:59], a[92:95], a[20:23], v[56:59]
s_xor_b32 m0, s84, 3072
v_mfma_f32_16x16x32_bf16 v[72:75], a[92:95], a[28:31], v[72:75]
s_waitcnt vmcnt(13)
s_xor_b32 s64, s72, 148480
ds_read_b128 a[32:35], v2 offset:32768
v_mfma_f32_16x16x32_bf16 v[72:75], a[88:91], a[24:27], v[72:75]
buffer_load_dwordx4 v13, s[48:51], s64 offen lds
v_mfma_f32_16x16x32_bf16 v[136:139], a[96:99], a[24:27], v[136:139]
ds_read_b128 a[36:39], v3 offset:32768
v_mfma_f32_16x16x32_bf16 v[136:139], a[100:103], a[28:31], v[136:139]
ds_read_b128 a[40:43], v2 offset:34816
v_subrev_u32 v6, 0x8000, v6
v_mfma_f32_16x16x32_bf16 v[120:123], a[100:103], a[20:23], v[120:123]
s_xor_b32 m0, s84, 4096
ds_read_b128 a[44:47], v3 offset:34816
v_mfma_f32_16x16x32_bf16 v[120:123], a[96:99], a[16:19], v[120:123]
s_xor_b32 s64, s73, 1024
ds_read_b128 a[48:51], v2 offset:36864
v_mfma_f32_16x16x32_bf16 v[104:107], a[96:99], a[8:11], v[104:107]
buffer_load_dwordx4 v12, s[48:51], s64 offen lds
v_mfma_f32_16x16x32_bf16 v[104:107], a[100:103], a[12:15], v[104:107]
ds_read_b128 a[52:55], v3 offset:36864
v_mfma_f32_16x16x32_bf16 v[88:91], a[100:103], a[4:7], v[88:91]
ds_read_b128 a[56:59], v2 offset:38912
v_mfma_f32_16x16x32_bf16 v[88:91], a[96:99], a[0:3], v[88:91]
s_waitcnt lgkmcnt(7)
s_xor_b32 m0, s84, 5120
ds_read_b128 a[60:63], v3 offset:38912
v_mfma_f32_16x16x32_bf16 v[28:31], a[104:107], a[0:3], v[28:31]
s_xor_b32 s64, s73, 17408
ds_read_b64_tr_b16 a[88:89], v10 offset:32768
v_mfma_f32_16x16x32_bf16 v[28:31], a[108:111], a[4:7], v[28:31]
buffer_load_dwordx4 v13, s[48:51], s64 offen lds
v_mfma_f32_16x16x32_bf16 v[44:47], a[108:111], a[12:15], v[44:47]
ds_read_b64_tr_b16 a[90:91], v10 offset:33792
v_subrev_u32 v7, 0x8000, v7
v_mfma_f32_16x16x32_bf16 v[44:47], a[104:107], a[8:11], v[44:47]
ds_read_b64_tr_b16 a[92:93], v10 offset:40960
v_mfma_f32_16x16x32_bf16 v[60:63], a[104:107], a[16:19], v[60:63]
s_xor_b32 m0, s84, 6144
ds_read_b64_tr_b16 a[94:95], v10 offset:41984
v_mfma_f32_16x16x32_bf16 v[60:63], a[108:111], a[20:23], v[60:63]
s_xor_b32 s64, s73, 132096
ds_read_b64_tr_b16 a[96:97], v11 offset:32768
v_mfma_f32_16x16x32_bf16 v[76:79], a[108:111], a[28:31], v[76:79]
buffer_load_dwordx4 v12, s[48:51], s64 offen lds
v_mfma_f32_16x16x32_bf16 v[76:79], a[104:107], a[24:27], v[76:79]
ds_read_b64_tr_b16 a[98:99], v11 offset:33792
v_mfma_f32_16x16x32_bf16 v[140:143], a[112:115], a[24:27], v[140:143]
ds_read_b64_tr_b16 a[100:101], v11 offset:40960
v_mfma_f32_16x16x32_bf16 v[140:143], a[116:119], a[28:31], v[140:143]
s_xor_b32 m0, s84, 7168
ds_read_b64_tr_b16 a[102:103], v11 offset:41984
v_subrev_u32 v8, 0x8000, v8
v_mfma_f32_16x16x32_bf16 v[124:127], a[116:119], a[20:23], v[124:127]
s_xor_b32 s64, s73, 148480
v_mfma_f32_16x16x32_bf16 v[124:127], a[112:115], a[16:19], v[124:127]
buffer_load_dwordx4 v13, s[48:51], s64 offen lds
v_mfma_f32_16x16x32_bf16 v[108:111], a[112:115], a[8:11], v[108:111]
v_mfma_f32_16x16x32_bf16 v[108:111], a[116:119], a[12:15], v[108:111]
v_mfma_f32_16x16x32_bf16 v[92:95], a[116:119], a[4:7], v[92:95]
v_subrev_u32 v9, 0x8000, v9
v_subrev_u32 v10, 0x8000, v10
v_mfma_f32_16x16x32_bf16 v[92:95], a[112:115], a[0:3], v[92:95]
s_add_u32 s65, s79, 25600
v_subrev_u32 v11, 0x8000, v11
v_mfma_f32_16x16x32_bf16 v[32:35], a[72:75], a[0:3], v[32:35]
buffer_store_dwordx4 a[196:199], v16, s[44:47], s65 offen sc1
v_mfma_f32_16x16x32_bf16 v[32:35], a[76:79], a[4:7], v[32:35]
v_mfma_f32_16x16x32_bf16 v[48:51], a[76:79], a[12:15], v[48:51]
s_waitcnt lgkmcnt(0)
s_barrier
v_mfma_f32_16x16x32_bf16 v[48:51], a[72:75], a[8:11], v[48:51]
s_xor_b32 m0, s77, 131072
ds_read_b64_tr_b16 a[104:105], v19 offset:4096
v_mfma_f32_16x16x32_bf16 v[64:67], a[72:75], a[16:19], v[64:67]
s_xor_b32 s64, s71, 4718592
ds_read_b64_tr_b16 a[106:107], v19 offset:4352
v_mfma_f32_16x16x32_bf16 v[64:67], a[76:79], a[20:23], v[64:67]
buffer_load_dwordx4 v14, s[56:59], s64 offen lds
v_mfma_f32_16x16x32_bf16 v[80:83], a[76:79], a[28:31], v[80:83]
ds_read_b64_tr_b16 a[108:109], v19 offset:6144
v_mfma_f32_16x16x32_bf16 v[80:83], a[72:75], a[24:27], v[80:83]
ds_read_b64_tr_b16 a[110:111], v19 offset:6400
v_mfma_f32_16x16x32_bf16 v[144:147], a[80:83], a[24:27], v[144:147]
ds_read_b64_tr_b16 a[112:113], v20 offset:4096
v_mfma_f32_16x16x32_bf16 v[144:147], a[84:87], a[28:31], v[144:147]
ds_read_b64_tr_b16 a[114:115], v20 offset:4352
v_mfma_f32_16x16x32_bf16 v[128:131], a[84:87], a[20:23], v[128:131]
ds_read_b64_tr_b16 a[116:117], v20 offset:6144
v_mfma_f32_16x16x32_bf16 v[128:131], a[80:83], a[16:19], v[128:131]
ds_read_b64_tr_b16 a[118:119], v20 offset:6400
v_mfma_f32_16x16x32_bf16 v[112:115], a[80:83], a[8:11], v[112:115]
s_add_u32 m0, s78, 147456
ds_read_b64_tr_b16 a[72:73], v19 offset:8192
v_mfma_f32_16x16x32_bf16 v[112:115], a[84:87], a[12:15], v[112:115]
s_add_u32 s64, s75, 3538944
ds_read_b64_tr_b16 a[74:75], v19 offset:8448
v_mfma_f32_16x16x32_bf16 v[96:99], a[84:87], a[4:7], v[96:99]
buffer_load_dwordx4 v23, s[60:63], s64 offen lds
v_mfma_f32_16x16x32_bf16 v[96:99], a[80:83], a[0:3], v[96:99]
ds_read_b64_tr_b16 a[76:77], v19 offset:10240
v_mfma_f32_16x16x32_bf16 v[36:39], a[88:91], a[0:3], v[36:39]
ds_read_b64_tr_b16 a[78:79], v19 offset:10496
v_mfma_f32_16x16x32_bf16 v[36:39], a[92:95], a[4:7], v[36:39]
ds_read_b64_tr_b16 a[80:81], v20 offset:8192
v_mfma_f32_16x16x32_bf16 v[52:55], a[92:95], a[12:15], v[52:55]
ds_read_b64_tr_b16 a[82:83], v20 offset:8448
v_mfma_f32_16x16x32_bf16 v[52:55], a[88:91], a[8:11], v[52:55]
ds_read_b64_tr_b16 a[84:85], v20 offset:10240
v_mfma_f32_16x16x32_bf16 v[68:71], a[88:91], a[16:19], v[68:71]
ds_read_b64_tr_b16 a[86:87], v20 offset:10496
v_mfma_f32_16x16x32_bf16 v[68:71], a[92:95], a[20:23], v[68:71]
s_xor_b32 m0, s77, 132096
v_mfma_f32_16x16x32_bf16 v[84:87], a[92:95], a[28:31], v[84:87]
s_xor_b32 s64, s71, 4751360
v_mfma_f32_16x16x32_bf16 v[84:87], a[88:91], a[24:27], v[84:87]
buffer_load_dwordx4 v14, s[56:59], s64 offen lds
v_mfma_f32_16x16x32_bf16 v[148:151], a[96:99], a[24:27], v[148:151]
ds_read_b64_tr_b16 a[88:89], v19 offset:0
v_mfma_f32_16x16x32_bf16 v[148:151], a[100:103], a[28:31], v[148:151]
ds_read_b64_tr_b16 a[90:91], v19 offset:256
v_mfma_f32_16x16x32_bf16 v[132:135], a[100:103], a[20:23], v[132:135]
ds_read_b64_tr_b16 a[92:93], v19 offset:2048
v_mfma_f32_16x16x32_bf16 v[132:135], a[96:99], a[16:19], v[132:135]
ds_read_b64_tr_b16 a[94:95], v19 offset:2304
v_mfma_f32_16x16x32_bf16 v[116:119], a[96:99], a[8:11], v[116:119]
v_mfma_f32_16x16x32_bf16 v[116:119], a[100:103], a[12:15], v[116:119]
v_mfma_f32_16x16x32_bf16 v[100:103], a[100:103], a[4:7], v[100:103]
s_add_u32 m0, s78, 151552
v_mfma_f32_16x16x32_bf16 v[100:103], a[96:99], a[0:3], v[100:103]
s_waitcnt lgkmcnt(4)
s_add_u32 s64, s75, 3540992
ds_read_b64_tr_b16 a[96:97], v20 offset:0
v_mfma_f32_16x16x32_bf16 v[184:187], a[104:107], a[32:35], v[184:187]
buffer_load_dwordx4 v23, s[60:63], s64 offen lds
v_mfma_f32_16x16x32_bf16 v[184:187], a[108:111], a[36:39], v[184:187]
ds_read_b64_tr_b16 a[98:99], v20 offset:256
v_mfma_f32_16x16x32_bf16 v[192:195], a[108:111], a[44:47], v[192:195]
ds_read_b64_tr_b16 a[100:101], v20 offset:2048
v_mfma_f32_16x16x32_bf16 v[192:195], a[104:107], a[40:43], v[192:195]
ds_read_b64_tr_b16 a[102:103], v20 offset:2304
v_mfma_f32_16x16x32_bf16 v[200:203], a[104:107], a[48:51], v[200:203]
v_mfma_f32_16x16x32_bf16 v[200:203], a[108:111], a[52:55], v[200:203]
v_mfma_f32_16x16x32_bf16 v[208:211], a[108:111], a[60:63], v[208:211]
v_mfma_f32_16x16x32_bf16 v[208:211], a[104:107], a[56:59], v[208:211]
ds_read_b64_tr_b16 a[104:105], v4 offset:0
v_mfma_f32_16x16x32_bf16 v[212:215], a[112:115], a[56:59], v[212:215]
s_xor_b32 m0, s77, 133120
ds_read_b64_tr_b16 a[106:107], v4 offset:1024
v_mfma_f32_16x16x32_bf16 v[212:215], a[116:119], a[60:63], v[212:215]
s_xor_b32 s64, s71, 4784128
ds_read_b64_tr_b16 a[108:109], v4 offset:8192
v_mfma_f32_16x16x32_bf16 v[204:207], a[116:119], a[52:55], v[204:207]
buffer_load_dwordx4 v15, s[56:59], s64 offen lds
v_mfma_f32_16x16x32_bf16 v[204:207], a[112:115], a[48:51], v[204:207]
ds_read_b64_tr_b16 a[110:111], v4 offset:9216
v_mfma_f32_16x16x32_bf16 v[196:199], a[112:115], a[40:43], v[196:199]
v_mfma_f32_16x16x32_bf16 v[196:199], a[116:119], a[44:47], v[196:199]
v_mfma_f32_16x16x32_bf16 v[188:191], a[116:119], a[36:39], v[188:191]
s_add_u32 s65, s79, 9216
v_mfma_f32_16x16x32_bf16 v[188:191], a[112:115], a[32:35], v[188:191]
buffer_store_dwordx4 a[200:203], v16, s[44:47], s65 offen sc1
v_mfma_f32_16x16x32_bf16 v[216:219], a[32:35], a[72:75], v[216:219]
ds_read_b64_tr_b16 a[112:113], v5 offset:0
v_mfma_f32_16x16x32_bf16 v[216:219], a[36:39], a[76:79], v[216:219]
s_add_u32 m0, s78, 155648
ds_read_b64_tr_b16 a[114:115], v5 offset:1024
v_mfma_f32_16x16x32_bf16 v[224:227], a[44:47], a[76:79], v[224:227]
s_add_u32 s64, s75, 3543040
ds_read_b64_tr_b16 a[116:117], v5 offset:8192
v_mfma_f32_16x16x32_bf16 v[224:227], a[40:43], a[72:75], v[224:227]
buffer_load_dwordx4 v23, s[60:63], s64 offen lds
v_mfma_f32_16x16x32_bf16 v[232:235], a[48:51], a[72:75], v[232:235]
ds_read_b64_tr_b16 a[118:119], v5 offset:9216
v_mfma_f32_16x16x32_bf16 v[232:235], a[52:55], a[76:79], v[232:235]
v_mfma_f32_16x16x32_bf16 v[240:243], a[60:63], a[76:79], v[240:243]
v_mfma_f32_16x16x32_bf16 v[240:243], a[56:59], a[72:75], v[240:243]
ds_read_b64_tr_b16 a[72:73], v6 offset:0
v_mfma_f32_16x16x32_bf16 v[244:247], a[56:59], a[80:83], v[244:247]
ds_read_b64_tr_b16 a[74:75], v6 offset:1024
v_mfma_f32_16x16x32_bf16 v[244:247], a[60:63], a[84:87], v[244:247]
ds_read_b64_tr_b16 a[76:77], v6 offset:8192
v_mfma_f32_16x16x32_bf16 v[236:239], a[52:55], a[84:87], v[236:239]
s_xor_b32 m0, s77, 134144
ds_read_b64_tr_b16 a[78:79], v6 offset:9216
v_mfma_f32_16x16x32_bf16 v[236:239], a[48:51], a[80:83], v[236:239]
s_xor_b32 s64, s71, 4816896
v_mfma_f32_16x16x32_bf16 v[228:231], a[40:43], a[80:83], v[228:231]
buffer_load_dwordx4 v15, s[56:59], s64 offen lds
v_mfma_f32_16x16x32_bf16 v[228:231], a[44:47], a[84:87], v[228:231]
v_mfma_f32_16x16x32_bf16 v[220:223], a[36:39], a[84:87], v[220:223]
v_mfma_f32_16x16x32_bf16 v[220:223], a[32:35], a[80:83], v[220:223]
s_waitcnt lgkmcnt(4)
ds_read_b64_tr_b16 a[80:81], v7 offset:0
v_mfma_f32_16x16x32_bf16 v[152:155], a[88:91], a[32:35], v[152:155]
ds_read_b64_tr_b16 a[82:83], v7 offset:1024
v_mfma_f32_16x16x32_bf16 v[152:155], a[92:95], a[36:39], v[152:155]
ds_read_b64_tr_b16 a[84:85], v7 offset:8192
v_mfma_f32_16x16x32_bf16 v[160:163], a[92:95], a[44:47], v[160:163]
ds_read_b64_tr_b16 a[86:87], v7 offset:9216
v_mfma_f32_16x16x32_bf16 v[160:163], a[88:91], a[40:43], v[160:163]
v_mfma_f32_16x16x32_bf16 v[168:171], a[88:91], a[48:51], v[168:171]
v_mfma_f32_16x16x32_bf16 v[168:171], a[92:95], a[52:55], v[168:171]
v_mfma_f32_16x16x32_bf16 v[176:179], a[92:95], a[60:63], v[176:179]
s_xor_b32 m0, s84, 32768
v_mfma_f32_16x16x32_bf16 v[176:179], a[88:91], a[56:59], v[176:179]
s_xor_b32 s64, s72, 1152
ds_read_b64_tr_b16 a[88:89], v8 offset:0
v_mfma_f32_16x16x32_bf16 v[180:183], a[96:99], a[56:59], v[180:183]
buffer_load_dwordx4 v12, s[48:51], s64 offen lds
v_mfma_f32_16x16x32_bf16 v[180:183], a[100:103], a[60:63], v[180:183]
ds_read_b64_tr_b16 a[90:91], v8 offset:1024
v_mfma_f32_16x16x32_bf16 v[172:175], a[100:103], a[52:55], v[172:175]
ds_read_b64_tr_b16 a[92:93], v8 offset:8192
v_mfma_f32_16x16x32_bf16 v[172:175], a[96:99], a[48:51], v[172:175]
s_xor_b32 m0, s84, 33792
ds_read_b64_tr_b16 a[94:95], v8 offset:9216
v_mfma_f32_16x16x32_bf16 v[164:167], a[96:99], a[40:43], v[164:167]
s_xor_b32 s64, s72, 17536
v_mfma_f32_16x16x32_bf16 v[164:167], a[100:103], a[44:47], v[164:167]
buffer_load_dwordx4 v13, s[48:51], s64 offen lds
v_mfma_f32_16x16x32_bf16 v[156:159], a[100:103], a[36:39], v[156:159]
v_mfma_f32_16x16x32_bf16 v[156:159], a[96:99], a[32:35], v[156:159]
ds_read_b64_tr_b16 a[96:97], v9 offset:0
v_mfma_f32_16x16x32_bf16 v[24:27], a[104:107], a[32:35], v[24:27]
s_xor_b32 m0, s84, 34816
ds_read_b64_tr_b16 a[98:99], v9 offset:1024
v_mfma_f32_16x16x32_bf16 v[24:27], a[108:111], a[36:39], v[24:27]
s_xor_b32 s64, s72, 132224
ds_read_b64_tr_b16 a[100:101], v9 offset:8192
v_mfma_f32_16x16x32_bf16 v[40:43], a[108:111], a[44:47], v[40:43]
buffer_load_dwordx4 v12, s[48:51], s64 offen lds
v_mfma_f32_16x16x32_bf16 v[40:43], a[104:107], a[40:43], v[40:43]
ds_read_b64_tr_b16 a[102:103], v9 offset:9216
v_mfma_f32_16x16x32_bf16 v[56:59], a[104:107], a[48:51], v[56:59]
v_mfma_f32_16x16x32_bf16 v[56:59], a[108:111], a[52:55], v[56:59]
s_xor_b32 m0, s84, 35840
v_mfma_f32_16x16x32_bf16 v[72:75], a[108:111], a[60:63], v[72:75]
s_waitcnt vmcnt(12)
s_xor_b32 s64, s72, 148608
ds_read_b128 a[0:3], v2 offset:0
v_mfma_f32_16x16x32_bf16 v[72:75], a[104:107], a[56:59], v[72:75]
buffer_load_dwordx4 v13, s[48:51], s64 offen lds
v_mfma_f32_16x16x32_bf16 v[136:139], a[112:115], a[56:59], v[136:139]
ds_read_b128 a[4:7], v3 offset:0
v_mfma_f32_16x16x32_bf16 v[136:139], a[116:119], a[60:63], v[136:139]
ds_read_b128 a[8:11], v2 offset:2048
v_mfma_f32_16x16x32_bf16 v[120:123], a[116:119], a[52:55], v[120:123]
s_xor_b32 m0, s84, 36864
ds_read_b128 a[12:15], v3 offset:2048
v_mfma_f32_16x16x32_bf16 v[120:123], a[112:115], a[48:51], v[120:123]
s_xor_b32 s64, s73, 1152
ds_read_b128 a[16:19], v2 offset:4096
v_mfma_f32_16x16x32_bf16 v[104:107], a[112:115], a[40:43], v[104:107]
buffer_load_dwordx4 v12, s[48:51], s64 offen lds
v_mfma_f32_16x16x32_bf16 v[104:107], a[116:119], a[44:47], v[104:107]
ds_read_b128 a[20:23], v3 offset:4096
v_mfma_f32_16x16x32_bf16 v[88:91], a[116:119], a[36:39], v[88:91]
ds_read_b128 a[24:27], v2 offset:6144
v_mfma_f32_16x16x32_bf16 v[88:91], a[112:115], a[32:35], v[88:91]
s_waitcnt lgkmcnt(7)
s_xor_b32 m0, s84, 37888
ds_read_b128 a[28:31], v3 offset:6144
v_mfma_f32_16x16x32_bf16 v[28:31], a[72:75], a[32:35], v[28:31]
s_xor_b32 s64, s73, 17536
ds_read_b64_tr_b16 a[104:105], v10 offset:0
v_mfma_f32_16x16x32_bf16 v[28:31], a[76:79], a[36:39], v[28:31]
s_add_u32 s65, s79, 26624
buffer_load_dwordx4 v13, s[48:51], s64 offen lds
v_mfma_f32_16x16x32_bf16 v[44:47], a[76:79], a[44:47], v[44:47]
buffer_store_dwordx4 a[204:207], v16, s[44:47], s65 offen sc1
v_mfma_f32_16x16x32_bf16 v[44:47], a[72:75], a[40:43], v[44:47]
ds_read_b64_tr_b16 a[106:107], v10 offset:1024
v_mfma_f32_16x16x32_bf16 v[60:63], a[72:75], a[48:51], v[60:63]
s_xor_b32 m0, s84, 38912
ds_read_b64_tr_b16 a[108:109], v10 offset:8192
v_mfma_f32_16x16x32_bf16 v[60:63], a[76:79], a[52:55], v[60:63]
s_xor_b32 s64, s73, 132224
ds_read_b64_tr_b16 a[110:111], v10 offset:9216
v_mfma_f32_16x16x32_bf16 v[76:79], a[76:79], a[60:63], v[76:79]
buffer_load_dwordx4 v12, s[48:51], s64 offen lds
v_mfma_f32_16x16x32_bf16 v[76:79], a[72:75], a[56:59], v[76:79]
ds_read_b64_tr_b16 a[112:113], v11 offset:0
v_mfma_f32_16x16x32_bf16 v[140:143], a[80:83], a[56:59], v[140:143]
ds_read_b64_tr_b16 a[114:115], v11 offset:1024
v_mfma_f32_16x16x32_bf16 v[140:143], a[84:87], a[60:63], v[140:143]
s_xor_b32 m0, s84, 39936
ds_read_b64_tr_b16 a[116:117], v11 offset:8192
v_mfma_f32_16x16x32_bf16 v[124:127], a[84:87], a[52:55], v[124:127]
s_xor_b32 s64, s73, 148608
ds_read_b64_tr_b16 a[118:119], v11 offset:9216
v_mfma_f32_16x16x32_bf16 v[124:127], a[80:83], a[48:51], v[124:127]
buffer_load_dwordx4 v13, s[48:51], s64 offen lds
v_mfma_f32_16x16x32_bf16 v[108:111], a[80:83], a[40:43], v[108:111]
v_mfma_f32_16x16x32_bf16 v[108:111], a[84:87], a[44:47], v[108:111]
v_mfma_f32_16x16x32_bf16 v[92:95], a[84:87], a[36:39], v[92:95]
v_mfma_f32_16x16x32_bf16 v[92:95], a[80:83], a[32:35], v[92:95]
v_mfma_f32_16x16x32_bf16 v[32:35], a[88:91], a[32:35], v[32:35]
v_mfma_f32_16x16x32_bf16 v[32:35], a[92:95], a[36:39], v[32:35]
v_mfma_f32_16x16x32_bf16 v[48:51], a[92:95], a[44:47], v[48:51]
s_waitcnt lgkmcnt(0)
s_barrier
v_mfma_f32_16x16x32_bf16 v[48:51], a[88:91], a[40:43], v[48:51]
s_xor_b32 m0, s77, 65536
ds_read_b64_tr_b16 a[72:73], v19 offset:36864
v_mfma_f32_16x16x32_bf16 v[64:67], a[88:91], a[48:51], v[64:67]
s_xor_b32 s64, s71, 5242880
ds_read_b64_tr_b16 a[74:75], v19 offset:37120
v_mfma_f32_16x16x32_bf16 v[64:67], a[92:95], a[52:55], v[64:67]
buffer_load_dwordx4 v14, s[56:59], s64 offen lds
v_mfma_f32_16x16x32_bf16 v[80:83], a[92:95], a[60:63], v[80:83]
ds_read_b64_tr_b16 a[76:77], v19 offset:38912
v_mfma_f32_16x16x32_bf16 v[80:83], a[88:91], a[56:59], v[80:83]
ds_read_b64_tr_b16 a[78:79], v19 offset:39168
v_mfma_f32_16x16x32_bf16 v[144:147], a[96:99], a[56:59], v[144:147]
ds_read_b64_tr_b16 a[80:81], v20 offset:36864
v_mfma_f32_16x16x32_bf16 v[144:147], a[100:103], a[60:63], v[144:147]
ds_read_b64_tr_b16 a[82:83], v20 offset:37120
v_mfma_f32_16x16x32_bf16 v[128:131], a[100:103], a[52:55], v[128:131]
ds_read_b64_tr_b16 a[84:85], v20 offset:38912
v_mfma_f32_16x16x32_bf16 v[128:131], a[96:99], a[48:51], v[128:131]
ds_read_b64_tr_b16 a[86:87], v20 offset:39168
v_mfma_f32_16x16x32_bf16 v[112:115], a[96:99], a[40:43], v[112:115]
s_add_u32 m0, s78, 81920
ds_read_b64_tr_b16 a[88:89], v19 offset:40960
v_mfma_f32_16x16x32_bf16 v[112:115], a[100:103], a[44:47], v[112:115]
s_add_u32 s64, s75, 3932160
ds_read_b64_tr_b16 a[90:91], v19 offset:41216
v_mfma_f32_16x16x32_bf16 v[96:99], a[100:103], a[36:39], v[96:99]
buffer_load_dwordx4 v23, s[60:63], s64 offen lds
v_mfma_f32_16x16x32_bf16 v[96:99], a[96:99], a[32:35], v[96:99]
ds_read_b64_tr_b16 a[92:93], v19 offset:43008
v_mfma_f32_16x16x32_bf16 v[36:39], a[104:107], a[32:35], v[36:39]
ds_read_b64_tr_b16 a[94:95], v19 offset:43264
v_mfma_f32_16x16x32_bf16 v[36:39], a[108:111], a[36:39], v[36:39]
ds_read_b64_tr_b16 a[96:97], v20 offset:40960
v_mfma_f32_16x16x32_bf16 v[52:55], a[108:111], a[44:47], v[52:55]
ds_read_b64_tr_b16 a[98:99], v20 offset:41216
v_mfma_f32_16x16x32_bf16 v[52:55], a[104:107], a[40:43], v[52:55]
ds_read_b64_tr_b16 a[100:101], v20 offset:43008
v_mfma_f32_16x16x32_bf16 v[68:71], a[104:107], a[48:51], v[68:71]
ds_read_b64_tr_b16 a[102:103], v20 offset:43264
v_mfma_f32_16x16x32_bf16 v[68:71], a[108:111], a[52:55], v[68:71]
s_xor_b32 m0, s77, 66560
v_mfma_f32_16x16x32_bf16 v[84:87], a[108:111], a[60:63], v[84:87]
s_xor_b32 s64, s71, 5275648
v_mfma_f32_16x16x32_bf16 v[84:87], a[104:107], a[56:59], v[84:87]
buffer_load_dwordx4 v14, s[56:59], s64 offen lds
v_mfma_f32_16x16x32_bf16 v[148:151], a[112:115], a[56:59], v[148:151]
ds_read_b64_tr_b16 a[104:105], v19 offset:32768
v_mfma_f32_16x16x32_bf16 v[148:151], a[116:119], a[60:63], v[148:151]
ds_read_b64_tr_b16 a[106:107], v19 offset:33024
v_mfma_f32_16x16x32_bf16 v[132:135], a[116:119], a[52:55], v[132:135]
ds_read_b64_tr_b16 a[108:109], v19 offset:34816
v_mfma_f32_16x16x32_bf16 v[132:135], a[112:115], a[48:51], v[132:135]
ds_read_b64_tr_b16 a[110:111], v19 offset:35072
v_mfma_f32_16x16x32_bf16 v[116:119], a[112:115], a[40:43], v[116:119]
v_mfma_f32_16x16x32_bf16 v[116:119], a[116:119], a[44:47], v[116:119]
v_mfma_f32_16x16x32_bf16 v[100:103], a[116:119], a[36:39], v[100:103]
s_add_u32 m0, s78, 86016
v_mfma_f32_16x16x32_bf16 v[100:103], a[112:115], a[32:35], v[100:103]
s_waitcnt lgkmcnt(4)
s_add_u32 s64, s75, 3934208
ds_read_b64_tr_b16 a[112:113], v20 offset:32768
v_mfma_f32_16x16x32_bf16 v[184:187], a[72:75], a[0:3], v[184:187]
buffer_load_dwordx4 v23, s[60:63], s64 offen lds
v_mfma_f32_16x16x32_bf16 v[184:187], a[76:79], a[4:7], v[184:187]
s_add_u32 s65, s79, 27648
ds_read_b64_tr_b16 a[114:115], v20 offset:33024
v_mfma_f32_16x16x32_bf16 v[192:195], a[76:79], a[12:15], v[192:195]
buffer_store_dwordx4 a[208:211], v16, s[44:47], s65 offen sc1
v_mfma_f32_16x16x32_bf16 v[192:195], a[72:75], a[8:11], v[192:195]
s_add_u32 s17, s78, .-L_pc+6144
ds_read_b64_tr_b16 a[116:117], v20 offset:34816
v_mfma_f32_16x16x32_bf16 v[200:203], a[72:75], a[16:19], v[200:203]
buffer_load_dword a252, v16, s[88:91], s17 offen
v_mfma_f32_16x16x32_bf16 v[200:203], a[76:79], a[20:23], v[200:203]
ds_read_b64_tr_b16 a[118:119], v20 offset:35072
v_mfma_f32_16x16x32_bf16 v[208:211], a[76:79], a[28:31], v[208:211]
v_mfma_f32_16x16x32_bf16 v[208:211], a[72:75], a[24:27], v[208:211]
ds_read_b64_tr_b16 a[72:73], v4 offset:32768
v_mfma_f32_16x16x32_bf16 v[212:215], a[80:83], a[24:27], v[212:215]
s_xor_b32 m0, s77, 67584
ds_read_b64_tr_b16 a[74:75], v4 offset:33792
v_mfma_f32_16x16x32_bf16 v[212:215], a[84:87], a[28:31], v[212:215]
s_xor_b32 s64, s71, 5308416
ds_read_b64_tr_b16 a[76:77], v4 offset:40960
v_mfma_f32_16x16x32_bf16 v[204:207], a[84:87], a[20:23], v[204:207]
buffer_load_dwordx4 v15, s[56:59], s64 offen lds
v_mfma_f32_16x16x32_bf16 v[204:207], a[80:83], a[16:19], v[204:207]
ds_read_b64_tr_b16 a[78:79], v4 offset:41984
v_mfma_f32_16x16x32_bf16 v[196:199], a[80:83], a[8:11], v[196:199]
v_mfma_f32_16x16x32_bf16 v[196:199], a[84:87], a[12:15], v[196:199]
v_mfma_f32_16x16x32_bf16 v[188:191], a[84:87], a[4:7], v[188:191]
v_mfma_f32_16x16x32_bf16 v[188:191], a[80:83], a[0:3], v[188:191]
ds_read_b64_tr_b16 a[80:81], v5 offset:32768
v_mfma_f32_16x16x32_bf16 v[216:219], a[0:3], a[88:91], v[216:219]
ds_read_b64_tr_b16 a[82:83], v5 offset:33792
v_mfma_f32_16x16x32_bf16 v[216:219], a[4:7], a[92:95], v[216:219]
s_add_u32 m0, s78, 90112
ds_read_b64_tr_b16 a[84:85], v5 offset:40960
v_mfma_f32_16x16x32_bf16 v[224:227], a[12:15], a[92:95], v[224:227]
s_add_u32 s64, s75, 3936256
ds_read_b64_tr_b16 a[86:87], v5 offset:41984
v_mfma_f32_16x16x32_bf16 v[224:227], a[8:11], a[88:91], v[224:227]
buffer_load_dwordx4 v23, s[60:63], s64 offen lds
v_mfma_f32_16x16x32_bf16 v[232:235], a[16:19], a[88:91], v[232:235]
v_mfma_f32_16x16x32_bf16 v[232:235], a[20:23], a[92:95], v[232:235]
v_mfma_f32_16x16x32_bf16 v[240:243], a[28:31], a[92:95], v[240:243]
v_mfma_f32_16x16x32_bf16 v[240:243], a[24:27], a[88:91], v[240:243]
ds_read_b64_tr_b16 a[88:89], v6 offset:32768
v_mfma_f32_16x16x32_bf16 v[244:247], a[24:27], a[96:99], v[244:247]
ds_read_b64_tr_b16 a[90:91], v6 offset:33792
v_mfma_f32_16x16x32_bf16 v[244:247], a[28:31], a[100:103], v[244:247]
ds_read_b64_tr_b16 a[92:93], v6 offset:40960
v_add_u32 v19, 0x8000, v19
v_mfma_f32_16x16x32_bf16 v[236:239], a[20:23], a[100:103], v[236:239]
s_xor_b32 m0, s77, 68608
ds_read_b64_tr_b16 a[94:95], v6 offset:41984
v_mfma_f32_16x16x32_bf16 v[236:239], a[16:19], a[96:99], v[236:239]
s_xor_b32 s64, s71, 5341184
v_mfma_f32_16x16x32_bf16 v[228:231], a[8:11], a[96:99], v[228:231]
buffer_load_dwordx4 v15, s[56:59], s64 offen lds
v_mfma_f32_16x16x32_bf16 v[228:231], a[12:15], a[100:103], v[228:231]
v_mfma_f32_16x16x32_bf16 v[220:223], a[4:7], a[100:103], v[220:223]
v_mfma_f32_16x16x32_bf16 v[220:223], a[0:3], a[96:99], v[220:223]
s_waitcnt lgkmcnt(4)
ds_read_b64_tr_b16 a[96:97], v7 offset:32768
v_mfma_f32_16x16x32_bf16 v[152:155], a[104:107], a[0:3], v[152:155]
ds_read_b64_tr_b16 a[98:99], v7 offset:33792
v_mfma_f32_16x16x32_bf16 v[152:155], a[108:111], a[4:7], v[152:155]
ds_read_b64_tr_b16 a[100:101], v7 offset:40960
v_add_u32 v20, 0x8000, v20
v_mfma_f32_16x16x32_bf16 v[160:163], a[108:111], a[12:15], v[160:163]
ds_read_b64_tr_b16 a[102:103], v7 offset:41984
v_mfma_f32_16x16x32_bf16 v[160:163], a[104:107], a[8:11], v[160:163]
v_mfma_f32_16x16x32_bf16 v[168:171], a[104:107], a[16:19], v[168:171]
v_mfma_f32_16x16x32_bf16 v[168:171], a[108:111], a[20:23], v[168:171]
v_mfma_f32_16x16x32_bf16 v[176:179], a[108:111], a[28:31], v[176:179]
s_xor_b32 m0, s84, 0
v_mfma_f32_16x16x32_bf16 v[176:179], a[104:107], a[24:27], v[176:179]
s_xor_b32 s64, s72, 1280
ds_read_b64_tr_b16 a[104:105], v8 offset:32768
v_mfma_f32_16x16x32_bf16 v[180:183], a[112:115], a[24:27], v[180:183]
buffer_load_dwordx4 v12, s[48:51], s64 offen lds
v_mfma_f32_16x16x32_bf16 v[180:183], a[116:119], a[28:31], v[180:183]
ds_read_b64_tr_b16 a[106:107], v8 offset:33792
v_add_u32 v4, 0x8000, v4
v_mfma_f32_16x16x32_bf16 v[172:175], a[116:119], a[20:23], v[172:175]
ds_read_b64_tr_b16 a[108:109], v8 offset:40960
v_mfma_f32_16x16x32_bf16 v[172:175], a[112:115], a[16:19], v[172:175]
s_xor_b32 m0, s84, 1024
ds_read_b64_tr_b16 a[110:111], v8 offset:41984
v_mfma_f32_16x16x32_bf16 v[164:167], a[112:115], a[8:11], v[164:167]
s_xor_b32 s64, s72, 17664
v_mfma_f32_16x16x32_bf16 v[164:167], a[116:119], a[12:15], v[164:167]
buffer_load_dwordx4 v13, s[48:51], s64 offen lds
v_mfma_f32_16x16x32_bf16 v[156:159], a[116:119], a[4:7], v[156:159]
v_mfma_f32_16x16x32_bf16 v[156:159], a[112:115], a[0:3], v[156:159]
ds_read_b64_tr_b16 a[112:113], v9 offset:32768
v_mfma_f32_16x16x32_bf16 v[24:27], a[72:75], a[0:3], v[24:27]
s_xor_b32 m0, s84, 2048
ds_read_b64_tr_b16 a[114:115], v9 offset:33792
v_mfma_f32_16x16x32_bf16 v[24:27], a[76:79], a[4:7], v[24:27]
s_xor_b32 s64, s72, 132352
ds_read_b64_tr_b16 a[116:117], v9 offset:40960
v_add_u32 v5, 0x8000, v5
v_mfma_f32_16x16x32_bf16 v[40:43], a[76:79], a[12:15], v[40:43]
buffer_load_dwordx4 v12, s[48:51], s64 offen lds
v_mfma_f32_16x16x32_bf16 v[40:43], a[72:75], a[8:11], v[40:43]
s_add_u32 s65, s79, 11264
ds_read_b64_tr_b16 a[118:119], v9 offset:41984
v_mfma_f32_16x16x32_bf16 v[56:59], a[72:75], a[16:19], v[56:59]
buffer_store_dwordx4 a[212:215], v16, s[44:47], s65 offen sc1
v_mfma_f32_16x16x32_bf16 v[56:59], a[76:79], a[20:23], v[56:59]
s_xor_b32 m0, s84, 3072
v_mfma_f32_16x16x32_bf16 v[72:75], a[76:79], a[28:31], v[72:75]
s_waitcnt vmcnt(13)
s_xor_b32 s64, s72, 148736
ds_read_b128 a[32:35], v2 offset:32768
v_mfma_f32_16x16x32_bf16 v[72:75], a[72:75], a[24:27], v[72:75]
buffer_load_dwordx4 v13, s[48:51], s64 offen lds
v_mfma_f32_16x16x32_bf16 v[136:139], a[80:83], a[24:27], v[136:139]
ds_read_b128 a[36:39], v3 offset:32768
v_mfma_f32_16x16x32_bf16 v[136:139], a[84:87], a[28:31], v[136:139]
ds_read_b128 a[40:43], v2 offset:34816
v_add_u32 v6, 0x8000, v6
v_mfma_f32_16x16x32_bf16 v[120:123], a[84:87], a[20:23], v[120:123]
s_xor_b32 m0, s84, 4096
ds_read_b128 a[44:47], v3 offset:34816
v_mfma_f32_16x16x32_bf16 v[120:123], a[80:83], a[16:19], v[120:123]
s_xor_b32 s64, s73, 1280
ds_read_b128 a[48:51], v2 offset:36864
v_mfma_f32_16x16x32_bf16 v[104:107], a[80:83], a[8:11], v[104:107]
buffer_load_dwordx4 v12, s[48:51], s64 offen lds
v_mfma_f32_16x16x32_bf16 v[104:107], a[84:87], a[12:15], v[104:107]
ds_read_b128 a[52:55], v3 offset:36864
v_mfma_f32_16x16x32_bf16 v[88:91], a[84:87], a[4:7], v[88:91]
ds_read_b128 a[56:59], v2 offset:38912
v_mfma_f32_16x16x32_bf16 v[88:91], a[80:83], a[0:3], v[88:91]
s_waitcnt lgkmcnt(7)
s_xor_b32 m0, s84, 5120
ds_read_b128 a[60:63], v3 offset:38912
v_mfma_f32_16x16x32_bf16 v[28:31], a[88:91], a[0:3], v[28:31]
s_xor_b32 s64, s73, 17664
ds_read_b64_tr_b16 a[72:73], v10 offset:32768
v_mfma_f32_16x16x32_bf16 v[28:31], a[92:95], a[4:7], v[28:31]
buffer_load_dwordx4 v13, s[48:51], s64 offen lds
v_mfma_f32_16x16x32_bf16 v[44:47], a[92:95], a[12:15], v[44:47]
ds_read_b64_tr_b16 a[74:75], v10 offset:33792
v_add_u32 v7, 0x8000, v7
v_mfma_f32_16x16x32_bf16 v[44:47], a[88:91], a[8:11], v[44:47]
ds_read_b64_tr_b16 a[76:77], v10 offset:40960
v_mfma_f32_16x16x32_bf16 v[60:63], a[88:91], a[16:19], v[60:63]
s_xor_b32 m0, s84, 6144
ds_read_b64_tr_b16 a[78:79], v10 offset:41984
v_mfma_f32_16x16x32_bf16 v[60:63], a[92:95], a[20:23], v[60:63]
s_xor_b32 s64, s73, 132352
ds_read_b64_tr_b16 a[80:81], v11 offset:32768
v_mfma_f32_16x16x32_bf16 v[76:79], a[92:95], a[28:31], v[76:79]
buffer_load_dwordx4 v12, s[48:51], s64 offen lds
v_mfma_f32_16x16x32_bf16 v[76:79], a[88:91], a[24:27], v[76:79]
ds_read_b64_tr_b16 a[82:83], v11 offset:33792
v_mfma_f32_16x16x32_bf16 v[140:143], a[96:99], a[24:27], v[140:143]
ds_read_b64_tr_b16 a[84:85], v11 offset:40960
v_mfma_f32_16x16x32_bf16 v[140:143], a[100:103], a[28:31], v[140:143]
s_xor_b32 m0, s84, 7168
ds_read_b64_tr_b16 a[86:87], v11 offset:41984
v_add_u32 v8, 0x8000, v8
v_mfma_f32_16x16x32_bf16 v[124:127], a[100:103], a[20:23], v[124:127]
s_xor_b32 s64, s73, 148736
v_mfma_f32_16x16x32_bf16 v[124:127], a[96:99], a[16:19], v[124:127]
buffer_load_dwordx4 v13, s[48:51], s64 offen lds
v_mfma_f32_16x16x32_bf16 v[108:111], a[96:99], a[8:11], v[108:111]
v_mfma_f32_16x16x32_bf16 v[108:111], a[100:103], a[12:15], v[108:111]
v_mfma_f32_16x16x32_bf16 v[92:95], a[100:103], a[4:7], v[92:95]
v_add_u32 v9, 0x8000, v9
v_add_u32 v10, 0x8000, v10
v_mfma_f32_16x16x32_bf16 v[92:95], a[96:99], a[0:3], v[92:95]
v_add_u32 v11, 0x8000, v11
v_mfma_f32_16x16x32_bf16 v[32:35], a[104:107], a[0:3], v[32:35]
v_mfma_f32_16x16x32_bf16 v[32:35], a[108:111], a[4:7], v[32:35]
v_mfma_f32_16x16x32_bf16 v[48:51], a[108:111], a[12:15], v[48:51]
s_waitcnt lgkmcnt(0)
s_barrier
v_mfma_f32_16x16x32_bf16 v[48:51], a[104:107], a[8:11], v[48:51]
s_xor_b32 m0, s77, 98304
ds_read_b64_tr_b16 a[88:89], v19 offset:36864
v_mfma_f32_16x16x32_bf16 v[64:67], a[104:107], a[16:19], v[64:67]
s_xor_b32 s64, s71, 5767168
ds_read_b64_tr_b16 a[90:91], v19 offset:37120
v_mfma_f32_16x16x32_bf16 v[64:67], a[108:111], a[20:23], v[64:67]
buffer_load_dwordx4 v14, s[56:59], s64 offen lds
v_mfma_f32_16x16x32_bf16 v[80:83], a[108:111], a[28:31], v[80:83]
ds_read_b64_tr_b16 a[92:93], v19 offset:38912
v_mfma_f32_16x16x32_bf16 v[80:83], a[104:107], a[24:27], v[80:83]
ds_read_b64_tr_b16 a[94:95], v19 offset:39168
v_mfma_f32_16x16x32_bf16 v[144:147], a[112:115], a[24:27], v[144:147]
ds_read_b64_tr_b16 a[96:97], v20 offset:36864
v_mfma_f32_16x16x32_bf16 v[144:147], a[116:119], a[28:31], v[144:147]
ds_read_b64_tr_b16 a[98:99], v20 offset:37120
v_mfma_f32_16x16x32_bf16 v[128:131], a[116:119], a[20:23], v[128:131]
ds_read_b64_tr_b16 a[100:101], v20 offset:38912
v_mfma_f32_16x16x32_bf16 v[128:131], a[112:115], a[16:19], v[128:131]
ds_read_b64_tr_b16 a[102:103], v20 offset:39168
v_mfma_f32_16x16x32_bf16 v[112:115], a[112:115], a[8:11], v[112:115]
s_add_u32 m0, s78, 114688
ds_read_b64_tr_b16 a[104:105], v19 offset:40960
v_mfma_f32_16x16x32_bf16 v[112:115], a[116:119], a[12:15], v[112:115]
s_add_u32 s64, s75, 4325376
ds_read_b64_tr_b16 a[106:107], v19 offset:41216
v_mfma_f32_16x16x32_bf16 v[96:99], a[116:119], a[4:7], v[96:99]
buffer_load_dwordx4 v23, s[60:63], s64 offen lds
v_mfma_f32_16x16x32_bf16 v[96:99], a[112:115], a[0:3], v[96:99]
ds_read_b64_tr_b16 a[108:109], v19 offset:43008
v_mfma_f32_16x16x32_bf16 v[36:39], a[72:75], a[0:3], v[36:39]
ds_read_b64_tr_b16 a[110:111], v19 offset:43264
v_mfma_f32_16x16x32_bf16 v[36:39], a[76:79], a[4:7], v[36:39]
ds_read_b64_tr_b16 a[112:113], v20 offset:40960
v_mfma_f32_16x16x32_bf16 v[52:55], a[76:79], a[12:15], v[52:55]
ds_read_b64_tr_b16 a[114:115], v20 offset:41216
v_mfma_f32_16x16x32_bf16 v[52:55], a[72:75], a[8:11], v[52:55]
ds_read_b64_tr_b16 a[116:117], v20 offset:43008
v_mfma_f32_16x16x32_bf16 v[68:71], a[72:75], a[16:19], v[68:71]
s_add_u32 s65, s79, 28672
ds_read_b64_tr_b16 a[118:119], v20 offset:43264
v_mfma_f32_16x16x32_bf16 v[68:71], a[76:79], a[20:23], v[68:71]
s_xor_b32 m0, s77, 99328
buffer_store_dwordx4 a[216:219], v16, s[44:47], s65 offen sc1
v_mfma_f32_16x16x32_bf16 v[84:87], a[76:79], a[28:31], v[84:87]
s_xor_b32 s64, s71, 5799936
v_mfma_f32_16x16x32_bf16 v[84:87], a[72:75], a[24:27], v[84:87]
buffer_load_dwordx4 v14, s[56:59], s64 offen lds
v_mfma_f32_16x16x32_bf16 v[148:151], a[80:83], a[24:27], v[148:151]
ds_read_b64_tr_b16 a[72:73], v19 offset:32768
v_mfma_f32_16x16x32_bf16 v[148:151], a[84:87], a[28:31], v[148:151]
ds_read_b64_tr_b16 a[74:75], v19 offset:33024
v_mfma_f32_16x16x32_bf16 v[132:135], a[84:87], a[20:23], v[132:135]
ds_read_b64_tr_b16 a[76:77], v19 offset:34816
v_mfma_f32_16x16x32_bf16 v[132:135], a[80:83], a[16:19], v[132:135]
ds_read_b64_tr_b16 a[78:79], v19 offset:35072
v_mfma_f32_16x16x32_bf16 v[116:119], a[80:83], a[8:11], v[116:119]
v_mfma_f32_16x16x32_bf16 v[116:119], a[84:87], a[12:15], v[116:119]
v_mfma_f32_16x16x32_bf16 v[100:103], a[84:87], a[4:7], v[100:103]
s_add_u32 m0, s78, 118784
v_mfma_f32_16x16x32_bf16 v[100:103], a[80:83], a[0:3], v[100:103]
s_waitcnt lgkmcnt(4)
s_add_u32 s64, s75, 4327424
ds_read_b64_tr_b16 a[80:81], v20 offset:32768
v_mfma_f32_16x16x32_bf16 v[184:187], a[88:91], a[32:35], v[184:187]
buffer_load_dwordx4 v23, s[60:63], s64 offen lds
v_mfma_f32_16x16x32_bf16 v[184:187], a[92:95], a[36:39], v[184:187]
ds_read_b64_tr_b16 a[82:83], v20 offset:33024
v_mfma_f32_16x16x32_bf16 v[192:195], a[92:95], a[44:47], v[192:195]
ds_read_b64_tr_b16 a[84:85], v20 offset:34816
v_mfma_f32_16x16x32_bf16 v[192:195], a[88:91], a[40:43], v[192:195]
ds_read_b64_tr_b16 a[86:87], v20 offset:35072
v_mfma_f32_16x16x32_bf16 v[200:203], a[88:91], a[48:51], v[200:203]
s_cmp_eq_u32 s30, 0
s_cselect_b32 s81, 256, 0
v_mfma_f32_16x16x32_bf16 v[200:203], a[92:95], a[52:55], v[200:203]
v_mfma_f32_16x16x32_bf16 v[208:211], a[92:95], a[60:63], v[208:211]
v_mfma_f32_16x16x32_bf16 v[208:211], a[88:91], a[56:59], v[208:211]
ds_read_b64_tr_b16 a[88:89], v4 offset:32768
v_mfma_f32_16x16x32_bf16 v[212:215], a[96:99], a[56:59], v[212:215]
s_xor_b32 m0, s77, 100352
ds_read_b64_tr_b16 a[90:91], v4 offset:33792
v_mfma_f32_16x16x32_bf16 v[212:215], a[100:103], a[60:63], v[212:215]
s_xor_b32 s64, s71, 5832704
ds_read_b64_tr_b16 a[92:93], v4 offset:40960
v_mfma_f32_16x16x32_bf16 v[204:207], a[100:103], a[52:55], v[204:207]
buffer_load_dwordx4 v15, s[56:59], s64 offen lds
v_mfma_f32_16x16x32_bf16 v[204:207], a[96:99], a[48:51], v[204:207]
ds_read_b64_tr_b16 a[94:95], v4 offset:41984
v_mfma_f32_16x16x32_bf16 v[196:199], a[96:99], a[40:43], v[196:199]
v_mfma_f32_16x16x32_bf16 v[196:199], a[100:103], a[44:47], v[196:199]
v_mfma_f32_16x16x32_bf16 v[188:191], a[100:103], a[36:39], v[188:191]
v_mfma_f32_16x16x32_bf16 v[188:191], a[96:99], a[32:35], v[188:191]
ds_read_b64_tr_b16 a[96:97], v5 offset:32768
v_mfma_f32_16x16x32_bf16 v[216:219], a[32:35], a[104:107], v[216:219]
ds_read_b64_tr_b16 a[98:99], v5 offset:33792
v_mfma_f32_16x16x32_bf16 v[216:219], a[36:39], a[108:111], v[216:219]
s_add_u32 m0, s78, 122880
ds_read_b64_tr_b16 a[100:101], v5 offset:40960
v_mfma_f32_16x16x32_bf16 v[224:227], a[44:47], a[108:111], v[224:227]
s_add_u32 s64, s75, 4329472
ds_read_b64_tr_b16 a[102:103], v5 offset:41984
v_mfma_f32_16x16x32_bf16 v[224:227], a[40:43], a[104:107], v[224:227]
buffer_load_dwordx4 v23, s[60:63], s64 offen lds
v_mfma_f32_16x16x32_bf16 v[232:235], a[48:51], a[104:107], v[232:235]
v_mfma_f32_16x16x32_bf16 v[232:235], a[52:55], a[108:111], v[232:235]
v_mfma_f32_16x16x32_bf16 v[240:243], a[60:63], a[108:111], v[240:243]
v_mfma_f32_16x16x32_bf16 v[240:243], a[56:59], a[104:107], v[240:243]
ds_read_b64_tr_b16 a[104:105], v6 offset:32768
v_mfma_f32_16x16x32_bf16 v[244:247], a[56:59], a[112:115], v[244:247]
ds_read_b64_tr_b16 a[106:107], v6 offset:33792
v_mfma_f32_16x16x32_bf16 v[244:247], a[60:63], a[116:119], v[244:247]
ds_read_b64_tr_b16 a[108:109], v6 offset:40960
v_subrev_u32 v19, 0x8000, v19
v_mfma_f32_16x16x32_bf16 v[236:239], a[52:55], a[116:119], v[236:239]
s_xor_b32 m0, s77, 101376
ds_read_b64_tr_b16 a[110:111], v6 offset:41984
v_mfma_f32_16x16x32_bf16 v[236:239], a[48:51], a[112:115], v[236:239]
s_xor_b32 s64, s71, 5865472
v_mfma_f32_16x16x32_bf16 v[228:231], a[40:43], a[112:115], v[228:231]
buffer_load_dwordx4 v15, s[56:59], s64 offen lds
v_mfma_f32_16x16x32_bf16 v[228:231], a[44:47], a[116:119], v[228:231]
v_mfma_f32_16x16x32_bf16 v[220:223], a[36:39], a[116:119], v[220:223]
v_mfma_f32_16x16x32_bf16 v[220:223], a[32:35], a[112:115], v[220:223]
s_waitcnt lgkmcnt(4)
ds_read_b64_tr_b16 a[112:113], v7 offset:32768
v_mfma_f32_16x16x32_bf16 v[152:155], a[72:75], a[32:35], v[152:155]
ds_read_b64_tr_b16 a[114:115], v7 offset:33792
v_mfma_f32_16x16x32_bf16 v[152:155], a[76:79], a[36:39], v[152:155]
ds_read_b64_tr_b16 a[116:117], v7 offset:40960
v_subrev_u32 v20, 0x8000, v20
v_mfma_f32_16x16x32_bf16 v[160:163], a[76:79], a[44:47], v[160:163]
ds_read_b64_tr_b16 a[118:119], v7 offset:41984
v_mfma_f32_16x16x32_bf16 v[160:163], a[72:75], a[40:43], v[160:163]
v_mfma_f32_16x16x32_bf16 v[168:171], a[72:75], a[48:51], v[168:171]
v_mfma_f32_16x16x32_bf16 v[168:171], a[76:79], a[52:55], v[168:171]
s_add_u32 s65, s79, 29696
v_mfma_f32_16x16x32_bf16 v[176:179], a[76:79], a[60:63], v[176:179]
s_xor_b32 m0, s84, 32768
buffer_store_dwordx4 a[220:223], v16, s[44:47], s65 offen sc1
v_mfma_f32_16x16x32_bf16 v[176:179], a[72:75], a[56:59], v[176:179]
s_xor_b32 s64, s72, 1408
ds_read_b64_tr_b16 a[72:73], v8 offset:32768
v_mfma_f32_16x16x32_bf16 v[180:183], a[80:83], a[56:59], v[180:183]
buffer_load_dwordx4 v12, s[48:51], s64 offen lds
v_mfma_f32_16x16x32_bf16 v[180:183], a[84:87], a[60:63], v[180:183]
ds_read_b64_tr_b16 a[74:75], v8 offset:33792
v_subrev_u32 v4, 0x8000, v4
v_mfma_f32_16x16x32_bf16 v[172:175], a[84:87], a[52:55], v[172:175]
ds_read_b64_tr_b16 a[76:77], v8 offset:40960
v_mfma_f32_16x16x32_bf16 v[172:175], a[80:83], a[48:51], v[172:175]
s_xor_b32 m0, s84, 33792
ds_read_b64_tr_b16 a[78:79], v8 offset:41984
v_mfma_f32_16x16x32_bf16 v[164:167], a[80:83], a[40:43], v[164:167]
s_xor_b32 s64, s72, 17792
v_mfma_f32_16x16x32_bf16 v[164:167], a[84:87], a[44:47], v[164:167]
buffer_load_dwordx4 v13, s[48:51], s64 offen lds
v_mfma_f32_16x16x32_bf16 v[156:159], a[84:87], a[36:39], v[156:159]
v_mfma_f32_16x16x32_bf16 v[156:159], a[80:83], a[32:35], v[156:159]
ds_read_b64_tr_b16 a[80:81], v9 offset:32768
v_mfma_f32_16x16x32_bf16 v[24:27], a[88:91], a[32:35], v[24:27]
s_xor_b32 m0, s84, 34816
ds_read_b64_tr_b16 a[82:83], v9 offset:33792
v_mfma_f32_16x16x32_bf16 v[24:27], a[92:95], a[36:39], v[24:27]
s_xor_b32 s64, s72, 132480
ds_read_b64_tr_b16 a[84:85], v9 offset:40960
v_subrev_u32 v5, 0x8000, v5
v_mfma_f32_16x16x32_bf16 v[40:43], a[92:95], a[44:47], v[40:43]
buffer_load_dwordx4 v12, s[48:51], s64 offen lds
v_mfma_f32_16x16x32_bf16 v[40:43], a[88:91], a[40:43], v[40:43]
ds_read_b64_tr_b16 a[86:87], v9 offset:41984
v_mfma_f32_16x16x32_bf16 v[56:59], a[88:91], a[48:51], v[56:59]
v_mfma_f32_16x16x32_bf16 v[56:59], a[92:95], a[52:55], v[56:59]
s_xor_b32 m0, s84, 35840
v_mfma_f32_16x16x32_bf16 v[72:75], a[92:95], a[60:63], v[72:75]
s_waitcnt vmcnt(12)
s_xor_b32 s64, s72, 148864
ds_read_b128 a[0:3], v2 offset:0
v_mfma_f32_16x16x32_bf16 v[72:75], a[88:91], a[56:59], v[72:75]
buffer_load_dwordx4 v13, s[48:51], s64 offen lds
v_mfma_f32_16x16x32_bf16 v[136:139], a[96:99], a[56:59], v[136:139]
ds_read_b128 a[4:7], v3 offset:0
v_mfma_f32_16x16x32_bf16 v[136:139], a[100:103], a[60:63], v[136:139]
ds_read_b128 a[8:11], v2 offset:2048
v_subrev_u32 v6, 0x8000, v6
v_mfma_f32_16x16x32_bf16 v[120:123], a[100:103], a[52:55], v[120:123]
s_xor_b32 m0, s84, 36864
ds_read_b128 a[12:15], v3 offset:2048
v_mfma_f32_16x16x32_bf16 v[120:123], a[96:99], a[48:51], v[120:123]
s_xor_b32 s64, s73, 1408
ds_read_b128 a[16:19], v2 offset:4096
v_mfma_f32_16x16x32_bf16 v[104:107], a[96:99], a[40:43], v[104:107]
buffer_load_dwordx4 v12, s[48:51], s64 offen lds
v_mfma_f32_16x16x32_bf16 v[104:107], a[100:103], a[44:47], v[104:107]
ds_read_b128 a[20:23], v3 offset:4096
v_mfma_f32_16x16x32_bf16 v[88:91], a[100:103], a[36:39], v[88:91]
ds_read_b128 a[24:27], v2 offset:6144
v_mfma_f32_16x16x32_bf16 v[88:91], a[96:99], a[32:35], v[88:91]
s_waitcnt lgkmcnt(7)
s_xor_b32 m0, s84, 37888
ds_read_b128 a[28:31], v3 offset:6144
v_mfma_f32_16x16x32_bf16 v[28:31], a[104:107], a[32:35], v[28:31]
s_xor_b32 s64, s73, 17792
ds_read_b64_tr_b16 a[88:89], v10 offset:32768
v_mfma_f32_16x16x32_bf16 v[28:31], a[108:111], a[36:39], v[28:31]
buffer_load_dwordx4 v13, s[48:51], s64 offen lds
v_mfma_f32_16x16x32_bf16 v[44:47], a[108:111], a[44:47], v[44:47]
ds_read_b64_tr_b16 a[90:91], v10 offset:33792
v_subrev_u32 v7, 0x8000, v7
v_mfma_f32_16x16x32_bf16 v[44:47], a[104:107], a[40:43], v[44:47]
ds_read_b64_tr_b16 a[92:93], v10 offset:40960
v_mfma_f32_16x16x32_bf16 v[60:63], a[104:107], a[48:51], v[60:63]
s_xor_b32 m0, s84, 38912
buffer_load_dword v1, off, s[52:55], s78 sc1
v_mfma_f32_16x16x32_bf16 v[60:63], a[108:111], a[52:55], v[60:63]
s_xor_b32 s64, s73, 132480
ds_read_b64_tr_b16 a[94:95], v10 offset:41984
v_mfma_f32_16x16x32_bf16 v[76:79], a[108:111], a[60:63], v[76:79]
buffer_load_dwordx4 v12, s[48:51], s64 offen lds
v_mfma_f32_16x16x32_bf16 v[76:79], a[104:107], a[56:59], v[76:79]
ds_read_b64_tr_b16 a[96:97], v11 offset:32768
v_mfma_f32_16x16x32_bf16 v[140:143], a[112:115], a[56:59], v[140:143]
ds_read_b64_tr_b16 a[98:99], v11 offset:33792
v_mfma_f32_16x16x32_bf16 v[140:143], a[116:119], a[60:63], v[140:143]
s_xor_b32 m0, s84, 39936
ds_read_b64_tr_b16 a[100:101], v11 offset:40960
v_subrev_u32 v8, 0x8000, v8
v_mfma_f32_16x16x32_bf16 v[124:127], a[116:119], a[52:55], v[124:127]
s_xor_b32 s64, s73, 148864
ds_read_b64_tr_b16 a[102:103], v11 offset:41984
v_mfma_f32_16x16x32_bf16 v[124:127], a[112:115], a[48:51], v[124:127]
buffer_load_dwordx4 v13, s[48:51], s64 offen lds
v_mfma_f32_16x16x32_bf16 v[108:111], a[112:115], a[40:43], v[108:111]
v_mfma_f32_16x16x32_bf16 v[108:111], a[116:119], a[44:47], v[108:111]
v_mfma_f32_16x16x32_bf16 v[92:95], a[116:119], a[36:39], v[92:95]
v_subrev_u32 v9, 0x8000, v9
v_subrev_u32 v10, 0x8000, v10
v_mfma_f32_16x16x32_bf16 v[92:95], a[112:115], a[32:35], v[92:95]
v_subrev_u32 v11, 0x8000, v11
v_mfma_f32_16x16x32_bf16 v[32:35], a[72:75], a[32:35], v[32:35]
v_mfma_f32_16x16x32_bf16 v[32:35], a[76:79], a[36:39], v[32:35]
v_mfma_f32_16x16x32_bf16 v[48:51], a[76:79], a[44:47], v[48:51]
s_waitcnt lgkmcnt(0)
s_barrier
v_mfma_f32_16x16x32_bf16 v[48:51], a[72:75], a[40:43], v[48:51]
s_xor_b32 m0, s77, 131072
ds_read_b64_tr_b16 a[104:105], v19 offset:4096
v_mfma_f32_16x16x32_bf16 v[64:67], a[72:75], a[48:51], v[64:67]
s_xor_b32 s64, s71, 6291456
ds_read_b64_tr_b16 a[106:107], v19 offset:4352
v_mfma_f32_16x16x32_bf16 v[64:67], a[76:79], a[52:55], v[64:67]
buffer_load_dwordx4 v14, s[56:59], s64 offen lds
v_mfma_f32_16x16x32_bf16 v[80:83], a[76:79], a[60:63], v[80:83]
ds_read_b64_tr_b16 a[108:109], v19 offset:6144
v_mfma_f32_16x16x32_bf16 v[80:83], a[72:75], a[56:59], v[80:83]
s_add_u32 s65, s79, 13312
ds_read_b64_tr_b16 a[110:111], v19 offset:6400
v_mfma_f32_16x16x32_bf16 v[144:147], a[80:83], a[56:59], v[144:147]
buffer_store_dwordx4 a[224:227], v16, s[44:47], s65 offen sc1
v_mfma_f32_16x16x32_bf16 v[144:147], a[84:87], a[60:63], v[144:147]
ds_read_b64_tr_b16 a[112:113], v20 offset:4096
v_mfma_f32_16x16x32_bf16 v[128:131], a[84:87], a[52:55], v[128:131]
ds_read_b64_tr_b16 a[114:115], v20 offset:4352
v_mfma_f32_16x16x32_bf16 v[128:131], a[80:83], a[48:51], v[128:131]
ds_read_b64_tr_b16 a[116:117], v20 offset:6144
v_mfma_f32_16x16x32_bf16 v[112:115], a[80:83], a[40:43], v[112:115]
s_add_u32 m0, s78, 147456
ds_read_b64_tr_b16 a[118:119], v20 offset:6400
v_mfma_f32_16x16x32_bf16 v[112:115], a[84:87], a[44:47], v[112:115]
s_add_u32 s64, s75, 4718592
ds_read_b64_tr_b16 a[72:73], v19 offset:8192
v_mfma_f32_16x16x32_bf16 v[96:99], a[84:87], a[36:39], v[96:99]
buffer_load_dwordx4 v23, s[60:63], s64 offen lds
v_mfma_f32_16x16x32_bf16 v[96:99], a[80:83], a[32:35], v[96:99]
ds_read_b64_tr_b16 a[74:75], v19 offset:8448
v_mfma_f32_16x16x32_bf16 v[36:39], a[88:91], a[32:35], v[36:39]
ds_read_b64_tr_b16 a[76:77], v19 offset:10240
v_mfma_f32_16x16x32_bf16 v[36:39], a[92:95], a[36:39], v[36:39]
ds_read_b64_tr_b16 a[78:79], v19 offset:10496
v_mfma_f32_16x16x32_bf16 v[52:55], a[92:95], a[44:47], v[52:55]
ds_read_b64_tr_b16 a[80:81], v20 offset:8192
v_mfma_f32_16x16x32_bf16 v[52:55], a[88:91], a[40:43], v[52:55]
ds_read_b64_tr_b16 a[82:83], v20 offset:8448
v_mfma_f32_16x16x32_bf16 v[68:71], a[88:91], a[48:51], v[68:71]
ds_read_b64_tr_b16 a[84:85], v20 offset:10240
v_mfma_f32_16x16x32_bf16 v[68:71], a[92:95], a[52:55], v[68:71]
s_xor_b32 m0, s77, 132096
ds_read_b64_tr_b16 a[86:87], v20 offset:10496
v_mfma_f32_16x16x32_bf16 v[84:87], a[92:95], a[60:63], v[84:87]
s_xor_b32 s64, s71, 6324224
v_mfma_f32_16x16x32_bf16 v[84:87], a[88:91], a[56:59], v[84:87]
buffer_load_dwordx4 v14, s[56:59], s64 offen lds
v_mfma_f32_16x16x32_bf16 v[148:151], a[96:99], a[56:59], v[148:151]
ds_read_b64_tr_b16 a[88:89], v19 offset:0
v_mfma_f32_16x16x32_bf16 v[148:151], a[100:103], a[60:63], v[148:151]
ds_read_b64_tr_b16 a[90:91], v19 offset:256
v_mfma_f32_16x16x32_bf16 v[132:135], a[100:103], a[52:55], v[132:135]
ds_read_b64_tr_b16 a[92:93], v19 offset:2048
v_mfma_f32_16x16x32_bf16 v[132:135], a[96:99], a[48:51], v[132:135]
ds_read_b64_tr_b16 a[94:95], v19 offset:2304
v_mfma_f32_16x16x32_bf16 v[116:119], a[96:99], a[40:43], v[116:119]
v_mfma_f32_16x16x32_bf16 v[116:119], a[100:103], a[44:47], v[116:119]
v_mfma_f32_16x16x32_bf16 v[100:103], a[100:103], a[36:39], v[100:103]
s_add_u32 m0, s78, 151552
v_mfma_f32_16x16x32_bf16 v[100:103], a[96:99], a[32:35], v[100:103]
s_waitcnt lgkmcnt(4)
s_add_u32 s64, s75, 4720640
ds_read_b64_tr_b16 a[96:97], v20 offset:0
v_mfma_f32_16x16x32_bf16 v[184:187], a[104:107], a[0:3], v[184:187]
buffer_load_dwordx4 v23, s[60:63], s64 offen lds
v_mfma_f32_16x16x32_bf16 v[184:187], a[108:111], a[4:7], v[184:187]
ds_read_b64_tr_b16 a[98:99], v20 offset:256
v_mfma_f32_16x16x32_bf16 v[192:195], a[108:111], a[12:15], v[192:195]
ds_read_b64_tr_b16 a[100:101], v20 offset:2048
v_mfma_f32_16x16x32_bf16 v[192:195], a[104:107], a[8:11], v[192:195]
s_add_u32 s17, s78, .-L_pc+6144
ds_read_b64_tr_b16 a[102:103], v20 offset:2304
v_mfma_f32_16x16x32_bf16 v[200:203], a[104:107], a[16:19], v[200:203]
buffer_load_dword a252, v16, s[88:91], s17 offen
v_mfma_f32_16x16x32_bf16 v[200:203], a[108:111], a[20:23], v[200:203]
v_mfma_f32_16x16x32_bf16 v[208:211], a[108:111], a[28:31], v[208:211]
v_mfma_f32_16x16x32_bf16 v[208:211], a[104:107], a[24:27], v[208:211]
ds_read_b64_tr_b16 a[104:105], v4 offset:0
v_mfma_f32_16x16x32_bf16 v[212:215], a[112:115], a[24:27], v[212:215]
s_xor_b32 m0, s77, 133120
ds_read_b64_tr_b16 a[106:107], v4 offset:1024
v_mfma_f32_16x16x32_bf16 v[212:215], a[116:119], a[28:31], v[212:215]
s_xor_b32 s64, s71, 6356992
ds_read_b64_tr_b16 a[108:109], v4 offset:8192
v_mfma_f32_16x16x32_bf16 v[204:207], a[116:119], a[20:23], v[204:207]
buffer_load_dwordx4 v15, s[56:59], s64 offen lds
v_mfma_f32_16x16x32_bf16 v[204:207], a[112:115], a[16:19], v[204:207]
ds_read_b64_tr_b16 a[110:111], v4 offset:9216
v_mfma_f32_16x16x32_bf16 v[196:199], a[112:115], a[8:11], v[196:199]
v_mfma_f32_16x16x32_bf16 v[196:199], a[116:119], a[12:15], v[196:199]
v_mfma_f32_16x16x32_bf16 v[188:191], a[116:119], a[4:7], v[188:191]
v_mfma_f32_16x16x32_bf16 v[188:191], a[112:115], a[0:3], v[188:191]
ds_read_b64_tr_b16 a[112:113], v5 offset:0
v_mfma_f32_16x16x32_bf16 v[216:219], a[0:3], a[72:75], v[216:219]
ds_read_b64_tr_b16 a[114:115], v5 offset:1024
v_mfma_f32_16x16x32_bf16 v[216:219], a[4:7], a[76:79], v[216:219]
s_add_u32 m0, s78, 155648
ds_read_b64_tr_b16 a[116:117], v5 offset:8192
v_mfma_f32_16x16x32_bf16 v[224:227], a[12:15], a[76:79], v[224:227]
s_add_u32 s64, s75, 4722688
ds_read_b64_tr_b16 a[118:119], v5 offset:9216
v_mfma_f32_16x16x32_bf16 v[224:227], a[8:11], a[72:75], v[224:227]
buffer_load_dwordx4 v23, s[60:63], s64 offen lds
v_mfma_f32_16x16x32_bf16 v[232:235], a[16:19], a[72:75], v[232:235]
v_mfma_f32_16x16x32_bf16 v[232:235], a[20:23], a[76:79], v[232:235]
v_mfma_f32_16x16x32_bf16 v[240:243], a[28:31], a[76:79], v[240:243]
v_mfma_f32_16x16x32_bf16 v[240:243], a[24:27], a[72:75], v[240:243]
ds_read_b64_tr_b16 a[72:73], v6 offset:0
v_mfma_f32_16x16x32_bf16 v[244:247], a[24:27], a[80:83], v[244:247]
s_add_u32 s65, s79, 30720
ds_read_b64_tr_b16 a[74:75], v6 offset:1024
v_mfma_f32_16x16x32_bf16 v[244:247], a[28:31], a[84:87], v[244:247]
buffer_store_dwordx4 a[228:231], v16, s[44:47], s65 offen sc1
v_mfma_f32_16x16x32_bf16 v[236:239], a[20:23], a[84:87], v[236:239]
s_xor_b32 m0, s77, 134144
ds_read_b64_tr_b16 a[76:77], v6 offset:8192
v_mfma_f32_16x16x32_bf16 v[236:239], a[16:19], a[80:83], v[236:239]
s_xor_b32 s64, s71, 6389760
ds_read_b64_tr_b16 a[78:79], v6 offset:9216
v_mfma_f32_16x16x32_bf16 v[228:231], a[8:11], a[80:83], v[228:231]
buffer_load_dwordx4 v15, s[56:59], s64 offen lds
v_mfma_f32_16x16x32_bf16 v[228:231], a[12:15], a[84:87], v[228:231]
v_mfma_f32_16x16x32_bf16 v[220:223], a[4:7], a[84:87], v[220:223]
v_mfma_f32_16x16x32_bf16 v[220:223], a[0:3], a[80:83], v[220:223]
s_waitcnt lgkmcnt(4)
ds_read_b64_tr_b16 a[80:81], v7 offset:0
v_mfma_f32_16x16x32_bf16 v[152:155], a[88:91], a[0:3], v[152:155]
ds_read_b64_tr_b16 a[82:83], v7 offset:1024
v_mfma_f32_16x16x32_bf16 v[152:155], a[92:95], a[4:7], v[152:155]
ds_read_b64_tr_b16 a[84:85], v7 offset:8192
v_mfma_f32_16x16x32_bf16 v[160:163], a[92:95], a[12:15], v[160:163]
ds_read_b64_tr_b16 a[86:87], v7 offset:9216
v_mfma_f32_16x16x32_bf16 v[160:163], a[88:91], a[8:11], v[160:163]
v_mfma_f32_16x16x32_bf16 v[168:171], a[88:91], a[16:19], v[168:171]
v_mfma_f32_16x16x32_bf16 v[168:171], a[92:95], a[20:23], v[168:171]
v_mfma_f32_16x16x32_bf16 v[176:179], a[92:95], a[28:31], v[176:179]
s_xor_b32 m0, s84, 0
v_mfma_f32_16x16x32_bf16 v[176:179], a[88:91], a[24:27], v[176:179]
s_xor_b32 s64, s72, 1536
ds_read_b64_tr_b16 a[88:89], v8 offset:0
v_mfma_f32_16x16x32_bf16 v[180:183], a[96:99], a[24:27], v[180:183]
buffer_load_dwordx4 v12, s[48:51], s64 offen lds
v_mfma_f32_16x16x32_bf16 v[180:183], a[100:103], a[28:31], v[180:183]
ds_read_b64_tr_b16 a[90:91], v8 offset:1024
v_mfma_f32_16x16x32_bf16 v[172:175], a[100:103], a[20:23], v[172:175]
ds_read_b64_tr_b16 a[92:93], v8 offset:8192
v_mfma_f32_16x16x32_bf16 v[172:175], a[96:99], a[16:19], v[172:175]
s_xor_b32 m0, s84, 1024
ds_read_b64_tr_b16 a[94:95], v8 offset:9216
v_mfma_f32_16x16x32_bf16 v[164:167], a[96:99], a[8:11], v[164:167]
s_xor_b32 s64, s72, 17920
v_mfma_f32_16x16x32_bf16 v[164:167], a[100:103], a[12:15], v[164:167]
buffer_load_dwordx4 v13, s[48:51], s64 offen lds
v_mfma_f32_16x16x32_bf16 v[156:159], a[100:103], a[4:7], v[156:159]
v_mfma_f32_16x16x32_bf16 v[156:159], a[96:99], a[0:3], v[156:159]
ds_read_b64_tr_b16 a[96:97], v9 offset:0
v_mfma_f32_16x16x32_bf16 v[24:27], a[104:107], a[0:3], v[24:27]
s_xor_b32 m0, s84, 2048
ds_read_b64_tr_b16 a[98:99], v9 offset:1024
v_mfma_f32_16x16x32_bf16 v[24:27], a[108:111], a[4:7], v[24:27]
s_xor_b32 s64, s72, 132608
ds_read_b64_tr_b16 a[100:101], v9 offset:8192
v_mfma_f32_16x16x32_bf16 v[40:43], a[108:111], a[12:15], v[40:43]
buffer_load_dwordx4 v12, s[48:51], s64 offen lds
v_mfma_f32_16x16x32_bf16 v[40:43], a[104:107], a[8:11], v[40:43]
ds_read_b64_tr_b16 a[102:103], v9 offset:9216
v_mfma_f32_16x16x32_bf16 v[56:59], a[104:107], a[16:19], v[56:59]
v_mfma_f32_16x16x32_bf16 v[56:59], a[108:111], a[20:23], v[56:59]
s_xor_b32 m0, s84, 3072
v_mfma_f32_16x16x32_bf16 v[72:75], a[108:111], a[28:31], v[72:75]
s_waitcnt vmcnt(13)
s_xor_b32 s64, s72, 148992
ds_read_b128 a[32:35], v2 offset:32768
v_mfma_f32_16x16x32_bf16 v[72:75], a[104:107], a[24:27], v[72:75]
buffer_load_dwordx4 v13, s[48:51], s64 offen lds
v_mfma_f32_16x16x32_bf16 v[136:139], a[112:115], a[24:27], v[136:139]
ds_read_b128 a[36:39], v3 offset:32768
v_mfma_f32_16x16x32_bf16 v[136:139], a[116:119], a[28:31], v[136:139]
ds_read_b128 a[40:43], v2 offset:34816
v_mfma_f32_16x16x32_bf16 v[120:123], a[116:119], a[20:23], v[120:123]
s_xor_b32 m0, s84, 4096
ds_read_b128 a[44:47], v3 offset:34816
v_mfma_f32_16x16x32_bf16 v[120:123], a[112:115], a[16:19], v[120:123]
s_xor_b32 s64, s73, 1536
ds_read_b128 a[48:51], v2 offset:36864
v_mfma_f32_16x16x32_bf16 v[104:107], a[112:115], a[8:11], v[104:107]
buffer_load_dwordx4 v12, s[48:51], s64 offen lds
v_mfma_f32_16x16x32_bf16 v[104:107], a[116:119], a[12:15], v[104:107]
ds_read_b128 a[52:55], v3 offset:36864
v_mfma_f32_16x16x32_bf16 v[88:91], a[116:119], a[4:7], v[88:91]
ds_read_b128 a[56:59], v2 offset:38912
v_mfma_f32_16x16x32_bf16 v[88:91], a[112:115], a[0:3], v[88:91]
s_waitcnt lgkmcnt(7)
s_xor_b32 m0, s84, 5120
ds_read_b128 a[60:63], v3 offset:38912
v_mfma_f32_16x16x32_bf16 v[28:31], a[72:75], a[0:3], v[28:31]
s_xor_b32 s64, s73, 17920
ds_read_b64_tr_b16 a[104:105], v10 offset:0
v_mfma_f32_16x16x32_bf16 v[28:31], a[76:79], a[4:7], v[28:31]
buffer_load_dwordx4 v13, s[48:51], s64 offen lds
v_mfma_f32_16x16x32_bf16 v[44:47], a[76:79], a[12:15], v[44:47]
ds_read_b64_tr_b16 a[106:107], v10 offset:1024
v_mfma_f32_16x16x32_bf16 v[44:47], a[72:75], a[8:11], v[44:47]
ds_read_b64_tr_b16 a[108:109], v10 offset:8192
v_mfma_f32_16x16x32_bf16 v[60:63], a[72:75], a[16:19], v[60:63]
s_xor_b32 m0, s84, 6144
ds_read_b64_tr_b16 a[110:111], v10 offset:9216
v_mfma_f32_16x16x32_bf16 v[60:63], a[76:79], a[20:23], v[60:63]
s_xor_b32 s64, s73, 132608
ds_read_b64_tr_b16 a[112:113], v11 offset:0
v_mfma_f32_16x16x32_bf16 v[76:79], a[76:79], a[28:31], v[76:79]
buffer_load_dwordx4 v12, s[48:51], s64 offen lds
v_mfma_f32_16x16x32_bf16 v[76:79], a[72:75], a[24:27], v[76:79]
ds_read_b64_tr_b16 a[114:115], v11 offset:1024
v_mfma_f32_16x16x32_bf16 v[140:143], a[80:83], a[24:27], v[140:143]
s_xor_b32 m0, s84, 7168
ds_read_b64_tr_b16 a[116:117], v11 offset:8192
v_mfma_f32_16x16x32_bf16 v[140:143], a[84:87], a[28:31], v[140:143]
s_xor_b32 s64, s73, 148992
ds_read_b64_tr_b16 a[118:119], v11 offset:9216
v_mfma_f32_16x16x32_bf16 v[124:127], a[84:87], a[20:23], v[124:127]
v_readfirstlane_b32 vcc_lo, v1
s_nop 0
s_cmp_lt_u32 vcc_lo, s81
s_cbranch_scc1 L_spin_1
L_spinbk_2:
v_mfma_f32_16x16x32_bf16 v[124:127], a[80:83], a[16:19], v[124:127]
s_add_u32 s65, s79, 31744
buffer_load_dwordx4 v13, s[48:51], s64 offen lds
v_mfma_f32_16x16x32_bf16 v[108:111], a[80:83], a[8:11], v[108:111]
buffer_store_dwordx4 a[232:235], v16, s[44:47], s65 offen sc1
v_mfma_f32_16x16x32_bf16 v[108:111], a[84:87], a[12:15], v[108:111]
v_mfma_f32_16x16x32_bf16 v[92:95], a[84:87], a[4:7], v[92:95]
s_add_u32 s52, s28, 59768832
s_addc_u32 s53, s29, 0
s_mov_b32 s54, 16384
v_mfma_f32_16x16x32_bf16 v[92:95], a[80:83], a[0:3], v[92:95]
v_mfma_f32_16x16x32_bf16 v[32:35], a[88:91], a[0:3], v[32:35]
v_mfma_f32_16x16x32_bf16 v[32:35], a[92:95], a[4:7], v[32:35]
v_mfma_f32_16x16x32_bf16 v[48:51], a[92:95], a[12:15], v[48:51]
s_waitcnt lgkmcnt(0)
s_barrier
v_mfma_f32_16x16x32_bf16 v[48:51], a[88:91], a[8:11], v[48:51]
s_xor_b32 m0, s77, 65536
ds_read_b64_tr_b16 a[72:73], v19 offset:36864
v_mfma_f32_16x16x32_bf16 v[64:67], a[88:91], a[16:19], v[64:67]
s_xor_b32 s64, s71, 6815744
ds_read_b64_tr_b16 a[74:75], v19 offset:37120
v_mfma_f32_16x16x32_bf16 v[64:67], a[92:95], a[20:23], v[64:67]
buffer_load_dwordx4 v14, s[56:59], s64 offen lds
v_mfma_f32_16x16x32_bf16 v[80:83], a[92:95], a[28:31], v[80:83]
ds_read_b64_tr_b16 a[76:77], v19 offset:38912
v_mfma_f32_16x16x32_bf16 v[80:83], a[88:91], a[24:27], v[80:83]
ds_read_b64_tr_b16 a[78:79], v19 offset:39168
v_mfma_f32_16x16x32_bf16 v[144:147], a[96:99], a[24:27], v[144:147]
ds_read_b64_tr_b16 a[80:81], v20 offset:36864
v_mfma_f32_16x16x32_bf16 v[144:147], a[100:103], a[28:31], v[144:147]
ds_read_b64_tr_b16 a[82:83], v20 offset:37120
v_mfma_f32_16x16x32_bf16 v[128:131], a[100:103], a[20:23], v[128:131]
ds_read_b64_tr_b16 a[84:85], v20 offset:38912
v_mfma_f32_16x16x32_bf16 v[128:131], a[96:99], a[16:19], v[128:131]
ds_read_b64_tr_b16 a[86:87], v20 offset:39168
v_mfma_f32_16x16x32_bf16 v[112:115], a[96:99], a[8:11], v[112:115]
s_add_u32 m0, s78, 81920
ds_read_b64_tr_b16 a[88:89], v19 offset:40960
v_mfma_f32_16x16x32_bf16 v[112:115], a[100:103], a[12:15], v[112:115]
s_add_u32 s64, s75, 5111808
ds_read_b64_tr_b16 a[90:91], v19 offset:41216
v_mfma_f32_16x16x32_bf16 v[96:99], a[100:103], a[4:7], v[96:99]
buffer_load_dwordx4 v23, s[60:63], s64 offen lds
v_mfma_f32_16x16x32_bf16 v[96:99], a[96:99], a[0:3], v[96:99]
ds_read_b64_tr_b16 a[92:93], v19 offset:43008
v_mfma_f32_16x16x32_bf16 v[36:39], a[104:107], a[0:3], v[36:39]
ds_read_b64_tr_b16 a[94:95], v19 offset:43264
v_mfma_f32_16x16x32_bf16 v[36:39], a[108:111], a[4:7], v[36:39]
ds_read_b64_tr_b16 a[96:97], v20 offset:40960
v_mfma_f32_16x16x32_bf16 v[52:55], a[108:111], a[12:15], v[52:55]
ds_read_b64_tr_b16 a[98:99], v20 offset:41216
v_mfma_f32_16x16x32_bf16 v[52:55], a[104:107], a[8:11], v[52:55]
ds_read_b64_tr_b16 a[100:101], v20 offset:43008
v_mfma_f32_16x16x32_bf16 v[68:71], a[104:107], a[16:19], v[68:71]
ds_read_b64_tr_b16 a[102:103], v20 offset:43264
v_mfma_f32_16x16x32_bf16 v[68:71], a[108:111], a[20:23], v[68:71]
s_xor_b32 m0, s77, 66560
v_mfma_f32_16x16x32_bf16 v[84:87], a[108:111], a[28:31], v[84:87]
s_xor_b32 s64, s71, 6848512
v_mfma_f32_16x16x32_bf16 v[84:87], a[104:107], a[24:27], v[84:87]
buffer_load_dwordx4 v14, s[56:59], s64 offen lds
v_mfma_f32_16x16x32_bf16 v[148:151], a[112:115], a[24:27], v[148:151]
ds_read_b64_tr_b16 a[104:105], v19 offset:32768
v_mfma_f32_16x16x32_bf16 v[148:151], a[116:119], a[28:31], v[148:151]
ds_read_b64_tr_b16 a[106:107], v19 offset:33024
v_mfma_f32_16x16x32_bf16 v[132:135], a[116:119], a[20:23], v[132:135]
ds_read_b64_tr_b16 a[108:109], v19 offset:34816
v_mfma_f32_16x16x32_bf16 v[132:135], a[112:115], a[16:19], v[132:135]
ds_read_b64_tr_b16 a[110:111], v19 offset:35072
v_mfma_f32_16x16x32_bf16 v[116:119], a[112:115], a[8:11], v[116:119]
v_mfma_f32_16x16x32_bf16 v[116:119], a[116:119], a[12:15], v[116:119]
v_mfma_f32_16x16x32_bf16 v[100:103], a[116:119], a[4:7], v[100:103]
s_add_u32 m0, s78, 86016
v_mfma_f32_16x16x32_bf16 v[100:103], a[112:115], a[0:3], v[100:103]
s_waitcnt lgkmcnt(4)
s_add_u32 s64, s75, 5113856
ds_read_b64_tr_b16 a[112:113], v20 offset:32768
v_mfma_f32_16x16x32_bf16 v[184:187], a[72:75], a[32:35], v[184:187]
buffer_load_dwordx4 v23, s[60:63], s64 offen lds
v_mfma_f32_16x16x32_bf16 v[184:187], a[76:79], a[36:39], v[184:187]
ds_read_b64_tr_b16 a[114:115], v20 offset:33024
v_mfma_f32_16x16x32_bf16 v[192:195], a[76:79], a[44:47], v[192:195]
ds_read_b64_tr_b16 a[116:117], v20 offset:34816
v_mfma_f32_16x16x32_bf16 v[192:195], a[72:75], a[40:43], v[192:195]
ds_read_b64_tr_b16 a[118:119], v20 offset:35072
v_mfma_f32_16x16x32_bf16 v[200:203], a[72:75], a[48:51], v[200:203]
v_mfma_f32_16x16x32_bf16 v[200:203], a[76:79], a[52:55], v[200:203]
v_mfma_f32_16x16x32_bf16 v[208:211], a[76:79], a[60:63], v[208:211]
v_mfma_f32_16x16x32_bf16 v[208:211], a[72:75], a[56:59], v[208:211]
ds_read_b64_tr_b16 a[72:73], v4 offset:32768
v_mfma_f32_16x16x32_bf16 v[212:215], a[80:83], a[56:59], v[212:215]
s_xor_b32 m0, s77, 67584
ds_read_b64_tr_b16 a[74:75], v4 offset:33792
v_mfma_f32_16x16x32_bf16 v[212:215], a[84:87], a[60:63], v[212:215]
s_xor_b32 s64, s71, 6881280
ds_read_b64_tr_b16 a[76:77], v4 offset:40960
v_mfma_f32_16x16x32_bf16 v[204:207], a[84:87], a[52:55], v[204:207]
buffer_load_dwordx4 v15, s[56:59], s64 offen lds
v_mfma_f32_16x16x32_bf16 v[204:207], a[80:83], a[48:51], v[204:207]
s_add_u32 s65, s79, 15360
ds_read_b64_tr_b16 a[78:79], v4 offset:41984
v_mfma_f32_16x16x32_bf16 v[196:199], a[80:83], a[40:43], v[196:199]
buffer_store_dwordx4 a[236:239], v16, s[44:47], s65 offen sc1
v_mfma_f32_16x16x32_bf16 v[196:199], a[84:87], a[44:47], v[196:199]
v_mfma_f32_16x16x32_bf16 v[188:191], a[84:87], a[36:39], v[188:191]
v_mfma_f32_16x16x32_bf16 v[188:191], a[80:83], a[32:35], v[188:191]
ds_read_b64_tr_b16 a[80:81], v5 offset:32768
v_mfma_f32_16x16x32_bf16 v[216:219], a[32:35], a[88:91], v[216:219]
ds_read_b64_tr_b16 a[82:83], v5 offset:33792
v_mfma_f32_16x16x32_bf16 v[216:219], a[36:39], a[92:95], v[216:219]
s_add_u32 m0, s78, 90112
ds_read_b64_tr_b16 a[84:85], v5 offset:40960
v_mfma_f32_16x16x32_bf16 v[224:227], a[44:47], a[92:95], v[224:227]
s_add_u32 s64, s75, 5115904
ds_read_b64_tr_b16 a[86:87], v5 offset:41984
v_mfma_f32_16x16x32_bf16 v[224:227], a[40:43], a[88:91], v[224:227]
buffer_load_dwordx4 v23, s[60:63], s64 offen lds
v_mfma_f32_16x16x32_bf16 v[232:235], a[48:51], a[88:91], v[232:235]
v_mfma_f32_16x16x32_bf16 v[232:235], a[52:55], a[92:95], v[232:235]
v_mfma_f32_16x16x32_bf16 v[240:243], a[60:63], a[92:95], v[240:243]
v_mfma_f32_16x16x32_bf16 v[240:243], a[56:59], a[88:91], v[240:243]
ds_read_b64_tr_b16 a[88:89], v6 offset:32768
v_mfma_f32_16x16x32_bf16 v[244:247], a[56:59], a[96:99], v[244:247]
ds_read_b64_tr_b16 a[90:91], v6 offset:33792
v_mfma_f32_16x16x32_bf16 v[244:247], a[60:63], a[100:103], v[244:247]
ds_read_b64_tr_b16 a[92:93], v6 offset:40960
v_add_u32 v19, 0x8000, v19
v_mfma_f32_16x16x32_bf16 v[236:239], a[52:55], a[100:103], v[236:239]
s_xor_b32 m0, s77, 68608
ds_read_b64_tr_b16 a[94:95], v6 offset:41984
v_mfma_f32_16x16x32_bf16 v[236:239], a[48:51], a[96:99], v[236:239]
s_xor_b32 s64, s71, 6914048
v_mfma_f32_16x16x32_bf16 v[228:231], a[40:43], a[96:99], v[228:231]
buffer_load_dwordx4 v15, s[56:59], s64 offen lds
v_mfma_f32_16x16x32_bf16 v[228:231], a[44:47], a[100:103], v[228:231]
v_mfma_f32_16x16x32_bf16 v[220:223], a[36:39], a[100:103], v[220:223]
v_mfma_f32_16x16x32_bf16 v[220:223], a[32:35], a[96:99], v[220:223]
s_waitcnt lgkmcnt(4)
ds_read_b64_tr_b16 a[96:97], v7 offset:32768
v_mfma_f32_16x16x32_bf16 v[152:155], a[104:107], a[32:35], v[152:155]
ds_read_b64_tr_b16 a[98:99], v7 offset:33792
v_mfma_f32_16x16x32_bf16 v[152:155], a[108:111], a[36:39], v[152:155]
ds_read_b64_tr_b16 a[100:101], v7 offset:40960
v_add_u32 v20, 0x8000, v20
v_mfma_f32_16x16x32_bf16 v[160:163], a[108:111], a[44:47], v[160:163]
ds_read_b64_tr_b16 a[102:103], v7 offset:41984
v_mfma_f32_16x16x32_bf16 v[160:163], a[104:107], a[40:43], v[160:163]
v_mfma_f32_16x16x32_bf16 v[168:171], a[104:107], a[48:51], v[168:171]
v_mfma_f32_16x16x32_bf16 v[168:171], a[108:111], a[52:55], v[168:171]
v_mfma_f32_16x16x32_bf16 v[176:179], a[108:111], a[60:63], v[176:179]
s_xor_b32 m0, s84, 32768
v_mfma_f32_16x16x32_bf16 v[176:179], a[104:107], a[56:59], v[176:179]
s_xor_b32 s64, s72, 1664
ds_read_b64_tr_b16 a[104:105], v8 offset:32768
v_mfma_f32_16x16x32_bf16 v[180:183], a[112:115], a[56:59], v[180:183]
buffer_load_dwordx4 v12, s[48:51], s64 offen lds
v_mfma_f32_16x16x32_bf16 v[180:183], a[116:119], a[60:63], v[180:183]
ds_read_b64_tr_b16 a[106:107], v8 offset:33792
v_add_u32 v4, 0x8000, v4
v_mfma_f32_16x16x32_bf16 v[172:175], a[116:119], a[52:55], v[172:175]
ds_read_b64_tr_b16 a[108:109], v8 offset:40960
v_mfma_f32_16x16x32_bf16 v[172:175], a[112:115], a[48:51], v[172:175]
s_xor_b32 m0, s84, 33792
ds_read_b64_tr_b16 a[110:111], v8 offset:41984
v_mfma_f32_16x16x32_bf16 v[164:167], a[112:115], a[40:43], v[164:167]
s_xor_b32 s64, s72, 18048
v_mfma_f32_16x16x32_bf16 v[164:167], a[116:119], a[44:47], v[164:167]
buffer_load_dwordx4 v13, s[48:51], s64 offen lds
v_mfma_f32_16x16x32_bf16 v[156:159], a[116:119], a[36:39], v[156:159]
v_mfma_f32_16x16x32_bf16 v[156:159], a[112:115], a[32:35], v[156:159]
ds_read_b64_tr_b16 a[112:113], v9 offset:32768
v_mfma_f32_16x16x32_bf16 v[24:27], a[72:75], a[32:35], v[24:27]
s_xor_b32 m0, s84, 34816
ds_read_b64_tr_b16 a[114:115], v9 offset:33792
v_mfma_f32_16x16x32_bf16 v[24:27], a[76:79], a[36:39], v[24:27]
s_xor_b32 s64, s72, 132736
ds_read_b64_tr_b16 a[116:117], v9 offset:40960
v_add_u32 v5, 0x8000, v5
v_mfma_f32_16x16x32_bf16 v[40:43], a[76:79], a[44:47], v[40:43]
buffer_load_dwordx4 v12, s[48:51], s64 offen lds
v_mfma_f32_16x16x32_bf16 v[40:43], a[72:75], a[40:43], v[40:43]
ds_read_b64_tr_b16 a[118:119], v9 offset:41984
v_mfma_f32_16x16x32_bf16 v[56:59], a[72:75], a[48:51], v[56:59]
v_mfma_f32_16x16x32_bf16 v[56:59], a[76:79], a[52:55], v[56:59]
s_xor_b32 m0, s84, 35840
v_mfma_f32_16x16x32_bf16 v[72:75], a[76:79], a[60:63], v[72:75]
s_waitcnt vmcnt(12)
s_xor_b32 s64, s72, 149120
ds_read_b128 a[0:3], v2 offset:0
v_mfma_f32_16x16x32_bf16 v[72:75], a[72:75], a[56:59], v[72:75]
buffer_load_dwordx4 v13, s[48:51], s64 offen lds
v_mfma_f32_16x16x32_bf16 v[136:139], a[80:83], a[56:59], v[136:139]
ds_read_b128 a[4:7], v3 offset:0
v_mfma_f32_16x16x32_bf16 v[136:139], a[84:87], a[60:63], v[136:139]
ds_read_b128 a[8:11], v2 offset:2048
v_add_u32 v6, 0x8000, v6
v_mfma_f32_16x16x32_bf16 v[120:123], a[84:87], a[52:55], v[120:123]
s_xor_b32 m0, s84, 36864
ds_read_b128 a[12:15], v3 offset:2048
v_mfma_f32_16x16x32_bf16 v[120:123], a[80:83], a[48:51], v[120:123]
s_xor_b32 s64, s73, 1664
ds_read_b128 a[16:19], v2 offset:4096
v_mfma_f32_16x16x32_bf16 v[104:107], a[80:83], a[40:43], v[104:107]
buffer_load_dwordx4 v12, s[48:51], s64 offen lds
v_mfma_f32_16x16x32_bf16 v[104:107], a[84:87], a[44:47], v[104:107]
ds_read_b128 a[20:23], v3 offset:4096
v_mfma_f32_16x16x32_bf16 v[88:91], a[84:87], a[36:39], v[88:91]
buffer_store_dwordx4 a[240:243], v16, s[44:47], s74 offen sc1
v_mfma_f32_16x16x32_bf16 v[88:91], a[80:83], a[32:35], v[88:91]
s_waitcnt lgkmcnt(6)
s_xor_b32 m0, s84, 37888
ds_read_b128 a[24:27], v2 offset:6144
v_mfma_f32_16x16x32_bf16 v[28:31], a[88:91], a[32:35], v[28:31]
s_xor_b32 s64, s73, 18048
ds_read_b128 a[28:31], v3 offset:6144
v_mfma_f32_16x16x32_bf16 v[28:31], a[92:95], a[36:39], v[28:31]
buffer_load_dwordx4 v13, s[48:51], s64 offen lds
v_mfma_f32_16x16x32_bf16 v[44:47], a[92:95], a[44:47], v[44:47]
ds_read_b64_tr_b16 a[72:73], v10 offset:32768
v_add_u32 v7, 0x8000, v7
v_mfma_f32_16x16x32_bf16 v[44:47], a[88:91], a[40:43], v[44:47]
ds_read_b64_tr_b16 a[74:75], v10 offset:33792
v_mfma_f32_16x16x32_bf16 v[60:63], a[88:91], a[48:51], v[60:63]
s_xor_b32 m0, s84, 38912
ds_read_b64_tr_b16 a[76:77], v10 offset:40960
v_mfma_f32_16x16x32_bf16 v[60:63], a[92:95], a[52:55], v[60:63]
s_xor_b32 s64, s73, 132736
ds_read_b64_tr_b16 a[78:79], v10 offset:41984
v_mfma_f32_16x16x32_bf16 v[76:79], a[92:95], a[60:63], v[76:79]
buffer_load_dwordx4 v12, s[48:51], s64 offen lds
v_mfma_f32_16x16x32_bf16 v[76:79], a[88:91], a[56:59], v[76:79]
ds_read_b64_tr_b16 a[80:81], v11 offset:32768
v_mfma_f32_16x16x32_bf16 v[140:143], a[96:99], a[56:59], v[140:143]
ds_read_b64_tr_b16 a[82:83], v11 offset:33792
v_mfma_f32_16x16x32_bf16 v[140:143], a[100:103], a[60:63], v[140:143]
s_xor_b32 m0, s84, 39936
ds_read_b64_tr_b16 a[84:85], v11 offset:40960
v_add_u32 v8, 0x8000, v8
v_mfma_f32_16x16x32_bf16 v[124:127], a[100:103], a[52:55], v[124:127]
s_xor_b32 s64, s73, 149120
ds_read_b64_tr_b16 a[86:87], v11 offset:41984
v_mfma_f32_16x16x32_bf16 v[124:127], a[96:99], a[48:51], v[124:127]
buffer_load_dwordx4 v13, s[48:51], s64 offen lds
v_mfma_f32_16x16x32_bf16 v[108:111], a[96:99], a[40:43], v[108:111]
v_mfma_f32_16x16x32_bf16 v[108:111], a[100:103], a[44:47], v[108:111]
v_mfma_f32_16x16x32_bf16 v[92:95], a[100:103], a[36:39], v[92:95]
v_add_u32 v9, 0x8000, v9
v_add_u32 v10, 0x8000, v10
v_mfma_f32_16x16x32_bf16 v[92:95], a[96:99], a[32:35], v[92:95]
v_add_u32 v11, 0x8000, v11
v_mfma_f32_16x16x32_bf16 v[32:35], a[104:107], a[32:35], v[32:35]
v_mfma_f32_16x16x32_bf16 v[32:35], a[108:111], a[36:39], v[32:35]
v_mfma_f32_16x16x32_bf16 v[48:51], a[108:111], a[44:47], v[48:51]
s_waitcnt lgkmcnt(0)
s_barrier
v_mfma_f32_16x16x32_bf16 v[48:51], a[104:107], a[40:43], v[48:51]
s_xor_b32 m0, s77, 98304
ds_read_b64_tr_b16 a[88:89], v19 offset:36864
v_mfma_f32_16x16x32_bf16 v[64:67], a[104:107], a[48:51], v[64:67]
s_xor_b32 s64, s71, 7340032
ds_read_b64_tr_b16 a[90:91], v19 offset:37120
v_mfma_f32_16x16x32_bf16 v[64:67], a[108:111], a[52:55], v[64:67]
buffer_load_dwordx4 v14, s[56:59], s64 offen lds
v_mfma_f32_16x16x32_bf16 v[80:83], a[108:111], a[60:63], v[80:83]
ds_read_b64_tr_b16 a[92:93], v19 offset:38912
v_mfma_f32_16x16x32_bf16 v[80:83], a[104:107], a[56:59], v[80:83]
ds_read_b64_tr_b16 a[94:95], v19 offset:39168
v_mfma_f32_16x16x32_bf16 v[144:147], a[112:115], a[56:59], v[144:147]
ds_read_b64_tr_b16 a[96:97], v20 offset:36864
v_mfma_f32_16x16x32_bf16 v[144:147], a[116:119], a[60:63], v[144:147]
ds_read_b64_tr_b16 a[98:99], v20 offset:37120
v_mfma_f32_16x16x32_bf16 v[128:131], a[116:119], a[52:55], v[128:131]
ds_read_b64_tr_b16 a[100:101], v20 offset:38912
v_mfma_f32_16x16x32_bf16 v[128:131], a[112:115], a[48:51], v[128:131]
ds_read_b64_tr_b16 a[102:103], v20 offset:39168
v_mfma_f32_16x16x32_bf16 v[112:115], a[112:115], a[40:43], v[112:115]
s_add_u32 m0, s78, 114688
ds_read_b64_tr_b16 a[104:105], v19 offset:40960
v_mfma_f32_16x16x32_bf16 v[112:115], a[116:119], a[44:47], v[112:115]
s_add_u32 s64, s75, 5505024
ds_read_b64_tr_b16 a[106:107], v19 offset:41216
v_mfma_f32_16x16x32_bf16 v[96:99], a[116:119], a[36:39], v[96:99]
buffer_load_dwordx4 v23, s[60:63], s64 offen lds
v_mfma_f32_16x16x32_bf16 v[96:99], a[112:115], a[32:35], v[96:99]
ds_read_b64_tr_b16 a[108:109], v19 offset:43008
v_mfma_f32_16x16x32_bf16 v[36:39], a[72:75], a[32:35], v[36:39]
ds_read_b64_tr_b16 a[110:111], v19 offset:43264
v_mfma_f32_16x16x32_bf16 v[36:39], a[76:79], a[36:39], v[36:39]
ds_read_b64_tr_b16 a[112:113], v20 offset:40960
v_mfma_f32_16x16x32_bf16 v[52:55], a[76:79], a[44:47], v[52:55]
ds_read_b64_tr_b16 a[114:115], v20 offset:41216
v_mfma_f32_16x16x32_bf16 v[52:55], a[72:75], a[40:43], v[52:55]
ds_read_b64_tr_b16 a[116:117], v20 offset:43008
v_mfma_f32_16x16x32_bf16 v[68:71], a[72:75], a[48:51], v[68:71]
ds_read_b64_tr_b16 a[118:119], v20 offset:43264
v_mfma_f32_16x16x32_bf16 v[68:71], a[76:79], a[52:55], v[68:71]
s_xor_b32 m0, s77, 99328
v_mfma_f32_16x16x32_bf16 v[84:87], a[76:79], a[60:63], v[84:87]
s_xor_b32 s64, s71, 7372800
v_mfma_f32_16x16x32_bf16 v[84:87], a[72:75], a[56:59], v[84:87]
buffer_load_dwordx4 v14, s[56:59], s64 offen lds
v_mfma_f32_16x16x32_bf16 v[148:151], a[80:83], a[56:59], v[148:151]
ds_read_b64_tr_b16 a[72:73], v19 offset:32768
v_mfma_f32_16x16x32_bf16 v[148:151], a[84:87], a[60:63], v[148:151]
ds_read_b64_tr_b16 a[74:75], v19 offset:33024
v_mfma_f32_16x16x32_bf16 v[132:135], a[84:87], a[52:55], v[132:135]
ds_read_b64_tr_b16 a[76:77], v19 offset:34816
v_mfma_f32_16x16x32_bf16 v[132:135], a[80:83], a[48:51], v[132:135]
ds_read_b64_tr_b16 a[78:79], v19 offset:35072
v_mfma_f32_16x16x32_bf16 v[116:119], a[80:83], a[40:43], v[116:119]
v_mfma_f32_16x16x32_bf16 v[116:119], a[84:87], a[44:47], v[116:119]
v_mfma_f32_16x16x32_bf16 v[100:103], a[84:87], a[36:39], v[100:103]
s_add_u32 m0, s78, 118784
v_mfma_f32_16x16x32_bf16 v[100:103], a[80:83], a[32:35], v[100:103]
s_waitcnt lgkmcnt(4)
s_add_u32 s64, s75, 5507072
ds_read_b64_tr_b16 a[80:81], v20 offset:32768
v_mfma_f32_16x16x32_bf16 v[184:187], a[88:91], a[0:3], v[184:187]
s_lshl_b32 s66, s30, 30
buffer_load_dwordx4 v23, s[60:63], s64 offen lds
v_mfma_f32_16x16x32_bf16 v[184:187], a[92:95], a[4:7], v[184:187]
ds_read_b64_tr_b16 a[82:83], v20 offset:33024
v_lshl_add_u32 v1, v0, 24, s66
v_mfma_f32_16x16x32_bf16 v[192:195], a[92:95], a[12:15], v[192:195]
s_lshl_b32 s70, s31, 8
ds_read_b64_tr_b16 a[84:85], v20 offset:34816
v_mfma_f32_16x16x32_bf16 v[192:195], a[88:91], a[8:11], v[192:195]
s_add_u32 s17, s78, .-L_pc+6144
ds_read_b64_tr_b16 a[86:87], v20 offset:35072
v_mfma_f32_16x16x32_bf16 v[200:203], a[88:91], a[16:19], v[200:203]
buffer_load_dword a252, v16, s[88:91], s17 offen
v_mfma_f32_16x16x32_bf16 v[200:203], a[92:95], a[20:23], v[200:203]
v_mfma_f32_16x16x32_bf16 v[208:211], a[92:95], a[28:31], v[208:211]
v_mfma_f32_16x16x32_bf16 v[208:211], a[88:91], a[24:27], v[208:211]
ds_read_b64_tr_b16 a[88:89], v4 offset:32768
v_mfma_f32_16x16x32_bf16 v[212:215], a[96:99], a[24:27], v[212:215]
s_xor_b32 m0, s77, 100352
ds_read_b64_tr_b16 a[90:91], v4 offset:33792
v_mfma_f32_16x16x32_bf16 v[212:215], a[100:103], a[28:31], v[212:215]
s_xor_b32 s64, s71, 7405568
ds_read_b64_tr_b16 a[92:93], v4 offset:40960
v_mfma_f32_16x16x32_bf16 v[204:207], a[100:103], a[20:23], v[204:207]
buffer_load_dwordx4 v15, s[56:59], s64 offen lds
v_mfma_f32_16x16x32_bf16 v[204:207], a[96:99], a[16:19], v[204:207]
ds_read_b64_tr_b16 a[94:95], v4 offset:41984
v_mfma_f32_16x16x32_bf16 v[196:199], a[96:99], a[8:11], v[196:199]
v_mfma_f32_16x16x32_bf16 v[196:199], a[100:103], a[12:15], v[196:199]
v_mfma_f32_16x16x32_bf16 v[188:191], a[100:103], a[4:7], v[188:191]
v_mfma_f32_16x16x32_bf16 v[188:191], a[96:99], a[0:3], v[188:191]
ds_read_b64_tr_b16 a[96:97], v5 offset:32768
v_mfma_f32_16x16x32_bf16 v[216:219], a[0:3], a[104:107], v[216:219]
ds_read_b64_tr_b16 a[98:99], v5 offset:33792
v_mfma_f32_16x16x32_bf16 v[216:219], a[4:7], a[108:111], v[216:219]
s_add_u32 m0, s78, 122880
ds_read_b64_tr_b16 a[100:101], v5 offset:40960
v_mfma_f32_16x16x32_bf16 v[224:227], a[12:15], a[108:111], v[224:227]
s_add_u32 s64, s75, 5509120
ds_read_b64_tr_b16 a[102:103], v5 offset:41984
v_mfma_f32_16x16x32_bf16 v[224:227], a[8:11], a[104:107], v[224:227]
buffer_load_dwordx4 v23, s[60:63], s64 offen lds
v_mfma_f32_16x16x32_bf16 v[232:235], a[16:19], a[104:107], v[232:235]
v_mfma_f32_16x16x32_bf16 v[232:235], a[20:23], a[108:111], v[232:235]
v_mfma_f32_16x16x32_bf16 v[240:243], a[28:31], a[108:111], v[240:243]
v_mfma_f32_16x16x32_bf16 v[240:243], a[24:27], a[104:107], v[240:243]
ds_read_b64_tr_b16 a[104:105], v6 offset:32768
v_mfma_f32_16x16x32_bf16 v[244:247], a[24:27], a[112:115], v[244:247]
ds_read_b64_tr_b16 a[106:107], v6 offset:33792
v_mfma_f32_16x16x32_bf16 v[244:247], a[28:31], a[116:119], v[244:247]
ds_read_b64_tr_b16 a[108:109], v6 offset:40960
v_subrev_u32 v19, 0x8000, v19
v_mfma_f32_16x16x32_bf16 v[236:239], a[20:23], a[116:119], v[236:239]
s_xor_b32 m0, s77, 101376
ds_read_b64_tr_b16 a[110:111], v6 offset:41984
v_mfma_f32_16x16x32_bf16 v[236:239], a[16:19], a[112:115], v[236:239]
s_xor_b32 s64, s71, 7438336
v_mfma_f32_16x16x32_bf16 v[228:231], a[8:11], a[112:115], v[228:231]
buffer_load_dwordx4 v15, s[56:59], s64 offen lds
v_mfma_f32_16x16x32_bf16 v[228:231], a[12:15], a[116:119], v[228:231]
v_mfma_f32_16x16x32_bf16 v[220:223], a[4:7], a[116:119], v[220:223]
v_mfma_f32_16x16x32_bf16 v[220:223], a[0:3], a[112:115], v[220:223]
s_waitcnt lgkmcnt(4)
ds_read_b64_tr_b16 a[112:113], v7 offset:32768
v_mfma_f32_16x16x32_bf16 v[152:155], a[72:75], a[0:3], v[152:155]
ds_read_b64_tr_b16 a[114:115], v7 offset:33792
v_mfma_f32_16x16x32_bf16 v[152:155], a[76:79], a[4:7], v[152:155]
ds_read_b64_tr_b16 a[116:117], v7 offset:40960
v_subrev_u32 v20, 0x8000, v20
v_mfma_f32_16x16x32_bf16 v[160:163], a[76:79], a[12:15], v[160:163]
ds_read_b64_tr_b16 a[118:119], v7 offset:41984
v_mfma_f32_16x16x32_bf16 v[160:163], a[72:75], a[8:11], v[160:163]
v_mfma_f32_16x16x32_bf16 v[168:171], a[72:75], a[16:19], v[168:171]
v_mfma_f32_16x16x32_bf16 v[168:171], a[76:79], a[20:23], v[168:171]
v_mfma_f32_16x16x32_bf16 v[176:179], a[76:79], a[28:31], v[176:179]
s_xor_b32 m0, s84, 0
v_mfma_f32_16x16x32_bf16 v[176:179], a[72:75], a[24:27], v[176:179]
s_xor_b32 s64, s72, 1792
ds_read_b64_tr_b16 a[72:73], v8 offset:32768
v_mfma_f32_16x16x32_bf16 v[180:183], a[80:83], a[24:27], v[180:183]
buffer_load_dwordx4 v12, s[48:51], s64 offen lds
v_mfma_f32_16x16x32_bf16 v[180:183], a[84:87], a[28:31], v[180:183]
ds_read_b64_tr_b16 a[74:75], v8 offset:33792
v_subrev_u32 v4, 0x8000, v4
v_mfma_f32_16x16x32_bf16 v[172:175], a[84:87], a[20:23], v[172:175]
ds_read_b64_tr_b16 a[76:77], v8 offset:40960
v_mfma_f32_16x16x32_bf16 v[172:175], a[80:83], a[16:19], v[172:175]
s_xor_b32 m0, s84, 1024
ds_read_b64_tr_b16 a[78:79], v8 offset:41984
v_mfma_f32_16x16x32_bf16 v[164:167], a[80:83], a[8:11], v[164:167]
s_xor_b32 s64, s72, 18176
v_mfma_f32_16x16x32_bf16 v[164:167], a[84:87], a[12:15], v[164:167]
buffer_load_dwordx4 v13, s[48:51], s64 offen lds
v_mfma_f32_16x16x32_bf16 v[156:159], a[84:87], a[4:7], v[156:159]
v_mfma_f32_16x16x32_bf16 v[156:159], a[80:83], a[0:3], v[156:159]
ds_read_b64_tr_b16 a[80:81], v9 offset:32768
v_mfma_f32_16x16x32_bf16 v[24:27], a[88:91], a[0:3], v[24:27]
s_xor_b32 m0, s84, 2048
ds_read_b64_tr_b16 a[82:83], v9 offset:33792
v_mfma_f32_16x16x32_bf16 v[24:27], a[92:95], a[4:7], v[24:27]
s_xor_b32 s64, s72, 132864
ds_read_b64_tr_b16 a[84:85], v9 offset:40960
v_subrev_u32 v5, 0x8000, v5
v_mfma_f32_16x16x32_bf16 v[40:43], a[92:95], a[12:15], v[40:43]
buffer_load_dwordx4 v12, s[48:51], s64 offen lds
v_mfma_f32_16x16x32_bf16 v[40:43], a[88:91], a[8:11], v[40:43]
ds_read_b64_tr_b16 a[86:87], v9 offset:41984
v_mfma_f32_16x16x32_bf16 v[56:59], a[88:91], a[16:19], v[56:59]
v_mfma_f32_16x16x32_bf16 v[56:59], a[92:95], a[20:23], v[56:59]
s_xor_b32 m0, s84, 3072
v_mfma_f32_16x16x32_bf16 v[72:75], a[92:95], a[28:31], v[72:75]
s_waitcnt vmcnt(11)
s_xor_b32 s64, s72, 149248
ds_read_b128 a[32:35], v2 offset:32768
v_mfma_f32_16x16x32_bf16 v[72:75], a[88:91], a[24:27], v[72:75]
buffer_load_dwordx4 v13, s[48:51], s64 offen lds
v_mfma_f32_16x16x32_bf16 v[136:139], a[96:99], a[24:27], v[136:139]
ds_read_b128 a[36:39], v3 offset:32768
v_mfma_f32_16x16x32_bf16 v[136:139], a[100:103], a[28:31], v[136:139]
ds_read_b128 a[40:43], v2 offset:34816
v_subrev_u32 v6, 0x8000, v6
v_mfma_f32_16x16x32_bf16 v[120:123], a[100:103], a[20:23], v[120:123]
s_xor_b32 m0, s84, 4096
ds_read_b128 a[44:47], v3 offset:34816
v_mfma_f32_16x16x32_bf16 v[120:123], a[96:99], a[16:19], v[120:123]
s_xor_b32 s64, s73, 1792
ds_read_b128 a[48:51], v2 offset:36864
v_mfma_f32_16x16x32_bf16 v[104:107], a[96:99], a[8:11], v[104:107]
buffer_load_dwordx4 v12, s[48:51], s64 offen lds
v_mfma_f32_16x16x32_bf16 v[104:107], a[100:103], a[12:15], v[104:107]
ds_read_b128 a[52:55], v3 offset:36864
v_mfma_f32_16x16x32_bf16 v[88:91], a[100:103], a[4:7], v[88:91]
ds_read_b128 a[56:59], v2 offset:38912
v_mfma_f32_16x16x32_bf16 v[88:91], a[96:99], a[0:3], v[88:91]
s_waitcnt lgkmcnt(7)
s_xor_b32 m0, s84, 5120
ds_read_b128 a[60:63], v3 offset:38912
v_mfma_f32_16x16x32_bf16 v[28:31], a[104:107], a[0:3], v[28:31]
s_xor_b32 s64, s73, 18176
ds_read_b64_tr_b16 a[88:89], v10 offset:32768
v_mfma_f32_16x16x32_bf16 v[28:31], a[108:111], a[4:7], v[28:31]
buffer_load_dwordx4 v13, s[48:51], s64 offen lds
v_mfma_f32_16x16x32_bf16 v[44:47], a[108:111], a[12:15], v[44:47]
ds_read_b64_tr_b16 a[90:91], v10 offset:33792
v_subrev_u32 v7, 0x8000, v7
v_mfma_f32_16x16x32_bf16 v[44:47], a[104:107], a[8:11], v[44:47]
ds_read_b64_tr_b16 a[92:93], v10 offset:40960
v_mfma_f32_16x16x32_bf16 v[60:63], a[104:107], a[16:19], v[60:63]
s_xor_b32 m0, s84, 6144
ds_read_b64_tr_b16 a[94:95], v10 offset:41984
v_mfma_f32_16x16x32_bf16 v[60:63], a[108:111], a[20:23], v[60:63]
s_xor_b32 s64, s73, 132864
ds_read_b64_tr_b16 a[96:97], v11 offset:32768
v_mfma_f32_16x16x32_bf16 v[76:79], a[108:111], a[28:31], v[76:79]
buffer_load_dwordx4 v12, s[48:51], s64 offen lds
v_mfma_f32_16x16x32_bf16 v[76:79], a[104:107], a[24:27], v[76:79]
ds_read_b64_tr_b16 a[98:99], v11 offset:33792
v_mfma_f32_16x16x32_bf16 v[140:143], a[112:115], a[24:27], v[140:143]
ds_read_b64_tr_b16 a[100:101], v11 offset:40960
v_mfma_f32_16x16x32_bf16 v[140:143], a[116:119], a[28:31], v[140:143]
s_xor_b32 m0, s84, 7168
ds_read_b64_tr_b16 a[102:103], v11 offset:41984
v_subrev_u32 v8, 0x8000, v8
v_mfma_f32_16x16x32_bf16 v[124:127], a[116:119], a[20:23], v[124:127]
s_xor_b32 s64, s73, 149248
v_mfma_f32_16x16x32_bf16 v[124:127], a[112:115], a[16:19], v[124:127]
buffer_load_dwordx4 v13, s[48:51], s64 offen lds
v_mfma_f32_16x16x32_bf16 v[108:111], a[112:115], a[8:11], v[108:111]
v_mfma_f32_16x16x32_bf16 v[108:111], a[116:119], a[12:15], v[108:111]
v_mfma_f32_16x16x32_bf16 v[92:95], a[116:119], a[4:7], v[92:95]
v_subrev_u32 v9, 0x8000, v9
v_subrev_u32 v10, 0x8000, v10
v_mfma_f32_16x16x32_bf16 v[92:95], a[112:115], a[0:3], v[92:95]
v_subrev_u32 v11, 0x8000, v11
v_mfma_f32_16x16x32_bf16 v[32:35], a[72:75], a[0:3], v[32:35]
v_mfma_f32_16x16x32_bf16 v[32:35], a[76:79], a[4:7], v[32:35]
v_mfma_f32_16x16x32_bf16 v[48:51], a[76:79], a[12:15], v[48:51]
s_waitcnt lgkmcnt(0)
s_barrier
v_mfma_f32_16x16x32_bf16 v[48:51], a[72:75], a[8:11], v[48:51]
s_mov_b64 exec, 1
buffer_atomic_add a251, v1, s[52:55], s70 offen offset:0 sc1
s_mov_b64 exec, -1
s_xor_b32 m0, s77, 131072
v_mfma_f32_16x16x32_bf16 v[64:67], a[72:75], a[16:19], v[64:67]
s_lshl4_add_u32 s70, s78, s70
s_xor_b32 s64, s71, 7864320
ds_read_b64_tr_b16 a[104:105], v19 offset:4096
v_mfma_f32_16x16x32_bf16 v[64:67], a[76:79], a[20:23], v[64:67]
s_lshr_b32 s81, s81, 5
buffer_load_dwordx4 v14, s[56:59], s64 offen lds
v_mfma_f32_16x16x32_bf16 v[80:83], a[76:79], a[28:31], v[80:83]
ds_read_b64_tr_b16 a[106:107], v19 offset:4352
v_mfma_f32_16x16x32_bf16 v[80:83], a[72:75], a[24:27], v[80:83]
ds_read_b64_tr_b16 a[108:109], v19 offset:6144
v_mfma_f32_16x16x32_bf16 v[144:147], a[80:83], a[24:27], v[144:147]
ds_read_b64_tr_b16 a[110:111], v19 offset:6400
v_mfma_f32_16x16x32_bf16 v[144:147], a[84:87], a[28:31], v[144:147]
ds_read_b64_tr_b16 a[112:113], v20 offset:4096
v_mfma_f32_16x16x32_bf16 v[128:131], a[84:87], a[20:23], v[128:131]
ds_read_b64_tr_b16 a[114:115], v20 offset:4352
v_mfma_f32_16x16x32_bf16 v[128:131], a[80:83], a[16:19], v[128:131]
ds_read_b64_tr_b16 a[116:117], v20 offset:6144
v_mfma_f32_16x16x32_bf16 v[112:115], a[80:83], a[8:11], v[112:115]
s_add_u32 m0, s78, 147456
ds_read_b64_tr_b16 a[118:119], v20 offset:6400
v_mfma_f32_16x16x32_bf16 v[112:115], a[84:87], a[12:15], v[112:115]
s_add_u32 s64, s75, 5898240
ds_read_b64_tr_b16 a[72:73], v19 offset:8192
v_mfma_f32_16x16x32_bf16 v[96:99], a[84:87], a[4:7], v[96:99]
buffer_load_dwordx4 v23, s[60:63], s64 offen lds
v_mfma_f32_16x16x32_bf16 v[96:99], a[80:83], a[0:3], v[96:99]
ds_read_b64_tr_b16 a[74:75], v19 offset:8448
v_mfma_f32_16x16x32_bf16 v[36:39], a[88:91], a[0:3], v[36:39]
ds_read_b64_tr_b16 a[76:77], v19 offset:10240
v_mfma_f32_16x16x32_bf16 v[36:39], a[92:95], a[4:7], v[36:39]
ds_read_b64_tr_b16 a[78:79], v19 offset:10496
v_mfma_f32_16x16x32_bf16 v[52:55], a[92:95], a[12:15], v[52:55]
ds_read_b64_tr_b16 a[80:81], v20 offset:8192
v_mfma_f32_16x16x32_bf16 v[52:55], a[88:91], a[8:11], v[52:55]
ds_read_b64_tr_b16 a[82:83], v20 offset:8448
v_mfma_f32_16x16x32_bf16 v[68:71], a[88:91], a[16:19], v[68:71]
ds_read_b64_tr_b16 a[84:85], v20 offset:10240
v_mfma_f32_16x16x32_bf16 v[68:71], a[92:95], a[20:23], v[68:71]
s_xor_b32 m0, s77, 132096
ds_read_b64_tr_b16 a[86:87], v20 offset:10496
v_mfma_f32_16x16x32_bf16 v[84:87], a[92:95], a[28:31], v[84:87]
s_xor_b32 s64, s71, 7897088
v_mfma_f32_16x16x32_bf16 v[84:87], a[88:91], a[24:27], v[84:87]
buffer_load_dwordx4 v14, s[56:59], s64 offen lds
v_mfma_f32_16x16x32_bf16 v[148:151], a[96:99], a[24:27], v[148:151]
ds_read_b64_tr_b16 a[88:89], v19 offset:0
v_mfma_f32_16x16x32_bf16 v[148:151], a[100:103], a[28:31], v[148:151]
ds_read_b64_tr_b16 a[90:91], v19 offset:256
v_mfma_f32_16x16x32_bf16 v[132:135], a[100:103], a[20:23], v[132:135]
ds_read_b64_tr_b16 a[92:93], v19 offset:2048
v_mfma_f32_16x16x32_bf16 v[132:135], a[96:99], a[16:19], v[132:135]
ds_read_b64_tr_b16 a[94:95], v19 offset:2304
v_mfma_f32_16x16x32_bf16 v[116:119], a[96:99], a[8:11], v[116:119]
v_mfma_f32_16x16x32_bf16 v[116:119], a[100:103], a[12:15], v[116:119]
v_mfma_f32_16x16x32_bf16 v[100:103], a[100:103], a[4:7], v[100:103]
s_add_u32 m0, s78, 151552
v_mfma_f32_16x16x32_bf16 v[100:103], a[96:99], a[0:3], v[100:103]
s_waitcnt lgkmcnt(4)
s_add_u32 s64, s75, 5900288
ds_read_b64_tr_b16 a[96:97], v20 offset:0
v_mfma_f32_16x16x32_bf16 v[184:187], a[104:107], a[32:35], v[184:187]
buffer_load_dwordx4 v23, s[60:63], s64 offen lds
v_mfma_f32_16x16x32_bf16 v[184:187], a[108:111], a[36:39], v[184:187]
ds_read_b64_tr_b16 a[98:99], v20 offset:256
v_and_b32 v22, 15, v0
v_mfma_f32_16x16x32_bf16 v[192:195], a[108:111], a[44:47], v[192:195]
ds_read_b64_tr_b16 a[100:101], v20 offset:2048
v_lshlrev_b32 v22, 3, v22
v_mfma_f32_16x16x32_bf16 v[192:195], a[104:107], a[40:43], v[192:195]
s_lshl_b32 s85, s30, 7
s_add_u32 s85, s85, 58720256
ds_read_b64_tr_b16 a[102:103], v20 offset:2304
v_mfma_f32_16x16x32_bf16 v[200:203], a[104:107], a[48:51], v[200:203]
s_lshl_b32 s86, s3, 10
s_add_u32 s86, s86, s85
s_lshl_b32 s87, s16, 10
s_lshl_b32 s68, s31, 20
s_add_u32 s32, s28, s68
s_addc_u32 s33, s29, 0
v_mfma_f32_16x16x32_bf16 v[200:203], a[108:111], a[52:55], v[200:203]
s_add_u32 s87, s87, s85
s_add_u32 s68, s16, 1
s_lshl_b32 s34, s68, 16
v_mfma_f32_16x16x32_bf16 v[208:211], a[108:111], a[60:63], v[208:211]
v_mfma_f32_16x16x32_bf16 v[208:211], a[104:107], a[56:59], v[208:211]
ds_read_b64_tr_b16 a[104:105], v4 offset:0
v_mfma_f32_16x16x32_bf16 v[212:215], a[112:115], a[56:59], v[212:215]
s_xor_b32 m0, s77, 133120
ds_read_b64_tr_b16 a[106:107], v4 offset:1024
v_mfma_f32_16x16x32_bf16 v[212:215], a[116:119], a[60:63], v[212:215]
s_xor_b32 s64, s71, 7929856
ds_read_b64_tr_b16 a[108:109], v4 offset:8192
v_mfma_f32_16x16x32_bf16 v[204:207], a[116:119], a[52:55], v[204:207]
buffer_load_dwordx4 v15, s[56:59], s64 offen lds
v_mfma_f32_16x16x32_bf16 v[204:207], a[112:115], a[48:51], v[204:207]
ds_read_b64_tr_b16 a[110:111], v4 offset:9216
v_mfma_f32_16x16x32_bf16 v[196:199], a[112:115], a[40:43], v[196:199]
v_mfma_f32_16x16x32_bf16 v[196:199], a[116:119], a[44:47], v[196:199]
v_mfma_f32_16x16x32_bf16 v[188:191], a[116:119], a[36:39], v[188:191]
v_mfma_f32_16x16x32_bf16 v[188:191], a[112:115], a[32:35], v[188:191]
ds_read_b64_tr_b16 a[112:113], v5 offset:0
v_mfma_f32_16x16x32_bf16 v[216:219], a[32:35], a[72:75], v[216:219]
ds_read_b64_tr_b16 a[114:115], v5 offset:1024
v_mfma_f32_16x16x32_bf16 v[216:219], a[36:39], a[76:79], v[216:219]
s_add_u32 m0, s78, 155648
ds_read_b64_tr_b16 a[116:117], v5 offset:8192
v_mfma_f32_16x16x32_bf16 v[224:227], a[44:47], a[76:79], v[224:227]
s_add_u32 s64, s75, 5902336
ds_read_b64_tr_b16 a[118:119], v5 offset:9216
v_mfma_f32_16x16x32_bf16 v[224:227], a[40:43], a[72:75], v[224:227]
buffer_load_dwordx4 v23, s[60:63], s64 offen lds
v_mfma_f32_16x16x32_bf16 v[232:235], a[48:51], a[72:75], v[232:235]
v_mfma_f32_16x16x32_bf16 v[232:235], a[52:55], a[76:79], v[232:235]
v_mfma_f32_16x16x32_bf16 v[240:243], a[60:63], a[76:79], v[240:243]
v_mfma_f32_16x16x32_bf16 v[240:243], a[56:59], a[72:75], v[240:243]
ds_read_b64_tr_b16 a[72:73], v6 offset:0
v_mfma_f32_16x16x32_bf16 v[244:247], a[56:59], a[80:83], v[244:247]
ds_read_b64_tr_b16 a[74:75], v6 offset:1024
v_mfma_f32_16x16x32_bf16 v[244:247], a[60:63], a[84:87], v[244:247]
ds_read_b64_tr_b16 a[76:77], v6 offset:8192
v_mfma_f32_16x16x32_bf16 v[236:239], a[52:55], a[84:87], v[236:239]
s_xor_b32 m0, s77, 134144
ds_read_b64_tr_b16 a[78:79], v6 offset:9216
v_mfma_f32_16x16x32_bf16 v[236:239], a[48:51], a[80:83], v[236:239]
s_xor_b32 s64, s71, 7962624
v_mfma_f32_16x16x32_bf16 v[228:231], a[40:43], a[80:83], v[228:231]
buffer_load_dwordx4 v15, s[56:59], s64 offen lds
v_mfma_f32_16x16x32_bf16 v[228:231], a[44:47], a[84:87], v[228:231]
v_mfma_f32_16x16x32_bf16 v[220:223], a[36:39], a[84:87], v[220:223]
v_mfma_f32_16x16x32_bf16 v[220:223], a[32:35], a[80:83], v[220:223]
s_waitcnt lgkmcnt(4)
ds_read_b64_tr_b16 a[80:81], v7 offset:0
v_mfma_f32_16x16x32_bf16 v[152:155], a[88:91], a[32:35], v[152:155]
ds_read_b64_tr_b16 a[82:83], v7 offset:1024
v_mfma_f32_16x16x32_bf16 v[152:155], a[92:95], a[36:39], v[152:155]
ds_read_b64_tr_b16 a[84:85], v7 offset:8192
v_mfma_f32_16x16x32_bf16 v[160:163], a[92:95], a[44:47], v[160:163]
ds_read_b64_tr_b16 a[86:87], v7 offset:9216
v_mfma_f32_16x16x32_bf16 v[160:163], a[88:91], a[40:43], v[160:163]
v_mfma_f32_16x16x32_bf16 v[168:171], a[88:91], a[48:51], v[168:171]
v_mfma_f32_16x16x32_bf16 v[168:171], a[92:95], a[52:55], v[168:171]
v_mfma_f32_16x16x32_bf16 v[176:179], a[92:95], a[60:63], v[176:179]
s_xor_b32 m0, s84, 32768
v_mfma_f32_16x16x32_bf16 v[176:179], a[88:91], a[56:59], v[176:179]
s_xor_b32 s64, s72, 1920
ds_read_b64_tr_b16 a[88:89], v8 offset:0
v_mfma_f32_16x16x32_bf16 v[180:183], a[96:99], a[56:59], v[180:183]
buffer_load_dwordx4 v12, s[48:51], s64 offen lds
v_mfma_f32_16x16x32_bf16 v[180:183], a[100:103], a[60:63], v[180:183]
ds_read_b64_tr_b16 a[90:91], v8 offset:1024
v_mfma_f32_16x16x32_bf16 v[172:175], a[100:103], a[52:55], v[172:175]
ds_read_b64_tr_b16 a[92:93], v8 offset:8192
v_mfma_f32_16x16x32_bf16 v[172:175], a[96:99], a[48:51], v[172:175]
s_xor_b32 m0, s84, 33792
ds_read_b64_tr_b16 a[94:95], v8 offset:9216
v_mfma_f32_16x16x32_bf16 v[164:167], a[96:99], a[40:43], v[164:167]
s_xor_b32 s64, s72, 18304
v_mfma_f32_16x16x32_bf16 v[164:167], a[100:103], a[44:47], v[164:167]
buffer_load_dwordx4 v13, s[48:51], s64 offen lds
v_mfma_f32_16x16x32_bf16 v[156:159], a[100:103], a[36:39], v[156:159]
v_mfma_f32_16x16x32_bf16 v[156:159], a[96:99], a[32:35], v[156:159]
ds_read_b64_tr_b16 a[96:97], v9 offset:0
v_mfma_f32_16x16x32_bf16 v[24:27], a[104:107], a[32:35], v[24:27]
s_xor_b32 m0, s84, 34816
ds_read_b64_tr_b16 a[98:99], v9 offset:1024
v_mfma_f32_16x16x32_bf16 v[24:27], a[108:111], a[36:39], v[24:27]
s_xor_b32 s64, s72, 132992
ds_read_b64_tr_b16 a[100:101], v9 offset:8192
v_mfma_f32_16x16x32_bf16 v[40:43], a[108:111], a[44:47], v[40:43]
buffer_load_dwordx4 v12, s[48:51], s64 offen lds
v_mfma_f32_16x16x32_bf16 v[40:43], a[104:107], a[40:43], v[40:43]
ds_read_b64_tr_b16 a[102:103], v9 offset:9216
v_mfma_f32_16x16x32_bf16 v[56:59], a[104:107], a[48:51], v[56:59]
v_mfma_f32_16x16x32_bf16 v[56:59], a[108:111], a[52:55], v[56:59]
s_xor_b32 m0, s84, 35840
v_mfma_f32_16x16x32_bf16 v[72:75], a[108:111], a[60:63], v[72:75]
s_waitcnt vmcnt(11)
s_xor_b32 s64, s72, 149376
ds_read_b128 a[0:3], v2 offset:0
v_mfma_f32_16x16x32_bf16 v[72:75], a[104:107], a[56:59], v[72:75]
buffer_load_dwordx4 v13, s[48:51], s64 offen lds
v_mfma_f32_16x16x32_bf16 v[136:139], a[112:115], a[56:59], v[136:139]
ds_read_b128 a[4:7], v3 offset:0
v_mfma_f32_16x16x32_bf16 v[136:139], a[116:119], a[60:63], v[136:139]
ds_read_b128 a[8:11], v2 offset:2048
v_mfma_f32_16x16x32_bf16 v[120:123], a[116:119], a[52:55], v[120:123]
s_xor_b32 m0, s84, 36864
ds_read_b128 a[12:15], v3 offset:2048
v_mfma_f32_16x16x32_bf16 v[120:123], a[112:115], a[48:51], v[120:123]
s_xor_b32 s64, s73, 1920
ds_read_b128 a[16:19], v2 offset:4096
v_mfma_f32_16x16x32_bf16 v[104:107], a[112:115], a[40:43], v[104:107]
buffer_load_dwordx4 v12, s[48:51], s64 offen lds
v_mfma_f32_16x16x32_bf16 v[104:107], a[116:119], a[44:47], v[104:107]
ds_read_b128 a[20:23], v3 offset:4096
v_mfma_f32_16x16x32_bf16 v[88:91], a[116:119], a[36:39], v[88:91]
ds_read_b128 a[24:27], v2 offset:6144
v_mfma_f32_16x16x32_bf16 v[88:91], a[112:115], a[32:35], v[88:91]
s_waitcnt lgkmcnt(7)
s_xor_b32 m0, s84, 37888
ds_read_b128 a[28:31], v3 offset:6144
v_mfma_f32_16x16x32_bf16 v[28:31], a[72:75], a[32:35], v[28:31]
s_xor_b32 s64, s73, 18304
ds_read_b64_tr_b16 a[104:105], v10 offset:0
v_mfma_f32_16x16x32_bf16 v[28:31], a[76:79], a[36:39], v[28:31]
buffer_load_dwordx4 v13, s[48:51], s64 offen lds
v_mfma_f32_16x16x32_bf16 v[44:47], a[76:79], a[44:47], v[44:47]
ds_read_b64_tr_b16 a[106:107], v10 offset:1024
v_mfma_f32_16x16x32_bf16 v[44:47], a[72:75], a[40:43], v[44:47]
ds_read_b64_tr_b16 a[108:109], v10 offset:8192
v_mfma_f32_16x16x32_bf16 v[60:63], a[72:75], a[48:51], v[60:63]
s_xor_b32 m0, s84, 38912
buffer_load_dword v1, off, s[52:55], s70 sc1
v_mfma_f32_16x16x32_bf16 v[60:63], a[76:79], a[52:55], v[60:63]
s_xor_b32 s64, s73, 132992
ds_read_b64_tr_b16 a[110:111], v10 offset:9216
v_mfma_f32_16x16x32_bf16 v[76:79], a[76:79], a[60:63], v[76:79]
buffer_load_dwordx4 v12, s[48:51], s64 offen lds
v_mfma_f32_16x16x32_bf16 v[76:79], a[72:75], a[56:59], v[76:79]
ds_read_b64_tr_b16 a[112:113], v11 offset:0
v_mfma_f32_16x16x32_bf16 v[140:143], a[80:83], a[56:59], v[140:143]
ds_read_b64_tr_b16 a[114:115], v11 offset:1024
v_mfma_f32_16x16x32_bf16 v[140:143], a[84:87], a[60:63], v[140:143]
s_xor_b32 m0, s84, 39936
ds_read_b64_tr_b16 a[116:117], v11 offset:8192
v_mfma_f32_16x16x32_bf16 v[124:127], a[84:87], a[52:55], v[124:127]
s_xor_b32 s64, s73, 149376
ds_read_b64_tr_b16 a[118:119], v11 offset:9216
v_mfma_f32_16x16x32_bf16 v[124:127], a[80:83], a[48:51], v[124:127]
buffer_load_dwordx4 v13, s[48:51], s64 offen lds
v_mfma_f32_16x16x32_bf16 v[108:111], a[80:83], a[40:43], v[108:111]
v_mfma_f32_16x16x32_bf16 v[108:111], a[84:87], a[44:47], v[108:111]
v_mfma_f32_16x16x32_bf16 v[92:95], a[84:87], a[36:39], v[92:95]
buffer_load_dwordx2 a[64:65], v22, s[44:47], s86 offen offset:0 sc1
v_mfma_f32_16x16x32_bf16 v[92:95], a[80:83], a[32:35], v[92:95]
buffer_load_dwordx2 a[66:67], v22, s[44:47], s86 offen offset:512 sc1
v_mfma_f32_16x16x32_bf16 v[32:35], a[88:91], a[32:35], v[32:35]
buffer_load_dwordx2 a[68:69], v22, s[44:47], s87 offen offset:0 sc1
v_mfma_f32_16x16x32_bf16 v[32:35], a[92:95], a[36:39], v[32:35]
buffer_load_dwordx2 a[70:71], v22, s[44:47], s87 offen offset:512 sc1
v_mfma_f32_16x16x32_bf16 v[48:51], a[92:95], a[44:47], v[48:51]
s_waitcnt lgkmcnt(0)
s_barrier
v_mfma_f32_16x16x32_bf16 v[48:51], a[88:91], a[40:43], v[48:51]
ds_read_b64_tr_b16 a[72:73], v19 offset:36864
v_mfma_f32_16x16x32_bf16 v[64:67], a[88:91], a[48:51], v[64:67]
s_lshl2_add_u32 s72, s2, s30
ds_read_b64_tr_b16 a[74:75], v19 offset:37120
v_mfma_f32_16x16x32_bf16 v[64:67], a[92:95], a[52:55], v[64:67]
s_lshl_b32 s72, s72, 12
ds_read_b64_tr_b16 a[76:77], v19 offset:38912
v_mfma_f32_16x16x32_bf16 v[80:83], a[92:95], a[60:63], v[80:83]
s_add_u32 s72, s72, 67108864
ds_read_b64_tr_b16 a[78:79], v19 offset:39168
v_mfma_f32_16x16x32_bf16 v[80:83], a[88:91], a[56:59], v[80:83]
ds_read_b64_tr_b16 a[80:81], v20 offset:36864
v_mfma_f32_16x16x32_bf16 v[144:147], a[96:99], a[56:59], v[144:147]
ds_read_b64_tr_b16 a[82:83], v20 offset:37120
v_mfma_f32_16x16x32_bf16 v[144:147], a[100:103], a[60:63], v[144:147]
ds_read_b64_tr_b16 a[84:85], v20 offset:38912
v_mfma_f32_16x16x32_bf16 v[128:131], a[100:103], a[52:55], v[128:131]
ds_read_b64_tr_b16 a[86:87], v20 offset:39168
v_mfma_f32_16x16x32_bf16 v[128:131], a[96:99], a[48:51], v[128:131]
ds_read_b64_tr_b16 a[88:89], v19 offset:40960
v_mfma_f32_16x16x32_bf16 v[112:115], a[96:99], a[40:43], v[112:115]
ds_read_b64_tr_b16 a[90:91], v19 offset:41216
v_mfma_f32_16x16x32_bf16 v[112:115], a[100:103], a[44:47], v[112:115]
ds_read_b64_tr_b16 a[92:93], v19 offset:43008
v_mfma_f32_16x16x32_bf16 v[96:99], a[100:103], a[36:39], v[96:99]
ds_read_b64_tr_b16 a[94:95], v19 offset:43264
v_mfma_f32_16x16x32_bf16 v[96:99], a[96:99], a[32:35], v[96:99]
ds_read_b64_tr_b16 a[96:97], v20 offset:40960
v_mfma_f32_16x16x32_bf16 v[36:39], a[104:107], a[32:35], v[36:39]
buffer_store_dwordx4 a[240:243], v16, s[44:47], s72 offen offset:0 sc1
v_mfma_f32_16x16x32_bf16 v[36:39], a[108:111], a[36:39], v[36:39]
ds_read_b64_tr_b16 a[98:99], v20 offset:41216
v_mfma_f32_16x16x32_bf16 v[52:55], a[108:111], a[44:47], v[52:55]
ds_read_b64_tr_b16 a[100:101], v20 offset:43008
v_mfma_f32_16x16x32_bf16 v[52:55], a[104:107], a[40:43], v[52:55]
ds_read_b64_tr_b16 a[102:103], v20 offset:43264
v_mfma_f32_16x16x32_bf16 v[68:71], a[104:107], a[48:51], v[68:71]
v_mfma_f32_16x16x32_bf16 v[68:71], a[108:111], a[52:55], v[68:71]
v_mfma_f32_16x16x32_bf16 v[84:87], a[108:111], a[60:63], v[84:87]
v_mfma_f32_16x16x32_bf16 v[84:87], a[104:107], a[56:59], v[84:87]
ds_read_b64_tr_b16 a[104:105], v19 offset:32768
v_mfma_f32_16x16x32_bf16 v[148:151], a[112:115], a[56:59], v[148:151]
ds_read_b64_tr_b16 a[106:107], v19 offset:33024
v_mfma_f32_16x16x32_bf16 v[148:151], a[116:119], a[60:63], v[148:151]
ds_read_b64_tr_b16 a[108:109], v19 offset:34816
v_mfma_f32_16x16x32_bf16 v[132:135], a[116:119], a[52:55], v[132:135]
ds_read_b64_tr_b16 a[110:111], v19 offset:35072
v_mfma_f32_16x16x32_bf16 v[132:135], a[112:115], a[48:51], v[132:135]
v_mfma_f32_16x16x32_bf16 v[116:119], a[112:115], a[40:43], v[116:119]
v_mfma_f32_16x16x32_bf16 v[116:119], a[116:119], a[44:47], v[116:119]
v_mfma_f32_16x16x32_bf16 v[100:103], a[116:119], a[36:39], v[100:103]
buffer_store_dwordx4 a[240:243], v16, s[44:47], s72 offen offset:1024 sc1
v_mfma_f32_16x16x32_bf16 v[100:103], a[112:115], a[32:35], v[100:103]
s_waitcnt lgkmcnt(4)
ds_read_b64_tr_b16 a[112:113], v20 offset:32768
v_mfma_f32_16x16x32_bf16 v[184:187], a[72:75], a[0:3], v[184:187]
ds_read_b64_tr_b16 a[114:115], v20 offset:33024
v_and_b32 v12, 15, v0
v_mfma_f32_16x16x32_bf16 v[184:187], a[76:79], a[4:7], v[184:187]
ds_read_b64_tr_b16 a[116:117], v20 offset:34816
v_lshrrev_b32 v13, 4, v0
v_mfma_f32_16x16x32_bf16 v[192:195], a[76:79], a[12:15], v[192:195]
ds_read_b64_tr_b16 a[118:119], v20 offset:35072
v_lshlrev_b32 v13, 2, v13
v_mfma_f32_16x16x32_bf16 v[192:195], a[72:75], a[8:11], v[192:195]
v_sub_u32 v12, v12, v13
v_mfma_f32_16x16x32_bf16 v[200:203], a[72:75], a[16:19], v[200:203]
s_lshl_b32 s66, s30, 4
v_mfma_f32_16x16x32_bf16 v[200:203], a[76:79], a[20:23], v[200:203]
v_add_u32 v13, s66, v12
v_cmp_gt_i32 s[0:1], 0, v13
v_mfma_f32_16x16x32_bf16 v[208:211], a[76:79], a[28:31], v[208:211]
v_cmp_gt_i32 s[4:5], 1, v13
v_cmp_gt_i32 s[6:7], 2, v13
v_mfma_f32_16x16x32_bf16 v[208:211], a[72:75], a[24:27], v[208:211]
ds_read_b64_tr_b16 a[72:73], v4 offset:32768
v_cmp_gt_i32 s[8:9], 3, v13
v_mfma_f32_16x16x32_bf16 v[212:215], a[80:83], a[24:27], v[212:215]
ds_read_b64_tr_b16 a[74:75], v4 offset:33792
v_cmp_gt_i32 s[10:11], 16, v13
v_mfma_f32_16x16x32_bf16 v[212:215], a[84:87], a[28:31], v[212:215]
ds_read_b64_tr_b16 a[76:77], v4 offset:40960
v_cmp_gt_i32 s[12:13], 17, v13
v_mfma_f32_16x16x32_bf16 v[204:207], a[84:87], a[20:23], v[204:207]
ds_read_b64_tr_b16 a[78:79], v4 offset:41984
v_cmp_gt_i32 s[18:19], 18, v13
v_mfma_f32_16x16x32_bf16 v[204:207], a[80:83], a[16:19], v[204:207]
v_cmp_gt_i32 s[22:23], 19, v13
v_cmp_gt_i32 s[26:27], 32, v13
v_mfma_f32_16x16x32_bf16 v[196:199], a[80:83], a[8:11], v[196:199]
buffer_store_dwordx4 a[240:243], v16, s[44:47], s72 offen offset:2048 sc1
v_mfma_f32_16x16x32_bf16 v[196:199], a[84:87], a[12:15], v[196:199]
v_cmp_gt_i32 s[56:57], 33, v13
v_cmp_gt_i32 s[58:59], 34, v13
v_mfma_f32_16x16x32_bf16 v[188:191], a[84:87], a[4:7], v[188:191]
v_cmp_gt_i32 s[60:61], 35, v13
v_cmp_gt_i32 s[62:63], 48, v13
v_mfma_f32_16x16x32_bf16 v[188:191], a[80:83], a[0:3], v[188:191]
ds_read_b64_tr_b16 a[80:81], v5 offset:32768
v_cmp_gt_i32 s[48:49], 49, v13
v_mfma_f32_16x16x32_bf16 v[216:219], a[0:3], a[88:91], v[216:219]
ds_read_b64_tr_b16 a[82:83], v5 offset:33792
v_cmp_gt_i32 s[50:51], 50, v13
v_mfma_f32_16x16x32_bf16 v[216:219], a[4:7], a[92:95], v[216:219]
ds_read_b64_tr_b16 a[84:85], v5 offset:40960
v_cmp_gt_i32 s[100:101], 51, v13
v_mfma_f32_16x16x32_bf16 v[224:227], a[12:15], a[92:95], v[224:227]
ds_read_b64_tr_b16 a[86:87], v5 offset:41984
v_subrev_u32 v17, 0, v12
v_mfma_f32_16x16x32_bf16 v[224:227], a[8:11], a[88:91], v[224:227]
v_lshlrev_b32 v18, 31, v17
v_or_b32 v21, v17, v18
v_mfma_f32_16x16x32_bf16 v[232:235], a[16:19], a[88:91], v[232:235]
v_ashrrev_i32 v21, 31, v21
v_and_b32 v248, 0xff800000, v21
v_mfma_f32_16x16x32_bf16 v[232:235], a[20:23], a[92:95], v[232:235]
v_not_b32 v17, v17
v_or_b32 v21, v17, v18
v_mfma_f32_16x16x32_bf16 v[240:243], a[28:31], a[92:95], v[240:243]
v_ashrrev_i32 v21, 31, v21
v_and_b32 v252, 0xff800000, v21
v_mfma_f32_16x16x32_bf16 v[240:243], a[24:27], a[88:91], v[240:243]
ds_read_b64_tr_b16 a[88:89], v6 offset:32768
v_subrev_u32 v17, 1, v12
v_mfma_f32_16x16x32_bf16 v[244:247], a[24:27], a[96:99], v[244:247]
ds_read_b64_tr_b16 a[90:91], v6 offset:33792
v_lshlrev_b32 v18, 31, v17
v_mfma_f32_16x16x32_bf16 v[244:247], a[28:31], a[100:103], v[244:247]
ds_read_b64_tr_b16 a[92:93], v6 offset:40960
v_add_u32 v19, 0x8000, v19
v_mfma_f32_16x16x32_bf16 v[236:239], a[20:23], a[100:103], v[236:239]
buffer_store_dwordx4 a[240:243], v16, s[44:47], s72 offen offset:3072 sc1
v_mfma_f32_16x16x32_bf16 v[236:239], a[16:19], a[96:99], v[236:239]
ds_read_b64_tr_b16 a[94:95], v6 offset:41984
v_or_b32 v21, v17, v18
v_mfma_f32_16x16x32_bf16 v[228:231], a[8:11], a[96:99], v[228:231]
v_ashrrev_i32 v21, 31, v21
v_and_b32 v249, 0xff800000, v21
v_mfma_f32_16x16x32_bf16 v[228:231], a[12:15], a[100:103], v[228:231]
v_not_b32 v17, v17
v_or_b32 v21, v17, v18
v_mfma_f32_16x16x32_bf16 v[220:223], a[4:7], a[100:103], v[220:223]
v_ashrrev_i32 v21, 31, v21
v_and_b32 v253, 0xff800000, v21
v_mfma_f32_16x16x32_bf16 v[220:223], a[0:3], a[96:99], v[220:223]
s_waitcnt lgkmcnt(4)
ds_read_b64_tr_b16 a[96:97], v7 offset:32768
v_subrev_u32 v17, 2, v12
v_mfma_f32_16x16x32_bf16 v[152:155], a[104:107], a[0:3], v[152:155]
ds_read_b64_tr_b16 a[98:99], v7 offset:33792
v_lshlrev_b32 v18, 31, v17
v_mfma_f32_16x16x32_bf16 v[152:155], a[108:111], a[4:7], v[152:155]
ds_read_b64_tr_b16 a[100:101], v7 offset:40960
v_add_u32 v20, 0x8000, v20
v_mfma_f32_16x16x32_bf16 v[160:163], a[108:111], a[12:15], v[160:163]
ds_read_b64_tr_b16 a[102:103], v7 offset:41984
v_or_b32 v21, v17, v18
v_mfma_f32_16x16x32_bf16 v[160:163], a[104:107], a[8:11], v[160:163]
v_ashrrev_i32 v21, 31, v21
v_and_b32 v250, 0xff800000, v21
v_mfma_f32_16x16x32_bf16 v[168:171], a[104:107], a[16:19], v[168:171]
v_not_b32 v17, v17
v_or_b32 v21, v17, v18
v_mfma_f32_16x16x32_bf16 v[168:171], a[108:111], a[20:23], v[168:171]
v_ashrrev_i32 v21, 31, v21
v_and_b32 v254, 0xff800000, v21
v_mfma_f32_16x16x32_bf16 v[176:179], a[108:111], a[28:31], v[176:179]
v_subrev_u32 v17, 3, v12
v_lshlrev_b32 v18, 31, v17
v_mfma_f32_16x16x32_bf16 v[176:179], a[104:107], a[24:27], v[176:179]
ds_read_b64_tr_b16 a[104:105], v8 offset:32768
v_or_b32 v21, v17, v18
v_mfma_f32_16x16x32_bf16 v[180:183], a[112:115], a[24:27], v[180:183]
ds_read_b64_tr_b16 a[106:107], v8 offset:33792
v_ashrrev_i32 v21, 31, v21
v_mfma_f32_16x16x32_bf16 v[180:183], a[116:119], a[28:31], v[180:183]
ds_read_b64_tr_b16 a[108:109], v8 offset:40960
v_add_u32 v4, 0x8000, v4
v_mfma_f32_16x16x32_bf16 v[172:175], a[116:119], a[20:23], v[172:175]
ds_read_b64_tr_b16 a[110:111], v8 offset:41984
v_and_b32 v251, 0xff800000, v21
v_mfma_f32_16x16x32_bf16 v[172:175], a[112:115], a[16:19], v[172:175]
v_not_b32 v17, v17
v_or_b32 v21, v17, v18
v_mfma_f32_16x16x32_bf16 v[164:167], a[112:115], a[8:11], v[164:167]
s_add_u32 s17, s78, .-L_pc+6144
v_ashrrev_i32 v21, 31, v21
v_and_b32 v255, 0xff800000, v21
v_mfma_f32_16x16x32_bf16 v[164:167], a[116:119], a[12:15], v[164:167]
s_and_b32 s66, s2, 7
s_lshr_b32 s67, s2, 3
s_and_b32 s83, s66, 1
v_mfma_f32_16x16x32_bf16 v[156:159], a[116:119], a[4:7], v[156:159]
s_and_b32 s68, s66, 2
s_and_b32 s69, s67, 7
s_lshl2_add_u32 s82, s68, s69
v_mfma_f32_16x16x32_bf16 v[156:159], a[112:115], a[0:3], v[156:159]
s_and_b32 s68, s66, 4
s_lshr_b32 s69, s67, 3
ds_read_b64_tr_b16 a[112:113], v9 offset:32768
v_mfma_f32_16x16x32_bf16 v[24:27], a[72:75], a[0:3], v[24:27]
s_xor_b32 s69, s69, 0
s_add_u32 s87, s68, s69
ds_read_b64_tr_b16 a[114:115], v9 offset:33792
v_mfma_f32_16x16x32_bf16 v[24:27], a[76:79], a[4:7], v[24:27]
s_lshl_b32 s87, s87, 8
ds_read_b64_tr_b16 a[116:117], v9 offset:40960
v_add_u32 v5, 0x8000, v5
v_mfma_f32_16x16x32_bf16 v[40:43], a[76:79], a[12:15], v[40:43]
s_lshl_b32 s86, s30, 13
buffer_load_dword a252, v16, s[88:91], s17 offen
v_mfma_f32_16x16x32_bf16 v[40:43], a[72:75], a[8:11], v[40:43]
s_lshl_b32 s85, s30, 16
s_add_u32 s85, s85, s87
ds_read_b64_tr_b16 a[118:119], v9 offset:41984
v_mfma_f32_16x16x32_bf16 v[56:59], a[72:75], a[16:19], v[56:59]
s_mul_i32 s66, s83, 1310720
s_add_u32 s85, s85, s66
s_mul_i32 s84, s82, 1310720
v_mfma_f32_16x16x32_bf16 v[56:59], a[76:79], a[20:23], v[56:59]
s_and_b32 s66, s30, 1
s_lshl_b32 s66, s66, 14
s_add_u32 s84, s84, s66
v_mfma_f32_16x16x32_bf16 v[72:75], a[76:79], a[28:31], v[72:75]
s_waitcnt vmcnt(9)
s_mul_i32 s66, s83, 163840
ds_read_b128 a[32:35], v2 offset:32768
v_mfma_f32_16x16x32_bf16 v[72:75], a[72:75], a[24:27], v[72:75]
s_add_u32 s84, s84, s66
s_add_u32 s84, s84, 34603008
s_add_u32 s17, s78, .-L_pc+9984
ds_read_b128 a[36:39], v3 offset:32768
v_mfma_f32_16x16x32_bf16 v[136:139], a[80:83], a[24:27], v[136:139]
s_sub_u32 s66, 15, s82
buffer_load_dword a252, v16, s[88:91], s17 offen
v_mfma_f32_16x16x32_bf16 v[136:139], a[84:87], a[28:31], v[136:139]
s_min_u32 s66, s66, s82
ds_read_b128 a[40:43], v2 offset:34816
v_add_u32 v6, 0x8000, v6
v_mfma_f32_16x16x32_bf16 v[120:123], a[84:87], a[20:23], v[120:123]
s_lshl1_add_u32 s66, s66, s83
s_lshl_b32 s80, s66, 8
ds_read_b128 a[44:47], v3 offset:34816
v_mfma_f32_16x16x32_bf16 v[120:123], a[80:83], a[16:19], v[120:123]
s_add_u32 s80, s80, 8192
s_and_b32 s67, s30, 1
ds_read_b128 a[48:51], v2 offset:36864
v_mfma_f32_16x16x32_bf16 v[104:107], a[80:83], a[8:11], v[104:107]
s_lshl_b32 s67, s67, 7
s_add_u32 s67, s67, s83
ds_read_b128 a[52:55], v3 offset:36864
v_mfma_f32_16x16x32_bf16 v[104:107], a[84:87], a[12:15], v[104:107]
s_lshl_b32 s67, s67, 7
s_add_u32 s67, s67, 98304
ds_read_b128 a[56:59], v2 offset:38912
v_mfma_f32_16x16x32_bf16 v[88:91], a[84:87], a[4:7], v[88:91]
s_lshl_b32 s66, s30, 11
ds_read_b128 a[60:63], v3 offset:38912
v_lshrrev_b32 v14, 4, v0
v_mfma_f32_16x16x32_bf16 v[88:91], a[80:83], a[0:3], v[88:91]
s_waitcnt lgkmcnt(8)
ds_read_b64_tr_b16 a[72:73], v10 offset:32768
v_bfe_u32 v12, v0, 1, 3
v_mfma_f32_16x16x32_bf16 v[28:31], a[88:91], a[0:3], v[28:31]
ds_read_b64_tr_b16 a[74:75], v10 offset:33792
v_xor_b32 v12, v12, v14
v_mfma_f32_16x16x32_bf16 v[28:31], a[92:95], a[4:7], v[28:31]
ds_read_b64_tr_b16 a[76:77], v10 offset:40960
v_add_u32 v7, 0x8000, v7
v_mfma_f32_16x16x32_bf16 v[44:47], a[92:95], a[12:15], v[44:47]
ds_read_b64_tr_b16 a[78:79], v10 offset:41984
v_lshlrev_b32 v12, 5, v12
v_mfma_f32_16x16x32_bf16 v[44:47], a[88:91], a[8:11], v[44:47]
ds_read_b64_tr_b16 a[80:81], v11 offset:32768
v_lshl_add_u32 v12, v14, 11, v12
v_mfma_f32_16x16x32_bf16 v[60:63], a[88:91], a[16:19], v[60:63]
ds_read_b64_tr_b16 a[82:83], v11 offset:33792
v_and_b32 v14, 1, v0
v_mfma_f32_16x16x32_bf16 v[60:63], a[92:95], a[20:23], v[60:63]
ds_read_b64_tr_b16 a[84:85], v11 offset:40960
v_lshl_add_u32 v12, v14, 4, v12
v_mfma_f32_16x16x32_bf16 v[76:79], a[92:95], a[28:31], v[76:79]
s_add_u32 s17, s78, .-L_pc+13824
ds_read_b64_tr_b16 a[86:87], v11 offset:41984
v_xor_b32 v13, 128, v12
v_mfma_f32_16x16x32_bf16 v[76:79], a[88:91], a[24:27], v[76:79]
buffer_load_dword a252, v16, s[88:91], s17 offen
v_mfma_f32_16x16x32_bf16 v[140:143], a[96:99], a[24:27], v[140:143]
v_readfirstlane_b32 vcc_lo, v1
s_nop 0
s_cmp_lt_u32 vcc_lo, s81
s_cbranch_scc1 L_spin_4
L_spinbk_5:
v_mfma_f32_16x16x32_bf16 v[140:143], a[100:103], a[28:31], v[140:143]
s_add_u32 s17, s78, L_F1-L_pc
v_add_u32 v8, 0x8000, v8
v_lshrrev_b32 v14, 4, v0
v_mfma_f32_16x16x32_bf16 v[124:127], a[100:103], a[20:23], v[124:127]
buffer_load_dword a252, v16, s[88:91], s17 offen
v_mfma_f32_16x16x32_bf16 v[124:127], a[96:99], a[16:19], v[124:127]
v_bfe_u32 v18, v0, 2, 2
v_lshl_add_u32 v14, v14, 2, v18
v_mfma_f32_16x16x32_bf16 v[108:111], a[96:99], a[8:11], v[108:111]
s_add_u32 s17, s78, L_F1-L_pc+4096
v_and_b32 v18, 3, v0
v_lshlrev_b32 v18, 3, v18
v_mfma_f32_16x16x32_bf16 v[108:111], a[100:103], a[12:15], v[108:111]
buffer_load_dword a252, v16, s[88:91], s17 offen
v_mfma_f32_16x16x32_bf16 v[92:95], a[100:103], a[4:7], v[92:95]
v_add_u32 v9, 0x8000, v9
v_add_u32 v10, 0x8000, v10
v_mfma_f32_16x16x32_bf16 v[92:95], a[96:99], a[0:3], v[92:95]
v_add_u32 v11, 0x8000, v11
v_lshl_add_u32 v18, v14, 8, v18
v_mfma_f32_16x16x32_bf16 v[32:35], a[104:107], a[0:3], v[32:35]
v_and_b32 v14, 7, v14
v_lshl_add_u32 v18, v14, 5, v18
v_mfma_f32_16x16x32_bf16 v[32:35], a[108:111], a[4:7], v[32:35]
v_xor_b32 v18, s67, v18
v_add_u32 v14, s66, v16
v_mfma_f32_16x16x32_bf16 v[48:51], a[108:111], a[12:15], v[48:51]
s_waitcnt lgkmcnt(0)
s_barrier
v_mfma_f32_16x16x32_bf16 v[48:51], a[104:107], a[8:11], v[48:51]
ds_read_b64_tr_b16 a[88:89], v19 offset:36864
v_xor_b32 v15, 0x800, v14
v_mfma_f32_16x16x32_bf16 v[64:67], a[104:107], a[16:19], v[64:67]
s_lshr_b32 s66, s30, 1
s_lshl_b32 s66, s66, 16
ds_read_b64_tr_b16 a[90:91], v19 offset:37120
v_mfma_f32_16x16x32_bf16 v[64:67], a[108:111], a[20:23], v[64:67]
s_and_b32 s67, s30, 1
s_lshl_b32 s67, s67, 10
s_mov_b32 m0, s76
ds_read_b64_tr_b16 a[92:93], v19 offset:38912
v_mfma_f32_16x16x32_bf16 v[80:83], a[108:111], a[28:31], v[80:83]
s_add_u32 s66, s66, s67
s_add_u32 s66, s66, 32768
s_lshl_b32 s64, s30, 14
ds_read_b64_tr_b16 a[94:95], v19 offset:39168
v_mfma_f32_16x16x32_bf16 v[80:83], a[104:107], a[24:27], v[80:83]
buffer_load_dwordx4 v16, s[32:35], s64 offen offset:0 sc1 lds
v_mfma_f32_16x16x32_bf16 v[144:147], a[112:115], a[24:27], v[144:147]
ds_read_b64_tr_b16 a[96:97], v20 offset:36864
v_add_u32 v17, s66, v16
v_mfma_f32_16x16x32_bf16 v[144:147], a[116:119], a[28:31], v[144:147]
ds_read_b64_tr_b16 a[98:99], v20 offset:37120
v_lshlrev_b32 v21, 5, v0
v_mfma_f32_16x16x32_bf16 v[128:131], a[116:119], a[20:23], v[128:131]
s_lshl2_add_u32 s73, s2, s30
s_lshl_b32 s73, s73, 11
s_lshl_b32 s66, s30, 11
v_mfma_f32_16x16x32_bf16 v[128:131], a[112:115], a[16:19], v[128:131]
s_add_u32 s66, s66, 32768
buffer_load_dwordx4 v16, s[32:35], s64 offen offset:1024 sc1 lds
v_mfma_f32_16x16x32_bf16 v[112:115], a[112:115], a[8:11], v[112:115]
ds_read_b64_tr_b16 a[100:101], v20 offset:38912
v_add_u32 v2, s66, v16
v_mfma_f32_16x16x32_bf16 v[112:115], a[116:119], a[12:15], v[112:115]
ds_read_b64_tr_b16 a[102:103], v20 offset:39168
v_add_u32 v3, 0x10000, v2
v_mfma_f32_16x16x32_bf16 v[96:99], a[116:119], a[4:7], v[96:99]
ds_read_b64_tr_b16 a[104:105], v19 offset:40960
v_mfma_f32_16x16x32_bf16 v[96:99], a[112:115], a[0:3], v[96:99]
buffer_load_dwordx4 v16, s[32:35], s64 offen offset:2048 sc1 lds
v_mfma_f32_16x16x32_bf16 v[36:39], a[72:75], a[0:3], v[36:39]
ds_read_b64_tr_b16 a[106:107], v19 offset:41216
v_mfma_f32_16x16x32_bf16 v[36:39], a[76:79], a[4:7], v[36:39]
ds_read_b64_tr_b16 a[108:109], v19 offset:43008
v_mfma_f32_16x16x32_bf16 v[52:55], a[76:79], a[12:15], v[52:55]
ds_read_b64_tr_b16 a[110:111], v19 offset:43264
v_mfma_f32_16x16x32_bf16 v[52:55], a[72:75], a[8:11], v[52:55]
buffer_load_dwordx4 v16, s[32:35], s64 offen offset:3072 sc1 lds
v_mfma_f32_16x16x32_bf16 v[68:71], a[72:75], a[16:19], v[68:71]
ds_read_b64_tr_b16 a[112:113], v20 offset:40960
v_mfma_f32_16x16x32_bf16 v[68:71], a[76:79], a[20:23], v[68:71]
s_add_u32 m0, s76, 4096
ds_read_b64_tr_b16 a[114:115], v20 offset:41216
v_mfma_f32_16x16x32_bf16 v[84:87], a[76:79], a[28:31], v[84:87]
s_add_u32 s64, s64, 4096
ds_read_b64_tr_b16 a[116:117], v20 offset:43008
v_mfma_f32_16x16x32_bf16 v[84:87], a[72:75], a[24:27], v[84:87]
buffer_load_dwordx4 v16, s[32:35], s64 offen offset:0 sc1 lds
v_mfma_f32_16x16x32_bf16 v[148:151], a[80:83], a[24:27], v[148:151]
ds_read_b64_tr_b16 a[118:119], v20 offset:43264
v_mfma_f32_16x16x32_bf16 v[148:151], a[84:87], a[28:31], v[148:151]
ds_read_b64_tr_b16 a[72:73], v19 offset:32768
v_mfma_f32_16x16x32_bf16 v[132:135], a[84:87], a[20:23], v[132:135]
ds_read_b64_tr_b16 a[74:75], v19 offset:33024
v_mfma_f32_16x16x32_bf16 v[132:135], a[80:83], a[16:19], v[132:135]
buffer_load_dwordx4 v16, s[32:35], s64 offen offset:1024 sc1 lds
v_mfma_f32_16x16x32_bf16 v[116:119], a[80:83], a[8:11], v[116:119]
ds_read_b64_tr_b16 a[76:77], v19 offset:34816
v_mfma_f32_16x16x32_bf16 v[116:119], a[84:87], a[12:15], v[116:119]
ds_read_b64_tr_b16 a[78:79], v19 offset:35072
v_mfma_f32_16x16x32_bf16 v[100:103], a[84:87], a[4:7], v[100:103]
v_mfma_f32_16x16x32_bf16 v[100:103], a[80:83], a[0:3], v[100:103]
s_waitcnt lgkmcnt(6)
buffer_load_dwordx4 v16, s[32:35], s64 offen offset:2048 sc1 lds
v_mfma_f32_16x16x32_bf16 v[184:187], a[88:91], a[32:35], v[184:187]
ds_read_b64_tr_b16 a[80:81], v20 offset:32768
v_bfe_u32 v1, v0, 1, 1
v_mfma_f32_16x16x32_bf16 v[184:187], a[92:95], a[36:39], v[184:187]
ds_read_b64_tr_b16 a[82:83], v20 offset:33024
v_subrev_u32 v1, 1, v1
v_mfma_f32_16x16x32_bf16 v[192:195], a[92:95], a[44:47], v[192:195]
ds_read_b64_tr_b16 a[84:85], v20 offset:34816
v_and_b32 v1, 0x3f803f80, v1
v_mfma_f32_16x16x32_bf16 v[192:195], a[88:91], a[40:43], v[192:195]
buffer_load_dwordx4 v16, s[32:35], s64 offen offset:3072 sc1 lds
v_mfma_f32_16x16x32_bf16 v[200:203], a[88:91], a[48:51], v[200:203]
ds_read_b64_tr_b16 a[86:87], v20 offset:35072
v_accvgpr_write_b32 a240, v1
v_mfma_f32_16x16x32_bf16 v[200:203], a[92:95], a[52:55], v[200:203]
v_accvgpr_write_b32 a241, v1
v_accvgpr_write_b32 a242, v1
v_mfma_f32_16x16x32_bf16 v[208:211], a[92:95], a[60:63], v[208:211]
s_lshr_b32 s64, s76, 1
s_add_u32 m0, s64, 81920
s_and_b32 s71, s64, 8192
s_add_u32 s64, s64, s71
s_add_u32 s64, s64, 8192
v_accvgpr_write_b32 a243, v1
v_mfma_f32_16x16x32_bf16 v[208:211], a[88:91], a[56:59], v[208:211]
buffer_load_dwordx4 v16, s[32:35], s64 offen offset:0 sc1 lds
v_mfma_f32_16x16x32_bf16 v[212:215], a[96:99], a[56:59], v[212:215]
ds_read_b64_tr_b16 a[88:89], v4 offset:32768
v_mfma_f32_16x16x32_bf16 v[212:215], a[100:103], a[60:63], v[212:215]
ds_read_b64_tr_b16 a[90:91], v4 offset:33792
v_mfma_f32_16x16x32_bf16 v[204:207], a[100:103], a[52:55], v[204:207]
ds_read_b64_tr_b16 a[92:93], v4 offset:40960
v_mfma_f32_16x16x32_bf16 v[204:207], a[96:99], a[48:51], v[204:207]
buffer_load_dwordx4 v16, s[32:35], s64 offen offset:1024 sc1 lds
v_mfma_f32_16x16x32_bf16 v[196:199], a[96:99], a[40:43], v[196:199]
ds_read_b64_tr_b16 a[94:95], v4 offset:41984
v_mfma_f32_16x16x32_bf16 v[196:199], a[100:103], a[44:47], v[196:199]
s_or_b32 s66, s3, s30
s_cmp_eq_u32 s66, 0
s_cselect_b32 s66, 0xff800000, 0
v_mfma_f32_16x16x32_bf16 v[188:191], a[100:103], a[36:39], v[188:191]
s_and_b32 s67, s74, 0x7800
s_cselect_b32 s67, 0, 0x70000000
s_add_u32 s77, s74, s67
v_mfma_f32_16x16x32_bf16 v[188:191], a[96:99], a[32:35], v[188:191]
s_sub_u32 s77, s77, 2048
buffer_load_dwordx4 v16, s[32:35], s64 offen offset:2048 sc1 lds
v_mfma_f32_16x16x32_bf16 v[216:219], a[32:35], a[104:107], v[216:219]
s_mov_b32 s68, 0x3e0293ee
ds_read_b64_tr_b16 a[96:97], v5 offset:32768
v_mfma_f32_16x16x32_bf16 v[216:219], a[36:39], a[108:111], v[216:219]
s_mov_b32 s69, s68
ds_read_b64_tr_b16 a[98:99], v5 offset:33792
v_cvt_pk_bf16_f32 v208, v208, v209
v_mfma_f32_16x16x32_bf16 v[224:227], a[44:47], a[108:111], v[224:227]
ds_read_b64_tr_b16 a[100:101], v5 offset:40960
v_cvt_pk_bf16_f32 v209, v210, v211
v_mfma_f32_16x16x32_bf16 v[224:227], a[40:43], a[104:107], v[224:227]
buffer_load_dwordx4 v16, s[32:35], s64 offen offset:3072 sc1 lds
v_mfma_f32_16x16x32_bf16 v[232:235], a[48:51], a[104:107], v[232:235]
ds_read_b64_tr_b16 a[102:103], v5 offset:41984
v_cvt_pk_bf16_f32 v210, v212, v213
v_mfma_f32_16x16x32_bf16 v[232:235], a[52:55], a[108:111], v[232:235]
v_cvt_pk_bf16_f32 v211, v214, v215
v_mfma_f32_16x16x32_bf16 v[240:243], a[60:63], a[108:111], v[240:243]
ds_write_b128 v3, v[208:211] offset:10240
v_mfma_f32_16x16x32_bf16 v[240:243], a[56:59], a[104:107], v[240:243]
ds_read_b64_tr_b16 a[104:105], v6 offset:32768
v_cvt_pk_bf16_f32 v200, v200, v201
v_mfma_f32_16x16x32_bf16 v[244:247], a[56:59], a[112:115], v[244:247]
s_waitcnt lgkmcnt(6)
ds_read_b64_tr_b16 a[106:107], v6 offset:33792
v_cvt_pk_bf16_f32 v201, v202, v203
v_mfma_f32_16x16x32_bf16 v[244:247], a[60:63], a[116:119], v[244:247]
ds_read_b64_tr_b16 a[108:109], v6 offset:40960
v_cvt_pk_bf16_f32 v202, v204, v205
v_mfma_f32_16x16x32_bf16 v[236:239], a[52:55], a[116:119], v[236:239]
ds_read_b64_tr_b16 a[110:111], v6 offset:41984
v_cvt_pk_bf16_f32 v203, v206, v207
v_mfma_f32_16x16x32_bf16 v[236:239], a[48:51], a[112:115], v[236:239]
ds_write_b128 v3, v[200:203] offset:2048
v_mfma_f32_16x16x32_bf16 v[228:231], a[40:43], a[112:115], v[228:231]
v_cvt_pk_bf16_f32 v192, v192, v193
v_cvt_pk_bf16_f32 v193, v194, v195
v_mfma_f32_16x16x32_bf16 v[228:231], a[44:47], a[116:119], v[228:231]
v_cvt_pk_bf16_f32 v194, v196, v197
v_cvt_pk_bf16_f32 v195, v198, v199
v_mfma_f32_16x16x32_bf16 v[220:223], a[36:39], a[116:119], v[220:223]
ds_write_b128 v2, v[192:195] offset:10240
v_mfma_f32_16x16x32_bf16 v[220:223], a[32:35], a[112:115], v[220:223]
ds_read_b64_tr_b16 a[112:113], v7 offset:32768
v_cvt_pk_bf16_f32 v184, v184, v185
v_mfma_f32_16x16x32_bf16 v[152:155], a[72:75], a[32:35], v[152:155]
ds_read_b64_tr_b16 a[114:115], v7 offset:33792
v_cvt_pk_bf16_f32 v185, v186, v187
v_mfma_f32_16x16x32_bf16 v[152:155], a[76:79], a[36:39], v[152:155]
ds_read_b64_tr_b16 a[116:117], v7 offset:40960
v_cvt_pk_bf16_f32 v186, v188, v189
v_mfma_f32_16x16x32_bf16 v[160:163], a[76:79], a[44:47], v[160:163]
ds_read_b64_tr_b16 a[118:119], v7 offset:41984
v_cvt_pk_bf16_f32 v187, v190, v191
v_mfma_f32_16x16x32_bf16 v[160:163], a[72:75], a[40:43], v[160:163]
ds_write_b128 v2, v[184:187] offset:2048
v_mfma_f32_16x16x32_bf16 v[168:171], a[72:75], a[48:51], v[168:171]
v_cvt_pk_bf16_f32 v219, v218, v219
v_cvt_pk_bf16_f32 v218, v216, v217
v_mfma_f32_16x16x32_bf16 v[168:171], a[76:79], a[52:55], v[168:171]
ds_write_b64 v2, v[218:219] offset:3072
v_mfma_f32_16x16x32_bf16 v[176:179], a[76:79], a[60:63], v[176:179]
buffer_load_dword a252, v21, s[36:39], s73 offen
v_mfma_f32_16x16x32_bf16 v[176:179], a[72:75], a[56:59], v[176:179]
ds_read_b64_tr_b16 a[72:73], v8 offset:32768
v_cvt_pk_bf16_f32 v227, v226, v227
v_mfma_f32_16x16x32_bf16 v[180:183], a[80:83], a[56:59], v[180:183]
ds_read_b64_tr_b16 a[74:75], v8 offset:33792
v_cvt_pk_bf16_f32 v226, v224, v225
v_mfma_f32_16x16x32_bf16 v[180:183], a[84:87], a[60:63], v[180:183]
ds_write_b64 v2, v[226:227] offset:11264
v_mfma_f32_16x16x32_bf16 v[172:175], a[84:87], a[52:55], v[172:175]
ds_read_b64_tr_b16 a[76:77], v8 offset:40960
v_cvt_pk_bf16_f32 v235, v234, v235
v_mfma_f32_16x16x32_bf16 v[172:175], a[80:83], a[48:51], v[172:175]
ds_read_b64_tr_b16 a[78:79], v8 offset:41984
v_cvt_pk_bf16_f32 v234, v232, v233
v_mfma_f32_16x16x32_bf16 v[164:167], a[80:83], a[40:43], v[164:167]
ds_write_b64 v3, v[234:235] offset:3072
v_mfma_f32_16x16x32_bf16 v[164:167], a[84:87], a[44:47], v[164:167]
v_cvt_pk_bf16_f32 v243, v242, v243
v_cvt_pk_bf16_f32 v242, v240, v241
v_mfma_f32_16x16x32_bf16 v[156:159], a[84:87], a[36:39], v[156:159]
ds_write_b64 v3, v[242:243] offset:11264
v_mfma_f32_16x16x32_bf16 v[156:159], a[80:83], a[32:35], v[156:159]
ds_read_b64_tr_b16 a[80:81], v9 offset:32768
v_cvt_pk_bf16_f32 v247, v246, v247
v_mfma_f32_16x16x32_bf16 v[24:27], a[88:91], a[32:35], v[24:27]
ds_read_b64_tr_b16 a[82:83], v9 offset:33792
v_cvt_pk_bf16_f32 v246, v244, v245
v_mfma_f32_16x16x32_bf16 v[24:27], a[92:95], a[36:39], v[24:27]
ds_write_b64 v3, v[246:247] offset:11272
v_mfma_f32_16x16x32_bf16 v[40:43], a[92:95], a[44:47], v[40:43]
ds_read_b64_tr_b16 a[84:85], v9 offset:40960
v_cvt_pk_bf16_f32 v239, v238, v239
v_cvt_pk_bf16_f32 v238, v236, v237
v_mfma_f32_16x16x32_bf16 v[40:43], a[88:91], a[40:43], v[40:43]
ds_write_b64 v3, v[238:239] offset:3080
v_mfma_f32_16x16x32_bf16 v[56:59], a[88:91], a[48:51], v[56:59]
ds_read_b64_tr_b16 a[86:87], v9 offset:41984
v_cvt_pk_bf16_f32 v231, v230, v231
v_cvt_pk_bf16_f32 v230, v228, v229
v_mfma_f32_16x16x32_bf16 v[56:59], a[92:95], a[52:55], v[56:59]
ds_write_b64 v2, v[230:231] offset:11272
v_mfma_f32_16x16x32_bf16 v[72:75], a[92:95], a[60:63], v[72:75]
v_cvt_pk_bf16_f32 v223, v222, v223
v_cvt_pk_bf16_f32 v222, v220, v221
v_mfma_f32_16x16x32_bf16 v[72:75], a[88:91], a[56:59], v[72:75]
s_waitcnt lgkmcnt(8)
ds_write_b64 v2, v[222:223] offset:3080
v_mfma_f32_16x16x32_bf16 v[136:139], a[96:99], a[56:59], v[136:139]
ds_read_b64_tr_b16 a[88:89], v10 offset:32768
v_cvt_pk_bf16_f32 v176, v176, v177
v_mfma_f32_16x16x32_bf16 v[136:139], a[100:103], a[60:63], v[136:139]
s_waitcnt lgkmcnt(0)
s_barrier
v_mfma_f32_16x16x32_bf16 v[120:123], a[100:103], a[52:55], v[120:123]
ds_read_b128 a[16:19], v17 offset:16384
v_cvt_pk_bf16_f32 v177, v178, v179
v_mfma_f32_16x16x32_bf16 v[120:123], a[96:99], a[48:51], v[120:123]
ds_read_b64_tr_b16 a[90:91], v10 offset:33792
v_cvt_pk_bf16_f32 v178, v180, v181
v_mfma_f32_16x16x32_bf16 v[104:107], a[96:99], a[40:43], v[104:107]
ds_read_b64_tr_b16 a[92:93], v10 offset:40960
v_cvt_pk_bf16_f32 v179, v182, v183
v_mfma_f32_16x16x32_bf16 v[104:107], a[100:103], a[44:47], v[104:107]
ds_read_b64_tr_b16 a[94:95], v10 offset:41984
v_cvt_pk_bf16_f32 v168, v168, v169
v_mfma_f32_16x16x32_bf16 v[88:91], a[100:103], a[36:39], v[88:91]
v_cvt_pk_bf16_f32 v169, v170, v171
v_cvt_pk_bf16_f32 v170, v172, v173
v_mfma_f32_16x16x32_bf16 v[88:91], a[96:99], a[32:35], v[88:91]
ds_read_b64_tr_b16 a[96:97], v11 offset:32768
v_cvt_pk_bf16_f32 v171, v174, v175
v_mfma_f32_16x16x32_bf16 v[28:31], a[104:107], a[32:35], v[28:31]
s_waitcnt lgkmcnt(4)
buffer_store_dwordx4 a[16:19], v16, s[44:47], s74 offen sc1
v_mfma_f32_16x16x32_bf16 v[28:31], a[108:111], a[36:39], v[28:31]
ds_read_b64_tr_b16 a[98:99], v11 offset:33792
v_cvt_pk_bf16_f32 v160, v160, v161
v_mfma_f32_16x16x32_bf16 v[44:47], a[108:111], a[44:47], v[44:47]
ds_read_b64_tr_b16 a[100:101], v11 offset:40960
v_cvt_pk_bf16_f32 v161, v162, v163
v_mfma_f32_16x16x32_bf16 v[44:47], a[104:107], a[40:43], v[44:47]
s_sub_u32 s81, s3, 1
ds_read_b64_tr_b16 a[102:103], v11 offset:41984
v_cvt_pk_bf16_f32 v162, v164, v165
v_mfma_f32_16x16x32_bf16 v[60:63], a[104:107], a[48:51], v[60:63]
s_sub_u32 s67, s3, 2
ds_read_b128 a[4:7], v2 offset:8192
v_cvt_pk_bf16_f32 v163, v166, v167
v_mfma_f32_16x16x32_bf16 v[60:63], a[108:111], a[52:55], v[60:63]
s_mul_i32 s81, s81, s67
ds_read_b128 a[12:15], v3 offset:8192
v_cvt_pk_bf16_f32 v152, v152, v153
v_mfma_f32_16x16x32_bf16 v[76:79], a[108:111], a[60:63], v[76:79]
s_lshl4_add_u32 s81, s81, s31
ds_read_b64 v[224:225], v2 offset:9216
v_cvt_pk_bf16_f32 v153, v154, v155
v_mfma_f32_16x16x32_bf16 v[76:79], a[104:107], a[56:59], v[76:79]
s_lshl2_add_u32 s81, s81, s30
ds_read_b64 v[228:229], v2 offset:9224
v_cvt_pk_bf16_f32 v154, v156, v157
v_mfma_f32_16x16x32_bf16 v[140:143], a[112:115], a[56:59], v[140:143]
s_mul_i32 s81, s81, 3328
ds_read_b64 v[240:241], v3 offset:9216
v_cvt_pk_bf16_f32 v155, v158, v159
v_mfma_f32_16x16x32_bf16 v[140:143], a[116:119], a[60:63], v[140:143]
s_mov_b32 s73, 0
ds_read_b64 v[244:245], v3 offset:9224
v_or_b32 v20, s66, v252
v_mfma_f32_16x16x32_bf16 v[124:127], a[116:119], a[52:55], v[124:127]
s_mov_b32 s72, 0x20000
v_or_b32 v21, s66, v253
v_or_b32 v22, s66, v254
v_mfma_f32_16x16x32_bf16 v[124:127], a[112:115], a[48:51], v[124:127]
s_lshl_b32 s67, s31, 15
v_or_b32 v23, s66, v255
v_mfma_f32_16x16x32_bf16 v[108:111], a[112:115], a[40:43], v[108:111]
s_add_u32 s67, s67, s78
s_mov_b32 s66, 0x3e8293ee
v_mul_f32 v72, s68, v72
v_mfma_f32_16x16x32_bf16 v[108:111], a[116:119], a[44:47], v[108:111]
s_add_u32 s67, s67, 33554432
v_mul_f32 v73, s68, v73
v_mul_f32 v74, s68, v74
v_mfma_f32_16x16x32_bf16 v[92:95], a[116:119], a[36:39], v[92:95]
s_mul_i32 s74, s3, 1310720
v_mul_f32 v75, s68, v75
v_mul_f32 v136, s68, v136
v_mfma_f32_16x16x32_bf16 v[92:95], a[112:115], a[32:35], v[92:95]
s_add_u32 s74, s74, s67
v_mul_f32 v137, s68, v137
v_mul_f32 v138, s68, v138
v_mfma_f32_16x16x32_bf16 v[32:35], a[72:75], a[32:35], v[32:35]
s_mul_i32 s75, s16, 1310720
v_mul_f32 v139, s68, v139
v_cvt_pk_bf16_f32 v72, v72, v73
v_mfma_f32_16x16x32_bf16 v[32:35], a[76:79], a[36:39], v[32:35]
s_add_u32 s75, s75, s67
v_cvt_pk_bf16_f32 v73, v74, v75
v_cvt_pk_bf16_f32 v74, v136, v137
v_mfma_f32_16x16x32_bf16 v[48:51], a[76:79], a[44:47], v[48:51]
s_mul_i32 s67, s31, 24576
v_cvt_pk_bf16_f32 v75, v138, v139
v_mul_f32 v56, s68, v56
v_mfma_f32_16x16x32_bf16 v[48:51], a[72:75], a[40:43], v[48:51]
s_sub_u32 s67, 1052672, s67
v_mul_f32 v57, s68, v57
v_mul_f32 v58, s68, v58
v_mfma_f32_16x16x32_bf16 v[64:67], a[72:75], a[48:51], v[64:67]
s_add_u32 s64, s74, s67
v_mul_f32 v59, s68, v59
v_mul_f32 v120, s68, v120
v_mfma_f32_16x16x32_bf16 v[64:67], a[76:79], a[52:55], v[64:67]
s_add_u32 s65, s75, s67
v_mul_f32 v121, s68, v121
v_mul_f32 v122, s68, v122
v_mfma_f32_16x16x32_bf16 v[80:83], a[76:79], a[60:63], v[80:83]
s_and_b32 s70, s30, 1
v_mul_f32 v123, s68, v123
v_cvt_pk_bf16_f32 v56, v56, v57
v_mfma_f32_16x16x32_bf16 v[80:83], a[72:75], a[56:59], v[80:83]
s_lshr_b32 s67, s30, 1
v_cvt_pk_bf16_f32 v57, v58, v59
v_cvt_pk_bf16_f32 v58, v120, v121
v_mfma_f32_16x16x32_bf16 v[144:147], a[80:83], a[56:59], v[144:147]
s_lshl3_add_u32 s71, s67, s70
v_cvt_pk_bf16_f32 v59, v122, v123
v_mul_f32 v40, s68, v40
v_mfma_f32_16x16x32_bf16 v[144:147], a[84:87], a[60:63], v[144:147]
s_add_u32 s71, s71, 4
v_mul_f32 v41, s68, v41
v_mul_f32 v42, s68, v42
v_mfma_f32_16x16x32_bf16 v[128:131], a[84:87], a[52:55], v[128:131]
s_lshl_b32 s71, s71, 13
v_mul_f32 v43, s68, v43
v_mul_f32 v104, s68, v104
v_mfma_f32_16x16x32_bf16 v[128:131], a[80:83], a[48:51], v[128:131]
s_lshl_b32 s70, s70, 14
v_mul_f32 v105, s68, v105
v_mul_f32 v106, s68, v106
v_mfma_f32_16x16x32_bf16 v[112:115], a[80:83], a[40:43], v[112:115]
s_mul_i32 s67, s67, 24576
v_mul_f32 v107, s68, v107
v_cvt_pk_bf16_f32 v40, v40, v41
v_mfma_f32_16x16x32_bf16 v[112:115], a[84:87], a[44:47], v[112:115]
s_sub_u32 s70, s70, s67
v_cvt_pk_bf16_f32 v41, v42, v43
v_cvt_pk_bf16_f32 v42, v104, v105
v_mfma_f32_16x16x32_bf16 v[96:99], a[84:87], a[36:39], v[96:99]
s_add_u32 s70, s70, 65536
v_cvt_pk_bf16_f32 v43, v106, v107
v_mul_f32 v24, s68, v24
v_mfma_f32_16x16x32_bf16 v[96:99], a[80:83], a[32:35], v[96:99]
s_waitcnt lgkmcnt(0)
v_mul_f32 v25, s68, v25
v_mul_f32 v26, s68, v26
v_mfma_f32_16x16x32_bf16 v[36:39], a[88:91], a[32:35], v[36:39]
v_mul_f32 v27, s68, v27
v_mul_f32 v88, s68, v88
v_mfma_f32_16x16x32_bf16 v[36:39], a[92:95], a[36:39], v[36:39]
v_mul_f32 v89, s68, v89
v_mul_f32 v90, s68, v90
v_mfma_f32_16x16x32_bf16 v[52:55], a[92:95], a[44:47], v[52:55]
v_mul_f32 v91, s68, v91
v_cvt_pk_bf16_f32 v24, v24, v25
v_mfma_f32_16x16x32_bf16 v[52:55], a[88:91], a[40:43], v[52:55]
v_cvt_pk_bf16_f32 v25, v26, v27
v_cvt_pk_bf16_f32 v26, v88, v89
v_mfma_f32_16x16x32_bf16 v[68:71], a[88:91], a[48:51], v[68:71]
v_cvt_pk_bf16_f32 v27, v90, v91
v_mul_f32 v76, s68, v76
v_mfma_f32_16x16x32_bf16 v[68:71], a[92:95], a[52:55], v[68:71]
v_mul_f32 v77, s68, v77
v_mul_f32 v78, s68, v78
v_mfma_f32_16x16x32_bf16 v[84:87], a[92:95], a[60:63], v[84:87]
v_mul_f32 v79, s68, v79
v_mul_f32 v140, s68, v140
v_mfma_f32_16x16x32_bf16 v[84:87], a[88:91], a[56:59], v[84:87]
v_mul_f32 v141, s68, v141
v_mul_f32 v142, s68, v142
v_mfma_f32_16x16x32_bf16 v[148:151], a[96:99], a[56:59], v[148:151]
v_mul_f32 v143, s68, v143
v_cvt_pk_bf16_f32 v76, v76, v77
v_mfma_f32_16x16x32_bf16 v[148:151], a[100:103], a[60:63], v[148:151]
v_cvt_pk_bf16_f32 v77, v78, v79
v_cvt_pk_bf16_f32 v78, v140, v141
v_mfma_f32_16x16x32_bf16 v[132:135], a[100:103], a[52:55], v[132:135]
v_cvt_pk_bf16_f32 v79, v142, v143
v_mul_f32 v60, s68, v60
v_mfma_f32_16x16x32_bf16 v[132:135], a[96:99], a[48:51], v[132:135]
v_mul_f32 v61, s68, v61
v_mul_f32 v62, s68, v62
v_mfma_f32_16x16x32_bf16 v[116:119], a[96:99], a[40:43], v[116:119]
v_mul_f32 v63, s68, v63
v_mul_f32 v124, s68, v124
v_mfma_f32_16x16x32_bf16 v[116:119], a[100:103], a[44:47], v[116:119]
v_mul_f32 v125, s68, v125
v_mul_f32 v126, s68, v126
v_mfma_f32_16x16x32_bf16 v[100:103], a[100:103], a[36:39], v[100:103]
v_mul_f32 v127, s68, v127
v_cvt_pk_bf16_f32 v60, v60, v61
v_mfma_f32_16x16x32_bf16 v[100:103], a[96:99], a[32:35], v[100:103]
v_cvt_pk_bf16_f32 v61, v62, v63
v_cvt_pk_bf16_f32 v62, v124, v125
v_cvt_pk_bf16_f32 v63, v126, v127
buffer_load_dwordx4 v[88:91], v16, s[44:47], s77 offen sc1
v_mfma_f32_16x16x32_bf16 v[196:199], v[192:195], v[160:163], v[248:251]
v_mfma_f32_16x16x32_bf16 v[212:215], v[208:211], v[176:179], v[248:251]
v_mfma_f32_16x16x32_bf16 v[164:167], a[4:7], v[160:163], v[252:255]
v_mfma_f32_16x16x32_bf16 v[180:183], a[12:15], v[176:179], v[252:255]
s_waitcnt vmcnt(24)
s_waitcnt vmcnt(25)
s_waitcnt vmcnt(26)
s_waitcnt vmcnt(27)
v_accvgpr_read_b32 v4, a64
v_accvgpr_read_b32 v5, a65
v_accvgpr_read_b32 v6, a66
v_accvgpr_read_b32 v7, a67
v_accvgpr_read_b32 v8, a68
v_accvgpr_read_b32 v9, a69
v_accvgpr_read_b32 v10, a70
v_accvgpr_read_b32 v11, a71
v_max3_f32 v121, v196, v197, v198
v_max3_f32 v121, v121, v199, v164
v_max3_f32 v121, v121, v165, v166
v_max_f32 v121, v121, v167
v_max3_f32 v123, v212, v213, v214
v_max3_f32 v123, v123, v215, v180
v_max3_f32 v123, v123, v181, v182
v_max_f32 v123, v123, v183
v_mov_b32 v105, v121
v_mov_b32 v107, v123
v_pk_mul_f32 v[28:29], v[28:29], s[68:69]
v_permlane16_swap_b32 v105, v121
v_permlane16_swap_b32 v107, v123
v_max_f32 v121, v121, v105
v_max_f32 v123, v123, v107
v_mov_b32 v105, v121
v_mov_b32 v107, v123
v_pk_mul_f32 v[30:31], v[30:31], s[68:69]
v_permlane32_swap_b32 v105, v121
v_permlane32_swap_b32 v107, v123
v_max_f32 v121, v121, v105
v_max_f32 v123, v123, v107
v_mul_f32 v121, s66, v121
v_mul_f32 v123, s66, v123
v_fma_f32 v164, v164, s66, -v121
v_fma_f32 v165, v165, s66, -v121
v_fma_f32 v166, v166, s66, -v121
v_fma_f32 v167, v167, s66, -v121
v_fma_f32 v196, v196, s66, -v121
v_fma_f32 v197, v197, s66, -v121
v_fma_f32 v198, v198, s66, -v121
v_fma_f32 v199, v199, s66, -v121
v_exp_f32 v164, v164
v_exp_f32 v165, v165
v_exp_f32 v166, v166
v_exp_f32 v167, v167
v_exp_f32 v196, v196
v_exp_f32 v197, v197
v_exp_f32 v198, v198
v_exp_f32 v199, v199
v_cvt_pk_bf16_f32 v164, v164, v165
v_cvt_pk_bf16_f32 v165, v166, v167
v_cvt_pk_bf16_f32 v166, v196, v197
v_cvt_pk_bf16_f32 v167, v198, v199
v_pk_mul_f32 v[92:93], v[92:93], s[68:69]
v_pk_mul_f32 v[94:95], v[94:95], s[68:69]
v_mfma_f32_16x16x32_bf16 v[196:199], a[244:247], v[164:167], 0
v_mfma_f32_16x16x32_bf16 v[160:163], v[224:227], v[164:167], 0
v_mfma_f32_16x16x32_bf16 v[192:195], v[228:231], v[164:167], 0
v_fma_f32 v180, v180, s66, -v123
v_fma_f32 v181, v181, s66, -v123
v_fma_f32 v182, v182, s66, -v123
v_fma_f32 v183, v183, s66, -v123
v_fma_f32 v212, v212, s66, -v123
v_fma_f32 v213, v213, s66, -v123
v_fma_f32 v214, v214, s66, -v123
v_fma_f32 v215, v215, s66, -v123
v_exp_f32 v180, v180
v_exp_f32 v181, v181
v_exp_f32 v182, v182
v_exp_f32 v183, v183
v_exp_f32 v212, v212
v_exp_f32 v213, v213
v_exp_f32 v214, v214
v_exp_f32 v215, v215
v_cvt_pk_bf16_f32 v180, v180, v181
v_cvt_pk_bf16_f32 v181, v182, v183
v_cvt_pk_bf16_f32 v182, v212, v213
v_cvt_pk_bf16_f32 v183, v214, v215
v_cvt_pk_bf16_f32 v28, v28, v29
v_cvt_pk_bf16_f32 v29, v30, v31
v_mfma_f32_16x16x32_bf16 v[212:215], a[244:247], v[180:183], 0
v_mfma_f32_16x16x32_bf16 v[176:179], v[240:243], v[180:183], 0
v_mfma_f32_16x16x32_bf16 v[208:211], v[244:247], v[180:183], 0
v_cvt_pk_bf16_f32 v30, v92, v93
v_cvt_pk_bf16_f32 v31, v94, v95
v_pk_mul_f32 v[44:45], v[44:45], s[68:69]
v_pk_mul_f32 v[46:47], v[46:47], s[68:69]
v_pk_mul_f32 v[108:109], v[108:109], s[68:69]
v_pk_mul_f32 v[110:111], v[110:111], s[68:69]
v_rcp_f32 v121, v196
v_rcp_f32 v123, v212
v_mul_f32 v121, v121, v7
v_mul_f32 v123, v123, v11
v_mul_f32 v160, v160, v121
v_mul_f32 v161, v161, v121
v_mul_f32 v162, v162, v121
v_mul_f32 v163, v163, v121
v_mul_f32 v192, v192, v121
v_mul_f32 v193, v193, v121
v_mul_f32 v194, v194, v121
v_mul_f32 v195, v195, v121
v_cvt_pk_bf16_f32 v160, v160, v161
v_cvt_pk_bf16_f32 v161, v162, v163
v_cvt_pk_bf16_f32 v162, v192, v193
v_cvt_pk_bf16_f32 v163, v194, v195
buffer_store_dwordx4 v[160:163], v16, s[44:47], s64 offen sc1
v_mul_f32 v176, v176, v123
v_mul_f32 v177, v177, v123
v_mul_f32 v178, v178, v123
v_mul_f32 v179, v179, v123
v_mul_f32 v208, v208, v123
v_mul_f32 v209, v209, v123
v_mul_f32 v210, v210, v123
v_mul_f32 v211, v211, v123
v_cvt_pk_bf16_f32 v176, v176, v177
v_cvt_pk_bf16_f32 v177, v178, v179
v_cvt_pk_bf16_f32 v178, v208, v209
v_cvt_pk_bf16_f32 v179, v210, v211
buffer_store_dwordx4 v[176:179], v16, s[44:47], s65 offen sc1
v_cvt_pk_bf16_f32 v44, v44, v45
v_cvt_pk_bf16_f32 v45, v46, v47
v_cvt_pk_bf16_f32 v46, v108, v109
v_cvt_pk_bf16_f32 v47, v110, v111
v_pk_mul_f32 v[32:33], v[32:33], s[68:69]
v_pk_mul_f32 v[34:35], v[34:35], s[68:69]
v_pk_mul_f32 v[96:97], v[96:97], s[68:69]
v_pk_mul_f32 v[98:99], v[98:99], s[68:69]
v_cvt_pk_bf16_f32 v32, v32, v33
v_cvt_pk_bf16_f32 v33, v34, v35
v_cvt_pk_bf16_f32 v34, v96, v97
v_cvt_pk_bf16_f32 v35, v98, v99
v_pk_mul_f32 v[48:49], v[48:49], s[68:69]
v_pk_mul_f32 v[50:51], v[50:51], s[68:69]
v_pk_mul_f32 v[112:113], v[112:113], s[68:69]
v_pk_mul_f32 v[114:115], v[114:115], s[68:69]
v_cvt_pk_bf16_f32 v48, v48, v49
v_cvt_pk_bf16_f32 v49, v50, v51
v_cvt_pk_bf16_f32 v50, v112, v113
v_cvt_pk_bf16_f32 v51, v114, v115
v_pk_mul_f32 v[64:65], v[64:65], s[68:69]
v_pk_mul_f32 v[66:67], v[66:67], s[68:69]
v_pk_mul_f32 v[128:129], v[128:129], s[68:69]
v_pk_mul_f32 v[130:131], v[130:131], s[68:69]
s_waitcnt vmcnt(2)
L_hchk:
v_max3_u32 v1, v88, v89, v90
v_max_u32 v1, v1, v91
v_cmp_eq_u32 vcc, -1, v1
s_cbranch_vccnz L_hretry
L_hgo:
ds_write_b128 v17, v[88:91]
s_sub_u32 s64, s64, 4096
s_sub_u32 s65, s65, 4096
v_cvt_pk_bf16_f32 v64, v64, v65
v_cvt_pk_bf16_f32 v65, v66, v67
v_cvt_pk_bf16_f32 v66, v128, v129
v_cvt_pk_bf16_f32 v67, v130, v131
v_pk_mul_f32 v[80:81], v[80:81], s[68:69]
v_pk_mul_f32 v[82:83], v[82:83], s[68:69]
v_pk_mul_f32 v[144:145], v[144:145], s[68:69]
v_pk_mul_f32 v[146:147], v[146:147], s[68:69]
s_waitcnt lgkmcnt(0)
s_barrier
ds_read_b128 a[0:3], v2 offset:0
ds_read_b128 a[8:11], v3 offset:0
ds_read_b64 v[216:217], v2 offset:1024
ds_read_b64 v[220:221], v2 offset:1032
ds_read_b64 v[232:233], v3 offset:1024
ds_read_b64 v[236:237], v3 offset:1032
v_cvt_pk_bf16_f32 v80, v80, v81
v_cvt_pk_bf16_f32 v81, v82, v83
v_cvt_pk_bf16_f32 v82, v144, v145
v_cvt_pk_bf16_f32 v83, v146, v147
v_pk_mul_f32 v[36:37], v[36:37], s[68:69]
v_pk_mul_f32 v[38:39], v[38:39], s[68:69]
v_pk_mul_f32 v[100:101], v[100:101], s[68:69]
v_pk_mul_f32 v[102:103], v[102:103], s[68:69]
v_cvt_pk_bf16_f32 v36, v36, v37
v_cvt_pk_bf16_f32 v37, v38, v39
v_cvt_pk_bf16_f32 v38, v100, v101
v_cvt_pk_bf16_f32 v39, v102, v103
v_pk_mul_f32 v[52:53], v[52:53], s[68:69]
v_pk_mul_f32 v[54:55], v[54:55], s[68:69]
v_pk_mul_f32 v[116:117], v[116:117], s[68:69]
v_pk_mul_f32 v[118:119], v[118:119], s[68:69]
v_mfma_f32_16x16x32_bf16 v[188:191], v[184:187], v[152:155], v[248:251]
v_mfma_f32_16x16x32_bf16 v[204:207], v[200:203], v[168:171], v[248:251]
s_waitcnt lgkmcnt(5)
v_mfma_f32_16x16x32_bf16 v[156:159], a[0:3], v[152:155], v[20:23]
s_waitcnt lgkmcnt(4)
v_mfma_f32_16x16x32_bf16 v[172:175], a[8:11], v[168:171], v[252:255]
v_cvt_pk_bf16_f32 v52, v52, v53
v_cvt_pk_bf16_f32 v53, v54, v55
v_cvt_pk_bf16_f32 v54, v116, v117
v_cvt_pk_bf16_f32 v55, v118, v119
v_pk_mul_f32 v[68:69], v[68:69], s[68:69]
v_pk_mul_f32 v[70:71], v[70:71], s[68:69]
v_pk_mul_f32 v[132:133], v[132:133], s[68:69]
v_pk_mul_f32 v[134:135], v[134:135], s[68:69]
v_max3_f32 v120, v188, v189, v190
v_max3_f32 v120, v120, v191, v156
v_max3_f32 v120, v120, v157, v158
v_max_f32 v120, v120, v159
v_max3_f32 v122, v204, v205, v206
v_max3_f32 v122, v122, v207, v172
v_max3_f32 v122, v122, v173, v174
v_max_f32 v122, v122, v175
v_mov_b32 v104, v120
v_mov_b32 v106, v122
v_cvt_pk_bf16_f32 v68, v68, v69
v_permlane16_swap_b32 v104, v120
v_permlane16_swap_b32 v106, v122
v_max_f32 v120, v120, v104
v_max_f32 v122, v122, v106
v_mov_b32 v104, v120
v_mov_b32 v106, v122
v_cvt_pk_bf16_f32 v69, v70, v71
v_permlane32_swap_b32 v104, v120
v_permlane32_swap_b32 v106, v122
v_max_f32 v120, v120, v104
v_max_f32 v122, v122, v106
v_mul_f32 v120, s66, v120
v_mul_f32 v122, s66, v122
v_fma_f32 v156, v156, s66, -v120
v_fma_f32 v157, v157, s66, -v120
v_fma_f32 v158, v158, s66, -v120
v_fma_f32 v159, v159, s66, -v120
v_fma_f32 v188, v188, s66, -v120
v_fma_f32 v189, v189, s66, -v120
v_fma_f32 v190, v190, s66, -v120
v_fma_f32 v191, v191, s66, -v120
v_exp_f32 v156, v156
v_exp_f32 v157, v157
v_exp_f32 v158, v158
v_exp_f32 v159, v159
v_exp_f32 v188, v188
v_exp_f32 v189, v189
v_exp_f32 v190, v190
v_exp_f32 v191, v191
v_cvt_pk_bf16_f32 v156, v156, v157
v_cvt_pk_bf16_f32 v157, v158, v159
v_cvt_pk_bf16_f32 v158, v188, v189
v_cvt_pk_bf16_f32 v159, v190, v191
v_cvt_pk_bf16_f32 v70, v132, v133
v_cvt_pk_bf16_f32 v71, v134, v135
v_mfma_f32_16x16x32_bf16 v[188:191], a[244:247], v[156:159], 0
s_waitcnt lgkmcnt(3)
v_mfma_f32_16x16x32_bf16 v[152:155], v[216:219], v[156:159], 0
s_waitcnt lgkmcnt(2)
v_mfma_f32_16x16x32_bf16 v[184:187], v[220:223], v[156:159], 0
v_fma_f32 v172, v172, s66, -v122
v_fma_f32 v173, v173, s66, -v122
v_fma_f32 v174, v174, s66, -v122
v_fma_f32 v175, v175, s66, -v122
v_fma_f32 v204, v204, s66, -v122
v_fma_f32 v205, v205, s66, -v122
v_fma_f32 v206, v206, s66, -v122
v_fma_f32 v207, v207, s66, -v122
v_exp_f32 v172, v172
v_exp_f32 v173, v173
v_exp_f32 v174, v174
v_exp_f32 v175, v175
v_exp_f32 v204, v204
v_exp_f32 v205, v205
v_exp_f32 v206, v206
v_exp_f32 v207, v207
v_cvt_pk_bf16_f32 v172, v172, v173
v_cvt_pk_bf16_f32 v173, v174, v175
v_cvt_pk_bf16_f32 v174, v204, v205
v_cvt_pk_bf16_f32 v175, v206, v207
v_pk_mul_f32 v[84:85], v[84:85], s[68:69]
v_pk_mul_f32 v[86:87], v[86:87], s[68:69]
v_mfma_f32_16x16x32_bf16 v[204:207], a[244:247], v[172:175], 0
s_waitcnt lgkmcnt(1)
v_mfma_f32_16x16x32_bf16 v[168:171], v[232:235], v[172:175], 0
s_waitcnt lgkmcnt(0)
v_mfma_f32_16x16x32_bf16 v[200:203], v[236:239], v[172:175], 0
v_pk_mul_f32 v[148:149], v[148:149], s[68:69]
v_pk_mul_f32 v[150:151], v[150:151], s[68:69]
v_cvt_pk_bf16_f32 v84, v84, v85
v_cvt_pk_bf16_f32 v85, v86, v87
v_cvt_pk_bf16_f32 v86, v148, v149
v_cvt_pk_bf16_f32 v87, v150, v151
v_rcp_f32 v120, v188
v_rcp_f32 v122, v204
v_mul_f32 v120, v120, v5
v_mul_f32 v122, v122, v9
v_mul_f32 v152, v152, v120
v_mul_f32 v153, v153, v120
v_mul_f32 v154, v154, v120
v_mul_f32 v155, v155, v120
v_mul_f32 v184, v184, v120
v_mul_f32 v185, v185, v120
v_mul_f32 v186, v186, v120
v_mul_f32 v187, v187, v120
v_cvt_pk_bf16_f32 v152, v152, v153
v_cvt_pk_bf16_f32 v153, v154, v155
v_cvt_pk_bf16_f32 v154, v184, v185
v_cvt_pk_bf16_f32 v155, v186, v187
buffer_store_dwordx4 v[152:155], v16, s[44:47], s64 offen sc1
v_mul_f32 v168, v168, v122
v_mul_f32 v169, v169, v122
v_mul_f32 v170, v170, v122
v_mul_f32 v171, v171, v122
v_mul_f32 v200, v200, v122
v_mul_f32 v201, v201, v122
v_mul_f32 v202, v202, v122
v_mul_f32 v203, v203, v122
v_cvt_pk_bf16_f32 v168, v168, v169
v_cvt_pk_bf16_f32 v169, v170, v171
v_cvt_pk_bf16_f32 v170, v200, v201
v_cvt_pk_bf16_f32 v171, v202, v203
buffer_store_dwordx4 v[168:171], v16, s[44:47], s65 offen sc1
v_mov_b32 v17, 0xff800000
v_and_b32 v5, 1, v0
v_mul_u32_u24 v5, 0xaaaa, v5
v_add_u32 v5, 0x4444, v5
v_lshl_or_b32 v5, v5, 16, v5
L_attstart_7:
v_mov_b32 v2, v16
v_add_u32 v3, 0x10000, v16
v_mov_b32 v1, 0
s_waitcnt lgkmcnt(0)
s_barrier
s_cmp_eq_u32 s3, 0
s_cbranch_scc1 L_F1
ds_read_b128 a[144:147], v2 offset:0
ds_read_b128 a[148:151], v2 offset:1024
ds_read_b128 a[152:155], v2 offset:2048
ds_read_b128 a[156:159], v2 offset:3072
ds_read_b128 a[160:163], v2 offset:4096
ds_read_b128 a[164:167], v2 offset:5120
ds_read_b128 a[168:171], v2 offset:6144
ds_read_b128 a[172:175], v2 offset:7168
s_mov_b32 m0, s71
s_nop 0
buffer_load_dwordx4 v16, s[32:35], s70 offen offset:0 sc1 lds
buffer_load_dwordx4 v16, s[32:35], s70 offen offset:1024 sc1 lds
s_waitcnt lgkmcnt(7)
v_mfma_f32_16x16x32_bf16 v[88:91], a[144:147], v[24:27], 0
s_waitcnt lgkmcnt(6)
ds_read_b128 a[176:179], v2 offset:8192
v_accvgpr_write_b32 a128, 0
v_mfma_f32_16x16x32_bf16 v[88:91], a[148:151], v[28:31], v[88:91]
s_waitcnt lgkmcnt(6)
ds_read_b128 a[180:183], v2 offset:9216
v_accvgpr_write_b32 a129, 0
v_mfma_f32_16x16x32_bf16 v[88:91], a[152:155], v[32:35], v[88:91]
s_waitcnt lgkmcnt(6)
buffer_load_dwordx4 v16, s[32:35], s70 offen offset:2048 sc1 lds
v_mfma_f32_16x16x32_bf16 v[88:91], a[156:159], v[36:39], v[88:91]
ds_read_b128 a[184:187], v2 offset:10240
v_accvgpr_write_b32 a130, 0
v_mfma_f32_16x16x32_bf16 v[104:107], a[156:159], v[52:55], 0
ds_read_b128 a[188:191], v2 offset:11264
v_accvgpr_write_b32 a131, 0
v_mfma_f32_16x16x32_bf16 v[104:107], a[152:155], v[48:51], v[104:107]
ds_read_b128 a[192:195], v2 offset:12288
v_accvgpr_write_b32 a132, 0
v_mfma_f32_16x16x32_bf16 v[104:107], a[148:151], v[44:47], v[104:107]
ds_read_b128 a[196:199], v2 offset:13312
v_accvgpr_write_b32 a133, 0
v_mfma_f32_16x16x32_bf16 v[104:107], a[144:147], v[40:43], v[104:107]
ds_read_b128 a[200:203], v2 offset:14336
v_accvgpr_write_b32 a134, 0
v_mfma_f32_16x16x32_bf16 v[120:123], a[144:147], v[56:59], 0
ds_read_b128 a[204:207], v2 offset:15360
v_accvgpr_write_b32 a135, 0
v_mfma_f32_16x16x32_bf16 v[120:123], a[148:151], v[60:63], v[120:123]
buffer_load_dwordx4 v16, s[32:35], s70 offen offset:3072 sc1 lds
v_mfma_f32_16x16x32_bf16 v[120:123], a[152:155], v[64:67], v[120:123]
v_accvgpr_write_b32 a136, 0
v_accvgpr_write_b32 a137, 0
v_mfma_f32_16x16x32_bf16 v[120:123], a[156:159], v[68:71], v[120:123]
v_accvgpr_write_b32 a138, 0
v_accvgpr_write_b32 a139, 0
v_mfma_f32_16x16x32_bf16 v[136:139], a[156:159], v[84:87], 0
v_accvgpr_write_b32 a140, 0
v_accvgpr_write_b32 a141, 0
v_mfma_f32_16x16x32_bf16 v[136:139], a[152:155], v[80:83], v[136:139]
v_accvgpr_write_b32 a142, 0
v_accvgpr_write_b32 a143, 0
v_mfma_f32_16x16x32_bf16 v[136:139], a[148:151], v[76:79], v[136:139]
v_mfma_f32_16x16x32_bf16 v[136:139], a[144:147], v[72:75], v[136:139]
s_waitcnt lgkmcnt(0)
s_nop 1
v_max3_f32 v20, v88, v89, v90
v_max_f32 v20, v20, v91
v_max3_f32 v21, v104, v105, v106
v_max_f32 v21, v21, v107
v_max3_f32 v22, v120, v121, v122
v_max_f32 v22, v22, v123
v_max3_f32 v23, v136, v137, v138
v_max_f32 v23, v23, v139
v_mov_b32 v248, v20
v_mov_b32 v249, v21
v_mov_b32 v250, v22
v_mov_b32 v251, v23
v_permlane16_swap_b32 v248, v20
v_permlane16_swap_b32 v249, v21
v_permlane16_swap_b32 v250, v22
v_permlane16_swap_b32 v251, v23
v_max_f32 v20, v20, v248
v_max_f32 v21, v21, v249
v_max_f32 v22, v22, v250
v_max_f32 v23, v23, v251
v_mov_b32 v248, v20
v_mov_b32 v249, v21
v_mov_b32 v250, v22
v_mov_b32 v251, v23
v_permlane32_swap_b32 v248, v20
v_permlane32_swap_b32 v249, v21
v_permlane32_swap_b32 v250, v22
v_permlane32_swap_b32 v251, v23
v_max_f32 v20, v20, v248
v_max_f32 v21, v21, v249
v_max_f32 v22, v22, v250
v_max_f32 v23, v23, v251
s_cmp_eq_u32 s73, 0
s_cselect_b64 vcc, 0, -1
v_cndmask_b32 v20, v20, v252, vcc
v_cndmask_b32 v21, v21, v253, vcc
v_cndmask_b32 v22, v22, v254, vcc
v_cndmask_b32 v23, v23, v255, vcc
v_sub_f32 v228, 0, v23
v_sub_f32 v229, 0, v23
v_sub_f32 v230, 0, v23
v_sub_f32 v231, 0, v23
v_sub_f32 v224, 0, v22
v_sub_f32 v225, 0, v22
v_sub_f32 v226, 0, v22
v_sub_f32 v227, 0, v22
v_sub_f32 v220, 0, v21
v_sub_f32 v221, 0, v21
v_sub_f32 v222, 0, v21
v_sub_f32 v223, 0, v21
v_sub_f32 v216, 0, v20
v_sub_f32 v217, 0, v20
v_sub_f32 v218, 0, v20
v_sub_f32 v219, 0, v20
v_mfma_f32_16x16x32_bf16 v[140:143], a[160:163], v[72:75], v[228:231]
s_add_u32 m0, s71, 4096
v_add_f32 v88, v88, v216
v_add_f32 v89, v89, v216
v_mfma_f32_16x16x32_bf16 v[140:143], a[164:167], v[76:79], v[140:143]
v_add_f32 v90, v90, v216
v_add_f32 v91, v91, v216
v_exp_f32 v88, v88
v_mfma_f32_16x16x32_bf16 v[140:143], a[168:171], v[80:83], v[140:143]
s_add_u32 s64, s70, 4096
v_exp_f32 v89, v89
v_mfma_f32_16x16x32_bf16 v[140:143], a[172:175], v[84:87], v[140:143]
buffer_load_dwordx4 v16, s[32:35], s64 offen offset:0 sc1 lds
v_mfma_f32_16x16x32_bf16 v[124:127], a[172:175], v[68:71], v[224:227]
v_exp_f32 v90, v90
v_mfma_f32_16x16x32_bf16 v[124:127], a[168:171], v[64:67], v[124:127]
v_exp_f32 v91, v91
v_mfma_f32_16x16x32_bf16 v[124:127], a[164:167], v[60:63], v[124:127]
v_add_f32 v104, v104, v220
v_add_f32 v105, v105, v220
v_add_f32 v106, v106, v220
v_add_f32 v107, v107, v220
v_exp_f32 v104, v104
v_mfma_f32_16x16x32_bf16 v[124:127], a[160:163], v[56:59], v[124:127]
v_exp_f32 v105, v105
v_mfma_f32_16x16x32_bf16 v[108:111], a[160:163], v[40:43], v[220:223]
v_exp_f32 v106, v106
v_mfma_f32_16x16x32_bf16 v[108:111], a[164:167], v[44:47], v[108:111]
buffer_load_dwordx4 v16, s[32:35], s64 offen offset:1024 sc1 lds
v_mfma_f32_16x16x32_bf16 v[108:111], a[168:171], v[48:51], v[108:111]
v_cvt_pk_bf16_f32 v152, v88, v89
v_add_f32 v120, v120, v224
v_mfma_f32_16x16x32_bf16 v[108:111], a[172:175], v[52:55], v[108:111]
v_exp_f32 v107, v107
v_mfma_f32_16x16x32_bf16 v[92:95], a[172:175], v[36:39], v[216:219]
v_add_f32 v121, v121, v224
v_add_f32 v122, v122, v224
v_add_f32 v123, v123, v224
v_exp_f32 v120, v120
v_mfma_f32_16x16x32_bf16 v[92:95], a[168:171], v[32:35], v[92:95]
v_cvt_pk_bf16_f32 v153, v90, v91
v_exp_f32 v121, v121
v_mfma_f32_16x16x32_bf16 v[92:95], a[164:167], v[28:31], v[92:95]
v_exp_f32 v122, v122
v_mfma_f32_16x16x32_bf16 v[92:95], a[160:163], v[24:27], v[92:95]
v_exp_f32 v123, v123
v_mfma_f32_16x16x32_bf16 v[96:99], a[176:179], v[24:27], v[216:219]
v_cvt_pk_bf16_f32 v160, v104, v105
v_add_f32 v136, v136, v228
v_mfma_f32_16x16x32_bf16 v[96:99], a[180:183], v[28:31], v[96:99]
buffer_load_dwordx4 v16, s[32:35], s64 offen offset:2048 sc1 lds
v_add_f32 v137, v137, v228
v_add_f32 v138, v138, v228
v_add_f32 v139, v139, v228
v_exp_f32 v136, v136
v_mfma_f32_16x16x32_bf16 v[96:99], a[184:187], v[32:35], v[96:99]
v_exp_f32 v137, v137
v_mfma_f32_16x16x32_bf16 v[96:99], a[188:191], v[36:39], v[96:99]
v_cvt_pk_bf16_f32 v161, v106, v107
v_cvt_pk_bf16_f32 v184, v120, v121
v_mfma_f32_16x16x32_bf16 v[112:115], a[188:191], v[52:55], v[220:223]
v_exp_f32 v138, v138
v_mfma_f32_16x16x32_bf16 v[112:115], a[184:187], v[48:51], v[112:115]
v_exp_f32 v139, v139
v_mfma_f32_16x16x32_bf16 v[112:115], a[180:183], v[44:47], v[112:115]
v_exp_f32 v140, v140
v_mfma_f32_16x16x32_bf16 v[112:115], a[176:179], v[40:43], v[112:115]
v_exp_f32 v141, v141
v_mfma_f32_16x16x32_bf16 v[128:131], a[176:179], v[56:59], v[224:227]
buffer_load_dwordx4 v16, s[32:35], s64 offen offset:3072 sc1 lds
v_cvt_pk_bf16_f32 v185, v122, v123
v_mfma_f32_16x16x32_bf16 v[128:131], a[180:183], v[60:63], v[128:131]
v_exp_f32 v142, v142
v_mfma_f32_16x16x32_bf16 v[128:131], a[184:187], v[64:67], v[128:131]
v_exp_f32 v143, v143
v_mfma_f32_16x16x32_bf16 v[128:131], a[188:191], v[68:71], v[128:131]
v_cvt_pk_bf16_f32 v192, v136, v137
v_cvt_pk_bf16_f32 v193, v138, v139
v_mfma_f32_16x16x32_bf16 v[144:147], a[188:191], v[84:87], v[228:231]
v_exp_f32 v124, v124
v_mfma_f32_16x16x32_bf16 v[144:147], a[184:187], v[80:83], v[144:147]
v_exp_f32 v125, v125
v_mfma_f32_16x16x32_bf16 v[144:147], a[180:183], v[76:79], v[144:147]
s_waitcnt vmcnt(8)
s_barrier
v_mfma_f32_16x16x32_bf16 v[144:147], a[176:179], v[72:75], v[144:147]
v_exp_f32 v126, v126
v_mfma_f32_16x16x32_bf16 v[148:151], a[192:195], v[72:75], v[228:231]
v_cvt_pk_bf16_f32 v194, v140, v141
v_cvt_pk_bf16_f32 v195, v142, v143
v_mfma_f32_16x16x32_bf16 v[148:151], a[196:199], v[76:79], v[148:151]
v_exp_f32 v127, v127
v_mfma_f32_16x16x32_bf16 v[148:151], a[200:203], v[80:83], v[148:151]
s_xor_b32 s71, s71, 16384
v_exp_f32 v108, v108
v_mfma_f32_16x16x32_bf16 v[148:151], a[204:207], v[84:87], v[148:151]
s_add_u32 s70, s70, 32768
v_exp_f32 v109, v109
v_mfma_f32_16x16x32_bf16 v[132:135], a[204:207], v[68:71], v[224:227]
s_mov_b32 m0, s71
v_exp_f32 v110, v110
v_mfma_f32_16x16x32_bf16 v[132:135], a[200:203], v[64:67], v[132:135]
buffer_load_dwordx4 v16, s[32:35], s70 offen offset:0 sc1 lds
v_mfma_f32_16x16x32_bf16 v[132:135], a[196:199], v[60:63], v[132:135]
v_cvt_pk_bf16_f32 v186, v124, v125
v_exp_f32 v111, v111
v_mfma_f32_16x16x32_bf16 v[132:135], a[192:195], v[56:59], v[132:135]
v_exp_f32 v92, v92
v_mfma_f32_16x16x32_bf16 v[116:119], a[192:195], v[40:43], v[220:223]
v_exp_f32 v93, v93
v_mfma_f32_16x16x32_bf16 v[116:119], a[196:199], v[44:47], v[116:119]
ds_read_b128 a[144:147], v2 offset:16384
v_cvt_pk_bf16_f32 v187, v126, v127
v_mfma_f32_16x16x32_bf16 v[116:119], a[200:203], v[48:51], v[116:119]
v_exp_f32 v94, v94
v_mfma_f32_16x16x32_bf16 v[116:119], a[204:207], v[52:55], v[116:119]
ds_read_b128 a[148:151], v2 offset:17408
v_cvt_pk_bf16_f32 v162, v108, v109
v_mfma_f32_16x16x32_bf16 v[100:103], a[204:207], v[36:39], v[216:219]
ds_read_b128 a[152:155], v2 offset:18432
buffer_load_dwordx4 v16, s[32:35], s70 offen offset:1024 sc1 lds
v_exp_f32 v95, v95
v_mfma_f32_16x16x32_bf16 v[100:103], a[200:203], v[32:35], v[100:103]
ds_read_b128 a[156:159], v2 offset:19456
v_exp_f32 v96, v96
v_mfma_f32_16x16x32_bf16 v[100:103], a[196:199], v[28:31], v[100:103]
v_cvt_pk_bf16_f32 v163, v110, v111
v_exp_f32 v97, v97
v_mfma_f32_16x16x32_bf16 v[100:103], a[192:195], v[24:27], v[100:103]
s_waitcnt lgkmcnt(3)
ds_read_b128 a[160:163], v2 offset:20480
ds_read_b128 a[164:167], v2 offset:21504
ds_read_b128 a[168:171], v2 offset:22528
ds_read_b128 a[172:175], v2 offset:23552
v_mfma_f32_16x16x32_bf16 v[88:91], a[144:147], v[24:27], v[216:219]
s_waitcnt lgkmcnt(6)
v_exp_f32 v98, v98
v_mfma_f32_16x16x32_bf16 v[88:91], a[148:151], v[28:31], v[88:91]
s_waitcnt lgkmcnt(5)
v_cvt_pk_bf16_f32 v154, v92, v93
v_exp_f32 v99, v99
v_mfma_f32_16x16x32_bf16 v[88:91], a[152:155], v[32:35], v[88:91]
s_waitcnt lgkmcnt(4)
v_exp_f32 v112, v112
v_mfma_f32_16x16x32_bf16 v[88:91], a[156:159], v[36:39], v[88:91]
v_exp_f32 v113, v113
v_mfma_f32_16x16x32_bf16 v[104:107], a[156:159], v[52:55], v[220:223]
v_cvt_pk_bf16_f32 v155, v94, v95
v_cvt_pk_bf16_f32 v156, v96, v97
v_mfma_f32_16x16x32_bf16 v[104:107], a[152:155], v[48:51], v[104:107]
buffer_load_dwordx4 v16, s[32:35], s70 offen offset:2048 sc1 lds
v_exp_f32 v114, v114
v_mfma_f32_16x16x32_bf16 v[104:107], a[148:151], v[44:47], v[104:107]
v_exp_f32 v115, v115
v_mfma_f32_16x16x32_bf16 v[104:107], a[144:147], v[40:43], v[104:107]
v_exp_f32 v128, v128
v_mfma_f32_16x16x32_bf16 v[120:123], a[144:147], v[56:59], v[224:227]
v_exp_f32 v129, v129
v_mfma_f32_16x16x32_bf16 v[120:123], a[148:151], v[60:63], v[120:123]
v_cvt_pk_bf16_f32 v157, v98, v99
v_cvt_pk_bf16_f32 v164, v112, v113
v_mfma_f32_16x16x32_bf16 v[120:123], a[152:155], v[64:67], v[120:123]
v_exp_f32 v130, v130
v_mfma_f32_16x16x32_bf16 v[120:123], a[156:159], v[68:71], v[120:123]
v_exp_f32 v131, v131
v_mfma_f32_16x16x32_bf16 v[136:139], a[156:159], v[84:87], v[228:231]
v_exp_f32 v144, v144
v_mfma_f32_16x16x32_bf16 v[136:139], a[152:155], v[80:83], v[136:139]
v_exp_f32 v145, v145
v_mfma_f32_16x16x32_bf16 v[136:139], a[148:151], v[76:79], v[136:139]
v_exp_f32 v146, v146
v_mfma_f32_16x16x32_bf16 v[136:139], a[144:147], v[72:75], v[136:139]
s_waitcnt lgkmcnt(0)
v_cvt_pk_bf16_f32 v165, v114, v115
v_cvt_pk_bf16_f32 v188, v128, v129
v_mfma_f32_16x16x32_bf16 v[140:143], a[160:163], v[72:75], v[228:231]
v_exp_f32 v147, v147
v_mfma_f32_16x16x32_bf16 v[140:143], a[164:167], v[76:79], v[140:143]
v_exp_f32 v148, v148
v_mfma_f32_16x16x32_bf16 v[140:143], a[168:171], v[80:83], v[140:143]
v_exp_f32 v149, v149
v_mfma_f32_16x16x32_bf16 v[140:143], a[172:175], v[84:87], v[140:143]
buffer_load_dwordx4 v16, s[32:35], s70 offen offset:3072 sc1 lds
v_mfma_f32_16x16x32_bf16 v[124:127], a[172:175], v[68:71], v[224:227]
v_cvt_pk_bf16_f32 v189, v130, v131
v_cvt_pk_bf16_f32 v196, v144, v145
v_mfma_f32_16x16x32_bf16 v[124:127], a[168:171], v[64:67], v[124:127]
v_exp_f32 v150, v150
v_mfma_f32_16x16x32_bf16 v[124:127], a[164:167], v[60:63], v[124:127]
v_exp_f32 v151, v151
v_mfma_f32_16x16x32_bf16 v[124:127], a[160:163], v[56:59], v[124:127]
v_exp_f32 v132, v132
v_mfma_f32_16x16x32_bf16 v[108:111], a[160:163], v[40:43], v[220:223]
ds_read_b128 a[176:179], v2 offset:24576
v_cvt_pk_bf16_f32 v197, v146, v147
v_mfma_f32_16x16x32_bf16 v[108:111], a[164:167], v[44:47], v[108:111]
ds_read_b128 a[180:183], v2 offset:25600
v_cvt_pk_bf16_f32 v198, v148, v149
v_mfma_f32_16x16x32_bf16 v[108:111], a[168:171], v[48:51], v[108:111]
ds_read_b128 a[184:187], v2 offset:26624
v_exp_f32 v133, v133
v_mfma_f32_16x16x32_bf16 v[108:111], a[172:175], v[52:55], v[108:111]
ds_read_b128 a[188:191], v2 offset:27648
v_exp_f32 v134, v134
v_mfma_f32_16x16x32_bf16 v[92:95], a[172:175], v[36:39], v[216:219]
v_exp_f32 v135, v135
v_mfma_f32_16x16x32_bf16 v[92:95], a[168:171], v[32:35], v[92:95]
v_exp_f32 v116, v116
v_mfma_f32_16x16x32_bf16 v[92:95], a[164:167], v[28:31], v[92:95]
v_exp_f32 v117, v117
v_mfma_f32_16x16x32_bf16 v[92:95], a[160:163], v[24:27], v[92:95]
s_waitcnt lgkmcnt(2)
v_cvt_pk_bf16_f32 v199, v150, v151
v_cvt_pk_bf16_f32 v190, v132, v133
v_mfma_f32_16x16x32_bf16 v[96:99], a[176:179], v[24:27], v[216:219]
v_exp_f32 v118, v118
v_mfma_f32_16x16x32_bf16 v[96:99], a[180:183], v[28:31], v[96:99]
s_waitcnt lgkmcnt(0)
s_add_u32 m0, s71, 4096
v_exp_f32 v119, v119
v_mfma_f32_16x16x32_bf16 v[96:99], a[184:187], v[32:35], v[96:99]
s_add_u32 s64, s70, 4096
v_exp_f32 v100, v100
v_mfma_f32_16x16x32_bf16 v[96:99], a[188:191], v[36:39], v[96:99]
buffer_load_dwordx4 v16, s[32:35], s64 offen offset:0 sc1 lds
v_mfma_f32_16x16x32_bf16 v[112:115], a[188:191], v[52:55], v[220:223]
v_exp_f32 v101, v101
v_mfma_f32_16x16x32_bf16 v[112:115], a[184:187], v[48:51], v[112:115]
v_cvt_pk_bf16_f32 v191, v134, v135
v_cvt_pk_bf16_f32 v166, v116, v117
v_mfma_f32_16x16x32_bf16 v[112:115], a[180:183], v[44:47], v[112:115]
v_exp_f32 v102, v102
v_mfma_f32_16x16x32_bf16 v[112:115], a[176:179], v[40:43], v[112:115]
v_exp_f32 v103, v103
v_mfma_f32_16x16x32_bf16 v[128:131], a[176:179], v[56:59], v[224:227]
s_lshl_b32 s66, s30, 30
ds_read_b128 a[192:195], v2 offset:28672
v_cvt_pk_bf16_f32 v167, v118, v119
v_mfma_f32_16x16x32_bf16 v[128:131], a[180:183], v[60:63], v[128:131]
ds_read_b128 a[196:199], v2 offset:29696
v_exp_f32 v88, v88
v_mfma_f32_16x16x32_bf16 v[128:131], a[184:187], v[64:67], v[128:131]
ds_read_b128 a[200:203], v2 offset:30720
v_exp_f32 v89, v89
v_mfma_f32_16x16x32_bf16 v[128:131], a[188:191], v[68:71], v[128:131]
ds_read_b128 a[204:207], v2 offset:31744
v_cvt_pk_bf16_f32 v158, v100, v101
v_mfma_f32_16x16x32_bf16 v[144:147], a[188:191], v[84:87], v[228:231]
v_exp_f32 v90, v90
v_mfma_f32_16x16x32_bf16 v[144:147], a[184:187], v[80:83], v[144:147]
v_exp_f32 v91, v91
v_mfma_f32_16x16x32_bf16 v[144:147], a[180:183], v[76:79], v[144:147]
v_exp_f32 v104, v104
v_mfma_f32_16x16x32_bf16 v[144:147], a[176:179], v[72:75], v[144:147]
s_waitcnt lgkmcnt(2)
v_exp_f32 v105, v105
v_mfma_f32_16x16x32_bf16 v[148:151], a[192:195], v[72:75], v[228:231]
v_cvt_pk_bf16_f32 v159, v102, v103
v_cvt_pk_bf16_f32 v168, v88, v89
v_mfma_f32_16x16x32_bf16 v[148:151], a[196:199], v[76:79], v[148:151]
s_waitcnt lgkmcnt(0)
v_exp_f32 v106, v106
v_mfma_f32_16x16x32_bf16 v[148:151], a[200:203], v[80:83], v[148:151]
v_exp_f32 v107, v107
v_mfma_f32_16x16x32_bf16 v[148:151], a[204:207], v[84:87], v[148:151]
buffer_load_dwordx4 v16, s[32:35], s64 offen offset:1024 sc1 lds
v_mfma_f32_16x16x32_bf16 v[132:135], a[204:207], v[68:71], v[224:227]
v_exp_f32 v120, v120
v_mfma_f32_16x16x32_bf16 v[132:135], a[200:203], v[64:67], v[132:135]
v_cvt_pk_bf16_f32 v169, v90, v91
v_cvt_pk_bf16_f32 v176, v104, v105
v_mfma_f32_16x16x32_bf16 v[132:135], a[196:199], v[60:63], v[132:135]
v_exp_f32 v121, v121
v_mfma_f32_16x16x32_bf16 v[132:135], a[192:195], v[56:59], v[132:135]
v_exp_f32 v122, v122
v_mfma_f32_16x16x32_bf16 v[116:119], a[192:195], v[40:43], v[220:223]
v_exp_f32 v123, v123
v_mfma_f32_16x16x32_bf16 v[116:119], a[196:199], v[44:47], v[116:119]
v_exp_f32 v136, v136
v_mfma_f32_16x16x32_bf16 v[116:119], a[200:203], v[48:51], v[116:119]
v_exp_f32 v137, v137
v_mfma_f32_16x16x32_bf16 v[116:119], a[204:207], v[52:55], v[116:119]
ds_read_b128 a[144:147], v3 offset:16384
v_cvt_pk_bf16_f32 v177, v106, v107
v_mfma_f32_16x16x32_bf16 v[100:103], a[204:207], v[36:39], v[216:219]
v_exp_f32 v138, v138
v_mfma_f32_16x16x32_bf16 v[100:103], a[200:203], v[32:35], v[100:103]
ds_read_b128 a[148:151], v3 offset:24576
v_cvt_pk_bf16_f32 v200, v120, v121
v_mfma_f32_16x16x32_bf16 v[100:103], a[196:199], v[28:31], v[100:103]
v_exp_f32 v139, v139
v_mfma_f32_16x16x32_bf16 v[100:103], a[192:195], v[24:27], v[100:103]
v_exp_f32 v140, v140
v_smfmac_f32_16x16x64_bf16 a[128:131], a[240:243], v[152:159], v5
v_cvt_pk_bf16_f32 v201, v122, v123
v_smfmac_f32_16x16x64_bf16 a[132:135], a[240:243], v[160:167], v5
v_exp_f32 v141, v141
v_smfmac_f32_16x16x64_bf16 a[136:139], a[240:243], v[184:191], v5
v_exp_f32 v142, v142
v_smfmac_f32_16x16x64_bf16 a[140:143], a[240:243], v[192:199], v5
s_waitcnt lgkmcnt(0)
buffer_load_dwordx4 v16, s[32:35], s64 offen offset:2048 sc1 lds
v_cvt_pk_bf16_f32 v208, v136, v137
v_mfma_f32_16x16x32_bf16 a[0:3], a[144:147], v[152:155], 0
ds_read_b128 a[152:155], v3 offset:17408
v_exp_f32 v143, v143
v_mfma_f32_16x16x32_bf16 a[0:3], a[148:151], v[156:159], a[0:3]
ds_read_b128 a[156:159], v3 offset:25600
v_exp_f32 v124, v124
v_mfma_f32_16x16x32_bf16 a[32:35], a[148:151], v[164:167], 0
v_cvt_pk_bf16_f32 v209, v138, v139
v_exp_f32 v125, v125
v_mfma_f32_16x16x32_bf16 a[32:35], a[144:147], v[160:163], a[32:35]
v_exp_f32 v126, v126
v_mfma_f32_16x16x32_bf16 a[64:67], a[144:147], v[184:187], 0
v_exp_f32 v127, v127
v_mfma_f32_16x16x32_bf16 a[64:67], a[148:151], v[188:191], a[64:67]
v_cvt_pk_bf16_f32 v210, v140, v141
v_cvt_pk_bf16_f32 v211, v142, v143
v_mfma_f32_16x16x32_bf16 a[96:99], a[148:151], v[196:199], 0
v_exp_f32 v108, v108
v_mfma_f32_16x16x32_bf16 a[96:99], a[144:147], v[192:195], a[96:99]
s_waitcnt lgkmcnt(0)
v_exp_f32 v109, v109
v_mfma_f32_16x16x32_bf16 a[100:103], a[152:155], v[192:195], 0
ds_read_b128 a[160:163], v3 offset:18432
v_cvt_pk_bf16_f32 v202, v124, v125
v_mfma_f32_16x16x32_bf16 a[100:103], a[156:159], v[196:199], a[100:103]
ds_read_b128 a[164:167], v3 offset:26624
v_exp_f32 v110, v110
v_mfma_f32_16x16x32_bf16 a[68:71], a[156:159], v[188:191], 0
v_exp_f32 v111, v111
v_mfma_f32_16x16x32_bf16 a[68:71], a[152:155], v[184:187], a[68:71]
v_exp_f32 v92, v92
v_mfma_f32_16x16x32_bf16 a[36:39], a[152:155], v[160:163], 0
v_exp_f32 v93, v93
v_mfma_f32_16x16x32_bf16 a[36:39], a[156:159], v[164:167], a[36:39]
v_cvt_pk_bf16_f32 v203, v126, v127
v_cvt_pk_bf16_f32 v178, v108, v109
v_mfma_f32_16x16x32_bf16 a[4:7], a[156:159], v[156:159], 0
buffer_load_dwordx4 v16, s[32:35], s64 offen offset:3072 sc1 lds
v_mfma_f32_16x16x32_bf16 a[4:7], a[152:155], v[152:155], a[4:7]
s_waitcnt lgkmcnt(0)
v_exp_f32 v94, v94
v_mfma_f32_16x16x32_bf16 a[8:11], a[160:163], v[152:155], 0
ds_read_b128 a[168:171], v3 offset:19456
v_cvt_pk_bf16_f32 v179, v110, v111
v_mfma_f32_16x16x32_bf16 a[8:11], a[164:167], v[156:159], a[8:11]
ds_read_b128 a[172:175], v3 offset:27648
v_exp_f32 v95, v95
v_mfma_f32_16x16x32_bf16 a[40:43], a[164:167], v[164:167], 0
v_exp_f32 v96, v96
v_mfma_f32_16x16x32_bf16 a[40:43], a[160:163], v[160:163], a[40:43]
v_exp_f32 v97, v97
v_mfma_f32_16x16x32_bf16 a[72:75], a[160:163], v[184:187], 0
v_exp_f32 v98, v98
v_mfma_f32_16x16x32_bf16 a[72:75], a[164:167], v[188:191], a[72:75]
v_exp_f32 v99, v99
v_mfma_f32_16x16x32_bf16 a[104:107], a[164:167], v[196:199], 0
ds_read_b128 a[176:179], v3 offset:20480
v_cvt_pk_bf16_f32 v170, v92, v93
v_mfma_f32_16x16x32_bf16 a[104:107], a[160:163], v[192:195], a[104:107]
s_waitcnt lgkmcnt(1)
v_exp_f32 v112, v112
v_mfma_f32_16x16x32_bf16 a[108:111], a[168:171], v[192:195], 0
v_exp_f32 v113, v113
v_mfma_f32_16x16x32_bf16 a[108:111], a[172:175], v[196:199], a[108:111]
ds_read_b128 a[180:183], v3 offset:28672
v_cvt_pk_bf16_f32 v171, v94, v95
v_mfma_f32_16x16x32_bf16 a[76:79], a[172:175], v[188:191], 0
v_exp_f32 v114, v114
v_mfma_f32_16x16x32_bf16 a[76:79], a[168:171], v[184:187], a[76:79]
v_cvt_pk_bf16_f32 v172, v96, v97
v_xor_b32 v2, 0x8000, v2
v_mfma_f32_16x16x32_bf16 a[44:47], a[168:171], v[160:163], 0
ds_read_b128 a[184:187], v3 offset:21504
ds_read_b128 a[188:191], v3 offset:29696
ds_read_b128 a[192:195], v3 offset:22528
ds_read_b128 a[196:199], v3 offset:30720
ds_read_b128 a[200:203], v3 offset:23552
ds_read_b128 a[204:207], v3 offset:31744
v_exp_f32 v115, v115
v_mfma_f32_16x16x32_bf16 a[44:47], a[172:175], v[164:167], a[44:47]
s_waitcnt vmcnt(8)
s_barrier
v_exp_f32 v128, v128
v_mfma_f32_16x16x32_bf16 a[12:15], a[172:175], v[156:159], 0
v_cvt_pk_bf16_f32 v173, v98, v99
v_cvt_pk_bf16_f32 v180, v112, v113
v_mfma_f32_16x16x32_bf16 a[12:15], a[168:171], v[152:155], a[12:15]
s_waitcnt lgkmcnt(6)
v_exp_f32 v129, v129
v_mfma_f32_16x16x32_bf16 a[16:19], a[176:179], v[152:155], 0
v_exp_f32 v130, v130
v_mfma_f32_16x16x32_bf16 a[16:19], a[180:183], v[156:159], a[16:19]
s_xor_b32 s71, s71, 49152
v_exp_f32 v131, v131
v_mfma_f32_16x16x32_bf16 a[48:51], a[180:183], v[164:167], 0
s_add_u32 s70, s70, 32768
v_exp_f32 v144, v144
v_mfma_f32_16x16x32_bf16 a[48:51], a[176:179], v[160:163], a[48:51]
s_mov_b32 m0, s71
v_exp_f32 v145, v145
v_mfma_f32_16x16x32_bf16 a[80:83], a[176:179], v[184:187], 0
buffer_load_dwordx4 v16, s[32:35], s70 offen offset:0 sc1 lds
v_cvt_pk_bf16_f32 v181, v114, v115
v_mfma_f32_16x16x32_bf16 a[80:83], a[180:183], v[188:191], a[80:83]
v_exp_f32 v146, v146
v_mfma_f32_16x16x32_bf16 a[112:115], a[180:183], v[196:199], 0
v_exp_f32 v147, v147
v_mfma_f32_16x16x32_bf16 a[112:115], a[176:179], v[192:195], a[112:115]
s_waitcnt lgkmcnt(0)
v_cvt_pk_bf16_f32 v204, v128, v129
v_cvt_pk_bf16_f32 v205, v130, v131
v_mfma_f32_16x16x32_bf16 a[116:119], a[184:187], v[192:195], 0
v_exp_f32 v148, v148
v_mfma_f32_16x16x32_bf16 a[116:119], a[188:191], v[196:199], a[116:119]
v_exp_f32 v149, v149
v_mfma_f32_16x16x32_bf16 a[84:87], a[188:191], v[188:191], 0
v_exp_f32 v150, v150
v_mfma_f32_16x16x32_bf16 a[84:87], a[184:187], v[184:187], a[84:87]
v_exp_f32 v151, v151
v_mfma_f32_16x16x32_bf16 a[52:55], a[184:187], v[160:163], 0
v_cvt_pk_bf16_f32 v212, v144, v145
v_cvt_pk_bf16_f32 v213, v146, v147
v_mfma_f32_16x16x32_bf16 a[52:55], a[188:191], v[164:167], a[52:55]
v_exp_f32 v132, v132
v_mfma_f32_16x16x32_bf16 a[20:23], a[188:191], v[156:159], 0
v_exp_f32 v133, v133
v_mfma_f32_16x16x32_bf16 a[20:23], a[184:187], v[152:155], a[20:23]
ds_read_b128 a[144:147], v2 offset:0
v_lshl_add_u32 v19, v0, 24, s66
v_mfma_f32_16x16x32_bf16 a[24:27], a[192:195], v[152:155], 0
s_lshr_b32 s67, s31, 4
v_exp_f32 v134, v134
v_mfma_f32_16x16x32_bf16 a[24:27], a[196:199], v[156:159], a[24:27]
s_lshl1_add_u32 s67, s3, s67
v_exp_f32 v135, v135
v_mfma_f32_16x16x32_bf16 a[56:59], a[196:199], v[164:167], 0
s_lshl_b32 s79, s67, 8
v_cvt_pk_bf16_f32 v214, v148, v149
v_cvt_pk_bf16_f32 v215, v150, v151
v_mfma_f32_16x16x32_bf16 a[56:59], a[192:195], v[160:163], a[56:59]
s_add_u32 s79, s79, 8192
buffer_load_dwordx4 v16, s[32:35], s70 offen offset:1024 sc1 lds
v_mfma_f32_16x16x32_bf16 a[88:91], a[192:195], v[184:187], 0
s_add_u32 s69, s31, 12
v_exp_f32 v116, v116
v_mfma_f32_16x16x32_bf16 a[88:91], a[196:199], v[188:191], a[88:91]
s_lshr_b32 s69, s69, 5
v_exp_f32 v117, v117
v_mfma_f32_16x16x32_bf16 a[120:123], a[196:199], v[196:199], 0
s_lshl1_add_u32 s69, s3, s69
v_exp_f32 v118, v118
v_mfma_f32_16x16x32_bf16 a[120:123], a[192:195], v[192:195], a[120:123]
s_lshl_b32 s69, s69, 8
v_cvt_pk_bf16_f32 v206, v132, v133
v_cvt_pk_bf16_f32 v207, v134, v135
v_mfma_f32_16x16x32_bf16 a[124:127], a[200:203], v[192:195], 0
s_add_u32 s69, s69, 8192
s_add_u32 s17, s78, L_D-L_pc+0
v_exp_f32 v119, v119
v_mfma_f32_16x16x32_bf16 a[124:127], a[204:207], v[196:199], a[124:127]
buffer_load_dword a252, v16, s[88:91], s17 offen
v_exp_f32 v100, v100
v_mfma_f32_16x16x32_bf16 a[92:95], a[204:207], v[188:191], 0
s_lshl_b32 s67, s73, 16
v_exp_f32 v101, v101
v_mfma_f32_16x16x32_bf16 a[92:95], a[200:203], v[184:187], a[92:95]
s_xor_b32 s68, s80, 256
s_add_u32 s17, s78, L_D-L_pc+4096
ds_read_b128 a[148:151], v2 offset:1024
v_cvt_pk_bf16_f32 v182, v116, v117
v_mfma_f32_16x16x32_bf16 a[60:63], a[200:203], v[160:163], 0
s_add_u32 s68, s68, s67
buffer_load_dword a252, v16, s[88:91], s17 offen
ds_read_b128 a[152:155], v2 offset:2048
v_exp_f32 v102, v102
v_mfma_f32_16x16x32_bf16 a[60:63], a[204:207], v[164:167], a[60:63]
s_add_u32 s67, s67, s69
ds_read_b128 a[156:159], v2 offset:3072
v_cvt_pk_bf16_f32 v183, v118, v119
v_mfma_f32_16x16x32_bf16 a[28:31], a[204:207], v[156:159], 0
s_mov_b64 exec, 1
buffer_atomic_add a251, v19, s[52:55], s67 offen offset:0 sc1
buffer_atomic_add a251, v19, s[52:55], s68 offen offset:0 sc1
s_mov_b64 exec, -1
s_add_u32 s17, s78, L_D-L_pc+8192
v_exp_f32 v103, v103
v_mfma_f32_16x16x32_bf16 a[28:31], a[200:203], v[152:155], a[28:31]
ds_read_b128 a[160:163], v2 offset:4096
buffer_load_dword a252, v16, s[88:91], s17 offen
ds_read_b128 a[164:167], v2 offset:5120
ds_read_b128 a[168:171], v2 offset:6144
ds_read_b128 a[172:175], v2 offset:7168
v_mul_u32_u24 v19, 52, v0
v_cvt_pk_bf16_f32 v174, v100, v101
v_cvt_pk_bf16_f32 v175, v102, v103
v_xor_b32 v3, 0x8000, v3
s_sub_u32 s72, s3, 1
s_cmp_eq_u32 s72, 0
s_cbranch_scc1 L_DD
.p2align 3
L_D:
s_waitcnt lgkmcnt(7)
v_mfma_f32_16x16x32_bf16 v[88:91], a[144:147], v[24:27], v[216:219]
s_waitcnt lgkmcnt(6)
ds_read_b128 a[176:179], v2 offset:8192
v_mfma_f32_16x16x32_bf16 v[88:91], a[148:151], v[28:31], v[88:91]
s_waitcnt lgkmcnt(6)
ds_read_b128 a[180:183], v2 offset:9216
v_mfma_f32_16x16x32_bf16 v[88:91], a[152:155], v[32:35], v[88:91]
s_waitcnt lgkmcnt(6)
buffer_load_dwordx4 v16, s[32:35], s70 offen offset:2048 sc1 lds
v_mfma_f32_16x16x32_bf16 v[88:91], a[156:159], v[36:39], v[88:91]
ds_read_b128 a[184:187], v2 offset:10240
v_mfma_f32_16x16x32_bf16 v[104:107], a[156:159], v[52:55], v[220:223]
v_mfma_f32_16x16x32_bf16 v[104:107], a[152:155], v[48:51], v[104:107]
buffer_load_dword a252, v19, s[40:43], s81 offen
v_mfma_f32_16x16x32_bf16 v[104:107], a[148:151], v[44:47], v[104:107]
ds_read_b128 a[188:191], v2 offset:11264
v_mfma_f32_16x16x32_bf16 v[104:107], a[144:147], v[40:43], v[104:107]
v_mfma_f32_16x16x32_bf16 v[120:123], a[144:147], v[56:59], v[224:227]
v_mfma_f32_16x16x32_bf16 v[120:123], a[148:151], v[60:63], v[120:123]
v_mfma_f32_16x16x32_bf16 v[120:123], a[152:155], v[64:67], v[120:123]
v_exp_f32 v88, v88
v_mfma_f32_16x16x32_bf16 v[120:123], a[156:159], v[68:71], v[120:123]
v_exp_f32 v89, v89
v_mfma_f32_16x16x32_bf16 v[136:139], a[156:159], v[84:87], v[228:231]
v_exp_f32 v90, v90
v_mfma_f32_16x16x32_bf16 v[136:139], a[152:155], v[80:83], v[136:139]
v_exp_f32 v91, v91
v_mfma_f32_16x16x32_bf16 v[136:139], a[148:151], v[76:79], v[136:139]
v_exp_f32 v104, v104
v_mfma_f32_16x16x32_bf16 v[136:139], a[144:147], v[72:75], v[136:139]
s_waitcnt lgkmcnt(0)
s_add_u32 s81, s81, 425984
v_exp_f32 v105, v105
v_mfma_f32_16x16x32_bf16 v[140:143], a[160:163], v[72:75], v[228:231]
v_exp_f32 v106, v106
v_mfma_f32_16x16x32_bf16 v[140:143], a[164:167], v[76:79], v[140:143]
buffer_load_dwordx4 v16, s[32:35], s70 offen offset:3072 sc1 lds
v_mfma_f32_16x16x32_bf16 v[140:143], a[168:171], v[80:83], v[140:143]
v_exp_f32 v107, v107
v_mfma_f32_16x16x32_bf16 v[140:143], a[172:175], v[84:87], v[140:143]
v_cvt_pk_bf16_f32 v152, v88, v89
v_cvt_pk_bf16_f32 v153, v90, v91
v_mfma_f32_16x16x32_bf16 v[124:127], a[172:175], v[68:71], v[224:227]
v_exp_f32 v120, v120
v_mfma_f32_16x16x32_bf16 v[124:127], a[168:171], v[64:67], v[124:127]
v_exp_f32 v121, v121
v_mfma_f32_16x16x32_bf16 v[124:127], a[164:167], v[60:63], v[124:127]
v_exp_f32 v122, v122
v_mfma_f32_16x16x32_bf16 v[124:127], a[160:163], v[56:59], v[124:127]
v_exp_f32 v123, v123
v_mfma_f32_16x16x32_bf16 v[108:111], a[160:163], v[40:43], v[220:223]
v_exp_f32 v136, v136
v_mfma_f32_16x16x32_bf16 v[108:111], a[164:167], v[44:47], v[108:111]
v_exp_f32 v137, v137
v_mfma_f32_16x16x32_bf16 v[108:111], a[168:171], v[48:51], v[108:111]
v_exp_f32 v138, v138
v_mfma_f32_16x16x32_bf16 v[108:111], a[172:175], v[52:55], v[108:111]
v_cvt_pk_bf16_f32 v160, v104, v105
v_cvt_pk_bf16_f32 v161, v106, v107
v_mfma_f32_16x16x32_bf16 v[92:95], a[172:175], v[36:39], v[216:219]
v_exp_f32 v139, v139
v_mfma_f32_16x16x32_bf16 v[92:95], a[168:171], v[32:35], v[92:95]
ds_read_b128 a[192:195], v2 offset:12288
v_cvt_pk_bf16_f32 v184, v120, v121
v_mfma_f32_16x16x32_bf16 v[92:95], a[164:167], v[28:31], v[92:95]
v_exp_f32 v140, v140
v_mfma_f32_16x16x32_bf16 v[92:95], a[160:163], v[24:27], v[92:95]
s_add_u32 m0, s71, 4096
ds_read_b128 a[196:199], v2 offset:13312
v_cvt_pk_bf16_f32 v185, v122, v123
v_mfma_f32_16x16x32_bf16 v[96:99], a[176:179], v[24:27], v[216:219]
s_add_u32 s64, s70, 4096
ds_read_b128 a[200:203], v2 offset:14336
v_cvt_pk_bf16_f32 v192, v136, v137
v_mfma_f32_16x16x32_bf16 v[96:99], a[180:183], v[28:31], v[96:99]
buffer_load_dwordx4 v16, s[32:35], s64 offen offset:0 sc1 lds
v_mfma_f32_16x16x32_bf16 v[96:99], a[184:187], v[32:35], v[96:99]
v_exp_f32 v141, v141
v_mfma_f32_16x16x32_bf16 v[96:99], a[188:191], v[36:39], v[96:99]
ds_read_b128 a[204:207], v2 offset:15360
v_cvt_pk_bf16_f32 v193, v138, v139
v_mfma_f32_16x16x32_bf16 v[112:115], a[188:191], v[52:55], v[220:223]
v_exp_f32 v142, v142
v_mfma_f32_16x16x32_bf16 v[112:115], a[184:187], v[48:51], v[112:115]
v_exp_f32 v143, v143
v_mfma_f32_16x16x32_bf16 v[112:115], a[180:183], v[44:47], v[112:115]
v_exp_f32 v124, v124
v_mfma_f32_16x16x32_bf16 v[112:115], a[176:179], v[40:43], v[112:115]
v_exp_f32 v125, v125
v_mfma_f32_16x16x32_bf16 v[128:131], a[176:179], v[56:59], v[224:227]
v_exp_f32 v126, v126
v_mfma_f32_16x16x32_bf16 v[128:131], a[180:183], v[60:63], v[128:131]
v_exp_f32 v127, v127
v_mfma_f32_16x16x32_bf16 v[128:131], a[184:187], v[64:67], v[128:131]
v_exp_f32 v108, v108
v_mfma_f32_16x16x32_bf16 v[128:131], a[188:191], v[68:71], v[128:131]
v_exp_f32 v109, v109
v_mfma_f32_16x16x32_bf16 v[144:147], a[188:191], v[84:87], v[228:231]
v_exp_f32 v110, v110
v_mfma_f32_16x16x32_bf16 v[144:147], a[184:187], v[80:83], v[144:147]
ds_read_b128 a[144:147], v3 offset:0
v_cvt_pk_bf16_f32 v194, v140, v141
v_mfma_f32_16x16x32_bf16 v[144:147], a[180:183], v[76:79], v[144:147]
ds_read_b128 a[148:151], v3 offset:8192
v_cvt_pk_bf16_f32 v195, v142, v143
v_mfma_f32_16x16x32_bf16 v[144:147], a[176:179], v[72:75], v[144:147]
s_waitcnt lgkmcnt(2)
v_exp_f32 v111, v111
v_mfma_f32_16x16x32_bf16 v[148:151], a[192:195], v[72:75], v[228:231]
buffer_load_dwordx4 v16, s[32:35], s64 offen offset:1024 sc1 lds
v_mfma_f32_16x16x32_bf16 v[148:151], a[196:199], v[76:79], v[148:151]
v_exp_f32 v92, v92
v_mfma_f32_16x16x32_bf16 v[148:151], a[200:203], v[80:83], v[148:151]
v_exp_f32 v93, v93
v_mfma_f32_16x16x32_bf16 v[148:151], a[204:207], v[84:87], v[148:151]
v_exp_f32 v94, v94
v_mfma_f32_16x16x32_bf16 v[132:135], a[204:207], v[68:71], v[224:227]
ds_read_b128 a[152:155], v3 offset:1024
v_cvt_pk_bf16_f32 v186, v124, v125
v_mfma_f32_16x16x32_bf16 v[132:135], a[200:203], v[64:67], v[132:135]
ds_read_b128 a[156:159], v3 offset:9216
v_cvt_pk_bf16_f32 v187, v126, v127
v_mfma_f32_16x16x32_bf16 v[132:135], a[196:199], v[60:63], v[132:135]
v_exp_f32 v95, v95
v_mfma_f32_16x16x32_bf16 v[132:135], a[192:195], v[56:59], v[132:135]
v_exp_f32 v96, v96
v_mfma_f32_16x16x32_bf16 v[116:119], a[192:195], v[40:43], v[220:223]
v_exp_f32 v97, v97
v_mfma_f32_16x16x32_bf16 v[116:119], a[196:199], v[44:47], v[116:119]
v_exp_f32 v98, v98
v_mfma_f32_16x16x32_bf16 v[116:119], a[200:203], v[48:51], v[116:119]
ds_read_b128 a[160:163], v3 offset:2048
v_cvt_pk_bf16_f32 v162, v108, v109
v_mfma_f32_16x16x32_bf16 v[116:119], a[204:207], v[52:55], v[116:119]
v_exp_f32 v99, v99
v_mfma_f32_16x16x32_bf16 v[100:103], a[204:207], v[36:39], v[216:219]
ds_read_b128 a[164:167], v3 offset:10240
v_cvt_pk_bf16_f32 v163, v110, v111
v_mfma_f32_16x16x32_bf16 v[100:103], a[200:203], v[32:35], v[100:103]
v_exp_f32 v112, v112
v_mfma_f32_16x16x32_bf16 v[100:103], a[196:199], v[28:31], v[100:103]
v_exp_f32 v113, v113
v_mfma_f32_16x16x32_bf16 v[100:103], a[192:195], v[24:27], v[100:103]
v_exp_f32 v114, v114
v_smfmac_f32_16x16x64_bf16 a[128:131], a[240:243], v[168:175], v5
ds_read_b128 a[168:171], v3 offset:3072
v_smfmac_f32_16x16x64_bf16 a[132:135], a[240:243], v[176:183], v5
ds_read_b128 a[172:175], v3 offset:11264
v_smfmac_f32_16x16x64_bf16 a[136:139], a[240:243], v[200:207], v5
ds_read_b128 a[176:179], v3 offset:4096
v_smfmac_f32_16x16x64_bf16 a[140:143], a[240:243], v[208:215], v5
s_waitcnt lgkmcnt(3)
buffer_load_dwordx4 v16, s[32:35], s64 offen offset:2048 sc1 lds
v_mfma_f32_16x16x32_bf16 a[0:3], a[144:147], v[168:171], a[0:3]
v_exp_f32 v115, v115
v_mfma_f32_16x16x32_bf16 a[0:3], a[148:151], v[172:175], a[0:3]
v_exp_f32 v128, v128
v_mfma_f32_16x16x32_bf16 a[32:35], a[148:151], v[180:183], a[32:35]
v_exp_f32 v129, v129
v_mfma_f32_16x16x32_bf16 a[32:35], a[144:147], v[176:179], a[32:35]
v_exp_f32 v130, v130
v_mfma_f32_16x16x32_bf16 a[64:67], a[144:147], v[200:203], a[64:67]
v_exp_f32 v131, v131
v_mfma_f32_16x16x32_bf16 a[64:67], a[148:151], v[204:207], a[64:67]
v_cvt_pk_bf16_f32 v154, v92, v93
v_cvt_pk_bf16_f32 v155, v94, v95
v_mfma_f32_16x16x32_bf16 a[96:99], a[148:151], v[212:215], a[96:99]
v_exp_f32 v144, v144
v_mfma_f32_16x16x32_bf16 a[96:99], a[144:147], v[208:211], a[96:99]
ds_read_b128 a[180:183], v3 offset:12288
v_cvt_pk_bf16_f32 v156, v96, v97
v_mfma_f32_16x16x32_bf16 a[100:103], a[152:155], v[208:211], a[100:103]
v_exp_f32 v145, v145
v_mfma_f32_16x16x32_bf16 a[100:103], a[156:159], v[212:215], a[100:103]
ds_read_b128 a[184:187], v3 offset:5120
v_cvt_pk_bf16_f32 v157, v98, v99
v_mfma_f32_16x16x32_bf16 a[68:71], a[156:159], v[204:207], a[68:71]
ds_read_b128 a[188:191], v3 offset:13312
v_cvt_pk_bf16_f32 v164, v112, v113
v_mfma_f32_16x16x32_bf16 a[68:71], a[152:155], v[200:203], a[68:71]
buffer_load_dwordx4 v16, s[32:35], s64 offen offset:3072 sc1 lds
v_mfma_f32_16x16x32_bf16 a[36:39], a[152:155], v[176:179], a[36:39]
ds_read_b128 a[192:195], v3 offset:6144
v_cvt_pk_bf16_f32 v165, v114, v115
v_mfma_f32_16x16x32_bf16 a[36:39], a[156:159], v[180:183], a[36:39]
ds_read_b128 a[196:199], v3 offset:14336
v_cvt_pk_bf16_f32 v188, v128, v129
v_mfma_f32_16x16x32_bf16 a[4:7], a[156:159], v[172:175], a[4:7]
ds_read_b128 a[200:203], v3 offset:7168
v_cvt_pk_bf16_f32 v189, v130, v131
v_mfma_f32_16x16x32_bf16 a[4:7], a[152:155], v[168:171], a[4:7]
v_exp_f32 v146, v146
v_mfma_f32_16x16x32_bf16 a[8:11], a[160:163], v[168:171], a[8:11]
v_exp_f32 v147, v147
v_mfma_f32_16x16x32_bf16 a[8:11], a[164:167], v[172:175], a[8:11]
v_exp_f32 v148, v148
v_mfma_f32_16x16x32_bf16 a[40:43], a[164:167], v[180:183], a[40:43]
ds_read_b128 a[204:207], v3 offset:15360
v_cvt_pk_bf16_f32 v196, v144, v145
v_mfma_f32_16x16x32_bf16 a[40:43], a[160:163], v[176:179], a[40:43]
v_exp_f32 v149, v149
v_mfma_f32_16x16x32_bf16 a[72:75], a[160:163], v[200:203], a[72:75]
v_exp_f32 v150, v150
v_mfma_f32_16x16x32_bf16 a[72:75], a[164:167], v[204:207], a[72:75]
v_exp_f32 v151, v151
v_mfma_f32_16x16x32_bf16 a[104:107], a[164:167], v[212:215], a[104:107]
v_exp_f32 v132, v132
v_mfma_f32_16x16x32_bf16 a[104:107], a[160:163], v[208:211], a[104:107]
s_waitcnt lgkmcnt(1)
v_exp_f32 v133, v133
v_mfma_f32_16x16x32_bf16 a[108:111], a[168:171], v[208:211], a[108:111]
v_exp_f32 v134, v134
v_mfma_f32_16x16x32_bf16 a[108:111], a[172:175], v[212:215], a[108:111]
v_exp_f32 v135, v135
v_mfma_f32_16x16x32_bf16 a[76:79], a[172:175], v[204:207], a[76:79]
v_exp_f32 v116, v116
v_mfma_f32_16x16x32_bf16 a[76:79], a[168:171], v[200:203], a[76:79]
v_exp_f32 v117, v117
v_mfma_f32_16x16x32_bf16 a[44:47], a[168:171], v[176:179], a[44:47]
v_exp_f32 v118, v118
v_mfma_f32_16x16x32_bf16 a[44:47], a[172:175], v[180:183], a[44:47]
s_waitcnt vmcnt(9)
s_barrier
v_mfma_f32_16x16x32_bf16 a[12:15], a[172:175], v[172:175], a[12:15]
s_xor_b32 s71, s71, 16384
v_exp_f32 v119, v119
v_mfma_f32_16x16x32_bf16 a[12:15], a[168:171], v[168:171], a[12:15]
s_add_u32 s70, s70, 32768
v_exp_f32 v100, v100
v_mfma_f32_16x16x32_bf16 a[16:19], a[176:179], v[168:171], a[16:19]
s_mov_b32 m0, s71
v_exp_f32 v101, v101
v_mfma_f32_16x16x32_bf16 a[16:19], a[180:183], v[172:175], a[16:19]
buffer_load_dwordx4 v16, s[32:35], s70 offen offset:0 sc1 lds
v_mfma_f32_16x16x32_bf16 a[48:51], a[180:183], v[180:183], a[48:51]
ds_read_b128 a[144:147], v2 offset:16384
v_cvt_pk_bf16_f32 v197, v146, v147
v_mfma_f32_16x16x32_bf16 a[48:51], a[176:179], v[176:179], a[48:51]
ds_read_b128 a[148:151], v2 offset:17408
v_cvt_pk_bf16_f32 v198, v148, v149
v_mfma_f32_16x16x32_bf16 a[80:83], a[176:179], v[200:203], a[80:83]
v_exp_f32 v102, v102
v_mfma_f32_16x16x32_bf16 a[80:83], a[180:183], v[204:207], a[80:83]
ds_read_b128 a[152:155], v2 offset:18432
v_cvt_pk_bf16_f32 v199, v150, v151
v_mfma_f32_16x16x32_bf16 a[112:115], a[180:183], v[212:215], a[112:115]
ds_read_b128 a[156:159], v2 offset:19456
v_cvt_pk_bf16_f32 v190, v132, v133
v_mfma_f32_16x16x32_bf16 a[112:115], a[176:179], v[208:211], a[112:115]
v_exp_f32 v103, v103
v_mfma_f32_16x16x32_bf16 a[116:119], a[184:187], v[208:211], a[116:119]
ds_read_b128 a[160:163], v2 offset:20480
v_cvt_pk_bf16_f32 v191, v134, v135
v_mfma_f32_16x16x32_bf16 a[116:119], a[188:191], v[212:215], a[116:119]
ds_read_b128 a[164:167], v2 offset:21504
v_cvt_pk_bf16_f32 v166, v116, v117
v_mfma_f32_16x16x32_bf16 a[84:87], a[188:191], v[204:207], a[84:87]
ds_read_b128 a[168:171], v2 offset:22528
v_cvt_pk_bf16_f32 v167, v118, v119
v_mfma_f32_16x16x32_bf16 a[84:87], a[184:187], v[200:203], a[84:87]
ds_read_b128 a[172:175], v2 offset:23552
v_cvt_pk_bf16_f32 v158, v100, v101
v_mfma_f32_16x16x32_bf16 a[52:55], a[184:187], v[176:179], a[52:55]
v_cvt_pk_bf16_f32 v159, v102, v103
v_mfma_f32_16x16x32_bf16 a[52:55], a[188:191], v[180:183], a[52:55]
v_mfma_f32_16x16x32_bf16 a[20:23], a[188:191], v[172:175], a[20:23]
v_mfma_f32_16x16x32_bf16 a[20:23], a[184:187], v[168:171], a[20:23]
v_mfma_f32_16x16x32_bf16 a[24:27], a[192:195], v[168:171], a[24:27]
buffer_load_dwordx4 v16, s[32:35], s70 offen offset:1024 sc1 lds
v_mfma_f32_16x16x32_bf16 a[24:27], a[196:199], v[172:175], a[24:27]
v_mfma_f32_16x16x32_bf16 a[56:59], a[196:199], v[180:183], a[56:59]
v_mfma_f32_16x16x32_bf16 a[56:59], a[192:195], v[176:179], a[56:59]
v_mfma_f32_16x16x32_bf16 a[88:91], a[192:195], v[200:203], a[88:91]
v_mfma_f32_16x16x32_bf16 a[88:91], a[196:199], v[204:207], a[88:91]
v_mfma_f32_16x16x32_bf16 a[120:123], a[196:199], v[212:215], a[120:123]
v_mfma_f32_16x16x32_bf16 a[120:123], a[192:195], v[208:211], a[120:123]
v_mfma_f32_16x16x32_bf16 a[124:127], a[200:203], v[208:211], a[124:127]
s_waitcnt lgkmcnt(0)
v_mfma_f32_16x16x32_bf16 a[124:127], a[204:207], v[212:215], a[124:127]
v_mfma_f32_16x16x32_bf16 a[92:95], a[204:207], v[204:207], a[92:95]
v_mfma_f32_16x16x32_bf16 a[92:95], a[200:203], v[200:203], a[92:95]
v_mfma_f32_16x16x32_bf16 a[60:63], a[200:203], v[176:179], a[60:63]
v_mfma_f32_16x16x32_bf16 a[60:63], a[204:207], v[180:183], a[60:63]
v_mfma_f32_16x16x32_bf16 a[28:31], a[204:207], v[172:175], a[28:31]
v_mfma_f32_16x16x32_bf16 a[28:31], a[200:203], v[168:171], a[28:31]
v_mfma_f32_16x16x32_bf16 v[88:91], a[144:147], v[24:27], v[216:219]
ds_read_b128 a[176:179], v2 offset:24576
v_mfma_f32_16x16x32_bf16 v[88:91], a[148:151], v[28:31], v[88:91]
ds_read_b128 a[180:183], v2 offset:25600
v_mfma_f32_16x16x32_bf16 v[88:91], a[152:155], v[32:35], v[88:91]
buffer_load_dwordx4 v16, s[32:35], s70 offen offset:2048 sc1 lds
v_mfma_f32_16x16x32_bf16 v[88:91], a[156:159], v[36:39], v[88:91]
ds_read_b128 a[184:187], v2 offset:26624
v_mfma_f32_16x16x32_bf16 v[104:107], a[156:159], v[52:55], v[220:223]
v_mfma_f32_16x16x32_bf16 v[104:107], a[152:155], v[48:51], v[104:107]
v_mfma_f32_16x16x32_bf16 v[104:107], a[148:151], v[44:47], v[104:107]
ds_read_b128 a[188:191], v2 offset:27648
v_mfma_f32_16x16x32_bf16 v[104:107], a[144:147], v[40:43], v[104:107]
v_mfma_f32_16x16x32_bf16 v[120:123], a[144:147], v[56:59], v[224:227]
v_mfma_f32_16x16x32_bf16 v[120:123], a[148:151], v[60:63], v[120:123]
v_mfma_f32_16x16x32_bf16 v[120:123], a[152:155], v[64:67], v[120:123]
v_exp_f32 v88, v88
v_mfma_f32_16x16x32_bf16 v[120:123], a[156:159], v[68:71], v[120:123]
v_exp_f32 v89, v89
v_mfma_f32_16x16x32_bf16 v[136:139], a[156:159], v[84:87], v[228:231]
v_exp_f32 v90, v90
v_mfma_f32_16x16x32_bf16 v[136:139], a[152:155], v[80:83], v[136:139]
v_exp_f32 v91, v91
v_mfma_f32_16x16x32_bf16 v[136:139], a[148:151], v[76:79], v[136:139]
v_exp_f32 v104, v104
v_mfma_f32_16x16x32_bf16 v[136:139], a[144:147], v[72:75], v[136:139]
v_exp_f32 v105, v105
v_mfma_f32_16x16x32_bf16 v[140:143], a[160:163], v[72:75], v[228:231]
v_exp_f32 v106, v106
v_mfma_f32_16x16x32_bf16 v[140:143], a[164:167], v[76:79], v[140:143]
buffer_load_dwordx4 v16, s[32:35], s70 offen offset:3072 sc1 lds
v_mfma_f32_16x16x32_bf16 v[140:143], a[168:171], v[80:83], v[140:143]
v_exp_f32 v107, v107
v_mfma_f32_16x16x32_bf16 v[140:143], a[172:175], v[84:87], v[140:143]
v_cvt_pk_bf16_f32 v168, v88, v89
v_cvt_pk_bf16_f32 v169, v90, v91
v_mfma_f32_16x16x32_bf16 v[124:127], a[172:175], v[68:71], v[224:227]
v_exp_f32 v120, v120
v_mfma_f32_16x16x32_bf16 v[124:127], a[168:171], v[64:67], v[124:127]
v_exp_f32 v121, v121
v_mfma_f32_16x16x32_bf16 v[124:127], a[164:167], v[60:63], v[124:127]
v_exp_f32 v122, v122
v_mfma_f32_16x16x32_bf16 v[124:127], a[160:163], v[56:59], v[124:127]
v_exp_f32 v123, v123
v_mfma_f32_16x16x32_bf16 v[108:111], a[160:163], v[40:43], v[220:223]
v_exp_f32 v136, v136
v_mfma_f32_16x16x32_bf16 v[108:111], a[164:167], v[44:47], v[108:111]
v_exp_f32 v137, v137
v_mfma_f32_16x16x32_bf16 v[108:111], a[168:171], v[48:51], v[108:111]
v_exp_f32 v138, v138
v_mfma_f32_16x16x32_bf16 v[108:111], a[172:175], v[52:55], v[108:111]
v_cvt_pk_bf16_f32 v176, v104, v105
v_cvt_pk_bf16_f32 v177, v106, v107
v_mfma_f32_16x16x32_bf16 v[92:95], a[172:175], v[36:39], v[216:219]
v_exp_f32 v139, v139
v_mfma_f32_16x16x32_bf16 v[92:95], a[168:171], v[32:35], v[92:95]
ds_read_b128 a[192:195], v2 offset:28672
v_cvt_pk_bf16_f32 v200, v120, v121
v_mfma_f32_16x16x32_bf16 v[92:95], a[164:167], v[28:31], v[92:95]
v_exp_f32 v140, v140
v_mfma_f32_16x16x32_bf16 v[92:95], a[160:163], v[24:27], v[92:95]
s_waitcnt lgkmcnt(1)
s_add_u32 m0, s71, 4096
ds_read_b128 a[196:199], v2 offset:29696
v_cvt_pk_bf16_f32 v201, v122, v123
v_mfma_f32_16x16x32_bf16 v[96:99], a[176:179], v[24:27], v[216:219]
s_add_u32 s64, s70, 4096
ds_read_b128 a[200:203], v2 offset:30720
v_cvt_pk_bf16_f32 v208, v136, v137
v_mfma_f32_16x16x32_bf16 v[96:99], a[180:183], v[28:31], v[96:99]
buffer_load_dwordx4 v16, s[32:35], s64 offen offset:0 sc1 lds
v_mfma_f32_16x16x32_bf16 v[96:99], a[184:187], v[32:35], v[96:99]
v_exp_f32 v141, v141
v_mfma_f32_16x16x32_bf16 v[96:99], a[188:191], v[36:39], v[96:99]
ds_read_b128 a[204:207], v2 offset:31744
v_cvt_pk_bf16_f32 v209, v138, v139
v_mfma_f32_16x16x32_bf16 v[112:115], a[188:191], v[52:55], v[220:223]
v_exp_f32 v142, v142
v_mfma_f32_16x16x32_bf16 v[112:115], a[184:187], v[48:51], v[112:115]
v_exp_f32 v143, v143
v_mfma_f32_16x16x32_bf16 v[112:115], a[180:183], v[44:47], v[112:115]
v_exp_f32 v124, v124
v_mfma_f32_16x16x32_bf16 v[112:115], a[176:179], v[40:43], v[112:115]
v_exp_f32 v125, v125
v_mfma_f32_16x16x32_bf16 v[128:131], a[176:179], v[56:59], v[224:227]
v_exp_f32 v126, v126
v_mfma_f32_16x16x32_bf16 v[128:131], a[180:183], v[60:63], v[128:131]
v_exp_f32 v127, v127
v_mfma_f32_16x16x32_bf16 v[128:131], a[184:187], v[64:67], v[128:131]
v_exp_f32 v108, v108
v_mfma_f32_16x16x32_bf16 v[128:131], a[188:191], v[68:71], v[128:131]
v_exp_f32 v109, v109
v_mfma_f32_16x16x32_bf16 v[144:147], a[188:191], v[84:87], v[228:231]
v_exp_f32 v110, v110
v_mfma_f32_16x16x32_bf16 v[144:147], a[184:187], v[80:83], v[144:147]
ds_read_b128 a[144:147], v3 offset:16384
v_cvt_pk_bf16_f32 v210, v140, v141
v_mfma_f32_16x16x32_bf16 v[144:147], a[180:183], v[76:79], v[144:147]
ds_read_b128 a[148:151], v3 offset:24576
v_cvt_pk_bf16_f32 v211, v142, v143
v_mfma_f32_16x16x32_bf16 v[144:147], a[176:179], v[72:75], v[144:147]
s_waitcnt lgkmcnt(2)
v_exp_f32 v111, v111
v_mfma_f32_16x16x32_bf16 v[148:151], a[192:195], v[72:75], v[228:231]
buffer_load_dwordx4 v16, s[32:35], s64 offen offset:1024 sc1 lds
v_mfma_f32_16x16x32_bf16 v[148:151], a[196:199], v[76:79], v[148:151]
v_exp_f32 v92, v92
v_mfma_f32_16x16x32_bf16 v[148:151], a[200:203], v[80:83], v[148:151]
v_exp_f32 v93, v93
v_mfma_f32_16x16x32_bf16 v[148:151], a[204:207], v[84:87], v[148:151]
v_exp_f32 v94, v94
v_mfma_f32_16x16x32_bf16 v[132:135], a[204:207], v[68:71], v[224:227]
ds_read_b128 a[152:155], v3 offset:17408
v_cvt_pk_bf16_f32 v202, v124, v125
v_mfma_f32_16x16x32_bf16 v[132:135], a[200:203], v[64:67], v[132:135]
ds_read_b128 a[156:159], v3 offset:25600
v_cvt_pk_bf16_f32 v203, v126, v127
v_mfma_f32_16x16x32_bf16 v[132:135], a[196:199], v[60:63], v[132:135]
v_exp_f32 v95, v95
v_mfma_f32_16x16x32_bf16 v[132:135], a[192:195], v[56:59], v[132:135]
v_exp_f32 v96, v96
v_mfma_f32_16x16x32_bf16 v[116:119], a[192:195], v[40:43], v[220:223]
v_exp_f32 v97, v97
v_mfma_f32_16x16x32_bf16 v[116:119], a[196:199], v[44:47], v[116:119]
v_exp_f32 v98, v98
v_mfma_f32_16x16x32_bf16 v[116:119], a[200:203], v[48:51], v[116:119]
ds_read_b128 a[160:163], v3 offset:18432
v_cvt_pk_bf16_f32 v178, v108, v109
v_mfma_f32_16x16x32_bf16 v[116:119], a[204:207], v[52:55], v[116:119]
v_exp_f32 v99, v99
v_mfma_f32_16x16x32_bf16 v[100:103], a[204:207], v[36:39], v[216:219]
ds_read_b128 a[164:167], v3 offset:26624
v_cvt_pk_bf16_f32 v179, v110, v111
v_mfma_f32_16x16x32_bf16 v[100:103], a[200:203], v[32:35], v[100:103]
v_exp_f32 v112, v112
v_mfma_f32_16x16x32_bf16 v[100:103], a[196:199], v[28:31], v[100:103]
v_exp_f32 v113, v113
v_mfma_f32_16x16x32_bf16 v[100:103], a[192:195], v[24:27], v[100:103]
v_exp_f32 v114, v114
v_smfmac_f32_16x16x64_bf16 a[128:131], a[240:243], v[152:159], v5
ds_read_b128 a[168:171], v3 offset:19456
v_smfmac_f32_16x16x64_bf16 a[132:135], a[240:243], v[160:167], v5
ds_read_b128 a[172:175], v3 offset:27648
v_smfmac_f32_16x16x64_bf16 a[136:139], a[240:243], v[184:191], v5
ds_read_b128 a[176:179], v3 offset:20480
v_smfmac_f32_16x16x64_bf16 a[140:143], a[240:243], v[192:199], v5
s_waitcnt lgkmcnt(3)
buffer_load_dwordx4 v16, s[32:35], s64 offen offset:2048 sc1 lds
v_mfma_f32_16x16x32_bf16 a[0:3], a[144:147], v[152:155], a[0:3]
v_exp_f32 v115, v115
v_mfma_f32_16x16x32_bf16 a[0:3], a[148:151], v[156:159], a[0:3]
v_exp_f32 v128, v128
v_mfma_f32_16x16x32_bf16 a[32:35], a[148:151], v[164:167], a[32:35]
v_exp_f32 v129, v129
v_mfma_f32_16x16x32_bf16 a[32:35], a[144:147], v[160:163], a[32:35]
v_exp_f32 v130, v130
v_mfma_f32_16x16x32_bf16 a[64:67], a[144:147], v[184:187], a[64:67]
v_exp_f32 v131, v131
v_mfma_f32_16x16x32_bf16 a[64:67], a[148:151], v[188:191], a[64:67]
v_cvt_pk_bf16_f32 v170, v92, v93
v_cvt_pk_bf16_f32 v171, v94, v95
v_mfma_f32_16x16x32_bf16 a[96:99], a[148:151], v[196:199], a[96:99]
v_exp_f32 v144, v144
v_mfma_f32_16x16x32_bf16 a[96:99], a[144:147], v[192:195], a[96:99]
ds_read_b128 a[180:183], v3 offset:28672
v_cvt_pk_bf16_f32 v172, v96, v97
v_mfma_f32_16x16x32_bf16 a[100:103], a[152:155], v[192:195], a[100:103]
v_exp_f32 v145, v145
v_mfma_f32_16x16x32_bf16 a[100:103], a[156:159], v[196:199], a[100:103]
ds_read_b128 a[184:187], v3 offset:21504
v_xor_b32 v2, 0x8000, v2
v_mfma_f32_16x16x32_bf16 a[68:71], a[156:159], v[188:191], a[68:71]
ds_read_b128 a[188:191], v3 offset:29696
v_cvt_pk_bf16_f32 v173, v98, v99
v_mfma_f32_16x16x32_bf16 a[68:71], a[152:155], v[184:187], a[68:71]
buffer_load_dwordx4 v16, s[32:35], s64 offen offset:3072 sc1 lds
v_mfma_f32_16x16x32_bf16 a[36:39], a[152:155], v[160:163], a[36:39]
ds_read_b128 a[192:195], v3 offset:22528
v_cvt_pk_bf16_f32 v180, v112, v113
v_mfma_f32_16x16x32_bf16 a[36:39], a[156:159], v[164:167], a[36:39]
ds_read_b128 a[196:199], v3 offset:30720
v_cvt_pk_bf16_f32 v181, v114, v115
v_mfma_f32_16x16x32_bf16 a[4:7], a[156:159], v[156:159], a[4:7]
ds_read_b128 a[200:203], v3 offset:23552
v_cvt_pk_bf16_f32 v204, v128, v129
v_mfma_f32_16x16x32_bf16 a[4:7], a[152:155], v[152:155], a[4:7]
v_exp_f32 v146, v146
v_mfma_f32_16x16x32_bf16 a[8:11], a[160:163], v[152:155], a[8:11]
v_exp_f32 v147, v147
v_mfma_f32_16x16x32_bf16 a[8:11], a[164:167], v[156:159], a[8:11]
v_exp_f32 v148, v148
v_mfma_f32_16x16x32_bf16 a[40:43], a[164:167], v[164:167], a[40:43]
ds_read_b128 a[204:207], v3 offset:31744
v_cvt_pk_bf16_f32 v205, v130, v131
v_mfma_f32_16x16x32_bf16 a[40:43], a[160:163], v[160:163], a[40:43]
v_exp_f32 v149, v149
v_mfma_f32_16x16x32_bf16 a[72:75], a[160:163], v[184:187], a[72:75]
v_exp_f32 v150, v150
v_mfma_f32_16x16x32_bf16 a[72:75], a[164:167], v[188:191], a[72:75]
v_exp_f32 v151, v151
v_mfma_f32_16x16x32_bf16 a[104:107], a[164:167], v[196:199], a[104:107]
v_exp_f32 v132, v132
v_mfma_f32_16x16x32_bf16 a[104:107], a[160:163], v[192:195], a[104:107]
s_waitcnt lgkmcnt(1)
v_exp_f32 v133, v133
v_mfma_f32_16x16x32_bf16 a[108:111], a[168:171], v[192:195], a[108:111]
v_exp_f32 v134, v134
v_mfma_f32_16x16x32_bf16 a[108:111], a[172:175], v[196:199], a[108:111]
v_exp_f32 v135, v135
v_mfma_f32_16x16x32_bf16 a[76:79], a[172:175], v[188:191], a[76:79]
v_exp_f32 v116, v116
v_mfma_f32_16x16x32_bf16 a[76:79], a[168:171], v[184:187], a[76:79]
v_exp_f32 v117, v117
v_mfma_f32_16x16x32_bf16 a[44:47], a[168:171], v[160:163], a[44:47]
v_exp_f32 v118, v118
v_mfma_f32_16x16x32_bf16 a[44:47], a[172:175], v[164:167], a[44:47]
s_waitcnt vmcnt(8)
s_barrier
v_mfma_f32_16x16x32_bf16 a[12:15], a[172:175], v[156:159], a[12:15]
s_xor_b32 s71, s71, 49152
v_exp_f32 v119, v119
v_mfma_f32_16x16x32_bf16 a[12:15], a[168:171], v[152:155], a[12:15]
s_add_u32 s70, s70, 32768
v_exp_f32 v100, v100
v_mfma_f32_16x16x32_bf16 a[16:19], a[176:179], v[152:155], a[16:19]
s_mov_b32 m0, s71
v_exp_f32 v101, v101
v_mfma_f32_16x16x32_bf16 a[16:19], a[180:183], v[156:159], a[16:19]
s_add_u32 s17, s78, L_DD-L_pc
buffer_load_dwordx4 v16, s[32:35], s70 offen offset:0 sc1 lds
v_mfma_f32_16x16x32_bf16 a[48:51], a[180:183], v[164:167], a[48:51]
buffer_load_dword a252, v16, s[88:91], s17 offen
v_mfma_f32_16x16x32_bf16 a[48:51], a[176:179], v[160:163], a[48:51]
v_cvt_pk_bf16_f32 v212, v144, v145
v_cvt_pk_bf16_f32 v213, v146, v147
v_mfma_f32_16x16x32_bf16 a[80:83], a[176:179], v[184:187], a[80:83]
s_add_u32 s17, s78, L_DD-L_pc+4096
ds_read_b128 a[144:147], v2 offset:0
v_cvt_pk_bf16_f32 v214, v148, v149
v_mfma_f32_16x16x32_bf16 a[80:83], a[180:183], v[188:191], a[80:83]
buffer_load_dword a252, v16, s[88:91], s17 offen
v_mfma_f32_16x16x32_bf16 a[112:115], a[180:183], v[196:199], a[112:115]
ds_read_b128 a[148:151], v2 offset:1024
v_cvt_pk_bf16_f32 v215, v150, v151
v_mfma_f32_16x16x32_bf16 a[112:115], a[176:179], v[192:195], a[112:115]
v_exp_f32 v102, v102
v_mfma_f32_16x16x32_bf16 a[116:119], a[184:187], v[192:195], a[116:119]
ds_read_b128 a[152:155], v2 offset:2048
v_cvt_pk_bf16_f32 v206, v132, v133
v_mfma_f32_16x16x32_bf16 a[116:119], a[188:191], v[196:199], a[116:119]
ds_read_b128 a[156:159], v2 offset:3072
v_cvt_pk_bf16_f32 v207, v134, v135
v_mfma_f32_16x16x32_bf16 a[84:87], a[188:191], v[188:191], a[84:87]
v_exp_f32 v103, v103
v_mfma_f32_16x16x32_bf16 a[84:87], a[184:187], v[184:187], a[84:87]
ds_read_b128 a[160:163], v2 offset:4096
v_cvt_pk_bf16_f32 v182, v116, v117
v_mfma_f32_16x16x32_bf16 a[52:55], a[184:187], v[160:163], a[52:55]
ds_read_b128 a[164:167], v2 offset:5120
v_cvt_pk_bf16_f32 v183, v118, v119
v_mfma_f32_16x16x32_bf16 a[52:55], a[188:191], v[164:167], a[52:55]
ds_read_b128 a[168:171], v2 offset:6144
v_xor_b32 v3, 0x8000, v3
v_mfma_f32_16x16x32_bf16 a[20:23], a[188:191], v[156:159], a[20:23]
ds_read_b128 a[172:175], v2 offset:7168
v_cvt_pk_bf16_f32 v174, v100, v101
v_mfma_f32_16x16x32_bf16 a[20:23], a[184:187], v[152:155], a[20:23]
v_cvt_pk_bf16_f32 v175, v102, v103
v_mfma_f32_16x16x32_bf16 a[24:27], a[192:195], v[152:155], a[24:27]
buffer_load_dwordx4 v16, s[32:35], s70 offen offset:1024 sc1 lds
v_mfma_f32_16x16x32_bf16 a[24:27], a[196:199], v[156:159], a[24:27]
v_mfma_f32_16x16x32_bf16 a[56:59], a[196:199], v[164:167], a[56:59]
v_mfma_f32_16x16x32_bf16 a[56:59], a[192:195], v[160:163], a[56:59]
v_mfma_f32_16x16x32_bf16 a[88:91], a[192:195], v[184:187], a[88:91]
v_mfma_f32_16x16x32_bf16 a[88:91], a[196:199], v[188:191], a[88:91]
v_mfma_f32_16x16x32_bf16 a[120:123], a[196:199], v[196:199], a[120:123]
s_sub_u32 s72, s72, 1
v_mfma_f32_16x16x32_bf16 a[120:123], a[192:195], v[192:195], a[120:123]
v_mfma_f32_16x16x32_bf16 a[124:127], a[200:203], v[192:195], a[124:127]
s_waitcnt lgkmcnt(0)
v_mfma_f32_16x16x32_bf16 a[124:127], a[204:207], v[196:199], a[124:127]
v_mfma_f32_16x16x32_bf16 a[92:95], a[204:207], v[188:191], a[92:95]
s_cmp_lg_u32 s72, 0
v_mfma_f32_16x16x32_bf16 a[92:95], a[200:203], v[184:187], a[92:95]
v_mfma_f32_16x16x32_bf16 a[60:63], a[200:203], v[160:163], a[60:63]
v_mfma_f32_16x16x32_bf16 a[60:63], a[204:207], v[164:167], a[60:63]
v_mfma_f32_16x16x32_bf16 a[28:31], a[204:207], v[156:159], a[28:31]
v_mfma_f32_16x16x32_bf16 a[28:31], a[200:203], v[152:155], a[28:31]
s_cbranch_scc1 L_D
L_DD:
s_waitcnt lgkmcnt(7)
v_mfma_f32_16x16x32_bf16 v[104:107], a[144:147], v[40:43], v[220:223]
s_waitcnt lgkmcnt(6)
ds_read_b128 a[176:179], v2 offset:8192
v_cndmask_b32 v88, v216, v17, s[0:1]
v_mfma_f32_16x16x32_bf16 v[104:107], a[148:151], v[44:47], v[104:107]
s_waitcnt lgkmcnt(6)
ds_read_b128 a[180:183], v2 offset:9216
v_cndmask_b32 v89, v216, v17, s[4:5]
v_mfma_f32_16x16x32_bf16 v[104:107], a[152:155], v[48:51], v[104:107]
s_waitcnt lgkmcnt(6)
buffer_load_dwordx4 v16, s[32:35], s70 offen offset:2048 sc1 lds
v_mfma_f32_16x16x32_bf16 v[104:107], a[156:159], v[52:55], v[104:107]
ds_read_b128 a[184:187], v2 offset:10240
v_cndmask_b32 v90, v216, v17, s[6:7]
v_mfma_f32_16x16x32_bf16 v[120:123], a[156:159], v[68:71], v[224:227]
ds_read_b128 a[188:191], v2 offset:11264
v_cndmask_b32 v91, v216, v17, s[8:9]
v_mfma_f32_16x16x32_bf16 v[120:123], a[152:155], v[64:67], v[120:123]
ds_read_b128 a[192:195], v2 offset:12288
v_cndmask_b32 v92, v216, v17, s[10:11]
v_mfma_f32_16x16x32_bf16 v[120:123], a[148:151], v[60:63], v[120:123]
ds_read_b128 a[196:199], v2 offset:13312
v_cndmask_b32 v93, v216, v17, s[12:13]
v_mfma_f32_16x16x32_bf16 v[120:123], a[144:147], v[56:59], v[120:123]
ds_read_b128 a[200:203], v2 offset:14336
v_cndmask_b32 v94, v216, v17, s[18:19]
v_mfma_f32_16x16x32_bf16 v[136:139], a[144:147], v[72:75], v[228:231]
ds_read_b128 a[204:207], v2 offset:15360
v_cndmask_b32 v95, v216, v17, s[22:23]
v_mfma_f32_16x16x32_bf16 v[136:139], a[148:151], v[76:79], v[136:139]
v_cndmask_b32 v96, v216, v17, s[26:27]
v_cndmask_b32 v97, v216, v17, s[56:57]
v_mfma_f32_16x16x32_bf16 v[136:139], a[152:155], v[80:83], v[136:139]
v_exp_f32 v104, v104
v_mfma_f32_16x16x32_bf16 v[136:139], a[156:159], v[84:87], v[136:139]
v_exp_f32 v105, v105
v_mfma_f32_16x16x32_bf16 v[88:91], a[156:159], v[36:39], v[88:91]
v_exp_f32 v106, v106
v_mfma_f32_16x16x32_bf16 v[88:91], a[152:155], v[32:35], v[88:91]
v_exp_f32 v107, v107
v_mfma_f32_16x16x32_bf16 v[88:91], a[148:151], v[28:31], v[88:91]
v_exp_f32 v120, v120
v_mfma_f32_16x16x32_bf16 v[88:91], a[144:147], v[24:27], v[88:91]
s_waitcnt lgkmcnt(0)
v_exp_f32 v121, v121
v_mfma_f32_16x16x32_bf16 v[140:143], a[160:163], v[72:75], v[228:231]
v_exp_f32 v122, v122
v_mfma_f32_16x16x32_bf16 v[140:143], a[164:167], v[76:79], v[140:143]
buffer_load_dwordx4 v16, s[32:35], s70 offen offset:3072 sc1 lds
v_mfma_f32_16x16x32_bf16 v[140:143], a[168:171], v[80:83], v[140:143]
s_add_u32 m0, s86, 131072
v_exp_f32 v123, v123
v_mfma_f32_16x16x32_bf16 v[140:143], a[172:175], v[84:87], v[140:143]
s_add_u32 s64, s85, 0
v_cvt_pk_bf16_f32 v160, v104, v105
v_cvt_pk_bf16_f32 v161, v106, v107
v_mfma_f32_16x16x32_bf16 v[124:127], a[172:175], v[68:71], v[224:227]
buffer_load_dwordx4 v12, s[36:39], s64 offen lds
v_mfma_f32_16x16x32_bf16 v[124:127], a[168:171], v[64:67], v[124:127]
s_add_u32 m0, s86, 132096
v_exp_f32 v136, v136
v_mfma_f32_16x16x32_bf16 v[124:127], a[164:167], v[60:63], v[124:127]
s_add_u32 s64, s85, 8192
v_exp_f32 v137, v137
v_mfma_f32_16x16x32_bf16 v[124:127], a[160:163], v[56:59], v[124:127]
buffer_load_dwordx4 v13, s[36:39], s64 offen lds
v_mfma_f32_16x16x32_bf16 v[108:111], a[160:163], v[40:43], v[220:223]
v_exp_f32 v138, v138
v_mfma_f32_16x16x32_bf16 v[108:111], a[164:167], v[44:47], v[108:111]
ds_read_b128 a[144:147], v3 offset:0
v_cndmask_b32 v98, v216, v17, s[58:59]
v_mfma_f32_16x16x32_bf16 v[108:111], a[168:171], v[48:51], v[108:111]
s_add_u32 m0, s86, 133120
ds_read_b128 a[148:151], v3 offset:8192
v_cndmask_b32 v99, v216, v17, s[60:61]
v_mfma_f32_16x16x32_bf16 v[108:111], a[172:175], v[52:55], v[108:111]
s_add_u32 s64, s85, 16384
v_cvt_pk_bf16_f32 v184, v120, v121
v_cvt_pk_bf16_f32 v185, v122, v123
v_mfma_f32_16x16x32_bf16 v[92:95], a[172:175], v[36:39], v[92:95]
buffer_load_dwordx4 v12, s[36:39], s64 offen lds
v_mfma_f32_16x16x32_bf16 v[92:95], a[168:171], v[32:35], v[92:95]
s_add_u32 m0, s86, 134144
v_exp_f32 v139, v139
v_mfma_f32_16x16x32_bf16 v[92:95], a[164:167], v[28:31], v[92:95]
s_add_u32 s64, s85, 24576
v_exp_f32 v88, v88
v_mfma_f32_16x16x32_bf16 v[92:95], a[160:163], v[24:27], v[92:95]
buffer_load_dwordx4 v13, s[36:39], s64 offen lds
v_mfma_f32_16x16x32_bf16 v[96:99], a[176:179], v[24:27], v[96:99]
s_add_u32 m0, s71, 4096
v_exp_f32 v89, v89
v_mfma_f32_16x16x32_bf16 v[96:99], a[180:183], v[28:31], v[96:99]
s_add_u32 s64, s70, 4096
v_exp_f32 v90, v90
v_mfma_f32_16x16x32_bf16 v[96:99], a[184:187], v[32:35], v[96:99]
buffer_load_dwordx4 v16, s[32:35], s64 offen offset:0 sc1 lds
v_mfma_f32_16x16x32_bf16 v[96:99], a[188:191], v[36:39], v[96:99]
v_cvt_pk_bf16_f32 v192, v136, v137
v_cvt_pk_bf16_f32 v193, v138, v139
v_mfma_f32_16x16x32_bf16 v[112:115], a[188:191], v[52:55], v[220:223]
v_exp_f32 v91, v91
v_mfma_f32_16x16x32_bf16 v[112:115], a[184:187], v[48:51], v[112:115]
v_exp_f32 v140, v140
v_mfma_f32_16x16x32_bf16 v[112:115], a[180:183], v[44:47], v[112:115]
v_exp_f32 v141, v141
v_mfma_f32_16x16x32_bf16 v[112:115], a[176:179], v[40:43], v[112:115]
v_exp_f32 v142, v142
v_mfma_f32_16x16x32_bf16 v[128:131], a[176:179], v[56:59], v[224:227]
v_exp_f32 v143, v143
v_mfma_f32_16x16x32_bf16 v[128:131], a[180:183], v[60:63], v[128:131]
v_exp_f32 v124, v124
v_mfma_f32_16x16x32_bf16 v[128:131], a[184:187], v[64:67], v[128:131]
v_cvt_pk_bf16_f32 v152, v88, v89
v_cvt_pk_bf16_f32 v153, v90, v91
v_mfma_f32_16x16x32_bf16 v[128:131], a[188:191], v[68:71], v[128:131]
v_exp_f32 v125, v125
v_mfma_f32_16x16x32_bf16 v[144:147], a[188:191], v[84:87], v[228:231]
v_exp_f32 v126, v126
v_mfma_f32_16x16x32_bf16 v[144:147], a[184:187], v[80:83], v[144:147]
v_exp_f32 v127, v127
v_mfma_f32_16x16x32_bf16 v[144:147], a[180:183], v[76:79], v[144:147]
v_exp_f32 v108, v108
v_mfma_f32_16x16x32_bf16 v[144:147], a[176:179], v[72:75], v[144:147]
ds_read_b128 a[152:155], v3 offset:1024
v_cndmask_b32 v100, v216, v17, s[62:63]
v_mfma_f32_16x16x32_bf16 v[148:151], a[192:195], v[72:75], v[228:231]
buffer_load_dwordx4 v16, s[32:35], s64 offen offset:1024 sc1 lds
v_mfma_f32_16x16x32_bf16 v[148:151], a[196:199], v[76:79], v[148:151]
ds_read_b128 a[156:159], v3 offset:9216
v_cndmask_b32 v101, v216, v17, s[48:49]
v_mfma_f32_16x16x32_bf16 v[148:151], a[200:203], v[80:83], v[148:151]
v_cvt_pk_bf16_f32 v194, v140, v141
v_cvt_pk_bf16_f32 v195, v142, v143
v_mfma_f32_16x16x32_bf16 v[148:151], a[204:207], v[84:87], v[148:151]
ds_read_b128 a[160:163], v3 offset:2048
v_cndmask_b32 v102, v216, v17, s[50:51]
v_mfma_f32_16x16x32_bf16 v[132:135], a[204:207], v[68:71], v[224:227]
ds_read_b128 a[164:167], v3 offset:10240
v_cndmask_b32 v103, v216, v17, s[100:101]
v_mfma_f32_16x16x32_bf16 v[132:135], a[200:203], v[64:67], v[132:135]
v_exp_f32 v109, v109
v_mfma_f32_16x16x32_bf16 v[132:135], a[196:199], v[60:63], v[132:135]
v_exp_f32 v110, v110
v_mfma_f32_16x16x32_bf16 v[132:135], a[192:195], v[56:59], v[132:135]
v_exp_f32 v111, v111
v_mfma_f32_16x16x32_bf16 v[116:119], a[192:195], v[40:43], v[220:223]
v_exp_f32 v92, v92
v_mfma_f32_16x16x32_bf16 v[116:119], a[196:199], v[44:47], v[116:119]
v_cvt_pk_bf16_f32 v186, v124, v125
v_cvt_pk_bf16_f32 v187, v126, v127
v_mfma_f32_16x16x32_bf16 v[116:119], a[200:203], v[48:51], v[116:119]
v_exp_f32 v93, v93
v_mfma_f32_16x16x32_bf16 v[116:119], a[204:207], v[52:55], v[116:119]
v_exp_f32 v94, v94
v_mfma_f32_16x16x32_bf16 v[100:103], a[204:207], v[36:39], v[100:103]
v_exp_f32 v95, v95
v_mfma_f32_16x16x32_bf16 v[100:103], a[200:203], v[32:35], v[100:103]
v_exp_f32 v96, v96
v_mfma_f32_16x16x32_bf16 v[100:103], a[196:199], v[28:31], v[100:103]
v_exp_f32 v97, v97
v_mfma_f32_16x16x32_bf16 v[100:103], a[192:195], v[24:27], v[100:103]
v_exp_f32 v98, v98
v_smfmac_f32_16x16x64_bf16 a[128:131], a[240:243], v[168:175], v5
ds_read_b128 a[168:171], v3 offset:3072
v_smfmac_f32_16x16x64_bf16 a[132:135], a[240:243], v[176:183], v5
v_cvt_pk_bf16_f32 v162, v108, v109
v_smfmac_f32_16x16x64_bf16 a[136:139], a[240:243], v[200:207], v5
ds_read_b128 a[172:175], v3 offset:11264
v_smfmac_f32_16x16x64_bf16 a[140:143], a[240:243], v[208:215], v5
s_waitcnt lgkmcnt(2)
buffer_load_dwordx4 v16, s[32:35], s64 offen offset:2048 sc1 lds
v_mfma_f32_16x16x32_bf16 a[0:3], a[144:147], v[168:171], a[0:3]
v_exp_f32 v99, v99
v_mfma_f32_16x16x32_bf16 a[0:3], a[148:151], v[172:175], a[0:3]
v_cvt_pk_bf16_f32 v163, v110, v111
v_cvt_pk_bf16_f32 v154, v92, v93
v_mfma_f32_16x16x32_bf16 a[32:35], a[148:151], v[180:183], a[32:35]
v_exp_f32 v112, v112
v_mfma_f32_16x16x32_bf16 a[32:35], a[144:147], v[176:179], a[32:35]
v_exp_f32 v113, v113
v_mfma_f32_16x16x32_bf16 a[64:67], a[144:147], v[200:203], a[64:67]
v_exp_f32 v114, v114
v_mfma_f32_16x16x32_bf16 a[64:67], a[148:151], v[204:207], a[64:67]
v_exp_f32 v115, v115
v_mfma_f32_16x16x32_bf16 a[96:99], a[148:151], v[212:215], a[96:99]
v_exp_f32 v128, v128
v_mfma_f32_16x16x32_bf16 a[96:99], a[144:147], v[208:211], a[96:99]
v_exp_f32 v129, v129
v_mfma_f32_16x16x32_bf16 a[100:103], a[152:155], v[208:211], a[100:103]
v_exp_f32 v130, v130
v_mfma_f32_16x16x32_bf16 a[100:103], a[156:159], v[212:215], a[100:103]
v_cvt_pk_bf16_f32 v155, v94, v95
v_cvt_pk_bf16_f32 v156, v96, v97
v_mfma_f32_16x16x32_bf16 a[68:71], a[156:159], v[204:207], a[68:71]
v_exp_f32 v131, v131
v_mfma_f32_16x16x32_bf16 a[68:71], a[152:155], v[200:203], a[68:71]
buffer_load_dwordx4 v16, s[32:35], s64 offen offset:3072 sc1 lds
v_mfma_f32_16x16x32_bf16 a[36:39], a[152:155], v[176:179], a[36:39]
s_add_u32 m0, s86, 135168
ds_read_b128 a[176:179], v3 offset:4096
v_cvt_pk_bf16_f32 v157, v98, v99
v_mfma_f32_16x16x32_bf16 a[36:39], a[156:159], v[180:183], a[36:39]
s_add_u32 s64, s85, 32768
v_exp_f32 v144, v144
v_mfma_f32_16x16x32_bf16 a[4:7], a[156:159], v[172:175], a[4:7]
buffer_load_dwordx4 v12, s[36:39], s64 offen lds
v_mfma_f32_16x16x32_bf16 a[4:7], a[152:155], v[168:171], a[4:7]
s_add_u32 m0, s86, 136192
ds_read_b128 a[180:183], v3 offset:12288
v_cvt_pk_bf16_f32 v164, v112, v113
v_mfma_f32_16x16x32_bf16 a[8:11], a[160:163], v[168:171], a[8:11]
s_add_u32 s64, s85, 40960
v_exp_f32 v145, v145
v_mfma_f32_16x16x32_bf16 a[8:11], a[164:167], v[172:175], a[8:11]
buffer_load_dwordx4 v13, s[36:39], s64 offen lds
v_mfma_f32_16x16x32_bf16 a[40:43], a[164:167], v[180:183], a[40:43]
ds_read_b128 a[184:187], v3 offset:5120
v_cvt_pk_bf16_f32 v165, v114, v115
v_mfma_f32_16x16x32_bf16 a[40:43], a[160:163], v[176:179], a[40:43]
ds_read_b128 a[188:191], v3 offset:13312
v_cvt_pk_bf16_f32 v188, v128, v129
v_mfma_f32_16x16x32_bf16 a[72:75], a[160:163], v[200:203], a[72:75]
ds_read_b128 a[192:195], v3 offset:6144
v_cvt_pk_bf16_f32 v189, v130, v131
v_mfma_f32_16x16x32_bf16 a[72:75], a[164:167], v[204:207], a[72:75]
ds_read_b128 a[196:199], v3 offset:14336
v_cvt_pk_bf16_f32 v196, v144, v145
v_mfma_f32_16x16x32_bf16 a[104:107], a[164:167], v[212:215], a[104:107]
ds_read_b128 a[200:203], v3 offset:7168
v_mfma_f32_16x16x32_bf16 a[104:107], a[160:163], v[208:211], a[104:107]
s_waitcnt lgkmcnt(5)
s_add_u32 m0, s86, 137216
ds_read_b128 a[204:207], v3 offset:15360
v_mfma_f32_16x16x32_bf16 a[108:111], a[168:171], v[208:211], a[108:111]
s_add_u32 s64, s85, 49152
v_exp_f32 v146, v146
v_mfma_f32_16x16x32_bf16 a[108:111], a[172:175], v[212:215], a[108:111]
buffer_load_dwordx4 v12, s[36:39], s64 offen lds
v_mfma_f32_16x16x32_bf16 a[76:79], a[172:175], v[204:207], a[76:79]
s_add_u32 m0, s86, 138240
v_exp_f32 v147, v147
v_mfma_f32_16x16x32_bf16 a[76:79], a[168:171], v[200:203], a[76:79]
s_add_u32 s64, s85, 57344
v_exp_f32 v148, v148
v_mfma_f32_16x16x32_bf16 a[44:47], a[168:171], v[176:179], a[44:47]
buffer_load_dwordx4 v13, s[36:39], s64 offen lds
v_mfma_f32_16x16x32_bf16 a[44:47], a[172:175], v[180:183], a[44:47]
s_waitcnt vmcnt(16)
s_barrier
v_mfma_f32_16x16x32_bf16 a[12:15], a[172:175], v[172:175], a[12:15]
s_xor_b32 s71, s71, 16384
v_exp_f32 v149, v149
v_mfma_f32_16x16x32_bf16 a[12:15], a[168:171], v[168:171], a[12:15]
s_add_u32 s70, s70, 32768
v_exp_f32 v150, v150
v_mfma_f32_16x16x32_bf16 a[16:19], a[176:179], v[168:171], a[16:19]
s_mov_b32 m0, s71
v_exp_f32 v151, v151
v_mfma_f32_16x16x32_bf16 a[16:19], a[180:183], v[172:175], a[16:19]
buffer_load_dwordx4 v16, s[32:35], s70 offen offset:0 sc1 lds
v_mfma_f32_16x16x32_bf16 a[48:51], a[180:183], v[180:183], a[48:51]
v_exp_f32 v132, v132
v_mfma_f32_16x16x32_bf16 a[48:51], a[176:179], v[176:179], a[48:51]
v_exp_f32 v133, v133
v_mfma_f32_16x16x32_bf16 a[80:83], a[176:179], v[200:203], a[80:83]
v_exp_f32 v134, v134
v_mfma_f32_16x16x32_bf16 a[80:83], a[180:183], v[204:207], a[80:83]
v_exp_f32 v135, v135
v_mfma_f32_16x16x32_bf16 a[112:115], a[180:183], v[212:215], a[112:115]
v_exp_f32 v116, v116
v_mfma_f32_16x16x32_bf16 a[112:115], a[176:179], v[208:211], a[112:115]
s_waitcnt lgkmcnt(0)
v_cvt_pk_bf16_f32 v197, v146, v147
v_cvt_pk_bf16_f32 v198, v148, v149
v_mfma_f32_16x16x32_bf16 a[116:119], a[184:187], v[208:211], a[116:119]
v_exp_f32 v117, v117
v_mfma_f32_16x16x32_bf16 a[116:119], a[188:191], v[212:215], a[116:119]
v_exp_f32 v118, v118
v_mfma_f32_16x16x32_bf16 a[84:87], a[188:191], v[204:207], a[84:87]
v_exp_f32 v119, v119
v_mfma_f32_16x16x32_bf16 a[84:87], a[184:187], v[200:203], a[84:87]
v_exp_f32 v100, v100
v_mfma_f32_16x16x32_bf16 a[52:55], a[184:187], v[176:179], a[52:55]
v_exp_f32 v101, v101
v_mfma_f32_16x16x32_bf16 a[52:55], a[188:191], v[180:183], a[52:55]
ds_read_b128 a[144:147], v2 offset:16384
v_cvt_pk_bf16_f32 v199, v150, v151
v_mfma_f32_16x16x32_bf16 a[20:23], a[188:191], v[172:175], a[20:23]
ds_read_b128 a[148:151], v2 offset:17408
v_cvt_pk_bf16_f32 v190, v132, v133
v_mfma_f32_16x16x32_bf16 a[20:23], a[184:187], v[168:171], a[20:23]
v_exp_f32 v102, v102
v_mfma_f32_16x16x32_bf16 a[24:27], a[192:195], v[168:171], a[24:27]
buffer_load_dwordx4 v16, s[32:35], s70 offen offset:1024 sc1 lds
v_mfma_f32_16x16x32_bf16 a[24:27], a[196:199], v[172:175], a[24:27]
ds_read_b128 a[152:155], v2 offset:18432
v_cvt_pk_bf16_f32 v191, v134, v135
v_mfma_f32_16x16x32_bf16 a[56:59], a[196:199], v[180:183], a[56:59]
ds_read_b128 a[156:159], v2 offset:19456
v_cvt_pk_bf16_f32 v166, v116, v117
v_mfma_f32_16x16x32_bf16 a[56:59], a[192:195], v[176:179], a[56:59]
v_exp_f32 v103, v103
v_mfma_f32_16x16x32_bf16 a[88:91], a[192:195], v[200:203], a[88:91]
ds_read_b128 a[160:163], v2 offset:20480
v_cvt_pk_bf16_f32 v167, v118, v119
v_mfma_f32_16x16x32_bf16 a[88:91], a[196:199], v[204:207], a[88:91]
ds_read_b128 a[164:167], v2 offset:21504
v_cvt_pk_bf16_f32 v158, v100, v101
v_mfma_f32_16x16x32_bf16 a[120:123], a[196:199], v[212:215], a[120:123]
ds_read_b128 a[168:171], v2 offset:22528
v_cvt_pk_bf16_f32 v159, v102, v103
v_mfma_f32_16x16x32_bf16 a[120:123], a[192:195], v[208:211], a[120:123]
ds_read_b128 a[172:175], v2 offset:23552
v_cndmask_b32 v104, v220, v17, s[0:1]
v_mfma_f32_16x16x32_bf16 a[124:127], a[200:203], v[208:211], a[124:127]
v_cndmask_b32 v105, v220, v17, s[4:5]
v_cndmask_b32 v106, v220, v17, s[6:7]
v_mfma_f32_16x16x32_bf16 a[124:127], a[204:207], v[212:215], a[124:127]
v_cndmask_b32 v107, v220, v17, s[8:9]
v_cndmask_b32 v108, v220, v17, s[10:11]
v_mfma_f32_16x16x32_bf16 a[92:95], a[204:207], v[204:207], a[92:95]
v_cndmask_b32 v109, v220, v17, s[12:13]
v_cndmask_b32 v110, v220, v17, s[18:19]
v_mfma_f32_16x16x32_bf16 a[92:95], a[200:203], v[200:203], a[92:95]
v_cndmask_b32 v111, v220, v17, s[22:23]
v_cndmask_b32 v112, v220, v17, s[26:27]
v_mfma_f32_16x16x32_bf16 a[60:63], a[200:203], v[176:179], a[60:63]
v_cndmask_b32 v113, v220, v17, s[56:57]
v_cndmask_b32 v114, v220, v17, s[58:59]
v_mfma_f32_16x16x32_bf16 a[60:63], a[204:207], v[180:183], a[60:63]
v_cndmask_b32 v115, v220, v17, s[60:61]
v_cndmask_b32 v116, v220, v17, s[62:63]
v_mfma_f32_16x16x32_bf16 a[28:31], a[204:207], v[172:175], a[28:31]
v_cndmask_b32 v117, v220, v17, s[48:49]
v_cndmask_b32 v118, v220, v17, s[50:51]
v_mfma_f32_16x16x32_bf16 a[28:31], a[200:203], v[168:171], a[28:31]
s_waitcnt lgkmcnt(0)
v_cndmask_b32 v119, v220, v17, s[100:101]
v_mfma_f32_16x16x32_bf16 v[120:123], a[144:147], v[56:59], v[224:227]
ds_read_b128 a[176:179], v2 offset:24576
v_mfma_f32_16x16x32_bf16 v[120:123], a[148:151], v[60:63], v[120:123]
ds_read_b128 a[180:183], v2 offset:25600
v_mfma_f32_16x16x32_bf16 v[120:123], a[152:155], v[64:67], v[120:123]
buffer_load_dwordx4 v16, s[32:35], s70 offen offset:2048 sc1 lds
v_mfma_f32_16x16x32_bf16 v[120:123], a[156:159], v[68:71], v[120:123]
ds_read_b128 a[184:187], v2 offset:26624
v_mfma_f32_16x16x32_bf16 v[136:139], a[156:159], v[84:87], v[228:231]
s_add_u32 s17, s78, L_T-L_pc
ds_read_b128 a[188:191], v2 offset:27648
v_mfma_f32_16x16x32_bf16 v[136:139], a[152:155], v[80:83], v[136:139]
buffer_load_dword a252, v16, s[88:91], s17 offen
v_mfma_f32_16x16x32_bf16 v[136:139], a[148:151], v[76:79], v[136:139]
v_mfma_f32_16x16x32_bf16 v[136:139], a[144:147], v[72:75], v[136:139]
v_mfma_f32_16x16x32_bf16 v[104:107], a[144:147], v[40:43], v[104:107]
s_add_u32 s17, s78, L_T-L_pc+4096
ds_read_b128 a[192:195], v2 offset:28672
v_mfma_f32_16x16x32_bf16 v[104:107], a[148:151], v[44:47], v[104:107]
buffer_load_dword a252, v16, s[88:91], s17 offen
v_mfma_f32_16x16x32_bf16 v[104:107], a[152:155], v[48:51], v[104:107]
v_exp_f32 v120, v120
v_mfma_f32_16x16x32_bf16 v[104:107], a[156:159], v[52:55], v[104:107]
v_exp_f32 v121, v121
v_mfma_f32_16x16x32_bf16 v[140:143], a[172:175], v[84:87], v[228:231]
v_exp_f32 v122, v122
v_mfma_f32_16x16x32_bf16 v[140:143], a[168:171], v[80:83], v[140:143]
v_exp_f32 v123, v123
v_mfma_f32_16x16x32_bf16 v[140:143], a[164:167], v[76:79], v[140:143]
v_exp_f32 v136, v136
v_mfma_f32_16x16x32_bf16 v[140:143], a[160:163], v[72:75], v[140:143]
buffer_load_dwordx4 v16, s[32:35], s70 offen offset:3072 sc1 lds
v_mfma_f32_16x16x32_bf16 v[124:127], a[160:163], v[56:59], v[224:227]
v_exp_f32 v137, v137
v_mfma_f32_16x16x32_bf16 v[124:127], a[164:167], v[60:63], v[124:127]
v_exp_f32 v138, v138
v_mfma_f32_16x16x32_bf16 v[124:127], a[168:171], v[64:67], v[124:127]
v_exp_f32 v139, v139
v_mfma_f32_16x16x32_bf16 v[124:127], a[172:175], v[68:71], v[124:127]
v_exp_f32 v104, v104
v_mfma_f32_16x16x32_bf16 v[108:111], a[172:175], v[52:55], v[108:111]
v_cvt_pk_bf16_f32 v200, v120, v121
v_cvt_pk_bf16_f32 v201, v122, v123
v_mfma_f32_16x16x32_bf16 v[108:111], a[168:171], v[48:51], v[108:111]
ds_read_b128 a[196:199], v2 offset:29696
v_cvt_pk_bf16_f32 v208, v136, v137
v_mfma_f32_16x16x32_bf16 v[108:111], a[164:167], v[44:47], v[108:111]
ds_read_b128 a[200:203], v2 offset:30720
v_cvt_pk_bf16_f32 v209, v138, v139
v_mfma_f32_16x16x32_bf16 v[108:111], a[160:163], v[40:43], v[108:111]
s_waitcnt lgkmcnt(2)
ds_read_b128 a[204:207], v2 offset:31744
v_mfma_f32_16x16x32_bf16 v[112:115], a[176:179], v[40:43], v[112:115]
v_exp_f32 v105, v105
v_mfma_f32_16x16x32_bf16 v[112:115], a[180:183], v[44:47], v[112:115]
v_exp_f32 v106, v106
v_mfma_f32_16x16x32_bf16 v[112:115], a[184:187], v[48:51], v[112:115]
v_exp_f32 v107, v107
v_mfma_f32_16x16x32_bf16 v[112:115], a[188:191], v[52:55], v[112:115]
s_add_u32 m0, s71, 4096
v_exp_f32 v140, v140
v_mfma_f32_16x16x32_bf16 v[128:131], a[188:191], v[68:71], v[224:227]
s_add_u32 s64, s70, 4096
v_exp_f32 v141, v141
v_mfma_f32_16x16x32_bf16 v[128:131], a[184:187], v[64:67], v[128:131]
buffer_load_dwordx4 v16, s[32:35], s64 offen offset:0 sc1 lds
v_mfma_f32_16x16x32_bf16 v[128:131], a[180:183], v[60:63], v[128:131]
v_exp_f32 v142, v142
v_mfma_f32_16x16x32_bf16 v[128:131], a[176:179], v[56:59], v[128:131]
v_exp_f32 v143, v143
v_mfma_f32_16x16x32_bf16 v[144:147], a[176:179], v[72:75], v[228:231]
ds_read_b128 a[144:147], v3 offset:16384
v_cvt_pk_bf16_f32 v176, v104, v105
v_mfma_f32_16x16x32_bf16 v[144:147], a[180:183], v[76:79], v[144:147]
ds_read_b128 a[148:151], v3 offset:24576
v_cvt_pk_bf16_f32 v177, v106, v107
v_mfma_f32_16x16x32_bf16 v[144:147], a[184:187], v[80:83], v[144:147]
v_exp_f32 v124, v124
v_mfma_f32_16x16x32_bf16 v[144:147], a[188:191], v[84:87], v[144:147]
s_waitcnt lgkmcnt(2)
v_exp_f32 v125, v125
v_mfma_f32_16x16x32_bf16 v[148:151], a[204:207], v[84:87], v[228:231]
v_exp_f32 v126, v126
v_mfma_f32_16x16x32_bf16 v[148:151], a[200:203], v[80:83], v[148:151]
v_exp_f32 v127, v127
v_mfma_f32_16x16x32_bf16 v[148:151], a[196:199], v[76:79], v[148:151]
ds_read_b128 a[152:155], v3 offset:17408
v_cvt_pk_bf16_f32 v210, v140, v141
v_mfma_f32_16x16x32_bf16 v[148:151], a[192:195], v[72:75], v[148:151]
ds_read_b128 a[156:159], v3 offset:25600
v_cvt_pk_bf16_f32 v211, v142, v143
v_mfma_f32_16x16x32_bf16 v[132:135], a[192:195], v[56:59], v[224:227]
v_exp_f32 v108, v108
v_mfma_f32_16x16x32_bf16 v[132:135], a[196:199], v[60:63], v[132:135]
v_exp_f32 v109, v109
v_mfma_f32_16x16x32_bf16 v[132:135], a[200:203], v[64:67], v[132:135]
buffer_load_dwordx4 v16, s[32:35], s64 offen offset:1024 sc1 lds
v_mfma_f32_16x16x32_bf16 v[132:135], a[204:207], v[68:71], v[132:135]
v_exp_f32 v110, v110
v_mfma_f32_16x16x32_bf16 v[116:119], a[204:207], v[52:55], v[116:119]
ds_read_b128 a[160:163], v3 offset:18432
v_cvt_pk_bf16_f32 v202, v124, v125
v_mfma_f32_16x16x32_bf16 v[116:119], a[200:203], v[48:51], v[116:119]
v_exp_f32 v111, v111
v_mfma_f32_16x16x32_bf16 v[116:119], a[196:199], v[44:47], v[116:119]
ds_read_b128 a[164:167], v3 offset:26624
v_cvt_pk_bf16_f32 v203, v126, v127
v_mfma_f32_16x16x32_bf16 v[116:119], a[192:195], v[40:43], v[116:119]
v_exp_f32 v112, v112
v_smfmac_f32_16x16x64_bf16 a[128:131], a[240:243], v[152:159], v5
ds_read_b128 a[168:171], v3 offset:19456
v_smfmac_f32_16x16x64_bf16 a[132:135], a[240:243], v[160:167], v5
ds_read_b128 a[172:175], v3 offset:27648
v_smfmac_f32_16x16x64_bf16 a[136:139], a[240:243], v[184:191], v5
ds_read_b128 a[176:179], v3 offset:20480
v_smfmac_f32_16x16x64_bf16 a[140:143], a[240:243], v[192:199], v5
s_waitcnt lgkmcnt(4)
ds_read_b128 a[180:183], v3 offset:28672
v_xor_b32 v2, 0x8000, v2
v_mfma_f32_16x16x32_bf16 a[0:3], a[144:147], v[152:155], a[0:3]
v_exp_f32 v113, v113
v_mfma_f32_16x16x32_bf16 a[0:3], a[148:151], v[156:159], a[0:3]
v_exp_f32 v114, v114
v_mfma_f32_16x16x32_bf16 a[32:35], a[148:151], v[164:167], a[32:35]
v_exp_f32 v115, v115
v_mfma_f32_16x16x32_bf16 a[32:35], a[144:147], v[160:163], a[32:35]
v_exp_f32 v128, v128
v_mfma_f32_16x16x32_bf16 a[64:67], a[144:147], v[184:187], a[64:67]
buffer_load_dwordx4 v16, s[32:35], s64 offen offset:2048 sc1 lds
v_mfma_f32_16x16x32_bf16 a[64:67], a[148:151], v[188:191], a[64:67]
v_exp_f32 v129, v129
v_mfma_f32_16x16x32_bf16 a[96:99], a[148:151], v[196:199], a[96:99]
v_exp_f32 v130, v130
v_mfma_f32_16x16x32_bf16 a[96:99], a[144:147], v[192:195], a[96:99]
v_exp_f32 v131, v131
v_mfma_f32_16x16x32_bf16 a[100:103], a[152:155], v[192:195], a[100:103]
v_exp_f32 v144, v144
v_mfma_f32_16x16x32_bf16 a[100:103], a[156:159], v[196:199], a[100:103]
v_exp_f32 v145, v145
v_mfma_f32_16x16x32_bf16 a[68:71], a[156:159], v[188:191], a[68:71]
ds_read_b128 a[184:187], v3 offset:21504
v_cvt_pk_bf16_f32 v178, v108, v109
v_mfma_f32_16x16x32_bf16 a[68:71], a[152:155], v[184:187], a[68:71]
ds_read_b128 a[188:191], v3 offset:29696
v_cvt_pk_bf16_f32 v179, v110, v111
v_mfma_f32_16x16x32_bf16 a[36:39], a[152:155], v[160:163], a[36:39]
ds_read_b128 a[192:195], v3 offset:22528
v_cvt_pk_bf16_f32 v180, v112, v113
v_mfma_f32_16x16x32_bf16 a[36:39], a[156:159], v[164:167], a[36:39]
v_exp_f32 v146, v146
v_mfma_f32_16x16x32_bf16 a[4:7], a[156:159], v[156:159], a[4:7]
v_exp_f32 v147, v147
v_mfma_f32_16x16x32_bf16 a[4:7], a[152:155], v[152:155], a[4:7]
v_exp_f32 v148, v148
v_mfma_f32_16x16x32_bf16 a[8:11], a[160:163], v[152:155], a[8:11]
s_waitcnt lgkmcnt(2)
ds_read_b128 a[196:199], v3 offset:30720
v_cvt_pk_bf16_f32 v181, v114, v115
v_mfma_f32_16x16x32_bf16 a[8:11], a[164:167], v[156:159], a[8:11]
buffer_load_dwordx4 v16, s[32:35], s64 offen offset:3072 sc1 lds
v_mfma_f32_16x16x32_bf16 a[40:43], a[164:167], v[164:167], a[40:43]
v_exp_f32 v149, v149
v_mfma_f32_16x16x32_bf16 a[40:43], a[160:163], v[160:163], a[40:43]
ds_read_b128 a[200:203], v3 offset:23552
v_cvt_pk_bf16_f32 v204, v128, v129
v_mfma_f32_16x16x32_bf16 a[72:75], a[160:163], v[184:187], a[72:75]
v_exp_f32 v150, v150
v_mfma_f32_16x16x32_bf16 a[72:75], a[164:167], v[188:191], a[72:75]
v_exp_f32 v151, v151
v_mfma_f32_16x16x32_bf16 a[104:107], a[164:167], v[196:199], a[104:107]
v_exp_f32 v132, v132
v_mfma_f32_16x16x32_bf16 a[104:107], a[160:163], v[192:195], a[104:107]
ds_read_b128 a[204:207], v3 offset:31744
v_cvt_pk_bf16_f32 v205, v130, v131
v_mfma_f32_16x16x32_bf16 a[108:111], a[168:171], v[192:195], a[108:111]
v_exp_f32 v133, v133
v_mfma_f32_16x16x32_bf16 a[108:111], a[172:175], v[196:199], a[108:111]
v_exp_f32 v134, v134
v_mfma_f32_16x16x32_bf16 a[76:79], a[172:175], v[188:191], a[76:79]
v_exp_f32 v135, v135
v_mfma_f32_16x16x32_bf16 a[76:79], a[168:171], v[184:187], a[76:79]
v_exp_f32 v116, v116
v_mfma_f32_16x16x32_bf16 a[44:47], a[168:171], v[160:163], a[44:47]
v_exp_f32 v117, v117
v_mfma_f32_16x16x32_bf16 a[44:47], a[172:175], v[164:167], a[44:47]
s_add_u32 s17, s78, L_T1-L_pc
v_exp_f32 v118, v118
v_mfma_f32_16x16x32_bf16 a[12:15], a[172:175], v[156:159], a[12:15]
buffer_load_dword a252, v16, s[88:91], s17 offen
v_mfma_f32_16x16x32_bf16 a[12:15], a[168:171], v[152:155], a[12:15]
v_exp_f32 v119, v119
v_mfma_f32_16x16x32_bf16 a[16:19], a[176:179], v[152:155], a[16:19]
v_cvt_pk_bf16_f32 v212, v144, v145
v_cvt_pk_bf16_f32 v213, v146, v147
v_mfma_f32_16x16x32_bf16 a[16:19], a[180:183], v[156:159], a[16:19]
s_waitcnt vmcnt(15)
s_barrier
v_mfma_f32_16x16x32_bf16 a[48:51], a[180:183], v[164:167], a[48:51]
s_xor_b32 s71, s71, 49152
ds_read_b128 a[144:147], v2 offset:0
v_cvt_pk_bf16_f32 v214, v148, v149
v_mfma_f32_16x16x32_bf16 a[48:51], a[176:179], v[160:163], a[48:51]
s_add_u32 s70, s70, 32768
ds_read_b128 a[148:151], v2 offset:1024
v_cvt_pk_bf16_f32 v215, v150, v151
v_mfma_f32_16x16x32_bf16 a[80:83], a[176:179], v[184:187], a[80:83]
s_mov_b32 m0, s71
ds_read_b128 a[152:155], v2 offset:2048
v_cvt_pk_bf16_f32 v206, v132, v133
v_mfma_f32_16x16x32_bf16 a[80:83], a[180:183], v[188:191], a[80:83]
buffer_load_dwordx4 v16, s[32:35], s70 offen offset:0 sc1 lds
v_mfma_f32_16x16x32_bf16 a[112:115], a[180:183], v[196:199], a[112:115]
s_add_u32 s17, s78, L_T1-L_pc+4096
ds_read_b128 a[156:159], v2 offset:3072
v_cvt_pk_bf16_f32 v207, v134, v135
v_mfma_f32_16x16x32_bf16 a[112:115], a[176:179], v[192:195], a[112:115]
buffer_load_dword a252, v16, s[88:91], s17 offen
v_mfma_f32_16x16x32_bf16 a[116:119], a[184:187], v[192:195], a[116:119]
s_waitcnt lgkmcnt(3)
ds_read_b128 a[160:163], v2 offset:4096
v_cvt_pk_bf16_f32 v182, v116, v117
v_mfma_f32_16x16x32_bf16 a[116:119], a[188:191], v[196:199], a[116:119]
ds_read_b128 a[164:167], v2 offset:5120
v_cvt_pk_bf16_f32 v183, v118, v119
v_mfma_f32_16x16x32_bf16 a[84:87], a[188:191], v[188:191], a[84:87]
ds_read_b128 a[168:171], v2 offset:6144
v_xor_b32 v3, 0x8000, v3
v_mfma_f32_16x16x32_bf16 a[84:87], a[184:187], v[184:187], a[84:87]
ds_read_b128 a[172:175], v2 offset:7168
v_accvgpr_read_b32 v20, a128
v_mfma_f32_16x16x32_bf16 a[52:55], a[184:187], v[160:163], a[52:55]
v_accvgpr_read_b32 v248, a129
v_add_f32 v20, v20, v248
v_mfma_f32_16x16x32_bf16 a[52:55], a[188:191], v[164:167], a[52:55]
v_max_f32 v1, v1, v20
v_mfma_f32_16x16x32_bf16 a[20:23], a[188:191], v[156:159], a[20:23]
v_rcp_f32 v20, v20
v_mfma_f32_16x16x32_bf16 a[20:23], a[184:187], v[152:155], a[20:23]
v_accvgpr_read_b32 v232, a0
v_accvgpr_read_b32 v233, a1
v_mfma_f32_16x16x32_bf16 a[24:27], a[192:195], v[152:155], a[24:27]
v_accvgpr_read_b32 v234, a2
v_accvgpr_read_b32 v235, a3
v_mfma_f32_16x16x32_bf16 a[24:27], a[196:199], v[156:159], a[24:27]
v_accvgpr_read_b32 v236, a4
v_accvgpr_read_b32 v237, a5
v_mfma_f32_16x16x32_bf16 a[56:59], a[196:199], v[164:167], a[56:59]
buffer_load_dwordx4 v16, s[32:35], s70 offen offset:1024 sc1 lds
v_mfma_f32_16x16x32_bf16 a[56:59], a[192:195], v[160:163], a[56:59]
v_accvgpr_read_b32 v238, a6
v_accvgpr_read_b32 v239, a7
v_mfma_f32_16x16x32_bf16 a[88:91], a[192:195], v[184:187], a[88:91]
v_mul_f32 v20, v20, v4
v_mul_f32 v232, v232, v20
v_mfma_f32_16x16x32_bf16 a[88:91], a[196:199], v[188:191], a[88:91]
v_mul_f32 v233, v233, v20
v_mul_f32 v234, v234, v20
v_mfma_f32_16x16x32_bf16 a[120:123], a[196:199], v[196:199], a[120:123]
v_mul_f32 v235, v235, v20
v_mul_f32 v236, v236, v20
v_mfma_f32_16x16x32_bf16 a[120:123], a[192:195], v[192:195], a[120:123]
v_mul_f32 v237, v237, v20
v_mul_f32 v238, v238, v20
v_mfma_f32_16x16x32_bf16 a[124:127], a[200:203], v[192:195], a[124:127]
v_mul_f32 v239, v239, v20
v_cvt_pk_bf16_f32 v232, v232, v233
v_mfma_f32_16x16x32_bf16 a[124:127], a[204:207], v[196:199], a[124:127]
v_cvt_pk_bf16_f32 v233, v234, v235
v_cvt_pk_bf16_f32 v234, v236, v237
v_mfma_f32_16x16x32_bf16 a[92:95], a[204:207], v[188:191], a[92:95]
v_cvt_pk_bf16_f32 v235, v238, v239
v_mfma_f32_16x16x32_bf16 a[92:95], a[200:203], v[184:187], a[92:95]
s_add_u32 s77, s74, 0
buffer_store_dwordx4 v[232:235], v16, s[44:47], s77 offen sc1
v_mfma_f32_16x16x32_bf16 a[60:63], a[200:203], v[160:163], a[60:63]
v_accvgpr_read_b32 v240, a8
v_accvgpr_read_b32 v241, a9
v_mfma_f32_16x16x32_bf16 a[60:63], a[204:207], v[164:167], a[60:63]
v_accvgpr_read_b32 v242, a10
v_accvgpr_read_b32 v243, a11
v_mfma_f32_16x16x32_bf16 a[28:31], a[204:207], v[156:159], a[28:31]
v_accvgpr_read_b32 v244, a12
v_accvgpr_read_b32 v245, a13
v_mfma_f32_16x16x32_bf16 a[28:31], a[200:203], v[152:155], a[28:31]
v_accvgpr_read_b32 v246, a14
v_accvgpr_read_b32 v247, a15
v_mul_f32 v240, v240, v20
v_mul_f32 v241, v241, v20
v_mul_f32 v242, v242, v20
v_mul_f32 v243, v243, v20
v_mul_f32 v244, v244, v20
v_mul_f32 v245, v245, v20
v_mul_f32 v246, v246, v20
v_mul_f32 v247, v247, v20
v_cvt_pk_bf16_f32 v240, v240, v241
v_cvt_pk_bf16_f32 v241, v242, v243
v_cvt_pk_bf16_f32 v242, v244, v245
v_cvt_pk_bf16_f32 v243, v246, v247
s_add_u32 s77, s74, 8192
buffer_store_dwordx4 v[240:243], v16, s[44:47], s77 offen sc1
v_accvgpr_read_b32 v232, a16
v_accvgpr_read_b32 v233, a17
v_accvgpr_read_b32 v234, a18
v_accvgpr_read_b32 v235, a19
v_accvgpr_read_b32 v236, a20
v_accvgpr_read_b32 v237, a21
v_accvgpr_read_b32 v238, a22
v_accvgpr_read_b32 v239, a23
v_mul_f32 v232, v232, v20
v_mul_f32 v233, v233, v20
v_mul_f32 v234, v234, v20
v_mul_f32 v235, v235, v20
v_mul_f32 v236, v236, v20
v_mul_f32 v237, v237, v20
v_mul_f32 v238, v238, v20
v_mul_f32 v239, v239, v20
v_cvt_pk_bf16_f32 v232, v232, v233
v_cvt_pk_bf16_f32 v233, v234, v235
v_cvt_pk_bf16_f32 v234, v236, v237
v_cvt_pk_bf16_f32 v235, v238, v239
s_add_u32 s77, s74, 16384
buffer_store_dwordx4 v[232:235], v16, s[44:47], s77 offen sc1
s_cmp_eq_u32 s3, 7
s_cbranch_scc1 L_T1
L_T:
s_waitcnt lgkmcnt(7)
v_mfma_f32_16x16x32_bf16 v[120:123], a[144:147], v[56:59], v[224:227]
s_waitcnt lgkmcnt(6)
ds_read_b128 a[176:179], v2 offset:8192
v_mfma_f32_16x16x32_bf16 v[120:123], a[148:151], v[60:63], v[120:123]
s_waitcnt lgkmcnt(6)
ds_read_b128 a[180:183], v2 offset:9216
v_mfma_f32_16x16x32_bf16 v[120:123], a[152:155], v[64:67], v[120:123]
s_waitcnt lgkmcnt(6)
buffer_load_dwordx4 v16, s[32:35], s70 offen offset:2048 sc1 lds
v_mfma_f32_16x16x32_bf16 v[120:123], a[156:159], v[68:71], v[120:123]
ds_read_b128 a[184:187], v2 offset:10240
v_mfma_f32_16x16x32_bf16 v[136:139], a[156:159], v[84:87], v[228:231]
ds_read_b128 a[188:191], v2 offset:11264
v_mfma_f32_16x16x32_bf16 v[136:139], a[152:155], v[80:83], v[136:139]
ds_read_b128 a[192:195], v2 offset:12288
v_mfma_f32_16x16x32_bf16 v[136:139], a[148:151], v[76:79], v[136:139]
ds_read_b128 a[196:199], v2 offset:13312
v_mfma_f32_16x16x32_bf16 v[136:139], a[144:147], v[72:75], v[136:139]
s_waitcnt lgkmcnt(4)
v_mfma_f32_16x16x32_bf16 v[140:143], a[160:163], v[72:75], v[228:231]
ds_read_b128 a[200:203], v2 offset:14336
v_accvgpr_read_b32 v240, a24
v_mfma_f32_16x16x32_bf16 v[140:143], a[164:167], v[76:79], v[140:143]
ds_read_b128 a[204:207], v2 offset:15360
v_accvgpr_read_b32 v241, a25
v_mfma_f32_16x16x32_bf16 v[140:143], a[168:171], v[80:83], v[140:143]
v_exp_f32 v120, v120
v_mfma_f32_16x16x32_bf16 v[140:143], a[172:175], v[84:87], v[140:143]
v_exp_f32 v121, v121
v_mfma_f32_16x16x32_bf16 v[124:127], a[172:175], v[68:71], v[224:227]
v_exp_f32 v122, v122
v_mfma_f32_16x16x32_bf16 v[124:127], a[168:171], v[64:67], v[124:127]
buffer_load_dwordx4 v16, s[32:35], s70 offen offset:3072 sc1 lds
v_mfma_f32_16x16x32_bf16 v[124:127], a[164:167], v[60:63], v[124:127]
v_exp_f32 v123, v123
v_mfma_f32_16x16x32_bf16 v[124:127], a[160:163], v[56:59], v[124:127]
v_exp_f32 v136, v136
v_mfma_f32_16x16x32_bf16 v[128:131], a[176:179], v[56:59], v[224:227]
v_exp_f32 v137, v137
v_mfma_f32_16x16x32_bf16 v[128:131], a[180:183], v[60:63], v[128:131]
s_waitcnt lgkmcnt(0)
v_exp_f32 v138, v138
v_mfma_f32_16x16x32_bf16 v[128:131], a[184:187], v[64:67], v[128:131]
v_exp_f32 v139, v139
v_mfma_f32_16x16x32_bf16 v[128:131], a[188:191], v[68:71], v[128:131]
s_add_u32 m0, s71, 4096
ds_read_b128 a[144:147], v3 offset:0
v_cvt_pk_bf16_f32 v184, v120, v121
v_mfma_f32_16x16x32_bf16 v[144:147], a[188:191], v[84:87], v[228:231]
s_add_u32 s64, s70, 4096
ds_read_b128 a[148:151], v3 offset:8192
v_cvt_pk_bf16_f32 v185, v122, v123
v_mfma_f32_16x16x32_bf16 v[144:147], a[184:187], v[80:83], v[144:147]
buffer_load_dwordx4 v16, s[32:35], s64 offen offset:0 sc1 lds
v_mfma_f32_16x16x32_bf16 v[144:147], a[180:183], v[76:79], v[144:147]
v_exp_f32 v140, v140
v_mfma_f32_16x16x32_bf16 v[144:147], a[176:179], v[72:75], v[144:147]
v_exp_f32 v141, v141
v_mfma_f32_16x16x32_bf16 v[148:151], a[192:195], v[72:75], v[228:231]
v_exp_f32 v142, v142
v_mfma_f32_16x16x32_bf16 v[148:151], a[196:199], v[76:79], v[148:151]
ds_read_b128 a[152:155], v3 offset:1024
v_cvt_pk_bf16_f32 v192, v136, v137
v_mfma_f32_16x16x32_bf16 v[148:151], a[200:203], v[80:83], v[148:151]
ds_read_b128 a[156:159], v3 offset:9216
v_cvt_pk_bf16_f32 v193, v138, v139
v_mfma_f32_16x16x32_bf16 v[148:151], a[204:207], v[84:87], v[148:151]
v_exp_f32 v143, v143
v_mfma_f32_16x16x32_bf16 v[132:135], a[204:207], v[68:71], v[224:227]
v_exp_f32 v124, v124
v_mfma_f32_16x16x32_bf16 v[132:135], a[200:203], v[64:67], v[132:135]
v_exp_f32 v125, v125
v_mfma_f32_16x16x32_bf16 v[132:135], a[196:199], v[60:63], v[132:135]
buffer_load_dwordx4 v16, s[32:35], s64 offen offset:1024 sc1 lds
v_mfma_f32_16x16x32_bf16 v[132:135], a[192:195], v[56:59], v[132:135]
ds_read_b128 a[160:163], v3 offset:2048
v_cvt_pk_bf16_f32 v194, v140, v141
v_smfmac_f32_16x16x64_bf16 a[132:135], a[240:243], v[176:183], v5
ds_read_b128 a[164:167], v3 offset:10240
v_smfmac_f32_16x16x64_bf16 a[136:139], a[240:243], v[200:207], v5
ds_read_b128 a[168:171], v3 offset:3072
v_accvgpr_read_b32 v242, a26
v_smfmac_f32_16x16x64_bf16 a[140:143], a[240:243], v[208:215], v5
s_waitcnt lgkmcnt(3)
ds_read_b128 a[172:175], v3 offset:11264
v_accvgpr_read_b32 v243, a27
v_mfma_f32_16x16x32_bf16 a[32:35], a[144:147], v[176:179], a[32:35]
ds_read_b128 a[176:179], v3 offset:4096
v_accvgpr_read_b32 v244, a28
v_mfma_f32_16x16x32_bf16 a[32:35], a[148:151], v[180:183], a[32:35]
ds_read_b128 a[180:183], v3 offset:12288
v_accvgpr_read_b32 v245, a29
v_mfma_f32_16x16x32_bf16 a[64:67], a[148:151], v[204:207], a[64:67]
ds_read_b128 a[184:187], v3 offset:5120
v_accvgpr_read_b32 v246, a30
v_mfma_f32_16x16x32_bf16 a[64:67], a[144:147], v[200:203], a[64:67]
ds_read_b128 a[188:191], v3 offset:13312
v_accvgpr_read_b32 v247, a31
v_mfma_f32_16x16x32_bf16 a[96:99], a[144:147], v[208:211], a[96:99]
ds_read_b128 a[192:195], v3 offset:6144
v_mul_f32 v240, v240, v20
v_mfma_f32_16x16x32_bf16 a[96:99], a[148:151], v[212:215], a[96:99]
ds_read_b128 a[196:199], v3 offset:14336
v_mul_f32 v241, v241, v20
v_mfma_f32_16x16x32_bf16 a[100:103], a[156:159], v[212:215], a[100:103]
ds_read_b128 a[200:203], v3 offset:7168
v_mul_f32 v242, v242, v20
v_mfma_f32_16x16x32_bf16 a[100:103], a[152:155], v[208:211], a[100:103]
ds_read_b128 a[204:207], v3 offset:15360
v_mul_f32 v243, v243, v20
v_mul_f32 v244, v244, v20
v_mul_f32 v245, v245, v20
v_mul_f32 v246, v246, v20
v_mul_f32 v247, v247, v20
v_cvt_pk_bf16_f32 v240, v240, v241
v_cvt_pk_bf16_f32 v241, v242, v243
v_cvt_pk_bf16_f32 v242, v244, v245
v_cvt_pk_bf16_f32 v243, v246, v247
s_add_u32 s77, s74, 24576
buffer_store_dwordx4 v[240:243], v16, s[44:47], s77 offen sc1
v_exp_f32 v126, v126
v_mfma_f32_16x16x32_bf16 a[68:71], a[152:155], v[200:203], a[68:71]
buffer_load_dwordx4 v16, s[32:35], s64 offen offset:2048 sc1 lds
v_cvt_pk_bf16_f32 v195, v142, v143
v_mfma_f32_16x16x32_bf16 a[68:71], a[156:159], v[204:207], a[68:71]
v_exp_f32 v127, v127
v_mfma_f32_16x16x32_bf16 a[36:39], a[156:159], v[180:183], a[36:39]
v_exp_f32 v128, v128
v_mfma_f32_16x16x32_bf16 a[36:39], a[152:155], v[176:179], a[36:39]
s_waitcnt lgkmcnt(2)
v_exp_f32 v129, v129
v_mfma_f32_16x16x32_bf16 a[40:43], a[160:163], v[176:179], a[40:43]
v_cvt_pk_bf16_f32 v186, v124, v125
v_cvt_pk_bf16_f32 v187, v126, v127
v_mfma_f32_16x16x32_bf16 a[40:43], a[164:167], v[180:183], a[40:43]
v_exp_f32 v130, v130
v_mfma_f32_16x16x32_bf16 a[72:75], a[164:167], v[204:207], a[72:75]
buffer_load_dwordx4 v16, s[32:35], s64 offen offset:3072 sc1 lds
v_mfma_f32_16x16x32_bf16 a[72:75], a[160:163], v[200:203], a[72:75]
v_exp_f32 v131, v131
v_mfma_f32_16x16x32_bf16 a[104:107], a[160:163], v[208:211], a[104:107]
v_exp_f32 v144, v144
v_mfma_f32_16x16x32_bf16 a[104:107], a[164:167], v[212:215], a[104:107]
v_exp_f32 v145, v145
v_mfma_f32_16x16x32_bf16 a[108:111], a[172:175], v[212:215], a[108:111]
v_exp_f32 v146, v146
v_mfma_f32_16x16x32_bf16 a[108:111], a[168:171], v[208:211], a[108:111]
v_exp_f32 v147, v147
v_mfma_f32_16x16x32_bf16 a[76:79], a[168:171], v[200:203], a[76:79]
v_exp_f32 v148, v148
v_mfma_f32_16x16x32_bf16 a[76:79], a[172:175], v[204:207], a[76:79]
v_exp_f32 v149, v149
v_mfma_f32_16x16x32_bf16 a[44:47], a[172:175], v[180:183], a[44:47]
v_cvt_pk_bf16_f32 v188, v128, v129
v_cvt_pk_bf16_f32 v189, v130, v131
v_mfma_f32_16x16x32_bf16 a[44:47], a[168:171], v[176:179], a[44:47]
v_exp_f32 v150, v150
v_mfma_f32_16x16x32_bf16 a[48:51], a[176:179], v[176:179], a[48:51]
v_exp_f32 v151, v151
v_mfma_f32_16x16x32_bf16 a[48:51], a[180:183], v[180:183], a[48:51]
v_exp_f32 v132, v132
v_mfma_f32_16x16x32_bf16 a[80:83], a[180:183], v[204:207], a[80:83]
s_waitcnt vmcnt(9)
s_barrier
v_mfma_f32_16x16x32_bf16 a[80:83], a[176:179], v[200:203], a[80:83]
s_xor_b32 s71, s71, 16384
v_exp_f32 v133, v133
v_mfma_f32_16x16x32_bf16 a[112:115], a[176:179], v[208:211], a[112:115]
s_add_u32 s70, s70, 32768
ds_read_b128 a[144:147], v2 offset:16384
v_cvt_pk_bf16_f32 v196, v144, v145
v_mfma_f32_16x16x32_bf16 a[112:115], a[180:183], v[212:215], a[112:115]
s_mov_b32 m0, s71
v_exp_f32 v134, v134
v_mfma_f32_16x16x32_bf16 a[116:119], a[188:191], v[212:215], a[116:119]
buffer_load_dwordx4 v16, s[32:35], s70 offen offset:0 sc1 lds
v_mfma_f32_16x16x32_bf16 a[116:119], a[184:187], v[208:211], a[116:119]
ds_read_b128 a[148:151], v2 offset:17408
v_cvt_pk_bf16_f32 v197, v146, v147
v_mfma_f32_16x16x32_bf16 a[84:87], a[184:187], v[200:203], a[84:87]
ds_read_b128 a[152:155], v2 offset:18432
v_cvt_pk_bf16_f32 v198, v148, v149
v_mfma_f32_16x16x32_bf16 a[84:87], a[188:191], v[204:207], a[84:87]
ds_read_b128 a[156:159], v2 offset:19456
v_cvt_pk_bf16_f32 v199, v150, v151
v_mfma_f32_16x16x32_bf16 a[52:55], a[188:191], v[180:183], a[52:55]
v_exp_f32 v135, v135
v_mfma_f32_16x16x32_bf16 a[52:55], a[184:187], v[176:179], a[52:55]
ds_read_b128 a[160:163], v2 offset:20480
v_cvt_pk_bf16_f32 v190, v132, v133
v_mfma_f32_16x16x32_bf16 a[56:59], a[192:195], v[176:179], a[56:59]
ds_read_b128 a[164:167], v2 offset:21504
v_cvt_pk_bf16_f32 v191, v134, v135
v_mfma_f32_16x16x32_bf16 a[56:59], a[196:199], v[180:183], a[56:59]
ds_read_b128 a[168:171], v2 offset:22528
v_accvgpr_read_b32 v21, a132
v_mfma_f32_16x16x32_bf16 a[88:91], a[196:199], v[204:207], a[88:91]
ds_read_b128 a[172:175], v2 offset:23552
v_accvgpr_read_b32 v248, a133
v_mfma_f32_16x16x32_bf16 a[88:91], a[192:195], v[200:203], a[88:91]
buffer_load_dwordx4 v16, s[32:35], s70 offen offset:1024 sc1 lds
v_mfma_f32_16x16x32_bf16 a[120:123], a[192:195], v[208:211], a[120:123]
v_add_f32 v21, v21, v248
v_max_f32 v1, v1, v21
v_mfma_f32_16x16x32_bf16 a[120:123], a[196:199], v[212:215], a[120:123]
s_waitcnt lgkmcnt(3)
v_rcp_f32 v21, v21
v_mfma_f32_16x16x32_bf16 a[124:127], a[204:207], v[212:215], a[124:127]
v_accvgpr_read_b32 v232, a32
v_accvgpr_read_b32 v233, a33
v_mfma_f32_16x16x32_bf16 a[124:127], a[200:203], v[208:211], a[124:127]
v_accvgpr_read_b32 v234, a34
v_accvgpr_read_b32 v235, a35
v_mfma_f32_16x16x32_bf16 a[92:95], a[200:203], v[200:203], a[92:95]
v_accvgpr_read_b32 v236, a36
v_accvgpr_read_b32 v237, a37
v_mfma_f32_16x16x32_bf16 a[92:95], a[204:207], v[204:207], a[92:95]
v_accvgpr_read_b32 v238, a38
v_accvgpr_read_b32 v239, a39
v_mfma_f32_16x16x32_bf16 a[60:63], a[204:207], v[180:183], a[60:63]
v_mul_f32 v21, v21, v6
v_mul_f32 v232, v232, v21
v_mfma_f32_16x16x32_bf16 a[60:63], a[200:203], v[176:179], a[60:63]
v_mul_f32 v233, v233, v21
v_mul_f32 v234, v234, v21
v_mfma_f32_16x16x32_bf16 v[120:123], a[144:147], v[56:59], v[224:227]
ds_read_b128 a[176:179], v2 offset:24576
ds_read_b128 a[180:183], v2 offset:25600
v_mfma_f32_16x16x32_bf16 v[120:123], a[148:151], v[60:63], v[120:123]
buffer_load_dwordx4 v16, s[32:35], s70 offen offset:2048 sc1 lds
v_mfma_f32_16x16x32_bf16 v[120:123], a[152:155], v[64:67], v[120:123]
s_add_u32 s64, s70, 4096
ds_read_b128 a[184:187], v2 offset:26624
ds_read_b128 a[188:191], v2 offset:27648
v_mfma_f32_16x16x32_bf16 v[120:123], a[156:159], v[68:71], v[120:123]
buffer_load_dwordx4 v16, s[32:35], s70 offen offset:3072 sc1 lds
v_mfma_f32_16x16x32_bf16 v[136:139], a[156:159], v[84:87], v[228:231]
s_add_u32 m0, s71, 4096
ds_read_b128 a[192:195], v2 offset:28672
ds_read_b128 a[196:199], v2 offset:29696
v_mfma_f32_16x16x32_bf16 v[136:139], a[152:155], v[80:83], v[136:139]
buffer_load_dwordx4 v16, s[32:35], s64 offen offset:0 sc1 lds
v_mfma_f32_16x16x32_bf16 v[136:139], a[148:151], v[76:79], v[136:139]
ds_read_b128 a[200:203], v2 offset:30720
ds_read_b128 a[204:207], v2 offset:31744
v_mfma_f32_16x16x32_bf16 v[136:139], a[144:147], v[72:75], v[136:139]
v_exp_f32 v120, v120
v_mfma_f32_16x16x32_bf16 v[140:143], a[160:163], v[72:75], v[228:231]
s_waitcnt lgkmcnt(4)
v_exp_f32 v121, v121
v_mfma_f32_16x16x32_bf16 v[140:143], a[164:167], v[76:79], v[140:143]
v_exp_f32 v122, v122
v_mfma_f32_16x16x32_bf16 v[140:143], a[168:171], v[80:83], v[140:143]
v_mul_f32 v235, v235, v21
v_mul_f32 v236, v236, v21
v_mul_f32 v237, v237, v21
v_mul_f32 v238, v238, v21
v_mul_f32 v239, v239, v21
v_cvt_pk_bf16_f32 v232, v232, v233
v_cvt_pk_bf16_f32 v233, v234, v235
v_cvt_pk_bf16_f32 v234, v236, v237
v_cvt_pk_bf16_f32 v235, v238, v239
s_add_u32 s77, s74, 4096
buffer_store_dwordx4 v[232:235], v16, s[44:47], s77 offen sc1
v_accvgpr_read_b32 v240, a40
v_accvgpr_read_b32 v241, a41
v_accvgpr_read_b32 v242, a42
v_accvgpr_read_b32 v243, a43
v_accvgpr_read_b32 v244, a44
v_accvgpr_read_b32 v245, a45
v_accvgpr_read_b32 v246, a46
v_accvgpr_read_b32 v247, a47
v_mul_f32 v240, v240, v21
v_mul_f32 v241, v241, v21
v_mul_f32 v242, v242, v21
v_mul_f32 v243, v243, v21
v_mul_f32 v244, v244, v21
v_mul_f32 v245, v245, v21
v_mul_f32 v246, v246, v21
v_mul_f32 v247, v247, v21
v_cvt_pk_bf16_f32 v240, v240, v241
v_cvt_pk_bf16_f32 v241, v242, v243
v_cvt_pk_bf16_f32 v242, v244, v245
v_cvt_pk_bf16_f32 v243, v246, v247
s_add_u32 s77, s74, 12288
buffer_store_dwordx4 v[240:243], v16, s[44:47], s77 offen sc1
v_accvgpr_read_b32 v232, a48
v_accvgpr_read_b32 v233, a49
v_accvgpr_read_b32 v234, a50
v_accvgpr_read_b32 v235, a51
v_accvgpr_read_b32 v236, a52
v_accvgpr_read_b32 v237, a53
v_accvgpr_read_b32 v238, a54
v_accvgpr_read_b32 v239, a55
v_mul_f32 v232, v232, v21
v_mul_f32 v233, v233, v21
v_mul_f32 v234, v234, v21
v_mul_f32 v235, v235, v21
v_mul_f32 v236, v236, v21
v_mul_f32 v237, v237, v21
v_mul_f32 v238, v238, v21
v_mul_f32 v239, v239, v21
v_cvt_pk_bf16_f32 v232, v232, v233
v_cvt_pk_bf16_f32 v233, v234, v235
v_cvt_pk_bf16_f32 v234, v236, v237
v_cvt_pk_bf16_f32 v235, v238, v239
s_add_u32 s77, s74, 20480
buffer_store_dwordx4 v[232:235], v16, s[44:47], s77 offen sc1
v_accvgpr_read_b32 v240, a56
v_accvgpr_read_b32 v241, a57
v_accvgpr_read_b32 v242, a58
v_accvgpr_read_b32 v243, a59
v_accvgpr_read_b32 v244, a60
v_accvgpr_read_b32 v245, a61
v_accvgpr_read_b32 v246, a62
v_accvgpr_read_b32 v247, a63
v_mul_f32 v240, v240, v21
v_mul_f32 v241, v241, v21
v_mul_f32 v242, v242, v21
v_mul_f32 v243, v243, v21
v_mul_f32 v244, v244, v21
v_mul_f32 v245, v245, v21
v_mul_f32 v246, v246, v21
v_mul_f32 v247, v247, v21
v_cvt_pk_bf16_f32 v240, v240, v241
v_cvt_pk_bf16_f32 v241, v242, v243
v_cvt_pk_bf16_f32 v242, v244, v245
v_cvt_pk_bf16_f32 v243, v246, v247
s_add_u32 s77, s74, 28672
buffer_store_dwordx4 v[240:243], v16, s[44:47], s77 offen sc1
v_exp_f32 v123, v123
v_mfma_f32_16x16x32_bf16 v[140:143], a[172:175], v[84:87], v[140:143]
v_exp_f32 v136, v136
v_mfma_f32_16x16x32_bf16 v[124:127], a[172:175], v[68:71], v[224:227]
ds_read_b128 a[144:147], v3 offset:16384
v_cvt_pk_bf16_f32 v200, v120, v121
v_mfma_f32_16x16x32_bf16 v[124:127], a[168:171], v[64:67], v[124:127]
v_exp_f32 v137, v137
v_mfma_f32_16x16x32_bf16 v[124:127], a[164:167], v[60:63], v[124:127]
ds_read_b128 a[148:151], v3 offset:24576
v_cvt_pk_bf16_f32 v201, v122, v123
v_mfma_f32_16x16x32_bf16 v[124:127], a[160:163], v[56:59], v[124:127]
v_exp_f32 v138, v138
v_mfma_f32_16x16x32_bf16 v[128:131], a[176:179], v[56:59], v[224:227]
ds_read_b128 a[152:155], v3 offset:17408
v_cvt_pk_bf16_f32 v208, v136, v137
v_mfma_f32_16x16x32_bf16 v[128:131], a[180:183], v[60:63], v[128:131]
v_exp_f32 v139, v139
v_mfma_f32_16x16x32_bf16 v[128:131], a[184:187], v[64:67], v[128:131]
ds_read_b128 a[156:159], v3 offset:25600
v_cvt_pk_bf16_f32 v209, v138, v139
v_mfma_f32_16x16x32_bf16 v[128:131], a[188:191], v[68:71], v[128:131]
v_exp_f32 v140, v140
v_mfma_f32_16x16x32_bf16 v[144:147], a[188:191], v[84:87], v[228:231]
buffer_load_dwordx4 v16, s[32:35], s64 offen offset:1024 sc1 lds
v_mfma_f32_16x16x32_bf16 v[144:147], a[184:187], v[80:83], v[144:147]
v_exp_f32 v141, v141
v_mfma_f32_16x16x32_bf16 v[144:147], a[180:183], v[76:79], v[144:147]
ds_read_b128 a[160:163], v3 offset:18432
v_cvt_pk_bf16_f32 v210, v140, v141
v_mfma_f32_16x16x32_bf16 v[144:147], a[176:179], v[72:75], v[144:147]
s_waitcnt lgkmcnt(2)
v_exp_f32 v142, v142
v_mfma_f32_16x16x32_bf16 v[148:151], a[192:195], v[72:75], v[228:231]
ds_read_b128 a[164:167], v3 offset:26624
ds_read_b128 a[168:171], v3 offset:19456
v_mfma_f32_16x16x32_bf16 v[148:151], a[196:199], v[76:79], v[148:151]
v_exp_f32 v143, v143
v_mfma_f32_16x16x32_bf16 v[148:151], a[200:203], v[80:83], v[148:151]
ds_read_b128 a[172:175], v3 offset:27648
v_cvt_pk_bf16_f32 v211, v142, v143
v_mfma_f32_16x16x32_bf16 v[148:151], a[204:207], v[84:87], v[148:151]
v_exp_f32 v124, v124
v_mfma_f32_16x16x32_bf16 v[132:135], a[204:207], v[68:71], v[224:227]
ds_read_b128 a[176:179], v3 offset:20480
buffer_load_dwordx4 v16, s[32:35], s64 offen offset:2048 sc1 lds
v_mfma_f32_16x16x32_bf16 v[132:135], a[200:203], v[64:67], v[132:135]
v_exp_f32 v125, v125
v_mfma_f32_16x16x32_bf16 v[132:135], a[196:199], v[60:63], v[132:135]
ds_read_b128 a[180:183], v3 offset:28672
v_cvt_pk_bf16_f32 v202, v124, v125
v_mfma_f32_16x16x32_bf16 v[132:135], a[192:195], v[56:59], v[132:135]
v_exp_f32 v126, v126
v_smfmac_f32_16x16x64_bf16 a[136:139], a[240:243], v[184:191], v5
ds_read_b128 a[184:187], v3 offset:21504
v_smfmac_f32_16x16x64_bf16 a[140:143], a[240:243], v[192:199], v5
ds_read_b128 a[188:191], v3 offset:29696
v_mfma_f32_16x16x32_bf16 a[64:67], a[144:147], v[184:187], a[64:67]
v_exp_f32 v127, v127
v_mfma_f32_16x16x32_bf16 a[64:67], a[148:151], v[188:191], a[64:67]
v_exp_f32 v128, v128
v_mfma_f32_16x16x32_bf16 a[96:99], a[148:151], v[196:199], a[96:99]
v_exp_f32 v129, v129
v_mfma_f32_16x16x32_bf16 a[96:99], a[144:147], v[192:195], a[96:99]
ds_read_b128 a[192:195], v3 offset:22528
v_cvt_pk_bf16_f32 v203, v126, v127
v_mfma_f32_16x16x32_bf16 a[100:103], a[152:155], v[192:195], a[100:103]
s_waitcnt lgkmcnt(2)
v_exp_f32 v130, v130
v_mfma_f32_16x16x32_bf16 a[100:103], a[156:159], v[196:199], a[100:103]
ds_read_b128 a[196:199], v3 offset:30720
v_cvt_pk_bf16_f32 v204, v128, v129
v_mfma_f32_16x16x32_bf16 a[68:71], a[156:159], v[188:191], a[68:71]
v_exp_f32 v131, v131
v_mfma_f32_16x16x32_bf16 a[68:71], a[152:155], v[184:187], a[68:71]
ds_read_b128 a[200:203], v3 offset:23552
v_cvt_pk_bf16_f32 v205, v130, v131
v_mfma_f32_16x16x32_bf16 a[72:75], a[160:163], v[184:187], a[72:75]
v_exp_f32 v144, v144
v_mfma_f32_16x16x32_bf16 a[72:75], a[164:167], v[188:191], a[72:75]
buffer_load_dwordx4 v16, s[32:35], s64 offen offset:3072 sc1 lds
v_mfma_f32_16x16x32_bf16 a[104:107], a[164:167], v[196:199], a[104:107]
s_xor_b32 s71, s71, 49152
v_exp_f32 v145, v145
v_mfma_f32_16x16x32_bf16 a[104:107], a[160:163], v[192:195], a[104:107]
ds_read_b128 a[204:207], v3 offset:31744
v_cvt_pk_bf16_f32 v212, v144, v145
v_mfma_f32_16x16x32_bf16 a[108:111], a[168:171], v[192:195], a[108:111]
s_add_u32 s70, s70, 32768
v_xor_b32 v2, 0x8000, v2
v_exp_f32 v146, v146
v_mfma_f32_16x16x32_bf16 a[108:111], a[172:175], v[196:199], a[108:111]
s_waitcnt vmcnt(12)
s_barrier
v_mfma_f32_16x16x32_bf16 a[76:79], a[172:175], v[188:191], a[76:79]
s_mov_b32 m0, s71
v_exp_f32 v147, v147
v_mfma_f32_16x16x32_bf16 a[76:79], a[168:171], v[184:187], a[76:79]
ds_read_b128 a[144:147], v2 offset:0
v_cvt_pk_bf16_f32 v213, v146, v147
v_mfma_f32_16x16x32_bf16 a[80:83], a[176:179], v[184:187], a[80:83]
v_exp_f32 v148, v148
v_mfma_f32_16x16x32_bf16 a[80:83], a[180:183], v[188:191], a[80:83]
ds_read_b128 a[148:151], v2 offset:1024
ds_read_b128 a[152:155], v2 offset:2048
v_mfma_f32_16x16x32_bf16 a[112:115], a[180:183], v[196:199], a[112:115]
v_exp_f32 v149, v149
v_mfma_f32_16x16x32_bf16 a[112:115], a[176:179], v[192:195], a[112:115]
ds_read_b128 a[156:159], v2 offset:3072
v_cvt_pk_bf16_f32 v214, v148, v149
v_mfma_f32_16x16x32_bf16 a[116:119], a[184:187], v[192:195], a[116:119]
s_waitcnt lgkmcnt(4)
v_exp_f32 v150, v150
v_mfma_f32_16x16x32_bf16 a[116:119], a[188:191], v[196:199], a[116:119]
buffer_load_dwordx4 v16, s[32:35], s70 offen offset:0 sc1 lds
v_mfma_f32_16x16x32_bf16 a[84:87], a[188:191], v[188:191], a[84:87]
v_exp_f32 v151, v151
v_mfma_f32_16x16x32_bf16 a[84:87], a[184:187], v[184:187], a[84:87]
ds_read_b128 a[160:163], v2 offset:4096
v_cvt_pk_bf16_f32 v215, v150, v151
v_mfma_f32_16x16x32_bf16 a[88:91], a[192:195], v[184:187], a[88:91]
v_exp_f32 v132, v132
v_mfma_f32_16x16x32_bf16 a[88:91], a[196:199], v[188:191], a[88:91]
ds_read_b128 a[164:167], v2 offset:5120
v_xor_b32 v3, 0x8000, v3
v_mfma_f32_16x16x32_bf16 a[120:123], a[196:199], v[196:199], a[120:123]
v_exp_f32 v133, v133
v_mfma_f32_16x16x32_bf16 a[120:123], a[192:195], v[192:195], a[120:123]
ds_read_b128 a[168:171], v2 offset:6144
v_cvt_pk_bf16_f32 v206, v132, v133
v_mfma_f32_16x16x32_bf16 a[124:127], a[200:203], v[192:195], a[124:127]
v_exp_f32 v134, v134
v_mfma_f32_16x16x32_bf16 a[124:127], a[204:207], v[196:199], a[124:127]
buffer_load_dwordx4 v16, s[32:35], s70 offen offset:1024 sc1 lds
v_mfma_f32_16x16x32_bf16 a[92:95], a[204:207], v[188:191], a[92:95]
v_exp_f32 v135, v135
v_mfma_f32_16x16x32_bf16 a[92:95], a[200:203], v[184:187], a[92:95]
ds_read_b128 a[172:175], v2 offset:7168
v_cvt_pk_bf16_f32 v207, v134, v135
s_lshl_b32 s72, s3, 1
s_sub_u32 s72, 13, s72
.p2align 3
L_S:
s_waitcnt lgkmcnt(7)
v_mfma_f32_16x16x32_bf16 v[120:123], a[144:147], v[56:59], v[224:227]
s_waitcnt lgkmcnt(6)
ds_read_b128 a[176:179], v2 offset:8192
ds_read_b128 a[180:183], v2 offset:9216
v_mfma_f32_16x16x32_bf16 v[120:123], a[148:151], v[60:63], v[120:123]
s_waitcnt lgkmcnt(7)
buffer_load_dwordx4 v16, s[32:35], s70 offen offset:2048 sc1 lds
v_mfma_f32_16x16x32_bf16 v[120:123], a[152:155], v[64:67], v[120:123]
s_waitcnt lgkmcnt(6)
s_add_u32 s64, s70, 4096
ds_read_b128 a[184:187], v2 offset:10240
ds_read_b128 a[188:191], v2 offset:11264
v_mfma_f32_16x16x32_bf16 v[120:123], a[156:159], v[68:71], v[120:123]
buffer_load_dwordx4 v16, s[32:35], s70 offen offset:3072 sc1 lds
v_mfma_f32_16x16x32_bf16 v[136:139], a[156:159], v[84:87], v[228:231]
s_add_u32 m0, s71, 4096
ds_read_b128 a[192:195], v2 offset:12288
ds_read_b128 a[196:199], v2 offset:13312
v_mfma_f32_16x16x32_bf16 v[136:139], a[152:155], v[80:83], v[136:139]
buffer_load_dwordx4 v16, s[32:35], s64 offen offset:0 sc1 lds
v_mfma_f32_16x16x32_bf16 v[136:139], a[148:151], v[76:79], v[136:139]
ds_read_b128 a[200:203], v2 offset:14336
ds_read_b128 a[204:207], v2 offset:15360
v_mfma_f32_16x16x32_bf16 v[136:139], a[144:147], v[72:75], v[136:139]
s_waitcnt lgkmcnt(6)
v_exp_f32 v120, v120
v_mfma_f32_16x16x32_bf16 v[140:143], a[160:163], v[72:75], v[228:231]
v_exp_f32 v121, v121
v_mfma_f32_16x16x32_bf16 v[140:143], a[164:167], v[76:79], v[140:143]
v_exp_f32 v122, v122
v_mfma_f32_16x16x32_bf16 v[140:143], a[168:171], v[80:83], v[140:143]
v_exp_f32 v123, v123
v_mfma_f32_16x16x32_bf16 v[140:143], a[172:175], v[84:87], v[140:143]
v_exp_f32 v136, v136
v_mfma_f32_16x16x32_bf16 v[124:127], a[172:175], v[68:71], v[224:227]
ds_read_b128 a[144:147], v3 offset:0
v_cvt_pk_bf16_f32 v184, v120, v121
v_mfma_f32_16x16x32_bf16 v[124:127], a[168:171], v[64:67], v[124:127]
v_exp_f32 v137, v137
v_mfma_f32_16x16x32_bf16 v[124:127], a[164:167], v[60:63], v[124:127]
ds_read_b128 a[148:151], v3 offset:8192
v_cvt_pk_bf16_f32 v185, v122, v123
v_mfma_f32_16x16x32_bf16 v[124:127], a[160:163], v[56:59], v[124:127]
v_exp_f32 v138, v138
v_mfma_f32_16x16x32_bf16 v[128:131], a[176:179], v[56:59], v[224:227]
ds_read_b128 a[152:155], v3 offset:1024
v_cvt_pk_bf16_f32 v192, v136, v137
v_mfma_f32_16x16x32_bf16 v[128:131], a[180:183], v[60:63], v[128:131]
s_waitcnt lgkmcnt(3)
v_exp_f32 v139, v139
v_mfma_f32_16x16x32_bf16 v[128:131], a[184:187], v[64:67], v[128:131]
ds_read_b128 a[156:159], v3 offset:9216
v_cvt_pk_bf16_f32 v193, v138, v139
v_mfma_f32_16x16x32_bf16 v[128:131], a[188:191], v[68:71], v[128:131]
v_exp_f32 v140, v140
v_mfma_f32_16x16x32_bf16 v[144:147], a[188:191], v[84:87], v[228:231]
buffer_load_dwordx4 v16, s[32:35], s64 offen offset:1024 sc1 lds
v_mfma_f32_16x16x32_bf16 v[144:147], a[184:187], v[80:83], v[144:147]
v_exp_f32 v141, v141
v_mfma_f32_16x16x32_bf16 v[144:147], a[180:183], v[76:79], v[144:147]
ds_read_b128 a[160:163], v3 offset:2048
v_cvt_pk_bf16_f32 v194, v140, v141
v_mfma_f32_16x16x32_bf16 v[144:147], a[176:179], v[72:75], v[144:147]
v_exp_f32 v142, v142
v_mfma_f32_16x16x32_bf16 v[148:151], a[192:195], v[72:75], v[228:231]
ds_read_b128 a[164:167], v3 offset:10240
ds_read_b128 a[168:171], v3 offset:3072
v_mfma_f32_16x16x32_bf16 v[148:151], a[196:199], v[76:79], v[148:151]
v_exp_f32 v143, v143
v_mfma_f32_16x16x32_bf16 v[148:151], a[200:203], v[80:83], v[148:151]
ds_read_b128 a[172:175], v3 offset:11264
v_cvt_pk_bf16_f32 v195, v142, v143
v_mfma_f32_16x16x32_bf16 v[148:151], a[204:207], v[84:87], v[148:151]
v_exp_f32 v124, v124
v_mfma_f32_16x16x32_bf16 v[132:135], a[204:207], v[68:71], v[224:227]
ds_read_b128 a[176:179], v3 offset:4096
buffer_load_dwordx4 v16, s[32:35], s64 offen offset:2048 sc1 lds
v_mfma_f32_16x16x32_bf16 v[132:135], a[200:203], v[64:67], v[132:135]
v_exp_f32 v125, v125
v_mfma_f32_16x16x32_bf16 v[132:135], a[196:199], v[60:63], v[132:135]
ds_read_b128 a[180:183], v3 offset:12288
v_cvt_pk_bf16_f32 v186, v124, v125
v_mfma_f32_16x16x32_bf16 v[132:135], a[192:195], v[56:59], v[132:135]
v_exp_f32 v126, v126
v_smfmac_f32_16x16x64_bf16 a[136:139], a[240:243], v[200:207], v5
ds_read_b128 a[184:187], v3 offset:5120
v_smfmac_f32_16x16x64_bf16 a[140:143], a[240:243], v[208:215], v5
s_waitcnt lgkmcnt(3)
ds_read_b128 a[188:191], v3 offset:13312
v_mfma_f32_16x16x32_bf16 a[64:67], a[144:147], v[200:203], a[64:67]
v_exp_f32 v127, v127
v_mfma_f32_16x16x32_bf16 a[64:67], a[148:151], v[204:207], a[64:67]
v_exp_f32 v128, v128
v_mfma_f32_16x16x32_bf16 a[96:99], a[148:151], v[212:215], a[96:99]
v_exp_f32 v129, v129
v_mfma_f32_16x16x32_bf16 a[96:99], a[144:147], v[208:211], a[96:99]
ds_read_b128 a[192:195], v3 offset:6144
v_cvt_pk_bf16_f32 v187, v126, v127
v_mfma_f32_16x16x32_bf16 a[100:103], a[152:155], v[208:211], a[100:103]
v_exp_f32 v130, v130
v_mfma_f32_16x16x32_bf16 a[100:103], a[156:159], v[212:215], a[100:103]
ds_read_b128 a[196:199], v3 offset:14336
v_cvt_pk_bf16_f32 v188, v128, v129
v_mfma_f32_16x16x32_bf16 a[68:71], a[156:159], v[204:207], a[68:71]
v_exp_f32 v131, v131
v_mfma_f32_16x16x32_bf16 a[68:71], a[152:155], v[200:203], a[68:71]
ds_read_b128 a[200:203], v3 offset:7168
v_cvt_pk_bf16_f32 v189, v130, v131
v_mfma_f32_16x16x32_bf16 a[72:75], a[160:163], v[200:203], a[72:75]
v_exp_f32 v144, v144
v_mfma_f32_16x16x32_bf16 a[72:75], a[164:167], v[204:207], a[72:75]
buffer_load_dwordx4 v16, s[32:35], s64 offen offset:3072 sc1 lds
v_mfma_f32_16x16x32_bf16 a[104:107], a[164:167], v[212:215], a[104:107]
s_xor_b32 s71, s71, 16384
v_exp_f32 v145, v145
v_mfma_f32_16x16x32_bf16 a[104:107], a[160:163], v[208:211], a[104:107]
ds_read_b128 a[204:207], v3 offset:15360
v_cvt_pk_bf16_f32 v196, v144, v145
v_mfma_f32_16x16x32_bf16 a[108:111], a[168:171], v[208:211], a[108:111]
s_add_u32 s70, s70, 32768
v_exp_f32 v146, v146
v_mfma_f32_16x16x32_bf16 a[108:111], a[172:175], v[212:215], a[108:111]
s_waitcnt vmcnt(8)
s_barrier
v_mfma_f32_16x16x32_bf16 a[76:79], a[172:175], v[204:207], a[76:79]
s_mov_b32 m0, s71
v_exp_f32 v147, v147
v_mfma_f32_16x16x32_bf16 a[76:79], a[168:171], v[200:203], a[76:79]
s_waitcnt lgkmcnt(1)
ds_read_b128 a[144:147], v2 offset:16384
v_cvt_pk_bf16_f32 v197, v146, v147
v_mfma_f32_16x16x32_bf16 a[80:83], a[176:179], v[200:203], a[80:83]
v_exp_f32 v148, v148
v_mfma_f32_16x16x32_bf16 a[80:83], a[180:183], v[204:207], a[80:83]
ds_read_b128 a[148:151], v2 offset:17408
ds_read_b128 a[152:155], v2 offset:18432
v_mfma_f32_16x16x32_bf16 a[112:115], a[180:183], v[212:215], a[112:115]
v_exp_f32 v149, v149
v_mfma_f32_16x16x32_bf16 a[112:115], a[176:179], v[208:211], a[112:115]
ds_read_b128 a[156:159], v2 offset:19456
v_cvt_pk_bf16_f32 v198, v148, v149
v_mfma_f32_16x16x32_bf16 a[116:119], a[184:187], v[208:211], a[116:119]
v_exp_f32 v150, v150
v_mfma_f32_16x16x32_bf16 a[116:119], a[188:191], v[212:215], a[116:119]
buffer_load_dwordx4 v16, s[32:35], s70 offen offset:0 sc1 lds
v_mfma_f32_16x16x32_bf16 a[84:87], a[188:191], v[204:207], a[84:87]
v_exp_f32 v151, v151
v_mfma_f32_16x16x32_bf16 a[84:87], a[184:187], v[200:203], a[84:87]
ds_read_b128 a[160:163], v2 offset:20480
v_cvt_pk_bf16_f32 v199, v150, v151
v_mfma_f32_16x16x32_bf16 a[88:91], a[192:195], v[200:203], a[88:91]
v_exp_f32 v132, v132
v_mfma_f32_16x16x32_bf16 a[88:91], a[196:199], v[204:207], a[88:91]
ds_read_b128 a[164:167], v2 offset:21504
v_mfma_f32_16x16x32_bf16 a[120:123], a[196:199], v[212:215], a[120:123]
v_exp_f32 v133, v133
v_mfma_f32_16x16x32_bf16 a[120:123], a[192:195], v[208:211], a[120:123]
ds_read_b128 a[168:171], v2 offset:22528
v_cvt_pk_bf16_f32 v190, v132, v133
v_mfma_f32_16x16x32_bf16 a[124:127], a[200:203], v[208:211], a[124:127]
s_waitcnt lgkmcnt(3)
v_exp_f32 v134, v134
v_mfma_f32_16x16x32_bf16 a[124:127], a[204:207], v[212:215], a[124:127]
buffer_load_dwordx4 v16, s[32:35], s70 offen offset:1024 sc1 lds
v_mfma_f32_16x16x32_bf16 a[92:95], a[204:207], v[204:207], a[92:95]
v_exp_f32 v135, v135
v_mfma_f32_16x16x32_bf16 a[92:95], a[200:203], v[200:203], a[92:95]
ds_read_b128 a[172:175], v2 offset:23552
v_cvt_pk_bf16_f32 v191, v134, v135
v_mfma_f32_16x16x32_bf16 v[120:123], a[144:147], v[56:59], v[224:227]
ds_read_b128 a[176:179], v2 offset:24576
ds_read_b128 a[180:183], v2 offset:25600
v_mfma_f32_16x16x32_bf16 v[120:123], a[148:151], v[60:63], v[120:123]
buffer_load_dwordx4 v16, s[32:35], s70 offen offset:2048 sc1 lds
v_mfma_f32_16x16x32_bf16 v[120:123], a[152:155], v[64:67], v[120:123]
s_add_u32 s64, s70, 4096
ds_read_b128 a[184:187], v2 offset:26624
ds_read_b128 a[188:191], v2 offset:27648
v_mfma_f32_16x16x32_bf16 v[120:123], a[156:159], v[68:71], v[120:123]
buffer_load_dwordx4 v16, s[32:35], s70 offen offset:3072 sc1 lds
v_mfma_f32_16x16x32_bf16 v[136:139], a[156:159], v[84:87], v[228:231]
s_add_u32 m0, s71, 4096
ds_read_b128 a[192:195], v2 offset:28672
ds_read_b128 a[196:199], v2 offset:29696
v_mfma_f32_16x16x32_bf16 v[136:139], a[152:155], v[80:83], v[136:139]
buffer_load_dwordx4 v16, s[32:35], s64 offen offset:0 sc1 lds
v_mfma_f32_16x16x32_bf16 v[136:139], a[148:151], v[76:79], v[136:139]
ds_read_b128 a[200:203], v2 offset:30720
ds_read_b128 a[204:207], v2 offset:31744
v_mfma_f32_16x16x32_bf16 v[136:139], a[144:147], v[72:75], v[136:139]
s_waitcnt lgkmcnt(6)
v_exp_f32 v120, v120
v_mfma_f32_16x16x32_bf16 v[140:143], a[160:163], v[72:75], v[228:231]
v_exp_f32 v121, v121
v_mfma_f32_16x16x32_bf16 v[140:143], a[164:167], v[76:79], v[140:143]
v_exp_f32 v122, v122
v_mfma_f32_16x16x32_bf16 v[140:143], a[168:171], v[80:83], v[140:143]
v_exp_f32 v123, v123
v_mfma_f32_16x16x32_bf16 v[140:143], a[172:175], v[84:87], v[140:143]
v_exp_f32 v136, v136
v_mfma_f32_16x16x32_bf16 v[124:127], a[172:175], v[68:71], v[224:227]
ds_read_b128 a[144:147], v3 offset:16384
v_cvt_pk_bf16_f32 v200, v120, v121
v_mfma_f32_16x16x32_bf16 v[124:127], a[168:171], v[64:67], v[124:127]
v_exp_f32 v137, v137
v_mfma_f32_16x16x32_bf16 v[124:127], a[164:167], v[60:63], v[124:127]
ds_read_b128 a[148:151], v3 offset:24576
v_cvt_pk_bf16_f32 v201, v122, v123
v_mfma_f32_16x16x32_bf16 v[124:127], a[160:163], v[56:59], v[124:127]
v_exp_f32 v138, v138
v_mfma_f32_16x16x32_bf16 v[128:131], a[176:179], v[56:59], v[224:227]
ds_read_b128 a[152:155], v3 offset:17408
v_cvt_pk_bf16_f32 v208, v136, v137
v_mfma_f32_16x16x32_bf16 v[128:131], a[180:183], v[60:63], v[128:131]
s_waitcnt lgkmcnt(3)
v_exp_f32 v139, v139
v_mfma_f32_16x16x32_bf16 v[128:131], a[184:187], v[64:67], v[128:131]
ds_read_b128 a[156:159], v3 offset:25600
v_cvt_pk_bf16_f32 v209, v138, v139
v_mfma_f32_16x16x32_bf16 v[128:131], a[188:191], v[68:71], v[128:131]
v_exp_f32 v140, v140
v_mfma_f32_16x16x32_bf16 v[144:147], a[188:191], v[84:87], v[228:231]
buffer_load_dwordx4 v16, s[32:35], s64 offen offset:1024 sc1 lds
v_mfma_f32_16x16x32_bf16 v[144:147], a[184:187], v[80:83], v[144:147]
v_exp_f32 v141, v141
v_mfma_f32_16x16x32_bf16 v[144:147], a[180:183], v[76:79], v[144:147]
ds_read_b128 a[160:163], v3 offset:18432
v_cvt_pk_bf16_f32 v210, v140, v141
v_mfma_f32_16x16x32_bf16 v[144:147], a[176:179], v[72:75], v[144:147]
v_exp_f32 v142, v142
v_mfma_f32_16x16x32_bf16 v[148:151], a[192:195], v[72:75], v[228:231]
ds_read_b128 a[164:167], v3 offset:26624
ds_read_b128 a[168:171], v3 offset:19456
v_mfma_f32_16x16x32_bf16 v[148:151], a[196:199], v[76:79], v[148:151]
v_exp_f32 v143, v143
v_mfma_f32_16x16x32_bf16 v[148:151], a[200:203], v[80:83], v[148:151]
ds_read_b128 a[172:175], v3 offset:27648
v_cvt_pk_bf16_f32 v211, v142, v143
v_mfma_f32_16x16x32_bf16 v[148:151], a[204:207], v[84:87], v[148:151]
v_exp_f32 v124, v124
v_mfma_f32_16x16x32_bf16 v[132:135], a[204:207], v[68:71], v[224:227]
ds_read_b128 a[176:179], v3 offset:20480
buffer_load_dwordx4 v16, s[32:35], s64 offen offset:2048 sc1 lds
v_mfma_f32_16x16x32_bf16 v[132:135], a[200:203], v[64:67], v[132:135]
v_exp_f32 v125, v125
v_mfma_f32_16x16x32_bf16 v[132:135], a[196:199], v[60:63], v[132:135]
ds_read_b128 a[180:183], v3 offset:28672
v_cvt_pk_bf16_f32 v202, v124, v125
v_mfma_f32_16x16x32_bf16 v[132:135], a[192:195], v[56:59], v[132:135]
v_exp_f32 v126, v126
v_smfmac_f32_16x16x64_bf16 a[136:139], a[240:243], v[184:191], v5
ds_read_b128 a[184:187], v3 offset:21504
v_smfmac_f32_16x16x64_bf16 a[140:143], a[240:243], v[192:199], v5
s_waitcnt lgkmcnt(3)
ds_read_b128 a[188:191], v3 offset:29696
v_mfma_f32_16x16x32_bf16 a[64:67], a[144:147], v[184:187], a[64:67]
v_exp_f32 v127, v127
v_mfma_f32_16x16x32_bf16 a[64:67], a[148:151], v[188:191], a[64:67]
v_exp_f32 v128, v128
v_mfma_f32_16x16x32_bf16 a[96:99], a[148:151], v[196:199], a[96:99]
v_exp_f32 v129, v129
v_mfma_f32_16x16x32_bf16 a[96:99], a[144:147], v[192:195], a[96:99]
ds_read_b128 a[192:195], v3 offset:22528
v_cvt_pk_bf16_f32 v203, v126, v127
v_mfma_f32_16x16x32_bf16 a[100:103], a[152:155], v[192:195], a[100:103]
v_exp_f32 v130, v130
v_mfma_f32_16x16x32_bf16 a[100:103], a[156:159], v[196:199], a[100:103]
ds_read_b128 a[196:199], v3 offset:30720
v_cvt_pk_bf16_f32 v204, v128, v129
v_mfma_f32_16x16x32_bf16 a[68:71], a[156:159], v[188:191], a[68:71]
v_exp_f32 v131, v131
v_mfma_f32_16x16x32_bf16 a[68:71], a[152:155], v[184:187], a[68:71]
ds_read_b128 a[200:203], v3 offset:23552
v_cvt_pk_bf16_f32 v205, v130, v131
v_mfma_f32_16x16x32_bf16 a[72:75], a[160:163], v[184:187], a[72:75]
v_exp_f32 v144, v144
v_mfma_f32_16x16x32_bf16 a[72:75], a[164:167], v[188:191], a[72:75]
buffer_load_dwordx4 v16, s[32:35], s64 offen offset:3072 sc1 lds
v_mfma_f32_16x16x32_bf16 a[104:107], a[164:167], v[196:199], a[104:107]
s_xor_b32 s71, s71, 49152
v_exp_f32 v145, v145
v_mfma_f32_16x16x32_bf16 a[104:107], a[160:163], v[192:195], a[104:107]
ds_read_b128 a[204:207], v3 offset:31744
v_cvt_pk_bf16_f32 v212, v144, v145
v_mfma_f32_16x16x32_bf16 a[108:111], a[168:171], v[192:195], a[108:111]
s_add_u32 s70, s70, 32768
v_xor_b32 v2, 0x8000, v2
v_exp_f32 v146, v146
v_mfma_f32_16x16x32_bf16 a[108:111], a[172:175], v[196:199], a[108:111]
s_waitcnt vmcnt(8)
s_barrier
v_mfma_f32_16x16x32_bf16 a[76:79], a[172:175], v[188:191], a[76:79]
s_mov_b32 m0, s71
v_exp_f32 v147, v147
v_mfma_f32_16x16x32_bf16 a[76:79], a[168:171], v[184:187], a[76:79]
s_waitcnt lgkmcnt(1)
ds_read_b128 a[144:147], v2 offset:0
v_cvt_pk_bf16_f32 v213, v146, v147
v_mfma_f32_16x16x32_bf16 a[80:83], a[176:179], v[184:187], a[80:83]
v_exp_f32 v148, v148
v_mfma_f32_16x16x32_bf16 a[80:83], a[180:183], v[188:191], a[80:83]
ds_read_b128 a[148:151], v2 offset:1024
ds_read_b128 a[152:155], v2 offset:2048
v_mfma_f32_16x16x32_bf16 a[112:115], a[180:183], v[196:199], a[112:115]
v_exp_f32 v149, v149
v_mfma_f32_16x16x32_bf16 a[112:115], a[176:179], v[192:195], a[112:115]
ds_read_b128 a[156:159], v2 offset:3072
v_cvt_pk_bf16_f32 v214, v148, v149
v_mfma_f32_16x16x32_bf16 a[116:119], a[184:187], v[192:195], a[116:119]
v_exp_f32 v150, v150
v_mfma_f32_16x16x32_bf16 a[116:119], a[188:191], v[196:199], a[116:119]
buffer_load_dwordx4 v16, s[32:35], s70 offen offset:0 sc1 lds
v_mfma_f32_16x16x32_bf16 a[84:87], a[188:191], v[188:191], a[84:87]
s_sub_u32 s72, s72, 1
v_exp_f32 v151, v151
v_mfma_f32_16x16x32_bf16 a[84:87], a[184:187], v[184:187], a[84:87]
ds_read_b128 a[160:163], v2 offset:4096
v_cvt_pk_bf16_f32 v215, v150, v151
v_mfma_f32_16x16x32_bf16 a[88:91], a[192:195], v[184:187], a[88:91]
v_exp_f32 v132, v132
v_mfma_f32_16x16x32_bf16 a[88:91], a[196:199], v[188:191], a[88:91]
ds_read_b128 a[164:167], v2 offset:5120
v_xor_b32 v3, 0x8000, v3
v_mfma_f32_16x16x32_bf16 a[120:123], a[196:199], v[196:199], a[120:123]
s_cmp_lg_u32 s72, 0
v_exp_f32 v133, v133
v_mfma_f32_16x16x32_bf16 a[120:123], a[192:195], v[192:195], a[120:123]
ds_read_b128 a[168:171], v2 offset:6144
v_cvt_pk_bf16_f32 v206, v132, v133
v_mfma_f32_16x16x32_bf16 a[124:127], a[200:203], v[192:195], a[124:127]
s_waitcnt lgkmcnt(3)
v_exp_f32 v134, v134
v_mfma_f32_16x16x32_bf16 a[124:127], a[204:207], v[196:199], a[124:127]
buffer_load_dwordx4 v16, s[32:35], s70 offen offset:1024 sc1 lds
v_mfma_f32_16x16x32_bf16 a[92:95], a[204:207], v[188:191], a[92:95]
v_exp_f32 v135, v135
v_mfma_f32_16x16x32_bf16 a[92:95], a[200:203], v[184:187], a[92:95]
ds_read_b128 a[172:175], v2 offset:7168
v_cvt_pk_bf16_f32 v207, v134, v135
s_cbranch_scc1 L_S
L_SD:
buffer_load_dword v19, off, s[52:55], s80 sc1
s_add_u32 s17, s78, L_TAIL-L_pc
buffer_load_dword a252, v16, s[88:91], s17 offen
s_add_u32 s17, s78, L_TAIL-L_pc+4096
buffer_load_dword a252, v16, s[88:91], s17 offen
s_add_u32 s17, s78, L_p5f0-L_pc
buffer_load_dword a252, v16, s[88:91], s17 offen
s_add_u32 s17, s78, L_p5f0-L_pc+4096
buffer_load_dword a252, v16, s[88:91], s17 offen
s_waitcnt lgkmcnt(7)
v_mfma_f32_16x16x32_bf16 v[136:139], a[144:147], v[72:75], v[228:231]
s_waitcnt lgkmcnt(6)
ds_read_b128 a[176:179], v2 offset:8192
ds_read_b128 a[180:183], v2 offset:9216
v_mfma_f32_16x16x32_bf16 v[136:139], a[148:151], v[76:79], v[136:139]
s_waitcnt lgkmcnt(7)
buffer_load_dwordx4 v16, s[32:35], s70 offen offset:2048 sc1 lds
v_cndmask_b32 v120, v224, v17, s[0:1]
v_cndmask_b32 v121, v224, v17, s[4:5]
v_cndmask_b32 v122, v224, v17, s[6:7]
v_cndmask_b32 v123, v224, v17, s[8:9]
v_mfma_f32_16x16x32_bf16 v[136:139], a[152:155], v[80:83], v[136:139]
s_waitcnt lgkmcnt(6)
s_add_u32 s64, s70, 4096
ds_read_b128 a[184:187], v2 offset:10240
ds_read_b128 a[188:191], v2 offset:11264
v_mfma_f32_16x16x32_bf16 v[136:139], a[156:159], v[84:87], v[136:139]
buffer_load_dwordx4 v16, s[32:35], s70 offen offset:3072 sc1 lds
v_mfma_f32_16x16x32_bf16 v[120:123], a[156:159], v[68:71], v[120:123]
s_add_u32 m0, s71, 4096
ds_read_b128 a[192:195], v2 offset:12288
ds_read_b128 a[196:199], v2 offset:13312
v_mfma_f32_16x16x32_bf16 v[120:123], a[152:155], v[64:67], v[120:123]
buffer_load_dwordx4 v16, s[32:35], s64 offen offset:0 sc1 lds
v_mfma_f32_16x16x32_bf16 v[120:123], a[148:151], v[60:63], v[120:123]
ds_read_b128 a[200:203], v2 offset:14336
ds_read_b128 a[204:207], v2 offset:15360
v_mfma_f32_16x16x32_bf16 v[120:123], a[144:147], v[56:59], v[120:123]
s_waitcnt lgkmcnt(6)
v_exp_f32 v136, v136
v_mfma_f32_16x16x32_bf16 v[140:143], a[160:163], v[72:75], v[228:231]
v_exp_f32 v137, v137
v_mfma_f32_16x16x32_bf16 v[140:143], a[164:167], v[76:79], v[140:143]
v_cndmask_b32 v124, v224, v17, s[10:11]
v_cndmask_b32 v125, v224, v17, s[12:13]
v_cndmask_b32 v126, v224, v17, s[18:19]
v_cndmask_b32 v127, v224, v17, s[22:23]
v_exp_f32 v138, v138
v_mfma_f32_16x16x32_bf16 v[140:143], a[168:171], v[80:83], v[140:143]
v_exp_f32 v139, v139
v_mfma_f32_16x16x32_bf16 v[140:143], a[172:175], v[84:87], v[140:143]
v_exp_f32 v120, v120
v_mfma_f32_16x16x32_bf16 v[124:127], a[172:175], v[68:71], v[124:127]
ds_read_b128 a[144:147], v3 offset:0
v_cvt_pk_bf16_f32 v192, v136, v137
v_mfma_f32_16x16x32_bf16 v[124:127], a[168:171], v[64:67], v[124:127]
v_cndmask_b32 v128, v224, v17, s[26:27]
v_cndmask_b32 v129, v224, v17, s[56:57]
v_cndmask_b32 v130, v224, v17, s[58:59]
v_cndmask_b32 v131, v224, v17, s[60:61]
v_exp_f32 v121, v121
v_mfma_f32_16x16x32_bf16 v[124:127], a[164:167], v[60:63], v[124:127]
s_mul_i32 s69, s83, 8
ds_read_b128 a[148:151], v3 offset:8192
v_cvt_pk_bf16_f32 v193, v138, v139
v_mfma_f32_16x16x32_bf16 v[124:127], a[160:163], v[56:59], v[124:127]
s_sub_u32 s69, 36, s69
v_exp_f32 v122, v122
v_mfma_f32_16x16x32_bf16 v[128:131], a[176:179], v[56:59], v[128:131]
ds_read_b128 a[152:155], v3 offset:1024
v_cvt_pk_bf16_f32 v184, v120, v121
v_mfma_f32_16x16x32_bf16 v[128:131], a[180:183], v[60:63], v[128:131]
s_waitcnt lgkmcnt(3)
v_exp_f32 v123, v123
v_mfma_f32_16x16x32_bf16 v[128:131], a[184:187], v[64:67], v[128:131]
ds_read_b128 a[156:159], v3 offset:9216
v_cvt_pk_bf16_f32 v185, v122, v123
v_mfma_f32_16x16x32_bf16 v[128:131], a[188:191], v[68:71], v[128:131]
v_exp_f32 v140, v140
v_mfma_f32_16x16x32_bf16 v[144:147], a[188:191], v[84:87], v[228:231]
buffer_load_dwordx4 v16, s[32:35], s64 offen offset:1024 sc1 lds
v_mfma_f32_16x16x32_bf16 v[144:147], a[184:187], v[80:83], v[144:147]
v_exp_f32 v141, v141
v_mfma_f32_16x16x32_bf16 v[144:147], a[180:183], v[76:79], v[144:147]
ds_read_b128 a[160:163], v3 offset:2048
v_cvt_pk_bf16_f32 v194, v140, v141
v_mfma_f32_16x16x32_bf16 v[144:147], a[176:179], v[72:75], v[144:147]
v_exp_f32 v142, v142
v_mfma_f32_16x16x32_bf16 v[148:151], a[192:195], v[72:75], v[228:231]
ds_read_b128 a[164:167], v3 offset:10240
ds_read_b128 a[168:171], v3 offset:3072
v_mfma_f32_16x16x32_bf16 v[148:151], a[196:199], v[76:79], v[148:151]
v_cndmask_b32 v132, v224, v17, s[62:63]
v_cndmask_b32 v133, v224, v17, s[48:49]
v_cndmask_b32 v134, v224, v17, s[50:51]
v_cndmask_b32 v135, v224, v17, s[100:101]
v_exp_f32 v143, v143
v_mfma_f32_16x16x32_bf16 v[148:151], a[200:203], v[80:83], v[148:151]
ds_read_b128 a[172:175], v3 offset:11264
v_cvt_pk_bf16_f32 v195, v142, v143
v_mfma_f32_16x16x32_bf16 v[148:151], a[204:207], v[84:87], v[148:151]
v_exp_f32 v124, v124
v_mfma_f32_16x16x32_bf16 v[132:135], a[204:207], v[68:71], v[132:135]
ds_read_b128 a[176:179], v3 offset:4096
buffer_load_dwordx4 v16, s[32:35], s64 offen offset:2048 sc1 lds
v_mfma_f32_16x16x32_bf16 v[132:135], a[200:203], v[64:67], v[132:135]
v_exp_f32 v125, v125
v_mfma_f32_16x16x32_bf16 v[132:135], a[196:199], v[60:63], v[132:135]
ds_read_b128 a[180:183], v3 offset:12288
v_cvt_pk_bf16_f32 v186, v124, v125
v_mfma_f32_16x16x32_bf16 v[132:135], a[192:195], v[56:59], v[132:135]
v_exp_f32 v126, v126
v_smfmac_f32_16x16x64_bf16 a[136:139], a[240:243], v[200:207], v5
ds_read_b128 a[184:187], v3 offset:5120
v_smfmac_f32_16x16x64_bf16 a[140:143], a[240:243], v[208:215], v5
s_waitcnt lgkmcnt(3)
ds_read_b128 a[188:191], v3 offset:13312
v_mfma_f32_16x16x32_bf16 a[64:67], a[144:147], v[200:203], a[64:67]
v_exp_f32 v127, v127
v_mfma_f32_16x16x32_bf16 a[64:67], a[148:151], v[204:207], a[64:67]
v_exp_f32 v128, v128
v_mfma_f32_16x16x32_bf16 a[96:99], a[148:151], v[212:215], a[96:99]
v_exp_f32 v129, v129
v_mfma_f32_16x16x32_bf16 a[96:99], a[144:147], v[208:211], a[96:99]
ds_read_b128 a[192:195], v3 offset:6144
v_cvt_pk_bf16_f32 v187, v126, v127
v_mfma_f32_16x16x32_bf16 a[100:103], a[152:155], v[208:211], a[100:103]
v_exp_f32 v130, v130
v_mfma_f32_16x16x32_bf16 a[100:103], a[156:159], v[212:215], a[100:103]
ds_read_b128 a[196:199], v3 offset:14336
v_cvt_pk_bf16_f32 v188, v128, v129
v_mfma_f32_16x16x32_bf16 a[68:71], a[156:159], v[204:207], a[68:71]
v_exp_f32 v131, v131
v_mfma_f32_16x16x32_bf16 a[68:71], a[152:155], v[200:203], a[68:71]
ds_read_b128 a[200:203], v3 offset:7168
v_cvt_pk_bf16_f32 v189, v130, v131
v_mfma_f32_16x16x32_bf16 a[72:75], a[160:163], v[200:203], a[72:75]
v_exp_f32 v144, v144
v_mfma_f32_16x16x32_bf16 a[72:75], a[164:167], v[204:207], a[72:75]
buffer_load_dwordx4 v16, s[32:35], s64 offen offset:3072 sc1 lds
v_mfma_f32_16x16x32_bf16 a[104:107], a[164:167], v[212:215], a[104:107]
v_exp_f32 v145, v145
v_mfma_f32_16x16x32_bf16 a[104:107], a[160:163], v[208:211], a[104:107]
ds_read_b128 a[204:207], v3 offset:15360
v_cvt_pk_bf16_f32 v196, v144, v145
v_mfma_f32_16x16x32_bf16 a[108:111], a[168:171], v[208:211], a[108:111]
v_exp_f32 v146, v146
v_mfma_f32_16x16x32_bf16 a[108:111], a[172:175], v[212:215], a[108:111]
s_waitcnt vmcnt(13)
s_barrier
v_mfma_f32_16x16x32_bf16 a[76:79], a[172:175], v[204:207], a[76:79]
v_exp_f32 v147, v147
v_mfma_f32_16x16x32_bf16 a[76:79], a[168:171], v[200:203], a[76:79]
s_waitcnt lgkmcnt(1)
ds_read_b128 a[144:147], v2 offset:16384
v_cvt_pk_bf16_f32 v197, v146, v147
v_mfma_f32_16x16x32_bf16 a[80:83], a[176:179], v[200:203], a[80:83]
s_waitcnt vmcnt(10)
v_readfirstlane_b32 vcc_lo, v19
s_nop 0
s_cmp_lt_u32 vcc_lo, s69
s_cbranch_scc1 L_spin_8
L_spinbk_9:
v_exp_f32 v148, v148
v_mfma_f32_16x16x32_bf16 a[80:83], a[180:183], v[204:207], a[80:83]
ds_read_b128 a[148:151], v2 offset:17408
ds_read_b128 a[152:155], v2 offset:18432
v_mfma_f32_16x16x32_bf16 a[112:115], a[180:183], v[212:215], a[112:115]
v_exp_f32 v149, v149
v_mfma_f32_16x16x32_bf16 a[112:115], a[176:179], v[208:211], a[112:115]
ds_read_b128 a[156:159], v2 offset:19456
v_cvt_pk_bf16_f32 v198, v148, v149
v_mfma_f32_16x16x32_bf16 a[116:119], a[184:187], v[208:211], a[116:119]
v_exp_f32 v150, v150
v_mfma_f32_16x16x32_bf16 a[116:119], a[188:191], v[212:215], a[116:119]
v_cndmask_b32 v136, v228, v17, s[0:1]
v_cndmask_b32 v137, v228, v17, s[4:5]
v_mfma_f32_16x16x32_bf16 a[84:87], a[188:191], v[204:207], a[84:87]
v_exp_f32 v151, v151
v_mfma_f32_16x16x32_bf16 a[84:87], a[184:187], v[200:203], a[84:87]
ds_read_b128 a[160:163], v2 offset:20480
v_cvt_pk_bf16_f32 v199, v150, v151
v_mfma_f32_16x16x32_bf16 a[88:91], a[192:195], v[200:203], a[88:91]
v_exp_f32 v132, v132
v_mfma_f32_16x16x32_bf16 a[88:91], a[196:199], v[204:207], a[88:91]
ds_read_b128 a[164:167], v2 offset:21504
v_cndmask_b32 v138, v228, v17, s[6:7]
v_mfma_f32_16x16x32_bf16 a[120:123], a[196:199], v[212:215], a[120:123]
v_exp_f32 v133, v133
v_mfma_f32_16x16x32_bf16 a[120:123], a[192:195], v[208:211], a[120:123]
ds_read_b128 a[168:171], v2 offset:22528
v_cvt_pk_bf16_f32 v190, v132, v133
v_mfma_f32_16x16x32_bf16 a[124:127], a[200:203], v[208:211], a[124:127]
s_waitcnt lgkmcnt(3)
v_exp_f32 v134, v134
v_mfma_f32_16x16x32_bf16 a[124:127], a[204:207], v[212:215], a[124:127]
v_cndmask_b32 v139, v228, v17, s[8:9]
v_cndmask_b32 v140, v228, v17, s[10:11]
v_mfma_f32_16x16x32_bf16 a[92:95], a[204:207], v[204:207], a[92:95]
v_exp_f32 v135, v135
v_mfma_f32_16x16x32_bf16 a[92:95], a[200:203], v[200:203], a[92:95]
ds_read_b128 a[172:175], v2 offset:23552
v_cvt_pk_bf16_f32 v191, v134, v135
v_mfma_f32_16x16x32_bf16 v[136:139], a[144:147], v[72:75], v[136:139]
ds_read_b128 a[176:179], v2 offset:24576
v_cndmask_b32 v141, v228, v17, s[12:13]
v_mfma_f32_16x16x32_bf16 v[136:139], a[148:151], v[76:79], v[136:139]
ds_read_b128 a[180:183], v2 offset:25600
v_cndmask_b32 v142, v228, v17, s[18:19]
v_cndmask_b32 v143, v228, v17, s[22:23]
v_mfma_f32_16x16x32_bf16 v[136:139], a[152:155], v[80:83], v[136:139]
ds_read_b128 a[184:187], v2 offset:26624
v_cndmask_b32 v144, v228, v17, s[26:27]
v_mfma_f32_16x16x32_bf16 v[136:139], a[156:159], v[84:87], v[136:139]
s_waitcnt lgkmcnt(3)
ds_read_b128 a[188:191], v2 offset:27648
v_cndmask_b32 v145, v228, v17, s[56:57]
v_mfma_f32_16x16x32_bf16 v[140:143], a[172:175], v[84:87], v[140:143]
ds_read_b128 a[192:195], v2 offset:28672
ds_read_b128 a[196:199], v2 offset:29696
ds_read_b128 a[200:203], v2 offset:30720
ds_read_b128 a[204:207], v2 offset:31744
v_mfma_f32_16x16x32_bf16 v[140:143], a[168:171], v[80:83], v[140:143]
ds_read_b128 a[144:147], v3 offset:16384
v_cndmask_b32 v146, v228, v17, s[58:59]
v_cndmask_b32 v147, v228, v17, s[60:61]
v_mfma_f32_16x16x32_bf16 v[140:143], a[164:167], v[76:79], v[140:143]
ds_read_b128 a[148:151], v3 offset:24576
v_cndmask_b32 v148, v228, v17, s[62:63]
v_mfma_f32_16x16x32_bf16 v[140:143], a[160:163], v[72:75], v[140:143]
s_waitcnt lgkmcnt(8)
ds_read_b128 a[152:155], v3 offset:17408
v_cndmask_b32 v149, v228, v17, s[48:49]
v_mfma_f32_16x16x32_bf16 v[144:147], a[176:179], v[72:75], v[144:147]
ds_read_b128 a[156:159], v3 offset:25600
v_cndmask_b32 v150, v228, v17, s[50:51]
v_mfma_f32_16x16x32_bf16 v[144:147], a[180:183], v[76:79], v[144:147]
s_waitcnt lgkmcnt(8)
ds_read_b128 a[160:163], v3 offset:18432
v_cndmask_b32 v151, v228, v17, s[100:101]
v_mfma_f32_16x16x32_bf16 v[144:147], a[184:187], v[80:83], v[144:147]
v_exp_f32 v136, v136
v_mfma_f32_16x16x32_bf16 v[144:147], a[188:191], v[84:87], v[144:147]
s_waitcnt lgkmcnt(4)
v_exp_f32 v137, v137
v_mfma_f32_16x16x32_bf16 v[148:151], a[204:207], v[84:87], v[148:151]
v_exp_f32 v138, v138
v_mfma_f32_16x16x32_bf16 v[148:151], a[200:203], v[80:83], v[148:151]
s_add_u32 s65, s84, 0
v_exp_f32 v139, v139
v_mfma_f32_16x16x32_bf16 v[148:151], a[196:199], v[76:79], v[148:151]
buffer_load_dwordx4 a[208:211], v14, s[44:47], s65 offen offset:0 sc1
v_mfma_f32_16x16x32_bf16 v[148:151], a[192:195], v[72:75], v[148:151]
ds_read_b128 a[164:167], v3 offset:26624
v_cvt_pk_bf16_f32 v208, v136, v137
v_smfmac_f32_16x16x64_bf16 a[136:139], a[240:243], v[184:191], v5
ds_read_b128 a[168:171], v3 offset:19456
v_smfmac_f32_16x16x64_bf16 a[140:143], a[240:243], v[192:199], v5
ds_read_b128 a[172:175], v3 offset:27648
v_mfma_f32_16x16x32_bf16 a[64:67], a[144:147], v[184:187], a[64:67]
s_waitcnt lgkmcnt(3)
v_exp_f32 v140, v140
v_mfma_f32_16x16x32_bf16 a[64:67], a[148:151], v[188:191], a[64:67]
buffer_load_dwordx4 a[216:219], v14, s[44:47], s65 offen offset:1024 sc1
v_mfma_f32_16x16x32_bf16 a[96:99], a[148:151], v[196:199], a[96:99]
v_exp_f32 v141, v141
v_mfma_f32_16x16x32_bf16 a[96:99], a[144:147], v[192:195], a[96:99]
buffer_load_dwordx4 a[224:227], v15, s[44:47], s65 offen offset:0 sc1
v_mfma_f32_16x16x32_bf16 a[100:103], a[152:155], v[192:195], a[100:103]
v_exp_f32 v142, v142
v_mfma_f32_16x16x32_bf16 a[100:103], a[156:159], v[196:199], a[100:103]
buffer_load_dwordx4 a[232:235], v15, s[44:47], s65 offen offset:1024 sc1
v_mfma_f32_16x16x32_bf16 a[68:71], a[156:159], v[188:191], a[68:71]
s_add_u32 s65, s84, 8192
ds_read_b128 a[176:179], v3 offset:20480
v_cvt_pk_bf16_f32 v209, v138, v139
v_mfma_f32_16x16x32_bf16 a[68:71], a[152:155], v[184:187], a[68:71]
buffer_load_dwordx4 a[212:215], v14, s[44:47], s65 offen offset:0 sc1
v_mfma_f32_16x16x32_bf16 a[72:75], a[160:163], v[184:187], a[72:75]
s_waitcnt lgkmcnt(1)
ds_read_b128 a[180:183], v3 offset:28672
v_cvt_pk_bf16_f32 v210, v140, v141
v_mfma_f32_16x16x32_bf16 a[72:75], a[164:167], v[188:191], a[72:75]
v_exp_f32 v143, v143
v_mfma_f32_16x16x32_bf16 a[104:107], a[164:167], v[196:199], a[104:107]
buffer_load_dwordx4 a[220:223], v14, s[44:47], s65 offen offset:1024 sc1
v_mfma_f32_16x16x32_bf16 a[104:107], a[160:163], v[192:195], a[104:107]
v_exp_f32 v144, v144
v_mfma_f32_16x16x32_bf16 a[108:111], a[168:171], v[192:195], a[108:111]
ds_read_b128 a[184:187], v3 offset:21504
v_xor_b32 v2, 0x8000, v2
v_mfma_f32_16x16x32_bf16 a[108:111], a[172:175], v[196:199], a[108:111]
buffer_load_dwordx4 a[228:231], v15, s[44:47], s65 offen offset:0 sc1
ds_read_b128 a[188:191], v3 offset:29696
v_mfma_f32_16x16x32_bf16 a[76:79], a[172:175], v[188:191], a[76:79]
v_exp_f32 v145, v145
v_mfma_f32_16x16x32_bf16 a[76:79], a[168:171], v[184:187], a[76:79]
s_waitcnt lgkmcnt(2)
buffer_load_dwordx4 a[236:239], v15, s[44:47], s65 offen offset:1024 sc1
v_mfma_f32_16x16x32_bf16 a[80:83], a[176:179], v[184:187], a[80:83]
s_add_u32 s65, s84, 32768
ds_read_b128 a[192:195], v3 offset:22528
v_cvt_pk_bf16_f32 v211, v142, v143
v_mfma_f32_16x16x32_bf16 a[80:83], a[180:183], v[188:191], a[80:83]
buffer_load_dwordx4 v[152:155], v14, s[44:47], s65 offen offset:0 sc1
ds_read_b128 a[196:199], v3 offset:30720
v_exp_f32 v146, v146
v_mfma_f32_16x16x32_bf16 a[112:115], a[180:183], v[196:199], a[112:115]
ds_read_b128 a[200:203], v3 offset:23552
ds_read_b128 a[204:207], v3 offset:31744
v_mfma_f32_16x16x32_bf16 a[112:115], a[176:179], v[192:195], a[112:115]
s_waitcnt vmcnt(9)
s_barrier
v_xor_b32 v3, 0x8000, v3
buffer_load_dwordx4 v[160:163], v14, s[44:47], s65 offen offset:1024 sc1
s_waitcnt lgkmcnt(4)
v_mfma_f32_16x16x32_bf16 a[116:119], a[184:187], v[192:195], a[116:119]
v_exp_f32 v147, v147
v_mfma_f32_16x16x32_bf16 a[116:119], a[188:191], v[196:199], a[116:119]
buffer_load_dwordx4 v[168:171], v15, s[44:47], s65 offen offset:0 sc1
v_mfma_f32_16x16x32_bf16 a[84:87], a[188:191], v[188:191], a[84:87]
v_exp_f32 v148, v148
v_mfma_f32_16x16x32_bf16 a[84:87], a[184:187], v[184:187], a[84:87]
s_waitcnt lgkmcnt(2)
buffer_load_dwordx4 v[176:179], v15, s[44:47], s65 offen offset:1024 sc1
v_cvt_pk_bf16_f32 v212, v144, v145
v_mfma_f32_16x16x32_bf16 a[88:91], a[192:195], v[184:187], a[88:91]
s_add_u32 s65, s84, 40960
v_exp_f32 v149, v149
v_mfma_f32_16x16x32_bf16 a[88:91], a[196:199], v[188:191], a[88:91]
buffer_load_dwordx4 v[156:159], v14, s[44:47], s65 offen offset:0 sc1
v_mfma_f32_16x16x32_bf16 a[120:123], a[196:199], v[196:199], a[120:123]
ds_read_b128 a[144:147], v3 offset:0
v_cvt_pk_bf16_f32 v213, v146, v147
v_mfma_f32_16x16x32_bf16 a[120:123], a[192:195], v[192:195], a[120:123]
s_waitcnt lgkmcnt(1)
buffer_load_dwordx4 v[164:167], v14, s[44:47], s65 offen offset:1024 sc1
ds_read_b128 a[148:151], v3 offset:8192
v_exp_f32 v150, v150
v_mfma_f32_16x16x32_bf16 a[124:127], a[200:203], v[192:195], a[124:127]
ds_read_b128 a[152:155], v3 offset:1024
v_cvt_pk_bf16_f32 v214, v148, v149
v_mfma_f32_16x16x32_bf16 a[124:127], a[204:207], v[196:199], a[124:127]
buffer_load_dwordx4 v[172:175], v15, s[44:47], s65 offen offset:0 sc1
ds_read_b128 a[156:159], v3 offset:9216
v_mfma_f32_16x16x32_bf16 a[92:95], a[204:207], v[188:191], a[92:95]
v_exp_f32 v151, v151
v_mfma_f32_16x16x32_bf16 a[92:95], a[200:203], v[184:187], a[92:95]
buffer_load_dwordx4 v[180:183], v15, s[44:47], s65 offen offset:1024 sc1
ds_read_b128 a[160:163], v3 offset:2048
ds_read_b128 a[164:167], v3 offset:10240
ds_read_b128 a[168:171], v3 offset:3072
ds_read_b128 a[172:175], v3 offset:11264
v_cvt_pk_bf16_f32 v215, v150, v151
v_accvgpr_read_b32 v22, a136
v_accvgpr_read_b32 v248, a137
v_add_f32 v22, v22, v248
v_max_f32 v1, v1, v22
v_rcp_f32 v22, v22
v_accvgpr_read_b32 v232, a64
v_accvgpr_read_b32 v233, a65
v_accvgpr_read_b32 v234, a66
v_accvgpr_read_b32 v235, a67
v_accvgpr_read_b32 v236, a68
v_accvgpr_read_b32 v237, a69
v_accvgpr_read_b32 v238, a70
v_accvgpr_read_b32 v239, a71
v_mul_f32 v22, v22, v8
v_mul_f32 v232, v232, v22
v_mul_f32 v233, v233, v22
v_mul_f32 v234, v234, v22
v_mul_f32 v235, v235, v22
v_mul_f32 v236, v236, v22
v_mul_f32 v237, v237, v22
v_mul_f32 v238, v238, v22
v_mul_f32 v239, v239, v22
v_cvt_pk_bf16_f32 v232, v232, v233
v_cvt_pk_bf16_f32 v233, v234, v235
v_cvt_pk_bf16_f32 v234, v236, v237
v_cvt_pk_bf16_f32 v235, v238, v239
s_add_u32 s77, s75, 0
buffer_store_dwordx4 v[232:235], v16, s[44:47], s77 offen sc1
L_TAIL:
ds_read_b128 a[176:179], v3 offset:4096
ds_read_b128 a[180:183], v3 offset:12288
ds_read_b128 a[184:187], v3 offset:5120
ds_read_b128 a[188:191], v3 offset:13312
v_smfmac_f32_16x16x64_bf16 a[140:143], a[240:243], v[208:215], v5
s_waitcnt lgkmcnt(11)
s_add_u32 m0, s86, 32768
s_add_u32 s64, s85, 262144
ds_read_b128 a[192:195], v3 offset:6144
v_mfma_f32_16x16x32_bf16 a[96:99], a[144:147], v[208:211], a[96:99]
s_waitcnt lgkmcnt(11)
ds_read_b128 a[196:199], v3 offset:14336
ds_read_b128 a[200:203], v3 offset:7168
ds_read_b128 a[204:207], v3 offset:15360
v_mfma_f32_16x16x32_bf16 a[96:99], a[148:151], v[212:215], a[96:99]
s_waitcnt lgkmcnt(12)
buffer_load_dwordx4 v12, s[36:39], s64 offen lds
v_mfma_f32_16x16x32_bf16 a[100:103], a[156:159], v[212:215], a[100:103]
s_add_u32 m0, s86, 33792
s_add_u32 s64, s85, 270336
v_accvgpr_read_b32 v240, a72
v_accvgpr_read_b32 v241, a73
v_mfma_f32_16x16x32_bf16 a[100:103], a[152:155], v[208:211], a[100:103]
s_waitcnt lgkmcnt(11)
buffer_load_dwordx4 v13, s[36:39], s64 offen lds
v_mfma_f32_16x16x32_bf16 a[104:107], a[160:163], v[208:211], a[104:107]
s_waitcnt lgkmcnt(10)
s_add_u32 m0, s86, 34816
s_add_u32 s64, s85, 278528
v_accvgpr_read_b32 v242, a74
v_accvgpr_read_b32 v243, a75
v_mfma_f32_16x16x32_bf16 a[104:107], a[164:167], v[212:215], a[104:107]
s_waitcnt lgkmcnt(8)
buffer_load_dwordx4 v12, s[36:39], s64 offen lds
v_mfma_f32_16x16x32_bf16 a[108:111], a[172:175], v[212:215], a[108:111]
s_add_u32 m0, s86, 35840
s_add_u32 s64, s85, 286720
v_accvgpr_read_b32 v244, a76
v_accvgpr_read_b32 v245, a77
v_mfma_f32_16x16x32_bf16 a[108:111], a[168:171], v[208:211], a[108:111]
s_waitcnt lgkmcnt(7)
buffer_load_dwordx4 v13, s[36:39], s64 offen lds
v_mfma_f32_16x16x32_bf16 a[112:115], a[176:179], v[208:211], a[112:115]
s_waitcnt lgkmcnt(6)
s_add_u32 m0, s86, 36864
s_add_u32 s64, s85, 294912
v_accvgpr_read_b32 v246, a78
v_accvgpr_read_b32 v247, a79
v_mfma_f32_16x16x32_bf16 a[112:115], a[180:183], v[212:215], a[112:115]
s_waitcnt lgkmcnt(4)
buffer_load_dwordx4 v12, s[36:39], s64 offen lds
v_mfma_f32_16x16x32_bf16 a[116:119], a[188:191], v[212:215], a[116:119]
s_add_u32 m0, s86, 37888
s_add_u32 s64, s85, 303104
v_mul_f32 v240, v240, v22
v_mul_f32 v241, v241, v22
v_mfma_f32_16x16x32_bf16 a[116:119], a[184:187], v[208:211], a[116:119]
s_waitcnt lgkmcnt(3)
buffer_load_dwordx4 v13, s[36:39], s64 offen lds
v_mfma_f32_16x16x32_bf16 a[120:123], a[192:195], v[208:211], a[120:123]
s_waitcnt lgkmcnt(2)
s_add_u32 m0, s86, 38912
s_add_u32 s64, s85, 311296
v_mul_f32 v242, v242, v22
v_mul_f32 v243, v243, v22
v_mfma_f32_16x16x32_bf16 a[120:123], a[196:199], v[212:215], a[120:123]
s_waitcnt lgkmcnt(0)
buffer_load_dwordx4 v12, s[36:39], s64 offen lds
v_mfma_f32_16x16x32_bf16 a[124:127], a[204:207], v[212:215], a[124:127]
s_add_u32 m0, s86, 39936
s_add_u32 s64, s85, 319488
v_mul_f32 v244, v244, v22
v_mul_f32 v245, v245, v22
v_mfma_f32_16x16x32_bf16 a[124:127], a[200:203], v[208:211], a[124:127]
buffer_load_dwordx4 v13, s[36:39], s64 offen lds
v_mul_f32 v246, v246, v22
v_mul_f32 v247, v247, v22
v_cvt_pk_bf16_f32 v240, v240, v241
v_cvt_pk_bf16_f32 v241, v242, v243
v_cvt_pk_bf16_f32 v242, v244, v245
v_cvt_pk_bf16_f32 v243, v246, v247
s_add_u32 s77, s75, 8192
buffer_store_dwordx4 v[240:243], v16, s[44:47], s77 offen sc1
v_accvgpr_read_b32 v23, a140
v_accvgpr_read_b32 v248, a141
v_add_f32 v23, v23, v248
v_max_f32 v1, v1, v23
v_rcp_f32 v23, v23
s_mov_b32 s66, 0x5d800000
v_cmp_le_f32 vcc, s66, v1
s_lshl_b32 s67, s30, 2
s_cmp_lg_u64 vcc, 0
s_cselect_b32 s66, 1, 0
v_mov_b32 v248, s67
v_mov_b32 v249, s66
ds_write_b32 v248, v249
v_accvgpr_read_b32 v232, a80
v_accvgpr_read_b32 v233, a81
v_accvgpr_read_b32 v234, a82
v_accvgpr_read_b32 v235, a83
v_accvgpr_read_b32 v236, a84
v_accvgpr_read_b32 v237, a85
v_accvgpr_read_b32 v238, a86
v_accvgpr_read_b32 v239, a87
v_pk_mul_f32 v[232:233], v[232:233], v[22:23] op_sel_hi:[1,0]
v_pk_mul_f32 v[234:235], v[234:235], v[22:23] op_sel_hi:[1,0]
v_pk_mul_f32 v[236:237], v[236:237], v[22:23] op_sel_hi:[1,0]
v_pk_mul_f32 v[238:239], v[238:239], v[22:23] op_sel_hi:[1,0]
v_cvt_pk_bf16_f32 v232, v232, v233
v_cvt_pk_bf16_f32 v233, v234, v235
v_cvt_pk_bf16_f32 v234, v236, v237
v_cvt_pk_bf16_f32 v235, v238, v239
s_add_u32 s77, s75, 16384
buffer_store_dwordx4 v[232:235], v16, s[44:47], s77 offen sc1
v_accvgpr_read_b32 v240, a88
v_accvgpr_read_b32 v241, a89
v_accvgpr_read_b32 v242, a90
v_accvgpr_read_b32 v243, a91
v_accvgpr_read_b32 v244, a92
v_accvgpr_read_b32 v245, a93
v_accvgpr_read_b32 v246, a94
v_accvgpr_read_b32 v247, a95
v_pk_mul_f32 v[240:241], v[240:241], v[22:23] op_sel_hi:[1,0]
v_pk_mul_f32 v[242:243], v[242:243], v[22:23] op_sel_hi:[1,0]
v_pk_mul_f32 v[244:245], v[244:245], v[22:23] op_sel_hi:[1,0]
v_pk_mul_f32 v[246:247], v[246:247], v[22:23] op_sel_hi:[1,0]
v_cvt_pk_bf16_f32 v240, v240, v241
v_cvt_pk_bf16_f32 v241, v242, v243
v_cvt_pk_bf16_f32 v242, v244, v245
v_cvt_pk_bf16_f32 v243, v246, v247
s_add_u32 s77, s75, 24576
buffer_store_dwordx4 v[240:243], v16, s[44:47], s77 offen sc1
v_accvgpr_read_b32 v232, a96
v_accvgpr_read_b32 v233, a97
v_accvgpr_read_b32 v234, a98
v_accvgpr_read_b32 v235, a99
v_accvgpr_read_b32 v236, a100
v_accvgpr_read_b32 v237, a101
v_accvgpr_read_b32 v238, a102
v_accvgpr_read_b32 v239, a103
v_mul_f32 v23, v23, v10
v_pk_mul_f32 v[232:233], v[232:233], v[22:23] op_sel:[0,1]
v_pk_mul_f32 v[234:235], v[234:235], v[22:23] op_sel:[0,1]
v_pk_mul_f32 v[236:237], v[236:237], v[22:23] op_sel:[0,1]
v_pk_mul_f32 v[238:239], v[238:239], v[22:23] op_sel:[0,1]
v_cvt_pk_bf16_f32 v232, v232, v233
v_cvt_pk_bf16_f32 v233, v234, v235
v_cvt_pk_bf16_f32 v234, v236, v237
v_cvt_pk_bf16_f32 v235, v238, v239
s_add_u32 s77, s75, 4096
buffer_store_dwordx4 v[232:235], v16, s[44:47], s77 offen sc1
v_accvgpr_read_b32 v240, a104
v_accvgpr_read_b32 v241, a105
v_accvgpr_read_b32 v242, a106
v_accvgpr_read_b32 v243, a107
v_accvgpr_read_b32 v244, a108
v_accvgpr_read_b32 v245, a109
v_accvgpr_read_b32 v246, a110
v_accvgpr_read_b32 v247, a111
v_pk_mul_f32 v[240:241], v[240:241], v[22:23] op_sel:[0,1]
v_pk_mul_f32 v[242:243], v[242:243], v[22:23] op_sel:[0,1]
v_pk_mul_f32 v[244:245], v[244:245], v[22:23] op_sel:[0,1]
v_pk_mul_f32 v[246:247], v[246:247], v[22:23] op_sel:[0,1]
v_cvt_pk_bf16_f32 v240, v240, v241
v_cvt_pk_bf16_f32 v241, v242, v243
v_cvt_pk_bf16_f32 v242, v244, v245
v_cvt_pk_bf16_f32 v243, v246, v247
s_add_u32 s77, s75, 12288
buffer_store_dwordx4 v[240:243], v16, s[44:47], s77 offen sc1
v_accvgpr_read_b32 v232, a112
v_accvgpr_read_b32 v233, a113
v_accvgpr_read_b32 v234, a114
v_accvgpr_read_b32 v235, a115
v_accvgpr_read_b32 v236, a116
v_accvgpr_read_b32 v237, a117
v_accvgpr_read_b32 v238, a118
v_accvgpr_read_b32 v239, a119
v_pk_mul_f32 v[232:233], v[232:233], v[22:23] op_sel:[0,1]
v_pk_mul_f32 v[234:235], v[234:235], v[22:23] op_sel:[0,1]
v_pk_mul_f32 v[236:237], v[236:237], v[22:23] op_sel:[0,1]
v_pk_mul_f32 v[238:239], v[238:239], v[22:23] op_sel:[0,1]
v_cvt_pk_bf16_f32 v232, v232, v233
v_cvt_pk_bf16_f32 v233, v234, v235
v_cvt_pk_bf16_f32 v234, v236, v237
v_cvt_pk_bf16_f32 v235, v238, v239
s_add_u32 s77, s75, 20480
buffer_store_dwordx4 v[232:235], v16, s[44:47], s77 offen sc1
v_accvgpr_read_b32 v240, a120
v_accvgpr_read_b32 v241, a121
v_accvgpr_read_b32 v242, a122
v_accvgpr_read_b32 v243, a123
v_accvgpr_read_b32 v244, a124
v_accvgpr_read_b32 v245, a125
v_accvgpr_read_b32 v246, a126
v_accvgpr_read_b32 v247, a127
v_pk_mul_f32 v[240:241], v[240:241], v[22:23] op_sel:[0,1]
v_pk_mul_f32 v[242:243], v[242:243], v[22:23] op_sel:[0,1]
v_pk_mul_f32 v[244:245], v[244:245], v[22:23] op_sel:[0,1]
v_pk_mul_f32 v[246:247], v[246:247], v[22:23] op_sel:[0,1]
v_cvt_pk_bf16_f32 v240, v240, v241
v_cvt_pk_bf16_f32 v241, v242, v243
v_cvt_pk_bf16_f32 v242, v244, v245
v_cvt_pk_bf16_f32 v243, v246, v247
s_add_u32 s77, s75, 28672
buffer_store_dwordx4 v[240:243], v16, s[44:47], s77 offen sc1
v_mov_b32 v248, 0
s_waitcnt lgkmcnt(0)
s_barrier
ds_read_b128 v[248:251], v248
v_xor_b32 v188, 128, v18
v_xor_b32 v189, 160, v18
v_xor_b32 v190, 192, v18
ds_read_b64_tr_b16 a[144:145], v188 offset:32768
ds_read_b64_tr_b16 a[146:147], v188 offset:36864
ds_read_b64_tr_b16 a[148:149], v188 offset:40960
ds_read_b64_tr_b16 a[150:151], v188 offset:45056
ds_read_b64_tr_b16 a[152:153], v189 offset:32768
ds_read_b64_tr_b16 a[154:155], v189 offset:36864
ds_read_b64_tr_b16 a[156:157], v189 offset:40960
ds_read_b64_tr_b16 a[158:159], v189 offset:45056
ds_read_b64_tr_b16 a[160:161], v190 offset:32768
ds_read_b64_tr_b16 a[162:163], v190 offset:36864
ds_read_b64_tr_b16 a[164:165], v190 offset:40960
ds_read_b64_tr_b16 a[166:167], v190 offset:45056
v_xor_b32 v191, 224, v18
v_xor_b32 v184, 0, v18
v_xor_b32 v185, 32, v18
v_xor_b32 v186, 64, v18
v_xor_b32 v187, 96, v18
s_waitcnt lgkmcnt(12)
v_or3_b32 v248, v248, v249, v250
v_or_b32 v248, v248, v251
s_nop 0
v_readfirstlane_b32 s66, v248
s_nop 0
s_cmp_gt_u32 s66, s73
s_cbranch_scc1 L_fallback_11
s_cmp_eq_u32 s83, 0
s_cbranch_scc1 L_p5f0
s_waitcnt lgkmcnt(10)
s_waitcnt vmcnt(28)
v_mfma_f32_16x16x32_bf16 v[136:139], a[144:147], a[232:235], 0
s_waitcnt vmcnt(24)
s_waitcnt lgkmcnt(8)
s_and_b32 s68, s82, 3
s_lshl_b32 s68, s68, 11
s_add_u32 m0, s86, 98304
ds_read_b64_tr_b16 a[168:169], v191 offset:32768
v_mfma_f32_16x16x32_bf16 v[136:139], a[148:151], a[236:239], v[136:139]
s_add_u32 s76, s86, s68
s_lshr_b32 s69, s87, 8
s_add_u32 s64, s85, 524288
ds_read_b64_tr_b16 a[170:171], v191 offset:36864
v_mfma_f32_16x16x32_bf16 v[104:107], a[148:151], a[228:231], 0
s_lshr_b32 s67, s82, 1
buffer_load_dwordx4 v12, s[36:39], s64 offen lds
v_mfma_f32_16x16x32_bf16 v[104:107], a[144:147], a[224:227], v[104:107]
s_xor_b32 s69, s69, s67
s_and_b32 s69, s69, 2
s_add_u32 m0, s86, 99328
s_add_u32 s64, s85, 532480
ds_read_b64_tr_b16 a[172:173], v191 offset:40960
v_mfma_f32_16x16x32_bf16 v[72:75], a[144:147], a[216:219], 0
s_and_b32 s71, s31, 4
buffer_load_dwordx4 v13, s[36:39], s64 offen lds
v_mfma_f32_16x16x32_bf16 v[72:75], a[148:151], a[220:223], v[72:75]
s_lshl_b32 s71, s71, 5
s_add_u32 s71, s71, s79
s_add_u32 m0, s86, 100352
s_add_u32 s64, s85, 540672
ds_read_b64_tr_b16 a[174:175], v191 offset:45056
v_mfma_f32_16x16x32_bf16 v[40:43], a[148:151], a[212:215], 0
s_add_u32 s71, s71, 4096
buffer_load_dwordx4 v12, s[36:39], s64 offen lds
v_mfma_f32_16x16x32_bf16 v[40:43], a[144:147], a[208:211], v[40:43]
s_waitcnt lgkmcnt(4)
s_add_u32 s72, s80, 4096
s_lshl_b32 s69, s69, 15
s_add_u32 m0, s86, 101376
s_add_u32 s64, s85, 548864
ds_read_b64_tr_b16 a[176:177], v184 offset:32768
v_mfma_f32_16x16x32_bf16 v[44:47], a[152:155], a[208:211], 0
s_add_u32 s68, s68, s69
buffer_load_dwordx4 v13, s[36:39], s64 offen lds
v_mfma_f32_16x16x32_bf16 v[44:47], a[156:159], a[212:215], v[44:47]
s_add_u32 m0, s86, 102400
ds_read_b64_tr_b16 a[178:179], v184 offset:36864
v_xor_b32 v192, 0x10000, v184
v_mfma_f32_16x16x32_bf16 v[76:79], a[156:159], a[220:223], 0
s_add_u32 s64, s85, 557056
ds_read_b64_tr_b16 a[180:181], v184 offset:40960
v_xor_b32 v193, 0x10000, v185
v_mfma_f32_16x16x32_bf16 v[76:79], a[152:155], a[216:219], v[76:79]
buffer_load_dwordx4 v12, s[36:39], s64 offen lds
v_mfma_f32_16x16x32_bf16 v[108:111], a[152:155], a[224:227], 0
s_add_u32 m0, s86, 103424
s_add_u32 s64, s85, 565248
ds_read_b64_tr_b16 a[182:183], v184 offset:45056
v_xor_b32 v194, 0x10000, v186
v_mfma_f32_16x16x32_bf16 v[108:111], a[156:159], a[228:231], v[108:111]
buffer_load_dwordx4 v13, s[36:39], s64 offen lds
v_mfma_f32_16x16x32_bf16 v[140:143], a[156:159], a[236:239], 0
s_add_u32 m0, s86, 104448
s_add_u32 s64, s85, 573440
ds_read_b64_tr_b16 a[184:185], v185 offset:32768
v_xor_b32 v195, 0x10000, v187
v_mfma_f32_16x16x32_bf16 v[140:143], a[152:155], a[232:235], v[140:143]
buffer_load_dwordx4 v12, s[36:39], s64 offen lds
v_mfma_f32_16x16x32_bf16 v[144:147], a[160:163], a[232:235], 0
s_add_u32 m0, s86, 105472
ds_read_b64_tr_b16 a[186:187], v185 offset:36864
v_xor_b32 v196, 0x10000, v188
v_mfma_f32_16x16x32_bf16 v[144:147], a[164:167], a[236:239], v[144:147]
s_add_u32 s64, s85, 581632
ds_read_b64_tr_b16 a[188:189], v185 offset:40960
v_xor_b32 v197, 0x10000, v189
v_mfma_f32_16x16x32_bf16 v[112:115], a[164:167], a[228:231], 0
buffer_load_dwordx4 v13, s[36:39], s64 offen lds
v_mfma_f32_16x16x32_bf16 v[112:115], a[160:163], a[224:227], v[112:115]
s_add_u32 s65, s84, 65536
ds_read_b64_tr_b16 a[190:191], v185 offset:45056
v_xor_b32 v198, 0x10000, v190
v_mfma_f32_16x16x32_bf16 v[80:83], a[160:163], a[216:219], 0
buffer_load_dwordx4 a[32:35], v14, s[44:47], s65 offen offset:0 sc1
v_mfma_f32_16x16x32_bf16 v[80:83], a[164:167], a[220:223], v[80:83]
ds_read_b64_tr_b16 a[192:193], v186 offset:32768
v_xor_b32 v199, 0x10000, v191
v_mfma_f32_16x16x32_bf16 v[48:51], a[164:167], a[212:215], 0
buffer_load_dwordx4 a[40:43], v14, s[44:47], s65 offen offset:1024 sc1
v_mfma_f32_16x16x32_bf16 v[48:51], a[160:163], a[208:211], v[48:51]
s_waitcnt lgkmcnt(4)
ds_read_b64_tr_b16 a[194:195], v186 offset:36864
v_mfma_f32_16x16x32_bf16 v[52:55], a[168:171], a[208:211], 0
ds_read_b64_tr_b16 a[196:197], v186 offset:40960
v_mfma_f32_16x16x32_bf16 v[52:55], a[172:175], a[212:215], v[52:55]
buffer_load_dwordx4 a[48:51], v15, s[44:47], s65 offen offset:0 sc1
v_mfma_f32_16x16x32_bf16 v[84:87], a[172:175], a[220:223], 0
ds_read_b64_tr_b16 a[198:199], v186 offset:45056
v_mfma_f32_16x16x32_bf16 v[84:87], a[168:171], a[216:219], v[84:87]
buffer_load_dwordx4 a[56:59], v15, s[44:47], s65 offen offset:1024 sc1
v_mfma_f32_16x16x32_bf16 v[116:119], a[168:171], a[224:227], 0
s_add_u32 s65, s84, 73728
ds_read_b64_tr_b16 a[200:201], v187 offset:32768
v_mfma_f32_16x16x32_bf16 v[116:119], a[172:175], a[228:231], v[116:119]
buffer_load_dwordx4 a[36:39], v14, s[44:47], s65 offen offset:0 sc1
v_mfma_f32_16x16x32_bf16 v[148:151], a[172:175], a[236:239], 0
ds_read_b64_tr_b16 a[202:203], v187 offset:36864
v_mfma_f32_16x16x32_bf16 v[148:151], a[168:171], a[232:235], v[148:151]
ds_read_b64_tr_b16 a[204:205], v187 offset:40960
v_mfma_f32_16x16x32_bf16 v[120:123], a[176:179], a[232:235], 0
buffer_load_dwordx4 a[44:47], v14, s[44:47], s65 offen offset:1024 sc1
v_mfma_f32_16x16x32_bf16 v[120:123], a[180:183], a[236:239], v[120:123]
ds_read_b64_tr_b16 a[206:207], v187 offset:45056
v_mfma_f32_16x16x32_bf16 v[88:91], a[180:183], a[228:231], 0
buffer_load_dwordx4 a[52:55], v15, s[44:47], s65 offen offset:0 sc1
v_mfma_f32_16x16x32_bf16 v[88:91], a[176:179], a[224:227], v[88:91]
v_mfma_f32_16x16x32_bf16 v[56:59], a[176:179], a[216:219], 0
buffer_load_dwordx4 a[60:63], v15, s[44:47], s65 offen offset:1024 sc1
v_mfma_f32_16x16x32_bf16 v[56:59], a[180:183], a[220:223], v[56:59]
v_mfma_f32_16x16x32_bf16 v[24:27], a[180:183], a[212:215], 0
v_mfma_f32_16x16x32_bf16 v[24:27], a[176:179], a[208:211], v[24:27]
s_waitcnt lgkmcnt(1)
buffer_load_dword v19, off, s[52:55], s72 sc1
v_mfma_f32_16x16x32_bf16 v[28:31], a[184:187], a[208:211], 0
s_add_u32 s85, s85, 2883584
s_lshl3_add_u32 s85, s68, s85
s_waitcnt vmcnt(24) lgkmcnt(0)
s_barrier
v_mfma_f32_16x16x32_bf16 v[28:31], a[188:191], a[212:215], v[28:31]
ds_read_b64_tr_b16 a[144:145], v196 offset:0
v_mfma_f32_16x16x32_bf16 v[60:63], a[188:191], a[220:223], 0
ds_read_b64_tr_b16 a[146:147], v196 offset:4096
v_mfma_f32_16x16x32_bf16 v[60:63], a[184:187], a[216:219], v[60:63]
s_xor_b32 m0, s76, 131072
ds_read_b64_tr_b16 a[148:149], v196 offset:8192
v_mfma_f32_16x16x32_bf16 v[92:95], a[184:187], a[224:227], 0
s_xor_b32 s64, s85, 0
ds_read_b64_tr_b16 a[150:151], v196 offset:12288
v_mfma_f32_16x16x32_bf16 v[92:95], a[188:191], a[228:231], v[92:95]
buffer_load_dwordx4 v12, s[40:43], s64 offen lds
v_mfma_f32_16x16x32_bf16 v[124:127], a[188:191], a[236:239], 0
s_xor_b32 m0, s76, 132096
ds_read_b64_tr_b16 a[152:153], v197 offset:0
v_mfma_f32_16x16x32_bf16 v[124:127], a[184:187], a[232:235], v[124:127]
s_xor_b32 s64, s85, 8192
ds_read_b64_tr_b16 a[154:155], v197 offset:4096
v_mfma_f32_16x16x32_bf16 v[128:131], a[192:195], a[232:235], 0
buffer_load_dwordx4 v13, s[40:43], s64 offen lds
v_mfma_f32_16x16x32_bf16 v[128:131], a[196:199], a[236:239], v[128:131]
ds_read_b64_tr_b16 a[156:157], v197 offset:8192
v_mfma_f32_16x16x32_bf16 v[96:99], a[196:199], a[228:231], 0
s_xor_b32 m0, s76, 133120
ds_read_b64_tr_b16 a[158:159], v197 offset:12288
v_mfma_f32_16x16x32_bf16 v[96:99], a[192:195], a[224:227], v[96:99]
s_xor_b32 s64, s85, 16384
ds_read_b64_tr_b16 a[160:161], v198 offset:0
v_mfma_f32_16x16x32_bf16 v[64:67], a[192:195], a[216:219], 0
buffer_load_dwordx4 v12, s[40:43], s64 offen lds
v_mfma_f32_16x16x32_bf16 v[64:67], a[196:199], a[220:223], v[64:67]
ds_read_b64_tr_b16 a[162:163], v198 offset:4096
v_mfma_f32_16x16x32_bf16 v[32:35], a[196:199], a[212:215], 0
s_xor_b32 m0, s76, 134144
ds_read_b64_tr_b16 a[164:165], v198 offset:8192
v_mfma_f32_16x16x32_bf16 v[32:35], a[192:195], a[208:211], v[32:35]
s_xor_b32 s64, s85, 24576
ds_read_b64_tr_b16 a[166:167], v198 offset:12288
v_mfma_f32_16x16x32_bf16 v[36:39], a[200:203], a[208:211], 0
buffer_load_dwordx4 v13, s[40:43], s64 offen lds
v_mfma_f32_16x16x32_bf16 v[36:39], a[204:207], a[212:215], v[36:39]
v_mfma_f32_16x16x32_bf16 v[68:71], a[204:207], a[220:223], 0
s_xor_b32 m0, s76, 135168
v_mfma_f32_16x16x32_bf16 v[68:71], a[200:203], a[216:219], v[68:71]
s_xor_b32 s64, s85, 32768
v_mfma_f32_16x16x32_bf16 v[100:103], a[200:203], a[224:227], 0
buffer_load_dwordx4 v12, s[40:43], s64 offen lds
v_mfma_f32_16x16x32_bf16 v[100:103], a[204:207], a[228:231], v[100:103]
v_mfma_f32_16x16x32_bf16 v[132:135], a[204:207], a[236:239], 0
v_mfma_f32_16x16x32_bf16 v[132:135], a[200:203], a[232:235], v[132:135]
s_waitcnt lgkmcnt(0)
v_mfma_f32_16x16x32_bf16 v[136:139], a[144:147], v[176:179], v[136:139]
s_waitcnt vmcnt(5)
v_readfirstlane_b32 vcc_lo, v19
s_nop 0
s_cmp_lt_u32 vcc_lo, 8
s_cbranch_scc1 L_spin_2016
L_spinbk_2017:
s_sub_u32 s84, s84, 688128
s_add_u32 s84, s84, s69
v_mfma_f32_16x16x32_bf16 v[136:139], a[148:151], v[180:183], v[136:139]
s_xor_b32 m0, s76, 136192
s_xor_b32 s64, s85, 40960
ds_read_b64_tr_b16 a[168:169], v199 offset:0
v_mfma_f32_16x16x32_bf16 v[104:107], a[148:151], v[172:175], v[104:107]
buffer_load_dwordx4 v13, s[40:43], s64 offen lds
v_mfma_f32_16x16x32_bf16 v[104:107], a[144:147], v[168:171], v[104:107]
s_xor_b32 m0, s76, 137216
ds_read_b64_tr_b16 a[170:171], v199 offset:4096
v_mfma_f32_16x16x32_bf16 v[72:75], a[144:147], v[160:163], v[72:75]
s_xor_b32 s64, s85, 49152
ds_read_b64_tr_b16 a[172:173], v199 offset:8192
v_mfma_f32_16x16x32_bf16 v[72:75], a[148:151], v[164:167], v[72:75]
buffer_load_dwordx4 v12, s[40:43], s64 offen lds
v_mfma_f32_16x16x32_bf16 v[40:43], a[148:151], v[156:159], v[40:43]
s_xor_b32 m0, s76, 138240
ds_read_b64_tr_b16 a[174:175], v199 offset:12288
v_mfma_f32_16x16x32_bf16 v[40:43], a[144:147], v[152:155], v[40:43]
s_xor_b32 s64, s85, 57344
ds_read_b64_tr_b16 a[176:177], v192 offset:0
v_mfma_f32_16x16x32_bf16 v[44:47], a[152:155], v[152:155], v[44:47]
buffer_load_dwordx4 v13, s[40:43], s64 offen lds
v_mfma_f32_16x16x32_bf16 v[44:47], a[156:159], v[156:159], v[44:47]
ds_read_b64_tr_b16 a[178:179], v192 offset:4096
v_mfma_f32_16x16x32_bf16 v[76:79], a[156:159], v[164:167], v[76:79]
ds_read_b64_tr_b16 a[180:181], v192 offset:8192
v_mfma_f32_16x16x32_bf16 v[76:79], a[152:155], v[160:163], v[76:79]
s_xor_b32 s65, s84, 0
ds_read_b64_tr_b16 a[182:183], v192 offset:12288
v_mfma_f32_16x16x32_bf16 v[108:111], a[152:155], v[168:171], v[108:111]
buffer_load_dwordx4 a[208:211], v14, s[44:47], s65 offen offset:0 sc1
v_mfma_f32_16x16x32_bf16 v[108:111], a[156:159], v[172:175], v[108:111]
ds_read_b64_tr_b16 a[184:185], v193 offset:0
v_mfma_f32_16x16x32_bf16 v[140:143], a[156:159], v[180:183], v[140:143]
ds_read_b64_tr_b16 a[186:187], v193 offset:4096
v_mfma_f32_16x16x32_bf16 v[140:143], a[152:155], v[176:179], v[140:143]
buffer_load_dwordx4 a[216:219], v14, s[44:47], s65 offen offset:1024 sc1
v_mfma_f32_16x16x32_bf16 v[144:147], a[160:163], v[176:179], v[144:147]
ds_read_b64_tr_b16 a[188:189], v193 offset:8192
v_mfma_f32_16x16x32_bf16 v[144:147], a[164:167], v[180:183], v[144:147]
ds_read_b64_tr_b16 a[190:191], v193 offset:12288
v_mfma_f32_16x16x32_bf16 v[112:115], a[164:167], v[172:175], v[112:115]
s_add_u32 s17, s78, L_p5loop-L_pc+0
buffer_load_dwordx4 a[224:227], v15, s[44:47], s65 offen offset:0 sc1
v_mfma_f32_16x16x32_bf16 v[112:115], a[160:163], v[168:171], v[112:115]
buffer_load_dword a252, v16, s[88:91], s17 offen
v_mfma_f32_16x16x32_bf16 v[80:83], a[160:163], v[160:163], v[80:83]
ds_read_b64_tr_b16 a[192:193], v194 offset:0
v_mfma_f32_16x16x32_bf16 v[80:83], a[164:167], v[164:167], v[80:83]
ds_read_b64_tr_b16 a[194:195], v194 offset:4096
v_mfma_f32_16x16x32_bf16 v[48:51], a[164:167], v[156:159], v[48:51]
buffer_load_dwordx4 a[232:235], v15, s[44:47], s65 offen offset:1024 sc1
v_mfma_f32_16x16x32_bf16 v[48:51], a[160:163], v[152:155], v[48:51]
s_waitcnt lgkmcnt(4)
ds_read_b64_tr_b16 a[196:197], v194 offset:8192
v_mfma_f32_16x16x32_bf16 v[52:55], a[168:171], v[152:155], v[52:55]
s_xor_b32 s65, s84, 8192
ds_read_b64_tr_b16 a[198:199], v194 offset:12288
v_mfma_f32_16x16x32_bf16 v[52:55], a[172:175], v[156:159], v[52:55]
s_add_u32 s17, s78, L_p5loop-L_pc+4096
buffer_load_dwordx4 a[212:215], v14, s[44:47], s65 offen offset:0 sc1
v_mfma_f32_16x16x32_bf16 v[84:87], a[172:175], v[164:167], v[84:87]
buffer_load_dword a252, v16, s[88:91], s17 offen
v_mfma_f32_16x16x32_bf16 v[84:87], a[168:171], v[160:163], v[84:87]
ds_read_b64_tr_b16 a[200:201], v195 offset:0
v_mfma_f32_16x16x32_bf16 v[116:119], a[168:171], v[168:171], v[116:119]
s_lshl_b32 s66, s30, 30
buffer_load_dwordx4 a[220:223], v14, s[44:47], s65 offen offset:1024 sc1
v_mfma_f32_16x16x32_bf16 v[116:119], a[172:175], v[172:175], v[116:119]
ds_read_b64_tr_b16 a[202:203], v195 offset:4096
v_lshl_add_u32 v1, v0, 24, s66
v_mfma_f32_16x16x32_bf16 v[148:151], a[172:175], v[180:183], v[148:151]
ds_read_b64_tr_b16 a[204:205], v195 offset:8192
v_mfma_f32_16x16x32_bf16 v[148:151], a[168:171], v[176:179], v[148:151]
ds_read_b64_tr_b16 a[206:207], v195 offset:12288
v_mfma_f32_16x16x32_bf16 v[120:123], a[176:179], v[176:179], v[120:123]
s_add_u32 s17, s78, L_p5loop-L_pc+8192
buffer_load_dwordx4 a[228:231], v15, s[44:47], s65 offen offset:0 sc1
v_mfma_f32_16x16x32_bf16 v[120:123], a[180:183], v[180:183], v[120:123]
buffer_load_dword a252, v16, s[88:91], s17 offen
v_mfma_f32_16x16x32_bf16 v[88:91], a[180:183], v[172:175], v[88:91]
v_mfma_f32_16x16x32_bf16 v[88:91], a[176:179], v[168:171], v[88:91]
buffer_load_dwordx4 a[236:239], v15, s[44:47], s65 offen offset:1024 sc1
v_mfma_f32_16x16x32_bf16 v[56:59], a[176:179], v[160:163], v[56:59]
v_mfma_f32_16x16x32_bf16 v[56:59], a[180:183], v[164:167], v[56:59]
v_mfma_f32_16x16x32_bf16 v[24:27], a[180:183], v[156:159], v[24:27]
v_mfma_f32_16x16x32_bf16 v[24:27], a[176:179], v[152:155], v[24:27]
v_mfma_f32_16x16x32_bf16 v[28:31], a[184:187], v[152:155], v[28:31]
s_waitcnt lgkmcnt(0)
s_barrier
v_mfma_f32_16x16x32_bf16 v[28:31], a[188:191], v[156:159], v[28:31]
s_mov_b64 exec, 1
buffer_atomic_add a251, v1, s[52:55], s71 offen offset:0 sc1
s_mov_b64 exec, -1
v_mfma_f32_16x16x32_bf16 v[60:63], a[188:191], v[164:167], v[60:63]
ds_read_b64_tr_b16 a[144:145], v188 offset:0
v_mfma_f32_16x16x32_bf16 v[60:63], a[184:187], v[160:163], v[60:63]
s_xor_b32 m0, s76, 32768
ds_read_b64_tr_b16 a[146:147], v188 offset:4096
v_mfma_f32_16x16x32_bf16 v[92:95], a[184:187], v[168:171], v[92:95]
s_xor_b32 s64, s85, 262144
ds_read_b64_tr_b16 a[148:149], v188 offset:8192
v_mfma_f32_16x16x32_bf16 v[92:95], a[188:191], v[172:175], v[92:95]
buffer_load_dwordx4 v12, s[40:43], s64 offen lds
v_mfma_f32_16x16x32_bf16 v[124:127], a[188:191], v[180:183], v[124:127]
s_xor_b32 m0, s76, 33792
ds_read_b64_tr_b16 a[150:151], v188 offset:12288
v_mfma_f32_16x16x32_bf16 v[124:127], a[184:187], v[176:179], v[124:127]
s_xor_b32 s64, s85, 270336
ds_read_b64_tr_b16 a[152:153], v189 offset:0
v_mfma_f32_16x16x32_bf16 v[128:131], a[192:195], v[176:179], v[128:131]
buffer_load_dwordx4 v13, s[40:43], s64 offen lds
v_mfma_f32_16x16x32_bf16 v[128:131], a[196:199], v[180:183], v[128:131]
ds_read_b64_tr_b16 a[154:155], v189 offset:4096
v_mfma_f32_16x16x32_bf16 v[96:99], a[196:199], v[172:175], v[96:99]
s_xor_b32 m0, s76, 34816
ds_read_b64_tr_b16 a[156:157], v189 offset:8192
v_mfma_f32_16x16x32_bf16 v[96:99], a[192:195], v[168:171], v[96:99]
s_xor_b32 s64, s85, 278528
ds_read_b64_tr_b16 a[158:159], v189 offset:12288
v_mfma_f32_16x16x32_bf16 v[64:67], a[192:195], v[160:163], v[64:67]
buffer_load_dwordx4 v12, s[40:43], s64 offen lds
v_mfma_f32_16x16x32_bf16 v[64:67], a[196:199], v[164:167], v[64:67]
ds_read_b64_tr_b16 a[160:161], v190 offset:0
v_mfma_f32_16x16x32_bf16 v[32:35], a[196:199], v[156:159], v[32:35]
s_xor_b32 m0, s76, 35840
ds_read_b64_tr_b16 a[162:163], v190 offset:4096
v_mfma_f32_16x16x32_bf16 v[32:35], a[192:195], v[152:155], v[32:35]
s_xor_b32 s64, s85, 286720
ds_read_b64_tr_b16 a[164:165], v190 offset:8192
v_mfma_f32_16x16x32_bf16 v[36:39], a[200:203], v[152:155], v[36:39]
buffer_load_dwordx4 v13, s[40:43], s64 offen lds
v_mfma_f32_16x16x32_bf16 v[36:39], a[204:207], v[156:159], v[36:39]
ds_read_b64_tr_b16 a[166:167], v190 offset:12288
v_mfma_f32_16x16x32_bf16 v[68:71], a[204:207], v[164:167], v[68:71]
s_xor_b32 m0, s76, 36864
v_mfma_f32_16x16x32_bf16 v[68:71], a[200:203], v[160:163], v[68:71]
s_xor_b32 s64, s85, 294912
v_mfma_f32_16x16x32_bf16 v[100:103], a[200:203], v[168:171], v[100:103]
buffer_load_dwordx4 v12, s[40:43], s64 offen lds
v_mfma_f32_16x16x32_bf16 v[100:103], a[204:207], v[172:175], v[100:103]
v_mfma_f32_16x16x32_bf16 v[132:135], a[204:207], v[180:183], v[132:135]
v_mfma_f32_16x16x32_bf16 v[132:135], a[200:203], v[176:179], v[132:135]
s_waitcnt lgkmcnt(1)
v_mfma_f32_16x16x32_bf16 v[136:139], a[144:147], a[56:59], v[136:139]
s_xor_b32 m0, s76, 37888
ds_read_b64_tr_b16 a[168:169], v191 offset:0
v_mfma_f32_16x16x32_bf16 v[136:139], a[148:151], a[60:63], v[136:139]
s_xor_b32 s64, s85, 303104
ds_read_b64_tr_b16 a[170:171], v191 offset:4096
v_mfma_f32_16x16x32_bf16 v[104:107], a[148:151], a[52:55], v[104:107]
buffer_load_dwordx4 v13, s[40:43], s64 offen lds
v_mfma_f32_16x16x32_bf16 v[104:107], a[144:147], a[48:51], v[104:107]
s_xor_b32 m0, s76, 38912
ds_read_b64_tr_b16 a[172:173], v191 offset:8192
v_mfma_f32_16x16x32_bf16 v[72:75], a[144:147], a[40:43], v[72:75]
s_xor_b32 s64, s85, 311296
ds_read_b64_tr_b16 a[174:175], v191 offset:12288
v_mfma_f32_16x16x32_bf16 v[72:75], a[148:151], a[44:47], v[72:75]
buffer_load_dwordx4 v12, s[40:43], s64 offen lds
v_mfma_f32_16x16x32_bf16 v[40:43], a[148:151], a[36:39], v[40:43]
s_xor_b32 m0, s76, 39936
ds_read_b64_tr_b16 a[176:177], v184 offset:0
v_mfma_f32_16x16x32_bf16 v[40:43], a[144:147], a[32:35], v[40:43]
s_xor_b32 s64, s85, 319488
ds_read_b64_tr_b16 a[178:179], v184 offset:4096
v_mfma_f32_16x16x32_bf16 v[44:47], a[152:155], a[32:35], v[44:47]
buffer_load_dwordx4 v13, s[40:43], s64 offen lds
v_mfma_f32_16x16x32_bf16 v[44:47], a[156:159], a[36:39], v[44:47]
ds_read_b64_tr_b16 a[180:181], v184 offset:8192
v_mfma_f32_16x16x32_bf16 v[76:79], a[156:159], a[44:47], v[76:79]
ds_read_b64_tr_b16 a[182:183], v184 offset:12288
v_mfma_f32_16x16x32_bf16 v[76:79], a[152:155], a[40:43], v[76:79]
s_xor_b32 s65, s84, 32768
ds_read_b64_tr_b16 a[184:185], v185 offset:0
v_mfma_f32_16x16x32_bf16 v[108:111], a[152:155], a[48:51], v[108:111]
buffer_load_dwordx4 v[152:155], v14, s[44:47], s65 offen offset:0 sc1
v_mfma_f32_16x16x32_bf16 v[108:111], a[156:159], a[52:55], v[108:111]
ds_read_b64_tr_b16 a[186:187], v185 offset:4096
v_mfma_f32_16x16x32_bf16 v[140:143], a[156:159], a[60:63], v[140:143]
ds_read_b64_tr_b16 a[188:189], v185 offset:8192
v_mfma_f32_16x16x32_bf16 v[140:143], a[152:155], a[56:59], v[140:143]
buffer_load_dwordx4 v[160:163], v14, s[44:47], s65 offen offset:1024 sc1
v_mfma_f32_16x16x32_bf16 v[144:147], a[160:163], a[56:59], v[144:147]
s_waitcnt lgkmcnt(5)
ds_read_b64_tr_b16 a[190:191], v185 offset:12288
v_mfma_f32_16x16x32_bf16 v[144:147], a[164:167], a[60:63], v[144:147]
v_mfma_f32_16x16x32_bf16 v[112:115], a[164:167], a[52:55], v[112:115]
buffer_load_dwordx4 v[168:171], v15, s[44:47], s65 offen offset:0 sc1
v_mfma_f32_16x16x32_bf16 v[112:115], a[160:163], a[48:51], v[112:115]
ds_read_b64_tr_b16 a[192:193], v186 offset:0
v_mfma_f32_16x16x32_bf16 v[80:83], a[160:163], a[40:43], v[80:83]
ds_read_b64_tr_b16 a[194:195], v186 offset:4096
v_mfma_f32_16x16x32_bf16 v[80:83], a[164:167], a[44:47], v[80:83]
ds_read_b64_tr_b16 a[196:197], v186 offset:8192
v_mfma_f32_16x16x32_bf16 v[48:51], a[164:167], a[36:39], v[48:51]
buffer_load_dwordx4 v[176:179], v15, s[44:47], s65 offen offset:1024 sc1
v_mfma_f32_16x16x32_bf16 v[48:51], a[160:163], a[32:35], v[48:51]
ds_read_b64_tr_b16 a[198:199], v186 offset:12288
v_mfma_f32_16x16x32_bf16 v[52:55], a[168:171], a[32:35], v[52:55]
s_xor_b32 s65, s84, 40960
v_mfma_f32_16x16x32_bf16 v[52:55], a[172:175], a[36:39], v[52:55]
buffer_load_dwordx4 v[156:159], v14, s[44:47], s65 offen offset:0 sc1
v_mfma_f32_16x16x32_bf16 v[84:87], a[172:175], a[44:47], v[84:87]
ds_read_b64_tr_b16 a[200:201], v187 offset:0
v_mfma_f32_16x16x32_bf16 v[84:87], a[168:171], a[40:43], v[84:87]
ds_read_b64_tr_b16 a[202:203], v187 offset:4096
v_mfma_f32_16x16x32_bf16 v[116:119], a[168:171], a[48:51], v[116:119]
buffer_load_dwordx4 v[164:167], v14, s[44:47], s65 offen offset:1024 sc1
v_mfma_f32_16x16x32_bf16 v[116:119], a[172:175], a[52:55], v[116:119]
ds_read_b64_tr_b16 a[204:205], v187 offset:8192
v_mfma_f32_16x16x32_bf16 v[148:151], a[172:175], a[60:63], v[148:151]
ds_read_b64_tr_b16 a[206:207], v187 offset:12288
v_mfma_f32_16x16x32_bf16 v[148:151], a[168:171], a[56:59], v[148:151]
v_mfma_f32_16x16x32_bf16 v[120:123], a[176:179], a[56:59], v[120:123]
s_waitcnt lgkmcnt(4)
buffer_load_dwordx4 v[172:175], v15, s[44:47], s65 offen offset:0 sc1
v_mfma_f32_16x16x32_bf16 v[120:123], a[180:183], a[60:63], v[120:123]
v_mfma_f32_16x16x32_bf16 v[88:91], a[180:183], a[52:55], v[88:91]
v_mfma_f32_16x16x32_bf16 v[88:91], a[176:179], a[48:51], v[88:91]
buffer_load_dwordx4 v[180:183], v15, s[44:47], s65 offen offset:1024 sc1
v_mfma_f32_16x16x32_bf16 v[56:59], a[176:179], a[40:43], v[56:59]
v_mfma_f32_16x16x32_bf16 v[56:59], a[180:183], a[44:47], v[56:59]
v_mfma_f32_16x16x32_bf16 v[24:27], a[180:183], a[36:39], v[24:27]
v_mfma_f32_16x16x32_bf16 v[24:27], a[176:179], a[32:35], v[24:27]
v_mfma_f32_16x16x32_bf16 v[28:31], a[184:187], a[32:35], v[28:31]
s_waitcnt vmcnt(28)
s_barrier
v_mfma_f32_16x16x32_bf16 v[28:31], a[188:191], a[36:39], v[28:31]
ds_read_b64_tr_b16 a[144:145], v188 offset:32768
v_mfma_f32_16x16x32_bf16 v[60:63], a[188:191], a[44:47], v[60:63]
ds_read_b64_tr_b16 a[146:147], v188 offset:36864
v_mfma_f32_16x16x32_bf16 v[60:63], a[184:187], a[40:43], v[60:63]
s_xor_b32 m0, s76, 65536
ds_read_b64_tr_b16 a[148:149], v188 offset:40960
v_mfma_f32_16x16x32_bf16 v[92:95], a[184:187], a[48:51], v[92:95]
s_xor_b32 s64, s85, 524288
ds_read_b64_tr_b16 a[150:151], v188 offset:45056
v_mfma_f32_16x16x32_bf16 v[92:95], a[188:191], a[52:55], v[92:95]
buffer_load_dwordx4 v12, s[40:43], s64 offen lds
v_mfma_f32_16x16x32_bf16 v[124:127], a[188:191], a[60:63], v[124:127]
s_xor_b32 m0, s76, 66560
ds_read_b64_tr_b16 a[152:153], v189 offset:32768
v_mfma_f32_16x16x32_bf16 v[124:127], a[184:187], a[56:59], v[124:127]
s_xor_b32 s64, s85, 532480
ds_read_b64_tr_b16 a[154:155], v189 offset:36864
v_mfma_f32_16x16x32_bf16 v[128:131], a[192:195], a[56:59], v[128:131]
buffer_load_dwordx4 v13, s[40:43], s64 offen lds
v_mfma_f32_16x16x32_bf16 v[128:131], a[196:199], a[60:63], v[128:131]
ds_read_b64_tr_b16 a[156:157], v189 offset:40960
v_mfma_f32_16x16x32_bf16 v[96:99], a[196:199], a[52:55], v[96:99]
s_xor_b32 m0, s76, 67584
ds_read_b64_tr_b16 a[158:159], v189 offset:45056
v_mfma_f32_16x16x32_bf16 v[96:99], a[192:195], a[48:51], v[96:99]
s_xor_b32 s64, s85, 540672
ds_read_b64_tr_b16 a[160:161], v190 offset:32768
v_mfma_f32_16x16x32_bf16 v[64:67], a[192:195], a[40:43], v[64:67]
buffer_load_dwordx4 v12, s[40:43], s64 offen lds
v_mfma_f32_16x16x32_bf16 v[64:67], a[196:199], a[44:47], v[64:67]
ds_read_b64_tr_b16 a[162:163], v190 offset:36864
v_mfma_f32_16x16x32_bf16 v[32:35], a[196:199], a[36:39], v[32:35]
s_xor_b32 m0, s76, 68608
ds_read_b64_tr_b16 a[164:165], v190 offset:40960
v_mfma_f32_16x16x32_bf16 v[32:35], a[192:195], a[32:35], v[32:35]
s_waitcnt lgkmcnt(5)
s_xor_b32 s64, s85, 548864
ds_read_b64_tr_b16 a[166:167], v190 offset:45056
v_mfma_f32_16x16x32_bf16 v[36:39], a[200:203], a[32:35], v[36:39]
buffer_load_dwordx4 v13, s[40:43], s64 offen lds
v_mfma_f32_16x16x32_bf16 v[36:39], a[204:207], a[36:39], v[36:39]
v_mfma_f32_16x16x32_bf16 v[68:71], a[204:207], a[44:47], v[68:71]
s_xor_b32 m0, s76, 69632
v_mfma_f32_16x16x32_bf16 v[68:71], a[200:203], a[40:43], v[68:71]
s_xor_b32 s64, s85, 557056
v_mfma_f32_16x16x32_bf16 v[100:103], a[200:203], a[48:51], v[100:103]
buffer_load_dwordx4 v12, s[40:43], s64 offen lds
v_mfma_f32_16x16x32_bf16 v[100:103], a[204:207], a[52:55], v[100:103]
s_mov_b32 s70, 3
s_mov_b32 s73, 2
v_mfma_f32_16x16x32_bf16 v[132:135], a[204:207], a[60:63], v[132:135]
v_mfma_f32_16x16x32_bf16 v[132:135], a[200:203], a[56:59], v[132:135]
L_p5join:
.p2align 3
L_p5loop:
s_waitcnt lgkmcnt(10)
s_waitcnt vmcnt(19)
v_mfma_f32_16x16x32_bf16 v[136:139], a[144:147], a[232:235], v[136:139]
s_waitcnt vmcnt(15)
s_waitcnt lgkmcnt(8)
s_xor_b32 m0, s76, 70656
s_xor_b32 s64, s85, 565248
ds_read_b64_tr_b16 a[168:169], v191 offset:32768
v_mfma_f32_16x16x32_bf16 v[136:139], a[148:151], a[236:239], v[136:139]
buffer_load_dwordx4 v13, s[40:43], s64 offen lds
v_mfma_f32_16x16x32_bf16 v[104:107], a[148:151], a[228:231], v[104:107]
s_xor_b32 m0, s76, 71680
ds_read_b64_tr_b16 a[170:171], v191 offset:36864
v_mfma_f32_16x16x32_bf16 v[104:107], a[144:147], a[224:227], v[104:107]
s_xor_b32 s64, s85, 573440
ds_read_b64_tr_b16 a[172:173], v191 offset:40960
v_mfma_f32_16x16x32_bf16 v[72:75], a[144:147], a[216:219], v[72:75]
buffer_load_dwordx4 v12, s[40:43], s64 offen lds
v_mfma_f32_16x16x32_bf16 v[72:75], a[148:151], a[220:223], v[72:75]
s_xor_b32 m0, s76, 72704
ds_read_b64_tr_b16 a[174:175], v191 offset:45056
v_mfma_f32_16x16x32_bf16 v[40:43], a[148:151], a[212:215], v[40:43]
s_xor_b32 s64, s85, 581632
ds_read_b64_tr_b16 a[176:177], v184 offset:32768
v_mfma_f32_16x16x32_bf16 v[40:43], a[144:147], a[208:211], v[40:43]
s_waitcnt lgkmcnt(5)
buffer_load_dwordx4 v13, s[40:43], s64 offen lds
v_mfma_f32_16x16x32_bf16 v[44:47], a[152:155], a[208:211], v[44:47]
ds_read_b64_tr_b16 a[178:179], v184 offset:36864
v_mfma_f32_16x16x32_bf16 v[44:47], a[156:159], a[212:215], v[44:47]
ds_read_b64_tr_b16 a[180:181], v184 offset:40960
v_mfma_f32_16x16x32_bf16 v[76:79], a[156:159], a[220:223], v[76:79]
s_xor_b32 s65, s84, 65536
ds_read_b64_tr_b16 a[182:183], v184 offset:45056
v_mfma_f32_16x16x32_bf16 v[76:79], a[152:155], a[216:219], v[76:79]
buffer_load_dwordx4 a[0:3], v14, s[44:47], s65 offen offset:0 sc1
v_mfma_f32_16x16x32_bf16 v[108:111], a[152:155], a[224:227], v[108:111]
ds_read_b64_tr_b16 a[184:185], v185 offset:32768
v_mfma_f32_16x16x32_bf16 v[108:111], a[156:159], a[228:231], v[108:111]
ds_read_b64_tr_b16 a[186:187], v185 offset:36864
v_mfma_f32_16x16x32_bf16 v[140:143], a[156:159], a[236:239], v[140:143]
buffer_load_dwordx4 a[8:11], v14, s[44:47], s65 offen offset:1024 sc1
v_mfma_f32_16x16x32_bf16 v[140:143], a[152:155], a[232:235], v[140:143]
ds_read_b64_tr_b16 a[188:189], v185 offset:40960
v_mfma_f32_16x16x32_bf16 v[144:147], a[160:163], a[232:235], v[144:147]
ds_read_b64_tr_b16 a[190:191], v185 offset:45056
v_mfma_f32_16x16x32_bf16 v[144:147], a[164:167], a[236:239], v[144:147]
v_mfma_f32_16x16x32_bf16 v[112:115], a[164:167], a[228:231], v[112:115]
buffer_load_dwordx4 a[16:19], v15, s[44:47], s65 offen offset:0 sc1
v_mfma_f32_16x16x32_bf16 v[112:115], a[160:163], a[224:227], v[112:115]
ds_read_b64_tr_b16 a[192:193], v186 offset:32768
v_mfma_f32_16x16x32_bf16 v[80:83], a[160:163], a[216:219], v[80:83]
ds_read_b64_tr_b16 a[194:195], v186 offset:36864
v_mfma_f32_16x16x32_bf16 v[80:83], a[164:167], a[220:223], v[80:83]
buffer_load_dwordx4 a[24:27], v15, s[44:47], s65 offen offset:1024 sc1
v_mfma_f32_16x16x32_bf16 v[48:51], a[164:167], a[212:215], v[48:51]
ds_read_b64_tr_b16 a[196:197], v186 offset:40960
v_mfma_f32_16x16x32_bf16 v[48:51], a[160:163], a[208:211], v[48:51]
s_waitcnt lgkmcnt(4)
ds_read_b64_tr_b16 a[198:199], v186 offset:45056
v_mfma_f32_16x16x32_bf16 v[52:55], a[168:171], a[208:211], v[52:55]
s_xor_b32 s65, s84, 73728
v_mfma_f32_16x16x32_bf16 v[52:55], a[172:175], a[212:215], v[52:55]
buffer_load_dwordx4 a[4:7], v14, s[44:47], s65 offen offset:0 sc1
v_mfma_f32_16x16x32_bf16 v[84:87], a[172:175], a[220:223], v[84:87]
ds_read_b64_tr_b16 a[200:201], v187 offset:32768
v_mfma_f32_16x16x32_bf16 v[84:87], a[168:171], a[216:219], v[84:87]
ds_read_b64_tr_b16 a[202:203], v187 offset:36864
v_mfma_f32_16x16x32_bf16 v[116:119], a[168:171], a[224:227], v[116:119]
buffer_load_dwordx4 a[12:15], v14, s[44:47], s65 offen offset:1024 sc1
v_mfma_f32_16x16x32_bf16 v[116:119], a[172:175], a[228:231], v[116:119]
ds_read_b64_tr_b16 a[204:205], v187 offset:40960
v_mfma_f32_16x16x32_bf16 v[148:151], a[172:175], a[236:239], v[148:151]
ds_read_b64_tr_b16 a[206:207], v187 offset:45056
v_mfma_f32_16x16x32_bf16 v[148:151], a[168:171], a[232:235], v[148:151]
v_mfma_f32_16x16x32_bf16 v[120:123], a[176:179], a[232:235], v[120:123]
buffer_load_dwordx4 a[20:23], v15, s[44:47], s65 offen offset:0 sc1
v_mfma_f32_16x16x32_bf16 v[120:123], a[180:183], a[236:239], v[120:123]
v_mfma_f32_16x16x32_bf16 v[88:91], a[180:183], a[228:231], v[88:91]
v_mfma_f32_16x16x32_bf16 v[88:91], a[176:179], a[224:227], v[88:91]
buffer_load_dwordx4 a[28:31], v15, s[44:47], s65 offen offset:1024 sc1
v_mfma_f32_16x16x32_bf16 v[56:59], a[176:179], a[216:219], v[56:59]
v_mfma_f32_16x16x32_bf16 v[56:59], a[180:183], a[220:223], v[56:59]
v_mfma_f32_16x16x32_bf16 v[24:27], a[180:183], a[212:215], v[24:27]
v_mfma_f32_16x16x32_bf16 v[24:27], a[176:179], a[208:211], v[24:27]
v_mfma_f32_16x16x32_bf16 v[28:31], a[184:187], a[208:211], v[28:31]
s_waitcnt vmcnt(24)
s_barrier
s_waitcnt lgkmcnt(0)
v_mfma_f32_16x16x32_bf16 v[28:31], a[188:191], a[212:215], v[28:31]
s_xor_b32 m0, s76, 98304
ds_read_b64_tr_b16 a[144:145], v196 offset:0
v_mfma_f32_16x16x32_bf16 v[60:63], a[188:191], a[220:223], v[60:63]
s_xor_b32 s64, s85, 786432
ds_read_b64_tr_b16 a[146:147], v196 offset:4096
v_mfma_f32_16x16x32_bf16 v[60:63], a[184:187], a[216:219], v[60:63]
buffer_load_dwordx4 v12, s[40:43], s64 offen lds
v_mfma_f32_16x16x32_bf16 v[92:95], a[184:187], a[224:227], v[92:95]
ds_read_b64_tr_b16 a[148:149], v196 offset:8192
v_mfma_f32_16x16x32_bf16 v[92:95], a[188:191], a[228:231], v[92:95]
s_xor_b32 m0, s76, 99328
ds_read_b64_tr_b16 a[150:151], v196 offset:12288
v_mfma_f32_16x16x32_bf16 v[124:127], a[188:191], a[236:239], v[124:127]
s_xor_b32 s64, s85, 794624
ds_read_b64_tr_b16 a[152:153], v197 offset:0
v_mfma_f32_16x16x32_bf16 v[124:127], a[184:187], a[232:235], v[124:127]
buffer_load_dwordx4 v13, s[40:43], s64 offen lds
v_mfma_f32_16x16x32_bf16 v[128:131], a[192:195], a[232:235], v[128:131]
ds_read_b64_tr_b16 a[154:155], v197 offset:4096
v_mfma_f32_16x16x32_bf16 v[128:131], a[196:199], a[236:239], v[128:131]
s_xor_b32 m0, s76, 100352
ds_read_b64_tr_b16 a[156:157], v197 offset:8192
v_mfma_f32_16x16x32_bf16 v[96:99], a[196:199], a[228:231], v[96:99]
s_xor_b32 s64, s85, 802816
ds_read_b64_tr_b16 a[158:159], v197 offset:12288
v_mfma_f32_16x16x32_bf16 v[96:99], a[192:195], a[224:227], v[96:99]
buffer_load_dwordx4 v12, s[40:43], s64 offen lds
v_mfma_f32_16x16x32_bf16 v[64:67], a[192:195], a[216:219], v[64:67]
ds_read_b64_tr_b16 a[160:161], v198 offset:0
v_mfma_f32_16x16x32_bf16 v[64:67], a[196:199], a[220:223], v[64:67]
s_xor_b32 m0, s76, 101376
ds_read_b64_tr_b16 a[162:163], v198 offset:4096
v_mfma_f32_16x16x32_bf16 v[32:35], a[196:199], a[212:215], v[32:35]
s_xor_b32 s64, s85, 811008
ds_read_b64_tr_b16 a[164:165], v198 offset:8192
v_mfma_f32_16x16x32_bf16 v[32:35], a[192:195], a[208:211], v[32:35]
buffer_load_dwordx4 v13, s[40:43], s64 offen lds
v_mfma_f32_16x16x32_bf16 v[36:39], a[200:203], a[208:211], v[36:39]
ds_read_b64_tr_b16 a[166:167], v198 offset:12288
v_mfma_f32_16x16x32_bf16 v[36:39], a[204:207], a[212:215], v[36:39]
s_xor_b32 m0, s76, 102400
v_mfma_f32_16x16x32_bf16 v[68:71], a[204:207], a[220:223], v[68:71]
s_xor_b32 s64, s85, 819200
v_mfma_f32_16x16x32_bf16 v[68:71], a[200:203], a[216:219], v[68:71]
buffer_load_dwordx4 v12, s[40:43], s64 offen lds
v_mfma_f32_16x16x32_bf16 v[100:103], a[200:203], a[224:227], v[100:103]
v_mfma_f32_16x16x32_bf16 v[100:103], a[204:207], a[228:231], v[100:103]
v_mfma_f32_16x16x32_bf16 v[132:135], a[204:207], a[236:239], v[132:135]
v_mfma_f32_16x16x32_bf16 v[132:135], a[200:203], a[232:235], v[132:135]
s_waitcnt vmcnt(25)
s_waitcnt lgkmcnt(1)
s_xor_b32 m0, s76, 103424
buffer_load_dword v19, off, s[52:55], s72 offset:128 sc1
v_mfma_f32_16x16x32_bf16 v[136:139], a[144:147], v[176:179], v[136:139]
s_waitcnt vmcnt(22)
s_xor_b32 s64, s85, 827392
ds_read_b64_tr_b16 a[168:169], v199 offset:0
v_mfma_f32_16x16x32_bf16 v[136:139], a[148:151], v[180:183], v[136:139]
buffer_load_dwordx4 v13, s[40:43], s64 offen lds
v_mfma_f32_16x16x32_bf16 v[104:107], a[148:151], v[172:175], v[104:107]
s_xor_b32 m0, s76, 104448
ds_read_b64_tr_b16 a[170:171], v199 offset:4096
v_mfma_f32_16x16x32_bf16 v[104:107], a[144:147], v[168:171], v[104:107]
s_xor_b32 s64, s85, 835584
ds_read_b64_tr_b16 a[172:173], v199 offset:8192
v_mfma_f32_16x16x32_bf16 v[72:75], a[144:147], v[160:163], v[72:75]
buffer_load_dwordx4 v12, s[40:43], s64 offen lds
v_mfma_f32_16x16x32_bf16 v[72:75], a[148:151], v[164:167], v[72:75]
s_xor_b32 m0, s76, 105472
ds_read_b64_tr_b16 a[174:175], v199 offset:12288
v_mfma_f32_16x16x32_bf16 v[40:43], a[148:151], v[156:159], v[40:43]
s_xor_b32 s64, s85, 843776
ds_read_b64_tr_b16 a[176:177], v192 offset:0
v_mfma_f32_16x16x32_bf16 v[40:43], a[144:147], v[152:155], v[40:43]
buffer_load_dwordx4 v13, s[40:43], s64 offen lds
v_mfma_f32_16x16x32_bf16 v[44:47], a[152:155], v[152:155], v[44:47]
ds_read_b64_tr_b16 a[178:179], v192 offset:4096
v_mfma_f32_16x16x32_bf16 v[44:47], a[156:159], v[156:159], v[44:47]
ds_read_b64_tr_b16 a[180:181], v192 offset:8192
v_mfma_f32_16x16x32_bf16 v[76:79], a[156:159], v[164:167], v[76:79]
s_xor_b32 s65, s84, 98304
ds_read_b64_tr_b16 a[182:183], v192 offset:12288
v_mfma_f32_16x16x32_bf16 v[76:79], a[152:155], v[160:163], v[76:79]
buffer_load_dwordx4 a[32:35], v14, s[44:47], s65 offen offset:0 sc1
v_mfma_f32_16x16x32_bf16 v[108:111], a[152:155], v[168:171], v[108:111]
ds_read_b64_tr_b16 a[184:185], v193 offset:0
v_mfma_f32_16x16x32_bf16 v[108:111], a[156:159], v[172:175], v[108:111]
ds_read_b64_tr_b16 a[186:187], v193 offset:4096
v_mfma_f32_16x16x32_bf16 v[140:143], a[156:159], v[180:183], v[140:143]
buffer_load_dwordx4 a[40:43], v14, s[44:47], s65 offen offset:1024 sc1
v_mfma_f32_16x16x32_bf16 v[140:143], a[152:155], v[176:179], v[140:143]
ds_read_b64_tr_b16 a[188:189], v193 offset:8192
v_mfma_f32_16x16x32_bf16 v[144:147], a[160:163], v[176:179], v[144:147]
s_waitcnt lgkmcnt(5)
s_lshl_b32 s75, s73, 20
s_add_u32 s85, s85, s75
ds_read_b64_tr_b16 a[190:191], v193 offset:12288
v_mfma_f32_16x16x32_bf16 v[144:147], a[164:167], v[180:183], v[144:147]
s_lshr_b32 s74, s73, 28
s_and_b32 s74, s74, 8
v_mfma_f32_16x16x32_bf16 v[112:115], a[164:167], v[172:175], v[112:115]
buffer_load_dwordx4 a[48:51], v15, s[44:47], s65 offen offset:0 sc1
v_mfma_f32_16x16x32_bf16 v[112:115], a[160:163], v[168:171], v[112:115]
ds_read_b64_tr_b16 a[192:193], v194 offset:0
v_mfma_f32_16x16x32_bf16 v[80:83], a[160:163], v[160:163], v[80:83]
ds_read_b64_tr_b16 a[194:195], v194 offset:4096
v_mfma_f32_16x16x32_bf16 v[80:83], a[164:167], v[164:167], v[80:83]
buffer_load_dwordx4 a[56:59], v15, s[44:47], s65 offen offset:1024 sc1
v_mfma_f32_16x16x32_bf16 v[48:51], a[164:167], v[156:159], v[48:51]
ds_read_b64_tr_b16 a[196:197], v194 offset:8192
v_mfma_f32_16x16x32_bf16 v[48:51], a[160:163], v[152:155], v[48:51]
ds_read_b64_tr_b16 a[198:199], v194 offset:12288
v_mfma_f32_16x16x32_bf16 v[52:55], a[168:171], v[152:155], v[52:55]
s_xor_b32 s65, s84, 106496
v_mfma_f32_16x16x32_bf16 v[52:55], a[172:175], v[156:159], v[52:55]
buffer_load_dwordx4 a[36:39], v14, s[44:47], s65 offen offset:0 sc1
v_mfma_f32_16x16x32_bf16 v[84:87], a[172:175], v[164:167], v[84:87]
ds_read_b64_tr_b16 a[200:201], v195 offset:0
v_mfma_f32_16x16x32_bf16 v[84:87], a[168:171], v[160:163], v[84:87]
ds_read_b64_tr_b16 a[202:203], v195 offset:4096
v_mfma_f32_16x16x32_bf16 v[116:119], a[168:171], v[168:171], v[116:119]
buffer_load_dwordx4 a[44:47], v14, s[44:47], s65 offen offset:1024 sc1
v_mfma_f32_16x16x32_bf16 v[116:119], a[172:175], v[172:175], v[116:119]
ds_read_b64_tr_b16 a[204:205], v195 offset:8192
v_mfma_f32_16x16x32_bf16 v[148:151], a[172:175], v[180:183], v[148:151]
ds_read_b64_tr_b16 a[206:207], v195 offset:12288
v_mfma_f32_16x16x32_bf16 v[148:151], a[168:171], v[176:179], v[148:151]
v_mfma_f32_16x16x32_bf16 v[120:123], a[176:179], v[176:179], v[120:123]
s_waitcnt lgkmcnt(4)
buffer_load_dwordx4 a[52:55], v15, s[44:47], s65 offen offset:0 sc1
v_mfma_f32_16x16x32_bf16 v[120:123], a[180:183], v[180:183], v[120:123]
v_mfma_f32_16x16x32_bf16 v[88:91], a[180:183], v[172:175], v[88:91]
v_mfma_f32_16x16x32_bf16 v[88:91], a[176:179], v[168:171], v[88:91]
buffer_load_dwordx4 a[60:63], v15, s[44:47], s65 offen offset:1024 sc1
v_mfma_f32_16x16x32_bf16 v[56:59], a[176:179], v[160:163], v[56:59]
v_mfma_f32_16x16x32_bf16 v[56:59], a[180:183], v[164:167], v[56:59]
v_mfma_f32_16x16x32_bf16 v[24:27], a[180:183], v[156:159], v[24:27]
v_mfma_f32_16x16x32_bf16 v[24:27], a[176:179], v[152:155], v[24:27]
v_mfma_f32_16x16x32_bf16 v[28:31], a[184:187], v[152:155], v[28:31]
s_waitcnt vmcnt(25)
s_barrier
v_mfma_f32_16x16x32_bf16 v[28:31], a[188:191], v[156:159], v[28:31]
s_xor_b32 m0, s76, 131072
ds_read_b64_tr_b16 a[144:145], v196 offset:32768
v_mfma_f32_16x16x32_bf16 v[60:63], a[188:191], v[164:167], v[60:63]
s_xor_b32 s64, s85, 0
ds_read_b64_tr_b16 a[146:147], v196 offset:36864
v_mfma_f32_16x16x32_bf16 v[60:63], a[184:187], v[160:163], v[60:63]
buffer_load_dwordx4 v12, s[40:43], s64 offen lds
v_mfma_f32_16x16x32_bf16 v[92:95], a[184:187], v[168:171], v[92:95]
s_lshl_b32 s75, s73, 17
s_add_u32 s84, s84, s75
ds_read_b64_tr_b16 a[148:149], v196 offset:40960
v_mfma_f32_16x16x32_bf16 v[92:95], a[188:191], v[172:175], v[92:95]
s_xor_b32 m0, s76, 132096
ds_read_b64_tr_b16 a[150:151], v196 offset:45056
v_mfma_f32_16x16x32_bf16 v[124:127], a[188:191], v[180:183], v[124:127]
s_xor_b32 s64, s85, 8192
ds_read_b64_tr_b16 a[152:153], v197 offset:32768
v_mfma_f32_16x16x32_bf16 v[124:127], a[184:187], v[176:179], v[124:127]
buffer_load_dwordx4 v13, s[40:43], s64 offen lds
v_mfma_f32_16x16x32_bf16 v[128:131], a[192:195], v[176:179], v[128:131]
ds_read_b64_tr_b16 a[154:155], v197 offset:36864
v_mfma_f32_16x16x32_bf16 v[128:131], a[196:199], v[180:183], v[128:131]
s_xor_b32 m0, s76, 133120
ds_read_b64_tr_b16 a[156:157], v197 offset:40960
v_mfma_f32_16x16x32_bf16 v[96:99], a[196:199], v[172:175], v[96:99]
s_xor_b32 s64, s85, 16384
ds_read_b64_tr_b16 a[158:159], v197 offset:45056
v_mfma_f32_16x16x32_bf16 v[96:99], a[192:195], v[168:171], v[96:99]
buffer_load_dwordx4 v12, s[40:43], s64 offen lds
v_mfma_f32_16x16x32_bf16 v[64:67], a[192:195], v[160:163], v[64:67]
ds_read_b64_tr_b16 a[160:161], v198 offset:32768
v_mfma_f32_16x16x32_bf16 v[64:67], a[196:199], v[164:167], v[64:67]
s_xor_b32 m0, s76, 134144
ds_read_b64_tr_b16 a[162:163], v198 offset:36864
v_mfma_f32_16x16x32_bf16 v[32:35], a[196:199], v[156:159], v[32:35]
s_xor_b32 s64, s85, 24576
ds_read_b64_tr_b16 a[164:165], v198 offset:40960
v_mfma_f32_16x16x32_bf16 v[32:35], a[192:195], v[152:155], v[32:35]
s_waitcnt lgkmcnt(6)
buffer_load_dwordx4 v13, s[40:43], s64 offen lds
v_mfma_f32_16x16x32_bf16 v[36:39], a[200:203], v[152:155], v[36:39]
ds_read_b64_tr_b16 a[166:167], v198 offset:45056
v_mfma_f32_16x16x32_bf16 v[36:39], a[204:207], v[156:159], v[36:39]
s_xor_b32 m0, s76, 135168
v_mfma_f32_16x16x32_bf16 v[68:71], a[204:207], v[164:167], v[68:71]
s_xor_b32 s64, s85, 32768
v_mfma_f32_16x16x32_bf16 v[68:71], a[200:203], v[160:163], v[68:71]
buffer_load_dwordx4 v12, s[40:43], s64 offen lds
v_mfma_f32_16x16x32_bf16 v[100:103], a[200:203], v[168:171], v[100:103]
v_mfma_f32_16x16x32_bf16 v[100:103], a[204:207], v[172:175], v[100:103]
v_mfma_f32_16x16x32_bf16 v[132:135], a[204:207], v[180:183], v[132:135]
v_mfma_f32_16x16x32_bf16 v[132:135], a[200:203], v[176:179], v[132:135]
s_waitcnt vmcnt(26)
v_mfma_f32_16x16x32_bf16 v[136:139], a[144:147], a[24:27], v[136:139]
s_waitcnt vmcnt(16)
v_readfirstlane_b32 vcc_lo, v19
s_nop 0
s_cmp_lt_u32 vcc_lo, s74
s_cbranch_scc1 L_spin_4022
L_spinbk_4023:
v_mfma_f32_16x16x32_bf16 v[136:139], a[148:151], a[28:31], v[136:139]
s_xor_b32 m0, s76, 136192
ds_read_b64_tr_b16 a[168:169], v199 offset:32768
v_mfma_f32_16x16x32_bf16 v[104:107], a[148:151], a[20:23], v[104:107]
s_xor_b32 s64, s85, 40960
ds_read_b64_tr_b16 a[170:171], v199 offset:36864
v_mfma_f32_16x16x32_bf16 v[104:107], a[144:147], a[16:19], v[104:107]
buffer_load_dwordx4 v13, s[40:43], s64 offen lds
v_mfma_f32_16x16x32_bf16 v[72:75], a[144:147], a[8:11], v[72:75]
s_xor_b32 m0, s76, 137216
ds_read_b64_tr_b16 a[172:173], v199 offset:40960
v_mfma_f32_16x16x32_bf16 v[72:75], a[148:151], a[12:15], v[72:75]
s_xor_b32 s64, s85, 49152
ds_read_b64_tr_b16 a[174:175], v199 offset:45056
v_mfma_f32_16x16x32_bf16 v[40:43], a[148:151], a[4:7], v[40:43]
buffer_load_dwordx4 v12, s[40:43], s64 offen lds
v_mfma_f32_16x16x32_bf16 v[40:43], a[144:147], a[0:3], v[40:43]
s_waitcnt lgkmcnt(4)
s_xor_b32 m0, s76, 138240
ds_read_b64_tr_b16 a[176:177], v192 offset:32768
v_mfma_f32_16x16x32_bf16 v[44:47], a[152:155], a[0:3], v[44:47]
s_xor_b32 s64, s85, 57344
ds_read_b64_tr_b16 a[178:179], v192 offset:36864
v_mfma_f32_16x16x32_bf16 v[44:47], a[156:159], a[4:7], v[44:47]
buffer_load_dwordx4 v13, s[40:43], s64 offen lds
v_mfma_f32_16x16x32_bf16 v[76:79], a[156:159], a[12:15], v[76:79]
ds_read_b64_tr_b16 a[180:181], v192 offset:40960
v_mfma_f32_16x16x32_bf16 v[76:79], a[152:155], a[8:11], v[76:79]
s_xor_b32 s65, s84, 0
ds_read_b64_tr_b16 a[182:183], v192 offset:45056
v_mfma_f32_16x16x32_bf16 v[108:111], a[152:155], a[16:19], v[108:111]
buffer_load_dwordx4 a[208:211], v14, s[44:47], s65 offen offset:0 sc1
v_mfma_f32_16x16x32_bf16 v[108:111], a[156:159], a[20:23], v[108:111]
ds_read_b64_tr_b16 a[184:185], v193 offset:32768
v_mfma_f32_16x16x32_bf16 v[140:143], a[156:159], a[28:31], v[140:143]
ds_read_b64_tr_b16 a[186:187], v193 offset:36864
v_mfma_f32_16x16x32_bf16 v[140:143], a[152:155], a[24:27], v[140:143]
ds_read_b64_tr_b16 a[188:189], v193 offset:40960
v_mfma_f32_16x16x32_bf16 v[144:147], a[160:163], a[24:27], v[144:147]
buffer_load_dwordx4 a[216:219], v14, s[44:47], s65 offen offset:1024 sc1
v_mfma_f32_16x16x32_bf16 v[144:147], a[164:167], a[28:31], v[144:147]
ds_read_b64_tr_b16 a[190:191], v193 offset:45056
v_mfma_f32_16x16x32_bf16 v[112:115], a[164:167], a[20:23], v[112:115]
ds_read_b64_tr_b16 a[192:193], v194 offset:32768
v_mfma_f32_16x16x32_bf16 v[112:115], a[160:163], a[16:19], v[112:115]
buffer_load_dwordx4 a[224:227], v15, s[44:47], s65 offen offset:0 sc1
v_mfma_f32_16x16x32_bf16 v[80:83], a[160:163], a[8:11], v[80:83]
ds_read_b64_tr_b16 a[194:195], v194 offset:36864
v_mfma_f32_16x16x32_bf16 v[80:83], a[164:167], a[12:15], v[80:83]
ds_read_b64_tr_b16 a[196:197], v194 offset:40960
v_mfma_f32_16x16x32_bf16 v[48:51], a[164:167], a[4:7], v[48:51]
buffer_load_dwordx4 a[232:235], v15, s[44:47], s65 offen offset:1024 sc1
v_mfma_f32_16x16x32_bf16 v[48:51], a[160:163], a[0:3], v[48:51]
s_waitcnt lgkmcnt(4)
ds_read_b64_tr_b16 a[198:199], v194 offset:45056
v_mfma_f32_16x16x32_bf16 v[52:55], a[168:171], a[0:3], v[52:55]
s_xor_b32 s65, s84, 8192
v_mfma_f32_16x16x32_bf16 v[52:55], a[172:175], a[4:7], v[52:55]
buffer_load_dwordx4 a[212:215], v14, s[44:47], s65 offen offset:0 sc1
v_mfma_f32_16x16x32_bf16 v[84:87], a[172:175], a[12:15], v[84:87]
ds_read_b64_tr_b16 a[200:201], v195 offset:32768
v_mfma_f32_16x16x32_bf16 v[84:87], a[168:171], a[8:11], v[84:87]
ds_read_b64_tr_b16 a[202:203], v195 offset:36864
v_mfma_f32_16x16x32_bf16 v[116:119], a[168:171], a[16:19], v[116:119]
ds_read_b64_tr_b16 a[204:205], v195 offset:40960
v_mfma_f32_16x16x32_bf16 v[116:119], a[172:175], a[20:23], v[116:119]
buffer_load_dwordx4 a[220:223], v14, s[44:47], s65 offen offset:1024 sc1
v_mfma_f32_16x16x32_bf16 v[148:151], a[172:175], a[28:31], v[148:151]
ds_read_b64_tr_b16 a[206:207], v195 offset:45056
v_mfma_f32_16x16x32_bf16 v[148:151], a[168:171], a[24:27], v[148:151]
v_mfma_f32_16x16x32_bf16 v[120:123], a[176:179], a[24:27], v[120:123]
buffer_load_dwordx4 a[228:231], v15, s[44:47], s65 offen offset:0 sc1
v_mfma_f32_16x16x32_bf16 v[120:123], a[180:183], a[28:31], v[120:123]
v_mfma_f32_16x16x32_bf16 v[88:91], a[180:183], a[20:23], v[88:91]
v_mfma_f32_16x16x32_bf16 v[88:91], a[176:179], a[16:19], v[88:91]
buffer_load_dwordx4 a[236:239], v15, s[44:47], s65 offen offset:1024 sc1
v_mfma_f32_16x16x32_bf16 v[56:59], a[176:179], a[8:11], v[56:59]
v_mfma_f32_16x16x32_bf16 v[56:59], a[180:183], a[12:15], v[56:59]
v_mfma_f32_16x16x32_bf16 v[24:27], a[180:183], a[4:7], v[24:27]
v_mfma_f32_16x16x32_bf16 v[24:27], a[176:179], a[0:3], v[24:27]
v_mfma_f32_16x16x32_bf16 v[28:31], a[184:187], a[0:3], v[28:31]
s_waitcnt vmcnt(24)
s_barrier
s_waitcnt lgkmcnt(0)
v_mfma_f32_16x16x32_bf16 v[28:31], a[188:191], a[4:7], v[28:31]
s_xor_b32 m0, s76, 32768
ds_read_b64_tr_b16 a[144:145], v188 offset:0
v_mfma_f32_16x16x32_bf16 v[60:63], a[188:191], a[12:15], v[60:63]
s_xor_b32 s64, s85, 262144
ds_read_b64_tr_b16 a[146:147], v188 offset:4096
v_mfma_f32_16x16x32_bf16 v[60:63], a[184:187], a[8:11], v[60:63]
buffer_load_dwordx4 v12, s[40:43], s64 offen lds
v_mfma_f32_16x16x32_bf16 v[92:95], a[184:187], a[16:19], v[92:95]
ds_read_b64_tr_b16 a[148:149], v188 offset:8192
v_mfma_f32_16x16x32_bf16 v[92:95], a[188:191], a[20:23], v[92:95]
s_xor_b32 m0, s76, 33792
ds_read_b64_tr_b16 a[150:151], v188 offset:12288
v_mfma_f32_16x16x32_bf16 v[124:127], a[188:191], a[28:31], v[124:127]
s_xor_b32 s64, s85, 270336
ds_read_b64_tr_b16 a[152:153], v189 offset:0
v_mfma_f32_16x16x32_bf16 v[124:127], a[184:187], a[24:27], v[124:127]
buffer_load_dwordx4 v13, s[40:43], s64 offen lds
v_mfma_f32_16x16x32_bf16 v[128:131], a[192:195], a[24:27], v[128:131]
ds_read_b64_tr_b16 a[154:155], v189 offset:4096
v_mfma_f32_16x16x32_bf16 v[128:131], a[196:199], a[28:31], v[128:131]
s_xor_b32 m0, s76, 34816
ds_read_b64_tr_b16 a[156:157], v189 offset:8192
v_mfma_f32_16x16x32_bf16 v[96:99], a[196:199], a[20:23], v[96:99]
s_xor_b32 s64, s85, 278528
ds_read_b64_tr_b16 a[158:159], v189 offset:12288
v_mfma_f32_16x16x32_bf16 v[96:99], a[192:195], a[16:19], v[96:99]
buffer_load_dwordx4 v12, s[40:43], s64 offen lds
v_mfma_f32_16x16x32_bf16 v[64:67], a[192:195], a[8:11], v[64:67]
ds_read_b64_tr_b16 a[160:161], v190 offset:0
v_mfma_f32_16x16x32_bf16 v[64:67], a[196:199], a[12:15], v[64:67]
s_xor_b32 m0, s76, 35840
ds_read_b64_tr_b16 a[162:163], v190 offset:4096
v_mfma_f32_16x16x32_bf16 v[32:35], a[196:199], a[4:7], v[32:35]
s_xor_b32 s64, s85, 286720
ds_read_b64_tr_b16 a[164:165], v190 offset:8192
v_mfma_f32_16x16x32_bf16 v[32:35], a[192:195], a[0:3], v[32:35]
buffer_load_dwordx4 v13, s[40:43], s64 offen lds
v_mfma_f32_16x16x32_bf16 v[36:39], a[200:203], a[0:3], v[36:39]
ds_read_b64_tr_b16 a[166:167], v190 offset:12288
v_mfma_f32_16x16x32_bf16 v[36:39], a[204:207], a[4:7], v[36:39]
s_xor_b32 m0, s76, 36864
v_mfma_f32_16x16x32_bf16 v[68:71], a[204:207], a[12:15], v[68:71]
s_xor_b32 s64, s85, 294912
v_mfma_f32_16x16x32_bf16 v[68:71], a[200:203], a[8:11], v[68:71]
buffer_load_dwordx4 v12, s[40:43], s64 offen lds
v_mfma_f32_16x16x32_bf16 v[100:103], a[200:203], a[16:19], v[100:103]
v_mfma_f32_16x16x32_bf16 v[100:103], a[204:207], a[20:23], v[100:103]
v_mfma_f32_16x16x32_bf16 v[132:135], a[204:207], a[28:31], v[132:135]
v_mfma_f32_16x16x32_bf16 v[132:135], a[200:203], a[24:27], v[132:135]
s_waitcnt vmcnt(25)
s_waitcnt lgkmcnt(1)
s_xor_b32 m0, s76, 37888
v_mfma_f32_16x16x32_bf16 v[136:139], a[144:147], a[56:59], v[136:139]
s_waitcnt vmcnt(21)
s_xor_b32 s64, s85, 303104
ds_read_b64_tr_b16 a[168:169], v191 offset:0
v_mfma_f32_16x16x32_bf16 v[136:139], a[148:151], a[60:63], v[136:139]
buffer_load_dwordx4 v13, s[40:43], s64 offen lds
v_mfma_f32_16x16x32_bf16 v[104:107], a[148:151], a[52:55], v[104:107]
s_xor_b32 m0, s76, 38912
ds_read_b64_tr_b16 a[170:171], v191 offset:4096
v_mfma_f32_16x16x32_bf16 v[104:107], a[144:147], a[48:51], v[104:107]
s_xor_b32 s64, s85, 311296
ds_read_b64_tr_b16 a[172:173], v191 offset:8192
v_mfma_f32_16x16x32_bf16 v[72:75], a[144:147], a[40:43], v[72:75]
buffer_load_dwordx4 v12, s[40:43], s64 offen lds
v_mfma_f32_16x16x32_bf16 v[72:75], a[148:151], a[44:47], v[72:75]
s_xor_b32 m0, s76, 39936
ds_read_b64_tr_b16 a[174:175], v191 offset:12288
v_mfma_f32_16x16x32_bf16 v[40:43], a[148:151], a[36:39], v[40:43]
s_xor_b32 s64, s85, 319488
ds_read_b64_tr_b16 a[176:177], v184 offset:0
v_mfma_f32_16x16x32_bf16 v[40:43], a[144:147], a[32:35], v[40:43]
buffer_load_dwordx4 v13, s[40:43], s64 offen lds
v_mfma_f32_16x16x32_bf16 v[44:47], a[152:155], a[32:35], v[44:47]
ds_read_b64_tr_b16 a[178:179], v184 offset:4096
v_mfma_f32_16x16x32_bf16 v[44:47], a[156:159], a[36:39], v[44:47]
ds_read_b64_tr_b16 a[180:181], v184 offset:8192
v_mfma_f32_16x16x32_bf16 v[76:79], a[156:159], a[44:47], v[76:79]
s_xor_b32 s65, s84, 32768
ds_read_b64_tr_b16 a[182:183], v184 offset:12288
v_mfma_f32_16x16x32_bf16 v[76:79], a[152:155], a[40:43], v[76:79]
buffer_load_dwordx4 v[152:155], v14, s[44:47], s65 offen offset:0 sc1
v_mfma_f32_16x16x32_bf16 v[108:111], a[152:155], a[48:51], v[108:111]
ds_read_b64_tr_b16 a[184:185], v185 offset:0
v_mfma_f32_16x16x32_bf16 v[108:111], a[156:159], a[52:55], v[108:111]
ds_read_b64_tr_b16 a[186:187], v185 offset:4096
v_mfma_f32_16x16x32_bf16 v[140:143], a[156:159], a[60:63], v[140:143]
buffer_load_dwordx4 v[160:163], v14, s[44:47], s65 offen offset:1024 sc1
v_mfma_f32_16x16x32_bf16 v[140:143], a[152:155], a[56:59], v[140:143]
ds_read_b64_tr_b16 a[188:189], v185 offset:8192
v_mfma_f32_16x16x32_bf16 v[144:147], a[160:163], a[56:59], v[144:147]
s_waitcnt lgkmcnt(5)
ds_read_b64_tr_b16 a[190:191], v185 offset:12288
v_mfma_f32_16x16x32_bf16 v[144:147], a[164:167], a[60:63], v[144:147]
v_mfma_f32_16x16x32_bf16 v[112:115], a[164:167], a[52:55], v[112:115]
buffer_load_dwordx4 v[168:171], v15, s[44:47], s65 offen offset:0 sc1
v_mfma_f32_16x16x32_bf16 v[112:115], a[160:163], a[48:51], v[112:115]
ds_read_b64_tr_b16 a[192:193], v186 offset:0
v_mfma_f32_16x16x32_bf16 v[80:83], a[160:163], a[40:43], v[80:83]
ds_read_b64_tr_b16 a[194:195], v186 offset:4096
v_mfma_f32_16x16x32_bf16 v[80:83], a[164:167], a[44:47], v[80:83]
buffer_load_dwordx4 v[176:179], v15, s[44:47], s65 offen offset:1024 sc1
v_mfma_f32_16x16x32_bf16 v[48:51], a[164:167], a[36:39], v[48:51]
ds_read_b64_tr_b16 a[196:197], v186 offset:8192
v_mfma_f32_16x16x32_bf16 v[48:51], a[160:163], a[32:35], v[48:51]
ds_read_b64_tr_b16 a[198:199], v186 offset:12288
v_mfma_f32_16x16x32_bf16 v[52:55], a[168:171], a[32:35], v[52:55]
s_xor_b32 s65, s84, 40960
v_mfma_f32_16x16x32_bf16 v[52:55], a[172:175], a[36:39], v[52:55]
buffer_load_dwordx4 v[156:159], v14, s[44:47], s65 offen offset:0 sc1
v_mfma_f32_16x16x32_bf16 v[84:87], a[172:175], a[44:47], v[84:87]
ds_read_b64_tr_b16 a[200:201], v187 offset:0
v_mfma_f32_16x16x32_bf16 v[84:87], a[168:171], a[40:43], v[84:87]
ds_read_b64_tr_b16 a[202:203], v187 offset:4096
v_mfma_f32_16x16x32_bf16 v[116:119], a[168:171], a[48:51], v[116:119]
buffer_load_dwordx4 v[164:167], v14, s[44:47], s65 offen offset:1024 sc1
v_mfma_f32_16x16x32_bf16 v[116:119], a[172:175], a[52:55], v[116:119]
ds_read_b64_tr_b16 a[204:205], v187 offset:8192
v_mfma_f32_16x16x32_bf16 v[148:151], a[172:175], a[60:63], v[148:151]
ds_read_b64_tr_b16 a[206:207], v187 offset:12288
v_mfma_f32_16x16x32_bf16 v[148:151], a[168:171], a[56:59], v[148:151]
v_mfma_f32_16x16x32_bf16 v[120:123], a[176:179], a[56:59], v[120:123]
s_waitcnt lgkmcnt(4)
buffer_load_dwordx4 v[172:175], v15, s[44:47], s65 offen offset:0 sc1
v_mfma_f32_16x16x32_bf16 v[120:123], a[180:183], a[60:63], v[120:123]
v_mfma_f32_16x16x32_bf16 v[88:91], a[180:183], a[52:55], v[88:91]
v_mfma_f32_16x16x32_bf16 v[88:91], a[176:179], a[48:51], v[88:91]
buffer_load_dwordx4 v[180:183], v15, s[44:47], s65 offen offset:1024 sc1
v_mfma_f32_16x16x32_bf16 v[56:59], a[176:179], a[40:43], v[56:59]
v_mfma_f32_16x16x32_bf16 v[56:59], a[180:183], a[44:47], v[56:59]
v_mfma_f32_16x16x32_bf16 v[24:27], a[180:183], a[36:39], v[24:27]
v_mfma_f32_16x16x32_bf16 v[24:27], a[176:179], a[32:35], v[24:27]
v_mfma_f32_16x16x32_bf16 v[28:31], a[184:187], a[32:35], v[28:31]
s_waitcnt vmcnt(24)
s_barrier
v_mfma_f32_16x16x32_bf16 v[28:31], a[188:191], a[36:39], v[28:31]
s_xor_b32 m0, s76, 65536
ds_read_b64_tr_b16 a[144:145], v188 offset:32768
v_mfma_f32_16x16x32_bf16 v[60:63], a[188:191], a[44:47], v[60:63]
s_xor_b32 s64, s85, 524288
ds_read_b64_tr_b16 a[146:147], v188 offset:36864
v_mfma_f32_16x16x32_bf16 v[60:63], a[184:187], a[40:43], v[60:63]
buffer_load_dwordx4 v12, s[40:43], s64 offen lds
v_mfma_f32_16x16x32_bf16 v[92:95], a[184:187], a[48:51], v[92:95]
ds_read_b64_tr_b16 a[148:149], v188 offset:40960
v_mfma_f32_16x16x32_bf16 v[92:95], a[188:191], a[52:55], v[92:95]
s_xor_b32 m0, s76, 66560
ds_read_b64_tr_b16 a[150:151], v188 offset:45056
v_mfma_f32_16x16x32_bf16 v[124:127], a[188:191], a[60:63], v[124:127]
s_xor_b32 s64, s85, 532480
ds_read_b64_tr_b16 a[152:153], v189 offset:32768
v_mfma_f32_16x16x32_bf16 v[124:127], a[184:187], a[56:59], v[124:127]
buffer_load_dwordx4 v13, s[40:43], s64 offen lds
v_mfma_f32_16x16x32_bf16 v[128:131], a[192:195], a[56:59], v[128:131]
ds_read_b64_tr_b16 a[154:155], v189 offset:36864
v_mfma_f32_16x16x32_bf16 v[128:131], a[196:199], a[60:63], v[128:131]
s_xor_b32 m0, s76, 67584
ds_read_b64_tr_b16 a[156:157], v189 offset:40960
v_mfma_f32_16x16x32_bf16 v[96:99], a[196:199], a[52:55], v[96:99]
s_xor_b32 s64, s85, 540672
ds_read_b64_tr_b16 a[158:159], v189 offset:45056
v_mfma_f32_16x16x32_bf16 v[96:99], a[192:195], a[48:51], v[96:99]
buffer_load_dwordx4 v12, s[40:43], s64 offen lds
v_mfma_f32_16x16x32_bf16 v[64:67], a[192:195], a[40:43], v[64:67]
ds_read_b64_tr_b16 a[160:161], v190 offset:32768
v_mfma_f32_16x16x32_bf16 v[64:67], a[196:199], a[44:47], v[64:67]
s_xor_b32 m0, s76, 68608
ds_read_b64_tr_b16 a[162:163], v190 offset:36864
v_mfma_f32_16x16x32_bf16 v[32:35], a[196:199], a[36:39], v[32:35]
s_xor_b32 s64, s85, 548864
ds_read_b64_tr_b16 a[164:165], v190 offset:40960
v_mfma_f32_16x16x32_bf16 v[32:35], a[192:195], a[32:35], v[32:35]
s_waitcnt lgkmcnt(6)
buffer_load_dwordx4 v13, s[40:43], s64 offen lds
v_mfma_f32_16x16x32_bf16 v[36:39], a[200:203], a[32:35], v[36:39]
ds_read_b64_tr_b16 a[166:167], v190 offset:45056
v_mfma_f32_16x16x32_bf16 v[36:39], a[204:207], a[36:39], v[36:39]
s_xor_b32 m0, s76, 69632
v_mfma_f32_16x16x32_bf16 v[68:71], a[204:207], a[44:47], v[68:71]
s_xor_b32 s64, s85, 557056
v_mfma_f32_16x16x32_bf16 v[68:71], a[200:203], a[40:43], v[68:71]
buffer_load_dwordx4 v12, s[40:43], s64 offen lds
v_mfma_f32_16x16x32_bf16 v[100:103], a[200:203], a[48:51], v[100:103]
s_sub_u32 s73, 1, s73
s_sub_u32 s70, s70, 1
s_cmp_lg_u32 s70, 0
v_mfma_f32_16x16x32_bf16 v[100:103], a[204:207], a[52:55], v[100:103]
v_mfma_f32_16x16x32_bf16 v[132:135], a[204:207], a[60:63], v[132:135]
v_mfma_f32_16x16x32_bf16 v[132:135], a[200:203], a[56:59], v[132:135]
s_cbranch_scc1 L_p5loop
L_p5last:
s_waitcnt lgkmcnt(10)
s_waitcnt vmcnt(25)
v_mfma_f32_16x16x32_bf16 v[136:139], a[144:147], a[232:235], v[136:139]
s_waitcnt vmcnt(21)
s_waitcnt lgkmcnt(8)
s_xor_b32 m0, s76, 70656
s_xor_b32 s64, s85, 565248
ds_read_b64_tr_b16 a[168:169], v191 offset:32768
v_mfma_f32_16x16x32_bf16 v[136:139], a[148:151], a[236:239], v[136:139]
buffer_load_dwordx4 v13, s[40:43], s64 offen lds
v_mfma_f32_16x16x32_bf16 v[104:107], a[148:151], a[228:231], v[104:107]
s_xor_b32 m0, s76, 71680
ds_read_b64_tr_b16 a[170:171], v191 offset:36864
v_mfma_f32_16x16x32_bf16 v[104:107], a[144:147], a[224:227], v[104:107]
s_xor_b32 s64, s85, 573440
ds_read_b64_tr_b16 a[172:173], v191 offset:40960
v_mfma_f32_16x16x32_bf16 v[72:75], a[144:147], a[216:219], v[72:75]
buffer_load_dwordx4 v12, s[40:43], s64 offen lds
v_mfma_f32_16x16x32_bf16 v[72:75], a[148:151], a[220:223], v[72:75]
s_xor_b32 m0, s76, 72704
ds_read_b64_tr_b16 a[174:175], v191 offset:45056
v_mfma_f32_16x16x32_bf16 v[40:43], a[148:151], a[212:215], v[40:43]
s_xor_b32 s64, s85, 581632
ds_read_b64_tr_b16 a[176:177], v184 offset:32768
v_mfma_f32_16x16x32_bf16 v[40:43], a[144:147], a[208:211], v[40:43]
s_waitcnt lgkmcnt(5)
buffer_load_dwordx4 v13, s[40:43], s64 offen lds
v_mfma_f32_16x16x32_bf16 v[44:47], a[152:155], a[208:211], v[44:47]
ds_read_b64_tr_b16 a[178:179], v184 offset:36864
v_mfma_f32_16x16x32_bf16 v[44:47], a[156:159], a[212:215], v[44:47]
ds_read_b64_tr_b16 a[180:181], v184 offset:40960
v_mfma_f32_16x16x32_bf16 v[76:79], a[156:159], a[220:223], v[76:79]
s_xor_b32 s65, s84, 65536
ds_read_b64_tr_b16 a[182:183], v184 offset:45056
v_mfma_f32_16x16x32_bf16 v[76:79], a[152:155], a[216:219], v[76:79]
buffer_load_dwordx4 a[0:3], v14, s[44:47], s65 offen offset:0 sc1
v_mfma_f32_16x16x32_bf16 v[108:111], a[152:155], a[224:227], v[108:111]
ds_read_b64_tr_b16 a[184:185], v185 offset:32768
v_mfma_f32_16x16x32_bf16 v[108:111], a[156:159], a[228:231], v[108:111]
ds_read_b64_tr_b16 a[186:187], v185 offset:36864
v_mfma_f32_16x16x32_bf16 v[140:143], a[156:159], a[236:239], v[140:143]
buffer_load_dwordx4 a[8:11], v14, s[44:47], s65 offen offset:1024 sc1
v_mfma_f32_16x16x32_bf16 v[140:143], a[152:155], a[232:235], v[140:143]
ds_read_b64_tr_b16 a[188:189], v185 offset:40960
v_mfma_f32_16x16x32_bf16 v[144:147], a[160:163], a[232:235], v[144:147]
ds_read_b64_tr_b16 a[190:191], v185 offset:45056
v_mfma_f32_16x16x32_bf16 v[144:147], a[164:167], a[236:239], v[144:147]
v_mfma_f32_16x16x32_bf16 v[112:115], a[164:167], a[228:231], v[112:115]
buffer_load_dwordx4 a[16:19], v15, s[44:47], s65 offen offset:0 sc1
v_mfma_f32_16x16x32_bf16 v[112:115], a[160:163], a[224:227], v[112:115]
ds_read_b64_tr_b16 a[192:193], v186 offset:32768
v_mfma_f32_16x16x32_bf16 v[80:83], a[160:163], a[216:219], v[80:83]
ds_read_b64_tr_b16 a[194:195], v186 offset:36864
v_mfma_f32_16x16x32_bf16 v[80:83], a[164:167], a[220:223], v[80:83]
buffer_load_dwordx4 a[24:27], v15, s[44:47], s65 offen offset:1024 sc1
v_mfma_f32_16x16x32_bf16 v[48:51], a[164:167], a[212:215], v[48:51]
ds_read_b64_tr_b16 a[196:197], v186 offset:40960
v_mfma_f32_16x16x32_bf16 v[48:51], a[160:163], a[208:211], v[48:51]
s_waitcnt lgkmcnt(4)
ds_read_b64_tr_b16 a[198:199], v186 offset:45056
v_mfma_f32_16x16x32_bf16 v[52:55], a[168:171], a[208:211], v[52:55]
s_xor_b32 s65, s84, 73728
v_mfma_f32_16x16x32_bf16 v[52:55], a[172:175], a[212:215], v[52:55]
buffer_load_dwordx4 a[4:7], v14, s[44:47], s65 offen offset:0 sc1
v_mfma_f32_16x16x32_bf16 v[84:87], a[172:175], a[220:223], v[84:87]
ds_read_b64_tr_b16 a[200:201], v187 offset:32768
v_mfma_f32_16x16x32_bf16 v[84:87], a[168:171], a[216:219], v[84:87]
ds_read_b64_tr_b16 a[202:203], v187 offset:36864
v_mfma_f32_16x16x32_bf16 v[116:119], a[168:171], a[224:227], v[116:119]
buffer_load_dwordx4 a[12:15], v14, s[44:47], s65 offen offset:1024 sc1
v_mfma_f32_16x16x32_bf16 v[116:119], a[172:175], a[228:231], v[116:119]
ds_read_b64_tr_b16 a[204:205], v187 offset:40960
v_mfma_f32_16x16x32_bf16 v[148:151], a[172:175], a[236:239], v[148:151]
ds_read_b64_tr_b16 a[206:207], v187 offset:45056
v_mfma_f32_16x16x32_bf16 v[148:151], a[168:171], a[232:235], v[148:151]
v_mfma_f32_16x16x32_bf16 v[120:123], a[176:179], a[232:235], v[120:123]
buffer_load_dwordx4 a[20:23], v15, s[44:47], s65 offen offset:0 sc1
v_mfma_f32_16x16x32_bf16 v[120:123], a[180:183], a[236:239], v[120:123]
v_mfma_f32_16x16x32_bf16 v[88:91], a[180:183], a[228:231], v[88:91]
v_mfma_f32_16x16x32_bf16 v[88:91], a[176:179], a[224:227], v[88:91]
buffer_load_dwordx4 a[28:31], v15, s[44:47], s65 offen offset:1024 sc1
v_mfma_f32_16x16x32_bf16 v[56:59], a[176:179], a[216:219], v[56:59]
v_mfma_f32_16x16x32_bf16 v[56:59], a[180:183], a[220:223], v[56:59]
v_mfma_f32_16x16x32_bf16 v[24:27], a[180:183], a[212:215], v[24:27]
v_mfma_f32_16x16x32_bf16 v[24:27], a[176:179], a[208:211], v[24:27]
v_mfma_f32_16x16x32_bf16 v[28:31], a[184:187], a[208:211], v[28:31]
s_waitcnt vmcnt(24)
s_barrier
s_waitcnt lgkmcnt(0)
v_mfma_f32_16x16x32_bf16 v[28:31], a[188:191], a[212:215], v[28:31]
s_xor_b32 m0, s76, 98304
ds_read_b64_tr_b16 a[144:145], v196 offset:0
v_mfma_f32_16x16x32_bf16 v[60:63], a[188:191], a[220:223], v[60:63]
s_xor_b32 s64, s85, 786432
ds_read_b64_tr_b16 a[146:147], v196 offset:4096
v_mfma_f32_16x16x32_bf16 v[60:63], a[184:187], a[216:219], v[60:63]
buffer_load_dwordx4 v12, s[40:43], s64 offen lds
v_mfma_f32_16x16x32_bf16 v[92:95], a[184:187], a[224:227], v[92:95]
ds_read_b64_tr_b16 a[148:149], v196 offset:8192
v_mfma_f32_16x16x32_bf16 v[92:95], a[188:191], a[228:231], v[92:95]
s_xor_b32 m0, s76, 99328
ds_read_b64_tr_b16 a[150:151], v196 offset:12288
v_mfma_f32_16x16x32_bf16 v[124:127], a[188:191], a[236:239], v[124:127]
s_xor_b32 s64, s85, 794624
ds_read_b64_tr_b16 a[152:153], v197 offset:0
v_mfma_f32_16x16x32_bf16 v[124:127], a[184:187], a[232:235], v[124:127]
buffer_load_dwordx4 v13, s[40:43], s64 offen lds
v_mfma_f32_16x16x32_bf16 v[128:131], a[192:195], a[232:235], v[128:131]
ds_read_b64_tr_b16 a[154:155], v197 offset:4096
v_mfma_f32_16x16x32_bf16 v[128:131], a[196:199], a[236:239], v[128:131]
s_xor_b32 m0, s76, 100352
ds_read_b64_tr_b16 a[156:157], v197 offset:8192
v_mfma_f32_16x16x32_bf16 v[96:99], a[196:199], a[228:231], v[96:99]
s_xor_b32 s64, s85, 802816
ds_read_b64_tr_b16 a[158:159], v197 offset:12288
v_mfma_f32_16x16x32_bf16 v[96:99], a[192:195], a[224:227], v[96:99]
buffer_load_dwordx4 v12, s[40:43], s64 offen lds
v_mfma_f32_16x16x32_bf16 v[64:67], a[192:195], a[216:219], v[64:67]
ds_read_b64_tr_b16 a[160:161], v198 offset:0
v_mfma_f32_16x16x32_bf16 v[64:67], a[196:199], a[220:223], v[64:67]
s_xor_b32 m0, s76, 101376
ds_read_b64_tr_b16 a[162:163], v198 offset:4096
v_mfma_f32_16x16x32_bf16 v[32:35], a[196:199], a[212:215], v[32:35]
s_xor_b32 s64, s85, 811008
ds_read_b64_tr_b16 a[164:165], v198 offset:8192
v_mfma_f32_16x16x32_bf16 v[32:35], a[192:195], a[208:211], v[32:35]
buffer_load_dwordx4 v13, s[40:43], s64 offen lds
v_mfma_f32_16x16x32_bf16 v[36:39], a[200:203], a[208:211], v[36:39]
ds_read_b64_tr_b16 a[166:167], v198 offset:12288
v_mfma_f32_16x16x32_bf16 v[36:39], a[204:207], a[212:215], v[36:39]
s_xor_b32 m0, s76, 102400
v_mfma_f32_16x16x32_bf16 v[68:71], a[204:207], a[220:223], v[68:71]
s_xor_b32 s64, s85, 819200
v_mfma_f32_16x16x32_bf16 v[68:71], a[200:203], a[216:219], v[68:71]
buffer_load_dwordx4 v12, s[40:43], s64 offen lds
v_mfma_f32_16x16x32_bf16 v[100:103], a[200:203], a[224:227], v[100:103]
s_xor_b32 s66, s2, 1
s_lshl2_add_u32 s66, s66, s30
s_lshl_b32 s73, s66, 12
v_mfma_f32_16x16x32_bf16 v[100:103], a[204:207], a[228:231], v[100:103]
s_add_u32 s73, s73, 67108864
s_lshl2_add_u32 s66, s2, s30
s_lshl_b32 s75, s66, 12
v_mfma_f32_16x16x32_bf16 v[132:135], a[204:207], a[236:239], v[132:135]
s_add_u32 s75, s75, 67108864
s_lshl_b32 s77, s82, 18
s_lshl_b32 s66, s30, 16
v_mfma_f32_16x16x32_bf16 v[132:135], a[200:203], a[232:235], v[132:135]
s_waitcnt vmcnt(25)
s_waitcnt lgkmcnt(1)
s_add_u32 s77, s77, s66
s_add_u32 s77, s77, s87
s_lshl_b32 s66, s83, 7
s_xor_b32 m0, s76, 103424
v_mfma_f32_16x16x32_bf16 v[136:139], a[144:147], v[176:179], v[136:139]
s_waitcnt vmcnt(21)
s_add_u32 s77, s77, s66
s_xor_b32 s64, s85, 827392
ds_read_b64_tr_b16 a[168:169], v199 offset:0
v_lshlrev_b32 v1, 24, v0
v_mfma_f32_16x16x32_bf16 v[136:139], a[148:151], v[180:183], v[136:139]
buffer_load_dwordx4 v13, s[40:43], s64 offen lds
v_mfma_f32_16x16x32_bf16 v[104:107], a[148:151], v[172:175], v[104:107]
s_xor_b32 m0, s76, 104448
ds_read_b64_tr_b16 a[170:171], v199 offset:4096
v_and_b32 v8, 7, v0
v_mfma_f32_16x16x32_bf16 v[104:107], a[144:147], v[168:171], v[104:107]
s_xor_b32 s64, s85, 835584
ds_read_b64_tr_b16 a[172:173], v199 offset:8192
v_lshlrev_b32 v8, 11, v8
v_mfma_f32_16x16x32_bf16 v[72:75], a[144:147], v[160:163], v[72:75]
buffer_load_dwordx4 v12, s[40:43], s64 offen lds
v_mfma_f32_16x16x32_bf16 v[72:75], a[148:151], v[164:167], v[72:75]
s_xor_b32 m0, s76, 105472
ds_read_b64_tr_b16 a[174:175], v199 offset:12288
v_bfe_u32 v10, v0, 3, 1
v_mfma_f32_16x16x32_bf16 v[40:43], a[148:151], v[156:159], v[40:43]
s_xor_b32 s64, s85, 843776
ds_read_b64_tr_b16 a[176:177], v192 offset:0
v_lshl_add_u32 v8, v10, 6, v8
v_mfma_f32_16x16x32_bf16 v[40:43], a[144:147], v[152:155], v[40:43]
buffer_load_dwordx4 v13, s[40:43], s64 offen lds
v_mfma_f32_16x16x32_bf16 v[44:47], a[152:155], v[152:155], v[44:47]
ds_read_b64_tr_b16 a[178:179], v192 offset:4096
v_bfe_u32 v10, v0, 4, 1
v_mfma_f32_16x16x32_bf16 v[44:47], a[156:159], v[156:159], v[44:47]
ds_read_b64_tr_b16 a[180:181], v192 offset:8192
v_lshl_add_u32 v8, v10, 5, v8
v_mfma_f32_16x16x32_bf16 v[76:79], a[156:159], v[164:167], v[76:79]
s_xor_b32 s65, s84, 98304
ds_read_b64_tr_b16 a[182:183], v192 offset:12288
v_lshrrev_b32 v10, 5, v0
v_mfma_f32_16x16x32_bf16 v[76:79], a[152:155], v[160:163], v[76:79]
buffer_load_dwordx4 a[32:35], v14, s[44:47], s65 offen offset:0 sc1
v_mfma_f32_16x16x32_bf16 v[108:111], a[152:155], v[168:171], v[108:111]
ds_read_b64_tr_b16 a[184:185], v193 offset:0
v_lshl_add_u32 v8, v10, 4, v8
v_mfma_f32_16x16x32_bf16 v[108:111], a[156:159], v[172:175], v[108:111]
ds_read_b64_tr_b16 a[186:187], v193 offset:4096
v_add_u32 v2, s86, v16
v_mfma_f32_16x16x32_bf16 v[140:143], a[156:159], v[180:183], v[140:143]
buffer_load_dwordx4 a[40:43], v14, s[44:47], s65 offen offset:1024 sc1
v_mfma_f32_16x16x32_bf16 v[140:143], a[152:155], v[176:179], v[140:143]
ds_read_b64_tr_b16 a[188:189], v193 offset:8192
v_xor_b32 v3, 0x2000, v2
v_mfma_f32_16x16x32_bf16 v[144:147], a[160:163], v[176:179], v[144:147]
s_waitcnt lgkmcnt(5)
ds_read_b64_tr_b16 a[190:191], v193 offset:12288
v_mov_b32 v232, 0
v_mfma_f32_16x16x32_bf16 v[144:147], a[164:167], v[180:183], v[144:147]
v_mov_b32 v233, 0
v_mov_b32 v236, 0
v_mfma_f32_16x16x32_bf16 v[112:115], a[164:167], v[172:175], v[112:115]
buffer_load_dwordx4 a[48:51], v15, s[44:47], s65 offen offset:0 sc1
v_mfma_f32_16x16x32_bf16 v[112:115], a[160:163], v[168:171], v[112:115]
ds_read_b64_tr_b16 a[192:193], v194 offset:0
v_mov_b32 v237, 0
v_mfma_f32_16x16x32_bf16 v[80:83], a[160:163], v[160:163], v[80:83]
ds_read_b64_tr_b16 a[194:195], v194 offset:4096
v_and_b32 v9, 1, v0
v_mfma_f32_16x16x32_bf16 v[80:83], a[164:167], v[164:167], v[80:83]
buffer_load_dwordx4 a[56:59], v15, s[44:47], s65 offen offset:1024 sc1
v_mfma_f32_16x16x32_bf16 v[48:51], a[164:167], v[156:159], v[48:51]
ds_read_b64_tr_b16 a[196:197], v194 offset:8192
v_lshlrev_b32 v9, 4, v9
v_mfma_f32_16x16x32_bf16 v[48:51], a[160:163], v[152:155], v[48:51]
ds_read_b64_tr_b16 a[198:199], v194 offset:12288
v_mov_b32 v10, 0x3f80
v_mfma_f32_16x16x32_bf16 v[52:55], a[168:171], v[152:155], v[52:55]
s_xor_b32 s65, s84, 106496
v_lshlrev_b32 v9, v9, v10
v_lshrrev_b32 v10, 4, v0
v_mfma_f32_16x16x32_bf16 v[52:55], a[172:175], v[156:159], v[52:55]
buffer_load_dwordx4 a[36:39], v14, s[44:47], s65 offen offset:0 sc1
v_mfma_f32_16x16x32_bf16 v[84:87], a[172:175], v[164:167], v[84:87]
ds_read_b64_tr_b16 a[200:201], v195 offset:0
v_lshlrev_b32 v10, 1, v10
v_mfma_f32_16x16x32_bf16 v[84:87], a[168:171], v[160:163], v[84:87]
ds_read_b64_tr_b16 a[202:203], v195 offset:4096
v_bfe_u32 v11, v0, 1, 3
v_mfma_f32_16x16x32_bf16 v[116:119], a[168:171], v[168:171], v[116:119]
buffer_load_dwordx4 a[44:47], v14, s[44:47], s65 offen offset:1024 sc1
v_mfma_f32_16x16x32_bf16 v[116:119], a[172:175], v[172:175], v[116:119]
ds_read_b64_tr_b16 a[204:205], v195 offset:8192
v_xor_b32 v10, v10, v11
v_mfma_f32_16x16x32_bf16 v[148:151], a[172:175], v[180:183], v[148:151]
ds_read_b64_tr_b16 a[206:207], v195 offset:12288
v_subrev_u32 v11, 1, v10
v_mfma_f32_16x16x32_bf16 v[148:151], a[168:171], v[176:179], v[148:151]
v_ashrrev_i32 v11, 31, v11
v_and_b32 v234, v11, v9
v_mfma_f32_16x16x32_bf16 v[120:123], a[176:179], v[176:179], v[120:123]
s_waitcnt lgkmcnt(4)
buffer_load_dwordx4 a[52:55], v15, s[44:47], s65 offen offset:0 sc1
v_mfma_f32_16x16x32_bf16 v[120:123], a[180:183], v[180:183], v[120:123]
v_xor_b32 v10, 1, v10
v_subrev_u32 v11, 1, v10
v_mfma_f32_16x16x32_bf16 v[88:91], a[180:183], v[172:175], v[88:91]
v_ashrrev_i32 v11, 31, v11
v_and_b32 v235, v11, v9
v_mfma_f32_16x16x32_bf16 v[88:91], a[176:179], v[168:171], v[88:91]
s_mov_b32 s48, s24
buffer_load_dwordx4 a[60:63], v15, s[44:47], s65 offen offset:1024 sc1
v_mfma_f32_16x16x32_bf16 v[56:59], a[176:179], v[160:163], v[56:59]
s_mov_b32 s49, s25
s_mov_b32 s50, 4194304
s_mov_b32 s51, 0x20000
v_mfma_f32_16x16x32_bf16 v[56:59], a[180:183], v[164:167], v[56:59]
v_mfma_f32_16x16x32_bf16 v[24:27], a[180:183], v[156:159], v[24:27]
v_mfma_f32_16x16x32_bf16 v[24:27], a[176:179], v[152:155], v[24:27]
v_mfma_f32_16x16x32_bf16 v[28:31], a[184:187], v[152:155], v[28:31]
s_waitcnt vmcnt(24)
s_barrier
v_mfma_f32_16x16x32_bf16 v[28:31], a[188:191], v[156:159], v[28:31]
ds_read_b64_tr_b16 a[144:145], v196 offset:32768
v_mfma_f32_16x16x32_bf16 v[60:63], a[188:191], v[164:167], v[60:63]
ds_read_b64_tr_b16 a[146:147], v196 offset:36864
v_mfma_f32_16x16x32_bf16 v[60:63], a[184:187], v[160:163], v[60:63]
ds_read_b64_tr_b16 a[148:149], v196 offset:40960
v_mfma_f32_16x16x32_bf16 v[92:95], a[184:187], v[168:171], v[92:95]
ds_read_b64_tr_b16 a[150:151], v196 offset:45056
v_mfma_f32_16x16x32_bf16 v[92:95], a[188:191], v[172:175], v[92:95]
ds_read_b64_tr_b16 a[152:153], v197 offset:32768
v_mfma_f32_16x16x32_bf16 v[124:127], a[188:191], v[180:183], v[124:127]
ds_read_b64_tr_b16 a[154:155], v197 offset:36864
v_mfma_f32_16x16x32_bf16 v[124:127], a[184:187], v[176:179], v[124:127]
ds_read_b64_tr_b16 a[156:157], v197 offset:40960
v_mfma_f32_16x16x32_bf16 v[128:131], a[192:195], v[176:179], v[128:131]
ds_read_b64_tr_b16 a[158:159], v197 offset:45056
v_mfma_f32_16x16x32_bf16 v[128:131], a[196:199], v[180:183], v[128:131]
ds_read_b64_tr_b16 a[160:161], v198 offset:32768
v_mfma_f32_16x16x32_bf16 v[96:99], a[196:199], v[172:175], v[96:99]
ds_read_b64_tr_b16 a[162:163], v198 offset:36864
v_mfma_f32_16x16x32_bf16 v[96:99], a[192:195], v[168:171], v[96:99]
ds_read_b64_tr_b16 a[164:165], v198 offset:40960
v_mfma_f32_16x16x32_bf16 v[64:67], a[192:195], v[160:163], v[64:67]
ds_read_b64_tr_b16 a[166:167], v198 offset:45056
v_mfma_f32_16x16x32_bf16 v[64:67], a[196:199], v[164:167], v[64:67]
v_mfma_f32_16x16x32_bf16 v[32:35], a[196:199], v[156:159], v[32:35]
v_mfma_f32_16x16x32_bf16 v[32:35], a[192:195], v[152:155], v[32:35]
s_waitcnt lgkmcnt(5)
v_mfma_f32_16x16x32_bf16 v[36:39], a[200:203], v[152:155], v[36:39]
v_mfma_f32_16x16x32_bf16 v[36:39], a[204:207], v[156:159], v[36:39]
v_mfma_f32_16x16x32_bf16 v[68:71], a[204:207], v[164:167], v[68:71]
v_mfma_f32_16x16x32_bf16 v[68:71], a[200:203], v[160:163], v[68:71]
v_mfma_f32_16x16x32_bf16 v[100:103], a[200:203], v[168:171], v[100:103]
v_mfma_f32_16x16x32_bf16 v[100:103], a[204:207], v[172:175], v[100:103]
v_mfma_f32_16x16x32_bf16 v[132:135], a[204:207], v[180:183], v[132:135]
v_mfma_f32_16x16x32_bf16 v[132:135], a[200:203], v[176:179], v[132:135]
s_waitcnt vmcnt(20)
v_mfma_f32_16x16x32_bf16 v[136:139], a[144:147], a[24:27], v[136:139]
s_waitcnt vmcnt(16)
ds_read_b64_tr_b16 a[168:169], v199 offset:32768
v_mfma_f32_16x16x32_bf16 v[136:139], a[148:151], a[28:31], v[136:139]
ds_read_b64_tr_b16 a[170:171], v199 offset:36864
v_mfma_f32_16x16x32_bf16 v[104:107], a[148:151], a[20:23], v[104:107]
ds_read_b64_tr_b16 a[172:173], v199 offset:40960
v_mfma_f32_16x16x32_bf16 v[104:107], a[144:147], a[16:19], v[104:107]
ds_read_b64_tr_b16 a[174:175], v199 offset:45056
v_mfma_f32_16x16x32_bf16 v[72:75], a[144:147], a[8:11], v[72:75]
v_mfma_f32_16x16x32_bf16 v[72:75], a[148:151], a[12:15], v[72:75]
v_mfma_f32_16x16x32_bf16 v[40:43], a[148:151], a[4:7], v[40:43]
s_waitcnt vmcnt(8)
s_barrier
v_mfma_f32_16x16x32_bf16 v[40:43], a[144:147], a[0:3], v[40:43]
ds_read_b64_tr_b16 a[176:177], v188 offset:0
v_mfma_f32_16x16x32_bf16 v[44:47], a[152:155], a[0:3], v[44:47]
s_waitcnt lgkmcnt(4)
ds_read_b64_tr_b16 a[178:179], v188 offset:4096
v_mfma_f32_16x16x32_bf16 v[44:47], a[156:159], a[4:7], v[44:47]
ds_read_b64_tr_b16 a[180:181], v188 offset:8192
v_mfma_f32_16x16x32_bf16 v[76:79], a[156:159], a[12:15], v[76:79]
ds_read_b64_tr_b16 a[182:183], v188 offset:12288
v_mfma_f32_16x16x32_bf16 v[76:79], a[152:155], a[8:11], v[76:79]
ds_read_b64_tr_b16 a[184:185], v189 offset:0
v_mfma_f32_16x16x32_bf16 v[108:111], a[152:155], a[16:19], v[108:111]
ds_read_b64_tr_b16 a[186:187], v189 offset:4096
v_mfma_f32_16x16x32_bf16 v[108:111], a[156:159], a[20:23], v[108:111]
ds_read_b64_tr_b16 a[188:189], v189 offset:8192
v_mfma_f32_16x16x32_bf16 v[140:143], a[156:159], a[28:31], v[140:143]
ds_read_b64_tr_b16 a[190:191], v189 offset:12288
v_mfma_f32_16x16x32_bf16 v[140:143], a[152:155], a[24:27], v[140:143]
v_mfma_f32_16x16x32_bf16 v[144:147], a[160:163], a[24:27], v[144:147]
v_mfma_f32_16x16x32_bf16 v[144:147], a[164:167], a[28:31], v[144:147]
v_mfma_f32_16x16x32_bf16 v[112:115], a[164:167], a[20:23], v[112:115]
ds_read_b64_tr_b16 a[192:193], v190 offset:0
v_mfma_f32_16x16x32_bf16 v[112:115], a[160:163], a[16:19], v[112:115]
ds_read_b64_tr_b16 a[194:195], v190 offset:4096
v_mfma_f32_16x16x32_bf16 v[80:83], a[160:163], a[8:11], v[80:83]
ds_read_b64_tr_b16 a[196:197], v190 offset:8192
v_mfma_f32_16x16x32_bf16 v[80:83], a[164:167], a[12:15], v[80:83]
ds_read_b64_tr_b16 a[198:199], v190 offset:12288
v_mfma_f32_16x16x32_bf16 v[48:51], a[164:167], a[4:7], v[48:51]
v_mfma_f32_16x16x32_bf16 v[48:51], a[160:163], a[0:3], v[48:51]
s_waitcnt lgkmcnt(4)
v_mfma_f32_16x16x32_bf16 v[52:55], a[168:171], a[0:3], v[52:55]
v_mfma_f32_16x16x32_bf16 v[52:55], a[172:175], a[4:7], v[52:55]
v_mfma_f32_16x16x32_bf16 v[84:87], a[172:175], a[12:15], v[84:87]
ds_read_b64_tr_b16 a[200:201], v191 offset:0
v_mfma_f32_16x16x32_bf16 v[84:87], a[168:171], a[8:11], v[84:87]
ds_read_b64_tr_b16 a[202:203], v191 offset:4096
v_mfma_f32_16x16x32_bf16 v[116:119], a[168:171], a[16:19], v[116:119]
ds_read_b64_tr_b16 a[204:205], v191 offset:8192
v_mfma_f32_16x16x32_bf16 v[116:119], a[172:175], a[20:23], v[116:119]
ds_read_b64_tr_b16 a[206:207], v191 offset:12288
v_mfma_f32_16x16x32_bf16 v[148:151], a[172:175], a[28:31], v[148:151]
v_mfma_f32_16x16x32_bf16 v[148:151], a[168:171], a[24:27], v[148:151]
s_waitcnt vmcnt(4)
v_mfma_f32_16x16x32_bf16 v[136:139], a[176:179], a[56:59], v[136:139]
s_waitcnt vmcnt(0)
v_mfma_f32_16x16x32_bf16 v[136:139], a[180:183], a[60:63], v[136:139]
v_mfma_f32_16x16x32_bf16 v[104:107], a[180:183], a[52:55], v[104:107]
ds_read_b64_tr_b16 a[144:145], v192 offset:32768
v_mfma_f32_16x16x32_bf16 v[104:107], a[176:179], a[48:51], v[104:107]
ds_read_b64_tr_b16 a[146:147], v192 offset:36864
v_mfma_f32_16x16x32_bf16 v[72:75], a[176:179], a[40:43], v[72:75]
ds_read_b64_tr_b16 a[148:149], v192 offset:40960
v_mfma_f32_16x16x32_bf16 v[72:75], a[180:183], a[44:47], v[72:75]
ds_read_b64_tr_b16 a[150:151], v192 offset:45056
v_mfma_f32_16x16x32_bf16 v[40:43], a[180:183], a[36:39], v[40:43]
v_mfma_f32_16x16x32_bf16 v[40:43], a[176:179], a[32:35], v[40:43]
v_mfma_f32_16x16x32_bf16 v[44:47], a[184:187], a[32:35], v[44:47]
v_mfma_f32_16x16x32_bf16 v[44:47], a[188:191], a[36:39], v[44:47]
ds_write_b128 v3, v[136:139] offset:4096
v_mfma_f32_16x16x32_bf16 v[76:79], a[188:191], a[44:47], v[76:79]
ds_read_b64_tr_b16 a[152:153], v193 offset:32768
v_mfma_f32_16x16x32_bf16 v[76:79], a[184:187], a[40:43], v[76:79]
ds_write_b128 v3, v[104:107] offset:0
v_mfma_f32_16x16x32_bf16 v[108:111], a[184:187], a[48:51], v[108:111]
ds_read_b64_tr_b16 a[154:155], v193 offset:36864
v_mfma_f32_16x16x32_bf16 v[108:111], a[188:191], a[52:55], v[108:111]
ds_read_b64_tr_b16 a[156:157], v193 offset:40960
v_mfma_f32_16x16x32_bf16 v[140:143], a[188:191], a[60:63], v[140:143]
ds_read_b64_tr_b16 a[158:159], v193 offset:45056
v_mfma_f32_16x16x32_bf16 v[140:143], a[184:187], a[56:59], v[140:143]
s_waitcnt lgkmcnt(6)
v_mfma_f32_16x16x32_bf16 v[144:147], a[192:195], a[56:59], v[144:147]
v_mfma_f32_16x16x32_bf16 v[144:147], a[196:199], a[60:63], v[144:147]
v_mfma_f32_16x16x32_bf16 v[112:115], a[196:199], a[52:55], v[112:115]
ds_read_b64_tr_b16 a[160:161], v194 offset:32768
v_mfma_f32_16x16x32_bf16 v[112:115], a[192:195], a[48:51], v[112:115]
ds_read_b64_tr_b16 a[162:163], v194 offset:36864
v_mfma_f32_16x16x32_bf16 v[80:83], a[192:195], a[40:43], v[80:83]
ds_read_b64_tr_b16 a[164:165], v194 offset:40960
v_mfma_f32_16x16x32_bf16 v[80:83], a[196:199], a[44:47], v[80:83]
ds_write_b128 v3, v[108:111] offset:1024
v_mfma_f32_16x16x32_bf16 v[48:51], a[196:199], a[36:39], v[48:51]
ds_read_b64_tr_b16 a[166:167], v194 offset:45056
v_mfma_f32_16x16x32_bf16 v[48:51], a[192:195], a[32:35], v[48:51]
ds_write_b128 v3, v[140:143] offset:5120
v_mfma_f32_16x16x32_bf16 v[52:55], a[200:203], a[32:35], v[52:55]
v_mfma_f32_16x16x32_bf16 v[52:55], a[204:207], a[36:39], v[52:55]
ds_write_b128 v3, v[144:147] offset:6144
v_mfma_f32_16x16x32_bf16 v[84:87], a[204:207], a[44:47], v[84:87]
ds_read_b64_tr_b16 a[168:169], v195 offset:32768
v_mfma_f32_16x16x32_bf16 v[84:87], a[200:203], a[40:43], v[84:87]
ds_write_b128 v3, v[112:115] offset:2048
v_mfma_f32_16x16x32_bf16 v[116:119], a[200:203], a[48:51], v[116:119]
ds_read_b64_tr_b16 a[170:171], v195 offset:36864
v_mfma_f32_16x16x32_bf16 v[116:119], a[204:207], a[52:55], v[116:119]
ds_read_b64_tr_b16 a[172:173], v195 offset:40960
v_mfma_f32_16x16x32_bf16 v[148:151], a[204:207], a[60:63], v[148:151]
ds_read_b64_tr_b16 a[174:175], v195 offset:45056
v_mfma_f32_16x16x32_bf16 v[148:151], a[200:203], a[56:59], v[148:151]
v_mfma_f32_16x16x32_bf16 v[120:123], a[144:147], a[24:27], v[120:123]
v_mfma_f32_16x16x32_bf16 v[120:123], a[148:151], a[28:31], v[120:123]
v_mfma_f32_16x16x32_bf16 v[88:91], a[148:151], a[20:23], v[88:91]
ds_read_b64_tr_b16 a[176:177], v184 offset:0
v_mfma_f32_16x16x32_bf16 v[88:91], a[144:147], a[16:19], v[88:91]
ds_read_b64_tr_b16 a[178:179], v184 offset:4096
v_mfma_f32_16x16x32_bf16 v[56:59], a[144:147], a[8:11], v[56:59]
ds_read_b64_tr_b16 a[180:181], v184 offset:8192
v_mfma_f32_16x16x32_bf16 v[56:59], a[148:151], a[12:15], v[56:59]
ds_write_b128 v3, v[116:119] offset:3072
v_mfma_f32_16x16x32_bf16 v[24:27], a[148:151], a[4:7], v[24:27]
ds_read_b64_tr_b16 a[182:183], v184 offset:12288
v_mfma_f32_16x16x32_bf16 v[24:27], a[144:147], a[0:3], v[24:27]
s_waitcnt lgkmcnt(5)
ds_write_b128 v3, v[148:151] offset:7168
v_mfma_f32_16x16x32_bf16 v[28:31], a[152:155], a[0:3], v[28:31]
v_mfma_f32_16x16x32_bf16 v[28:31], a[156:159], a[4:7], v[28:31]
v_mfma_f32_16x16x32_bf16 v[60:63], a[156:159], a[12:15], v[60:63]
s_waitcnt lgkmcnt(0)
s_barrier
v_mfma_f32_16x16x32_bf16 v[60:63], a[152:155], a[8:11], v[60:63]
ds_read_b128 v[200:203], v2 offset:0
ds_read_b128 v[204:207], v2 offset:1024
v_mfma_f32_16x16x32_bf16 v[92:95], a[152:155], a[16:19], v[92:95]
ds_read_b128 v[208:211], v2 offset:2048
ds_read_b128 v[212:215], v2 offset:3072
v_mfma_f32_16x16x32_bf16 v[92:95], a[156:159], a[20:23], v[92:95]
ds_read_b128 v[216:219], v2 offset:4096
ds_read_b128 v[220:223], v2 offset:5120
v_mfma_f32_16x16x32_bf16 v[124:127], a[156:159], a[28:31], v[124:127]
ds_read_b128 v[224:227], v2 offset:6144
ds_read_b128 v[228:231], v2 offset:7168
v_mfma_f32_16x16x32_bf16 v[124:127], a[152:155], a[24:27], v[124:127]
ds_read_b64_tr_b16 a[184:185], v185 offset:0
v_mfma_f32_16x16x32_bf16 v[128:131], a[160:163], a[24:27], v[128:131]
ds_read_b64_tr_b16 a[186:187], v185 offset:4096
v_mfma_f32_16x16x32_bf16 v[128:131], a[164:167], a[28:31], v[128:131]
ds_read_b64_tr_b16 a[188:189], v185 offset:8192
v_mfma_f32_16x16x32_bf16 v[96:99], a[164:167], a[20:23], v[96:99]
s_waitcnt lgkmcnt(10)
ds_read_b64_tr_b16 a[190:191], v185 offset:12288
v_add_f32 v200, v200, v40
v_mfma_f32_16x16x32_bf16 v[96:99], a[160:163], a[16:19], v[96:99]
ds_read_b64_tr_b16 a[192:193], v186 offset:0
v_add_f32 v201, v201, v41
v_mfma_f32_16x16x32_bf16 v[64:67], a[160:163], a[8:11], v[64:67]
ds_read_b64_tr_b16 a[194:195], v186 offset:4096
v_add_f32 v202, v202, v42
v_mfma_f32_16x16x32_bf16 v[64:67], a[164:167], a[12:15], v[64:67]
ds_read_b64_tr_b16 a[196:197], v186 offset:8192
v_add_f32 v203, v203, v43
v_mfma_f32_16x16x32_bf16 v[32:35], a[164:167], a[4:7], v[32:35]
s_waitcnt lgkmcnt(7)
ds_read_b64_tr_b16 a[198:199], v186 offset:12288
v_add_f32 v204, v204, v44
v_mfma_f32_16x16x32_bf16 v[32:35], a[160:163], a[0:3], v[32:35]
v_add_f32 v205, v205, v45
v_add_f32 v206, v206, v46
v_mfma_f32_16x16x32_bf16 v[36:39], a[168:171], a[0:3], v[36:39]
v_add_f32 v207, v207, v47
v_cvt_pk_bf16_f32 v200, v200, v201
v_mfma_f32_16x16x32_bf16 v[36:39], a[172:175], a[4:7], v[36:39]
v_cvt_pk_bf16_f32 v201, v202, v203
v_cvt_pk_bf16_f32 v202, v204, v205
v_cvt_pk_bf16_f32 v203, v206, v207
v_mfma_f32_16x16x32_bf16 v[68:71], a[172:175], a[12:15], v[68:71]
buffer_store_dwordx4 v[200:203], v16, s[44:47], s73 offen offset:0 sc1
v_mfma_f32_16x16x32_bf16 v[68:71], a[168:171], a[8:11], v[68:71]
ds_read_b64_tr_b16 a[200:201], v187 offset:0
v_add_f32 v208, v208, v48
v_mfma_f32_16x16x32_bf16 v[100:103], a[168:171], a[16:19], v[100:103]
ds_read_b64_tr_b16 a[202:203], v187 offset:4096
v_add_f32 v209, v209, v49
v_mfma_f32_16x16x32_bf16 v[100:103], a[172:175], a[20:23], v[100:103]
ds_read_b64_tr_b16 a[204:205], v187 offset:8192
v_add_f32 v210, v210, v50
v_mfma_f32_16x16x32_bf16 v[132:135], a[172:175], a[28:31], v[132:135]
ds_read_b64_tr_b16 a[206:207], v187 offset:12288
v_add_f32 v211, v211, v51
v_mfma_f32_16x16x32_bf16 v[132:135], a[168:171], a[24:27], v[132:135]
v_add_f32 v212, v212, v52
v_add_f32 v213, v213, v53
v_mfma_f32_16x16x32_bf16 v[120:123], a[176:179], a[56:59], v[120:123]
v_add_f32 v214, v214, v54
v_add_f32 v215, v215, v55
v_mfma_f32_16x16x32_bf16 v[120:123], a[180:183], a[60:63], v[120:123]
v_cvt_pk_bf16_f32 v208, v208, v209
v_cvt_pk_bf16_f32 v209, v210, v211
v_cvt_pk_bf16_f32 v210, v212, v213
v_cvt_pk_bf16_f32 v211, v214, v215
v_mfma_f32_16x16x32_bf16 v[88:91], a[180:183], a[52:55], v[88:91]
buffer_store_dwordx4 v[208:211], v16, s[44:47], s73 offen offset:1024 sc1
v_mfma_f32_16x16x32_bf16 v[88:91], a[176:179], a[48:51], v[88:91]
v_add_f32 v216, v216, v72
v_add_f32 v217, v217, v73
v_mfma_f32_16x16x32_bf16 v[56:59], a[176:179], a[40:43], v[56:59]
v_add_f32 v218, v218, v74
v_add_f32 v219, v219, v75
v_mfma_f32_16x16x32_bf16 v[56:59], a[180:183], a[44:47], v[56:59]
v_add_f32 v220, v220, v76
v_add_f32 v221, v221, v77
v_mfma_f32_16x16x32_bf16 v[24:27], a[180:183], a[36:39], v[24:27]
v_add_f32 v222, v222, v78
v_add_f32 v223, v223, v79
v_mfma_f32_16x16x32_bf16 v[24:27], a[176:179], a[32:35], v[24:27]
s_waitcnt lgkmcnt(0)
v_cvt_pk_bf16_f32 v216, v216, v217
v_cvt_pk_bf16_f32 v217, v218, v219
v_mfma_f32_16x16x32_bf16 v[28:31], a[184:187], a[32:35], v[28:31]
v_cvt_pk_bf16_f32 v218, v220, v221
v_cvt_pk_bf16_f32 v219, v222, v223
v_mfma_f32_16x16x32_bf16 v[28:31], a[188:191], a[36:39], v[28:31]
buffer_store_dwordx4 v[216:219], v16, s[44:47], s73 offen offset:2048 sc1
v_mfma_f32_16x16x32_bf16 v[60:63], a[188:191], a[44:47], v[60:63]
v_add_f32 v224, v224, v80
v_add_f32 v225, v225, v81
v_mfma_f32_16x16x32_bf16 v[60:63], a[184:187], a[40:43], v[60:63]
v_add_f32 v226, v226, v82
v_add_f32 v227, v227, v83
v_mfma_f32_16x16x32_bf16 v[92:95], a[184:187], a[48:51], v[92:95]
v_add_f32 v228, v228, v84
v_add_f32 v229, v229, v85
v_mfma_f32_16x16x32_bf16 v[92:95], a[188:191], a[52:55], v[92:95]
v_add_f32 v230, v230, v86
v_add_f32 v231, v231, v87
v_mfma_f32_16x16x32_bf16 v[124:127], a[188:191], a[60:63], v[124:127]
v_cvt_pk_bf16_f32 v224, v224, v225
v_cvt_pk_bf16_f32 v225, v226, v227
v_mfma_f32_16x16x32_bf16 v[124:127], a[184:187], a[56:59], v[124:127]
v_cvt_pk_bf16_f32 v226, v228, v229
v_cvt_pk_bf16_f32 v227, v230, v231
v_mfma_f32_16x16x32_bf16 v[128:131], a[192:195], a[56:59], v[128:131]
buffer_store_dwordx4 v[224:227], v16, s[44:47], s73 offen offset:3072 sc1
v_mfma_f32_16x16x32_bf16 v[128:131], a[196:199], a[60:63], v[128:131]
ds_write_b128 v3, v[120:123] offset:36864
v_mfma_f32_16x16x32_bf16 v[96:99], a[196:199], a[52:55], v[96:99]
ds_write_b128 v3, v[88:91] offset:32768
v_mfma_f32_16x16x32_bf16 v[96:99], a[192:195], a[48:51], v[96:99]
v_mfma_f32_16x16x32_bf16 v[64:67], a[192:195], a[40:43], v[64:67]
v_mfma_f32_16x16x32_bf16 v[64:67], a[196:199], a[44:47], v[64:67]
ds_write_b128 v3, v[92:95] offset:33792
v_mfma_f32_16x16x32_bf16 v[32:35], a[196:199], a[36:39], v[32:35]
v_mfma_f32_16x16x32_bf16 v[32:35], a[192:195], a[32:35], v[32:35]
ds_write_b128 v3, v[124:127] offset:37888
v_mfma_f32_16x16x32_bf16 v[36:39], a[200:203], a[32:35], v[36:39]
v_mfma_f32_16x16x32_bf16 v[36:39], a[204:207], a[36:39], v[36:39]
ds_write_b128 v3, v[128:131] offset:38912
v_mfma_f32_16x16x32_bf16 v[68:71], a[204:207], a[44:47], v[68:71]
v_mfma_f32_16x16x32_bf16 v[68:71], a[200:203], a[40:43], v[68:71]
ds_write_b128 v3, v[96:99] offset:34816
v_mfma_f32_16x16x32_bf16 v[100:103], a[200:203], a[48:51], v[100:103]
v_mfma_f32_16x16x32_bf16 v[100:103], a[204:207], a[52:55], v[100:103]
v_mfma_f32_16x16x32_bf16 v[132:135], a[204:207], a[60:63], v[132:135]
v_mfma_f32_16x16x32_bf16 v[132:135], a[200:203], a[56:59], v[132:135]
buffer_load_dwordx4 v[152:155], v16, s[44:47], s75 offen offset:0 sc1
buffer_load_dwordx4 v[156:159], v16, s[44:47], s75 offen offset:1024 sc1
buffer_load_dwordx4 v[160:163], v16, s[44:47], s75 offen offset:2048 sc1
buffer_load_dwordx4 v[164:167], v16, s[44:47], s75 offen offset:3072 sc1
s_nop 3
ds_write_b128 v3, v[100:103] offset:35840
ds_write_b128 v3, v[132:135] offset:39936
s_mov_b32 s72, 0x20000
s_waitcnt lgkmcnt(0)
s_barrier
ds_read_b128 v[88:91], v2 offset:32768
ds_read_b128 v[92:95], v2 offset:33792
ds_read_b128 v[96:99], v2 offset:34816
ds_read_b128 v[100:103], v2 offset:35840
ds_read_b128 v[120:123], v2 offset:36864
ds_read_b128 v[124:127], v2 offset:37888
ds_read_b128 v[128:131], v2 offset:38912
ds_read_b128 v[132:135], v2 offset:39936
s_waitcnt lgkmcnt(7)
v_add_f32 v24, v24, v88
v_add_f32 v25, v25, v89
v_add_f32 v26, v26, v90
v_add_f32 v27, v27, v91
s_waitcnt lgkmcnt(6)
v_add_f32 v28, v28, v92
v_add_f32 v29, v29, v93
v_add_f32 v30, v30, v94
v_add_f32 v31, v31, v95
s_waitcnt lgkmcnt(5)
v_add_f32 v32, v32, v96
v_add_f32 v33, v33, v97
v_add_f32 v34, v34, v98
v_add_f32 v35, v35, v99
s_waitcnt lgkmcnt(4)
v_add_f32 v36, v36, v100
v_add_f32 v37, v37, v101
v_add_f32 v38, v38, v102
v_add_f32 v39, v39, v103
s_waitcnt lgkmcnt(3)
v_add_f32 v56, v56, v120
v_add_f32 v57, v57, v121
v_add_f32 v58, v58, v122
v_add_f32 v59, v59, v123
s_waitcnt lgkmcnt(2)
v_add_f32 v60, v60, v124
v_add_f32 v61, v61, v125
v_add_f32 v62, v62, v126
v_add_f32 v63, v63, v127
s_waitcnt lgkmcnt(1)
v_add_f32 v64, v64, v128
v_add_f32 v65, v65, v129
v_add_f32 v66, v66, v130
v_add_f32 v67, v67, v131
s_waitcnt lgkmcnt(0)
v_add_f32 v68, v68, v132
v_add_f32 v69, v69, v133
v_add_f32 v70, v70, v134
v_add_f32 v71, v71, v135
L_xchk:
s_waitcnt vmcnt(0)
v_max3_u32 v9, v152, v153, v154
v_max3_u32 v9, v9, v155, v156
v_max3_u32 v9, v9, v157, v158
v_max3_u32 v9, v9, v159, v160
v_max3_u32 v9, v9, v161, v162
v_max3_u32 v9, v9, v163, v164
v_max3_u32 v9, v9, v165, v166
v_max_u32 v9, v9, v167
v_cmp_eq_u32 vcc, -1, v9
s_cbranch_vccnz L_xretry
L_xgo:
v_mfma_f32_16x16x32_bf16 v[24:27], v[234:237], v[152:155], v[24:27]
v_mfma_f32_16x16x32_bf16 v[28:31], v[232:235], v[152:155], v[28:31]
v_mfma_f32_16x16x32_bf16 v[32:35], v[234:237], v[156:159], v[32:35]
v_mfma_f32_16x16x32_bf16 v[36:39], v[232:235], v[156:159], v[36:39]
v_mfma_f32_16x16x32_bf16 v[56:59], v[234:237], v[160:163], v[56:59]
v_mfma_f32_16x16x32_bf16 v[60:63], v[232:235], v[160:163], v[60:63]
v_mfma_f32_16x16x32_bf16 v[64:67], v[234:237], v[164:167], v[64:67]
v_mfma_f32_16x16x32_bf16 v[68:71], v[232:235], v[164:167], v[68:71]
s_nop 1
v_cvt_pk_bf16_f32 v24, v24, v25
v_cvt_pk_bf16_f32 v25, v26, v27
v_cvt_pk_bf16_f32 v26, v28, v29
v_cvt_pk_bf16_f32 v27, v30, v31
v_cvt_pk_bf16_f32 v32, v32, v33
v_cvt_pk_bf16_f32 v33, v34, v35
v_cvt_pk_bf16_f32 v34, v36, v37
v_cvt_pk_bf16_f32 v35, v38, v39
v_permlane16_swap_b32 v24, v26
v_permlane16_swap_b32 v25, v27
v_permlane16_swap_b32 v32, v34
v_permlane16_swap_b32 v33, v35
v_mov_b32 v28, v24
v_mov_b32 v29, v25
v_mov_b32 v30, v26
v_mov_b32 v31, v27
v_mov_b32_dpp v24, v32 row_ror:8 row_mask:0xf bank_mask:0xc
v_mov_b32_dpp v25, v33 row_ror:8 row_mask:0xf bank_mask:0xc
v_mov_b32_dpp v26, v34 row_ror:8 row_mask:0xf bank_mask:0xc
v_mov_b32_dpp v27, v35 row_ror:8 row_mask:0xf bank_mask:0xc
v_mov_b32_dpp v32, v28 row_ror:8 row_mask:0xf bank_mask:0x3
v_mov_b32_dpp v33, v29 row_ror:8 row_mask:0xf bank_mask:0x3
v_mov_b32_dpp v34, v30 row_ror:8 row_mask:0xf bank_mask:0x3
v_mov_b32_dpp v35, v31 row_ror:8 row_mask:0xf bank_mask:0x3
buffer_store_dwordx4 v[24:27], v8, s[48:51], s77 offen sc1
s_add_u32 s77, s77, 16384
buffer_store_dwordx4 v[32:35], v8, s[48:51], s77 offen sc1
s_add_u32 s77, s77, 16384
v_cvt_pk_bf16_f32 v56, v56, v57
v_cvt_pk_bf16_f32 v57, v58, v59
v_cvt_pk_bf16_f32 v58, v60, v61
v_cvt_pk_bf16_f32 v59, v62, v63
v_cvt_pk_bf16_f32 v64, v64, v65
v_cvt_pk_bf16_f32 v65, v66, v67
v_cvt_pk_bf16_f32 v66, v68, v69
v_cvt_pk_bf16_f32 v67, v70, v71
v_permlane16_swap_b32 v56, v58
v_permlane16_swap_b32 v57, v59
v_permlane16_swap_b32 v64, v66
v_permlane16_swap_b32 v65, v67
v_mov_b32 v60, v56
v_mov_b32 v61, v57
v_mov_b32 v62, v58
v_mov_b32 v63, v59
v_mov_b32_dpp v56, v64 row_ror:8 row_mask:0xf bank_mask:0xc
v_mov_b32_dpp v57, v65 row_ror:8 row_mask:0xf bank_mask:0xc
v_mov_b32_dpp v58, v66 row_ror:8 row_mask:0xf bank_mask:0xc
v_mov_b32_dpp v59, v67 row_ror:8 row_mask:0xf bank_mask:0xc
v_mov_b32_dpp v64, v60 row_ror:8 row_mask:0xf bank_mask:0x3
v_mov_b32_dpp v65, v61 row_ror:8 row_mask:0xf bank_mask:0x3
v_mov_b32_dpp v66, v62 row_ror:8 row_mask:0xf bank_mask:0x3
v_mov_b32_dpp v67, v63 row_ror:8 row_mask:0xf bank_mask:0x3
buffer_store_dwordx4 v[56:59], v8, s[48:51], s77 offen sc1
s_add_u32 s77, s77, 16384
buffer_store_dwordx4 v[64:67], v8, s[48:51], s77 offen sc1
s_add_u32 s77, s77, 16384
L_end:
s_endpgm
L_xretry:
s_sub_u32 s72, s72, 1
s_cbranch_scc1 L_xgo
buffer_load_dwordx4 v[152:155], v16, s[44:47], s75 offen offset:0 sc1
buffer_load_dwordx4 v[156:159], v16, s[44:47], s75 offen offset:1024 sc1
buffer_load_dwordx4 v[160:163], v16, s[44:47], s75 offen offset:2048 sc1
buffer_load_dwordx4 v[164:167], v16, s[44:47], s75 offen offset:3072 sc1
s_branch L_xchk
L_spin_1:
s_mov_b32 vcc_hi, 0x80000
L_spinlp_3:
s_sleep 1
buffer_load_dword v1, off, s[52:55], s78 offset:0 sc1
s_waitcnt vmcnt(0)
v_readfirstlane_b32 vcc_lo, v1
s_sub_u32 vcc_hi, vcc_hi, 1
s_cbranch_scc1 L_spinbk_2
s_cmp_lt_u32 vcc_lo, s81
s_cbranch_scc1 L_spinlp_3
s_branch L_spinbk_2
L_spin_4:
s_mov_b32 vcc_hi, 0x80000
L_spinlp_6:
s_sleep 1
buffer_load_dword v1, off, s[52:55], s70 offset:0 sc1
s_waitcnt vmcnt(0)
v_readfirstlane_b32 vcc_lo, v1
s_sub_u32 vcc_hi, vcc_hi, 1
s_cbranch_scc1 L_spinbk_5
s_cmp_lt_u32 vcc_lo, s81
s_cbranch_scc1 L_spinlp_6
s_branch L_spinbk_5
L_hretry:
s_sub_u32 s72, s72, 1
s_cbranch_scc1 L_hgo
buffer_load_dwordx4 v[88:91], v16, s[44:47], s77 offen sc1
s_waitcnt vmcnt(0)
s_branch L_hchk
L_spin_8:
s_mov_b32 vcc_hi, 0x80000
L_spinlp_10:
s_sleep 1
buffer_load_dword v19, off, s[52:55], s80 offset:0 sc1
s_waitcnt vmcnt(0)
v_readfirstlane_b32 vcc_lo, v19
s_sub_u32 vcc_hi, vcc_hi, 1
s_cbranch_scc1 L_spinbk_9
s_cmp_lt_u32 vcc_lo, s69
s_cbranch_scc1 L_spinlp_10
s_branch L_spinbk_9
L_spin_1012:
s_mov_b32 vcc_hi, 0x80000
L_spinlp_1014:
s_sleep 1
buffer_load_dword v19, off, s[52:55], s80 offset:0 sc1
s_waitcnt vmcnt(0)
v_readfirstlane_b32 vcc_lo, v19
s_sub_u32 vcc_hi, vcc_hi, 1
s_cbranch_scc1 L_spinbk_1013
s_cmp_lt_u32 vcc_lo, s69
s_cbranch_scc1 L_spinlp_1014
s_branch L_spinbk_1013
L_F1:
ds_read_b128 a[144:147], v2 offset:0
ds_read_b128 a[148:151], v2 offset:1024
ds_read_b128 a[152:155], v2 offset:2048
ds_read_b128 a[156:159], v2 offset:3072
ds_read_b128 a[160:163], v2 offset:4096
ds_read_b128 a[164:167], v2 offset:5120
ds_read_b128 a[168:171], v2 offset:6144
ds_read_b128 a[172:175], v2 offset:7168
s_mov_b32 m0, s71
s_nop 0
buffer_load_dwordx4 v16, s[32:35], s70 offen offset:0 sc1 lds
buffer_load_dwordx4 v16, s[32:35], s70 offen offset:1024 sc1 lds
s_waitcnt lgkmcnt(7)
v_mfma_f32_16x16x32_bf16 v[104:107], a[144:147], v[40:43], 0
s_waitcnt lgkmcnt(6)
ds_read_b128 a[176:179], v2 offset:8192
v_cndmask_b32 v88, 0, v17, s[0:1]
v_mfma_f32_16x16x32_bf16 v[104:107], a[148:151], v[44:47], v[104:107]
s_waitcnt lgkmcnt(6)
ds_read_b128 a[180:183], v2 offset:9216
v_cndmask_b32 v89, 0, v17, s[4:5]
v_mfma_f32_16x16x32_bf16 v[104:107], a[152:155], v[48:51], v[104:107]
s_waitcnt lgkmcnt(6)
buffer_load_dwordx4 v16, s[32:35], s70 offen offset:2048 sc1 lds
v_mfma_f32_16x16x32_bf16 v[104:107], a[156:159], v[52:55], v[104:107]
ds_read_b128 a[184:187], v2 offset:10240
v_cndmask_b32 v90, 0, v17, s[6:7]
v_mfma_f32_16x16x32_bf16 v[120:123], a[156:159], v[68:71], 0
ds_read_b128 a[188:191], v2 offset:11264
v_cndmask_b32 v91, 0, v17, s[8:9]
v_mfma_f32_16x16x32_bf16 v[120:123], a[152:155], v[64:67], v[120:123]
ds_read_b128 a[192:195], v2 offset:12288
v_accvgpr_write_b32 a128, 0
v_mfma_f32_16x16x32_bf16 v[120:123], a[148:151], v[60:63], v[120:123]
ds_read_b128 a[196:199], v2 offset:13312
v_accvgpr_write_b32 a129, 0
v_mfma_f32_16x16x32_bf16 v[120:123], a[144:147], v[56:59], v[120:123]
ds_read_b128 a[200:203], v2 offset:14336
v_accvgpr_write_b32 a130, 0
v_mfma_f32_16x16x32_bf16 v[136:139], a[144:147], v[72:75], 0
ds_read_b128 a[204:207], v2 offset:15360
v_accvgpr_write_b32 a131, 0
v_mfma_f32_16x16x32_bf16 v[136:139], a[148:151], v[76:79], v[136:139]
buffer_load_dwordx4 v16, s[32:35], s70 offen offset:3072 sc1 lds
v_mfma_f32_16x16x32_bf16 v[136:139], a[152:155], v[80:83], v[136:139]
v_accvgpr_write_b32 a132, 0
v_accvgpr_write_b32 a133, 0
v_mfma_f32_16x16x32_bf16 v[136:139], a[156:159], v[84:87], v[136:139]
v_accvgpr_write_b32 a134, 0
v_accvgpr_write_b32 a135, 0
v_mfma_f32_16x16x32_bf16 v[88:91], a[156:159], v[36:39], v[88:91]
v_accvgpr_write_b32 a136, 0
v_accvgpr_write_b32 a137, 0
v_mfma_f32_16x16x32_bf16 v[88:91], a[152:155], v[32:35], v[88:91]
v_accvgpr_write_b32 a138, 0
v_accvgpr_write_b32 a139, 0
v_mfma_f32_16x16x32_bf16 v[88:91], a[148:151], v[28:31], v[88:91]
v_accvgpr_write_b32 a140, 0
v_accvgpr_write_b32 a141, 0
v_mfma_f32_16x16x32_bf16 v[88:91], a[144:147], v[24:27], v[88:91]
s_waitcnt lgkmcnt(0)
s_nop 1
v_max3_f32 v21, v104, v105, v106
v_max_f32 v21, v21, v107
v_max3_f32 v22, v120, v121, v122
v_max_f32 v22, v22, v123
v_max3_f32 v23, v136, v137, v138
v_max_f32 v23, v23, v139
v_max3_f32 v20, v88, v89, v90
v_max_f32 v20, v20, v91
v_mov_b32 v248, v20
v_mov_b32 v249, v21
v_mov_b32 v250, v22
v_mov_b32 v251, v23
v_permlane16_swap_b32 v248, v20
v_permlane16_swap_b32 v249, v21
v_permlane16_swap_b32 v250, v22
v_permlane16_swap_b32 v251, v23
v_max_f32 v20, v20, v248
v_max_f32 v21, v21, v249
v_max_f32 v22, v22, v250
v_max_f32 v23, v23, v251
v_mov_b32 v248, v20
v_mov_b32 v249, v21
v_mov_b32 v250, v22
v_mov_b32 v251, v23
v_permlane32_swap_b32 v248, v20
v_permlane32_swap_b32 v249, v21
v_permlane32_swap_b32 v250, v22
v_permlane32_swap_b32 v251, v23
v_max_f32 v20, v20, v248
v_max_f32 v21, v21, v249
v_max_f32 v22, v22, v250
v_max_f32 v23, v23, v251
s_cmp_eq_u32 s73, 0
s_cselect_b64 vcc, 0, -1
v_cndmask_b32 v20, v20, v252, vcc
v_cndmask_b32 v21, v21, v253, vcc
v_cndmask_b32 v22, v22, v254, vcc
v_cndmask_b32 v23, v23, v255, vcc
v_sub_f32 v228, 0, v23
v_sub_f32 v229, 0, v23
v_sub_f32 v230, 0, v23
v_sub_f32 v231, 0, v23
v_sub_f32 v224, 0, v22
v_sub_f32 v225, 0, v22
v_sub_f32 v226, 0, v22
v_sub_f32 v227, 0, v22
v_sub_f32 v220, 0, v21
v_sub_f32 v221, 0, v21
v_sub_f32 v222, 0, v21
v_sub_f32 v223, 0, v21
v_sub_f32 v216, 0, v20
v_sub_f32 v217, 0, v20
v_sub_f32 v218, 0, v20
v_sub_f32 v219, 0, v20
v_mfma_f32_16x16x32_bf16 v[140:143], a[160:163], v[72:75], v[228:231]
s_add_u32 m0, s71, 4096
v_add_f32 v104, v104, v220
v_add_f32 v105, v105, v220
v_mfma_f32_16x16x32_bf16 v[140:143], a[164:167], v[76:79], v[140:143]
v_add_f32 v106, v106, v220
v_add_f32 v107, v107, v220
v_exp_f32 v104, v104
v_mfma_f32_16x16x32_bf16 v[140:143], a[168:171], v[80:83], v[140:143]
s_add_u32 s64, s70, 4096
v_exp_f32 v105, v105
v_mfma_f32_16x16x32_bf16 v[140:143], a[172:175], v[84:87], v[140:143]
buffer_load_dwordx4 v16, s[32:35], s64 offen offset:0 sc1 lds
v_mfma_f32_16x16x32_bf16 v[124:127], a[172:175], v[68:71], v[224:227]
v_exp_f32 v106, v106
v_mfma_f32_16x16x32_bf16 v[124:127], a[168:171], v[64:67], v[124:127]
v_exp_f32 v107, v107
v_mfma_f32_16x16x32_bf16 v[124:127], a[164:167], v[60:63], v[124:127]
v_add_f32 v120, v120, v224
v_add_f32 v121, v121, v224
v_add_f32 v122, v122, v224
v_add_f32 v123, v123, v224
v_exp_f32 v120, v120
v_mfma_f32_16x16x32_bf16 v[124:127], a[160:163], v[56:59], v[124:127]
v_exp_f32 v121, v121
v_mfma_f32_16x16x32_bf16 v[108:111], a[160:163], v[40:43], v[220:223]
v_exp_f32 v122, v122
v_mfma_f32_16x16x32_bf16 v[108:111], a[164:167], v[44:47], v[108:111]
v_cndmask_b32 v92, v216, v17, s[10:11]
v_cndmask_b32 v93, v216, v17, s[12:13]
v_cndmask_b32 v94, v216, v17, s[18:19]
v_cndmask_b32 v95, v216, v17, s[22:23]
v_mfma_f32_16x16x32_bf16 v[108:111], a[168:171], v[48:51], v[108:111]
buffer_load_dwordx4 v16, s[32:35], s64 offen offset:1024 sc1 lds
v_cvt_pk_bf16_f32 v160, v104, v105
v_mfma_f32_16x16x32_bf16 v[108:111], a[172:175], v[52:55], v[108:111]
v_exp_f32 v123, v123
v_mfma_f32_16x16x32_bf16 v[92:95], a[172:175], v[36:39], v[92:95]
v_add_f32 v136, v136, v228
v_add_f32 v137, v137, v228
v_add_f32 v138, v138, v228
v_add_f32 v139, v139, v228
v_exp_f32 v136, v136
v_mfma_f32_16x16x32_bf16 v[92:95], a[168:171], v[32:35], v[92:95]
v_cvt_pk_bf16_f32 v161, v106, v107
v_exp_f32 v137, v137
v_cndmask_b32 v96, v216, v17, s[26:27]
v_cndmask_b32 v97, v216, v17, s[56:57]
v_cndmask_b32 v98, v216, v17, s[58:59]
v_cndmask_b32 v99, v216, v17, s[60:61]
v_mfma_f32_16x16x32_bf16 v[92:95], a[164:167], v[28:31], v[92:95]
v_exp_f32 v138, v138
v_mfma_f32_16x16x32_bf16 v[92:95], a[160:163], v[24:27], v[92:95]
v_exp_f32 v139, v139
v_mfma_f32_16x16x32_bf16 v[96:99], a[176:179], v[24:27], v[96:99]
v_cvt_pk_bf16_f32 v184, v120, v121
v_add_f32 v88, v88, v216
v_mfma_f32_16x16x32_bf16 v[96:99], a[180:183], v[28:31], v[96:99]
buffer_load_dwordx4 v16, s[32:35], s64 offen offset:2048 sc1 lds
v_add_f32 v89, v89, v216
v_add_f32 v90, v90, v216
v_add_f32 v91, v91, v216
v_exp_f32 v88, v88
v_mfma_f32_16x16x32_bf16 v[96:99], a[184:187], v[32:35], v[96:99]
v_exp_f32 v89, v89
v_mfma_f32_16x16x32_bf16 v[96:99], a[188:191], v[36:39], v[96:99]
v_cvt_pk_bf16_f32 v185, v122, v123
v_cvt_pk_bf16_f32 v192, v136, v137
v_mfma_f32_16x16x32_bf16 v[112:115], a[188:191], v[52:55], v[220:223]
v_exp_f32 v90, v90
v_mfma_f32_16x16x32_bf16 v[112:115], a[184:187], v[48:51], v[112:115]
v_exp_f32 v91, v91
v_mfma_f32_16x16x32_bf16 v[112:115], a[180:183], v[44:47], v[112:115]
v_exp_f32 v140, v140
v_mfma_f32_16x16x32_bf16 v[112:115], a[176:179], v[40:43], v[112:115]
v_exp_f32 v141, v141
v_mfma_f32_16x16x32_bf16 v[128:131], a[176:179], v[56:59], v[224:227]
buffer_load_dwordx4 v16, s[32:35], s64 offen offset:3072 sc1 lds
v_cvt_pk_bf16_f32 v193, v138, v139
v_mfma_f32_16x16x32_bf16 v[128:131], a[180:183], v[60:63], v[128:131]
v_exp_f32 v142, v142
v_mfma_f32_16x16x32_bf16 v[128:131], a[184:187], v[64:67], v[128:131]
v_exp_f32 v143, v143
v_mfma_f32_16x16x32_bf16 v[128:131], a[188:191], v[68:71], v[128:131]
v_cvt_pk_bf16_f32 v152, v88, v89
v_cvt_pk_bf16_f32 v153, v90, v91
v_mfma_f32_16x16x32_bf16 v[144:147], a[188:191], v[84:87], v[228:231]
v_exp_f32 v124, v124
v_mfma_f32_16x16x32_bf16 v[144:147], a[184:187], v[80:83], v[144:147]
v_exp_f32 v125, v125
v_mfma_f32_16x16x32_bf16 v[144:147], a[180:183], v[76:79], v[144:147]
s_waitcnt vmcnt(8)
s_barrier
v_mfma_f32_16x16x32_bf16 v[144:147], a[176:179], v[72:75], v[144:147]
v_exp_f32 v126, v126
v_mfma_f32_16x16x32_bf16 v[148:151], a[192:195], v[72:75], v[228:231]
v_cvt_pk_bf16_f32 v194, v140, v141
v_cvt_pk_bf16_f32 v195, v142, v143
v_mfma_f32_16x16x32_bf16 v[148:151], a[196:199], v[76:79], v[148:151]
v_exp_f32 v127, v127
v_mfma_f32_16x16x32_bf16 v[148:151], a[200:203], v[80:83], v[148:151]
s_xor_b32 s71, s71, 16384
v_exp_f32 v108, v108
v_mfma_f32_16x16x32_bf16 v[148:151], a[204:207], v[84:87], v[148:151]
s_add_u32 s70, s70, 32768
v_exp_f32 v109, v109
v_mfma_f32_16x16x32_bf16 v[132:135], a[204:207], v[68:71], v[224:227]
s_mov_b32 m0, s71
v_exp_f32 v110, v110
v_mfma_f32_16x16x32_bf16 v[132:135], a[200:203], v[64:67], v[132:135]
buffer_load_dwordx4 v16, s[32:35], s70 offen offset:0 sc1 lds
v_mfma_f32_16x16x32_bf16 v[132:135], a[196:199], v[60:63], v[132:135]
v_cvt_pk_bf16_f32 v186, v124, v125
v_exp_f32 v111, v111
v_mfma_f32_16x16x32_bf16 v[132:135], a[192:195], v[56:59], v[132:135]
v_exp_f32 v92, v92
v_mfma_f32_16x16x32_bf16 v[116:119], a[192:195], v[40:43], v[220:223]
ds_read_b128 a[144:147], v2 offset:16384
v_cndmask_b32 v100, v216, v17, s[62:63]
v_mfma_f32_16x16x32_bf16 v[116:119], a[196:199], v[44:47], v[116:119]
ds_read_b128 a[148:151], v2 offset:17408
v_cndmask_b32 v101, v216, v17, s[48:49]
v_cndmask_b32 v102, v216, v17, s[50:51]
v_cndmask_b32 v103, v216, v17, s[100:101]
v_cvt_pk_bf16_f32 v187, v126, v127
v_exp_f32 v93, v93
v_mfma_f32_16x16x32_bf16 v[116:119], a[200:203], v[48:51], v[116:119]
v_exp_f32 v94, v94
v_mfma_f32_16x16x32_bf16 v[116:119], a[204:207], v[52:55], v[116:119]
ds_read_b128 a[152:155], v2 offset:18432
v_cvt_pk_bf16_f32 v162, v108, v109
v_mfma_f32_16x16x32_bf16 v[100:103], a[204:207], v[36:39], v[100:103]
buffer_load_dwordx4 v16, s[32:35], s70 offen offset:1024 sc1 lds
v_exp_f32 v95, v95
v_mfma_f32_16x16x32_bf16 v[100:103], a[200:203], v[32:35], v[100:103]
ds_read_b128 a[156:159], v2 offset:19456
v_exp_f32 v96, v96
v_mfma_f32_16x16x32_bf16 v[100:103], a[196:199], v[28:31], v[100:103]
v_cvt_pk_bf16_f32 v163, v110, v111
v_exp_f32 v97, v97
v_mfma_f32_16x16x32_bf16 v[100:103], a[192:195], v[24:27], v[100:103]
s_waitcnt lgkmcnt(2)
ds_read_b128 a[160:163], v2 offset:20480
ds_read_b128 a[164:167], v2 offset:21504
ds_read_b128 a[168:171], v2 offset:22528
ds_read_b128 a[172:175], v2 offset:23552
v_mfma_f32_16x16x32_bf16 v[120:123], a[144:147], v[56:59], v[224:227]
v_exp_f32 v98, v98
v_mfma_f32_16x16x32_bf16 v[120:123], a[148:151], v[60:63], v[120:123]
s_waitcnt lgkmcnt(5)
v_cvt_pk_bf16_f32 v154, v92, v93
v_exp_f32 v99, v99
v_mfma_f32_16x16x32_bf16 v[120:123], a[152:155], v[64:67], v[120:123]
s_waitcnt lgkmcnt(4)
v_exp_f32 v112, v112
v_mfma_f32_16x16x32_bf16 v[120:123], a[156:159], v[68:71], v[120:123]
v_exp_f32 v113, v113
v_mfma_f32_16x16x32_bf16 v[136:139], a[156:159], v[84:87], v[228:231]
v_cvt_pk_bf16_f32 v155, v94, v95
v_cndmask_b32 v104, v220, v17, s[0:1]
v_mfma_f32_16x16x32_bf16 v[136:139], a[152:155], v[80:83], v[136:139]
ds_read_b128 a[176:179], v2 offset:24576
buffer_load_dwordx4 v16, s[32:35], s70 offen offset:2048 sc1 lds
v_cndmask_b32 v105, v220, v17, s[4:5]
v_cndmask_b32 v106, v220, v17, s[6:7]
v_cndmask_b32 v107, v220, v17, s[8:9]
v_exp_f32 v114, v114
v_mfma_f32_16x16x32_bf16 v[136:139], a[148:151], v[76:79], v[136:139]
v_cvt_pk_bf16_f32 v156, v96, v97
v_cvt_pk_bf16_f32 v157, v98, v99
v_mfma_f32_16x16x32_bf16 v[136:139], a[144:147], v[72:75], v[136:139]
v_exp_f32 v115, v115
v_mfma_f32_16x16x32_bf16 v[104:107], a[144:147], v[40:43], v[104:107]
v_exp_f32 v128, v128
v_mfma_f32_16x16x32_bf16 v[104:107], a[148:151], v[44:47], v[104:107]
v_exp_f32 v129, v129
v_mfma_f32_16x16x32_bf16 v[104:107], a[152:155], v[48:51], v[104:107]
v_exp_f32 v130, v130
v_mfma_f32_16x16x32_bf16 v[104:107], a[156:159], v[52:55], v[104:107]
s_waitcnt lgkmcnt(0)
v_exp_f32 v131, v131
v_mfma_f32_16x16x32_bf16 v[140:143], a[172:175], v[84:87], v[228:231]
v_cvt_pk_bf16_f32 v164, v112, v113
v_cvt_pk_bf16_f32 v165, v114, v115
v_mfma_f32_16x16x32_bf16 v[140:143], a[168:171], v[80:83], v[140:143]
v_exp_f32 v144, v144
v_mfma_f32_16x16x32_bf16 v[140:143], a[164:167], v[76:79], v[140:143]
v_exp_f32 v145, v145
v_mfma_f32_16x16x32_bf16 v[140:143], a[160:163], v[72:75], v[140:143]
v_exp_f32 v146, v146
v_mfma_f32_16x16x32_bf16 v[124:127], a[160:163], v[56:59], v[224:227]
ds_read_b128 a[180:183], v2 offset:25600
v_cndmask_b32 v108, v220, v17, s[10:11]
v_mfma_f32_16x16x32_bf16 v[124:127], a[164:167], v[60:63], v[124:127]
ds_read_b128 a[184:187], v2 offset:26624
buffer_load_dwordx4 v16, s[32:35], s70 offen offset:3072 sc1 lds
v_cndmask_b32 v109, v220, v17, s[12:13]
v_cndmask_b32 v110, v220, v17, s[18:19]
v_cndmask_b32 v111, v220, v17, s[22:23]
v_cvt_pk_bf16_f32 v188, v128, v129
v_mfma_f32_16x16x32_bf16 v[124:127], a[168:171], v[64:67], v[124:127]
s_add_u32 m0, s86, 131072
v_exp_f32 v147, v147
v_mfma_f32_16x16x32_bf16 v[124:127], a[172:175], v[68:71], v[124:127]
s_add_u32 s64, s85, 0
ds_read_b128 a[188:191], v2 offset:27648
v_exp_f32 v148, v148
v_mfma_f32_16x16x32_bf16 v[108:111], a[172:175], v[52:55], v[108:111]
buffer_load_dwordx4 v12, s[36:39], s64 offen lds
v_cvt_pk_bf16_f32 v189, v130, v131
v_exp_f32 v149, v149
v_mfma_f32_16x16x32_bf16 v[108:111], a[168:171], v[48:51], v[108:111]
s_add_u32 m0, s86, 132096
ds_read_b128 a[192:195], v2 offset:28672
v_cndmask_b32 v112, v220, v17, s[26:27]
v_cndmask_b32 v113, v220, v17, s[56:57]
v_cndmask_b32 v114, v220, v17, s[58:59]
v_cndmask_b32 v115, v220, v17, s[60:61]
v_mfma_f32_16x16x32_bf16 v[108:111], a[164:167], v[44:47], v[108:111]
s_add_u32 s64, s85, 8192
v_exp_f32 v150, v150
v_mfma_f32_16x16x32_bf16 v[108:111], a[160:163], v[40:43], v[108:111]
buffer_load_dwordx4 v13, s[36:39], s64 offen lds
v_cvt_pk_bf16_f32 v196, v144, v145
v_exp_f32 v151, v151
v_mfma_f32_16x16x32_bf16 v[112:115], a[176:179], v[40:43], v[112:115]
s_waitcnt lgkmcnt(2)
s_add_u32 m0, s86, 133120
v_exp_f32 v132, v132
v_mfma_f32_16x16x32_bf16 v[112:115], a[180:183], v[44:47], v[112:115]
s_add_u32 s64, s85, 16384
v_exp_f32 v133, v133
v_mfma_f32_16x16x32_bf16 v[112:115], a[184:187], v[48:51], v[112:115]
s_waitcnt lgkmcnt(1)
buffer_load_dwordx4 v12, s[36:39], s64 offen lds
v_cvt_pk_bf16_f32 v197, v146, v147
v_mfma_f32_16x16x32_bf16 v[112:115], a[188:191], v[52:55], v[112:115]
s_add_u32 m0, s86, 134144
v_exp_f32 v134, v134
v_mfma_f32_16x16x32_bf16 v[128:131], a[188:191], v[68:71], v[224:227]
s_add_u32 s64, s85, 24576
ds_read_b128 a[196:199], v2 offset:29696
ds_read_b128 a[200:203], v2 offset:30720
ds_read_b128 a[204:207], v2 offset:31744
v_cvt_pk_bf16_f32 v198, v148, v149
v_mfma_f32_16x16x32_bf16 v[128:131], a[184:187], v[64:67], v[128:131]
buffer_load_dwordx4 v13, s[36:39], s64 offen lds
v_exp_f32 v135, v135
v_mfma_f32_16x16x32_bf16 v[128:131], a[180:183], v[60:63], v[128:131]
s_add_u32 m0, s71, 4096
v_exp_f32 v116, v116
v_mfma_f32_16x16x32_bf16 v[128:131], a[176:179], v[56:59], v[128:131]
s_add_u32 s64, s70, 4096
v_cvt_pk_bf16_f32 v199, v150, v151
v_exp_f32 v117, v117
v_mfma_f32_16x16x32_bf16 v[144:147], a[176:179], v[72:75], v[228:231]
buffer_load_dwordx4 v16, s[32:35], s64 offen offset:0 sc1 lds
v_mfma_f32_16x16x32_bf16 v[144:147], a[180:183], v[76:79], v[144:147]
v_exp_f32 v118, v118
v_mfma_f32_16x16x32_bf16 v[144:147], a[184:187], v[80:83], v[144:147]
v_cvt_pk_bf16_f32 v190, v132, v133
v_exp_f32 v119, v119
v_mfma_f32_16x16x32_bf16 v[144:147], a[188:191], v[84:87], v[144:147]
s_waitcnt lgkmcnt(0)
v_exp_f32 v100, v100
v_mfma_f32_16x16x32_bf16 v[148:151], a[204:207], v[84:87], v[228:231]
v_exp_f32 v101, v101
v_mfma_f32_16x16x32_bf16 v[148:151], a[200:203], v[80:83], v[148:151]
v_cvt_pk_bf16_f32 v191, v134, v135
v_cvt_pk_bf16_f32 v166, v116, v117
v_cvt_pk_bf16_f32 v167, v118, v119
v_mfma_f32_16x16x32_bf16 v[148:151], a[196:199], v[76:79], v[148:151]
v_exp_f32 v102, v102
v_mfma_f32_16x16x32_bf16 v[148:151], a[192:195], v[72:75], v[148:151]
v_exp_f32 v103, v103
v_mfma_f32_16x16x32_bf16 v[132:135], a[192:195], v[56:59], v[224:227]
s_lshl_b32 s66, s30, 30
ds_read_b128 a[144:147], v3 offset:16384
v_cndmask_b32 v116, v220, v17, s[62:63]
v_mfma_f32_16x16x32_bf16 v[132:135], a[196:199], v[60:63], v[132:135]
ds_read_b128 a[148:151], v3 offset:24576
v_cndmask_b32 v117, v220, v17, s[48:49]
v_cndmask_b32 v118, v220, v17, s[50:51]
v_cndmask_b32 v119, v220, v17, s[100:101]
v_exp_f32 v120, v120
v_mfma_f32_16x16x32_bf16 v[132:135], a[200:203], v[64:67], v[132:135]
v_exp_f32 v121, v121
v_mfma_f32_16x16x32_bf16 v[132:135], a[204:207], v[68:71], v[132:135]
v_exp_f32 v122, v122
v_mfma_f32_16x16x32_bf16 v[116:119], a[204:207], v[52:55], v[116:119]
ds_read_b128 a[152:155], v3 offset:17408
v_accvgpr_write_b32 a142, 0
v_mfma_f32_16x16x32_bf16 v[116:119], a[200:203], v[48:51], v[116:119]
ds_read_b128 a[156:159], v3 offset:25600
buffer_load_dwordx4 v16, s[32:35], s64 offen offset:1024 sc1 lds
v_accvgpr_write_b32 a143, 0
v_cvt_pk_bf16_f32 v158, v100, v101
v_cvt_pk_bf16_f32 v159, v102, v103
v_mfma_f32_16x16x32_bf16 v[116:119], a[196:199], v[44:47], v[116:119]
v_exp_f32 v123, v123
v_mfma_f32_16x16x32_bf16 v[116:119], a[192:195], v[40:43], v[116:119]
v_exp_f32 v136, v136
v_smfmac_f32_16x16x64_bf16 a[128:131], a[240:243], v[152:159], v5
ds_read_b128 a[160:163], v3 offset:18432
v_smfmac_f32_16x16x64_bf16 a[132:135], a[240:243], v[160:167], v5
v_exp_f32 v137, v137
v_smfmac_f32_16x16x64_bf16 a[136:139], a[240:243], v[184:191], v5
v_exp_f32 v138, v138
v_smfmac_f32_16x16x64_bf16 a[140:143], a[240:243], v[192:199], v5
s_waitcnt lgkmcnt(1)
v_cvt_pk_bf16_f32 v200, v120, v121
v_mfma_f32_16x16x32_bf16 a[0:3], a[144:147], v[152:155], 0
v_exp_f32 v139, v139
v_mfma_f32_16x16x32_bf16 a[0:3], a[148:151], v[156:159], a[0:3]
v_exp_f32 v104, v104
v_mfma_f32_16x16x32_bf16 a[32:35], a[148:151], v[164:167], 0
v_cvt_pk_bf16_f32 v201, v122, v123
v_cvt_pk_bf16_f32 v208, v136, v137
v_mfma_f32_16x16x32_bf16 a[32:35], a[144:147], v[160:163], a[32:35]
v_exp_f32 v105, v105
v_mfma_f32_16x16x32_bf16 a[64:67], a[144:147], v[184:187], 0
v_exp_f32 v106, v106
v_mfma_f32_16x16x32_bf16 a[64:67], a[148:151], v[188:191], a[64:67]
v_exp_f32 v107, v107
v_mfma_f32_16x16x32_bf16 a[96:99], a[148:151], v[196:199], 0
buffer_load_dwordx4 v16, s[32:35], s64 offen offset:2048 sc1 lds
v_mfma_f32_16x16x32_bf16 a[96:99], a[144:147], v[192:195], a[96:99]
v_exp_f32 v140, v140
v_mfma_f32_16x16x32_bf16 a[100:103], a[152:155], v[192:195], 0
ds_read_b128 a[164:167], v3 offset:26624
v_cvt_pk_bf16_f32 v209, v138, v139
v_mfma_f32_16x16x32_bf16 a[100:103], a[156:159], v[196:199], a[100:103]
v_exp_f32 v141, v141
v_mfma_f32_16x16x32_bf16 a[68:71], a[156:159], v[188:191], 0
v_exp_f32 v142, v142
v_mfma_f32_16x16x32_bf16 a[68:71], a[152:155], v[184:187], a[68:71]
v_cvt_pk_bf16_f32 v176, v104, v105
v_cvt_pk_bf16_f32 v177, v106, v107
v_mfma_f32_16x16x32_bf16 a[36:39], a[152:155], v[160:163], 0
v_exp_f32 v143, v143
v_mfma_f32_16x16x32_bf16 a[36:39], a[156:159], v[164:167], a[36:39]
v_exp_f32 v124, v124
v_mfma_f32_16x16x32_bf16 a[4:7], a[156:159], v[156:159], 0
v_exp_f32 v125, v125
v_mfma_f32_16x16x32_bf16 a[4:7], a[152:155], v[152:155], a[4:7]
s_waitcnt lgkmcnt(0)
ds_read_b128 a[168:171], v3 offset:19456
v_cvt_pk_bf16_f32 v210, v140, v141
v_mfma_f32_16x16x32_bf16 a[8:11], a[160:163], v[152:155], 0
v_exp_f32 v126, v126
v_mfma_f32_16x16x32_bf16 a[8:11], a[164:167], v[156:159], a[8:11]
ds_read_b128 a[172:175], v3 offset:27648
v_cvt_pk_bf16_f32 v211, v142, v143
v_mfma_f32_16x16x32_bf16 a[40:43], a[164:167], v[164:167], 0
v_exp_f32 v127, v127
v_mfma_f32_16x16x32_bf16 a[40:43], a[160:163], v[160:163], a[40:43]
v_exp_f32 v108, v108
v_mfma_f32_16x16x32_bf16 a[72:75], a[160:163], v[184:187], 0
buffer_load_dwordx4 v16, s[32:35], s64 offen offset:3072 sc1 lds
v_mfma_f32_16x16x32_bf16 a[72:75], a[164:167], v[188:191], a[72:75]
v_exp_f32 v109, v109
v_mfma_f32_16x16x32_bf16 a[104:107], a[164:167], v[196:199], 0
v_exp_f32 v110, v110
v_mfma_f32_16x16x32_bf16 a[104:107], a[160:163], v[192:195], a[104:107]
s_waitcnt lgkmcnt(0)
ds_read_b128 a[176:179], v3 offset:20480
v_cvt_pk_bf16_f32 v202, v124, v125
v_mfma_f32_16x16x32_bf16 a[108:111], a[168:171], v[192:195], 0
v_exp_f32 v111, v111
v_mfma_f32_16x16x32_bf16 a[108:111], a[172:175], v[196:199], a[108:111]
ds_read_b128 a[180:183], v3 offset:28672
v_cvt_pk_bf16_f32 v203, v126, v127
v_mfma_f32_16x16x32_bf16 a[76:79], a[172:175], v[188:191], 0
s_add_u32 m0, s86, 135168
v_exp_f32 v112, v112
v_mfma_f32_16x16x32_bf16 a[76:79], a[168:171], v[184:187], a[76:79]
s_add_u32 s64, s85, 32768
v_exp_f32 v113, v113
v_mfma_f32_16x16x32_bf16 a[44:47], a[168:171], v[160:163], 0
buffer_load_dwordx4 v12, s[36:39], s64 offen lds
v_mfma_f32_16x16x32_bf16 a[44:47], a[172:175], v[164:167], a[44:47]
s_add_u32 m0, s86, 136192
v_cvt_pk_bf16_f32 v178, v108, v109
v_exp_f32 v114, v114
v_mfma_f32_16x16x32_bf16 a[12:15], a[172:175], v[156:159], 0
s_add_u32 s64, s85, 40960
v_exp_f32 v115, v115
v_mfma_f32_16x16x32_bf16 a[12:15], a[168:171], v[152:155], a[12:15]
s_waitcnt lgkmcnt(0)
buffer_load_dwordx4 v13, s[36:39], s64 offen lds
v_mfma_f32_16x16x32_bf16 a[16:19], a[176:179], v[152:155], 0
s_add_u32 m0, s86, 137216
ds_read_b128 a[184:187], v3 offset:21504
ds_read_b128 a[188:191], v3 offset:29696
ds_read_b128 a[192:195], v3 offset:22528
ds_read_b128 a[196:199], v3 offset:30720
ds_read_b128 a[200:203], v3 offset:23552
ds_read_b128 a[204:207], v3 offset:31744
v_xor_b32 v2, 0x8000, v2
v_exp_f32 v128, v128
v_mfma_f32_16x16x32_bf16 a[16:19], a[180:183], v[156:159], a[16:19]
s_waitcnt vmcnt(14)
s_barrier
s_add_u32 s64, s85, 49152
v_cvt_pk_bf16_f32 v179, v110, v111
v_mfma_f32_16x16x32_bf16 a[48:51], a[180:183], v[164:167], 0
buffer_load_dwordx4 v12, s[36:39], s64 offen lds
v_exp_f32 v129, v129
v_mfma_f32_16x16x32_bf16 a[48:51], a[176:179], v[160:163], a[48:51]
s_add_u32 m0, s86, 138240
v_exp_f32 v130, v130
v_mfma_f32_16x16x32_bf16 a[80:83], a[176:179], v[184:187], 0
s_add_u32 s64, s85, 57344
v_cvt_pk_bf16_f32 v180, v112, v113
v_cvt_pk_bf16_f32 v181, v114, v115
v_mfma_f32_16x16x32_bf16 a[80:83], a[180:183], v[188:191], a[80:83]
buffer_load_dwordx4 v13, s[36:39], s64 offen lds
v_exp_f32 v131, v131
v_mfma_f32_16x16x32_bf16 a[112:115], a[180:183], v[196:199], 0
v_exp_f32 v144, v144
v_mfma_f32_16x16x32_bf16 a[112:115], a[176:179], v[192:195], a[112:115]
s_waitcnt lgkmcnt(0)
s_xor_b32 s71, s71, 49152
s_add_u32 s70, s70, 32768
s_mov_b32 m0, s71
v_exp_f32 v145, v145
v_mfma_f32_16x16x32_bf16 a[116:119], a[184:187], v[192:195], 0
buffer_load_dwordx4 v16, s[32:35], s70 offen offset:0 sc1 lds
v_mfma_f32_16x16x32_bf16 a[116:119], a[188:191], v[196:199], a[116:119]
v_exp_f32 v146, v146
v_mfma_f32_16x16x32_bf16 a[84:87], a[188:191], v[188:191], 0
v_cvt_pk_bf16_f32 v204, v128, v129
v_cvt_pk_bf16_f32 v205, v130, v131
v_mfma_f32_16x16x32_bf16 a[84:87], a[184:187], v[184:187], a[84:87]
v_exp_f32 v147, v147
v_mfma_f32_16x16x32_bf16 a[52:55], a[184:187], v[160:163], 0
v_exp_f32 v148, v148
v_mfma_f32_16x16x32_bf16 a[52:55], a[188:191], v[164:167], a[52:55]
v_exp_f32 v149, v149
v_mfma_f32_16x16x32_bf16 a[20:23], a[188:191], v[156:159], 0
ds_read_b128 a[144:147], v2 offset:0
v_lshl_add_u32 v19, v0, 24, s66
v_mfma_f32_16x16x32_bf16 a[20:23], a[184:187], v[152:155], a[20:23]
s_lshr_b32 s67, s31, 4
v_exp_f32 v150, v150
v_mfma_f32_16x16x32_bf16 a[24:27], a[192:195], v[152:155], 0
s_lshl1_add_u32 s67, s3, s67
v_cvt_pk_bf16_f32 v212, v144, v145
v_cvt_pk_bf16_f32 v213, v146, v147
v_mfma_f32_16x16x32_bf16 a[24:27], a[196:199], v[156:159], a[24:27]
s_lshl_b32 s79, s67, 8
v_exp_f32 v151, v151
v_mfma_f32_16x16x32_bf16 a[56:59], a[196:199], v[164:167], 0
s_add_u32 s79, s79, 8192
v_exp_f32 v132, v132
v_mfma_f32_16x16x32_bf16 a[56:59], a[192:195], v[160:163], a[56:59]
s_add_u32 s69, s31, 12
v_exp_f32 v133, v133
v_mfma_f32_16x16x32_bf16 a[88:91], a[192:195], v[184:187], 0
s_lshr_b32 s69, s69, 5
buffer_load_dwordx4 v16, s[32:35], s70 offen offset:1024 sc1 lds
v_mfma_f32_16x16x32_bf16 a[88:91], a[196:199], v[188:191], a[88:91]
s_lshl1_add_u32 s69, s3, s69
v_exp_f32 v134, v134
v_mfma_f32_16x16x32_bf16 a[120:123], a[196:199], v[196:199], 0
s_lshl_b32 s69, s69, 8
v_cvt_pk_bf16_f32 v214, v148, v149
v_cvt_pk_bf16_f32 v215, v150, v151
v_mfma_f32_16x16x32_bf16 a[120:123], a[192:195], v[192:195], a[120:123]
s_add_u32 s69, s69, 8192
v_exp_f32 v135, v135
v_mfma_f32_16x16x32_bf16 a[124:127], a[200:203], v[192:195], 0
s_lshl_b32 s67, s73, 16
v_exp_f32 v116, v116
v_mfma_f32_16x16x32_bf16 a[124:127], a[204:207], v[196:199], a[124:127]
s_xor_b32 s68, s80, 256
v_exp_f32 v117, v117
v_mfma_f32_16x16x32_bf16 a[92:95], a[204:207], v[188:191], 0
s_add_u32 s68, s68, s67
s_add_u32 s17, s78, L_T-L_pc+0
ds_read_b128 a[148:151], v2 offset:1024
v_cvt_pk_bf16_f32 v206, v132, v133
v_mfma_f32_16x16x32_bf16 a[92:95], a[200:203], v[184:187], a[92:95]
s_add_u32 s67, s67, s69
buffer_load_dword a252, v16, s[88:91], s17 offen
v_mfma_f32_16x16x32_bf16 a[60:63], a[200:203], v[160:163], 0
ds_read_b128 a[152:155], v2 offset:2048
v_exp_f32 v118, v118
v_mfma_f32_16x16x32_bf16 a[60:63], a[204:207], v[164:167], a[60:63]
s_add_u32 s17, s78, L_T-L_pc+4096
ds_read_b128 a[156:159], v2 offset:3072
v_cvt_pk_bf16_f32 v207, v134, v135
v_mfma_f32_16x16x32_bf16 a[28:31], a[204:207], v[156:159], 0
s_mov_b64 exec, 1
buffer_atomic_add a251, v19, s[52:55], s67 offen offset:0 sc1
buffer_atomic_add a251, v19, s[52:55], s68 offen offset:0 sc1
s_mov_b64 exec, -1
v_exp_f32 v119, v119
v_mfma_f32_16x16x32_bf16 a[28:31], a[200:203], v[152:155], a[28:31]
ds_read_b128 a[160:163], v2 offset:4096
buffer_load_dword a252, v16, s[88:91], s17 offen
ds_read_b128 a[164:167], v2 offset:5120
ds_read_b128 a[168:171], v2 offset:6144
ds_read_b128 a[172:175], v2 offset:7168
v_mul_u32_u24 v19, 52, v0
v_cvt_pk_bf16_f32 v182, v116, v117
v_cvt_pk_bf16_f32 v183, v118, v119
v_xor_b32 v3, 0x8000, v3
v_accvgpr_read_b32 v20, a128
v_accvgpr_read_b32 v248, a129
v_add_f32 v20, v20, v248
v_max_f32 v1, v1, v20
v_rcp_f32 v20, v20
v_accvgpr_read_b32 v232, a0
v_accvgpr_read_b32 v233, a1
v_accvgpr_read_b32 v234, a2
v_accvgpr_read_b32 v235, a3
v_accvgpr_read_b32 v236, a4
v_accvgpr_read_b32 v237, a5
v_accvgpr_read_b32 v238, a6
v_accvgpr_read_b32 v239, a7
v_mul_f32 v20, v20, v4
v_mul_f32 v232, v232, v20
v_mul_f32 v233, v233, v20
v_mul_f32 v234, v234, v20
v_mul_f32 v235, v235, v20
v_mul_f32 v236, v236, v20
v_mul_f32 v237, v237, v20
v_mul_f32 v238, v238, v20
v_mul_f32 v239, v239, v20
v_cvt_pk_bf16_f32 v232, v232, v233
v_cvt_pk_bf16_f32 v233, v234, v235
v_cvt_pk_bf16_f32 v234, v236, v237
v_cvt_pk_bf16_f32 v235, v238, v239
s_add_u32 s77, s74, 0
buffer_store_dwordx4 v[232:235], v16, s[44:47], s77 offen sc1
v_accvgpr_read_b32 v240, a8
v_accvgpr_read_b32 v241, a9
v_accvgpr_read_b32 v242, a10
v_accvgpr_read_b32 v243, a11
v_accvgpr_read_b32 v244, a12
v_accvgpr_read_b32 v245, a13
v_accvgpr_read_b32 v246, a14
v_accvgpr_read_b32 v247, a15
v_mul_f32 v240, v240, v20
v_mul_f32 v241, v241, v20
v_mul_f32 v242, v242, v20
v_mul_f32 v243, v243, v20
v_mul_f32 v244, v244, v20
v_mul_f32 v245, v245, v20
v_mul_f32 v246, v246, v20
v_mul_f32 v247, v247, v20
v_cvt_pk_bf16_f32 v240, v240, v241
v_cvt_pk_bf16_f32 v241, v242, v243
v_cvt_pk_bf16_f32 v242, v244, v245
v_cvt_pk_bf16_f32 v243, v246, v247
s_add_u32 s77, s74, 8192
buffer_store_dwordx4 v[240:243], v16, s[44:47], s77 offen sc1
v_accvgpr_read_b32 v232, a16
v_accvgpr_read_b32 v233, a17
v_accvgpr_read_b32 v234, a18
v_accvgpr_read_b32 v235, a19
v_accvgpr_read_b32 v236, a20
v_accvgpr_read_b32 v237, a21
v_accvgpr_read_b32 v238, a22
v_accvgpr_read_b32 v239, a23
v_mul_f32 v232, v232, v20
v_mul_f32 v233, v233, v20
v_mul_f32 v234, v234, v20
v_mul_f32 v235, v235, v20
v_mul_f32 v236, v236, v20
v_mul_f32 v237, v237, v20
v_mul_f32 v238, v238, v20
v_mul_f32 v239, v239, v20
v_cvt_pk_bf16_f32 v232, v232, v233
v_cvt_pk_bf16_f32 v233, v234, v235
v_cvt_pk_bf16_f32 v234, v236, v237
v_cvt_pk_bf16_f32 v235, v238, v239
s_add_u32 s77, s74, 16384
buffer_store_dwordx4 v[232:235], v16, s[44:47], s77 offen sc1
s_branch L_T
L_T1:
buffer_load_dword v19, off, s[52:55], s80 sc1
s_add_u32 s17, s78, L_TAIL-L_pc
buffer_load_dword a252, v16, s[88:91], s17 offen
s_add_u32 s17, s78, L_TAIL-L_pc+4096
buffer_load_dword a252, v16, s[88:91], s17 offen
s_add_u32 s17, s78, L_p5f0-L_pc
buffer_load_dword a252, v16, s[88:91], s17 offen
s_add_u32 s17, s78, L_p5f0-L_pc+4096
buffer_load_dword a252, v16, s[88:91], s17 offen
s_waitcnt lgkmcnt(7)
v_mfma_f32_16x16x32_bf16 v[136:139], a[144:147], v[72:75], v[228:231]
s_waitcnt lgkmcnt(6)
ds_read_b128 a[176:179], v2 offset:8192
v_cndmask_b32 v120, v224, v17, s[0:1]
v_mfma_f32_16x16x32_bf16 v[136:139], a[148:151], v[76:79], v[136:139]
s_waitcnt lgkmcnt(6)
ds_read_b128 a[180:183], v2 offset:9216
v_cndmask_b32 v121, v224, v17, s[4:5]
v_cndmask_b32 v122, v224, v17, s[6:7]
v_cndmask_b32 v123, v224, v17, s[8:9]
v_mfma_f32_16x16x32_bf16 v[136:139], a[152:155], v[80:83], v[136:139]
s_waitcnt lgkmcnt(6)
buffer_load_dwordx4 v16, s[32:35], s70 offen offset:2048 sc1 lds
v_mfma_f32_16x16x32_bf16 v[136:139], a[156:159], v[84:87], v[136:139]
ds_read_b128 a[184:187], v2 offset:10240
v_cndmask_b32 v124, v224, v17, s[10:11]
v_mfma_f32_16x16x32_bf16 v[120:123], a[156:159], v[68:71], v[120:123]
ds_read_b128 a[188:191], v2 offset:11264
v_cndmask_b32 v125, v224, v17, s[12:13]
v_mfma_f32_16x16x32_bf16 v[120:123], a[152:155], v[64:67], v[120:123]
ds_read_b128 a[192:195], v2 offset:12288
v_cndmask_b32 v126, v224, v17, s[18:19]
v_mfma_f32_16x16x32_bf16 v[120:123], a[148:151], v[60:63], v[120:123]
ds_read_b128 a[196:199], v2 offset:13312
v_cndmask_b32 v127, v224, v17, s[22:23]
v_mfma_f32_16x16x32_bf16 v[120:123], a[144:147], v[56:59], v[120:123]
s_waitcnt lgkmcnt(4)
ds_read_b128 a[200:203], v2 offset:14336
v_cndmask_b32 v128, v224, v17, s[26:27]
v_mfma_f32_16x16x32_bf16 v[140:143], a[160:163], v[72:75], v[228:231]
ds_read_b128 a[204:207], v2 offset:15360
v_cndmask_b32 v129, v224, v17, s[56:57]
v_mfma_f32_16x16x32_bf16 v[140:143], a[164:167], v[76:79], v[140:143]
ds_read_b128 a[144:147], v3 offset:0
v_cndmask_b32 v130, v224, v17, s[58:59]
v_mfma_f32_16x16x32_bf16 v[140:143], a[168:171], v[80:83], v[140:143]
v_exp_f32 v136, v136
v_mfma_f32_16x16x32_bf16 v[140:143], a[172:175], v[84:87], v[140:143]
v_exp_f32 v137, v137
v_mfma_f32_16x16x32_bf16 v[124:127], a[172:175], v[68:71], v[124:127]
ds_read_b128 a[148:151], v3 offset:8192
v_cndmask_b32 v131, v224, v17, s[60:61]
v_mfma_f32_16x16x32_bf16 v[124:127], a[168:171], v[64:67], v[124:127]
v_exp_f32 v138, v138
v_mfma_f32_16x16x32_bf16 v[124:127], a[164:167], v[60:63], v[124:127]
s_mul_i32 s69, s83, 8
buffer_load_dwordx4 v16, s[32:35], s70 offen offset:3072 sc1 lds
v_mfma_f32_16x16x32_bf16 v[124:127], a[160:163], v[56:59], v[124:127]
s_sub_u32 s69, 36, s69
v_exp_f32 v139, v139
v_mfma_f32_16x16x32_bf16 v[128:131], a[176:179], v[56:59], v[128:131]
v_exp_f32 v120, v120
v_mfma_f32_16x16x32_bf16 v[128:131], a[180:183], v[60:63], v[128:131]
s_waitcnt lgkmcnt(1)
v_exp_f32 v121, v121
v_mfma_f32_16x16x32_bf16 v[128:131], a[184:187], v[64:67], v[128:131]
v_exp_f32 v122, v122
v_mfma_f32_16x16x32_bf16 v[128:131], a[188:191], v[68:71], v[128:131]
s_add_u32 m0, s71, 4096
ds_read_b128 a[152:155], v3 offset:1024
v_cndmask_b32 v132, v224, v17, s[62:63]
v_mfma_f32_16x16x32_bf16 v[144:147], a[188:191], v[84:87], v[228:231]
s_add_u32 s64, s70, 4096
v_cvt_pk_bf16_f32 v192, v136, v137
v_cndmask_b32 v133, v224, v17, s[48:49]
v_mfma_f32_16x16x32_bf16 v[144:147], a[184:187], v[80:83], v[144:147]
buffer_load_dwordx4 v16, s[32:35], s64 offen offset:0 sc1 lds
v_mfma_f32_16x16x32_bf16 v[144:147], a[180:183], v[76:79], v[144:147]
ds_read_b128 a[156:159], v3 offset:9216
v_cndmask_b32 v134, v224, v17, s[50:51]
v_mfma_f32_16x16x32_bf16 v[144:147], a[176:179], v[72:75], v[144:147]
ds_read_b128 a[160:163], v3 offset:2048
v_cndmask_b32 v135, v224, v17, s[100:101]
v_mfma_f32_16x16x32_bf16 v[148:151], a[192:195], v[72:75], v[228:231]
v_exp_f32 v123, v123
v_mfma_f32_16x16x32_bf16 v[148:151], a[196:199], v[76:79], v[148:151]
v_cvt_pk_bf16_f32 v193, v138, v139
v_cvt_pk_bf16_f32 v184, v120, v121
v_mfma_f32_16x16x32_bf16 v[148:151], a[200:203], v[80:83], v[148:151]
v_exp_f32 v140, v140
v_mfma_f32_16x16x32_bf16 v[148:151], a[204:207], v[84:87], v[148:151]
v_exp_f32 v141, v141
v_mfma_f32_16x16x32_bf16 v[132:135], a[204:207], v[68:71], v[132:135]
v_exp_f32 v142, v142
v_mfma_f32_16x16x32_bf16 v[132:135], a[200:203], v[64:67], v[132:135]
v_exp_f32 v143, v143
v_mfma_f32_16x16x32_bf16 v[132:135], a[196:199], v[60:63], v[132:135]
buffer_load_dwordx4 v16, s[32:35], s64 offen offset:1024 sc1 lds
v_mfma_f32_16x16x32_bf16 v[132:135], a[192:195], v[56:59], v[132:135]
v_exp_f32 v124, v124
v_smfmac_f32_16x16x64_bf16 a[132:135], a[240:243], v[176:183], v5
ds_read_b128 a[164:167], v3 offset:10240
v_smfmac_f32_16x16x64_bf16 a[136:139], a[240:243], v[200:207], v5
ds_read_b128 a[168:171], v3 offset:3072
v_accvgpr_read_b32 v240, a24
v_smfmac_f32_16x16x64_bf16 a[140:143], a[240:243], v[208:215], v5
v_cvt_pk_bf16_f32 v185, v122, v123
v_mfma_f32_16x16x32_bf16 a[32:35], a[144:147], v[176:179], a[32:35]
s_waitcnt lgkmcnt(2)
v_exp_f32 v125, v125
v_mfma_f32_16x16x32_bf16 a[32:35], a[148:151], v[180:183], a[32:35]
ds_read_b128 a[172:175], v3 offset:11264
v_accvgpr_read_b32 v241, a25
v_mfma_f32_16x16x32_bf16 a[64:67], a[148:151], v[204:207], a[64:67]
ds_read_b128 a[176:179], v3 offset:4096
v_accvgpr_read_b32 v242, a26
v_mfma_f32_16x16x32_bf16 a[64:67], a[144:147], v[200:203], a[64:67]
v_cvt_pk_bf16_f32 v194, v140, v141
v_accvgpr_read_b32 v243, a27
v_mfma_f32_16x16x32_bf16 a[96:99], a[144:147], v[208:211], a[96:99]
ds_read_b128 a[180:183], v3 offset:12288
v_accvgpr_read_b32 v244, a28
v_mfma_f32_16x16x32_bf16 a[96:99], a[148:151], v[212:215], a[96:99]
ds_read_b128 a[184:187], v3 offset:5120
v_accvgpr_read_b32 v245, a29
v_mfma_f32_16x16x32_bf16 a[100:103], a[156:159], v[212:215], a[100:103]
ds_read_b128 a[188:191], v3 offset:13312
v_accvgpr_read_b32 v246, a30
v_mfma_f32_16x16x32_bf16 a[100:103], a[152:155], v[208:211], a[100:103]
ds_read_b128 a[192:195], v3 offset:6144
v_accvgpr_read_b32 v247, a31
v_mul_f32 v240, v240, v20
v_mul_f32 v241, v241, v20
v_mul_f32 v242, v242, v20
v_mul_f32 v243, v243, v20
v_mul_f32 v244, v244, v20
v_mul_f32 v245, v245, v20
v_mul_f32 v246, v246, v20
v_mul_f32 v247, v247, v20
v_cvt_pk_bf16_f32 v240, v240, v241
v_cvt_pk_bf16_f32 v241, v242, v243
v_cvt_pk_bf16_f32 v242, v244, v245
v_cvt_pk_bf16_f32 v243, v246, v247
s_add_u32 s77, s74, 24576
buffer_store_dwordx4 v[240:243], v16, s[44:47], s77 offen sc1
v_exp_f32 v126, v126
v_mfma_f32_16x16x32_bf16 a[68:71], a[152:155], v[200:203], a[68:71]
buffer_load_dwordx4 v16, s[32:35], s64 offen offset:2048 sc1 lds
v_cvt_pk_bf16_f32 v195, v142, v143
v_mfma_f32_16x16x32_bf16 a[68:71], a[156:159], v[204:207], a[68:71]
v_exp_f32 v127, v127
v_mfma_f32_16x16x32_bf16 a[36:39], a[156:159], v[180:183], a[36:39]
v_exp_f32 v128, v128
v_mfma_f32_16x16x32_bf16 a[36:39], a[152:155], v[176:179], a[36:39]
v_exp_f32 v129, v129
v_mfma_f32_16x16x32_bf16 a[40:43], a[160:163], v[176:179], a[40:43]
s_waitcnt lgkmcnt(1)
v_cvt_pk_bf16_f32 v186, v124, v125
v_cvt_pk_bf16_f32 v187, v126, v127
v_mfma_f32_16x16x32_bf16 a[40:43], a[164:167], v[180:183], a[40:43]
v_exp_f32 v130, v130
v_mfma_f32_16x16x32_bf16 a[72:75], a[164:167], v[204:207], a[72:75]
buffer_load_dwordx4 v16, s[32:35], s64 offen offset:3072 sc1 lds
v_mfma_f32_16x16x32_bf16 a[72:75], a[160:163], v[200:203], a[72:75]
v_exp_f32 v131, v131
v_mfma_f32_16x16x32_bf16 a[104:107], a[160:163], v[208:211], a[104:107]
v_exp_f32 v144, v144
v_mfma_f32_16x16x32_bf16 a[104:107], a[164:167], v[212:215], a[104:107]
v_exp_f32 v145, v145
v_mfma_f32_16x16x32_bf16 a[108:111], a[172:175], v[212:215], a[108:111]
v_exp_f32 v146, v146
v_mfma_f32_16x16x32_bf16 a[108:111], a[168:171], v[208:211], a[108:111]
ds_read_b128 a[196:199], v3 offset:14336
v_cvt_pk_bf16_f32 v188, v128, v129
v_mfma_f32_16x16x32_bf16 a[76:79], a[168:171], v[200:203], a[76:79]
ds_read_b128 a[200:203], v3 offset:7168
v_cvt_pk_bf16_f32 v189, v130, v131
v_mfma_f32_16x16x32_bf16 a[76:79], a[172:175], v[204:207], a[76:79]
ds_read_b128 a[204:207], v3 offset:15360
v_cvt_pk_bf16_f32 v196, v144, v145
v_mfma_f32_16x16x32_bf16 a[44:47], a[172:175], v[180:183], a[44:47]
v_exp_f32 v147, v147
v_mfma_f32_16x16x32_bf16 a[44:47], a[168:171], v[176:179], a[44:47]
v_exp_f32 v148, v148
v_mfma_f32_16x16x32_bf16 a[48:51], a[176:179], v[176:179], a[48:51]
v_exp_f32 v149, v149
v_mfma_f32_16x16x32_bf16 a[48:51], a[180:183], v[180:183], a[48:51]
v_exp_f32 v150, v150
v_mfma_f32_16x16x32_bf16 a[80:83], a[180:183], v[204:207], a[80:83]
s_waitcnt vmcnt(14)
s_barrier
v_mfma_f32_16x16x32_bf16 a[80:83], a[176:179], v[200:203], a[80:83]
v_exp_f32 v151, v151
v_mfma_f32_16x16x32_bf16 a[112:115], a[176:179], v[208:211], a[112:115]
v_exp_f32 v132, v132
v_mfma_f32_16x16x32_bf16 a[112:115], a[180:183], v[212:215], a[112:115]
v_exp_f32 v133, v133
v_mfma_f32_16x16x32_bf16 a[116:119], a[188:191], v[212:215], a[116:119]
ds_read_b128 a[144:147], v2 offset:16384
v_cvt_pk_bf16_f32 v197, v146, v147
v_mfma_f32_16x16x32_bf16 a[116:119], a[184:187], v[208:211], a[116:119]
v_exp_f32 v134, v134
v_mfma_f32_16x16x32_bf16 a[84:87], a[184:187], v[200:203], a[84:87]
s_waitcnt vmcnt(11)
v_readfirstlane_b32 vcc_lo, v19
s_nop 0
s_cmp_lt_u32 vcc_lo, s69
s_cbranch_scc1 L_spin_1012
L_spinbk_1013:
v_mfma_f32_16x16x32_bf16 a[84:87], a[188:191], v[204:207], a[84:87]
ds_read_b128 a[148:151], v2 offset:17408
v_cvt_pk_bf16_f32 v198, v148, v149
v_mfma_f32_16x16x32_bf16 a[52:55], a[188:191], v[180:183], a[52:55]
ds_read_b128 a[152:155], v2 offset:18432
v_cvt_pk_bf16_f32 v199, v150, v151
v_mfma_f32_16x16x32_bf16 a[52:55], a[184:187], v[176:179], a[52:55]
s_waitcnt lgkmcnt(3)
ds_read_b128 a[156:159], v2 offset:19456
v_cndmask_b32 v136, v228, v17, s[0:1]
v_mfma_f32_16x16x32_bf16 a[56:59], a[192:195], v[176:179], a[56:59]
ds_read_b128 a[160:163], v2 offset:20480
v_cndmask_b32 v137, v228, v17, s[4:5]
v_mfma_f32_16x16x32_bf16 a[56:59], a[196:199], v[180:183], a[56:59]
ds_read_b128 a[164:167], v2 offset:21504
v_cndmask_b32 v138, v228, v17, s[6:7]
v_mfma_f32_16x16x32_bf16 a[88:91], a[196:199], v[204:207], a[88:91]
ds_read_b128 a[168:171], v2 offset:22528
v_cndmask_b32 v139, v228, v17, s[8:9]
v_mfma_f32_16x16x32_bf16 a[88:91], a[192:195], v[200:203], a[88:91]
v_exp_f32 v135, v135
v_mfma_f32_16x16x32_bf16 a[120:123], a[192:195], v[208:211], a[120:123]
ds_read_b128 a[172:175], v2 offset:23552
v_cvt_pk_bf16_f32 v190, v132, v133
v_mfma_f32_16x16x32_bf16 a[120:123], a[196:199], v[212:215], a[120:123]
v_cndmask_b32 v140, v228, v17, s[10:11]
v_cvt_pk_bf16_f32 v191, v134, v135
v_mfma_f32_16x16x32_bf16 a[124:127], a[204:207], v[212:215], a[124:127]
v_cndmask_b32 v141, v228, v17, s[12:13]
v_cndmask_b32 v142, v228, v17, s[18:19]
v_mfma_f32_16x16x32_bf16 a[124:127], a[200:203], v[208:211], a[124:127]
v_cndmask_b32 v143, v228, v17, s[22:23]
v_cndmask_b32 v144, v228, v17, s[26:27]
v_mfma_f32_16x16x32_bf16 a[92:95], a[200:203], v[200:203], a[92:95]
v_cndmask_b32 v145, v228, v17, s[56:57]
v_cndmask_b32 v146, v228, v17, s[58:59]
v_mfma_f32_16x16x32_bf16 a[92:95], a[204:207], v[204:207], a[92:95]
v_cndmask_b32 v147, v228, v17, s[60:61]
v_cndmask_b32 v148, v228, v17, s[62:63]
v_mfma_f32_16x16x32_bf16 a[60:63], a[204:207], v[180:183], a[60:63]
v_cndmask_b32 v149, v228, v17, s[48:49]
v_cndmask_b32 v150, v228, v17, s[50:51]
v_mfma_f32_16x16x32_bf16 a[60:63], a[200:203], v[176:179], a[60:63]
s_waitcnt lgkmcnt(0)
v_cndmask_b32 v151, v228, v17, s[100:101]
v_accvgpr_read_b32 v21, a132
v_mfma_f32_16x16x32_bf16 v[136:139], a[144:147], v[72:75], v[136:139]
ds_read_b128 a[176:179], v2 offset:24576
v_accvgpr_read_b32 v248, a133
v_mfma_f32_16x16x32_bf16 v[136:139], a[148:151], v[76:79], v[136:139]
ds_read_b128 a[180:183], v2 offset:25600
v_add_f32 v21, v21, v248
v_mfma_f32_16x16x32_bf16 v[136:139], a[152:155], v[80:83], v[136:139]
ds_read_b128 a[184:187], v2 offset:26624
v_max_f32 v1, v1, v21
v_mfma_f32_16x16x32_bf16 v[136:139], a[156:159], v[84:87], v[136:139]
ds_read_b128 a[188:191], v2 offset:27648
ds_read_b128 a[192:195], v2 offset:28672
v_mfma_f32_16x16x32_bf16 v[140:143], a[172:175], v[84:87], v[140:143]
ds_read_b128 a[196:199], v2 offset:29696
ds_read_b128 a[200:203], v2 offset:30720
ds_read_b128 a[204:207], v2 offset:31744
v_mfma_f32_16x16x32_bf16 v[140:143], a[168:171], v[80:83], v[140:143]
v_rcp_f32 v21, v21
v_mfma_f32_16x16x32_bf16 v[140:143], a[164:167], v[76:79], v[140:143]
ds_read_b128 a[144:147], v3 offset:16384
v_accvgpr_read_b32 v232, a32
v_mfma_f32_16x16x32_bf16 v[140:143], a[160:163], v[72:75], v[140:143]
s_waitcnt lgkmcnt(7)
ds_read_b128 a[148:151], v3 offset:24576
v_accvgpr_read_b32 v233, a33
v_mfma_f32_16x16x32_bf16 v[144:147], a[176:179], v[72:75], v[144:147]
ds_read_b128 a[152:155], v3 offset:17408
v_accvgpr_read_b32 v234, a34
v_mfma_f32_16x16x32_bf16 v[144:147], a[180:183], v[76:79], v[144:147]
s_waitcnt lgkmcnt(6)
ds_read_b128 a[156:159], v3 offset:25600
v_accvgpr_read_b32 v235, a35
v_mfma_f32_16x16x32_bf16 v[144:147], a[184:187], v[80:83], v[144:147]
ds_read_b128 a[160:163], v3 offset:18432
v_accvgpr_read_b32 v236, a36
v_accvgpr_read_b32 v237, a37
v_accvgpr_read_b32 v238, a38
v_accvgpr_read_b32 v239, a39
v_mul_f32 v21, v21, v6
v_mul_f32 v232, v232, v21
v_mul_f32 v233, v233, v21
v_mul_f32 v234, v234, v21
v_mul_f32 v235, v235, v21
v_mul_f32 v236, v236, v21
v_mul_f32 v237, v237, v21
v_mul_f32 v238, v238, v21
v_mul_f32 v239, v239, v21
v_cvt_pk_bf16_f32 v232, v232, v233
v_cvt_pk_bf16_f32 v233, v234, v235
v_cvt_pk_bf16_f32 v234, v236, v237
v_cvt_pk_bf16_f32 v235, v238, v239
s_add_u32 s77, s74, 4096
buffer_store_dwordx4 v[232:235], v16, s[44:47], s77 offen sc1
v_accvgpr_read_b32 v240, a40
v_accvgpr_read_b32 v241, a41
v_accvgpr_read_b32 v242, a42
v_accvgpr_read_b32 v243, a43
v_accvgpr_read_b32 v244, a44
v_accvgpr_read_b32 v245, a45
v_accvgpr_read_b32 v246, a46
v_accvgpr_read_b32 v247, a47
v_mul_f32 v240, v240, v21
v_mul_f32 v241, v241, v21
v_mul_f32 v242, v242, v21
v_mul_f32 v243, v243, v21
v_mul_f32 v244, v244, v21
v_mul_f32 v245, v245, v21
v_mul_f32 v246, v246, v21
v_mul_f32 v247, v247, v21
v_cvt_pk_bf16_f32 v240, v240, v241
v_cvt_pk_bf16_f32 v241, v242, v243
v_cvt_pk_bf16_f32 v242, v244, v245
v_cvt_pk_bf16_f32 v243, v246, v247
s_add_u32 s77, s74, 12288
buffer_store_dwordx4 v[240:243], v16, s[44:47], s77 offen sc1
v_accvgpr_read_b32 v232, a48
v_accvgpr_read_b32 v233, a49
v_accvgpr_read_b32 v234, a50
v_accvgpr_read_b32 v235, a51
v_accvgpr_read_b32 v236, a52
v_accvgpr_read_b32 v237, a53
v_accvgpr_read_b32 v238, a54
v_accvgpr_read_b32 v239, a55
v_mul_f32 v232, v232, v21
v_mul_f32 v233, v233, v21
v_mul_f32 v234, v234, v21
v_mul_f32 v235, v235, v21
v_mul_f32 v236, v236, v21
v_mul_f32 v237, v237, v21
v_mul_f32 v238, v238, v21
v_mul_f32 v239, v239, v21
v_cvt_pk_bf16_f32 v232, v232, v233
v_cvt_pk_bf16_f32 v233, v234, v235
v_cvt_pk_bf16_f32 v234, v236, v237
v_cvt_pk_bf16_f32 v235, v238, v239
s_add_u32 s77, s74, 20480
buffer_store_dwordx4 v[232:235], v16, s[44:47], s77 offen sc1
v_accvgpr_read_b32 v240, a56
v_accvgpr_read_b32 v241, a57
v_accvgpr_read_b32 v242, a58
v_accvgpr_read_b32 v243, a59
v_accvgpr_read_b32 v244, a60
v_accvgpr_read_b32 v245, a61
v_accvgpr_read_b32 v246, a62
v_accvgpr_read_b32 v247, a63
v_mul_f32 v240, v240, v21
v_mul_f32 v241, v241, v21
v_mul_f32 v242, v242, v21
v_mul_f32 v243, v243, v21
v_mul_f32 v244, v244, v21
v_mul_f32 v245, v245, v21
v_mul_f32 v246, v246, v21
v_mul_f32 v247, v247, v21
v_cvt_pk_bf16_f32 v240, v240, v241
v_cvt_pk_bf16_f32 v241, v242, v243
v_cvt_pk_bf16_f32 v242, v244, v245
v_cvt_pk_bf16_f32 v243, v246, v247
s_add_u32 s77, s74, 28672
buffer_store_dwordx4 v[240:243], v16, s[44:47], s77 offen sc1
v_exp_f32 v136, v136
v_mfma_f32_16x16x32_bf16 v[144:147], a[188:191], v[84:87], v[144:147]
s_waitcnt lgkmcnt(5)
v_exp_f32 v137, v137
v_mfma_f32_16x16x32_bf16 v[148:151], a[204:207], v[84:87], v[148:151]
v_exp_f32 v138, v138
v_mfma_f32_16x16x32_bf16 v[148:151], a[200:203], v[80:83], v[148:151]
s_add_u32 s65, s84, 0
v_exp_f32 v139, v139
v_mfma_f32_16x16x32_bf16 v[148:151], a[196:199], v[76:79], v[148:151]
buffer_load_dwordx4 a[208:211], v14, s[44:47], s65 offen offset:0 sc1
v_mfma_f32_16x16x32_bf16 v[148:151], a[192:195], v[72:75], v[148:151]
ds_read_b128 a[164:167], v3 offset:26624
v_cvt_pk_bf16_f32 v208, v136, v137
v_smfmac_f32_16x16x64_bf16 a[136:139], a[240:243], v[184:191], v5
ds_read_b128 a[168:171], v3 offset:19456
v_smfmac_f32_16x16x64_bf16 a[140:143], a[240:243], v[192:199], v5
s_waitcnt lgkmcnt(2)
ds_read_b128 a[172:175], v3 offset:27648
v_mfma_f32_16x16x32_bf16 a[64:67], a[144:147], v[184:187], a[64:67]
v_exp_f32 v140, v140
v_mfma_f32_16x16x32_bf16 a[64:67], a[148:151], v[188:191], a[64:67]
buffer_load_dwordx4 a[216:219], v14, s[44:47], s65 offen offset:1024 sc1
v_mfma_f32_16x16x32_bf16 a[96:99], a[148:151], v[196:199], a[96:99]
v_exp_f32 v141, v141
v_mfma_f32_16x16x32_bf16 a[96:99], a[144:147], v[192:195], a[96:99]
buffer_load_dwordx4 a[224:227], v15, s[44:47], s65 offen offset:0 sc1
v_mfma_f32_16x16x32_bf16 a[100:103], a[152:155], v[192:195], a[100:103]
v_exp_f32 v142, v142
v_mfma_f32_16x16x32_bf16 a[100:103], a[156:159], v[196:199], a[100:103]
buffer_load_dwordx4 a[232:235], v15, s[44:47], s65 offen offset:1024 sc1
v_mfma_f32_16x16x32_bf16 a[68:71], a[156:159], v[188:191], a[68:71]
s_add_u32 s65, s84, 8192
ds_read_b128 a[176:179], v3 offset:20480
v_cvt_pk_bf16_f32 v209, v138, v139
v_mfma_f32_16x16x32_bf16 a[68:71], a[152:155], v[184:187], a[68:71]
buffer_load_dwordx4 a[212:215], v14, s[44:47], s65 offen offset:0 sc1
v_mfma_f32_16x16x32_bf16 a[72:75], a[160:163], v[184:187], a[72:75]
s_waitcnt lgkmcnt(1)
ds_read_b128 a[180:183], v3 offset:28672
v_cvt_pk_bf16_f32 v210, v140, v141
v_mfma_f32_16x16x32_bf16 a[72:75], a[164:167], v[188:191], a[72:75]
v_exp_f32 v143, v143
v_mfma_f32_16x16x32_bf16 a[104:107], a[164:167], v[196:199], a[104:107]
buffer_load_dwordx4 a[220:223], v14, s[44:47], s65 offen offset:1024 sc1
v_mfma_f32_16x16x32_bf16 a[104:107], a[160:163], v[192:195], a[104:107]
v_exp_f32 v144, v144
v_mfma_f32_16x16x32_bf16 a[108:111], a[168:171], v[192:195], a[108:111]
ds_read_b128 a[184:187], v3 offset:21504
v_xor_b32 v2, 0x8000, v2
v_mfma_f32_16x16x32_bf16 a[108:111], a[172:175], v[196:199], a[108:111]
buffer_load_dwordx4 a[228:231], v15, s[44:47], s65 offen offset:0 sc1
ds_read_b128 a[188:191], v3 offset:29696
v_mfma_f32_16x16x32_bf16 a[76:79], a[172:175], v[188:191], a[76:79]
v_exp_f32 v145, v145
v_mfma_f32_16x16x32_bf16 a[76:79], a[168:171], v[184:187], a[76:79]
s_waitcnt lgkmcnt(2)
buffer_load_dwordx4 a[236:239], v15, s[44:47], s65 offen offset:1024 sc1
v_mfma_f32_16x16x32_bf16 a[80:83], a[176:179], v[184:187], a[80:83]
s_add_u32 s65, s84, 32768
ds_read_b128 a[192:195], v3 offset:22528
v_cvt_pk_bf16_f32 v211, v142, v143
v_mfma_f32_16x16x32_bf16 a[80:83], a[180:183], v[188:191], a[80:83]
buffer_load_dwordx4 v[152:155], v14, s[44:47], s65 offen offset:0 sc1
ds_read_b128 a[196:199], v3 offset:30720
v_exp_f32 v146, v146
v_mfma_f32_16x16x32_bf16 a[112:115], a[180:183], v[196:199], a[112:115]
ds_read_b128 a[200:203], v3 offset:23552
ds_read_b128 a[204:207], v3 offset:31744
v_mfma_f32_16x16x32_bf16 a[112:115], a[176:179], v[192:195], a[112:115]
s_waitcnt vmcnt(13)
s_barrier
v_xor_b32 v3, 0x8000, v3
buffer_load_dwordx4 v[160:163], v14, s[44:47], s65 offen offset:1024 sc1
s_waitcnt lgkmcnt(4)
v_mfma_f32_16x16x32_bf16 a[116:119], a[184:187], v[192:195], a[116:119]
v_exp_f32 v147, v147
v_mfma_f32_16x16x32_bf16 a[116:119], a[188:191], v[196:199], a[116:119]
buffer_load_dwordx4 v[168:171], v15, s[44:47], s65 offen offset:0 sc1
v_mfma_f32_16x16x32_bf16 a[84:87], a[188:191], v[188:191], a[84:87]
v_exp_f32 v148, v148
v_mfma_f32_16x16x32_bf16 a[84:87], a[184:187], v[184:187], a[84:87]
s_waitcnt lgkmcnt(2)
buffer_load_dwordx4 v[176:179], v15, s[44:47], s65 offen offset:1024 sc1
v_cvt_pk_bf16_f32 v212, v144, v145
v_mfma_f32_16x16x32_bf16 a[88:91], a[192:195], v[184:187], a[88:91]
s_add_u32 s65, s84, 40960
v_exp_f32 v149, v149
v_mfma_f32_16x16x32_bf16 a[88:91], a[196:199], v[188:191], a[88:91]
buffer_load_dwordx4 v[156:159], v14, s[44:47], s65 offen offset:0 sc1
v_mfma_f32_16x16x32_bf16 a[120:123], a[196:199], v[196:199], a[120:123]
ds_read_b128 a[144:147], v3 offset:0
v_cvt_pk_bf16_f32 v213, v146, v147
v_mfma_f32_16x16x32_bf16 a[120:123], a[192:195], v[192:195], a[120:123]
s_waitcnt lgkmcnt(1)
buffer_load_dwordx4 v[164:167], v14, s[44:47], s65 offen offset:1024 sc1
ds_read_b128 a[148:151], v3 offset:8192
v_exp_f32 v150, v150
v_mfma_f32_16x16x32_bf16 a[124:127], a[200:203], v[192:195], a[124:127]
ds_read_b128 a[152:155], v3 offset:1024
v_cvt_pk_bf16_f32 v214, v148, v149
v_mfma_f32_16x16x32_bf16 a[124:127], a[204:207], v[196:199], a[124:127]
buffer_load_dwordx4 v[172:175], v15, s[44:47], s65 offen offset:0 sc1
ds_read_b128 a[156:159], v3 offset:9216
v_mfma_f32_16x16x32_bf16 a[92:95], a[204:207], v[188:191], a[92:95]
v_exp_f32 v151, v151
v_mfma_f32_16x16x32_bf16 a[92:95], a[200:203], v[184:187], a[92:95]
buffer_load_dwordx4 v[180:183], v15, s[44:47], s65 offen offset:1024 sc1
ds_read_b128 a[160:163], v3 offset:2048
ds_read_b128 a[164:167], v3 offset:10240
ds_read_b128 a[168:171], v3 offset:3072
ds_read_b128 a[172:175], v3 offset:11264
v_cvt_pk_bf16_f32 v215, v150, v151
v_accvgpr_read_b32 v22, a136
v_accvgpr_read_b32 v248, a137
v_add_f32 v22, v22, v248
v_max_f32 v1, v1, v22
v_rcp_f32 v22, v22
v_accvgpr_read_b32 v232, a64
v_accvgpr_read_b32 v233, a65
v_accvgpr_read_b32 v234, a66
v_accvgpr_read_b32 v235, a67
v_accvgpr_read_b32 v236, a68
v_accvgpr_read_b32 v237, a69
v_accvgpr_read_b32 v238, a70
v_accvgpr_read_b32 v239, a71
v_mul_f32 v22, v22, v8
v_mul_f32 v232, v232, v22
v_mul_f32 v233, v233, v22
v_mul_f32 v234, v234, v22
v_mul_f32 v235, v235, v22
v_mul_f32 v236, v236, v22
v_mul_f32 v237, v237, v22
v_mul_f32 v238, v238, v22
v_mul_f32 v239, v239, v22
v_cvt_pk_bf16_f32 v232, v232, v233
v_cvt_pk_bf16_f32 v233, v234, v235
v_cvt_pk_bf16_f32 v234, v236, v237
v_cvt_pk_bf16_f32 v235, v238, v239
s_add_u32 s77, s75, 0
buffer_store_dwordx4 v[232:235], v16, s[44:47], s77 offen sc1
s_branch L_TAIL
L_fallback_11:
s_waitcnt vmcnt(0) lgkmcnt(0)
s_barrier
s_mov_b32 s73, 1
s_mov_b32 s81, 0
v_and_b32 v232, 15, v0
v_lshrrev_b32 v233, 4, v0
v_lshlrev_b32 v233, 2, v233
v_sub_u32 v232, v232, v233
s_lshl_b32 s66, s30, 4
v_add_u32 v232, s66, v232
s_lshl_b32 s66, s16, 7
v_add_u32 v234, s66, v232
s_lshl_b32 s66, s3, 7
v_add_u32 v232, s66, v232
v_add_u32 v233, 64, v232
v_add_u32 v235, 64, v234
s_mov_b32 m0, s76
s_lshl_b32 s64, s30, 14
s_nop 0
buffer_load_dwordx4 v16, s[32:35], s64 offen offset:0 sc1 lds
s_nop 0
buffer_load_dwordx4 v16, s[32:35], s64 offen offset:1024 sc1 lds
s_nop 0
buffer_load_dwordx4 v16, s[32:35], s64 offen offset:2048 sc1 lds
s_nop 0
buffer_load_dwordx4 v16, s[32:35], s64 offen offset:3072 sc1 lds
s_add_u32 m0, s76, 4096
s_add_u32 s64, s64, 4096
s_nop 0
buffer_load_dwordx4 v16, s[32:35], s64 offen offset:0 sc1 lds
s_nop 0
buffer_load_dwordx4 v16, s[32:35], s64 offen offset:1024 sc1 lds
s_nop 0
buffer_load_dwordx4 v16, s[32:35], s64 offen offset:2048 sc1 lds
s_nop 0
buffer_load_dwordx4 v16, s[32:35], s64 offen offset:3072 sc1 lds
s_lshr_b32 s64, s76, 1
s_add_u32 m0, s64, 81920
s_and_b32 s71, s64, 8192
s_add_u32 s64, s64, s71
s_add_u32 s64, s64, 8192
s_nop 0
buffer_load_dwordx4 v16, s[32:35], s64 offen offset:0 sc1 lds
s_nop 0
buffer_load_dwordx4 v16, s[32:35], s64 offen offset:1024 sc1 lds
s_nop 0
buffer_load_dwordx4 v16, s[32:35], s64 offen offset:2048 sc1 lds
s_nop 0
buffer_load_dwordx4 v16, s[32:35], s64 offen offset:3072 sc1 lds
v_mov_b32 v20, 0xff800000
v_mov_b32 v21, 0xff800000
v_mov_b32 v22, 0xff800000
v_mov_b32 v23, 0xff800000
L_fbl_1015:
buffer_load_dwordx4 a[144:147], v16, s[32:35], s81 offen offset:0 sc1
buffer_load_dwordx4 a[148:151], v16, s[32:35], s81 offen offset:1024 sc1
buffer_load_dwordx4 a[152:155], v16, s[32:35], s81 offen offset:2048 sc1
buffer_load_dwordx4 a[156:159], v16, s[32:35], s81 offen offset:3072 sc1
s_add_u32 s64, s81, 4096
buffer_load_dwordx4 a[160:163], v16, s[32:35], s64 offen offset:0 sc1
buffer_load_dwordx4 a[164:167], v16, s[32:35], s64 offen offset:1024 sc1
buffer_load_dwordx4 a[168:171], v16, s[32:35], s64 offen offset:2048 sc1
buffer_load_dwordx4 a[172:175], v16, s[32:35], s64 offen offset:3072 sc1
v_subrev_u32 v88, 0, v232
v_ashrrev_i32 v88, 31, v88
v_and_b32 v88, 0xff800000, v88
v_subrev_u32 v89, 1, v232
v_ashrrev_i32 v89, 31, v89
v_and_b32 v89, 0xff800000, v89
v_subrev_u32 v90, 2, v232
v_ashrrev_i32 v90, 31, v90
v_and_b32 v90, 0xff800000, v90
v_subrev_u32 v91, 3, v232
v_ashrrev_i32 v91, 31, v91
v_and_b32 v91, 0xff800000, v91
v_subrev_u32 v92, 16, v232
v_ashrrev_i32 v92, 31, v92
v_and_b32 v92, 0xff800000, v92
v_subrev_u32 v93, 17, v232
v_ashrrev_i32 v93, 31, v93
v_and_b32 v93, 0xff800000, v93
v_subrev_u32 v94, 18, v232
v_ashrrev_i32 v94, 31, v94
v_and_b32 v94, 0xff800000, v94
v_subrev_u32 v95, 19, v232
v_ashrrev_i32 v95, 31, v95
v_and_b32 v95, 0xff800000, v95
v_subrev_u32 v232, 32, v232
v_subrev_u32 v104, 0, v233
v_ashrrev_i32 v104, 31, v104
v_and_b32 v104, 0xff800000, v104
v_subrev_u32 v105, 1, v233
v_ashrrev_i32 v105, 31, v105
v_and_b32 v105, 0xff800000, v105
v_subrev_u32 v106, 2, v233
v_ashrrev_i32 v106, 31, v106
v_and_b32 v106, 0xff800000, v106
v_subrev_u32 v107, 3, v233
v_ashrrev_i32 v107, 31, v107
v_and_b32 v107, 0xff800000, v107
v_subrev_u32 v108, 16, v233
v_ashrrev_i32 v108, 31, v108
v_and_b32 v108, 0xff800000, v108
v_subrev_u32 v109, 17, v233
v_ashrrev_i32 v109, 31, v109
v_and_b32 v109, 0xff800000, v109
v_subrev_u32 v110, 18, v233
v_ashrrev_i32 v110, 31, v110
v_and_b32 v110, 0xff800000, v110
v_subrev_u32 v111, 19, v233
v_ashrrev_i32 v111, 31, v111
v_and_b32 v111, 0xff800000, v111
v_subrev_u32 v233, 32, v233
v_subrev_u32 v120, 0, v234
v_ashrrev_i32 v120, 31, v120
v_and_b32 v120, 0xff800000, v120
v_subrev_u32 v121, 1, v234
v_ashrrev_i32 v121, 31, v121
v_and_b32 v121, 0xff800000, v121
v_subrev_u32 v122, 2, v234
v_ashrrev_i32 v122, 31, v122
v_and_b32 v122, 0xff800000, v122
v_subrev_u32 v123, 3, v234
v_ashrrev_i32 v123, 31, v123
v_and_b32 v123, 0xff800000, v123
v_subrev_u32 v124, 16, v234
v_ashrrev_i32 v124, 31, v124
v_and_b32 v124, 0xff800000, v124
v_subrev_u32 v125, 17, v234
v_ashrrev_i32 v125, 31, v125
v_and_b32 v125, 0xff800000, v125
v_subrev_u32 v126, 18, v234
v_ashrrev_i32 v126, 31, v126
v_and_b32 v126, 0xff800000, v126
v_subrev_u32 v127, 19, v234
v_ashrrev_i32 v127, 31, v127
v_and_b32 v127, 0xff800000, v127
v_subrev_u32 v234, 32, v234
v_subrev_u32 v136, 0, v235
v_ashrrev_i32 v136, 31, v136
v_and_b32 v136, 0xff800000, v136
v_subrev_u32 v137, 1, v235
v_ashrrev_i32 v137, 31, v137
v_and_b32 v137, 0xff800000, v137
v_subrev_u32 v138, 2, v235
v_ashrrev_i32 v138, 31, v138
v_and_b32 v138, 0xff800000, v138
v_subrev_u32 v139, 3, v235
v_ashrrev_i32 v139, 31, v139
v_and_b32 v139, 0xff800000, v139
v_subrev_u32 v140, 16, v235
v_ashrrev_i32 v140, 31, v140
v_and_b32 v140, 0xff800000, v140
v_subrev_u32 v141, 17, v235
v_ashrrev_i32 v141, 31, v141
v_and_b32 v141, 0xff800000, v141
v_subrev_u32 v142, 18, v235
v_ashrrev_i32 v142, 31, v142
v_and_b32 v142, 0xff800000, v142
v_subrev_u32 v143, 19, v235
v_ashrrev_i32 v143, 31, v143
v_and_b32 v143, 0xff800000, v143
v_subrev_u32 v235, 32, v235
s_waitcnt vmcnt(0)
v_mfma_f32_16x16x32_bf16 v[88:91], a[144:147], v[24:27], v[88:91]
v_mfma_f32_16x16x32_bf16 v[104:107], a[144:147], v[40:43], v[104:107]
v_mfma_f32_16x16x32_bf16 v[120:123], a[144:147], v[56:59], v[120:123]
v_mfma_f32_16x16x32_bf16 v[136:139], a[144:147], v[72:75], v[136:139]
v_mfma_f32_16x16x32_bf16 v[88:91], a[148:151], v[28:31], v[88:91]
v_mfma_f32_16x16x32_bf16 v[104:107], a[148:151], v[44:47], v[104:107]
v_mfma_f32_16x16x32_bf16 v[120:123], a[148:151], v[60:63], v[120:123]
v_mfma_f32_16x16x32_bf16 v[136:139], a[148:151], v[76:79], v[136:139]
v_mfma_f32_16x16x32_bf16 v[88:91], a[152:155], v[32:35], v[88:91]
v_mfma_f32_16x16x32_bf16 v[104:107], a[152:155], v[48:51], v[104:107]
v_mfma_f32_16x16x32_bf16 v[120:123], a[152:155], v[64:67], v[120:123]
v_mfma_f32_16x16x32_bf16 v[136:139], a[152:155], v[80:83], v[136:139]
v_mfma_f32_16x16x32_bf16 v[88:91], a[156:159], v[36:39], v[88:91]
v_mfma_f32_16x16x32_bf16 v[104:107], a[156:159], v[52:55], v[104:107]
v_mfma_f32_16x16x32_bf16 v[120:123], a[156:159], v[68:71], v[120:123]
v_mfma_f32_16x16x32_bf16 v[136:139], a[156:159], v[84:87], v[136:139]
v_mfma_f32_16x16x32_bf16 v[92:95], a[160:163], v[24:27], v[92:95]
v_mfma_f32_16x16x32_bf16 v[108:111], a[160:163], v[40:43], v[108:111]
v_mfma_f32_16x16x32_bf16 v[124:127], a[160:163], v[56:59], v[124:127]
v_mfma_f32_16x16x32_bf16 v[140:143], a[160:163], v[72:75], v[140:143]
v_mfma_f32_16x16x32_bf16 v[92:95], a[164:167], v[28:31], v[92:95]
v_mfma_f32_16x16x32_bf16 v[108:111], a[164:167], v[44:47], v[108:111]
v_mfma_f32_16x16x32_bf16 v[124:127], a[164:167], v[60:63], v[124:127]
v_mfma_f32_16x16x32_bf16 v[140:143], a[164:167], v[76:79], v[140:143]
v_mfma_f32_16x16x32_bf16 v[92:95], a[168:171], v[32:35], v[92:95]
v_mfma_f32_16x16x32_bf16 v[108:111], a[168:171], v[48:51], v[108:111]
v_mfma_f32_16x16x32_bf16 v[124:127], a[168:171], v[64:67], v[124:127]
v_mfma_f32_16x16x32_bf16 v[140:143], a[168:171], v[80:83], v[140:143]
v_mfma_f32_16x16x32_bf16 v[92:95], a[172:175], v[36:39], v[92:95]
v_mfma_f32_16x16x32_bf16 v[108:111], a[172:175], v[52:55], v[108:111]
v_mfma_f32_16x16x32_bf16 v[124:127], a[172:175], v[68:71], v[124:127]
v_mfma_f32_16x16x32_bf16 v[140:143], a[172:175], v[84:87], v[140:143]
s_nop 7
v_max3_f32 v20, v20, v88, v89
v_max3_f32 v20, v20, v90, v91
v_max3_f32 v20, v20, v92, v93
v_max3_f32 v20, v20, v94, v95
v_max3_f32 v21, v21, v104, v105
v_max3_f32 v21, v21, v106, v107
v_max3_f32 v21, v21, v108, v109
v_max3_f32 v21, v21, v110, v111
v_max3_f32 v22, v22, v120, v121
v_max3_f32 v22, v22, v122, v123
v_max3_f32 v22, v22, v124, v125
v_max3_f32 v22, v22, v126, v127
v_max3_f32 v23, v23, v136, v137
v_max3_f32 v23, v23, v138, v139
v_max3_f32 v23, v23, v140, v141
v_max3_f32 v23, v23, v142, v143
s_add_u32 s81, s81, 16384
s_cmp_lt_u32 s81, s34
s_cbranch_scc1 L_fbl_1015
v_mov_b32 v248, v20
v_mov_b32 v249, v21
v_mov_b32 v250, v22
v_mov_b32 v251, v23
v_permlane16_swap_b32 v248, v20
v_permlane16_swap_b32 v249, v21
v_permlane16_swap_b32 v250, v22
v_permlane16_swap_b32 v251, v23
v_max_f32 v20, v20, v248
v_max_f32 v21, v21, v249
v_max_f32 v22, v22, v250
v_max_f32 v23, v23, v251
v_mov_b32 v248, v20
v_mov_b32 v249, v21
v_mov_b32 v250, v22
v_mov_b32 v251, v23
v_permlane32_swap_b32 v248, v20
v_permlane32_swap_b32 v249, v21
v_permlane32_swap_b32 v250, v22
v_permlane32_swap_b32 v251, v23
v_max_f32 v20, v20, v248
v_max_f32 v21, v21, v249
v_max_f32 v22, v22, v250
v_max_f32 v23, v23, v251
v_mov_b32 v252, v20
v_mov_b32 v253, v21
v_mov_b32 v254, v22
v_mov_b32 v255, v23
s_and_b32 s70, s30, 1
s_lshr_b32 s67, s30, 1
s_lshl3_add_u32 s71, s67, s70
s_add_u32 s71, s71, 4
s_lshl_b32 s71, s71, 13
s_lshl_b32 s70, s70, 14
s_mul_i32 s67, s67, 24576
s_sub_u32 s70, s70, s67
s_add_u32 s70, s70, 65536
s_branch L_attstart_7
L_spin_2016:
s_mov_b32 vcc_hi, 0x80000
L_spinlp_2018:
s_sleep 1
buffer_load_dword v19, off, s[52:55], s72 offset:0 sc1
s_waitcnt vmcnt(0)
v_readfirstlane_b32 vcc_lo, v19
s_sub_u32 vcc_hi, vcc_hi, 1
s_cbranch_scc1 L_spinbk_2017
s_cmp_lt_u32 vcc_lo, 8
s_cbranch_scc1 L_spinlp_2018
s_branch L_spinbk_2017
L_spin_3019:
s_mov_b32 vcc_hi, 0x80000
L_spinlp_3021:
s_sleep 1
buffer_load_dword v19, off, s[52:55], s72 offset:0 sc1
s_waitcnt vmcnt(0)
v_readfirstlane_b32 vcc_lo, v19
s_sub_u32 vcc_hi, vcc_hi, 1
s_cbranch_scc1 L_spinbk_3020
s_cmp_lt_u32 vcc_lo, 8
s_cbranch_scc1 L_spinlp_3021
s_branch L_spinbk_3020
L_p5f0:
s_waitcnt lgkmcnt(10)
s_waitcnt vmcnt(28)
v_mfma_f32_16x16x32_bf16 v[136:139], a[144:147], a[232:235], 0
s_waitcnt vmcnt(24)
s_waitcnt lgkmcnt(8)
s_add_u32 m0, s86, 65536
ds_read_b64_tr_b16 a[168:169], v191 offset:32768
v_xor_b32 v192, 0x10000, v184
v_mfma_f32_16x16x32_bf16 v[136:139], a[148:151], a[236:239], v[136:139]
s_add_u32 s64, s85, 524288
ds_read_b64_tr_b16 a[170:171], v191 offset:36864
v_xor_b32 v193, 0x10000, v185
v_mfma_f32_16x16x32_bf16 v[104:107], a[148:151], a[228:231], 0
buffer_load_dwordx4 v12, s[36:39], s64 offen lds
v_mfma_f32_16x16x32_bf16 v[104:107], a[144:147], a[224:227], v[104:107]
s_add_u32 m0, s86, 66560
s_add_u32 s64, s85, 532480
ds_read_b64_tr_b16 a[172:173], v191 offset:40960
v_xor_b32 v194, 0x10000, v186
v_mfma_f32_16x16x32_bf16 v[72:75], a[144:147], a[216:219], 0
s_and_b32 s71, s31, 4
buffer_load_dwordx4 v13, s[36:39], s64 offen lds
v_mfma_f32_16x16x32_bf16 v[72:75], a[148:151], a[220:223], v[72:75]
s_lshl_b32 s71, s71, 5
s_add_u32 s71, s71, s79
s_add_u32 m0, s86, 67584
s_add_u32 s64, s85, 540672
ds_read_b64_tr_b16 a[174:175], v191 offset:45056
v_mfma_f32_16x16x32_bf16 v[40:43], a[148:151], a[212:215], 0
s_add_u32 s71, s71, 4096
buffer_load_dwordx4 v12, s[36:39], s64 offen lds
v_mfma_f32_16x16x32_bf16 v[40:43], a[144:147], a[208:211], v[40:43]
s_waitcnt lgkmcnt(4)
s_add_u32 s72, s80, 4096
s_add_u32 m0, s86, 68608
s_add_u32 s64, s85, 548864
ds_read_b64_tr_b16 a[176:177], v184 offset:32768
v_xor_b32 v195, 0x10000, v187
v_mfma_f32_16x16x32_bf16 v[44:47], a[152:155], a[208:211], 0
buffer_load_dwordx4 v13, s[36:39], s64 offen lds
v_mfma_f32_16x16x32_bf16 v[44:47], a[156:159], a[212:215], v[44:47]
s_add_u32 m0, s86, 69632
ds_read_b64_tr_b16 a[178:179], v184 offset:36864
v_xor_b32 v196, 0x10000, v188
v_mfma_f32_16x16x32_bf16 v[76:79], a[156:159], a[220:223], 0
s_add_u32 s64, s85, 557056
ds_read_b64_tr_b16 a[180:181], v184 offset:40960
v_xor_b32 v197, 0x10000, v189
v_mfma_f32_16x16x32_bf16 v[76:79], a[152:155], a[216:219], v[76:79]
buffer_load_dwordx4 v12, s[36:39], s64 offen lds
v_mfma_f32_16x16x32_bf16 v[108:111], a[152:155], a[224:227], 0
s_add_u32 m0, s86, 70656
s_add_u32 s64, s85, 565248
ds_read_b64_tr_b16 a[182:183], v184 offset:45056
v_xor_b32 v198, 0x10000, v190
v_mfma_f32_16x16x32_bf16 v[108:111], a[156:159], a[228:231], v[108:111]
buffer_load_dwordx4 v13, s[36:39], s64 offen lds
v_mfma_f32_16x16x32_bf16 v[140:143], a[156:159], a[236:239], 0
s_add_u32 m0, s86, 71680
s_add_u32 s64, s85, 573440
ds_read_b64_tr_b16 a[184:185], v185 offset:32768
v_xor_b32 v199, 0x10000, v191
v_mfma_f32_16x16x32_bf16 v[140:143], a[152:155], a[232:235], v[140:143]
buffer_load_dwordx4 v12, s[36:39], s64 offen lds
v_mfma_f32_16x16x32_bf16 v[144:147], a[160:163], a[232:235], 0
s_add_u32 m0, s86, 72704
ds_read_b64_tr_b16 a[186:187], v185 offset:36864
v_mfma_f32_16x16x32_bf16 v[144:147], a[164:167], a[236:239], v[144:147]
s_add_u32 s64, s85, 581632
ds_read_b64_tr_b16 a[188:189], v185 offset:40960
v_mfma_f32_16x16x32_bf16 v[112:115], a[164:167], a[228:231], 0
buffer_load_dwordx4 v13, s[36:39], s64 offen lds
v_mfma_f32_16x16x32_bf16 v[112:115], a[160:163], a[224:227], v[112:115]
s_add_u32 s65, s84, 65536
ds_read_b64_tr_b16 a[190:191], v185 offset:45056
v_mfma_f32_16x16x32_bf16 v[80:83], a[160:163], a[216:219], 0
buffer_load_dwordx4 a[0:3], v14, s[44:47], s65 offen offset:0 sc1
v_mfma_f32_16x16x32_bf16 v[80:83], a[164:167], a[220:223], v[80:83]
ds_read_b64_tr_b16 a[192:193], v186 offset:32768
v_mfma_f32_16x16x32_bf16 v[48:51], a[164:167], a[212:215], 0
buffer_load_dwordx4 a[8:11], v14, s[44:47], s65 offen offset:1024 sc1
v_mfma_f32_16x16x32_bf16 v[48:51], a[160:163], a[208:211], v[48:51]
s_waitcnt lgkmcnt(4)
ds_read_b64_tr_b16 a[194:195], v186 offset:36864
v_mfma_f32_16x16x32_bf16 v[52:55], a[168:171], a[208:211], 0
ds_read_b64_tr_b16 a[196:197], v186 offset:40960
v_mfma_f32_16x16x32_bf16 v[52:55], a[172:175], a[212:215], v[52:55]
buffer_load_dwordx4 a[16:19], v15, s[44:47], s65 offen offset:0 sc1
v_mfma_f32_16x16x32_bf16 v[84:87], a[172:175], a[220:223], 0
ds_read_b64_tr_b16 a[198:199], v186 offset:45056
v_mfma_f32_16x16x32_bf16 v[84:87], a[168:171], a[216:219], v[84:87]
buffer_load_dwordx4 a[24:27], v15, s[44:47], s65 offen offset:1024 sc1
v_mfma_f32_16x16x32_bf16 v[116:119], a[168:171], a[224:227], 0
s_add_u32 s65, s84, 73728
ds_read_b64_tr_b16 a[200:201], v187 offset:32768
v_mfma_f32_16x16x32_bf16 v[116:119], a[172:175], a[228:231], v[116:119]
buffer_load_dwordx4 a[4:7], v14, s[44:47], s65 offen offset:0 sc1
v_mfma_f32_16x16x32_bf16 v[148:151], a[172:175], a[236:239], 0
ds_read_b64_tr_b16 a[202:203], v187 offset:36864
v_mfma_f32_16x16x32_bf16 v[148:151], a[168:171], a[232:235], v[148:151]
ds_read_b64_tr_b16 a[204:205], v187 offset:40960
v_mfma_f32_16x16x32_bf16 v[120:123], a[176:179], a[232:235], 0
buffer_load_dwordx4 a[12:15], v14, s[44:47], s65 offen offset:1024 sc1
v_mfma_f32_16x16x32_bf16 v[120:123], a[180:183], a[236:239], v[120:123]
ds_read_b64_tr_b16 a[206:207], v187 offset:45056
v_mfma_f32_16x16x32_bf16 v[88:91], a[180:183], a[228:231], 0
buffer_load_dwordx4 a[20:23], v15, s[44:47], s65 offen offset:0 sc1
v_mfma_f32_16x16x32_bf16 v[88:91], a[176:179], a[224:227], v[88:91]
v_mfma_f32_16x16x32_bf16 v[56:59], a[176:179], a[216:219], 0
buffer_load_dwordx4 a[28:31], v15, s[44:47], s65 offen offset:1024 sc1
v_mfma_f32_16x16x32_bf16 v[56:59], a[180:183], a[220:223], v[56:59]
v_mfma_f32_16x16x32_bf16 v[24:27], a[180:183], a[212:215], 0
v_mfma_f32_16x16x32_bf16 v[24:27], a[176:179], a[208:211], v[24:27]
s_waitcnt lgkmcnt(1)
v_mfma_f32_16x16x32_bf16 v[28:31], a[184:187], a[208:211], 0
s_waitcnt vmcnt(23)
s_barrier
v_mfma_f32_16x16x32_bf16 v[28:31], a[188:191], a[212:215], v[28:31]
ds_read_b64_tr_b16 a[144:145], v196 offset:0
v_mfma_f32_16x16x32_bf16 v[60:63], a[188:191], a[220:223], 0
ds_read_b64_tr_b16 a[146:147], v196 offset:4096
v_mfma_f32_16x16x32_bf16 v[60:63], a[184:187], a[216:219], v[60:63]
s_add_u32 m0, s86, 0
ds_read_b64_tr_b16 a[148:149], v196 offset:8192
v_mfma_f32_16x16x32_bf16 v[92:95], a[184:187], a[224:227], 0
s_add_u32 s64, s85, 786432
ds_read_b64_tr_b16 a[150:151], v196 offset:12288
v_mfma_f32_16x16x32_bf16 v[92:95], a[188:191], a[228:231], v[92:95]
buffer_load_dwordx4 v12, s[36:39], s64 offen lds
v_mfma_f32_16x16x32_bf16 v[124:127], a[188:191], a[236:239], 0
s_add_u32 m0, s86, 1024
ds_read_b64_tr_b16 a[152:153], v197 offset:0
v_mfma_f32_16x16x32_bf16 v[124:127], a[184:187], a[232:235], v[124:127]
s_add_u32 s64, s85, 794624
ds_read_b64_tr_b16 a[154:155], v197 offset:4096
v_mfma_f32_16x16x32_bf16 v[128:131], a[192:195], a[232:235], 0
buffer_load_dwordx4 v13, s[36:39], s64 offen lds
v_mfma_f32_16x16x32_bf16 v[128:131], a[196:199], a[236:239], v[128:131]
ds_read_b64_tr_b16 a[156:157], v197 offset:8192
v_mfma_f32_16x16x32_bf16 v[96:99], a[196:199], a[228:231], 0
s_add_u32 m0, s86, 2048
ds_read_b64_tr_b16 a[158:159], v197 offset:12288
v_mfma_f32_16x16x32_bf16 v[96:99], a[192:195], a[224:227], v[96:99]
s_add_u32 s64, s85, 802816
ds_read_b64_tr_b16 a[160:161], v198 offset:0
v_mfma_f32_16x16x32_bf16 v[64:67], a[192:195], a[216:219], 0
buffer_load_dwordx4 v12, s[36:39], s64 offen lds
v_mfma_f32_16x16x32_bf16 v[64:67], a[196:199], a[220:223], v[64:67]
ds_read_b64_tr_b16 a[162:163], v198 offset:4096
v_mfma_f32_16x16x32_bf16 v[32:35], a[196:199], a[212:215], 0
s_add_u32 m0, s86, 3072
ds_read_b64_tr_b16 a[164:165], v198 offset:8192
v_mfma_f32_16x16x32_bf16 v[32:35], a[192:195], a[208:211], v[32:35]
s_add_u32 s64, s85, 811008
ds_read_b64_tr_b16 a[166:167], v198 offset:12288
v_mfma_f32_16x16x32_bf16 v[36:39], a[200:203], a[208:211], 0
s_waitcnt lgkmcnt(6)
buffer_load_dwordx4 v13, s[36:39], s64 offen lds
v_mfma_f32_16x16x32_bf16 v[36:39], a[204:207], a[212:215], v[36:39]
v_mfma_f32_16x16x32_bf16 v[68:71], a[204:207], a[220:223], 0
s_add_u32 m0, s86, 4096
v_mfma_f32_16x16x32_bf16 v[68:71], a[200:203], a[216:219], v[68:71]
s_add_u32 s64, s85, 819200
v_mfma_f32_16x16x32_bf16 v[100:103], a[200:203], a[224:227], 0
buffer_load_dwordx4 v12, s[36:39], s64 offen lds
v_mfma_f32_16x16x32_bf16 v[100:103], a[204:207], a[228:231], v[100:103]
v_mfma_f32_16x16x32_bf16 v[132:135], a[204:207], a[236:239], 0
v_mfma_f32_16x16x32_bf16 v[132:135], a[200:203], a[232:235], v[132:135]
v_mfma_f32_16x16x32_bf16 v[136:139], a[144:147], v[176:179], v[136:139]
s_add_u32 m0, s86, 5120
ds_read_b64_tr_b16 a[168:169], v199 offset:0
v_xor_b32 v200, 0x18000, v184
v_mfma_f32_16x16x32_bf16 v[136:139], a[148:151], v[180:183], v[136:139]
s_add_u32 s64, s85, 827392
ds_read_b64_tr_b16 a[170:171], v199 offset:4096
v_xor_b32 v201, 0x18000, v185
v_mfma_f32_16x16x32_bf16 v[104:107], a[148:151], v[172:175], v[104:107]
buffer_load_dwordx4 v13, s[36:39], s64 offen lds
v_mfma_f32_16x16x32_bf16 v[104:107], a[144:147], v[168:171], v[104:107]
s_add_u32 m0, s86, 6144
ds_read_b64_tr_b16 a[172:173], v199 offset:8192
v_xor_b32 v202, 0x18000, v186
v_mfma_f32_16x16x32_bf16 v[72:75], a[144:147], v[160:163], v[72:75]
s_add_u32 s64, s85, 835584
ds_read_b64_tr_b16 a[174:175], v199 offset:12288
v_xor_b32 v203, 0x18000, v187
v_mfma_f32_16x16x32_bf16 v[72:75], a[148:151], v[164:167], v[72:75]
buffer_load_dwordx4 v12, s[36:39], s64 offen lds
v_mfma_f32_16x16x32_bf16 v[40:43], a[148:151], v[156:159], v[40:43]
s_add_u32 m0, s86, 7168
ds_read_b64_tr_b16 a[176:177], v192 offset:0
v_xor_b32 v204, 0x18000, v188
v_mfma_f32_16x16x32_bf16 v[40:43], a[144:147], v[152:155], v[40:43]
s_add_u32 s64, s85, 843776
ds_read_b64_tr_b16 a[178:179], v192 offset:4096
v_xor_b32 v205, 0x18000, v189
v_mfma_f32_16x16x32_bf16 v[44:47], a[152:155], v[152:155], v[44:47]
s_waitcnt lgkmcnt(5)
buffer_load_dwordx4 v13, s[36:39], s64 offen lds
v_mfma_f32_16x16x32_bf16 v[44:47], a[156:159], v[156:159], v[44:47]
ds_read_b64_tr_b16 a[180:181], v192 offset:8192
v_xor_b32 v206, 0x18000, v190
v_mfma_f32_16x16x32_bf16 v[76:79], a[156:159], v[164:167], v[76:79]
ds_read_b64_tr_b16 a[182:183], v192 offset:12288
v_xor_b32 v207, 0x18000, v191
v_mfma_f32_16x16x32_bf16 v[76:79], a[152:155], v[160:163], v[76:79]
s_add_u32 s65, s84, 98304
ds_read_b64_tr_b16 a[184:185], v193 offset:0
v_mfma_f32_16x16x32_bf16 v[108:111], a[152:155], v[168:171], v[108:111]
buffer_load_dwordx4 a[64:67], v14, s[44:47], s65 offen offset:0 sc1
v_mfma_f32_16x16x32_bf16 v[108:111], a[156:159], v[172:175], v[108:111]
ds_read_b64_tr_b16 a[186:187], v193 offset:4096
v_mfma_f32_16x16x32_bf16 v[140:143], a[156:159], v[180:183], v[140:143]
ds_read_b64_tr_b16 a[188:189], v193 offset:8192
v_mfma_f32_16x16x32_bf16 v[140:143], a[152:155], v[176:179], v[140:143]
buffer_load_dwordx4 a[72:75], v14, s[44:47], s65 offen offset:1024 sc1
v_mfma_f32_16x16x32_bf16 v[144:147], a[160:163], v[176:179], v[144:147]
ds_read_b64_tr_b16 a[190:191], v193 offset:12288
v_mfma_f32_16x16x32_bf16 v[144:147], a[164:167], v[180:183], v[144:147]
v_mfma_f32_16x16x32_bf16 v[112:115], a[164:167], v[172:175], v[112:115]
buffer_load_dwordx4 a[80:83], v15, s[44:47], s65 offen offset:0 sc1
v_mfma_f32_16x16x32_bf16 v[112:115], a[160:163], v[168:171], v[112:115]
ds_read_b64_tr_b16 a[192:193], v194 offset:0
v_mfma_f32_16x16x32_bf16 v[80:83], a[160:163], v[160:163], v[80:83]
ds_read_b64_tr_b16 a[194:195], v194 offset:4096
v_mfma_f32_16x16x32_bf16 v[80:83], a[164:167], v[164:167], v[80:83]
ds_read_b64_tr_b16 a[196:197], v194 offset:8192
v_mfma_f32_16x16x32_bf16 v[48:51], a[164:167], v[156:159], v[48:51]
buffer_load_dwordx4 a[88:91], v15, s[44:47], s65 offen offset:1024 sc1
v_mfma_f32_16x16x32_bf16 v[48:51], a[160:163], v[152:155], v[48:51]
s_waitcnt lgkmcnt(4)
ds_read_b64_tr_b16 a[198:199], v194 offset:12288
v_mfma_f32_16x16x32_bf16 v[52:55], a[168:171], v[152:155], v[52:55]
s_add_u32 s65, s84, 106496
v_mfma_f32_16x16x32_bf16 v[52:55], a[172:175], v[156:159], v[52:55]
buffer_load_dwordx4 a[68:71], v14, s[44:47], s65 offen offset:0 sc1
v_mfma_f32_16x16x32_bf16 v[84:87], a[172:175], v[164:167], v[84:87]
ds_read_b64_tr_b16 a[200:201], v195 offset:0
v_mfma_f32_16x16x32_bf16 v[84:87], a[168:171], v[160:163], v[84:87]
ds_read_b64_tr_b16 a[202:203], v195 offset:4096
v_mfma_f32_16x16x32_bf16 v[116:119], a[168:171], v[168:171], v[116:119]
s_lshl_b32 s66, s30, 30
buffer_load_dwordx4 a[76:79], v14, s[44:47], s65 offen offset:1024 sc1
v_mfma_f32_16x16x32_bf16 v[116:119], a[172:175], v[172:175], v[116:119]
ds_read_b64_tr_b16 a[204:205], v195 offset:8192
v_lshl_add_u32 v1, v0, 24, s66
v_mfma_f32_16x16x32_bf16 v[148:151], a[172:175], v[180:183], v[148:151]
ds_read_b64_tr_b16 a[206:207], v195 offset:12288
v_mfma_f32_16x16x32_bf16 v[148:151], a[168:171], v[176:179], v[148:151]
v_mfma_f32_16x16x32_bf16 v[120:123], a[176:179], v[176:179], v[120:123]
buffer_load_dwordx4 a[84:87], v15, s[44:47], s65 offen offset:0 sc1
v_mfma_f32_16x16x32_bf16 v[120:123], a[180:183], v[180:183], v[120:123]
v_mfma_f32_16x16x32_bf16 v[88:91], a[180:183], v[172:175], v[88:91]
v_mfma_f32_16x16x32_bf16 v[88:91], a[176:179], v[168:171], v[88:91]
buffer_load_dwordx4 a[92:95], v15, s[44:47], s65 offen offset:1024 sc1
v_mfma_f32_16x16x32_bf16 v[56:59], a[176:179], v[160:163], v[56:59]
v_mfma_f32_16x16x32_bf16 v[56:59], a[180:183], v[164:167], v[56:59]
v_mfma_f32_16x16x32_bf16 v[24:27], a[180:183], v[156:159], v[24:27]
v_mfma_f32_16x16x32_bf16 v[24:27], a[176:179], v[152:155], v[24:27]
v_mfma_f32_16x16x32_bf16 v[28:31], a[184:187], v[152:155], v[28:31]
s_waitcnt vmcnt(24)
s_barrier
s_waitcnt lgkmcnt(0)
v_mfma_f32_16x16x32_bf16 v[28:31], a[188:191], v[156:159], v[28:31]
s_mov_b64 exec, 1
buffer_atomic_add a251, v1, s[52:55], s71 offen offset:0 sc1
s_mov_b64 exec, -1
v_mfma_f32_16x16x32_bf16 v[60:63], a[188:191], v[164:167], v[60:63]
ds_read_b64_tr_b16 a[144:145], v196 offset:32768
v_mfma_f32_16x16x32_bf16 v[60:63], a[184:187], v[160:163], v[60:63]
s_add_u32 m0, s86, 98304
ds_read_b64_tr_b16 a[146:147], v196 offset:36864
v_mfma_f32_16x16x32_bf16 v[92:95], a[184:187], v[168:171], v[92:95]
s_add_u32 s64, s85, 1048576
ds_read_b64_tr_b16 a[148:149], v196 offset:40960
v_mfma_f32_16x16x32_bf16 v[92:95], a[188:191], v[172:175], v[92:95]
buffer_load_dwordx4 v12, s[36:39], s64 offen lds
v_mfma_f32_16x16x32_bf16 v[124:127], a[188:191], v[180:183], v[124:127]
s_add_u32 m0, s86, 99328
ds_read_b64_tr_b16 a[150:151], v196 offset:45056
v_mfma_f32_16x16x32_bf16 v[124:127], a[184:187], v[176:179], v[124:127]
s_add_u32 s64, s85, 1056768
ds_read_b64_tr_b16 a[152:153], v197 offset:32768
v_mfma_f32_16x16x32_bf16 v[128:131], a[192:195], v[176:179], v[128:131]
buffer_load_dwordx4 v13, s[36:39], s64 offen lds
v_mfma_f32_16x16x32_bf16 v[128:131], a[196:199], v[180:183], v[128:131]
ds_read_b64_tr_b16 a[154:155], v197 offset:36864
v_mfma_f32_16x16x32_bf16 v[96:99], a[196:199], v[172:175], v[96:99]
s_add_u32 m0, s86, 100352
ds_read_b64_tr_b16 a[156:157], v197 offset:40960
v_mfma_f32_16x16x32_bf16 v[96:99], a[192:195], v[168:171], v[96:99]
s_add_u32 s64, s85, 1064960
ds_read_b64_tr_b16 a[158:159], v197 offset:45056
v_mfma_f32_16x16x32_bf16 v[64:67], a[192:195], v[160:163], v[64:67]
buffer_load_dwordx4 v12, s[36:39], s64 offen lds
v_mfma_f32_16x16x32_bf16 v[64:67], a[196:199], v[164:167], v[64:67]
ds_read_b64_tr_b16 a[160:161], v198 offset:32768
v_mfma_f32_16x16x32_bf16 v[32:35], a[196:199], v[156:159], v[32:35]
s_add_u32 m0, s86, 101376
ds_read_b64_tr_b16 a[162:163], v198 offset:36864
v_mfma_f32_16x16x32_bf16 v[32:35], a[192:195], v[152:155], v[32:35]
s_add_u32 s64, s85, 1073152
ds_read_b64_tr_b16 a[164:165], v198 offset:40960
v_mfma_f32_16x16x32_bf16 v[36:39], a[200:203], v[152:155], v[36:39]
buffer_load_dwordx4 v13, s[36:39], s64 offen lds
v_mfma_f32_16x16x32_bf16 v[36:39], a[204:207], v[156:159], v[36:39]
ds_read_b64_tr_b16 a[166:167], v198 offset:45056
v_mfma_f32_16x16x32_bf16 v[68:71], a[204:207], v[164:167], v[68:71]
s_add_u32 m0, s86, 102400
v_mfma_f32_16x16x32_bf16 v[68:71], a[200:203], v[160:163], v[68:71]
s_add_u32 s64, s85, 1081344
v_mfma_f32_16x16x32_bf16 v[100:103], a[200:203], v[168:171], v[100:103]
buffer_load_dwordx4 v12, s[36:39], s64 offen lds
v_mfma_f32_16x16x32_bf16 v[100:103], a[204:207], v[172:175], v[100:103]
v_mfma_f32_16x16x32_bf16 v[132:135], a[204:207], v[180:183], v[132:135]
s_add_u32 m0, s86, 103424
v_mfma_f32_16x16x32_bf16 v[132:135], a[200:203], v[176:179], v[132:135]
s_waitcnt vmcnt(26)
s_waitcnt lgkmcnt(1)
s_add_u32 s64, s85, 1089536
v_mfma_f32_16x16x32_bf16 v[136:139], a[144:147], a[24:27], v[136:139]
s_waitcnt vmcnt(22)
s_and_b32 s68, s82, 3
s_lshl_b32 s68, s68, 11
ds_read_b64_tr_b16 a[168:169], v199 offset:32768
v_mfma_f32_16x16x32_bf16 v[136:139], a[148:151], a[28:31], v[136:139]
s_add_u32 s76, s86, s68
s_lshr_b32 s69, s87, 8
ds_read_b64_tr_b16 a[170:171], v199 offset:36864
v_mfma_f32_16x16x32_bf16 v[104:107], a[148:151], a[20:23], v[104:107]
s_lshr_b32 s67, s82, 1
buffer_load_dwordx4 v13, s[36:39], s64 offen lds
v_mfma_f32_16x16x32_bf16 v[104:107], a[144:147], a[16:19], v[104:107]
s_xor_b32 s69, s69, s67
s_and_b32 s69, s69, 2
s_add_u32 m0, s86, 104448
ds_read_b64_tr_b16 a[172:173], v199 offset:40960
v_mfma_f32_16x16x32_bf16 v[72:75], a[144:147], a[8:11], v[72:75]
s_lshl_b32 s69, s69, 15
s_add_u32 s68, s68, s69
s_add_u32 s64, s85, 1097728
ds_read_b64_tr_b16 a[174:175], v199 offset:45056
v_mfma_f32_16x16x32_bf16 v[72:75], a[148:151], a[12:15], v[72:75]
buffer_load_dwordx4 v12, s[36:39], s64 offen lds
v_mfma_f32_16x16x32_bf16 v[40:43], a[148:151], a[4:7], v[40:43]
s_add_u32 m0, s86, 105472
ds_read_b64_tr_b16 a[176:177], v192 offset:32768
v_mfma_f32_16x16x32_bf16 v[40:43], a[144:147], a[0:3], v[40:43]
s_add_u32 s64, s85, 1105920
ds_read_b64_tr_b16 a[178:179], v192 offset:36864
v_mfma_f32_16x16x32_bf16 v[44:47], a[152:155], a[0:3], v[44:47]
buffer_load_dwordx4 v13, s[36:39], s64 offen lds
v_mfma_f32_16x16x32_bf16 v[44:47], a[156:159], a[4:7], v[44:47]
ds_read_b64_tr_b16 a[180:181], v192 offset:40960
v_mfma_f32_16x16x32_bf16 v[76:79], a[156:159], a[12:15], v[76:79]
ds_read_b64_tr_b16 a[182:183], v192 offset:45056
v_mfma_f32_16x16x32_bf16 v[76:79], a[152:155], a[8:11], v[76:79]
s_add_u32 s65, s84, 131072
ds_read_b64_tr_b16 a[184:185], v193 offset:32768
v_mfma_f32_16x16x32_bf16 v[108:111], a[152:155], a[16:19], v[108:111]
buffer_load_dwordx4 a[32:35], v14, s[44:47], s65 offen offset:0 sc1
v_mfma_f32_16x16x32_bf16 v[108:111], a[156:159], a[20:23], v[108:111]
ds_read_b64_tr_b16 a[186:187], v193 offset:36864
v_mfma_f32_16x16x32_bf16 v[140:143], a[156:159], a[28:31], v[140:143]
ds_read_b64_tr_b16 a[188:189], v193 offset:40960
v_mfma_f32_16x16x32_bf16 v[140:143], a[152:155], a[24:27], v[140:143]
buffer_load_dwordx4 a[40:43], v14, s[44:47], s65 offen offset:1024 sc1
v_mfma_f32_16x16x32_bf16 v[144:147], a[160:163], a[24:27], v[144:147]
s_waitcnt lgkmcnt(5)
ds_read_b64_tr_b16 a[190:191], v193 offset:45056
v_mfma_f32_16x16x32_bf16 v[144:147], a[164:167], a[28:31], v[144:147]
v_mfma_f32_16x16x32_bf16 v[112:115], a[164:167], a[20:23], v[112:115]
buffer_load_dwordx4 a[48:51], v15, s[44:47], s65 offen offset:0 sc1
v_mfma_f32_16x16x32_bf16 v[112:115], a[160:163], a[16:19], v[112:115]
ds_read_b64_tr_b16 a[192:193], v194 offset:32768
v_mfma_f32_16x16x32_bf16 v[80:83], a[160:163], a[8:11], v[80:83]
ds_read_b64_tr_b16 a[194:195], v194 offset:36864
v_mfma_f32_16x16x32_bf16 v[80:83], a[164:167], a[12:15], v[80:83]
ds_read_b64_tr_b16 a[196:197], v194 offset:40960
v_mfma_f32_16x16x32_bf16 v[48:51], a[164:167], a[4:7], v[48:51]
buffer_load_dwordx4 a[56:59], v15, s[44:47], s65 offen offset:1024 sc1
v_mfma_f32_16x16x32_bf16 v[48:51], a[160:163], a[0:3], v[48:51]
ds_read_b64_tr_b16 a[198:199], v194 offset:45056
v_mfma_f32_16x16x32_bf16 v[52:55], a[168:171], a[0:3], v[52:55]
s_add_u32 s65, s84, 139264
v_mfma_f32_16x16x32_bf16 v[52:55], a[172:175], a[4:7], v[52:55]
buffer_load_dwordx4 a[36:39], v14, s[44:47], s65 offen offset:0 sc1
v_mfma_f32_16x16x32_bf16 v[84:87], a[172:175], a[12:15], v[84:87]
ds_read_b64_tr_b16 a[200:201], v195 offset:32768
v_mfma_f32_16x16x32_bf16 v[84:87], a[168:171], a[8:11], v[84:87]
ds_read_b64_tr_b16 a[202:203], v195 offset:36864
v_mfma_f32_16x16x32_bf16 v[116:119], a[168:171], a[16:19], v[116:119]
buffer_load_dwordx4 a[44:47], v14, s[44:47], s65 offen offset:1024 sc1
v_mfma_f32_16x16x32_bf16 v[116:119], a[172:175], a[20:23], v[116:119]
ds_read_b64_tr_b16 a[204:205], v195 offset:40960
v_mfma_f32_16x16x32_bf16 v[148:151], a[172:175], a[28:31], v[148:151]
ds_read_b64_tr_b16 a[206:207], v195 offset:45056
v_mfma_f32_16x16x32_bf16 v[148:151], a[168:171], a[24:27], v[148:151]
v_mfma_f32_16x16x32_bf16 v[120:123], a[176:179], a[24:27], v[120:123]
s_waitcnt lgkmcnt(4)
buffer_load_dwordx4 a[52:55], v15, s[44:47], s65 offen offset:0 sc1
v_mfma_f32_16x16x32_bf16 v[120:123], a[180:183], a[28:31], v[120:123]
v_mfma_f32_16x16x32_bf16 v[88:91], a[180:183], a[20:23], v[88:91]
v_mfma_f32_16x16x32_bf16 v[88:91], a[176:179], a[16:19], v[88:91]
buffer_load_dwordx4 a[60:63], v15, s[44:47], s65 offen offset:1024 sc1
v_mfma_f32_16x16x32_bf16 v[56:59], a[176:179], a[8:11], v[56:59]
v_mfma_f32_16x16x32_bf16 v[56:59], a[180:183], a[12:15], v[56:59]
v_mfma_f32_16x16x32_bf16 v[24:27], a[180:183], a[4:7], v[24:27]
v_mfma_f32_16x16x32_bf16 v[24:27], a[176:179], a[0:3], v[24:27]
s_lshl3_add_u32 s85, s68, s85
v_mfma_f32_16x16x32_bf16 v[28:31], a[184:187], a[0:3], v[28:31]
s_waitcnt vmcnt(25)
s_barrier
v_mfma_f32_16x16x32_bf16 v[28:31], a[188:191], a[4:7], v[28:31]
ds_read_b64_tr_b16 a[144:145], v204 offset:0
v_mfma_f32_16x16x32_bf16 v[60:63], a[188:191], a[12:15], v[60:63]
ds_read_b64_tr_b16 a[146:147], v204 offset:4096
v_mfma_f32_16x16x32_bf16 v[60:63], a[184:187], a[8:11], v[60:63]
s_xor_b32 m0, s76, 131072
ds_read_b64_tr_b16 a[148:149], v204 offset:8192
v_mfma_f32_16x16x32_bf16 v[92:95], a[184:187], a[16:19], v[92:95]
s_xor_b32 s64, s85, 0
ds_read_b64_tr_b16 a[150:151], v204 offset:12288
v_mfma_f32_16x16x32_bf16 v[92:95], a[188:191], a[20:23], v[92:95]
buffer_load_dwordx4 v12, s[40:43], s64 offen lds
v_mfma_f32_16x16x32_bf16 v[124:127], a[188:191], a[28:31], v[124:127]
s_xor_b32 m0, s76, 132096
ds_read_b64_tr_b16 a[152:153], v205 offset:0
v_mfma_f32_16x16x32_bf16 v[124:127], a[184:187], a[24:27], v[124:127]
s_xor_b32 s64, s85, 8192
ds_read_b64_tr_b16 a[154:155], v205 offset:4096
v_mfma_f32_16x16x32_bf16 v[128:131], a[192:195], a[24:27], v[128:131]
buffer_load_dwordx4 v13, s[40:43], s64 offen lds
v_mfma_f32_16x16x32_bf16 v[128:131], a[196:199], a[28:31], v[128:131]
ds_read_b64_tr_b16 a[156:157], v205 offset:8192
v_mfma_f32_16x16x32_bf16 v[96:99], a[196:199], a[20:23], v[96:99]
s_xor_b32 m0, s76, 133120
ds_read_b64_tr_b16 a[158:159], v205 offset:12288
v_mfma_f32_16x16x32_bf16 v[96:99], a[192:195], a[16:19], v[96:99]
s_xor_b32 s64, s85, 16384
ds_read_b64_tr_b16 a[160:161], v206 offset:0
v_mfma_f32_16x16x32_bf16 v[64:67], a[192:195], a[8:11], v[64:67]
buffer_load_dwordx4 v12, s[40:43], s64 offen lds
v_mfma_f32_16x16x32_bf16 v[64:67], a[196:199], a[12:15], v[64:67]
ds_read_b64_tr_b16 a[162:163], v206 offset:4096
v_mfma_f32_16x16x32_bf16 v[32:35], a[196:199], a[4:7], v[32:35]
s_xor_b32 m0, s76, 134144
ds_read_b64_tr_b16 a[164:165], v206 offset:8192
v_mfma_f32_16x16x32_bf16 v[32:35], a[192:195], a[0:3], v[32:35]
s_waitcnt lgkmcnt(5)
s_xor_b32 s64, s85, 24576
ds_read_b64_tr_b16 a[166:167], v206 offset:12288
v_mfma_f32_16x16x32_bf16 v[36:39], a[200:203], a[0:3], v[36:39]
buffer_load_dwordx4 v13, s[40:43], s64 offen lds
v_mfma_f32_16x16x32_bf16 v[36:39], a[204:207], a[4:7], v[36:39]
v_mfma_f32_16x16x32_bf16 v[68:71], a[204:207], a[12:15], v[68:71]
s_xor_b32 m0, s76, 135168
v_mfma_f32_16x16x32_bf16 v[68:71], a[200:203], a[8:11], v[68:71]
s_xor_b32 s64, s85, 32768
v_mfma_f32_16x16x32_bf16 v[100:103], a[200:203], a[16:19], v[100:103]
buffer_load_dwordx4 v12, s[40:43], s64 offen lds
v_mfma_f32_16x16x32_bf16 v[100:103], a[204:207], a[20:23], v[100:103]
v_mfma_f32_16x16x32_bf16 v[132:135], a[204:207], a[28:31], v[132:135]
v_mfma_f32_16x16x32_bf16 v[132:135], a[200:203], a[24:27], v[132:135]
s_waitcnt vmcnt(26)
v_mfma_f32_16x16x32_bf16 v[136:139], a[144:147], a[88:91], v[136:139]
s_waitcnt vmcnt(22)
s_xor_b32 m0, s76, 136192
ds_read_b64_tr_b16 a[168:169], v207 offset:0
v_mfma_f32_16x16x32_bf16 v[136:139], a[148:151], a[92:95], v[136:139]
s_xor_b32 s64, s85, 40960
ds_read_b64_tr_b16 a[170:171], v207 offset:4096
v_mfma_f32_16x16x32_bf16 v[104:107], a[148:151], a[84:87], v[104:107]
buffer_load_dwordx4 v13, s[40:43], s64 offen lds
v_mfma_f32_16x16x32_bf16 v[104:107], a[144:147], a[80:83], v[104:107]
ds_read_b64_tr_b16 a[172:173], v207 offset:8192
v_mfma_f32_16x16x32_bf16 v[72:75], a[144:147], a[72:75], v[72:75]
ds_read_b64_tr_b16 a[174:175], v207 offset:12288
v_mfma_f32_16x16x32_bf16 v[72:75], a[148:151], a[76:79], v[72:75]
ds_read_b64_tr_b16 a[176:177], v200 offset:0
v_mfma_f32_16x16x32_bf16 v[40:43], a[148:151], a[68:71], v[40:43]
ds_read_b64_tr_b16 a[178:179], v200 offset:4096
v_mfma_f32_16x16x32_bf16 v[40:43], a[144:147], a[64:67], v[40:43]
ds_read_b64_tr_b16 a[180:181], v200 offset:8192
v_mfma_f32_16x16x32_bf16 v[44:47], a[152:155], a[64:67], v[44:47]
s_waitcnt lgkmcnt(6)
s_xor_b32 m0, s76, 137216
ds_read_b64_tr_b16 a[182:183], v200 offset:12288
v_mfma_f32_16x16x32_bf16 v[44:47], a[156:159], a[68:71], v[44:47]
s_xor_b32 s64, s85, 49152
v_mfma_f32_16x16x32_bf16 v[76:79], a[156:159], a[76:79], v[76:79]
buffer_load_dwordx4 v12, s[40:43], s64 offen lds
v_mfma_f32_16x16x32_bf16 v[76:79], a[152:155], a[72:75], v[76:79]
ds_read_b64_tr_b16 a[184:185], v201 offset:0
v_mfma_f32_16x16x32_bf16 v[108:111], a[152:155], a[80:83], v[108:111]
ds_read_b64_tr_b16 a[186:187], v201 offset:4096
v_mfma_f32_16x16x32_bf16 v[108:111], a[156:159], a[84:87], v[108:111]
ds_read_b64_tr_b16 a[188:189], v201 offset:8192
v_mfma_f32_16x16x32_bf16 v[140:143], a[156:159], a[92:95], v[140:143]
ds_read_b64_tr_b16 a[190:191], v201 offset:12288
v_mfma_f32_16x16x32_bf16 v[140:143], a[152:155], a[88:91], v[140:143]
v_mfma_f32_16x16x32_bf16 v[144:147], a[160:163], a[88:91], v[144:147]
v_mfma_f32_16x16x32_bf16 v[144:147], a[164:167], a[92:95], v[144:147]
s_xor_b32 m0, s76, 138240
s_add_u32 s17, s78, L_p5loop-L_pc+0
v_mfma_f32_16x16x32_bf16 v[112:115], a[164:167], a[84:87], v[112:115]
s_xor_b32 s64, s85, 57344
buffer_load_dword a252, v16, s[88:91], s17 offen
v_mfma_f32_16x16x32_bf16 v[112:115], a[160:163], a[80:83], v[112:115]
buffer_load_dwordx4 v13, s[40:43], s64 offen lds
v_mfma_f32_16x16x32_bf16 v[80:83], a[160:163], a[72:75], v[80:83]
s_add_u32 s17, s78, L_p5loop-L_pc+4096
ds_read_b64_tr_b16 a[192:193], v202 offset:0
v_mfma_f32_16x16x32_bf16 v[80:83], a[164:167], a[76:79], v[80:83]
buffer_load_dword a252, v16, s[88:91], s17 offen
v_mfma_f32_16x16x32_bf16 v[48:51], a[164:167], a[68:71], v[48:51]
ds_read_b64_tr_b16 a[194:195], v202 offset:4096
v_mfma_f32_16x16x32_bf16 v[48:51], a[160:163], a[64:67], v[48:51]
s_waitcnt lgkmcnt(2)
s_add_u32 s17, s78, L_p5loop-L_pc+8192
ds_read_b64_tr_b16 a[196:197], v202 offset:8192
v_mfma_f32_16x16x32_bf16 v[52:55], a[168:171], a[64:67], v[52:55]
buffer_load_dword a252, v16, s[88:91], s17 offen
v_mfma_f32_16x16x32_bf16 v[52:55], a[172:175], a[68:71], v[52:55]
ds_read_b64_tr_b16 a[198:199], v202 offset:12288
v_mfma_f32_16x16x32_bf16 v[84:87], a[172:175], a[76:79], v[84:87]
ds_read_b64_tr_b16 a[200:201], v203 offset:0
v_mfma_f32_16x16x32_bf16 v[84:87], a[168:171], a[72:75], v[84:87]
ds_read_b64_tr_b16 a[202:203], v203 offset:4096
v_mfma_f32_16x16x32_bf16 v[116:119], a[168:171], a[80:83], v[116:119]
ds_read_b64_tr_b16 a[204:205], v203 offset:8192
v_mfma_f32_16x16x32_bf16 v[116:119], a[172:175], a[84:87], v[116:119]
ds_read_b64_tr_b16 a[206:207], v203 offset:12288
v_mfma_f32_16x16x32_bf16 v[148:151], a[172:175], a[92:95], v[148:151]
buffer_load_dword v19, off, s[52:55], s72 sc1
v_mfma_f32_16x16x32_bf16 v[148:151], a[168:171], a[88:91], v[148:151]
v_mfma_f32_16x16x32_bf16 v[120:123], a[176:179], a[88:91], v[120:123]
v_mfma_f32_16x16x32_bf16 v[120:123], a[180:183], a[92:95], v[120:123]
v_mfma_f32_16x16x32_bf16 v[88:91], a[180:183], a[84:87], v[88:91]
v_mfma_f32_16x16x32_bf16 v[88:91], a[176:179], a[80:83], v[88:91]
v_mfma_f32_16x16x32_bf16 v[56:59], a[176:179], a[72:75], v[56:59]
v_mfma_f32_16x16x32_bf16 v[56:59], a[180:183], a[76:79], v[56:59]
v_mfma_f32_16x16x32_bf16 v[24:27], a[180:183], a[68:71], v[24:27]
v_mfma_f32_16x16x32_bf16 v[24:27], a[176:179], a[64:67], v[24:27]
v_mfma_f32_16x16x32_bf16 v[28:31], a[184:187], a[64:67], v[28:31]
s_waitcnt vmcnt(20)
s_barrier
v_mfma_f32_16x16x32_bf16 v[28:31], a[188:191], a[68:71], v[28:31]
ds_read_b64_tr_b16 a[144:145], v188 offset:0
v_mfma_f32_16x16x32_bf16 v[60:63], a[188:191], a[76:79], v[60:63]
ds_read_b64_tr_b16 a[146:147], v188 offset:4096
v_mfma_f32_16x16x32_bf16 v[60:63], a[184:187], a[72:75], v[60:63]
s_xor_b32 m0, s76, 32768
ds_read_b64_tr_b16 a[148:149], v188 offset:8192
v_mfma_f32_16x16x32_bf16 v[92:95], a[184:187], a[80:83], v[92:95]
s_xor_b32 s64, s85, 262144
ds_read_b64_tr_b16 a[150:151], v188 offset:12288
v_mfma_f32_16x16x32_bf16 v[92:95], a[188:191], a[84:87], v[92:95]
buffer_load_dwordx4 v12, s[40:43], s64 offen lds
v_mfma_f32_16x16x32_bf16 v[124:127], a[188:191], a[92:95], v[124:127]
s_xor_b32 m0, s76, 33792
ds_read_b64_tr_b16 a[152:153], v189 offset:0
v_mfma_f32_16x16x32_bf16 v[124:127], a[184:187], a[88:91], v[124:127]
s_waitcnt lgkmcnt(5)
s_xor_b32 s64, s85, 270336
ds_read_b64_tr_b16 a[154:155], v189 offset:4096
v_mfma_f32_16x16x32_bf16 v[128:131], a[192:195], a[88:91], v[128:131]
buffer_load_dwordx4 v13, s[40:43], s64 offen lds
v_mfma_f32_16x16x32_bf16 v[128:131], a[196:199], a[92:95], v[128:131]
s_xor_b32 m0, s76, 34816
ds_read_b64_tr_b16 a[156:157], v189 offset:8192
v_mfma_f32_16x16x32_bf16 v[96:99], a[196:199], a[84:87], v[96:99]
s_xor_b32 s64, s85, 278528
ds_read_b64_tr_b16 a[158:159], v189 offset:12288
v_mfma_f32_16x16x32_bf16 v[96:99], a[192:195], a[80:83], v[96:99]
buffer_load_dwordx4 v12, s[40:43], s64 offen lds
v_mfma_f32_16x16x32_bf16 v[64:67], a[192:195], a[72:75], v[64:67]
s_xor_b32 m0, s76, 35840
ds_read_b64_tr_b16 a[160:161], v190 offset:0
v_mfma_f32_16x16x32_bf16 v[64:67], a[196:199], a[76:79], v[64:67]
s_xor_b32 s64, s85, 286720
ds_read_b64_tr_b16 a[162:163], v190 offset:4096
v_mfma_f32_16x16x32_bf16 v[32:35], a[196:199], a[68:71], v[32:35]
buffer_load_dwordx4 v13, s[40:43], s64 offen lds
v_mfma_f32_16x16x32_bf16 v[32:35], a[192:195], a[64:67], v[32:35]
s_xor_b32 m0, s76, 36864
ds_read_b64_tr_b16 a[164:165], v190 offset:8192
v_mfma_f32_16x16x32_bf16 v[36:39], a[200:203], a[64:67], v[36:39]
s_xor_b32 s64, s85, 294912
ds_read_b64_tr_b16 a[166:167], v190 offset:12288
v_mfma_f32_16x16x32_bf16 v[36:39], a[204:207], a[68:71], v[36:39]
buffer_load_dwordx4 v12, s[40:43], s64 offen lds
v_mfma_f32_16x16x32_bf16 v[68:71], a[204:207], a[76:79], v[68:71]
s_xor_b32 m0, s76, 37888
v_mfma_f32_16x16x32_bf16 v[68:71], a[200:203], a[72:75], v[68:71]
s_xor_b32 s64, s85, 303104
v_mfma_f32_16x16x32_bf16 v[100:103], a[200:203], a[80:83], v[100:103]
buffer_load_dwordx4 v13, s[40:43], s64 offen lds
v_mfma_f32_16x16x32_bf16 v[100:103], a[204:207], a[84:87], v[100:103]
v_mfma_f32_16x16x32_bf16 v[132:135], a[204:207], a[92:95], v[132:135]
v_mfma_f32_16x16x32_bf16 v[132:135], a[200:203], a[88:91], v[132:135]
s_waitcnt vmcnt(22)
s_waitcnt lgkmcnt(1)
v_mfma_f32_16x16x32_bf16 v[136:139], a[144:147], a[56:59], v[136:139]
s_waitcnt vmcnt(6)
v_readfirstlane_b32 vcc_lo, v19
s_nop 0
s_cmp_lt_u32 vcc_lo, 8
s_cbranch_scc1 L_spin_3019
L_spinbk_3020:
s_sub_u32 s84, s84, 1048576
s_add_u32 s84, s84, s69
v_mfma_f32_16x16x32_bf16 v[136:139], a[148:151], a[60:63], v[136:139]
s_xor_b32 s65, s84, 0
ds_read_b64_tr_b16 a[168:169], v191 offset:0
v_mfma_f32_16x16x32_bf16 v[104:107], a[148:151], a[52:55], v[104:107]
buffer_load_dwordx4 a[208:211], v14, s[44:47], s65 offen offset:0 sc1
v_mfma_f32_16x16x32_bf16 v[104:107], a[144:147], a[48:51], v[104:107]
ds_read_b64_tr_b16 a[170:171], v191 offset:4096
v_mfma_f32_16x16x32_bf16 v[72:75], a[144:147], a[40:43], v[72:75]
buffer_load_dwordx4 a[216:219], v14, s[44:47], s65 offen offset:1024 sc1
v_mfma_f32_16x16x32_bf16 v[72:75], a[148:151], a[44:47], v[72:75]
ds_read_b64_tr_b16 a[172:173], v191 offset:8192
v_mfma_f32_16x16x32_bf16 v[40:43], a[148:151], a[36:39], v[40:43]
buffer_load_dwordx4 a[224:227], v15, s[44:47], s65 offen offset:0 sc1
v_mfma_f32_16x16x32_bf16 v[40:43], a[144:147], a[32:35], v[40:43]
ds_read_b64_tr_b16 a[174:175], v191 offset:12288
v_mfma_f32_16x16x32_bf16 v[44:47], a[152:155], a[32:35], v[44:47]
buffer_load_dwordx4 a[232:235], v15, s[44:47], s65 offen offset:1024 sc1
v_mfma_f32_16x16x32_bf16 v[44:47], a[156:159], a[36:39], v[44:47]
s_xor_b32 s65, s84, 8192
ds_read_b64_tr_b16 a[176:177], v184 offset:0
v_mfma_f32_16x16x32_bf16 v[76:79], a[156:159], a[44:47], v[76:79]
buffer_load_dwordx4 a[212:215], v14, s[44:47], s65 offen offset:0 sc1
v_mfma_f32_16x16x32_bf16 v[76:79], a[152:155], a[40:43], v[76:79]
ds_read_b64_tr_b16 a[178:179], v184 offset:4096
v_mfma_f32_16x16x32_bf16 v[108:111], a[152:155], a[48:51], v[108:111]
buffer_load_dwordx4 a[220:223], v14, s[44:47], s65 offen offset:1024 sc1
v_mfma_f32_16x16x32_bf16 v[108:111], a[156:159], a[52:55], v[108:111]
ds_read_b64_tr_b16 a[180:181], v184 offset:8192
v_mfma_f32_16x16x32_bf16 v[140:143], a[156:159], a[60:63], v[140:143]
buffer_load_dwordx4 a[228:231], v15, s[44:47], s65 offen offset:0 sc1
v_mfma_f32_16x16x32_bf16 v[140:143], a[152:155], a[56:59], v[140:143]
ds_read_b64_tr_b16 a[182:183], v184 offset:12288
v_mfma_f32_16x16x32_bf16 v[144:147], a[160:163], a[56:59], v[144:147]
s_waitcnt lgkmcnt(4)
buffer_load_dwordx4 a[236:239], v15, s[44:47], s65 offen offset:1024 sc1
v_mfma_f32_16x16x32_bf16 v[144:147], a[164:167], a[60:63], v[144:147]
s_xor_b32 m0, s76, 38912
s_xor_b32 s64, s85, 311296
ds_read_b64_tr_b16 a[184:185], v185 offset:0
v_mfma_f32_16x16x32_bf16 v[112:115], a[164:167], a[52:55], v[112:115]
buffer_load_dwordx4 v12, s[40:43], s64 offen lds
v_mfma_f32_16x16x32_bf16 v[112:115], a[160:163], a[48:51], v[112:115]
s_xor_b32 m0, s76, 39936
s_xor_b32 s64, s85, 319488
ds_read_b64_tr_b16 a[186:187], v185 offset:4096
v_mfma_f32_16x16x32_bf16 v[80:83], a[160:163], a[40:43], v[80:83]
buffer_load_dwordx4 v13, s[40:43], s64 offen lds
v_mfma_f32_16x16x32_bf16 v[80:83], a[164:167], a[44:47], v[80:83]
s_xor_b32 s65, s84, 32768
ds_read_b64_tr_b16 a[188:189], v185 offset:8192
v_mfma_f32_16x16x32_bf16 v[48:51], a[164:167], a[36:39], v[48:51]
buffer_load_dwordx4 v[152:155], v14, s[44:47], s65 offen offset:0 sc1
v_mfma_f32_16x16x32_bf16 v[48:51], a[160:163], a[32:35], v[48:51]
ds_read_b64_tr_b16 a[190:191], v185 offset:12288
v_mfma_f32_16x16x32_bf16 v[52:55], a[168:171], a[32:35], v[52:55]
buffer_load_dwordx4 v[160:163], v14, s[44:47], s65 offen offset:1024 sc1
v_mfma_f32_16x16x32_bf16 v[52:55], a[172:175], a[36:39], v[52:55]
ds_read_b64_tr_b16 a[192:193], v186 offset:0
v_mfma_f32_16x16x32_bf16 v[84:87], a[172:175], a[44:47], v[84:87]
buffer_load_dwordx4 v[168:171], v15, s[44:47], s65 offen offset:0 sc1
v_mfma_f32_16x16x32_bf16 v[84:87], a[168:171], a[40:43], v[84:87]
ds_read_b64_tr_b16 a[194:195], v186 offset:4096
v_mfma_f32_16x16x32_bf16 v[116:119], a[168:171], a[48:51], v[116:119]
buffer_load_dwordx4 v[176:179], v15, s[44:47], s65 offen offset:1024 sc1
v_mfma_f32_16x16x32_bf16 v[116:119], a[172:175], a[52:55], v[116:119]
s_xor_b32 s65, s84, 40960
ds_read_b64_tr_b16 a[196:197], v186 offset:8192
v_mfma_f32_16x16x32_bf16 v[148:151], a[172:175], a[60:63], v[148:151]
buffer_load_dwordx4 v[156:159], v14, s[44:47], s65 offen offset:0 sc1
v_mfma_f32_16x16x32_bf16 v[148:151], a[168:171], a[56:59], v[148:151]
s_waitcnt lgkmcnt(3)
ds_read_b64_tr_b16 a[198:199], v186 offset:12288
v_mfma_f32_16x16x32_bf16 v[120:123], a[176:179], a[56:59], v[120:123]
buffer_load_dwordx4 v[164:167], v14, s[44:47], s65 offen offset:1024 sc1
v_mfma_f32_16x16x32_bf16 v[120:123], a[180:183], a[60:63], v[120:123]
ds_read_b64_tr_b16 a[200:201], v187 offset:0
v_mfma_f32_16x16x32_bf16 v[88:91], a[180:183], a[52:55], v[88:91]
buffer_load_dwordx4 v[172:175], v15, s[44:47], s65 offen offset:0 sc1
v_mfma_f32_16x16x32_bf16 v[88:91], a[176:179], a[48:51], v[88:91]
ds_read_b64_tr_b16 a[202:203], v187 offset:4096
v_mfma_f32_16x16x32_bf16 v[56:59], a[176:179], a[40:43], v[56:59]
buffer_load_dwordx4 v[180:183], v15, s[44:47], s65 offen offset:1024 sc1
v_mfma_f32_16x16x32_bf16 v[56:59], a[180:183], a[44:47], v[56:59]
ds_read_b64_tr_b16 a[204:205], v187 offset:8192
v_mfma_f32_16x16x32_bf16 v[24:27], a[180:183], a[36:39], v[24:27]
ds_read_b64_tr_b16 a[206:207], v187 offset:12288
v_mfma_f32_16x16x32_bf16 v[24:27], a[176:179], a[32:35], v[24:27]
v_mfma_f32_16x16x32_bf16 v[28:31], a[184:187], a[32:35], v[28:31]
s_barrier
v_mfma_f32_16x16x32_bf16 v[28:31], a[188:191], a[36:39], v[28:31]
ds_read_b64_tr_b16 a[144:145], v188 offset:32768
v_mfma_f32_16x16x32_bf16 v[60:63], a[188:191], a[44:47], v[60:63]
ds_read_b64_tr_b16 a[146:147], v188 offset:36864
v_mfma_f32_16x16x32_bf16 v[60:63], a[184:187], a[40:43], v[60:63]
s_xor_b32 m0, s76, 65536
ds_read_b64_tr_b16 a[148:149], v188 offset:40960
v_mfma_f32_16x16x32_bf16 v[92:95], a[184:187], a[48:51], v[92:95]
s_xor_b32 s64, s85, 524288
ds_read_b64_tr_b16 a[150:151], v188 offset:45056
v_mfma_f32_16x16x32_bf16 v[92:95], a[188:191], a[52:55], v[92:95]
buffer_load_dwordx4 v12, s[40:43], s64 offen lds
v_mfma_f32_16x16x32_bf16 v[124:127], a[188:191], a[60:63], v[124:127]
s_xor_b32 m0, s76, 66560
ds_read_b64_tr_b16 a[152:153], v189 offset:32768
v_mfma_f32_16x16x32_bf16 v[124:127], a[184:187], a[56:59], v[124:127]
s_waitcnt lgkmcnt(5)
s_xor_b32 s64, s85, 532480
ds_read_b64_tr_b16 a[154:155], v189 offset:36864
v_mfma_f32_16x16x32_bf16 v[128:131], a[192:195], a[56:59], v[128:131]
buffer_load_dwordx4 v13, s[40:43], s64 offen lds
v_mfma_f32_16x16x32_bf16 v[128:131], a[196:199], a[60:63], v[128:131]
ds_read_b64_tr_b16 a[156:157], v189 offset:40960
v_mfma_f32_16x16x32_bf16 v[96:99], a[196:199], a[52:55], v[96:99]
s_xor_b32 m0, s76, 67584
ds_read_b64_tr_b16 a[158:159], v189 offset:45056
v_mfma_f32_16x16x32_bf16 v[96:99], a[192:195], a[48:51], v[96:99]
s_xor_b32 s64, s85, 540672
ds_read_b64_tr_b16 a[160:161], v190 offset:32768
v_mfma_f32_16x16x32_bf16 v[64:67], a[192:195], a[40:43], v[64:67]
buffer_load_dwordx4 v12, s[40:43], s64 offen lds
v_mfma_f32_16x16x32_bf16 v[64:67], a[196:199], a[44:47], v[64:67]
ds_read_b64_tr_b16 a[162:163], v190 offset:36864
v_mfma_f32_16x16x32_bf16 v[32:35], a[196:199], a[36:39], v[32:35]
s_xor_b32 m0, s76, 68608
ds_read_b64_tr_b16 a[164:165], v190 offset:40960
v_mfma_f32_16x16x32_bf16 v[32:35], a[192:195], a[32:35], v[32:35]
s_xor_b32 s64, s85, 548864
ds_read_b64_tr_b16 a[166:167], v190 offset:45056
v_mfma_f32_16x16x32_bf16 v[36:39], a[200:203], a[32:35], v[36:39]
buffer_load_dwordx4 v13, s[40:43], s64 offen lds
v_mfma_f32_16x16x32_bf16 v[36:39], a[204:207], a[36:39], v[36:39]
v_mfma_f32_16x16x32_bf16 v[68:71], a[204:207], a[44:47], v[68:71]
s_xor_b32 m0, s76, 69632
v_mfma_f32_16x16x32_bf16 v[68:71], a[200:203], a[40:43], v[68:71]
s_xor_b32 s64, s85, 557056
v_mfma_f32_16x16x32_bf16 v[100:103], a[200:203], a[48:51], v[100:103]
buffer_load_dwordx4 v12, s[40:43], s64 offen lds
v_mfma_f32_16x16x32_bf16 v[100:103], a[204:207], a[52:55], v[100:103]
s_mov_b32 s70, 3
s_mov_b32 s73, 2
v_mfma_f32_16x16x32_bf16 v[132:135], a[204:207], a[60:63], v[132:135]
v_mfma_f32_16x16x32_bf16 v[132:135], a[200:203], a[56:59], v[132:135]
s_branch L_p5join
L_spin_4022:
s_mov_b32 vcc_hi, 0x80000
L_spinlp_4024:
s_sleep 1
buffer_load_dword v19, off, s[52:55], s72 offset:128 sc1
s_waitcnt vmcnt(0)
v_readfirstlane_b32 vcc_lo, v19
s_sub_u32 vcc_hi, vcc_hi, 1
s_cbranch_scc1 L_spinbk_4023
s_cmp_lt_u32 vcc_lo, s74
s_cbranch_scc1 L_spinlp_4024
s_branch L_spinbk_4023
L_codeend:
.section .rodata,"a"
.p2align 6
.amdhsa_kernel gated_mix__compressed_kv_cla__sliding_local_dilated__prompt_kernel
  .amdhsa_next_free_vgpr 512
  .amdhsa_next_free_sgpr 102
  .amdhsa_accum_offset 256
  .amdhsa_group_segment_fixed_size 0
  .amdhsa_kernarg_size 104
  .amdhsa_user_sgpr_count 2
  .amdhsa_user_sgpr_kernarg_segment_ptr 1
  .amdhsa_system_sgpr_workgroup_id_x 1
.end_amdhsa_kernel
```

```asm
; @launch grid=(256,1,1) block=(256,1,1) lds=163840
.amdgcn_target "amdgcn-amd-amdhsa--gfx950"
.text
.globl gated_mix__compressed_kv_cla__sliding_local_dilated__prompt_kernel
.p2align 8
.type gated_mix__compressed_kv_cla__sliding_local_dilated__prompt_kernel,@function
gated_mix__compressed_kv_cla__sliding_local_dilated__prompt_kernel:
s_cmp_ge_u32 s2, 256
s_cbranch_scc1 L_end
s_load_dwordx16 s[4:19], s[0:1], 0
s_load_dwordx8 s[20:27], s[0:1], 64
s_load_dwordx2 s[28:29], s[0:1], 96
s_getpc_b64 s[88:89]
L_pc:
v_lshrrev_b32 v1, 6, v0
s_lshr_b32 s67, s2, 3
v_lshl_add_u32 v24, s67, 2, v1
s_mov_b32 s90, L_codeend-L_pc
s_mov_b32 s91, 0x20000
v_and_b32 v25, 7, v0
v_lshlrev_b32 v25, 7, v25
v_lshl_add_u32 v24, v24, 10, v25
buffer_load_dword a252, v24, s[88:91], 0 offen
v_and_b32 v0, 63, v0
v_readfirstlane_b32 s30, v1
v_lshrrev_b32 v24, 3, v0
v_lshrrev_b32 v25, 4, v0
v_and_b32 v26, 7, v0
v_xor_b32 v26, v26, v25
v_lshlrev_b32 v26, 4, v26
v_lshl_add_u32 v12, v24, 10, v26
v_xor_b32 v13, 64, v12
v_bfe_u32 v26, v0, 1, 3
v_xor_b32 v26, v26, v25
v_lshlrev_b32 v26, 5, v26
v_and_b32 v24, 1, v0
v_lshl_add_u32 v26, v24, 4, v26
v_lshl_add_u32 v14, v25, 13, v26
v_xor_b32 v15, 128, v14
s_and_b32 s66, s2, 7
s_and_b32 s68, s67, 3
s_lshl2_add_u32 s31, s66, s68
s_cmp_eq_u32 s68, 0
s_cselect_b32 s90, s90, 0
s_lshr_b32 s3, s67, 2
s_lshl2_add_u32 s80, s67, s30
s_lshl_b32 s70, s3, 18
s_lshl_b32 s66, s30, 16
s_add_u32 s70, s70, s66
s_lshl_b32 s71, s30, 17
s_lshl_b32 s66, s31, 8
s_add_u32 s71, s71, s66
s_lshl_b32 s76, s30, 13
s_lshl_b32 s77, s30, 12
s_lshl_b32 s78, s30, 10
s_cmp_eq_u32 s30, 0
s_cbranch_scc1 L_pg1
s_cmp_eq_u32 s30, 1
s_cbranch_scc1 L_pg2
s_cmp_eq_u32 s30, 2
s_cbranch_scc1 L_pg3
s_branch L_pg4
L_tr9:
s_waitcnt lgkmcnt(0)
s_mov_b32 s32, s6
s_mov_b32 s33, s7
s_mov_b32 s34, 2097152
s_mov_b32 s35, 0x20000
s_mov_b32 s36, s10
s_mov_b32 s37, s11
s_mov_b32 s38, 4194304
s_mov_b32 s39, 0x20000
s_mov_b32 s40, s12
s_mov_b32 s41, s13
s_mov_b32 s42, 4194304
s_mov_b32 s43, 0x20000
s_xor_b32 m0, s76, 0
s_xor_b32 s64, s70, 0
buffer_load_dwordx4 v12, s[32:35], s64 offen lds
s_xor_b32 m0, s76, 1024
s_xor_b32 s64, s70, 8192
buffer_load_dwordx4 v13, s[32:35], s64 offen lds
s_xor_b32 m0, s76, 2048
s_xor_b32 s64, s70, 16384
buffer_load_dwordx4 v12, s[32:35], s64 offen lds
s_xor_b32 m0, s76, 3072
s_xor_b32 s64, s70, 24576
buffer_load_dwordx4 v13, s[32:35], s64 offen lds
s_xor_b32 m0, s77, 65536
s_xor_b32 s64, s71, 0
buffer_load_dwordx4 v14, s[36:39], s64 offen lds
s_xor_b32 m0, s77, 66560
s_xor_b32 s64, s71, 32768
buffer_load_dwordx4 v14, s[36:39], s64 offen lds
s_xor_b32 m0, s77, 67584
s_xor_b32 s64, s71, 65536
buffer_load_dwordx4 v15, s[36:39], s64 offen lds
s_xor_b32 m0, s77, 68608
s_xor_b32 s64, s71, 98304
buffer_load_dwordx4 v15, s[36:39], s64 offen lds
s_mov_b32 s44, s28
s_mov_b32 s45, s29
s_mov_b32 s46, 134217728
s_mov_b32 s47, 0x20000
s_mov_b32 s48, s4
s_mov_b32 s49, s5
s_mov_b32 s50, 4194304
s_mov_b32 s51, 0x20000
s_mov_b32 s52, s26
s_mov_b32 s53, s27
s_mov_b32 s54, 256
s_mov_b32 s55, 0x20000
s_mov_b32 s56, s8
s_mov_b32 s57, s9
s_mov_b32 s58, 8388608
s_mov_b32 s59, 0x20000
s_mov_b32 s60, s18
s_mov_b32 s61, s19
s_mov_b32 s62, 6291456
s_mov_b32 s63, 0x20000
v_accvgpr_write_b32 a251, 1
v_and_b32 v24, 15, v0
v_lshrrev_b32 v26, 1, v24
v_xor_b32 v26, v26, v25
v_lshlrev_b32 v26, 4, v26
v_lshl_add_u32 v26, v24, 7, v26
v_add_u32 v2, s76, v26
v_xor_b32 v3, 64, v2
v_bfe_u32 v24, v0, 2, 2
v_lshl_add_u32 v27, v25, 3, v24
v_and_b32 v1, 3, v0
v_cmp_eq_u32 vcc, 0, v1
v_lshlrev_b32 v1, 3, v1
v_lshl_add_u32 v26, v27, 8, v1
v_add_u32 v26, 65536, v26
v_and_b32 v1, 1, v25
v_lshl_add_u32 v24, v1, 2, v24
v_lshlrev_b32 v16, 4, v0
v_mov_b32 v28, 0x3f803f80
v_cndmask_b32 v28, 0, v28, vcc
v_accvgpr_write_b32 a244, v28
v_accvgpr_write_b32 a245, v28
v_accvgpr_write_b32 a246, v28
v_accvgpr_write_b32 a247, v28
v_xor_b32 v1, 0, v24
v_lshl_add_u32 v4, v1, 5, v26
v_xor_b32 v1, 1, v24
v_lshl_add_u32 v5, v1, 5, v26
v_xor_b32 v1, 2, v24
v_lshl_add_u32 v6, v1, 5, v26
v_xor_b32 v1, 3, v24
v_lshl_add_u32 v7, v1, 5, v26
v_xor_b32 v1, 4, v24
v_lshl_add_u32 v8, v1, 5, v26
v_xor_b32 v1, 5, v24
v_lshl_add_u32 v9, v1, 5, v26
v_xor_b32 v1, 6, v24
v_lshl_add_u32 v10, v1, 5, v26
v_xor_b32 v1, 7, v24
v_lshl_add_u32 v11, v1, 5, v26
s_sub_u32 s16, 15, s3
s_lshl_b32 s72, s3, 18
s_lshl_b32 s73, s16, 18
s_cmp_lt_u32 s30, 2
s_cselect_b32 s67, s3, s16
s_lshl4_add_u32 s74, s31, s67
s_and_b32 s66, s30, 1
s_lshl1_add_u32 s74, s74, s66
s_lshl_b32 s74, s74, 10
s_add_u32 s74, s74, 60817408
s_lshl_b32 s66, s30, 15
s_add_u32 s72, s72, s66
s_add_u32 s73, s73, s66
s_mul_i32 s75, s30, 98304
s_lshl_b32 s66, s31, 6
s_add_u32 s75, s75, s66
s_lshl_b32 s79, s31, 20
s_lshl_b32 s66, s3, 17
s_add_u32 s79, s79, s66
s_lshl_b32 s66, s30, 15
s_add_u32 s79, s79, s66
v_bfe_u32 v23, v0, 1, 1
v_lshrrev_b32 v1, 5, v0
v_xor_b32 v23, v23, v1
v_lshlrev_b32 v23, 5, v23
v_and_b32 v1, 1, v0
v_lshl_add_u32 v23, v1, 4, v23
v_lshrrev_b32 v1, 2, v0
v_mul_u32_u24 v1, 6144, v1
v_add_u32 v23, v1, v23
s_lshl_b32 s81, s80, 13
s_and_b32 s67, s2, 7
s_lshl_b32 s82, s67, 8
s_add_u32 s82, s82, s81
s_lshl_b32 s67, s67, 10
s_add_u32 s81, s81, s67
s_add_u32 s83, s81, 1048576
v_mul_u32_u24 v1, 1792, v25
v_add_u32 v1, v1, v16
s_lshl_b32 s68, s2, 3
s_lshl1_add_u32 s68, s30, s68
v_lshrrev_b32 v18, 5, v0
v_add_u32 v18, s68, v18
v_and_b32 v19, 31, v0
v_lshlrev_b32 v19, 4, v19
v_lshl_add_u32 v18, v18, 11, v19
v_mov_b32 v21, 0
v_min_u32 v20, 1, v0
v_lshlrev_b32 v20, 30, v20
v_accvgpr_write_b32 a240, -1
v_accvgpr_write_b32 a241, -1
v_accvgpr_write_b32 a242, -1
v_accvgpr_write_b32 a243, -1
s_lshr_b32 s69, s2, 7
s_or_b32 s69, s69, s30
s_lshl_b32 s69, s69, 21
s_add_u32 s69, s69, s2
s_lshl_b32 s69, s69, 7
s_add_u32 s69, s69, 59768832
s_cmp_eq_u32 s30, 0
s_cbranch_scc1 L_pg5
s_cmp_eq_u32 s30, 1
s_cbranch_scc1 L_pg6
s_cmp_eq_u32 s30, 2
s_cbranch_scc1 L_pg7
s_branch L_pg8
L_tr0:
s_branch L_base
.p2align 12
L_pg1:
s_branch L_tr9
L_base:
s_xor_b32 m0, s76, 4096
s_xor_b32 s64, s70, 32768
buffer_load_dwordx4 v12, s[32:35], s64 offen lds
s_xor_b32 m0, s76, 5120
s_xor_b32 s64, s70, 40960
buffer_load_dwordx4 v13, s[32:35], s64 offen lds
s_xor_b32 m0, s76, 6144
s_xor_b32 s64, s70, 49152
buffer_load_dwordx4 v12, s[32:35], s64 offen lds
s_xor_b32 m0, s76, 7168
s_xor_b32 s64, s70, 57344
buffer_load_dwordx4 v13, s[32:35], s64 offen lds
s_xor_b32 m0, s77, 81920
s_xor_b32 s64, s71, 0
buffer_load_dwordx4 v14, s[40:43], s64 offen lds
s_xor_b32 m0, s77, 82944
s_xor_b32 s64, s71, 32768
buffer_load_dwordx4 v14, s[40:43], s64 offen lds
s_xor_b32 m0, s77, 83968
s_xor_b32 s64, s71, 65536
buffer_load_dwordx4 v15, s[40:43], s64 offen lds
s_xor_b32 m0, s77, 84992
s_xor_b32 s64, s71, 98304
buffer_load_dwordx4 v15, s[40:43], s64 offen lds
s_and_b32 s66, s31, 3
s_lshl_b32 s67, s66, 11
s_add_u32 s84, s76, s67
s_lshl3_add_u32 s70, s67, s70
s_and_b32 s67, s66, 1
s_lshl_b32 s67, s67, 17
s_add_u32 s72, s72, s67
s_add_u32 s67, s73, s67
s_bitcmp1_b32 s66, 1
s_cselect_b32 s73, s72, s67
s_cselect_b32 s72, s67, s72
s_and_b32 s66, s3, 3
s_lshl_b32 s67, s66, 10
s_add_u32 s77, s77, s67
s_lshl_b32 s67, s66, 15
s_add_u32 s71, s71, s67
s_and_b32 s67, s66, 2
s_lshl_b32 s67, s67, 6
v_xor_b32 v14, s67, v14
v_xor_b32 v15, s67, v15
s_and_b32 s66, s3, 4
s_cselect_b64 s[36:37], s[12:13], s[10:11]
s_cselect_b64 s[40:41], s[10:11], s[12:13]
s_lshl_b32 s66, s66, 12
s_add_u32 s77, s77, s66
s_waitcnt vmcnt(8)
s_barrier
ds_read_b128 a[0:3], v2 offset:0
ds_read_b128 a[4:7], v3 offset:0
ds_read_b64_tr_b16 a[176:177], v4 offset:0
ds_read_b64_tr_b16 a[178:179], v4 offset:1024
ds_read_b64_tr_b16 a[180:181], v4 offset:8192
ds_read_b64_tr_b16 a[182:183], v4 offset:9216
ds_read_b128 a[8:11], v2 offset:2048
ds_read_b128 a[12:15], v3 offset:2048
ds_read_b64_tr_b16 a[184:185], v5 offset:0
ds_read_b64_tr_b16 a[186:187], v5 offset:1024
ds_read_b64_tr_b16 a[188:189], v5 offset:8192
ds_read_b64_tr_b16 a[190:191], v5 offset:9216
ds_read_b64_tr_b16 a[88:89], v6 offset:0
ds_read_b64_tr_b16 a[90:91], v6 offset:1024
ds_read_b64_tr_b16 a[92:93], v6 offset:8192
ds_read_b64_tr_b16 a[94:95], v6 offset:9216
s_waitcnt lgkmcnt(12)
v_mfma_f32_16x16x32_bf16 v[184:187], a[176:179], a[0:3], 0
s_waitcnt lgkmcnt(10)
s_xor_b32 m0, s77, 98304
ds_read_b64_tr_b16 a[96:97], v7 offset:0
v_mfma_f32_16x16x32_bf16 v[184:187], a[180:183], a[4:7], v[184:187]
s_waitcnt lgkmcnt(9)
s_xor_b32 s64, s71, 524288
ds_read_b64_tr_b16 a[98:99], v7 offset:1024
v_mfma_f32_16x16x32_bf16 v[192:195], a[180:183], a[12:15], 0
buffer_load_dwordx4 v14, s[36:39], s64 offen lds
v_mfma_f32_16x16x32_bf16 v[192:195], a[176:179], a[8:11], v[192:195]
s_waitcnt lgkmcnt(8)
ds_read_b64_tr_b16 a[100:101], v7 offset:8192
v_mfma_f32_16x16x32_bf16 v[196:199], a[184:187], a[8:11], 0
s_waitcnt lgkmcnt(7)
s_xor_b32 m0, s77, 99328
ds_read_b64_tr_b16 a[102:103], v7 offset:9216
v_mfma_f32_16x16x32_bf16 v[196:199], a[188:191], a[12:15], v[196:199]
s_xor_b32 s64, s71, 557056
ds_read_b64_tr_b16 a[104:105], v8 offset:0
v_mfma_f32_16x16x32_bf16 v[188:191], a[188:191], a[4:7], 0
buffer_load_dwordx4 v14, s[36:39], s64 offen lds
v_mfma_f32_16x16x32_bf16 v[188:191], a[184:187], a[0:3], v[188:191]
s_waitcnt lgkmcnt(7)
ds_read_b64_tr_b16 a[106:107], v8 offset:1024
v_mfma_f32_16x16x32_bf16 v[216:219], a[88:91], a[0:3], 0
s_waitcnt lgkmcnt(6)
s_xor_b32 m0, s77, 100352
ds_read_b64_tr_b16 a[108:109], v8 offset:8192
v_mfma_f32_16x16x32_bf16 v[216:219], a[92:95], a[4:7], v[216:219]
s_xor_b32 s64, s71, 589824
ds_read_b64_tr_b16 a[110:111], v8 offset:9216
v_mfma_f32_16x16x32_bf16 v[224:227], a[92:95], a[12:15], 0
buffer_load_dwordx4 v15, s[36:39], s64 offen lds
v_mfma_f32_16x16x32_bf16 v[224:227], a[88:91], a[8:11], v[224:227]
s_waitcnt lgkmcnt(6)
ds_read_b64_tr_b16 a[112:113], v9 offset:0
v_mfma_f32_16x16x32_bf16 v[228:231], a[96:99], a[8:11], 0
s_waitcnt lgkmcnt(5)
ds_read_b64_tr_b16 a[114:115], v9 offset:1024
v_mfma_f32_16x16x32_bf16 v[228:231], a[100:103], a[12:15], v[228:231]
s_xor_b32 m0, s77, 101376
ds_read_b64_tr_b16 a[116:117], v9 offset:8192
v_mfma_f32_16x16x32_bf16 v[220:223], a[100:103], a[4:7], 0
s_xor_b32 s64, s71, 622592
ds_read_b64_tr_b16 a[118:119], v9 offset:9216
v_mfma_f32_16x16x32_bf16 v[220:223], a[96:99], a[0:3], v[220:223]
s_waitcnt lgkmcnt(6)
buffer_load_dwordx4 v15, s[36:39], s64 offen lds
v_mfma_f32_16x16x32_bf16 v[152:155], a[104:107], a[0:3], 0
s_waitcnt lgkmcnt(4)
ds_read_b64_tr_b16 a[72:73], v10 offset:0
v_mfma_f32_16x16x32_bf16 v[152:155], a[108:111], a[4:7], v[152:155]
s_xor_b32 m0, s77, 114688
ds_read_b64_tr_b16 a[74:75], v10 offset:1024
v_mfma_f32_16x16x32_bf16 v[160:163], a[108:111], a[12:15], 0
s_xor_b32 s64, s71, 524288
ds_read_b64_tr_b16 a[76:77], v10 offset:8192
ds_read_b64_tr_b16 a[78:79], v10 offset:9216
v_mfma_f32_16x16x32_bf16 v[160:163], a[104:107], a[8:11], v[160:163]
s_waitcnt lgkmcnt(6)
buffer_load_dwordx4 v14, s[40:43], s64 offen lds
v_mfma_f32_16x16x32_bf16 v[164:167], a[112:115], a[8:11], 0
s_waitcnt lgkmcnt(4)
s_xor_b32 m0, s77, 115712
ds_read_b64_tr_b16 a[80:81], v11 offset:0
v_mfma_f32_16x16x32_bf16 v[164:167], a[116:119], a[12:15], v[164:167]
s_xor_b32 s64, s71, 557056
ds_read_b64_tr_b16 a[82:83], v11 offset:1024
v_mfma_f32_16x16x32_bf16 v[156:159], a[116:119], a[4:7], 0
ds_read_b64_tr_b16 a[84:85], v11 offset:8192
ds_read_b64_tr_b16 a[86:87], v11 offset:9216
s_waitcnt vmcnt(9)
v_mfma_f32_16x16x32_bf16 v[156:159], a[112:115], a[0:3], v[156:159]
s_waitcnt lgkmcnt(6)
buffer_load_dwordx4 v14, s[40:43], s64 offen lds
v_mfma_f32_16x16x32_bf16 v[24:27], a[72:75], a[0:3], 0
s_waitcnt lgkmcnt(4)
s_xor_b32 m0, s77, 116736
ds_read_b128 a[16:19], v2 offset:4096
ds_read_b128 a[20:23], v3 offset:4096
v_mfma_f32_16x16x32_bf16 v[24:27], a[76:79], a[4:7], v[24:27]
s_xor_b32 s64, s71, 589824
ds_read_b128 a[24:27], v2 offset:6144
ds_read_b128 a[28:31], v3 offset:6144
v_mfma_f32_16x16x32_bf16 v[40:43], a[76:79], a[12:15], 0
buffer_load_dwordx4 v15, s[40:43], s64 offen lds
v_mfma_f32_16x16x32_bf16 v[40:43], a[72:75], a[8:11], v[40:43]
s_waitcnt lgkmcnt(6)
v_mfma_f32_16x16x32_bf16 v[104:107], a[80:83], a[8:11], 0
s_waitcnt lgkmcnt(4)
s_xor_b32 m0, s77, 117760
v_mfma_f32_16x16x32_bf16 v[104:107], a[84:87], a[12:15], v[104:107]
s_xor_b32 s64, s71, 622592
v_mfma_f32_16x16x32_bf16 v[88:91], a[84:87], a[4:7], 0
buffer_load_dwordx4 v15, s[40:43], s64 offen lds
v_mfma_f32_16x16x32_bf16 v[88:91], a[80:83], a[0:3], v[88:91]
s_waitcnt lgkmcnt(3)
v_mfma_f32_16x16x32_bf16 v[232:235], a[88:91], a[16:19], 0
s_waitcnt lgkmcnt(2)
v_mfma_f32_16x16x32_bf16 v[232:235], a[92:95], a[20:23], v[232:235]
s_waitcnt lgkmcnt(0)
s_xor_b32 m0, s84, 32768
v_mfma_f32_16x16x32_bf16 v[240:243], a[92:95], a[28:31], 0
s_xor_b32 s64, s70, 128
v_mfma_f32_16x16x32_bf16 v[240:243], a[88:91], a[24:27], v[240:243]
buffer_load_dwordx4 v12, s[32:35], s64 offen lds
v_mfma_f32_16x16x32_bf16 v[244:247], a[96:99], a[24:27], 0
s_xor_b32 m0, s84, 33792
v_mfma_f32_16x16x32_bf16 v[244:247], a[100:103], a[28:31], v[244:247]
s_xor_b32 s64, s70, 8320
v_mfma_f32_16x16x32_bf16 v[236:239], a[100:103], a[20:23], 0
s_waitcnt vmcnt(9)
s_barrier
v_mfma_f32_16x16x32_bf16 v[236:239], a[96:99], a[16:19], v[236:239]
buffer_load_dwordx4 v13, s[32:35], s64 offen lds
v_mfma_f32_16x16x32_bf16 v[168:171], a[104:107], a[16:19], 0
ds_read_b64_tr_b16 a[88:89], v4 offset:16384
v_mfma_f32_16x16x32_bf16 v[168:171], a[108:111], a[20:23], v[168:171]
s_xor_b32 m0, s84, 34816
ds_read_b64_tr_b16 a[90:91], v4 offset:17408
v_mfma_f32_16x16x32_bf16 v[176:179], a[108:111], a[28:31], 0
s_xor_b32 s64, s70, 16512
ds_read_b64_tr_b16 a[92:93], v4 offset:24576
v_mfma_f32_16x16x32_bf16 v[176:179], a[104:107], a[24:27], v[176:179]
buffer_load_dwordx4 v12, s[32:35], s64 offen lds
v_mfma_f32_16x16x32_bf16 v[180:183], a[112:115], a[24:27], 0
ds_read_b64_tr_b16 a[94:95], v4 offset:25600
v_mfma_f32_16x16x32_bf16 v[180:183], a[116:119], a[28:31], v[180:183]
s_xor_b32 m0, s84, 35840
ds_read_b64_tr_b16 a[96:97], v5 offset:16384
v_mfma_f32_16x16x32_bf16 v[172:175], a[116:119], a[20:23], 0
s_xor_b32 s64, s70, 24704
ds_read_b64_tr_b16 a[98:99], v5 offset:17408
v_mfma_f32_16x16x32_bf16 v[172:175], a[112:115], a[16:19], v[172:175]
buffer_load_dwordx4 v13, s[32:35], s64 offen lds
v_mfma_f32_16x16x32_bf16 v[56:59], a[72:75], a[16:19], 0
ds_read_b64_tr_b16 a[100:101], v5 offset:24576
v_mfma_f32_16x16x32_bf16 v[56:59], a[76:79], a[20:23], v[56:59]
s_xor_b32 m0, s84, 36864
ds_read_b64_tr_b16 a[102:103], v5 offset:25600
v_mfma_f32_16x16x32_bf16 v[72:75], a[76:79], a[28:31], 0
s_xor_b32 s64, s70, 32896
ds_read_b64_tr_b16 a[104:105], v6 offset:16384
v_mfma_f32_16x16x32_bf16 v[72:75], a[72:75], a[24:27], v[72:75]
buffer_load_dwordx4 v12, s[32:35], s64 offen lds
v_mfma_f32_16x16x32_bf16 v[136:139], a[80:83], a[24:27], 0
ds_read_b64_tr_b16 a[106:107], v6 offset:17408
v_mfma_f32_16x16x32_bf16 v[136:139], a[84:87], a[28:31], v[136:139]
s_xor_b32 m0, s84, 37888
ds_read_b64_tr_b16 a[108:109], v6 offset:24576
v_mfma_f32_16x16x32_bf16 v[120:123], a[84:87], a[20:23], 0
s_xor_b32 s64, s70, 41088
ds_read_b64_tr_b16 a[110:111], v6 offset:25600
v_mfma_f32_16x16x32_bf16 v[120:123], a[80:83], a[16:19], v[120:123]
buffer_load_dwordx4 v13, s[32:35], s64 offen lds
v_mfma_f32_16x16x32_bf16 v[200:203], a[176:179], a[16:19], 0
ds_read_b64_tr_b16 a[112:113], v7 offset:16384
v_mfma_f32_16x16x32_bf16 v[200:203], a[180:183], a[20:23], v[200:203]
s_xor_b32 m0, s84, 38912
ds_read_b64_tr_b16 a[114:115], v7 offset:17408
v_mfma_f32_16x16x32_bf16 v[208:211], a[180:183], a[28:31], 0
s_xor_b32 s64, s70, 49280
ds_read_b64_tr_b16 a[116:117], v7 offset:24576
v_mfma_f32_16x16x32_bf16 v[208:211], a[176:179], a[24:27], v[208:211]
buffer_load_dwordx4 v12, s[32:35], s64 offen lds
v_mfma_f32_16x16x32_bf16 v[212:215], a[184:187], a[24:27], 0
ds_read_b64_tr_b16 a[118:119], v7 offset:25600
v_mfma_f32_16x16x32_bf16 v[212:215], a[188:191], a[28:31], v[212:215]
s_xor_b32 m0, s84, 39936
ds_read_b64_tr_b16 a[72:73], v8 offset:16384
v_mfma_f32_16x16x32_bf16 v[204:207], a[188:191], a[20:23], 0
s_xor_b32 s64, s70, 57472
ds_read_b64_tr_b16 a[74:75], v8 offset:17408
v_mfma_f32_16x16x32_bf16 v[204:207], a[184:187], a[16:19], v[204:207]
s_waitcnt lgkmcnt(7)
buffer_load_dwordx4 v13, s[32:35], s64 offen lds
v_mfma_f32_16x16x32_bf16 v[28:31], a[0:3], a[88:91], 0
ds_read_b64_tr_b16 a[76:77], v8 offset:24576
v_mfma_f32_16x16x32_bf16 v[28:31], a[4:7], a[92:95], v[28:31]
ds_read_b64_tr_b16 a[78:79], v8 offset:25600
v_mfma_f32_16x16x32_bf16 v[44:47], a[12:15], a[92:95], 0
ds_read_b64_tr_b16 a[80:81], v9 offset:16384
v_mfma_f32_16x16x32_bf16 v[44:47], a[8:11], a[88:91], v[44:47]
ds_read_b64_tr_b16 a[82:83], v9 offset:17408
v_mfma_f32_16x16x32_bf16 v[60:63], a[16:19], a[88:91], 0
s_xor_b32 m0, s77, 131072
ds_read_b64_tr_b16 a[84:85], v9 offset:24576
v_mfma_f32_16x16x32_bf16 v[60:63], a[20:23], a[92:95], v[60:63]
s_xor_b32 s64, s71, 1048576
ds_read_b64_tr_b16 a[86:87], v9 offset:25600
v_mfma_f32_16x16x32_bf16 v[76:79], a[28:31], a[92:95], 0
buffer_load_dwordx4 v14, s[36:39], s64 offen lds
v_mfma_f32_16x16x32_bf16 v[76:79], a[24:27], a[88:91], v[76:79]
s_xor_b32 m0, s77, 132096
ds_read_b64_tr_b16 a[88:89], v10 offset:16384
v_mfma_f32_16x16x32_bf16 v[140:143], a[24:27], a[96:99], 0
s_xor_b32 s64, s71, 1081344
ds_read_b64_tr_b16 a[90:91], v10 offset:17408
v_mfma_f32_16x16x32_bf16 v[140:143], a[28:31], a[100:103], v[140:143]
buffer_load_dwordx4 v14, s[36:39], s64 offen lds
v_mfma_f32_16x16x32_bf16 v[124:127], a[20:23], a[100:103], 0
ds_read_b64_tr_b16 a[92:93], v10 offset:24576
v_mfma_f32_16x16x32_bf16 v[124:127], a[16:19], a[96:99], v[124:127]
s_xor_b32 m0, s77, 133120
ds_read_b64_tr_b16 a[94:95], v10 offset:25600
v_mfma_f32_16x16x32_bf16 v[108:111], a[8:11], a[96:99], 0
s_xor_b32 s64, s71, 1114112
v_mfma_f32_16x16x32_bf16 v[108:111], a[12:15], a[100:103], v[108:111]
buffer_load_dwordx4 v15, s[36:39], s64 offen lds
v_mfma_f32_16x16x32_bf16 v[92:95], a[4:7], a[100:103], 0
v_mfma_f32_16x16x32_bf16 v[92:95], a[0:3], a[96:99], v[92:95]
s_xor_b32 m0, s77, 134144
ds_read_b64_tr_b16 a[96:97], v11 offset:16384
v_mfma_f32_16x16x32_bf16 v[32:35], a[0:3], a[104:107], 0
s_waitcnt lgkmcnt(5)
s_xor_b32 s64, s71, 1146880
ds_read_b64_tr_b16 a[98:99], v11 offset:17408
v_mfma_f32_16x16x32_bf16 v[32:35], a[4:7], a[108:111], v[32:35]
buffer_load_dwordx4 v15, s[36:39], s64 offen lds
v_mfma_f32_16x16x32_bf16 v[48:51], a[12:15], a[108:111], 0
ds_read_b64_tr_b16 a[100:101], v11 offset:24576
v_mfma_f32_16x16x32_bf16 v[48:51], a[8:11], a[104:107], v[48:51]
s_xor_b32 m0, s77, 147456
ds_read_b64_tr_b16 a[102:103], v11 offset:25600
v_mfma_f32_16x16x32_bf16 v[64:67], a[16:19], a[104:107], 0
s_xor_b32 s64, s71, 1048576
v_mfma_f32_16x16x32_bf16 v[64:67], a[20:23], a[108:111], v[64:67]
buffer_load_dwordx4 v14, s[40:43], s64 offen lds
v_mfma_f32_16x16x32_bf16 v[80:83], a[28:31], a[108:111], 0
s_xor_b32 m0, s77, 148480
v_mfma_f32_16x16x32_bf16 v[80:83], a[24:27], a[104:107], v[80:83]
s_xor_b32 s64, s71, 1081344
v_mfma_f32_16x16x32_bf16 v[144:147], a[24:27], a[112:115], 0
buffer_load_dwordx4 v14, s[40:43], s64 offen lds
v_mfma_f32_16x16x32_bf16 v[144:147], a[28:31], a[116:119], v[144:147]
v_mfma_f32_16x16x32_bf16 v[128:131], a[20:23], a[116:119], 0
s_xor_b32 m0, s77, 149504
v_mfma_f32_16x16x32_bf16 v[128:131], a[16:19], a[112:115], v[128:131]
s_xor_b32 s64, s71, 1114112
v_mfma_f32_16x16x32_bf16 v[112:115], a[8:11], a[112:115], 0
buffer_load_dwordx4 v15, s[40:43], s64 offen lds
v_mfma_f32_16x16x32_bf16 v[112:115], a[12:15], a[116:119], v[112:115]
v_mfma_f32_16x16x32_bf16 v[96:99], a[4:7], a[116:119], 0
s_xor_b32 m0, s77, 150528
v_mfma_f32_16x16x32_bf16 v[96:99], a[0:3], a[112:115], v[96:99]
s_xor_b32 s64, s71, 1146880
v_mfma_f32_16x16x32_bf16 v[36:39], a[0:3], a[72:75], 0
buffer_load_dwordx4 v15, s[40:43], s64 offen lds
v_mfma_f32_16x16x32_bf16 v[36:39], a[4:7], a[76:79], v[36:39]
s_xor_b32 m0, s84, 0
v_mfma_f32_16x16x32_bf16 v[52:55], a[12:15], a[76:79], 0
s_waitcnt vmcnt(16) lgkmcnt(0)
s_barrier
v_mfma_f32_16x16x32_bf16 v[52:55], a[8:11], a[72:75], v[52:55]
s_xor_b32 s64, s70, 256
ds_read_b64_tr_b16 a[104:105], v4 offset:32768
v_mfma_f32_16x16x32_bf16 v[68:71], a[16:19], a[72:75], 0
buffer_load_dwordx4 v12, s[32:35], s64 offen lds
v_mfma_f32_16x16x32_bf16 v[68:71], a[20:23], a[76:79], v[68:71]
s_xor_b32 m0, s84, 1024
global_load_dwordx4 a[144:147], v18, s[4:5] offset:0
v_mfma_f32_16x16x32_bf16 v[84:87], a[28:31], a[76:79], 0
s_xor_b32 s64, s70, 8448
ds_read_b64_tr_b16 a[106:107], v4 offset:33792
v_mfma_f32_16x16x32_bf16 v[84:87], a[24:27], a[72:75], v[84:87]
buffer_load_dwordx4 v13, s[32:35], s64 offen lds
v_mfma_f32_16x16x32_bf16 v[148:151], a[24:27], a[80:83], 0
ds_read_b64_tr_b16 a[108:109], v4 offset:40960
v_mfma_f32_16x16x32_bf16 v[148:151], a[28:31], a[84:87], v[148:151]
s_xor_b32 m0, s84, 2048
ds_read_b64_tr_b16 a[110:111], v4 offset:41984
v_mfma_f32_16x16x32_bf16 v[132:135], a[20:23], a[84:87], 0
s_waitcnt vmcnt(11)
s_xor_b32 s64, s70, 16640
ds_read_b128 a[32:35], v2 offset:32768
v_mfma_f32_16x16x32_bf16 v[132:135], a[16:19], a[80:83], v[132:135]
buffer_load_dwordx4 v12, s[32:35], s64 offen lds
v_mfma_f32_16x16x32_bf16 v[116:119], a[8:11], a[80:83], 0
ds_read_b128 a[36:39], v3 offset:32768
v_mfma_f32_16x16x32_bf16 v[116:119], a[12:15], a[84:87], v[116:119]
s_xor_b32 m0, s84, 3072
ds_read_b128 a[40:43], v2 offset:34816
v_mfma_f32_16x16x32_bf16 v[100:103], a[4:7], a[84:87], 0
s_xor_b32 s64, s70, 24832
ds_read_b128 a[44:47], v3 offset:34816
v_mfma_f32_16x16x32_bf16 v[100:103], a[0:3], a[80:83], v[100:103]
buffer_load_dwordx4 v13, s[32:35], s64 offen lds
v_mfma_f32_16x16x32_bf16 v[248:251], a[0:3], a[88:91], 0
ds_read_b128 a[48:51], v2 offset:36864
v_mfma_f32_16x16x32_bf16 v[248:251], a[4:7], a[92:95], v[248:251]
s_xor_b32 m0, s84, 4096
ds_read_b128 a[52:55], v3 offset:36864
v_mfma_f32_16x16x32_bf16 v[252:255], a[12:15], a[92:95], 0
s_xor_b32 s64, s70, 33024
ds_read_b128 a[56:59], v2 offset:38912
v_mfma_f32_16x16x32_bf16 v[252:255], a[8:11], a[88:91], v[252:255]
buffer_load_dwordx4 v12, s[32:35], s64 offen lds
v_mfma_f32_16x16x32_bf16 a[120:123], a[16:19], a[88:91], 0
s_xor_b32 m0, s84, 5120
ds_read_b128 a[60:63], v3 offset:38912
v_mfma_f32_16x16x32_bf16 a[120:123], a[20:23], a[92:95], a[120:123]
s_xor_b32 s64, s70, 41216
ds_read_b64_tr_b16 a[112:113], v5 offset:32768
v_mfma_f32_16x16x32_bf16 a[124:127], a[28:31], a[92:95], 0
buffer_load_dwordx4 v13, s[32:35], s64 offen lds
v_mfma_f32_16x16x32_bf16 a[124:127], a[24:27], a[88:91], a[124:127]
ds_read_b64_tr_b16 a[114:115], v5 offset:33792
v_mfma_f32_16x16x32_bf16 a[128:131], a[24:27], a[96:99], 0
s_xor_b32 m0, s84, 6144
ds_read_b64_tr_b16 a[116:117], v5 offset:40960
v_mfma_f32_16x16x32_bf16 a[128:131], a[28:31], a[100:103], a[128:131]
s_xor_b32 s64, s70, 49408
ds_read_b64_tr_b16 a[118:119], v5 offset:41984
v_mfma_f32_16x16x32_bf16 a[132:135], a[20:23], a[100:103], 0
buffer_load_dwordx4 v12, s[32:35], s64 offen lds
v_mfma_f32_16x16x32_bf16 a[132:135], a[16:19], a[96:99], a[132:135]
global_load_dwordx4 a[160:163], v19, s[22:23] offset:0
v_mfma_f32_16x16x32_bf16 a[136:139], a[8:11], a[96:99], 0
s_xor_b32 m0, s84, 7168
ds_read_b64_tr_b16 a[72:73], v6 offset:32768
v_mfma_f32_16x16x32_bf16 a[136:139], a[12:15], a[100:103], a[136:139]
s_xor_b32 s64, s70, 57600
ds_read_b64_tr_b16 a[74:75], v6 offset:33792
v_mfma_f32_16x16x32_bf16 a[140:143], a[4:7], a[100:103], 0
buffer_load_dwordx4 v13, s[32:35], s64 offen lds
v_mfma_f32_16x16x32_bf16 a[140:143], a[0:3], a[96:99], a[140:143]
s_waitcnt lgkmcnt(5)
ds_read_b64_tr_b16 a[76:77], v6 offset:40960
v_mfma_f32_16x16x32_bf16 v[184:187], a[104:107], a[32:35], v[184:187]
ds_read_b64_tr_b16 a[78:79], v6 offset:41984
v_mfma_f32_16x16x32_bf16 v[184:187], a[108:111], a[36:39], v[184:187]
ds_read_b64_tr_b16 a[80:81], v7 offset:32768
v_mfma_f32_16x16x32_bf16 v[192:195], a[108:111], a[44:47], v[192:195]
s_xor_b32 m0, s77, 65536
ds_read_b64_tr_b16 a[82:83], v7 offset:33792
v_mfma_f32_16x16x32_bf16 v[192:195], a[104:107], a[40:43], v[192:195]
s_xor_b32 s64, s71, 1572864
ds_read_b64_tr_b16 a[84:85], v7 offset:40960
v_mfma_f32_16x16x32_bf16 v[200:203], a[104:107], a[48:51], v[200:203]
buffer_load_dwordx4 v14, s[36:39], s64 offen lds
v_mfma_f32_16x16x32_bf16 v[200:203], a[108:111], a[52:55], v[200:203]
ds_read_b64_tr_b16 a[86:87], v7 offset:41984
v_mfma_f32_16x16x32_bf16 v[208:211], a[108:111], a[60:63], v[208:211]
s_xor_b32 m0, s77, 66560
ds_read_b64_tr_b16 a[88:89], v8 offset:32768
v_mfma_f32_16x16x32_bf16 v[208:211], a[104:107], a[56:59], v[208:211]
s_waitcnt lgkmcnt(7)
s_xor_b32 s64, s71, 1605632
ds_read_b64_tr_b16 a[90:91], v8 offset:33792
v_mfma_f32_16x16x32_bf16 v[212:215], a[112:115], a[56:59], v[212:215]
buffer_load_dwordx4 v14, s[36:39], s64 offen lds
v_mfma_f32_16x16x32_bf16 v[212:215], a[116:119], a[60:63], v[212:215]
ds_read_b64_tr_b16 a[92:93], v8 offset:40960
v_mfma_f32_16x16x32_bf16 v[204:207], a[116:119], a[52:55], v[204:207]
s_xor_b32 m0, s77, 67584
ds_read_b64_tr_b16 a[94:95], v8 offset:41984
v_mfma_f32_16x16x32_bf16 v[204:207], a[112:115], a[48:51], v[204:207]
s_xor_b32 s64, s71, 1638400
ds_read_b64_tr_b16 a[96:97], v9 offset:32768
v_mfma_f32_16x16x32_bf16 v[196:199], a[112:115], a[40:43], v[196:199]
buffer_load_dwordx4 v15, s[36:39], s64 offen lds
v_mfma_f32_16x16x32_bf16 v[196:199], a[116:119], a[44:47], v[196:199]
ds_read_b64_tr_b16 a[98:99], v9 offset:33792
v_mfma_f32_16x16x32_bf16 v[188:191], a[116:119], a[36:39], v[188:191]
s_xor_b32 m0, s77, 68608
ds_read_b64_tr_b16 a[100:101], v9 offset:40960
v_mfma_f32_16x16x32_bf16 v[188:191], a[112:115], a[32:35], v[188:191]
s_xor_b32 s64, s71, 1671168
ds_read_b64_tr_b16 a[102:103], v9 offset:41984
v_mfma_f32_16x16x32_bf16 v[216:219], a[72:75], a[32:35], v[216:219]
s_waitcnt lgkmcnt(7)
buffer_load_dwordx4 v15, s[36:39], s64 offen lds
v_mfma_f32_16x16x32_bf16 v[216:219], a[76:79], a[36:39], v[216:219]
global_load_dwordx4 a[148:151], v18, s[4:5] offset:512
v_mfma_f32_16x16x32_bf16 v[224:227], a[76:79], a[44:47], v[224:227]
ds_read_b64_tr_b16 a[104:105], v10 offset:32768
v_mfma_f32_16x16x32_bf16 v[224:227], a[72:75], a[40:43], v[224:227]
s_xor_b32 m0, s77, 81920
ds_read_b64_tr_b16 a[106:107], v10 offset:33792
v_mfma_f32_16x16x32_bf16 v[232:235], a[72:75], a[48:51], v[232:235]
s_xor_b32 s64, s71, 1572864
ds_read_b64_tr_b16 a[108:109], v10 offset:40960
v_mfma_f32_16x16x32_bf16 v[232:235], a[76:79], a[52:55], v[232:235]
buffer_load_dwordx4 v14, s[40:43], s64 offen lds
v_mfma_f32_16x16x32_bf16 v[240:243], a[76:79], a[60:63], v[240:243]
ds_read_b64_tr_b16 a[110:111], v10 offset:41984
v_mfma_f32_16x16x32_bf16 v[240:243], a[72:75], a[56:59], v[240:243]
s_xor_b32 m0, s77, 82944
ds_read_b64_tr_b16 a[112:113], v11 offset:32768
v_mfma_f32_16x16x32_bf16 v[244:247], a[80:83], a[56:59], v[244:247]
s_xor_b32 s64, s71, 1605632
ds_read_b64_tr_b16 a[114:115], v11 offset:33792
v_mfma_f32_16x16x32_bf16 v[244:247], a[84:87], a[60:63], v[244:247]
buffer_load_dwordx4 v14, s[40:43], s64 offen lds
v_mfma_f32_16x16x32_bf16 v[236:239], a[84:87], a[52:55], v[236:239]
ds_read_b64_tr_b16 a[116:117], v11 offset:40960
v_mfma_f32_16x16x32_bf16 v[236:239], a[80:83], a[48:51], v[236:239]
s_xor_b32 m0, s77, 83968
ds_read_b64_tr_b16 a[118:119], v11 offset:41984
v_mfma_f32_16x16x32_bf16 v[228:231], a[80:83], a[40:43], v[228:231]
s_xor_b32 s64, s71, 1638400
ds_read_b64_tr_b16 a[72:73], v4 offset:49152
v_mfma_f32_16x16x32_bf16 v[228:231], a[84:87], a[44:47], v[228:231]
buffer_load_dwordx4 v15, s[40:43], s64 offen lds
v_mfma_f32_16x16x32_bf16 v[220:223], a[84:87], a[36:39], v[220:223]
ds_read_b64_tr_b16 a[74:75], v4 offset:50176
v_mfma_f32_16x16x32_bf16 v[220:223], a[80:83], a[32:35], v[220:223]
s_waitcnt lgkmcnt(7)
s_xor_b32 m0, s77, 84992
ds_read_b64_tr_b16 a[76:77], v4 offset:57344
v_mfma_f32_16x16x32_bf16 v[152:155], a[88:91], a[32:35], v[152:155]
s_xor_b32 s64, s71, 1671168
ds_read_b64_tr_b16 a[78:79], v4 offset:58368
v_mfma_f32_16x16x32_bf16 v[152:155], a[92:95], a[36:39], v[152:155]
buffer_load_dwordx4 v15, s[40:43], s64 offen lds
v_mfma_f32_16x16x32_bf16 v[160:163], a[92:95], a[44:47], v[160:163]
ds_read_b64_tr_b16 a[80:81], v5 offset:49152
v_mfma_f32_16x16x32_bf16 v[160:163], a[88:91], a[40:43], v[160:163]
ds_read_b64_tr_b16 a[82:83], v5 offset:50176
v_mfma_f32_16x16x32_bf16 v[168:171], a[88:91], a[48:51], v[168:171]
ds_read_b64_tr_b16 a[84:85], v5 offset:57344
v_mfma_f32_16x16x32_bf16 v[168:171], a[92:95], a[52:55], v[168:171]
ds_read_b64_tr_b16 a[86:87], v5 offset:58368
v_mfma_f32_16x16x32_bf16 v[176:179], a[92:95], a[60:63], v[176:179]
s_xor_b32 m0, s84, 32768
global_load_dwordx4 a[164:167], v19, s[22:23] offset:512
v_mfma_f32_16x16x32_bf16 v[176:179], a[88:91], a[56:59], v[176:179]
s_xor_b32 s64, s70, 384
ds_read_b64_tr_b16 a[88:89], v6 offset:49152
v_mfma_f32_16x16x32_bf16 v[180:183], a[96:99], a[56:59], v[180:183]
buffer_load_dwordx4 v12, s[32:35], s64 offen lds
v_mfma_f32_16x16x32_bf16 v[180:183], a[100:103], a[60:63], v[180:183]
ds_read_b64_tr_b16 a[90:91], v6 offset:50176
v_mfma_f32_16x16x32_bf16 v[172:175], a[100:103], a[52:55], v[172:175]
ds_read_b64_tr_b16 a[92:93], v6 offset:57344
v_mfma_f32_16x16x32_bf16 v[172:175], a[96:99], a[48:51], v[172:175]
ds_read_b64_tr_b16 a[94:95], v6 offset:58368
v_mfma_f32_16x16x32_bf16 v[164:167], a[96:99], a[40:43], v[164:167]
v_mfma_f32_16x16x32_bf16 v[164:167], a[100:103], a[44:47], v[164:167]
s_xor_b32 m0, s84, 33792
v_mfma_f32_16x16x32_bf16 v[156:159], a[100:103], a[36:39], v[156:159]
s_xor_b32 s64, s70, 8576
v_mfma_f32_16x16x32_bf16 v[156:159], a[96:99], a[32:35], v[156:159]
buffer_load_dwordx4 v13, s[32:35], s64 offen lds
v_mfma_f32_16x16x32_bf16 v[24:27], a[104:107], a[32:35], v[24:27]
s_waitcnt lgkmcnt(4)
ds_read_b64_tr_b16 a[96:97], v7 offset:49152
v_mfma_f32_16x16x32_bf16 v[24:27], a[108:111], a[36:39], v[24:27]
ds_read_b64_tr_b16 a[98:99], v7 offset:50176
v_mfma_f32_16x16x32_bf16 v[40:43], a[108:111], a[44:47], v[40:43]
ds_read_b64_tr_b16 a[100:101], v7 offset:57344
v_mfma_f32_16x16x32_bf16 v[40:43], a[104:107], a[40:43], v[40:43]
ds_read_b64_tr_b16 a[102:103], v7 offset:58368
v_mfma_f32_16x16x32_bf16 v[56:59], a[104:107], a[48:51], v[56:59]
s_xor_b32 m0, s84, 34816
v_mfma_f32_16x16x32_bf16 v[56:59], a[108:111], a[52:55], v[56:59]
s_xor_b32 s64, s70, 16768
v_mfma_f32_16x16x32_bf16 v[72:75], a[108:111], a[60:63], v[72:75]
s_waitcnt vmcnt(12)
buffer_load_dwordx4 v12, s[32:35], s64 offen lds
v_mfma_f32_16x16x32_bf16 v[72:75], a[104:107], a[56:59], v[72:75]
ds_read_b64_tr_b16 a[104:105], v8 offset:49152
v_mfma_f32_16x16x32_bf16 v[136:139], a[112:115], a[56:59], v[136:139]
ds_read_b64_tr_b16 a[106:107], v8 offset:50176
v_mfma_f32_16x16x32_bf16 v[136:139], a[116:119], a[60:63], v[136:139]
ds_read_b64_tr_b16 a[108:109], v8 offset:57344
v_add_u32 v4, 0x8000, v4
v_mfma_f32_16x16x32_bf16 v[120:123], a[116:119], a[52:55], v[120:123]
ds_read_b64_tr_b16 a[110:111], v8 offset:58368
v_mfma_f32_16x16x32_bf16 v[120:123], a[112:115], a[48:51], v[120:123]
s_xor_b32 m0, s84, 35840
ds_read_b128 a[0:3], v2 offset:0
v_mfma_f32_16x16x32_bf16 v[104:107], a[112:115], a[40:43], v[104:107]
s_xor_b32 s64, s70, 24960
global_load_dwordx4 a[152:155], v18, s[4:5] offset:1024
v_mfma_f32_16x16x32_bf16 v[104:107], a[116:119], a[44:47], v[104:107]
s_branch L_po2
L_pg2:
s_branch L_tr9
L_po2:
buffer_load_dwordx4 v13, s[32:35], s64 offen lds
v_mfma_f32_16x16x32_bf16 v[88:91], a[116:119], a[36:39], v[88:91]
ds_read_b128 a[4:7], v3 offset:0
v_mfma_f32_16x16x32_bf16 v[88:91], a[112:115], a[32:35], v[88:91]
ds_read_b128 a[8:11], v2 offset:2048
v_mfma_f32_16x16x32_bf16 v[28:31], a[32:35], a[72:75], v[28:31]
ds_read_b128 a[12:15], v3 offset:2048
v_mfma_f32_16x16x32_bf16 v[28:31], a[36:39], a[76:79], v[28:31]
ds_read_b128 a[16:19], v2 offset:4096
v_add_u32 v5, 0x8000, v5
v_mfma_f32_16x16x32_bf16 v[44:47], a[44:47], a[76:79], v[44:47]
s_xor_b32 m0, s84, 36864
ds_read_b128 a[20:23], v3 offset:4096
v_mfma_f32_16x16x32_bf16 v[44:47], a[40:43], a[72:75], v[44:47]
s_xor_b32 s64, s70, 33152
ds_read_b128 a[24:27], v2 offset:6144
v_mfma_f32_16x16x32_bf16 v[60:63], a[48:51], a[72:75], v[60:63]
buffer_load_dwordx4 v12, s[32:35], s64 offen lds
v_mfma_f32_16x16x32_bf16 v[60:63], a[52:55], a[76:79], v[60:63]
ds_read_b128 a[28:31], v3 offset:6144
v_mfma_f32_16x16x32_bf16 v[76:79], a[60:63], a[76:79], v[76:79]
ds_read_b64_tr_b16 a[112:113], v9 offset:49152
v_mfma_f32_16x16x32_bf16 v[76:79], a[56:59], a[72:75], v[76:79]
ds_read_b64_tr_b16 a[114:115], v9 offset:50176
v_mfma_f32_16x16x32_bf16 v[140:143], a[56:59], a[80:83], v[140:143]
ds_read_b64_tr_b16 a[116:117], v9 offset:57344
v_mfma_f32_16x16x32_bf16 v[140:143], a[60:63], a[84:87], v[140:143]
s_xor_b32 m0, s84, 37888
ds_read_b64_tr_b16 a[118:119], v9 offset:58368
v_add_u32 v6, 0x8000, v6
v_mfma_f32_16x16x32_bf16 v[124:127], a[52:55], a[84:87], v[124:127]
s_xor_b32 s64, s70, 41344
ds_read_b64_tr_b16 a[72:73], v10 offset:49152
v_mfma_f32_16x16x32_bf16 v[124:127], a[48:51], a[80:83], v[124:127]
buffer_load_dwordx4 v13, s[32:35], s64 offen lds
v_mfma_f32_16x16x32_bf16 v[108:111], a[40:43], a[80:83], v[108:111]
ds_read_b64_tr_b16 a[74:75], v10 offset:50176
v_mfma_f32_16x16x32_bf16 v[108:111], a[44:47], a[84:87], v[108:111]
ds_read_b64_tr_b16 a[76:77], v10 offset:57344
v_mfma_f32_16x16x32_bf16 v[92:95], a[36:39], a[84:87], v[92:95]
ds_read_b64_tr_b16 a[78:79], v10 offset:58368
v_mfma_f32_16x16x32_bf16 v[92:95], a[32:35], a[80:83], v[92:95]
s_waitcnt lgkmcnt(8)
ds_read_b64_tr_b16 a[80:81], v11 offset:49152
v_mfma_f32_16x16x32_bf16 v[32:35], a[32:35], a[88:91], v[32:35]
s_xor_b32 m0, s84, 38912
ds_read_b64_tr_b16 a[82:83], v11 offset:50176
v_mfma_f32_16x16x32_bf16 v[32:35], a[36:39], a[92:95], v[32:35]
s_xor_b32 s64, s70, 49536
ds_read_b64_tr_b16 a[84:85], v11 offset:57344
v_add_u32 v7, 0x8000, v7
v_mfma_f32_16x16x32_bf16 v[48:51], a[44:47], a[92:95], v[48:51]
buffer_load_dwordx4 v12, s[32:35], s64 offen lds
v_mfma_f32_16x16x32_bf16 v[48:51], a[40:43], a[88:91], v[48:51]
global_load_dwordx4 a[168:171], v19, s[22:23] offset:1024
v_mfma_f32_16x16x32_bf16 v[64:67], a[48:51], a[88:91], v[64:67]
ds_read_b64_tr_b16 a[86:87], v11 offset:58368
v_mfma_f32_16x16x32_bf16 v[64:67], a[52:55], a[92:95], v[64:67]
v_mfma_f32_16x16x32_bf16 v[80:83], a[60:63], a[92:95], v[80:83]
v_mfma_f32_16x16x32_bf16 v[80:83], a[56:59], a[88:91], v[80:83]
s_xor_b32 m0, s84, 39936
v_mfma_f32_16x16x32_bf16 v[144:147], a[56:59], a[96:99], v[144:147]
s_xor_b32 s64, s70, 57728
v_mfma_f32_16x16x32_bf16 v[144:147], a[60:63], a[100:103], v[144:147]
buffer_load_dwordx4 v13, s[32:35], s64 offen lds
v_mfma_f32_16x16x32_bf16 v[128:131], a[52:55], a[100:103], v[128:131]
v_add_u32 v8, 0x8000, v8
v_mfma_f32_16x16x32_bf16 v[128:131], a[48:51], a[96:99], v[128:131]
v_mfma_f32_16x16x32_bf16 v[112:115], a[40:43], a[96:99], v[112:115]
v_mfma_f32_16x16x32_bf16 v[112:115], a[44:47], a[100:103], v[112:115]
v_mfma_f32_16x16x32_bf16 v[96:99], a[36:39], a[100:103], v[96:99]
v_add_u32 v9, 0x8000, v9
v_add_u32 v10, 0x8000, v10
v_mfma_f32_16x16x32_bf16 v[96:99], a[32:35], a[96:99], v[96:99]
v_add_u32 v11, 0x8000, v11
v_mfma_f32_16x16x32_bf16 v[36:39], a[32:35], a[104:107], v[36:39]
v_mfma_f32_16x16x32_bf16 v[36:39], a[36:39], a[108:111], v[36:39]
v_mfma_f32_16x16x32_bf16 v[52:55], a[44:47], a[108:111], v[52:55]
s_waitcnt lgkmcnt(0)
s_barrier
v_mfma_f32_16x16x32_bf16 v[52:55], a[40:43], a[104:107], v[52:55]
s_xor_b32 m0, s77, 98304
ds_read_b64_tr_b16 a[88:89], v4 offset:32768
v_mfma_f32_16x16x32_bf16 v[68:71], a[48:51], a[104:107], v[68:71]
s_xor_b32 s64, s71, 2097152
ds_read_b64_tr_b16 a[90:91], v4 offset:33792
v_mfma_f32_16x16x32_bf16 v[68:71], a[52:55], a[108:111], v[68:71]
buffer_load_dwordx4 v14, s[36:39], s64 offen lds
v_mfma_f32_16x16x32_bf16 v[84:87], a[60:63], a[108:111], v[84:87]
ds_read_b64_tr_b16 a[92:93], v4 offset:40960
v_mfma_f32_16x16x32_bf16 v[84:87], a[56:59], a[104:107], v[84:87]
ds_read_b64_tr_b16 a[94:95], v4 offset:41984
v_mfma_f32_16x16x32_bf16 v[148:151], a[56:59], a[112:115], v[148:151]
global_load_dwordx4 a[156:159], v18, s[4:5] offset:1536
v_mfma_f32_16x16x32_bf16 v[148:151], a[60:63], a[116:119], v[148:151]
ds_read_b64_tr_b16 a[96:97], v5 offset:32768
v_mfma_f32_16x16x32_bf16 v[132:135], a[52:55], a[116:119], v[132:135]
ds_read_b64_tr_b16 a[98:99], v5 offset:33792
v_mfma_f32_16x16x32_bf16 v[132:135], a[48:51], a[112:115], v[132:135]
s_xor_b32 m0, s77, 99328
ds_read_b64_tr_b16 a[100:101], v5 offset:40960
v_mfma_f32_16x16x32_bf16 v[116:119], a[40:43], a[112:115], v[116:119]
s_xor_b32 s64, s71, 2129920
ds_read_b64_tr_b16 a[102:103], v5 offset:41984
v_mfma_f32_16x16x32_bf16 v[116:119], a[44:47], a[116:119], v[116:119]
buffer_load_dwordx4 v14, s[36:39], s64 offen lds
v_mfma_f32_16x16x32_bf16 v[100:103], a[36:39], a[116:119], v[100:103]
ds_read_b64_tr_b16 a[104:105], v6 offset:32768
v_mfma_f32_16x16x32_bf16 v[100:103], a[32:35], a[112:115], v[100:103]
ds_read_b64_tr_b16 a[106:107], v6 offset:33792
v_mfma_f32_16x16x32_bf16 v[248:251], a[32:35], a[72:75], v[248:251]
ds_read_b64_tr_b16 a[108:109], v6 offset:40960
v_mfma_f32_16x16x32_bf16 v[248:251], a[36:39], a[76:79], v[248:251]
ds_read_b64_tr_b16 a[110:111], v6 offset:41984
v_mfma_f32_16x16x32_bf16 v[252:255], a[44:47], a[76:79], v[252:255]
ds_read_b64_tr_b16 a[112:113], v7 offset:32768
v_mfma_f32_16x16x32_bf16 v[252:255], a[40:43], a[72:75], v[252:255]
s_xor_b32 m0, s77, 100352
ds_read_b64_tr_b16 a[114:115], v7 offset:33792
v_mfma_f32_16x16x32_bf16 a[120:123], a[48:51], a[72:75], a[120:123]
s_xor_b32 s64, s71, 2162688
ds_read_b64_tr_b16 a[116:117], v7 offset:40960
v_mfma_f32_16x16x32_bf16 a[120:123], a[52:55], a[76:79], a[120:123]
buffer_load_dwordx4 v15, s[36:39], s64 offen lds
v_mfma_f32_16x16x32_bf16 a[124:127], a[60:63], a[76:79], a[124:127]
ds_read_b64_tr_b16 a[118:119], v7 offset:41984
v_mfma_f32_16x16x32_bf16 a[124:127], a[56:59], a[72:75], a[124:127]
ds_read_b64_tr_b16 a[72:73], v8 offset:32768
v_mfma_f32_16x16x32_bf16 a[128:131], a[56:59], a[80:83], a[128:131]
ds_read_b64_tr_b16 a[74:75], v8 offset:33792
v_mfma_f32_16x16x32_bf16 a[128:131], a[60:63], a[84:87], a[128:131]
ds_read_b64_tr_b16 a[76:77], v8 offset:40960
v_mfma_f32_16x16x32_bf16 a[132:135], a[52:55], a[84:87], a[132:135]
ds_read_b64_tr_b16 a[78:79], v8 offset:41984
v_mfma_f32_16x16x32_bf16 a[132:135], a[48:51], a[80:83], a[132:135]
s_xor_b32 m0, s77, 101376
v_mfma_f32_16x16x32_bf16 a[136:139], a[40:43], a[80:83], a[136:139]
s_xor_b32 s64, s71, 2195456
v_mfma_f32_16x16x32_bf16 a[136:139], a[44:47], a[84:87], a[136:139]
buffer_load_dwordx4 v15, s[36:39], s64 offen lds
v_mfma_f32_16x16x32_bf16 a[140:143], a[36:39], a[84:87], a[140:143]
global_load_dwordx4 a[172:175], v19, s[22:23] offset:1536
v_mfma_f32_16x16x32_bf16 a[140:143], a[32:35], a[80:83], a[140:143]
s_waitcnt lgkmcnt(5)
ds_read_b64_tr_b16 a[80:81], v9 offset:32768
v_mfma_f32_16x16x32_bf16 v[184:187], a[88:91], a[0:3], v[184:187]
ds_read_b64_tr_b16 a[82:83], v9 offset:33792
v_mfma_f32_16x16x32_bf16 v[184:187], a[92:95], a[4:7], v[184:187]
ds_read_b64_tr_b16 a[84:85], v9 offset:40960
v_mfma_f32_16x16x32_bf16 v[192:195], a[92:95], a[12:15], v[192:195]
ds_read_b64_tr_b16 a[86:87], v9 offset:41984
v_mfma_f32_16x16x32_bf16 v[192:195], a[88:91], a[8:11], v[192:195]
s_xor_b32 m0, s77, 114688
v_mfma_f32_16x16x32_bf16 v[200:203], a[88:91], a[16:19], v[200:203]
s_xor_b32 s64, s71, 2097152
v_mfma_f32_16x16x32_bf16 v[200:203], a[92:95], a[20:23], v[200:203]
buffer_load_dwordx4 v14, s[40:43], s64 offen lds
v_mfma_f32_16x16x32_bf16 v[208:211], a[92:95], a[28:31], v[208:211]
v_mfma_f32_16x16x32_bf16 v[208:211], a[88:91], a[24:27], v[208:211]
ds_read_b64_tr_b16 a[88:89], v10 offset:32768
v_mfma_f32_16x16x32_bf16 v[212:215], a[96:99], a[24:27], v[212:215]
ds_read_b64_tr_b16 a[90:91], v10 offset:33792
v_mfma_f32_16x16x32_bf16 v[212:215], a[100:103], a[28:31], v[212:215]
ds_read_b64_tr_b16 a[92:93], v10 offset:40960
v_mfma_f32_16x16x32_bf16 v[204:207], a[100:103], a[20:23], v[204:207]
ds_read_b64_tr_b16 a[94:95], v10 offset:41984
v_mfma_f32_16x16x32_bf16 v[204:207], a[96:99], a[16:19], v[204:207]
s_xor_b32 m0, s77, 115712
v_mfma_f32_16x16x32_bf16 v[196:199], a[96:99], a[8:11], v[196:199]
s_xor_b32 s64, s71, 2129920
v_mfma_f32_16x16x32_bf16 v[196:199], a[100:103], a[12:15], v[196:199]
buffer_load_dwordx4 v14, s[40:43], s64 offen lds
v_mfma_f32_16x16x32_bf16 v[188:191], a[100:103], a[4:7], v[188:191]
v_mfma_f32_16x16x32_bf16 v[188:191], a[96:99], a[0:3], v[188:191]
ds_read_b64_tr_b16 a[96:97], v11 offset:32768
v_mfma_f32_16x16x32_bf16 v[216:219], a[104:107], a[0:3], v[216:219]
ds_read_b64_tr_b16 a[98:99], v11 offset:33792
v_mfma_f32_16x16x32_bf16 v[216:219], a[108:111], a[4:7], v[216:219]
ds_read_b64_tr_b16 a[100:101], v11 offset:40960
v_mfma_f32_16x16x32_bf16 v[224:227], a[108:111], a[12:15], v[224:227]
ds_read_b64_tr_b16 a[102:103], v11 offset:41984
v_mfma_f32_16x16x32_bf16 v[224:227], a[104:107], a[8:11], v[224:227]
s_xor_b32 m0, s77, 116736
v_mfma_f32_16x16x32_bf16 v[232:235], a[104:107], a[16:19], v[232:235]
s_xor_b32 s64, s71, 2162688
buffer_store_dword v21, v20, s[44:47], s69 offen sc1
v_mfma_f32_16x16x32_bf16 v[232:235], a[108:111], a[20:23], v[232:235]
buffer_load_dwordx4 v15, s[40:43], s64 offen lds
v_mfma_f32_16x16x32_bf16 v[240:243], a[108:111], a[28:31], v[240:243]
v_mfma_f32_16x16x32_bf16 v[240:243], a[104:107], a[24:27], v[240:243]
ds_read_b64_tr_b16 a[104:105], v4 offset:49152
v_mfma_f32_16x16x32_bf16 v[244:247], a[112:115], a[24:27], v[244:247]
s_waitcnt lgkmcnt(5)
buffer_load_dword a252, v16, s[56:59], s81 offen
v_mfma_f32_16x16x32_bf16 v[244:247], a[116:119], a[28:31], v[244:247]
ds_read_b64_tr_b16 a[106:107], v4 offset:50176
v_mfma_f32_16x16x32_bf16 v[236:239], a[116:119], a[20:23], v[236:239]
ds_read_b64_tr_b16 a[108:109], v4 offset:57344
v_mfma_f32_16x16x32_bf16 v[236:239], a[112:115], a[16:19], v[236:239]
s_xor_b32 m0, s77, 117760
ds_read_b64_tr_b16 a[110:111], v4 offset:58368
v_mfma_f32_16x16x32_bf16 v[228:231], a[112:115], a[8:11], v[228:231]
s_xor_b32 s64, s71, 2195456
v_mfma_f32_16x16x32_bf16 v[228:231], a[116:119], a[12:15], v[228:231]
buffer_load_dwordx4 v15, s[40:43], s64 offen lds
v_mfma_f32_16x16x32_bf16 v[220:223], a[116:119], a[4:7], v[220:223]
v_mfma_f32_16x16x32_bf16 v[220:223], a[112:115], a[0:3], v[220:223]
ds_read_b64_tr_b16 a[112:113], v5 offset:49152
v_mfma_f32_16x16x32_bf16 v[152:155], a[72:75], a[0:3], v[152:155]
ds_read_b64_tr_b16 a[114:115], v5 offset:50176
v_mfma_f32_16x16x32_bf16 v[152:155], a[76:79], a[4:7], v[152:155]
ds_read_b64_tr_b16 a[116:117], v5 offset:57344
v_mfma_f32_16x16x32_bf16 v[160:163], a[76:79], a[12:15], v[160:163]
ds_read_b64_tr_b16 a[118:119], v5 offset:58368
v_mfma_f32_16x16x32_bf16 v[160:163], a[72:75], a[8:11], v[160:163]
v_mfma_f32_16x16x32_bf16 v[168:171], a[72:75], a[16:19], v[168:171]
v_mfma_f32_16x16x32_bf16 v[168:171], a[76:79], a[20:23], v[168:171]
v_mfma_f32_16x16x32_bf16 v[176:179], a[76:79], a[28:31], v[176:179]
s_xor_b32 m0, s84, 0
v_mfma_f32_16x16x32_bf16 v[176:179], a[72:75], a[24:27], v[176:179]
s_xor_b32 s64, s70, 512
ds_read_b64_tr_b16 a[72:73], v6 offset:49152
v_mfma_f32_16x16x32_bf16 v[180:183], a[80:83], a[24:27], v[180:183]
buffer_load_dwordx4 v12, s[32:35], s64 offen lds
v_mfma_f32_16x16x32_bf16 v[180:183], a[84:87], a[28:31], v[180:183]
ds_read_b64_tr_b16 a[74:75], v6 offset:50176
v_mfma_f32_16x16x32_bf16 v[172:175], a[84:87], a[20:23], v[172:175]
ds_read_b64_tr_b16 a[76:77], v6 offset:57344
v_mfma_f32_16x16x32_bf16 v[172:175], a[80:83], a[16:19], v[172:175]
ds_read_b64_tr_b16 a[78:79], v6 offset:58368
v_mfma_f32_16x16x32_bf16 v[164:167], a[80:83], a[8:11], v[164:167]
v_mfma_f32_16x16x32_bf16 v[164:167], a[84:87], a[12:15], v[164:167]
s_xor_b32 m0, s84, 1024
v_mfma_f32_16x16x32_bf16 v[156:159], a[84:87], a[4:7], v[156:159]
s_xor_b32 s64, s70, 8704
v_mfma_f32_16x16x32_bf16 v[156:159], a[80:83], a[0:3], v[156:159]
buffer_load_dwordx4 v13, s[32:35], s64 offen lds
v_mfma_f32_16x16x32_bf16 v[24:27], a[88:91], a[0:3], v[24:27]
ds_read_b64_tr_b16 a[80:81], v7 offset:49152
v_mfma_f32_16x16x32_bf16 v[24:27], a[92:95], a[4:7], v[24:27]
ds_read_b64_tr_b16 a[82:83], v7 offset:50176
v_mfma_f32_16x16x32_bf16 v[40:43], a[92:95], a[12:15], v[40:43]
ds_read_b64_tr_b16 a[84:85], v7 offset:57344
v_mfma_f32_16x16x32_bf16 v[40:43], a[88:91], a[8:11], v[40:43]
ds_read_b64_tr_b16 a[86:87], v7 offset:58368
v_mfma_f32_16x16x32_bf16 v[56:59], a[88:91], a[16:19], v[56:59]
s_xor_b32 m0, s84, 2048
v_mfma_f32_16x16x32_bf16 v[56:59], a[92:95], a[20:23], v[56:59]
s_xor_b32 s64, s70, 16896
v_mfma_f32_16x16x32_bf16 v[72:75], a[92:95], a[28:31], v[72:75]
s_waitcnt vmcnt(14)
buffer_load_dwordx4 v12, s[32:35], s64 offen lds
v_mfma_f32_16x16x32_bf16 v[72:75], a[88:91], a[24:27], v[72:75]
s_waitcnt lgkmcnt(4)
ds_read_b64_tr_b16 a[88:89], v8 offset:49152
v_mfma_f32_16x16x32_bf16 v[136:139], a[96:99], a[24:27], v[136:139]
buffer_load_dword a252, v1, s[60:63], s82 offen
v_mfma_f32_16x16x32_bf16 v[136:139], a[100:103], a[28:31], v[136:139]
ds_read_b64_tr_b16 a[90:91], v8 offset:50176
v_subrev_u32 v4, 0x8000, v4
v_mfma_f32_16x16x32_bf16 v[120:123], a[100:103], a[20:23], v[120:123]
ds_read_b64_tr_b16 a[92:93], v8 offset:57344
v_mfma_f32_16x16x32_bf16 v[120:123], a[96:99], a[16:19], v[120:123]
s_xor_b32 m0, s84, 3072
ds_read_b64_tr_b16 a[94:95], v8 offset:58368
v_mfma_f32_16x16x32_bf16 v[104:107], a[96:99], a[8:11], v[104:107]
s_xor_b32 s64, s70, 25088
ds_read_b128 a[32:35], v2 offset:32768
v_mfma_f32_16x16x32_bf16 v[104:107], a[100:103], a[12:15], v[104:107]
buffer_load_dwordx4 v13, s[32:35], s64 offen lds
v_mfma_f32_16x16x32_bf16 v[88:91], a[100:103], a[4:7], v[88:91]
ds_read_b128 a[36:39], v3 offset:32768
v_mfma_f32_16x16x32_bf16 v[88:91], a[96:99], a[0:3], v[88:91]
ds_read_b128 a[40:43], v2 offset:34816
v_mfma_f32_16x16x32_bf16 v[28:31], a[0:3], a[104:107], v[28:31]
ds_read_b128 a[44:47], v3 offset:34816
v_mfma_f32_16x16x32_bf16 v[28:31], a[4:7], a[108:111], v[28:31]
ds_read_b128 a[48:51], v2 offset:36864
v_subrev_u32 v5, 0x8000, v5
v_mfma_f32_16x16x32_bf16 v[44:47], a[12:15], a[108:111], v[44:47]
s_xor_b32 m0, s84, 4096
ds_read_b128 a[52:55], v3 offset:36864
v_mfma_f32_16x16x32_bf16 v[44:47], a[8:11], a[104:107], v[44:47]
s_xor_b32 s64, s70, 33280
ds_read_b128 a[56:59], v2 offset:38912
v_mfma_f32_16x16x32_bf16 v[60:63], a[16:19], a[104:107], v[60:63]
buffer_load_dwordx4 v12, s[32:35], s64 offen lds
v_mfma_f32_16x16x32_bf16 v[60:63], a[20:23], a[108:111], v[60:63]
ds_read_b128 a[60:63], v3 offset:38912
v_mfma_f32_16x16x32_bf16 v[76:79], a[28:31], a[108:111], v[76:79]
ds_read_b64_tr_b16 a[96:97], v9 offset:49152
v_mfma_f32_16x16x32_bf16 v[76:79], a[24:27], a[104:107], v[76:79]
ds_read_b64_tr_b16 a[98:99], v9 offset:50176
v_mfma_f32_16x16x32_bf16 v[140:143], a[24:27], a[112:115], v[140:143]
ds_read_b64_tr_b16 a[100:101], v9 offset:57344
v_mfma_f32_16x16x32_bf16 v[140:143], a[28:31], a[116:119], v[140:143]
s_xor_b32 m0, s84, 5120
ds_read_b64_tr_b16 a[102:103], v9 offset:58368
v_subrev_u32 v6, 0x8000, v6
v_mfma_f32_16x16x32_bf16 v[124:127], a[20:23], a[116:119], v[124:127]
s_xor_b32 s64, s70, 41472
ds_read_b64_tr_b16 a[104:105], v10 offset:49152
v_mfma_f32_16x16x32_bf16 v[124:127], a[16:19], a[112:115], v[124:127]
buffer_load_dwordx4 v13, s[32:35], s64 offen lds
v_mfma_f32_16x16x32_bf16 v[108:111], a[8:11], a[112:115], v[108:111]
ds_read_b64_tr_b16 a[106:107], v10 offset:50176
v_mfma_f32_16x16x32_bf16 v[108:111], a[12:15], a[116:119], v[108:111]
ds_read_b64_tr_b16 a[108:109], v10 offset:57344
v_mfma_f32_16x16x32_bf16 v[92:95], a[4:7], a[116:119], v[92:95]
ds_read_b64_tr_b16 a[110:111], v10 offset:58368
v_mfma_f32_16x16x32_bf16 v[92:95], a[0:3], a[112:115], v[92:95]
ds_read_b64_tr_b16 a[112:113], v11 offset:49152
v_mfma_f32_16x16x32_bf16 v[32:35], a[0:3], a[72:75], v[32:35]
s_xor_b32 m0, s84, 6144
ds_read_b64_tr_b16 a[114:115], v11 offset:50176
v_mfma_f32_16x16x32_bf16 v[32:35], a[4:7], a[76:79], v[32:35]
s_xor_b32 s64, s70, 49664
ds_read_b64_tr_b16 a[116:117], v11 offset:57344
v_subrev_u32 v7, 0x8000, v7
v_mfma_f32_16x16x32_bf16 v[48:51], a[12:15], a[76:79], v[48:51]
buffer_load_dwordx4 v12, s[32:35], s64 offen lds
v_mfma_f32_16x16x32_bf16 v[48:51], a[8:11], a[72:75], v[48:51]
ds_read_b64_tr_b16 a[118:119], v11 offset:58368
v_mfma_f32_16x16x32_bf16 v[64:67], a[16:19], a[72:75], v[64:67]
v_mfma_f32_16x16x32_bf16 v[64:67], a[20:23], a[76:79], v[64:67]
v_mfma_f32_16x16x32_bf16 v[80:83], a[28:31], a[76:79], v[80:83]
v_mfma_f32_16x16x32_bf16 v[80:83], a[24:27], a[72:75], v[80:83]
s_waitcnt lgkmcnt(5)
s_xor_b32 m0, s84, 7168
s_add_u32 s81, s81, 1048576
v_mfma_f32_16x16x32_bf16 v[144:147], a[24:27], a[80:83], v[144:147]
s_xor_b32 s64, s70, 57856
buffer_load_dword a252, v16, s[56:59], s81 offen
v_mfma_f32_16x16x32_bf16 v[144:147], a[28:31], a[84:87], v[144:147]
buffer_load_dwordx4 v13, s[32:35], s64 offen lds
v_mfma_f32_16x16x32_bf16 v[128:131], a[20:23], a[84:87], v[128:131]
v_subrev_u32 v8, 0x8000, v8
v_mfma_f32_16x16x32_bf16 v[128:131], a[16:19], a[80:83], v[128:131]
v_mfma_f32_16x16x32_bf16 v[112:115], a[8:11], a[80:83], v[112:115]
v_mfma_f32_16x16x32_bf16 v[112:115], a[12:15], a[84:87], v[112:115]
v_mfma_f32_16x16x32_bf16 v[96:99], a[4:7], a[84:87], v[96:99]
v_subrev_u32 v9, 0x8000, v9
v_subrev_u32 v10, 0x8000, v10
v_mfma_f32_16x16x32_bf16 v[96:99], a[0:3], a[80:83], v[96:99]
v_subrev_u32 v11, 0x8000, v11
v_mfma_f32_16x16x32_bf16 v[36:39], a[0:3], a[88:91], v[36:39]
v_mfma_f32_16x16x32_bf16 v[36:39], a[4:7], a[92:95], v[36:39]
v_mfma_f32_16x16x32_bf16 v[52:55], a[12:15], a[92:95], v[52:55]
s_waitcnt lgkmcnt(0)
s_barrier
v_mfma_f32_16x16x32_bf16 v[52:55], a[8:11], a[88:91], v[52:55]
s_xor_b32 m0, s77, 131072
ds_read_b64_tr_b16 a[72:73], v4 offset:0
v_mfma_f32_16x16x32_bf16 v[68:71], a[16:19], a[88:91], v[68:71]
s_xor_b32 s64, s71, 2621440
ds_read_b64_tr_b16 a[74:75], v4 offset:1024
v_mfma_f32_16x16x32_bf16 v[68:71], a[20:23], a[92:95], v[68:71]
buffer_load_dwordx4 v14, s[36:39], s64 offen lds
v_mfma_f32_16x16x32_bf16 v[84:87], a[28:31], a[92:95], v[84:87]
ds_read_b64_tr_b16 a[76:77], v4 offset:8192
v_mfma_f32_16x16x32_bf16 v[84:87], a[24:27], a[88:91], v[84:87]
ds_read_b64_tr_b16 a[78:79], v4 offset:9216
v_mfma_f32_16x16x32_bf16 v[148:151], a[24:27], a[96:99], v[148:151]
ds_read_b64_tr_b16 a[80:81], v5 offset:0
v_mfma_f32_16x16x32_bf16 v[148:151], a[28:31], a[100:103], v[148:151]
ds_read_b64_tr_b16 a[82:83], v5 offset:1024
v_mfma_f32_16x16x32_bf16 v[132:135], a[20:23], a[100:103], v[132:135]
ds_read_b64_tr_b16 a[84:85], v5 offset:8192
v_mfma_f32_16x16x32_bf16 v[132:135], a[16:19], a[96:99], v[132:135]
s_xor_b32 m0, s77, 132096
ds_read_b64_tr_b16 a[86:87], v5 offset:9216
v_mfma_f32_16x16x32_bf16 v[116:119], a[8:11], a[96:99], v[116:119]
s_xor_b32 s64, s71, 2654208
ds_read_b64_tr_b16 a[88:89], v6 offset:0
v_mfma_f32_16x16x32_bf16 v[116:119], a[12:15], a[100:103], v[116:119]
buffer_load_dwordx4 v14, s[36:39], s64 offen lds
v_mfma_f32_16x16x32_bf16 v[100:103], a[4:7], a[100:103], v[100:103]
ds_read_b64_tr_b16 a[90:91], v6 offset:1024
v_mfma_f32_16x16x32_bf16 v[100:103], a[0:3], a[96:99], v[100:103]
ds_read_b64_tr_b16 a[92:93], v6 offset:8192
v_mfma_f32_16x16x32_bf16 v[248:251], a[0:3], a[104:107], v[248:251]
ds_read_b64_tr_b16 a[94:95], v6 offset:9216
v_mfma_f32_16x16x32_bf16 v[248:251], a[4:7], a[108:111], v[248:251]
ds_read_b64_tr_b16 a[96:97], v7 offset:0
v_mfma_f32_16x16x32_bf16 v[252:255], a[12:15], a[108:111], v[252:255]
ds_read_b64_tr_b16 a[98:99], v7 offset:1024
v_mfma_f32_16x16x32_bf16 v[252:255], a[8:11], a[104:107], v[252:255]
s_xor_b32 m0, s77, 133120
ds_read_b64_tr_b16 a[100:101], v7 offset:8192
v_mfma_f32_16x16x32_bf16 a[120:123], a[16:19], a[104:107], a[120:123]
s_xor_b32 s64, s71, 2686976
ds_read_b64_tr_b16 a[102:103], v7 offset:9216
v_mfma_f32_16x16x32_bf16 a[120:123], a[20:23], a[108:111], a[120:123]
buffer_load_dwordx4 v15, s[36:39], s64 offen lds
v_mfma_f32_16x16x32_bf16 a[124:127], a[28:31], a[108:111], a[124:127]
v_mfma_f32_16x16x32_bf16 a[124:127], a[24:27], a[104:107], a[124:127]
s_add_u32 s82, s82, 1048576
ds_read_b64_tr_b16 a[104:105], v8 offset:0
v_mfma_f32_16x16x32_bf16 a[128:131], a[24:27], a[112:115], a[128:131]
buffer_load_dword a252, v1, s[60:63], s82 offen
v_mfma_f32_16x16x32_bf16 a[128:131], a[28:31], a[116:119], a[128:131]
ds_read_b64_tr_b16 a[106:107], v8 offset:1024
v_mfma_f32_16x16x32_bf16 a[132:135], a[20:23], a[116:119], a[132:135]
ds_read_b64_tr_b16 a[108:109], v8 offset:8192
v_mfma_f32_16x16x32_bf16 a[132:135], a[16:19], a[112:115], a[132:135]
s_xor_b32 m0, s77, 134144
ds_read_b64_tr_b16 a[110:111], v8 offset:9216
v_mfma_f32_16x16x32_bf16 a[136:139], a[8:11], a[112:115], a[136:139]
s_xor_b32 s64, s71, 2719744
v_mfma_f32_16x16x32_bf16 a[136:139], a[12:15], a[116:119], a[136:139]
buffer_load_dwordx4 v15, s[36:39], s64 offen lds
v_mfma_f32_16x16x32_bf16 a[140:143], a[4:7], a[116:119], a[140:143]
v_mfma_f32_16x16x32_bf16 a[140:143], a[0:3], a[112:115], a[140:143]
s_waitcnt lgkmcnt(4)
ds_read_b64_tr_b16 a[112:113], v9 offset:0
v_mfma_f32_16x16x32_bf16 v[184:187], a[72:75], a[32:35], v[184:187]
ds_read_b64_tr_b16 a[114:115], v9 offset:1024
v_mov_b32 v17, 0
v_mfma_f32_16x16x32_bf16 v[184:187], a[76:79], a[36:39], v[184:187]
ds_read_b64_tr_b16 a[116:117], v9 offset:8192
v_accvgpr_read_b32 v19, a144
v_mfma_f32_16x16x32_bf16 v[192:195], a[76:79], a[44:47], v[192:195]
ds_read_b64_tr_b16 a[118:119], v9 offset:9216
v_accvgpr_read_b32 v21, a160
v_mfma_f32_16x16x32_bf16 v[192:195], a[72:75], a[40:43], v[192:195]
s_xor_b32 m0, s77, 147456
v_lshlrev_b32 v18, 16, v19
v_and_b32 v19, 0xffff0000, v19
v_mfma_f32_16x16x32_bf16 v[200:203], a[72:75], a[48:51], v[200:203]
s_xor_b32 s64, s71, 2621440
v_lshlrev_b32 v20, 16, v21
v_and_b32 v21, 0xffff0000, v21
v_mfma_f32_16x16x32_bf16 v[200:203], a[76:79], a[52:55], v[200:203]
buffer_load_dwordx4 v14, s[40:43], s64 offen lds
v_mfma_f32_16x16x32_bf16 v[208:211], a[76:79], a[60:63], v[208:211]
v_mul_f32 v18, v18, v20
v_mul_f32 v19, v19, v21
v_mfma_f32_16x16x32_bf16 v[208:211], a[72:75], a[56:59], v[208:211]
ds_read_b64_tr_b16 a[72:73], v10 offset:0
v_cvt_pk_bf16_f32 v18, v18, v19
v_mfma_f32_16x16x32_bf16 v[212:215], a[80:83], a[56:59], v[212:215]
ds_read_b64_tr_b16 a[74:75], v10 offset:1024
v_lshlrev_b32 v19, 16, v18
v_mfma_f32_16x16x32_bf16 v[212:215], a[84:87], a[60:63], v[212:215]
ds_read_b64_tr_b16 a[76:77], v10 offset:8192
v_and_b32 v18, 0xffff0000, v18
v_mfma_f32_16x16x32_bf16 v[204:207], a[84:87], a[52:55], v[204:207]
ds_read_b64_tr_b16 a[78:79], v10 offset:9216
v_add_f32 v17, v17, v19
v_mfma_f32_16x16x32_bf16 v[204:207], a[80:83], a[48:51], v[204:207]
s_xor_b32 m0, s77, 148480
v_add_f32 v17, v17, v18
v_accvgpr_read_b32 v19, a145
v_mfma_f32_16x16x32_bf16 v[196:199], a[80:83], a[40:43], v[196:199]
s_xor_b32 s64, s71, 2654208
v_accvgpr_read_b32 v21, a161
v_lshlrev_b32 v18, 16, v19
v_mfma_f32_16x16x32_bf16 v[196:199], a[84:87], a[44:47], v[196:199]
buffer_load_dwordx4 v14, s[40:43], s64 offen lds
v_mfma_f32_16x16x32_bf16 v[188:191], a[84:87], a[36:39], v[188:191]
v_and_b32 v19, 0xffff0000, v19
v_lshlrev_b32 v20, 16, v21
v_mfma_f32_16x16x32_bf16 v[188:191], a[80:83], a[32:35], v[188:191]
ds_read_b64_tr_b16 a[80:81], v11 offset:0
v_and_b32 v21, 0xffff0000, v21
v_mfma_f32_16x16x32_bf16 v[216:219], a[88:91], a[32:35], v[216:219]
ds_read_b64_tr_b16 a[82:83], v11 offset:1024
v_mul_f32 v18, v18, v20
v_mfma_f32_16x16x32_bf16 v[216:219], a[92:95], a[36:39], v[216:219]
ds_read_b64_tr_b16 a[84:85], v11 offset:8192
v_mul_f32 v19, v19, v21
v_mfma_f32_16x16x32_bf16 v[224:227], a[92:95], a[44:47], v[224:227]
ds_read_b64_tr_b16 a[86:87], v11 offset:9216
v_cvt_pk_bf16_f32 v18, v18, v19
v_mfma_f32_16x16x32_bf16 v[224:227], a[88:91], a[40:43], v[224:227]
s_xor_b32 m0, s77, 149504
v_lshlrev_b32 v19, 16, v18
v_and_b32 v18, 0xffff0000, v18
v_mfma_f32_16x16x32_bf16 v[232:235], a[88:91], a[48:51], v[232:235]
s_xor_b32 s64, s71, 2686976
v_add_f32 v17, v17, v19
v_add_f32 v17, v17, v18
v_mfma_f32_16x16x32_bf16 v[232:235], a[92:95], a[52:55], v[232:235]
buffer_load_dwordx4 v15, s[40:43], s64 offen lds
v_mfma_f32_16x16x32_bf16 v[240:243], a[92:95], a[60:63], v[240:243]
v_accvgpr_read_b32 v19, a146
v_accvgpr_read_b32 v21, a162
v_mfma_f32_16x16x32_bf16 v[240:243], a[88:91], a[56:59], v[240:243]
s_add_u32 s81, s81, 1048576
ds_read_b64_tr_b16 a[88:89], v4 offset:16384
v_lshlrev_b32 v18, 16, v19
v_mfma_f32_16x16x32_bf16 v[244:247], a[96:99], a[56:59], v[244:247]
buffer_load_dword a252, v16, s[56:59], s81 offen
v_mfma_f32_16x16x32_bf16 v[244:247], a[100:103], a[60:63], v[244:247]
ds_read_b64_tr_b16 a[90:91], v4 offset:17408
v_and_b32 v19, 0xffff0000, v19
v_mfma_f32_16x16x32_bf16 v[236:239], a[100:103], a[52:55], v[236:239]
ds_read_b64_tr_b16 a[92:93], v4 offset:24576
v_lshlrev_b32 v20, 16, v21
v_mfma_f32_16x16x32_bf16 v[236:239], a[96:99], a[48:51], v[236:239]
s_xor_b32 m0, s77, 150528
ds_read_b64_tr_b16 a[94:95], v4 offset:25600
v_and_b32 v21, 0xffff0000, v21
v_mfma_f32_16x16x32_bf16 v[228:231], a[96:99], a[40:43], v[228:231]
s_xor_b32 s64, s71, 2719744
v_mul_f32 v18, v18, v20
v_mul_f32 v19, v19, v21
v_mfma_f32_16x16x32_bf16 v[228:231], a[100:103], a[44:47], v[228:231]
buffer_load_dwordx4 v15, s[40:43], s64 offen lds
v_mfma_f32_16x16x32_bf16 v[220:223], a[100:103], a[36:39], v[220:223]
v_cvt_pk_bf16_f32 v18, v18, v19
v_lshlrev_b32 v19, 16, v18
v_mfma_f32_16x16x32_bf16 v[220:223], a[96:99], a[32:35], v[220:223]
s_waitcnt lgkmcnt(4)
ds_read_b64_tr_b16 a[96:97], v5 offset:16384
v_and_b32 v18, 0xffff0000, v18
v_mfma_f32_16x16x32_bf16 v[152:155], a[104:107], a[32:35], v[152:155]
ds_read_b64_tr_b16 a[98:99], v5 offset:17408
v_add_f32 v17, v17, v19
v_mfma_f32_16x16x32_bf16 v[152:155], a[108:111], a[36:39], v[152:155]
ds_read_b64_tr_b16 a[100:101], v5 offset:24576
v_add_f32 v17, v17, v18
v_mfma_f32_16x16x32_bf16 v[160:163], a[108:111], a[44:47], v[160:163]
ds_read_b64_tr_b16 a[102:103], v5 offset:25600
v_accvgpr_read_b32 v19, a147
v_mfma_f32_16x16x32_bf16 v[160:163], a[104:107], a[40:43], v[160:163]
v_accvgpr_read_b32 v21, a163
v_lshlrev_b32 v18, 16, v19
v_mfma_f32_16x16x32_bf16 v[168:171], a[104:107], a[48:51], v[168:171]
s_branch L_po3
L_pg3:
s_branch L_tr9
L_po3:
v_and_b32 v19, 0xffff0000, v19
v_lshlrev_b32 v20, 16, v21
v_mfma_f32_16x16x32_bf16 v[168:171], a[108:111], a[52:55], v[168:171]
v_and_b32 v21, 0xffff0000, v21
v_mul_f32 v18, v18, v20
v_mfma_f32_16x16x32_bf16 v[176:179], a[108:111], a[60:63], v[176:179]
s_xor_b32 m0, s84, 32768
v_mul_f32 v19, v19, v21
v_cvt_pk_bf16_f32 v18, v18, v19
v_mfma_f32_16x16x32_bf16 v[176:179], a[104:107], a[56:59], v[176:179]
s_xor_b32 s64, s70, 640
ds_read_b64_tr_b16 a[104:105], v6 offset:16384
v_lshlrev_b32 v19, 16, v18
v_mfma_f32_16x16x32_bf16 v[180:183], a[112:115], a[56:59], v[180:183]
buffer_load_dwordx4 v12, s[32:35], s64 offen lds
v_mfma_f32_16x16x32_bf16 v[180:183], a[116:119], a[60:63], v[180:183]
ds_read_b64_tr_b16 a[106:107], v6 offset:17408
v_and_b32 v18, 0xffff0000, v18
v_mfma_f32_16x16x32_bf16 v[172:175], a[116:119], a[52:55], v[172:175]
ds_read_b64_tr_b16 a[108:109], v6 offset:24576
v_add_f32 v17, v17, v19
v_mfma_f32_16x16x32_bf16 v[172:175], a[112:115], a[48:51], v[172:175]
ds_read_b64_tr_b16 a[110:111], v6 offset:25600
v_add_f32 v17, v17, v18
v_mfma_f32_16x16x32_bf16 v[164:167], a[112:115], a[40:43], v[164:167]
v_accvgpr_read_b32 v19, a148
v_accvgpr_read_b32 v21, a164
v_mfma_f32_16x16x32_bf16 v[164:167], a[116:119], a[44:47], v[164:167]
s_xor_b32 m0, s84, 33792
v_lshlrev_b32 v18, 16, v19
v_and_b32 v19, 0xffff0000, v19
v_mfma_f32_16x16x32_bf16 v[156:159], a[116:119], a[36:39], v[156:159]
s_xor_b32 s64, s70, 8832
v_lshlrev_b32 v20, 16, v21
v_and_b32 v21, 0xffff0000, v21
v_mfma_f32_16x16x32_bf16 v[156:159], a[112:115], a[32:35], v[156:159]
buffer_load_dwordx4 v13, s[32:35], s64 offen lds
v_mfma_f32_16x16x32_bf16 v[24:27], a[72:75], a[32:35], v[24:27]
ds_read_b64_tr_b16 a[112:113], v7 offset:16384
v_mul_f32 v18, v18, v20
v_mfma_f32_16x16x32_bf16 v[24:27], a[76:79], a[36:39], v[24:27]
ds_read_b64_tr_b16 a[114:115], v7 offset:17408
v_mul_f32 v19, v19, v21
v_mfma_f32_16x16x32_bf16 v[40:43], a[76:79], a[44:47], v[40:43]
ds_read_b64_tr_b16 a[116:117], v7 offset:24576
v_cvt_pk_bf16_f32 v18, v18, v19
v_mfma_f32_16x16x32_bf16 v[40:43], a[72:75], a[40:43], v[40:43]
ds_read_b64_tr_b16 a[118:119], v7 offset:25600
v_lshlrev_b32 v19, 16, v18
v_mfma_f32_16x16x32_bf16 v[56:59], a[72:75], a[48:51], v[56:59]
s_xor_b32 m0, s84, 34816
v_and_b32 v18, 0xffff0000, v18
v_add_f32 v17, v17, v19
v_mfma_f32_16x16x32_bf16 v[56:59], a[76:79], a[52:55], v[56:59]
s_xor_b32 s64, s70, 17024
v_add_f32 v17, v17, v18
v_accvgpr_read_b32 v19, a149
v_mfma_f32_16x16x32_bf16 v[72:75], a[76:79], a[60:63], v[72:75]
s_waitcnt vmcnt(12)
buffer_load_dwordx4 v12, s[32:35], s64 offen lds
v_mfma_f32_16x16x32_bf16 v[72:75], a[72:75], a[56:59], v[72:75]
s_add_u32 s81, s81, 1048576
ds_read_b64_tr_b16 a[72:73], v8 offset:16384
v_accvgpr_read_b32 v21, a165
v_mfma_f32_16x16x32_bf16 v[136:139], a[80:83], a[56:59], v[136:139]
buffer_load_dword a252, v16, s[56:59], s81 offen
v_mfma_f32_16x16x32_bf16 v[136:139], a[84:87], a[60:63], v[136:139]
ds_read_b64_tr_b16 a[74:75], v8 offset:17408
v_lshlrev_b32 v18, 16, v19
v_mfma_f32_16x16x32_bf16 v[120:123], a[84:87], a[52:55], v[120:123]
ds_read_b64_tr_b16 a[76:77], v8 offset:24576
v_and_b32 v19, 0xffff0000, v19
v_mfma_f32_16x16x32_bf16 v[120:123], a[80:83], a[48:51], v[120:123]
s_xor_b32 m0, s84, 35840
ds_read_b64_tr_b16 a[78:79], v8 offset:25600
v_lshlrev_b32 v20, 16, v21
v_mfma_f32_16x16x32_bf16 v[104:107], a[80:83], a[40:43], v[104:107]
s_xor_b32 s64, s70, 25216
ds_read_b128 a[0:3], v2 offset:0
v_and_b32 v21, 0xffff0000, v21
v_mfma_f32_16x16x32_bf16 v[104:107], a[84:87], a[44:47], v[104:107]
buffer_load_dwordx4 v13, s[32:35], s64 offen lds
v_mfma_f32_16x16x32_bf16 v[88:91], a[84:87], a[36:39], v[88:91]
ds_read_b128 a[4:7], v3 offset:0
v_mul_f32 v18, v18, v20
v_mfma_f32_16x16x32_bf16 v[88:91], a[80:83], a[32:35], v[88:91]
s_waitcnt lgkmcnt(6)
ds_read_b128 a[8:11], v2 offset:2048
v_mul_f32 v19, v19, v21
v_mfma_f32_16x16x32_bf16 v[28:31], a[32:35], a[88:91], v[28:31]
ds_read_b128 a[12:15], v3 offset:2048
v_cvt_pk_bf16_f32 v18, v18, v19
v_mfma_f32_16x16x32_bf16 v[28:31], a[36:39], a[92:95], v[28:31]
ds_read_b128 a[16:19], v2 offset:4096
v_lshlrev_b32 v19, 16, v18
v_mfma_f32_16x16x32_bf16 v[44:47], a[44:47], a[92:95], v[44:47]
s_xor_b32 m0, s84, 36864
ds_read_b128 a[20:23], v3 offset:4096
v_and_b32 v18, 0xffff0000, v18
v_mfma_f32_16x16x32_bf16 v[44:47], a[40:43], a[88:91], v[44:47]
s_xor_b32 s64, s70, 33408
ds_read_b128 a[24:27], v2 offset:6144
v_add_f32 v17, v17, v19
v_mfma_f32_16x16x32_bf16 v[60:63], a[48:51], a[88:91], v[60:63]
buffer_load_dwordx4 v12, s[32:35], s64 offen lds
v_mfma_f32_16x16x32_bf16 v[60:63], a[52:55], a[92:95], v[60:63]
ds_read_b128 a[28:31], v3 offset:6144
v_add_f32 v17, v17, v18
v_mfma_f32_16x16x32_bf16 v[76:79], a[60:63], a[92:95], v[76:79]
ds_read_b64_tr_b16 a[80:81], v9 offset:16384
v_accvgpr_read_b32 v19, a150
v_mfma_f32_16x16x32_bf16 v[76:79], a[56:59], a[88:91], v[76:79]
ds_read_b64_tr_b16 a[82:83], v9 offset:17408
v_accvgpr_read_b32 v21, a166
v_mfma_f32_16x16x32_bf16 v[140:143], a[56:59], a[96:99], v[140:143]
ds_read_b64_tr_b16 a[84:85], v9 offset:24576
v_lshlrev_b32 v18, 16, v19
v_mfma_f32_16x16x32_bf16 v[140:143], a[60:63], a[100:103], v[140:143]
s_xor_b32 m0, s84, 37888
ds_read_b64_tr_b16 a[86:87], v9 offset:25600
v_and_b32 v19, 0xffff0000, v19
v_mfma_f32_16x16x32_bf16 v[124:127], a[52:55], a[100:103], v[124:127]
s_xor_b32 s64, s70, 41600
ds_read_b64_tr_b16 a[88:89], v10 offset:16384
v_lshlrev_b32 v20, 16, v21
v_mfma_f32_16x16x32_bf16 v[124:127], a[48:51], a[96:99], v[124:127]
buffer_load_dwordx4 v13, s[32:35], s64 offen lds
v_mfma_f32_16x16x32_bf16 v[108:111], a[40:43], a[96:99], v[108:111]
ds_read_b64_tr_b16 a[90:91], v10 offset:17408
v_and_b32 v21, 0xffff0000, v21
v_mfma_f32_16x16x32_bf16 v[108:111], a[44:47], a[100:103], v[108:111]
ds_read_b64_tr_b16 a[92:93], v10 offset:24576
v_mul_f32 v18, v18, v20
v_mfma_f32_16x16x32_bf16 v[92:95], a[36:39], a[100:103], v[92:95]
ds_read_b64_tr_b16 a[94:95], v10 offset:25600
v_mul_f32 v19, v19, v21
v_mfma_f32_16x16x32_bf16 v[92:95], a[32:35], a[96:99], v[92:95]
ds_read_b64_tr_b16 a[96:97], v11 offset:16384
v_cvt_pk_bf16_f32 v18, v18, v19
v_mfma_f32_16x16x32_bf16 v[32:35], a[32:35], a[104:107], v[32:35]
s_xor_b32 m0, s84, 38912
ds_read_b64_tr_b16 a[98:99], v11 offset:17408
v_lshlrev_b32 v19, 16, v18
v_mfma_f32_16x16x32_bf16 v[32:35], a[36:39], a[108:111], v[32:35]
s_xor_b32 s64, s70, 49792
ds_read_b64_tr_b16 a[100:101], v11 offset:24576
v_and_b32 v18, 0xffff0000, v18
v_mfma_f32_16x16x32_bf16 v[48:51], a[44:47], a[108:111], v[48:51]
buffer_load_dwordx4 v12, s[32:35], s64 offen lds
v_mfma_f32_16x16x32_bf16 v[48:51], a[40:43], a[104:107], v[48:51]
ds_read_b64_tr_b16 a[102:103], v11 offset:25600
v_add_f32 v17, v17, v19
v_mfma_f32_16x16x32_bf16 v[64:67], a[48:51], a[104:107], v[64:67]
v_add_f32 v17, v17, v18
v_accvgpr_read_b32 v19, a151
v_mfma_f32_16x16x32_bf16 v[64:67], a[52:55], a[108:111], v[64:67]
v_accvgpr_read_b32 v21, a167
v_lshlrev_b32 v18, 16, v19
v_mfma_f32_16x16x32_bf16 v[80:83], a[60:63], a[108:111], v[80:83]
s_add_u32 s82, s82, 1048576
v_and_b32 v19, 0xffff0000, v19
v_lshlrev_b32 v20, 16, v21
v_mfma_f32_16x16x32_bf16 v[80:83], a[56:59], a[104:107], v[80:83]
s_xor_b32 m0, s84, 39936
v_and_b32 v21, 0xffff0000, v21
v_mul_f32 v18, v18, v20
v_mfma_f32_16x16x32_bf16 v[144:147], a[56:59], a[112:115], v[144:147]
s_xor_b32 s64, s70, 57984
buffer_load_dword a252, v1, s[60:63], s82 offen
v_mfma_f32_16x16x32_bf16 v[144:147], a[60:63], a[116:119], v[144:147]
buffer_load_dwordx4 v13, s[32:35], s64 offen lds
v_mfma_f32_16x16x32_bf16 v[128:131], a[52:55], a[116:119], v[128:131]
v_mul_f32 v19, v19, v21
v_cvt_pk_bf16_f32 v18, v18, v19
v_mfma_f32_16x16x32_bf16 v[128:131], a[48:51], a[112:115], v[128:131]
v_lshlrev_b32 v19, 16, v18
v_and_b32 v18, 0xffff0000, v18
v_mfma_f32_16x16x32_bf16 v[112:115], a[40:43], a[112:115], v[112:115]
v_add_f32 v17, v17, v19
v_add_f32 v17, v17, v18
v_mfma_f32_16x16x32_bf16 v[112:115], a[44:47], a[116:119], v[112:115]
v_accvgpr_read_b32 v19, a152
v_accvgpr_read_b32 v21, a168
v_mfma_f32_16x16x32_bf16 v[96:99], a[36:39], a[116:119], v[96:99]
v_lshlrev_b32 v18, 16, v19
v_and_b32 v19, 0xffff0000, v19
v_mfma_f32_16x16x32_bf16 v[96:99], a[32:35], a[112:115], v[96:99]
s_waitcnt lgkmcnt(0)
v_lshlrev_b32 v20, 16, v21
v_and_b32 v21, 0xffff0000, v21
v_mfma_f32_16x16x32_bf16 v[36:39], a[32:35], a[72:75], v[36:39]
v_mul_f32 v18, v18, v20
v_mul_f32 v19, v19, v21
v_mfma_f32_16x16x32_bf16 v[36:39], a[36:39], a[76:79], v[36:39]
v_cvt_pk_bf16_f32 v18, v18, v19
v_lshlrev_b32 v19, 16, v18
v_mfma_f32_16x16x32_bf16 v[52:55], a[44:47], a[76:79], v[52:55]
s_waitcnt lgkmcnt(0)
s_barrier
v_mfma_f32_16x16x32_bf16 v[52:55], a[40:43], a[72:75], v[52:55]
s_xor_b32 m0, s77, 65536
ds_read_b64_tr_b16 a[104:105], v4 offset:32768
v_and_b32 v18, 0xffff0000, v18
v_mfma_f32_16x16x32_bf16 v[68:71], a[48:51], a[72:75], v[68:71]
s_xor_b32 s64, s71, 3145728
ds_read_b64_tr_b16 a[106:107], v4 offset:33792
v_add_f32 v17, v17, v19
v_mfma_f32_16x16x32_bf16 v[68:71], a[52:55], a[76:79], v[68:71]
buffer_load_dwordx4 v14, s[36:39], s64 offen lds
v_mfma_f32_16x16x32_bf16 v[84:87], a[60:63], a[76:79], v[84:87]
ds_read_b64_tr_b16 a[108:109], v4 offset:40960
v_add_f32 v17, v17, v18
v_mfma_f32_16x16x32_bf16 v[84:87], a[56:59], a[72:75], v[84:87]
ds_read_b64_tr_b16 a[110:111], v4 offset:41984
v_accvgpr_read_b32 v19, a153
v_mfma_f32_16x16x32_bf16 v[148:151], a[56:59], a[80:83], v[148:151]
ds_read_b64_tr_b16 a[112:113], v5 offset:32768
v_accvgpr_read_b32 v21, a169
v_mfma_f32_16x16x32_bf16 v[148:151], a[60:63], a[84:87], v[148:151]
ds_read_b64_tr_b16 a[114:115], v5 offset:33792
v_lshlrev_b32 v18, 16, v19
v_mfma_f32_16x16x32_bf16 v[132:135], a[52:55], a[84:87], v[132:135]
ds_read_b64_tr_b16 a[116:117], v5 offset:40960
v_and_b32 v19, 0xffff0000, v19
v_mfma_f32_16x16x32_bf16 v[132:135], a[48:51], a[80:83], v[132:135]
s_xor_b32 m0, s77, 66560
ds_read_b64_tr_b16 a[118:119], v5 offset:41984
v_lshlrev_b32 v20, 16, v21
v_mfma_f32_16x16x32_bf16 v[116:119], a[40:43], a[80:83], v[116:119]
s_xor_b32 s64, s71, 3178496
ds_read_b64_tr_b16 a[72:73], v6 offset:32768
v_and_b32 v21, 0xffff0000, v21
v_mfma_f32_16x16x32_bf16 v[116:119], a[44:47], a[84:87], v[116:119]
buffer_load_dwordx4 v14, s[36:39], s64 offen lds
v_mfma_f32_16x16x32_bf16 v[100:103], a[36:39], a[84:87], v[100:103]
ds_read_b64_tr_b16 a[74:75], v6 offset:33792
v_mul_f32 v18, v18, v20
v_mfma_f32_16x16x32_bf16 v[100:103], a[32:35], a[80:83], v[100:103]
ds_read_b64_tr_b16 a[76:77], v6 offset:40960
v_mul_f32 v19, v19, v21
v_mfma_f32_16x16x32_bf16 v[248:251], a[32:35], a[88:91], v[248:251]
ds_read_b64_tr_b16 a[78:79], v6 offset:41984
v_cvt_pk_bf16_f32 v18, v18, v19
v_mfma_f32_16x16x32_bf16 v[248:251], a[36:39], a[92:95], v[248:251]
ds_read_b64_tr_b16 a[80:81], v7 offset:32768
v_lshlrev_b32 v19, 16, v18
v_mfma_f32_16x16x32_bf16 v[252:255], a[44:47], a[92:95], v[252:255]
ds_read_b64_tr_b16 a[82:83], v7 offset:33792
v_and_b32 v18, 0xffff0000, v18
v_mfma_f32_16x16x32_bf16 v[252:255], a[40:43], a[88:91], v[252:255]
s_xor_b32 m0, s77, 67584
ds_read_b64_tr_b16 a[84:85], v7 offset:40960
v_add_f32 v17, v17, v19
v_mfma_f32_16x16x32_bf16 a[120:123], a[48:51], a[88:91], a[120:123]
s_xor_b32 s64, s71, 3211264
ds_read_b64_tr_b16 a[86:87], v7 offset:41984
v_add_f32 v17, v17, v18
v_mfma_f32_16x16x32_bf16 a[120:123], a[52:55], a[92:95], a[120:123]
buffer_load_dwordx4 v15, s[36:39], s64 offen lds
v_mfma_f32_16x16x32_bf16 a[124:127], a[60:63], a[92:95], a[124:127]
v_accvgpr_read_b32 v19, a154
v_accvgpr_read_b32 v21, a170
v_mfma_f32_16x16x32_bf16 a[124:127], a[56:59], a[88:91], a[124:127]
s_add_u32 s81, s81, 1048576
ds_read_b64_tr_b16 a[88:89], v8 offset:32768
v_lshlrev_b32 v18, 16, v19
v_mfma_f32_16x16x32_bf16 a[128:131], a[56:59], a[96:99], a[128:131]
buffer_load_dword a252, v16, s[56:59], s81 offen
v_mfma_f32_16x16x32_bf16 a[128:131], a[60:63], a[100:103], a[128:131]
ds_read_b64_tr_b16 a[90:91], v8 offset:33792
v_and_b32 v19, 0xffff0000, v19
v_mfma_f32_16x16x32_bf16 a[132:135], a[52:55], a[100:103], a[132:135]
ds_read_b64_tr_b16 a[92:93], v8 offset:40960
v_lshlrev_b32 v20, 16, v21
v_mfma_f32_16x16x32_bf16 a[132:135], a[48:51], a[96:99], a[132:135]
s_xor_b32 m0, s77, 68608
ds_read_b64_tr_b16 a[94:95], v8 offset:41984
v_and_b32 v21, 0xffff0000, v21
v_mfma_f32_16x16x32_bf16 a[136:139], a[40:43], a[96:99], a[136:139]
s_xor_b32 s64, s71, 3244032
v_mul_f32 v18, v18, v20
v_mul_f32 v19, v19, v21
v_mfma_f32_16x16x32_bf16 a[136:139], a[44:47], a[100:103], a[136:139]
buffer_load_dwordx4 v15, s[36:39], s64 offen lds
v_mfma_f32_16x16x32_bf16 a[140:143], a[36:39], a[100:103], a[140:143]
v_cvt_pk_bf16_f32 v18, v18, v19
v_lshlrev_b32 v19, 16, v18
v_mfma_f32_16x16x32_bf16 a[140:143], a[32:35], a[96:99], a[140:143]
s_waitcnt lgkmcnt(4)
ds_read_b64_tr_b16 a[96:97], v9 offset:32768
v_and_b32 v18, 0xffff0000, v18
v_mfma_f32_16x16x32_bf16 v[184:187], a[104:107], a[0:3], v[184:187]
ds_read_b64_tr_b16 a[98:99], v9 offset:33792
v_add_f32 v17, v17, v19
v_mfma_f32_16x16x32_bf16 v[184:187], a[108:111], a[4:7], v[184:187]
ds_read_b64_tr_b16 a[100:101], v9 offset:40960
v_add_f32 v17, v17, v18
v_mfma_f32_16x16x32_bf16 v[192:195], a[108:111], a[12:15], v[192:195]
ds_read_b64_tr_b16 a[102:103], v9 offset:41984
v_accvgpr_read_b32 v19, a155
v_mfma_f32_16x16x32_bf16 v[192:195], a[104:107], a[8:11], v[192:195]
s_xor_b32 m0, s77, 81920
v_accvgpr_read_b32 v21, a171
v_lshlrev_b32 v18, 16, v19
v_mfma_f32_16x16x32_bf16 v[200:203], a[104:107], a[16:19], v[200:203]
s_xor_b32 s64, s71, 3145728
v_and_b32 v19, 0xffff0000, v19
v_lshlrev_b32 v20, 16, v21
v_mfma_f32_16x16x32_bf16 v[200:203], a[108:111], a[20:23], v[200:203]
buffer_load_dwordx4 v14, s[40:43], s64 offen lds
v_mfma_f32_16x16x32_bf16 v[208:211], a[108:111], a[28:31], v[208:211]
v_and_b32 v21, 0xffff0000, v21
v_mul_f32 v18, v18, v20
v_mfma_f32_16x16x32_bf16 v[208:211], a[104:107], a[24:27], v[208:211]
ds_read_b64_tr_b16 a[104:105], v10 offset:32768
v_mul_f32 v19, v19, v21
v_mfma_f32_16x16x32_bf16 v[212:215], a[112:115], a[24:27], v[212:215]
ds_read_b64_tr_b16 a[106:107], v10 offset:33792
v_cvt_pk_bf16_f32 v18, v18, v19
v_mfma_f32_16x16x32_bf16 v[212:215], a[116:119], a[28:31], v[212:215]
ds_read_b64_tr_b16 a[108:109], v10 offset:40960
v_lshlrev_b32 v19, 16, v18
v_mfma_f32_16x16x32_bf16 v[204:207], a[116:119], a[20:23], v[204:207]
ds_read_b64_tr_b16 a[110:111], v10 offset:41984
v_and_b32 v18, 0xffff0000, v18
v_mfma_f32_16x16x32_bf16 v[204:207], a[112:115], a[16:19], v[204:207]
s_xor_b32 m0, s77, 82944
v_add_f32 v17, v17, v19
v_add_f32 v17, v17, v18
v_mfma_f32_16x16x32_bf16 v[196:199], a[112:115], a[8:11], v[196:199]
s_xor_b32 s64, s71, 3178496
v_accvgpr_read_b32 v19, a156
v_accvgpr_read_b32 v21, a172
v_mfma_f32_16x16x32_bf16 v[196:199], a[116:119], a[12:15], v[196:199]
buffer_load_dwordx4 v14, s[40:43], s64 offen lds
v_mfma_f32_16x16x32_bf16 v[188:191], a[116:119], a[4:7], v[188:191]
v_lshlrev_b32 v18, 16, v19
v_and_b32 v19, 0xffff0000, v19
v_mfma_f32_16x16x32_bf16 v[188:191], a[112:115], a[0:3], v[188:191]
ds_read_b64_tr_b16 a[112:113], v11 offset:32768
v_lshlrev_b32 v20, 16, v21
v_mfma_f32_16x16x32_bf16 v[216:219], a[72:75], a[0:3], v[216:219]
ds_read_b64_tr_b16 a[114:115], v11 offset:33792
v_and_b32 v21, 0xffff0000, v21
v_mfma_f32_16x16x32_bf16 v[216:219], a[76:79], a[4:7], v[216:219]
ds_read_b64_tr_b16 a[116:117], v11 offset:40960
v_mul_f32 v18, v18, v20
v_mfma_f32_16x16x32_bf16 v[224:227], a[76:79], a[12:15], v[224:227]
ds_read_b64_tr_b16 a[118:119], v11 offset:41984
v_mul_f32 v19, v19, v21
v_mfma_f32_16x16x32_bf16 v[224:227], a[72:75], a[8:11], v[224:227]
s_xor_b32 m0, s77, 83968
v_cvt_pk_bf16_f32 v18, v18, v19
v_lshlrev_b32 v19, 16, v18
v_mfma_f32_16x16x32_bf16 v[232:235], a[72:75], a[16:19], v[232:235]
s_xor_b32 s64, s71, 3211264
v_and_b32 v18, 0xffff0000, v18
v_add_f32 v17, v17, v19
v_mfma_f32_16x16x32_bf16 v[232:235], a[76:79], a[20:23], v[232:235]
buffer_load_dwordx4 v15, s[40:43], s64 offen lds
v_mfma_f32_16x16x32_bf16 v[240:243], a[76:79], a[28:31], v[240:243]
v_add_f32 v17, v17, v18
v_accvgpr_read_b32 v19, a157
v_mfma_f32_16x16x32_bf16 v[240:243], a[72:75], a[24:27], v[240:243]
s_add_u32 s82, s82, 1048576
ds_read_b64_tr_b16 a[72:73], v4 offset:49152
v_accvgpr_read_b32 v21, a173
v_mfma_f32_16x16x32_bf16 v[244:247], a[80:83], a[24:27], v[244:247]
buffer_load_dword a252, v1, s[60:63], s82 offen
v_mfma_f32_16x16x32_bf16 v[244:247], a[84:87], a[28:31], v[244:247]
ds_read_b64_tr_b16 a[74:75], v4 offset:50176
v_lshlrev_b32 v18, 16, v19
v_mfma_f32_16x16x32_bf16 v[236:239], a[84:87], a[20:23], v[236:239]
ds_read_b64_tr_b16 a[76:77], v4 offset:57344
v_and_b32 v19, 0xffff0000, v19
v_mfma_f32_16x16x32_bf16 v[236:239], a[80:83], a[16:19], v[236:239]
s_xor_b32 m0, s77, 84992
ds_read_b64_tr_b16 a[78:79], v4 offset:58368
v_lshlrev_b32 v20, 16, v21
v_mfma_f32_16x16x32_bf16 v[228:231], a[80:83], a[8:11], v[228:231]
s_xor_b32 s64, s71, 3244032
v_and_b32 v21, 0xffff0000, v21
v_mul_f32 v18, v18, v20
v_mfma_f32_16x16x32_bf16 v[228:231], a[84:87], a[12:15], v[228:231]
buffer_load_dwordx4 v15, s[40:43], s64 offen lds
v_mfma_f32_16x16x32_bf16 v[220:223], a[84:87], a[4:7], v[220:223]
v_mul_f32 v19, v19, v21
v_cvt_pk_bf16_f32 v18, v18, v19
v_mfma_f32_16x16x32_bf16 v[220:223], a[80:83], a[0:3], v[220:223]
s_waitcnt lgkmcnt(4)
ds_read_b64_tr_b16 a[80:81], v5 offset:49152
v_lshlrev_b32 v19, 16, v18
v_mfma_f32_16x16x32_bf16 v[152:155], a[88:91], a[0:3], v[152:155]
ds_read_b64_tr_b16 a[82:83], v5 offset:50176
v_and_b32 v18, 0xffff0000, v18
v_mfma_f32_16x16x32_bf16 v[152:155], a[92:95], a[4:7], v[152:155]
ds_read_b64_tr_b16 a[84:85], v5 offset:57344
v_add_f32 v17, v17, v19
v_mfma_f32_16x16x32_bf16 v[160:163], a[92:95], a[12:15], v[160:163]
ds_read_b64_tr_b16 a[86:87], v5 offset:58368
v_add_f32 v17, v17, v18
v_mfma_f32_16x16x32_bf16 v[160:163], a[88:91], a[8:11], v[160:163]
v_accvgpr_read_b32 v19, a158
v_accvgpr_read_b32 v21, a174
v_mfma_f32_16x16x32_bf16 v[168:171], a[88:91], a[16:19], v[168:171]
v_lshlrev_b32 v18, 16, v19
v_and_b32 v19, 0xffff0000, v19
v_mfma_f32_16x16x32_bf16 v[168:171], a[92:95], a[20:23], v[168:171]
v_lshlrev_b32 v20, 16, v21
v_and_b32 v21, 0xffff0000, v21
v_mfma_f32_16x16x32_bf16 v[176:179], a[92:95], a[28:31], v[176:179]
s_xor_b32 m0, s84, 0
v_mul_f32 v18, v18, v20
v_mul_f32 v19, v19, v21
v_mfma_f32_16x16x32_bf16 v[176:179], a[88:91], a[24:27], v[176:179]
s_xor_b32 s64, s70, 768
ds_read_b64_tr_b16 a[88:89], v6 offset:49152
v_cvt_pk_bf16_f32 v18, v18, v19
v_mfma_f32_16x16x32_bf16 v[180:183], a[96:99], a[24:27], v[180:183]
buffer_load_dwordx4 v12, s[32:35], s64 offen lds
v_mfma_f32_16x16x32_bf16 v[180:183], a[100:103], a[28:31], v[180:183]
ds_read_b64_tr_b16 a[90:91], v6 offset:50176
v_lshlrev_b32 v19, 16, v18
v_mfma_f32_16x16x32_bf16 v[172:175], a[100:103], a[20:23], v[172:175]
ds_read_b64_tr_b16 a[92:93], v6 offset:57344
v_and_b32 v18, 0xffff0000, v18
v_mfma_f32_16x16x32_bf16 v[172:175], a[96:99], a[16:19], v[172:175]
ds_read_b64_tr_b16 a[94:95], v6 offset:58368
v_add_f32 v17, v17, v19
v_mfma_f32_16x16x32_bf16 v[164:167], a[96:99], a[8:11], v[164:167]
v_add_f32 v17, v17, v18
v_accvgpr_read_b32 v19, a159
v_mfma_f32_16x16x32_bf16 v[164:167], a[100:103], a[12:15], v[164:167]
s_xor_b32 m0, s84, 1024
v_accvgpr_read_b32 v21, a175
v_lshlrev_b32 v18, 16, v19
v_mfma_f32_16x16x32_bf16 v[156:159], a[100:103], a[4:7], v[156:159]
s_xor_b32 s64, s70, 8960
v_and_b32 v19, 0xffff0000, v19
v_lshlrev_b32 v20, 16, v21
v_mfma_f32_16x16x32_bf16 v[156:159], a[96:99], a[0:3], v[156:159]
buffer_load_dwordx4 v13, s[32:35], s64 offen lds
v_mfma_f32_16x16x32_bf16 v[24:27], a[104:107], a[0:3], v[24:27]
ds_read_b64_tr_b16 a[96:97], v7 offset:49152
v_and_b32 v21, 0xffff0000, v21
v_mfma_f32_16x16x32_bf16 v[24:27], a[108:111], a[4:7], v[24:27]
ds_read_b64_tr_b16 a[98:99], v7 offset:50176
v_mul_f32 v18, v18, v20
v_mfma_f32_16x16x32_bf16 v[40:43], a[108:111], a[12:15], v[40:43]
ds_read_b64_tr_b16 a[100:101], v7 offset:57344
v_mul_f32 v19, v19, v21
v_mfma_f32_16x16x32_bf16 v[40:43], a[104:107], a[8:11], v[40:43]
ds_read_b64_tr_b16 a[102:103], v7 offset:58368
v_cvt_pk_bf16_f32 v18, v18, v19
v_mfma_f32_16x16x32_bf16 v[56:59], a[104:107], a[16:19], v[56:59]
s_xor_b32 m0, s84, 2048
v_lshlrev_b32 v19, 16, v18
v_and_b32 v18, 0xffff0000, v18
v_mfma_f32_16x16x32_bf16 v[56:59], a[108:111], a[20:23], v[56:59]
s_xor_b32 s64, s70, 17152
v_add_f32 v17, v17, v19
v_add_f32 v17, v17, v18
v_mfma_f32_16x16x32_bf16 v[72:75], a[108:111], a[28:31], v[72:75]
s_waitcnt vmcnt(12)
buffer_load_dwordx4 v12, s[32:35], s64 offen lds
v_mfma_f32_16x16x32_bf16 v[72:75], a[104:107], a[24:27], v[72:75]
s_add_u32 s81, s81, 1048576
ds_read_b64_tr_b16 a[104:105], v8 offset:49152
v_add_f32_dpp v17, v17, v17 row_ror:8 row_mask:0xf bank_mask:0xf
v_mfma_f32_16x16x32_bf16 v[136:139], a[112:115], a[24:27], v[136:139]
buffer_load_dword a252, v16, s[56:59], s81 offen
v_mfma_f32_16x16x32_bf16 v[136:139], a[116:119], a[28:31], v[136:139]
ds_read_b64_tr_b16 a[106:107], v8 offset:50176
v_add_u32 v4, 0x8000, v4
v_mfma_f32_16x16x32_bf16 v[120:123], a[116:119], a[20:23], v[120:123]
ds_read_b64_tr_b16 a[108:109], v8 offset:57344
v_add_f32_dpp v17, v17, v17 row_ror:4 row_mask:0xf bank_mask:0xf
v_mfma_f32_16x16x32_bf16 v[120:123], a[112:115], a[16:19], v[120:123]
s_xor_b32 m0, s84, 3072
ds_read_b64_tr_b16 a[110:111], v8 offset:58368
v_mfma_f32_16x16x32_bf16 v[104:107], a[112:115], a[8:11], v[104:107]
s_xor_b32 s64, s70, 25344
ds_read_b128 a[32:35], v2 offset:32768
v_add_f32_dpp v17, v17, v17 row_ror:2 row_mask:0xf bank_mask:0xf
v_mfma_f32_16x16x32_bf16 v[104:107], a[116:119], a[12:15], v[104:107]
buffer_load_dwordx4 v13, s[32:35], s64 offen lds
v_mfma_f32_16x16x32_bf16 v[88:91], a[116:119], a[4:7], v[88:91]
ds_read_b128 a[36:39], v3 offset:32768
v_add_f32_dpp v17, v17, v17 row_ror:1 row_mask:0xf bank_mask:0xf
v_mfma_f32_16x16x32_bf16 v[88:91], a[112:115], a[0:3], v[88:91]
s_waitcnt lgkmcnt(6)
ds_read_b128 a[40:43], v2 offset:34816
v_mov_b32 v18, v17
v_mfma_f32_16x16x32_bf16 v[28:31], a[0:3], a[72:75], v[28:31]
ds_read_b128 a[44:47], v3 offset:34816
v_mfma_f32_16x16x32_bf16 v[28:31], a[4:7], a[76:79], v[28:31]
ds_read_b128 a[48:51], v2 offset:36864
v_add_u32 v5, 0x8000, v5
v_mfma_f32_16x16x32_bf16 v[44:47], a[12:15], a[76:79], v[44:47]
s_xor_b32 m0, s84, 4096
ds_read_b128 a[52:55], v3 offset:36864
v_permlane16_swap_b32 v18, v17
v_mfma_f32_16x16x32_bf16 v[44:47], a[8:11], a[72:75], v[44:47]
s_xor_b32 s64, s70, 33536
ds_read_b128 a[56:59], v2 offset:38912
v_add_f32 v17, v17, v18
v_mfma_f32_16x16x32_bf16 v[60:63], a[16:19], a[72:75], v[60:63]
buffer_load_dwordx4 v12, s[32:35], s64 offen lds
v_mfma_f32_16x16x32_bf16 v[60:63], a[20:23], a[76:79], v[60:63]
ds_read_b128 a[60:63], v3 offset:38912
v_cvt_pk_bf16_f32 v17, v17, v17
v_mfma_f32_16x16x32_bf16 v[76:79], a[28:31], a[76:79], v[76:79]
ds_read_b64_tr_b16 a[112:113], v9 offset:49152
v_and_b32 v17, 0xffff0000, v17
v_mfma_f32_16x16x32_bf16 v[76:79], a[24:27], a[72:75], v[76:79]
ds_read_b64_tr_b16 a[114:115], v9 offset:50176
v_mul_f32 v17, 0xbfb8aa3b, v17
v_mfma_f32_16x16x32_bf16 v[140:143], a[24:27], a[80:83], v[140:143]
ds_read_b64_tr_b16 a[116:117], v9 offset:57344
v_mfma_f32_16x16x32_bf16 v[140:143], a[28:31], a[84:87], v[140:143]
s_xor_b32 m0, s84, 5120
ds_read_b64_tr_b16 a[118:119], v9 offset:58368
v_add_u32 v6, 0x8000, v6
v_mfma_f32_16x16x32_bf16 v[124:127], a[20:23], a[84:87], v[124:127]
s_xor_b32 s64, s70, 41728
ds_read_b64_tr_b16 a[72:73], v10 offset:49152
v_mfma_f32_16x16x32_bf16 v[124:127], a[16:19], a[80:83], v[124:127]
buffer_load_dwordx4 v13, s[32:35], s64 offen lds
v_mfma_f32_16x16x32_bf16 v[108:111], a[8:11], a[80:83], v[108:111]
ds_read_b64_tr_b16 a[74:75], v10 offset:50176
v_mfma_f32_16x16x32_bf16 v[108:111], a[12:15], a[84:87], v[108:111]
ds_read_b64_tr_b16 a[76:77], v10 offset:57344
v_mfma_f32_16x16x32_bf16 v[92:95], a[4:7], a[84:87], v[92:95]
ds_read_b64_tr_b16 a[78:79], v10 offset:58368
v_mfma_f32_16x16x32_bf16 v[92:95], a[0:3], a[80:83], v[92:95]
ds_read_b64_tr_b16 a[80:81], v11 offset:49152
v_mfma_f32_16x16x32_bf16 v[32:35], a[0:3], a[88:91], v[32:35]
s_xor_b32 m0, s84, 6144
ds_read_b64_tr_b16 a[82:83], v11 offset:50176
v_mfma_f32_16x16x32_bf16 v[32:35], a[4:7], a[92:95], v[32:35]
s_xor_b32 s64, s70, 49920
ds_read_b64_tr_b16 a[84:85], v11 offset:57344
v_add_u32 v7, 0x8000, v7
v_mfma_f32_16x16x32_bf16 v[48:51], a[12:15], a[92:95], v[48:51]
buffer_load_dwordx4 v12, s[32:35], s64 offen lds
v_mfma_f32_16x16x32_bf16 v[48:51], a[8:11], a[88:91], v[48:51]
ds_read_b64_tr_b16 a[86:87], v11 offset:58368
v_mfma_f32_16x16x32_bf16 v[64:67], a[16:19], a[88:91], v[64:67]
v_exp_f32 v17, v17
v_mfma_f32_16x16x32_bf16 v[64:67], a[20:23], a[92:95], v[64:67]
v_add_f32 v17, 1.0, v17
v_mfma_f32_16x16x32_bf16 v[80:83], a[28:31], a[92:95], v[80:83]
v_rcp_f32 v17, v17
v_mfma_f32_16x16x32_bf16 v[80:83], a[24:27], a[88:91], v[80:83]
s_xor_b32 m0, s84, 7168
s_add_u32 s81, s81, 1048576
v_cvt_pk_bf16_f32 v18, v17, v17
v_mfma_f32_16x16x32_bf16 v[144:147], a[24:27], a[96:99], v[144:147]
s_xor_b32 s64, s70, 58112
buffer_load_dword a252, v16, s[56:59], s81 offen
v_mfma_f32_16x16x32_bf16 v[144:147], a[28:31], a[100:103], v[144:147]
buffer_load_dwordx4 v13, s[32:35], s64 offen lds
v_mfma_f32_16x16x32_bf16 v[128:131], a[20:23], a[100:103], v[128:131]
s_branch L_po4
L_pg4:
s_branch L_tr9
L_po4:
v_add_u32 v8, 0x8000, v8
v_and_b32 v18, 0xffff0000, v18
v_mfma_f32_16x16x32_bf16 v[128:131], a[16:19], a[96:99], v[128:131]
v_sub_f32 v19, 1.0, v18
v_mfma_f32_16x16x32_bf16 v[112:115], a[8:11], a[96:99], v[112:115]
v_cvt_pk_bf16_f32 v19, v19, v19
v_mfma_f32_16x16x32_bf16 v[112:115], a[12:15], a[100:103], v[112:115]
v_and_b32 v19, 0xffff0000, v19
v_mfma_f32_16x16x32_bf16 v[96:99], a[4:7], a[100:103], v[96:99]
v_add_u32 v9, 0x8000, v9
v_add_u32 v10, 0x8000, v10
v_mfma_f32_16x16x32_bf16 v[96:99], a[0:3], a[96:99], v[96:99]
s_waitcnt lgkmcnt(0)
v_add_u32 v11, 0x8000, v11
v_and_b32 v20, 31, v0
v_mfma_f32_16x16x32_bf16 v[36:39], a[0:3], a[104:107], v[36:39]
v_lshlrev_b32 v20, 27, v20
v_mfma_f32_16x16x32_bf16 v[36:39], a[4:7], a[108:111], v[36:39]
v_lshrrev_b32 v21, 2, v0
v_mfma_f32_16x16x32_bf16 v[52:55], a[12:15], a[108:111], v[52:55]
s_waitcnt lgkmcnt(0)
s_barrier
v_mfma_f32_16x16x32_bf16 v[52:55], a[8:11], a[104:107], v[52:55]
s_xor_b32 m0, s77, 98304
ds_read_b64_tr_b16 a[88:89], v4 offset:32768
v_add_u32 v20, v20, v21
v_mfma_f32_16x16x32_bf16 v[68:71], a[16:19], a[104:107], v[68:71]
s_xor_b32 s64, s71, 3670016
ds_read_b64_tr_b16 a[90:91], v4 offset:33792
v_mfma_f32_16x16x32_bf16 v[68:71], a[20:23], a[108:111], v[68:71]
buffer_load_dwordx4 v14, s[36:39], s64 offen lds
v_mfma_f32_16x16x32_bf16 v[84:87], a[28:31], a[108:111], v[84:87]
ds_read_b64_tr_b16 a[92:93], v4 offset:40960
v_mfma_f32_16x16x32_bf16 v[84:87], a[24:27], a[104:107], v[84:87]
ds_read_b64_tr_b16 a[94:95], v4 offset:41984
v_mfma_f32_16x16x32_bf16 v[148:151], a[24:27], a[112:115], v[148:151]
ds_read_b64_tr_b16 a[96:97], v5 offset:32768
v_mfma_f32_16x16x32_bf16 v[148:151], a[28:31], a[116:119], v[148:151]
ds_read_b64_tr_b16 a[98:99], v5 offset:33792
v_mfma_f32_16x16x32_bf16 v[132:135], a[20:23], a[116:119], v[132:135]
ds_read_b64_tr_b16 a[100:101], v5 offset:40960
v_mfma_f32_16x16x32_bf16 v[132:135], a[16:19], a[112:115], v[132:135]
s_xor_b32 m0, s77, 99328
ds_read_b64_tr_b16 a[102:103], v5 offset:41984
v_mfma_f32_16x16x32_bf16 v[116:119], a[8:11], a[112:115], v[116:119]
s_xor_b32 s64, s71, 3702784
ds_read_b64_tr_b16 a[104:105], v6 offset:32768
v_mfma_f32_16x16x32_bf16 v[116:119], a[12:15], a[116:119], v[116:119]
buffer_load_dwordx4 v14, s[36:39], s64 offen lds
v_mfma_f32_16x16x32_bf16 v[100:103], a[4:7], a[116:119], v[100:103]
ds_read_b64_tr_b16 a[106:107], v6 offset:33792
v_mfma_f32_16x16x32_bf16 v[100:103], a[0:3], a[112:115], v[100:103]
ds_read_b64_tr_b16 a[108:109], v6 offset:40960
v_mfma_f32_16x16x32_bf16 v[248:251], a[0:3], a[72:75], v[248:251]
ds_read_b64_tr_b16 a[110:111], v6 offset:41984
v_mfma_f32_16x16x32_bf16 v[248:251], a[4:7], a[76:79], v[248:251]
ds_read_b64_tr_b16 a[112:113], v7 offset:32768
v_mfma_f32_16x16x32_bf16 v[252:255], a[12:15], a[76:79], v[252:255]
ds_read_b64_tr_b16 a[114:115], v7 offset:33792
v_mfma_f32_16x16x32_bf16 v[252:255], a[8:11], a[72:75], v[252:255]
s_xor_b32 m0, s77, 100352
ds_read_b64_tr_b16 a[116:117], v7 offset:40960
v_mfma_f32_16x16x32_bf16 a[120:123], a[16:19], a[72:75], a[120:123]
s_xor_b32 s64, s71, 3735552
s_lshl2_add_u32 s65, s2, s30
ds_read_b64_tr_b16 a[118:119], v7 offset:41984
v_mfma_f32_16x16x32_bf16 a[120:123], a[20:23], a[76:79], a[120:123]
s_lshl4_add_u32 s65, s65, 58720256
buffer_load_dwordx4 v15, s[36:39], s64 offen lds
v_mfma_f32_16x16x32_bf16 a[124:127], a[28:31], a[76:79], a[124:127]
buffer_store_dwordx2 v[18:19], v20, s[44:47], s65 offen sc1
v_mfma_f32_16x16x32_bf16 a[124:127], a[24:27], a[72:75], a[124:127]
s_add_u32 s82, s82, 1048576
ds_read_b64_tr_b16 a[72:73], v8 offset:32768
v_lshrrev_b32 v21, 4, v0
v_mfma_f32_16x16x32_bf16 a[128:131], a[24:27], a[80:83], a[128:131]
buffer_load_dword a252, v1, s[60:63], s82 offen
v_mfma_f32_16x16x32_bf16 a[128:131], a[28:31], a[84:87], a[128:131]
ds_read_b64_tr_b16 a[74:75], v8 offset:33792
v_bfe_u32 v19, v0, 2, 2
v_mfma_f32_16x16x32_bf16 a[132:135], a[20:23], a[84:87], a[132:135]
ds_read_b64_tr_b16 a[76:77], v8 offset:40960
v_lshl_add_u32 v19, v21, 3, v19
v_mfma_f32_16x16x32_bf16 a[132:135], a[16:19], a[80:83], a[132:135]
s_xor_b32 m0, s77, 101376
ds_read_b64_tr_b16 a[78:79], v8 offset:41984
v_lshlrev_b32 v19, 6, v19
v_mfma_f32_16x16x32_bf16 a[136:139], a[8:11], a[80:83], a[136:139]
s_xor_b32 s64, s71, 3768320
v_and_b32 v21, 1, v21
v_mfma_f32_16x16x32_bf16 a[136:139], a[12:15], a[84:87], a[136:139]
buffer_load_dwordx4 v15, s[36:39], s64 offen lds
v_mfma_f32_16x16x32_bf16 a[140:143], a[4:7], a[84:87], a[140:143]
v_lshl_add_u32 v19, v21, 5, v19
v_mfma_f32_16x16x32_bf16 a[140:143], a[0:3], a[80:83], a[140:143]
s_waitcnt lgkmcnt(4)
ds_read_b64_tr_b16 a[80:81], v9 offset:32768
v_and_b32 v21, 3, v0
v_mfma_f32_16x16x32_bf16 v[184:187], a[88:91], a[32:35], v[184:187]
ds_read_b64_tr_b16 a[82:83], v9 offset:33792
v_lshl_add_u32 v19, v21, 3, v19
v_mfma_f32_16x16x32_bf16 v[184:187], a[92:95], a[36:39], v[184:187]
ds_read_b64_tr_b16 a[84:85], v9 offset:40960
v_add_u32 v19, 114688, v19
v_mfma_f32_16x16x32_bf16 v[192:195], a[92:95], a[44:47], v[192:195]
ds_read_b64_tr_b16 a[86:87], v9 offset:41984
v_xor_b32 v20, 32, v19
v_mfma_f32_16x16x32_bf16 v[192:195], a[88:91], a[40:43], v[192:195]
s_xor_b32 m0, s77, 114688
v_mfma_f32_16x16x32_bf16 v[200:203], a[88:91], a[48:51], v[200:203]
s_xor_b32 s64, s71, 3670016
v_mfma_f32_16x16x32_bf16 v[200:203], a[92:95], a[52:55], v[200:203]
buffer_load_dwordx4 v14, s[40:43], s64 offen lds
v_mfma_f32_16x16x32_bf16 v[208:211], a[92:95], a[60:63], v[208:211]
v_mfma_f32_16x16x32_bf16 v[208:211], a[88:91], a[56:59], v[208:211]
ds_read_b64_tr_b16 a[88:89], v10 offset:32768
v_mfma_f32_16x16x32_bf16 v[212:215], a[96:99], a[56:59], v[212:215]
ds_read_b64_tr_b16 a[90:91], v10 offset:33792
v_mfma_f32_16x16x32_bf16 v[212:215], a[100:103], a[60:63], v[212:215]
ds_read_b64_tr_b16 a[92:93], v10 offset:40960
v_mfma_f32_16x16x32_bf16 v[204:207], a[100:103], a[52:55], v[204:207]
ds_read_b64_tr_b16 a[94:95], v10 offset:41984
v_mfma_f32_16x16x32_bf16 v[204:207], a[96:99], a[48:51], v[204:207]
s_xor_b32 m0, s77, 115712
v_mfma_f32_16x16x32_bf16 v[196:199], a[96:99], a[40:43], v[196:199]
s_xor_b32 s64, s71, 3702784
v_mfma_f32_16x16x32_bf16 v[196:199], a[100:103], a[44:47], v[196:199]
buffer_load_dwordx4 v14, s[40:43], s64 offen lds
v_mfma_f32_16x16x32_bf16 v[188:191], a[100:103], a[36:39], v[188:191]
v_mfma_f32_16x16x32_bf16 v[188:191], a[96:99], a[32:35], v[188:191]
ds_read_b64_tr_b16 a[96:97], v11 offset:32768
v_mfma_f32_16x16x32_bf16 v[216:219], a[104:107], a[32:35], v[216:219]
ds_read_b64_tr_b16 a[98:99], v11 offset:33792
v_mfma_f32_16x16x32_bf16 v[216:219], a[108:111], a[36:39], v[216:219]
ds_read_b64_tr_b16 a[100:101], v11 offset:40960
v_mfma_f32_16x16x32_bf16 v[224:227], a[108:111], a[44:47], v[224:227]
ds_read_b64_tr_b16 a[102:103], v11 offset:41984
v_mfma_f32_16x16x32_bf16 v[224:227], a[104:107], a[40:43], v[224:227]
s_xor_b32 m0, s77, 116736
v_mfma_f32_16x16x32_bf16 v[232:235], a[104:107], a[48:51], v[232:235]
s_xor_b32 s64, s71, 3735552
v_mfma_f32_16x16x32_bf16 v[232:235], a[108:111], a[52:55], v[232:235]
buffer_load_dwordx4 v15, s[40:43], s64 offen lds
v_mfma_f32_16x16x32_bf16 v[240:243], a[108:111], a[60:63], v[240:243]
v_mfma_f32_16x16x32_bf16 v[240:243], a[104:107], a[56:59], v[240:243]
s_add_u32 s81, s81, 1048576
ds_read_b64_tr_b16 a[104:105], v4 offset:49152
v_mfma_f32_16x16x32_bf16 v[244:247], a[112:115], a[56:59], v[244:247]
buffer_load_dword a252, v16, s[56:59], s81 offen
v_mfma_f32_16x16x32_bf16 v[244:247], a[116:119], a[60:63], v[244:247]
ds_read_b64_tr_b16 a[106:107], v4 offset:50176
v_mfma_f32_16x16x32_bf16 v[236:239], a[116:119], a[52:55], v[236:239]
ds_read_b64_tr_b16 a[108:109], v4 offset:57344
v_mfma_f32_16x16x32_bf16 v[236:239], a[112:115], a[48:51], v[236:239]
s_xor_b32 m0, s77, 117760
ds_read_b64_tr_b16 a[110:111], v4 offset:58368
v_mfma_f32_16x16x32_bf16 v[228:231], a[112:115], a[40:43], v[228:231]
s_xor_b32 s64, s71, 3768320
v_mfma_f32_16x16x32_bf16 v[228:231], a[116:119], a[44:47], v[228:231]
buffer_load_dwordx4 v15, s[40:43], s64 offen lds
v_mfma_f32_16x16x32_bf16 v[220:223], a[116:119], a[36:39], v[220:223]
v_mfma_f32_16x16x32_bf16 v[220:223], a[112:115], a[32:35], v[220:223]
s_waitcnt lgkmcnt(4)
ds_read_b64_tr_b16 a[112:113], v5 offset:49152
v_mfma_f32_16x16x32_bf16 v[152:155], a[72:75], a[32:35], v[152:155]
ds_read_b64_tr_b16 a[114:115], v5 offset:50176
v_mfma_f32_16x16x32_bf16 v[152:155], a[76:79], a[36:39], v[152:155]
ds_read_b64_tr_b16 a[116:117], v5 offset:57344
v_mfma_f32_16x16x32_bf16 v[160:163], a[76:79], a[44:47], v[160:163]
ds_read_b64_tr_b16 a[118:119], v5 offset:58368
v_mfma_f32_16x16x32_bf16 v[160:163], a[72:75], a[40:43], v[160:163]
v_mfma_f32_16x16x32_bf16 v[168:171], a[72:75], a[48:51], v[168:171]
v_mfma_f32_16x16x32_bf16 v[168:171], a[76:79], a[52:55], v[168:171]
v_mfma_f32_16x16x32_bf16 v[176:179], a[76:79], a[60:63], v[176:179]
s_xor_b32 m0, s84, 32768
v_mfma_f32_16x16x32_bf16 v[176:179], a[72:75], a[56:59], v[176:179]
s_xor_b32 s64, s70, 896
ds_read_b64_tr_b16 a[72:73], v6 offset:49152
v_mfma_f32_16x16x32_bf16 v[180:183], a[80:83], a[56:59], v[180:183]
buffer_load_dwordx4 v12, s[32:35], s64 offen lds
v_mfma_f32_16x16x32_bf16 v[180:183], a[84:87], a[60:63], v[180:183]
ds_read_b64_tr_b16 a[74:75], v6 offset:50176
v_mfma_f32_16x16x32_bf16 v[172:175], a[84:87], a[52:55], v[172:175]
ds_read_b64_tr_b16 a[76:77], v6 offset:57344
v_mfma_f32_16x16x32_bf16 v[172:175], a[80:83], a[48:51], v[172:175]
ds_read_b64_tr_b16 a[78:79], v6 offset:58368
v_mfma_f32_16x16x32_bf16 v[164:167], a[80:83], a[40:43], v[164:167]
v_mfma_f32_16x16x32_bf16 v[164:167], a[84:87], a[44:47], v[164:167]
s_xor_b32 m0, s84, 33792
v_mfma_f32_16x16x32_bf16 v[156:159], a[84:87], a[36:39], v[156:159]
s_xor_b32 s64, s70, 9088
v_mfma_f32_16x16x32_bf16 v[156:159], a[80:83], a[32:35], v[156:159]
buffer_load_dwordx4 v13, s[32:35], s64 offen lds
v_mfma_f32_16x16x32_bf16 v[24:27], a[88:91], a[32:35], v[24:27]
ds_read_b64_tr_b16 a[80:81], v7 offset:49152
v_mfma_f32_16x16x32_bf16 v[24:27], a[92:95], a[36:39], v[24:27]
ds_read_b64_tr_b16 a[82:83], v7 offset:50176
v_mfma_f32_16x16x32_bf16 v[40:43], a[92:95], a[44:47], v[40:43]
ds_read_b64_tr_b16 a[84:85], v7 offset:57344
v_mfma_f32_16x16x32_bf16 v[40:43], a[88:91], a[40:43], v[40:43]
ds_read_b64_tr_b16 a[86:87], v7 offset:58368
v_mfma_f32_16x16x32_bf16 v[56:59], a[88:91], a[48:51], v[56:59]
s_xor_b32 m0, s84, 34816
v_mfma_f32_16x16x32_bf16 v[56:59], a[92:95], a[52:55], v[56:59]
s_xor_b32 s64, s70, 17280
v_mfma_f32_16x16x32_bf16 v[72:75], a[92:95], a[60:63], v[72:75]
s_waitcnt vmcnt(13)
buffer_load_dwordx4 v12, s[32:35], s64 offen lds
v_mfma_f32_16x16x32_bf16 v[72:75], a[88:91], a[56:59], v[72:75]
s_add_u32 s82, s82, 1048576
ds_read_b64_tr_b16 a[88:89], v8 offset:49152
v_mfma_f32_16x16x32_bf16 v[136:139], a[96:99], a[56:59], v[136:139]
buffer_load_dword a252, v1, s[60:63], s82 offen
v_mfma_f32_16x16x32_bf16 v[136:139], a[100:103], a[60:63], v[136:139]
ds_read_b64_tr_b16 a[90:91], v8 offset:50176
v_subrev_u32 v4, 0x8000, v4
v_mfma_f32_16x16x32_bf16 v[120:123], a[100:103], a[52:55], v[120:123]
ds_read_b64_tr_b16 a[92:93], v8 offset:57344
v_mfma_f32_16x16x32_bf16 v[120:123], a[96:99], a[48:51], v[120:123]
s_xor_b32 m0, s84, 35840
ds_read_b64_tr_b16 a[94:95], v8 offset:58368
v_mfma_f32_16x16x32_bf16 v[104:107], a[96:99], a[40:43], v[104:107]
s_xor_b32 s64, s70, 25472
ds_read_b128 a[0:3], v2 offset:0
v_mfma_f32_16x16x32_bf16 v[104:107], a[100:103], a[44:47], v[104:107]
buffer_load_dwordx4 v13, s[32:35], s64 offen lds
v_mfma_f32_16x16x32_bf16 v[88:91], a[100:103], a[36:39], v[88:91]
ds_read_b128 a[4:7], v3 offset:0
v_mfma_f32_16x16x32_bf16 v[88:91], a[96:99], a[32:35], v[88:91]
s_waitcnt lgkmcnt(6)
ds_read_b128 a[8:11], v2 offset:2048
v_mfma_f32_16x16x32_bf16 v[28:31], a[32:35], a[104:107], v[28:31]
ds_read_b128 a[12:15], v3 offset:2048
v_mfma_f32_16x16x32_bf16 v[28:31], a[36:39], a[108:111], v[28:31]
ds_read_b128 a[16:19], v2 offset:4096
v_subrev_u32 v5, 0x8000, v5
v_mfma_f32_16x16x32_bf16 v[44:47], a[44:47], a[108:111], v[44:47]
s_xor_b32 m0, s84, 36864
ds_read_b128 a[20:23], v3 offset:4096
v_mfma_f32_16x16x32_bf16 v[44:47], a[40:43], a[104:107], v[44:47]
s_xor_b32 s64, s70, 33664
ds_read_b128 a[24:27], v2 offset:6144
v_mfma_f32_16x16x32_bf16 v[60:63], a[48:51], a[104:107], v[60:63]
buffer_load_dwordx4 v12, s[32:35], s64 offen lds
v_mfma_f32_16x16x32_bf16 v[60:63], a[52:55], a[108:111], v[60:63]
ds_read_b128 a[28:31], v3 offset:6144
v_mfma_f32_16x16x32_bf16 v[76:79], a[60:63], a[108:111], v[76:79]
ds_read_b64_tr_b16 a[96:97], v9 offset:49152
v_mfma_f32_16x16x32_bf16 v[76:79], a[56:59], a[104:107], v[76:79]
ds_read_b64_tr_b16 a[98:99], v9 offset:50176
v_mfma_f32_16x16x32_bf16 v[140:143], a[56:59], a[112:115], v[140:143]
ds_read_b64_tr_b16 a[100:101], v9 offset:57344
v_mfma_f32_16x16x32_bf16 v[140:143], a[60:63], a[116:119], v[140:143]
s_xor_b32 m0, s84, 37888
ds_read_b64_tr_b16 a[102:103], v9 offset:58368
v_subrev_u32 v6, 0x8000, v6
v_mfma_f32_16x16x32_bf16 v[124:127], a[52:55], a[116:119], v[124:127]
s_xor_b32 s64, s70, 41856
ds_read_b64_tr_b16 a[104:105], v10 offset:49152
v_mfma_f32_16x16x32_bf16 v[124:127], a[48:51], a[112:115], v[124:127]
buffer_load_dwordx4 v13, s[32:35], s64 offen lds
v_mfma_f32_16x16x32_bf16 v[108:111], a[40:43], a[112:115], v[108:111]
ds_read_b64_tr_b16 a[106:107], v10 offset:50176
v_mfma_f32_16x16x32_bf16 v[108:111], a[44:47], a[116:119], v[108:111]
ds_read_b64_tr_b16 a[108:109], v10 offset:57344
v_mfma_f32_16x16x32_bf16 v[92:95], a[36:39], a[116:119], v[92:95]
ds_read_b64_tr_b16 a[110:111], v10 offset:58368
v_mfma_f32_16x16x32_bf16 v[92:95], a[32:35], a[112:115], v[92:95]
ds_read_b64_tr_b16 a[112:113], v11 offset:49152
v_mfma_f32_16x16x32_bf16 v[32:35], a[32:35], a[72:75], v[32:35]
s_xor_b32 m0, s84, 38912
ds_read_b64_tr_b16 a[114:115], v11 offset:50176
v_mfma_f32_16x16x32_bf16 v[32:35], a[36:39], a[76:79], v[32:35]
s_xor_b32 s64, s70, 50048
ds_read_b64_tr_b16 a[116:117], v11 offset:57344
v_subrev_u32 v7, 0x8000, v7
v_mfma_f32_16x16x32_bf16 v[48:51], a[44:47], a[76:79], v[48:51]
buffer_load_dwordx4 v12, s[32:35], s64 offen lds
v_mfma_f32_16x16x32_bf16 v[48:51], a[40:43], a[72:75], v[48:51]
ds_read_b64_tr_b16 a[118:119], v11 offset:58368
v_mfma_f32_16x16x32_bf16 v[64:67], a[48:51], a[72:75], v[64:67]
v_mfma_f32_16x16x32_bf16 v[64:67], a[52:55], a[76:79], v[64:67]
v_mfma_f32_16x16x32_bf16 v[80:83], a[60:63], a[76:79], v[80:83]
v_mfma_f32_16x16x32_bf16 v[80:83], a[56:59], a[72:75], v[80:83]
s_xor_b32 m0, s84, 39936
v_mfma_f32_16x16x32_bf16 v[144:147], a[56:59], a[80:83], v[144:147]
s_xor_b32 s64, s70, 58240
v_mfma_f32_16x16x32_bf16 v[144:147], a[60:63], a[84:87], v[144:147]
buffer_load_dwordx4 v13, s[32:35], s64 offen lds
v_mfma_f32_16x16x32_bf16 v[128:131], a[52:55], a[84:87], v[128:131]
v_subrev_u32 v8, 0x8000, v8
v_mfma_f32_16x16x32_bf16 v[128:131], a[48:51], a[80:83], v[128:131]
v_mfma_f32_16x16x32_bf16 v[112:115], a[40:43], a[80:83], v[112:115]
v_mfma_f32_16x16x32_bf16 v[112:115], a[44:47], a[84:87], v[112:115]
v_mfma_f32_16x16x32_bf16 v[96:99], a[36:39], a[84:87], v[96:99]
s_and_b32 s77, s77, 0x3fff
v_subrev_u32 v9, 0x8000, v9
v_subrev_u32 v10, 0x8000, v10
v_mfma_f32_16x16x32_bf16 v[96:99], a[32:35], a[80:83], v[96:99]
s_waitcnt lgkmcnt(0)
v_subrev_u32 v11, 0x8000, v11
v_mfma_f32_16x16x32_bf16 v[36:39], a[32:35], a[88:91], v[36:39]
v_mfma_f32_16x16x32_bf16 v[36:39], a[36:39], a[92:95], v[36:39]
v_mfma_f32_16x16x32_bf16 v[52:55], a[44:47], a[92:95], v[52:55]
s_waitcnt lgkmcnt(0)
s_barrier
v_mfma_f32_16x16x32_bf16 v[52:55], a[40:43], a[88:91], v[52:55]
s_xor_b32 m0, s77, 131072
ds_read_b64_tr_b16 a[72:73], v4 offset:0
v_mfma_f32_16x16x32_bf16 v[68:71], a[48:51], a[88:91], v[68:71]
s_xor_b32 s64, s71, 0
ds_read_b64_tr_b16 a[74:75], v4 offset:1024
v_mfma_f32_16x16x32_bf16 v[68:71], a[52:55], a[92:95], v[68:71]
buffer_load_dwordx4 v14, s[56:59], s64 offen lds
v_mfma_f32_16x16x32_bf16 v[84:87], a[60:63], a[92:95], v[84:87]
ds_read_b64_tr_b16 a[76:77], v4 offset:8192
v_mfma_f32_16x16x32_bf16 v[84:87], a[56:59], a[88:91], v[84:87]
ds_read_b64_tr_b16 a[78:79], v4 offset:9216
v_mfma_f32_16x16x32_bf16 v[148:151], a[56:59], a[96:99], v[148:151]
ds_read_b64_tr_b16 a[80:81], v5 offset:0
v_lshrrev_b32 v13, 3, v0
v_mfma_f32_16x16x32_bf16 v[148:151], a[60:63], a[100:103], v[148:151]
ds_read_b64_tr_b16 a[82:83], v5 offset:1024
v_lshl_add_u32 v12, v13, 10, v12
v_mfma_f32_16x16x32_bf16 v[132:135], a[52:55], a[100:103], v[132:135]
ds_read_b64_tr_b16 a[84:85], v5 offset:8192
v_xor_b32 v13, 64, v12
v_mfma_f32_16x16x32_bf16 v[132:135], a[48:51], a[96:99], v[132:135]
ds_read_b64_tr_b16 a[86:87], v5 offset:9216
v_mfma_f32_16x16x32_bf16 v[116:119], a[40:43], a[96:99], v[116:119]
s_add_u32 m0, s78, 147456
ds_read_b64_tr_b16 a[88:89], v6 offset:0
v_mfma_f32_16x16x32_bf16 v[116:119], a[44:47], a[100:103], v[116:119]
s_add_u32 s64, s75, 0
ds_read_b64_tr_b16 a[90:91], v6 offset:1024
v_mfma_f32_16x16x32_bf16 v[100:103], a[36:39], a[100:103], v[100:103]
buffer_load_dwordx4 v23, s[60:63], s64 offen lds
v_mfma_f32_16x16x32_bf16 v[100:103], a[32:35], a[96:99], v[100:103]
ds_read_b64_tr_b16 a[92:93], v6 offset:8192
v_mfma_f32_16x16x32_bf16 v[248:251], a[32:35], a[104:107], v[248:251]
ds_read_b64_tr_b16 a[94:95], v6 offset:9216
v_mfma_f32_16x16x32_bf16 v[248:251], a[36:39], a[108:111], v[248:251]
ds_read_b64_tr_b16 a[96:97], v7 offset:0
v_mfma_f32_16x16x32_bf16 v[252:255], a[44:47], a[108:111], v[252:255]
ds_read_b64_tr_b16 a[98:99], v7 offset:1024
v_mfma_f32_16x16x32_bf16 v[252:255], a[40:43], a[104:107], v[252:255]
ds_read_b64_tr_b16 a[100:101], v7 offset:8192
v_mfma_f32_16x16x32_bf16 a[120:123], a[48:51], a[104:107], a[120:123]
ds_read_b64_tr_b16 a[102:103], v7 offset:9216
v_mfma_f32_16x16x32_bf16 a[120:123], a[52:55], a[108:111], a[120:123]
s_xor_b32 m0, s77, 132096
v_mfma_f32_16x16x32_bf16 a[124:127], a[60:63], a[108:111], a[124:127]
s_xor_b32 s64, s71, 32768
v_mfma_f32_16x16x32_bf16 a[124:127], a[56:59], a[104:107], a[124:127]
buffer_load_dwordx4 v14, s[56:59], s64 offen lds
v_mfma_f32_16x16x32_bf16 a[128:131], a[56:59], a[112:115], a[128:131]
ds_read_b64_tr_b16 a[104:105], v8 offset:0
v_mfma_f32_16x16x32_bf16 a[128:131], a[60:63], a[116:119], a[128:131]
ds_read_b64_tr_b16 a[106:107], v8 offset:1024
v_mfma_f32_16x16x32_bf16 a[132:135], a[52:55], a[116:119], a[132:135]
ds_read_b64_tr_b16 a[108:109], v8 offset:8192
v_mfma_f32_16x16x32_bf16 a[132:135], a[48:51], a[112:115], a[132:135]
ds_read_b64_tr_b16 a[110:111], v8 offset:9216
v_mfma_f32_16x16x32_bf16 a[136:139], a[40:43], a[112:115], a[136:139]
v_mfma_f32_16x16x32_bf16 a[136:139], a[44:47], a[116:119], a[136:139]
v_mfma_f32_16x16x32_bf16 a[140:143], a[36:39], a[116:119], a[140:143]
s_add_u32 m0, s78, 151552
v_mfma_f32_16x16x32_bf16 a[140:143], a[32:35], a[112:115], a[140:143]
s_waitcnt lgkmcnt(4)
s_add_u32 s64, s75, 2048
ds_read_b64_tr_b16 a[112:113], v9 offset:0
v_mfma_f32_16x16x32_bf16 v[184:187], a[72:75], a[0:3], v[184:187]
buffer_load_dwordx4 v23, s[60:63], s64 offen lds
v_mfma_f32_16x16x32_bf16 v[184:187], a[76:79], a[4:7], v[184:187]
ds_read_b64_tr_b16 a[114:115], v9 offset:1024
v_mfma_f32_16x16x32_bf16 v[192:195], a[76:79], a[12:15], v[192:195]
ds_read_b64_tr_b16 a[116:117], v9 offset:8192
v_mfma_f32_16x16x32_bf16 v[192:195], a[72:75], a[8:11], v[192:195]
ds_read_b64_tr_b16 a[118:119], v9 offset:9216
v_mfma_f32_16x16x32_bf16 v[200:203], a[72:75], a[16:19], v[200:203]
v_mfma_f32_16x16x32_bf16 v[200:203], a[76:79], a[20:23], v[200:203]
v_mfma_f32_16x16x32_bf16 v[208:211], a[76:79], a[28:31], v[208:211]
v_mfma_f32_16x16x32_bf16 v[208:211], a[72:75], a[24:27], v[208:211]
ds_read_b64_tr_b16 a[72:73], v10 offset:0
v_mfma_f32_16x16x32_bf16 v[212:215], a[80:83], a[24:27], v[212:215]
s_xor_b32 m0, s77, 133120
ds_read_b64_tr_b16 a[74:75], v10 offset:1024
v_mfma_f32_16x16x32_bf16 v[212:215], a[84:87], a[28:31], v[212:215]
s_xor_b32 s64, s71, 65536
ds_read_b64_tr_b16 a[76:77], v10 offset:8192
v_mfma_f32_16x16x32_bf16 v[204:207], a[84:87], a[20:23], v[204:207]
buffer_load_dwordx4 v15, s[56:59], s64 offen lds
v_mfma_f32_16x16x32_bf16 v[204:207], a[80:83], a[16:19], v[204:207]
ds_read_b64_tr_b16 a[78:79], v10 offset:9216
v_mfma_f32_16x16x32_bf16 v[196:199], a[80:83], a[8:11], v[196:199]
v_mfma_f32_16x16x32_bf16 v[196:199], a[84:87], a[12:15], v[196:199]
v_mfma_f32_16x16x32_bf16 v[188:191], a[84:87], a[4:7], v[188:191]
v_mfma_f32_16x16x32_bf16 v[188:191], a[80:83], a[0:3], v[188:191]
ds_read_b64_tr_b16 a[80:81], v11 offset:0
v_mfma_f32_16x16x32_bf16 v[216:219], a[88:91], a[0:3], v[216:219]
ds_read_b64_tr_b16 a[82:83], v11 offset:1024
v_mfma_f32_16x16x32_bf16 v[216:219], a[92:95], a[4:7], v[216:219]
s_add_u32 m0, s78, 155648
ds_read_b64_tr_b16 a[84:85], v11 offset:8192
v_mfma_f32_16x16x32_bf16 v[224:227], a[92:95], a[12:15], v[224:227]
s_add_u32 s64, s75, 4096
ds_read_b64_tr_b16 a[86:87], v11 offset:9216
v_mfma_f32_16x16x32_bf16 v[224:227], a[88:91], a[8:11], v[224:227]
buffer_load_dwordx4 v23, s[60:63], s64 offen lds
v_mfma_f32_16x16x32_bf16 v[232:235], a[88:91], a[16:19], v[232:235]
v_mfma_f32_16x16x32_bf16 v[232:235], a[92:95], a[20:23], v[232:235]
v_mfma_f32_16x16x32_bf16 v[240:243], a[92:95], a[28:31], v[240:243]
v_mfma_f32_16x16x32_bf16 v[240:243], a[88:91], a[24:27], v[240:243]
ds_read_b64_tr_b16 a[88:89], v4 offset:16384
v_mfma_f32_16x16x32_bf16 v[244:247], a[96:99], a[24:27], v[244:247]
ds_read_b64_tr_b16 a[90:91], v4 offset:17408
v_mfma_f32_16x16x32_bf16 v[244:247], a[100:103], a[28:31], v[244:247]
ds_read_b64_tr_b16 a[92:93], v4 offset:24576
v_mfma_f32_16x16x32_bf16 v[236:239], a[100:103], a[20:23], v[236:239]
s_xor_b32 m0, s77, 134144
ds_read_b64_tr_b16 a[94:95], v4 offset:25600
v_mfma_f32_16x16x32_bf16 v[236:239], a[96:99], a[16:19], v[236:239]
s_xor_b32 s64, s71, 98304
v_mfma_f32_16x16x32_bf16 v[228:231], a[96:99], a[8:11], v[228:231]
buffer_load_dwordx4 v15, s[56:59], s64 offen lds
v_mfma_f32_16x16x32_bf16 v[228:231], a[100:103], a[12:15], v[228:231]
v_mfma_f32_16x16x32_bf16 v[220:223], a[100:103], a[4:7], v[220:223]
v_mfma_f32_16x16x32_bf16 v[220:223], a[96:99], a[0:3], v[220:223]
s_waitcnt lgkmcnt(4)
ds_read_b64_tr_b16 a[96:97], v5 offset:16384
v_mfma_f32_16x16x32_bf16 v[152:155], a[104:107], a[0:3], v[152:155]
ds_read_b64_tr_b16 a[98:99], v5 offset:17408
v_mfma_f32_16x16x32_bf16 v[152:155], a[108:111], a[4:7], v[152:155]
ds_read_b64_tr_b16 a[100:101], v5 offset:24576
v_mfma_f32_16x16x32_bf16 v[160:163], a[108:111], a[12:15], v[160:163]
ds_read_b64_tr_b16 a[102:103], v5 offset:25600
v_mfma_f32_16x16x32_bf16 v[160:163], a[104:107], a[8:11], v[160:163]
v_mfma_f32_16x16x32_bf16 v[168:171], a[104:107], a[16:19], v[168:171]
v_mfma_f32_16x16x32_bf16 v[168:171], a[108:111], a[20:23], v[168:171]
v_mfma_f32_16x16x32_bf16 v[176:179], a[108:111], a[28:31], v[176:179]
s_xor_b32 m0, s84, 0
v_mfma_f32_16x16x32_bf16 v[176:179], a[104:107], a[24:27], v[176:179]
s_xor_b32 s64, s72, 0
ds_read_b64_tr_b16 a[104:105], v6 offset:16384
v_mfma_f32_16x16x32_bf16 v[180:183], a[112:115], a[24:27], v[180:183]
buffer_load_dwordx4 v12, s[48:51], s64 offen lds
v_mfma_f32_16x16x32_bf16 v[180:183], a[116:119], a[28:31], v[180:183]
ds_read_b64_tr_b16 a[106:107], v6 offset:17408
v_mfma_f32_16x16x32_bf16 v[172:175], a[116:119], a[20:23], v[172:175]
ds_read_b64_tr_b16 a[108:109], v6 offset:24576
v_mfma_f32_16x16x32_bf16 v[172:175], a[112:115], a[16:19], v[172:175]
ds_read_b64_tr_b16 a[110:111], v6 offset:25600
v_mfma_f32_16x16x32_bf16 v[164:167], a[112:115], a[8:11], v[164:167]
v_mfma_f32_16x16x32_bf16 v[164:167], a[116:119], a[12:15], v[164:167]
s_xor_b32 m0, s84, 1024
v_mfma_f32_16x16x32_bf16 v[156:159], a[116:119], a[4:7], v[156:159]
s_xor_b32 s64, s72, 16384
v_mfma_f32_16x16x32_bf16 v[156:159], a[112:115], a[0:3], v[156:159]
buffer_load_dwordx4 v13, s[48:51], s64 offen lds
v_mfma_f32_16x16x32_bf16 v[24:27], a[72:75], a[0:3], v[24:27]
ds_read_b64_tr_b16 a[112:113], v7 offset:16384
v_mfma_f32_16x16x32_bf16 v[24:27], a[76:79], a[4:7], v[24:27]
ds_read_b64_tr_b16 a[114:115], v7 offset:17408
v_mfma_f32_16x16x32_bf16 v[40:43], a[76:79], a[12:15], v[40:43]
ds_read_b64_tr_b16 a[116:117], v7 offset:24576
v_mfma_f32_16x16x32_bf16 v[40:43], a[72:75], a[8:11], v[40:43]
ds_read_b64_tr_b16 a[118:119], v7 offset:25600
v_mfma_f32_16x16x32_bf16 v[56:59], a[72:75], a[16:19], v[56:59]
s_xor_b32 m0, s84, 2048
v_mfma_f32_16x16x32_bf16 v[56:59], a[76:79], a[20:23], v[56:59]
s_xor_b32 s64, s72, 131072
v_mfma_f32_16x16x32_bf16 v[72:75], a[76:79], a[28:31], v[72:75]
s_waitcnt vmcnt(9)
buffer_load_dwordx4 v12, s[48:51], s64 offen lds
v_mfma_f32_16x16x32_bf16 v[72:75], a[72:75], a[24:27], v[72:75]
ds_read_b64_tr_b16 a[72:73], v8 offset:16384
v_mfma_f32_16x16x32_bf16 v[136:139], a[80:83], a[24:27], v[136:139]
ds_read_b64_tr_b16 a[74:75], v8 offset:17408
v_mfma_f32_16x16x32_bf16 v[136:139], a[84:87], a[28:31], v[136:139]
ds_read_b64_tr_b16 a[76:77], v8 offset:24576
v_mfma_f32_16x16x32_bf16 v[120:123], a[84:87], a[20:23], v[120:123]
ds_read_b64_tr_b16 a[78:79], v8 offset:25600
v_mfma_f32_16x16x32_bf16 v[120:123], a[80:83], a[16:19], v[120:123]
s_xor_b32 m0, s84, 3072
ds_read_b128 a[32:35], v2 offset:32768
v_mfma_f32_16x16x32_bf16 v[104:107], a[80:83], a[8:11], v[104:107]
s_xor_b32 s64, s72, 147456
ds_read_b128 a[36:39], v3 offset:32768
v_mfma_f32_16x16x32_bf16 v[104:107], a[84:87], a[12:15], v[104:107]
buffer_load_dwordx4 v13, s[48:51], s64 offen lds
v_mfma_f32_16x16x32_bf16 v[88:91], a[84:87], a[4:7], v[88:91]
ds_read_b128 a[40:43], v2 offset:34816
v_mfma_f32_16x16x32_bf16 v[88:91], a[80:83], a[0:3], v[88:91]
s_waitcnt lgkmcnt(7)
ds_read_b128 a[44:47], v3 offset:34816
v_mfma_f32_16x16x32_bf16 v[28:31], a[0:3], a[88:91], v[28:31]
ds_read_b128 a[48:51], v2 offset:36864
v_mfma_f32_16x16x32_bf16 v[28:31], a[4:7], a[92:95], v[28:31]
ds_read_b128 a[52:55], v3 offset:36864
v_mfma_f32_16x16x32_bf16 v[44:47], a[12:15], a[92:95], v[44:47]
s_xor_b32 m0, s84, 4096
ds_read_b128 a[56:59], v2 offset:38912
v_mfma_f32_16x16x32_bf16 v[44:47], a[8:11], a[88:91], v[44:47]
s_xor_b32 s64, s73, 0
ds_read_b128 a[60:63], v3 offset:38912
v_mfma_f32_16x16x32_bf16 v[60:63], a[16:19], a[88:91], v[60:63]
buffer_load_dwordx4 v12, s[48:51], s64 offen lds
v_mfma_f32_16x16x32_bf16 v[60:63], a[20:23], a[92:95], v[60:63]
ds_read_b64_tr_b16 a[80:81], v9 offset:16384
v_mfma_f32_16x16x32_bf16 v[76:79], a[28:31], a[92:95], v[76:79]
ds_read_b64_tr_b16 a[82:83], v9 offset:17408
v_mfma_f32_16x16x32_bf16 v[76:79], a[24:27], a[88:91], v[76:79]
ds_read_b64_tr_b16 a[84:85], v9 offset:24576
v_mfma_f32_16x16x32_bf16 v[140:143], a[24:27], a[96:99], v[140:143]
ds_read_b64_tr_b16 a[86:87], v9 offset:25600
v_mfma_f32_16x16x32_bf16 v[140:143], a[28:31], a[100:103], v[140:143]
s_xor_b32 m0, s84, 5120
ds_read_b64_tr_b16 a[88:89], v10 offset:16384
v_mfma_f32_16x16x32_bf16 v[124:127], a[20:23], a[100:103], v[124:127]
s_xor_b32 s64, s73, 16384
ds_read_b64_tr_b16 a[90:91], v10 offset:17408
v_mfma_f32_16x16x32_bf16 v[124:127], a[16:19], a[96:99], v[124:127]
buffer_load_dwordx4 v13, s[48:51], s64 offen lds
v_mfma_f32_16x16x32_bf16 v[108:111], a[8:11], a[96:99], v[108:111]
ds_read_b64_tr_b16 a[92:93], v10 offset:24576
v_mfma_f32_16x16x32_bf16 v[108:111], a[12:15], a[100:103], v[108:111]
s_branch L_po5
L_pg5:
s_branch L_pg9
L_po5:
ds_read_b64_tr_b16 a[94:95], v10 offset:25600
v_mfma_f32_16x16x32_bf16 v[92:95], a[4:7], a[100:103], v[92:95]
v_mfma_f32_16x16x32_bf16 v[92:95], a[0:3], a[96:99], v[92:95]
ds_read_b64_tr_b16 a[96:97], v11 offset:16384
v_mfma_f32_16x16x32_bf16 v[32:35], a[0:3], a[104:107], v[32:35]
s_xor_b32 m0, s84, 6144
ds_read_b64_tr_b16 a[98:99], v11 offset:17408
v_mfma_f32_16x16x32_bf16 v[32:35], a[4:7], a[108:111], v[32:35]
s_xor_b32 s64, s73, 131072
ds_read_b64_tr_b16 a[100:101], v11 offset:24576
v_mfma_f32_16x16x32_bf16 v[48:51], a[12:15], a[108:111], v[48:51]
buffer_load_dwordx4 v12, s[48:51], s64 offen lds
v_mfma_f32_16x16x32_bf16 v[48:51], a[8:11], a[104:107], v[48:51]
ds_read_b64_tr_b16 a[102:103], v11 offset:25600
v_mfma_f32_16x16x32_bf16 v[64:67], a[16:19], a[104:107], v[64:67]
v_mfma_f32_16x16x32_bf16 v[64:67], a[20:23], a[108:111], v[64:67]
v_mfma_f32_16x16x32_bf16 v[80:83], a[28:31], a[108:111], v[80:83]
v_mfma_f32_16x16x32_bf16 v[80:83], a[24:27], a[104:107], v[80:83]
s_xor_b32 m0, s84, 7168
v_mfma_f32_16x16x32_bf16 v[144:147], a[24:27], a[112:115], v[144:147]
s_xor_b32 s64, s73, 147456
v_mfma_f32_16x16x32_bf16 v[144:147], a[28:31], a[116:119], v[144:147]
buffer_load_dwordx4 v13, s[48:51], s64 offen lds
v_mfma_f32_16x16x32_bf16 v[128:131], a[20:23], a[116:119], v[128:131]
v_mfma_f32_16x16x32_bf16 v[128:131], a[16:19], a[112:115], v[128:131]
v_mfma_f32_16x16x32_bf16 v[112:115], a[8:11], a[112:115], v[112:115]
v_mfma_f32_16x16x32_bf16 v[112:115], a[12:15], a[116:119], v[112:115]
v_mfma_f32_16x16x32_bf16 v[96:99], a[4:7], a[116:119], v[96:99]
v_mfma_f32_16x16x32_bf16 v[96:99], a[0:3], a[112:115], v[96:99]
s_waitcnt lgkmcnt(0)
v_mfma_f32_16x16x32_bf16 v[36:39], a[0:3], a[72:75], v[36:39]
v_mfma_f32_16x16x32_bf16 v[36:39], a[4:7], a[76:79], v[36:39]
v_mfma_f32_16x16x32_bf16 v[52:55], a[12:15], a[76:79], v[52:55]
s_waitcnt lgkmcnt(0)
s_barrier
v_mfma_f32_16x16x32_bf16 v[52:55], a[8:11], a[72:75], v[52:55]
s_xor_b32 m0, s77, 65536
ds_read_b64_tr_b16 a[104:105], v4 offset:32768
v_mfma_f32_16x16x32_bf16 v[68:71], a[16:19], a[72:75], v[68:71]
s_xor_b32 s64, s71, 524288
ds_read_b64_tr_b16 a[106:107], v4 offset:33792
v_mfma_f32_16x16x32_bf16 v[68:71], a[20:23], a[76:79], v[68:71]
buffer_load_dwordx4 v14, s[56:59], s64 offen lds
v_mfma_f32_16x16x32_bf16 v[84:87], a[28:31], a[76:79], v[84:87]
ds_read_b64_tr_b16 a[108:109], v4 offset:40960
v_mfma_f32_16x16x32_bf16 v[84:87], a[24:27], a[72:75], v[84:87]
ds_read_b64_tr_b16 a[110:111], v4 offset:41984
v_mfma_f32_16x16x32_bf16 v[148:151], a[24:27], a[80:83], v[148:151]
ds_read_b64_tr_b16 a[112:113], v5 offset:32768
v_mfma_f32_16x16x32_bf16 v[148:151], a[28:31], a[84:87], v[148:151]
ds_read_b64_tr_b16 a[114:115], v5 offset:33792
v_mfma_f32_16x16x32_bf16 v[132:135], a[20:23], a[84:87], v[132:135]
ds_read_b64_tr_b16 a[116:117], v5 offset:40960
v_mfma_f32_16x16x32_bf16 v[132:135], a[16:19], a[80:83], v[132:135]
ds_read_b64_tr_b16 a[118:119], v5 offset:41984
v_mfma_f32_16x16x32_bf16 v[116:119], a[8:11], a[80:83], v[116:119]
s_add_u32 m0, s78, 81920
ds_read_b64_tr_b16 a[72:73], v6 offset:32768
v_mfma_f32_16x16x32_bf16 v[116:119], a[12:15], a[84:87], v[116:119]
s_add_u32 s64, s75, 393216
ds_read_b64_tr_b16 a[74:75], v6 offset:33792
v_mfma_f32_16x16x32_bf16 v[100:103], a[4:7], a[84:87], v[100:103]
buffer_load_dwordx4 v23, s[60:63], s64 offen lds
v_mfma_f32_16x16x32_bf16 v[100:103], a[0:3], a[80:83], v[100:103]
ds_read_b64_tr_b16 a[76:77], v6 offset:40960
v_mfma_f32_16x16x32_bf16 v[248:251], a[0:3], a[88:91], v[248:251]
ds_read_b64_tr_b16 a[78:79], v6 offset:41984
v_mfma_f32_16x16x32_bf16 v[248:251], a[4:7], a[92:95], v[248:251]
ds_read_b64_tr_b16 a[80:81], v7 offset:32768
v_mfma_f32_16x16x32_bf16 v[252:255], a[12:15], a[92:95], v[252:255]
ds_read_b64_tr_b16 a[82:83], v7 offset:33792
v_mfma_f32_16x16x32_bf16 v[252:255], a[8:11], a[88:91], v[252:255]
ds_read_b64_tr_b16 a[84:85], v7 offset:40960
v_mfma_f32_16x16x32_bf16 a[120:123], a[16:19], a[88:91], a[120:123]
ds_read_b64_tr_b16 a[86:87], v7 offset:41984
v_mfma_f32_16x16x32_bf16 a[120:123], a[20:23], a[92:95], a[120:123]
s_xor_b32 m0, s77, 66560
v_mfma_f32_16x16x32_bf16 a[124:127], a[28:31], a[92:95], a[124:127]
s_xor_b32 s64, s71, 557056
v_mfma_f32_16x16x32_bf16 a[124:127], a[24:27], a[88:91], a[124:127]
buffer_load_dwordx4 v14, s[56:59], s64 offen lds
v_mfma_f32_16x16x32_bf16 a[128:131], a[24:27], a[96:99], a[128:131]
ds_read_b64_tr_b16 a[88:89], v8 offset:32768
v_mfma_f32_16x16x32_bf16 a[128:131], a[28:31], a[100:103], a[128:131]
ds_read_b64_tr_b16 a[90:91], v8 offset:33792
v_mfma_f32_16x16x32_bf16 a[132:135], a[20:23], a[100:103], a[132:135]
ds_read_b64_tr_b16 a[92:93], v8 offset:40960
v_mfma_f32_16x16x32_bf16 a[132:135], a[16:19], a[96:99], a[132:135]
ds_read_b64_tr_b16 a[94:95], v8 offset:41984
v_mfma_f32_16x16x32_bf16 a[136:139], a[8:11], a[96:99], a[136:139]
v_mfma_f32_16x16x32_bf16 a[136:139], a[12:15], a[100:103], a[136:139]
v_mfma_f32_16x16x32_bf16 a[140:143], a[4:7], a[100:103], a[140:143]
s_add_u32 m0, s78, 86016
v_mfma_f32_16x16x32_bf16 a[140:143], a[0:3], a[96:99], a[140:143]
s_waitcnt lgkmcnt(4)
s_add_u32 s64, s75, 395264
ds_read_b64_tr_b16 a[96:97], v9 offset:32768
v_mfma_f32_16x16x32_bf16 v[184:187], a[104:107], a[32:35], v[184:187]
s_lshl_b32 s66, s30, 30
buffer_load_dwordx4 v23, s[60:63], s64 offen lds
v_mfma_f32_16x16x32_bf16 v[184:187], a[108:111], a[36:39], v[184:187]
ds_read_b64_tr_b16 a[98:99], v9 offset:33792
v_lshl_add_u32 v1, v0, 24, s66
v_mfma_f32_16x16x32_bf16 v[192:195], a[108:111], a[44:47], v[192:195]
s_lshr_b32 s66, s3, 1
ds_read_b64_tr_b16 a[100:101], v9 offset:40960
v_mfma_f32_16x16x32_bf16 v[192:195], a[104:107], a[40:43], v[192:195]
s_lshl_b32 s66, s66, 12
ds_read_b64_tr_b16 a[102:103], v9 offset:41984
v_mfma_f32_16x16x32_bf16 v[200:203], a[104:107], a[48:51], v[200:203]
v_mfma_f32_16x16x32_bf16 v[200:203], a[108:111], a[52:55], v[200:203]
v_mfma_f32_16x16x32_bf16 v[208:211], a[108:111], a[60:63], v[208:211]
v_mfma_f32_16x16x32_bf16 v[208:211], a[104:107], a[56:59], v[208:211]
ds_read_b64_tr_b16 a[104:105], v10 offset:32768
v_mfma_f32_16x16x32_bf16 v[212:215], a[112:115], a[56:59], v[212:215]
s_xor_b32 m0, s77, 67584
ds_read_b64_tr_b16 a[106:107], v10 offset:33792
v_mfma_f32_16x16x32_bf16 v[212:215], a[116:119], a[60:63], v[212:215]
s_xor_b32 s64, s71, 589824
ds_read_b64_tr_b16 a[108:109], v10 offset:40960
v_mfma_f32_16x16x32_bf16 v[204:207], a[116:119], a[52:55], v[204:207]
buffer_load_dwordx4 v15, s[56:59], s64 offen lds
v_mfma_f32_16x16x32_bf16 v[204:207], a[112:115], a[48:51], v[204:207]
ds_read_b64_tr_b16 a[110:111], v10 offset:41984
v_mfma_f32_16x16x32_bf16 v[196:199], a[112:115], a[40:43], v[196:199]
v_mfma_f32_16x16x32_bf16 v[196:199], a[116:119], a[44:47], v[196:199]
v_mfma_f32_16x16x32_bf16 v[188:191], a[116:119], a[36:39], v[188:191]
v_mfma_f32_16x16x32_bf16 v[188:191], a[112:115], a[32:35], v[188:191]
s_add_u32 s67, s79, 20480
ds_read_b64_tr_b16 a[112:113], v11 offset:32768
v_mfma_f32_16x16x32_bf16 v[216:219], a[72:75], a[32:35], v[216:219]
ds_read_b64_tr_b16 a[114:115], v11 offset:33792
v_mfma_f32_16x16x32_bf16 v[216:219], a[76:79], a[36:39], v[216:219]
s_add_u32 m0, s78, 90112
ds_read_b64_tr_b16 a[116:117], v11 offset:40960
v_cvt_pk_bf16_f32 v215, v214, v215
v_mfma_f32_16x16x32_bf16 v[224:227], a[76:79], a[44:47], v[224:227]
s_add_u32 s64, s75, 397312
ds_read_b64_tr_b16 a[118:119], v11 offset:41984
v_cvt_pk_bf16_f32 v214, v212, v213
v_mfma_f32_16x16x32_bf16 v[224:227], a[72:75], a[40:43], v[224:227]
buffer_load_dwordx4 v23, s[60:63], s64 offen lds
v_mfma_f32_16x16x32_bf16 v[232:235], a[72:75], a[48:51], v[232:235]
v_cvt_pk_bf16_f32 v212, v208, v209
v_cvt_pk_bf16_f32 v213, v210, v211
v_mfma_f32_16x16x32_bf16 v[232:235], a[76:79], a[52:55], v[232:235]
buffer_store_dwordx4 v[212:215], v16, s[44:47], s67 offen sc1
v_mfma_f32_16x16x32_bf16 v[240:243], a[76:79], a[60:63], v[240:243]
v_cvt_pk_bf16_f32 v207, v206, v207
v_cvt_pk_bf16_f32 v206, v204, v205
v_mfma_f32_16x16x32_bf16 v[240:243], a[72:75], a[56:59], v[240:243]
ds_read_b64_tr_b16 a[72:73], v4 offset:49152
v_cvt_pk_bf16_f32 v204, v200, v201
v_mfma_f32_16x16x32_bf16 v[244:247], a[80:83], a[56:59], v[244:247]
ds_read_b64_tr_b16 a[74:75], v4 offset:50176
v_cvt_pk_bf16_f32 v205, v202, v203
v_mfma_f32_16x16x32_bf16 v[244:247], a[84:87], a[60:63], v[244:247]
ds_read_b64_tr_b16 a[76:77], v4 offset:57344
v_accvgpr_write_b32 a144, v204
v_mfma_f32_16x16x32_bf16 v[236:239], a[84:87], a[52:55], v[236:239]
s_xor_b32 m0, s77, 68608
ds_read_b64_tr_b16 a[78:79], v4 offset:58368
v_accvgpr_write_b32 a145, v205
v_mfma_f32_16x16x32_bf16 v[236:239], a[80:83], a[48:51], v[236:239]
s_xor_b32 s64, s71, 622592
v_accvgpr_write_b32 a146, v206
v_accvgpr_write_b32 a147, v207
v_mfma_f32_16x16x32_bf16 v[228:231], a[80:83], a[40:43], v[228:231]
buffer_load_dwordx4 v15, s[56:59], s64 offen lds
v_mfma_f32_16x16x32_bf16 v[228:231], a[84:87], a[44:47], v[228:231]
v_cvt_pk_bf16_f32 v199, v198, v199
v_cvt_pk_bf16_f32 v198, v196, v197
v_mfma_f32_16x16x32_bf16 v[220:223], a[84:87], a[36:39], v[220:223]
v_cvt_pk_bf16_f32 v196, v192, v193
v_cvt_pk_bf16_f32 v197, v194, v195
v_mfma_f32_16x16x32_bf16 v[220:223], a[80:83], a[32:35], v[220:223]
s_waitcnt lgkmcnt(4)
ds_read_b64_tr_b16 a[80:81], v5 offset:49152
v_accvgpr_write_b32 a148, v196
v_mfma_f32_16x16x32_bf16 v[152:155], a[88:91], a[32:35], v[152:155]
ds_read_b64_tr_b16 a[82:83], v5 offset:50176
v_accvgpr_write_b32 a149, v197
v_mfma_f32_16x16x32_bf16 v[152:155], a[92:95], a[36:39], v[152:155]
ds_read_b64_tr_b16 a[84:85], v5 offset:57344
v_accvgpr_write_b32 a150, v198
v_mfma_f32_16x16x32_bf16 v[160:163], a[92:95], a[44:47], v[160:163]
ds_read_b64_tr_b16 a[86:87], v5 offset:58368
v_accvgpr_write_b32 a151, v199
v_mfma_f32_16x16x32_bf16 v[160:163], a[88:91], a[40:43], v[160:163]
v_cvt_pk_bf16_f32 v191, v190, v191
v_cvt_pk_bf16_f32 v190, v188, v189
v_mfma_f32_16x16x32_bf16 v[168:171], a[88:91], a[48:51], v[168:171]
v_cvt_pk_bf16_f32 v188, v184, v185
v_cvt_pk_bf16_f32 v189, v186, v187
v_mfma_f32_16x16x32_bf16 v[168:171], a[92:95], a[52:55], v[168:171]
v_accvgpr_write_b32 a152, v188
v_accvgpr_write_b32 a153, v189
v_mfma_f32_16x16x32_bf16 v[176:179], a[92:95], a[60:63], v[176:179]
s_xor_b32 m0, s84, 32768
v_accvgpr_write_b32 a154, v190
v_accvgpr_write_b32 a155, v191
v_mfma_f32_16x16x32_bf16 v[176:179], a[88:91], a[56:59], v[176:179]
s_add_u32 s67, s79, 21504
s_xor_b32 s64, s72, 128
ds_read_b64_tr_b16 a[88:89], v6 offset:49152
v_cvt_pk_bf16_f32 v247, v246, v247
v_mfma_f32_16x16x32_bf16 v[180:183], a[96:99], a[56:59], v[180:183]
buffer_load_dwordx4 v12, s[48:51], s64 offen lds
v_mfma_f32_16x16x32_bf16 v[180:183], a[100:103], a[60:63], v[180:183]
ds_read_b64_tr_b16 a[90:91], v6 offset:50176
v_cvt_pk_bf16_f32 v246, v244, v245
v_mfma_f32_16x16x32_bf16 v[172:175], a[100:103], a[52:55], v[172:175]
ds_read_b64_tr_b16 a[92:93], v6 offset:57344
v_cvt_pk_bf16_f32 v244, v240, v241
v_mfma_f32_16x16x32_bf16 v[172:175], a[96:99], a[48:51], v[172:175]
ds_read_b64_tr_b16 a[94:95], v6 offset:58368
v_cvt_pk_bf16_f32 v245, v242, v243
v_mfma_f32_16x16x32_bf16 v[164:167], a[96:99], a[40:43], v[164:167]
buffer_store_dwordx4 v[244:247], v16, s[44:47], s67 offen sc1
v_mfma_f32_16x16x32_bf16 v[164:167], a[100:103], a[44:47], v[164:167]
s_xor_b32 m0, s84, 33792
v_cvt_pk_bf16_f32 v239, v238, v239
v_cvt_pk_bf16_f32 v238, v236, v237
v_mfma_f32_16x16x32_bf16 v[156:159], a[100:103], a[36:39], v[156:159]
s_xor_b32 s64, s72, 16512
v_cvt_pk_bf16_f32 v236, v232, v233
v_cvt_pk_bf16_f32 v237, v234, v235
v_mfma_f32_16x16x32_bf16 v[156:159], a[96:99], a[32:35], v[156:159]
buffer_load_dwordx4 v13, s[48:51], s64 offen lds
v_mfma_f32_16x16x32_bf16 v[24:27], a[104:107], a[32:35], v[24:27]
ds_read_b64_tr_b16 a[96:97], v7 offset:49152
v_accvgpr_write_b32 a156, v236
v_mfma_f32_16x16x32_bf16 v[24:27], a[108:111], a[36:39], v[24:27]
ds_read_b64_tr_b16 a[98:99], v7 offset:50176
v_accvgpr_write_b32 a157, v237
v_mfma_f32_16x16x32_bf16 v[40:43], a[108:111], a[44:47], v[40:43]
ds_read_b64_tr_b16 a[100:101], v7 offset:57344
v_accvgpr_write_b32 a158, v238
v_mfma_f32_16x16x32_bf16 v[40:43], a[104:107], a[40:43], v[40:43]
ds_read_b64_tr_b16 a[102:103], v7 offset:58368
v_accvgpr_write_b32 a159, v239
v_mfma_f32_16x16x32_bf16 v[56:59], a[104:107], a[48:51], v[56:59]
s_xor_b32 m0, s84, 34816
v_cvt_pk_bf16_f32 v231, v230, v231
v_cvt_pk_bf16_f32 v230, v228, v229
v_mfma_f32_16x16x32_bf16 v[56:59], a[108:111], a[52:55], v[56:59]
s_xor_b32 s64, s72, 131200
v_cvt_pk_bf16_f32 v228, v224, v225
v_cvt_pk_bf16_f32 v229, v226, v227
v_mfma_f32_16x16x32_bf16 v[72:75], a[108:111], a[60:63], v[72:75]
s_waitcnt vmcnt(11)
buffer_load_dwordx4 v12, s[48:51], s64 offen lds
v_mfma_f32_16x16x32_bf16 v[72:75], a[104:107], a[56:59], v[72:75]
ds_read_b64_tr_b16 a[104:105], v8 offset:49152
v_accvgpr_write_b32 a160, v228
v_mfma_f32_16x16x32_bf16 v[136:139], a[112:115], a[56:59], v[136:139]
ds_read_b64_tr_b16 a[106:107], v8 offset:50176
v_accvgpr_write_b32 a161, v229
v_mfma_f32_16x16x32_bf16 v[136:139], a[116:119], a[60:63], v[136:139]
ds_read_b64_tr_b16 a[108:109], v8 offset:57344
v_add_u32 v4, 0x8000, v4
v_mfma_f32_16x16x32_bf16 v[120:123], a[116:119], a[52:55], v[120:123]
ds_read_b64_tr_b16 a[110:111], v8 offset:58368
v_accvgpr_write_b32 a162, v230
v_mfma_f32_16x16x32_bf16 v[120:123], a[112:115], a[48:51], v[120:123]
s_xor_b32 m0, s84, 35840
ds_read_b128 a[0:3], v2 offset:0
v_accvgpr_write_b32 a163, v231
v_mfma_f32_16x16x32_bf16 v[104:107], a[112:115], a[40:43], v[104:107]
s_xor_b32 s64, s72, 147584
ds_read_b128 a[4:7], v3 offset:0
v_cvt_pk_bf16_f32 v223, v222, v223
v_mfma_f32_16x16x32_bf16 v[104:107], a[116:119], a[44:47], v[104:107]
buffer_load_dwordx4 v13, s[48:51], s64 offen lds
v_mfma_f32_16x16x32_bf16 v[88:91], a[116:119], a[36:39], v[88:91]
ds_read_b128 a[8:11], v2 offset:2048
v_cvt_pk_bf16_f32 v222, v220, v221
v_mfma_f32_16x16x32_bf16 v[88:91], a[112:115], a[32:35], v[88:91]
s_waitcnt lgkmcnt(7)
ds_read_b128 a[12:15], v3 offset:2048
v_cvt_pk_bf16_f32 v220, v216, v217
v_mfma_f32_16x16x32_bf16 v[28:31], a[32:35], a[72:75], v[28:31]
ds_read_b128 a[16:19], v2 offset:4096
v_cvt_pk_bf16_f32 v221, v218, v219
v_mfma_f32_16x16x32_bf16 v[28:31], a[36:39], a[76:79], v[28:31]
ds_read_b128 a[20:23], v3 offset:4096
v_add_u32 v5, 0x8000, v5
v_mfma_f32_16x16x32_bf16 v[44:47], a[44:47], a[76:79], v[44:47]
s_xor_b32 m0, s84, 36864
ds_read_b128 a[24:27], v2 offset:6144
v_accvgpr_write_b32 a164, v220
v_mfma_f32_16x16x32_bf16 v[44:47], a[40:43], a[72:75], v[44:47]
s_xor_b32 s64, s73, 128
ds_read_b128 a[28:31], v3 offset:6144
v_accvgpr_write_b32 a165, v221
v_mfma_f32_16x16x32_bf16 v[60:63], a[48:51], a[72:75], v[60:63]
buffer_load_dwordx4 v12, s[48:51], s64 offen lds
v_mfma_f32_16x16x32_bf16 v[60:63], a[52:55], a[76:79], v[60:63]
ds_read_b64_tr_b16 a[112:113], v9 offset:49152
v_accvgpr_write_b32 a166, v222
v_mfma_f32_16x16x32_bf16 v[76:79], a[60:63], a[76:79], v[76:79]
ds_read_b64_tr_b16 a[114:115], v9 offset:50176
v_accvgpr_write_b32 a167, v223
v_mfma_f32_16x16x32_bf16 v[76:79], a[56:59], a[72:75], v[76:79]
s_add_u32 s67, s79, 22528
ds_read_b64_tr_b16 a[116:117], v9 offset:57344
v_cvt_pk_bf16_f32 v183, v182, v183
v_mfma_f32_16x16x32_bf16 v[140:143], a[56:59], a[80:83], v[140:143]
ds_read_b64_tr_b16 a[118:119], v9 offset:58368
v_cvt_pk_bf16_f32 v182, v180, v181
v_mfma_f32_16x16x32_bf16 v[140:143], a[60:63], a[84:87], v[140:143]
s_xor_b32 m0, s84, 37888
ds_read_b64_tr_b16 a[72:73], v10 offset:49152
v_add_u32 v6, 0x8000, v6
v_mfma_f32_16x16x32_bf16 v[124:127], a[52:55], a[84:87], v[124:127]
s_xor_b32 s64, s73, 16512
ds_read_b64_tr_b16 a[74:75], v10 offset:50176
v_cvt_pk_bf16_f32 v180, v176, v177
v_mfma_f32_16x16x32_bf16 v[124:127], a[48:51], a[80:83], v[124:127]
buffer_load_dwordx4 v13, s[48:51], s64 offen lds
v_mfma_f32_16x16x32_bf16 v[108:111], a[40:43], a[80:83], v[108:111]
ds_read_b64_tr_b16 a[76:77], v10 offset:57344
v_cvt_pk_bf16_f32 v181, v178, v179
v_mfma_f32_16x16x32_bf16 v[108:111], a[44:47], a[84:87], v[108:111]
ds_read_b64_tr_b16 a[78:79], v10 offset:58368
v_mfma_f32_16x16x32_bf16 v[92:95], a[36:39], a[84:87], v[92:95]
buffer_store_dwordx4 v[180:183], v16, s[44:47], s67 offen sc1
v_mfma_f32_16x16x32_bf16 v[92:95], a[32:35], a[80:83], v[92:95]
ds_read_b64_tr_b16 a[80:81], v11 offset:49152
v_cvt_pk_bf16_f32 v175, v174, v175
v_mfma_f32_16x16x32_bf16 v[32:35], a[32:35], a[88:91], v[32:35]
s_xor_b32 m0, s84, 38912
ds_read_b64_tr_b16 a[82:83], v11 offset:50176
v_cvt_pk_bf16_f32 v174, v172, v173
v_mfma_f32_16x16x32_bf16 v[32:35], a[36:39], a[92:95], v[32:35]
s_xor_b32 s64, s73, 131200
ds_read_b64_tr_b16 a[84:85], v11 offset:57344
v_add_u32 v7, 0x8000, v7
v_mfma_f32_16x16x32_bf16 v[48:51], a[44:47], a[92:95], v[48:51]
buffer_load_dwordx4 v12, s[48:51], s64 offen lds
v_mfma_f32_16x16x32_bf16 v[48:51], a[40:43], a[88:91], v[48:51]
ds_read_b64_tr_b16 a[86:87], v11 offset:58368
v_cvt_pk_bf16_f32 v172, v168, v169
v_mfma_f32_16x16x32_bf16 v[64:67], a[48:51], a[88:91], v[64:67]
v_cvt_pk_bf16_f32 v173, v170, v171
v_accvgpr_write_b32 a168, v172
v_mfma_f32_16x16x32_bf16 v[64:67], a[52:55], a[92:95], v[64:67]
v_accvgpr_write_b32 a169, v173
v_accvgpr_write_b32 a170, v174
v_mfma_f32_16x16x32_bf16 v[80:83], a[60:63], a[92:95], v[80:83]
v_accvgpr_write_b32 a171, v175
v_cvt_pk_bf16_f32 v167, v166, v167
v_mfma_f32_16x16x32_bf16 v[80:83], a[56:59], a[88:91], v[80:83]
s_xor_b32 m0, s84, 39936
v_cvt_pk_bf16_f32 v166, v164, v165
v_cvt_pk_bf16_f32 v164, v160, v161
v_mfma_f32_16x16x32_bf16 v[144:147], a[56:59], a[96:99], v[144:147]
s_xor_b32 s64, s73, 147584
v_cvt_pk_bf16_f32 v165, v162, v163
v_accvgpr_write_b32 a172, v164
v_mfma_f32_16x16x32_bf16 v[144:147], a[60:63], a[100:103], v[144:147]
buffer_load_dwordx4 v13, s[48:51], s64 offen lds
v_mfma_f32_16x16x32_bf16 v[128:131], a[52:55], a[100:103], v[128:131]
v_add_u32 v8, 0x8000, v8
v_accvgpr_write_b32 a173, v165
v_mfma_f32_16x16x32_bf16 v[128:131], a[48:51], a[96:99], v[128:131]
v_accvgpr_write_b32 a174, v166
v_accvgpr_write_b32 a175, v167
v_mfma_f32_16x16x32_bf16 v[112:115], a[40:43], a[96:99], v[112:115]
v_cvt_pk_bf16_f32 v159, v158, v159
v_cvt_pk_bf16_f32 v158, v156, v157
v_mfma_f32_16x16x32_bf16 v[112:115], a[44:47], a[100:103], v[112:115]
v_cvt_pk_bf16_f32 v156, v152, v153
v_cvt_pk_bf16_f32 v157, v154, v155
v_mfma_f32_16x16x32_bf16 v[96:99], a[36:39], a[100:103], v[96:99]
v_add_u32 v9, 0x8000, v9
v_add_u32 v10, 0x8000, v10
v_mfma_f32_16x16x32_bf16 v[96:99], a[32:35], a[96:99], v[96:99]
s_waitcnt lgkmcnt(0)
v_add_u32 v11, 0x8000, v11
v_accvgpr_write_b32 a176, v156
v_mfma_f32_16x16x32_bf16 v[36:39], a[32:35], a[104:107], v[36:39]
v_accvgpr_write_b32 a177, v157
v_accvgpr_write_b32 a178, v158
v_mfma_f32_16x16x32_bf16 v[36:39], a[36:39], a[108:111], v[36:39]
v_accvgpr_write_b32 a179, v159
v_mfma_f32_16x16x32_bf16 v[52:55], a[44:47], a[108:111], v[52:55]
s_add_u32 s67, s79, 23552
s_waitcnt lgkmcnt(0)
s_barrier
v_mfma_f32_16x16x32_bf16 v[52:55], a[40:43], a[104:107], v[52:55]
s_xor_b32 m0, s77, 98304
ds_read_b64_tr_b16 a[88:89], v19 offset:36864
v_cvt_pk_bf16_f32 v139, v138, v139
v_mfma_f32_16x16x32_bf16 v[68:71], a[48:51], a[104:107], v[68:71]
s_xor_b32 s64, s71, 1048576
ds_read_b64_tr_b16 a[90:91], v19 offset:37120
v_cvt_pk_bf16_f32 v138, v136, v137
v_mfma_f32_16x16x32_bf16 v[68:71], a[52:55], a[108:111], v[68:71]
buffer_load_dwordx4 v14, s[56:59], s64 offen lds
v_mfma_f32_16x16x32_bf16 v[84:87], a[60:63], a[108:111], v[84:87]
ds_read_b64_tr_b16 a[92:93], v19 offset:38912
v_cvt_pk_bf16_f32 v136, v72, v73
v_mfma_f32_16x16x32_bf16 v[84:87], a[56:59], a[104:107], v[84:87]
ds_read_b64_tr_b16 a[94:95], v19 offset:39168
v_cvt_pk_bf16_f32 v137, v74, v75
v_mfma_f32_16x16x32_bf16 v[148:151], a[56:59], a[112:115], v[148:151]
ds_read_b64_tr_b16 a[96:97], v20 offset:36864
v_mfma_f32_16x16x32_bf16 v[148:151], a[60:63], a[116:119], v[148:151]
ds_read_b64_tr_b16 a[98:99], v20 offset:37120
v_mfma_f32_16x16x32_bf16 v[132:135], a[52:55], a[116:119], v[132:135]
ds_read_b64_tr_b16 a[100:101], v20 offset:38912
v_mfma_f32_16x16x32_bf16 v[132:135], a[48:51], a[112:115], v[132:135]
ds_read_b64_tr_b16 a[102:103], v20 offset:39168
v_mfma_f32_16x16x32_bf16 v[116:119], a[40:43], a[112:115], v[116:119]
s_add_u32 m0, s78, 114688
ds_read_b64_tr_b16 a[104:105], v19 offset:40960
v_mfma_f32_16x16x32_bf16 v[116:119], a[44:47], a[116:119], v[116:119]
s_add_u32 s64, s75, 786432
ds_read_b64_tr_b16 a[106:107], v19 offset:41216
v_mfma_f32_16x16x32_bf16 v[100:103], a[36:39], a[116:119], v[100:103]
buffer_load_dwordx4 v23, s[60:63], s64 offen lds
v_mfma_f32_16x16x32_bf16 v[100:103], a[32:35], a[112:115], v[100:103]
ds_read_b64_tr_b16 a[108:109], v19 offset:43008
v_mfma_f32_16x16x32_bf16 v[248:251], a[32:35], a[72:75], v[248:251]
ds_read_b64_tr_b16 a[110:111], v19 offset:43264
v_mfma_f32_16x16x32_bf16 v[248:251], a[36:39], a[76:79], v[248:251]
ds_read_b64_tr_b16 a[112:113], v20 offset:40960
v_mfma_f32_16x16x32_bf16 v[252:255], a[44:47], a[76:79], v[252:255]
ds_read_b64_tr_b16 a[114:115], v20 offset:41216
v_mfma_f32_16x16x32_bf16 v[252:255], a[40:43], a[72:75], v[252:255]
ds_read_b64_tr_b16 a[116:117], v20 offset:43008
v_mfma_f32_16x16x32_bf16 a[120:123], a[48:51], a[72:75], a[120:123]
ds_read_b64_tr_b16 a[118:119], v20 offset:43264
v_mfma_f32_16x16x32_bf16 a[120:123], a[52:55], a[76:79], a[120:123]
s_xor_b32 m0, s77, 99328
buffer_store_dwordx4 v[136:139], v16, s[44:47], s67 offen sc1
v_mfma_f32_16x16x32_bf16 a[124:127], a[60:63], a[76:79], a[124:127]
s_xor_b32 s64, s71, 1081344
v_cvt_pk_bf16_f32 v123, v122, v123
v_cvt_pk_bf16_f32 v122, v120, v121
v_mfma_f32_16x16x32_bf16 a[124:127], a[56:59], a[72:75], a[124:127]
buffer_load_dwordx4 v14, s[56:59], s64 offen lds
v_mfma_f32_16x16x32_bf16 a[128:131], a[56:59], a[80:83], a[128:131]
ds_read_b64_tr_b16 a[72:73], v19 offset:32768
v_cvt_pk_bf16_f32 v120, v56, v57
v_mfma_f32_16x16x32_bf16 a[128:131], a[60:63], a[84:87], a[128:131]
ds_read_b64_tr_b16 a[74:75], v19 offset:33024
v_cvt_pk_bf16_f32 v121, v58, v59
v_mfma_f32_16x16x32_bf16 a[132:135], a[52:55], a[84:87], a[132:135]
ds_read_b64_tr_b16 a[76:77], v19 offset:34816
v_accvgpr_write_b32 a180, v120
v_mfma_f32_16x16x32_bf16 a[132:135], a[48:51], a[80:83], a[132:135]
ds_read_b64_tr_b16 a[78:79], v19 offset:35072
v_accvgpr_write_b32 a181, v121
v_mfma_f32_16x16x32_bf16 a[136:139], a[40:43], a[80:83], a[136:139]
v_accvgpr_write_b32 a182, v122
v_accvgpr_write_b32 a183, v123
v_mfma_f32_16x16x32_bf16 a[136:139], a[44:47], a[84:87], a[136:139]
v_cvt_pk_bf16_f32 v107, v106, v107
v_cvt_pk_bf16_f32 v106, v104, v105
v_mfma_f32_16x16x32_bf16 a[140:143], a[36:39], a[84:87], a[140:143]
s_add_u32 m0, s78, 118784
v_cvt_pk_bf16_f32 v104, v40, v41
v_cvt_pk_bf16_f32 v105, v42, v43
v_mfma_f32_16x16x32_bf16 a[140:143], a[32:35], a[80:83], a[140:143]
s_waitcnt lgkmcnt(4)
s_add_u32 s64, s75, 788480
ds_read_b64_tr_b16 a[80:81], v20 offset:32768
v_accvgpr_write_b32 a184, v104
v_mfma_f32_16x16x32_bf16 v[184:187], a[88:91], a[0:3], 0
buffer_load_dwordx4 v23, s[60:63], s64 offen lds
v_mfma_f32_16x16x32_bf16 v[184:187], a[92:95], a[4:7], v[184:187]
ds_read_b64_tr_b16 a[82:83], v20 offset:33024
v_accvgpr_write_b32 a185, v105
v_mfma_f32_16x16x32_bf16 v[192:195], a[92:95], a[12:15], 0
ds_read_b64_tr_b16 a[84:85], v20 offset:34816
v_accvgpr_write_b32 a186, v106
v_mfma_f32_16x16x32_bf16 v[192:195], a[88:91], a[8:11], v[192:195]
ds_read_b64_tr_b16 a[86:87], v20 offset:35072
v_accvgpr_write_b32 a187, v107
v_mfma_f32_16x16x32_bf16 v[200:203], a[88:91], a[16:19], 0
v_cvt_pk_bf16_f32 v91, v90, v91
v_cvt_pk_bf16_f32 v90, v88, v89
v_mfma_f32_16x16x32_bf16 v[200:203], a[92:95], a[20:23], v[200:203]
v_cvt_pk_bf16_f32 v88, v24, v25
v_cvt_pk_bf16_f32 v89, v26, v27
v_mfma_f32_16x16x32_bf16 v[208:211], a[92:95], a[28:31], 0
v_accvgpr_write_b32 a188, v88
v_accvgpr_write_b32 a189, v89
v_mfma_f32_16x16x32_bf16 v[208:211], a[88:91], a[24:27], v[208:211]
s_xor_b32 m0, s77, 100352
ds_read_b64_tr_b16 a[88:89], v4 offset:32768
v_accvgpr_write_b32 a190, v90
v_mfma_f32_16x16x32_bf16 v[212:215], a[96:99], a[24:27], 0
s_xor_b32 s64, s71, 1114112
ds_read_b64_tr_b16 a[90:91], v4 offset:33792
v_accvgpr_write_b32 a191, v91
v_mfma_f32_16x16x32_bf16 v[212:215], a[100:103], a[28:31], v[212:215]
s_add_u32 s67, s79, 8192
ds_read_b64_tr_b16 a[92:93], v4 offset:40960
v_cvt_pk_bf16_f32 v47, v46, v47
v_mfma_f32_16x16x32_bf16 v[204:207], a[100:103], a[20:23], 0
buffer_load_dwordx4 v15, s[56:59], s64 offen lds
v_mfma_f32_16x16x32_bf16 v[204:207], a[96:99], a[16:19], v[204:207]
ds_read_b64_tr_b16 a[94:95], v4 offset:41984
v_cvt_pk_bf16_f32 v46, v44, v45
v_mfma_f32_16x16x32_bf16 v[196:199], a[96:99], a[8:11], 0
v_cvt_pk_bf16_f32 v44, v28, v29
v_cvt_pk_bf16_f32 v45, v30, v31
v_mfma_f32_16x16x32_bf16 v[196:199], a[100:103], a[12:15], v[196:199]
buffer_store_dwordx4 v[44:47], v16, s[44:47], s67 offen sc1
v_mfma_f32_16x16x32_bf16 v[188:191], a[100:103], a[4:7], 0
v_cvt_pk_bf16_f32 v79, v78, v79
v_cvt_pk_bf16_f32 v78, v76, v77
v_mfma_f32_16x16x32_bf16 v[188:191], a[96:99], a[0:3], v[188:191]
ds_read_b64_tr_b16 a[96:97], v5 offset:32768
v_cvt_pk_bf16_f32 v76, v60, v61
v_mfma_f32_16x16x32_bf16 v[216:219], a[0:3], a[104:107], 0
s_branch L_po6
L_pg6:
s_branch L_pg10
L_po6:
ds_read_b64_tr_b16 a[98:99], v5 offset:33792
v_cvt_pk_bf16_f32 v77, v62, v63
v_mfma_f32_16x16x32_bf16 v[216:219], a[4:7], a[108:111], v[216:219]
s_add_u32 m0, s78, 122880
ds_read_b64_tr_b16 a[100:101], v5 offset:40960
v_accvgpr_write_b32 a192, v76
v_mfma_f32_16x16x32_bf16 v[224:227], a[12:15], a[108:111], 0
s_add_u32 s64, s75, 790528
ds_read_b64_tr_b16 a[102:103], v5 offset:41984
v_accvgpr_write_b32 a193, v77
v_mfma_f32_16x16x32_bf16 v[224:227], a[8:11], a[104:107], v[224:227]
buffer_load_dwordx4 v23, s[60:63], s64 offen lds
v_mfma_f32_16x16x32_bf16 v[232:235], a[16:19], a[104:107], 0
v_accvgpr_write_b32 a194, v78
v_accvgpr_write_b32 a195, v79
v_mfma_f32_16x16x32_bf16 v[232:235], a[20:23], a[108:111], v[232:235]
v_cvt_pk_bf16_f32 v124, v124, v125
v_cvt_pk_bf16_f32 v125, v126, v127
v_mfma_f32_16x16x32_bf16 v[240:243], a[28:31], a[108:111], 0
v_cvt_pk_bf16_f32 v126, v140, v141
v_cvt_pk_bf16_f32 v127, v142, v143
v_mfma_f32_16x16x32_bf16 v[240:243], a[24:27], a[104:107], v[240:243]
ds_read_b64_tr_b16 a[104:105], v6 offset:32768
v_accvgpr_write_b32 a196, v124
v_mfma_f32_16x16x32_bf16 v[244:247], a[24:27], a[112:115], 0
ds_read_b64_tr_b16 a[106:107], v6 offset:33792
v_accvgpr_write_b32 a197, v125
v_mfma_f32_16x16x32_bf16 v[244:247], a[28:31], a[116:119], v[244:247]
ds_read_b64_tr_b16 a[108:109], v6 offset:40960
v_accvgpr_write_b32 a198, v126
v_mfma_f32_16x16x32_bf16 v[236:239], a[20:23], a[116:119], 0
s_xor_b32 m0, s77, 101376
ds_read_b64_tr_b16 a[110:111], v6 offset:41984
v_accvgpr_write_b32 a199, v127
v_mfma_f32_16x16x32_bf16 v[236:239], a[16:19], a[112:115], v[236:239]
s_xor_b32 s64, s71, 1146880
v_cvt_pk_bf16_f32 v92, v92, v93
v_cvt_pk_bf16_f32 v93, v94, v95
v_mfma_f32_16x16x32_bf16 v[228:231], a[8:11], a[112:115], 0
buffer_load_dwordx4 v15, s[56:59], s64 offen lds
v_mfma_f32_16x16x32_bf16 v[228:231], a[12:15], a[116:119], v[228:231]
v_cvt_pk_bf16_f32 v94, v108, v109
v_cvt_pk_bf16_f32 v95, v110, v111
v_mfma_f32_16x16x32_bf16 v[220:223], a[4:7], a[116:119], 0
v_accvgpr_write_b32 a200, v92
v_accvgpr_write_b32 a201, v93
v_mfma_f32_16x16x32_bf16 v[220:223], a[0:3], a[112:115], v[220:223]
s_waitcnt lgkmcnt(4)
ds_read_b64_tr_b16 a[112:113], v7 offset:32768
v_accvgpr_write_b32 a202, v94
v_mfma_f32_16x16x32_bf16 v[152:155], a[72:75], a[0:3], 0
ds_read_b64_tr_b16 a[114:115], v7 offset:33792
v_accvgpr_write_b32 a203, v95
v_mfma_f32_16x16x32_bf16 v[152:155], a[76:79], a[4:7], v[152:155]
s_add_u32 s67, s79, 10240
ds_read_b64_tr_b16 a[116:117], v7 offset:40960
v_cvt_pk_bf16_f32 v51, v50, v51
v_mfma_f32_16x16x32_bf16 v[160:163], a[76:79], a[12:15], 0
ds_read_b64_tr_b16 a[118:119], v7 offset:41984
v_cvt_pk_bf16_f32 v50, v48, v49
v_mfma_f32_16x16x32_bf16 v[160:163], a[72:75], a[8:11], v[160:163]
v_cvt_pk_bf16_f32 v48, v32, v33
v_cvt_pk_bf16_f32 v49, v34, v35
v_mfma_f32_16x16x32_bf16 v[168:171], a[72:75], a[16:19], 0
buffer_store_dwordx4 v[48:51], v16, s[44:47], s67 offen sc1
v_mfma_f32_16x16x32_bf16 v[168:171], a[76:79], a[20:23], v[168:171]
v_subrev_u32 v19, 0x8000, v19
v_subrev_u32 v20, 0x8000, v20
v_mfma_f32_16x16x32_bf16 v[176:179], a[76:79], a[28:31], 0
s_xor_b32 m0, s84, 0
v_cvt_pk_bf16_f32 v83, v82, v83
v_cvt_pk_bf16_f32 v82, v80, v81
v_mfma_f32_16x16x32_bf16 v[176:179], a[72:75], a[24:27], v[176:179]
s_xor_b32 s64, s72, 256
ds_read_b64_tr_b16 a[72:73], v8 offset:32768
v_cvt_pk_bf16_f32 v80, v64, v65
v_mfma_f32_16x16x32_bf16 v[180:183], a[80:83], a[24:27], 0
buffer_load_dwordx4 v12, s[48:51], s64 offen lds
v_mfma_f32_16x16x32_bf16 v[180:183], a[84:87], a[28:31], v[180:183]
ds_read_b64_tr_b16 a[74:75], v8 offset:33792
v_subrev_u32 v4, 0x8000, v4
v_mfma_f32_16x16x32_bf16 v[172:175], a[84:87], a[20:23], 0
ds_read_b64_tr_b16 a[76:77], v8 offset:40960
v_cvt_pk_bf16_f32 v81, v66, v67
v_mfma_f32_16x16x32_bf16 v[172:175], a[80:83], a[16:19], v[172:175]
s_xor_b32 m0, s84, 1024
ds_read_b64_tr_b16 a[78:79], v8 offset:41984
v_accvgpr_write_b32 a204, v80
v_mfma_f32_16x16x32_bf16 v[164:167], a[80:83], a[8:11], 0
s_xor_b32 s64, s72, 16640
v_accvgpr_write_b32 a205, v81
v_accvgpr_write_b32 a206, v82
v_mfma_f32_16x16x32_bf16 v[164:167], a[84:87], a[12:15], v[164:167]
buffer_load_dwordx4 v13, s[48:51], s64 offen lds
v_mfma_f32_16x16x32_bf16 v[156:159], a[84:87], a[4:7], 0
v_accvgpr_write_b32 a207, v83
v_cvt_pk_bf16_f32 v128, v128, v129
v_mfma_f32_16x16x32_bf16 v[156:159], a[80:83], a[0:3], v[156:159]
ds_read_b64_tr_b16 a[80:81], v9 offset:32768
v_cvt_pk_bf16_f32 v129, v130, v131
v_mfma_f32_16x16x32_bf16 v[24:27], a[88:91], a[0:3], 0
s_xor_b32 m0, s84, 2048
ds_read_b64_tr_b16 a[82:83], v9 offset:33792
v_cvt_pk_bf16_f32 v130, v144, v145
v_mfma_f32_16x16x32_bf16 v[24:27], a[92:95], a[4:7], v[24:27]
s_xor_b32 s64, s72, 131328
ds_read_b64_tr_b16 a[84:85], v9 offset:40960
v_subrev_u32 v5, 0x8000, v5
v_mfma_f32_16x16x32_bf16 v[40:43], a[92:95], a[12:15], 0
buffer_load_dwordx4 v12, s[48:51], s64 offen lds
v_mfma_f32_16x16x32_bf16 v[40:43], a[88:91], a[8:11], v[40:43]
ds_read_b64_tr_b16 a[86:87], v9 offset:41984
v_cvt_pk_bf16_f32 v131, v146, v147
v_mfma_f32_16x16x32_bf16 v[56:59], a[88:91], a[16:19], 0
s_xor_b32 m0, s84, 3072
v_accvgpr_write_b32 a208, v128
v_accvgpr_write_b32 a209, v129
v_mfma_f32_16x16x32_bf16 v[56:59], a[92:95], a[20:23], v[56:59]
s_xor_b32 s64, s72, 147712
v_accvgpr_write_b32 a210, v130
v_accvgpr_write_b32 a211, v131
v_mfma_f32_16x16x32_bf16 v[72:75], a[92:95], a[28:31], 0
s_waitcnt vmcnt(13)
ds_read_b128 a[32:35], v2 offset:32768
v_cvt_pk_bf16_f32 v96, v96, v97
v_mfma_f32_16x16x32_bf16 v[72:75], a[88:91], a[24:27], v[72:75]
buffer_load_dwordx4 v13, s[48:51], s64 offen lds
v_mfma_f32_16x16x32_bf16 v[136:139], a[96:99], a[24:27], 0
ds_read_b128 a[36:39], v3 offset:32768
v_cvt_pk_bf16_f32 v97, v98, v99
v_mfma_f32_16x16x32_bf16 v[136:139], a[100:103], a[28:31], v[136:139]
ds_read_b128 a[40:43], v2 offset:34816
v_subrev_u32 v6, 0x8000, v6
v_mfma_f32_16x16x32_bf16 v[120:123], a[100:103], a[20:23], 0
s_xor_b32 m0, s84, 4096
ds_read_b128 a[44:47], v3 offset:34816
v_cvt_pk_bf16_f32 v98, v112, v113
v_mfma_f32_16x16x32_bf16 v[120:123], a[96:99], a[16:19], v[120:123]
s_xor_b32 s64, s73, 256
ds_read_b128 a[48:51], v2 offset:36864
v_cvt_pk_bf16_f32 v99, v114, v115
v_mfma_f32_16x16x32_bf16 v[104:107], a[96:99], a[8:11], 0
buffer_load_dwordx4 v12, s[48:51], s64 offen lds
v_mfma_f32_16x16x32_bf16 v[104:107], a[100:103], a[12:15], v[104:107]
ds_read_b128 a[52:55], v3 offset:36864
v_accvgpr_write_b32 a212, v96
v_mfma_f32_16x16x32_bf16 v[88:91], a[100:103], a[4:7], 0
ds_read_b128 a[56:59], v2 offset:38912
v_accvgpr_write_b32 a213, v97
v_mfma_f32_16x16x32_bf16 v[88:91], a[96:99], a[0:3], v[88:91]
s_waitcnt lgkmcnt(7)
s_xor_b32 m0, s84, 5120
ds_read_b128 a[60:63], v3 offset:38912
v_accvgpr_write_b32 a214, v98
v_mfma_f32_16x16x32_bf16 v[28:31], a[104:107], a[0:3], 0
s_xor_b32 s64, s73, 16640
ds_read_b64_tr_b16 a[88:89], v10 offset:32768
v_accvgpr_write_b32 a215, v99
v_mfma_f32_16x16x32_bf16 v[28:31], a[108:111], a[4:7], v[28:31]
s_add_u32 s67, s79, 12288
buffer_load_dwordx4 v13, s[48:51], s64 offen lds
v_mfma_f32_16x16x32_bf16 v[44:47], a[108:111], a[12:15], 0
ds_read_b64_tr_b16 a[90:91], v10 offset:33792
v_subrev_u32 v7, 0x8000, v7
v_mfma_f32_16x16x32_bf16 v[44:47], a[104:107], a[8:11], v[44:47]
ds_read_b64_tr_b16 a[92:93], v10 offset:40960
v_cvt_pk_bf16_f32 v55, v54, v55
v_mfma_f32_16x16x32_bf16 v[60:63], a[104:107], a[16:19], 0
s_xor_b32 m0, s84, 6144
ds_read_b64_tr_b16 a[94:95], v10 offset:41984
v_cvt_pk_bf16_f32 v54, v52, v53
v_mfma_f32_16x16x32_bf16 v[60:63], a[108:111], a[20:23], v[60:63]
s_xor_b32 s64, s73, 131328
ds_read_b64_tr_b16 a[96:97], v11 offset:32768
v_cvt_pk_bf16_f32 v52, v36, v37
v_mfma_f32_16x16x32_bf16 v[76:79], a[108:111], a[28:31], 0
buffer_load_dwordx4 v12, s[48:51], s64 offen lds
v_mfma_f32_16x16x32_bf16 v[76:79], a[104:107], a[24:27], v[76:79]
ds_read_b64_tr_b16 a[98:99], v11 offset:33792
v_cvt_pk_bf16_f32 v53, v38, v39
v_mfma_f32_16x16x32_bf16 v[140:143], a[112:115], a[24:27], 0
ds_read_b64_tr_b16 a[100:101], v11 offset:40960
v_mfma_f32_16x16x32_bf16 v[140:143], a[116:119], a[28:31], v[140:143]
s_xor_b32 m0, s84, 7168
ds_read_b64_tr_b16 a[102:103], v11 offset:41984
v_subrev_u32 v8, 0x8000, v8
v_mfma_f32_16x16x32_bf16 v[124:127], a[116:119], a[20:23], 0
s_xor_b32 s64, s73, 147712
buffer_store_dwordx4 v[52:55], v16, s[44:47], s67 offen sc1
v_mfma_f32_16x16x32_bf16 v[124:127], a[112:115], a[16:19], v[124:127]
buffer_load_dwordx4 v13, s[48:51], s64 offen lds
v_mfma_f32_16x16x32_bf16 v[108:111], a[112:115], a[8:11], 0
v_cvt_pk_bf16_f32 v87, v86, v87
v_cvt_pk_bf16_f32 v86, v84, v85
v_mfma_f32_16x16x32_bf16 v[108:111], a[116:119], a[12:15], v[108:111]
v_cvt_pk_bf16_f32 v84, v68, v69
v_cvt_pk_bf16_f32 v85, v70, v71
v_mfma_f32_16x16x32_bf16 v[92:95], a[116:119], a[4:7], 0
v_subrev_u32 v9, 0x8000, v9
v_subrev_u32 v10, 0x8000, v10
v_mfma_f32_16x16x32_bf16 v[92:95], a[112:115], a[0:3], v[92:95]
v_subrev_u32 v11, 0x8000, v11
v_accvgpr_write_b32 a216, v84
v_mfma_f32_16x16x32_bf16 v[32:35], a[72:75], a[0:3], 0
v_accvgpr_write_b32 a217, v85
v_accvgpr_write_b32 a218, v86
v_mfma_f32_16x16x32_bf16 v[32:35], a[76:79], a[4:7], v[32:35]
v_accvgpr_write_b32 a219, v87
v_cvt_pk_bf16_f32 v132, v132, v133
v_mfma_f32_16x16x32_bf16 v[48:51], a[76:79], a[12:15], 0
s_waitcnt lgkmcnt(0)
s_barrier
v_mfma_f32_16x16x32_bf16 v[48:51], a[72:75], a[8:11], v[48:51]
s_xor_b32 m0, s77, 131072
ds_read_b64_tr_b16 a[104:105], v19 offset:4096
v_cvt_pk_bf16_f32 v133, v134, v135
v_mfma_f32_16x16x32_bf16 v[64:67], a[72:75], a[16:19], 0
s_xor_b32 s64, s71, 1572864
ds_read_b64_tr_b16 a[106:107], v19 offset:4352
v_cvt_pk_bf16_f32 v134, v148, v149
v_mfma_f32_16x16x32_bf16 v[64:67], a[76:79], a[20:23], v[64:67]
buffer_load_dwordx4 v14, s[56:59], s64 offen lds
v_mfma_f32_16x16x32_bf16 v[80:83], a[76:79], a[28:31], 0
ds_read_b64_tr_b16 a[108:109], v19 offset:6144
v_cvt_pk_bf16_f32 v135, v150, v151
v_mfma_f32_16x16x32_bf16 v[80:83], a[72:75], a[24:27], v[80:83]
ds_read_b64_tr_b16 a[110:111], v19 offset:6400
v_accvgpr_write_b32 a220, v132
v_mfma_f32_16x16x32_bf16 v[144:147], a[80:83], a[24:27], 0
ds_read_b64_tr_b16 a[112:113], v20 offset:4096
v_accvgpr_write_b32 a221, v133
v_mfma_f32_16x16x32_bf16 v[144:147], a[84:87], a[28:31], v[144:147]
ds_read_b64_tr_b16 a[114:115], v20 offset:4352
v_accvgpr_write_b32 a222, v134
v_mfma_f32_16x16x32_bf16 v[128:131], a[84:87], a[20:23], 0
ds_read_b64_tr_b16 a[116:117], v20 offset:6144
v_accvgpr_write_b32 a223, v135
v_mfma_f32_16x16x32_bf16 v[128:131], a[80:83], a[16:19], v[128:131]
ds_read_b64_tr_b16 a[118:119], v20 offset:6400
v_cvt_pk_bf16_f32 v100, v100, v101
v_mfma_f32_16x16x32_bf16 v[112:115], a[80:83], a[8:11], 0
s_add_u32 m0, s78, 147456
ds_read_b64_tr_b16 a[72:73], v19 offset:8192
v_cvt_pk_bf16_f32 v101, v102, v103
v_mfma_f32_16x16x32_bf16 v[112:115], a[84:87], a[12:15], v[112:115]
s_add_u32 s64, s75, 1179648
ds_read_b64_tr_b16 a[74:75], v19 offset:8448
v_cvt_pk_bf16_f32 v102, v116, v117
v_mfma_f32_16x16x32_bf16 v[96:99], a[84:87], a[4:7], 0
buffer_load_dwordx4 v23, s[60:63], s64 offen lds
v_mfma_f32_16x16x32_bf16 v[96:99], a[80:83], a[0:3], v[96:99]
ds_read_b64_tr_b16 a[76:77], v19 offset:10240
v_cvt_pk_bf16_f32 v103, v118, v119
v_mfma_f32_16x16x32_bf16 v[36:39], a[88:91], a[0:3], 0
ds_read_b64_tr_b16 a[78:79], v19 offset:10496
v_accvgpr_write_b32 a224, v100
v_mfma_f32_16x16x32_bf16 v[36:39], a[92:95], a[4:7], v[36:39]
ds_read_b64_tr_b16 a[80:81], v20 offset:8192
v_accvgpr_write_b32 a225, v101
v_mfma_f32_16x16x32_bf16 v[52:55], a[92:95], a[12:15], 0
s_xor_b32 s68, s66, 0
ds_read_b64_tr_b16 a[82:83], v20 offset:8448
v_accvgpr_write_b32 a226, v102
v_mfma_f32_16x16x32_bf16 v[52:55], a[88:91], a[8:11], v[52:55]
s_xor_b32 m0, s77, 132096
ds_read_b64_tr_b16 a[84:85], v20 offset:10240
v_accvgpr_write_b32 a227, v103
v_mfma_f32_16x16x32_bf16 v[68:71], a[88:91], a[16:19], 0
s_add_u32 s67, s79, 14336
ds_read_b64_tr_b16 a[86:87], v20 offset:10496
v_cvt_pk_bf16_f32 v255, v254, v255
v_mfma_f32_16x16x32_bf16 v[68:71], a[92:95], a[20:23], v[68:71]
s_xor_b32 s64, s71, 1605632
v_cvt_pk_bf16_f32 v254, v252, v253
v_cvt_pk_bf16_f32 v252, v248, v249
v_mfma_f32_16x16x32_bf16 v[84:87], a[92:95], a[28:31], 0
s_mov_b64 exec, 1
buffer_atomic_add a251, v1, s[52:55], s68 offen offset:0 sc1
s_mov_b64 exec, -1
v_mfma_f32_16x16x32_bf16 v[84:87], a[88:91], a[24:27], v[84:87]
buffer_load_dwordx4 v14, s[56:59], s64 offen lds
v_mfma_f32_16x16x32_bf16 v[148:151], a[96:99], a[24:27], 0
ds_read_b64_tr_b16 a[88:89], v19 offset:0
v_cvt_pk_bf16_f32 v253, v250, v251
v_mfma_f32_16x16x32_bf16 v[148:151], a[100:103], a[28:31], v[148:151]
ds_read_b64_tr_b16 a[90:91], v19 offset:256
v_mfma_f32_16x16x32_bf16 v[132:135], a[100:103], a[20:23], 0
ds_read_b64_tr_b16 a[92:93], v19 offset:2048
v_mfma_f32_16x16x32_bf16 v[132:135], a[96:99], a[16:19], v[132:135]
s_add_u32 s65, s79, 16384
ds_read_b64_tr_b16 a[94:95], v19 offset:2304
v_mfma_f32_16x16x32_bf16 v[116:119], a[96:99], a[8:11], 0
buffer_store_dwordx4 a[144:147], v16, s[44:47], s65 offen sc1
v_mfma_f32_16x16x32_bf16 v[116:119], a[100:103], a[12:15], v[116:119]
buffer_store_dwordx4 v[252:255], v16, s[44:47], s67 offen sc1
v_mfma_f32_16x16x32_bf16 v[100:103], a[100:103], a[4:7], 0
s_add_u32 m0, s78, 151552
v_mfma_f32_16x16x32_bf16 v[100:103], a[96:99], a[0:3], v[100:103]
s_waitcnt lgkmcnt(4)
s_add_u32 s64, s75, 1181696
ds_read_b64_tr_b16 a[96:97], v20 offset:0
v_accvgpr_read_b32 v248, a120
v_mfma_f32_16x16x32_bf16 v[184:187], a[104:107], a[32:35], v[184:187]
buffer_load_dwordx4 v23, s[60:63], s64 offen lds
v_mfma_f32_16x16x32_bf16 v[184:187], a[108:111], a[36:39], v[184:187]
ds_read_b64_tr_b16 a[98:99], v20 offset:256
v_accvgpr_read_b32 v249, a121
v_mfma_f32_16x16x32_bf16 v[192:195], a[108:111], a[44:47], v[192:195]
ds_read_b64_tr_b16 a[100:101], v20 offset:2048
v_accvgpr_read_b32 v250, a122
v_mfma_f32_16x16x32_bf16 v[192:195], a[104:107], a[40:43], v[192:195]
ds_read_b64_tr_b16 a[102:103], v20 offset:2304
v_accvgpr_read_b32 v251, a123
v_mfma_f32_16x16x32_bf16 v[200:203], a[104:107], a[48:51], v[200:203]
v_accvgpr_read_b32 v252, a124
v_accvgpr_read_b32 v253, a125
v_mfma_f32_16x16x32_bf16 v[200:203], a[108:111], a[52:55], v[200:203]
v_accvgpr_read_b32 v254, a126
v_accvgpr_read_b32 v255, a127
v_mfma_f32_16x16x32_bf16 v[208:211], a[108:111], a[60:63], v[208:211]
v_cvt_pk_bf16_f32 v255, v254, v255
v_cvt_pk_bf16_f32 v254, v252, v253
v_mfma_f32_16x16x32_bf16 v[208:211], a[104:107], a[56:59], v[208:211]
ds_read_b64_tr_b16 a[104:105], v4 offset:0
v_cvt_pk_bf16_f32 v252, v248, v249
v_mfma_f32_16x16x32_bf16 v[212:215], a[112:115], a[56:59], v[212:215]
s_xor_b32 m0, s77, 133120
ds_read_b64_tr_b16 a[106:107], v4 offset:1024
v_cvt_pk_bf16_f32 v253, v250, v251
v_mfma_f32_16x16x32_bf16 v[212:215], a[116:119], a[60:63], v[212:215]
s_xor_b32 s64, s71, 1638400
ds_read_b64_tr_b16 a[108:109], v4 offset:8192
v_accvgpr_write_b32 a228, v252
v_mfma_f32_16x16x32_bf16 v[204:207], a[116:119], a[52:55], v[204:207]
buffer_load_dwordx4 v15, s[56:59], s64 offen lds
v_mfma_f32_16x16x32_bf16 v[204:207], a[112:115], a[48:51], v[204:207]
ds_read_b64_tr_b16 a[110:111], v4 offset:9216
v_accvgpr_write_b32 a229, v253
v_mfma_f32_16x16x32_bf16 v[196:199], a[112:115], a[40:43], v[196:199]
v_accvgpr_write_b32 a230, v254
v_accvgpr_write_b32 a231, v255
v_mfma_f32_16x16x32_bf16 v[196:199], a[116:119], a[44:47], v[196:199]
v_mfma_f32_16x16x32_bf16 v[188:191], a[116:119], a[36:39], v[188:191]
v_accvgpr_read_b32 v248, a132
v_accvgpr_read_b32 v249, a133
v_mfma_f32_16x16x32_bf16 v[188:191], a[112:115], a[32:35], v[188:191]
ds_read_b64_tr_b16 a[112:113], v5 offset:0
v_accvgpr_read_b32 v250, a134
v_mfma_f32_16x16x32_bf16 v[216:219], a[32:35], a[72:75], v[216:219]
ds_read_b64_tr_b16 a[114:115], v5 offset:1024
v_accvgpr_read_b32 v251, a135
v_mfma_f32_16x16x32_bf16 v[216:219], a[36:39], a[76:79], v[216:219]
s_add_u32 m0, s78, 155648
ds_read_b64_tr_b16 a[116:117], v5 offset:8192
v_accvgpr_read_b32 v252, a128
v_mfma_f32_16x16x32_bf16 v[224:227], a[44:47], a[76:79], v[224:227]
s_add_u32 s64, s75, 1183744
ds_read_b64_tr_b16 a[118:119], v5 offset:9216
v_accvgpr_read_b32 v253, a129
v_mfma_f32_16x16x32_bf16 v[224:227], a[40:43], a[72:75], v[224:227]
buffer_load_dwordx4 v23, s[60:63], s64 offen lds
v_mfma_f32_16x16x32_bf16 v[232:235], a[48:51], a[72:75], v[232:235]
v_accvgpr_read_b32 v254, a130
v_accvgpr_read_b32 v255, a131
v_mfma_f32_16x16x32_bf16 v[232:235], a[52:55], a[76:79], v[232:235]
v_cvt_pk_bf16_f32 v255, v254, v255
v_cvt_pk_bf16_f32 v254, v252, v253
v_mfma_f32_16x16x32_bf16 v[240:243], a[60:63], a[76:79], v[240:243]
v_cvt_pk_bf16_f32 v252, v248, v249
v_cvt_pk_bf16_f32 v253, v250, v251
v_mfma_f32_16x16x32_bf16 v[240:243], a[56:59], a[72:75], v[240:243]
ds_read_b64_tr_b16 a[72:73], v6 offset:0
v_accvgpr_write_b32 a232, v252
v_mfma_f32_16x16x32_bf16 v[244:247], a[56:59], a[80:83], v[244:247]
ds_read_b64_tr_b16 a[74:75], v6 offset:1024
v_accvgpr_write_b32 a233, v253
v_mfma_f32_16x16x32_bf16 v[244:247], a[60:63], a[84:87], v[244:247]
ds_read_b64_tr_b16 a[76:77], v6 offset:8192
v_accvgpr_write_b32 a234, v254
v_mfma_f32_16x16x32_bf16 v[236:239], a[52:55], a[84:87], v[236:239]
s_xor_b32 m0, s77, 134144
ds_read_b64_tr_b16 a[78:79], v6 offset:9216
v_accvgpr_write_b32 a235, v255
v_mfma_f32_16x16x32_bf16 v[236:239], a[48:51], a[80:83], v[236:239]
s_xor_b32 s64, s71, 1671168
v_mfma_f32_16x16x32_bf16 v[228:231], a[40:43], a[80:83], v[228:231]
buffer_load_dwordx4 v15, s[56:59], s64 offen lds
v_mfma_f32_16x16x32_bf16 v[228:231], a[44:47], a[84:87], v[228:231]
v_accvgpr_read_b32 v248, a140
v_accvgpr_read_b32 v249, a141
v_mfma_f32_16x16x32_bf16 v[220:223], a[36:39], a[84:87], v[220:223]
v_accvgpr_read_b32 v250, a142
v_accvgpr_read_b32 v251, a143
v_mfma_f32_16x16x32_bf16 v[220:223], a[32:35], a[80:83], v[220:223]
s_waitcnt lgkmcnt(4)
ds_read_b64_tr_b16 a[80:81], v7 offset:0
v_accvgpr_read_b32 v252, a136
v_mfma_f32_16x16x32_bf16 v[152:155], a[88:91], a[32:35], v[152:155]
ds_read_b64_tr_b16 a[82:83], v7 offset:1024
v_accvgpr_read_b32 v253, a137
v_mfma_f32_16x16x32_bf16 v[152:155], a[92:95], a[36:39], v[152:155]
ds_read_b64_tr_b16 a[84:85], v7 offset:8192
v_accvgpr_read_b32 v254, a138
v_mfma_f32_16x16x32_bf16 v[160:163], a[92:95], a[44:47], v[160:163]
ds_read_b64_tr_b16 a[86:87], v7 offset:9216
v_accvgpr_read_b32 v255, a139
v_mfma_f32_16x16x32_bf16 v[160:163], a[88:91], a[40:43], v[160:163]
v_cvt_pk_bf16_f32 v255, v254, v255
v_cvt_pk_bf16_f32 v254, v252, v253
v_mfma_f32_16x16x32_bf16 v[168:171], a[88:91], a[48:51], v[168:171]
v_cvt_pk_bf16_f32 v252, v248, v249
v_cvt_pk_bf16_f32 v253, v250, v251
v_mfma_f32_16x16x32_bf16 v[168:171], a[92:95], a[52:55], v[168:171]
v_accvgpr_write_b32 a236, v252
v_accvgpr_write_b32 a237, v253
v_mfma_f32_16x16x32_bf16 v[176:179], a[92:95], a[60:63], v[176:179]
s_xor_b32 m0, s84, 32768
v_accvgpr_write_b32 a238, v254
v_accvgpr_write_b32 a239, v255
v_mfma_f32_16x16x32_bf16 v[176:179], a[88:91], a[56:59], v[176:179]
s_xor_b32 s64, s72, 384
ds_read_b64_tr_b16 a[88:89], v8 offset:0
v_mfma_f32_16x16x32_bf16 v[180:183], a[96:99], a[56:59], v[180:183]
buffer_load_dwordx4 v12, s[48:51], s64 offen lds
v_mfma_f32_16x16x32_bf16 v[180:183], a[100:103], a[60:63], v[180:183]
ds_read_b64_tr_b16 a[90:91], v8 offset:1024
v_mfma_f32_16x16x32_bf16 v[172:175], a[100:103], a[52:55], v[172:175]
ds_read_b64_tr_b16 a[92:93], v8 offset:8192
v_mfma_f32_16x16x32_bf16 v[172:175], a[96:99], a[48:51], v[172:175]
s_xor_b32 m0, s84, 33792
ds_read_b64_tr_b16 a[94:95], v8 offset:9216
v_mfma_f32_16x16x32_bf16 v[164:167], a[96:99], a[40:43], v[164:167]
s_xor_b32 s64, s72, 16768
v_mfma_f32_16x16x32_bf16 v[164:167], a[100:103], a[44:47], v[164:167]
s_add_u32 s65, s79, 4096
buffer_load_dwordx4 v13, s[48:51], s64 offen lds
v_mfma_f32_16x16x32_bf16 v[156:159], a[100:103], a[36:39], v[156:159]
buffer_store_dwordx4 a[148:151], v16, s[44:47], s65 offen sc1
v_mfma_f32_16x16x32_bf16 v[156:159], a[96:99], a[32:35], v[156:159]
ds_read_b64_tr_b16 a[96:97], v9 offset:0
v_mfma_f32_16x16x32_bf16 v[24:27], a[104:107], a[32:35], v[24:27]
s_xor_b32 m0, s84, 34816
ds_read_b64_tr_b16 a[98:99], v9 offset:1024
v_mfma_f32_16x16x32_bf16 v[24:27], a[108:111], a[36:39], v[24:27]
s_xor_b32 s64, s72, 131456
ds_read_b64_tr_b16 a[100:101], v9 offset:8192
v_mfma_f32_16x16x32_bf16 v[40:43], a[108:111], a[44:47], v[40:43]
buffer_load_dwordx4 v12, s[48:51], s64 offen lds
v_mfma_f32_16x16x32_bf16 v[40:43], a[104:107], a[40:43], v[40:43]
ds_read_b64_tr_b16 a[102:103], v9 offset:9216
v_mfma_f32_16x16x32_bf16 v[56:59], a[104:107], a[48:51], v[56:59]
v_mfma_f32_16x16x32_bf16 v[56:59], a[108:111], a[52:55], v[56:59]
s_xor_b32 m0, s84, 35840
v_mfma_f32_16x16x32_bf16 v[72:75], a[108:111], a[60:63], v[72:75]
s_waitcnt vmcnt(14)
s_xor_b32 s64, s72, 147840
ds_read_b128 a[0:3], v2 offset:0
v_mfma_f32_16x16x32_bf16 v[72:75], a[104:107], a[56:59], v[72:75]
buffer_load_dwordx4 v13, s[48:51], s64 offen lds
v_mfma_f32_16x16x32_bf16 v[136:139], a[112:115], a[56:59], v[136:139]
ds_read_b128 a[4:7], v3 offset:0
v_mfma_f32_16x16x32_bf16 v[136:139], a[116:119], a[60:63], v[136:139]
ds_read_b128 a[8:11], v2 offset:2048
v_mfma_f32_16x16x32_bf16 v[120:123], a[116:119], a[52:55], v[120:123]
s_xor_b32 m0, s84, 36864
ds_read_b128 a[12:15], v3 offset:2048
v_mfma_f32_16x16x32_bf16 v[120:123], a[112:115], a[48:51], v[120:123]
s_xor_b32 s64, s73, 384
ds_read_b128 a[16:19], v2 offset:4096
v_mfma_f32_16x16x32_bf16 v[104:107], a[112:115], a[40:43], v[104:107]
buffer_load_dwordx4 v12, s[48:51], s64 offen lds
v_mfma_f32_16x16x32_bf16 v[104:107], a[116:119], a[44:47], v[104:107]
ds_read_b128 a[20:23], v3 offset:4096
v_mfma_f32_16x16x32_bf16 v[88:91], a[116:119], a[36:39], v[88:91]
ds_read_b128 a[24:27], v2 offset:6144
v_mfma_f32_16x16x32_bf16 v[88:91], a[112:115], a[32:35], v[88:91]
s_waitcnt lgkmcnt(7)
s_xor_b32 m0, s84, 37888
ds_read_b128 a[28:31], v3 offset:6144
v_mfma_f32_16x16x32_bf16 v[28:31], a[72:75], a[32:35], v[28:31]
s_xor_b32 s64, s73, 16768
ds_read_b64_tr_b16 a[104:105], v10 offset:0
v_mfma_f32_16x16x32_bf16 v[28:31], a[76:79], a[36:39], v[28:31]
buffer_load_dwordx4 v13, s[48:51], s64 offen lds
v_mfma_f32_16x16x32_bf16 v[44:47], a[76:79], a[44:47], v[44:47]
ds_read_b64_tr_b16 a[106:107], v10 offset:1024
v_mfma_f32_16x16x32_bf16 v[44:47], a[72:75], a[40:43], v[44:47]
ds_read_b64_tr_b16 a[108:109], v10 offset:8192
v_mfma_f32_16x16x32_bf16 v[60:63], a[72:75], a[48:51], v[60:63]
s_xor_b32 m0, s84, 38912
ds_read_b64_tr_b16 a[110:111], v10 offset:9216
v_mfma_f32_16x16x32_bf16 v[60:63], a[76:79], a[52:55], v[60:63]
s_xor_b32 s64, s73, 131456
ds_read_b64_tr_b16 a[112:113], v11 offset:0
v_mfma_f32_16x16x32_bf16 v[76:79], a[76:79], a[60:63], v[76:79]
buffer_load_dwordx4 v12, s[48:51], s64 offen lds
v_mfma_f32_16x16x32_bf16 v[76:79], a[72:75], a[56:59], v[76:79]
ds_read_b64_tr_b16 a[114:115], v11 offset:1024
v_mfma_f32_16x16x32_bf16 v[140:143], a[80:83], a[56:59], v[140:143]
ds_read_b64_tr_b16 a[116:117], v11 offset:8192
v_mfma_f32_16x16x32_bf16 v[140:143], a[84:87], a[60:63], v[140:143]
s_xor_b32 m0, s84, 39936
ds_read_b64_tr_b16 a[118:119], v11 offset:9216
v_mfma_f32_16x16x32_bf16 v[124:127], a[84:87], a[52:55], v[124:127]
s_xor_b32 s64, s73, 147840
v_mfma_f32_16x16x32_bf16 v[124:127], a[80:83], a[48:51], v[124:127]
buffer_load_dwordx4 v13, s[48:51], s64 offen lds
v_mfma_f32_16x16x32_bf16 v[108:111], a[80:83], a[40:43], v[108:111]
v_mfma_f32_16x16x32_bf16 v[108:111], a[84:87], a[44:47], v[108:111]
v_mfma_f32_16x16x32_bf16 v[92:95], a[84:87], a[36:39], v[92:95]
v_mfma_f32_16x16x32_bf16 v[92:95], a[80:83], a[32:35], v[92:95]
v_mfma_f32_16x16x32_bf16 v[32:35], a[88:91], a[32:35], v[32:35]
v_mfma_f32_16x16x32_bf16 v[32:35], a[92:95], a[36:39], v[32:35]
v_mfma_f32_16x16x32_bf16 v[48:51], a[92:95], a[44:47], v[48:51]
s_waitcnt lgkmcnt(0)
s_barrier
v_mfma_f32_16x16x32_bf16 v[48:51], a[88:91], a[40:43], v[48:51]
s_xor_b32 m0, s77, 65536
ds_read_b64_tr_b16 a[72:73], v19 offset:36864
v_mfma_f32_16x16x32_bf16 v[64:67], a[88:91], a[48:51], v[64:67]
s_branch L_po7
L_pg7:
s_branch L_pg11
L_po7:
s_xor_b32 s64, s71, 2097152
ds_read_b64_tr_b16 a[74:75], v19 offset:37120
v_mfma_f32_16x16x32_bf16 v[64:67], a[92:95], a[52:55], v[64:67]
buffer_load_dwordx4 v14, s[56:59], s64 offen lds
v_mfma_f32_16x16x32_bf16 v[80:83], a[92:95], a[60:63], v[80:83]
ds_read_b64_tr_b16 a[76:77], v19 offset:38912
v_mfma_f32_16x16x32_bf16 v[80:83], a[88:91], a[56:59], v[80:83]
ds_read_b64_tr_b16 a[78:79], v19 offset:39168
v_mfma_f32_16x16x32_bf16 v[144:147], a[96:99], a[56:59], v[144:147]
ds_read_b64_tr_b16 a[80:81], v20 offset:36864
v_mfma_f32_16x16x32_bf16 v[144:147], a[100:103], a[60:63], v[144:147]
ds_read_b64_tr_b16 a[82:83], v20 offset:37120
v_mfma_f32_16x16x32_bf16 v[128:131], a[100:103], a[52:55], v[128:131]
ds_read_b64_tr_b16 a[84:85], v20 offset:38912
v_mfma_f32_16x16x32_bf16 v[128:131], a[96:99], a[48:51], v[128:131]
ds_read_b64_tr_b16 a[86:87], v20 offset:39168
v_mfma_f32_16x16x32_bf16 v[112:115], a[96:99], a[40:43], v[112:115]
s_add_u32 m0, s78, 81920
ds_read_b64_tr_b16 a[88:89], v19 offset:40960
v_mfma_f32_16x16x32_bf16 v[112:115], a[100:103], a[44:47], v[112:115]
s_add_u32 s64, s75, 1572864
ds_read_b64_tr_b16 a[90:91], v19 offset:41216
v_mfma_f32_16x16x32_bf16 v[96:99], a[100:103], a[36:39], v[96:99]
s_add_u32 s65, s79, 0
buffer_load_dwordx4 v23, s[60:63], s64 offen lds
v_mfma_f32_16x16x32_bf16 v[96:99], a[96:99], a[32:35], v[96:99]
buffer_store_dwordx4 a[152:155], v16, s[44:47], s65 offen sc1
v_mfma_f32_16x16x32_bf16 v[36:39], a[104:107], a[32:35], v[36:39]
ds_read_b64_tr_b16 a[92:93], v19 offset:43008
v_mfma_f32_16x16x32_bf16 v[36:39], a[108:111], a[36:39], v[36:39]
ds_read_b64_tr_b16 a[94:95], v19 offset:43264
v_mfma_f32_16x16x32_bf16 v[52:55], a[108:111], a[44:47], v[52:55]
ds_read_b64_tr_b16 a[96:97], v20 offset:40960
v_mfma_f32_16x16x32_bf16 v[52:55], a[104:107], a[40:43], v[52:55]
ds_read_b64_tr_b16 a[98:99], v20 offset:41216
v_mfma_f32_16x16x32_bf16 v[68:71], a[104:107], a[48:51], v[68:71]
s_xor_b32 m0, s77, 66560
ds_read_b64_tr_b16 a[100:101], v20 offset:43008
v_mfma_f32_16x16x32_bf16 v[68:71], a[108:111], a[52:55], v[68:71]
s_xor_b32 s64, s71, 2129920
s_xor_b32 s68, s66, 4096
ds_read_b64_tr_b16 a[102:103], v20 offset:43264
v_mfma_f32_16x16x32_bf16 v[84:87], a[108:111], a[60:63], v[84:87]
s_mov_b64 exec, 1
buffer_atomic_add a251, v1, s[52:55], s68 offen offset:0 sc1
s_mov_b64 exec, -1
v_mfma_f32_16x16x32_bf16 v[84:87], a[104:107], a[56:59], v[84:87]
buffer_load_dwordx4 v14, s[56:59], s64 offen lds
v_mfma_f32_16x16x32_bf16 v[148:151], a[112:115], a[56:59], v[148:151]
ds_read_b64_tr_b16 a[104:105], v19 offset:32768
v_mfma_f32_16x16x32_bf16 v[148:151], a[116:119], a[60:63], v[148:151]
ds_read_b64_tr_b16 a[106:107], v19 offset:33024
v_mfma_f32_16x16x32_bf16 v[132:135], a[116:119], a[52:55], v[132:135]
ds_read_b64_tr_b16 a[108:109], v19 offset:34816
v_mfma_f32_16x16x32_bf16 v[132:135], a[112:115], a[48:51], v[132:135]
ds_read_b64_tr_b16 a[110:111], v19 offset:35072
v_mfma_f32_16x16x32_bf16 v[116:119], a[112:115], a[40:43], v[116:119]
v_mfma_f32_16x16x32_bf16 v[116:119], a[116:119], a[44:47], v[116:119]
v_mfma_f32_16x16x32_bf16 v[100:103], a[116:119], a[36:39], v[100:103]
s_add_u32 m0, s78, 86016
v_mfma_f32_16x16x32_bf16 v[100:103], a[112:115], a[32:35], v[100:103]
s_waitcnt lgkmcnt(4)
s_add_u32 s64, s75, 1574912
ds_read_b64_tr_b16 a[112:113], v20 offset:32768
v_mfma_f32_16x16x32_bf16 v[184:187], a[72:75], a[0:3], v[184:187]
buffer_load_dwordx4 v23, s[60:63], s64 offen lds
v_mfma_f32_16x16x32_bf16 v[184:187], a[76:79], a[4:7], v[184:187]
ds_read_b64_tr_b16 a[114:115], v20 offset:33024
v_mfma_f32_16x16x32_bf16 v[192:195], a[76:79], a[12:15], v[192:195]
ds_read_b64_tr_b16 a[116:117], v20 offset:34816
v_mfma_f32_16x16x32_bf16 v[192:195], a[72:75], a[8:11], v[192:195]
ds_read_b64_tr_b16 a[118:119], v20 offset:35072
v_mfma_f32_16x16x32_bf16 v[200:203], a[72:75], a[16:19], v[200:203]
v_mfma_f32_16x16x32_bf16 v[200:203], a[76:79], a[20:23], v[200:203]
v_mfma_f32_16x16x32_bf16 v[208:211], a[76:79], a[28:31], v[208:211]
v_mfma_f32_16x16x32_bf16 v[208:211], a[72:75], a[24:27], v[208:211]
ds_read_b64_tr_b16 a[72:73], v4 offset:32768
v_mfma_f32_16x16x32_bf16 v[212:215], a[80:83], a[24:27], v[212:215]
s_xor_b32 m0, s77, 67584
ds_read_b64_tr_b16 a[74:75], v4 offset:33792
v_mfma_f32_16x16x32_bf16 v[212:215], a[84:87], a[28:31], v[212:215]
s_xor_b32 s64, s71, 2162688
ds_read_b64_tr_b16 a[76:77], v4 offset:40960
v_mfma_f32_16x16x32_bf16 v[204:207], a[84:87], a[20:23], v[204:207]
buffer_load_dwordx4 v15, s[56:59], s64 offen lds
v_mfma_f32_16x16x32_bf16 v[204:207], a[80:83], a[16:19], v[204:207]
ds_read_b64_tr_b16 a[78:79], v4 offset:41984
v_mfma_f32_16x16x32_bf16 v[196:199], a[80:83], a[8:11], v[196:199]
v_mfma_f32_16x16x32_bf16 v[196:199], a[84:87], a[12:15], v[196:199]
v_mfma_f32_16x16x32_bf16 v[188:191], a[84:87], a[4:7], v[188:191]
v_mfma_f32_16x16x32_bf16 v[188:191], a[80:83], a[0:3], v[188:191]
ds_read_b64_tr_b16 a[80:81], v5 offset:32768
v_mfma_f32_16x16x32_bf16 v[216:219], a[0:3], a[88:91], v[216:219]
ds_read_b64_tr_b16 a[82:83], v5 offset:33792
v_mfma_f32_16x16x32_bf16 v[216:219], a[4:7], a[92:95], v[216:219]
s_add_u32 m0, s78, 90112
ds_read_b64_tr_b16 a[84:85], v5 offset:40960
v_mfma_f32_16x16x32_bf16 v[224:227], a[12:15], a[92:95], v[224:227]
s_add_u32 s64, s75, 1576960
ds_read_b64_tr_b16 a[86:87], v5 offset:41984
v_mfma_f32_16x16x32_bf16 v[224:227], a[8:11], a[88:91], v[224:227]
buffer_load_dwordx4 v23, s[60:63], s64 offen lds
v_mfma_f32_16x16x32_bf16 v[232:235], a[16:19], a[88:91], v[232:235]
v_mfma_f32_16x16x32_bf16 v[232:235], a[20:23], a[92:95], v[232:235]
v_mfma_f32_16x16x32_bf16 v[240:243], a[28:31], a[92:95], v[240:243]
v_mfma_f32_16x16x32_bf16 v[240:243], a[24:27], a[88:91], v[240:243]
ds_read_b64_tr_b16 a[88:89], v6 offset:32768
v_mfma_f32_16x16x32_bf16 v[244:247], a[24:27], a[96:99], v[244:247]
ds_read_b64_tr_b16 a[90:91], v6 offset:33792
v_mfma_f32_16x16x32_bf16 v[244:247], a[28:31], a[100:103], v[244:247]
ds_read_b64_tr_b16 a[92:93], v6 offset:40960
v_add_u32 v19, 0x8000, v19
v_mfma_f32_16x16x32_bf16 v[236:239], a[20:23], a[100:103], v[236:239]
s_xor_b32 m0, s77, 68608
ds_read_b64_tr_b16 a[94:95], v6 offset:41984
v_mfma_f32_16x16x32_bf16 v[236:239], a[16:19], a[96:99], v[236:239]
s_xor_b32 s64, s71, 2195456
v_mfma_f32_16x16x32_bf16 v[228:231], a[8:11], a[96:99], v[228:231]
buffer_load_dwordx4 v15, s[56:59], s64 offen lds
v_mfma_f32_16x16x32_bf16 v[228:231], a[12:15], a[100:103], v[228:231]
v_mfma_f32_16x16x32_bf16 v[220:223], a[4:7], a[100:103], v[220:223]
v_mfma_f32_16x16x32_bf16 v[220:223], a[0:3], a[96:99], v[220:223]
s_waitcnt lgkmcnt(4)
s_add_u32 s65, s79, 17408
ds_read_b64_tr_b16 a[96:97], v7 offset:32768
v_mfma_f32_16x16x32_bf16 v[152:155], a[104:107], a[0:3], v[152:155]
buffer_store_dwordx4 a[156:159], v16, s[44:47], s65 offen sc1
v_mfma_f32_16x16x32_bf16 v[152:155], a[108:111], a[4:7], v[152:155]
ds_read_b64_tr_b16 a[98:99], v7 offset:33792
v_add_u32 v20, 0x8000, v20
v_mfma_f32_16x16x32_bf16 v[160:163], a[108:111], a[12:15], v[160:163]
ds_read_b64_tr_b16 a[100:101], v7 offset:40960
v_mfma_f32_16x16x32_bf16 v[160:163], a[104:107], a[8:11], v[160:163]
ds_read_b64_tr_b16 a[102:103], v7 offset:41984
v_mfma_f32_16x16x32_bf16 v[168:171], a[104:107], a[16:19], v[168:171]
v_mfma_f32_16x16x32_bf16 v[168:171], a[108:111], a[20:23], v[168:171]
v_mfma_f32_16x16x32_bf16 v[176:179], a[108:111], a[28:31], v[176:179]
s_xor_b32 m0, s84, 0
v_mfma_f32_16x16x32_bf16 v[176:179], a[104:107], a[24:27], v[176:179]
s_xor_b32 s64, s72, 512
ds_read_b64_tr_b16 a[104:105], v8 offset:32768
v_mfma_f32_16x16x32_bf16 v[180:183], a[112:115], a[24:27], v[180:183]
buffer_load_dwordx4 v12, s[48:51], s64 offen lds
v_mfma_f32_16x16x32_bf16 v[180:183], a[116:119], a[28:31], v[180:183]
ds_read_b64_tr_b16 a[106:107], v8 offset:33792
v_add_u32 v4, 0x8000, v4
v_mfma_f32_16x16x32_bf16 v[172:175], a[116:119], a[20:23], v[172:175]
ds_read_b64_tr_b16 a[108:109], v8 offset:40960
v_mfma_f32_16x16x32_bf16 v[172:175], a[112:115], a[16:19], v[172:175]
s_xor_b32 m0, s84, 1024
ds_read_b64_tr_b16 a[110:111], v8 offset:41984
v_mfma_f32_16x16x32_bf16 v[164:167], a[112:115], a[8:11], v[164:167]
s_xor_b32 s64, s72, 16896
v_mfma_f32_16x16x32_bf16 v[164:167], a[116:119], a[12:15], v[164:167]
buffer_load_dwordx4 v13, s[48:51], s64 offen lds
v_mfma_f32_16x16x32_bf16 v[156:159], a[116:119], a[4:7], v[156:159]
v_mfma_f32_16x16x32_bf16 v[156:159], a[112:115], a[0:3], v[156:159]
ds_read_b64_tr_b16 a[112:113], v9 offset:32768
v_mfma_f32_16x16x32_bf16 v[24:27], a[72:75], a[0:3], v[24:27]
s_xor_b32 m0, s84, 2048
ds_read_b64_tr_b16 a[114:115], v9 offset:33792
v_mfma_f32_16x16x32_bf16 v[24:27], a[76:79], a[4:7], v[24:27]
s_xor_b32 s64, s72, 131584
ds_read_b64_tr_b16 a[116:117], v9 offset:40960
v_add_u32 v5, 0x8000, v5
v_mfma_f32_16x16x32_bf16 v[40:43], a[76:79], a[12:15], v[40:43]
buffer_load_dwordx4 v12, s[48:51], s64 offen lds
v_mfma_f32_16x16x32_bf16 v[40:43], a[72:75], a[8:11], v[40:43]
ds_read_b64_tr_b16 a[118:119], v9 offset:41984
v_mfma_f32_16x16x32_bf16 v[56:59], a[72:75], a[16:19], v[56:59]
v_mfma_f32_16x16x32_bf16 v[56:59], a[76:79], a[20:23], v[56:59]
s_xor_b32 m0, s84, 3072
v_mfma_f32_16x16x32_bf16 v[72:75], a[76:79], a[28:31], v[72:75]
s_waitcnt vmcnt(13)
s_xor_b32 s64, s72, 147968
ds_read_b128 a[32:35], v2 offset:32768
v_mfma_f32_16x16x32_bf16 v[72:75], a[72:75], a[24:27], v[72:75]
buffer_load_dwordx4 v13, s[48:51], s64 offen lds
v_mfma_f32_16x16x32_bf16 v[136:139], a[80:83], a[24:27], v[136:139]
ds_read_b128 a[36:39], v3 offset:32768
v_mfma_f32_16x16x32_bf16 v[136:139], a[84:87], a[28:31], v[136:139]
ds_read_b128 a[40:43], v2 offset:34816
v_add_u32 v6, 0x8000, v6
v_mfma_f32_16x16x32_bf16 v[120:123], a[84:87], a[20:23], v[120:123]
s_xor_b32 m0, s84, 4096
ds_read_b128 a[44:47], v3 offset:34816
v_mfma_f32_16x16x32_bf16 v[120:123], a[80:83], a[16:19], v[120:123]
s_xor_b32 s64, s73, 512
ds_read_b128 a[48:51], v2 offset:36864
v_mfma_f32_16x16x32_bf16 v[104:107], a[80:83], a[8:11], v[104:107]
buffer_load_dwordx4 v12, s[48:51], s64 offen lds
v_mfma_f32_16x16x32_bf16 v[104:107], a[84:87], a[12:15], v[104:107]
ds_read_b128 a[52:55], v3 offset:36864
v_mfma_f32_16x16x32_bf16 v[88:91], a[84:87], a[4:7], v[88:91]
ds_read_b128 a[56:59], v2 offset:38912
v_mfma_f32_16x16x32_bf16 v[88:91], a[80:83], a[0:3], v[88:91]
s_waitcnt lgkmcnt(7)
s_xor_b32 m0, s84, 5120
ds_read_b128 a[60:63], v3 offset:38912
v_mfma_f32_16x16x32_bf16 v[28:31], a[88:91], a[0:3], v[28:31]
s_xor_b32 s64, s73, 16896
ds_read_b64_tr_b16 a[72:73], v10 offset:32768
v_mfma_f32_16x16x32_bf16 v[28:31], a[92:95], a[4:7], v[28:31]
buffer_load_dwordx4 v13, s[48:51], s64 offen lds
v_mfma_f32_16x16x32_bf16 v[44:47], a[92:95], a[12:15], v[44:47]
ds_read_b64_tr_b16 a[74:75], v10 offset:33792
v_add_u32 v7, 0x8000, v7
v_mfma_f32_16x16x32_bf16 v[44:47], a[88:91], a[8:11], v[44:47]
ds_read_b64_tr_b16 a[76:77], v10 offset:40960
v_mfma_f32_16x16x32_bf16 v[60:63], a[88:91], a[16:19], v[60:63]
s_xor_b32 m0, s84, 6144
ds_read_b64_tr_b16 a[78:79], v10 offset:41984
v_mfma_f32_16x16x32_bf16 v[60:63], a[92:95], a[20:23], v[60:63]
s_xor_b32 s64, s73, 131584
ds_read_b64_tr_b16 a[80:81], v11 offset:32768
v_mfma_f32_16x16x32_bf16 v[76:79], a[92:95], a[28:31], v[76:79]
buffer_load_dwordx4 v12, s[48:51], s64 offen lds
v_mfma_f32_16x16x32_bf16 v[76:79], a[88:91], a[24:27], v[76:79]
ds_read_b64_tr_b16 a[82:83], v11 offset:33792
v_mfma_f32_16x16x32_bf16 v[140:143], a[96:99], a[24:27], v[140:143]
ds_read_b64_tr_b16 a[84:85], v11 offset:40960
v_mfma_f32_16x16x32_bf16 v[140:143], a[100:103], a[28:31], v[140:143]
s_xor_b32 m0, s84, 7168
ds_read_b64_tr_b16 a[86:87], v11 offset:41984
v_add_u32 v8, 0x8000, v8
v_mfma_f32_16x16x32_bf16 v[124:127], a[100:103], a[20:23], v[124:127]
s_xor_b32 s64, s73, 147968
v_mfma_f32_16x16x32_bf16 v[124:127], a[96:99], a[16:19], v[124:127]
buffer_load_dwordx4 v13, s[48:51], s64 offen lds
v_mfma_f32_16x16x32_bf16 v[108:111], a[96:99], a[8:11], v[108:111]
v_mfma_f32_16x16x32_bf16 v[108:111], a[100:103], a[12:15], v[108:111]
v_mfma_f32_16x16x32_bf16 v[92:95], a[100:103], a[4:7], v[92:95]
v_add_u32 v9, 0x8000, v9
v_add_u32 v10, 0x8000, v10
v_mfma_f32_16x16x32_bf16 v[92:95], a[96:99], a[0:3], v[92:95]
v_add_u32 v11, 0x8000, v11
v_mfma_f32_16x16x32_bf16 v[32:35], a[104:107], a[0:3], v[32:35]
s_add_u32 s65, s79, 5120
v_mfma_f32_16x16x32_bf16 v[32:35], a[108:111], a[4:7], v[32:35]
buffer_store_dwordx4 a[160:163], v16, s[44:47], s65 offen sc1
v_mfma_f32_16x16x32_bf16 v[48:51], a[108:111], a[12:15], v[48:51]
s_waitcnt lgkmcnt(0)
s_barrier
v_mfma_f32_16x16x32_bf16 v[48:51], a[104:107], a[8:11], v[48:51]
s_xor_b32 m0, s77, 98304
ds_read_b64_tr_b16 a[88:89], v19 offset:36864
v_mfma_f32_16x16x32_bf16 v[64:67], a[104:107], a[16:19], v[64:67]
s_xor_b32 s64, s71, 2621440
ds_read_b64_tr_b16 a[90:91], v19 offset:37120
v_mfma_f32_16x16x32_bf16 v[64:67], a[108:111], a[20:23], v[64:67]
buffer_load_dwordx4 v14, s[56:59], s64 offen lds
v_mfma_f32_16x16x32_bf16 v[80:83], a[108:111], a[28:31], v[80:83]
ds_read_b64_tr_b16 a[92:93], v19 offset:38912
v_mfma_f32_16x16x32_bf16 v[80:83], a[104:107], a[24:27], v[80:83]
ds_read_b64_tr_b16 a[94:95], v19 offset:39168
v_mfma_f32_16x16x32_bf16 v[144:147], a[112:115], a[24:27], v[144:147]
ds_read_b64_tr_b16 a[96:97], v20 offset:36864
v_mfma_f32_16x16x32_bf16 v[144:147], a[116:119], a[28:31], v[144:147]
ds_read_b64_tr_b16 a[98:99], v20 offset:37120
v_mfma_f32_16x16x32_bf16 v[128:131], a[116:119], a[20:23], v[128:131]
ds_read_b64_tr_b16 a[100:101], v20 offset:38912
v_mfma_f32_16x16x32_bf16 v[128:131], a[112:115], a[16:19], v[128:131]
ds_read_b64_tr_b16 a[102:103], v20 offset:39168
v_mfma_f32_16x16x32_bf16 v[112:115], a[112:115], a[8:11], v[112:115]
s_add_u32 m0, s78, 114688
ds_read_b64_tr_b16 a[104:105], v19 offset:40960
v_mfma_f32_16x16x32_bf16 v[112:115], a[116:119], a[12:15], v[112:115]
s_add_u32 s64, s75, 1966080
ds_read_b64_tr_b16 a[106:107], v19 offset:41216
v_mfma_f32_16x16x32_bf16 v[96:99], a[116:119], a[4:7], v[96:99]
buffer_load_dwordx4 v23, s[60:63], s64 offen lds
v_mfma_f32_16x16x32_bf16 v[96:99], a[112:115], a[0:3], v[96:99]
ds_read_b64_tr_b16 a[108:109], v19 offset:43008
v_mfma_f32_16x16x32_bf16 v[36:39], a[72:75], a[0:3], v[36:39]
ds_read_b64_tr_b16 a[110:111], v19 offset:43264
v_mfma_f32_16x16x32_bf16 v[36:39], a[76:79], a[4:7], v[36:39]
ds_read_b64_tr_b16 a[112:113], v20 offset:40960
v_mfma_f32_16x16x32_bf16 v[52:55], a[76:79], a[12:15], v[52:55]
ds_read_b64_tr_b16 a[114:115], v20 offset:41216
v_mfma_f32_16x16x32_bf16 v[52:55], a[72:75], a[8:11], v[52:55]
ds_read_b64_tr_b16 a[116:117], v20 offset:43008
v_mfma_f32_16x16x32_bf16 v[68:71], a[72:75], a[16:19], v[68:71]
s_xor_b32 m0, s77, 99328
ds_read_b64_tr_b16 a[118:119], v20 offset:43264
v_mfma_f32_16x16x32_bf16 v[68:71], a[76:79], a[20:23], v[68:71]
s_xor_b32 s64, s71, 2654208
s_xor_b32 s68, s66, 8192
v_mfma_f32_16x16x32_bf16 v[84:87], a[76:79], a[28:31], v[84:87]
s_mov_b64 exec, 1
buffer_atomic_add a251, v1, s[52:55], s68 offen offset:0 sc1
s_mov_b64 exec, -1
v_mfma_f32_16x16x32_bf16 v[84:87], a[72:75], a[24:27], v[84:87]
buffer_load_dwordx4 v14, s[56:59], s64 offen lds
v_mfma_f32_16x16x32_bf16 v[148:151], a[80:83], a[24:27], v[148:151]
ds_read_b64_tr_b16 a[72:73], v19 offset:32768
v_mfma_f32_16x16x32_bf16 v[148:151], a[84:87], a[28:31], v[148:151]
ds_read_b64_tr_b16 a[74:75], v19 offset:33024
v_mfma_f32_16x16x32_bf16 v[132:135], a[84:87], a[20:23], v[132:135]
ds_read_b64_tr_b16 a[76:77], v19 offset:34816
v_mfma_f32_16x16x32_bf16 v[132:135], a[80:83], a[16:19], v[132:135]
ds_read_b64_tr_b16 a[78:79], v19 offset:35072
v_mfma_f32_16x16x32_bf16 v[116:119], a[80:83], a[8:11], v[116:119]
v_mfma_f32_16x16x32_bf16 v[116:119], a[84:87], a[12:15], v[116:119]
v_mfma_f32_16x16x32_bf16 v[100:103], a[84:87], a[4:7], v[100:103]
s_add_u32 m0, s78, 118784
v_mfma_f32_16x16x32_bf16 v[100:103], a[80:83], a[0:3], v[100:103]
s_waitcnt lgkmcnt(4)
s_add_u32 s64, s75, 1968128
ds_read_b64_tr_b16 a[80:81], v20 offset:32768
v_mfma_f32_16x16x32_bf16 v[184:187], a[88:91], a[32:35], v[184:187]
buffer_load_dwordx4 v23, s[60:63], s64 offen lds
v_mfma_f32_16x16x32_bf16 v[184:187], a[92:95], a[36:39], v[184:187]
ds_read_b64_tr_b16 a[82:83], v20 offset:33024
v_mfma_f32_16x16x32_bf16 v[192:195], a[92:95], a[44:47], v[192:195]
ds_read_b64_tr_b16 a[84:85], v20 offset:34816
v_mfma_f32_16x16x32_bf16 v[192:195], a[88:91], a[40:43], v[192:195]
ds_read_b64_tr_b16 a[86:87], v20 offset:35072
v_mfma_f32_16x16x32_bf16 v[200:203], a[88:91], a[48:51], v[200:203]
v_mfma_f32_16x16x32_bf16 v[200:203], a[92:95], a[52:55], v[200:203]
v_mfma_f32_16x16x32_bf16 v[208:211], a[92:95], a[60:63], v[208:211]
v_mfma_f32_16x16x32_bf16 v[208:211], a[88:91], a[56:59], v[208:211]
ds_read_b64_tr_b16 a[88:89], v4 offset:32768
v_mfma_f32_16x16x32_bf16 v[212:215], a[96:99], a[56:59], v[212:215]
s_xor_b32 m0, s77, 100352
ds_read_b64_tr_b16 a[90:91], v4 offset:33792
v_mfma_f32_16x16x32_bf16 v[212:215], a[100:103], a[60:63], v[212:215]
s_xor_b32 s64, s71, 2686976
ds_read_b64_tr_b16 a[92:93], v4 offset:40960
v_mfma_f32_16x16x32_bf16 v[204:207], a[100:103], a[52:55], v[204:207]
buffer_load_dwordx4 v15, s[56:59], s64 offen lds
v_mfma_f32_16x16x32_bf16 v[204:207], a[96:99], a[48:51], v[204:207]
ds_read_b64_tr_b16 a[94:95], v4 offset:41984
v_mfma_f32_16x16x32_bf16 v[196:199], a[96:99], a[40:43], v[196:199]
v_mfma_f32_16x16x32_bf16 v[196:199], a[100:103], a[44:47], v[196:199]
v_mfma_f32_16x16x32_bf16 v[188:191], a[100:103], a[36:39], v[188:191]
v_mfma_f32_16x16x32_bf16 v[188:191], a[96:99], a[32:35], v[188:191]
ds_read_b64_tr_b16 a[96:97], v5 offset:32768
v_mfma_f32_16x16x32_bf16 v[216:219], a[32:35], a[104:107], v[216:219]
ds_read_b64_tr_b16 a[98:99], v5 offset:33792
v_mfma_f32_16x16x32_bf16 v[216:219], a[36:39], a[108:111], v[216:219]
s_add_u32 m0, s78, 122880
ds_read_b64_tr_b16 a[100:101], v5 offset:40960
v_mfma_f32_16x16x32_bf16 v[224:227], a[44:47], a[108:111], v[224:227]
s_add_u32 s64, s75, 1970176
ds_read_b64_tr_b16 a[102:103], v5 offset:41984
v_mfma_f32_16x16x32_bf16 v[224:227], a[40:43], a[104:107], v[224:227]
s_add_u32 s65, s79, 1024
buffer_load_dwordx4 v23, s[60:63], s64 offen lds
v_mfma_f32_16x16x32_bf16 v[232:235], a[48:51], a[104:107], v[232:235]
buffer_store_dwordx4 a[164:167], v16, s[44:47], s65 offen sc1
v_mfma_f32_16x16x32_bf16 v[232:235], a[52:55], a[108:111], v[232:235]
v_mfma_f32_16x16x32_bf16 v[240:243], a[60:63], a[108:111], v[240:243]
v_mfma_f32_16x16x32_bf16 v[240:243], a[56:59], a[104:107], v[240:243]
ds_read_b64_tr_b16 a[104:105], v6 offset:32768
v_mfma_f32_16x16x32_bf16 v[244:247], a[56:59], a[112:115], v[244:247]
ds_read_b64_tr_b16 a[106:107], v6 offset:33792
v_mfma_f32_16x16x32_bf16 v[244:247], a[60:63], a[116:119], v[244:247]
ds_read_b64_tr_b16 a[108:109], v6 offset:40960
v_subrev_u32 v19, 0x8000, v19
v_mfma_f32_16x16x32_bf16 v[236:239], a[52:55], a[116:119], v[236:239]
s_xor_b32 m0, s77, 101376
ds_read_b64_tr_b16 a[110:111], v6 offset:41984
v_mfma_f32_16x16x32_bf16 v[236:239], a[48:51], a[112:115], v[236:239]
s_xor_b32 s64, s71, 2719744
v_mfma_f32_16x16x32_bf16 v[228:231], a[40:43], a[112:115], v[228:231]
buffer_load_dwordx4 v15, s[56:59], s64 offen lds
v_mfma_f32_16x16x32_bf16 v[228:231], a[44:47], a[116:119], v[228:231]
v_mfma_f32_16x16x32_bf16 v[220:223], a[36:39], a[116:119], v[220:223]
v_mfma_f32_16x16x32_bf16 v[220:223], a[32:35], a[112:115], v[220:223]
s_waitcnt lgkmcnt(4)
ds_read_b64_tr_b16 a[112:113], v7 offset:32768
v_mfma_f32_16x16x32_bf16 v[152:155], a[72:75], a[32:35], v[152:155]
ds_read_b64_tr_b16 a[114:115], v7 offset:33792
v_mfma_f32_16x16x32_bf16 v[152:155], a[76:79], a[36:39], v[152:155]
ds_read_b64_tr_b16 a[116:117], v7 offset:40960
v_subrev_u32 v20, 0x8000, v20
v_mfma_f32_16x16x32_bf16 v[160:163], a[76:79], a[44:47], v[160:163]
ds_read_b64_tr_b16 a[118:119], v7 offset:41984
v_mfma_f32_16x16x32_bf16 v[160:163], a[72:75], a[40:43], v[160:163]
v_mfma_f32_16x16x32_bf16 v[168:171], a[72:75], a[48:51], v[168:171]
v_mfma_f32_16x16x32_bf16 v[168:171], a[76:79], a[52:55], v[168:171]
v_mfma_f32_16x16x32_bf16 v[176:179], a[76:79], a[60:63], v[176:179]
s_xor_b32 m0, s84, 32768
v_mfma_f32_16x16x32_bf16 v[176:179], a[72:75], a[56:59], v[176:179]
s_xor_b32 s64, s72, 640
ds_read_b64_tr_b16 a[72:73], v8 offset:32768
v_mfma_f32_16x16x32_bf16 v[180:183], a[80:83], a[56:59], v[180:183]
buffer_load_dwordx4 v12, s[48:51], s64 offen lds
v_mfma_f32_16x16x32_bf16 v[180:183], a[84:87], a[60:63], v[180:183]
ds_read_b64_tr_b16 a[74:75], v8 offset:33792
v_subrev_u32 v4, 0x8000, v4
v_mfma_f32_16x16x32_bf16 v[172:175], a[84:87], a[52:55], v[172:175]
ds_read_b64_tr_b16 a[76:77], v8 offset:40960
v_mfma_f32_16x16x32_bf16 v[172:175], a[80:83], a[48:51], v[172:175]
s_xor_b32 m0, s84, 33792
ds_read_b64_tr_b16 a[78:79], v8 offset:41984
v_mfma_f32_16x16x32_bf16 v[164:167], a[80:83], a[40:43], v[164:167]
s_xor_b32 s64, s72, 17024
v_mfma_f32_16x16x32_bf16 v[164:167], a[84:87], a[44:47], v[164:167]
buffer_load_dwordx4 v13, s[48:51], s64 offen lds
v_mfma_f32_16x16x32_bf16 v[156:159], a[84:87], a[36:39], v[156:159]
v_mfma_f32_16x16x32_bf16 v[156:159], a[80:83], a[32:35], v[156:159]
ds_read_b64_tr_b16 a[80:81], v9 offset:32768
v_mfma_f32_16x16x32_bf16 v[24:27], a[88:91], a[32:35], v[24:27]
s_xor_b32 m0, s84, 34816
ds_read_b64_tr_b16 a[82:83], v9 offset:33792
v_mfma_f32_16x16x32_bf16 v[24:27], a[92:95], a[36:39], v[24:27]
s_xor_b32 s64, s72, 131712
ds_read_b64_tr_b16 a[84:85], v9 offset:40960
v_subrev_u32 v5, 0x8000, v5
v_mfma_f32_16x16x32_bf16 v[40:43], a[92:95], a[44:47], v[40:43]
buffer_load_dwordx4 v12, s[48:51], s64 offen lds
v_mfma_f32_16x16x32_bf16 v[40:43], a[88:91], a[40:43], v[40:43]
ds_read_b64_tr_b16 a[86:87], v9 offset:41984
v_mfma_f32_16x16x32_bf16 v[56:59], a[88:91], a[48:51], v[56:59]
v_mfma_f32_16x16x32_bf16 v[56:59], a[92:95], a[52:55], v[56:59]
s_xor_b32 m0, s84, 35840
v_mfma_f32_16x16x32_bf16 v[72:75], a[92:95], a[60:63], v[72:75]
s_waitcnt vmcnt(13)
s_xor_b32 s64, s72, 148096
ds_read_b128 a[0:3], v2 offset:0
v_mfma_f32_16x16x32_bf16 v[72:75], a[88:91], a[56:59], v[72:75]
buffer_load_dwordx4 v13, s[48:51], s64 offen lds
v_mfma_f32_16x16x32_bf16 v[136:139], a[96:99], a[56:59], v[136:139]
ds_read_b128 a[4:7], v3 offset:0
v_mfma_f32_16x16x32_bf16 v[136:139], a[100:103], a[60:63], v[136:139]
ds_read_b128 a[8:11], v2 offset:2048
v_subrev_u32 v6, 0x8000, v6
v_mfma_f32_16x16x32_bf16 v[120:123], a[100:103], a[52:55], v[120:123]
s_xor_b32 m0, s84, 36864
ds_read_b128 a[12:15], v3 offset:2048
v_mfma_f32_16x16x32_bf16 v[120:123], a[96:99], a[48:51], v[120:123]
s_xor_b32 s64, s73, 640
ds_read_b128 a[16:19], v2 offset:4096
v_mfma_f32_16x16x32_bf16 v[104:107], a[96:99], a[40:43], v[104:107]
buffer_load_dwordx4 v12, s[48:51], s64 offen lds
v_mfma_f32_16x16x32_bf16 v[104:107], a[100:103], a[44:47], v[104:107]
ds_read_b128 a[20:23], v3 offset:4096
v_mfma_f32_16x16x32_bf16 v[88:91], a[100:103], a[36:39], v[88:91]
ds_read_b128 a[24:27], v2 offset:6144
v_mfma_f32_16x16x32_bf16 v[88:91], a[96:99], a[32:35], v[88:91]
s_waitcnt lgkmcnt(7)
s_xor_b32 m0, s84, 37888
ds_read_b128 a[28:31], v3 offset:6144
v_mfma_f32_16x16x32_bf16 v[28:31], a[104:107], a[32:35], v[28:31]
s_xor_b32 s64, s73, 17024
ds_read_b64_tr_b16 a[88:89], v10 offset:32768
v_mfma_f32_16x16x32_bf16 v[28:31], a[108:111], a[36:39], v[28:31]
buffer_load_dwordx4 v13, s[48:51], s64 offen lds
v_mfma_f32_16x16x32_bf16 v[44:47], a[108:111], a[44:47], v[44:47]
ds_read_b64_tr_b16 a[90:91], v10 offset:33792
v_subrev_u32 v7, 0x8000, v7
v_mfma_f32_16x16x32_bf16 v[44:47], a[104:107], a[40:43], v[44:47]
s_add_u32 s65, s79, 18432
ds_read_b64_tr_b16 a[92:93], v10 offset:40960
v_mfma_f32_16x16x32_bf16 v[60:63], a[104:107], a[48:51], v[60:63]
s_xor_b32 m0, s84, 38912
buffer_store_dwordx4 a[168:171], v16, s[44:47], s65 offen sc1
v_mfma_f32_16x16x32_bf16 v[60:63], a[108:111], a[52:55], v[60:63]
s_xor_b32 s64, s73, 131712
ds_read_b64_tr_b16 a[94:95], v10 offset:41984
v_mfma_f32_16x16x32_bf16 v[76:79], a[108:111], a[60:63], v[76:79]
buffer_load_dwordx4 v12, s[48:51], s64 offen lds
v_mfma_f32_16x16x32_bf16 v[76:79], a[104:107], a[56:59], v[76:79]
ds_read_b64_tr_b16 a[96:97], v11 offset:32768
v_mfma_f32_16x16x32_bf16 v[140:143], a[112:115], a[56:59], v[140:143]
ds_read_b64_tr_b16 a[98:99], v11 offset:33792
v_mfma_f32_16x16x32_bf16 v[140:143], a[116:119], a[60:63], v[140:143]
s_xor_b32 m0, s84, 39936
ds_read_b64_tr_b16 a[100:101], v11 offset:40960
v_subrev_u32 v8, 0x8000, v8
v_mfma_f32_16x16x32_bf16 v[124:127], a[116:119], a[52:55], v[124:127]
s_xor_b32 s64, s73, 148096
ds_read_b64_tr_b16 a[102:103], v11 offset:41984
v_mfma_f32_16x16x32_bf16 v[124:127], a[112:115], a[48:51], v[124:127]
buffer_load_dwordx4 v13, s[48:51], s64 offen lds
v_mfma_f32_16x16x32_bf16 v[108:111], a[112:115], a[40:43], v[108:111]
v_mfma_f32_16x16x32_bf16 v[108:111], a[116:119], a[44:47], v[108:111]
v_mfma_f32_16x16x32_bf16 v[92:95], a[116:119], a[36:39], v[92:95]
v_subrev_u32 v9, 0x8000, v9
v_subrev_u32 v10, 0x8000, v10
v_mfma_f32_16x16x32_bf16 v[92:95], a[112:115], a[32:35], v[92:95]
v_subrev_u32 v11, 0x8000, v11
v_mfma_f32_16x16x32_bf16 v[32:35], a[72:75], a[32:35], v[32:35]
v_mfma_f32_16x16x32_bf16 v[32:35], a[76:79], a[36:39], v[32:35]
v_mfma_f32_16x16x32_bf16 v[48:51], a[76:79], a[44:47], v[48:51]
s_waitcnt lgkmcnt(0)
s_barrier
v_mfma_f32_16x16x32_bf16 v[48:51], a[72:75], a[40:43], v[48:51]
s_xor_b32 m0, s77, 131072
ds_read_b64_tr_b16 a[104:105], v19 offset:4096
v_mfma_f32_16x16x32_bf16 v[64:67], a[72:75], a[48:51], v[64:67]
s_xor_b32 s64, s71, 3145728
ds_read_b64_tr_b16 a[106:107], v19 offset:4352
v_mfma_f32_16x16x32_bf16 v[64:67], a[76:79], a[52:55], v[64:67]
buffer_load_dwordx4 v14, s[56:59], s64 offen lds
v_mfma_f32_16x16x32_bf16 v[80:83], a[76:79], a[60:63], v[80:83]
ds_read_b64_tr_b16 a[108:109], v19 offset:6144
v_mfma_f32_16x16x32_bf16 v[80:83], a[72:75], a[56:59], v[80:83]
ds_read_b64_tr_b16 a[110:111], v19 offset:6400
v_mfma_f32_16x16x32_bf16 v[144:147], a[80:83], a[56:59], v[144:147]
ds_read_b64_tr_b16 a[112:113], v20 offset:4096
v_mfma_f32_16x16x32_bf16 v[144:147], a[84:87], a[60:63], v[144:147]
ds_read_b64_tr_b16 a[114:115], v20 offset:4352
v_mfma_f32_16x16x32_bf16 v[128:131], a[84:87], a[52:55], v[128:131]
ds_read_b64_tr_b16 a[116:117], v20 offset:6144
v_mfma_f32_16x16x32_bf16 v[128:131], a[80:83], a[48:51], v[128:131]
ds_read_b64_tr_b16 a[118:119], v20 offset:6400
v_mfma_f32_16x16x32_bf16 v[112:115], a[80:83], a[40:43], v[112:115]
s_add_u32 m0, s78, 147456
ds_read_b64_tr_b16 a[72:73], v19 offset:8192
v_mfma_f32_16x16x32_bf16 v[112:115], a[84:87], a[44:47], v[112:115]
s_add_u32 s64, s75, 2359296
ds_read_b64_tr_b16 a[74:75], v19 offset:8448
v_mfma_f32_16x16x32_bf16 v[96:99], a[84:87], a[36:39], v[96:99]
buffer_load_dwordx4 v23, s[60:63], s64 offen lds
v_mfma_f32_16x16x32_bf16 v[96:99], a[80:83], a[32:35], v[96:99]
ds_read_b64_tr_b16 a[76:77], v19 offset:10240
v_mfma_f32_16x16x32_bf16 v[36:39], a[88:91], a[32:35], v[36:39]
s_branch L_po8
L_pg8:
s_branch L_pg12
L_po8:
ds_read_b64_tr_b16 a[78:79], v19 offset:10496
v_mfma_f32_16x16x32_bf16 v[36:39], a[92:95], a[36:39], v[36:39]
ds_read_b64_tr_b16 a[80:81], v20 offset:8192
v_mfma_f32_16x16x32_bf16 v[52:55], a[92:95], a[44:47], v[52:55]
ds_read_b64_tr_b16 a[82:83], v20 offset:8448
v_mfma_f32_16x16x32_bf16 v[52:55], a[88:91], a[40:43], v[52:55]
ds_read_b64_tr_b16 a[84:85], v20 offset:10240
v_mfma_f32_16x16x32_bf16 v[68:71], a[88:91], a[48:51], v[68:71]
s_xor_b32 m0, s77, 132096
ds_read_b64_tr_b16 a[86:87], v20 offset:10496
v_mfma_f32_16x16x32_bf16 v[68:71], a[92:95], a[52:55], v[68:71]
s_xor_b32 s64, s71, 3178496
s_xor_b32 s68, s66, 12288
v_mfma_f32_16x16x32_bf16 v[84:87], a[92:95], a[60:63], v[84:87]
s_mov_b64 exec, 1
buffer_atomic_add a251, v1, s[52:55], s68 offen offset:0 sc1
s_mov_b64 exec, -1
v_mfma_f32_16x16x32_bf16 v[84:87], a[88:91], a[56:59], v[84:87]
buffer_load_dwordx4 v14, s[56:59], s64 offen lds
v_mfma_f32_16x16x32_bf16 v[148:151], a[96:99], a[56:59], v[148:151]
ds_read_b64_tr_b16 a[88:89], v19 offset:0
v_mfma_f32_16x16x32_bf16 v[148:151], a[100:103], a[60:63], v[148:151]
ds_read_b64_tr_b16 a[90:91], v19 offset:256
v_mfma_f32_16x16x32_bf16 v[132:135], a[100:103], a[52:55], v[132:135]
ds_read_b64_tr_b16 a[92:93], v19 offset:2048
v_mfma_f32_16x16x32_bf16 v[132:135], a[96:99], a[48:51], v[132:135]
ds_read_b64_tr_b16 a[94:95], v19 offset:2304
v_mfma_f32_16x16x32_bf16 v[116:119], a[96:99], a[40:43], v[116:119]
v_mfma_f32_16x16x32_bf16 v[116:119], a[100:103], a[44:47], v[116:119]
v_mfma_f32_16x16x32_bf16 v[100:103], a[100:103], a[36:39], v[100:103]
s_add_u32 m0, s78, 151552
v_mfma_f32_16x16x32_bf16 v[100:103], a[96:99], a[32:35], v[100:103]
s_waitcnt lgkmcnt(4)
s_add_u32 s64, s75, 2361344
ds_read_b64_tr_b16 a[96:97], v20 offset:0
v_mfma_f32_16x16x32_bf16 v[184:187], a[104:107], a[0:3], v[184:187]
s_mov_b32 s36, s20
buffer_load_dwordx4 v23, s[60:63], s64 offen lds
v_mfma_f32_16x16x32_bf16 v[184:187], a[108:111], a[4:7], v[184:187]
s_mov_b32 s37, s21
ds_read_b64_tr_b16 a[98:99], v20 offset:256
v_mfma_f32_16x16x32_bf16 v[192:195], a[108:111], a[12:15], v[192:195]
s_mov_b32 s38, 2097152
ds_read_b64_tr_b16 a[100:101], v20 offset:2048
v_mfma_f32_16x16x32_bf16 v[192:195], a[104:107], a[8:11], v[192:195]
s_mov_b32 s40, s14
ds_read_b64_tr_b16 a[102:103], v20 offset:2304
v_mfma_f32_16x16x32_bf16 v[200:203], a[104:107], a[16:19], v[200:203]
s_mov_b32 s41, s15
s_add_u32 s65, s79, 6144
v_mfma_f32_16x16x32_bf16 v[200:203], a[108:111], a[20:23], v[200:203]
s_mov_b32 s42, 8388608
buffer_store_dwordx4 a[172:175], v16, s[44:47], s65 offen sc1
v_mfma_f32_16x16x32_bf16 v[208:211], a[108:111], a[28:31], v[208:211]
v_mfma_f32_16x16x32_bf16 v[208:211], a[104:107], a[24:27], v[208:211]
ds_read_b64_tr_b16 a[104:105], v4 offset:0
v_mfma_f32_16x16x32_bf16 v[212:215], a[112:115], a[24:27], v[212:215]
s_xor_b32 m0, s77, 133120
ds_read_b64_tr_b16 a[106:107], v4 offset:1024
v_mfma_f32_16x16x32_bf16 v[212:215], a[116:119], a[28:31], v[212:215]
s_xor_b32 s64, s71, 3211264
ds_read_b64_tr_b16 a[108:109], v4 offset:8192
v_mfma_f32_16x16x32_bf16 v[204:207], a[116:119], a[20:23], v[204:207]
buffer_load_dwordx4 v15, s[56:59], s64 offen lds
v_mfma_f32_16x16x32_bf16 v[204:207], a[112:115], a[16:19], v[204:207]
ds_read_b64_tr_b16 a[110:111], v4 offset:9216
v_mfma_f32_16x16x32_bf16 v[196:199], a[112:115], a[8:11], v[196:199]
v_mfma_f32_16x16x32_bf16 v[196:199], a[116:119], a[12:15], v[196:199]
v_mfma_f32_16x16x32_bf16 v[188:191], a[116:119], a[4:7], v[188:191]
v_mfma_f32_16x16x32_bf16 v[188:191], a[112:115], a[0:3], v[188:191]
ds_read_b64_tr_b16 a[112:113], v5 offset:0
v_mfma_f32_16x16x32_bf16 v[216:219], a[0:3], a[72:75], v[216:219]
ds_read_b64_tr_b16 a[114:115], v5 offset:1024
v_mfma_f32_16x16x32_bf16 v[216:219], a[4:7], a[76:79], v[216:219]
s_add_u32 m0, s78, 155648
ds_read_b64_tr_b16 a[116:117], v5 offset:8192
v_mfma_f32_16x16x32_bf16 v[224:227], a[12:15], a[76:79], v[224:227]
s_add_u32 s64, s75, 2363392
ds_read_b64_tr_b16 a[118:119], v5 offset:9216
v_mfma_f32_16x16x32_bf16 v[224:227], a[8:11], a[72:75], v[224:227]
buffer_load_dwordx4 v23, s[60:63], s64 offen lds
v_mfma_f32_16x16x32_bf16 v[232:235], a[16:19], a[72:75], v[232:235]
v_mfma_f32_16x16x32_bf16 v[232:235], a[20:23], a[76:79], v[232:235]
v_mfma_f32_16x16x32_bf16 v[240:243], a[28:31], a[76:79], v[240:243]
v_mfma_f32_16x16x32_bf16 v[240:243], a[24:27], a[72:75], v[240:243]
ds_read_b64_tr_b16 a[72:73], v6 offset:0
v_mfma_f32_16x16x32_bf16 v[244:247], a[24:27], a[80:83], v[244:247]
ds_read_b64_tr_b16 a[74:75], v6 offset:1024
v_mfma_f32_16x16x32_bf16 v[244:247], a[28:31], a[84:87], v[244:247]
ds_read_b64_tr_b16 a[76:77], v6 offset:8192
v_mfma_f32_16x16x32_bf16 v[236:239], a[20:23], a[84:87], v[236:239]
s_xor_b32 m0, s77, 134144
ds_read_b64_tr_b16 a[78:79], v6 offset:9216
v_mfma_f32_16x16x32_bf16 v[236:239], a[16:19], a[80:83], v[236:239]
s_xor_b32 s64, s71, 3244032
v_mfma_f32_16x16x32_bf16 v[228:231], a[8:11], a[80:83], v[228:231]
buffer_load_dwordx4 v15, s[56:59], s64 offen lds
v_mfma_f32_16x16x32_bf16 v[228:231], a[12:15], a[84:87], v[228:231]
v_mfma_f32_16x16x32_bf16 v[220:223], a[4:7], a[84:87], v[220:223]
v_mfma_f32_16x16x32_bf16 v[220:223], a[0:3], a[80:83], v[220:223]
s_waitcnt lgkmcnt(4)
ds_read_b64_tr_b16 a[80:81], v7 offset:0
v_mfma_f32_16x16x32_bf16 v[152:155], a[88:91], a[0:3], v[152:155]
ds_read_b64_tr_b16 a[82:83], v7 offset:1024
v_mfma_f32_16x16x32_bf16 v[152:155], a[92:95], a[4:7], v[152:155]
ds_read_b64_tr_b16 a[84:85], v7 offset:8192
v_mfma_f32_16x16x32_bf16 v[160:163], a[92:95], a[12:15], v[160:163]
ds_read_b64_tr_b16 a[86:87], v7 offset:9216
v_mfma_f32_16x16x32_bf16 v[160:163], a[88:91], a[8:11], v[160:163]
v_mfma_f32_16x16x32_bf16 v[168:171], a[88:91], a[16:19], v[168:171]
v_mfma_f32_16x16x32_bf16 v[168:171], a[92:95], a[20:23], v[168:171]
v_mfma_f32_16x16x32_bf16 v[176:179], a[92:95], a[28:31], v[176:179]
s_xor_b32 m0, s84, 0
v_mfma_f32_16x16x32_bf16 v[176:179], a[88:91], a[24:27], v[176:179]
s_xor_b32 s64, s72, 768
ds_read_b64_tr_b16 a[88:89], v8 offset:0
v_mfma_f32_16x16x32_bf16 v[180:183], a[96:99], a[24:27], v[180:183]
buffer_load_dwordx4 v12, s[48:51], s64 offen lds
v_mfma_f32_16x16x32_bf16 v[180:183], a[100:103], a[28:31], v[180:183]
ds_read_b64_tr_b16 a[90:91], v8 offset:1024
v_mfma_f32_16x16x32_bf16 v[172:175], a[100:103], a[20:23], v[172:175]
ds_read_b64_tr_b16 a[92:93], v8 offset:8192
v_mfma_f32_16x16x32_bf16 v[172:175], a[96:99], a[16:19], v[172:175]
s_xor_b32 m0, s84, 1024
ds_read_b64_tr_b16 a[94:95], v8 offset:9216
v_mfma_f32_16x16x32_bf16 v[164:167], a[96:99], a[8:11], v[164:167]
s_xor_b32 s64, s72, 17152
v_mfma_f32_16x16x32_bf16 v[164:167], a[100:103], a[12:15], v[164:167]
buffer_load_dwordx4 v13, s[48:51], s64 offen lds
v_mfma_f32_16x16x32_bf16 v[156:159], a[100:103], a[4:7], v[156:159]
v_mfma_f32_16x16x32_bf16 v[156:159], a[96:99], a[0:3], v[156:159]
ds_read_b64_tr_b16 a[96:97], v9 offset:0
v_mfma_f32_16x16x32_bf16 v[24:27], a[104:107], a[0:3], v[24:27]
s_xor_b32 m0, s84, 2048
ds_read_b64_tr_b16 a[98:99], v9 offset:1024
v_mfma_f32_16x16x32_bf16 v[24:27], a[108:111], a[4:7], v[24:27]
s_xor_b32 s64, s72, 131840
ds_read_b64_tr_b16 a[100:101], v9 offset:8192
v_mfma_f32_16x16x32_bf16 v[40:43], a[108:111], a[12:15], v[40:43]
buffer_load_dwordx4 v12, s[48:51], s64 offen lds
v_mfma_f32_16x16x32_bf16 v[40:43], a[104:107], a[8:11], v[40:43]
ds_read_b64_tr_b16 a[102:103], v9 offset:9216
v_mfma_f32_16x16x32_bf16 v[56:59], a[104:107], a[16:19], v[56:59]
v_mfma_f32_16x16x32_bf16 v[56:59], a[108:111], a[20:23], v[56:59]
s_xor_b32 m0, s84, 3072
v_mfma_f32_16x16x32_bf16 v[72:75], a[108:111], a[28:31], v[72:75]
s_waitcnt vmcnt(12)
s_xor_b32 s64, s72, 148224
ds_read_b128 a[32:35], v2 offset:32768
v_mfma_f32_16x16x32_bf16 v[72:75], a[104:107], a[24:27], v[72:75]
s_add_u32 s65, s79, 2048
buffer_load_dwordx4 v13, s[48:51], s64 offen lds
v_mfma_f32_16x16x32_bf16 v[136:139], a[112:115], a[24:27], v[136:139]
buffer_store_dwordx4 a[176:179], v16, s[44:47], s65 offen sc1
v_mfma_f32_16x16x32_bf16 v[136:139], a[116:119], a[28:31], v[136:139]
ds_read_b128 a[36:39], v3 offset:32768
v_mfma_f32_16x16x32_bf16 v[120:123], a[116:119], a[20:23], v[120:123]
s_xor_b32 m0, s84, 4096
ds_read_b128 a[40:43], v2 offset:34816
v_mfma_f32_16x16x32_bf16 v[120:123], a[112:115], a[16:19], v[120:123]
s_xor_b32 s64, s73, 768
ds_read_b128 a[44:47], v3 offset:34816
v_mfma_f32_16x16x32_bf16 v[104:107], a[112:115], a[8:11], v[104:107]
buffer_load_dwordx4 v12, s[48:51], s64 offen lds
v_mfma_f32_16x16x32_bf16 v[104:107], a[116:119], a[12:15], v[104:107]
ds_read_b128 a[48:51], v2 offset:36864
v_mfma_f32_16x16x32_bf16 v[88:91], a[116:119], a[4:7], v[88:91]
ds_read_b128 a[52:55], v3 offset:36864
v_mfma_f32_16x16x32_bf16 v[88:91], a[112:115], a[0:3], v[88:91]
s_waitcnt lgkmcnt(6)
s_xor_b32 m0, s84, 5120
ds_read_b128 a[56:59], v2 offset:38912
v_mfma_f32_16x16x32_bf16 v[28:31], a[72:75], a[0:3], v[28:31]
s_xor_b32 s64, s73, 17152
ds_read_b128 a[60:63], v3 offset:38912
v_mfma_f32_16x16x32_bf16 v[28:31], a[76:79], a[4:7], v[28:31]
buffer_load_dwordx4 v13, s[48:51], s64 offen lds
v_mfma_f32_16x16x32_bf16 v[44:47], a[76:79], a[12:15], v[44:47]
ds_read_b64_tr_b16 a[104:105], v10 offset:0
v_mfma_f32_16x16x32_bf16 v[44:47], a[72:75], a[8:11], v[44:47]
ds_read_b64_tr_b16 a[106:107], v10 offset:1024
v_mfma_f32_16x16x32_bf16 v[60:63], a[72:75], a[16:19], v[60:63]
s_xor_b32 m0, s84, 6144
ds_read_b64_tr_b16 a[108:109], v10 offset:8192
v_mfma_f32_16x16x32_bf16 v[60:63], a[76:79], a[20:23], v[60:63]
s_xor_b32 s64, s73, 131840
ds_read_b64_tr_b16 a[110:111], v10 offset:9216
v_mfma_f32_16x16x32_bf16 v[76:79], a[76:79], a[28:31], v[76:79]
buffer_load_dwordx4 v12, s[48:51], s64 offen lds
v_mfma_f32_16x16x32_bf16 v[76:79], a[72:75], a[24:27], v[76:79]
ds_read_b64_tr_b16 a[112:113], v11 offset:0
v_mfma_f32_16x16x32_bf16 v[140:143], a[80:83], a[24:27], v[140:143]
ds_read_b64_tr_b16 a[114:115], v11 offset:1024
v_mfma_f32_16x16x32_bf16 v[140:143], a[84:87], a[28:31], v[140:143]
s_xor_b32 m0, s84, 7168
ds_read_b64_tr_b16 a[116:117], v11 offset:8192
v_mfma_f32_16x16x32_bf16 v[124:127], a[84:87], a[20:23], v[124:127]
s_xor_b32 s64, s73, 148224
ds_read_b64_tr_b16 a[118:119], v11 offset:9216
v_mfma_f32_16x16x32_bf16 v[124:127], a[80:83], a[16:19], v[124:127]
buffer_load_dwordx4 v13, s[48:51], s64 offen lds
v_mfma_f32_16x16x32_bf16 v[108:111], a[80:83], a[8:11], v[108:111]
v_mfma_f32_16x16x32_bf16 v[108:111], a[84:87], a[12:15], v[108:111]
v_mfma_f32_16x16x32_bf16 v[92:95], a[84:87], a[4:7], v[92:95]
v_mfma_f32_16x16x32_bf16 v[92:95], a[80:83], a[0:3], v[92:95]
v_mfma_f32_16x16x32_bf16 v[32:35], a[88:91], a[0:3], v[32:35]
v_mfma_f32_16x16x32_bf16 v[32:35], a[92:95], a[4:7], v[32:35]
v_mfma_f32_16x16x32_bf16 v[48:51], a[92:95], a[12:15], v[48:51]
s_waitcnt lgkmcnt(0)
s_barrier
v_mfma_f32_16x16x32_bf16 v[48:51], a[88:91], a[8:11], v[48:51]
s_xor_b32 m0, s77, 65536
ds_read_b64_tr_b16 a[72:73], v19 offset:36864
v_mfma_f32_16x16x32_bf16 v[64:67], a[88:91], a[16:19], v[64:67]
s_xor_b32 s64, s71, 3670016
ds_read_b64_tr_b16 a[74:75], v19 offset:37120
v_mfma_f32_16x16x32_bf16 v[64:67], a[92:95], a[20:23], v[64:67]
buffer_load_dwordx4 v14, s[56:59], s64 offen lds
v_mfma_f32_16x16x32_bf16 v[80:83], a[92:95], a[28:31], v[80:83]
ds_read_b64_tr_b16 a[76:77], v19 offset:38912
v_mfma_f32_16x16x32_bf16 v[80:83], a[88:91], a[24:27], v[80:83]
ds_read_b64_tr_b16 a[78:79], v19 offset:39168
v_mfma_f32_16x16x32_bf16 v[144:147], a[96:99], a[24:27], v[144:147]
ds_read_b64_tr_b16 a[80:81], v20 offset:36864
v_mfma_f32_16x16x32_bf16 v[144:147], a[100:103], a[28:31], v[144:147]
ds_read_b64_tr_b16 a[82:83], v20 offset:37120
v_mfma_f32_16x16x32_bf16 v[128:131], a[100:103], a[20:23], v[128:131]
ds_read_b64_tr_b16 a[84:85], v20 offset:38912
v_mfma_f32_16x16x32_bf16 v[128:131], a[96:99], a[16:19], v[128:131]
ds_read_b64_tr_b16 a[86:87], v20 offset:39168
v_mfma_f32_16x16x32_bf16 v[112:115], a[96:99], a[8:11], v[112:115]
s_add_u32 m0, s78, 81920
ds_read_b64_tr_b16 a[88:89], v19 offset:40960
v_mfma_f32_16x16x32_bf16 v[112:115], a[100:103], a[12:15], v[112:115]
s_add_u32 s64, s75, 2752512
ds_read_b64_tr_b16 a[90:91], v19 offset:41216
v_mfma_f32_16x16x32_bf16 v[96:99], a[100:103], a[4:7], v[96:99]
buffer_load_dwordx4 v23, s[60:63], s64 offen lds
v_mfma_f32_16x16x32_bf16 v[96:99], a[96:99], a[0:3], v[96:99]
ds_read_b64_tr_b16 a[92:93], v19 offset:43008
v_mfma_f32_16x16x32_bf16 v[36:39], a[104:107], a[0:3], v[36:39]
ds_read_b64_tr_b16 a[94:95], v19 offset:43264
v_mfma_f32_16x16x32_bf16 v[36:39], a[108:111], a[4:7], v[36:39]
ds_read_b64_tr_b16 a[96:97], v20 offset:40960
v_mfma_f32_16x16x32_bf16 v[52:55], a[108:111], a[12:15], v[52:55]
ds_read_b64_tr_b16 a[98:99], v20 offset:41216
v_mfma_f32_16x16x32_bf16 v[52:55], a[104:107], a[8:11], v[52:55]
ds_read_b64_tr_b16 a[100:101], v20 offset:43008
v_mfma_f32_16x16x32_bf16 v[68:71], a[104:107], a[16:19], v[68:71]
ds_read_b64_tr_b16 a[102:103], v20 offset:43264
v_mfma_f32_16x16x32_bf16 v[68:71], a[108:111], a[20:23], v[68:71]
s_xor_b32 m0, s77, 66560
v_mfma_f32_16x16x32_bf16 v[84:87], a[108:111], a[28:31], v[84:87]
s_xor_b32 s64, s71, 3702784
v_mfma_f32_16x16x32_bf16 v[84:87], a[104:107], a[24:27], v[84:87]
s_add_u32 s65, s79, 19456
buffer_load_dwordx4 v14, s[56:59], s64 offen lds
v_mfma_f32_16x16x32_bf16 v[148:151], a[112:115], a[24:27], v[148:151]
buffer_store_dwordx4 a[180:183], v16, s[44:47], s65 offen sc1
v_mfma_f32_16x16x32_bf16 v[148:151], a[116:119], a[28:31], v[148:151]
ds_read_b64_tr_b16 a[104:105], v19 offset:32768
v_mfma_f32_16x16x32_bf16 v[132:135], a[116:119], a[20:23], v[132:135]
ds_read_b64_tr_b16 a[106:107], v19 offset:33024
v_mfma_f32_16x16x32_bf16 v[132:135], a[112:115], a[16:19], v[132:135]
ds_read_b64_tr_b16 a[108:109], v19 offset:34816
v_mfma_f32_16x16x32_bf16 v[116:119], a[112:115], a[8:11], v[116:119]
ds_read_b64_tr_b16 a[110:111], v19 offset:35072
v_mfma_f32_16x16x32_bf16 v[116:119], a[116:119], a[12:15], v[116:119]
v_mfma_f32_16x16x32_bf16 v[100:103], a[116:119], a[4:7], v[100:103]
s_add_u32 m0, s78, 86016
v_mfma_f32_16x16x32_bf16 v[100:103], a[112:115], a[0:3], v[100:103]
s_waitcnt lgkmcnt(4)
s_add_u32 s64, s75, 2754560
ds_read_b64_tr_b16 a[112:113], v20 offset:32768
v_mfma_f32_16x16x32_bf16 v[184:187], a[72:75], a[32:35], v[184:187]
buffer_load_dwordx4 v23, s[60:63], s64 offen lds
v_mfma_f32_16x16x32_bf16 v[184:187], a[76:79], a[36:39], v[184:187]
ds_read_b64_tr_b16 a[114:115], v20 offset:33024
v_mfma_f32_16x16x32_bf16 v[192:195], a[76:79], a[44:47], v[192:195]
ds_read_b64_tr_b16 a[116:117], v20 offset:34816
v_mfma_f32_16x16x32_bf16 v[192:195], a[72:75], a[40:43], v[192:195]
ds_read_b64_tr_b16 a[118:119], v20 offset:35072
v_mfma_f32_16x16x32_bf16 v[200:203], a[72:75], a[48:51], v[200:203]
v_mfma_f32_16x16x32_bf16 v[200:203], a[76:79], a[52:55], v[200:203]
v_mfma_f32_16x16x32_bf16 v[208:211], a[76:79], a[60:63], v[208:211]
v_mfma_f32_16x16x32_bf16 v[208:211], a[72:75], a[56:59], v[208:211]
ds_read_b64_tr_b16 a[72:73], v4 offset:32768
v_mfma_f32_16x16x32_bf16 v[212:215], a[80:83], a[56:59], v[212:215]
s_xor_b32 m0, s77, 67584
ds_read_b64_tr_b16 a[74:75], v4 offset:33792
v_mfma_f32_16x16x32_bf16 v[212:215], a[84:87], a[60:63], v[212:215]
s_xor_b32 s64, s71, 3735552
ds_read_b64_tr_b16 a[76:77], v4 offset:40960
v_mfma_f32_16x16x32_bf16 v[204:207], a[84:87], a[52:55], v[204:207]
buffer_load_dwordx4 v15, s[56:59], s64 offen lds
v_mfma_f32_16x16x32_bf16 v[204:207], a[80:83], a[48:51], v[204:207]
ds_read_b64_tr_b16 a[78:79], v4 offset:41984
v_mfma_f32_16x16x32_bf16 v[196:199], a[80:83], a[40:43], v[196:199]
v_mfma_f32_16x16x32_bf16 v[196:199], a[84:87], a[44:47], v[196:199]
v_mfma_f32_16x16x32_bf16 v[188:191], a[84:87], a[36:39], v[188:191]
v_mfma_f32_16x16x32_bf16 v[188:191], a[80:83], a[32:35], v[188:191]
ds_read_b64_tr_b16 a[80:81], v5 offset:32768
v_mfma_f32_16x16x32_bf16 v[216:219], a[32:35], a[88:91], v[216:219]
ds_read_b64_tr_b16 a[82:83], v5 offset:33792
v_mfma_f32_16x16x32_bf16 v[216:219], a[36:39], a[92:95], v[216:219]
s_add_u32 m0, s78, 90112
ds_read_b64_tr_b16 a[84:85], v5 offset:40960
v_mfma_f32_16x16x32_bf16 v[224:227], a[44:47], a[92:95], v[224:227]
s_add_u32 s64, s75, 2756608
ds_read_b64_tr_b16 a[86:87], v5 offset:41984
v_mfma_f32_16x16x32_bf16 v[224:227], a[40:43], a[88:91], v[224:227]
buffer_load_dwordx4 v23, s[60:63], s64 offen lds
v_mfma_f32_16x16x32_bf16 v[232:235], a[48:51], a[88:91], v[232:235]
v_mfma_f32_16x16x32_bf16 v[232:235], a[52:55], a[92:95], v[232:235]
v_mfma_f32_16x16x32_bf16 v[240:243], a[60:63], a[92:95], v[240:243]
v_mfma_f32_16x16x32_bf16 v[240:243], a[56:59], a[88:91], v[240:243]
ds_read_b64_tr_b16 a[88:89], v6 offset:32768
v_mfma_f32_16x16x32_bf16 v[244:247], a[56:59], a[96:99], v[244:247]
ds_read_b64_tr_b16 a[90:91], v6 offset:33792
v_mfma_f32_16x16x32_bf16 v[244:247], a[60:63], a[100:103], v[244:247]
ds_read_b64_tr_b16 a[92:93], v6 offset:40960
v_add_u32 v19, 0x8000, v19
v_mfma_f32_16x16x32_bf16 v[236:239], a[52:55], a[100:103], v[236:239]
s_xor_b32 m0, s77, 68608
ds_read_b64_tr_b16 a[94:95], v6 offset:41984
v_mfma_f32_16x16x32_bf16 v[236:239], a[48:51], a[96:99], v[236:239]
s_xor_b32 s64, s71, 3768320
v_mfma_f32_16x16x32_bf16 v[228:231], a[40:43], a[96:99], v[228:231]
buffer_load_dwordx4 v15, s[56:59], s64 offen lds
v_mfma_f32_16x16x32_bf16 v[228:231], a[44:47], a[100:103], v[228:231]
v_mfma_f32_16x16x32_bf16 v[220:223], a[36:39], a[100:103], v[220:223]
v_mfma_f32_16x16x32_bf16 v[220:223], a[32:35], a[96:99], v[220:223]
s_waitcnt lgkmcnt(4)
ds_read_b64_tr_b16 a[96:97], v7 offset:32768
v_mfma_f32_16x16x32_bf16 v[152:155], a[104:107], a[32:35], v[152:155]
ds_read_b64_tr_b16 a[98:99], v7 offset:33792
v_mfma_f32_16x16x32_bf16 v[152:155], a[108:111], a[36:39], v[152:155]
ds_read_b64_tr_b16 a[100:101], v7 offset:40960
v_add_u32 v20, 0x8000, v20
v_mfma_f32_16x16x32_bf16 v[160:163], a[108:111], a[44:47], v[160:163]
ds_read_b64_tr_b16 a[102:103], v7 offset:41984
v_mfma_f32_16x16x32_bf16 v[160:163], a[104:107], a[40:43], v[160:163]
v_mfma_f32_16x16x32_bf16 v[168:171], a[104:107], a[48:51], v[168:171]
v_mfma_f32_16x16x32_bf16 v[168:171], a[108:111], a[52:55], v[168:171]
v_mfma_f32_16x16x32_bf16 v[176:179], a[108:111], a[60:63], v[176:179]
s_xor_b32 m0, s84, 32768
v_mfma_f32_16x16x32_bf16 v[176:179], a[104:107], a[56:59], v[176:179]
s_xor_b32 s64, s72, 896
ds_read_b64_tr_b16 a[104:105], v8 offset:32768
v_mfma_f32_16x16x32_bf16 v[180:183], a[112:115], a[56:59], v[180:183]
buffer_load_dwordx4 v12, s[48:51], s64 offen lds
v_mfma_f32_16x16x32_bf16 v[180:183], a[116:119], a[60:63], v[180:183]
s_add_u32 s65, s79, 7168
ds_read_b64_tr_b16 a[106:107], v8 offset:33792
v_add_u32 v4, 0x8000, v4
v_mfma_f32_16x16x32_bf16 v[172:175], a[116:119], a[52:55], v[172:175]
buffer_store_dwordx4 a[184:187], v16, s[44:47], s65 offen sc1
v_mfma_f32_16x16x32_bf16 v[172:175], a[112:115], a[48:51], v[172:175]
s_xor_b32 m0, s84, 33792
ds_read_b64_tr_b16 a[108:109], v8 offset:40960
v_mfma_f32_16x16x32_bf16 v[164:167], a[112:115], a[40:43], v[164:167]
s_xor_b32 s64, s72, 17280
ds_read_b64_tr_b16 a[110:111], v8 offset:41984
v_mfma_f32_16x16x32_bf16 v[164:167], a[116:119], a[44:47], v[164:167]
buffer_load_dwordx4 v13, s[48:51], s64 offen lds
v_mfma_f32_16x16x32_bf16 v[156:159], a[116:119], a[36:39], v[156:159]
v_mfma_f32_16x16x32_bf16 v[156:159], a[112:115], a[32:35], v[156:159]
ds_read_b64_tr_b16 a[112:113], v9 offset:32768
v_mfma_f32_16x16x32_bf16 v[24:27], a[72:75], a[32:35], v[24:27]
s_xor_b32 m0, s84, 34816
ds_read_b64_tr_b16 a[114:115], v9 offset:33792
v_mfma_f32_16x16x32_bf16 v[24:27], a[76:79], a[36:39], v[24:27]
s_xor_b32 s64, s72, 131968
ds_read_b64_tr_b16 a[116:117], v9 offset:40960
v_add_u32 v5, 0x8000, v5
v_mfma_f32_16x16x32_bf16 v[40:43], a[76:79], a[44:47], v[40:43]
buffer_load_dwordx4 v12, s[48:51], s64 offen lds
v_mfma_f32_16x16x32_bf16 v[40:43], a[72:75], a[40:43], v[40:43]
ds_read_b64_tr_b16 a[118:119], v9 offset:41984
v_mfma_f32_16x16x32_bf16 v[56:59], a[72:75], a[48:51], v[56:59]
v_mfma_f32_16x16x32_bf16 v[56:59], a[76:79], a[52:55], v[56:59]
s_xor_b32 m0, s84, 35840
v_mfma_f32_16x16x32_bf16 v[72:75], a[76:79], a[60:63], v[72:75]
s_waitcnt vmcnt(12)
s_xor_b32 s64, s72, 148352
ds_read_b128 a[0:3], v2 offset:0
v_mfma_f32_16x16x32_bf16 v[72:75], a[72:75], a[56:59], v[72:75]
buffer_load_dwordx4 v13, s[48:51], s64 offen lds
v_mfma_f32_16x16x32_bf16 v[136:139], a[80:83], a[56:59], v[136:139]
ds_read_b128 a[4:7], v3 offset:0
v_mfma_f32_16x16x32_bf16 v[136:139], a[84:87], a[60:63], v[136:139]
ds_read_b128 a[8:11], v2 offset:2048
v_add_u32 v6, 0x8000, v6
v_mfma_f32_16x16x32_bf16 v[120:123], a[84:87], a[52:55], v[120:123]
s_xor_b32 m0, s84, 36864
ds_read_b128 a[12:15], v3 offset:2048
v_mfma_f32_16x16x32_bf16 v[120:123], a[80:83], a[48:51], v[120:123]
s_xor_b32 s64, s73, 896
ds_read_b128 a[16:19], v2 offset:4096
v_mfma_f32_16x16x32_bf16 v[104:107], a[80:83], a[40:43], v[104:107]
buffer_load_dwordx4 v12, s[48:51], s64 offen lds
v_mfma_f32_16x16x32_bf16 v[104:107], a[84:87], a[44:47], v[104:107]
ds_read_b128 a[20:23], v3 offset:4096
v_mfma_f32_16x16x32_bf16 v[88:91], a[84:87], a[36:39], v[88:91]
ds_read_b128 a[24:27], v2 offset:6144
v_mfma_f32_16x16x32_bf16 v[88:91], a[80:83], a[32:35], v[88:91]
s_waitcnt lgkmcnt(7)
s_xor_b32 m0, s84, 37888
ds_read_b128 a[28:31], v3 offset:6144
v_mfma_f32_16x16x32_bf16 v[28:31], a[88:91], a[32:35], v[28:31]
s_xor_b32 s64, s73, 17280
ds_read_b64_tr_b16 a[72:73], v10 offset:32768
v_mfma_f32_16x16x32_bf16 v[28:31], a[92:95], a[36:39], v[28:31]
buffer_load_dwordx4 v13, s[48:51], s64 offen lds
v_mfma_f32_16x16x32_bf16 v[44:47], a[92:95], a[44:47], v[44:47]
ds_read_b64_tr_b16 a[74:75], v10 offset:33792
v_add_u32 v7, 0x8000, v7
v_mfma_f32_16x16x32_bf16 v[44:47], a[88:91], a[40:43], v[44:47]
ds_read_b64_tr_b16 a[76:77], v10 offset:40960
v_mfma_f32_16x16x32_bf16 v[60:63], a[88:91], a[48:51], v[60:63]
s_xor_b32 m0, s84, 38912
ds_read_b64_tr_b16 a[78:79], v10 offset:41984
v_mfma_f32_16x16x32_bf16 v[60:63], a[92:95], a[52:55], v[60:63]
s_xor_b32 s64, s73, 131968
ds_read_b64_tr_b16 a[80:81], v11 offset:32768
v_mfma_f32_16x16x32_bf16 v[76:79], a[92:95], a[60:63], v[76:79]
buffer_load_dwordx4 v12, s[48:51], s64 offen lds
v_mfma_f32_16x16x32_bf16 v[76:79], a[88:91], a[56:59], v[76:79]
ds_read_b64_tr_b16 a[82:83], v11 offset:33792
v_mfma_f32_16x16x32_bf16 v[140:143], a[96:99], a[56:59], v[140:143]
ds_read_b64_tr_b16 a[84:85], v11 offset:40960
v_mfma_f32_16x16x32_bf16 v[140:143], a[100:103], a[60:63], v[140:143]
s_xor_b32 m0, s84, 39936
ds_read_b64_tr_b16 a[86:87], v11 offset:41984
v_add_u32 v8, 0x8000, v8
v_mfma_f32_16x16x32_bf16 v[124:127], a[100:103], a[52:55], v[124:127]
s_xor_b32 s64, s73, 148352
v_mfma_f32_16x16x32_bf16 v[124:127], a[96:99], a[48:51], v[124:127]
buffer_load_dwordx4 v13, s[48:51], s64 offen lds
v_mfma_f32_16x16x32_bf16 v[108:111], a[96:99], a[40:43], v[108:111]
v_mfma_f32_16x16x32_bf16 v[108:111], a[100:103], a[44:47], v[108:111]
v_mfma_f32_16x16x32_bf16 v[92:95], a[100:103], a[36:39], v[92:95]
v_add_u32 v9, 0x8000, v9
v_add_u32 v10, 0x8000, v10
v_mfma_f32_16x16x32_bf16 v[92:95], a[96:99], a[32:35], v[92:95]
v_add_u32 v11, 0x8000, v11
v_mfma_f32_16x16x32_bf16 v[32:35], a[104:107], a[32:35], v[32:35]
v_mfma_f32_16x16x32_bf16 v[32:35], a[108:111], a[36:39], v[32:35]
v_mfma_f32_16x16x32_bf16 v[48:51], a[108:111], a[44:47], v[48:51]
s_waitcnt lgkmcnt(0)
s_barrier
v_mfma_f32_16x16x32_bf16 v[48:51], a[104:107], a[40:43], v[48:51]
s_xor_b32 m0, s77, 98304
ds_read_b64_tr_b16 a[88:89], v19 offset:36864
v_mfma_f32_16x16x32_bf16 v[64:67], a[104:107], a[48:51], v[64:67]
s_xor_b32 s64, s71, 4194304
ds_read_b64_tr_b16 a[90:91], v19 offset:37120
v_mfma_f32_16x16x32_bf16 v[64:67], a[108:111], a[52:55], v[64:67]
buffer_load_dwordx4 v14, s[56:59], s64 offen lds
v_mfma_f32_16x16x32_bf16 v[80:83], a[108:111], a[60:63], v[80:83]
ds_read_b64_tr_b16 a[92:93], v19 offset:38912
v_mfma_f32_16x16x32_bf16 v[80:83], a[104:107], a[56:59], v[80:83]
ds_read_b64_tr_b16 a[94:95], v19 offset:39168
v_mfma_f32_16x16x32_bf16 v[144:147], a[112:115], a[56:59], v[144:147]
ds_read_b64_tr_b16 a[96:97], v20 offset:36864
v_mfma_f32_16x16x32_bf16 v[144:147], a[116:119], a[60:63], v[144:147]
ds_read_b64_tr_b16 a[98:99], v20 offset:37120
v_mfma_f32_16x16x32_bf16 v[128:131], a[116:119], a[52:55], v[128:131]
s_add_u32 s65, s79, 3072
ds_read_b64_tr_b16 a[100:101], v20 offset:38912
v_mfma_f32_16x16x32_bf16 v[128:131], a[112:115], a[48:51], v[128:131]
buffer_store_dwordx4 a[188:191], v16, s[44:47], s65 offen sc1
v_mfma_f32_16x16x32_bf16 v[112:115], a[112:115], a[40:43], v[112:115]
s_add_u32 m0, s78, 114688
ds_read_b64_tr_b16 a[102:103], v20 offset:39168
v_mfma_f32_16x16x32_bf16 v[112:115], a[116:119], a[44:47], v[112:115]
s_add_u32 s64, s75, 3145728
ds_read_b64_tr_b16 a[104:105], v19 offset:40960
v_mfma_f32_16x16x32_bf16 v[96:99], a[116:119], a[36:39], v[96:99]
buffer_load_dwordx4 v23, s[60:63], s64 offen lds
v_mfma_f32_16x16x32_bf16 v[96:99], a[112:115], a[32:35], v[96:99]
ds_read_b64_tr_b16 a[106:107], v19 offset:41216
v_mfma_f32_16x16x32_bf16 v[36:39], a[72:75], a[32:35], v[36:39]
ds_read_b64_tr_b16 a[108:109], v19 offset:43008
v_mfma_f32_16x16x32_bf16 v[36:39], a[76:79], a[36:39], v[36:39]
ds_read_b64_tr_b16 a[110:111], v19 offset:43264
v_mfma_f32_16x16x32_bf16 v[52:55], a[76:79], a[44:47], v[52:55]
ds_read_b64_tr_b16 a[112:113], v20 offset:40960
v_mfma_f32_16x16x32_bf16 v[52:55], a[72:75], a[40:43], v[52:55]
ds_read_b64_tr_b16 a[114:115], v20 offset:41216
v_mfma_f32_16x16x32_bf16 v[68:71], a[72:75], a[48:51], v[68:71]
ds_read_b64_tr_b16 a[116:117], v20 offset:43008
v_mfma_f32_16x16x32_bf16 v[68:71], a[76:79], a[52:55], v[68:71]
s_xor_b32 m0, s77, 99328
ds_read_b64_tr_b16 a[118:119], v20 offset:43264
v_mfma_f32_16x16x32_bf16 v[84:87], a[76:79], a[60:63], v[84:87]
s_xor_b32 s64, s71, 4227072
v_mfma_f32_16x16x32_bf16 v[84:87], a[72:75], a[56:59], v[84:87]
buffer_load_dwordx4 v14, s[56:59], s64 offen lds
v_mfma_f32_16x16x32_bf16 v[148:151], a[80:83], a[56:59], v[148:151]
ds_read_b64_tr_b16 a[72:73], v19 offset:32768
v_mfma_f32_16x16x32_bf16 v[148:151], a[84:87], a[60:63], v[148:151]
ds_read_b64_tr_b16 a[74:75], v19 offset:33024
v_mfma_f32_16x16x32_bf16 v[132:135], a[84:87], a[52:55], v[132:135]
ds_read_b64_tr_b16 a[76:77], v19 offset:34816
v_mfma_f32_16x16x32_bf16 v[132:135], a[80:83], a[48:51], v[132:135]
ds_read_b64_tr_b16 a[78:79], v19 offset:35072
v_mfma_f32_16x16x32_bf16 v[116:119], a[80:83], a[40:43], v[116:119]
v_mfma_f32_16x16x32_bf16 v[116:119], a[84:87], a[44:47], v[116:119]
v_mfma_f32_16x16x32_bf16 v[100:103], a[84:87], a[36:39], v[100:103]
s_add_u32 m0, s78, 118784
v_mfma_f32_16x16x32_bf16 v[100:103], a[80:83], a[32:35], v[100:103]
s_waitcnt lgkmcnt(4)
s_add_u32 s64, s75, 3147776
ds_read_b64_tr_b16 a[80:81], v20 offset:32768
v_mfma_f32_16x16x32_bf16 v[184:187], a[88:91], a[0:3], v[184:187]
buffer_load_dwordx4 v23, s[60:63], s64 offen lds
v_mfma_f32_16x16x32_bf16 v[184:187], a[92:95], a[4:7], v[184:187]
ds_read_b64_tr_b16 a[82:83], v20 offset:33024
v_mfma_f32_16x16x32_bf16 v[192:195], a[92:95], a[12:15], v[192:195]
s_branch L_po9
L_pg9:
s_branch L_tr0
L_po9:
ds_read_b64_tr_b16 a[84:85], v20 offset:34816
v_mfma_f32_16x16x32_bf16 v[192:195], a[88:91], a[8:11], v[192:195]
ds_read_b64_tr_b16 a[86:87], v20 offset:35072
v_mfma_f32_16x16x32_bf16 v[200:203], a[88:91], a[16:19], v[200:203]
v_mfma_f32_16x16x32_bf16 v[200:203], a[92:95], a[20:23], v[200:203]
v_mfma_f32_16x16x32_bf16 v[208:211], a[92:95], a[28:31], v[208:211]
v_mfma_f32_16x16x32_bf16 v[208:211], a[88:91], a[24:27], v[208:211]
ds_read_b64_tr_b16 a[88:89], v4 offset:32768
v_mfma_f32_16x16x32_bf16 v[212:215], a[96:99], a[24:27], v[212:215]
s_xor_b32 m0, s77, 100352
ds_read_b64_tr_b16 a[90:91], v4 offset:33792
v_mfma_f32_16x16x32_bf16 v[212:215], a[100:103], a[28:31], v[212:215]
s_xor_b32 s64, s71, 4259840
ds_read_b64_tr_b16 a[92:93], v4 offset:40960
v_mfma_f32_16x16x32_bf16 v[204:207], a[100:103], a[20:23], v[204:207]
buffer_load_dwordx4 v15, s[56:59], s64 offen lds
v_mfma_f32_16x16x32_bf16 v[204:207], a[96:99], a[16:19], v[204:207]
ds_read_b64_tr_b16 a[94:95], v4 offset:41984
v_mfma_f32_16x16x32_bf16 v[196:199], a[96:99], a[8:11], v[196:199]
v_mfma_f32_16x16x32_bf16 v[196:199], a[100:103], a[12:15], v[196:199]
v_mfma_f32_16x16x32_bf16 v[188:191], a[100:103], a[4:7], v[188:191]
v_mfma_f32_16x16x32_bf16 v[188:191], a[96:99], a[0:3], v[188:191]
ds_read_b64_tr_b16 a[96:97], v5 offset:32768
v_mfma_f32_16x16x32_bf16 v[216:219], a[0:3], a[104:107], v[216:219]
ds_read_b64_tr_b16 a[98:99], v5 offset:33792
v_mfma_f32_16x16x32_bf16 v[216:219], a[4:7], a[108:111], v[216:219]
s_add_u32 m0, s78, 122880
ds_read_b64_tr_b16 a[100:101], v5 offset:40960
v_mfma_f32_16x16x32_bf16 v[224:227], a[12:15], a[108:111], v[224:227]
s_add_u32 s64, s75, 3149824
ds_read_b64_tr_b16 a[102:103], v5 offset:41984
v_mfma_f32_16x16x32_bf16 v[224:227], a[8:11], a[104:107], v[224:227]
buffer_load_dwordx4 v23, s[60:63], s64 offen lds
v_mfma_f32_16x16x32_bf16 v[232:235], a[16:19], a[104:107], v[232:235]
v_mfma_f32_16x16x32_bf16 v[232:235], a[20:23], a[108:111], v[232:235]
v_mfma_f32_16x16x32_bf16 v[240:243], a[28:31], a[108:111], v[240:243]
v_mfma_f32_16x16x32_bf16 v[240:243], a[24:27], a[104:107], v[240:243]
ds_read_b64_tr_b16 a[104:105], v6 offset:32768
v_mfma_f32_16x16x32_bf16 v[244:247], a[24:27], a[112:115], v[244:247]
ds_read_b64_tr_b16 a[106:107], v6 offset:33792
v_mfma_f32_16x16x32_bf16 v[244:247], a[28:31], a[116:119], v[244:247]
ds_read_b64_tr_b16 a[108:109], v6 offset:40960
v_subrev_u32 v19, 0x8000, v19
v_mfma_f32_16x16x32_bf16 v[236:239], a[20:23], a[116:119], v[236:239]
s_xor_b32 m0, s77, 101376
ds_read_b64_tr_b16 a[110:111], v6 offset:41984
v_mfma_f32_16x16x32_bf16 v[236:239], a[16:19], a[112:115], v[236:239]
s_xor_b32 s64, s71, 4292608
v_mfma_f32_16x16x32_bf16 v[228:231], a[8:11], a[112:115], v[228:231]
s_add_u32 s65, s79, 24576
buffer_load_dwordx4 v15, s[56:59], s64 offen lds
v_mfma_f32_16x16x32_bf16 v[228:231], a[12:15], a[116:119], v[228:231]
buffer_store_dwordx4 a[192:195], v16, s[44:47], s65 offen sc1
v_mfma_f32_16x16x32_bf16 v[220:223], a[4:7], a[116:119], v[220:223]
v_mfma_f32_16x16x32_bf16 v[220:223], a[0:3], a[112:115], v[220:223]
s_waitcnt lgkmcnt(4)
ds_read_b64_tr_b16 a[112:113], v7 offset:32768
v_mfma_f32_16x16x32_bf16 v[152:155], a[72:75], a[0:3], v[152:155]
ds_read_b64_tr_b16 a[114:115], v7 offset:33792
v_mfma_f32_16x16x32_bf16 v[152:155], a[76:79], a[4:7], v[152:155]
ds_read_b64_tr_b16 a[116:117], v7 offset:40960
v_subrev_u32 v20, 0x8000, v20
v_mfma_f32_16x16x32_bf16 v[160:163], a[76:79], a[12:15], v[160:163]
ds_read_b64_tr_b16 a[118:119], v7 offset:41984
v_mfma_f32_16x16x32_bf16 v[160:163], a[72:75], a[8:11], v[160:163]
v_mfma_f32_16x16x32_bf16 v[168:171], a[72:75], a[16:19], v[168:171]
v_mfma_f32_16x16x32_bf16 v[168:171], a[76:79], a[20:23], v[168:171]
v_mfma_f32_16x16x32_bf16 v[176:179], a[76:79], a[28:31], v[176:179]
s_xor_b32 m0, s84, 0
v_mfma_f32_16x16x32_bf16 v[176:179], a[72:75], a[24:27], v[176:179]
s_xor_b32 s64, s72, 1024
ds_read_b64_tr_b16 a[72:73], v8 offset:32768
v_mfma_f32_16x16x32_bf16 v[180:183], a[80:83], a[24:27], v[180:183]
buffer_load_dwordx4 v12, s[48:51], s64 offen lds
v_mfma_f32_16x16x32_bf16 v[180:183], a[84:87], a[28:31], v[180:183]
ds_read_b64_tr_b16 a[74:75], v8 offset:33792
v_subrev_u32 v4, 0x8000, v4
v_mfma_f32_16x16x32_bf16 v[172:175], a[84:87], a[20:23], v[172:175]
ds_read_b64_tr_b16 a[76:77], v8 offset:40960
v_mfma_f32_16x16x32_bf16 v[172:175], a[80:83], a[16:19], v[172:175]
s_xor_b32 m0, s84, 1024
ds_read_b64_tr_b16 a[78:79], v8 offset:41984
v_mfma_f32_16x16x32_bf16 v[164:167], a[80:83], a[8:11], v[164:167]
s_xor_b32 s64, s72, 17408
v_mfma_f32_16x16x32_bf16 v[164:167], a[84:87], a[12:15], v[164:167]
buffer_load_dwordx4 v13, s[48:51], s64 offen lds
v_mfma_f32_16x16x32_bf16 v[156:159], a[84:87], a[4:7], v[156:159]
v_mfma_f32_16x16x32_bf16 v[156:159], a[80:83], a[0:3], v[156:159]
ds_read_b64_tr_b16 a[80:81], v9 offset:32768
v_mfma_f32_16x16x32_bf16 v[24:27], a[88:91], a[0:3], v[24:27]
s_xor_b32 m0, s84, 2048
ds_read_b64_tr_b16 a[82:83], v9 offset:33792
v_mfma_f32_16x16x32_bf16 v[24:27], a[92:95], a[4:7], v[24:27]
s_xor_b32 s64, s72, 132096
ds_read_b64_tr_b16 a[84:85], v9 offset:40960
v_subrev_u32 v5, 0x8000, v5
v_mfma_f32_16x16x32_bf16 v[40:43], a[92:95], a[12:15], v[40:43]
buffer_load_dwordx4 v12, s[48:51], s64 offen lds
v_mfma_f32_16x16x32_bf16 v[40:43], a[88:91], a[8:11], v[40:43]
ds_read_b64_tr_b16 a[86:87], v9 offset:41984
v_mfma_f32_16x16x32_bf16 v[56:59], a[88:91], a[16:19], v[56:59]
v_mfma_f32_16x16x32_bf16 v[56:59], a[92:95], a[20:23], v[56:59]
s_xor_b32 m0, s84, 3072
v_mfma_f32_16x16x32_bf16 v[72:75], a[92:95], a[28:31], v[72:75]
s_waitcnt vmcnt(12)
s_xor_b32 s64, s72, 148480
ds_read_b128 a[32:35], v2 offset:32768
v_mfma_f32_16x16x32_bf16 v[72:75], a[88:91], a[24:27], v[72:75]
buffer_load_dwordx4 v13, s[48:51], s64 offen lds
v_mfma_f32_16x16x32_bf16 v[136:139], a[96:99], a[24:27], v[136:139]
ds_read_b128 a[36:39], v3 offset:32768
v_mfma_f32_16x16x32_bf16 v[136:139], a[100:103], a[28:31], v[136:139]
ds_read_b128 a[40:43], v2 offset:34816
v_subrev_u32 v6, 0x8000, v6
v_mfma_f32_16x16x32_bf16 v[120:123], a[100:103], a[20:23], v[120:123]
s_xor_b32 m0, s84, 4096
ds_read_b128 a[44:47], v3 offset:34816
v_mfma_f32_16x16x32_bf16 v[120:123], a[96:99], a[16:19], v[120:123]
s_xor_b32 s64, s73, 1024
ds_read_b128 a[48:51], v2 offset:36864
v_mfma_f32_16x16x32_bf16 v[104:107], a[96:99], a[8:11], v[104:107]
buffer_load_dwordx4 v12, s[48:51], s64 offen lds
v_mfma_f32_16x16x32_bf16 v[104:107], a[100:103], a[12:15], v[104:107]
ds_read_b128 a[52:55], v3 offset:36864
v_mfma_f32_16x16x32_bf16 v[88:91], a[100:103], a[4:7], v[88:91]
ds_read_b128 a[56:59], v2 offset:38912
v_mfma_f32_16x16x32_bf16 v[88:91], a[96:99], a[0:3], v[88:91]
s_waitcnt lgkmcnt(7)
s_xor_b32 m0, s84, 5120
ds_read_b128 a[60:63], v3 offset:38912
v_mfma_f32_16x16x32_bf16 v[28:31], a[104:107], a[0:3], v[28:31]
s_xor_b32 s64, s73, 17408
ds_read_b64_tr_b16 a[88:89], v10 offset:32768
v_mfma_f32_16x16x32_bf16 v[28:31], a[108:111], a[4:7], v[28:31]
buffer_load_dwordx4 v13, s[48:51], s64 offen lds
v_mfma_f32_16x16x32_bf16 v[44:47], a[108:111], a[12:15], v[44:47]
ds_read_b64_tr_b16 a[90:91], v10 offset:33792
v_subrev_u32 v7, 0x8000, v7
v_mfma_f32_16x16x32_bf16 v[44:47], a[104:107], a[8:11], v[44:47]
ds_read_b64_tr_b16 a[92:93], v10 offset:40960
v_mfma_f32_16x16x32_bf16 v[60:63], a[104:107], a[16:19], v[60:63]
s_xor_b32 m0, s84, 6144
ds_read_b64_tr_b16 a[94:95], v10 offset:41984
v_mfma_f32_16x16x32_bf16 v[60:63], a[108:111], a[20:23], v[60:63]
s_xor_b32 s64, s73, 132096
ds_read_b64_tr_b16 a[96:97], v11 offset:32768
v_mfma_f32_16x16x32_bf16 v[76:79], a[108:111], a[28:31], v[76:79]
buffer_load_dwordx4 v12, s[48:51], s64 offen lds
v_mfma_f32_16x16x32_bf16 v[76:79], a[104:107], a[24:27], v[76:79]
ds_read_b64_tr_b16 a[98:99], v11 offset:33792
v_mfma_f32_16x16x32_bf16 v[140:143], a[112:115], a[24:27], v[140:143]
ds_read_b64_tr_b16 a[100:101], v11 offset:40960
v_mfma_f32_16x16x32_bf16 v[140:143], a[116:119], a[28:31], v[140:143]
s_xor_b32 m0, s84, 7168
ds_read_b64_tr_b16 a[102:103], v11 offset:41984
v_subrev_u32 v8, 0x8000, v8
v_mfma_f32_16x16x32_bf16 v[124:127], a[116:119], a[20:23], v[124:127]
s_xor_b32 s64, s73, 148480
v_mfma_f32_16x16x32_bf16 v[124:127], a[112:115], a[16:19], v[124:127]
buffer_load_dwordx4 v13, s[48:51], s64 offen lds
v_mfma_f32_16x16x32_bf16 v[108:111], a[112:115], a[8:11], v[108:111]
v_mfma_f32_16x16x32_bf16 v[108:111], a[116:119], a[12:15], v[108:111]
v_mfma_f32_16x16x32_bf16 v[92:95], a[116:119], a[4:7], v[92:95]
v_subrev_u32 v9, 0x8000, v9
v_subrev_u32 v10, 0x8000, v10
v_mfma_f32_16x16x32_bf16 v[92:95], a[112:115], a[0:3], v[92:95]
s_add_u32 s65, s79, 25600
v_subrev_u32 v11, 0x8000, v11
v_mfma_f32_16x16x32_bf16 v[32:35], a[72:75], a[0:3], v[32:35]
buffer_store_dwordx4 a[196:199], v16, s[44:47], s65 offen sc1
v_mfma_f32_16x16x32_bf16 v[32:35], a[76:79], a[4:7], v[32:35]
v_mfma_f32_16x16x32_bf16 v[48:51], a[76:79], a[12:15], v[48:51]
s_waitcnt lgkmcnt(0)
s_barrier
v_mfma_f32_16x16x32_bf16 v[48:51], a[72:75], a[8:11], v[48:51]
s_xor_b32 m0, s77, 131072
ds_read_b64_tr_b16 a[104:105], v19 offset:4096
v_mfma_f32_16x16x32_bf16 v[64:67], a[72:75], a[16:19], v[64:67]
s_xor_b32 s64, s71, 4718592
ds_read_b64_tr_b16 a[106:107], v19 offset:4352
v_mfma_f32_16x16x32_bf16 v[64:67], a[76:79], a[20:23], v[64:67]
buffer_load_dwordx4 v14, s[56:59], s64 offen lds
v_mfma_f32_16x16x32_bf16 v[80:83], a[76:79], a[28:31], v[80:83]
ds_read_b64_tr_b16 a[108:109], v19 offset:6144
v_mfma_f32_16x16x32_bf16 v[80:83], a[72:75], a[24:27], v[80:83]
ds_read_b64_tr_b16 a[110:111], v19 offset:6400
v_mfma_f32_16x16x32_bf16 v[144:147], a[80:83], a[24:27], v[144:147]
ds_read_b64_tr_b16 a[112:113], v20 offset:4096
v_mfma_f32_16x16x32_bf16 v[144:147], a[84:87], a[28:31], v[144:147]
ds_read_b64_tr_b16 a[114:115], v20 offset:4352
v_mfma_f32_16x16x32_bf16 v[128:131], a[84:87], a[20:23], v[128:131]
ds_read_b64_tr_b16 a[116:117], v20 offset:6144
v_mfma_f32_16x16x32_bf16 v[128:131], a[80:83], a[16:19], v[128:131]
ds_read_b64_tr_b16 a[118:119], v20 offset:6400
v_mfma_f32_16x16x32_bf16 v[112:115], a[80:83], a[8:11], v[112:115]
s_add_u32 m0, s78, 147456
ds_read_b64_tr_b16 a[72:73], v19 offset:8192
v_mfma_f32_16x16x32_bf16 v[112:115], a[84:87], a[12:15], v[112:115]
s_add_u32 s64, s75, 3538944
ds_read_b64_tr_b16 a[74:75], v19 offset:8448
v_mfma_f32_16x16x32_bf16 v[96:99], a[84:87], a[4:7], v[96:99]
buffer_load_dwordx4 v23, s[60:63], s64 offen lds
v_mfma_f32_16x16x32_bf16 v[96:99], a[80:83], a[0:3], v[96:99]
ds_read_b64_tr_b16 a[76:77], v19 offset:10240
v_mfma_f32_16x16x32_bf16 v[36:39], a[88:91], a[0:3], v[36:39]
ds_read_b64_tr_b16 a[78:79], v19 offset:10496
v_mfma_f32_16x16x32_bf16 v[36:39], a[92:95], a[4:7], v[36:39]
ds_read_b64_tr_b16 a[80:81], v20 offset:8192
v_mfma_f32_16x16x32_bf16 v[52:55], a[92:95], a[12:15], v[52:55]
ds_read_b64_tr_b16 a[82:83], v20 offset:8448
v_mfma_f32_16x16x32_bf16 v[52:55], a[88:91], a[8:11], v[52:55]
ds_read_b64_tr_b16 a[84:85], v20 offset:10240
v_mfma_f32_16x16x32_bf16 v[68:71], a[88:91], a[16:19], v[68:71]
ds_read_b64_tr_b16 a[86:87], v20 offset:10496
v_mfma_f32_16x16x32_bf16 v[68:71], a[92:95], a[20:23], v[68:71]
s_xor_b32 m0, s77, 132096
v_mfma_f32_16x16x32_bf16 v[84:87], a[92:95], a[28:31], v[84:87]
s_xor_b32 s64, s71, 4751360
v_mfma_f32_16x16x32_bf16 v[84:87], a[88:91], a[24:27], v[84:87]
buffer_load_dwordx4 v14, s[56:59], s64 offen lds
v_mfma_f32_16x16x32_bf16 v[148:151], a[96:99], a[24:27], v[148:151]
ds_read_b64_tr_b16 a[88:89], v19 offset:0
v_mfma_f32_16x16x32_bf16 v[148:151], a[100:103], a[28:31], v[148:151]
ds_read_b64_tr_b16 a[90:91], v19 offset:256
v_mfma_f32_16x16x32_bf16 v[132:135], a[100:103], a[20:23], v[132:135]
ds_read_b64_tr_b16 a[92:93], v19 offset:2048
v_mfma_f32_16x16x32_bf16 v[132:135], a[96:99], a[16:19], v[132:135]
ds_read_b64_tr_b16 a[94:95], v19 offset:2304
v_mfma_f32_16x16x32_bf16 v[116:119], a[96:99], a[8:11], v[116:119]
v_mfma_f32_16x16x32_bf16 v[116:119], a[100:103], a[12:15], v[116:119]
v_mfma_f32_16x16x32_bf16 v[100:103], a[100:103], a[4:7], v[100:103]
s_add_u32 m0, s78, 151552
v_mfma_f32_16x16x32_bf16 v[100:103], a[96:99], a[0:3], v[100:103]
s_waitcnt lgkmcnt(4)
s_add_u32 s64, s75, 3540992
ds_read_b64_tr_b16 a[96:97], v20 offset:0
v_mfma_f32_16x16x32_bf16 v[184:187], a[104:107], a[32:35], v[184:187]
buffer_load_dwordx4 v23, s[60:63], s64 offen lds
v_mfma_f32_16x16x32_bf16 v[184:187], a[108:111], a[36:39], v[184:187]
ds_read_b64_tr_b16 a[98:99], v20 offset:256
v_mfma_f32_16x16x32_bf16 v[192:195], a[108:111], a[44:47], v[192:195]
ds_read_b64_tr_b16 a[100:101], v20 offset:2048
v_mfma_f32_16x16x32_bf16 v[192:195], a[104:107], a[40:43], v[192:195]
ds_read_b64_tr_b16 a[102:103], v20 offset:2304
v_mfma_f32_16x16x32_bf16 v[200:203], a[104:107], a[48:51], v[200:203]
v_mfma_f32_16x16x32_bf16 v[200:203], a[108:111], a[52:55], v[200:203]
v_mfma_f32_16x16x32_bf16 v[208:211], a[108:111], a[60:63], v[208:211]
v_mfma_f32_16x16x32_bf16 v[208:211], a[104:107], a[56:59], v[208:211]
ds_read_b64_tr_b16 a[104:105], v4 offset:0
v_mfma_f32_16x16x32_bf16 v[212:215], a[112:115], a[56:59], v[212:215]
s_xor_b32 m0, s77, 133120
ds_read_b64_tr_b16 a[106:107], v4 offset:1024
v_mfma_f32_16x16x32_bf16 v[212:215], a[116:119], a[60:63], v[212:215]
s_xor_b32 s64, s71, 4784128
ds_read_b64_tr_b16 a[108:109], v4 offset:8192
v_mfma_f32_16x16x32_bf16 v[204:207], a[116:119], a[52:55], v[204:207]
buffer_load_dwordx4 v15, s[56:59], s64 offen lds
v_mfma_f32_16x16x32_bf16 v[204:207], a[112:115], a[48:51], v[204:207]
ds_read_b64_tr_b16 a[110:111], v4 offset:9216
v_mfma_f32_16x16x32_bf16 v[196:199], a[112:115], a[40:43], v[196:199]
v_mfma_f32_16x16x32_bf16 v[196:199], a[116:119], a[44:47], v[196:199]
v_mfma_f32_16x16x32_bf16 v[188:191], a[116:119], a[36:39], v[188:191]
s_add_u32 s65, s79, 9216
v_mfma_f32_16x16x32_bf16 v[188:191], a[112:115], a[32:35], v[188:191]
buffer_store_dwordx4 a[200:203], v16, s[44:47], s65 offen sc1
v_mfma_f32_16x16x32_bf16 v[216:219], a[32:35], a[72:75], v[216:219]
ds_read_b64_tr_b16 a[112:113], v5 offset:0
v_mfma_f32_16x16x32_bf16 v[216:219], a[36:39], a[76:79], v[216:219]
s_add_u32 m0, s78, 155648
ds_read_b64_tr_b16 a[114:115], v5 offset:1024
v_mfma_f32_16x16x32_bf16 v[224:227], a[44:47], a[76:79], v[224:227]
s_add_u32 s64, s75, 3543040
ds_read_b64_tr_b16 a[116:117], v5 offset:8192
v_mfma_f32_16x16x32_bf16 v[224:227], a[40:43], a[72:75], v[224:227]
buffer_load_dwordx4 v23, s[60:63], s64 offen lds
v_mfma_f32_16x16x32_bf16 v[232:235], a[48:51], a[72:75], v[232:235]
ds_read_b64_tr_b16 a[118:119], v5 offset:9216
v_mfma_f32_16x16x32_bf16 v[232:235], a[52:55], a[76:79], v[232:235]
v_mfma_f32_16x16x32_bf16 v[240:243], a[60:63], a[76:79], v[240:243]
v_mfma_f32_16x16x32_bf16 v[240:243], a[56:59], a[72:75], v[240:243]
ds_read_b64_tr_b16 a[72:73], v6 offset:0
v_mfma_f32_16x16x32_bf16 v[244:247], a[56:59], a[80:83], v[244:247]
ds_read_b64_tr_b16 a[74:75], v6 offset:1024
v_mfma_f32_16x16x32_bf16 v[244:247], a[60:63], a[84:87], v[244:247]
ds_read_b64_tr_b16 a[76:77], v6 offset:8192
v_mfma_f32_16x16x32_bf16 v[236:239], a[52:55], a[84:87], v[236:239]
s_xor_b32 m0, s77, 134144
ds_read_b64_tr_b16 a[78:79], v6 offset:9216
v_mfma_f32_16x16x32_bf16 v[236:239], a[48:51], a[80:83], v[236:239]
s_xor_b32 s64, s71, 4816896
v_mfma_f32_16x16x32_bf16 v[228:231], a[40:43], a[80:83], v[228:231]
buffer_load_dwordx4 v15, s[56:59], s64 offen lds
v_mfma_f32_16x16x32_bf16 v[228:231], a[44:47], a[84:87], v[228:231]
v_mfma_f32_16x16x32_bf16 v[220:223], a[36:39], a[84:87], v[220:223]
v_mfma_f32_16x16x32_bf16 v[220:223], a[32:35], a[80:83], v[220:223]
s_waitcnt lgkmcnt(4)
ds_read_b64_tr_b16 a[80:81], v7 offset:0
v_mfma_f32_16x16x32_bf16 v[152:155], a[88:91], a[32:35], v[152:155]
ds_read_b64_tr_b16 a[82:83], v7 offset:1024
v_mfma_f32_16x16x32_bf16 v[152:155], a[92:95], a[36:39], v[152:155]
ds_read_b64_tr_b16 a[84:85], v7 offset:8192
v_mfma_f32_16x16x32_bf16 v[160:163], a[92:95], a[44:47], v[160:163]
ds_read_b64_tr_b16 a[86:87], v7 offset:9216
v_mfma_f32_16x16x32_bf16 v[160:163], a[88:91], a[40:43], v[160:163]
v_mfma_f32_16x16x32_bf16 v[168:171], a[88:91], a[48:51], v[168:171]
v_mfma_f32_16x16x32_bf16 v[168:171], a[92:95], a[52:55], v[168:171]
v_mfma_f32_16x16x32_bf16 v[176:179], a[92:95], a[60:63], v[176:179]
s_xor_b32 m0, s84, 32768
v_mfma_f32_16x16x32_bf16 v[176:179], a[88:91], a[56:59], v[176:179]
s_xor_b32 s64, s72, 1152
ds_read_b64_tr_b16 a[88:89], v8 offset:0
v_mfma_f32_16x16x32_bf16 v[180:183], a[96:99], a[56:59], v[180:183]
buffer_load_dwordx4 v12, s[48:51], s64 offen lds
v_mfma_f32_16x16x32_bf16 v[180:183], a[100:103], a[60:63], v[180:183]
ds_read_b64_tr_b16 a[90:91], v8 offset:1024
v_mfma_f32_16x16x32_bf16 v[172:175], a[100:103], a[52:55], v[172:175]
ds_read_b64_tr_b16 a[92:93], v8 offset:8192
v_mfma_f32_16x16x32_bf16 v[172:175], a[96:99], a[48:51], v[172:175]
s_xor_b32 m0, s84, 33792
ds_read_b64_tr_b16 a[94:95], v8 offset:9216
v_mfma_f32_16x16x32_bf16 v[164:167], a[96:99], a[40:43], v[164:167]
s_xor_b32 s64, s72, 17536
v_mfma_f32_16x16x32_bf16 v[164:167], a[100:103], a[44:47], v[164:167]
buffer_load_dwordx4 v13, s[48:51], s64 offen lds
v_mfma_f32_16x16x32_bf16 v[156:159], a[100:103], a[36:39], v[156:159]
v_mfma_f32_16x16x32_bf16 v[156:159], a[96:99], a[32:35], v[156:159]
ds_read_b64_tr_b16 a[96:97], v9 offset:0
v_mfma_f32_16x16x32_bf16 v[24:27], a[104:107], a[32:35], v[24:27]
s_xor_b32 m0, s84, 34816
ds_read_b64_tr_b16 a[98:99], v9 offset:1024
v_mfma_f32_16x16x32_bf16 v[24:27], a[108:111], a[36:39], v[24:27]
s_xor_b32 s64, s72, 132224
ds_read_b64_tr_b16 a[100:101], v9 offset:8192
v_mfma_f32_16x16x32_bf16 v[40:43], a[108:111], a[44:47], v[40:43]
buffer_load_dwordx4 v12, s[48:51], s64 offen lds
v_mfma_f32_16x16x32_bf16 v[40:43], a[104:107], a[40:43], v[40:43]
ds_read_b64_tr_b16 a[102:103], v9 offset:9216
v_mfma_f32_16x16x32_bf16 v[56:59], a[104:107], a[48:51], v[56:59]
v_mfma_f32_16x16x32_bf16 v[56:59], a[108:111], a[52:55], v[56:59]
s_xor_b32 m0, s84, 35840
v_mfma_f32_16x16x32_bf16 v[72:75], a[108:111], a[60:63], v[72:75]
s_waitcnt vmcnt(12)
s_xor_b32 s64, s72, 148608
ds_read_b128 a[0:3], v2 offset:0
v_mfma_f32_16x16x32_bf16 v[72:75], a[104:107], a[56:59], v[72:75]
buffer_load_dwordx4 v13, s[48:51], s64 offen lds
v_mfma_f32_16x16x32_bf16 v[136:139], a[112:115], a[56:59], v[136:139]
ds_read_b128 a[4:7], v3 offset:0
v_mfma_f32_16x16x32_bf16 v[136:139], a[116:119], a[60:63], v[136:139]
ds_read_b128 a[8:11], v2 offset:2048
v_mfma_f32_16x16x32_bf16 v[120:123], a[116:119], a[52:55], v[120:123]
s_xor_b32 m0, s84, 36864
ds_read_b128 a[12:15], v3 offset:2048
v_mfma_f32_16x16x32_bf16 v[120:123], a[112:115], a[48:51], v[120:123]
s_xor_b32 s64, s73, 1152
ds_read_b128 a[16:19], v2 offset:4096
v_mfma_f32_16x16x32_bf16 v[104:107], a[112:115], a[40:43], v[104:107]
buffer_load_dwordx4 v12, s[48:51], s64 offen lds
v_mfma_f32_16x16x32_bf16 v[104:107], a[116:119], a[44:47], v[104:107]
ds_read_b128 a[20:23], v3 offset:4096
v_mfma_f32_16x16x32_bf16 v[88:91], a[116:119], a[36:39], v[88:91]
ds_read_b128 a[24:27], v2 offset:6144
v_mfma_f32_16x16x32_bf16 v[88:91], a[112:115], a[32:35], v[88:91]
s_waitcnt lgkmcnt(7)
s_xor_b32 m0, s84, 37888
ds_read_b128 a[28:31], v3 offset:6144
v_mfma_f32_16x16x32_bf16 v[28:31], a[72:75], a[32:35], v[28:31]
s_xor_b32 s64, s73, 17536
ds_read_b64_tr_b16 a[104:105], v10 offset:0
v_mfma_f32_16x16x32_bf16 v[28:31], a[76:79], a[36:39], v[28:31]
s_add_u32 s65, s79, 26624
buffer_load_dwordx4 v13, s[48:51], s64 offen lds
v_mfma_f32_16x16x32_bf16 v[44:47], a[76:79], a[44:47], v[44:47]
buffer_store_dwordx4 a[204:207], v16, s[44:47], s65 offen sc1
v_mfma_f32_16x16x32_bf16 v[44:47], a[72:75], a[40:43], v[44:47]
ds_read_b64_tr_b16 a[106:107], v10 offset:1024
v_mfma_f32_16x16x32_bf16 v[60:63], a[72:75], a[48:51], v[60:63]
s_xor_b32 m0, s84, 38912
ds_read_b64_tr_b16 a[108:109], v10 offset:8192
v_mfma_f32_16x16x32_bf16 v[60:63], a[76:79], a[52:55], v[60:63]
s_xor_b32 s64, s73, 132224
ds_read_b64_tr_b16 a[110:111], v10 offset:9216
v_mfma_f32_16x16x32_bf16 v[76:79], a[76:79], a[60:63], v[76:79]
buffer_load_dwordx4 v12, s[48:51], s64 offen lds
v_mfma_f32_16x16x32_bf16 v[76:79], a[72:75], a[56:59], v[76:79]
ds_read_b64_tr_b16 a[112:113], v11 offset:0
v_mfma_f32_16x16x32_bf16 v[140:143], a[80:83], a[56:59], v[140:143]
ds_read_b64_tr_b16 a[114:115], v11 offset:1024
v_mfma_f32_16x16x32_bf16 v[140:143], a[84:87], a[60:63], v[140:143]
s_xor_b32 m0, s84, 39936
ds_read_b64_tr_b16 a[116:117], v11 offset:8192
v_mfma_f32_16x16x32_bf16 v[124:127], a[84:87], a[52:55], v[124:127]
s_xor_b32 s64, s73, 148608
ds_read_b64_tr_b16 a[118:119], v11 offset:9216
v_mfma_f32_16x16x32_bf16 v[124:127], a[80:83], a[48:51], v[124:127]
buffer_load_dwordx4 v13, s[48:51], s64 offen lds
v_mfma_f32_16x16x32_bf16 v[108:111], a[80:83], a[40:43], v[108:111]
v_mfma_f32_16x16x32_bf16 v[108:111], a[84:87], a[44:47], v[108:111]
v_mfma_f32_16x16x32_bf16 v[92:95], a[84:87], a[36:39], v[92:95]
v_mfma_f32_16x16x32_bf16 v[92:95], a[80:83], a[32:35], v[92:95]
v_mfma_f32_16x16x32_bf16 v[32:35], a[88:91], a[32:35], v[32:35]
v_mfma_f32_16x16x32_bf16 v[32:35], a[92:95], a[36:39], v[32:35]
v_mfma_f32_16x16x32_bf16 v[48:51], a[92:95], a[44:47], v[48:51]
s_waitcnt lgkmcnt(0)
s_barrier
v_mfma_f32_16x16x32_bf16 v[48:51], a[88:91], a[40:43], v[48:51]
s_xor_b32 m0, s77, 65536
ds_read_b64_tr_b16 a[72:73], v19 offset:36864
v_mfma_f32_16x16x32_bf16 v[64:67], a[88:91], a[48:51], v[64:67]
s_xor_b32 s64, s71, 5242880
ds_read_b64_tr_b16 a[74:75], v19 offset:37120
v_mfma_f32_16x16x32_bf16 v[64:67], a[92:95], a[52:55], v[64:67]
buffer_load_dwordx4 v14, s[56:59], s64 offen lds
v_mfma_f32_16x16x32_bf16 v[80:83], a[92:95], a[60:63], v[80:83]
ds_read_b64_tr_b16 a[76:77], v19 offset:38912
v_mfma_f32_16x16x32_bf16 v[80:83], a[88:91], a[56:59], v[80:83]
ds_read_b64_tr_b16 a[78:79], v19 offset:39168
v_mfma_f32_16x16x32_bf16 v[144:147], a[96:99], a[56:59], v[144:147]
ds_read_b64_tr_b16 a[80:81], v20 offset:36864
v_mfma_f32_16x16x32_bf16 v[144:147], a[100:103], a[60:63], v[144:147]
ds_read_b64_tr_b16 a[82:83], v20 offset:37120
v_mfma_f32_16x16x32_bf16 v[128:131], a[100:103], a[52:55], v[128:131]
ds_read_b64_tr_b16 a[84:85], v20 offset:38912
v_mfma_f32_16x16x32_bf16 v[128:131], a[96:99], a[48:51], v[128:131]
ds_read_b64_tr_b16 a[86:87], v20 offset:39168
v_mfma_f32_16x16x32_bf16 v[112:115], a[96:99], a[40:43], v[112:115]
s_add_u32 m0, s78, 81920
ds_read_b64_tr_b16 a[88:89], v19 offset:40960
v_mfma_f32_16x16x32_bf16 v[112:115], a[100:103], a[44:47], v[112:115]
s_add_u32 s64, s75, 3932160
ds_read_b64_tr_b16 a[90:91], v19 offset:41216
v_mfma_f32_16x16x32_bf16 v[96:99], a[100:103], a[36:39], v[96:99]
buffer_load_dwordx4 v23, s[60:63], s64 offen lds
v_mfma_f32_16x16x32_bf16 v[96:99], a[96:99], a[32:35], v[96:99]
ds_read_b64_tr_b16 a[92:93], v19 offset:43008
v_mfma_f32_16x16x32_bf16 v[36:39], a[104:107], a[32:35], v[36:39]
ds_read_b64_tr_b16 a[94:95], v19 offset:43264
v_mfma_f32_16x16x32_bf16 v[36:39], a[108:111], a[36:39], v[36:39]
ds_read_b64_tr_b16 a[96:97], v20 offset:40960
v_mfma_f32_16x16x32_bf16 v[52:55], a[108:111], a[44:47], v[52:55]
ds_read_b64_tr_b16 a[98:99], v20 offset:41216
v_mfma_f32_16x16x32_bf16 v[52:55], a[104:107], a[40:43], v[52:55]
ds_read_b64_tr_b16 a[100:101], v20 offset:43008
v_mfma_f32_16x16x32_bf16 v[68:71], a[104:107], a[48:51], v[68:71]
ds_read_b64_tr_b16 a[102:103], v20 offset:43264
v_mfma_f32_16x16x32_bf16 v[68:71], a[108:111], a[52:55], v[68:71]
s_xor_b32 m0, s77, 66560
v_mfma_f32_16x16x32_bf16 v[84:87], a[108:111], a[60:63], v[84:87]
s_xor_b32 s64, s71, 5275648
v_mfma_f32_16x16x32_bf16 v[84:87], a[104:107], a[56:59], v[84:87]
buffer_load_dwordx4 v14, s[56:59], s64 offen lds
v_mfma_f32_16x16x32_bf16 v[148:151], a[112:115], a[56:59], v[148:151]
ds_read_b64_tr_b16 a[104:105], v19 offset:32768
v_mfma_f32_16x16x32_bf16 v[148:151], a[116:119], a[60:63], v[148:151]
ds_read_b64_tr_b16 a[106:107], v19 offset:33024
v_mfma_f32_16x16x32_bf16 v[132:135], a[116:119], a[52:55], v[132:135]
ds_read_b64_tr_b16 a[108:109], v19 offset:34816
v_mfma_f32_16x16x32_bf16 v[132:135], a[112:115], a[48:51], v[132:135]
ds_read_b64_tr_b16 a[110:111], v19 offset:35072
v_mfma_f32_16x16x32_bf16 v[116:119], a[112:115], a[40:43], v[116:119]
v_mfma_f32_16x16x32_bf16 v[116:119], a[116:119], a[44:47], v[116:119]
v_mfma_f32_16x16x32_bf16 v[100:103], a[116:119], a[36:39], v[100:103]
s_add_u32 m0, s78, 86016
v_mfma_f32_16x16x32_bf16 v[100:103], a[112:115], a[32:35], v[100:103]
s_waitcnt lgkmcnt(4)
s_add_u32 s64, s75, 3934208
ds_read_b64_tr_b16 a[112:113], v20 offset:32768
v_mfma_f32_16x16x32_bf16 v[184:187], a[72:75], a[0:3], v[184:187]
buffer_load_dwordx4 v23, s[60:63], s64 offen lds
v_mfma_f32_16x16x32_bf16 v[184:187], a[76:79], a[4:7], v[184:187]
s_add_u32 s65, s79, 27648
ds_read_b64_tr_b16 a[114:115], v20 offset:33024
v_mfma_f32_16x16x32_bf16 v[192:195], a[76:79], a[12:15], v[192:195]
buffer_store_dwordx4 a[208:211], v16, s[44:47], s65 offen sc1
v_mfma_f32_16x16x32_bf16 v[192:195], a[72:75], a[8:11], v[192:195]
ds_read_b64_tr_b16 a[116:117], v20 offset:34816
v_mfma_f32_16x16x32_bf16 v[200:203], a[72:75], a[16:19], v[200:203]
ds_read_b64_tr_b16 a[118:119], v20 offset:35072
v_mfma_f32_16x16x32_bf16 v[200:203], a[76:79], a[20:23], v[200:203]
v_mfma_f32_16x16x32_bf16 v[208:211], a[76:79], a[28:31], v[208:211]
v_mfma_f32_16x16x32_bf16 v[208:211], a[72:75], a[24:27], v[208:211]
ds_read_b64_tr_b16 a[72:73], v4 offset:32768
v_mfma_f32_16x16x32_bf16 v[212:215], a[80:83], a[24:27], v[212:215]
s_xor_b32 m0, s77, 67584
ds_read_b64_tr_b16 a[74:75], v4 offset:33792
v_mfma_f32_16x16x32_bf16 v[212:215], a[84:87], a[28:31], v[212:215]
s_xor_b32 s64, s71, 5308416
ds_read_b64_tr_b16 a[76:77], v4 offset:40960
v_mfma_f32_16x16x32_bf16 v[204:207], a[84:87], a[20:23], v[204:207]
buffer_load_dwordx4 v15, s[56:59], s64 offen lds
v_mfma_f32_16x16x32_bf16 v[204:207], a[80:83], a[16:19], v[204:207]
ds_read_b64_tr_b16 a[78:79], v4 offset:41984
v_mfma_f32_16x16x32_bf16 v[196:199], a[80:83], a[8:11], v[196:199]
v_mfma_f32_16x16x32_bf16 v[196:199], a[84:87], a[12:15], v[196:199]
v_mfma_f32_16x16x32_bf16 v[188:191], a[84:87], a[4:7], v[188:191]
v_mfma_f32_16x16x32_bf16 v[188:191], a[80:83], a[0:3], v[188:191]
ds_read_b64_tr_b16 a[80:81], v5 offset:32768
v_mfma_f32_16x16x32_bf16 v[216:219], a[0:3], a[88:91], v[216:219]
ds_read_b64_tr_b16 a[82:83], v5 offset:33792
v_mfma_f32_16x16x32_bf16 v[216:219], a[4:7], a[92:95], v[216:219]
s_add_u32 m0, s78, 90112
ds_read_b64_tr_b16 a[84:85], v5 offset:40960
v_mfma_f32_16x16x32_bf16 v[224:227], a[12:15], a[92:95], v[224:227]
s_add_u32 s64, s75, 3936256
ds_read_b64_tr_b16 a[86:87], v5 offset:41984
v_mfma_f32_16x16x32_bf16 v[224:227], a[8:11], a[88:91], v[224:227]
buffer_load_dwordx4 v23, s[60:63], s64 offen lds
v_mfma_f32_16x16x32_bf16 v[232:235], a[16:19], a[88:91], v[232:235]
v_mfma_f32_16x16x32_bf16 v[232:235], a[20:23], a[92:95], v[232:235]
v_mfma_f32_16x16x32_bf16 v[240:243], a[28:31], a[92:95], v[240:243]
v_mfma_f32_16x16x32_bf16 v[240:243], a[24:27], a[88:91], v[240:243]
ds_read_b64_tr_b16 a[88:89], v6 offset:32768
v_mfma_f32_16x16x32_bf16 v[244:247], a[24:27], a[96:99], v[244:247]
ds_read_b64_tr_b16 a[90:91], v6 offset:33792
v_mfma_f32_16x16x32_bf16 v[244:247], a[28:31], a[100:103], v[244:247]
ds_read_b64_tr_b16 a[92:93], v6 offset:40960
v_add_u32 v19, 0x8000, v19
v_mfma_f32_16x16x32_bf16 v[236:239], a[20:23], a[100:103], v[236:239]
s_branch L_po10
L_pg10:
s_branch L_tr0
L_po10:
s_xor_b32 m0, s77, 68608
ds_read_b64_tr_b16 a[94:95], v6 offset:41984
v_mfma_f32_16x16x32_bf16 v[236:239], a[16:19], a[96:99], v[236:239]
s_xor_b32 s64, s71, 5341184
v_mfma_f32_16x16x32_bf16 v[228:231], a[8:11], a[96:99], v[228:231]
buffer_load_dwordx4 v15, s[56:59], s64 offen lds
v_mfma_f32_16x16x32_bf16 v[228:231], a[12:15], a[100:103], v[228:231]
v_mfma_f32_16x16x32_bf16 v[220:223], a[4:7], a[100:103], v[220:223]
v_mfma_f32_16x16x32_bf16 v[220:223], a[0:3], a[96:99], v[220:223]
s_waitcnt lgkmcnt(4)
ds_read_b64_tr_b16 a[96:97], v7 offset:32768
v_mfma_f32_16x16x32_bf16 v[152:155], a[104:107], a[0:3], v[152:155]
ds_read_b64_tr_b16 a[98:99], v7 offset:33792
v_mfma_f32_16x16x32_bf16 v[152:155], a[108:111], a[4:7], v[152:155]
ds_read_b64_tr_b16 a[100:101], v7 offset:40960
v_add_u32 v20, 0x8000, v20
v_mfma_f32_16x16x32_bf16 v[160:163], a[108:111], a[12:15], v[160:163]
ds_read_b64_tr_b16 a[102:103], v7 offset:41984
v_mfma_f32_16x16x32_bf16 v[160:163], a[104:107], a[8:11], v[160:163]
v_mfma_f32_16x16x32_bf16 v[168:171], a[104:107], a[16:19], v[168:171]
v_mfma_f32_16x16x32_bf16 v[168:171], a[108:111], a[20:23], v[168:171]
v_mfma_f32_16x16x32_bf16 v[176:179], a[108:111], a[28:31], v[176:179]
s_xor_b32 m0, s84, 0
v_mfma_f32_16x16x32_bf16 v[176:179], a[104:107], a[24:27], v[176:179]
s_xor_b32 s64, s72, 1280
ds_read_b64_tr_b16 a[104:105], v8 offset:32768
v_mfma_f32_16x16x32_bf16 v[180:183], a[112:115], a[24:27], v[180:183]
buffer_load_dwordx4 v12, s[48:51], s64 offen lds
v_mfma_f32_16x16x32_bf16 v[180:183], a[116:119], a[28:31], v[180:183]
ds_read_b64_tr_b16 a[106:107], v8 offset:33792
v_add_u32 v4, 0x8000, v4
v_mfma_f32_16x16x32_bf16 v[172:175], a[116:119], a[20:23], v[172:175]
ds_read_b64_tr_b16 a[108:109], v8 offset:40960
v_mfma_f32_16x16x32_bf16 v[172:175], a[112:115], a[16:19], v[172:175]
s_xor_b32 m0, s84, 1024
ds_read_b64_tr_b16 a[110:111], v8 offset:41984
v_mfma_f32_16x16x32_bf16 v[164:167], a[112:115], a[8:11], v[164:167]
s_xor_b32 s64, s72, 17664
v_mfma_f32_16x16x32_bf16 v[164:167], a[116:119], a[12:15], v[164:167]
buffer_load_dwordx4 v13, s[48:51], s64 offen lds
v_mfma_f32_16x16x32_bf16 v[156:159], a[116:119], a[4:7], v[156:159]
v_mfma_f32_16x16x32_bf16 v[156:159], a[112:115], a[0:3], v[156:159]
ds_read_b64_tr_b16 a[112:113], v9 offset:32768
v_mfma_f32_16x16x32_bf16 v[24:27], a[72:75], a[0:3], v[24:27]
s_xor_b32 m0, s84, 2048
ds_read_b64_tr_b16 a[114:115], v9 offset:33792
v_mfma_f32_16x16x32_bf16 v[24:27], a[76:79], a[4:7], v[24:27]
s_xor_b32 s64, s72, 132352
ds_read_b64_tr_b16 a[116:117], v9 offset:40960
v_add_u32 v5, 0x8000, v5
v_mfma_f32_16x16x32_bf16 v[40:43], a[76:79], a[12:15], v[40:43]
buffer_load_dwordx4 v12, s[48:51], s64 offen lds
v_mfma_f32_16x16x32_bf16 v[40:43], a[72:75], a[8:11], v[40:43]
s_add_u32 s65, s79, 11264
ds_read_b64_tr_b16 a[118:119], v9 offset:41984
v_mfma_f32_16x16x32_bf16 v[56:59], a[72:75], a[16:19], v[56:59]
buffer_store_dwordx4 a[212:215], v16, s[44:47], s65 offen sc1
v_mfma_f32_16x16x32_bf16 v[56:59], a[76:79], a[20:23], v[56:59]
s_xor_b32 m0, s84, 3072
v_mfma_f32_16x16x32_bf16 v[72:75], a[76:79], a[28:31], v[72:75]
s_waitcnt vmcnt(12)
s_xor_b32 s64, s72, 148736
ds_read_b128 a[32:35], v2 offset:32768
v_mfma_f32_16x16x32_bf16 v[72:75], a[72:75], a[24:27], v[72:75]
buffer_load_dwordx4 v13, s[48:51], s64 offen lds
v_mfma_f32_16x16x32_bf16 v[136:139], a[80:83], a[24:27], v[136:139]
ds_read_b128 a[36:39], v3 offset:32768
v_mfma_f32_16x16x32_bf16 v[136:139], a[84:87], a[28:31], v[136:139]
ds_read_b128 a[40:43], v2 offset:34816
v_add_u32 v6, 0x8000, v6
v_mfma_f32_16x16x32_bf16 v[120:123], a[84:87], a[20:23], v[120:123]
s_xor_b32 m0, s84, 4096
ds_read_b128 a[44:47], v3 offset:34816
v_mfma_f32_16x16x32_bf16 v[120:123], a[80:83], a[16:19], v[120:123]
s_xor_b32 s64, s73, 1280
ds_read_b128 a[48:51], v2 offset:36864
v_mfma_f32_16x16x32_bf16 v[104:107], a[80:83], a[8:11], v[104:107]
buffer_load_dwordx4 v12, s[48:51], s64 offen lds
v_mfma_f32_16x16x32_bf16 v[104:107], a[84:87], a[12:15], v[104:107]
ds_read_b128 a[52:55], v3 offset:36864
v_mfma_f32_16x16x32_bf16 v[88:91], a[84:87], a[4:7], v[88:91]
ds_read_b128 a[56:59], v2 offset:38912
v_mfma_f32_16x16x32_bf16 v[88:91], a[80:83], a[0:3], v[88:91]
s_waitcnt lgkmcnt(7)
s_xor_b32 m0, s84, 5120
ds_read_b128 a[60:63], v3 offset:38912
v_mfma_f32_16x16x32_bf16 v[28:31], a[88:91], a[0:3], v[28:31]
s_xor_b32 s64, s73, 17664
ds_read_b64_tr_b16 a[72:73], v10 offset:32768
v_mfma_f32_16x16x32_bf16 v[28:31], a[92:95], a[4:7], v[28:31]
buffer_load_dwordx4 v13, s[48:51], s64 offen lds
v_mfma_f32_16x16x32_bf16 v[44:47], a[92:95], a[12:15], v[44:47]
ds_read_b64_tr_b16 a[74:75], v10 offset:33792
v_add_u32 v7, 0x8000, v7
v_mfma_f32_16x16x32_bf16 v[44:47], a[88:91], a[8:11], v[44:47]
ds_read_b64_tr_b16 a[76:77], v10 offset:40960
v_mfma_f32_16x16x32_bf16 v[60:63], a[88:91], a[16:19], v[60:63]
s_xor_b32 m0, s84, 6144
ds_read_b64_tr_b16 a[78:79], v10 offset:41984
v_mfma_f32_16x16x32_bf16 v[60:63], a[92:95], a[20:23], v[60:63]
s_xor_b32 s64, s73, 132352
ds_read_b64_tr_b16 a[80:81], v11 offset:32768
v_mfma_f32_16x16x32_bf16 v[76:79], a[92:95], a[28:31], v[76:79]
buffer_load_dwordx4 v12, s[48:51], s64 offen lds
v_mfma_f32_16x16x32_bf16 v[76:79], a[88:91], a[24:27], v[76:79]
ds_read_b64_tr_b16 a[82:83], v11 offset:33792
v_mfma_f32_16x16x32_bf16 v[140:143], a[96:99], a[24:27], v[140:143]
ds_read_b64_tr_b16 a[84:85], v11 offset:40960
v_mfma_f32_16x16x32_bf16 v[140:143], a[100:103], a[28:31], v[140:143]
s_xor_b32 m0, s84, 7168
ds_read_b64_tr_b16 a[86:87], v11 offset:41984
v_add_u32 v8, 0x8000, v8
v_mfma_f32_16x16x32_bf16 v[124:127], a[100:103], a[20:23], v[124:127]
s_xor_b32 s64, s73, 148736
v_mfma_f32_16x16x32_bf16 v[124:127], a[96:99], a[16:19], v[124:127]
buffer_load_dwordx4 v13, s[48:51], s64 offen lds
v_mfma_f32_16x16x32_bf16 v[108:111], a[96:99], a[8:11], v[108:111]
v_mfma_f32_16x16x32_bf16 v[108:111], a[100:103], a[12:15], v[108:111]
v_mfma_f32_16x16x32_bf16 v[92:95], a[100:103], a[4:7], v[92:95]
v_add_u32 v9, 0x8000, v9
v_add_u32 v10, 0x8000, v10
v_mfma_f32_16x16x32_bf16 v[92:95], a[96:99], a[0:3], v[92:95]
v_add_u32 v11, 0x8000, v11
v_mfma_f32_16x16x32_bf16 v[32:35], a[104:107], a[0:3], v[32:35]
v_mfma_f32_16x16x32_bf16 v[32:35], a[108:111], a[4:7], v[32:35]
v_mfma_f32_16x16x32_bf16 v[48:51], a[108:111], a[12:15], v[48:51]
s_waitcnt lgkmcnt(0)
s_barrier
v_mfma_f32_16x16x32_bf16 v[48:51], a[104:107], a[8:11], v[48:51]
s_xor_b32 m0, s77, 98304
ds_read_b64_tr_b16 a[88:89], v19 offset:36864
v_mfma_f32_16x16x32_bf16 v[64:67], a[104:107], a[16:19], v[64:67]
s_xor_b32 s64, s71, 5767168
ds_read_b64_tr_b16 a[90:91], v19 offset:37120
v_mfma_f32_16x16x32_bf16 v[64:67], a[108:111], a[20:23], v[64:67]
buffer_load_dwordx4 v14, s[56:59], s64 offen lds
v_mfma_f32_16x16x32_bf16 v[80:83], a[108:111], a[28:31], v[80:83]
ds_read_b64_tr_b16 a[92:93], v19 offset:38912
v_mfma_f32_16x16x32_bf16 v[80:83], a[104:107], a[24:27], v[80:83]
ds_read_b64_tr_b16 a[94:95], v19 offset:39168
v_mfma_f32_16x16x32_bf16 v[144:147], a[112:115], a[24:27], v[144:147]
ds_read_b64_tr_b16 a[96:97], v20 offset:36864
v_mfma_f32_16x16x32_bf16 v[144:147], a[116:119], a[28:31], v[144:147]
ds_read_b64_tr_b16 a[98:99], v20 offset:37120
v_mfma_f32_16x16x32_bf16 v[128:131], a[116:119], a[20:23], v[128:131]
ds_read_b64_tr_b16 a[100:101], v20 offset:38912
v_mfma_f32_16x16x32_bf16 v[128:131], a[112:115], a[16:19], v[128:131]
ds_read_b64_tr_b16 a[102:103], v20 offset:39168
v_mfma_f32_16x16x32_bf16 v[112:115], a[112:115], a[8:11], v[112:115]
s_add_u32 m0, s78, 114688
ds_read_b64_tr_b16 a[104:105], v19 offset:40960
v_mfma_f32_16x16x32_bf16 v[112:115], a[116:119], a[12:15], v[112:115]
s_add_u32 s64, s75, 4325376
ds_read_b64_tr_b16 a[106:107], v19 offset:41216
v_mfma_f32_16x16x32_bf16 v[96:99], a[116:119], a[4:7], v[96:99]
buffer_load_dwordx4 v23, s[60:63], s64 offen lds
v_mfma_f32_16x16x32_bf16 v[96:99], a[112:115], a[0:3], v[96:99]
ds_read_b64_tr_b16 a[108:109], v19 offset:43008
v_mfma_f32_16x16x32_bf16 v[36:39], a[72:75], a[0:3], v[36:39]
ds_read_b64_tr_b16 a[110:111], v19 offset:43264
v_mfma_f32_16x16x32_bf16 v[36:39], a[76:79], a[4:7], v[36:39]
ds_read_b64_tr_b16 a[112:113], v20 offset:40960
v_mfma_f32_16x16x32_bf16 v[52:55], a[76:79], a[12:15], v[52:55]
ds_read_b64_tr_b16 a[114:115], v20 offset:41216
v_mfma_f32_16x16x32_bf16 v[52:55], a[72:75], a[8:11], v[52:55]
ds_read_b64_tr_b16 a[116:117], v20 offset:43008
v_mfma_f32_16x16x32_bf16 v[68:71], a[72:75], a[16:19], v[68:71]
s_add_u32 s65, s79, 28672
ds_read_b64_tr_b16 a[118:119], v20 offset:43264
v_mfma_f32_16x16x32_bf16 v[68:71], a[76:79], a[20:23], v[68:71]
s_xor_b32 m0, s77, 99328
buffer_store_dwordx4 a[216:219], v16, s[44:47], s65 offen sc1
v_mfma_f32_16x16x32_bf16 v[84:87], a[76:79], a[28:31], v[84:87]
s_xor_b32 s64, s71, 5799936
v_mfma_f32_16x16x32_bf16 v[84:87], a[72:75], a[24:27], v[84:87]
buffer_load_dwordx4 v14, s[56:59], s64 offen lds
v_mfma_f32_16x16x32_bf16 v[148:151], a[80:83], a[24:27], v[148:151]
ds_read_b64_tr_b16 a[72:73], v19 offset:32768
v_mfma_f32_16x16x32_bf16 v[148:151], a[84:87], a[28:31], v[148:151]
ds_read_b64_tr_b16 a[74:75], v19 offset:33024
v_mfma_f32_16x16x32_bf16 v[132:135], a[84:87], a[20:23], v[132:135]
ds_read_b64_tr_b16 a[76:77], v19 offset:34816
v_mfma_f32_16x16x32_bf16 v[132:135], a[80:83], a[16:19], v[132:135]
ds_read_b64_tr_b16 a[78:79], v19 offset:35072
v_mfma_f32_16x16x32_bf16 v[116:119], a[80:83], a[8:11], v[116:119]
v_mfma_f32_16x16x32_bf16 v[116:119], a[84:87], a[12:15], v[116:119]
v_mfma_f32_16x16x32_bf16 v[100:103], a[84:87], a[4:7], v[100:103]
s_add_u32 m0, s78, 118784
v_mfma_f32_16x16x32_bf16 v[100:103], a[80:83], a[0:3], v[100:103]
s_waitcnt lgkmcnt(4)
s_add_u32 s64, s75, 4327424
ds_read_b64_tr_b16 a[80:81], v20 offset:32768
v_mfma_f32_16x16x32_bf16 v[184:187], a[88:91], a[32:35], v[184:187]
buffer_load_dwordx4 v23, s[60:63], s64 offen lds
v_mfma_f32_16x16x32_bf16 v[184:187], a[92:95], a[36:39], v[184:187]
ds_read_b64_tr_b16 a[82:83], v20 offset:33024
v_mfma_f32_16x16x32_bf16 v[192:195], a[92:95], a[44:47], v[192:195]
ds_read_b64_tr_b16 a[84:85], v20 offset:34816
v_mfma_f32_16x16x32_bf16 v[192:195], a[88:91], a[40:43], v[192:195]
ds_read_b64_tr_b16 a[86:87], v20 offset:35072
v_mfma_f32_16x16x32_bf16 v[200:203], a[88:91], a[48:51], v[200:203]
s_cmp_eq_u32 s30, 0
s_cselect_b32 s81, 256, 0
v_mfma_f32_16x16x32_bf16 v[200:203], a[92:95], a[52:55], v[200:203]
v_mfma_f32_16x16x32_bf16 v[208:211], a[92:95], a[60:63], v[208:211]
v_mfma_f32_16x16x32_bf16 v[208:211], a[88:91], a[56:59], v[208:211]
ds_read_b64_tr_b16 a[88:89], v4 offset:32768
v_mfma_f32_16x16x32_bf16 v[212:215], a[96:99], a[56:59], v[212:215]
s_xor_b32 m0, s77, 100352
ds_read_b64_tr_b16 a[90:91], v4 offset:33792
v_mfma_f32_16x16x32_bf16 v[212:215], a[100:103], a[60:63], v[212:215]
s_xor_b32 s64, s71, 5832704
ds_read_b64_tr_b16 a[92:93], v4 offset:40960
v_mfma_f32_16x16x32_bf16 v[204:207], a[100:103], a[52:55], v[204:207]
buffer_load_dwordx4 v15, s[56:59], s64 offen lds
v_mfma_f32_16x16x32_bf16 v[204:207], a[96:99], a[48:51], v[204:207]
ds_read_b64_tr_b16 a[94:95], v4 offset:41984
v_mfma_f32_16x16x32_bf16 v[196:199], a[96:99], a[40:43], v[196:199]
v_mfma_f32_16x16x32_bf16 v[196:199], a[100:103], a[44:47], v[196:199]
v_mfma_f32_16x16x32_bf16 v[188:191], a[100:103], a[36:39], v[188:191]
v_mfma_f32_16x16x32_bf16 v[188:191], a[96:99], a[32:35], v[188:191]
ds_read_b64_tr_b16 a[96:97], v5 offset:32768
v_mfma_f32_16x16x32_bf16 v[216:219], a[32:35], a[104:107], v[216:219]
ds_read_b64_tr_b16 a[98:99], v5 offset:33792
v_mfma_f32_16x16x32_bf16 v[216:219], a[36:39], a[108:111], v[216:219]
s_add_u32 m0, s78, 122880
ds_read_b64_tr_b16 a[100:101], v5 offset:40960
v_mfma_f32_16x16x32_bf16 v[224:227], a[44:47], a[108:111], v[224:227]
s_add_u32 s64, s75, 4329472
ds_read_b64_tr_b16 a[102:103], v5 offset:41984
v_mfma_f32_16x16x32_bf16 v[224:227], a[40:43], a[104:107], v[224:227]
buffer_load_dwordx4 v23, s[60:63], s64 offen lds
v_mfma_f32_16x16x32_bf16 v[232:235], a[48:51], a[104:107], v[232:235]
v_mfma_f32_16x16x32_bf16 v[232:235], a[52:55], a[108:111], v[232:235]
v_mfma_f32_16x16x32_bf16 v[240:243], a[60:63], a[108:111], v[240:243]
v_mfma_f32_16x16x32_bf16 v[240:243], a[56:59], a[104:107], v[240:243]
ds_read_b64_tr_b16 a[104:105], v6 offset:32768
v_mfma_f32_16x16x32_bf16 v[244:247], a[56:59], a[112:115], v[244:247]
ds_read_b64_tr_b16 a[106:107], v6 offset:33792
v_mfma_f32_16x16x32_bf16 v[244:247], a[60:63], a[116:119], v[244:247]
ds_read_b64_tr_b16 a[108:109], v6 offset:40960
v_subrev_u32 v19, 0x8000, v19
v_mfma_f32_16x16x32_bf16 v[236:239], a[52:55], a[116:119], v[236:239]
s_xor_b32 m0, s77, 101376
ds_read_b64_tr_b16 a[110:111], v6 offset:41984
v_mfma_f32_16x16x32_bf16 v[236:239], a[48:51], a[112:115], v[236:239]
s_xor_b32 s64, s71, 5865472
v_mfma_f32_16x16x32_bf16 v[228:231], a[40:43], a[112:115], v[228:231]
buffer_load_dwordx4 v15, s[56:59], s64 offen lds
v_mfma_f32_16x16x32_bf16 v[228:231], a[44:47], a[116:119], v[228:231]
v_mfma_f32_16x16x32_bf16 v[220:223], a[36:39], a[116:119], v[220:223]
v_mfma_f32_16x16x32_bf16 v[220:223], a[32:35], a[112:115], v[220:223]
s_waitcnt lgkmcnt(4)
ds_read_b64_tr_b16 a[112:113], v7 offset:32768
v_mfma_f32_16x16x32_bf16 v[152:155], a[72:75], a[32:35], v[152:155]
ds_read_b64_tr_b16 a[114:115], v7 offset:33792
v_mfma_f32_16x16x32_bf16 v[152:155], a[76:79], a[36:39], v[152:155]
ds_read_b64_tr_b16 a[116:117], v7 offset:40960
v_subrev_u32 v20, 0x8000, v20
v_mfma_f32_16x16x32_bf16 v[160:163], a[76:79], a[44:47], v[160:163]
ds_read_b64_tr_b16 a[118:119], v7 offset:41984
v_mfma_f32_16x16x32_bf16 v[160:163], a[72:75], a[40:43], v[160:163]
v_mfma_f32_16x16x32_bf16 v[168:171], a[72:75], a[48:51], v[168:171]
v_mfma_f32_16x16x32_bf16 v[168:171], a[76:79], a[52:55], v[168:171]
s_add_u32 s65, s79, 29696
v_mfma_f32_16x16x32_bf16 v[176:179], a[76:79], a[60:63], v[176:179]
s_xor_b32 m0, s84, 32768
buffer_store_dwordx4 a[220:223], v16, s[44:47], s65 offen sc1
v_mfma_f32_16x16x32_bf16 v[176:179], a[72:75], a[56:59], v[176:179]
s_xor_b32 s64, s72, 1408
ds_read_b64_tr_b16 a[72:73], v8 offset:32768
v_mfma_f32_16x16x32_bf16 v[180:183], a[80:83], a[56:59], v[180:183]
buffer_load_dwordx4 v12, s[48:51], s64 offen lds
v_mfma_f32_16x16x32_bf16 v[180:183], a[84:87], a[60:63], v[180:183]
ds_read_b64_tr_b16 a[74:75], v8 offset:33792
v_subrev_u32 v4, 0x8000, v4
v_mfma_f32_16x16x32_bf16 v[172:175], a[84:87], a[52:55], v[172:175]
ds_read_b64_tr_b16 a[76:77], v8 offset:40960
v_mfma_f32_16x16x32_bf16 v[172:175], a[80:83], a[48:51], v[172:175]
s_xor_b32 m0, s84, 33792
ds_read_b64_tr_b16 a[78:79], v8 offset:41984
v_mfma_f32_16x16x32_bf16 v[164:167], a[80:83], a[40:43], v[164:167]
s_xor_b32 s64, s72, 17792
v_mfma_f32_16x16x32_bf16 v[164:167], a[84:87], a[44:47], v[164:167]
buffer_load_dwordx4 v13, s[48:51], s64 offen lds
v_mfma_f32_16x16x32_bf16 v[156:159], a[84:87], a[36:39], v[156:159]
v_mfma_f32_16x16x32_bf16 v[156:159], a[80:83], a[32:35], v[156:159]
ds_read_b64_tr_b16 a[80:81], v9 offset:32768
v_mfma_f32_16x16x32_bf16 v[24:27], a[88:91], a[32:35], v[24:27]
s_xor_b32 m0, s84, 34816
ds_read_b64_tr_b16 a[82:83], v9 offset:33792
v_mfma_f32_16x16x32_bf16 v[24:27], a[92:95], a[36:39], v[24:27]
s_xor_b32 s64, s72, 132480
ds_read_b64_tr_b16 a[84:85], v9 offset:40960
v_subrev_u32 v5, 0x8000, v5
v_mfma_f32_16x16x32_bf16 v[40:43], a[92:95], a[44:47], v[40:43]
buffer_load_dwordx4 v12, s[48:51], s64 offen lds
v_mfma_f32_16x16x32_bf16 v[40:43], a[88:91], a[40:43], v[40:43]
ds_read_b64_tr_b16 a[86:87], v9 offset:41984
v_mfma_f32_16x16x32_bf16 v[56:59], a[88:91], a[48:51], v[56:59]
v_mfma_f32_16x16x32_bf16 v[56:59], a[92:95], a[52:55], v[56:59]
s_xor_b32 m0, s84, 35840
v_mfma_f32_16x16x32_bf16 v[72:75], a[92:95], a[60:63], v[72:75]
s_waitcnt vmcnt(12)
s_xor_b32 s64, s72, 148864
ds_read_b128 a[0:3], v2 offset:0
v_mfma_f32_16x16x32_bf16 v[72:75], a[88:91], a[56:59], v[72:75]
buffer_load_dwordx4 v13, s[48:51], s64 offen lds
v_mfma_f32_16x16x32_bf16 v[136:139], a[96:99], a[56:59], v[136:139]
ds_read_b128 a[4:7], v3 offset:0
v_mfma_f32_16x16x32_bf16 v[136:139], a[100:103], a[60:63], v[136:139]
ds_read_b128 a[8:11], v2 offset:2048
v_subrev_u32 v6, 0x8000, v6
v_mfma_f32_16x16x32_bf16 v[120:123], a[100:103], a[52:55], v[120:123]
s_xor_b32 m0, s84, 36864
ds_read_b128 a[12:15], v3 offset:2048
v_mfma_f32_16x16x32_bf16 v[120:123], a[96:99], a[48:51], v[120:123]
s_xor_b32 s64, s73, 1408
ds_read_b128 a[16:19], v2 offset:4096
v_mfma_f32_16x16x32_bf16 v[104:107], a[96:99], a[40:43], v[104:107]
buffer_load_dwordx4 v12, s[48:51], s64 offen lds
v_mfma_f32_16x16x32_bf16 v[104:107], a[100:103], a[44:47], v[104:107]
ds_read_b128 a[20:23], v3 offset:4096
v_mfma_f32_16x16x32_bf16 v[88:91], a[100:103], a[36:39], v[88:91]
ds_read_b128 a[24:27], v2 offset:6144
v_mfma_f32_16x16x32_bf16 v[88:91], a[96:99], a[32:35], v[88:91]
s_waitcnt lgkmcnt(7)
s_xor_b32 m0, s84, 37888
ds_read_b128 a[28:31], v3 offset:6144
v_mfma_f32_16x16x32_bf16 v[28:31], a[104:107], a[32:35], v[28:31]
s_xor_b32 s64, s73, 17792
ds_read_b64_tr_b16 a[88:89], v10 offset:32768
v_mfma_f32_16x16x32_bf16 v[28:31], a[108:111], a[36:39], v[28:31]
buffer_load_dwordx4 v13, s[48:51], s64 offen lds
v_mfma_f32_16x16x32_bf16 v[44:47], a[108:111], a[44:47], v[44:47]
ds_read_b64_tr_b16 a[90:91], v10 offset:33792
v_subrev_u32 v7, 0x8000, v7
v_mfma_f32_16x16x32_bf16 v[44:47], a[104:107], a[40:43], v[44:47]
ds_read_b64_tr_b16 a[92:93], v10 offset:40960
v_mfma_f32_16x16x32_bf16 v[60:63], a[104:107], a[48:51], v[60:63]
s_xor_b32 m0, s84, 38912
buffer_load_dword v1, off, s[52:55], s78 sc1
v_mfma_f32_16x16x32_bf16 v[60:63], a[108:111], a[52:55], v[60:63]
s_xor_b32 s64, s73, 132480
ds_read_b64_tr_b16 a[94:95], v10 offset:41984
v_mfma_f32_16x16x32_bf16 v[76:79], a[108:111], a[60:63], v[76:79]
buffer_load_dwordx4 v12, s[48:51], s64 offen lds
v_mfma_f32_16x16x32_bf16 v[76:79], a[104:107], a[56:59], v[76:79]
ds_read_b64_tr_b16 a[96:97], v11 offset:32768
v_mfma_f32_16x16x32_bf16 v[140:143], a[112:115], a[56:59], v[140:143]
ds_read_b64_tr_b16 a[98:99], v11 offset:33792
v_mfma_f32_16x16x32_bf16 v[140:143], a[116:119], a[60:63], v[140:143]
s_xor_b32 m0, s84, 39936
ds_read_b64_tr_b16 a[100:101], v11 offset:40960
v_subrev_u32 v8, 0x8000, v8
v_mfma_f32_16x16x32_bf16 v[124:127], a[116:119], a[52:55], v[124:127]
s_xor_b32 s64, s73, 148864
ds_read_b64_tr_b16 a[102:103], v11 offset:41984
v_mfma_f32_16x16x32_bf16 v[124:127], a[112:115], a[48:51], v[124:127]
buffer_load_dwordx4 v13, s[48:51], s64 offen lds
v_mfma_f32_16x16x32_bf16 v[108:111], a[112:115], a[40:43], v[108:111]
v_mfma_f32_16x16x32_bf16 v[108:111], a[116:119], a[44:47], v[108:111]
v_mfma_f32_16x16x32_bf16 v[92:95], a[116:119], a[36:39], v[92:95]
v_subrev_u32 v9, 0x8000, v9
v_subrev_u32 v10, 0x8000, v10
v_mfma_f32_16x16x32_bf16 v[92:95], a[112:115], a[32:35], v[92:95]
v_subrev_u32 v11, 0x8000, v11
v_mfma_f32_16x16x32_bf16 v[32:35], a[72:75], a[32:35], v[32:35]
v_mfma_f32_16x16x32_bf16 v[32:35], a[76:79], a[36:39], v[32:35]
v_mfma_f32_16x16x32_bf16 v[48:51], a[76:79], a[44:47], v[48:51]
s_waitcnt lgkmcnt(0)
s_barrier
v_mfma_f32_16x16x32_bf16 v[48:51], a[72:75], a[40:43], v[48:51]
s_xor_b32 m0, s77, 131072
ds_read_b64_tr_b16 a[104:105], v19 offset:4096
v_mfma_f32_16x16x32_bf16 v[64:67], a[72:75], a[48:51], v[64:67]
s_xor_b32 s64, s71, 6291456
ds_read_b64_tr_b16 a[106:107], v19 offset:4352
v_mfma_f32_16x16x32_bf16 v[64:67], a[76:79], a[52:55], v[64:67]
buffer_load_dwordx4 v14, s[56:59], s64 offen lds
v_mfma_f32_16x16x32_bf16 v[80:83], a[76:79], a[60:63], v[80:83]
ds_read_b64_tr_b16 a[108:109], v19 offset:6144
v_mfma_f32_16x16x32_bf16 v[80:83], a[72:75], a[56:59], v[80:83]
s_add_u32 s65, s79, 13312
ds_read_b64_tr_b16 a[110:111], v19 offset:6400
v_mfma_f32_16x16x32_bf16 v[144:147], a[80:83], a[56:59], v[144:147]
buffer_store_dwordx4 a[224:227], v16, s[44:47], s65 offen sc1
v_mfma_f32_16x16x32_bf16 v[144:147], a[84:87], a[60:63], v[144:147]
ds_read_b64_tr_b16 a[112:113], v20 offset:4096
v_mfma_f32_16x16x32_bf16 v[128:131], a[84:87], a[52:55], v[128:131]
ds_read_b64_tr_b16 a[114:115], v20 offset:4352
v_mfma_f32_16x16x32_bf16 v[128:131], a[80:83], a[48:51], v[128:131]
ds_read_b64_tr_b16 a[116:117], v20 offset:6144
v_mfma_f32_16x16x32_bf16 v[112:115], a[80:83], a[40:43], v[112:115]
s_add_u32 m0, s78, 147456
ds_read_b64_tr_b16 a[118:119], v20 offset:6400
v_mfma_f32_16x16x32_bf16 v[112:115], a[84:87], a[44:47], v[112:115]
s_add_u32 s64, s75, 4718592
ds_read_b64_tr_b16 a[72:73], v19 offset:8192
v_mfma_f32_16x16x32_bf16 v[96:99], a[84:87], a[36:39], v[96:99]
buffer_load_dwordx4 v23, s[60:63], s64 offen lds
v_mfma_f32_16x16x32_bf16 v[96:99], a[80:83], a[32:35], v[96:99]
ds_read_b64_tr_b16 a[74:75], v19 offset:8448
v_mfma_f32_16x16x32_bf16 v[36:39], a[88:91], a[32:35], v[36:39]
ds_read_b64_tr_b16 a[76:77], v19 offset:10240
v_mfma_f32_16x16x32_bf16 v[36:39], a[92:95], a[36:39], v[36:39]
ds_read_b64_tr_b16 a[78:79], v19 offset:10496
v_mfma_f32_16x16x32_bf16 v[52:55], a[92:95], a[44:47], v[52:55]
ds_read_b64_tr_b16 a[80:81], v20 offset:8192
v_mfma_f32_16x16x32_bf16 v[52:55], a[88:91], a[40:43], v[52:55]
ds_read_b64_tr_b16 a[82:83], v20 offset:8448
v_mfma_f32_16x16x32_bf16 v[68:71], a[88:91], a[48:51], v[68:71]
ds_read_b64_tr_b16 a[84:85], v20 offset:10240
v_mfma_f32_16x16x32_bf16 v[68:71], a[92:95], a[52:55], v[68:71]
s_xor_b32 m0, s77, 132096
ds_read_b64_tr_b16 a[86:87], v20 offset:10496
v_mfma_f32_16x16x32_bf16 v[84:87], a[92:95], a[60:63], v[84:87]
s_xor_b32 s64, s71, 6324224
v_mfma_f32_16x16x32_bf16 v[84:87], a[88:91], a[56:59], v[84:87]
buffer_load_dwordx4 v14, s[56:59], s64 offen lds
v_mfma_f32_16x16x32_bf16 v[148:151], a[96:99], a[56:59], v[148:151]
ds_read_b64_tr_b16 a[88:89], v19 offset:0
v_mfma_f32_16x16x32_bf16 v[148:151], a[100:103], a[60:63], v[148:151]
ds_read_b64_tr_b16 a[90:91], v19 offset:256
v_mfma_f32_16x16x32_bf16 v[132:135], a[100:103], a[52:55], v[132:135]
ds_read_b64_tr_b16 a[92:93], v19 offset:2048
v_mfma_f32_16x16x32_bf16 v[132:135], a[96:99], a[48:51], v[132:135]
ds_read_b64_tr_b16 a[94:95], v19 offset:2304
v_mfma_f32_16x16x32_bf16 v[116:119], a[96:99], a[40:43], v[116:119]
v_mfma_f32_16x16x32_bf16 v[116:119], a[100:103], a[44:47], v[116:119]
v_mfma_f32_16x16x32_bf16 v[100:103], a[100:103], a[36:39], v[100:103]
s_add_u32 m0, s78, 151552
v_mfma_f32_16x16x32_bf16 v[100:103], a[96:99], a[32:35], v[100:103]
s_waitcnt lgkmcnt(4)
s_add_u32 s64, s75, 4720640
ds_read_b64_tr_b16 a[96:97], v20 offset:0
v_mfma_f32_16x16x32_bf16 v[184:187], a[104:107], a[0:3], v[184:187]
buffer_load_dwordx4 v23, s[60:63], s64 offen lds
v_mfma_f32_16x16x32_bf16 v[184:187], a[108:111], a[4:7], v[184:187]
ds_read_b64_tr_b16 a[98:99], v20 offset:256
v_mfma_f32_16x16x32_bf16 v[192:195], a[108:111], a[12:15], v[192:195]
ds_read_b64_tr_b16 a[100:101], v20 offset:2048
v_mfma_f32_16x16x32_bf16 v[192:195], a[104:107], a[8:11], v[192:195]
ds_read_b64_tr_b16 a[102:103], v20 offset:2304
v_mfma_f32_16x16x32_bf16 v[200:203], a[104:107], a[16:19], v[200:203]
v_mfma_f32_16x16x32_bf16 v[200:203], a[108:111], a[20:23], v[200:203]
v_mfma_f32_16x16x32_bf16 v[208:211], a[108:111], a[28:31], v[208:211]
v_mfma_f32_16x16x32_bf16 v[208:211], a[104:107], a[24:27], v[208:211]
ds_read_b64_tr_b16 a[104:105], v4 offset:0
v_mfma_f32_16x16x32_bf16 v[212:215], a[112:115], a[24:27], v[212:215]
s_xor_b32 m0, s77, 133120
ds_read_b64_tr_b16 a[106:107], v4 offset:1024
v_mfma_f32_16x16x32_bf16 v[212:215], a[116:119], a[28:31], v[212:215]
s_xor_b32 s64, s71, 6356992
ds_read_b64_tr_b16 a[108:109], v4 offset:8192
v_mfma_f32_16x16x32_bf16 v[204:207], a[116:119], a[20:23], v[204:207]
buffer_load_dwordx4 v15, s[56:59], s64 offen lds
v_mfma_f32_16x16x32_bf16 v[204:207], a[112:115], a[16:19], v[204:207]
ds_read_b64_tr_b16 a[110:111], v4 offset:9216
v_mfma_f32_16x16x32_bf16 v[196:199], a[112:115], a[8:11], v[196:199]
v_mfma_f32_16x16x32_bf16 v[196:199], a[116:119], a[12:15], v[196:199]
v_mfma_f32_16x16x32_bf16 v[188:191], a[116:119], a[4:7], v[188:191]
v_mfma_f32_16x16x32_bf16 v[188:191], a[112:115], a[0:3], v[188:191]
ds_read_b64_tr_b16 a[112:113], v5 offset:0
v_mfma_f32_16x16x32_bf16 v[216:219], a[0:3], a[72:75], v[216:219]
ds_read_b64_tr_b16 a[114:115], v5 offset:1024
v_mfma_f32_16x16x32_bf16 v[216:219], a[4:7], a[76:79], v[216:219]
s_add_u32 m0, s78, 155648
ds_read_b64_tr_b16 a[116:117], v5 offset:8192
v_mfma_f32_16x16x32_bf16 v[224:227], a[12:15], a[76:79], v[224:227]
s_add_u32 s64, s75, 4722688
ds_read_b64_tr_b16 a[118:119], v5 offset:9216
v_mfma_f32_16x16x32_bf16 v[224:227], a[8:11], a[72:75], v[224:227]
buffer_load_dwordx4 v23, s[60:63], s64 offen lds
v_mfma_f32_16x16x32_bf16 v[232:235], a[16:19], a[72:75], v[232:235]
v_mfma_f32_16x16x32_bf16 v[232:235], a[20:23], a[76:79], v[232:235]
v_mfma_f32_16x16x32_bf16 v[240:243], a[28:31], a[76:79], v[240:243]
v_mfma_f32_16x16x32_bf16 v[240:243], a[24:27], a[72:75], v[240:243]
ds_read_b64_tr_b16 a[72:73], v6 offset:0
v_mfma_f32_16x16x32_bf16 v[244:247], a[24:27], a[80:83], v[244:247]
s_add_u32 s65, s79, 30720
ds_read_b64_tr_b16 a[74:75], v6 offset:1024
v_mfma_f32_16x16x32_bf16 v[244:247], a[28:31], a[84:87], v[244:247]
buffer_store_dwordx4 a[228:231], v16, s[44:47], s65 offen sc1
v_mfma_f32_16x16x32_bf16 v[236:239], a[20:23], a[84:87], v[236:239]
s_xor_b32 m0, s77, 134144
ds_read_b64_tr_b16 a[76:77], v6 offset:8192
v_mfma_f32_16x16x32_bf16 v[236:239], a[16:19], a[80:83], v[236:239]
s_xor_b32 s64, s71, 6389760
ds_read_b64_tr_b16 a[78:79], v6 offset:9216
v_mfma_f32_16x16x32_bf16 v[228:231], a[8:11], a[80:83], v[228:231]
buffer_load_dwordx4 v15, s[56:59], s64 offen lds
v_mfma_f32_16x16x32_bf16 v[228:231], a[12:15], a[84:87], v[228:231]
v_mfma_f32_16x16x32_bf16 v[220:223], a[4:7], a[84:87], v[220:223]
v_mfma_f32_16x16x32_bf16 v[220:223], a[0:3], a[80:83], v[220:223]
s_waitcnt lgkmcnt(4)
ds_read_b64_tr_b16 a[80:81], v7 offset:0
v_mfma_f32_16x16x32_bf16 v[152:155], a[88:91], a[0:3], v[152:155]
ds_read_b64_tr_b16 a[82:83], v7 offset:1024
v_mfma_f32_16x16x32_bf16 v[152:155], a[92:95], a[4:7], v[152:155]
ds_read_b64_tr_b16 a[84:85], v7 offset:8192
v_mfma_f32_16x16x32_bf16 v[160:163], a[92:95], a[12:15], v[160:163]
ds_read_b64_tr_b16 a[86:87], v7 offset:9216
v_mfma_f32_16x16x32_bf16 v[160:163], a[88:91], a[8:11], v[160:163]
v_mfma_f32_16x16x32_bf16 v[168:171], a[88:91], a[16:19], v[168:171]
v_mfma_f32_16x16x32_bf16 v[168:171], a[92:95], a[20:23], v[168:171]
v_mfma_f32_16x16x32_bf16 v[176:179], a[92:95], a[28:31], v[176:179]
s_xor_b32 m0, s84, 0
v_mfma_f32_16x16x32_bf16 v[176:179], a[88:91], a[24:27], v[176:179]
s_xor_b32 s64, s72, 1536
ds_read_b64_tr_b16 a[88:89], v8 offset:0
v_mfma_f32_16x16x32_bf16 v[180:183], a[96:99], a[24:27], v[180:183]
buffer_load_dwordx4 v12, s[48:51], s64 offen lds
v_mfma_f32_16x16x32_bf16 v[180:183], a[100:103], a[28:31], v[180:183]
ds_read_b64_tr_b16 a[90:91], v8 offset:1024
v_mfma_f32_16x16x32_bf16 v[172:175], a[100:103], a[20:23], v[172:175]
ds_read_b64_tr_b16 a[92:93], v8 offset:8192
v_mfma_f32_16x16x32_bf16 v[172:175], a[96:99], a[16:19], v[172:175]
s_branch L_po11
L_pg11:
s_branch L_tr0
L_po11:
s_xor_b32 m0, s84, 1024
ds_read_b64_tr_b16 a[94:95], v8 offset:9216
v_mfma_f32_16x16x32_bf16 v[164:167], a[96:99], a[8:11], v[164:167]
s_xor_b32 s64, s72, 17920
v_mfma_f32_16x16x32_bf16 v[164:167], a[100:103], a[12:15], v[164:167]
buffer_load_dwordx4 v13, s[48:51], s64 offen lds
v_mfma_f32_16x16x32_bf16 v[156:159], a[100:103], a[4:7], v[156:159]
v_mfma_f32_16x16x32_bf16 v[156:159], a[96:99], a[0:3], v[156:159]
ds_read_b64_tr_b16 a[96:97], v9 offset:0
v_mfma_f32_16x16x32_bf16 v[24:27], a[104:107], a[0:3], v[24:27]
s_xor_b32 m0, s84, 2048
ds_read_b64_tr_b16 a[98:99], v9 offset:1024
v_mfma_f32_16x16x32_bf16 v[24:27], a[108:111], a[4:7], v[24:27]
s_xor_b32 s64, s72, 132608
ds_read_b64_tr_b16 a[100:101], v9 offset:8192
v_mfma_f32_16x16x32_bf16 v[40:43], a[108:111], a[12:15], v[40:43]
buffer_load_dwordx4 v12, s[48:51], s64 offen lds
v_mfma_f32_16x16x32_bf16 v[40:43], a[104:107], a[8:11], v[40:43]
ds_read_b64_tr_b16 a[102:103], v9 offset:9216
v_mfma_f32_16x16x32_bf16 v[56:59], a[104:107], a[16:19], v[56:59]
v_mfma_f32_16x16x32_bf16 v[56:59], a[108:111], a[20:23], v[56:59]
s_xor_b32 m0, s84, 3072
v_mfma_f32_16x16x32_bf16 v[72:75], a[108:111], a[28:31], v[72:75]
s_waitcnt vmcnt(12)
s_xor_b32 s64, s72, 148992
ds_read_b128 a[32:35], v2 offset:32768
v_mfma_f32_16x16x32_bf16 v[72:75], a[104:107], a[24:27], v[72:75]
buffer_load_dwordx4 v13, s[48:51], s64 offen lds
v_mfma_f32_16x16x32_bf16 v[136:139], a[112:115], a[24:27], v[136:139]
ds_read_b128 a[36:39], v3 offset:32768
v_mfma_f32_16x16x32_bf16 v[136:139], a[116:119], a[28:31], v[136:139]
ds_read_b128 a[40:43], v2 offset:34816
v_mfma_f32_16x16x32_bf16 v[120:123], a[116:119], a[20:23], v[120:123]
s_xor_b32 m0, s84, 4096
ds_read_b128 a[44:47], v3 offset:34816
v_mfma_f32_16x16x32_bf16 v[120:123], a[112:115], a[16:19], v[120:123]
s_xor_b32 s64, s73, 1536
ds_read_b128 a[48:51], v2 offset:36864
v_mfma_f32_16x16x32_bf16 v[104:107], a[112:115], a[8:11], v[104:107]
buffer_load_dwordx4 v12, s[48:51], s64 offen lds
v_mfma_f32_16x16x32_bf16 v[104:107], a[116:119], a[12:15], v[104:107]
ds_read_b128 a[52:55], v3 offset:36864
v_mfma_f32_16x16x32_bf16 v[88:91], a[116:119], a[4:7], v[88:91]
ds_read_b128 a[56:59], v2 offset:38912
v_mfma_f32_16x16x32_bf16 v[88:91], a[112:115], a[0:3], v[88:91]
s_waitcnt lgkmcnt(7)
s_xor_b32 m0, s84, 5120
ds_read_b128 a[60:63], v3 offset:38912
v_mfma_f32_16x16x32_bf16 v[28:31], a[72:75], a[0:3], v[28:31]
s_xor_b32 s64, s73, 17920
ds_read_b64_tr_b16 a[104:105], v10 offset:0
v_mfma_f32_16x16x32_bf16 v[28:31], a[76:79], a[4:7], v[28:31]
buffer_load_dwordx4 v13, s[48:51], s64 offen lds
v_mfma_f32_16x16x32_bf16 v[44:47], a[76:79], a[12:15], v[44:47]
ds_read_b64_tr_b16 a[106:107], v10 offset:1024
v_mfma_f32_16x16x32_bf16 v[44:47], a[72:75], a[8:11], v[44:47]
ds_read_b64_tr_b16 a[108:109], v10 offset:8192
v_mfma_f32_16x16x32_bf16 v[60:63], a[72:75], a[16:19], v[60:63]
s_xor_b32 m0, s84, 6144
ds_read_b64_tr_b16 a[110:111], v10 offset:9216
v_mfma_f32_16x16x32_bf16 v[60:63], a[76:79], a[20:23], v[60:63]
s_xor_b32 s64, s73, 132608
ds_read_b64_tr_b16 a[112:113], v11 offset:0
v_mfma_f32_16x16x32_bf16 v[76:79], a[76:79], a[28:31], v[76:79]
buffer_load_dwordx4 v12, s[48:51], s64 offen lds
v_mfma_f32_16x16x32_bf16 v[76:79], a[72:75], a[24:27], v[76:79]
ds_read_b64_tr_b16 a[114:115], v11 offset:1024
v_mfma_f32_16x16x32_bf16 v[140:143], a[80:83], a[24:27], v[140:143]
s_xor_b32 m0, s84, 7168
ds_read_b64_tr_b16 a[116:117], v11 offset:8192
v_mfma_f32_16x16x32_bf16 v[140:143], a[84:87], a[28:31], v[140:143]
s_xor_b32 s64, s73, 148992
ds_read_b64_tr_b16 a[118:119], v11 offset:9216
v_mfma_f32_16x16x32_bf16 v[124:127], a[84:87], a[20:23], v[124:127]
v_readfirstlane_b32 vcc_lo, v1
s_nop 0
s_cmp_lt_u32 vcc_lo, s81
s_cbranch_scc1 L_spin_1
L_spinbk_2:
v_mfma_f32_16x16x32_bf16 v[124:127], a[80:83], a[16:19], v[124:127]
s_add_u32 s65, s79, 31744
buffer_load_dwordx4 v13, s[48:51], s64 offen lds
v_mfma_f32_16x16x32_bf16 v[108:111], a[80:83], a[8:11], v[108:111]
buffer_store_dwordx4 a[232:235], v16, s[44:47], s65 offen sc1
v_mfma_f32_16x16x32_bf16 v[108:111], a[84:87], a[12:15], v[108:111]
v_mfma_f32_16x16x32_bf16 v[92:95], a[84:87], a[4:7], v[92:95]
s_add_u32 s52, s28, 59768832
s_addc_u32 s53, s29, 0
s_mov_b32 s54, 16384
v_mfma_f32_16x16x32_bf16 v[92:95], a[80:83], a[0:3], v[92:95]
v_mfma_f32_16x16x32_bf16 v[32:35], a[88:91], a[0:3], v[32:35]
v_mfma_f32_16x16x32_bf16 v[32:35], a[92:95], a[4:7], v[32:35]
v_mfma_f32_16x16x32_bf16 v[48:51], a[92:95], a[12:15], v[48:51]
s_waitcnt lgkmcnt(0)
s_barrier
v_mfma_f32_16x16x32_bf16 v[48:51], a[88:91], a[8:11], v[48:51]
s_xor_b32 m0, s77, 65536
ds_read_b64_tr_b16 a[72:73], v19 offset:36864
v_mfma_f32_16x16x32_bf16 v[64:67], a[88:91], a[16:19], v[64:67]
s_xor_b32 s64, s71, 6815744
ds_read_b64_tr_b16 a[74:75], v19 offset:37120
v_mfma_f32_16x16x32_bf16 v[64:67], a[92:95], a[20:23], v[64:67]
buffer_load_dwordx4 v14, s[56:59], s64 offen lds
v_mfma_f32_16x16x32_bf16 v[80:83], a[92:95], a[28:31], v[80:83]
ds_read_b64_tr_b16 a[76:77], v19 offset:38912
v_mfma_f32_16x16x32_bf16 v[80:83], a[88:91], a[24:27], v[80:83]
ds_read_b64_tr_b16 a[78:79], v19 offset:39168
v_mfma_f32_16x16x32_bf16 v[144:147], a[96:99], a[24:27], v[144:147]
ds_read_b64_tr_b16 a[80:81], v20 offset:36864
v_mfma_f32_16x16x32_bf16 v[144:147], a[100:103], a[28:31], v[144:147]
ds_read_b64_tr_b16 a[82:83], v20 offset:37120
v_mfma_f32_16x16x32_bf16 v[128:131], a[100:103], a[20:23], v[128:131]
ds_read_b64_tr_b16 a[84:85], v20 offset:38912
v_mfma_f32_16x16x32_bf16 v[128:131], a[96:99], a[16:19], v[128:131]
ds_read_b64_tr_b16 a[86:87], v20 offset:39168
v_mfma_f32_16x16x32_bf16 v[112:115], a[96:99], a[8:11], v[112:115]
s_add_u32 m0, s78, 81920
ds_read_b64_tr_b16 a[88:89], v19 offset:40960
v_mfma_f32_16x16x32_bf16 v[112:115], a[100:103], a[12:15], v[112:115]
s_add_u32 s64, s75, 5111808
ds_read_b64_tr_b16 a[90:91], v19 offset:41216
v_mfma_f32_16x16x32_bf16 v[96:99], a[100:103], a[4:7], v[96:99]
buffer_load_dwordx4 v23, s[60:63], s64 offen lds
v_mfma_f32_16x16x32_bf16 v[96:99], a[96:99], a[0:3], v[96:99]
ds_read_b64_tr_b16 a[92:93], v19 offset:43008
v_mfma_f32_16x16x32_bf16 v[36:39], a[104:107], a[0:3], v[36:39]
ds_read_b64_tr_b16 a[94:95], v19 offset:43264
v_mfma_f32_16x16x32_bf16 v[36:39], a[108:111], a[4:7], v[36:39]
ds_read_b64_tr_b16 a[96:97], v20 offset:40960
v_mfma_f32_16x16x32_bf16 v[52:55], a[108:111], a[12:15], v[52:55]
ds_read_b64_tr_b16 a[98:99], v20 offset:41216
v_mfma_f32_16x16x32_bf16 v[52:55], a[104:107], a[8:11], v[52:55]
ds_read_b64_tr_b16 a[100:101], v20 offset:43008
v_mfma_f32_16x16x32_bf16 v[68:71], a[104:107], a[16:19], v[68:71]
ds_read_b64_tr_b16 a[102:103], v20 offset:43264
v_mfma_f32_16x16x32_bf16 v[68:71], a[108:111], a[20:23], v[68:71]
s_xor_b32 m0, s77, 66560
v_mfma_f32_16x16x32_bf16 v[84:87], a[108:111], a[28:31], v[84:87]
s_xor_b32 s64, s71, 6848512
v_mfma_f32_16x16x32_bf16 v[84:87], a[104:107], a[24:27], v[84:87]
buffer_load_dwordx4 v14, s[56:59], s64 offen lds
v_mfma_f32_16x16x32_bf16 v[148:151], a[112:115], a[24:27], v[148:151]
ds_read_b64_tr_b16 a[104:105], v19 offset:32768
v_mfma_f32_16x16x32_bf16 v[148:151], a[116:119], a[28:31], v[148:151]
ds_read_b64_tr_b16 a[106:107], v19 offset:33024
v_mfma_f32_16x16x32_bf16 v[132:135], a[116:119], a[20:23], v[132:135]
ds_read_b64_tr_b16 a[108:109], v19 offset:34816
v_mfma_f32_16x16x32_bf16 v[132:135], a[112:115], a[16:19], v[132:135]
ds_read_b64_tr_b16 a[110:111], v19 offset:35072
v_mfma_f32_16x16x32_bf16 v[116:119], a[112:115], a[8:11], v[116:119]
v_mfma_f32_16x16x32_bf16 v[116:119], a[116:119], a[12:15], v[116:119]
v_mfma_f32_16x16x32_bf16 v[100:103], a[116:119], a[4:7], v[100:103]
s_add_u32 m0, s78, 86016
v_mfma_f32_16x16x32_bf16 v[100:103], a[112:115], a[0:3], v[100:103]
s_waitcnt lgkmcnt(4)
s_add_u32 s64, s75, 5113856
ds_read_b64_tr_b16 a[112:113], v20 offset:32768
v_mfma_f32_16x16x32_bf16 v[184:187], a[72:75], a[32:35], v[184:187]
buffer_load_dwordx4 v23, s[60:63], s64 offen lds
v_mfma_f32_16x16x32_bf16 v[184:187], a[76:79], a[36:39], v[184:187]
ds_read_b64_tr_b16 a[114:115], v20 offset:33024
v_mfma_f32_16x16x32_bf16 v[192:195], a[76:79], a[44:47], v[192:195]
ds_read_b64_tr_b16 a[116:117], v20 offset:34816
v_mfma_f32_16x16x32_bf16 v[192:195], a[72:75], a[40:43], v[192:195]
ds_read_b64_tr_b16 a[118:119], v20 offset:35072
v_mfma_f32_16x16x32_bf16 v[200:203], a[72:75], a[48:51], v[200:203]
v_mfma_f32_16x16x32_bf16 v[200:203], a[76:79], a[52:55], v[200:203]
v_mfma_f32_16x16x32_bf16 v[208:211], a[76:79], a[60:63], v[208:211]
v_mfma_f32_16x16x32_bf16 v[208:211], a[72:75], a[56:59], v[208:211]
ds_read_b64_tr_b16 a[72:73], v4 offset:32768
v_mfma_f32_16x16x32_bf16 v[212:215], a[80:83], a[56:59], v[212:215]
s_xor_b32 m0, s77, 67584
ds_read_b64_tr_b16 a[74:75], v4 offset:33792
v_mfma_f32_16x16x32_bf16 v[212:215], a[84:87], a[60:63], v[212:215]
s_xor_b32 s64, s71, 6881280
ds_read_b64_tr_b16 a[76:77], v4 offset:40960
v_mfma_f32_16x16x32_bf16 v[204:207], a[84:87], a[52:55], v[204:207]
buffer_load_dwordx4 v15, s[56:59], s64 offen lds
v_mfma_f32_16x16x32_bf16 v[204:207], a[80:83], a[48:51], v[204:207]
s_add_u32 s65, s79, 15360
ds_read_b64_tr_b16 a[78:79], v4 offset:41984
v_mfma_f32_16x16x32_bf16 v[196:199], a[80:83], a[40:43], v[196:199]
buffer_store_dwordx4 a[236:239], v16, s[44:47], s65 offen sc1
v_mfma_f32_16x16x32_bf16 v[196:199], a[84:87], a[44:47], v[196:199]
v_mfma_f32_16x16x32_bf16 v[188:191], a[84:87], a[36:39], v[188:191]
v_mfma_f32_16x16x32_bf16 v[188:191], a[80:83], a[32:35], v[188:191]
ds_read_b64_tr_b16 a[80:81], v5 offset:32768
v_mfma_f32_16x16x32_bf16 v[216:219], a[32:35], a[88:91], v[216:219]
ds_read_b64_tr_b16 a[82:83], v5 offset:33792
v_mfma_f32_16x16x32_bf16 v[216:219], a[36:39], a[92:95], v[216:219]
s_add_u32 m0, s78, 90112
ds_read_b64_tr_b16 a[84:85], v5 offset:40960
v_mfma_f32_16x16x32_bf16 v[224:227], a[44:47], a[92:95], v[224:227]
s_add_u32 s64, s75, 5115904
ds_read_b64_tr_b16 a[86:87], v5 offset:41984
v_mfma_f32_16x16x32_bf16 v[224:227], a[40:43], a[88:91], v[224:227]
buffer_load_dwordx4 v23, s[60:63], s64 offen lds
v_mfma_f32_16x16x32_bf16 v[232:235], a[48:51], a[88:91], v[232:235]
v_mfma_f32_16x16x32_bf16 v[232:235], a[52:55], a[92:95], v[232:235]
v_mfma_f32_16x16x32_bf16 v[240:243], a[60:63], a[92:95], v[240:243]
v_mfma_f32_16x16x32_bf16 v[240:243], a[56:59], a[88:91], v[240:243]
ds_read_b64_tr_b16 a[88:89], v6 offset:32768
v_mfma_f32_16x16x32_bf16 v[244:247], a[56:59], a[96:99], v[244:247]
ds_read_b64_tr_b16 a[90:91], v6 offset:33792
v_mfma_f32_16x16x32_bf16 v[244:247], a[60:63], a[100:103], v[244:247]
ds_read_b64_tr_b16 a[92:93], v6 offset:40960
v_add_u32 v19, 0x8000, v19
v_mfma_f32_16x16x32_bf16 v[236:239], a[52:55], a[100:103], v[236:239]
s_xor_b32 m0, s77, 68608
ds_read_b64_tr_b16 a[94:95], v6 offset:41984
v_mfma_f32_16x16x32_bf16 v[236:239], a[48:51], a[96:99], v[236:239]
s_xor_b32 s64, s71, 6914048
v_mfma_f32_16x16x32_bf16 v[228:231], a[40:43], a[96:99], v[228:231]
buffer_load_dwordx4 v15, s[56:59], s64 offen lds
v_mfma_f32_16x16x32_bf16 v[228:231], a[44:47], a[100:103], v[228:231]
v_mfma_f32_16x16x32_bf16 v[220:223], a[36:39], a[100:103], v[220:223]
v_mfma_f32_16x16x32_bf16 v[220:223], a[32:35], a[96:99], v[220:223]
s_waitcnt lgkmcnt(4)
ds_read_b64_tr_b16 a[96:97], v7 offset:32768
v_mfma_f32_16x16x32_bf16 v[152:155], a[104:107], a[32:35], v[152:155]
ds_read_b64_tr_b16 a[98:99], v7 offset:33792
v_mfma_f32_16x16x32_bf16 v[152:155], a[108:111], a[36:39], v[152:155]
ds_read_b64_tr_b16 a[100:101], v7 offset:40960
v_add_u32 v20, 0x8000, v20
v_mfma_f32_16x16x32_bf16 v[160:163], a[108:111], a[44:47], v[160:163]
ds_read_b64_tr_b16 a[102:103], v7 offset:41984
v_mfma_f32_16x16x32_bf16 v[160:163], a[104:107], a[40:43], v[160:163]
v_mfma_f32_16x16x32_bf16 v[168:171], a[104:107], a[48:51], v[168:171]
v_mfma_f32_16x16x32_bf16 v[168:171], a[108:111], a[52:55], v[168:171]
v_mfma_f32_16x16x32_bf16 v[176:179], a[108:111], a[60:63], v[176:179]
s_xor_b32 m0, s84, 32768
v_mfma_f32_16x16x32_bf16 v[176:179], a[104:107], a[56:59], v[176:179]
s_xor_b32 s64, s72, 1664
ds_read_b64_tr_b16 a[104:105], v8 offset:32768
v_mfma_f32_16x16x32_bf16 v[180:183], a[112:115], a[56:59], v[180:183]
buffer_load_dwordx4 v12, s[48:51], s64 offen lds
v_mfma_f32_16x16x32_bf16 v[180:183], a[116:119], a[60:63], v[180:183]
ds_read_b64_tr_b16 a[106:107], v8 offset:33792
v_add_u32 v4, 0x8000, v4
v_mfma_f32_16x16x32_bf16 v[172:175], a[116:119], a[52:55], v[172:175]
ds_read_b64_tr_b16 a[108:109], v8 offset:40960
v_mfma_f32_16x16x32_bf16 v[172:175], a[112:115], a[48:51], v[172:175]
s_xor_b32 m0, s84, 33792
ds_read_b64_tr_b16 a[110:111], v8 offset:41984
v_mfma_f32_16x16x32_bf16 v[164:167], a[112:115], a[40:43], v[164:167]
s_xor_b32 s64, s72, 18048
v_mfma_f32_16x16x32_bf16 v[164:167], a[116:119], a[44:47], v[164:167]
buffer_load_dwordx4 v13, s[48:51], s64 offen lds
v_mfma_f32_16x16x32_bf16 v[156:159], a[116:119], a[36:39], v[156:159]
v_mfma_f32_16x16x32_bf16 v[156:159], a[112:115], a[32:35], v[156:159]
ds_read_b64_tr_b16 a[112:113], v9 offset:32768
v_mfma_f32_16x16x32_bf16 v[24:27], a[72:75], a[32:35], v[24:27]
s_xor_b32 m0, s84, 34816
ds_read_b64_tr_b16 a[114:115], v9 offset:33792
v_mfma_f32_16x16x32_bf16 v[24:27], a[76:79], a[36:39], v[24:27]
s_xor_b32 s64, s72, 132736
ds_read_b64_tr_b16 a[116:117], v9 offset:40960
v_add_u32 v5, 0x8000, v5
v_mfma_f32_16x16x32_bf16 v[40:43], a[76:79], a[44:47], v[40:43]
buffer_load_dwordx4 v12, s[48:51], s64 offen lds
v_mfma_f32_16x16x32_bf16 v[40:43], a[72:75], a[40:43], v[40:43]
ds_read_b64_tr_b16 a[118:119], v9 offset:41984
v_mfma_f32_16x16x32_bf16 v[56:59], a[72:75], a[48:51], v[56:59]
v_mfma_f32_16x16x32_bf16 v[56:59], a[76:79], a[52:55], v[56:59]
s_xor_b32 m0, s84, 35840
v_mfma_f32_16x16x32_bf16 v[72:75], a[76:79], a[60:63], v[72:75]
s_waitcnt vmcnt(12)
s_xor_b32 s64, s72, 149120
ds_read_b128 a[0:3], v2 offset:0
v_mfma_f32_16x16x32_bf16 v[72:75], a[72:75], a[56:59], v[72:75]
buffer_load_dwordx4 v13, s[48:51], s64 offen lds
v_mfma_f32_16x16x32_bf16 v[136:139], a[80:83], a[56:59], v[136:139]
ds_read_b128 a[4:7], v3 offset:0
v_mfma_f32_16x16x32_bf16 v[136:139], a[84:87], a[60:63], v[136:139]
ds_read_b128 a[8:11], v2 offset:2048
v_add_u32 v6, 0x8000, v6
v_mfma_f32_16x16x32_bf16 v[120:123], a[84:87], a[52:55], v[120:123]
s_xor_b32 m0, s84, 36864
ds_read_b128 a[12:15], v3 offset:2048
v_mfma_f32_16x16x32_bf16 v[120:123], a[80:83], a[48:51], v[120:123]
s_xor_b32 s64, s73, 1664
ds_read_b128 a[16:19], v2 offset:4096
v_mfma_f32_16x16x32_bf16 v[104:107], a[80:83], a[40:43], v[104:107]
buffer_load_dwordx4 v12, s[48:51], s64 offen lds
v_mfma_f32_16x16x32_bf16 v[104:107], a[84:87], a[44:47], v[104:107]
ds_read_b128 a[20:23], v3 offset:4096
v_mfma_f32_16x16x32_bf16 v[88:91], a[84:87], a[36:39], v[88:91]
buffer_store_dwordx4 a[240:243], v16, s[44:47], s74 offen sc1
v_mfma_f32_16x16x32_bf16 v[88:91], a[80:83], a[32:35], v[88:91]
s_waitcnt lgkmcnt(6)
s_xor_b32 m0, s84, 37888
ds_read_b128 a[24:27], v2 offset:6144
v_mfma_f32_16x16x32_bf16 v[28:31], a[88:91], a[32:35], v[28:31]
s_xor_b32 s64, s73, 18048
ds_read_b128 a[28:31], v3 offset:6144
v_mfma_f32_16x16x32_bf16 v[28:31], a[92:95], a[36:39], v[28:31]
buffer_load_dwordx4 v13, s[48:51], s64 offen lds
v_mfma_f32_16x16x32_bf16 v[44:47], a[92:95], a[44:47], v[44:47]
ds_read_b64_tr_b16 a[72:73], v10 offset:32768
v_add_u32 v7, 0x8000, v7
v_mfma_f32_16x16x32_bf16 v[44:47], a[88:91], a[40:43], v[44:47]
ds_read_b64_tr_b16 a[74:75], v10 offset:33792
v_mfma_f32_16x16x32_bf16 v[60:63], a[88:91], a[48:51], v[60:63]
s_xor_b32 m0, s84, 38912
ds_read_b64_tr_b16 a[76:77], v10 offset:40960
v_mfma_f32_16x16x32_bf16 v[60:63], a[92:95], a[52:55], v[60:63]
s_xor_b32 s64, s73, 132736
ds_read_b64_tr_b16 a[78:79], v10 offset:41984
v_mfma_f32_16x16x32_bf16 v[76:79], a[92:95], a[60:63], v[76:79]
buffer_load_dwordx4 v12, s[48:51], s64 offen lds
v_mfma_f32_16x16x32_bf16 v[76:79], a[88:91], a[56:59], v[76:79]
ds_read_b64_tr_b16 a[80:81], v11 offset:32768
v_mfma_f32_16x16x32_bf16 v[140:143], a[96:99], a[56:59], v[140:143]
ds_read_b64_tr_b16 a[82:83], v11 offset:33792
v_lshrrev_b32 v22, 2, v0
v_mfma_f32_16x16x32_bf16 v[140:143], a[100:103], a[60:63], v[140:143]
s_xor_b32 m0, s84, 39936
ds_read_b64_tr_b16 a[84:85], v11 offset:40960
v_add_u32 v8, 0x8000, v8
v_mfma_f32_16x16x32_bf16 v[124:127], a[100:103], a[52:55], v[124:127]
s_xor_b32 s64, s73, 149120
ds_read_b64_tr_b16 a[86:87], v11 offset:41984
v_mul_u32_u24 v22, 3584, v22
v_mfma_f32_16x16x32_bf16 v[124:127], a[96:99], a[48:51], v[124:127]
buffer_load_dwordx4 v13, s[48:51], s64 offen lds
v_mfma_f32_16x16x32_bf16 v[108:111], a[96:99], a[40:43], v[108:111]
v_lshl_add_u32 v22, v0, 7, v22
v_mfma_f32_16x16x32_bf16 v[108:111], a[100:103], a[44:47], v[108:111]
v_mfma_f32_16x16x32_bf16 v[92:95], a[100:103], a[36:39], v[92:95]
v_add_u32 v9, 0x8000, v9
v_add_u32 v10, 0x8000, v10
v_mfma_f32_16x16x32_bf16 v[92:95], a[96:99], a[32:35], v[92:95]
v_add_u32 v11, 0x8000, v11
v_mfma_f32_16x16x32_bf16 v[32:35], a[104:107], a[32:35], v[32:35]
v_mfma_f32_16x16x32_bf16 v[32:35], a[108:111], a[36:39], v[32:35]
v_mfma_f32_16x16x32_bf16 v[48:51], a[108:111], a[44:47], v[48:51]
s_waitcnt lgkmcnt(0)
s_barrier
v_mfma_f32_16x16x32_bf16 v[48:51], a[104:107], a[40:43], v[48:51]
s_xor_b32 m0, s77, 98304
ds_read_b64_tr_b16 a[88:89], v19 offset:36864
v_mfma_f32_16x16x32_bf16 v[64:67], a[104:107], a[48:51], v[64:67]
s_xor_b32 s64, s71, 7340032
ds_read_b64_tr_b16 a[90:91], v19 offset:37120
v_mfma_f32_16x16x32_bf16 v[64:67], a[108:111], a[52:55], v[64:67]
buffer_load_dwordx4 v14, s[56:59], s64 offen lds
v_mfma_f32_16x16x32_bf16 v[80:83], a[108:111], a[60:63], v[80:83]
ds_read_b64_tr_b16 a[92:93], v19 offset:38912
v_mfma_f32_16x16x32_bf16 v[80:83], a[104:107], a[56:59], v[80:83]
ds_read_b64_tr_b16 a[94:95], v19 offset:39168
v_mfma_f32_16x16x32_bf16 v[144:147], a[112:115], a[56:59], v[144:147]
ds_read_b64_tr_b16 a[96:97], v20 offset:36864
v_mfma_f32_16x16x32_bf16 v[144:147], a[116:119], a[60:63], v[144:147]
ds_read_b64_tr_b16 a[98:99], v20 offset:37120
v_mfma_f32_16x16x32_bf16 v[128:131], a[116:119], a[52:55], v[128:131]
ds_read_b64_tr_b16 a[100:101], v20 offset:38912
v_mfma_f32_16x16x32_bf16 v[128:131], a[112:115], a[48:51], v[128:131]
ds_read_b64_tr_b16 a[102:103], v20 offset:39168
v_mfma_f32_16x16x32_bf16 v[112:115], a[112:115], a[40:43], v[112:115]
s_add_u32 m0, s78, 114688
ds_read_b64_tr_b16 a[104:105], v19 offset:40960
v_mfma_f32_16x16x32_bf16 v[112:115], a[116:119], a[44:47], v[112:115]
s_add_u32 s64, s75, 5505024
ds_read_b64_tr_b16 a[106:107], v19 offset:41216
v_mfma_f32_16x16x32_bf16 v[96:99], a[116:119], a[36:39], v[96:99]
buffer_load_dwordx4 v23, s[60:63], s64 offen lds
v_mfma_f32_16x16x32_bf16 v[96:99], a[112:115], a[32:35], v[96:99]
ds_read_b64_tr_b16 a[108:109], v19 offset:43008
v_mfma_f32_16x16x32_bf16 v[36:39], a[72:75], a[32:35], v[36:39]
ds_read_b64_tr_b16 a[110:111], v19 offset:43264
v_mfma_f32_16x16x32_bf16 v[36:39], a[76:79], a[36:39], v[36:39]
ds_read_b64_tr_b16 a[112:113], v20 offset:40960
v_mfma_f32_16x16x32_bf16 v[52:55], a[76:79], a[44:47], v[52:55]
ds_read_b64_tr_b16 a[114:115], v20 offset:41216
v_mfma_f32_16x16x32_bf16 v[52:55], a[72:75], a[40:43], v[52:55]
s_lshr_b32 s17, s78, 1
ds_read_b64_tr_b16 a[116:117], v20 offset:43008
v_mfma_f32_16x16x32_bf16 v[68:71], a[72:75], a[48:51], v[68:71]
s_add_u32 s17, s17, L_base-L_pc-4+49152
ds_read_b64_tr_b16 a[118:119], v20 offset:43264
v_mfma_f32_16x16x32_bf16 v[68:71], a[76:79], a[52:55], v[68:71]
s_xor_b32 m0, s77, 99328
buffer_load_dword a252, v22, s[88:91], s17 offen
v_mfma_f32_16x16x32_bf16 v[84:87], a[76:79], a[60:63], v[84:87]
s_xor_b32 s64, s71, 7372800
v_mfma_f32_16x16x32_bf16 v[84:87], a[72:75], a[56:59], v[84:87]
buffer_load_dwordx4 v14, s[56:59], s64 offen lds
v_mfma_f32_16x16x32_bf16 v[148:151], a[80:83], a[56:59], v[148:151]
ds_read_b64_tr_b16 a[72:73], v19 offset:32768
v_mfma_f32_16x16x32_bf16 v[148:151], a[84:87], a[60:63], v[148:151]
ds_read_b64_tr_b16 a[74:75], v19 offset:33024
v_mfma_f32_16x16x32_bf16 v[132:135], a[84:87], a[52:55], v[132:135]
ds_read_b64_tr_b16 a[76:77], v19 offset:34816
v_mfma_f32_16x16x32_bf16 v[132:135], a[80:83], a[48:51], v[132:135]
ds_read_b64_tr_b16 a[78:79], v19 offset:35072
v_mfma_f32_16x16x32_bf16 v[116:119], a[80:83], a[40:43], v[116:119]
v_mfma_f32_16x16x32_bf16 v[116:119], a[84:87], a[44:47], v[116:119]
v_mfma_f32_16x16x32_bf16 v[100:103], a[84:87], a[36:39], v[100:103]
s_add_u32 m0, s78, 118784
v_mfma_f32_16x16x32_bf16 v[100:103], a[80:83], a[32:35], v[100:103]
s_waitcnt lgkmcnt(4)
s_add_u32 s64, s75, 5507072
ds_read_b64_tr_b16 a[80:81], v20 offset:32768
v_mfma_f32_16x16x32_bf16 v[184:187], a[88:91], a[0:3], v[184:187]
s_lshl_b32 s66, s30, 30
buffer_load_dwordx4 v23, s[60:63], s64 offen lds
v_mfma_f32_16x16x32_bf16 v[184:187], a[92:95], a[4:7], v[184:187]
ds_read_b64_tr_b16 a[82:83], v20 offset:33024
v_lshl_add_u32 v1, v0, 24, s66
v_mfma_f32_16x16x32_bf16 v[192:195], a[92:95], a[12:15], v[192:195]
s_lshl_b32 s70, s31, 8
ds_read_b64_tr_b16 a[84:85], v20 offset:34816
v_mfma_f32_16x16x32_bf16 v[192:195], a[88:91], a[8:11], v[192:195]
ds_read_b64_tr_b16 a[86:87], v20 offset:35072
v_mfma_f32_16x16x32_bf16 v[200:203], a[88:91], a[16:19], v[200:203]
v_mfma_f32_16x16x32_bf16 v[200:203], a[92:95], a[20:23], v[200:203]
v_mfma_f32_16x16x32_bf16 v[208:211], a[92:95], a[28:31], v[208:211]
v_mfma_f32_16x16x32_bf16 v[208:211], a[88:91], a[24:27], v[208:211]
ds_read_b64_tr_b16 a[88:89], v4 offset:32768
v_mfma_f32_16x16x32_bf16 v[212:215], a[96:99], a[24:27], v[212:215]
s_xor_b32 m0, s77, 100352
ds_read_b64_tr_b16 a[90:91], v4 offset:33792
v_mfma_f32_16x16x32_bf16 v[212:215], a[100:103], a[28:31], v[212:215]
s_xor_b32 s64, s71, 7405568
ds_read_b64_tr_b16 a[92:93], v4 offset:40960
v_mfma_f32_16x16x32_bf16 v[204:207], a[100:103], a[20:23], v[204:207]
buffer_load_dwordx4 v15, s[56:59], s64 offen lds
v_mfma_f32_16x16x32_bf16 v[204:207], a[96:99], a[16:19], v[204:207]
ds_read_b64_tr_b16 a[94:95], v4 offset:41984
v_mfma_f32_16x16x32_bf16 v[196:199], a[96:99], a[8:11], v[196:199]
v_mfma_f32_16x16x32_bf16 v[196:199], a[100:103], a[12:15], v[196:199]
v_mfma_f32_16x16x32_bf16 v[188:191], a[100:103], a[4:7], v[188:191]
v_mfma_f32_16x16x32_bf16 v[188:191], a[96:99], a[0:3], v[188:191]
ds_read_b64_tr_b16 a[96:97], v5 offset:32768
v_mfma_f32_16x16x32_bf16 v[216:219], a[0:3], a[104:107], v[216:219]
ds_read_b64_tr_b16 a[98:99], v5 offset:33792
v_mfma_f32_16x16x32_bf16 v[216:219], a[4:7], a[108:111], v[216:219]
s_add_u32 m0, s78, 122880
ds_read_b64_tr_b16 a[100:101], v5 offset:40960
v_mfma_f32_16x16x32_bf16 v[224:227], a[12:15], a[108:111], v[224:227]
s_add_u32 s64, s75, 5509120
ds_read_b64_tr_b16 a[102:103], v5 offset:41984
v_mfma_f32_16x16x32_bf16 v[224:227], a[8:11], a[104:107], v[224:227]
buffer_load_dwordx4 v23, s[60:63], s64 offen lds
v_mfma_f32_16x16x32_bf16 v[232:235], a[16:19], a[104:107], v[232:235]
v_mfma_f32_16x16x32_bf16 v[232:235], a[20:23], a[108:111], v[232:235]
v_mfma_f32_16x16x32_bf16 v[240:243], a[28:31], a[108:111], v[240:243]
v_mfma_f32_16x16x32_bf16 v[240:243], a[24:27], a[104:107], v[240:243]
ds_read_b64_tr_b16 a[104:105], v6 offset:32768
v_mfma_f32_16x16x32_bf16 v[244:247], a[24:27], a[112:115], v[244:247]
ds_read_b64_tr_b16 a[106:107], v6 offset:33792
v_mfma_f32_16x16x32_bf16 v[244:247], a[28:31], a[116:119], v[244:247]
ds_read_b64_tr_b16 a[108:109], v6 offset:40960
v_subrev_u32 v19, 0x8000, v19
v_mfma_f32_16x16x32_bf16 v[236:239], a[20:23], a[116:119], v[236:239]
s_xor_b32 m0, s77, 101376
ds_read_b64_tr_b16 a[110:111], v6 offset:41984
v_mfma_f32_16x16x32_bf16 v[236:239], a[16:19], a[112:115], v[236:239]
s_xor_b32 s64, s71, 7438336
v_mfma_f32_16x16x32_bf16 v[228:231], a[8:11], a[112:115], v[228:231]
buffer_load_dwordx4 v15, s[56:59], s64 offen lds
v_mfma_f32_16x16x32_bf16 v[228:231], a[12:15], a[116:119], v[228:231]
v_mfma_f32_16x16x32_bf16 v[220:223], a[4:7], a[116:119], v[220:223]
v_mfma_f32_16x16x32_bf16 v[220:223], a[0:3], a[112:115], v[220:223]
s_waitcnt lgkmcnt(4)
ds_read_b64_tr_b16 a[112:113], v7 offset:32768
v_mfma_f32_16x16x32_bf16 v[152:155], a[72:75], a[0:3], v[152:155]
ds_read_b64_tr_b16 a[114:115], v7 offset:33792
v_mfma_f32_16x16x32_bf16 v[152:155], a[76:79], a[4:7], v[152:155]
ds_read_b64_tr_b16 a[116:117], v7 offset:40960
v_subrev_u32 v20, 0x8000, v20
v_mfma_f32_16x16x32_bf16 v[160:163], a[76:79], a[12:15], v[160:163]
ds_read_b64_tr_b16 a[118:119], v7 offset:41984
v_mfma_f32_16x16x32_bf16 v[160:163], a[72:75], a[8:11], v[160:163]
v_mfma_f32_16x16x32_bf16 v[168:171], a[72:75], a[16:19], v[168:171]
v_mfma_f32_16x16x32_bf16 v[168:171], a[76:79], a[20:23], v[168:171]
v_mfma_f32_16x16x32_bf16 v[176:179], a[76:79], a[28:31], v[176:179]
s_xor_b32 m0, s84, 0
v_mfma_f32_16x16x32_bf16 v[176:179], a[72:75], a[24:27], v[176:179]
s_xor_b32 s64, s72, 1792
ds_read_b64_tr_b16 a[72:73], v8 offset:32768
v_mfma_f32_16x16x32_bf16 v[180:183], a[80:83], a[24:27], v[180:183]
buffer_load_dwordx4 v12, s[48:51], s64 offen lds
v_mfma_f32_16x16x32_bf16 v[180:183], a[84:87], a[28:31], v[180:183]
ds_read_b64_tr_b16 a[74:75], v8 offset:33792
v_subrev_u32 v4, 0x8000, v4
v_mfma_f32_16x16x32_bf16 v[172:175], a[84:87], a[20:23], v[172:175]
ds_read_b64_tr_b16 a[76:77], v8 offset:40960
v_mfma_f32_16x16x32_bf16 v[172:175], a[80:83], a[16:19], v[172:175]
s_xor_b32 m0, s84, 1024
ds_read_b64_tr_b16 a[78:79], v8 offset:41984
v_mfma_f32_16x16x32_bf16 v[164:167], a[80:83], a[8:11], v[164:167]
s_xor_b32 s64, s72, 18176
v_mfma_f32_16x16x32_bf16 v[164:167], a[84:87], a[12:15], v[164:167]
buffer_load_dwordx4 v13, s[48:51], s64 offen lds
v_mfma_f32_16x16x32_bf16 v[156:159], a[84:87], a[4:7], v[156:159]
v_mfma_f32_16x16x32_bf16 v[156:159], a[80:83], a[0:3], v[156:159]
ds_read_b64_tr_b16 a[80:81], v9 offset:32768
v_mfma_f32_16x16x32_bf16 v[24:27], a[88:91], a[0:3], v[24:27]
s_xor_b32 m0, s84, 2048
ds_read_b64_tr_b16 a[82:83], v9 offset:33792
v_mfma_f32_16x16x32_bf16 v[24:27], a[92:95], a[4:7], v[24:27]
s_xor_b32 s64, s72, 132864
ds_read_b64_tr_b16 a[84:85], v9 offset:40960
v_subrev_u32 v5, 0x8000, v5
v_mfma_f32_16x16x32_bf16 v[40:43], a[92:95], a[12:15], v[40:43]
buffer_load_dwordx4 v12, s[48:51], s64 offen lds
v_mfma_f32_16x16x32_bf16 v[40:43], a[88:91], a[8:11], v[40:43]
ds_read_b64_tr_b16 a[86:87], v9 offset:41984
v_mfma_f32_16x16x32_bf16 v[56:59], a[88:91], a[16:19], v[56:59]
v_mfma_f32_16x16x32_bf16 v[56:59], a[92:95], a[20:23], v[56:59]
s_xor_b32 m0, s84, 3072
v_mfma_f32_16x16x32_bf16 v[72:75], a[92:95], a[28:31], v[72:75]
s_waitcnt vmcnt(11)
s_xor_b32 s64, s72, 149248
ds_read_b128 a[32:35], v2 offset:32768
v_mfma_f32_16x16x32_bf16 v[72:75], a[88:91], a[24:27], v[72:75]
buffer_load_dwordx4 v13, s[48:51], s64 offen lds
v_mfma_f32_16x16x32_bf16 v[136:139], a[96:99], a[24:27], v[136:139]
ds_read_b128 a[36:39], v3 offset:32768
v_mfma_f32_16x16x32_bf16 v[136:139], a[100:103], a[28:31], v[136:139]
ds_read_b128 a[40:43], v2 offset:34816
v_subrev_u32 v6, 0x8000, v6
v_mfma_f32_16x16x32_bf16 v[120:123], a[100:103], a[20:23], v[120:123]
s_branch L_po12
L_pg12:
s_branch L_tr0
L_po12:
s_xor_b32 m0, s84, 4096
ds_read_b128 a[44:47], v3 offset:34816
v_mfma_f32_16x16x32_bf16 v[120:123], a[96:99], a[16:19], v[120:123]
s_xor_b32 s64, s73, 1792
ds_read_b128 a[48:51], v2 offset:36864
v_mfma_f32_16x16x32_bf16 v[104:107], a[96:99], a[8:11], v[104:107]
buffer_load_dwordx4 v12, s[48:51], s64 offen lds
v_mfma_f32_16x16x32_bf16 v[104:107], a[100:103], a[12:15], v[104:107]
ds_read_b128 a[52:55], v3 offset:36864
v_mfma_f32_16x16x32_bf16 v[88:91], a[100:103], a[4:7], v[88:91]
ds_read_b128 a[56:59], v2 offset:38912
v_mfma_f32_16x16x32_bf16 v[88:91], a[96:99], a[0:3], v[88:91]
s_waitcnt lgkmcnt(7)
s_xor_b32 m0, s84, 5120
ds_read_b128 a[60:63], v3 offset:38912
v_mfma_f32_16x16x32_bf16 v[28:31], a[104:107], a[0:3], v[28:31]
s_xor_b32 s64, s73, 18176
ds_read_b64_tr_b16 a[88:89], v10 offset:32768
v_mfma_f32_16x16x32_bf16 v[28:31], a[108:111], a[4:7], v[28:31]
buffer_load_dwordx4 v13, s[48:51], s64 offen lds
v_mfma_f32_16x16x32_bf16 v[44:47], a[108:111], a[12:15], v[44:47]
ds_read_b64_tr_b16 a[90:91], v10 offset:33792
v_subrev_u32 v7, 0x8000, v7
v_mfma_f32_16x16x32_bf16 v[44:47], a[104:107], a[8:11], v[44:47]
ds_read_b64_tr_b16 a[92:93], v10 offset:40960
v_mfma_f32_16x16x32_bf16 v[60:63], a[104:107], a[16:19], v[60:63]
s_xor_b32 m0, s84, 6144
ds_read_b64_tr_b16 a[94:95], v10 offset:41984
v_mfma_f32_16x16x32_bf16 v[60:63], a[108:111], a[20:23], v[60:63]
s_xor_b32 s64, s73, 132864
ds_read_b64_tr_b16 a[96:97], v11 offset:32768
v_mfma_f32_16x16x32_bf16 v[76:79], a[108:111], a[28:31], v[76:79]
buffer_load_dwordx4 v12, s[48:51], s64 offen lds
v_mfma_f32_16x16x32_bf16 v[76:79], a[104:107], a[24:27], v[76:79]
ds_read_b64_tr_b16 a[98:99], v11 offset:33792
v_mfma_f32_16x16x32_bf16 v[140:143], a[112:115], a[24:27], v[140:143]
ds_read_b64_tr_b16 a[100:101], v11 offset:40960
v_mfma_f32_16x16x32_bf16 v[140:143], a[116:119], a[28:31], v[140:143]
s_xor_b32 m0, s84, 7168
ds_read_b64_tr_b16 a[102:103], v11 offset:41984
v_subrev_u32 v8, 0x8000, v8
v_mfma_f32_16x16x32_bf16 v[124:127], a[116:119], a[20:23], v[124:127]
s_xor_b32 s64, s73, 149248
v_mfma_f32_16x16x32_bf16 v[124:127], a[112:115], a[16:19], v[124:127]
buffer_load_dwordx4 v13, s[48:51], s64 offen lds
v_mfma_f32_16x16x32_bf16 v[108:111], a[112:115], a[8:11], v[108:111]
v_mfma_f32_16x16x32_bf16 v[108:111], a[116:119], a[12:15], v[108:111]
v_mfma_f32_16x16x32_bf16 v[92:95], a[116:119], a[4:7], v[92:95]
v_subrev_u32 v9, 0x8000, v9
v_subrev_u32 v10, 0x8000, v10
v_mfma_f32_16x16x32_bf16 v[92:95], a[112:115], a[0:3], v[92:95]
v_subrev_u32 v11, 0x8000, v11
v_mfma_f32_16x16x32_bf16 v[32:35], a[72:75], a[0:3], v[32:35]
v_mfma_f32_16x16x32_bf16 v[32:35], a[76:79], a[4:7], v[32:35]
v_mfma_f32_16x16x32_bf16 v[48:51], a[76:79], a[12:15], v[48:51]
s_cmp_eq_u32 s30, 0
s_cbranch_scc1 L_pg13
s_cmp_eq_u32 s30, 1
s_cbranch_scc1 L_pg14
s_cmp_eq_u32 s30, 2
s_cbranch_scc1 L_pg15
s_branch L_pg16
L_tr1:
s_waitcnt lgkmcnt(0)
s_barrier
v_mfma_f32_16x16x32_bf16 v[48:51], a[72:75], a[8:11], v[48:51]
s_mov_b64 exec, 1
buffer_atomic_add a251, v1, s[52:55], s70 offen offset:0 sc1
s_mov_b64 exec, -1
s_xor_b32 m0, s77, 131072
v_mfma_f32_16x16x32_bf16 v[64:67], a[72:75], a[16:19], v[64:67]
s_lshl4_add_u32 s70, s78, s70
s_xor_b32 s64, s71, 7864320
ds_read_b64_tr_b16 a[104:105], v19 offset:4096
v_mfma_f32_16x16x32_bf16 v[64:67], a[76:79], a[20:23], v[64:67]
s_lshr_b32 s81, s81, 5
buffer_load_dwordx4 v14, s[56:59], s64 offen lds
v_mfma_f32_16x16x32_bf16 v[80:83], a[76:79], a[28:31], v[80:83]
ds_read_b64_tr_b16 a[106:107], v19 offset:4352
v_mfma_f32_16x16x32_bf16 v[80:83], a[72:75], a[24:27], v[80:83]
ds_read_b64_tr_b16 a[108:109], v19 offset:6144
v_mfma_f32_16x16x32_bf16 v[144:147], a[80:83], a[24:27], v[144:147]
ds_read_b64_tr_b16 a[110:111], v19 offset:6400
v_mfma_f32_16x16x32_bf16 v[144:147], a[84:87], a[28:31], v[144:147]
ds_read_b64_tr_b16 a[112:113], v20 offset:4096
v_mfma_f32_16x16x32_bf16 v[128:131], a[84:87], a[20:23], v[128:131]
ds_read_b64_tr_b16 a[114:115], v20 offset:4352
v_mfma_f32_16x16x32_bf16 v[128:131], a[80:83], a[16:19], v[128:131]
ds_read_b64_tr_b16 a[116:117], v20 offset:6144
v_mfma_f32_16x16x32_bf16 v[112:115], a[80:83], a[8:11], v[112:115]
s_add_u32 m0, s78, 147456
ds_read_b64_tr_b16 a[118:119], v20 offset:6400
v_mfma_f32_16x16x32_bf16 v[112:115], a[84:87], a[12:15], v[112:115]
s_add_u32 s64, s75, 5898240
ds_read_b64_tr_b16 a[72:73], v19 offset:8192
v_mfma_f32_16x16x32_bf16 v[96:99], a[84:87], a[4:7], v[96:99]
buffer_load_dwordx4 v23, s[60:63], s64 offen lds
v_mfma_f32_16x16x32_bf16 v[96:99], a[80:83], a[0:3], v[96:99]
ds_read_b64_tr_b16 a[74:75], v19 offset:8448
v_mfma_f32_16x16x32_bf16 v[36:39], a[88:91], a[0:3], v[36:39]
ds_read_b64_tr_b16 a[76:77], v19 offset:10240
v_mfma_f32_16x16x32_bf16 v[36:39], a[92:95], a[4:7], v[36:39]
ds_read_b64_tr_b16 a[78:79], v19 offset:10496
v_mfma_f32_16x16x32_bf16 v[52:55], a[92:95], a[12:15], v[52:55]
ds_read_b64_tr_b16 a[80:81], v20 offset:8192
v_mfma_f32_16x16x32_bf16 v[52:55], a[88:91], a[8:11], v[52:55]
ds_read_b64_tr_b16 a[82:83], v20 offset:8448
v_mfma_f32_16x16x32_bf16 v[68:71], a[88:91], a[16:19], v[68:71]
ds_read_b64_tr_b16 a[84:85], v20 offset:10240
v_mfma_f32_16x16x32_bf16 v[68:71], a[92:95], a[20:23], v[68:71]
s_xor_b32 m0, s77, 132096
ds_read_b64_tr_b16 a[86:87], v20 offset:10496
v_mfma_f32_16x16x32_bf16 v[84:87], a[92:95], a[28:31], v[84:87]
s_xor_b32 s64, s71, 7897088
v_mfma_f32_16x16x32_bf16 v[84:87], a[88:91], a[24:27], v[84:87]
buffer_load_dwordx4 v14, s[56:59], s64 offen lds
v_mfma_f32_16x16x32_bf16 v[148:151], a[96:99], a[24:27], v[148:151]
ds_read_b64_tr_b16 a[88:89], v19 offset:0
v_mfma_f32_16x16x32_bf16 v[148:151], a[100:103], a[28:31], v[148:151]
ds_read_b64_tr_b16 a[90:91], v19 offset:256
v_mfma_f32_16x16x32_bf16 v[132:135], a[100:103], a[20:23], v[132:135]
ds_read_b64_tr_b16 a[92:93], v19 offset:2048
v_mfma_f32_16x16x32_bf16 v[132:135], a[96:99], a[16:19], v[132:135]
ds_read_b64_tr_b16 a[94:95], v19 offset:2304
v_mfma_f32_16x16x32_bf16 v[116:119], a[96:99], a[8:11], v[116:119]
v_mfma_f32_16x16x32_bf16 v[116:119], a[100:103], a[12:15], v[116:119]
v_mfma_f32_16x16x32_bf16 v[100:103], a[100:103], a[4:7], v[100:103]
s_add_u32 m0, s78, 151552
v_mfma_f32_16x16x32_bf16 v[100:103], a[96:99], a[0:3], v[100:103]
s_waitcnt lgkmcnt(4)
s_add_u32 s64, s75, 5900288
ds_read_b64_tr_b16 a[96:97], v20 offset:0
v_mfma_f32_16x16x32_bf16 v[184:187], a[104:107], a[32:35], v[184:187]
buffer_load_dwordx4 v23, s[60:63], s64 offen lds
v_mfma_f32_16x16x32_bf16 v[184:187], a[108:111], a[36:39], v[184:187]
ds_read_b64_tr_b16 a[98:99], v20 offset:256
v_and_b32 v22, 15, v0
v_mfma_f32_16x16x32_bf16 v[192:195], a[108:111], a[44:47], v[192:195]
ds_read_b64_tr_b16 a[100:101], v20 offset:2048
v_lshlrev_b32 v22, 3, v22
v_mfma_f32_16x16x32_bf16 v[192:195], a[104:107], a[40:43], v[192:195]
s_lshl_b32 s85, s30, 7
s_add_u32 s85, s85, 58720256
ds_read_b64_tr_b16 a[102:103], v20 offset:2304
v_mfma_f32_16x16x32_bf16 v[200:203], a[104:107], a[48:51], v[200:203]
s_lshl_b32 s86, s3, 10
s_add_u32 s86, s86, s85
s_lshl_b32 s87, s16, 10
s_lshl_b32 s68, s31, 20
s_add_u32 s32, s28, s68
s_addc_u32 s33, s29, 0
v_mfma_f32_16x16x32_bf16 v[200:203], a[108:111], a[52:55], v[200:203]
s_add_u32 s87, s87, s85
s_add_u32 s68, s16, 1
s_lshl_b32 s34, s68, 16
v_mfma_f32_16x16x32_bf16 v[208:211], a[108:111], a[60:63], v[208:211]
v_mfma_f32_16x16x32_bf16 v[208:211], a[104:107], a[56:59], v[208:211]
ds_read_b64_tr_b16 a[104:105], v4 offset:0
v_mfma_f32_16x16x32_bf16 v[212:215], a[112:115], a[56:59], v[212:215]
s_xor_b32 m0, s77, 133120
ds_read_b64_tr_b16 a[106:107], v4 offset:1024
v_mfma_f32_16x16x32_bf16 v[212:215], a[116:119], a[60:63], v[212:215]
s_xor_b32 s64, s71, 7929856
ds_read_b64_tr_b16 a[108:109], v4 offset:8192
v_mfma_f32_16x16x32_bf16 v[204:207], a[116:119], a[52:55], v[204:207]
buffer_load_dwordx4 v15, s[56:59], s64 offen lds
v_mfma_f32_16x16x32_bf16 v[204:207], a[112:115], a[48:51], v[204:207]
ds_read_b64_tr_b16 a[110:111], v4 offset:9216
v_mfma_f32_16x16x32_bf16 v[196:199], a[112:115], a[40:43], v[196:199]
v_mfma_f32_16x16x32_bf16 v[196:199], a[116:119], a[44:47], v[196:199]
v_mfma_f32_16x16x32_bf16 v[188:191], a[116:119], a[36:39], v[188:191]
v_mfma_f32_16x16x32_bf16 v[188:191], a[112:115], a[32:35], v[188:191]
ds_read_b64_tr_b16 a[112:113], v5 offset:0
v_mfma_f32_16x16x32_bf16 v[216:219], a[32:35], a[72:75], v[216:219]
ds_read_b64_tr_b16 a[114:115], v5 offset:1024
v_mfma_f32_16x16x32_bf16 v[216:219], a[36:39], a[76:79], v[216:219]
s_add_u32 m0, s78, 155648
ds_read_b64_tr_b16 a[116:117], v5 offset:8192
v_mfma_f32_16x16x32_bf16 v[224:227], a[44:47], a[76:79], v[224:227]
s_add_u32 s64, s75, 5902336
ds_read_b64_tr_b16 a[118:119], v5 offset:9216
v_mfma_f32_16x16x32_bf16 v[224:227], a[40:43], a[72:75], v[224:227]
buffer_load_dwordx4 v23, s[60:63], s64 offen lds
v_mfma_f32_16x16x32_bf16 v[232:235], a[48:51], a[72:75], v[232:235]
v_mfma_f32_16x16x32_bf16 v[232:235], a[52:55], a[76:79], v[232:235]
v_mfma_f32_16x16x32_bf16 v[240:243], a[60:63], a[76:79], v[240:243]
v_mfma_f32_16x16x32_bf16 v[240:243], a[56:59], a[72:75], v[240:243]
ds_read_b64_tr_b16 a[72:73], v6 offset:0
v_mfma_f32_16x16x32_bf16 v[244:247], a[56:59], a[80:83], v[244:247]
ds_read_b64_tr_b16 a[74:75], v6 offset:1024
v_mfma_f32_16x16x32_bf16 v[244:247], a[60:63], a[84:87], v[244:247]
ds_read_b64_tr_b16 a[76:77], v6 offset:8192
v_mfma_f32_16x16x32_bf16 v[236:239], a[52:55], a[84:87], v[236:239]
s_xor_b32 m0, s77, 134144
ds_read_b64_tr_b16 a[78:79], v6 offset:9216
v_mfma_f32_16x16x32_bf16 v[236:239], a[48:51], a[80:83], v[236:239]
s_xor_b32 s64, s71, 7962624
v_mfma_f32_16x16x32_bf16 v[228:231], a[40:43], a[80:83], v[228:231]
buffer_load_dwordx4 v15, s[56:59], s64 offen lds
v_mfma_f32_16x16x32_bf16 v[228:231], a[44:47], a[84:87], v[228:231]
v_mfma_f32_16x16x32_bf16 v[220:223], a[36:39], a[84:87], v[220:223]
v_mfma_f32_16x16x32_bf16 v[220:223], a[32:35], a[80:83], v[220:223]
s_waitcnt lgkmcnt(4)
ds_read_b64_tr_b16 a[80:81], v7 offset:0
v_mfma_f32_16x16x32_bf16 v[152:155], a[88:91], a[32:35], v[152:155]
ds_read_b64_tr_b16 a[82:83], v7 offset:1024
v_mfma_f32_16x16x32_bf16 v[152:155], a[92:95], a[36:39], v[152:155]
ds_read_b64_tr_b16 a[84:85], v7 offset:8192
v_mfma_f32_16x16x32_bf16 v[160:163], a[92:95], a[44:47], v[160:163]
ds_read_b64_tr_b16 a[86:87], v7 offset:9216
v_mfma_f32_16x16x32_bf16 v[160:163], a[88:91], a[40:43], v[160:163]
v_mfma_f32_16x16x32_bf16 v[168:171], a[88:91], a[48:51], v[168:171]
v_mfma_f32_16x16x32_bf16 v[168:171], a[92:95], a[52:55], v[168:171]
v_mfma_f32_16x16x32_bf16 v[176:179], a[92:95], a[60:63], v[176:179]
s_xor_b32 m0, s84, 32768
v_mfma_f32_16x16x32_bf16 v[176:179], a[88:91], a[56:59], v[176:179]
s_xor_b32 s64, s72, 1920
ds_read_b64_tr_b16 a[88:89], v8 offset:0
v_mfma_f32_16x16x32_bf16 v[180:183], a[96:99], a[56:59], v[180:183]
buffer_load_dwordx4 v12, s[48:51], s64 offen lds
v_mfma_f32_16x16x32_bf16 v[180:183], a[100:103], a[60:63], v[180:183]
ds_read_b64_tr_b16 a[90:91], v8 offset:1024
v_mfma_f32_16x16x32_bf16 v[172:175], a[100:103], a[52:55], v[172:175]
ds_read_b64_tr_b16 a[92:93], v8 offset:8192
v_mfma_f32_16x16x32_bf16 v[172:175], a[96:99], a[48:51], v[172:175]
s_xor_b32 m0, s84, 33792
ds_read_b64_tr_b16 a[94:95], v8 offset:9216
v_mfma_f32_16x16x32_bf16 v[164:167], a[96:99], a[40:43], v[164:167]
s_xor_b32 s64, s72, 18304
v_mfma_f32_16x16x32_bf16 v[164:167], a[100:103], a[44:47], v[164:167]
buffer_load_dwordx4 v13, s[48:51], s64 offen lds
v_mfma_f32_16x16x32_bf16 v[156:159], a[100:103], a[36:39], v[156:159]
v_mfma_f32_16x16x32_bf16 v[156:159], a[96:99], a[32:35], v[156:159]
ds_read_b64_tr_b16 a[96:97], v9 offset:0
v_mfma_f32_16x16x32_bf16 v[24:27], a[104:107], a[32:35], v[24:27]
s_xor_b32 m0, s84, 34816
ds_read_b64_tr_b16 a[98:99], v9 offset:1024
v_mfma_f32_16x16x32_bf16 v[24:27], a[108:111], a[36:39], v[24:27]
s_xor_b32 s64, s72, 132992
ds_read_b64_tr_b16 a[100:101], v9 offset:8192
v_mfma_f32_16x16x32_bf16 v[40:43], a[108:111], a[44:47], v[40:43]
buffer_load_dwordx4 v12, s[48:51], s64 offen lds
v_mfma_f32_16x16x32_bf16 v[40:43], a[104:107], a[40:43], v[40:43]
ds_read_b64_tr_b16 a[102:103], v9 offset:9216
v_mfma_f32_16x16x32_bf16 v[56:59], a[104:107], a[48:51], v[56:59]
v_mfma_f32_16x16x32_bf16 v[56:59], a[108:111], a[52:55], v[56:59]
s_xor_b32 m0, s84, 35840
v_mfma_f32_16x16x32_bf16 v[72:75], a[108:111], a[60:63], v[72:75]
s_waitcnt vmcnt(11)
s_xor_b32 s64, s72, 149376
ds_read_b128 a[0:3], v2 offset:0
v_mfma_f32_16x16x32_bf16 v[72:75], a[104:107], a[56:59], v[72:75]
buffer_load_dwordx4 v13, s[48:51], s64 offen lds
v_mfma_f32_16x16x32_bf16 v[136:139], a[112:115], a[56:59], v[136:139]
ds_read_b128 a[4:7], v3 offset:0
v_mfma_f32_16x16x32_bf16 v[136:139], a[116:119], a[60:63], v[136:139]
ds_read_b128 a[8:11], v2 offset:2048
v_mfma_f32_16x16x32_bf16 v[120:123], a[116:119], a[52:55], v[120:123]
s_xor_b32 m0, s84, 36864
ds_read_b128 a[12:15], v3 offset:2048
v_mfma_f32_16x16x32_bf16 v[120:123], a[112:115], a[48:51], v[120:123]
s_xor_b32 s64, s73, 1920
ds_read_b128 a[16:19], v2 offset:4096
v_mfma_f32_16x16x32_bf16 v[104:107], a[112:115], a[40:43], v[104:107]
buffer_load_dwordx4 v12, s[48:51], s64 offen lds
v_mfma_f32_16x16x32_bf16 v[104:107], a[116:119], a[44:47], v[104:107]
ds_read_b128 a[20:23], v3 offset:4096
v_mfma_f32_16x16x32_bf16 v[88:91], a[116:119], a[36:39], v[88:91]
ds_read_b128 a[24:27], v2 offset:6144
v_mfma_f32_16x16x32_bf16 v[88:91], a[112:115], a[32:35], v[88:91]
s_waitcnt lgkmcnt(7)
s_xor_b32 m0, s84, 37888
ds_read_b128 a[28:31], v3 offset:6144
v_mfma_f32_16x16x32_bf16 v[28:31], a[72:75], a[32:35], v[28:31]
s_xor_b32 s64, s73, 18304
ds_read_b64_tr_b16 a[104:105], v10 offset:0
v_mfma_f32_16x16x32_bf16 v[28:31], a[76:79], a[36:39], v[28:31]
buffer_load_dwordx4 v13, s[48:51], s64 offen lds
v_mfma_f32_16x16x32_bf16 v[44:47], a[76:79], a[44:47], v[44:47]
ds_read_b64_tr_b16 a[106:107], v10 offset:1024
v_mfma_f32_16x16x32_bf16 v[44:47], a[72:75], a[40:43], v[44:47]
ds_read_b64_tr_b16 a[108:109], v10 offset:8192
v_mfma_f32_16x16x32_bf16 v[60:63], a[72:75], a[48:51], v[60:63]
s_xor_b32 m0, s84, 38912
buffer_load_dword v1, off, s[52:55], s70 sc1
v_mfma_f32_16x16x32_bf16 v[60:63], a[76:79], a[52:55], v[60:63]
s_xor_b32 s64, s73, 132992
ds_read_b64_tr_b16 a[110:111], v10 offset:9216
v_mfma_f32_16x16x32_bf16 v[76:79], a[76:79], a[60:63], v[76:79]
buffer_load_dwordx4 v12, s[48:51], s64 offen lds
v_mfma_f32_16x16x32_bf16 v[76:79], a[72:75], a[56:59], v[76:79]
ds_read_b64_tr_b16 a[112:113], v11 offset:0
v_mfma_f32_16x16x32_bf16 v[140:143], a[80:83], a[56:59], v[140:143]
ds_read_b64_tr_b16 a[114:115], v11 offset:1024
v_mfma_f32_16x16x32_bf16 v[140:143], a[84:87], a[60:63], v[140:143]
s_xor_b32 m0, s84, 39936
ds_read_b64_tr_b16 a[116:117], v11 offset:8192
v_mfma_f32_16x16x32_bf16 v[124:127], a[84:87], a[52:55], v[124:127]
s_xor_b32 s64, s73, 149376
ds_read_b64_tr_b16 a[118:119], v11 offset:9216
v_mfma_f32_16x16x32_bf16 v[124:127], a[80:83], a[48:51], v[124:127]
buffer_load_dwordx4 v13, s[48:51], s64 offen lds
v_mfma_f32_16x16x32_bf16 v[108:111], a[80:83], a[40:43], v[108:111]
v_mfma_f32_16x16x32_bf16 v[108:111], a[84:87], a[44:47], v[108:111]
v_mfma_f32_16x16x32_bf16 v[92:95], a[84:87], a[36:39], v[92:95]
buffer_load_dwordx2 a[64:65], v22, s[44:47], s86 offen offset:0 sc1
v_mfma_f32_16x16x32_bf16 v[92:95], a[80:83], a[32:35], v[92:95]
buffer_load_dwordx2 a[66:67], v22, s[44:47], s86 offen offset:512 sc1
v_mfma_f32_16x16x32_bf16 v[32:35], a[88:91], a[32:35], v[32:35]
buffer_load_dwordx2 a[68:69], v22, s[44:47], s87 offen offset:0 sc1
v_mfma_f32_16x16x32_bf16 v[32:35], a[92:95], a[36:39], v[32:35]
buffer_load_dwordx2 a[70:71], v22, s[44:47], s87 offen offset:512 sc1
v_mfma_f32_16x16x32_bf16 v[48:51], a[92:95], a[44:47], v[48:51]
s_waitcnt lgkmcnt(0)
s_barrier
v_mfma_f32_16x16x32_bf16 v[48:51], a[88:91], a[40:43], v[48:51]
ds_read_b64_tr_b16 a[72:73], v19 offset:36864
v_mfma_f32_16x16x32_bf16 v[64:67], a[88:91], a[48:51], v[64:67]
s_lshl2_add_u32 s72, s2, s30
ds_read_b64_tr_b16 a[74:75], v19 offset:37120
v_mfma_f32_16x16x32_bf16 v[64:67], a[92:95], a[52:55], v[64:67]
s_lshl_b32 s72, s72, 12
ds_read_b64_tr_b16 a[76:77], v19 offset:38912
v_mfma_f32_16x16x32_bf16 v[80:83], a[92:95], a[60:63], v[80:83]
s_add_u32 s72, s72, 67108864
ds_read_b64_tr_b16 a[78:79], v19 offset:39168
v_mfma_f32_16x16x32_bf16 v[80:83], a[88:91], a[56:59], v[80:83]
ds_read_b64_tr_b16 a[80:81], v20 offset:36864
v_mfma_f32_16x16x32_bf16 v[144:147], a[96:99], a[56:59], v[144:147]
ds_read_b64_tr_b16 a[82:83], v20 offset:37120
v_mfma_f32_16x16x32_bf16 v[144:147], a[100:103], a[60:63], v[144:147]
ds_read_b64_tr_b16 a[84:85], v20 offset:38912
v_mfma_f32_16x16x32_bf16 v[128:131], a[100:103], a[52:55], v[128:131]
ds_read_b64_tr_b16 a[86:87], v20 offset:39168
v_mfma_f32_16x16x32_bf16 v[128:131], a[96:99], a[48:51], v[128:131]
ds_read_b64_tr_b16 a[88:89], v19 offset:40960
v_mfma_f32_16x16x32_bf16 v[112:115], a[96:99], a[40:43], v[112:115]
ds_read_b64_tr_b16 a[90:91], v19 offset:41216
v_mfma_f32_16x16x32_bf16 v[112:115], a[100:103], a[44:47], v[112:115]
ds_read_b64_tr_b16 a[92:93], v19 offset:43008
v_mfma_f32_16x16x32_bf16 v[96:99], a[100:103], a[36:39], v[96:99]
ds_read_b64_tr_b16 a[94:95], v19 offset:43264
v_mfma_f32_16x16x32_bf16 v[96:99], a[96:99], a[32:35], v[96:99]
ds_read_b64_tr_b16 a[96:97], v20 offset:40960
v_mfma_f32_16x16x32_bf16 v[36:39], a[104:107], a[32:35], v[36:39]
buffer_store_dwordx4 a[240:243], v16, s[44:47], s72 offen offset:0 sc1
v_mfma_f32_16x16x32_bf16 v[36:39], a[108:111], a[36:39], v[36:39]
ds_read_b64_tr_b16 a[98:99], v20 offset:41216
v_mfma_f32_16x16x32_bf16 v[52:55], a[108:111], a[44:47], v[52:55]
ds_read_b64_tr_b16 a[100:101], v20 offset:43008
v_mfma_f32_16x16x32_bf16 v[52:55], a[104:107], a[40:43], v[52:55]
ds_read_b64_tr_b16 a[102:103], v20 offset:43264
v_mfma_f32_16x16x32_bf16 v[68:71], a[104:107], a[48:51], v[68:71]
v_mfma_f32_16x16x32_bf16 v[68:71], a[108:111], a[52:55], v[68:71]
v_mfma_f32_16x16x32_bf16 v[84:87], a[108:111], a[60:63], v[84:87]
v_mfma_f32_16x16x32_bf16 v[84:87], a[104:107], a[56:59], v[84:87]
ds_read_b64_tr_b16 a[104:105], v19 offset:32768
v_mfma_f32_16x16x32_bf16 v[148:151], a[112:115], a[56:59], v[148:151]
ds_read_b64_tr_b16 a[106:107], v19 offset:33024
v_mfma_f32_16x16x32_bf16 v[148:151], a[116:119], a[60:63], v[148:151]
ds_read_b64_tr_b16 a[108:109], v19 offset:34816
v_mfma_f32_16x16x32_bf16 v[132:135], a[116:119], a[52:55], v[132:135]
ds_read_b64_tr_b16 a[110:111], v19 offset:35072
v_mfma_f32_16x16x32_bf16 v[132:135], a[112:115], a[48:51], v[132:135]
v_mfma_f32_16x16x32_bf16 v[116:119], a[112:115], a[40:43], v[116:119]
v_mfma_f32_16x16x32_bf16 v[116:119], a[116:119], a[44:47], v[116:119]
v_mfma_f32_16x16x32_bf16 v[100:103], a[116:119], a[36:39], v[100:103]
buffer_store_dwordx4 a[240:243], v16, s[44:47], s72 offen offset:1024 sc1
v_mfma_f32_16x16x32_bf16 v[100:103], a[112:115], a[32:35], v[100:103]
s_waitcnt lgkmcnt(4)
ds_read_b64_tr_b16 a[112:113], v20 offset:32768
v_mfma_f32_16x16x32_bf16 v[184:187], a[72:75], a[0:3], v[184:187]
ds_read_b64_tr_b16 a[114:115], v20 offset:33024
v_and_b32 v12, 15, v0
v_mfma_f32_16x16x32_bf16 v[184:187], a[76:79], a[4:7], v[184:187]
ds_read_b64_tr_b16 a[116:117], v20 offset:34816
v_lshrrev_b32 v13, 4, v0
v_mfma_f32_16x16x32_bf16 v[192:195], a[76:79], a[12:15], v[192:195]
ds_read_b64_tr_b16 a[118:119], v20 offset:35072
v_lshlrev_b32 v13, 2, v13
v_mfma_f32_16x16x32_bf16 v[192:195], a[72:75], a[8:11], v[192:195]
v_sub_u32 v12, v12, v13
v_mfma_f32_16x16x32_bf16 v[200:203], a[72:75], a[16:19], v[200:203]
s_lshl_b32 s66, s30, 4
v_mfma_f32_16x16x32_bf16 v[200:203], a[76:79], a[20:23], v[200:203]
v_add_u32 v13, s66, v12
v_cmp_gt_i32 s[0:1], 0, v13
v_mfma_f32_16x16x32_bf16 v[208:211], a[76:79], a[28:31], v[208:211]
v_cmp_gt_i32 s[4:5], 1, v13
v_cmp_gt_i32 s[6:7], 2, v13
v_mfma_f32_16x16x32_bf16 v[208:211], a[72:75], a[24:27], v[208:211]
ds_read_b64_tr_b16 a[72:73], v4 offset:32768
v_cmp_gt_i32 s[8:9], 3, v13
v_mfma_f32_16x16x32_bf16 v[212:215], a[80:83], a[24:27], v[212:215]
ds_read_b64_tr_b16 a[74:75], v4 offset:33792
v_cmp_gt_i32 s[10:11], 16, v13
v_mfma_f32_16x16x32_bf16 v[212:215], a[84:87], a[28:31], v[212:215]
ds_read_b64_tr_b16 a[76:77], v4 offset:40960
v_cmp_gt_i32 s[12:13], 17, v13
v_mfma_f32_16x16x32_bf16 v[204:207], a[84:87], a[20:23], v[204:207]
ds_read_b64_tr_b16 a[78:79], v4 offset:41984
v_cmp_gt_i32 s[18:19], 18, v13
v_mfma_f32_16x16x32_bf16 v[204:207], a[80:83], a[16:19], v[204:207]
v_cmp_gt_i32 s[22:23], 19, v13
v_cmp_gt_i32 s[26:27], 32, v13
v_mfma_f32_16x16x32_bf16 v[196:199], a[80:83], a[8:11], v[196:199]
buffer_store_dwordx4 a[240:243], v16, s[44:47], s72 offen offset:2048 sc1
v_mfma_f32_16x16x32_bf16 v[196:199], a[84:87], a[12:15], v[196:199]
v_cmp_gt_i32 s[56:57], 33, v13
v_cmp_gt_i32 s[58:59], 34, v13
v_mfma_f32_16x16x32_bf16 v[188:191], a[84:87], a[4:7], v[188:191]
v_cmp_gt_i32 s[60:61], 35, v13
v_cmp_gt_i32 s[62:63], 48, v13
v_mfma_f32_16x16x32_bf16 v[188:191], a[80:83], a[0:3], v[188:191]
ds_read_b64_tr_b16 a[80:81], v5 offset:32768
v_cmp_gt_i32 s[48:49], 49, v13
v_mfma_f32_16x16x32_bf16 v[216:219], a[0:3], a[88:91], v[216:219]
ds_read_b64_tr_b16 a[82:83], v5 offset:33792
v_cmp_gt_i32 s[50:51], 50, v13
v_mfma_f32_16x16x32_bf16 v[216:219], a[4:7], a[92:95], v[216:219]
ds_read_b64_tr_b16 a[84:85], v5 offset:40960
v_cmp_gt_i32 s[100:101], 51, v13
v_mfma_f32_16x16x32_bf16 v[224:227], a[12:15], a[92:95], v[224:227]
ds_read_b64_tr_b16 a[86:87], v5 offset:41984
v_subrev_u32 v17, 0, v12
v_mfma_f32_16x16x32_bf16 v[224:227], a[8:11], a[88:91], v[224:227]
v_lshlrev_b32 v18, 31, v17
v_or_b32 v21, v17, v18
v_mfma_f32_16x16x32_bf16 v[232:235], a[16:19], a[88:91], v[232:235]
v_ashrrev_i32 v21, 31, v21
v_and_b32 v248, 0xff800000, v21
v_mfma_f32_16x16x32_bf16 v[232:235], a[20:23], a[92:95], v[232:235]
v_not_b32 v17, v17
v_or_b32 v21, v17, v18
v_mfma_f32_16x16x32_bf16 v[240:243], a[28:31], a[92:95], v[240:243]
v_ashrrev_i32 v21, 31, v21
v_and_b32 v252, 0xff800000, v21
v_mfma_f32_16x16x32_bf16 v[240:243], a[24:27], a[88:91], v[240:243]
ds_read_b64_tr_b16 a[88:89], v6 offset:32768
v_subrev_u32 v17, 1, v12
v_mfma_f32_16x16x32_bf16 v[244:247], a[24:27], a[96:99], v[244:247]
ds_read_b64_tr_b16 a[90:91], v6 offset:33792
v_lshlrev_b32 v18, 31, v17
v_mfma_f32_16x16x32_bf16 v[244:247], a[28:31], a[100:103], v[244:247]
ds_read_b64_tr_b16 a[92:93], v6 offset:40960
v_add_u32 v19, 0x8000, v19
v_mfma_f32_16x16x32_bf16 v[236:239], a[20:23], a[100:103], v[236:239]
buffer_store_dwordx4 a[240:243], v16, s[44:47], s72 offen offset:3072 sc1
v_mfma_f32_16x16x32_bf16 v[236:239], a[16:19], a[96:99], v[236:239]
ds_read_b64_tr_b16 a[94:95], v6 offset:41984
v_or_b32 v21, v17, v18
v_mfma_f32_16x16x32_bf16 v[228:231], a[8:11], a[96:99], v[228:231]
v_ashrrev_i32 v21, 31, v21
v_and_b32 v249, 0xff800000, v21
v_mfma_f32_16x16x32_bf16 v[228:231], a[12:15], a[100:103], v[228:231]
v_not_b32 v17, v17
v_or_b32 v21, v17, v18
v_mfma_f32_16x16x32_bf16 v[220:223], a[4:7], a[100:103], v[220:223]
v_ashrrev_i32 v21, 31, v21
v_and_b32 v253, 0xff800000, v21
v_mfma_f32_16x16x32_bf16 v[220:223], a[0:3], a[96:99], v[220:223]
s_waitcnt lgkmcnt(4)
ds_read_b64_tr_b16 a[96:97], v7 offset:32768
v_subrev_u32 v17, 2, v12
v_mfma_f32_16x16x32_bf16 v[152:155], a[104:107], a[0:3], v[152:155]
ds_read_b64_tr_b16 a[98:99], v7 offset:33792
v_lshlrev_b32 v18, 31, v17
v_mfma_f32_16x16x32_bf16 v[152:155], a[108:111], a[4:7], v[152:155]
ds_read_b64_tr_b16 a[100:101], v7 offset:40960
v_add_u32 v20, 0x8000, v20
v_mfma_f32_16x16x32_bf16 v[160:163], a[108:111], a[12:15], v[160:163]
ds_read_b64_tr_b16 a[102:103], v7 offset:41984
v_or_b32 v21, v17, v18
v_mfma_f32_16x16x32_bf16 v[160:163], a[104:107], a[8:11], v[160:163]
v_ashrrev_i32 v21, 31, v21
v_and_b32 v250, 0xff800000, v21
v_mfma_f32_16x16x32_bf16 v[168:171], a[104:107], a[16:19], v[168:171]
v_not_b32 v17, v17
v_or_b32 v21, v17, v18
v_mfma_f32_16x16x32_bf16 v[168:171], a[108:111], a[20:23], v[168:171]
v_ashrrev_i32 v21, 31, v21
v_and_b32 v254, 0xff800000, v21
v_mfma_f32_16x16x32_bf16 v[176:179], a[108:111], a[28:31], v[176:179]
v_subrev_u32 v17, 3, v12
v_lshlrev_b32 v18, 31, v17
v_mfma_f32_16x16x32_bf16 v[176:179], a[104:107], a[24:27], v[176:179]
ds_read_b64_tr_b16 a[104:105], v8 offset:32768
v_or_b32 v21, v17, v18
v_mfma_f32_16x16x32_bf16 v[180:183], a[112:115], a[24:27], v[180:183]
ds_read_b64_tr_b16 a[106:107], v8 offset:33792
v_ashrrev_i32 v21, 31, v21
v_mfma_f32_16x16x32_bf16 v[180:183], a[116:119], a[28:31], v[180:183]
ds_read_b64_tr_b16 a[108:109], v8 offset:40960
v_add_u32 v4, 0x8000, v4
v_mfma_f32_16x16x32_bf16 v[172:175], a[116:119], a[20:23], v[172:175]
ds_read_b64_tr_b16 a[110:111], v8 offset:41984
v_and_b32 v251, 0xff800000, v21
v_mfma_f32_16x16x32_bf16 v[172:175], a[112:115], a[16:19], v[172:175]
v_not_b32 v17, v17
v_or_b32 v21, v17, v18
v_mfma_f32_16x16x32_bf16 v[164:167], a[112:115], a[8:11], v[164:167]
v_ashrrev_i32 v21, 31, v21
v_and_b32 v255, 0xff800000, v21
v_mfma_f32_16x16x32_bf16 v[164:167], a[116:119], a[12:15], v[164:167]
s_and_b32 s66, s2, 7
s_lshr_b32 s67, s2, 3
s_and_b32 s83, s66, 1
v_mfma_f32_16x16x32_bf16 v[156:159], a[116:119], a[4:7], v[156:159]
s_and_b32 s68, s66, 2
s_and_b32 s69, s67, 7
s_lshl2_add_u32 s82, s68, s69
v_mfma_f32_16x16x32_bf16 v[156:159], a[112:115], a[0:3], v[156:159]
s_and_b32 s68, s66, 4
s_lshr_b32 s69, s67, 3
ds_read_b64_tr_b16 a[112:113], v9 offset:32768
v_mfma_f32_16x16x32_bf16 v[24:27], a[72:75], a[0:3], v[24:27]
s_xor_b32 s69, s69, 0
s_add_u32 s87, s68, s69
ds_read_b64_tr_b16 a[114:115], v9 offset:33792
v_mfma_f32_16x16x32_bf16 v[24:27], a[76:79], a[4:7], v[24:27]
s_lshl_b32 s87, s87, 8
ds_read_b64_tr_b16 a[116:117], v9 offset:40960
v_add_u32 v5, 0x8000, v5
v_mfma_f32_16x16x32_bf16 v[40:43], a[76:79], a[12:15], v[40:43]
s_lshl_b32 s86, s30, 13
s_lshl_b32 s85, s30, 16
ds_read_b64_tr_b16 a[118:119], v9 offset:41984
v_mfma_f32_16x16x32_bf16 v[40:43], a[72:75], a[8:11], v[40:43]
s_add_u32 s85, s85, s87
s_mul_i32 s66, s83, 1310720
s_add_u32 s85, s85, s66
v_mfma_f32_16x16x32_bf16 v[56:59], a[72:75], a[16:19], v[56:59]
s_mul_i32 s84, s82, 1310720
s_and_b32 s66, s30, 1
s_lshl_b32 s66, s66, 14
v_mfma_f32_16x16x32_bf16 v[56:59], a[76:79], a[20:23], v[56:59]
s_add_u32 s84, s84, s66
s_mul_i32 s66, s83, 163840
s_add_u32 s84, s84, s66
v_mfma_f32_16x16x32_bf16 v[72:75], a[76:79], a[28:31], v[72:75]
s_waitcnt vmcnt(8)
s_add_u32 s84, s84, 34603008
ds_read_b128 a[32:35], v2 offset:32768
v_mfma_f32_16x16x32_bf16 v[72:75], a[72:75], a[24:27], v[72:75]
s_sub_u32 s66, 15, s82
s_min_u32 s66, s66, s82
ds_read_b128 a[36:39], v3 offset:32768
v_mfma_f32_16x16x32_bf16 v[136:139], a[80:83], a[24:27], v[136:139]
s_lshl1_add_u32 s66, s66, s83
s_lshl_b32 s80, s66, 8
ds_read_b128 a[40:43], v2 offset:34816
v_mfma_f32_16x16x32_bf16 v[136:139], a[84:87], a[28:31], v[136:139]
s_add_u32 s80, s80, 8192
ds_read_b128 a[44:47], v3 offset:34816
v_add_u32 v6, 0x8000, v6
v_mfma_f32_16x16x32_bf16 v[120:123], a[84:87], a[20:23], v[120:123]
s_and_b32 s67, s30, 1
s_lshl_b32 s67, s67, 7
ds_read_b128 a[48:51], v2 offset:36864
v_mfma_f32_16x16x32_bf16 v[120:123], a[80:83], a[16:19], v[120:123]
s_branch L_po13
L_pg13:
s_branch L_pg17
L_po13:
s_add_u32 s67, s67, s83
s_lshl_b32 s67, s67, 7
ds_read_b128 a[52:55], v3 offset:36864
v_mfma_f32_16x16x32_bf16 v[104:107], a[80:83], a[8:11], v[104:107]
s_add_u32 s67, s67, 98304
s_lshl_b32 s66, s30, 11
ds_read_b128 a[56:59], v2 offset:38912
v_mfma_f32_16x16x32_bf16 v[104:107], a[84:87], a[12:15], v[104:107]
ds_read_b128 a[60:63], v3 offset:38912
v_lshrrev_b32 v14, 4, v0
v_mfma_f32_16x16x32_bf16 v[88:91], a[84:87], a[4:7], v[88:91]
ds_read_b64_tr_b16 a[72:73], v10 offset:32768
v_bfe_u32 v12, v0, 1, 3
v_mfma_f32_16x16x32_bf16 v[88:91], a[80:83], a[0:3], v[88:91]
s_waitcnt lgkmcnt(9)
ds_read_b64_tr_b16 a[74:75], v10 offset:33792
v_xor_b32 v12, v12, v14
v_mfma_f32_16x16x32_bf16 v[28:31], a[88:91], a[0:3], v[28:31]
ds_read_b64_tr_b16 a[76:77], v10 offset:40960
v_lshlrev_b32 v12, 5, v12
v_mfma_f32_16x16x32_bf16 v[28:31], a[92:95], a[4:7], v[28:31]
ds_read_b64_tr_b16 a[78:79], v10 offset:41984
v_add_u32 v7, 0x8000, v7
v_mfma_f32_16x16x32_bf16 v[44:47], a[92:95], a[12:15], v[44:47]
ds_read_b64_tr_b16 a[80:81], v11 offset:32768
v_lshl_add_u32 v12, v14, 11, v12
v_mfma_f32_16x16x32_bf16 v[44:47], a[88:91], a[8:11], v[44:47]
ds_read_b64_tr_b16 a[82:83], v11 offset:33792
v_and_b32 v14, 1, v0
v_mfma_f32_16x16x32_bf16 v[60:63], a[88:91], a[16:19], v[60:63]
ds_read_b64_tr_b16 a[84:85], v11 offset:40960
v_lshl_add_u32 v12, v14, 4, v12
v_mfma_f32_16x16x32_bf16 v[60:63], a[92:95], a[20:23], v[60:63]
ds_read_b64_tr_b16 a[86:87], v11 offset:41984
v_xor_b32 v13, 128, v12
v_mfma_f32_16x16x32_bf16 v[76:79], a[92:95], a[28:31], v[76:79]
v_readfirstlane_b32 vcc_lo, v1
s_nop 0
s_cmp_lt_u32 vcc_lo, s81
s_cbranch_scc1 L_spin_4
L_spinbk_5:
v_mfma_f32_16x16x32_bf16 v[76:79], a[88:91], a[24:27], v[76:79]
v_lshrrev_b32 v14, 4, v0
v_bfe_u32 v18, v0, 2, 2
v_mfma_f32_16x16x32_bf16 v[140:143], a[96:99], a[24:27], v[140:143]
v_lshl_add_u32 v14, v14, 2, v18
v_and_b32 v18, 3, v0
v_mfma_f32_16x16x32_bf16 v[140:143], a[100:103], a[28:31], v[140:143]
v_add_u32 v8, 0x8000, v8
v_lshlrev_b32 v18, 3, v18
v_mfma_f32_16x16x32_bf16 v[124:127], a[100:103], a[20:23], v[124:127]
v_lshl_add_u32 v18, v14, 8, v18
v_and_b32 v14, 7, v14
v_mfma_f32_16x16x32_bf16 v[124:127], a[96:99], a[16:19], v[124:127]
v_lshl_add_u32 v18, v14, 5, v18
v_xor_b32 v18, s67, v18
v_mfma_f32_16x16x32_bf16 v[108:111], a[96:99], a[8:11], v[108:111]
v_add_u32 v14, s66, v16
v_xor_b32 v15, 0x800, v14
v_mfma_f32_16x16x32_bf16 v[108:111], a[100:103], a[12:15], v[108:111]
s_lshr_b32 s66, s30, 1
s_lshl_b32 s66, s66, 16
s_and_b32 s67, s30, 1
v_mfma_f32_16x16x32_bf16 v[92:95], a[100:103], a[4:7], v[92:95]
s_lshl_b32 s67, s67, 10
v_add_u32 v9, 0x8000, v9
v_add_u32 v10, 0x8000, v10
v_mfma_f32_16x16x32_bf16 v[92:95], a[96:99], a[0:3], v[92:95]
s_add_u32 s66, s66, s67
s_add_u32 s66, s66, 32768
v_add_u32 v11, 0x8000, v11
v_mfma_f32_16x16x32_bf16 v[32:35], a[104:107], a[0:3], v[32:35]
v_add_u32 v17, s66, v16
v_lshlrev_b32 v21, 5, v0
v_mfma_f32_16x16x32_bf16 v[32:35], a[108:111], a[4:7], v[32:35]
s_lshl2_add_u32 s73, s2, s30
s_lshl_b32 s73, s73, 11
s_lshl_b32 s66, s30, 11
v_mfma_f32_16x16x32_bf16 v[48:51], a[108:111], a[12:15], v[48:51]
s_add_u32 s66, s66, 32768
s_waitcnt lgkmcnt(0)
s_barrier
v_mfma_f32_16x16x32_bf16 v[48:51], a[104:107], a[8:11], v[48:51]
ds_read_b64_tr_b16 a[88:89], v19 offset:36864
v_add_u32 v2, s66, v16
v_mfma_f32_16x16x32_bf16 v[64:67], a[104:107], a[16:19], v[64:67]
ds_read_b64_tr_b16 a[90:91], v19 offset:37120
v_add_u32 v3, 0x10000, v2
v_mfma_f32_16x16x32_bf16 v[64:67], a[108:111], a[20:23], v[64:67]
s_mov_b32 m0, s76
ds_read_b64_tr_b16 a[92:93], v19 offset:38912
v_mfma_f32_16x16x32_bf16 v[80:83], a[108:111], a[28:31], v[80:83]
s_lshl_b32 s64, s30, 14
ds_read_b64_tr_b16 a[94:95], v19 offset:39168
v_mfma_f32_16x16x32_bf16 v[80:83], a[104:107], a[24:27], v[80:83]
buffer_load_dwordx4 v16, s[32:35], s64 offen offset:0 sc1 lds
v_mfma_f32_16x16x32_bf16 v[144:147], a[112:115], a[24:27], v[144:147]
ds_read_b64_tr_b16 a[96:97], v20 offset:36864
v_mfma_f32_16x16x32_bf16 v[144:147], a[116:119], a[28:31], v[144:147]
ds_read_b64_tr_b16 a[98:99], v20 offset:37120
v_mfma_f32_16x16x32_bf16 v[128:131], a[116:119], a[20:23], v[128:131]
ds_read_b64_tr_b16 a[100:101], v20 offset:38912
v_mfma_f32_16x16x32_bf16 v[128:131], a[112:115], a[16:19], v[128:131]
buffer_load_dwordx4 v16, s[32:35], s64 offen offset:1024 sc1 lds
v_mfma_f32_16x16x32_bf16 v[112:115], a[112:115], a[8:11], v[112:115]
ds_read_b64_tr_b16 a[102:103], v20 offset:39168
v_mfma_f32_16x16x32_bf16 v[112:115], a[116:119], a[12:15], v[112:115]
ds_read_b64_tr_b16 a[104:105], v19 offset:40960
v_mfma_f32_16x16x32_bf16 v[96:99], a[116:119], a[4:7], v[96:99]
ds_read_b64_tr_b16 a[106:107], v19 offset:41216
v_mfma_f32_16x16x32_bf16 v[96:99], a[112:115], a[0:3], v[96:99]
buffer_load_dwordx4 v16, s[32:35], s64 offen offset:2048 sc1 lds
v_mfma_f32_16x16x32_bf16 v[36:39], a[72:75], a[0:3], v[36:39]
ds_read_b64_tr_b16 a[108:109], v19 offset:43008
v_mfma_f32_16x16x32_bf16 v[36:39], a[76:79], a[4:7], v[36:39]
ds_read_b64_tr_b16 a[110:111], v19 offset:43264
v_mfma_f32_16x16x32_bf16 v[52:55], a[76:79], a[12:15], v[52:55]
ds_read_b64_tr_b16 a[112:113], v20 offset:40960
v_mfma_f32_16x16x32_bf16 v[52:55], a[72:75], a[8:11], v[52:55]
buffer_load_dwordx4 v16, s[32:35], s64 offen offset:3072 sc1 lds
v_mfma_f32_16x16x32_bf16 v[68:71], a[72:75], a[16:19], v[68:71]
ds_read_b64_tr_b16 a[114:115], v20 offset:41216
v_mfma_f32_16x16x32_bf16 v[68:71], a[76:79], a[20:23], v[68:71]
s_add_u32 m0, s76, 4096
ds_read_b64_tr_b16 a[116:117], v20 offset:43008
v_mfma_f32_16x16x32_bf16 v[84:87], a[76:79], a[28:31], v[84:87]
s_add_u32 s64, s64, 4096
ds_read_b64_tr_b16 a[118:119], v20 offset:43264
v_mfma_f32_16x16x32_bf16 v[84:87], a[72:75], a[24:27], v[84:87]
buffer_load_dwordx4 v16, s[32:35], s64 offen offset:0 sc1 lds
v_mfma_f32_16x16x32_bf16 v[148:151], a[80:83], a[24:27], v[148:151]
ds_read_b64_tr_b16 a[72:73], v19 offset:32768
v_mfma_f32_16x16x32_bf16 v[148:151], a[84:87], a[28:31], v[148:151]
ds_read_b64_tr_b16 a[74:75], v19 offset:33024
v_mfma_f32_16x16x32_bf16 v[132:135], a[84:87], a[20:23], v[132:135]
ds_read_b64_tr_b16 a[76:77], v19 offset:34816
v_mfma_f32_16x16x32_bf16 v[132:135], a[80:83], a[16:19], v[132:135]
buffer_load_dwordx4 v16, s[32:35], s64 offen offset:1024 sc1 lds
v_mfma_f32_16x16x32_bf16 v[116:119], a[80:83], a[8:11], v[116:119]
ds_read_b64_tr_b16 a[78:79], v19 offset:35072
v_mfma_f32_16x16x32_bf16 v[116:119], a[84:87], a[12:15], v[116:119]
v_mfma_f32_16x16x32_bf16 v[100:103], a[84:87], a[4:7], v[100:103]
v_mfma_f32_16x16x32_bf16 v[100:103], a[80:83], a[0:3], v[100:103]
s_waitcnt lgkmcnt(5)
buffer_load_dwordx4 v16, s[32:35], s64 offen offset:2048 sc1 lds
v_mfma_f32_16x16x32_bf16 v[184:187], a[88:91], a[32:35], v[184:187]
ds_read_b64_tr_b16 a[80:81], v20 offset:32768
v_bfe_u32 v1, v0, 1, 1
v_mfma_f32_16x16x32_bf16 v[184:187], a[92:95], a[36:39], v[184:187]
ds_read_b64_tr_b16 a[82:83], v20 offset:33024
v_subrev_u32 v1, 1, v1
v_mfma_f32_16x16x32_bf16 v[192:195], a[92:95], a[44:47], v[192:195]
ds_read_b64_tr_b16 a[84:85], v20 offset:34816
v_and_b32 v1, 0x3f803f80, v1
v_mfma_f32_16x16x32_bf16 v[192:195], a[88:91], a[40:43], v[192:195]
buffer_load_dwordx4 v16, s[32:35], s64 offen offset:3072 sc1 lds
v_mfma_f32_16x16x32_bf16 v[200:203], a[88:91], a[48:51], v[200:203]
ds_read_b64_tr_b16 a[86:87], v20 offset:35072
v_accvgpr_write_b32 a240, v1
v_mfma_f32_16x16x32_bf16 v[200:203], a[92:95], a[52:55], v[200:203]
v_accvgpr_write_b32 a241, v1
v_accvgpr_write_b32 a242, v1
v_mfma_f32_16x16x32_bf16 v[208:211], a[92:95], a[60:63], v[208:211]
s_lshr_b32 s64, s76, 1
s_add_u32 m0, s64, 81920
s_and_b32 s71, s64, 8192
s_add_u32 s64, s64, s71
s_add_u32 s64, s64, 8192
v_accvgpr_write_b32 a243, v1
v_mfma_f32_16x16x32_bf16 v[208:211], a[88:91], a[56:59], v[208:211]
buffer_load_dwordx4 v16, s[32:35], s64 offen offset:0 sc1 lds
v_mfma_f32_16x16x32_bf16 v[212:215], a[96:99], a[56:59], v[212:215]
ds_read_b64_tr_b16 a[88:89], v4 offset:32768
v_mfma_f32_16x16x32_bf16 v[212:215], a[100:103], a[60:63], v[212:215]
ds_read_b64_tr_b16 a[90:91], v4 offset:33792
v_mfma_f32_16x16x32_bf16 v[204:207], a[100:103], a[52:55], v[204:207]
ds_read_b64_tr_b16 a[92:93], v4 offset:40960
v_mfma_f32_16x16x32_bf16 v[204:207], a[96:99], a[48:51], v[204:207]
buffer_load_dwordx4 v16, s[32:35], s64 offen offset:1024 sc1 lds
v_mfma_f32_16x16x32_bf16 v[196:199], a[96:99], a[40:43], v[196:199]
ds_read_b64_tr_b16 a[94:95], v4 offset:41984
v_mfma_f32_16x16x32_bf16 v[196:199], a[100:103], a[44:47], v[196:199]
s_or_b32 s66, s3, s30
s_cmp_eq_u32 s66, 0
s_cselect_b32 s66, 0xff800000, 0
v_mfma_f32_16x16x32_bf16 v[188:191], a[100:103], a[36:39], v[188:191]
s_and_b32 s67, s74, 0x7800
s_cselect_b32 s67, 0, 0x70000000
s_add_u32 s77, s74, s67
v_mfma_f32_16x16x32_bf16 v[188:191], a[96:99], a[32:35], v[188:191]
s_sub_u32 s77, s77, 2048
buffer_load_dwordx4 v16, s[32:35], s64 offen offset:2048 sc1 lds
v_mfma_f32_16x16x32_bf16 v[216:219], a[32:35], a[104:107], v[216:219]
s_mov_b32 s68, 0x3e0293ee
ds_read_b64_tr_b16 a[96:97], v5 offset:32768
v_mfma_f32_16x16x32_bf16 v[216:219], a[36:39], a[108:111], v[216:219]
s_mov_b32 s69, s68
ds_read_b64_tr_b16 a[98:99], v5 offset:33792
v_cvt_pk_bf16_f32 v208, v208, v209
v_mfma_f32_16x16x32_bf16 v[224:227], a[44:47], a[108:111], v[224:227]
ds_read_b64_tr_b16 a[100:101], v5 offset:40960
v_cvt_pk_bf16_f32 v209, v210, v211
v_mfma_f32_16x16x32_bf16 v[224:227], a[40:43], a[104:107], v[224:227]
buffer_load_dwordx4 v16, s[32:35], s64 offen offset:3072 sc1 lds
v_mfma_f32_16x16x32_bf16 v[232:235], a[48:51], a[104:107], v[232:235]
ds_read_b64_tr_b16 a[102:103], v5 offset:41984
v_cvt_pk_bf16_f32 v210, v212, v213
v_mfma_f32_16x16x32_bf16 v[232:235], a[52:55], a[108:111], v[232:235]
v_cvt_pk_bf16_f32 v211, v214, v215
v_mfma_f32_16x16x32_bf16 v[240:243], a[60:63], a[108:111], v[240:243]
ds_write_b128 v3, v[208:211] offset:10240
v_mfma_f32_16x16x32_bf16 v[240:243], a[56:59], a[104:107], v[240:243]
ds_read_b64_tr_b16 a[104:105], v6 offset:32768
v_cvt_pk_bf16_f32 v200, v200, v201
v_mfma_f32_16x16x32_bf16 v[244:247], a[56:59], a[112:115], v[244:247]
s_waitcnt lgkmcnt(6)
ds_read_b64_tr_b16 a[106:107], v6 offset:33792
v_cvt_pk_bf16_f32 v201, v202, v203
v_mfma_f32_16x16x32_bf16 v[244:247], a[60:63], a[116:119], v[244:247]
ds_read_b64_tr_b16 a[108:109], v6 offset:40960
v_cvt_pk_bf16_f32 v202, v204, v205
v_mfma_f32_16x16x32_bf16 v[236:239], a[52:55], a[116:119], v[236:239]
ds_read_b64_tr_b16 a[110:111], v6 offset:41984
v_cvt_pk_bf16_f32 v203, v206, v207
v_mfma_f32_16x16x32_bf16 v[236:239], a[48:51], a[112:115], v[236:239]
ds_write_b128 v3, v[200:203] offset:2048
v_mfma_f32_16x16x32_bf16 v[228:231], a[40:43], a[112:115], v[228:231]
v_cvt_pk_bf16_f32 v192, v192, v193
v_cvt_pk_bf16_f32 v193, v194, v195
v_mfma_f32_16x16x32_bf16 v[228:231], a[44:47], a[116:119], v[228:231]
v_cvt_pk_bf16_f32 v194, v196, v197
v_cvt_pk_bf16_f32 v195, v198, v199
v_mfma_f32_16x16x32_bf16 v[220:223], a[36:39], a[116:119], v[220:223]
ds_write_b128 v2, v[192:195] offset:10240
v_mfma_f32_16x16x32_bf16 v[220:223], a[32:35], a[112:115], v[220:223]
ds_read_b64_tr_b16 a[112:113], v7 offset:32768
v_cvt_pk_bf16_f32 v184, v184, v185
v_mfma_f32_16x16x32_bf16 v[152:155], a[72:75], a[32:35], v[152:155]
ds_read_b64_tr_b16 a[114:115], v7 offset:33792
v_cvt_pk_bf16_f32 v185, v186, v187
v_mfma_f32_16x16x32_bf16 v[152:155], a[76:79], a[36:39], v[152:155]
ds_read_b64_tr_b16 a[116:117], v7 offset:40960
v_cvt_pk_bf16_f32 v186, v188, v189
v_mfma_f32_16x16x32_bf16 v[160:163], a[76:79], a[44:47], v[160:163]
ds_read_b64_tr_b16 a[118:119], v7 offset:41984
v_cvt_pk_bf16_f32 v187, v190, v191
v_mfma_f32_16x16x32_bf16 v[160:163], a[72:75], a[40:43], v[160:163]
ds_write_b128 v2, v[184:187] offset:2048
v_mfma_f32_16x16x32_bf16 v[168:171], a[72:75], a[48:51], v[168:171]
v_cvt_pk_bf16_f32 v219, v218, v219
v_cvt_pk_bf16_f32 v218, v216, v217
v_mfma_f32_16x16x32_bf16 v[168:171], a[76:79], a[52:55], v[168:171]
ds_write_b64 v2, v[218:219] offset:3072
v_mfma_f32_16x16x32_bf16 v[176:179], a[76:79], a[60:63], v[176:179]
buffer_load_dword a252, v21, s[36:39], s73 offen
v_mfma_f32_16x16x32_bf16 v[176:179], a[72:75], a[56:59], v[176:179]
ds_read_b64_tr_b16 a[72:73], v8 offset:32768
v_cvt_pk_bf16_f32 v227, v226, v227
v_mfma_f32_16x16x32_bf16 v[180:183], a[80:83], a[56:59], v[180:183]
ds_read_b64_tr_b16 a[74:75], v8 offset:33792
v_cvt_pk_bf16_f32 v226, v224, v225
v_mfma_f32_16x16x32_bf16 v[180:183], a[84:87], a[60:63], v[180:183]
ds_write_b64 v2, v[226:227] offset:11264
v_mfma_f32_16x16x32_bf16 v[172:175], a[84:87], a[52:55], v[172:175]
ds_read_b64_tr_b16 a[76:77], v8 offset:40960
v_cvt_pk_bf16_f32 v235, v234, v235
v_mfma_f32_16x16x32_bf16 v[172:175], a[80:83], a[48:51], v[172:175]
ds_read_b64_tr_b16 a[78:79], v8 offset:41984
v_cvt_pk_bf16_f32 v234, v232, v233
v_mfma_f32_16x16x32_bf16 v[164:167], a[80:83], a[40:43], v[164:167]
ds_write_b64 v3, v[234:235] offset:3072
v_mfma_f32_16x16x32_bf16 v[164:167], a[84:87], a[44:47], v[164:167]
v_cvt_pk_bf16_f32 v243, v242, v243
v_cvt_pk_bf16_f32 v242, v240, v241
v_mfma_f32_16x16x32_bf16 v[156:159], a[84:87], a[36:39], v[156:159]
ds_write_b64 v3, v[242:243] offset:11264
v_mfma_f32_16x16x32_bf16 v[156:159], a[80:83], a[32:35], v[156:159]
ds_read_b64_tr_b16 a[80:81], v9 offset:32768
v_cvt_pk_bf16_f32 v247, v246, v247
v_mfma_f32_16x16x32_bf16 v[24:27], a[88:91], a[32:35], v[24:27]
ds_read_b64_tr_b16 a[82:83], v9 offset:33792
v_cvt_pk_bf16_f32 v246, v244, v245
v_mfma_f32_16x16x32_bf16 v[24:27], a[92:95], a[36:39], v[24:27]
ds_write_b64 v3, v[246:247] offset:11272
v_mfma_f32_16x16x32_bf16 v[40:43], a[92:95], a[44:47], v[40:43]
ds_read_b64_tr_b16 a[84:85], v9 offset:40960
v_cvt_pk_bf16_f32 v239, v238, v239
v_cvt_pk_bf16_f32 v238, v236, v237
v_mfma_f32_16x16x32_bf16 v[40:43], a[88:91], a[40:43], v[40:43]
ds_write_b64 v3, v[238:239] offset:3080
v_mfma_f32_16x16x32_bf16 v[56:59], a[88:91], a[48:51], v[56:59]
ds_read_b64_tr_b16 a[86:87], v9 offset:41984
v_cvt_pk_bf16_f32 v231, v230, v231
v_cvt_pk_bf16_f32 v230, v228, v229
v_mfma_f32_16x16x32_bf16 v[56:59], a[92:95], a[52:55], v[56:59]
ds_write_b64 v2, v[230:231] offset:11272
v_mfma_f32_16x16x32_bf16 v[72:75], a[92:95], a[60:63], v[72:75]
v_cvt_pk_bf16_f32 v223, v222, v223
v_cvt_pk_bf16_f32 v222, v220, v221
v_mfma_f32_16x16x32_bf16 v[72:75], a[88:91], a[56:59], v[72:75]
s_waitcnt lgkmcnt(8)
ds_write_b64 v2, v[222:223] offset:3080
v_mfma_f32_16x16x32_bf16 v[136:139], a[96:99], a[56:59], v[136:139]
ds_read_b64_tr_b16 a[88:89], v10 offset:32768
v_cvt_pk_bf16_f32 v176, v176, v177
v_mfma_f32_16x16x32_bf16 v[136:139], a[100:103], a[60:63], v[136:139]
s_waitcnt lgkmcnt(0)
s_barrier
v_mfma_f32_16x16x32_bf16 v[120:123], a[100:103], a[52:55], v[120:123]
ds_read_b128 a[16:19], v17 offset:16384
v_cvt_pk_bf16_f32 v177, v178, v179
v_mfma_f32_16x16x32_bf16 v[120:123], a[96:99], a[48:51], v[120:123]
ds_read_b64_tr_b16 a[90:91], v10 offset:33792
v_cvt_pk_bf16_f32 v178, v180, v181
v_mfma_f32_16x16x32_bf16 v[104:107], a[96:99], a[40:43], v[104:107]
ds_read_b64_tr_b16 a[92:93], v10 offset:40960
v_cvt_pk_bf16_f32 v179, v182, v183
v_mfma_f32_16x16x32_bf16 v[104:107], a[100:103], a[44:47], v[104:107]
ds_read_b64_tr_b16 a[94:95], v10 offset:41984
v_cvt_pk_bf16_f32 v168, v168, v169
v_mfma_f32_16x16x32_bf16 v[88:91], a[100:103], a[36:39], v[88:91]
v_cvt_pk_bf16_f32 v169, v170, v171
v_cvt_pk_bf16_f32 v170, v172, v173
v_mfma_f32_16x16x32_bf16 v[88:91], a[96:99], a[32:35], v[88:91]
ds_read_b64_tr_b16 a[96:97], v11 offset:32768
v_cvt_pk_bf16_f32 v171, v174, v175
v_mfma_f32_16x16x32_bf16 v[28:31], a[104:107], a[32:35], v[28:31]
s_waitcnt lgkmcnt(4)
buffer_store_dwordx4 a[16:19], v16, s[44:47], s74 offen sc1
v_mfma_f32_16x16x32_bf16 v[28:31], a[108:111], a[36:39], v[28:31]
ds_read_b64_tr_b16 a[98:99], v11 offset:33792
v_cvt_pk_bf16_f32 v160, v160, v161
v_mfma_f32_16x16x32_bf16 v[44:47], a[108:111], a[44:47], v[44:47]
ds_read_b64_tr_b16 a[100:101], v11 offset:40960
v_cvt_pk_bf16_f32 v161, v162, v163
v_mfma_f32_16x16x32_bf16 v[44:47], a[104:107], a[40:43], v[44:47]
s_sub_u32 s81, s3, 1
ds_read_b64_tr_b16 a[102:103], v11 offset:41984
v_cvt_pk_bf16_f32 v162, v164, v165
v_mfma_f32_16x16x32_bf16 v[60:63], a[104:107], a[48:51], v[60:63]
s_sub_u32 s67, s3, 2
ds_read_b128 a[4:7], v2 offset:8192
v_cvt_pk_bf16_f32 v163, v166, v167
v_mfma_f32_16x16x32_bf16 v[60:63], a[108:111], a[52:55], v[60:63]
s_mul_i32 s81, s81, s67
ds_read_b128 a[12:15], v3 offset:8192
v_cvt_pk_bf16_f32 v152, v152, v153
v_mfma_f32_16x16x32_bf16 v[76:79], a[108:111], a[60:63], v[76:79]
s_lshl4_add_u32 s81, s81, s31
ds_read_b64 v[224:225], v2 offset:9216
v_cvt_pk_bf16_f32 v153, v154, v155
v_mfma_f32_16x16x32_bf16 v[76:79], a[104:107], a[56:59], v[76:79]
s_lshl2_add_u32 s81, s81, s30
ds_read_b64 v[228:229], v2 offset:9224
v_cvt_pk_bf16_f32 v154, v156, v157
v_mfma_f32_16x16x32_bf16 v[140:143], a[112:115], a[56:59], v[140:143]
s_mul_i32 s81, s81, 3328
ds_read_b64 v[240:241], v3 offset:9216
v_cvt_pk_bf16_f32 v155, v158, v159
v_mfma_f32_16x16x32_bf16 v[140:143], a[116:119], a[60:63], v[140:143]
s_mov_b32 s73, 0
ds_read_b64 v[244:245], v3 offset:9224
v_or_b32 v20, s66, v252
v_mfma_f32_16x16x32_bf16 v[124:127], a[116:119], a[52:55], v[124:127]
s_mov_b32 s72, 0x20000
v_or_b32 v21, s66, v253
v_or_b32 v22, s66, v254
v_mfma_f32_16x16x32_bf16 v[124:127], a[112:115], a[48:51], v[124:127]
s_lshl_b32 s67, s31, 15
v_or_b32 v23, s66, v255
v_mfma_f32_16x16x32_bf16 v[108:111], a[112:115], a[40:43], v[108:111]
s_add_u32 s67, s67, s78
s_mov_b32 s66, 0x3e8293ee
v_mul_f32 v72, s68, v72
v_mfma_f32_16x16x32_bf16 v[108:111], a[116:119], a[44:47], v[108:111]
s_add_u32 s67, s67, 33554432
v_mul_f32 v73, s68, v73
v_mul_f32 v74, s68, v74
v_mfma_f32_16x16x32_bf16 v[92:95], a[116:119], a[36:39], v[92:95]
s_mul_i32 s74, s3, 1310720
v_mul_f32 v75, s68, v75
v_mul_f32 v136, s68, v136
v_mfma_f32_16x16x32_bf16 v[92:95], a[112:115], a[32:35], v[92:95]
s_add_u32 s74, s74, s67
v_mul_f32 v137, s68, v137
v_mul_f32 v138, s68, v138
v_mfma_f32_16x16x32_bf16 v[32:35], a[72:75], a[32:35], v[32:35]
s_mul_i32 s75, s16, 1310720
v_mul_f32 v139, s68, v139
v_cvt_pk_bf16_f32 v72, v72, v73
v_mfma_f32_16x16x32_bf16 v[32:35], a[76:79], a[36:39], v[32:35]
s_add_u32 s75, s75, s67
v_cvt_pk_bf16_f32 v73, v74, v75
v_cvt_pk_bf16_f32 v74, v136, v137
v_mfma_f32_16x16x32_bf16 v[48:51], a[76:79], a[44:47], v[48:51]
s_mul_i32 s67, s31, 24576
v_cvt_pk_bf16_f32 v75, v138, v139
v_mul_f32 v56, s68, v56
v_mfma_f32_16x16x32_bf16 v[48:51], a[72:75], a[40:43], v[48:51]
s_sub_u32 s67, 1052672, s67
v_mul_f32 v57, s68, v57
v_mul_f32 v58, s68, v58
v_mfma_f32_16x16x32_bf16 v[64:67], a[72:75], a[48:51], v[64:67]
s_add_u32 s64, s74, s67
v_mul_f32 v59, s68, v59
v_mul_f32 v120, s68, v120
v_mfma_f32_16x16x32_bf16 v[64:67], a[76:79], a[52:55], v[64:67]
s_add_u32 s65, s75, s67
v_mul_f32 v121, s68, v121
v_mul_f32 v122, s68, v122
v_mfma_f32_16x16x32_bf16 v[80:83], a[76:79], a[60:63], v[80:83]
s_and_b32 s70, s30, 1
v_mul_f32 v123, s68, v123
v_cvt_pk_bf16_f32 v56, v56, v57
v_mfma_f32_16x16x32_bf16 v[80:83], a[72:75], a[56:59], v[80:83]
s_lshr_b32 s67, s30, 1
v_cvt_pk_bf16_f32 v57, v58, v59
v_cvt_pk_bf16_f32 v58, v120, v121
v_mfma_f32_16x16x32_bf16 v[144:147], a[80:83], a[56:59], v[144:147]
s_lshl3_add_u32 s71, s67, s70
v_cvt_pk_bf16_f32 v59, v122, v123
v_mul_f32 v40, s68, v40
v_mfma_f32_16x16x32_bf16 v[144:147], a[84:87], a[60:63], v[144:147]
s_add_u32 s71, s71, 4
v_mul_f32 v41, s68, v41
v_mul_f32 v42, s68, v42
v_mfma_f32_16x16x32_bf16 v[128:131], a[84:87], a[52:55], v[128:131]
s_lshl_b32 s71, s71, 13
v_mul_f32 v43, s68, v43
v_mul_f32 v104, s68, v104
v_mfma_f32_16x16x32_bf16 v[128:131], a[80:83], a[48:51], v[128:131]
s_lshl_b32 s70, s70, 14
v_mul_f32 v105, s68, v105
v_mul_f32 v106, s68, v106
v_mfma_f32_16x16x32_bf16 v[112:115], a[80:83], a[40:43], v[112:115]
s_mul_i32 s67, s67, 24576
v_mul_f32 v107, s68, v107
v_cvt_pk_bf16_f32 v40, v40, v41
v_mfma_f32_16x16x32_bf16 v[112:115], a[84:87], a[44:47], v[112:115]
s_sub_u32 s70, s70, s67
v_cvt_pk_bf16_f32 v41, v42, v43
v_cvt_pk_bf16_f32 v42, v104, v105
v_mfma_f32_16x16x32_bf16 v[96:99], a[84:87], a[36:39], v[96:99]
s_add_u32 s70, s70, 65536
v_cvt_pk_bf16_f32 v43, v106, v107
v_mul_f32 v24, s68, v24
v_mfma_f32_16x16x32_bf16 v[96:99], a[80:83], a[32:35], v[96:99]
s_waitcnt lgkmcnt(0)
v_mul_f32 v25, s68, v25
v_mul_f32 v26, s68, v26
v_mfma_f32_16x16x32_bf16 v[36:39], a[88:91], a[32:35], v[36:39]
v_mul_f32 v27, s68, v27
v_mul_f32 v88, s68, v88
v_mfma_f32_16x16x32_bf16 v[36:39], a[92:95], a[36:39], v[36:39]
v_mul_f32 v89, s68, v89
v_mul_f32 v90, s68, v90
v_mfma_f32_16x16x32_bf16 v[52:55], a[92:95], a[44:47], v[52:55]
v_mul_f32 v91, s68, v91
v_cvt_pk_bf16_f32 v24, v24, v25
v_mfma_f32_16x16x32_bf16 v[52:55], a[88:91], a[40:43], v[52:55]
v_cvt_pk_bf16_f32 v25, v26, v27
v_cvt_pk_bf16_f32 v26, v88, v89
v_mfma_f32_16x16x32_bf16 v[68:71], a[88:91], a[48:51], v[68:71]
v_cvt_pk_bf16_f32 v27, v90, v91
v_mul_f32 v76, s68, v76
v_mfma_f32_16x16x32_bf16 v[68:71], a[92:95], a[52:55], v[68:71]
v_mul_f32 v77, s68, v77
v_mul_f32 v78, s68, v78
v_mfma_f32_16x16x32_bf16 v[84:87], a[92:95], a[60:63], v[84:87]
v_mul_f32 v79, s68, v79
v_mul_f32 v140, s68, v140
v_mfma_f32_16x16x32_bf16 v[84:87], a[88:91], a[56:59], v[84:87]
v_mul_f32 v141, s68, v141
v_mul_f32 v142, s68, v142
v_mfma_f32_16x16x32_bf16 v[148:151], a[96:99], a[56:59], v[148:151]
v_mul_f32 v143, s68, v143
v_cvt_pk_bf16_f32 v76, v76, v77
v_mfma_f32_16x16x32_bf16 v[148:151], a[100:103], a[60:63], v[148:151]
v_cvt_pk_bf16_f32 v77, v78, v79
v_cvt_pk_bf16_f32 v78, v140, v141
v_mfma_f32_16x16x32_bf16 v[132:135], a[100:103], a[52:55], v[132:135]
v_cvt_pk_bf16_f32 v79, v142, v143
v_mul_f32 v60, s68, v60
v_mfma_f32_16x16x32_bf16 v[132:135], a[96:99], a[48:51], v[132:135]
v_mul_f32 v61, s68, v61
v_mul_f32 v62, s68, v62
v_mfma_f32_16x16x32_bf16 v[116:119], a[96:99], a[40:43], v[116:119]
v_mul_f32 v63, s68, v63
v_mul_f32 v124, s68, v124
v_mfma_f32_16x16x32_bf16 v[116:119], a[100:103], a[44:47], v[116:119]
v_mul_f32 v125, s68, v125
v_mul_f32 v126, s68, v126
v_mfma_f32_16x16x32_bf16 v[100:103], a[100:103], a[36:39], v[100:103]
v_mul_f32 v127, s68, v127
v_cvt_pk_bf16_f32 v60, v60, v61
v_mfma_f32_16x16x32_bf16 v[100:103], a[96:99], a[32:35], v[100:103]
v_cvt_pk_bf16_f32 v61, v62, v63
v_cvt_pk_bf16_f32 v62, v124, v125
v_cvt_pk_bf16_f32 v63, v126, v127
buffer_load_dwordx4 v[88:91], v16, s[44:47], s77 offen sc1
v_mfma_f32_16x16x32_bf16 v[196:199], v[192:195], v[160:163], v[248:251]
v_mfma_f32_16x16x32_bf16 v[212:215], v[208:211], v[176:179], v[248:251]
v_mfma_f32_16x16x32_bf16 v[164:167], a[4:7], v[160:163], v[252:255]
v_mfma_f32_16x16x32_bf16 v[180:183], a[12:15], v[176:179], v[252:255]
s_waitcnt vmcnt(19)
s_waitcnt vmcnt(20)
s_waitcnt vmcnt(21)
s_waitcnt vmcnt(22)
v_accvgpr_read_b32 v4, a64
v_accvgpr_read_b32 v5, a65
v_accvgpr_read_b32 v6, a66
v_accvgpr_read_b32 v7, a67
v_accvgpr_read_b32 v8, a68
v_accvgpr_read_b32 v9, a69
v_accvgpr_read_b32 v10, a70
v_accvgpr_read_b32 v11, a71
v_max3_f32 v121, v196, v197, v198
v_max3_f32 v121, v121, v199, v164
v_max3_f32 v121, v121, v165, v166
v_max_f32 v121, v121, v167
v_max3_f32 v123, v212, v213, v214
v_max3_f32 v123, v123, v215, v180
v_max3_f32 v123, v123, v181, v182
v_max_f32 v123, v123, v183
v_mov_b32 v105, v121
v_mov_b32 v107, v123
v_pk_mul_f32 v[28:29], v[28:29], s[68:69]
v_permlane16_swap_b32 v105, v121
v_permlane16_swap_b32 v107, v123
v_max_f32 v121, v121, v105
v_max_f32 v123, v123, v107
v_mov_b32 v105, v121
v_mov_b32 v107, v123
v_pk_mul_f32 v[30:31], v[30:31], s[68:69]
v_permlane32_swap_b32 v105, v121
v_permlane32_swap_b32 v107, v123
v_max_f32 v121, v121, v105
v_max_f32 v123, v123, v107
v_mul_f32 v121, s66, v121
v_mul_f32 v123, s66, v123
v_fma_f32 v164, v164, s66, -v121
v_fma_f32 v165, v165, s66, -v121
v_fma_f32 v166, v166, s66, -v121
v_fma_f32 v167, v167, s66, -v121
v_fma_f32 v196, v196, s66, -v121
v_fma_f32 v197, v197, s66, -v121
v_fma_f32 v198, v198, s66, -v121
v_fma_f32 v199, v199, s66, -v121
v_exp_f32 v164, v164
v_exp_f32 v165, v165
v_exp_f32 v166, v166
v_exp_f32 v167, v167
v_exp_f32 v196, v196
v_exp_f32 v197, v197
v_exp_f32 v198, v198
v_exp_f32 v199, v199
v_cvt_pk_bf16_f32 v164, v164, v165
v_cvt_pk_bf16_f32 v165, v166, v167
v_cvt_pk_bf16_f32 v166, v196, v197
v_cvt_pk_bf16_f32 v167, v198, v199
v_pk_mul_f32 v[92:93], v[92:93], s[68:69]
v_pk_mul_f32 v[94:95], v[94:95], s[68:69]
v_mfma_f32_16x16x32_bf16 v[196:199], a[244:247], v[164:167], 0
v_mfma_f32_16x16x32_bf16 v[160:163], v[224:227], v[164:167], 0
v_mfma_f32_16x16x32_bf16 v[192:195], v[228:231], v[164:167], 0
v_fma_f32 v180, v180, s66, -v123
v_fma_f32 v181, v181, s66, -v123
v_fma_f32 v182, v182, s66, -v123
v_fma_f32 v183, v183, s66, -v123
v_fma_f32 v212, v212, s66, -v123
v_fma_f32 v213, v213, s66, -v123
v_fma_f32 v214, v214, s66, -v123
v_fma_f32 v215, v215, s66, -v123
v_exp_f32 v180, v180
v_exp_f32 v181, v181
v_exp_f32 v182, v182
v_exp_f32 v183, v183
v_exp_f32 v212, v212
v_exp_f32 v213, v213
v_exp_f32 v214, v214
v_exp_f32 v215, v215
v_cvt_pk_bf16_f32 v180, v180, v181
v_cvt_pk_bf16_f32 v181, v182, v183
v_cvt_pk_bf16_f32 v182, v212, v213
v_cvt_pk_bf16_f32 v183, v214, v215
v_cvt_pk_bf16_f32 v28, v28, v29
v_cvt_pk_bf16_f32 v29, v30, v31
v_mfma_f32_16x16x32_bf16 v[212:215], a[244:247], v[180:183], 0
v_mfma_f32_16x16x32_bf16 v[176:179], v[240:243], v[180:183], 0
s_branch L_po14
L_pg14:
s_branch L_pg18
L_po14:
v_mfma_f32_16x16x32_bf16 v[208:211], v[244:247], v[180:183], 0
v_cvt_pk_bf16_f32 v30, v92, v93
v_cvt_pk_bf16_f32 v31, v94, v95
v_pk_mul_f32 v[44:45], v[44:45], s[68:69]
v_pk_mul_f32 v[46:47], v[46:47], s[68:69]
v_pk_mul_f32 v[108:109], v[108:109], s[68:69]
v_pk_mul_f32 v[110:111], v[110:111], s[68:69]
v_rcp_f32 v121, v196
v_rcp_f32 v123, v212
v_mul_f32 v121, v121, v7
v_mul_f32 v123, v123, v11
v_mul_f32 v160, v160, v121
v_mul_f32 v161, v161, v121
v_mul_f32 v162, v162, v121
v_mul_f32 v163, v163, v121
v_mul_f32 v192, v192, v121
v_mul_f32 v193, v193, v121
v_mul_f32 v194, v194, v121
v_mul_f32 v195, v195, v121
v_cvt_pk_bf16_f32 v160, v160, v161
v_cvt_pk_bf16_f32 v161, v162, v163
v_cvt_pk_bf16_f32 v162, v192, v193
v_cvt_pk_bf16_f32 v163, v194, v195
buffer_store_dwordx4 v[160:163], v16, s[44:47], s64 offen sc1
v_mul_f32 v176, v176, v123
v_mul_f32 v177, v177, v123
v_mul_f32 v178, v178, v123
v_mul_f32 v179, v179, v123
v_mul_f32 v208, v208, v123
v_mul_f32 v209, v209, v123
v_mul_f32 v210, v210, v123
v_mul_f32 v211, v211, v123
v_cvt_pk_bf16_f32 v176, v176, v177
v_cvt_pk_bf16_f32 v177, v178, v179
v_cvt_pk_bf16_f32 v178, v208, v209
v_cvt_pk_bf16_f32 v179, v210, v211
buffer_store_dwordx4 v[176:179], v16, s[44:47], s65 offen sc1
v_cvt_pk_bf16_f32 v44, v44, v45
v_cvt_pk_bf16_f32 v45, v46, v47
v_cvt_pk_bf16_f32 v46, v108, v109
v_cvt_pk_bf16_f32 v47, v110, v111
v_pk_mul_f32 v[32:33], v[32:33], s[68:69]
v_pk_mul_f32 v[34:35], v[34:35], s[68:69]
v_pk_mul_f32 v[96:97], v[96:97], s[68:69]
v_pk_mul_f32 v[98:99], v[98:99], s[68:69]
v_cvt_pk_bf16_f32 v32, v32, v33
v_cvt_pk_bf16_f32 v33, v34, v35
v_cvt_pk_bf16_f32 v34, v96, v97
v_cvt_pk_bf16_f32 v35, v98, v99
v_pk_mul_f32 v[48:49], v[48:49], s[68:69]
v_pk_mul_f32 v[50:51], v[50:51], s[68:69]
v_pk_mul_f32 v[112:113], v[112:113], s[68:69]
v_pk_mul_f32 v[114:115], v[114:115], s[68:69]
v_cvt_pk_bf16_f32 v48, v48, v49
v_cvt_pk_bf16_f32 v49, v50, v51
v_cvt_pk_bf16_f32 v50, v112, v113
v_cvt_pk_bf16_f32 v51, v114, v115
v_pk_mul_f32 v[64:65], v[64:65], s[68:69]
v_pk_mul_f32 v[66:67], v[66:67], s[68:69]
v_pk_mul_f32 v[128:129], v[128:129], s[68:69]
v_pk_mul_f32 v[130:131], v[130:131], s[68:69]
s_waitcnt vmcnt(2)
L_hchk:
v_max3_u32 v1, v88, v89, v90
v_max_u32 v1, v1, v91
v_cmp_eq_u32 vcc, -1, v1
s_cbranch_vccnz L_hretry
L_hgo:
ds_write_b128 v17, v[88:91]
s_sub_u32 s64, s64, 4096
s_sub_u32 s65, s65, 4096
v_cvt_pk_bf16_f32 v64, v64, v65
v_cvt_pk_bf16_f32 v65, v66, v67
v_cvt_pk_bf16_f32 v66, v128, v129
v_cvt_pk_bf16_f32 v67, v130, v131
v_pk_mul_f32 v[80:81], v[80:81], s[68:69]
v_pk_mul_f32 v[82:83], v[82:83], s[68:69]
v_pk_mul_f32 v[144:145], v[144:145], s[68:69]
v_pk_mul_f32 v[146:147], v[146:147], s[68:69]
s_waitcnt lgkmcnt(0)
s_barrier
ds_read_b128 a[0:3], v2 offset:0
ds_read_b128 a[8:11], v3 offset:0
ds_read_b64 v[216:217], v2 offset:1024
ds_read_b64 v[220:221], v2 offset:1032
ds_read_b64 v[232:233], v3 offset:1024
ds_read_b64 v[236:237], v3 offset:1032
v_cvt_pk_bf16_f32 v80, v80, v81
v_cvt_pk_bf16_f32 v81, v82, v83
v_cvt_pk_bf16_f32 v82, v144, v145
v_cvt_pk_bf16_f32 v83, v146, v147
v_pk_mul_f32 v[36:37], v[36:37], s[68:69]
v_pk_mul_f32 v[38:39], v[38:39], s[68:69]
v_pk_mul_f32 v[100:101], v[100:101], s[68:69]
v_pk_mul_f32 v[102:103], v[102:103], s[68:69]
v_cvt_pk_bf16_f32 v36, v36, v37
v_cvt_pk_bf16_f32 v37, v38, v39
v_cvt_pk_bf16_f32 v38, v100, v101
v_cvt_pk_bf16_f32 v39, v102, v103
v_pk_mul_f32 v[52:53], v[52:53], s[68:69]
v_pk_mul_f32 v[54:55], v[54:55], s[68:69]
v_pk_mul_f32 v[116:117], v[116:117], s[68:69]
v_pk_mul_f32 v[118:119], v[118:119], s[68:69]
v_mfma_f32_16x16x32_bf16 v[188:191], v[184:187], v[152:155], v[248:251]
v_mfma_f32_16x16x32_bf16 v[204:207], v[200:203], v[168:171], v[248:251]
s_waitcnt lgkmcnt(5)
v_mfma_f32_16x16x32_bf16 v[156:159], a[0:3], v[152:155], v[20:23]
s_waitcnt lgkmcnt(4)
v_mfma_f32_16x16x32_bf16 v[172:175], a[8:11], v[168:171], v[252:255]
v_cvt_pk_bf16_f32 v52, v52, v53
v_cvt_pk_bf16_f32 v53, v54, v55
v_cvt_pk_bf16_f32 v54, v116, v117
v_cvt_pk_bf16_f32 v55, v118, v119
v_pk_mul_f32 v[68:69], v[68:69], s[68:69]
v_pk_mul_f32 v[70:71], v[70:71], s[68:69]
v_pk_mul_f32 v[132:133], v[132:133], s[68:69]
v_pk_mul_f32 v[134:135], v[134:135], s[68:69]
v_max3_f32 v120, v188, v189, v190
v_max3_f32 v120, v120, v191, v156
v_max3_f32 v120, v120, v157, v158
v_max_f32 v120, v120, v159
v_max3_f32 v122, v204, v205, v206
v_max3_f32 v122, v122, v207, v172
v_max3_f32 v122, v122, v173, v174
v_max_f32 v122, v122, v175
v_mov_b32 v104, v120
v_mov_b32 v106, v122
v_cvt_pk_bf16_f32 v68, v68, v69
v_permlane16_swap_b32 v104, v120
v_permlane16_swap_b32 v106, v122
v_max_f32 v120, v120, v104
v_max_f32 v122, v122, v106
v_mov_b32 v104, v120
v_mov_b32 v106, v122
v_cvt_pk_bf16_f32 v69, v70, v71
v_permlane32_swap_b32 v104, v120
v_permlane32_swap_b32 v106, v122
v_max_f32 v120, v120, v104
v_max_f32 v122, v122, v106
v_mul_f32 v120, s66, v120
v_mul_f32 v122, s66, v122
v_fma_f32 v156, v156, s66, -v120
v_fma_f32 v157, v157, s66, -v120
v_fma_f32 v158, v158, s66, -v120
v_fma_f32 v159, v159, s66, -v120
v_fma_f32 v188, v188, s66, -v120
v_fma_f32 v189, v189, s66, -v120
v_fma_f32 v190, v190, s66, -v120
v_fma_f32 v191, v191, s66, -v120
v_exp_f32 v156, v156
v_exp_f32 v157, v157
v_exp_f32 v158, v158
v_exp_f32 v159, v159
v_exp_f32 v188, v188
v_exp_f32 v189, v189
v_exp_f32 v190, v190
v_exp_f32 v191, v191
v_cvt_pk_bf16_f32 v156, v156, v157
v_cvt_pk_bf16_f32 v157, v158, v159
v_cvt_pk_bf16_f32 v158, v188, v189
v_cvt_pk_bf16_f32 v159, v190, v191
v_cvt_pk_bf16_f32 v70, v132, v133
v_cvt_pk_bf16_f32 v71, v134, v135
v_mfma_f32_16x16x32_bf16 v[188:191], a[244:247], v[156:159], 0
s_waitcnt lgkmcnt(3)
v_mfma_f32_16x16x32_bf16 v[152:155], v[216:219], v[156:159], 0
s_waitcnt lgkmcnt(2)
v_mfma_f32_16x16x32_bf16 v[184:187], v[220:223], v[156:159], 0
v_fma_f32 v172, v172, s66, -v122
v_fma_f32 v173, v173, s66, -v122
v_fma_f32 v174, v174, s66, -v122
v_fma_f32 v175, v175, s66, -v122
v_fma_f32 v204, v204, s66, -v122
v_fma_f32 v205, v205, s66, -v122
v_fma_f32 v206, v206, s66, -v122
v_fma_f32 v207, v207, s66, -v122
v_exp_f32 v172, v172
v_exp_f32 v173, v173
v_exp_f32 v174, v174
v_exp_f32 v175, v175
v_exp_f32 v204, v204
v_exp_f32 v205, v205
v_exp_f32 v206, v206
v_exp_f32 v207, v207
v_cvt_pk_bf16_f32 v172, v172, v173
v_cvt_pk_bf16_f32 v173, v174, v175
v_cvt_pk_bf16_f32 v174, v204, v205
v_cvt_pk_bf16_f32 v175, v206, v207
v_pk_mul_f32 v[84:85], v[84:85], s[68:69]
v_pk_mul_f32 v[86:87], v[86:87], s[68:69]
v_mfma_f32_16x16x32_bf16 v[204:207], a[244:247], v[172:175], 0
s_waitcnt lgkmcnt(1)
v_mfma_f32_16x16x32_bf16 v[168:171], v[232:235], v[172:175], 0
s_waitcnt lgkmcnt(0)
v_mfma_f32_16x16x32_bf16 v[200:203], v[236:239], v[172:175], 0
v_pk_mul_f32 v[148:149], v[148:149], s[68:69]
v_pk_mul_f32 v[150:151], v[150:151], s[68:69]
v_cvt_pk_bf16_f32 v84, v84, v85
v_cvt_pk_bf16_f32 v85, v86, v87
v_cvt_pk_bf16_f32 v86, v148, v149
v_cvt_pk_bf16_f32 v87, v150, v151
v_rcp_f32 v120, v188
v_rcp_f32 v122, v204
v_mul_f32 v120, v120, v5
v_mul_f32 v122, v122, v9
v_mul_f32 v152, v152, v120
v_mul_f32 v153, v153, v120
v_mul_f32 v154, v154, v120
v_mul_f32 v155, v155, v120
v_mul_f32 v184, v184, v120
v_mul_f32 v185, v185, v120
v_mul_f32 v186, v186, v120
v_mul_f32 v187, v187, v120
v_cvt_pk_bf16_f32 v152, v152, v153
v_cvt_pk_bf16_f32 v153, v154, v155
v_cvt_pk_bf16_f32 v154, v184, v185
v_cvt_pk_bf16_f32 v155, v186, v187
buffer_store_dwordx4 v[152:155], v16, s[44:47], s64 offen sc1
v_mul_f32 v168, v168, v122
v_mul_f32 v169, v169, v122
v_mul_f32 v170, v170, v122
v_mul_f32 v171, v171, v122
v_mul_f32 v200, v200, v122
v_mul_f32 v201, v201, v122
v_mul_f32 v202, v202, v122
v_mul_f32 v203, v203, v122
v_cvt_pk_bf16_f32 v168, v168, v169
v_cvt_pk_bf16_f32 v169, v170, v171
v_cvt_pk_bf16_f32 v170, v200, v201
v_cvt_pk_bf16_f32 v171, v202, v203
buffer_store_dwordx4 v[168:171], v16, s[44:47], s65 offen sc1
v_mov_b32 v17, 0xff800000
v_and_b32 v5, 1, v0
v_mul_u32_u24 v5, 0xaaaa, v5
v_add_u32 v5, 0x4444, v5
v_lshl_or_b32 v5, v5, 16, v5
L_attstart_7:
v_mov_b32 v2, v16
v_add_u32 v3, 0x10000, v16
v_mov_b32 v1, 0
s_waitcnt lgkmcnt(0)
s_barrier
s_cmp_eq_u32 s3, 0
s_cbranch_scc1 L_F1
ds_read_b128 a[144:147], v2 offset:0
ds_read_b128 a[148:151], v2 offset:1024
ds_read_b128 a[152:155], v2 offset:2048
ds_read_b128 a[156:159], v2 offset:3072
ds_read_b128 a[160:163], v2 offset:4096
ds_read_b128 a[164:167], v2 offset:5120
ds_read_b128 a[168:171], v2 offset:6144
ds_read_b128 a[172:175], v2 offset:7168
s_mov_b32 m0, s71
s_nop 0
buffer_load_dwordx4 v16, s[32:35], s70 offen offset:0 sc1 lds
buffer_load_dwordx4 v16, s[32:35], s70 offen offset:1024 sc1 lds
s_waitcnt lgkmcnt(7)
v_mfma_f32_16x16x32_bf16 v[88:91], a[144:147], v[24:27], 0
s_waitcnt lgkmcnt(6)
ds_read_b128 a[176:179], v2 offset:8192
v_accvgpr_write_b32 a128, 0
v_mfma_f32_16x16x32_bf16 v[88:91], a[148:151], v[28:31], v[88:91]
s_waitcnt lgkmcnt(6)
ds_read_b128 a[180:183], v2 offset:9216
v_accvgpr_write_b32 a129, 0
v_mfma_f32_16x16x32_bf16 v[88:91], a[152:155], v[32:35], v[88:91]
s_waitcnt lgkmcnt(6)
buffer_load_dwordx4 v16, s[32:35], s70 offen offset:2048 sc1 lds
v_mfma_f32_16x16x32_bf16 v[88:91], a[156:159], v[36:39], v[88:91]
ds_read_b128 a[184:187], v2 offset:10240
v_accvgpr_write_b32 a130, 0
v_mfma_f32_16x16x32_bf16 v[104:107], a[156:159], v[52:55], 0
ds_read_b128 a[188:191], v2 offset:11264
v_accvgpr_write_b32 a131, 0
v_mfma_f32_16x16x32_bf16 v[104:107], a[152:155], v[48:51], v[104:107]
ds_read_b128 a[192:195], v2 offset:12288
v_accvgpr_write_b32 a132, 0
v_mfma_f32_16x16x32_bf16 v[104:107], a[148:151], v[44:47], v[104:107]
ds_read_b128 a[196:199], v2 offset:13312
v_accvgpr_write_b32 a133, 0
v_mfma_f32_16x16x32_bf16 v[104:107], a[144:147], v[40:43], v[104:107]
ds_read_b128 a[200:203], v2 offset:14336
v_accvgpr_write_b32 a134, 0
v_mfma_f32_16x16x32_bf16 v[120:123], a[144:147], v[56:59], 0
ds_read_b128 a[204:207], v2 offset:15360
v_accvgpr_write_b32 a135, 0
v_mfma_f32_16x16x32_bf16 v[120:123], a[148:151], v[60:63], v[120:123]
buffer_load_dwordx4 v16, s[32:35], s70 offen offset:3072 sc1 lds
v_mfma_f32_16x16x32_bf16 v[120:123], a[152:155], v[64:67], v[120:123]
v_accvgpr_write_b32 a136, 0
v_accvgpr_write_b32 a137, 0
v_mfma_f32_16x16x32_bf16 v[120:123], a[156:159], v[68:71], v[120:123]
v_accvgpr_write_b32 a138, 0
v_accvgpr_write_b32 a139, 0
v_mfma_f32_16x16x32_bf16 v[136:139], a[156:159], v[84:87], 0
v_accvgpr_write_b32 a140, 0
v_accvgpr_write_b32 a141, 0
v_mfma_f32_16x16x32_bf16 v[136:139], a[152:155], v[80:83], v[136:139]
v_accvgpr_write_b32 a142, 0
v_accvgpr_write_b32 a143, 0
v_mfma_f32_16x16x32_bf16 v[136:139], a[148:151], v[76:79], v[136:139]
v_mfma_f32_16x16x32_bf16 v[136:139], a[144:147], v[72:75], v[136:139]
s_waitcnt lgkmcnt(0)
s_nop 1
v_max3_f32 v20, v88, v89, v90
v_max_f32 v20, v20, v91
v_max3_f32 v21, v104, v105, v106
v_max_f32 v21, v21, v107
v_max3_f32 v22, v120, v121, v122
v_max_f32 v22, v22, v123
v_max3_f32 v23, v136, v137, v138
v_max_f32 v23, v23, v139
v_mov_b32 v248, v20
v_mov_b32 v249, v21
v_mov_b32 v250, v22
v_mov_b32 v251, v23
v_permlane16_swap_b32 v248, v20
v_permlane16_swap_b32 v249, v21
v_permlane16_swap_b32 v250, v22
v_permlane16_swap_b32 v251, v23
v_max_f32 v20, v20, v248
v_max_f32 v21, v21, v249
v_max_f32 v22, v22, v250
v_max_f32 v23, v23, v251
v_mov_b32 v248, v20
v_mov_b32 v249, v21
v_mov_b32 v250, v22
v_mov_b32 v251, v23
v_permlane32_swap_b32 v248, v20
v_permlane32_swap_b32 v249, v21
v_permlane32_swap_b32 v250, v22
v_permlane32_swap_b32 v251, v23
v_max_f32 v20, v20, v248
v_max_f32 v21, v21, v249
v_max_f32 v22, v22, v250
v_max_f32 v23, v23, v251
s_cmp_eq_u32 s73, 0
s_cselect_b64 vcc, 0, -1
v_cndmask_b32 v20, v20, v252, vcc
v_cndmask_b32 v21, v21, v253, vcc
v_cndmask_b32 v22, v22, v254, vcc
v_cndmask_b32 v23, v23, v255, vcc
v_sub_f32 v228, 0, v23
v_sub_f32 v229, 0, v23
v_sub_f32 v230, 0, v23
v_sub_f32 v231, 0, v23
v_sub_f32 v224, 0, v22
v_sub_f32 v225, 0, v22
v_sub_f32 v226, 0, v22
v_sub_f32 v227, 0, v22
v_sub_f32 v220, 0, v21
v_sub_f32 v221, 0, v21
v_sub_f32 v222, 0, v21
v_sub_f32 v223, 0, v21
v_sub_f32 v216, 0, v20
v_sub_f32 v217, 0, v20
v_sub_f32 v218, 0, v20
v_sub_f32 v219, 0, v20
v_mfma_f32_16x16x32_bf16 v[140:143], a[160:163], v[72:75], v[228:231]
s_add_u32 m0, s71, 4096
v_add_f32 v88, v88, v216
v_add_f32 v89, v89, v216
v_mfma_f32_16x16x32_bf16 v[140:143], a[164:167], v[76:79], v[140:143]
v_add_f32 v90, v90, v216
v_add_f32 v91, v91, v216
v_exp_f32 v88, v88
v_mfma_f32_16x16x32_bf16 v[140:143], a[168:171], v[80:83], v[140:143]
s_add_u32 s64, s70, 4096
v_exp_f32 v89, v89
v_mfma_f32_16x16x32_bf16 v[140:143], a[172:175], v[84:87], v[140:143]
buffer_load_dwordx4 v16, s[32:35], s64 offen offset:0 sc1 lds
v_mfma_f32_16x16x32_bf16 v[124:127], a[172:175], v[68:71], v[224:227]
v_exp_f32 v90, v90
v_mfma_f32_16x16x32_bf16 v[124:127], a[168:171], v[64:67], v[124:127]
v_exp_f32 v91, v91
v_mfma_f32_16x16x32_bf16 v[124:127], a[164:167], v[60:63], v[124:127]
v_add_f32 v104, v104, v220
v_add_f32 v105, v105, v220
v_add_f32 v106, v106, v220
v_add_f32 v107, v107, v220
v_exp_f32 v104, v104
v_mfma_f32_16x16x32_bf16 v[124:127], a[160:163], v[56:59], v[124:127]
v_exp_f32 v105, v105
v_mfma_f32_16x16x32_bf16 v[108:111], a[160:163], v[40:43], v[220:223]
v_exp_f32 v106, v106
v_mfma_f32_16x16x32_bf16 v[108:111], a[164:167], v[44:47], v[108:111]
buffer_load_dwordx4 v16, s[32:35], s64 offen offset:1024 sc1 lds
v_mfma_f32_16x16x32_bf16 v[108:111], a[168:171], v[48:51], v[108:111]
v_cvt_pk_bf16_f32 v152, v88, v89
v_add_f32 v120, v120, v224
v_mfma_f32_16x16x32_bf16 v[108:111], a[172:175], v[52:55], v[108:111]
v_exp_f32 v107, v107
v_mfma_f32_16x16x32_bf16 v[92:95], a[172:175], v[36:39], v[216:219]
v_add_f32 v121, v121, v224
v_add_f32 v122, v122, v224
v_add_f32 v123, v123, v224
v_exp_f32 v120, v120
v_mfma_f32_16x16x32_bf16 v[92:95], a[168:171], v[32:35], v[92:95]
v_cvt_pk_bf16_f32 v153, v90, v91
v_exp_f32 v121, v121
v_mfma_f32_16x16x32_bf16 v[92:95], a[164:167], v[28:31], v[92:95]
v_exp_f32 v122, v122
v_mfma_f32_16x16x32_bf16 v[92:95], a[160:163], v[24:27], v[92:95]
v_exp_f32 v123, v123
v_mfma_f32_16x16x32_bf16 v[96:99], a[176:179], v[24:27], v[216:219]
v_cvt_pk_bf16_f32 v160, v104, v105
v_add_f32 v136, v136, v228
v_mfma_f32_16x16x32_bf16 v[96:99], a[180:183], v[28:31], v[96:99]
buffer_load_dwordx4 v16, s[32:35], s64 offen offset:2048 sc1 lds
v_add_f32 v137, v137, v228
v_add_f32 v138, v138, v228
v_add_f32 v139, v139, v228
v_exp_f32 v136, v136
v_mfma_f32_16x16x32_bf16 v[96:99], a[184:187], v[32:35], v[96:99]
v_exp_f32 v137, v137
v_mfma_f32_16x16x32_bf16 v[96:99], a[188:191], v[36:39], v[96:99]
v_cvt_pk_bf16_f32 v161, v106, v107
v_cvt_pk_bf16_f32 v184, v120, v121
v_mfma_f32_16x16x32_bf16 v[112:115], a[188:191], v[52:55], v[220:223]
v_exp_f32 v138, v138
v_mfma_f32_16x16x32_bf16 v[112:115], a[184:187], v[48:51], v[112:115]
v_exp_f32 v139, v139
v_mfma_f32_16x16x32_bf16 v[112:115], a[180:183], v[44:47], v[112:115]
v_exp_f32 v140, v140
v_mfma_f32_16x16x32_bf16 v[112:115], a[176:179], v[40:43], v[112:115]
v_exp_f32 v141, v141
v_mfma_f32_16x16x32_bf16 v[128:131], a[176:179], v[56:59], v[224:227]
buffer_load_dwordx4 v16, s[32:35], s64 offen offset:3072 sc1 lds
v_cvt_pk_bf16_f32 v185, v122, v123
v_mfma_f32_16x16x32_bf16 v[128:131], a[180:183], v[60:63], v[128:131]
v_exp_f32 v142, v142
v_mfma_f32_16x16x32_bf16 v[128:131], a[184:187], v[64:67], v[128:131]
v_exp_f32 v143, v143
v_mfma_f32_16x16x32_bf16 v[128:131], a[188:191], v[68:71], v[128:131]
v_cvt_pk_bf16_f32 v192, v136, v137
v_cvt_pk_bf16_f32 v193, v138, v139
v_mfma_f32_16x16x32_bf16 v[144:147], a[188:191], v[84:87], v[228:231]
v_exp_f32 v124, v124
v_mfma_f32_16x16x32_bf16 v[144:147], a[184:187], v[80:83], v[144:147]
v_exp_f32 v125, v125
v_mfma_f32_16x16x32_bf16 v[144:147], a[180:183], v[76:79], v[144:147]
s_waitcnt vmcnt(8)
s_barrier
v_mfma_f32_16x16x32_bf16 v[144:147], a[176:179], v[72:75], v[144:147]
v_exp_f32 v126, v126
v_mfma_f32_16x16x32_bf16 v[148:151], a[192:195], v[72:75], v[228:231]
v_cvt_pk_bf16_f32 v194, v140, v141
v_cvt_pk_bf16_f32 v195, v142, v143
v_mfma_f32_16x16x32_bf16 v[148:151], a[196:199], v[76:79], v[148:151]
v_exp_f32 v127, v127
v_mfma_f32_16x16x32_bf16 v[148:151], a[200:203], v[80:83], v[148:151]
s_xor_b32 s71, s71, 16384
v_exp_f32 v108, v108
v_mfma_f32_16x16x32_bf16 v[148:151], a[204:207], v[84:87], v[148:151]
s_add_u32 s70, s70, 32768
v_exp_f32 v109, v109
v_mfma_f32_16x16x32_bf16 v[132:135], a[204:207], v[68:71], v[224:227]
s_mov_b32 m0, s71
v_exp_f32 v110, v110
v_mfma_f32_16x16x32_bf16 v[132:135], a[200:203], v[64:67], v[132:135]
buffer_load_dwordx4 v16, s[32:35], s70 offen offset:0 sc1 lds
v_mfma_f32_16x16x32_bf16 v[132:135], a[196:199], v[60:63], v[132:135]
v_cvt_pk_bf16_f32 v186, v124, v125
v_exp_f32 v111, v111
v_mfma_f32_16x16x32_bf16 v[132:135], a[192:195], v[56:59], v[132:135]
v_exp_f32 v92, v92
v_mfma_f32_16x16x32_bf16 v[116:119], a[192:195], v[40:43], v[220:223]
v_exp_f32 v93, v93
v_mfma_f32_16x16x32_bf16 v[116:119], a[196:199], v[44:47], v[116:119]
ds_read_b128 a[144:147], v2 offset:16384
v_cvt_pk_bf16_f32 v187, v126, v127
v_mfma_f32_16x16x32_bf16 v[116:119], a[200:203], v[48:51], v[116:119]
v_exp_f32 v94, v94
v_mfma_f32_16x16x32_bf16 v[116:119], a[204:207], v[52:55], v[116:119]
ds_read_b128 a[148:151], v2 offset:17408
v_cvt_pk_bf16_f32 v162, v108, v109
v_mfma_f32_16x16x32_bf16 v[100:103], a[204:207], v[36:39], v[216:219]
ds_read_b128 a[152:155], v2 offset:18432
buffer_load_dwordx4 v16, s[32:35], s70 offen offset:1024 sc1 lds
v_exp_f32 v95, v95
v_mfma_f32_16x16x32_bf16 v[100:103], a[200:203], v[32:35], v[100:103]
ds_read_b128 a[156:159], v2 offset:19456
v_exp_f32 v96, v96
v_mfma_f32_16x16x32_bf16 v[100:103], a[196:199], v[28:31], v[100:103]
v_cvt_pk_bf16_f32 v163, v110, v111
v_exp_f32 v97, v97
v_mfma_f32_16x16x32_bf16 v[100:103], a[192:195], v[24:27], v[100:103]
s_waitcnt lgkmcnt(3)
ds_read_b128 a[160:163], v2 offset:20480
ds_read_b128 a[164:167], v2 offset:21504
ds_read_b128 a[168:171], v2 offset:22528
ds_read_b128 a[172:175], v2 offset:23552
v_mfma_f32_16x16x32_bf16 v[88:91], a[144:147], v[24:27], v[216:219]
s_waitcnt lgkmcnt(6)
v_exp_f32 v98, v98
v_mfma_f32_16x16x32_bf16 v[88:91], a[148:151], v[28:31], v[88:91]
s_waitcnt lgkmcnt(5)
v_cvt_pk_bf16_f32 v154, v92, v93
v_exp_f32 v99, v99
v_mfma_f32_16x16x32_bf16 v[88:91], a[152:155], v[32:35], v[88:91]
s_waitcnt lgkmcnt(4)
v_exp_f32 v112, v112
v_mfma_f32_16x16x32_bf16 v[88:91], a[156:159], v[36:39], v[88:91]
v_exp_f32 v113, v113
v_mfma_f32_16x16x32_bf16 v[104:107], a[156:159], v[52:55], v[220:223]
v_cvt_pk_bf16_f32 v155, v94, v95
v_cvt_pk_bf16_f32 v156, v96, v97
v_mfma_f32_16x16x32_bf16 v[104:107], a[152:155], v[48:51], v[104:107]
buffer_load_dwordx4 v16, s[32:35], s70 offen offset:2048 sc1 lds
v_exp_f32 v114, v114
v_mfma_f32_16x16x32_bf16 v[104:107], a[148:151], v[44:47], v[104:107]
v_exp_f32 v115, v115
v_mfma_f32_16x16x32_bf16 v[104:107], a[144:147], v[40:43], v[104:107]
v_exp_f32 v128, v128
v_mfma_f32_16x16x32_bf16 v[120:123], a[144:147], v[56:59], v[224:227]
v_exp_f32 v129, v129
v_mfma_f32_16x16x32_bf16 v[120:123], a[148:151], v[60:63], v[120:123]
v_cvt_pk_bf16_f32 v157, v98, v99
v_cvt_pk_bf16_f32 v164, v112, v113
v_mfma_f32_16x16x32_bf16 v[120:123], a[152:155], v[64:67], v[120:123]
v_exp_f32 v130, v130
v_mfma_f32_16x16x32_bf16 v[120:123], a[156:159], v[68:71], v[120:123]
v_exp_f32 v131, v131
v_mfma_f32_16x16x32_bf16 v[136:139], a[156:159], v[84:87], v[228:231]
v_exp_f32 v144, v144
v_mfma_f32_16x16x32_bf16 v[136:139], a[152:155], v[80:83], v[136:139]
v_exp_f32 v145, v145
v_mfma_f32_16x16x32_bf16 v[136:139], a[148:151], v[76:79], v[136:139]
v_exp_f32 v146, v146
v_mfma_f32_16x16x32_bf16 v[136:139], a[144:147], v[72:75], v[136:139]
s_waitcnt lgkmcnt(0)
v_cvt_pk_bf16_f32 v165, v114, v115
v_cvt_pk_bf16_f32 v188, v128, v129
v_mfma_f32_16x16x32_bf16 v[140:143], a[160:163], v[72:75], v[228:231]
v_exp_f32 v147, v147
v_mfma_f32_16x16x32_bf16 v[140:143], a[164:167], v[76:79], v[140:143]
v_exp_f32 v148, v148
v_mfma_f32_16x16x32_bf16 v[140:143], a[168:171], v[80:83], v[140:143]
v_exp_f32 v149, v149
v_mfma_f32_16x16x32_bf16 v[140:143], a[172:175], v[84:87], v[140:143]
buffer_load_dwordx4 v16, s[32:35], s70 offen offset:3072 sc1 lds
v_mfma_f32_16x16x32_bf16 v[124:127], a[172:175], v[68:71], v[224:227]
v_cvt_pk_bf16_f32 v189, v130, v131
v_cvt_pk_bf16_f32 v196, v144, v145
v_mfma_f32_16x16x32_bf16 v[124:127], a[168:171], v[64:67], v[124:127]
v_exp_f32 v150, v150
v_mfma_f32_16x16x32_bf16 v[124:127], a[164:167], v[60:63], v[124:127]
v_exp_f32 v151, v151
v_mfma_f32_16x16x32_bf16 v[124:127], a[160:163], v[56:59], v[124:127]
v_exp_f32 v132, v132
v_mfma_f32_16x16x32_bf16 v[108:111], a[160:163], v[40:43], v[220:223]
ds_read_b128 a[176:179], v2 offset:24576
v_cvt_pk_bf16_f32 v197, v146, v147
v_mfma_f32_16x16x32_bf16 v[108:111], a[164:167], v[44:47], v[108:111]
ds_read_b128 a[180:183], v2 offset:25600
v_cvt_pk_bf16_f32 v198, v148, v149
v_mfma_f32_16x16x32_bf16 v[108:111], a[168:171], v[48:51], v[108:111]
ds_read_b128 a[184:187], v2 offset:26624
v_exp_f32 v133, v133
v_mfma_f32_16x16x32_bf16 v[108:111], a[172:175], v[52:55], v[108:111]
ds_read_b128 a[188:191], v2 offset:27648
v_exp_f32 v134, v134
v_mfma_f32_16x16x32_bf16 v[92:95], a[172:175], v[36:39], v[216:219]
v_exp_f32 v135, v135
v_mfma_f32_16x16x32_bf16 v[92:95], a[168:171], v[32:35], v[92:95]
v_exp_f32 v116, v116
v_mfma_f32_16x16x32_bf16 v[92:95], a[164:167], v[28:31], v[92:95]
v_exp_f32 v117, v117
v_mfma_f32_16x16x32_bf16 v[92:95], a[160:163], v[24:27], v[92:95]
s_waitcnt lgkmcnt(2)
v_cvt_pk_bf16_f32 v199, v150, v151
v_cvt_pk_bf16_f32 v190, v132, v133
v_mfma_f32_16x16x32_bf16 v[96:99], a[176:179], v[24:27], v[216:219]
v_exp_f32 v118, v118
v_mfma_f32_16x16x32_bf16 v[96:99], a[180:183], v[28:31], v[96:99]
s_waitcnt lgkmcnt(0)
s_add_u32 m0, s71, 4096
v_exp_f32 v119, v119
v_mfma_f32_16x16x32_bf16 v[96:99], a[184:187], v[32:35], v[96:99]
s_add_u32 s64, s70, 4096
v_exp_f32 v100, v100
v_mfma_f32_16x16x32_bf16 v[96:99], a[188:191], v[36:39], v[96:99]
buffer_load_dwordx4 v16, s[32:35], s64 offen offset:0 sc1 lds
v_mfma_f32_16x16x32_bf16 v[112:115], a[188:191], v[52:55], v[220:223]
v_exp_f32 v101, v101
v_mfma_f32_16x16x32_bf16 v[112:115], a[184:187], v[48:51], v[112:115]
v_cvt_pk_bf16_f32 v191, v134, v135
v_cvt_pk_bf16_f32 v166, v116, v117
v_mfma_f32_16x16x32_bf16 v[112:115], a[180:183], v[44:47], v[112:115]
v_exp_f32 v102, v102
v_mfma_f32_16x16x32_bf16 v[112:115], a[176:179], v[40:43], v[112:115]
v_exp_f32 v103, v103
v_mfma_f32_16x16x32_bf16 v[128:131], a[176:179], v[56:59], v[224:227]
s_lshl_b32 s66, s30, 30
ds_read_b128 a[192:195], v2 offset:28672
v_cvt_pk_bf16_f32 v167, v118, v119
v_mfma_f32_16x16x32_bf16 v[128:131], a[180:183], v[60:63], v[128:131]
ds_read_b128 a[196:199], v2 offset:29696
v_exp_f32 v88, v88
v_mfma_f32_16x16x32_bf16 v[128:131], a[184:187], v[64:67], v[128:131]
ds_read_b128 a[200:203], v2 offset:30720
v_exp_f32 v89, v89
v_mfma_f32_16x16x32_bf16 v[128:131], a[188:191], v[68:71], v[128:131]
ds_read_b128 a[204:207], v2 offset:31744
v_cvt_pk_bf16_f32 v158, v100, v101
v_mfma_f32_16x16x32_bf16 v[144:147], a[188:191], v[84:87], v[228:231]
v_exp_f32 v90, v90
v_mfma_f32_16x16x32_bf16 v[144:147], a[184:187], v[80:83], v[144:147]
v_exp_f32 v91, v91
v_mfma_f32_16x16x32_bf16 v[144:147], a[180:183], v[76:79], v[144:147]
v_exp_f32 v104, v104
v_mfma_f32_16x16x32_bf16 v[144:147], a[176:179], v[72:75], v[144:147]
s_waitcnt lgkmcnt(2)
v_exp_f32 v105, v105
v_mfma_f32_16x16x32_bf16 v[148:151], a[192:195], v[72:75], v[228:231]
v_cvt_pk_bf16_f32 v159, v102, v103
v_cvt_pk_bf16_f32 v168, v88, v89
v_mfma_f32_16x16x32_bf16 v[148:151], a[196:199], v[76:79], v[148:151]
s_waitcnt lgkmcnt(0)
v_exp_f32 v106, v106
v_mfma_f32_16x16x32_bf16 v[148:151], a[200:203], v[80:83], v[148:151]
v_exp_f32 v107, v107
v_mfma_f32_16x16x32_bf16 v[148:151], a[204:207], v[84:87], v[148:151]
buffer_load_dwordx4 v16, s[32:35], s64 offen offset:1024 sc1 lds
v_mfma_f32_16x16x32_bf16 v[132:135], a[204:207], v[68:71], v[224:227]
v_exp_f32 v120, v120
v_mfma_f32_16x16x32_bf16 v[132:135], a[200:203], v[64:67], v[132:135]
v_cvt_pk_bf16_f32 v169, v90, v91
v_cvt_pk_bf16_f32 v176, v104, v105
v_mfma_f32_16x16x32_bf16 v[132:135], a[196:199], v[60:63], v[132:135]
v_exp_f32 v121, v121
v_mfma_f32_16x16x32_bf16 v[132:135], a[192:195], v[56:59], v[132:135]
v_exp_f32 v122, v122
v_mfma_f32_16x16x32_bf16 v[116:119], a[192:195], v[40:43], v[220:223]
v_exp_f32 v123, v123
v_mfma_f32_16x16x32_bf16 v[116:119], a[196:199], v[44:47], v[116:119]
v_exp_f32 v136, v136
v_mfma_f32_16x16x32_bf16 v[116:119], a[200:203], v[48:51], v[116:119]
v_exp_f32 v137, v137
v_mfma_f32_16x16x32_bf16 v[116:119], a[204:207], v[52:55], v[116:119]
ds_read_b128 a[144:147], v3 offset:16384
v_cvt_pk_bf16_f32 v177, v106, v107
v_mfma_f32_16x16x32_bf16 v[100:103], a[204:207], v[36:39], v[216:219]
s_branch L_po15
L_pg15:
s_branch L_pg19
L_po15:
v_exp_f32 v138, v138
v_mfma_f32_16x16x32_bf16 v[100:103], a[200:203], v[32:35], v[100:103]
ds_read_b128 a[148:151], v3 offset:24576
v_cvt_pk_bf16_f32 v200, v120, v121
v_mfma_f32_16x16x32_bf16 v[100:103], a[196:199], v[28:31], v[100:103]
v_exp_f32 v139, v139
v_mfma_f32_16x16x32_bf16 v[100:103], a[192:195], v[24:27], v[100:103]
v_exp_f32 v140, v140
v_smfmac_f32_16x16x64_bf16 a[128:131], a[240:243], v[152:159], v5
v_cvt_pk_bf16_f32 v201, v122, v123
v_smfmac_f32_16x16x64_bf16 a[132:135], a[240:243], v[160:167], v5
v_exp_f32 v141, v141
v_smfmac_f32_16x16x64_bf16 a[136:139], a[240:243], v[184:191], v5
v_exp_f32 v142, v142
v_smfmac_f32_16x16x64_bf16 a[140:143], a[240:243], v[192:199], v5
s_waitcnt lgkmcnt(0)
buffer_load_dwordx4 v16, s[32:35], s64 offen offset:2048 sc1 lds
v_cvt_pk_bf16_f32 v208, v136, v137
v_mfma_f32_16x16x32_bf16 a[0:3], a[144:147], v[152:155], 0
ds_read_b128 a[152:155], v3 offset:17408
v_exp_f32 v143, v143
v_mfma_f32_16x16x32_bf16 a[0:3], a[148:151], v[156:159], a[0:3]
ds_read_b128 a[156:159], v3 offset:25600
v_exp_f32 v124, v124
v_mfma_f32_16x16x32_bf16 a[32:35], a[148:151], v[164:167], 0
v_cvt_pk_bf16_f32 v209, v138, v139
v_exp_f32 v125, v125
v_mfma_f32_16x16x32_bf16 a[32:35], a[144:147], v[160:163], a[32:35]
v_exp_f32 v126, v126
v_mfma_f32_16x16x32_bf16 a[64:67], a[144:147], v[184:187], 0
v_exp_f32 v127, v127
v_mfma_f32_16x16x32_bf16 a[64:67], a[148:151], v[188:191], a[64:67]
v_cvt_pk_bf16_f32 v210, v140, v141
v_cvt_pk_bf16_f32 v211, v142, v143
v_mfma_f32_16x16x32_bf16 a[96:99], a[148:151], v[196:199], 0
v_exp_f32 v108, v108
v_mfma_f32_16x16x32_bf16 a[96:99], a[144:147], v[192:195], a[96:99]
s_waitcnt lgkmcnt(0)
v_exp_f32 v109, v109
v_mfma_f32_16x16x32_bf16 a[100:103], a[152:155], v[192:195], 0
ds_read_b128 a[160:163], v3 offset:18432
v_cvt_pk_bf16_f32 v202, v124, v125
v_mfma_f32_16x16x32_bf16 a[100:103], a[156:159], v[196:199], a[100:103]
ds_read_b128 a[164:167], v3 offset:26624
v_exp_f32 v110, v110
v_mfma_f32_16x16x32_bf16 a[68:71], a[156:159], v[188:191], 0
v_exp_f32 v111, v111
v_mfma_f32_16x16x32_bf16 a[68:71], a[152:155], v[184:187], a[68:71]
v_exp_f32 v92, v92
v_mfma_f32_16x16x32_bf16 a[36:39], a[152:155], v[160:163], 0
v_exp_f32 v93, v93
v_mfma_f32_16x16x32_bf16 a[36:39], a[156:159], v[164:167], a[36:39]
v_cvt_pk_bf16_f32 v203, v126, v127
v_cvt_pk_bf16_f32 v178, v108, v109
v_mfma_f32_16x16x32_bf16 a[4:7], a[156:159], v[156:159], 0
buffer_load_dwordx4 v16, s[32:35], s64 offen offset:3072 sc1 lds
v_mfma_f32_16x16x32_bf16 a[4:7], a[152:155], v[152:155], a[4:7]
s_waitcnt lgkmcnt(0)
v_exp_f32 v94, v94
v_mfma_f32_16x16x32_bf16 a[8:11], a[160:163], v[152:155], 0
ds_read_b128 a[168:171], v3 offset:19456
v_cvt_pk_bf16_f32 v179, v110, v111
v_mfma_f32_16x16x32_bf16 a[8:11], a[164:167], v[156:159], a[8:11]
ds_read_b128 a[172:175], v3 offset:27648
v_exp_f32 v95, v95
v_mfma_f32_16x16x32_bf16 a[40:43], a[164:167], v[164:167], 0
v_exp_f32 v96, v96
v_mfma_f32_16x16x32_bf16 a[40:43], a[160:163], v[160:163], a[40:43]
v_exp_f32 v97, v97
v_mfma_f32_16x16x32_bf16 a[72:75], a[160:163], v[184:187], 0
v_exp_f32 v98, v98
v_mfma_f32_16x16x32_bf16 a[72:75], a[164:167], v[188:191], a[72:75]
v_exp_f32 v99, v99
v_mfma_f32_16x16x32_bf16 a[104:107], a[164:167], v[196:199], 0
ds_read_b128 a[176:179], v3 offset:20480
v_cvt_pk_bf16_f32 v170, v92, v93
v_mfma_f32_16x16x32_bf16 a[104:107], a[160:163], v[192:195], a[104:107]
s_waitcnt lgkmcnt(1)
v_exp_f32 v112, v112
v_mfma_f32_16x16x32_bf16 a[108:111], a[168:171], v[192:195], 0
v_exp_f32 v113, v113
v_mfma_f32_16x16x32_bf16 a[108:111], a[172:175], v[196:199], a[108:111]
ds_read_b128 a[180:183], v3 offset:28672
v_cvt_pk_bf16_f32 v171, v94, v95
v_mfma_f32_16x16x32_bf16 a[76:79], a[172:175], v[188:191], 0
v_exp_f32 v114, v114
v_mfma_f32_16x16x32_bf16 a[76:79], a[168:171], v[184:187], a[76:79]
v_cvt_pk_bf16_f32 v172, v96, v97
v_xor_b32 v2, 0x8000, v2
v_mfma_f32_16x16x32_bf16 a[44:47], a[168:171], v[160:163], 0
ds_read_b128 a[184:187], v3 offset:21504
ds_read_b128 a[188:191], v3 offset:29696
ds_read_b128 a[192:195], v3 offset:22528
ds_read_b128 a[196:199], v3 offset:30720
ds_read_b128 a[200:203], v3 offset:23552
ds_read_b128 a[204:207], v3 offset:31744
v_exp_f32 v115, v115
v_mfma_f32_16x16x32_bf16 a[44:47], a[172:175], v[164:167], a[44:47]
s_waitcnt vmcnt(8)
s_barrier
v_exp_f32 v128, v128
v_mfma_f32_16x16x32_bf16 a[12:15], a[172:175], v[156:159], 0
v_cvt_pk_bf16_f32 v173, v98, v99
v_cvt_pk_bf16_f32 v180, v112, v113
v_mfma_f32_16x16x32_bf16 a[12:15], a[168:171], v[152:155], a[12:15]
s_waitcnt lgkmcnt(6)
v_exp_f32 v129, v129
v_mfma_f32_16x16x32_bf16 a[16:19], a[176:179], v[152:155], 0
v_exp_f32 v130, v130
v_mfma_f32_16x16x32_bf16 a[16:19], a[180:183], v[156:159], a[16:19]
s_xor_b32 s71, s71, 49152
v_exp_f32 v131, v131
v_mfma_f32_16x16x32_bf16 a[48:51], a[180:183], v[164:167], 0
s_add_u32 s70, s70, 32768
v_exp_f32 v144, v144
v_mfma_f32_16x16x32_bf16 a[48:51], a[176:179], v[160:163], a[48:51]
s_mov_b32 m0, s71
v_exp_f32 v145, v145
v_mfma_f32_16x16x32_bf16 a[80:83], a[176:179], v[184:187], 0
buffer_load_dwordx4 v16, s[32:35], s70 offen offset:0 sc1 lds
v_cvt_pk_bf16_f32 v181, v114, v115
v_mfma_f32_16x16x32_bf16 a[80:83], a[180:183], v[188:191], a[80:83]
v_exp_f32 v146, v146
v_mfma_f32_16x16x32_bf16 a[112:115], a[180:183], v[196:199], 0
v_exp_f32 v147, v147
v_mfma_f32_16x16x32_bf16 a[112:115], a[176:179], v[192:195], a[112:115]
s_waitcnt lgkmcnt(0)
v_cvt_pk_bf16_f32 v204, v128, v129
v_cvt_pk_bf16_f32 v205, v130, v131
v_mfma_f32_16x16x32_bf16 a[116:119], a[184:187], v[192:195], 0
v_exp_f32 v148, v148
v_mfma_f32_16x16x32_bf16 a[116:119], a[188:191], v[196:199], a[116:119]
v_exp_f32 v149, v149
v_mfma_f32_16x16x32_bf16 a[84:87], a[188:191], v[188:191], 0
v_exp_f32 v150, v150
v_mfma_f32_16x16x32_bf16 a[84:87], a[184:187], v[184:187], a[84:87]
v_exp_f32 v151, v151
v_mfma_f32_16x16x32_bf16 a[52:55], a[184:187], v[160:163], 0
v_cvt_pk_bf16_f32 v212, v144, v145
v_cvt_pk_bf16_f32 v213, v146, v147
v_mfma_f32_16x16x32_bf16 a[52:55], a[188:191], v[164:167], a[52:55]
v_exp_f32 v132, v132
v_mfma_f32_16x16x32_bf16 a[20:23], a[188:191], v[156:159], 0
v_exp_f32 v133, v133
v_mfma_f32_16x16x32_bf16 a[20:23], a[184:187], v[152:155], a[20:23]
ds_read_b128 a[144:147], v2 offset:0
v_lshl_add_u32 v19, v0, 24, s66
v_mfma_f32_16x16x32_bf16 a[24:27], a[192:195], v[152:155], 0
s_lshr_b32 s67, s31, 4
v_exp_f32 v134, v134
v_mfma_f32_16x16x32_bf16 a[24:27], a[196:199], v[156:159], a[24:27]
s_lshl1_add_u32 s67, s3, s67
v_exp_f32 v135, v135
v_mfma_f32_16x16x32_bf16 a[56:59], a[196:199], v[164:167], 0
s_lshl_b32 s79, s67, 8
v_cvt_pk_bf16_f32 v214, v148, v149
v_cvt_pk_bf16_f32 v215, v150, v151
v_mfma_f32_16x16x32_bf16 a[56:59], a[192:195], v[160:163], a[56:59]
s_add_u32 s79, s79, 8192
buffer_load_dwordx4 v16, s[32:35], s70 offen offset:1024 sc1 lds
v_mfma_f32_16x16x32_bf16 a[88:91], a[192:195], v[184:187], 0
s_add_u32 s69, s31, 12
v_exp_f32 v116, v116
v_mfma_f32_16x16x32_bf16 a[88:91], a[196:199], v[188:191], a[88:91]
s_lshr_b32 s69, s69, 5
v_exp_f32 v117, v117
v_mfma_f32_16x16x32_bf16 a[120:123], a[196:199], v[196:199], 0
s_lshl1_add_u32 s69, s3, s69
v_exp_f32 v118, v118
v_mfma_f32_16x16x32_bf16 a[120:123], a[192:195], v[192:195], a[120:123]
s_lshl_b32 s69, s69, 8
v_cvt_pk_bf16_f32 v206, v132, v133
v_cvt_pk_bf16_f32 v207, v134, v135
v_mfma_f32_16x16x32_bf16 a[124:127], a[200:203], v[192:195], 0
s_add_u32 s69, s69, 8192
v_exp_f32 v119, v119
v_mfma_f32_16x16x32_bf16 a[124:127], a[204:207], v[196:199], a[124:127]
s_lshl_b32 s67, s73, 16
v_exp_f32 v100, v100
v_mfma_f32_16x16x32_bf16 a[92:95], a[204:207], v[188:191], 0
s_xor_b32 s68, s80, 256
v_exp_f32 v101, v101
v_mfma_f32_16x16x32_bf16 a[92:95], a[200:203], v[184:187], a[92:95]
s_add_u32 s68, s68, s67
ds_read_b128 a[148:151], v2 offset:1024
v_cvt_pk_bf16_f32 v182, v116, v117
v_mfma_f32_16x16x32_bf16 a[60:63], a[200:203], v[160:163], 0
ds_read_b128 a[152:155], v2 offset:2048
v_exp_f32 v102, v102
v_mfma_f32_16x16x32_bf16 a[60:63], a[204:207], v[164:167], a[60:63]
s_add_u32 s67, s67, s69
ds_read_b128 a[156:159], v2 offset:3072
v_cvt_pk_bf16_f32 v183, v118, v119
v_mfma_f32_16x16x32_bf16 a[28:31], a[204:207], v[156:159], 0
s_mov_b64 exec, 1
buffer_atomic_add a251, v19, s[52:55], s67 offen offset:0 sc1
buffer_atomic_add a251, v19, s[52:55], s68 offen offset:0 sc1
s_mov_b64 exec, -1
v_exp_f32 v103, v103
v_mfma_f32_16x16x32_bf16 a[28:31], a[200:203], v[152:155], a[28:31]
ds_read_b128 a[160:163], v2 offset:4096
ds_read_b128 a[164:167], v2 offset:5120
ds_read_b128 a[168:171], v2 offset:6144
ds_read_b128 a[172:175], v2 offset:7168
v_mul_u32_u24 v19, 52, v0
v_cvt_pk_bf16_f32 v174, v100, v101
v_cvt_pk_bf16_f32 v175, v102, v103
v_xor_b32 v3, 0x8000, v3
s_sub_u32 s72, s3, 1
s_cmp_eq_u32 s72, 0
s_cbranch_scc1 L_DD
L_D:
s_waitcnt lgkmcnt(7)
v_mfma_f32_16x16x32_bf16 v[88:91], a[144:147], v[24:27], v[216:219]
s_waitcnt lgkmcnt(6)
ds_read_b128 a[176:179], v2 offset:8192
v_mfma_f32_16x16x32_bf16 v[88:91], a[148:151], v[28:31], v[88:91]
s_waitcnt lgkmcnt(6)
ds_read_b128 a[180:183], v2 offset:9216
v_mfma_f32_16x16x32_bf16 v[88:91], a[152:155], v[32:35], v[88:91]
s_waitcnt lgkmcnt(6)
buffer_load_dwordx4 v16, s[32:35], s70 offen offset:2048 sc1 lds
v_mfma_f32_16x16x32_bf16 v[88:91], a[156:159], v[36:39], v[88:91]
ds_read_b128 a[184:187], v2 offset:10240
v_mfma_f32_16x16x32_bf16 v[104:107], a[156:159], v[52:55], v[220:223]
v_mfma_f32_16x16x32_bf16 v[104:107], a[152:155], v[48:51], v[104:107]
buffer_load_dword a252, v19, s[40:43], s81 offen
v_mfma_f32_16x16x32_bf16 v[104:107], a[148:151], v[44:47], v[104:107]
ds_read_b128 a[188:191], v2 offset:11264
v_mfma_f32_16x16x32_bf16 v[104:107], a[144:147], v[40:43], v[104:107]
v_mfma_f32_16x16x32_bf16 v[120:123], a[144:147], v[56:59], v[224:227]
v_mfma_f32_16x16x32_bf16 v[120:123], a[148:151], v[60:63], v[120:123]
v_mfma_f32_16x16x32_bf16 v[120:123], a[152:155], v[64:67], v[120:123]
v_exp_f32 v88, v88
v_mfma_f32_16x16x32_bf16 v[120:123], a[156:159], v[68:71], v[120:123]
v_exp_f32 v89, v89
v_mfma_f32_16x16x32_bf16 v[136:139], a[156:159], v[84:87], v[228:231]
v_exp_f32 v90, v90
v_mfma_f32_16x16x32_bf16 v[136:139], a[152:155], v[80:83], v[136:139]
v_exp_f32 v91, v91
v_mfma_f32_16x16x32_bf16 v[136:139], a[148:151], v[76:79], v[136:139]
v_exp_f32 v104, v104
v_mfma_f32_16x16x32_bf16 v[136:139], a[144:147], v[72:75], v[136:139]
s_waitcnt lgkmcnt(0)
s_add_u32 s81, s81, 425984
v_exp_f32 v105, v105
v_mfma_f32_16x16x32_bf16 v[140:143], a[160:163], v[72:75], v[228:231]
v_exp_f32 v106, v106
v_mfma_f32_16x16x32_bf16 v[140:143], a[164:167], v[76:79], v[140:143]
buffer_load_dwordx4 v16, s[32:35], s70 offen offset:3072 sc1 lds
v_mfma_f32_16x16x32_bf16 v[140:143], a[168:171], v[80:83], v[140:143]
v_exp_f32 v107, v107
v_mfma_f32_16x16x32_bf16 v[140:143], a[172:175], v[84:87], v[140:143]
v_cvt_pk_bf16_f32 v152, v88, v89
v_cvt_pk_bf16_f32 v153, v90, v91
v_mfma_f32_16x16x32_bf16 v[124:127], a[172:175], v[68:71], v[224:227]
v_exp_f32 v120, v120
v_mfma_f32_16x16x32_bf16 v[124:127], a[168:171], v[64:67], v[124:127]
v_exp_f32 v121, v121
v_mfma_f32_16x16x32_bf16 v[124:127], a[164:167], v[60:63], v[124:127]
v_exp_f32 v122, v122
v_mfma_f32_16x16x32_bf16 v[124:127], a[160:163], v[56:59], v[124:127]
v_exp_f32 v123, v123
v_mfma_f32_16x16x32_bf16 v[108:111], a[160:163], v[40:43], v[220:223]
v_exp_f32 v136, v136
v_mfma_f32_16x16x32_bf16 v[108:111], a[164:167], v[44:47], v[108:111]
v_exp_f32 v137, v137
v_mfma_f32_16x16x32_bf16 v[108:111], a[168:171], v[48:51], v[108:111]
v_exp_f32 v138, v138
v_mfma_f32_16x16x32_bf16 v[108:111], a[172:175], v[52:55], v[108:111]
v_cvt_pk_bf16_f32 v160, v104, v105
v_cvt_pk_bf16_f32 v161, v106, v107
v_mfma_f32_16x16x32_bf16 v[92:95], a[172:175], v[36:39], v[216:219]
v_exp_f32 v139, v139
v_mfma_f32_16x16x32_bf16 v[92:95], a[168:171], v[32:35], v[92:95]
ds_read_b128 a[192:195], v2 offset:12288
v_cvt_pk_bf16_f32 v184, v120, v121
v_mfma_f32_16x16x32_bf16 v[92:95], a[164:167], v[28:31], v[92:95]
v_exp_f32 v140, v140
v_mfma_f32_16x16x32_bf16 v[92:95], a[160:163], v[24:27], v[92:95]
s_add_u32 m0, s71, 4096
ds_read_b128 a[196:199], v2 offset:13312
v_cvt_pk_bf16_f32 v185, v122, v123
v_mfma_f32_16x16x32_bf16 v[96:99], a[176:179], v[24:27], v[216:219]
s_add_u32 s64, s70, 4096
ds_read_b128 a[200:203], v2 offset:14336
v_cvt_pk_bf16_f32 v192, v136, v137
v_mfma_f32_16x16x32_bf16 v[96:99], a[180:183], v[28:31], v[96:99]
buffer_load_dwordx4 v16, s[32:35], s64 offen offset:0 sc1 lds
v_mfma_f32_16x16x32_bf16 v[96:99], a[184:187], v[32:35], v[96:99]
v_exp_f32 v141, v141
v_mfma_f32_16x16x32_bf16 v[96:99], a[188:191], v[36:39], v[96:99]
ds_read_b128 a[204:207], v2 offset:15360
v_cvt_pk_bf16_f32 v193, v138, v139
v_mfma_f32_16x16x32_bf16 v[112:115], a[188:191], v[52:55], v[220:223]
v_exp_f32 v142, v142
v_mfma_f32_16x16x32_bf16 v[112:115], a[184:187], v[48:51], v[112:115]
v_exp_f32 v143, v143
v_mfma_f32_16x16x32_bf16 v[112:115], a[180:183], v[44:47], v[112:115]
v_exp_f32 v124, v124
v_mfma_f32_16x16x32_bf16 v[112:115], a[176:179], v[40:43], v[112:115]
v_exp_f32 v125, v125
v_mfma_f32_16x16x32_bf16 v[128:131], a[176:179], v[56:59], v[224:227]
v_exp_f32 v126, v126
v_mfma_f32_16x16x32_bf16 v[128:131], a[180:183], v[60:63], v[128:131]
v_exp_f32 v127, v127
v_mfma_f32_16x16x32_bf16 v[128:131], a[184:187], v[64:67], v[128:131]
v_exp_f32 v108, v108
v_mfma_f32_16x16x32_bf16 v[128:131], a[188:191], v[68:71], v[128:131]
v_exp_f32 v109, v109
v_mfma_f32_16x16x32_bf16 v[144:147], a[188:191], v[84:87], v[228:231]
v_exp_f32 v110, v110
v_mfma_f32_16x16x32_bf16 v[144:147], a[184:187], v[80:83], v[144:147]
ds_read_b128 a[144:147], v3 offset:0
v_cvt_pk_bf16_f32 v194, v140, v141
v_mfma_f32_16x16x32_bf16 v[144:147], a[180:183], v[76:79], v[144:147]
ds_read_b128 a[148:151], v3 offset:8192
v_cvt_pk_bf16_f32 v195, v142, v143
v_mfma_f32_16x16x32_bf16 v[144:147], a[176:179], v[72:75], v[144:147]
s_waitcnt lgkmcnt(2)
v_exp_f32 v111, v111
v_mfma_f32_16x16x32_bf16 v[148:151], a[192:195], v[72:75], v[228:231]
buffer_load_dwordx4 v16, s[32:35], s64 offen offset:1024 sc1 lds
v_mfma_f32_16x16x32_bf16 v[148:151], a[196:199], v[76:79], v[148:151]
v_exp_f32 v92, v92
v_mfma_f32_16x16x32_bf16 v[148:151], a[200:203], v[80:83], v[148:151]
v_exp_f32 v93, v93
v_mfma_f32_16x16x32_bf16 v[148:151], a[204:207], v[84:87], v[148:151]
v_exp_f32 v94, v94
v_mfma_f32_16x16x32_bf16 v[132:135], a[204:207], v[68:71], v[224:227]
ds_read_b128 a[152:155], v3 offset:1024
v_cvt_pk_bf16_f32 v186, v124, v125
v_mfma_f32_16x16x32_bf16 v[132:135], a[200:203], v[64:67], v[132:135]
ds_read_b128 a[156:159], v3 offset:9216
v_cvt_pk_bf16_f32 v187, v126, v127
v_mfma_f32_16x16x32_bf16 v[132:135], a[196:199], v[60:63], v[132:135]
v_exp_f32 v95, v95
v_mfma_f32_16x16x32_bf16 v[132:135], a[192:195], v[56:59], v[132:135]
v_exp_f32 v96, v96
v_mfma_f32_16x16x32_bf16 v[116:119], a[192:195], v[40:43], v[220:223]
v_exp_f32 v97, v97
v_mfma_f32_16x16x32_bf16 v[116:119], a[196:199], v[44:47], v[116:119]
v_exp_f32 v98, v98
v_mfma_f32_16x16x32_bf16 v[116:119], a[200:203], v[48:51], v[116:119]
ds_read_b128 a[160:163], v3 offset:2048
v_cvt_pk_bf16_f32 v162, v108, v109
v_mfma_f32_16x16x32_bf16 v[116:119], a[204:207], v[52:55], v[116:119]
v_exp_f32 v99, v99
v_mfma_f32_16x16x32_bf16 v[100:103], a[204:207], v[36:39], v[216:219]
ds_read_b128 a[164:167], v3 offset:10240
v_cvt_pk_bf16_f32 v163, v110, v111
v_mfma_f32_16x16x32_bf16 v[100:103], a[200:203], v[32:35], v[100:103]
v_exp_f32 v112, v112
v_mfma_f32_16x16x32_bf16 v[100:103], a[196:199], v[28:31], v[100:103]
v_exp_f32 v113, v113
v_mfma_f32_16x16x32_bf16 v[100:103], a[192:195], v[24:27], v[100:103]
v_exp_f32 v114, v114
v_smfmac_f32_16x16x64_bf16 a[128:131], a[240:243], v[168:175], v5
ds_read_b128 a[168:171], v3 offset:3072
v_smfmac_f32_16x16x64_bf16 a[132:135], a[240:243], v[176:183], v5
ds_read_b128 a[172:175], v3 offset:11264
v_smfmac_f32_16x16x64_bf16 a[136:139], a[240:243], v[200:207], v5
ds_read_b128 a[176:179], v3 offset:4096
v_smfmac_f32_16x16x64_bf16 a[140:143], a[240:243], v[208:215], v5
s_waitcnt lgkmcnt(3)
buffer_load_dwordx4 v16, s[32:35], s64 offen offset:2048 sc1 lds
v_mfma_f32_16x16x32_bf16 a[0:3], a[144:147], v[168:171], a[0:3]
v_exp_f32 v115, v115
v_mfma_f32_16x16x32_bf16 a[0:3], a[148:151], v[172:175], a[0:3]
v_exp_f32 v128, v128
v_mfma_f32_16x16x32_bf16 a[32:35], a[148:151], v[180:183], a[32:35]
v_exp_f32 v129, v129
v_mfma_f32_16x16x32_bf16 a[32:35], a[144:147], v[176:179], a[32:35]
v_exp_f32 v130, v130
v_mfma_f32_16x16x32_bf16 a[64:67], a[144:147], v[200:203], a[64:67]
v_exp_f32 v131, v131
v_mfma_f32_16x16x32_bf16 a[64:67], a[148:151], v[204:207], a[64:67]
v_cvt_pk_bf16_f32 v154, v92, v93
v_cvt_pk_bf16_f32 v155, v94, v95
v_mfma_f32_16x16x32_bf16 a[96:99], a[148:151], v[212:215], a[96:99]
v_exp_f32 v144, v144
v_mfma_f32_16x16x32_bf16 a[96:99], a[144:147], v[208:211], a[96:99]
ds_read_b128 a[180:183], v3 offset:12288
v_cvt_pk_bf16_f32 v156, v96, v97
v_mfma_f32_16x16x32_bf16 a[100:103], a[152:155], v[208:211], a[100:103]
v_exp_f32 v145, v145
v_mfma_f32_16x16x32_bf16 a[100:103], a[156:159], v[212:215], a[100:103]
ds_read_b128 a[184:187], v3 offset:5120
v_cvt_pk_bf16_f32 v157, v98, v99
v_mfma_f32_16x16x32_bf16 a[68:71], a[156:159], v[204:207], a[68:71]
ds_read_b128 a[188:191], v3 offset:13312
v_cvt_pk_bf16_f32 v164, v112, v113
v_mfma_f32_16x16x32_bf16 a[68:71], a[152:155], v[200:203], a[68:71]
buffer_load_dwordx4 v16, s[32:35], s64 offen offset:3072 sc1 lds
v_mfma_f32_16x16x32_bf16 a[36:39], a[152:155], v[176:179], a[36:39]
ds_read_b128 a[192:195], v3 offset:6144
v_cvt_pk_bf16_f32 v165, v114, v115
v_mfma_f32_16x16x32_bf16 a[36:39], a[156:159], v[180:183], a[36:39]
ds_read_b128 a[196:199], v3 offset:14336
v_cvt_pk_bf16_f32 v188, v128, v129
v_mfma_f32_16x16x32_bf16 a[4:7], a[156:159], v[172:175], a[4:7]
ds_read_b128 a[200:203], v3 offset:7168
v_cvt_pk_bf16_f32 v189, v130, v131
v_mfma_f32_16x16x32_bf16 a[4:7], a[152:155], v[168:171], a[4:7]
v_exp_f32 v146, v146
v_mfma_f32_16x16x32_bf16 a[8:11], a[160:163], v[168:171], a[8:11]
v_exp_f32 v147, v147
v_mfma_f32_16x16x32_bf16 a[8:11], a[164:167], v[172:175], a[8:11]
v_exp_f32 v148, v148
v_mfma_f32_16x16x32_bf16 a[40:43], a[164:167], v[180:183], a[40:43]
ds_read_b128 a[204:207], v3 offset:15360
v_cvt_pk_bf16_f32 v196, v144, v145
v_mfma_f32_16x16x32_bf16 a[40:43], a[160:163], v[176:179], a[40:43]
v_exp_f32 v149, v149
v_mfma_f32_16x16x32_bf16 a[72:75], a[160:163], v[200:203], a[72:75]
v_exp_f32 v150, v150
v_mfma_f32_16x16x32_bf16 a[72:75], a[164:167], v[204:207], a[72:75]
v_exp_f32 v151, v151
v_mfma_f32_16x16x32_bf16 a[104:107], a[164:167], v[212:215], a[104:107]
v_exp_f32 v132, v132
v_mfma_f32_16x16x32_bf16 a[104:107], a[160:163], v[208:211], a[104:107]
s_waitcnt lgkmcnt(1)
v_exp_f32 v133, v133
v_mfma_f32_16x16x32_bf16 a[108:111], a[168:171], v[208:211], a[108:111]
v_exp_f32 v134, v134
v_mfma_f32_16x16x32_bf16 a[108:111], a[172:175], v[212:215], a[108:111]
v_exp_f32 v135, v135
v_mfma_f32_16x16x32_bf16 a[76:79], a[172:175], v[204:207], a[76:79]
v_exp_f32 v116, v116
v_mfma_f32_16x16x32_bf16 a[76:79], a[168:171], v[200:203], a[76:79]
v_exp_f32 v117, v117
v_mfma_f32_16x16x32_bf16 a[44:47], a[168:171], v[176:179], a[44:47]
v_exp_f32 v118, v118
v_mfma_f32_16x16x32_bf16 a[44:47], a[172:175], v[180:183], a[44:47]
s_waitcnt vmcnt(9)
s_barrier
v_mfma_f32_16x16x32_bf16 a[12:15], a[172:175], v[172:175], a[12:15]
s_xor_b32 s71, s71, 16384
v_exp_f32 v119, v119
v_mfma_f32_16x16x32_bf16 a[12:15], a[168:171], v[168:171], a[12:15]
s_add_u32 s70, s70, 32768
v_exp_f32 v100, v100
v_mfma_f32_16x16x32_bf16 a[16:19], a[176:179], v[168:171], a[16:19]
s_mov_b32 m0, s71
v_exp_f32 v101, v101
v_mfma_f32_16x16x32_bf16 a[16:19], a[180:183], v[172:175], a[16:19]
buffer_load_dwordx4 v16, s[32:35], s70 offen offset:0 sc1 lds
v_mfma_f32_16x16x32_bf16 a[48:51], a[180:183], v[180:183], a[48:51]
ds_read_b128 a[144:147], v2 offset:16384
v_cvt_pk_bf16_f32 v197, v146, v147
v_mfma_f32_16x16x32_bf16 a[48:51], a[176:179], v[176:179], a[48:51]
ds_read_b128 a[148:151], v2 offset:17408
v_cvt_pk_bf16_f32 v198, v148, v149
v_mfma_f32_16x16x32_bf16 a[80:83], a[176:179], v[200:203], a[80:83]
v_exp_f32 v102, v102
v_mfma_f32_16x16x32_bf16 a[80:83], a[180:183], v[204:207], a[80:83]
ds_read_b128 a[152:155], v2 offset:18432
v_cvt_pk_bf16_f32 v199, v150, v151
v_mfma_f32_16x16x32_bf16 a[112:115], a[180:183], v[212:215], a[112:115]
ds_read_b128 a[156:159], v2 offset:19456
v_cvt_pk_bf16_f32 v190, v132, v133
v_mfma_f32_16x16x32_bf16 a[112:115], a[176:179], v[208:211], a[112:115]
v_exp_f32 v103, v103
v_mfma_f32_16x16x32_bf16 a[116:119], a[184:187], v[208:211], a[116:119]
ds_read_b128 a[160:163], v2 offset:20480
v_cvt_pk_bf16_f32 v191, v134, v135
v_mfma_f32_16x16x32_bf16 a[116:119], a[188:191], v[212:215], a[116:119]
ds_read_b128 a[164:167], v2 offset:21504
v_cvt_pk_bf16_f32 v166, v116, v117
v_mfma_f32_16x16x32_bf16 a[84:87], a[188:191], v[204:207], a[84:87]
ds_read_b128 a[168:171], v2 offset:22528
v_cvt_pk_bf16_f32 v167, v118, v119
v_mfma_f32_16x16x32_bf16 a[84:87], a[184:187], v[200:203], a[84:87]
ds_read_b128 a[172:175], v2 offset:23552
v_cvt_pk_bf16_f32 v158, v100, v101
v_mfma_f32_16x16x32_bf16 a[52:55], a[184:187], v[176:179], a[52:55]
v_cvt_pk_bf16_f32 v159, v102, v103
v_mfma_f32_16x16x32_bf16 a[52:55], a[188:191], v[180:183], a[52:55]
v_mfma_f32_16x16x32_bf16 a[20:23], a[188:191], v[172:175], a[20:23]
v_mfma_f32_16x16x32_bf16 a[20:23], a[184:187], v[168:171], a[20:23]
v_mfma_f32_16x16x32_bf16 a[24:27], a[192:195], v[168:171], a[24:27]
buffer_load_dwordx4 v16, s[32:35], s70 offen offset:1024 sc1 lds
v_mfma_f32_16x16x32_bf16 a[24:27], a[196:199], v[172:175], a[24:27]
v_mfma_f32_16x16x32_bf16 a[56:59], a[196:199], v[180:183], a[56:59]
v_mfma_f32_16x16x32_bf16 a[56:59], a[192:195], v[176:179], a[56:59]
v_mfma_f32_16x16x32_bf16 a[88:91], a[192:195], v[200:203], a[88:91]
v_mfma_f32_16x16x32_bf16 a[88:91], a[196:199], v[204:207], a[88:91]
v_mfma_f32_16x16x32_bf16 a[120:123], a[196:199], v[212:215], a[120:123]
v_mfma_f32_16x16x32_bf16 a[120:123], a[192:195], v[208:211], a[120:123]
v_mfma_f32_16x16x32_bf16 a[124:127], a[200:203], v[208:211], a[124:127]
s_waitcnt lgkmcnt(0)
v_mfma_f32_16x16x32_bf16 a[124:127], a[204:207], v[212:215], a[124:127]
v_mfma_f32_16x16x32_bf16 a[92:95], a[204:207], v[204:207], a[92:95]
v_mfma_f32_16x16x32_bf16 a[92:95], a[200:203], v[200:203], a[92:95]
v_mfma_f32_16x16x32_bf16 a[60:63], a[200:203], v[176:179], a[60:63]
v_mfma_f32_16x16x32_bf16 a[60:63], a[204:207], v[180:183], a[60:63]
v_mfma_f32_16x16x32_bf16 a[28:31], a[204:207], v[172:175], a[28:31]
v_mfma_f32_16x16x32_bf16 a[28:31], a[200:203], v[168:171], a[28:31]
v_mfma_f32_16x16x32_bf16 v[88:91], a[144:147], v[24:27], v[216:219]
ds_read_b128 a[176:179], v2 offset:24576
v_mfma_f32_16x16x32_bf16 v[88:91], a[148:151], v[28:31], v[88:91]
ds_read_b128 a[180:183], v2 offset:25600
v_mfma_f32_16x16x32_bf16 v[88:91], a[152:155], v[32:35], v[88:91]
buffer_load_dwordx4 v16, s[32:35], s70 offen offset:2048 sc1 lds
v_mfma_f32_16x16x32_bf16 v[88:91], a[156:159], v[36:39], v[88:91]
ds_read_b128 a[184:187], v2 offset:26624
v_mfma_f32_16x16x32_bf16 v[104:107], a[156:159], v[52:55], v[220:223]
v_mfma_f32_16x16x32_bf16 v[104:107], a[152:155], v[48:51], v[104:107]
v_mfma_f32_16x16x32_bf16 v[104:107], a[148:151], v[44:47], v[104:107]
ds_read_b128 a[188:191], v2 offset:27648
v_mfma_f32_16x16x32_bf16 v[104:107], a[144:147], v[40:43], v[104:107]
v_mfma_f32_16x16x32_bf16 v[120:123], a[144:147], v[56:59], v[224:227]
v_mfma_f32_16x16x32_bf16 v[120:123], a[148:151], v[60:63], v[120:123]
v_mfma_f32_16x16x32_bf16 v[120:123], a[152:155], v[64:67], v[120:123]
v_exp_f32 v88, v88
v_mfma_f32_16x16x32_bf16 v[120:123], a[156:159], v[68:71], v[120:123]
v_exp_f32 v89, v89
v_mfma_f32_16x16x32_bf16 v[136:139], a[156:159], v[84:87], v[228:231]
v_exp_f32 v90, v90
v_mfma_f32_16x16x32_bf16 v[136:139], a[152:155], v[80:83], v[136:139]
v_exp_f32 v91, v91
v_mfma_f32_16x16x32_bf16 v[136:139], a[148:151], v[76:79], v[136:139]
v_exp_f32 v104, v104
v_mfma_f32_16x16x32_bf16 v[136:139], a[144:147], v[72:75], v[136:139]
v_exp_f32 v105, v105
v_mfma_f32_16x16x32_bf16 v[140:143], a[160:163], v[72:75], v[228:231]
v_exp_f32 v106, v106
v_mfma_f32_16x16x32_bf16 v[140:143], a[164:167], v[76:79], v[140:143]
buffer_load_dwordx4 v16, s[32:35], s70 offen offset:3072 sc1 lds
v_mfma_f32_16x16x32_bf16 v[140:143], a[168:171], v[80:83], v[140:143]
v_exp_f32 v107, v107
v_mfma_f32_16x16x32_bf16 v[140:143], a[172:175], v[84:87], v[140:143]
v_cvt_pk_bf16_f32 v168, v88, v89
v_cvt_pk_bf16_f32 v169, v90, v91
v_mfma_f32_16x16x32_bf16 v[124:127], a[172:175], v[68:71], v[224:227]
v_exp_f32 v120, v120
v_mfma_f32_16x16x32_bf16 v[124:127], a[168:171], v[64:67], v[124:127]
v_exp_f32 v121, v121
v_mfma_f32_16x16x32_bf16 v[124:127], a[164:167], v[60:63], v[124:127]
v_exp_f32 v122, v122
v_mfma_f32_16x16x32_bf16 v[124:127], a[160:163], v[56:59], v[124:127]
v_exp_f32 v123, v123
v_mfma_f32_16x16x32_bf16 v[108:111], a[160:163], v[40:43], v[220:223]
v_exp_f32 v136, v136
v_mfma_f32_16x16x32_bf16 v[108:111], a[164:167], v[44:47], v[108:111]
v_exp_f32 v137, v137
v_mfma_f32_16x16x32_bf16 v[108:111], a[168:171], v[48:51], v[108:111]
v_exp_f32 v138, v138
v_mfma_f32_16x16x32_bf16 v[108:111], a[172:175], v[52:55], v[108:111]
v_cvt_pk_bf16_f32 v176, v104, v105
v_cvt_pk_bf16_f32 v177, v106, v107
v_mfma_f32_16x16x32_bf16 v[92:95], a[172:175], v[36:39], v[216:219]
v_exp_f32 v139, v139
v_mfma_f32_16x16x32_bf16 v[92:95], a[168:171], v[32:35], v[92:95]
ds_read_b128 a[192:195], v2 offset:28672
v_cvt_pk_bf16_f32 v200, v120, v121
v_mfma_f32_16x16x32_bf16 v[92:95], a[164:167], v[28:31], v[92:95]
v_exp_f32 v140, v140
v_mfma_f32_16x16x32_bf16 v[92:95], a[160:163], v[24:27], v[92:95]
s_waitcnt lgkmcnt(1)
s_add_u32 m0, s71, 4096
ds_read_b128 a[196:199], v2 offset:29696
v_cvt_pk_bf16_f32 v201, v122, v123
v_mfma_f32_16x16x32_bf16 v[96:99], a[176:179], v[24:27], v[216:219]
s_add_u32 s64, s70, 4096
ds_read_b128 a[200:203], v2 offset:30720
v_cvt_pk_bf16_f32 v208, v136, v137
v_mfma_f32_16x16x32_bf16 v[96:99], a[180:183], v[28:31], v[96:99]
buffer_load_dwordx4 v16, s[32:35], s64 offen offset:0 sc1 lds
v_mfma_f32_16x16x32_bf16 v[96:99], a[184:187], v[32:35], v[96:99]
v_exp_f32 v141, v141
v_mfma_f32_16x16x32_bf16 v[96:99], a[188:191], v[36:39], v[96:99]
ds_read_b128 a[204:207], v2 offset:31744
v_cvt_pk_bf16_f32 v209, v138, v139
v_mfma_f32_16x16x32_bf16 v[112:115], a[188:191], v[52:55], v[220:223]
v_exp_f32 v142, v142
v_mfma_f32_16x16x32_bf16 v[112:115], a[184:187], v[48:51], v[112:115]
v_exp_f32 v143, v143
v_mfma_f32_16x16x32_bf16 v[112:115], a[180:183], v[44:47], v[112:115]
v_exp_f32 v124, v124
v_mfma_f32_16x16x32_bf16 v[112:115], a[176:179], v[40:43], v[112:115]
v_exp_f32 v125, v125
v_mfma_f32_16x16x32_bf16 v[128:131], a[176:179], v[56:59], v[224:227]
v_exp_f32 v126, v126
v_mfma_f32_16x16x32_bf16 v[128:131], a[180:183], v[60:63], v[128:131]
v_exp_f32 v127, v127
v_mfma_f32_16x16x32_bf16 v[128:131], a[184:187], v[64:67], v[128:131]
v_exp_f32 v108, v108
v_mfma_f32_16x16x32_bf16 v[128:131], a[188:191], v[68:71], v[128:131]
v_exp_f32 v109, v109
v_mfma_f32_16x16x32_bf16 v[144:147], a[188:191], v[84:87], v[228:231]
v_exp_f32 v110, v110
v_mfma_f32_16x16x32_bf16 v[144:147], a[184:187], v[80:83], v[144:147]
ds_read_b128 a[144:147], v3 offset:16384
v_cvt_pk_bf16_f32 v210, v140, v141
v_mfma_f32_16x16x32_bf16 v[144:147], a[180:183], v[76:79], v[144:147]
ds_read_b128 a[148:151], v3 offset:24576
v_cvt_pk_bf16_f32 v211, v142, v143
v_mfma_f32_16x16x32_bf16 v[144:147], a[176:179], v[72:75], v[144:147]
s_waitcnt lgkmcnt(2)
v_exp_f32 v111, v111
v_mfma_f32_16x16x32_bf16 v[148:151], a[192:195], v[72:75], v[228:231]
s_branch L_po16
L_pg16:
s_branch L_pg20
L_po16:
buffer_load_dwordx4 v16, s[32:35], s64 offen offset:1024 sc1 lds
v_mfma_f32_16x16x32_bf16 v[148:151], a[196:199], v[76:79], v[148:151]
v_exp_f32 v92, v92
v_mfma_f32_16x16x32_bf16 v[148:151], a[200:203], v[80:83], v[148:151]
v_exp_f32 v93, v93
v_mfma_f32_16x16x32_bf16 v[148:151], a[204:207], v[84:87], v[148:151]
v_exp_f32 v94, v94
v_mfma_f32_16x16x32_bf16 v[132:135], a[204:207], v[68:71], v[224:227]
ds_read_b128 a[152:155], v3 offset:17408
v_cvt_pk_bf16_f32 v202, v124, v125
v_mfma_f32_16x16x32_bf16 v[132:135], a[200:203], v[64:67], v[132:135]
ds_read_b128 a[156:159], v3 offset:25600
v_cvt_pk_bf16_f32 v203, v126, v127
v_mfma_f32_16x16x32_bf16 v[132:135], a[196:199], v[60:63], v[132:135]
v_exp_f32 v95, v95
v_mfma_f32_16x16x32_bf16 v[132:135], a[192:195], v[56:59], v[132:135]
v_exp_f32 v96, v96
v_mfma_f32_16x16x32_bf16 v[116:119], a[192:195], v[40:43], v[220:223]
v_exp_f32 v97, v97
v_mfma_f32_16x16x32_bf16 v[116:119], a[196:199], v[44:47], v[116:119]
v_exp_f32 v98, v98
v_mfma_f32_16x16x32_bf16 v[116:119], a[200:203], v[48:51], v[116:119]
ds_read_b128 a[160:163], v3 offset:18432
v_cvt_pk_bf16_f32 v178, v108, v109
v_mfma_f32_16x16x32_bf16 v[116:119], a[204:207], v[52:55], v[116:119]
v_exp_f32 v99, v99
v_mfma_f32_16x16x32_bf16 v[100:103], a[204:207], v[36:39], v[216:219]
ds_read_b128 a[164:167], v3 offset:26624
v_cvt_pk_bf16_f32 v179, v110, v111
v_mfma_f32_16x16x32_bf16 v[100:103], a[200:203], v[32:35], v[100:103]
v_exp_f32 v112, v112
v_mfma_f32_16x16x32_bf16 v[100:103], a[196:199], v[28:31], v[100:103]
v_exp_f32 v113, v113
v_mfma_f32_16x16x32_bf16 v[100:103], a[192:195], v[24:27], v[100:103]
v_exp_f32 v114, v114
v_smfmac_f32_16x16x64_bf16 a[128:131], a[240:243], v[152:159], v5
ds_read_b128 a[168:171], v3 offset:19456
v_smfmac_f32_16x16x64_bf16 a[132:135], a[240:243], v[160:167], v5
ds_read_b128 a[172:175], v3 offset:27648
v_smfmac_f32_16x16x64_bf16 a[136:139], a[240:243], v[184:191], v5
ds_read_b128 a[176:179], v3 offset:20480
v_smfmac_f32_16x16x64_bf16 a[140:143], a[240:243], v[192:199], v5
s_waitcnt lgkmcnt(3)
buffer_load_dwordx4 v16, s[32:35], s64 offen offset:2048 sc1 lds
v_mfma_f32_16x16x32_bf16 a[0:3], a[144:147], v[152:155], a[0:3]
v_exp_f32 v115, v115
v_mfma_f32_16x16x32_bf16 a[0:3], a[148:151], v[156:159], a[0:3]
v_exp_f32 v128, v128
v_mfma_f32_16x16x32_bf16 a[32:35], a[148:151], v[164:167], a[32:35]
v_exp_f32 v129, v129
v_mfma_f32_16x16x32_bf16 a[32:35], a[144:147], v[160:163], a[32:35]
v_exp_f32 v130, v130
v_mfma_f32_16x16x32_bf16 a[64:67], a[144:147], v[184:187], a[64:67]
v_exp_f32 v131, v131
v_mfma_f32_16x16x32_bf16 a[64:67], a[148:151], v[188:191], a[64:67]
v_cvt_pk_bf16_f32 v170, v92, v93
v_cvt_pk_bf16_f32 v171, v94, v95
v_mfma_f32_16x16x32_bf16 a[96:99], a[148:151], v[196:199], a[96:99]
v_exp_f32 v144, v144
v_mfma_f32_16x16x32_bf16 a[96:99], a[144:147], v[192:195], a[96:99]
ds_read_b128 a[180:183], v3 offset:28672
v_cvt_pk_bf16_f32 v172, v96, v97
v_mfma_f32_16x16x32_bf16 a[100:103], a[152:155], v[192:195], a[100:103]
v_exp_f32 v145, v145
v_mfma_f32_16x16x32_bf16 a[100:103], a[156:159], v[196:199], a[100:103]
ds_read_b128 a[184:187], v3 offset:21504
v_xor_b32 v2, 0x8000, v2
v_mfma_f32_16x16x32_bf16 a[68:71], a[156:159], v[188:191], a[68:71]
ds_read_b128 a[188:191], v3 offset:29696
v_cvt_pk_bf16_f32 v173, v98, v99
v_mfma_f32_16x16x32_bf16 a[68:71], a[152:155], v[184:187], a[68:71]
buffer_load_dwordx4 v16, s[32:35], s64 offen offset:3072 sc1 lds
v_mfma_f32_16x16x32_bf16 a[36:39], a[152:155], v[160:163], a[36:39]
ds_read_b128 a[192:195], v3 offset:22528
v_cvt_pk_bf16_f32 v180, v112, v113
v_mfma_f32_16x16x32_bf16 a[36:39], a[156:159], v[164:167], a[36:39]
ds_read_b128 a[196:199], v3 offset:30720
v_cvt_pk_bf16_f32 v181, v114, v115
v_mfma_f32_16x16x32_bf16 a[4:7], a[156:159], v[156:159], a[4:7]
ds_read_b128 a[200:203], v3 offset:23552
v_cvt_pk_bf16_f32 v204, v128, v129
v_mfma_f32_16x16x32_bf16 a[4:7], a[152:155], v[152:155], a[4:7]
v_exp_f32 v146, v146
v_mfma_f32_16x16x32_bf16 a[8:11], a[160:163], v[152:155], a[8:11]
v_exp_f32 v147, v147
v_mfma_f32_16x16x32_bf16 a[8:11], a[164:167], v[156:159], a[8:11]
v_exp_f32 v148, v148
v_mfma_f32_16x16x32_bf16 a[40:43], a[164:167], v[164:167], a[40:43]
ds_read_b128 a[204:207], v3 offset:31744
v_cvt_pk_bf16_f32 v205, v130, v131
v_mfma_f32_16x16x32_bf16 a[40:43], a[160:163], v[160:163], a[40:43]
v_exp_f32 v149, v149
v_mfma_f32_16x16x32_bf16 a[72:75], a[160:163], v[184:187], a[72:75]
v_exp_f32 v150, v150
v_mfma_f32_16x16x32_bf16 a[72:75], a[164:167], v[188:191], a[72:75]
v_exp_f32 v151, v151
v_mfma_f32_16x16x32_bf16 a[104:107], a[164:167], v[196:199], a[104:107]
v_exp_f32 v132, v132
v_mfma_f32_16x16x32_bf16 a[104:107], a[160:163], v[192:195], a[104:107]
s_waitcnt lgkmcnt(1)
v_exp_f32 v133, v133
v_mfma_f32_16x16x32_bf16 a[108:111], a[168:171], v[192:195], a[108:111]
v_exp_f32 v134, v134
v_mfma_f32_16x16x32_bf16 a[108:111], a[172:175], v[196:199], a[108:111]
v_exp_f32 v135, v135
v_mfma_f32_16x16x32_bf16 a[76:79], a[172:175], v[188:191], a[76:79]
v_exp_f32 v116, v116
v_mfma_f32_16x16x32_bf16 a[76:79], a[168:171], v[184:187], a[76:79]
v_exp_f32 v117, v117
v_mfma_f32_16x16x32_bf16 a[44:47], a[168:171], v[160:163], a[44:47]
v_exp_f32 v118, v118
v_mfma_f32_16x16x32_bf16 a[44:47], a[172:175], v[164:167], a[44:47]
s_waitcnt vmcnt(8)
s_barrier
v_mfma_f32_16x16x32_bf16 a[12:15], a[172:175], v[156:159], a[12:15]
s_xor_b32 s71, s71, 49152
v_exp_f32 v119, v119
v_mfma_f32_16x16x32_bf16 a[12:15], a[168:171], v[152:155], a[12:15]
s_add_u32 s70, s70, 32768
v_exp_f32 v100, v100
v_mfma_f32_16x16x32_bf16 a[16:19], a[176:179], v[152:155], a[16:19]
s_mov_b32 m0, s71
v_exp_f32 v101, v101
v_mfma_f32_16x16x32_bf16 a[16:19], a[180:183], v[156:159], a[16:19]
buffer_load_dwordx4 v16, s[32:35], s70 offen offset:0 sc1 lds
v_mfma_f32_16x16x32_bf16 a[48:51], a[180:183], v[164:167], a[48:51]
ds_read_b128 a[144:147], v2 offset:0
v_cvt_pk_bf16_f32 v212, v144, v145
v_mfma_f32_16x16x32_bf16 a[48:51], a[176:179], v[160:163], a[48:51]
ds_read_b128 a[148:151], v2 offset:1024
v_cvt_pk_bf16_f32 v213, v146, v147
v_mfma_f32_16x16x32_bf16 a[80:83], a[176:179], v[184:187], a[80:83]
v_exp_f32 v102, v102
v_mfma_f32_16x16x32_bf16 a[80:83], a[180:183], v[188:191], a[80:83]
ds_read_b128 a[152:155], v2 offset:2048
v_cvt_pk_bf16_f32 v214, v148, v149
v_mfma_f32_16x16x32_bf16 a[112:115], a[180:183], v[196:199], a[112:115]
ds_read_b128 a[156:159], v2 offset:3072
v_cvt_pk_bf16_f32 v215, v150, v151
v_mfma_f32_16x16x32_bf16 a[112:115], a[176:179], v[192:195], a[112:115]
v_exp_f32 v103, v103
v_mfma_f32_16x16x32_bf16 a[116:119], a[184:187], v[192:195], a[116:119]
ds_read_b128 a[160:163], v2 offset:4096
v_cvt_pk_bf16_f32 v206, v132, v133
v_mfma_f32_16x16x32_bf16 a[116:119], a[188:191], v[196:199], a[116:119]
ds_read_b128 a[164:167], v2 offset:5120
v_cvt_pk_bf16_f32 v207, v134, v135
v_mfma_f32_16x16x32_bf16 a[84:87], a[188:191], v[188:191], a[84:87]
ds_read_b128 a[168:171], v2 offset:6144
v_xor_b32 v3, 0x8000, v3
v_mfma_f32_16x16x32_bf16 a[84:87], a[184:187], v[184:187], a[84:87]
ds_read_b128 a[172:175], v2 offset:7168
v_cvt_pk_bf16_f32 v182, v116, v117
v_mfma_f32_16x16x32_bf16 a[52:55], a[184:187], v[160:163], a[52:55]
v_cvt_pk_bf16_f32 v183, v118, v119
v_cvt_pk_bf16_f32 v174, v100, v101
v_mfma_f32_16x16x32_bf16 a[52:55], a[188:191], v[164:167], a[52:55]
v_cvt_pk_bf16_f32 v175, v102, v103
v_mfma_f32_16x16x32_bf16 a[20:23], a[188:191], v[156:159], a[20:23]
v_mfma_f32_16x16x32_bf16 a[20:23], a[184:187], v[152:155], a[20:23]
v_mfma_f32_16x16x32_bf16 a[24:27], a[192:195], v[152:155], a[24:27]
buffer_load_dwordx4 v16, s[32:35], s70 offen offset:1024 sc1 lds
v_mfma_f32_16x16x32_bf16 a[24:27], a[196:199], v[156:159], a[24:27]
v_mfma_f32_16x16x32_bf16 a[56:59], a[196:199], v[164:167], a[56:59]
v_mfma_f32_16x16x32_bf16 a[56:59], a[192:195], v[160:163], a[56:59]
v_mfma_f32_16x16x32_bf16 a[88:91], a[192:195], v[184:187], a[88:91]
v_mfma_f32_16x16x32_bf16 a[88:91], a[196:199], v[188:191], a[88:91]
v_mfma_f32_16x16x32_bf16 a[120:123], a[196:199], v[196:199], a[120:123]
s_sub_u32 s72, s72, 1
v_mfma_f32_16x16x32_bf16 a[120:123], a[192:195], v[192:195], a[120:123]
v_mfma_f32_16x16x32_bf16 a[124:127], a[200:203], v[192:195], a[124:127]
s_waitcnt lgkmcnt(0)
v_mfma_f32_16x16x32_bf16 a[124:127], a[204:207], v[196:199], a[124:127]
v_mfma_f32_16x16x32_bf16 a[92:95], a[204:207], v[188:191], a[92:95]
s_cmp_lg_u32 s72, 0
v_mfma_f32_16x16x32_bf16 a[92:95], a[200:203], v[184:187], a[92:95]
v_mfma_f32_16x16x32_bf16 a[60:63], a[200:203], v[160:163], a[60:63]
v_mfma_f32_16x16x32_bf16 a[60:63], a[204:207], v[164:167], a[60:63]
v_mfma_f32_16x16x32_bf16 a[28:31], a[204:207], v[156:159], a[28:31]
v_mfma_f32_16x16x32_bf16 a[28:31], a[200:203], v[152:155], a[28:31]
s_cbranch_scc1 L_D
L_DD:
s_waitcnt lgkmcnt(7)
v_mfma_f32_16x16x32_bf16 v[104:107], a[144:147], v[40:43], v[220:223]
s_waitcnt lgkmcnt(6)
ds_read_b128 a[176:179], v2 offset:8192
v_cndmask_b32 v88, v216, v17, s[0:1]
v_mfma_f32_16x16x32_bf16 v[104:107], a[148:151], v[44:47], v[104:107]
s_waitcnt lgkmcnt(6)
ds_read_b128 a[180:183], v2 offset:9216
v_cndmask_b32 v89, v216, v17, s[4:5]
v_mfma_f32_16x16x32_bf16 v[104:107], a[152:155], v[48:51], v[104:107]
s_waitcnt lgkmcnt(6)
buffer_load_dwordx4 v16, s[32:35], s70 offen offset:2048 sc1 lds
v_mfma_f32_16x16x32_bf16 v[104:107], a[156:159], v[52:55], v[104:107]
ds_read_b128 a[184:187], v2 offset:10240
v_cndmask_b32 v90, v216, v17, s[6:7]
v_mfma_f32_16x16x32_bf16 v[120:123], a[156:159], v[68:71], v[224:227]
ds_read_b128 a[188:191], v2 offset:11264
v_cndmask_b32 v91, v216, v17, s[8:9]
v_mfma_f32_16x16x32_bf16 v[120:123], a[152:155], v[64:67], v[120:123]
ds_read_b128 a[192:195], v2 offset:12288
v_cndmask_b32 v92, v216, v17, s[10:11]
v_mfma_f32_16x16x32_bf16 v[120:123], a[148:151], v[60:63], v[120:123]
ds_read_b128 a[196:199], v2 offset:13312
v_cndmask_b32 v93, v216, v17, s[12:13]
v_mfma_f32_16x16x32_bf16 v[120:123], a[144:147], v[56:59], v[120:123]
ds_read_b128 a[200:203], v2 offset:14336
v_cndmask_b32 v94, v216, v17, s[18:19]
v_mfma_f32_16x16x32_bf16 v[136:139], a[144:147], v[72:75], v[228:231]
ds_read_b128 a[204:207], v2 offset:15360
v_cndmask_b32 v95, v216, v17, s[22:23]
v_mfma_f32_16x16x32_bf16 v[136:139], a[148:151], v[76:79], v[136:139]
v_cndmask_b32 v96, v216, v17, s[26:27]
v_cndmask_b32 v97, v216, v17, s[56:57]
v_mfma_f32_16x16x32_bf16 v[136:139], a[152:155], v[80:83], v[136:139]
v_exp_f32 v104, v104
v_mfma_f32_16x16x32_bf16 v[136:139], a[156:159], v[84:87], v[136:139]
v_exp_f32 v105, v105
v_mfma_f32_16x16x32_bf16 v[88:91], a[156:159], v[36:39], v[88:91]
v_exp_f32 v106, v106
v_mfma_f32_16x16x32_bf16 v[88:91], a[152:155], v[32:35], v[88:91]
v_exp_f32 v107, v107
v_mfma_f32_16x16x32_bf16 v[88:91], a[148:151], v[28:31], v[88:91]
v_exp_f32 v120, v120
v_mfma_f32_16x16x32_bf16 v[88:91], a[144:147], v[24:27], v[88:91]
s_waitcnt lgkmcnt(0)
v_exp_f32 v121, v121
v_mfma_f32_16x16x32_bf16 v[140:143], a[160:163], v[72:75], v[228:231]
v_exp_f32 v122, v122
v_mfma_f32_16x16x32_bf16 v[140:143], a[164:167], v[76:79], v[140:143]
buffer_load_dwordx4 v16, s[32:35], s70 offen offset:3072 sc1 lds
v_mfma_f32_16x16x32_bf16 v[140:143], a[168:171], v[80:83], v[140:143]
s_add_u32 m0, s86, 131072
v_exp_f32 v123, v123
v_mfma_f32_16x16x32_bf16 v[140:143], a[172:175], v[84:87], v[140:143]
s_add_u32 s64, s85, 0
v_cvt_pk_bf16_f32 v160, v104, v105
v_cvt_pk_bf16_f32 v161, v106, v107
v_mfma_f32_16x16x32_bf16 v[124:127], a[172:175], v[68:71], v[224:227]
buffer_load_dwordx4 v12, s[36:39], s64 offen lds
v_mfma_f32_16x16x32_bf16 v[124:127], a[168:171], v[64:67], v[124:127]
s_add_u32 m0, s86, 132096
v_exp_f32 v136, v136
v_mfma_f32_16x16x32_bf16 v[124:127], a[164:167], v[60:63], v[124:127]
s_add_u32 s64, s85, 8192
v_exp_f32 v137, v137
v_mfma_f32_16x16x32_bf16 v[124:127], a[160:163], v[56:59], v[124:127]
buffer_load_dwordx4 v13, s[36:39], s64 offen lds
v_mfma_f32_16x16x32_bf16 v[108:111], a[160:163], v[40:43], v[220:223]
v_exp_f32 v138, v138
v_mfma_f32_16x16x32_bf16 v[108:111], a[164:167], v[44:47], v[108:111]
ds_read_b128 a[144:147], v3 offset:0
v_cndmask_b32 v98, v216, v17, s[58:59]
v_mfma_f32_16x16x32_bf16 v[108:111], a[168:171], v[48:51], v[108:111]
s_add_u32 m0, s86, 133120
ds_read_b128 a[148:151], v3 offset:8192
v_cndmask_b32 v99, v216, v17, s[60:61]
v_mfma_f32_16x16x32_bf16 v[108:111], a[172:175], v[52:55], v[108:111]
s_add_u32 s64, s85, 16384
v_cvt_pk_bf16_f32 v184, v120, v121
v_cvt_pk_bf16_f32 v185, v122, v123
v_mfma_f32_16x16x32_bf16 v[92:95], a[172:175], v[36:39], v[92:95]
buffer_load_dwordx4 v12, s[36:39], s64 offen lds
v_mfma_f32_16x16x32_bf16 v[92:95], a[168:171], v[32:35], v[92:95]
s_add_u32 m0, s86, 134144
v_exp_f32 v139, v139
v_mfma_f32_16x16x32_bf16 v[92:95], a[164:167], v[28:31], v[92:95]
s_add_u32 s64, s85, 24576
v_exp_f32 v88, v88
v_mfma_f32_16x16x32_bf16 v[92:95], a[160:163], v[24:27], v[92:95]
buffer_load_dwordx4 v13, s[36:39], s64 offen lds
v_mfma_f32_16x16x32_bf16 v[96:99], a[176:179], v[24:27], v[96:99]
s_add_u32 m0, s71, 4096
v_exp_f32 v89, v89
v_mfma_f32_16x16x32_bf16 v[96:99], a[180:183], v[28:31], v[96:99]
s_add_u32 s64, s70, 4096
v_exp_f32 v90, v90
v_mfma_f32_16x16x32_bf16 v[96:99], a[184:187], v[32:35], v[96:99]
buffer_load_dwordx4 v16, s[32:35], s64 offen offset:0 sc1 lds
v_mfma_f32_16x16x32_bf16 v[96:99], a[188:191], v[36:39], v[96:99]
v_cvt_pk_bf16_f32 v192, v136, v137
v_cvt_pk_bf16_f32 v193, v138, v139
v_mfma_f32_16x16x32_bf16 v[112:115], a[188:191], v[52:55], v[220:223]
v_exp_f32 v91, v91
v_mfma_f32_16x16x32_bf16 v[112:115], a[184:187], v[48:51], v[112:115]
v_exp_f32 v140, v140
v_mfma_f32_16x16x32_bf16 v[112:115], a[180:183], v[44:47], v[112:115]
v_exp_f32 v141, v141
v_mfma_f32_16x16x32_bf16 v[112:115], a[176:179], v[40:43], v[112:115]
v_exp_f32 v142, v142
v_mfma_f32_16x16x32_bf16 v[128:131], a[176:179], v[56:59], v[224:227]
v_exp_f32 v143, v143
v_mfma_f32_16x16x32_bf16 v[128:131], a[180:183], v[60:63], v[128:131]
v_exp_f32 v124, v124
v_mfma_f32_16x16x32_bf16 v[128:131], a[184:187], v[64:67], v[128:131]
v_cvt_pk_bf16_f32 v152, v88, v89
v_cvt_pk_bf16_f32 v153, v90, v91
v_mfma_f32_16x16x32_bf16 v[128:131], a[188:191], v[68:71], v[128:131]
v_exp_f32 v125, v125
v_mfma_f32_16x16x32_bf16 v[144:147], a[188:191], v[84:87], v[228:231]
v_exp_f32 v126, v126
v_mfma_f32_16x16x32_bf16 v[144:147], a[184:187], v[80:83], v[144:147]
v_exp_f32 v127, v127
v_mfma_f32_16x16x32_bf16 v[144:147], a[180:183], v[76:79], v[144:147]
v_exp_f32 v108, v108
v_mfma_f32_16x16x32_bf16 v[144:147], a[176:179], v[72:75], v[144:147]
ds_read_b128 a[152:155], v3 offset:1024
v_cndmask_b32 v100, v216, v17, s[62:63]
v_mfma_f32_16x16x32_bf16 v[148:151], a[192:195], v[72:75], v[228:231]
buffer_load_dwordx4 v16, s[32:35], s64 offen offset:1024 sc1 lds
v_mfma_f32_16x16x32_bf16 v[148:151], a[196:199], v[76:79], v[148:151]
ds_read_b128 a[156:159], v3 offset:9216
v_cndmask_b32 v101, v216, v17, s[48:49]
v_mfma_f32_16x16x32_bf16 v[148:151], a[200:203], v[80:83], v[148:151]
v_cvt_pk_bf16_f32 v194, v140, v141
v_cvt_pk_bf16_f32 v195, v142, v143
v_mfma_f32_16x16x32_bf16 v[148:151], a[204:207], v[84:87], v[148:151]
ds_read_b128 a[160:163], v3 offset:2048
v_cndmask_b32 v102, v216, v17, s[50:51]
v_mfma_f32_16x16x32_bf16 v[132:135], a[204:207], v[68:71], v[224:227]
ds_read_b128 a[164:167], v3 offset:10240
v_cndmask_b32 v103, v216, v17, s[100:101]
v_mfma_f32_16x16x32_bf16 v[132:135], a[200:203], v[64:67], v[132:135]
v_exp_f32 v109, v109
v_mfma_f32_16x16x32_bf16 v[132:135], a[196:199], v[60:63], v[132:135]
v_exp_f32 v110, v110
v_mfma_f32_16x16x32_bf16 v[132:135], a[192:195], v[56:59], v[132:135]
v_exp_f32 v111, v111
v_mfma_f32_16x16x32_bf16 v[116:119], a[192:195], v[40:43], v[220:223]
v_exp_f32 v92, v92
v_mfma_f32_16x16x32_bf16 v[116:119], a[196:199], v[44:47], v[116:119]
v_cvt_pk_bf16_f32 v186, v124, v125
v_cvt_pk_bf16_f32 v187, v126, v127
v_mfma_f32_16x16x32_bf16 v[116:119], a[200:203], v[48:51], v[116:119]
v_exp_f32 v93, v93
v_mfma_f32_16x16x32_bf16 v[116:119], a[204:207], v[52:55], v[116:119]
v_exp_f32 v94, v94
v_mfma_f32_16x16x32_bf16 v[100:103], a[204:207], v[36:39], v[100:103]
v_exp_f32 v95, v95
v_mfma_f32_16x16x32_bf16 v[100:103], a[200:203], v[32:35], v[100:103]
v_exp_f32 v96, v96
v_mfma_f32_16x16x32_bf16 v[100:103], a[196:199], v[28:31], v[100:103]
v_exp_f32 v97, v97
v_mfma_f32_16x16x32_bf16 v[100:103], a[192:195], v[24:27], v[100:103]
v_exp_f32 v98, v98
v_smfmac_f32_16x16x64_bf16 a[128:131], a[240:243], v[168:175], v5
ds_read_b128 a[168:171], v3 offset:3072
v_smfmac_f32_16x16x64_bf16 a[132:135], a[240:243], v[176:183], v5
v_cvt_pk_bf16_f32 v162, v108, v109
v_smfmac_f32_16x16x64_bf16 a[136:139], a[240:243], v[200:207], v5
ds_read_b128 a[172:175], v3 offset:11264
v_smfmac_f32_16x16x64_bf16 a[140:143], a[240:243], v[208:215], v5
s_waitcnt lgkmcnt(2)
buffer_load_dwordx4 v16, s[32:35], s64 offen offset:2048 sc1 lds
v_mfma_f32_16x16x32_bf16 a[0:3], a[144:147], v[168:171], a[0:3]
v_exp_f32 v99, v99
v_mfma_f32_16x16x32_bf16 a[0:3], a[148:151], v[172:175], a[0:3]
v_cvt_pk_bf16_f32 v163, v110, v111
v_cvt_pk_bf16_f32 v154, v92, v93
v_mfma_f32_16x16x32_bf16 a[32:35], a[148:151], v[180:183], a[32:35]
v_exp_f32 v112, v112
v_mfma_f32_16x16x32_bf16 a[32:35], a[144:147], v[176:179], a[32:35]
v_exp_f32 v113, v113
v_mfma_f32_16x16x32_bf16 a[64:67], a[144:147], v[200:203], a[64:67]
v_exp_f32 v114, v114
v_mfma_f32_16x16x32_bf16 a[64:67], a[148:151], v[204:207], a[64:67]
v_exp_f32 v115, v115
v_mfma_f32_16x16x32_bf16 a[96:99], a[148:151], v[212:215], a[96:99]
v_exp_f32 v128, v128
v_mfma_f32_16x16x32_bf16 a[96:99], a[144:147], v[208:211], a[96:99]
v_exp_f32 v129, v129
v_mfma_f32_16x16x32_bf16 a[100:103], a[152:155], v[208:211], a[100:103]
v_exp_f32 v130, v130
v_mfma_f32_16x16x32_bf16 a[100:103], a[156:159], v[212:215], a[100:103]
v_cvt_pk_bf16_f32 v155, v94, v95
v_cvt_pk_bf16_f32 v156, v96, v97
v_mfma_f32_16x16x32_bf16 a[68:71], a[156:159], v[204:207], a[68:71]
v_exp_f32 v131, v131
v_mfma_f32_16x16x32_bf16 a[68:71], a[152:155], v[200:203], a[68:71]
buffer_load_dwordx4 v16, s[32:35], s64 offen offset:3072 sc1 lds
v_mfma_f32_16x16x32_bf16 a[36:39], a[152:155], v[176:179], a[36:39]
s_add_u32 m0, s86, 135168
ds_read_b128 a[176:179], v3 offset:4096
v_cvt_pk_bf16_f32 v157, v98, v99
v_mfma_f32_16x16x32_bf16 a[36:39], a[156:159], v[180:183], a[36:39]
s_add_u32 s64, s85, 32768
v_exp_f32 v144, v144
v_mfma_f32_16x16x32_bf16 a[4:7], a[156:159], v[172:175], a[4:7]
buffer_load_dwordx4 v12, s[36:39], s64 offen lds
v_mfma_f32_16x16x32_bf16 a[4:7], a[152:155], v[168:171], a[4:7]
s_add_u32 m0, s86, 136192
ds_read_b128 a[180:183], v3 offset:12288
v_cvt_pk_bf16_f32 v164, v112, v113
v_mfma_f32_16x16x32_bf16 a[8:11], a[160:163], v[168:171], a[8:11]
s_add_u32 s64, s85, 40960
v_exp_f32 v145, v145
v_mfma_f32_16x16x32_bf16 a[8:11], a[164:167], v[172:175], a[8:11]
buffer_load_dwordx4 v13, s[36:39], s64 offen lds
v_mfma_f32_16x16x32_bf16 a[40:43], a[164:167], v[180:183], a[40:43]
ds_read_b128 a[184:187], v3 offset:5120
v_cvt_pk_bf16_f32 v165, v114, v115
v_mfma_f32_16x16x32_bf16 a[40:43], a[160:163], v[176:179], a[40:43]
ds_read_b128 a[188:191], v3 offset:13312
v_cvt_pk_bf16_f32 v188, v128, v129
v_mfma_f32_16x16x32_bf16 a[72:75], a[160:163], v[200:203], a[72:75]
ds_read_b128 a[192:195], v3 offset:6144
v_cvt_pk_bf16_f32 v189, v130, v131
v_mfma_f32_16x16x32_bf16 a[72:75], a[164:167], v[204:207], a[72:75]
ds_read_b128 a[196:199], v3 offset:14336
v_cvt_pk_bf16_f32 v196, v144, v145
v_mfma_f32_16x16x32_bf16 a[104:107], a[164:167], v[212:215], a[104:107]
ds_read_b128 a[200:203], v3 offset:7168
v_mfma_f32_16x16x32_bf16 a[104:107], a[160:163], v[208:211], a[104:107]
s_waitcnt lgkmcnt(5)
s_add_u32 m0, s86, 137216
ds_read_b128 a[204:207], v3 offset:15360
v_mfma_f32_16x16x32_bf16 a[108:111], a[168:171], v[208:211], a[108:111]
s_add_u32 s64, s85, 49152
v_exp_f32 v146, v146
v_mfma_f32_16x16x32_bf16 a[108:111], a[172:175], v[212:215], a[108:111]
buffer_load_dwordx4 v12, s[36:39], s64 offen lds
v_mfma_f32_16x16x32_bf16 a[76:79], a[172:175], v[204:207], a[76:79]
s_add_u32 m0, s86, 138240
v_exp_f32 v147, v147
v_mfma_f32_16x16x32_bf16 a[76:79], a[168:171], v[200:203], a[76:79]
s_add_u32 s64, s85, 57344
v_exp_f32 v148, v148
v_mfma_f32_16x16x32_bf16 a[44:47], a[168:171], v[176:179], a[44:47]
buffer_load_dwordx4 v13, s[36:39], s64 offen lds
v_mfma_f32_16x16x32_bf16 a[44:47], a[172:175], v[180:183], a[44:47]
s_waitcnt vmcnt(16)
s_barrier
v_mfma_f32_16x16x32_bf16 a[12:15], a[172:175], v[172:175], a[12:15]
s_xor_b32 s71, s71, 16384
v_exp_f32 v149, v149
v_mfma_f32_16x16x32_bf16 a[12:15], a[168:171], v[168:171], a[12:15]
s_add_u32 s70, s70, 32768
v_exp_f32 v150, v150
v_mfma_f32_16x16x32_bf16 a[16:19], a[176:179], v[168:171], a[16:19]
s_mov_b32 m0, s71
v_exp_f32 v151, v151
v_mfma_f32_16x16x32_bf16 a[16:19], a[180:183], v[172:175], a[16:19]
buffer_load_dwordx4 v16, s[32:35], s70 offen offset:0 sc1 lds
v_mfma_f32_16x16x32_bf16 a[48:51], a[180:183], v[180:183], a[48:51]
v_exp_f32 v132, v132
v_mfma_f32_16x16x32_bf16 a[48:51], a[176:179], v[176:179], a[48:51]
v_exp_f32 v133, v133
v_mfma_f32_16x16x32_bf16 a[80:83], a[176:179], v[200:203], a[80:83]
v_exp_f32 v134, v134
v_mfma_f32_16x16x32_bf16 a[80:83], a[180:183], v[204:207], a[80:83]
v_exp_f32 v135, v135
v_mfma_f32_16x16x32_bf16 a[112:115], a[180:183], v[212:215], a[112:115]
v_exp_f32 v116, v116
v_mfma_f32_16x16x32_bf16 a[112:115], a[176:179], v[208:211], a[112:115]
s_waitcnt lgkmcnt(0)
v_cvt_pk_bf16_f32 v197, v146, v147
v_cvt_pk_bf16_f32 v198, v148, v149
v_mfma_f32_16x16x32_bf16 a[116:119], a[184:187], v[208:211], a[116:119]
v_exp_f32 v117, v117
v_mfma_f32_16x16x32_bf16 a[116:119], a[188:191], v[212:215], a[116:119]
v_exp_f32 v118, v118
v_mfma_f32_16x16x32_bf16 a[84:87], a[188:191], v[204:207], a[84:87]
v_exp_f32 v119, v119
v_mfma_f32_16x16x32_bf16 a[84:87], a[184:187], v[200:203], a[84:87]
v_exp_f32 v100, v100
v_mfma_f32_16x16x32_bf16 a[52:55], a[184:187], v[176:179], a[52:55]
v_exp_f32 v101, v101
v_mfma_f32_16x16x32_bf16 a[52:55], a[188:191], v[180:183], a[52:55]
ds_read_b128 a[144:147], v2 offset:16384
v_cvt_pk_bf16_f32 v199, v150, v151
v_mfma_f32_16x16x32_bf16 a[20:23], a[188:191], v[172:175], a[20:23]
ds_read_b128 a[148:151], v2 offset:17408
v_cvt_pk_bf16_f32 v190, v132, v133
v_mfma_f32_16x16x32_bf16 a[20:23], a[184:187], v[168:171], a[20:23]
v_exp_f32 v102, v102
v_mfma_f32_16x16x32_bf16 a[24:27], a[192:195], v[168:171], a[24:27]
buffer_load_dwordx4 v16, s[32:35], s70 offen offset:1024 sc1 lds
v_mfma_f32_16x16x32_bf16 a[24:27], a[196:199], v[172:175], a[24:27]
ds_read_b128 a[152:155], v2 offset:18432
v_cvt_pk_bf16_f32 v191, v134, v135
v_mfma_f32_16x16x32_bf16 a[56:59], a[196:199], v[180:183], a[56:59]
ds_read_b128 a[156:159], v2 offset:19456
v_cvt_pk_bf16_f32 v166, v116, v117
v_mfma_f32_16x16x32_bf16 a[56:59], a[192:195], v[176:179], a[56:59]
v_exp_f32 v103, v103
v_mfma_f32_16x16x32_bf16 a[88:91], a[192:195], v[200:203], a[88:91]
ds_read_b128 a[160:163], v2 offset:20480
v_cvt_pk_bf16_f32 v167, v118, v119
v_mfma_f32_16x16x32_bf16 a[88:91], a[196:199], v[204:207], a[88:91]
ds_read_b128 a[164:167], v2 offset:21504
v_cvt_pk_bf16_f32 v158, v100, v101
v_mfma_f32_16x16x32_bf16 a[120:123], a[196:199], v[212:215], a[120:123]
ds_read_b128 a[168:171], v2 offset:22528
v_cvt_pk_bf16_f32 v159, v102, v103
v_mfma_f32_16x16x32_bf16 a[120:123], a[192:195], v[208:211], a[120:123]
ds_read_b128 a[172:175], v2 offset:23552
v_cndmask_b32 v104, v220, v17, s[0:1]
v_mfma_f32_16x16x32_bf16 a[124:127], a[200:203], v[208:211], a[124:127]
v_cndmask_b32 v105, v220, v17, s[4:5]
v_cndmask_b32 v106, v220, v17, s[6:7]
v_mfma_f32_16x16x32_bf16 a[124:127], a[204:207], v[212:215], a[124:127]
v_cndmask_b32 v107, v220, v17, s[8:9]
v_cndmask_b32 v108, v220, v17, s[10:11]
v_mfma_f32_16x16x32_bf16 a[92:95], a[204:207], v[204:207], a[92:95]
v_cndmask_b32 v109, v220, v17, s[12:13]
v_cndmask_b32 v110, v220, v17, s[18:19]
v_mfma_f32_16x16x32_bf16 a[92:95], a[200:203], v[200:203], a[92:95]
v_cndmask_b32 v111, v220, v17, s[22:23]
v_cndmask_b32 v112, v220, v17, s[26:27]
v_mfma_f32_16x16x32_bf16 a[60:63], a[200:203], v[176:179], a[60:63]
v_cndmask_b32 v113, v220, v17, s[56:57]
v_cndmask_b32 v114, v220, v17, s[58:59]
v_mfma_f32_16x16x32_bf16 a[60:63], a[204:207], v[180:183], a[60:63]
v_cndmask_b32 v115, v220, v17, s[60:61]
v_cndmask_b32 v116, v220, v17, s[62:63]
v_mfma_f32_16x16x32_bf16 a[28:31], a[204:207], v[172:175], a[28:31]
v_cndmask_b32 v117, v220, v17, s[48:49]
v_cndmask_b32 v118, v220, v17, s[50:51]
v_mfma_f32_16x16x32_bf16 a[28:31], a[200:203], v[168:171], a[28:31]
s_waitcnt lgkmcnt(0)
v_cndmask_b32 v119, v220, v17, s[100:101]
v_mfma_f32_16x16x32_bf16 v[120:123], a[144:147], v[56:59], v[224:227]
ds_read_b128 a[176:179], v2 offset:24576
v_mfma_f32_16x16x32_bf16 v[120:123], a[148:151], v[60:63], v[120:123]
ds_read_b128 a[180:183], v2 offset:25600
v_mfma_f32_16x16x32_bf16 v[120:123], a[152:155], v[64:67], v[120:123]
buffer_load_dwordx4 v16, s[32:35], s70 offen offset:2048 sc1 lds
v_mfma_f32_16x16x32_bf16 v[120:123], a[156:159], v[68:71], v[120:123]
ds_read_b128 a[184:187], v2 offset:26624
v_mfma_f32_16x16x32_bf16 v[136:139], a[156:159], v[84:87], v[228:231]
ds_read_b128 a[188:191], v2 offset:27648
v_mfma_f32_16x16x32_bf16 v[136:139], a[152:155], v[80:83], v[136:139]
v_mfma_f32_16x16x32_bf16 v[136:139], a[148:151], v[76:79], v[136:139]
v_mfma_f32_16x16x32_bf16 v[136:139], a[144:147], v[72:75], v[136:139]
v_mfma_f32_16x16x32_bf16 v[104:107], a[144:147], v[40:43], v[104:107]
ds_read_b128 a[192:195], v2 offset:28672
v_mfma_f32_16x16x32_bf16 v[104:107], a[148:151], v[44:47], v[104:107]
v_mfma_f32_16x16x32_bf16 v[104:107], a[152:155], v[48:51], v[104:107]
v_exp_f32 v120, v120
v_mfma_f32_16x16x32_bf16 v[104:107], a[156:159], v[52:55], v[104:107]
v_exp_f32 v121, v121
v_mfma_f32_16x16x32_bf16 v[140:143], a[172:175], v[84:87], v[228:231]
v_exp_f32 v122, v122
v_mfma_f32_16x16x32_bf16 v[140:143], a[168:171], v[80:83], v[140:143]
v_exp_f32 v123, v123
v_mfma_f32_16x16x32_bf16 v[140:143], a[164:167], v[76:79], v[140:143]
v_exp_f32 v136, v136
v_mfma_f32_16x16x32_bf16 v[140:143], a[160:163], v[72:75], v[140:143]
buffer_load_dwordx4 v16, s[32:35], s70 offen offset:3072 sc1 lds
v_mfma_f32_16x16x32_bf16 v[124:127], a[160:163], v[56:59], v[224:227]
v_exp_f32 v137, v137
v_mfma_f32_16x16x32_bf16 v[124:127], a[164:167], v[60:63], v[124:127]
v_exp_f32 v138, v138
v_mfma_f32_16x16x32_bf16 v[124:127], a[168:171], v[64:67], v[124:127]
v_exp_f32 v139, v139
v_mfma_f32_16x16x32_bf16 v[124:127], a[172:175], v[68:71], v[124:127]
v_exp_f32 v104, v104
v_mfma_f32_16x16x32_bf16 v[108:111], a[172:175], v[52:55], v[108:111]
v_cvt_pk_bf16_f32 v200, v120, v121
v_cvt_pk_bf16_f32 v201, v122, v123
v_mfma_f32_16x16x32_bf16 v[108:111], a[168:171], v[48:51], v[108:111]
ds_read_b128 a[196:199], v2 offset:29696
v_cvt_pk_bf16_f32 v208, v136, v137
v_mfma_f32_16x16x32_bf16 v[108:111], a[164:167], v[44:47], v[108:111]
ds_read_b128 a[200:203], v2 offset:30720
v_cvt_pk_bf16_f32 v209, v138, v139
v_mfma_f32_16x16x32_bf16 v[108:111], a[160:163], v[40:43], v[108:111]
s_waitcnt lgkmcnt(2)
ds_read_b128 a[204:207], v2 offset:31744
v_mfma_f32_16x16x32_bf16 v[112:115], a[176:179], v[40:43], v[112:115]
v_exp_f32 v105, v105
v_mfma_f32_16x16x32_bf16 v[112:115], a[180:183], v[44:47], v[112:115]
v_exp_f32 v106, v106
v_mfma_f32_16x16x32_bf16 v[112:115], a[184:187], v[48:51], v[112:115]
v_exp_f32 v107, v107
v_mfma_f32_16x16x32_bf16 v[112:115], a[188:191], v[52:55], v[112:115]
s_add_u32 m0, s71, 4096
v_exp_f32 v140, v140
v_mfma_f32_16x16x32_bf16 v[128:131], a[188:191], v[68:71], v[224:227]
s_branch L_po17
L_pg17:
s_branch L_pg21
L_po17:
s_add_u32 s64, s70, 4096
v_exp_f32 v141, v141
v_mfma_f32_16x16x32_bf16 v[128:131], a[184:187], v[64:67], v[128:131]
buffer_load_dwordx4 v16, s[32:35], s64 offen offset:0 sc1 lds
v_mfma_f32_16x16x32_bf16 v[128:131], a[180:183], v[60:63], v[128:131]
v_exp_f32 v142, v142
v_mfma_f32_16x16x32_bf16 v[128:131], a[176:179], v[56:59], v[128:131]
v_exp_f32 v143, v143
v_mfma_f32_16x16x32_bf16 v[144:147], a[176:179], v[72:75], v[228:231]
ds_read_b128 a[144:147], v3 offset:16384
v_cvt_pk_bf16_f32 v176, v104, v105
v_mfma_f32_16x16x32_bf16 v[144:147], a[180:183], v[76:79], v[144:147]
ds_read_b128 a[148:151], v3 offset:24576
v_cvt_pk_bf16_f32 v177, v106, v107
v_mfma_f32_16x16x32_bf16 v[144:147], a[184:187], v[80:83], v[144:147]
v_exp_f32 v124, v124
v_mfma_f32_16x16x32_bf16 v[144:147], a[188:191], v[84:87], v[144:147]
s_waitcnt lgkmcnt(2)
v_exp_f32 v125, v125
v_mfma_f32_16x16x32_bf16 v[148:151], a[204:207], v[84:87], v[228:231]
v_exp_f32 v126, v126
v_mfma_f32_16x16x32_bf16 v[148:151], a[200:203], v[80:83], v[148:151]
v_exp_f32 v127, v127
v_mfma_f32_16x16x32_bf16 v[148:151], a[196:199], v[76:79], v[148:151]
ds_read_b128 a[152:155], v3 offset:17408
v_cvt_pk_bf16_f32 v210, v140, v141
v_mfma_f32_16x16x32_bf16 v[148:151], a[192:195], v[72:75], v[148:151]
ds_read_b128 a[156:159], v3 offset:25600
v_cvt_pk_bf16_f32 v211, v142, v143
v_mfma_f32_16x16x32_bf16 v[132:135], a[192:195], v[56:59], v[224:227]
v_exp_f32 v108, v108
v_mfma_f32_16x16x32_bf16 v[132:135], a[196:199], v[60:63], v[132:135]
v_exp_f32 v109, v109
v_mfma_f32_16x16x32_bf16 v[132:135], a[200:203], v[64:67], v[132:135]
buffer_load_dwordx4 v16, s[32:35], s64 offen offset:1024 sc1 lds
v_mfma_f32_16x16x32_bf16 v[132:135], a[204:207], v[68:71], v[132:135]
v_exp_f32 v110, v110
v_mfma_f32_16x16x32_bf16 v[116:119], a[204:207], v[52:55], v[116:119]
ds_read_b128 a[160:163], v3 offset:18432
v_cvt_pk_bf16_f32 v202, v124, v125
v_mfma_f32_16x16x32_bf16 v[116:119], a[200:203], v[48:51], v[116:119]
v_exp_f32 v111, v111
v_mfma_f32_16x16x32_bf16 v[116:119], a[196:199], v[44:47], v[116:119]
ds_read_b128 a[164:167], v3 offset:26624
v_cvt_pk_bf16_f32 v203, v126, v127
v_mfma_f32_16x16x32_bf16 v[116:119], a[192:195], v[40:43], v[116:119]
v_exp_f32 v112, v112
v_smfmac_f32_16x16x64_bf16 a[128:131], a[240:243], v[152:159], v5
ds_read_b128 a[168:171], v3 offset:19456
v_smfmac_f32_16x16x64_bf16 a[132:135], a[240:243], v[160:167], v5
ds_read_b128 a[172:175], v3 offset:27648
v_smfmac_f32_16x16x64_bf16 a[136:139], a[240:243], v[184:191], v5
ds_read_b128 a[176:179], v3 offset:20480
v_smfmac_f32_16x16x64_bf16 a[140:143], a[240:243], v[192:199], v5
s_waitcnt lgkmcnt(4)
ds_read_b128 a[180:183], v3 offset:28672
v_xor_b32 v2, 0x8000, v2
v_mfma_f32_16x16x32_bf16 a[0:3], a[144:147], v[152:155], a[0:3]
v_exp_f32 v113, v113
v_mfma_f32_16x16x32_bf16 a[0:3], a[148:151], v[156:159], a[0:3]
v_exp_f32 v114, v114
v_mfma_f32_16x16x32_bf16 a[32:35], a[148:151], v[164:167], a[32:35]
v_exp_f32 v115, v115
v_mfma_f32_16x16x32_bf16 a[32:35], a[144:147], v[160:163], a[32:35]
v_exp_f32 v128, v128
v_mfma_f32_16x16x32_bf16 a[64:67], a[144:147], v[184:187], a[64:67]
buffer_load_dwordx4 v16, s[32:35], s64 offen offset:2048 sc1 lds
v_mfma_f32_16x16x32_bf16 a[64:67], a[148:151], v[188:191], a[64:67]
v_exp_f32 v129, v129
v_mfma_f32_16x16x32_bf16 a[96:99], a[148:151], v[196:199], a[96:99]
v_exp_f32 v130, v130
v_mfma_f32_16x16x32_bf16 a[96:99], a[144:147], v[192:195], a[96:99]
v_exp_f32 v131, v131
v_mfma_f32_16x16x32_bf16 a[100:103], a[152:155], v[192:195], a[100:103]
v_exp_f32 v144, v144
v_mfma_f32_16x16x32_bf16 a[100:103], a[156:159], v[196:199], a[100:103]
v_exp_f32 v145, v145
v_mfma_f32_16x16x32_bf16 a[68:71], a[156:159], v[188:191], a[68:71]
ds_read_b128 a[184:187], v3 offset:21504
v_cvt_pk_bf16_f32 v178, v108, v109
v_mfma_f32_16x16x32_bf16 a[68:71], a[152:155], v[184:187], a[68:71]
ds_read_b128 a[188:191], v3 offset:29696
v_cvt_pk_bf16_f32 v179, v110, v111
v_mfma_f32_16x16x32_bf16 a[36:39], a[152:155], v[160:163], a[36:39]
ds_read_b128 a[192:195], v3 offset:22528
v_cvt_pk_bf16_f32 v180, v112, v113
v_mfma_f32_16x16x32_bf16 a[36:39], a[156:159], v[164:167], a[36:39]
v_exp_f32 v146, v146
v_mfma_f32_16x16x32_bf16 a[4:7], a[156:159], v[156:159], a[4:7]
v_exp_f32 v147, v147
v_mfma_f32_16x16x32_bf16 a[4:7], a[152:155], v[152:155], a[4:7]
v_exp_f32 v148, v148
v_mfma_f32_16x16x32_bf16 a[8:11], a[160:163], v[152:155], a[8:11]
s_waitcnt lgkmcnt(2)
ds_read_b128 a[196:199], v3 offset:30720
v_cvt_pk_bf16_f32 v181, v114, v115
v_mfma_f32_16x16x32_bf16 a[8:11], a[164:167], v[156:159], a[8:11]
buffer_load_dwordx4 v16, s[32:35], s64 offen offset:3072 sc1 lds
v_mfma_f32_16x16x32_bf16 a[40:43], a[164:167], v[164:167], a[40:43]
v_exp_f32 v149, v149
v_mfma_f32_16x16x32_bf16 a[40:43], a[160:163], v[160:163], a[40:43]
ds_read_b128 a[200:203], v3 offset:23552
v_cvt_pk_bf16_f32 v204, v128, v129
v_mfma_f32_16x16x32_bf16 a[72:75], a[160:163], v[184:187], a[72:75]
v_exp_f32 v150, v150
v_mfma_f32_16x16x32_bf16 a[72:75], a[164:167], v[188:191], a[72:75]
v_exp_f32 v151, v151
v_mfma_f32_16x16x32_bf16 a[104:107], a[164:167], v[196:199], a[104:107]
v_exp_f32 v132, v132
v_mfma_f32_16x16x32_bf16 a[104:107], a[160:163], v[192:195], a[104:107]
ds_read_b128 a[204:207], v3 offset:31744
v_cvt_pk_bf16_f32 v205, v130, v131
v_mfma_f32_16x16x32_bf16 a[108:111], a[168:171], v[192:195], a[108:111]
v_exp_f32 v133, v133
v_mfma_f32_16x16x32_bf16 a[108:111], a[172:175], v[196:199], a[108:111]
v_exp_f32 v134, v134
v_mfma_f32_16x16x32_bf16 a[76:79], a[172:175], v[188:191], a[76:79]
v_exp_f32 v135, v135
v_mfma_f32_16x16x32_bf16 a[76:79], a[168:171], v[184:187], a[76:79]
v_exp_f32 v116, v116
v_mfma_f32_16x16x32_bf16 a[44:47], a[168:171], v[160:163], a[44:47]
v_exp_f32 v117, v117
v_mfma_f32_16x16x32_bf16 a[44:47], a[172:175], v[164:167], a[44:47]
v_exp_f32 v118, v118
v_mfma_f32_16x16x32_bf16 a[12:15], a[172:175], v[156:159], a[12:15]
v_exp_f32 v119, v119
v_mfma_f32_16x16x32_bf16 a[12:15], a[168:171], v[152:155], a[12:15]
v_cvt_pk_bf16_f32 v212, v144, v145
v_cvt_pk_bf16_f32 v213, v146, v147
v_mfma_f32_16x16x32_bf16 a[16:19], a[176:179], v[152:155], a[16:19]
v_cvt_pk_bf16_f32 v214, v148, v149
v_cvt_pk_bf16_f32 v215, v150, v151
v_mfma_f32_16x16x32_bf16 a[16:19], a[180:183], v[156:159], a[16:19]
s_waitcnt vmcnt(12)
s_barrier
v_mfma_f32_16x16x32_bf16 a[48:51], a[180:183], v[164:167], a[48:51]
s_xor_b32 s71, s71, 49152
ds_read_b128 a[144:147], v2 offset:0
v_cvt_pk_bf16_f32 v206, v132, v133
v_mfma_f32_16x16x32_bf16 a[48:51], a[176:179], v[160:163], a[48:51]
s_add_u32 s70, s70, 32768
ds_read_b128 a[148:151], v2 offset:1024
v_cvt_pk_bf16_f32 v207, v134, v135
v_mfma_f32_16x16x32_bf16 a[80:83], a[176:179], v[184:187], a[80:83]
s_mov_b32 m0, s71
ds_read_b128 a[152:155], v2 offset:2048
v_cvt_pk_bf16_f32 v182, v116, v117
v_mfma_f32_16x16x32_bf16 a[80:83], a[180:183], v[188:191], a[80:83]
buffer_load_dwordx4 v16, s[32:35], s70 offen offset:0 sc1 lds
v_mfma_f32_16x16x32_bf16 a[112:115], a[180:183], v[196:199], a[112:115]
ds_read_b128 a[156:159], v2 offset:3072
v_cvt_pk_bf16_f32 v183, v118, v119
v_mfma_f32_16x16x32_bf16 a[112:115], a[176:179], v[192:195], a[112:115]
ds_read_b128 a[160:163], v2 offset:4096
v_xor_b32 v3, 0x8000, v3
v_mfma_f32_16x16x32_bf16 a[116:119], a[184:187], v[192:195], a[116:119]
s_waitcnt lgkmcnt(4)
ds_read_b128 a[164:167], v2 offset:5120
v_accvgpr_read_b32 v20, a128
v_mfma_f32_16x16x32_bf16 a[116:119], a[188:191], v[196:199], a[116:119]
ds_read_b128 a[168:171], v2 offset:6144
v_accvgpr_read_b32 v248, a129
v_mfma_f32_16x16x32_bf16 a[84:87], a[188:191], v[188:191], a[84:87]
ds_read_b128 a[172:175], v2 offset:7168
v_add_f32 v20, v20, v248
v_mfma_f32_16x16x32_bf16 a[84:87], a[184:187], v[184:187], a[84:87]
v_max_f32 v1, v1, v20
v_mfma_f32_16x16x32_bf16 a[52:55], a[184:187], v[160:163], a[52:55]
v_rcp_f32 v20, v20
v_mfma_f32_16x16x32_bf16 a[52:55], a[188:191], v[164:167], a[52:55]
v_accvgpr_read_b32 v232, a0
v_accvgpr_read_b32 v233, a1
v_mfma_f32_16x16x32_bf16 a[20:23], a[188:191], v[156:159], a[20:23]
v_accvgpr_read_b32 v234, a2
v_accvgpr_read_b32 v235, a3
v_mfma_f32_16x16x32_bf16 a[20:23], a[184:187], v[152:155], a[20:23]
v_accvgpr_read_b32 v236, a4
v_accvgpr_read_b32 v237, a5
v_mfma_f32_16x16x32_bf16 a[24:27], a[192:195], v[152:155], a[24:27]
v_accvgpr_read_b32 v238, a6
v_accvgpr_read_b32 v239, a7
v_mfma_f32_16x16x32_bf16 a[24:27], a[196:199], v[156:159], a[24:27]
v_mul_f32 v20, v20, v4
v_mul_f32 v232, v232, v20
v_mfma_f32_16x16x32_bf16 a[56:59], a[196:199], v[164:167], a[56:59]
buffer_load_dwordx4 v16, s[32:35], s70 offen offset:1024 sc1 lds
v_mfma_f32_16x16x32_bf16 a[56:59], a[192:195], v[160:163], a[56:59]
v_mul_f32 v233, v233, v20
v_mul_f32 v234, v234, v20
v_mfma_f32_16x16x32_bf16 a[88:91], a[192:195], v[184:187], a[88:91]
v_mul_f32 v235, v235, v20
v_mul_f32 v236, v236, v20
v_mfma_f32_16x16x32_bf16 a[88:91], a[196:199], v[188:191], a[88:91]
v_mul_f32 v237, v237, v20
v_mul_f32 v238, v238, v20
v_mfma_f32_16x16x32_bf16 a[120:123], a[196:199], v[196:199], a[120:123]
v_mul_f32 v239, v239, v20
v_cvt_pk_bf16_f32 v232, v232, v233
v_mfma_f32_16x16x32_bf16 a[120:123], a[192:195], v[192:195], a[120:123]
v_cvt_pk_bf16_f32 v233, v234, v235
v_cvt_pk_bf16_f32 v234, v236, v237
v_mfma_f32_16x16x32_bf16 a[124:127], a[200:203], v[192:195], a[124:127]
v_cvt_pk_bf16_f32 v235, v238, v239
v_mfma_f32_16x16x32_bf16 a[124:127], a[204:207], v[196:199], a[124:127]
s_add_u32 s77, s74, 0
buffer_store_dwordx4 v[232:235], v16, s[44:47], s77 offen sc1
v_mfma_f32_16x16x32_bf16 a[92:95], a[204:207], v[188:191], a[92:95]
v_accvgpr_read_b32 v240, a8
v_accvgpr_read_b32 v241, a9
v_mfma_f32_16x16x32_bf16 a[92:95], a[200:203], v[184:187], a[92:95]
v_accvgpr_read_b32 v242, a10
v_accvgpr_read_b32 v243, a11
v_mfma_f32_16x16x32_bf16 a[60:63], a[200:203], v[160:163], a[60:63]
v_accvgpr_read_b32 v244, a12
v_accvgpr_read_b32 v245, a13
v_mfma_f32_16x16x32_bf16 a[60:63], a[204:207], v[164:167], a[60:63]
v_accvgpr_read_b32 v246, a14
v_accvgpr_read_b32 v247, a15
v_mfma_f32_16x16x32_bf16 a[28:31], a[204:207], v[156:159], a[28:31]
v_mul_f32 v240, v240, v20
v_mul_f32 v241, v241, v20
v_mfma_f32_16x16x32_bf16 a[28:31], a[200:203], v[152:155], a[28:31]
v_mul_f32 v242, v242, v20
v_mul_f32 v243, v243, v20
v_mul_f32 v244, v244, v20
v_mul_f32 v245, v245, v20
v_mul_f32 v246, v246, v20
v_mul_f32 v247, v247, v20
v_cvt_pk_bf16_f32 v240, v240, v241
v_cvt_pk_bf16_f32 v241, v242, v243
v_cvt_pk_bf16_f32 v242, v244, v245
v_cvt_pk_bf16_f32 v243, v246, v247
s_add_u32 s77, s74, 8192
buffer_store_dwordx4 v[240:243], v16, s[44:47], s77 offen sc1
v_accvgpr_read_b32 v232, a16
v_accvgpr_read_b32 v233, a17
v_accvgpr_read_b32 v234, a18
v_accvgpr_read_b32 v235, a19
v_accvgpr_read_b32 v236, a20
v_accvgpr_read_b32 v237, a21
v_accvgpr_read_b32 v238, a22
v_accvgpr_read_b32 v239, a23
v_mul_f32 v232, v232, v20
v_mul_f32 v233, v233, v20
v_mul_f32 v234, v234, v20
v_mul_f32 v235, v235, v20
v_mul_f32 v236, v236, v20
v_mul_f32 v237, v237, v20
v_mul_f32 v238, v238, v20
v_mul_f32 v239, v239, v20
v_cvt_pk_bf16_f32 v232, v232, v233
v_cvt_pk_bf16_f32 v233, v234, v235
v_cvt_pk_bf16_f32 v234, v236, v237
v_cvt_pk_bf16_f32 v235, v238, v239
s_add_u32 s77, s74, 16384
buffer_store_dwordx4 v[232:235], v16, s[44:47], s77 offen sc1
s_cmp_eq_u32 s3, 7
s_cbranch_scc1 L_T1
L_T:
s_waitcnt lgkmcnt(7)
v_mfma_f32_16x16x32_bf16 v[120:123], a[144:147], v[56:59], v[224:227]
s_waitcnt lgkmcnt(6)
ds_read_b128 a[176:179], v2 offset:8192
v_mfma_f32_16x16x32_bf16 v[120:123], a[148:151], v[60:63], v[120:123]
s_waitcnt lgkmcnt(6)
ds_read_b128 a[180:183], v2 offset:9216
v_mfma_f32_16x16x32_bf16 v[120:123], a[152:155], v[64:67], v[120:123]
s_waitcnt lgkmcnt(6)
buffer_load_dwordx4 v16, s[32:35], s70 offen offset:2048 sc1 lds
v_mfma_f32_16x16x32_bf16 v[120:123], a[156:159], v[68:71], v[120:123]
ds_read_b128 a[184:187], v2 offset:10240
v_mfma_f32_16x16x32_bf16 v[136:139], a[156:159], v[84:87], v[228:231]
ds_read_b128 a[188:191], v2 offset:11264
v_mfma_f32_16x16x32_bf16 v[136:139], a[152:155], v[80:83], v[136:139]
ds_read_b128 a[192:195], v2 offset:12288
v_mfma_f32_16x16x32_bf16 v[136:139], a[148:151], v[76:79], v[136:139]
ds_read_b128 a[196:199], v2 offset:13312
v_mfma_f32_16x16x32_bf16 v[136:139], a[144:147], v[72:75], v[136:139]
s_waitcnt lgkmcnt(4)
v_mfma_f32_16x16x32_bf16 v[140:143], a[160:163], v[72:75], v[228:231]
ds_read_b128 a[200:203], v2 offset:14336
v_accvgpr_read_b32 v240, a24
v_mfma_f32_16x16x32_bf16 v[140:143], a[164:167], v[76:79], v[140:143]
ds_read_b128 a[204:207], v2 offset:15360
v_accvgpr_read_b32 v241, a25
v_mfma_f32_16x16x32_bf16 v[140:143], a[168:171], v[80:83], v[140:143]
v_exp_f32 v120, v120
v_mfma_f32_16x16x32_bf16 v[140:143], a[172:175], v[84:87], v[140:143]
v_exp_f32 v121, v121
v_mfma_f32_16x16x32_bf16 v[124:127], a[172:175], v[68:71], v[224:227]
v_exp_f32 v122, v122
v_mfma_f32_16x16x32_bf16 v[124:127], a[168:171], v[64:67], v[124:127]
buffer_load_dwordx4 v16, s[32:35], s70 offen offset:3072 sc1 lds
v_mfma_f32_16x16x32_bf16 v[124:127], a[164:167], v[60:63], v[124:127]
v_exp_f32 v123, v123
v_mfma_f32_16x16x32_bf16 v[124:127], a[160:163], v[56:59], v[124:127]
v_exp_f32 v136, v136
v_mfma_f32_16x16x32_bf16 v[128:131], a[176:179], v[56:59], v[224:227]
v_exp_f32 v137, v137
v_mfma_f32_16x16x32_bf16 v[128:131], a[180:183], v[60:63], v[128:131]
s_waitcnt lgkmcnt(0)
v_exp_f32 v138, v138
v_mfma_f32_16x16x32_bf16 v[128:131], a[184:187], v[64:67], v[128:131]
v_exp_f32 v139, v139
v_mfma_f32_16x16x32_bf16 v[128:131], a[188:191], v[68:71], v[128:131]
s_add_u32 m0, s71, 4096
ds_read_b128 a[144:147], v3 offset:0
v_cvt_pk_bf16_f32 v184, v120, v121
v_mfma_f32_16x16x32_bf16 v[144:147], a[188:191], v[84:87], v[228:231]
s_add_u32 s64, s70, 4096
ds_read_b128 a[148:151], v3 offset:8192
v_cvt_pk_bf16_f32 v185, v122, v123
v_mfma_f32_16x16x32_bf16 v[144:147], a[184:187], v[80:83], v[144:147]
buffer_load_dwordx4 v16, s[32:35], s64 offen offset:0 sc1 lds
v_mfma_f32_16x16x32_bf16 v[144:147], a[180:183], v[76:79], v[144:147]
v_exp_f32 v140, v140
v_mfma_f32_16x16x32_bf16 v[144:147], a[176:179], v[72:75], v[144:147]
v_exp_f32 v141, v141
v_mfma_f32_16x16x32_bf16 v[148:151], a[192:195], v[72:75], v[228:231]
v_exp_f32 v142, v142
v_mfma_f32_16x16x32_bf16 v[148:151], a[196:199], v[76:79], v[148:151]
ds_read_b128 a[152:155], v3 offset:1024
v_cvt_pk_bf16_f32 v192, v136, v137
v_mfma_f32_16x16x32_bf16 v[148:151], a[200:203], v[80:83], v[148:151]
ds_read_b128 a[156:159], v3 offset:9216
v_cvt_pk_bf16_f32 v193, v138, v139
v_mfma_f32_16x16x32_bf16 v[148:151], a[204:207], v[84:87], v[148:151]
v_exp_f32 v143, v143
v_mfma_f32_16x16x32_bf16 v[132:135], a[204:207], v[68:71], v[224:227]
v_exp_f32 v124, v124
v_mfma_f32_16x16x32_bf16 v[132:135], a[200:203], v[64:67], v[132:135]
v_exp_f32 v125, v125
v_mfma_f32_16x16x32_bf16 v[132:135], a[196:199], v[60:63], v[132:135]
buffer_load_dwordx4 v16, s[32:35], s64 offen offset:1024 sc1 lds
v_mfma_f32_16x16x32_bf16 v[132:135], a[192:195], v[56:59], v[132:135]
ds_read_b128 a[160:163], v3 offset:2048
v_cvt_pk_bf16_f32 v194, v140, v141
v_smfmac_f32_16x16x64_bf16 a[132:135], a[240:243], v[176:183], v5
ds_read_b128 a[164:167], v3 offset:10240
v_smfmac_f32_16x16x64_bf16 a[136:139], a[240:243], v[200:207], v5
ds_read_b128 a[168:171], v3 offset:3072
v_accvgpr_read_b32 v242, a26
v_smfmac_f32_16x16x64_bf16 a[140:143], a[240:243], v[208:215], v5
s_waitcnt lgkmcnt(3)
ds_read_b128 a[172:175], v3 offset:11264
v_accvgpr_read_b32 v243, a27
v_mfma_f32_16x16x32_bf16 a[32:35], a[144:147], v[176:179], a[32:35]
ds_read_b128 a[176:179], v3 offset:4096
v_accvgpr_read_b32 v244, a28
v_mfma_f32_16x16x32_bf16 a[32:35], a[148:151], v[180:183], a[32:35]
ds_read_b128 a[180:183], v3 offset:12288
v_accvgpr_read_b32 v245, a29
v_mfma_f32_16x16x32_bf16 a[64:67], a[148:151], v[204:207], a[64:67]
ds_read_b128 a[184:187], v3 offset:5120
v_accvgpr_read_b32 v246, a30
v_mfma_f32_16x16x32_bf16 a[64:67], a[144:147], v[200:203], a[64:67]
ds_read_b128 a[188:191], v3 offset:13312
v_accvgpr_read_b32 v247, a31
v_mfma_f32_16x16x32_bf16 a[96:99], a[144:147], v[208:211], a[96:99]
ds_read_b128 a[192:195], v3 offset:6144
v_mul_f32 v240, v240, v20
v_mfma_f32_16x16x32_bf16 a[96:99], a[148:151], v[212:215], a[96:99]
ds_read_b128 a[196:199], v3 offset:14336
v_mul_f32 v241, v241, v20
v_mfma_f32_16x16x32_bf16 a[100:103], a[156:159], v[212:215], a[100:103]
ds_read_b128 a[200:203], v3 offset:7168
v_mul_f32 v242, v242, v20
v_mfma_f32_16x16x32_bf16 a[100:103], a[152:155], v[208:211], a[100:103]
ds_read_b128 a[204:207], v3 offset:15360
v_mul_f32 v243, v243, v20
v_mul_f32 v244, v244, v20
v_mul_f32 v245, v245, v20
v_mul_f32 v246, v246, v20
v_mul_f32 v247, v247, v20
v_cvt_pk_bf16_f32 v240, v240, v241
v_cvt_pk_bf16_f32 v241, v242, v243
v_cvt_pk_bf16_f32 v242, v244, v245
v_cvt_pk_bf16_f32 v243, v246, v247
s_add_u32 s77, s74, 24576
buffer_store_dwordx4 v[240:243], v16, s[44:47], s77 offen sc1
v_exp_f32 v126, v126
v_mfma_f32_16x16x32_bf16 a[68:71], a[152:155], v[200:203], a[68:71]
buffer_load_dwordx4 v16, s[32:35], s64 offen offset:2048 sc1 lds
v_cvt_pk_bf16_f32 v195, v142, v143
v_mfma_f32_16x16x32_bf16 a[68:71], a[156:159], v[204:207], a[68:71]
v_exp_f32 v127, v127
v_mfma_f32_16x16x32_bf16 a[36:39], a[156:159], v[180:183], a[36:39]
v_exp_f32 v128, v128
v_mfma_f32_16x16x32_bf16 a[36:39], a[152:155], v[176:179], a[36:39]
s_waitcnt lgkmcnt(2)
v_exp_f32 v129, v129
v_mfma_f32_16x16x32_bf16 a[40:43], a[160:163], v[176:179], a[40:43]
v_cvt_pk_bf16_f32 v186, v124, v125
v_cvt_pk_bf16_f32 v187, v126, v127
v_mfma_f32_16x16x32_bf16 a[40:43], a[164:167], v[180:183], a[40:43]
v_exp_f32 v130, v130
v_mfma_f32_16x16x32_bf16 a[72:75], a[164:167], v[204:207], a[72:75]
buffer_load_dwordx4 v16, s[32:35], s64 offen offset:3072 sc1 lds
v_mfma_f32_16x16x32_bf16 a[72:75], a[160:163], v[200:203], a[72:75]
v_exp_f32 v131, v131
v_mfma_f32_16x16x32_bf16 a[104:107], a[160:163], v[208:211], a[104:107]
v_exp_f32 v144, v144
v_mfma_f32_16x16x32_bf16 a[104:107], a[164:167], v[212:215], a[104:107]
v_exp_f32 v145, v145
v_mfma_f32_16x16x32_bf16 a[108:111], a[172:175], v[212:215], a[108:111]
v_exp_f32 v146, v146
v_mfma_f32_16x16x32_bf16 a[108:111], a[168:171], v[208:211], a[108:111]
v_exp_f32 v147, v147
v_mfma_f32_16x16x32_bf16 a[76:79], a[168:171], v[200:203], a[76:79]
v_exp_f32 v148, v148
v_mfma_f32_16x16x32_bf16 a[76:79], a[172:175], v[204:207], a[76:79]
v_exp_f32 v149, v149
v_mfma_f32_16x16x32_bf16 a[44:47], a[172:175], v[180:183], a[44:47]
v_cvt_pk_bf16_f32 v188, v128, v129
v_cvt_pk_bf16_f32 v189, v130, v131
v_mfma_f32_16x16x32_bf16 a[44:47], a[168:171], v[176:179], a[44:47]
v_exp_f32 v150, v150
v_mfma_f32_16x16x32_bf16 a[48:51], a[176:179], v[176:179], a[48:51]
v_exp_f32 v151, v151
v_mfma_f32_16x16x32_bf16 a[48:51], a[180:183], v[180:183], a[48:51]
v_exp_f32 v132, v132
v_mfma_f32_16x16x32_bf16 a[80:83], a[180:183], v[204:207], a[80:83]
s_waitcnt vmcnt(9)
s_barrier
v_mfma_f32_16x16x32_bf16 a[80:83], a[176:179], v[200:203], a[80:83]
s_xor_b32 s71, s71, 16384
v_exp_f32 v133, v133
v_mfma_f32_16x16x32_bf16 a[112:115], a[176:179], v[208:211], a[112:115]
s_add_u32 s70, s70, 32768
ds_read_b128 a[144:147], v2 offset:16384
v_cvt_pk_bf16_f32 v196, v144, v145
v_mfma_f32_16x16x32_bf16 a[112:115], a[180:183], v[212:215], a[112:115]
s_mov_b32 m0, s71
v_exp_f32 v134, v134
v_mfma_f32_16x16x32_bf16 a[116:119], a[188:191], v[212:215], a[116:119]
buffer_load_dwordx4 v16, s[32:35], s70 offen offset:0 sc1 lds
v_mfma_f32_16x16x32_bf16 a[116:119], a[184:187], v[208:211], a[116:119]
ds_read_b128 a[148:151], v2 offset:17408
v_cvt_pk_bf16_f32 v197, v146, v147
v_mfma_f32_16x16x32_bf16 a[84:87], a[184:187], v[200:203], a[84:87]
ds_read_b128 a[152:155], v2 offset:18432
v_cvt_pk_bf16_f32 v198, v148, v149
v_mfma_f32_16x16x32_bf16 a[84:87], a[188:191], v[204:207], a[84:87]
ds_read_b128 a[156:159], v2 offset:19456
v_cvt_pk_bf16_f32 v199, v150, v151
v_mfma_f32_16x16x32_bf16 a[52:55], a[188:191], v[180:183], a[52:55]
v_exp_f32 v135, v135
v_mfma_f32_16x16x32_bf16 a[52:55], a[184:187], v[176:179], a[52:55]
ds_read_b128 a[160:163], v2 offset:20480
v_cvt_pk_bf16_f32 v190, v132, v133
v_mfma_f32_16x16x32_bf16 a[56:59], a[192:195], v[176:179], a[56:59]
ds_read_b128 a[164:167], v2 offset:21504
v_cvt_pk_bf16_f32 v191, v134, v135
v_mfma_f32_16x16x32_bf16 a[56:59], a[196:199], v[180:183], a[56:59]
ds_read_b128 a[168:171], v2 offset:22528
v_accvgpr_read_b32 v21, a132
v_mfma_f32_16x16x32_bf16 a[88:91], a[196:199], v[204:207], a[88:91]
ds_read_b128 a[172:175], v2 offset:23552
v_accvgpr_read_b32 v248, a133
v_mfma_f32_16x16x32_bf16 a[88:91], a[192:195], v[200:203], a[88:91]
buffer_load_dwordx4 v16, s[32:35], s70 offen offset:1024 sc1 lds
v_mfma_f32_16x16x32_bf16 a[120:123], a[192:195], v[208:211], a[120:123]
v_add_f32 v21, v21, v248
v_max_f32 v1, v1, v21
v_mfma_f32_16x16x32_bf16 a[120:123], a[196:199], v[212:215], a[120:123]
s_waitcnt lgkmcnt(3)
v_rcp_f32 v21, v21
v_mfma_f32_16x16x32_bf16 a[124:127], a[204:207], v[212:215], a[124:127]
v_accvgpr_read_b32 v232, a32
v_accvgpr_read_b32 v233, a33
v_mfma_f32_16x16x32_bf16 a[124:127], a[200:203], v[208:211], a[124:127]
v_accvgpr_read_b32 v234, a34
v_accvgpr_read_b32 v235, a35
v_mfma_f32_16x16x32_bf16 a[92:95], a[200:203], v[200:203], a[92:95]
v_accvgpr_read_b32 v236, a36
v_accvgpr_read_b32 v237, a37
v_mfma_f32_16x16x32_bf16 a[92:95], a[204:207], v[204:207], a[92:95]
v_accvgpr_read_b32 v238, a38
v_accvgpr_read_b32 v239, a39
v_mfma_f32_16x16x32_bf16 a[60:63], a[204:207], v[180:183], a[60:63]
v_mul_f32 v21, v21, v6
v_mul_f32 v232, v232, v21
v_mfma_f32_16x16x32_bf16 a[60:63], a[200:203], v[176:179], a[60:63]
v_mul_f32 v233, v233, v21
v_mul_f32 v234, v234, v21
v_mfma_f32_16x16x32_bf16 v[120:123], a[144:147], v[56:59], v[224:227]
ds_read_b128 a[176:179], v2 offset:24576
ds_read_b128 a[180:183], v2 offset:25600
v_mfma_f32_16x16x32_bf16 v[120:123], a[148:151], v[60:63], v[120:123]
buffer_load_dwordx4 v16, s[32:35], s70 offen offset:2048 sc1 lds
v_mfma_f32_16x16x32_bf16 v[120:123], a[152:155], v[64:67], v[120:123]
s_add_u32 s64, s70, 4096
ds_read_b128 a[184:187], v2 offset:26624
ds_read_b128 a[188:191], v2 offset:27648
v_mfma_f32_16x16x32_bf16 v[120:123], a[156:159], v[68:71], v[120:123]
buffer_load_dwordx4 v16, s[32:35], s70 offen offset:3072 sc1 lds
v_mfma_f32_16x16x32_bf16 v[136:139], a[156:159], v[84:87], v[228:231]
s_add_u32 m0, s71, 4096
ds_read_b128 a[192:195], v2 offset:28672
ds_read_b128 a[196:199], v2 offset:29696
v_mfma_f32_16x16x32_bf16 v[136:139], a[152:155], v[80:83], v[136:139]
buffer_load_dwordx4 v16, s[32:35], s64 offen offset:0 sc1 lds
v_mfma_f32_16x16x32_bf16 v[136:139], a[148:151], v[76:79], v[136:139]
ds_read_b128 a[200:203], v2 offset:30720
ds_read_b128 a[204:207], v2 offset:31744
v_mfma_f32_16x16x32_bf16 v[136:139], a[144:147], v[72:75], v[136:139]
v_exp_f32 v120, v120
v_mfma_f32_16x16x32_bf16 v[140:143], a[160:163], v[72:75], v[228:231]
s_waitcnt lgkmcnt(4)
v_exp_f32 v121, v121
v_mfma_f32_16x16x32_bf16 v[140:143], a[164:167], v[76:79], v[140:143]
v_exp_f32 v122, v122
v_mfma_f32_16x16x32_bf16 v[140:143], a[168:171], v[80:83], v[140:143]
v_mul_f32 v235, v235, v21
v_mul_f32 v236, v236, v21
v_mul_f32 v237, v237, v21
v_mul_f32 v238, v238, v21
v_mul_f32 v239, v239, v21
v_cvt_pk_bf16_f32 v232, v232, v233
v_cvt_pk_bf16_f32 v233, v234, v235
v_cvt_pk_bf16_f32 v234, v236, v237
v_cvt_pk_bf16_f32 v235, v238, v239
s_add_u32 s77, s74, 4096
buffer_store_dwordx4 v[232:235], v16, s[44:47], s77 offen sc1
v_accvgpr_read_b32 v240, a40
v_accvgpr_read_b32 v241, a41
v_accvgpr_read_b32 v242, a42
v_accvgpr_read_b32 v243, a43
v_accvgpr_read_b32 v244, a44
v_accvgpr_read_b32 v245, a45
v_accvgpr_read_b32 v246, a46
v_accvgpr_read_b32 v247, a47
v_mul_f32 v240, v240, v21
v_mul_f32 v241, v241, v21
v_mul_f32 v242, v242, v21
v_mul_f32 v243, v243, v21
v_mul_f32 v244, v244, v21
v_mul_f32 v245, v245, v21
v_mul_f32 v246, v246, v21
v_mul_f32 v247, v247, v21
v_cvt_pk_bf16_f32 v240, v240, v241
v_cvt_pk_bf16_f32 v241, v242, v243
v_cvt_pk_bf16_f32 v242, v244, v245
v_cvt_pk_bf16_f32 v243, v246, v247
s_add_u32 s77, s74, 12288
buffer_store_dwordx4 v[240:243], v16, s[44:47], s77 offen sc1
v_accvgpr_read_b32 v232, a48
v_accvgpr_read_b32 v233, a49
v_accvgpr_read_b32 v234, a50
v_accvgpr_read_b32 v235, a51
v_accvgpr_read_b32 v236, a52
v_accvgpr_read_b32 v237, a53
v_accvgpr_read_b32 v238, a54
v_accvgpr_read_b32 v239, a55
v_mul_f32 v232, v232, v21
v_mul_f32 v233, v233, v21
v_mul_f32 v234, v234, v21
v_mul_f32 v235, v235, v21
v_mul_f32 v236, v236, v21
v_mul_f32 v237, v237, v21
v_mul_f32 v238, v238, v21
v_mul_f32 v239, v239, v21
v_cvt_pk_bf16_f32 v232, v232, v233
v_cvt_pk_bf16_f32 v233, v234, v235
v_cvt_pk_bf16_f32 v234, v236, v237
v_cvt_pk_bf16_f32 v235, v238, v239
s_add_u32 s77, s74, 20480
buffer_store_dwordx4 v[232:235], v16, s[44:47], s77 offen sc1
v_accvgpr_read_b32 v240, a56
v_accvgpr_read_b32 v241, a57
v_accvgpr_read_b32 v242, a58
v_accvgpr_read_b32 v243, a59
v_accvgpr_read_b32 v244, a60
v_accvgpr_read_b32 v245, a61
v_accvgpr_read_b32 v246, a62
v_accvgpr_read_b32 v247, a63
v_mul_f32 v240, v240, v21
v_mul_f32 v241, v241, v21
v_mul_f32 v242, v242, v21
v_mul_f32 v243, v243, v21
v_mul_f32 v244, v244, v21
v_mul_f32 v245, v245, v21
v_mul_f32 v246, v246, v21
v_mul_f32 v247, v247, v21
v_cvt_pk_bf16_f32 v240, v240, v241
v_cvt_pk_bf16_f32 v241, v242, v243
v_cvt_pk_bf16_f32 v242, v244, v245
v_cvt_pk_bf16_f32 v243, v246, v247
s_add_u32 s77, s74, 28672
buffer_store_dwordx4 v[240:243], v16, s[44:47], s77 offen sc1
v_exp_f32 v123, v123
v_mfma_f32_16x16x32_bf16 v[140:143], a[172:175], v[84:87], v[140:143]
v_exp_f32 v136, v136
v_mfma_f32_16x16x32_bf16 v[124:127], a[172:175], v[68:71], v[224:227]
ds_read_b128 a[144:147], v3 offset:16384
v_cvt_pk_bf16_f32 v200, v120, v121
v_mfma_f32_16x16x32_bf16 v[124:127], a[168:171], v[64:67], v[124:127]
s_branch L_po18
L_pg18:
s_branch L_pg22
L_po18:
v_exp_f32 v137, v137
v_mfma_f32_16x16x32_bf16 v[124:127], a[164:167], v[60:63], v[124:127]
ds_read_b128 a[148:151], v3 offset:24576
v_cvt_pk_bf16_f32 v201, v122, v123
v_mfma_f32_16x16x32_bf16 v[124:127], a[160:163], v[56:59], v[124:127]
v_exp_f32 v138, v138
v_mfma_f32_16x16x32_bf16 v[128:131], a[176:179], v[56:59], v[224:227]
ds_read_b128 a[152:155], v3 offset:17408
v_cvt_pk_bf16_f32 v208, v136, v137
v_mfma_f32_16x16x32_bf16 v[128:131], a[180:183], v[60:63], v[128:131]
v_exp_f32 v139, v139
v_mfma_f32_16x16x32_bf16 v[128:131], a[184:187], v[64:67], v[128:131]
ds_read_b128 a[156:159], v3 offset:25600
v_cvt_pk_bf16_f32 v209, v138, v139
v_mfma_f32_16x16x32_bf16 v[128:131], a[188:191], v[68:71], v[128:131]
v_exp_f32 v140, v140
v_mfma_f32_16x16x32_bf16 v[144:147], a[188:191], v[84:87], v[228:231]
buffer_load_dwordx4 v16, s[32:35], s64 offen offset:1024 sc1 lds
v_mfma_f32_16x16x32_bf16 v[144:147], a[184:187], v[80:83], v[144:147]
v_exp_f32 v141, v141
v_mfma_f32_16x16x32_bf16 v[144:147], a[180:183], v[76:79], v[144:147]
ds_read_b128 a[160:163], v3 offset:18432
v_cvt_pk_bf16_f32 v210, v140, v141
v_mfma_f32_16x16x32_bf16 v[144:147], a[176:179], v[72:75], v[144:147]
s_waitcnt lgkmcnt(2)
v_exp_f32 v142, v142
v_mfma_f32_16x16x32_bf16 v[148:151], a[192:195], v[72:75], v[228:231]
ds_read_b128 a[164:167], v3 offset:26624
ds_read_b128 a[168:171], v3 offset:19456
v_mfma_f32_16x16x32_bf16 v[148:151], a[196:199], v[76:79], v[148:151]
v_exp_f32 v143, v143
v_mfma_f32_16x16x32_bf16 v[148:151], a[200:203], v[80:83], v[148:151]
ds_read_b128 a[172:175], v3 offset:27648
v_cvt_pk_bf16_f32 v211, v142, v143
v_mfma_f32_16x16x32_bf16 v[148:151], a[204:207], v[84:87], v[148:151]
v_exp_f32 v124, v124
v_mfma_f32_16x16x32_bf16 v[132:135], a[204:207], v[68:71], v[224:227]
ds_read_b128 a[176:179], v3 offset:20480
buffer_load_dwordx4 v16, s[32:35], s64 offen offset:2048 sc1 lds
v_mfma_f32_16x16x32_bf16 v[132:135], a[200:203], v[64:67], v[132:135]
v_exp_f32 v125, v125
v_mfma_f32_16x16x32_bf16 v[132:135], a[196:199], v[60:63], v[132:135]
ds_read_b128 a[180:183], v3 offset:28672
v_cvt_pk_bf16_f32 v202, v124, v125
v_mfma_f32_16x16x32_bf16 v[132:135], a[192:195], v[56:59], v[132:135]
v_exp_f32 v126, v126
v_smfmac_f32_16x16x64_bf16 a[136:139], a[240:243], v[184:191], v5
ds_read_b128 a[184:187], v3 offset:21504
v_smfmac_f32_16x16x64_bf16 a[140:143], a[240:243], v[192:199], v5
ds_read_b128 a[188:191], v3 offset:29696
v_mfma_f32_16x16x32_bf16 a[64:67], a[144:147], v[184:187], a[64:67]
v_exp_f32 v127, v127
v_mfma_f32_16x16x32_bf16 a[64:67], a[148:151], v[188:191], a[64:67]
v_exp_f32 v128, v128
v_mfma_f32_16x16x32_bf16 a[96:99], a[148:151], v[196:199], a[96:99]
v_exp_f32 v129, v129
v_mfma_f32_16x16x32_bf16 a[96:99], a[144:147], v[192:195], a[96:99]
ds_read_b128 a[192:195], v3 offset:22528
v_cvt_pk_bf16_f32 v203, v126, v127
v_mfma_f32_16x16x32_bf16 a[100:103], a[152:155], v[192:195], a[100:103]
s_waitcnt lgkmcnt(2)
v_exp_f32 v130, v130
v_mfma_f32_16x16x32_bf16 a[100:103], a[156:159], v[196:199], a[100:103]
ds_read_b128 a[196:199], v3 offset:30720
v_cvt_pk_bf16_f32 v204, v128, v129
v_mfma_f32_16x16x32_bf16 a[68:71], a[156:159], v[188:191], a[68:71]
v_exp_f32 v131, v131
v_mfma_f32_16x16x32_bf16 a[68:71], a[152:155], v[184:187], a[68:71]
ds_read_b128 a[200:203], v3 offset:23552
v_cvt_pk_bf16_f32 v205, v130, v131
v_mfma_f32_16x16x32_bf16 a[72:75], a[160:163], v[184:187], a[72:75]
v_exp_f32 v144, v144
v_mfma_f32_16x16x32_bf16 a[72:75], a[164:167], v[188:191], a[72:75]
buffer_load_dwordx4 v16, s[32:35], s64 offen offset:3072 sc1 lds
v_mfma_f32_16x16x32_bf16 a[104:107], a[164:167], v[196:199], a[104:107]
s_xor_b32 s71, s71, 49152
v_exp_f32 v145, v145
v_mfma_f32_16x16x32_bf16 a[104:107], a[160:163], v[192:195], a[104:107]
ds_read_b128 a[204:207], v3 offset:31744
v_cvt_pk_bf16_f32 v212, v144, v145
v_mfma_f32_16x16x32_bf16 a[108:111], a[168:171], v[192:195], a[108:111]
s_add_u32 s70, s70, 32768
v_xor_b32 v2, 0x8000, v2
v_exp_f32 v146, v146
v_mfma_f32_16x16x32_bf16 a[108:111], a[172:175], v[196:199], a[108:111]
s_waitcnt vmcnt(12)
s_barrier
v_mfma_f32_16x16x32_bf16 a[76:79], a[172:175], v[188:191], a[76:79]
s_mov_b32 m0, s71
v_exp_f32 v147, v147
v_mfma_f32_16x16x32_bf16 a[76:79], a[168:171], v[184:187], a[76:79]
ds_read_b128 a[144:147], v2 offset:0
v_cvt_pk_bf16_f32 v213, v146, v147
v_mfma_f32_16x16x32_bf16 a[80:83], a[176:179], v[184:187], a[80:83]
v_exp_f32 v148, v148
v_mfma_f32_16x16x32_bf16 a[80:83], a[180:183], v[188:191], a[80:83]
ds_read_b128 a[148:151], v2 offset:1024
ds_read_b128 a[152:155], v2 offset:2048
v_mfma_f32_16x16x32_bf16 a[112:115], a[180:183], v[196:199], a[112:115]
v_exp_f32 v149, v149
v_mfma_f32_16x16x32_bf16 a[112:115], a[176:179], v[192:195], a[112:115]
ds_read_b128 a[156:159], v2 offset:3072
v_cvt_pk_bf16_f32 v214, v148, v149
v_mfma_f32_16x16x32_bf16 a[116:119], a[184:187], v[192:195], a[116:119]
s_waitcnt lgkmcnt(4)
v_exp_f32 v150, v150
v_mfma_f32_16x16x32_bf16 a[116:119], a[188:191], v[196:199], a[116:119]
buffer_load_dwordx4 v16, s[32:35], s70 offen offset:0 sc1 lds
v_mfma_f32_16x16x32_bf16 a[84:87], a[188:191], v[188:191], a[84:87]
v_exp_f32 v151, v151
v_mfma_f32_16x16x32_bf16 a[84:87], a[184:187], v[184:187], a[84:87]
ds_read_b128 a[160:163], v2 offset:4096
v_cvt_pk_bf16_f32 v215, v150, v151
v_mfma_f32_16x16x32_bf16 a[88:91], a[192:195], v[184:187], a[88:91]
v_exp_f32 v132, v132
v_mfma_f32_16x16x32_bf16 a[88:91], a[196:199], v[188:191], a[88:91]
ds_read_b128 a[164:167], v2 offset:5120
v_xor_b32 v3, 0x8000, v3
v_mfma_f32_16x16x32_bf16 a[120:123], a[196:199], v[196:199], a[120:123]
v_exp_f32 v133, v133
v_mfma_f32_16x16x32_bf16 a[120:123], a[192:195], v[192:195], a[120:123]
ds_read_b128 a[168:171], v2 offset:6144
v_cvt_pk_bf16_f32 v206, v132, v133
v_mfma_f32_16x16x32_bf16 a[124:127], a[200:203], v[192:195], a[124:127]
v_exp_f32 v134, v134
v_mfma_f32_16x16x32_bf16 a[124:127], a[204:207], v[196:199], a[124:127]
buffer_load_dwordx4 v16, s[32:35], s70 offen offset:1024 sc1 lds
v_mfma_f32_16x16x32_bf16 a[92:95], a[204:207], v[188:191], a[92:95]
v_exp_f32 v135, v135
v_mfma_f32_16x16x32_bf16 a[92:95], a[200:203], v[184:187], a[92:95]
ds_read_b128 a[172:175], v2 offset:7168
v_cvt_pk_bf16_f32 v207, v134, v135
s_lshl_b32 s72, s3, 1
s_sub_u32 s72, 13, s72
L_S:
s_waitcnt lgkmcnt(7)
v_mfma_f32_16x16x32_bf16 v[120:123], a[144:147], v[56:59], v[224:227]
s_waitcnt lgkmcnt(6)
ds_read_b128 a[176:179], v2 offset:8192
ds_read_b128 a[180:183], v2 offset:9216
v_mfma_f32_16x16x32_bf16 v[120:123], a[148:151], v[60:63], v[120:123]
s_waitcnt lgkmcnt(7)
buffer_load_dwordx4 v16, s[32:35], s70 offen offset:2048 sc1 lds
v_mfma_f32_16x16x32_bf16 v[120:123], a[152:155], v[64:67], v[120:123]
s_waitcnt lgkmcnt(6)
s_add_u32 s64, s70, 4096
ds_read_b128 a[184:187], v2 offset:10240
ds_read_b128 a[188:191], v2 offset:11264
v_mfma_f32_16x16x32_bf16 v[120:123], a[156:159], v[68:71], v[120:123]
buffer_load_dwordx4 v16, s[32:35], s70 offen offset:3072 sc1 lds
v_mfma_f32_16x16x32_bf16 v[136:139], a[156:159], v[84:87], v[228:231]
s_add_u32 m0, s71, 4096
ds_read_b128 a[192:195], v2 offset:12288
ds_read_b128 a[196:199], v2 offset:13312
v_mfma_f32_16x16x32_bf16 v[136:139], a[152:155], v[80:83], v[136:139]
buffer_load_dwordx4 v16, s[32:35], s64 offen offset:0 sc1 lds
v_mfma_f32_16x16x32_bf16 v[136:139], a[148:151], v[76:79], v[136:139]
ds_read_b128 a[200:203], v2 offset:14336
ds_read_b128 a[204:207], v2 offset:15360
v_mfma_f32_16x16x32_bf16 v[136:139], a[144:147], v[72:75], v[136:139]
s_waitcnt lgkmcnt(6)
v_exp_f32 v120, v120
v_mfma_f32_16x16x32_bf16 v[140:143], a[160:163], v[72:75], v[228:231]
v_exp_f32 v121, v121
v_mfma_f32_16x16x32_bf16 v[140:143], a[164:167], v[76:79], v[140:143]
v_exp_f32 v122, v122
v_mfma_f32_16x16x32_bf16 v[140:143], a[168:171], v[80:83], v[140:143]
v_exp_f32 v123, v123
v_mfma_f32_16x16x32_bf16 v[140:143], a[172:175], v[84:87], v[140:143]
v_exp_f32 v136, v136
v_mfma_f32_16x16x32_bf16 v[124:127], a[172:175], v[68:71], v[224:227]
ds_read_b128 a[144:147], v3 offset:0
v_cvt_pk_bf16_f32 v184, v120, v121
v_mfma_f32_16x16x32_bf16 v[124:127], a[168:171], v[64:67], v[124:127]
v_exp_f32 v137, v137
v_mfma_f32_16x16x32_bf16 v[124:127], a[164:167], v[60:63], v[124:127]
ds_read_b128 a[148:151], v3 offset:8192
v_cvt_pk_bf16_f32 v185, v122, v123
v_mfma_f32_16x16x32_bf16 v[124:127], a[160:163], v[56:59], v[124:127]
v_exp_f32 v138, v138
v_mfma_f32_16x16x32_bf16 v[128:131], a[176:179], v[56:59], v[224:227]
ds_read_b128 a[152:155], v3 offset:1024
v_cvt_pk_bf16_f32 v192, v136, v137
v_mfma_f32_16x16x32_bf16 v[128:131], a[180:183], v[60:63], v[128:131]
s_waitcnt lgkmcnt(3)
v_exp_f32 v139, v139
v_mfma_f32_16x16x32_bf16 v[128:131], a[184:187], v[64:67], v[128:131]
ds_read_b128 a[156:159], v3 offset:9216
v_cvt_pk_bf16_f32 v193, v138, v139
v_mfma_f32_16x16x32_bf16 v[128:131], a[188:191], v[68:71], v[128:131]
v_exp_f32 v140, v140
v_mfma_f32_16x16x32_bf16 v[144:147], a[188:191], v[84:87], v[228:231]
buffer_load_dwordx4 v16, s[32:35], s64 offen offset:1024 sc1 lds
v_mfma_f32_16x16x32_bf16 v[144:147], a[184:187], v[80:83], v[144:147]
v_exp_f32 v141, v141
v_mfma_f32_16x16x32_bf16 v[144:147], a[180:183], v[76:79], v[144:147]
ds_read_b128 a[160:163], v3 offset:2048
v_cvt_pk_bf16_f32 v194, v140, v141
v_mfma_f32_16x16x32_bf16 v[144:147], a[176:179], v[72:75], v[144:147]
v_exp_f32 v142, v142
v_mfma_f32_16x16x32_bf16 v[148:151], a[192:195], v[72:75], v[228:231]
ds_read_b128 a[164:167], v3 offset:10240
ds_read_b128 a[168:171], v3 offset:3072
v_mfma_f32_16x16x32_bf16 v[148:151], a[196:199], v[76:79], v[148:151]
v_exp_f32 v143, v143
v_mfma_f32_16x16x32_bf16 v[148:151], a[200:203], v[80:83], v[148:151]
ds_read_b128 a[172:175], v3 offset:11264
v_cvt_pk_bf16_f32 v195, v142, v143
v_mfma_f32_16x16x32_bf16 v[148:151], a[204:207], v[84:87], v[148:151]
v_exp_f32 v124, v124
v_mfma_f32_16x16x32_bf16 v[132:135], a[204:207], v[68:71], v[224:227]
ds_read_b128 a[176:179], v3 offset:4096
buffer_load_dwordx4 v16, s[32:35], s64 offen offset:2048 sc1 lds
v_mfma_f32_16x16x32_bf16 v[132:135], a[200:203], v[64:67], v[132:135]
v_exp_f32 v125, v125
v_mfma_f32_16x16x32_bf16 v[132:135], a[196:199], v[60:63], v[132:135]
ds_read_b128 a[180:183], v3 offset:12288
v_cvt_pk_bf16_f32 v186, v124, v125
v_mfma_f32_16x16x32_bf16 v[132:135], a[192:195], v[56:59], v[132:135]
v_exp_f32 v126, v126
v_smfmac_f32_16x16x64_bf16 a[136:139], a[240:243], v[200:207], v5
ds_read_b128 a[184:187], v3 offset:5120
v_smfmac_f32_16x16x64_bf16 a[140:143], a[240:243], v[208:215], v5
s_waitcnt lgkmcnt(3)
ds_read_b128 a[188:191], v3 offset:13312
v_mfma_f32_16x16x32_bf16 a[64:67], a[144:147], v[200:203], a[64:67]
v_exp_f32 v127, v127
v_mfma_f32_16x16x32_bf16 a[64:67], a[148:151], v[204:207], a[64:67]
v_exp_f32 v128, v128
v_mfma_f32_16x16x32_bf16 a[96:99], a[148:151], v[212:215], a[96:99]
v_exp_f32 v129, v129
v_mfma_f32_16x16x32_bf16 a[96:99], a[144:147], v[208:211], a[96:99]
ds_read_b128 a[192:195], v3 offset:6144
v_cvt_pk_bf16_f32 v187, v126, v127
v_mfma_f32_16x16x32_bf16 a[100:103], a[152:155], v[208:211], a[100:103]
v_exp_f32 v130, v130
v_mfma_f32_16x16x32_bf16 a[100:103], a[156:159], v[212:215], a[100:103]
ds_read_b128 a[196:199], v3 offset:14336
v_cvt_pk_bf16_f32 v188, v128, v129
v_mfma_f32_16x16x32_bf16 a[68:71], a[156:159], v[204:207], a[68:71]
v_exp_f32 v131, v131
v_mfma_f32_16x16x32_bf16 a[68:71], a[152:155], v[200:203], a[68:71]
ds_read_b128 a[200:203], v3 offset:7168
v_cvt_pk_bf16_f32 v189, v130, v131
v_mfma_f32_16x16x32_bf16 a[72:75], a[160:163], v[200:203], a[72:75]
v_exp_f32 v144, v144
v_mfma_f32_16x16x32_bf16 a[72:75], a[164:167], v[204:207], a[72:75]
buffer_load_dwordx4 v16, s[32:35], s64 offen offset:3072 sc1 lds
v_mfma_f32_16x16x32_bf16 a[104:107], a[164:167], v[212:215], a[104:107]
s_xor_b32 s71, s71, 16384
v_exp_f32 v145, v145
v_mfma_f32_16x16x32_bf16 a[104:107], a[160:163], v[208:211], a[104:107]
ds_read_b128 a[204:207], v3 offset:15360
v_cvt_pk_bf16_f32 v196, v144, v145
v_mfma_f32_16x16x32_bf16 a[108:111], a[168:171], v[208:211], a[108:111]
s_add_u32 s70, s70, 32768
v_exp_f32 v146, v146
v_mfma_f32_16x16x32_bf16 a[108:111], a[172:175], v[212:215], a[108:111]
s_waitcnt vmcnt(8)
s_barrier
v_mfma_f32_16x16x32_bf16 a[76:79], a[172:175], v[204:207], a[76:79]
s_mov_b32 m0, s71
v_exp_f32 v147, v147
v_mfma_f32_16x16x32_bf16 a[76:79], a[168:171], v[200:203], a[76:79]
s_waitcnt lgkmcnt(1)
ds_read_b128 a[144:147], v2 offset:16384
v_cvt_pk_bf16_f32 v197, v146, v147
v_mfma_f32_16x16x32_bf16 a[80:83], a[176:179], v[200:203], a[80:83]
v_exp_f32 v148, v148
v_mfma_f32_16x16x32_bf16 a[80:83], a[180:183], v[204:207], a[80:83]
ds_read_b128 a[148:151], v2 offset:17408
ds_read_b128 a[152:155], v2 offset:18432
v_mfma_f32_16x16x32_bf16 a[112:115], a[180:183], v[212:215], a[112:115]
v_exp_f32 v149, v149
v_mfma_f32_16x16x32_bf16 a[112:115], a[176:179], v[208:211], a[112:115]
ds_read_b128 a[156:159], v2 offset:19456
v_cvt_pk_bf16_f32 v198, v148, v149
v_mfma_f32_16x16x32_bf16 a[116:119], a[184:187], v[208:211], a[116:119]
v_exp_f32 v150, v150
v_mfma_f32_16x16x32_bf16 a[116:119], a[188:191], v[212:215], a[116:119]
buffer_load_dwordx4 v16, s[32:35], s70 offen offset:0 sc1 lds
v_mfma_f32_16x16x32_bf16 a[84:87], a[188:191], v[204:207], a[84:87]
v_exp_f32 v151, v151
v_mfma_f32_16x16x32_bf16 a[84:87], a[184:187], v[200:203], a[84:87]
ds_read_b128 a[160:163], v2 offset:20480
v_cvt_pk_bf16_f32 v199, v150, v151
v_mfma_f32_16x16x32_bf16 a[88:91], a[192:195], v[200:203], a[88:91]
v_exp_f32 v132, v132
v_mfma_f32_16x16x32_bf16 a[88:91], a[196:199], v[204:207], a[88:91]
ds_read_b128 a[164:167], v2 offset:21504
v_mfma_f32_16x16x32_bf16 a[120:123], a[196:199], v[212:215], a[120:123]
v_exp_f32 v133, v133
v_mfma_f32_16x16x32_bf16 a[120:123], a[192:195], v[208:211], a[120:123]
ds_read_b128 a[168:171], v2 offset:22528
v_cvt_pk_bf16_f32 v190, v132, v133
v_mfma_f32_16x16x32_bf16 a[124:127], a[200:203], v[208:211], a[124:127]
s_waitcnt lgkmcnt(3)
v_exp_f32 v134, v134
v_mfma_f32_16x16x32_bf16 a[124:127], a[204:207], v[212:215], a[124:127]
buffer_load_dwordx4 v16, s[32:35], s70 offen offset:1024 sc1 lds
v_mfma_f32_16x16x32_bf16 a[92:95], a[204:207], v[204:207], a[92:95]
v_exp_f32 v135, v135
v_mfma_f32_16x16x32_bf16 a[92:95], a[200:203], v[200:203], a[92:95]
ds_read_b128 a[172:175], v2 offset:23552
v_cvt_pk_bf16_f32 v191, v134, v135
v_mfma_f32_16x16x32_bf16 v[120:123], a[144:147], v[56:59], v[224:227]
ds_read_b128 a[176:179], v2 offset:24576
ds_read_b128 a[180:183], v2 offset:25600
v_mfma_f32_16x16x32_bf16 v[120:123], a[148:151], v[60:63], v[120:123]
buffer_load_dwordx4 v16, s[32:35], s70 offen offset:2048 sc1 lds
v_mfma_f32_16x16x32_bf16 v[120:123], a[152:155], v[64:67], v[120:123]
s_add_u32 s64, s70, 4096
ds_read_b128 a[184:187], v2 offset:26624
ds_read_b128 a[188:191], v2 offset:27648
v_mfma_f32_16x16x32_bf16 v[120:123], a[156:159], v[68:71], v[120:123]
buffer_load_dwordx4 v16, s[32:35], s70 offen offset:3072 sc1 lds
v_mfma_f32_16x16x32_bf16 v[136:139], a[156:159], v[84:87], v[228:231]
s_add_u32 m0, s71, 4096
ds_read_b128 a[192:195], v2 offset:28672
ds_read_b128 a[196:199], v2 offset:29696
v_mfma_f32_16x16x32_bf16 v[136:139], a[152:155], v[80:83], v[136:139]
buffer_load_dwordx4 v16, s[32:35], s64 offen offset:0 sc1 lds
v_mfma_f32_16x16x32_bf16 v[136:139], a[148:151], v[76:79], v[136:139]
ds_read_b128 a[200:203], v2 offset:30720
ds_read_b128 a[204:207], v2 offset:31744
v_mfma_f32_16x16x32_bf16 v[136:139], a[144:147], v[72:75], v[136:139]
s_waitcnt lgkmcnt(6)
v_exp_f32 v120, v120
v_mfma_f32_16x16x32_bf16 v[140:143], a[160:163], v[72:75], v[228:231]
v_exp_f32 v121, v121
v_mfma_f32_16x16x32_bf16 v[140:143], a[164:167], v[76:79], v[140:143]
v_exp_f32 v122, v122
v_mfma_f32_16x16x32_bf16 v[140:143], a[168:171], v[80:83], v[140:143]
v_exp_f32 v123, v123
v_mfma_f32_16x16x32_bf16 v[140:143], a[172:175], v[84:87], v[140:143]
v_exp_f32 v136, v136
v_mfma_f32_16x16x32_bf16 v[124:127], a[172:175], v[68:71], v[224:227]
ds_read_b128 a[144:147], v3 offset:16384
v_cvt_pk_bf16_f32 v200, v120, v121
v_mfma_f32_16x16x32_bf16 v[124:127], a[168:171], v[64:67], v[124:127]
v_exp_f32 v137, v137
v_mfma_f32_16x16x32_bf16 v[124:127], a[164:167], v[60:63], v[124:127]
ds_read_b128 a[148:151], v3 offset:24576
v_cvt_pk_bf16_f32 v201, v122, v123
v_mfma_f32_16x16x32_bf16 v[124:127], a[160:163], v[56:59], v[124:127]
v_exp_f32 v138, v138
v_mfma_f32_16x16x32_bf16 v[128:131], a[176:179], v[56:59], v[224:227]
ds_read_b128 a[152:155], v3 offset:17408
v_cvt_pk_bf16_f32 v208, v136, v137
v_mfma_f32_16x16x32_bf16 v[128:131], a[180:183], v[60:63], v[128:131]
s_waitcnt lgkmcnt(3)
v_exp_f32 v139, v139
v_mfma_f32_16x16x32_bf16 v[128:131], a[184:187], v[64:67], v[128:131]
ds_read_b128 a[156:159], v3 offset:25600
v_cvt_pk_bf16_f32 v209, v138, v139
v_mfma_f32_16x16x32_bf16 v[128:131], a[188:191], v[68:71], v[128:131]
v_exp_f32 v140, v140
v_mfma_f32_16x16x32_bf16 v[144:147], a[188:191], v[84:87], v[228:231]
buffer_load_dwordx4 v16, s[32:35], s64 offen offset:1024 sc1 lds
v_mfma_f32_16x16x32_bf16 v[144:147], a[184:187], v[80:83], v[144:147]
v_exp_f32 v141, v141
v_mfma_f32_16x16x32_bf16 v[144:147], a[180:183], v[76:79], v[144:147]
ds_read_b128 a[160:163], v3 offset:18432
v_cvt_pk_bf16_f32 v210, v140, v141
v_mfma_f32_16x16x32_bf16 v[144:147], a[176:179], v[72:75], v[144:147]
v_exp_f32 v142, v142
v_mfma_f32_16x16x32_bf16 v[148:151], a[192:195], v[72:75], v[228:231]
ds_read_b128 a[164:167], v3 offset:26624
ds_read_b128 a[168:171], v3 offset:19456
v_mfma_f32_16x16x32_bf16 v[148:151], a[196:199], v[76:79], v[148:151]
v_exp_f32 v143, v143
v_mfma_f32_16x16x32_bf16 v[148:151], a[200:203], v[80:83], v[148:151]
ds_read_b128 a[172:175], v3 offset:27648
v_cvt_pk_bf16_f32 v211, v142, v143
v_mfma_f32_16x16x32_bf16 v[148:151], a[204:207], v[84:87], v[148:151]
v_exp_f32 v124, v124
v_mfma_f32_16x16x32_bf16 v[132:135], a[204:207], v[68:71], v[224:227]
ds_read_b128 a[176:179], v3 offset:20480
buffer_load_dwordx4 v16, s[32:35], s64 offen offset:2048 sc1 lds
v_mfma_f32_16x16x32_bf16 v[132:135], a[200:203], v[64:67], v[132:135]
v_exp_f32 v125, v125
v_mfma_f32_16x16x32_bf16 v[132:135], a[196:199], v[60:63], v[132:135]
ds_read_b128 a[180:183], v3 offset:28672
v_cvt_pk_bf16_f32 v202, v124, v125
v_mfma_f32_16x16x32_bf16 v[132:135], a[192:195], v[56:59], v[132:135]
v_exp_f32 v126, v126
v_smfmac_f32_16x16x64_bf16 a[136:139], a[240:243], v[184:191], v5
ds_read_b128 a[184:187], v3 offset:21504
v_smfmac_f32_16x16x64_bf16 a[140:143], a[240:243], v[192:199], v5
s_waitcnt lgkmcnt(3)
ds_read_b128 a[188:191], v3 offset:29696
v_mfma_f32_16x16x32_bf16 a[64:67], a[144:147], v[184:187], a[64:67]
v_exp_f32 v127, v127
v_mfma_f32_16x16x32_bf16 a[64:67], a[148:151], v[188:191], a[64:67]
v_exp_f32 v128, v128
v_mfma_f32_16x16x32_bf16 a[96:99], a[148:151], v[196:199], a[96:99]
v_exp_f32 v129, v129
v_mfma_f32_16x16x32_bf16 a[96:99], a[144:147], v[192:195], a[96:99]
ds_read_b128 a[192:195], v3 offset:22528
v_cvt_pk_bf16_f32 v203, v126, v127
v_mfma_f32_16x16x32_bf16 a[100:103], a[152:155], v[192:195], a[100:103]
v_exp_f32 v130, v130
v_mfma_f32_16x16x32_bf16 a[100:103], a[156:159], v[196:199], a[100:103]
ds_read_b128 a[196:199], v3 offset:30720
v_cvt_pk_bf16_f32 v204, v128, v129
v_mfma_f32_16x16x32_bf16 a[68:71], a[156:159], v[188:191], a[68:71]
v_exp_f32 v131, v131
v_mfma_f32_16x16x32_bf16 a[68:71], a[152:155], v[184:187], a[68:71]
ds_read_b128 a[200:203], v3 offset:23552
v_cvt_pk_bf16_f32 v205, v130, v131
v_mfma_f32_16x16x32_bf16 a[72:75], a[160:163], v[184:187], a[72:75]
v_exp_f32 v144, v144
v_mfma_f32_16x16x32_bf16 a[72:75], a[164:167], v[188:191], a[72:75]
buffer_load_dwordx4 v16, s[32:35], s64 offen offset:3072 sc1 lds
v_mfma_f32_16x16x32_bf16 a[104:107], a[164:167], v[196:199], a[104:107]
s_xor_b32 s71, s71, 49152
v_exp_f32 v145, v145
v_mfma_f32_16x16x32_bf16 a[104:107], a[160:163], v[192:195], a[104:107]
ds_read_b128 a[204:207], v3 offset:31744
v_cvt_pk_bf16_f32 v212, v144, v145
v_mfma_f32_16x16x32_bf16 a[108:111], a[168:171], v[192:195], a[108:111]
s_add_u32 s70, s70, 32768
v_xor_b32 v2, 0x8000, v2
v_exp_f32 v146, v146
v_mfma_f32_16x16x32_bf16 a[108:111], a[172:175], v[196:199], a[108:111]
s_waitcnt vmcnt(8)
s_barrier
v_mfma_f32_16x16x32_bf16 a[76:79], a[172:175], v[188:191], a[76:79]
s_mov_b32 m0, s71
v_exp_f32 v147, v147
v_mfma_f32_16x16x32_bf16 a[76:79], a[168:171], v[184:187], a[76:79]
s_waitcnt lgkmcnt(1)
ds_read_b128 a[144:147], v2 offset:0
v_cvt_pk_bf16_f32 v213, v146, v147
v_mfma_f32_16x16x32_bf16 a[80:83], a[176:179], v[184:187], a[80:83]
v_exp_f32 v148, v148
v_mfma_f32_16x16x32_bf16 a[80:83], a[180:183], v[188:191], a[80:83]
ds_read_b128 a[148:151], v2 offset:1024
ds_read_b128 a[152:155], v2 offset:2048
v_mfma_f32_16x16x32_bf16 a[112:115], a[180:183], v[196:199], a[112:115]
v_exp_f32 v149, v149
v_mfma_f32_16x16x32_bf16 a[112:115], a[176:179], v[192:195], a[112:115]
ds_read_b128 a[156:159], v2 offset:3072
v_cvt_pk_bf16_f32 v214, v148, v149
v_mfma_f32_16x16x32_bf16 a[116:119], a[184:187], v[192:195], a[116:119]
v_exp_f32 v150, v150
v_mfma_f32_16x16x32_bf16 a[116:119], a[188:191], v[196:199], a[116:119]
buffer_load_dwordx4 v16, s[32:35], s70 offen offset:0 sc1 lds
v_mfma_f32_16x16x32_bf16 a[84:87], a[188:191], v[188:191], a[84:87]
s_sub_u32 s72, s72, 1
v_exp_f32 v151, v151
v_mfma_f32_16x16x32_bf16 a[84:87], a[184:187], v[184:187], a[84:87]
ds_read_b128 a[160:163], v2 offset:4096
v_cvt_pk_bf16_f32 v215, v150, v151
v_mfma_f32_16x16x32_bf16 a[88:91], a[192:195], v[184:187], a[88:91]
v_exp_f32 v132, v132
v_mfma_f32_16x16x32_bf16 a[88:91], a[196:199], v[188:191], a[88:91]
ds_read_b128 a[164:167], v2 offset:5120
v_xor_b32 v3, 0x8000, v3
v_mfma_f32_16x16x32_bf16 a[120:123], a[196:199], v[196:199], a[120:123]
s_cmp_lg_u32 s72, 0
v_exp_f32 v133, v133
v_mfma_f32_16x16x32_bf16 a[120:123], a[192:195], v[192:195], a[120:123]
ds_read_b128 a[168:171], v2 offset:6144
v_cvt_pk_bf16_f32 v206, v132, v133
v_mfma_f32_16x16x32_bf16 a[124:127], a[200:203], v[192:195], a[124:127]
s_waitcnt lgkmcnt(3)
v_exp_f32 v134, v134
v_mfma_f32_16x16x32_bf16 a[124:127], a[204:207], v[196:199], a[124:127]
buffer_load_dwordx4 v16, s[32:35], s70 offen offset:1024 sc1 lds
v_mfma_f32_16x16x32_bf16 a[92:95], a[204:207], v[188:191], a[92:95]
v_exp_f32 v135, v135
v_mfma_f32_16x16x32_bf16 a[92:95], a[200:203], v[184:187], a[92:95]
ds_read_b128 a[172:175], v2 offset:7168
v_cvt_pk_bf16_f32 v207, v134, v135
s_cbranch_scc1 L_S
L_SD:
buffer_load_dword v19, off, s[52:55], s80 sc1
s_waitcnt lgkmcnt(7)
v_mfma_f32_16x16x32_bf16 v[136:139], a[144:147], v[72:75], v[228:231]
s_waitcnt lgkmcnt(6)
ds_read_b128 a[176:179], v2 offset:8192
ds_read_b128 a[180:183], v2 offset:9216
v_mfma_f32_16x16x32_bf16 v[136:139], a[148:151], v[76:79], v[136:139]
s_waitcnt lgkmcnt(7)
buffer_load_dwordx4 v16, s[32:35], s70 offen offset:2048 sc1 lds
v_cndmask_b32 v120, v224, v17, s[0:1]
v_cndmask_b32 v121, v224, v17, s[4:5]
v_cndmask_b32 v122, v224, v17, s[6:7]
v_cndmask_b32 v123, v224, v17, s[8:9]
v_mfma_f32_16x16x32_bf16 v[136:139], a[152:155], v[80:83], v[136:139]
s_waitcnt lgkmcnt(6)
s_add_u32 s64, s70, 4096
ds_read_b128 a[184:187], v2 offset:10240
ds_read_b128 a[188:191], v2 offset:11264
v_mfma_f32_16x16x32_bf16 v[136:139], a[156:159], v[84:87], v[136:139]
buffer_load_dwordx4 v16, s[32:35], s70 offen offset:3072 sc1 lds
v_mfma_f32_16x16x32_bf16 v[120:123], a[156:159], v[68:71], v[120:123]
s_add_u32 m0, s71, 4096
ds_read_b128 a[192:195], v2 offset:12288
ds_read_b128 a[196:199], v2 offset:13312
v_mfma_f32_16x16x32_bf16 v[120:123], a[152:155], v[64:67], v[120:123]
buffer_load_dwordx4 v16, s[32:35], s64 offen offset:0 sc1 lds
v_mfma_f32_16x16x32_bf16 v[120:123], a[148:151], v[60:63], v[120:123]
ds_read_b128 a[200:203], v2 offset:14336
ds_read_b128 a[204:207], v2 offset:15360
v_mfma_f32_16x16x32_bf16 v[120:123], a[144:147], v[56:59], v[120:123]
s_waitcnt lgkmcnt(6)
v_exp_f32 v136, v136
v_mfma_f32_16x16x32_bf16 v[140:143], a[160:163], v[72:75], v[228:231]
v_exp_f32 v137, v137
v_mfma_f32_16x16x32_bf16 v[140:143], a[164:167], v[76:79], v[140:143]
v_cndmask_b32 v124, v224, v17, s[10:11]
v_cndmask_b32 v125, v224, v17, s[12:13]
v_cndmask_b32 v126, v224, v17, s[18:19]
v_cndmask_b32 v127, v224, v17, s[22:23]
v_exp_f32 v138, v138
v_mfma_f32_16x16x32_bf16 v[140:143], a[168:171], v[80:83], v[140:143]
v_exp_f32 v139, v139
v_mfma_f32_16x16x32_bf16 v[140:143], a[172:175], v[84:87], v[140:143]
v_exp_f32 v120, v120
v_mfma_f32_16x16x32_bf16 v[124:127], a[172:175], v[68:71], v[124:127]
ds_read_b128 a[144:147], v3 offset:0
v_cvt_pk_bf16_f32 v192, v136, v137
v_mfma_f32_16x16x32_bf16 v[124:127], a[168:171], v[64:67], v[124:127]
v_cndmask_b32 v128, v224, v17, s[26:27]
v_cndmask_b32 v129, v224, v17, s[56:57]
v_cndmask_b32 v130, v224, v17, s[58:59]
v_cndmask_b32 v131, v224, v17, s[60:61]
v_exp_f32 v121, v121
v_mfma_f32_16x16x32_bf16 v[124:127], a[164:167], v[60:63], v[124:127]
s_mul_i32 s69, s83, 8
ds_read_b128 a[148:151], v3 offset:8192
v_cvt_pk_bf16_f32 v193, v138, v139
v_mfma_f32_16x16x32_bf16 v[124:127], a[160:163], v[56:59], v[124:127]
s_sub_u32 s69, 36, s69
v_exp_f32 v122, v122
v_mfma_f32_16x16x32_bf16 v[128:131], a[176:179], v[56:59], v[128:131]
ds_read_b128 a[152:155], v3 offset:1024
v_cvt_pk_bf16_f32 v184, v120, v121
v_mfma_f32_16x16x32_bf16 v[128:131], a[180:183], v[60:63], v[128:131]
s_waitcnt lgkmcnt(3)
v_exp_f32 v123, v123
v_mfma_f32_16x16x32_bf16 v[128:131], a[184:187], v[64:67], v[128:131]
ds_read_b128 a[156:159], v3 offset:9216
v_cvt_pk_bf16_f32 v185, v122, v123
v_mfma_f32_16x16x32_bf16 v[128:131], a[188:191], v[68:71], v[128:131]
v_exp_f32 v140, v140
v_mfma_f32_16x16x32_bf16 v[144:147], a[188:191], v[84:87], v[228:231]
buffer_load_dwordx4 v16, s[32:35], s64 offen offset:1024 sc1 lds
v_mfma_f32_16x16x32_bf16 v[144:147], a[184:187], v[80:83], v[144:147]
v_exp_f32 v141, v141
v_mfma_f32_16x16x32_bf16 v[144:147], a[180:183], v[76:79], v[144:147]
ds_read_b128 a[160:163], v3 offset:2048
v_cvt_pk_bf16_f32 v194, v140, v141
v_mfma_f32_16x16x32_bf16 v[144:147], a[176:179], v[72:75], v[144:147]
v_exp_f32 v142, v142
v_mfma_f32_16x16x32_bf16 v[148:151], a[192:195], v[72:75], v[228:231]
ds_read_b128 a[164:167], v3 offset:10240
ds_read_b128 a[168:171], v3 offset:3072
v_mfma_f32_16x16x32_bf16 v[148:151], a[196:199], v[76:79], v[148:151]
v_cndmask_b32 v132, v224, v17, s[62:63]
v_cndmask_b32 v133, v224, v17, s[48:49]
v_cndmask_b32 v134, v224, v17, s[50:51]
v_cndmask_b32 v135, v224, v17, s[100:101]
v_exp_f32 v143, v143
v_mfma_f32_16x16x32_bf16 v[148:151], a[200:203], v[80:83], v[148:151]
ds_read_b128 a[172:175], v3 offset:11264
v_cvt_pk_bf16_f32 v195, v142, v143
v_mfma_f32_16x16x32_bf16 v[148:151], a[204:207], v[84:87], v[148:151]
v_exp_f32 v124, v124
v_mfma_f32_16x16x32_bf16 v[132:135], a[204:207], v[68:71], v[132:135]
ds_read_b128 a[176:179], v3 offset:4096
buffer_load_dwordx4 v16, s[32:35], s64 offen offset:2048 sc1 lds
v_mfma_f32_16x16x32_bf16 v[132:135], a[200:203], v[64:67], v[132:135]
v_exp_f32 v125, v125
v_mfma_f32_16x16x32_bf16 v[132:135], a[196:199], v[60:63], v[132:135]
ds_read_b128 a[180:183], v3 offset:12288
v_cvt_pk_bf16_f32 v186, v124, v125
v_mfma_f32_16x16x32_bf16 v[132:135], a[192:195], v[56:59], v[132:135]
v_exp_f32 v126, v126
v_smfmac_f32_16x16x64_bf16 a[136:139], a[240:243], v[200:207], v5
ds_read_b128 a[184:187], v3 offset:5120
v_smfmac_f32_16x16x64_bf16 a[140:143], a[240:243], v[208:215], v5
s_branch L_po19
L_pg19:
s_branch L_pg23
L_po19:
s_waitcnt lgkmcnt(3)
ds_read_b128 a[188:191], v3 offset:13312
v_mfma_f32_16x16x32_bf16 a[64:67], a[144:147], v[200:203], a[64:67]
v_exp_f32 v127, v127
v_mfma_f32_16x16x32_bf16 a[64:67], a[148:151], v[204:207], a[64:67]
v_exp_f32 v128, v128
v_mfma_f32_16x16x32_bf16 a[96:99], a[148:151], v[212:215], a[96:99]
v_exp_f32 v129, v129
v_mfma_f32_16x16x32_bf16 a[96:99], a[144:147], v[208:211], a[96:99]
ds_read_b128 a[192:195], v3 offset:6144
v_cvt_pk_bf16_f32 v187, v126, v127
v_mfma_f32_16x16x32_bf16 a[100:103], a[152:155], v[208:211], a[100:103]
v_exp_f32 v130, v130
v_mfma_f32_16x16x32_bf16 a[100:103], a[156:159], v[212:215], a[100:103]
ds_read_b128 a[196:199], v3 offset:14336
v_cvt_pk_bf16_f32 v188, v128, v129
v_mfma_f32_16x16x32_bf16 a[68:71], a[156:159], v[204:207], a[68:71]
v_exp_f32 v131, v131
v_mfma_f32_16x16x32_bf16 a[68:71], a[152:155], v[200:203], a[68:71]
ds_read_b128 a[200:203], v3 offset:7168
v_cvt_pk_bf16_f32 v189, v130, v131
v_mfma_f32_16x16x32_bf16 a[72:75], a[160:163], v[200:203], a[72:75]
v_exp_f32 v144, v144
v_mfma_f32_16x16x32_bf16 a[72:75], a[164:167], v[204:207], a[72:75]
buffer_load_dwordx4 v16, s[32:35], s64 offen offset:3072 sc1 lds
v_mfma_f32_16x16x32_bf16 a[104:107], a[164:167], v[212:215], a[104:107]
v_exp_f32 v145, v145
v_mfma_f32_16x16x32_bf16 a[104:107], a[160:163], v[208:211], a[104:107]
ds_read_b128 a[204:207], v3 offset:15360
v_cvt_pk_bf16_f32 v196, v144, v145
v_mfma_f32_16x16x32_bf16 a[108:111], a[168:171], v[208:211], a[108:111]
v_exp_f32 v146, v146
v_mfma_f32_16x16x32_bf16 a[108:111], a[172:175], v[212:215], a[108:111]
s_waitcnt vmcnt(9)
s_barrier
v_mfma_f32_16x16x32_bf16 a[76:79], a[172:175], v[204:207], a[76:79]
v_exp_f32 v147, v147
v_mfma_f32_16x16x32_bf16 a[76:79], a[168:171], v[200:203], a[76:79]
s_waitcnt lgkmcnt(1)
ds_read_b128 a[144:147], v2 offset:16384
v_cvt_pk_bf16_f32 v197, v146, v147
v_mfma_f32_16x16x32_bf16 a[80:83], a[176:179], v[200:203], a[80:83]
s_waitcnt vmcnt(6)
v_readfirstlane_b32 vcc_lo, v19
s_nop 0
s_cmp_lt_u32 vcc_lo, s69
s_cbranch_scc1 L_spin_8
L_spinbk_9:
v_exp_f32 v148, v148
v_mfma_f32_16x16x32_bf16 a[80:83], a[180:183], v[204:207], a[80:83]
ds_read_b128 a[148:151], v2 offset:17408
ds_read_b128 a[152:155], v2 offset:18432
v_mfma_f32_16x16x32_bf16 a[112:115], a[180:183], v[212:215], a[112:115]
v_exp_f32 v149, v149
v_mfma_f32_16x16x32_bf16 a[112:115], a[176:179], v[208:211], a[112:115]
ds_read_b128 a[156:159], v2 offset:19456
v_cvt_pk_bf16_f32 v198, v148, v149
v_mfma_f32_16x16x32_bf16 a[116:119], a[184:187], v[208:211], a[116:119]
v_exp_f32 v150, v150
v_mfma_f32_16x16x32_bf16 a[116:119], a[188:191], v[212:215], a[116:119]
v_cndmask_b32 v136, v228, v17, s[0:1]
v_cndmask_b32 v137, v228, v17, s[4:5]
v_mfma_f32_16x16x32_bf16 a[84:87], a[188:191], v[204:207], a[84:87]
v_exp_f32 v151, v151
v_mfma_f32_16x16x32_bf16 a[84:87], a[184:187], v[200:203], a[84:87]
ds_read_b128 a[160:163], v2 offset:20480
v_cvt_pk_bf16_f32 v199, v150, v151
v_mfma_f32_16x16x32_bf16 a[88:91], a[192:195], v[200:203], a[88:91]
v_exp_f32 v132, v132
v_mfma_f32_16x16x32_bf16 a[88:91], a[196:199], v[204:207], a[88:91]
ds_read_b128 a[164:167], v2 offset:21504
v_cndmask_b32 v138, v228, v17, s[6:7]
v_mfma_f32_16x16x32_bf16 a[120:123], a[196:199], v[212:215], a[120:123]
v_exp_f32 v133, v133
v_mfma_f32_16x16x32_bf16 a[120:123], a[192:195], v[208:211], a[120:123]
ds_read_b128 a[168:171], v2 offset:22528
v_cvt_pk_bf16_f32 v190, v132, v133
v_mfma_f32_16x16x32_bf16 a[124:127], a[200:203], v[208:211], a[124:127]
s_waitcnt lgkmcnt(3)
v_exp_f32 v134, v134
v_mfma_f32_16x16x32_bf16 a[124:127], a[204:207], v[212:215], a[124:127]
v_cndmask_b32 v139, v228, v17, s[8:9]
v_cndmask_b32 v140, v228, v17, s[10:11]
v_mfma_f32_16x16x32_bf16 a[92:95], a[204:207], v[204:207], a[92:95]
v_exp_f32 v135, v135
v_mfma_f32_16x16x32_bf16 a[92:95], a[200:203], v[200:203], a[92:95]
ds_read_b128 a[172:175], v2 offset:23552
v_cvt_pk_bf16_f32 v191, v134, v135
v_mfma_f32_16x16x32_bf16 v[136:139], a[144:147], v[72:75], v[136:139]
ds_read_b128 a[176:179], v2 offset:24576
v_cndmask_b32 v141, v228, v17, s[12:13]
v_mfma_f32_16x16x32_bf16 v[136:139], a[148:151], v[76:79], v[136:139]
ds_read_b128 a[180:183], v2 offset:25600
v_cndmask_b32 v142, v228, v17, s[18:19]
v_cndmask_b32 v143, v228, v17, s[22:23]
v_mfma_f32_16x16x32_bf16 v[136:139], a[152:155], v[80:83], v[136:139]
ds_read_b128 a[184:187], v2 offset:26624
v_cndmask_b32 v144, v228, v17, s[26:27]
v_mfma_f32_16x16x32_bf16 v[136:139], a[156:159], v[84:87], v[136:139]
s_waitcnt lgkmcnt(3)
ds_read_b128 a[188:191], v2 offset:27648
v_cndmask_b32 v145, v228, v17, s[56:57]
v_mfma_f32_16x16x32_bf16 v[140:143], a[172:175], v[84:87], v[140:143]
ds_read_b128 a[192:195], v2 offset:28672
ds_read_b128 a[196:199], v2 offset:29696
ds_read_b128 a[200:203], v2 offset:30720
ds_read_b128 a[204:207], v2 offset:31744
v_mfma_f32_16x16x32_bf16 v[140:143], a[168:171], v[80:83], v[140:143]
ds_read_b128 a[144:147], v3 offset:16384
v_cndmask_b32 v146, v228, v17, s[58:59]
v_cndmask_b32 v147, v228, v17, s[60:61]
v_mfma_f32_16x16x32_bf16 v[140:143], a[164:167], v[76:79], v[140:143]
ds_read_b128 a[148:151], v3 offset:24576
v_cndmask_b32 v148, v228, v17, s[62:63]
v_mfma_f32_16x16x32_bf16 v[140:143], a[160:163], v[72:75], v[140:143]
s_waitcnt lgkmcnt(8)
ds_read_b128 a[152:155], v3 offset:17408
v_cndmask_b32 v149, v228, v17, s[48:49]
v_mfma_f32_16x16x32_bf16 v[144:147], a[176:179], v[72:75], v[144:147]
ds_read_b128 a[156:159], v3 offset:25600
v_cndmask_b32 v150, v228, v17, s[50:51]
v_mfma_f32_16x16x32_bf16 v[144:147], a[180:183], v[76:79], v[144:147]
s_waitcnt lgkmcnt(8)
ds_read_b128 a[160:163], v3 offset:18432
v_cndmask_b32 v151, v228, v17, s[100:101]
v_mfma_f32_16x16x32_bf16 v[144:147], a[184:187], v[80:83], v[144:147]
v_exp_f32 v136, v136
v_mfma_f32_16x16x32_bf16 v[144:147], a[188:191], v[84:87], v[144:147]
s_waitcnt lgkmcnt(4)
v_exp_f32 v137, v137
v_mfma_f32_16x16x32_bf16 v[148:151], a[204:207], v[84:87], v[148:151]
v_exp_f32 v138, v138
v_mfma_f32_16x16x32_bf16 v[148:151], a[200:203], v[80:83], v[148:151]
s_add_u32 s65, s84, 0
v_exp_f32 v139, v139
v_mfma_f32_16x16x32_bf16 v[148:151], a[196:199], v[76:79], v[148:151]
buffer_load_dwordx4 a[208:211], v14, s[44:47], s65 offen offset:0 sc1
v_mfma_f32_16x16x32_bf16 v[148:151], a[192:195], v[72:75], v[148:151]
ds_read_b128 a[164:167], v3 offset:26624
v_cvt_pk_bf16_f32 v208, v136, v137
v_smfmac_f32_16x16x64_bf16 a[136:139], a[240:243], v[184:191], v5
ds_read_b128 a[168:171], v3 offset:19456
v_smfmac_f32_16x16x64_bf16 a[140:143], a[240:243], v[192:199], v5
ds_read_b128 a[172:175], v3 offset:27648
v_mfma_f32_16x16x32_bf16 a[64:67], a[144:147], v[184:187], a[64:67]
s_waitcnt lgkmcnt(3)
v_exp_f32 v140, v140
v_mfma_f32_16x16x32_bf16 a[64:67], a[148:151], v[188:191], a[64:67]
buffer_load_dwordx4 a[216:219], v14, s[44:47], s65 offen offset:1024 sc1
v_mfma_f32_16x16x32_bf16 a[96:99], a[148:151], v[196:199], a[96:99]
v_exp_f32 v141, v141
v_mfma_f32_16x16x32_bf16 a[96:99], a[144:147], v[192:195], a[96:99]
buffer_load_dwordx4 a[224:227], v15, s[44:47], s65 offen offset:0 sc1
v_mfma_f32_16x16x32_bf16 a[100:103], a[152:155], v[192:195], a[100:103]
v_exp_f32 v142, v142
v_mfma_f32_16x16x32_bf16 a[100:103], a[156:159], v[196:199], a[100:103]
buffer_load_dwordx4 a[232:235], v15, s[44:47], s65 offen offset:1024 sc1
v_mfma_f32_16x16x32_bf16 a[68:71], a[156:159], v[188:191], a[68:71]
s_add_u32 s65, s84, 8192
ds_read_b128 a[176:179], v3 offset:20480
v_cvt_pk_bf16_f32 v209, v138, v139
v_mfma_f32_16x16x32_bf16 a[68:71], a[152:155], v[184:187], a[68:71]
buffer_load_dwordx4 a[212:215], v14, s[44:47], s65 offen offset:0 sc1
v_mfma_f32_16x16x32_bf16 a[72:75], a[160:163], v[184:187], a[72:75]
s_waitcnt lgkmcnt(1)
ds_read_b128 a[180:183], v3 offset:28672
v_cvt_pk_bf16_f32 v210, v140, v141
v_mfma_f32_16x16x32_bf16 a[72:75], a[164:167], v[188:191], a[72:75]
v_exp_f32 v143, v143
v_mfma_f32_16x16x32_bf16 a[104:107], a[164:167], v[196:199], a[104:107]
buffer_load_dwordx4 a[220:223], v14, s[44:47], s65 offen offset:1024 sc1
v_mfma_f32_16x16x32_bf16 a[104:107], a[160:163], v[192:195], a[104:107]
v_exp_f32 v144, v144
v_mfma_f32_16x16x32_bf16 a[108:111], a[168:171], v[192:195], a[108:111]
ds_read_b128 a[184:187], v3 offset:21504
v_xor_b32 v2, 0x8000, v2
v_mfma_f32_16x16x32_bf16 a[108:111], a[172:175], v[196:199], a[108:111]
buffer_load_dwordx4 a[228:231], v15, s[44:47], s65 offen offset:0 sc1
ds_read_b128 a[188:191], v3 offset:29696
v_mfma_f32_16x16x32_bf16 a[76:79], a[172:175], v[188:191], a[76:79]
v_exp_f32 v145, v145
v_mfma_f32_16x16x32_bf16 a[76:79], a[168:171], v[184:187], a[76:79]
s_waitcnt lgkmcnt(2)
buffer_load_dwordx4 a[236:239], v15, s[44:47], s65 offen offset:1024 sc1
v_mfma_f32_16x16x32_bf16 a[80:83], a[176:179], v[184:187], a[80:83]
s_add_u32 s65, s84, 32768
ds_read_b128 a[192:195], v3 offset:22528
v_cvt_pk_bf16_f32 v211, v142, v143
v_mfma_f32_16x16x32_bf16 a[80:83], a[180:183], v[188:191], a[80:83]
buffer_load_dwordx4 v[152:155], v14, s[44:47], s65 offen offset:0 sc1
ds_read_b128 a[196:199], v3 offset:30720
v_exp_f32 v146, v146
v_mfma_f32_16x16x32_bf16 a[112:115], a[180:183], v[196:199], a[112:115]
ds_read_b128 a[200:203], v3 offset:23552
ds_read_b128 a[204:207], v3 offset:31744
v_mfma_f32_16x16x32_bf16 a[112:115], a[176:179], v[192:195], a[112:115]
s_waitcnt vmcnt(9)
s_barrier
v_xor_b32 v3, 0x8000, v3
buffer_load_dwordx4 v[160:163], v14, s[44:47], s65 offen offset:1024 sc1
s_waitcnt lgkmcnt(4)
v_mfma_f32_16x16x32_bf16 a[116:119], a[184:187], v[192:195], a[116:119]
v_exp_f32 v147, v147
v_mfma_f32_16x16x32_bf16 a[116:119], a[188:191], v[196:199], a[116:119]
buffer_load_dwordx4 v[168:171], v15, s[44:47], s65 offen offset:0 sc1
v_mfma_f32_16x16x32_bf16 a[84:87], a[188:191], v[188:191], a[84:87]
v_exp_f32 v148, v148
v_mfma_f32_16x16x32_bf16 a[84:87], a[184:187], v[184:187], a[84:87]
s_waitcnt lgkmcnt(2)
buffer_load_dwordx4 v[176:179], v15, s[44:47], s65 offen offset:1024 sc1
v_cvt_pk_bf16_f32 v212, v144, v145
v_mfma_f32_16x16x32_bf16 a[88:91], a[192:195], v[184:187], a[88:91]
s_add_u32 s65, s84, 40960
v_exp_f32 v149, v149
v_mfma_f32_16x16x32_bf16 a[88:91], a[196:199], v[188:191], a[88:91]
buffer_load_dwordx4 v[156:159], v14, s[44:47], s65 offen offset:0 sc1
v_mfma_f32_16x16x32_bf16 a[120:123], a[196:199], v[196:199], a[120:123]
ds_read_b128 a[144:147], v3 offset:0
v_cvt_pk_bf16_f32 v213, v146, v147
v_mfma_f32_16x16x32_bf16 a[120:123], a[192:195], v[192:195], a[120:123]
s_waitcnt lgkmcnt(1)
buffer_load_dwordx4 v[164:167], v14, s[44:47], s65 offen offset:1024 sc1
ds_read_b128 a[148:151], v3 offset:8192
v_exp_f32 v150, v150
v_mfma_f32_16x16x32_bf16 a[124:127], a[200:203], v[192:195], a[124:127]
ds_read_b128 a[152:155], v3 offset:1024
v_cvt_pk_bf16_f32 v214, v148, v149
v_mfma_f32_16x16x32_bf16 a[124:127], a[204:207], v[196:199], a[124:127]
buffer_load_dwordx4 v[172:175], v15, s[44:47], s65 offen offset:0 sc1
ds_read_b128 a[156:159], v3 offset:9216
v_mfma_f32_16x16x32_bf16 a[92:95], a[204:207], v[188:191], a[92:95]
v_exp_f32 v151, v151
v_mfma_f32_16x16x32_bf16 a[92:95], a[200:203], v[184:187], a[92:95]
buffer_load_dwordx4 v[180:183], v15, s[44:47], s65 offen offset:1024 sc1
ds_read_b128 a[160:163], v3 offset:2048
ds_read_b128 a[164:167], v3 offset:10240
ds_read_b128 a[168:171], v3 offset:3072
ds_read_b128 a[172:175], v3 offset:11264
v_cvt_pk_bf16_f32 v215, v150, v151
v_accvgpr_read_b32 v22, a136
v_accvgpr_read_b32 v248, a137
v_add_f32 v22, v22, v248
v_max_f32 v1, v1, v22
v_rcp_f32 v22, v22
v_accvgpr_read_b32 v232, a64
v_accvgpr_read_b32 v233, a65
v_accvgpr_read_b32 v234, a66
v_accvgpr_read_b32 v235, a67
v_accvgpr_read_b32 v236, a68
v_accvgpr_read_b32 v237, a69
v_accvgpr_read_b32 v238, a70
v_accvgpr_read_b32 v239, a71
v_mul_f32 v22, v22, v8
v_mul_f32 v232, v232, v22
v_mul_f32 v233, v233, v22
v_mul_f32 v234, v234, v22
v_mul_f32 v235, v235, v22
v_mul_f32 v236, v236, v22
v_mul_f32 v237, v237, v22
v_mul_f32 v238, v238, v22
v_mul_f32 v239, v239, v22
v_cvt_pk_bf16_f32 v232, v232, v233
v_cvt_pk_bf16_f32 v233, v234, v235
v_cvt_pk_bf16_f32 v234, v236, v237
v_cvt_pk_bf16_f32 v235, v238, v239
s_add_u32 s77, s75, 0
buffer_store_dwordx4 v[232:235], v16, s[44:47], s77 offen sc1
L_TAIL:
ds_read_b128 a[176:179], v3 offset:4096
ds_read_b128 a[180:183], v3 offset:12288
ds_read_b128 a[184:187], v3 offset:5120
ds_read_b128 a[188:191], v3 offset:13312
v_smfmac_f32_16x16x64_bf16 a[140:143], a[240:243], v[208:215], v5
s_waitcnt lgkmcnt(11)
s_add_u32 m0, s86, 32768
s_add_u32 s64, s85, 262144
ds_read_b128 a[192:195], v3 offset:6144
v_mfma_f32_16x16x32_bf16 a[96:99], a[144:147], v[208:211], a[96:99]
s_waitcnt lgkmcnt(11)
ds_read_b128 a[196:199], v3 offset:14336
ds_read_b128 a[200:203], v3 offset:7168
ds_read_b128 a[204:207], v3 offset:15360
v_mfma_f32_16x16x32_bf16 a[96:99], a[148:151], v[212:215], a[96:99]
s_waitcnt lgkmcnt(12)
buffer_load_dwordx4 v12, s[36:39], s64 offen lds
v_mfma_f32_16x16x32_bf16 a[100:103], a[156:159], v[212:215], a[100:103]
s_add_u32 m0, s86, 33792
s_add_u32 s64, s85, 270336
v_accvgpr_read_b32 v240, a72
v_accvgpr_read_b32 v241, a73
v_mfma_f32_16x16x32_bf16 a[100:103], a[152:155], v[208:211], a[100:103]
s_waitcnt lgkmcnt(11)
buffer_load_dwordx4 v13, s[36:39], s64 offen lds
v_mfma_f32_16x16x32_bf16 a[104:107], a[160:163], v[208:211], a[104:107]
s_waitcnt lgkmcnt(10)
s_add_u32 m0, s86, 34816
s_add_u32 s64, s85, 278528
v_accvgpr_read_b32 v242, a74
v_accvgpr_read_b32 v243, a75
v_mfma_f32_16x16x32_bf16 a[104:107], a[164:167], v[212:215], a[104:107]
s_waitcnt lgkmcnt(8)
buffer_load_dwordx4 v12, s[36:39], s64 offen lds
v_mfma_f32_16x16x32_bf16 a[108:111], a[172:175], v[212:215], a[108:111]
s_add_u32 m0, s86, 35840
s_add_u32 s64, s85, 286720
v_accvgpr_read_b32 v244, a76
v_accvgpr_read_b32 v245, a77
v_mfma_f32_16x16x32_bf16 a[108:111], a[168:171], v[208:211], a[108:111]
s_waitcnt lgkmcnt(7)
buffer_load_dwordx4 v13, s[36:39], s64 offen lds
v_mfma_f32_16x16x32_bf16 a[112:115], a[176:179], v[208:211], a[112:115]
s_waitcnt lgkmcnt(6)
s_add_u32 m0, s86, 36864
s_add_u32 s64, s85, 294912
v_accvgpr_read_b32 v246, a78
v_accvgpr_read_b32 v247, a79
v_mfma_f32_16x16x32_bf16 a[112:115], a[180:183], v[212:215], a[112:115]
s_waitcnt lgkmcnt(4)
buffer_load_dwordx4 v12, s[36:39], s64 offen lds
v_mfma_f32_16x16x32_bf16 a[116:119], a[188:191], v[212:215], a[116:119]
s_add_u32 m0, s86, 37888
s_add_u32 s64, s85, 303104
v_mul_f32 v240, v240, v22
v_mul_f32 v241, v241, v22
v_mfma_f32_16x16x32_bf16 a[116:119], a[184:187], v[208:211], a[116:119]
s_waitcnt lgkmcnt(3)
buffer_load_dwordx4 v13, s[36:39], s64 offen lds
v_mfma_f32_16x16x32_bf16 a[120:123], a[192:195], v[208:211], a[120:123]
s_waitcnt lgkmcnt(2)
s_add_u32 m0, s86, 38912
s_add_u32 s64, s85, 311296
v_mul_f32 v242, v242, v22
v_mul_f32 v243, v243, v22
v_mfma_f32_16x16x32_bf16 a[120:123], a[196:199], v[212:215], a[120:123]
s_waitcnt lgkmcnt(0)
buffer_load_dwordx4 v12, s[36:39], s64 offen lds
v_mfma_f32_16x16x32_bf16 a[124:127], a[204:207], v[212:215], a[124:127]
s_add_u32 m0, s86, 39936
s_add_u32 s64, s85, 319488
v_mul_f32 v244, v244, v22
v_mul_f32 v245, v245, v22
v_mfma_f32_16x16x32_bf16 a[124:127], a[200:203], v[208:211], a[124:127]
buffer_load_dwordx4 v13, s[36:39], s64 offen lds
v_mul_f32 v246, v246, v22
v_mul_f32 v247, v247, v22
v_cvt_pk_bf16_f32 v240, v240, v241
v_cvt_pk_bf16_f32 v241, v242, v243
v_cvt_pk_bf16_f32 v242, v244, v245
v_cvt_pk_bf16_f32 v243, v246, v247
s_add_u32 s77, s75, 8192
buffer_store_dwordx4 v[240:243], v16, s[44:47], s77 offen sc1
v_accvgpr_read_b32 v23, a140
v_accvgpr_read_b32 v248, a141
v_add_f32 v23, v23, v248
v_max_f32 v1, v1, v23
v_rcp_f32 v23, v23
s_mov_b32 s66, 0x5d800000
v_cmp_le_f32 vcc, s66, v1
s_lshl_b32 s67, s30, 2
s_cmp_lg_u64 vcc, 0
s_cselect_b32 s66, 1, 0
v_mov_b32 v248, s67
v_mov_b32 v249, s66
ds_write_b32 v248, v249
v_accvgpr_read_b32 v232, a80
v_accvgpr_read_b32 v233, a81
v_accvgpr_read_b32 v234, a82
v_accvgpr_read_b32 v235, a83
v_accvgpr_read_b32 v236, a84
v_accvgpr_read_b32 v237, a85
v_accvgpr_read_b32 v238, a86
v_accvgpr_read_b32 v239, a87
v_pk_mul_f32 v[232:233], v[232:233], v[22:23] op_sel_hi:[1,0]
v_pk_mul_f32 v[234:235], v[234:235], v[22:23] op_sel_hi:[1,0]
v_pk_mul_f32 v[236:237], v[236:237], v[22:23] op_sel_hi:[1,0]
v_pk_mul_f32 v[238:239], v[238:239], v[22:23] op_sel_hi:[1,0]
v_cvt_pk_bf16_f32 v232, v232, v233
v_cvt_pk_bf16_f32 v233, v234, v235
v_cvt_pk_bf16_f32 v234, v236, v237
v_cvt_pk_bf16_f32 v235, v238, v239
s_add_u32 s77, s75, 16384
buffer_store_dwordx4 v[232:235], v16, s[44:47], s77 offen sc1
v_accvgpr_read_b32 v240, a88
v_accvgpr_read_b32 v241, a89
v_accvgpr_read_b32 v242, a90
v_accvgpr_read_b32 v243, a91
v_accvgpr_read_b32 v244, a92
v_accvgpr_read_b32 v245, a93
v_accvgpr_read_b32 v246, a94
v_accvgpr_read_b32 v247, a95
v_pk_mul_f32 v[240:241], v[240:241], v[22:23] op_sel_hi:[1,0]
v_pk_mul_f32 v[242:243], v[242:243], v[22:23] op_sel_hi:[1,0]
v_pk_mul_f32 v[244:245], v[244:245], v[22:23] op_sel_hi:[1,0]
v_pk_mul_f32 v[246:247], v[246:247], v[22:23] op_sel_hi:[1,0]
v_cvt_pk_bf16_f32 v240, v240, v241
v_cvt_pk_bf16_f32 v241, v242, v243
v_cvt_pk_bf16_f32 v242, v244, v245
v_cvt_pk_bf16_f32 v243, v246, v247
s_add_u32 s77, s75, 24576
buffer_store_dwordx4 v[240:243], v16, s[44:47], s77 offen sc1
v_accvgpr_read_b32 v232, a96
v_accvgpr_read_b32 v233, a97
v_accvgpr_read_b32 v234, a98
v_accvgpr_read_b32 v235, a99
v_accvgpr_read_b32 v236, a100
v_accvgpr_read_b32 v237, a101
v_accvgpr_read_b32 v238, a102
v_accvgpr_read_b32 v239, a103
v_mul_f32 v23, v23, v10
v_pk_mul_f32 v[232:233], v[232:233], v[22:23] op_sel:[0,1]
v_pk_mul_f32 v[234:235], v[234:235], v[22:23] op_sel:[0,1]
v_pk_mul_f32 v[236:237], v[236:237], v[22:23] op_sel:[0,1]
v_pk_mul_f32 v[238:239], v[238:239], v[22:23] op_sel:[0,1]
v_cvt_pk_bf16_f32 v232, v232, v233
v_cvt_pk_bf16_f32 v233, v234, v235
v_cvt_pk_bf16_f32 v234, v236, v237
v_cvt_pk_bf16_f32 v235, v238, v239
s_add_u32 s77, s75, 4096
buffer_store_dwordx4 v[232:235], v16, s[44:47], s77 offen sc1
v_accvgpr_read_b32 v240, a104
v_accvgpr_read_b32 v241, a105
v_accvgpr_read_b32 v242, a106
v_accvgpr_read_b32 v243, a107
v_accvgpr_read_b32 v244, a108
v_accvgpr_read_b32 v245, a109
v_accvgpr_read_b32 v246, a110
v_accvgpr_read_b32 v247, a111
v_pk_mul_f32 v[240:241], v[240:241], v[22:23] op_sel:[0,1]
v_pk_mul_f32 v[242:243], v[242:243], v[22:23] op_sel:[0,1]
v_pk_mul_f32 v[244:245], v[244:245], v[22:23] op_sel:[0,1]
v_pk_mul_f32 v[246:247], v[246:247], v[22:23] op_sel:[0,1]
v_cvt_pk_bf16_f32 v240, v240, v241
v_cvt_pk_bf16_f32 v241, v242, v243
v_cvt_pk_bf16_f32 v242, v244, v245
v_cvt_pk_bf16_f32 v243, v246, v247
s_add_u32 s77, s75, 12288
buffer_store_dwordx4 v[240:243], v16, s[44:47], s77 offen sc1
v_accvgpr_read_b32 v232, a112
v_accvgpr_read_b32 v233, a113
v_accvgpr_read_b32 v234, a114
v_accvgpr_read_b32 v235, a115
v_accvgpr_read_b32 v236, a116
v_accvgpr_read_b32 v237, a117
v_accvgpr_read_b32 v238, a118
v_accvgpr_read_b32 v239, a119
v_pk_mul_f32 v[232:233], v[232:233], v[22:23] op_sel:[0,1]
v_pk_mul_f32 v[234:235], v[234:235], v[22:23] op_sel:[0,1]
v_pk_mul_f32 v[236:237], v[236:237], v[22:23] op_sel:[0,1]
v_pk_mul_f32 v[238:239], v[238:239], v[22:23] op_sel:[0,1]
v_cvt_pk_bf16_f32 v232, v232, v233
v_cvt_pk_bf16_f32 v233, v234, v235
v_cvt_pk_bf16_f32 v234, v236, v237
v_cvt_pk_bf16_f32 v235, v238, v239
s_add_u32 s77, s75, 20480
buffer_store_dwordx4 v[232:235], v16, s[44:47], s77 offen sc1
v_accvgpr_read_b32 v240, a120
v_accvgpr_read_b32 v241, a121
v_accvgpr_read_b32 v242, a122
v_accvgpr_read_b32 v243, a123
v_accvgpr_read_b32 v244, a124
v_accvgpr_read_b32 v245, a125
v_accvgpr_read_b32 v246, a126
v_accvgpr_read_b32 v247, a127
v_pk_mul_f32 v[240:241], v[240:241], v[22:23] op_sel:[0,1]
v_pk_mul_f32 v[242:243], v[242:243], v[22:23] op_sel:[0,1]
v_pk_mul_f32 v[244:245], v[244:245], v[22:23] op_sel:[0,1]
v_pk_mul_f32 v[246:247], v[246:247], v[22:23] op_sel:[0,1]
v_cvt_pk_bf16_f32 v240, v240, v241
v_cvt_pk_bf16_f32 v241, v242, v243
v_cvt_pk_bf16_f32 v242, v244, v245
v_cvt_pk_bf16_f32 v243, v246, v247
s_add_u32 s77, s75, 28672
buffer_store_dwordx4 v[240:243], v16, s[44:47], s77 offen sc1
v_mov_b32 v248, 0
s_waitcnt lgkmcnt(0)
s_barrier
ds_read_b128 v[248:251], v248
v_xor_b32 v188, 128, v18
v_xor_b32 v189, 160, v18
v_xor_b32 v190, 192, v18
ds_read_b64_tr_b16 a[144:145], v188 offset:32768
ds_read_b64_tr_b16 a[146:147], v188 offset:36864
ds_read_b64_tr_b16 a[148:149], v188 offset:40960
ds_read_b64_tr_b16 a[150:151], v188 offset:45056
ds_read_b64_tr_b16 a[152:153], v189 offset:32768
ds_read_b64_tr_b16 a[154:155], v189 offset:36864
ds_read_b64_tr_b16 a[156:157], v189 offset:40960
ds_read_b64_tr_b16 a[158:159], v189 offset:45056
ds_read_b64_tr_b16 a[160:161], v190 offset:32768
ds_read_b64_tr_b16 a[162:163], v190 offset:36864
ds_read_b64_tr_b16 a[164:165], v190 offset:40960
ds_read_b64_tr_b16 a[166:167], v190 offset:45056
v_xor_b32 v191, 224, v18
v_xor_b32 v184, 0, v18
v_xor_b32 v185, 32, v18
v_xor_b32 v186, 64, v18
v_xor_b32 v187, 96, v18
s_waitcnt lgkmcnt(12)
v_or3_b32 v248, v248, v249, v250
v_or_b32 v248, v248, v251
s_nop 0
v_readfirstlane_b32 s66, v248
s_nop 0
s_cmp_gt_u32 s66, s73
s_cbranch_scc1 L_fallback_11
s_cmp_eq_u32 s83, 0
s_cbranch_scc1 L_p5f0
s_waitcnt lgkmcnt(10)
s_waitcnt vmcnt(28)
v_mfma_f32_16x16x32_bf16 v[136:139], a[144:147], a[232:235], 0
s_waitcnt vmcnt(24)
s_waitcnt lgkmcnt(8)
s_and_b32 s68, s82, 3
s_lshl_b32 s68, s68, 11
s_add_u32 m0, s86, 98304
ds_read_b64_tr_b16 a[168:169], v191 offset:32768
v_mfma_f32_16x16x32_bf16 v[136:139], a[148:151], a[236:239], v[136:139]
s_add_u32 s76, s86, s68
s_lshr_b32 s69, s87, 8
s_add_u32 s64, s85, 524288
ds_read_b64_tr_b16 a[170:171], v191 offset:36864
v_mfma_f32_16x16x32_bf16 v[104:107], a[148:151], a[228:231], 0
s_lshr_b32 s67, s82, 1
buffer_load_dwordx4 v12, s[36:39], s64 offen lds
v_mfma_f32_16x16x32_bf16 v[104:107], a[144:147], a[224:227], v[104:107]
s_xor_b32 s69, s69, s67
s_and_b32 s69, s69, 2
s_add_u32 m0, s86, 99328
s_add_u32 s64, s85, 532480
ds_read_b64_tr_b16 a[172:173], v191 offset:40960
v_mfma_f32_16x16x32_bf16 v[72:75], a[144:147], a[216:219], 0
s_and_b32 s71, s31, 4
buffer_load_dwordx4 v13, s[36:39], s64 offen lds
v_mfma_f32_16x16x32_bf16 v[72:75], a[148:151], a[220:223], v[72:75]
s_lshl_b32 s71, s71, 5
s_add_u32 s71, s71, s79
s_add_u32 m0, s86, 100352
s_add_u32 s64, s85, 540672
ds_read_b64_tr_b16 a[174:175], v191 offset:45056
v_mfma_f32_16x16x32_bf16 v[40:43], a[148:151], a[212:215], 0
s_add_u32 s71, s71, 4096
buffer_load_dwordx4 v12, s[36:39], s64 offen lds
v_mfma_f32_16x16x32_bf16 v[40:43], a[144:147], a[208:211], v[40:43]
s_waitcnt lgkmcnt(4)
s_add_u32 s72, s80, 4096
s_lshl_b32 s69, s69, 15
s_add_u32 m0, s86, 101376
s_add_u32 s64, s85, 548864
ds_read_b64_tr_b16 a[176:177], v184 offset:32768
v_mfma_f32_16x16x32_bf16 v[44:47], a[152:155], a[208:211], 0
s_add_u32 s68, s68, s69
buffer_load_dwordx4 v13, s[36:39], s64 offen lds
v_mfma_f32_16x16x32_bf16 v[44:47], a[156:159], a[212:215], v[44:47]
s_add_u32 m0, s86, 102400
ds_read_b64_tr_b16 a[178:179], v184 offset:36864
v_xor_b32 v192, 0x10000, v184
v_mfma_f32_16x16x32_bf16 v[76:79], a[156:159], a[220:223], 0
s_add_u32 s64, s85, 557056
ds_read_b64_tr_b16 a[180:181], v184 offset:40960
v_xor_b32 v193, 0x10000, v185
v_mfma_f32_16x16x32_bf16 v[76:79], a[152:155], a[216:219], v[76:79]
buffer_load_dwordx4 v12, s[36:39], s64 offen lds
v_mfma_f32_16x16x32_bf16 v[108:111], a[152:155], a[224:227], 0
s_add_u32 m0, s86, 103424
s_add_u32 s64, s85, 565248
ds_read_b64_tr_b16 a[182:183], v184 offset:45056
v_xor_b32 v194, 0x10000, v186
v_mfma_f32_16x16x32_bf16 v[108:111], a[156:159], a[228:231], v[108:111]
buffer_load_dwordx4 v13, s[36:39], s64 offen lds
v_mfma_f32_16x16x32_bf16 v[140:143], a[156:159], a[236:239], 0
s_add_u32 m0, s86, 104448
s_add_u32 s64, s85, 573440
ds_read_b64_tr_b16 a[184:185], v185 offset:32768
v_xor_b32 v195, 0x10000, v187
v_mfma_f32_16x16x32_bf16 v[140:143], a[152:155], a[232:235], v[140:143]
buffer_load_dwordx4 v12, s[36:39], s64 offen lds
v_mfma_f32_16x16x32_bf16 v[144:147], a[160:163], a[232:235], 0
s_add_u32 m0, s86, 105472
ds_read_b64_tr_b16 a[186:187], v185 offset:36864
v_xor_b32 v196, 0x10000, v188
v_mfma_f32_16x16x32_bf16 v[144:147], a[164:167], a[236:239], v[144:147]
s_branch L_po20
L_pg20:
s_branch L_pg24
L_po20:
s_add_u32 s64, s85, 581632
ds_read_b64_tr_b16 a[188:189], v185 offset:40960
v_xor_b32 v197, 0x10000, v189
v_mfma_f32_16x16x32_bf16 v[112:115], a[164:167], a[228:231], 0
buffer_load_dwordx4 v13, s[36:39], s64 offen lds
v_mfma_f32_16x16x32_bf16 v[112:115], a[160:163], a[224:227], v[112:115]
s_add_u32 s65, s84, 65536
ds_read_b64_tr_b16 a[190:191], v185 offset:45056
v_xor_b32 v198, 0x10000, v190
v_mfma_f32_16x16x32_bf16 v[80:83], a[160:163], a[216:219], 0
buffer_load_dwordx4 a[32:35], v14, s[44:47], s65 offen offset:0 sc1
v_mfma_f32_16x16x32_bf16 v[80:83], a[164:167], a[220:223], v[80:83]
ds_read_b64_tr_b16 a[192:193], v186 offset:32768
v_xor_b32 v199, 0x10000, v191
v_mfma_f32_16x16x32_bf16 v[48:51], a[164:167], a[212:215], 0
buffer_load_dwordx4 a[40:43], v14, s[44:47], s65 offen offset:1024 sc1
v_mfma_f32_16x16x32_bf16 v[48:51], a[160:163], a[208:211], v[48:51]
s_waitcnt lgkmcnt(4)
ds_read_b64_tr_b16 a[194:195], v186 offset:36864
v_mfma_f32_16x16x32_bf16 v[52:55], a[168:171], a[208:211], 0
ds_read_b64_tr_b16 a[196:197], v186 offset:40960
v_mfma_f32_16x16x32_bf16 v[52:55], a[172:175], a[212:215], v[52:55]
buffer_load_dwordx4 a[48:51], v15, s[44:47], s65 offen offset:0 sc1
v_mfma_f32_16x16x32_bf16 v[84:87], a[172:175], a[220:223], 0
ds_read_b64_tr_b16 a[198:199], v186 offset:45056
v_mfma_f32_16x16x32_bf16 v[84:87], a[168:171], a[216:219], v[84:87]
buffer_load_dwordx4 a[56:59], v15, s[44:47], s65 offen offset:1024 sc1
v_mfma_f32_16x16x32_bf16 v[116:119], a[168:171], a[224:227], 0
s_add_u32 s65, s84, 73728
ds_read_b64_tr_b16 a[200:201], v187 offset:32768
v_mfma_f32_16x16x32_bf16 v[116:119], a[172:175], a[228:231], v[116:119]
buffer_load_dwordx4 a[36:39], v14, s[44:47], s65 offen offset:0 sc1
v_mfma_f32_16x16x32_bf16 v[148:151], a[172:175], a[236:239], 0
ds_read_b64_tr_b16 a[202:203], v187 offset:36864
v_mfma_f32_16x16x32_bf16 v[148:151], a[168:171], a[232:235], v[148:151]
ds_read_b64_tr_b16 a[204:205], v187 offset:40960
v_mfma_f32_16x16x32_bf16 v[120:123], a[176:179], a[232:235], 0
buffer_load_dwordx4 a[44:47], v14, s[44:47], s65 offen offset:1024 sc1
v_mfma_f32_16x16x32_bf16 v[120:123], a[180:183], a[236:239], v[120:123]
ds_read_b64_tr_b16 a[206:207], v187 offset:45056
v_mfma_f32_16x16x32_bf16 v[88:91], a[180:183], a[228:231], 0
buffer_load_dwordx4 a[52:55], v15, s[44:47], s65 offen offset:0 sc1
v_mfma_f32_16x16x32_bf16 v[88:91], a[176:179], a[224:227], v[88:91]
v_mfma_f32_16x16x32_bf16 v[56:59], a[176:179], a[216:219], 0
buffer_load_dwordx4 a[60:63], v15, s[44:47], s65 offen offset:1024 sc1
v_mfma_f32_16x16x32_bf16 v[56:59], a[180:183], a[220:223], v[56:59]
v_mfma_f32_16x16x32_bf16 v[24:27], a[180:183], a[212:215], 0
v_mfma_f32_16x16x32_bf16 v[24:27], a[176:179], a[208:211], v[24:27]
s_waitcnt lgkmcnt(1)
buffer_load_dword v19, off, s[52:55], s72 sc1
v_mfma_f32_16x16x32_bf16 v[28:31], a[184:187], a[208:211], 0
s_add_u32 s85, s85, 2883584
s_lshl3_add_u32 s85, s68, s85
s_waitcnt vmcnt(24) lgkmcnt(0)
s_barrier
v_mfma_f32_16x16x32_bf16 v[28:31], a[188:191], a[212:215], v[28:31]
ds_read_b64_tr_b16 a[144:145], v196 offset:0
v_mfma_f32_16x16x32_bf16 v[60:63], a[188:191], a[220:223], 0
ds_read_b64_tr_b16 a[146:147], v196 offset:4096
v_mfma_f32_16x16x32_bf16 v[60:63], a[184:187], a[216:219], v[60:63]
s_xor_b32 m0, s76, 131072
ds_read_b64_tr_b16 a[148:149], v196 offset:8192
v_mfma_f32_16x16x32_bf16 v[92:95], a[184:187], a[224:227], 0
s_xor_b32 s64, s85, 0
ds_read_b64_tr_b16 a[150:151], v196 offset:12288
v_mfma_f32_16x16x32_bf16 v[92:95], a[188:191], a[228:231], v[92:95]
buffer_load_dwordx4 v12, s[40:43], s64 offen lds
v_mfma_f32_16x16x32_bf16 v[124:127], a[188:191], a[236:239], 0
s_xor_b32 m0, s76, 132096
ds_read_b64_tr_b16 a[152:153], v197 offset:0
v_mfma_f32_16x16x32_bf16 v[124:127], a[184:187], a[232:235], v[124:127]
s_xor_b32 s64, s85, 8192
ds_read_b64_tr_b16 a[154:155], v197 offset:4096
v_mfma_f32_16x16x32_bf16 v[128:131], a[192:195], a[232:235], 0
buffer_load_dwordx4 v13, s[40:43], s64 offen lds
v_mfma_f32_16x16x32_bf16 v[128:131], a[196:199], a[236:239], v[128:131]
ds_read_b64_tr_b16 a[156:157], v197 offset:8192
v_mfma_f32_16x16x32_bf16 v[96:99], a[196:199], a[228:231], 0
s_xor_b32 m0, s76, 133120
ds_read_b64_tr_b16 a[158:159], v197 offset:12288
v_mfma_f32_16x16x32_bf16 v[96:99], a[192:195], a[224:227], v[96:99]
s_xor_b32 s64, s85, 16384
ds_read_b64_tr_b16 a[160:161], v198 offset:0
v_mfma_f32_16x16x32_bf16 v[64:67], a[192:195], a[216:219], 0
buffer_load_dwordx4 v12, s[40:43], s64 offen lds
v_mfma_f32_16x16x32_bf16 v[64:67], a[196:199], a[220:223], v[64:67]
ds_read_b64_tr_b16 a[162:163], v198 offset:4096
v_mfma_f32_16x16x32_bf16 v[32:35], a[196:199], a[212:215], 0
s_xor_b32 m0, s76, 134144
ds_read_b64_tr_b16 a[164:165], v198 offset:8192
v_mfma_f32_16x16x32_bf16 v[32:35], a[192:195], a[208:211], v[32:35]
s_xor_b32 s64, s85, 24576
ds_read_b64_tr_b16 a[166:167], v198 offset:12288
v_mfma_f32_16x16x32_bf16 v[36:39], a[200:203], a[208:211], 0
buffer_load_dwordx4 v13, s[40:43], s64 offen lds
v_mfma_f32_16x16x32_bf16 v[36:39], a[204:207], a[212:215], v[36:39]
v_mfma_f32_16x16x32_bf16 v[68:71], a[204:207], a[220:223], 0
s_xor_b32 m0, s76, 135168
v_mfma_f32_16x16x32_bf16 v[68:71], a[200:203], a[216:219], v[68:71]
s_xor_b32 s64, s85, 32768
v_mfma_f32_16x16x32_bf16 v[100:103], a[200:203], a[224:227], 0
buffer_load_dwordx4 v12, s[40:43], s64 offen lds
v_mfma_f32_16x16x32_bf16 v[100:103], a[204:207], a[228:231], v[100:103]
v_mfma_f32_16x16x32_bf16 v[132:135], a[204:207], a[236:239], 0
v_mfma_f32_16x16x32_bf16 v[132:135], a[200:203], a[232:235], v[132:135]
s_waitcnt lgkmcnt(0)
v_mfma_f32_16x16x32_bf16 v[136:139], a[144:147], v[176:179], v[136:139]
s_waitcnt vmcnt(5)
v_readfirstlane_b32 vcc_lo, v19
s_nop 0
s_cmp_lt_u32 vcc_lo, 8
s_cbranch_scc1 L_spin_2016
L_spinbk_2017:
s_sub_u32 s84, s84, 688128
s_add_u32 s84, s84, s69
v_mfma_f32_16x16x32_bf16 v[136:139], a[148:151], v[180:183], v[136:139]
s_xor_b32 m0, s76, 136192
s_xor_b32 s64, s85, 40960
ds_read_b64_tr_b16 a[168:169], v199 offset:0
v_mfma_f32_16x16x32_bf16 v[104:107], a[148:151], v[172:175], v[104:107]
buffer_load_dwordx4 v13, s[40:43], s64 offen lds
v_mfma_f32_16x16x32_bf16 v[104:107], a[144:147], v[168:171], v[104:107]
s_xor_b32 m0, s76, 137216
ds_read_b64_tr_b16 a[170:171], v199 offset:4096
v_mfma_f32_16x16x32_bf16 v[72:75], a[144:147], v[160:163], v[72:75]
s_xor_b32 s64, s85, 49152
ds_read_b64_tr_b16 a[172:173], v199 offset:8192
v_mfma_f32_16x16x32_bf16 v[72:75], a[148:151], v[164:167], v[72:75]
buffer_load_dwordx4 v12, s[40:43], s64 offen lds
v_mfma_f32_16x16x32_bf16 v[40:43], a[148:151], v[156:159], v[40:43]
s_xor_b32 m0, s76, 138240
ds_read_b64_tr_b16 a[174:175], v199 offset:12288
v_mfma_f32_16x16x32_bf16 v[40:43], a[144:147], v[152:155], v[40:43]
s_xor_b32 s64, s85, 57344
ds_read_b64_tr_b16 a[176:177], v192 offset:0
v_mfma_f32_16x16x32_bf16 v[44:47], a[152:155], v[152:155], v[44:47]
buffer_load_dwordx4 v13, s[40:43], s64 offen lds
v_mfma_f32_16x16x32_bf16 v[44:47], a[156:159], v[156:159], v[44:47]
ds_read_b64_tr_b16 a[178:179], v192 offset:4096
v_mfma_f32_16x16x32_bf16 v[76:79], a[156:159], v[164:167], v[76:79]
ds_read_b64_tr_b16 a[180:181], v192 offset:8192
v_mfma_f32_16x16x32_bf16 v[76:79], a[152:155], v[160:163], v[76:79]
s_xor_b32 s65, s84, 0
ds_read_b64_tr_b16 a[182:183], v192 offset:12288
v_mfma_f32_16x16x32_bf16 v[108:111], a[152:155], v[168:171], v[108:111]
buffer_load_dwordx4 a[208:211], v14, s[44:47], s65 offen offset:0 sc1
v_mfma_f32_16x16x32_bf16 v[108:111], a[156:159], v[172:175], v[108:111]
ds_read_b64_tr_b16 a[184:185], v193 offset:0
v_mfma_f32_16x16x32_bf16 v[140:143], a[156:159], v[180:183], v[140:143]
ds_read_b64_tr_b16 a[186:187], v193 offset:4096
v_mfma_f32_16x16x32_bf16 v[140:143], a[152:155], v[176:179], v[140:143]
buffer_load_dwordx4 a[216:219], v14, s[44:47], s65 offen offset:1024 sc1
v_mfma_f32_16x16x32_bf16 v[144:147], a[160:163], v[176:179], v[144:147]
ds_read_b64_tr_b16 a[188:189], v193 offset:8192
v_mfma_f32_16x16x32_bf16 v[144:147], a[164:167], v[180:183], v[144:147]
ds_read_b64_tr_b16 a[190:191], v193 offset:12288
v_mfma_f32_16x16x32_bf16 v[112:115], a[164:167], v[172:175], v[112:115]
buffer_load_dwordx4 a[224:227], v15, s[44:47], s65 offen offset:0 sc1
v_mfma_f32_16x16x32_bf16 v[112:115], a[160:163], v[168:171], v[112:115]
ds_read_b64_tr_b16 a[192:193], v194 offset:0
v_mfma_f32_16x16x32_bf16 v[80:83], a[160:163], v[160:163], v[80:83]
ds_read_b64_tr_b16 a[194:195], v194 offset:4096
v_mfma_f32_16x16x32_bf16 v[80:83], a[164:167], v[164:167], v[80:83]
ds_read_b64_tr_b16 a[196:197], v194 offset:8192
v_mfma_f32_16x16x32_bf16 v[48:51], a[164:167], v[156:159], v[48:51]
buffer_load_dwordx4 a[232:235], v15, s[44:47], s65 offen offset:1024 sc1
v_mfma_f32_16x16x32_bf16 v[48:51], a[160:163], v[152:155], v[48:51]
s_waitcnt lgkmcnt(5)
ds_read_b64_tr_b16 a[198:199], v194 offset:12288
v_mfma_f32_16x16x32_bf16 v[52:55], a[168:171], v[152:155], v[52:55]
s_xor_b32 s65, s84, 8192
v_mfma_f32_16x16x32_bf16 v[52:55], a[172:175], v[156:159], v[52:55]
buffer_load_dwordx4 a[212:215], v14, s[44:47], s65 offen offset:0 sc1
v_mfma_f32_16x16x32_bf16 v[84:87], a[172:175], v[164:167], v[84:87]
ds_read_b64_tr_b16 a[200:201], v195 offset:0
v_mfma_f32_16x16x32_bf16 v[84:87], a[168:171], v[160:163], v[84:87]
ds_read_b64_tr_b16 a[202:203], v195 offset:4096
v_mfma_f32_16x16x32_bf16 v[116:119], a[168:171], v[168:171], v[116:119]
s_lshl_b32 s66, s30, 30
buffer_load_dwordx4 a[220:223], v14, s[44:47], s65 offen offset:1024 sc1
v_mfma_f32_16x16x32_bf16 v[116:119], a[172:175], v[172:175], v[116:119]
ds_read_b64_tr_b16 a[204:205], v195 offset:8192
v_lshl_add_u32 v1, v0, 24, s66
v_mfma_f32_16x16x32_bf16 v[148:151], a[172:175], v[180:183], v[148:151]
ds_read_b64_tr_b16 a[206:207], v195 offset:12288
v_mfma_f32_16x16x32_bf16 v[148:151], a[168:171], v[176:179], v[148:151]
v_mfma_f32_16x16x32_bf16 v[120:123], a[176:179], v[176:179], v[120:123]
buffer_load_dwordx4 a[228:231], v15, s[44:47], s65 offen offset:0 sc1
v_mfma_f32_16x16x32_bf16 v[120:123], a[180:183], v[180:183], v[120:123]
v_mfma_f32_16x16x32_bf16 v[88:91], a[180:183], v[172:175], v[88:91]
v_mfma_f32_16x16x32_bf16 v[88:91], a[176:179], v[168:171], v[88:91]
buffer_load_dwordx4 a[236:239], v15, s[44:47], s65 offen offset:1024 sc1
v_mfma_f32_16x16x32_bf16 v[56:59], a[176:179], v[160:163], v[56:59]
v_mfma_f32_16x16x32_bf16 v[56:59], a[180:183], v[164:167], v[56:59]
v_mfma_f32_16x16x32_bf16 v[24:27], a[180:183], v[156:159], v[24:27]
v_mfma_f32_16x16x32_bf16 v[24:27], a[176:179], v[152:155], v[24:27]
v_mfma_f32_16x16x32_bf16 v[28:31], a[184:187], v[152:155], v[28:31]
s_waitcnt lgkmcnt(0)
s_barrier
v_mfma_f32_16x16x32_bf16 v[28:31], a[188:191], v[156:159], v[28:31]
s_mov_b64 exec, 1
buffer_atomic_add a251, v1, s[52:55], s71 offen offset:0 sc1
s_mov_b64 exec, -1
v_mfma_f32_16x16x32_bf16 v[60:63], a[188:191], v[164:167], v[60:63]
ds_read_b64_tr_b16 a[144:145], v188 offset:0
v_mfma_f32_16x16x32_bf16 v[60:63], a[184:187], v[160:163], v[60:63]
s_xor_b32 m0, s76, 32768
ds_read_b64_tr_b16 a[146:147], v188 offset:4096
v_mfma_f32_16x16x32_bf16 v[92:95], a[184:187], v[168:171], v[92:95]
s_xor_b32 s64, s85, 262144
ds_read_b64_tr_b16 a[148:149], v188 offset:8192
v_mfma_f32_16x16x32_bf16 v[92:95], a[188:191], v[172:175], v[92:95]
buffer_load_dwordx4 v12, s[40:43], s64 offen lds
v_mfma_f32_16x16x32_bf16 v[124:127], a[188:191], v[180:183], v[124:127]
s_xor_b32 m0, s76, 33792
ds_read_b64_tr_b16 a[150:151], v188 offset:12288
v_mfma_f32_16x16x32_bf16 v[124:127], a[184:187], v[176:179], v[124:127]
s_xor_b32 s64, s85, 270336
ds_read_b64_tr_b16 a[152:153], v189 offset:0
v_mfma_f32_16x16x32_bf16 v[128:131], a[192:195], v[176:179], v[128:131]
buffer_load_dwordx4 v13, s[40:43], s64 offen lds
v_mfma_f32_16x16x32_bf16 v[128:131], a[196:199], v[180:183], v[128:131]
ds_read_b64_tr_b16 a[154:155], v189 offset:4096
v_mfma_f32_16x16x32_bf16 v[96:99], a[196:199], v[172:175], v[96:99]
s_xor_b32 m0, s76, 34816
ds_read_b64_tr_b16 a[156:157], v189 offset:8192
v_mfma_f32_16x16x32_bf16 v[96:99], a[192:195], v[168:171], v[96:99]
s_xor_b32 s64, s85, 278528
ds_read_b64_tr_b16 a[158:159], v189 offset:12288
v_mfma_f32_16x16x32_bf16 v[64:67], a[192:195], v[160:163], v[64:67]
buffer_load_dwordx4 v12, s[40:43], s64 offen lds
v_mfma_f32_16x16x32_bf16 v[64:67], a[196:199], v[164:167], v[64:67]
ds_read_b64_tr_b16 a[160:161], v190 offset:0
v_mfma_f32_16x16x32_bf16 v[32:35], a[196:199], v[156:159], v[32:35]
s_xor_b32 m0, s76, 35840
ds_read_b64_tr_b16 a[162:163], v190 offset:4096
v_mfma_f32_16x16x32_bf16 v[32:35], a[192:195], v[152:155], v[32:35]
s_xor_b32 s64, s85, 286720
ds_read_b64_tr_b16 a[164:165], v190 offset:8192
v_mfma_f32_16x16x32_bf16 v[36:39], a[200:203], v[152:155], v[36:39]
buffer_load_dwordx4 v13, s[40:43], s64 offen lds
v_mfma_f32_16x16x32_bf16 v[36:39], a[204:207], v[156:159], v[36:39]
ds_read_b64_tr_b16 a[166:167], v190 offset:12288
v_mfma_f32_16x16x32_bf16 v[68:71], a[204:207], v[164:167], v[68:71]
s_xor_b32 m0, s76, 36864
v_mfma_f32_16x16x32_bf16 v[68:71], a[200:203], v[160:163], v[68:71]
s_xor_b32 s64, s85, 294912
v_mfma_f32_16x16x32_bf16 v[100:103], a[200:203], v[168:171], v[100:103]
buffer_load_dwordx4 v12, s[40:43], s64 offen lds
v_mfma_f32_16x16x32_bf16 v[100:103], a[204:207], v[172:175], v[100:103]
v_mfma_f32_16x16x32_bf16 v[132:135], a[204:207], v[180:183], v[132:135]
v_mfma_f32_16x16x32_bf16 v[132:135], a[200:203], v[176:179], v[132:135]
s_waitcnt lgkmcnt(1)
v_mfma_f32_16x16x32_bf16 v[136:139], a[144:147], a[56:59], v[136:139]
s_xor_b32 m0, s76, 37888
ds_read_b64_tr_b16 a[168:169], v191 offset:0
v_mfma_f32_16x16x32_bf16 v[136:139], a[148:151], a[60:63], v[136:139]
s_xor_b32 s64, s85, 303104
ds_read_b64_tr_b16 a[170:171], v191 offset:4096
v_mfma_f32_16x16x32_bf16 v[104:107], a[148:151], a[52:55], v[104:107]
buffer_load_dwordx4 v13, s[40:43], s64 offen lds
v_mfma_f32_16x16x32_bf16 v[104:107], a[144:147], a[48:51], v[104:107]
s_xor_b32 m0, s76, 38912
ds_read_b64_tr_b16 a[172:173], v191 offset:8192
v_mfma_f32_16x16x32_bf16 v[72:75], a[144:147], a[40:43], v[72:75]
s_xor_b32 s64, s85, 311296
ds_read_b64_tr_b16 a[174:175], v191 offset:12288
v_mfma_f32_16x16x32_bf16 v[72:75], a[148:151], a[44:47], v[72:75]
buffer_load_dwordx4 v12, s[40:43], s64 offen lds
v_mfma_f32_16x16x32_bf16 v[40:43], a[148:151], a[36:39], v[40:43]
s_xor_b32 m0, s76, 39936
ds_read_b64_tr_b16 a[176:177], v184 offset:0
v_mfma_f32_16x16x32_bf16 v[40:43], a[144:147], a[32:35], v[40:43]
s_xor_b32 s64, s85, 319488
ds_read_b64_tr_b16 a[178:179], v184 offset:4096
v_mfma_f32_16x16x32_bf16 v[44:47], a[152:155], a[32:35], v[44:47]
buffer_load_dwordx4 v13, s[40:43], s64 offen lds
v_mfma_f32_16x16x32_bf16 v[44:47], a[156:159], a[36:39], v[44:47]
ds_read_b64_tr_b16 a[180:181], v184 offset:8192
v_mfma_f32_16x16x32_bf16 v[76:79], a[156:159], a[44:47], v[76:79]
ds_read_b64_tr_b16 a[182:183], v184 offset:12288
v_mfma_f32_16x16x32_bf16 v[76:79], a[152:155], a[40:43], v[76:79]
s_xor_b32 s65, s84, 32768
ds_read_b64_tr_b16 a[184:185], v185 offset:0
v_mfma_f32_16x16x32_bf16 v[108:111], a[152:155], a[48:51], v[108:111]
buffer_load_dwordx4 v[152:155], v14, s[44:47], s65 offen offset:0 sc1
v_mfma_f32_16x16x32_bf16 v[108:111], a[156:159], a[52:55], v[108:111]
ds_read_b64_tr_b16 a[186:187], v185 offset:4096
v_mfma_f32_16x16x32_bf16 v[140:143], a[156:159], a[60:63], v[140:143]
ds_read_b64_tr_b16 a[188:189], v185 offset:8192
v_mfma_f32_16x16x32_bf16 v[140:143], a[152:155], a[56:59], v[140:143]
buffer_load_dwordx4 v[160:163], v14, s[44:47], s65 offen offset:1024 sc1
v_mfma_f32_16x16x32_bf16 v[144:147], a[160:163], a[56:59], v[144:147]
s_waitcnt lgkmcnt(5)
ds_read_b64_tr_b16 a[190:191], v185 offset:12288
v_mfma_f32_16x16x32_bf16 v[144:147], a[164:167], a[60:63], v[144:147]
v_mfma_f32_16x16x32_bf16 v[112:115], a[164:167], a[52:55], v[112:115]
buffer_load_dwordx4 v[168:171], v15, s[44:47], s65 offen offset:0 sc1
v_mfma_f32_16x16x32_bf16 v[112:115], a[160:163], a[48:51], v[112:115]
ds_read_b64_tr_b16 a[192:193], v186 offset:0
v_mfma_f32_16x16x32_bf16 v[80:83], a[160:163], a[40:43], v[80:83]
ds_read_b64_tr_b16 a[194:195], v186 offset:4096
v_mfma_f32_16x16x32_bf16 v[80:83], a[164:167], a[44:47], v[80:83]
ds_read_b64_tr_b16 a[196:197], v186 offset:8192
v_mfma_f32_16x16x32_bf16 v[48:51], a[164:167], a[36:39], v[48:51]
buffer_load_dwordx4 v[176:179], v15, s[44:47], s65 offen offset:1024 sc1
v_mfma_f32_16x16x32_bf16 v[48:51], a[160:163], a[32:35], v[48:51]
ds_read_b64_tr_b16 a[198:199], v186 offset:12288
v_mfma_f32_16x16x32_bf16 v[52:55], a[168:171], a[32:35], v[52:55]
s_xor_b32 s65, s84, 40960
v_mfma_f32_16x16x32_bf16 v[52:55], a[172:175], a[36:39], v[52:55]
buffer_load_dwordx4 v[156:159], v14, s[44:47], s65 offen offset:0 sc1
v_mfma_f32_16x16x32_bf16 v[84:87], a[172:175], a[44:47], v[84:87]
ds_read_b64_tr_b16 a[200:201], v187 offset:0
v_mfma_f32_16x16x32_bf16 v[84:87], a[168:171], a[40:43], v[84:87]
ds_read_b64_tr_b16 a[202:203], v187 offset:4096
v_mfma_f32_16x16x32_bf16 v[116:119], a[168:171], a[48:51], v[116:119]
buffer_load_dwordx4 v[164:167], v14, s[44:47], s65 offen offset:1024 sc1
v_mfma_f32_16x16x32_bf16 v[116:119], a[172:175], a[52:55], v[116:119]
ds_read_b64_tr_b16 a[204:205], v187 offset:8192
v_mfma_f32_16x16x32_bf16 v[148:151], a[172:175], a[60:63], v[148:151]
ds_read_b64_tr_b16 a[206:207], v187 offset:12288
v_mfma_f32_16x16x32_bf16 v[148:151], a[168:171], a[56:59], v[148:151]
v_mfma_f32_16x16x32_bf16 v[120:123], a[176:179], a[56:59], v[120:123]
s_waitcnt lgkmcnt(4)
buffer_load_dwordx4 v[172:175], v15, s[44:47], s65 offen offset:0 sc1
v_mfma_f32_16x16x32_bf16 v[120:123], a[180:183], a[60:63], v[120:123]
v_mfma_f32_16x16x32_bf16 v[88:91], a[180:183], a[52:55], v[88:91]
v_mfma_f32_16x16x32_bf16 v[88:91], a[176:179], a[48:51], v[88:91]
buffer_load_dwordx4 v[180:183], v15, s[44:47], s65 offen offset:1024 sc1
v_mfma_f32_16x16x32_bf16 v[56:59], a[176:179], a[40:43], v[56:59]
v_mfma_f32_16x16x32_bf16 v[56:59], a[180:183], a[44:47], v[56:59]
v_mfma_f32_16x16x32_bf16 v[24:27], a[180:183], a[36:39], v[24:27]
v_mfma_f32_16x16x32_bf16 v[24:27], a[176:179], a[32:35], v[24:27]
v_mfma_f32_16x16x32_bf16 v[28:31], a[184:187], a[32:35], v[28:31]
s_waitcnt vmcnt(25)
s_barrier
v_mfma_f32_16x16x32_bf16 v[28:31], a[188:191], a[36:39], v[28:31]
ds_read_b64_tr_b16 a[144:145], v188 offset:32768
v_mfma_f32_16x16x32_bf16 v[60:63], a[188:191], a[44:47], v[60:63]
ds_read_b64_tr_b16 a[146:147], v188 offset:36864
v_mfma_f32_16x16x32_bf16 v[60:63], a[184:187], a[40:43], v[60:63]
s_xor_b32 m0, s76, 65536
ds_read_b64_tr_b16 a[148:149], v188 offset:40960
v_mfma_f32_16x16x32_bf16 v[92:95], a[184:187], a[48:51], v[92:95]
s_xor_b32 s64, s85, 524288
ds_read_b64_tr_b16 a[150:151], v188 offset:45056
v_mfma_f32_16x16x32_bf16 v[92:95], a[188:191], a[52:55], v[92:95]
buffer_load_dwordx4 v12, s[40:43], s64 offen lds
v_mfma_f32_16x16x32_bf16 v[124:127], a[188:191], a[60:63], v[124:127]
s_xor_b32 m0, s76, 66560
ds_read_b64_tr_b16 a[152:153], v189 offset:32768
v_mfma_f32_16x16x32_bf16 v[124:127], a[184:187], a[56:59], v[124:127]
s_xor_b32 s64, s85, 532480
ds_read_b64_tr_b16 a[154:155], v189 offset:36864
v_mfma_f32_16x16x32_bf16 v[128:131], a[192:195], a[56:59], v[128:131]
buffer_load_dwordx4 v13, s[40:43], s64 offen lds
v_mfma_f32_16x16x32_bf16 v[128:131], a[196:199], a[60:63], v[128:131]
ds_read_b64_tr_b16 a[156:157], v189 offset:40960
v_mfma_f32_16x16x32_bf16 v[96:99], a[196:199], a[52:55], v[96:99]
s_xor_b32 m0, s76, 67584
ds_read_b64_tr_b16 a[158:159], v189 offset:45056
v_mfma_f32_16x16x32_bf16 v[96:99], a[192:195], a[48:51], v[96:99]
s_xor_b32 s64, s85, 540672
ds_read_b64_tr_b16 a[160:161], v190 offset:32768
v_mfma_f32_16x16x32_bf16 v[64:67], a[192:195], a[40:43], v[64:67]
buffer_load_dwordx4 v12, s[40:43], s64 offen lds
v_mfma_f32_16x16x32_bf16 v[64:67], a[196:199], a[44:47], v[64:67]
ds_read_b64_tr_b16 a[162:163], v190 offset:36864
v_mfma_f32_16x16x32_bf16 v[32:35], a[196:199], a[36:39], v[32:35]
s_xor_b32 m0, s76, 68608
ds_read_b64_tr_b16 a[164:165], v190 offset:40960
v_mfma_f32_16x16x32_bf16 v[32:35], a[192:195], a[32:35], v[32:35]
s_waitcnt lgkmcnt(5)
s_xor_b32 s64, s85, 548864
ds_read_b64_tr_b16 a[166:167], v190 offset:45056
v_mfma_f32_16x16x32_bf16 v[36:39], a[200:203], a[32:35], v[36:39]
buffer_load_dwordx4 v13, s[40:43], s64 offen lds
v_mfma_f32_16x16x32_bf16 v[36:39], a[204:207], a[36:39], v[36:39]
v_mfma_f32_16x16x32_bf16 v[68:71], a[204:207], a[44:47], v[68:71]
s_xor_b32 m0, s76, 69632
v_mfma_f32_16x16x32_bf16 v[68:71], a[200:203], a[40:43], v[68:71]
s_xor_b32 s64, s85, 557056
v_mfma_f32_16x16x32_bf16 v[100:103], a[200:203], a[48:51], v[100:103]
buffer_load_dwordx4 v12, s[40:43], s64 offen lds
v_mfma_f32_16x16x32_bf16 v[100:103], a[204:207], a[52:55], v[100:103]
s_mov_b32 s70, 3
s_mov_b32 s73, 2
v_mfma_f32_16x16x32_bf16 v[132:135], a[204:207], a[60:63], v[132:135]
v_mfma_f32_16x16x32_bf16 v[132:135], a[200:203], a[56:59], v[132:135]
s_branch L_p5join
.p2align 12
L_pg21:
s_branch L_pg25
L_p5join:
L_p5loop:
s_waitcnt lgkmcnt(10)
s_waitcnt vmcnt(19)
v_mfma_f32_16x16x32_bf16 v[136:139], a[144:147], a[232:235], v[136:139]
s_waitcnt vmcnt(15)
s_waitcnt lgkmcnt(8)
s_xor_b32 m0, s76, 70656
s_xor_b32 s64, s85, 565248
ds_read_b64_tr_b16 a[168:169], v191 offset:32768
v_mfma_f32_16x16x32_bf16 v[136:139], a[148:151], a[236:239], v[136:139]
buffer_load_dwordx4 v13, s[40:43], s64 offen lds
v_mfma_f32_16x16x32_bf16 v[104:107], a[148:151], a[228:231], v[104:107]
s_xor_b32 m0, s76, 71680
ds_read_b64_tr_b16 a[170:171], v191 offset:36864
v_mfma_f32_16x16x32_bf16 v[104:107], a[144:147], a[224:227], v[104:107]
s_xor_b32 s64, s85, 573440
ds_read_b64_tr_b16 a[172:173], v191 offset:40960
v_mfma_f32_16x16x32_bf16 v[72:75], a[144:147], a[216:219], v[72:75]
buffer_load_dwordx4 v12, s[40:43], s64 offen lds
v_mfma_f32_16x16x32_bf16 v[72:75], a[148:151], a[220:223], v[72:75]
s_xor_b32 m0, s76, 72704
ds_read_b64_tr_b16 a[174:175], v191 offset:45056
v_mfma_f32_16x16x32_bf16 v[40:43], a[148:151], a[212:215], v[40:43]
s_xor_b32 s64, s85, 581632
ds_read_b64_tr_b16 a[176:177], v184 offset:32768
v_mfma_f32_16x16x32_bf16 v[40:43], a[144:147], a[208:211], v[40:43]
s_waitcnt lgkmcnt(5)
buffer_load_dwordx4 v13, s[40:43], s64 offen lds
v_mfma_f32_16x16x32_bf16 v[44:47], a[152:155], a[208:211], v[44:47]
ds_read_b64_tr_b16 a[178:179], v184 offset:36864
v_mfma_f32_16x16x32_bf16 v[44:47], a[156:159], a[212:215], v[44:47]
ds_read_b64_tr_b16 a[180:181], v184 offset:40960
v_mfma_f32_16x16x32_bf16 v[76:79], a[156:159], a[220:223], v[76:79]
s_xor_b32 s65, s84, 65536
ds_read_b64_tr_b16 a[182:183], v184 offset:45056
v_mfma_f32_16x16x32_bf16 v[76:79], a[152:155], a[216:219], v[76:79]
buffer_load_dwordx4 a[0:3], v14, s[44:47], s65 offen offset:0 sc1
v_mfma_f32_16x16x32_bf16 v[108:111], a[152:155], a[224:227], v[108:111]
ds_read_b64_tr_b16 a[184:185], v185 offset:32768
v_mfma_f32_16x16x32_bf16 v[108:111], a[156:159], a[228:231], v[108:111]
ds_read_b64_tr_b16 a[186:187], v185 offset:36864
v_mfma_f32_16x16x32_bf16 v[140:143], a[156:159], a[236:239], v[140:143]
buffer_load_dwordx4 a[8:11], v14, s[44:47], s65 offen offset:1024 sc1
v_mfma_f32_16x16x32_bf16 v[140:143], a[152:155], a[232:235], v[140:143]
ds_read_b64_tr_b16 a[188:189], v185 offset:40960
v_mfma_f32_16x16x32_bf16 v[144:147], a[160:163], a[232:235], v[144:147]
ds_read_b64_tr_b16 a[190:191], v185 offset:45056
v_mfma_f32_16x16x32_bf16 v[144:147], a[164:167], a[236:239], v[144:147]
v_mfma_f32_16x16x32_bf16 v[112:115], a[164:167], a[228:231], v[112:115]
buffer_load_dwordx4 a[16:19], v15, s[44:47], s65 offen offset:0 sc1
v_mfma_f32_16x16x32_bf16 v[112:115], a[160:163], a[224:227], v[112:115]
ds_read_b64_tr_b16 a[192:193], v186 offset:32768
v_mfma_f32_16x16x32_bf16 v[80:83], a[160:163], a[216:219], v[80:83]
ds_read_b64_tr_b16 a[194:195], v186 offset:36864
v_mfma_f32_16x16x32_bf16 v[80:83], a[164:167], a[220:223], v[80:83]
buffer_load_dwordx4 a[24:27], v15, s[44:47], s65 offen offset:1024 sc1
v_mfma_f32_16x16x32_bf16 v[48:51], a[164:167], a[212:215], v[48:51]
ds_read_b64_tr_b16 a[196:197], v186 offset:40960
v_mfma_f32_16x16x32_bf16 v[48:51], a[160:163], a[208:211], v[48:51]
s_waitcnt lgkmcnt(4)
ds_read_b64_tr_b16 a[198:199], v186 offset:45056
v_mfma_f32_16x16x32_bf16 v[52:55], a[168:171], a[208:211], v[52:55]
s_xor_b32 s65, s84, 73728
v_mfma_f32_16x16x32_bf16 v[52:55], a[172:175], a[212:215], v[52:55]
buffer_load_dwordx4 a[4:7], v14, s[44:47], s65 offen offset:0 sc1
v_mfma_f32_16x16x32_bf16 v[84:87], a[172:175], a[220:223], v[84:87]
ds_read_b64_tr_b16 a[200:201], v187 offset:32768
v_mfma_f32_16x16x32_bf16 v[84:87], a[168:171], a[216:219], v[84:87]
ds_read_b64_tr_b16 a[202:203], v187 offset:36864
v_mfma_f32_16x16x32_bf16 v[116:119], a[168:171], a[224:227], v[116:119]
buffer_load_dwordx4 a[12:15], v14, s[44:47], s65 offen offset:1024 sc1
v_mfma_f32_16x16x32_bf16 v[116:119], a[172:175], a[228:231], v[116:119]
ds_read_b64_tr_b16 a[204:205], v187 offset:40960
v_mfma_f32_16x16x32_bf16 v[148:151], a[172:175], a[236:239], v[148:151]
ds_read_b64_tr_b16 a[206:207], v187 offset:45056
v_mfma_f32_16x16x32_bf16 v[148:151], a[168:171], a[232:235], v[148:151]
v_mfma_f32_16x16x32_bf16 v[120:123], a[176:179], a[232:235], v[120:123]
buffer_load_dwordx4 a[20:23], v15, s[44:47], s65 offen offset:0 sc1
v_mfma_f32_16x16x32_bf16 v[120:123], a[180:183], a[236:239], v[120:123]
v_mfma_f32_16x16x32_bf16 v[88:91], a[180:183], a[228:231], v[88:91]
v_mfma_f32_16x16x32_bf16 v[88:91], a[176:179], a[224:227], v[88:91]
buffer_load_dwordx4 a[28:31], v15, s[44:47], s65 offen offset:1024 sc1
v_mfma_f32_16x16x32_bf16 v[56:59], a[176:179], a[216:219], v[56:59]
v_mfma_f32_16x16x32_bf16 v[56:59], a[180:183], a[220:223], v[56:59]
v_mfma_f32_16x16x32_bf16 v[24:27], a[180:183], a[212:215], v[24:27]
v_mfma_f32_16x16x32_bf16 v[24:27], a[176:179], a[208:211], v[24:27]
v_mfma_f32_16x16x32_bf16 v[28:31], a[184:187], a[208:211], v[28:31]
s_waitcnt vmcnt(24)
s_barrier
s_waitcnt lgkmcnt(0)
v_mfma_f32_16x16x32_bf16 v[28:31], a[188:191], a[212:215], v[28:31]
s_xor_b32 m0, s76, 98304
ds_read_b64_tr_b16 a[144:145], v196 offset:0
v_mfma_f32_16x16x32_bf16 v[60:63], a[188:191], a[220:223], v[60:63]
s_xor_b32 s64, s85, 786432
ds_read_b64_tr_b16 a[146:147], v196 offset:4096
v_mfma_f32_16x16x32_bf16 v[60:63], a[184:187], a[216:219], v[60:63]
buffer_load_dwordx4 v12, s[40:43], s64 offen lds
v_mfma_f32_16x16x32_bf16 v[92:95], a[184:187], a[224:227], v[92:95]
ds_read_b64_tr_b16 a[148:149], v196 offset:8192
v_mfma_f32_16x16x32_bf16 v[92:95], a[188:191], a[228:231], v[92:95]
s_xor_b32 m0, s76, 99328
ds_read_b64_tr_b16 a[150:151], v196 offset:12288
v_mfma_f32_16x16x32_bf16 v[124:127], a[188:191], a[236:239], v[124:127]
s_xor_b32 s64, s85, 794624
ds_read_b64_tr_b16 a[152:153], v197 offset:0
v_mfma_f32_16x16x32_bf16 v[124:127], a[184:187], a[232:235], v[124:127]
buffer_load_dwordx4 v13, s[40:43], s64 offen lds
v_mfma_f32_16x16x32_bf16 v[128:131], a[192:195], a[232:235], v[128:131]
ds_read_b64_tr_b16 a[154:155], v197 offset:4096
v_mfma_f32_16x16x32_bf16 v[128:131], a[196:199], a[236:239], v[128:131]
s_xor_b32 m0, s76, 100352
ds_read_b64_tr_b16 a[156:157], v197 offset:8192
v_mfma_f32_16x16x32_bf16 v[96:99], a[196:199], a[228:231], v[96:99]
s_xor_b32 s64, s85, 802816
ds_read_b64_tr_b16 a[158:159], v197 offset:12288
v_mfma_f32_16x16x32_bf16 v[96:99], a[192:195], a[224:227], v[96:99]
buffer_load_dwordx4 v12, s[40:43], s64 offen lds
v_mfma_f32_16x16x32_bf16 v[64:67], a[192:195], a[216:219], v[64:67]
ds_read_b64_tr_b16 a[160:161], v198 offset:0
v_mfma_f32_16x16x32_bf16 v[64:67], a[196:199], a[220:223], v[64:67]
s_xor_b32 m0, s76, 101376
ds_read_b64_tr_b16 a[162:163], v198 offset:4096
v_mfma_f32_16x16x32_bf16 v[32:35], a[196:199], a[212:215], v[32:35]
s_xor_b32 s64, s85, 811008
ds_read_b64_tr_b16 a[164:165], v198 offset:8192
v_mfma_f32_16x16x32_bf16 v[32:35], a[192:195], a[208:211], v[32:35]
buffer_load_dwordx4 v13, s[40:43], s64 offen lds
v_mfma_f32_16x16x32_bf16 v[36:39], a[200:203], a[208:211], v[36:39]
ds_read_b64_tr_b16 a[166:167], v198 offset:12288
v_mfma_f32_16x16x32_bf16 v[36:39], a[204:207], a[212:215], v[36:39]
s_xor_b32 m0, s76, 102400
v_mfma_f32_16x16x32_bf16 v[68:71], a[204:207], a[220:223], v[68:71]
s_xor_b32 s64, s85, 819200
v_mfma_f32_16x16x32_bf16 v[68:71], a[200:203], a[216:219], v[68:71]
buffer_load_dwordx4 v12, s[40:43], s64 offen lds
v_mfma_f32_16x16x32_bf16 v[100:103], a[200:203], a[224:227], v[100:103]
v_mfma_f32_16x16x32_bf16 v[100:103], a[204:207], a[228:231], v[100:103]
v_mfma_f32_16x16x32_bf16 v[132:135], a[204:207], a[236:239], v[132:135]
v_mfma_f32_16x16x32_bf16 v[132:135], a[200:203], a[232:235], v[132:135]
s_waitcnt vmcnt(25)
s_waitcnt lgkmcnt(1)
s_xor_b32 m0, s76, 103424
buffer_load_dword v19, off, s[52:55], s72 offset:128 sc1
v_mfma_f32_16x16x32_bf16 v[136:139], a[144:147], v[176:179], v[136:139]
s_waitcnt vmcnt(22)
s_xor_b32 s64, s85, 827392
ds_read_b64_tr_b16 a[168:169], v199 offset:0
v_mfma_f32_16x16x32_bf16 v[136:139], a[148:151], v[180:183], v[136:139]
buffer_load_dwordx4 v13, s[40:43], s64 offen lds
v_mfma_f32_16x16x32_bf16 v[104:107], a[148:151], v[172:175], v[104:107]
s_xor_b32 m0, s76, 104448
ds_read_b64_tr_b16 a[170:171], v199 offset:4096
v_mfma_f32_16x16x32_bf16 v[104:107], a[144:147], v[168:171], v[104:107]
s_xor_b32 s64, s85, 835584
ds_read_b64_tr_b16 a[172:173], v199 offset:8192
v_mfma_f32_16x16x32_bf16 v[72:75], a[144:147], v[160:163], v[72:75]
buffer_load_dwordx4 v12, s[40:43], s64 offen lds
v_mfma_f32_16x16x32_bf16 v[72:75], a[148:151], v[164:167], v[72:75]
s_xor_b32 m0, s76, 105472
ds_read_b64_tr_b16 a[174:175], v199 offset:12288
v_mfma_f32_16x16x32_bf16 v[40:43], a[148:151], v[156:159], v[40:43]
s_xor_b32 s64, s85, 843776
ds_read_b64_tr_b16 a[176:177], v192 offset:0
v_mfma_f32_16x16x32_bf16 v[40:43], a[144:147], v[152:155], v[40:43]
buffer_load_dwordx4 v13, s[40:43], s64 offen lds
v_mfma_f32_16x16x32_bf16 v[44:47], a[152:155], v[152:155], v[44:47]
ds_read_b64_tr_b16 a[178:179], v192 offset:4096
v_mfma_f32_16x16x32_bf16 v[44:47], a[156:159], v[156:159], v[44:47]
ds_read_b64_tr_b16 a[180:181], v192 offset:8192
v_mfma_f32_16x16x32_bf16 v[76:79], a[156:159], v[164:167], v[76:79]
s_xor_b32 s65, s84, 98304
ds_read_b64_tr_b16 a[182:183], v192 offset:12288
v_mfma_f32_16x16x32_bf16 v[76:79], a[152:155], v[160:163], v[76:79]
buffer_load_dwordx4 a[32:35], v14, s[44:47], s65 offen offset:0 sc1
v_mfma_f32_16x16x32_bf16 v[108:111], a[152:155], v[168:171], v[108:111]
ds_read_b64_tr_b16 a[184:185], v193 offset:0
v_mfma_f32_16x16x32_bf16 v[108:111], a[156:159], v[172:175], v[108:111]
ds_read_b64_tr_b16 a[186:187], v193 offset:4096
v_mfma_f32_16x16x32_bf16 v[140:143], a[156:159], v[180:183], v[140:143]
buffer_load_dwordx4 a[40:43], v14, s[44:47], s65 offen offset:1024 sc1
v_mfma_f32_16x16x32_bf16 v[140:143], a[152:155], v[176:179], v[140:143]
ds_read_b64_tr_b16 a[188:189], v193 offset:8192
v_mfma_f32_16x16x32_bf16 v[144:147], a[160:163], v[176:179], v[144:147]
s_waitcnt lgkmcnt(5)
s_lshl_b32 s75, s73, 20
s_add_u32 s85, s85, s75
ds_read_b64_tr_b16 a[190:191], v193 offset:12288
v_mfma_f32_16x16x32_bf16 v[144:147], a[164:167], v[180:183], v[144:147]
s_lshr_b32 s74, s73, 28
s_and_b32 s74, s74, 8
v_mfma_f32_16x16x32_bf16 v[112:115], a[164:167], v[172:175], v[112:115]
buffer_load_dwordx4 a[48:51], v15, s[44:47], s65 offen offset:0 sc1
v_mfma_f32_16x16x32_bf16 v[112:115], a[160:163], v[168:171], v[112:115]
ds_read_b64_tr_b16 a[192:193], v194 offset:0
v_mfma_f32_16x16x32_bf16 v[80:83], a[160:163], v[160:163], v[80:83]
ds_read_b64_tr_b16 a[194:195], v194 offset:4096
v_mfma_f32_16x16x32_bf16 v[80:83], a[164:167], v[164:167], v[80:83]
buffer_load_dwordx4 a[56:59], v15, s[44:47], s65 offen offset:1024 sc1
v_mfma_f32_16x16x32_bf16 v[48:51], a[164:167], v[156:159], v[48:51]
ds_read_b64_tr_b16 a[196:197], v194 offset:8192
v_mfma_f32_16x16x32_bf16 v[48:51], a[160:163], v[152:155], v[48:51]
ds_read_b64_tr_b16 a[198:199], v194 offset:12288
v_mfma_f32_16x16x32_bf16 v[52:55], a[168:171], v[152:155], v[52:55]
s_xor_b32 s65, s84, 106496
v_mfma_f32_16x16x32_bf16 v[52:55], a[172:175], v[156:159], v[52:55]
buffer_load_dwordx4 a[36:39], v14, s[44:47], s65 offen offset:0 sc1
v_mfma_f32_16x16x32_bf16 v[84:87], a[172:175], v[164:167], v[84:87]
ds_read_b64_tr_b16 a[200:201], v195 offset:0
v_mfma_f32_16x16x32_bf16 v[84:87], a[168:171], v[160:163], v[84:87]
ds_read_b64_tr_b16 a[202:203], v195 offset:4096
v_mfma_f32_16x16x32_bf16 v[116:119], a[168:171], v[168:171], v[116:119]
buffer_load_dwordx4 a[44:47], v14, s[44:47], s65 offen offset:1024 sc1
v_mfma_f32_16x16x32_bf16 v[116:119], a[172:175], v[172:175], v[116:119]
ds_read_b64_tr_b16 a[204:205], v195 offset:8192
v_mfma_f32_16x16x32_bf16 v[148:151], a[172:175], v[180:183], v[148:151]
ds_read_b64_tr_b16 a[206:207], v195 offset:12288
v_mfma_f32_16x16x32_bf16 v[148:151], a[168:171], v[176:179], v[148:151]
v_mfma_f32_16x16x32_bf16 v[120:123], a[176:179], v[176:179], v[120:123]
s_waitcnt lgkmcnt(4)
buffer_load_dwordx4 a[52:55], v15, s[44:47], s65 offen offset:0 sc1
v_mfma_f32_16x16x32_bf16 v[120:123], a[180:183], v[180:183], v[120:123]
v_mfma_f32_16x16x32_bf16 v[88:91], a[180:183], v[172:175], v[88:91]
v_mfma_f32_16x16x32_bf16 v[88:91], a[176:179], v[168:171], v[88:91]
buffer_load_dwordx4 a[60:63], v15, s[44:47], s65 offen offset:1024 sc1
v_mfma_f32_16x16x32_bf16 v[56:59], a[176:179], v[160:163], v[56:59]
v_mfma_f32_16x16x32_bf16 v[56:59], a[180:183], v[164:167], v[56:59]
v_mfma_f32_16x16x32_bf16 v[24:27], a[180:183], v[156:159], v[24:27]
v_mfma_f32_16x16x32_bf16 v[24:27], a[176:179], v[152:155], v[24:27]
v_mfma_f32_16x16x32_bf16 v[28:31], a[184:187], v[152:155], v[28:31]
s_waitcnt vmcnt(25)
s_barrier
v_mfma_f32_16x16x32_bf16 v[28:31], a[188:191], v[156:159], v[28:31]
s_xor_b32 m0, s76, 131072
ds_read_b64_tr_b16 a[144:145], v196 offset:32768
v_mfma_f32_16x16x32_bf16 v[60:63], a[188:191], v[164:167], v[60:63]
s_xor_b32 s64, s85, 0
ds_read_b64_tr_b16 a[146:147], v196 offset:36864
v_mfma_f32_16x16x32_bf16 v[60:63], a[184:187], v[160:163], v[60:63]
buffer_load_dwordx4 v12, s[40:43], s64 offen lds
v_mfma_f32_16x16x32_bf16 v[92:95], a[184:187], v[168:171], v[92:95]
s_lshl_b32 s75, s73, 17
s_add_u32 s84, s84, s75
ds_read_b64_tr_b16 a[148:149], v196 offset:40960
v_mfma_f32_16x16x32_bf16 v[92:95], a[188:191], v[172:175], v[92:95]
s_xor_b32 m0, s76, 132096
ds_read_b64_tr_b16 a[150:151], v196 offset:45056
v_mfma_f32_16x16x32_bf16 v[124:127], a[188:191], v[180:183], v[124:127]
s_xor_b32 s64, s85, 8192
ds_read_b64_tr_b16 a[152:153], v197 offset:32768
v_mfma_f32_16x16x32_bf16 v[124:127], a[184:187], v[176:179], v[124:127]
buffer_load_dwordx4 v13, s[40:43], s64 offen lds
v_mfma_f32_16x16x32_bf16 v[128:131], a[192:195], v[176:179], v[128:131]
ds_read_b64_tr_b16 a[154:155], v197 offset:36864
v_mfma_f32_16x16x32_bf16 v[128:131], a[196:199], v[180:183], v[128:131]
s_xor_b32 m0, s76, 133120
ds_read_b64_tr_b16 a[156:157], v197 offset:40960
v_mfma_f32_16x16x32_bf16 v[96:99], a[196:199], v[172:175], v[96:99]
s_xor_b32 s64, s85, 16384
ds_read_b64_tr_b16 a[158:159], v197 offset:45056
v_mfma_f32_16x16x32_bf16 v[96:99], a[192:195], v[168:171], v[96:99]
buffer_load_dwordx4 v12, s[40:43], s64 offen lds
v_mfma_f32_16x16x32_bf16 v[64:67], a[192:195], v[160:163], v[64:67]
ds_read_b64_tr_b16 a[160:161], v198 offset:32768
v_mfma_f32_16x16x32_bf16 v[64:67], a[196:199], v[164:167], v[64:67]
s_xor_b32 m0, s76, 134144
ds_read_b64_tr_b16 a[162:163], v198 offset:36864
v_mfma_f32_16x16x32_bf16 v[32:35], a[196:199], v[156:159], v[32:35]
s_xor_b32 s64, s85, 24576
ds_read_b64_tr_b16 a[164:165], v198 offset:40960
v_mfma_f32_16x16x32_bf16 v[32:35], a[192:195], v[152:155], v[32:35]
s_waitcnt lgkmcnt(6)
buffer_load_dwordx4 v13, s[40:43], s64 offen lds
v_mfma_f32_16x16x32_bf16 v[36:39], a[200:203], v[152:155], v[36:39]
ds_read_b64_tr_b16 a[166:167], v198 offset:45056
v_mfma_f32_16x16x32_bf16 v[36:39], a[204:207], v[156:159], v[36:39]
s_xor_b32 m0, s76, 135168
v_mfma_f32_16x16x32_bf16 v[68:71], a[204:207], v[164:167], v[68:71]
s_xor_b32 s64, s85, 32768
v_mfma_f32_16x16x32_bf16 v[68:71], a[200:203], v[160:163], v[68:71]
buffer_load_dwordx4 v12, s[40:43], s64 offen lds
v_mfma_f32_16x16x32_bf16 v[100:103], a[200:203], v[168:171], v[100:103]
v_mfma_f32_16x16x32_bf16 v[100:103], a[204:207], v[172:175], v[100:103]
v_mfma_f32_16x16x32_bf16 v[132:135], a[204:207], v[180:183], v[132:135]
v_mfma_f32_16x16x32_bf16 v[132:135], a[200:203], v[176:179], v[132:135]
s_waitcnt vmcnt(26)
v_mfma_f32_16x16x32_bf16 v[136:139], a[144:147], a[24:27], v[136:139]
s_waitcnt vmcnt(16)
v_readfirstlane_b32 vcc_lo, v19
s_nop 0
s_cmp_lt_u32 vcc_lo, s74
s_cbranch_scc1 L_spin_4022
L_spinbk_4023:
v_mfma_f32_16x16x32_bf16 v[136:139], a[148:151], a[28:31], v[136:139]
s_xor_b32 m0, s76, 136192
ds_read_b64_tr_b16 a[168:169], v199 offset:32768
v_mfma_f32_16x16x32_bf16 v[104:107], a[148:151], a[20:23], v[104:107]
s_xor_b32 s64, s85, 40960
ds_read_b64_tr_b16 a[170:171], v199 offset:36864
v_mfma_f32_16x16x32_bf16 v[104:107], a[144:147], a[16:19], v[104:107]
buffer_load_dwordx4 v13, s[40:43], s64 offen lds
v_mfma_f32_16x16x32_bf16 v[72:75], a[144:147], a[8:11], v[72:75]
s_xor_b32 m0, s76, 137216
ds_read_b64_tr_b16 a[172:173], v199 offset:40960
v_mfma_f32_16x16x32_bf16 v[72:75], a[148:151], a[12:15], v[72:75]
s_xor_b32 s64, s85, 49152
ds_read_b64_tr_b16 a[174:175], v199 offset:45056
v_mfma_f32_16x16x32_bf16 v[40:43], a[148:151], a[4:7], v[40:43]
buffer_load_dwordx4 v12, s[40:43], s64 offen lds
v_mfma_f32_16x16x32_bf16 v[40:43], a[144:147], a[0:3], v[40:43]
s_waitcnt lgkmcnt(4)
s_xor_b32 m0, s76, 138240
ds_read_b64_tr_b16 a[176:177], v192 offset:32768
v_mfma_f32_16x16x32_bf16 v[44:47], a[152:155], a[0:3], v[44:47]
s_xor_b32 s64, s85, 57344
ds_read_b64_tr_b16 a[178:179], v192 offset:36864
v_mfma_f32_16x16x32_bf16 v[44:47], a[156:159], a[4:7], v[44:47]
buffer_load_dwordx4 v13, s[40:43], s64 offen lds
v_mfma_f32_16x16x32_bf16 v[76:79], a[156:159], a[12:15], v[76:79]
ds_read_b64_tr_b16 a[180:181], v192 offset:40960
v_mfma_f32_16x16x32_bf16 v[76:79], a[152:155], a[8:11], v[76:79]
s_xor_b32 s65, s84, 0
ds_read_b64_tr_b16 a[182:183], v192 offset:45056
v_mfma_f32_16x16x32_bf16 v[108:111], a[152:155], a[16:19], v[108:111]
buffer_load_dwordx4 a[208:211], v14, s[44:47], s65 offen offset:0 sc1
v_mfma_f32_16x16x32_bf16 v[108:111], a[156:159], a[20:23], v[108:111]
ds_read_b64_tr_b16 a[184:185], v193 offset:32768
v_mfma_f32_16x16x32_bf16 v[140:143], a[156:159], a[28:31], v[140:143]
ds_read_b64_tr_b16 a[186:187], v193 offset:36864
v_mfma_f32_16x16x32_bf16 v[140:143], a[152:155], a[24:27], v[140:143]
ds_read_b64_tr_b16 a[188:189], v193 offset:40960
v_mfma_f32_16x16x32_bf16 v[144:147], a[160:163], a[24:27], v[144:147]
buffer_load_dwordx4 a[216:219], v14, s[44:47], s65 offen offset:1024 sc1
v_mfma_f32_16x16x32_bf16 v[144:147], a[164:167], a[28:31], v[144:147]
ds_read_b64_tr_b16 a[190:191], v193 offset:45056
v_mfma_f32_16x16x32_bf16 v[112:115], a[164:167], a[20:23], v[112:115]
ds_read_b64_tr_b16 a[192:193], v194 offset:32768
v_mfma_f32_16x16x32_bf16 v[112:115], a[160:163], a[16:19], v[112:115]
buffer_load_dwordx4 a[224:227], v15, s[44:47], s65 offen offset:0 sc1
v_mfma_f32_16x16x32_bf16 v[80:83], a[160:163], a[8:11], v[80:83]
ds_read_b64_tr_b16 a[194:195], v194 offset:36864
v_mfma_f32_16x16x32_bf16 v[80:83], a[164:167], a[12:15], v[80:83]
ds_read_b64_tr_b16 a[196:197], v194 offset:40960
v_mfma_f32_16x16x32_bf16 v[48:51], a[164:167], a[4:7], v[48:51]
buffer_load_dwordx4 a[232:235], v15, s[44:47], s65 offen offset:1024 sc1
v_mfma_f32_16x16x32_bf16 v[48:51], a[160:163], a[0:3], v[48:51]
s_waitcnt lgkmcnt(4)
ds_read_b64_tr_b16 a[198:199], v194 offset:45056
v_mfma_f32_16x16x32_bf16 v[52:55], a[168:171], a[0:3], v[52:55]
s_xor_b32 s65, s84, 8192
v_mfma_f32_16x16x32_bf16 v[52:55], a[172:175], a[4:7], v[52:55]
buffer_load_dwordx4 a[212:215], v14, s[44:47], s65 offen offset:0 sc1
v_mfma_f32_16x16x32_bf16 v[84:87], a[172:175], a[12:15], v[84:87]
ds_read_b64_tr_b16 a[200:201], v195 offset:32768
v_mfma_f32_16x16x32_bf16 v[84:87], a[168:171], a[8:11], v[84:87]
ds_read_b64_tr_b16 a[202:203], v195 offset:36864
v_mfma_f32_16x16x32_bf16 v[116:119], a[168:171], a[16:19], v[116:119]
ds_read_b64_tr_b16 a[204:205], v195 offset:40960
v_mfma_f32_16x16x32_bf16 v[116:119], a[172:175], a[20:23], v[116:119]
buffer_load_dwordx4 a[220:223], v14, s[44:47], s65 offen offset:1024 sc1
v_mfma_f32_16x16x32_bf16 v[148:151], a[172:175], a[28:31], v[148:151]
ds_read_b64_tr_b16 a[206:207], v195 offset:45056
v_mfma_f32_16x16x32_bf16 v[148:151], a[168:171], a[24:27], v[148:151]
v_mfma_f32_16x16x32_bf16 v[120:123], a[176:179], a[24:27], v[120:123]
buffer_load_dwordx4 a[228:231], v15, s[44:47], s65 offen offset:0 sc1
v_mfma_f32_16x16x32_bf16 v[120:123], a[180:183], a[28:31], v[120:123]
v_mfma_f32_16x16x32_bf16 v[88:91], a[180:183], a[20:23], v[88:91]
v_mfma_f32_16x16x32_bf16 v[88:91], a[176:179], a[16:19], v[88:91]
buffer_load_dwordx4 a[236:239], v15, s[44:47], s65 offen offset:1024 sc1
v_mfma_f32_16x16x32_bf16 v[56:59], a[176:179], a[8:11], v[56:59]
v_mfma_f32_16x16x32_bf16 v[56:59], a[180:183], a[12:15], v[56:59]
v_mfma_f32_16x16x32_bf16 v[24:27], a[180:183], a[4:7], v[24:27]
v_mfma_f32_16x16x32_bf16 v[24:27], a[176:179], a[0:3], v[24:27]
v_mfma_f32_16x16x32_bf16 v[28:31], a[184:187], a[0:3], v[28:31]
s_waitcnt vmcnt(24)
s_barrier
s_waitcnt lgkmcnt(0)
v_mfma_f32_16x16x32_bf16 v[28:31], a[188:191], a[4:7], v[28:31]
s_xor_b32 m0, s76, 32768
ds_read_b64_tr_b16 a[144:145], v188 offset:0
v_mfma_f32_16x16x32_bf16 v[60:63], a[188:191], a[12:15], v[60:63]
s_xor_b32 s64, s85, 262144
ds_read_b64_tr_b16 a[146:147], v188 offset:4096
v_mfma_f32_16x16x32_bf16 v[60:63], a[184:187], a[8:11], v[60:63]
buffer_load_dwordx4 v12, s[40:43], s64 offen lds
v_mfma_f32_16x16x32_bf16 v[92:95], a[184:187], a[16:19], v[92:95]
ds_read_b64_tr_b16 a[148:149], v188 offset:8192
v_mfma_f32_16x16x32_bf16 v[92:95], a[188:191], a[20:23], v[92:95]
s_xor_b32 m0, s76, 33792
ds_read_b64_tr_b16 a[150:151], v188 offset:12288
v_mfma_f32_16x16x32_bf16 v[124:127], a[188:191], a[28:31], v[124:127]
s_xor_b32 s64, s85, 270336
ds_read_b64_tr_b16 a[152:153], v189 offset:0
v_mfma_f32_16x16x32_bf16 v[124:127], a[184:187], a[24:27], v[124:127]
buffer_load_dwordx4 v13, s[40:43], s64 offen lds
v_mfma_f32_16x16x32_bf16 v[128:131], a[192:195], a[24:27], v[128:131]
ds_read_b64_tr_b16 a[154:155], v189 offset:4096
v_mfma_f32_16x16x32_bf16 v[128:131], a[196:199], a[28:31], v[128:131]
s_xor_b32 m0, s76, 34816
ds_read_b64_tr_b16 a[156:157], v189 offset:8192
v_mfma_f32_16x16x32_bf16 v[96:99], a[196:199], a[20:23], v[96:99]
s_xor_b32 s64, s85, 278528
ds_read_b64_tr_b16 a[158:159], v189 offset:12288
v_mfma_f32_16x16x32_bf16 v[96:99], a[192:195], a[16:19], v[96:99]
buffer_load_dwordx4 v12, s[40:43], s64 offen lds
v_mfma_f32_16x16x32_bf16 v[64:67], a[192:195], a[8:11], v[64:67]
ds_read_b64_tr_b16 a[160:161], v190 offset:0
v_mfma_f32_16x16x32_bf16 v[64:67], a[196:199], a[12:15], v[64:67]
s_xor_b32 m0, s76, 35840
ds_read_b64_tr_b16 a[162:163], v190 offset:4096
v_mfma_f32_16x16x32_bf16 v[32:35], a[196:199], a[4:7], v[32:35]
s_xor_b32 s64, s85, 286720
ds_read_b64_tr_b16 a[164:165], v190 offset:8192
v_mfma_f32_16x16x32_bf16 v[32:35], a[192:195], a[0:3], v[32:35]
buffer_load_dwordx4 v13, s[40:43], s64 offen lds
v_mfma_f32_16x16x32_bf16 v[36:39], a[200:203], a[0:3], v[36:39]
ds_read_b64_tr_b16 a[166:167], v190 offset:12288
v_mfma_f32_16x16x32_bf16 v[36:39], a[204:207], a[4:7], v[36:39]
s_xor_b32 m0, s76, 36864
v_mfma_f32_16x16x32_bf16 v[68:71], a[204:207], a[12:15], v[68:71]
s_xor_b32 s64, s85, 294912
v_mfma_f32_16x16x32_bf16 v[68:71], a[200:203], a[8:11], v[68:71]
buffer_load_dwordx4 v12, s[40:43], s64 offen lds
v_mfma_f32_16x16x32_bf16 v[100:103], a[200:203], a[16:19], v[100:103]
v_mfma_f32_16x16x32_bf16 v[100:103], a[204:207], a[20:23], v[100:103]
v_mfma_f32_16x16x32_bf16 v[132:135], a[204:207], a[28:31], v[132:135]
v_mfma_f32_16x16x32_bf16 v[132:135], a[200:203], a[24:27], v[132:135]
s_waitcnt vmcnt(25)
s_waitcnt lgkmcnt(1)
s_xor_b32 m0, s76, 37888
v_mfma_f32_16x16x32_bf16 v[136:139], a[144:147], a[56:59], v[136:139]
s_waitcnt vmcnt(21)
s_xor_b32 s64, s85, 303104
ds_read_b64_tr_b16 a[168:169], v191 offset:0
v_mfma_f32_16x16x32_bf16 v[136:139], a[148:151], a[60:63], v[136:139]
buffer_load_dwordx4 v13, s[40:43], s64 offen lds
v_mfma_f32_16x16x32_bf16 v[104:107], a[148:151], a[52:55], v[104:107]
s_xor_b32 m0, s76, 38912
ds_read_b64_tr_b16 a[170:171], v191 offset:4096
v_mfma_f32_16x16x32_bf16 v[104:107], a[144:147], a[48:51], v[104:107]
s_xor_b32 s64, s85, 311296
ds_read_b64_tr_b16 a[172:173], v191 offset:8192
v_mfma_f32_16x16x32_bf16 v[72:75], a[144:147], a[40:43], v[72:75]
buffer_load_dwordx4 v12, s[40:43], s64 offen lds
v_mfma_f32_16x16x32_bf16 v[72:75], a[148:151], a[44:47], v[72:75]
s_xor_b32 m0, s76, 39936
ds_read_b64_tr_b16 a[174:175], v191 offset:12288
v_mfma_f32_16x16x32_bf16 v[40:43], a[148:151], a[36:39], v[40:43]
s_xor_b32 s64, s85, 319488
ds_read_b64_tr_b16 a[176:177], v184 offset:0
v_mfma_f32_16x16x32_bf16 v[40:43], a[144:147], a[32:35], v[40:43]
buffer_load_dwordx4 v13, s[40:43], s64 offen lds
v_mfma_f32_16x16x32_bf16 v[44:47], a[152:155], a[32:35], v[44:47]
ds_read_b64_tr_b16 a[178:179], v184 offset:4096
v_mfma_f32_16x16x32_bf16 v[44:47], a[156:159], a[36:39], v[44:47]
ds_read_b64_tr_b16 a[180:181], v184 offset:8192
v_mfma_f32_16x16x32_bf16 v[76:79], a[156:159], a[44:47], v[76:79]
s_xor_b32 s65, s84, 32768
ds_read_b64_tr_b16 a[182:183], v184 offset:12288
v_mfma_f32_16x16x32_bf16 v[76:79], a[152:155], a[40:43], v[76:79]
buffer_load_dwordx4 v[152:155], v14, s[44:47], s65 offen offset:0 sc1
v_mfma_f32_16x16x32_bf16 v[108:111], a[152:155], a[48:51], v[108:111]
ds_read_b64_tr_b16 a[184:185], v185 offset:0
v_mfma_f32_16x16x32_bf16 v[108:111], a[156:159], a[52:55], v[108:111]
ds_read_b64_tr_b16 a[186:187], v185 offset:4096
v_mfma_f32_16x16x32_bf16 v[140:143], a[156:159], a[60:63], v[140:143]
buffer_load_dwordx4 v[160:163], v14, s[44:47], s65 offen offset:1024 sc1
v_mfma_f32_16x16x32_bf16 v[140:143], a[152:155], a[56:59], v[140:143]
ds_read_b64_tr_b16 a[188:189], v185 offset:8192
v_mfma_f32_16x16x32_bf16 v[144:147], a[160:163], a[56:59], v[144:147]
s_waitcnt lgkmcnt(5)
ds_read_b64_tr_b16 a[190:191], v185 offset:12288
v_mfma_f32_16x16x32_bf16 v[144:147], a[164:167], a[60:63], v[144:147]
v_mfma_f32_16x16x32_bf16 v[112:115], a[164:167], a[52:55], v[112:115]
buffer_load_dwordx4 v[168:171], v15, s[44:47], s65 offen offset:0 sc1
v_mfma_f32_16x16x32_bf16 v[112:115], a[160:163], a[48:51], v[112:115]
ds_read_b64_tr_b16 a[192:193], v186 offset:0
v_mfma_f32_16x16x32_bf16 v[80:83], a[160:163], a[40:43], v[80:83]
ds_read_b64_tr_b16 a[194:195], v186 offset:4096
v_mfma_f32_16x16x32_bf16 v[80:83], a[164:167], a[44:47], v[80:83]
buffer_load_dwordx4 v[176:179], v15, s[44:47], s65 offen offset:1024 sc1
v_mfma_f32_16x16x32_bf16 v[48:51], a[164:167], a[36:39], v[48:51]
ds_read_b64_tr_b16 a[196:197], v186 offset:8192
v_mfma_f32_16x16x32_bf16 v[48:51], a[160:163], a[32:35], v[48:51]
ds_read_b64_tr_b16 a[198:199], v186 offset:12288
v_mfma_f32_16x16x32_bf16 v[52:55], a[168:171], a[32:35], v[52:55]
s_xor_b32 s65, s84, 40960
v_mfma_f32_16x16x32_bf16 v[52:55], a[172:175], a[36:39], v[52:55]
buffer_load_dwordx4 v[156:159], v14, s[44:47], s65 offen offset:0 sc1
v_mfma_f32_16x16x32_bf16 v[84:87], a[172:175], a[44:47], v[84:87]
ds_read_b64_tr_b16 a[200:201], v187 offset:0
v_mfma_f32_16x16x32_bf16 v[84:87], a[168:171], a[40:43], v[84:87]
ds_read_b64_tr_b16 a[202:203], v187 offset:4096
v_mfma_f32_16x16x32_bf16 v[116:119], a[168:171], a[48:51], v[116:119]
buffer_load_dwordx4 v[164:167], v14, s[44:47], s65 offen offset:1024 sc1
v_mfma_f32_16x16x32_bf16 v[116:119], a[172:175], a[52:55], v[116:119]
ds_read_b64_tr_b16 a[204:205], v187 offset:8192
v_mfma_f32_16x16x32_bf16 v[148:151], a[172:175], a[60:63], v[148:151]
ds_read_b64_tr_b16 a[206:207], v187 offset:12288
v_mfma_f32_16x16x32_bf16 v[148:151], a[168:171], a[56:59], v[148:151]
v_mfma_f32_16x16x32_bf16 v[120:123], a[176:179], a[56:59], v[120:123]
s_waitcnt lgkmcnt(4)
buffer_load_dwordx4 v[172:175], v15, s[44:47], s65 offen offset:0 sc1
v_mfma_f32_16x16x32_bf16 v[120:123], a[180:183], a[60:63], v[120:123]
v_mfma_f32_16x16x32_bf16 v[88:91], a[180:183], a[52:55], v[88:91]
v_mfma_f32_16x16x32_bf16 v[88:91], a[176:179], a[48:51], v[88:91]
buffer_load_dwordx4 v[180:183], v15, s[44:47], s65 offen offset:1024 sc1
v_mfma_f32_16x16x32_bf16 v[56:59], a[176:179], a[40:43], v[56:59]
v_mfma_f32_16x16x32_bf16 v[56:59], a[180:183], a[44:47], v[56:59]
v_mfma_f32_16x16x32_bf16 v[24:27], a[180:183], a[36:39], v[24:27]
v_mfma_f32_16x16x32_bf16 v[24:27], a[176:179], a[32:35], v[24:27]
v_mfma_f32_16x16x32_bf16 v[28:31], a[184:187], a[32:35], v[28:31]
s_waitcnt vmcnt(24)
s_barrier
v_mfma_f32_16x16x32_bf16 v[28:31], a[188:191], a[36:39], v[28:31]
s_xor_b32 m0, s76, 65536
ds_read_b64_tr_b16 a[144:145], v188 offset:32768
v_mfma_f32_16x16x32_bf16 v[60:63], a[188:191], a[44:47], v[60:63]
s_xor_b32 s64, s85, 524288
ds_read_b64_tr_b16 a[146:147], v188 offset:36864
v_mfma_f32_16x16x32_bf16 v[60:63], a[184:187], a[40:43], v[60:63]
buffer_load_dwordx4 v12, s[40:43], s64 offen lds
v_mfma_f32_16x16x32_bf16 v[92:95], a[184:187], a[48:51], v[92:95]
ds_read_b64_tr_b16 a[148:149], v188 offset:40960
v_mfma_f32_16x16x32_bf16 v[92:95], a[188:191], a[52:55], v[92:95]
s_xor_b32 m0, s76, 66560
ds_read_b64_tr_b16 a[150:151], v188 offset:45056
v_mfma_f32_16x16x32_bf16 v[124:127], a[188:191], a[60:63], v[124:127]
s_xor_b32 s64, s85, 532480
ds_read_b64_tr_b16 a[152:153], v189 offset:32768
v_mfma_f32_16x16x32_bf16 v[124:127], a[184:187], a[56:59], v[124:127]
buffer_load_dwordx4 v13, s[40:43], s64 offen lds
v_mfma_f32_16x16x32_bf16 v[128:131], a[192:195], a[56:59], v[128:131]
ds_read_b64_tr_b16 a[154:155], v189 offset:36864
v_mfma_f32_16x16x32_bf16 v[128:131], a[196:199], a[60:63], v[128:131]
s_branch L_po22
L_pg22:
s_branch L_tr1
L_po22:
s_xor_b32 m0, s76, 67584
ds_read_b64_tr_b16 a[156:157], v189 offset:40960
v_mfma_f32_16x16x32_bf16 v[96:99], a[196:199], a[52:55], v[96:99]
s_xor_b32 s64, s85, 540672
ds_read_b64_tr_b16 a[158:159], v189 offset:45056
v_mfma_f32_16x16x32_bf16 v[96:99], a[192:195], a[48:51], v[96:99]
buffer_load_dwordx4 v12, s[40:43], s64 offen lds
v_mfma_f32_16x16x32_bf16 v[64:67], a[192:195], a[40:43], v[64:67]
ds_read_b64_tr_b16 a[160:161], v190 offset:32768
v_mfma_f32_16x16x32_bf16 v[64:67], a[196:199], a[44:47], v[64:67]
s_xor_b32 m0, s76, 68608
ds_read_b64_tr_b16 a[162:163], v190 offset:36864
v_mfma_f32_16x16x32_bf16 v[32:35], a[196:199], a[36:39], v[32:35]
s_xor_b32 s64, s85, 548864
ds_read_b64_tr_b16 a[164:165], v190 offset:40960
v_mfma_f32_16x16x32_bf16 v[32:35], a[192:195], a[32:35], v[32:35]
s_waitcnt lgkmcnt(6)
buffer_load_dwordx4 v13, s[40:43], s64 offen lds
v_mfma_f32_16x16x32_bf16 v[36:39], a[200:203], a[32:35], v[36:39]
ds_read_b64_tr_b16 a[166:167], v190 offset:45056
v_mfma_f32_16x16x32_bf16 v[36:39], a[204:207], a[36:39], v[36:39]
s_xor_b32 m0, s76, 69632
v_mfma_f32_16x16x32_bf16 v[68:71], a[204:207], a[44:47], v[68:71]
s_xor_b32 s64, s85, 557056
v_mfma_f32_16x16x32_bf16 v[68:71], a[200:203], a[40:43], v[68:71]
buffer_load_dwordx4 v12, s[40:43], s64 offen lds
v_mfma_f32_16x16x32_bf16 v[100:103], a[200:203], a[48:51], v[100:103]
s_sub_u32 s73, 1, s73
s_sub_u32 s70, s70, 1
s_cmp_lg_u32 s70, 0
v_mfma_f32_16x16x32_bf16 v[100:103], a[204:207], a[52:55], v[100:103]
v_mfma_f32_16x16x32_bf16 v[132:135], a[204:207], a[60:63], v[132:135]
v_mfma_f32_16x16x32_bf16 v[132:135], a[200:203], a[56:59], v[132:135]
s_cbranch_scc1 L_p5loop
L_p5last:
s_waitcnt lgkmcnt(10)
s_waitcnt vmcnt(25)
v_mfma_f32_16x16x32_bf16 v[136:139], a[144:147], a[232:235], v[136:139]
s_waitcnt vmcnt(21)
s_waitcnt lgkmcnt(8)
s_xor_b32 m0, s76, 70656
s_xor_b32 s64, s85, 565248
ds_read_b64_tr_b16 a[168:169], v191 offset:32768
v_mfma_f32_16x16x32_bf16 v[136:139], a[148:151], a[236:239], v[136:139]
buffer_load_dwordx4 v13, s[40:43], s64 offen lds
v_mfma_f32_16x16x32_bf16 v[104:107], a[148:151], a[228:231], v[104:107]
s_xor_b32 m0, s76, 71680
ds_read_b64_tr_b16 a[170:171], v191 offset:36864
v_mfma_f32_16x16x32_bf16 v[104:107], a[144:147], a[224:227], v[104:107]
s_xor_b32 s64, s85, 573440
ds_read_b64_tr_b16 a[172:173], v191 offset:40960
v_mfma_f32_16x16x32_bf16 v[72:75], a[144:147], a[216:219], v[72:75]
buffer_load_dwordx4 v12, s[40:43], s64 offen lds
v_mfma_f32_16x16x32_bf16 v[72:75], a[148:151], a[220:223], v[72:75]
s_xor_b32 m0, s76, 72704
ds_read_b64_tr_b16 a[174:175], v191 offset:45056
v_mfma_f32_16x16x32_bf16 v[40:43], a[148:151], a[212:215], v[40:43]
s_xor_b32 s64, s85, 581632
ds_read_b64_tr_b16 a[176:177], v184 offset:32768
v_mfma_f32_16x16x32_bf16 v[40:43], a[144:147], a[208:211], v[40:43]
s_waitcnt lgkmcnt(5)
buffer_load_dwordx4 v13, s[40:43], s64 offen lds
v_mfma_f32_16x16x32_bf16 v[44:47], a[152:155], a[208:211], v[44:47]
ds_read_b64_tr_b16 a[178:179], v184 offset:36864
v_mfma_f32_16x16x32_bf16 v[44:47], a[156:159], a[212:215], v[44:47]
ds_read_b64_tr_b16 a[180:181], v184 offset:40960
v_mfma_f32_16x16x32_bf16 v[76:79], a[156:159], a[220:223], v[76:79]
s_xor_b32 s65, s84, 65536
ds_read_b64_tr_b16 a[182:183], v184 offset:45056
v_mfma_f32_16x16x32_bf16 v[76:79], a[152:155], a[216:219], v[76:79]
buffer_load_dwordx4 a[0:3], v14, s[44:47], s65 offen offset:0 sc1
v_mfma_f32_16x16x32_bf16 v[108:111], a[152:155], a[224:227], v[108:111]
ds_read_b64_tr_b16 a[184:185], v185 offset:32768
v_mfma_f32_16x16x32_bf16 v[108:111], a[156:159], a[228:231], v[108:111]
ds_read_b64_tr_b16 a[186:187], v185 offset:36864
v_mfma_f32_16x16x32_bf16 v[140:143], a[156:159], a[236:239], v[140:143]
buffer_load_dwordx4 a[8:11], v14, s[44:47], s65 offen offset:1024 sc1
v_mfma_f32_16x16x32_bf16 v[140:143], a[152:155], a[232:235], v[140:143]
ds_read_b64_tr_b16 a[188:189], v185 offset:40960
v_mfma_f32_16x16x32_bf16 v[144:147], a[160:163], a[232:235], v[144:147]
ds_read_b64_tr_b16 a[190:191], v185 offset:45056
v_mfma_f32_16x16x32_bf16 v[144:147], a[164:167], a[236:239], v[144:147]
v_mfma_f32_16x16x32_bf16 v[112:115], a[164:167], a[228:231], v[112:115]
buffer_load_dwordx4 a[16:19], v15, s[44:47], s65 offen offset:0 sc1
v_mfma_f32_16x16x32_bf16 v[112:115], a[160:163], a[224:227], v[112:115]
ds_read_b64_tr_b16 a[192:193], v186 offset:32768
v_mfma_f32_16x16x32_bf16 v[80:83], a[160:163], a[216:219], v[80:83]
ds_read_b64_tr_b16 a[194:195], v186 offset:36864
v_mfma_f32_16x16x32_bf16 v[80:83], a[164:167], a[220:223], v[80:83]
buffer_load_dwordx4 a[24:27], v15, s[44:47], s65 offen offset:1024 sc1
v_mfma_f32_16x16x32_bf16 v[48:51], a[164:167], a[212:215], v[48:51]
ds_read_b64_tr_b16 a[196:197], v186 offset:40960
v_mfma_f32_16x16x32_bf16 v[48:51], a[160:163], a[208:211], v[48:51]
s_waitcnt lgkmcnt(4)
ds_read_b64_tr_b16 a[198:199], v186 offset:45056
v_mfma_f32_16x16x32_bf16 v[52:55], a[168:171], a[208:211], v[52:55]
s_xor_b32 s65, s84, 73728
v_mfma_f32_16x16x32_bf16 v[52:55], a[172:175], a[212:215], v[52:55]
buffer_load_dwordx4 a[4:7], v14, s[44:47], s65 offen offset:0 sc1
v_mfma_f32_16x16x32_bf16 v[84:87], a[172:175], a[220:223], v[84:87]
ds_read_b64_tr_b16 a[200:201], v187 offset:32768
v_mfma_f32_16x16x32_bf16 v[84:87], a[168:171], a[216:219], v[84:87]
ds_read_b64_tr_b16 a[202:203], v187 offset:36864
v_mfma_f32_16x16x32_bf16 v[116:119], a[168:171], a[224:227], v[116:119]
buffer_load_dwordx4 a[12:15], v14, s[44:47], s65 offen offset:1024 sc1
v_mfma_f32_16x16x32_bf16 v[116:119], a[172:175], a[228:231], v[116:119]
ds_read_b64_tr_b16 a[204:205], v187 offset:40960
v_mfma_f32_16x16x32_bf16 v[148:151], a[172:175], a[236:239], v[148:151]
ds_read_b64_tr_b16 a[206:207], v187 offset:45056
v_mfma_f32_16x16x32_bf16 v[148:151], a[168:171], a[232:235], v[148:151]
v_mfma_f32_16x16x32_bf16 v[120:123], a[176:179], a[232:235], v[120:123]
buffer_load_dwordx4 a[20:23], v15, s[44:47], s65 offen offset:0 sc1
v_mfma_f32_16x16x32_bf16 v[120:123], a[180:183], a[236:239], v[120:123]
v_mfma_f32_16x16x32_bf16 v[88:91], a[180:183], a[228:231], v[88:91]
v_mfma_f32_16x16x32_bf16 v[88:91], a[176:179], a[224:227], v[88:91]
buffer_load_dwordx4 a[28:31], v15, s[44:47], s65 offen offset:1024 sc1
v_mfma_f32_16x16x32_bf16 v[56:59], a[176:179], a[216:219], v[56:59]
v_mfma_f32_16x16x32_bf16 v[56:59], a[180:183], a[220:223], v[56:59]
v_mfma_f32_16x16x32_bf16 v[24:27], a[180:183], a[212:215], v[24:27]
v_mfma_f32_16x16x32_bf16 v[24:27], a[176:179], a[208:211], v[24:27]
v_mfma_f32_16x16x32_bf16 v[28:31], a[184:187], a[208:211], v[28:31]
s_waitcnt vmcnt(24)
s_barrier
s_waitcnt lgkmcnt(0)
v_mfma_f32_16x16x32_bf16 v[28:31], a[188:191], a[212:215], v[28:31]
s_xor_b32 m0, s76, 98304
ds_read_b64_tr_b16 a[144:145], v196 offset:0
v_mfma_f32_16x16x32_bf16 v[60:63], a[188:191], a[220:223], v[60:63]
s_xor_b32 s64, s85, 786432
ds_read_b64_tr_b16 a[146:147], v196 offset:4096
v_mfma_f32_16x16x32_bf16 v[60:63], a[184:187], a[216:219], v[60:63]
buffer_load_dwordx4 v12, s[40:43], s64 offen lds
v_mfma_f32_16x16x32_bf16 v[92:95], a[184:187], a[224:227], v[92:95]
ds_read_b64_tr_b16 a[148:149], v196 offset:8192
v_mfma_f32_16x16x32_bf16 v[92:95], a[188:191], a[228:231], v[92:95]
s_xor_b32 m0, s76, 99328
ds_read_b64_tr_b16 a[150:151], v196 offset:12288
v_mfma_f32_16x16x32_bf16 v[124:127], a[188:191], a[236:239], v[124:127]
s_xor_b32 s64, s85, 794624
ds_read_b64_tr_b16 a[152:153], v197 offset:0
v_mfma_f32_16x16x32_bf16 v[124:127], a[184:187], a[232:235], v[124:127]
buffer_load_dwordx4 v13, s[40:43], s64 offen lds
v_mfma_f32_16x16x32_bf16 v[128:131], a[192:195], a[232:235], v[128:131]
ds_read_b64_tr_b16 a[154:155], v197 offset:4096
v_mfma_f32_16x16x32_bf16 v[128:131], a[196:199], a[236:239], v[128:131]
s_xor_b32 m0, s76, 100352
ds_read_b64_tr_b16 a[156:157], v197 offset:8192
v_mfma_f32_16x16x32_bf16 v[96:99], a[196:199], a[228:231], v[96:99]
s_xor_b32 s64, s85, 802816
ds_read_b64_tr_b16 a[158:159], v197 offset:12288
v_mfma_f32_16x16x32_bf16 v[96:99], a[192:195], a[224:227], v[96:99]
buffer_load_dwordx4 v12, s[40:43], s64 offen lds
v_mfma_f32_16x16x32_bf16 v[64:67], a[192:195], a[216:219], v[64:67]
ds_read_b64_tr_b16 a[160:161], v198 offset:0
v_mfma_f32_16x16x32_bf16 v[64:67], a[196:199], a[220:223], v[64:67]
s_xor_b32 m0, s76, 101376
ds_read_b64_tr_b16 a[162:163], v198 offset:4096
v_mfma_f32_16x16x32_bf16 v[32:35], a[196:199], a[212:215], v[32:35]
s_xor_b32 s64, s85, 811008
ds_read_b64_tr_b16 a[164:165], v198 offset:8192
v_mfma_f32_16x16x32_bf16 v[32:35], a[192:195], a[208:211], v[32:35]
buffer_load_dwordx4 v13, s[40:43], s64 offen lds
v_mfma_f32_16x16x32_bf16 v[36:39], a[200:203], a[208:211], v[36:39]
ds_read_b64_tr_b16 a[166:167], v198 offset:12288
v_mfma_f32_16x16x32_bf16 v[36:39], a[204:207], a[212:215], v[36:39]
s_xor_b32 m0, s76, 102400
v_mfma_f32_16x16x32_bf16 v[68:71], a[204:207], a[220:223], v[68:71]
s_xor_b32 s64, s85, 819200
v_mfma_f32_16x16x32_bf16 v[68:71], a[200:203], a[216:219], v[68:71]
buffer_load_dwordx4 v12, s[40:43], s64 offen lds
v_mfma_f32_16x16x32_bf16 v[100:103], a[200:203], a[224:227], v[100:103]
s_xor_b32 s66, s2, 1
s_lshl2_add_u32 s66, s66, s30
s_lshl_b32 s73, s66, 12
v_mfma_f32_16x16x32_bf16 v[100:103], a[204:207], a[228:231], v[100:103]
s_add_u32 s73, s73, 67108864
s_lshl2_add_u32 s66, s2, s30
s_lshl_b32 s75, s66, 12
v_mfma_f32_16x16x32_bf16 v[132:135], a[204:207], a[236:239], v[132:135]
s_add_u32 s75, s75, 67108864
s_lshl_b32 s77, s82, 18
s_lshl_b32 s66, s30, 16
v_mfma_f32_16x16x32_bf16 v[132:135], a[200:203], a[232:235], v[132:135]
s_waitcnt vmcnt(25)
s_waitcnt lgkmcnt(1)
s_add_u32 s77, s77, s66
s_add_u32 s77, s77, s87
s_lshl_b32 s66, s83, 7
s_xor_b32 m0, s76, 103424
v_mfma_f32_16x16x32_bf16 v[136:139], a[144:147], v[176:179], v[136:139]
s_waitcnt vmcnt(21)
s_add_u32 s77, s77, s66
s_xor_b32 s64, s85, 827392
ds_read_b64_tr_b16 a[168:169], v199 offset:0
v_lshlrev_b32 v1, 24, v0
v_mfma_f32_16x16x32_bf16 v[136:139], a[148:151], v[180:183], v[136:139]
buffer_load_dwordx4 v13, s[40:43], s64 offen lds
v_mfma_f32_16x16x32_bf16 v[104:107], a[148:151], v[172:175], v[104:107]
s_xor_b32 m0, s76, 104448
ds_read_b64_tr_b16 a[170:171], v199 offset:4096
v_and_b32 v8, 7, v0
v_mfma_f32_16x16x32_bf16 v[104:107], a[144:147], v[168:171], v[104:107]
s_xor_b32 s64, s85, 835584
ds_read_b64_tr_b16 a[172:173], v199 offset:8192
v_lshlrev_b32 v8, 11, v8
v_mfma_f32_16x16x32_bf16 v[72:75], a[144:147], v[160:163], v[72:75]
buffer_load_dwordx4 v12, s[40:43], s64 offen lds
v_mfma_f32_16x16x32_bf16 v[72:75], a[148:151], v[164:167], v[72:75]
s_xor_b32 m0, s76, 105472
ds_read_b64_tr_b16 a[174:175], v199 offset:12288
v_bfe_u32 v10, v0, 3, 1
v_mfma_f32_16x16x32_bf16 v[40:43], a[148:151], v[156:159], v[40:43]
s_xor_b32 s64, s85, 843776
ds_read_b64_tr_b16 a[176:177], v192 offset:0
v_lshl_add_u32 v8, v10, 6, v8
v_mfma_f32_16x16x32_bf16 v[40:43], a[144:147], v[152:155], v[40:43]
buffer_load_dwordx4 v13, s[40:43], s64 offen lds
v_mfma_f32_16x16x32_bf16 v[44:47], a[152:155], v[152:155], v[44:47]
ds_read_b64_tr_b16 a[178:179], v192 offset:4096
v_bfe_u32 v10, v0, 4, 1
v_mfma_f32_16x16x32_bf16 v[44:47], a[156:159], v[156:159], v[44:47]
ds_read_b64_tr_b16 a[180:181], v192 offset:8192
v_lshl_add_u32 v8, v10, 5, v8
v_mfma_f32_16x16x32_bf16 v[76:79], a[156:159], v[164:167], v[76:79]
s_xor_b32 s65, s84, 98304
ds_read_b64_tr_b16 a[182:183], v192 offset:12288
v_lshrrev_b32 v10, 5, v0
v_mfma_f32_16x16x32_bf16 v[76:79], a[152:155], v[160:163], v[76:79]
buffer_load_dwordx4 a[32:35], v14, s[44:47], s65 offen offset:0 sc1
v_mfma_f32_16x16x32_bf16 v[108:111], a[152:155], v[168:171], v[108:111]
ds_read_b64_tr_b16 a[184:185], v193 offset:0
v_lshl_add_u32 v8, v10, 4, v8
v_mfma_f32_16x16x32_bf16 v[108:111], a[156:159], v[172:175], v[108:111]
ds_read_b64_tr_b16 a[186:187], v193 offset:4096
v_add_u32 v2, s86, v16
v_mfma_f32_16x16x32_bf16 v[140:143], a[156:159], v[180:183], v[140:143]
buffer_load_dwordx4 a[40:43], v14, s[44:47], s65 offen offset:1024 sc1
v_mfma_f32_16x16x32_bf16 v[140:143], a[152:155], v[176:179], v[140:143]
ds_read_b64_tr_b16 a[188:189], v193 offset:8192
v_xor_b32 v3, 0x2000, v2
v_mfma_f32_16x16x32_bf16 v[144:147], a[160:163], v[176:179], v[144:147]
s_waitcnt lgkmcnt(5)
ds_read_b64_tr_b16 a[190:191], v193 offset:12288
v_mov_b32 v232, 0
v_mfma_f32_16x16x32_bf16 v[144:147], a[164:167], v[180:183], v[144:147]
v_mov_b32 v233, 0
v_mov_b32 v236, 0
v_mfma_f32_16x16x32_bf16 v[112:115], a[164:167], v[172:175], v[112:115]
buffer_load_dwordx4 a[48:51], v15, s[44:47], s65 offen offset:0 sc1
v_mfma_f32_16x16x32_bf16 v[112:115], a[160:163], v[168:171], v[112:115]
ds_read_b64_tr_b16 a[192:193], v194 offset:0
v_mov_b32 v237, 0
v_mfma_f32_16x16x32_bf16 v[80:83], a[160:163], v[160:163], v[80:83]
ds_read_b64_tr_b16 a[194:195], v194 offset:4096
v_and_b32 v9, 1, v0
v_mfma_f32_16x16x32_bf16 v[80:83], a[164:167], v[164:167], v[80:83]
buffer_load_dwordx4 a[56:59], v15, s[44:47], s65 offen offset:1024 sc1
v_mfma_f32_16x16x32_bf16 v[48:51], a[164:167], v[156:159], v[48:51]
ds_read_b64_tr_b16 a[196:197], v194 offset:8192
v_lshlrev_b32 v9, 4, v9
v_mfma_f32_16x16x32_bf16 v[48:51], a[160:163], v[152:155], v[48:51]
ds_read_b64_tr_b16 a[198:199], v194 offset:12288
v_mov_b32 v10, 0x3f80
v_mfma_f32_16x16x32_bf16 v[52:55], a[168:171], v[152:155], v[52:55]
s_xor_b32 s65, s84, 106496
v_lshlrev_b32 v9, v9, v10
v_lshrrev_b32 v10, 4, v0
v_mfma_f32_16x16x32_bf16 v[52:55], a[172:175], v[156:159], v[52:55]
buffer_load_dwordx4 a[36:39], v14, s[44:47], s65 offen offset:0 sc1
v_mfma_f32_16x16x32_bf16 v[84:87], a[172:175], v[164:167], v[84:87]
ds_read_b64_tr_b16 a[200:201], v195 offset:0
v_lshlrev_b32 v10, 1, v10
v_mfma_f32_16x16x32_bf16 v[84:87], a[168:171], v[160:163], v[84:87]
ds_read_b64_tr_b16 a[202:203], v195 offset:4096
v_bfe_u32 v11, v0, 1, 3
v_mfma_f32_16x16x32_bf16 v[116:119], a[168:171], v[168:171], v[116:119]
buffer_load_dwordx4 a[44:47], v14, s[44:47], s65 offen offset:1024 sc1
v_mfma_f32_16x16x32_bf16 v[116:119], a[172:175], v[172:175], v[116:119]
ds_read_b64_tr_b16 a[204:205], v195 offset:8192
v_xor_b32 v10, v10, v11
v_mfma_f32_16x16x32_bf16 v[148:151], a[172:175], v[180:183], v[148:151]
ds_read_b64_tr_b16 a[206:207], v195 offset:12288
v_subrev_u32 v11, 1, v10
v_mfma_f32_16x16x32_bf16 v[148:151], a[168:171], v[176:179], v[148:151]
v_ashrrev_i32 v11, 31, v11
v_and_b32 v234, v11, v9
v_mfma_f32_16x16x32_bf16 v[120:123], a[176:179], v[176:179], v[120:123]
s_waitcnt lgkmcnt(4)
buffer_load_dwordx4 a[52:55], v15, s[44:47], s65 offen offset:0 sc1
v_mfma_f32_16x16x32_bf16 v[120:123], a[180:183], v[180:183], v[120:123]
v_xor_b32 v10, 1, v10
v_subrev_u32 v11, 1, v10
v_mfma_f32_16x16x32_bf16 v[88:91], a[180:183], v[172:175], v[88:91]
v_ashrrev_i32 v11, 31, v11
v_and_b32 v235, v11, v9
v_mfma_f32_16x16x32_bf16 v[88:91], a[176:179], v[168:171], v[88:91]
s_mov_b32 s48, s24
buffer_load_dwordx4 a[60:63], v15, s[44:47], s65 offen offset:1024 sc1
v_mfma_f32_16x16x32_bf16 v[56:59], a[176:179], v[160:163], v[56:59]
s_mov_b32 s49, s25
s_mov_b32 s50, 4194304
s_mov_b32 s51, 0x20000
v_mfma_f32_16x16x32_bf16 v[56:59], a[180:183], v[164:167], v[56:59]
v_mfma_f32_16x16x32_bf16 v[24:27], a[180:183], v[156:159], v[24:27]
v_mfma_f32_16x16x32_bf16 v[24:27], a[176:179], v[152:155], v[24:27]
v_mfma_f32_16x16x32_bf16 v[28:31], a[184:187], v[152:155], v[28:31]
s_waitcnt vmcnt(24)
s_barrier
v_mfma_f32_16x16x32_bf16 v[28:31], a[188:191], v[156:159], v[28:31]
ds_read_b64_tr_b16 a[144:145], v196 offset:32768
v_mfma_f32_16x16x32_bf16 v[60:63], a[188:191], v[164:167], v[60:63]
ds_read_b64_tr_b16 a[146:147], v196 offset:36864
v_mfma_f32_16x16x32_bf16 v[60:63], a[184:187], v[160:163], v[60:63]
ds_read_b64_tr_b16 a[148:149], v196 offset:40960
v_mfma_f32_16x16x32_bf16 v[92:95], a[184:187], v[168:171], v[92:95]
ds_read_b64_tr_b16 a[150:151], v196 offset:45056
v_mfma_f32_16x16x32_bf16 v[92:95], a[188:191], v[172:175], v[92:95]
ds_read_b64_tr_b16 a[152:153], v197 offset:32768
v_mfma_f32_16x16x32_bf16 v[124:127], a[188:191], v[180:183], v[124:127]
ds_read_b64_tr_b16 a[154:155], v197 offset:36864
v_mfma_f32_16x16x32_bf16 v[124:127], a[184:187], v[176:179], v[124:127]
ds_read_b64_tr_b16 a[156:157], v197 offset:40960
v_mfma_f32_16x16x32_bf16 v[128:131], a[192:195], v[176:179], v[128:131]
ds_read_b64_tr_b16 a[158:159], v197 offset:45056
v_mfma_f32_16x16x32_bf16 v[128:131], a[196:199], v[180:183], v[128:131]
ds_read_b64_tr_b16 a[160:161], v198 offset:32768
v_mfma_f32_16x16x32_bf16 v[96:99], a[196:199], v[172:175], v[96:99]
ds_read_b64_tr_b16 a[162:163], v198 offset:36864
v_mfma_f32_16x16x32_bf16 v[96:99], a[192:195], v[168:171], v[96:99]
ds_read_b64_tr_b16 a[164:165], v198 offset:40960
v_mfma_f32_16x16x32_bf16 v[64:67], a[192:195], v[160:163], v[64:67]
ds_read_b64_tr_b16 a[166:167], v198 offset:45056
v_mfma_f32_16x16x32_bf16 v[64:67], a[196:199], v[164:167], v[64:67]
v_mfma_f32_16x16x32_bf16 v[32:35], a[196:199], v[156:159], v[32:35]
v_mfma_f32_16x16x32_bf16 v[32:35], a[192:195], v[152:155], v[32:35]
s_waitcnt lgkmcnt(5)
v_mfma_f32_16x16x32_bf16 v[36:39], a[200:203], v[152:155], v[36:39]
v_mfma_f32_16x16x32_bf16 v[36:39], a[204:207], v[156:159], v[36:39]
v_mfma_f32_16x16x32_bf16 v[68:71], a[204:207], v[164:167], v[68:71]
v_mfma_f32_16x16x32_bf16 v[68:71], a[200:203], v[160:163], v[68:71]
v_mfma_f32_16x16x32_bf16 v[100:103], a[200:203], v[168:171], v[100:103]
v_mfma_f32_16x16x32_bf16 v[100:103], a[204:207], v[172:175], v[100:103]
v_mfma_f32_16x16x32_bf16 v[132:135], a[204:207], v[180:183], v[132:135]
v_mfma_f32_16x16x32_bf16 v[132:135], a[200:203], v[176:179], v[132:135]
s_waitcnt vmcnt(20)
v_mfma_f32_16x16x32_bf16 v[136:139], a[144:147], a[24:27], v[136:139]
s_waitcnt vmcnt(16)
ds_read_b64_tr_b16 a[168:169], v199 offset:32768
v_mfma_f32_16x16x32_bf16 v[136:139], a[148:151], a[28:31], v[136:139]
ds_read_b64_tr_b16 a[170:171], v199 offset:36864
v_mfma_f32_16x16x32_bf16 v[104:107], a[148:151], a[20:23], v[104:107]
ds_read_b64_tr_b16 a[172:173], v199 offset:40960
v_mfma_f32_16x16x32_bf16 v[104:107], a[144:147], a[16:19], v[104:107]
ds_read_b64_tr_b16 a[174:175], v199 offset:45056
v_mfma_f32_16x16x32_bf16 v[72:75], a[144:147], a[8:11], v[72:75]
v_mfma_f32_16x16x32_bf16 v[72:75], a[148:151], a[12:15], v[72:75]
v_mfma_f32_16x16x32_bf16 v[40:43], a[148:151], a[4:7], v[40:43]
s_waitcnt vmcnt(8)
s_barrier
v_mfma_f32_16x16x32_bf16 v[40:43], a[144:147], a[0:3], v[40:43]
ds_read_b64_tr_b16 a[176:177], v188 offset:0
v_mfma_f32_16x16x32_bf16 v[44:47], a[152:155], a[0:3], v[44:47]
s_waitcnt lgkmcnt(4)
ds_read_b64_tr_b16 a[178:179], v188 offset:4096
v_mfma_f32_16x16x32_bf16 v[44:47], a[156:159], a[4:7], v[44:47]
ds_read_b64_tr_b16 a[180:181], v188 offset:8192
v_mfma_f32_16x16x32_bf16 v[76:79], a[156:159], a[12:15], v[76:79]
ds_read_b64_tr_b16 a[182:183], v188 offset:12288
v_mfma_f32_16x16x32_bf16 v[76:79], a[152:155], a[8:11], v[76:79]
ds_read_b64_tr_b16 a[184:185], v189 offset:0
v_mfma_f32_16x16x32_bf16 v[108:111], a[152:155], a[16:19], v[108:111]
ds_read_b64_tr_b16 a[186:187], v189 offset:4096
v_mfma_f32_16x16x32_bf16 v[108:111], a[156:159], a[20:23], v[108:111]
ds_read_b64_tr_b16 a[188:189], v189 offset:8192
v_mfma_f32_16x16x32_bf16 v[140:143], a[156:159], a[28:31], v[140:143]
ds_read_b64_tr_b16 a[190:191], v189 offset:12288
v_mfma_f32_16x16x32_bf16 v[140:143], a[152:155], a[24:27], v[140:143]
v_mfma_f32_16x16x32_bf16 v[144:147], a[160:163], a[24:27], v[144:147]
v_mfma_f32_16x16x32_bf16 v[144:147], a[164:167], a[28:31], v[144:147]
v_mfma_f32_16x16x32_bf16 v[112:115], a[164:167], a[20:23], v[112:115]
ds_read_b64_tr_b16 a[192:193], v190 offset:0
v_mfma_f32_16x16x32_bf16 v[112:115], a[160:163], a[16:19], v[112:115]
ds_read_b64_tr_b16 a[194:195], v190 offset:4096
v_mfma_f32_16x16x32_bf16 v[80:83], a[160:163], a[8:11], v[80:83]
ds_read_b64_tr_b16 a[196:197], v190 offset:8192
v_mfma_f32_16x16x32_bf16 v[80:83], a[164:167], a[12:15], v[80:83]
ds_read_b64_tr_b16 a[198:199], v190 offset:12288
v_mfma_f32_16x16x32_bf16 v[48:51], a[164:167], a[4:7], v[48:51]
v_mfma_f32_16x16x32_bf16 v[48:51], a[160:163], a[0:3], v[48:51]
s_waitcnt lgkmcnt(4)
v_mfma_f32_16x16x32_bf16 v[52:55], a[168:171], a[0:3], v[52:55]
v_mfma_f32_16x16x32_bf16 v[52:55], a[172:175], a[4:7], v[52:55]
v_mfma_f32_16x16x32_bf16 v[84:87], a[172:175], a[12:15], v[84:87]
ds_read_b64_tr_b16 a[200:201], v191 offset:0
v_mfma_f32_16x16x32_bf16 v[84:87], a[168:171], a[8:11], v[84:87]
ds_read_b64_tr_b16 a[202:203], v191 offset:4096
v_mfma_f32_16x16x32_bf16 v[116:119], a[168:171], a[16:19], v[116:119]
ds_read_b64_tr_b16 a[204:205], v191 offset:8192
v_mfma_f32_16x16x32_bf16 v[116:119], a[172:175], a[20:23], v[116:119]
ds_read_b64_tr_b16 a[206:207], v191 offset:12288
v_mfma_f32_16x16x32_bf16 v[148:151], a[172:175], a[28:31], v[148:151]
v_mfma_f32_16x16x32_bf16 v[148:151], a[168:171], a[24:27], v[148:151]
s_waitcnt vmcnt(4)
v_mfma_f32_16x16x32_bf16 v[136:139], a[176:179], a[56:59], v[136:139]
s_waitcnt vmcnt(0)
v_mfma_f32_16x16x32_bf16 v[136:139], a[180:183], a[60:63], v[136:139]
v_mfma_f32_16x16x32_bf16 v[104:107], a[180:183], a[52:55], v[104:107]
ds_read_b64_tr_b16 a[144:145], v192 offset:32768
v_mfma_f32_16x16x32_bf16 v[104:107], a[176:179], a[48:51], v[104:107]
ds_read_b64_tr_b16 a[146:147], v192 offset:36864
v_mfma_f32_16x16x32_bf16 v[72:75], a[176:179], a[40:43], v[72:75]
ds_read_b64_tr_b16 a[148:149], v192 offset:40960
v_mfma_f32_16x16x32_bf16 v[72:75], a[180:183], a[44:47], v[72:75]
ds_read_b64_tr_b16 a[150:151], v192 offset:45056
v_mfma_f32_16x16x32_bf16 v[40:43], a[180:183], a[36:39], v[40:43]
v_mfma_f32_16x16x32_bf16 v[40:43], a[176:179], a[32:35], v[40:43]
v_mfma_f32_16x16x32_bf16 v[44:47], a[184:187], a[32:35], v[44:47]
v_mfma_f32_16x16x32_bf16 v[44:47], a[188:191], a[36:39], v[44:47]
ds_write_b128 v3, v[136:139] offset:4096
v_mfma_f32_16x16x32_bf16 v[76:79], a[188:191], a[44:47], v[76:79]
ds_read_b64_tr_b16 a[152:153], v193 offset:32768
v_mfma_f32_16x16x32_bf16 v[76:79], a[184:187], a[40:43], v[76:79]
ds_write_b128 v3, v[104:107] offset:0
v_mfma_f32_16x16x32_bf16 v[108:111], a[184:187], a[48:51], v[108:111]
ds_read_b64_tr_b16 a[154:155], v193 offset:36864
v_mfma_f32_16x16x32_bf16 v[108:111], a[188:191], a[52:55], v[108:111]
ds_read_b64_tr_b16 a[156:157], v193 offset:40960
v_mfma_f32_16x16x32_bf16 v[140:143], a[188:191], a[60:63], v[140:143]
ds_read_b64_tr_b16 a[158:159], v193 offset:45056
v_mfma_f32_16x16x32_bf16 v[140:143], a[184:187], a[56:59], v[140:143]
s_waitcnt lgkmcnt(6)
v_mfma_f32_16x16x32_bf16 v[144:147], a[192:195], a[56:59], v[144:147]
v_mfma_f32_16x16x32_bf16 v[144:147], a[196:199], a[60:63], v[144:147]
v_mfma_f32_16x16x32_bf16 v[112:115], a[196:199], a[52:55], v[112:115]
ds_read_b64_tr_b16 a[160:161], v194 offset:32768
v_mfma_f32_16x16x32_bf16 v[112:115], a[192:195], a[48:51], v[112:115]
ds_read_b64_tr_b16 a[162:163], v194 offset:36864
v_mfma_f32_16x16x32_bf16 v[80:83], a[192:195], a[40:43], v[80:83]
ds_read_b64_tr_b16 a[164:165], v194 offset:40960
v_mfma_f32_16x16x32_bf16 v[80:83], a[196:199], a[44:47], v[80:83]
ds_write_b128 v3, v[108:111] offset:1024
v_mfma_f32_16x16x32_bf16 v[48:51], a[196:199], a[36:39], v[48:51]
ds_read_b64_tr_b16 a[166:167], v194 offset:45056
v_mfma_f32_16x16x32_bf16 v[48:51], a[192:195], a[32:35], v[48:51]
ds_write_b128 v3, v[140:143] offset:5120
v_mfma_f32_16x16x32_bf16 v[52:55], a[200:203], a[32:35], v[52:55]
v_mfma_f32_16x16x32_bf16 v[52:55], a[204:207], a[36:39], v[52:55]
ds_write_b128 v3, v[144:147] offset:6144
v_mfma_f32_16x16x32_bf16 v[84:87], a[204:207], a[44:47], v[84:87]
ds_read_b64_tr_b16 a[168:169], v195 offset:32768
v_mfma_f32_16x16x32_bf16 v[84:87], a[200:203], a[40:43], v[84:87]
ds_write_b128 v3, v[112:115] offset:2048
v_mfma_f32_16x16x32_bf16 v[116:119], a[200:203], a[48:51], v[116:119]
ds_read_b64_tr_b16 a[170:171], v195 offset:36864
v_mfma_f32_16x16x32_bf16 v[116:119], a[204:207], a[52:55], v[116:119]
ds_read_b64_tr_b16 a[172:173], v195 offset:40960
v_mfma_f32_16x16x32_bf16 v[148:151], a[204:207], a[60:63], v[148:151]
ds_read_b64_tr_b16 a[174:175], v195 offset:45056
v_mfma_f32_16x16x32_bf16 v[148:151], a[200:203], a[56:59], v[148:151]
v_mfma_f32_16x16x32_bf16 v[120:123], a[144:147], a[24:27], v[120:123]
v_mfma_f32_16x16x32_bf16 v[120:123], a[148:151], a[28:31], v[120:123]
v_mfma_f32_16x16x32_bf16 v[88:91], a[148:151], a[20:23], v[88:91]
ds_read_b64_tr_b16 a[176:177], v184 offset:0
v_mfma_f32_16x16x32_bf16 v[88:91], a[144:147], a[16:19], v[88:91]
ds_read_b64_tr_b16 a[178:179], v184 offset:4096
v_mfma_f32_16x16x32_bf16 v[56:59], a[144:147], a[8:11], v[56:59]
ds_read_b64_tr_b16 a[180:181], v184 offset:8192
v_mfma_f32_16x16x32_bf16 v[56:59], a[148:151], a[12:15], v[56:59]
ds_write_b128 v3, v[116:119] offset:3072
v_mfma_f32_16x16x32_bf16 v[24:27], a[148:151], a[4:7], v[24:27]
ds_read_b64_tr_b16 a[182:183], v184 offset:12288
v_mfma_f32_16x16x32_bf16 v[24:27], a[144:147], a[0:3], v[24:27]
s_waitcnt lgkmcnt(5)
ds_write_b128 v3, v[148:151] offset:7168
v_mfma_f32_16x16x32_bf16 v[28:31], a[152:155], a[0:3], v[28:31]
v_mfma_f32_16x16x32_bf16 v[28:31], a[156:159], a[4:7], v[28:31]
v_mfma_f32_16x16x32_bf16 v[60:63], a[156:159], a[12:15], v[60:63]
s_waitcnt lgkmcnt(0)
s_barrier
v_mfma_f32_16x16x32_bf16 v[60:63], a[152:155], a[8:11], v[60:63]
ds_read_b128 v[200:203], v2 offset:0
ds_read_b128 v[204:207], v2 offset:1024
v_mfma_f32_16x16x32_bf16 v[92:95], a[152:155], a[16:19], v[92:95]
ds_read_b128 v[208:211], v2 offset:2048
ds_read_b128 v[212:215], v2 offset:3072
v_mfma_f32_16x16x32_bf16 v[92:95], a[156:159], a[20:23], v[92:95]
ds_read_b128 v[216:219], v2 offset:4096
ds_read_b128 v[220:223], v2 offset:5120
v_mfma_f32_16x16x32_bf16 v[124:127], a[156:159], a[28:31], v[124:127]
ds_read_b128 v[224:227], v2 offset:6144
ds_read_b128 v[228:231], v2 offset:7168
v_mfma_f32_16x16x32_bf16 v[124:127], a[152:155], a[24:27], v[124:127]
ds_read_b64_tr_b16 a[184:185], v185 offset:0
v_mfma_f32_16x16x32_bf16 v[128:131], a[160:163], a[24:27], v[128:131]
ds_read_b64_tr_b16 a[186:187], v185 offset:4096
v_mfma_f32_16x16x32_bf16 v[128:131], a[164:167], a[28:31], v[128:131]
ds_read_b64_tr_b16 a[188:189], v185 offset:8192
v_mfma_f32_16x16x32_bf16 v[96:99], a[164:167], a[20:23], v[96:99]
s_waitcnt lgkmcnt(10)
ds_read_b64_tr_b16 a[190:191], v185 offset:12288
v_add_f32 v200, v200, v40
v_mfma_f32_16x16x32_bf16 v[96:99], a[160:163], a[16:19], v[96:99]
ds_read_b64_tr_b16 a[192:193], v186 offset:0
v_add_f32 v201, v201, v41
v_mfma_f32_16x16x32_bf16 v[64:67], a[160:163], a[8:11], v[64:67]
ds_read_b64_tr_b16 a[194:195], v186 offset:4096
v_add_f32 v202, v202, v42
v_mfma_f32_16x16x32_bf16 v[64:67], a[164:167], a[12:15], v[64:67]
ds_read_b64_tr_b16 a[196:197], v186 offset:8192
v_add_f32 v203, v203, v43
v_mfma_f32_16x16x32_bf16 v[32:35], a[164:167], a[4:7], v[32:35]
s_waitcnt lgkmcnt(7)
ds_read_b64_tr_b16 a[198:199], v186 offset:12288
v_add_f32 v204, v204, v44
v_mfma_f32_16x16x32_bf16 v[32:35], a[160:163], a[0:3], v[32:35]
v_add_f32 v205, v205, v45
v_add_f32 v206, v206, v46
v_mfma_f32_16x16x32_bf16 v[36:39], a[168:171], a[0:3], v[36:39]
v_add_f32 v207, v207, v47
v_cvt_pk_bf16_f32 v200, v200, v201
v_mfma_f32_16x16x32_bf16 v[36:39], a[172:175], a[4:7], v[36:39]
v_cvt_pk_bf16_f32 v201, v202, v203
v_cvt_pk_bf16_f32 v202, v204, v205
v_cvt_pk_bf16_f32 v203, v206, v207
v_mfma_f32_16x16x32_bf16 v[68:71], a[172:175], a[12:15], v[68:71]
buffer_store_dwordx4 v[200:203], v16, s[44:47], s73 offen offset:0 sc1
v_mfma_f32_16x16x32_bf16 v[68:71], a[168:171], a[8:11], v[68:71]
ds_read_b64_tr_b16 a[200:201], v187 offset:0
v_add_f32 v208, v208, v48
v_mfma_f32_16x16x32_bf16 v[100:103], a[168:171], a[16:19], v[100:103]
ds_read_b64_tr_b16 a[202:203], v187 offset:4096
v_add_f32 v209, v209, v49
v_mfma_f32_16x16x32_bf16 v[100:103], a[172:175], a[20:23], v[100:103]
ds_read_b64_tr_b16 a[204:205], v187 offset:8192
v_add_f32 v210, v210, v50
v_mfma_f32_16x16x32_bf16 v[132:135], a[172:175], a[28:31], v[132:135]
ds_read_b64_tr_b16 a[206:207], v187 offset:12288
v_add_f32 v211, v211, v51
v_mfma_f32_16x16x32_bf16 v[132:135], a[168:171], a[24:27], v[132:135]
v_add_f32 v212, v212, v52
v_add_f32 v213, v213, v53
v_mfma_f32_16x16x32_bf16 v[120:123], a[176:179], a[56:59], v[120:123]
v_add_f32 v214, v214, v54
v_add_f32 v215, v215, v55
v_mfma_f32_16x16x32_bf16 v[120:123], a[180:183], a[60:63], v[120:123]
v_cvt_pk_bf16_f32 v208, v208, v209
v_cvt_pk_bf16_f32 v209, v210, v211
v_cvt_pk_bf16_f32 v210, v212, v213
v_cvt_pk_bf16_f32 v211, v214, v215
v_mfma_f32_16x16x32_bf16 v[88:91], a[180:183], a[52:55], v[88:91]
buffer_store_dwordx4 v[208:211], v16, s[44:47], s73 offen offset:1024 sc1
v_mfma_f32_16x16x32_bf16 v[88:91], a[176:179], a[48:51], v[88:91]
v_add_f32 v216, v216, v72
v_add_f32 v217, v217, v73
v_mfma_f32_16x16x32_bf16 v[56:59], a[176:179], a[40:43], v[56:59]
v_add_f32 v218, v218, v74
v_add_f32 v219, v219, v75
v_mfma_f32_16x16x32_bf16 v[56:59], a[180:183], a[44:47], v[56:59]
s_branch L_po23
L_pg23:
s_branch L_tr1
L_po23:
v_add_f32 v220, v220, v76
v_add_f32 v221, v221, v77
v_mfma_f32_16x16x32_bf16 v[24:27], a[180:183], a[36:39], v[24:27]
v_add_f32 v222, v222, v78
v_add_f32 v223, v223, v79
v_mfma_f32_16x16x32_bf16 v[24:27], a[176:179], a[32:35], v[24:27]
s_waitcnt lgkmcnt(0)
v_cvt_pk_bf16_f32 v216, v216, v217
v_cvt_pk_bf16_f32 v217, v218, v219
v_mfma_f32_16x16x32_bf16 v[28:31], a[184:187], a[32:35], v[28:31]
v_cvt_pk_bf16_f32 v218, v220, v221
v_cvt_pk_bf16_f32 v219, v222, v223
v_mfma_f32_16x16x32_bf16 v[28:31], a[188:191], a[36:39], v[28:31]
buffer_store_dwordx4 v[216:219], v16, s[44:47], s73 offen offset:2048 sc1
v_mfma_f32_16x16x32_bf16 v[60:63], a[188:191], a[44:47], v[60:63]
v_add_f32 v224, v224, v80
v_add_f32 v225, v225, v81
v_mfma_f32_16x16x32_bf16 v[60:63], a[184:187], a[40:43], v[60:63]
v_add_f32 v226, v226, v82
v_add_f32 v227, v227, v83
v_mfma_f32_16x16x32_bf16 v[92:95], a[184:187], a[48:51], v[92:95]
v_add_f32 v228, v228, v84
v_add_f32 v229, v229, v85
v_mfma_f32_16x16x32_bf16 v[92:95], a[188:191], a[52:55], v[92:95]
v_add_f32 v230, v230, v86
v_add_f32 v231, v231, v87
v_mfma_f32_16x16x32_bf16 v[124:127], a[188:191], a[60:63], v[124:127]
v_cvt_pk_bf16_f32 v224, v224, v225
v_cvt_pk_bf16_f32 v225, v226, v227
v_mfma_f32_16x16x32_bf16 v[124:127], a[184:187], a[56:59], v[124:127]
v_cvt_pk_bf16_f32 v226, v228, v229
v_cvt_pk_bf16_f32 v227, v230, v231
v_mfma_f32_16x16x32_bf16 v[128:131], a[192:195], a[56:59], v[128:131]
buffer_store_dwordx4 v[224:227], v16, s[44:47], s73 offen offset:3072 sc1
v_mfma_f32_16x16x32_bf16 v[128:131], a[196:199], a[60:63], v[128:131]
ds_write_b128 v3, v[120:123] offset:36864
v_mfma_f32_16x16x32_bf16 v[96:99], a[196:199], a[52:55], v[96:99]
ds_write_b128 v3, v[88:91] offset:32768
v_mfma_f32_16x16x32_bf16 v[96:99], a[192:195], a[48:51], v[96:99]
v_mfma_f32_16x16x32_bf16 v[64:67], a[192:195], a[40:43], v[64:67]
v_mfma_f32_16x16x32_bf16 v[64:67], a[196:199], a[44:47], v[64:67]
ds_write_b128 v3, v[92:95] offset:33792
v_mfma_f32_16x16x32_bf16 v[32:35], a[196:199], a[36:39], v[32:35]
v_mfma_f32_16x16x32_bf16 v[32:35], a[192:195], a[32:35], v[32:35]
ds_write_b128 v3, v[124:127] offset:37888
v_mfma_f32_16x16x32_bf16 v[36:39], a[200:203], a[32:35], v[36:39]
v_mfma_f32_16x16x32_bf16 v[36:39], a[204:207], a[36:39], v[36:39]
ds_write_b128 v3, v[128:131] offset:38912
v_mfma_f32_16x16x32_bf16 v[68:71], a[204:207], a[44:47], v[68:71]
v_mfma_f32_16x16x32_bf16 v[68:71], a[200:203], a[40:43], v[68:71]
ds_write_b128 v3, v[96:99] offset:34816
v_mfma_f32_16x16x32_bf16 v[100:103], a[200:203], a[48:51], v[100:103]
v_mfma_f32_16x16x32_bf16 v[100:103], a[204:207], a[52:55], v[100:103]
v_mfma_f32_16x16x32_bf16 v[132:135], a[204:207], a[60:63], v[132:135]
v_mfma_f32_16x16x32_bf16 v[132:135], a[200:203], a[56:59], v[132:135]
buffer_load_dwordx4 v[152:155], v16, s[44:47], s75 offen offset:0 sc1
buffer_load_dwordx4 v[156:159], v16, s[44:47], s75 offen offset:1024 sc1
buffer_load_dwordx4 v[160:163], v16, s[44:47], s75 offen offset:2048 sc1
buffer_load_dwordx4 v[164:167], v16, s[44:47], s75 offen offset:3072 sc1
s_nop 3
ds_write_b128 v3, v[100:103] offset:35840
ds_write_b128 v3, v[132:135] offset:39936
s_mov_b32 s72, 0x20000
s_waitcnt lgkmcnt(0)
s_barrier
ds_read_b128 v[88:91], v2 offset:32768
ds_read_b128 v[92:95], v2 offset:33792
ds_read_b128 v[96:99], v2 offset:34816
ds_read_b128 v[100:103], v2 offset:35840
ds_read_b128 v[120:123], v2 offset:36864
ds_read_b128 v[124:127], v2 offset:37888
ds_read_b128 v[128:131], v2 offset:38912
ds_read_b128 v[132:135], v2 offset:39936
s_waitcnt lgkmcnt(7)
v_add_f32 v24, v24, v88
v_add_f32 v25, v25, v89
v_add_f32 v26, v26, v90
v_add_f32 v27, v27, v91
s_waitcnt lgkmcnt(6)
v_add_f32 v28, v28, v92
v_add_f32 v29, v29, v93
v_add_f32 v30, v30, v94
v_add_f32 v31, v31, v95
s_waitcnt lgkmcnt(5)
v_add_f32 v32, v32, v96
v_add_f32 v33, v33, v97
v_add_f32 v34, v34, v98
v_add_f32 v35, v35, v99
s_waitcnt lgkmcnt(4)
v_add_f32 v36, v36, v100
v_add_f32 v37, v37, v101
v_add_f32 v38, v38, v102
v_add_f32 v39, v39, v103
s_waitcnt lgkmcnt(3)
v_add_f32 v56, v56, v120
v_add_f32 v57, v57, v121
v_add_f32 v58, v58, v122
v_add_f32 v59, v59, v123
s_waitcnt lgkmcnt(2)
v_add_f32 v60, v60, v124
v_add_f32 v61, v61, v125
v_add_f32 v62, v62, v126
v_add_f32 v63, v63, v127
s_waitcnt lgkmcnt(1)
v_add_f32 v64, v64, v128
v_add_f32 v65, v65, v129
v_add_f32 v66, v66, v130
v_add_f32 v67, v67, v131
s_waitcnt lgkmcnt(0)
v_add_f32 v68, v68, v132
v_add_f32 v69, v69, v133
v_add_f32 v70, v70, v134
v_add_f32 v71, v71, v135
L_xchk:
s_waitcnt vmcnt(0)
v_max3_u32 v9, v152, v153, v154
v_max3_u32 v9, v9, v155, v156
v_max3_u32 v9, v9, v157, v158
v_max3_u32 v9, v9, v159, v160
v_max3_u32 v9, v9, v161, v162
v_max3_u32 v9, v9, v163, v164
v_max3_u32 v9, v9, v165, v166
v_max_u32 v9, v9, v167
v_cmp_eq_u32 vcc, -1, v9
s_cbranch_vccnz L_xretry
L_xgo:
v_mfma_f32_16x16x32_bf16 v[24:27], v[234:237], v[152:155], v[24:27]
v_mfma_f32_16x16x32_bf16 v[28:31], v[232:235], v[152:155], v[28:31]
v_mfma_f32_16x16x32_bf16 v[32:35], v[234:237], v[156:159], v[32:35]
v_mfma_f32_16x16x32_bf16 v[36:39], v[232:235], v[156:159], v[36:39]
v_mfma_f32_16x16x32_bf16 v[56:59], v[234:237], v[160:163], v[56:59]
v_mfma_f32_16x16x32_bf16 v[60:63], v[232:235], v[160:163], v[60:63]
v_mfma_f32_16x16x32_bf16 v[64:67], v[234:237], v[164:167], v[64:67]
v_mfma_f32_16x16x32_bf16 v[68:71], v[232:235], v[164:167], v[68:71]
s_nop 1
v_cvt_pk_bf16_f32 v24, v24, v25
v_cvt_pk_bf16_f32 v25, v26, v27
v_cvt_pk_bf16_f32 v26, v28, v29
v_cvt_pk_bf16_f32 v27, v30, v31
v_cvt_pk_bf16_f32 v32, v32, v33
v_cvt_pk_bf16_f32 v33, v34, v35
v_cvt_pk_bf16_f32 v34, v36, v37
v_cvt_pk_bf16_f32 v35, v38, v39
v_permlane16_swap_b32 v24, v26
v_permlane16_swap_b32 v25, v27
v_permlane16_swap_b32 v32, v34
v_permlane16_swap_b32 v33, v35
v_mov_b32 v28, v24
v_mov_b32 v29, v25
v_mov_b32 v30, v26
v_mov_b32 v31, v27
v_mov_b32_dpp v24, v32 row_ror:8 row_mask:0xf bank_mask:0xc
v_mov_b32_dpp v25, v33 row_ror:8 row_mask:0xf bank_mask:0xc
v_mov_b32_dpp v26, v34 row_ror:8 row_mask:0xf bank_mask:0xc
v_mov_b32_dpp v27, v35 row_ror:8 row_mask:0xf bank_mask:0xc
v_mov_b32_dpp v32, v28 row_ror:8 row_mask:0xf bank_mask:0x3
v_mov_b32_dpp v33, v29 row_ror:8 row_mask:0xf bank_mask:0x3
v_mov_b32_dpp v34, v30 row_ror:8 row_mask:0xf bank_mask:0x3
v_mov_b32_dpp v35, v31 row_ror:8 row_mask:0xf bank_mask:0x3
buffer_store_dwordx4 v[24:27], v8, s[48:51], s77 offen sc1
s_add_u32 s77, s77, 16384
buffer_store_dwordx4 v[32:35], v8, s[48:51], s77 offen sc1
s_add_u32 s77, s77, 16384
v_cvt_pk_bf16_f32 v56, v56, v57
v_cvt_pk_bf16_f32 v57, v58, v59
v_cvt_pk_bf16_f32 v58, v60, v61
v_cvt_pk_bf16_f32 v59, v62, v63
v_cvt_pk_bf16_f32 v64, v64, v65
v_cvt_pk_bf16_f32 v65, v66, v67
v_cvt_pk_bf16_f32 v66, v68, v69
v_cvt_pk_bf16_f32 v67, v70, v71
v_permlane16_swap_b32 v56, v58
v_permlane16_swap_b32 v57, v59
v_permlane16_swap_b32 v64, v66
v_permlane16_swap_b32 v65, v67
v_mov_b32 v60, v56
v_mov_b32 v61, v57
v_mov_b32 v62, v58
v_mov_b32 v63, v59
v_mov_b32_dpp v56, v64 row_ror:8 row_mask:0xf bank_mask:0xc
v_mov_b32_dpp v57, v65 row_ror:8 row_mask:0xf bank_mask:0xc
v_mov_b32_dpp v58, v66 row_ror:8 row_mask:0xf bank_mask:0xc
v_mov_b32_dpp v59, v67 row_ror:8 row_mask:0xf bank_mask:0xc
v_mov_b32_dpp v64, v60 row_ror:8 row_mask:0xf bank_mask:0x3
v_mov_b32_dpp v65, v61 row_ror:8 row_mask:0xf bank_mask:0x3
v_mov_b32_dpp v66, v62 row_ror:8 row_mask:0xf bank_mask:0x3
v_mov_b32_dpp v67, v63 row_ror:8 row_mask:0xf bank_mask:0x3
buffer_store_dwordx4 v[56:59], v8, s[48:51], s77 offen sc1
s_add_u32 s77, s77, 16384
buffer_store_dwordx4 v[64:67], v8, s[48:51], s77 offen sc1
s_add_u32 s77, s77, 16384
L_end:
s_endpgm
L_xretry:
s_sub_u32 s72, s72, 1
s_cbranch_scc1 L_xgo
buffer_load_dwordx4 v[152:155], v16, s[44:47], s75 offen offset:0 sc1
buffer_load_dwordx4 v[156:159], v16, s[44:47], s75 offen offset:1024 sc1
buffer_load_dwordx4 v[160:163], v16, s[44:47], s75 offen offset:2048 sc1
buffer_load_dwordx4 v[164:167], v16, s[44:47], s75 offen offset:3072 sc1
s_branch L_xchk
L_spin_1:
s_mov_b32 vcc_hi, 0x80000
L_spinlp_3:
s_sleep 1
buffer_load_dword v1, off, s[52:55], s78 offset:0 sc1
s_waitcnt vmcnt(0)
v_readfirstlane_b32 vcc_lo, v1
s_sub_u32 vcc_hi, vcc_hi, 1
s_cbranch_scc1 L_spinbk_2
s_cmp_lt_u32 vcc_lo, s81
s_cbranch_scc1 L_spinlp_3
s_branch L_spinbk_2
L_spin_4:
s_mov_b32 vcc_hi, 0x80000
L_spinlp_6:
s_sleep 1
buffer_load_dword v1, off, s[52:55], s70 offset:0 sc1
s_waitcnt vmcnt(0)
v_readfirstlane_b32 vcc_lo, v1
s_sub_u32 vcc_hi, vcc_hi, 1
s_cbranch_scc1 L_spinbk_5
s_cmp_lt_u32 vcc_lo, s81
s_cbranch_scc1 L_spinlp_6
s_branch L_spinbk_5
L_hretry:
s_sub_u32 s72, s72, 1
s_cbranch_scc1 L_hgo
buffer_load_dwordx4 v[88:91], v16, s[44:47], s77 offen sc1
s_waitcnt vmcnt(0)
s_branch L_hchk
L_spin_8:
s_mov_b32 vcc_hi, 0x80000
L_spinlp_10:
s_sleep 1
buffer_load_dword v19, off, s[52:55], s80 offset:0 sc1
s_waitcnt vmcnt(0)
v_readfirstlane_b32 vcc_lo, v19
s_sub_u32 vcc_hi, vcc_hi, 1
s_cbranch_scc1 L_spinbk_9
s_cmp_lt_u32 vcc_lo, s69
s_cbranch_scc1 L_spinlp_10
s_branch L_spinbk_9
L_spin_1012:
s_mov_b32 vcc_hi, 0x80000
L_spinlp_1014:
s_sleep 1
buffer_load_dword v19, off, s[52:55], s80 offset:0 sc1
s_waitcnt vmcnt(0)
v_readfirstlane_b32 vcc_lo, v19
s_sub_u32 vcc_hi, vcc_hi, 1
s_cbranch_scc1 L_spinbk_1013
s_cmp_lt_u32 vcc_lo, s69
s_cbranch_scc1 L_spinlp_1014
s_branch L_spinbk_1013
L_F1:
ds_read_b128 a[144:147], v2 offset:0
ds_read_b128 a[148:151], v2 offset:1024
ds_read_b128 a[152:155], v2 offset:2048
ds_read_b128 a[156:159], v2 offset:3072
ds_read_b128 a[160:163], v2 offset:4096
ds_read_b128 a[164:167], v2 offset:5120
ds_read_b128 a[168:171], v2 offset:6144
ds_read_b128 a[172:175], v2 offset:7168
s_mov_b32 m0, s71
s_nop 0
buffer_load_dwordx4 v16, s[32:35], s70 offen offset:0 sc1 lds
buffer_load_dwordx4 v16, s[32:35], s70 offen offset:1024 sc1 lds
s_waitcnt lgkmcnt(7)
v_mfma_f32_16x16x32_bf16 v[104:107], a[144:147], v[40:43], 0
s_waitcnt lgkmcnt(6)
ds_read_b128 a[176:179], v2 offset:8192
v_cndmask_b32 v88, 0, v17, s[0:1]
v_mfma_f32_16x16x32_bf16 v[104:107], a[148:151], v[44:47], v[104:107]
s_waitcnt lgkmcnt(6)
ds_read_b128 a[180:183], v2 offset:9216
v_cndmask_b32 v89, 0, v17, s[4:5]
v_mfma_f32_16x16x32_bf16 v[104:107], a[152:155], v[48:51], v[104:107]
s_waitcnt lgkmcnt(6)
buffer_load_dwordx4 v16, s[32:35], s70 offen offset:2048 sc1 lds
v_mfma_f32_16x16x32_bf16 v[104:107], a[156:159], v[52:55], v[104:107]
ds_read_b128 a[184:187], v2 offset:10240
v_cndmask_b32 v90, 0, v17, s[6:7]
v_mfma_f32_16x16x32_bf16 v[120:123], a[156:159], v[68:71], 0
ds_read_b128 a[188:191], v2 offset:11264
v_cndmask_b32 v91, 0, v17, s[8:9]
v_mfma_f32_16x16x32_bf16 v[120:123], a[152:155], v[64:67], v[120:123]
ds_read_b128 a[192:195], v2 offset:12288
v_accvgpr_write_b32 a128, 0
v_mfma_f32_16x16x32_bf16 v[120:123], a[148:151], v[60:63], v[120:123]
ds_read_b128 a[196:199], v2 offset:13312
v_accvgpr_write_b32 a129, 0
v_mfma_f32_16x16x32_bf16 v[120:123], a[144:147], v[56:59], v[120:123]
ds_read_b128 a[200:203], v2 offset:14336
v_accvgpr_write_b32 a130, 0
v_mfma_f32_16x16x32_bf16 v[136:139], a[144:147], v[72:75], 0
ds_read_b128 a[204:207], v2 offset:15360
v_accvgpr_write_b32 a131, 0
v_mfma_f32_16x16x32_bf16 v[136:139], a[148:151], v[76:79], v[136:139]
buffer_load_dwordx4 v16, s[32:35], s70 offen offset:3072 sc1 lds
v_mfma_f32_16x16x32_bf16 v[136:139], a[152:155], v[80:83], v[136:139]
v_accvgpr_write_b32 a132, 0
v_accvgpr_write_b32 a133, 0
v_mfma_f32_16x16x32_bf16 v[136:139], a[156:159], v[84:87], v[136:139]
v_accvgpr_write_b32 a134, 0
v_accvgpr_write_b32 a135, 0
v_mfma_f32_16x16x32_bf16 v[88:91], a[156:159], v[36:39], v[88:91]
v_accvgpr_write_b32 a136, 0
v_accvgpr_write_b32 a137, 0
v_mfma_f32_16x16x32_bf16 v[88:91], a[152:155], v[32:35], v[88:91]
v_accvgpr_write_b32 a138, 0
v_accvgpr_write_b32 a139, 0
v_mfma_f32_16x16x32_bf16 v[88:91], a[148:151], v[28:31], v[88:91]
v_accvgpr_write_b32 a140, 0
v_accvgpr_write_b32 a141, 0
v_mfma_f32_16x16x32_bf16 v[88:91], a[144:147], v[24:27], v[88:91]
s_waitcnt lgkmcnt(0)
s_nop 1
v_max3_f32 v21, v104, v105, v106
v_max_f32 v21, v21, v107
v_max3_f32 v22, v120, v121, v122
v_max_f32 v22, v22, v123
v_max3_f32 v23, v136, v137, v138
v_max_f32 v23, v23, v139
v_max3_f32 v20, v88, v89, v90
v_max_f32 v20, v20, v91
v_mov_b32 v248, v20
v_mov_b32 v249, v21
v_mov_b32 v250, v22
v_mov_b32 v251, v23
v_permlane16_swap_b32 v248, v20
v_permlane16_swap_b32 v249, v21
v_permlane16_swap_b32 v250, v22
v_permlane16_swap_b32 v251, v23
v_max_f32 v20, v20, v248
v_max_f32 v21, v21, v249
v_max_f32 v22, v22, v250
v_max_f32 v23, v23, v251
v_mov_b32 v248, v20
v_mov_b32 v249, v21
v_mov_b32 v250, v22
v_mov_b32 v251, v23
v_permlane32_swap_b32 v248, v20
v_permlane32_swap_b32 v249, v21
v_permlane32_swap_b32 v250, v22
v_permlane32_swap_b32 v251, v23
v_max_f32 v20, v20, v248
v_max_f32 v21, v21, v249
v_max_f32 v22, v22, v250
v_max_f32 v23, v23, v251
s_cmp_eq_u32 s73, 0
s_cselect_b64 vcc, 0, -1
v_cndmask_b32 v20, v20, v252, vcc
v_cndmask_b32 v21, v21, v253, vcc
v_cndmask_b32 v22, v22, v254, vcc
v_cndmask_b32 v23, v23, v255, vcc
v_sub_f32 v228, 0, v23
v_sub_f32 v229, 0, v23
v_sub_f32 v230, 0, v23
v_sub_f32 v231, 0, v23
v_sub_f32 v224, 0, v22
v_sub_f32 v225, 0, v22
v_sub_f32 v226, 0, v22
v_sub_f32 v227, 0, v22
v_sub_f32 v220, 0, v21
v_sub_f32 v221, 0, v21
v_sub_f32 v222, 0, v21
v_sub_f32 v223, 0, v21
v_sub_f32 v216, 0, v20
v_sub_f32 v217, 0, v20
v_sub_f32 v218, 0, v20
v_sub_f32 v219, 0, v20
v_mfma_f32_16x16x32_bf16 v[140:143], a[160:163], v[72:75], v[228:231]
s_add_u32 m0, s71, 4096
v_add_f32 v104, v104, v220
v_add_f32 v105, v105, v220
v_mfma_f32_16x16x32_bf16 v[140:143], a[164:167], v[76:79], v[140:143]
v_add_f32 v106, v106, v220
v_add_f32 v107, v107, v220
v_exp_f32 v104, v104
v_mfma_f32_16x16x32_bf16 v[140:143], a[168:171], v[80:83], v[140:143]
s_add_u32 s64, s70, 4096
v_exp_f32 v105, v105
v_mfma_f32_16x16x32_bf16 v[140:143], a[172:175], v[84:87], v[140:143]
buffer_load_dwordx4 v16, s[32:35], s64 offen offset:0 sc1 lds
v_mfma_f32_16x16x32_bf16 v[124:127], a[172:175], v[68:71], v[224:227]
v_exp_f32 v106, v106
v_mfma_f32_16x16x32_bf16 v[124:127], a[168:171], v[64:67], v[124:127]
v_exp_f32 v107, v107
v_mfma_f32_16x16x32_bf16 v[124:127], a[164:167], v[60:63], v[124:127]
v_add_f32 v120, v120, v224
v_add_f32 v121, v121, v224
v_add_f32 v122, v122, v224
v_add_f32 v123, v123, v224
v_exp_f32 v120, v120
v_mfma_f32_16x16x32_bf16 v[124:127], a[160:163], v[56:59], v[124:127]
v_exp_f32 v121, v121
v_mfma_f32_16x16x32_bf16 v[108:111], a[160:163], v[40:43], v[220:223]
v_exp_f32 v122, v122
v_mfma_f32_16x16x32_bf16 v[108:111], a[164:167], v[44:47], v[108:111]
v_cndmask_b32 v92, v216, v17, s[10:11]
v_cndmask_b32 v93, v216, v17, s[12:13]
v_cndmask_b32 v94, v216, v17, s[18:19]
v_cndmask_b32 v95, v216, v17, s[22:23]
v_mfma_f32_16x16x32_bf16 v[108:111], a[168:171], v[48:51], v[108:111]
buffer_load_dwordx4 v16, s[32:35], s64 offen offset:1024 sc1 lds
v_cvt_pk_bf16_f32 v160, v104, v105
v_mfma_f32_16x16x32_bf16 v[108:111], a[172:175], v[52:55], v[108:111]
v_exp_f32 v123, v123
v_mfma_f32_16x16x32_bf16 v[92:95], a[172:175], v[36:39], v[92:95]
v_add_f32 v136, v136, v228
v_add_f32 v137, v137, v228
v_add_f32 v138, v138, v228
v_add_f32 v139, v139, v228
v_exp_f32 v136, v136
v_mfma_f32_16x16x32_bf16 v[92:95], a[168:171], v[32:35], v[92:95]
v_cvt_pk_bf16_f32 v161, v106, v107
v_exp_f32 v137, v137
v_cndmask_b32 v96, v216, v17, s[26:27]
v_cndmask_b32 v97, v216, v17, s[56:57]
v_cndmask_b32 v98, v216, v17, s[58:59]
v_cndmask_b32 v99, v216, v17, s[60:61]
v_mfma_f32_16x16x32_bf16 v[92:95], a[164:167], v[28:31], v[92:95]
v_exp_f32 v138, v138
v_mfma_f32_16x16x32_bf16 v[92:95], a[160:163], v[24:27], v[92:95]
v_exp_f32 v139, v139
v_mfma_f32_16x16x32_bf16 v[96:99], a[176:179], v[24:27], v[96:99]
v_cvt_pk_bf16_f32 v184, v120, v121
v_add_f32 v88, v88, v216
v_mfma_f32_16x16x32_bf16 v[96:99], a[180:183], v[28:31], v[96:99]
buffer_load_dwordx4 v16, s[32:35], s64 offen offset:2048 sc1 lds
v_add_f32 v89, v89, v216
v_add_f32 v90, v90, v216
v_add_f32 v91, v91, v216
v_exp_f32 v88, v88
v_mfma_f32_16x16x32_bf16 v[96:99], a[184:187], v[32:35], v[96:99]
v_exp_f32 v89, v89
v_mfma_f32_16x16x32_bf16 v[96:99], a[188:191], v[36:39], v[96:99]
v_cvt_pk_bf16_f32 v185, v122, v123
v_cvt_pk_bf16_f32 v192, v136, v137
v_mfma_f32_16x16x32_bf16 v[112:115], a[188:191], v[52:55], v[220:223]
v_exp_f32 v90, v90
v_mfma_f32_16x16x32_bf16 v[112:115], a[184:187], v[48:51], v[112:115]
v_exp_f32 v91, v91
v_mfma_f32_16x16x32_bf16 v[112:115], a[180:183], v[44:47], v[112:115]
v_exp_f32 v140, v140
v_mfma_f32_16x16x32_bf16 v[112:115], a[176:179], v[40:43], v[112:115]
v_exp_f32 v141, v141
v_mfma_f32_16x16x32_bf16 v[128:131], a[176:179], v[56:59], v[224:227]
buffer_load_dwordx4 v16, s[32:35], s64 offen offset:3072 sc1 lds
v_cvt_pk_bf16_f32 v193, v138, v139
v_mfma_f32_16x16x32_bf16 v[128:131], a[180:183], v[60:63], v[128:131]
v_exp_f32 v142, v142
v_mfma_f32_16x16x32_bf16 v[128:131], a[184:187], v[64:67], v[128:131]
v_exp_f32 v143, v143
v_mfma_f32_16x16x32_bf16 v[128:131], a[188:191], v[68:71], v[128:131]
v_cvt_pk_bf16_f32 v152, v88, v89
v_cvt_pk_bf16_f32 v153, v90, v91
v_mfma_f32_16x16x32_bf16 v[144:147], a[188:191], v[84:87], v[228:231]
v_exp_f32 v124, v124
v_mfma_f32_16x16x32_bf16 v[144:147], a[184:187], v[80:83], v[144:147]
v_exp_f32 v125, v125
v_mfma_f32_16x16x32_bf16 v[144:147], a[180:183], v[76:79], v[144:147]
s_waitcnt vmcnt(8)
s_barrier
v_mfma_f32_16x16x32_bf16 v[144:147], a[176:179], v[72:75], v[144:147]
v_exp_f32 v126, v126
v_mfma_f32_16x16x32_bf16 v[148:151], a[192:195], v[72:75], v[228:231]
v_cvt_pk_bf16_f32 v194, v140, v141
v_cvt_pk_bf16_f32 v195, v142, v143
v_mfma_f32_16x16x32_bf16 v[148:151], a[196:199], v[76:79], v[148:151]
v_exp_f32 v127, v127
v_mfma_f32_16x16x32_bf16 v[148:151], a[200:203], v[80:83], v[148:151]
s_xor_b32 s71, s71, 16384
v_exp_f32 v108, v108
v_mfma_f32_16x16x32_bf16 v[148:151], a[204:207], v[84:87], v[148:151]
s_add_u32 s70, s70, 32768
v_exp_f32 v109, v109
v_mfma_f32_16x16x32_bf16 v[132:135], a[204:207], v[68:71], v[224:227]
s_mov_b32 m0, s71
v_exp_f32 v110, v110
v_mfma_f32_16x16x32_bf16 v[132:135], a[200:203], v[64:67], v[132:135]
buffer_load_dwordx4 v16, s[32:35], s70 offen offset:0 sc1 lds
v_mfma_f32_16x16x32_bf16 v[132:135], a[196:199], v[60:63], v[132:135]
v_cvt_pk_bf16_f32 v186, v124, v125
v_exp_f32 v111, v111
v_mfma_f32_16x16x32_bf16 v[132:135], a[192:195], v[56:59], v[132:135]
v_exp_f32 v92, v92
v_mfma_f32_16x16x32_bf16 v[116:119], a[192:195], v[40:43], v[220:223]
ds_read_b128 a[144:147], v2 offset:16384
v_cndmask_b32 v100, v216, v17, s[62:63]
v_mfma_f32_16x16x32_bf16 v[116:119], a[196:199], v[44:47], v[116:119]
ds_read_b128 a[148:151], v2 offset:17408
v_cndmask_b32 v101, v216, v17, s[48:49]
v_cndmask_b32 v102, v216, v17, s[50:51]
v_cndmask_b32 v103, v216, v17, s[100:101]
v_cvt_pk_bf16_f32 v187, v126, v127
v_exp_f32 v93, v93
v_mfma_f32_16x16x32_bf16 v[116:119], a[200:203], v[48:51], v[116:119]
v_exp_f32 v94, v94
v_mfma_f32_16x16x32_bf16 v[116:119], a[204:207], v[52:55], v[116:119]
ds_read_b128 a[152:155], v2 offset:18432
v_cvt_pk_bf16_f32 v162, v108, v109
v_mfma_f32_16x16x32_bf16 v[100:103], a[204:207], v[36:39], v[100:103]
buffer_load_dwordx4 v16, s[32:35], s70 offen offset:1024 sc1 lds
v_exp_f32 v95, v95
v_mfma_f32_16x16x32_bf16 v[100:103], a[200:203], v[32:35], v[100:103]
ds_read_b128 a[156:159], v2 offset:19456
v_exp_f32 v96, v96
v_mfma_f32_16x16x32_bf16 v[100:103], a[196:199], v[28:31], v[100:103]
v_cvt_pk_bf16_f32 v163, v110, v111
v_exp_f32 v97, v97
v_mfma_f32_16x16x32_bf16 v[100:103], a[192:195], v[24:27], v[100:103]
s_waitcnt lgkmcnt(2)
ds_read_b128 a[160:163], v2 offset:20480
ds_read_b128 a[164:167], v2 offset:21504
ds_read_b128 a[168:171], v2 offset:22528
ds_read_b128 a[172:175], v2 offset:23552
v_mfma_f32_16x16x32_bf16 v[120:123], a[144:147], v[56:59], v[224:227]
v_exp_f32 v98, v98
v_mfma_f32_16x16x32_bf16 v[120:123], a[148:151], v[60:63], v[120:123]
s_waitcnt lgkmcnt(5)
v_cvt_pk_bf16_f32 v154, v92, v93
v_exp_f32 v99, v99
v_mfma_f32_16x16x32_bf16 v[120:123], a[152:155], v[64:67], v[120:123]
s_waitcnt lgkmcnt(4)
v_exp_f32 v112, v112
v_mfma_f32_16x16x32_bf16 v[120:123], a[156:159], v[68:71], v[120:123]
v_exp_f32 v113, v113
v_mfma_f32_16x16x32_bf16 v[136:139], a[156:159], v[84:87], v[228:231]
v_cvt_pk_bf16_f32 v155, v94, v95
v_cndmask_b32 v104, v220, v17, s[0:1]
v_mfma_f32_16x16x32_bf16 v[136:139], a[152:155], v[80:83], v[136:139]
ds_read_b128 a[176:179], v2 offset:24576
buffer_load_dwordx4 v16, s[32:35], s70 offen offset:2048 sc1 lds
v_cndmask_b32 v105, v220, v17, s[4:5]
v_cndmask_b32 v106, v220, v17, s[6:7]
v_cndmask_b32 v107, v220, v17, s[8:9]
v_exp_f32 v114, v114
v_mfma_f32_16x16x32_bf16 v[136:139], a[148:151], v[76:79], v[136:139]
v_cvt_pk_bf16_f32 v156, v96, v97
v_cvt_pk_bf16_f32 v157, v98, v99
v_mfma_f32_16x16x32_bf16 v[136:139], a[144:147], v[72:75], v[136:139]
v_exp_f32 v115, v115
v_mfma_f32_16x16x32_bf16 v[104:107], a[144:147], v[40:43], v[104:107]
v_exp_f32 v128, v128
v_mfma_f32_16x16x32_bf16 v[104:107], a[148:151], v[44:47], v[104:107]
v_exp_f32 v129, v129
v_mfma_f32_16x16x32_bf16 v[104:107], a[152:155], v[48:51], v[104:107]
v_exp_f32 v130, v130
v_mfma_f32_16x16x32_bf16 v[104:107], a[156:159], v[52:55], v[104:107]
s_waitcnt lgkmcnt(0)
v_exp_f32 v131, v131
v_mfma_f32_16x16x32_bf16 v[140:143], a[172:175], v[84:87], v[228:231]
v_cvt_pk_bf16_f32 v164, v112, v113
v_cvt_pk_bf16_f32 v165, v114, v115
v_mfma_f32_16x16x32_bf16 v[140:143], a[168:171], v[80:83], v[140:143]
v_exp_f32 v144, v144
v_mfma_f32_16x16x32_bf16 v[140:143], a[164:167], v[76:79], v[140:143]
v_exp_f32 v145, v145
v_mfma_f32_16x16x32_bf16 v[140:143], a[160:163], v[72:75], v[140:143]
v_exp_f32 v146, v146
v_mfma_f32_16x16x32_bf16 v[124:127], a[160:163], v[56:59], v[224:227]
ds_read_b128 a[180:183], v2 offset:25600
v_cndmask_b32 v108, v220, v17, s[10:11]
v_mfma_f32_16x16x32_bf16 v[124:127], a[164:167], v[60:63], v[124:127]
ds_read_b128 a[184:187], v2 offset:26624
buffer_load_dwordx4 v16, s[32:35], s70 offen offset:3072 sc1 lds
v_cndmask_b32 v109, v220, v17, s[12:13]
v_cndmask_b32 v110, v220, v17, s[18:19]
v_cndmask_b32 v111, v220, v17, s[22:23]
v_cvt_pk_bf16_f32 v188, v128, v129
v_mfma_f32_16x16x32_bf16 v[124:127], a[168:171], v[64:67], v[124:127]
s_add_u32 m0, s86, 131072
v_exp_f32 v147, v147
v_mfma_f32_16x16x32_bf16 v[124:127], a[172:175], v[68:71], v[124:127]
s_add_u32 s64, s85, 0
ds_read_b128 a[188:191], v2 offset:27648
v_exp_f32 v148, v148
v_mfma_f32_16x16x32_bf16 v[108:111], a[172:175], v[52:55], v[108:111]
buffer_load_dwordx4 v12, s[36:39], s64 offen lds
v_cvt_pk_bf16_f32 v189, v130, v131
v_exp_f32 v149, v149
v_mfma_f32_16x16x32_bf16 v[108:111], a[168:171], v[48:51], v[108:111]
s_add_u32 m0, s86, 132096
ds_read_b128 a[192:195], v2 offset:28672
v_cndmask_b32 v112, v220, v17, s[26:27]
v_cndmask_b32 v113, v220, v17, s[56:57]
v_cndmask_b32 v114, v220, v17, s[58:59]
v_cndmask_b32 v115, v220, v17, s[60:61]
v_mfma_f32_16x16x32_bf16 v[108:111], a[164:167], v[44:47], v[108:111]
s_add_u32 s64, s85, 8192
v_exp_f32 v150, v150
v_mfma_f32_16x16x32_bf16 v[108:111], a[160:163], v[40:43], v[108:111]
buffer_load_dwordx4 v13, s[36:39], s64 offen lds
v_cvt_pk_bf16_f32 v196, v144, v145
v_exp_f32 v151, v151
v_mfma_f32_16x16x32_bf16 v[112:115], a[176:179], v[40:43], v[112:115]
s_waitcnt lgkmcnt(2)
s_add_u32 m0, s86, 133120
v_exp_f32 v132, v132
v_mfma_f32_16x16x32_bf16 v[112:115], a[180:183], v[44:47], v[112:115]
s_add_u32 s64, s85, 16384
v_exp_f32 v133, v133
v_mfma_f32_16x16x32_bf16 v[112:115], a[184:187], v[48:51], v[112:115]
s_waitcnt lgkmcnt(1)
buffer_load_dwordx4 v12, s[36:39], s64 offen lds
v_cvt_pk_bf16_f32 v197, v146, v147
v_mfma_f32_16x16x32_bf16 v[112:115], a[188:191], v[52:55], v[112:115]
s_add_u32 m0, s86, 134144
v_exp_f32 v134, v134
v_mfma_f32_16x16x32_bf16 v[128:131], a[188:191], v[68:71], v[224:227]
s_add_u32 s64, s85, 24576
ds_read_b128 a[196:199], v2 offset:29696
ds_read_b128 a[200:203], v2 offset:30720
ds_read_b128 a[204:207], v2 offset:31744
v_cvt_pk_bf16_f32 v198, v148, v149
v_mfma_f32_16x16x32_bf16 v[128:131], a[184:187], v[64:67], v[128:131]
buffer_load_dwordx4 v13, s[36:39], s64 offen lds
v_exp_f32 v135, v135
v_mfma_f32_16x16x32_bf16 v[128:131], a[180:183], v[60:63], v[128:131]
s_add_u32 m0, s71, 4096
v_exp_f32 v116, v116
v_mfma_f32_16x16x32_bf16 v[128:131], a[176:179], v[56:59], v[128:131]
s_add_u32 s64, s70, 4096
v_cvt_pk_bf16_f32 v199, v150, v151
v_exp_f32 v117, v117
v_mfma_f32_16x16x32_bf16 v[144:147], a[176:179], v[72:75], v[228:231]
buffer_load_dwordx4 v16, s[32:35], s64 offen offset:0 sc1 lds
v_mfma_f32_16x16x32_bf16 v[144:147], a[180:183], v[76:79], v[144:147]
v_exp_f32 v118, v118
v_mfma_f32_16x16x32_bf16 v[144:147], a[184:187], v[80:83], v[144:147]
v_cvt_pk_bf16_f32 v190, v132, v133
v_exp_f32 v119, v119
v_mfma_f32_16x16x32_bf16 v[144:147], a[188:191], v[84:87], v[144:147]
s_waitcnt lgkmcnt(0)
v_exp_f32 v100, v100
v_mfma_f32_16x16x32_bf16 v[148:151], a[204:207], v[84:87], v[228:231]
v_exp_f32 v101, v101
v_mfma_f32_16x16x32_bf16 v[148:151], a[200:203], v[80:83], v[148:151]
v_cvt_pk_bf16_f32 v191, v134, v135
v_cvt_pk_bf16_f32 v166, v116, v117
v_cvt_pk_bf16_f32 v167, v118, v119
v_mfma_f32_16x16x32_bf16 v[148:151], a[196:199], v[76:79], v[148:151]
v_exp_f32 v102, v102
v_mfma_f32_16x16x32_bf16 v[148:151], a[192:195], v[72:75], v[148:151]
v_exp_f32 v103, v103
v_mfma_f32_16x16x32_bf16 v[132:135], a[192:195], v[56:59], v[224:227]
s_lshl_b32 s66, s30, 30
ds_read_b128 a[144:147], v3 offset:16384
v_cndmask_b32 v116, v220, v17, s[62:63]
v_mfma_f32_16x16x32_bf16 v[132:135], a[196:199], v[60:63], v[132:135]
ds_read_b128 a[148:151], v3 offset:24576
v_cndmask_b32 v117, v220, v17, s[48:49]
v_cndmask_b32 v118, v220, v17, s[50:51]
v_cndmask_b32 v119, v220, v17, s[100:101]
v_exp_f32 v120, v120
v_mfma_f32_16x16x32_bf16 v[132:135], a[200:203], v[64:67], v[132:135]
v_exp_f32 v121, v121
v_mfma_f32_16x16x32_bf16 v[132:135], a[204:207], v[68:71], v[132:135]
v_exp_f32 v122, v122
v_mfma_f32_16x16x32_bf16 v[116:119], a[204:207], v[52:55], v[116:119]
ds_read_b128 a[152:155], v3 offset:17408
v_accvgpr_write_b32 a142, 0
v_mfma_f32_16x16x32_bf16 v[116:119], a[200:203], v[48:51], v[116:119]
ds_read_b128 a[156:159], v3 offset:25600
buffer_load_dwordx4 v16, s[32:35], s64 offen offset:1024 sc1 lds
v_accvgpr_write_b32 a143, 0
v_cvt_pk_bf16_f32 v158, v100, v101
v_cvt_pk_bf16_f32 v159, v102, v103
v_mfma_f32_16x16x32_bf16 v[116:119], a[196:199], v[44:47], v[116:119]
v_exp_f32 v123, v123
v_mfma_f32_16x16x32_bf16 v[116:119], a[192:195], v[40:43], v[116:119]
v_exp_f32 v136, v136
v_smfmac_f32_16x16x64_bf16 a[128:131], a[240:243], v[152:159], v5
ds_read_b128 a[160:163], v3 offset:18432
v_smfmac_f32_16x16x64_bf16 a[132:135], a[240:243], v[160:167], v5
v_exp_f32 v137, v137
v_smfmac_f32_16x16x64_bf16 a[136:139], a[240:243], v[184:191], v5
v_exp_f32 v138, v138
v_smfmac_f32_16x16x64_bf16 a[140:143], a[240:243], v[192:199], v5
s_waitcnt lgkmcnt(1)
v_cvt_pk_bf16_f32 v200, v120, v121
v_mfma_f32_16x16x32_bf16 a[0:3], a[144:147], v[152:155], 0
v_exp_f32 v139, v139
v_mfma_f32_16x16x32_bf16 a[0:3], a[148:151], v[156:159], a[0:3]
v_exp_f32 v104, v104
v_mfma_f32_16x16x32_bf16 a[32:35], a[148:151], v[164:167], 0
v_cvt_pk_bf16_f32 v201, v122, v123
v_cvt_pk_bf16_f32 v208, v136, v137
v_mfma_f32_16x16x32_bf16 a[32:35], a[144:147], v[160:163], a[32:35]
v_exp_f32 v105, v105
v_mfma_f32_16x16x32_bf16 a[64:67], a[144:147], v[184:187], 0
v_exp_f32 v106, v106
v_mfma_f32_16x16x32_bf16 a[64:67], a[148:151], v[188:191], a[64:67]
v_exp_f32 v107, v107
v_mfma_f32_16x16x32_bf16 a[96:99], a[148:151], v[196:199], 0
buffer_load_dwordx4 v16, s[32:35], s64 offen offset:2048 sc1 lds
v_mfma_f32_16x16x32_bf16 a[96:99], a[144:147], v[192:195], a[96:99]
v_exp_f32 v140, v140
v_mfma_f32_16x16x32_bf16 a[100:103], a[152:155], v[192:195], 0
ds_read_b128 a[164:167], v3 offset:26624
v_cvt_pk_bf16_f32 v209, v138, v139
v_mfma_f32_16x16x32_bf16 a[100:103], a[156:159], v[196:199], a[100:103]
v_exp_f32 v141, v141
v_mfma_f32_16x16x32_bf16 a[68:71], a[156:159], v[188:191], 0
v_exp_f32 v142, v142
v_mfma_f32_16x16x32_bf16 a[68:71], a[152:155], v[184:187], a[68:71]
v_cvt_pk_bf16_f32 v176, v104, v105
v_cvt_pk_bf16_f32 v177, v106, v107
v_mfma_f32_16x16x32_bf16 a[36:39], a[152:155], v[160:163], 0
v_exp_f32 v143, v143
v_mfma_f32_16x16x32_bf16 a[36:39], a[156:159], v[164:167], a[36:39]
v_exp_f32 v124, v124
v_mfma_f32_16x16x32_bf16 a[4:7], a[156:159], v[156:159], 0
v_exp_f32 v125, v125
v_mfma_f32_16x16x32_bf16 a[4:7], a[152:155], v[152:155], a[4:7]
s_waitcnt lgkmcnt(0)
ds_read_b128 a[168:171], v3 offset:19456
v_cvt_pk_bf16_f32 v210, v140, v141
v_mfma_f32_16x16x32_bf16 a[8:11], a[160:163], v[152:155], 0
v_exp_f32 v126, v126
v_mfma_f32_16x16x32_bf16 a[8:11], a[164:167], v[156:159], a[8:11]
ds_read_b128 a[172:175], v3 offset:27648
v_cvt_pk_bf16_f32 v211, v142, v143
v_mfma_f32_16x16x32_bf16 a[40:43], a[164:167], v[164:167], 0
v_exp_f32 v127, v127
v_mfma_f32_16x16x32_bf16 a[40:43], a[160:163], v[160:163], a[40:43]
v_exp_f32 v108, v108
v_mfma_f32_16x16x32_bf16 a[72:75], a[160:163], v[184:187], 0
buffer_load_dwordx4 v16, s[32:35], s64 offen offset:3072 sc1 lds
v_mfma_f32_16x16x32_bf16 a[72:75], a[164:167], v[188:191], a[72:75]
v_exp_f32 v109, v109
v_mfma_f32_16x16x32_bf16 a[104:107], a[164:167], v[196:199], 0
v_exp_f32 v110, v110
v_mfma_f32_16x16x32_bf16 a[104:107], a[160:163], v[192:195], a[104:107]
s_waitcnt lgkmcnt(0)
ds_read_b128 a[176:179], v3 offset:20480
v_cvt_pk_bf16_f32 v202, v124, v125
v_mfma_f32_16x16x32_bf16 a[108:111], a[168:171], v[192:195], 0
v_exp_f32 v111, v111
v_mfma_f32_16x16x32_bf16 a[108:111], a[172:175], v[196:199], a[108:111]
ds_read_b128 a[180:183], v3 offset:28672
v_cvt_pk_bf16_f32 v203, v126, v127
v_mfma_f32_16x16x32_bf16 a[76:79], a[172:175], v[188:191], 0
s_add_u32 m0, s86, 135168
v_exp_f32 v112, v112
v_mfma_f32_16x16x32_bf16 a[76:79], a[168:171], v[184:187], a[76:79]
s_add_u32 s64, s85, 32768
v_exp_f32 v113, v113
v_mfma_f32_16x16x32_bf16 a[44:47], a[168:171], v[160:163], 0
buffer_load_dwordx4 v12, s[36:39], s64 offen lds
v_mfma_f32_16x16x32_bf16 a[44:47], a[172:175], v[164:167], a[44:47]
s_add_u32 m0, s86, 136192
v_cvt_pk_bf16_f32 v178, v108, v109
v_exp_f32 v114, v114
v_mfma_f32_16x16x32_bf16 a[12:15], a[172:175], v[156:159], 0
s_add_u32 s64, s85, 40960
v_exp_f32 v115, v115
v_mfma_f32_16x16x32_bf16 a[12:15], a[168:171], v[152:155], a[12:15]
s_waitcnt lgkmcnt(0)
buffer_load_dwordx4 v13, s[36:39], s64 offen lds
v_mfma_f32_16x16x32_bf16 a[16:19], a[176:179], v[152:155], 0
s_add_u32 m0, s86, 137216
ds_read_b128 a[184:187], v3 offset:21504
ds_read_b128 a[188:191], v3 offset:29696
ds_read_b128 a[192:195], v3 offset:22528
ds_read_b128 a[196:199], v3 offset:30720
ds_read_b128 a[200:203], v3 offset:23552
ds_read_b128 a[204:207], v3 offset:31744
v_xor_b32 v2, 0x8000, v2
v_exp_f32 v128, v128
v_mfma_f32_16x16x32_bf16 a[16:19], a[180:183], v[156:159], a[16:19]
s_waitcnt vmcnt(14)
s_barrier
s_add_u32 s64, s85, 49152
v_cvt_pk_bf16_f32 v179, v110, v111
v_mfma_f32_16x16x32_bf16 a[48:51], a[180:183], v[164:167], 0
buffer_load_dwordx4 v12, s[36:39], s64 offen lds
v_exp_f32 v129, v129
v_mfma_f32_16x16x32_bf16 a[48:51], a[176:179], v[160:163], a[48:51]
s_add_u32 m0, s86, 138240
v_exp_f32 v130, v130
v_mfma_f32_16x16x32_bf16 a[80:83], a[176:179], v[184:187], 0
s_add_u32 s64, s85, 57344
v_cvt_pk_bf16_f32 v180, v112, v113
v_cvt_pk_bf16_f32 v181, v114, v115
v_mfma_f32_16x16x32_bf16 a[80:83], a[180:183], v[188:191], a[80:83]
buffer_load_dwordx4 v13, s[36:39], s64 offen lds
v_exp_f32 v131, v131
v_mfma_f32_16x16x32_bf16 a[112:115], a[180:183], v[196:199], 0
v_exp_f32 v144, v144
v_mfma_f32_16x16x32_bf16 a[112:115], a[176:179], v[192:195], a[112:115]
s_waitcnt lgkmcnt(0)
s_xor_b32 s71, s71, 49152
s_add_u32 s70, s70, 32768
s_mov_b32 m0, s71
v_exp_f32 v145, v145
v_mfma_f32_16x16x32_bf16 a[116:119], a[184:187], v[192:195], 0
buffer_load_dwordx4 v16, s[32:35], s70 offen offset:0 sc1 lds
v_mfma_f32_16x16x32_bf16 a[116:119], a[188:191], v[196:199], a[116:119]
v_exp_f32 v146, v146
v_mfma_f32_16x16x32_bf16 a[84:87], a[188:191], v[188:191], 0
v_cvt_pk_bf16_f32 v204, v128, v129
v_cvt_pk_bf16_f32 v205, v130, v131
v_mfma_f32_16x16x32_bf16 a[84:87], a[184:187], v[184:187], a[84:87]
v_exp_f32 v147, v147
v_mfma_f32_16x16x32_bf16 a[52:55], a[184:187], v[160:163], 0
v_exp_f32 v148, v148
v_mfma_f32_16x16x32_bf16 a[52:55], a[188:191], v[164:167], a[52:55]
v_exp_f32 v149, v149
v_mfma_f32_16x16x32_bf16 a[20:23], a[188:191], v[156:159], 0
ds_read_b128 a[144:147], v2 offset:0
v_lshl_add_u32 v19, v0, 24, s66
v_mfma_f32_16x16x32_bf16 a[20:23], a[184:187], v[152:155], a[20:23]
s_lshr_b32 s67, s31, 4
v_exp_f32 v150, v150
v_mfma_f32_16x16x32_bf16 a[24:27], a[192:195], v[152:155], 0
s_lshl1_add_u32 s67, s3, s67
v_cvt_pk_bf16_f32 v212, v144, v145
v_cvt_pk_bf16_f32 v213, v146, v147
v_mfma_f32_16x16x32_bf16 a[24:27], a[196:199], v[156:159], a[24:27]
s_lshl_b32 s79, s67, 8
v_exp_f32 v151, v151
v_mfma_f32_16x16x32_bf16 a[56:59], a[196:199], v[164:167], 0
s_add_u32 s79, s79, 8192
v_exp_f32 v132, v132
v_mfma_f32_16x16x32_bf16 a[56:59], a[192:195], v[160:163], a[56:59]
s_add_u32 s69, s31, 12
v_exp_f32 v133, v133
v_mfma_f32_16x16x32_bf16 a[88:91], a[192:195], v[184:187], 0
s_lshr_b32 s69, s69, 5
buffer_load_dwordx4 v16, s[32:35], s70 offen offset:1024 sc1 lds
v_mfma_f32_16x16x32_bf16 a[88:91], a[196:199], v[188:191], a[88:91]
s_lshl1_add_u32 s69, s3, s69
v_exp_f32 v134, v134
v_mfma_f32_16x16x32_bf16 a[120:123], a[196:199], v[196:199], 0
s_lshl_b32 s69, s69, 8
v_cvt_pk_bf16_f32 v214, v148, v149
v_cvt_pk_bf16_f32 v215, v150, v151
v_mfma_f32_16x16x32_bf16 a[120:123], a[192:195], v[192:195], a[120:123]
s_add_u32 s69, s69, 8192
v_exp_f32 v135, v135
v_mfma_f32_16x16x32_bf16 a[124:127], a[200:203], v[192:195], 0
s_lshl_b32 s67, s73, 16
v_exp_f32 v116, v116
v_mfma_f32_16x16x32_bf16 a[124:127], a[204:207], v[196:199], a[124:127]
s_xor_b32 s68, s80, 256
v_exp_f32 v117, v117
v_mfma_f32_16x16x32_bf16 a[92:95], a[204:207], v[188:191], 0
s_add_u32 s68, s68, s67
ds_read_b128 a[148:151], v2 offset:1024
v_cvt_pk_bf16_f32 v206, v132, v133
v_mfma_f32_16x16x32_bf16 a[92:95], a[200:203], v[184:187], a[92:95]
s_add_u32 s67, s67, s69
v_exp_f32 v118, v118
v_mfma_f32_16x16x32_bf16 a[60:63], a[200:203], v[160:163], 0
ds_read_b128 a[152:155], v2 offset:2048
v_cvt_pk_bf16_f32 v207, v134, v135
v_mfma_f32_16x16x32_bf16 a[60:63], a[204:207], v[164:167], a[60:63]
ds_read_b128 a[156:159], v2 offset:3072
v_cvt_pk_bf16_f32 v182, v116, v117
v_mfma_f32_16x16x32_bf16 a[28:31], a[204:207], v[156:159], 0
s_mov_b64 exec, 1
buffer_atomic_add a251, v19, s[52:55], s67 offen offset:0 sc1
buffer_atomic_add a251, v19, s[52:55], s68 offen offset:0 sc1
s_mov_b64 exec, -1
v_exp_f32 v119, v119
v_mfma_f32_16x16x32_bf16 a[28:31], a[200:203], v[152:155], a[28:31]
ds_read_b128 a[160:163], v2 offset:4096
ds_read_b128 a[164:167], v2 offset:5120
ds_read_b128 a[168:171], v2 offset:6144
ds_read_b128 a[172:175], v2 offset:7168
v_mul_u32_u24 v19, 52, v0
v_cvt_pk_bf16_f32 v183, v118, v119
v_xor_b32 v3, 0x8000, v3
v_accvgpr_read_b32 v20, a128
v_accvgpr_read_b32 v248, a129
v_add_f32 v20, v20, v248
v_max_f32 v1, v1, v20
v_rcp_f32 v20, v20
v_accvgpr_read_b32 v232, a0
v_accvgpr_read_b32 v233, a1
v_accvgpr_read_b32 v234, a2
v_accvgpr_read_b32 v235, a3
v_accvgpr_read_b32 v236, a4
v_accvgpr_read_b32 v237, a5
v_accvgpr_read_b32 v238, a6
v_accvgpr_read_b32 v239, a7
v_mul_f32 v20, v20, v4
v_mul_f32 v232, v232, v20
v_mul_f32 v233, v233, v20
v_mul_f32 v234, v234, v20
v_mul_f32 v235, v235, v20
v_mul_f32 v236, v236, v20
v_mul_f32 v237, v237, v20
v_mul_f32 v238, v238, v20
v_mul_f32 v239, v239, v20
v_cvt_pk_bf16_f32 v232, v232, v233
v_cvt_pk_bf16_f32 v233, v234, v235
v_cvt_pk_bf16_f32 v234, v236, v237
v_cvt_pk_bf16_f32 v235, v238, v239
s_add_u32 s77, s74, 0
buffer_store_dwordx4 v[232:235], v16, s[44:47], s77 offen sc1
v_accvgpr_read_b32 v240, a8
v_accvgpr_read_b32 v241, a9
v_accvgpr_read_b32 v242, a10
v_accvgpr_read_b32 v243, a11
v_accvgpr_read_b32 v244, a12
v_accvgpr_read_b32 v245, a13
v_accvgpr_read_b32 v246, a14
v_accvgpr_read_b32 v247, a15
v_mul_f32 v240, v240, v20
v_mul_f32 v241, v241, v20
v_mul_f32 v242, v242, v20
v_mul_f32 v243, v243, v20
v_mul_f32 v244, v244, v20
v_mul_f32 v245, v245, v20
v_mul_f32 v246, v246, v20
v_mul_f32 v247, v247, v20
v_cvt_pk_bf16_f32 v240, v240, v241
v_cvt_pk_bf16_f32 v241, v242, v243
v_cvt_pk_bf16_f32 v242, v244, v245
v_cvt_pk_bf16_f32 v243, v246, v247
s_add_u32 s77, s74, 8192
buffer_store_dwordx4 v[240:243], v16, s[44:47], s77 offen sc1
v_accvgpr_read_b32 v232, a16
v_accvgpr_read_b32 v233, a17
v_accvgpr_read_b32 v234, a18
v_accvgpr_read_b32 v235, a19
v_accvgpr_read_b32 v236, a20
v_accvgpr_read_b32 v237, a21
v_accvgpr_read_b32 v238, a22
v_accvgpr_read_b32 v239, a23
v_mul_f32 v232, v232, v20
v_mul_f32 v233, v233, v20
v_mul_f32 v234, v234, v20
v_mul_f32 v235, v235, v20
v_mul_f32 v236, v236, v20
v_mul_f32 v237, v237, v20
v_mul_f32 v238, v238, v20
v_mul_f32 v239, v239, v20
v_cvt_pk_bf16_f32 v232, v232, v233
v_cvt_pk_bf16_f32 v233, v234, v235
v_cvt_pk_bf16_f32 v234, v236, v237
v_cvt_pk_bf16_f32 v235, v238, v239
s_add_u32 s77, s74, 16384
buffer_store_dwordx4 v[232:235], v16, s[44:47], s77 offen sc1
s_branch L_T
L_T1:
buffer_load_dword v19, off, s[52:55], s80 sc1
s_waitcnt lgkmcnt(7)
v_mfma_f32_16x16x32_bf16 v[136:139], a[144:147], v[72:75], v[228:231]
s_waitcnt lgkmcnt(6)
ds_read_b128 a[176:179], v2 offset:8192
v_cndmask_b32 v120, v224, v17, s[0:1]
v_mfma_f32_16x16x32_bf16 v[136:139], a[148:151], v[76:79], v[136:139]
s_waitcnt lgkmcnt(6)
ds_read_b128 a[180:183], v2 offset:9216
v_cndmask_b32 v121, v224, v17, s[4:5]
v_cndmask_b32 v122, v224, v17, s[6:7]
v_cndmask_b32 v123, v224, v17, s[8:9]
v_mfma_f32_16x16x32_bf16 v[136:139], a[152:155], v[80:83], v[136:139]
s_waitcnt lgkmcnt(6)
buffer_load_dwordx4 v16, s[32:35], s70 offen offset:2048 sc1 lds
v_mfma_f32_16x16x32_bf16 v[136:139], a[156:159], v[84:87], v[136:139]
ds_read_b128 a[184:187], v2 offset:10240
v_cndmask_b32 v124, v224, v17, s[10:11]
v_mfma_f32_16x16x32_bf16 v[120:123], a[156:159], v[68:71], v[120:123]
ds_read_b128 a[188:191], v2 offset:11264
v_cndmask_b32 v125, v224, v17, s[12:13]
v_mfma_f32_16x16x32_bf16 v[120:123], a[152:155], v[64:67], v[120:123]
ds_read_b128 a[192:195], v2 offset:12288
v_cndmask_b32 v126, v224, v17, s[18:19]
v_mfma_f32_16x16x32_bf16 v[120:123], a[148:151], v[60:63], v[120:123]
ds_read_b128 a[196:199], v2 offset:13312
v_cndmask_b32 v127, v224, v17, s[22:23]
v_mfma_f32_16x16x32_bf16 v[120:123], a[144:147], v[56:59], v[120:123]
s_waitcnt lgkmcnt(4)
ds_read_b128 a[200:203], v2 offset:14336
v_cndmask_b32 v128, v224, v17, s[26:27]
v_mfma_f32_16x16x32_bf16 v[140:143], a[160:163], v[72:75], v[228:231]
ds_read_b128 a[204:207], v2 offset:15360
v_cndmask_b32 v129, v224, v17, s[56:57]
v_mfma_f32_16x16x32_bf16 v[140:143], a[164:167], v[76:79], v[140:143]
ds_read_b128 a[144:147], v3 offset:0
v_cndmask_b32 v130, v224, v17, s[58:59]
v_mfma_f32_16x16x32_bf16 v[140:143], a[168:171], v[80:83], v[140:143]
v_exp_f32 v136, v136
v_mfma_f32_16x16x32_bf16 v[140:143], a[172:175], v[84:87], v[140:143]
v_exp_f32 v137, v137
v_mfma_f32_16x16x32_bf16 v[124:127], a[172:175], v[68:71], v[124:127]
ds_read_b128 a[148:151], v3 offset:8192
v_cndmask_b32 v131, v224, v17, s[60:61]
v_mfma_f32_16x16x32_bf16 v[124:127], a[168:171], v[64:67], v[124:127]
v_exp_f32 v138, v138
v_mfma_f32_16x16x32_bf16 v[124:127], a[164:167], v[60:63], v[124:127]
s_mul_i32 s69, s83, 8
buffer_load_dwordx4 v16, s[32:35], s70 offen offset:3072 sc1 lds
v_mfma_f32_16x16x32_bf16 v[124:127], a[160:163], v[56:59], v[124:127]
s_sub_u32 s69, 36, s69
v_exp_f32 v139, v139
v_mfma_f32_16x16x32_bf16 v[128:131], a[176:179], v[56:59], v[128:131]
v_exp_f32 v120, v120
v_mfma_f32_16x16x32_bf16 v[128:131], a[180:183], v[60:63], v[128:131]
s_waitcnt lgkmcnt(1)
v_exp_f32 v121, v121
v_mfma_f32_16x16x32_bf16 v[128:131], a[184:187], v[64:67], v[128:131]
v_exp_f32 v122, v122
v_mfma_f32_16x16x32_bf16 v[128:131], a[188:191], v[68:71], v[128:131]
s_add_u32 m0, s71, 4096
ds_read_b128 a[152:155], v3 offset:1024
v_cndmask_b32 v132, v224, v17, s[62:63]
v_mfma_f32_16x16x32_bf16 v[144:147], a[188:191], v[84:87], v[228:231]
s_add_u32 s64, s70, 4096
v_cvt_pk_bf16_f32 v192, v136, v137
v_cndmask_b32 v133, v224, v17, s[48:49]
v_mfma_f32_16x16x32_bf16 v[144:147], a[184:187], v[80:83], v[144:147]
buffer_load_dwordx4 v16, s[32:35], s64 offen offset:0 sc1 lds
v_mfma_f32_16x16x32_bf16 v[144:147], a[180:183], v[76:79], v[144:147]
ds_read_b128 a[156:159], v3 offset:9216
v_cndmask_b32 v134, v224, v17, s[50:51]
v_mfma_f32_16x16x32_bf16 v[144:147], a[176:179], v[72:75], v[144:147]
ds_read_b128 a[160:163], v3 offset:2048
v_cndmask_b32 v135, v224, v17, s[100:101]
v_mfma_f32_16x16x32_bf16 v[148:151], a[192:195], v[72:75], v[228:231]
v_exp_f32 v123, v123
v_mfma_f32_16x16x32_bf16 v[148:151], a[196:199], v[76:79], v[148:151]
v_cvt_pk_bf16_f32 v193, v138, v139
v_cvt_pk_bf16_f32 v184, v120, v121
v_mfma_f32_16x16x32_bf16 v[148:151], a[200:203], v[80:83], v[148:151]
v_exp_f32 v140, v140
v_mfma_f32_16x16x32_bf16 v[148:151], a[204:207], v[84:87], v[148:151]
v_exp_f32 v141, v141
v_mfma_f32_16x16x32_bf16 v[132:135], a[204:207], v[68:71], v[132:135]
v_exp_f32 v142, v142
v_mfma_f32_16x16x32_bf16 v[132:135], a[200:203], v[64:67], v[132:135]
v_exp_f32 v143, v143
v_mfma_f32_16x16x32_bf16 v[132:135], a[196:199], v[60:63], v[132:135]
buffer_load_dwordx4 v16, s[32:35], s64 offen offset:1024 sc1 lds
v_mfma_f32_16x16x32_bf16 v[132:135], a[192:195], v[56:59], v[132:135]
v_exp_f32 v124, v124
v_smfmac_f32_16x16x64_bf16 a[132:135], a[240:243], v[176:183], v5
ds_read_b128 a[164:167], v3 offset:10240
v_smfmac_f32_16x16x64_bf16 a[136:139], a[240:243], v[200:207], v5
ds_read_b128 a[168:171], v3 offset:3072
v_accvgpr_read_b32 v240, a24
v_smfmac_f32_16x16x64_bf16 a[140:143], a[240:243], v[208:215], v5
v_cvt_pk_bf16_f32 v185, v122, v123
v_mfma_f32_16x16x32_bf16 a[32:35], a[144:147], v[176:179], a[32:35]
s_waitcnt lgkmcnt(2)
v_exp_f32 v125, v125
v_mfma_f32_16x16x32_bf16 a[32:35], a[148:151], v[180:183], a[32:35]
ds_read_b128 a[172:175], v3 offset:11264
v_accvgpr_read_b32 v241, a25
v_mfma_f32_16x16x32_bf16 a[64:67], a[148:151], v[204:207], a[64:67]
ds_read_b128 a[176:179], v3 offset:4096
v_accvgpr_read_b32 v242, a26
v_mfma_f32_16x16x32_bf16 a[64:67], a[144:147], v[200:203], a[64:67]
v_cvt_pk_bf16_f32 v194, v140, v141
v_accvgpr_read_b32 v243, a27
v_mfma_f32_16x16x32_bf16 a[96:99], a[144:147], v[208:211], a[96:99]
ds_read_b128 a[180:183], v3 offset:12288
v_accvgpr_read_b32 v244, a28
v_mfma_f32_16x16x32_bf16 a[96:99], a[148:151], v[212:215], a[96:99]
ds_read_b128 a[184:187], v3 offset:5120
v_accvgpr_read_b32 v245, a29
v_mfma_f32_16x16x32_bf16 a[100:103], a[156:159], v[212:215], a[100:103]
ds_read_b128 a[188:191], v3 offset:13312
v_accvgpr_read_b32 v246, a30
v_mfma_f32_16x16x32_bf16 a[100:103], a[152:155], v[208:211], a[100:103]
ds_read_b128 a[192:195], v3 offset:6144
v_accvgpr_read_b32 v247, a31
v_mul_f32 v240, v240, v20
v_mul_f32 v241, v241, v20
v_mul_f32 v242, v242, v20
v_mul_f32 v243, v243, v20
v_mul_f32 v244, v244, v20
v_mul_f32 v245, v245, v20
v_mul_f32 v246, v246, v20
v_mul_f32 v247, v247, v20
v_cvt_pk_bf16_f32 v240, v240, v241
v_cvt_pk_bf16_f32 v241, v242, v243
v_cvt_pk_bf16_f32 v242, v244, v245
v_cvt_pk_bf16_f32 v243, v246, v247
s_add_u32 s77, s74, 24576
buffer_store_dwordx4 v[240:243], v16, s[44:47], s77 offen sc1
v_exp_f32 v126, v126
v_mfma_f32_16x16x32_bf16 a[68:71], a[152:155], v[200:203], a[68:71]
buffer_load_dwordx4 v16, s[32:35], s64 offen offset:2048 sc1 lds
v_cvt_pk_bf16_f32 v195, v142, v143
v_mfma_f32_16x16x32_bf16 a[68:71], a[156:159], v[204:207], a[68:71]
v_exp_f32 v127, v127
v_mfma_f32_16x16x32_bf16 a[36:39], a[156:159], v[180:183], a[36:39]
v_exp_f32 v128, v128
v_mfma_f32_16x16x32_bf16 a[36:39], a[152:155], v[176:179], a[36:39]
v_exp_f32 v129, v129
v_mfma_f32_16x16x32_bf16 a[40:43], a[160:163], v[176:179], a[40:43]
s_waitcnt lgkmcnt(1)
v_cvt_pk_bf16_f32 v186, v124, v125
v_cvt_pk_bf16_f32 v187, v126, v127
v_mfma_f32_16x16x32_bf16 a[40:43], a[164:167], v[180:183], a[40:43]
v_exp_f32 v130, v130
v_mfma_f32_16x16x32_bf16 a[72:75], a[164:167], v[204:207], a[72:75]
buffer_load_dwordx4 v16, s[32:35], s64 offen offset:3072 sc1 lds
v_mfma_f32_16x16x32_bf16 a[72:75], a[160:163], v[200:203], a[72:75]
v_exp_f32 v131, v131
v_mfma_f32_16x16x32_bf16 a[104:107], a[160:163], v[208:211], a[104:107]
v_exp_f32 v144, v144
v_mfma_f32_16x16x32_bf16 a[104:107], a[164:167], v[212:215], a[104:107]
v_exp_f32 v145, v145
v_mfma_f32_16x16x32_bf16 a[108:111], a[172:175], v[212:215], a[108:111]
v_exp_f32 v146, v146
v_mfma_f32_16x16x32_bf16 a[108:111], a[168:171], v[208:211], a[108:111]
ds_read_b128 a[196:199], v3 offset:14336
v_cvt_pk_bf16_f32 v188, v128, v129
v_mfma_f32_16x16x32_bf16 a[76:79], a[168:171], v[200:203], a[76:79]
ds_read_b128 a[200:203], v3 offset:7168
v_cvt_pk_bf16_f32 v189, v130, v131
v_mfma_f32_16x16x32_bf16 a[76:79], a[172:175], v[204:207], a[76:79]
ds_read_b128 a[204:207], v3 offset:15360
v_cvt_pk_bf16_f32 v196, v144, v145
v_mfma_f32_16x16x32_bf16 a[44:47], a[172:175], v[180:183], a[44:47]
v_exp_f32 v147, v147
v_mfma_f32_16x16x32_bf16 a[44:47], a[168:171], v[176:179], a[44:47]
v_exp_f32 v148, v148
v_mfma_f32_16x16x32_bf16 a[48:51], a[176:179], v[176:179], a[48:51]
v_exp_f32 v149, v149
v_mfma_f32_16x16x32_bf16 a[48:51], a[180:183], v[180:183], a[48:51]
v_exp_f32 v150, v150
v_mfma_f32_16x16x32_bf16 a[80:83], a[180:183], v[204:207], a[80:83]
s_waitcnt vmcnt(10)
s_barrier
v_mfma_f32_16x16x32_bf16 a[80:83], a[176:179], v[200:203], a[80:83]
v_exp_f32 v151, v151
v_mfma_f32_16x16x32_bf16 a[112:115], a[176:179], v[208:211], a[112:115]
v_exp_f32 v132, v132
v_mfma_f32_16x16x32_bf16 a[112:115], a[180:183], v[212:215], a[112:115]
v_exp_f32 v133, v133
v_mfma_f32_16x16x32_bf16 a[116:119], a[188:191], v[212:215], a[116:119]
ds_read_b128 a[144:147], v2 offset:16384
v_cvt_pk_bf16_f32 v197, v146, v147
v_mfma_f32_16x16x32_bf16 a[116:119], a[184:187], v[208:211], a[116:119]
v_exp_f32 v134, v134
v_mfma_f32_16x16x32_bf16 a[84:87], a[184:187], v[200:203], a[84:87]
s_waitcnt vmcnt(7)
v_readfirstlane_b32 vcc_lo, v19
s_nop 0
s_cmp_lt_u32 vcc_lo, s69
s_cbranch_scc1 L_spin_1012
L_spinbk_1013:
v_mfma_f32_16x16x32_bf16 a[84:87], a[188:191], v[204:207], a[84:87]
ds_read_b128 a[148:151], v2 offset:17408
v_cvt_pk_bf16_f32 v198, v148, v149
v_mfma_f32_16x16x32_bf16 a[52:55], a[188:191], v[180:183], a[52:55]
ds_read_b128 a[152:155], v2 offset:18432
v_cvt_pk_bf16_f32 v199, v150, v151
v_mfma_f32_16x16x32_bf16 a[52:55], a[184:187], v[176:179], a[52:55]
s_waitcnt lgkmcnt(3)
ds_read_b128 a[156:159], v2 offset:19456
v_cndmask_b32 v136, v228, v17, s[0:1]
v_mfma_f32_16x16x32_bf16 a[56:59], a[192:195], v[176:179], a[56:59]
ds_read_b128 a[160:163], v2 offset:20480
v_cndmask_b32 v137, v228, v17, s[4:5]
v_mfma_f32_16x16x32_bf16 a[56:59], a[196:199], v[180:183], a[56:59]
ds_read_b128 a[164:167], v2 offset:21504
v_cndmask_b32 v138, v228, v17, s[6:7]
v_mfma_f32_16x16x32_bf16 a[88:91], a[196:199], v[204:207], a[88:91]
ds_read_b128 a[168:171], v2 offset:22528
v_cndmask_b32 v139, v228, v17, s[8:9]
v_mfma_f32_16x16x32_bf16 a[88:91], a[192:195], v[200:203], a[88:91]
v_exp_f32 v135, v135
v_mfma_f32_16x16x32_bf16 a[120:123], a[192:195], v[208:211], a[120:123]
ds_read_b128 a[172:175], v2 offset:23552
v_cvt_pk_bf16_f32 v190, v132, v133
v_mfma_f32_16x16x32_bf16 a[120:123], a[196:199], v[212:215], a[120:123]
v_cndmask_b32 v140, v228, v17, s[10:11]
v_cvt_pk_bf16_f32 v191, v134, v135
v_mfma_f32_16x16x32_bf16 a[124:127], a[204:207], v[212:215], a[124:127]
v_cndmask_b32 v141, v228, v17, s[12:13]
v_cndmask_b32 v142, v228, v17, s[18:19]
v_mfma_f32_16x16x32_bf16 a[124:127], a[200:203], v[208:211], a[124:127]
v_cndmask_b32 v143, v228, v17, s[22:23]
v_cndmask_b32 v144, v228, v17, s[26:27]
v_mfma_f32_16x16x32_bf16 a[92:95], a[200:203], v[200:203], a[92:95]
v_cndmask_b32 v145, v228, v17, s[56:57]
v_cndmask_b32 v146, v228, v17, s[58:59]
v_mfma_f32_16x16x32_bf16 a[92:95], a[204:207], v[204:207], a[92:95]
v_cndmask_b32 v147, v228, v17, s[60:61]
v_cndmask_b32 v148, v228, v17, s[62:63]
v_mfma_f32_16x16x32_bf16 a[60:63], a[204:207], v[180:183], a[60:63]
v_cndmask_b32 v149, v228, v17, s[48:49]
v_cndmask_b32 v150, v228, v17, s[50:51]
v_mfma_f32_16x16x32_bf16 a[60:63], a[200:203], v[176:179], a[60:63]
s_waitcnt lgkmcnt(0)
v_cndmask_b32 v151, v228, v17, s[100:101]
v_accvgpr_read_b32 v21, a132
v_mfma_f32_16x16x32_bf16 v[136:139], a[144:147], v[72:75], v[136:139]
ds_read_b128 a[176:179], v2 offset:24576
v_accvgpr_read_b32 v248, a133
v_mfma_f32_16x16x32_bf16 v[136:139], a[148:151], v[76:79], v[136:139]
ds_read_b128 a[180:183], v2 offset:25600
v_add_f32 v21, v21, v248
v_mfma_f32_16x16x32_bf16 v[136:139], a[152:155], v[80:83], v[136:139]
ds_read_b128 a[184:187], v2 offset:26624
v_max_f32 v1, v1, v21
v_mfma_f32_16x16x32_bf16 v[136:139], a[156:159], v[84:87], v[136:139]
ds_read_b128 a[188:191], v2 offset:27648
ds_read_b128 a[192:195], v2 offset:28672
v_mfma_f32_16x16x32_bf16 v[140:143], a[172:175], v[84:87], v[140:143]
ds_read_b128 a[196:199], v2 offset:29696
ds_read_b128 a[200:203], v2 offset:30720
ds_read_b128 a[204:207], v2 offset:31744
v_mfma_f32_16x16x32_bf16 v[140:143], a[168:171], v[80:83], v[140:143]
v_rcp_f32 v21, v21
v_mfma_f32_16x16x32_bf16 v[140:143], a[164:167], v[76:79], v[140:143]
ds_read_b128 a[144:147], v3 offset:16384
v_accvgpr_read_b32 v232, a32
v_mfma_f32_16x16x32_bf16 v[140:143], a[160:163], v[72:75], v[140:143]
s_waitcnt lgkmcnt(7)
ds_read_b128 a[148:151], v3 offset:24576
v_accvgpr_read_b32 v233, a33
v_mfma_f32_16x16x32_bf16 v[144:147], a[176:179], v[72:75], v[144:147]
ds_read_b128 a[152:155], v3 offset:17408
v_accvgpr_read_b32 v234, a34
v_mfma_f32_16x16x32_bf16 v[144:147], a[180:183], v[76:79], v[144:147]
s_waitcnt lgkmcnt(6)
ds_read_b128 a[156:159], v3 offset:25600
v_accvgpr_read_b32 v235, a35
v_mfma_f32_16x16x32_bf16 v[144:147], a[184:187], v[80:83], v[144:147]
ds_read_b128 a[160:163], v3 offset:18432
v_accvgpr_read_b32 v236, a36
v_accvgpr_read_b32 v237, a37
v_accvgpr_read_b32 v238, a38
v_accvgpr_read_b32 v239, a39
v_mul_f32 v21, v21, v6
v_mul_f32 v232, v232, v21
v_mul_f32 v233, v233, v21
v_mul_f32 v234, v234, v21
v_mul_f32 v235, v235, v21
v_mul_f32 v236, v236, v21
v_mul_f32 v237, v237, v21
v_mul_f32 v238, v238, v21
v_mul_f32 v239, v239, v21
v_cvt_pk_bf16_f32 v232, v232, v233
v_cvt_pk_bf16_f32 v233, v234, v235
v_cvt_pk_bf16_f32 v234, v236, v237
v_cvt_pk_bf16_f32 v235, v238, v239
s_add_u32 s77, s74, 4096
buffer_store_dwordx4 v[232:235], v16, s[44:47], s77 offen sc1
v_accvgpr_read_b32 v240, a40
v_accvgpr_read_b32 v241, a41
v_accvgpr_read_b32 v242, a42
v_accvgpr_read_b32 v243, a43
v_accvgpr_read_b32 v244, a44
v_accvgpr_read_b32 v245, a45
v_accvgpr_read_b32 v246, a46
v_accvgpr_read_b32 v247, a47
v_mul_f32 v240, v240, v21
v_mul_f32 v241, v241, v21
v_mul_f32 v242, v242, v21
v_mul_f32 v243, v243, v21
v_mul_f32 v244, v244, v21
v_mul_f32 v245, v245, v21
v_mul_f32 v246, v246, v21
v_mul_f32 v247, v247, v21
v_cvt_pk_bf16_f32 v240, v240, v241
v_cvt_pk_bf16_f32 v241, v242, v243
v_cvt_pk_bf16_f32 v242, v244, v245
v_cvt_pk_bf16_f32 v243, v246, v247
s_add_u32 s77, s74, 12288
buffer_store_dwordx4 v[240:243], v16, s[44:47], s77 offen sc1
v_accvgpr_read_b32 v232, a48
v_accvgpr_read_b32 v233, a49
v_accvgpr_read_b32 v234, a50
v_accvgpr_read_b32 v235, a51
v_accvgpr_read_b32 v236, a52
v_accvgpr_read_b32 v237, a53
v_accvgpr_read_b32 v238, a54
v_accvgpr_read_b32 v239, a55
v_mul_f32 v232, v232, v21
v_mul_f32 v233, v233, v21
v_mul_f32 v234, v234, v21
v_mul_f32 v235, v235, v21
v_mul_f32 v236, v236, v21
v_mul_f32 v237, v237, v21
v_mul_f32 v238, v238, v21
v_mul_f32 v239, v239, v21
v_cvt_pk_bf16_f32 v232, v232, v233
v_cvt_pk_bf16_f32 v233, v234, v235
v_cvt_pk_bf16_f32 v234, v236, v237
v_cvt_pk_bf16_f32 v235, v238, v239
s_add_u32 s77, s74, 20480
buffer_store_dwordx4 v[232:235], v16, s[44:47], s77 offen sc1
v_accvgpr_read_b32 v240, a56
v_accvgpr_read_b32 v241, a57
v_accvgpr_read_b32 v242, a58
v_accvgpr_read_b32 v243, a59
v_accvgpr_read_b32 v244, a60
v_accvgpr_read_b32 v245, a61
v_accvgpr_read_b32 v246, a62
v_accvgpr_read_b32 v247, a63
v_mul_f32 v240, v240, v21
v_mul_f32 v241, v241, v21
v_mul_f32 v242, v242, v21
v_mul_f32 v243, v243, v21
v_mul_f32 v244, v244, v21
v_mul_f32 v245, v245, v21
v_mul_f32 v246, v246, v21
v_mul_f32 v247, v247, v21
v_cvt_pk_bf16_f32 v240, v240, v241
v_cvt_pk_bf16_f32 v241, v242, v243
v_cvt_pk_bf16_f32 v242, v244, v245
v_cvt_pk_bf16_f32 v243, v246, v247
s_add_u32 s77, s74, 28672
buffer_store_dwordx4 v[240:243], v16, s[44:47], s77 offen sc1
v_exp_f32 v136, v136
v_mfma_f32_16x16x32_bf16 v[144:147], a[188:191], v[84:87], v[144:147]
s_waitcnt lgkmcnt(5)
v_exp_f32 v137, v137
v_mfma_f32_16x16x32_bf16 v[148:151], a[204:207], v[84:87], v[148:151]
v_exp_f32 v138, v138
v_mfma_f32_16x16x32_bf16 v[148:151], a[200:203], v[80:83], v[148:151]
s_add_u32 s65, s84, 0
v_exp_f32 v139, v139
v_mfma_f32_16x16x32_bf16 v[148:151], a[196:199], v[76:79], v[148:151]
buffer_load_dwordx4 a[208:211], v14, s[44:47], s65 offen offset:0 sc1
v_mfma_f32_16x16x32_bf16 v[148:151], a[192:195], v[72:75], v[148:151]
ds_read_b128 a[164:167], v3 offset:26624
v_cvt_pk_bf16_f32 v208, v136, v137
v_smfmac_f32_16x16x64_bf16 a[136:139], a[240:243], v[184:191], v5
ds_read_b128 a[168:171], v3 offset:19456
v_smfmac_f32_16x16x64_bf16 a[140:143], a[240:243], v[192:199], v5
s_waitcnt lgkmcnt(2)
ds_read_b128 a[172:175], v3 offset:27648
v_mfma_f32_16x16x32_bf16 a[64:67], a[144:147], v[184:187], a[64:67]
v_exp_f32 v140, v140
v_mfma_f32_16x16x32_bf16 a[64:67], a[148:151], v[188:191], a[64:67]
buffer_load_dwordx4 a[216:219], v14, s[44:47], s65 offen offset:1024 sc1
v_mfma_f32_16x16x32_bf16 a[96:99], a[148:151], v[196:199], a[96:99]
v_exp_f32 v141, v141
v_mfma_f32_16x16x32_bf16 a[96:99], a[144:147], v[192:195], a[96:99]
buffer_load_dwordx4 a[224:227], v15, s[44:47], s65 offen offset:0 sc1
v_mfma_f32_16x16x32_bf16 a[100:103], a[152:155], v[192:195], a[100:103]
v_exp_f32 v142, v142
v_mfma_f32_16x16x32_bf16 a[100:103], a[156:159], v[196:199], a[100:103]
buffer_load_dwordx4 a[232:235], v15, s[44:47], s65 offen offset:1024 sc1
v_mfma_f32_16x16x32_bf16 a[68:71], a[156:159], v[188:191], a[68:71]
s_add_u32 s65, s84, 8192
ds_read_b128 a[176:179], v3 offset:20480
v_cvt_pk_bf16_f32 v209, v138, v139
v_mfma_f32_16x16x32_bf16 a[68:71], a[152:155], v[184:187], a[68:71]
buffer_load_dwordx4 a[212:215], v14, s[44:47], s65 offen offset:0 sc1
v_mfma_f32_16x16x32_bf16 a[72:75], a[160:163], v[184:187], a[72:75]
s_waitcnt lgkmcnt(1)
ds_read_b128 a[180:183], v3 offset:28672
v_cvt_pk_bf16_f32 v210, v140, v141
v_mfma_f32_16x16x32_bf16 a[72:75], a[164:167], v[188:191], a[72:75]
v_exp_f32 v143, v143
v_mfma_f32_16x16x32_bf16 a[104:107], a[164:167], v[196:199], a[104:107]
buffer_load_dwordx4 a[220:223], v14, s[44:47], s65 offen offset:1024 sc1
v_mfma_f32_16x16x32_bf16 a[104:107], a[160:163], v[192:195], a[104:107]
v_exp_f32 v144, v144
v_mfma_f32_16x16x32_bf16 a[108:111], a[168:171], v[192:195], a[108:111]
ds_read_b128 a[184:187], v3 offset:21504
v_xor_b32 v2, 0x8000, v2
v_mfma_f32_16x16x32_bf16 a[108:111], a[172:175], v[196:199], a[108:111]
buffer_load_dwordx4 a[228:231], v15, s[44:47], s65 offen offset:0 sc1
ds_read_b128 a[188:191], v3 offset:29696
v_mfma_f32_16x16x32_bf16 a[76:79], a[172:175], v[188:191], a[76:79]
v_exp_f32 v145, v145
v_mfma_f32_16x16x32_bf16 a[76:79], a[168:171], v[184:187], a[76:79]
s_waitcnt lgkmcnt(2)
buffer_load_dwordx4 a[236:239], v15, s[44:47], s65 offen offset:1024 sc1
v_mfma_f32_16x16x32_bf16 a[80:83], a[176:179], v[184:187], a[80:83]
s_add_u32 s65, s84, 32768
ds_read_b128 a[192:195], v3 offset:22528
v_cvt_pk_bf16_f32 v211, v142, v143
v_mfma_f32_16x16x32_bf16 a[80:83], a[180:183], v[188:191], a[80:83]
buffer_load_dwordx4 v[152:155], v14, s[44:47], s65 offen offset:0 sc1
ds_read_b128 a[196:199], v3 offset:30720
v_exp_f32 v146, v146
v_mfma_f32_16x16x32_bf16 a[112:115], a[180:183], v[196:199], a[112:115]
ds_read_b128 a[200:203], v3 offset:23552
ds_read_b128 a[204:207], v3 offset:31744
v_mfma_f32_16x16x32_bf16 a[112:115], a[176:179], v[192:195], a[112:115]
s_waitcnt vmcnt(13)
s_barrier
v_xor_b32 v3, 0x8000, v3
buffer_load_dwordx4 v[160:163], v14, s[44:47], s65 offen offset:1024 sc1
s_waitcnt lgkmcnt(4)
v_mfma_f32_16x16x32_bf16 a[116:119], a[184:187], v[192:195], a[116:119]
v_exp_f32 v147, v147
v_mfma_f32_16x16x32_bf16 a[116:119], a[188:191], v[196:199], a[116:119]
buffer_load_dwordx4 v[168:171], v15, s[44:47], s65 offen offset:0 sc1
v_mfma_f32_16x16x32_bf16 a[84:87], a[188:191], v[188:191], a[84:87]
v_exp_f32 v148, v148
v_mfma_f32_16x16x32_bf16 a[84:87], a[184:187], v[184:187], a[84:87]
s_waitcnt lgkmcnt(2)
buffer_load_dwordx4 v[176:179], v15, s[44:47], s65 offen offset:1024 sc1
v_cvt_pk_bf16_f32 v212, v144, v145
v_mfma_f32_16x16x32_bf16 a[88:91], a[192:195], v[184:187], a[88:91]
s_add_u32 s65, s84, 40960
v_exp_f32 v149, v149
v_mfma_f32_16x16x32_bf16 a[88:91], a[196:199], v[188:191], a[88:91]
buffer_load_dwordx4 v[156:159], v14, s[44:47], s65 offen offset:0 sc1
v_mfma_f32_16x16x32_bf16 a[120:123], a[196:199], v[196:199], a[120:123]
ds_read_b128 a[144:147], v3 offset:0
v_cvt_pk_bf16_f32 v213, v146, v147
v_mfma_f32_16x16x32_bf16 a[120:123], a[192:195], v[192:195], a[120:123]
s_waitcnt lgkmcnt(1)
buffer_load_dwordx4 v[164:167], v14, s[44:47], s65 offen offset:1024 sc1
ds_read_b128 a[148:151], v3 offset:8192
v_exp_f32 v150, v150
v_mfma_f32_16x16x32_bf16 a[124:127], a[200:203], v[192:195], a[124:127]
ds_read_b128 a[152:155], v3 offset:1024
v_cvt_pk_bf16_f32 v214, v148, v149
v_mfma_f32_16x16x32_bf16 a[124:127], a[204:207], v[196:199], a[124:127]
buffer_load_dwordx4 v[172:175], v15, s[44:47], s65 offen offset:0 sc1
ds_read_b128 a[156:159], v3 offset:9216
v_mfma_f32_16x16x32_bf16 a[92:95], a[204:207], v[188:191], a[92:95]
v_exp_f32 v151, v151
v_mfma_f32_16x16x32_bf16 a[92:95], a[200:203], v[184:187], a[92:95]
buffer_load_dwordx4 v[180:183], v15, s[44:47], s65 offen offset:1024 sc1
ds_read_b128 a[160:163], v3 offset:2048
ds_read_b128 a[164:167], v3 offset:10240
ds_read_b128 a[168:171], v3 offset:3072
ds_read_b128 a[172:175], v3 offset:11264
v_cvt_pk_bf16_f32 v215, v150, v151
v_accvgpr_read_b32 v22, a136
v_accvgpr_read_b32 v248, a137
v_add_f32 v22, v22, v248
v_max_f32 v1, v1, v22
v_rcp_f32 v22, v22
v_accvgpr_read_b32 v232, a64
v_accvgpr_read_b32 v233, a65
v_accvgpr_read_b32 v234, a66
v_accvgpr_read_b32 v235, a67
v_accvgpr_read_b32 v236, a68
v_accvgpr_read_b32 v237, a69
v_accvgpr_read_b32 v238, a70
v_accvgpr_read_b32 v239, a71
v_mul_f32 v22, v22, v8
v_mul_f32 v232, v232, v22
v_mul_f32 v233, v233, v22
v_mul_f32 v234, v234, v22
v_mul_f32 v235, v235, v22
v_mul_f32 v236, v236, v22
v_mul_f32 v237, v237, v22
v_mul_f32 v238, v238, v22
v_mul_f32 v239, v239, v22
v_cvt_pk_bf16_f32 v232, v232, v233
v_cvt_pk_bf16_f32 v233, v234, v235
v_cvt_pk_bf16_f32 v234, v236, v237
v_cvt_pk_bf16_f32 v235, v238, v239
s_add_u32 s77, s75, 0
buffer_store_dwordx4 v[232:235], v16, s[44:47], s77 offen sc1
s_branch L_TAIL
L_fallback_11:
s_waitcnt vmcnt(0) lgkmcnt(0)
s_barrier
s_mov_b32 s73, 1
s_mov_b32 s81, 0
v_and_b32 v232, 15, v0
v_lshrrev_b32 v233, 4, v0
v_lshlrev_b32 v233, 2, v233
v_sub_u32 v232, v232, v233
s_lshl_b32 s66, s30, 4
v_add_u32 v232, s66, v232
s_lshl_b32 s66, s16, 7
v_add_u32 v234, s66, v232
s_lshl_b32 s66, s3, 7
v_add_u32 v232, s66, v232
v_add_u32 v233, 64, v232
v_add_u32 v235, 64, v234
s_mov_b32 m0, s76
s_lshl_b32 s64, s30, 14
s_nop 0
buffer_load_dwordx4 v16, s[32:35], s64 offen offset:0 sc1 lds
s_nop 0
buffer_load_dwordx4 v16, s[32:35], s64 offen offset:1024 sc1 lds
s_nop 0
buffer_load_dwordx4 v16, s[32:35], s64 offen offset:2048 sc1 lds
s_nop 0
buffer_load_dwordx4 v16, s[32:35], s64 offen offset:3072 sc1 lds
s_add_u32 m0, s76, 4096
s_add_u32 s64, s64, 4096
s_nop 0
buffer_load_dwordx4 v16, s[32:35], s64 offen offset:0 sc1 lds
s_nop 0
buffer_load_dwordx4 v16, s[32:35], s64 offen offset:1024 sc1 lds
s_nop 0
buffer_load_dwordx4 v16, s[32:35], s64 offen offset:2048 sc1 lds
s_nop 0
buffer_load_dwordx4 v16, s[32:35], s64 offen offset:3072 sc1 lds
s_lshr_b32 s64, s76, 1
s_add_u32 m0, s64, 81920
s_and_b32 s71, s64, 8192
s_add_u32 s64, s64, s71
s_add_u32 s64, s64, 8192
s_nop 0
buffer_load_dwordx4 v16, s[32:35], s64 offen offset:0 sc1 lds
s_nop 0
buffer_load_dwordx4 v16, s[32:35], s64 offen offset:1024 sc1 lds
s_nop 0
buffer_load_dwordx4 v16, s[32:35], s64 offen offset:2048 sc1 lds
s_nop 0
buffer_load_dwordx4 v16, s[32:35], s64 offen offset:3072 sc1 lds
v_mov_b32 v20, 0xff800000
v_mov_b32 v21, 0xff800000
v_mov_b32 v22, 0xff800000
v_mov_b32 v23, 0xff800000
L_fbl_1015:
buffer_load_dwordx4 a[144:147], v16, s[32:35], s81 offen offset:0 sc1
buffer_load_dwordx4 a[148:151], v16, s[32:35], s81 offen offset:1024 sc1
buffer_load_dwordx4 a[152:155], v16, s[32:35], s81 offen offset:2048 sc1
buffer_load_dwordx4 a[156:159], v16, s[32:35], s81 offen offset:3072 sc1
s_add_u32 s64, s81, 4096
buffer_load_dwordx4 a[160:163], v16, s[32:35], s64 offen offset:0 sc1
buffer_load_dwordx4 a[164:167], v16, s[32:35], s64 offen offset:1024 sc1
buffer_load_dwordx4 a[168:171], v16, s[32:35], s64 offen offset:2048 sc1
buffer_load_dwordx4 a[172:175], v16, s[32:35], s64 offen offset:3072 sc1
v_subrev_u32 v88, 0, v232
v_ashrrev_i32 v88, 31, v88
v_and_b32 v88, 0xff800000, v88
v_subrev_u32 v89, 1, v232
v_ashrrev_i32 v89, 31, v89
v_and_b32 v89, 0xff800000, v89
v_subrev_u32 v90, 2, v232
v_ashrrev_i32 v90, 31, v90
v_and_b32 v90, 0xff800000, v90
v_subrev_u32 v91, 3, v232
v_ashrrev_i32 v91, 31, v91
v_and_b32 v91, 0xff800000, v91
v_subrev_u32 v92, 16, v232
v_ashrrev_i32 v92, 31, v92
v_and_b32 v92, 0xff800000, v92
v_subrev_u32 v93, 17, v232
v_ashrrev_i32 v93, 31, v93
v_and_b32 v93, 0xff800000, v93
v_subrev_u32 v94, 18, v232
v_ashrrev_i32 v94, 31, v94
v_and_b32 v94, 0xff800000, v94
v_subrev_u32 v95, 19, v232
v_ashrrev_i32 v95, 31, v95
v_and_b32 v95, 0xff800000, v95
v_subrev_u32 v232, 32, v232
v_subrev_u32 v104, 0, v233
v_ashrrev_i32 v104, 31, v104
v_and_b32 v104, 0xff800000, v104
v_subrev_u32 v105, 1, v233
v_ashrrev_i32 v105, 31, v105
v_and_b32 v105, 0xff800000, v105
v_subrev_u32 v106, 2, v233
v_ashrrev_i32 v106, 31, v106
v_and_b32 v106, 0xff800000, v106
v_subrev_u32 v107, 3, v233
v_ashrrev_i32 v107, 31, v107
v_and_b32 v107, 0xff800000, v107
v_subrev_u32 v108, 16, v233
v_ashrrev_i32 v108, 31, v108
v_and_b32 v108, 0xff800000, v108
v_subrev_u32 v109, 17, v233
v_ashrrev_i32 v109, 31, v109
v_and_b32 v109, 0xff800000, v109
v_subrev_u32 v110, 18, v233
v_ashrrev_i32 v110, 31, v110
v_and_b32 v110, 0xff800000, v110
v_subrev_u32 v111, 19, v233
v_ashrrev_i32 v111, 31, v111
v_and_b32 v111, 0xff800000, v111
v_subrev_u32 v233, 32, v233
v_subrev_u32 v120, 0, v234
v_ashrrev_i32 v120, 31, v120
v_and_b32 v120, 0xff800000, v120
v_subrev_u32 v121, 1, v234
v_ashrrev_i32 v121, 31, v121
v_and_b32 v121, 0xff800000, v121
v_subrev_u32 v122, 2, v234
v_ashrrev_i32 v122, 31, v122
v_and_b32 v122, 0xff800000, v122
v_subrev_u32 v123, 3, v234
v_ashrrev_i32 v123, 31, v123
v_and_b32 v123, 0xff800000, v123
v_subrev_u32 v124, 16, v234
v_ashrrev_i32 v124, 31, v124
v_and_b32 v124, 0xff800000, v124
v_subrev_u32 v125, 17, v234
v_ashrrev_i32 v125, 31, v125
v_and_b32 v125, 0xff800000, v125
v_subrev_u32 v126, 18, v234
v_ashrrev_i32 v126, 31, v126
v_and_b32 v126, 0xff800000, v126
v_subrev_u32 v127, 19, v234
v_ashrrev_i32 v127, 31, v127
v_and_b32 v127, 0xff800000, v127
v_subrev_u32 v234, 32, v234
v_subrev_u32 v136, 0, v235
v_ashrrev_i32 v136, 31, v136
v_and_b32 v136, 0xff800000, v136
v_subrev_u32 v137, 1, v235
v_ashrrev_i32 v137, 31, v137
v_and_b32 v137, 0xff800000, v137
v_subrev_u32 v138, 2, v235
v_ashrrev_i32 v138, 31, v138
v_and_b32 v138, 0xff800000, v138
v_subrev_u32 v139, 3, v235
v_ashrrev_i32 v139, 31, v139
v_and_b32 v139, 0xff800000, v139
v_subrev_u32 v140, 16, v235
v_ashrrev_i32 v140, 31, v140
v_and_b32 v140, 0xff800000, v140
v_subrev_u32 v141, 17, v235
v_ashrrev_i32 v141, 31, v141
v_and_b32 v141, 0xff800000, v141
v_subrev_u32 v142, 18, v235
v_ashrrev_i32 v142, 31, v142
v_and_b32 v142, 0xff800000, v142
v_subrev_u32 v143, 19, v235
v_ashrrev_i32 v143, 31, v143
v_and_b32 v143, 0xff800000, v143
v_subrev_u32 v235, 32, v235
s_waitcnt vmcnt(0)
v_mfma_f32_16x16x32_bf16 v[88:91], a[144:147], v[24:27], v[88:91]
v_mfma_f32_16x16x32_bf16 v[104:107], a[144:147], v[40:43], v[104:107]
v_mfma_f32_16x16x32_bf16 v[120:123], a[144:147], v[56:59], v[120:123]
v_mfma_f32_16x16x32_bf16 v[136:139], a[144:147], v[72:75], v[136:139]
v_mfma_f32_16x16x32_bf16 v[88:91], a[148:151], v[28:31], v[88:91]
v_mfma_f32_16x16x32_bf16 v[104:107], a[148:151], v[44:47], v[104:107]
v_mfma_f32_16x16x32_bf16 v[120:123], a[148:151], v[60:63], v[120:123]
v_mfma_f32_16x16x32_bf16 v[136:139], a[148:151], v[76:79], v[136:139]
v_mfma_f32_16x16x32_bf16 v[88:91], a[152:155], v[32:35], v[88:91]
v_mfma_f32_16x16x32_bf16 v[104:107], a[152:155], v[48:51], v[104:107]
v_mfma_f32_16x16x32_bf16 v[120:123], a[152:155], v[64:67], v[120:123]
v_mfma_f32_16x16x32_bf16 v[136:139], a[152:155], v[80:83], v[136:139]
v_mfma_f32_16x16x32_bf16 v[88:91], a[156:159], v[36:39], v[88:91]
v_mfma_f32_16x16x32_bf16 v[104:107], a[156:159], v[52:55], v[104:107]
v_mfma_f32_16x16x32_bf16 v[120:123], a[156:159], v[68:71], v[120:123]
v_mfma_f32_16x16x32_bf16 v[136:139], a[156:159], v[84:87], v[136:139]
v_mfma_f32_16x16x32_bf16 v[92:95], a[160:163], v[24:27], v[92:95]
v_mfma_f32_16x16x32_bf16 v[108:111], a[160:163], v[40:43], v[108:111]
v_mfma_f32_16x16x32_bf16 v[124:127], a[160:163], v[56:59], v[124:127]
v_mfma_f32_16x16x32_bf16 v[140:143], a[160:163], v[72:75], v[140:143]
v_mfma_f32_16x16x32_bf16 v[92:95], a[164:167], v[28:31], v[92:95]
v_mfma_f32_16x16x32_bf16 v[108:111], a[164:167], v[44:47], v[108:111]
v_mfma_f32_16x16x32_bf16 v[124:127], a[164:167], v[60:63], v[124:127]
v_mfma_f32_16x16x32_bf16 v[140:143], a[164:167], v[76:79], v[140:143]
v_mfma_f32_16x16x32_bf16 v[92:95], a[168:171], v[32:35], v[92:95]
v_mfma_f32_16x16x32_bf16 v[108:111], a[168:171], v[48:51], v[108:111]
v_mfma_f32_16x16x32_bf16 v[124:127], a[168:171], v[64:67], v[124:127]
v_mfma_f32_16x16x32_bf16 v[140:143], a[168:171], v[80:83], v[140:143]
v_mfma_f32_16x16x32_bf16 v[92:95], a[172:175], v[36:39], v[92:95]
v_mfma_f32_16x16x32_bf16 v[108:111], a[172:175], v[52:55], v[108:111]
v_mfma_f32_16x16x32_bf16 v[124:127], a[172:175], v[68:71], v[124:127]
v_mfma_f32_16x16x32_bf16 v[140:143], a[172:175], v[84:87], v[140:143]
s_nop 7
v_max3_f32 v20, v20, v88, v89
v_max3_f32 v20, v20, v90, v91
v_max3_f32 v20, v20, v92, v93
v_max3_f32 v20, v20, v94, v95
v_max3_f32 v21, v21, v104, v105
v_max3_f32 v21, v21, v106, v107
v_max3_f32 v21, v21, v108, v109
v_max3_f32 v21, v21, v110, v111
v_max3_f32 v22, v22, v120, v121
v_max3_f32 v22, v22, v122, v123
v_max3_f32 v22, v22, v124, v125
v_max3_f32 v22, v22, v126, v127
v_max3_f32 v23, v23, v136, v137
v_max3_f32 v23, v23, v138, v139
v_max3_f32 v23, v23, v140, v141
v_max3_f32 v23, v23, v142, v143
s_add_u32 s81, s81, 16384
s_cmp_lt_u32 s81, s34
s_cbranch_scc1 L_fbl_1015
v_mov_b32 v248, v20
v_mov_b32 v249, v21
v_mov_b32 v250, v22
v_mov_b32 v251, v23
v_permlane16_swap_b32 v248, v20
v_permlane16_swap_b32 v249, v21
v_permlane16_swap_b32 v250, v22
v_permlane16_swap_b32 v251, v23
v_max_f32 v20, v20, v248
v_max_f32 v21, v21, v249
v_max_f32 v22, v22, v250
v_max_f32 v23, v23, v251
v_mov_b32 v248, v20
v_mov_b32 v249, v21
v_mov_b32 v250, v22
v_mov_b32 v251, v23
v_permlane32_swap_b32 v248, v20
v_permlane32_swap_b32 v249, v21
v_permlane32_swap_b32 v250, v22
v_permlane32_swap_b32 v251, v23
v_max_f32 v20, v20, v248
v_max_f32 v21, v21, v249
v_max_f32 v22, v22, v250
v_max_f32 v23, v23, v251
v_mov_b32 v252, v20
v_mov_b32 v253, v21
v_mov_b32 v254, v22
v_mov_b32 v255, v23
s_and_b32 s70, s30, 1
s_lshr_b32 s67, s30, 1
s_lshl3_add_u32 s71, s67, s70
s_add_u32 s71, s71, 4
s_lshl_b32 s71, s71, 13
s_lshl_b32 s70, s70, 14
s_mul_i32 s67, s67, 24576
s_sub_u32 s70, s70, s67
s_add_u32 s70, s70, 65536
s_branch L_attstart_7
L_spin_2016:
s_mov_b32 vcc_hi, 0x80000
L_spinlp_2018:
s_sleep 1
buffer_load_dword v19, off, s[52:55], s72 offset:0 sc1
s_waitcnt vmcnt(0)
v_readfirstlane_b32 vcc_lo, v19
s_sub_u32 vcc_hi, vcc_hi, 1
s_cbranch_scc1 L_spinbk_2017
s_cmp_lt_u32 vcc_lo, 8
s_cbranch_scc1 L_spinlp_2018
s_branch L_spinbk_2017
L_spin_3019:
s_mov_b32 vcc_hi, 0x80000
L_spinlp_3021:
s_sleep 1
buffer_load_dword v19, off, s[52:55], s72 offset:0 sc1
s_waitcnt vmcnt(0)
v_readfirstlane_b32 vcc_lo, v19
s_sub_u32 vcc_hi, vcc_hi, 1
s_cbranch_scc1 L_spinbk_3020
s_cmp_lt_u32 vcc_lo, 8
s_cbranch_scc1 L_spinlp_3021
s_branch L_spinbk_3020
.p2align 12
L_pg24:
s_branch L_tr1
L_p5f0:
s_waitcnt lgkmcnt(10)
s_waitcnt vmcnt(28)
v_mfma_f32_16x16x32_bf16 v[136:139], a[144:147], a[232:235], 0
s_waitcnt vmcnt(24)
s_waitcnt lgkmcnt(8)
s_add_u32 m0, s86, 65536
ds_read_b64_tr_b16 a[168:169], v191 offset:32768
v_xor_b32 v192, 0x10000, v184
v_mfma_f32_16x16x32_bf16 v[136:139], a[148:151], a[236:239], v[136:139]
s_add_u32 s64, s85, 524288
ds_read_b64_tr_b16 a[170:171], v191 offset:36864
v_xor_b32 v193, 0x10000, v185
v_mfma_f32_16x16x32_bf16 v[104:107], a[148:151], a[228:231], 0
buffer_load_dwordx4 v12, s[36:39], s64 offen lds
v_mfma_f32_16x16x32_bf16 v[104:107], a[144:147], a[224:227], v[104:107]
s_add_u32 m0, s86, 66560
s_add_u32 s64, s85, 532480
ds_read_b64_tr_b16 a[172:173], v191 offset:40960
v_xor_b32 v194, 0x10000, v186
v_mfma_f32_16x16x32_bf16 v[72:75], a[144:147], a[216:219], 0
s_and_b32 s71, s31, 4
buffer_load_dwordx4 v13, s[36:39], s64 offen lds
v_mfma_f32_16x16x32_bf16 v[72:75], a[148:151], a[220:223], v[72:75]
s_lshl_b32 s71, s71, 5
s_add_u32 s71, s71, s79
s_add_u32 m0, s86, 67584
s_add_u32 s64, s85, 540672
ds_read_b64_tr_b16 a[174:175], v191 offset:45056
v_mfma_f32_16x16x32_bf16 v[40:43], a[148:151], a[212:215], 0
s_add_u32 s71, s71, 4096
buffer_load_dwordx4 v12, s[36:39], s64 offen lds
v_mfma_f32_16x16x32_bf16 v[40:43], a[144:147], a[208:211], v[40:43]
s_waitcnt lgkmcnt(4)
s_add_u32 s72, s80, 4096
s_add_u32 m0, s86, 68608
s_add_u32 s64, s85, 548864
ds_read_b64_tr_b16 a[176:177], v184 offset:32768
v_xor_b32 v195, 0x10000, v187
v_mfma_f32_16x16x32_bf16 v[44:47], a[152:155], a[208:211], 0
buffer_load_dwordx4 v13, s[36:39], s64 offen lds
v_mfma_f32_16x16x32_bf16 v[44:47], a[156:159], a[212:215], v[44:47]
s_add_u32 m0, s86, 69632
ds_read_b64_tr_b16 a[178:179], v184 offset:36864
v_xor_b32 v196, 0x10000, v188
v_mfma_f32_16x16x32_bf16 v[76:79], a[156:159], a[220:223], 0
s_add_u32 s64, s85, 557056
ds_read_b64_tr_b16 a[180:181], v184 offset:40960
v_xor_b32 v197, 0x10000, v189
v_mfma_f32_16x16x32_bf16 v[76:79], a[152:155], a[216:219], v[76:79]
buffer_load_dwordx4 v12, s[36:39], s64 offen lds
v_mfma_f32_16x16x32_bf16 v[108:111], a[152:155], a[224:227], 0
s_add_u32 m0, s86, 70656
s_add_u32 s64, s85, 565248
ds_read_b64_tr_b16 a[182:183], v184 offset:45056
v_xor_b32 v198, 0x10000, v190
v_mfma_f32_16x16x32_bf16 v[108:111], a[156:159], a[228:231], v[108:111]
buffer_load_dwordx4 v13, s[36:39], s64 offen lds
v_mfma_f32_16x16x32_bf16 v[140:143], a[156:159], a[236:239], 0
s_add_u32 m0, s86, 71680
s_add_u32 s64, s85, 573440
ds_read_b64_tr_b16 a[184:185], v185 offset:32768
v_xor_b32 v199, 0x10000, v191
v_mfma_f32_16x16x32_bf16 v[140:143], a[152:155], a[232:235], v[140:143]
buffer_load_dwordx4 v12, s[36:39], s64 offen lds
v_mfma_f32_16x16x32_bf16 v[144:147], a[160:163], a[232:235], 0
s_add_u32 m0, s86, 72704
ds_read_b64_tr_b16 a[186:187], v185 offset:36864
v_mfma_f32_16x16x32_bf16 v[144:147], a[164:167], a[236:239], v[144:147]
s_add_u32 s64, s85, 581632
ds_read_b64_tr_b16 a[188:189], v185 offset:40960
v_mfma_f32_16x16x32_bf16 v[112:115], a[164:167], a[228:231], 0
buffer_load_dwordx4 v13, s[36:39], s64 offen lds
v_mfma_f32_16x16x32_bf16 v[112:115], a[160:163], a[224:227], v[112:115]
s_add_u32 s65, s84, 65536
ds_read_b64_tr_b16 a[190:191], v185 offset:45056
v_mfma_f32_16x16x32_bf16 v[80:83], a[160:163], a[216:219], 0
buffer_load_dwordx4 a[0:3], v14, s[44:47], s65 offen offset:0 sc1
v_mfma_f32_16x16x32_bf16 v[80:83], a[164:167], a[220:223], v[80:83]
ds_read_b64_tr_b16 a[192:193], v186 offset:32768
v_mfma_f32_16x16x32_bf16 v[48:51], a[164:167], a[212:215], 0
buffer_load_dwordx4 a[8:11], v14, s[44:47], s65 offen offset:1024 sc1
v_mfma_f32_16x16x32_bf16 v[48:51], a[160:163], a[208:211], v[48:51]
s_waitcnt lgkmcnt(4)
ds_read_b64_tr_b16 a[194:195], v186 offset:36864
v_mfma_f32_16x16x32_bf16 v[52:55], a[168:171], a[208:211], 0
ds_read_b64_tr_b16 a[196:197], v186 offset:40960
v_mfma_f32_16x16x32_bf16 v[52:55], a[172:175], a[212:215], v[52:55]
buffer_load_dwordx4 a[16:19], v15, s[44:47], s65 offen offset:0 sc1
v_mfma_f32_16x16x32_bf16 v[84:87], a[172:175], a[220:223], 0
ds_read_b64_tr_b16 a[198:199], v186 offset:45056
v_mfma_f32_16x16x32_bf16 v[84:87], a[168:171], a[216:219], v[84:87]
buffer_load_dwordx4 a[24:27], v15, s[44:47], s65 offen offset:1024 sc1
v_mfma_f32_16x16x32_bf16 v[116:119], a[168:171], a[224:227], 0
s_add_u32 s65, s84, 73728
ds_read_b64_tr_b16 a[200:201], v187 offset:32768
v_mfma_f32_16x16x32_bf16 v[116:119], a[172:175], a[228:231], v[116:119]
buffer_load_dwordx4 a[4:7], v14, s[44:47], s65 offen offset:0 sc1
v_mfma_f32_16x16x32_bf16 v[148:151], a[172:175], a[236:239], 0
ds_read_b64_tr_b16 a[202:203], v187 offset:36864
v_mfma_f32_16x16x32_bf16 v[148:151], a[168:171], a[232:235], v[148:151]
ds_read_b64_tr_b16 a[204:205], v187 offset:40960
v_mfma_f32_16x16x32_bf16 v[120:123], a[176:179], a[232:235], 0
buffer_load_dwordx4 a[12:15], v14, s[44:47], s65 offen offset:1024 sc1
v_mfma_f32_16x16x32_bf16 v[120:123], a[180:183], a[236:239], v[120:123]
ds_read_b64_tr_b16 a[206:207], v187 offset:45056
v_mfma_f32_16x16x32_bf16 v[88:91], a[180:183], a[228:231], 0
buffer_load_dwordx4 a[20:23], v15, s[44:47], s65 offen offset:0 sc1
v_mfma_f32_16x16x32_bf16 v[88:91], a[176:179], a[224:227], v[88:91]
v_mfma_f32_16x16x32_bf16 v[56:59], a[176:179], a[216:219], 0
buffer_load_dwordx4 a[28:31], v15, s[44:47], s65 offen offset:1024 sc1
v_mfma_f32_16x16x32_bf16 v[56:59], a[180:183], a[220:223], v[56:59]
v_mfma_f32_16x16x32_bf16 v[24:27], a[180:183], a[212:215], 0
v_mfma_f32_16x16x32_bf16 v[24:27], a[176:179], a[208:211], v[24:27]
s_waitcnt lgkmcnt(1)
v_mfma_f32_16x16x32_bf16 v[28:31], a[184:187], a[208:211], 0
s_waitcnt vmcnt(23)
s_barrier
v_mfma_f32_16x16x32_bf16 v[28:31], a[188:191], a[212:215], v[28:31]
ds_read_b64_tr_b16 a[144:145], v196 offset:0
v_mfma_f32_16x16x32_bf16 v[60:63], a[188:191], a[220:223], 0
ds_read_b64_tr_b16 a[146:147], v196 offset:4096
v_mfma_f32_16x16x32_bf16 v[60:63], a[184:187], a[216:219], v[60:63]
s_add_u32 m0, s86, 0
ds_read_b64_tr_b16 a[148:149], v196 offset:8192
v_mfma_f32_16x16x32_bf16 v[92:95], a[184:187], a[224:227], 0
s_add_u32 s64, s85, 786432
ds_read_b64_tr_b16 a[150:151], v196 offset:12288
v_mfma_f32_16x16x32_bf16 v[92:95], a[188:191], a[228:231], v[92:95]
buffer_load_dwordx4 v12, s[36:39], s64 offen lds
v_mfma_f32_16x16x32_bf16 v[124:127], a[188:191], a[236:239], 0
s_add_u32 m0, s86, 1024
ds_read_b64_tr_b16 a[152:153], v197 offset:0
v_mfma_f32_16x16x32_bf16 v[124:127], a[184:187], a[232:235], v[124:127]
s_add_u32 s64, s85, 794624
ds_read_b64_tr_b16 a[154:155], v197 offset:4096
v_mfma_f32_16x16x32_bf16 v[128:131], a[192:195], a[232:235], 0
buffer_load_dwordx4 v13, s[36:39], s64 offen lds
v_mfma_f32_16x16x32_bf16 v[128:131], a[196:199], a[236:239], v[128:131]
ds_read_b64_tr_b16 a[156:157], v197 offset:8192
v_mfma_f32_16x16x32_bf16 v[96:99], a[196:199], a[228:231], 0
s_add_u32 m0, s86, 2048
ds_read_b64_tr_b16 a[158:159], v197 offset:12288
v_mfma_f32_16x16x32_bf16 v[96:99], a[192:195], a[224:227], v[96:99]
s_add_u32 s64, s85, 802816
ds_read_b64_tr_b16 a[160:161], v198 offset:0
v_mfma_f32_16x16x32_bf16 v[64:67], a[192:195], a[216:219], 0
buffer_load_dwordx4 v12, s[36:39], s64 offen lds
v_mfma_f32_16x16x32_bf16 v[64:67], a[196:199], a[220:223], v[64:67]
ds_read_b64_tr_b16 a[162:163], v198 offset:4096
v_mfma_f32_16x16x32_bf16 v[32:35], a[196:199], a[212:215], 0
s_add_u32 m0, s86, 3072
ds_read_b64_tr_b16 a[164:165], v198 offset:8192
v_mfma_f32_16x16x32_bf16 v[32:35], a[192:195], a[208:211], v[32:35]
s_add_u32 s64, s85, 811008
ds_read_b64_tr_b16 a[166:167], v198 offset:12288
v_mfma_f32_16x16x32_bf16 v[36:39], a[200:203], a[208:211], 0
s_waitcnt lgkmcnt(6)
buffer_load_dwordx4 v13, s[36:39], s64 offen lds
v_mfma_f32_16x16x32_bf16 v[36:39], a[204:207], a[212:215], v[36:39]
v_mfma_f32_16x16x32_bf16 v[68:71], a[204:207], a[220:223], 0
s_add_u32 m0, s86, 4096
v_mfma_f32_16x16x32_bf16 v[68:71], a[200:203], a[216:219], v[68:71]
s_add_u32 s64, s85, 819200
v_mfma_f32_16x16x32_bf16 v[100:103], a[200:203], a[224:227], 0
buffer_load_dwordx4 v12, s[36:39], s64 offen lds
v_mfma_f32_16x16x32_bf16 v[100:103], a[204:207], a[228:231], v[100:103]
v_mfma_f32_16x16x32_bf16 v[132:135], a[204:207], a[236:239], 0
v_mfma_f32_16x16x32_bf16 v[132:135], a[200:203], a[232:235], v[132:135]
v_mfma_f32_16x16x32_bf16 v[136:139], a[144:147], v[176:179], v[136:139]
s_add_u32 m0, s86, 5120
ds_read_b64_tr_b16 a[168:169], v199 offset:0
v_xor_b32 v200, 0x18000, v184
v_mfma_f32_16x16x32_bf16 v[136:139], a[148:151], v[180:183], v[136:139]
s_add_u32 s64, s85, 827392
ds_read_b64_tr_b16 a[170:171], v199 offset:4096
v_xor_b32 v201, 0x18000, v185
v_mfma_f32_16x16x32_bf16 v[104:107], a[148:151], v[172:175], v[104:107]
buffer_load_dwordx4 v13, s[36:39], s64 offen lds
v_mfma_f32_16x16x32_bf16 v[104:107], a[144:147], v[168:171], v[104:107]
s_add_u32 m0, s86, 6144
ds_read_b64_tr_b16 a[172:173], v199 offset:8192
v_xor_b32 v202, 0x18000, v186
v_mfma_f32_16x16x32_bf16 v[72:75], a[144:147], v[160:163], v[72:75]
s_add_u32 s64, s85, 835584
ds_read_b64_tr_b16 a[174:175], v199 offset:12288
v_xor_b32 v203, 0x18000, v187
v_mfma_f32_16x16x32_bf16 v[72:75], a[148:151], v[164:167], v[72:75]
buffer_load_dwordx4 v12, s[36:39], s64 offen lds
v_mfma_f32_16x16x32_bf16 v[40:43], a[148:151], v[156:159], v[40:43]
s_add_u32 m0, s86, 7168
ds_read_b64_tr_b16 a[176:177], v192 offset:0
v_xor_b32 v204, 0x18000, v188
v_mfma_f32_16x16x32_bf16 v[40:43], a[144:147], v[152:155], v[40:43]
s_add_u32 s64, s85, 843776
ds_read_b64_tr_b16 a[178:179], v192 offset:4096
v_xor_b32 v205, 0x18000, v189
v_mfma_f32_16x16x32_bf16 v[44:47], a[152:155], v[152:155], v[44:47]
s_waitcnt lgkmcnt(5)
buffer_load_dwordx4 v13, s[36:39], s64 offen lds
v_mfma_f32_16x16x32_bf16 v[44:47], a[156:159], v[156:159], v[44:47]
ds_read_b64_tr_b16 a[180:181], v192 offset:8192
v_xor_b32 v206, 0x18000, v190
v_mfma_f32_16x16x32_bf16 v[76:79], a[156:159], v[164:167], v[76:79]
ds_read_b64_tr_b16 a[182:183], v192 offset:12288
v_xor_b32 v207, 0x18000, v191
v_mfma_f32_16x16x32_bf16 v[76:79], a[152:155], v[160:163], v[76:79]
s_add_u32 s65, s84, 98304
ds_read_b64_tr_b16 a[184:185], v193 offset:0
v_mfma_f32_16x16x32_bf16 v[108:111], a[152:155], v[168:171], v[108:111]
buffer_load_dwordx4 a[64:67], v14, s[44:47], s65 offen offset:0 sc1
v_mfma_f32_16x16x32_bf16 v[108:111], a[156:159], v[172:175], v[108:111]
ds_read_b64_tr_b16 a[186:187], v193 offset:4096
v_mfma_f32_16x16x32_bf16 v[140:143], a[156:159], v[180:183], v[140:143]
ds_read_b64_tr_b16 a[188:189], v193 offset:8192
v_mfma_f32_16x16x32_bf16 v[140:143], a[152:155], v[176:179], v[140:143]
buffer_load_dwordx4 a[72:75], v14, s[44:47], s65 offen offset:1024 sc1
v_mfma_f32_16x16x32_bf16 v[144:147], a[160:163], v[176:179], v[144:147]
ds_read_b64_tr_b16 a[190:191], v193 offset:12288
v_mfma_f32_16x16x32_bf16 v[144:147], a[164:167], v[180:183], v[144:147]
v_mfma_f32_16x16x32_bf16 v[112:115], a[164:167], v[172:175], v[112:115]
buffer_load_dwordx4 a[80:83], v15, s[44:47], s65 offen offset:0 sc1
v_mfma_f32_16x16x32_bf16 v[112:115], a[160:163], v[168:171], v[112:115]
ds_read_b64_tr_b16 a[192:193], v194 offset:0
v_mfma_f32_16x16x32_bf16 v[80:83], a[160:163], v[160:163], v[80:83]
ds_read_b64_tr_b16 a[194:195], v194 offset:4096
v_mfma_f32_16x16x32_bf16 v[80:83], a[164:167], v[164:167], v[80:83]
ds_read_b64_tr_b16 a[196:197], v194 offset:8192
v_mfma_f32_16x16x32_bf16 v[48:51], a[164:167], v[156:159], v[48:51]
buffer_load_dwordx4 a[88:91], v15, s[44:47], s65 offen offset:1024 sc1
v_mfma_f32_16x16x32_bf16 v[48:51], a[160:163], v[152:155], v[48:51]
s_waitcnt lgkmcnt(4)
ds_read_b64_tr_b16 a[198:199], v194 offset:12288
v_mfma_f32_16x16x32_bf16 v[52:55], a[168:171], v[152:155], v[52:55]
s_add_u32 s65, s84, 106496
v_mfma_f32_16x16x32_bf16 v[52:55], a[172:175], v[156:159], v[52:55]
buffer_load_dwordx4 a[68:71], v14, s[44:47], s65 offen offset:0 sc1
v_mfma_f32_16x16x32_bf16 v[84:87], a[172:175], v[164:167], v[84:87]
ds_read_b64_tr_b16 a[200:201], v195 offset:0
v_mfma_f32_16x16x32_bf16 v[84:87], a[168:171], v[160:163], v[84:87]
ds_read_b64_tr_b16 a[202:203], v195 offset:4096
v_mfma_f32_16x16x32_bf16 v[116:119], a[168:171], v[168:171], v[116:119]
s_lshl_b32 s66, s30, 30
buffer_load_dwordx4 a[76:79], v14, s[44:47], s65 offen offset:1024 sc1
v_mfma_f32_16x16x32_bf16 v[116:119], a[172:175], v[172:175], v[116:119]
ds_read_b64_tr_b16 a[204:205], v195 offset:8192
v_lshl_add_u32 v1, v0, 24, s66
v_mfma_f32_16x16x32_bf16 v[148:151], a[172:175], v[180:183], v[148:151]
ds_read_b64_tr_b16 a[206:207], v195 offset:12288
v_mfma_f32_16x16x32_bf16 v[148:151], a[168:171], v[176:179], v[148:151]
v_mfma_f32_16x16x32_bf16 v[120:123], a[176:179], v[176:179], v[120:123]
buffer_load_dwordx4 a[84:87], v15, s[44:47], s65 offen offset:0 sc1
v_mfma_f32_16x16x32_bf16 v[120:123], a[180:183], v[180:183], v[120:123]
v_mfma_f32_16x16x32_bf16 v[88:91], a[180:183], v[172:175], v[88:91]
v_mfma_f32_16x16x32_bf16 v[88:91], a[176:179], v[168:171], v[88:91]
buffer_load_dwordx4 a[92:95], v15, s[44:47], s65 offen offset:1024 sc1
v_mfma_f32_16x16x32_bf16 v[56:59], a[176:179], v[160:163], v[56:59]
v_mfma_f32_16x16x32_bf16 v[56:59], a[180:183], v[164:167], v[56:59]
v_mfma_f32_16x16x32_bf16 v[24:27], a[180:183], v[156:159], v[24:27]
v_mfma_f32_16x16x32_bf16 v[24:27], a[176:179], v[152:155], v[24:27]
v_mfma_f32_16x16x32_bf16 v[28:31], a[184:187], v[152:155], v[28:31]
s_waitcnt vmcnt(24)
s_barrier
s_waitcnt lgkmcnt(0)
v_mfma_f32_16x16x32_bf16 v[28:31], a[188:191], v[156:159], v[28:31]
s_mov_b64 exec, 1
buffer_atomic_add a251, v1, s[52:55], s71 offen offset:0 sc1
s_mov_b64 exec, -1
v_mfma_f32_16x16x32_bf16 v[60:63], a[188:191], v[164:167], v[60:63]
ds_read_b64_tr_b16 a[144:145], v196 offset:32768
v_mfma_f32_16x16x32_bf16 v[60:63], a[184:187], v[160:163], v[60:63]
s_add_u32 m0, s86, 98304
ds_read_b64_tr_b16 a[146:147], v196 offset:36864
v_mfma_f32_16x16x32_bf16 v[92:95], a[184:187], v[168:171], v[92:95]
s_add_u32 s64, s85, 1048576
ds_read_b64_tr_b16 a[148:149], v196 offset:40960
v_mfma_f32_16x16x32_bf16 v[92:95], a[188:191], v[172:175], v[92:95]
buffer_load_dwordx4 v12, s[36:39], s64 offen lds
v_mfma_f32_16x16x32_bf16 v[124:127], a[188:191], v[180:183], v[124:127]
s_add_u32 m0, s86, 99328
ds_read_b64_tr_b16 a[150:151], v196 offset:45056
v_mfma_f32_16x16x32_bf16 v[124:127], a[184:187], v[176:179], v[124:127]
s_add_u32 s64, s85, 1056768
ds_read_b64_tr_b16 a[152:153], v197 offset:32768
v_mfma_f32_16x16x32_bf16 v[128:131], a[192:195], v[176:179], v[128:131]
buffer_load_dwordx4 v13, s[36:39], s64 offen lds
v_mfma_f32_16x16x32_bf16 v[128:131], a[196:199], v[180:183], v[128:131]
ds_read_b64_tr_b16 a[154:155], v197 offset:36864
v_mfma_f32_16x16x32_bf16 v[96:99], a[196:199], v[172:175], v[96:99]
s_add_u32 m0, s86, 100352
ds_read_b64_tr_b16 a[156:157], v197 offset:40960
v_mfma_f32_16x16x32_bf16 v[96:99], a[192:195], v[168:171], v[96:99]
s_add_u32 s64, s85, 1064960
ds_read_b64_tr_b16 a[158:159], v197 offset:45056
v_mfma_f32_16x16x32_bf16 v[64:67], a[192:195], v[160:163], v[64:67]
buffer_load_dwordx4 v12, s[36:39], s64 offen lds
v_mfma_f32_16x16x32_bf16 v[64:67], a[196:199], v[164:167], v[64:67]
ds_read_b64_tr_b16 a[160:161], v198 offset:32768
v_mfma_f32_16x16x32_bf16 v[32:35], a[196:199], v[156:159], v[32:35]
s_add_u32 m0, s86, 101376
ds_read_b64_tr_b16 a[162:163], v198 offset:36864
v_mfma_f32_16x16x32_bf16 v[32:35], a[192:195], v[152:155], v[32:35]
s_add_u32 s64, s85, 1073152
ds_read_b64_tr_b16 a[164:165], v198 offset:40960
v_mfma_f32_16x16x32_bf16 v[36:39], a[200:203], v[152:155], v[36:39]
buffer_load_dwordx4 v13, s[36:39], s64 offen lds
v_mfma_f32_16x16x32_bf16 v[36:39], a[204:207], v[156:159], v[36:39]
ds_read_b64_tr_b16 a[166:167], v198 offset:45056
v_mfma_f32_16x16x32_bf16 v[68:71], a[204:207], v[164:167], v[68:71]
s_add_u32 m0, s86, 102400
v_mfma_f32_16x16x32_bf16 v[68:71], a[200:203], v[160:163], v[68:71]
s_add_u32 s64, s85, 1081344
v_mfma_f32_16x16x32_bf16 v[100:103], a[200:203], v[168:171], v[100:103]
buffer_load_dwordx4 v12, s[36:39], s64 offen lds
v_mfma_f32_16x16x32_bf16 v[100:103], a[204:207], v[172:175], v[100:103]
v_mfma_f32_16x16x32_bf16 v[132:135], a[204:207], v[180:183], v[132:135]
s_add_u32 m0, s86, 103424
v_mfma_f32_16x16x32_bf16 v[132:135], a[200:203], v[176:179], v[132:135]
s_waitcnt vmcnt(26)
s_waitcnt lgkmcnt(1)
s_add_u32 s64, s85, 1089536
v_mfma_f32_16x16x32_bf16 v[136:139], a[144:147], a[24:27], v[136:139]
s_waitcnt vmcnt(22)
s_and_b32 s68, s82, 3
s_lshl_b32 s68, s68, 11
ds_read_b64_tr_b16 a[168:169], v199 offset:32768
v_mfma_f32_16x16x32_bf16 v[136:139], a[148:151], a[28:31], v[136:139]
s_add_u32 s76, s86, s68
s_lshr_b32 s69, s87, 8
ds_read_b64_tr_b16 a[170:171], v199 offset:36864
v_mfma_f32_16x16x32_bf16 v[104:107], a[148:151], a[20:23], v[104:107]
s_lshr_b32 s67, s82, 1
buffer_load_dwordx4 v13, s[36:39], s64 offen lds
v_mfma_f32_16x16x32_bf16 v[104:107], a[144:147], a[16:19], v[104:107]
s_xor_b32 s69, s69, s67
s_and_b32 s69, s69, 2
s_add_u32 m0, s86, 104448
ds_read_b64_tr_b16 a[172:173], v199 offset:40960
v_mfma_f32_16x16x32_bf16 v[72:75], a[144:147], a[8:11], v[72:75]
s_lshl_b32 s69, s69, 15
s_add_u32 s68, s68, s69
s_add_u32 s64, s85, 1097728
ds_read_b64_tr_b16 a[174:175], v199 offset:45056
v_mfma_f32_16x16x32_bf16 v[72:75], a[148:151], a[12:15], v[72:75]
buffer_load_dwordx4 v12, s[36:39], s64 offen lds
v_mfma_f32_16x16x32_bf16 v[40:43], a[148:151], a[4:7], v[40:43]
s_add_u32 m0, s86, 105472
ds_read_b64_tr_b16 a[176:177], v192 offset:32768
v_mfma_f32_16x16x32_bf16 v[40:43], a[144:147], a[0:3], v[40:43]
s_add_u32 s64, s85, 1105920
ds_read_b64_tr_b16 a[178:179], v192 offset:36864
v_mfma_f32_16x16x32_bf16 v[44:47], a[152:155], a[0:3], v[44:47]
buffer_load_dwordx4 v13, s[36:39], s64 offen lds
v_mfma_f32_16x16x32_bf16 v[44:47], a[156:159], a[4:7], v[44:47]
ds_read_b64_tr_b16 a[180:181], v192 offset:40960
v_mfma_f32_16x16x32_bf16 v[76:79], a[156:159], a[12:15], v[76:79]
ds_read_b64_tr_b16 a[182:183], v192 offset:45056
v_mfma_f32_16x16x32_bf16 v[76:79], a[152:155], a[8:11], v[76:79]
s_add_u32 s65, s84, 131072
ds_read_b64_tr_b16 a[184:185], v193 offset:32768
v_mfma_f32_16x16x32_bf16 v[108:111], a[152:155], a[16:19], v[108:111]
buffer_load_dwordx4 a[32:35], v14, s[44:47], s65 offen offset:0 sc1
v_mfma_f32_16x16x32_bf16 v[108:111], a[156:159], a[20:23], v[108:111]
ds_read_b64_tr_b16 a[186:187], v193 offset:36864
v_mfma_f32_16x16x32_bf16 v[140:143], a[156:159], a[28:31], v[140:143]
ds_read_b64_tr_b16 a[188:189], v193 offset:40960
v_mfma_f32_16x16x32_bf16 v[140:143], a[152:155], a[24:27], v[140:143]
buffer_load_dwordx4 a[40:43], v14, s[44:47], s65 offen offset:1024 sc1
v_mfma_f32_16x16x32_bf16 v[144:147], a[160:163], a[24:27], v[144:147]
s_waitcnt lgkmcnt(5)
ds_read_b64_tr_b16 a[190:191], v193 offset:45056
v_mfma_f32_16x16x32_bf16 v[144:147], a[164:167], a[28:31], v[144:147]
v_mfma_f32_16x16x32_bf16 v[112:115], a[164:167], a[20:23], v[112:115]
buffer_load_dwordx4 a[48:51], v15, s[44:47], s65 offen offset:0 sc1
v_mfma_f32_16x16x32_bf16 v[112:115], a[160:163], a[16:19], v[112:115]
ds_read_b64_tr_b16 a[192:193], v194 offset:32768
v_mfma_f32_16x16x32_bf16 v[80:83], a[160:163], a[8:11], v[80:83]
ds_read_b64_tr_b16 a[194:195], v194 offset:36864
v_mfma_f32_16x16x32_bf16 v[80:83], a[164:167], a[12:15], v[80:83]
ds_read_b64_tr_b16 a[196:197], v194 offset:40960
v_mfma_f32_16x16x32_bf16 v[48:51], a[164:167], a[4:7], v[48:51]
buffer_load_dwordx4 a[56:59], v15, s[44:47], s65 offen offset:1024 sc1
v_mfma_f32_16x16x32_bf16 v[48:51], a[160:163], a[0:3], v[48:51]
ds_read_b64_tr_b16 a[198:199], v194 offset:45056
v_mfma_f32_16x16x32_bf16 v[52:55], a[168:171], a[0:3], v[52:55]
s_add_u32 s65, s84, 139264
v_mfma_f32_16x16x32_bf16 v[52:55], a[172:175], a[4:7], v[52:55]
buffer_load_dwordx4 a[36:39], v14, s[44:47], s65 offen offset:0 sc1
v_mfma_f32_16x16x32_bf16 v[84:87], a[172:175], a[12:15], v[84:87]
ds_read_b64_tr_b16 a[200:201], v195 offset:32768
v_mfma_f32_16x16x32_bf16 v[84:87], a[168:171], a[8:11], v[84:87]
ds_read_b64_tr_b16 a[202:203], v195 offset:36864
v_mfma_f32_16x16x32_bf16 v[116:119], a[168:171], a[16:19], v[116:119]
buffer_load_dwordx4 a[44:47], v14, s[44:47], s65 offen offset:1024 sc1
v_mfma_f32_16x16x32_bf16 v[116:119], a[172:175], a[20:23], v[116:119]
ds_read_b64_tr_b16 a[204:205], v195 offset:40960
v_mfma_f32_16x16x32_bf16 v[148:151], a[172:175], a[28:31], v[148:151]
ds_read_b64_tr_b16 a[206:207], v195 offset:45056
v_mfma_f32_16x16x32_bf16 v[148:151], a[168:171], a[24:27], v[148:151]
v_mfma_f32_16x16x32_bf16 v[120:123], a[176:179], a[24:27], v[120:123]
s_waitcnt lgkmcnt(4)
buffer_load_dwordx4 a[52:55], v15, s[44:47], s65 offen offset:0 sc1
v_mfma_f32_16x16x32_bf16 v[120:123], a[180:183], a[28:31], v[120:123]
v_mfma_f32_16x16x32_bf16 v[88:91], a[180:183], a[20:23], v[88:91]
v_mfma_f32_16x16x32_bf16 v[88:91], a[176:179], a[16:19], v[88:91]
buffer_load_dwordx4 a[60:63], v15, s[44:47], s65 offen offset:1024 sc1
v_mfma_f32_16x16x32_bf16 v[56:59], a[176:179], a[8:11], v[56:59]
v_mfma_f32_16x16x32_bf16 v[56:59], a[180:183], a[12:15], v[56:59]
v_mfma_f32_16x16x32_bf16 v[24:27], a[180:183], a[4:7], v[24:27]
v_mfma_f32_16x16x32_bf16 v[24:27], a[176:179], a[0:3], v[24:27]
s_lshl3_add_u32 s85, s68, s85
v_mfma_f32_16x16x32_bf16 v[28:31], a[184:187], a[0:3], v[28:31]
s_waitcnt vmcnt(25)
s_barrier
v_mfma_f32_16x16x32_bf16 v[28:31], a[188:191], a[4:7], v[28:31]
ds_read_b64_tr_b16 a[144:145], v204 offset:0
v_mfma_f32_16x16x32_bf16 v[60:63], a[188:191], a[12:15], v[60:63]
ds_read_b64_tr_b16 a[146:147], v204 offset:4096
v_mfma_f32_16x16x32_bf16 v[60:63], a[184:187], a[8:11], v[60:63]
s_xor_b32 m0, s76, 131072
ds_read_b64_tr_b16 a[148:149], v204 offset:8192
v_mfma_f32_16x16x32_bf16 v[92:95], a[184:187], a[16:19], v[92:95]
s_xor_b32 s64, s85, 0
ds_read_b64_tr_b16 a[150:151], v204 offset:12288
v_mfma_f32_16x16x32_bf16 v[92:95], a[188:191], a[20:23], v[92:95]
buffer_load_dwordx4 v12, s[40:43], s64 offen lds
v_mfma_f32_16x16x32_bf16 v[124:127], a[188:191], a[28:31], v[124:127]
s_xor_b32 m0, s76, 132096
ds_read_b64_tr_b16 a[152:153], v205 offset:0
v_mfma_f32_16x16x32_bf16 v[124:127], a[184:187], a[24:27], v[124:127]
s_xor_b32 s64, s85, 8192
ds_read_b64_tr_b16 a[154:155], v205 offset:4096
v_mfma_f32_16x16x32_bf16 v[128:131], a[192:195], a[24:27], v[128:131]
buffer_load_dwordx4 v13, s[40:43], s64 offen lds
v_mfma_f32_16x16x32_bf16 v[128:131], a[196:199], a[28:31], v[128:131]
ds_read_b64_tr_b16 a[156:157], v205 offset:8192
v_mfma_f32_16x16x32_bf16 v[96:99], a[196:199], a[20:23], v[96:99]
s_xor_b32 m0, s76, 133120
ds_read_b64_tr_b16 a[158:159], v205 offset:12288
v_mfma_f32_16x16x32_bf16 v[96:99], a[192:195], a[16:19], v[96:99]
s_xor_b32 s64, s85, 16384
ds_read_b64_tr_b16 a[160:161], v206 offset:0
v_mfma_f32_16x16x32_bf16 v[64:67], a[192:195], a[8:11], v[64:67]
buffer_load_dwordx4 v12, s[40:43], s64 offen lds
v_mfma_f32_16x16x32_bf16 v[64:67], a[196:199], a[12:15], v[64:67]
ds_read_b64_tr_b16 a[162:163], v206 offset:4096
v_mfma_f32_16x16x32_bf16 v[32:35], a[196:199], a[4:7], v[32:35]
s_xor_b32 m0, s76, 134144
ds_read_b64_tr_b16 a[164:165], v206 offset:8192
v_mfma_f32_16x16x32_bf16 v[32:35], a[192:195], a[0:3], v[32:35]
s_waitcnt lgkmcnt(5)
s_xor_b32 s64, s85, 24576
ds_read_b64_tr_b16 a[166:167], v206 offset:12288
v_mfma_f32_16x16x32_bf16 v[36:39], a[200:203], a[0:3], v[36:39]
buffer_load_dwordx4 v13, s[40:43], s64 offen lds
v_mfma_f32_16x16x32_bf16 v[36:39], a[204:207], a[4:7], v[36:39]
v_mfma_f32_16x16x32_bf16 v[68:71], a[204:207], a[12:15], v[68:71]
s_xor_b32 m0, s76, 135168
v_mfma_f32_16x16x32_bf16 v[68:71], a[200:203], a[8:11], v[68:71]
s_xor_b32 s64, s85, 32768
v_mfma_f32_16x16x32_bf16 v[100:103], a[200:203], a[16:19], v[100:103]
buffer_load_dwordx4 v12, s[40:43], s64 offen lds
v_mfma_f32_16x16x32_bf16 v[100:103], a[204:207], a[20:23], v[100:103]
v_mfma_f32_16x16x32_bf16 v[132:135], a[204:207], a[28:31], v[132:135]
v_mfma_f32_16x16x32_bf16 v[132:135], a[200:203], a[24:27], v[132:135]
s_waitcnt vmcnt(26)
v_mfma_f32_16x16x32_bf16 v[136:139], a[144:147], a[88:91], v[136:139]
s_waitcnt vmcnt(22)
s_xor_b32 m0, s76, 136192
ds_read_b64_tr_b16 a[168:169], v207 offset:0
v_mfma_f32_16x16x32_bf16 v[136:139], a[148:151], a[92:95], v[136:139]
s_xor_b32 s64, s85, 40960
ds_read_b64_tr_b16 a[170:171], v207 offset:4096
v_mfma_f32_16x16x32_bf16 v[104:107], a[148:151], a[84:87], v[104:107]
buffer_load_dwordx4 v13, s[40:43], s64 offen lds
v_mfma_f32_16x16x32_bf16 v[104:107], a[144:147], a[80:83], v[104:107]
ds_read_b64_tr_b16 a[172:173], v207 offset:8192
v_mfma_f32_16x16x32_bf16 v[72:75], a[144:147], a[72:75], v[72:75]
ds_read_b64_tr_b16 a[174:175], v207 offset:12288
v_mfma_f32_16x16x32_bf16 v[72:75], a[148:151], a[76:79], v[72:75]
ds_read_b64_tr_b16 a[176:177], v200 offset:0
v_mfma_f32_16x16x32_bf16 v[40:43], a[148:151], a[68:71], v[40:43]
ds_read_b64_tr_b16 a[178:179], v200 offset:4096
v_mfma_f32_16x16x32_bf16 v[40:43], a[144:147], a[64:67], v[40:43]
ds_read_b64_tr_b16 a[180:181], v200 offset:8192
v_mfma_f32_16x16x32_bf16 v[44:47], a[152:155], a[64:67], v[44:47]
s_waitcnt lgkmcnt(6)
s_xor_b32 m0, s76, 137216
ds_read_b64_tr_b16 a[182:183], v200 offset:12288
v_mfma_f32_16x16x32_bf16 v[44:47], a[156:159], a[68:71], v[44:47]
s_xor_b32 s64, s85, 49152
v_mfma_f32_16x16x32_bf16 v[76:79], a[156:159], a[76:79], v[76:79]
buffer_load_dwordx4 v12, s[40:43], s64 offen lds
v_mfma_f32_16x16x32_bf16 v[76:79], a[152:155], a[72:75], v[76:79]
ds_read_b64_tr_b16 a[184:185], v201 offset:0
v_mfma_f32_16x16x32_bf16 v[108:111], a[152:155], a[80:83], v[108:111]
ds_read_b64_tr_b16 a[186:187], v201 offset:4096
v_mfma_f32_16x16x32_bf16 v[108:111], a[156:159], a[84:87], v[108:111]
ds_read_b64_tr_b16 a[188:189], v201 offset:8192
v_mfma_f32_16x16x32_bf16 v[140:143], a[156:159], a[92:95], v[140:143]
ds_read_b64_tr_b16 a[190:191], v201 offset:12288
v_mfma_f32_16x16x32_bf16 v[140:143], a[152:155], a[88:91], v[140:143]
v_mfma_f32_16x16x32_bf16 v[144:147], a[160:163], a[88:91], v[144:147]
v_mfma_f32_16x16x32_bf16 v[144:147], a[164:167], a[92:95], v[144:147]
s_xor_b32 m0, s76, 138240
v_mfma_f32_16x16x32_bf16 v[112:115], a[164:167], a[84:87], v[112:115]
s_xor_b32 s64, s85, 57344
ds_read_b64_tr_b16 a[192:193], v202 offset:0
v_mfma_f32_16x16x32_bf16 v[112:115], a[160:163], a[80:83], v[112:115]
buffer_load_dwordx4 v13, s[40:43], s64 offen lds
v_mfma_f32_16x16x32_bf16 v[80:83], a[160:163], a[72:75], v[80:83]
ds_read_b64_tr_b16 a[194:195], v202 offset:4096
v_mfma_f32_16x16x32_bf16 v[80:83], a[164:167], a[76:79], v[80:83]
ds_read_b64_tr_b16 a[196:197], v202 offset:8192
v_mfma_f32_16x16x32_bf16 v[48:51], a[164:167], a[68:71], v[48:51]
ds_read_b64_tr_b16 a[198:199], v202 offset:12288
v_mfma_f32_16x16x32_bf16 v[48:51], a[160:163], a[64:67], v[48:51]
s_waitcnt lgkmcnt(4)
v_mfma_f32_16x16x32_bf16 v[52:55], a[168:171], a[64:67], v[52:55]
v_mfma_f32_16x16x32_bf16 v[52:55], a[172:175], a[68:71], v[52:55]
v_mfma_f32_16x16x32_bf16 v[84:87], a[172:175], a[76:79], v[84:87]
ds_read_b64_tr_b16 a[200:201], v203 offset:0
v_mfma_f32_16x16x32_bf16 v[84:87], a[168:171], a[72:75], v[84:87]
ds_read_b64_tr_b16 a[202:203], v203 offset:4096
v_mfma_f32_16x16x32_bf16 v[116:119], a[168:171], a[80:83], v[116:119]
ds_read_b64_tr_b16 a[204:205], v203 offset:8192
v_mfma_f32_16x16x32_bf16 v[116:119], a[172:175], a[84:87], v[116:119]
ds_read_b64_tr_b16 a[206:207], v203 offset:12288
v_mfma_f32_16x16x32_bf16 v[148:151], a[172:175], a[92:95], v[148:151]
buffer_load_dword v19, off, s[52:55], s72 sc1
v_mfma_f32_16x16x32_bf16 v[148:151], a[168:171], a[88:91], v[148:151]
v_mfma_f32_16x16x32_bf16 v[120:123], a[176:179], a[88:91], v[120:123]
v_mfma_f32_16x16x32_bf16 v[120:123], a[180:183], a[92:95], v[120:123]
v_mfma_f32_16x16x32_bf16 v[88:91], a[180:183], a[84:87], v[88:91]
v_mfma_f32_16x16x32_bf16 v[88:91], a[176:179], a[80:83], v[88:91]
s_branch L_po25
L_pg25:
s_branch L_tr1
L_po25:
v_mfma_f32_16x16x32_bf16 v[56:59], a[176:179], a[72:75], v[56:59]
v_mfma_f32_16x16x32_bf16 v[56:59], a[180:183], a[76:79], v[56:59]
v_mfma_f32_16x16x32_bf16 v[24:27], a[180:183], a[68:71], v[24:27]
v_mfma_f32_16x16x32_bf16 v[24:27], a[176:179], a[64:67], v[24:27]
v_mfma_f32_16x16x32_bf16 v[28:31], a[184:187], a[64:67], v[28:31]
s_waitcnt vmcnt(17)
s_barrier
v_mfma_f32_16x16x32_bf16 v[28:31], a[188:191], a[68:71], v[28:31]
ds_read_b64_tr_b16 a[144:145], v188 offset:0
v_mfma_f32_16x16x32_bf16 v[60:63], a[188:191], a[76:79], v[60:63]
ds_read_b64_tr_b16 a[146:147], v188 offset:4096
v_mfma_f32_16x16x32_bf16 v[60:63], a[184:187], a[72:75], v[60:63]
s_xor_b32 m0, s76, 32768
ds_read_b64_tr_b16 a[148:149], v188 offset:8192
v_mfma_f32_16x16x32_bf16 v[92:95], a[184:187], a[80:83], v[92:95]
s_xor_b32 s64, s85, 262144
ds_read_b64_tr_b16 a[150:151], v188 offset:12288
v_mfma_f32_16x16x32_bf16 v[92:95], a[188:191], a[84:87], v[92:95]
buffer_load_dwordx4 v12, s[40:43], s64 offen lds
v_mfma_f32_16x16x32_bf16 v[124:127], a[188:191], a[92:95], v[124:127]
s_xor_b32 m0, s76, 33792
ds_read_b64_tr_b16 a[152:153], v189 offset:0
v_mfma_f32_16x16x32_bf16 v[124:127], a[184:187], a[88:91], v[124:127]
s_waitcnt lgkmcnt(5)
s_xor_b32 s64, s85, 270336
ds_read_b64_tr_b16 a[154:155], v189 offset:4096
v_mfma_f32_16x16x32_bf16 v[128:131], a[192:195], a[88:91], v[128:131]
buffer_load_dwordx4 v13, s[40:43], s64 offen lds
v_mfma_f32_16x16x32_bf16 v[128:131], a[196:199], a[92:95], v[128:131]
s_xor_b32 m0, s76, 34816
ds_read_b64_tr_b16 a[156:157], v189 offset:8192
v_mfma_f32_16x16x32_bf16 v[96:99], a[196:199], a[84:87], v[96:99]
s_xor_b32 s64, s85, 278528
ds_read_b64_tr_b16 a[158:159], v189 offset:12288
v_mfma_f32_16x16x32_bf16 v[96:99], a[192:195], a[80:83], v[96:99]
buffer_load_dwordx4 v12, s[40:43], s64 offen lds
v_mfma_f32_16x16x32_bf16 v[64:67], a[192:195], a[72:75], v[64:67]
s_xor_b32 m0, s76, 35840
ds_read_b64_tr_b16 a[160:161], v190 offset:0
v_mfma_f32_16x16x32_bf16 v[64:67], a[196:199], a[76:79], v[64:67]
s_xor_b32 s64, s85, 286720
ds_read_b64_tr_b16 a[162:163], v190 offset:4096
v_mfma_f32_16x16x32_bf16 v[32:35], a[196:199], a[68:71], v[32:35]
buffer_load_dwordx4 v13, s[40:43], s64 offen lds
v_mfma_f32_16x16x32_bf16 v[32:35], a[192:195], a[64:67], v[32:35]
s_xor_b32 m0, s76, 36864
ds_read_b64_tr_b16 a[164:165], v190 offset:8192
v_mfma_f32_16x16x32_bf16 v[36:39], a[200:203], a[64:67], v[36:39]
s_xor_b32 s64, s85, 294912
ds_read_b64_tr_b16 a[166:167], v190 offset:12288
v_mfma_f32_16x16x32_bf16 v[36:39], a[204:207], a[68:71], v[36:39]
buffer_load_dwordx4 v12, s[40:43], s64 offen lds
v_mfma_f32_16x16x32_bf16 v[68:71], a[204:207], a[76:79], v[68:71]
s_xor_b32 m0, s76, 37888
v_mfma_f32_16x16x32_bf16 v[68:71], a[200:203], a[72:75], v[68:71]
s_xor_b32 s64, s85, 303104
v_mfma_f32_16x16x32_bf16 v[100:103], a[200:203], a[80:83], v[100:103]
buffer_load_dwordx4 v13, s[40:43], s64 offen lds
v_mfma_f32_16x16x32_bf16 v[100:103], a[204:207], a[84:87], v[100:103]
v_mfma_f32_16x16x32_bf16 v[132:135], a[204:207], a[92:95], v[132:135]
v_mfma_f32_16x16x32_bf16 v[132:135], a[200:203], a[88:91], v[132:135]
s_waitcnt vmcnt(19)
s_waitcnt lgkmcnt(1)
v_mfma_f32_16x16x32_bf16 v[136:139], a[144:147], a[56:59], v[136:139]
s_waitcnt vmcnt(6)
v_readfirstlane_b32 vcc_lo, v19
s_nop 0
s_cmp_lt_u32 vcc_lo, 8
s_cbranch_scc1 L_spin_3019
L_spinbk_3020:
s_sub_u32 s84, s84, 1048576
s_add_u32 s84, s84, s69
v_mfma_f32_16x16x32_bf16 v[136:139], a[148:151], a[60:63], v[136:139]
s_xor_b32 s65, s84, 0
ds_read_b64_tr_b16 a[168:169], v191 offset:0
v_mfma_f32_16x16x32_bf16 v[104:107], a[148:151], a[52:55], v[104:107]
buffer_load_dwordx4 a[208:211], v14, s[44:47], s65 offen offset:0 sc1
v_mfma_f32_16x16x32_bf16 v[104:107], a[144:147], a[48:51], v[104:107]
ds_read_b64_tr_b16 a[170:171], v191 offset:4096
v_mfma_f32_16x16x32_bf16 v[72:75], a[144:147], a[40:43], v[72:75]
buffer_load_dwordx4 a[216:219], v14, s[44:47], s65 offen offset:1024 sc1
v_mfma_f32_16x16x32_bf16 v[72:75], a[148:151], a[44:47], v[72:75]
ds_read_b64_tr_b16 a[172:173], v191 offset:8192
v_mfma_f32_16x16x32_bf16 v[40:43], a[148:151], a[36:39], v[40:43]
buffer_load_dwordx4 a[224:227], v15, s[44:47], s65 offen offset:0 sc1
v_mfma_f32_16x16x32_bf16 v[40:43], a[144:147], a[32:35], v[40:43]
ds_read_b64_tr_b16 a[174:175], v191 offset:12288
v_mfma_f32_16x16x32_bf16 v[44:47], a[152:155], a[32:35], v[44:47]
buffer_load_dwordx4 a[232:235], v15, s[44:47], s65 offen offset:1024 sc1
v_mfma_f32_16x16x32_bf16 v[44:47], a[156:159], a[36:39], v[44:47]
s_xor_b32 s65, s84, 8192
ds_read_b64_tr_b16 a[176:177], v184 offset:0
v_mfma_f32_16x16x32_bf16 v[76:79], a[156:159], a[44:47], v[76:79]
buffer_load_dwordx4 a[212:215], v14, s[44:47], s65 offen offset:0 sc1
v_mfma_f32_16x16x32_bf16 v[76:79], a[152:155], a[40:43], v[76:79]
ds_read_b64_tr_b16 a[178:179], v184 offset:4096
v_mfma_f32_16x16x32_bf16 v[108:111], a[152:155], a[48:51], v[108:111]
buffer_load_dwordx4 a[220:223], v14, s[44:47], s65 offen offset:1024 sc1
v_mfma_f32_16x16x32_bf16 v[108:111], a[156:159], a[52:55], v[108:111]
ds_read_b64_tr_b16 a[180:181], v184 offset:8192
v_mfma_f32_16x16x32_bf16 v[140:143], a[156:159], a[60:63], v[140:143]
buffer_load_dwordx4 a[228:231], v15, s[44:47], s65 offen offset:0 sc1
v_mfma_f32_16x16x32_bf16 v[140:143], a[152:155], a[56:59], v[140:143]
ds_read_b64_tr_b16 a[182:183], v184 offset:12288
v_mfma_f32_16x16x32_bf16 v[144:147], a[160:163], a[56:59], v[144:147]
s_waitcnt lgkmcnt(4)
buffer_load_dwordx4 a[236:239], v15, s[44:47], s65 offen offset:1024 sc1
v_mfma_f32_16x16x32_bf16 v[144:147], a[164:167], a[60:63], v[144:147]
s_xor_b32 m0, s76, 38912
s_xor_b32 s64, s85, 311296
ds_read_b64_tr_b16 a[184:185], v185 offset:0
v_mfma_f32_16x16x32_bf16 v[112:115], a[164:167], a[52:55], v[112:115]
buffer_load_dwordx4 v12, s[40:43], s64 offen lds
v_mfma_f32_16x16x32_bf16 v[112:115], a[160:163], a[48:51], v[112:115]
s_xor_b32 m0, s76, 39936
s_xor_b32 s64, s85, 319488
ds_read_b64_tr_b16 a[186:187], v185 offset:4096
v_mfma_f32_16x16x32_bf16 v[80:83], a[160:163], a[40:43], v[80:83]
buffer_load_dwordx4 v13, s[40:43], s64 offen lds
v_mfma_f32_16x16x32_bf16 v[80:83], a[164:167], a[44:47], v[80:83]
s_xor_b32 s65, s84, 32768
ds_read_b64_tr_b16 a[188:189], v185 offset:8192
v_mfma_f32_16x16x32_bf16 v[48:51], a[164:167], a[36:39], v[48:51]
buffer_load_dwordx4 v[152:155], v14, s[44:47], s65 offen offset:0 sc1
v_mfma_f32_16x16x32_bf16 v[48:51], a[160:163], a[32:35], v[48:51]
ds_read_b64_tr_b16 a[190:191], v185 offset:12288
v_mfma_f32_16x16x32_bf16 v[52:55], a[168:171], a[32:35], v[52:55]
buffer_load_dwordx4 v[160:163], v14, s[44:47], s65 offen offset:1024 sc1
v_mfma_f32_16x16x32_bf16 v[52:55], a[172:175], a[36:39], v[52:55]
ds_read_b64_tr_b16 a[192:193], v186 offset:0
v_mfma_f32_16x16x32_bf16 v[84:87], a[172:175], a[44:47], v[84:87]
buffer_load_dwordx4 v[168:171], v15, s[44:47], s65 offen offset:0 sc1
v_mfma_f32_16x16x32_bf16 v[84:87], a[168:171], a[40:43], v[84:87]
ds_read_b64_tr_b16 a[194:195], v186 offset:4096
v_mfma_f32_16x16x32_bf16 v[116:119], a[168:171], a[48:51], v[116:119]
buffer_load_dwordx4 v[176:179], v15, s[44:47], s65 offen offset:1024 sc1
v_mfma_f32_16x16x32_bf16 v[116:119], a[172:175], a[52:55], v[116:119]
s_xor_b32 s65, s84, 40960
ds_read_b64_tr_b16 a[196:197], v186 offset:8192
v_mfma_f32_16x16x32_bf16 v[148:151], a[172:175], a[60:63], v[148:151]
buffer_load_dwordx4 v[156:159], v14, s[44:47], s65 offen offset:0 sc1
v_mfma_f32_16x16x32_bf16 v[148:151], a[168:171], a[56:59], v[148:151]
s_waitcnt lgkmcnt(3)
ds_read_b64_tr_b16 a[198:199], v186 offset:12288
v_mfma_f32_16x16x32_bf16 v[120:123], a[176:179], a[56:59], v[120:123]
buffer_load_dwordx4 v[164:167], v14, s[44:47], s65 offen offset:1024 sc1
v_mfma_f32_16x16x32_bf16 v[120:123], a[180:183], a[60:63], v[120:123]
ds_read_b64_tr_b16 a[200:201], v187 offset:0
v_mfma_f32_16x16x32_bf16 v[88:91], a[180:183], a[52:55], v[88:91]
buffer_load_dwordx4 v[172:175], v15, s[44:47], s65 offen offset:0 sc1
v_mfma_f32_16x16x32_bf16 v[88:91], a[176:179], a[48:51], v[88:91]
ds_read_b64_tr_b16 a[202:203], v187 offset:4096
v_mfma_f32_16x16x32_bf16 v[56:59], a[176:179], a[40:43], v[56:59]
buffer_load_dwordx4 v[180:183], v15, s[44:47], s65 offen offset:1024 sc1
v_mfma_f32_16x16x32_bf16 v[56:59], a[180:183], a[44:47], v[56:59]
ds_read_b64_tr_b16 a[204:205], v187 offset:8192
v_mfma_f32_16x16x32_bf16 v[24:27], a[180:183], a[36:39], v[24:27]
ds_read_b64_tr_b16 a[206:207], v187 offset:12288
v_mfma_f32_16x16x32_bf16 v[24:27], a[176:179], a[32:35], v[24:27]
v_mfma_f32_16x16x32_bf16 v[28:31], a[184:187], a[32:35], v[28:31]
s_barrier
v_mfma_f32_16x16x32_bf16 v[28:31], a[188:191], a[36:39], v[28:31]
ds_read_b64_tr_b16 a[144:145], v188 offset:32768
v_mfma_f32_16x16x32_bf16 v[60:63], a[188:191], a[44:47], v[60:63]
ds_read_b64_tr_b16 a[146:147], v188 offset:36864
v_mfma_f32_16x16x32_bf16 v[60:63], a[184:187], a[40:43], v[60:63]
s_xor_b32 m0, s76, 65536
ds_read_b64_tr_b16 a[148:149], v188 offset:40960
v_mfma_f32_16x16x32_bf16 v[92:95], a[184:187], a[48:51], v[92:95]
s_xor_b32 s64, s85, 524288
ds_read_b64_tr_b16 a[150:151], v188 offset:45056
v_mfma_f32_16x16x32_bf16 v[92:95], a[188:191], a[52:55], v[92:95]
buffer_load_dwordx4 v12, s[40:43], s64 offen lds
v_mfma_f32_16x16x32_bf16 v[124:127], a[188:191], a[60:63], v[124:127]
s_xor_b32 m0, s76, 66560
ds_read_b64_tr_b16 a[152:153], v189 offset:32768
v_mfma_f32_16x16x32_bf16 v[124:127], a[184:187], a[56:59], v[124:127]
s_waitcnt lgkmcnt(5)
s_xor_b32 s64, s85, 532480
ds_read_b64_tr_b16 a[154:155], v189 offset:36864
v_mfma_f32_16x16x32_bf16 v[128:131], a[192:195], a[56:59], v[128:131]
buffer_load_dwordx4 v13, s[40:43], s64 offen lds
v_mfma_f32_16x16x32_bf16 v[128:131], a[196:199], a[60:63], v[128:131]
ds_read_b64_tr_b16 a[156:157], v189 offset:40960
v_mfma_f32_16x16x32_bf16 v[96:99], a[196:199], a[52:55], v[96:99]
s_xor_b32 m0, s76, 67584
ds_read_b64_tr_b16 a[158:159], v189 offset:45056
v_mfma_f32_16x16x32_bf16 v[96:99], a[192:195], a[48:51], v[96:99]
s_xor_b32 s64, s85, 540672
ds_read_b64_tr_b16 a[160:161], v190 offset:32768
v_mfma_f32_16x16x32_bf16 v[64:67], a[192:195], a[40:43], v[64:67]
buffer_load_dwordx4 v12, s[40:43], s64 offen lds
v_mfma_f32_16x16x32_bf16 v[64:67], a[196:199], a[44:47], v[64:67]
ds_read_b64_tr_b16 a[162:163], v190 offset:36864
v_mfma_f32_16x16x32_bf16 v[32:35], a[196:199], a[36:39], v[32:35]
s_xor_b32 m0, s76, 68608
ds_read_b64_tr_b16 a[164:165], v190 offset:40960
v_mfma_f32_16x16x32_bf16 v[32:35], a[192:195], a[32:35], v[32:35]
s_xor_b32 s64, s85, 548864
ds_read_b64_tr_b16 a[166:167], v190 offset:45056
v_mfma_f32_16x16x32_bf16 v[36:39], a[200:203], a[32:35], v[36:39]
buffer_load_dwordx4 v13, s[40:43], s64 offen lds
v_mfma_f32_16x16x32_bf16 v[36:39], a[204:207], a[36:39], v[36:39]
v_mfma_f32_16x16x32_bf16 v[68:71], a[204:207], a[44:47], v[68:71]
s_xor_b32 m0, s76, 69632
v_mfma_f32_16x16x32_bf16 v[68:71], a[200:203], a[40:43], v[68:71]
s_xor_b32 s64, s85, 557056
v_mfma_f32_16x16x32_bf16 v[100:103], a[200:203], a[48:51], v[100:103]
buffer_load_dwordx4 v12, s[40:43], s64 offen lds
v_mfma_f32_16x16x32_bf16 v[100:103], a[204:207], a[52:55], v[100:103]
s_mov_b32 s70, 3
s_mov_b32 s73, 2
v_mfma_f32_16x16x32_bf16 v[132:135], a[204:207], a[60:63], v[132:135]
v_mfma_f32_16x16x32_bf16 v[132:135], a[200:203], a[56:59], v[132:135]
s_branch L_p5join
L_spin_4022:
s_mov_b32 vcc_hi, 0x80000
L_spinlp_4024:
s_sleep 1
buffer_load_dword v19, off, s[52:55], s72 offset:128 sc1
s_waitcnt vmcnt(0)
v_readfirstlane_b32 vcc_lo, v19
s_sub_u32 vcc_hi, vcc_hi, 1
s_cbranch_scc1 L_spinbk_4023
s_cmp_lt_u32 vcc_lo, s74
s_cbranch_scc1 L_spinlp_4024
s_branch L_spinbk_4023
L_codeend:
.section .rodata,"a"
.p2align 6
.amdhsa_kernel gated_mix__compressed_kv_cla__sliding_local_dilated__prompt_kernel
  .amdhsa_next_free_vgpr 512
  .amdhsa_next_free_sgpr 102
  .amdhsa_accum_offset 256
  .amdhsa_group_segment_fixed_size 0
  .amdhsa_kernarg_size 104
  .amdhsa_user_sgpr_count 2
  .amdhsa_user_sgpr_kernarg_segment_ptr 1
  .amdhsa_system_sgpr_workgroup_id_x 1
.end_amdhsa_kernel
```

```asm
; @launch grid=(256,1,1) block=(256,1,1) lds=163840
.amdgcn_target "amdgcn-amd-amdhsa--gfx950"
.text
.globl gated_mix__compressed_kv_cla__sliding_local_dilated__prompt_kernel
.p2align 8
.type gated_mix__compressed_kv_cla__sliding_local_dilated__prompt_kernel,@function
gated_mix__compressed_kv_cla__sliding_local_dilated__prompt_kernel:
s_cmp_ge_u32 s2, 256
s_cbranch_scc1 L_end
s_load_dwordx16 s[4:19], s[0:1], 0
s_load_dwordx8 s[20:27], s[0:1], 64
s_load_dwordx2 s[28:29], s[0:1], 96
s_getpc_b64 s[88:89]
L_pc:
v_lshrrev_b32 v1, 6, v0
s_lshr_b32 s67, s2, 3
v_lshl_add_u32 v24, s67, 2, v1
s_mov_b32 s90, L_codeend-L_pc
s_mov_b32 s91, 0x20000
v_and_b32 v25, 7, v0
v_lshlrev_b32 v25, 7, v25
v_lshl_add_u32 v24, v24, 10, v25
buffer_load_dword a252, v24, s[88:91], 0 offen
v_and_b32 v0, 63, v0
v_readfirstlane_b32 s30, v1
v_lshrrev_b32 v24, 3, v0
v_lshrrev_b32 v25, 4, v0
v_and_b32 v26, 7, v0
v_xor_b32 v26, v26, v25
v_lshlrev_b32 v26, 4, v26
v_lshl_add_u32 v12, v24, 10, v26
v_xor_b32 v13, 64, v12
v_bfe_u32 v26, v0, 1, 3
v_xor_b32 v26, v26, v25
v_lshlrev_b32 v26, 5, v26
v_and_b32 v24, 1, v0
v_lshl_add_u32 v26, v24, 4, v26
v_lshl_add_u32 v14, v25, 13, v26
v_xor_b32 v15, 128, v14
s_and_b32 s66, s2, 7
s_and_b32 s68, s67, 3
s_lshl2_add_u32 s31, s66, s68
s_cmp_eq_u32 s68, 0
s_cselect_b32 s90, s90, 0
s_lshr_b32 s3, s67, 2
s_lshl2_add_u32 s80, s67, s30
s_lshl_b32 s70, s3, 18
s_lshl_b32 s66, s30, 16
s_add_u32 s70, s70, s66
s_lshl_b32 s71, s30, 17
s_lshl_b32 s66, s31, 8
s_add_u32 s71, s71, s66
s_lshl_b32 s76, s30, 13
s_lshl_b32 s77, s30, 12
s_lshl_b32 s78, s30, 10
s_cmp_eq_u32 s30, 0
s_cbranch_scc1 L_pg1
s_cmp_eq_u32 s30, 1
s_cbranch_scc1 L_tr9
s_cmp_eq_u32 s30, 2
s_cbranch_scc1 L_tr9
s_branch L_tr9
L_tr9:
s_waitcnt lgkmcnt(0)
s_mov_b32 s32, s6
s_mov_b32 s33, s7
s_mov_b32 s34, 2097152
s_mov_b32 s35, 0x20000
s_mov_b32 s36, s10
s_mov_b32 s37, s11
s_mov_b32 s38, 4194304
s_mov_b32 s39, 0x20000
s_mov_b32 s40, s12
s_mov_b32 s41, s13
s_mov_b32 s42, 4194304
s_mov_b32 s43, 0x20000
s_xor_b32 m0, s76, 0
s_xor_b32 s64, s70, 0
buffer_load_dwordx4 v12, s[32:35], s64 offen lds
s_xor_b32 m0, s76, 1024
s_xor_b32 s64, s70, 8192
buffer_load_dwordx4 v13, s[32:35], s64 offen lds
s_xor_b32 m0, s76, 2048
s_xor_b32 s64, s70, 16384
buffer_load_dwordx4 v12, s[32:35], s64 offen lds
s_xor_b32 m0, s76, 3072
s_xor_b32 s64, s70, 24576
buffer_load_dwordx4 v13, s[32:35], s64 offen lds
s_xor_b32 m0, s77, 65536
s_xor_b32 s64, s71, 0
buffer_load_dwordx4 v14, s[36:39], s64 offen lds
s_xor_b32 m0, s77, 66560
s_xor_b32 s64, s71, 32768
buffer_load_dwordx4 v14, s[36:39], s64 offen lds
s_xor_b32 m0, s77, 67584
s_xor_b32 s64, s71, 65536
buffer_load_dwordx4 v15, s[36:39], s64 offen lds
s_xor_b32 m0, s77, 68608
s_xor_b32 s64, s71, 98304
buffer_load_dwordx4 v15, s[36:39], s64 offen lds
s_mov_b32 s44, s28
s_mov_b32 s45, s29
s_mov_b32 s46, 134217728
s_mov_b32 s47, 0x20000
s_mov_b32 s48, s4
s_mov_b32 s49, s5
s_mov_b32 s50, 4194304
s_mov_b32 s51, 0x20000
s_mov_b32 s52, s26
s_mov_b32 s53, s27
s_mov_b32 s54, 256
s_mov_b32 s55, 0x20000
s_mov_b32 s56, s8
s_mov_b32 s57, s9
s_mov_b32 s58, 8388608
s_mov_b32 s59, 0x20000
s_mov_b32 s60, s18
s_mov_b32 s61, s19
s_mov_b32 s62, 6291456
s_mov_b32 s63, 0x20000
v_accvgpr_write_b32 a251, 1
v_and_b32 v24, 15, v0
v_lshrrev_b32 v26, 1, v24
v_xor_b32 v26, v26, v25
v_lshlrev_b32 v26, 4, v26
v_lshl_add_u32 v26, v24, 7, v26
v_add_u32 v2, s76, v26
v_xor_b32 v3, 64, v2
v_bfe_u32 v24, v0, 2, 2
v_lshl_add_u32 v27, v25, 3, v24
v_and_b32 v1, 3, v0
v_cmp_eq_u32 vcc, 0, v1
v_lshlrev_b32 v1, 3, v1
v_lshl_add_u32 v26, v27, 8, v1
v_add_u32 v26, 65536, v26
v_and_b32 v1, 1, v25
v_lshl_add_u32 v24, v1, 2, v24
v_lshlrev_b32 v16, 4, v0
v_mov_b32 v28, 0x3f803f80
v_cndmask_b32 v28, 0, v28, vcc
v_accvgpr_write_b32 a244, v28
v_accvgpr_write_b32 a245, v28
v_accvgpr_write_b32 a246, v28
v_accvgpr_write_b32 a247, v28
v_xor_b32 v1, 0, v24
v_lshl_add_u32 v4, v1, 5, v26
v_xor_b32 v1, 1, v24
v_lshl_add_u32 v5, v1, 5, v26
v_xor_b32 v1, 2, v24
v_lshl_add_u32 v6, v1, 5, v26
v_xor_b32 v1, 3, v24
v_lshl_add_u32 v7, v1, 5, v26
v_xor_b32 v1, 4, v24
v_lshl_add_u32 v8, v1, 5, v26
v_xor_b32 v1, 5, v24
v_lshl_add_u32 v9, v1, 5, v26
v_xor_b32 v1, 6, v24
v_lshl_add_u32 v10, v1, 5, v26
v_xor_b32 v1, 7, v24
v_lshl_add_u32 v11, v1, 5, v26
s_sub_u32 s16, 15, s3
s_lshl_b32 s72, s3, 18
s_lshl_b32 s73, s16, 18
s_cmp_lt_u32 s30, 2
s_cselect_b32 s67, s3, s16
s_lshl4_add_u32 s74, s31, s67
s_and_b32 s66, s30, 1
s_lshl1_add_u32 s74, s74, s66
s_lshl_b32 s74, s74, 10
s_add_u32 s74, s74, 60817408
s_lshl_b32 s66, s30, 15
s_add_u32 s72, s72, s66
s_add_u32 s73, s73, s66
s_mul_i32 s75, s30, 98304
s_lshl_b32 s66, s31, 6
s_add_u32 s75, s75, s66
s_lshl_b32 s79, s31, 20
s_lshl_b32 s66, s3, 17
s_add_u32 s79, s79, s66
s_lshl_b32 s66, s30, 15
s_add_u32 s79, s79, s66
v_bfe_u32 v23, v0, 1, 1
v_lshrrev_b32 v1, 5, v0
v_xor_b32 v23, v23, v1
v_lshlrev_b32 v23, 5, v23
v_and_b32 v1, 1, v0
v_lshl_add_u32 v23, v1, 4, v23
v_lshrrev_b32 v1, 2, v0
v_mul_u32_u24 v1, 6144, v1
v_add_u32 v23, v1, v23
s_lshl_b32 s81, s80, 13
s_and_b32 s67, s2, 7
s_lshl_b32 s82, s67, 8
s_add_u32 s82, s82, s81
s_lshl_b32 s67, s67, 10
s_add_u32 s81, s81, s67
s_add_u32 s83, s81, 1048576
v_mul_u32_u24 v1, 1792, v25
v_add_u32 v1, v1, v16
s_lshl_b32 s68, s2, 3
s_lshl1_add_u32 s68, s30, s68
v_lshrrev_b32 v18, 5, v0
v_add_u32 v18, s68, v18
v_and_b32 v19, 31, v0
v_lshlrev_b32 v19, 4, v19
v_lshl_add_u32 v18, v18, 11, v19
v_mov_b32 v21, 0
v_min_u32 v20, 1, v0
v_lshlrev_b32 v20, 30, v20
v_accvgpr_write_b32 a240, -1
v_accvgpr_write_b32 a241, -1
v_accvgpr_write_b32 a242, -1
v_accvgpr_write_b32 a243, -1
s_lshr_b32 s69, s2, 7
s_or_b32 s69, s69, s30
s_lshl_b32 s69, s69, 21
s_add_u32 s69, s69, s2
s_lshl_b32 s69, s69, 7
s_add_u32 s69, s69, 59768832
s_cmp_eq_u32 s30, 0
s_cbranch_scc1 L_pg2
s_cmp_eq_u32 s30, 1
s_cbranch_scc1 L_pg3
s_cmp_eq_u32 s30, 2
s_cbranch_scc1 L_pg4
s_branch L_pg5
L_tr0:
s_branch L_base
.p2align 12
L_pg1:
s_branch L_tr9
L_base:
s_xor_b32 m0, s76, 4096
s_xor_b32 s64, s70, 32768
buffer_load_dwordx4 v12, s[32:35], s64 offen lds
s_xor_b32 m0, s76, 5120
s_xor_b32 s64, s70, 40960
buffer_load_dwordx4 v13, s[32:35], s64 offen lds
s_xor_b32 m0, s76, 6144
s_xor_b32 s64, s70, 49152
buffer_load_dwordx4 v12, s[32:35], s64 offen lds
s_xor_b32 m0, s76, 7168
s_xor_b32 s64, s70, 57344
buffer_load_dwordx4 v13, s[32:35], s64 offen lds
s_xor_b32 m0, s77, 81920
s_xor_b32 s64, s71, 0
buffer_load_dwordx4 v14, s[40:43], s64 offen lds
s_xor_b32 m0, s77, 82944
s_xor_b32 s64, s71, 32768
buffer_load_dwordx4 v14, s[40:43], s64 offen lds
s_xor_b32 m0, s77, 83968
s_xor_b32 s64, s71, 65536
buffer_load_dwordx4 v15, s[40:43], s64 offen lds
s_xor_b32 m0, s77, 84992
s_xor_b32 s64, s71, 98304
buffer_load_dwordx4 v15, s[40:43], s64 offen lds
s_and_b32 s66, s31, 3
s_lshl_b32 s67, s66, 11
s_add_u32 s84, s76, s67
s_lshl3_add_u32 s70, s67, s70
s_and_b32 s67, s66, 1
s_lshl_b32 s67, s67, 17
s_add_u32 s72, s72, s67
s_add_u32 s67, s73, s67
s_bitcmp1_b32 s66, 1
s_cselect_b32 s73, s72, s67
s_cselect_b32 s72, s67, s72
s_and_b32 s66, s3, 3
s_lshl_b32 s67, s66, 10
s_add_u32 s77, s77, s67
s_lshl_b32 s67, s66, 15
s_add_u32 s71, s71, s67
s_and_b32 s67, s66, 2
s_lshl_b32 s67, s67, 6
v_xor_b32 v14, s67, v14
v_xor_b32 v15, s67, v15
s_and_b32 s66, s3, 4
s_cselect_b64 s[36:37], s[12:13], s[10:11]
s_cselect_b64 s[40:41], s[10:11], s[12:13]
s_lshl_b32 s66, s66, 12
s_add_u32 s77, s77, s66
s_waitcnt vmcnt(8)
s_barrier
ds_read_b128 a[0:3], v2 offset:0
ds_read_b128 a[4:7], v3 offset:0
ds_read_b64_tr_b16 a[176:177], v4 offset:0
ds_read_b64_tr_b16 a[178:179], v4 offset:1024
ds_read_b64_tr_b16 a[180:181], v4 offset:8192
ds_read_b64_tr_b16 a[182:183], v4 offset:9216
ds_read_b128 a[8:11], v2 offset:2048
ds_read_b128 a[12:15], v3 offset:2048
ds_read_b64_tr_b16 a[184:185], v5 offset:0
ds_read_b64_tr_b16 a[186:187], v5 offset:1024
ds_read_b64_tr_b16 a[188:189], v5 offset:8192
ds_read_b64_tr_b16 a[190:191], v5 offset:9216
ds_read_b64_tr_b16 a[88:89], v6 offset:0
ds_read_b64_tr_b16 a[90:91], v6 offset:1024
ds_read_b64_tr_b16 a[92:93], v6 offset:8192
ds_read_b64_tr_b16 a[94:95], v6 offset:9216
s_waitcnt lgkmcnt(12)
v_mfma_f32_16x16x32_bf16 v[184:187], a[176:179], a[0:3], 0
s_waitcnt lgkmcnt(10)
s_xor_b32 m0, s77, 98304
ds_read_b64_tr_b16 a[96:97], v7 offset:0
v_mfma_f32_16x16x32_bf16 v[184:187], a[180:183], a[4:7], v[184:187]
s_waitcnt lgkmcnt(9)
s_xor_b32 s64, s71, 524288
ds_read_b64_tr_b16 a[98:99], v7 offset:1024
v_mfma_f32_16x16x32_bf16 v[192:195], a[180:183], a[12:15], 0
buffer_load_dwordx4 v14, s[36:39], s64 offen lds
v_mfma_f32_16x16x32_bf16 v[192:195], a[176:179], a[8:11], v[192:195]
s_waitcnt lgkmcnt(8)
ds_read_b64_tr_b16 a[100:101], v7 offset:8192
v_mfma_f32_16x16x32_bf16 v[196:199], a[184:187], a[8:11], 0
s_waitcnt lgkmcnt(7)
s_xor_b32 m0, s77, 99328
ds_read_b64_tr_b16 a[102:103], v7 offset:9216
v_mfma_f32_16x16x32_bf16 v[196:199], a[188:191], a[12:15], v[196:199]
s_xor_b32 s64, s71, 557056
ds_read_b64_tr_b16 a[104:105], v8 offset:0
v_mfma_f32_16x16x32_bf16 v[188:191], a[188:191], a[4:7], 0
buffer_load_dwordx4 v14, s[36:39], s64 offen lds
v_mfma_f32_16x16x32_bf16 v[188:191], a[184:187], a[0:3], v[188:191]
s_waitcnt lgkmcnt(7)
ds_read_b64_tr_b16 a[106:107], v8 offset:1024
v_mfma_f32_16x16x32_bf16 v[216:219], a[88:91], a[0:3], 0
s_waitcnt lgkmcnt(6)
s_xor_b32 m0, s77, 100352
ds_read_b64_tr_b16 a[108:109], v8 offset:8192
v_mfma_f32_16x16x32_bf16 v[216:219], a[92:95], a[4:7], v[216:219]
s_xor_b32 s64, s71, 589824
ds_read_b64_tr_b16 a[110:111], v8 offset:9216
v_mfma_f32_16x16x32_bf16 v[224:227], a[92:95], a[12:15], 0
buffer_load_dwordx4 v15, s[36:39], s64 offen lds
v_mfma_f32_16x16x32_bf16 v[224:227], a[88:91], a[8:11], v[224:227]
s_waitcnt lgkmcnt(6)
ds_read_b64_tr_b16 a[112:113], v9 offset:0
v_mfma_f32_16x16x32_bf16 v[228:231], a[96:99], a[8:11], 0
s_waitcnt lgkmcnt(5)
ds_read_b64_tr_b16 a[114:115], v9 offset:1024
v_mfma_f32_16x16x32_bf16 v[228:231], a[100:103], a[12:15], v[228:231]
s_xor_b32 m0, s77, 101376
ds_read_b64_tr_b16 a[116:117], v9 offset:8192
v_mfma_f32_16x16x32_bf16 v[220:223], a[100:103], a[4:7], 0
s_xor_b32 s64, s71, 622592
ds_read_b64_tr_b16 a[118:119], v9 offset:9216
v_mfma_f32_16x16x32_bf16 v[220:223], a[96:99], a[0:3], v[220:223]
s_waitcnt lgkmcnt(6)
buffer_load_dwordx4 v15, s[36:39], s64 offen lds
v_mfma_f32_16x16x32_bf16 v[152:155], a[104:107], a[0:3], 0
s_waitcnt lgkmcnt(4)
ds_read_b64_tr_b16 a[72:73], v10 offset:0
v_mfma_f32_16x16x32_bf16 v[152:155], a[108:111], a[4:7], v[152:155]
s_xor_b32 m0, s77, 114688
ds_read_b64_tr_b16 a[74:75], v10 offset:1024
v_mfma_f32_16x16x32_bf16 v[160:163], a[108:111], a[12:15], 0
s_xor_b32 s64, s71, 524288
ds_read_b64_tr_b16 a[76:77], v10 offset:8192
ds_read_b64_tr_b16 a[78:79], v10 offset:9216
v_mfma_f32_16x16x32_bf16 v[160:163], a[104:107], a[8:11], v[160:163]
s_waitcnt lgkmcnt(6)
buffer_load_dwordx4 v14, s[40:43], s64 offen lds
v_mfma_f32_16x16x32_bf16 v[164:167], a[112:115], a[8:11], 0
s_waitcnt lgkmcnt(4)
s_xor_b32 m0, s77, 115712
ds_read_b64_tr_b16 a[80:81], v11 offset:0
v_mfma_f32_16x16x32_bf16 v[164:167], a[116:119], a[12:15], v[164:167]
s_xor_b32 s64, s71, 557056
ds_read_b64_tr_b16 a[82:83], v11 offset:1024
v_mfma_f32_16x16x32_bf16 v[156:159], a[116:119], a[4:7], 0
ds_read_b64_tr_b16 a[84:85], v11 offset:8192
ds_read_b64_tr_b16 a[86:87], v11 offset:9216
s_waitcnt vmcnt(9)
v_mfma_f32_16x16x32_bf16 v[156:159], a[112:115], a[0:3], v[156:159]
s_waitcnt lgkmcnt(6)
buffer_load_dwordx4 v14, s[40:43], s64 offen lds
v_mfma_f32_16x16x32_bf16 v[24:27], a[72:75], a[0:3], 0
s_waitcnt lgkmcnt(4)
s_xor_b32 m0, s77, 116736
ds_read_b128 a[16:19], v2 offset:4096
ds_read_b128 a[20:23], v3 offset:4096
v_mfma_f32_16x16x32_bf16 v[24:27], a[76:79], a[4:7], v[24:27]
s_xor_b32 s64, s71, 589824
ds_read_b128 a[24:27], v2 offset:6144
ds_read_b128 a[28:31], v3 offset:6144
v_mfma_f32_16x16x32_bf16 v[40:43], a[76:79], a[12:15], 0
buffer_load_dwordx4 v15, s[40:43], s64 offen lds
v_mfma_f32_16x16x32_bf16 v[40:43], a[72:75], a[8:11], v[40:43]
s_waitcnt lgkmcnt(6)
v_mfma_f32_16x16x32_bf16 v[104:107], a[80:83], a[8:11], 0
s_waitcnt lgkmcnt(4)
s_xor_b32 m0, s77, 117760
v_mfma_f32_16x16x32_bf16 v[104:107], a[84:87], a[12:15], v[104:107]
s_xor_b32 s64, s71, 622592
v_mfma_f32_16x16x32_bf16 v[88:91], a[84:87], a[4:7], 0
buffer_load_dwordx4 v15, s[40:43], s64 offen lds
v_mfma_f32_16x16x32_bf16 v[88:91], a[80:83], a[0:3], v[88:91]
s_waitcnt lgkmcnt(3)
v_mfma_f32_16x16x32_bf16 v[232:235], a[88:91], a[16:19], 0
s_waitcnt lgkmcnt(2)
v_mfma_f32_16x16x32_bf16 v[232:235], a[92:95], a[20:23], v[232:235]
s_waitcnt lgkmcnt(0)
s_xor_b32 m0, s84, 32768
v_mfma_f32_16x16x32_bf16 v[240:243], a[92:95], a[28:31], 0
s_xor_b32 s64, s70, 128
v_mfma_f32_16x16x32_bf16 v[240:243], a[88:91], a[24:27], v[240:243]
buffer_load_dwordx4 v12, s[32:35], s64 offen lds
v_mfma_f32_16x16x32_bf16 v[244:247], a[96:99], a[24:27], 0
s_xor_b32 m0, s84, 33792
v_mfma_f32_16x16x32_bf16 v[244:247], a[100:103], a[28:31], v[244:247]
s_xor_b32 s64, s70, 8320
v_mfma_f32_16x16x32_bf16 v[236:239], a[100:103], a[20:23], 0
s_waitcnt vmcnt(9)
s_barrier
v_mfma_f32_16x16x32_bf16 v[236:239], a[96:99], a[16:19], v[236:239]
buffer_load_dwordx4 v13, s[32:35], s64 offen lds
v_mfma_f32_16x16x32_bf16 v[168:171], a[104:107], a[16:19], 0
ds_read_b64_tr_b16 a[88:89], v4 offset:16384
v_mfma_f32_16x16x32_bf16 v[168:171], a[108:111], a[20:23], v[168:171]
s_xor_b32 m0, s84, 34816
ds_read_b64_tr_b16 a[90:91], v4 offset:17408
v_mfma_f32_16x16x32_bf16 v[176:179], a[108:111], a[28:31], 0
s_xor_b32 s64, s70, 16512
ds_read_b64_tr_b16 a[92:93], v4 offset:24576
v_mfma_f32_16x16x32_bf16 v[176:179], a[104:107], a[24:27], v[176:179]
buffer_load_dwordx4 v12, s[32:35], s64 offen lds
v_mfma_f32_16x16x32_bf16 v[180:183], a[112:115], a[24:27], 0
ds_read_b64_tr_b16 a[94:95], v4 offset:25600
v_mfma_f32_16x16x32_bf16 v[180:183], a[116:119], a[28:31], v[180:183]
s_xor_b32 m0, s84, 35840
ds_read_b64_tr_b16 a[96:97], v5 offset:16384
v_mfma_f32_16x16x32_bf16 v[172:175], a[116:119], a[20:23], 0
s_xor_b32 s64, s70, 24704
ds_read_b64_tr_b16 a[98:99], v5 offset:17408
v_mfma_f32_16x16x32_bf16 v[172:175], a[112:115], a[16:19], v[172:175]
buffer_load_dwordx4 v13, s[32:35], s64 offen lds
v_mfma_f32_16x16x32_bf16 v[56:59], a[72:75], a[16:19], 0
ds_read_b64_tr_b16 a[100:101], v5 offset:24576
v_mfma_f32_16x16x32_bf16 v[56:59], a[76:79], a[20:23], v[56:59]
s_xor_b32 m0, s84, 36864
ds_read_b64_tr_b16 a[102:103], v5 offset:25600
v_mfma_f32_16x16x32_bf16 v[72:75], a[76:79], a[28:31], 0
s_xor_b32 s64, s70, 32896
ds_read_b64_tr_b16 a[104:105], v6 offset:16384
v_mfma_f32_16x16x32_bf16 v[72:75], a[72:75], a[24:27], v[72:75]
buffer_load_dwordx4 v12, s[32:35], s64 offen lds
v_mfma_f32_16x16x32_bf16 v[136:139], a[80:83], a[24:27], 0
ds_read_b64_tr_b16 a[106:107], v6 offset:17408
v_mfma_f32_16x16x32_bf16 v[136:139], a[84:87], a[28:31], v[136:139]
s_xor_b32 m0, s84, 37888
ds_read_b64_tr_b16 a[108:109], v6 offset:24576
v_mfma_f32_16x16x32_bf16 v[120:123], a[84:87], a[20:23], 0
s_xor_b32 s64, s70, 41088
ds_read_b64_tr_b16 a[110:111], v6 offset:25600
v_mfma_f32_16x16x32_bf16 v[120:123], a[80:83], a[16:19], v[120:123]
buffer_load_dwordx4 v13, s[32:35], s64 offen lds
v_mfma_f32_16x16x32_bf16 v[200:203], a[176:179], a[16:19], 0
ds_read_b64_tr_b16 a[112:113], v7 offset:16384
v_mfma_f32_16x16x32_bf16 v[200:203], a[180:183], a[20:23], v[200:203]
s_xor_b32 m0, s84, 38912
ds_read_b64_tr_b16 a[114:115], v7 offset:17408
v_mfma_f32_16x16x32_bf16 v[208:211], a[180:183], a[28:31], 0
s_xor_b32 s64, s70, 49280
ds_read_b64_tr_b16 a[116:117], v7 offset:24576
v_mfma_f32_16x16x32_bf16 v[208:211], a[176:179], a[24:27], v[208:211]
buffer_load_dwordx4 v12, s[32:35], s64 offen lds
v_mfma_f32_16x16x32_bf16 v[212:215], a[184:187], a[24:27], 0
ds_read_b64_tr_b16 a[118:119], v7 offset:25600
v_mfma_f32_16x16x32_bf16 v[212:215], a[188:191], a[28:31], v[212:215]
s_xor_b32 m0, s84, 39936
ds_read_b64_tr_b16 a[72:73], v8 offset:16384
v_mfma_f32_16x16x32_bf16 v[204:207], a[188:191], a[20:23], 0
s_xor_b32 s64, s70, 57472
ds_read_b64_tr_b16 a[74:75], v8 offset:17408
v_mfma_f32_16x16x32_bf16 v[204:207], a[184:187], a[16:19], v[204:207]
s_waitcnt lgkmcnt(7)
buffer_load_dwordx4 v13, s[32:35], s64 offen lds
v_mfma_f32_16x16x32_bf16 v[28:31], a[0:3], a[88:91], 0
ds_read_b64_tr_b16 a[76:77], v8 offset:24576
v_mfma_f32_16x16x32_bf16 v[28:31], a[4:7], a[92:95], v[28:31]
ds_read_b64_tr_b16 a[78:79], v8 offset:25600
v_mfma_f32_16x16x32_bf16 v[44:47], a[12:15], a[92:95], 0
ds_read_b64_tr_b16 a[80:81], v9 offset:16384
v_mfma_f32_16x16x32_bf16 v[44:47], a[8:11], a[88:91], v[44:47]
ds_read_b64_tr_b16 a[82:83], v9 offset:17408
v_mfma_f32_16x16x32_bf16 v[60:63], a[16:19], a[88:91], 0
s_xor_b32 m0, s77, 131072
ds_read_b64_tr_b16 a[84:85], v9 offset:24576
v_mfma_f32_16x16x32_bf16 v[60:63], a[20:23], a[92:95], v[60:63]
s_xor_b32 s64, s71, 1048576
ds_read_b64_tr_b16 a[86:87], v9 offset:25600
v_mfma_f32_16x16x32_bf16 v[76:79], a[28:31], a[92:95], 0
buffer_load_dwordx4 v14, s[36:39], s64 offen lds
v_mfma_f32_16x16x32_bf16 v[76:79], a[24:27], a[88:91], v[76:79]
s_xor_b32 m0, s77, 132096
ds_read_b64_tr_b16 a[88:89], v10 offset:16384
v_mfma_f32_16x16x32_bf16 v[140:143], a[24:27], a[96:99], 0
s_xor_b32 s64, s71, 1081344
ds_read_b64_tr_b16 a[90:91], v10 offset:17408
v_mfma_f32_16x16x32_bf16 v[140:143], a[28:31], a[100:103], v[140:143]
buffer_load_dwordx4 v14, s[36:39], s64 offen lds
v_mfma_f32_16x16x32_bf16 v[124:127], a[20:23], a[100:103], 0
ds_read_b64_tr_b16 a[92:93], v10 offset:24576
v_mfma_f32_16x16x32_bf16 v[124:127], a[16:19], a[96:99], v[124:127]
s_xor_b32 m0, s77, 133120
ds_read_b64_tr_b16 a[94:95], v10 offset:25600
v_mfma_f32_16x16x32_bf16 v[108:111], a[8:11], a[96:99], 0
s_xor_b32 s64, s71, 1114112
v_mfma_f32_16x16x32_bf16 v[108:111], a[12:15], a[100:103], v[108:111]
buffer_load_dwordx4 v15, s[36:39], s64 offen lds
v_mfma_f32_16x16x32_bf16 v[92:95], a[4:7], a[100:103], 0
v_mfma_f32_16x16x32_bf16 v[92:95], a[0:3], a[96:99], v[92:95]
s_xor_b32 m0, s77, 134144
ds_read_b64_tr_b16 a[96:97], v11 offset:16384
v_mfma_f32_16x16x32_bf16 v[32:35], a[0:3], a[104:107], 0
s_waitcnt lgkmcnt(5)
s_xor_b32 s64, s71, 1146880
ds_read_b64_tr_b16 a[98:99], v11 offset:17408
v_mfma_f32_16x16x32_bf16 v[32:35], a[4:7], a[108:111], v[32:35]
buffer_load_dwordx4 v15, s[36:39], s64 offen lds
v_mfma_f32_16x16x32_bf16 v[48:51], a[12:15], a[108:111], 0
ds_read_b64_tr_b16 a[100:101], v11 offset:24576
v_mfma_f32_16x16x32_bf16 v[48:51], a[8:11], a[104:107], v[48:51]
s_xor_b32 m0, s77, 147456
ds_read_b64_tr_b16 a[102:103], v11 offset:25600
v_mfma_f32_16x16x32_bf16 v[64:67], a[16:19], a[104:107], 0
s_xor_b32 s64, s71, 1048576
v_mfma_f32_16x16x32_bf16 v[64:67], a[20:23], a[108:111], v[64:67]
buffer_load_dwordx4 v14, s[40:43], s64 offen lds
v_mfma_f32_16x16x32_bf16 v[80:83], a[28:31], a[108:111], 0
s_xor_b32 m0, s77, 148480
v_mfma_f32_16x16x32_bf16 v[80:83], a[24:27], a[104:107], v[80:83]
s_xor_b32 s64, s71, 1081344
v_mfma_f32_16x16x32_bf16 v[144:147], a[24:27], a[112:115], 0
buffer_load_dwordx4 v14, s[40:43], s64 offen lds
v_mfma_f32_16x16x32_bf16 v[144:147], a[28:31], a[116:119], v[144:147]
v_mfma_f32_16x16x32_bf16 v[128:131], a[20:23], a[116:119], 0
s_xor_b32 m0, s77, 149504
v_mfma_f32_16x16x32_bf16 v[128:131], a[16:19], a[112:115], v[128:131]
s_xor_b32 s64, s71, 1114112
v_mfma_f32_16x16x32_bf16 v[112:115], a[8:11], a[112:115], 0
buffer_load_dwordx4 v15, s[40:43], s64 offen lds
v_mfma_f32_16x16x32_bf16 v[112:115], a[12:15], a[116:119], v[112:115]
v_mfma_f32_16x16x32_bf16 v[96:99], a[4:7], a[116:119], 0
s_xor_b32 m0, s77, 150528
v_mfma_f32_16x16x32_bf16 v[96:99], a[0:3], a[112:115], v[96:99]
s_xor_b32 s64, s71, 1146880
v_mfma_f32_16x16x32_bf16 v[36:39], a[0:3], a[72:75], 0
buffer_load_dwordx4 v15, s[40:43], s64 offen lds
v_mfma_f32_16x16x32_bf16 v[36:39], a[4:7], a[76:79], v[36:39]
s_xor_b32 m0, s84, 0
v_mfma_f32_16x16x32_bf16 v[52:55], a[12:15], a[76:79], 0
s_waitcnt vmcnt(16) lgkmcnt(0)
s_barrier
v_mfma_f32_16x16x32_bf16 v[52:55], a[8:11], a[72:75], v[52:55]
s_xor_b32 s64, s70, 256
ds_read_b64_tr_b16 a[104:105], v4 offset:32768
v_mfma_f32_16x16x32_bf16 v[68:71], a[16:19], a[72:75], 0
buffer_load_dwordx4 v12, s[32:35], s64 offen lds
v_mfma_f32_16x16x32_bf16 v[68:71], a[20:23], a[76:79], v[68:71]
s_xor_b32 m0, s84, 1024
global_load_dwordx4 a[144:147], v18, s[4:5] offset:0
v_mfma_f32_16x16x32_bf16 v[84:87], a[28:31], a[76:79], 0
s_xor_b32 s64, s70, 8448
ds_read_b64_tr_b16 a[106:107], v4 offset:33792
v_mfma_f32_16x16x32_bf16 v[84:87], a[24:27], a[72:75], v[84:87]
buffer_load_dwordx4 v13, s[32:35], s64 offen lds
v_mfma_f32_16x16x32_bf16 v[148:151], a[24:27], a[80:83], 0
ds_read_b64_tr_b16 a[108:109], v4 offset:40960
v_mfma_f32_16x16x32_bf16 v[148:151], a[28:31], a[84:87], v[148:151]
s_xor_b32 m0, s84, 2048
ds_read_b64_tr_b16 a[110:111], v4 offset:41984
v_mfma_f32_16x16x32_bf16 v[132:135], a[20:23], a[84:87], 0
s_waitcnt vmcnt(11)
s_xor_b32 s64, s70, 16640
ds_read_b128 a[32:35], v2 offset:32768
v_mfma_f32_16x16x32_bf16 v[132:135], a[16:19], a[80:83], v[132:135]
buffer_load_dwordx4 v12, s[32:35], s64 offen lds
v_mfma_f32_16x16x32_bf16 v[116:119], a[8:11], a[80:83], 0
ds_read_b128 a[36:39], v3 offset:32768
v_mfma_f32_16x16x32_bf16 v[116:119], a[12:15], a[84:87], v[116:119]
s_xor_b32 m0, s84, 3072
ds_read_b128 a[40:43], v2 offset:34816
v_mfma_f32_16x16x32_bf16 v[100:103], a[4:7], a[84:87], 0
s_xor_b32 s64, s70, 24832
ds_read_b128 a[44:47], v3 offset:34816
v_mfma_f32_16x16x32_bf16 v[100:103], a[0:3], a[80:83], v[100:103]
buffer_load_dwordx4 v13, s[32:35], s64 offen lds
v_mfma_f32_16x16x32_bf16 v[248:251], a[0:3], a[88:91], 0
ds_read_b128 a[48:51], v2 offset:36864
v_mfma_f32_16x16x32_bf16 v[248:251], a[4:7], a[92:95], v[248:251]
s_xor_b32 m0, s84, 4096
ds_read_b128 a[52:55], v3 offset:36864
v_mfma_f32_16x16x32_bf16 v[252:255], a[12:15], a[92:95], 0
s_xor_b32 s64, s70, 33024
ds_read_b128 a[56:59], v2 offset:38912
v_mfma_f32_16x16x32_bf16 v[252:255], a[8:11], a[88:91], v[252:255]
buffer_load_dwordx4 v12, s[32:35], s64 offen lds
v_mfma_f32_16x16x32_bf16 a[120:123], a[16:19], a[88:91], 0
s_xor_b32 m0, s84, 5120
ds_read_b128 a[60:63], v3 offset:38912
v_mfma_f32_16x16x32_bf16 a[120:123], a[20:23], a[92:95], a[120:123]
s_xor_b32 s64, s70, 41216
ds_read_b64_tr_b16 a[112:113], v5 offset:32768
v_mfma_f32_16x16x32_bf16 a[124:127], a[28:31], a[92:95], 0
buffer_load_dwordx4 v13, s[32:35], s64 offen lds
v_mfma_f32_16x16x32_bf16 a[124:127], a[24:27], a[88:91], a[124:127]
ds_read_b64_tr_b16 a[114:115], v5 offset:33792
v_mfma_f32_16x16x32_bf16 a[128:131], a[24:27], a[96:99], 0
s_xor_b32 m0, s84, 6144
ds_read_b64_tr_b16 a[116:117], v5 offset:40960
v_mfma_f32_16x16x32_bf16 a[128:131], a[28:31], a[100:103], a[128:131]
s_xor_b32 s64, s70, 49408
ds_read_b64_tr_b16 a[118:119], v5 offset:41984
v_mfma_f32_16x16x32_bf16 a[132:135], a[20:23], a[100:103], 0
buffer_load_dwordx4 v12, s[32:35], s64 offen lds
v_mfma_f32_16x16x32_bf16 a[132:135], a[16:19], a[96:99], a[132:135]
global_load_dwordx4 a[160:163], v19, s[22:23] offset:0
v_mfma_f32_16x16x32_bf16 a[136:139], a[8:11], a[96:99], 0
s_xor_b32 m0, s84, 7168
ds_read_b64_tr_b16 a[72:73], v6 offset:32768
v_mfma_f32_16x16x32_bf16 a[136:139], a[12:15], a[100:103], a[136:139]
s_xor_b32 s64, s70, 57600
ds_read_b64_tr_b16 a[74:75], v6 offset:33792
v_mfma_f32_16x16x32_bf16 a[140:143], a[4:7], a[100:103], 0
buffer_load_dwordx4 v13, s[32:35], s64 offen lds
v_mfma_f32_16x16x32_bf16 a[140:143], a[0:3], a[96:99], a[140:143]
s_waitcnt lgkmcnt(5)
ds_read_b64_tr_b16 a[76:77], v6 offset:40960
v_mfma_f32_16x16x32_bf16 v[184:187], a[104:107], a[32:35], v[184:187]
ds_read_b64_tr_b16 a[78:79], v6 offset:41984
v_mfma_f32_16x16x32_bf16 v[184:187], a[108:111], a[36:39], v[184:187]
ds_read_b64_tr_b16 a[80:81], v7 offset:32768
v_mfma_f32_16x16x32_bf16 v[192:195], a[108:111], a[44:47], v[192:195]
s_xor_b32 m0, s77, 65536
ds_read_b64_tr_b16 a[82:83], v7 offset:33792
v_mfma_f32_16x16x32_bf16 v[192:195], a[104:107], a[40:43], v[192:195]
s_xor_b32 s64, s71, 1572864
ds_read_b64_tr_b16 a[84:85], v7 offset:40960
v_mfma_f32_16x16x32_bf16 v[200:203], a[104:107], a[48:51], v[200:203]
buffer_load_dwordx4 v14, s[36:39], s64 offen lds
v_mfma_f32_16x16x32_bf16 v[200:203], a[108:111], a[52:55], v[200:203]
ds_read_b64_tr_b16 a[86:87], v7 offset:41984
v_mfma_f32_16x16x32_bf16 v[208:211], a[108:111], a[60:63], v[208:211]
s_xor_b32 m0, s77, 66560
ds_read_b64_tr_b16 a[88:89], v8 offset:32768
v_mfma_f32_16x16x32_bf16 v[208:211], a[104:107], a[56:59], v[208:211]
s_waitcnt lgkmcnt(7)
s_xor_b32 s64, s71, 1605632
ds_read_b64_tr_b16 a[90:91], v8 offset:33792
v_mfma_f32_16x16x32_bf16 v[212:215], a[112:115], a[56:59], v[212:215]
buffer_load_dwordx4 v14, s[36:39], s64 offen lds
v_mfma_f32_16x16x32_bf16 v[212:215], a[116:119], a[60:63], v[212:215]
ds_read_b64_tr_b16 a[92:93], v8 offset:40960
v_mfma_f32_16x16x32_bf16 v[204:207], a[116:119], a[52:55], v[204:207]
s_xor_b32 m0, s77, 67584
ds_read_b64_tr_b16 a[94:95], v8 offset:41984
v_mfma_f32_16x16x32_bf16 v[204:207], a[112:115], a[48:51], v[204:207]
s_xor_b32 s64, s71, 1638400
ds_read_b64_tr_b16 a[96:97], v9 offset:32768
v_mfma_f32_16x16x32_bf16 v[196:199], a[112:115], a[40:43], v[196:199]
buffer_load_dwordx4 v15, s[36:39], s64 offen lds
v_mfma_f32_16x16x32_bf16 v[196:199], a[116:119], a[44:47], v[196:199]
ds_read_b64_tr_b16 a[98:99], v9 offset:33792
v_mfma_f32_16x16x32_bf16 v[188:191], a[116:119], a[36:39], v[188:191]
s_xor_b32 m0, s77, 68608
ds_read_b64_tr_b16 a[100:101], v9 offset:40960
v_mfma_f32_16x16x32_bf16 v[188:191], a[112:115], a[32:35], v[188:191]
s_xor_b32 s64, s71, 1671168
ds_read_b64_tr_b16 a[102:103], v9 offset:41984
v_mfma_f32_16x16x32_bf16 v[216:219], a[72:75], a[32:35], v[216:219]
s_waitcnt lgkmcnt(7)
buffer_load_dwordx4 v15, s[36:39], s64 offen lds
v_mfma_f32_16x16x32_bf16 v[216:219], a[76:79], a[36:39], v[216:219]
global_load_dwordx4 a[148:151], v18, s[4:5] offset:512
v_mfma_f32_16x16x32_bf16 v[224:227], a[76:79], a[44:47], v[224:227]
ds_read_b64_tr_b16 a[104:105], v10 offset:32768
v_mfma_f32_16x16x32_bf16 v[224:227], a[72:75], a[40:43], v[224:227]
s_xor_b32 m0, s77, 81920
ds_read_b64_tr_b16 a[106:107], v10 offset:33792
v_mfma_f32_16x16x32_bf16 v[232:235], a[72:75], a[48:51], v[232:235]
s_xor_b32 s64, s71, 1572864
ds_read_b64_tr_b16 a[108:109], v10 offset:40960
v_mfma_f32_16x16x32_bf16 v[232:235], a[76:79], a[52:55], v[232:235]
buffer_load_dwordx4 v14, s[40:43], s64 offen lds
v_mfma_f32_16x16x32_bf16 v[240:243], a[76:79], a[60:63], v[240:243]
ds_read_b64_tr_b16 a[110:111], v10 offset:41984
v_mfma_f32_16x16x32_bf16 v[240:243], a[72:75], a[56:59], v[240:243]
s_xor_b32 m0, s77, 82944
ds_read_b64_tr_b16 a[112:113], v11 offset:32768
v_mfma_f32_16x16x32_bf16 v[244:247], a[80:83], a[56:59], v[244:247]
s_xor_b32 s64, s71, 1605632
ds_read_b64_tr_b16 a[114:115], v11 offset:33792
v_mfma_f32_16x16x32_bf16 v[244:247], a[84:87], a[60:63], v[244:247]
buffer_load_dwordx4 v14, s[40:43], s64 offen lds
v_mfma_f32_16x16x32_bf16 v[236:239], a[84:87], a[52:55], v[236:239]
ds_read_b64_tr_b16 a[116:117], v11 offset:40960
v_mfma_f32_16x16x32_bf16 v[236:239], a[80:83], a[48:51], v[236:239]
s_xor_b32 m0, s77, 83968
ds_read_b64_tr_b16 a[118:119], v11 offset:41984
v_mfma_f32_16x16x32_bf16 v[228:231], a[80:83], a[40:43], v[228:231]
s_xor_b32 s64, s71, 1638400
ds_read_b64_tr_b16 a[72:73], v4 offset:49152
v_mfma_f32_16x16x32_bf16 v[228:231], a[84:87], a[44:47], v[228:231]
buffer_load_dwordx4 v15, s[40:43], s64 offen lds
v_mfma_f32_16x16x32_bf16 v[220:223], a[84:87], a[36:39], v[220:223]
ds_read_b64_tr_b16 a[74:75], v4 offset:50176
v_mfma_f32_16x16x32_bf16 v[220:223], a[80:83], a[32:35], v[220:223]
s_waitcnt lgkmcnt(7)
s_xor_b32 m0, s77, 84992
ds_read_b64_tr_b16 a[76:77], v4 offset:57344
v_mfma_f32_16x16x32_bf16 v[152:155], a[88:91], a[32:35], v[152:155]
s_xor_b32 s64, s71, 1671168
ds_read_b64_tr_b16 a[78:79], v4 offset:58368
v_mfma_f32_16x16x32_bf16 v[152:155], a[92:95], a[36:39], v[152:155]
buffer_load_dwordx4 v15, s[40:43], s64 offen lds
v_mfma_f32_16x16x32_bf16 v[160:163], a[92:95], a[44:47], v[160:163]
ds_read_b64_tr_b16 a[80:81], v5 offset:49152
v_mfma_f32_16x16x32_bf16 v[160:163], a[88:91], a[40:43], v[160:163]
ds_read_b64_tr_b16 a[82:83], v5 offset:50176
v_mfma_f32_16x16x32_bf16 v[168:171], a[88:91], a[48:51], v[168:171]
ds_read_b64_tr_b16 a[84:85], v5 offset:57344
v_mfma_f32_16x16x32_bf16 v[168:171], a[92:95], a[52:55], v[168:171]
ds_read_b64_tr_b16 a[86:87], v5 offset:58368
v_mfma_f32_16x16x32_bf16 v[176:179], a[92:95], a[60:63], v[176:179]
s_xor_b32 m0, s84, 32768
global_load_dwordx4 a[164:167], v19, s[22:23] offset:512
v_mfma_f32_16x16x32_bf16 v[176:179], a[88:91], a[56:59], v[176:179]
s_xor_b32 s64, s70, 384
ds_read_b64_tr_b16 a[88:89], v6 offset:49152
v_mfma_f32_16x16x32_bf16 v[180:183], a[96:99], a[56:59], v[180:183]
buffer_load_dwordx4 v12, s[32:35], s64 offen lds
v_mfma_f32_16x16x32_bf16 v[180:183], a[100:103], a[60:63], v[180:183]
ds_read_b64_tr_b16 a[90:91], v6 offset:50176
v_mfma_f32_16x16x32_bf16 v[172:175], a[100:103], a[52:55], v[172:175]
ds_read_b64_tr_b16 a[92:93], v6 offset:57344
v_mfma_f32_16x16x32_bf16 v[172:175], a[96:99], a[48:51], v[172:175]
ds_read_b64_tr_b16 a[94:95], v6 offset:58368
v_mfma_f32_16x16x32_bf16 v[164:167], a[96:99], a[40:43], v[164:167]
v_mfma_f32_16x16x32_bf16 v[164:167], a[100:103], a[44:47], v[164:167]
s_xor_b32 m0, s84, 33792
v_mfma_f32_16x16x32_bf16 v[156:159], a[100:103], a[36:39], v[156:159]
s_xor_b32 s64, s70, 8576
v_mfma_f32_16x16x32_bf16 v[156:159], a[96:99], a[32:35], v[156:159]
buffer_load_dwordx4 v13, s[32:35], s64 offen lds
v_mfma_f32_16x16x32_bf16 v[24:27], a[104:107], a[32:35], v[24:27]
s_waitcnt lgkmcnt(4)
ds_read_b64_tr_b16 a[96:97], v7 offset:49152
v_mfma_f32_16x16x32_bf16 v[24:27], a[108:111], a[36:39], v[24:27]
ds_read_b64_tr_b16 a[98:99], v7 offset:50176
v_mfma_f32_16x16x32_bf16 v[40:43], a[108:111], a[44:47], v[40:43]
ds_read_b64_tr_b16 a[100:101], v7 offset:57344
v_mfma_f32_16x16x32_bf16 v[40:43], a[104:107], a[40:43], v[40:43]
ds_read_b64_tr_b16 a[102:103], v7 offset:58368
v_mfma_f32_16x16x32_bf16 v[56:59], a[104:107], a[48:51], v[56:59]
s_xor_b32 m0, s84, 34816
v_mfma_f32_16x16x32_bf16 v[56:59], a[108:111], a[52:55], v[56:59]
s_xor_b32 s64, s70, 16768
v_mfma_f32_16x16x32_bf16 v[72:75], a[108:111], a[60:63], v[72:75]
s_waitcnt vmcnt(12)
buffer_load_dwordx4 v12, s[32:35], s64 offen lds
v_mfma_f32_16x16x32_bf16 v[72:75], a[104:107], a[56:59], v[72:75]
ds_read_b64_tr_b16 a[104:105], v8 offset:49152
v_mfma_f32_16x16x32_bf16 v[136:139], a[112:115], a[56:59], v[136:139]
ds_read_b64_tr_b16 a[106:107], v8 offset:50176
v_mfma_f32_16x16x32_bf16 v[136:139], a[116:119], a[60:63], v[136:139]
ds_read_b64_tr_b16 a[108:109], v8 offset:57344
v_add_u32 v4, 0x8000, v4
v_mfma_f32_16x16x32_bf16 v[120:123], a[116:119], a[52:55], v[120:123]
ds_read_b64_tr_b16 a[110:111], v8 offset:58368
v_mfma_f32_16x16x32_bf16 v[120:123], a[112:115], a[48:51], v[120:123]
s_xor_b32 m0, s84, 35840
ds_read_b128 a[0:3], v2 offset:0
v_mfma_f32_16x16x32_bf16 v[104:107], a[112:115], a[40:43], v[104:107]
s_xor_b32 s64, s70, 24960
global_load_dwordx4 a[152:155], v18, s[4:5] offset:1024
v_mfma_f32_16x16x32_bf16 v[104:107], a[116:119], a[44:47], v[104:107]
s_branch L_po2
L_pg2:
s_branch L_tr0
L_po2:
buffer_load_dwordx4 v13, s[32:35], s64 offen lds
v_mfma_f32_16x16x32_bf16 v[88:91], a[116:119], a[36:39], v[88:91]
ds_read_b128 a[4:7], v3 offset:0
v_mfma_f32_16x16x32_bf16 v[88:91], a[112:115], a[32:35], v[88:91]
ds_read_b128 a[8:11], v2 offset:2048
v_mfma_f32_16x16x32_bf16 v[28:31], a[32:35], a[72:75], v[28:31]
ds_read_b128 a[12:15], v3 offset:2048
v_mfma_f32_16x16x32_bf16 v[28:31], a[36:39], a[76:79], v[28:31]
ds_read_b128 a[16:19], v2 offset:4096
v_add_u32 v5, 0x8000, v5
v_mfma_f32_16x16x32_bf16 v[44:47], a[44:47], a[76:79], v[44:47]
s_xor_b32 m0, s84, 36864
ds_read_b128 a[20:23], v3 offset:4096
v_mfma_f32_16x16x32_bf16 v[44:47], a[40:43], a[72:75], v[44:47]
s_xor_b32 s64, s70, 33152
ds_read_b128 a[24:27], v2 offset:6144
v_mfma_f32_16x16x32_bf16 v[60:63], a[48:51], a[72:75], v[60:63]
buffer_load_dwordx4 v12, s[32:35], s64 offen lds
v_mfma_f32_16x16x32_bf16 v[60:63], a[52:55], a[76:79], v[60:63]
ds_read_b128 a[28:31], v3 offset:6144
v_mfma_f32_16x16x32_bf16 v[76:79], a[60:63], a[76:79], v[76:79]
ds_read_b64_tr_b16 a[112:113], v9 offset:49152
v_mfma_f32_16x16x32_bf16 v[76:79], a[56:59], a[72:75], v[76:79]
ds_read_b64_tr_b16 a[114:115], v9 offset:50176
v_mfma_f32_16x16x32_bf16 v[140:143], a[56:59], a[80:83], v[140:143]
ds_read_b64_tr_b16 a[116:117], v9 offset:57344
v_mfma_f32_16x16x32_bf16 v[140:143], a[60:63], a[84:87], v[140:143]
s_xor_b32 m0, s84, 37888
ds_read_b64_tr_b16 a[118:119], v9 offset:58368
v_add_u32 v6, 0x8000, v6
v_mfma_f32_16x16x32_bf16 v[124:127], a[52:55], a[84:87], v[124:127]
s_xor_b32 s64, s70, 41344
ds_read_b64_tr_b16 a[72:73], v10 offset:49152
v_mfma_f32_16x16x32_bf16 v[124:127], a[48:51], a[80:83], v[124:127]
buffer_load_dwordx4 v13, s[32:35], s64 offen lds
v_mfma_f32_16x16x32_bf16 v[108:111], a[40:43], a[80:83], v[108:111]
ds_read_b64_tr_b16 a[74:75], v10 offset:50176
v_mfma_f32_16x16x32_bf16 v[108:111], a[44:47], a[84:87], v[108:111]
ds_read_b64_tr_b16 a[76:77], v10 offset:57344
v_mfma_f32_16x16x32_bf16 v[92:95], a[36:39], a[84:87], v[92:95]
ds_read_b64_tr_b16 a[78:79], v10 offset:58368
v_mfma_f32_16x16x32_bf16 v[92:95], a[32:35], a[80:83], v[92:95]
s_waitcnt lgkmcnt(8)
ds_read_b64_tr_b16 a[80:81], v11 offset:49152
v_mfma_f32_16x16x32_bf16 v[32:35], a[32:35], a[88:91], v[32:35]
s_xor_b32 m0, s84, 38912
ds_read_b64_tr_b16 a[82:83], v11 offset:50176
v_mfma_f32_16x16x32_bf16 v[32:35], a[36:39], a[92:95], v[32:35]
s_xor_b32 s64, s70, 49536
ds_read_b64_tr_b16 a[84:85], v11 offset:57344
v_add_u32 v7, 0x8000, v7
v_mfma_f32_16x16x32_bf16 v[48:51], a[44:47], a[92:95], v[48:51]
buffer_load_dwordx4 v12, s[32:35], s64 offen lds
v_mfma_f32_16x16x32_bf16 v[48:51], a[40:43], a[88:91], v[48:51]
global_load_dwordx4 a[168:171], v19, s[22:23] offset:1024
v_mfma_f32_16x16x32_bf16 v[64:67], a[48:51], a[88:91], v[64:67]
ds_read_b64_tr_b16 a[86:87], v11 offset:58368
v_mfma_f32_16x16x32_bf16 v[64:67], a[52:55], a[92:95], v[64:67]
v_mfma_f32_16x16x32_bf16 v[80:83], a[60:63], a[92:95], v[80:83]
v_mfma_f32_16x16x32_bf16 v[80:83], a[56:59], a[88:91], v[80:83]
s_xor_b32 m0, s84, 39936
v_mfma_f32_16x16x32_bf16 v[144:147], a[56:59], a[96:99], v[144:147]
s_xor_b32 s64, s70, 57728
v_mfma_f32_16x16x32_bf16 v[144:147], a[60:63], a[100:103], v[144:147]
buffer_load_dwordx4 v13, s[32:35], s64 offen lds
v_mfma_f32_16x16x32_bf16 v[128:131], a[52:55], a[100:103], v[128:131]
v_add_u32 v8, 0x8000, v8
v_mfma_f32_16x16x32_bf16 v[128:131], a[48:51], a[96:99], v[128:131]
v_mfma_f32_16x16x32_bf16 v[112:115], a[40:43], a[96:99], v[112:115]
v_mfma_f32_16x16x32_bf16 v[112:115], a[44:47], a[100:103], v[112:115]
v_mfma_f32_16x16x32_bf16 v[96:99], a[36:39], a[100:103], v[96:99]
v_add_u32 v9, 0x8000, v9
v_add_u32 v10, 0x8000, v10
v_mfma_f32_16x16x32_bf16 v[96:99], a[32:35], a[96:99], v[96:99]
v_add_u32 v11, 0x8000, v11
v_mfma_f32_16x16x32_bf16 v[36:39], a[32:35], a[104:107], v[36:39]
v_mfma_f32_16x16x32_bf16 v[36:39], a[36:39], a[108:111], v[36:39]
v_mfma_f32_16x16x32_bf16 v[52:55], a[44:47], a[108:111], v[52:55]
s_cmp_eq_u32 s30, 0
s_cbranch_scc1 L_pg6
s_cmp_eq_u32 s30, 1
s_cbranch_scc1 L_pg7
s_cmp_eq_u32 s30, 2
s_cbranch_scc1 L_pg8
s_branch L_pg9
L_tr1:
s_waitcnt lgkmcnt(0)
s_barrier
v_mfma_f32_16x16x32_bf16 v[52:55], a[40:43], a[104:107], v[52:55]
s_xor_b32 m0, s77, 98304
ds_read_b64_tr_b16 a[88:89], v4 offset:32768
v_mfma_f32_16x16x32_bf16 v[68:71], a[48:51], a[104:107], v[68:71]
s_xor_b32 s64, s71, 2097152
ds_read_b64_tr_b16 a[90:91], v4 offset:33792
v_mfma_f32_16x16x32_bf16 v[68:71], a[52:55], a[108:111], v[68:71]
buffer_load_dwordx4 v14, s[36:39], s64 offen lds
v_mfma_f32_16x16x32_bf16 v[84:87], a[60:63], a[108:111], v[84:87]
ds_read_b64_tr_b16 a[92:93], v4 offset:40960
v_mfma_f32_16x16x32_bf16 v[84:87], a[56:59], a[104:107], v[84:87]
ds_read_b64_tr_b16 a[94:95], v4 offset:41984
v_mfma_f32_16x16x32_bf16 v[148:151], a[56:59], a[112:115], v[148:151]
global_load_dwordx4 a[156:159], v18, s[4:5] offset:1536
v_mfma_f32_16x16x32_bf16 v[148:151], a[60:63], a[116:119], v[148:151]
ds_read_b64_tr_b16 a[96:97], v5 offset:32768
v_mfma_f32_16x16x32_bf16 v[132:135], a[52:55], a[116:119], v[132:135]
ds_read_b64_tr_b16 a[98:99], v5 offset:33792
v_mfma_f32_16x16x32_bf16 v[132:135], a[48:51], a[112:115], v[132:135]
s_xor_b32 m0, s77, 99328
ds_read_b64_tr_b16 a[100:101], v5 offset:40960
v_mfma_f32_16x16x32_bf16 v[116:119], a[40:43], a[112:115], v[116:119]
s_xor_b32 s64, s71, 2129920
ds_read_b64_tr_b16 a[102:103], v5 offset:41984
v_mfma_f32_16x16x32_bf16 v[116:119], a[44:47], a[116:119], v[116:119]
buffer_load_dwordx4 v14, s[36:39], s64 offen lds
v_mfma_f32_16x16x32_bf16 v[100:103], a[36:39], a[116:119], v[100:103]
ds_read_b64_tr_b16 a[104:105], v6 offset:32768
v_mfma_f32_16x16x32_bf16 v[100:103], a[32:35], a[112:115], v[100:103]
ds_read_b64_tr_b16 a[106:107], v6 offset:33792
v_mfma_f32_16x16x32_bf16 v[248:251], a[32:35], a[72:75], v[248:251]
ds_read_b64_tr_b16 a[108:109], v6 offset:40960
v_mfma_f32_16x16x32_bf16 v[248:251], a[36:39], a[76:79], v[248:251]
ds_read_b64_tr_b16 a[110:111], v6 offset:41984
v_mfma_f32_16x16x32_bf16 v[252:255], a[44:47], a[76:79], v[252:255]
ds_read_b64_tr_b16 a[112:113], v7 offset:32768
v_mfma_f32_16x16x32_bf16 v[252:255], a[40:43], a[72:75], v[252:255]
s_xor_b32 m0, s77, 100352
ds_read_b64_tr_b16 a[114:115], v7 offset:33792
v_mfma_f32_16x16x32_bf16 a[120:123], a[48:51], a[72:75], a[120:123]
s_xor_b32 s64, s71, 2162688
ds_read_b64_tr_b16 a[116:117], v7 offset:40960
v_mfma_f32_16x16x32_bf16 a[120:123], a[52:55], a[76:79], a[120:123]
buffer_load_dwordx4 v15, s[36:39], s64 offen lds
v_mfma_f32_16x16x32_bf16 a[124:127], a[60:63], a[76:79], a[124:127]
ds_read_b64_tr_b16 a[118:119], v7 offset:41984
v_mfma_f32_16x16x32_bf16 a[124:127], a[56:59], a[72:75], a[124:127]
ds_read_b64_tr_b16 a[72:73], v8 offset:32768
v_mfma_f32_16x16x32_bf16 a[128:131], a[56:59], a[80:83], a[128:131]
ds_read_b64_tr_b16 a[74:75], v8 offset:33792
v_mfma_f32_16x16x32_bf16 a[128:131], a[60:63], a[84:87], a[128:131]
ds_read_b64_tr_b16 a[76:77], v8 offset:40960
v_mfma_f32_16x16x32_bf16 a[132:135], a[52:55], a[84:87], a[132:135]
ds_read_b64_tr_b16 a[78:79], v8 offset:41984
v_mfma_f32_16x16x32_bf16 a[132:135], a[48:51], a[80:83], a[132:135]
s_xor_b32 m0, s77, 101376
v_mfma_f32_16x16x32_bf16 a[136:139], a[40:43], a[80:83], a[136:139]
s_xor_b32 s64, s71, 2195456
v_mfma_f32_16x16x32_bf16 a[136:139], a[44:47], a[84:87], a[136:139]
buffer_load_dwordx4 v15, s[36:39], s64 offen lds
v_mfma_f32_16x16x32_bf16 a[140:143], a[36:39], a[84:87], a[140:143]
global_load_dwordx4 a[172:175], v19, s[22:23] offset:1536
v_mfma_f32_16x16x32_bf16 a[140:143], a[32:35], a[80:83], a[140:143]
s_waitcnt lgkmcnt(5)
ds_read_b64_tr_b16 a[80:81], v9 offset:32768
v_mfma_f32_16x16x32_bf16 v[184:187], a[88:91], a[0:3], v[184:187]
ds_read_b64_tr_b16 a[82:83], v9 offset:33792
v_mfma_f32_16x16x32_bf16 v[184:187], a[92:95], a[4:7], v[184:187]
ds_read_b64_tr_b16 a[84:85], v9 offset:40960
v_mfma_f32_16x16x32_bf16 v[192:195], a[92:95], a[12:15], v[192:195]
ds_read_b64_tr_b16 a[86:87], v9 offset:41984
v_mfma_f32_16x16x32_bf16 v[192:195], a[88:91], a[8:11], v[192:195]
s_xor_b32 m0, s77, 114688
v_mfma_f32_16x16x32_bf16 v[200:203], a[88:91], a[16:19], v[200:203]
s_xor_b32 s64, s71, 2097152
v_mfma_f32_16x16x32_bf16 v[200:203], a[92:95], a[20:23], v[200:203]
buffer_load_dwordx4 v14, s[40:43], s64 offen lds
v_mfma_f32_16x16x32_bf16 v[208:211], a[92:95], a[28:31], v[208:211]
v_mfma_f32_16x16x32_bf16 v[208:211], a[88:91], a[24:27], v[208:211]
ds_read_b64_tr_b16 a[88:89], v10 offset:32768
v_mfma_f32_16x16x32_bf16 v[212:215], a[96:99], a[24:27], v[212:215]
ds_read_b64_tr_b16 a[90:91], v10 offset:33792
v_mfma_f32_16x16x32_bf16 v[212:215], a[100:103], a[28:31], v[212:215]
ds_read_b64_tr_b16 a[92:93], v10 offset:40960
v_mfma_f32_16x16x32_bf16 v[204:207], a[100:103], a[20:23], v[204:207]
ds_read_b64_tr_b16 a[94:95], v10 offset:41984
v_mfma_f32_16x16x32_bf16 v[204:207], a[96:99], a[16:19], v[204:207]
s_xor_b32 m0, s77, 115712
v_mfma_f32_16x16x32_bf16 v[196:199], a[96:99], a[8:11], v[196:199]
s_xor_b32 s64, s71, 2129920
v_mfma_f32_16x16x32_bf16 v[196:199], a[100:103], a[12:15], v[196:199]
buffer_load_dwordx4 v14, s[40:43], s64 offen lds
v_mfma_f32_16x16x32_bf16 v[188:191], a[100:103], a[4:7], v[188:191]
v_mfma_f32_16x16x32_bf16 v[188:191], a[96:99], a[0:3], v[188:191]
ds_read_b64_tr_b16 a[96:97], v11 offset:32768
v_mfma_f32_16x16x32_bf16 v[216:219], a[104:107], a[0:3], v[216:219]
ds_read_b64_tr_b16 a[98:99], v11 offset:33792
v_mfma_f32_16x16x32_bf16 v[216:219], a[108:111], a[4:7], v[216:219]
ds_read_b64_tr_b16 a[100:101], v11 offset:40960
v_mfma_f32_16x16x32_bf16 v[224:227], a[108:111], a[12:15], v[224:227]
ds_read_b64_tr_b16 a[102:103], v11 offset:41984
v_mfma_f32_16x16x32_bf16 v[224:227], a[104:107], a[8:11], v[224:227]
s_xor_b32 m0, s77, 116736
v_mfma_f32_16x16x32_bf16 v[232:235], a[104:107], a[16:19], v[232:235]
s_xor_b32 s64, s71, 2162688
buffer_store_dword v21, v20, s[44:47], s69 offen sc1
v_mfma_f32_16x16x32_bf16 v[232:235], a[108:111], a[20:23], v[232:235]
buffer_load_dwordx4 v15, s[40:43], s64 offen lds
v_mfma_f32_16x16x32_bf16 v[240:243], a[108:111], a[28:31], v[240:243]
v_mfma_f32_16x16x32_bf16 v[240:243], a[104:107], a[24:27], v[240:243]
ds_read_b64_tr_b16 a[104:105], v4 offset:49152
v_mfma_f32_16x16x32_bf16 v[244:247], a[112:115], a[24:27], v[244:247]
s_waitcnt lgkmcnt(5)
buffer_load_dword a252, v16, s[56:59], s81 offen
v_mfma_f32_16x16x32_bf16 v[244:247], a[116:119], a[28:31], v[244:247]
ds_read_b64_tr_b16 a[106:107], v4 offset:50176
v_mfma_f32_16x16x32_bf16 v[236:239], a[116:119], a[20:23], v[236:239]
ds_read_b64_tr_b16 a[108:109], v4 offset:57344
v_mfma_f32_16x16x32_bf16 v[236:239], a[112:115], a[16:19], v[236:239]
s_xor_b32 m0, s77, 117760
ds_read_b64_tr_b16 a[110:111], v4 offset:58368
v_mfma_f32_16x16x32_bf16 v[228:231], a[112:115], a[8:11], v[228:231]
s_xor_b32 s64, s71, 2195456
v_mfma_f32_16x16x32_bf16 v[228:231], a[116:119], a[12:15], v[228:231]
buffer_load_dwordx4 v15, s[40:43], s64 offen lds
v_mfma_f32_16x16x32_bf16 v[220:223], a[116:119], a[4:7], v[220:223]
v_mfma_f32_16x16x32_bf16 v[220:223], a[112:115], a[0:3], v[220:223]
ds_read_b64_tr_b16 a[112:113], v5 offset:49152
v_mfma_f32_16x16x32_bf16 v[152:155], a[72:75], a[0:3], v[152:155]
ds_read_b64_tr_b16 a[114:115], v5 offset:50176
v_mfma_f32_16x16x32_bf16 v[152:155], a[76:79], a[4:7], v[152:155]
ds_read_b64_tr_b16 a[116:117], v5 offset:57344
v_mfma_f32_16x16x32_bf16 v[160:163], a[76:79], a[12:15], v[160:163]
ds_read_b64_tr_b16 a[118:119], v5 offset:58368
v_mfma_f32_16x16x32_bf16 v[160:163], a[72:75], a[8:11], v[160:163]
v_mfma_f32_16x16x32_bf16 v[168:171], a[72:75], a[16:19], v[168:171]
v_mfma_f32_16x16x32_bf16 v[168:171], a[76:79], a[20:23], v[168:171]
v_mfma_f32_16x16x32_bf16 v[176:179], a[76:79], a[28:31], v[176:179]
s_xor_b32 m0, s84, 0
v_mfma_f32_16x16x32_bf16 v[176:179], a[72:75], a[24:27], v[176:179]
s_xor_b32 s64, s70, 512
ds_read_b64_tr_b16 a[72:73], v6 offset:49152
v_mfma_f32_16x16x32_bf16 v[180:183], a[80:83], a[24:27], v[180:183]
buffer_load_dwordx4 v12, s[32:35], s64 offen lds
v_mfma_f32_16x16x32_bf16 v[180:183], a[84:87], a[28:31], v[180:183]
ds_read_b64_tr_b16 a[74:75], v6 offset:50176
v_mfma_f32_16x16x32_bf16 v[172:175], a[84:87], a[20:23], v[172:175]
ds_read_b64_tr_b16 a[76:77], v6 offset:57344
v_mfma_f32_16x16x32_bf16 v[172:175], a[80:83], a[16:19], v[172:175]
ds_read_b64_tr_b16 a[78:79], v6 offset:58368
v_mfma_f32_16x16x32_bf16 v[164:167], a[80:83], a[8:11], v[164:167]
v_mfma_f32_16x16x32_bf16 v[164:167], a[84:87], a[12:15], v[164:167]
s_xor_b32 m0, s84, 1024
v_mfma_f32_16x16x32_bf16 v[156:159], a[84:87], a[4:7], v[156:159]
s_xor_b32 s64, s70, 8704
v_mfma_f32_16x16x32_bf16 v[156:159], a[80:83], a[0:3], v[156:159]
buffer_load_dwordx4 v13, s[32:35], s64 offen lds
v_mfma_f32_16x16x32_bf16 v[24:27], a[88:91], a[0:3], v[24:27]
ds_read_b64_tr_b16 a[80:81], v7 offset:49152
v_mfma_f32_16x16x32_bf16 v[24:27], a[92:95], a[4:7], v[24:27]
ds_read_b64_tr_b16 a[82:83], v7 offset:50176
v_mfma_f32_16x16x32_bf16 v[40:43], a[92:95], a[12:15], v[40:43]
ds_read_b64_tr_b16 a[84:85], v7 offset:57344
v_mfma_f32_16x16x32_bf16 v[40:43], a[88:91], a[8:11], v[40:43]
ds_read_b64_tr_b16 a[86:87], v7 offset:58368
v_mfma_f32_16x16x32_bf16 v[56:59], a[88:91], a[16:19], v[56:59]
s_xor_b32 m0, s84, 2048
v_mfma_f32_16x16x32_bf16 v[56:59], a[92:95], a[20:23], v[56:59]
s_xor_b32 s64, s70, 16896
v_mfma_f32_16x16x32_bf16 v[72:75], a[92:95], a[28:31], v[72:75]
s_waitcnt vmcnt(14)
buffer_load_dwordx4 v12, s[32:35], s64 offen lds
v_mfma_f32_16x16x32_bf16 v[72:75], a[88:91], a[24:27], v[72:75]
s_waitcnt lgkmcnt(4)
ds_read_b64_tr_b16 a[88:89], v8 offset:49152
v_mfma_f32_16x16x32_bf16 v[136:139], a[96:99], a[24:27], v[136:139]
buffer_load_dword a252, v1, s[60:63], s82 offen
v_mfma_f32_16x16x32_bf16 v[136:139], a[100:103], a[28:31], v[136:139]
ds_read_b64_tr_b16 a[90:91], v8 offset:50176
v_subrev_u32 v4, 0x8000, v4
v_mfma_f32_16x16x32_bf16 v[120:123], a[100:103], a[20:23], v[120:123]
ds_read_b64_tr_b16 a[92:93], v8 offset:57344
v_mfma_f32_16x16x32_bf16 v[120:123], a[96:99], a[16:19], v[120:123]
s_xor_b32 m0, s84, 3072
ds_read_b64_tr_b16 a[94:95], v8 offset:58368
v_mfma_f32_16x16x32_bf16 v[104:107], a[96:99], a[8:11], v[104:107]
s_xor_b32 s64, s70, 25088
ds_read_b128 a[32:35], v2 offset:32768
v_mfma_f32_16x16x32_bf16 v[104:107], a[100:103], a[12:15], v[104:107]
buffer_load_dwordx4 v13, s[32:35], s64 offen lds
v_mfma_f32_16x16x32_bf16 v[88:91], a[100:103], a[4:7], v[88:91]
ds_read_b128 a[36:39], v3 offset:32768
v_mfma_f32_16x16x32_bf16 v[88:91], a[96:99], a[0:3], v[88:91]
ds_read_b128 a[40:43], v2 offset:34816
v_mfma_f32_16x16x32_bf16 v[28:31], a[0:3], a[104:107], v[28:31]
ds_read_b128 a[44:47], v3 offset:34816
v_mfma_f32_16x16x32_bf16 v[28:31], a[4:7], a[108:111], v[28:31]
ds_read_b128 a[48:51], v2 offset:36864
v_subrev_u32 v5, 0x8000, v5
v_mfma_f32_16x16x32_bf16 v[44:47], a[12:15], a[108:111], v[44:47]
s_xor_b32 m0, s84, 4096
ds_read_b128 a[52:55], v3 offset:36864
v_mfma_f32_16x16x32_bf16 v[44:47], a[8:11], a[104:107], v[44:47]
s_xor_b32 s64, s70, 33280
ds_read_b128 a[56:59], v2 offset:38912
v_mfma_f32_16x16x32_bf16 v[60:63], a[16:19], a[104:107], v[60:63]
buffer_load_dwordx4 v12, s[32:35], s64 offen lds
v_mfma_f32_16x16x32_bf16 v[60:63], a[20:23], a[108:111], v[60:63]
ds_read_b128 a[60:63], v3 offset:38912
v_mfma_f32_16x16x32_bf16 v[76:79], a[28:31], a[108:111], v[76:79]
ds_read_b64_tr_b16 a[96:97], v9 offset:49152
v_mfma_f32_16x16x32_bf16 v[76:79], a[24:27], a[104:107], v[76:79]
ds_read_b64_tr_b16 a[98:99], v9 offset:50176
v_mfma_f32_16x16x32_bf16 v[140:143], a[24:27], a[112:115], v[140:143]
ds_read_b64_tr_b16 a[100:101], v9 offset:57344
v_mfma_f32_16x16x32_bf16 v[140:143], a[28:31], a[116:119], v[140:143]
s_xor_b32 m0, s84, 5120
ds_read_b64_tr_b16 a[102:103], v9 offset:58368
v_subrev_u32 v6, 0x8000, v6
v_mfma_f32_16x16x32_bf16 v[124:127], a[20:23], a[116:119], v[124:127]
s_xor_b32 s64, s70, 41472
ds_read_b64_tr_b16 a[104:105], v10 offset:49152
v_mfma_f32_16x16x32_bf16 v[124:127], a[16:19], a[112:115], v[124:127]
buffer_load_dwordx4 v13, s[32:35], s64 offen lds
v_mfma_f32_16x16x32_bf16 v[108:111], a[8:11], a[112:115], v[108:111]
ds_read_b64_tr_b16 a[106:107], v10 offset:50176
v_mfma_f32_16x16x32_bf16 v[108:111], a[12:15], a[116:119], v[108:111]
ds_read_b64_tr_b16 a[108:109], v10 offset:57344
v_mfma_f32_16x16x32_bf16 v[92:95], a[4:7], a[116:119], v[92:95]
ds_read_b64_tr_b16 a[110:111], v10 offset:58368
v_mfma_f32_16x16x32_bf16 v[92:95], a[0:3], a[112:115], v[92:95]
ds_read_b64_tr_b16 a[112:113], v11 offset:49152
v_mfma_f32_16x16x32_bf16 v[32:35], a[0:3], a[72:75], v[32:35]
s_xor_b32 m0, s84, 6144
ds_read_b64_tr_b16 a[114:115], v11 offset:50176
v_mfma_f32_16x16x32_bf16 v[32:35], a[4:7], a[76:79], v[32:35]
s_xor_b32 s64, s70, 49664
ds_read_b64_tr_b16 a[116:117], v11 offset:57344
v_subrev_u32 v7, 0x8000, v7
v_mfma_f32_16x16x32_bf16 v[48:51], a[12:15], a[76:79], v[48:51]
buffer_load_dwordx4 v12, s[32:35], s64 offen lds
v_mfma_f32_16x16x32_bf16 v[48:51], a[8:11], a[72:75], v[48:51]
ds_read_b64_tr_b16 a[118:119], v11 offset:58368
v_mfma_f32_16x16x32_bf16 v[64:67], a[16:19], a[72:75], v[64:67]
v_mfma_f32_16x16x32_bf16 v[64:67], a[20:23], a[76:79], v[64:67]
v_mfma_f32_16x16x32_bf16 v[80:83], a[28:31], a[76:79], v[80:83]
v_mfma_f32_16x16x32_bf16 v[80:83], a[24:27], a[72:75], v[80:83]
s_waitcnt lgkmcnt(5)
s_xor_b32 m0, s84, 7168
s_add_u32 s81, s81, 1048576
v_mfma_f32_16x16x32_bf16 v[144:147], a[24:27], a[80:83], v[144:147]
s_xor_b32 s64, s70, 57856
buffer_load_dword a252, v16, s[56:59], s81 offen
v_mfma_f32_16x16x32_bf16 v[144:147], a[28:31], a[84:87], v[144:147]
buffer_load_dwordx4 v13, s[32:35], s64 offen lds
v_mfma_f32_16x16x32_bf16 v[128:131], a[20:23], a[84:87], v[128:131]
v_subrev_u32 v8, 0x8000, v8
v_mfma_f32_16x16x32_bf16 v[128:131], a[16:19], a[80:83], v[128:131]
v_mfma_f32_16x16x32_bf16 v[112:115], a[8:11], a[80:83], v[112:115]
v_mfma_f32_16x16x32_bf16 v[112:115], a[12:15], a[84:87], v[112:115]
v_mfma_f32_16x16x32_bf16 v[96:99], a[4:7], a[84:87], v[96:99]
v_subrev_u32 v9, 0x8000, v9
v_subrev_u32 v10, 0x8000, v10
v_mfma_f32_16x16x32_bf16 v[96:99], a[0:3], a[80:83], v[96:99]
v_subrev_u32 v11, 0x8000, v11
v_mfma_f32_16x16x32_bf16 v[36:39], a[0:3], a[88:91], v[36:39]
v_mfma_f32_16x16x32_bf16 v[36:39], a[4:7], a[92:95], v[36:39]
v_mfma_f32_16x16x32_bf16 v[52:55], a[12:15], a[92:95], v[52:55]
s_waitcnt lgkmcnt(0)
s_barrier
v_mfma_f32_16x16x32_bf16 v[52:55], a[8:11], a[88:91], v[52:55]
s_xor_b32 m0, s77, 131072
ds_read_b64_tr_b16 a[72:73], v4 offset:0
v_mfma_f32_16x16x32_bf16 v[68:71], a[16:19], a[88:91], v[68:71]
s_xor_b32 s64, s71, 2621440
ds_read_b64_tr_b16 a[74:75], v4 offset:1024
v_mfma_f32_16x16x32_bf16 v[68:71], a[20:23], a[92:95], v[68:71]
buffer_load_dwordx4 v14, s[36:39], s64 offen lds
v_mfma_f32_16x16x32_bf16 v[84:87], a[28:31], a[92:95], v[84:87]
ds_read_b64_tr_b16 a[76:77], v4 offset:8192
v_mfma_f32_16x16x32_bf16 v[84:87], a[24:27], a[88:91], v[84:87]
ds_read_b64_tr_b16 a[78:79], v4 offset:9216
v_mfma_f32_16x16x32_bf16 v[148:151], a[24:27], a[96:99], v[148:151]
ds_read_b64_tr_b16 a[80:81], v5 offset:0
v_mfma_f32_16x16x32_bf16 v[148:151], a[28:31], a[100:103], v[148:151]
ds_read_b64_tr_b16 a[82:83], v5 offset:1024
v_mfma_f32_16x16x32_bf16 v[132:135], a[20:23], a[100:103], v[132:135]
ds_read_b64_tr_b16 a[84:85], v5 offset:8192
v_mfma_f32_16x16x32_bf16 v[132:135], a[16:19], a[96:99], v[132:135]
s_xor_b32 m0, s77, 132096
ds_read_b64_tr_b16 a[86:87], v5 offset:9216
v_mfma_f32_16x16x32_bf16 v[116:119], a[8:11], a[96:99], v[116:119]
s_xor_b32 s64, s71, 2654208
ds_read_b64_tr_b16 a[88:89], v6 offset:0
v_mfma_f32_16x16x32_bf16 v[116:119], a[12:15], a[100:103], v[116:119]
buffer_load_dwordx4 v14, s[36:39], s64 offen lds
v_mfma_f32_16x16x32_bf16 v[100:103], a[4:7], a[100:103], v[100:103]
ds_read_b64_tr_b16 a[90:91], v6 offset:1024
v_mfma_f32_16x16x32_bf16 v[100:103], a[0:3], a[96:99], v[100:103]
ds_read_b64_tr_b16 a[92:93], v6 offset:8192
v_mfma_f32_16x16x32_bf16 v[248:251], a[0:3], a[104:107], v[248:251]
ds_read_b64_tr_b16 a[94:95], v6 offset:9216
v_mfma_f32_16x16x32_bf16 v[248:251], a[4:7], a[108:111], v[248:251]
ds_read_b64_tr_b16 a[96:97], v7 offset:0
v_mfma_f32_16x16x32_bf16 v[252:255], a[12:15], a[108:111], v[252:255]
ds_read_b64_tr_b16 a[98:99], v7 offset:1024
v_mfma_f32_16x16x32_bf16 v[252:255], a[8:11], a[104:107], v[252:255]
s_xor_b32 m0, s77, 133120
ds_read_b64_tr_b16 a[100:101], v7 offset:8192
v_mfma_f32_16x16x32_bf16 a[120:123], a[16:19], a[104:107], a[120:123]
s_xor_b32 s64, s71, 2686976
ds_read_b64_tr_b16 a[102:103], v7 offset:9216
v_mfma_f32_16x16x32_bf16 a[120:123], a[20:23], a[108:111], a[120:123]
buffer_load_dwordx4 v15, s[36:39], s64 offen lds
v_mfma_f32_16x16x32_bf16 a[124:127], a[28:31], a[108:111], a[124:127]
v_mfma_f32_16x16x32_bf16 a[124:127], a[24:27], a[104:107], a[124:127]
s_add_u32 s82, s82, 1048576
ds_read_b64_tr_b16 a[104:105], v8 offset:0
v_mfma_f32_16x16x32_bf16 a[128:131], a[24:27], a[112:115], a[128:131]
buffer_load_dword a252, v1, s[60:63], s82 offen
v_mfma_f32_16x16x32_bf16 a[128:131], a[28:31], a[116:119], a[128:131]
ds_read_b64_tr_b16 a[106:107], v8 offset:1024
v_mfma_f32_16x16x32_bf16 a[132:135], a[20:23], a[116:119], a[132:135]
ds_read_b64_tr_b16 a[108:109], v8 offset:8192
v_mfma_f32_16x16x32_bf16 a[132:135], a[16:19], a[112:115], a[132:135]
s_xor_b32 m0, s77, 134144
ds_read_b64_tr_b16 a[110:111], v8 offset:9216
v_mfma_f32_16x16x32_bf16 a[136:139], a[8:11], a[112:115], a[136:139]
s_xor_b32 s64, s71, 2719744
v_mfma_f32_16x16x32_bf16 a[136:139], a[12:15], a[116:119], a[136:139]
buffer_load_dwordx4 v15, s[36:39], s64 offen lds
v_mfma_f32_16x16x32_bf16 a[140:143], a[4:7], a[116:119], a[140:143]
v_mfma_f32_16x16x32_bf16 a[140:143], a[0:3], a[112:115], a[140:143]
s_waitcnt lgkmcnt(4)
ds_read_b64_tr_b16 a[112:113], v9 offset:0
v_mfma_f32_16x16x32_bf16 v[184:187], a[72:75], a[32:35], v[184:187]
ds_read_b64_tr_b16 a[114:115], v9 offset:1024
v_mov_b32 v17, 0
v_mfma_f32_16x16x32_bf16 v[184:187], a[76:79], a[36:39], v[184:187]
ds_read_b64_tr_b16 a[116:117], v9 offset:8192
v_accvgpr_read_b32 v19, a144
v_mfma_f32_16x16x32_bf16 v[192:195], a[76:79], a[44:47], v[192:195]
ds_read_b64_tr_b16 a[118:119], v9 offset:9216
v_accvgpr_read_b32 v21, a160
v_mfma_f32_16x16x32_bf16 v[192:195], a[72:75], a[40:43], v[192:195]
s_xor_b32 m0, s77, 147456
v_lshlrev_b32 v18, 16, v19
v_and_b32 v19, 0xffff0000, v19
v_mfma_f32_16x16x32_bf16 v[200:203], a[72:75], a[48:51], v[200:203]
s_xor_b32 s64, s71, 2621440
v_lshlrev_b32 v20, 16, v21
v_and_b32 v21, 0xffff0000, v21
v_mfma_f32_16x16x32_bf16 v[200:203], a[76:79], a[52:55], v[200:203]
buffer_load_dwordx4 v14, s[40:43], s64 offen lds
v_mfma_f32_16x16x32_bf16 v[208:211], a[76:79], a[60:63], v[208:211]
v_mul_f32 v18, v18, v20
v_mul_f32 v19, v19, v21
v_mfma_f32_16x16x32_bf16 v[208:211], a[72:75], a[56:59], v[208:211]
ds_read_b64_tr_b16 a[72:73], v10 offset:0
v_cvt_pk_bf16_f32 v18, v18, v19
v_mfma_f32_16x16x32_bf16 v[212:215], a[80:83], a[56:59], v[212:215]
ds_read_b64_tr_b16 a[74:75], v10 offset:1024
v_lshlrev_b32 v19, 16, v18
v_mfma_f32_16x16x32_bf16 v[212:215], a[84:87], a[60:63], v[212:215]
ds_read_b64_tr_b16 a[76:77], v10 offset:8192
v_and_b32 v18, 0xffff0000, v18
v_mfma_f32_16x16x32_bf16 v[204:207], a[84:87], a[52:55], v[204:207]
ds_read_b64_tr_b16 a[78:79], v10 offset:9216
v_add_f32 v17, v17, v19
v_mfma_f32_16x16x32_bf16 v[204:207], a[80:83], a[48:51], v[204:207]
s_xor_b32 m0, s77, 148480
v_add_f32 v17, v17, v18
v_accvgpr_read_b32 v19, a145
v_mfma_f32_16x16x32_bf16 v[196:199], a[80:83], a[40:43], v[196:199]
s_xor_b32 s64, s71, 2654208
v_accvgpr_read_b32 v21, a161
v_lshlrev_b32 v18, 16, v19
v_mfma_f32_16x16x32_bf16 v[196:199], a[84:87], a[44:47], v[196:199]
buffer_load_dwordx4 v14, s[40:43], s64 offen lds
v_mfma_f32_16x16x32_bf16 v[188:191], a[84:87], a[36:39], v[188:191]
v_and_b32 v19, 0xffff0000, v19
v_lshlrev_b32 v20, 16, v21
v_mfma_f32_16x16x32_bf16 v[188:191], a[80:83], a[32:35], v[188:191]
ds_read_b64_tr_b16 a[80:81], v11 offset:0
v_and_b32 v21, 0xffff0000, v21
v_mfma_f32_16x16x32_bf16 v[216:219], a[88:91], a[32:35], v[216:219]
ds_read_b64_tr_b16 a[82:83], v11 offset:1024
v_mul_f32 v18, v18, v20
v_mfma_f32_16x16x32_bf16 v[216:219], a[92:95], a[36:39], v[216:219]
ds_read_b64_tr_b16 a[84:85], v11 offset:8192
v_mul_f32 v19, v19, v21
v_mfma_f32_16x16x32_bf16 v[224:227], a[92:95], a[44:47], v[224:227]
ds_read_b64_tr_b16 a[86:87], v11 offset:9216
v_cvt_pk_bf16_f32 v18, v18, v19
v_mfma_f32_16x16x32_bf16 v[224:227], a[88:91], a[40:43], v[224:227]
s_xor_b32 m0, s77, 149504
v_lshlrev_b32 v19, 16, v18
v_and_b32 v18, 0xffff0000, v18
v_mfma_f32_16x16x32_bf16 v[232:235], a[88:91], a[48:51], v[232:235]
s_xor_b32 s64, s71, 2686976
v_add_f32 v17, v17, v19
v_add_f32 v17, v17, v18
v_mfma_f32_16x16x32_bf16 v[232:235], a[92:95], a[52:55], v[232:235]
buffer_load_dwordx4 v15, s[40:43], s64 offen lds
v_mfma_f32_16x16x32_bf16 v[240:243], a[92:95], a[60:63], v[240:243]
v_accvgpr_read_b32 v19, a146
v_accvgpr_read_b32 v21, a162
v_mfma_f32_16x16x32_bf16 v[240:243], a[88:91], a[56:59], v[240:243]
s_add_u32 s81, s81, 1048576
ds_read_b64_tr_b16 a[88:89], v4 offset:16384
v_lshlrev_b32 v18, 16, v19
v_mfma_f32_16x16x32_bf16 v[244:247], a[96:99], a[56:59], v[244:247]
buffer_load_dword a252, v16, s[56:59], s81 offen
v_mfma_f32_16x16x32_bf16 v[244:247], a[100:103], a[60:63], v[244:247]
ds_read_b64_tr_b16 a[90:91], v4 offset:17408
v_and_b32 v19, 0xffff0000, v19
v_mfma_f32_16x16x32_bf16 v[236:239], a[100:103], a[52:55], v[236:239]
ds_read_b64_tr_b16 a[92:93], v4 offset:24576
v_lshlrev_b32 v20, 16, v21
v_mfma_f32_16x16x32_bf16 v[236:239], a[96:99], a[48:51], v[236:239]
s_xor_b32 m0, s77, 150528
ds_read_b64_tr_b16 a[94:95], v4 offset:25600
v_and_b32 v21, 0xffff0000, v21
v_mfma_f32_16x16x32_bf16 v[228:231], a[96:99], a[40:43], v[228:231]
s_xor_b32 s64, s71, 2719744
v_mul_f32 v18, v18, v20
v_mul_f32 v19, v19, v21
v_mfma_f32_16x16x32_bf16 v[228:231], a[100:103], a[44:47], v[228:231]
buffer_load_dwordx4 v15, s[40:43], s64 offen lds
v_mfma_f32_16x16x32_bf16 v[220:223], a[100:103], a[36:39], v[220:223]
v_cvt_pk_bf16_f32 v18, v18, v19
v_lshlrev_b32 v19, 16, v18
v_mfma_f32_16x16x32_bf16 v[220:223], a[96:99], a[32:35], v[220:223]
s_waitcnt lgkmcnt(4)
ds_read_b64_tr_b16 a[96:97], v5 offset:16384
v_and_b32 v18, 0xffff0000, v18
v_mfma_f32_16x16x32_bf16 v[152:155], a[104:107], a[32:35], v[152:155]
ds_read_b64_tr_b16 a[98:99], v5 offset:17408
v_add_f32 v17, v17, v19
v_mfma_f32_16x16x32_bf16 v[152:155], a[108:111], a[36:39], v[152:155]
ds_read_b64_tr_b16 a[100:101], v5 offset:24576
v_add_f32 v17, v17, v18
v_mfma_f32_16x16x32_bf16 v[160:163], a[108:111], a[44:47], v[160:163]
s_branch L_po3
L_pg3:
s_branch L_tr0
L_po3:
ds_read_b64_tr_b16 a[102:103], v5 offset:25600
v_accvgpr_read_b32 v19, a147
v_mfma_f32_16x16x32_bf16 v[160:163], a[104:107], a[40:43], v[160:163]
v_accvgpr_read_b32 v21, a163
v_lshlrev_b32 v18, 16, v19
v_mfma_f32_16x16x32_bf16 v[168:171], a[104:107], a[48:51], v[168:171]
v_and_b32 v19, 0xffff0000, v19
v_lshlrev_b32 v20, 16, v21
v_mfma_f32_16x16x32_bf16 v[168:171], a[108:111], a[52:55], v[168:171]
v_and_b32 v21, 0xffff0000, v21
v_mul_f32 v18, v18, v20
v_mfma_f32_16x16x32_bf16 v[176:179], a[108:111], a[60:63], v[176:179]
s_xor_b32 m0, s84, 32768
v_mul_f32 v19, v19, v21
v_cvt_pk_bf16_f32 v18, v18, v19
v_mfma_f32_16x16x32_bf16 v[176:179], a[104:107], a[56:59], v[176:179]
s_xor_b32 s64, s70, 640
ds_read_b64_tr_b16 a[104:105], v6 offset:16384
v_lshlrev_b32 v19, 16, v18
v_mfma_f32_16x16x32_bf16 v[180:183], a[112:115], a[56:59], v[180:183]
buffer_load_dwordx4 v12, s[32:35], s64 offen lds
v_mfma_f32_16x16x32_bf16 v[180:183], a[116:119], a[60:63], v[180:183]
ds_read_b64_tr_b16 a[106:107], v6 offset:17408
v_and_b32 v18, 0xffff0000, v18
v_mfma_f32_16x16x32_bf16 v[172:175], a[116:119], a[52:55], v[172:175]
ds_read_b64_tr_b16 a[108:109], v6 offset:24576
v_add_f32 v17, v17, v19
v_mfma_f32_16x16x32_bf16 v[172:175], a[112:115], a[48:51], v[172:175]
ds_read_b64_tr_b16 a[110:111], v6 offset:25600
v_add_f32 v17, v17, v18
v_mfma_f32_16x16x32_bf16 v[164:167], a[112:115], a[40:43], v[164:167]
v_accvgpr_read_b32 v19, a148
v_accvgpr_read_b32 v21, a164
v_mfma_f32_16x16x32_bf16 v[164:167], a[116:119], a[44:47], v[164:167]
s_xor_b32 m0, s84, 33792
v_lshlrev_b32 v18, 16, v19
v_and_b32 v19, 0xffff0000, v19
v_mfma_f32_16x16x32_bf16 v[156:159], a[116:119], a[36:39], v[156:159]
s_xor_b32 s64, s70, 8832
v_lshlrev_b32 v20, 16, v21
v_and_b32 v21, 0xffff0000, v21
v_mfma_f32_16x16x32_bf16 v[156:159], a[112:115], a[32:35], v[156:159]
buffer_load_dwordx4 v13, s[32:35], s64 offen lds
v_mfma_f32_16x16x32_bf16 v[24:27], a[72:75], a[32:35], v[24:27]
ds_read_b64_tr_b16 a[112:113], v7 offset:16384
v_mul_f32 v18, v18, v20
v_mfma_f32_16x16x32_bf16 v[24:27], a[76:79], a[36:39], v[24:27]
ds_read_b64_tr_b16 a[114:115], v7 offset:17408
v_mul_f32 v19, v19, v21
v_mfma_f32_16x16x32_bf16 v[40:43], a[76:79], a[44:47], v[40:43]
ds_read_b64_tr_b16 a[116:117], v7 offset:24576
v_cvt_pk_bf16_f32 v18, v18, v19
v_mfma_f32_16x16x32_bf16 v[40:43], a[72:75], a[40:43], v[40:43]
ds_read_b64_tr_b16 a[118:119], v7 offset:25600
v_lshlrev_b32 v19, 16, v18
v_mfma_f32_16x16x32_bf16 v[56:59], a[72:75], a[48:51], v[56:59]
s_xor_b32 m0, s84, 34816
v_and_b32 v18, 0xffff0000, v18
v_add_f32 v17, v17, v19
v_mfma_f32_16x16x32_bf16 v[56:59], a[76:79], a[52:55], v[56:59]
s_xor_b32 s64, s70, 17024
v_add_f32 v17, v17, v18
v_accvgpr_read_b32 v19, a149
v_mfma_f32_16x16x32_bf16 v[72:75], a[76:79], a[60:63], v[72:75]
s_waitcnt vmcnt(12)
buffer_load_dwordx4 v12, s[32:35], s64 offen lds
v_mfma_f32_16x16x32_bf16 v[72:75], a[72:75], a[56:59], v[72:75]
s_add_u32 s81, s81, 1048576
ds_read_b64_tr_b16 a[72:73], v8 offset:16384
v_accvgpr_read_b32 v21, a165
v_mfma_f32_16x16x32_bf16 v[136:139], a[80:83], a[56:59], v[136:139]
buffer_load_dword a252, v16, s[56:59], s81 offen
v_mfma_f32_16x16x32_bf16 v[136:139], a[84:87], a[60:63], v[136:139]
ds_read_b64_tr_b16 a[74:75], v8 offset:17408
v_lshlrev_b32 v18, 16, v19
v_mfma_f32_16x16x32_bf16 v[120:123], a[84:87], a[52:55], v[120:123]
ds_read_b64_tr_b16 a[76:77], v8 offset:24576
v_and_b32 v19, 0xffff0000, v19
v_mfma_f32_16x16x32_bf16 v[120:123], a[80:83], a[48:51], v[120:123]
s_xor_b32 m0, s84, 35840
ds_read_b64_tr_b16 a[78:79], v8 offset:25600
v_lshlrev_b32 v20, 16, v21
v_mfma_f32_16x16x32_bf16 v[104:107], a[80:83], a[40:43], v[104:107]
s_xor_b32 s64, s70, 25216
ds_read_b128 a[0:3], v2 offset:0
v_and_b32 v21, 0xffff0000, v21
v_mfma_f32_16x16x32_bf16 v[104:107], a[84:87], a[44:47], v[104:107]
buffer_load_dwordx4 v13, s[32:35], s64 offen lds
v_mfma_f32_16x16x32_bf16 v[88:91], a[84:87], a[36:39], v[88:91]
ds_read_b128 a[4:7], v3 offset:0
v_mul_f32 v18, v18, v20
v_mfma_f32_16x16x32_bf16 v[88:91], a[80:83], a[32:35], v[88:91]
s_waitcnt lgkmcnt(6)
ds_read_b128 a[8:11], v2 offset:2048
v_mul_f32 v19, v19, v21
v_mfma_f32_16x16x32_bf16 v[28:31], a[32:35], a[88:91], v[28:31]
ds_read_b128 a[12:15], v3 offset:2048
v_cvt_pk_bf16_f32 v18, v18, v19
v_mfma_f32_16x16x32_bf16 v[28:31], a[36:39], a[92:95], v[28:31]
ds_read_b128 a[16:19], v2 offset:4096
v_lshlrev_b32 v19, 16, v18
v_mfma_f32_16x16x32_bf16 v[44:47], a[44:47], a[92:95], v[44:47]
s_xor_b32 m0, s84, 36864
ds_read_b128 a[20:23], v3 offset:4096
v_and_b32 v18, 0xffff0000, v18
v_mfma_f32_16x16x32_bf16 v[44:47], a[40:43], a[88:91], v[44:47]
s_xor_b32 s64, s70, 33408
ds_read_b128 a[24:27], v2 offset:6144
v_add_f32 v17, v17, v19
v_mfma_f32_16x16x32_bf16 v[60:63], a[48:51], a[88:91], v[60:63]
buffer_load_dwordx4 v12, s[32:35], s64 offen lds
v_mfma_f32_16x16x32_bf16 v[60:63], a[52:55], a[92:95], v[60:63]
ds_read_b128 a[28:31], v3 offset:6144
v_add_f32 v17, v17, v18
v_mfma_f32_16x16x32_bf16 v[76:79], a[60:63], a[92:95], v[76:79]
ds_read_b64_tr_b16 a[80:81], v9 offset:16384
v_accvgpr_read_b32 v19, a150
v_mfma_f32_16x16x32_bf16 v[76:79], a[56:59], a[88:91], v[76:79]
ds_read_b64_tr_b16 a[82:83], v9 offset:17408
v_accvgpr_read_b32 v21, a166
v_mfma_f32_16x16x32_bf16 v[140:143], a[56:59], a[96:99], v[140:143]
ds_read_b64_tr_b16 a[84:85], v9 offset:24576
v_lshlrev_b32 v18, 16, v19
v_mfma_f32_16x16x32_bf16 v[140:143], a[60:63], a[100:103], v[140:143]
s_xor_b32 m0, s84, 37888
ds_read_b64_tr_b16 a[86:87], v9 offset:25600
v_and_b32 v19, 0xffff0000, v19
v_mfma_f32_16x16x32_bf16 v[124:127], a[52:55], a[100:103], v[124:127]
s_xor_b32 s64, s70, 41600
ds_read_b64_tr_b16 a[88:89], v10 offset:16384
v_lshlrev_b32 v20, 16, v21
v_mfma_f32_16x16x32_bf16 v[124:127], a[48:51], a[96:99], v[124:127]
buffer_load_dwordx4 v13, s[32:35], s64 offen lds
v_mfma_f32_16x16x32_bf16 v[108:111], a[40:43], a[96:99], v[108:111]
ds_read_b64_tr_b16 a[90:91], v10 offset:17408
v_and_b32 v21, 0xffff0000, v21
v_mfma_f32_16x16x32_bf16 v[108:111], a[44:47], a[100:103], v[108:111]
ds_read_b64_tr_b16 a[92:93], v10 offset:24576
v_mul_f32 v18, v18, v20
v_mfma_f32_16x16x32_bf16 v[92:95], a[36:39], a[100:103], v[92:95]
ds_read_b64_tr_b16 a[94:95], v10 offset:25600
v_mul_f32 v19, v19, v21
v_mfma_f32_16x16x32_bf16 v[92:95], a[32:35], a[96:99], v[92:95]
ds_read_b64_tr_b16 a[96:97], v11 offset:16384
v_cvt_pk_bf16_f32 v18, v18, v19
v_mfma_f32_16x16x32_bf16 v[32:35], a[32:35], a[104:107], v[32:35]
s_xor_b32 m0, s84, 38912
ds_read_b64_tr_b16 a[98:99], v11 offset:17408
v_lshlrev_b32 v19, 16, v18
v_mfma_f32_16x16x32_bf16 v[32:35], a[36:39], a[108:111], v[32:35]
s_xor_b32 s64, s70, 49792
ds_read_b64_tr_b16 a[100:101], v11 offset:24576
v_and_b32 v18, 0xffff0000, v18
v_mfma_f32_16x16x32_bf16 v[48:51], a[44:47], a[108:111], v[48:51]
buffer_load_dwordx4 v12, s[32:35], s64 offen lds
v_mfma_f32_16x16x32_bf16 v[48:51], a[40:43], a[104:107], v[48:51]
ds_read_b64_tr_b16 a[102:103], v11 offset:25600
v_add_f32 v17, v17, v19
v_mfma_f32_16x16x32_bf16 v[64:67], a[48:51], a[104:107], v[64:67]
v_add_f32 v17, v17, v18
v_accvgpr_read_b32 v19, a151
v_mfma_f32_16x16x32_bf16 v[64:67], a[52:55], a[108:111], v[64:67]
v_accvgpr_read_b32 v21, a167
v_lshlrev_b32 v18, 16, v19
v_mfma_f32_16x16x32_bf16 v[80:83], a[60:63], a[108:111], v[80:83]
s_add_u32 s82, s82, 1048576
v_and_b32 v19, 0xffff0000, v19
v_lshlrev_b32 v20, 16, v21
v_mfma_f32_16x16x32_bf16 v[80:83], a[56:59], a[104:107], v[80:83]
s_xor_b32 m0, s84, 39936
v_and_b32 v21, 0xffff0000, v21
v_mul_f32 v18, v18, v20
v_mfma_f32_16x16x32_bf16 v[144:147], a[56:59], a[112:115], v[144:147]
s_xor_b32 s64, s70, 57984
buffer_load_dword a252, v1, s[60:63], s82 offen
v_mfma_f32_16x16x32_bf16 v[144:147], a[60:63], a[116:119], v[144:147]
buffer_load_dwordx4 v13, s[32:35], s64 offen lds
v_mfma_f32_16x16x32_bf16 v[128:131], a[52:55], a[116:119], v[128:131]
v_mul_f32 v19, v19, v21
v_cvt_pk_bf16_f32 v18, v18, v19
v_mfma_f32_16x16x32_bf16 v[128:131], a[48:51], a[112:115], v[128:131]
v_lshlrev_b32 v19, 16, v18
v_and_b32 v18, 0xffff0000, v18
v_mfma_f32_16x16x32_bf16 v[112:115], a[40:43], a[112:115], v[112:115]
v_add_f32 v17, v17, v19
v_add_f32 v17, v17, v18
v_mfma_f32_16x16x32_bf16 v[112:115], a[44:47], a[116:119], v[112:115]
v_accvgpr_read_b32 v19, a152
v_accvgpr_read_b32 v21, a168
v_mfma_f32_16x16x32_bf16 v[96:99], a[36:39], a[116:119], v[96:99]
v_lshlrev_b32 v18, 16, v19
v_and_b32 v19, 0xffff0000, v19
v_mfma_f32_16x16x32_bf16 v[96:99], a[32:35], a[112:115], v[96:99]
s_waitcnt lgkmcnt(0)
v_lshlrev_b32 v20, 16, v21
v_and_b32 v21, 0xffff0000, v21
v_mfma_f32_16x16x32_bf16 v[36:39], a[32:35], a[72:75], v[36:39]
v_mul_f32 v18, v18, v20
v_mul_f32 v19, v19, v21
v_mfma_f32_16x16x32_bf16 v[36:39], a[36:39], a[76:79], v[36:39]
v_cvt_pk_bf16_f32 v18, v18, v19
v_lshlrev_b32 v19, 16, v18
v_mfma_f32_16x16x32_bf16 v[52:55], a[44:47], a[76:79], v[52:55]
s_waitcnt lgkmcnt(0)
s_barrier
v_mfma_f32_16x16x32_bf16 v[52:55], a[40:43], a[72:75], v[52:55]
s_xor_b32 m0, s77, 65536
ds_read_b64_tr_b16 a[104:105], v4 offset:32768
v_and_b32 v18, 0xffff0000, v18
v_mfma_f32_16x16x32_bf16 v[68:71], a[48:51], a[72:75], v[68:71]
s_xor_b32 s64, s71, 3145728
ds_read_b64_tr_b16 a[106:107], v4 offset:33792
v_add_f32 v17, v17, v19
v_mfma_f32_16x16x32_bf16 v[68:71], a[52:55], a[76:79], v[68:71]
buffer_load_dwordx4 v14, s[36:39], s64 offen lds
v_mfma_f32_16x16x32_bf16 v[84:87], a[60:63], a[76:79], v[84:87]
ds_read_b64_tr_b16 a[108:109], v4 offset:40960
v_add_f32 v17, v17, v18
v_mfma_f32_16x16x32_bf16 v[84:87], a[56:59], a[72:75], v[84:87]
ds_read_b64_tr_b16 a[110:111], v4 offset:41984
v_accvgpr_read_b32 v19, a153
v_mfma_f32_16x16x32_bf16 v[148:151], a[56:59], a[80:83], v[148:151]
ds_read_b64_tr_b16 a[112:113], v5 offset:32768
v_accvgpr_read_b32 v21, a169
v_mfma_f32_16x16x32_bf16 v[148:151], a[60:63], a[84:87], v[148:151]
ds_read_b64_tr_b16 a[114:115], v5 offset:33792
v_lshlrev_b32 v18, 16, v19
v_mfma_f32_16x16x32_bf16 v[132:135], a[52:55], a[84:87], v[132:135]
ds_read_b64_tr_b16 a[116:117], v5 offset:40960
v_and_b32 v19, 0xffff0000, v19
v_mfma_f32_16x16x32_bf16 v[132:135], a[48:51], a[80:83], v[132:135]
s_xor_b32 m0, s77, 66560
ds_read_b64_tr_b16 a[118:119], v5 offset:41984
v_lshlrev_b32 v20, 16, v21
v_mfma_f32_16x16x32_bf16 v[116:119], a[40:43], a[80:83], v[116:119]
s_xor_b32 s64, s71, 3178496
ds_read_b64_tr_b16 a[72:73], v6 offset:32768
v_and_b32 v21, 0xffff0000, v21
v_mfma_f32_16x16x32_bf16 v[116:119], a[44:47], a[84:87], v[116:119]
buffer_load_dwordx4 v14, s[36:39], s64 offen lds
v_mfma_f32_16x16x32_bf16 v[100:103], a[36:39], a[84:87], v[100:103]
ds_read_b64_tr_b16 a[74:75], v6 offset:33792
v_mul_f32 v18, v18, v20
v_mfma_f32_16x16x32_bf16 v[100:103], a[32:35], a[80:83], v[100:103]
ds_read_b64_tr_b16 a[76:77], v6 offset:40960
v_mul_f32 v19, v19, v21
v_mfma_f32_16x16x32_bf16 v[248:251], a[32:35], a[88:91], v[248:251]
ds_read_b64_tr_b16 a[78:79], v6 offset:41984
v_cvt_pk_bf16_f32 v18, v18, v19
v_mfma_f32_16x16x32_bf16 v[248:251], a[36:39], a[92:95], v[248:251]
ds_read_b64_tr_b16 a[80:81], v7 offset:32768
v_lshlrev_b32 v19, 16, v18
v_mfma_f32_16x16x32_bf16 v[252:255], a[44:47], a[92:95], v[252:255]
ds_read_b64_tr_b16 a[82:83], v7 offset:33792
v_and_b32 v18, 0xffff0000, v18
v_mfma_f32_16x16x32_bf16 v[252:255], a[40:43], a[88:91], v[252:255]
s_xor_b32 m0, s77, 67584
ds_read_b64_tr_b16 a[84:85], v7 offset:40960
v_add_f32 v17, v17, v19
v_mfma_f32_16x16x32_bf16 a[120:123], a[48:51], a[88:91], a[120:123]
s_xor_b32 s64, s71, 3211264
ds_read_b64_tr_b16 a[86:87], v7 offset:41984
v_add_f32 v17, v17, v18
v_mfma_f32_16x16x32_bf16 a[120:123], a[52:55], a[92:95], a[120:123]
buffer_load_dwordx4 v15, s[36:39], s64 offen lds
v_mfma_f32_16x16x32_bf16 a[124:127], a[60:63], a[92:95], a[124:127]
v_accvgpr_read_b32 v19, a154
v_accvgpr_read_b32 v21, a170
v_mfma_f32_16x16x32_bf16 a[124:127], a[56:59], a[88:91], a[124:127]
s_add_u32 s81, s81, 1048576
ds_read_b64_tr_b16 a[88:89], v8 offset:32768
v_lshlrev_b32 v18, 16, v19
v_mfma_f32_16x16x32_bf16 a[128:131], a[56:59], a[96:99], a[128:131]
buffer_load_dword a252, v16, s[56:59], s81 offen
v_mfma_f32_16x16x32_bf16 a[128:131], a[60:63], a[100:103], a[128:131]
ds_read_b64_tr_b16 a[90:91], v8 offset:33792
v_and_b32 v19, 0xffff0000, v19
v_mfma_f32_16x16x32_bf16 a[132:135], a[52:55], a[100:103], a[132:135]
ds_read_b64_tr_b16 a[92:93], v8 offset:40960
v_lshlrev_b32 v20, 16, v21
v_mfma_f32_16x16x32_bf16 a[132:135], a[48:51], a[96:99], a[132:135]
s_xor_b32 m0, s77, 68608
ds_read_b64_tr_b16 a[94:95], v8 offset:41984
v_and_b32 v21, 0xffff0000, v21
v_mfma_f32_16x16x32_bf16 a[136:139], a[40:43], a[96:99], a[136:139]
s_xor_b32 s64, s71, 3244032
v_mul_f32 v18, v18, v20
v_mul_f32 v19, v19, v21
v_mfma_f32_16x16x32_bf16 a[136:139], a[44:47], a[100:103], a[136:139]
buffer_load_dwordx4 v15, s[36:39], s64 offen lds
v_mfma_f32_16x16x32_bf16 a[140:143], a[36:39], a[100:103], a[140:143]
v_cvt_pk_bf16_f32 v18, v18, v19
v_lshlrev_b32 v19, 16, v18
v_mfma_f32_16x16x32_bf16 a[140:143], a[32:35], a[96:99], a[140:143]
s_waitcnt lgkmcnt(4)
ds_read_b64_tr_b16 a[96:97], v9 offset:32768
v_and_b32 v18, 0xffff0000, v18
v_mfma_f32_16x16x32_bf16 v[184:187], a[104:107], a[0:3], v[184:187]
ds_read_b64_tr_b16 a[98:99], v9 offset:33792
v_add_f32 v17, v17, v19
v_mfma_f32_16x16x32_bf16 v[184:187], a[108:111], a[4:7], v[184:187]
ds_read_b64_tr_b16 a[100:101], v9 offset:40960
v_add_f32 v17, v17, v18
v_mfma_f32_16x16x32_bf16 v[192:195], a[108:111], a[12:15], v[192:195]
ds_read_b64_tr_b16 a[102:103], v9 offset:41984
v_accvgpr_read_b32 v19, a155
v_mfma_f32_16x16x32_bf16 v[192:195], a[104:107], a[8:11], v[192:195]
s_xor_b32 m0, s77, 81920
v_accvgpr_read_b32 v21, a171
v_lshlrev_b32 v18, 16, v19
v_mfma_f32_16x16x32_bf16 v[200:203], a[104:107], a[16:19], v[200:203]
s_xor_b32 s64, s71, 3145728
v_and_b32 v19, 0xffff0000, v19
v_lshlrev_b32 v20, 16, v21
v_mfma_f32_16x16x32_bf16 v[200:203], a[108:111], a[20:23], v[200:203]
buffer_load_dwordx4 v14, s[40:43], s64 offen lds
v_mfma_f32_16x16x32_bf16 v[208:211], a[108:111], a[28:31], v[208:211]
v_and_b32 v21, 0xffff0000, v21
v_mul_f32 v18, v18, v20
v_mfma_f32_16x16x32_bf16 v[208:211], a[104:107], a[24:27], v[208:211]
ds_read_b64_tr_b16 a[104:105], v10 offset:32768
v_mul_f32 v19, v19, v21
v_mfma_f32_16x16x32_bf16 v[212:215], a[112:115], a[24:27], v[212:215]
ds_read_b64_tr_b16 a[106:107], v10 offset:33792
v_cvt_pk_bf16_f32 v18, v18, v19
v_mfma_f32_16x16x32_bf16 v[212:215], a[116:119], a[28:31], v[212:215]
ds_read_b64_tr_b16 a[108:109], v10 offset:40960
v_lshlrev_b32 v19, 16, v18
v_mfma_f32_16x16x32_bf16 v[204:207], a[116:119], a[20:23], v[204:207]
ds_read_b64_tr_b16 a[110:111], v10 offset:41984
v_and_b32 v18, 0xffff0000, v18
v_mfma_f32_16x16x32_bf16 v[204:207], a[112:115], a[16:19], v[204:207]
s_xor_b32 m0, s77, 82944
v_add_f32 v17, v17, v19
v_add_f32 v17, v17, v18
v_mfma_f32_16x16x32_bf16 v[196:199], a[112:115], a[8:11], v[196:199]
s_xor_b32 s64, s71, 3178496
v_accvgpr_read_b32 v19, a156
v_accvgpr_read_b32 v21, a172
v_mfma_f32_16x16x32_bf16 v[196:199], a[116:119], a[12:15], v[196:199]
buffer_load_dwordx4 v14, s[40:43], s64 offen lds
v_mfma_f32_16x16x32_bf16 v[188:191], a[116:119], a[4:7], v[188:191]
v_lshlrev_b32 v18, 16, v19
v_and_b32 v19, 0xffff0000, v19
v_mfma_f32_16x16x32_bf16 v[188:191], a[112:115], a[0:3], v[188:191]
ds_read_b64_tr_b16 a[112:113], v11 offset:32768
v_lshlrev_b32 v20, 16, v21
v_mfma_f32_16x16x32_bf16 v[216:219], a[72:75], a[0:3], v[216:219]
ds_read_b64_tr_b16 a[114:115], v11 offset:33792
v_and_b32 v21, 0xffff0000, v21
v_mfma_f32_16x16x32_bf16 v[216:219], a[76:79], a[4:7], v[216:219]
ds_read_b64_tr_b16 a[116:117], v11 offset:40960
v_mul_f32 v18, v18, v20
v_mfma_f32_16x16x32_bf16 v[224:227], a[76:79], a[12:15], v[224:227]
ds_read_b64_tr_b16 a[118:119], v11 offset:41984
v_mul_f32 v19, v19, v21
v_mfma_f32_16x16x32_bf16 v[224:227], a[72:75], a[8:11], v[224:227]
s_xor_b32 m0, s77, 83968
v_cvt_pk_bf16_f32 v18, v18, v19
v_lshlrev_b32 v19, 16, v18
v_mfma_f32_16x16x32_bf16 v[232:235], a[72:75], a[16:19], v[232:235]
s_xor_b32 s64, s71, 3211264
v_and_b32 v18, 0xffff0000, v18
v_add_f32 v17, v17, v19
v_mfma_f32_16x16x32_bf16 v[232:235], a[76:79], a[20:23], v[232:235]
buffer_load_dwordx4 v15, s[40:43], s64 offen lds
v_mfma_f32_16x16x32_bf16 v[240:243], a[76:79], a[28:31], v[240:243]
v_add_f32 v17, v17, v18
v_accvgpr_read_b32 v19, a157
v_mfma_f32_16x16x32_bf16 v[240:243], a[72:75], a[24:27], v[240:243]
s_add_u32 s82, s82, 1048576
ds_read_b64_tr_b16 a[72:73], v4 offset:49152
v_accvgpr_read_b32 v21, a173
v_mfma_f32_16x16x32_bf16 v[244:247], a[80:83], a[24:27], v[244:247]
buffer_load_dword a252, v1, s[60:63], s82 offen
v_mfma_f32_16x16x32_bf16 v[244:247], a[84:87], a[28:31], v[244:247]
ds_read_b64_tr_b16 a[74:75], v4 offset:50176
v_lshlrev_b32 v18, 16, v19
v_mfma_f32_16x16x32_bf16 v[236:239], a[84:87], a[20:23], v[236:239]
ds_read_b64_tr_b16 a[76:77], v4 offset:57344
v_and_b32 v19, 0xffff0000, v19
v_mfma_f32_16x16x32_bf16 v[236:239], a[80:83], a[16:19], v[236:239]
s_xor_b32 m0, s77, 84992
ds_read_b64_tr_b16 a[78:79], v4 offset:58368
v_lshlrev_b32 v20, 16, v21
v_mfma_f32_16x16x32_bf16 v[228:231], a[80:83], a[8:11], v[228:231]
s_xor_b32 s64, s71, 3244032
v_and_b32 v21, 0xffff0000, v21
v_mul_f32 v18, v18, v20
v_mfma_f32_16x16x32_bf16 v[228:231], a[84:87], a[12:15], v[228:231]
buffer_load_dwordx4 v15, s[40:43], s64 offen lds
v_mfma_f32_16x16x32_bf16 v[220:223], a[84:87], a[4:7], v[220:223]
v_mul_f32 v19, v19, v21
v_cvt_pk_bf16_f32 v18, v18, v19
v_mfma_f32_16x16x32_bf16 v[220:223], a[80:83], a[0:3], v[220:223]
s_waitcnt lgkmcnt(4)
ds_read_b64_tr_b16 a[80:81], v5 offset:49152
v_lshlrev_b32 v19, 16, v18
v_mfma_f32_16x16x32_bf16 v[152:155], a[88:91], a[0:3], v[152:155]
ds_read_b64_tr_b16 a[82:83], v5 offset:50176
v_and_b32 v18, 0xffff0000, v18
v_mfma_f32_16x16x32_bf16 v[152:155], a[92:95], a[4:7], v[152:155]
ds_read_b64_tr_b16 a[84:85], v5 offset:57344
v_add_f32 v17, v17, v19
v_mfma_f32_16x16x32_bf16 v[160:163], a[92:95], a[12:15], v[160:163]
ds_read_b64_tr_b16 a[86:87], v5 offset:58368
v_add_f32 v17, v17, v18
v_mfma_f32_16x16x32_bf16 v[160:163], a[88:91], a[8:11], v[160:163]
v_accvgpr_read_b32 v19, a158
v_accvgpr_read_b32 v21, a174
v_mfma_f32_16x16x32_bf16 v[168:171], a[88:91], a[16:19], v[168:171]
v_lshlrev_b32 v18, 16, v19
v_and_b32 v19, 0xffff0000, v19
v_mfma_f32_16x16x32_bf16 v[168:171], a[92:95], a[20:23], v[168:171]
v_lshlrev_b32 v20, 16, v21
v_and_b32 v21, 0xffff0000, v21
v_mfma_f32_16x16x32_bf16 v[176:179], a[92:95], a[28:31], v[176:179]
s_xor_b32 m0, s84, 0
v_mul_f32 v18, v18, v20
v_mul_f32 v19, v19, v21
v_mfma_f32_16x16x32_bf16 v[176:179], a[88:91], a[24:27], v[176:179]
s_xor_b32 s64, s70, 768
ds_read_b64_tr_b16 a[88:89], v6 offset:49152
v_cvt_pk_bf16_f32 v18, v18, v19
v_mfma_f32_16x16x32_bf16 v[180:183], a[96:99], a[24:27], v[180:183]
buffer_load_dwordx4 v12, s[32:35], s64 offen lds
v_mfma_f32_16x16x32_bf16 v[180:183], a[100:103], a[28:31], v[180:183]
ds_read_b64_tr_b16 a[90:91], v6 offset:50176
v_lshlrev_b32 v19, 16, v18
v_mfma_f32_16x16x32_bf16 v[172:175], a[100:103], a[20:23], v[172:175]
ds_read_b64_tr_b16 a[92:93], v6 offset:57344
v_and_b32 v18, 0xffff0000, v18
v_mfma_f32_16x16x32_bf16 v[172:175], a[96:99], a[16:19], v[172:175]
ds_read_b64_tr_b16 a[94:95], v6 offset:58368
v_add_f32 v17, v17, v19
v_mfma_f32_16x16x32_bf16 v[164:167], a[96:99], a[8:11], v[164:167]
v_add_f32 v17, v17, v18
v_accvgpr_read_b32 v19, a159
v_mfma_f32_16x16x32_bf16 v[164:167], a[100:103], a[12:15], v[164:167]
s_xor_b32 m0, s84, 1024
v_accvgpr_read_b32 v21, a175
v_lshlrev_b32 v18, 16, v19
v_mfma_f32_16x16x32_bf16 v[156:159], a[100:103], a[4:7], v[156:159]
s_xor_b32 s64, s70, 8960
v_and_b32 v19, 0xffff0000, v19
v_lshlrev_b32 v20, 16, v21
v_mfma_f32_16x16x32_bf16 v[156:159], a[96:99], a[0:3], v[156:159]
buffer_load_dwordx4 v13, s[32:35], s64 offen lds
v_mfma_f32_16x16x32_bf16 v[24:27], a[104:107], a[0:3], v[24:27]
ds_read_b64_tr_b16 a[96:97], v7 offset:49152
v_and_b32 v21, 0xffff0000, v21
v_mfma_f32_16x16x32_bf16 v[24:27], a[108:111], a[4:7], v[24:27]
ds_read_b64_tr_b16 a[98:99], v7 offset:50176
v_mul_f32 v18, v18, v20
v_mfma_f32_16x16x32_bf16 v[40:43], a[108:111], a[12:15], v[40:43]
ds_read_b64_tr_b16 a[100:101], v7 offset:57344
v_mul_f32 v19, v19, v21
v_mfma_f32_16x16x32_bf16 v[40:43], a[104:107], a[8:11], v[40:43]
ds_read_b64_tr_b16 a[102:103], v7 offset:58368
v_cvt_pk_bf16_f32 v18, v18, v19
v_mfma_f32_16x16x32_bf16 v[56:59], a[104:107], a[16:19], v[56:59]
s_xor_b32 m0, s84, 2048
v_lshlrev_b32 v19, 16, v18
v_and_b32 v18, 0xffff0000, v18
v_mfma_f32_16x16x32_bf16 v[56:59], a[108:111], a[20:23], v[56:59]
s_xor_b32 s64, s70, 17152
v_add_f32 v17, v17, v19
v_add_f32 v17, v17, v18
v_mfma_f32_16x16x32_bf16 v[72:75], a[108:111], a[28:31], v[72:75]
s_waitcnt vmcnt(12)
buffer_load_dwordx4 v12, s[32:35], s64 offen lds
v_mfma_f32_16x16x32_bf16 v[72:75], a[104:107], a[24:27], v[72:75]
s_add_u32 s81, s81, 1048576
ds_read_b64_tr_b16 a[104:105], v8 offset:49152
v_add_f32_dpp v17, v17, v17 row_ror:8 row_mask:0xf bank_mask:0xf
v_mfma_f32_16x16x32_bf16 v[136:139], a[112:115], a[24:27], v[136:139]
buffer_load_dword a252, v16, s[56:59], s81 offen
v_mfma_f32_16x16x32_bf16 v[136:139], a[116:119], a[28:31], v[136:139]
ds_read_b64_tr_b16 a[106:107], v8 offset:50176
v_add_u32 v4, 0x8000, v4
v_mfma_f32_16x16x32_bf16 v[120:123], a[116:119], a[20:23], v[120:123]
ds_read_b64_tr_b16 a[108:109], v8 offset:57344
v_add_f32_dpp v17, v17, v17 row_ror:4 row_mask:0xf bank_mask:0xf
v_mfma_f32_16x16x32_bf16 v[120:123], a[112:115], a[16:19], v[120:123]
s_xor_b32 m0, s84, 3072
ds_read_b64_tr_b16 a[110:111], v8 offset:58368
v_mfma_f32_16x16x32_bf16 v[104:107], a[112:115], a[8:11], v[104:107]
s_xor_b32 s64, s70, 25344
ds_read_b128 a[32:35], v2 offset:32768
v_add_f32_dpp v17, v17, v17 row_ror:2 row_mask:0xf bank_mask:0xf
v_mfma_f32_16x16x32_bf16 v[104:107], a[116:119], a[12:15], v[104:107]
buffer_load_dwordx4 v13, s[32:35], s64 offen lds
v_mfma_f32_16x16x32_bf16 v[88:91], a[116:119], a[4:7], v[88:91]
ds_read_b128 a[36:39], v3 offset:32768
v_add_f32_dpp v17, v17, v17 row_ror:1 row_mask:0xf bank_mask:0xf
v_mfma_f32_16x16x32_bf16 v[88:91], a[112:115], a[0:3], v[88:91]
s_waitcnt lgkmcnt(6)
ds_read_b128 a[40:43], v2 offset:34816
v_mov_b32 v18, v17
v_mfma_f32_16x16x32_bf16 v[28:31], a[0:3], a[72:75], v[28:31]
ds_read_b128 a[44:47], v3 offset:34816
v_mfma_f32_16x16x32_bf16 v[28:31], a[4:7], a[76:79], v[28:31]
ds_read_b128 a[48:51], v2 offset:36864
v_add_u32 v5, 0x8000, v5
v_mfma_f32_16x16x32_bf16 v[44:47], a[12:15], a[76:79], v[44:47]
s_xor_b32 m0, s84, 4096
ds_read_b128 a[52:55], v3 offset:36864
v_permlane16_swap_b32 v18, v17
v_mfma_f32_16x16x32_bf16 v[44:47], a[8:11], a[72:75], v[44:47]
s_xor_b32 s64, s70, 33536
ds_read_b128 a[56:59], v2 offset:38912
v_add_f32 v17, v17, v18
v_mfma_f32_16x16x32_bf16 v[60:63], a[16:19], a[72:75], v[60:63]
buffer_load_dwordx4 v12, s[32:35], s64 offen lds
v_mfma_f32_16x16x32_bf16 v[60:63], a[20:23], a[76:79], v[60:63]
ds_read_b128 a[60:63], v3 offset:38912
v_cvt_pk_bf16_f32 v17, v17, v17
v_mfma_f32_16x16x32_bf16 v[76:79], a[28:31], a[76:79], v[76:79]
ds_read_b64_tr_b16 a[112:113], v9 offset:49152
v_and_b32 v17, 0xffff0000, v17
v_mfma_f32_16x16x32_bf16 v[76:79], a[24:27], a[72:75], v[76:79]
ds_read_b64_tr_b16 a[114:115], v9 offset:50176
v_mul_f32 v17, 0xbfb8aa3b, v17
v_mfma_f32_16x16x32_bf16 v[140:143], a[24:27], a[80:83], v[140:143]
ds_read_b64_tr_b16 a[116:117], v9 offset:57344
v_mfma_f32_16x16x32_bf16 v[140:143], a[28:31], a[84:87], v[140:143]
s_xor_b32 m0, s84, 5120
ds_read_b64_tr_b16 a[118:119], v9 offset:58368
v_add_u32 v6, 0x8000, v6
v_mfma_f32_16x16x32_bf16 v[124:127], a[20:23], a[84:87], v[124:127]
s_xor_b32 s64, s70, 41728
ds_read_b64_tr_b16 a[72:73], v10 offset:49152
v_mfma_f32_16x16x32_bf16 v[124:127], a[16:19], a[80:83], v[124:127]
buffer_load_dwordx4 v13, s[32:35], s64 offen lds
v_mfma_f32_16x16x32_bf16 v[108:111], a[8:11], a[80:83], v[108:111]
ds_read_b64_tr_b16 a[74:75], v10 offset:50176
v_mfma_f32_16x16x32_bf16 v[108:111], a[12:15], a[84:87], v[108:111]
ds_read_b64_tr_b16 a[76:77], v10 offset:57344
v_mfma_f32_16x16x32_bf16 v[92:95], a[4:7], a[84:87], v[92:95]
ds_read_b64_tr_b16 a[78:79], v10 offset:58368
v_mfma_f32_16x16x32_bf16 v[92:95], a[0:3], a[80:83], v[92:95]
ds_read_b64_tr_b16 a[80:81], v11 offset:49152
v_mfma_f32_16x16x32_bf16 v[32:35], a[0:3], a[88:91], v[32:35]
s_xor_b32 m0, s84, 6144
ds_read_b64_tr_b16 a[82:83], v11 offset:50176
v_mfma_f32_16x16x32_bf16 v[32:35], a[4:7], a[92:95], v[32:35]
s_xor_b32 s64, s70, 49920
ds_read_b64_tr_b16 a[84:85], v11 offset:57344
v_add_u32 v7, 0x8000, v7
v_mfma_f32_16x16x32_bf16 v[48:51], a[12:15], a[92:95], v[48:51]
buffer_load_dwordx4 v12, s[32:35], s64 offen lds
v_mfma_f32_16x16x32_bf16 v[48:51], a[8:11], a[88:91], v[48:51]
ds_read_b64_tr_b16 a[86:87], v11 offset:58368
v_mfma_f32_16x16x32_bf16 v[64:67], a[16:19], a[88:91], v[64:67]
v_exp_f32 v17, v17
v_mfma_f32_16x16x32_bf16 v[64:67], a[20:23], a[92:95], v[64:67]
v_add_f32 v17, 1.0, v17
v_mfma_f32_16x16x32_bf16 v[80:83], a[28:31], a[92:95], v[80:83]
v_rcp_f32 v17, v17
v_mfma_f32_16x16x32_bf16 v[80:83], a[24:27], a[88:91], v[80:83]
s_xor_b32 m0, s84, 7168
s_add_u32 s81, s81, 1048576
v_cvt_pk_bf16_f32 v18, v17, v17
v_mfma_f32_16x16x32_bf16 v[144:147], a[24:27], a[96:99], v[144:147]
s_xor_b32 s64, s70, 58112
buffer_load_dword a252, v16, s[56:59], s81 offen
v_mfma_f32_16x16x32_bf16 v[144:147], a[28:31], a[100:103], v[144:147]
s_branch L_po4
L_pg4:
s_branch L_tr0
L_po4:
buffer_load_dwordx4 v13, s[32:35], s64 offen lds
v_mfma_f32_16x16x32_bf16 v[128:131], a[20:23], a[100:103], v[128:131]
v_add_u32 v8, 0x8000, v8
v_and_b32 v18, 0xffff0000, v18
v_mfma_f32_16x16x32_bf16 v[128:131], a[16:19], a[96:99], v[128:131]
v_sub_f32 v19, 1.0, v18
v_mfma_f32_16x16x32_bf16 v[112:115], a[8:11], a[96:99], v[112:115]
v_cvt_pk_bf16_f32 v19, v19, v19
v_mfma_f32_16x16x32_bf16 v[112:115], a[12:15], a[100:103], v[112:115]
v_and_b32 v19, 0xffff0000, v19
v_mfma_f32_16x16x32_bf16 v[96:99], a[4:7], a[100:103], v[96:99]
v_add_u32 v9, 0x8000, v9
v_add_u32 v10, 0x8000, v10
v_mfma_f32_16x16x32_bf16 v[96:99], a[0:3], a[96:99], v[96:99]
s_waitcnt lgkmcnt(0)
v_add_u32 v11, 0x8000, v11
v_and_b32 v20, 31, v0
v_mfma_f32_16x16x32_bf16 v[36:39], a[0:3], a[104:107], v[36:39]
v_lshlrev_b32 v20, 27, v20
v_mfma_f32_16x16x32_bf16 v[36:39], a[4:7], a[108:111], v[36:39]
v_lshrrev_b32 v21, 2, v0
v_mfma_f32_16x16x32_bf16 v[52:55], a[12:15], a[108:111], v[52:55]
s_waitcnt lgkmcnt(0)
s_barrier
v_mfma_f32_16x16x32_bf16 v[52:55], a[8:11], a[104:107], v[52:55]
s_xor_b32 m0, s77, 98304
ds_read_b64_tr_b16 a[88:89], v4 offset:32768
v_add_u32 v20, v20, v21
v_mfma_f32_16x16x32_bf16 v[68:71], a[16:19], a[104:107], v[68:71]
s_xor_b32 s64, s71, 3670016
ds_read_b64_tr_b16 a[90:91], v4 offset:33792
v_mfma_f32_16x16x32_bf16 v[68:71], a[20:23], a[108:111], v[68:71]
buffer_load_dwordx4 v14, s[36:39], s64 offen lds
v_mfma_f32_16x16x32_bf16 v[84:87], a[28:31], a[108:111], v[84:87]
ds_read_b64_tr_b16 a[92:93], v4 offset:40960
v_mfma_f32_16x16x32_bf16 v[84:87], a[24:27], a[104:107], v[84:87]
ds_read_b64_tr_b16 a[94:95], v4 offset:41984
v_mfma_f32_16x16x32_bf16 v[148:151], a[24:27], a[112:115], v[148:151]
ds_read_b64_tr_b16 a[96:97], v5 offset:32768
v_mfma_f32_16x16x32_bf16 v[148:151], a[28:31], a[116:119], v[148:151]
ds_read_b64_tr_b16 a[98:99], v5 offset:33792
v_mfma_f32_16x16x32_bf16 v[132:135], a[20:23], a[116:119], v[132:135]
ds_read_b64_tr_b16 a[100:101], v5 offset:40960
v_mfma_f32_16x16x32_bf16 v[132:135], a[16:19], a[112:115], v[132:135]
s_xor_b32 m0, s77, 99328
ds_read_b64_tr_b16 a[102:103], v5 offset:41984
v_mfma_f32_16x16x32_bf16 v[116:119], a[8:11], a[112:115], v[116:119]
s_xor_b32 s64, s71, 3702784
ds_read_b64_tr_b16 a[104:105], v6 offset:32768
v_mfma_f32_16x16x32_bf16 v[116:119], a[12:15], a[116:119], v[116:119]
buffer_load_dwordx4 v14, s[36:39], s64 offen lds
v_mfma_f32_16x16x32_bf16 v[100:103], a[4:7], a[116:119], v[100:103]
ds_read_b64_tr_b16 a[106:107], v6 offset:33792
v_mfma_f32_16x16x32_bf16 v[100:103], a[0:3], a[112:115], v[100:103]
ds_read_b64_tr_b16 a[108:109], v6 offset:40960
v_mfma_f32_16x16x32_bf16 v[248:251], a[0:3], a[72:75], v[248:251]
ds_read_b64_tr_b16 a[110:111], v6 offset:41984
v_mfma_f32_16x16x32_bf16 v[248:251], a[4:7], a[76:79], v[248:251]
ds_read_b64_tr_b16 a[112:113], v7 offset:32768
v_mfma_f32_16x16x32_bf16 v[252:255], a[12:15], a[76:79], v[252:255]
ds_read_b64_tr_b16 a[114:115], v7 offset:33792
v_mfma_f32_16x16x32_bf16 v[252:255], a[8:11], a[72:75], v[252:255]
s_xor_b32 m0, s77, 100352
ds_read_b64_tr_b16 a[116:117], v7 offset:40960
v_mfma_f32_16x16x32_bf16 a[120:123], a[16:19], a[72:75], a[120:123]
s_xor_b32 s64, s71, 3735552
s_lshl2_add_u32 s65, s2, s30
ds_read_b64_tr_b16 a[118:119], v7 offset:41984
v_mfma_f32_16x16x32_bf16 a[120:123], a[20:23], a[76:79], a[120:123]
s_lshl4_add_u32 s65, s65, 58720256
buffer_load_dwordx4 v15, s[36:39], s64 offen lds
v_mfma_f32_16x16x32_bf16 a[124:127], a[28:31], a[76:79], a[124:127]
buffer_store_dwordx2 v[18:19], v20, s[44:47], s65 offen sc1
v_mfma_f32_16x16x32_bf16 a[124:127], a[24:27], a[72:75], a[124:127]
s_add_u32 s82, s82, 1048576
ds_read_b64_tr_b16 a[72:73], v8 offset:32768
v_lshrrev_b32 v21, 4, v0
v_mfma_f32_16x16x32_bf16 a[128:131], a[24:27], a[80:83], a[128:131]
buffer_load_dword a252, v1, s[60:63], s82 offen
v_mfma_f32_16x16x32_bf16 a[128:131], a[28:31], a[84:87], a[128:131]
ds_read_b64_tr_b16 a[74:75], v8 offset:33792
v_bfe_u32 v19, v0, 2, 2
v_mfma_f32_16x16x32_bf16 a[132:135], a[20:23], a[84:87], a[132:135]
ds_read_b64_tr_b16 a[76:77], v8 offset:40960
v_lshl_add_u32 v19, v21, 3, v19
v_mfma_f32_16x16x32_bf16 a[132:135], a[16:19], a[80:83], a[132:135]
s_xor_b32 m0, s77, 101376
ds_read_b64_tr_b16 a[78:79], v8 offset:41984
v_lshlrev_b32 v19, 6, v19
v_mfma_f32_16x16x32_bf16 a[136:139], a[8:11], a[80:83], a[136:139]
s_xor_b32 s64, s71, 3768320
v_and_b32 v21, 1, v21
v_mfma_f32_16x16x32_bf16 a[136:139], a[12:15], a[84:87], a[136:139]
buffer_load_dwordx4 v15, s[36:39], s64 offen lds
v_mfma_f32_16x16x32_bf16 a[140:143], a[4:7], a[84:87], a[140:143]
v_lshl_add_u32 v19, v21, 5, v19
v_mfma_f32_16x16x32_bf16 a[140:143], a[0:3], a[80:83], a[140:143]
s_waitcnt lgkmcnt(4)
ds_read_b64_tr_b16 a[80:81], v9 offset:32768
v_and_b32 v21, 3, v0
v_mfma_f32_16x16x32_bf16 v[184:187], a[88:91], a[32:35], v[184:187]
ds_read_b64_tr_b16 a[82:83], v9 offset:33792
v_lshl_add_u32 v19, v21, 3, v19
v_mfma_f32_16x16x32_bf16 v[184:187], a[92:95], a[36:39], v[184:187]
ds_read_b64_tr_b16 a[84:85], v9 offset:40960
v_add_u32 v19, 114688, v19
v_mfma_f32_16x16x32_bf16 v[192:195], a[92:95], a[44:47], v[192:195]
ds_read_b64_tr_b16 a[86:87], v9 offset:41984
v_xor_b32 v20, 32, v19
v_mfma_f32_16x16x32_bf16 v[192:195], a[88:91], a[40:43], v[192:195]
s_xor_b32 m0, s77, 114688
v_mfma_f32_16x16x32_bf16 v[200:203], a[88:91], a[48:51], v[200:203]
s_xor_b32 s64, s71, 3670016
v_mfma_f32_16x16x32_bf16 v[200:203], a[92:95], a[52:55], v[200:203]
buffer_load_dwordx4 v14, s[40:43], s64 offen lds
v_mfma_f32_16x16x32_bf16 v[208:211], a[92:95], a[60:63], v[208:211]
v_mfma_f32_16x16x32_bf16 v[208:211], a[88:91], a[56:59], v[208:211]
ds_read_b64_tr_b16 a[88:89], v10 offset:32768
v_mfma_f32_16x16x32_bf16 v[212:215], a[96:99], a[56:59], v[212:215]
ds_read_b64_tr_b16 a[90:91], v10 offset:33792
v_mfma_f32_16x16x32_bf16 v[212:215], a[100:103], a[60:63], v[212:215]
ds_read_b64_tr_b16 a[92:93], v10 offset:40960
v_mfma_f32_16x16x32_bf16 v[204:207], a[100:103], a[52:55], v[204:207]
ds_read_b64_tr_b16 a[94:95], v10 offset:41984
v_mfma_f32_16x16x32_bf16 v[204:207], a[96:99], a[48:51], v[204:207]
s_xor_b32 m0, s77, 115712
v_mfma_f32_16x16x32_bf16 v[196:199], a[96:99], a[40:43], v[196:199]
s_xor_b32 s64, s71, 3702784
v_mfma_f32_16x16x32_bf16 v[196:199], a[100:103], a[44:47], v[196:199]
buffer_load_dwordx4 v14, s[40:43], s64 offen lds
v_mfma_f32_16x16x32_bf16 v[188:191], a[100:103], a[36:39], v[188:191]
v_mfma_f32_16x16x32_bf16 v[188:191], a[96:99], a[32:35], v[188:191]
ds_read_b64_tr_b16 a[96:97], v11 offset:32768
v_mfma_f32_16x16x32_bf16 v[216:219], a[104:107], a[32:35], v[216:219]
ds_read_b64_tr_b16 a[98:99], v11 offset:33792
v_mfma_f32_16x16x32_bf16 v[216:219], a[108:111], a[36:39], v[216:219]
ds_read_b64_tr_b16 a[100:101], v11 offset:40960
v_mfma_f32_16x16x32_bf16 v[224:227], a[108:111], a[44:47], v[224:227]
ds_read_b64_tr_b16 a[102:103], v11 offset:41984
v_mfma_f32_16x16x32_bf16 v[224:227], a[104:107], a[40:43], v[224:227]
s_xor_b32 m0, s77, 116736
v_mfma_f32_16x16x32_bf16 v[232:235], a[104:107], a[48:51], v[232:235]
s_xor_b32 s64, s71, 3735552
v_mfma_f32_16x16x32_bf16 v[232:235], a[108:111], a[52:55], v[232:235]
buffer_load_dwordx4 v15, s[40:43], s64 offen lds
v_mfma_f32_16x16x32_bf16 v[240:243], a[108:111], a[60:63], v[240:243]
v_mfma_f32_16x16x32_bf16 v[240:243], a[104:107], a[56:59], v[240:243]
s_add_u32 s81, s81, 1048576
ds_read_b64_tr_b16 a[104:105], v4 offset:49152
v_mfma_f32_16x16x32_bf16 v[244:247], a[112:115], a[56:59], v[244:247]
buffer_load_dword a252, v16, s[56:59], s81 offen
v_mfma_f32_16x16x32_bf16 v[244:247], a[116:119], a[60:63], v[244:247]
ds_read_b64_tr_b16 a[106:107], v4 offset:50176
v_mfma_f32_16x16x32_bf16 v[236:239], a[116:119], a[52:55], v[236:239]
ds_read_b64_tr_b16 a[108:109], v4 offset:57344
v_mfma_f32_16x16x32_bf16 v[236:239], a[112:115], a[48:51], v[236:239]
s_xor_b32 m0, s77, 117760
ds_read_b64_tr_b16 a[110:111], v4 offset:58368
v_mfma_f32_16x16x32_bf16 v[228:231], a[112:115], a[40:43], v[228:231]
s_xor_b32 s64, s71, 3768320
v_mfma_f32_16x16x32_bf16 v[228:231], a[116:119], a[44:47], v[228:231]
buffer_load_dwordx4 v15, s[40:43], s64 offen lds
v_mfma_f32_16x16x32_bf16 v[220:223], a[116:119], a[36:39], v[220:223]
v_mfma_f32_16x16x32_bf16 v[220:223], a[112:115], a[32:35], v[220:223]
s_waitcnt lgkmcnt(4)
ds_read_b64_tr_b16 a[112:113], v5 offset:49152
v_mfma_f32_16x16x32_bf16 v[152:155], a[72:75], a[32:35], v[152:155]
ds_read_b64_tr_b16 a[114:115], v5 offset:50176
v_mfma_f32_16x16x32_bf16 v[152:155], a[76:79], a[36:39], v[152:155]
ds_read_b64_tr_b16 a[116:117], v5 offset:57344
v_mfma_f32_16x16x32_bf16 v[160:163], a[76:79], a[44:47], v[160:163]
ds_read_b64_tr_b16 a[118:119], v5 offset:58368
v_mfma_f32_16x16x32_bf16 v[160:163], a[72:75], a[40:43], v[160:163]
v_mfma_f32_16x16x32_bf16 v[168:171], a[72:75], a[48:51], v[168:171]
v_mfma_f32_16x16x32_bf16 v[168:171], a[76:79], a[52:55], v[168:171]
v_mfma_f32_16x16x32_bf16 v[176:179], a[76:79], a[60:63], v[176:179]
s_xor_b32 m0, s84, 32768
v_mfma_f32_16x16x32_bf16 v[176:179], a[72:75], a[56:59], v[176:179]
s_xor_b32 s64, s70, 896
ds_read_b64_tr_b16 a[72:73], v6 offset:49152
v_mfma_f32_16x16x32_bf16 v[180:183], a[80:83], a[56:59], v[180:183]
buffer_load_dwordx4 v12, s[32:35], s64 offen lds
v_mfma_f32_16x16x32_bf16 v[180:183], a[84:87], a[60:63], v[180:183]
ds_read_b64_tr_b16 a[74:75], v6 offset:50176
v_mfma_f32_16x16x32_bf16 v[172:175], a[84:87], a[52:55], v[172:175]
ds_read_b64_tr_b16 a[76:77], v6 offset:57344
v_mfma_f32_16x16x32_bf16 v[172:175], a[80:83], a[48:51], v[172:175]
ds_read_b64_tr_b16 a[78:79], v6 offset:58368
v_mfma_f32_16x16x32_bf16 v[164:167], a[80:83], a[40:43], v[164:167]
v_mfma_f32_16x16x32_bf16 v[164:167], a[84:87], a[44:47], v[164:167]
s_xor_b32 m0, s84, 33792
v_mfma_f32_16x16x32_bf16 v[156:159], a[84:87], a[36:39], v[156:159]
s_xor_b32 s64, s70, 9088
v_mfma_f32_16x16x32_bf16 v[156:159], a[80:83], a[32:35], v[156:159]
buffer_load_dwordx4 v13, s[32:35], s64 offen lds
v_mfma_f32_16x16x32_bf16 v[24:27], a[88:91], a[32:35], v[24:27]
ds_read_b64_tr_b16 a[80:81], v7 offset:49152
v_mfma_f32_16x16x32_bf16 v[24:27], a[92:95], a[36:39], v[24:27]
ds_read_b64_tr_b16 a[82:83], v7 offset:50176
v_mfma_f32_16x16x32_bf16 v[40:43], a[92:95], a[44:47], v[40:43]
ds_read_b64_tr_b16 a[84:85], v7 offset:57344
v_mfma_f32_16x16x32_bf16 v[40:43], a[88:91], a[40:43], v[40:43]
ds_read_b64_tr_b16 a[86:87], v7 offset:58368
v_mfma_f32_16x16x32_bf16 v[56:59], a[88:91], a[48:51], v[56:59]
s_xor_b32 m0, s84, 34816
v_mfma_f32_16x16x32_bf16 v[56:59], a[92:95], a[52:55], v[56:59]
s_xor_b32 s64, s70, 17280
v_mfma_f32_16x16x32_bf16 v[72:75], a[92:95], a[60:63], v[72:75]
s_waitcnt vmcnt(13)
buffer_load_dwordx4 v12, s[32:35], s64 offen lds
v_mfma_f32_16x16x32_bf16 v[72:75], a[88:91], a[56:59], v[72:75]
s_add_u32 s82, s82, 1048576
ds_read_b64_tr_b16 a[88:89], v8 offset:49152
v_mfma_f32_16x16x32_bf16 v[136:139], a[96:99], a[56:59], v[136:139]
buffer_load_dword a252, v1, s[60:63], s82 offen
v_mfma_f32_16x16x32_bf16 v[136:139], a[100:103], a[60:63], v[136:139]
ds_read_b64_tr_b16 a[90:91], v8 offset:50176
v_subrev_u32 v4, 0x8000, v4
v_mfma_f32_16x16x32_bf16 v[120:123], a[100:103], a[52:55], v[120:123]
ds_read_b64_tr_b16 a[92:93], v8 offset:57344
v_mfma_f32_16x16x32_bf16 v[120:123], a[96:99], a[48:51], v[120:123]
s_xor_b32 m0, s84, 35840
ds_read_b64_tr_b16 a[94:95], v8 offset:58368
v_mfma_f32_16x16x32_bf16 v[104:107], a[96:99], a[40:43], v[104:107]
s_xor_b32 s64, s70, 25472
ds_read_b128 a[0:3], v2 offset:0
v_mfma_f32_16x16x32_bf16 v[104:107], a[100:103], a[44:47], v[104:107]
buffer_load_dwordx4 v13, s[32:35], s64 offen lds
v_mfma_f32_16x16x32_bf16 v[88:91], a[100:103], a[36:39], v[88:91]
ds_read_b128 a[4:7], v3 offset:0
v_mfma_f32_16x16x32_bf16 v[88:91], a[96:99], a[32:35], v[88:91]
s_waitcnt lgkmcnt(6)
ds_read_b128 a[8:11], v2 offset:2048
v_mfma_f32_16x16x32_bf16 v[28:31], a[32:35], a[104:107], v[28:31]
ds_read_b128 a[12:15], v3 offset:2048
v_mfma_f32_16x16x32_bf16 v[28:31], a[36:39], a[108:111], v[28:31]
ds_read_b128 a[16:19], v2 offset:4096
v_subrev_u32 v5, 0x8000, v5
v_mfma_f32_16x16x32_bf16 v[44:47], a[44:47], a[108:111], v[44:47]
s_xor_b32 m0, s84, 36864
ds_read_b128 a[20:23], v3 offset:4096
v_mfma_f32_16x16x32_bf16 v[44:47], a[40:43], a[104:107], v[44:47]
s_xor_b32 s64, s70, 33664
ds_read_b128 a[24:27], v2 offset:6144
v_mfma_f32_16x16x32_bf16 v[60:63], a[48:51], a[104:107], v[60:63]
buffer_load_dwordx4 v12, s[32:35], s64 offen lds
v_mfma_f32_16x16x32_bf16 v[60:63], a[52:55], a[108:111], v[60:63]
ds_read_b128 a[28:31], v3 offset:6144
v_mfma_f32_16x16x32_bf16 v[76:79], a[60:63], a[108:111], v[76:79]
ds_read_b64_tr_b16 a[96:97], v9 offset:49152
v_mfma_f32_16x16x32_bf16 v[76:79], a[56:59], a[104:107], v[76:79]
ds_read_b64_tr_b16 a[98:99], v9 offset:50176
v_mfma_f32_16x16x32_bf16 v[140:143], a[56:59], a[112:115], v[140:143]
ds_read_b64_tr_b16 a[100:101], v9 offset:57344
v_mfma_f32_16x16x32_bf16 v[140:143], a[60:63], a[116:119], v[140:143]
s_xor_b32 m0, s84, 37888
ds_read_b64_tr_b16 a[102:103], v9 offset:58368
v_subrev_u32 v6, 0x8000, v6
v_mfma_f32_16x16x32_bf16 v[124:127], a[52:55], a[116:119], v[124:127]
s_xor_b32 s64, s70, 41856
ds_read_b64_tr_b16 a[104:105], v10 offset:49152
v_mfma_f32_16x16x32_bf16 v[124:127], a[48:51], a[112:115], v[124:127]
buffer_load_dwordx4 v13, s[32:35], s64 offen lds
v_mfma_f32_16x16x32_bf16 v[108:111], a[40:43], a[112:115], v[108:111]
ds_read_b64_tr_b16 a[106:107], v10 offset:50176
v_mfma_f32_16x16x32_bf16 v[108:111], a[44:47], a[116:119], v[108:111]
ds_read_b64_tr_b16 a[108:109], v10 offset:57344
v_mfma_f32_16x16x32_bf16 v[92:95], a[36:39], a[116:119], v[92:95]
ds_read_b64_tr_b16 a[110:111], v10 offset:58368
v_mfma_f32_16x16x32_bf16 v[92:95], a[32:35], a[112:115], v[92:95]
ds_read_b64_tr_b16 a[112:113], v11 offset:49152
v_mfma_f32_16x16x32_bf16 v[32:35], a[32:35], a[72:75], v[32:35]
s_xor_b32 m0, s84, 38912
ds_read_b64_tr_b16 a[114:115], v11 offset:50176
v_mfma_f32_16x16x32_bf16 v[32:35], a[36:39], a[76:79], v[32:35]
s_xor_b32 s64, s70, 50048
ds_read_b64_tr_b16 a[116:117], v11 offset:57344
v_subrev_u32 v7, 0x8000, v7
v_mfma_f32_16x16x32_bf16 v[48:51], a[44:47], a[76:79], v[48:51]
buffer_load_dwordx4 v12, s[32:35], s64 offen lds
v_mfma_f32_16x16x32_bf16 v[48:51], a[40:43], a[72:75], v[48:51]
ds_read_b64_tr_b16 a[118:119], v11 offset:58368
v_mfma_f32_16x16x32_bf16 v[64:67], a[48:51], a[72:75], v[64:67]
v_mfma_f32_16x16x32_bf16 v[64:67], a[52:55], a[76:79], v[64:67]
v_mfma_f32_16x16x32_bf16 v[80:83], a[60:63], a[76:79], v[80:83]
v_mfma_f32_16x16x32_bf16 v[80:83], a[56:59], a[72:75], v[80:83]
s_xor_b32 m0, s84, 39936
v_mfma_f32_16x16x32_bf16 v[144:147], a[56:59], a[80:83], v[144:147]
s_xor_b32 s64, s70, 58240
v_mfma_f32_16x16x32_bf16 v[144:147], a[60:63], a[84:87], v[144:147]
buffer_load_dwordx4 v13, s[32:35], s64 offen lds
v_mfma_f32_16x16x32_bf16 v[128:131], a[52:55], a[84:87], v[128:131]
v_subrev_u32 v8, 0x8000, v8
v_mfma_f32_16x16x32_bf16 v[128:131], a[48:51], a[80:83], v[128:131]
v_mfma_f32_16x16x32_bf16 v[112:115], a[40:43], a[80:83], v[112:115]
v_mfma_f32_16x16x32_bf16 v[112:115], a[44:47], a[84:87], v[112:115]
v_mfma_f32_16x16x32_bf16 v[96:99], a[36:39], a[84:87], v[96:99]
s_and_b32 s77, s77, 0x3fff
v_subrev_u32 v9, 0x8000, v9
v_subrev_u32 v10, 0x8000, v10
v_mfma_f32_16x16x32_bf16 v[96:99], a[32:35], a[80:83], v[96:99]
s_waitcnt lgkmcnt(0)
v_subrev_u32 v11, 0x8000, v11
v_mfma_f32_16x16x32_bf16 v[36:39], a[32:35], a[88:91], v[36:39]
v_mfma_f32_16x16x32_bf16 v[36:39], a[36:39], a[92:95], v[36:39]
v_mfma_f32_16x16x32_bf16 v[52:55], a[44:47], a[92:95], v[52:55]
s_waitcnt lgkmcnt(0)
s_barrier
v_mfma_f32_16x16x32_bf16 v[52:55], a[40:43], a[88:91], v[52:55]
s_xor_b32 m0, s77, 131072
ds_read_b64_tr_b16 a[72:73], v4 offset:0
v_mfma_f32_16x16x32_bf16 v[68:71], a[48:51], a[88:91], v[68:71]
s_xor_b32 s64, s71, 0
ds_read_b64_tr_b16 a[74:75], v4 offset:1024
v_mfma_f32_16x16x32_bf16 v[68:71], a[52:55], a[92:95], v[68:71]
buffer_load_dwordx4 v14, s[56:59], s64 offen lds
v_mfma_f32_16x16x32_bf16 v[84:87], a[60:63], a[92:95], v[84:87]
ds_read_b64_tr_b16 a[76:77], v4 offset:8192
v_mfma_f32_16x16x32_bf16 v[84:87], a[56:59], a[88:91], v[84:87]
ds_read_b64_tr_b16 a[78:79], v4 offset:9216
v_mfma_f32_16x16x32_bf16 v[148:151], a[56:59], a[96:99], v[148:151]
ds_read_b64_tr_b16 a[80:81], v5 offset:0
v_lshrrev_b32 v13, 3, v0
v_mfma_f32_16x16x32_bf16 v[148:151], a[60:63], a[100:103], v[148:151]
ds_read_b64_tr_b16 a[82:83], v5 offset:1024
v_lshl_add_u32 v12, v13, 10, v12
v_mfma_f32_16x16x32_bf16 v[132:135], a[52:55], a[100:103], v[132:135]
ds_read_b64_tr_b16 a[84:85], v5 offset:8192
v_xor_b32 v13, 64, v12
v_mfma_f32_16x16x32_bf16 v[132:135], a[48:51], a[96:99], v[132:135]
ds_read_b64_tr_b16 a[86:87], v5 offset:9216
v_mfma_f32_16x16x32_bf16 v[116:119], a[40:43], a[96:99], v[116:119]
s_add_u32 m0, s78, 147456
ds_read_b64_tr_b16 a[88:89], v6 offset:0
v_mfma_f32_16x16x32_bf16 v[116:119], a[44:47], a[100:103], v[116:119]
s_add_u32 s64, s75, 0
ds_read_b64_tr_b16 a[90:91], v6 offset:1024
v_mfma_f32_16x16x32_bf16 v[100:103], a[36:39], a[100:103], v[100:103]
buffer_load_dwordx4 v23, s[60:63], s64 offen lds
v_mfma_f32_16x16x32_bf16 v[100:103], a[32:35], a[96:99], v[100:103]
ds_read_b64_tr_b16 a[92:93], v6 offset:8192
v_mfma_f32_16x16x32_bf16 v[248:251], a[32:35], a[104:107], v[248:251]
ds_read_b64_tr_b16 a[94:95], v6 offset:9216
v_mfma_f32_16x16x32_bf16 v[248:251], a[36:39], a[108:111], v[248:251]
ds_read_b64_tr_b16 a[96:97], v7 offset:0
v_mfma_f32_16x16x32_bf16 v[252:255], a[44:47], a[108:111], v[252:255]
ds_read_b64_tr_b16 a[98:99], v7 offset:1024
v_mfma_f32_16x16x32_bf16 v[252:255], a[40:43], a[104:107], v[252:255]
ds_read_b64_tr_b16 a[100:101], v7 offset:8192
v_mfma_f32_16x16x32_bf16 a[120:123], a[48:51], a[104:107], a[120:123]
ds_read_b64_tr_b16 a[102:103], v7 offset:9216
v_mfma_f32_16x16x32_bf16 a[120:123], a[52:55], a[108:111], a[120:123]
s_xor_b32 m0, s77, 132096
v_mfma_f32_16x16x32_bf16 a[124:127], a[60:63], a[108:111], a[124:127]
s_xor_b32 s64, s71, 32768
v_mfma_f32_16x16x32_bf16 a[124:127], a[56:59], a[104:107], a[124:127]
buffer_load_dwordx4 v14, s[56:59], s64 offen lds
v_mfma_f32_16x16x32_bf16 a[128:131], a[56:59], a[112:115], a[128:131]
ds_read_b64_tr_b16 a[104:105], v8 offset:0
v_mfma_f32_16x16x32_bf16 a[128:131], a[60:63], a[116:119], a[128:131]
ds_read_b64_tr_b16 a[106:107], v8 offset:1024
v_mfma_f32_16x16x32_bf16 a[132:135], a[52:55], a[116:119], a[132:135]
ds_read_b64_tr_b16 a[108:109], v8 offset:8192
v_mfma_f32_16x16x32_bf16 a[132:135], a[48:51], a[112:115], a[132:135]
ds_read_b64_tr_b16 a[110:111], v8 offset:9216
v_mfma_f32_16x16x32_bf16 a[136:139], a[40:43], a[112:115], a[136:139]
v_mfma_f32_16x16x32_bf16 a[136:139], a[44:47], a[116:119], a[136:139]
v_mfma_f32_16x16x32_bf16 a[140:143], a[36:39], a[116:119], a[140:143]
s_add_u32 m0, s78, 151552
v_mfma_f32_16x16x32_bf16 a[140:143], a[32:35], a[112:115], a[140:143]
s_waitcnt lgkmcnt(4)
s_add_u32 s64, s75, 2048
ds_read_b64_tr_b16 a[112:113], v9 offset:0
v_mfma_f32_16x16x32_bf16 v[184:187], a[72:75], a[0:3], v[184:187]
buffer_load_dwordx4 v23, s[60:63], s64 offen lds
v_mfma_f32_16x16x32_bf16 v[184:187], a[76:79], a[4:7], v[184:187]
ds_read_b64_tr_b16 a[114:115], v9 offset:1024
v_mfma_f32_16x16x32_bf16 v[192:195], a[76:79], a[12:15], v[192:195]
ds_read_b64_tr_b16 a[116:117], v9 offset:8192
v_mfma_f32_16x16x32_bf16 v[192:195], a[72:75], a[8:11], v[192:195]
ds_read_b64_tr_b16 a[118:119], v9 offset:9216
v_mfma_f32_16x16x32_bf16 v[200:203], a[72:75], a[16:19], v[200:203]
v_mfma_f32_16x16x32_bf16 v[200:203], a[76:79], a[20:23], v[200:203]
v_mfma_f32_16x16x32_bf16 v[208:211], a[76:79], a[28:31], v[208:211]
v_mfma_f32_16x16x32_bf16 v[208:211], a[72:75], a[24:27], v[208:211]
ds_read_b64_tr_b16 a[72:73], v10 offset:0
v_mfma_f32_16x16x32_bf16 v[212:215], a[80:83], a[24:27], v[212:215]
s_xor_b32 m0, s77, 133120
ds_read_b64_tr_b16 a[74:75], v10 offset:1024
v_mfma_f32_16x16x32_bf16 v[212:215], a[84:87], a[28:31], v[212:215]
s_xor_b32 s64, s71, 65536
ds_read_b64_tr_b16 a[76:77], v10 offset:8192
v_mfma_f32_16x16x32_bf16 v[204:207], a[84:87], a[20:23], v[204:207]
buffer_load_dwordx4 v15, s[56:59], s64 offen lds
v_mfma_f32_16x16x32_bf16 v[204:207], a[80:83], a[16:19], v[204:207]
ds_read_b64_tr_b16 a[78:79], v10 offset:9216
v_mfma_f32_16x16x32_bf16 v[196:199], a[80:83], a[8:11], v[196:199]
v_mfma_f32_16x16x32_bf16 v[196:199], a[84:87], a[12:15], v[196:199]
v_mfma_f32_16x16x32_bf16 v[188:191], a[84:87], a[4:7], v[188:191]
v_mfma_f32_16x16x32_bf16 v[188:191], a[80:83], a[0:3], v[188:191]
ds_read_b64_tr_b16 a[80:81], v11 offset:0
v_mfma_f32_16x16x32_bf16 v[216:219], a[88:91], a[0:3], v[216:219]
ds_read_b64_tr_b16 a[82:83], v11 offset:1024
v_mfma_f32_16x16x32_bf16 v[216:219], a[92:95], a[4:7], v[216:219]
s_add_u32 m0, s78, 155648
ds_read_b64_tr_b16 a[84:85], v11 offset:8192
v_mfma_f32_16x16x32_bf16 v[224:227], a[92:95], a[12:15], v[224:227]
s_add_u32 s64, s75, 4096
ds_read_b64_tr_b16 a[86:87], v11 offset:9216
v_mfma_f32_16x16x32_bf16 v[224:227], a[88:91], a[8:11], v[224:227]
buffer_load_dwordx4 v23, s[60:63], s64 offen lds
v_mfma_f32_16x16x32_bf16 v[232:235], a[88:91], a[16:19], v[232:235]
v_mfma_f32_16x16x32_bf16 v[232:235], a[92:95], a[20:23], v[232:235]
v_mfma_f32_16x16x32_bf16 v[240:243], a[92:95], a[28:31], v[240:243]
v_mfma_f32_16x16x32_bf16 v[240:243], a[88:91], a[24:27], v[240:243]
ds_read_b64_tr_b16 a[88:89], v4 offset:16384
v_mfma_f32_16x16x32_bf16 v[244:247], a[96:99], a[24:27], v[244:247]
ds_read_b64_tr_b16 a[90:91], v4 offset:17408
v_mfma_f32_16x16x32_bf16 v[244:247], a[100:103], a[28:31], v[244:247]
ds_read_b64_tr_b16 a[92:93], v4 offset:24576
v_mfma_f32_16x16x32_bf16 v[236:239], a[100:103], a[20:23], v[236:239]
s_xor_b32 m0, s77, 134144
ds_read_b64_tr_b16 a[94:95], v4 offset:25600
v_mfma_f32_16x16x32_bf16 v[236:239], a[96:99], a[16:19], v[236:239]
s_xor_b32 s64, s71, 98304
v_mfma_f32_16x16x32_bf16 v[228:231], a[96:99], a[8:11], v[228:231]
buffer_load_dwordx4 v15, s[56:59], s64 offen lds
v_mfma_f32_16x16x32_bf16 v[228:231], a[100:103], a[12:15], v[228:231]
v_mfma_f32_16x16x32_bf16 v[220:223], a[100:103], a[4:7], v[220:223]
v_mfma_f32_16x16x32_bf16 v[220:223], a[96:99], a[0:3], v[220:223]
s_waitcnt lgkmcnt(4)
ds_read_b64_tr_b16 a[96:97], v5 offset:16384
v_mfma_f32_16x16x32_bf16 v[152:155], a[104:107], a[0:3], v[152:155]
ds_read_b64_tr_b16 a[98:99], v5 offset:17408
v_mfma_f32_16x16x32_bf16 v[152:155], a[108:111], a[4:7], v[152:155]
ds_read_b64_tr_b16 a[100:101], v5 offset:24576
v_mfma_f32_16x16x32_bf16 v[160:163], a[108:111], a[12:15], v[160:163]
ds_read_b64_tr_b16 a[102:103], v5 offset:25600
v_mfma_f32_16x16x32_bf16 v[160:163], a[104:107], a[8:11], v[160:163]
v_mfma_f32_16x16x32_bf16 v[168:171], a[104:107], a[16:19], v[168:171]
v_mfma_f32_16x16x32_bf16 v[168:171], a[108:111], a[20:23], v[168:171]
v_mfma_f32_16x16x32_bf16 v[176:179], a[108:111], a[28:31], v[176:179]
s_xor_b32 m0, s84, 0
v_mfma_f32_16x16x32_bf16 v[176:179], a[104:107], a[24:27], v[176:179]
s_xor_b32 s64, s72, 0
ds_read_b64_tr_b16 a[104:105], v6 offset:16384
v_mfma_f32_16x16x32_bf16 v[180:183], a[112:115], a[24:27], v[180:183]
buffer_load_dwordx4 v12, s[48:51], s64 offen lds
v_mfma_f32_16x16x32_bf16 v[180:183], a[116:119], a[28:31], v[180:183]
ds_read_b64_tr_b16 a[106:107], v6 offset:17408
v_mfma_f32_16x16x32_bf16 v[172:175], a[116:119], a[20:23], v[172:175]
ds_read_b64_tr_b16 a[108:109], v6 offset:24576
v_mfma_f32_16x16x32_bf16 v[172:175], a[112:115], a[16:19], v[172:175]
ds_read_b64_tr_b16 a[110:111], v6 offset:25600
v_mfma_f32_16x16x32_bf16 v[164:167], a[112:115], a[8:11], v[164:167]
v_mfma_f32_16x16x32_bf16 v[164:167], a[116:119], a[12:15], v[164:167]
s_xor_b32 m0, s84, 1024
v_mfma_f32_16x16x32_bf16 v[156:159], a[116:119], a[4:7], v[156:159]
s_xor_b32 s64, s72, 16384
v_mfma_f32_16x16x32_bf16 v[156:159], a[112:115], a[0:3], v[156:159]
buffer_load_dwordx4 v13, s[48:51], s64 offen lds
v_mfma_f32_16x16x32_bf16 v[24:27], a[72:75], a[0:3], v[24:27]
ds_read_b64_tr_b16 a[112:113], v7 offset:16384
v_mfma_f32_16x16x32_bf16 v[24:27], a[76:79], a[4:7], v[24:27]
ds_read_b64_tr_b16 a[114:115], v7 offset:17408
v_mfma_f32_16x16x32_bf16 v[40:43], a[76:79], a[12:15], v[40:43]
ds_read_b64_tr_b16 a[116:117], v7 offset:24576
v_mfma_f32_16x16x32_bf16 v[40:43], a[72:75], a[8:11], v[40:43]
ds_read_b64_tr_b16 a[118:119], v7 offset:25600
v_mfma_f32_16x16x32_bf16 v[56:59], a[72:75], a[16:19], v[56:59]
s_xor_b32 m0, s84, 2048
v_mfma_f32_16x16x32_bf16 v[56:59], a[76:79], a[20:23], v[56:59]
s_xor_b32 s64, s72, 131072
v_mfma_f32_16x16x32_bf16 v[72:75], a[76:79], a[28:31], v[72:75]
s_waitcnt vmcnt(9)
buffer_load_dwordx4 v12, s[48:51], s64 offen lds
v_mfma_f32_16x16x32_bf16 v[72:75], a[72:75], a[24:27], v[72:75]
ds_read_b64_tr_b16 a[72:73], v8 offset:16384
v_mfma_f32_16x16x32_bf16 v[136:139], a[80:83], a[24:27], v[136:139]
ds_read_b64_tr_b16 a[74:75], v8 offset:17408
v_mfma_f32_16x16x32_bf16 v[136:139], a[84:87], a[28:31], v[136:139]
ds_read_b64_tr_b16 a[76:77], v8 offset:24576
v_mfma_f32_16x16x32_bf16 v[120:123], a[84:87], a[20:23], v[120:123]
ds_read_b64_tr_b16 a[78:79], v8 offset:25600
v_mfma_f32_16x16x32_bf16 v[120:123], a[80:83], a[16:19], v[120:123]
s_xor_b32 m0, s84, 3072
ds_read_b128 a[32:35], v2 offset:32768
v_mfma_f32_16x16x32_bf16 v[104:107], a[80:83], a[8:11], v[104:107]
s_xor_b32 s64, s72, 147456
ds_read_b128 a[36:39], v3 offset:32768
v_mfma_f32_16x16x32_bf16 v[104:107], a[84:87], a[12:15], v[104:107]
buffer_load_dwordx4 v13, s[48:51], s64 offen lds
v_mfma_f32_16x16x32_bf16 v[88:91], a[84:87], a[4:7], v[88:91]
ds_read_b128 a[40:43], v2 offset:34816
v_mfma_f32_16x16x32_bf16 v[88:91], a[80:83], a[0:3], v[88:91]
s_waitcnt lgkmcnt(7)
ds_read_b128 a[44:47], v3 offset:34816
v_mfma_f32_16x16x32_bf16 v[28:31], a[0:3], a[88:91], v[28:31]
ds_read_b128 a[48:51], v2 offset:36864
v_mfma_f32_16x16x32_bf16 v[28:31], a[4:7], a[92:95], v[28:31]
ds_read_b128 a[52:55], v3 offset:36864
v_mfma_f32_16x16x32_bf16 v[44:47], a[12:15], a[92:95], v[44:47]
s_xor_b32 m0, s84, 4096
ds_read_b128 a[56:59], v2 offset:38912
v_mfma_f32_16x16x32_bf16 v[44:47], a[8:11], a[88:91], v[44:47]
s_xor_b32 s64, s73, 0
ds_read_b128 a[60:63], v3 offset:38912
v_mfma_f32_16x16x32_bf16 v[60:63], a[16:19], a[88:91], v[60:63]
buffer_load_dwordx4 v12, s[48:51], s64 offen lds
v_mfma_f32_16x16x32_bf16 v[60:63], a[20:23], a[92:95], v[60:63]
ds_read_b64_tr_b16 a[80:81], v9 offset:16384
v_mfma_f32_16x16x32_bf16 v[76:79], a[28:31], a[92:95], v[76:79]
ds_read_b64_tr_b16 a[82:83], v9 offset:17408
v_mfma_f32_16x16x32_bf16 v[76:79], a[24:27], a[88:91], v[76:79]
ds_read_b64_tr_b16 a[84:85], v9 offset:24576
v_mfma_f32_16x16x32_bf16 v[140:143], a[24:27], a[96:99], v[140:143]
ds_read_b64_tr_b16 a[86:87], v9 offset:25600
v_mfma_f32_16x16x32_bf16 v[140:143], a[28:31], a[100:103], v[140:143]
s_xor_b32 m0, s84, 5120
ds_read_b64_tr_b16 a[88:89], v10 offset:16384
v_mfma_f32_16x16x32_bf16 v[124:127], a[20:23], a[100:103], v[124:127]
s_xor_b32 s64, s73, 16384
ds_read_b64_tr_b16 a[90:91], v10 offset:17408
v_mfma_f32_16x16x32_bf16 v[124:127], a[16:19], a[96:99], v[124:127]
buffer_load_dwordx4 v13, s[48:51], s64 offen lds
v_mfma_f32_16x16x32_bf16 v[108:111], a[8:11], a[96:99], v[108:111]
s_branch L_po5
L_pg5:
s_branch L_tr0
L_po5:
ds_read_b64_tr_b16 a[92:93], v10 offset:24576
v_mfma_f32_16x16x32_bf16 v[108:111], a[12:15], a[100:103], v[108:111]
ds_read_b64_tr_b16 a[94:95], v10 offset:25600
v_mfma_f32_16x16x32_bf16 v[92:95], a[4:7], a[100:103], v[92:95]
v_mfma_f32_16x16x32_bf16 v[92:95], a[0:3], a[96:99], v[92:95]
ds_read_b64_tr_b16 a[96:97], v11 offset:16384
v_mfma_f32_16x16x32_bf16 v[32:35], a[0:3], a[104:107], v[32:35]
s_xor_b32 m0, s84, 6144
ds_read_b64_tr_b16 a[98:99], v11 offset:17408
v_mfma_f32_16x16x32_bf16 v[32:35], a[4:7], a[108:111], v[32:35]
s_xor_b32 s64, s73, 131072
ds_read_b64_tr_b16 a[100:101], v11 offset:24576
v_mfma_f32_16x16x32_bf16 v[48:51], a[12:15], a[108:111], v[48:51]
buffer_load_dwordx4 v12, s[48:51], s64 offen lds
v_mfma_f32_16x16x32_bf16 v[48:51], a[8:11], a[104:107], v[48:51]
ds_read_b64_tr_b16 a[102:103], v11 offset:25600
v_mfma_f32_16x16x32_bf16 v[64:67], a[16:19], a[104:107], v[64:67]
v_mfma_f32_16x16x32_bf16 v[64:67], a[20:23], a[108:111], v[64:67]
v_mfma_f32_16x16x32_bf16 v[80:83], a[28:31], a[108:111], v[80:83]
v_mfma_f32_16x16x32_bf16 v[80:83], a[24:27], a[104:107], v[80:83]
s_xor_b32 m0, s84, 7168
v_mfma_f32_16x16x32_bf16 v[144:147], a[24:27], a[112:115], v[144:147]
s_xor_b32 s64, s73, 147456
v_mfma_f32_16x16x32_bf16 v[144:147], a[28:31], a[116:119], v[144:147]
buffer_load_dwordx4 v13, s[48:51], s64 offen lds
v_mfma_f32_16x16x32_bf16 v[128:131], a[20:23], a[116:119], v[128:131]
v_mfma_f32_16x16x32_bf16 v[128:131], a[16:19], a[112:115], v[128:131]
v_mfma_f32_16x16x32_bf16 v[112:115], a[8:11], a[112:115], v[112:115]
v_mfma_f32_16x16x32_bf16 v[112:115], a[12:15], a[116:119], v[112:115]
v_mfma_f32_16x16x32_bf16 v[96:99], a[4:7], a[116:119], v[96:99]
v_mfma_f32_16x16x32_bf16 v[96:99], a[0:3], a[112:115], v[96:99]
s_waitcnt lgkmcnt(0)
v_mfma_f32_16x16x32_bf16 v[36:39], a[0:3], a[72:75], v[36:39]
v_mfma_f32_16x16x32_bf16 v[36:39], a[4:7], a[76:79], v[36:39]
v_mfma_f32_16x16x32_bf16 v[52:55], a[12:15], a[76:79], v[52:55]
s_waitcnt lgkmcnt(0)
s_barrier
v_mfma_f32_16x16x32_bf16 v[52:55], a[8:11], a[72:75], v[52:55]
s_xor_b32 m0, s77, 65536
ds_read_b64_tr_b16 a[104:105], v4 offset:32768
v_mfma_f32_16x16x32_bf16 v[68:71], a[16:19], a[72:75], v[68:71]
s_xor_b32 s64, s71, 524288
ds_read_b64_tr_b16 a[106:107], v4 offset:33792
v_mfma_f32_16x16x32_bf16 v[68:71], a[20:23], a[76:79], v[68:71]
buffer_load_dwordx4 v14, s[56:59], s64 offen lds
v_mfma_f32_16x16x32_bf16 v[84:87], a[28:31], a[76:79], v[84:87]
ds_read_b64_tr_b16 a[108:109], v4 offset:40960
v_mfma_f32_16x16x32_bf16 v[84:87], a[24:27], a[72:75], v[84:87]
ds_read_b64_tr_b16 a[110:111], v4 offset:41984
v_mfma_f32_16x16x32_bf16 v[148:151], a[24:27], a[80:83], v[148:151]
ds_read_b64_tr_b16 a[112:113], v5 offset:32768
v_mfma_f32_16x16x32_bf16 v[148:151], a[28:31], a[84:87], v[148:151]
ds_read_b64_tr_b16 a[114:115], v5 offset:33792
v_mfma_f32_16x16x32_bf16 v[132:135], a[20:23], a[84:87], v[132:135]
ds_read_b64_tr_b16 a[116:117], v5 offset:40960
v_mfma_f32_16x16x32_bf16 v[132:135], a[16:19], a[80:83], v[132:135]
ds_read_b64_tr_b16 a[118:119], v5 offset:41984
v_mfma_f32_16x16x32_bf16 v[116:119], a[8:11], a[80:83], v[116:119]
s_add_u32 m0, s78, 81920
ds_read_b64_tr_b16 a[72:73], v6 offset:32768
v_mfma_f32_16x16x32_bf16 v[116:119], a[12:15], a[84:87], v[116:119]
s_add_u32 s64, s75, 393216
ds_read_b64_tr_b16 a[74:75], v6 offset:33792
v_mfma_f32_16x16x32_bf16 v[100:103], a[4:7], a[84:87], v[100:103]
buffer_load_dwordx4 v23, s[60:63], s64 offen lds
v_mfma_f32_16x16x32_bf16 v[100:103], a[0:3], a[80:83], v[100:103]
ds_read_b64_tr_b16 a[76:77], v6 offset:40960
v_mfma_f32_16x16x32_bf16 v[248:251], a[0:3], a[88:91], v[248:251]
ds_read_b64_tr_b16 a[78:79], v6 offset:41984
v_mfma_f32_16x16x32_bf16 v[248:251], a[4:7], a[92:95], v[248:251]
ds_read_b64_tr_b16 a[80:81], v7 offset:32768
v_mfma_f32_16x16x32_bf16 v[252:255], a[12:15], a[92:95], v[252:255]
ds_read_b64_tr_b16 a[82:83], v7 offset:33792
v_mfma_f32_16x16x32_bf16 v[252:255], a[8:11], a[88:91], v[252:255]
ds_read_b64_tr_b16 a[84:85], v7 offset:40960
v_mfma_f32_16x16x32_bf16 a[120:123], a[16:19], a[88:91], a[120:123]
ds_read_b64_tr_b16 a[86:87], v7 offset:41984
v_mfma_f32_16x16x32_bf16 a[120:123], a[20:23], a[92:95], a[120:123]
s_xor_b32 m0, s77, 66560
v_mfma_f32_16x16x32_bf16 a[124:127], a[28:31], a[92:95], a[124:127]
s_xor_b32 s64, s71, 557056
v_mfma_f32_16x16x32_bf16 a[124:127], a[24:27], a[88:91], a[124:127]
buffer_load_dwordx4 v14, s[56:59], s64 offen lds
v_mfma_f32_16x16x32_bf16 a[128:131], a[24:27], a[96:99], a[128:131]
ds_read_b64_tr_b16 a[88:89], v8 offset:32768
v_mfma_f32_16x16x32_bf16 a[128:131], a[28:31], a[100:103], a[128:131]
ds_read_b64_tr_b16 a[90:91], v8 offset:33792
v_mfma_f32_16x16x32_bf16 a[132:135], a[20:23], a[100:103], a[132:135]
ds_read_b64_tr_b16 a[92:93], v8 offset:40960
v_mfma_f32_16x16x32_bf16 a[132:135], a[16:19], a[96:99], a[132:135]
ds_read_b64_tr_b16 a[94:95], v8 offset:41984
v_mfma_f32_16x16x32_bf16 a[136:139], a[8:11], a[96:99], a[136:139]
v_mfma_f32_16x16x32_bf16 a[136:139], a[12:15], a[100:103], a[136:139]
v_mfma_f32_16x16x32_bf16 a[140:143], a[4:7], a[100:103], a[140:143]
s_add_u32 m0, s78, 86016
v_mfma_f32_16x16x32_bf16 a[140:143], a[0:3], a[96:99], a[140:143]
s_waitcnt lgkmcnt(4)
s_add_u32 s64, s75, 395264
ds_read_b64_tr_b16 a[96:97], v9 offset:32768
v_mfma_f32_16x16x32_bf16 v[184:187], a[104:107], a[32:35], v[184:187]
s_lshl_b32 s66, s30, 30
buffer_load_dwordx4 v23, s[60:63], s64 offen lds
v_mfma_f32_16x16x32_bf16 v[184:187], a[108:111], a[36:39], v[184:187]
ds_read_b64_tr_b16 a[98:99], v9 offset:33792
v_lshl_add_u32 v1, v0, 24, s66
v_mfma_f32_16x16x32_bf16 v[192:195], a[108:111], a[44:47], v[192:195]
s_lshr_b32 s66, s3, 1
ds_read_b64_tr_b16 a[100:101], v9 offset:40960
v_mfma_f32_16x16x32_bf16 v[192:195], a[104:107], a[40:43], v[192:195]
s_lshl_b32 s66, s66, 12
ds_read_b64_tr_b16 a[102:103], v9 offset:41984
v_mfma_f32_16x16x32_bf16 v[200:203], a[104:107], a[48:51], v[200:203]
v_mfma_f32_16x16x32_bf16 v[200:203], a[108:111], a[52:55], v[200:203]
v_mfma_f32_16x16x32_bf16 v[208:211], a[108:111], a[60:63], v[208:211]
v_mfma_f32_16x16x32_bf16 v[208:211], a[104:107], a[56:59], v[208:211]
ds_read_b64_tr_b16 a[104:105], v10 offset:32768
v_mfma_f32_16x16x32_bf16 v[212:215], a[112:115], a[56:59], v[212:215]
s_xor_b32 m0, s77, 67584
ds_read_b64_tr_b16 a[106:107], v10 offset:33792
v_mfma_f32_16x16x32_bf16 v[212:215], a[116:119], a[60:63], v[212:215]
s_xor_b32 s64, s71, 589824
ds_read_b64_tr_b16 a[108:109], v10 offset:40960
v_mfma_f32_16x16x32_bf16 v[204:207], a[116:119], a[52:55], v[204:207]
buffer_load_dwordx4 v15, s[56:59], s64 offen lds
v_mfma_f32_16x16x32_bf16 v[204:207], a[112:115], a[48:51], v[204:207]
ds_read_b64_tr_b16 a[110:111], v10 offset:41984
v_mfma_f32_16x16x32_bf16 v[196:199], a[112:115], a[40:43], v[196:199]
v_mfma_f32_16x16x32_bf16 v[196:199], a[116:119], a[44:47], v[196:199]
v_mfma_f32_16x16x32_bf16 v[188:191], a[116:119], a[36:39], v[188:191]
v_mfma_f32_16x16x32_bf16 v[188:191], a[112:115], a[32:35], v[188:191]
s_add_u32 s67, s79, 20480
ds_read_b64_tr_b16 a[112:113], v11 offset:32768
v_mfma_f32_16x16x32_bf16 v[216:219], a[72:75], a[32:35], v[216:219]
ds_read_b64_tr_b16 a[114:115], v11 offset:33792
v_mfma_f32_16x16x32_bf16 v[216:219], a[76:79], a[36:39], v[216:219]
s_add_u32 m0, s78, 90112
ds_read_b64_tr_b16 a[116:117], v11 offset:40960
v_cvt_pk_bf16_f32 v215, v214, v215
v_mfma_f32_16x16x32_bf16 v[224:227], a[76:79], a[44:47], v[224:227]
s_add_u32 s64, s75, 397312
ds_read_b64_tr_b16 a[118:119], v11 offset:41984
v_cvt_pk_bf16_f32 v214, v212, v213
v_mfma_f32_16x16x32_bf16 v[224:227], a[72:75], a[40:43], v[224:227]
buffer_load_dwordx4 v23, s[60:63], s64 offen lds
v_mfma_f32_16x16x32_bf16 v[232:235], a[72:75], a[48:51], v[232:235]
v_cvt_pk_bf16_f32 v212, v208, v209
v_cvt_pk_bf16_f32 v213, v210, v211
v_mfma_f32_16x16x32_bf16 v[232:235], a[76:79], a[52:55], v[232:235]
buffer_store_dwordx4 v[212:215], v16, s[44:47], s67 offen sc1
v_mfma_f32_16x16x32_bf16 v[240:243], a[76:79], a[60:63], v[240:243]
v_cvt_pk_bf16_f32 v207, v206, v207
v_cvt_pk_bf16_f32 v206, v204, v205
v_mfma_f32_16x16x32_bf16 v[240:243], a[72:75], a[56:59], v[240:243]
ds_read_b64_tr_b16 a[72:73], v4 offset:49152
v_cvt_pk_bf16_f32 v204, v200, v201
v_mfma_f32_16x16x32_bf16 v[244:247], a[80:83], a[56:59], v[244:247]
ds_read_b64_tr_b16 a[74:75], v4 offset:50176
v_cvt_pk_bf16_f32 v205, v202, v203
v_mfma_f32_16x16x32_bf16 v[244:247], a[84:87], a[60:63], v[244:247]
ds_read_b64_tr_b16 a[76:77], v4 offset:57344
v_accvgpr_write_b32 a144, v204
v_mfma_f32_16x16x32_bf16 v[236:239], a[84:87], a[52:55], v[236:239]
s_xor_b32 m0, s77, 68608
ds_read_b64_tr_b16 a[78:79], v4 offset:58368
v_accvgpr_write_b32 a145, v205
v_mfma_f32_16x16x32_bf16 v[236:239], a[80:83], a[48:51], v[236:239]
s_xor_b32 s64, s71, 622592
v_accvgpr_write_b32 a146, v206
v_accvgpr_write_b32 a147, v207
v_mfma_f32_16x16x32_bf16 v[228:231], a[80:83], a[40:43], v[228:231]
buffer_load_dwordx4 v15, s[56:59], s64 offen lds
v_mfma_f32_16x16x32_bf16 v[228:231], a[84:87], a[44:47], v[228:231]
v_cvt_pk_bf16_f32 v199, v198, v199
v_cvt_pk_bf16_f32 v198, v196, v197
v_mfma_f32_16x16x32_bf16 v[220:223], a[84:87], a[36:39], v[220:223]
v_cvt_pk_bf16_f32 v196, v192, v193
v_cvt_pk_bf16_f32 v197, v194, v195
v_mfma_f32_16x16x32_bf16 v[220:223], a[80:83], a[32:35], v[220:223]
s_waitcnt lgkmcnt(4)
ds_read_b64_tr_b16 a[80:81], v5 offset:49152
v_accvgpr_write_b32 a148, v196
v_mfma_f32_16x16x32_bf16 v[152:155], a[88:91], a[32:35], v[152:155]
ds_read_b64_tr_b16 a[82:83], v5 offset:50176
v_accvgpr_write_b32 a149, v197
v_mfma_f32_16x16x32_bf16 v[152:155], a[92:95], a[36:39], v[152:155]
ds_read_b64_tr_b16 a[84:85], v5 offset:57344
v_accvgpr_write_b32 a150, v198
v_mfma_f32_16x16x32_bf16 v[160:163], a[92:95], a[44:47], v[160:163]
ds_read_b64_tr_b16 a[86:87], v5 offset:58368
v_accvgpr_write_b32 a151, v199
v_mfma_f32_16x16x32_bf16 v[160:163], a[88:91], a[40:43], v[160:163]
v_cvt_pk_bf16_f32 v191, v190, v191
v_cvt_pk_bf16_f32 v190, v188, v189
v_mfma_f32_16x16x32_bf16 v[168:171], a[88:91], a[48:51], v[168:171]
v_cvt_pk_bf16_f32 v188, v184, v185
v_cvt_pk_bf16_f32 v189, v186, v187
v_mfma_f32_16x16x32_bf16 v[168:171], a[92:95], a[52:55], v[168:171]
v_accvgpr_write_b32 a152, v188
v_accvgpr_write_b32 a153, v189
v_mfma_f32_16x16x32_bf16 v[176:179], a[92:95], a[60:63], v[176:179]
s_xor_b32 m0, s84, 32768
v_accvgpr_write_b32 a154, v190
v_accvgpr_write_b32 a155, v191
v_mfma_f32_16x16x32_bf16 v[176:179], a[88:91], a[56:59], v[176:179]
s_add_u32 s67, s79, 21504
s_xor_b32 s64, s72, 128
ds_read_b64_tr_b16 a[88:89], v6 offset:49152
v_cvt_pk_bf16_f32 v247, v246, v247
v_mfma_f32_16x16x32_bf16 v[180:183], a[96:99], a[56:59], v[180:183]
buffer_load_dwordx4 v12, s[48:51], s64 offen lds
v_mfma_f32_16x16x32_bf16 v[180:183], a[100:103], a[60:63], v[180:183]
ds_read_b64_tr_b16 a[90:91], v6 offset:50176
v_cvt_pk_bf16_f32 v246, v244, v245
v_mfma_f32_16x16x32_bf16 v[172:175], a[100:103], a[52:55], v[172:175]
ds_read_b64_tr_b16 a[92:93], v6 offset:57344
v_cvt_pk_bf16_f32 v244, v240, v241
v_mfma_f32_16x16x32_bf16 v[172:175], a[96:99], a[48:51], v[172:175]
ds_read_b64_tr_b16 a[94:95], v6 offset:58368
v_cvt_pk_bf16_f32 v245, v242, v243
v_mfma_f32_16x16x32_bf16 v[164:167], a[96:99], a[40:43], v[164:167]
buffer_store_dwordx4 v[244:247], v16, s[44:47], s67 offen sc1
v_mfma_f32_16x16x32_bf16 v[164:167], a[100:103], a[44:47], v[164:167]
s_xor_b32 m0, s84, 33792
v_cvt_pk_bf16_f32 v239, v238, v239
v_cvt_pk_bf16_f32 v238, v236, v237
v_mfma_f32_16x16x32_bf16 v[156:159], a[100:103], a[36:39], v[156:159]
s_xor_b32 s64, s72, 16512
v_cvt_pk_bf16_f32 v236, v232, v233
v_cvt_pk_bf16_f32 v237, v234, v235
v_mfma_f32_16x16x32_bf16 v[156:159], a[96:99], a[32:35], v[156:159]
buffer_load_dwordx4 v13, s[48:51], s64 offen lds
v_mfma_f32_16x16x32_bf16 v[24:27], a[104:107], a[32:35], v[24:27]
ds_read_b64_tr_b16 a[96:97], v7 offset:49152
v_accvgpr_write_b32 a156, v236
v_mfma_f32_16x16x32_bf16 v[24:27], a[108:111], a[36:39], v[24:27]
ds_read_b64_tr_b16 a[98:99], v7 offset:50176
v_accvgpr_write_b32 a157, v237
v_mfma_f32_16x16x32_bf16 v[40:43], a[108:111], a[44:47], v[40:43]
ds_read_b64_tr_b16 a[100:101], v7 offset:57344
v_accvgpr_write_b32 a158, v238
v_mfma_f32_16x16x32_bf16 v[40:43], a[104:107], a[40:43], v[40:43]
ds_read_b64_tr_b16 a[102:103], v7 offset:58368
v_accvgpr_write_b32 a159, v239
v_mfma_f32_16x16x32_bf16 v[56:59], a[104:107], a[48:51], v[56:59]
s_xor_b32 m0, s84, 34816
v_cvt_pk_bf16_f32 v231, v230, v231
v_cvt_pk_bf16_f32 v230, v228, v229
v_mfma_f32_16x16x32_bf16 v[56:59], a[108:111], a[52:55], v[56:59]
s_xor_b32 s64, s72, 131200
v_cvt_pk_bf16_f32 v228, v224, v225
v_cvt_pk_bf16_f32 v229, v226, v227
v_mfma_f32_16x16x32_bf16 v[72:75], a[108:111], a[60:63], v[72:75]
s_waitcnt vmcnt(11)
buffer_load_dwordx4 v12, s[48:51], s64 offen lds
v_mfma_f32_16x16x32_bf16 v[72:75], a[104:107], a[56:59], v[72:75]
ds_read_b64_tr_b16 a[104:105], v8 offset:49152
v_accvgpr_write_b32 a160, v228
v_mfma_f32_16x16x32_bf16 v[136:139], a[112:115], a[56:59], v[136:139]
ds_read_b64_tr_b16 a[106:107], v8 offset:50176
v_accvgpr_write_b32 a161, v229
v_mfma_f32_16x16x32_bf16 v[136:139], a[116:119], a[60:63], v[136:139]
ds_read_b64_tr_b16 a[108:109], v8 offset:57344
v_add_u32 v4, 0x8000, v4
v_mfma_f32_16x16x32_bf16 v[120:123], a[116:119], a[52:55], v[120:123]
ds_read_b64_tr_b16 a[110:111], v8 offset:58368
v_accvgpr_write_b32 a162, v230
v_mfma_f32_16x16x32_bf16 v[120:123], a[112:115], a[48:51], v[120:123]
s_xor_b32 m0, s84, 35840
ds_read_b128 a[0:3], v2 offset:0
v_accvgpr_write_b32 a163, v231
v_mfma_f32_16x16x32_bf16 v[104:107], a[112:115], a[40:43], v[104:107]
s_xor_b32 s64, s72, 147584
ds_read_b128 a[4:7], v3 offset:0
v_cvt_pk_bf16_f32 v223, v222, v223
v_mfma_f32_16x16x32_bf16 v[104:107], a[116:119], a[44:47], v[104:107]
buffer_load_dwordx4 v13, s[48:51], s64 offen lds
v_mfma_f32_16x16x32_bf16 v[88:91], a[116:119], a[36:39], v[88:91]
ds_read_b128 a[8:11], v2 offset:2048
v_cvt_pk_bf16_f32 v222, v220, v221
v_mfma_f32_16x16x32_bf16 v[88:91], a[112:115], a[32:35], v[88:91]
s_waitcnt lgkmcnt(7)
ds_read_b128 a[12:15], v3 offset:2048
v_cvt_pk_bf16_f32 v220, v216, v217
v_mfma_f32_16x16x32_bf16 v[28:31], a[32:35], a[72:75], v[28:31]
ds_read_b128 a[16:19], v2 offset:4096
v_cvt_pk_bf16_f32 v221, v218, v219
v_mfma_f32_16x16x32_bf16 v[28:31], a[36:39], a[76:79], v[28:31]
ds_read_b128 a[20:23], v3 offset:4096
v_add_u32 v5, 0x8000, v5
v_mfma_f32_16x16x32_bf16 v[44:47], a[44:47], a[76:79], v[44:47]
s_xor_b32 m0, s84, 36864
ds_read_b128 a[24:27], v2 offset:6144
v_accvgpr_write_b32 a164, v220
v_mfma_f32_16x16x32_bf16 v[44:47], a[40:43], a[72:75], v[44:47]
s_xor_b32 s64, s73, 128
ds_read_b128 a[28:31], v3 offset:6144
v_accvgpr_write_b32 a165, v221
v_mfma_f32_16x16x32_bf16 v[60:63], a[48:51], a[72:75], v[60:63]
buffer_load_dwordx4 v12, s[48:51], s64 offen lds
v_mfma_f32_16x16x32_bf16 v[60:63], a[52:55], a[76:79], v[60:63]
ds_read_b64_tr_b16 a[112:113], v9 offset:49152
v_accvgpr_write_b32 a166, v222
v_mfma_f32_16x16x32_bf16 v[76:79], a[60:63], a[76:79], v[76:79]
ds_read_b64_tr_b16 a[114:115], v9 offset:50176
v_accvgpr_write_b32 a167, v223
v_mfma_f32_16x16x32_bf16 v[76:79], a[56:59], a[72:75], v[76:79]
s_add_u32 s67, s79, 22528
ds_read_b64_tr_b16 a[116:117], v9 offset:57344
v_cvt_pk_bf16_f32 v183, v182, v183
v_mfma_f32_16x16x32_bf16 v[140:143], a[56:59], a[80:83], v[140:143]
ds_read_b64_tr_b16 a[118:119], v9 offset:58368
v_cvt_pk_bf16_f32 v182, v180, v181
v_mfma_f32_16x16x32_bf16 v[140:143], a[60:63], a[84:87], v[140:143]
s_xor_b32 m0, s84, 37888
ds_read_b64_tr_b16 a[72:73], v10 offset:49152
v_add_u32 v6, 0x8000, v6
v_mfma_f32_16x16x32_bf16 v[124:127], a[52:55], a[84:87], v[124:127]
s_xor_b32 s64, s73, 16512
ds_read_b64_tr_b16 a[74:75], v10 offset:50176
v_cvt_pk_bf16_f32 v180, v176, v177
v_mfma_f32_16x16x32_bf16 v[124:127], a[48:51], a[80:83], v[124:127]
buffer_load_dwordx4 v13, s[48:51], s64 offen lds
v_mfma_f32_16x16x32_bf16 v[108:111], a[40:43], a[80:83], v[108:111]
ds_read_b64_tr_b16 a[76:77], v10 offset:57344
v_cvt_pk_bf16_f32 v181, v178, v179
v_mfma_f32_16x16x32_bf16 v[108:111], a[44:47], a[84:87], v[108:111]
ds_read_b64_tr_b16 a[78:79], v10 offset:58368
v_mfma_f32_16x16x32_bf16 v[92:95], a[36:39], a[84:87], v[92:95]
buffer_store_dwordx4 v[180:183], v16, s[44:47], s67 offen sc1
v_mfma_f32_16x16x32_bf16 v[92:95], a[32:35], a[80:83], v[92:95]
ds_read_b64_tr_b16 a[80:81], v11 offset:49152
v_cvt_pk_bf16_f32 v175, v174, v175
v_mfma_f32_16x16x32_bf16 v[32:35], a[32:35], a[88:91], v[32:35]
s_xor_b32 m0, s84, 38912
ds_read_b64_tr_b16 a[82:83], v11 offset:50176
v_cvt_pk_bf16_f32 v174, v172, v173
v_mfma_f32_16x16x32_bf16 v[32:35], a[36:39], a[92:95], v[32:35]
s_xor_b32 s64, s73, 131200
ds_read_b64_tr_b16 a[84:85], v11 offset:57344
v_add_u32 v7, 0x8000, v7
v_mfma_f32_16x16x32_bf16 v[48:51], a[44:47], a[92:95], v[48:51]
buffer_load_dwordx4 v12, s[48:51], s64 offen lds
v_mfma_f32_16x16x32_bf16 v[48:51], a[40:43], a[88:91], v[48:51]
ds_read_b64_tr_b16 a[86:87], v11 offset:58368
v_cvt_pk_bf16_f32 v172, v168, v169
v_mfma_f32_16x16x32_bf16 v[64:67], a[48:51], a[88:91], v[64:67]
v_cvt_pk_bf16_f32 v173, v170, v171
v_accvgpr_write_b32 a168, v172
v_mfma_f32_16x16x32_bf16 v[64:67], a[52:55], a[92:95], v[64:67]
v_accvgpr_write_b32 a169, v173
v_accvgpr_write_b32 a170, v174
v_mfma_f32_16x16x32_bf16 v[80:83], a[60:63], a[92:95], v[80:83]
v_accvgpr_write_b32 a171, v175
v_cvt_pk_bf16_f32 v167, v166, v167
v_mfma_f32_16x16x32_bf16 v[80:83], a[56:59], a[88:91], v[80:83]
s_xor_b32 m0, s84, 39936
v_cvt_pk_bf16_f32 v166, v164, v165
v_cvt_pk_bf16_f32 v164, v160, v161
v_mfma_f32_16x16x32_bf16 v[144:147], a[56:59], a[96:99], v[144:147]
s_xor_b32 s64, s73, 147584
v_cvt_pk_bf16_f32 v165, v162, v163
v_accvgpr_write_b32 a172, v164
v_mfma_f32_16x16x32_bf16 v[144:147], a[60:63], a[100:103], v[144:147]
buffer_load_dwordx4 v13, s[48:51], s64 offen lds
v_mfma_f32_16x16x32_bf16 v[128:131], a[52:55], a[100:103], v[128:131]
v_add_u32 v8, 0x8000, v8
v_accvgpr_write_b32 a173, v165
v_mfma_f32_16x16x32_bf16 v[128:131], a[48:51], a[96:99], v[128:131]
v_accvgpr_write_b32 a174, v166
v_accvgpr_write_b32 a175, v167
v_mfma_f32_16x16x32_bf16 v[112:115], a[40:43], a[96:99], v[112:115]
v_cvt_pk_bf16_f32 v159, v158, v159
v_cvt_pk_bf16_f32 v158, v156, v157
v_mfma_f32_16x16x32_bf16 v[112:115], a[44:47], a[100:103], v[112:115]
v_cvt_pk_bf16_f32 v156, v152, v153
v_cvt_pk_bf16_f32 v157, v154, v155
v_mfma_f32_16x16x32_bf16 v[96:99], a[36:39], a[100:103], v[96:99]
v_add_u32 v9, 0x8000, v9
v_add_u32 v10, 0x8000, v10
v_mfma_f32_16x16x32_bf16 v[96:99], a[32:35], a[96:99], v[96:99]
s_waitcnt lgkmcnt(0)
v_add_u32 v11, 0x8000, v11
v_accvgpr_write_b32 a176, v156
v_mfma_f32_16x16x32_bf16 v[36:39], a[32:35], a[104:107], v[36:39]
v_accvgpr_write_b32 a177, v157
v_accvgpr_write_b32 a178, v158
v_mfma_f32_16x16x32_bf16 v[36:39], a[36:39], a[108:111], v[36:39]
v_accvgpr_write_b32 a179, v159
v_mfma_f32_16x16x32_bf16 v[52:55], a[44:47], a[108:111], v[52:55]
s_add_u32 s67, s79, 23552
s_waitcnt lgkmcnt(0)
s_barrier
v_mfma_f32_16x16x32_bf16 v[52:55], a[40:43], a[104:107], v[52:55]
s_xor_b32 m0, s77, 98304
ds_read_b64_tr_b16 a[88:89], v19 offset:36864
v_cvt_pk_bf16_f32 v139, v138, v139
v_mfma_f32_16x16x32_bf16 v[68:71], a[48:51], a[104:107], v[68:71]
s_xor_b32 s64, s71, 1048576
ds_read_b64_tr_b16 a[90:91], v19 offset:37120
v_cvt_pk_bf16_f32 v138, v136, v137
v_mfma_f32_16x16x32_bf16 v[68:71], a[52:55], a[108:111], v[68:71]
buffer_load_dwordx4 v14, s[56:59], s64 offen lds
v_mfma_f32_16x16x32_bf16 v[84:87], a[60:63], a[108:111], v[84:87]
ds_read_b64_tr_b16 a[92:93], v19 offset:38912
v_cvt_pk_bf16_f32 v136, v72, v73
v_mfma_f32_16x16x32_bf16 v[84:87], a[56:59], a[104:107], v[84:87]
ds_read_b64_tr_b16 a[94:95], v19 offset:39168
v_cvt_pk_bf16_f32 v137, v74, v75
v_mfma_f32_16x16x32_bf16 v[148:151], a[56:59], a[112:115], v[148:151]
ds_read_b64_tr_b16 a[96:97], v20 offset:36864
v_mfma_f32_16x16x32_bf16 v[148:151], a[60:63], a[116:119], v[148:151]
ds_read_b64_tr_b16 a[98:99], v20 offset:37120
v_mfma_f32_16x16x32_bf16 v[132:135], a[52:55], a[116:119], v[132:135]
ds_read_b64_tr_b16 a[100:101], v20 offset:38912
v_mfma_f32_16x16x32_bf16 v[132:135], a[48:51], a[112:115], v[132:135]
ds_read_b64_tr_b16 a[102:103], v20 offset:39168
v_mfma_f32_16x16x32_bf16 v[116:119], a[40:43], a[112:115], v[116:119]
s_add_u32 m0, s78, 114688
ds_read_b64_tr_b16 a[104:105], v19 offset:40960
v_mfma_f32_16x16x32_bf16 v[116:119], a[44:47], a[116:119], v[116:119]
s_add_u32 s64, s75, 786432
ds_read_b64_tr_b16 a[106:107], v19 offset:41216
v_mfma_f32_16x16x32_bf16 v[100:103], a[36:39], a[116:119], v[100:103]
buffer_load_dwordx4 v23, s[60:63], s64 offen lds
v_mfma_f32_16x16x32_bf16 v[100:103], a[32:35], a[112:115], v[100:103]
ds_read_b64_tr_b16 a[108:109], v19 offset:43008
v_mfma_f32_16x16x32_bf16 v[248:251], a[32:35], a[72:75], v[248:251]
ds_read_b64_tr_b16 a[110:111], v19 offset:43264
v_mfma_f32_16x16x32_bf16 v[248:251], a[36:39], a[76:79], v[248:251]
ds_read_b64_tr_b16 a[112:113], v20 offset:40960
v_mfma_f32_16x16x32_bf16 v[252:255], a[44:47], a[76:79], v[252:255]
ds_read_b64_tr_b16 a[114:115], v20 offset:41216
v_mfma_f32_16x16x32_bf16 v[252:255], a[40:43], a[72:75], v[252:255]
ds_read_b64_tr_b16 a[116:117], v20 offset:43008
v_mfma_f32_16x16x32_bf16 a[120:123], a[48:51], a[72:75], a[120:123]
ds_read_b64_tr_b16 a[118:119], v20 offset:43264
v_mfma_f32_16x16x32_bf16 a[120:123], a[52:55], a[76:79], a[120:123]
s_xor_b32 m0, s77, 99328
buffer_store_dwordx4 v[136:139], v16, s[44:47], s67 offen sc1
v_mfma_f32_16x16x32_bf16 a[124:127], a[60:63], a[76:79], a[124:127]
s_xor_b32 s64, s71, 1081344
v_cvt_pk_bf16_f32 v123, v122, v123
v_cvt_pk_bf16_f32 v122, v120, v121
v_mfma_f32_16x16x32_bf16 a[124:127], a[56:59], a[72:75], a[124:127]
buffer_load_dwordx4 v14, s[56:59], s64 offen lds
v_mfma_f32_16x16x32_bf16 a[128:131], a[56:59], a[80:83], a[128:131]
ds_read_b64_tr_b16 a[72:73], v19 offset:32768
v_cvt_pk_bf16_f32 v120, v56, v57
v_mfma_f32_16x16x32_bf16 a[128:131], a[60:63], a[84:87], a[128:131]
ds_read_b64_tr_b16 a[74:75], v19 offset:33024
v_cvt_pk_bf16_f32 v121, v58, v59
v_mfma_f32_16x16x32_bf16 a[132:135], a[52:55], a[84:87], a[132:135]
ds_read_b64_tr_b16 a[76:77], v19 offset:34816
v_accvgpr_write_b32 a180, v120
v_mfma_f32_16x16x32_bf16 a[132:135], a[48:51], a[80:83], a[132:135]
ds_read_b64_tr_b16 a[78:79], v19 offset:35072
v_accvgpr_write_b32 a181, v121
v_mfma_f32_16x16x32_bf16 a[136:139], a[40:43], a[80:83], a[136:139]
v_accvgpr_write_b32 a182, v122
v_accvgpr_write_b32 a183, v123
v_mfma_f32_16x16x32_bf16 a[136:139], a[44:47], a[84:87], a[136:139]
v_cvt_pk_bf16_f32 v107, v106, v107
v_cvt_pk_bf16_f32 v106, v104, v105
v_mfma_f32_16x16x32_bf16 a[140:143], a[36:39], a[84:87], a[140:143]
s_add_u32 m0, s78, 118784
v_cvt_pk_bf16_f32 v104, v40, v41
v_cvt_pk_bf16_f32 v105, v42, v43
v_mfma_f32_16x16x32_bf16 a[140:143], a[32:35], a[80:83], a[140:143]
s_waitcnt lgkmcnt(4)
s_add_u32 s64, s75, 788480
ds_read_b64_tr_b16 a[80:81], v20 offset:32768
v_accvgpr_write_b32 a184, v104
v_mfma_f32_16x16x32_bf16 v[184:187], a[88:91], a[0:3], 0
buffer_load_dwordx4 v23, s[60:63], s64 offen lds
v_mfma_f32_16x16x32_bf16 v[184:187], a[92:95], a[4:7], v[184:187]
ds_read_b64_tr_b16 a[82:83], v20 offset:33024
v_accvgpr_write_b32 a185, v105
v_mfma_f32_16x16x32_bf16 v[192:195], a[92:95], a[12:15], 0
ds_read_b64_tr_b16 a[84:85], v20 offset:34816
v_accvgpr_write_b32 a186, v106
v_mfma_f32_16x16x32_bf16 v[192:195], a[88:91], a[8:11], v[192:195]
ds_read_b64_tr_b16 a[86:87], v20 offset:35072
v_accvgpr_write_b32 a187, v107
v_mfma_f32_16x16x32_bf16 v[200:203], a[88:91], a[16:19], 0
v_cvt_pk_bf16_f32 v91, v90, v91
v_cvt_pk_bf16_f32 v90, v88, v89
v_mfma_f32_16x16x32_bf16 v[200:203], a[92:95], a[20:23], v[200:203]
v_cvt_pk_bf16_f32 v88, v24, v25
v_cvt_pk_bf16_f32 v89, v26, v27
v_mfma_f32_16x16x32_bf16 v[208:211], a[92:95], a[28:31], 0
v_accvgpr_write_b32 a188, v88
v_accvgpr_write_b32 a189, v89
v_mfma_f32_16x16x32_bf16 v[208:211], a[88:91], a[24:27], v[208:211]
s_xor_b32 m0, s77, 100352
ds_read_b64_tr_b16 a[88:89], v4 offset:32768
v_accvgpr_write_b32 a190, v90
v_mfma_f32_16x16x32_bf16 v[212:215], a[96:99], a[24:27], 0
s_xor_b32 s64, s71, 1114112
ds_read_b64_tr_b16 a[90:91], v4 offset:33792
v_accvgpr_write_b32 a191, v91
v_mfma_f32_16x16x32_bf16 v[212:215], a[100:103], a[28:31], v[212:215]
s_add_u32 s67, s79, 8192
ds_read_b64_tr_b16 a[92:93], v4 offset:40960
v_cvt_pk_bf16_f32 v47, v46, v47
v_mfma_f32_16x16x32_bf16 v[204:207], a[100:103], a[20:23], 0
buffer_load_dwordx4 v15, s[56:59], s64 offen lds
v_mfma_f32_16x16x32_bf16 v[204:207], a[96:99], a[16:19], v[204:207]
ds_read_b64_tr_b16 a[94:95], v4 offset:41984
v_cvt_pk_bf16_f32 v46, v44, v45
v_mfma_f32_16x16x32_bf16 v[196:199], a[96:99], a[8:11], 0
v_cvt_pk_bf16_f32 v44, v28, v29
v_cvt_pk_bf16_f32 v45, v30, v31
v_mfma_f32_16x16x32_bf16 v[196:199], a[100:103], a[12:15], v[196:199]
buffer_store_dwordx4 v[44:47], v16, s[44:47], s67 offen sc1
v_mfma_f32_16x16x32_bf16 v[188:191], a[100:103], a[4:7], 0
v_cvt_pk_bf16_f32 v79, v78, v79
v_cvt_pk_bf16_f32 v78, v76, v77
v_mfma_f32_16x16x32_bf16 v[188:191], a[96:99], a[0:3], v[188:191]
s_branch L_po6
L_pg6:
s_branch L_pg10
L_po6:
ds_read_b64_tr_b16 a[96:97], v5 offset:32768
v_cvt_pk_bf16_f32 v76, v60, v61
v_mfma_f32_16x16x32_bf16 v[216:219], a[0:3], a[104:107], 0
ds_read_b64_tr_b16 a[98:99], v5 offset:33792
v_cvt_pk_bf16_f32 v77, v62, v63
v_mfma_f32_16x16x32_bf16 v[216:219], a[4:7], a[108:111], v[216:219]
s_add_u32 m0, s78, 122880
ds_read_b64_tr_b16 a[100:101], v5 offset:40960
v_accvgpr_write_b32 a192, v76
v_mfma_f32_16x16x32_bf16 v[224:227], a[12:15], a[108:111], 0
s_add_u32 s64, s75, 790528
ds_read_b64_tr_b16 a[102:103], v5 offset:41984
v_accvgpr_write_b32 a193, v77
v_mfma_f32_16x16x32_bf16 v[224:227], a[8:11], a[104:107], v[224:227]
buffer_load_dwordx4 v23, s[60:63], s64 offen lds
v_mfma_f32_16x16x32_bf16 v[232:235], a[16:19], a[104:107], 0
v_accvgpr_write_b32 a194, v78
v_accvgpr_write_b32 a195, v79
v_mfma_f32_16x16x32_bf16 v[232:235], a[20:23], a[108:111], v[232:235]
v_cvt_pk_bf16_f32 v124, v124, v125
v_cvt_pk_bf16_f32 v125, v126, v127
v_mfma_f32_16x16x32_bf16 v[240:243], a[28:31], a[108:111], 0
v_cvt_pk_bf16_f32 v126, v140, v141
v_cvt_pk_bf16_f32 v127, v142, v143
v_mfma_f32_16x16x32_bf16 v[240:243], a[24:27], a[104:107], v[240:243]
ds_read_b64_tr_b16 a[104:105], v6 offset:32768
v_accvgpr_write_b32 a196, v124
v_mfma_f32_16x16x32_bf16 v[244:247], a[24:27], a[112:115], 0
ds_read_b64_tr_b16 a[106:107], v6 offset:33792
v_accvgpr_write_b32 a197, v125
v_mfma_f32_16x16x32_bf16 v[244:247], a[28:31], a[116:119], v[244:247]
ds_read_b64_tr_b16 a[108:109], v6 offset:40960
v_accvgpr_write_b32 a198, v126
v_mfma_f32_16x16x32_bf16 v[236:239], a[20:23], a[116:119], 0
s_xor_b32 m0, s77, 101376
ds_read_b64_tr_b16 a[110:111], v6 offset:41984
v_accvgpr_write_b32 a199, v127
v_mfma_f32_16x16x32_bf16 v[236:239], a[16:19], a[112:115], v[236:239]
s_xor_b32 s64, s71, 1146880
v_cvt_pk_bf16_f32 v92, v92, v93
v_cvt_pk_bf16_f32 v93, v94, v95
v_mfma_f32_16x16x32_bf16 v[228:231], a[8:11], a[112:115], 0
buffer_load_dwordx4 v15, s[56:59], s64 offen lds
v_mfma_f32_16x16x32_bf16 v[228:231], a[12:15], a[116:119], v[228:231]
v_cvt_pk_bf16_f32 v94, v108, v109
v_cvt_pk_bf16_f32 v95, v110, v111
v_mfma_f32_16x16x32_bf16 v[220:223], a[4:7], a[116:119], 0
v_accvgpr_write_b32 a200, v92
v_accvgpr_write_b32 a201, v93
v_mfma_f32_16x16x32_bf16 v[220:223], a[0:3], a[112:115], v[220:223]
s_waitcnt lgkmcnt(4)
ds_read_b64_tr_b16 a[112:113], v7 offset:32768
v_accvgpr_write_b32 a202, v94
v_mfma_f32_16x16x32_bf16 v[152:155], a[72:75], a[0:3], 0
ds_read_b64_tr_b16 a[114:115], v7 offset:33792
v_accvgpr_write_b32 a203, v95
v_mfma_f32_16x16x32_bf16 v[152:155], a[76:79], a[4:7], v[152:155]
s_add_u32 s67, s79, 10240
ds_read_b64_tr_b16 a[116:117], v7 offset:40960
v_cvt_pk_bf16_f32 v51, v50, v51
v_mfma_f32_16x16x32_bf16 v[160:163], a[76:79], a[12:15], 0
ds_read_b64_tr_b16 a[118:119], v7 offset:41984
v_cvt_pk_bf16_f32 v50, v48, v49
v_mfma_f32_16x16x32_bf16 v[160:163], a[72:75], a[8:11], v[160:163]
v_cvt_pk_bf16_f32 v48, v32, v33
v_cvt_pk_bf16_f32 v49, v34, v35
v_mfma_f32_16x16x32_bf16 v[168:171], a[72:75], a[16:19], 0
buffer_store_dwordx4 v[48:51], v16, s[44:47], s67 offen sc1
v_mfma_f32_16x16x32_bf16 v[168:171], a[76:79], a[20:23], v[168:171]
v_subrev_u32 v19, 0x8000, v19
v_subrev_u32 v20, 0x8000, v20
v_mfma_f32_16x16x32_bf16 v[176:179], a[76:79], a[28:31], 0
s_xor_b32 m0, s84, 0
v_cvt_pk_bf16_f32 v83, v82, v83
v_cvt_pk_bf16_f32 v82, v80, v81
v_mfma_f32_16x16x32_bf16 v[176:179], a[72:75], a[24:27], v[176:179]
s_xor_b32 s64, s72, 256
ds_read_b64_tr_b16 a[72:73], v8 offset:32768
v_cvt_pk_bf16_f32 v80, v64, v65
v_mfma_f32_16x16x32_bf16 v[180:183], a[80:83], a[24:27], 0
buffer_load_dwordx4 v12, s[48:51], s64 offen lds
v_mfma_f32_16x16x32_bf16 v[180:183], a[84:87], a[28:31], v[180:183]
ds_read_b64_tr_b16 a[74:75], v8 offset:33792
v_subrev_u32 v4, 0x8000, v4
v_mfma_f32_16x16x32_bf16 v[172:175], a[84:87], a[20:23], 0
ds_read_b64_tr_b16 a[76:77], v8 offset:40960
v_cvt_pk_bf16_f32 v81, v66, v67
v_mfma_f32_16x16x32_bf16 v[172:175], a[80:83], a[16:19], v[172:175]
s_xor_b32 m0, s84, 1024
ds_read_b64_tr_b16 a[78:79], v8 offset:41984
v_accvgpr_write_b32 a204, v80
v_mfma_f32_16x16x32_bf16 v[164:167], a[80:83], a[8:11], 0
s_xor_b32 s64, s72, 16640
v_accvgpr_write_b32 a205, v81
v_accvgpr_write_b32 a206, v82
v_mfma_f32_16x16x32_bf16 v[164:167], a[84:87], a[12:15], v[164:167]
buffer_load_dwordx4 v13, s[48:51], s64 offen lds
v_mfma_f32_16x16x32_bf16 v[156:159], a[84:87], a[4:7], 0
v_accvgpr_write_b32 a207, v83
v_cvt_pk_bf16_f32 v128, v128, v129
v_mfma_f32_16x16x32_bf16 v[156:159], a[80:83], a[0:3], v[156:159]
ds_read_b64_tr_b16 a[80:81], v9 offset:32768
v_cvt_pk_bf16_f32 v129, v130, v131
v_mfma_f32_16x16x32_bf16 v[24:27], a[88:91], a[0:3], 0
s_xor_b32 m0, s84, 2048
ds_read_b64_tr_b16 a[82:83], v9 offset:33792
v_cvt_pk_bf16_f32 v130, v144, v145
v_mfma_f32_16x16x32_bf16 v[24:27], a[92:95], a[4:7], v[24:27]
s_xor_b32 s64, s72, 131328
ds_read_b64_tr_b16 a[84:85], v9 offset:40960
v_subrev_u32 v5, 0x8000, v5
v_mfma_f32_16x16x32_bf16 v[40:43], a[92:95], a[12:15], 0
buffer_load_dwordx4 v12, s[48:51], s64 offen lds
v_mfma_f32_16x16x32_bf16 v[40:43], a[88:91], a[8:11], v[40:43]
ds_read_b64_tr_b16 a[86:87], v9 offset:41984
v_cvt_pk_bf16_f32 v131, v146, v147
v_mfma_f32_16x16x32_bf16 v[56:59], a[88:91], a[16:19], 0
s_xor_b32 m0, s84, 3072
v_accvgpr_write_b32 a208, v128
v_accvgpr_write_b32 a209, v129
v_mfma_f32_16x16x32_bf16 v[56:59], a[92:95], a[20:23], v[56:59]
s_xor_b32 s64, s72, 147712
v_accvgpr_write_b32 a210, v130
v_accvgpr_write_b32 a211, v131
v_mfma_f32_16x16x32_bf16 v[72:75], a[92:95], a[28:31], 0
s_waitcnt vmcnt(13)
ds_read_b128 a[32:35], v2 offset:32768
v_cvt_pk_bf16_f32 v96, v96, v97
v_mfma_f32_16x16x32_bf16 v[72:75], a[88:91], a[24:27], v[72:75]
buffer_load_dwordx4 v13, s[48:51], s64 offen lds
v_mfma_f32_16x16x32_bf16 v[136:139], a[96:99], a[24:27], 0
ds_read_b128 a[36:39], v3 offset:32768
v_cvt_pk_bf16_f32 v97, v98, v99
v_mfma_f32_16x16x32_bf16 v[136:139], a[100:103], a[28:31], v[136:139]
ds_read_b128 a[40:43], v2 offset:34816
v_subrev_u32 v6, 0x8000, v6
v_mfma_f32_16x16x32_bf16 v[120:123], a[100:103], a[20:23], 0
s_xor_b32 m0, s84, 4096
ds_read_b128 a[44:47], v3 offset:34816
v_cvt_pk_bf16_f32 v98, v112, v113
v_mfma_f32_16x16x32_bf16 v[120:123], a[96:99], a[16:19], v[120:123]
s_xor_b32 s64, s73, 256
ds_read_b128 a[48:51], v2 offset:36864
v_cvt_pk_bf16_f32 v99, v114, v115
v_mfma_f32_16x16x32_bf16 v[104:107], a[96:99], a[8:11], 0
buffer_load_dwordx4 v12, s[48:51], s64 offen lds
v_mfma_f32_16x16x32_bf16 v[104:107], a[100:103], a[12:15], v[104:107]
ds_read_b128 a[52:55], v3 offset:36864
v_accvgpr_write_b32 a212, v96
v_mfma_f32_16x16x32_bf16 v[88:91], a[100:103], a[4:7], 0
ds_read_b128 a[56:59], v2 offset:38912
v_accvgpr_write_b32 a213, v97
v_mfma_f32_16x16x32_bf16 v[88:91], a[96:99], a[0:3], v[88:91]
s_waitcnt lgkmcnt(7)
s_xor_b32 m0, s84, 5120
ds_read_b128 a[60:63], v3 offset:38912
v_accvgpr_write_b32 a214, v98
v_mfma_f32_16x16x32_bf16 v[28:31], a[104:107], a[0:3], 0
s_xor_b32 s64, s73, 16640
ds_read_b64_tr_b16 a[88:89], v10 offset:32768
v_accvgpr_write_b32 a215, v99
v_mfma_f32_16x16x32_bf16 v[28:31], a[108:111], a[4:7], v[28:31]
s_add_u32 s67, s79, 12288
buffer_load_dwordx4 v13, s[48:51], s64 offen lds
v_mfma_f32_16x16x32_bf16 v[44:47], a[108:111], a[12:15], 0
ds_read_b64_tr_b16 a[90:91], v10 offset:33792
v_subrev_u32 v7, 0x8000, v7
v_mfma_f32_16x16x32_bf16 v[44:47], a[104:107], a[8:11], v[44:47]
ds_read_b64_tr_b16 a[92:93], v10 offset:40960
v_cvt_pk_bf16_f32 v55, v54, v55
v_mfma_f32_16x16x32_bf16 v[60:63], a[104:107], a[16:19], 0
s_xor_b32 m0, s84, 6144
ds_read_b64_tr_b16 a[94:95], v10 offset:41984
v_cvt_pk_bf16_f32 v54, v52, v53
v_mfma_f32_16x16x32_bf16 v[60:63], a[108:111], a[20:23], v[60:63]
s_xor_b32 s64, s73, 131328
ds_read_b64_tr_b16 a[96:97], v11 offset:32768
v_cvt_pk_bf16_f32 v52, v36, v37
v_mfma_f32_16x16x32_bf16 v[76:79], a[108:111], a[28:31], 0
buffer_load_dwordx4 v12, s[48:51], s64 offen lds
v_mfma_f32_16x16x32_bf16 v[76:79], a[104:107], a[24:27], v[76:79]
ds_read_b64_tr_b16 a[98:99], v11 offset:33792
v_cvt_pk_bf16_f32 v53, v38, v39
v_mfma_f32_16x16x32_bf16 v[140:143], a[112:115], a[24:27], 0
ds_read_b64_tr_b16 a[100:101], v11 offset:40960
v_mfma_f32_16x16x32_bf16 v[140:143], a[116:119], a[28:31], v[140:143]
s_xor_b32 m0, s84, 7168
ds_read_b64_tr_b16 a[102:103], v11 offset:41984
v_subrev_u32 v8, 0x8000, v8
v_mfma_f32_16x16x32_bf16 v[124:127], a[116:119], a[20:23], 0
s_xor_b32 s64, s73, 147712
buffer_store_dwordx4 v[52:55], v16, s[44:47], s67 offen sc1
v_mfma_f32_16x16x32_bf16 v[124:127], a[112:115], a[16:19], v[124:127]
buffer_load_dwordx4 v13, s[48:51], s64 offen lds
v_mfma_f32_16x16x32_bf16 v[108:111], a[112:115], a[8:11], 0
v_cvt_pk_bf16_f32 v87, v86, v87
v_cvt_pk_bf16_f32 v86, v84, v85
v_mfma_f32_16x16x32_bf16 v[108:111], a[116:119], a[12:15], v[108:111]
v_cvt_pk_bf16_f32 v84, v68, v69
v_cvt_pk_bf16_f32 v85, v70, v71
v_mfma_f32_16x16x32_bf16 v[92:95], a[116:119], a[4:7], 0
v_subrev_u32 v9, 0x8000, v9
v_subrev_u32 v10, 0x8000, v10
v_mfma_f32_16x16x32_bf16 v[92:95], a[112:115], a[0:3], v[92:95]
v_subrev_u32 v11, 0x8000, v11
v_accvgpr_write_b32 a216, v84
v_mfma_f32_16x16x32_bf16 v[32:35], a[72:75], a[0:3], 0
v_accvgpr_write_b32 a217, v85
v_accvgpr_write_b32 a218, v86
v_mfma_f32_16x16x32_bf16 v[32:35], a[76:79], a[4:7], v[32:35]
v_accvgpr_write_b32 a219, v87
v_cvt_pk_bf16_f32 v132, v132, v133
v_mfma_f32_16x16x32_bf16 v[48:51], a[76:79], a[12:15], 0
s_waitcnt lgkmcnt(0)
s_barrier
v_mfma_f32_16x16x32_bf16 v[48:51], a[72:75], a[8:11], v[48:51]
s_xor_b32 m0, s77, 131072
ds_read_b64_tr_b16 a[104:105], v19 offset:4096
v_cvt_pk_bf16_f32 v133, v134, v135
v_mfma_f32_16x16x32_bf16 v[64:67], a[72:75], a[16:19], 0
s_xor_b32 s64, s71, 1572864
ds_read_b64_tr_b16 a[106:107], v19 offset:4352
v_cvt_pk_bf16_f32 v134, v148, v149
v_mfma_f32_16x16x32_bf16 v[64:67], a[76:79], a[20:23], v[64:67]
buffer_load_dwordx4 v14, s[56:59], s64 offen lds
v_mfma_f32_16x16x32_bf16 v[80:83], a[76:79], a[28:31], 0
ds_read_b64_tr_b16 a[108:109], v19 offset:6144
v_cvt_pk_bf16_f32 v135, v150, v151
v_mfma_f32_16x16x32_bf16 v[80:83], a[72:75], a[24:27], v[80:83]
ds_read_b64_tr_b16 a[110:111], v19 offset:6400
v_accvgpr_write_b32 a220, v132
v_mfma_f32_16x16x32_bf16 v[144:147], a[80:83], a[24:27], 0
ds_read_b64_tr_b16 a[112:113], v20 offset:4096
v_accvgpr_write_b32 a221, v133
v_mfma_f32_16x16x32_bf16 v[144:147], a[84:87], a[28:31], v[144:147]
ds_read_b64_tr_b16 a[114:115], v20 offset:4352
v_accvgpr_write_b32 a222, v134
v_mfma_f32_16x16x32_bf16 v[128:131], a[84:87], a[20:23], 0
ds_read_b64_tr_b16 a[116:117], v20 offset:6144
v_accvgpr_write_b32 a223, v135
v_mfma_f32_16x16x32_bf16 v[128:131], a[80:83], a[16:19], v[128:131]
ds_read_b64_tr_b16 a[118:119], v20 offset:6400
v_cvt_pk_bf16_f32 v100, v100, v101
v_mfma_f32_16x16x32_bf16 v[112:115], a[80:83], a[8:11], 0
s_add_u32 m0, s78, 147456
ds_read_b64_tr_b16 a[72:73], v19 offset:8192
v_cvt_pk_bf16_f32 v101, v102, v103
v_mfma_f32_16x16x32_bf16 v[112:115], a[84:87], a[12:15], v[112:115]
s_add_u32 s64, s75, 1179648
ds_read_b64_tr_b16 a[74:75], v19 offset:8448
v_cvt_pk_bf16_f32 v102, v116, v117
v_mfma_f32_16x16x32_bf16 v[96:99], a[84:87], a[4:7], 0
buffer_load_dwordx4 v23, s[60:63], s64 offen lds
v_mfma_f32_16x16x32_bf16 v[96:99], a[80:83], a[0:3], v[96:99]
ds_read_b64_tr_b16 a[76:77], v19 offset:10240
v_cvt_pk_bf16_f32 v103, v118, v119
v_mfma_f32_16x16x32_bf16 v[36:39], a[88:91], a[0:3], 0
ds_read_b64_tr_b16 a[78:79], v19 offset:10496
v_accvgpr_write_b32 a224, v100
v_mfma_f32_16x16x32_bf16 v[36:39], a[92:95], a[4:7], v[36:39]
ds_read_b64_tr_b16 a[80:81], v20 offset:8192
v_accvgpr_write_b32 a225, v101
v_mfma_f32_16x16x32_bf16 v[52:55], a[92:95], a[12:15], 0
s_xor_b32 s68, s66, 0
ds_read_b64_tr_b16 a[82:83], v20 offset:8448
v_accvgpr_write_b32 a226, v102
v_mfma_f32_16x16x32_bf16 v[52:55], a[88:91], a[8:11], v[52:55]
s_xor_b32 m0, s77, 132096
ds_read_b64_tr_b16 a[84:85], v20 offset:10240
v_accvgpr_write_b32 a227, v103
v_mfma_f32_16x16x32_bf16 v[68:71], a[88:91], a[16:19], 0
s_add_u32 s67, s79, 14336
ds_read_b64_tr_b16 a[86:87], v20 offset:10496
v_cvt_pk_bf16_f32 v255, v254, v255
v_mfma_f32_16x16x32_bf16 v[68:71], a[92:95], a[20:23], v[68:71]
s_xor_b32 s64, s71, 1605632
v_cvt_pk_bf16_f32 v254, v252, v253
v_cvt_pk_bf16_f32 v252, v248, v249
v_mfma_f32_16x16x32_bf16 v[84:87], a[92:95], a[28:31], 0
s_mov_b64 exec, 1
buffer_atomic_add a251, v1, s[52:55], s68 offen offset:0 sc1
s_mov_b64 exec, -1
v_mfma_f32_16x16x32_bf16 v[84:87], a[88:91], a[24:27], v[84:87]
buffer_load_dwordx4 v14, s[56:59], s64 offen lds
v_mfma_f32_16x16x32_bf16 v[148:151], a[96:99], a[24:27], 0
ds_read_b64_tr_b16 a[88:89], v19 offset:0
v_cvt_pk_bf16_f32 v253, v250, v251
v_mfma_f32_16x16x32_bf16 v[148:151], a[100:103], a[28:31], v[148:151]
ds_read_b64_tr_b16 a[90:91], v19 offset:256
v_mfma_f32_16x16x32_bf16 v[132:135], a[100:103], a[20:23], 0
ds_read_b64_tr_b16 a[92:93], v19 offset:2048
v_mfma_f32_16x16x32_bf16 v[132:135], a[96:99], a[16:19], v[132:135]
s_add_u32 s65, s79, 16384
ds_read_b64_tr_b16 a[94:95], v19 offset:2304
v_mfma_f32_16x16x32_bf16 v[116:119], a[96:99], a[8:11], 0
buffer_store_dwordx4 a[144:147], v16, s[44:47], s65 offen sc1
v_mfma_f32_16x16x32_bf16 v[116:119], a[100:103], a[12:15], v[116:119]
buffer_store_dwordx4 v[252:255], v16, s[44:47], s67 offen sc1
v_mfma_f32_16x16x32_bf16 v[100:103], a[100:103], a[4:7], 0
s_add_u32 m0, s78, 151552
v_mfma_f32_16x16x32_bf16 v[100:103], a[96:99], a[0:3], v[100:103]
s_waitcnt lgkmcnt(4)
s_add_u32 s64, s75, 1181696
ds_read_b64_tr_b16 a[96:97], v20 offset:0
v_accvgpr_read_b32 v248, a120
v_mfma_f32_16x16x32_bf16 v[184:187], a[104:107], a[32:35], v[184:187]
buffer_load_dwordx4 v23, s[60:63], s64 offen lds
v_mfma_f32_16x16x32_bf16 v[184:187], a[108:111], a[36:39], v[184:187]
ds_read_b64_tr_b16 a[98:99], v20 offset:256
v_accvgpr_read_b32 v249, a121
v_mfma_f32_16x16x32_bf16 v[192:195], a[108:111], a[44:47], v[192:195]
ds_read_b64_tr_b16 a[100:101], v20 offset:2048
v_accvgpr_read_b32 v250, a122
v_mfma_f32_16x16x32_bf16 v[192:195], a[104:107], a[40:43], v[192:195]
ds_read_b64_tr_b16 a[102:103], v20 offset:2304
v_accvgpr_read_b32 v251, a123
v_mfma_f32_16x16x32_bf16 v[200:203], a[104:107], a[48:51], v[200:203]
v_accvgpr_read_b32 v252, a124
v_accvgpr_read_b32 v253, a125
v_mfma_f32_16x16x32_bf16 v[200:203], a[108:111], a[52:55], v[200:203]
v_accvgpr_read_b32 v254, a126
v_accvgpr_read_b32 v255, a127
v_mfma_f32_16x16x32_bf16 v[208:211], a[108:111], a[60:63], v[208:211]
v_cvt_pk_bf16_f32 v255, v254, v255
v_cvt_pk_bf16_f32 v254, v252, v253
v_mfma_f32_16x16x32_bf16 v[208:211], a[104:107], a[56:59], v[208:211]
ds_read_b64_tr_b16 a[104:105], v4 offset:0
v_cvt_pk_bf16_f32 v252, v248, v249
v_mfma_f32_16x16x32_bf16 v[212:215], a[112:115], a[56:59], v[212:215]
s_xor_b32 m0, s77, 133120
ds_read_b64_tr_b16 a[106:107], v4 offset:1024
v_cvt_pk_bf16_f32 v253, v250, v251
v_mfma_f32_16x16x32_bf16 v[212:215], a[116:119], a[60:63], v[212:215]
s_xor_b32 s64, s71, 1638400
ds_read_b64_tr_b16 a[108:109], v4 offset:8192
v_accvgpr_write_b32 a228, v252
v_mfma_f32_16x16x32_bf16 v[204:207], a[116:119], a[52:55], v[204:207]
buffer_load_dwordx4 v15, s[56:59], s64 offen lds
v_mfma_f32_16x16x32_bf16 v[204:207], a[112:115], a[48:51], v[204:207]
ds_read_b64_tr_b16 a[110:111], v4 offset:9216
v_accvgpr_write_b32 a229, v253
v_mfma_f32_16x16x32_bf16 v[196:199], a[112:115], a[40:43], v[196:199]
v_accvgpr_write_b32 a230, v254
v_accvgpr_write_b32 a231, v255
v_mfma_f32_16x16x32_bf16 v[196:199], a[116:119], a[44:47], v[196:199]
v_mfma_f32_16x16x32_bf16 v[188:191], a[116:119], a[36:39], v[188:191]
v_accvgpr_read_b32 v248, a132
v_accvgpr_read_b32 v249, a133
v_mfma_f32_16x16x32_bf16 v[188:191], a[112:115], a[32:35], v[188:191]
ds_read_b64_tr_b16 a[112:113], v5 offset:0
v_accvgpr_read_b32 v250, a134
v_mfma_f32_16x16x32_bf16 v[216:219], a[32:35], a[72:75], v[216:219]
ds_read_b64_tr_b16 a[114:115], v5 offset:1024
v_accvgpr_read_b32 v251, a135
v_mfma_f32_16x16x32_bf16 v[216:219], a[36:39], a[76:79], v[216:219]
s_add_u32 m0, s78, 155648
ds_read_b64_tr_b16 a[116:117], v5 offset:8192
v_accvgpr_read_b32 v252, a128
v_mfma_f32_16x16x32_bf16 v[224:227], a[44:47], a[76:79], v[224:227]
s_add_u32 s64, s75, 1183744
ds_read_b64_tr_b16 a[118:119], v5 offset:9216
v_accvgpr_read_b32 v253, a129
v_mfma_f32_16x16x32_bf16 v[224:227], a[40:43], a[72:75], v[224:227]
buffer_load_dwordx4 v23, s[60:63], s64 offen lds
v_mfma_f32_16x16x32_bf16 v[232:235], a[48:51], a[72:75], v[232:235]
v_accvgpr_read_b32 v254, a130
v_accvgpr_read_b32 v255, a131
v_mfma_f32_16x16x32_bf16 v[232:235], a[52:55], a[76:79], v[232:235]
v_cvt_pk_bf16_f32 v255, v254, v255
v_cvt_pk_bf16_f32 v254, v252, v253
v_mfma_f32_16x16x32_bf16 v[240:243], a[60:63], a[76:79], v[240:243]
v_cvt_pk_bf16_f32 v252, v248, v249
v_cvt_pk_bf16_f32 v253, v250, v251
v_mfma_f32_16x16x32_bf16 v[240:243], a[56:59], a[72:75], v[240:243]
ds_read_b64_tr_b16 a[72:73], v6 offset:0
v_accvgpr_write_b32 a232, v252
v_mfma_f32_16x16x32_bf16 v[244:247], a[56:59], a[80:83], v[244:247]
ds_read_b64_tr_b16 a[74:75], v6 offset:1024
v_accvgpr_write_b32 a233, v253
v_mfma_f32_16x16x32_bf16 v[244:247], a[60:63], a[84:87], v[244:247]
ds_read_b64_tr_b16 a[76:77], v6 offset:8192
v_accvgpr_write_b32 a234, v254
v_mfma_f32_16x16x32_bf16 v[236:239], a[52:55], a[84:87], v[236:239]
s_xor_b32 m0, s77, 134144
ds_read_b64_tr_b16 a[78:79], v6 offset:9216
v_accvgpr_write_b32 a235, v255
v_mfma_f32_16x16x32_bf16 v[236:239], a[48:51], a[80:83], v[236:239]
s_xor_b32 s64, s71, 1671168
v_mfma_f32_16x16x32_bf16 v[228:231], a[40:43], a[80:83], v[228:231]
buffer_load_dwordx4 v15, s[56:59], s64 offen lds
v_mfma_f32_16x16x32_bf16 v[228:231], a[44:47], a[84:87], v[228:231]
v_accvgpr_read_b32 v248, a140
v_accvgpr_read_b32 v249, a141
v_mfma_f32_16x16x32_bf16 v[220:223], a[36:39], a[84:87], v[220:223]
v_accvgpr_read_b32 v250, a142
v_accvgpr_read_b32 v251, a143
v_mfma_f32_16x16x32_bf16 v[220:223], a[32:35], a[80:83], v[220:223]
s_waitcnt lgkmcnt(4)
ds_read_b64_tr_b16 a[80:81], v7 offset:0
v_accvgpr_read_b32 v252, a136
v_mfma_f32_16x16x32_bf16 v[152:155], a[88:91], a[32:35], v[152:155]
ds_read_b64_tr_b16 a[82:83], v7 offset:1024
v_accvgpr_read_b32 v253, a137
v_mfma_f32_16x16x32_bf16 v[152:155], a[92:95], a[36:39], v[152:155]
ds_read_b64_tr_b16 a[84:85], v7 offset:8192
v_accvgpr_read_b32 v254, a138
v_mfma_f32_16x16x32_bf16 v[160:163], a[92:95], a[44:47], v[160:163]
ds_read_b64_tr_b16 a[86:87], v7 offset:9216
v_accvgpr_read_b32 v255, a139
v_mfma_f32_16x16x32_bf16 v[160:163], a[88:91], a[40:43], v[160:163]
v_cvt_pk_bf16_f32 v255, v254, v255
v_cvt_pk_bf16_f32 v254, v252, v253
v_mfma_f32_16x16x32_bf16 v[168:171], a[88:91], a[48:51], v[168:171]
v_cvt_pk_bf16_f32 v252, v248, v249
v_cvt_pk_bf16_f32 v253, v250, v251
v_mfma_f32_16x16x32_bf16 v[168:171], a[92:95], a[52:55], v[168:171]
v_accvgpr_write_b32 a236, v252
v_accvgpr_write_b32 a237, v253
v_mfma_f32_16x16x32_bf16 v[176:179], a[92:95], a[60:63], v[176:179]
s_xor_b32 m0, s84, 32768
v_accvgpr_write_b32 a238, v254
v_accvgpr_write_b32 a239, v255
v_mfma_f32_16x16x32_bf16 v[176:179], a[88:91], a[56:59], v[176:179]
s_xor_b32 s64, s72, 384
ds_read_b64_tr_b16 a[88:89], v8 offset:0
v_mfma_f32_16x16x32_bf16 v[180:183], a[96:99], a[56:59], v[180:183]
s_add_u32 s65, s79, 4096
buffer_load_dwordx4 v12, s[48:51], s64 offen lds
v_mfma_f32_16x16x32_bf16 v[180:183], a[100:103], a[60:63], v[180:183]
buffer_store_dwordx4 a[148:151], v16, s[44:47], s65 offen sc1
v_mfma_f32_16x16x32_bf16 v[172:175], a[100:103], a[52:55], v[172:175]
ds_read_b64_tr_b16 a[90:91], v8 offset:1024
v_mfma_f32_16x16x32_bf16 v[172:175], a[96:99], a[48:51], v[172:175]
s_xor_b32 m0, s84, 33792
ds_read_b64_tr_b16 a[92:93], v8 offset:8192
v_mfma_f32_16x16x32_bf16 v[164:167], a[96:99], a[40:43], v[164:167]
s_xor_b32 s64, s72, 16768
ds_read_b64_tr_b16 a[94:95], v8 offset:9216
v_mfma_f32_16x16x32_bf16 v[164:167], a[100:103], a[44:47], v[164:167]
buffer_load_dwordx4 v13, s[48:51], s64 offen lds
v_mfma_f32_16x16x32_bf16 v[156:159], a[100:103], a[36:39], v[156:159]
v_mfma_f32_16x16x32_bf16 v[156:159], a[96:99], a[32:35], v[156:159]
ds_read_b64_tr_b16 a[96:97], v9 offset:0
v_mfma_f32_16x16x32_bf16 v[24:27], a[104:107], a[32:35], v[24:27]
s_xor_b32 m0, s84, 34816
ds_read_b64_tr_b16 a[98:99], v9 offset:1024
v_mfma_f32_16x16x32_bf16 v[24:27], a[108:111], a[36:39], v[24:27]
s_xor_b32 s64, s72, 131456
ds_read_b64_tr_b16 a[100:101], v9 offset:8192
v_mfma_f32_16x16x32_bf16 v[40:43], a[108:111], a[44:47], v[40:43]
buffer_load_dwordx4 v12, s[48:51], s64 offen lds
v_mfma_f32_16x16x32_bf16 v[40:43], a[104:107], a[40:43], v[40:43]
ds_read_b64_tr_b16 a[102:103], v9 offset:9216
v_mfma_f32_16x16x32_bf16 v[56:59], a[104:107], a[48:51], v[56:59]
v_mfma_f32_16x16x32_bf16 v[56:59], a[108:111], a[52:55], v[56:59]
s_xor_b32 m0, s84, 35840
v_mfma_f32_16x16x32_bf16 v[72:75], a[108:111], a[60:63], v[72:75]
s_waitcnt vmcnt(14)
s_xor_b32 s64, s72, 147840
ds_read_b128 a[0:3], v2 offset:0
v_mfma_f32_16x16x32_bf16 v[72:75], a[104:107], a[56:59], v[72:75]
buffer_load_dwordx4 v13, s[48:51], s64 offen lds
v_mfma_f32_16x16x32_bf16 v[136:139], a[112:115], a[56:59], v[136:139]
ds_read_b128 a[4:7], v3 offset:0
v_mfma_f32_16x16x32_bf16 v[136:139], a[116:119], a[60:63], v[136:139]
ds_read_b128 a[8:11], v2 offset:2048
v_mfma_f32_16x16x32_bf16 v[120:123], a[116:119], a[52:55], v[120:123]
s_xor_b32 m0, s84, 36864
ds_read_b128 a[12:15], v3 offset:2048
v_mfma_f32_16x16x32_bf16 v[120:123], a[112:115], a[48:51], v[120:123]
s_xor_b32 s64, s73, 384
ds_read_b128 a[16:19], v2 offset:4096
v_mfma_f32_16x16x32_bf16 v[104:107], a[112:115], a[40:43], v[104:107]
buffer_load_dwordx4 v12, s[48:51], s64 offen lds
v_mfma_f32_16x16x32_bf16 v[104:107], a[116:119], a[44:47], v[104:107]
ds_read_b128 a[20:23], v3 offset:4096
v_mfma_f32_16x16x32_bf16 v[88:91], a[116:119], a[36:39], v[88:91]
ds_read_b128 a[24:27], v2 offset:6144
v_mfma_f32_16x16x32_bf16 v[88:91], a[112:115], a[32:35], v[88:91]
s_waitcnt lgkmcnt(7)
s_xor_b32 m0, s84, 37888
ds_read_b128 a[28:31], v3 offset:6144
v_mfma_f32_16x16x32_bf16 v[28:31], a[72:75], a[32:35], v[28:31]
s_xor_b32 s64, s73, 16768
ds_read_b64_tr_b16 a[104:105], v10 offset:0
v_mfma_f32_16x16x32_bf16 v[28:31], a[76:79], a[36:39], v[28:31]
buffer_load_dwordx4 v13, s[48:51], s64 offen lds
v_mfma_f32_16x16x32_bf16 v[44:47], a[76:79], a[44:47], v[44:47]
ds_read_b64_tr_b16 a[106:107], v10 offset:1024
v_mfma_f32_16x16x32_bf16 v[44:47], a[72:75], a[40:43], v[44:47]
ds_read_b64_tr_b16 a[108:109], v10 offset:8192
v_mfma_f32_16x16x32_bf16 v[60:63], a[72:75], a[48:51], v[60:63]
s_xor_b32 m0, s84, 38912
ds_read_b64_tr_b16 a[110:111], v10 offset:9216
v_mfma_f32_16x16x32_bf16 v[60:63], a[76:79], a[52:55], v[60:63]
s_xor_b32 s64, s73, 131456
ds_read_b64_tr_b16 a[112:113], v11 offset:0
v_mfma_f32_16x16x32_bf16 v[76:79], a[76:79], a[60:63], v[76:79]
buffer_load_dwordx4 v12, s[48:51], s64 offen lds
v_mfma_f32_16x16x32_bf16 v[76:79], a[72:75], a[56:59], v[76:79]
ds_read_b64_tr_b16 a[114:115], v11 offset:1024
v_mfma_f32_16x16x32_bf16 v[140:143], a[80:83], a[56:59], v[140:143]
ds_read_b64_tr_b16 a[116:117], v11 offset:8192
v_mfma_f32_16x16x32_bf16 v[140:143], a[84:87], a[60:63], v[140:143]
s_xor_b32 m0, s84, 39936
ds_read_b64_tr_b16 a[118:119], v11 offset:9216
v_mfma_f32_16x16x32_bf16 v[124:127], a[84:87], a[52:55], v[124:127]
s_xor_b32 s64, s73, 147840
v_mfma_f32_16x16x32_bf16 v[124:127], a[80:83], a[48:51], v[124:127]
buffer_load_dwordx4 v13, s[48:51], s64 offen lds
v_mfma_f32_16x16x32_bf16 v[108:111], a[80:83], a[40:43], v[108:111]
v_mfma_f32_16x16x32_bf16 v[108:111], a[84:87], a[44:47], v[108:111]
v_mfma_f32_16x16x32_bf16 v[92:95], a[84:87], a[36:39], v[92:95]
v_mfma_f32_16x16x32_bf16 v[92:95], a[80:83], a[32:35], v[92:95]
v_mfma_f32_16x16x32_bf16 v[32:35], a[88:91], a[32:35], v[32:35]
v_mfma_f32_16x16x32_bf16 v[32:35], a[92:95], a[36:39], v[32:35]
s_branch L_po7
L_pg7:
s_branch L_pg11
L_po7:
v_mfma_f32_16x16x32_bf16 v[48:51], a[92:95], a[44:47], v[48:51]
s_waitcnt lgkmcnt(0)
s_barrier
v_mfma_f32_16x16x32_bf16 v[48:51], a[88:91], a[40:43], v[48:51]
s_xor_b32 m0, s77, 65536
ds_read_b64_tr_b16 a[72:73], v19 offset:36864
v_mfma_f32_16x16x32_bf16 v[64:67], a[88:91], a[48:51], v[64:67]
s_xor_b32 s64, s71, 2097152
ds_read_b64_tr_b16 a[74:75], v19 offset:37120
v_mfma_f32_16x16x32_bf16 v[64:67], a[92:95], a[52:55], v[64:67]
s_add_u32 s65, s79, 0
buffer_load_dwordx4 v14, s[56:59], s64 offen lds
v_mfma_f32_16x16x32_bf16 v[80:83], a[92:95], a[60:63], v[80:83]
buffer_store_dwordx4 a[152:155], v16, s[44:47], s65 offen sc1
v_mfma_f32_16x16x32_bf16 v[80:83], a[88:91], a[56:59], v[80:83]
ds_read_b64_tr_b16 a[76:77], v19 offset:38912
v_mfma_f32_16x16x32_bf16 v[144:147], a[96:99], a[56:59], v[144:147]
ds_read_b64_tr_b16 a[78:79], v19 offset:39168
v_mfma_f32_16x16x32_bf16 v[144:147], a[100:103], a[60:63], v[144:147]
ds_read_b64_tr_b16 a[80:81], v20 offset:36864
v_mfma_f32_16x16x32_bf16 v[128:131], a[100:103], a[52:55], v[128:131]
ds_read_b64_tr_b16 a[82:83], v20 offset:37120
v_mfma_f32_16x16x32_bf16 v[128:131], a[96:99], a[48:51], v[128:131]
ds_read_b64_tr_b16 a[84:85], v20 offset:38912
v_mfma_f32_16x16x32_bf16 v[112:115], a[96:99], a[40:43], v[112:115]
s_add_u32 m0, s78, 81920
ds_read_b64_tr_b16 a[86:87], v20 offset:39168
v_mfma_f32_16x16x32_bf16 v[112:115], a[100:103], a[44:47], v[112:115]
s_add_u32 s64, s75, 1572864
ds_read_b64_tr_b16 a[88:89], v19 offset:40960
v_mfma_f32_16x16x32_bf16 v[96:99], a[100:103], a[36:39], v[96:99]
buffer_load_dwordx4 v23, s[60:63], s64 offen lds
v_mfma_f32_16x16x32_bf16 v[96:99], a[96:99], a[32:35], v[96:99]
ds_read_b64_tr_b16 a[90:91], v19 offset:41216
v_mfma_f32_16x16x32_bf16 v[36:39], a[104:107], a[32:35], v[36:39]
ds_read_b64_tr_b16 a[92:93], v19 offset:43008
v_mfma_f32_16x16x32_bf16 v[36:39], a[108:111], a[36:39], v[36:39]
ds_read_b64_tr_b16 a[94:95], v19 offset:43264
v_mfma_f32_16x16x32_bf16 v[52:55], a[108:111], a[44:47], v[52:55]
ds_read_b64_tr_b16 a[96:97], v20 offset:40960
v_mfma_f32_16x16x32_bf16 v[52:55], a[104:107], a[40:43], v[52:55]
ds_read_b64_tr_b16 a[98:99], v20 offset:41216
v_mfma_f32_16x16x32_bf16 v[68:71], a[104:107], a[48:51], v[68:71]
s_xor_b32 m0, s77, 66560
ds_read_b64_tr_b16 a[100:101], v20 offset:43008
v_mfma_f32_16x16x32_bf16 v[68:71], a[108:111], a[52:55], v[68:71]
s_xor_b32 s64, s71, 2129920
s_xor_b32 s68, s66, 4096
ds_read_b64_tr_b16 a[102:103], v20 offset:43264
v_mfma_f32_16x16x32_bf16 v[84:87], a[108:111], a[60:63], v[84:87]
s_mov_b64 exec, 1
buffer_atomic_add a251, v1, s[52:55], s68 offen offset:0 sc1
s_mov_b64 exec, -1
v_mfma_f32_16x16x32_bf16 v[84:87], a[104:107], a[56:59], v[84:87]
buffer_load_dwordx4 v14, s[56:59], s64 offen lds
v_mfma_f32_16x16x32_bf16 v[148:151], a[112:115], a[56:59], v[148:151]
ds_read_b64_tr_b16 a[104:105], v19 offset:32768
v_mfma_f32_16x16x32_bf16 v[148:151], a[116:119], a[60:63], v[148:151]
ds_read_b64_tr_b16 a[106:107], v19 offset:33024
v_mfma_f32_16x16x32_bf16 v[132:135], a[116:119], a[52:55], v[132:135]
ds_read_b64_tr_b16 a[108:109], v19 offset:34816
v_mfma_f32_16x16x32_bf16 v[132:135], a[112:115], a[48:51], v[132:135]
ds_read_b64_tr_b16 a[110:111], v19 offset:35072
v_mfma_f32_16x16x32_bf16 v[116:119], a[112:115], a[40:43], v[116:119]
v_mfma_f32_16x16x32_bf16 v[116:119], a[116:119], a[44:47], v[116:119]
v_mfma_f32_16x16x32_bf16 v[100:103], a[116:119], a[36:39], v[100:103]
s_add_u32 m0, s78, 86016
v_mfma_f32_16x16x32_bf16 v[100:103], a[112:115], a[32:35], v[100:103]
s_waitcnt lgkmcnt(4)
s_add_u32 s64, s75, 1574912
ds_read_b64_tr_b16 a[112:113], v20 offset:32768
v_mfma_f32_16x16x32_bf16 v[184:187], a[72:75], a[0:3], v[184:187]
buffer_load_dwordx4 v23, s[60:63], s64 offen lds
v_mfma_f32_16x16x32_bf16 v[184:187], a[76:79], a[4:7], v[184:187]
ds_read_b64_tr_b16 a[114:115], v20 offset:33024
v_mfma_f32_16x16x32_bf16 v[192:195], a[76:79], a[12:15], v[192:195]
ds_read_b64_tr_b16 a[116:117], v20 offset:34816
v_mfma_f32_16x16x32_bf16 v[192:195], a[72:75], a[8:11], v[192:195]
ds_read_b64_tr_b16 a[118:119], v20 offset:35072
v_mfma_f32_16x16x32_bf16 v[200:203], a[72:75], a[16:19], v[200:203]
v_mfma_f32_16x16x32_bf16 v[200:203], a[76:79], a[20:23], v[200:203]
v_mfma_f32_16x16x32_bf16 v[208:211], a[76:79], a[28:31], v[208:211]
v_mfma_f32_16x16x32_bf16 v[208:211], a[72:75], a[24:27], v[208:211]
ds_read_b64_tr_b16 a[72:73], v4 offset:32768
v_mfma_f32_16x16x32_bf16 v[212:215], a[80:83], a[24:27], v[212:215]
s_xor_b32 m0, s77, 67584
ds_read_b64_tr_b16 a[74:75], v4 offset:33792
v_mfma_f32_16x16x32_bf16 v[212:215], a[84:87], a[28:31], v[212:215]
s_xor_b32 s64, s71, 2162688
ds_read_b64_tr_b16 a[76:77], v4 offset:40960
v_mfma_f32_16x16x32_bf16 v[204:207], a[84:87], a[20:23], v[204:207]
buffer_load_dwordx4 v15, s[56:59], s64 offen lds
v_mfma_f32_16x16x32_bf16 v[204:207], a[80:83], a[16:19], v[204:207]
ds_read_b64_tr_b16 a[78:79], v4 offset:41984
v_mfma_f32_16x16x32_bf16 v[196:199], a[80:83], a[8:11], v[196:199]
v_mfma_f32_16x16x32_bf16 v[196:199], a[84:87], a[12:15], v[196:199]
v_mfma_f32_16x16x32_bf16 v[188:191], a[84:87], a[4:7], v[188:191]
v_mfma_f32_16x16x32_bf16 v[188:191], a[80:83], a[0:3], v[188:191]
ds_read_b64_tr_b16 a[80:81], v5 offset:32768
v_mfma_f32_16x16x32_bf16 v[216:219], a[0:3], a[88:91], v[216:219]
ds_read_b64_tr_b16 a[82:83], v5 offset:33792
v_mfma_f32_16x16x32_bf16 v[216:219], a[4:7], a[92:95], v[216:219]
s_add_u32 m0, s78, 90112
s_add_u32 s65, s79, 17408
ds_read_b64_tr_b16 a[84:85], v5 offset:40960
v_mfma_f32_16x16x32_bf16 v[224:227], a[12:15], a[92:95], v[224:227]
s_add_u32 s64, s75, 1576960
buffer_store_dwordx4 a[156:159], v16, s[44:47], s65 offen sc1
v_mfma_f32_16x16x32_bf16 v[224:227], a[8:11], a[88:91], v[224:227]
buffer_load_dwordx4 v23, s[60:63], s64 offen lds
v_mfma_f32_16x16x32_bf16 v[232:235], a[16:19], a[88:91], v[232:235]
ds_read_b64_tr_b16 a[86:87], v5 offset:41984
v_mfma_f32_16x16x32_bf16 v[232:235], a[20:23], a[92:95], v[232:235]
v_mfma_f32_16x16x32_bf16 v[240:243], a[28:31], a[92:95], v[240:243]
v_mfma_f32_16x16x32_bf16 v[240:243], a[24:27], a[88:91], v[240:243]
ds_read_b64_tr_b16 a[88:89], v6 offset:32768
v_mfma_f32_16x16x32_bf16 v[244:247], a[24:27], a[96:99], v[244:247]
ds_read_b64_tr_b16 a[90:91], v6 offset:33792
v_mfma_f32_16x16x32_bf16 v[244:247], a[28:31], a[100:103], v[244:247]
ds_read_b64_tr_b16 a[92:93], v6 offset:40960
v_add_u32 v19, 0x8000, v19
v_mfma_f32_16x16x32_bf16 v[236:239], a[20:23], a[100:103], v[236:239]
s_xor_b32 m0, s77, 68608
ds_read_b64_tr_b16 a[94:95], v6 offset:41984
v_mfma_f32_16x16x32_bf16 v[236:239], a[16:19], a[96:99], v[236:239]
s_xor_b32 s64, s71, 2195456
v_mfma_f32_16x16x32_bf16 v[228:231], a[8:11], a[96:99], v[228:231]
buffer_load_dwordx4 v15, s[56:59], s64 offen lds
v_mfma_f32_16x16x32_bf16 v[228:231], a[12:15], a[100:103], v[228:231]
v_mfma_f32_16x16x32_bf16 v[220:223], a[4:7], a[100:103], v[220:223]
v_mfma_f32_16x16x32_bf16 v[220:223], a[0:3], a[96:99], v[220:223]
s_waitcnt lgkmcnt(4)
ds_read_b64_tr_b16 a[96:97], v7 offset:32768
v_mfma_f32_16x16x32_bf16 v[152:155], a[104:107], a[0:3], v[152:155]
ds_read_b64_tr_b16 a[98:99], v7 offset:33792
v_mfma_f32_16x16x32_bf16 v[152:155], a[108:111], a[4:7], v[152:155]
ds_read_b64_tr_b16 a[100:101], v7 offset:40960
v_add_u32 v20, 0x8000, v20
v_mfma_f32_16x16x32_bf16 v[160:163], a[108:111], a[12:15], v[160:163]
ds_read_b64_tr_b16 a[102:103], v7 offset:41984
v_mfma_f32_16x16x32_bf16 v[160:163], a[104:107], a[8:11], v[160:163]
v_mfma_f32_16x16x32_bf16 v[168:171], a[104:107], a[16:19], v[168:171]
v_mfma_f32_16x16x32_bf16 v[168:171], a[108:111], a[20:23], v[168:171]
v_mfma_f32_16x16x32_bf16 v[176:179], a[108:111], a[28:31], v[176:179]
s_xor_b32 m0, s84, 0
v_mfma_f32_16x16x32_bf16 v[176:179], a[104:107], a[24:27], v[176:179]
s_xor_b32 s64, s72, 512
ds_read_b64_tr_b16 a[104:105], v8 offset:32768
v_mfma_f32_16x16x32_bf16 v[180:183], a[112:115], a[24:27], v[180:183]
buffer_load_dwordx4 v12, s[48:51], s64 offen lds
v_mfma_f32_16x16x32_bf16 v[180:183], a[116:119], a[28:31], v[180:183]
ds_read_b64_tr_b16 a[106:107], v8 offset:33792
v_add_u32 v4, 0x8000, v4
v_mfma_f32_16x16x32_bf16 v[172:175], a[116:119], a[20:23], v[172:175]
ds_read_b64_tr_b16 a[108:109], v8 offset:40960
v_mfma_f32_16x16x32_bf16 v[172:175], a[112:115], a[16:19], v[172:175]
s_xor_b32 m0, s84, 1024
ds_read_b64_tr_b16 a[110:111], v8 offset:41984
v_mfma_f32_16x16x32_bf16 v[164:167], a[112:115], a[8:11], v[164:167]
s_xor_b32 s64, s72, 16896
v_mfma_f32_16x16x32_bf16 v[164:167], a[116:119], a[12:15], v[164:167]
buffer_load_dwordx4 v13, s[48:51], s64 offen lds
v_mfma_f32_16x16x32_bf16 v[156:159], a[116:119], a[4:7], v[156:159]
v_mfma_f32_16x16x32_bf16 v[156:159], a[112:115], a[0:3], v[156:159]
ds_read_b64_tr_b16 a[112:113], v9 offset:32768
v_mfma_f32_16x16x32_bf16 v[24:27], a[72:75], a[0:3], v[24:27]
s_xor_b32 m0, s84, 2048
ds_read_b64_tr_b16 a[114:115], v9 offset:33792
v_mfma_f32_16x16x32_bf16 v[24:27], a[76:79], a[4:7], v[24:27]
s_xor_b32 s64, s72, 131584
ds_read_b64_tr_b16 a[116:117], v9 offset:40960
v_add_u32 v5, 0x8000, v5
v_mfma_f32_16x16x32_bf16 v[40:43], a[76:79], a[12:15], v[40:43]
buffer_load_dwordx4 v12, s[48:51], s64 offen lds
v_mfma_f32_16x16x32_bf16 v[40:43], a[72:75], a[8:11], v[40:43]
ds_read_b64_tr_b16 a[118:119], v9 offset:41984
v_mfma_f32_16x16x32_bf16 v[56:59], a[72:75], a[16:19], v[56:59]
v_mfma_f32_16x16x32_bf16 v[56:59], a[76:79], a[20:23], v[56:59]
s_xor_b32 m0, s84, 3072
v_mfma_f32_16x16x32_bf16 v[72:75], a[76:79], a[28:31], v[72:75]
s_waitcnt vmcnt(13)
s_xor_b32 s64, s72, 147968
ds_read_b128 a[32:35], v2 offset:32768
v_mfma_f32_16x16x32_bf16 v[72:75], a[72:75], a[24:27], v[72:75]
buffer_load_dwordx4 v13, s[48:51], s64 offen lds
v_mfma_f32_16x16x32_bf16 v[136:139], a[80:83], a[24:27], v[136:139]
ds_read_b128 a[36:39], v3 offset:32768
v_mfma_f32_16x16x32_bf16 v[136:139], a[84:87], a[28:31], v[136:139]
ds_read_b128 a[40:43], v2 offset:34816
v_add_u32 v6, 0x8000, v6
v_mfma_f32_16x16x32_bf16 v[120:123], a[84:87], a[20:23], v[120:123]
s_xor_b32 m0, s84, 4096
ds_read_b128 a[44:47], v3 offset:34816
v_mfma_f32_16x16x32_bf16 v[120:123], a[80:83], a[16:19], v[120:123]
s_xor_b32 s64, s73, 512
ds_read_b128 a[48:51], v2 offset:36864
v_mfma_f32_16x16x32_bf16 v[104:107], a[80:83], a[8:11], v[104:107]
buffer_load_dwordx4 v12, s[48:51], s64 offen lds
v_mfma_f32_16x16x32_bf16 v[104:107], a[84:87], a[12:15], v[104:107]
ds_read_b128 a[52:55], v3 offset:36864
v_mfma_f32_16x16x32_bf16 v[88:91], a[84:87], a[4:7], v[88:91]
s_add_u32 s65, s79, 5120
ds_read_b128 a[56:59], v2 offset:38912
v_mfma_f32_16x16x32_bf16 v[88:91], a[80:83], a[0:3], v[88:91]
s_waitcnt lgkmcnt(7)
s_xor_b32 m0, s84, 5120
buffer_store_dwordx4 a[160:163], v16, s[44:47], s65 offen sc1
v_mfma_f32_16x16x32_bf16 v[28:31], a[88:91], a[0:3], v[28:31]
s_xor_b32 s64, s73, 16896
ds_read_b128 a[60:63], v3 offset:38912
v_mfma_f32_16x16x32_bf16 v[28:31], a[92:95], a[4:7], v[28:31]
buffer_load_dwordx4 v13, s[48:51], s64 offen lds
v_mfma_f32_16x16x32_bf16 v[44:47], a[92:95], a[12:15], v[44:47]
ds_read_b64_tr_b16 a[72:73], v10 offset:32768
v_add_u32 v7, 0x8000, v7
v_mfma_f32_16x16x32_bf16 v[44:47], a[88:91], a[8:11], v[44:47]
ds_read_b64_tr_b16 a[74:75], v10 offset:33792
v_mfma_f32_16x16x32_bf16 v[60:63], a[88:91], a[16:19], v[60:63]
s_xor_b32 m0, s84, 6144
ds_read_b64_tr_b16 a[76:77], v10 offset:40960
v_mfma_f32_16x16x32_bf16 v[60:63], a[92:95], a[20:23], v[60:63]
s_xor_b32 s64, s73, 131584
ds_read_b64_tr_b16 a[78:79], v10 offset:41984
v_mfma_f32_16x16x32_bf16 v[76:79], a[92:95], a[28:31], v[76:79]
buffer_load_dwordx4 v12, s[48:51], s64 offen lds
v_mfma_f32_16x16x32_bf16 v[76:79], a[88:91], a[24:27], v[76:79]
ds_read_b64_tr_b16 a[80:81], v11 offset:32768
v_mfma_f32_16x16x32_bf16 v[140:143], a[96:99], a[24:27], v[140:143]
ds_read_b64_tr_b16 a[82:83], v11 offset:33792
v_mfma_f32_16x16x32_bf16 v[140:143], a[100:103], a[28:31], v[140:143]
s_xor_b32 m0, s84, 7168
ds_read_b64_tr_b16 a[84:85], v11 offset:40960
v_add_u32 v8, 0x8000, v8
v_mfma_f32_16x16x32_bf16 v[124:127], a[100:103], a[20:23], v[124:127]
s_xor_b32 s64, s73, 147968
ds_read_b64_tr_b16 a[86:87], v11 offset:41984
v_mfma_f32_16x16x32_bf16 v[124:127], a[96:99], a[16:19], v[124:127]
buffer_load_dwordx4 v13, s[48:51], s64 offen lds
v_mfma_f32_16x16x32_bf16 v[108:111], a[96:99], a[8:11], v[108:111]
v_mfma_f32_16x16x32_bf16 v[108:111], a[100:103], a[12:15], v[108:111]
v_mfma_f32_16x16x32_bf16 v[92:95], a[100:103], a[4:7], v[92:95]
v_add_u32 v9, 0x8000, v9
v_add_u32 v10, 0x8000, v10
v_mfma_f32_16x16x32_bf16 v[92:95], a[96:99], a[0:3], v[92:95]
v_add_u32 v11, 0x8000, v11
v_mfma_f32_16x16x32_bf16 v[32:35], a[104:107], a[0:3], v[32:35]
v_mfma_f32_16x16x32_bf16 v[32:35], a[108:111], a[4:7], v[32:35]
v_mfma_f32_16x16x32_bf16 v[48:51], a[108:111], a[12:15], v[48:51]
s_waitcnt lgkmcnt(0)
s_barrier
v_mfma_f32_16x16x32_bf16 v[48:51], a[104:107], a[8:11], v[48:51]
s_xor_b32 m0, s77, 98304
ds_read_b64_tr_b16 a[88:89], v19 offset:36864
v_mfma_f32_16x16x32_bf16 v[64:67], a[104:107], a[16:19], v[64:67]
s_xor_b32 s64, s71, 2621440
ds_read_b64_tr_b16 a[90:91], v19 offset:37120
v_mfma_f32_16x16x32_bf16 v[64:67], a[108:111], a[20:23], v[64:67]
buffer_load_dwordx4 v14, s[56:59], s64 offen lds
v_mfma_f32_16x16x32_bf16 v[80:83], a[108:111], a[28:31], v[80:83]
ds_read_b64_tr_b16 a[92:93], v19 offset:38912
v_mfma_f32_16x16x32_bf16 v[80:83], a[104:107], a[24:27], v[80:83]
ds_read_b64_tr_b16 a[94:95], v19 offset:39168
v_mfma_f32_16x16x32_bf16 v[144:147], a[112:115], a[24:27], v[144:147]
ds_read_b64_tr_b16 a[96:97], v20 offset:36864
v_mfma_f32_16x16x32_bf16 v[144:147], a[116:119], a[28:31], v[144:147]
ds_read_b64_tr_b16 a[98:99], v20 offset:37120
v_mfma_f32_16x16x32_bf16 v[128:131], a[116:119], a[20:23], v[128:131]
ds_read_b64_tr_b16 a[100:101], v20 offset:38912
v_mfma_f32_16x16x32_bf16 v[128:131], a[112:115], a[16:19], v[128:131]
ds_read_b64_tr_b16 a[102:103], v20 offset:39168
v_mfma_f32_16x16x32_bf16 v[112:115], a[112:115], a[8:11], v[112:115]
s_add_u32 m0, s78, 114688
ds_read_b64_tr_b16 a[104:105], v19 offset:40960
v_mfma_f32_16x16x32_bf16 v[112:115], a[116:119], a[12:15], v[112:115]
s_add_u32 s64, s75, 1966080
ds_read_b64_tr_b16 a[106:107], v19 offset:41216
v_mfma_f32_16x16x32_bf16 v[96:99], a[116:119], a[4:7], v[96:99]
buffer_load_dwordx4 v23, s[60:63], s64 offen lds
v_mfma_f32_16x16x32_bf16 v[96:99], a[112:115], a[0:3], v[96:99]
ds_read_b64_tr_b16 a[108:109], v19 offset:43008
v_mfma_f32_16x16x32_bf16 v[36:39], a[72:75], a[0:3], v[36:39]
ds_read_b64_tr_b16 a[110:111], v19 offset:43264
v_mfma_f32_16x16x32_bf16 v[36:39], a[76:79], a[4:7], v[36:39]
ds_read_b64_tr_b16 a[112:113], v20 offset:40960
v_mfma_f32_16x16x32_bf16 v[52:55], a[76:79], a[12:15], v[52:55]
ds_read_b64_tr_b16 a[114:115], v20 offset:41216
v_mfma_f32_16x16x32_bf16 v[52:55], a[72:75], a[8:11], v[52:55]
ds_read_b64_tr_b16 a[116:117], v20 offset:43008
v_mfma_f32_16x16x32_bf16 v[68:71], a[72:75], a[16:19], v[68:71]
s_xor_b32 m0, s77, 99328
ds_read_b64_tr_b16 a[118:119], v20 offset:43264
v_mfma_f32_16x16x32_bf16 v[68:71], a[76:79], a[20:23], v[68:71]
s_xor_b32 s64, s71, 2654208
s_xor_b32 s68, s66, 8192
v_mfma_f32_16x16x32_bf16 v[84:87], a[76:79], a[28:31], v[84:87]
s_mov_b64 exec, 1
buffer_atomic_add a251, v1, s[52:55], s68 offen offset:0 sc1
s_mov_b64 exec, -1
v_mfma_f32_16x16x32_bf16 v[84:87], a[72:75], a[24:27], v[84:87]
buffer_load_dwordx4 v14, s[56:59], s64 offen lds
v_mfma_f32_16x16x32_bf16 v[148:151], a[80:83], a[24:27], v[148:151]
ds_read_b64_tr_b16 a[72:73], v19 offset:32768
v_mfma_f32_16x16x32_bf16 v[148:151], a[84:87], a[28:31], v[148:151]
ds_read_b64_tr_b16 a[74:75], v19 offset:33024
v_mfma_f32_16x16x32_bf16 v[132:135], a[84:87], a[20:23], v[132:135]
s_add_u32 s65, s79, 1024
ds_read_b64_tr_b16 a[76:77], v19 offset:34816
v_mfma_f32_16x16x32_bf16 v[132:135], a[80:83], a[16:19], v[132:135]
buffer_store_dwordx4 a[164:167], v16, s[44:47], s65 offen sc1
v_mfma_f32_16x16x32_bf16 v[116:119], a[80:83], a[8:11], v[116:119]
ds_read_b64_tr_b16 a[78:79], v19 offset:35072
v_mfma_f32_16x16x32_bf16 v[116:119], a[84:87], a[12:15], v[116:119]
v_mfma_f32_16x16x32_bf16 v[100:103], a[84:87], a[4:7], v[100:103]
s_add_u32 m0, s78, 118784
v_mfma_f32_16x16x32_bf16 v[100:103], a[80:83], a[0:3], v[100:103]
s_waitcnt lgkmcnt(4)
s_add_u32 s64, s75, 1968128
ds_read_b64_tr_b16 a[80:81], v20 offset:32768
v_mfma_f32_16x16x32_bf16 v[184:187], a[88:91], a[32:35], v[184:187]
buffer_load_dwordx4 v23, s[60:63], s64 offen lds
v_mfma_f32_16x16x32_bf16 v[184:187], a[92:95], a[36:39], v[184:187]
ds_read_b64_tr_b16 a[82:83], v20 offset:33024
v_mfma_f32_16x16x32_bf16 v[192:195], a[92:95], a[44:47], v[192:195]
ds_read_b64_tr_b16 a[84:85], v20 offset:34816
v_mfma_f32_16x16x32_bf16 v[192:195], a[88:91], a[40:43], v[192:195]
ds_read_b64_tr_b16 a[86:87], v20 offset:35072
v_mfma_f32_16x16x32_bf16 v[200:203], a[88:91], a[48:51], v[200:203]
v_mfma_f32_16x16x32_bf16 v[200:203], a[92:95], a[52:55], v[200:203]
v_mfma_f32_16x16x32_bf16 v[208:211], a[92:95], a[60:63], v[208:211]
v_mfma_f32_16x16x32_bf16 v[208:211], a[88:91], a[56:59], v[208:211]
ds_read_b64_tr_b16 a[88:89], v4 offset:32768
v_mfma_f32_16x16x32_bf16 v[212:215], a[96:99], a[56:59], v[212:215]
s_xor_b32 m0, s77, 100352
ds_read_b64_tr_b16 a[90:91], v4 offset:33792
v_mfma_f32_16x16x32_bf16 v[212:215], a[100:103], a[60:63], v[212:215]
s_xor_b32 s64, s71, 2686976
ds_read_b64_tr_b16 a[92:93], v4 offset:40960
v_mfma_f32_16x16x32_bf16 v[204:207], a[100:103], a[52:55], v[204:207]
buffer_load_dwordx4 v15, s[56:59], s64 offen lds
v_mfma_f32_16x16x32_bf16 v[204:207], a[96:99], a[48:51], v[204:207]
ds_read_b64_tr_b16 a[94:95], v4 offset:41984
v_mfma_f32_16x16x32_bf16 v[196:199], a[96:99], a[40:43], v[196:199]
v_mfma_f32_16x16x32_bf16 v[196:199], a[100:103], a[44:47], v[196:199]
v_mfma_f32_16x16x32_bf16 v[188:191], a[100:103], a[36:39], v[188:191]
v_mfma_f32_16x16x32_bf16 v[188:191], a[96:99], a[32:35], v[188:191]
ds_read_b64_tr_b16 a[96:97], v5 offset:32768
v_mfma_f32_16x16x32_bf16 v[216:219], a[32:35], a[104:107], v[216:219]
ds_read_b64_tr_b16 a[98:99], v5 offset:33792
v_mfma_f32_16x16x32_bf16 v[216:219], a[36:39], a[108:111], v[216:219]
s_add_u32 m0, s78, 122880
ds_read_b64_tr_b16 a[100:101], v5 offset:40960
v_mfma_f32_16x16x32_bf16 v[224:227], a[44:47], a[108:111], v[224:227]
s_add_u32 s64, s75, 1970176
ds_read_b64_tr_b16 a[102:103], v5 offset:41984
v_mfma_f32_16x16x32_bf16 v[224:227], a[40:43], a[104:107], v[224:227]
buffer_load_dwordx4 v23, s[60:63], s64 offen lds
v_mfma_f32_16x16x32_bf16 v[232:235], a[48:51], a[104:107], v[232:235]
v_mfma_f32_16x16x32_bf16 v[232:235], a[52:55], a[108:111], v[232:235]
v_mfma_f32_16x16x32_bf16 v[240:243], a[60:63], a[108:111], v[240:243]
v_mfma_f32_16x16x32_bf16 v[240:243], a[56:59], a[104:107], v[240:243]
ds_read_b64_tr_b16 a[104:105], v6 offset:32768
v_mfma_f32_16x16x32_bf16 v[244:247], a[56:59], a[112:115], v[244:247]
ds_read_b64_tr_b16 a[106:107], v6 offset:33792
v_mfma_f32_16x16x32_bf16 v[244:247], a[60:63], a[116:119], v[244:247]
ds_read_b64_tr_b16 a[108:109], v6 offset:40960
v_subrev_u32 v19, 0x8000, v19
v_mfma_f32_16x16x32_bf16 v[236:239], a[52:55], a[116:119], v[236:239]
s_xor_b32 m0, s77, 101376
ds_read_b64_tr_b16 a[110:111], v6 offset:41984
v_mfma_f32_16x16x32_bf16 v[236:239], a[48:51], a[112:115], v[236:239]
s_xor_b32 s64, s71, 2719744
v_mfma_f32_16x16x32_bf16 v[228:231], a[40:43], a[112:115], v[228:231]
buffer_load_dwordx4 v15, s[56:59], s64 offen lds
v_mfma_f32_16x16x32_bf16 v[228:231], a[44:47], a[116:119], v[228:231]
v_mfma_f32_16x16x32_bf16 v[220:223], a[36:39], a[116:119], v[220:223]
v_mfma_f32_16x16x32_bf16 v[220:223], a[32:35], a[112:115], v[220:223]
s_waitcnt lgkmcnt(4)
ds_read_b64_tr_b16 a[112:113], v7 offset:32768
v_mfma_f32_16x16x32_bf16 v[152:155], a[72:75], a[32:35], v[152:155]
ds_read_b64_tr_b16 a[114:115], v7 offset:33792
v_mfma_f32_16x16x32_bf16 v[152:155], a[76:79], a[36:39], v[152:155]
ds_read_b64_tr_b16 a[116:117], v7 offset:40960
v_subrev_u32 v20, 0x8000, v20
v_mfma_f32_16x16x32_bf16 v[160:163], a[76:79], a[44:47], v[160:163]
ds_read_b64_tr_b16 a[118:119], v7 offset:41984
v_mfma_f32_16x16x32_bf16 v[160:163], a[72:75], a[40:43], v[160:163]
v_mfma_f32_16x16x32_bf16 v[168:171], a[72:75], a[48:51], v[168:171]
v_mfma_f32_16x16x32_bf16 v[168:171], a[76:79], a[52:55], v[168:171]
v_mfma_f32_16x16x32_bf16 v[176:179], a[76:79], a[60:63], v[176:179]
s_xor_b32 m0, s84, 32768
v_mfma_f32_16x16x32_bf16 v[176:179], a[72:75], a[56:59], v[176:179]
s_xor_b32 s64, s72, 640
ds_read_b64_tr_b16 a[72:73], v8 offset:32768
v_mfma_f32_16x16x32_bf16 v[180:183], a[80:83], a[56:59], v[180:183]
s_add_u32 s65, s79, 18432
buffer_load_dwordx4 v12, s[48:51], s64 offen lds
v_mfma_f32_16x16x32_bf16 v[180:183], a[84:87], a[60:63], v[180:183]
buffer_store_dwordx4 a[168:171], v16, s[44:47], s65 offen sc1
v_mfma_f32_16x16x32_bf16 v[172:175], a[84:87], a[52:55], v[172:175]
ds_read_b64_tr_b16 a[74:75], v8 offset:33792
v_subrev_u32 v4, 0x8000, v4
v_mfma_f32_16x16x32_bf16 v[172:175], a[80:83], a[48:51], v[172:175]
s_xor_b32 m0, s84, 33792
ds_read_b64_tr_b16 a[76:77], v8 offset:40960
v_mfma_f32_16x16x32_bf16 v[164:167], a[80:83], a[40:43], v[164:167]
s_xor_b32 s64, s72, 17024
ds_read_b64_tr_b16 a[78:79], v8 offset:41984
v_mfma_f32_16x16x32_bf16 v[164:167], a[84:87], a[44:47], v[164:167]
buffer_load_dwordx4 v13, s[48:51], s64 offen lds
v_mfma_f32_16x16x32_bf16 v[156:159], a[84:87], a[36:39], v[156:159]
v_mfma_f32_16x16x32_bf16 v[156:159], a[80:83], a[32:35], v[156:159]
ds_read_b64_tr_b16 a[80:81], v9 offset:32768
v_mfma_f32_16x16x32_bf16 v[24:27], a[88:91], a[32:35], v[24:27]
s_xor_b32 m0, s84, 34816
ds_read_b64_tr_b16 a[82:83], v9 offset:33792
v_mfma_f32_16x16x32_bf16 v[24:27], a[92:95], a[36:39], v[24:27]
s_xor_b32 s64, s72, 131712
ds_read_b64_tr_b16 a[84:85], v9 offset:40960
v_subrev_u32 v5, 0x8000, v5
v_mfma_f32_16x16x32_bf16 v[40:43], a[92:95], a[44:47], v[40:43]
buffer_load_dwordx4 v12, s[48:51], s64 offen lds
v_mfma_f32_16x16x32_bf16 v[40:43], a[88:91], a[40:43], v[40:43]
ds_read_b64_tr_b16 a[86:87], v9 offset:41984
v_mfma_f32_16x16x32_bf16 v[56:59], a[88:91], a[48:51], v[56:59]
v_mfma_f32_16x16x32_bf16 v[56:59], a[92:95], a[52:55], v[56:59]
s_xor_b32 m0, s84, 35840
v_mfma_f32_16x16x32_bf16 v[72:75], a[92:95], a[60:63], v[72:75]
s_waitcnt vmcnt(13)
s_xor_b32 s64, s72, 148096
ds_read_b128 a[0:3], v2 offset:0
v_mfma_f32_16x16x32_bf16 v[72:75], a[88:91], a[56:59], v[72:75]
buffer_load_dwordx4 v13, s[48:51], s64 offen lds
v_mfma_f32_16x16x32_bf16 v[136:139], a[96:99], a[56:59], v[136:139]
ds_read_b128 a[4:7], v3 offset:0
v_mfma_f32_16x16x32_bf16 v[136:139], a[100:103], a[60:63], v[136:139]
ds_read_b128 a[8:11], v2 offset:2048
v_subrev_u32 v6, 0x8000, v6
v_mfma_f32_16x16x32_bf16 v[120:123], a[100:103], a[52:55], v[120:123]
s_xor_b32 m0, s84, 36864
ds_read_b128 a[12:15], v3 offset:2048
v_mfma_f32_16x16x32_bf16 v[120:123], a[96:99], a[48:51], v[120:123]
s_xor_b32 s64, s73, 640
ds_read_b128 a[16:19], v2 offset:4096
v_mfma_f32_16x16x32_bf16 v[104:107], a[96:99], a[40:43], v[104:107]
buffer_load_dwordx4 v12, s[48:51], s64 offen lds
v_mfma_f32_16x16x32_bf16 v[104:107], a[100:103], a[44:47], v[104:107]
ds_read_b128 a[20:23], v3 offset:4096
v_mfma_f32_16x16x32_bf16 v[88:91], a[100:103], a[36:39], v[88:91]
ds_read_b128 a[24:27], v2 offset:6144
v_mfma_f32_16x16x32_bf16 v[88:91], a[96:99], a[32:35], v[88:91]
s_waitcnt lgkmcnt(7)
s_xor_b32 m0, s84, 37888
ds_read_b128 a[28:31], v3 offset:6144
v_mfma_f32_16x16x32_bf16 v[28:31], a[104:107], a[32:35], v[28:31]
s_xor_b32 s64, s73, 17024
ds_read_b64_tr_b16 a[88:89], v10 offset:32768
v_mfma_f32_16x16x32_bf16 v[28:31], a[108:111], a[36:39], v[28:31]
buffer_load_dwordx4 v13, s[48:51], s64 offen lds
v_mfma_f32_16x16x32_bf16 v[44:47], a[108:111], a[44:47], v[44:47]
ds_read_b64_tr_b16 a[90:91], v10 offset:33792
v_subrev_u32 v7, 0x8000, v7
v_mfma_f32_16x16x32_bf16 v[44:47], a[104:107], a[40:43], v[44:47]
ds_read_b64_tr_b16 a[92:93], v10 offset:40960
v_mfma_f32_16x16x32_bf16 v[60:63], a[104:107], a[48:51], v[60:63]
s_xor_b32 m0, s84, 38912
ds_read_b64_tr_b16 a[94:95], v10 offset:41984
v_mfma_f32_16x16x32_bf16 v[60:63], a[108:111], a[52:55], v[60:63]
s_xor_b32 s64, s73, 131712
ds_read_b64_tr_b16 a[96:97], v11 offset:32768
v_mfma_f32_16x16x32_bf16 v[76:79], a[108:111], a[60:63], v[76:79]
buffer_load_dwordx4 v12, s[48:51], s64 offen lds
v_mfma_f32_16x16x32_bf16 v[76:79], a[104:107], a[56:59], v[76:79]
ds_read_b64_tr_b16 a[98:99], v11 offset:33792
v_mfma_f32_16x16x32_bf16 v[140:143], a[112:115], a[56:59], v[140:143]
ds_read_b64_tr_b16 a[100:101], v11 offset:40960
v_mfma_f32_16x16x32_bf16 v[140:143], a[116:119], a[60:63], v[140:143]
s_xor_b32 m0, s84, 39936
ds_read_b64_tr_b16 a[102:103], v11 offset:41984
v_subrev_u32 v8, 0x8000, v8
v_mfma_f32_16x16x32_bf16 v[124:127], a[116:119], a[52:55], v[124:127]
s_xor_b32 s64, s73, 148096
v_mfma_f32_16x16x32_bf16 v[124:127], a[112:115], a[48:51], v[124:127]
buffer_load_dwordx4 v13, s[48:51], s64 offen lds
v_mfma_f32_16x16x32_bf16 v[108:111], a[112:115], a[40:43], v[108:111]
v_mfma_f32_16x16x32_bf16 v[108:111], a[116:119], a[44:47], v[108:111]
v_mfma_f32_16x16x32_bf16 v[92:95], a[116:119], a[36:39], v[92:95]
v_subrev_u32 v9, 0x8000, v9
v_subrev_u32 v10, 0x8000, v10
v_mfma_f32_16x16x32_bf16 v[92:95], a[112:115], a[32:35], v[92:95]
v_subrev_u32 v11, 0x8000, v11
v_mfma_f32_16x16x32_bf16 v[32:35], a[72:75], a[32:35], v[32:35]
v_mfma_f32_16x16x32_bf16 v[32:35], a[76:79], a[36:39], v[32:35]
v_mfma_f32_16x16x32_bf16 v[48:51], a[76:79], a[44:47], v[48:51]
s_waitcnt lgkmcnt(0)
s_barrier
v_mfma_f32_16x16x32_bf16 v[48:51], a[72:75], a[40:43], v[48:51]
s_xor_b32 m0, s77, 131072
ds_read_b64_tr_b16 a[104:105], v19 offset:4096
v_mfma_f32_16x16x32_bf16 v[64:67], a[72:75], a[48:51], v[64:67]
s_xor_b32 s64, s71, 3145728
ds_read_b64_tr_b16 a[106:107], v19 offset:4352
v_mfma_f32_16x16x32_bf16 v[64:67], a[76:79], a[52:55], v[64:67]
s_add_u32 s65, s79, 6144
buffer_load_dwordx4 v14, s[56:59], s64 offen lds
v_mfma_f32_16x16x32_bf16 v[80:83], a[76:79], a[60:63], v[80:83]
buffer_store_dwordx4 a[172:175], v16, s[44:47], s65 offen sc1
v_mfma_f32_16x16x32_bf16 v[80:83], a[72:75], a[56:59], v[80:83]
ds_read_b64_tr_b16 a[108:109], v19 offset:6144
v_mfma_f32_16x16x32_bf16 v[144:147], a[80:83], a[56:59], v[144:147]
ds_read_b64_tr_b16 a[110:111], v19 offset:6400
v_mfma_f32_16x16x32_bf16 v[144:147], a[84:87], a[60:63], v[144:147]
ds_read_b64_tr_b16 a[112:113], v20 offset:4096
v_mfma_f32_16x16x32_bf16 v[128:131], a[84:87], a[52:55], v[128:131]
ds_read_b64_tr_b16 a[114:115], v20 offset:4352
v_mfma_f32_16x16x32_bf16 v[128:131], a[80:83], a[48:51], v[128:131]
ds_read_b64_tr_b16 a[116:117], v20 offset:6144
v_mfma_f32_16x16x32_bf16 v[112:115], a[80:83], a[40:43], v[112:115]
s_add_u32 m0, s78, 147456
ds_read_b64_tr_b16 a[118:119], v20 offset:6400
v_mfma_f32_16x16x32_bf16 v[112:115], a[84:87], a[44:47], v[112:115]
s_add_u32 s64, s75, 2359296
ds_read_b64_tr_b16 a[72:73], v19 offset:8192
v_mfma_f32_16x16x32_bf16 v[96:99], a[84:87], a[36:39], v[96:99]
s_branch L_po8
L_pg8:
s_branch L_pg12
L_po8:
buffer_load_dwordx4 v23, s[60:63], s64 offen lds
v_mfma_f32_16x16x32_bf16 v[96:99], a[80:83], a[32:35], v[96:99]
ds_read_b64_tr_b16 a[74:75], v19 offset:8448
v_mfma_f32_16x16x32_bf16 v[36:39], a[88:91], a[32:35], v[36:39]
ds_read_b64_tr_b16 a[76:77], v19 offset:10240
v_mfma_f32_16x16x32_bf16 v[36:39], a[92:95], a[36:39], v[36:39]
ds_read_b64_tr_b16 a[78:79], v19 offset:10496
v_mfma_f32_16x16x32_bf16 v[52:55], a[92:95], a[44:47], v[52:55]
ds_read_b64_tr_b16 a[80:81], v20 offset:8192
v_mfma_f32_16x16x32_bf16 v[52:55], a[88:91], a[40:43], v[52:55]
ds_read_b64_tr_b16 a[82:83], v20 offset:8448
v_mfma_f32_16x16x32_bf16 v[68:71], a[88:91], a[48:51], v[68:71]
s_xor_b32 m0, s77, 132096
ds_read_b64_tr_b16 a[84:85], v20 offset:10240
v_mfma_f32_16x16x32_bf16 v[68:71], a[92:95], a[52:55], v[68:71]
s_xor_b32 s64, s71, 3178496
s_xor_b32 s68, s66, 12288
ds_read_b64_tr_b16 a[86:87], v20 offset:10496
v_mfma_f32_16x16x32_bf16 v[84:87], a[92:95], a[60:63], v[84:87]
s_mov_b64 exec, 1
buffer_atomic_add a251, v1, s[52:55], s68 offen offset:0 sc1
s_mov_b64 exec, -1
v_mfma_f32_16x16x32_bf16 v[84:87], a[88:91], a[56:59], v[84:87]
buffer_load_dwordx4 v14, s[56:59], s64 offen lds
v_mfma_f32_16x16x32_bf16 v[148:151], a[96:99], a[56:59], v[148:151]
ds_read_b64_tr_b16 a[88:89], v19 offset:0
v_mfma_f32_16x16x32_bf16 v[148:151], a[100:103], a[60:63], v[148:151]
ds_read_b64_tr_b16 a[90:91], v19 offset:256
v_mfma_f32_16x16x32_bf16 v[132:135], a[100:103], a[52:55], v[132:135]
ds_read_b64_tr_b16 a[92:93], v19 offset:2048
v_mfma_f32_16x16x32_bf16 v[132:135], a[96:99], a[48:51], v[132:135]
ds_read_b64_tr_b16 a[94:95], v19 offset:2304
v_mfma_f32_16x16x32_bf16 v[116:119], a[96:99], a[40:43], v[116:119]
v_mfma_f32_16x16x32_bf16 v[116:119], a[100:103], a[44:47], v[116:119]
v_mfma_f32_16x16x32_bf16 v[100:103], a[100:103], a[36:39], v[100:103]
s_add_u32 m0, s78, 151552
v_mfma_f32_16x16x32_bf16 v[100:103], a[96:99], a[32:35], v[100:103]
s_waitcnt lgkmcnt(4)
s_add_u32 s64, s75, 2361344
ds_read_b64_tr_b16 a[96:97], v20 offset:0
v_mfma_f32_16x16x32_bf16 v[184:187], a[104:107], a[0:3], v[184:187]
s_mov_b32 s36, s20
buffer_load_dwordx4 v23, s[60:63], s64 offen lds
v_mfma_f32_16x16x32_bf16 v[184:187], a[108:111], a[4:7], v[184:187]
s_mov_b32 s37, s21
ds_read_b64_tr_b16 a[98:99], v20 offset:256
v_mfma_f32_16x16x32_bf16 v[192:195], a[108:111], a[12:15], v[192:195]
s_mov_b32 s38, 2097152
ds_read_b64_tr_b16 a[100:101], v20 offset:2048
v_mfma_f32_16x16x32_bf16 v[192:195], a[104:107], a[8:11], v[192:195]
s_mov_b32 s40, s14
ds_read_b64_tr_b16 a[102:103], v20 offset:2304
v_mfma_f32_16x16x32_bf16 v[200:203], a[104:107], a[16:19], v[200:203]
s_mov_b32 s41, s15
v_mfma_f32_16x16x32_bf16 v[200:203], a[108:111], a[20:23], v[200:203]
s_mov_b32 s42, 8388608
v_mfma_f32_16x16x32_bf16 v[208:211], a[108:111], a[28:31], v[208:211]
v_mfma_f32_16x16x32_bf16 v[208:211], a[104:107], a[24:27], v[208:211]
ds_read_b64_tr_b16 a[104:105], v4 offset:0
v_mfma_f32_16x16x32_bf16 v[212:215], a[112:115], a[24:27], v[212:215]
s_xor_b32 m0, s77, 133120
ds_read_b64_tr_b16 a[106:107], v4 offset:1024
v_mfma_f32_16x16x32_bf16 v[212:215], a[116:119], a[28:31], v[212:215]
s_xor_b32 s64, s71, 3211264
ds_read_b64_tr_b16 a[108:109], v4 offset:8192
v_mfma_f32_16x16x32_bf16 v[204:207], a[116:119], a[20:23], v[204:207]
buffer_load_dwordx4 v15, s[56:59], s64 offen lds
v_mfma_f32_16x16x32_bf16 v[204:207], a[112:115], a[16:19], v[204:207]
ds_read_b64_tr_b16 a[110:111], v4 offset:9216
v_mfma_f32_16x16x32_bf16 v[196:199], a[112:115], a[8:11], v[196:199]
v_mfma_f32_16x16x32_bf16 v[196:199], a[116:119], a[12:15], v[196:199]
v_mfma_f32_16x16x32_bf16 v[188:191], a[116:119], a[4:7], v[188:191]
v_mfma_f32_16x16x32_bf16 v[188:191], a[112:115], a[0:3], v[188:191]
ds_read_b64_tr_b16 a[112:113], v5 offset:0
v_mfma_f32_16x16x32_bf16 v[216:219], a[0:3], a[72:75], v[216:219]
ds_read_b64_tr_b16 a[114:115], v5 offset:1024
v_mfma_f32_16x16x32_bf16 v[216:219], a[4:7], a[76:79], v[216:219]
s_add_u32 m0, s78, 155648
s_add_u32 s65, s79, 2048
ds_read_b64_tr_b16 a[116:117], v5 offset:8192
v_mfma_f32_16x16x32_bf16 v[224:227], a[12:15], a[76:79], v[224:227]
s_add_u32 s64, s75, 2363392
buffer_store_dwordx4 a[176:179], v16, s[44:47], s65 offen sc1
v_mfma_f32_16x16x32_bf16 v[224:227], a[8:11], a[72:75], v[224:227]
buffer_load_dwordx4 v23, s[60:63], s64 offen lds
v_mfma_f32_16x16x32_bf16 v[232:235], a[16:19], a[72:75], v[232:235]
ds_read_b64_tr_b16 a[118:119], v5 offset:9216
v_mfma_f32_16x16x32_bf16 v[232:235], a[20:23], a[76:79], v[232:235]
v_mfma_f32_16x16x32_bf16 v[240:243], a[28:31], a[76:79], v[240:243]
v_mfma_f32_16x16x32_bf16 v[240:243], a[24:27], a[72:75], v[240:243]
ds_read_b64_tr_b16 a[72:73], v6 offset:0
v_mfma_f32_16x16x32_bf16 v[244:247], a[24:27], a[80:83], v[244:247]
ds_read_b64_tr_b16 a[74:75], v6 offset:1024
v_mfma_f32_16x16x32_bf16 v[244:247], a[28:31], a[84:87], v[244:247]
ds_read_b64_tr_b16 a[76:77], v6 offset:8192
v_mfma_f32_16x16x32_bf16 v[236:239], a[20:23], a[84:87], v[236:239]
s_xor_b32 m0, s77, 134144
ds_read_b64_tr_b16 a[78:79], v6 offset:9216
v_mfma_f32_16x16x32_bf16 v[236:239], a[16:19], a[80:83], v[236:239]
s_xor_b32 s64, s71, 3244032
v_mfma_f32_16x16x32_bf16 v[228:231], a[8:11], a[80:83], v[228:231]
buffer_load_dwordx4 v15, s[56:59], s64 offen lds
v_mfma_f32_16x16x32_bf16 v[228:231], a[12:15], a[84:87], v[228:231]
v_mfma_f32_16x16x32_bf16 v[220:223], a[4:7], a[84:87], v[220:223]
v_mfma_f32_16x16x32_bf16 v[220:223], a[0:3], a[80:83], v[220:223]
s_waitcnt lgkmcnt(4)
ds_read_b64_tr_b16 a[80:81], v7 offset:0
v_mfma_f32_16x16x32_bf16 v[152:155], a[88:91], a[0:3], v[152:155]
ds_read_b64_tr_b16 a[82:83], v7 offset:1024
v_mfma_f32_16x16x32_bf16 v[152:155], a[92:95], a[4:7], v[152:155]
ds_read_b64_tr_b16 a[84:85], v7 offset:8192
v_mfma_f32_16x16x32_bf16 v[160:163], a[92:95], a[12:15], v[160:163]
ds_read_b64_tr_b16 a[86:87], v7 offset:9216
v_mfma_f32_16x16x32_bf16 v[160:163], a[88:91], a[8:11], v[160:163]
v_mfma_f32_16x16x32_bf16 v[168:171], a[88:91], a[16:19], v[168:171]
v_mfma_f32_16x16x32_bf16 v[168:171], a[92:95], a[20:23], v[168:171]
v_mfma_f32_16x16x32_bf16 v[176:179], a[92:95], a[28:31], v[176:179]
s_xor_b32 m0, s84, 0
v_mfma_f32_16x16x32_bf16 v[176:179], a[88:91], a[24:27], v[176:179]
s_xor_b32 s64, s72, 768
ds_read_b64_tr_b16 a[88:89], v8 offset:0
v_mfma_f32_16x16x32_bf16 v[180:183], a[96:99], a[24:27], v[180:183]
buffer_load_dwordx4 v12, s[48:51], s64 offen lds
v_mfma_f32_16x16x32_bf16 v[180:183], a[100:103], a[28:31], v[180:183]
ds_read_b64_tr_b16 a[90:91], v8 offset:1024
v_mfma_f32_16x16x32_bf16 v[172:175], a[100:103], a[20:23], v[172:175]
ds_read_b64_tr_b16 a[92:93], v8 offset:8192
v_mfma_f32_16x16x32_bf16 v[172:175], a[96:99], a[16:19], v[172:175]
s_xor_b32 m0, s84, 1024
ds_read_b64_tr_b16 a[94:95], v8 offset:9216
v_mfma_f32_16x16x32_bf16 v[164:167], a[96:99], a[8:11], v[164:167]
s_xor_b32 s64, s72, 17152
v_mfma_f32_16x16x32_bf16 v[164:167], a[100:103], a[12:15], v[164:167]
buffer_load_dwordx4 v13, s[48:51], s64 offen lds
v_mfma_f32_16x16x32_bf16 v[156:159], a[100:103], a[4:7], v[156:159]
v_mfma_f32_16x16x32_bf16 v[156:159], a[96:99], a[0:3], v[156:159]
ds_read_b64_tr_b16 a[96:97], v9 offset:0
v_mfma_f32_16x16x32_bf16 v[24:27], a[104:107], a[0:3], v[24:27]
s_xor_b32 m0, s84, 2048
ds_read_b64_tr_b16 a[98:99], v9 offset:1024
v_mfma_f32_16x16x32_bf16 v[24:27], a[108:111], a[4:7], v[24:27]
s_xor_b32 s64, s72, 131840
ds_read_b64_tr_b16 a[100:101], v9 offset:8192
v_mfma_f32_16x16x32_bf16 v[40:43], a[108:111], a[12:15], v[40:43]
buffer_load_dwordx4 v12, s[48:51], s64 offen lds
v_mfma_f32_16x16x32_bf16 v[40:43], a[104:107], a[8:11], v[40:43]
ds_read_b64_tr_b16 a[102:103], v9 offset:9216
v_mfma_f32_16x16x32_bf16 v[56:59], a[104:107], a[16:19], v[56:59]
v_mfma_f32_16x16x32_bf16 v[56:59], a[108:111], a[20:23], v[56:59]
s_xor_b32 m0, s84, 3072
v_mfma_f32_16x16x32_bf16 v[72:75], a[108:111], a[28:31], v[72:75]
s_waitcnt vmcnt(13)
s_xor_b32 s64, s72, 148224
ds_read_b128 a[32:35], v2 offset:32768
v_mfma_f32_16x16x32_bf16 v[72:75], a[104:107], a[24:27], v[72:75]
buffer_load_dwordx4 v13, s[48:51], s64 offen lds
v_mfma_f32_16x16x32_bf16 v[136:139], a[112:115], a[24:27], v[136:139]
ds_read_b128 a[36:39], v3 offset:32768
v_mfma_f32_16x16x32_bf16 v[136:139], a[116:119], a[28:31], v[136:139]
ds_read_b128 a[40:43], v2 offset:34816
v_mfma_f32_16x16x32_bf16 v[120:123], a[116:119], a[20:23], v[120:123]
s_xor_b32 m0, s84, 4096
ds_read_b128 a[44:47], v3 offset:34816
v_mfma_f32_16x16x32_bf16 v[120:123], a[112:115], a[16:19], v[120:123]
s_xor_b32 s64, s73, 768
ds_read_b128 a[48:51], v2 offset:36864
v_mfma_f32_16x16x32_bf16 v[104:107], a[112:115], a[8:11], v[104:107]
buffer_load_dwordx4 v12, s[48:51], s64 offen lds
v_mfma_f32_16x16x32_bf16 v[104:107], a[116:119], a[12:15], v[104:107]
s_add_u32 s65, s79, 19456
ds_read_b128 a[52:55], v3 offset:36864
v_mfma_f32_16x16x32_bf16 v[88:91], a[116:119], a[4:7], v[88:91]
buffer_store_dwordx4 a[180:183], v16, s[44:47], s65 offen sc1
v_mfma_f32_16x16x32_bf16 v[88:91], a[112:115], a[0:3], v[88:91]
s_waitcnt lgkmcnt(6)
s_xor_b32 m0, s84, 5120
ds_read_b128 a[56:59], v2 offset:38912
v_mfma_f32_16x16x32_bf16 v[28:31], a[72:75], a[0:3], v[28:31]
s_xor_b32 s64, s73, 17152
ds_read_b128 a[60:63], v3 offset:38912
v_mfma_f32_16x16x32_bf16 v[28:31], a[76:79], a[4:7], v[28:31]
buffer_load_dwordx4 v13, s[48:51], s64 offen lds
v_mfma_f32_16x16x32_bf16 v[44:47], a[76:79], a[12:15], v[44:47]
ds_read_b64_tr_b16 a[104:105], v10 offset:0
v_mfma_f32_16x16x32_bf16 v[44:47], a[72:75], a[8:11], v[44:47]
ds_read_b64_tr_b16 a[106:107], v10 offset:1024
v_mfma_f32_16x16x32_bf16 v[60:63], a[72:75], a[16:19], v[60:63]
s_xor_b32 m0, s84, 6144
ds_read_b64_tr_b16 a[108:109], v10 offset:8192
v_mfma_f32_16x16x32_bf16 v[60:63], a[76:79], a[20:23], v[60:63]
s_xor_b32 s64, s73, 131840
ds_read_b64_tr_b16 a[110:111], v10 offset:9216
v_mfma_f32_16x16x32_bf16 v[76:79], a[76:79], a[28:31], v[76:79]
buffer_load_dwordx4 v12, s[48:51], s64 offen lds
v_mfma_f32_16x16x32_bf16 v[76:79], a[72:75], a[24:27], v[76:79]
ds_read_b64_tr_b16 a[112:113], v11 offset:0
v_mfma_f32_16x16x32_bf16 v[140:143], a[80:83], a[24:27], v[140:143]
ds_read_b64_tr_b16 a[114:115], v11 offset:1024
v_mfma_f32_16x16x32_bf16 v[140:143], a[84:87], a[28:31], v[140:143]
s_xor_b32 m0, s84, 7168
ds_read_b64_tr_b16 a[116:117], v11 offset:8192
v_mfma_f32_16x16x32_bf16 v[124:127], a[84:87], a[20:23], v[124:127]
s_xor_b32 s64, s73, 148224
ds_read_b64_tr_b16 a[118:119], v11 offset:9216
v_mfma_f32_16x16x32_bf16 v[124:127], a[80:83], a[16:19], v[124:127]
buffer_load_dwordx4 v13, s[48:51], s64 offen lds
v_mfma_f32_16x16x32_bf16 v[108:111], a[80:83], a[8:11], v[108:111]
v_mfma_f32_16x16x32_bf16 v[108:111], a[84:87], a[12:15], v[108:111]
v_mfma_f32_16x16x32_bf16 v[92:95], a[84:87], a[4:7], v[92:95]
v_mfma_f32_16x16x32_bf16 v[92:95], a[80:83], a[0:3], v[92:95]
v_mfma_f32_16x16x32_bf16 v[32:35], a[88:91], a[0:3], v[32:35]
v_mfma_f32_16x16x32_bf16 v[32:35], a[92:95], a[4:7], v[32:35]
v_mfma_f32_16x16x32_bf16 v[48:51], a[92:95], a[12:15], v[48:51]
s_waitcnt lgkmcnt(0)
s_barrier
v_mfma_f32_16x16x32_bf16 v[48:51], a[88:91], a[8:11], v[48:51]
s_xor_b32 m0, s77, 65536
ds_read_b64_tr_b16 a[72:73], v19 offset:36864
v_mfma_f32_16x16x32_bf16 v[64:67], a[88:91], a[16:19], v[64:67]
s_xor_b32 s64, s71, 3670016
ds_read_b64_tr_b16 a[74:75], v19 offset:37120
v_mfma_f32_16x16x32_bf16 v[64:67], a[92:95], a[20:23], v[64:67]
buffer_load_dwordx4 v14, s[56:59], s64 offen lds
v_mfma_f32_16x16x32_bf16 v[80:83], a[92:95], a[28:31], v[80:83]
ds_read_b64_tr_b16 a[76:77], v19 offset:38912
v_mfma_f32_16x16x32_bf16 v[80:83], a[88:91], a[24:27], v[80:83]
ds_read_b64_tr_b16 a[78:79], v19 offset:39168
v_mfma_f32_16x16x32_bf16 v[144:147], a[96:99], a[24:27], v[144:147]
ds_read_b64_tr_b16 a[80:81], v20 offset:36864
v_mfma_f32_16x16x32_bf16 v[144:147], a[100:103], a[28:31], v[144:147]
ds_read_b64_tr_b16 a[82:83], v20 offset:37120
v_mfma_f32_16x16x32_bf16 v[128:131], a[100:103], a[20:23], v[128:131]
ds_read_b64_tr_b16 a[84:85], v20 offset:38912
v_mfma_f32_16x16x32_bf16 v[128:131], a[96:99], a[16:19], v[128:131]
ds_read_b64_tr_b16 a[86:87], v20 offset:39168
v_mfma_f32_16x16x32_bf16 v[112:115], a[96:99], a[8:11], v[112:115]
s_add_u32 m0, s78, 81920
ds_read_b64_tr_b16 a[88:89], v19 offset:40960
v_mfma_f32_16x16x32_bf16 v[112:115], a[100:103], a[12:15], v[112:115]
s_add_u32 s64, s75, 2752512
ds_read_b64_tr_b16 a[90:91], v19 offset:41216
v_mfma_f32_16x16x32_bf16 v[96:99], a[100:103], a[4:7], v[96:99]
buffer_load_dwordx4 v23, s[60:63], s64 offen lds
v_mfma_f32_16x16x32_bf16 v[96:99], a[96:99], a[0:3], v[96:99]
ds_read_b64_tr_b16 a[92:93], v19 offset:43008
v_mfma_f32_16x16x32_bf16 v[36:39], a[104:107], a[0:3], v[36:39]
ds_read_b64_tr_b16 a[94:95], v19 offset:43264
v_mfma_f32_16x16x32_bf16 v[36:39], a[108:111], a[4:7], v[36:39]
ds_read_b64_tr_b16 a[96:97], v20 offset:40960
v_mfma_f32_16x16x32_bf16 v[52:55], a[108:111], a[12:15], v[52:55]
ds_read_b64_tr_b16 a[98:99], v20 offset:41216
v_mfma_f32_16x16x32_bf16 v[52:55], a[104:107], a[8:11], v[52:55]
ds_read_b64_tr_b16 a[100:101], v20 offset:43008
v_mfma_f32_16x16x32_bf16 v[68:71], a[104:107], a[16:19], v[68:71]
ds_read_b64_tr_b16 a[102:103], v20 offset:43264
v_mfma_f32_16x16x32_bf16 v[68:71], a[108:111], a[20:23], v[68:71]
s_xor_b32 m0, s77, 66560
v_mfma_f32_16x16x32_bf16 v[84:87], a[108:111], a[28:31], v[84:87]
s_xor_b32 s64, s71, 3702784
v_mfma_f32_16x16x32_bf16 v[84:87], a[104:107], a[24:27], v[84:87]
buffer_load_dwordx4 v14, s[56:59], s64 offen lds
v_mfma_f32_16x16x32_bf16 v[148:151], a[112:115], a[24:27], v[148:151]
ds_read_b64_tr_b16 a[104:105], v19 offset:32768
v_mfma_f32_16x16x32_bf16 v[148:151], a[116:119], a[28:31], v[148:151]
ds_read_b64_tr_b16 a[106:107], v19 offset:33024
v_mfma_f32_16x16x32_bf16 v[132:135], a[116:119], a[20:23], v[132:135]
s_add_u32 s65, s79, 7168
ds_read_b64_tr_b16 a[108:109], v19 offset:34816
v_mfma_f32_16x16x32_bf16 v[132:135], a[112:115], a[16:19], v[132:135]
buffer_store_dwordx4 a[184:187], v16, s[44:47], s65 offen sc1
v_mfma_f32_16x16x32_bf16 v[116:119], a[112:115], a[8:11], v[116:119]
ds_read_b64_tr_b16 a[110:111], v19 offset:35072
v_mfma_f32_16x16x32_bf16 v[116:119], a[116:119], a[12:15], v[116:119]
v_mfma_f32_16x16x32_bf16 v[100:103], a[116:119], a[4:7], v[100:103]
s_add_u32 m0, s78, 86016
v_mfma_f32_16x16x32_bf16 v[100:103], a[112:115], a[0:3], v[100:103]
s_waitcnt lgkmcnt(4)
s_add_u32 s64, s75, 2754560
ds_read_b64_tr_b16 a[112:113], v20 offset:32768
v_mfma_f32_16x16x32_bf16 v[184:187], a[72:75], a[32:35], v[184:187]
buffer_load_dwordx4 v23, s[60:63], s64 offen lds
v_mfma_f32_16x16x32_bf16 v[184:187], a[76:79], a[36:39], v[184:187]
ds_read_b64_tr_b16 a[114:115], v20 offset:33024
v_mfma_f32_16x16x32_bf16 v[192:195], a[76:79], a[44:47], v[192:195]
ds_read_b64_tr_b16 a[116:117], v20 offset:34816
v_mfma_f32_16x16x32_bf16 v[192:195], a[72:75], a[40:43], v[192:195]
ds_read_b64_tr_b16 a[118:119], v20 offset:35072
v_mfma_f32_16x16x32_bf16 v[200:203], a[72:75], a[48:51], v[200:203]
v_mfma_f32_16x16x32_bf16 v[200:203], a[76:79], a[52:55], v[200:203]
v_mfma_f32_16x16x32_bf16 v[208:211], a[76:79], a[60:63], v[208:211]
v_mfma_f32_16x16x32_bf16 v[208:211], a[72:75], a[56:59], v[208:211]
ds_read_b64_tr_b16 a[72:73], v4 offset:32768
v_mfma_f32_16x16x32_bf16 v[212:215], a[80:83], a[56:59], v[212:215]
s_xor_b32 m0, s77, 67584
ds_read_b64_tr_b16 a[74:75], v4 offset:33792
v_mfma_f32_16x16x32_bf16 v[212:215], a[84:87], a[60:63], v[212:215]
s_xor_b32 s64, s71, 3735552
ds_read_b64_tr_b16 a[76:77], v4 offset:40960
v_mfma_f32_16x16x32_bf16 v[204:207], a[84:87], a[52:55], v[204:207]
buffer_load_dwordx4 v15, s[56:59], s64 offen lds
v_mfma_f32_16x16x32_bf16 v[204:207], a[80:83], a[48:51], v[204:207]
ds_read_b64_tr_b16 a[78:79], v4 offset:41984
v_mfma_f32_16x16x32_bf16 v[196:199], a[80:83], a[40:43], v[196:199]
v_mfma_f32_16x16x32_bf16 v[196:199], a[84:87], a[44:47], v[196:199]
v_mfma_f32_16x16x32_bf16 v[188:191], a[84:87], a[36:39], v[188:191]
v_mfma_f32_16x16x32_bf16 v[188:191], a[80:83], a[32:35], v[188:191]
ds_read_b64_tr_b16 a[80:81], v5 offset:32768
v_mfma_f32_16x16x32_bf16 v[216:219], a[32:35], a[88:91], v[216:219]
ds_read_b64_tr_b16 a[82:83], v5 offset:33792
v_mfma_f32_16x16x32_bf16 v[216:219], a[36:39], a[92:95], v[216:219]
s_add_u32 m0, s78, 90112
ds_read_b64_tr_b16 a[84:85], v5 offset:40960
v_mfma_f32_16x16x32_bf16 v[224:227], a[44:47], a[92:95], v[224:227]
s_add_u32 s64, s75, 2756608
ds_read_b64_tr_b16 a[86:87], v5 offset:41984
v_mfma_f32_16x16x32_bf16 v[224:227], a[40:43], a[88:91], v[224:227]
buffer_load_dwordx4 v23, s[60:63], s64 offen lds
v_mfma_f32_16x16x32_bf16 v[232:235], a[48:51], a[88:91], v[232:235]
v_mfma_f32_16x16x32_bf16 v[232:235], a[52:55], a[92:95], v[232:235]
v_mfma_f32_16x16x32_bf16 v[240:243], a[60:63], a[92:95], v[240:243]
v_mfma_f32_16x16x32_bf16 v[240:243], a[56:59], a[88:91], v[240:243]
ds_read_b64_tr_b16 a[88:89], v6 offset:32768
v_mfma_f32_16x16x32_bf16 v[244:247], a[56:59], a[96:99], v[244:247]
ds_read_b64_tr_b16 a[90:91], v6 offset:33792
v_mfma_f32_16x16x32_bf16 v[244:247], a[60:63], a[100:103], v[244:247]
ds_read_b64_tr_b16 a[92:93], v6 offset:40960
v_add_u32 v19, 0x8000, v19
v_mfma_f32_16x16x32_bf16 v[236:239], a[52:55], a[100:103], v[236:239]
s_xor_b32 m0, s77, 68608
ds_read_b64_tr_b16 a[94:95], v6 offset:41984
v_mfma_f32_16x16x32_bf16 v[236:239], a[48:51], a[96:99], v[236:239]
s_xor_b32 s64, s71, 3768320
v_mfma_f32_16x16x32_bf16 v[228:231], a[40:43], a[96:99], v[228:231]
buffer_load_dwordx4 v15, s[56:59], s64 offen lds
v_mfma_f32_16x16x32_bf16 v[228:231], a[44:47], a[100:103], v[228:231]
v_mfma_f32_16x16x32_bf16 v[220:223], a[36:39], a[100:103], v[220:223]
v_mfma_f32_16x16x32_bf16 v[220:223], a[32:35], a[96:99], v[220:223]
s_waitcnt lgkmcnt(4)
ds_read_b64_tr_b16 a[96:97], v7 offset:32768
v_mfma_f32_16x16x32_bf16 v[152:155], a[104:107], a[32:35], v[152:155]
ds_read_b64_tr_b16 a[98:99], v7 offset:33792
v_mfma_f32_16x16x32_bf16 v[152:155], a[108:111], a[36:39], v[152:155]
ds_read_b64_tr_b16 a[100:101], v7 offset:40960
v_add_u32 v20, 0x8000, v20
v_mfma_f32_16x16x32_bf16 v[160:163], a[108:111], a[44:47], v[160:163]
ds_read_b64_tr_b16 a[102:103], v7 offset:41984
v_mfma_f32_16x16x32_bf16 v[160:163], a[104:107], a[40:43], v[160:163]
v_mfma_f32_16x16x32_bf16 v[168:171], a[104:107], a[48:51], v[168:171]
v_mfma_f32_16x16x32_bf16 v[168:171], a[108:111], a[52:55], v[168:171]
v_mfma_f32_16x16x32_bf16 v[176:179], a[108:111], a[60:63], v[176:179]
s_xor_b32 m0, s84, 32768
v_mfma_f32_16x16x32_bf16 v[176:179], a[104:107], a[56:59], v[176:179]
s_xor_b32 s64, s72, 896
ds_read_b64_tr_b16 a[104:105], v8 offset:32768
v_mfma_f32_16x16x32_bf16 v[180:183], a[112:115], a[56:59], v[180:183]
s_add_u32 s65, s79, 3072
buffer_load_dwordx4 v12, s[48:51], s64 offen lds
v_mfma_f32_16x16x32_bf16 v[180:183], a[116:119], a[60:63], v[180:183]
buffer_store_dwordx4 a[188:191], v16, s[44:47], s65 offen sc1
v_mfma_f32_16x16x32_bf16 v[172:175], a[116:119], a[52:55], v[172:175]
ds_read_b64_tr_b16 a[106:107], v8 offset:33792
v_add_u32 v4, 0x8000, v4
v_mfma_f32_16x16x32_bf16 v[172:175], a[112:115], a[48:51], v[172:175]
s_xor_b32 m0, s84, 33792
ds_read_b64_tr_b16 a[108:109], v8 offset:40960
v_mfma_f32_16x16x32_bf16 v[164:167], a[112:115], a[40:43], v[164:167]
s_xor_b32 s64, s72, 17280
ds_read_b64_tr_b16 a[110:111], v8 offset:41984
v_mfma_f32_16x16x32_bf16 v[164:167], a[116:119], a[44:47], v[164:167]
buffer_load_dwordx4 v13, s[48:51], s64 offen lds
v_mfma_f32_16x16x32_bf16 v[156:159], a[116:119], a[36:39], v[156:159]
v_mfma_f32_16x16x32_bf16 v[156:159], a[112:115], a[32:35], v[156:159]
ds_read_b64_tr_b16 a[112:113], v9 offset:32768
v_mfma_f32_16x16x32_bf16 v[24:27], a[72:75], a[32:35], v[24:27]
s_xor_b32 m0, s84, 34816
ds_read_b64_tr_b16 a[114:115], v9 offset:33792
v_mfma_f32_16x16x32_bf16 v[24:27], a[76:79], a[36:39], v[24:27]
s_xor_b32 s64, s72, 131968
ds_read_b64_tr_b16 a[116:117], v9 offset:40960
v_add_u32 v5, 0x8000, v5
v_mfma_f32_16x16x32_bf16 v[40:43], a[76:79], a[44:47], v[40:43]
buffer_load_dwordx4 v12, s[48:51], s64 offen lds
v_mfma_f32_16x16x32_bf16 v[40:43], a[72:75], a[40:43], v[40:43]
ds_read_b64_tr_b16 a[118:119], v9 offset:41984
v_mfma_f32_16x16x32_bf16 v[56:59], a[72:75], a[48:51], v[56:59]
v_mfma_f32_16x16x32_bf16 v[56:59], a[76:79], a[52:55], v[56:59]
s_xor_b32 m0, s84, 35840
v_mfma_f32_16x16x32_bf16 v[72:75], a[76:79], a[60:63], v[72:75]
s_waitcnt vmcnt(12)
s_xor_b32 s64, s72, 148352
ds_read_b128 a[0:3], v2 offset:0
v_mfma_f32_16x16x32_bf16 v[72:75], a[72:75], a[56:59], v[72:75]
buffer_load_dwordx4 v13, s[48:51], s64 offen lds
v_mfma_f32_16x16x32_bf16 v[136:139], a[80:83], a[56:59], v[136:139]
ds_read_b128 a[4:7], v3 offset:0
v_mfma_f32_16x16x32_bf16 v[136:139], a[84:87], a[60:63], v[136:139]
ds_read_b128 a[8:11], v2 offset:2048
v_add_u32 v6, 0x8000, v6
v_mfma_f32_16x16x32_bf16 v[120:123], a[84:87], a[52:55], v[120:123]
s_xor_b32 m0, s84, 36864
ds_read_b128 a[12:15], v3 offset:2048
v_mfma_f32_16x16x32_bf16 v[120:123], a[80:83], a[48:51], v[120:123]
s_xor_b32 s64, s73, 896
ds_read_b128 a[16:19], v2 offset:4096
v_mfma_f32_16x16x32_bf16 v[104:107], a[80:83], a[40:43], v[104:107]
buffer_load_dwordx4 v12, s[48:51], s64 offen lds
v_mfma_f32_16x16x32_bf16 v[104:107], a[84:87], a[44:47], v[104:107]
ds_read_b128 a[20:23], v3 offset:4096
v_mfma_f32_16x16x32_bf16 v[88:91], a[84:87], a[36:39], v[88:91]
ds_read_b128 a[24:27], v2 offset:6144
v_mfma_f32_16x16x32_bf16 v[88:91], a[80:83], a[32:35], v[88:91]
s_waitcnt lgkmcnt(7)
s_xor_b32 m0, s84, 37888
ds_read_b128 a[28:31], v3 offset:6144
v_mfma_f32_16x16x32_bf16 v[28:31], a[88:91], a[32:35], v[28:31]
s_xor_b32 s64, s73, 17280
ds_read_b64_tr_b16 a[72:73], v10 offset:32768
v_mfma_f32_16x16x32_bf16 v[28:31], a[92:95], a[36:39], v[28:31]
buffer_load_dwordx4 v13, s[48:51], s64 offen lds
v_mfma_f32_16x16x32_bf16 v[44:47], a[92:95], a[44:47], v[44:47]
ds_read_b64_tr_b16 a[74:75], v10 offset:33792
v_add_u32 v7, 0x8000, v7
v_mfma_f32_16x16x32_bf16 v[44:47], a[88:91], a[40:43], v[44:47]
ds_read_b64_tr_b16 a[76:77], v10 offset:40960
v_mfma_f32_16x16x32_bf16 v[60:63], a[88:91], a[48:51], v[60:63]
s_xor_b32 m0, s84, 38912
ds_read_b64_tr_b16 a[78:79], v10 offset:41984
v_mfma_f32_16x16x32_bf16 v[60:63], a[92:95], a[52:55], v[60:63]
s_xor_b32 s64, s73, 131968
ds_read_b64_tr_b16 a[80:81], v11 offset:32768
v_mfma_f32_16x16x32_bf16 v[76:79], a[92:95], a[60:63], v[76:79]
buffer_load_dwordx4 v12, s[48:51], s64 offen lds
v_mfma_f32_16x16x32_bf16 v[76:79], a[88:91], a[56:59], v[76:79]
ds_read_b64_tr_b16 a[82:83], v11 offset:33792
v_mfma_f32_16x16x32_bf16 v[140:143], a[96:99], a[56:59], v[140:143]
ds_read_b64_tr_b16 a[84:85], v11 offset:40960
v_mfma_f32_16x16x32_bf16 v[140:143], a[100:103], a[60:63], v[140:143]
s_xor_b32 m0, s84, 39936
ds_read_b64_tr_b16 a[86:87], v11 offset:41984
v_add_u32 v8, 0x8000, v8
v_mfma_f32_16x16x32_bf16 v[124:127], a[100:103], a[52:55], v[124:127]
s_xor_b32 s64, s73, 148352
v_mfma_f32_16x16x32_bf16 v[124:127], a[96:99], a[48:51], v[124:127]
buffer_load_dwordx4 v13, s[48:51], s64 offen lds
v_mfma_f32_16x16x32_bf16 v[108:111], a[96:99], a[40:43], v[108:111]
v_mfma_f32_16x16x32_bf16 v[108:111], a[100:103], a[44:47], v[108:111]
v_mfma_f32_16x16x32_bf16 v[92:95], a[100:103], a[36:39], v[92:95]
v_add_u32 v9, 0x8000, v9
v_add_u32 v10, 0x8000, v10
v_mfma_f32_16x16x32_bf16 v[92:95], a[96:99], a[32:35], v[92:95]
v_add_u32 v11, 0x8000, v11
v_mfma_f32_16x16x32_bf16 v[32:35], a[104:107], a[32:35], v[32:35]
v_mfma_f32_16x16x32_bf16 v[32:35], a[108:111], a[36:39], v[32:35]
v_mfma_f32_16x16x32_bf16 v[48:51], a[108:111], a[44:47], v[48:51]
s_waitcnt lgkmcnt(0)
s_barrier
v_mfma_f32_16x16x32_bf16 v[48:51], a[104:107], a[40:43], v[48:51]
s_xor_b32 m0, s77, 98304
ds_read_b64_tr_b16 a[88:89], v19 offset:36864
v_mfma_f32_16x16x32_bf16 v[64:67], a[104:107], a[48:51], v[64:67]
s_xor_b32 s64, s71, 4194304
ds_read_b64_tr_b16 a[90:91], v19 offset:37120
v_mfma_f32_16x16x32_bf16 v[64:67], a[108:111], a[52:55], v[64:67]
s_add_u32 s65, s79, 24576
buffer_load_dwordx4 v14, s[56:59], s64 offen lds
v_mfma_f32_16x16x32_bf16 v[80:83], a[108:111], a[60:63], v[80:83]
buffer_store_dwordx4 a[192:195], v16, s[44:47], s65 offen sc1
v_mfma_f32_16x16x32_bf16 v[80:83], a[104:107], a[56:59], v[80:83]
ds_read_b64_tr_b16 a[92:93], v19 offset:38912
v_mfma_f32_16x16x32_bf16 v[144:147], a[112:115], a[56:59], v[144:147]
ds_read_b64_tr_b16 a[94:95], v19 offset:39168
v_mfma_f32_16x16x32_bf16 v[144:147], a[116:119], a[60:63], v[144:147]
ds_read_b64_tr_b16 a[96:97], v20 offset:36864
v_mfma_f32_16x16x32_bf16 v[128:131], a[116:119], a[52:55], v[128:131]
ds_read_b64_tr_b16 a[98:99], v20 offset:37120
v_mfma_f32_16x16x32_bf16 v[128:131], a[112:115], a[48:51], v[128:131]
ds_read_b64_tr_b16 a[100:101], v20 offset:38912
v_mfma_f32_16x16x32_bf16 v[112:115], a[112:115], a[40:43], v[112:115]
s_add_u32 m0, s78, 114688
ds_read_b64_tr_b16 a[102:103], v20 offset:39168
v_mfma_f32_16x16x32_bf16 v[112:115], a[116:119], a[44:47], v[112:115]
s_add_u32 s64, s75, 3145728
ds_read_b64_tr_b16 a[104:105], v19 offset:40960
v_mfma_f32_16x16x32_bf16 v[96:99], a[116:119], a[36:39], v[96:99]
buffer_load_dwordx4 v23, s[60:63], s64 offen lds
v_mfma_f32_16x16x32_bf16 v[96:99], a[112:115], a[32:35], v[96:99]
ds_read_b64_tr_b16 a[106:107], v19 offset:41216
v_mfma_f32_16x16x32_bf16 v[36:39], a[72:75], a[32:35], v[36:39]
ds_read_b64_tr_b16 a[108:109], v19 offset:43008
v_mfma_f32_16x16x32_bf16 v[36:39], a[76:79], a[36:39], v[36:39]
ds_read_b64_tr_b16 a[110:111], v19 offset:43264
v_mfma_f32_16x16x32_bf16 v[52:55], a[76:79], a[44:47], v[52:55]
ds_read_b64_tr_b16 a[112:113], v20 offset:40960
v_mfma_f32_16x16x32_bf16 v[52:55], a[72:75], a[40:43], v[52:55]
ds_read_b64_tr_b16 a[114:115], v20 offset:41216
v_mfma_f32_16x16x32_bf16 v[68:71], a[72:75], a[48:51], v[68:71]
ds_read_b64_tr_b16 a[116:117], v20 offset:43008
v_mfma_f32_16x16x32_bf16 v[68:71], a[76:79], a[52:55], v[68:71]
s_xor_b32 m0, s77, 99328
ds_read_b64_tr_b16 a[118:119], v20 offset:43264
v_mfma_f32_16x16x32_bf16 v[84:87], a[76:79], a[60:63], v[84:87]
s_xor_b32 s64, s71, 4227072
v_mfma_f32_16x16x32_bf16 v[84:87], a[72:75], a[56:59], v[84:87]
buffer_load_dwordx4 v14, s[56:59], s64 offen lds
v_mfma_f32_16x16x32_bf16 v[148:151], a[80:83], a[56:59], v[148:151]
ds_read_b64_tr_b16 a[72:73], v19 offset:32768
v_mfma_f32_16x16x32_bf16 v[148:151], a[84:87], a[60:63], v[148:151]
ds_read_b64_tr_b16 a[74:75], v19 offset:33024
v_mfma_f32_16x16x32_bf16 v[132:135], a[84:87], a[52:55], v[132:135]
ds_read_b64_tr_b16 a[76:77], v19 offset:34816
v_mfma_f32_16x16x32_bf16 v[132:135], a[80:83], a[48:51], v[132:135]
ds_read_b64_tr_b16 a[78:79], v19 offset:35072
v_mfma_f32_16x16x32_bf16 v[116:119], a[80:83], a[40:43], v[116:119]
v_mfma_f32_16x16x32_bf16 v[116:119], a[84:87], a[44:47], v[116:119]
v_mfma_f32_16x16x32_bf16 v[100:103], a[84:87], a[36:39], v[100:103]
s_add_u32 m0, s78, 118784
v_mfma_f32_16x16x32_bf16 v[100:103], a[80:83], a[32:35], v[100:103]
s_waitcnt lgkmcnt(4)
s_add_u32 s64, s75, 3147776
ds_read_b64_tr_b16 a[80:81], v20 offset:32768
v_mfma_f32_16x16x32_bf16 v[184:187], a[88:91], a[0:3], v[184:187]
s_branch L_po9
L_pg9:
s_branch L_pg13
L_po9:
buffer_load_dwordx4 v23, s[60:63], s64 offen lds
v_mfma_f32_16x16x32_bf16 v[184:187], a[92:95], a[4:7], v[184:187]
ds_read_b64_tr_b16 a[82:83], v20 offset:33024
v_mfma_f32_16x16x32_bf16 v[192:195], a[92:95], a[12:15], v[192:195]
ds_read_b64_tr_b16 a[84:85], v20 offset:34816
v_mfma_f32_16x16x32_bf16 v[192:195], a[88:91], a[8:11], v[192:195]
ds_read_b64_tr_b16 a[86:87], v20 offset:35072
v_mfma_f32_16x16x32_bf16 v[200:203], a[88:91], a[16:19], v[200:203]
v_mfma_f32_16x16x32_bf16 v[200:203], a[92:95], a[20:23], v[200:203]
v_mfma_f32_16x16x32_bf16 v[208:211], a[92:95], a[28:31], v[208:211]
v_mfma_f32_16x16x32_bf16 v[208:211], a[88:91], a[24:27], v[208:211]
ds_read_b64_tr_b16 a[88:89], v4 offset:32768
v_mfma_f32_16x16x32_bf16 v[212:215], a[96:99], a[24:27], v[212:215]
s_xor_b32 m0, s77, 100352
ds_read_b64_tr_b16 a[90:91], v4 offset:33792
v_mfma_f32_16x16x32_bf16 v[212:215], a[100:103], a[28:31], v[212:215]
s_xor_b32 s64, s71, 4259840
ds_read_b64_tr_b16 a[92:93], v4 offset:40960
v_mfma_f32_16x16x32_bf16 v[204:207], a[100:103], a[20:23], v[204:207]
buffer_load_dwordx4 v15, s[56:59], s64 offen lds
v_mfma_f32_16x16x32_bf16 v[204:207], a[96:99], a[16:19], v[204:207]
ds_read_b64_tr_b16 a[94:95], v4 offset:41984
v_mfma_f32_16x16x32_bf16 v[196:199], a[96:99], a[8:11], v[196:199]
v_mfma_f32_16x16x32_bf16 v[196:199], a[100:103], a[12:15], v[196:199]
v_mfma_f32_16x16x32_bf16 v[188:191], a[100:103], a[4:7], v[188:191]
v_mfma_f32_16x16x32_bf16 v[188:191], a[96:99], a[0:3], v[188:191]
ds_read_b64_tr_b16 a[96:97], v5 offset:32768
v_mfma_f32_16x16x32_bf16 v[216:219], a[0:3], a[104:107], v[216:219]
s_add_u32 s65, s79, 25600
ds_read_b64_tr_b16 a[98:99], v5 offset:33792
v_mfma_f32_16x16x32_bf16 v[216:219], a[4:7], a[108:111], v[216:219]
s_add_u32 m0, s78, 122880
buffer_store_dwordx4 a[196:199], v16, s[44:47], s65 offen sc1
v_mfma_f32_16x16x32_bf16 v[224:227], a[12:15], a[108:111], v[224:227]
s_add_u32 s64, s75, 3149824
ds_read_b64_tr_b16 a[100:101], v5 offset:40960
v_mfma_f32_16x16x32_bf16 v[224:227], a[8:11], a[104:107], v[224:227]
buffer_load_dwordx4 v23, s[60:63], s64 offen lds
v_mfma_f32_16x16x32_bf16 v[232:235], a[16:19], a[104:107], v[232:235]
ds_read_b64_tr_b16 a[102:103], v5 offset:41984
v_mfma_f32_16x16x32_bf16 v[232:235], a[20:23], a[108:111], v[232:235]
v_mfma_f32_16x16x32_bf16 v[240:243], a[28:31], a[108:111], v[240:243]
v_mfma_f32_16x16x32_bf16 v[240:243], a[24:27], a[104:107], v[240:243]
ds_read_b64_tr_b16 a[104:105], v6 offset:32768
v_mfma_f32_16x16x32_bf16 v[244:247], a[24:27], a[112:115], v[244:247]
ds_read_b64_tr_b16 a[106:107], v6 offset:33792
v_mfma_f32_16x16x32_bf16 v[244:247], a[28:31], a[116:119], v[244:247]
ds_read_b64_tr_b16 a[108:109], v6 offset:40960
v_subrev_u32 v19, 0x8000, v19
v_mfma_f32_16x16x32_bf16 v[236:239], a[20:23], a[116:119], v[236:239]
s_xor_b32 m0, s77, 101376
ds_read_b64_tr_b16 a[110:111], v6 offset:41984
v_mfma_f32_16x16x32_bf16 v[236:239], a[16:19], a[112:115], v[236:239]
s_xor_b32 s64, s71, 4292608
v_mfma_f32_16x16x32_bf16 v[228:231], a[8:11], a[112:115], v[228:231]
buffer_load_dwordx4 v15, s[56:59], s64 offen lds
v_mfma_f32_16x16x32_bf16 v[228:231], a[12:15], a[116:119], v[228:231]
v_mfma_f32_16x16x32_bf16 v[220:223], a[4:7], a[116:119], v[220:223]
v_mfma_f32_16x16x32_bf16 v[220:223], a[0:3], a[112:115], v[220:223]
s_waitcnt lgkmcnt(4)
ds_read_b64_tr_b16 a[112:113], v7 offset:32768
v_mfma_f32_16x16x32_bf16 v[152:155], a[72:75], a[0:3], v[152:155]
ds_read_b64_tr_b16 a[114:115], v7 offset:33792
v_mfma_f32_16x16x32_bf16 v[152:155], a[76:79], a[4:7], v[152:155]
ds_read_b64_tr_b16 a[116:117], v7 offset:40960
v_subrev_u32 v20, 0x8000, v20
v_mfma_f32_16x16x32_bf16 v[160:163], a[76:79], a[12:15], v[160:163]
ds_read_b64_tr_b16 a[118:119], v7 offset:41984
v_mfma_f32_16x16x32_bf16 v[160:163], a[72:75], a[8:11], v[160:163]
v_mfma_f32_16x16x32_bf16 v[168:171], a[72:75], a[16:19], v[168:171]
v_mfma_f32_16x16x32_bf16 v[168:171], a[76:79], a[20:23], v[168:171]
v_mfma_f32_16x16x32_bf16 v[176:179], a[76:79], a[28:31], v[176:179]
s_xor_b32 m0, s84, 0
v_mfma_f32_16x16x32_bf16 v[176:179], a[72:75], a[24:27], v[176:179]
s_xor_b32 s64, s72, 1024
ds_read_b64_tr_b16 a[72:73], v8 offset:32768
v_mfma_f32_16x16x32_bf16 v[180:183], a[80:83], a[24:27], v[180:183]
buffer_load_dwordx4 v12, s[48:51], s64 offen lds
v_mfma_f32_16x16x32_bf16 v[180:183], a[84:87], a[28:31], v[180:183]
ds_read_b64_tr_b16 a[74:75], v8 offset:33792
v_subrev_u32 v4, 0x8000, v4
v_mfma_f32_16x16x32_bf16 v[172:175], a[84:87], a[20:23], v[172:175]
ds_read_b64_tr_b16 a[76:77], v8 offset:40960
v_mfma_f32_16x16x32_bf16 v[172:175], a[80:83], a[16:19], v[172:175]
s_xor_b32 m0, s84, 1024
ds_read_b64_tr_b16 a[78:79], v8 offset:41984
v_mfma_f32_16x16x32_bf16 v[164:167], a[80:83], a[8:11], v[164:167]
s_xor_b32 s64, s72, 17408
v_mfma_f32_16x16x32_bf16 v[164:167], a[84:87], a[12:15], v[164:167]
buffer_load_dwordx4 v13, s[48:51], s64 offen lds
v_mfma_f32_16x16x32_bf16 v[156:159], a[84:87], a[4:7], v[156:159]
v_mfma_f32_16x16x32_bf16 v[156:159], a[80:83], a[0:3], v[156:159]
ds_read_b64_tr_b16 a[80:81], v9 offset:32768
v_mfma_f32_16x16x32_bf16 v[24:27], a[88:91], a[0:3], v[24:27]
s_xor_b32 m0, s84, 2048
ds_read_b64_tr_b16 a[82:83], v9 offset:33792
v_mfma_f32_16x16x32_bf16 v[24:27], a[92:95], a[4:7], v[24:27]
s_xor_b32 s64, s72, 132096
ds_read_b64_tr_b16 a[84:85], v9 offset:40960
v_subrev_u32 v5, 0x8000, v5
v_mfma_f32_16x16x32_bf16 v[40:43], a[92:95], a[12:15], v[40:43]
buffer_load_dwordx4 v12, s[48:51], s64 offen lds
v_mfma_f32_16x16x32_bf16 v[40:43], a[88:91], a[8:11], v[40:43]
ds_read_b64_tr_b16 a[86:87], v9 offset:41984
v_mfma_f32_16x16x32_bf16 v[56:59], a[88:91], a[16:19], v[56:59]
v_mfma_f32_16x16x32_bf16 v[56:59], a[92:95], a[20:23], v[56:59]
s_xor_b32 m0, s84, 3072
v_mfma_f32_16x16x32_bf16 v[72:75], a[92:95], a[28:31], v[72:75]
s_waitcnt vmcnt(12)
s_xor_b32 s64, s72, 148480
ds_read_b128 a[32:35], v2 offset:32768
v_mfma_f32_16x16x32_bf16 v[72:75], a[88:91], a[24:27], v[72:75]
buffer_load_dwordx4 v13, s[48:51], s64 offen lds
v_mfma_f32_16x16x32_bf16 v[136:139], a[96:99], a[24:27], v[136:139]
ds_read_b128 a[36:39], v3 offset:32768
v_mfma_f32_16x16x32_bf16 v[136:139], a[100:103], a[28:31], v[136:139]
ds_read_b128 a[40:43], v2 offset:34816
v_subrev_u32 v6, 0x8000, v6
v_mfma_f32_16x16x32_bf16 v[120:123], a[100:103], a[20:23], v[120:123]
s_xor_b32 m0, s84, 4096
ds_read_b128 a[44:47], v3 offset:34816
v_mfma_f32_16x16x32_bf16 v[120:123], a[96:99], a[16:19], v[120:123]
s_xor_b32 s64, s73, 1024
ds_read_b128 a[48:51], v2 offset:36864
v_mfma_f32_16x16x32_bf16 v[104:107], a[96:99], a[8:11], v[104:107]
buffer_load_dwordx4 v12, s[48:51], s64 offen lds
v_mfma_f32_16x16x32_bf16 v[104:107], a[100:103], a[12:15], v[104:107]
s_add_u32 s65, s79, 9216
ds_read_b128 a[52:55], v3 offset:36864
v_mfma_f32_16x16x32_bf16 v[88:91], a[100:103], a[4:7], v[88:91]
buffer_store_dwordx4 a[200:203], v16, s[44:47], s65 offen sc1
v_mfma_f32_16x16x32_bf16 v[88:91], a[96:99], a[0:3], v[88:91]
s_waitcnt lgkmcnt(6)
s_xor_b32 m0, s84, 5120
ds_read_b128 a[56:59], v2 offset:38912
v_mfma_f32_16x16x32_bf16 v[28:31], a[104:107], a[0:3], v[28:31]
s_xor_b32 s64, s73, 17408
ds_read_b128 a[60:63], v3 offset:38912
v_mfma_f32_16x16x32_bf16 v[28:31], a[108:111], a[4:7], v[28:31]
buffer_load_dwordx4 v13, s[48:51], s64 offen lds
v_mfma_f32_16x16x32_bf16 v[44:47], a[108:111], a[12:15], v[44:47]
ds_read_b64_tr_b16 a[88:89], v10 offset:32768
v_subrev_u32 v7, 0x8000, v7
v_mfma_f32_16x16x32_bf16 v[44:47], a[104:107], a[8:11], v[44:47]
ds_read_b64_tr_b16 a[90:91], v10 offset:33792
v_mfma_f32_16x16x32_bf16 v[60:63], a[104:107], a[16:19], v[60:63]
s_xor_b32 m0, s84, 6144
ds_read_b64_tr_b16 a[92:93], v10 offset:40960
v_mfma_f32_16x16x32_bf16 v[60:63], a[108:111], a[20:23], v[60:63]
s_xor_b32 s64, s73, 132096
ds_read_b64_tr_b16 a[94:95], v10 offset:41984
v_mfma_f32_16x16x32_bf16 v[76:79], a[108:111], a[28:31], v[76:79]
buffer_load_dwordx4 v12, s[48:51], s64 offen lds
v_mfma_f32_16x16x32_bf16 v[76:79], a[104:107], a[24:27], v[76:79]
ds_read_b64_tr_b16 a[96:97], v11 offset:32768
v_mfma_f32_16x16x32_bf16 v[140:143], a[112:115], a[24:27], v[140:143]
ds_read_b64_tr_b16 a[98:99], v11 offset:33792
v_mfma_f32_16x16x32_bf16 v[140:143], a[116:119], a[28:31], v[140:143]
s_xor_b32 m0, s84, 7168
ds_read_b64_tr_b16 a[100:101], v11 offset:40960
v_subrev_u32 v8, 0x8000, v8
v_mfma_f32_16x16x32_bf16 v[124:127], a[116:119], a[20:23], v[124:127]
s_xor_b32 s64, s73, 148480
ds_read_b64_tr_b16 a[102:103], v11 offset:41984
v_mfma_f32_16x16x32_bf16 v[124:127], a[112:115], a[16:19], v[124:127]
buffer_load_dwordx4 v13, s[48:51], s64 offen lds
v_mfma_f32_16x16x32_bf16 v[108:111], a[112:115], a[8:11], v[108:111]
v_mfma_f32_16x16x32_bf16 v[108:111], a[116:119], a[12:15], v[108:111]
v_mfma_f32_16x16x32_bf16 v[92:95], a[116:119], a[4:7], v[92:95]
v_subrev_u32 v9, 0x8000, v9
v_subrev_u32 v10, 0x8000, v10
v_mfma_f32_16x16x32_bf16 v[92:95], a[112:115], a[0:3], v[92:95]
v_subrev_u32 v11, 0x8000, v11
v_mfma_f32_16x16x32_bf16 v[32:35], a[72:75], a[0:3], v[32:35]
v_mfma_f32_16x16x32_bf16 v[32:35], a[76:79], a[4:7], v[32:35]
v_mfma_f32_16x16x32_bf16 v[48:51], a[76:79], a[12:15], v[48:51]
s_waitcnt lgkmcnt(0)
s_barrier
v_mfma_f32_16x16x32_bf16 v[48:51], a[72:75], a[8:11], v[48:51]
s_xor_b32 m0, s77, 131072
ds_read_b64_tr_b16 a[104:105], v19 offset:4096
v_mfma_f32_16x16x32_bf16 v[64:67], a[72:75], a[16:19], v[64:67]
s_xor_b32 s64, s71, 4718592
ds_read_b64_tr_b16 a[106:107], v19 offset:4352
v_mfma_f32_16x16x32_bf16 v[64:67], a[76:79], a[20:23], v[64:67]
buffer_load_dwordx4 v14, s[56:59], s64 offen lds
v_mfma_f32_16x16x32_bf16 v[80:83], a[76:79], a[28:31], v[80:83]
ds_read_b64_tr_b16 a[108:109], v19 offset:6144
v_mfma_f32_16x16x32_bf16 v[80:83], a[72:75], a[24:27], v[80:83]
ds_read_b64_tr_b16 a[110:111], v19 offset:6400
v_mfma_f32_16x16x32_bf16 v[144:147], a[80:83], a[24:27], v[144:147]
ds_read_b64_tr_b16 a[112:113], v20 offset:4096
v_mfma_f32_16x16x32_bf16 v[144:147], a[84:87], a[28:31], v[144:147]
ds_read_b64_tr_b16 a[114:115], v20 offset:4352
v_mfma_f32_16x16x32_bf16 v[128:131], a[84:87], a[20:23], v[128:131]
ds_read_b64_tr_b16 a[116:117], v20 offset:6144
v_mfma_f32_16x16x32_bf16 v[128:131], a[80:83], a[16:19], v[128:131]
ds_read_b64_tr_b16 a[118:119], v20 offset:6400
v_mfma_f32_16x16x32_bf16 v[112:115], a[80:83], a[8:11], v[112:115]
s_add_u32 m0, s78, 147456
ds_read_b64_tr_b16 a[72:73], v19 offset:8192
v_mfma_f32_16x16x32_bf16 v[112:115], a[84:87], a[12:15], v[112:115]
s_add_u32 s64, s75, 3538944
ds_read_b64_tr_b16 a[74:75], v19 offset:8448
v_mfma_f32_16x16x32_bf16 v[96:99], a[84:87], a[4:7], v[96:99]
buffer_load_dwordx4 v23, s[60:63], s64 offen lds
v_mfma_f32_16x16x32_bf16 v[96:99], a[80:83], a[0:3], v[96:99]
ds_read_b64_tr_b16 a[76:77], v19 offset:10240
v_mfma_f32_16x16x32_bf16 v[36:39], a[88:91], a[0:3], v[36:39]
ds_read_b64_tr_b16 a[78:79], v19 offset:10496
v_mfma_f32_16x16x32_bf16 v[36:39], a[92:95], a[4:7], v[36:39]
ds_read_b64_tr_b16 a[80:81], v20 offset:8192
v_mfma_f32_16x16x32_bf16 v[52:55], a[92:95], a[12:15], v[52:55]
ds_read_b64_tr_b16 a[82:83], v20 offset:8448
v_mfma_f32_16x16x32_bf16 v[52:55], a[88:91], a[8:11], v[52:55]
ds_read_b64_tr_b16 a[84:85], v20 offset:10240
v_mfma_f32_16x16x32_bf16 v[68:71], a[88:91], a[16:19], v[68:71]
ds_read_b64_tr_b16 a[86:87], v20 offset:10496
v_mfma_f32_16x16x32_bf16 v[68:71], a[92:95], a[20:23], v[68:71]
s_xor_b32 m0, s77, 132096
v_mfma_f32_16x16x32_bf16 v[84:87], a[92:95], a[28:31], v[84:87]
s_xor_b32 s64, s71, 4751360
v_mfma_f32_16x16x32_bf16 v[84:87], a[88:91], a[24:27], v[84:87]
buffer_load_dwordx4 v14, s[56:59], s64 offen lds
v_mfma_f32_16x16x32_bf16 v[148:151], a[96:99], a[24:27], v[148:151]
ds_read_b64_tr_b16 a[88:89], v19 offset:0
v_mfma_f32_16x16x32_bf16 v[148:151], a[100:103], a[28:31], v[148:151]
ds_read_b64_tr_b16 a[90:91], v19 offset:256
v_mfma_f32_16x16x32_bf16 v[132:135], a[100:103], a[20:23], v[132:135]
s_add_u32 s65, s79, 26624
ds_read_b64_tr_b16 a[92:93], v19 offset:2048
v_mfma_f32_16x16x32_bf16 v[132:135], a[96:99], a[16:19], v[132:135]
buffer_store_dwordx4 a[204:207], v16, s[44:47], s65 offen sc1
v_mfma_f32_16x16x32_bf16 v[116:119], a[96:99], a[8:11], v[116:119]
ds_read_b64_tr_b16 a[94:95], v19 offset:2304
v_mfma_f32_16x16x32_bf16 v[116:119], a[100:103], a[12:15], v[116:119]
v_mfma_f32_16x16x32_bf16 v[100:103], a[100:103], a[4:7], v[100:103]
s_add_u32 m0, s78, 151552
v_mfma_f32_16x16x32_bf16 v[100:103], a[96:99], a[0:3], v[100:103]
s_waitcnt lgkmcnt(4)
s_add_u32 s64, s75, 3540992
ds_read_b64_tr_b16 a[96:97], v20 offset:0
v_mfma_f32_16x16x32_bf16 v[184:187], a[104:107], a[32:35], v[184:187]
buffer_load_dwordx4 v23, s[60:63], s64 offen lds
v_mfma_f32_16x16x32_bf16 v[184:187], a[108:111], a[36:39], v[184:187]
ds_read_b64_tr_b16 a[98:99], v20 offset:256
v_mfma_f32_16x16x32_bf16 v[192:195], a[108:111], a[44:47], v[192:195]
ds_read_b64_tr_b16 a[100:101], v20 offset:2048
v_mfma_f32_16x16x32_bf16 v[192:195], a[104:107], a[40:43], v[192:195]
ds_read_b64_tr_b16 a[102:103], v20 offset:2304
v_mfma_f32_16x16x32_bf16 v[200:203], a[104:107], a[48:51], v[200:203]
s_cmp_eq_u32 s30, 0
s_cselect_b32 s81, 256, 0
v_mfma_f32_16x16x32_bf16 v[200:203], a[108:111], a[52:55], v[200:203]
v_mfma_f32_16x16x32_bf16 v[208:211], a[108:111], a[60:63], v[208:211]
v_mfma_f32_16x16x32_bf16 v[208:211], a[104:107], a[56:59], v[208:211]
ds_read_b64_tr_b16 a[104:105], v4 offset:0
v_mfma_f32_16x16x32_bf16 v[212:215], a[112:115], a[56:59], v[212:215]
s_xor_b32 m0, s77, 133120
ds_read_b64_tr_b16 a[106:107], v4 offset:1024
v_mfma_f32_16x16x32_bf16 v[212:215], a[116:119], a[60:63], v[212:215]
s_xor_b32 s64, s71, 4784128
ds_read_b64_tr_b16 a[108:109], v4 offset:8192
v_mfma_f32_16x16x32_bf16 v[204:207], a[116:119], a[52:55], v[204:207]
buffer_load_dwordx4 v15, s[56:59], s64 offen lds
v_mfma_f32_16x16x32_bf16 v[204:207], a[112:115], a[48:51], v[204:207]
ds_read_b64_tr_b16 a[110:111], v4 offset:9216
v_mfma_f32_16x16x32_bf16 v[196:199], a[112:115], a[40:43], v[196:199]
v_mfma_f32_16x16x32_bf16 v[196:199], a[116:119], a[44:47], v[196:199]
v_mfma_f32_16x16x32_bf16 v[188:191], a[116:119], a[36:39], v[188:191]
v_mfma_f32_16x16x32_bf16 v[188:191], a[112:115], a[32:35], v[188:191]
ds_read_b64_tr_b16 a[112:113], v5 offset:0
v_mfma_f32_16x16x32_bf16 v[216:219], a[32:35], a[72:75], v[216:219]
ds_read_b64_tr_b16 a[114:115], v5 offset:1024
v_mfma_f32_16x16x32_bf16 v[216:219], a[36:39], a[76:79], v[216:219]
s_add_u32 m0, s78, 155648
ds_read_b64_tr_b16 a[116:117], v5 offset:8192
v_mfma_f32_16x16x32_bf16 v[224:227], a[44:47], a[76:79], v[224:227]
s_add_u32 s64, s75, 3543040
ds_read_b64_tr_b16 a[118:119], v5 offset:9216
v_mfma_f32_16x16x32_bf16 v[224:227], a[40:43], a[72:75], v[224:227]
buffer_load_dwordx4 v23, s[60:63], s64 offen lds
v_mfma_f32_16x16x32_bf16 v[232:235], a[48:51], a[72:75], v[232:235]
v_mfma_f32_16x16x32_bf16 v[232:235], a[52:55], a[76:79], v[232:235]
v_mfma_f32_16x16x32_bf16 v[240:243], a[60:63], a[76:79], v[240:243]
v_mfma_f32_16x16x32_bf16 v[240:243], a[56:59], a[72:75], v[240:243]
ds_read_b64_tr_b16 a[72:73], v6 offset:0
v_mfma_f32_16x16x32_bf16 v[244:247], a[56:59], a[80:83], v[244:247]
ds_read_b64_tr_b16 a[74:75], v6 offset:1024
v_mfma_f32_16x16x32_bf16 v[244:247], a[60:63], a[84:87], v[244:247]
ds_read_b64_tr_b16 a[76:77], v6 offset:8192
v_mfma_f32_16x16x32_bf16 v[236:239], a[52:55], a[84:87], v[236:239]
s_xor_b32 m0, s77, 134144
ds_read_b64_tr_b16 a[78:79], v6 offset:9216
v_mfma_f32_16x16x32_bf16 v[236:239], a[48:51], a[80:83], v[236:239]
s_xor_b32 s64, s71, 4816896
v_mfma_f32_16x16x32_bf16 v[228:231], a[40:43], a[80:83], v[228:231]
buffer_load_dwordx4 v15, s[56:59], s64 offen lds
v_mfma_f32_16x16x32_bf16 v[228:231], a[44:47], a[84:87], v[228:231]
v_mfma_f32_16x16x32_bf16 v[220:223], a[36:39], a[84:87], v[220:223]
v_mfma_f32_16x16x32_bf16 v[220:223], a[32:35], a[80:83], v[220:223]
s_waitcnt lgkmcnt(4)
ds_read_b64_tr_b16 a[80:81], v7 offset:0
v_mfma_f32_16x16x32_bf16 v[152:155], a[88:91], a[32:35], v[152:155]
ds_read_b64_tr_b16 a[82:83], v7 offset:1024
v_mfma_f32_16x16x32_bf16 v[152:155], a[92:95], a[36:39], v[152:155]
ds_read_b64_tr_b16 a[84:85], v7 offset:8192
v_mfma_f32_16x16x32_bf16 v[160:163], a[92:95], a[44:47], v[160:163]
ds_read_b64_tr_b16 a[86:87], v7 offset:9216
v_mfma_f32_16x16x32_bf16 v[160:163], a[88:91], a[40:43], v[160:163]
v_mfma_f32_16x16x32_bf16 v[168:171], a[88:91], a[48:51], v[168:171]
v_mfma_f32_16x16x32_bf16 v[168:171], a[92:95], a[52:55], v[168:171]
v_mfma_f32_16x16x32_bf16 v[176:179], a[92:95], a[60:63], v[176:179]
s_xor_b32 m0, s84, 32768
v_mfma_f32_16x16x32_bf16 v[176:179], a[88:91], a[56:59], v[176:179]
s_xor_b32 s64, s72, 1152
ds_read_b64_tr_b16 a[88:89], v8 offset:0
v_mfma_f32_16x16x32_bf16 v[180:183], a[96:99], a[56:59], v[180:183]
s_add_u32 s65, s79, 27648
buffer_load_dwordx4 v12, s[48:51], s64 offen lds
v_mfma_f32_16x16x32_bf16 v[180:183], a[100:103], a[60:63], v[180:183]
buffer_store_dwordx4 a[208:211], v16, s[44:47], s65 offen sc1
v_mfma_f32_16x16x32_bf16 v[172:175], a[100:103], a[52:55], v[172:175]
ds_read_b64_tr_b16 a[90:91], v8 offset:1024
v_mfma_f32_16x16x32_bf16 v[172:175], a[96:99], a[48:51], v[172:175]
s_xor_b32 m0, s84, 33792
ds_read_b64_tr_b16 a[92:93], v8 offset:8192
v_mfma_f32_16x16x32_bf16 v[164:167], a[96:99], a[40:43], v[164:167]
s_xor_b32 s64, s72, 17536
ds_read_b64_tr_b16 a[94:95], v8 offset:9216
v_mfma_f32_16x16x32_bf16 v[164:167], a[100:103], a[44:47], v[164:167]
buffer_load_dwordx4 v13, s[48:51], s64 offen lds
v_mfma_f32_16x16x32_bf16 v[156:159], a[100:103], a[36:39], v[156:159]
v_mfma_f32_16x16x32_bf16 v[156:159], a[96:99], a[32:35], v[156:159]
ds_read_b64_tr_b16 a[96:97], v9 offset:0
v_mfma_f32_16x16x32_bf16 v[24:27], a[104:107], a[32:35], v[24:27]
s_xor_b32 m0, s84, 34816
ds_read_b64_tr_b16 a[98:99], v9 offset:1024
v_mfma_f32_16x16x32_bf16 v[24:27], a[108:111], a[36:39], v[24:27]
s_xor_b32 s64, s72, 132224
ds_read_b64_tr_b16 a[100:101], v9 offset:8192
v_mfma_f32_16x16x32_bf16 v[40:43], a[108:111], a[44:47], v[40:43]
buffer_load_dwordx4 v12, s[48:51], s64 offen lds
v_mfma_f32_16x16x32_bf16 v[40:43], a[104:107], a[40:43], v[40:43]
ds_read_b64_tr_b16 a[102:103], v9 offset:9216
v_mfma_f32_16x16x32_bf16 v[56:59], a[104:107], a[48:51], v[56:59]
v_mfma_f32_16x16x32_bf16 v[56:59], a[108:111], a[52:55], v[56:59]
s_xor_b32 m0, s84, 35840
v_mfma_f32_16x16x32_bf16 v[72:75], a[108:111], a[60:63], v[72:75]
s_waitcnt vmcnt(12)
s_xor_b32 s64, s72, 148608
ds_read_b128 a[0:3], v2 offset:0
v_mfma_f32_16x16x32_bf16 v[72:75], a[104:107], a[56:59], v[72:75]
buffer_load_dwordx4 v13, s[48:51], s64 offen lds
v_mfma_f32_16x16x32_bf16 v[136:139], a[112:115], a[56:59], v[136:139]
ds_read_b128 a[4:7], v3 offset:0
v_mfma_f32_16x16x32_bf16 v[136:139], a[116:119], a[60:63], v[136:139]
ds_read_b128 a[8:11], v2 offset:2048
v_mfma_f32_16x16x32_bf16 v[120:123], a[116:119], a[52:55], v[120:123]
s_xor_b32 m0, s84, 36864
ds_read_b128 a[12:15], v3 offset:2048
v_mfma_f32_16x16x32_bf16 v[120:123], a[112:115], a[48:51], v[120:123]
s_xor_b32 s64, s73, 1152
ds_read_b128 a[16:19], v2 offset:4096
v_mfma_f32_16x16x32_bf16 v[104:107], a[112:115], a[40:43], v[104:107]
buffer_load_dwordx4 v12, s[48:51], s64 offen lds
v_mfma_f32_16x16x32_bf16 v[104:107], a[116:119], a[44:47], v[104:107]
ds_read_b128 a[20:23], v3 offset:4096
v_mfma_f32_16x16x32_bf16 v[88:91], a[116:119], a[36:39], v[88:91]
ds_read_b128 a[24:27], v2 offset:6144
v_mfma_f32_16x16x32_bf16 v[88:91], a[112:115], a[32:35], v[88:91]
s_waitcnt lgkmcnt(7)
s_xor_b32 m0, s84, 37888
ds_read_b128 a[28:31], v3 offset:6144
v_mfma_f32_16x16x32_bf16 v[28:31], a[72:75], a[32:35], v[28:31]
s_xor_b32 s64, s73, 17536
ds_read_b64_tr_b16 a[104:105], v10 offset:0
v_mfma_f32_16x16x32_bf16 v[28:31], a[76:79], a[36:39], v[28:31]
buffer_load_dwordx4 v13, s[48:51], s64 offen lds
v_mfma_f32_16x16x32_bf16 v[44:47], a[76:79], a[44:47], v[44:47]
ds_read_b64_tr_b16 a[106:107], v10 offset:1024
v_mfma_f32_16x16x32_bf16 v[44:47], a[72:75], a[40:43], v[44:47]
ds_read_b64_tr_b16 a[108:109], v10 offset:8192
v_mfma_f32_16x16x32_bf16 v[60:63], a[72:75], a[48:51], v[60:63]
s_xor_b32 m0, s84, 38912
ds_read_b64_tr_b16 a[110:111], v10 offset:9216
v_mfma_f32_16x16x32_bf16 v[60:63], a[76:79], a[52:55], v[60:63]
s_xor_b32 s64, s73, 132224
ds_read_b64_tr_b16 a[112:113], v11 offset:0
v_mfma_f32_16x16x32_bf16 v[76:79], a[76:79], a[60:63], v[76:79]
buffer_load_dwordx4 v12, s[48:51], s64 offen lds
v_mfma_f32_16x16x32_bf16 v[76:79], a[72:75], a[56:59], v[76:79]
ds_read_b64_tr_b16 a[114:115], v11 offset:1024
v_mfma_f32_16x16x32_bf16 v[140:143], a[80:83], a[56:59], v[140:143]
ds_read_b64_tr_b16 a[116:117], v11 offset:8192
v_mfma_f32_16x16x32_bf16 v[140:143], a[84:87], a[60:63], v[140:143]
s_xor_b32 m0, s84, 39936
ds_read_b64_tr_b16 a[118:119], v11 offset:9216
v_mfma_f32_16x16x32_bf16 v[124:127], a[84:87], a[52:55], v[124:127]
s_xor_b32 s64, s73, 148608
v_mfma_f32_16x16x32_bf16 v[124:127], a[80:83], a[48:51], v[124:127]
buffer_load_dwordx4 v13, s[48:51], s64 offen lds
v_mfma_f32_16x16x32_bf16 v[108:111], a[80:83], a[40:43], v[108:111]
v_mfma_f32_16x16x32_bf16 v[108:111], a[84:87], a[44:47], v[108:111]
v_mfma_f32_16x16x32_bf16 v[92:95], a[84:87], a[36:39], v[92:95]
v_mfma_f32_16x16x32_bf16 v[92:95], a[80:83], a[32:35], v[92:95]
v_mfma_f32_16x16x32_bf16 v[32:35], a[88:91], a[32:35], v[32:35]
v_mfma_f32_16x16x32_bf16 v[32:35], a[92:95], a[36:39], v[32:35]
v_mfma_f32_16x16x32_bf16 v[48:51], a[92:95], a[44:47], v[48:51]
s_waitcnt lgkmcnt(0)
s_barrier
v_mfma_f32_16x16x32_bf16 v[48:51], a[88:91], a[40:43], v[48:51]
s_xor_b32 m0, s77, 65536
s_add_u32 s65, s79, 11264
ds_read_b64_tr_b16 a[72:73], v19 offset:36864
v_mfma_f32_16x16x32_bf16 v[64:67], a[88:91], a[48:51], v[64:67]
s_xor_b32 s64, s71, 5242880
buffer_store_dwordx4 a[212:215], v16, s[44:47], s65 offen sc1
v_mfma_f32_16x16x32_bf16 v[64:67], a[92:95], a[52:55], v[64:67]
buffer_load_dwordx4 v14, s[56:59], s64 offen lds
v_mfma_f32_16x16x32_bf16 v[80:83], a[92:95], a[60:63], v[80:83]
ds_read_b64_tr_b16 a[74:75], v19 offset:37120
v_mfma_f32_16x16x32_bf16 v[80:83], a[88:91], a[56:59], v[80:83]
buffer_load_dword v1, off, s[52:55], s78 sc1
v_mfma_f32_16x16x32_bf16 v[144:147], a[96:99], a[56:59], v[144:147]
ds_read_b64_tr_b16 a[76:77], v19 offset:38912
v_mfma_f32_16x16x32_bf16 v[144:147], a[100:103], a[60:63], v[144:147]
ds_read_b64_tr_b16 a[78:79], v19 offset:39168
v_mfma_f32_16x16x32_bf16 v[128:131], a[100:103], a[52:55], v[128:131]
ds_read_b64_tr_b16 a[80:81], v20 offset:36864
v_mfma_f32_16x16x32_bf16 v[128:131], a[96:99], a[48:51], v[128:131]
ds_read_b64_tr_b16 a[82:83], v20 offset:37120
v_mfma_f32_16x16x32_bf16 v[112:115], a[96:99], a[40:43], v[112:115]
s_add_u32 m0, s78, 81920
ds_read_b64_tr_b16 a[84:85], v20 offset:38912
v_mfma_f32_16x16x32_bf16 v[112:115], a[100:103], a[44:47], v[112:115]
s_add_u32 s64, s75, 3932160
ds_read_b64_tr_b16 a[86:87], v20 offset:39168
v_mfma_f32_16x16x32_bf16 v[96:99], a[100:103], a[36:39], v[96:99]
buffer_load_dwordx4 v23, s[60:63], s64 offen lds
v_mfma_f32_16x16x32_bf16 v[96:99], a[96:99], a[32:35], v[96:99]
ds_read_b64_tr_b16 a[88:89], v19 offset:40960
v_mfma_f32_16x16x32_bf16 v[36:39], a[104:107], a[32:35], v[36:39]
ds_read_b64_tr_b16 a[90:91], v19 offset:41216
v_mfma_f32_16x16x32_bf16 v[36:39], a[108:111], a[36:39], v[36:39]
ds_read_b64_tr_b16 a[92:93], v19 offset:43008
v_mfma_f32_16x16x32_bf16 v[52:55], a[108:111], a[44:47], v[52:55]
ds_read_b64_tr_b16 a[94:95], v19 offset:43264
v_mfma_f32_16x16x32_bf16 v[52:55], a[104:107], a[40:43], v[52:55]
ds_read_b64_tr_b16 a[96:97], v20 offset:40960
v_mfma_f32_16x16x32_bf16 v[68:71], a[104:107], a[48:51], v[68:71]
ds_read_b64_tr_b16 a[98:99], v20 offset:41216
v_mfma_f32_16x16x32_bf16 v[68:71], a[108:111], a[52:55], v[68:71]
s_xor_b32 m0, s77, 66560
ds_read_b64_tr_b16 a[100:101], v20 offset:43008
v_mfma_f32_16x16x32_bf16 v[84:87], a[108:111], a[60:63], v[84:87]
s_xor_b32 s64, s71, 5275648
ds_read_b64_tr_b16 a[102:103], v20 offset:43264
v_mfma_f32_16x16x32_bf16 v[84:87], a[104:107], a[56:59], v[84:87]
buffer_load_dwordx4 v14, s[56:59], s64 offen lds
v_mfma_f32_16x16x32_bf16 v[148:151], a[112:115], a[56:59], v[148:151]
ds_read_b64_tr_b16 a[104:105], v19 offset:32768
v_mfma_f32_16x16x32_bf16 v[148:151], a[116:119], a[60:63], v[148:151]
ds_read_b64_tr_b16 a[106:107], v19 offset:33024
v_mfma_f32_16x16x32_bf16 v[132:135], a[116:119], a[52:55], v[132:135]
ds_read_b64_tr_b16 a[108:109], v19 offset:34816
v_mfma_f32_16x16x32_bf16 v[132:135], a[112:115], a[48:51], v[132:135]
ds_read_b64_tr_b16 a[110:111], v19 offset:35072
v_mfma_f32_16x16x32_bf16 v[116:119], a[112:115], a[40:43], v[116:119]
v_mfma_f32_16x16x32_bf16 v[116:119], a[116:119], a[44:47], v[116:119]
v_mfma_f32_16x16x32_bf16 v[100:103], a[116:119], a[36:39], v[100:103]
s_add_u32 m0, s78, 86016
v_mfma_f32_16x16x32_bf16 v[100:103], a[112:115], a[32:35], v[100:103]
s_waitcnt lgkmcnt(5)
s_add_u32 s64, s75, 3934208
ds_read_b64_tr_b16 a[112:113], v20 offset:32768
v_mfma_f32_16x16x32_bf16 v[184:187], a[72:75], a[0:3], v[184:187]
buffer_load_dwordx4 v23, s[60:63], s64 offen lds
v_mfma_f32_16x16x32_bf16 v[184:187], a[76:79], a[4:7], v[184:187]
ds_read_b64_tr_b16 a[114:115], v20 offset:33024
v_mfma_f32_16x16x32_bf16 v[192:195], a[76:79], a[12:15], v[192:195]
ds_read_b64_tr_b16 a[116:117], v20 offset:34816
v_mfma_f32_16x16x32_bf16 v[192:195], a[72:75], a[8:11], v[192:195]
ds_read_b64_tr_b16 a[118:119], v20 offset:35072
v_mfma_f32_16x16x32_bf16 v[200:203], a[72:75], a[16:19], v[200:203]
v_mfma_f32_16x16x32_bf16 v[200:203], a[76:79], a[20:23], v[200:203]
v_mfma_f32_16x16x32_bf16 v[208:211], a[76:79], a[28:31], v[208:211]
v_mfma_f32_16x16x32_bf16 v[208:211], a[72:75], a[24:27], v[208:211]
ds_read_b64_tr_b16 a[72:73], v4 offset:32768
v_mfma_f32_16x16x32_bf16 v[212:215], a[80:83], a[24:27], v[212:215]
s_xor_b32 m0, s77, 67584
ds_read_b64_tr_b16 a[74:75], v4 offset:33792
v_mfma_f32_16x16x32_bf16 v[212:215], a[84:87], a[28:31], v[212:215]
s_xor_b32 s64, s71, 5308416
ds_read_b64_tr_b16 a[76:77], v4 offset:40960
v_mfma_f32_16x16x32_bf16 v[204:207], a[84:87], a[20:23], v[204:207]
buffer_load_dwordx4 v15, s[56:59], s64 offen lds
v_mfma_f32_16x16x32_bf16 v[204:207], a[80:83], a[16:19], v[204:207]
ds_read_b64_tr_b16 a[78:79], v4 offset:41984
v_mfma_f32_16x16x32_bf16 v[196:199], a[80:83], a[8:11], v[196:199]
v_mfma_f32_16x16x32_bf16 v[196:199], a[84:87], a[12:15], v[196:199]
v_mfma_f32_16x16x32_bf16 v[188:191], a[84:87], a[4:7], v[188:191]
v_mfma_f32_16x16x32_bf16 v[188:191], a[80:83], a[0:3], v[188:191]
ds_read_b64_tr_b16 a[80:81], v5 offset:32768
v_mfma_f32_16x16x32_bf16 v[216:219], a[0:3], a[88:91], v[216:219]
s_add_u32 s65, s79, 28672
ds_read_b64_tr_b16 a[82:83], v5 offset:33792
v_mfma_f32_16x16x32_bf16 v[216:219], a[4:7], a[92:95], v[216:219]
s_add_u32 m0, s78, 90112
buffer_store_dwordx4 a[216:219], v16, s[44:47], s65 offen sc1
v_mfma_f32_16x16x32_bf16 v[224:227], a[12:15], a[92:95], v[224:227]
s_add_u32 s64, s75, 3936256
ds_read_b64_tr_b16 a[84:85], v5 offset:40960
v_mfma_f32_16x16x32_bf16 v[224:227], a[8:11], a[88:91], v[224:227]
buffer_load_dwordx4 v23, s[60:63], s64 offen lds
v_mfma_f32_16x16x32_bf16 v[232:235], a[16:19], a[88:91], v[232:235]
s_branch L_po10
L_pg10:
s_branch L_tr1
L_po10:
ds_read_b64_tr_b16 a[86:87], v5 offset:41984
v_mfma_f32_16x16x32_bf16 v[232:235], a[20:23], a[92:95], v[232:235]
v_mfma_f32_16x16x32_bf16 v[240:243], a[28:31], a[92:95], v[240:243]
v_mfma_f32_16x16x32_bf16 v[240:243], a[24:27], a[88:91], v[240:243]
ds_read_b64_tr_b16 a[88:89], v6 offset:32768
v_mfma_f32_16x16x32_bf16 v[244:247], a[24:27], a[96:99], v[244:247]
s_waitcnt lgkmcnt(5)
ds_read_b64_tr_b16 a[90:91], v6 offset:33792
v_mfma_f32_16x16x32_bf16 v[244:247], a[28:31], a[100:103], v[244:247]
ds_read_b64_tr_b16 a[92:93], v6 offset:40960
v_add_u32 v19, 0x8000, v19
v_mfma_f32_16x16x32_bf16 v[236:239], a[20:23], a[100:103], v[236:239]
s_xor_b32 m0, s77, 68608
ds_read_b64_tr_b16 a[94:95], v6 offset:41984
v_mfma_f32_16x16x32_bf16 v[236:239], a[16:19], a[96:99], v[236:239]
s_xor_b32 s64, s71, 5341184
v_mfma_f32_16x16x32_bf16 v[228:231], a[8:11], a[96:99], v[228:231]
buffer_load_dwordx4 v15, s[56:59], s64 offen lds
v_mfma_f32_16x16x32_bf16 v[228:231], a[12:15], a[100:103], v[228:231]
v_mfma_f32_16x16x32_bf16 v[220:223], a[4:7], a[100:103], v[220:223]
v_mfma_f32_16x16x32_bf16 v[220:223], a[0:3], a[96:99], v[220:223]
ds_read_b64_tr_b16 a[96:97], v7 offset:32768
v_mfma_f32_16x16x32_bf16 v[152:155], a[104:107], a[0:3], v[152:155]
ds_read_b64_tr_b16 a[98:99], v7 offset:33792
v_mfma_f32_16x16x32_bf16 v[152:155], a[108:111], a[4:7], v[152:155]
ds_read_b64_tr_b16 a[100:101], v7 offset:40960
v_add_u32 v20, 0x8000, v20
v_mfma_f32_16x16x32_bf16 v[160:163], a[108:111], a[12:15], v[160:163]
ds_read_b64_tr_b16 a[102:103], v7 offset:41984
v_mfma_f32_16x16x32_bf16 v[160:163], a[104:107], a[8:11], v[160:163]
v_mfma_f32_16x16x32_bf16 v[168:171], a[104:107], a[16:19], v[168:171]
v_mfma_f32_16x16x32_bf16 v[168:171], a[108:111], a[20:23], v[168:171]
v_mfma_f32_16x16x32_bf16 v[176:179], a[108:111], a[28:31], v[176:179]
s_xor_b32 m0, s84, 0
v_mfma_f32_16x16x32_bf16 v[176:179], a[104:107], a[24:27], v[176:179]
s_xor_b32 s64, s72, 1280
ds_read_b64_tr_b16 a[104:105], v8 offset:32768
v_mfma_f32_16x16x32_bf16 v[180:183], a[112:115], a[24:27], v[180:183]
buffer_load_dwordx4 v12, s[48:51], s64 offen lds
v_mfma_f32_16x16x32_bf16 v[180:183], a[116:119], a[28:31], v[180:183]
ds_read_b64_tr_b16 a[106:107], v8 offset:33792
v_add_u32 v4, 0x8000, v4
v_mfma_f32_16x16x32_bf16 v[172:175], a[116:119], a[20:23], v[172:175]
ds_read_b64_tr_b16 a[108:109], v8 offset:40960
v_mfma_f32_16x16x32_bf16 v[172:175], a[112:115], a[16:19], v[172:175]
s_xor_b32 m0, s84, 1024
ds_read_b64_tr_b16 a[110:111], v8 offset:41984
v_mfma_f32_16x16x32_bf16 v[164:167], a[112:115], a[8:11], v[164:167]
s_xor_b32 s64, s72, 17664
v_mfma_f32_16x16x32_bf16 v[164:167], a[116:119], a[12:15], v[164:167]
buffer_load_dwordx4 v13, s[48:51], s64 offen lds
v_mfma_f32_16x16x32_bf16 v[156:159], a[116:119], a[4:7], v[156:159]
v_mfma_f32_16x16x32_bf16 v[156:159], a[112:115], a[0:3], v[156:159]
ds_read_b64_tr_b16 a[112:113], v9 offset:32768
v_mfma_f32_16x16x32_bf16 v[24:27], a[72:75], a[0:3], v[24:27]
s_xor_b32 m0, s84, 2048
ds_read_b64_tr_b16 a[114:115], v9 offset:33792
v_mfma_f32_16x16x32_bf16 v[24:27], a[76:79], a[4:7], v[24:27]
s_xor_b32 s64, s72, 132352
ds_read_b64_tr_b16 a[116:117], v9 offset:40960
v_add_u32 v5, 0x8000, v5
v_mfma_f32_16x16x32_bf16 v[40:43], a[76:79], a[12:15], v[40:43]
buffer_load_dwordx4 v12, s[48:51], s64 offen lds
v_mfma_f32_16x16x32_bf16 v[40:43], a[72:75], a[8:11], v[40:43]
ds_read_b64_tr_b16 a[118:119], v9 offset:41984
v_mfma_f32_16x16x32_bf16 v[56:59], a[72:75], a[16:19], v[56:59]
v_mfma_f32_16x16x32_bf16 v[56:59], a[76:79], a[20:23], v[56:59]
s_xor_b32 m0, s84, 3072
v_mfma_f32_16x16x32_bf16 v[72:75], a[76:79], a[28:31], v[72:75]
s_waitcnt vmcnt(13)
s_xor_b32 s64, s72, 148736
ds_read_b128 a[32:35], v2 offset:32768
v_mfma_f32_16x16x32_bf16 v[72:75], a[72:75], a[24:27], v[72:75]
s_waitcnt lgkmcnt(5)
buffer_load_dwordx4 v13, s[48:51], s64 offen lds
v_mfma_f32_16x16x32_bf16 v[136:139], a[80:83], a[24:27], v[136:139]
ds_read_b128 a[36:39], v3 offset:32768
v_mfma_f32_16x16x32_bf16 v[136:139], a[84:87], a[28:31], v[136:139]
ds_read_b128 a[40:43], v2 offset:34816
v_add_u32 v6, 0x8000, v6
v_mfma_f32_16x16x32_bf16 v[120:123], a[84:87], a[20:23], v[120:123]
s_xor_b32 m0, s84, 4096
ds_read_b128 a[44:47], v3 offset:34816
v_mfma_f32_16x16x32_bf16 v[120:123], a[80:83], a[16:19], v[120:123]
s_xor_b32 s64, s73, 1280
ds_read_b128 a[48:51], v2 offset:36864
v_mfma_f32_16x16x32_bf16 v[104:107], a[80:83], a[8:11], v[104:107]
buffer_load_dwordx4 v12, s[48:51], s64 offen lds
v_mfma_f32_16x16x32_bf16 v[104:107], a[84:87], a[12:15], v[104:107]
s_add_u32 s65, s79, 29696
ds_read_b128 a[52:55], v3 offset:36864
v_mfma_f32_16x16x32_bf16 v[88:91], a[84:87], a[4:7], v[88:91]
buffer_store_dwordx4 a[220:223], v16, s[44:47], s65 offen sc1
v_mfma_f32_16x16x32_bf16 v[88:91], a[80:83], a[0:3], v[88:91]
s_xor_b32 m0, s84, 5120
ds_read_b128 a[56:59], v2 offset:38912
v_mfma_f32_16x16x32_bf16 v[28:31], a[88:91], a[0:3], v[28:31]
s_xor_b32 s64, s73, 17664
ds_read_b128 a[60:63], v3 offset:38912
v_mfma_f32_16x16x32_bf16 v[28:31], a[92:95], a[4:7], v[28:31]
buffer_load_dwordx4 v13, s[48:51], s64 offen lds
v_mfma_f32_16x16x32_bf16 v[44:47], a[92:95], a[12:15], v[44:47]
ds_read_b64_tr_b16 a[72:73], v10 offset:32768
v_add_u32 v7, 0x8000, v7
v_mfma_f32_16x16x32_bf16 v[44:47], a[88:91], a[8:11], v[44:47]
ds_read_b64_tr_b16 a[74:75], v10 offset:33792
v_mfma_f32_16x16x32_bf16 v[60:63], a[88:91], a[16:19], v[60:63]
s_xor_b32 m0, s84, 6144
ds_read_b64_tr_b16 a[76:77], v10 offset:40960
v_mfma_f32_16x16x32_bf16 v[60:63], a[92:95], a[20:23], v[60:63]
s_xor_b32 s64, s73, 132352
ds_read_b64_tr_b16 a[78:79], v10 offset:41984
v_mfma_f32_16x16x32_bf16 v[76:79], a[92:95], a[28:31], v[76:79]
buffer_load_dwordx4 v12, s[48:51], s64 offen lds
v_mfma_f32_16x16x32_bf16 v[76:79], a[88:91], a[24:27], v[76:79]
ds_read_b64_tr_b16 a[80:81], v11 offset:32768
v_mfma_f32_16x16x32_bf16 v[140:143], a[96:99], a[24:27], v[140:143]
ds_read_b64_tr_b16 a[82:83], v11 offset:33792
v_mfma_f32_16x16x32_bf16 v[140:143], a[100:103], a[28:31], v[140:143]
s_xor_b32 m0, s84, 7168
ds_read_b64_tr_b16 a[84:85], v11 offset:40960
v_add_u32 v8, 0x8000, v8
v_mfma_f32_16x16x32_bf16 v[124:127], a[100:103], a[20:23], v[124:127]
s_xor_b32 s64, s73, 148736
ds_read_b64_tr_b16 a[86:87], v11 offset:41984
v_mfma_f32_16x16x32_bf16 v[124:127], a[96:99], a[16:19], v[124:127]
buffer_load_dwordx4 v13, s[48:51], s64 offen lds
v_mfma_f32_16x16x32_bf16 v[108:111], a[96:99], a[8:11], v[108:111]
v_mfma_f32_16x16x32_bf16 v[108:111], a[100:103], a[12:15], v[108:111]
v_mfma_f32_16x16x32_bf16 v[92:95], a[100:103], a[4:7], v[92:95]
v_add_u32 v9, 0x8000, v9
v_add_u32 v10, 0x8000, v10
v_mfma_f32_16x16x32_bf16 v[92:95], a[96:99], a[0:3], v[92:95]
v_add_u32 v11, 0x8000, v11
v_mfma_f32_16x16x32_bf16 v[32:35], a[104:107], a[0:3], v[32:35]
v_mfma_f32_16x16x32_bf16 v[32:35], a[108:111], a[4:7], v[32:35]
v_mfma_f32_16x16x32_bf16 v[48:51], a[108:111], a[12:15], v[48:51]
s_waitcnt lgkmcnt(0)
s_barrier
v_mfma_f32_16x16x32_bf16 v[48:51], a[104:107], a[8:11], v[48:51]
s_xor_b32 m0, s77, 98304
ds_read_b64_tr_b16 a[88:89], v19 offset:36864
v_mfma_f32_16x16x32_bf16 v[64:67], a[104:107], a[16:19], v[64:67]
s_xor_b32 s64, s71, 5767168
ds_read_b64_tr_b16 a[90:91], v19 offset:37120
v_mfma_f32_16x16x32_bf16 v[64:67], a[108:111], a[20:23], v[64:67]
buffer_load_dwordx4 v14, s[56:59], s64 offen lds
v_mfma_f32_16x16x32_bf16 v[80:83], a[108:111], a[28:31], v[80:83]
ds_read_b64_tr_b16 a[92:93], v19 offset:38912
v_mfma_f32_16x16x32_bf16 v[80:83], a[104:107], a[24:27], v[80:83]
ds_read_b64_tr_b16 a[94:95], v19 offset:39168
v_mfma_f32_16x16x32_bf16 v[144:147], a[112:115], a[24:27], v[144:147]
ds_read_b64_tr_b16 a[96:97], v20 offset:36864
v_mfma_f32_16x16x32_bf16 v[144:147], a[116:119], a[28:31], v[144:147]
ds_read_b64_tr_b16 a[98:99], v20 offset:37120
v_mfma_f32_16x16x32_bf16 v[128:131], a[116:119], a[20:23], v[128:131]
ds_read_b64_tr_b16 a[100:101], v20 offset:38912
v_mfma_f32_16x16x32_bf16 v[128:131], a[112:115], a[16:19], v[128:131]
ds_read_b64_tr_b16 a[102:103], v20 offset:39168
v_mfma_f32_16x16x32_bf16 v[112:115], a[112:115], a[8:11], v[112:115]
s_add_u32 m0, s78, 114688
ds_read_b64_tr_b16 a[104:105], v19 offset:40960
v_mfma_f32_16x16x32_bf16 v[112:115], a[116:119], a[12:15], v[112:115]
s_add_u32 s64, s75, 4325376
ds_read_b64_tr_b16 a[106:107], v19 offset:41216
v_mfma_f32_16x16x32_bf16 v[96:99], a[116:119], a[4:7], v[96:99]
buffer_load_dwordx4 v23, s[60:63], s64 offen lds
v_mfma_f32_16x16x32_bf16 v[96:99], a[112:115], a[0:3], v[96:99]
ds_read_b64_tr_b16 a[108:109], v19 offset:43008
v_mfma_f32_16x16x32_bf16 v[36:39], a[72:75], a[0:3], v[36:39]
ds_read_b64_tr_b16 a[110:111], v19 offset:43264
v_mfma_f32_16x16x32_bf16 v[36:39], a[76:79], a[4:7], v[36:39]
ds_read_b64_tr_b16 a[112:113], v20 offset:40960
v_mfma_f32_16x16x32_bf16 v[52:55], a[76:79], a[12:15], v[52:55]
ds_read_b64_tr_b16 a[114:115], v20 offset:41216
v_mfma_f32_16x16x32_bf16 v[52:55], a[72:75], a[8:11], v[52:55]
ds_read_b64_tr_b16 a[116:117], v20 offset:43008
v_mfma_f32_16x16x32_bf16 v[68:71], a[72:75], a[16:19], v[68:71]
ds_read_b64_tr_b16 a[118:119], v20 offset:43264
v_mfma_f32_16x16x32_bf16 v[68:71], a[76:79], a[20:23], v[68:71]
s_xor_b32 m0, s77, 99328
v_mfma_f32_16x16x32_bf16 v[84:87], a[76:79], a[28:31], v[84:87]
s_xor_b32 s64, s71, 5799936
v_mfma_f32_16x16x32_bf16 v[84:87], a[72:75], a[24:27], v[84:87]
buffer_load_dwordx4 v14, s[56:59], s64 offen lds
v_mfma_f32_16x16x32_bf16 v[148:151], a[80:83], a[24:27], v[148:151]
ds_read_b64_tr_b16 a[72:73], v19 offset:32768
v_mfma_f32_16x16x32_bf16 v[148:151], a[84:87], a[28:31], v[148:151]
ds_read_b64_tr_b16 a[74:75], v19 offset:33024
v_mfma_f32_16x16x32_bf16 v[132:135], a[84:87], a[20:23], v[132:135]
s_add_u32 s65, s79, 13312
ds_read_b64_tr_b16 a[76:77], v19 offset:34816
v_mfma_f32_16x16x32_bf16 v[132:135], a[80:83], a[16:19], v[132:135]
buffer_store_dwordx4 a[224:227], v16, s[44:47], s65 offen sc1
v_mfma_f32_16x16x32_bf16 v[116:119], a[80:83], a[8:11], v[116:119]
ds_read_b64_tr_b16 a[78:79], v19 offset:35072
v_mfma_f32_16x16x32_bf16 v[116:119], a[84:87], a[12:15], v[116:119]
v_mfma_f32_16x16x32_bf16 v[100:103], a[84:87], a[4:7], v[100:103]
s_add_u32 m0, s78, 118784
v_mfma_f32_16x16x32_bf16 v[100:103], a[80:83], a[0:3], v[100:103]
s_waitcnt lgkmcnt(4)
s_add_u32 s64, s75, 4327424
ds_read_b64_tr_b16 a[80:81], v20 offset:32768
v_mfma_f32_16x16x32_bf16 v[184:187], a[88:91], a[32:35], v[184:187]
buffer_load_dwordx4 v23, s[60:63], s64 offen lds
v_mfma_f32_16x16x32_bf16 v[184:187], a[92:95], a[36:39], v[184:187]
ds_read_b64_tr_b16 a[82:83], v20 offset:33024
v_mfma_f32_16x16x32_bf16 v[192:195], a[92:95], a[44:47], v[192:195]
ds_read_b64_tr_b16 a[84:85], v20 offset:34816
v_mfma_f32_16x16x32_bf16 v[192:195], a[88:91], a[40:43], v[192:195]
ds_read_b64_tr_b16 a[86:87], v20 offset:35072
v_mfma_f32_16x16x32_bf16 v[200:203], a[88:91], a[48:51], v[200:203]
v_mfma_f32_16x16x32_bf16 v[200:203], a[92:95], a[52:55], v[200:203]
v_mfma_f32_16x16x32_bf16 v[208:211], a[92:95], a[60:63], v[208:211]
v_mfma_f32_16x16x32_bf16 v[208:211], a[88:91], a[56:59], v[208:211]
ds_read_b64_tr_b16 a[88:89], v4 offset:32768
v_mfma_f32_16x16x32_bf16 v[212:215], a[96:99], a[56:59], v[212:215]
s_xor_b32 m0, s77, 100352
ds_read_b64_tr_b16 a[90:91], v4 offset:33792
v_mfma_f32_16x16x32_bf16 v[212:215], a[100:103], a[60:63], v[212:215]
s_xor_b32 s64, s71, 5832704
ds_read_b64_tr_b16 a[92:93], v4 offset:40960
v_mfma_f32_16x16x32_bf16 v[204:207], a[100:103], a[52:55], v[204:207]
buffer_load_dwordx4 v15, s[56:59], s64 offen lds
v_mfma_f32_16x16x32_bf16 v[204:207], a[96:99], a[48:51], v[204:207]
ds_read_b64_tr_b16 a[94:95], v4 offset:41984
v_mfma_f32_16x16x32_bf16 v[196:199], a[96:99], a[40:43], v[196:199]
v_mfma_f32_16x16x32_bf16 v[196:199], a[100:103], a[44:47], v[196:199]
v_mfma_f32_16x16x32_bf16 v[188:191], a[100:103], a[36:39], v[188:191]
v_mfma_f32_16x16x32_bf16 v[188:191], a[96:99], a[32:35], v[188:191]
ds_read_b64_tr_b16 a[96:97], v5 offset:32768
v_mfma_f32_16x16x32_bf16 v[216:219], a[32:35], a[104:107], v[216:219]
ds_read_b64_tr_b16 a[98:99], v5 offset:33792
v_mfma_f32_16x16x32_bf16 v[216:219], a[36:39], a[108:111], v[216:219]
s_add_u32 m0, s78, 122880
ds_read_b64_tr_b16 a[100:101], v5 offset:40960
v_mfma_f32_16x16x32_bf16 v[224:227], a[44:47], a[108:111], v[224:227]
s_add_u32 s64, s75, 4329472
ds_read_b64_tr_b16 a[102:103], v5 offset:41984
v_mfma_f32_16x16x32_bf16 v[224:227], a[40:43], a[104:107], v[224:227]
buffer_load_dwordx4 v23, s[60:63], s64 offen lds
v_mfma_f32_16x16x32_bf16 v[232:235], a[48:51], a[104:107], v[232:235]
v_mfma_f32_16x16x32_bf16 v[232:235], a[52:55], a[108:111], v[232:235]
v_mfma_f32_16x16x32_bf16 v[240:243], a[60:63], a[108:111], v[240:243]
v_mfma_f32_16x16x32_bf16 v[240:243], a[56:59], a[104:107], v[240:243]
ds_read_b64_tr_b16 a[104:105], v6 offset:32768
v_mfma_f32_16x16x32_bf16 v[244:247], a[56:59], a[112:115], v[244:247]
ds_read_b64_tr_b16 a[106:107], v6 offset:33792
v_mfma_f32_16x16x32_bf16 v[244:247], a[60:63], a[116:119], v[244:247]
ds_read_b64_tr_b16 a[108:109], v6 offset:40960
v_subrev_u32 v19, 0x8000, v19
v_mfma_f32_16x16x32_bf16 v[236:239], a[52:55], a[116:119], v[236:239]
s_xor_b32 m0, s77, 101376
ds_read_b64_tr_b16 a[110:111], v6 offset:41984
v_mfma_f32_16x16x32_bf16 v[236:239], a[48:51], a[112:115], v[236:239]
s_xor_b32 s64, s71, 5865472
v_mfma_f32_16x16x32_bf16 v[228:231], a[40:43], a[112:115], v[228:231]
buffer_load_dwordx4 v15, s[56:59], s64 offen lds
v_mfma_f32_16x16x32_bf16 v[228:231], a[44:47], a[116:119], v[228:231]
v_mfma_f32_16x16x32_bf16 v[220:223], a[36:39], a[116:119], v[220:223]
v_mfma_f32_16x16x32_bf16 v[220:223], a[32:35], a[112:115], v[220:223]
s_waitcnt lgkmcnt(4)
ds_read_b64_tr_b16 a[112:113], v7 offset:32768
v_mfma_f32_16x16x32_bf16 v[152:155], a[72:75], a[32:35], v[152:155]
ds_read_b64_tr_b16 a[114:115], v7 offset:33792
v_mfma_f32_16x16x32_bf16 v[152:155], a[76:79], a[36:39], v[152:155]
ds_read_b64_tr_b16 a[116:117], v7 offset:40960
v_subrev_u32 v20, 0x8000, v20
v_mfma_f32_16x16x32_bf16 v[160:163], a[76:79], a[44:47], v[160:163]
ds_read_b64_tr_b16 a[118:119], v7 offset:41984
v_mfma_f32_16x16x32_bf16 v[160:163], a[72:75], a[40:43], v[160:163]
v_mfma_f32_16x16x32_bf16 v[168:171], a[72:75], a[48:51], v[168:171]
v_mfma_f32_16x16x32_bf16 v[168:171], a[76:79], a[52:55], v[168:171]
v_mfma_f32_16x16x32_bf16 v[176:179], a[76:79], a[60:63], v[176:179]
s_xor_b32 m0, s84, 32768
s_add_u32 s65, s79, 30720
v_mfma_f32_16x16x32_bf16 v[176:179], a[72:75], a[56:59], v[176:179]
s_xor_b32 s64, s72, 1408
buffer_store_dwordx4 a[228:231], v16, s[44:47], s65 offen sc1
v_mfma_f32_16x16x32_bf16 v[180:183], a[80:83], a[56:59], v[180:183]
buffer_load_dwordx4 v12, s[48:51], s64 offen lds
v_mfma_f32_16x16x32_bf16 v[180:183], a[84:87], a[60:63], v[180:183]
ds_read_b64_tr_b16 a[72:73], v8 offset:32768
v_subrev_u32 v4, 0x8000, v4
v_mfma_f32_16x16x32_bf16 v[172:175], a[84:87], a[52:55], v[172:175]
ds_read_b64_tr_b16 a[74:75], v8 offset:33792
v_mfma_f32_16x16x32_bf16 v[172:175], a[80:83], a[48:51], v[172:175]
s_xor_b32 m0, s84, 33792
ds_read_b64_tr_b16 a[76:77], v8 offset:40960
v_mfma_f32_16x16x32_bf16 v[164:167], a[80:83], a[40:43], v[164:167]
s_xor_b32 s64, s72, 17792
ds_read_b64_tr_b16 a[78:79], v8 offset:41984
v_mfma_f32_16x16x32_bf16 v[164:167], a[84:87], a[44:47], v[164:167]
buffer_load_dwordx4 v13, s[48:51], s64 offen lds
v_mfma_f32_16x16x32_bf16 v[156:159], a[84:87], a[36:39], v[156:159]
v_mfma_f32_16x16x32_bf16 v[156:159], a[80:83], a[32:35], v[156:159]
ds_read_b64_tr_b16 a[80:81], v9 offset:32768
v_mfma_f32_16x16x32_bf16 v[24:27], a[88:91], a[32:35], v[24:27]
s_xor_b32 m0, s84, 34816
ds_read_b64_tr_b16 a[82:83], v9 offset:33792
v_mfma_f32_16x16x32_bf16 v[24:27], a[92:95], a[36:39], v[24:27]
s_xor_b32 s64, s72, 132480
ds_read_b64_tr_b16 a[84:85], v9 offset:40960
v_subrev_u32 v5, 0x8000, v5
v_mfma_f32_16x16x32_bf16 v[40:43], a[92:95], a[44:47], v[40:43]
buffer_load_dwordx4 v12, s[48:51], s64 offen lds
v_mfma_f32_16x16x32_bf16 v[40:43], a[88:91], a[40:43], v[40:43]
ds_read_b64_tr_b16 a[86:87], v9 offset:41984
v_mfma_f32_16x16x32_bf16 v[56:59], a[88:91], a[48:51], v[56:59]
v_mfma_f32_16x16x32_bf16 v[56:59], a[92:95], a[52:55], v[56:59]
s_xor_b32 m0, s84, 35840
v_mfma_f32_16x16x32_bf16 v[72:75], a[92:95], a[60:63], v[72:75]
s_waitcnt vmcnt(12)
s_xor_b32 s64, s72, 148864
ds_read_b128 a[0:3], v2 offset:0
v_mfma_f32_16x16x32_bf16 v[72:75], a[88:91], a[56:59], v[72:75]
buffer_load_dwordx4 v13, s[48:51], s64 offen lds
v_mfma_f32_16x16x32_bf16 v[136:139], a[96:99], a[56:59], v[136:139]
ds_read_b128 a[4:7], v3 offset:0
v_mfma_f32_16x16x32_bf16 v[136:139], a[100:103], a[60:63], v[136:139]
ds_read_b128 a[8:11], v2 offset:2048
v_subrev_u32 v6, 0x8000, v6
v_mfma_f32_16x16x32_bf16 v[120:123], a[100:103], a[52:55], v[120:123]
s_xor_b32 m0, s84, 36864
ds_read_b128 a[12:15], v3 offset:2048
v_mfma_f32_16x16x32_bf16 v[120:123], a[96:99], a[48:51], v[120:123]
s_xor_b32 s64, s73, 1408
ds_read_b128 a[16:19], v2 offset:4096
v_mfma_f32_16x16x32_bf16 v[104:107], a[96:99], a[40:43], v[104:107]
buffer_load_dwordx4 v12, s[48:51], s64 offen lds
v_mfma_f32_16x16x32_bf16 v[104:107], a[100:103], a[44:47], v[104:107]
ds_read_b128 a[20:23], v3 offset:4096
v_mfma_f32_16x16x32_bf16 v[88:91], a[100:103], a[36:39], v[88:91]
ds_read_b128 a[24:27], v2 offset:6144
v_mfma_f32_16x16x32_bf16 v[88:91], a[96:99], a[32:35], v[88:91]
s_waitcnt lgkmcnt(7)
s_xor_b32 m0, s84, 37888
ds_read_b128 a[28:31], v3 offset:6144
v_mfma_f32_16x16x32_bf16 v[28:31], a[104:107], a[32:35], v[28:31]
s_xor_b32 s64, s73, 17792
ds_read_b64_tr_b16 a[88:89], v10 offset:32768
v_mfma_f32_16x16x32_bf16 v[28:31], a[108:111], a[36:39], v[28:31]
buffer_load_dwordx4 v13, s[48:51], s64 offen lds
v_mfma_f32_16x16x32_bf16 v[44:47], a[108:111], a[44:47], v[44:47]
ds_read_b64_tr_b16 a[90:91], v10 offset:33792
v_subrev_u32 v7, 0x8000, v7
v_mfma_f32_16x16x32_bf16 v[44:47], a[104:107], a[40:43], v[44:47]
ds_read_b64_tr_b16 a[92:93], v10 offset:40960
v_mfma_f32_16x16x32_bf16 v[60:63], a[104:107], a[48:51], v[60:63]
s_xor_b32 m0, s84, 38912
ds_read_b64_tr_b16 a[94:95], v10 offset:41984
v_mfma_f32_16x16x32_bf16 v[60:63], a[108:111], a[52:55], v[60:63]
s_xor_b32 s64, s73, 132480
ds_read_b64_tr_b16 a[96:97], v11 offset:32768
v_mfma_f32_16x16x32_bf16 v[76:79], a[108:111], a[60:63], v[76:79]
buffer_load_dwordx4 v12, s[48:51], s64 offen lds
v_mfma_f32_16x16x32_bf16 v[76:79], a[104:107], a[56:59], v[76:79]
ds_read_b64_tr_b16 a[98:99], v11 offset:33792
v_mfma_f32_16x16x32_bf16 v[140:143], a[112:115], a[56:59], v[140:143]
s_xor_b32 m0, s84, 39936
ds_read_b64_tr_b16 a[100:101], v11 offset:40960
v_mfma_f32_16x16x32_bf16 v[140:143], a[116:119], a[60:63], v[140:143]
s_xor_b32 s64, s73, 148864
ds_read_b64_tr_b16 a[102:103], v11 offset:41984
v_subrev_u32 v8, 0x8000, v8
v_mfma_f32_16x16x32_bf16 v[124:127], a[116:119], a[52:55], v[124:127]
v_readfirstlane_b32 vcc_lo, v1
s_nop 0
s_cmp_lt_u32 vcc_lo, s81
s_cbranch_scc1 L_spin_1
L_spinbk_2:
v_mfma_f32_16x16x32_bf16 v[124:127], a[112:115], a[48:51], v[124:127]
buffer_load_dwordx4 v13, s[48:51], s64 offen lds
v_mfma_f32_16x16x32_bf16 v[108:111], a[112:115], a[40:43], v[108:111]
v_mfma_f32_16x16x32_bf16 v[108:111], a[116:119], a[44:47], v[108:111]
v_mfma_f32_16x16x32_bf16 v[92:95], a[116:119], a[36:39], v[92:95]
v_subrev_u32 v9, 0x8000, v9
v_subrev_u32 v10, 0x8000, v10
v_mfma_f32_16x16x32_bf16 v[92:95], a[112:115], a[32:35], v[92:95]
v_subrev_u32 v11, 0x8000, v11
v_mfma_f32_16x16x32_bf16 v[32:35], a[72:75], a[32:35], v[32:35]
s_add_u32 s52, s28, 59768832
s_addc_u32 s53, s29, 0
s_mov_b32 s54, 16384
v_mfma_f32_16x16x32_bf16 v[32:35], a[76:79], a[36:39], v[32:35]
v_mfma_f32_16x16x32_bf16 v[48:51], a[76:79], a[44:47], v[48:51]
s_waitcnt lgkmcnt(0)
s_barrier
v_mfma_f32_16x16x32_bf16 v[48:51], a[72:75], a[40:43], v[48:51]
s_xor_b32 m0, s77, 131072
s_add_u32 s65, s79, 31744
ds_read_b64_tr_b16 a[104:105], v19 offset:4096
v_mfma_f32_16x16x32_bf16 v[64:67], a[72:75], a[48:51], v[64:67]
s_xor_b32 s64, s71, 6291456
buffer_store_dwordx4 a[232:235], v16, s[44:47], s65 offen sc1
v_mfma_f32_16x16x32_bf16 v[64:67], a[76:79], a[52:55], v[64:67]
buffer_load_dwordx4 v14, s[56:59], s64 offen lds
v_mfma_f32_16x16x32_bf16 v[80:83], a[76:79], a[60:63], v[80:83]
ds_read_b64_tr_b16 a[106:107], v19 offset:4352
v_mfma_f32_16x16x32_bf16 v[80:83], a[72:75], a[56:59], v[80:83]
ds_read_b64_tr_b16 a[108:109], v19 offset:6144
v_mfma_f32_16x16x32_bf16 v[144:147], a[80:83], a[56:59], v[144:147]
ds_read_b64_tr_b16 a[110:111], v19 offset:6400
v_mfma_f32_16x16x32_bf16 v[144:147], a[84:87], a[60:63], v[144:147]
ds_read_b64_tr_b16 a[112:113], v20 offset:4096
v_mfma_f32_16x16x32_bf16 v[128:131], a[84:87], a[52:55], v[128:131]
ds_read_b64_tr_b16 a[114:115], v20 offset:4352
v_mfma_f32_16x16x32_bf16 v[128:131], a[80:83], a[48:51], v[128:131]
ds_read_b64_tr_b16 a[116:117], v20 offset:6144
v_mfma_f32_16x16x32_bf16 v[112:115], a[80:83], a[40:43], v[112:115]
s_add_u32 m0, s78, 147456
ds_read_b64_tr_b16 a[118:119], v20 offset:6400
v_mfma_f32_16x16x32_bf16 v[112:115], a[84:87], a[44:47], v[112:115]
s_add_u32 s64, s75, 4718592
ds_read_b64_tr_b16 a[72:73], v19 offset:8192
v_mfma_f32_16x16x32_bf16 v[96:99], a[84:87], a[36:39], v[96:99]
buffer_load_dwordx4 v23, s[60:63], s64 offen lds
v_mfma_f32_16x16x32_bf16 v[96:99], a[80:83], a[32:35], v[96:99]
ds_read_b64_tr_b16 a[74:75], v19 offset:8448
v_mfma_f32_16x16x32_bf16 v[36:39], a[88:91], a[32:35], v[36:39]
ds_read_b64_tr_b16 a[76:77], v19 offset:10240
v_mfma_f32_16x16x32_bf16 v[36:39], a[92:95], a[36:39], v[36:39]
ds_read_b64_tr_b16 a[78:79], v19 offset:10496
v_mfma_f32_16x16x32_bf16 v[52:55], a[92:95], a[44:47], v[52:55]
ds_read_b64_tr_b16 a[80:81], v20 offset:8192
v_mfma_f32_16x16x32_bf16 v[52:55], a[88:91], a[40:43], v[52:55]
ds_read_b64_tr_b16 a[82:83], v20 offset:8448
v_mfma_f32_16x16x32_bf16 v[68:71], a[88:91], a[48:51], v[68:71]
ds_read_b64_tr_b16 a[84:85], v20 offset:10240
v_mfma_f32_16x16x32_bf16 v[68:71], a[92:95], a[52:55], v[68:71]
s_xor_b32 m0, s77, 132096
ds_read_b64_tr_b16 a[86:87], v20 offset:10496
v_mfma_f32_16x16x32_bf16 v[84:87], a[92:95], a[60:63], v[84:87]
s_xor_b32 s64, s71, 6324224
v_mfma_f32_16x16x32_bf16 v[84:87], a[88:91], a[56:59], v[84:87]
buffer_load_dwordx4 v14, s[56:59], s64 offen lds
v_mfma_f32_16x16x32_bf16 v[148:151], a[96:99], a[56:59], v[148:151]
ds_read_b64_tr_b16 a[88:89], v19 offset:0
v_mfma_f32_16x16x32_bf16 v[148:151], a[100:103], a[60:63], v[148:151]
ds_read_b64_tr_b16 a[90:91], v19 offset:256
v_mfma_f32_16x16x32_bf16 v[132:135], a[100:103], a[52:55], v[132:135]
ds_read_b64_tr_b16 a[92:93], v19 offset:2048
v_mfma_f32_16x16x32_bf16 v[132:135], a[96:99], a[48:51], v[132:135]
ds_read_b64_tr_b16 a[94:95], v19 offset:2304
v_mfma_f32_16x16x32_bf16 v[116:119], a[96:99], a[40:43], v[116:119]
v_mfma_f32_16x16x32_bf16 v[116:119], a[100:103], a[44:47], v[116:119]
v_mfma_f32_16x16x32_bf16 v[100:103], a[100:103], a[36:39], v[100:103]
s_add_u32 m0, s78, 151552
v_mfma_f32_16x16x32_bf16 v[100:103], a[96:99], a[32:35], v[100:103]
s_waitcnt lgkmcnt(4)
s_add_u32 s64, s75, 4720640
ds_read_b64_tr_b16 a[96:97], v20 offset:0
v_mfma_f32_16x16x32_bf16 v[184:187], a[104:107], a[0:3], v[184:187]
buffer_load_dwordx4 v23, s[60:63], s64 offen lds
v_mfma_f32_16x16x32_bf16 v[184:187], a[108:111], a[4:7], v[184:187]
ds_read_b64_tr_b16 a[98:99], v20 offset:256
v_mfma_f32_16x16x32_bf16 v[192:195], a[108:111], a[12:15], v[192:195]
ds_read_b64_tr_b16 a[100:101], v20 offset:2048
v_mfma_f32_16x16x32_bf16 v[192:195], a[104:107], a[8:11], v[192:195]
ds_read_b64_tr_b16 a[102:103], v20 offset:2304
v_mfma_f32_16x16x32_bf16 v[200:203], a[104:107], a[16:19], v[200:203]
v_mfma_f32_16x16x32_bf16 v[200:203], a[108:111], a[20:23], v[200:203]
v_mfma_f32_16x16x32_bf16 v[208:211], a[108:111], a[28:31], v[208:211]
v_mfma_f32_16x16x32_bf16 v[208:211], a[104:107], a[24:27], v[208:211]
ds_read_b64_tr_b16 a[104:105], v4 offset:0
v_mfma_f32_16x16x32_bf16 v[212:215], a[112:115], a[24:27], v[212:215]
s_xor_b32 m0, s77, 133120
ds_read_b64_tr_b16 a[106:107], v4 offset:1024
v_mfma_f32_16x16x32_bf16 v[212:215], a[116:119], a[28:31], v[212:215]
s_xor_b32 s64, s71, 6356992
ds_read_b64_tr_b16 a[108:109], v4 offset:8192
v_mfma_f32_16x16x32_bf16 v[204:207], a[116:119], a[20:23], v[204:207]
buffer_load_dwordx4 v15, s[56:59], s64 offen lds
v_mfma_f32_16x16x32_bf16 v[204:207], a[112:115], a[16:19], v[204:207]
ds_read_b64_tr_b16 a[110:111], v4 offset:9216
v_mfma_f32_16x16x32_bf16 v[196:199], a[112:115], a[8:11], v[196:199]
v_mfma_f32_16x16x32_bf16 v[196:199], a[116:119], a[12:15], v[196:199]
v_mfma_f32_16x16x32_bf16 v[188:191], a[116:119], a[4:7], v[188:191]
v_mfma_f32_16x16x32_bf16 v[188:191], a[112:115], a[0:3], v[188:191]
ds_read_b64_tr_b16 a[112:113], v5 offset:0
v_mfma_f32_16x16x32_bf16 v[216:219], a[0:3], a[72:75], v[216:219]
s_add_u32 s65, s79, 15360
ds_read_b64_tr_b16 a[114:115], v5 offset:1024
v_mfma_f32_16x16x32_bf16 v[216:219], a[4:7], a[76:79], v[216:219]
s_add_u32 m0, s78, 155648
buffer_store_dwordx4 a[236:239], v16, s[44:47], s65 offen sc1
v_mfma_f32_16x16x32_bf16 v[224:227], a[12:15], a[76:79], v[224:227]
s_add_u32 s64, s75, 4722688
ds_read_b64_tr_b16 a[116:117], v5 offset:8192
v_mfma_f32_16x16x32_bf16 v[224:227], a[8:11], a[72:75], v[224:227]
buffer_load_dwordx4 v23, s[60:63], s64 offen lds
v_mfma_f32_16x16x32_bf16 v[232:235], a[16:19], a[72:75], v[232:235]
ds_read_b64_tr_b16 a[118:119], v5 offset:9216
v_mfma_f32_16x16x32_bf16 v[232:235], a[20:23], a[76:79], v[232:235]
v_mfma_f32_16x16x32_bf16 v[240:243], a[28:31], a[76:79], v[240:243]
v_mfma_f32_16x16x32_bf16 v[240:243], a[24:27], a[72:75], v[240:243]
ds_read_b64_tr_b16 a[72:73], v6 offset:0
v_mfma_f32_16x16x32_bf16 v[244:247], a[24:27], a[80:83], v[244:247]
ds_read_b64_tr_b16 a[74:75], v6 offset:1024
v_mfma_f32_16x16x32_bf16 v[244:247], a[28:31], a[84:87], v[244:247]
ds_read_b64_tr_b16 a[76:77], v6 offset:8192
v_mfma_f32_16x16x32_bf16 v[236:239], a[20:23], a[84:87], v[236:239]
s_xor_b32 m0, s77, 134144
ds_read_b64_tr_b16 a[78:79], v6 offset:9216
v_mfma_f32_16x16x32_bf16 v[236:239], a[16:19], a[80:83], v[236:239]
s_xor_b32 s64, s71, 6389760
v_mfma_f32_16x16x32_bf16 v[228:231], a[8:11], a[80:83], v[228:231]
buffer_load_dwordx4 v15, s[56:59], s64 offen lds
v_mfma_f32_16x16x32_bf16 v[228:231], a[12:15], a[84:87], v[228:231]
v_mfma_f32_16x16x32_bf16 v[220:223], a[4:7], a[84:87], v[220:223]
v_mfma_f32_16x16x32_bf16 v[220:223], a[0:3], a[80:83], v[220:223]
s_waitcnt lgkmcnt(4)
ds_read_b64_tr_b16 a[80:81], v7 offset:0
v_mfma_f32_16x16x32_bf16 v[152:155], a[88:91], a[0:3], v[152:155]
ds_read_b64_tr_b16 a[82:83], v7 offset:1024
v_mfma_f32_16x16x32_bf16 v[152:155], a[92:95], a[4:7], v[152:155]
ds_read_b64_tr_b16 a[84:85], v7 offset:8192
v_mfma_f32_16x16x32_bf16 v[160:163], a[92:95], a[12:15], v[160:163]
ds_read_b64_tr_b16 a[86:87], v7 offset:9216
v_mfma_f32_16x16x32_bf16 v[160:163], a[88:91], a[8:11], v[160:163]
v_mfma_f32_16x16x32_bf16 v[168:171], a[88:91], a[16:19], v[168:171]
v_mfma_f32_16x16x32_bf16 v[168:171], a[92:95], a[20:23], v[168:171]
s_branch L_po11
L_pg11:
s_branch L_tr1
L_po11:
v_mfma_f32_16x16x32_bf16 v[176:179], a[92:95], a[28:31], v[176:179]
s_xor_b32 m0, s84, 0
v_mfma_f32_16x16x32_bf16 v[176:179], a[88:91], a[24:27], v[176:179]
s_xor_b32 s64, s72, 1536
ds_read_b64_tr_b16 a[88:89], v8 offset:0
v_mfma_f32_16x16x32_bf16 v[180:183], a[96:99], a[24:27], v[180:183]
buffer_load_dwordx4 v12, s[48:51], s64 offen lds
v_mfma_f32_16x16x32_bf16 v[180:183], a[100:103], a[28:31], v[180:183]
ds_read_b64_tr_b16 a[90:91], v8 offset:1024
v_mfma_f32_16x16x32_bf16 v[172:175], a[100:103], a[20:23], v[172:175]
ds_read_b64_tr_b16 a[92:93], v8 offset:8192
v_mfma_f32_16x16x32_bf16 v[172:175], a[96:99], a[16:19], v[172:175]
s_xor_b32 m0, s84, 1024
ds_read_b64_tr_b16 a[94:95], v8 offset:9216
v_mfma_f32_16x16x32_bf16 v[164:167], a[96:99], a[8:11], v[164:167]
s_xor_b32 s64, s72, 17920
v_mfma_f32_16x16x32_bf16 v[164:167], a[100:103], a[12:15], v[164:167]
buffer_load_dwordx4 v13, s[48:51], s64 offen lds
v_mfma_f32_16x16x32_bf16 v[156:159], a[100:103], a[4:7], v[156:159]
v_mfma_f32_16x16x32_bf16 v[156:159], a[96:99], a[0:3], v[156:159]
ds_read_b64_tr_b16 a[96:97], v9 offset:0
v_mfma_f32_16x16x32_bf16 v[24:27], a[104:107], a[0:3], v[24:27]
s_xor_b32 m0, s84, 2048
ds_read_b64_tr_b16 a[98:99], v9 offset:1024
v_mfma_f32_16x16x32_bf16 v[24:27], a[108:111], a[4:7], v[24:27]
s_xor_b32 s64, s72, 132608
ds_read_b64_tr_b16 a[100:101], v9 offset:8192
v_mfma_f32_16x16x32_bf16 v[40:43], a[108:111], a[12:15], v[40:43]
buffer_load_dwordx4 v12, s[48:51], s64 offen lds
v_mfma_f32_16x16x32_bf16 v[40:43], a[104:107], a[8:11], v[40:43]
ds_read_b64_tr_b16 a[102:103], v9 offset:9216
v_mfma_f32_16x16x32_bf16 v[56:59], a[104:107], a[16:19], v[56:59]
v_mfma_f32_16x16x32_bf16 v[56:59], a[108:111], a[20:23], v[56:59]
s_xor_b32 m0, s84, 3072
v_mfma_f32_16x16x32_bf16 v[72:75], a[108:111], a[28:31], v[72:75]
s_waitcnt vmcnt(12)
s_xor_b32 s64, s72, 148992
ds_read_b128 a[32:35], v2 offset:32768
v_mfma_f32_16x16x32_bf16 v[72:75], a[104:107], a[24:27], v[72:75]
buffer_load_dwordx4 v13, s[48:51], s64 offen lds
v_mfma_f32_16x16x32_bf16 v[136:139], a[112:115], a[24:27], v[136:139]
ds_read_b128 a[36:39], v3 offset:32768
v_mfma_f32_16x16x32_bf16 v[136:139], a[116:119], a[28:31], v[136:139]
ds_read_b128 a[40:43], v2 offset:34816
v_mfma_f32_16x16x32_bf16 v[120:123], a[116:119], a[20:23], v[120:123]
s_xor_b32 m0, s84, 4096
ds_read_b128 a[44:47], v3 offset:34816
v_mfma_f32_16x16x32_bf16 v[120:123], a[112:115], a[16:19], v[120:123]
s_xor_b32 s64, s73, 1536
ds_read_b128 a[48:51], v2 offset:36864
v_mfma_f32_16x16x32_bf16 v[104:107], a[112:115], a[8:11], v[104:107]
buffer_load_dwordx4 v12, s[48:51], s64 offen lds
v_mfma_f32_16x16x32_bf16 v[104:107], a[116:119], a[12:15], v[104:107]
ds_read_b128 a[52:55], v3 offset:36864
v_mfma_f32_16x16x32_bf16 v[88:91], a[116:119], a[4:7], v[88:91]
buffer_store_dwordx4 a[240:243], v16, s[44:47], s74 offen sc1
v_mfma_f32_16x16x32_bf16 v[88:91], a[112:115], a[0:3], v[88:91]
s_waitcnt lgkmcnt(6)
s_xor_b32 m0, s84, 5120
ds_read_b128 a[56:59], v2 offset:38912
v_mfma_f32_16x16x32_bf16 v[28:31], a[72:75], a[0:3], v[28:31]
s_xor_b32 s64, s73, 17920
ds_read_b128 a[60:63], v3 offset:38912
v_mfma_f32_16x16x32_bf16 v[28:31], a[76:79], a[4:7], v[28:31]
buffer_load_dwordx4 v13, s[48:51], s64 offen lds
v_mfma_f32_16x16x32_bf16 v[44:47], a[76:79], a[12:15], v[44:47]
ds_read_b64_tr_b16 a[104:105], v10 offset:0
v_mfma_f32_16x16x32_bf16 v[44:47], a[72:75], a[8:11], v[44:47]
ds_read_b64_tr_b16 a[106:107], v10 offset:1024
v_mfma_f32_16x16x32_bf16 v[60:63], a[72:75], a[16:19], v[60:63]
s_xor_b32 m0, s84, 6144
ds_read_b64_tr_b16 a[108:109], v10 offset:8192
v_mfma_f32_16x16x32_bf16 v[60:63], a[76:79], a[20:23], v[60:63]
s_xor_b32 s64, s73, 132608
ds_read_b64_tr_b16 a[110:111], v10 offset:9216
v_mfma_f32_16x16x32_bf16 v[76:79], a[76:79], a[28:31], v[76:79]
buffer_load_dwordx4 v12, s[48:51], s64 offen lds
v_mfma_f32_16x16x32_bf16 v[76:79], a[72:75], a[24:27], v[76:79]
ds_read_b64_tr_b16 a[112:113], v11 offset:0
v_mfma_f32_16x16x32_bf16 v[140:143], a[80:83], a[24:27], v[140:143]
ds_read_b64_tr_b16 a[114:115], v11 offset:1024
v_mfma_f32_16x16x32_bf16 v[140:143], a[84:87], a[28:31], v[140:143]
s_xor_b32 m0, s84, 7168
ds_read_b64_tr_b16 a[116:117], v11 offset:8192
v_mfma_f32_16x16x32_bf16 v[124:127], a[84:87], a[20:23], v[124:127]
s_xor_b32 s64, s73, 148992
ds_read_b64_tr_b16 a[118:119], v11 offset:9216
v_mfma_f32_16x16x32_bf16 v[124:127], a[80:83], a[16:19], v[124:127]
buffer_load_dwordx4 v13, s[48:51], s64 offen lds
v_mfma_f32_16x16x32_bf16 v[108:111], a[80:83], a[8:11], v[108:111]
v_mfma_f32_16x16x32_bf16 v[108:111], a[84:87], a[12:15], v[108:111]
v_mfma_f32_16x16x32_bf16 v[92:95], a[84:87], a[4:7], v[92:95]
v_mfma_f32_16x16x32_bf16 v[92:95], a[80:83], a[0:3], v[92:95]
v_mfma_f32_16x16x32_bf16 v[32:35], a[88:91], a[0:3], v[32:35]
v_mfma_f32_16x16x32_bf16 v[32:35], a[92:95], a[4:7], v[32:35]
v_mfma_f32_16x16x32_bf16 v[48:51], a[92:95], a[12:15], v[48:51]
s_waitcnt lgkmcnt(0)
s_barrier
v_mfma_f32_16x16x32_bf16 v[48:51], a[88:91], a[8:11], v[48:51]
s_xor_b32 m0, s77, 65536
ds_read_b64_tr_b16 a[72:73], v19 offset:36864
v_mfma_f32_16x16x32_bf16 v[64:67], a[88:91], a[16:19], v[64:67]
s_xor_b32 s64, s71, 6815744
ds_read_b64_tr_b16 a[74:75], v19 offset:37120
v_mfma_f32_16x16x32_bf16 v[64:67], a[92:95], a[20:23], v[64:67]
buffer_load_dwordx4 v14, s[56:59], s64 offen lds
v_mfma_f32_16x16x32_bf16 v[80:83], a[92:95], a[28:31], v[80:83]
ds_read_b64_tr_b16 a[76:77], v19 offset:38912
v_mfma_f32_16x16x32_bf16 v[80:83], a[88:91], a[24:27], v[80:83]
ds_read_b64_tr_b16 a[78:79], v19 offset:39168
v_mfma_f32_16x16x32_bf16 v[144:147], a[96:99], a[24:27], v[144:147]
ds_read_b64_tr_b16 a[80:81], v20 offset:36864
v_mfma_f32_16x16x32_bf16 v[144:147], a[100:103], a[28:31], v[144:147]
ds_read_b64_tr_b16 a[82:83], v20 offset:37120
v_mfma_f32_16x16x32_bf16 v[128:131], a[100:103], a[20:23], v[128:131]
ds_read_b64_tr_b16 a[84:85], v20 offset:38912
v_mfma_f32_16x16x32_bf16 v[128:131], a[96:99], a[16:19], v[128:131]
ds_read_b64_tr_b16 a[86:87], v20 offset:39168
v_mfma_f32_16x16x32_bf16 v[112:115], a[96:99], a[8:11], v[112:115]
s_add_u32 m0, s78, 81920
ds_read_b64_tr_b16 a[88:89], v19 offset:40960
v_mfma_f32_16x16x32_bf16 v[112:115], a[100:103], a[12:15], v[112:115]
s_add_u32 s64, s75, 5111808
ds_read_b64_tr_b16 a[90:91], v19 offset:41216
v_mfma_f32_16x16x32_bf16 v[96:99], a[100:103], a[4:7], v[96:99]
buffer_load_dwordx4 v23, s[60:63], s64 offen lds
v_mfma_f32_16x16x32_bf16 v[96:99], a[96:99], a[0:3], v[96:99]
ds_read_b64_tr_b16 a[92:93], v19 offset:43008
v_mfma_f32_16x16x32_bf16 v[36:39], a[104:107], a[0:3], v[36:39]
ds_read_b64_tr_b16 a[94:95], v19 offset:43264
v_mfma_f32_16x16x32_bf16 v[36:39], a[108:111], a[4:7], v[36:39]
ds_read_b64_tr_b16 a[96:97], v20 offset:40960
v_mfma_f32_16x16x32_bf16 v[52:55], a[108:111], a[12:15], v[52:55]
ds_read_b64_tr_b16 a[98:99], v20 offset:41216
v_mfma_f32_16x16x32_bf16 v[52:55], a[104:107], a[8:11], v[52:55]
ds_read_b64_tr_b16 a[100:101], v20 offset:43008
v_mfma_f32_16x16x32_bf16 v[68:71], a[104:107], a[16:19], v[68:71]
ds_read_b64_tr_b16 a[102:103], v20 offset:43264
v_mfma_f32_16x16x32_bf16 v[68:71], a[108:111], a[20:23], v[68:71]
s_xor_b32 m0, s77, 66560
v_mfma_f32_16x16x32_bf16 v[84:87], a[108:111], a[28:31], v[84:87]
s_xor_b32 s64, s71, 6848512
v_mfma_f32_16x16x32_bf16 v[84:87], a[104:107], a[24:27], v[84:87]
buffer_load_dwordx4 v14, s[56:59], s64 offen lds
v_mfma_f32_16x16x32_bf16 v[148:151], a[112:115], a[24:27], v[148:151]
ds_read_b64_tr_b16 a[104:105], v19 offset:32768
v_mfma_f32_16x16x32_bf16 v[148:151], a[116:119], a[28:31], v[148:151]
ds_read_b64_tr_b16 a[106:107], v19 offset:33024
v_mfma_f32_16x16x32_bf16 v[132:135], a[116:119], a[20:23], v[132:135]
ds_read_b64_tr_b16 a[108:109], v19 offset:34816
v_mfma_f32_16x16x32_bf16 v[132:135], a[112:115], a[16:19], v[132:135]
ds_read_b64_tr_b16 a[110:111], v19 offset:35072
v_mfma_f32_16x16x32_bf16 v[116:119], a[112:115], a[8:11], v[116:119]
v_mfma_f32_16x16x32_bf16 v[116:119], a[116:119], a[12:15], v[116:119]
v_mfma_f32_16x16x32_bf16 v[100:103], a[116:119], a[4:7], v[100:103]
s_add_u32 m0, s78, 86016
v_mfma_f32_16x16x32_bf16 v[100:103], a[112:115], a[0:3], v[100:103]
s_waitcnt lgkmcnt(4)
s_add_u32 s64, s75, 5113856
ds_read_b64_tr_b16 a[112:113], v20 offset:32768
v_mfma_f32_16x16x32_bf16 v[184:187], a[72:75], a[32:35], v[184:187]
s_lshl_b32 s66, s30, 30
buffer_load_dwordx4 v23, s[60:63], s64 offen lds
v_mfma_f32_16x16x32_bf16 v[184:187], a[76:79], a[36:39], v[184:187]
ds_read_b64_tr_b16 a[114:115], v20 offset:33024
v_lshl_add_u32 v1, v0, 24, s66
v_mfma_f32_16x16x32_bf16 v[192:195], a[76:79], a[44:47], v[192:195]
s_lshl_b32 s70, s31, 8
ds_read_b64_tr_b16 a[116:117], v20 offset:34816
v_mfma_f32_16x16x32_bf16 v[192:195], a[72:75], a[40:43], v[192:195]
ds_read_b64_tr_b16 a[118:119], v20 offset:35072
v_mfma_f32_16x16x32_bf16 v[200:203], a[72:75], a[48:51], v[200:203]
v_mfma_f32_16x16x32_bf16 v[200:203], a[76:79], a[52:55], v[200:203]
v_mfma_f32_16x16x32_bf16 v[208:211], a[76:79], a[60:63], v[208:211]
v_mfma_f32_16x16x32_bf16 v[208:211], a[72:75], a[56:59], v[208:211]
ds_read_b64_tr_b16 a[72:73], v4 offset:32768
v_mfma_f32_16x16x32_bf16 v[212:215], a[80:83], a[56:59], v[212:215]
s_xor_b32 m0, s77, 67584
ds_read_b64_tr_b16 a[74:75], v4 offset:33792
v_mfma_f32_16x16x32_bf16 v[212:215], a[84:87], a[60:63], v[212:215]
s_xor_b32 s64, s71, 6881280
ds_read_b64_tr_b16 a[76:77], v4 offset:40960
v_mfma_f32_16x16x32_bf16 v[204:207], a[84:87], a[52:55], v[204:207]
buffer_load_dwordx4 v15, s[56:59], s64 offen lds
v_mfma_f32_16x16x32_bf16 v[204:207], a[80:83], a[48:51], v[204:207]
ds_read_b64_tr_b16 a[78:79], v4 offset:41984
v_mfma_f32_16x16x32_bf16 v[196:199], a[80:83], a[40:43], v[196:199]
v_mfma_f32_16x16x32_bf16 v[196:199], a[84:87], a[44:47], v[196:199]
v_mfma_f32_16x16x32_bf16 v[188:191], a[84:87], a[36:39], v[188:191]
v_mfma_f32_16x16x32_bf16 v[188:191], a[80:83], a[32:35], v[188:191]
ds_read_b64_tr_b16 a[80:81], v5 offset:32768
v_mfma_f32_16x16x32_bf16 v[216:219], a[32:35], a[88:91], v[216:219]
ds_read_b64_tr_b16 a[82:83], v5 offset:33792
v_mfma_f32_16x16x32_bf16 v[216:219], a[36:39], a[92:95], v[216:219]
s_add_u32 m0, s78, 90112
ds_read_b64_tr_b16 a[84:85], v5 offset:40960
v_mfma_f32_16x16x32_bf16 v[224:227], a[44:47], a[92:95], v[224:227]
s_add_u32 s64, s75, 5115904
ds_read_b64_tr_b16 a[86:87], v5 offset:41984
v_mfma_f32_16x16x32_bf16 v[224:227], a[40:43], a[88:91], v[224:227]
buffer_load_dwordx4 v23, s[60:63], s64 offen lds
v_mfma_f32_16x16x32_bf16 v[232:235], a[48:51], a[88:91], v[232:235]
v_mfma_f32_16x16x32_bf16 v[232:235], a[52:55], a[92:95], v[232:235]
v_mfma_f32_16x16x32_bf16 v[240:243], a[60:63], a[92:95], v[240:243]
v_mfma_f32_16x16x32_bf16 v[240:243], a[56:59], a[88:91], v[240:243]
ds_read_b64_tr_b16 a[88:89], v6 offset:32768
v_mfma_f32_16x16x32_bf16 v[244:247], a[56:59], a[96:99], v[244:247]
ds_read_b64_tr_b16 a[90:91], v6 offset:33792
v_mfma_f32_16x16x32_bf16 v[244:247], a[60:63], a[100:103], v[244:247]
ds_read_b64_tr_b16 a[92:93], v6 offset:40960
v_add_u32 v19, 0x8000, v19
v_mfma_f32_16x16x32_bf16 v[236:239], a[52:55], a[100:103], v[236:239]
s_xor_b32 m0, s77, 68608
ds_read_b64_tr_b16 a[94:95], v6 offset:41984
v_mfma_f32_16x16x32_bf16 v[236:239], a[48:51], a[96:99], v[236:239]
s_xor_b32 s64, s71, 6914048
v_mfma_f32_16x16x32_bf16 v[228:231], a[40:43], a[96:99], v[228:231]
buffer_load_dwordx4 v15, s[56:59], s64 offen lds
v_mfma_f32_16x16x32_bf16 v[228:231], a[44:47], a[100:103], v[228:231]
v_mfma_f32_16x16x32_bf16 v[220:223], a[36:39], a[100:103], v[220:223]
v_mfma_f32_16x16x32_bf16 v[220:223], a[32:35], a[96:99], v[220:223]
s_waitcnt lgkmcnt(4)
ds_read_b64_tr_b16 a[96:97], v7 offset:32768
v_mfma_f32_16x16x32_bf16 v[152:155], a[104:107], a[32:35], v[152:155]
ds_read_b64_tr_b16 a[98:99], v7 offset:33792
v_mfma_f32_16x16x32_bf16 v[152:155], a[108:111], a[36:39], v[152:155]
ds_read_b64_tr_b16 a[100:101], v7 offset:40960
v_add_u32 v20, 0x8000, v20
v_mfma_f32_16x16x32_bf16 v[160:163], a[108:111], a[44:47], v[160:163]
ds_read_b64_tr_b16 a[102:103], v7 offset:41984
v_mfma_f32_16x16x32_bf16 v[160:163], a[104:107], a[40:43], v[160:163]
v_mfma_f32_16x16x32_bf16 v[168:171], a[104:107], a[48:51], v[168:171]
v_mfma_f32_16x16x32_bf16 v[168:171], a[108:111], a[52:55], v[168:171]
v_mfma_f32_16x16x32_bf16 v[176:179], a[108:111], a[60:63], v[176:179]
s_xor_b32 m0, s84, 32768
v_mfma_f32_16x16x32_bf16 v[176:179], a[104:107], a[56:59], v[176:179]
s_xor_b32 s64, s72, 1664
ds_read_b64_tr_b16 a[104:105], v8 offset:32768
v_mfma_f32_16x16x32_bf16 v[180:183], a[112:115], a[56:59], v[180:183]
buffer_load_dwordx4 v12, s[48:51], s64 offen lds
v_mfma_f32_16x16x32_bf16 v[180:183], a[116:119], a[60:63], v[180:183]
ds_read_b64_tr_b16 a[106:107], v8 offset:33792
v_add_u32 v4, 0x8000, v4
v_mfma_f32_16x16x32_bf16 v[172:175], a[116:119], a[52:55], v[172:175]
ds_read_b64_tr_b16 a[108:109], v8 offset:40960
v_mfma_f32_16x16x32_bf16 v[172:175], a[112:115], a[48:51], v[172:175]
s_xor_b32 m0, s84, 33792
ds_read_b64_tr_b16 a[110:111], v8 offset:41984
v_mfma_f32_16x16x32_bf16 v[164:167], a[112:115], a[40:43], v[164:167]
s_xor_b32 s64, s72, 18048
v_mfma_f32_16x16x32_bf16 v[164:167], a[116:119], a[44:47], v[164:167]
buffer_load_dwordx4 v13, s[48:51], s64 offen lds
v_mfma_f32_16x16x32_bf16 v[156:159], a[116:119], a[36:39], v[156:159]
v_mfma_f32_16x16x32_bf16 v[156:159], a[112:115], a[32:35], v[156:159]
ds_read_b64_tr_b16 a[112:113], v9 offset:32768
v_mfma_f32_16x16x32_bf16 v[24:27], a[72:75], a[32:35], v[24:27]
s_xor_b32 m0, s84, 34816
ds_read_b64_tr_b16 a[114:115], v9 offset:33792
v_mfma_f32_16x16x32_bf16 v[24:27], a[76:79], a[36:39], v[24:27]
s_xor_b32 s64, s72, 132736
ds_read_b64_tr_b16 a[116:117], v9 offset:40960
v_add_u32 v5, 0x8000, v5
v_mfma_f32_16x16x32_bf16 v[40:43], a[76:79], a[44:47], v[40:43]
buffer_load_dwordx4 v12, s[48:51], s64 offen lds
v_mfma_f32_16x16x32_bf16 v[40:43], a[72:75], a[40:43], v[40:43]
ds_read_b64_tr_b16 a[118:119], v9 offset:41984
v_mfma_f32_16x16x32_bf16 v[56:59], a[72:75], a[48:51], v[56:59]
v_mfma_f32_16x16x32_bf16 v[56:59], a[76:79], a[52:55], v[56:59]
s_xor_b32 m0, s84, 35840
v_mfma_f32_16x16x32_bf16 v[72:75], a[76:79], a[60:63], v[72:75]
s_waitcnt vmcnt(10)
s_xor_b32 s64, s72, 149120
ds_read_b128 a[0:3], v2 offset:0
v_mfma_f32_16x16x32_bf16 v[72:75], a[72:75], a[56:59], v[72:75]
buffer_load_dwordx4 v13, s[48:51], s64 offen lds
v_mfma_f32_16x16x32_bf16 v[136:139], a[80:83], a[56:59], v[136:139]
ds_read_b128 a[4:7], v3 offset:0
v_mfma_f32_16x16x32_bf16 v[136:139], a[84:87], a[60:63], v[136:139]
ds_read_b128 a[8:11], v2 offset:2048
v_add_u32 v6, 0x8000, v6
v_mfma_f32_16x16x32_bf16 v[120:123], a[84:87], a[52:55], v[120:123]
s_xor_b32 m0, s84, 36864
ds_read_b128 a[12:15], v3 offset:2048
v_mfma_f32_16x16x32_bf16 v[120:123], a[80:83], a[48:51], v[120:123]
s_xor_b32 s64, s73, 1664
ds_read_b128 a[16:19], v2 offset:4096
v_mfma_f32_16x16x32_bf16 v[104:107], a[80:83], a[40:43], v[104:107]
buffer_load_dwordx4 v12, s[48:51], s64 offen lds
v_mfma_f32_16x16x32_bf16 v[104:107], a[84:87], a[44:47], v[104:107]
ds_read_b128 a[20:23], v3 offset:4096
v_mfma_f32_16x16x32_bf16 v[88:91], a[84:87], a[36:39], v[88:91]
ds_read_b128 a[24:27], v2 offset:6144
v_mfma_f32_16x16x32_bf16 v[88:91], a[80:83], a[32:35], v[88:91]
s_waitcnt lgkmcnt(7)
s_xor_b32 m0, s84, 37888
ds_read_b128 a[28:31], v3 offset:6144
v_mfma_f32_16x16x32_bf16 v[28:31], a[88:91], a[32:35], v[28:31]
s_xor_b32 s64, s73, 18048
ds_read_b64_tr_b16 a[72:73], v10 offset:32768
v_mfma_f32_16x16x32_bf16 v[28:31], a[92:95], a[36:39], v[28:31]
buffer_load_dwordx4 v13, s[48:51], s64 offen lds
v_mfma_f32_16x16x32_bf16 v[44:47], a[92:95], a[44:47], v[44:47]
ds_read_b64_tr_b16 a[74:75], v10 offset:33792
v_add_u32 v7, 0x8000, v7
v_mfma_f32_16x16x32_bf16 v[44:47], a[88:91], a[40:43], v[44:47]
ds_read_b64_tr_b16 a[76:77], v10 offset:40960
v_mfma_f32_16x16x32_bf16 v[60:63], a[88:91], a[48:51], v[60:63]
s_xor_b32 m0, s84, 38912
ds_read_b64_tr_b16 a[78:79], v10 offset:41984
v_mfma_f32_16x16x32_bf16 v[60:63], a[92:95], a[52:55], v[60:63]
s_xor_b32 s64, s73, 132736
ds_read_b64_tr_b16 a[80:81], v11 offset:32768
v_mfma_f32_16x16x32_bf16 v[76:79], a[92:95], a[60:63], v[76:79]
buffer_load_dwordx4 v12, s[48:51], s64 offen lds
v_mfma_f32_16x16x32_bf16 v[76:79], a[88:91], a[56:59], v[76:79]
ds_read_b64_tr_b16 a[82:83], v11 offset:33792
v_mfma_f32_16x16x32_bf16 v[140:143], a[96:99], a[56:59], v[140:143]
ds_read_b64_tr_b16 a[84:85], v11 offset:40960
v_lshrrev_b32 v22, 2, v0
v_mfma_f32_16x16x32_bf16 v[140:143], a[100:103], a[60:63], v[140:143]
s_xor_b32 m0, s84, 39936
ds_read_b64_tr_b16 a[86:87], v11 offset:41984
v_add_u32 v8, 0x8000, v8
v_mfma_f32_16x16x32_bf16 v[124:127], a[100:103], a[52:55], v[124:127]
s_xor_b32 s64, s73, 149120
v_mul_u32_u24 v22, 3584, v22
v_lshl_add_u32 v22, v0, 7, v22
v_mfma_f32_16x16x32_bf16 v[124:127], a[96:99], a[48:51], v[124:127]
buffer_load_dwordx4 v13, s[48:51], s64 offen lds
v_mfma_f32_16x16x32_bf16 v[108:111], a[96:99], a[40:43], v[108:111]
v_mfma_f32_16x16x32_bf16 v[108:111], a[100:103], a[44:47], v[108:111]
v_mfma_f32_16x16x32_bf16 v[92:95], a[100:103], a[36:39], v[92:95]
v_add_u32 v9, 0x8000, v9
v_add_u32 v10, 0x8000, v10
v_mfma_f32_16x16x32_bf16 v[92:95], a[96:99], a[32:35], v[92:95]
v_add_u32 v11, 0x8000, v11
v_mfma_f32_16x16x32_bf16 v[32:35], a[104:107], a[32:35], v[32:35]
v_mfma_f32_16x16x32_bf16 v[32:35], a[108:111], a[36:39], v[32:35]
v_mfma_f32_16x16x32_bf16 v[48:51], a[108:111], a[44:47], v[48:51]
s_waitcnt lgkmcnt(0)
s_barrier
v_mfma_f32_16x16x32_bf16 v[48:51], a[104:107], a[40:43], v[48:51]
s_mov_b64 exec, 1
buffer_atomic_add a251, v1, s[52:55], s70 offen offset:0 sc1
s_mov_b64 exec, -1
s_xor_b32 m0, s77, 98304
v_mfma_f32_16x16x32_bf16 v[64:67], a[104:107], a[48:51], v[64:67]
s_lshl4_add_u32 s70, s78, s70
s_xor_b32 s64, s71, 7340032
ds_read_b64_tr_b16 a[88:89], v19 offset:36864
v_mfma_f32_16x16x32_bf16 v[64:67], a[108:111], a[52:55], v[64:67]
s_lshr_b32 s81, s81, 5
buffer_load_dwordx4 v14, s[56:59], s64 offen lds
v_mfma_f32_16x16x32_bf16 v[80:83], a[108:111], a[60:63], v[80:83]
ds_read_b64_tr_b16 a[90:91], v19 offset:37120
v_mfma_f32_16x16x32_bf16 v[80:83], a[104:107], a[56:59], v[80:83]
ds_read_b64_tr_b16 a[92:93], v19 offset:38912
v_mfma_f32_16x16x32_bf16 v[144:147], a[112:115], a[56:59], v[144:147]
ds_read_b64_tr_b16 a[94:95], v19 offset:39168
v_mfma_f32_16x16x32_bf16 v[144:147], a[116:119], a[60:63], v[144:147]
ds_read_b64_tr_b16 a[96:97], v20 offset:36864
v_mfma_f32_16x16x32_bf16 v[128:131], a[116:119], a[52:55], v[128:131]
ds_read_b64_tr_b16 a[98:99], v20 offset:37120
v_mfma_f32_16x16x32_bf16 v[128:131], a[112:115], a[48:51], v[128:131]
ds_read_b64_tr_b16 a[100:101], v20 offset:38912
v_mfma_f32_16x16x32_bf16 v[112:115], a[112:115], a[40:43], v[112:115]
s_add_u32 m0, s78, 114688
ds_read_b64_tr_b16 a[102:103], v20 offset:39168
v_mfma_f32_16x16x32_bf16 v[112:115], a[116:119], a[44:47], v[112:115]
s_add_u32 s64, s75, 5505024
ds_read_b64_tr_b16 a[104:105], v19 offset:40960
v_mfma_f32_16x16x32_bf16 v[96:99], a[116:119], a[36:39], v[96:99]
buffer_load_dwordx4 v23, s[60:63], s64 offen lds
v_mfma_f32_16x16x32_bf16 v[96:99], a[112:115], a[32:35], v[96:99]
ds_read_b64_tr_b16 a[106:107], v19 offset:41216
v_mfma_f32_16x16x32_bf16 v[36:39], a[72:75], a[32:35], v[36:39]
ds_read_b64_tr_b16 a[108:109], v19 offset:43008
v_mfma_f32_16x16x32_bf16 v[36:39], a[76:79], a[36:39], v[36:39]
ds_read_b64_tr_b16 a[110:111], v19 offset:43264
v_mfma_f32_16x16x32_bf16 v[52:55], a[76:79], a[44:47], v[52:55]
ds_read_b64_tr_b16 a[112:113], v20 offset:40960
v_mfma_f32_16x16x32_bf16 v[52:55], a[72:75], a[40:43], v[52:55]
ds_read_b64_tr_b16 a[114:115], v20 offset:41216
v_mfma_f32_16x16x32_bf16 v[68:71], a[72:75], a[48:51], v[68:71]
s_lshr_b32 s17, s78, 1
ds_read_b64_tr_b16 a[116:117], v20 offset:43008
v_mfma_f32_16x16x32_bf16 v[68:71], a[76:79], a[52:55], v[68:71]
s_xor_b32 m0, s77, 99328
s_add_u32 s17, s17, L_base-L_pc-4+53248
ds_read_b64_tr_b16 a[118:119], v20 offset:43264
v_mfma_f32_16x16x32_bf16 v[84:87], a[76:79], a[60:63], v[84:87]
s_xor_b32 s64, s71, 7372800
buffer_load_dword a252, v22, s[88:91], s17 offen
v_mfma_f32_16x16x32_bf16 v[84:87], a[72:75], a[56:59], v[84:87]
buffer_load_dwordx4 v14, s[56:59], s64 offen lds
v_mfma_f32_16x16x32_bf16 v[148:151], a[80:83], a[56:59], v[148:151]
ds_read_b64_tr_b16 a[72:73], v19 offset:32768
v_mfma_f32_16x16x32_bf16 v[148:151], a[84:87], a[60:63], v[148:151]
ds_read_b64_tr_b16 a[74:75], v19 offset:33024
v_mfma_f32_16x16x32_bf16 v[132:135], a[84:87], a[52:55], v[132:135]
ds_read_b64_tr_b16 a[76:77], v19 offset:34816
v_mfma_f32_16x16x32_bf16 v[132:135], a[80:83], a[48:51], v[132:135]
ds_read_b64_tr_b16 a[78:79], v19 offset:35072
v_mfma_f32_16x16x32_bf16 v[116:119], a[80:83], a[40:43], v[116:119]
v_mfma_f32_16x16x32_bf16 v[116:119], a[84:87], a[44:47], v[116:119]
v_mfma_f32_16x16x32_bf16 v[100:103], a[84:87], a[36:39], v[100:103]
s_add_u32 m0, s78, 118784
v_mfma_f32_16x16x32_bf16 v[100:103], a[80:83], a[32:35], v[100:103]
s_waitcnt lgkmcnt(4)
s_add_u32 s64, s75, 5507072
ds_read_b64_tr_b16 a[80:81], v20 offset:32768
v_mfma_f32_16x16x32_bf16 v[184:187], a[88:91], a[0:3], v[184:187]
buffer_load_dwordx4 v23, s[60:63], s64 offen lds
v_mfma_f32_16x16x32_bf16 v[184:187], a[92:95], a[4:7], v[184:187]
ds_read_b64_tr_b16 a[82:83], v20 offset:33024
v_mfma_f32_16x16x32_bf16 v[192:195], a[92:95], a[12:15], v[192:195]
ds_read_b64_tr_b16 a[84:85], v20 offset:34816
v_mfma_f32_16x16x32_bf16 v[192:195], a[88:91], a[8:11], v[192:195]
ds_read_b64_tr_b16 a[86:87], v20 offset:35072
v_mfma_f32_16x16x32_bf16 v[200:203], a[88:91], a[16:19], v[200:203]
v_mfma_f32_16x16x32_bf16 v[200:203], a[92:95], a[20:23], v[200:203]
v_mfma_f32_16x16x32_bf16 v[208:211], a[92:95], a[28:31], v[208:211]
v_mfma_f32_16x16x32_bf16 v[208:211], a[88:91], a[24:27], v[208:211]
ds_read_b64_tr_b16 a[88:89], v4 offset:32768
v_mfma_f32_16x16x32_bf16 v[212:215], a[96:99], a[24:27], v[212:215]
s_xor_b32 m0, s77, 100352
ds_read_b64_tr_b16 a[90:91], v4 offset:33792
v_mfma_f32_16x16x32_bf16 v[212:215], a[100:103], a[28:31], v[212:215]
s_xor_b32 s64, s71, 7405568
ds_read_b64_tr_b16 a[92:93], v4 offset:40960
v_mfma_f32_16x16x32_bf16 v[204:207], a[100:103], a[20:23], v[204:207]
buffer_load_dwordx4 v15, s[56:59], s64 offen lds
v_mfma_f32_16x16x32_bf16 v[204:207], a[96:99], a[16:19], v[204:207]
ds_read_b64_tr_b16 a[94:95], v4 offset:41984
v_mfma_f32_16x16x32_bf16 v[196:199], a[96:99], a[8:11], v[196:199]
v_mfma_f32_16x16x32_bf16 v[196:199], a[100:103], a[12:15], v[196:199]
v_mfma_f32_16x16x32_bf16 v[188:191], a[100:103], a[4:7], v[188:191]
v_mfma_f32_16x16x32_bf16 v[188:191], a[96:99], a[0:3], v[188:191]
ds_read_b64_tr_b16 a[96:97], v5 offset:32768
v_mfma_f32_16x16x32_bf16 v[216:219], a[0:3], a[104:107], v[216:219]
ds_read_b64_tr_b16 a[98:99], v5 offset:33792
v_mfma_f32_16x16x32_bf16 v[216:219], a[4:7], a[108:111], v[216:219]
s_add_u32 m0, s78, 122880
ds_read_b64_tr_b16 a[100:101], v5 offset:40960
v_mfma_f32_16x16x32_bf16 v[224:227], a[12:15], a[108:111], v[224:227]
s_add_u32 s64, s75, 5509120
ds_read_b64_tr_b16 a[102:103], v5 offset:41984
v_mfma_f32_16x16x32_bf16 v[224:227], a[8:11], a[104:107], v[224:227]
buffer_load_dwordx4 v23, s[60:63], s64 offen lds
v_mfma_f32_16x16x32_bf16 v[232:235], a[16:19], a[104:107], v[232:235]
v_mfma_f32_16x16x32_bf16 v[232:235], a[20:23], a[108:111], v[232:235]
v_mfma_f32_16x16x32_bf16 v[240:243], a[28:31], a[108:111], v[240:243]
v_mfma_f32_16x16x32_bf16 v[240:243], a[24:27], a[104:107], v[240:243]
ds_read_b64_tr_b16 a[104:105], v6 offset:32768
v_mfma_f32_16x16x32_bf16 v[244:247], a[24:27], a[112:115], v[244:247]
ds_read_b64_tr_b16 a[106:107], v6 offset:33792
v_mfma_f32_16x16x32_bf16 v[244:247], a[28:31], a[116:119], v[244:247]
ds_read_b64_tr_b16 a[108:109], v6 offset:40960
v_subrev_u32 v19, 0x8000, v19
v_mfma_f32_16x16x32_bf16 v[236:239], a[20:23], a[116:119], v[236:239]
s_xor_b32 m0, s77, 101376
ds_read_b64_tr_b16 a[110:111], v6 offset:41984
v_mfma_f32_16x16x32_bf16 v[236:239], a[16:19], a[112:115], v[236:239]
s_xor_b32 s64, s71, 7438336
v_mfma_f32_16x16x32_bf16 v[228:231], a[8:11], a[112:115], v[228:231]
buffer_load_dwordx4 v15, s[56:59], s64 offen lds
v_mfma_f32_16x16x32_bf16 v[228:231], a[12:15], a[116:119], v[228:231]
v_mfma_f32_16x16x32_bf16 v[220:223], a[4:7], a[116:119], v[220:223]
v_mfma_f32_16x16x32_bf16 v[220:223], a[0:3], a[112:115], v[220:223]
s_waitcnt lgkmcnt(4)
ds_read_b64_tr_b16 a[112:113], v7 offset:32768
v_mfma_f32_16x16x32_bf16 v[152:155], a[72:75], a[0:3], v[152:155]
ds_read_b64_tr_b16 a[114:115], v7 offset:33792
v_mfma_f32_16x16x32_bf16 v[152:155], a[76:79], a[4:7], v[152:155]
ds_read_b64_tr_b16 a[116:117], v7 offset:40960
v_subrev_u32 v20, 0x8000, v20
v_mfma_f32_16x16x32_bf16 v[160:163], a[76:79], a[12:15], v[160:163]
ds_read_b64_tr_b16 a[118:119], v7 offset:41984
v_mfma_f32_16x16x32_bf16 v[160:163], a[72:75], a[8:11], v[160:163]
v_mfma_f32_16x16x32_bf16 v[168:171], a[72:75], a[16:19], v[168:171]
v_mfma_f32_16x16x32_bf16 v[168:171], a[76:79], a[20:23], v[168:171]
v_mfma_f32_16x16x32_bf16 v[176:179], a[76:79], a[28:31], v[176:179]
s_xor_b32 m0, s84, 0
v_mfma_f32_16x16x32_bf16 v[176:179], a[72:75], a[24:27], v[176:179]
s_xor_b32 s64, s72, 1792
ds_read_b64_tr_b16 a[72:73], v8 offset:32768
v_mfma_f32_16x16x32_bf16 v[180:183], a[80:83], a[24:27], v[180:183]
buffer_load_dwordx4 v12, s[48:51], s64 offen lds
v_mfma_f32_16x16x32_bf16 v[180:183], a[84:87], a[28:31], v[180:183]
ds_read_b64_tr_b16 a[74:75], v8 offset:33792
v_subrev_u32 v4, 0x8000, v4
v_mfma_f32_16x16x32_bf16 v[172:175], a[84:87], a[20:23], v[172:175]
ds_read_b64_tr_b16 a[76:77], v8 offset:40960
v_mfma_f32_16x16x32_bf16 v[172:175], a[80:83], a[16:19], v[172:175]
s_xor_b32 m0, s84, 1024
ds_read_b64_tr_b16 a[78:79], v8 offset:41984
v_mfma_f32_16x16x32_bf16 v[164:167], a[80:83], a[8:11], v[164:167]
s_xor_b32 s64, s72, 18176
v_mfma_f32_16x16x32_bf16 v[164:167], a[84:87], a[12:15], v[164:167]
buffer_load_dwordx4 v13, s[48:51], s64 offen lds
v_mfma_f32_16x16x32_bf16 v[156:159], a[84:87], a[4:7], v[156:159]
v_mfma_f32_16x16x32_bf16 v[156:159], a[80:83], a[0:3], v[156:159]
ds_read_b64_tr_b16 a[80:81], v9 offset:32768
v_mfma_f32_16x16x32_bf16 v[24:27], a[88:91], a[0:3], v[24:27]
s_xor_b32 m0, s84, 2048
ds_read_b64_tr_b16 a[82:83], v9 offset:33792
v_mfma_f32_16x16x32_bf16 v[24:27], a[92:95], a[4:7], v[24:27]
s_xor_b32 s64, s72, 132864
ds_read_b64_tr_b16 a[84:85], v9 offset:40960
v_subrev_u32 v5, 0x8000, v5
v_mfma_f32_16x16x32_bf16 v[40:43], a[92:95], a[12:15], v[40:43]
buffer_load_dwordx4 v12, s[48:51], s64 offen lds
v_mfma_f32_16x16x32_bf16 v[40:43], a[88:91], a[8:11], v[40:43]
ds_read_b64_tr_b16 a[86:87], v9 offset:41984
v_mfma_f32_16x16x32_bf16 v[56:59], a[88:91], a[16:19], v[56:59]
v_mfma_f32_16x16x32_bf16 v[56:59], a[92:95], a[20:23], v[56:59]
s_xor_b32 m0, s84, 3072
v_mfma_f32_16x16x32_bf16 v[72:75], a[92:95], a[28:31], v[72:75]
s_waitcnt vmcnt(12)
s_xor_b32 s64, s72, 149248
ds_read_b128 a[32:35], v2 offset:32768
v_mfma_f32_16x16x32_bf16 v[72:75], a[88:91], a[24:27], v[72:75]
s_branch L_po12
L_pg12:
s_branch L_tr1
L_po12:
buffer_load_dwordx4 v13, s[48:51], s64 offen lds
v_mfma_f32_16x16x32_bf16 v[136:139], a[96:99], a[24:27], v[136:139]
ds_read_b128 a[36:39], v3 offset:32768
v_mfma_f32_16x16x32_bf16 v[136:139], a[100:103], a[28:31], v[136:139]
ds_read_b128 a[40:43], v2 offset:34816
v_subrev_u32 v6, 0x8000, v6
v_mfma_f32_16x16x32_bf16 v[120:123], a[100:103], a[20:23], v[120:123]
s_xor_b32 m0, s84, 4096
ds_read_b128 a[44:47], v3 offset:34816
v_mfma_f32_16x16x32_bf16 v[120:123], a[96:99], a[16:19], v[120:123]
s_xor_b32 s64, s73, 1792
ds_read_b128 a[48:51], v2 offset:36864
v_mfma_f32_16x16x32_bf16 v[104:107], a[96:99], a[8:11], v[104:107]
buffer_load_dwordx4 v12, s[48:51], s64 offen lds
v_mfma_f32_16x16x32_bf16 v[104:107], a[100:103], a[12:15], v[104:107]
ds_read_b128 a[52:55], v3 offset:36864
v_mfma_f32_16x16x32_bf16 v[88:91], a[100:103], a[4:7], v[88:91]
ds_read_b128 a[56:59], v2 offset:38912
v_mfma_f32_16x16x32_bf16 v[88:91], a[96:99], a[0:3], v[88:91]
s_waitcnt lgkmcnt(7)
s_xor_b32 m0, s84, 5120
ds_read_b128 a[60:63], v3 offset:38912
v_mfma_f32_16x16x32_bf16 v[28:31], a[104:107], a[0:3], v[28:31]
s_xor_b32 s64, s73, 18176
ds_read_b64_tr_b16 a[88:89], v10 offset:32768
v_mfma_f32_16x16x32_bf16 v[28:31], a[108:111], a[4:7], v[28:31]
buffer_load_dwordx4 v13, s[48:51], s64 offen lds
v_mfma_f32_16x16x32_bf16 v[44:47], a[108:111], a[12:15], v[44:47]
ds_read_b64_tr_b16 a[90:91], v10 offset:33792
v_subrev_u32 v7, 0x8000, v7
v_mfma_f32_16x16x32_bf16 v[44:47], a[104:107], a[8:11], v[44:47]
ds_read_b64_tr_b16 a[92:93], v10 offset:40960
v_mfma_f32_16x16x32_bf16 v[60:63], a[104:107], a[16:19], v[60:63]
s_xor_b32 m0, s84, 6144
ds_read_b64_tr_b16 a[94:95], v10 offset:41984
v_mfma_f32_16x16x32_bf16 v[60:63], a[108:111], a[20:23], v[60:63]
s_xor_b32 s64, s73, 132864
ds_read_b64_tr_b16 a[96:97], v11 offset:32768
v_mfma_f32_16x16x32_bf16 v[76:79], a[108:111], a[28:31], v[76:79]
buffer_load_dwordx4 v12, s[48:51], s64 offen lds
v_mfma_f32_16x16x32_bf16 v[76:79], a[104:107], a[24:27], v[76:79]
ds_read_b64_tr_b16 a[98:99], v11 offset:33792
v_mfma_f32_16x16x32_bf16 v[140:143], a[112:115], a[24:27], v[140:143]
ds_read_b64_tr_b16 a[100:101], v11 offset:40960
v_mfma_f32_16x16x32_bf16 v[140:143], a[116:119], a[28:31], v[140:143]
s_xor_b32 m0, s84, 7168
ds_read_b64_tr_b16 a[102:103], v11 offset:41984
v_subrev_u32 v8, 0x8000, v8
v_mfma_f32_16x16x32_bf16 v[124:127], a[116:119], a[20:23], v[124:127]
s_xor_b32 s64, s73, 149248
v_mfma_f32_16x16x32_bf16 v[124:127], a[112:115], a[16:19], v[124:127]
buffer_load_dwordx4 v13, s[48:51], s64 offen lds
v_mfma_f32_16x16x32_bf16 v[108:111], a[112:115], a[8:11], v[108:111]
v_mfma_f32_16x16x32_bf16 v[108:111], a[116:119], a[12:15], v[108:111]
v_mfma_f32_16x16x32_bf16 v[92:95], a[116:119], a[4:7], v[92:95]
v_subrev_u32 v9, 0x8000, v9
v_subrev_u32 v10, 0x8000, v10
v_mfma_f32_16x16x32_bf16 v[92:95], a[112:115], a[0:3], v[92:95]
v_subrev_u32 v11, 0x8000, v11
v_mfma_f32_16x16x32_bf16 v[32:35], a[72:75], a[0:3], v[32:35]
v_mfma_f32_16x16x32_bf16 v[32:35], a[76:79], a[4:7], v[32:35]
v_mfma_f32_16x16x32_bf16 v[48:51], a[76:79], a[12:15], v[48:51]
s_cmp_eq_u32 s30, 0
s_cbranch_scc1 L_pg14
s_cmp_eq_u32 s30, 1
s_cbranch_scc1 L_pg15
s_cmp_eq_u32 s30, 2
s_cbranch_scc1 L_pg16
s_branch L_pg17
L_tr2:
s_waitcnt lgkmcnt(0)
s_barrier
v_mfma_f32_16x16x32_bf16 v[48:51], a[72:75], a[8:11], v[48:51]
s_xor_b32 m0, s77, 131072
buffer_load_dword v1, off, s[52:55], s70 sc1
v_mfma_f32_16x16x32_bf16 v[64:67], a[72:75], a[16:19], v[64:67]
s_xor_b32 s64, s71, 7864320
ds_read_b64_tr_b16 a[104:105], v19 offset:4096
v_mfma_f32_16x16x32_bf16 v[64:67], a[76:79], a[20:23], v[64:67]
buffer_load_dwordx4 v14, s[56:59], s64 offen lds
v_mfma_f32_16x16x32_bf16 v[80:83], a[76:79], a[28:31], v[80:83]
ds_read_b64_tr_b16 a[106:107], v19 offset:4352
v_mfma_f32_16x16x32_bf16 v[80:83], a[72:75], a[24:27], v[80:83]
ds_read_b64_tr_b16 a[108:109], v19 offset:6144
v_mfma_f32_16x16x32_bf16 v[144:147], a[80:83], a[24:27], v[144:147]
ds_read_b64_tr_b16 a[110:111], v19 offset:6400
v_mfma_f32_16x16x32_bf16 v[144:147], a[84:87], a[28:31], v[144:147]
ds_read_b64_tr_b16 a[112:113], v20 offset:4096
v_mfma_f32_16x16x32_bf16 v[128:131], a[84:87], a[20:23], v[128:131]
ds_read_b64_tr_b16 a[114:115], v20 offset:4352
v_mfma_f32_16x16x32_bf16 v[128:131], a[80:83], a[16:19], v[128:131]
ds_read_b64_tr_b16 a[116:117], v20 offset:6144
v_mfma_f32_16x16x32_bf16 v[112:115], a[80:83], a[8:11], v[112:115]
s_add_u32 m0, s78, 147456
ds_read_b64_tr_b16 a[118:119], v20 offset:6400
v_mfma_f32_16x16x32_bf16 v[112:115], a[84:87], a[12:15], v[112:115]
s_add_u32 s64, s75, 5898240
ds_read_b64_tr_b16 a[72:73], v19 offset:8192
v_mfma_f32_16x16x32_bf16 v[96:99], a[84:87], a[4:7], v[96:99]
buffer_load_dwordx4 v23, s[60:63], s64 offen lds
v_mfma_f32_16x16x32_bf16 v[96:99], a[80:83], a[0:3], v[96:99]
ds_read_b64_tr_b16 a[74:75], v19 offset:8448
v_mfma_f32_16x16x32_bf16 v[36:39], a[88:91], a[0:3], v[36:39]
ds_read_b64_tr_b16 a[76:77], v19 offset:10240
v_mfma_f32_16x16x32_bf16 v[36:39], a[92:95], a[4:7], v[36:39]
ds_read_b64_tr_b16 a[78:79], v19 offset:10496
v_mfma_f32_16x16x32_bf16 v[52:55], a[92:95], a[12:15], v[52:55]
ds_read_b64_tr_b16 a[80:81], v20 offset:8192
v_mfma_f32_16x16x32_bf16 v[52:55], a[88:91], a[8:11], v[52:55]
ds_read_b64_tr_b16 a[82:83], v20 offset:8448
v_mfma_f32_16x16x32_bf16 v[68:71], a[88:91], a[16:19], v[68:71]
ds_read_b64_tr_b16 a[84:85], v20 offset:10240
v_mfma_f32_16x16x32_bf16 v[68:71], a[92:95], a[20:23], v[68:71]
s_xor_b32 m0, s77, 132096
ds_read_b64_tr_b16 a[86:87], v20 offset:10496
v_mfma_f32_16x16x32_bf16 v[84:87], a[92:95], a[28:31], v[84:87]
s_xor_b32 s64, s71, 7897088
v_mfma_f32_16x16x32_bf16 v[84:87], a[88:91], a[24:27], v[84:87]
buffer_load_dwordx4 v14, s[56:59], s64 offen lds
v_mfma_f32_16x16x32_bf16 v[148:151], a[96:99], a[24:27], v[148:151]
ds_read_b64_tr_b16 a[88:89], v19 offset:0
v_mfma_f32_16x16x32_bf16 v[148:151], a[100:103], a[28:31], v[148:151]
ds_read_b64_tr_b16 a[90:91], v19 offset:256
v_mfma_f32_16x16x32_bf16 v[132:135], a[100:103], a[20:23], v[132:135]
ds_read_b64_tr_b16 a[92:93], v19 offset:2048
v_mfma_f32_16x16x32_bf16 v[132:135], a[96:99], a[16:19], v[132:135]
ds_read_b64_tr_b16 a[94:95], v19 offset:2304
v_mfma_f32_16x16x32_bf16 v[116:119], a[96:99], a[8:11], v[116:119]
v_mfma_f32_16x16x32_bf16 v[116:119], a[100:103], a[12:15], v[116:119]
v_mfma_f32_16x16x32_bf16 v[100:103], a[100:103], a[4:7], v[100:103]
s_add_u32 m0, s78, 151552
v_mfma_f32_16x16x32_bf16 v[100:103], a[96:99], a[0:3], v[100:103]
s_waitcnt lgkmcnt(4)
s_add_u32 s64, s75, 5900288
ds_read_b64_tr_b16 a[96:97], v20 offset:0
v_mfma_f32_16x16x32_bf16 v[184:187], a[104:107], a[32:35], v[184:187]
buffer_load_dwordx4 v23, s[60:63], s64 offen lds
v_mfma_f32_16x16x32_bf16 v[184:187], a[108:111], a[36:39], v[184:187]
ds_read_b64_tr_b16 a[98:99], v20 offset:256
v_and_b32 v22, 15, v0
v_mfma_f32_16x16x32_bf16 v[192:195], a[108:111], a[44:47], v[192:195]
ds_read_b64_tr_b16 a[100:101], v20 offset:2048
v_lshlrev_b32 v22, 3, v22
v_mfma_f32_16x16x32_bf16 v[192:195], a[104:107], a[40:43], v[192:195]
s_lshl_b32 s85, s30, 7
s_add_u32 s85, s85, 58720256
ds_read_b64_tr_b16 a[102:103], v20 offset:2304
v_mfma_f32_16x16x32_bf16 v[200:203], a[104:107], a[48:51], v[200:203]
s_lshl_b32 s86, s3, 10
s_add_u32 s86, s86, s85
s_lshl_b32 s87, s16, 10
s_lshl_b32 s68, s31, 20
s_add_u32 s32, s28, s68
s_addc_u32 s33, s29, 0
v_mfma_f32_16x16x32_bf16 v[200:203], a[108:111], a[52:55], v[200:203]
s_add_u32 s87, s87, s85
s_add_u32 s68, s16, 1
s_lshl_b32 s34, s68, 16
v_mfma_f32_16x16x32_bf16 v[208:211], a[108:111], a[60:63], v[208:211]
v_mfma_f32_16x16x32_bf16 v[208:211], a[104:107], a[56:59], v[208:211]
ds_read_b64_tr_b16 a[104:105], v4 offset:0
v_mfma_f32_16x16x32_bf16 v[212:215], a[112:115], a[56:59], v[212:215]
s_xor_b32 m0, s77, 133120
ds_read_b64_tr_b16 a[106:107], v4 offset:1024
v_mfma_f32_16x16x32_bf16 v[212:215], a[116:119], a[60:63], v[212:215]
s_xor_b32 s64, s71, 7929856
ds_read_b64_tr_b16 a[108:109], v4 offset:8192
v_mfma_f32_16x16x32_bf16 v[204:207], a[116:119], a[52:55], v[204:207]
buffer_load_dwordx4 v15, s[56:59], s64 offen lds
v_mfma_f32_16x16x32_bf16 v[204:207], a[112:115], a[48:51], v[204:207]
ds_read_b64_tr_b16 a[110:111], v4 offset:9216
v_mfma_f32_16x16x32_bf16 v[196:199], a[112:115], a[40:43], v[196:199]
v_mfma_f32_16x16x32_bf16 v[196:199], a[116:119], a[44:47], v[196:199]
v_mfma_f32_16x16x32_bf16 v[188:191], a[116:119], a[36:39], v[188:191]
v_mfma_f32_16x16x32_bf16 v[188:191], a[112:115], a[32:35], v[188:191]
ds_read_b64_tr_b16 a[112:113], v5 offset:0
v_mfma_f32_16x16x32_bf16 v[216:219], a[32:35], a[72:75], v[216:219]
ds_read_b64_tr_b16 a[114:115], v5 offset:1024
v_mfma_f32_16x16x32_bf16 v[216:219], a[36:39], a[76:79], v[216:219]
s_add_u32 m0, s78, 155648
ds_read_b64_tr_b16 a[116:117], v5 offset:8192
v_mfma_f32_16x16x32_bf16 v[224:227], a[44:47], a[76:79], v[224:227]
s_add_u32 s64, s75, 5902336
ds_read_b64_tr_b16 a[118:119], v5 offset:9216
v_mfma_f32_16x16x32_bf16 v[224:227], a[40:43], a[72:75], v[224:227]
buffer_load_dwordx4 v23, s[60:63], s64 offen lds
v_mfma_f32_16x16x32_bf16 v[232:235], a[48:51], a[72:75], v[232:235]
v_mfma_f32_16x16x32_bf16 v[232:235], a[52:55], a[76:79], v[232:235]
v_mfma_f32_16x16x32_bf16 v[240:243], a[60:63], a[76:79], v[240:243]
v_mfma_f32_16x16x32_bf16 v[240:243], a[56:59], a[72:75], v[240:243]
ds_read_b64_tr_b16 a[72:73], v6 offset:0
v_mfma_f32_16x16x32_bf16 v[244:247], a[56:59], a[80:83], v[244:247]
ds_read_b64_tr_b16 a[74:75], v6 offset:1024
v_mfma_f32_16x16x32_bf16 v[244:247], a[60:63], a[84:87], v[244:247]
ds_read_b64_tr_b16 a[76:77], v6 offset:8192
v_mfma_f32_16x16x32_bf16 v[236:239], a[52:55], a[84:87], v[236:239]
s_xor_b32 m0, s77, 134144
ds_read_b64_tr_b16 a[78:79], v6 offset:9216
v_mfma_f32_16x16x32_bf16 v[236:239], a[48:51], a[80:83], v[236:239]
s_xor_b32 s64, s71, 7962624
v_mfma_f32_16x16x32_bf16 v[228:231], a[40:43], a[80:83], v[228:231]
buffer_load_dwordx4 v15, s[56:59], s64 offen lds
v_mfma_f32_16x16x32_bf16 v[228:231], a[44:47], a[84:87], v[228:231]
v_mfma_f32_16x16x32_bf16 v[220:223], a[36:39], a[84:87], v[220:223]
v_mfma_f32_16x16x32_bf16 v[220:223], a[32:35], a[80:83], v[220:223]
s_waitcnt lgkmcnt(4)
ds_read_b64_tr_b16 a[80:81], v7 offset:0
v_mfma_f32_16x16x32_bf16 v[152:155], a[88:91], a[32:35], v[152:155]
ds_read_b64_tr_b16 a[82:83], v7 offset:1024
v_mfma_f32_16x16x32_bf16 v[152:155], a[92:95], a[36:39], v[152:155]
ds_read_b64_tr_b16 a[84:85], v7 offset:8192
v_mfma_f32_16x16x32_bf16 v[160:163], a[92:95], a[44:47], v[160:163]
ds_read_b64_tr_b16 a[86:87], v7 offset:9216
v_mfma_f32_16x16x32_bf16 v[160:163], a[88:91], a[40:43], v[160:163]
v_mfma_f32_16x16x32_bf16 v[168:171], a[88:91], a[48:51], v[168:171]
v_mfma_f32_16x16x32_bf16 v[168:171], a[92:95], a[52:55], v[168:171]
v_mfma_f32_16x16x32_bf16 v[176:179], a[92:95], a[60:63], v[176:179]
s_xor_b32 m0, s84, 32768
v_mfma_f32_16x16x32_bf16 v[176:179], a[88:91], a[56:59], v[176:179]
s_xor_b32 s64, s72, 1920
ds_read_b64_tr_b16 a[88:89], v8 offset:0
v_mfma_f32_16x16x32_bf16 v[180:183], a[96:99], a[56:59], v[180:183]
buffer_load_dwordx4 v12, s[48:51], s64 offen lds
v_mfma_f32_16x16x32_bf16 v[180:183], a[100:103], a[60:63], v[180:183]
ds_read_b64_tr_b16 a[90:91], v8 offset:1024
v_mfma_f32_16x16x32_bf16 v[172:175], a[100:103], a[52:55], v[172:175]
ds_read_b64_tr_b16 a[92:93], v8 offset:8192
v_mfma_f32_16x16x32_bf16 v[172:175], a[96:99], a[48:51], v[172:175]
s_xor_b32 m0, s84, 33792
ds_read_b64_tr_b16 a[94:95], v8 offset:9216
v_mfma_f32_16x16x32_bf16 v[164:167], a[96:99], a[40:43], v[164:167]
s_xor_b32 s64, s72, 18304
v_mfma_f32_16x16x32_bf16 v[164:167], a[100:103], a[44:47], v[164:167]
buffer_load_dwordx4 v13, s[48:51], s64 offen lds
v_mfma_f32_16x16x32_bf16 v[156:159], a[100:103], a[36:39], v[156:159]
v_mfma_f32_16x16x32_bf16 v[156:159], a[96:99], a[32:35], v[156:159]
ds_read_b64_tr_b16 a[96:97], v9 offset:0
v_mfma_f32_16x16x32_bf16 v[24:27], a[104:107], a[32:35], v[24:27]
s_xor_b32 m0, s84, 34816
ds_read_b64_tr_b16 a[98:99], v9 offset:1024
v_mfma_f32_16x16x32_bf16 v[24:27], a[108:111], a[36:39], v[24:27]
s_xor_b32 s64, s72, 132992
ds_read_b64_tr_b16 a[100:101], v9 offset:8192
v_mfma_f32_16x16x32_bf16 v[40:43], a[108:111], a[44:47], v[40:43]
buffer_load_dwordx4 v12, s[48:51], s64 offen lds
v_mfma_f32_16x16x32_bf16 v[40:43], a[104:107], a[40:43], v[40:43]
ds_read_b64_tr_b16 a[102:103], v9 offset:9216
v_mfma_f32_16x16x32_bf16 v[56:59], a[104:107], a[48:51], v[56:59]
v_mfma_f32_16x16x32_bf16 v[56:59], a[108:111], a[52:55], v[56:59]
s_xor_b32 m0, s84, 35840
v_mfma_f32_16x16x32_bf16 v[72:75], a[108:111], a[60:63], v[72:75]
s_waitcnt vmcnt(11)
s_xor_b32 s64, s72, 149376
ds_read_b128 a[0:3], v2 offset:0
v_mfma_f32_16x16x32_bf16 v[72:75], a[104:107], a[56:59], v[72:75]
buffer_load_dwordx4 v13, s[48:51], s64 offen lds
v_mfma_f32_16x16x32_bf16 v[136:139], a[112:115], a[56:59], v[136:139]
ds_read_b128 a[4:7], v3 offset:0
v_mfma_f32_16x16x32_bf16 v[136:139], a[116:119], a[60:63], v[136:139]
ds_read_b128 a[8:11], v2 offset:2048
v_mfma_f32_16x16x32_bf16 v[120:123], a[116:119], a[52:55], v[120:123]
s_xor_b32 m0, s84, 36864
ds_read_b128 a[12:15], v3 offset:2048
v_mfma_f32_16x16x32_bf16 v[120:123], a[112:115], a[48:51], v[120:123]
s_xor_b32 s64, s73, 1920
ds_read_b128 a[16:19], v2 offset:4096
v_mfma_f32_16x16x32_bf16 v[104:107], a[112:115], a[40:43], v[104:107]
buffer_load_dwordx4 v12, s[48:51], s64 offen lds
v_mfma_f32_16x16x32_bf16 v[104:107], a[116:119], a[44:47], v[104:107]
ds_read_b128 a[20:23], v3 offset:4096
v_mfma_f32_16x16x32_bf16 v[88:91], a[116:119], a[36:39], v[88:91]
ds_read_b128 a[24:27], v2 offset:6144
v_mfma_f32_16x16x32_bf16 v[88:91], a[112:115], a[32:35], v[88:91]
s_waitcnt lgkmcnt(7)
s_xor_b32 m0, s84, 37888
ds_read_b128 a[28:31], v3 offset:6144
v_mfma_f32_16x16x32_bf16 v[28:31], a[72:75], a[32:35], v[28:31]
s_xor_b32 s64, s73, 18304
ds_read_b64_tr_b16 a[104:105], v10 offset:0
v_mfma_f32_16x16x32_bf16 v[28:31], a[76:79], a[36:39], v[28:31]
buffer_load_dwordx4 v13, s[48:51], s64 offen lds
v_mfma_f32_16x16x32_bf16 v[44:47], a[76:79], a[44:47], v[44:47]
ds_read_b64_tr_b16 a[106:107], v10 offset:1024
v_mfma_f32_16x16x32_bf16 v[44:47], a[72:75], a[40:43], v[44:47]
ds_read_b64_tr_b16 a[108:109], v10 offset:8192
v_mfma_f32_16x16x32_bf16 v[60:63], a[72:75], a[48:51], v[60:63]
s_xor_b32 m0, s84, 38912
ds_read_b64_tr_b16 a[110:111], v10 offset:9216
v_mfma_f32_16x16x32_bf16 v[60:63], a[76:79], a[52:55], v[60:63]
s_xor_b32 s64, s73, 132992
ds_read_b64_tr_b16 a[112:113], v11 offset:0
v_mfma_f32_16x16x32_bf16 v[76:79], a[76:79], a[60:63], v[76:79]
buffer_load_dwordx4 v12, s[48:51], s64 offen lds
v_mfma_f32_16x16x32_bf16 v[76:79], a[72:75], a[56:59], v[76:79]
ds_read_b64_tr_b16 a[114:115], v11 offset:1024
v_mfma_f32_16x16x32_bf16 v[140:143], a[80:83], a[56:59], v[140:143]
ds_read_b64_tr_b16 a[116:117], v11 offset:8192
v_mfma_f32_16x16x32_bf16 v[140:143], a[84:87], a[60:63], v[140:143]
s_xor_b32 m0, s84, 39936
ds_read_b64_tr_b16 a[118:119], v11 offset:9216
v_mfma_f32_16x16x32_bf16 v[124:127], a[84:87], a[52:55], v[124:127]
s_xor_b32 s64, s73, 149376
v_mfma_f32_16x16x32_bf16 v[124:127], a[80:83], a[48:51], v[124:127]
buffer_load_dwordx4 v13, s[48:51], s64 offen lds
v_mfma_f32_16x16x32_bf16 v[108:111], a[80:83], a[40:43], v[108:111]
v_mfma_f32_16x16x32_bf16 v[108:111], a[84:87], a[44:47], v[108:111]
v_mfma_f32_16x16x32_bf16 v[92:95], a[84:87], a[36:39], v[92:95]
s_waitcnt vmcnt(15)
v_readfirstlane_b32 vcc_lo, v1
s_nop 0
s_cmp_lt_u32 vcc_lo, s81
s_cbranch_scc1 L_spin_4
L_spinbk_5:
v_mfma_f32_16x16x32_bf16 v[92:95], a[80:83], a[32:35], v[92:95]
buffer_load_dwordx2 a[64:65], v22, s[44:47], s86 offen offset:0 sc1
v_mfma_f32_16x16x32_bf16 v[32:35], a[88:91], a[32:35], v[32:35]
buffer_load_dwordx2 a[66:67], v22, s[44:47], s86 offen offset:512 sc1
v_mfma_f32_16x16x32_bf16 v[32:35], a[92:95], a[36:39], v[32:35]
buffer_load_dwordx2 a[68:69], v22, s[44:47], s87 offen offset:0 sc1
v_mfma_f32_16x16x32_bf16 v[48:51], a[92:95], a[44:47], v[48:51]
s_waitcnt lgkmcnt(0)
s_barrier
v_mfma_f32_16x16x32_bf16 v[48:51], a[88:91], a[40:43], v[48:51]
ds_read_b64_tr_b16 a[72:73], v19 offset:36864
v_mfma_f32_16x16x32_bf16 v[64:67], a[88:91], a[48:51], v[64:67]
s_lshl2_add_u32 s72, s2, s30
ds_read_b64_tr_b16 a[74:75], v19 offset:37120
v_mfma_f32_16x16x32_bf16 v[64:67], a[92:95], a[52:55], v[64:67]
s_lshl_b32 s72, s72, 12
s_mov_b32 m0, s76
ds_read_b64_tr_b16 a[76:77], v19 offset:38912
v_mfma_f32_16x16x32_bf16 v[80:83], a[92:95], a[60:63], v[80:83]
s_add_u32 s72, s72, 67108864
s_lshl_b32 s64, s30, 14
ds_read_b64_tr_b16 a[78:79], v19 offset:39168
v_mfma_f32_16x16x32_bf16 v[80:83], a[88:91], a[56:59], v[80:83]
buffer_load_dwordx4 v16, s[32:35], s64 offen offset:0 sc1 lds
v_mfma_f32_16x16x32_bf16 v[144:147], a[96:99], a[56:59], v[144:147]
buffer_load_dwordx2 a[70:71], v22, s[44:47], s87 offen offset:512 sc1
v_mfma_f32_16x16x32_bf16 v[144:147], a[100:103], a[60:63], v[144:147]
ds_read_b64_tr_b16 a[80:81], v20 offset:36864
v_mfma_f32_16x16x32_bf16 v[128:131], a[100:103], a[52:55], v[128:131]
ds_read_b64_tr_b16 a[82:83], v20 offset:37120
v_mfma_f32_16x16x32_bf16 v[128:131], a[96:99], a[48:51], v[128:131]
ds_read_b64_tr_b16 a[84:85], v20 offset:38912
v_mfma_f32_16x16x32_bf16 v[112:115], a[96:99], a[40:43], v[112:115]
ds_read_b64_tr_b16 a[86:87], v20 offset:39168
v_mfma_f32_16x16x32_bf16 v[112:115], a[100:103], a[44:47], v[112:115]
ds_read_b64_tr_b16 a[88:89], v19 offset:40960
v_mfma_f32_16x16x32_bf16 v[96:99], a[100:103], a[36:39], v[96:99]
ds_read_b64_tr_b16 a[90:91], v19 offset:41216
v_mfma_f32_16x16x32_bf16 v[96:99], a[96:99], a[32:35], v[96:99]
buffer_load_dwordx4 v16, s[32:35], s64 offen offset:1024 sc1 lds
v_mfma_f32_16x16x32_bf16 v[36:39], a[104:107], a[32:35], v[36:39]
buffer_store_dwordx4 a[240:243], v16, s[44:47], s72 offen offset:0 sc1
v_mfma_f32_16x16x32_bf16 v[36:39], a[108:111], a[36:39], v[36:39]
ds_read_b64_tr_b16 a[92:93], v19 offset:43008
v_mfma_f32_16x16x32_bf16 v[52:55], a[108:111], a[44:47], v[52:55]
ds_read_b64_tr_b16 a[94:95], v19 offset:43264
v_mfma_f32_16x16x32_bf16 v[52:55], a[104:107], a[40:43], v[52:55]
ds_read_b64_tr_b16 a[96:97], v20 offset:40960
v_mfma_f32_16x16x32_bf16 v[68:71], a[104:107], a[48:51], v[68:71]
ds_read_b64_tr_b16 a[98:99], v20 offset:41216
v_mfma_f32_16x16x32_bf16 v[68:71], a[108:111], a[52:55], v[68:71]
ds_read_b64_tr_b16 a[100:101], v20 offset:43008
v_mfma_f32_16x16x32_bf16 v[84:87], a[108:111], a[60:63], v[84:87]
ds_read_b64_tr_b16 a[102:103], v20 offset:43264
v_mfma_f32_16x16x32_bf16 v[84:87], a[104:107], a[56:59], v[84:87]
buffer_load_dwordx4 v16, s[32:35], s64 offen offset:2048 sc1 lds
v_mfma_f32_16x16x32_bf16 v[148:151], a[112:115], a[56:59], v[148:151]
ds_read_b64_tr_b16 a[104:105], v19 offset:32768
v_mfma_f32_16x16x32_bf16 v[148:151], a[116:119], a[60:63], v[148:151]
ds_read_b64_tr_b16 a[106:107], v19 offset:33024
v_mfma_f32_16x16x32_bf16 v[132:135], a[116:119], a[52:55], v[132:135]
ds_read_b64_tr_b16 a[108:109], v19 offset:34816
v_mfma_f32_16x16x32_bf16 v[132:135], a[112:115], a[48:51], v[132:135]
ds_read_b64_tr_b16 a[110:111], v19 offset:35072
v_mfma_f32_16x16x32_bf16 v[116:119], a[112:115], a[40:43], v[116:119]
v_mfma_f32_16x16x32_bf16 v[116:119], a[116:119], a[44:47], v[116:119]
v_mfma_f32_16x16x32_bf16 v[100:103], a[116:119], a[36:39], v[100:103]
buffer_store_dwordx4 a[240:243], v16, s[44:47], s72 offen offset:1024 sc1
v_mfma_f32_16x16x32_bf16 v[100:103], a[112:115], a[32:35], v[100:103]
s_waitcnt lgkmcnt(5)
buffer_load_dwordx4 v16, s[32:35], s64 offen offset:3072 sc1 lds
v_mfma_f32_16x16x32_bf16 v[184:187], a[72:75], a[0:3], v[184:187]
ds_read_b64_tr_b16 a[112:113], v20 offset:32768
v_and_b32 v12, 15, v0
v_mfma_f32_16x16x32_bf16 v[184:187], a[76:79], a[4:7], v[184:187]
ds_read_b64_tr_b16 a[114:115], v20 offset:33024
v_lshrrev_b32 v13, 4, v0
v_mfma_f32_16x16x32_bf16 v[192:195], a[76:79], a[12:15], v[192:195]
ds_read_b64_tr_b16 a[116:117], v20 offset:34816
v_lshlrev_b32 v13, 2, v13
v_mfma_f32_16x16x32_bf16 v[192:195], a[72:75], a[8:11], v[192:195]
ds_read_b64_tr_b16 a[118:119], v20 offset:35072
v_sub_u32 v12, v12, v13
v_mfma_f32_16x16x32_bf16 v[200:203], a[72:75], a[16:19], v[200:203]
s_lshl_b32 s66, s30, 4
v_mfma_f32_16x16x32_bf16 v[200:203], a[76:79], a[20:23], v[200:203]
s_add_u32 m0, s76, 4096
v_add_u32 v13, s66, v12
v_cmp_gt_i32 s[0:1], 0, v13
v_mfma_f32_16x16x32_bf16 v[208:211], a[76:79], a[28:31], v[208:211]
s_add_u32 s64, s64, 4096
v_cmp_gt_i32 s[4:5], 1, v13
v_cmp_gt_i32 s[6:7], 2, v13
v_mfma_f32_16x16x32_bf16 v[208:211], a[72:75], a[24:27], v[208:211]
buffer_load_dwordx4 v16, s[32:35], s64 offen offset:0 sc1 lds
v_mfma_f32_16x16x32_bf16 v[212:215], a[80:83], a[24:27], v[212:215]
ds_read_b64_tr_b16 a[72:73], v4 offset:32768
v_cmp_gt_i32 s[8:9], 3, v13
v_mfma_f32_16x16x32_bf16 v[212:215], a[84:87], a[28:31], v[212:215]
ds_read_b64_tr_b16 a[74:75], v4 offset:33792
v_cmp_gt_i32 s[10:11], 16, v13
v_mfma_f32_16x16x32_bf16 v[204:207], a[84:87], a[20:23], v[204:207]
ds_read_b64_tr_b16 a[76:77], v4 offset:40960
v_cmp_gt_i32 s[12:13], 17, v13
v_mfma_f32_16x16x32_bf16 v[204:207], a[80:83], a[16:19], v[204:207]
ds_read_b64_tr_b16 a[78:79], v4 offset:41984
v_cmp_gt_i32 s[18:19], 18, v13
v_mfma_f32_16x16x32_bf16 v[196:199], a[80:83], a[8:11], v[196:199]
buffer_store_dwordx4 a[240:243], v16, s[44:47], s72 offen offset:2048 sc1
v_mfma_f32_16x16x32_bf16 v[196:199], a[84:87], a[12:15], v[196:199]
v_cmp_gt_i32 s[22:23], 19, v13
v_cmp_gt_i32 s[26:27], 32, v13
v_mfma_f32_16x16x32_bf16 v[188:191], a[84:87], a[4:7], v[188:191]
v_cmp_gt_i32 s[56:57], 33, v13
v_cmp_gt_i32 s[58:59], 34, v13
v_mfma_f32_16x16x32_bf16 v[188:191], a[80:83], a[0:3], v[188:191]
buffer_load_dwordx4 v16, s[32:35], s64 offen offset:1024 sc1 lds
v_mfma_f32_16x16x32_bf16 v[216:219], a[0:3], a[88:91], v[216:219]
ds_read_b64_tr_b16 a[80:81], v5 offset:32768
v_cmp_gt_i32 s[60:61], 35, v13
v_mfma_f32_16x16x32_bf16 v[216:219], a[4:7], a[92:95], v[216:219]
ds_read_b64_tr_b16 a[82:83], v5 offset:33792
v_cmp_gt_i32 s[62:63], 48, v13
v_mfma_f32_16x16x32_bf16 v[224:227], a[12:15], a[92:95], v[224:227]
ds_read_b64_tr_b16 a[84:85], v5 offset:40960
v_cmp_gt_i32 s[48:49], 49, v13
v_mfma_f32_16x16x32_bf16 v[224:227], a[8:11], a[88:91], v[224:227]
ds_read_b64_tr_b16 a[86:87], v5 offset:41984
v_cmp_gt_i32 s[50:51], 50, v13
v_mfma_f32_16x16x32_bf16 v[232:235], a[16:19], a[88:91], v[232:235]
v_cmp_gt_i32 s[100:101], 51, v13
v_subrev_u32 v17, 0, v12
v_mfma_f32_16x16x32_bf16 v[232:235], a[20:23], a[92:95], v[232:235]
v_lshlrev_b32 v18, 31, v17
v_or_b32 v21, v17, v18
v_mfma_f32_16x16x32_bf16 v[240:243], a[28:31], a[92:95], v[240:243]
v_ashrrev_i32 v21, 31, v21
v_and_b32 v248, 0xff800000, v21
v_mfma_f32_16x16x32_bf16 v[240:243], a[24:27], a[88:91], v[240:243]
buffer_load_dwordx4 v16, s[32:35], s64 offen offset:2048 sc1 lds
v_mfma_f32_16x16x32_bf16 v[244:247], a[24:27], a[96:99], v[244:247]
s_waitcnt lgkmcnt(4)
ds_read_b64_tr_b16 a[88:89], v6 offset:32768
v_not_b32 v17, v17
v_mfma_f32_16x16x32_bf16 v[244:247], a[28:31], a[100:103], v[244:247]
ds_read_b64_tr_b16 a[90:91], v6 offset:33792
v_add_u32 v19, 0x8000, v19
v_mfma_f32_16x16x32_bf16 v[236:239], a[20:23], a[100:103], v[236:239]
buffer_store_dwordx4 a[240:243], v16, s[44:47], s72 offen offset:3072 sc1
v_mfma_f32_16x16x32_bf16 v[236:239], a[16:19], a[96:99], v[236:239]
ds_read_b64_tr_b16 a[92:93], v6 offset:40960
v_or_b32 v21, v17, v18
v_mfma_f32_16x16x32_bf16 v[228:231], a[8:11], a[96:99], v[228:231]
ds_read_b64_tr_b16 a[94:95], v6 offset:41984
v_ashrrev_i32 v21, 31, v21
v_mfma_f32_16x16x32_bf16 v[228:231], a[12:15], a[100:103], v[228:231]
v_and_b32 v252, 0xff800000, v21
v_subrev_u32 v17, 1, v12
v_mfma_f32_16x16x32_bf16 v[220:223], a[4:7], a[100:103], v[220:223]
v_lshlrev_b32 v18, 31, v17
v_or_b32 v21, v17, v18
v_mfma_f32_16x16x32_bf16 v[220:223], a[0:3], a[96:99], v[220:223]
buffer_load_dwordx4 v16, s[32:35], s64 offen offset:3072 sc1 lds
v_mfma_f32_16x16x32_bf16 v[152:155], a[104:107], a[0:3], v[152:155]
ds_read_b64_tr_b16 a[96:97], v7 offset:32768
v_ashrrev_i32 v21, 31, v21
v_mfma_f32_16x16x32_bf16 v[152:155], a[108:111], a[4:7], v[152:155]
ds_read_b64_tr_b16 a[98:99], v7 offset:33792
v_add_u32 v20, 0x8000, v20
v_mfma_f32_16x16x32_bf16 v[160:163], a[108:111], a[12:15], v[160:163]
s_lshr_b32 s64, s76, 1
ds_read_b64_tr_b16 a[100:101], v7 offset:40960
v_and_b32 v249, 0xff800000, v21
v_mfma_f32_16x16x32_bf16 v[160:163], a[104:107], a[8:11], v[160:163]
s_add_u32 m0, s64, 81920
ds_read_b64_tr_b16 a[102:103], v7 offset:41984
v_not_b32 v17, v17
v_mfma_f32_16x16x32_bf16 v[168:171], a[104:107], a[16:19], v[168:171]
s_and_b32 s71, s64, 8192
v_or_b32 v21, v17, v18
v_ashrrev_i32 v21, 31, v21
v_mfma_f32_16x16x32_bf16 v[168:171], a[108:111], a[20:23], v[168:171]
s_add_u32 s64, s64, s71
v_and_b32 v253, 0xff800000, v21
v_subrev_u32 v17, 2, v12
v_mfma_f32_16x16x32_bf16 v[176:179], a[108:111], a[28:31], v[176:179]
s_add_u32 s64, s64, 8192
v_lshlrev_b32 v18, 31, v17
v_or_b32 v21, v17, v18
v_mfma_f32_16x16x32_bf16 v[176:179], a[104:107], a[24:27], v[176:179]
buffer_load_dwordx4 v16, s[32:35], s64 offen offset:0 sc1 lds
v_mfma_f32_16x16x32_bf16 v[180:183], a[112:115], a[24:27], v[180:183]
ds_read_b64_tr_b16 a[104:105], v8 offset:32768
v_ashrrev_i32 v21, 31, v21
v_mfma_f32_16x16x32_bf16 v[180:183], a[116:119], a[28:31], v[180:183]
ds_read_b64_tr_b16 a[106:107], v8 offset:33792
v_add_u32 v4, 0x8000, v4
v_mfma_f32_16x16x32_bf16 v[172:175], a[116:119], a[20:23], v[172:175]
ds_read_b64_tr_b16 a[108:109], v8 offset:40960
v_and_b32 v250, 0xff800000, v21
v_mfma_f32_16x16x32_bf16 v[172:175], a[112:115], a[16:19], v[172:175]
ds_read_b64_tr_b16 a[110:111], v8 offset:41984
v_not_b32 v17, v17
v_mfma_f32_16x16x32_bf16 v[164:167], a[112:115], a[8:11], v[164:167]
v_or_b32 v21, v17, v18
v_ashrrev_i32 v21, 31, v21
v_mfma_f32_16x16x32_bf16 v[164:167], a[116:119], a[12:15], v[164:167]
v_and_b32 v254, 0xff800000, v21
v_subrev_u32 v17, 3, v12
v_mfma_f32_16x16x32_bf16 v[156:159], a[116:119], a[4:7], v[156:159]
v_lshlrev_b32 v18, 31, v17
v_or_b32 v21, v17, v18
v_mfma_f32_16x16x32_bf16 v[156:159], a[112:115], a[0:3], v[156:159]
buffer_load_dwordx4 v16, s[32:35], s64 offen offset:1024 sc1 lds
v_mfma_f32_16x16x32_bf16 v[24:27], a[72:75], a[0:3], v[24:27]
ds_read_b64_tr_b16 a[112:113], v9 offset:32768
v_ashrrev_i32 v21, 31, v21
v_mfma_f32_16x16x32_bf16 v[24:27], a[76:79], a[4:7], v[24:27]
ds_read_b64_tr_b16 a[114:115], v9 offset:33792
v_add_u32 v5, 0x8000, v5
v_mfma_f32_16x16x32_bf16 v[40:43], a[76:79], a[12:15], v[40:43]
ds_read_b64_tr_b16 a[116:117], v9 offset:40960
v_and_b32 v251, 0xff800000, v21
v_mfma_f32_16x16x32_bf16 v[40:43], a[72:75], a[8:11], v[40:43]
ds_read_b64_tr_b16 a[118:119], v9 offset:41984
v_not_b32 v17, v17
v_mfma_f32_16x16x32_bf16 v[56:59], a[72:75], a[16:19], v[56:59]
v_or_b32 v21, v17, v18
v_ashrrev_i32 v21, 31, v21
v_mfma_f32_16x16x32_bf16 v[56:59], a[76:79], a[20:23], v[56:59]
v_and_b32 v255, 0xff800000, v21
v_mfma_f32_16x16x32_bf16 v[72:75], a[76:79], a[28:31], v[72:75]
s_waitcnt vmcnt(18)
s_and_b32 s66, s2, 7
ds_read_b128 a[32:35], v2 offset:32768
v_mfma_f32_16x16x32_bf16 v[72:75], a[72:75], a[24:27], v[72:75]
s_waitcnt lgkmcnt(5)
s_lshr_b32 s67, s2, 3
buffer_load_dwordx4 v16, s[32:35], s64 offen offset:2048 sc1 lds
v_mfma_f32_16x16x32_bf16 v[136:139], a[80:83], a[24:27], v[136:139]
s_branch L_po13
L_pg13:
s_branch L_tr1
L_po13:
s_and_b32 s83, s66, 1
s_and_b32 s68, s66, 2
ds_read_b128 a[36:39], v3 offset:32768
v_mfma_f32_16x16x32_bf16 v[136:139], a[84:87], a[28:31], v[136:139]
s_and_b32 s69, s67, 7
ds_read_b128 a[40:43], v2 offset:34816
v_add_u32 v6, 0x8000, v6
v_mfma_f32_16x16x32_bf16 v[120:123], a[84:87], a[20:23], v[120:123]
s_lshl2_add_u32 s82, s68, s69
s_and_b32 s68, s66, 4
ds_read_b128 a[44:47], v3 offset:34816
v_mfma_f32_16x16x32_bf16 v[120:123], a[80:83], a[16:19], v[120:123]
s_lshr_b32 s69, s67, 3
s_xor_b32 s69, s69, 0
ds_read_b128 a[48:51], v2 offset:36864
v_mfma_f32_16x16x32_bf16 v[104:107], a[80:83], a[8:11], v[104:107]
s_add_u32 s87, s68, s69
s_lshl_b32 s87, s87, 8
ds_read_b128 a[52:55], v3 offset:36864
v_mfma_f32_16x16x32_bf16 v[104:107], a[84:87], a[12:15], v[104:107]
s_lshl_b32 s86, s30, 13
s_lshl_b32 s85, s30, 16
ds_read_b128 a[56:59], v2 offset:38912
v_mfma_f32_16x16x32_bf16 v[88:91], a[84:87], a[4:7], v[88:91]
s_add_u32 s85, s85, s87
s_mul_i32 s66, s83, 1310720
ds_read_b128 a[60:63], v3 offset:38912
v_mfma_f32_16x16x32_bf16 v[88:91], a[80:83], a[0:3], v[88:91]
s_add_u32 s85, s85, s66
buffer_load_dwordx4 v16, s[32:35], s64 offen offset:3072 sc1 lds
v_mfma_f32_16x16x32_bf16 v[28:31], a[88:91], a[0:3], v[28:31]
s_mul_i32 s84, s82, 1310720
s_and_b32 s66, s30, 1
ds_read_b64_tr_b16 a[72:73], v10 offset:32768
v_mfma_f32_16x16x32_bf16 v[28:31], a[92:95], a[4:7], v[28:31]
s_lshl_b32 s66, s66, 14
ds_read_b64_tr_b16 a[74:75], v10 offset:33792
v_add_u32 v7, 0x8000, v7
v_mfma_f32_16x16x32_bf16 v[44:47], a[92:95], a[12:15], v[44:47]
s_add_u32 s84, s84, s66
s_mul_i32 s66, s83, 163840
ds_read_b64_tr_b16 a[76:77], v10 offset:40960
v_mfma_f32_16x16x32_bf16 v[44:47], a[88:91], a[8:11], v[44:47]
s_add_u32 s84, s84, s66
s_add_u32 s84, s84, 34603008
ds_read_b64_tr_b16 a[78:79], v10 offset:41984
v_mfma_f32_16x16x32_bf16 v[60:63], a[88:91], a[16:19], v[60:63]
s_sub_u32 s66, 15, s82
s_min_u32 s66, s66, s82
ds_read_b64_tr_b16 a[80:81], v11 offset:32768
v_mfma_f32_16x16x32_bf16 v[60:63], a[92:95], a[20:23], v[60:63]
s_lshl1_add_u32 s66, s66, s83
s_lshl_b32 s80, s66, 8
ds_read_b64_tr_b16 a[82:83], v11 offset:33792
v_mfma_f32_16x16x32_bf16 v[76:79], a[92:95], a[28:31], v[76:79]
s_add_u32 s80, s80, 8192
s_and_b32 s67, s30, 1
ds_read_b64_tr_b16 a[84:85], v11 offset:40960
v_mfma_f32_16x16x32_bf16 v[76:79], a[88:91], a[24:27], v[76:79]
s_lshl_b32 s67, s67, 7
s_add_u32 s67, s67, s83
ds_read_b64_tr_b16 a[86:87], v11 offset:41984
v_mfma_f32_16x16x32_bf16 v[140:143], a[96:99], a[24:27], v[140:143]
s_lshl_b32 s67, s67, 7
s_add_u32 s67, s67, 98304
s_lshl_b32 s66, s30, 11
v_mfma_f32_16x16x32_bf16 v[140:143], a[100:103], a[28:31], v[140:143]
v_add_u32 v8, 0x8000, v8
v_lshrrev_b32 v14, 4, v0
v_mfma_f32_16x16x32_bf16 v[124:127], a[100:103], a[20:23], v[124:127]
v_bfe_u32 v12, v0, 1, 3
v_xor_b32 v12, v12, v14
v_mfma_f32_16x16x32_bf16 v[124:127], a[96:99], a[16:19], v[124:127]
v_lshlrev_b32 v12, 5, v12
v_lshl_add_u32 v12, v14, 11, v12
v_mfma_f32_16x16x32_bf16 v[108:111], a[96:99], a[8:11], v[108:111]
v_and_b32 v14, 1, v0
v_lshl_add_u32 v12, v14, 4, v12
v_mfma_f32_16x16x32_bf16 v[108:111], a[100:103], a[12:15], v[108:111]
v_xor_b32 v13, 128, v12
v_lshrrev_b32 v14, 4, v0
v_mfma_f32_16x16x32_bf16 v[92:95], a[100:103], a[4:7], v[92:95]
v_add_u32 v9, 0x8000, v9
v_add_u32 v10, 0x8000, v10
v_mfma_f32_16x16x32_bf16 v[92:95], a[96:99], a[0:3], v[92:95]
v_add_u32 v11, 0x8000, v11
v_bfe_u32 v18, v0, 2, 2
v_mfma_f32_16x16x32_bf16 v[32:35], a[104:107], a[0:3], v[32:35]
v_lshl_add_u32 v14, v14, 2, v18
v_and_b32 v18, 3, v0
v_mfma_f32_16x16x32_bf16 v[32:35], a[108:111], a[4:7], v[32:35]
v_lshlrev_b32 v18, 3, v18
v_lshl_add_u32 v18, v14, 8, v18
v_mfma_f32_16x16x32_bf16 v[48:51], a[108:111], a[12:15], v[48:51]
s_waitcnt lgkmcnt(0)
s_barrier
v_mfma_f32_16x16x32_bf16 v[48:51], a[104:107], a[8:11], v[48:51]
ds_read_b64_tr_b16 a[88:89], v19 offset:36864
v_and_b32 v14, 7, v14
v_mfma_f32_16x16x32_bf16 v[64:67], a[104:107], a[16:19], v[64:67]
ds_read_b64_tr_b16 a[90:91], v19 offset:37120
v_lshl_add_u32 v18, v14, 5, v18
v_mfma_f32_16x16x32_bf16 v[64:67], a[108:111], a[20:23], v[64:67]
ds_read_b64_tr_b16 a[92:93], v19 offset:38912
v_xor_b32 v18, s67, v18
v_mfma_f32_16x16x32_bf16 v[80:83], a[108:111], a[28:31], v[80:83]
ds_read_b64_tr_b16 a[94:95], v19 offset:39168
v_add_u32 v14, s66, v16
v_mfma_f32_16x16x32_bf16 v[80:83], a[104:107], a[24:27], v[80:83]
ds_read_b64_tr_b16 a[96:97], v20 offset:36864
v_xor_b32 v15, 0x800, v14
v_mfma_f32_16x16x32_bf16 v[144:147], a[112:115], a[24:27], v[144:147]
s_lshr_b32 s66, s30, 1
s_lshl_b32 s66, s66, 16
s_and_b32 s67, s30, 1
v_mfma_f32_16x16x32_bf16 v[144:147], a[116:119], a[28:31], v[144:147]
s_lshl_b32 s67, s67, 10
s_add_u32 s66, s66, s67
s_add_u32 s66, s66, 32768
v_mfma_f32_16x16x32_bf16 v[128:131], a[116:119], a[20:23], v[128:131]
ds_read_b64_tr_b16 a[98:99], v20 offset:37120
v_add_u32 v17, s66, v16
v_mfma_f32_16x16x32_bf16 v[128:131], a[112:115], a[16:19], v[128:131]
ds_read_b64_tr_b16 a[100:101], v20 offset:38912
v_lshlrev_b32 v21, 5, v0
v_mfma_f32_16x16x32_bf16 v[112:115], a[112:115], a[8:11], v[112:115]
s_lshl2_add_u32 s73, s2, s30
s_lshl_b32 s73, s73, 11
s_lshl_b32 s66, s30, 11
v_mfma_f32_16x16x32_bf16 v[112:115], a[116:119], a[12:15], v[112:115]
s_add_u32 s66, s66, 32768
ds_read_b64_tr_b16 a[102:103], v20 offset:39168
v_add_u32 v2, s66, v16
v_mfma_f32_16x16x32_bf16 v[96:99], a[116:119], a[4:7], v[96:99]
ds_read_b64_tr_b16 a[104:105], v19 offset:40960
v_add_u32 v3, 0x10000, v2
v_mfma_f32_16x16x32_bf16 v[96:99], a[112:115], a[0:3], v[96:99]
ds_read_b64_tr_b16 a[106:107], v19 offset:41216
v_mfma_f32_16x16x32_bf16 v[36:39], a[72:75], a[0:3], v[36:39]
ds_read_b64_tr_b16 a[108:109], v19 offset:43008
v_mfma_f32_16x16x32_bf16 v[36:39], a[76:79], a[4:7], v[36:39]
ds_read_b64_tr_b16 a[110:111], v19 offset:43264
v_mfma_f32_16x16x32_bf16 v[52:55], a[76:79], a[12:15], v[52:55]
ds_read_b64_tr_b16 a[112:113], v20 offset:40960
v_mfma_f32_16x16x32_bf16 v[52:55], a[72:75], a[8:11], v[52:55]
ds_read_b64_tr_b16 a[114:115], v20 offset:41216
v_mfma_f32_16x16x32_bf16 v[68:71], a[72:75], a[16:19], v[68:71]
ds_read_b64_tr_b16 a[116:117], v20 offset:43008
v_mfma_f32_16x16x32_bf16 v[68:71], a[76:79], a[20:23], v[68:71]
ds_read_b64_tr_b16 a[118:119], v20 offset:43264
v_mfma_f32_16x16x32_bf16 v[84:87], a[76:79], a[28:31], v[84:87]
v_mfma_f32_16x16x32_bf16 v[84:87], a[72:75], a[24:27], v[84:87]
ds_read_b64_tr_b16 a[72:73], v19 offset:32768
v_mfma_f32_16x16x32_bf16 v[148:151], a[80:83], a[24:27], v[148:151]
ds_read_b64_tr_b16 a[74:75], v19 offset:33024
v_mfma_f32_16x16x32_bf16 v[148:151], a[84:87], a[28:31], v[148:151]
ds_read_b64_tr_b16 a[76:77], v19 offset:34816
v_mfma_f32_16x16x32_bf16 v[132:135], a[84:87], a[20:23], v[132:135]
ds_read_b64_tr_b16 a[78:79], v19 offset:35072
v_mfma_f32_16x16x32_bf16 v[132:135], a[80:83], a[16:19], v[132:135]
v_mfma_f32_16x16x32_bf16 v[116:119], a[80:83], a[8:11], v[116:119]
v_mfma_f32_16x16x32_bf16 v[116:119], a[84:87], a[12:15], v[116:119]
v_mfma_f32_16x16x32_bf16 v[100:103], a[84:87], a[4:7], v[100:103]
v_mfma_f32_16x16x32_bf16 v[100:103], a[80:83], a[0:3], v[100:103]
s_waitcnt lgkmcnt(4)
ds_read_b64_tr_b16 a[80:81], v20 offset:32768
v_mfma_f32_16x16x32_bf16 v[184:187], a[88:91], a[32:35], v[184:187]
buffer_load_dword a252, v21, s[36:39], s73 offen
v_mfma_f32_16x16x32_bf16 v[184:187], a[92:95], a[36:39], v[184:187]
ds_read_b64_tr_b16 a[82:83], v20 offset:33024
v_bfe_u32 v1, v0, 1, 1
v_mfma_f32_16x16x32_bf16 v[192:195], a[92:95], a[44:47], v[192:195]
ds_read_b64_tr_b16 a[84:85], v20 offset:34816
v_subrev_u32 v1, 1, v1
v_mfma_f32_16x16x32_bf16 v[192:195], a[88:91], a[40:43], v[192:195]
ds_read_b64_tr_b16 a[86:87], v20 offset:35072
v_and_b32 v1, 0x3f803f80, v1
v_mfma_f32_16x16x32_bf16 v[200:203], a[88:91], a[48:51], v[200:203]
v_accvgpr_write_b32 a240, v1
v_accvgpr_write_b32 a241, v1
v_mfma_f32_16x16x32_bf16 v[200:203], a[92:95], a[52:55], v[200:203]
v_accvgpr_write_b32 a242, v1
v_accvgpr_write_b32 a243, v1
v_mfma_f32_16x16x32_bf16 v[208:211], a[92:95], a[60:63], v[208:211]
s_or_b32 s66, s3, s30
s_cmp_eq_u32 s66, 0
s_cselect_b32 s66, 0xff800000, 0
v_mfma_f32_16x16x32_bf16 v[208:211], a[88:91], a[56:59], v[208:211]
ds_read_b64_tr_b16 a[88:89], v4 offset:32768
v_mfma_f32_16x16x32_bf16 v[212:215], a[96:99], a[56:59], v[212:215]
ds_read_b64_tr_b16 a[90:91], v4 offset:33792
v_mfma_f32_16x16x32_bf16 v[212:215], a[100:103], a[60:63], v[212:215]
ds_read_b64_tr_b16 a[92:93], v4 offset:40960
v_mfma_f32_16x16x32_bf16 v[204:207], a[100:103], a[52:55], v[204:207]
ds_read_b64_tr_b16 a[94:95], v4 offset:41984
v_mfma_f32_16x16x32_bf16 v[204:207], a[96:99], a[48:51], v[204:207]
s_and_b32 s67, s74, 0x7800
s_cselect_b32 s67, 0, 0x70000000
s_add_u32 s77, s74, s67
v_mfma_f32_16x16x32_bf16 v[196:199], a[96:99], a[40:43], v[196:199]
s_sub_u32 s77, s77, 2048
v_mfma_f32_16x16x32_bf16 v[196:199], a[100:103], a[44:47], v[196:199]
s_mov_b32 s68, 0x3e0293ee
v_mfma_f32_16x16x32_bf16 v[188:191], a[100:103], a[36:39], v[188:191]
s_mov_b32 s69, s68
v_mfma_f32_16x16x32_bf16 v[188:191], a[96:99], a[32:35], v[188:191]
ds_read_b64_tr_b16 a[96:97], v5 offset:32768
v_mfma_f32_16x16x32_bf16 v[216:219], a[32:35], a[104:107], v[216:219]
ds_read_b64_tr_b16 a[98:99], v5 offset:33792
v_mfma_f32_16x16x32_bf16 v[216:219], a[36:39], a[108:111], v[216:219]
ds_read_b64_tr_b16 a[100:101], v5 offset:40960
v_cvt_pk_bf16_f32 v208, v208, v209
v_mfma_f32_16x16x32_bf16 v[224:227], a[44:47], a[108:111], v[224:227]
ds_read_b64_tr_b16 a[102:103], v5 offset:41984
v_cvt_pk_bf16_f32 v209, v210, v211
v_mfma_f32_16x16x32_bf16 v[224:227], a[40:43], a[104:107], v[224:227]
v_cvt_pk_bf16_f32 v210, v212, v213
v_cvt_pk_bf16_f32 v211, v214, v215
v_mfma_f32_16x16x32_bf16 v[232:235], a[48:51], a[104:107], v[232:235]
ds_write_b128 v3, v[208:211] offset:10240
v_mfma_f32_16x16x32_bf16 v[232:235], a[52:55], a[108:111], v[232:235]
v_cvt_pk_bf16_f32 v200, v200, v201
v_cvt_pk_bf16_f32 v201, v202, v203
v_mfma_f32_16x16x32_bf16 v[240:243], a[60:63], a[108:111], v[240:243]
v_cvt_pk_bf16_f32 v202, v204, v205
v_cvt_pk_bf16_f32 v203, v206, v207
v_mfma_f32_16x16x32_bf16 v[240:243], a[56:59], a[104:107], v[240:243]
ds_write_b128 v3, v[200:203] offset:2048
v_mfma_f32_16x16x32_bf16 v[244:247], a[56:59], a[112:115], v[244:247]
ds_read_b64_tr_b16 a[104:105], v6 offset:32768
v_cvt_pk_bf16_f32 v192, v192, v193
v_mfma_f32_16x16x32_bf16 v[244:247], a[60:63], a[116:119], v[244:247]
ds_read_b64_tr_b16 a[106:107], v6 offset:33792
v_cvt_pk_bf16_f32 v193, v194, v195
v_mfma_f32_16x16x32_bf16 v[236:239], a[52:55], a[116:119], v[236:239]
ds_read_b64_tr_b16 a[108:109], v6 offset:40960
v_cvt_pk_bf16_f32 v194, v196, v197
v_mfma_f32_16x16x32_bf16 v[236:239], a[48:51], a[112:115], v[236:239]
ds_read_b64_tr_b16 a[110:111], v6 offset:41984
v_cvt_pk_bf16_f32 v195, v198, v199
v_mfma_f32_16x16x32_bf16 v[228:231], a[40:43], a[112:115], v[228:231]
ds_write_b128 v2, v[192:195] offset:10240
v_mfma_f32_16x16x32_bf16 v[228:231], a[44:47], a[116:119], v[228:231]
v_cvt_pk_bf16_f32 v184, v184, v185
v_cvt_pk_bf16_f32 v185, v186, v187
v_mfma_f32_16x16x32_bf16 v[220:223], a[36:39], a[116:119], v[220:223]
v_cvt_pk_bf16_f32 v186, v188, v189
v_cvt_pk_bf16_f32 v187, v190, v191
v_mfma_f32_16x16x32_bf16 v[220:223], a[32:35], a[112:115], v[220:223]
s_waitcnt lgkmcnt(6)
ds_write_b128 v2, v[184:187] offset:2048
v_mfma_f32_16x16x32_bf16 v[152:155], a[72:75], a[32:35], v[152:155]
ds_read_b64_tr_b16 a[112:113], v7 offset:32768
v_cvt_pk_bf16_f32 v219, v218, v219
v_mfma_f32_16x16x32_bf16 v[152:155], a[76:79], a[36:39], v[152:155]
ds_read_b64_tr_b16 a[114:115], v7 offset:33792
v_cvt_pk_bf16_f32 v218, v216, v217
v_mfma_f32_16x16x32_bf16 v[160:163], a[76:79], a[44:47], v[160:163]
ds_write_b64 v2, v[218:219] offset:3072
v_mfma_f32_16x16x32_bf16 v[160:163], a[72:75], a[40:43], v[160:163]
ds_read_b64_tr_b16 a[116:117], v7 offset:40960
v_cvt_pk_bf16_f32 v227, v226, v227
v_mfma_f32_16x16x32_bf16 v[168:171], a[72:75], a[48:51], v[168:171]
ds_read_b64_tr_b16 a[118:119], v7 offset:41984
v_cvt_pk_bf16_f32 v226, v224, v225
v_mfma_f32_16x16x32_bf16 v[168:171], a[76:79], a[52:55], v[168:171]
ds_write_b64 v2, v[226:227] offset:11264
v_mfma_f32_16x16x32_bf16 v[176:179], a[76:79], a[60:63], v[176:179]
v_cvt_pk_bf16_f32 v235, v234, v235
v_cvt_pk_bf16_f32 v234, v232, v233
v_mfma_f32_16x16x32_bf16 v[176:179], a[72:75], a[56:59], v[176:179]
ds_write_b64 v3, v[234:235] offset:3072
v_mfma_f32_16x16x32_bf16 v[180:183], a[80:83], a[56:59], v[180:183]
ds_read_b64_tr_b16 a[72:73], v8 offset:32768
v_cvt_pk_bf16_f32 v243, v242, v243
v_mfma_f32_16x16x32_bf16 v[180:183], a[84:87], a[60:63], v[180:183]
ds_read_b64_tr_b16 a[74:75], v8 offset:33792
v_cvt_pk_bf16_f32 v242, v240, v241
v_mfma_f32_16x16x32_bf16 v[172:175], a[84:87], a[52:55], v[172:175]
ds_write_b64 v3, v[242:243] offset:11264
v_mfma_f32_16x16x32_bf16 v[172:175], a[80:83], a[48:51], v[172:175]
ds_read_b64_tr_b16 a[76:77], v8 offset:40960
v_cvt_pk_bf16_f32 v247, v246, v247
v_mfma_f32_16x16x32_bf16 v[164:167], a[80:83], a[40:43], v[164:167]
ds_read_b64_tr_b16 a[78:79], v8 offset:41984
v_cvt_pk_bf16_f32 v246, v244, v245
v_mfma_f32_16x16x32_bf16 v[164:167], a[84:87], a[44:47], v[164:167]
ds_write_b64 v3, v[246:247] offset:11272
v_mfma_f32_16x16x32_bf16 v[156:159], a[84:87], a[36:39], v[156:159]
v_cvt_pk_bf16_f32 v239, v238, v239
v_cvt_pk_bf16_f32 v238, v236, v237
v_mfma_f32_16x16x32_bf16 v[156:159], a[80:83], a[32:35], v[156:159]
ds_write_b64 v3, v[238:239] offset:3080
v_mfma_f32_16x16x32_bf16 v[24:27], a[88:91], a[32:35], v[24:27]
ds_read_b64_tr_b16 a[80:81], v9 offset:32768
v_cvt_pk_bf16_f32 v231, v230, v231
v_mfma_f32_16x16x32_bf16 v[24:27], a[92:95], a[36:39], v[24:27]
ds_read_b64_tr_b16 a[82:83], v9 offset:33792
v_cvt_pk_bf16_f32 v230, v228, v229
v_mfma_f32_16x16x32_bf16 v[40:43], a[92:95], a[44:47], v[40:43]
ds_write_b64 v2, v[230:231] offset:11272
v_mfma_f32_16x16x32_bf16 v[40:43], a[88:91], a[40:43], v[40:43]
ds_read_b64_tr_b16 a[84:85], v9 offset:40960
v_cvt_pk_bf16_f32 v223, v222, v223
v_mfma_f32_16x16x32_bf16 v[56:59], a[88:91], a[48:51], v[56:59]
ds_read_b64_tr_b16 a[86:87], v9 offset:41984
v_cvt_pk_bf16_f32 v222, v220, v221
v_mfma_f32_16x16x32_bf16 v[56:59], a[92:95], a[52:55], v[56:59]
ds_write_b64 v2, v[222:223] offset:3080
v_mfma_f32_16x16x32_bf16 v[72:75], a[92:95], a[60:63], v[72:75]
v_cvt_pk_bf16_f32 v176, v176, v177
v_cvt_pk_bf16_f32 v177, v178, v179
v_mfma_f32_16x16x32_bf16 v[72:75], a[88:91], a[56:59], v[72:75]
s_waitcnt lgkmcnt(0)
s_barrier
v_mfma_f32_16x16x32_bf16 v[136:139], a[96:99], a[56:59], v[136:139]
ds_read_b128 a[16:19], v17 offset:16384
v_cvt_pk_bf16_f32 v178, v180, v181
v_mfma_f32_16x16x32_bf16 v[136:139], a[100:103], a[60:63], v[136:139]
ds_read_b64_tr_b16 a[88:89], v10 offset:32768
v_cvt_pk_bf16_f32 v179, v182, v183
v_mfma_f32_16x16x32_bf16 v[120:123], a[100:103], a[52:55], v[120:123]
ds_read_b64_tr_b16 a[90:91], v10 offset:33792
v_cvt_pk_bf16_f32 v168, v168, v169
v_mfma_f32_16x16x32_bf16 v[120:123], a[96:99], a[48:51], v[120:123]
ds_read_b64_tr_b16 a[92:93], v10 offset:40960
v_cvt_pk_bf16_f32 v169, v170, v171
v_mfma_f32_16x16x32_bf16 v[104:107], a[96:99], a[40:43], v[104:107]
ds_read_b64_tr_b16 a[94:95], v10 offset:41984
v_cvt_pk_bf16_f32 v170, v172, v173
v_mfma_f32_16x16x32_bf16 v[104:107], a[100:103], a[44:47], v[104:107]
v_cvt_pk_bf16_f32 v171, v174, v175
v_cvt_pk_bf16_f32 v160, v160, v161
v_mfma_f32_16x16x32_bf16 v[88:91], a[100:103], a[36:39], v[88:91]
s_waitcnt lgkmcnt(4)
buffer_store_dwordx4 a[16:19], v16, s[44:47], s74 offen sc1
v_mfma_f32_16x16x32_bf16 v[88:91], a[96:99], a[32:35], v[88:91]
ds_read_b64_tr_b16 a[96:97], v11 offset:32768
v_cvt_pk_bf16_f32 v161, v162, v163
v_mfma_f32_16x16x32_bf16 v[28:31], a[104:107], a[32:35], v[28:31]
ds_read_b64_tr_b16 a[98:99], v11 offset:33792
v_cvt_pk_bf16_f32 v162, v164, v165
v_mfma_f32_16x16x32_bf16 v[28:31], a[108:111], a[36:39], v[28:31]
ds_read_b64_tr_b16 a[100:101], v11 offset:40960
v_cvt_pk_bf16_f32 v163, v166, v167
v_mfma_f32_16x16x32_bf16 v[44:47], a[108:111], a[44:47], v[44:47]
ds_read_b64_tr_b16 a[102:103], v11 offset:41984
v_cvt_pk_bf16_f32 v152, v152, v153
v_mfma_f32_16x16x32_bf16 v[44:47], a[104:107], a[40:43], v[44:47]
s_sub_u32 s81, s3, 1
ds_read_b128 a[4:7], v2 offset:8192
v_cvt_pk_bf16_f32 v153, v154, v155
v_mfma_f32_16x16x32_bf16 v[60:63], a[104:107], a[48:51], v[60:63]
s_sub_u32 s67, s3, 2
ds_read_b128 a[12:15], v3 offset:8192
v_cvt_pk_bf16_f32 v154, v156, v157
v_mfma_f32_16x16x32_bf16 v[60:63], a[108:111], a[52:55], v[60:63]
s_mul_i32 s81, s81, s67
ds_read_b64 v[224:225], v2 offset:9216
v_cvt_pk_bf16_f32 v155, v158, v159
v_mfma_f32_16x16x32_bf16 v[76:79], a[108:111], a[60:63], v[76:79]
s_lshl4_add_u32 s81, s81, s31
ds_read_b64 v[228:229], v2 offset:9224
v_or_b32 v20, s66, v252
v_mfma_f32_16x16x32_bf16 v[76:79], a[104:107], a[56:59], v[76:79]
s_lshl2_add_u32 s81, s81, s30
ds_read_b64 v[240:241], v3 offset:9216
v_or_b32 v21, s66, v253
v_mfma_f32_16x16x32_bf16 v[140:143], a[112:115], a[56:59], v[140:143]
s_mul_i32 s81, s81, 3328
ds_read_b64 v[244:245], v3 offset:9224
v_or_b32 v22, s66, v254
v_mfma_f32_16x16x32_bf16 v[140:143], a[116:119], a[60:63], v[140:143]
s_mov_b32 s73, 0
v_or_b32 v23, s66, v255
v_mfma_f32_16x16x32_bf16 v[124:127], a[116:119], a[52:55], v[124:127]
s_mov_b32 s72, 0x20000
s_mov_b32 s66, 0x3e8293ee
v_mul_f32 v72, s68, v72
v_mfma_f32_16x16x32_bf16 v[124:127], a[112:115], a[48:51], v[124:127]
s_lshl_b32 s67, s31, 15
v_mul_f32 v73, s68, v73
v_mul_f32 v74, s68, v74
v_mfma_f32_16x16x32_bf16 v[108:111], a[112:115], a[40:43], v[108:111]
s_add_u32 s67, s67, s78
v_mul_f32 v75, s68, v75
v_mul_f32 v136, s68, v136
v_mfma_f32_16x16x32_bf16 v[108:111], a[116:119], a[44:47], v[108:111]
s_add_u32 s67, s67, 33554432
v_mul_f32 v137, s68, v137
v_mul_f32 v138, s68, v138
v_mfma_f32_16x16x32_bf16 v[92:95], a[116:119], a[36:39], v[92:95]
s_mul_i32 s74, s3, 1310720
v_mul_f32 v139, s68, v139
v_cvt_pk_bf16_f32 v72, v72, v73
v_mfma_f32_16x16x32_bf16 v[92:95], a[112:115], a[32:35], v[92:95]
s_add_u32 s74, s74, s67
v_cvt_pk_bf16_f32 v73, v74, v75
v_cvt_pk_bf16_f32 v74, v136, v137
v_mfma_f32_16x16x32_bf16 v[32:35], a[72:75], a[32:35], v[32:35]
s_mul_i32 s75, s16, 1310720
v_cvt_pk_bf16_f32 v75, v138, v139
v_mul_f32 v56, s68, v56
v_mfma_f32_16x16x32_bf16 v[32:35], a[76:79], a[36:39], v[32:35]
s_add_u32 s75, s75, s67
v_mul_f32 v57, s68, v57
v_mul_f32 v58, s68, v58
v_mfma_f32_16x16x32_bf16 v[48:51], a[76:79], a[44:47], v[48:51]
s_mul_i32 s67, s31, 24576
v_mul_f32 v59, s68, v59
v_mul_f32 v120, s68, v120
v_mfma_f32_16x16x32_bf16 v[48:51], a[72:75], a[40:43], v[48:51]
s_sub_u32 s67, 1052672, s67
v_mul_f32 v121, s68, v121
v_mul_f32 v122, s68, v122
v_mfma_f32_16x16x32_bf16 v[64:67], a[72:75], a[48:51], v[64:67]
s_add_u32 s64, s74, s67
v_mul_f32 v123, s68, v123
v_cvt_pk_bf16_f32 v56, v56, v57
v_mfma_f32_16x16x32_bf16 v[64:67], a[76:79], a[52:55], v[64:67]
s_add_u32 s65, s75, s67
v_cvt_pk_bf16_f32 v57, v58, v59
v_cvt_pk_bf16_f32 v58, v120, v121
v_mfma_f32_16x16x32_bf16 v[80:83], a[76:79], a[60:63], v[80:83]
s_and_b32 s70, s30, 1
v_cvt_pk_bf16_f32 v59, v122, v123
v_mul_f32 v40, s68, v40
v_mfma_f32_16x16x32_bf16 v[80:83], a[72:75], a[56:59], v[80:83]
s_lshr_b32 s67, s30, 1
v_mul_f32 v41, s68, v41
v_mul_f32 v42, s68, v42
v_mfma_f32_16x16x32_bf16 v[144:147], a[80:83], a[56:59], v[144:147]
s_lshl3_add_u32 s71, s67, s70
v_mul_f32 v43, s68, v43
v_mul_f32 v104, s68, v104
v_mfma_f32_16x16x32_bf16 v[144:147], a[84:87], a[60:63], v[144:147]
s_add_u32 s71, s71, 4
v_mul_f32 v105, s68, v105
v_mul_f32 v106, s68, v106
v_mfma_f32_16x16x32_bf16 v[128:131], a[84:87], a[52:55], v[128:131]
s_lshl_b32 s71, s71, 13
v_mul_f32 v107, s68, v107
v_cvt_pk_bf16_f32 v40, v40, v41
v_mfma_f32_16x16x32_bf16 v[128:131], a[80:83], a[48:51], v[128:131]
s_lshl_b32 s70, s70, 14
v_cvt_pk_bf16_f32 v41, v42, v43
v_cvt_pk_bf16_f32 v42, v104, v105
v_mfma_f32_16x16x32_bf16 v[112:115], a[80:83], a[40:43], v[112:115]
s_mul_i32 s67, s67, 24576
v_cvt_pk_bf16_f32 v43, v106, v107
v_mul_f32 v24, s68, v24
v_mfma_f32_16x16x32_bf16 v[112:115], a[84:87], a[44:47], v[112:115]
s_sub_u32 s70, s70, s67
v_mul_f32 v25, s68, v25
v_mul_f32 v26, s68, v26
v_mfma_f32_16x16x32_bf16 v[96:99], a[84:87], a[36:39], v[96:99]
s_add_u32 s70, s70, 65536
v_mul_f32 v27, s68, v27
v_mul_f32 v88, s68, v88
v_mfma_f32_16x16x32_bf16 v[96:99], a[80:83], a[32:35], v[96:99]
s_waitcnt lgkmcnt(0)
v_mul_f32 v89, s68, v89
v_mul_f32 v90, s68, v90
v_mfma_f32_16x16x32_bf16 v[36:39], a[88:91], a[32:35], v[36:39]
v_mul_f32 v91, s68, v91
v_cvt_pk_bf16_f32 v24, v24, v25
v_mfma_f32_16x16x32_bf16 v[36:39], a[92:95], a[36:39], v[36:39]
v_cvt_pk_bf16_f32 v25, v26, v27
v_cvt_pk_bf16_f32 v26, v88, v89
v_mfma_f32_16x16x32_bf16 v[52:55], a[92:95], a[44:47], v[52:55]
v_cvt_pk_bf16_f32 v27, v90, v91
v_mul_f32 v76, s68, v76
v_mfma_f32_16x16x32_bf16 v[52:55], a[88:91], a[40:43], v[52:55]
v_mul_f32 v77, s68, v77
v_mul_f32 v78, s68, v78
v_mfma_f32_16x16x32_bf16 v[68:71], a[88:91], a[48:51], v[68:71]
v_mul_f32 v79, s68, v79
v_mul_f32 v140, s68, v140
v_mfma_f32_16x16x32_bf16 v[68:71], a[92:95], a[52:55], v[68:71]
v_mul_f32 v141, s68, v141
v_mul_f32 v142, s68, v142
v_mfma_f32_16x16x32_bf16 v[84:87], a[92:95], a[60:63], v[84:87]
v_mul_f32 v143, s68, v143
v_cvt_pk_bf16_f32 v76, v76, v77
v_mfma_f32_16x16x32_bf16 v[84:87], a[88:91], a[56:59], v[84:87]
v_cvt_pk_bf16_f32 v77, v78, v79
v_cvt_pk_bf16_f32 v78, v140, v141
v_mfma_f32_16x16x32_bf16 v[148:151], a[96:99], a[56:59], v[148:151]
v_cvt_pk_bf16_f32 v79, v142, v143
v_mul_f32 v60, s68, v60
v_mfma_f32_16x16x32_bf16 v[148:151], a[100:103], a[60:63], v[148:151]
v_mul_f32 v61, s68, v61
v_mul_f32 v62, s68, v62
v_mfma_f32_16x16x32_bf16 v[132:135], a[100:103], a[52:55], v[132:135]
v_mul_f32 v63, s68, v63
v_mul_f32 v124, s68, v124
v_mfma_f32_16x16x32_bf16 v[132:135], a[96:99], a[48:51], v[132:135]
v_mul_f32 v125, s68, v125
v_mul_f32 v126, s68, v126
v_mfma_f32_16x16x32_bf16 v[116:119], a[96:99], a[40:43], v[116:119]
v_mul_f32 v127, s68, v127
v_cvt_pk_bf16_f32 v60, v60, v61
v_mfma_f32_16x16x32_bf16 v[116:119], a[100:103], a[44:47], v[116:119]
v_cvt_pk_bf16_f32 v61, v62, v63
v_cvt_pk_bf16_f32 v62, v124, v125
v_mfma_f32_16x16x32_bf16 v[100:103], a[100:103], a[36:39], v[100:103]
v_cvt_pk_bf16_f32 v63, v126, v127
v_mfma_f32_16x16x32_bf16 v[100:103], a[96:99], a[32:35], v[100:103]
buffer_load_dwordx4 v[88:91], v16, s[44:47], s77 offen sc1
v_mfma_f32_16x16x32_bf16 v[196:199], v[192:195], v[160:163], v[248:251]
v_mfma_f32_16x16x32_bf16 v[212:215], v[208:211], v[176:179], v[248:251]
v_mfma_f32_16x16x32_bf16 v[164:167], a[4:7], v[160:163], v[252:255]
v_mfma_f32_16x16x32_bf16 v[180:183], a[12:15], v[176:179], v[252:255]
s_waitcnt vmcnt(18)
s_waitcnt vmcnt(20)
s_waitcnt vmcnt(21)
s_waitcnt vmcnt(22)
v_accvgpr_read_b32 v4, a64
v_accvgpr_read_b32 v5, a65
v_accvgpr_read_b32 v6, a66
v_accvgpr_read_b32 v7, a67
v_accvgpr_read_b32 v8, a68
v_accvgpr_read_b32 v9, a69
v_accvgpr_read_b32 v10, a70
v_accvgpr_read_b32 v11, a71
v_max3_f32 v121, v196, v197, v198
v_max3_f32 v121, v121, v199, v164
v_max3_f32 v121, v121, v165, v166
v_max_f32 v121, v121, v167
v_max3_f32 v123, v212, v213, v214
v_max3_f32 v123, v123, v215, v180
v_max3_f32 v123, v123, v181, v182
v_max_f32 v123, v123, v183
v_mov_b32 v105, v121
v_mov_b32 v107, v123
v_pk_mul_f32 v[28:29], v[28:29], s[68:69]
v_permlane16_swap_b32 v105, v121
v_permlane16_swap_b32 v107, v123
v_max_f32 v121, v121, v105
v_max_f32 v123, v123, v107
v_mov_b32 v105, v121
v_mov_b32 v107, v123
v_pk_mul_f32 v[30:31], v[30:31], s[68:69]
v_permlane32_swap_b32 v105, v121
v_permlane32_swap_b32 v107, v123
v_max_f32 v121, v121, v105
v_max_f32 v123, v123, v107
v_mul_f32 v121, s66, v121
v_mul_f32 v123, s66, v123
v_fma_f32 v164, v164, s66, -v121
v_fma_f32 v165, v165, s66, -v121
v_fma_f32 v166, v166, s66, -v121
v_fma_f32 v167, v167, s66, -v121
v_fma_f32 v196, v196, s66, -v121
v_fma_f32 v197, v197, s66, -v121
v_fma_f32 v198, v198, s66, -v121
v_fma_f32 v199, v199, s66, -v121
v_exp_f32 v164, v164
v_exp_f32 v165, v165
v_exp_f32 v166, v166
v_exp_f32 v167, v167
v_exp_f32 v196, v196
v_exp_f32 v197, v197
v_exp_f32 v198, v198
v_exp_f32 v199, v199
v_cvt_pk_bf16_f32 v164, v164, v165
v_cvt_pk_bf16_f32 v165, v166, v167
v_cvt_pk_bf16_f32 v166, v196, v197
v_cvt_pk_bf16_f32 v167, v198, v199
v_pk_mul_f32 v[92:93], v[92:93], s[68:69]
v_pk_mul_f32 v[94:95], v[94:95], s[68:69]
v_mfma_f32_16x16x32_bf16 v[196:199], a[244:247], v[164:167], 0
v_mfma_f32_16x16x32_bf16 v[160:163], v[224:227], v[164:167], 0
v_mfma_f32_16x16x32_bf16 v[192:195], v[228:231], v[164:167], 0
v_fma_f32 v180, v180, s66, -v123
v_fma_f32 v181, v181, s66, -v123
v_fma_f32 v182, v182, s66, -v123
v_fma_f32 v183, v183, s66, -v123
v_fma_f32 v212, v212, s66, -v123
v_fma_f32 v213, v213, s66, -v123
v_fma_f32 v214, v214, s66, -v123
v_fma_f32 v215, v215, s66, -v123
v_exp_f32 v180, v180
v_exp_f32 v181, v181
v_exp_f32 v182, v182
v_exp_f32 v183, v183
v_exp_f32 v212, v212
v_exp_f32 v213, v213
v_exp_f32 v214, v214
v_exp_f32 v215, v215
v_cvt_pk_bf16_f32 v180, v180, v181
v_cvt_pk_bf16_f32 v181, v182, v183
v_cvt_pk_bf16_f32 v182, v212, v213
v_cvt_pk_bf16_f32 v183, v214, v215
v_cvt_pk_bf16_f32 v28, v28, v29
v_cvt_pk_bf16_f32 v29, v30, v31
v_mfma_f32_16x16x32_bf16 v[212:215], a[244:247], v[180:183], 0
s_branch L_po14
L_pg14:
s_branch L_pg18
L_po14:
v_mfma_f32_16x16x32_bf16 v[176:179], v[240:243], v[180:183], 0
v_mfma_f32_16x16x32_bf16 v[208:211], v[244:247], v[180:183], 0
v_cvt_pk_bf16_f32 v30, v92, v93
v_cvt_pk_bf16_f32 v31, v94, v95
v_pk_mul_f32 v[44:45], v[44:45], s[68:69]
v_pk_mul_f32 v[46:47], v[46:47], s[68:69]
v_pk_mul_f32 v[108:109], v[108:109], s[68:69]
v_pk_mul_f32 v[110:111], v[110:111], s[68:69]
v_rcp_f32 v121, v196
v_rcp_f32 v123, v212
v_mul_f32 v121, v121, v7
v_mul_f32 v123, v123, v11
v_mul_f32 v160, v160, v121
v_mul_f32 v161, v161, v121
v_mul_f32 v162, v162, v121
v_mul_f32 v163, v163, v121
v_mul_f32 v192, v192, v121
v_mul_f32 v193, v193, v121
v_mul_f32 v194, v194, v121
v_mul_f32 v195, v195, v121
v_cvt_pk_bf16_f32 v160, v160, v161
v_cvt_pk_bf16_f32 v161, v162, v163
v_cvt_pk_bf16_f32 v162, v192, v193
v_cvt_pk_bf16_f32 v163, v194, v195
buffer_store_dwordx4 v[160:163], v16, s[44:47], s64 offen sc1
v_mul_f32 v176, v176, v123
v_mul_f32 v177, v177, v123
v_mul_f32 v178, v178, v123
v_mul_f32 v179, v179, v123
v_mul_f32 v208, v208, v123
v_mul_f32 v209, v209, v123
v_mul_f32 v210, v210, v123
v_mul_f32 v211, v211, v123
v_cvt_pk_bf16_f32 v176, v176, v177
v_cvt_pk_bf16_f32 v177, v178, v179
v_cvt_pk_bf16_f32 v178, v208, v209
v_cvt_pk_bf16_f32 v179, v210, v211
buffer_store_dwordx4 v[176:179], v16, s[44:47], s65 offen sc1
v_cvt_pk_bf16_f32 v44, v44, v45
v_cvt_pk_bf16_f32 v45, v46, v47
v_cvt_pk_bf16_f32 v46, v108, v109
v_cvt_pk_bf16_f32 v47, v110, v111
v_pk_mul_f32 v[32:33], v[32:33], s[68:69]
v_pk_mul_f32 v[34:35], v[34:35], s[68:69]
v_pk_mul_f32 v[96:97], v[96:97], s[68:69]
v_pk_mul_f32 v[98:99], v[98:99], s[68:69]
v_cvt_pk_bf16_f32 v32, v32, v33
v_cvt_pk_bf16_f32 v33, v34, v35
v_cvt_pk_bf16_f32 v34, v96, v97
v_cvt_pk_bf16_f32 v35, v98, v99
v_pk_mul_f32 v[48:49], v[48:49], s[68:69]
v_pk_mul_f32 v[50:51], v[50:51], s[68:69]
v_pk_mul_f32 v[112:113], v[112:113], s[68:69]
v_pk_mul_f32 v[114:115], v[114:115], s[68:69]
v_cvt_pk_bf16_f32 v48, v48, v49
v_cvt_pk_bf16_f32 v49, v50, v51
v_cvt_pk_bf16_f32 v50, v112, v113
v_cvt_pk_bf16_f32 v51, v114, v115
v_pk_mul_f32 v[64:65], v[64:65], s[68:69]
v_pk_mul_f32 v[66:67], v[66:67], s[68:69]
v_pk_mul_f32 v[128:129], v[128:129], s[68:69]
v_pk_mul_f32 v[130:131], v[130:131], s[68:69]
s_waitcnt vmcnt(2)
L_hchk:
v_max3_u32 v1, v88, v89, v90
v_max_u32 v1, v1, v91
v_cmp_eq_u32 vcc, -1, v1
s_cbranch_vccnz L_hretry
L_hgo:
ds_write_b128 v17, v[88:91]
s_sub_u32 s64, s64, 4096
s_sub_u32 s65, s65, 4096
v_cvt_pk_bf16_f32 v64, v64, v65
v_cvt_pk_bf16_f32 v65, v66, v67
v_cvt_pk_bf16_f32 v66, v128, v129
v_cvt_pk_bf16_f32 v67, v130, v131
v_pk_mul_f32 v[80:81], v[80:81], s[68:69]
v_pk_mul_f32 v[82:83], v[82:83], s[68:69]
v_pk_mul_f32 v[144:145], v[144:145], s[68:69]
v_pk_mul_f32 v[146:147], v[146:147], s[68:69]
s_waitcnt lgkmcnt(0)
s_barrier
ds_read_b128 a[0:3], v2 offset:0
ds_read_b128 a[8:11], v3 offset:0
ds_read_b64 v[216:217], v2 offset:1024
ds_read_b64 v[220:221], v2 offset:1032
ds_read_b64 v[232:233], v3 offset:1024
ds_read_b64 v[236:237], v3 offset:1032
v_cvt_pk_bf16_f32 v80, v80, v81
v_cvt_pk_bf16_f32 v81, v82, v83
v_cvt_pk_bf16_f32 v82, v144, v145
v_cvt_pk_bf16_f32 v83, v146, v147
v_pk_mul_f32 v[36:37], v[36:37], s[68:69]
v_pk_mul_f32 v[38:39], v[38:39], s[68:69]
v_pk_mul_f32 v[100:101], v[100:101], s[68:69]
v_pk_mul_f32 v[102:103], v[102:103], s[68:69]
v_cvt_pk_bf16_f32 v36, v36, v37
v_cvt_pk_bf16_f32 v37, v38, v39
v_cvt_pk_bf16_f32 v38, v100, v101
v_cvt_pk_bf16_f32 v39, v102, v103
v_pk_mul_f32 v[52:53], v[52:53], s[68:69]
v_pk_mul_f32 v[54:55], v[54:55], s[68:69]
v_pk_mul_f32 v[116:117], v[116:117], s[68:69]
v_pk_mul_f32 v[118:119], v[118:119], s[68:69]
v_mfma_f32_16x16x32_bf16 v[188:191], v[184:187], v[152:155], v[248:251]
v_mfma_f32_16x16x32_bf16 v[204:207], v[200:203], v[168:171], v[248:251]
s_waitcnt lgkmcnt(5)
v_mfma_f32_16x16x32_bf16 v[156:159], a[0:3], v[152:155], v[20:23]
s_waitcnt lgkmcnt(4)
v_mfma_f32_16x16x32_bf16 v[172:175], a[8:11], v[168:171], v[252:255]
v_cvt_pk_bf16_f32 v52, v52, v53
v_cvt_pk_bf16_f32 v53, v54, v55
v_cvt_pk_bf16_f32 v54, v116, v117
v_cvt_pk_bf16_f32 v55, v118, v119
v_pk_mul_f32 v[68:69], v[68:69], s[68:69]
v_pk_mul_f32 v[70:71], v[70:71], s[68:69]
v_pk_mul_f32 v[132:133], v[132:133], s[68:69]
v_pk_mul_f32 v[134:135], v[134:135], s[68:69]
v_max3_f32 v120, v188, v189, v190
v_max3_f32 v120, v120, v191, v156
v_max3_f32 v120, v120, v157, v158
v_max_f32 v120, v120, v159
v_max3_f32 v122, v204, v205, v206
v_max3_f32 v122, v122, v207, v172
v_max3_f32 v122, v122, v173, v174
v_max_f32 v122, v122, v175
v_mov_b32 v104, v120
v_mov_b32 v106, v122
v_cvt_pk_bf16_f32 v68, v68, v69
v_permlane16_swap_b32 v104, v120
v_permlane16_swap_b32 v106, v122
v_max_f32 v120, v120, v104
v_max_f32 v122, v122, v106
v_mov_b32 v104, v120
v_mov_b32 v106, v122
v_cvt_pk_bf16_f32 v69, v70, v71
v_permlane32_swap_b32 v104, v120
v_permlane32_swap_b32 v106, v122
v_max_f32 v120, v120, v104
v_max_f32 v122, v122, v106
v_mul_f32 v120, s66, v120
v_mul_f32 v122, s66, v122
v_fma_f32 v156, v156, s66, -v120
v_fma_f32 v157, v157, s66, -v120
v_fma_f32 v158, v158, s66, -v120
v_fma_f32 v159, v159, s66, -v120
v_fma_f32 v188, v188, s66, -v120
v_fma_f32 v189, v189, s66, -v120
v_fma_f32 v190, v190, s66, -v120
v_fma_f32 v191, v191, s66, -v120
v_exp_f32 v156, v156
v_exp_f32 v157, v157
v_exp_f32 v158, v158
v_exp_f32 v159, v159
v_exp_f32 v188, v188
v_exp_f32 v189, v189
v_exp_f32 v190, v190
v_exp_f32 v191, v191
v_cvt_pk_bf16_f32 v156, v156, v157
v_cvt_pk_bf16_f32 v157, v158, v159
v_cvt_pk_bf16_f32 v158, v188, v189
v_cvt_pk_bf16_f32 v159, v190, v191
v_cvt_pk_bf16_f32 v70, v132, v133
v_cvt_pk_bf16_f32 v71, v134, v135
v_mfma_f32_16x16x32_bf16 v[188:191], a[244:247], v[156:159], 0
s_waitcnt lgkmcnt(3)
v_mfma_f32_16x16x32_bf16 v[152:155], v[216:219], v[156:159], 0
s_waitcnt lgkmcnt(2)
v_mfma_f32_16x16x32_bf16 v[184:187], v[220:223], v[156:159], 0
v_fma_f32 v172, v172, s66, -v122
v_fma_f32 v173, v173, s66, -v122
v_fma_f32 v174, v174, s66, -v122
v_fma_f32 v175, v175, s66, -v122
v_fma_f32 v204, v204, s66, -v122
v_fma_f32 v205, v205, s66, -v122
v_fma_f32 v206, v206, s66, -v122
v_fma_f32 v207, v207, s66, -v122
v_exp_f32 v172, v172
v_exp_f32 v173, v173
v_exp_f32 v174, v174
v_exp_f32 v175, v175
v_exp_f32 v204, v204
v_exp_f32 v205, v205
v_exp_f32 v206, v206
v_exp_f32 v207, v207
v_cvt_pk_bf16_f32 v172, v172, v173
v_cvt_pk_bf16_f32 v173, v174, v175
v_cvt_pk_bf16_f32 v174, v204, v205
v_cvt_pk_bf16_f32 v175, v206, v207
v_pk_mul_f32 v[84:85], v[84:85], s[68:69]
v_pk_mul_f32 v[86:87], v[86:87], s[68:69]
v_mfma_f32_16x16x32_bf16 v[204:207], a[244:247], v[172:175], 0
s_waitcnt lgkmcnt(1)
v_mfma_f32_16x16x32_bf16 v[168:171], v[232:235], v[172:175], 0
s_waitcnt lgkmcnt(0)
v_mfma_f32_16x16x32_bf16 v[200:203], v[236:239], v[172:175], 0
v_pk_mul_f32 v[148:149], v[148:149], s[68:69]
v_pk_mul_f32 v[150:151], v[150:151], s[68:69]
v_cvt_pk_bf16_f32 v84, v84, v85
v_cvt_pk_bf16_f32 v85, v86, v87
v_cvt_pk_bf16_f32 v86, v148, v149
v_cvt_pk_bf16_f32 v87, v150, v151
v_rcp_f32 v120, v188
v_rcp_f32 v122, v204
v_mul_f32 v120, v120, v5
v_mul_f32 v122, v122, v9
v_mul_f32 v152, v152, v120
v_mul_f32 v153, v153, v120
v_mul_f32 v154, v154, v120
v_mul_f32 v155, v155, v120
v_mul_f32 v184, v184, v120
v_mul_f32 v185, v185, v120
v_mul_f32 v186, v186, v120
v_mul_f32 v187, v187, v120
v_cvt_pk_bf16_f32 v152, v152, v153
v_cvt_pk_bf16_f32 v153, v154, v155
v_cvt_pk_bf16_f32 v154, v184, v185
v_cvt_pk_bf16_f32 v155, v186, v187
buffer_store_dwordx4 v[152:155], v16, s[44:47], s64 offen sc1
v_mul_f32 v168, v168, v122
v_mul_f32 v169, v169, v122
v_mul_f32 v170, v170, v122
v_mul_f32 v171, v171, v122
v_mul_f32 v200, v200, v122
v_mul_f32 v201, v201, v122
v_mul_f32 v202, v202, v122
v_mul_f32 v203, v203, v122
v_cvt_pk_bf16_f32 v168, v168, v169
v_cvt_pk_bf16_f32 v169, v170, v171
v_cvt_pk_bf16_f32 v170, v200, v201
v_cvt_pk_bf16_f32 v171, v202, v203
buffer_store_dwordx4 v[168:171], v16, s[44:47], s65 offen sc1
v_mov_b32 v17, 0xff800000
v_and_b32 v5, 1, v0
v_mul_u32_u24 v5, 0xaaaa, v5
v_add_u32 v5, 0x4444, v5
v_lshl_or_b32 v5, v5, 16, v5
L_attstart_7:
v_mov_b32 v2, v16
v_add_u32 v3, 0x10000, v16
v_mov_b32 v1, 0
s_waitcnt lgkmcnt(0)
s_barrier
s_cmp_eq_u32 s3, 0
s_cbranch_scc1 L_F1
ds_read_b128 a[144:147], v2 offset:0
ds_read_b128 a[148:151], v2 offset:1024
ds_read_b128 a[152:155], v2 offset:2048
ds_read_b128 a[156:159], v2 offset:3072
ds_read_b128 a[160:163], v2 offset:4096
ds_read_b128 a[164:167], v2 offset:5120
ds_read_b128 a[168:171], v2 offset:6144
ds_read_b128 a[172:175], v2 offset:7168
s_mov_b32 m0, s71
s_nop 0
buffer_load_dwordx4 v16, s[32:35], s70 offen offset:0 sc1 lds
buffer_load_dwordx4 v16, s[32:35], s70 offen offset:1024 sc1 lds
s_waitcnt lgkmcnt(7)
v_mfma_f32_16x16x32_bf16 v[88:91], a[144:147], v[24:27], 0
s_waitcnt lgkmcnt(6)
ds_read_b128 a[176:179], v2 offset:8192
v_accvgpr_write_b32 a128, 0
v_mfma_f32_16x16x32_bf16 v[88:91], a[148:151], v[28:31], v[88:91]
s_waitcnt lgkmcnt(6)
ds_read_b128 a[180:183], v2 offset:9216
v_accvgpr_write_b32 a129, 0
v_mfma_f32_16x16x32_bf16 v[88:91], a[152:155], v[32:35], v[88:91]
s_waitcnt lgkmcnt(6)
buffer_load_dwordx4 v16, s[32:35], s70 offen offset:2048 sc1 lds
v_mfma_f32_16x16x32_bf16 v[88:91], a[156:159], v[36:39], v[88:91]
ds_read_b128 a[184:187], v2 offset:10240
v_accvgpr_write_b32 a130, 0
v_mfma_f32_16x16x32_bf16 v[104:107], a[156:159], v[52:55], 0
ds_read_b128 a[188:191], v2 offset:11264
v_accvgpr_write_b32 a131, 0
v_mfma_f32_16x16x32_bf16 v[104:107], a[152:155], v[48:51], v[104:107]
ds_read_b128 a[192:195], v2 offset:12288
v_accvgpr_write_b32 a132, 0
v_mfma_f32_16x16x32_bf16 v[104:107], a[148:151], v[44:47], v[104:107]
ds_read_b128 a[196:199], v2 offset:13312
v_accvgpr_write_b32 a133, 0
v_mfma_f32_16x16x32_bf16 v[104:107], a[144:147], v[40:43], v[104:107]
ds_read_b128 a[200:203], v2 offset:14336
v_accvgpr_write_b32 a134, 0
v_mfma_f32_16x16x32_bf16 v[120:123], a[144:147], v[56:59], 0
ds_read_b128 a[204:207], v2 offset:15360
v_accvgpr_write_b32 a135, 0
v_mfma_f32_16x16x32_bf16 v[120:123], a[148:151], v[60:63], v[120:123]
buffer_load_dwordx4 v16, s[32:35], s70 offen offset:3072 sc1 lds
v_mfma_f32_16x16x32_bf16 v[120:123], a[152:155], v[64:67], v[120:123]
v_accvgpr_write_b32 a136, 0
v_accvgpr_write_b32 a137, 0
v_mfma_f32_16x16x32_bf16 v[120:123], a[156:159], v[68:71], v[120:123]
v_accvgpr_write_b32 a138, 0
v_accvgpr_write_b32 a139, 0
v_mfma_f32_16x16x32_bf16 v[136:139], a[156:159], v[84:87], 0
v_accvgpr_write_b32 a140, 0
v_accvgpr_write_b32 a141, 0
v_mfma_f32_16x16x32_bf16 v[136:139], a[152:155], v[80:83], v[136:139]
v_accvgpr_write_b32 a142, 0
v_accvgpr_write_b32 a143, 0
v_mfma_f32_16x16x32_bf16 v[136:139], a[148:151], v[76:79], v[136:139]
v_mfma_f32_16x16x32_bf16 v[136:139], a[144:147], v[72:75], v[136:139]
s_waitcnt lgkmcnt(0)
s_nop 1
v_max3_f32 v20, v88, v89, v90
v_max_f32 v20, v20, v91
v_max3_f32 v21, v104, v105, v106
v_max_f32 v21, v21, v107
v_max3_f32 v22, v120, v121, v122
v_max_f32 v22, v22, v123
v_max3_f32 v23, v136, v137, v138
v_max_f32 v23, v23, v139
v_mov_b32 v248, v20
v_mov_b32 v249, v21
v_mov_b32 v250, v22
v_mov_b32 v251, v23
v_permlane16_swap_b32 v248, v20
v_permlane16_swap_b32 v249, v21
v_permlane16_swap_b32 v250, v22
v_permlane16_swap_b32 v251, v23
v_max_f32 v20, v20, v248
v_max_f32 v21, v21, v249
v_max_f32 v22, v22, v250
v_max_f32 v23, v23, v251
v_mov_b32 v248, v20
v_mov_b32 v249, v21
v_mov_b32 v250, v22
v_mov_b32 v251, v23
v_permlane32_swap_b32 v248, v20
v_permlane32_swap_b32 v249, v21
v_permlane32_swap_b32 v250, v22
v_permlane32_swap_b32 v251, v23
v_max_f32 v20, v20, v248
v_max_f32 v21, v21, v249
v_max_f32 v22, v22, v250
v_max_f32 v23, v23, v251
s_cmp_eq_u32 s73, 0
s_cselect_b64 vcc, 0, -1
v_cndmask_b32 v20, v20, v252, vcc
v_cndmask_b32 v21, v21, v253, vcc
v_cndmask_b32 v22, v22, v254, vcc
v_cndmask_b32 v23, v23, v255, vcc
v_sub_f32 v228, 0, v23
v_sub_f32 v229, 0, v23
v_sub_f32 v230, 0, v23
v_sub_f32 v231, 0, v23
v_sub_f32 v224, 0, v22
v_sub_f32 v225, 0, v22
v_sub_f32 v226, 0, v22
v_sub_f32 v227, 0, v22
v_sub_f32 v220, 0, v21
v_sub_f32 v221, 0, v21
v_sub_f32 v222, 0, v21
v_sub_f32 v223, 0, v21
v_sub_f32 v216, 0, v20
v_sub_f32 v217, 0, v20
v_sub_f32 v218, 0, v20
v_sub_f32 v219, 0, v20
v_mfma_f32_16x16x32_bf16 v[140:143], a[160:163], v[72:75], v[228:231]
s_add_u32 m0, s71, 4096
v_add_f32 v88, v88, v216
v_add_f32 v89, v89, v216
v_mfma_f32_16x16x32_bf16 v[140:143], a[164:167], v[76:79], v[140:143]
v_add_f32 v90, v90, v216
v_add_f32 v91, v91, v216
v_exp_f32 v88, v88
v_mfma_f32_16x16x32_bf16 v[140:143], a[168:171], v[80:83], v[140:143]
s_add_u32 s64, s70, 4096
v_exp_f32 v89, v89
v_mfma_f32_16x16x32_bf16 v[140:143], a[172:175], v[84:87], v[140:143]
buffer_load_dwordx4 v16, s[32:35], s64 offen offset:0 sc1 lds
v_mfma_f32_16x16x32_bf16 v[124:127], a[172:175], v[68:71], v[224:227]
v_exp_f32 v90, v90
v_mfma_f32_16x16x32_bf16 v[124:127], a[168:171], v[64:67], v[124:127]
v_exp_f32 v91, v91
v_mfma_f32_16x16x32_bf16 v[124:127], a[164:167], v[60:63], v[124:127]
v_add_f32 v104, v104, v220
v_add_f32 v105, v105, v220
v_add_f32 v106, v106, v220
v_add_f32 v107, v107, v220
v_exp_f32 v104, v104
v_mfma_f32_16x16x32_bf16 v[124:127], a[160:163], v[56:59], v[124:127]
v_exp_f32 v105, v105
v_mfma_f32_16x16x32_bf16 v[108:111], a[160:163], v[40:43], v[220:223]
v_exp_f32 v106, v106
v_mfma_f32_16x16x32_bf16 v[108:111], a[164:167], v[44:47], v[108:111]
buffer_load_dwordx4 v16, s[32:35], s64 offen offset:1024 sc1 lds
v_mfma_f32_16x16x32_bf16 v[108:111], a[168:171], v[48:51], v[108:111]
v_cvt_pk_bf16_f32 v152, v88, v89
v_add_f32 v120, v120, v224
v_mfma_f32_16x16x32_bf16 v[108:111], a[172:175], v[52:55], v[108:111]
v_exp_f32 v107, v107
v_mfma_f32_16x16x32_bf16 v[92:95], a[172:175], v[36:39], v[216:219]
v_add_f32 v121, v121, v224
v_add_f32 v122, v122, v224
v_add_f32 v123, v123, v224
v_exp_f32 v120, v120
v_mfma_f32_16x16x32_bf16 v[92:95], a[168:171], v[32:35], v[92:95]
v_cvt_pk_bf16_f32 v153, v90, v91
v_exp_f32 v121, v121
v_mfma_f32_16x16x32_bf16 v[92:95], a[164:167], v[28:31], v[92:95]
v_exp_f32 v122, v122
v_mfma_f32_16x16x32_bf16 v[92:95], a[160:163], v[24:27], v[92:95]
v_exp_f32 v123, v123
v_mfma_f32_16x16x32_bf16 v[96:99], a[176:179], v[24:27], v[216:219]
v_cvt_pk_bf16_f32 v160, v104, v105
v_add_f32 v136, v136, v228
v_mfma_f32_16x16x32_bf16 v[96:99], a[180:183], v[28:31], v[96:99]
buffer_load_dwordx4 v16, s[32:35], s64 offen offset:2048 sc1 lds
v_add_f32 v137, v137, v228
v_add_f32 v138, v138, v228
v_add_f32 v139, v139, v228
v_exp_f32 v136, v136
v_mfma_f32_16x16x32_bf16 v[96:99], a[184:187], v[32:35], v[96:99]
v_exp_f32 v137, v137
v_mfma_f32_16x16x32_bf16 v[96:99], a[188:191], v[36:39], v[96:99]
v_cvt_pk_bf16_f32 v161, v106, v107
v_cvt_pk_bf16_f32 v184, v120, v121
v_mfma_f32_16x16x32_bf16 v[112:115], a[188:191], v[52:55], v[220:223]
v_exp_f32 v138, v138
v_mfma_f32_16x16x32_bf16 v[112:115], a[184:187], v[48:51], v[112:115]
v_exp_f32 v139, v139
v_mfma_f32_16x16x32_bf16 v[112:115], a[180:183], v[44:47], v[112:115]
v_exp_f32 v140, v140
v_mfma_f32_16x16x32_bf16 v[112:115], a[176:179], v[40:43], v[112:115]
v_exp_f32 v141, v141
v_mfma_f32_16x16x32_bf16 v[128:131], a[176:179], v[56:59], v[224:227]
buffer_load_dwordx4 v16, s[32:35], s64 offen offset:3072 sc1 lds
v_cvt_pk_bf16_f32 v185, v122, v123
v_mfma_f32_16x16x32_bf16 v[128:131], a[180:183], v[60:63], v[128:131]
v_exp_f32 v142, v142
v_mfma_f32_16x16x32_bf16 v[128:131], a[184:187], v[64:67], v[128:131]
v_exp_f32 v143, v143
v_mfma_f32_16x16x32_bf16 v[128:131], a[188:191], v[68:71], v[128:131]
v_cvt_pk_bf16_f32 v192, v136, v137
v_cvt_pk_bf16_f32 v193, v138, v139
v_mfma_f32_16x16x32_bf16 v[144:147], a[188:191], v[84:87], v[228:231]
v_exp_f32 v124, v124
v_mfma_f32_16x16x32_bf16 v[144:147], a[184:187], v[80:83], v[144:147]
v_exp_f32 v125, v125
v_mfma_f32_16x16x32_bf16 v[144:147], a[180:183], v[76:79], v[144:147]
s_waitcnt vmcnt(8)
s_barrier
v_mfma_f32_16x16x32_bf16 v[144:147], a[176:179], v[72:75], v[144:147]
v_exp_f32 v126, v126
v_mfma_f32_16x16x32_bf16 v[148:151], a[192:195], v[72:75], v[228:231]
v_cvt_pk_bf16_f32 v194, v140, v141
v_cvt_pk_bf16_f32 v195, v142, v143
v_mfma_f32_16x16x32_bf16 v[148:151], a[196:199], v[76:79], v[148:151]
v_exp_f32 v127, v127
v_mfma_f32_16x16x32_bf16 v[148:151], a[200:203], v[80:83], v[148:151]
s_xor_b32 s71, s71, 16384
v_exp_f32 v108, v108
v_mfma_f32_16x16x32_bf16 v[148:151], a[204:207], v[84:87], v[148:151]
s_add_u32 s70, s70, 32768
v_exp_f32 v109, v109
v_mfma_f32_16x16x32_bf16 v[132:135], a[204:207], v[68:71], v[224:227]
s_mov_b32 m0, s71
v_exp_f32 v110, v110
v_mfma_f32_16x16x32_bf16 v[132:135], a[200:203], v[64:67], v[132:135]
buffer_load_dwordx4 v16, s[32:35], s70 offen offset:0 sc1 lds
v_mfma_f32_16x16x32_bf16 v[132:135], a[196:199], v[60:63], v[132:135]
v_cvt_pk_bf16_f32 v186, v124, v125
v_exp_f32 v111, v111
v_mfma_f32_16x16x32_bf16 v[132:135], a[192:195], v[56:59], v[132:135]
v_exp_f32 v92, v92
v_mfma_f32_16x16x32_bf16 v[116:119], a[192:195], v[40:43], v[220:223]
v_exp_f32 v93, v93
v_mfma_f32_16x16x32_bf16 v[116:119], a[196:199], v[44:47], v[116:119]
ds_read_b128 a[144:147], v2 offset:16384
v_cvt_pk_bf16_f32 v187, v126, v127
v_mfma_f32_16x16x32_bf16 v[116:119], a[200:203], v[48:51], v[116:119]
v_exp_f32 v94, v94
v_mfma_f32_16x16x32_bf16 v[116:119], a[204:207], v[52:55], v[116:119]
ds_read_b128 a[148:151], v2 offset:17408
v_cvt_pk_bf16_f32 v162, v108, v109
v_mfma_f32_16x16x32_bf16 v[100:103], a[204:207], v[36:39], v[216:219]
ds_read_b128 a[152:155], v2 offset:18432
buffer_load_dwordx4 v16, s[32:35], s70 offen offset:1024 sc1 lds
v_exp_f32 v95, v95
v_mfma_f32_16x16x32_bf16 v[100:103], a[200:203], v[32:35], v[100:103]
ds_read_b128 a[156:159], v2 offset:19456
v_exp_f32 v96, v96
v_mfma_f32_16x16x32_bf16 v[100:103], a[196:199], v[28:31], v[100:103]
v_cvt_pk_bf16_f32 v163, v110, v111
v_exp_f32 v97, v97
v_mfma_f32_16x16x32_bf16 v[100:103], a[192:195], v[24:27], v[100:103]
s_waitcnt lgkmcnt(3)
ds_read_b128 a[160:163], v2 offset:20480
ds_read_b128 a[164:167], v2 offset:21504
ds_read_b128 a[168:171], v2 offset:22528
ds_read_b128 a[172:175], v2 offset:23552
v_mfma_f32_16x16x32_bf16 v[88:91], a[144:147], v[24:27], v[216:219]
s_waitcnt lgkmcnt(6)
v_exp_f32 v98, v98
v_mfma_f32_16x16x32_bf16 v[88:91], a[148:151], v[28:31], v[88:91]
s_waitcnt lgkmcnt(5)
v_cvt_pk_bf16_f32 v154, v92, v93
v_exp_f32 v99, v99
v_mfma_f32_16x16x32_bf16 v[88:91], a[152:155], v[32:35], v[88:91]
s_waitcnt lgkmcnt(4)
v_exp_f32 v112, v112
v_mfma_f32_16x16x32_bf16 v[88:91], a[156:159], v[36:39], v[88:91]
v_exp_f32 v113, v113
v_mfma_f32_16x16x32_bf16 v[104:107], a[156:159], v[52:55], v[220:223]
v_cvt_pk_bf16_f32 v155, v94, v95
v_cvt_pk_bf16_f32 v156, v96, v97
v_mfma_f32_16x16x32_bf16 v[104:107], a[152:155], v[48:51], v[104:107]
buffer_load_dwordx4 v16, s[32:35], s70 offen offset:2048 sc1 lds
v_exp_f32 v114, v114
v_mfma_f32_16x16x32_bf16 v[104:107], a[148:151], v[44:47], v[104:107]
v_exp_f32 v115, v115
v_mfma_f32_16x16x32_bf16 v[104:107], a[144:147], v[40:43], v[104:107]
v_exp_f32 v128, v128
v_mfma_f32_16x16x32_bf16 v[120:123], a[144:147], v[56:59], v[224:227]
v_exp_f32 v129, v129
v_mfma_f32_16x16x32_bf16 v[120:123], a[148:151], v[60:63], v[120:123]
v_cvt_pk_bf16_f32 v157, v98, v99
v_cvt_pk_bf16_f32 v164, v112, v113
v_mfma_f32_16x16x32_bf16 v[120:123], a[152:155], v[64:67], v[120:123]
v_exp_f32 v130, v130
v_mfma_f32_16x16x32_bf16 v[120:123], a[156:159], v[68:71], v[120:123]
v_exp_f32 v131, v131
v_mfma_f32_16x16x32_bf16 v[136:139], a[156:159], v[84:87], v[228:231]
v_exp_f32 v144, v144
v_mfma_f32_16x16x32_bf16 v[136:139], a[152:155], v[80:83], v[136:139]
v_exp_f32 v145, v145
v_mfma_f32_16x16x32_bf16 v[136:139], a[148:151], v[76:79], v[136:139]
v_exp_f32 v146, v146
v_mfma_f32_16x16x32_bf16 v[136:139], a[144:147], v[72:75], v[136:139]
s_waitcnt lgkmcnt(0)
v_cvt_pk_bf16_f32 v165, v114, v115
v_cvt_pk_bf16_f32 v188, v128, v129
v_mfma_f32_16x16x32_bf16 v[140:143], a[160:163], v[72:75], v[228:231]
v_exp_f32 v147, v147
v_mfma_f32_16x16x32_bf16 v[140:143], a[164:167], v[76:79], v[140:143]
v_exp_f32 v148, v148
v_mfma_f32_16x16x32_bf16 v[140:143], a[168:171], v[80:83], v[140:143]
v_exp_f32 v149, v149
v_mfma_f32_16x16x32_bf16 v[140:143], a[172:175], v[84:87], v[140:143]
buffer_load_dwordx4 v16, s[32:35], s70 offen offset:3072 sc1 lds
v_mfma_f32_16x16x32_bf16 v[124:127], a[172:175], v[68:71], v[224:227]
v_cvt_pk_bf16_f32 v189, v130, v131
v_cvt_pk_bf16_f32 v196, v144, v145
v_mfma_f32_16x16x32_bf16 v[124:127], a[168:171], v[64:67], v[124:127]
v_exp_f32 v150, v150
v_mfma_f32_16x16x32_bf16 v[124:127], a[164:167], v[60:63], v[124:127]
v_exp_f32 v151, v151
v_mfma_f32_16x16x32_bf16 v[124:127], a[160:163], v[56:59], v[124:127]
v_exp_f32 v132, v132
v_mfma_f32_16x16x32_bf16 v[108:111], a[160:163], v[40:43], v[220:223]
ds_read_b128 a[176:179], v2 offset:24576
v_cvt_pk_bf16_f32 v197, v146, v147
v_mfma_f32_16x16x32_bf16 v[108:111], a[164:167], v[44:47], v[108:111]
ds_read_b128 a[180:183], v2 offset:25600
v_cvt_pk_bf16_f32 v198, v148, v149
v_mfma_f32_16x16x32_bf16 v[108:111], a[168:171], v[48:51], v[108:111]
ds_read_b128 a[184:187], v2 offset:26624
v_exp_f32 v133, v133
v_mfma_f32_16x16x32_bf16 v[108:111], a[172:175], v[52:55], v[108:111]
ds_read_b128 a[188:191], v2 offset:27648
v_exp_f32 v134, v134
v_mfma_f32_16x16x32_bf16 v[92:95], a[172:175], v[36:39], v[216:219]
v_exp_f32 v135, v135
v_mfma_f32_16x16x32_bf16 v[92:95], a[168:171], v[32:35], v[92:95]
v_exp_f32 v116, v116
v_mfma_f32_16x16x32_bf16 v[92:95], a[164:167], v[28:31], v[92:95]
v_exp_f32 v117, v117
v_mfma_f32_16x16x32_bf16 v[92:95], a[160:163], v[24:27], v[92:95]
s_waitcnt lgkmcnt(2)
v_cvt_pk_bf16_f32 v199, v150, v151
v_cvt_pk_bf16_f32 v190, v132, v133
v_mfma_f32_16x16x32_bf16 v[96:99], a[176:179], v[24:27], v[216:219]
v_exp_f32 v118, v118
v_mfma_f32_16x16x32_bf16 v[96:99], a[180:183], v[28:31], v[96:99]
s_waitcnt lgkmcnt(0)
s_add_u32 m0, s71, 4096
v_exp_f32 v119, v119
v_mfma_f32_16x16x32_bf16 v[96:99], a[184:187], v[32:35], v[96:99]
s_add_u32 s64, s70, 4096
v_exp_f32 v100, v100
v_mfma_f32_16x16x32_bf16 v[96:99], a[188:191], v[36:39], v[96:99]
buffer_load_dwordx4 v16, s[32:35], s64 offen offset:0 sc1 lds
v_mfma_f32_16x16x32_bf16 v[112:115], a[188:191], v[52:55], v[220:223]
v_exp_f32 v101, v101
v_mfma_f32_16x16x32_bf16 v[112:115], a[184:187], v[48:51], v[112:115]
v_cvt_pk_bf16_f32 v191, v134, v135
v_cvt_pk_bf16_f32 v166, v116, v117
v_mfma_f32_16x16x32_bf16 v[112:115], a[180:183], v[44:47], v[112:115]
v_exp_f32 v102, v102
v_mfma_f32_16x16x32_bf16 v[112:115], a[176:179], v[40:43], v[112:115]
v_exp_f32 v103, v103
v_mfma_f32_16x16x32_bf16 v[128:131], a[176:179], v[56:59], v[224:227]
s_lshl_b32 s66, s30, 30
ds_read_b128 a[192:195], v2 offset:28672
v_cvt_pk_bf16_f32 v167, v118, v119
v_mfma_f32_16x16x32_bf16 v[128:131], a[180:183], v[60:63], v[128:131]
ds_read_b128 a[196:199], v2 offset:29696
v_exp_f32 v88, v88
v_mfma_f32_16x16x32_bf16 v[128:131], a[184:187], v[64:67], v[128:131]
ds_read_b128 a[200:203], v2 offset:30720
v_exp_f32 v89, v89
v_mfma_f32_16x16x32_bf16 v[128:131], a[188:191], v[68:71], v[128:131]
ds_read_b128 a[204:207], v2 offset:31744
v_cvt_pk_bf16_f32 v158, v100, v101
v_mfma_f32_16x16x32_bf16 v[144:147], a[188:191], v[84:87], v[228:231]
v_exp_f32 v90, v90
v_mfma_f32_16x16x32_bf16 v[144:147], a[184:187], v[80:83], v[144:147]
v_exp_f32 v91, v91
v_mfma_f32_16x16x32_bf16 v[144:147], a[180:183], v[76:79], v[144:147]
v_exp_f32 v104, v104
v_mfma_f32_16x16x32_bf16 v[144:147], a[176:179], v[72:75], v[144:147]
s_waitcnt lgkmcnt(2)
v_exp_f32 v105, v105
v_mfma_f32_16x16x32_bf16 v[148:151], a[192:195], v[72:75], v[228:231]
v_cvt_pk_bf16_f32 v159, v102, v103
v_cvt_pk_bf16_f32 v168, v88, v89
v_mfma_f32_16x16x32_bf16 v[148:151], a[196:199], v[76:79], v[148:151]
s_waitcnt lgkmcnt(0)
v_exp_f32 v106, v106
v_mfma_f32_16x16x32_bf16 v[148:151], a[200:203], v[80:83], v[148:151]
v_exp_f32 v107, v107
v_mfma_f32_16x16x32_bf16 v[148:151], a[204:207], v[84:87], v[148:151]
buffer_load_dwordx4 v16, s[32:35], s64 offen offset:1024 sc1 lds
v_mfma_f32_16x16x32_bf16 v[132:135], a[204:207], v[68:71], v[224:227]
v_exp_f32 v120, v120
v_mfma_f32_16x16x32_bf16 v[132:135], a[200:203], v[64:67], v[132:135]
v_cvt_pk_bf16_f32 v169, v90, v91
v_cvt_pk_bf16_f32 v176, v104, v105
v_mfma_f32_16x16x32_bf16 v[132:135], a[196:199], v[60:63], v[132:135]
v_exp_f32 v121, v121
v_mfma_f32_16x16x32_bf16 v[132:135], a[192:195], v[56:59], v[132:135]
v_exp_f32 v122, v122
v_mfma_f32_16x16x32_bf16 v[116:119], a[192:195], v[40:43], v[220:223]
v_exp_f32 v123, v123
v_mfma_f32_16x16x32_bf16 v[116:119], a[196:199], v[44:47], v[116:119]
v_exp_f32 v136, v136
v_mfma_f32_16x16x32_bf16 v[116:119], a[200:203], v[48:51], v[116:119]
s_branch L_po15
L_pg15:
s_branch L_pg19
L_po15:
v_exp_f32 v137, v137
v_mfma_f32_16x16x32_bf16 v[116:119], a[204:207], v[52:55], v[116:119]
ds_read_b128 a[144:147], v3 offset:16384
v_cvt_pk_bf16_f32 v177, v106, v107
v_mfma_f32_16x16x32_bf16 v[100:103], a[204:207], v[36:39], v[216:219]
v_exp_f32 v138, v138
v_mfma_f32_16x16x32_bf16 v[100:103], a[200:203], v[32:35], v[100:103]
ds_read_b128 a[148:151], v3 offset:24576
v_cvt_pk_bf16_f32 v200, v120, v121
v_mfma_f32_16x16x32_bf16 v[100:103], a[196:199], v[28:31], v[100:103]
v_exp_f32 v139, v139
v_mfma_f32_16x16x32_bf16 v[100:103], a[192:195], v[24:27], v[100:103]
v_exp_f32 v140, v140
v_smfmac_f32_16x16x64_bf16 a[128:131], a[240:243], v[152:159], v5
v_cvt_pk_bf16_f32 v201, v122, v123
v_smfmac_f32_16x16x64_bf16 a[132:135], a[240:243], v[160:167], v5
v_exp_f32 v141, v141
v_smfmac_f32_16x16x64_bf16 a[136:139], a[240:243], v[184:191], v5
v_exp_f32 v142, v142
v_smfmac_f32_16x16x64_bf16 a[140:143], a[240:243], v[192:199], v5
s_waitcnt lgkmcnt(0)
buffer_load_dwordx4 v16, s[32:35], s64 offen offset:2048 sc1 lds
v_cvt_pk_bf16_f32 v208, v136, v137
v_mfma_f32_16x16x32_bf16 a[0:3], a[144:147], v[152:155], 0
ds_read_b128 a[152:155], v3 offset:17408
v_exp_f32 v143, v143
v_mfma_f32_16x16x32_bf16 a[0:3], a[148:151], v[156:159], a[0:3]
ds_read_b128 a[156:159], v3 offset:25600
v_exp_f32 v124, v124
v_mfma_f32_16x16x32_bf16 a[32:35], a[148:151], v[164:167], 0
v_cvt_pk_bf16_f32 v209, v138, v139
v_exp_f32 v125, v125
v_mfma_f32_16x16x32_bf16 a[32:35], a[144:147], v[160:163], a[32:35]
v_exp_f32 v126, v126
v_mfma_f32_16x16x32_bf16 a[64:67], a[144:147], v[184:187], 0
v_exp_f32 v127, v127
v_mfma_f32_16x16x32_bf16 a[64:67], a[148:151], v[188:191], a[64:67]
v_cvt_pk_bf16_f32 v210, v140, v141
v_cvt_pk_bf16_f32 v211, v142, v143
v_mfma_f32_16x16x32_bf16 a[96:99], a[148:151], v[196:199], 0
v_exp_f32 v108, v108
v_mfma_f32_16x16x32_bf16 a[96:99], a[144:147], v[192:195], a[96:99]
s_waitcnt lgkmcnt(0)
v_exp_f32 v109, v109
v_mfma_f32_16x16x32_bf16 a[100:103], a[152:155], v[192:195], 0
ds_read_b128 a[160:163], v3 offset:18432
v_cvt_pk_bf16_f32 v202, v124, v125
v_mfma_f32_16x16x32_bf16 a[100:103], a[156:159], v[196:199], a[100:103]
ds_read_b128 a[164:167], v3 offset:26624
v_exp_f32 v110, v110
v_mfma_f32_16x16x32_bf16 a[68:71], a[156:159], v[188:191], 0
v_exp_f32 v111, v111
v_mfma_f32_16x16x32_bf16 a[68:71], a[152:155], v[184:187], a[68:71]
v_exp_f32 v92, v92
v_mfma_f32_16x16x32_bf16 a[36:39], a[152:155], v[160:163], 0
v_exp_f32 v93, v93
v_mfma_f32_16x16x32_bf16 a[36:39], a[156:159], v[164:167], a[36:39]
v_cvt_pk_bf16_f32 v203, v126, v127
v_cvt_pk_bf16_f32 v178, v108, v109
v_mfma_f32_16x16x32_bf16 a[4:7], a[156:159], v[156:159], 0
buffer_load_dwordx4 v16, s[32:35], s64 offen offset:3072 sc1 lds
v_mfma_f32_16x16x32_bf16 a[4:7], a[152:155], v[152:155], a[4:7]
s_waitcnt lgkmcnt(0)
v_exp_f32 v94, v94
v_mfma_f32_16x16x32_bf16 a[8:11], a[160:163], v[152:155], 0
ds_read_b128 a[168:171], v3 offset:19456
v_cvt_pk_bf16_f32 v179, v110, v111
v_mfma_f32_16x16x32_bf16 a[8:11], a[164:167], v[156:159], a[8:11]
ds_read_b128 a[172:175], v3 offset:27648
v_exp_f32 v95, v95
v_mfma_f32_16x16x32_bf16 a[40:43], a[164:167], v[164:167], 0
v_exp_f32 v96, v96
v_mfma_f32_16x16x32_bf16 a[40:43], a[160:163], v[160:163], a[40:43]
v_exp_f32 v97, v97
v_mfma_f32_16x16x32_bf16 a[72:75], a[160:163], v[184:187], 0
v_exp_f32 v98, v98
v_mfma_f32_16x16x32_bf16 a[72:75], a[164:167], v[188:191], a[72:75]
v_exp_f32 v99, v99
v_mfma_f32_16x16x32_bf16 a[104:107], a[164:167], v[196:199], 0
ds_read_b128 a[176:179], v3 offset:20480
v_cvt_pk_bf16_f32 v170, v92, v93
v_mfma_f32_16x16x32_bf16 a[104:107], a[160:163], v[192:195], a[104:107]
s_waitcnt lgkmcnt(1)
v_exp_f32 v112, v112
v_mfma_f32_16x16x32_bf16 a[108:111], a[168:171], v[192:195], 0
v_exp_f32 v113, v113
v_mfma_f32_16x16x32_bf16 a[108:111], a[172:175], v[196:199], a[108:111]
ds_read_b128 a[180:183], v3 offset:28672
v_cvt_pk_bf16_f32 v171, v94, v95
v_mfma_f32_16x16x32_bf16 a[76:79], a[172:175], v[188:191], 0
v_exp_f32 v114, v114
v_mfma_f32_16x16x32_bf16 a[76:79], a[168:171], v[184:187], a[76:79]
v_cvt_pk_bf16_f32 v172, v96, v97
v_xor_b32 v2, 0x8000, v2
v_mfma_f32_16x16x32_bf16 a[44:47], a[168:171], v[160:163], 0
ds_read_b128 a[184:187], v3 offset:21504
ds_read_b128 a[188:191], v3 offset:29696
ds_read_b128 a[192:195], v3 offset:22528
ds_read_b128 a[196:199], v3 offset:30720
ds_read_b128 a[200:203], v3 offset:23552
ds_read_b128 a[204:207], v3 offset:31744
v_exp_f32 v115, v115
v_mfma_f32_16x16x32_bf16 a[44:47], a[172:175], v[164:167], a[44:47]
s_waitcnt vmcnt(8)
s_barrier
v_exp_f32 v128, v128
v_mfma_f32_16x16x32_bf16 a[12:15], a[172:175], v[156:159], 0
v_cvt_pk_bf16_f32 v173, v98, v99
v_cvt_pk_bf16_f32 v180, v112, v113
v_mfma_f32_16x16x32_bf16 a[12:15], a[168:171], v[152:155], a[12:15]
s_waitcnt lgkmcnt(6)
v_exp_f32 v129, v129
v_mfma_f32_16x16x32_bf16 a[16:19], a[176:179], v[152:155], 0
v_exp_f32 v130, v130
v_mfma_f32_16x16x32_bf16 a[16:19], a[180:183], v[156:159], a[16:19]
s_xor_b32 s71, s71, 49152
v_exp_f32 v131, v131
v_mfma_f32_16x16x32_bf16 a[48:51], a[180:183], v[164:167], 0
s_add_u32 s70, s70, 32768
v_exp_f32 v144, v144
v_mfma_f32_16x16x32_bf16 a[48:51], a[176:179], v[160:163], a[48:51]
s_mov_b32 m0, s71
v_exp_f32 v145, v145
v_mfma_f32_16x16x32_bf16 a[80:83], a[176:179], v[184:187], 0
buffer_load_dwordx4 v16, s[32:35], s70 offen offset:0 sc1 lds
v_cvt_pk_bf16_f32 v181, v114, v115
v_mfma_f32_16x16x32_bf16 a[80:83], a[180:183], v[188:191], a[80:83]
v_exp_f32 v146, v146
v_mfma_f32_16x16x32_bf16 a[112:115], a[180:183], v[196:199], 0
v_exp_f32 v147, v147
v_mfma_f32_16x16x32_bf16 a[112:115], a[176:179], v[192:195], a[112:115]
s_waitcnt lgkmcnt(0)
v_cvt_pk_bf16_f32 v204, v128, v129
v_cvt_pk_bf16_f32 v205, v130, v131
v_mfma_f32_16x16x32_bf16 a[116:119], a[184:187], v[192:195], 0
v_exp_f32 v148, v148
v_mfma_f32_16x16x32_bf16 a[116:119], a[188:191], v[196:199], a[116:119]
v_exp_f32 v149, v149
v_mfma_f32_16x16x32_bf16 a[84:87], a[188:191], v[188:191], 0
v_exp_f32 v150, v150
v_mfma_f32_16x16x32_bf16 a[84:87], a[184:187], v[184:187], a[84:87]
v_exp_f32 v151, v151
v_mfma_f32_16x16x32_bf16 a[52:55], a[184:187], v[160:163], 0
v_cvt_pk_bf16_f32 v212, v144, v145
v_cvt_pk_bf16_f32 v213, v146, v147
v_mfma_f32_16x16x32_bf16 a[52:55], a[188:191], v[164:167], a[52:55]
v_exp_f32 v132, v132
v_mfma_f32_16x16x32_bf16 a[20:23], a[188:191], v[156:159], 0
v_exp_f32 v133, v133
v_mfma_f32_16x16x32_bf16 a[20:23], a[184:187], v[152:155], a[20:23]
ds_read_b128 a[144:147], v2 offset:0
v_lshl_add_u32 v19, v0, 24, s66
v_mfma_f32_16x16x32_bf16 a[24:27], a[192:195], v[152:155], 0
s_lshr_b32 s67, s31, 4
v_exp_f32 v134, v134
v_mfma_f32_16x16x32_bf16 a[24:27], a[196:199], v[156:159], a[24:27]
s_lshl1_add_u32 s67, s3, s67
v_exp_f32 v135, v135
v_mfma_f32_16x16x32_bf16 a[56:59], a[196:199], v[164:167], 0
s_lshl_b32 s79, s67, 8
v_cvt_pk_bf16_f32 v214, v148, v149
v_cvt_pk_bf16_f32 v215, v150, v151
v_mfma_f32_16x16x32_bf16 a[56:59], a[192:195], v[160:163], a[56:59]
s_add_u32 s79, s79, 8192
buffer_load_dwordx4 v16, s[32:35], s70 offen offset:1024 sc1 lds
v_mfma_f32_16x16x32_bf16 a[88:91], a[192:195], v[184:187], 0
s_add_u32 s69, s31, 12
v_exp_f32 v116, v116
v_mfma_f32_16x16x32_bf16 a[88:91], a[196:199], v[188:191], a[88:91]
s_lshr_b32 s69, s69, 5
v_exp_f32 v117, v117
v_mfma_f32_16x16x32_bf16 a[120:123], a[196:199], v[196:199], 0
s_lshl1_add_u32 s69, s3, s69
v_exp_f32 v118, v118
v_mfma_f32_16x16x32_bf16 a[120:123], a[192:195], v[192:195], a[120:123]
s_lshl_b32 s69, s69, 8
v_cvt_pk_bf16_f32 v206, v132, v133
v_cvt_pk_bf16_f32 v207, v134, v135
v_mfma_f32_16x16x32_bf16 a[124:127], a[200:203], v[192:195], 0
s_add_u32 s69, s69, 8192
v_exp_f32 v119, v119
v_mfma_f32_16x16x32_bf16 a[124:127], a[204:207], v[196:199], a[124:127]
s_lshl_b32 s67, s73, 16
v_exp_f32 v100, v100
v_mfma_f32_16x16x32_bf16 a[92:95], a[204:207], v[188:191], 0
s_xor_b32 s68, s80, 256
v_exp_f32 v101, v101
v_mfma_f32_16x16x32_bf16 a[92:95], a[200:203], v[184:187], a[92:95]
s_add_u32 s68, s68, s67
ds_read_b128 a[148:151], v2 offset:1024
v_cvt_pk_bf16_f32 v182, v116, v117
v_mfma_f32_16x16x32_bf16 a[60:63], a[200:203], v[160:163], 0
ds_read_b128 a[152:155], v2 offset:2048
v_exp_f32 v102, v102
v_mfma_f32_16x16x32_bf16 a[60:63], a[204:207], v[164:167], a[60:63]
s_add_u32 s67, s67, s69
ds_read_b128 a[156:159], v2 offset:3072
v_cvt_pk_bf16_f32 v183, v118, v119
v_mfma_f32_16x16x32_bf16 a[28:31], a[204:207], v[156:159], 0
s_mov_b64 exec, 1
buffer_atomic_add a251, v19, s[52:55], s67 offen offset:0 sc1
buffer_atomic_add a251, v19, s[52:55], s68 offen offset:0 sc1
s_mov_b64 exec, -1
v_exp_f32 v103, v103
v_mfma_f32_16x16x32_bf16 a[28:31], a[200:203], v[152:155], a[28:31]
ds_read_b128 a[160:163], v2 offset:4096
ds_read_b128 a[164:167], v2 offset:5120
ds_read_b128 a[168:171], v2 offset:6144
ds_read_b128 a[172:175], v2 offset:7168
v_mul_u32_u24 v19, 52, v0
v_cvt_pk_bf16_f32 v174, v100, v101
v_cvt_pk_bf16_f32 v175, v102, v103
v_xor_b32 v3, 0x8000, v3
s_sub_u32 s72, s3, 1
s_cmp_eq_u32 s72, 0
s_cbranch_scc1 L_DD
L_D:
s_waitcnt lgkmcnt(7)
v_mfma_f32_16x16x32_bf16 v[88:91], a[144:147], v[24:27], v[216:219]
s_waitcnt lgkmcnt(6)
ds_read_b128 a[176:179], v2 offset:8192
v_mfma_f32_16x16x32_bf16 v[88:91], a[148:151], v[28:31], v[88:91]
s_waitcnt lgkmcnt(6)
ds_read_b128 a[180:183], v2 offset:9216
v_mfma_f32_16x16x32_bf16 v[88:91], a[152:155], v[32:35], v[88:91]
s_waitcnt lgkmcnt(6)
buffer_load_dwordx4 v16, s[32:35], s70 offen offset:2048 sc1 lds
v_mfma_f32_16x16x32_bf16 v[88:91], a[156:159], v[36:39], v[88:91]
ds_read_b128 a[184:187], v2 offset:10240
v_mfma_f32_16x16x32_bf16 v[104:107], a[156:159], v[52:55], v[220:223]
v_mfma_f32_16x16x32_bf16 v[104:107], a[152:155], v[48:51], v[104:107]
buffer_load_dword a252, v19, s[40:43], s81 offen
v_mfma_f32_16x16x32_bf16 v[104:107], a[148:151], v[44:47], v[104:107]
ds_read_b128 a[188:191], v2 offset:11264
v_mfma_f32_16x16x32_bf16 v[104:107], a[144:147], v[40:43], v[104:107]
v_mfma_f32_16x16x32_bf16 v[120:123], a[144:147], v[56:59], v[224:227]
v_mfma_f32_16x16x32_bf16 v[120:123], a[148:151], v[60:63], v[120:123]
v_mfma_f32_16x16x32_bf16 v[120:123], a[152:155], v[64:67], v[120:123]
v_exp_f32 v88, v88
v_mfma_f32_16x16x32_bf16 v[120:123], a[156:159], v[68:71], v[120:123]
v_exp_f32 v89, v89
v_mfma_f32_16x16x32_bf16 v[136:139], a[156:159], v[84:87], v[228:231]
v_exp_f32 v90, v90
v_mfma_f32_16x16x32_bf16 v[136:139], a[152:155], v[80:83], v[136:139]
v_exp_f32 v91, v91
v_mfma_f32_16x16x32_bf16 v[136:139], a[148:151], v[76:79], v[136:139]
v_exp_f32 v104, v104
v_mfma_f32_16x16x32_bf16 v[136:139], a[144:147], v[72:75], v[136:139]
s_waitcnt lgkmcnt(0)
s_add_u32 s81, s81, 425984
v_exp_f32 v105, v105
v_mfma_f32_16x16x32_bf16 v[140:143], a[160:163], v[72:75], v[228:231]
v_exp_f32 v106, v106
v_mfma_f32_16x16x32_bf16 v[140:143], a[164:167], v[76:79], v[140:143]
buffer_load_dwordx4 v16, s[32:35], s70 offen offset:3072 sc1 lds
v_mfma_f32_16x16x32_bf16 v[140:143], a[168:171], v[80:83], v[140:143]
v_exp_f32 v107, v107
v_mfma_f32_16x16x32_bf16 v[140:143], a[172:175], v[84:87], v[140:143]
v_cvt_pk_bf16_f32 v152, v88, v89
v_cvt_pk_bf16_f32 v153, v90, v91
v_mfma_f32_16x16x32_bf16 v[124:127], a[172:175], v[68:71], v[224:227]
v_exp_f32 v120, v120
v_mfma_f32_16x16x32_bf16 v[124:127], a[168:171], v[64:67], v[124:127]
v_exp_f32 v121, v121
v_mfma_f32_16x16x32_bf16 v[124:127], a[164:167], v[60:63], v[124:127]
v_exp_f32 v122, v122
v_mfma_f32_16x16x32_bf16 v[124:127], a[160:163], v[56:59], v[124:127]
v_exp_f32 v123, v123
v_mfma_f32_16x16x32_bf16 v[108:111], a[160:163], v[40:43], v[220:223]
v_exp_f32 v136, v136
v_mfma_f32_16x16x32_bf16 v[108:111], a[164:167], v[44:47], v[108:111]
v_exp_f32 v137, v137
v_mfma_f32_16x16x32_bf16 v[108:111], a[168:171], v[48:51], v[108:111]
v_exp_f32 v138, v138
v_mfma_f32_16x16x32_bf16 v[108:111], a[172:175], v[52:55], v[108:111]
v_cvt_pk_bf16_f32 v160, v104, v105
v_cvt_pk_bf16_f32 v161, v106, v107
v_mfma_f32_16x16x32_bf16 v[92:95], a[172:175], v[36:39], v[216:219]
v_exp_f32 v139, v139
v_mfma_f32_16x16x32_bf16 v[92:95], a[168:171], v[32:35], v[92:95]
ds_read_b128 a[192:195], v2 offset:12288
v_cvt_pk_bf16_f32 v184, v120, v121
v_mfma_f32_16x16x32_bf16 v[92:95], a[164:167], v[28:31], v[92:95]
v_exp_f32 v140, v140
v_mfma_f32_16x16x32_bf16 v[92:95], a[160:163], v[24:27], v[92:95]
s_add_u32 m0, s71, 4096
ds_read_b128 a[196:199], v2 offset:13312
v_cvt_pk_bf16_f32 v185, v122, v123
v_mfma_f32_16x16x32_bf16 v[96:99], a[176:179], v[24:27], v[216:219]
s_add_u32 s64, s70, 4096
ds_read_b128 a[200:203], v2 offset:14336
v_cvt_pk_bf16_f32 v192, v136, v137
v_mfma_f32_16x16x32_bf16 v[96:99], a[180:183], v[28:31], v[96:99]
buffer_load_dwordx4 v16, s[32:35], s64 offen offset:0 sc1 lds
v_mfma_f32_16x16x32_bf16 v[96:99], a[184:187], v[32:35], v[96:99]
v_exp_f32 v141, v141
v_mfma_f32_16x16x32_bf16 v[96:99], a[188:191], v[36:39], v[96:99]
ds_read_b128 a[204:207], v2 offset:15360
v_cvt_pk_bf16_f32 v193, v138, v139
v_mfma_f32_16x16x32_bf16 v[112:115], a[188:191], v[52:55], v[220:223]
v_exp_f32 v142, v142
v_mfma_f32_16x16x32_bf16 v[112:115], a[184:187], v[48:51], v[112:115]
v_exp_f32 v143, v143
v_mfma_f32_16x16x32_bf16 v[112:115], a[180:183], v[44:47], v[112:115]
v_exp_f32 v124, v124
v_mfma_f32_16x16x32_bf16 v[112:115], a[176:179], v[40:43], v[112:115]
v_exp_f32 v125, v125
v_mfma_f32_16x16x32_bf16 v[128:131], a[176:179], v[56:59], v[224:227]
v_exp_f32 v126, v126
v_mfma_f32_16x16x32_bf16 v[128:131], a[180:183], v[60:63], v[128:131]
v_exp_f32 v127, v127
v_mfma_f32_16x16x32_bf16 v[128:131], a[184:187], v[64:67], v[128:131]
v_exp_f32 v108, v108
v_mfma_f32_16x16x32_bf16 v[128:131], a[188:191], v[68:71], v[128:131]
v_exp_f32 v109, v109
v_mfma_f32_16x16x32_bf16 v[144:147], a[188:191], v[84:87], v[228:231]
v_exp_f32 v110, v110
v_mfma_f32_16x16x32_bf16 v[144:147], a[184:187], v[80:83], v[144:147]
ds_read_b128 a[144:147], v3 offset:0
v_cvt_pk_bf16_f32 v194, v140, v141
v_mfma_f32_16x16x32_bf16 v[144:147], a[180:183], v[76:79], v[144:147]
ds_read_b128 a[148:151], v3 offset:8192
v_cvt_pk_bf16_f32 v195, v142, v143
v_mfma_f32_16x16x32_bf16 v[144:147], a[176:179], v[72:75], v[144:147]
s_waitcnt lgkmcnt(2)
v_exp_f32 v111, v111
v_mfma_f32_16x16x32_bf16 v[148:151], a[192:195], v[72:75], v[228:231]
buffer_load_dwordx4 v16, s[32:35], s64 offen offset:1024 sc1 lds
v_mfma_f32_16x16x32_bf16 v[148:151], a[196:199], v[76:79], v[148:151]
v_exp_f32 v92, v92
v_mfma_f32_16x16x32_bf16 v[148:151], a[200:203], v[80:83], v[148:151]
v_exp_f32 v93, v93
v_mfma_f32_16x16x32_bf16 v[148:151], a[204:207], v[84:87], v[148:151]
v_exp_f32 v94, v94
v_mfma_f32_16x16x32_bf16 v[132:135], a[204:207], v[68:71], v[224:227]
ds_read_b128 a[152:155], v3 offset:1024
v_cvt_pk_bf16_f32 v186, v124, v125
v_mfma_f32_16x16x32_bf16 v[132:135], a[200:203], v[64:67], v[132:135]
ds_read_b128 a[156:159], v3 offset:9216
v_cvt_pk_bf16_f32 v187, v126, v127
v_mfma_f32_16x16x32_bf16 v[132:135], a[196:199], v[60:63], v[132:135]
v_exp_f32 v95, v95
v_mfma_f32_16x16x32_bf16 v[132:135], a[192:195], v[56:59], v[132:135]
v_exp_f32 v96, v96
v_mfma_f32_16x16x32_bf16 v[116:119], a[192:195], v[40:43], v[220:223]
v_exp_f32 v97, v97
v_mfma_f32_16x16x32_bf16 v[116:119], a[196:199], v[44:47], v[116:119]
v_exp_f32 v98, v98
v_mfma_f32_16x16x32_bf16 v[116:119], a[200:203], v[48:51], v[116:119]
ds_read_b128 a[160:163], v3 offset:2048
v_cvt_pk_bf16_f32 v162, v108, v109
v_mfma_f32_16x16x32_bf16 v[116:119], a[204:207], v[52:55], v[116:119]
v_exp_f32 v99, v99
v_mfma_f32_16x16x32_bf16 v[100:103], a[204:207], v[36:39], v[216:219]
ds_read_b128 a[164:167], v3 offset:10240
v_cvt_pk_bf16_f32 v163, v110, v111
v_mfma_f32_16x16x32_bf16 v[100:103], a[200:203], v[32:35], v[100:103]
v_exp_f32 v112, v112
v_mfma_f32_16x16x32_bf16 v[100:103], a[196:199], v[28:31], v[100:103]
v_exp_f32 v113, v113
v_mfma_f32_16x16x32_bf16 v[100:103], a[192:195], v[24:27], v[100:103]
v_exp_f32 v114, v114
v_smfmac_f32_16x16x64_bf16 a[128:131], a[240:243], v[168:175], v5
ds_read_b128 a[168:171], v3 offset:3072
v_smfmac_f32_16x16x64_bf16 a[132:135], a[240:243], v[176:183], v5
ds_read_b128 a[172:175], v3 offset:11264
v_smfmac_f32_16x16x64_bf16 a[136:139], a[240:243], v[200:207], v5
ds_read_b128 a[176:179], v3 offset:4096
v_smfmac_f32_16x16x64_bf16 a[140:143], a[240:243], v[208:215], v5
s_waitcnt lgkmcnt(3)
buffer_load_dwordx4 v16, s[32:35], s64 offen offset:2048 sc1 lds
v_mfma_f32_16x16x32_bf16 a[0:3], a[144:147], v[168:171], a[0:3]
v_exp_f32 v115, v115
v_mfma_f32_16x16x32_bf16 a[0:3], a[148:151], v[172:175], a[0:3]
v_exp_f32 v128, v128
v_mfma_f32_16x16x32_bf16 a[32:35], a[148:151], v[180:183], a[32:35]
v_exp_f32 v129, v129
v_mfma_f32_16x16x32_bf16 a[32:35], a[144:147], v[176:179], a[32:35]
v_exp_f32 v130, v130
v_mfma_f32_16x16x32_bf16 a[64:67], a[144:147], v[200:203], a[64:67]
v_exp_f32 v131, v131
v_mfma_f32_16x16x32_bf16 a[64:67], a[148:151], v[204:207], a[64:67]
v_cvt_pk_bf16_f32 v154, v92, v93
v_cvt_pk_bf16_f32 v155, v94, v95
v_mfma_f32_16x16x32_bf16 a[96:99], a[148:151], v[212:215], a[96:99]
v_exp_f32 v144, v144
v_mfma_f32_16x16x32_bf16 a[96:99], a[144:147], v[208:211], a[96:99]
ds_read_b128 a[180:183], v3 offset:12288
v_cvt_pk_bf16_f32 v156, v96, v97
v_mfma_f32_16x16x32_bf16 a[100:103], a[152:155], v[208:211], a[100:103]
v_exp_f32 v145, v145
v_mfma_f32_16x16x32_bf16 a[100:103], a[156:159], v[212:215], a[100:103]
ds_read_b128 a[184:187], v3 offset:5120
v_cvt_pk_bf16_f32 v157, v98, v99
v_mfma_f32_16x16x32_bf16 a[68:71], a[156:159], v[204:207], a[68:71]
ds_read_b128 a[188:191], v3 offset:13312
v_cvt_pk_bf16_f32 v164, v112, v113
v_mfma_f32_16x16x32_bf16 a[68:71], a[152:155], v[200:203], a[68:71]
buffer_load_dwordx4 v16, s[32:35], s64 offen offset:3072 sc1 lds
v_mfma_f32_16x16x32_bf16 a[36:39], a[152:155], v[176:179], a[36:39]
ds_read_b128 a[192:195], v3 offset:6144
v_cvt_pk_bf16_f32 v165, v114, v115
v_mfma_f32_16x16x32_bf16 a[36:39], a[156:159], v[180:183], a[36:39]
ds_read_b128 a[196:199], v3 offset:14336
v_cvt_pk_bf16_f32 v188, v128, v129
v_mfma_f32_16x16x32_bf16 a[4:7], a[156:159], v[172:175], a[4:7]
ds_read_b128 a[200:203], v3 offset:7168
v_cvt_pk_bf16_f32 v189, v130, v131
v_mfma_f32_16x16x32_bf16 a[4:7], a[152:155], v[168:171], a[4:7]
v_exp_f32 v146, v146
v_mfma_f32_16x16x32_bf16 a[8:11], a[160:163], v[168:171], a[8:11]
v_exp_f32 v147, v147
v_mfma_f32_16x16x32_bf16 a[8:11], a[164:167], v[172:175], a[8:11]
v_exp_f32 v148, v148
v_mfma_f32_16x16x32_bf16 a[40:43], a[164:167], v[180:183], a[40:43]
ds_read_b128 a[204:207], v3 offset:15360
v_cvt_pk_bf16_f32 v196, v144, v145
v_mfma_f32_16x16x32_bf16 a[40:43], a[160:163], v[176:179], a[40:43]
v_exp_f32 v149, v149
v_mfma_f32_16x16x32_bf16 a[72:75], a[160:163], v[200:203], a[72:75]
v_exp_f32 v150, v150
v_mfma_f32_16x16x32_bf16 a[72:75], a[164:167], v[204:207], a[72:75]
v_exp_f32 v151, v151
v_mfma_f32_16x16x32_bf16 a[104:107], a[164:167], v[212:215], a[104:107]
v_exp_f32 v132, v132
v_mfma_f32_16x16x32_bf16 a[104:107], a[160:163], v[208:211], a[104:107]
s_waitcnt lgkmcnt(1)
v_exp_f32 v133, v133
v_mfma_f32_16x16x32_bf16 a[108:111], a[168:171], v[208:211], a[108:111]
v_exp_f32 v134, v134
v_mfma_f32_16x16x32_bf16 a[108:111], a[172:175], v[212:215], a[108:111]
v_exp_f32 v135, v135
v_mfma_f32_16x16x32_bf16 a[76:79], a[172:175], v[204:207], a[76:79]
v_exp_f32 v116, v116
v_mfma_f32_16x16x32_bf16 a[76:79], a[168:171], v[200:203], a[76:79]
v_exp_f32 v117, v117
v_mfma_f32_16x16x32_bf16 a[44:47], a[168:171], v[176:179], a[44:47]
v_exp_f32 v118, v118
v_mfma_f32_16x16x32_bf16 a[44:47], a[172:175], v[180:183], a[44:47]
s_waitcnt vmcnt(9)
s_barrier
v_mfma_f32_16x16x32_bf16 a[12:15], a[172:175], v[172:175], a[12:15]
s_xor_b32 s71, s71, 16384
v_exp_f32 v119, v119
v_mfma_f32_16x16x32_bf16 a[12:15], a[168:171], v[168:171], a[12:15]
s_add_u32 s70, s70, 32768
v_exp_f32 v100, v100
v_mfma_f32_16x16x32_bf16 a[16:19], a[176:179], v[168:171], a[16:19]
s_mov_b32 m0, s71
v_exp_f32 v101, v101
v_mfma_f32_16x16x32_bf16 a[16:19], a[180:183], v[172:175], a[16:19]
buffer_load_dwordx4 v16, s[32:35], s70 offen offset:0 sc1 lds
v_mfma_f32_16x16x32_bf16 a[48:51], a[180:183], v[180:183], a[48:51]
ds_read_b128 a[144:147], v2 offset:16384
v_cvt_pk_bf16_f32 v197, v146, v147
v_mfma_f32_16x16x32_bf16 a[48:51], a[176:179], v[176:179], a[48:51]
ds_read_b128 a[148:151], v2 offset:17408
v_cvt_pk_bf16_f32 v198, v148, v149
v_mfma_f32_16x16x32_bf16 a[80:83], a[176:179], v[200:203], a[80:83]
v_exp_f32 v102, v102
v_mfma_f32_16x16x32_bf16 a[80:83], a[180:183], v[204:207], a[80:83]
ds_read_b128 a[152:155], v2 offset:18432
v_cvt_pk_bf16_f32 v199, v150, v151
v_mfma_f32_16x16x32_bf16 a[112:115], a[180:183], v[212:215], a[112:115]
ds_read_b128 a[156:159], v2 offset:19456
v_cvt_pk_bf16_f32 v190, v132, v133
v_mfma_f32_16x16x32_bf16 a[112:115], a[176:179], v[208:211], a[112:115]
v_exp_f32 v103, v103
v_mfma_f32_16x16x32_bf16 a[116:119], a[184:187], v[208:211], a[116:119]
ds_read_b128 a[160:163], v2 offset:20480
v_cvt_pk_bf16_f32 v191, v134, v135
v_mfma_f32_16x16x32_bf16 a[116:119], a[188:191], v[212:215], a[116:119]
ds_read_b128 a[164:167], v2 offset:21504
v_cvt_pk_bf16_f32 v166, v116, v117
v_mfma_f32_16x16x32_bf16 a[84:87], a[188:191], v[204:207], a[84:87]
ds_read_b128 a[168:171], v2 offset:22528
v_cvt_pk_bf16_f32 v167, v118, v119
v_mfma_f32_16x16x32_bf16 a[84:87], a[184:187], v[200:203], a[84:87]
ds_read_b128 a[172:175], v2 offset:23552
v_cvt_pk_bf16_f32 v158, v100, v101
v_mfma_f32_16x16x32_bf16 a[52:55], a[184:187], v[176:179], a[52:55]
v_cvt_pk_bf16_f32 v159, v102, v103
v_mfma_f32_16x16x32_bf16 a[52:55], a[188:191], v[180:183], a[52:55]
v_mfma_f32_16x16x32_bf16 a[20:23], a[188:191], v[172:175], a[20:23]
v_mfma_f32_16x16x32_bf16 a[20:23], a[184:187], v[168:171], a[20:23]
v_mfma_f32_16x16x32_bf16 a[24:27], a[192:195], v[168:171], a[24:27]
buffer_load_dwordx4 v16, s[32:35], s70 offen offset:1024 sc1 lds
v_mfma_f32_16x16x32_bf16 a[24:27], a[196:199], v[172:175], a[24:27]
v_mfma_f32_16x16x32_bf16 a[56:59], a[196:199], v[180:183], a[56:59]
v_mfma_f32_16x16x32_bf16 a[56:59], a[192:195], v[176:179], a[56:59]
v_mfma_f32_16x16x32_bf16 a[88:91], a[192:195], v[200:203], a[88:91]
v_mfma_f32_16x16x32_bf16 a[88:91], a[196:199], v[204:207], a[88:91]
v_mfma_f32_16x16x32_bf16 a[120:123], a[196:199], v[212:215], a[120:123]
v_mfma_f32_16x16x32_bf16 a[120:123], a[192:195], v[208:211], a[120:123]
v_mfma_f32_16x16x32_bf16 a[124:127], a[200:203], v[208:211], a[124:127]
s_waitcnt lgkmcnt(0)
v_mfma_f32_16x16x32_bf16 a[124:127], a[204:207], v[212:215], a[124:127]
v_mfma_f32_16x16x32_bf16 a[92:95], a[204:207], v[204:207], a[92:95]
v_mfma_f32_16x16x32_bf16 a[92:95], a[200:203], v[200:203], a[92:95]
v_mfma_f32_16x16x32_bf16 a[60:63], a[200:203], v[176:179], a[60:63]
v_mfma_f32_16x16x32_bf16 a[60:63], a[204:207], v[180:183], a[60:63]
v_mfma_f32_16x16x32_bf16 a[28:31], a[204:207], v[172:175], a[28:31]
v_mfma_f32_16x16x32_bf16 a[28:31], a[200:203], v[168:171], a[28:31]
v_mfma_f32_16x16x32_bf16 v[88:91], a[144:147], v[24:27], v[216:219]
ds_read_b128 a[176:179], v2 offset:24576
v_mfma_f32_16x16x32_bf16 v[88:91], a[148:151], v[28:31], v[88:91]
ds_read_b128 a[180:183], v2 offset:25600
v_mfma_f32_16x16x32_bf16 v[88:91], a[152:155], v[32:35], v[88:91]
buffer_load_dwordx4 v16, s[32:35], s70 offen offset:2048 sc1 lds
v_mfma_f32_16x16x32_bf16 v[88:91], a[156:159], v[36:39], v[88:91]
ds_read_b128 a[184:187], v2 offset:26624
v_mfma_f32_16x16x32_bf16 v[104:107], a[156:159], v[52:55], v[220:223]
v_mfma_f32_16x16x32_bf16 v[104:107], a[152:155], v[48:51], v[104:107]
v_mfma_f32_16x16x32_bf16 v[104:107], a[148:151], v[44:47], v[104:107]
ds_read_b128 a[188:191], v2 offset:27648
v_mfma_f32_16x16x32_bf16 v[104:107], a[144:147], v[40:43], v[104:107]
v_mfma_f32_16x16x32_bf16 v[120:123], a[144:147], v[56:59], v[224:227]
v_mfma_f32_16x16x32_bf16 v[120:123], a[148:151], v[60:63], v[120:123]
v_mfma_f32_16x16x32_bf16 v[120:123], a[152:155], v[64:67], v[120:123]
v_exp_f32 v88, v88
v_mfma_f32_16x16x32_bf16 v[120:123], a[156:159], v[68:71], v[120:123]
v_exp_f32 v89, v89
v_mfma_f32_16x16x32_bf16 v[136:139], a[156:159], v[84:87], v[228:231]
v_exp_f32 v90, v90
v_mfma_f32_16x16x32_bf16 v[136:139], a[152:155], v[80:83], v[136:139]
v_exp_f32 v91, v91
v_mfma_f32_16x16x32_bf16 v[136:139], a[148:151], v[76:79], v[136:139]
v_exp_f32 v104, v104
v_mfma_f32_16x16x32_bf16 v[136:139], a[144:147], v[72:75], v[136:139]
v_exp_f32 v105, v105
v_mfma_f32_16x16x32_bf16 v[140:143], a[160:163], v[72:75], v[228:231]
v_exp_f32 v106, v106
v_mfma_f32_16x16x32_bf16 v[140:143], a[164:167], v[76:79], v[140:143]
buffer_load_dwordx4 v16, s[32:35], s70 offen offset:3072 sc1 lds
v_mfma_f32_16x16x32_bf16 v[140:143], a[168:171], v[80:83], v[140:143]
v_exp_f32 v107, v107
v_mfma_f32_16x16x32_bf16 v[140:143], a[172:175], v[84:87], v[140:143]
v_cvt_pk_bf16_f32 v168, v88, v89
v_cvt_pk_bf16_f32 v169, v90, v91
v_mfma_f32_16x16x32_bf16 v[124:127], a[172:175], v[68:71], v[224:227]
v_exp_f32 v120, v120
v_mfma_f32_16x16x32_bf16 v[124:127], a[168:171], v[64:67], v[124:127]
v_exp_f32 v121, v121
v_mfma_f32_16x16x32_bf16 v[124:127], a[164:167], v[60:63], v[124:127]
v_exp_f32 v122, v122
v_mfma_f32_16x16x32_bf16 v[124:127], a[160:163], v[56:59], v[124:127]
v_exp_f32 v123, v123
v_mfma_f32_16x16x32_bf16 v[108:111], a[160:163], v[40:43], v[220:223]
v_exp_f32 v136, v136
v_mfma_f32_16x16x32_bf16 v[108:111], a[164:167], v[44:47], v[108:111]
v_exp_f32 v137, v137
v_mfma_f32_16x16x32_bf16 v[108:111], a[168:171], v[48:51], v[108:111]
v_exp_f32 v138, v138
v_mfma_f32_16x16x32_bf16 v[108:111], a[172:175], v[52:55], v[108:111]
v_cvt_pk_bf16_f32 v176, v104, v105
v_cvt_pk_bf16_f32 v177, v106, v107
v_mfma_f32_16x16x32_bf16 v[92:95], a[172:175], v[36:39], v[216:219]
v_exp_f32 v139, v139
v_mfma_f32_16x16x32_bf16 v[92:95], a[168:171], v[32:35], v[92:95]
ds_read_b128 a[192:195], v2 offset:28672
v_cvt_pk_bf16_f32 v200, v120, v121
v_mfma_f32_16x16x32_bf16 v[92:95], a[164:167], v[28:31], v[92:95]
v_exp_f32 v140, v140
v_mfma_f32_16x16x32_bf16 v[92:95], a[160:163], v[24:27], v[92:95]
s_waitcnt lgkmcnt(1)
s_add_u32 m0, s71, 4096
ds_read_b128 a[196:199], v2 offset:29696
v_cvt_pk_bf16_f32 v201, v122, v123
v_mfma_f32_16x16x32_bf16 v[96:99], a[176:179], v[24:27], v[216:219]
s_add_u32 s64, s70, 4096
ds_read_b128 a[200:203], v2 offset:30720
v_cvt_pk_bf16_f32 v208, v136, v137
v_mfma_f32_16x16x32_bf16 v[96:99], a[180:183], v[28:31], v[96:99]
buffer_load_dwordx4 v16, s[32:35], s64 offen offset:0 sc1 lds
v_mfma_f32_16x16x32_bf16 v[96:99], a[184:187], v[32:35], v[96:99]
v_exp_f32 v141, v141
v_mfma_f32_16x16x32_bf16 v[96:99], a[188:191], v[36:39], v[96:99]
ds_read_b128 a[204:207], v2 offset:31744
v_cvt_pk_bf16_f32 v209, v138, v139
v_mfma_f32_16x16x32_bf16 v[112:115], a[188:191], v[52:55], v[220:223]
v_exp_f32 v142, v142
v_mfma_f32_16x16x32_bf16 v[112:115], a[184:187], v[48:51], v[112:115]
v_exp_f32 v143, v143
v_mfma_f32_16x16x32_bf16 v[112:115], a[180:183], v[44:47], v[112:115]
v_exp_f32 v124, v124
v_mfma_f32_16x16x32_bf16 v[112:115], a[176:179], v[40:43], v[112:115]
v_exp_f32 v125, v125
v_mfma_f32_16x16x32_bf16 v[128:131], a[176:179], v[56:59], v[224:227]
v_exp_f32 v126, v126
v_mfma_f32_16x16x32_bf16 v[128:131], a[180:183], v[60:63], v[128:131]
v_exp_f32 v127, v127
v_mfma_f32_16x16x32_bf16 v[128:131], a[184:187], v[64:67], v[128:131]
v_exp_f32 v108, v108
v_mfma_f32_16x16x32_bf16 v[128:131], a[188:191], v[68:71], v[128:131]
v_exp_f32 v109, v109
v_mfma_f32_16x16x32_bf16 v[144:147], a[188:191], v[84:87], v[228:231]
v_exp_f32 v110, v110
v_mfma_f32_16x16x32_bf16 v[144:147], a[184:187], v[80:83], v[144:147]
ds_read_b128 a[144:147], v3 offset:16384
v_cvt_pk_bf16_f32 v210, v140, v141
v_mfma_f32_16x16x32_bf16 v[144:147], a[180:183], v[76:79], v[144:147]
ds_read_b128 a[148:151], v3 offset:24576
v_cvt_pk_bf16_f32 v211, v142, v143
v_mfma_f32_16x16x32_bf16 v[144:147], a[176:179], v[72:75], v[144:147]
s_branch L_po16
L_pg16:
s_branch L_pg20
L_po16:
s_waitcnt lgkmcnt(2)
v_exp_f32 v111, v111
v_mfma_f32_16x16x32_bf16 v[148:151], a[192:195], v[72:75], v[228:231]
buffer_load_dwordx4 v16, s[32:35], s64 offen offset:1024 sc1 lds
v_mfma_f32_16x16x32_bf16 v[148:151], a[196:199], v[76:79], v[148:151]
v_exp_f32 v92, v92
v_mfma_f32_16x16x32_bf16 v[148:151], a[200:203], v[80:83], v[148:151]
v_exp_f32 v93, v93
v_mfma_f32_16x16x32_bf16 v[148:151], a[204:207], v[84:87], v[148:151]
v_exp_f32 v94, v94
v_mfma_f32_16x16x32_bf16 v[132:135], a[204:207], v[68:71], v[224:227]
ds_read_b128 a[152:155], v3 offset:17408
v_cvt_pk_bf16_f32 v202, v124, v125
v_mfma_f32_16x16x32_bf16 v[132:135], a[200:203], v[64:67], v[132:135]
ds_read_b128 a[156:159], v3 offset:25600
v_cvt_pk_bf16_f32 v203, v126, v127
v_mfma_f32_16x16x32_bf16 v[132:135], a[196:199], v[60:63], v[132:135]
v_exp_f32 v95, v95
v_mfma_f32_16x16x32_bf16 v[132:135], a[192:195], v[56:59], v[132:135]
v_exp_f32 v96, v96
v_mfma_f32_16x16x32_bf16 v[116:119], a[192:195], v[40:43], v[220:223]
v_exp_f32 v97, v97
v_mfma_f32_16x16x32_bf16 v[116:119], a[196:199], v[44:47], v[116:119]
v_exp_f32 v98, v98
v_mfma_f32_16x16x32_bf16 v[116:119], a[200:203], v[48:51], v[116:119]
ds_read_b128 a[160:163], v3 offset:18432
v_cvt_pk_bf16_f32 v178, v108, v109
v_mfma_f32_16x16x32_bf16 v[116:119], a[204:207], v[52:55], v[116:119]
v_exp_f32 v99, v99
v_mfma_f32_16x16x32_bf16 v[100:103], a[204:207], v[36:39], v[216:219]
ds_read_b128 a[164:167], v3 offset:26624
v_cvt_pk_bf16_f32 v179, v110, v111
v_mfma_f32_16x16x32_bf16 v[100:103], a[200:203], v[32:35], v[100:103]
v_exp_f32 v112, v112
v_mfma_f32_16x16x32_bf16 v[100:103], a[196:199], v[28:31], v[100:103]
v_exp_f32 v113, v113
v_mfma_f32_16x16x32_bf16 v[100:103], a[192:195], v[24:27], v[100:103]
v_exp_f32 v114, v114
v_smfmac_f32_16x16x64_bf16 a[128:131], a[240:243], v[152:159], v5
ds_read_b128 a[168:171], v3 offset:19456
v_smfmac_f32_16x16x64_bf16 a[132:135], a[240:243], v[160:167], v5
ds_read_b128 a[172:175], v3 offset:27648
v_smfmac_f32_16x16x64_bf16 a[136:139], a[240:243], v[184:191], v5
ds_read_b128 a[176:179], v3 offset:20480
v_smfmac_f32_16x16x64_bf16 a[140:143], a[240:243], v[192:199], v5
s_waitcnt lgkmcnt(3)
buffer_load_dwordx4 v16, s[32:35], s64 offen offset:2048 sc1 lds
v_mfma_f32_16x16x32_bf16 a[0:3], a[144:147], v[152:155], a[0:3]
v_exp_f32 v115, v115
v_mfma_f32_16x16x32_bf16 a[0:3], a[148:151], v[156:159], a[0:3]
v_exp_f32 v128, v128
v_mfma_f32_16x16x32_bf16 a[32:35], a[148:151], v[164:167], a[32:35]
v_exp_f32 v129, v129
v_mfma_f32_16x16x32_bf16 a[32:35], a[144:147], v[160:163], a[32:35]
v_exp_f32 v130, v130
v_mfma_f32_16x16x32_bf16 a[64:67], a[144:147], v[184:187], a[64:67]
v_exp_f32 v131, v131
v_mfma_f32_16x16x32_bf16 a[64:67], a[148:151], v[188:191], a[64:67]
v_cvt_pk_bf16_f32 v170, v92, v93
v_cvt_pk_bf16_f32 v171, v94, v95
v_mfma_f32_16x16x32_bf16 a[96:99], a[148:151], v[196:199], a[96:99]
v_exp_f32 v144, v144
v_mfma_f32_16x16x32_bf16 a[96:99], a[144:147], v[192:195], a[96:99]
ds_read_b128 a[180:183], v3 offset:28672
v_cvt_pk_bf16_f32 v172, v96, v97
v_mfma_f32_16x16x32_bf16 a[100:103], a[152:155], v[192:195], a[100:103]
v_exp_f32 v145, v145
v_mfma_f32_16x16x32_bf16 a[100:103], a[156:159], v[196:199], a[100:103]
ds_read_b128 a[184:187], v3 offset:21504
v_xor_b32 v2, 0x8000, v2
v_mfma_f32_16x16x32_bf16 a[68:71], a[156:159], v[188:191], a[68:71]
ds_read_b128 a[188:191], v3 offset:29696
v_cvt_pk_bf16_f32 v173, v98, v99
v_mfma_f32_16x16x32_bf16 a[68:71], a[152:155], v[184:187], a[68:71]
buffer_load_dwordx4 v16, s[32:35], s64 offen offset:3072 sc1 lds
v_mfma_f32_16x16x32_bf16 a[36:39], a[152:155], v[160:163], a[36:39]
ds_read_b128 a[192:195], v3 offset:22528
v_cvt_pk_bf16_f32 v180, v112, v113
v_mfma_f32_16x16x32_bf16 a[36:39], a[156:159], v[164:167], a[36:39]
ds_read_b128 a[196:199], v3 offset:30720
v_cvt_pk_bf16_f32 v181, v114, v115
v_mfma_f32_16x16x32_bf16 a[4:7], a[156:159], v[156:159], a[4:7]
ds_read_b128 a[200:203], v3 offset:23552
v_cvt_pk_bf16_f32 v204, v128, v129
v_mfma_f32_16x16x32_bf16 a[4:7], a[152:155], v[152:155], a[4:7]
v_exp_f32 v146, v146
v_mfma_f32_16x16x32_bf16 a[8:11], a[160:163], v[152:155], a[8:11]
v_exp_f32 v147, v147
v_mfma_f32_16x16x32_bf16 a[8:11], a[164:167], v[156:159], a[8:11]
v_exp_f32 v148, v148
v_mfma_f32_16x16x32_bf16 a[40:43], a[164:167], v[164:167], a[40:43]
ds_read_b128 a[204:207], v3 offset:31744
v_cvt_pk_bf16_f32 v205, v130, v131
v_mfma_f32_16x16x32_bf16 a[40:43], a[160:163], v[160:163], a[40:43]
v_exp_f32 v149, v149
v_mfma_f32_16x16x32_bf16 a[72:75], a[160:163], v[184:187], a[72:75]
v_exp_f32 v150, v150
v_mfma_f32_16x16x32_bf16 a[72:75], a[164:167], v[188:191], a[72:75]
v_exp_f32 v151, v151
v_mfma_f32_16x16x32_bf16 a[104:107], a[164:167], v[196:199], a[104:107]
v_exp_f32 v132, v132
v_mfma_f32_16x16x32_bf16 a[104:107], a[160:163], v[192:195], a[104:107]
s_waitcnt lgkmcnt(1)
v_exp_f32 v133, v133
v_mfma_f32_16x16x32_bf16 a[108:111], a[168:171], v[192:195], a[108:111]
v_exp_f32 v134, v134
v_mfma_f32_16x16x32_bf16 a[108:111], a[172:175], v[196:199], a[108:111]
v_exp_f32 v135, v135
v_mfma_f32_16x16x32_bf16 a[76:79], a[172:175], v[188:191], a[76:79]
v_exp_f32 v116, v116
v_mfma_f32_16x16x32_bf16 a[76:79], a[168:171], v[184:187], a[76:79]
v_exp_f32 v117, v117
v_mfma_f32_16x16x32_bf16 a[44:47], a[168:171], v[160:163], a[44:47]
v_exp_f32 v118, v118
v_mfma_f32_16x16x32_bf16 a[44:47], a[172:175], v[164:167], a[44:47]
s_waitcnt vmcnt(8)
s_barrier
v_mfma_f32_16x16x32_bf16 a[12:15], a[172:175], v[156:159], a[12:15]
s_xor_b32 s71, s71, 49152
v_exp_f32 v119, v119
v_mfma_f32_16x16x32_bf16 a[12:15], a[168:171], v[152:155], a[12:15]
s_add_u32 s70, s70, 32768
v_exp_f32 v100, v100
v_mfma_f32_16x16x32_bf16 a[16:19], a[176:179], v[152:155], a[16:19]
s_mov_b32 m0, s71
v_exp_f32 v101, v101
v_mfma_f32_16x16x32_bf16 a[16:19], a[180:183], v[156:159], a[16:19]
buffer_load_dwordx4 v16, s[32:35], s70 offen offset:0 sc1 lds
v_mfma_f32_16x16x32_bf16 a[48:51], a[180:183], v[164:167], a[48:51]
ds_read_b128 a[144:147], v2 offset:0
v_cvt_pk_bf16_f32 v212, v144, v145
v_mfma_f32_16x16x32_bf16 a[48:51], a[176:179], v[160:163], a[48:51]
ds_read_b128 a[148:151], v2 offset:1024
v_cvt_pk_bf16_f32 v213, v146, v147
v_mfma_f32_16x16x32_bf16 a[80:83], a[176:179], v[184:187], a[80:83]
v_exp_f32 v102, v102
v_mfma_f32_16x16x32_bf16 a[80:83], a[180:183], v[188:191], a[80:83]
ds_read_b128 a[152:155], v2 offset:2048
v_cvt_pk_bf16_f32 v214, v148, v149
v_mfma_f32_16x16x32_bf16 a[112:115], a[180:183], v[196:199], a[112:115]
ds_read_b128 a[156:159], v2 offset:3072
v_cvt_pk_bf16_f32 v215, v150, v151
v_mfma_f32_16x16x32_bf16 a[112:115], a[176:179], v[192:195], a[112:115]
v_exp_f32 v103, v103
v_mfma_f32_16x16x32_bf16 a[116:119], a[184:187], v[192:195], a[116:119]
ds_read_b128 a[160:163], v2 offset:4096
v_cvt_pk_bf16_f32 v206, v132, v133
v_mfma_f32_16x16x32_bf16 a[116:119], a[188:191], v[196:199], a[116:119]
ds_read_b128 a[164:167], v2 offset:5120
v_cvt_pk_bf16_f32 v207, v134, v135
v_mfma_f32_16x16x32_bf16 a[84:87], a[188:191], v[188:191], a[84:87]
ds_read_b128 a[168:171], v2 offset:6144
v_xor_b32 v3, 0x8000, v3
v_mfma_f32_16x16x32_bf16 a[84:87], a[184:187], v[184:187], a[84:87]
ds_read_b128 a[172:175], v2 offset:7168
v_cvt_pk_bf16_f32 v182, v116, v117
v_mfma_f32_16x16x32_bf16 a[52:55], a[184:187], v[160:163], a[52:55]
v_cvt_pk_bf16_f32 v183, v118, v119
v_cvt_pk_bf16_f32 v174, v100, v101
v_mfma_f32_16x16x32_bf16 a[52:55], a[188:191], v[164:167], a[52:55]
v_cvt_pk_bf16_f32 v175, v102, v103
v_mfma_f32_16x16x32_bf16 a[20:23], a[188:191], v[156:159], a[20:23]
v_mfma_f32_16x16x32_bf16 a[20:23], a[184:187], v[152:155], a[20:23]
v_mfma_f32_16x16x32_bf16 a[24:27], a[192:195], v[152:155], a[24:27]
buffer_load_dwordx4 v16, s[32:35], s70 offen offset:1024 sc1 lds
v_mfma_f32_16x16x32_bf16 a[24:27], a[196:199], v[156:159], a[24:27]
v_mfma_f32_16x16x32_bf16 a[56:59], a[196:199], v[164:167], a[56:59]
v_mfma_f32_16x16x32_bf16 a[56:59], a[192:195], v[160:163], a[56:59]
v_mfma_f32_16x16x32_bf16 a[88:91], a[192:195], v[184:187], a[88:91]
v_mfma_f32_16x16x32_bf16 a[88:91], a[196:199], v[188:191], a[88:91]
v_mfma_f32_16x16x32_bf16 a[120:123], a[196:199], v[196:199], a[120:123]
s_sub_u32 s72, s72, 1
v_mfma_f32_16x16x32_bf16 a[120:123], a[192:195], v[192:195], a[120:123]
v_mfma_f32_16x16x32_bf16 a[124:127], a[200:203], v[192:195], a[124:127]
s_waitcnt lgkmcnt(0)
v_mfma_f32_16x16x32_bf16 a[124:127], a[204:207], v[196:199], a[124:127]
v_mfma_f32_16x16x32_bf16 a[92:95], a[204:207], v[188:191], a[92:95]
s_cmp_lg_u32 s72, 0
v_mfma_f32_16x16x32_bf16 a[92:95], a[200:203], v[184:187], a[92:95]
v_mfma_f32_16x16x32_bf16 a[60:63], a[200:203], v[160:163], a[60:63]
v_mfma_f32_16x16x32_bf16 a[60:63], a[204:207], v[164:167], a[60:63]
v_mfma_f32_16x16x32_bf16 a[28:31], a[204:207], v[156:159], a[28:31]
v_mfma_f32_16x16x32_bf16 a[28:31], a[200:203], v[152:155], a[28:31]
s_cbranch_scc1 L_D
L_DD:
s_waitcnt lgkmcnt(7)
v_mfma_f32_16x16x32_bf16 v[104:107], a[144:147], v[40:43], v[220:223]
s_waitcnt lgkmcnt(6)
ds_read_b128 a[176:179], v2 offset:8192
v_cndmask_b32 v88, v216, v17, s[0:1]
v_mfma_f32_16x16x32_bf16 v[104:107], a[148:151], v[44:47], v[104:107]
s_waitcnt lgkmcnt(6)
ds_read_b128 a[180:183], v2 offset:9216
v_cndmask_b32 v89, v216, v17, s[4:5]
v_mfma_f32_16x16x32_bf16 v[104:107], a[152:155], v[48:51], v[104:107]
s_waitcnt lgkmcnt(6)
buffer_load_dwordx4 v16, s[32:35], s70 offen offset:2048 sc1 lds
v_mfma_f32_16x16x32_bf16 v[104:107], a[156:159], v[52:55], v[104:107]
ds_read_b128 a[184:187], v2 offset:10240
v_cndmask_b32 v90, v216, v17, s[6:7]
v_mfma_f32_16x16x32_bf16 v[120:123], a[156:159], v[68:71], v[224:227]
ds_read_b128 a[188:191], v2 offset:11264
v_cndmask_b32 v91, v216, v17, s[8:9]
v_mfma_f32_16x16x32_bf16 v[120:123], a[152:155], v[64:67], v[120:123]
ds_read_b128 a[192:195], v2 offset:12288
v_cndmask_b32 v92, v216, v17, s[10:11]
v_mfma_f32_16x16x32_bf16 v[120:123], a[148:151], v[60:63], v[120:123]
ds_read_b128 a[196:199], v2 offset:13312
v_cndmask_b32 v93, v216, v17, s[12:13]
v_mfma_f32_16x16x32_bf16 v[120:123], a[144:147], v[56:59], v[120:123]
ds_read_b128 a[200:203], v2 offset:14336
v_cndmask_b32 v94, v216, v17, s[18:19]
v_mfma_f32_16x16x32_bf16 v[136:139], a[144:147], v[72:75], v[228:231]
ds_read_b128 a[204:207], v2 offset:15360
v_cndmask_b32 v95, v216, v17, s[22:23]
v_mfma_f32_16x16x32_bf16 v[136:139], a[148:151], v[76:79], v[136:139]
v_cndmask_b32 v96, v216, v17, s[26:27]
v_cndmask_b32 v97, v216, v17, s[56:57]
v_mfma_f32_16x16x32_bf16 v[136:139], a[152:155], v[80:83], v[136:139]
v_exp_f32 v104, v104
v_mfma_f32_16x16x32_bf16 v[136:139], a[156:159], v[84:87], v[136:139]
v_exp_f32 v105, v105
v_mfma_f32_16x16x32_bf16 v[88:91], a[156:159], v[36:39], v[88:91]
v_exp_f32 v106, v106
v_mfma_f32_16x16x32_bf16 v[88:91], a[152:155], v[32:35], v[88:91]
v_exp_f32 v107, v107
v_mfma_f32_16x16x32_bf16 v[88:91], a[148:151], v[28:31], v[88:91]
v_exp_f32 v120, v120
v_mfma_f32_16x16x32_bf16 v[88:91], a[144:147], v[24:27], v[88:91]
s_waitcnt lgkmcnt(0)
v_exp_f32 v121, v121
v_mfma_f32_16x16x32_bf16 v[140:143], a[160:163], v[72:75], v[228:231]
v_exp_f32 v122, v122
v_mfma_f32_16x16x32_bf16 v[140:143], a[164:167], v[76:79], v[140:143]
buffer_load_dwordx4 v16, s[32:35], s70 offen offset:3072 sc1 lds
v_mfma_f32_16x16x32_bf16 v[140:143], a[168:171], v[80:83], v[140:143]
s_add_u32 m0, s86, 131072
v_exp_f32 v123, v123
v_mfma_f32_16x16x32_bf16 v[140:143], a[172:175], v[84:87], v[140:143]
s_add_u32 s64, s85, 0
v_cvt_pk_bf16_f32 v160, v104, v105
v_cvt_pk_bf16_f32 v161, v106, v107
v_mfma_f32_16x16x32_bf16 v[124:127], a[172:175], v[68:71], v[224:227]
buffer_load_dwordx4 v12, s[36:39], s64 offen lds
v_mfma_f32_16x16x32_bf16 v[124:127], a[168:171], v[64:67], v[124:127]
s_add_u32 m0, s86, 132096
v_exp_f32 v136, v136
v_mfma_f32_16x16x32_bf16 v[124:127], a[164:167], v[60:63], v[124:127]
s_add_u32 s64, s85, 8192
v_exp_f32 v137, v137
v_mfma_f32_16x16x32_bf16 v[124:127], a[160:163], v[56:59], v[124:127]
buffer_load_dwordx4 v13, s[36:39], s64 offen lds
v_mfma_f32_16x16x32_bf16 v[108:111], a[160:163], v[40:43], v[220:223]
v_exp_f32 v138, v138
v_mfma_f32_16x16x32_bf16 v[108:111], a[164:167], v[44:47], v[108:111]
ds_read_b128 a[144:147], v3 offset:0
v_cndmask_b32 v98, v216, v17, s[58:59]
v_mfma_f32_16x16x32_bf16 v[108:111], a[168:171], v[48:51], v[108:111]
s_add_u32 m0, s86, 133120
ds_read_b128 a[148:151], v3 offset:8192
v_cndmask_b32 v99, v216, v17, s[60:61]
v_mfma_f32_16x16x32_bf16 v[108:111], a[172:175], v[52:55], v[108:111]
s_add_u32 s64, s85, 16384
v_cvt_pk_bf16_f32 v184, v120, v121
v_cvt_pk_bf16_f32 v185, v122, v123
v_mfma_f32_16x16x32_bf16 v[92:95], a[172:175], v[36:39], v[92:95]
buffer_load_dwordx4 v12, s[36:39], s64 offen lds
v_mfma_f32_16x16x32_bf16 v[92:95], a[168:171], v[32:35], v[92:95]
s_add_u32 m0, s86, 134144
v_exp_f32 v139, v139
v_mfma_f32_16x16x32_bf16 v[92:95], a[164:167], v[28:31], v[92:95]
s_add_u32 s64, s85, 24576
v_exp_f32 v88, v88
v_mfma_f32_16x16x32_bf16 v[92:95], a[160:163], v[24:27], v[92:95]
buffer_load_dwordx4 v13, s[36:39], s64 offen lds
v_mfma_f32_16x16x32_bf16 v[96:99], a[176:179], v[24:27], v[96:99]
s_add_u32 m0, s71, 4096
v_exp_f32 v89, v89
v_mfma_f32_16x16x32_bf16 v[96:99], a[180:183], v[28:31], v[96:99]
s_add_u32 s64, s70, 4096
v_exp_f32 v90, v90
v_mfma_f32_16x16x32_bf16 v[96:99], a[184:187], v[32:35], v[96:99]
buffer_load_dwordx4 v16, s[32:35], s64 offen offset:0 sc1 lds
v_mfma_f32_16x16x32_bf16 v[96:99], a[188:191], v[36:39], v[96:99]
v_cvt_pk_bf16_f32 v192, v136, v137
v_cvt_pk_bf16_f32 v193, v138, v139
v_mfma_f32_16x16x32_bf16 v[112:115], a[188:191], v[52:55], v[220:223]
v_exp_f32 v91, v91
v_mfma_f32_16x16x32_bf16 v[112:115], a[184:187], v[48:51], v[112:115]
v_exp_f32 v140, v140
v_mfma_f32_16x16x32_bf16 v[112:115], a[180:183], v[44:47], v[112:115]
v_exp_f32 v141, v141
v_mfma_f32_16x16x32_bf16 v[112:115], a[176:179], v[40:43], v[112:115]
v_exp_f32 v142, v142
v_mfma_f32_16x16x32_bf16 v[128:131], a[176:179], v[56:59], v[224:227]
v_exp_f32 v143, v143
v_mfma_f32_16x16x32_bf16 v[128:131], a[180:183], v[60:63], v[128:131]
v_exp_f32 v124, v124
v_mfma_f32_16x16x32_bf16 v[128:131], a[184:187], v[64:67], v[128:131]
v_cvt_pk_bf16_f32 v152, v88, v89
v_cvt_pk_bf16_f32 v153, v90, v91
v_mfma_f32_16x16x32_bf16 v[128:131], a[188:191], v[68:71], v[128:131]
v_exp_f32 v125, v125
v_mfma_f32_16x16x32_bf16 v[144:147], a[188:191], v[84:87], v[228:231]
v_exp_f32 v126, v126
v_mfma_f32_16x16x32_bf16 v[144:147], a[184:187], v[80:83], v[144:147]
v_exp_f32 v127, v127
v_mfma_f32_16x16x32_bf16 v[144:147], a[180:183], v[76:79], v[144:147]
v_exp_f32 v108, v108
v_mfma_f32_16x16x32_bf16 v[144:147], a[176:179], v[72:75], v[144:147]
ds_read_b128 a[152:155], v3 offset:1024
v_cndmask_b32 v100, v216, v17, s[62:63]
v_mfma_f32_16x16x32_bf16 v[148:151], a[192:195], v[72:75], v[228:231]
buffer_load_dwordx4 v16, s[32:35], s64 offen offset:1024 sc1 lds
v_mfma_f32_16x16x32_bf16 v[148:151], a[196:199], v[76:79], v[148:151]
ds_read_b128 a[156:159], v3 offset:9216
v_cndmask_b32 v101, v216, v17, s[48:49]
v_mfma_f32_16x16x32_bf16 v[148:151], a[200:203], v[80:83], v[148:151]
v_cvt_pk_bf16_f32 v194, v140, v141
v_cvt_pk_bf16_f32 v195, v142, v143
v_mfma_f32_16x16x32_bf16 v[148:151], a[204:207], v[84:87], v[148:151]
ds_read_b128 a[160:163], v3 offset:2048
v_cndmask_b32 v102, v216, v17, s[50:51]
v_mfma_f32_16x16x32_bf16 v[132:135], a[204:207], v[68:71], v[224:227]
ds_read_b128 a[164:167], v3 offset:10240
v_cndmask_b32 v103, v216, v17, s[100:101]
v_mfma_f32_16x16x32_bf16 v[132:135], a[200:203], v[64:67], v[132:135]
v_exp_f32 v109, v109
v_mfma_f32_16x16x32_bf16 v[132:135], a[196:199], v[60:63], v[132:135]
v_exp_f32 v110, v110
v_mfma_f32_16x16x32_bf16 v[132:135], a[192:195], v[56:59], v[132:135]
v_exp_f32 v111, v111
v_mfma_f32_16x16x32_bf16 v[116:119], a[192:195], v[40:43], v[220:223]
v_exp_f32 v92, v92
v_mfma_f32_16x16x32_bf16 v[116:119], a[196:199], v[44:47], v[116:119]
v_cvt_pk_bf16_f32 v186, v124, v125
v_cvt_pk_bf16_f32 v187, v126, v127
v_mfma_f32_16x16x32_bf16 v[116:119], a[200:203], v[48:51], v[116:119]
v_exp_f32 v93, v93
v_mfma_f32_16x16x32_bf16 v[116:119], a[204:207], v[52:55], v[116:119]
v_exp_f32 v94, v94
v_mfma_f32_16x16x32_bf16 v[100:103], a[204:207], v[36:39], v[100:103]
v_exp_f32 v95, v95
v_mfma_f32_16x16x32_bf16 v[100:103], a[200:203], v[32:35], v[100:103]
v_exp_f32 v96, v96
v_mfma_f32_16x16x32_bf16 v[100:103], a[196:199], v[28:31], v[100:103]
v_exp_f32 v97, v97
v_mfma_f32_16x16x32_bf16 v[100:103], a[192:195], v[24:27], v[100:103]
v_exp_f32 v98, v98
v_smfmac_f32_16x16x64_bf16 a[128:131], a[240:243], v[168:175], v5
ds_read_b128 a[168:171], v3 offset:3072
v_smfmac_f32_16x16x64_bf16 a[132:135], a[240:243], v[176:183], v5
v_cvt_pk_bf16_f32 v162, v108, v109
v_smfmac_f32_16x16x64_bf16 a[136:139], a[240:243], v[200:207], v5
ds_read_b128 a[172:175], v3 offset:11264
v_smfmac_f32_16x16x64_bf16 a[140:143], a[240:243], v[208:215], v5
s_waitcnt lgkmcnt(2)
buffer_load_dwordx4 v16, s[32:35], s64 offen offset:2048 sc1 lds
v_mfma_f32_16x16x32_bf16 a[0:3], a[144:147], v[168:171], a[0:3]
v_exp_f32 v99, v99
v_mfma_f32_16x16x32_bf16 a[0:3], a[148:151], v[172:175], a[0:3]
v_cvt_pk_bf16_f32 v163, v110, v111
v_cvt_pk_bf16_f32 v154, v92, v93
v_mfma_f32_16x16x32_bf16 a[32:35], a[148:151], v[180:183], a[32:35]
v_exp_f32 v112, v112
v_mfma_f32_16x16x32_bf16 a[32:35], a[144:147], v[176:179], a[32:35]
v_exp_f32 v113, v113
v_mfma_f32_16x16x32_bf16 a[64:67], a[144:147], v[200:203], a[64:67]
v_exp_f32 v114, v114
v_mfma_f32_16x16x32_bf16 a[64:67], a[148:151], v[204:207], a[64:67]
v_exp_f32 v115, v115
v_mfma_f32_16x16x32_bf16 a[96:99], a[148:151], v[212:215], a[96:99]
v_exp_f32 v128, v128
v_mfma_f32_16x16x32_bf16 a[96:99], a[144:147], v[208:211], a[96:99]
v_exp_f32 v129, v129
v_mfma_f32_16x16x32_bf16 a[100:103], a[152:155], v[208:211], a[100:103]
v_exp_f32 v130, v130
v_mfma_f32_16x16x32_bf16 a[100:103], a[156:159], v[212:215], a[100:103]
v_cvt_pk_bf16_f32 v155, v94, v95
v_cvt_pk_bf16_f32 v156, v96, v97
v_mfma_f32_16x16x32_bf16 a[68:71], a[156:159], v[204:207], a[68:71]
v_exp_f32 v131, v131
v_mfma_f32_16x16x32_bf16 a[68:71], a[152:155], v[200:203], a[68:71]
buffer_load_dwordx4 v16, s[32:35], s64 offen offset:3072 sc1 lds
v_mfma_f32_16x16x32_bf16 a[36:39], a[152:155], v[176:179], a[36:39]
s_add_u32 m0, s86, 135168
ds_read_b128 a[176:179], v3 offset:4096
v_cvt_pk_bf16_f32 v157, v98, v99
v_mfma_f32_16x16x32_bf16 a[36:39], a[156:159], v[180:183], a[36:39]
s_add_u32 s64, s85, 32768
v_exp_f32 v144, v144
v_mfma_f32_16x16x32_bf16 a[4:7], a[156:159], v[172:175], a[4:7]
buffer_load_dwordx4 v12, s[36:39], s64 offen lds
v_mfma_f32_16x16x32_bf16 a[4:7], a[152:155], v[168:171], a[4:7]
s_add_u32 m0, s86, 136192
ds_read_b128 a[180:183], v3 offset:12288
v_cvt_pk_bf16_f32 v164, v112, v113
v_mfma_f32_16x16x32_bf16 a[8:11], a[160:163], v[168:171], a[8:11]
s_add_u32 s64, s85, 40960
v_exp_f32 v145, v145
v_mfma_f32_16x16x32_bf16 a[8:11], a[164:167], v[172:175], a[8:11]
buffer_load_dwordx4 v13, s[36:39], s64 offen lds
v_mfma_f32_16x16x32_bf16 a[40:43], a[164:167], v[180:183], a[40:43]
ds_read_b128 a[184:187], v3 offset:5120
v_cvt_pk_bf16_f32 v165, v114, v115
v_mfma_f32_16x16x32_bf16 a[40:43], a[160:163], v[176:179], a[40:43]
ds_read_b128 a[188:191], v3 offset:13312
v_cvt_pk_bf16_f32 v188, v128, v129
v_mfma_f32_16x16x32_bf16 a[72:75], a[160:163], v[200:203], a[72:75]
ds_read_b128 a[192:195], v3 offset:6144
v_cvt_pk_bf16_f32 v189, v130, v131
v_mfma_f32_16x16x32_bf16 a[72:75], a[164:167], v[204:207], a[72:75]
ds_read_b128 a[196:199], v3 offset:14336
v_cvt_pk_bf16_f32 v196, v144, v145
v_mfma_f32_16x16x32_bf16 a[104:107], a[164:167], v[212:215], a[104:107]
ds_read_b128 a[200:203], v3 offset:7168
v_mfma_f32_16x16x32_bf16 a[104:107], a[160:163], v[208:211], a[104:107]
s_waitcnt lgkmcnt(5)
s_add_u32 m0, s86, 137216
ds_read_b128 a[204:207], v3 offset:15360
v_mfma_f32_16x16x32_bf16 a[108:111], a[168:171], v[208:211], a[108:111]
s_add_u32 s64, s85, 49152
v_exp_f32 v146, v146
v_mfma_f32_16x16x32_bf16 a[108:111], a[172:175], v[212:215], a[108:111]
buffer_load_dwordx4 v12, s[36:39], s64 offen lds
v_mfma_f32_16x16x32_bf16 a[76:79], a[172:175], v[204:207], a[76:79]
s_add_u32 m0, s86, 138240
v_exp_f32 v147, v147
v_mfma_f32_16x16x32_bf16 a[76:79], a[168:171], v[200:203], a[76:79]
s_add_u32 s64, s85, 57344
v_exp_f32 v148, v148
v_mfma_f32_16x16x32_bf16 a[44:47], a[168:171], v[176:179], a[44:47]
buffer_load_dwordx4 v13, s[36:39], s64 offen lds
v_mfma_f32_16x16x32_bf16 a[44:47], a[172:175], v[180:183], a[44:47]
s_waitcnt vmcnt(16)
s_barrier
v_mfma_f32_16x16x32_bf16 a[12:15], a[172:175], v[172:175], a[12:15]
s_xor_b32 s71, s71, 16384
v_exp_f32 v149, v149
v_mfma_f32_16x16x32_bf16 a[12:15], a[168:171], v[168:171], a[12:15]
s_add_u32 s70, s70, 32768
v_exp_f32 v150, v150
v_mfma_f32_16x16x32_bf16 a[16:19], a[176:179], v[168:171], a[16:19]
s_mov_b32 m0, s71
v_exp_f32 v151, v151
v_mfma_f32_16x16x32_bf16 a[16:19], a[180:183], v[172:175], a[16:19]
buffer_load_dwordx4 v16, s[32:35], s70 offen offset:0 sc1 lds
v_mfma_f32_16x16x32_bf16 a[48:51], a[180:183], v[180:183], a[48:51]
v_exp_f32 v132, v132
v_mfma_f32_16x16x32_bf16 a[48:51], a[176:179], v[176:179], a[48:51]
v_exp_f32 v133, v133
v_mfma_f32_16x16x32_bf16 a[80:83], a[176:179], v[200:203], a[80:83]
v_exp_f32 v134, v134
v_mfma_f32_16x16x32_bf16 a[80:83], a[180:183], v[204:207], a[80:83]
v_exp_f32 v135, v135
v_mfma_f32_16x16x32_bf16 a[112:115], a[180:183], v[212:215], a[112:115]
v_exp_f32 v116, v116
v_mfma_f32_16x16x32_bf16 a[112:115], a[176:179], v[208:211], a[112:115]
s_waitcnt lgkmcnt(0)
v_cvt_pk_bf16_f32 v197, v146, v147
v_cvt_pk_bf16_f32 v198, v148, v149
v_mfma_f32_16x16x32_bf16 a[116:119], a[184:187], v[208:211], a[116:119]
v_exp_f32 v117, v117
v_mfma_f32_16x16x32_bf16 a[116:119], a[188:191], v[212:215], a[116:119]
v_exp_f32 v118, v118
v_mfma_f32_16x16x32_bf16 a[84:87], a[188:191], v[204:207], a[84:87]
v_exp_f32 v119, v119
v_mfma_f32_16x16x32_bf16 a[84:87], a[184:187], v[200:203], a[84:87]
v_exp_f32 v100, v100
v_mfma_f32_16x16x32_bf16 a[52:55], a[184:187], v[176:179], a[52:55]
v_exp_f32 v101, v101
v_mfma_f32_16x16x32_bf16 a[52:55], a[188:191], v[180:183], a[52:55]
ds_read_b128 a[144:147], v2 offset:16384
v_cvt_pk_bf16_f32 v199, v150, v151
v_mfma_f32_16x16x32_bf16 a[20:23], a[188:191], v[172:175], a[20:23]
ds_read_b128 a[148:151], v2 offset:17408
v_cvt_pk_bf16_f32 v190, v132, v133
v_mfma_f32_16x16x32_bf16 a[20:23], a[184:187], v[168:171], a[20:23]
v_exp_f32 v102, v102
v_mfma_f32_16x16x32_bf16 a[24:27], a[192:195], v[168:171], a[24:27]
buffer_load_dwordx4 v16, s[32:35], s70 offen offset:1024 sc1 lds
v_mfma_f32_16x16x32_bf16 a[24:27], a[196:199], v[172:175], a[24:27]
ds_read_b128 a[152:155], v2 offset:18432
v_cvt_pk_bf16_f32 v191, v134, v135
v_mfma_f32_16x16x32_bf16 a[56:59], a[196:199], v[180:183], a[56:59]
ds_read_b128 a[156:159], v2 offset:19456
v_cvt_pk_bf16_f32 v166, v116, v117
v_mfma_f32_16x16x32_bf16 a[56:59], a[192:195], v[176:179], a[56:59]
v_exp_f32 v103, v103
v_mfma_f32_16x16x32_bf16 a[88:91], a[192:195], v[200:203], a[88:91]
ds_read_b128 a[160:163], v2 offset:20480
v_cvt_pk_bf16_f32 v167, v118, v119
v_mfma_f32_16x16x32_bf16 a[88:91], a[196:199], v[204:207], a[88:91]
ds_read_b128 a[164:167], v2 offset:21504
v_cvt_pk_bf16_f32 v158, v100, v101
v_mfma_f32_16x16x32_bf16 a[120:123], a[196:199], v[212:215], a[120:123]
ds_read_b128 a[168:171], v2 offset:22528
v_cvt_pk_bf16_f32 v159, v102, v103
v_mfma_f32_16x16x32_bf16 a[120:123], a[192:195], v[208:211], a[120:123]
ds_read_b128 a[172:175], v2 offset:23552
v_cndmask_b32 v104, v220, v17, s[0:1]
v_mfma_f32_16x16x32_bf16 a[124:127], a[200:203], v[208:211], a[124:127]
v_cndmask_b32 v105, v220, v17, s[4:5]
v_cndmask_b32 v106, v220, v17, s[6:7]
v_mfma_f32_16x16x32_bf16 a[124:127], a[204:207], v[212:215], a[124:127]
v_cndmask_b32 v107, v220, v17, s[8:9]
v_cndmask_b32 v108, v220, v17, s[10:11]
v_mfma_f32_16x16x32_bf16 a[92:95], a[204:207], v[204:207], a[92:95]
v_cndmask_b32 v109, v220, v17, s[12:13]
v_cndmask_b32 v110, v220, v17, s[18:19]
v_mfma_f32_16x16x32_bf16 a[92:95], a[200:203], v[200:203], a[92:95]
v_cndmask_b32 v111, v220, v17, s[22:23]
v_cndmask_b32 v112, v220, v17, s[26:27]
v_mfma_f32_16x16x32_bf16 a[60:63], a[200:203], v[176:179], a[60:63]
v_cndmask_b32 v113, v220, v17, s[56:57]
v_cndmask_b32 v114, v220, v17, s[58:59]
v_mfma_f32_16x16x32_bf16 a[60:63], a[204:207], v[180:183], a[60:63]
v_cndmask_b32 v115, v220, v17, s[60:61]
v_cndmask_b32 v116, v220, v17, s[62:63]
v_mfma_f32_16x16x32_bf16 a[28:31], a[204:207], v[172:175], a[28:31]
v_cndmask_b32 v117, v220, v17, s[48:49]
v_cndmask_b32 v118, v220, v17, s[50:51]
v_mfma_f32_16x16x32_bf16 a[28:31], a[200:203], v[168:171], a[28:31]
s_waitcnt lgkmcnt(0)
v_cndmask_b32 v119, v220, v17, s[100:101]
v_mfma_f32_16x16x32_bf16 v[120:123], a[144:147], v[56:59], v[224:227]
ds_read_b128 a[176:179], v2 offset:24576
v_mfma_f32_16x16x32_bf16 v[120:123], a[148:151], v[60:63], v[120:123]
ds_read_b128 a[180:183], v2 offset:25600
v_mfma_f32_16x16x32_bf16 v[120:123], a[152:155], v[64:67], v[120:123]
buffer_load_dwordx4 v16, s[32:35], s70 offen offset:2048 sc1 lds
v_mfma_f32_16x16x32_bf16 v[120:123], a[156:159], v[68:71], v[120:123]
ds_read_b128 a[184:187], v2 offset:26624
v_mfma_f32_16x16x32_bf16 v[136:139], a[156:159], v[84:87], v[228:231]
ds_read_b128 a[188:191], v2 offset:27648
v_mfma_f32_16x16x32_bf16 v[136:139], a[152:155], v[80:83], v[136:139]
v_mfma_f32_16x16x32_bf16 v[136:139], a[148:151], v[76:79], v[136:139]
v_mfma_f32_16x16x32_bf16 v[136:139], a[144:147], v[72:75], v[136:139]
v_mfma_f32_16x16x32_bf16 v[104:107], a[144:147], v[40:43], v[104:107]
ds_read_b128 a[192:195], v2 offset:28672
v_mfma_f32_16x16x32_bf16 v[104:107], a[148:151], v[44:47], v[104:107]
v_mfma_f32_16x16x32_bf16 v[104:107], a[152:155], v[48:51], v[104:107]
v_exp_f32 v120, v120
v_mfma_f32_16x16x32_bf16 v[104:107], a[156:159], v[52:55], v[104:107]
v_exp_f32 v121, v121
v_mfma_f32_16x16x32_bf16 v[140:143], a[172:175], v[84:87], v[228:231]
v_exp_f32 v122, v122
v_mfma_f32_16x16x32_bf16 v[140:143], a[168:171], v[80:83], v[140:143]
v_exp_f32 v123, v123
v_mfma_f32_16x16x32_bf16 v[140:143], a[164:167], v[76:79], v[140:143]
v_exp_f32 v136, v136
v_mfma_f32_16x16x32_bf16 v[140:143], a[160:163], v[72:75], v[140:143]
buffer_load_dwordx4 v16, s[32:35], s70 offen offset:3072 sc1 lds
v_mfma_f32_16x16x32_bf16 v[124:127], a[160:163], v[56:59], v[224:227]
v_exp_f32 v137, v137
v_mfma_f32_16x16x32_bf16 v[124:127], a[164:167], v[60:63], v[124:127]
v_exp_f32 v138, v138
v_mfma_f32_16x16x32_bf16 v[124:127], a[168:171], v[64:67], v[124:127]
v_exp_f32 v139, v139
v_mfma_f32_16x16x32_bf16 v[124:127], a[172:175], v[68:71], v[124:127]
v_exp_f32 v104, v104
v_mfma_f32_16x16x32_bf16 v[108:111], a[172:175], v[52:55], v[108:111]
v_cvt_pk_bf16_f32 v200, v120, v121
v_cvt_pk_bf16_f32 v201, v122, v123
v_mfma_f32_16x16x32_bf16 v[108:111], a[168:171], v[48:51], v[108:111]
ds_read_b128 a[196:199], v2 offset:29696
v_cvt_pk_bf16_f32 v208, v136, v137
v_mfma_f32_16x16x32_bf16 v[108:111], a[164:167], v[44:47], v[108:111]
ds_read_b128 a[200:203], v2 offset:30720
v_cvt_pk_bf16_f32 v209, v138, v139
v_mfma_f32_16x16x32_bf16 v[108:111], a[160:163], v[40:43], v[108:111]
s_waitcnt lgkmcnt(2)
ds_read_b128 a[204:207], v2 offset:31744
v_mfma_f32_16x16x32_bf16 v[112:115], a[176:179], v[40:43], v[112:115]
v_exp_f32 v105, v105
v_mfma_f32_16x16x32_bf16 v[112:115], a[180:183], v[44:47], v[112:115]
v_exp_f32 v106, v106
v_mfma_f32_16x16x32_bf16 v[112:115], a[184:187], v[48:51], v[112:115]
s_branch L_po17
L_pg17:
s_branch L_pg21
L_po17:
v_exp_f32 v107, v107
v_mfma_f32_16x16x32_bf16 v[112:115], a[188:191], v[52:55], v[112:115]
s_add_u32 m0, s71, 4096
v_exp_f32 v140, v140
v_mfma_f32_16x16x32_bf16 v[128:131], a[188:191], v[68:71], v[224:227]
s_add_u32 s64, s70, 4096
v_exp_f32 v141, v141
v_mfma_f32_16x16x32_bf16 v[128:131], a[184:187], v[64:67], v[128:131]
buffer_load_dwordx4 v16, s[32:35], s64 offen offset:0 sc1 lds
v_mfma_f32_16x16x32_bf16 v[128:131], a[180:183], v[60:63], v[128:131]
v_exp_f32 v142, v142
v_mfma_f32_16x16x32_bf16 v[128:131], a[176:179], v[56:59], v[128:131]
v_exp_f32 v143, v143
v_mfma_f32_16x16x32_bf16 v[144:147], a[176:179], v[72:75], v[228:231]
ds_read_b128 a[144:147], v3 offset:16384
v_cvt_pk_bf16_f32 v176, v104, v105
v_mfma_f32_16x16x32_bf16 v[144:147], a[180:183], v[76:79], v[144:147]
ds_read_b128 a[148:151], v3 offset:24576
v_cvt_pk_bf16_f32 v177, v106, v107
v_mfma_f32_16x16x32_bf16 v[144:147], a[184:187], v[80:83], v[144:147]
v_exp_f32 v124, v124
v_mfma_f32_16x16x32_bf16 v[144:147], a[188:191], v[84:87], v[144:147]
s_waitcnt lgkmcnt(2)
v_exp_f32 v125, v125
v_mfma_f32_16x16x32_bf16 v[148:151], a[204:207], v[84:87], v[228:231]
v_exp_f32 v126, v126
v_mfma_f32_16x16x32_bf16 v[148:151], a[200:203], v[80:83], v[148:151]
v_exp_f32 v127, v127
v_mfma_f32_16x16x32_bf16 v[148:151], a[196:199], v[76:79], v[148:151]
ds_read_b128 a[152:155], v3 offset:17408
v_cvt_pk_bf16_f32 v210, v140, v141
v_mfma_f32_16x16x32_bf16 v[148:151], a[192:195], v[72:75], v[148:151]
ds_read_b128 a[156:159], v3 offset:25600
v_cvt_pk_bf16_f32 v211, v142, v143
v_mfma_f32_16x16x32_bf16 v[132:135], a[192:195], v[56:59], v[224:227]
v_exp_f32 v108, v108
v_mfma_f32_16x16x32_bf16 v[132:135], a[196:199], v[60:63], v[132:135]
v_exp_f32 v109, v109
v_mfma_f32_16x16x32_bf16 v[132:135], a[200:203], v[64:67], v[132:135]
buffer_load_dwordx4 v16, s[32:35], s64 offen offset:1024 sc1 lds
v_mfma_f32_16x16x32_bf16 v[132:135], a[204:207], v[68:71], v[132:135]
v_exp_f32 v110, v110
v_mfma_f32_16x16x32_bf16 v[116:119], a[204:207], v[52:55], v[116:119]
ds_read_b128 a[160:163], v3 offset:18432
v_cvt_pk_bf16_f32 v202, v124, v125
v_mfma_f32_16x16x32_bf16 v[116:119], a[200:203], v[48:51], v[116:119]
v_exp_f32 v111, v111
v_mfma_f32_16x16x32_bf16 v[116:119], a[196:199], v[44:47], v[116:119]
ds_read_b128 a[164:167], v3 offset:26624
v_cvt_pk_bf16_f32 v203, v126, v127
v_mfma_f32_16x16x32_bf16 v[116:119], a[192:195], v[40:43], v[116:119]
v_exp_f32 v112, v112
v_smfmac_f32_16x16x64_bf16 a[128:131], a[240:243], v[152:159], v5
ds_read_b128 a[168:171], v3 offset:19456
v_smfmac_f32_16x16x64_bf16 a[132:135], a[240:243], v[160:167], v5
ds_read_b128 a[172:175], v3 offset:27648
v_smfmac_f32_16x16x64_bf16 a[136:139], a[240:243], v[184:191], v5
ds_read_b128 a[176:179], v3 offset:20480
v_smfmac_f32_16x16x64_bf16 a[140:143], a[240:243], v[192:199], v5
s_waitcnt lgkmcnt(4)
ds_read_b128 a[180:183], v3 offset:28672
v_xor_b32 v2, 0x8000, v2
v_mfma_f32_16x16x32_bf16 a[0:3], a[144:147], v[152:155], a[0:3]
v_exp_f32 v113, v113
v_mfma_f32_16x16x32_bf16 a[0:3], a[148:151], v[156:159], a[0:3]
v_exp_f32 v114, v114
v_mfma_f32_16x16x32_bf16 a[32:35], a[148:151], v[164:167], a[32:35]
v_exp_f32 v115, v115
v_mfma_f32_16x16x32_bf16 a[32:35], a[144:147], v[160:163], a[32:35]
v_exp_f32 v128, v128
v_mfma_f32_16x16x32_bf16 a[64:67], a[144:147], v[184:187], a[64:67]
buffer_load_dwordx4 v16, s[32:35], s64 offen offset:2048 sc1 lds
v_mfma_f32_16x16x32_bf16 a[64:67], a[148:151], v[188:191], a[64:67]
v_exp_f32 v129, v129
v_mfma_f32_16x16x32_bf16 a[96:99], a[148:151], v[196:199], a[96:99]
v_exp_f32 v130, v130
v_mfma_f32_16x16x32_bf16 a[96:99], a[144:147], v[192:195], a[96:99]
v_exp_f32 v131, v131
v_mfma_f32_16x16x32_bf16 a[100:103], a[152:155], v[192:195], a[100:103]
v_exp_f32 v144, v144
v_mfma_f32_16x16x32_bf16 a[100:103], a[156:159], v[196:199], a[100:103]
v_exp_f32 v145, v145
v_mfma_f32_16x16x32_bf16 a[68:71], a[156:159], v[188:191], a[68:71]
ds_read_b128 a[184:187], v3 offset:21504
v_cvt_pk_bf16_f32 v178, v108, v109
v_mfma_f32_16x16x32_bf16 a[68:71], a[152:155], v[184:187], a[68:71]
ds_read_b128 a[188:191], v3 offset:29696
v_cvt_pk_bf16_f32 v179, v110, v111
v_mfma_f32_16x16x32_bf16 a[36:39], a[152:155], v[160:163], a[36:39]
ds_read_b128 a[192:195], v3 offset:22528
v_cvt_pk_bf16_f32 v180, v112, v113
v_mfma_f32_16x16x32_bf16 a[36:39], a[156:159], v[164:167], a[36:39]
v_exp_f32 v146, v146
v_mfma_f32_16x16x32_bf16 a[4:7], a[156:159], v[156:159], a[4:7]
v_exp_f32 v147, v147
v_mfma_f32_16x16x32_bf16 a[4:7], a[152:155], v[152:155], a[4:7]
v_exp_f32 v148, v148
v_mfma_f32_16x16x32_bf16 a[8:11], a[160:163], v[152:155], a[8:11]
s_waitcnt lgkmcnt(2)
ds_read_b128 a[196:199], v3 offset:30720
v_cvt_pk_bf16_f32 v181, v114, v115
v_mfma_f32_16x16x32_bf16 a[8:11], a[164:167], v[156:159], a[8:11]
buffer_load_dwordx4 v16, s[32:35], s64 offen offset:3072 sc1 lds
v_mfma_f32_16x16x32_bf16 a[40:43], a[164:167], v[164:167], a[40:43]
v_exp_f32 v149, v149
v_mfma_f32_16x16x32_bf16 a[40:43], a[160:163], v[160:163], a[40:43]
ds_read_b128 a[200:203], v3 offset:23552
v_cvt_pk_bf16_f32 v204, v128, v129
v_mfma_f32_16x16x32_bf16 a[72:75], a[160:163], v[184:187], a[72:75]
v_exp_f32 v150, v150
v_mfma_f32_16x16x32_bf16 a[72:75], a[164:167], v[188:191], a[72:75]
v_exp_f32 v151, v151
v_mfma_f32_16x16x32_bf16 a[104:107], a[164:167], v[196:199], a[104:107]
v_exp_f32 v132, v132
v_mfma_f32_16x16x32_bf16 a[104:107], a[160:163], v[192:195], a[104:107]
ds_read_b128 a[204:207], v3 offset:31744
v_cvt_pk_bf16_f32 v205, v130, v131
v_mfma_f32_16x16x32_bf16 a[108:111], a[168:171], v[192:195], a[108:111]
v_exp_f32 v133, v133
v_mfma_f32_16x16x32_bf16 a[108:111], a[172:175], v[196:199], a[108:111]
v_exp_f32 v134, v134
v_mfma_f32_16x16x32_bf16 a[76:79], a[172:175], v[188:191], a[76:79]
v_exp_f32 v135, v135
v_mfma_f32_16x16x32_bf16 a[76:79], a[168:171], v[184:187], a[76:79]
v_exp_f32 v116, v116
v_mfma_f32_16x16x32_bf16 a[44:47], a[168:171], v[160:163], a[44:47]
v_exp_f32 v117, v117
v_mfma_f32_16x16x32_bf16 a[44:47], a[172:175], v[164:167], a[44:47]
v_exp_f32 v118, v118
v_mfma_f32_16x16x32_bf16 a[12:15], a[172:175], v[156:159], a[12:15]
v_exp_f32 v119, v119
v_mfma_f32_16x16x32_bf16 a[12:15], a[168:171], v[152:155], a[12:15]
v_cvt_pk_bf16_f32 v212, v144, v145
v_cvt_pk_bf16_f32 v213, v146, v147
v_mfma_f32_16x16x32_bf16 a[16:19], a[176:179], v[152:155], a[16:19]
v_cvt_pk_bf16_f32 v214, v148, v149
v_cvt_pk_bf16_f32 v215, v150, v151
v_mfma_f32_16x16x32_bf16 a[16:19], a[180:183], v[156:159], a[16:19]
s_waitcnt vmcnt(12)
s_barrier
v_mfma_f32_16x16x32_bf16 a[48:51], a[180:183], v[164:167], a[48:51]
s_xor_b32 s71, s71, 49152
ds_read_b128 a[144:147], v2 offset:0
v_cvt_pk_bf16_f32 v206, v132, v133
v_mfma_f32_16x16x32_bf16 a[48:51], a[176:179], v[160:163], a[48:51]
s_add_u32 s70, s70, 32768
ds_read_b128 a[148:151], v2 offset:1024
v_cvt_pk_bf16_f32 v207, v134, v135
v_mfma_f32_16x16x32_bf16 a[80:83], a[176:179], v[184:187], a[80:83]
s_mov_b32 m0, s71
ds_read_b128 a[152:155], v2 offset:2048
v_cvt_pk_bf16_f32 v182, v116, v117
v_mfma_f32_16x16x32_bf16 a[80:83], a[180:183], v[188:191], a[80:83]
buffer_load_dwordx4 v16, s[32:35], s70 offen offset:0 sc1 lds
v_mfma_f32_16x16x32_bf16 a[112:115], a[180:183], v[196:199], a[112:115]
ds_read_b128 a[156:159], v2 offset:3072
v_cvt_pk_bf16_f32 v183, v118, v119
v_mfma_f32_16x16x32_bf16 a[112:115], a[176:179], v[192:195], a[112:115]
ds_read_b128 a[160:163], v2 offset:4096
v_xor_b32 v3, 0x8000, v3
v_mfma_f32_16x16x32_bf16 a[116:119], a[184:187], v[192:195], a[116:119]
s_waitcnt lgkmcnt(4)
ds_read_b128 a[164:167], v2 offset:5120
v_accvgpr_read_b32 v20, a128
v_mfma_f32_16x16x32_bf16 a[116:119], a[188:191], v[196:199], a[116:119]
ds_read_b128 a[168:171], v2 offset:6144
v_accvgpr_read_b32 v248, a129
v_mfma_f32_16x16x32_bf16 a[84:87], a[188:191], v[188:191], a[84:87]
ds_read_b128 a[172:175], v2 offset:7168
v_add_f32 v20, v20, v248
v_mfma_f32_16x16x32_bf16 a[84:87], a[184:187], v[184:187], a[84:87]
v_max_f32 v1, v1, v20
v_mfma_f32_16x16x32_bf16 a[52:55], a[184:187], v[160:163], a[52:55]
v_rcp_f32 v20, v20
v_mfma_f32_16x16x32_bf16 a[52:55], a[188:191], v[164:167], a[52:55]
v_accvgpr_read_b32 v232, a0
v_accvgpr_read_b32 v233, a1
v_mfma_f32_16x16x32_bf16 a[20:23], a[188:191], v[156:159], a[20:23]
v_accvgpr_read_b32 v234, a2
v_accvgpr_read_b32 v235, a3
v_mfma_f32_16x16x32_bf16 a[20:23], a[184:187], v[152:155], a[20:23]
v_accvgpr_read_b32 v236, a4
v_accvgpr_read_b32 v237, a5
v_mfma_f32_16x16x32_bf16 a[24:27], a[192:195], v[152:155], a[24:27]
v_accvgpr_read_b32 v238, a6
v_accvgpr_read_b32 v239, a7
v_mfma_f32_16x16x32_bf16 a[24:27], a[196:199], v[156:159], a[24:27]
v_mul_f32 v20, v20, v4
v_mul_f32 v232, v232, v20
v_mfma_f32_16x16x32_bf16 a[56:59], a[196:199], v[164:167], a[56:59]
buffer_load_dwordx4 v16, s[32:35], s70 offen offset:1024 sc1 lds
v_mfma_f32_16x16x32_bf16 a[56:59], a[192:195], v[160:163], a[56:59]
v_mul_f32 v233, v233, v20
v_mul_f32 v234, v234, v20
v_mfma_f32_16x16x32_bf16 a[88:91], a[192:195], v[184:187], a[88:91]
v_mul_f32 v235, v235, v20
v_mul_f32 v236, v236, v20
v_mfma_f32_16x16x32_bf16 a[88:91], a[196:199], v[188:191], a[88:91]
v_mul_f32 v237, v237, v20
v_mul_f32 v238, v238, v20
v_mfma_f32_16x16x32_bf16 a[120:123], a[196:199], v[196:199], a[120:123]
v_mul_f32 v239, v239, v20
v_cvt_pk_bf16_f32 v232, v232, v233
v_mfma_f32_16x16x32_bf16 a[120:123], a[192:195], v[192:195], a[120:123]
v_cvt_pk_bf16_f32 v233, v234, v235
v_cvt_pk_bf16_f32 v234, v236, v237
v_mfma_f32_16x16x32_bf16 a[124:127], a[200:203], v[192:195], a[124:127]
v_cvt_pk_bf16_f32 v235, v238, v239
v_mfma_f32_16x16x32_bf16 a[124:127], a[204:207], v[196:199], a[124:127]
s_add_u32 s77, s74, 0
buffer_store_dwordx4 v[232:235], v16, s[44:47], s77 offen sc1
v_mfma_f32_16x16x32_bf16 a[92:95], a[204:207], v[188:191], a[92:95]
v_accvgpr_read_b32 v240, a8
v_accvgpr_read_b32 v241, a9
v_mfma_f32_16x16x32_bf16 a[92:95], a[200:203], v[184:187], a[92:95]
v_accvgpr_read_b32 v242, a10
v_accvgpr_read_b32 v243, a11
v_mfma_f32_16x16x32_bf16 a[60:63], a[200:203], v[160:163], a[60:63]
v_accvgpr_read_b32 v244, a12
v_accvgpr_read_b32 v245, a13
v_mfma_f32_16x16x32_bf16 a[60:63], a[204:207], v[164:167], a[60:63]
v_accvgpr_read_b32 v246, a14
v_accvgpr_read_b32 v247, a15
v_mfma_f32_16x16x32_bf16 a[28:31], a[204:207], v[156:159], a[28:31]
v_mul_f32 v240, v240, v20
v_mul_f32 v241, v241, v20
v_mfma_f32_16x16x32_bf16 a[28:31], a[200:203], v[152:155], a[28:31]
v_mul_f32 v242, v242, v20
v_mul_f32 v243, v243, v20
v_mul_f32 v244, v244, v20
v_mul_f32 v245, v245, v20
v_mul_f32 v246, v246, v20
v_mul_f32 v247, v247, v20
v_cvt_pk_bf16_f32 v240, v240, v241
v_cvt_pk_bf16_f32 v241, v242, v243
v_cvt_pk_bf16_f32 v242, v244, v245
v_cvt_pk_bf16_f32 v243, v246, v247
s_add_u32 s77, s74, 8192
buffer_store_dwordx4 v[240:243], v16, s[44:47], s77 offen sc1
v_accvgpr_read_b32 v232, a16
v_accvgpr_read_b32 v233, a17
v_accvgpr_read_b32 v234, a18
v_accvgpr_read_b32 v235, a19
v_accvgpr_read_b32 v236, a20
v_accvgpr_read_b32 v237, a21
v_accvgpr_read_b32 v238, a22
v_accvgpr_read_b32 v239, a23
v_mul_f32 v232, v232, v20
v_mul_f32 v233, v233, v20
v_mul_f32 v234, v234, v20
v_mul_f32 v235, v235, v20
v_mul_f32 v236, v236, v20
v_mul_f32 v237, v237, v20
v_mul_f32 v238, v238, v20
v_mul_f32 v239, v239, v20
v_cvt_pk_bf16_f32 v232, v232, v233
v_cvt_pk_bf16_f32 v233, v234, v235
v_cvt_pk_bf16_f32 v234, v236, v237
v_cvt_pk_bf16_f32 v235, v238, v239
s_add_u32 s77, s74, 16384
buffer_store_dwordx4 v[232:235], v16, s[44:47], s77 offen sc1
s_cmp_eq_u32 s3, 7
s_cbranch_scc1 L_T1
L_T:
s_waitcnt lgkmcnt(7)
v_mfma_f32_16x16x32_bf16 v[120:123], a[144:147], v[56:59], v[224:227]
s_waitcnt lgkmcnt(6)
ds_read_b128 a[176:179], v2 offset:8192
v_mfma_f32_16x16x32_bf16 v[120:123], a[148:151], v[60:63], v[120:123]
s_waitcnt lgkmcnt(6)
ds_read_b128 a[180:183], v2 offset:9216
v_mfma_f32_16x16x32_bf16 v[120:123], a[152:155], v[64:67], v[120:123]
s_waitcnt lgkmcnt(6)
buffer_load_dwordx4 v16, s[32:35], s70 offen offset:2048 sc1 lds
v_mfma_f32_16x16x32_bf16 v[120:123], a[156:159], v[68:71], v[120:123]
ds_read_b128 a[184:187], v2 offset:10240
v_mfma_f32_16x16x32_bf16 v[136:139], a[156:159], v[84:87], v[228:231]
ds_read_b128 a[188:191], v2 offset:11264
v_mfma_f32_16x16x32_bf16 v[136:139], a[152:155], v[80:83], v[136:139]
ds_read_b128 a[192:195], v2 offset:12288
v_mfma_f32_16x16x32_bf16 v[136:139], a[148:151], v[76:79], v[136:139]
ds_read_b128 a[196:199], v2 offset:13312
v_mfma_f32_16x16x32_bf16 v[136:139], a[144:147], v[72:75], v[136:139]
s_waitcnt lgkmcnt(4)
v_mfma_f32_16x16x32_bf16 v[140:143], a[160:163], v[72:75], v[228:231]
ds_read_b128 a[200:203], v2 offset:14336
v_accvgpr_read_b32 v240, a24
v_mfma_f32_16x16x32_bf16 v[140:143], a[164:167], v[76:79], v[140:143]
ds_read_b128 a[204:207], v2 offset:15360
v_accvgpr_read_b32 v241, a25
v_mfma_f32_16x16x32_bf16 v[140:143], a[168:171], v[80:83], v[140:143]
v_exp_f32 v120, v120
v_mfma_f32_16x16x32_bf16 v[140:143], a[172:175], v[84:87], v[140:143]
v_exp_f32 v121, v121
v_mfma_f32_16x16x32_bf16 v[124:127], a[172:175], v[68:71], v[224:227]
v_exp_f32 v122, v122
v_mfma_f32_16x16x32_bf16 v[124:127], a[168:171], v[64:67], v[124:127]
buffer_load_dwordx4 v16, s[32:35], s70 offen offset:3072 sc1 lds
v_mfma_f32_16x16x32_bf16 v[124:127], a[164:167], v[60:63], v[124:127]
v_exp_f32 v123, v123
v_mfma_f32_16x16x32_bf16 v[124:127], a[160:163], v[56:59], v[124:127]
v_exp_f32 v136, v136
v_mfma_f32_16x16x32_bf16 v[128:131], a[176:179], v[56:59], v[224:227]
v_exp_f32 v137, v137
v_mfma_f32_16x16x32_bf16 v[128:131], a[180:183], v[60:63], v[128:131]
s_waitcnt lgkmcnt(0)
v_exp_f32 v138, v138
v_mfma_f32_16x16x32_bf16 v[128:131], a[184:187], v[64:67], v[128:131]
v_exp_f32 v139, v139
v_mfma_f32_16x16x32_bf16 v[128:131], a[188:191], v[68:71], v[128:131]
s_add_u32 m0, s71, 4096
ds_read_b128 a[144:147], v3 offset:0
v_cvt_pk_bf16_f32 v184, v120, v121
v_mfma_f32_16x16x32_bf16 v[144:147], a[188:191], v[84:87], v[228:231]
s_add_u32 s64, s70, 4096
ds_read_b128 a[148:151], v3 offset:8192
v_cvt_pk_bf16_f32 v185, v122, v123
v_mfma_f32_16x16x32_bf16 v[144:147], a[184:187], v[80:83], v[144:147]
buffer_load_dwordx4 v16, s[32:35], s64 offen offset:0 sc1 lds
v_mfma_f32_16x16x32_bf16 v[144:147], a[180:183], v[76:79], v[144:147]
v_exp_f32 v140, v140
v_mfma_f32_16x16x32_bf16 v[144:147], a[176:179], v[72:75], v[144:147]
v_exp_f32 v141, v141
v_mfma_f32_16x16x32_bf16 v[148:151], a[192:195], v[72:75], v[228:231]
v_exp_f32 v142, v142
v_mfma_f32_16x16x32_bf16 v[148:151], a[196:199], v[76:79], v[148:151]
ds_read_b128 a[152:155], v3 offset:1024
v_cvt_pk_bf16_f32 v192, v136, v137
v_mfma_f32_16x16x32_bf16 v[148:151], a[200:203], v[80:83], v[148:151]
ds_read_b128 a[156:159], v3 offset:9216
v_cvt_pk_bf16_f32 v193, v138, v139
v_mfma_f32_16x16x32_bf16 v[148:151], a[204:207], v[84:87], v[148:151]
v_exp_f32 v143, v143
v_mfma_f32_16x16x32_bf16 v[132:135], a[204:207], v[68:71], v[224:227]
v_exp_f32 v124, v124
v_mfma_f32_16x16x32_bf16 v[132:135], a[200:203], v[64:67], v[132:135]
v_exp_f32 v125, v125
v_mfma_f32_16x16x32_bf16 v[132:135], a[196:199], v[60:63], v[132:135]
buffer_load_dwordx4 v16, s[32:35], s64 offen offset:1024 sc1 lds
v_mfma_f32_16x16x32_bf16 v[132:135], a[192:195], v[56:59], v[132:135]
ds_read_b128 a[160:163], v3 offset:2048
v_cvt_pk_bf16_f32 v194, v140, v141
v_smfmac_f32_16x16x64_bf16 a[132:135], a[240:243], v[176:183], v5
ds_read_b128 a[164:167], v3 offset:10240
v_smfmac_f32_16x16x64_bf16 a[136:139], a[240:243], v[200:207], v5
ds_read_b128 a[168:171], v3 offset:3072
v_accvgpr_read_b32 v242, a26
v_smfmac_f32_16x16x64_bf16 a[140:143], a[240:243], v[208:215], v5
s_waitcnt lgkmcnt(3)
ds_read_b128 a[172:175], v3 offset:11264
v_accvgpr_read_b32 v243, a27
v_mfma_f32_16x16x32_bf16 a[32:35], a[144:147], v[176:179], a[32:35]
ds_read_b128 a[176:179], v3 offset:4096
v_accvgpr_read_b32 v244, a28
v_mfma_f32_16x16x32_bf16 a[32:35], a[148:151], v[180:183], a[32:35]
ds_read_b128 a[180:183], v3 offset:12288
v_accvgpr_read_b32 v245, a29
v_mfma_f32_16x16x32_bf16 a[64:67], a[148:151], v[204:207], a[64:67]
ds_read_b128 a[184:187], v3 offset:5120
v_accvgpr_read_b32 v246, a30
v_mfma_f32_16x16x32_bf16 a[64:67], a[144:147], v[200:203], a[64:67]
ds_read_b128 a[188:191], v3 offset:13312
v_accvgpr_read_b32 v247, a31
v_mfma_f32_16x16x32_bf16 a[96:99], a[144:147], v[208:211], a[96:99]
ds_read_b128 a[192:195], v3 offset:6144
v_mul_f32 v240, v240, v20
v_mfma_f32_16x16x32_bf16 a[96:99], a[148:151], v[212:215], a[96:99]
ds_read_b128 a[196:199], v3 offset:14336
v_mul_f32 v241, v241, v20
v_mfma_f32_16x16x32_bf16 a[100:103], a[156:159], v[212:215], a[100:103]
ds_read_b128 a[200:203], v3 offset:7168
v_mul_f32 v242, v242, v20
v_mfma_f32_16x16x32_bf16 a[100:103], a[152:155], v[208:211], a[100:103]
ds_read_b128 a[204:207], v3 offset:15360
v_mul_f32 v243, v243, v20
v_mul_f32 v244, v244, v20
v_mul_f32 v245, v245, v20
v_mul_f32 v246, v246, v20
v_mul_f32 v247, v247, v20
v_cvt_pk_bf16_f32 v240, v240, v241
v_cvt_pk_bf16_f32 v241, v242, v243
v_cvt_pk_bf16_f32 v242, v244, v245
v_cvt_pk_bf16_f32 v243, v246, v247
s_add_u32 s77, s74, 24576
buffer_store_dwordx4 v[240:243], v16, s[44:47], s77 offen sc1
v_exp_f32 v126, v126
v_mfma_f32_16x16x32_bf16 a[68:71], a[152:155], v[200:203], a[68:71]
buffer_load_dwordx4 v16, s[32:35], s64 offen offset:2048 sc1 lds
v_cvt_pk_bf16_f32 v195, v142, v143
v_mfma_f32_16x16x32_bf16 a[68:71], a[156:159], v[204:207], a[68:71]
v_exp_f32 v127, v127
v_mfma_f32_16x16x32_bf16 a[36:39], a[156:159], v[180:183], a[36:39]
v_exp_f32 v128, v128
v_mfma_f32_16x16x32_bf16 a[36:39], a[152:155], v[176:179], a[36:39]
s_waitcnt lgkmcnt(2)
v_exp_f32 v129, v129
v_mfma_f32_16x16x32_bf16 a[40:43], a[160:163], v[176:179], a[40:43]
v_cvt_pk_bf16_f32 v186, v124, v125
v_cvt_pk_bf16_f32 v187, v126, v127
v_mfma_f32_16x16x32_bf16 a[40:43], a[164:167], v[180:183], a[40:43]
v_exp_f32 v130, v130
v_mfma_f32_16x16x32_bf16 a[72:75], a[164:167], v[204:207], a[72:75]
buffer_load_dwordx4 v16, s[32:35], s64 offen offset:3072 sc1 lds
v_mfma_f32_16x16x32_bf16 a[72:75], a[160:163], v[200:203], a[72:75]
v_exp_f32 v131, v131
v_mfma_f32_16x16x32_bf16 a[104:107], a[160:163], v[208:211], a[104:107]
v_exp_f32 v144, v144
v_mfma_f32_16x16x32_bf16 a[104:107], a[164:167], v[212:215], a[104:107]
v_exp_f32 v145, v145
v_mfma_f32_16x16x32_bf16 a[108:111], a[172:175], v[212:215], a[108:111]
v_exp_f32 v146, v146
v_mfma_f32_16x16x32_bf16 a[108:111], a[168:171], v[208:211], a[108:111]
v_exp_f32 v147, v147
v_mfma_f32_16x16x32_bf16 a[76:79], a[168:171], v[200:203], a[76:79]
v_exp_f32 v148, v148
v_mfma_f32_16x16x32_bf16 a[76:79], a[172:175], v[204:207], a[76:79]
v_exp_f32 v149, v149
v_mfma_f32_16x16x32_bf16 a[44:47], a[172:175], v[180:183], a[44:47]
v_cvt_pk_bf16_f32 v188, v128, v129
v_cvt_pk_bf16_f32 v189, v130, v131
v_mfma_f32_16x16x32_bf16 a[44:47], a[168:171], v[176:179], a[44:47]
v_exp_f32 v150, v150
v_mfma_f32_16x16x32_bf16 a[48:51], a[176:179], v[176:179], a[48:51]
v_exp_f32 v151, v151
v_mfma_f32_16x16x32_bf16 a[48:51], a[180:183], v[180:183], a[48:51]
v_exp_f32 v132, v132
v_mfma_f32_16x16x32_bf16 a[80:83], a[180:183], v[204:207], a[80:83]
s_waitcnt vmcnt(9)
s_barrier
v_mfma_f32_16x16x32_bf16 a[80:83], a[176:179], v[200:203], a[80:83]
s_xor_b32 s71, s71, 16384
v_exp_f32 v133, v133
v_mfma_f32_16x16x32_bf16 a[112:115], a[176:179], v[208:211], a[112:115]
s_add_u32 s70, s70, 32768
ds_read_b128 a[144:147], v2 offset:16384
v_cvt_pk_bf16_f32 v196, v144, v145
v_mfma_f32_16x16x32_bf16 a[112:115], a[180:183], v[212:215], a[112:115]
s_mov_b32 m0, s71
v_exp_f32 v134, v134
v_mfma_f32_16x16x32_bf16 a[116:119], a[188:191], v[212:215], a[116:119]
buffer_load_dwordx4 v16, s[32:35], s70 offen offset:0 sc1 lds
v_mfma_f32_16x16x32_bf16 a[116:119], a[184:187], v[208:211], a[116:119]
ds_read_b128 a[148:151], v2 offset:17408
v_cvt_pk_bf16_f32 v197, v146, v147
v_mfma_f32_16x16x32_bf16 a[84:87], a[184:187], v[200:203], a[84:87]
ds_read_b128 a[152:155], v2 offset:18432
v_cvt_pk_bf16_f32 v198, v148, v149
v_mfma_f32_16x16x32_bf16 a[84:87], a[188:191], v[204:207], a[84:87]
ds_read_b128 a[156:159], v2 offset:19456
v_cvt_pk_bf16_f32 v199, v150, v151
v_mfma_f32_16x16x32_bf16 a[52:55], a[188:191], v[180:183], a[52:55]
v_exp_f32 v135, v135
v_mfma_f32_16x16x32_bf16 a[52:55], a[184:187], v[176:179], a[52:55]
ds_read_b128 a[160:163], v2 offset:20480
v_cvt_pk_bf16_f32 v190, v132, v133
v_mfma_f32_16x16x32_bf16 a[56:59], a[192:195], v[176:179], a[56:59]
ds_read_b128 a[164:167], v2 offset:21504
v_cvt_pk_bf16_f32 v191, v134, v135
v_mfma_f32_16x16x32_bf16 a[56:59], a[196:199], v[180:183], a[56:59]
ds_read_b128 a[168:171], v2 offset:22528
v_accvgpr_read_b32 v21, a132
v_mfma_f32_16x16x32_bf16 a[88:91], a[196:199], v[204:207], a[88:91]
ds_read_b128 a[172:175], v2 offset:23552
v_accvgpr_read_b32 v248, a133
v_mfma_f32_16x16x32_bf16 a[88:91], a[192:195], v[200:203], a[88:91]
buffer_load_dwordx4 v16, s[32:35], s70 offen offset:1024 sc1 lds
v_mfma_f32_16x16x32_bf16 a[120:123], a[192:195], v[208:211], a[120:123]
v_add_f32 v21, v21, v248
v_max_f32 v1, v1, v21
v_mfma_f32_16x16x32_bf16 a[120:123], a[196:199], v[212:215], a[120:123]
s_waitcnt lgkmcnt(3)
v_rcp_f32 v21, v21
v_mfma_f32_16x16x32_bf16 a[124:127], a[204:207], v[212:215], a[124:127]
v_accvgpr_read_b32 v232, a32
v_accvgpr_read_b32 v233, a33
v_mfma_f32_16x16x32_bf16 a[124:127], a[200:203], v[208:211], a[124:127]
v_accvgpr_read_b32 v234, a34
v_accvgpr_read_b32 v235, a35
v_mfma_f32_16x16x32_bf16 a[92:95], a[200:203], v[200:203], a[92:95]
v_accvgpr_read_b32 v236, a36
v_accvgpr_read_b32 v237, a37
v_mfma_f32_16x16x32_bf16 a[92:95], a[204:207], v[204:207], a[92:95]
v_accvgpr_read_b32 v238, a38
v_accvgpr_read_b32 v239, a39
v_mfma_f32_16x16x32_bf16 a[60:63], a[204:207], v[180:183], a[60:63]
v_mul_f32 v21, v21, v6
v_mul_f32 v232, v232, v21
v_mfma_f32_16x16x32_bf16 a[60:63], a[200:203], v[176:179], a[60:63]
v_mul_f32 v233, v233, v21
v_mul_f32 v234, v234, v21
v_mfma_f32_16x16x32_bf16 v[120:123], a[144:147], v[56:59], v[224:227]
ds_read_b128 a[176:179], v2 offset:24576
ds_read_b128 a[180:183], v2 offset:25600
v_mfma_f32_16x16x32_bf16 v[120:123], a[148:151], v[60:63], v[120:123]
buffer_load_dwordx4 v16, s[32:35], s70 offen offset:2048 sc1 lds
v_mfma_f32_16x16x32_bf16 v[120:123], a[152:155], v[64:67], v[120:123]
s_add_u32 s64, s70, 4096
ds_read_b128 a[184:187], v2 offset:26624
ds_read_b128 a[188:191], v2 offset:27648
v_mfma_f32_16x16x32_bf16 v[120:123], a[156:159], v[68:71], v[120:123]
buffer_load_dwordx4 v16, s[32:35], s70 offen offset:3072 sc1 lds
v_mfma_f32_16x16x32_bf16 v[136:139], a[156:159], v[84:87], v[228:231]
s_add_u32 m0, s71, 4096
ds_read_b128 a[192:195], v2 offset:28672
ds_read_b128 a[196:199], v2 offset:29696
v_mfma_f32_16x16x32_bf16 v[136:139], a[152:155], v[80:83], v[136:139]
buffer_load_dwordx4 v16, s[32:35], s64 offen offset:0 sc1 lds
v_mfma_f32_16x16x32_bf16 v[136:139], a[148:151], v[76:79], v[136:139]
ds_read_b128 a[200:203], v2 offset:30720
ds_read_b128 a[204:207], v2 offset:31744
v_mfma_f32_16x16x32_bf16 v[136:139], a[144:147], v[72:75], v[136:139]
v_exp_f32 v120, v120
v_mfma_f32_16x16x32_bf16 v[140:143], a[160:163], v[72:75], v[228:231]
s_waitcnt lgkmcnt(4)
v_exp_f32 v121, v121
v_mfma_f32_16x16x32_bf16 v[140:143], a[164:167], v[76:79], v[140:143]
v_exp_f32 v122, v122
v_mfma_f32_16x16x32_bf16 v[140:143], a[168:171], v[80:83], v[140:143]
v_mul_f32 v235, v235, v21
v_mul_f32 v236, v236, v21
v_mul_f32 v237, v237, v21
v_mul_f32 v238, v238, v21
v_mul_f32 v239, v239, v21
v_cvt_pk_bf16_f32 v232, v232, v233
v_cvt_pk_bf16_f32 v233, v234, v235
v_cvt_pk_bf16_f32 v234, v236, v237
v_cvt_pk_bf16_f32 v235, v238, v239
s_add_u32 s77, s74, 4096
buffer_store_dwordx4 v[232:235], v16, s[44:47], s77 offen sc1
v_accvgpr_read_b32 v240, a40
v_accvgpr_read_b32 v241, a41
v_accvgpr_read_b32 v242, a42
v_accvgpr_read_b32 v243, a43
v_accvgpr_read_b32 v244, a44
v_accvgpr_read_b32 v245, a45
v_accvgpr_read_b32 v246, a46
v_accvgpr_read_b32 v247, a47
v_mul_f32 v240, v240, v21
v_mul_f32 v241, v241, v21
v_mul_f32 v242, v242, v21
v_mul_f32 v243, v243, v21
v_mul_f32 v244, v244, v21
v_mul_f32 v245, v245, v21
v_mul_f32 v246, v246, v21
v_mul_f32 v247, v247, v21
v_cvt_pk_bf16_f32 v240, v240, v241
v_cvt_pk_bf16_f32 v241, v242, v243
v_cvt_pk_bf16_f32 v242, v244, v245
v_cvt_pk_bf16_f32 v243, v246, v247
s_add_u32 s77, s74, 12288
buffer_store_dwordx4 v[240:243], v16, s[44:47], s77 offen sc1
v_accvgpr_read_b32 v232, a48
v_accvgpr_read_b32 v233, a49
v_accvgpr_read_b32 v234, a50
v_accvgpr_read_b32 v235, a51
v_accvgpr_read_b32 v236, a52
v_accvgpr_read_b32 v237, a53
v_accvgpr_read_b32 v238, a54
v_accvgpr_read_b32 v239, a55
v_mul_f32 v232, v232, v21
v_mul_f32 v233, v233, v21
v_mul_f32 v234, v234, v21
v_mul_f32 v235, v235, v21
v_mul_f32 v236, v236, v21
v_mul_f32 v237, v237, v21
v_mul_f32 v238, v238, v21
v_mul_f32 v239, v239, v21
v_cvt_pk_bf16_f32 v232, v232, v233
v_cvt_pk_bf16_f32 v233, v234, v235
v_cvt_pk_bf16_f32 v234, v236, v237
v_cvt_pk_bf16_f32 v235, v238, v239
s_add_u32 s77, s74, 20480
buffer_store_dwordx4 v[232:235], v16, s[44:47], s77 offen sc1
v_accvgpr_read_b32 v240, a56
v_accvgpr_read_b32 v241, a57
v_accvgpr_read_b32 v242, a58
v_accvgpr_read_b32 v243, a59
v_accvgpr_read_b32 v244, a60
v_accvgpr_read_b32 v245, a61
v_accvgpr_read_b32 v246, a62
v_accvgpr_read_b32 v247, a63
v_mul_f32 v240, v240, v21
v_mul_f32 v241, v241, v21
v_mul_f32 v242, v242, v21
v_mul_f32 v243, v243, v21
v_mul_f32 v244, v244, v21
v_mul_f32 v245, v245, v21
v_mul_f32 v246, v246, v21
v_mul_f32 v247, v247, v21
v_cvt_pk_bf16_f32 v240, v240, v241
v_cvt_pk_bf16_f32 v241, v242, v243
v_cvt_pk_bf16_f32 v242, v244, v245
v_cvt_pk_bf16_f32 v243, v246, v247
s_add_u32 s77, s74, 28672
buffer_store_dwordx4 v[240:243], v16, s[44:47], s77 offen sc1
v_exp_f32 v123, v123
v_mfma_f32_16x16x32_bf16 v[140:143], a[172:175], v[84:87], v[140:143]
s_branch L_po18
L_pg18:
s_branch L_pg22
L_po18:
v_exp_f32 v136, v136
v_mfma_f32_16x16x32_bf16 v[124:127], a[172:175], v[68:71], v[224:227]
ds_read_b128 a[144:147], v3 offset:16384
v_cvt_pk_bf16_f32 v200, v120, v121
v_mfma_f32_16x16x32_bf16 v[124:127], a[168:171], v[64:67], v[124:127]
v_exp_f32 v137, v137
v_mfma_f32_16x16x32_bf16 v[124:127], a[164:167], v[60:63], v[124:127]
ds_read_b128 a[148:151], v3 offset:24576
v_cvt_pk_bf16_f32 v201, v122, v123
v_mfma_f32_16x16x32_bf16 v[124:127], a[160:163], v[56:59], v[124:127]
v_exp_f32 v138, v138
v_mfma_f32_16x16x32_bf16 v[128:131], a[176:179], v[56:59], v[224:227]
ds_read_b128 a[152:155], v3 offset:17408
v_cvt_pk_bf16_f32 v208, v136, v137
v_mfma_f32_16x16x32_bf16 v[128:131], a[180:183], v[60:63], v[128:131]
v_exp_f32 v139, v139
v_mfma_f32_16x16x32_bf16 v[128:131], a[184:187], v[64:67], v[128:131]
ds_read_b128 a[156:159], v3 offset:25600
v_cvt_pk_bf16_f32 v209, v138, v139
v_mfma_f32_16x16x32_bf16 v[128:131], a[188:191], v[68:71], v[128:131]
v_exp_f32 v140, v140
v_mfma_f32_16x16x32_bf16 v[144:147], a[188:191], v[84:87], v[228:231]
buffer_load_dwordx4 v16, s[32:35], s64 offen offset:1024 sc1 lds
v_mfma_f32_16x16x32_bf16 v[144:147], a[184:187], v[80:83], v[144:147]
v_exp_f32 v141, v141
v_mfma_f32_16x16x32_bf16 v[144:147], a[180:183], v[76:79], v[144:147]
ds_read_b128 a[160:163], v3 offset:18432
v_cvt_pk_bf16_f32 v210, v140, v141
v_mfma_f32_16x16x32_bf16 v[144:147], a[176:179], v[72:75], v[144:147]
s_waitcnt lgkmcnt(2)
v_exp_f32 v142, v142
v_mfma_f32_16x16x32_bf16 v[148:151], a[192:195], v[72:75], v[228:231]
ds_read_b128 a[164:167], v3 offset:26624
ds_read_b128 a[168:171], v3 offset:19456
v_mfma_f32_16x16x32_bf16 v[148:151], a[196:199], v[76:79], v[148:151]
v_exp_f32 v143, v143
v_mfma_f32_16x16x32_bf16 v[148:151], a[200:203], v[80:83], v[148:151]
ds_read_b128 a[172:175], v3 offset:27648
v_cvt_pk_bf16_f32 v211, v142, v143
v_mfma_f32_16x16x32_bf16 v[148:151], a[204:207], v[84:87], v[148:151]
v_exp_f32 v124, v124
v_mfma_f32_16x16x32_bf16 v[132:135], a[204:207], v[68:71], v[224:227]
ds_read_b128 a[176:179], v3 offset:20480
buffer_load_dwordx4 v16, s[32:35], s64 offen offset:2048 sc1 lds
v_mfma_f32_16x16x32_bf16 v[132:135], a[200:203], v[64:67], v[132:135]
v_exp_f32 v125, v125
v_mfma_f32_16x16x32_bf16 v[132:135], a[196:199], v[60:63], v[132:135]
ds_read_b128 a[180:183], v3 offset:28672
v_cvt_pk_bf16_f32 v202, v124, v125
v_mfma_f32_16x16x32_bf16 v[132:135], a[192:195], v[56:59], v[132:135]
v_exp_f32 v126, v126
v_smfmac_f32_16x16x64_bf16 a[136:139], a[240:243], v[184:191], v5
ds_read_b128 a[184:187], v3 offset:21504
v_smfmac_f32_16x16x64_bf16 a[140:143], a[240:243], v[192:199], v5
ds_read_b128 a[188:191], v3 offset:29696
v_mfma_f32_16x16x32_bf16 a[64:67], a[144:147], v[184:187], a[64:67]
v_exp_f32 v127, v127
v_mfma_f32_16x16x32_bf16 a[64:67], a[148:151], v[188:191], a[64:67]
v_exp_f32 v128, v128
v_mfma_f32_16x16x32_bf16 a[96:99], a[148:151], v[196:199], a[96:99]
v_exp_f32 v129, v129
v_mfma_f32_16x16x32_bf16 a[96:99], a[144:147], v[192:195], a[96:99]
ds_read_b128 a[192:195], v3 offset:22528
v_cvt_pk_bf16_f32 v203, v126, v127
v_mfma_f32_16x16x32_bf16 a[100:103], a[152:155], v[192:195], a[100:103]
s_waitcnt lgkmcnt(2)
v_exp_f32 v130, v130
v_mfma_f32_16x16x32_bf16 a[100:103], a[156:159], v[196:199], a[100:103]
ds_read_b128 a[196:199], v3 offset:30720
v_cvt_pk_bf16_f32 v204, v128, v129
v_mfma_f32_16x16x32_bf16 a[68:71], a[156:159], v[188:191], a[68:71]
v_exp_f32 v131, v131
v_mfma_f32_16x16x32_bf16 a[68:71], a[152:155], v[184:187], a[68:71]
ds_read_b128 a[200:203], v3 offset:23552
v_cvt_pk_bf16_f32 v205, v130, v131
v_mfma_f32_16x16x32_bf16 a[72:75], a[160:163], v[184:187], a[72:75]
v_exp_f32 v144, v144
v_mfma_f32_16x16x32_bf16 a[72:75], a[164:167], v[188:191], a[72:75]
buffer_load_dwordx4 v16, s[32:35], s64 offen offset:3072 sc1 lds
v_mfma_f32_16x16x32_bf16 a[104:107], a[164:167], v[196:199], a[104:107]
s_xor_b32 s71, s71, 49152
v_exp_f32 v145, v145
v_mfma_f32_16x16x32_bf16 a[104:107], a[160:163], v[192:195], a[104:107]
ds_read_b128 a[204:207], v3 offset:31744
v_cvt_pk_bf16_f32 v212, v144, v145
v_mfma_f32_16x16x32_bf16 a[108:111], a[168:171], v[192:195], a[108:111]
s_add_u32 s70, s70, 32768
v_xor_b32 v2, 0x8000, v2
v_exp_f32 v146, v146
v_mfma_f32_16x16x32_bf16 a[108:111], a[172:175], v[196:199], a[108:111]
s_waitcnt vmcnt(12)
s_barrier
v_mfma_f32_16x16x32_bf16 a[76:79], a[172:175], v[188:191], a[76:79]
s_mov_b32 m0, s71
v_exp_f32 v147, v147
v_mfma_f32_16x16x32_bf16 a[76:79], a[168:171], v[184:187], a[76:79]
ds_read_b128 a[144:147], v2 offset:0
v_cvt_pk_bf16_f32 v213, v146, v147
v_mfma_f32_16x16x32_bf16 a[80:83], a[176:179], v[184:187], a[80:83]
v_exp_f32 v148, v148
v_mfma_f32_16x16x32_bf16 a[80:83], a[180:183], v[188:191], a[80:83]
ds_read_b128 a[148:151], v2 offset:1024
ds_read_b128 a[152:155], v2 offset:2048
v_mfma_f32_16x16x32_bf16 a[112:115], a[180:183], v[196:199], a[112:115]
v_exp_f32 v149, v149
v_mfma_f32_16x16x32_bf16 a[112:115], a[176:179], v[192:195], a[112:115]
ds_read_b128 a[156:159], v2 offset:3072
v_cvt_pk_bf16_f32 v214, v148, v149
v_mfma_f32_16x16x32_bf16 a[116:119], a[184:187], v[192:195], a[116:119]
s_waitcnt lgkmcnt(4)
v_exp_f32 v150, v150
v_mfma_f32_16x16x32_bf16 a[116:119], a[188:191], v[196:199], a[116:119]
buffer_load_dwordx4 v16, s[32:35], s70 offen offset:0 sc1 lds
v_mfma_f32_16x16x32_bf16 a[84:87], a[188:191], v[188:191], a[84:87]
v_exp_f32 v151, v151
v_mfma_f32_16x16x32_bf16 a[84:87], a[184:187], v[184:187], a[84:87]
ds_read_b128 a[160:163], v2 offset:4096
v_cvt_pk_bf16_f32 v215, v150, v151
v_mfma_f32_16x16x32_bf16 a[88:91], a[192:195], v[184:187], a[88:91]
v_exp_f32 v132, v132
v_mfma_f32_16x16x32_bf16 a[88:91], a[196:199], v[188:191], a[88:91]
ds_read_b128 a[164:167], v2 offset:5120
v_xor_b32 v3, 0x8000, v3
v_mfma_f32_16x16x32_bf16 a[120:123], a[196:199], v[196:199], a[120:123]
v_exp_f32 v133, v133
v_mfma_f32_16x16x32_bf16 a[120:123], a[192:195], v[192:195], a[120:123]
ds_read_b128 a[168:171], v2 offset:6144
v_cvt_pk_bf16_f32 v206, v132, v133
v_mfma_f32_16x16x32_bf16 a[124:127], a[200:203], v[192:195], a[124:127]
v_exp_f32 v134, v134
v_mfma_f32_16x16x32_bf16 a[124:127], a[204:207], v[196:199], a[124:127]
buffer_load_dwordx4 v16, s[32:35], s70 offen offset:1024 sc1 lds
v_mfma_f32_16x16x32_bf16 a[92:95], a[204:207], v[188:191], a[92:95]
v_exp_f32 v135, v135
v_mfma_f32_16x16x32_bf16 a[92:95], a[200:203], v[184:187], a[92:95]
ds_read_b128 a[172:175], v2 offset:7168
v_cvt_pk_bf16_f32 v207, v134, v135
s_lshl_b32 s72, s3, 1
s_sub_u32 s72, 13, s72
L_S:
s_waitcnt lgkmcnt(7)
v_mfma_f32_16x16x32_bf16 v[120:123], a[144:147], v[56:59], v[224:227]
s_waitcnt lgkmcnt(6)
ds_read_b128 a[176:179], v2 offset:8192
ds_read_b128 a[180:183], v2 offset:9216
v_mfma_f32_16x16x32_bf16 v[120:123], a[148:151], v[60:63], v[120:123]
s_waitcnt lgkmcnt(7)
buffer_load_dwordx4 v16, s[32:35], s70 offen offset:2048 sc1 lds
v_mfma_f32_16x16x32_bf16 v[120:123], a[152:155], v[64:67], v[120:123]
s_waitcnt lgkmcnt(6)
s_add_u32 s64, s70, 4096
ds_read_b128 a[184:187], v2 offset:10240
ds_read_b128 a[188:191], v2 offset:11264
v_mfma_f32_16x16x32_bf16 v[120:123], a[156:159], v[68:71], v[120:123]
buffer_load_dwordx4 v16, s[32:35], s70 offen offset:3072 sc1 lds
v_mfma_f32_16x16x32_bf16 v[136:139], a[156:159], v[84:87], v[228:231]
s_add_u32 m0, s71, 4096
ds_read_b128 a[192:195], v2 offset:12288
ds_read_b128 a[196:199], v2 offset:13312
v_mfma_f32_16x16x32_bf16 v[136:139], a[152:155], v[80:83], v[136:139]
buffer_load_dwordx4 v16, s[32:35], s64 offen offset:0 sc1 lds
v_mfma_f32_16x16x32_bf16 v[136:139], a[148:151], v[76:79], v[136:139]
ds_read_b128 a[200:203], v2 offset:14336
ds_read_b128 a[204:207], v2 offset:15360
v_mfma_f32_16x16x32_bf16 v[136:139], a[144:147], v[72:75], v[136:139]
s_waitcnt lgkmcnt(6)
v_exp_f32 v120, v120
v_mfma_f32_16x16x32_bf16 v[140:143], a[160:163], v[72:75], v[228:231]
v_exp_f32 v121, v121
v_mfma_f32_16x16x32_bf16 v[140:143], a[164:167], v[76:79], v[140:143]
v_exp_f32 v122, v122
v_mfma_f32_16x16x32_bf16 v[140:143], a[168:171], v[80:83], v[140:143]
v_exp_f32 v123, v123
v_mfma_f32_16x16x32_bf16 v[140:143], a[172:175], v[84:87], v[140:143]
v_exp_f32 v136, v136
v_mfma_f32_16x16x32_bf16 v[124:127], a[172:175], v[68:71], v[224:227]
ds_read_b128 a[144:147], v3 offset:0
v_cvt_pk_bf16_f32 v184, v120, v121
v_mfma_f32_16x16x32_bf16 v[124:127], a[168:171], v[64:67], v[124:127]
v_exp_f32 v137, v137
v_mfma_f32_16x16x32_bf16 v[124:127], a[164:167], v[60:63], v[124:127]
ds_read_b128 a[148:151], v3 offset:8192
v_cvt_pk_bf16_f32 v185, v122, v123
v_mfma_f32_16x16x32_bf16 v[124:127], a[160:163], v[56:59], v[124:127]
v_exp_f32 v138, v138
v_mfma_f32_16x16x32_bf16 v[128:131], a[176:179], v[56:59], v[224:227]
ds_read_b128 a[152:155], v3 offset:1024
v_cvt_pk_bf16_f32 v192, v136, v137
v_mfma_f32_16x16x32_bf16 v[128:131], a[180:183], v[60:63], v[128:131]
s_waitcnt lgkmcnt(3)
v_exp_f32 v139, v139
v_mfma_f32_16x16x32_bf16 v[128:131], a[184:187], v[64:67], v[128:131]
ds_read_b128 a[156:159], v3 offset:9216
v_cvt_pk_bf16_f32 v193, v138, v139
v_mfma_f32_16x16x32_bf16 v[128:131], a[188:191], v[68:71], v[128:131]
v_exp_f32 v140, v140
v_mfma_f32_16x16x32_bf16 v[144:147], a[188:191], v[84:87], v[228:231]
buffer_load_dwordx4 v16, s[32:35], s64 offen offset:1024 sc1 lds
v_mfma_f32_16x16x32_bf16 v[144:147], a[184:187], v[80:83], v[144:147]
v_exp_f32 v141, v141
v_mfma_f32_16x16x32_bf16 v[144:147], a[180:183], v[76:79], v[144:147]
ds_read_b128 a[160:163], v3 offset:2048
v_cvt_pk_bf16_f32 v194, v140, v141
v_mfma_f32_16x16x32_bf16 v[144:147], a[176:179], v[72:75], v[144:147]
v_exp_f32 v142, v142
v_mfma_f32_16x16x32_bf16 v[148:151], a[192:195], v[72:75], v[228:231]
ds_read_b128 a[164:167], v3 offset:10240
ds_read_b128 a[168:171], v3 offset:3072
v_mfma_f32_16x16x32_bf16 v[148:151], a[196:199], v[76:79], v[148:151]
v_exp_f32 v143, v143
v_mfma_f32_16x16x32_bf16 v[148:151], a[200:203], v[80:83], v[148:151]
ds_read_b128 a[172:175], v3 offset:11264
v_cvt_pk_bf16_f32 v195, v142, v143
v_mfma_f32_16x16x32_bf16 v[148:151], a[204:207], v[84:87], v[148:151]
v_exp_f32 v124, v124
v_mfma_f32_16x16x32_bf16 v[132:135], a[204:207], v[68:71], v[224:227]
ds_read_b128 a[176:179], v3 offset:4096
buffer_load_dwordx4 v16, s[32:35], s64 offen offset:2048 sc1 lds
v_mfma_f32_16x16x32_bf16 v[132:135], a[200:203], v[64:67], v[132:135]
v_exp_f32 v125, v125
v_mfma_f32_16x16x32_bf16 v[132:135], a[196:199], v[60:63], v[132:135]
ds_read_b128 a[180:183], v3 offset:12288
v_cvt_pk_bf16_f32 v186, v124, v125
v_mfma_f32_16x16x32_bf16 v[132:135], a[192:195], v[56:59], v[132:135]
v_exp_f32 v126, v126
v_smfmac_f32_16x16x64_bf16 a[136:139], a[240:243], v[200:207], v5
ds_read_b128 a[184:187], v3 offset:5120
v_smfmac_f32_16x16x64_bf16 a[140:143], a[240:243], v[208:215], v5
s_waitcnt lgkmcnt(3)
ds_read_b128 a[188:191], v3 offset:13312
v_mfma_f32_16x16x32_bf16 a[64:67], a[144:147], v[200:203], a[64:67]
v_exp_f32 v127, v127
v_mfma_f32_16x16x32_bf16 a[64:67], a[148:151], v[204:207], a[64:67]
v_exp_f32 v128, v128
v_mfma_f32_16x16x32_bf16 a[96:99], a[148:151], v[212:215], a[96:99]
v_exp_f32 v129, v129
v_mfma_f32_16x16x32_bf16 a[96:99], a[144:147], v[208:211], a[96:99]
ds_read_b128 a[192:195], v3 offset:6144
v_cvt_pk_bf16_f32 v187, v126, v127
v_mfma_f32_16x16x32_bf16 a[100:103], a[152:155], v[208:211], a[100:103]
v_exp_f32 v130, v130
v_mfma_f32_16x16x32_bf16 a[100:103], a[156:159], v[212:215], a[100:103]
ds_read_b128 a[196:199], v3 offset:14336
v_cvt_pk_bf16_f32 v188, v128, v129
v_mfma_f32_16x16x32_bf16 a[68:71], a[156:159], v[204:207], a[68:71]
v_exp_f32 v131, v131
v_mfma_f32_16x16x32_bf16 a[68:71], a[152:155], v[200:203], a[68:71]
ds_read_b128 a[200:203], v3 offset:7168
v_cvt_pk_bf16_f32 v189, v130, v131
v_mfma_f32_16x16x32_bf16 a[72:75], a[160:163], v[200:203], a[72:75]
v_exp_f32 v144, v144
v_mfma_f32_16x16x32_bf16 a[72:75], a[164:167], v[204:207], a[72:75]
buffer_load_dwordx4 v16, s[32:35], s64 offen offset:3072 sc1 lds
v_mfma_f32_16x16x32_bf16 a[104:107], a[164:167], v[212:215], a[104:107]
s_xor_b32 s71, s71, 16384
v_exp_f32 v145, v145
v_mfma_f32_16x16x32_bf16 a[104:107], a[160:163], v[208:211], a[104:107]
ds_read_b128 a[204:207], v3 offset:15360
v_cvt_pk_bf16_f32 v196, v144, v145
v_mfma_f32_16x16x32_bf16 a[108:111], a[168:171], v[208:211], a[108:111]
s_add_u32 s70, s70, 32768
v_exp_f32 v146, v146
v_mfma_f32_16x16x32_bf16 a[108:111], a[172:175], v[212:215], a[108:111]
s_waitcnt vmcnt(8)
s_barrier
v_mfma_f32_16x16x32_bf16 a[76:79], a[172:175], v[204:207], a[76:79]
s_mov_b32 m0, s71
v_exp_f32 v147, v147
v_mfma_f32_16x16x32_bf16 a[76:79], a[168:171], v[200:203], a[76:79]
s_waitcnt lgkmcnt(1)
ds_read_b128 a[144:147], v2 offset:16384
v_cvt_pk_bf16_f32 v197, v146, v147
v_mfma_f32_16x16x32_bf16 a[80:83], a[176:179], v[200:203], a[80:83]
v_exp_f32 v148, v148
v_mfma_f32_16x16x32_bf16 a[80:83], a[180:183], v[204:207], a[80:83]
ds_read_b128 a[148:151], v2 offset:17408
ds_read_b128 a[152:155], v2 offset:18432
v_mfma_f32_16x16x32_bf16 a[112:115], a[180:183], v[212:215], a[112:115]
v_exp_f32 v149, v149
v_mfma_f32_16x16x32_bf16 a[112:115], a[176:179], v[208:211], a[112:115]
ds_read_b128 a[156:159], v2 offset:19456
v_cvt_pk_bf16_f32 v198, v148, v149
v_mfma_f32_16x16x32_bf16 a[116:119], a[184:187], v[208:211], a[116:119]
v_exp_f32 v150, v150
v_mfma_f32_16x16x32_bf16 a[116:119], a[188:191], v[212:215], a[116:119]
buffer_load_dwordx4 v16, s[32:35], s70 offen offset:0 sc1 lds
v_mfma_f32_16x16x32_bf16 a[84:87], a[188:191], v[204:207], a[84:87]
v_exp_f32 v151, v151
v_mfma_f32_16x16x32_bf16 a[84:87], a[184:187], v[200:203], a[84:87]
ds_read_b128 a[160:163], v2 offset:20480
v_cvt_pk_bf16_f32 v199, v150, v151
v_mfma_f32_16x16x32_bf16 a[88:91], a[192:195], v[200:203], a[88:91]
v_exp_f32 v132, v132
v_mfma_f32_16x16x32_bf16 a[88:91], a[196:199], v[204:207], a[88:91]
ds_read_b128 a[164:167], v2 offset:21504
v_mfma_f32_16x16x32_bf16 a[120:123], a[196:199], v[212:215], a[120:123]
v_exp_f32 v133, v133
v_mfma_f32_16x16x32_bf16 a[120:123], a[192:195], v[208:211], a[120:123]
ds_read_b128 a[168:171], v2 offset:22528
v_cvt_pk_bf16_f32 v190, v132, v133
v_mfma_f32_16x16x32_bf16 a[124:127], a[200:203], v[208:211], a[124:127]
s_waitcnt lgkmcnt(3)
v_exp_f32 v134, v134
v_mfma_f32_16x16x32_bf16 a[124:127], a[204:207], v[212:215], a[124:127]
buffer_load_dwordx4 v16, s[32:35], s70 offen offset:1024 sc1 lds
v_mfma_f32_16x16x32_bf16 a[92:95], a[204:207], v[204:207], a[92:95]
v_exp_f32 v135, v135
v_mfma_f32_16x16x32_bf16 a[92:95], a[200:203], v[200:203], a[92:95]
ds_read_b128 a[172:175], v2 offset:23552
v_cvt_pk_bf16_f32 v191, v134, v135
v_mfma_f32_16x16x32_bf16 v[120:123], a[144:147], v[56:59], v[224:227]
ds_read_b128 a[176:179], v2 offset:24576
ds_read_b128 a[180:183], v2 offset:25600
v_mfma_f32_16x16x32_bf16 v[120:123], a[148:151], v[60:63], v[120:123]
buffer_load_dwordx4 v16, s[32:35], s70 offen offset:2048 sc1 lds
v_mfma_f32_16x16x32_bf16 v[120:123], a[152:155], v[64:67], v[120:123]
s_add_u32 s64, s70, 4096
ds_read_b128 a[184:187], v2 offset:26624
ds_read_b128 a[188:191], v2 offset:27648
v_mfma_f32_16x16x32_bf16 v[120:123], a[156:159], v[68:71], v[120:123]
buffer_load_dwordx4 v16, s[32:35], s70 offen offset:3072 sc1 lds
v_mfma_f32_16x16x32_bf16 v[136:139], a[156:159], v[84:87], v[228:231]
s_add_u32 m0, s71, 4096
ds_read_b128 a[192:195], v2 offset:28672
ds_read_b128 a[196:199], v2 offset:29696
v_mfma_f32_16x16x32_bf16 v[136:139], a[152:155], v[80:83], v[136:139]
buffer_load_dwordx4 v16, s[32:35], s64 offen offset:0 sc1 lds
v_mfma_f32_16x16x32_bf16 v[136:139], a[148:151], v[76:79], v[136:139]
ds_read_b128 a[200:203], v2 offset:30720
ds_read_b128 a[204:207], v2 offset:31744
v_mfma_f32_16x16x32_bf16 v[136:139], a[144:147], v[72:75], v[136:139]
s_waitcnt lgkmcnt(6)
v_exp_f32 v120, v120
v_mfma_f32_16x16x32_bf16 v[140:143], a[160:163], v[72:75], v[228:231]
v_exp_f32 v121, v121
v_mfma_f32_16x16x32_bf16 v[140:143], a[164:167], v[76:79], v[140:143]
v_exp_f32 v122, v122
v_mfma_f32_16x16x32_bf16 v[140:143], a[168:171], v[80:83], v[140:143]
v_exp_f32 v123, v123
v_mfma_f32_16x16x32_bf16 v[140:143], a[172:175], v[84:87], v[140:143]
v_exp_f32 v136, v136
v_mfma_f32_16x16x32_bf16 v[124:127], a[172:175], v[68:71], v[224:227]
ds_read_b128 a[144:147], v3 offset:16384
v_cvt_pk_bf16_f32 v200, v120, v121
v_mfma_f32_16x16x32_bf16 v[124:127], a[168:171], v[64:67], v[124:127]
v_exp_f32 v137, v137
v_mfma_f32_16x16x32_bf16 v[124:127], a[164:167], v[60:63], v[124:127]
ds_read_b128 a[148:151], v3 offset:24576
v_cvt_pk_bf16_f32 v201, v122, v123
v_mfma_f32_16x16x32_bf16 v[124:127], a[160:163], v[56:59], v[124:127]
v_exp_f32 v138, v138
v_mfma_f32_16x16x32_bf16 v[128:131], a[176:179], v[56:59], v[224:227]
ds_read_b128 a[152:155], v3 offset:17408
v_cvt_pk_bf16_f32 v208, v136, v137
v_mfma_f32_16x16x32_bf16 v[128:131], a[180:183], v[60:63], v[128:131]
s_waitcnt lgkmcnt(3)
v_exp_f32 v139, v139
v_mfma_f32_16x16x32_bf16 v[128:131], a[184:187], v[64:67], v[128:131]
ds_read_b128 a[156:159], v3 offset:25600
v_cvt_pk_bf16_f32 v209, v138, v139
v_mfma_f32_16x16x32_bf16 v[128:131], a[188:191], v[68:71], v[128:131]
v_exp_f32 v140, v140
v_mfma_f32_16x16x32_bf16 v[144:147], a[188:191], v[84:87], v[228:231]
buffer_load_dwordx4 v16, s[32:35], s64 offen offset:1024 sc1 lds
v_mfma_f32_16x16x32_bf16 v[144:147], a[184:187], v[80:83], v[144:147]
v_exp_f32 v141, v141
v_mfma_f32_16x16x32_bf16 v[144:147], a[180:183], v[76:79], v[144:147]
ds_read_b128 a[160:163], v3 offset:18432
v_cvt_pk_bf16_f32 v210, v140, v141
v_mfma_f32_16x16x32_bf16 v[144:147], a[176:179], v[72:75], v[144:147]
v_exp_f32 v142, v142
v_mfma_f32_16x16x32_bf16 v[148:151], a[192:195], v[72:75], v[228:231]
ds_read_b128 a[164:167], v3 offset:26624
ds_read_b128 a[168:171], v3 offset:19456
v_mfma_f32_16x16x32_bf16 v[148:151], a[196:199], v[76:79], v[148:151]
v_exp_f32 v143, v143
v_mfma_f32_16x16x32_bf16 v[148:151], a[200:203], v[80:83], v[148:151]
ds_read_b128 a[172:175], v3 offset:27648
v_cvt_pk_bf16_f32 v211, v142, v143
v_mfma_f32_16x16x32_bf16 v[148:151], a[204:207], v[84:87], v[148:151]
v_exp_f32 v124, v124
v_mfma_f32_16x16x32_bf16 v[132:135], a[204:207], v[68:71], v[224:227]
ds_read_b128 a[176:179], v3 offset:20480
buffer_load_dwordx4 v16, s[32:35], s64 offen offset:2048 sc1 lds
v_mfma_f32_16x16x32_bf16 v[132:135], a[200:203], v[64:67], v[132:135]
v_exp_f32 v125, v125
v_mfma_f32_16x16x32_bf16 v[132:135], a[196:199], v[60:63], v[132:135]
ds_read_b128 a[180:183], v3 offset:28672
v_cvt_pk_bf16_f32 v202, v124, v125
v_mfma_f32_16x16x32_bf16 v[132:135], a[192:195], v[56:59], v[132:135]
v_exp_f32 v126, v126
v_smfmac_f32_16x16x64_bf16 a[136:139], a[240:243], v[184:191], v5
ds_read_b128 a[184:187], v3 offset:21504
v_smfmac_f32_16x16x64_bf16 a[140:143], a[240:243], v[192:199], v5
s_waitcnt lgkmcnt(3)
ds_read_b128 a[188:191], v3 offset:29696
v_mfma_f32_16x16x32_bf16 a[64:67], a[144:147], v[184:187], a[64:67]
v_exp_f32 v127, v127
v_mfma_f32_16x16x32_bf16 a[64:67], a[148:151], v[188:191], a[64:67]
v_exp_f32 v128, v128
v_mfma_f32_16x16x32_bf16 a[96:99], a[148:151], v[196:199], a[96:99]
v_exp_f32 v129, v129
v_mfma_f32_16x16x32_bf16 a[96:99], a[144:147], v[192:195], a[96:99]
ds_read_b128 a[192:195], v3 offset:22528
v_cvt_pk_bf16_f32 v203, v126, v127
v_mfma_f32_16x16x32_bf16 a[100:103], a[152:155], v[192:195], a[100:103]
v_exp_f32 v130, v130
v_mfma_f32_16x16x32_bf16 a[100:103], a[156:159], v[196:199], a[100:103]
ds_read_b128 a[196:199], v3 offset:30720
v_cvt_pk_bf16_f32 v204, v128, v129
v_mfma_f32_16x16x32_bf16 a[68:71], a[156:159], v[188:191], a[68:71]
v_exp_f32 v131, v131
v_mfma_f32_16x16x32_bf16 a[68:71], a[152:155], v[184:187], a[68:71]
ds_read_b128 a[200:203], v3 offset:23552
v_cvt_pk_bf16_f32 v205, v130, v131
v_mfma_f32_16x16x32_bf16 a[72:75], a[160:163], v[184:187], a[72:75]
v_exp_f32 v144, v144
v_mfma_f32_16x16x32_bf16 a[72:75], a[164:167], v[188:191], a[72:75]
buffer_load_dwordx4 v16, s[32:35], s64 offen offset:3072 sc1 lds
v_mfma_f32_16x16x32_bf16 a[104:107], a[164:167], v[196:199], a[104:107]
s_xor_b32 s71, s71, 49152
v_exp_f32 v145, v145
v_mfma_f32_16x16x32_bf16 a[104:107], a[160:163], v[192:195], a[104:107]
ds_read_b128 a[204:207], v3 offset:31744
v_cvt_pk_bf16_f32 v212, v144, v145
v_mfma_f32_16x16x32_bf16 a[108:111], a[168:171], v[192:195], a[108:111]
s_add_u32 s70, s70, 32768
v_xor_b32 v2, 0x8000, v2
v_exp_f32 v146, v146
v_mfma_f32_16x16x32_bf16 a[108:111], a[172:175], v[196:199], a[108:111]
s_waitcnt vmcnt(8)
s_barrier
v_mfma_f32_16x16x32_bf16 a[76:79], a[172:175], v[188:191], a[76:79]
s_mov_b32 m0, s71
v_exp_f32 v147, v147
v_mfma_f32_16x16x32_bf16 a[76:79], a[168:171], v[184:187], a[76:79]
s_waitcnt lgkmcnt(1)
ds_read_b128 a[144:147], v2 offset:0
v_cvt_pk_bf16_f32 v213, v146, v147
v_mfma_f32_16x16x32_bf16 a[80:83], a[176:179], v[184:187], a[80:83]
v_exp_f32 v148, v148
v_mfma_f32_16x16x32_bf16 a[80:83], a[180:183], v[188:191], a[80:83]
ds_read_b128 a[148:151], v2 offset:1024
ds_read_b128 a[152:155], v2 offset:2048
v_mfma_f32_16x16x32_bf16 a[112:115], a[180:183], v[196:199], a[112:115]
v_exp_f32 v149, v149
v_mfma_f32_16x16x32_bf16 a[112:115], a[176:179], v[192:195], a[112:115]
ds_read_b128 a[156:159], v2 offset:3072
v_cvt_pk_bf16_f32 v214, v148, v149
v_mfma_f32_16x16x32_bf16 a[116:119], a[184:187], v[192:195], a[116:119]
v_exp_f32 v150, v150
v_mfma_f32_16x16x32_bf16 a[116:119], a[188:191], v[196:199], a[116:119]
buffer_load_dwordx4 v16, s[32:35], s70 offen offset:0 sc1 lds
v_mfma_f32_16x16x32_bf16 a[84:87], a[188:191], v[188:191], a[84:87]
s_sub_u32 s72, s72, 1
v_exp_f32 v151, v151
v_mfma_f32_16x16x32_bf16 a[84:87], a[184:187], v[184:187], a[84:87]
ds_read_b128 a[160:163], v2 offset:4096
v_cvt_pk_bf16_f32 v215, v150, v151
v_mfma_f32_16x16x32_bf16 a[88:91], a[192:195], v[184:187], a[88:91]
v_exp_f32 v132, v132
v_mfma_f32_16x16x32_bf16 a[88:91], a[196:199], v[188:191], a[88:91]
ds_read_b128 a[164:167], v2 offset:5120
v_xor_b32 v3, 0x8000, v3
v_mfma_f32_16x16x32_bf16 a[120:123], a[196:199], v[196:199], a[120:123]
s_cmp_lg_u32 s72, 0
v_exp_f32 v133, v133
v_mfma_f32_16x16x32_bf16 a[120:123], a[192:195], v[192:195], a[120:123]
ds_read_b128 a[168:171], v2 offset:6144
v_cvt_pk_bf16_f32 v206, v132, v133
v_mfma_f32_16x16x32_bf16 a[124:127], a[200:203], v[192:195], a[124:127]
s_waitcnt lgkmcnt(3)
v_exp_f32 v134, v134
v_mfma_f32_16x16x32_bf16 a[124:127], a[204:207], v[196:199], a[124:127]
buffer_load_dwordx4 v16, s[32:35], s70 offen offset:1024 sc1 lds
v_mfma_f32_16x16x32_bf16 a[92:95], a[204:207], v[188:191], a[92:95]
v_exp_f32 v135, v135
v_mfma_f32_16x16x32_bf16 a[92:95], a[200:203], v[184:187], a[92:95]
ds_read_b128 a[172:175], v2 offset:7168
v_cvt_pk_bf16_f32 v207, v134, v135
s_cbranch_scc1 L_S
L_SD:
buffer_load_dword v19, off, s[52:55], s80 sc1
s_waitcnt lgkmcnt(7)
v_mfma_f32_16x16x32_bf16 v[136:139], a[144:147], v[72:75], v[228:231]
s_waitcnt lgkmcnt(6)
ds_read_b128 a[176:179], v2 offset:8192
ds_read_b128 a[180:183], v2 offset:9216
v_mfma_f32_16x16x32_bf16 v[136:139], a[148:151], v[76:79], v[136:139]
s_waitcnt lgkmcnt(7)
buffer_load_dwordx4 v16, s[32:35], s70 offen offset:2048 sc1 lds
v_cndmask_b32 v120, v224, v17, s[0:1]
v_cndmask_b32 v121, v224, v17, s[4:5]
v_cndmask_b32 v122, v224, v17, s[6:7]
v_cndmask_b32 v123, v224, v17, s[8:9]
v_mfma_f32_16x16x32_bf16 v[136:139], a[152:155], v[80:83], v[136:139]
s_waitcnt lgkmcnt(6)
s_add_u32 s64, s70, 4096
ds_read_b128 a[184:187], v2 offset:10240
ds_read_b128 a[188:191], v2 offset:11264
v_mfma_f32_16x16x32_bf16 v[136:139], a[156:159], v[84:87], v[136:139]
buffer_load_dwordx4 v16, s[32:35], s70 offen offset:3072 sc1 lds
v_mfma_f32_16x16x32_bf16 v[120:123], a[156:159], v[68:71], v[120:123]
s_add_u32 m0, s71, 4096
ds_read_b128 a[192:195], v2 offset:12288
ds_read_b128 a[196:199], v2 offset:13312
v_mfma_f32_16x16x32_bf16 v[120:123], a[152:155], v[64:67], v[120:123]
buffer_load_dwordx4 v16, s[32:35], s64 offen offset:0 sc1 lds
v_mfma_f32_16x16x32_bf16 v[120:123], a[148:151], v[60:63], v[120:123]
ds_read_b128 a[200:203], v2 offset:14336
ds_read_b128 a[204:207], v2 offset:15360
v_mfma_f32_16x16x32_bf16 v[120:123], a[144:147], v[56:59], v[120:123]
s_waitcnt lgkmcnt(6)
v_exp_f32 v136, v136
v_mfma_f32_16x16x32_bf16 v[140:143], a[160:163], v[72:75], v[228:231]
v_exp_f32 v137, v137
v_mfma_f32_16x16x32_bf16 v[140:143], a[164:167], v[76:79], v[140:143]
v_cndmask_b32 v124, v224, v17, s[10:11]
v_cndmask_b32 v125, v224, v17, s[12:13]
v_cndmask_b32 v126, v224, v17, s[18:19]
v_cndmask_b32 v127, v224, v17, s[22:23]
v_exp_f32 v138, v138
v_mfma_f32_16x16x32_bf16 v[140:143], a[168:171], v[80:83], v[140:143]
v_exp_f32 v139, v139
v_mfma_f32_16x16x32_bf16 v[140:143], a[172:175], v[84:87], v[140:143]
v_exp_f32 v120, v120
v_mfma_f32_16x16x32_bf16 v[124:127], a[172:175], v[68:71], v[124:127]
ds_read_b128 a[144:147], v3 offset:0
v_cvt_pk_bf16_f32 v192, v136, v137
v_mfma_f32_16x16x32_bf16 v[124:127], a[168:171], v[64:67], v[124:127]
v_cndmask_b32 v128, v224, v17, s[26:27]
v_cndmask_b32 v129, v224, v17, s[56:57]
v_cndmask_b32 v130, v224, v17, s[58:59]
v_cndmask_b32 v131, v224, v17, s[60:61]
v_exp_f32 v121, v121
v_mfma_f32_16x16x32_bf16 v[124:127], a[164:167], v[60:63], v[124:127]
s_mul_i32 s69, s83, 8
ds_read_b128 a[148:151], v3 offset:8192
v_cvt_pk_bf16_f32 v193, v138, v139
v_mfma_f32_16x16x32_bf16 v[124:127], a[160:163], v[56:59], v[124:127]
s_sub_u32 s69, 36, s69
v_exp_f32 v122, v122
v_mfma_f32_16x16x32_bf16 v[128:131], a[176:179], v[56:59], v[128:131]
ds_read_b128 a[152:155], v3 offset:1024
v_cvt_pk_bf16_f32 v184, v120, v121
v_mfma_f32_16x16x32_bf16 v[128:131], a[180:183], v[60:63], v[128:131]
s_waitcnt lgkmcnt(3)
v_exp_f32 v123, v123
v_mfma_f32_16x16x32_bf16 v[128:131], a[184:187], v[64:67], v[128:131]
ds_read_b128 a[156:159], v3 offset:9216
v_cvt_pk_bf16_f32 v185, v122, v123
v_mfma_f32_16x16x32_bf16 v[128:131], a[188:191], v[68:71], v[128:131]
v_exp_f32 v140, v140
v_mfma_f32_16x16x32_bf16 v[144:147], a[188:191], v[84:87], v[228:231]
buffer_load_dwordx4 v16, s[32:35], s64 offen offset:1024 sc1 lds
v_mfma_f32_16x16x32_bf16 v[144:147], a[184:187], v[80:83], v[144:147]
v_exp_f32 v141, v141
v_mfma_f32_16x16x32_bf16 v[144:147], a[180:183], v[76:79], v[144:147]
ds_read_b128 a[160:163], v3 offset:2048
v_cvt_pk_bf16_f32 v194, v140, v141
v_mfma_f32_16x16x32_bf16 v[144:147], a[176:179], v[72:75], v[144:147]
v_exp_f32 v142, v142
v_mfma_f32_16x16x32_bf16 v[148:151], a[192:195], v[72:75], v[228:231]
ds_read_b128 a[164:167], v3 offset:10240
ds_read_b128 a[168:171], v3 offset:3072
v_mfma_f32_16x16x32_bf16 v[148:151], a[196:199], v[76:79], v[148:151]
v_cndmask_b32 v132, v224, v17, s[62:63]
v_cndmask_b32 v133, v224, v17, s[48:49]
v_cndmask_b32 v134, v224, v17, s[50:51]
v_cndmask_b32 v135, v224, v17, s[100:101]
v_exp_f32 v143, v143
v_mfma_f32_16x16x32_bf16 v[148:151], a[200:203], v[80:83], v[148:151]
ds_read_b128 a[172:175], v3 offset:11264
v_cvt_pk_bf16_f32 v195, v142, v143
v_mfma_f32_16x16x32_bf16 v[148:151], a[204:207], v[84:87], v[148:151]
v_exp_f32 v124, v124
v_mfma_f32_16x16x32_bf16 v[132:135], a[204:207], v[68:71], v[132:135]
ds_read_b128 a[176:179], v3 offset:4096
buffer_load_dwordx4 v16, s[32:35], s64 offen offset:2048 sc1 lds
v_mfma_f32_16x16x32_bf16 v[132:135], a[200:203], v[64:67], v[132:135]
v_exp_f32 v125, v125
v_mfma_f32_16x16x32_bf16 v[132:135], a[196:199], v[60:63], v[132:135]
ds_read_b128 a[180:183], v3 offset:12288
v_cvt_pk_bf16_f32 v186, v124, v125
v_mfma_f32_16x16x32_bf16 v[132:135], a[192:195], v[56:59], v[132:135]
s_branch L_po19
L_pg19:
s_branch L_pg23
L_po19:
v_exp_f32 v126, v126
v_smfmac_f32_16x16x64_bf16 a[136:139], a[240:243], v[200:207], v5
ds_read_b128 a[184:187], v3 offset:5120
v_smfmac_f32_16x16x64_bf16 a[140:143], a[240:243], v[208:215], v5
s_waitcnt lgkmcnt(3)
ds_read_b128 a[188:191], v3 offset:13312
v_mfma_f32_16x16x32_bf16 a[64:67], a[144:147], v[200:203], a[64:67]
v_exp_f32 v127, v127
v_mfma_f32_16x16x32_bf16 a[64:67], a[148:151], v[204:207], a[64:67]
v_exp_f32 v128, v128
v_mfma_f32_16x16x32_bf16 a[96:99], a[148:151], v[212:215], a[96:99]
v_exp_f32 v129, v129
v_mfma_f32_16x16x32_bf16 a[96:99], a[144:147], v[208:211], a[96:99]
ds_read_b128 a[192:195], v3 offset:6144
v_cvt_pk_bf16_f32 v187, v126, v127
v_mfma_f32_16x16x32_bf16 a[100:103], a[152:155], v[208:211], a[100:103]
v_exp_f32 v130, v130
v_mfma_f32_16x16x32_bf16 a[100:103], a[156:159], v[212:215], a[100:103]
ds_read_b128 a[196:199], v3 offset:14336
v_cvt_pk_bf16_f32 v188, v128, v129
v_mfma_f32_16x16x32_bf16 a[68:71], a[156:159], v[204:207], a[68:71]
v_exp_f32 v131, v131
v_mfma_f32_16x16x32_bf16 a[68:71], a[152:155], v[200:203], a[68:71]
ds_read_b128 a[200:203], v3 offset:7168
v_cvt_pk_bf16_f32 v189, v130, v131
v_mfma_f32_16x16x32_bf16 a[72:75], a[160:163], v[200:203], a[72:75]
v_exp_f32 v144, v144
v_mfma_f32_16x16x32_bf16 a[72:75], a[164:167], v[204:207], a[72:75]
buffer_load_dwordx4 v16, s[32:35], s64 offen offset:3072 sc1 lds
v_mfma_f32_16x16x32_bf16 a[104:107], a[164:167], v[212:215], a[104:107]
v_exp_f32 v145, v145
v_mfma_f32_16x16x32_bf16 a[104:107], a[160:163], v[208:211], a[104:107]
ds_read_b128 a[204:207], v3 offset:15360
v_cvt_pk_bf16_f32 v196, v144, v145
v_mfma_f32_16x16x32_bf16 a[108:111], a[168:171], v[208:211], a[108:111]
v_exp_f32 v146, v146
v_mfma_f32_16x16x32_bf16 a[108:111], a[172:175], v[212:215], a[108:111]
s_waitcnt vmcnt(9)
s_barrier
v_mfma_f32_16x16x32_bf16 a[76:79], a[172:175], v[204:207], a[76:79]
v_exp_f32 v147, v147
v_mfma_f32_16x16x32_bf16 a[76:79], a[168:171], v[200:203], a[76:79]
s_waitcnt lgkmcnt(1)
ds_read_b128 a[144:147], v2 offset:16384
v_cvt_pk_bf16_f32 v197, v146, v147
v_mfma_f32_16x16x32_bf16 a[80:83], a[176:179], v[200:203], a[80:83]
s_waitcnt vmcnt(6)
v_readfirstlane_b32 vcc_lo, v19
s_nop 0
s_cmp_lt_u32 vcc_lo, s69
s_cbranch_scc1 L_spin_8
L_spinbk_9:
v_exp_f32 v148, v148
v_mfma_f32_16x16x32_bf16 a[80:83], a[180:183], v[204:207], a[80:83]
ds_read_b128 a[148:151], v2 offset:17408
ds_read_b128 a[152:155], v2 offset:18432
v_mfma_f32_16x16x32_bf16 a[112:115], a[180:183], v[212:215], a[112:115]
v_exp_f32 v149, v149
v_mfma_f32_16x16x32_bf16 a[112:115], a[176:179], v[208:211], a[112:115]
ds_read_b128 a[156:159], v2 offset:19456
v_cvt_pk_bf16_f32 v198, v148, v149
v_mfma_f32_16x16x32_bf16 a[116:119], a[184:187], v[208:211], a[116:119]
v_exp_f32 v150, v150
v_mfma_f32_16x16x32_bf16 a[116:119], a[188:191], v[212:215], a[116:119]
v_cndmask_b32 v136, v228, v17, s[0:1]
v_cndmask_b32 v137, v228, v17, s[4:5]
v_mfma_f32_16x16x32_bf16 a[84:87], a[188:191], v[204:207], a[84:87]
v_exp_f32 v151, v151
v_mfma_f32_16x16x32_bf16 a[84:87], a[184:187], v[200:203], a[84:87]
ds_read_b128 a[160:163], v2 offset:20480
v_cvt_pk_bf16_f32 v199, v150, v151
v_mfma_f32_16x16x32_bf16 a[88:91], a[192:195], v[200:203], a[88:91]
v_exp_f32 v132, v132
v_mfma_f32_16x16x32_bf16 a[88:91], a[196:199], v[204:207], a[88:91]
ds_read_b128 a[164:167], v2 offset:21504
v_cndmask_b32 v138, v228, v17, s[6:7]
v_mfma_f32_16x16x32_bf16 a[120:123], a[196:199], v[212:215], a[120:123]
v_exp_f32 v133, v133
v_mfma_f32_16x16x32_bf16 a[120:123], a[192:195], v[208:211], a[120:123]
ds_read_b128 a[168:171], v2 offset:22528
v_cvt_pk_bf16_f32 v190, v132, v133
v_mfma_f32_16x16x32_bf16 a[124:127], a[200:203], v[208:211], a[124:127]
s_waitcnt lgkmcnt(3)
v_exp_f32 v134, v134
v_mfma_f32_16x16x32_bf16 a[124:127], a[204:207], v[212:215], a[124:127]
v_cndmask_b32 v139, v228, v17, s[8:9]
v_cndmask_b32 v140, v228, v17, s[10:11]
v_mfma_f32_16x16x32_bf16 a[92:95], a[204:207], v[204:207], a[92:95]
v_exp_f32 v135, v135
v_mfma_f32_16x16x32_bf16 a[92:95], a[200:203], v[200:203], a[92:95]
ds_read_b128 a[172:175], v2 offset:23552
v_cvt_pk_bf16_f32 v191, v134, v135
v_mfma_f32_16x16x32_bf16 v[136:139], a[144:147], v[72:75], v[136:139]
ds_read_b128 a[176:179], v2 offset:24576
v_cndmask_b32 v141, v228, v17, s[12:13]
v_mfma_f32_16x16x32_bf16 v[136:139], a[148:151], v[76:79], v[136:139]
ds_read_b128 a[180:183], v2 offset:25600
v_cndmask_b32 v142, v228, v17, s[18:19]
v_cndmask_b32 v143, v228, v17, s[22:23]
v_mfma_f32_16x16x32_bf16 v[136:139], a[152:155], v[80:83], v[136:139]
ds_read_b128 a[184:187], v2 offset:26624
v_cndmask_b32 v144, v228, v17, s[26:27]
v_mfma_f32_16x16x32_bf16 v[136:139], a[156:159], v[84:87], v[136:139]
s_waitcnt lgkmcnt(3)
ds_read_b128 a[188:191], v2 offset:27648
v_cndmask_b32 v145, v228, v17, s[56:57]
v_mfma_f32_16x16x32_bf16 v[140:143], a[172:175], v[84:87], v[140:143]
ds_read_b128 a[192:195], v2 offset:28672
ds_read_b128 a[196:199], v2 offset:29696
ds_read_b128 a[200:203], v2 offset:30720
ds_read_b128 a[204:207], v2 offset:31744
v_mfma_f32_16x16x32_bf16 v[140:143], a[168:171], v[80:83], v[140:143]
ds_read_b128 a[144:147], v3 offset:16384
v_cndmask_b32 v146, v228, v17, s[58:59]
v_cndmask_b32 v147, v228, v17, s[60:61]
v_mfma_f32_16x16x32_bf16 v[140:143], a[164:167], v[76:79], v[140:143]
ds_read_b128 a[148:151], v3 offset:24576
v_cndmask_b32 v148, v228, v17, s[62:63]
v_mfma_f32_16x16x32_bf16 v[140:143], a[160:163], v[72:75], v[140:143]
s_waitcnt lgkmcnt(8)
ds_read_b128 a[152:155], v3 offset:17408
v_cndmask_b32 v149, v228, v17, s[48:49]
v_mfma_f32_16x16x32_bf16 v[144:147], a[176:179], v[72:75], v[144:147]
ds_read_b128 a[156:159], v3 offset:25600
v_cndmask_b32 v150, v228, v17, s[50:51]
v_mfma_f32_16x16x32_bf16 v[144:147], a[180:183], v[76:79], v[144:147]
s_waitcnt lgkmcnt(8)
ds_read_b128 a[160:163], v3 offset:18432
v_cndmask_b32 v151, v228, v17, s[100:101]
v_mfma_f32_16x16x32_bf16 v[144:147], a[184:187], v[80:83], v[144:147]
v_exp_f32 v136, v136
v_mfma_f32_16x16x32_bf16 v[144:147], a[188:191], v[84:87], v[144:147]
s_waitcnt lgkmcnt(4)
v_exp_f32 v137, v137
v_mfma_f32_16x16x32_bf16 v[148:151], a[204:207], v[84:87], v[148:151]
v_exp_f32 v138, v138
v_mfma_f32_16x16x32_bf16 v[148:151], a[200:203], v[80:83], v[148:151]
s_add_u32 s65, s84, 0
v_exp_f32 v139, v139
v_mfma_f32_16x16x32_bf16 v[148:151], a[196:199], v[76:79], v[148:151]
buffer_load_dwordx4 a[208:211], v14, s[44:47], s65 offen offset:0 sc1
v_mfma_f32_16x16x32_bf16 v[148:151], a[192:195], v[72:75], v[148:151]
ds_read_b128 a[164:167], v3 offset:26624
v_cvt_pk_bf16_f32 v208, v136, v137
v_smfmac_f32_16x16x64_bf16 a[136:139], a[240:243], v[184:191], v5
ds_read_b128 a[168:171], v3 offset:19456
v_smfmac_f32_16x16x64_bf16 a[140:143], a[240:243], v[192:199], v5
ds_read_b128 a[172:175], v3 offset:27648
v_mfma_f32_16x16x32_bf16 a[64:67], a[144:147], v[184:187], a[64:67]
s_waitcnt lgkmcnt(3)
v_exp_f32 v140, v140
v_mfma_f32_16x16x32_bf16 a[64:67], a[148:151], v[188:191], a[64:67]
buffer_load_dwordx4 a[216:219], v14, s[44:47], s65 offen offset:1024 sc1
v_mfma_f32_16x16x32_bf16 a[96:99], a[148:151], v[196:199], a[96:99]
v_exp_f32 v141, v141
v_mfma_f32_16x16x32_bf16 a[96:99], a[144:147], v[192:195], a[96:99]
buffer_load_dwordx4 a[224:227], v15, s[44:47], s65 offen offset:0 sc1
v_mfma_f32_16x16x32_bf16 a[100:103], a[152:155], v[192:195], a[100:103]
v_exp_f32 v142, v142
v_mfma_f32_16x16x32_bf16 a[100:103], a[156:159], v[196:199], a[100:103]
buffer_load_dwordx4 a[232:235], v15, s[44:47], s65 offen offset:1024 sc1
v_mfma_f32_16x16x32_bf16 a[68:71], a[156:159], v[188:191], a[68:71]
s_add_u32 s65, s84, 8192
ds_read_b128 a[176:179], v3 offset:20480
v_cvt_pk_bf16_f32 v209, v138, v139
v_mfma_f32_16x16x32_bf16 a[68:71], a[152:155], v[184:187], a[68:71]
buffer_load_dwordx4 a[212:215], v14, s[44:47], s65 offen offset:0 sc1
v_mfma_f32_16x16x32_bf16 a[72:75], a[160:163], v[184:187], a[72:75]
s_waitcnt lgkmcnt(1)
ds_read_b128 a[180:183], v3 offset:28672
v_cvt_pk_bf16_f32 v210, v140, v141
v_mfma_f32_16x16x32_bf16 a[72:75], a[164:167], v[188:191], a[72:75]
v_exp_f32 v143, v143
v_mfma_f32_16x16x32_bf16 a[104:107], a[164:167], v[196:199], a[104:107]
buffer_load_dwordx4 a[220:223], v14, s[44:47], s65 offen offset:1024 sc1
v_mfma_f32_16x16x32_bf16 a[104:107], a[160:163], v[192:195], a[104:107]
v_exp_f32 v144, v144
v_mfma_f32_16x16x32_bf16 a[108:111], a[168:171], v[192:195], a[108:111]
ds_read_b128 a[184:187], v3 offset:21504
v_xor_b32 v2, 0x8000, v2
v_mfma_f32_16x16x32_bf16 a[108:111], a[172:175], v[196:199], a[108:111]
buffer_load_dwordx4 a[228:231], v15, s[44:47], s65 offen offset:0 sc1
ds_read_b128 a[188:191], v3 offset:29696
v_mfma_f32_16x16x32_bf16 a[76:79], a[172:175], v[188:191], a[76:79]
v_exp_f32 v145, v145
v_mfma_f32_16x16x32_bf16 a[76:79], a[168:171], v[184:187], a[76:79]
s_waitcnt lgkmcnt(2)
buffer_load_dwordx4 a[236:239], v15, s[44:47], s65 offen offset:1024 sc1
v_mfma_f32_16x16x32_bf16 a[80:83], a[176:179], v[184:187], a[80:83]
s_add_u32 s65, s84, 32768
ds_read_b128 a[192:195], v3 offset:22528
v_cvt_pk_bf16_f32 v211, v142, v143
v_mfma_f32_16x16x32_bf16 a[80:83], a[180:183], v[188:191], a[80:83]
buffer_load_dwordx4 v[152:155], v14, s[44:47], s65 offen offset:0 sc1
ds_read_b128 a[196:199], v3 offset:30720
v_exp_f32 v146, v146
v_mfma_f32_16x16x32_bf16 a[112:115], a[180:183], v[196:199], a[112:115]
ds_read_b128 a[200:203], v3 offset:23552
ds_read_b128 a[204:207], v3 offset:31744
v_mfma_f32_16x16x32_bf16 a[112:115], a[176:179], v[192:195], a[112:115]
s_waitcnt vmcnt(9)
s_barrier
v_xor_b32 v3, 0x8000, v3
buffer_load_dwordx4 v[160:163], v14, s[44:47], s65 offen offset:1024 sc1
s_waitcnt lgkmcnt(4)
v_mfma_f32_16x16x32_bf16 a[116:119], a[184:187], v[192:195], a[116:119]
v_exp_f32 v147, v147
v_mfma_f32_16x16x32_bf16 a[116:119], a[188:191], v[196:199], a[116:119]
buffer_load_dwordx4 v[168:171], v15, s[44:47], s65 offen offset:0 sc1
v_mfma_f32_16x16x32_bf16 a[84:87], a[188:191], v[188:191], a[84:87]
v_exp_f32 v148, v148
v_mfma_f32_16x16x32_bf16 a[84:87], a[184:187], v[184:187], a[84:87]
s_waitcnt lgkmcnt(2)
buffer_load_dwordx4 v[176:179], v15, s[44:47], s65 offen offset:1024 sc1
v_cvt_pk_bf16_f32 v212, v144, v145
v_mfma_f32_16x16x32_bf16 a[88:91], a[192:195], v[184:187], a[88:91]
s_add_u32 s65, s84, 40960
v_exp_f32 v149, v149
v_mfma_f32_16x16x32_bf16 a[88:91], a[196:199], v[188:191], a[88:91]
buffer_load_dwordx4 v[156:159], v14, s[44:47], s65 offen offset:0 sc1
v_mfma_f32_16x16x32_bf16 a[120:123], a[196:199], v[196:199], a[120:123]
ds_read_b128 a[144:147], v3 offset:0
v_cvt_pk_bf16_f32 v213, v146, v147
v_mfma_f32_16x16x32_bf16 a[120:123], a[192:195], v[192:195], a[120:123]
s_waitcnt lgkmcnt(1)
buffer_load_dwordx4 v[164:167], v14, s[44:47], s65 offen offset:1024 sc1
ds_read_b128 a[148:151], v3 offset:8192
v_exp_f32 v150, v150
v_mfma_f32_16x16x32_bf16 a[124:127], a[200:203], v[192:195], a[124:127]
ds_read_b128 a[152:155], v3 offset:1024
v_cvt_pk_bf16_f32 v214, v148, v149
v_mfma_f32_16x16x32_bf16 a[124:127], a[204:207], v[196:199], a[124:127]
buffer_load_dwordx4 v[172:175], v15, s[44:47], s65 offen offset:0 sc1
ds_read_b128 a[156:159], v3 offset:9216
v_mfma_f32_16x16x32_bf16 a[92:95], a[204:207], v[188:191], a[92:95]
v_exp_f32 v151, v151
v_mfma_f32_16x16x32_bf16 a[92:95], a[200:203], v[184:187], a[92:95]
buffer_load_dwordx4 v[180:183], v15, s[44:47], s65 offen offset:1024 sc1
ds_read_b128 a[160:163], v3 offset:2048
ds_read_b128 a[164:167], v3 offset:10240
ds_read_b128 a[168:171], v3 offset:3072
ds_read_b128 a[172:175], v3 offset:11264
v_cvt_pk_bf16_f32 v215, v150, v151
v_accvgpr_read_b32 v22, a136
v_accvgpr_read_b32 v248, a137
v_add_f32 v22, v22, v248
v_max_f32 v1, v1, v22
v_rcp_f32 v22, v22
v_accvgpr_read_b32 v232, a64
v_accvgpr_read_b32 v233, a65
v_accvgpr_read_b32 v234, a66
v_accvgpr_read_b32 v235, a67
v_accvgpr_read_b32 v236, a68
v_accvgpr_read_b32 v237, a69
v_accvgpr_read_b32 v238, a70
v_accvgpr_read_b32 v239, a71
v_mul_f32 v22, v22, v8
v_mul_f32 v232, v232, v22
v_mul_f32 v233, v233, v22
v_mul_f32 v234, v234, v22
v_mul_f32 v235, v235, v22
v_mul_f32 v236, v236, v22
v_mul_f32 v237, v237, v22
v_mul_f32 v238, v238, v22
v_mul_f32 v239, v239, v22
v_cvt_pk_bf16_f32 v232, v232, v233
v_cvt_pk_bf16_f32 v233, v234, v235
v_cvt_pk_bf16_f32 v234, v236, v237
v_cvt_pk_bf16_f32 v235, v238, v239
s_add_u32 s77, s75, 0
buffer_store_dwordx4 v[232:235], v16, s[44:47], s77 offen sc1
L_TAIL:
ds_read_b128 a[176:179], v3 offset:4096
ds_read_b128 a[180:183], v3 offset:12288
ds_read_b128 a[184:187], v3 offset:5120
ds_read_b128 a[188:191], v3 offset:13312
v_smfmac_f32_16x16x64_bf16 a[140:143], a[240:243], v[208:215], v5
s_waitcnt lgkmcnt(11)
s_add_u32 m0, s86, 32768
s_add_u32 s64, s85, 262144
ds_read_b128 a[192:195], v3 offset:6144
v_mfma_f32_16x16x32_bf16 a[96:99], a[144:147], v[208:211], a[96:99]
s_waitcnt lgkmcnt(11)
ds_read_b128 a[196:199], v3 offset:14336
ds_read_b128 a[200:203], v3 offset:7168
ds_read_b128 a[204:207], v3 offset:15360
v_mfma_f32_16x16x32_bf16 a[96:99], a[148:151], v[212:215], a[96:99]
s_waitcnt lgkmcnt(12)
buffer_load_dwordx4 v12, s[36:39], s64 offen lds
v_mfma_f32_16x16x32_bf16 a[100:103], a[156:159], v[212:215], a[100:103]
s_add_u32 m0, s86, 33792
s_add_u32 s64, s85, 270336
v_accvgpr_read_b32 v240, a72
v_accvgpr_read_b32 v241, a73
v_mfma_f32_16x16x32_bf16 a[100:103], a[152:155], v[208:211], a[100:103]
s_waitcnt lgkmcnt(11)
buffer_load_dwordx4 v13, s[36:39], s64 offen lds
v_mfma_f32_16x16x32_bf16 a[104:107], a[160:163], v[208:211], a[104:107]
s_waitcnt lgkmcnt(10)
s_add_u32 m0, s86, 34816
s_add_u32 s64, s85, 278528
v_accvgpr_read_b32 v242, a74
v_accvgpr_read_b32 v243, a75
v_mfma_f32_16x16x32_bf16 a[104:107], a[164:167], v[212:215], a[104:107]
s_waitcnt lgkmcnt(8)
buffer_load_dwordx4 v12, s[36:39], s64 offen lds
v_mfma_f32_16x16x32_bf16 a[108:111], a[172:175], v[212:215], a[108:111]
s_add_u32 m0, s86, 35840
s_add_u32 s64, s85, 286720
v_accvgpr_read_b32 v244, a76
v_accvgpr_read_b32 v245, a77
v_mfma_f32_16x16x32_bf16 a[108:111], a[168:171], v[208:211], a[108:111]
s_waitcnt lgkmcnt(7)
buffer_load_dwordx4 v13, s[36:39], s64 offen lds
v_mfma_f32_16x16x32_bf16 a[112:115], a[176:179], v[208:211], a[112:115]
s_waitcnt lgkmcnt(6)
s_add_u32 m0, s86, 36864
s_add_u32 s64, s85, 294912
v_accvgpr_read_b32 v246, a78
v_accvgpr_read_b32 v247, a79
v_mfma_f32_16x16x32_bf16 a[112:115], a[180:183], v[212:215], a[112:115]
s_waitcnt lgkmcnt(4)
buffer_load_dwordx4 v12, s[36:39], s64 offen lds
v_mfma_f32_16x16x32_bf16 a[116:119], a[188:191], v[212:215], a[116:119]
s_add_u32 m0, s86, 37888
s_add_u32 s64, s85, 303104
v_mul_f32 v240, v240, v22
v_mul_f32 v241, v241, v22
v_mfma_f32_16x16x32_bf16 a[116:119], a[184:187], v[208:211], a[116:119]
s_waitcnt lgkmcnt(3)
buffer_load_dwordx4 v13, s[36:39], s64 offen lds
v_mfma_f32_16x16x32_bf16 a[120:123], a[192:195], v[208:211], a[120:123]
s_waitcnt lgkmcnt(2)
s_add_u32 m0, s86, 38912
s_add_u32 s64, s85, 311296
v_mul_f32 v242, v242, v22
v_mul_f32 v243, v243, v22
v_mfma_f32_16x16x32_bf16 a[120:123], a[196:199], v[212:215], a[120:123]
s_waitcnt lgkmcnt(0)
buffer_load_dwordx4 v12, s[36:39], s64 offen lds
v_mfma_f32_16x16x32_bf16 a[124:127], a[204:207], v[212:215], a[124:127]
s_add_u32 m0, s86, 39936
s_add_u32 s64, s85, 319488
v_mul_f32 v244, v244, v22
v_mul_f32 v245, v245, v22
v_mfma_f32_16x16x32_bf16 a[124:127], a[200:203], v[208:211], a[124:127]
buffer_load_dwordx4 v13, s[36:39], s64 offen lds
v_mul_f32 v246, v246, v22
v_mul_f32 v247, v247, v22
v_cvt_pk_bf16_f32 v240, v240, v241
v_cvt_pk_bf16_f32 v241, v242, v243
v_cvt_pk_bf16_f32 v242, v244, v245
v_cvt_pk_bf16_f32 v243, v246, v247
s_add_u32 s77, s75, 8192
buffer_store_dwordx4 v[240:243], v16, s[44:47], s77 offen sc1
v_accvgpr_read_b32 v23, a140
v_accvgpr_read_b32 v248, a141
v_add_f32 v23, v23, v248
v_max_f32 v1, v1, v23
v_rcp_f32 v23, v23
s_mov_b32 s66, 0x5d800000
v_cmp_le_f32 vcc, s66, v1
s_lshl_b32 s67, s30, 2
s_cmp_lg_u64 vcc, 0
s_cselect_b32 s66, 1, 0
v_mov_b32 v248, s67
v_mov_b32 v249, s66
ds_write_b32 v248, v249
v_accvgpr_read_b32 v232, a80
v_accvgpr_read_b32 v233, a81
v_accvgpr_read_b32 v234, a82
v_accvgpr_read_b32 v235, a83
v_accvgpr_read_b32 v236, a84
v_accvgpr_read_b32 v237, a85
v_accvgpr_read_b32 v238, a86
v_accvgpr_read_b32 v239, a87
v_pk_mul_f32 v[232:233], v[232:233], v[22:23] op_sel_hi:[1,0]
v_pk_mul_f32 v[234:235], v[234:235], v[22:23] op_sel_hi:[1,0]
v_pk_mul_f32 v[236:237], v[236:237], v[22:23] op_sel_hi:[1,0]
v_pk_mul_f32 v[238:239], v[238:239], v[22:23] op_sel_hi:[1,0]
v_cvt_pk_bf16_f32 v232, v232, v233
v_cvt_pk_bf16_f32 v233, v234, v235
v_cvt_pk_bf16_f32 v234, v236, v237
v_cvt_pk_bf16_f32 v235, v238, v239
s_add_u32 s77, s75, 16384
buffer_store_dwordx4 v[232:235], v16, s[44:47], s77 offen sc1
v_accvgpr_read_b32 v240, a88
v_accvgpr_read_b32 v241, a89
v_accvgpr_read_b32 v242, a90
v_accvgpr_read_b32 v243, a91
v_accvgpr_read_b32 v244, a92
v_accvgpr_read_b32 v245, a93
v_accvgpr_read_b32 v246, a94
v_accvgpr_read_b32 v247, a95
v_pk_mul_f32 v[240:241], v[240:241], v[22:23] op_sel_hi:[1,0]
v_pk_mul_f32 v[242:243], v[242:243], v[22:23] op_sel_hi:[1,0]
v_pk_mul_f32 v[244:245], v[244:245], v[22:23] op_sel_hi:[1,0]
v_pk_mul_f32 v[246:247], v[246:247], v[22:23] op_sel_hi:[1,0]
v_cvt_pk_bf16_f32 v240, v240, v241
v_cvt_pk_bf16_f32 v241, v242, v243
v_cvt_pk_bf16_f32 v242, v244, v245
v_cvt_pk_bf16_f32 v243, v246, v247
s_add_u32 s77, s75, 24576
buffer_store_dwordx4 v[240:243], v16, s[44:47], s77 offen sc1
v_accvgpr_read_b32 v232, a96
v_accvgpr_read_b32 v233, a97
v_accvgpr_read_b32 v234, a98
v_accvgpr_read_b32 v235, a99
v_accvgpr_read_b32 v236, a100
v_accvgpr_read_b32 v237, a101
v_accvgpr_read_b32 v238, a102
v_accvgpr_read_b32 v239, a103
v_mul_f32 v23, v23, v10
v_pk_mul_f32 v[232:233], v[232:233], v[22:23] op_sel:[0,1]
v_pk_mul_f32 v[234:235], v[234:235], v[22:23] op_sel:[0,1]
v_pk_mul_f32 v[236:237], v[236:237], v[22:23] op_sel:[0,1]
v_pk_mul_f32 v[238:239], v[238:239], v[22:23] op_sel:[0,1]
v_cvt_pk_bf16_f32 v232, v232, v233
v_cvt_pk_bf16_f32 v233, v234, v235
v_cvt_pk_bf16_f32 v234, v236, v237
v_cvt_pk_bf16_f32 v235, v238, v239
s_add_u32 s77, s75, 4096
buffer_store_dwordx4 v[232:235], v16, s[44:47], s77 offen sc1
v_accvgpr_read_b32 v240, a104
v_accvgpr_read_b32 v241, a105
v_accvgpr_read_b32 v242, a106
v_accvgpr_read_b32 v243, a107
v_accvgpr_read_b32 v244, a108
v_accvgpr_read_b32 v245, a109
v_accvgpr_read_b32 v246, a110
v_accvgpr_read_b32 v247, a111
v_pk_mul_f32 v[240:241], v[240:241], v[22:23] op_sel:[0,1]
v_pk_mul_f32 v[242:243], v[242:243], v[22:23] op_sel:[0,1]
v_pk_mul_f32 v[244:245], v[244:245], v[22:23] op_sel:[0,1]
v_pk_mul_f32 v[246:247], v[246:247], v[22:23] op_sel:[0,1]
v_cvt_pk_bf16_f32 v240, v240, v241
v_cvt_pk_bf16_f32 v241, v242, v243
v_cvt_pk_bf16_f32 v242, v244, v245
v_cvt_pk_bf16_f32 v243, v246, v247
s_add_u32 s77, s75, 12288
buffer_store_dwordx4 v[240:243], v16, s[44:47], s77 offen sc1
v_accvgpr_read_b32 v232, a112
v_accvgpr_read_b32 v233, a113
v_accvgpr_read_b32 v234, a114
v_accvgpr_read_b32 v235, a115
v_accvgpr_read_b32 v236, a116
v_accvgpr_read_b32 v237, a117
v_accvgpr_read_b32 v238, a118
v_accvgpr_read_b32 v239, a119
v_pk_mul_f32 v[232:233], v[232:233], v[22:23] op_sel:[0,1]
v_pk_mul_f32 v[234:235], v[234:235], v[22:23] op_sel:[0,1]
v_pk_mul_f32 v[236:237], v[236:237], v[22:23] op_sel:[0,1]
v_pk_mul_f32 v[238:239], v[238:239], v[22:23] op_sel:[0,1]
v_cvt_pk_bf16_f32 v232, v232, v233
v_cvt_pk_bf16_f32 v233, v234, v235
v_cvt_pk_bf16_f32 v234, v236, v237
v_cvt_pk_bf16_f32 v235, v238, v239
s_add_u32 s77, s75, 20480
buffer_store_dwordx4 v[232:235], v16, s[44:47], s77 offen sc1
v_accvgpr_read_b32 v240, a120
v_accvgpr_read_b32 v241, a121
v_accvgpr_read_b32 v242, a122
v_accvgpr_read_b32 v243, a123
v_accvgpr_read_b32 v244, a124
v_accvgpr_read_b32 v245, a125
v_accvgpr_read_b32 v246, a126
v_accvgpr_read_b32 v247, a127
v_pk_mul_f32 v[240:241], v[240:241], v[22:23] op_sel:[0,1]
v_pk_mul_f32 v[242:243], v[242:243], v[22:23] op_sel:[0,1]
v_pk_mul_f32 v[244:245], v[244:245], v[22:23] op_sel:[0,1]
v_pk_mul_f32 v[246:247], v[246:247], v[22:23] op_sel:[0,1]
v_cvt_pk_bf16_f32 v240, v240, v241
v_cvt_pk_bf16_f32 v241, v242, v243
v_cvt_pk_bf16_f32 v242, v244, v245
v_cvt_pk_bf16_f32 v243, v246, v247
s_add_u32 s77, s75, 28672
buffer_store_dwordx4 v[240:243], v16, s[44:47], s77 offen sc1
v_mov_b32 v248, 0
s_waitcnt lgkmcnt(0)
s_barrier
ds_read_b128 v[248:251], v248
v_xor_b32 v188, 128, v18
v_xor_b32 v189, 160, v18
v_xor_b32 v190, 192, v18
ds_read_b64_tr_b16 a[144:145], v188 offset:32768
ds_read_b64_tr_b16 a[146:147], v188 offset:36864
ds_read_b64_tr_b16 a[148:149], v188 offset:40960
ds_read_b64_tr_b16 a[150:151], v188 offset:45056
ds_read_b64_tr_b16 a[152:153], v189 offset:32768
ds_read_b64_tr_b16 a[154:155], v189 offset:36864
ds_read_b64_tr_b16 a[156:157], v189 offset:40960
ds_read_b64_tr_b16 a[158:159], v189 offset:45056
ds_read_b64_tr_b16 a[160:161], v190 offset:32768
ds_read_b64_tr_b16 a[162:163], v190 offset:36864
ds_read_b64_tr_b16 a[164:165], v190 offset:40960
ds_read_b64_tr_b16 a[166:167], v190 offset:45056
v_xor_b32 v191, 224, v18
v_xor_b32 v184, 0, v18
v_xor_b32 v185, 32, v18
v_xor_b32 v186, 64, v18
v_xor_b32 v187, 96, v18
s_waitcnt lgkmcnt(12)
v_or3_b32 v248, v248, v249, v250
v_or_b32 v248, v248, v251
s_nop 0
v_readfirstlane_b32 s66, v248
s_nop 0
s_cmp_gt_u32 s66, s73
s_cbranch_scc1 L_fallback_11
s_cmp_eq_u32 s83, 0
s_cbranch_scc1 L_p5f0
s_waitcnt lgkmcnt(10)
s_waitcnt vmcnt(28)
v_mfma_f32_16x16x32_bf16 v[136:139], a[144:147], a[232:235], 0
s_waitcnt vmcnt(24)
s_waitcnt lgkmcnt(8)
s_and_b32 s68, s82, 3
s_lshl_b32 s68, s68, 11
s_add_u32 m0, s86, 98304
ds_read_b64_tr_b16 a[168:169], v191 offset:32768
v_mfma_f32_16x16x32_bf16 v[136:139], a[148:151], a[236:239], v[136:139]
s_add_u32 s76, s86, s68
s_lshr_b32 s69, s87, 8
s_add_u32 s64, s85, 524288
ds_read_b64_tr_b16 a[170:171], v191 offset:36864
v_mfma_f32_16x16x32_bf16 v[104:107], a[148:151], a[228:231], 0
s_lshr_b32 s67, s82, 1
buffer_load_dwordx4 v12, s[36:39], s64 offen lds
v_mfma_f32_16x16x32_bf16 v[104:107], a[144:147], a[224:227], v[104:107]
s_xor_b32 s69, s69, s67
s_and_b32 s69, s69, 2
s_add_u32 m0, s86, 99328
s_add_u32 s64, s85, 532480
ds_read_b64_tr_b16 a[172:173], v191 offset:40960
v_mfma_f32_16x16x32_bf16 v[72:75], a[144:147], a[216:219], 0
s_and_b32 s71, s31, 4
buffer_load_dwordx4 v13, s[36:39], s64 offen lds
v_mfma_f32_16x16x32_bf16 v[72:75], a[148:151], a[220:223], v[72:75]
s_lshl_b32 s71, s71, 5
s_add_u32 s71, s71, s79
s_add_u32 m0, s86, 100352
s_add_u32 s64, s85, 540672
ds_read_b64_tr_b16 a[174:175], v191 offset:45056
v_mfma_f32_16x16x32_bf16 v[40:43], a[148:151], a[212:215], 0
s_add_u32 s71, s71, 4096
buffer_load_dwordx4 v12, s[36:39], s64 offen lds
v_mfma_f32_16x16x32_bf16 v[40:43], a[144:147], a[208:211], v[40:43]
s_waitcnt lgkmcnt(4)
s_add_u32 s72, s80, 4096
s_lshl_b32 s69, s69, 15
s_add_u32 m0, s86, 101376
s_add_u32 s64, s85, 548864
ds_read_b64_tr_b16 a[176:177], v184 offset:32768
v_mfma_f32_16x16x32_bf16 v[44:47], a[152:155], a[208:211], 0
s_add_u32 s68, s68, s69
buffer_load_dwordx4 v13, s[36:39], s64 offen lds
v_mfma_f32_16x16x32_bf16 v[44:47], a[156:159], a[212:215], v[44:47]
s_add_u32 m0, s86, 102400
ds_read_b64_tr_b16 a[178:179], v184 offset:36864
v_xor_b32 v192, 0x10000, v184
v_mfma_f32_16x16x32_bf16 v[76:79], a[156:159], a[220:223], 0
s_add_u32 s64, s85, 557056
ds_read_b64_tr_b16 a[180:181], v184 offset:40960
v_xor_b32 v193, 0x10000, v185
v_mfma_f32_16x16x32_bf16 v[76:79], a[152:155], a[216:219], v[76:79]
buffer_load_dwordx4 v12, s[36:39], s64 offen lds
v_mfma_f32_16x16x32_bf16 v[108:111], a[152:155], a[224:227], 0
s_add_u32 m0, s86, 103424
s_add_u32 s64, s85, 565248
ds_read_b64_tr_b16 a[182:183], v184 offset:45056
v_xor_b32 v194, 0x10000, v186
v_mfma_f32_16x16x32_bf16 v[108:111], a[156:159], a[228:231], v[108:111]
buffer_load_dwordx4 v13, s[36:39], s64 offen lds
v_mfma_f32_16x16x32_bf16 v[140:143], a[156:159], a[236:239], 0
s_add_u32 m0, s86, 104448
s_add_u32 s64, s85, 573440
ds_read_b64_tr_b16 a[184:185], v185 offset:32768
v_xor_b32 v195, 0x10000, v187
v_mfma_f32_16x16x32_bf16 v[140:143], a[152:155], a[232:235], v[140:143]
s_branch L_po20
L_pg20:
s_branch L_pg24
L_po20:
buffer_load_dwordx4 v12, s[36:39], s64 offen lds
v_mfma_f32_16x16x32_bf16 v[144:147], a[160:163], a[232:235], 0
s_add_u32 m0, s86, 105472
ds_read_b64_tr_b16 a[186:187], v185 offset:36864
v_xor_b32 v196, 0x10000, v188
v_mfma_f32_16x16x32_bf16 v[144:147], a[164:167], a[236:239], v[144:147]
s_add_u32 s64, s85, 581632
ds_read_b64_tr_b16 a[188:189], v185 offset:40960
v_xor_b32 v197, 0x10000, v189
v_mfma_f32_16x16x32_bf16 v[112:115], a[164:167], a[228:231], 0
buffer_load_dwordx4 v13, s[36:39], s64 offen lds
v_mfma_f32_16x16x32_bf16 v[112:115], a[160:163], a[224:227], v[112:115]
s_add_u32 s65, s84, 65536
ds_read_b64_tr_b16 a[190:191], v185 offset:45056
v_xor_b32 v198, 0x10000, v190
v_mfma_f32_16x16x32_bf16 v[80:83], a[160:163], a[216:219], 0
buffer_load_dwordx4 a[32:35], v14, s[44:47], s65 offen offset:0 sc1
v_mfma_f32_16x16x32_bf16 v[80:83], a[164:167], a[220:223], v[80:83]
ds_read_b64_tr_b16 a[192:193], v186 offset:32768
v_xor_b32 v199, 0x10000, v191
v_mfma_f32_16x16x32_bf16 v[48:51], a[164:167], a[212:215], 0
buffer_load_dwordx4 a[40:43], v14, s[44:47], s65 offen offset:1024 sc1
v_mfma_f32_16x16x32_bf16 v[48:51], a[160:163], a[208:211], v[48:51]
s_waitcnt lgkmcnt(4)
ds_read_b64_tr_b16 a[194:195], v186 offset:36864
v_mfma_f32_16x16x32_bf16 v[52:55], a[168:171], a[208:211], 0
ds_read_b64_tr_b16 a[196:197], v186 offset:40960
v_mfma_f32_16x16x32_bf16 v[52:55], a[172:175], a[212:215], v[52:55]
buffer_load_dwordx4 a[48:51], v15, s[44:47], s65 offen offset:0 sc1
v_mfma_f32_16x16x32_bf16 v[84:87], a[172:175], a[220:223], 0
ds_read_b64_tr_b16 a[198:199], v186 offset:45056
v_mfma_f32_16x16x32_bf16 v[84:87], a[168:171], a[216:219], v[84:87]
buffer_load_dwordx4 a[56:59], v15, s[44:47], s65 offen offset:1024 sc1
v_mfma_f32_16x16x32_bf16 v[116:119], a[168:171], a[224:227], 0
s_add_u32 s65, s84, 73728
ds_read_b64_tr_b16 a[200:201], v187 offset:32768
v_mfma_f32_16x16x32_bf16 v[116:119], a[172:175], a[228:231], v[116:119]
buffer_load_dwordx4 a[36:39], v14, s[44:47], s65 offen offset:0 sc1
v_mfma_f32_16x16x32_bf16 v[148:151], a[172:175], a[236:239], 0
ds_read_b64_tr_b16 a[202:203], v187 offset:36864
v_mfma_f32_16x16x32_bf16 v[148:151], a[168:171], a[232:235], v[148:151]
ds_read_b64_tr_b16 a[204:205], v187 offset:40960
v_mfma_f32_16x16x32_bf16 v[120:123], a[176:179], a[232:235], 0
buffer_load_dwordx4 a[44:47], v14, s[44:47], s65 offen offset:1024 sc1
v_mfma_f32_16x16x32_bf16 v[120:123], a[180:183], a[236:239], v[120:123]
ds_read_b64_tr_b16 a[206:207], v187 offset:45056
v_mfma_f32_16x16x32_bf16 v[88:91], a[180:183], a[228:231], 0
buffer_load_dwordx4 a[52:55], v15, s[44:47], s65 offen offset:0 sc1
v_mfma_f32_16x16x32_bf16 v[88:91], a[176:179], a[224:227], v[88:91]
v_mfma_f32_16x16x32_bf16 v[56:59], a[176:179], a[216:219], 0
buffer_load_dwordx4 a[60:63], v15, s[44:47], s65 offen offset:1024 sc1
v_mfma_f32_16x16x32_bf16 v[56:59], a[180:183], a[220:223], v[56:59]
v_mfma_f32_16x16x32_bf16 v[24:27], a[180:183], a[212:215], 0
v_mfma_f32_16x16x32_bf16 v[24:27], a[176:179], a[208:211], v[24:27]
s_waitcnt lgkmcnt(1)
buffer_load_dword v19, off, s[52:55], s72 sc1
v_mfma_f32_16x16x32_bf16 v[28:31], a[184:187], a[208:211], 0
s_add_u32 s85, s85, 2883584
s_lshl3_add_u32 s85, s68, s85
s_waitcnt vmcnt(24) lgkmcnt(0)
s_barrier
v_mfma_f32_16x16x32_bf16 v[28:31], a[188:191], a[212:215], v[28:31]
ds_read_b64_tr_b16 a[144:145], v196 offset:0
v_mfma_f32_16x16x32_bf16 v[60:63], a[188:191], a[220:223], 0
ds_read_b64_tr_b16 a[146:147], v196 offset:4096
v_mfma_f32_16x16x32_bf16 v[60:63], a[184:187], a[216:219], v[60:63]
s_xor_b32 m0, s76, 131072
ds_read_b64_tr_b16 a[148:149], v196 offset:8192
v_mfma_f32_16x16x32_bf16 v[92:95], a[184:187], a[224:227], 0
s_xor_b32 s64, s85, 0
ds_read_b64_tr_b16 a[150:151], v196 offset:12288
v_mfma_f32_16x16x32_bf16 v[92:95], a[188:191], a[228:231], v[92:95]
buffer_load_dwordx4 v12, s[40:43], s64 offen lds
v_mfma_f32_16x16x32_bf16 v[124:127], a[188:191], a[236:239], 0
s_xor_b32 m0, s76, 132096
ds_read_b64_tr_b16 a[152:153], v197 offset:0
v_mfma_f32_16x16x32_bf16 v[124:127], a[184:187], a[232:235], v[124:127]
s_xor_b32 s64, s85, 8192
ds_read_b64_tr_b16 a[154:155], v197 offset:4096
v_mfma_f32_16x16x32_bf16 v[128:131], a[192:195], a[232:235], 0
buffer_load_dwordx4 v13, s[40:43], s64 offen lds
v_mfma_f32_16x16x32_bf16 v[128:131], a[196:199], a[236:239], v[128:131]
ds_read_b64_tr_b16 a[156:157], v197 offset:8192
v_mfma_f32_16x16x32_bf16 v[96:99], a[196:199], a[228:231], 0
s_xor_b32 m0, s76, 133120
ds_read_b64_tr_b16 a[158:159], v197 offset:12288
v_mfma_f32_16x16x32_bf16 v[96:99], a[192:195], a[224:227], v[96:99]
s_xor_b32 s64, s85, 16384
ds_read_b64_tr_b16 a[160:161], v198 offset:0
v_mfma_f32_16x16x32_bf16 v[64:67], a[192:195], a[216:219], 0
buffer_load_dwordx4 v12, s[40:43], s64 offen lds
v_mfma_f32_16x16x32_bf16 v[64:67], a[196:199], a[220:223], v[64:67]
ds_read_b64_tr_b16 a[162:163], v198 offset:4096
v_mfma_f32_16x16x32_bf16 v[32:35], a[196:199], a[212:215], 0
s_xor_b32 m0, s76, 134144
ds_read_b64_tr_b16 a[164:165], v198 offset:8192
v_mfma_f32_16x16x32_bf16 v[32:35], a[192:195], a[208:211], v[32:35]
s_xor_b32 s64, s85, 24576
ds_read_b64_tr_b16 a[166:167], v198 offset:12288
v_mfma_f32_16x16x32_bf16 v[36:39], a[200:203], a[208:211], 0
buffer_load_dwordx4 v13, s[40:43], s64 offen lds
v_mfma_f32_16x16x32_bf16 v[36:39], a[204:207], a[212:215], v[36:39]
v_mfma_f32_16x16x32_bf16 v[68:71], a[204:207], a[220:223], 0
s_xor_b32 m0, s76, 135168
v_mfma_f32_16x16x32_bf16 v[68:71], a[200:203], a[216:219], v[68:71]
s_xor_b32 s64, s85, 32768
v_mfma_f32_16x16x32_bf16 v[100:103], a[200:203], a[224:227], 0
buffer_load_dwordx4 v12, s[40:43], s64 offen lds
v_mfma_f32_16x16x32_bf16 v[100:103], a[204:207], a[228:231], v[100:103]
v_mfma_f32_16x16x32_bf16 v[132:135], a[204:207], a[236:239], 0
v_mfma_f32_16x16x32_bf16 v[132:135], a[200:203], a[232:235], v[132:135]
s_waitcnt lgkmcnt(0)
v_mfma_f32_16x16x32_bf16 v[136:139], a[144:147], v[176:179], v[136:139]
s_waitcnt vmcnt(5)
v_readfirstlane_b32 vcc_lo, v19
s_nop 0
s_cmp_lt_u32 vcc_lo, 8
s_cbranch_scc1 L_spin_2016
L_spinbk_2017:
s_sub_u32 s84, s84, 688128
s_add_u32 s84, s84, s69
v_mfma_f32_16x16x32_bf16 v[136:139], a[148:151], v[180:183], v[136:139]
s_xor_b32 m0, s76, 136192
s_xor_b32 s64, s85, 40960
ds_read_b64_tr_b16 a[168:169], v199 offset:0
v_mfma_f32_16x16x32_bf16 v[104:107], a[148:151], v[172:175], v[104:107]
buffer_load_dwordx4 v13, s[40:43], s64 offen lds
v_mfma_f32_16x16x32_bf16 v[104:107], a[144:147], v[168:171], v[104:107]
s_xor_b32 m0, s76, 137216
ds_read_b64_tr_b16 a[170:171], v199 offset:4096
v_mfma_f32_16x16x32_bf16 v[72:75], a[144:147], v[160:163], v[72:75]
s_xor_b32 s64, s85, 49152
ds_read_b64_tr_b16 a[172:173], v199 offset:8192
v_mfma_f32_16x16x32_bf16 v[72:75], a[148:151], v[164:167], v[72:75]
buffer_load_dwordx4 v12, s[40:43], s64 offen lds
v_mfma_f32_16x16x32_bf16 v[40:43], a[148:151], v[156:159], v[40:43]
s_xor_b32 m0, s76, 138240
ds_read_b64_tr_b16 a[174:175], v199 offset:12288
v_mfma_f32_16x16x32_bf16 v[40:43], a[144:147], v[152:155], v[40:43]
s_xor_b32 s64, s85, 57344
ds_read_b64_tr_b16 a[176:177], v192 offset:0
v_mfma_f32_16x16x32_bf16 v[44:47], a[152:155], v[152:155], v[44:47]
buffer_load_dwordx4 v13, s[40:43], s64 offen lds
v_mfma_f32_16x16x32_bf16 v[44:47], a[156:159], v[156:159], v[44:47]
ds_read_b64_tr_b16 a[178:179], v192 offset:4096
v_mfma_f32_16x16x32_bf16 v[76:79], a[156:159], v[164:167], v[76:79]
ds_read_b64_tr_b16 a[180:181], v192 offset:8192
v_mfma_f32_16x16x32_bf16 v[76:79], a[152:155], v[160:163], v[76:79]
s_xor_b32 s65, s84, 0
ds_read_b64_tr_b16 a[182:183], v192 offset:12288
v_mfma_f32_16x16x32_bf16 v[108:111], a[152:155], v[168:171], v[108:111]
buffer_load_dwordx4 a[208:211], v14, s[44:47], s65 offen offset:0 sc1
v_mfma_f32_16x16x32_bf16 v[108:111], a[156:159], v[172:175], v[108:111]
ds_read_b64_tr_b16 a[184:185], v193 offset:0
v_mfma_f32_16x16x32_bf16 v[140:143], a[156:159], v[180:183], v[140:143]
ds_read_b64_tr_b16 a[186:187], v193 offset:4096
v_mfma_f32_16x16x32_bf16 v[140:143], a[152:155], v[176:179], v[140:143]
buffer_load_dwordx4 a[216:219], v14, s[44:47], s65 offen offset:1024 sc1
v_mfma_f32_16x16x32_bf16 v[144:147], a[160:163], v[176:179], v[144:147]
ds_read_b64_tr_b16 a[188:189], v193 offset:8192
v_mfma_f32_16x16x32_bf16 v[144:147], a[164:167], v[180:183], v[144:147]
ds_read_b64_tr_b16 a[190:191], v193 offset:12288
v_mfma_f32_16x16x32_bf16 v[112:115], a[164:167], v[172:175], v[112:115]
buffer_load_dwordx4 a[224:227], v15, s[44:47], s65 offen offset:0 sc1
v_mfma_f32_16x16x32_bf16 v[112:115], a[160:163], v[168:171], v[112:115]
ds_read_b64_tr_b16 a[192:193], v194 offset:0
v_mfma_f32_16x16x32_bf16 v[80:83], a[160:163], v[160:163], v[80:83]
ds_read_b64_tr_b16 a[194:195], v194 offset:4096
v_mfma_f32_16x16x32_bf16 v[80:83], a[164:167], v[164:167], v[80:83]
ds_read_b64_tr_b16 a[196:197], v194 offset:8192
v_mfma_f32_16x16x32_bf16 v[48:51], a[164:167], v[156:159], v[48:51]
buffer_load_dwordx4 a[232:235], v15, s[44:47], s65 offen offset:1024 sc1
v_mfma_f32_16x16x32_bf16 v[48:51], a[160:163], v[152:155], v[48:51]
s_waitcnt lgkmcnt(5)
ds_read_b64_tr_b16 a[198:199], v194 offset:12288
v_mfma_f32_16x16x32_bf16 v[52:55], a[168:171], v[152:155], v[52:55]
s_xor_b32 s65, s84, 8192
v_mfma_f32_16x16x32_bf16 v[52:55], a[172:175], v[156:159], v[52:55]
buffer_load_dwordx4 a[212:215], v14, s[44:47], s65 offen offset:0 sc1
v_mfma_f32_16x16x32_bf16 v[84:87], a[172:175], v[164:167], v[84:87]
ds_read_b64_tr_b16 a[200:201], v195 offset:0
v_mfma_f32_16x16x32_bf16 v[84:87], a[168:171], v[160:163], v[84:87]
ds_read_b64_tr_b16 a[202:203], v195 offset:4096
v_mfma_f32_16x16x32_bf16 v[116:119], a[168:171], v[168:171], v[116:119]
s_lshl_b32 s66, s30, 30
buffer_load_dwordx4 a[220:223], v14, s[44:47], s65 offen offset:1024 sc1
v_mfma_f32_16x16x32_bf16 v[116:119], a[172:175], v[172:175], v[116:119]
ds_read_b64_tr_b16 a[204:205], v195 offset:8192
v_lshl_add_u32 v1, v0, 24, s66
v_mfma_f32_16x16x32_bf16 v[148:151], a[172:175], v[180:183], v[148:151]
ds_read_b64_tr_b16 a[206:207], v195 offset:12288
v_mfma_f32_16x16x32_bf16 v[148:151], a[168:171], v[176:179], v[148:151]
v_mfma_f32_16x16x32_bf16 v[120:123], a[176:179], v[176:179], v[120:123]
buffer_load_dwordx4 a[228:231], v15, s[44:47], s65 offen offset:0 sc1
v_mfma_f32_16x16x32_bf16 v[120:123], a[180:183], v[180:183], v[120:123]
v_mfma_f32_16x16x32_bf16 v[88:91], a[180:183], v[172:175], v[88:91]
v_mfma_f32_16x16x32_bf16 v[88:91], a[176:179], v[168:171], v[88:91]
buffer_load_dwordx4 a[236:239], v15, s[44:47], s65 offen offset:1024 sc1
v_mfma_f32_16x16x32_bf16 v[56:59], a[176:179], v[160:163], v[56:59]
v_mfma_f32_16x16x32_bf16 v[56:59], a[180:183], v[164:167], v[56:59]
v_mfma_f32_16x16x32_bf16 v[24:27], a[180:183], v[156:159], v[24:27]
v_mfma_f32_16x16x32_bf16 v[24:27], a[176:179], v[152:155], v[24:27]
v_mfma_f32_16x16x32_bf16 v[28:31], a[184:187], v[152:155], v[28:31]
s_waitcnt lgkmcnt(0)
s_barrier
v_mfma_f32_16x16x32_bf16 v[28:31], a[188:191], v[156:159], v[28:31]
s_mov_b64 exec, 1
buffer_atomic_add a251, v1, s[52:55], s71 offen offset:0 sc1
s_mov_b64 exec, -1
v_mfma_f32_16x16x32_bf16 v[60:63], a[188:191], v[164:167], v[60:63]
ds_read_b64_tr_b16 a[144:145], v188 offset:0
v_mfma_f32_16x16x32_bf16 v[60:63], a[184:187], v[160:163], v[60:63]
s_xor_b32 m0, s76, 32768
ds_read_b64_tr_b16 a[146:147], v188 offset:4096
v_mfma_f32_16x16x32_bf16 v[92:95], a[184:187], v[168:171], v[92:95]
s_xor_b32 s64, s85, 262144
ds_read_b64_tr_b16 a[148:149], v188 offset:8192
v_mfma_f32_16x16x32_bf16 v[92:95], a[188:191], v[172:175], v[92:95]
buffer_load_dwordx4 v12, s[40:43], s64 offen lds
v_mfma_f32_16x16x32_bf16 v[124:127], a[188:191], v[180:183], v[124:127]
s_xor_b32 m0, s76, 33792
ds_read_b64_tr_b16 a[150:151], v188 offset:12288
v_mfma_f32_16x16x32_bf16 v[124:127], a[184:187], v[176:179], v[124:127]
s_xor_b32 s64, s85, 270336
ds_read_b64_tr_b16 a[152:153], v189 offset:0
v_mfma_f32_16x16x32_bf16 v[128:131], a[192:195], v[176:179], v[128:131]
buffer_load_dwordx4 v13, s[40:43], s64 offen lds
v_mfma_f32_16x16x32_bf16 v[128:131], a[196:199], v[180:183], v[128:131]
ds_read_b64_tr_b16 a[154:155], v189 offset:4096
v_mfma_f32_16x16x32_bf16 v[96:99], a[196:199], v[172:175], v[96:99]
s_xor_b32 m0, s76, 34816
ds_read_b64_tr_b16 a[156:157], v189 offset:8192
v_mfma_f32_16x16x32_bf16 v[96:99], a[192:195], v[168:171], v[96:99]
s_xor_b32 s64, s85, 278528
ds_read_b64_tr_b16 a[158:159], v189 offset:12288
v_mfma_f32_16x16x32_bf16 v[64:67], a[192:195], v[160:163], v[64:67]
buffer_load_dwordx4 v12, s[40:43], s64 offen lds
v_mfma_f32_16x16x32_bf16 v[64:67], a[196:199], v[164:167], v[64:67]
ds_read_b64_tr_b16 a[160:161], v190 offset:0
v_mfma_f32_16x16x32_bf16 v[32:35], a[196:199], v[156:159], v[32:35]
s_xor_b32 m0, s76, 35840
ds_read_b64_tr_b16 a[162:163], v190 offset:4096
v_mfma_f32_16x16x32_bf16 v[32:35], a[192:195], v[152:155], v[32:35]
s_xor_b32 s64, s85, 286720
ds_read_b64_tr_b16 a[164:165], v190 offset:8192
v_mfma_f32_16x16x32_bf16 v[36:39], a[200:203], v[152:155], v[36:39]
buffer_load_dwordx4 v13, s[40:43], s64 offen lds
v_mfma_f32_16x16x32_bf16 v[36:39], a[204:207], v[156:159], v[36:39]
ds_read_b64_tr_b16 a[166:167], v190 offset:12288
v_mfma_f32_16x16x32_bf16 v[68:71], a[204:207], v[164:167], v[68:71]
s_xor_b32 m0, s76, 36864
v_mfma_f32_16x16x32_bf16 v[68:71], a[200:203], v[160:163], v[68:71]
s_xor_b32 s64, s85, 294912
v_mfma_f32_16x16x32_bf16 v[100:103], a[200:203], v[168:171], v[100:103]
buffer_load_dwordx4 v12, s[40:43], s64 offen lds
v_mfma_f32_16x16x32_bf16 v[100:103], a[204:207], v[172:175], v[100:103]
v_mfma_f32_16x16x32_bf16 v[132:135], a[204:207], v[180:183], v[132:135]
v_mfma_f32_16x16x32_bf16 v[132:135], a[200:203], v[176:179], v[132:135]
s_waitcnt lgkmcnt(1)
v_mfma_f32_16x16x32_bf16 v[136:139], a[144:147], a[56:59], v[136:139]
s_xor_b32 m0, s76, 37888
ds_read_b64_tr_b16 a[168:169], v191 offset:0
v_mfma_f32_16x16x32_bf16 v[136:139], a[148:151], a[60:63], v[136:139]
s_xor_b32 s64, s85, 303104
ds_read_b64_tr_b16 a[170:171], v191 offset:4096
v_mfma_f32_16x16x32_bf16 v[104:107], a[148:151], a[52:55], v[104:107]
buffer_load_dwordx4 v13, s[40:43], s64 offen lds
v_mfma_f32_16x16x32_bf16 v[104:107], a[144:147], a[48:51], v[104:107]
s_xor_b32 m0, s76, 38912
ds_read_b64_tr_b16 a[172:173], v191 offset:8192
v_mfma_f32_16x16x32_bf16 v[72:75], a[144:147], a[40:43], v[72:75]
s_xor_b32 s64, s85, 311296
ds_read_b64_tr_b16 a[174:175], v191 offset:12288
v_mfma_f32_16x16x32_bf16 v[72:75], a[148:151], a[44:47], v[72:75]
buffer_load_dwordx4 v12, s[40:43], s64 offen lds
v_mfma_f32_16x16x32_bf16 v[40:43], a[148:151], a[36:39], v[40:43]
s_xor_b32 m0, s76, 39936
ds_read_b64_tr_b16 a[176:177], v184 offset:0
v_mfma_f32_16x16x32_bf16 v[40:43], a[144:147], a[32:35], v[40:43]
s_xor_b32 s64, s85, 319488
ds_read_b64_tr_b16 a[178:179], v184 offset:4096
v_mfma_f32_16x16x32_bf16 v[44:47], a[152:155], a[32:35], v[44:47]
buffer_load_dwordx4 v13, s[40:43], s64 offen lds
v_mfma_f32_16x16x32_bf16 v[44:47], a[156:159], a[36:39], v[44:47]
ds_read_b64_tr_b16 a[180:181], v184 offset:8192
v_mfma_f32_16x16x32_bf16 v[76:79], a[156:159], a[44:47], v[76:79]
ds_read_b64_tr_b16 a[182:183], v184 offset:12288
v_mfma_f32_16x16x32_bf16 v[76:79], a[152:155], a[40:43], v[76:79]
s_xor_b32 s65, s84, 32768
ds_read_b64_tr_b16 a[184:185], v185 offset:0
v_mfma_f32_16x16x32_bf16 v[108:111], a[152:155], a[48:51], v[108:111]
buffer_load_dwordx4 v[152:155], v14, s[44:47], s65 offen offset:0 sc1
v_mfma_f32_16x16x32_bf16 v[108:111], a[156:159], a[52:55], v[108:111]
ds_read_b64_tr_b16 a[186:187], v185 offset:4096
v_mfma_f32_16x16x32_bf16 v[140:143], a[156:159], a[60:63], v[140:143]
ds_read_b64_tr_b16 a[188:189], v185 offset:8192
v_mfma_f32_16x16x32_bf16 v[140:143], a[152:155], a[56:59], v[140:143]
buffer_load_dwordx4 v[160:163], v14, s[44:47], s65 offen offset:1024 sc1
v_mfma_f32_16x16x32_bf16 v[144:147], a[160:163], a[56:59], v[144:147]
s_waitcnt lgkmcnt(5)
ds_read_b64_tr_b16 a[190:191], v185 offset:12288
v_mfma_f32_16x16x32_bf16 v[144:147], a[164:167], a[60:63], v[144:147]
v_mfma_f32_16x16x32_bf16 v[112:115], a[164:167], a[52:55], v[112:115]
buffer_load_dwordx4 v[168:171], v15, s[44:47], s65 offen offset:0 sc1
v_mfma_f32_16x16x32_bf16 v[112:115], a[160:163], a[48:51], v[112:115]
ds_read_b64_tr_b16 a[192:193], v186 offset:0
v_mfma_f32_16x16x32_bf16 v[80:83], a[160:163], a[40:43], v[80:83]
ds_read_b64_tr_b16 a[194:195], v186 offset:4096
v_mfma_f32_16x16x32_bf16 v[80:83], a[164:167], a[44:47], v[80:83]
ds_read_b64_tr_b16 a[196:197], v186 offset:8192
v_mfma_f32_16x16x32_bf16 v[48:51], a[164:167], a[36:39], v[48:51]
buffer_load_dwordx4 v[176:179], v15, s[44:47], s65 offen offset:1024 sc1
v_mfma_f32_16x16x32_bf16 v[48:51], a[160:163], a[32:35], v[48:51]
ds_read_b64_tr_b16 a[198:199], v186 offset:12288
v_mfma_f32_16x16x32_bf16 v[52:55], a[168:171], a[32:35], v[52:55]
s_xor_b32 s65, s84, 40960
v_mfma_f32_16x16x32_bf16 v[52:55], a[172:175], a[36:39], v[52:55]
buffer_load_dwordx4 v[156:159], v14, s[44:47], s65 offen offset:0 sc1
v_mfma_f32_16x16x32_bf16 v[84:87], a[172:175], a[44:47], v[84:87]
ds_read_b64_tr_b16 a[200:201], v187 offset:0
v_mfma_f32_16x16x32_bf16 v[84:87], a[168:171], a[40:43], v[84:87]
ds_read_b64_tr_b16 a[202:203], v187 offset:4096
v_mfma_f32_16x16x32_bf16 v[116:119], a[168:171], a[48:51], v[116:119]
buffer_load_dwordx4 v[164:167], v14, s[44:47], s65 offen offset:1024 sc1
v_mfma_f32_16x16x32_bf16 v[116:119], a[172:175], a[52:55], v[116:119]
ds_read_b64_tr_b16 a[204:205], v187 offset:8192
v_mfma_f32_16x16x32_bf16 v[148:151], a[172:175], a[60:63], v[148:151]
ds_read_b64_tr_b16 a[206:207], v187 offset:12288
v_mfma_f32_16x16x32_bf16 v[148:151], a[168:171], a[56:59], v[148:151]
v_mfma_f32_16x16x32_bf16 v[120:123], a[176:179], a[56:59], v[120:123]
s_waitcnt lgkmcnt(4)
buffer_load_dwordx4 v[172:175], v15, s[44:47], s65 offen offset:0 sc1
v_mfma_f32_16x16x32_bf16 v[120:123], a[180:183], a[60:63], v[120:123]
v_mfma_f32_16x16x32_bf16 v[88:91], a[180:183], a[52:55], v[88:91]
v_mfma_f32_16x16x32_bf16 v[88:91], a[176:179], a[48:51], v[88:91]
buffer_load_dwordx4 v[180:183], v15, s[44:47], s65 offen offset:1024 sc1
v_mfma_f32_16x16x32_bf16 v[56:59], a[176:179], a[40:43], v[56:59]
v_mfma_f32_16x16x32_bf16 v[56:59], a[180:183], a[44:47], v[56:59]
v_mfma_f32_16x16x32_bf16 v[24:27], a[180:183], a[36:39], v[24:27]
v_mfma_f32_16x16x32_bf16 v[24:27], a[176:179], a[32:35], v[24:27]
v_mfma_f32_16x16x32_bf16 v[28:31], a[184:187], a[32:35], v[28:31]
s_waitcnt vmcnt(25)
s_barrier
v_mfma_f32_16x16x32_bf16 v[28:31], a[188:191], a[36:39], v[28:31]
ds_read_b64_tr_b16 a[144:145], v188 offset:32768
v_mfma_f32_16x16x32_bf16 v[60:63], a[188:191], a[44:47], v[60:63]
ds_read_b64_tr_b16 a[146:147], v188 offset:36864
v_mfma_f32_16x16x32_bf16 v[60:63], a[184:187], a[40:43], v[60:63]
s_xor_b32 m0, s76, 65536
ds_read_b64_tr_b16 a[148:149], v188 offset:40960
v_mfma_f32_16x16x32_bf16 v[92:95], a[184:187], a[48:51], v[92:95]
s_xor_b32 s64, s85, 524288
ds_read_b64_tr_b16 a[150:151], v188 offset:45056
v_mfma_f32_16x16x32_bf16 v[92:95], a[188:191], a[52:55], v[92:95]
buffer_load_dwordx4 v12, s[40:43], s64 offen lds
v_mfma_f32_16x16x32_bf16 v[124:127], a[188:191], a[60:63], v[124:127]
s_xor_b32 m0, s76, 66560
ds_read_b64_tr_b16 a[152:153], v189 offset:32768
v_mfma_f32_16x16x32_bf16 v[124:127], a[184:187], a[56:59], v[124:127]
s_xor_b32 s64, s85, 532480
ds_read_b64_tr_b16 a[154:155], v189 offset:36864
v_mfma_f32_16x16x32_bf16 v[128:131], a[192:195], a[56:59], v[128:131]
buffer_load_dwordx4 v13, s[40:43], s64 offen lds
v_mfma_f32_16x16x32_bf16 v[128:131], a[196:199], a[60:63], v[128:131]
ds_read_b64_tr_b16 a[156:157], v189 offset:40960
v_mfma_f32_16x16x32_bf16 v[96:99], a[196:199], a[52:55], v[96:99]
s_xor_b32 m0, s76, 67584
ds_read_b64_tr_b16 a[158:159], v189 offset:45056
v_mfma_f32_16x16x32_bf16 v[96:99], a[192:195], a[48:51], v[96:99]
s_xor_b32 s64, s85, 540672
ds_read_b64_tr_b16 a[160:161], v190 offset:32768
v_mfma_f32_16x16x32_bf16 v[64:67], a[192:195], a[40:43], v[64:67]
buffer_load_dwordx4 v12, s[40:43], s64 offen lds
v_mfma_f32_16x16x32_bf16 v[64:67], a[196:199], a[44:47], v[64:67]
ds_read_b64_tr_b16 a[162:163], v190 offset:36864
v_mfma_f32_16x16x32_bf16 v[32:35], a[196:199], a[36:39], v[32:35]
s_xor_b32 m0, s76, 68608
ds_read_b64_tr_b16 a[164:165], v190 offset:40960
v_mfma_f32_16x16x32_bf16 v[32:35], a[192:195], a[32:35], v[32:35]
s_waitcnt lgkmcnt(5)
s_xor_b32 s64, s85, 548864
ds_read_b64_tr_b16 a[166:167], v190 offset:45056
v_mfma_f32_16x16x32_bf16 v[36:39], a[200:203], a[32:35], v[36:39]
buffer_load_dwordx4 v13, s[40:43], s64 offen lds
v_mfma_f32_16x16x32_bf16 v[36:39], a[204:207], a[36:39], v[36:39]
v_mfma_f32_16x16x32_bf16 v[68:71], a[204:207], a[44:47], v[68:71]
s_xor_b32 m0, s76, 69632
v_mfma_f32_16x16x32_bf16 v[68:71], a[200:203], a[40:43], v[68:71]
s_xor_b32 s64, s85, 557056
v_mfma_f32_16x16x32_bf16 v[100:103], a[200:203], a[48:51], v[100:103]
buffer_load_dwordx4 v12, s[40:43], s64 offen lds
v_mfma_f32_16x16x32_bf16 v[100:103], a[204:207], a[52:55], v[100:103]
s_mov_b32 s70, 3
s_mov_b32 s73, 2
v_mfma_f32_16x16x32_bf16 v[132:135], a[204:207], a[60:63], v[132:135]
v_mfma_f32_16x16x32_bf16 v[132:135], a[200:203], a[56:59], v[132:135]
s_branch L_p5join
.p2align 12
L_pg21:
s_branch L_pg25
L_p5join:
L_p5loop:
s_waitcnt lgkmcnt(10)
s_waitcnt vmcnt(19)
v_mfma_f32_16x16x32_bf16 v[136:139], a[144:147], a[232:235], v[136:139]
s_waitcnt vmcnt(15)
s_waitcnt lgkmcnt(8)
s_xor_b32 m0, s76, 70656
s_xor_b32 s64, s85, 565248
ds_read_b64_tr_b16 a[168:169], v191 offset:32768
v_mfma_f32_16x16x32_bf16 v[136:139], a[148:151], a[236:239], v[136:139]
buffer_load_dwordx4 v13, s[40:43], s64 offen lds
v_mfma_f32_16x16x32_bf16 v[104:107], a[148:151], a[228:231], v[104:107]
s_xor_b32 m0, s76, 71680
ds_read_b64_tr_b16 a[170:171], v191 offset:36864
v_mfma_f32_16x16x32_bf16 v[104:107], a[144:147], a[224:227], v[104:107]
s_xor_b32 s64, s85, 573440
ds_read_b64_tr_b16 a[172:173], v191 offset:40960
v_mfma_f32_16x16x32_bf16 v[72:75], a[144:147], a[216:219], v[72:75]
buffer_load_dwordx4 v12, s[40:43], s64 offen lds
v_mfma_f32_16x16x32_bf16 v[72:75], a[148:151], a[220:223], v[72:75]
s_xor_b32 m0, s76, 72704
ds_read_b64_tr_b16 a[174:175], v191 offset:45056
v_mfma_f32_16x16x32_bf16 v[40:43], a[148:151], a[212:215], v[40:43]
s_xor_b32 s64, s85, 581632
ds_read_b64_tr_b16 a[176:177], v184 offset:32768
v_mfma_f32_16x16x32_bf16 v[40:43], a[144:147], a[208:211], v[40:43]
s_waitcnt lgkmcnt(5)
buffer_load_dwordx4 v13, s[40:43], s64 offen lds
v_mfma_f32_16x16x32_bf16 v[44:47], a[152:155], a[208:211], v[44:47]
ds_read_b64_tr_b16 a[178:179], v184 offset:36864
v_mfma_f32_16x16x32_bf16 v[44:47], a[156:159], a[212:215], v[44:47]
ds_read_b64_tr_b16 a[180:181], v184 offset:40960
v_mfma_f32_16x16x32_bf16 v[76:79], a[156:159], a[220:223], v[76:79]
s_xor_b32 s65, s84, 65536
ds_read_b64_tr_b16 a[182:183], v184 offset:45056
v_mfma_f32_16x16x32_bf16 v[76:79], a[152:155], a[216:219], v[76:79]
buffer_load_dwordx4 a[0:3], v14, s[44:47], s65 offen offset:0 sc1
v_mfma_f32_16x16x32_bf16 v[108:111], a[152:155], a[224:227], v[108:111]
ds_read_b64_tr_b16 a[184:185], v185 offset:32768
v_mfma_f32_16x16x32_bf16 v[108:111], a[156:159], a[228:231], v[108:111]
ds_read_b64_tr_b16 a[186:187], v185 offset:36864
v_mfma_f32_16x16x32_bf16 v[140:143], a[156:159], a[236:239], v[140:143]
buffer_load_dwordx4 a[8:11], v14, s[44:47], s65 offen offset:1024 sc1
v_mfma_f32_16x16x32_bf16 v[140:143], a[152:155], a[232:235], v[140:143]
ds_read_b64_tr_b16 a[188:189], v185 offset:40960
v_mfma_f32_16x16x32_bf16 v[144:147], a[160:163], a[232:235], v[144:147]
ds_read_b64_tr_b16 a[190:191], v185 offset:45056
v_mfma_f32_16x16x32_bf16 v[144:147], a[164:167], a[236:239], v[144:147]
v_mfma_f32_16x16x32_bf16 v[112:115], a[164:167], a[228:231], v[112:115]
buffer_load_dwordx4 a[16:19], v15, s[44:47], s65 offen offset:0 sc1
v_mfma_f32_16x16x32_bf16 v[112:115], a[160:163], a[224:227], v[112:115]
ds_read_b64_tr_b16 a[192:193], v186 offset:32768
v_mfma_f32_16x16x32_bf16 v[80:83], a[160:163], a[216:219], v[80:83]
ds_read_b64_tr_b16 a[194:195], v186 offset:36864
v_mfma_f32_16x16x32_bf16 v[80:83], a[164:167], a[220:223], v[80:83]
buffer_load_dwordx4 a[24:27], v15, s[44:47], s65 offen offset:1024 sc1
v_mfma_f32_16x16x32_bf16 v[48:51], a[164:167], a[212:215], v[48:51]
ds_read_b64_tr_b16 a[196:197], v186 offset:40960
v_mfma_f32_16x16x32_bf16 v[48:51], a[160:163], a[208:211], v[48:51]
s_waitcnt lgkmcnt(4)
ds_read_b64_tr_b16 a[198:199], v186 offset:45056
v_mfma_f32_16x16x32_bf16 v[52:55], a[168:171], a[208:211], v[52:55]
s_xor_b32 s65, s84, 73728
v_mfma_f32_16x16x32_bf16 v[52:55], a[172:175], a[212:215], v[52:55]
buffer_load_dwordx4 a[4:7], v14, s[44:47], s65 offen offset:0 sc1
v_mfma_f32_16x16x32_bf16 v[84:87], a[172:175], a[220:223], v[84:87]
ds_read_b64_tr_b16 a[200:201], v187 offset:32768
v_mfma_f32_16x16x32_bf16 v[84:87], a[168:171], a[216:219], v[84:87]
ds_read_b64_tr_b16 a[202:203], v187 offset:36864
v_mfma_f32_16x16x32_bf16 v[116:119], a[168:171], a[224:227], v[116:119]
buffer_load_dwordx4 a[12:15], v14, s[44:47], s65 offen offset:1024 sc1
v_mfma_f32_16x16x32_bf16 v[116:119], a[172:175], a[228:231], v[116:119]
ds_read_b64_tr_b16 a[204:205], v187 offset:40960
v_mfma_f32_16x16x32_bf16 v[148:151], a[172:175], a[236:239], v[148:151]
ds_read_b64_tr_b16 a[206:207], v187 offset:45056
v_mfma_f32_16x16x32_bf16 v[148:151], a[168:171], a[232:235], v[148:151]
v_mfma_f32_16x16x32_bf16 v[120:123], a[176:179], a[232:235], v[120:123]
buffer_load_dwordx4 a[20:23], v15, s[44:47], s65 offen offset:0 sc1
v_mfma_f32_16x16x32_bf16 v[120:123], a[180:183], a[236:239], v[120:123]
v_mfma_f32_16x16x32_bf16 v[88:91], a[180:183], a[228:231], v[88:91]
v_mfma_f32_16x16x32_bf16 v[88:91], a[176:179], a[224:227], v[88:91]
buffer_load_dwordx4 a[28:31], v15, s[44:47], s65 offen offset:1024 sc1
v_mfma_f32_16x16x32_bf16 v[56:59], a[176:179], a[216:219], v[56:59]
v_mfma_f32_16x16x32_bf16 v[56:59], a[180:183], a[220:223], v[56:59]
v_mfma_f32_16x16x32_bf16 v[24:27], a[180:183], a[212:215], v[24:27]
v_mfma_f32_16x16x32_bf16 v[24:27], a[176:179], a[208:211], v[24:27]
v_mfma_f32_16x16x32_bf16 v[28:31], a[184:187], a[208:211], v[28:31]
s_waitcnt vmcnt(24)
s_barrier
s_waitcnt lgkmcnt(0)
v_mfma_f32_16x16x32_bf16 v[28:31], a[188:191], a[212:215], v[28:31]
s_xor_b32 m0, s76, 98304
ds_read_b64_tr_b16 a[144:145], v196 offset:0
v_mfma_f32_16x16x32_bf16 v[60:63], a[188:191], a[220:223], v[60:63]
s_xor_b32 s64, s85, 786432
ds_read_b64_tr_b16 a[146:147], v196 offset:4096
v_mfma_f32_16x16x32_bf16 v[60:63], a[184:187], a[216:219], v[60:63]
buffer_load_dwordx4 v12, s[40:43], s64 offen lds
v_mfma_f32_16x16x32_bf16 v[92:95], a[184:187], a[224:227], v[92:95]
ds_read_b64_tr_b16 a[148:149], v196 offset:8192
v_mfma_f32_16x16x32_bf16 v[92:95], a[188:191], a[228:231], v[92:95]
s_xor_b32 m0, s76, 99328
ds_read_b64_tr_b16 a[150:151], v196 offset:12288
v_mfma_f32_16x16x32_bf16 v[124:127], a[188:191], a[236:239], v[124:127]
s_xor_b32 s64, s85, 794624
ds_read_b64_tr_b16 a[152:153], v197 offset:0
v_mfma_f32_16x16x32_bf16 v[124:127], a[184:187], a[232:235], v[124:127]
buffer_load_dwordx4 v13, s[40:43], s64 offen lds
v_mfma_f32_16x16x32_bf16 v[128:131], a[192:195], a[232:235], v[128:131]
ds_read_b64_tr_b16 a[154:155], v197 offset:4096
v_mfma_f32_16x16x32_bf16 v[128:131], a[196:199], a[236:239], v[128:131]
s_xor_b32 m0, s76, 100352
ds_read_b64_tr_b16 a[156:157], v197 offset:8192
v_mfma_f32_16x16x32_bf16 v[96:99], a[196:199], a[228:231], v[96:99]
s_xor_b32 s64, s85, 802816
ds_read_b64_tr_b16 a[158:159], v197 offset:12288
v_mfma_f32_16x16x32_bf16 v[96:99], a[192:195], a[224:227], v[96:99]
buffer_load_dwordx4 v12, s[40:43], s64 offen lds
v_mfma_f32_16x16x32_bf16 v[64:67], a[192:195], a[216:219], v[64:67]
ds_read_b64_tr_b16 a[160:161], v198 offset:0
v_mfma_f32_16x16x32_bf16 v[64:67], a[196:199], a[220:223], v[64:67]
s_xor_b32 m0, s76, 101376
ds_read_b64_tr_b16 a[162:163], v198 offset:4096
v_mfma_f32_16x16x32_bf16 v[32:35], a[196:199], a[212:215], v[32:35]
s_xor_b32 s64, s85, 811008
ds_read_b64_tr_b16 a[164:165], v198 offset:8192
v_mfma_f32_16x16x32_bf16 v[32:35], a[192:195], a[208:211], v[32:35]
buffer_load_dwordx4 v13, s[40:43], s64 offen lds
v_mfma_f32_16x16x32_bf16 v[36:39], a[200:203], a[208:211], v[36:39]
ds_read_b64_tr_b16 a[166:167], v198 offset:12288
v_mfma_f32_16x16x32_bf16 v[36:39], a[204:207], a[212:215], v[36:39]
s_xor_b32 m0, s76, 102400
v_mfma_f32_16x16x32_bf16 v[68:71], a[204:207], a[220:223], v[68:71]
s_xor_b32 s64, s85, 819200
v_mfma_f32_16x16x32_bf16 v[68:71], a[200:203], a[216:219], v[68:71]
buffer_load_dwordx4 v12, s[40:43], s64 offen lds
v_mfma_f32_16x16x32_bf16 v[100:103], a[200:203], a[224:227], v[100:103]
v_mfma_f32_16x16x32_bf16 v[100:103], a[204:207], a[228:231], v[100:103]
v_mfma_f32_16x16x32_bf16 v[132:135], a[204:207], a[236:239], v[132:135]
v_mfma_f32_16x16x32_bf16 v[132:135], a[200:203], a[232:235], v[132:135]
s_waitcnt vmcnt(25)
s_waitcnt lgkmcnt(1)
s_xor_b32 m0, s76, 103424
buffer_load_dword v19, off, s[52:55], s72 offset:128 sc1
v_mfma_f32_16x16x32_bf16 v[136:139], a[144:147], v[176:179], v[136:139]
s_waitcnt vmcnt(22)
s_xor_b32 s64, s85, 827392
ds_read_b64_tr_b16 a[168:169], v199 offset:0
v_mfma_f32_16x16x32_bf16 v[136:139], a[148:151], v[180:183], v[136:139]
buffer_load_dwordx4 v13, s[40:43], s64 offen lds
v_mfma_f32_16x16x32_bf16 v[104:107], a[148:151], v[172:175], v[104:107]
s_xor_b32 m0, s76, 104448
ds_read_b64_tr_b16 a[170:171], v199 offset:4096
v_mfma_f32_16x16x32_bf16 v[104:107], a[144:147], v[168:171], v[104:107]
s_xor_b32 s64, s85, 835584
ds_read_b64_tr_b16 a[172:173], v199 offset:8192
v_mfma_f32_16x16x32_bf16 v[72:75], a[144:147], v[160:163], v[72:75]
buffer_load_dwordx4 v12, s[40:43], s64 offen lds
v_mfma_f32_16x16x32_bf16 v[72:75], a[148:151], v[164:167], v[72:75]
s_xor_b32 m0, s76, 105472
ds_read_b64_tr_b16 a[174:175], v199 offset:12288
v_mfma_f32_16x16x32_bf16 v[40:43], a[148:151], v[156:159], v[40:43]
s_xor_b32 s64, s85, 843776
ds_read_b64_tr_b16 a[176:177], v192 offset:0
v_mfma_f32_16x16x32_bf16 v[40:43], a[144:147], v[152:155], v[40:43]
buffer_load_dwordx4 v13, s[40:43], s64 offen lds
v_mfma_f32_16x16x32_bf16 v[44:47], a[152:155], v[152:155], v[44:47]
ds_read_b64_tr_b16 a[178:179], v192 offset:4096
v_mfma_f32_16x16x32_bf16 v[44:47], a[156:159], v[156:159], v[44:47]
ds_read_b64_tr_b16 a[180:181], v192 offset:8192
v_mfma_f32_16x16x32_bf16 v[76:79], a[156:159], v[164:167], v[76:79]
s_xor_b32 s65, s84, 98304
ds_read_b64_tr_b16 a[182:183], v192 offset:12288
v_mfma_f32_16x16x32_bf16 v[76:79], a[152:155], v[160:163], v[76:79]
buffer_load_dwordx4 a[32:35], v14, s[44:47], s65 offen offset:0 sc1
v_mfma_f32_16x16x32_bf16 v[108:111], a[152:155], v[168:171], v[108:111]
ds_read_b64_tr_b16 a[184:185], v193 offset:0
v_mfma_f32_16x16x32_bf16 v[108:111], a[156:159], v[172:175], v[108:111]
ds_read_b64_tr_b16 a[186:187], v193 offset:4096
v_mfma_f32_16x16x32_bf16 v[140:143], a[156:159], v[180:183], v[140:143]
buffer_load_dwordx4 a[40:43], v14, s[44:47], s65 offen offset:1024 sc1
v_mfma_f32_16x16x32_bf16 v[140:143], a[152:155], v[176:179], v[140:143]
ds_read_b64_tr_b16 a[188:189], v193 offset:8192
v_mfma_f32_16x16x32_bf16 v[144:147], a[160:163], v[176:179], v[144:147]
s_waitcnt lgkmcnt(5)
s_lshl_b32 s75, s73, 20
s_add_u32 s85, s85, s75
ds_read_b64_tr_b16 a[190:191], v193 offset:12288
v_mfma_f32_16x16x32_bf16 v[144:147], a[164:167], v[180:183], v[144:147]
s_lshr_b32 s74, s73, 28
s_and_b32 s74, s74, 8
v_mfma_f32_16x16x32_bf16 v[112:115], a[164:167], v[172:175], v[112:115]
buffer_load_dwordx4 a[48:51], v15, s[44:47], s65 offen offset:0 sc1
v_mfma_f32_16x16x32_bf16 v[112:115], a[160:163], v[168:171], v[112:115]
ds_read_b64_tr_b16 a[192:193], v194 offset:0
v_mfma_f32_16x16x32_bf16 v[80:83], a[160:163], v[160:163], v[80:83]
ds_read_b64_tr_b16 a[194:195], v194 offset:4096
v_mfma_f32_16x16x32_bf16 v[80:83], a[164:167], v[164:167], v[80:83]
buffer_load_dwordx4 a[56:59], v15, s[44:47], s65 offen offset:1024 sc1
v_mfma_f32_16x16x32_bf16 v[48:51], a[164:167], v[156:159], v[48:51]
ds_read_b64_tr_b16 a[196:197], v194 offset:8192
v_mfma_f32_16x16x32_bf16 v[48:51], a[160:163], v[152:155], v[48:51]
ds_read_b64_tr_b16 a[198:199], v194 offset:12288
v_mfma_f32_16x16x32_bf16 v[52:55], a[168:171], v[152:155], v[52:55]
s_xor_b32 s65, s84, 106496
v_mfma_f32_16x16x32_bf16 v[52:55], a[172:175], v[156:159], v[52:55]
buffer_load_dwordx4 a[36:39], v14, s[44:47], s65 offen offset:0 sc1
v_mfma_f32_16x16x32_bf16 v[84:87], a[172:175], v[164:167], v[84:87]
ds_read_b64_tr_b16 a[200:201], v195 offset:0
v_mfma_f32_16x16x32_bf16 v[84:87], a[168:171], v[160:163], v[84:87]
ds_read_b64_tr_b16 a[202:203], v195 offset:4096
v_mfma_f32_16x16x32_bf16 v[116:119], a[168:171], v[168:171], v[116:119]
buffer_load_dwordx4 a[44:47], v14, s[44:47], s65 offen offset:1024 sc1
v_mfma_f32_16x16x32_bf16 v[116:119], a[172:175], v[172:175], v[116:119]
ds_read_b64_tr_b16 a[204:205], v195 offset:8192
v_mfma_f32_16x16x32_bf16 v[148:151], a[172:175], v[180:183], v[148:151]
ds_read_b64_tr_b16 a[206:207], v195 offset:12288
v_mfma_f32_16x16x32_bf16 v[148:151], a[168:171], v[176:179], v[148:151]
v_mfma_f32_16x16x32_bf16 v[120:123], a[176:179], v[176:179], v[120:123]
s_waitcnt lgkmcnt(4)
buffer_load_dwordx4 a[52:55], v15, s[44:47], s65 offen offset:0 sc1
v_mfma_f32_16x16x32_bf16 v[120:123], a[180:183], v[180:183], v[120:123]
v_mfma_f32_16x16x32_bf16 v[88:91], a[180:183], v[172:175], v[88:91]
v_mfma_f32_16x16x32_bf16 v[88:91], a[176:179], v[168:171], v[88:91]
buffer_load_dwordx4 a[60:63], v15, s[44:47], s65 offen offset:1024 sc1
v_mfma_f32_16x16x32_bf16 v[56:59], a[176:179], v[160:163], v[56:59]
v_mfma_f32_16x16x32_bf16 v[56:59], a[180:183], v[164:167], v[56:59]
v_mfma_f32_16x16x32_bf16 v[24:27], a[180:183], v[156:159], v[24:27]
v_mfma_f32_16x16x32_bf16 v[24:27], a[176:179], v[152:155], v[24:27]
v_mfma_f32_16x16x32_bf16 v[28:31], a[184:187], v[152:155], v[28:31]
s_waitcnt vmcnt(25)
s_barrier
v_mfma_f32_16x16x32_bf16 v[28:31], a[188:191], v[156:159], v[28:31]
s_xor_b32 m0, s76, 131072
ds_read_b64_tr_b16 a[144:145], v196 offset:32768
v_mfma_f32_16x16x32_bf16 v[60:63], a[188:191], v[164:167], v[60:63]
s_xor_b32 s64, s85, 0
ds_read_b64_tr_b16 a[146:147], v196 offset:36864
v_mfma_f32_16x16x32_bf16 v[60:63], a[184:187], v[160:163], v[60:63]
buffer_load_dwordx4 v12, s[40:43], s64 offen lds
v_mfma_f32_16x16x32_bf16 v[92:95], a[184:187], v[168:171], v[92:95]
s_lshl_b32 s75, s73, 17
s_add_u32 s84, s84, s75
ds_read_b64_tr_b16 a[148:149], v196 offset:40960
v_mfma_f32_16x16x32_bf16 v[92:95], a[188:191], v[172:175], v[92:95]
s_xor_b32 m0, s76, 132096
ds_read_b64_tr_b16 a[150:151], v196 offset:45056
v_mfma_f32_16x16x32_bf16 v[124:127], a[188:191], v[180:183], v[124:127]
s_xor_b32 s64, s85, 8192
ds_read_b64_tr_b16 a[152:153], v197 offset:32768
v_mfma_f32_16x16x32_bf16 v[124:127], a[184:187], v[176:179], v[124:127]
buffer_load_dwordx4 v13, s[40:43], s64 offen lds
v_mfma_f32_16x16x32_bf16 v[128:131], a[192:195], v[176:179], v[128:131]
ds_read_b64_tr_b16 a[154:155], v197 offset:36864
v_mfma_f32_16x16x32_bf16 v[128:131], a[196:199], v[180:183], v[128:131]
s_xor_b32 m0, s76, 133120
ds_read_b64_tr_b16 a[156:157], v197 offset:40960
v_mfma_f32_16x16x32_bf16 v[96:99], a[196:199], v[172:175], v[96:99]
s_xor_b32 s64, s85, 16384
ds_read_b64_tr_b16 a[158:159], v197 offset:45056
v_mfma_f32_16x16x32_bf16 v[96:99], a[192:195], v[168:171], v[96:99]
buffer_load_dwordx4 v12, s[40:43], s64 offen lds
v_mfma_f32_16x16x32_bf16 v[64:67], a[192:195], v[160:163], v[64:67]
ds_read_b64_tr_b16 a[160:161], v198 offset:32768
v_mfma_f32_16x16x32_bf16 v[64:67], a[196:199], v[164:167], v[64:67]
s_xor_b32 m0, s76, 134144
ds_read_b64_tr_b16 a[162:163], v198 offset:36864
v_mfma_f32_16x16x32_bf16 v[32:35], a[196:199], v[156:159], v[32:35]
s_xor_b32 s64, s85, 24576
ds_read_b64_tr_b16 a[164:165], v198 offset:40960
v_mfma_f32_16x16x32_bf16 v[32:35], a[192:195], v[152:155], v[32:35]
s_waitcnt lgkmcnt(6)
buffer_load_dwordx4 v13, s[40:43], s64 offen lds
v_mfma_f32_16x16x32_bf16 v[36:39], a[200:203], v[152:155], v[36:39]
ds_read_b64_tr_b16 a[166:167], v198 offset:45056
v_mfma_f32_16x16x32_bf16 v[36:39], a[204:207], v[156:159], v[36:39]
s_xor_b32 m0, s76, 135168
v_mfma_f32_16x16x32_bf16 v[68:71], a[204:207], v[164:167], v[68:71]
s_xor_b32 s64, s85, 32768
v_mfma_f32_16x16x32_bf16 v[68:71], a[200:203], v[160:163], v[68:71]
buffer_load_dwordx4 v12, s[40:43], s64 offen lds
v_mfma_f32_16x16x32_bf16 v[100:103], a[200:203], v[168:171], v[100:103]
v_mfma_f32_16x16x32_bf16 v[100:103], a[204:207], v[172:175], v[100:103]
v_mfma_f32_16x16x32_bf16 v[132:135], a[204:207], v[180:183], v[132:135]
v_mfma_f32_16x16x32_bf16 v[132:135], a[200:203], v[176:179], v[132:135]
s_waitcnt vmcnt(26)
v_mfma_f32_16x16x32_bf16 v[136:139], a[144:147], a[24:27], v[136:139]
s_waitcnt vmcnt(16)
v_readfirstlane_b32 vcc_lo, v19
s_nop 0
s_cmp_lt_u32 vcc_lo, s74
s_cbranch_scc1 L_spin_4022
L_spinbk_4023:
v_mfma_f32_16x16x32_bf16 v[136:139], a[148:151], a[28:31], v[136:139]
s_xor_b32 m0, s76, 136192
ds_read_b64_tr_b16 a[168:169], v199 offset:32768
v_mfma_f32_16x16x32_bf16 v[104:107], a[148:151], a[20:23], v[104:107]
s_xor_b32 s64, s85, 40960
ds_read_b64_tr_b16 a[170:171], v199 offset:36864
v_mfma_f32_16x16x32_bf16 v[104:107], a[144:147], a[16:19], v[104:107]
buffer_load_dwordx4 v13, s[40:43], s64 offen lds
v_mfma_f32_16x16x32_bf16 v[72:75], a[144:147], a[8:11], v[72:75]
s_xor_b32 m0, s76, 137216
ds_read_b64_tr_b16 a[172:173], v199 offset:40960
v_mfma_f32_16x16x32_bf16 v[72:75], a[148:151], a[12:15], v[72:75]
s_xor_b32 s64, s85, 49152
ds_read_b64_tr_b16 a[174:175], v199 offset:45056
v_mfma_f32_16x16x32_bf16 v[40:43], a[148:151], a[4:7], v[40:43]
buffer_load_dwordx4 v12, s[40:43], s64 offen lds
v_mfma_f32_16x16x32_bf16 v[40:43], a[144:147], a[0:3], v[40:43]
s_waitcnt lgkmcnt(4)
s_xor_b32 m0, s76, 138240
ds_read_b64_tr_b16 a[176:177], v192 offset:32768
v_mfma_f32_16x16x32_bf16 v[44:47], a[152:155], a[0:3], v[44:47]
s_xor_b32 s64, s85, 57344
ds_read_b64_tr_b16 a[178:179], v192 offset:36864
v_mfma_f32_16x16x32_bf16 v[44:47], a[156:159], a[4:7], v[44:47]
buffer_load_dwordx4 v13, s[40:43], s64 offen lds
v_mfma_f32_16x16x32_bf16 v[76:79], a[156:159], a[12:15], v[76:79]
ds_read_b64_tr_b16 a[180:181], v192 offset:40960
v_mfma_f32_16x16x32_bf16 v[76:79], a[152:155], a[8:11], v[76:79]
s_xor_b32 s65, s84, 0
ds_read_b64_tr_b16 a[182:183], v192 offset:45056
v_mfma_f32_16x16x32_bf16 v[108:111], a[152:155], a[16:19], v[108:111]
buffer_load_dwordx4 a[208:211], v14, s[44:47], s65 offen offset:0 sc1
v_mfma_f32_16x16x32_bf16 v[108:111], a[156:159], a[20:23], v[108:111]
ds_read_b64_tr_b16 a[184:185], v193 offset:32768
v_mfma_f32_16x16x32_bf16 v[140:143], a[156:159], a[28:31], v[140:143]
ds_read_b64_tr_b16 a[186:187], v193 offset:36864
v_mfma_f32_16x16x32_bf16 v[140:143], a[152:155], a[24:27], v[140:143]
ds_read_b64_tr_b16 a[188:189], v193 offset:40960
v_mfma_f32_16x16x32_bf16 v[144:147], a[160:163], a[24:27], v[144:147]
buffer_load_dwordx4 a[216:219], v14, s[44:47], s65 offen offset:1024 sc1
v_mfma_f32_16x16x32_bf16 v[144:147], a[164:167], a[28:31], v[144:147]
ds_read_b64_tr_b16 a[190:191], v193 offset:45056
v_mfma_f32_16x16x32_bf16 v[112:115], a[164:167], a[20:23], v[112:115]
ds_read_b64_tr_b16 a[192:193], v194 offset:32768
v_mfma_f32_16x16x32_bf16 v[112:115], a[160:163], a[16:19], v[112:115]
buffer_load_dwordx4 a[224:227], v15, s[44:47], s65 offen offset:0 sc1
v_mfma_f32_16x16x32_bf16 v[80:83], a[160:163], a[8:11], v[80:83]
ds_read_b64_tr_b16 a[194:195], v194 offset:36864
v_mfma_f32_16x16x32_bf16 v[80:83], a[164:167], a[12:15], v[80:83]
ds_read_b64_tr_b16 a[196:197], v194 offset:40960
v_mfma_f32_16x16x32_bf16 v[48:51], a[164:167], a[4:7], v[48:51]
buffer_load_dwordx4 a[232:235], v15, s[44:47], s65 offen offset:1024 sc1
v_mfma_f32_16x16x32_bf16 v[48:51], a[160:163], a[0:3], v[48:51]
s_waitcnt lgkmcnt(4)
ds_read_b64_tr_b16 a[198:199], v194 offset:45056
v_mfma_f32_16x16x32_bf16 v[52:55], a[168:171], a[0:3], v[52:55]
s_xor_b32 s65, s84, 8192
v_mfma_f32_16x16x32_bf16 v[52:55], a[172:175], a[4:7], v[52:55]
buffer_load_dwordx4 a[212:215], v14, s[44:47], s65 offen offset:0 sc1
v_mfma_f32_16x16x32_bf16 v[84:87], a[172:175], a[12:15], v[84:87]
ds_read_b64_tr_b16 a[200:201], v195 offset:32768
v_mfma_f32_16x16x32_bf16 v[84:87], a[168:171], a[8:11], v[84:87]
ds_read_b64_tr_b16 a[202:203], v195 offset:36864
v_mfma_f32_16x16x32_bf16 v[116:119], a[168:171], a[16:19], v[116:119]
ds_read_b64_tr_b16 a[204:205], v195 offset:40960
v_mfma_f32_16x16x32_bf16 v[116:119], a[172:175], a[20:23], v[116:119]
buffer_load_dwordx4 a[220:223], v14, s[44:47], s65 offen offset:1024 sc1
v_mfma_f32_16x16x32_bf16 v[148:151], a[172:175], a[28:31], v[148:151]
ds_read_b64_tr_b16 a[206:207], v195 offset:45056
v_mfma_f32_16x16x32_bf16 v[148:151], a[168:171], a[24:27], v[148:151]
v_mfma_f32_16x16x32_bf16 v[120:123], a[176:179], a[24:27], v[120:123]
buffer_load_dwordx4 a[228:231], v15, s[44:47], s65 offen offset:0 sc1
v_mfma_f32_16x16x32_bf16 v[120:123], a[180:183], a[28:31], v[120:123]
v_mfma_f32_16x16x32_bf16 v[88:91], a[180:183], a[20:23], v[88:91]
v_mfma_f32_16x16x32_bf16 v[88:91], a[176:179], a[16:19], v[88:91]
buffer_load_dwordx4 a[236:239], v15, s[44:47], s65 offen offset:1024 sc1
v_mfma_f32_16x16x32_bf16 v[56:59], a[176:179], a[8:11], v[56:59]
v_mfma_f32_16x16x32_bf16 v[56:59], a[180:183], a[12:15], v[56:59]
v_mfma_f32_16x16x32_bf16 v[24:27], a[180:183], a[4:7], v[24:27]
v_mfma_f32_16x16x32_bf16 v[24:27], a[176:179], a[0:3], v[24:27]
v_mfma_f32_16x16x32_bf16 v[28:31], a[184:187], a[0:3], v[28:31]
s_waitcnt vmcnt(24)
s_barrier
s_waitcnt lgkmcnt(0)
v_mfma_f32_16x16x32_bf16 v[28:31], a[188:191], a[4:7], v[28:31]
s_xor_b32 m0, s76, 32768
ds_read_b64_tr_b16 a[144:145], v188 offset:0
v_mfma_f32_16x16x32_bf16 v[60:63], a[188:191], a[12:15], v[60:63]
s_xor_b32 s64, s85, 262144
ds_read_b64_tr_b16 a[146:147], v188 offset:4096
v_mfma_f32_16x16x32_bf16 v[60:63], a[184:187], a[8:11], v[60:63]
buffer_load_dwordx4 v12, s[40:43], s64 offen lds
v_mfma_f32_16x16x32_bf16 v[92:95], a[184:187], a[16:19], v[92:95]
ds_read_b64_tr_b16 a[148:149], v188 offset:8192
v_mfma_f32_16x16x32_bf16 v[92:95], a[188:191], a[20:23], v[92:95]
s_xor_b32 m0, s76, 33792
ds_read_b64_tr_b16 a[150:151], v188 offset:12288
v_mfma_f32_16x16x32_bf16 v[124:127], a[188:191], a[28:31], v[124:127]
s_xor_b32 s64, s85, 270336
ds_read_b64_tr_b16 a[152:153], v189 offset:0
v_mfma_f32_16x16x32_bf16 v[124:127], a[184:187], a[24:27], v[124:127]
buffer_load_dwordx4 v13, s[40:43], s64 offen lds
v_mfma_f32_16x16x32_bf16 v[128:131], a[192:195], a[24:27], v[128:131]
ds_read_b64_tr_b16 a[154:155], v189 offset:4096
v_mfma_f32_16x16x32_bf16 v[128:131], a[196:199], a[28:31], v[128:131]
s_xor_b32 m0, s76, 34816
ds_read_b64_tr_b16 a[156:157], v189 offset:8192
v_mfma_f32_16x16x32_bf16 v[96:99], a[196:199], a[20:23], v[96:99]
s_xor_b32 s64, s85, 278528
ds_read_b64_tr_b16 a[158:159], v189 offset:12288
v_mfma_f32_16x16x32_bf16 v[96:99], a[192:195], a[16:19], v[96:99]
buffer_load_dwordx4 v12, s[40:43], s64 offen lds
v_mfma_f32_16x16x32_bf16 v[64:67], a[192:195], a[8:11], v[64:67]
ds_read_b64_tr_b16 a[160:161], v190 offset:0
v_mfma_f32_16x16x32_bf16 v[64:67], a[196:199], a[12:15], v[64:67]
s_xor_b32 m0, s76, 35840
ds_read_b64_tr_b16 a[162:163], v190 offset:4096
v_mfma_f32_16x16x32_bf16 v[32:35], a[196:199], a[4:7], v[32:35]
s_xor_b32 s64, s85, 286720
ds_read_b64_tr_b16 a[164:165], v190 offset:8192
v_mfma_f32_16x16x32_bf16 v[32:35], a[192:195], a[0:3], v[32:35]
buffer_load_dwordx4 v13, s[40:43], s64 offen lds
v_mfma_f32_16x16x32_bf16 v[36:39], a[200:203], a[0:3], v[36:39]
ds_read_b64_tr_b16 a[166:167], v190 offset:12288
v_mfma_f32_16x16x32_bf16 v[36:39], a[204:207], a[4:7], v[36:39]
s_xor_b32 m0, s76, 36864
v_mfma_f32_16x16x32_bf16 v[68:71], a[204:207], a[12:15], v[68:71]
s_xor_b32 s64, s85, 294912
v_mfma_f32_16x16x32_bf16 v[68:71], a[200:203], a[8:11], v[68:71]
buffer_load_dwordx4 v12, s[40:43], s64 offen lds
v_mfma_f32_16x16x32_bf16 v[100:103], a[200:203], a[16:19], v[100:103]
v_mfma_f32_16x16x32_bf16 v[100:103], a[204:207], a[20:23], v[100:103]
v_mfma_f32_16x16x32_bf16 v[132:135], a[204:207], a[28:31], v[132:135]
v_mfma_f32_16x16x32_bf16 v[132:135], a[200:203], a[24:27], v[132:135]
s_waitcnt vmcnt(25)
s_waitcnt lgkmcnt(1)
s_xor_b32 m0, s76, 37888
v_mfma_f32_16x16x32_bf16 v[136:139], a[144:147], a[56:59], v[136:139]
s_waitcnt vmcnt(21)
s_xor_b32 s64, s85, 303104
ds_read_b64_tr_b16 a[168:169], v191 offset:0
v_mfma_f32_16x16x32_bf16 v[136:139], a[148:151], a[60:63], v[136:139]
buffer_load_dwordx4 v13, s[40:43], s64 offen lds
v_mfma_f32_16x16x32_bf16 v[104:107], a[148:151], a[52:55], v[104:107]
s_xor_b32 m0, s76, 38912
ds_read_b64_tr_b16 a[170:171], v191 offset:4096
v_mfma_f32_16x16x32_bf16 v[104:107], a[144:147], a[48:51], v[104:107]
s_xor_b32 s64, s85, 311296
ds_read_b64_tr_b16 a[172:173], v191 offset:8192
v_mfma_f32_16x16x32_bf16 v[72:75], a[144:147], a[40:43], v[72:75]
buffer_load_dwordx4 v12, s[40:43], s64 offen lds
v_mfma_f32_16x16x32_bf16 v[72:75], a[148:151], a[44:47], v[72:75]
s_xor_b32 m0, s76, 39936
ds_read_b64_tr_b16 a[174:175], v191 offset:12288
v_mfma_f32_16x16x32_bf16 v[40:43], a[148:151], a[36:39], v[40:43]
s_xor_b32 s64, s85, 319488
ds_read_b64_tr_b16 a[176:177], v184 offset:0
v_mfma_f32_16x16x32_bf16 v[40:43], a[144:147], a[32:35], v[40:43]
buffer_load_dwordx4 v13, s[40:43], s64 offen lds
v_mfma_f32_16x16x32_bf16 v[44:47], a[152:155], a[32:35], v[44:47]
ds_read_b64_tr_b16 a[178:179], v184 offset:4096
v_mfma_f32_16x16x32_bf16 v[44:47], a[156:159], a[36:39], v[44:47]
ds_read_b64_tr_b16 a[180:181], v184 offset:8192
v_mfma_f32_16x16x32_bf16 v[76:79], a[156:159], a[44:47], v[76:79]
s_xor_b32 s65, s84, 32768
ds_read_b64_tr_b16 a[182:183], v184 offset:12288
v_mfma_f32_16x16x32_bf16 v[76:79], a[152:155], a[40:43], v[76:79]
buffer_load_dwordx4 v[152:155], v14, s[44:47], s65 offen offset:0 sc1
v_mfma_f32_16x16x32_bf16 v[108:111], a[152:155], a[48:51], v[108:111]
ds_read_b64_tr_b16 a[184:185], v185 offset:0
v_mfma_f32_16x16x32_bf16 v[108:111], a[156:159], a[52:55], v[108:111]
ds_read_b64_tr_b16 a[186:187], v185 offset:4096
v_mfma_f32_16x16x32_bf16 v[140:143], a[156:159], a[60:63], v[140:143]
buffer_load_dwordx4 v[160:163], v14, s[44:47], s65 offen offset:1024 sc1
v_mfma_f32_16x16x32_bf16 v[140:143], a[152:155], a[56:59], v[140:143]
ds_read_b64_tr_b16 a[188:189], v185 offset:8192
v_mfma_f32_16x16x32_bf16 v[144:147], a[160:163], a[56:59], v[144:147]
s_waitcnt lgkmcnt(5)
ds_read_b64_tr_b16 a[190:191], v185 offset:12288
v_mfma_f32_16x16x32_bf16 v[144:147], a[164:167], a[60:63], v[144:147]
v_mfma_f32_16x16x32_bf16 v[112:115], a[164:167], a[52:55], v[112:115]
buffer_load_dwordx4 v[168:171], v15, s[44:47], s65 offen offset:0 sc1
v_mfma_f32_16x16x32_bf16 v[112:115], a[160:163], a[48:51], v[112:115]
ds_read_b64_tr_b16 a[192:193], v186 offset:0
v_mfma_f32_16x16x32_bf16 v[80:83], a[160:163], a[40:43], v[80:83]
ds_read_b64_tr_b16 a[194:195], v186 offset:4096
v_mfma_f32_16x16x32_bf16 v[80:83], a[164:167], a[44:47], v[80:83]
buffer_load_dwordx4 v[176:179], v15, s[44:47], s65 offen offset:1024 sc1
v_mfma_f32_16x16x32_bf16 v[48:51], a[164:167], a[36:39], v[48:51]
ds_read_b64_tr_b16 a[196:197], v186 offset:8192
v_mfma_f32_16x16x32_bf16 v[48:51], a[160:163], a[32:35], v[48:51]
ds_read_b64_tr_b16 a[198:199], v186 offset:12288
v_mfma_f32_16x16x32_bf16 v[52:55], a[168:171], a[32:35], v[52:55]
s_xor_b32 s65, s84, 40960
v_mfma_f32_16x16x32_bf16 v[52:55], a[172:175], a[36:39], v[52:55]
buffer_load_dwordx4 v[156:159], v14, s[44:47], s65 offen offset:0 sc1
v_mfma_f32_16x16x32_bf16 v[84:87], a[172:175], a[44:47], v[84:87]
ds_read_b64_tr_b16 a[200:201], v187 offset:0
v_mfma_f32_16x16x32_bf16 v[84:87], a[168:171], a[40:43], v[84:87]
ds_read_b64_tr_b16 a[202:203], v187 offset:4096
v_mfma_f32_16x16x32_bf16 v[116:119], a[168:171], a[48:51], v[116:119]
buffer_load_dwordx4 v[164:167], v14, s[44:47], s65 offen offset:1024 sc1
v_mfma_f32_16x16x32_bf16 v[116:119], a[172:175], a[52:55], v[116:119]
ds_read_b64_tr_b16 a[204:205], v187 offset:8192
v_mfma_f32_16x16x32_bf16 v[148:151], a[172:175], a[60:63], v[148:151]
ds_read_b64_tr_b16 a[206:207], v187 offset:12288
v_mfma_f32_16x16x32_bf16 v[148:151], a[168:171], a[56:59], v[148:151]
v_mfma_f32_16x16x32_bf16 v[120:123], a[176:179], a[56:59], v[120:123]
s_waitcnt lgkmcnt(4)
buffer_load_dwordx4 v[172:175], v15, s[44:47], s65 offen offset:0 sc1
v_mfma_f32_16x16x32_bf16 v[120:123], a[180:183], a[60:63], v[120:123]
v_mfma_f32_16x16x32_bf16 v[88:91], a[180:183], a[52:55], v[88:91]
v_mfma_f32_16x16x32_bf16 v[88:91], a[176:179], a[48:51], v[88:91]
buffer_load_dwordx4 v[180:183], v15, s[44:47], s65 offen offset:1024 sc1
v_mfma_f32_16x16x32_bf16 v[56:59], a[176:179], a[40:43], v[56:59]
v_mfma_f32_16x16x32_bf16 v[56:59], a[180:183], a[44:47], v[56:59]
v_mfma_f32_16x16x32_bf16 v[24:27], a[180:183], a[36:39], v[24:27]
v_mfma_f32_16x16x32_bf16 v[24:27], a[176:179], a[32:35], v[24:27]
v_mfma_f32_16x16x32_bf16 v[28:31], a[184:187], a[32:35], v[28:31]
s_waitcnt vmcnt(24)
s_barrier
v_mfma_f32_16x16x32_bf16 v[28:31], a[188:191], a[36:39], v[28:31]
s_xor_b32 m0, s76, 65536
ds_read_b64_tr_b16 a[144:145], v188 offset:32768
v_mfma_f32_16x16x32_bf16 v[60:63], a[188:191], a[44:47], v[60:63]
s_xor_b32 s64, s85, 524288
ds_read_b64_tr_b16 a[146:147], v188 offset:36864
v_mfma_f32_16x16x32_bf16 v[60:63], a[184:187], a[40:43], v[60:63]
buffer_load_dwordx4 v12, s[40:43], s64 offen lds
v_mfma_f32_16x16x32_bf16 v[92:95], a[184:187], a[48:51], v[92:95]
ds_read_b64_tr_b16 a[148:149], v188 offset:40960
v_mfma_f32_16x16x32_bf16 v[92:95], a[188:191], a[52:55], v[92:95]
s_xor_b32 m0, s76, 66560
ds_read_b64_tr_b16 a[150:151], v188 offset:45056
v_mfma_f32_16x16x32_bf16 v[124:127], a[188:191], a[60:63], v[124:127]
s_xor_b32 s64, s85, 532480
ds_read_b64_tr_b16 a[152:153], v189 offset:32768
v_mfma_f32_16x16x32_bf16 v[124:127], a[184:187], a[56:59], v[124:127]
buffer_load_dwordx4 v13, s[40:43], s64 offen lds
v_mfma_f32_16x16x32_bf16 v[128:131], a[192:195], a[56:59], v[128:131]
ds_read_b64_tr_b16 a[154:155], v189 offset:36864
v_mfma_f32_16x16x32_bf16 v[128:131], a[196:199], a[60:63], v[128:131]
s_branch L_po22
L_pg22:
s_branch L_tr2
L_po22:
s_xor_b32 m0, s76, 67584
ds_read_b64_tr_b16 a[156:157], v189 offset:40960
v_mfma_f32_16x16x32_bf16 v[96:99], a[196:199], a[52:55], v[96:99]
s_xor_b32 s64, s85, 540672
ds_read_b64_tr_b16 a[158:159], v189 offset:45056
v_mfma_f32_16x16x32_bf16 v[96:99], a[192:195], a[48:51], v[96:99]
buffer_load_dwordx4 v12, s[40:43], s64 offen lds
v_mfma_f32_16x16x32_bf16 v[64:67], a[192:195], a[40:43], v[64:67]
ds_read_b64_tr_b16 a[160:161], v190 offset:32768
v_mfma_f32_16x16x32_bf16 v[64:67], a[196:199], a[44:47], v[64:67]
s_xor_b32 m0, s76, 68608
ds_read_b64_tr_b16 a[162:163], v190 offset:36864
v_mfma_f32_16x16x32_bf16 v[32:35], a[196:199], a[36:39], v[32:35]
s_xor_b32 s64, s85, 548864
ds_read_b64_tr_b16 a[164:165], v190 offset:40960
v_mfma_f32_16x16x32_bf16 v[32:35], a[192:195], a[32:35], v[32:35]
s_waitcnt lgkmcnt(6)
buffer_load_dwordx4 v13, s[40:43], s64 offen lds
v_mfma_f32_16x16x32_bf16 v[36:39], a[200:203], a[32:35], v[36:39]
ds_read_b64_tr_b16 a[166:167], v190 offset:45056
v_mfma_f32_16x16x32_bf16 v[36:39], a[204:207], a[36:39], v[36:39]
s_xor_b32 m0, s76, 69632
v_mfma_f32_16x16x32_bf16 v[68:71], a[204:207], a[44:47], v[68:71]
s_xor_b32 s64, s85, 557056
v_mfma_f32_16x16x32_bf16 v[68:71], a[200:203], a[40:43], v[68:71]
buffer_load_dwordx4 v12, s[40:43], s64 offen lds
v_mfma_f32_16x16x32_bf16 v[100:103], a[200:203], a[48:51], v[100:103]
s_sub_u32 s73, 1, s73
s_sub_u32 s70, s70, 1
s_cmp_lg_u32 s70, 0
v_mfma_f32_16x16x32_bf16 v[100:103], a[204:207], a[52:55], v[100:103]
v_mfma_f32_16x16x32_bf16 v[132:135], a[204:207], a[60:63], v[132:135]
v_mfma_f32_16x16x32_bf16 v[132:135], a[200:203], a[56:59], v[132:135]
s_cbranch_scc1 L_p5loop
L_p5last:
s_waitcnt lgkmcnt(10)
s_waitcnt vmcnt(25)
v_mfma_f32_16x16x32_bf16 v[136:139], a[144:147], a[232:235], v[136:139]
s_waitcnt vmcnt(21)
s_waitcnt lgkmcnt(8)
s_xor_b32 m0, s76, 70656
s_xor_b32 s64, s85, 565248
ds_read_b64_tr_b16 a[168:169], v191 offset:32768
v_mfma_f32_16x16x32_bf16 v[136:139], a[148:151], a[236:239], v[136:139]
buffer_load_dwordx4 v13, s[40:43], s64 offen lds
v_mfma_f32_16x16x32_bf16 v[104:107], a[148:151], a[228:231], v[104:107]
s_xor_b32 m0, s76, 71680
ds_read_b64_tr_b16 a[170:171], v191 offset:36864
v_mfma_f32_16x16x32_bf16 v[104:107], a[144:147], a[224:227], v[104:107]
s_xor_b32 s64, s85, 573440
ds_read_b64_tr_b16 a[172:173], v191 offset:40960
v_mfma_f32_16x16x32_bf16 v[72:75], a[144:147], a[216:219], v[72:75]
buffer_load_dwordx4 v12, s[40:43], s64 offen lds
v_mfma_f32_16x16x32_bf16 v[72:75], a[148:151], a[220:223], v[72:75]
s_xor_b32 m0, s76, 72704
ds_read_b64_tr_b16 a[174:175], v191 offset:45056
v_mfma_f32_16x16x32_bf16 v[40:43], a[148:151], a[212:215], v[40:43]
s_xor_b32 s64, s85, 581632
ds_read_b64_tr_b16 a[176:177], v184 offset:32768
v_mfma_f32_16x16x32_bf16 v[40:43], a[144:147], a[208:211], v[40:43]
s_waitcnt lgkmcnt(5)
buffer_load_dwordx4 v13, s[40:43], s64 offen lds
v_mfma_f32_16x16x32_bf16 v[44:47], a[152:155], a[208:211], v[44:47]
ds_read_b64_tr_b16 a[178:179], v184 offset:36864
v_mfma_f32_16x16x32_bf16 v[44:47], a[156:159], a[212:215], v[44:47]
ds_read_b64_tr_b16 a[180:181], v184 offset:40960
v_mfma_f32_16x16x32_bf16 v[76:79], a[156:159], a[220:223], v[76:79]
s_xor_b32 s65, s84, 65536
ds_read_b64_tr_b16 a[182:183], v184 offset:45056
v_mfma_f32_16x16x32_bf16 v[76:79], a[152:155], a[216:219], v[76:79]
buffer_load_dwordx4 a[0:3], v14, s[44:47], s65 offen offset:0 sc1
v_mfma_f32_16x16x32_bf16 v[108:111], a[152:155], a[224:227], v[108:111]
ds_read_b64_tr_b16 a[184:185], v185 offset:32768
v_mfma_f32_16x16x32_bf16 v[108:111], a[156:159], a[228:231], v[108:111]
ds_read_b64_tr_b16 a[186:187], v185 offset:36864
v_mfma_f32_16x16x32_bf16 v[140:143], a[156:159], a[236:239], v[140:143]
buffer_load_dwordx4 a[8:11], v14, s[44:47], s65 offen offset:1024 sc1
v_mfma_f32_16x16x32_bf16 v[140:143], a[152:155], a[232:235], v[140:143]
ds_read_b64_tr_b16 a[188:189], v185 offset:40960
v_mfma_f32_16x16x32_bf16 v[144:147], a[160:163], a[232:235], v[144:147]
ds_read_b64_tr_b16 a[190:191], v185 offset:45056
v_mfma_f32_16x16x32_bf16 v[144:147], a[164:167], a[236:239], v[144:147]
v_mfma_f32_16x16x32_bf16 v[112:115], a[164:167], a[228:231], v[112:115]
buffer_load_dwordx4 a[16:19], v15, s[44:47], s65 offen offset:0 sc1
v_mfma_f32_16x16x32_bf16 v[112:115], a[160:163], a[224:227], v[112:115]
ds_read_b64_tr_b16 a[192:193], v186 offset:32768
v_mfma_f32_16x16x32_bf16 v[80:83], a[160:163], a[216:219], v[80:83]
ds_read_b64_tr_b16 a[194:195], v186 offset:36864
v_mfma_f32_16x16x32_bf16 v[80:83], a[164:167], a[220:223], v[80:83]
buffer_load_dwordx4 a[24:27], v15, s[44:47], s65 offen offset:1024 sc1
v_mfma_f32_16x16x32_bf16 v[48:51], a[164:167], a[212:215], v[48:51]
ds_read_b64_tr_b16 a[196:197], v186 offset:40960
v_mfma_f32_16x16x32_bf16 v[48:51], a[160:163], a[208:211], v[48:51]
s_waitcnt lgkmcnt(4)
ds_read_b64_tr_b16 a[198:199], v186 offset:45056
v_mfma_f32_16x16x32_bf16 v[52:55], a[168:171], a[208:211], v[52:55]
s_xor_b32 s65, s84, 73728
v_mfma_f32_16x16x32_bf16 v[52:55], a[172:175], a[212:215], v[52:55]
buffer_load_dwordx4 a[4:7], v14, s[44:47], s65 offen offset:0 sc1
v_mfma_f32_16x16x32_bf16 v[84:87], a[172:175], a[220:223], v[84:87]
ds_read_b64_tr_b16 a[200:201], v187 offset:32768
v_mfma_f32_16x16x32_bf16 v[84:87], a[168:171], a[216:219], v[84:87]
ds_read_b64_tr_b16 a[202:203], v187 offset:36864
v_mfma_f32_16x16x32_bf16 v[116:119], a[168:171], a[224:227], v[116:119]
buffer_load_dwordx4 a[12:15], v14, s[44:47], s65 offen offset:1024 sc1
v_mfma_f32_16x16x32_bf16 v[116:119], a[172:175], a[228:231], v[116:119]
ds_read_b64_tr_b16 a[204:205], v187 offset:40960
v_mfma_f32_16x16x32_bf16 v[148:151], a[172:175], a[236:239], v[148:151]
ds_read_b64_tr_b16 a[206:207], v187 offset:45056
v_mfma_f32_16x16x32_bf16 v[148:151], a[168:171], a[232:235], v[148:151]
v_mfma_f32_16x16x32_bf16 v[120:123], a[176:179], a[232:235], v[120:123]
buffer_load_dwordx4 a[20:23], v15, s[44:47], s65 offen offset:0 sc1
v_mfma_f32_16x16x32_bf16 v[120:123], a[180:183], a[236:239], v[120:123]
v_mfma_f32_16x16x32_bf16 v[88:91], a[180:183], a[228:231], v[88:91]
v_mfma_f32_16x16x32_bf16 v[88:91], a[176:179], a[224:227], v[88:91]
buffer_load_dwordx4 a[28:31], v15, s[44:47], s65 offen offset:1024 sc1
v_mfma_f32_16x16x32_bf16 v[56:59], a[176:179], a[216:219], v[56:59]
v_mfma_f32_16x16x32_bf16 v[56:59], a[180:183], a[220:223], v[56:59]
v_mfma_f32_16x16x32_bf16 v[24:27], a[180:183], a[212:215], v[24:27]
v_mfma_f32_16x16x32_bf16 v[24:27], a[176:179], a[208:211], v[24:27]
v_mfma_f32_16x16x32_bf16 v[28:31], a[184:187], a[208:211], v[28:31]
s_waitcnt vmcnt(24)
s_barrier
s_waitcnt lgkmcnt(0)
v_mfma_f32_16x16x32_bf16 v[28:31], a[188:191], a[212:215], v[28:31]
s_xor_b32 m0, s76, 98304
ds_read_b64_tr_b16 a[144:145], v196 offset:0
v_mfma_f32_16x16x32_bf16 v[60:63], a[188:191], a[220:223], v[60:63]
s_xor_b32 s64, s85, 786432
ds_read_b64_tr_b16 a[146:147], v196 offset:4096
v_mfma_f32_16x16x32_bf16 v[60:63], a[184:187], a[216:219], v[60:63]
buffer_load_dwordx4 v12, s[40:43], s64 offen lds
v_mfma_f32_16x16x32_bf16 v[92:95], a[184:187], a[224:227], v[92:95]
ds_read_b64_tr_b16 a[148:149], v196 offset:8192
v_mfma_f32_16x16x32_bf16 v[92:95], a[188:191], a[228:231], v[92:95]
s_xor_b32 m0, s76, 99328
ds_read_b64_tr_b16 a[150:151], v196 offset:12288
v_mfma_f32_16x16x32_bf16 v[124:127], a[188:191], a[236:239], v[124:127]
s_xor_b32 s64, s85, 794624
ds_read_b64_tr_b16 a[152:153], v197 offset:0
v_mfma_f32_16x16x32_bf16 v[124:127], a[184:187], a[232:235], v[124:127]
buffer_load_dwordx4 v13, s[40:43], s64 offen lds
v_mfma_f32_16x16x32_bf16 v[128:131], a[192:195], a[232:235], v[128:131]
ds_read_b64_tr_b16 a[154:155], v197 offset:4096
v_mfma_f32_16x16x32_bf16 v[128:131], a[196:199], a[236:239], v[128:131]
s_xor_b32 m0, s76, 100352
ds_read_b64_tr_b16 a[156:157], v197 offset:8192
v_mfma_f32_16x16x32_bf16 v[96:99], a[196:199], a[228:231], v[96:99]
s_xor_b32 s64, s85, 802816
ds_read_b64_tr_b16 a[158:159], v197 offset:12288
v_mfma_f32_16x16x32_bf16 v[96:99], a[192:195], a[224:227], v[96:99]
buffer_load_dwordx4 v12, s[40:43], s64 offen lds
v_mfma_f32_16x16x32_bf16 v[64:67], a[192:195], a[216:219], v[64:67]
ds_read_b64_tr_b16 a[160:161], v198 offset:0
v_mfma_f32_16x16x32_bf16 v[64:67], a[196:199], a[220:223], v[64:67]
s_xor_b32 m0, s76, 101376
ds_read_b64_tr_b16 a[162:163], v198 offset:4096
v_mfma_f32_16x16x32_bf16 v[32:35], a[196:199], a[212:215], v[32:35]
s_xor_b32 s64, s85, 811008
ds_read_b64_tr_b16 a[164:165], v198 offset:8192
v_mfma_f32_16x16x32_bf16 v[32:35], a[192:195], a[208:211], v[32:35]
buffer_load_dwordx4 v13, s[40:43], s64 offen lds
v_mfma_f32_16x16x32_bf16 v[36:39], a[200:203], a[208:211], v[36:39]
ds_read_b64_tr_b16 a[166:167], v198 offset:12288
v_mfma_f32_16x16x32_bf16 v[36:39], a[204:207], a[212:215], v[36:39]
s_xor_b32 m0, s76, 102400
v_mfma_f32_16x16x32_bf16 v[68:71], a[204:207], a[220:223], v[68:71]
s_xor_b32 s64, s85, 819200
v_mfma_f32_16x16x32_bf16 v[68:71], a[200:203], a[216:219], v[68:71]
buffer_load_dwordx4 v12, s[40:43], s64 offen lds
v_mfma_f32_16x16x32_bf16 v[100:103], a[200:203], a[224:227], v[100:103]
s_xor_b32 s66, s2, 1
s_lshl2_add_u32 s66, s66, s30
s_lshl_b32 s73, s66, 12
v_mfma_f32_16x16x32_bf16 v[100:103], a[204:207], a[228:231], v[100:103]
s_add_u32 s73, s73, 67108864
s_lshl2_add_u32 s66, s2, s30
s_lshl_b32 s75, s66, 12
v_mfma_f32_16x16x32_bf16 v[132:135], a[204:207], a[236:239], v[132:135]
s_add_u32 s75, s75, 67108864
s_lshl_b32 s77, s82, 18
s_lshl_b32 s66, s30, 16
v_mfma_f32_16x16x32_bf16 v[132:135], a[200:203], a[232:235], v[132:135]
s_waitcnt vmcnt(25)
s_waitcnt lgkmcnt(1)
s_add_u32 s77, s77, s66
s_add_u32 s77, s77, s87
s_lshl_b32 s66, s83, 7
s_xor_b32 m0, s76, 103424
v_mfma_f32_16x16x32_bf16 v[136:139], a[144:147], v[176:179], v[136:139]
s_waitcnt vmcnt(21)
s_add_u32 s77, s77, s66
s_xor_b32 s64, s85, 827392
ds_read_b64_tr_b16 a[168:169], v199 offset:0
v_lshlrev_b32 v1, 24, v0
v_mfma_f32_16x16x32_bf16 v[136:139], a[148:151], v[180:183], v[136:139]
buffer_load_dwordx4 v13, s[40:43], s64 offen lds
v_mfma_f32_16x16x32_bf16 v[104:107], a[148:151], v[172:175], v[104:107]
s_xor_b32 m0, s76, 104448
ds_read_b64_tr_b16 a[170:171], v199 offset:4096
v_and_b32 v8, 7, v0
v_mfma_f32_16x16x32_bf16 v[104:107], a[144:147], v[168:171], v[104:107]
s_xor_b32 s64, s85, 835584
ds_read_b64_tr_b16 a[172:173], v199 offset:8192
v_lshlrev_b32 v8, 11, v8
v_mfma_f32_16x16x32_bf16 v[72:75], a[144:147], v[160:163], v[72:75]
buffer_load_dwordx4 v12, s[40:43], s64 offen lds
v_mfma_f32_16x16x32_bf16 v[72:75], a[148:151], v[164:167], v[72:75]
s_xor_b32 m0, s76, 105472
ds_read_b64_tr_b16 a[174:175], v199 offset:12288
v_bfe_u32 v10, v0, 3, 1
v_mfma_f32_16x16x32_bf16 v[40:43], a[148:151], v[156:159], v[40:43]
s_xor_b32 s64, s85, 843776
ds_read_b64_tr_b16 a[176:177], v192 offset:0
v_lshl_add_u32 v8, v10, 6, v8
v_mfma_f32_16x16x32_bf16 v[40:43], a[144:147], v[152:155], v[40:43]
buffer_load_dwordx4 v13, s[40:43], s64 offen lds
v_mfma_f32_16x16x32_bf16 v[44:47], a[152:155], v[152:155], v[44:47]
ds_read_b64_tr_b16 a[178:179], v192 offset:4096
v_bfe_u32 v10, v0, 4, 1
v_mfma_f32_16x16x32_bf16 v[44:47], a[156:159], v[156:159], v[44:47]
ds_read_b64_tr_b16 a[180:181], v192 offset:8192
v_lshl_add_u32 v8, v10, 5, v8
v_mfma_f32_16x16x32_bf16 v[76:79], a[156:159], v[164:167], v[76:79]
s_xor_b32 s65, s84, 98304
ds_read_b64_tr_b16 a[182:183], v192 offset:12288
v_lshrrev_b32 v10, 5, v0
v_mfma_f32_16x16x32_bf16 v[76:79], a[152:155], v[160:163], v[76:79]
buffer_load_dwordx4 a[32:35], v14, s[44:47], s65 offen offset:0 sc1
v_mfma_f32_16x16x32_bf16 v[108:111], a[152:155], v[168:171], v[108:111]
ds_read_b64_tr_b16 a[184:185], v193 offset:0
v_lshl_add_u32 v8, v10, 4, v8
v_mfma_f32_16x16x32_bf16 v[108:111], a[156:159], v[172:175], v[108:111]
ds_read_b64_tr_b16 a[186:187], v193 offset:4096
v_add_u32 v2, s86, v16
v_mfma_f32_16x16x32_bf16 v[140:143], a[156:159], v[180:183], v[140:143]
buffer_load_dwordx4 a[40:43], v14, s[44:47], s65 offen offset:1024 sc1
v_mfma_f32_16x16x32_bf16 v[140:143], a[152:155], v[176:179], v[140:143]
ds_read_b64_tr_b16 a[188:189], v193 offset:8192
v_xor_b32 v3, 0x2000, v2
v_mfma_f32_16x16x32_bf16 v[144:147], a[160:163], v[176:179], v[144:147]
s_waitcnt lgkmcnt(5)
ds_read_b64_tr_b16 a[190:191], v193 offset:12288
v_mov_b32 v232, 0
v_mfma_f32_16x16x32_bf16 v[144:147], a[164:167], v[180:183], v[144:147]
v_mov_b32 v233, 0
v_mov_b32 v236, 0
v_mfma_f32_16x16x32_bf16 v[112:115], a[164:167], v[172:175], v[112:115]
buffer_load_dwordx4 a[48:51], v15, s[44:47], s65 offen offset:0 sc1
v_mfma_f32_16x16x32_bf16 v[112:115], a[160:163], v[168:171], v[112:115]
ds_read_b64_tr_b16 a[192:193], v194 offset:0
v_mov_b32 v237, 0
v_mfma_f32_16x16x32_bf16 v[80:83], a[160:163], v[160:163], v[80:83]
ds_read_b64_tr_b16 a[194:195], v194 offset:4096
v_and_b32 v9, 1, v0
v_mfma_f32_16x16x32_bf16 v[80:83], a[164:167], v[164:167], v[80:83]
buffer_load_dwordx4 a[56:59], v15, s[44:47], s65 offen offset:1024 sc1
v_mfma_f32_16x16x32_bf16 v[48:51], a[164:167], v[156:159], v[48:51]
ds_read_b64_tr_b16 a[196:197], v194 offset:8192
v_lshlrev_b32 v9, 4, v9
v_mfma_f32_16x16x32_bf16 v[48:51], a[160:163], v[152:155], v[48:51]
ds_read_b64_tr_b16 a[198:199], v194 offset:12288
v_mov_b32 v10, 0x3f80
v_mfma_f32_16x16x32_bf16 v[52:55], a[168:171], v[152:155], v[52:55]
s_xor_b32 s65, s84, 106496
v_lshlrev_b32 v9, v9, v10
v_lshrrev_b32 v10, 4, v0
v_mfma_f32_16x16x32_bf16 v[52:55], a[172:175], v[156:159], v[52:55]
buffer_load_dwordx4 a[36:39], v14, s[44:47], s65 offen offset:0 sc1
v_mfma_f32_16x16x32_bf16 v[84:87], a[172:175], v[164:167], v[84:87]
ds_read_b64_tr_b16 a[200:201], v195 offset:0
v_lshlrev_b32 v10, 1, v10
v_mfma_f32_16x16x32_bf16 v[84:87], a[168:171], v[160:163], v[84:87]
ds_read_b64_tr_b16 a[202:203], v195 offset:4096
v_bfe_u32 v11, v0, 1, 3
v_mfma_f32_16x16x32_bf16 v[116:119], a[168:171], v[168:171], v[116:119]
buffer_load_dwordx4 a[44:47], v14, s[44:47], s65 offen offset:1024 sc1
v_mfma_f32_16x16x32_bf16 v[116:119], a[172:175], v[172:175], v[116:119]
ds_read_b64_tr_b16 a[204:205], v195 offset:8192
v_xor_b32 v10, v10, v11
v_mfma_f32_16x16x32_bf16 v[148:151], a[172:175], v[180:183], v[148:151]
ds_read_b64_tr_b16 a[206:207], v195 offset:12288
v_subrev_u32 v11, 1, v10
v_mfma_f32_16x16x32_bf16 v[148:151], a[168:171], v[176:179], v[148:151]
v_ashrrev_i32 v11, 31, v11
v_and_b32 v234, v11, v9
v_mfma_f32_16x16x32_bf16 v[120:123], a[176:179], v[176:179], v[120:123]
s_waitcnt lgkmcnt(4)
buffer_load_dwordx4 a[52:55], v15, s[44:47], s65 offen offset:0 sc1
v_mfma_f32_16x16x32_bf16 v[120:123], a[180:183], v[180:183], v[120:123]
v_xor_b32 v10, 1, v10
v_subrev_u32 v11, 1, v10
v_mfma_f32_16x16x32_bf16 v[88:91], a[180:183], v[172:175], v[88:91]
v_ashrrev_i32 v11, 31, v11
v_and_b32 v235, v11, v9
v_mfma_f32_16x16x32_bf16 v[88:91], a[176:179], v[168:171], v[88:91]
s_mov_b32 s48, s24
buffer_load_dwordx4 a[60:63], v15, s[44:47], s65 offen offset:1024 sc1
v_mfma_f32_16x16x32_bf16 v[56:59], a[176:179], v[160:163], v[56:59]
s_mov_b32 s49, s25
s_mov_b32 s50, 4194304
s_mov_b32 s51, 0x20000
v_mfma_f32_16x16x32_bf16 v[56:59], a[180:183], v[164:167], v[56:59]
v_mfma_f32_16x16x32_bf16 v[24:27], a[180:183], v[156:159], v[24:27]
v_mfma_f32_16x16x32_bf16 v[24:27], a[176:179], v[152:155], v[24:27]
v_mfma_f32_16x16x32_bf16 v[28:31], a[184:187], v[152:155], v[28:31]
s_waitcnt vmcnt(24)
s_barrier
v_mfma_f32_16x16x32_bf16 v[28:31], a[188:191], v[156:159], v[28:31]
ds_read_b64_tr_b16 a[144:145], v196 offset:32768
v_mfma_f32_16x16x32_bf16 v[60:63], a[188:191], v[164:167], v[60:63]
ds_read_b64_tr_b16 a[146:147], v196 offset:36864
v_mfma_f32_16x16x32_bf16 v[60:63], a[184:187], v[160:163], v[60:63]
ds_read_b64_tr_b16 a[148:149], v196 offset:40960
v_mfma_f32_16x16x32_bf16 v[92:95], a[184:187], v[168:171], v[92:95]
ds_read_b64_tr_b16 a[150:151], v196 offset:45056
v_mfma_f32_16x16x32_bf16 v[92:95], a[188:191], v[172:175], v[92:95]
ds_read_b64_tr_b16 a[152:153], v197 offset:32768
v_mfma_f32_16x16x32_bf16 v[124:127], a[188:191], v[180:183], v[124:127]
ds_read_b64_tr_b16 a[154:155], v197 offset:36864
v_mfma_f32_16x16x32_bf16 v[124:127], a[184:187], v[176:179], v[124:127]
ds_read_b64_tr_b16 a[156:157], v197 offset:40960
v_mfma_f32_16x16x32_bf16 v[128:131], a[192:195], v[176:179], v[128:131]
ds_read_b64_tr_b16 a[158:159], v197 offset:45056
v_mfma_f32_16x16x32_bf16 v[128:131], a[196:199], v[180:183], v[128:131]
ds_read_b64_tr_b16 a[160:161], v198 offset:32768
v_mfma_f32_16x16x32_bf16 v[96:99], a[196:199], v[172:175], v[96:99]
ds_read_b64_tr_b16 a[162:163], v198 offset:36864
v_mfma_f32_16x16x32_bf16 v[96:99], a[192:195], v[168:171], v[96:99]
ds_read_b64_tr_b16 a[164:165], v198 offset:40960
v_mfma_f32_16x16x32_bf16 v[64:67], a[192:195], v[160:163], v[64:67]
ds_read_b64_tr_b16 a[166:167], v198 offset:45056
v_mfma_f32_16x16x32_bf16 v[64:67], a[196:199], v[164:167], v[64:67]
v_mfma_f32_16x16x32_bf16 v[32:35], a[196:199], v[156:159], v[32:35]
v_mfma_f32_16x16x32_bf16 v[32:35], a[192:195], v[152:155], v[32:35]
s_waitcnt lgkmcnt(5)
v_mfma_f32_16x16x32_bf16 v[36:39], a[200:203], v[152:155], v[36:39]
v_mfma_f32_16x16x32_bf16 v[36:39], a[204:207], v[156:159], v[36:39]
v_mfma_f32_16x16x32_bf16 v[68:71], a[204:207], v[164:167], v[68:71]
v_mfma_f32_16x16x32_bf16 v[68:71], a[200:203], v[160:163], v[68:71]
v_mfma_f32_16x16x32_bf16 v[100:103], a[200:203], v[168:171], v[100:103]
v_mfma_f32_16x16x32_bf16 v[100:103], a[204:207], v[172:175], v[100:103]
v_mfma_f32_16x16x32_bf16 v[132:135], a[204:207], v[180:183], v[132:135]
v_mfma_f32_16x16x32_bf16 v[132:135], a[200:203], v[176:179], v[132:135]
s_waitcnt vmcnt(20)
v_mfma_f32_16x16x32_bf16 v[136:139], a[144:147], a[24:27], v[136:139]
s_waitcnt vmcnt(16)
ds_read_b64_tr_b16 a[168:169], v199 offset:32768
v_mfma_f32_16x16x32_bf16 v[136:139], a[148:151], a[28:31], v[136:139]
ds_read_b64_tr_b16 a[170:171], v199 offset:36864
v_mfma_f32_16x16x32_bf16 v[104:107], a[148:151], a[20:23], v[104:107]
ds_read_b64_tr_b16 a[172:173], v199 offset:40960
v_mfma_f32_16x16x32_bf16 v[104:107], a[144:147], a[16:19], v[104:107]
ds_read_b64_tr_b16 a[174:175], v199 offset:45056
v_mfma_f32_16x16x32_bf16 v[72:75], a[144:147], a[8:11], v[72:75]
v_mfma_f32_16x16x32_bf16 v[72:75], a[148:151], a[12:15], v[72:75]
v_mfma_f32_16x16x32_bf16 v[40:43], a[148:151], a[4:7], v[40:43]
s_waitcnt vmcnt(8)
s_barrier
v_mfma_f32_16x16x32_bf16 v[40:43], a[144:147], a[0:3], v[40:43]
ds_read_b64_tr_b16 a[176:177], v188 offset:0
v_mfma_f32_16x16x32_bf16 v[44:47], a[152:155], a[0:3], v[44:47]
s_waitcnt lgkmcnt(4)
ds_read_b64_tr_b16 a[178:179], v188 offset:4096
v_mfma_f32_16x16x32_bf16 v[44:47], a[156:159], a[4:7], v[44:47]
ds_read_b64_tr_b16 a[180:181], v188 offset:8192
v_mfma_f32_16x16x32_bf16 v[76:79], a[156:159], a[12:15], v[76:79]
ds_read_b64_tr_b16 a[182:183], v188 offset:12288
v_mfma_f32_16x16x32_bf16 v[76:79], a[152:155], a[8:11], v[76:79]
ds_read_b64_tr_b16 a[184:185], v189 offset:0
v_mfma_f32_16x16x32_bf16 v[108:111], a[152:155], a[16:19], v[108:111]
ds_read_b64_tr_b16 a[186:187], v189 offset:4096
v_mfma_f32_16x16x32_bf16 v[108:111], a[156:159], a[20:23], v[108:111]
ds_read_b64_tr_b16 a[188:189], v189 offset:8192
v_mfma_f32_16x16x32_bf16 v[140:143], a[156:159], a[28:31], v[140:143]
ds_read_b64_tr_b16 a[190:191], v189 offset:12288
v_mfma_f32_16x16x32_bf16 v[140:143], a[152:155], a[24:27], v[140:143]
v_mfma_f32_16x16x32_bf16 v[144:147], a[160:163], a[24:27], v[144:147]
v_mfma_f32_16x16x32_bf16 v[144:147], a[164:167], a[28:31], v[144:147]
v_mfma_f32_16x16x32_bf16 v[112:115], a[164:167], a[20:23], v[112:115]
ds_read_b64_tr_b16 a[192:193], v190 offset:0
v_mfma_f32_16x16x32_bf16 v[112:115], a[160:163], a[16:19], v[112:115]
ds_read_b64_tr_b16 a[194:195], v190 offset:4096
v_mfma_f32_16x16x32_bf16 v[80:83], a[160:163], a[8:11], v[80:83]
ds_read_b64_tr_b16 a[196:197], v190 offset:8192
v_mfma_f32_16x16x32_bf16 v[80:83], a[164:167], a[12:15], v[80:83]
ds_read_b64_tr_b16 a[198:199], v190 offset:12288
v_mfma_f32_16x16x32_bf16 v[48:51], a[164:167], a[4:7], v[48:51]
v_mfma_f32_16x16x32_bf16 v[48:51], a[160:163], a[0:3], v[48:51]
s_waitcnt lgkmcnt(4)
v_mfma_f32_16x16x32_bf16 v[52:55], a[168:171], a[0:3], v[52:55]
v_mfma_f32_16x16x32_bf16 v[52:55], a[172:175], a[4:7], v[52:55]
v_mfma_f32_16x16x32_bf16 v[84:87], a[172:175], a[12:15], v[84:87]
ds_read_b64_tr_b16 a[200:201], v191 offset:0
v_mfma_f32_16x16x32_bf16 v[84:87], a[168:171], a[8:11], v[84:87]
ds_read_b64_tr_b16 a[202:203], v191 offset:4096
v_mfma_f32_16x16x32_bf16 v[116:119], a[168:171], a[16:19], v[116:119]
ds_read_b64_tr_b16 a[204:205], v191 offset:8192
v_mfma_f32_16x16x32_bf16 v[116:119], a[172:175], a[20:23], v[116:119]
ds_read_b64_tr_b16 a[206:207], v191 offset:12288
v_mfma_f32_16x16x32_bf16 v[148:151], a[172:175], a[28:31], v[148:151]
v_mfma_f32_16x16x32_bf16 v[148:151], a[168:171], a[24:27], v[148:151]
s_waitcnt vmcnt(4)
v_mfma_f32_16x16x32_bf16 v[136:139], a[176:179], a[56:59], v[136:139]
s_waitcnt vmcnt(0)
v_mfma_f32_16x16x32_bf16 v[136:139], a[180:183], a[60:63], v[136:139]
v_mfma_f32_16x16x32_bf16 v[104:107], a[180:183], a[52:55], v[104:107]
ds_read_b64_tr_b16 a[144:145], v192 offset:32768
v_mfma_f32_16x16x32_bf16 v[104:107], a[176:179], a[48:51], v[104:107]
ds_read_b64_tr_b16 a[146:147], v192 offset:36864
v_mfma_f32_16x16x32_bf16 v[72:75], a[176:179], a[40:43], v[72:75]
ds_read_b64_tr_b16 a[148:149], v192 offset:40960
v_mfma_f32_16x16x32_bf16 v[72:75], a[180:183], a[44:47], v[72:75]
ds_read_b64_tr_b16 a[150:151], v192 offset:45056
v_mfma_f32_16x16x32_bf16 v[40:43], a[180:183], a[36:39], v[40:43]
v_mfma_f32_16x16x32_bf16 v[40:43], a[176:179], a[32:35], v[40:43]
v_mfma_f32_16x16x32_bf16 v[44:47], a[184:187], a[32:35], v[44:47]
v_mfma_f32_16x16x32_bf16 v[44:47], a[188:191], a[36:39], v[44:47]
ds_write_b128 v3, v[136:139] offset:4096
v_mfma_f32_16x16x32_bf16 v[76:79], a[188:191], a[44:47], v[76:79]
ds_read_b64_tr_b16 a[152:153], v193 offset:32768
v_mfma_f32_16x16x32_bf16 v[76:79], a[184:187], a[40:43], v[76:79]
ds_write_b128 v3, v[104:107] offset:0
v_mfma_f32_16x16x32_bf16 v[108:111], a[184:187], a[48:51], v[108:111]
ds_read_b64_tr_b16 a[154:155], v193 offset:36864
v_mfma_f32_16x16x32_bf16 v[108:111], a[188:191], a[52:55], v[108:111]
ds_read_b64_tr_b16 a[156:157], v193 offset:40960
v_mfma_f32_16x16x32_bf16 v[140:143], a[188:191], a[60:63], v[140:143]
ds_read_b64_tr_b16 a[158:159], v193 offset:45056
v_mfma_f32_16x16x32_bf16 v[140:143], a[184:187], a[56:59], v[140:143]
s_waitcnt lgkmcnt(6)
v_mfma_f32_16x16x32_bf16 v[144:147], a[192:195], a[56:59], v[144:147]
v_mfma_f32_16x16x32_bf16 v[144:147], a[196:199], a[60:63], v[144:147]
v_mfma_f32_16x16x32_bf16 v[112:115], a[196:199], a[52:55], v[112:115]
ds_read_b64_tr_b16 a[160:161], v194 offset:32768
v_mfma_f32_16x16x32_bf16 v[112:115], a[192:195], a[48:51], v[112:115]
ds_read_b64_tr_b16 a[162:163], v194 offset:36864
v_mfma_f32_16x16x32_bf16 v[80:83], a[192:195], a[40:43], v[80:83]
ds_read_b64_tr_b16 a[164:165], v194 offset:40960
v_mfma_f32_16x16x32_bf16 v[80:83], a[196:199], a[44:47], v[80:83]
ds_write_b128 v3, v[108:111] offset:1024
v_mfma_f32_16x16x32_bf16 v[48:51], a[196:199], a[36:39], v[48:51]
ds_read_b64_tr_b16 a[166:167], v194 offset:45056
v_mfma_f32_16x16x32_bf16 v[48:51], a[192:195], a[32:35], v[48:51]
ds_write_b128 v3, v[140:143] offset:5120
v_mfma_f32_16x16x32_bf16 v[52:55], a[200:203], a[32:35], v[52:55]
v_mfma_f32_16x16x32_bf16 v[52:55], a[204:207], a[36:39], v[52:55]
ds_write_b128 v3, v[144:147] offset:6144
v_mfma_f32_16x16x32_bf16 v[84:87], a[204:207], a[44:47], v[84:87]
ds_read_b64_tr_b16 a[168:169], v195 offset:32768
v_mfma_f32_16x16x32_bf16 v[84:87], a[200:203], a[40:43], v[84:87]
ds_write_b128 v3, v[112:115] offset:2048
v_mfma_f32_16x16x32_bf16 v[116:119], a[200:203], a[48:51], v[116:119]
ds_read_b64_tr_b16 a[170:171], v195 offset:36864
v_mfma_f32_16x16x32_bf16 v[116:119], a[204:207], a[52:55], v[116:119]
ds_read_b64_tr_b16 a[172:173], v195 offset:40960
v_mfma_f32_16x16x32_bf16 v[148:151], a[204:207], a[60:63], v[148:151]
ds_read_b64_tr_b16 a[174:175], v195 offset:45056
v_mfma_f32_16x16x32_bf16 v[148:151], a[200:203], a[56:59], v[148:151]
v_mfma_f32_16x16x32_bf16 v[120:123], a[144:147], a[24:27], v[120:123]
v_mfma_f32_16x16x32_bf16 v[120:123], a[148:151], a[28:31], v[120:123]
v_mfma_f32_16x16x32_bf16 v[88:91], a[148:151], a[20:23], v[88:91]
ds_read_b64_tr_b16 a[176:177], v184 offset:0
v_mfma_f32_16x16x32_bf16 v[88:91], a[144:147], a[16:19], v[88:91]
ds_read_b64_tr_b16 a[178:179], v184 offset:4096
v_mfma_f32_16x16x32_bf16 v[56:59], a[144:147], a[8:11], v[56:59]
ds_read_b64_tr_b16 a[180:181], v184 offset:8192
v_mfma_f32_16x16x32_bf16 v[56:59], a[148:151], a[12:15], v[56:59]
ds_write_b128 v3, v[116:119] offset:3072
v_mfma_f32_16x16x32_bf16 v[24:27], a[148:151], a[4:7], v[24:27]
ds_read_b64_tr_b16 a[182:183], v184 offset:12288
v_mfma_f32_16x16x32_bf16 v[24:27], a[144:147], a[0:3], v[24:27]
s_waitcnt lgkmcnt(5)
ds_write_b128 v3, v[148:151] offset:7168
v_mfma_f32_16x16x32_bf16 v[28:31], a[152:155], a[0:3], v[28:31]
v_mfma_f32_16x16x32_bf16 v[28:31], a[156:159], a[4:7], v[28:31]
v_mfma_f32_16x16x32_bf16 v[60:63], a[156:159], a[12:15], v[60:63]
s_waitcnt lgkmcnt(0)
s_barrier
v_mfma_f32_16x16x32_bf16 v[60:63], a[152:155], a[8:11], v[60:63]
ds_read_b128 v[200:203], v2 offset:0
ds_read_b128 v[204:207], v2 offset:1024
v_mfma_f32_16x16x32_bf16 v[92:95], a[152:155], a[16:19], v[92:95]
ds_read_b128 v[208:211], v2 offset:2048
ds_read_b128 v[212:215], v2 offset:3072
v_mfma_f32_16x16x32_bf16 v[92:95], a[156:159], a[20:23], v[92:95]
ds_read_b128 v[216:219], v2 offset:4096
ds_read_b128 v[220:223], v2 offset:5120
v_mfma_f32_16x16x32_bf16 v[124:127], a[156:159], a[28:31], v[124:127]
ds_read_b128 v[224:227], v2 offset:6144
ds_read_b128 v[228:231], v2 offset:7168
v_mfma_f32_16x16x32_bf16 v[124:127], a[152:155], a[24:27], v[124:127]
ds_read_b64_tr_b16 a[184:185], v185 offset:0
v_mfma_f32_16x16x32_bf16 v[128:131], a[160:163], a[24:27], v[128:131]
ds_read_b64_tr_b16 a[186:187], v185 offset:4096
v_mfma_f32_16x16x32_bf16 v[128:131], a[164:167], a[28:31], v[128:131]
ds_read_b64_tr_b16 a[188:189], v185 offset:8192
v_mfma_f32_16x16x32_bf16 v[96:99], a[164:167], a[20:23], v[96:99]
s_waitcnt lgkmcnt(10)
ds_read_b64_tr_b16 a[190:191], v185 offset:12288
v_add_f32 v200, v200, v40
v_mfma_f32_16x16x32_bf16 v[96:99], a[160:163], a[16:19], v[96:99]
ds_read_b64_tr_b16 a[192:193], v186 offset:0
v_add_f32 v201, v201, v41
v_mfma_f32_16x16x32_bf16 v[64:67], a[160:163], a[8:11], v[64:67]
ds_read_b64_tr_b16 a[194:195], v186 offset:4096
v_add_f32 v202, v202, v42
v_mfma_f32_16x16x32_bf16 v[64:67], a[164:167], a[12:15], v[64:67]
ds_read_b64_tr_b16 a[196:197], v186 offset:8192
v_add_f32 v203, v203, v43
v_mfma_f32_16x16x32_bf16 v[32:35], a[164:167], a[4:7], v[32:35]
s_waitcnt lgkmcnt(7)
ds_read_b64_tr_b16 a[198:199], v186 offset:12288
v_add_f32 v204, v204, v44
v_mfma_f32_16x16x32_bf16 v[32:35], a[160:163], a[0:3], v[32:35]
v_add_f32 v205, v205, v45
v_add_f32 v206, v206, v46
v_mfma_f32_16x16x32_bf16 v[36:39], a[168:171], a[0:3], v[36:39]
v_add_f32 v207, v207, v47
v_cvt_pk_bf16_f32 v200, v200, v201
v_mfma_f32_16x16x32_bf16 v[36:39], a[172:175], a[4:7], v[36:39]
v_cvt_pk_bf16_f32 v201, v202, v203
v_cvt_pk_bf16_f32 v202, v204, v205
v_cvt_pk_bf16_f32 v203, v206, v207
v_mfma_f32_16x16x32_bf16 v[68:71], a[172:175], a[12:15], v[68:71]
buffer_store_dwordx4 v[200:203], v16, s[44:47], s73 offen offset:0 sc1
v_mfma_f32_16x16x32_bf16 v[68:71], a[168:171], a[8:11], v[68:71]
ds_read_b64_tr_b16 a[200:201], v187 offset:0
v_add_f32 v208, v208, v48
v_mfma_f32_16x16x32_bf16 v[100:103], a[168:171], a[16:19], v[100:103]
ds_read_b64_tr_b16 a[202:203], v187 offset:4096
v_add_f32 v209, v209, v49
v_mfma_f32_16x16x32_bf16 v[100:103], a[172:175], a[20:23], v[100:103]
ds_read_b64_tr_b16 a[204:205], v187 offset:8192
v_add_f32 v210, v210, v50
v_mfma_f32_16x16x32_bf16 v[132:135], a[172:175], a[28:31], v[132:135]
ds_read_b64_tr_b16 a[206:207], v187 offset:12288
v_add_f32 v211, v211, v51
v_mfma_f32_16x16x32_bf16 v[132:135], a[168:171], a[24:27], v[132:135]
v_add_f32 v212, v212, v52
v_add_f32 v213, v213, v53
v_mfma_f32_16x16x32_bf16 v[120:123], a[176:179], a[56:59], v[120:123]
v_add_f32 v214, v214, v54
v_add_f32 v215, v215, v55
v_mfma_f32_16x16x32_bf16 v[120:123], a[180:183], a[60:63], v[120:123]
v_cvt_pk_bf16_f32 v208, v208, v209
v_cvt_pk_bf16_f32 v209, v210, v211
v_cvt_pk_bf16_f32 v210, v212, v213
v_cvt_pk_bf16_f32 v211, v214, v215
v_mfma_f32_16x16x32_bf16 v[88:91], a[180:183], a[52:55], v[88:91]
buffer_store_dwordx4 v[208:211], v16, s[44:47], s73 offen offset:1024 sc1
v_mfma_f32_16x16x32_bf16 v[88:91], a[176:179], a[48:51], v[88:91]
v_add_f32 v216, v216, v72
v_add_f32 v217, v217, v73
v_mfma_f32_16x16x32_bf16 v[56:59], a[176:179], a[40:43], v[56:59]
v_add_f32 v218, v218, v74
v_add_f32 v219, v219, v75
v_mfma_f32_16x16x32_bf16 v[56:59], a[180:183], a[44:47], v[56:59]
s_branch L_po23
L_pg23:
s_branch L_tr2
L_po23:
v_add_f32 v220, v220, v76
v_add_f32 v221, v221, v77
v_mfma_f32_16x16x32_bf16 v[24:27], a[180:183], a[36:39], v[24:27]
v_add_f32 v222, v222, v78
v_add_f32 v223, v223, v79
v_mfma_f32_16x16x32_bf16 v[24:27], a[176:179], a[32:35], v[24:27]
s_waitcnt lgkmcnt(0)
v_cvt_pk_bf16_f32 v216, v216, v217
v_cvt_pk_bf16_f32 v217, v218, v219
v_mfma_f32_16x16x32_bf16 v[28:31], a[184:187], a[32:35], v[28:31]
v_cvt_pk_bf16_f32 v218, v220, v221
v_cvt_pk_bf16_f32 v219, v222, v223
v_mfma_f32_16x16x32_bf16 v[28:31], a[188:191], a[36:39], v[28:31]
buffer_store_dwordx4 v[216:219], v16, s[44:47], s73 offen offset:2048 sc1
v_mfma_f32_16x16x32_bf16 v[60:63], a[188:191], a[44:47], v[60:63]
v_add_f32 v224, v224, v80
v_add_f32 v225, v225, v81
v_mfma_f32_16x16x32_bf16 v[60:63], a[184:187], a[40:43], v[60:63]
v_add_f32 v226, v226, v82
v_add_f32 v227, v227, v83
v_mfma_f32_16x16x32_bf16 v[92:95], a[184:187], a[48:51], v[92:95]
v_add_f32 v228, v228, v84
v_add_f32 v229, v229, v85
v_mfma_f32_16x16x32_bf16 v[92:95], a[188:191], a[52:55], v[92:95]
v_add_f32 v230, v230, v86
v_add_f32 v231, v231, v87
v_mfma_f32_16x16x32_bf16 v[124:127], a[188:191], a[60:63], v[124:127]
v_cvt_pk_bf16_f32 v224, v224, v225
v_cvt_pk_bf16_f32 v225, v226, v227
v_mfma_f32_16x16x32_bf16 v[124:127], a[184:187], a[56:59], v[124:127]
v_cvt_pk_bf16_f32 v226, v228, v229
v_cvt_pk_bf16_f32 v227, v230, v231
v_mfma_f32_16x16x32_bf16 v[128:131], a[192:195], a[56:59], v[128:131]
buffer_store_dwordx4 v[224:227], v16, s[44:47], s73 offen offset:3072 sc1
v_mfma_f32_16x16x32_bf16 v[128:131], a[196:199], a[60:63], v[128:131]
ds_write_b128 v3, v[120:123] offset:36864
v_mfma_f32_16x16x32_bf16 v[96:99], a[196:199], a[52:55], v[96:99]
ds_write_b128 v3, v[88:91] offset:32768
v_mfma_f32_16x16x32_bf16 v[96:99], a[192:195], a[48:51], v[96:99]
v_mfma_f32_16x16x32_bf16 v[64:67], a[192:195], a[40:43], v[64:67]
v_mfma_f32_16x16x32_bf16 v[64:67], a[196:199], a[44:47], v[64:67]
ds_write_b128 v3, v[92:95] offset:33792
v_mfma_f32_16x16x32_bf16 v[32:35], a[196:199], a[36:39], v[32:35]
v_mfma_f32_16x16x32_bf16 v[32:35], a[192:195], a[32:35], v[32:35]
ds_write_b128 v3, v[124:127] offset:37888
v_mfma_f32_16x16x32_bf16 v[36:39], a[200:203], a[32:35], v[36:39]
v_mfma_f32_16x16x32_bf16 v[36:39], a[204:207], a[36:39], v[36:39]
ds_write_b128 v3, v[128:131] offset:38912
v_mfma_f32_16x16x32_bf16 v[68:71], a[204:207], a[44:47], v[68:71]
v_mfma_f32_16x16x32_bf16 v[68:71], a[200:203], a[40:43], v[68:71]
ds_write_b128 v3, v[96:99] offset:34816
v_mfma_f32_16x16x32_bf16 v[100:103], a[200:203], a[48:51], v[100:103]
v_mfma_f32_16x16x32_bf16 v[100:103], a[204:207], a[52:55], v[100:103]
v_mfma_f32_16x16x32_bf16 v[132:135], a[204:207], a[60:63], v[132:135]
v_mfma_f32_16x16x32_bf16 v[132:135], a[200:203], a[56:59], v[132:135]
buffer_load_dwordx4 v[152:155], v16, s[44:47], s75 offen offset:0 sc1
buffer_load_dwordx4 v[156:159], v16, s[44:47], s75 offen offset:1024 sc1
buffer_load_dwordx4 v[160:163], v16, s[44:47], s75 offen offset:2048 sc1
buffer_load_dwordx4 v[164:167], v16, s[44:47], s75 offen offset:3072 sc1
s_nop 3
ds_write_b128 v3, v[100:103] offset:35840
ds_write_b128 v3, v[132:135] offset:39936
s_mov_b32 s72, 0x20000
s_waitcnt lgkmcnt(0)
s_barrier
ds_read_b128 v[88:91], v2 offset:32768
ds_read_b128 v[92:95], v2 offset:33792
ds_read_b128 v[96:99], v2 offset:34816
ds_read_b128 v[100:103], v2 offset:35840
ds_read_b128 v[120:123], v2 offset:36864
ds_read_b128 v[124:127], v2 offset:37888
ds_read_b128 v[128:131], v2 offset:38912
ds_read_b128 v[132:135], v2 offset:39936
s_waitcnt lgkmcnt(7)
v_add_f32 v24, v24, v88
v_add_f32 v25, v25, v89
v_add_f32 v26, v26, v90
v_add_f32 v27, v27, v91
s_waitcnt lgkmcnt(6)
v_add_f32 v28, v28, v92
v_add_f32 v29, v29, v93
v_add_f32 v30, v30, v94
v_add_f32 v31, v31, v95
s_waitcnt lgkmcnt(5)
v_add_f32 v32, v32, v96
v_add_f32 v33, v33, v97
v_add_f32 v34, v34, v98
v_add_f32 v35, v35, v99
s_waitcnt lgkmcnt(4)
v_add_f32 v36, v36, v100
v_add_f32 v37, v37, v101
v_add_f32 v38, v38, v102
v_add_f32 v39, v39, v103
s_waitcnt lgkmcnt(3)
v_add_f32 v56, v56, v120
v_add_f32 v57, v57, v121
v_add_f32 v58, v58, v122
v_add_f32 v59, v59, v123
s_waitcnt lgkmcnt(2)
v_add_f32 v60, v60, v124
v_add_f32 v61, v61, v125
v_add_f32 v62, v62, v126
v_add_f32 v63, v63, v127
s_waitcnt lgkmcnt(1)
v_add_f32 v64, v64, v128
v_add_f32 v65, v65, v129
v_add_f32 v66, v66, v130
v_add_f32 v67, v67, v131
s_waitcnt lgkmcnt(0)
v_add_f32 v68, v68, v132
v_add_f32 v69, v69, v133
v_add_f32 v70, v70, v134
v_add_f32 v71, v71, v135
L_xchk:
s_waitcnt vmcnt(0)
v_max3_u32 v9, v152, v153, v154
v_max3_u32 v9, v9, v155, v156
v_max3_u32 v9, v9, v157, v158
v_max3_u32 v9, v9, v159, v160
v_max3_u32 v9, v9, v161, v162
v_max3_u32 v9, v9, v163, v164
v_max3_u32 v9, v9, v165, v166
v_max_u32 v9, v9, v167
v_cmp_eq_u32 vcc, -1, v9
s_cbranch_vccnz L_xretry
L_xgo:
v_mfma_f32_16x16x32_bf16 v[24:27], v[234:237], v[152:155], v[24:27]
v_mfma_f32_16x16x32_bf16 v[28:31], v[232:235], v[152:155], v[28:31]
v_mfma_f32_16x16x32_bf16 v[32:35], v[234:237], v[156:159], v[32:35]
v_mfma_f32_16x16x32_bf16 v[36:39], v[232:235], v[156:159], v[36:39]
v_mfma_f32_16x16x32_bf16 v[56:59], v[234:237], v[160:163], v[56:59]
v_mfma_f32_16x16x32_bf16 v[60:63], v[232:235], v[160:163], v[60:63]
v_mfma_f32_16x16x32_bf16 v[64:67], v[234:237], v[164:167], v[64:67]
v_mfma_f32_16x16x32_bf16 v[68:71], v[232:235], v[164:167], v[68:71]
s_nop 1
v_cvt_pk_bf16_f32 v24, v24, v25
v_cvt_pk_bf16_f32 v25, v26, v27
v_cvt_pk_bf16_f32 v26, v28, v29
v_cvt_pk_bf16_f32 v27, v30, v31
v_cvt_pk_bf16_f32 v32, v32, v33
v_cvt_pk_bf16_f32 v33, v34, v35
v_cvt_pk_bf16_f32 v34, v36, v37
v_cvt_pk_bf16_f32 v35, v38, v39
v_permlane16_swap_b32 v24, v26
v_permlane16_swap_b32 v25, v27
v_permlane16_swap_b32 v32, v34
v_permlane16_swap_b32 v33, v35
v_mov_b32 v28, v24
v_mov_b32 v29, v25
v_mov_b32 v30, v26
v_mov_b32 v31, v27
v_mov_b32_dpp v24, v32 row_ror:8 row_mask:0xf bank_mask:0xc
v_mov_b32_dpp v25, v33 row_ror:8 row_mask:0xf bank_mask:0xc
v_mov_b32_dpp v26, v34 row_ror:8 row_mask:0xf bank_mask:0xc
v_mov_b32_dpp v27, v35 row_ror:8 row_mask:0xf bank_mask:0xc
v_mov_b32_dpp v32, v28 row_ror:8 row_mask:0xf bank_mask:0x3
v_mov_b32_dpp v33, v29 row_ror:8 row_mask:0xf bank_mask:0x3
v_mov_b32_dpp v34, v30 row_ror:8 row_mask:0xf bank_mask:0x3
v_mov_b32_dpp v35, v31 row_ror:8 row_mask:0xf bank_mask:0x3
buffer_store_dwordx4 v[24:27], v8, s[48:51], s77 offen sc1
s_add_u32 s77, s77, 16384
buffer_store_dwordx4 v[32:35], v8, s[48:51], s77 offen sc1
s_add_u32 s77, s77, 16384
v_cvt_pk_bf16_f32 v56, v56, v57
v_cvt_pk_bf16_f32 v57, v58, v59
v_cvt_pk_bf16_f32 v58, v60, v61
v_cvt_pk_bf16_f32 v59, v62, v63
v_cvt_pk_bf16_f32 v64, v64, v65
v_cvt_pk_bf16_f32 v65, v66, v67
v_cvt_pk_bf16_f32 v66, v68, v69
v_cvt_pk_bf16_f32 v67, v70, v71
v_permlane16_swap_b32 v56, v58
v_permlane16_swap_b32 v57, v59
v_permlane16_swap_b32 v64, v66
v_permlane16_swap_b32 v65, v67
v_mov_b32 v60, v56
v_mov_b32 v61, v57
v_mov_b32 v62, v58
v_mov_b32 v63, v59
v_mov_b32_dpp v56, v64 row_ror:8 row_mask:0xf bank_mask:0xc
v_mov_b32_dpp v57, v65 row_ror:8 row_mask:0xf bank_mask:0xc
v_mov_b32_dpp v58, v66 row_ror:8 row_mask:0xf bank_mask:0xc
v_mov_b32_dpp v59, v67 row_ror:8 row_mask:0xf bank_mask:0xc
v_mov_b32_dpp v64, v60 row_ror:8 row_mask:0xf bank_mask:0x3
v_mov_b32_dpp v65, v61 row_ror:8 row_mask:0xf bank_mask:0x3
v_mov_b32_dpp v66, v62 row_ror:8 row_mask:0xf bank_mask:0x3
v_mov_b32_dpp v67, v63 row_ror:8 row_mask:0xf bank_mask:0x3
buffer_store_dwordx4 v[56:59], v8, s[48:51], s77 offen sc1
s_add_u32 s77, s77, 16384
buffer_store_dwordx4 v[64:67], v8, s[48:51], s77 offen sc1
s_add_u32 s77, s77, 16384
L_end:
s_endpgm
L_xretry:
s_sub_u32 s72, s72, 1
s_cbranch_scc1 L_xgo
buffer_load_dwordx4 v[152:155], v16, s[44:47], s75 offen offset:0 sc1
buffer_load_dwordx4 v[156:159], v16, s[44:47], s75 offen offset:1024 sc1
buffer_load_dwordx4 v[160:163], v16, s[44:47], s75 offen offset:2048 sc1
buffer_load_dwordx4 v[164:167], v16, s[44:47], s75 offen offset:3072 sc1
s_branch L_xchk
L_spin_1:
s_mov_b32 vcc_hi, 0x80000
L_spinlp_3:
s_sleep 1
buffer_load_dword v1, off, s[52:55], s78 offset:0 sc1
s_waitcnt vmcnt(0)
v_readfirstlane_b32 vcc_lo, v1
s_sub_u32 vcc_hi, vcc_hi, 1
s_cbranch_scc1 L_spinbk_2
s_cmp_lt_u32 vcc_lo, s81
s_cbranch_scc1 L_spinlp_3
s_branch L_spinbk_2
L_spin_4:
s_mov_b32 vcc_hi, 0x80000
L_spinlp_6:
s_sleep 1
buffer_load_dword v1, off, s[52:55], s70 offset:0 sc1
s_waitcnt vmcnt(0)
v_readfirstlane_b32 vcc_lo, v1
s_sub_u32 vcc_hi, vcc_hi, 1
s_cbranch_scc1 L_spinbk_5
s_cmp_lt_u32 vcc_lo, s81
s_cbranch_scc1 L_spinlp_6
s_branch L_spinbk_5
L_hretry:
s_sub_u32 s72, s72, 1
s_cbranch_scc1 L_hgo
buffer_load_dwordx4 v[88:91], v16, s[44:47], s77 offen sc1
s_waitcnt vmcnt(0)
s_branch L_hchk
L_spin_8:
s_mov_b32 vcc_hi, 0x80000
L_spinlp_10:
s_sleep 1
buffer_load_dword v19, off, s[52:55], s80 offset:0 sc1
s_waitcnt vmcnt(0)
v_readfirstlane_b32 vcc_lo, v19
s_sub_u32 vcc_hi, vcc_hi, 1
s_cbranch_scc1 L_spinbk_9
s_cmp_lt_u32 vcc_lo, s69
s_cbranch_scc1 L_spinlp_10
s_branch L_spinbk_9
L_spin_1012:
s_mov_b32 vcc_hi, 0x80000
L_spinlp_1014:
s_sleep 1
buffer_load_dword v19, off, s[52:55], s80 offset:0 sc1
s_waitcnt vmcnt(0)
v_readfirstlane_b32 vcc_lo, v19
s_sub_u32 vcc_hi, vcc_hi, 1
s_cbranch_scc1 L_spinbk_1013
s_cmp_lt_u32 vcc_lo, s69
s_cbranch_scc1 L_spinlp_1014
s_branch L_spinbk_1013
L_F1:
ds_read_b128 a[144:147], v2 offset:0
ds_read_b128 a[148:151], v2 offset:1024
ds_read_b128 a[152:155], v2 offset:2048
ds_read_b128 a[156:159], v2 offset:3072
ds_read_b128 a[160:163], v2 offset:4096
ds_read_b128 a[164:167], v2 offset:5120
ds_read_b128 a[168:171], v2 offset:6144
ds_read_b128 a[172:175], v2 offset:7168
s_mov_b32 m0, s71
s_nop 0
buffer_load_dwordx4 v16, s[32:35], s70 offen offset:0 sc1 lds
buffer_load_dwordx4 v16, s[32:35], s70 offen offset:1024 sc1 lds
s_waitcnt lgkmcnt(7)
v_mfma_f32_16x16x32_bf16 v[104:107], a[144:147], v[40:43], 0
s_waitcnt lgkmcnt(6)
ds_read_b128 a[176:179], v2 offset:8192
v_cndmask_b32 v88, 0, v17, s[0:1]
v_mfma_f32_16x16x32_bf16 v[104:107], a[148:151], v[44:47], v[104:107]
s_waitcnt lgkmcnt(6)
ds_read_b128 a[180:183], v2 offset:9216
v_cndmask_b32 v89, 0, v17, s[4:5]
v_mfma_f32_16x16x32_bf16 v[104:107], a[152:155], v[48:51], v[104:107]
s_waitcnt lgkmcnt(6)
buffer_load_dwordx4 v16, s[32:35], s70 offen offset:2048 sc1 lds
v_mfma_f32_16x16x32_bf16 v[104:107], a[156:159], v[52:55], v[104:107]
ds_read_b128 a[184:187], v2 offset:10240
v_cndmask_b32 v90, 0, v17, s[6:7]
v_mfma_f32_16x16x32_bf16 v[120:123], a[156:159], v[68:71], 0
ds_read_b128 a[188:191], v2 offset:11264
v_cndmask_b32 v91, 0, v17, s[8:9]
v_mfma_f32_16x16x32_bf16 v[120:123], a[152:155], v[64:67], v[120:123]
ds_read_b128 a[192:195], v2 offset:12288
v_accvgpr_write_b32 a128, 0
v_mfma_f32_16x16x32_bf16 v[120:123], a[148:151], v[60:63], v[120:123]
ds_read_b128 a[196:199], v2 offset:13312
v_accvgpr_write_b32 a129, 0
v_mfma_f32_16x16x32_bf16 v[120:123], a[144:147], v[56:59], v[120:123]
ds_read_b128 a[200:203], v2 offset:14336
v_accvgpr_write_b32 a130, 0
v_mfma_f32_16x16x32_bf16 v[136:139], a[144:147], v[72:75], 0
ds_read_b128 a[204:207], v2 offset:15360
v_accvgpr_write_b32 a131, 0
v_mfma_f32_16x16x32_bf16 v[136:139], a[148:151], v[76:79], v[136:139]
buffer_load_dwordx4 v16, s[32:35], s70 offen offset:3072 sc1 lds
v_mfma_f32_16x16x32_bf16 v[136:139], a[152:155], v[80:83], v[136:139]
v_accvgpr_write_b32 a132, 0
v_accvgpr_write_b32 a133, 0
v_mfma_f32_16x16x32_bf16 v[136:139], a[156:159], v[84:87], v[136:139]
v_accvgpr_write_b32 a134, 0
v_accvgpr_write_b32 a135, 0
v_mfma_f32_16x16x32_bf16 v[88:91], a[156:159], v[36:39], v[88:91]
v_accvgpr_write_b32 a136, 0
v_accvgpr_write_b32 a137, 0
v_mfma_f32_16x16x32_bf16 v[88:91], a[152:155], v[32:35], v[88:91]
v_accvgpr_write_b32 a138, 0
v_accvgpr_write_b32 a139, 0
v_mfma_f32_16x16x32_bf16 v[88:91], a[148:151], v[28:31], v[88:91]
v_accvgpr_write_b32 a140, 0
v_accvgpr_write_b32 a141, 0
v_mfma_f32_16x16x32_bf16 v[88:91], a[144:147], v[24:27], v[88:91]
s_waitcnt lgkmcnt(0)
s_nop 1
v_max3_f32 v21, v104, v105, v106
v_max_f32 v21, v21, v107
v_max3_f32 v22, v120, v121, v122
v_max_f32 v22, v22, v123
v_max3_f32 v23, v136, v137, v138
v_max_f32 v23, v23, v139
v_max3_f32 v20, v88, v89, v90
v_max_f32 v20, v20, v91
v_mov_b32 v248, v20
v_mov_b32 v249, v21
v_mov_b32 v250, v22
v_mov_b32 v251, v23
v_permlane16_swap_b32 v248, v20
v_permlane16_swap_b32 v249, v21
v_permlane16_swap_b32 v250, v22
v_permlane16_swap_b32 v251, v23
v_max_f32 v20, v20, v248
v_max_f32 v21, v21, v249
v_max_f32 v22, v22, v250
v_max_f32 v23, v23, v251
v_mov_b32 v248, v20
v_mov_b32 v249, v21
v_mov_b32 v250, v22
v_mov_b32 v251, v23
v_permlane32_swap_b32 v248, v20
v_permlane32_swap_b32 v249, v21
v_permlane32_swap_b32 v250, v22
v_permlane32_swap_b32 v251, v23
v_max_f32 v20, v20, v248
v_max_f32 v21, v21, v249
v_max_f32 v22, v22, v250
v_max_f32 v23, v23, v251
s_cmp_eq_u32 s73, 0
s_cselect_b64 vcc, 0, -1
v_cndmask_b32 v20, v20, v252, vcc
v_cndmask_b32 v21, v21, v253, vcc
v_cndmask_b32 v22, v22, v254, vcc
v_cndmask_b32 v23, v23, v255, vcc
v_sub_f32 v228, 0, v23
v_sub_f32 v229, 0, v23
v_sub_f32 v230, 0, v23
v_sub_f32 v231, 0, v23
v_sub_f32 v224, 0, v22
v_sub_f32 v225, 0, v22
v_sub_f32 v226, 0, v22
v_sub_f32 v227, 0, v22
v_sub_f32 v220, 0, v21
v_sub_f32 v221, 0, v21
v_sub_f32 v222, 0, v21
v_sub_f32 v223, 0, v21
v_sub_f32 v216, 0, v20
v_sub_f32 v217, 0, v20
v_sub_f32 v218, 0, v20
v_sub_f32 v219, 0, v20
v_mfma_f32_16x16x32_bf16 v[140:143], a[160:163], v[72:75], v[228:231]
s_add_u32 m0, s71, 4096
v_add_f32 v104, v104, v220
v_add_f32 v105, v105, v220
v_mfma_f32_16x16x32_bf16 v[140:143], a[164:167], v[76:79], v[140:143]
v_add_f32 v106, v106, v220
v_add_f32 v107, v107, v220
v_exp_f32 v104, v104
v_mfma_f32_16x16x32_bf16 v[140:143], a[168:171], v[80:83], v[140:143]
s_add_u32 s64, s70, 4096
v_exp_f32 v105, v105
v_mfma_f32_16x16x32_bf16 v[140:143], a[172:175], v[84:87], v[140:143]
buffer_load_dwordx4 v16, s[32:35], s64 offen offset:0 sc1 lds
v_mfma_f32_16x16x32_bf16 v[124:127], a[172:175], v[68:71], v[224:227]
v_exp_f32 v106, v106
v_mfma_f32_16x16x32_bf16 v[124:127], a[168:171], v[64:67], v[124:127]
v_exp_f32 v107, v107
v_mfma_f32_16x16x32_bf16 v[124:127], a[164:167], v[60:63], v[124:127]
v_add_f32 v120, v120, v224
v_add_f32 v121, v121, v224
v_add_f32 v122, v122, v224
v_add_f32 v123, v123, v224
v_exp_f32 v120, v120
v_mfma_f32_16x16x32_bf16 v[124:127], a[160:163], v[56:59], v[124:127]
v_exp_f32 v121, v121
v_mfma_f32_16x16x32_bf16 v[108:111], a[160:163], v[40:43], v[220:223]
v_exp_f32 v122, v122
v_mfma_f32_16x16x32_bf16 v[108:111], a[164:167], v[44:47], v[108:111]
v_cndmask_b32 v92, v216, v17, s[10:11]
v_cndmask_b32 v93, v216, v17, s[12:13]
v_cndmask_b32 v94, v216, v17, s[18:19]
v_cndmask_b32 v95, v216, v17, s[22:23]
v_mfma_f32_16x16x32_bf16 v[108:111], a[168:171], v[48:51], v[108:111]
buffer_load_dwordx4 v16, s[32:35], s64 offen offset:1024 sc1 lds
v_cvt_pk_bf16_f32 v160, v104, v105
v_mfma_f32_16x16x32_bf16 v[108:111], a[172:175], v[52:55], v[108:111]
v_exp_f32 v123, v123
v_mfma_f32_16x16x32_bf16 v[92:95], a[172:175], v[36:39], v[92:95]
v_add_f32 v136, v136, v228
v_add_f32 v137, v137, v228
v_add_f32 v138, v138, v228
v_add_f32 v139, v139, v228
v_exp_f32 v136, v136
v_mfma_f32_16x16x32_bf16 v[92:95], a[168:171], v[32:35], v[92:95]
v_cvt_pk_bf16_f32 v161, v106, v107
v_exp_f32 v137, v137
v_cndmask_b32 v96, v216, v17, s[26:27]
v_cndmask_b32 v97, v216, v17, s[56:57]
v_cndmask_b32 v98, v216, v17, s[58:59]
v_cndmask_b32 v99, v216, v17, s[60:61]
v_mfma_f32_16x16x32_bf16 v[92:95], a[164:167], v[28:31], v[92:95]
v_exp_f32 v138, v138
v_mfma_f32_16x16x32_bf16 v[92:95], a[160:163], v[24:27], v[92:95]
v_exp_f32 v139, v139
v_mfma_f32_16x16x32_bf16 v[96:99], a[176:179], v[24:27], v[96:99]
v_cvt_pk_bf16_f32 v184, v120, v121
v_add_f32 v88, v88, v216
v_mfma_f32_16x16x32_bf16 v[96:99], a[180:183], v[28:31], v[96:99]
buffer_load_dwordx4 v16, s[32:35], s64 offen offset:2048 sc1 lds
v_add_f32 v89, v89, v216
v_add_f32 v90, v90, v216
v_add_f32 v91, v91, v216
v_exp_f32 v88, v88
v_mfma_f32_16x16x32_bf16 v[96:99], a[184:187], v[32:35], v[96:99]
v_exp_f32 v89, v89
v_mfma_f32_16x16x32_bf16 v[96:99], a[188:191], v[36:39], v[96:99]
v_cvt_pk_bf16_f32 v185, v122, v123
v_cvt_pk_bf16_f32 v192, v136, v137
v_mfma_f32_16x16x32_bf16 v[112:115], a[188:191], v[52:55], v[220:223]
v_exp_f32 v90, v90
v_mfma_f32_16x16x32_bf16 v[112:115], a[184:187], v[48:51], v[112:115]
v_exp_f32 v91, v91
v_mfma_f32_16x16x32_bf16 v[112:115], a[180:183], v[44:47], v[112:115]
v_exp_f32 v140, v140
v_mfma_f32_16x16x32_bf16 v[112:115], a[176:179], v[40:43], v[112:115]
v_exp_f32 v141, v141
v_mfma_f32_16x16x32_bf16 v[128:131], a[176:179], v[56:59], v[224:227]
buffer_load_dwordx4 v16, s[32:35], s64 offen offset:3072 sc1 lds
v_cvt_pk_bf16_f32 v193, v138, v139
v_mfma_f32_16x16x32_bf16 v[128:131], a[180:183], v[60:63], v[128:131]
v_exp_f32 v142, v142
v_mfma_f32_16x16x32_bf16 v[128:131], a[184:187], v[64:67], v[128:131]
v_exp_f32 v143, v143
v_mfma_f32_16x16x32_bf16 v[128:131], a[188:191], v[68:71], v[128:131]
v_cvt_pk_bf16_f32 v152, v88, v89
v_cvt_pk_bf16_f32 v153, v90, v91
v_mfma_f32_16x16x32_bf16 v[144:147], a[188:191], v[84:87], v[228:231]
v_exp_f32 v124, v124
v_mfma_f32_16x16x32_bf16 v[144:147], a[184:187], v[80:83], v[144:147]
v_exp_f32 v125, v125
v_mfma_f32_16x16x32_bf16 v[144:147], a[180:183], v[76:79], v[144:147]
s_waitcnt vmcnt(8)
s_barrier
v_mfma_f32_16x16x32_bf16 v[144:147], a[176:179], v[72:75], v[144:147]
v_exp_f32 v126, v126
v_mfma_f32_16x16x32_bf16 v[148:151], a[192:195], v[72:75], v[228:231]
v_cvt_pk_bf16_f32 v194, v140, v141
v_cvt_pk_bf16_f32 v195, v142, v143
v_mfma_f32_16x16x32_bf16 v[148:151], a[196:199], v[76:79], v[148:151]
v_exp_f32 v127, v127
v_mfma_f32_16x16x32_bf16 v[148:151], a[200:203], v[80:83], v[148:151]
s_xor_b32 s71, s71, 16384
v_exp_f32 v108, v108
v_mfma_f32_16x16x32_bf16 v[148:151], a[204:207], v[84:87], v[148:151]
s_add_u32 s70, s70, 32768
v_exp_f32 v109, v109
v_mfma_f32_16x16x32_bf16 v[132:135], a[204:207], v[68:71], v[224:227]
s_mov_b32 m0, s71
v_exp_f32 v110, v110
v_mfma_f32_16x16x32_bf16 v[132:135], a[200:203], v[64:67], v[132:135]
buffer_load_dwordx4 v16, s[32:35], s70 offen offset:0 sc1 lds
v_mfma_f32_16x16x32_bf16 v[132:135], a[196:199], v[60:63], v[132:135]
v_cvt_pk_bf16_f32 v186, v124, v125
v_exp_f32 v111, v111
v_mfma_f32_16x16x32_bf16 v[132:135], a[192:195], v[56:59], v[132:135]
v_exp_f32 v92, v92
v_mfma_f32_16x16x32_bf16 v[116:119], a[192:195], v[40:43], v[220:223]
ds_read_b128 a[144:147], v2 offset:16384
v_cndmask_b32 v100, v216, v17, s[62:63]
v_mfma_f32_16x16x32_bf16 v[116:119], a[196:199], v[44:47], v[116:119]
ds_read_b128 a[148:151], v2 offset:17408
v_cndmask_b32 v101, v216, v17, s[48:49]
v_cndmask_b32 v102, v216, v17, s[50:51]
v_cndmask_b32 v103, v216, v17, s[100:101]
v_cvt_pk_bf16_f32 v187, v126, v127
v_exp_f32 v93, v93
v_mfma_f32_16x16x32_bf16 v[116:119], a[200:203], v[48:51], v[116:119]
v_exp_f32 v94, v94
v_mfma_f32_16x16x32_bf16 v[116:119], a[204:207], v[52:55], v[116:119]
ds_read_b128 a[152:155], v2 offset:18432
v_cvt_pk_bf16_f32 v162, v108, v109
v_mfma_f32_16x16x32_bf16 v[100:103], a[204:207], v[36:39], v[100:103]
buffer_load_dwordx4 v16, s[32:35], s70 offen offset:1024 sc1 lds
v_exp_f32 v95, v95
v_mfma_f32_16x16x32_bf16 v[100:103], a[200:203], v[32:35], v[100:103]
ds_read_b128 a[156:159], v2 offset:19456
v_exp_f32 v96, v96
v_mfma_f32_16x16x32_bf16 v[100:103], a[196:199], v[28:31], v[100:103]
v_cvt_pk_bf16_f32 v163, v110, v111
v_exp_f32 v97, v97
v_mfma_f32_16x16x32_bf16 v[100:103], a[192:195], v[24:27], v[100:103]
s_waitcnt lgkmcnt(2)
ds_read_b128 a[160:163], v2 offset:20480
ds_read_b128 a[164:167], v2 offset:21504
ds_read_b128 a[168:171], v2 offset:22528
ds_read_b128 a[172:175], v2 offset:23552
v_mfma_f32_16x16x32_bf16 v[120:123], a[144:147], v[56:59], v[224:227]
v_exp_f32 v98, v98
v_mfma_f32_16x16x32_bf16 v[120:123], a[148:151], v[60:63], v[120:123]
s_waitcnt lgkmcnt(5)
v_cvt_pk_bf16_f32 v154, v92, v93
v_exp_f32 v99, v99
v_mfma_f32_16x16x32_bf16 v[120:123], a[152:155], v[64:67], v[120:123]
s_waitcnt lgkmcnt(4)
v_exp_f32 v112, v112
v_mfma_f32_16x16x32_bf16 v[120:123], a[156:159], v[68:71], v[120:123]
v_exp_f32 v113, v113
v_mfma_f32_16x16x32_bf16 v[136:139], a[156:159], v[84:87], v[228:231]
v_cvt_pk_bf16_f32 v155, v94, v95
v_cndmask_b32 v104, v220, v17, s[0:1]
v_mfma_f32_16x16x32_bf16 v[136:139], a[152:155], v[80:83], v[136:139]
ds_read_b128 a[176:179], v2 offset:24576
buffer_load_dwordx4 v16, s[32:35], s70 offen offset:2048 sc1 lds
v_cndmask_b32 v105, v220, v17, s[4:5]
v_cndmask_b32 v106, v220, v17, s[6:7]
v_cndmask_b32 v107, v220, v17, s[8:9]
v_exp_f32 v114, v114
v_mfma_f32_16x16x32_bf16 v[136:139], a[148:151], v[76:79], v[136:139]
v_cvt_pk_bf16_f32 v156, v96, v97
v_cvt_pk_bf16_f32 v157, v98, v99
v_mfma_f32_16x16x32_bf16 v[136:139], a[144:147], v[72:75], v[136:139]
v_exp_f32 v115, v115
v_mfma_f32_16x16x32_bf16 v[104:107], a[144:147], v[40:43], v[104:107]
v_exp_f32 v128, v128
v_mfma_f32_16x16x32_bf16 v[104:107], a[148:151], v[44:47], v[104:107]
v_exp_f32 v129, v129
v_mfma_f32_16x16x32_bf16 v[104:107], a[152:155], v[48:51], v[104:107]
v_exp_f32 v130, v130
v_mfma_f32_16x16x32_bf16 v[104:107], a[156:159], v[52:55], v[104:107]
s_waitcnt lgkmcnt(0)
v_exp_f32 v131, v131
v_mfma_f32_16x16x32_bf16 v[140:143], a[172:175], v[84:87], v[228:231]
v_cvt_pk_bf16_f32 v164, v112, v113
v_cvt_pk_bf16_f32 v165, v114, v115
v_mfma_f32_16x16x32_bf16 v[140:143], a[168:171], v[80:83], v[140:143]
v_exp_f32 v144, v144
v_mfma_f32_16x16x32_bf16 v[140:143], a[164:167], v[76:79], v[140:143]
v_exp_f32 v145, v145
v_mfma_f32_16x16x32_bf16 v[140:143], a[160:163], v[72:75], v[140:143]
v_exp_f32 v146, v146
v_mfma_f32_16x16x32_bf16 v[124:127], a[160:163], v[56:59], v[224:227]
ds_read_b128 a[180:183], v2 offset:25600
v_cndmask_b32 v108, v220, v17, s[10:11]
v_mfma_f32_16x16x32_bf16 v[124:127], a[164:167], v[60:63], v[124:127]
ds_read_b128 a[184:187], v2 offset:26624
buffer_load_dwordx4 v16, s[32:35], s70 offen offset:3072 sc1 lds
v_cndmask_b32 v109, v220, v17, s[12:13]
v_cndmask_b32 v110, v220, v17, s[18:19]
v_cndmask_b32 v111, v220, v17, s[22:23]
v_cvt_pk_bf16_f32 v188, v128, v129
v_mfma_f32_16x16x32_bf16 v[124:127], a[168:171], v[64:67], v[124:127]
s_add_u32 m0, s86, 131072
v_exp_f32 v147, v147
v_mfma_f32_16x16x32_bf16 v[124:127], a[172:175], v[68:71], v[124:127]
s_add_u32 s64, s85, 0
ds_read_b128 a[188:191], v2 offset:27648
v_exp_f32 v148, v148
v_mfma_f32_16x16x32_bf16 v[108:111], a[172:175], v[52:55], v[108:111]
buffer_load_dwordx4 v12, s[36:39], s64 offen lds
v_cvt_pk_bf16_f32 v189, v130, v131
v_exp_f32 v149, v149
v_mfma_f32_16x16x32_bf16 v[108:111], a[168:171], v[48:51], v[108:111]
s_add_u32 m0, s86, 132096
ds_read_b128 a[192:195], v2 offset:28672
v_cndmask_b32 v112, v220, v17, s[26:27]
v_cndmask_b32 v113, v220, v17, s[56:57]
v_cndmask_b32 v114, v220, v17, s[58:59]
v_cndmask_b32 v115, v220, v17, s[60:61]
v_mfma_f32_16x16x32_bf16 v[108:111], a[164:167], v[44:47], v[108:111]
s_add_u32 s64, s85, 8192
v_exp_f32 v150, v150
v_mfma_f32_16x16x32_bf16 v[108:111], a[160:163], v[40:43], v[108:111]
buffer_load_dwordx4 v13, s[36:39], s64 offen lds
v_cvt_pk_bf16_f32 v196, v144, v145
v_exp_f32 v151, v151
v_mfma_f32_16x16x32_bf16 v[112:115], a[176:179], v[40:43], v[112:115]
s_waitcnt lgkmcnt(2)
s_add_u32 m0, s86, 133120
v_exp_f32 v132, v132
v_mfma_f32_16x16x32_bf16 v[112:115], a[180:183], v[44:47], v[112:115]
s_add_u32 s64, s85, 16384
v_exp_f32 v133, v133
v_mfma_f32_16x16x32_bf16 v[112:115], a[184:187], v[48:51], v[112:115]
s_waitcnt lgkmcnt(1)
buffer_load_dwordx4 v12, s[36:39], s64 offen lds
v_cvt_pk_bf16_f32 v197, v146, v147
v_mfma_f32_16x16x32_bf16 v[112:115], a[188:191], v[52:55], v[112:115]
s_add_u32 m0, s86, 134144
v_exp_f32 v134, v134
v_mfma_f32_16x16x32_bf16 v[128:131], a[188:191], v[68:71], v[224:227]
s_add_u32 s64, s85, 24576
ds_read_b128 a[196:199], v2 offset:29696
ds_read_b128 a[200:203], v2 offset:30720
ds_read_b128 a[204:207], v2 offset:31744
v_cvt_pk_bf16_f32 v198, v148, v149
v_mfma_f32_16x16x32_bf16 v[128:131], a[184:187], v[64:67], v[128:131]
buffer_load_dwordx4 v13, s[36:39], s64 offen lds
v_exp_f32 v135, v135
v_mfma_f32_16x16x32_bf16 v[128:131], a[180:183], v[60:63], v[128:131]
s_add_u32 m0, s71, 4096
v_exp_f32 v116, v116
v_mfma_f32_16x16x32_bf16 v[128:131], a[176:179], v[56:59], v[128:131]
s_add_u32 s64, s70, 4096
v_cvt_pk_bf16_f32 v199, v150, v151
v_exp_f32 v117, v117
v_mfma_f32_16x16x32_bf16 v[144:147], a[176:179], v[72:75], v[228:231]
buffer_load_dwordx4 v16, s[32:35], s64 offen offset:0 sc1 lds
v_mfma_f32_16x16x32_bf16 v[144:147], a[180:183], v[76:79], v[144:147]
v_exp_f32 v118, v118
v_mfma_f32_16x16x32_bf16 v[144:147], a[184:187], v[80:83], v[144:147]
v_cvt_pk_bf16_f32 v190, v132, v133
v_exp_f32 v119, v119
v_mfma_f32_16x16x32_bf16 v[144:147], a[188:191], v[84:87], v[144:147]
s_waitcnt lgkmcnt(0)
v_exp_f32 v100, v100
v_mfma_f32_16x16x32_bf16 v[148:151], a[204:207], v[84:87], v[228:231]
v_exp_f32 v101, v101
v_mfma_f32_16x16x32_bf16 v[148:151], a[200:203], v[80:83], v[148:151]
v_cvt_pk_bf16_f32 v191, v134, v135
v_cvt_pk_bf16_f32 v166, v116, v117
v_cvt_pk_bf16_f32 v167, v118, v119
v_mfma_f32_16x16x32_bf16 v[148:151], a[196:199], v[76:79], v[148:151]
v_exp_f32 v102, v102
v_mfma_f32_16x16x32_bf16 v[148:151], a[192:195], v[72:75], v[148:151]
v_exp_f32 v103, v103
v_mfma_f32_16x16x32_bf16 v[132:135], a[192:195], v[56:59], v[224:227]
s_lshl_b32 s66, s30, 30
ds_read_b128 a[144:147], v3 offset:16384
v_cndmask_b32 v116, v220, v17, s[62:63]
v_mfma_f32_16x16x32_bf16 v[132:135], a[196:199], v[60:63], v[132:135]
ds_read_b128 a[148:151], v3 offset:24576
v_cndmask_b32 v117, v220, v17, s[48:49]
v_cndmask_b32 v118, v220, v17, s[50:51]
v_cndmask_b32 v119, v220, v17, s[100:101]
v_exp_f32 v120, v120
v_mfma_f32_16x16x32_bf16 v[132:135], a[200:203], v[64:67], v[132:135]
v_exp_f32 v121, v121
v_mfma_f32_16x16x32_bf16 v[132:135], a[204:207], v[68:71], v[132:135]
v_exp_f32 v122, v122
v_mfma_f32_16x16x32_bf16 v[116:119], a[204:207], v[52:55], v[116:119]
ds_read_b128 a[152:155], v3 offset:17408
v_accvgpr_write_b32 a142, 0
v_mfma_f32_16x16x32_bf16 v[116:119], a[200:203], v[48:51], v[116:119]
ds_read_b128 a[156:159], v3 offset:25600
buffer_load_dwordx4 v16, s[32:35], s64 offen offset:1024 sc1 lds
v_accvgpr_write_b32 a143, 0
v_cvt_pk_bf16_f32 v158, v100, v101
v_cvt_pk_bf16_f32 v159, v102, v103
v_mfma_f32_16x16x32_bf16 v[116:119], a[196:199], v[44:47], v[116:119]
v_exp_f32 v123, v123
v_mfma_f32_16x16x32_bf16 v[116:119], a[192:195], v[40:43], v[116:119]
v_exp_f32 v136, v136
v_smfmac_f32_16x16x64_bf16 a[128:131], a[240:243], v[152:159], v5
ds_read_b128 a[160:163], v3 offset:18432
v_smfmac_f32_16x16x64_bf16 a[132:135], a[240:243], v[160:167], v5
v_exp_f32 v137, v137
v_smfmac_f32_16x16x64_bf16 a[136:139], a[240:243], v[184:191], v5
v_exp_f32 v138, v138
v_smfmac_f32_16x16x64_bf16 a[140:143], a[240:243], v[192:199], v5
s_waitcnt lgkmcnt(1)
v_cvt_pk_bf16_f32 v200, v120, v121
v_mfma_f32_16x16x32_bf16 a[0:3], a[144:147], v[152:155], 0
v_exp_f32 v139, v139
v_mfma_f32_16x16x32_bf16 a[0:3], a[148:151], v[156:159], a[0:3]
v_exp_f32 v104, v104
v_mfma_f32_16x16x32_bf16 a[32:35], a[148:151], v[164:167], 0
v_cvt_pk_bf16_f32 v201, v122, v123
v_cvt_pk_bf16_f32 v208, v136, v137
v_mfma_f32_16x16x32_bf16 a[32:35], a[144:147], v[160:163], a[32:35]
v_exp_f32 v105, v105
v_mfma_f32_16x16x32_bf16 a[64:67], a[144:147], v[184:187], 0
v_exp_f32 v106, v106
v_mfma_f32_16x16x32_bf16 a[64:67], a[148:151], v[188:191], a[64:67]
v_exp_f32 v107, v107
v_mfma_f32_16x16x32_bf16 a[96:99], a[148:151], v[196:199], 0
buffer_load_dwordx4 v16, s[32:35], s64 offen offset:2048 sc1 lds
v_mfma_f32_16x16x32_bf16 a[96:99], a[144:147], v[192:195], a[96:99]
v_exp_f32 v140, v140
v_mfma_f32_16x16x32_bf16 a[100:103], a[152:155], v[192:195], 0
ds_read_b128 a[164:167], v3 offset:26624
v_cvt_pk_bf16_f32 v209, v138, v139
v_mfma_f32_16x16x32_bf16 a[100:103], a[156:159], v[196:199], a[100:103]
v_exp_f32 v141, v141
v_mfma_f32_16x16x32_bf16 a[68:71], a[156:159], v[188:191], 0
v_exp_f32 v142, v142
v_mfma_f32_16x16x32_bf16 a[68:71], a[152:155], v[184:187], a[68:71]
v_cvt_pk_bf16_f32 v176, v104, v105
v_cvt_pk_bf16_f32 v177, v106, v107
v_mfma_f32_16x16x32_bf16 a[36:39], a[152:155], v[160:163], 0
v_exp_f32 v143, v143
v_mfma_f32_16x16x32_bf16 a[36:39], a[156:159], v[164:167], a[36:39]
v_exp_f32 v124, v124
v_mfma_f32_16x16x32_bf16 a[4:7], a[156:159], v[156:159], 0
v_exp_f32 v125, v125
v_mfma_f32_16x16x32_bf16 a[4:7], a[152:155], v[152:155], a[4:7]
s_waitcnt lgkmcnt(0)
ds_read_b128 a[168:171], v3 offset:19456
v_cvt_pk_bf16_f32 v210, v140, v141
v_mfma_f32_16x16x32_bf16 a[8:11], a[160:163], v[152:155], 0
v_exp_f32 v126, v126
v_mfma_f32_16x16x32_bf16 a[8:11], a[164:167], v[156:159], a[8:11]
ds_read_b128 a[172:175], v3 offset:27648
v_cvt_pk_bf16_f32 v211, v142, v143
v_mfma_f32_16x16x32_bf16 a[40:43], a[164:167], v[164:167], 0
v_exp_f32 v127, v127
v_mfma_f32_16x16x32_bf16 a[40:43], a[160:163], v[160:163], a[40:43]
v_exp_f32 v108, v108
v_mfma_f32_16x16x32_bf16 a[72:75], a[160:163], v[184:187], 0
buffer_load_dwordx4 v16, s[32:35], s64 offen offset:3072 sc1 lds
v_mfma_f32_16x16x32_bf16 a[72:75], a[164:167], v[188:191], a[72:75]
v_exp_f32 v109, v109
v_mfma_f32_16x16x32_bf16 a[104:107], a[164:167], v[196:199], 0
v_exp_f32 v110, v110
v_mfma_f32_16x16x32_bf16 a[104:107], a[160:163], v[192:195], a[104:107]
s_waitcnt lgkmcnt(0)
ds_read_b128 a[176:179], v3 offset:20480
v_cvt_pk_bf16_f32 v202, v124, v125
v_mfma_f32_16x16x32_bf16 a[108:111], a[168:171], v[192:195], 0
v_exp_f32 v111, v111
v_mfma_f32_16x16x32_bf16 a[108:111], a[172:175], v[196:199], a[108:111]
ds_read_b128 a[180:183], v3 offset:28672
v_cvt_pk_bf16_f32 v203, v126, v127
v_mfma_f32_16x16x32_bf16 a[76:79], a[172:175], v[188:191], 0
s_add_u32 m0, s86, 135168
v_exp_f32 v112, v112
v_mfma_f32_16x16x32_bf16 a[76:79], a[168:171], v[184:187], a[76:79]
s_add_u32 s64, s85, 32768
v_exp_f32 v113, v113
v_mfma_f32_16x16x32_bf16 a[44:47], a[168:171], v[160:163], 0
buffer_load_dwordx4 v12, s[36:39], s64 offen lds
v_mfma_f32_16x16x32_bf16 a[44:47], a[172:175], v[164:167], a[44:47]
s_add_u32 m0, s86, 136192
v_cvt_pk_bf16_f32 v178, v108, v109
v_exp_f32 v114, v114
v_mfma_f32_16x16x32_bf16 a[12:15], a[172:175], v[156:159], 0
s_add_u32 s64, s85, 40960
v_exp_f32 v115, v115
v_mfma_f32_16x16x32_bf16 a[12:15], a[168:171], v[152:155], a[12:15]
s_waitcnt lgkmcnt(0)
buffer_load_dwordx4 v13, s[36:39], s64 offen lds
v_mfma_f32_16x16x32_bf16 a[16:19], a[176:179], v[152:155], 0
s_add_u32 m0, s86, 137216
ds_read_b128 a[184:187], v3 offset:21504
ds_read_b128 a[188:191], v3 offset:29696
ds_read_b128 a[192:195], v3 offset:22528
ds_read_b128 a[196:199], v3 offset:30720
ds_read_b128 a[200:203], v3 offset:23552
ds_read_b128 a[204:207], v3 offset:31744
v_xor_b32 v2, 0x8000, v2
v_exp_f32 v128, v128
v_mfma_f32_16x16x32_bf16 a[16:19], a[180:183], v[156:159], a[16:19]
s_waitcnt vmcnt(14)
s_barrier
s_add_u32 s64, s85, 49152
v_cvt_pk_bf16_f32 v179, v110, v111
v_mfma_f32_16x16x32_bf16 a[48:51], a[180:183], v[164:167], 0
buffer_load_dwordx4 v12, s[36:39], s64 offen lds
v_exp_f32 v129, v129
v_mfma_f32_16x16x32_bf16 a[48:51], a[176:179], v[160:163], a[48:51]
s_add_u32 m0, s86, 138240
v_exp_f32 v130, v130
v_mfma_f32_16x16x32_bf16 a[80:83], a[176:179], v[184:187], 0
s_add_u32 s64, s85, 57344
v_cvt_pk_bf16_f32 v180, v112, v113
v_cvt_pk_bf16_f32 v181, v114, v115
v_mfma_f32_16x16x32_bf16 a[80:83], a[180:183], v[188:191], a[80:83]
buffer_load_dwordx4 v13, s[36:39], s64 offen lds
v_exp_f32 v131, v131
v_mfma_f32_16x16x32_bf16 a[112:115], a[180:183], v[196:199], 0
v_exp_f32 v144, v144
v_mfma_f32_16x16x32_bf16 a[112:115], a[176:179], v[192:195], a[112:115]
s_waitcnt lgkmcnt(0)
s_xor_b32 s71, s71, 49152
s_add_u32 s70, s70, 32768
s_mov_b32 m0, s71
v_exp_f32 v145, v145
v_mfma_f32_16x16x32_bf16 a[116:119], a[184:187], v[192:195], 0
buffer_load_dwordx4 v16, s[32:35], s70 offen offset:0 sc1 lds
v_mfma_f32_16x16x32_bf16 a[116:119], a[188:191], v[196:199], a[116:119]
v_exp_f32 v146, v146
v_mfma_f32_16x16x32_bf16 a[84:87], a[188:191], v[188:191], 0
v_cvt_pk_bf16_f32 v204, v128, v129
v_cvt_pk_bf16_f32 v205, v130, v131
v_mfma_f32_16x16x32_bf16 a[84:87], a[184:187], v[184:187], a[84:87]
v_exp_f32 v147, v147
v_mfma_f32_16x16x32_bf16 a[52:55], a[184:187], v[160:163], 0
v_exp_f32 v148, v148
v_mfma_f32_16x16x32_bf16 a[52:55], a[188:191], v[164:167], a[52:55]
v_exp_f32 v149, v149
v_mfma_f32_16x16x32_bf16 a[20:23], a[188:191], v[156:159], 0
ds_read_b128 a[144:147], v2 offset:0
v_lshl_add_u32 v19, v0, 24, s66
v_mfma_f32_16x16x32_bf16 a[20:23], a[184:187], v[152:155], a[20:23]
s_lshr_b32 s67, s31, 4
v_exp_f32 v150, v150
v_mfma_f32_16x16x32_bf16 a[24:27], a[192:195], v[152:155], 0
s_lshl1_add_u32 s67, s3, s67
v_cvt_pk_bf16_f32 v212, v144, v145
v_cvt_pk_bf16_f32 v213, v146, v147
v_mfma_f32_16x16x32_bf16 a[24:27], a[196:199], v[156:159], a[24:27]
s_lshl_b32 s79, s67, 8
v_exp_f32 v151, v151
v_mfma_f32_16x16x32_bf16 a[56:59], a[196:199], v[164:167], 0
s_add_u32 s79, s79, 8192
v_exp_f32 v132, v132
v_mfma_f32_16x16x32_bf16 a[56:59], a[192:195], v[160:163], a[56:59]
s_add_u32 s69, s31, 12
v_exp_f32 v133, v133
v_mfma_f32_16x16x32_bf16 a[88:91], a[192:195], v[184:187], 0
s_lshr_b32 s69, s69, 5
buffer_load_dwordx4 v16, s[32:35], s70 offen offset:1024 sc1 lds
v_mfma_f32_16x16x32_bf16 a[88:91], a[196:199], v[188:191], a[88:91]
s_lshl1_add_u32 s69, s3, s69
v_exp_f32 v134, v134
v_mfma_f32_16x16x32_bf16 a[120:123], a[196:199], v[196:199], 0
s_lshl_b32 s69, s69, 8
v_cvt_pk_bf16_f32 v214, v148, v149
v_cvt_pk_bf16_f32 v215, v150, v151
v_mfma_f32_16x16x32_bf16 a[120:123], a[192:195], v[192:195], a[120:123]
s_add_u32 s69, s69, 8192
v_exp_f32 v135, v135
v_mfma_f32_16x16x32_bf16 a[124:127], a[200:203], v[192:195], 0
s_lshl_b32 s67, s73, 16
v_exp_f32 v116, v116
v_mfma_f32_16x16x32_bf16 a[124:127], a[204:207], v[196:199], a[124:127]
s_xor_b32 s68, s80, 256
v_exp_f32 v117, v117
v_mfma_f32_16x16x32_bf16 a[92:95], a[204:207], v[188:191], 0
s_add_u32 s68, s68, s67
ds_read_b128 a[148:151], v2 offset:1024
v_cvt_pk_bf16_f32 v206, v132, v133
v_mfma_f32_16x16x32_bf16 a[92:95], a[200:203], v[184:187], a[92:95]
s_add_u32 s67, s67, s69
v_exp_f32 v118, v118
v_mfma_f32_16x16x32_bf16 a[60:63], a[200:203], v[160:163], 0
ds_read_b128 a[152:155], v2 offset:2048
v_cvt_pk_bf16_f32 v207, v134, v135
v_mfma_f32_16x16x32_bf16 a[60:63], a[204:207], v[164:167], a[60:63]
ds_read_b128 a[156:159], v2 offset:3072
v_cvt_pk_bf16_f32 v182, v116, v117
v_mfma_f32_16x16x32_bf16 a[28:31], a[204:207], v[156:159], 0
s_mov_b64 exec, 1
buffer_atomic_add a251, v19, s[52:55], s67 offen offset:0 sc1
buffer_atomic_add a251, v19, s[52:55], s68 offen offset:0 sc1
s_mov_b64 exec, -1
v_exp_f32 v119, v119
v_mfma_f32_16x16x32_bf16 a[28:31], a[200:203], v[152:155], a[28:31]
ds_read_b128 a[160:163], v2 offset:4096
ds_read_b128 a[164:167], v2 offset:5120
ds_read_b128 a[168:171], v2 offset:6144
ds_read_b128 a[172:175], v2 offset:7168
v_mul_u32_u24 v19, 52, v0
v_cvt_pk_bf16_f32 v183, v118, v119
v_xor_b32 v3, 0x8000, v3
v_accvgpr_read_b32 v20, a128
v_accvgpr_read_b32 v248, a129
v_add_f32 v20, v20, v248
v_max_f32 v1, v1, v20
v_rcp_f32 v20, v20
v_accvgpr_read_b32 v232, a0
v_accvgpr_read_b32 v233, a1
v_accvgpr_read_b32 v234, a2
v_accvgpr_read_b32 v235, a3
v_accvgpr_read_b32 v236, a4
v_accvgpr_read_b32 v237, a5
v_accvgpr_read_b32 v238, a6
v_accvgpr_read_b32 v239, a7
v_mul_f32 v20, v20, v4
v_mul_f32 v232, v232, v20
v_mul_f32 v233, v233, v20
v_mul_f32 v234, v234, v20
v_mul_f32 v235, v235, v20
v_mul_f32 v236, v236, v20
v_mul_f32 v237, v237, v20
v_mul_f32 v238, v238, v20
v_mul_f32 v239, v239, v20
v_cvt_pk_bf16_f32 v232, v232, v233
v_cvt_pk_bf16_f32 v233, v234, v235
v_cvt_pk_bf16_f32 v234, v236, v237
v_cvt_pk_bf16_f32 v235, v238, v239
s_add_u32 s77, s74, 0
buffer_store_dwordx4 v[232:235], v16, s[44:47], s77 offen sc1
v_accvgpr_read_b32 v240, a8
v_accvgpr_read_b32 v241, a9
v_accvgpr_read_b32 v242, a10
v_accvgpr_read_b32 v243, a11
v_accvgpr_read_b32 v244, a12
v_accvgpr_read_b32 v245, a13
v_accvgpr_read_b32 v246, a14
v_accvgpr_read_b32 v247, a15
v_mul_f32 v240, v240, v20
v_mul_f32 v241, v241, v20
v_mul_f32 v242, v242, v20
v_mul_f32 v243, v243, v20
v_mul_f32 v244, v244, v20
v_mul_f32 v245, v245, v20
v_mul_f32 v246, v246, v20
v_mul_f32 v247, v247, v20
v_cvt_pk_bf16_f32 v240, v240, v241
v_cvt_pk_bf16_f32 v241, v242, v243
v_cvt_pk_bf16_f32 v242, v244, v245
v_cvt_pk_bf16_f32 v243, v246, v247
s_add_u32 s77, s74, 8192
buffer_store_dwordx4 v[240:243], v16, s[44:47], s77 offen sc1
v_accvgpr_read_b32 v232, a16
v_accvgpr_read_b32 v233, a17
v_accvgpr_read_b32 v234, a18
v_accvgpr_read_b32 v235, a19
v_accvgpr_read_b32 v236, a20
v_accvgpr_read_b32 v237, a21
v_accvgpr_read_b32 v238, a22
v_accvgpr_read_b32 v239, a23
v_mul_f32 v232, v232, v20
v_mul_f32 v233, v233, v20
v_mul_f32 v234, v234, v20
v_mul_f32 v235, v235, v20
v_mul_f32 v236, v236, v20
v_mul_f32 v237, v237, v20
v_mul_f32 v238, v238, v20
v_mul_f32 v239, v239, v20
v_cvt_pk_bf16_f32 v232, v232, v233
v_cvt_pk_bf16_f32 v233, v234, v235
v_cvt_pk_bf16_f32 v234, v236, v237
v_cvt_pk_bf16_f32 v235, v238, v239
s_add_u32 s77, s74, 16384
buffer_store_dwordx4 v[232:235], v16, s[44:47], s77 offen sc1
s_branch L_T
L_T1:
buffer_load_dword v19, off, s[52:55], s80 sc1
s_waitcnt lgkmcnt(7)
v_mfma_f32_16x16x32_bf16 v[136:139], a[144:147], v[72:75], v[228:231]
s_waitcnt lgkmcnt(6)
ds_read_b128 a[176:179], v2 offset:8192
v_cndmask_b32 v120, v224, v17, s[0:1]
v_mfma_f32_16x16x32_bf16 v[136:139], a[148:151], v[76:79], v[136:139]
s_waitcnt lgkmcnt(6)
ds_read_b128 a[180:183], v2 offset:9216
v_cndmask_b32 v121, v224, v17, s[4:5]
v_cndmask_b32 v122, v224, v17, s[6:7]
v_cndmask_b32 v123, v224, v17, s[8:9]
v_mfma_f32_16x16x32_bf16 v[136:139], a[152:155], v[80:83], v[136:139]
s_waitcnt lgkmcnt(6)
buffer_load_dwordx4 v16, s[32:35], s70 offen offset:2048 sc1 lds
v_mfma_f32_16x16x32_bf16 v[136:139], a[156:159], v[84:87], v[136:139]
ds_read_b128 a[184:187], v2 offset:10240
v_cndmask_b32 v124, v224, v17, s[10:11]
v_mfma_f32_16x16x32_bf16 v[120:123], a[156:159], v[68:71], v[120:123]
ds_read_b128 a[188:191], v2 offset:11264
v_cndmask_b32 v125, v224, v17, s[12:13]
v_mfma_f32_16x16x32_bf16 v[120:123], a[152:155], v[64:67], v[120:123]
ds_read_b128 a[192:195], v2 offset:12288
v_cndmask_b32 v126, v224, v17, s[18:19]
v_mfma_f32_16x16x32_bf16 v[120:123], a[148:151], v[60:63], v[120:123]
ds_read_b128 a[196:199], v2 offset:13312
v_cndmask_b32 v127, v224, v17, s[22:23]
v_mfma_f32_16x16x32_bf16 v[120:123], a[144:147], v[56:59], v[120:123]
s_waitcnt lgkmcnt(4)
ds_read_b128 a[200:203], v2 offset:14336
v_cndmask_b32 v128, v224, v17, s[26:27]
v_mfma_f32_16x16x32_bf16 v[140:143], a[160:163], v[72:75], v[228:231]
ds_read_b128 a[204:207], v2 offset:15360
v_cndmask_b32 v129, v224, v17, s[56:57]
v_mfma_f32_16x16x32_bf16 v[140:143], a[164:167], v[76:79], v[140:143]
ds_read_b128 a[144:147], v3 offset:0
v_cndmask_b32 v130, v224, v17, s[58:59]
v_mfma_f32_16x16x32_bf16 v[140:143], a[168:171], v[80:83], v[140:143]
v_exp_f32 v136, v136
v_mfma_f32_16x16x32_bf16 v[140:143], a[172:175], v[84:87], v[140:143]
v_exp_f32 v137, v137
v_mfma_f32_16x16x32_bf16 v[124:127], a[172:175], v[68:71], v[124:127]
ds_read_b128 a[148:151], v3 offset:8192
v_cndmask_b32 v131, v224, v17, s[60:61]
v_mfma_f32_16x16x32_bf16 v[124:127], a[168:171], v[64:67], v[124:127]
v_exp_f32 v138, v138
v_mfma_f32_16x16x32_bf16 v[124:127], a[164:167], v[60:63], v[124:127]
s_mul_i32 s69, s83, 8
buffer_load_dwordx4 v16, s[32:35], s70 offen offset:3072 sc1 lds
v_mfma_f32_16x16x32_bf16 v[124:127], a[160:163], v[56:59], v[124:127]
s_sub_u32 s69, 36, s69
v_exp_f32 v139, v139
v_mfma_f32_16x16x32_bf16 v[128:131], a[176:179], v[56:59], v[128:131]
v_exp_f32 v120, v120
v_mfma_f32_16x16x32_bf16 v[128:131], a[180:183], v[60:63], v[128:131]
s_waitcnt lgkmcnt(1)
v_exp_f32 v121, v121
v_mfma_f32_16x16x32_bf16 v[128:131], a[184:187], v[64:67], v[128:131]
v_exp_f32 v122, v122
v_mfma_f32_16x16x32_bf16 v[128:131], a[188:191], v[68:71], v[128:131]
s_add_u32 m0, s71, 4096
ds_read_b128 a[152:155], v3 offset:1024
v_cndmask_b32 v132, v224, v17, s[62:63]
v_mfma_f32_16x16x32_bf16 v[144:147], a[188:191], v[84:87], v[228:231]
s_add_u32 s64, s70, 4096
v_cvt_pk_bf16_f32 v192, v136, v137
v_cndmask_b32 v133, v224, v17, s[48:49]
v_mfma_f32_16x16x32_bf16 v[144:147], a[184:187], v[80:83], v[144:147]
buffer_load_dwordx4 v16, s[32:35], s64 offen offset:0 sc1 lds
v_mfma_f32_16x16x32_bf16 v[144:147], a[180:183], v[76:79], v[144:147]
ds_read_b128 a[156:159], v3 offset:9216
v_cndmask_b32 v134, v224, v17, s[50:51]
v_mfma_f32_16x16x32_bf16 v[144:147], a[176:179], v[72:75], v[144:147]
ds_read_b128 a[160:163], v3 offset:2048
v_cndmask_b32 v135, v224, v17, s[100:101]
v_mfma_f32_16x16x32_bf16 v[148:151], a[192:195], v[72:75], v[228:231]
v_exp_f32 v123, v123
v_mfma_f32_16x16x32_bf16 v[148:151], a[196:199], v[76:79], v[148:151]
v_cvt_pk_bf16_f32 v193, v138, v139
v_cvt_pk_bf16_f32 v184, v120, v121
v_mfma_f32_16x16x32_bf16 v[148:151], a[200:203], v[80:83], v[148:151]
v_exp_f32 v140, v140
v_mfma_f32_16x16x32_bf16 v[148:151], a[204:207], v[84:87], v[148:151]
v_exp_f32 v141, v141
v_mfma_f32_16x16x32_bf16 v[132:135], a[204:207], v[68:71], v[132:135]
v_exp_f32 v142, v142
v_mfma_f32_16x16x32_bf16 v[132:135], a[200:203], v[64:67], v[132:135]
v_exp_f32 v143, v143
v_mfma_f32_16x16x32_bf16 v[132:135], a[196:199], v[60:63], v[132:135]
buffer_load_dwordx4 v16, s[32:35], s64 offen offset:1024 sc1 lds
v_mfma_f32_16x16x32_bf16 v[132:135], a[192:195], v[56:59], v[132:135]
v_exp_f32 v124, v124
v_smfmac_f32_16x16x64_bf16 a[132:135], a[240:243], v[176:183], v5
ds_read_b128 a[164:167], v3 offset:10240
v_smfmac_f32_16x16x64_bf16 a[136:139], a[240:243], v[200:207], v5
ds_read_b128 a[168:171], v3 offset:3072
v_accvgpr_read_b32 v240, a24
v_smfmac_f32_16x16x64_bf16 a[140:143], a[240:243], v[208:215], v5
v_cvt_pk_bf16_f32 v185, v122, v123
v_mfma_f32_16x16x32_bf16 a[32:35], a[144:147], v[176:179], a[32:35]
s_waitcnt lgkmcnt(2)
v_exp_f32 v125, v125
v_mfma_f32_16x16x32_bf16 a[32:35], a[148:151], v[180:183], a[32:35]
ds_read_b128 a[172:175], v3 offset:11264
v_accvgpr_read_b32 v241, a25
v_mfma_f32_16x16x32_bf16 a[64:67], a[148:151], v[204:207], a[64:67]
ds_read_b128 a[176:179], v3 offset:4096
v_accvgpr_read_b32 v242, a26
v_mfma_f32_16x16x32_bf16 a[64:67], a[144:147], v[200:203], a[64:67]
v_cvt_pk_bf16_f32 v194, v140, v141
v_accvgpr_read_b32 v243, a27
v_mfma_f32_16x16x32_bf16 a[96:99], a[144:147], v[208:211], a[96:99]
ds_read_b128 a[180:183], v3 offset:12288
v_accvgpr_read_b32 v244, a28
v_mfma_f32_16x16x32_bf16 a[96:99], a[148:151], v[212:215], a[96:99]
ds_read_b128 a[184:187], v3 offset:5120
v_accvgpr_read_b32 v245, a29
v_mfma_f32_16x16x32_bf16 a[100:103], a[156:159], v[212:215], a[100:103]
ds_read_b128 a[188:191], v3 offset:13312
v_accvgpr_read_b32 v246, a30
v_mfma_f32_16x16x32_bf16 a[100:103], a[152:155], v[208:211], a[100:103]
ds_read_b128 a[192:195], v3 offset:6144
v_accvgpr_read_b32 v247, a31
v_mul_f32 v240, v240, v20
v_mul_f32 v241, v241, v20
v_mul_f32 v242, v242, v20
v_mul_f32 v243, v243, v20
v_mul_f32 v244, v244, v20
v_mul_f32 v245, v245, v20
v_mul_f32 v246, v246, v20
v_mul_f32 v247, v247, v20
v_cvt_pk_bf16_f32 v240, v240, v241
v_cvt_pk_bf16_f32 v241, v242, v243
v_cvt_pk_bf16_f32 v242, v244, v245
v_cvt_pk_bf16_f32 v243, v246, v247
s_add_u32 s77, s74, 24576
buffer_store_dwordx4 v[240:243], v16, s[44:47], s77 offen sc1
v_exp_f32 v126, v126
v_mfma_f32_16x16x32_bf16 a[68:71], a[152:155], v[200:203], a[68:71]
buffer_load_dwordx4 v16, s[32:35], s64 offen offset:2048 sc1 lds
v_cvt_pk_bf16_f32 v195, v142, v143
v_mfma_f32_16x16x32_bf16 a[68:71], a[156:159], v[204:207], a[68:71]
v_exp_f32 v127, v127
v_mfma_f32_16x16x32_bf16 a[36:39], a[156:159], v[180:183], a[36:39]
v_exp_f32 v128, v128
v_mfma_f32_16x16x32_bf16 a[36:39], a[152:155], v[176:179], a[36:39]
v_exp_f32 v129, v129
v_mfma_f32_16x16x32_bf16 a[40:43], a[160:163], v[176:179], a[40:43]
s_waitcnt lgkmcnt(1)
v_cvt_pk_bf16_f32 v186, v124, v125
v_cvt_pk_bf16_f32 v187, v126, v127
v_mfma_f32_16x16x32_bf16 a[40:43], a[164:167], v[180:183], a[40:43]
v_exp_f32 v130, v130
v_mfma_f32_16x16x32_bf16 a[72:75], a[164:167], v[204:207], a[72:75]
buffer_load_dwordx4 v16, s[32:35], s64 offen offset:3072 sc1 lds
v_mfma_f32_16x16x32_bf16 a[72:75], a[160:163], v[200:203], a[72:75]
v_exp_f32 v131, v131
v_mfma_f32_16x16x32_bf16 a[104:107], a[160:163], v[208:211], a[104:107]
v_exp_f32 v144, v144
v_mfma_f32_16x16x32_bf16 a[104:107], a[164:167], v[212:215], a[104:107]
v_exp_f32 v145, v145
v_mfma_f32_16x16x32_bf16 a[108:111], a[172:175], v[212:215], a[108:111]
v_exp_f32 v146, v146
v_mfma_f32_16x16x32_bf16 a[108:111], a[168:171], v[208:211], a[108:111]
ds_read_b128 a[196:199], v3 offset:14336
v_cvt_pk_bf16_f32 v188, v128, v129
v_mfma_f32_16x16x32_bf16 a[76:79], a[168:171], v[200:203], a[76:79]
ds_read_b128 a[200:203], v3 offset:7168
v_cvt_pk_bf16_f32 v189, v130, v131
v_mfma_f32_16x16x32_bf16 a[76:79], a[172:175], v[204:207], a[76:79]
ds_read_b128 a[204:207], v3 offset:15360
v_cvt_pk_bf16_f32 v196, v144, v145
v_mfma_f32_16x16x32_bf16 a[44:47], a[172:175], v[180:183], a[44:47]
v_exp_f32 v147, v147
v_mfma_f32_16x16x32_bf16 a[44:47], a[168:171], v[176:179], a[44:47]
v_exp_f32 v148, v148
v_mfma_f32_16x16x32_bf16 a[48:51], a[176:179], v[176:179], a[48:51]
v_exp_f32 v149, v149
v_mfma_f32_16x16x32_bf16 a[48:51], a[180:183], v[180:183], a[48:51]
v_exp_f32 v150, v150
v_mfma_f32_16x16x32_bf16 a[80:83], a[180:183], v[204:207], a[80:83]
s_waitcnt vmcnt(10)
s_barrier
v_mfma_f32_16x16x32_bf16 a[80:83], a[176:179], v[200:203], a[80:83]
v_exp_f32 v151, v151
v_mfma_f32_16x16x32_bf16 a[112:115], a[176:179], v[208:211], a[112:115]
v_exp_f32 v132, v132
v_mfma_f32_16x16x32_bf16 a[112:115], a[180:183], v[212:215], a[112:115]
v_exp_f32 v133, v133
v_mfma_f32_16x16x32_bf16 a[116:119], a[188:191], v[212:215], a[116:119]
ds_read_b128 a[144:147], v2 offset:16384
v_cvt_pk_bf16_f32 v197, v146, v147
v_mfma_f32_16x16x32_bf16 a[116:119], a[184:187], v[208:211], a[116:119]
v_exp_f32 v134, v134
v_mfma_f32_16x16x32_bf16 a[84:87], a[184:187], v[200:203], a[84:87]
s_waitcnt vmcnt(7)
v_readfirstlane_b32 vcc_lo, v19
s_nop 0
s_cmp_lt_u32 vcc_lo, s69
s_cbranch_scc1 L_spin_1012
L_spinbk_1013:
v_mfma_f32_16x16x32_bf16 a[84:87], a[188:191], v[204:207], a[84:87]
ds_read_b128 a[148:151], v2 offset:17408
v_cvt_pk_bf16_f32 v198, v148, v149
v_mfma_f32_16x16x32_bf16 a[52:55], a[188:191], v[180:183], a[52:55]
ds_read_b128 a[152:155], v2 offset:18432
v_cvt_pk_bf16_f32 v199, v150, v151
v_mfma_f32_16x16x32_bf16 a[52:55], a[184:187], v[176:179], a[52:55]
s_waitcnt lgkmcnt(3)
ds_read_b128 a[156:159], v2 offset:19456
v_cndmask_b32 v136, v228, v17, s[0:1]
v_mfma_f32_16x16x32_bf16 a[56:59], a[192:195], v[176:179], a[56:59]
ds_read_b128 a[160:163], v2 offset:20480
v_cndmask_b32 v137, v228, v17, s[4:5]
v_mfma_f32_16x16x32_bf16 a[56:59], a[196:199], v[180:183], a[56:59]
ds_read_b128 a[164:167], v2 offset:21504
v_cndmask_b32 v138, v228, v17, s[6:7]
v_mfma_f32_16x16x32_bf16 a[88:91], a[196:199], v[204:207], a[88:91]
ds_read_b128 a[168:171], v2 offset:22528
v_cndmask_b32 v139, v228, v17, s[8:9]
v_mfma_f32_16x16x32_bf16 a[88:91], a[192:195], v[200:203], a[88:91]
v_exp_f32 v135, v135
v_mfma_f32_16x16x32_bf16 a[120:123], a[192:195], v[208:211], a[120:123]
ds_read_b128 a[172:175], v2 offset:23552
v_cvt_pk_bf16_f32 v190, v132, v133
v_mfma_f32_16x16x32_bf16 a[120:123], a[196:199], v[212:215], a[120:123]
v_cndmask_b32 v140, v228, v17, s[10:11]
v_cvt_pk_bf16_f32 v191, v134, v135
v_mfma_f32_16x16x32_bf16 a[124:127], a[204:207], v[212:215], a[124:127]
v_cndmask_b32 v141, v228, v17, s[12:13]
v_cndmask_b32 v142, v228, v17, s[18:19]
v_mfma_f32_16x16x32_bf16 a[124:127], a[200:203], v[208:211], a[124:127]
v_cndmask_b32 v143, v228, v17, s[22:23]
v_cndmask_b32 v144, v228, v17, s[26:27]
v_mfma_f32_16x16x32_bf16 a[92:95], a[200:203], v[200:203], a[92:95]
v_cndmask_b32 v145, v228, v17, s[56:57]
v_cndmask_b32 v146, v228, v17, s[58:59]
v_mfma_f32_16x16x32_bf16 a[92:95], a[204:207], v[204:207], a[92:95]
v_cndmask_b32 v147, v228, v17, s[60:61]
v_cndmask_b32 v148, v228, v17, s[62:63]
v_mfma_f32_16x16x32_bf16 a[60:63], a[204:207], v[180:183], a[60:63]
v_cndmask_b32 v149, v228, v17, s[48:49]
v_cndmask_b32 v150, v228, v17, s[50:51]
v_mfma_f32_16x16x32_bf16 a[60:63], a[200:203], v[176:179], a[60:63]
s_waitcnt lgkmcnt(0)
v_cndmask_b32 v151, v228, v17, s[100:101]
v_accvgpr_read_b32 v21, a132
v_mfma_f32_16x16x32_bf16 v[136:139], a[144:147], v[72:75], v[136:139]
ds_read_b128 a[176:179], v2 offset:24576
v_accvgpr_read_b32 v248, a133
v_mfma_f32_16x16x32_bf16 v[136:139], a[148:151], v[76:79], v[136:139]
ds_read_b128 a[180:183], v2 offset:25600
v_add_f32 v21, v21, v248
v_mfma_f32_16x16x32_bf16 v[136:139], a[152:155], v[80:83], v[136:139]
ds_read_b128 a[184:187], v2 offset:26624
v_max_f32 v1, v1, v21
v_mfma_f32_16x16x32_bf16 v[136:139], a[156:159], v[84:87], v[136:139]
ds_read_b128 a[188:191], v2 offset:27648
ds_read_b128 a[192:195], v2 offset:28672
v_mfma_f32_16x16x32_bf16 v[140:143], a[172:175], v[84:87], v[140:143]
ds_read_b128 a[196:199], v2 offset:29696
ds_read_b128 a[200:203], v2 offset:30720
ds_read_b128 a[204:207], v2 offset:31744
v_mfma_f32_16x16x32_bf16 v[140:143], a[168:171], v[80:83], v[140:143]
v_rcp_f32 v21, v21
v_mfma_f32_16x16x32_bf16 v[140:143], a[164:167], v[76:79], v[140:143]
ds_read_b128 a[144:147], v3 offset:16384
v_accvgpr_read_b32 v232, a32
v_mfma_f32_16x16x32_bf16 v[140:143], a[160:163], v[72:75], v[140:143]
s_waitcnt lgkmcnt(7)
ds_read_b128 a[148:151], v3 offset:24576
v_accvgpr_read_b32 v233, a33
v_mfma_f32_16x16x32_bf16 v[144:147], a[176:179], v[72:75], v[144:147]
ds_read_b128 a[152:155], v3 offset:17408
v_accvgpr_read_b32 v234, a34
v_mfma_f32_16x16x32_bf16 v[144:147], a[180:183], v[76:79], v[144:147]
s_waitcnt lgkmcnt(6)
ds_read_b128 a[156:159], v3 offset:25600
v_accvgpr_read_b32 v235, a35
v_mfma_f32_16x16x32_bf16 v[144:147], a[184:187], v[80:83], v[144:147]
ds_read_b128 a[160:163], v3 offset:18432
v_accvgpr_read_b32 v236, a36
v_accvgpr_read_b32 v237, a37
v_accvgpr_read_b32 v238, a38
v_accvgpr_read_b32 v239, a39
v_mul_f32 v21, v21, v6
v_mul_f32 v232, v232, v21
v_mul_f32 v233, v233, v21
v_mul_f32 v234, v234, v21
v_mul_f32 v235, v235, v21
v_mul_f32 v236, v236, v21
v_mul_f32 v237, v237, v21
v_mul_f32 v238, v238, v21
v_mul_f32 v239, v239, v21
v_cvt_pk_bf16_f32 v232, v232, v233
v_cvt_pk_bf16_f32 v233, v234, v235
v_cvt_pk_bf16_f32 v234, v236, v237
v_cvt_pk_bf16_f32 v235, v238, v239
s_add_u32 s77, s74, 4096
buffer_store_dwordx4 v[232:235], v16, s[44:47], s77 offen sc1
v_accvgpr_read_b32 v240, a40
v_accvgpr_read_b32 v241, a41
v_accvgpr_read_b32 v242, a42
v_accvgpr_read_b32 v243, a43
v_accvgpr_read_b32 v244, a44
v_accvgpr_read_b32 v245, a45
v_accvgpr_read_b32 v246, a46
v_accvgpr_read_b32 v247, a47
v_mul_f32 v240, v240, v21
v_mul_f32 v241, v241, v21
v_mul_f32 v242, v242, v21
v_mul_f32 v243, v243, v21
v_mul_f32 v244, v244, v21
v_mul_f32 v245, v245, v21
v_mul_f32 v246, v246, v21
v_mul_f32 v247, v247, v21
v_cvt_pk_bf16_f32 v240, v240, v241
v_cvt_pk_bf16_f32 v241, v242, v243
v_cvt_pk_bf16_f32 v242, v244, v245
v_cvt_pk_bf16_f32 v243, v246, v247
s_add_u32 s77, s74, 12288
buffer_store_dwordx4 v[240:243], v16, s[44:47], s77 offen sc1
v_accvgpr_read_b32 v232, a48
v_accvgpr_read_b32 v233, a49
v_accvgpr_read_b32 v234, a50
v_accvgpr_read_b32 v235, a51
v_accvgpr_read_b32 v236, a52
v_accvgpr_read_b32 v237, a53
v_accvgpr_read_b32 v238, a54
v_accvgpr_read_b32 v239, a55
v_mul_f32 v232, v232, v21
v_mul_f32 v233, v233, v21
v_mul_f32 v234, v234, v21
v_mul_f32 v235, v235, v21
v_mul_f32 v236, v236, v21
v_mul_f32 v237, v237, v21
v_mul_f32 v238, v238, v21
v_mul_f32 v239, v239, v21
v_cvt_pk_bf16_f32 v232, v232, v233
v_cvt_pk_bf16_f32 v233, v234, v235
v_cvt_pk_bf16_f32 v234, v236, v237
v_cvt_pk_bf16_f32 v235, v238, v239
s_add_u32 s77, s74, 20480
buffer_store_dwordx4 v[232:235], v16, s[44:47], s77 offen sc1
v_accvgpr_read_b32 v240, a56
v_accvgpr_read_b32 v241, a57
v_accvgpr_read_b32 v242, a58
v_accvgpr_read_b32 v243, a59
v_accvgpr_read_b32 v244, a60
v_accvgpr_read_b32 v245, a61
v_accvgpr_read_b32 v246, a62
v_accvgpr_read_b32 v247, a63
v_mul_f32 v240, v240, v21
v_mul_f32 v241, v241, v21
v_mul_f32 v242, v242, v21
v_mul_f32 v243, v243, v21
v_mul_f32 v244, v244, v21
v_mul_f32 v245, v245, v21
v_mul_f32 v246, v246, v21
v_mul_f32 v247, v247, v21
v_cvt_pk_bf16_f32 v240, v240, v241
v_cvt_pk_bf16_f32 v241, v242, v243
v_cvt_pk_bf16_f32 v242, v244, v245
v_cvt_pk_bf16_f32 v243, v246, v247
s_add_u32 s77, s74, 28672
buffer_store_dwordx4 v[240:243], v16, s[44:47], s77 offen sc1
v_exp_f32 v136, v136
v_mfma_f32_16x16x32_bf16 v[144:147], a[188:191], v[84:87], v[144:147]
s_waitcnt lgkmcnt(5)
v_exp_f32 v137, v137
v_mfma_f32_16x16x32_bf16 v[148:151], a[204:207], v[84:87], v[148:151]
v_exp_f32 v138, v138
v_mfma_f32_16x16x32_bf16 v[148:151], a[200:203], v[80:83], v[148:151]
s_add_u32 s65, s84, 0
v_exp_f32 v139, v139
v_mfma_f32_16x16x32_bf16 v[148:151], a[196:199], v[76:79], v[148:151]
buffer_load_dwordx4 a[208:211], v14, s[44:47], s65 offen offset:0 sc1
v_mfma_f32_16x16x32_bf16 v[148:151], a[192:195], v[72:75], v[148:151]
ds_read_b128 a[164:167], v3 offset:26624
v_cvt_pk_bf16_f32 v208, v136, v137
v_smfmac_f32_16x16x64_bf16 a[136:139], a[240:243], v[184:191], v5
ds_read_b128 a[168:171], v3 offset:19456
v_smfmac_f32_16x16x64_bf16 a[140:143], a[240:243], v[192:199], v5
s_waitcnt lgkmcnt(2)
ds_read_b128 a[172:175], v3 offset:27648
v_mfma_f32_16x16x32_bf16 a[64:67], a[144:147], v[184:187], a[64:67]
v_exp_f32 v140, v140
v_mfma_f32_16x16x32_bf16 a[64:67], a[148:151], v[188:191], a[64:67]
buffer_load_dwordx4 a[216:219], v14, s[44:47], s65 offen offset:1024 sc1
v_mfma_f32_16x16x32_bf16 a[96:99], a[148:151], v[196:199], a[96:99]
v_exp_f32 v141, v141
v_mfma_f32_16x16x32_bf16 a[96:99], a[144:147], v[192:195], a[96:99]
buffer_load_dwordx4 a[224:227], v15, s[44:47], s65 offen offset:0 sc1
v_mfma_f32_16x16x32_bf16 a[100:103], a[152:155], v[192:195], a[100:103]
v_exp_f32 v142, v142
v_mfma_f32_16x16x32_bf16 a[100:103], a[156:159], v[196:199], a[100:103]
buffer_load_dwordx4 a[232:235], v15, s[44:47], s65 offen offset:1024 sc1
v_mfma_f32_16x16x32_bf16 a[68:71], a[156:159], v[188:191], a[68:71]
s_add_u32 s65, s84, 8192
ds_read_b128 a[176:179], v3 offset:20480
v_cvt_pk_bf16_f32 v209, v138, v139
v_mfma_f32_16x16x32_bf16 a[68:71], a[152:155], v[184:187], a[68:71]
buffer_load_dwordx4 a[212:215], v14, s[44:47], s65 offen offset:0 sc1
v_mfma_f32_16x16x32_bf16 a[72:75], a[160:163], v[184:187], a[72:75]
s_waitcnt lgkmcnt(1)
ds_read_b128 a[180:183], v3 offset:28672
v_cvt_pk_bf16_f32 v210, v140, v141
v_mfma_f32_16x16x32_bf16 a[72:75], a[164:167], v[188:191], a[72:75]
v_exp_f32 v143, v143
v_mfma_f32_16x16x32_bf16 a[104:107], a[164:167], v[196:199], a[104:107]
buffer_load_dwordx4 a[220:223], v14, s[44:47], s65 offen offset:1024 sc1
v_mfma_f32_16x16x32_bf16 a[104:107], a[160:163], v[192:195], a[104:107]
v_exp_f32 v144, v144
v_mfma_f32_16x16x32_bf16 a[108:111], a[168:171], v[192:195], a[108:111]
ds_read_b128 a[184:187], v3 offset:21504
v_xor_b32 v2, 0x8000, v2
v_mfma_f32_16x16x32_bf16 a[108:111], a[172:175], v[196:199], a[108:111]
buffer_load_dwordx4 a[228:231], v15, s[44:47], s65 offen offset:0 sc1
ds_read_b128 a[188:191], v3 offset:29696
v_mfma_f32_16x16x32_bf16 a[76:79], a[172:175], v[188:191], a[76:79]
v_exp_f32 v145, v145
v_mfma_f32_16x16x32_bf16 a[76:79], a[168:171], v[184:187], a[76:79]
s_waitcnt lgkmcnt(2)
buffer_load_dwordx4 a[236:239], v15, s[44:47], s65 offen offset:1024 sc1
v_mfma_f32_16x16x32_bf16 a[80:83], a[176:179], v[184:187], a[80:83]
s_add_u32 s65, s84, 32768
ds_read_b128 a[192:195], v3 offset:22528
v_cvt_pk_bf16_f32 v211, v142, v143
v_mfma_f32_16x16x32_bf16 a[80:83], a[180:183], v[188:191], a[80:83]
buffer_load_dwordx4 v[152:155], v14, s[44:47], s65 offen offset:0 sc1
ds_read_b128 a[196:199], v3 offset:30720
v_exp_f32 v146, v146
v_mfma_f32_16x16x32_bf16 a[112:115], a[180:183], v[196:199], a[112:115]
ds_read_b128 a[200:203], v3 offset:23552
ds_read_b128 a[204:207], v3 offset:31744
v_mfma_f32_16x16x32_bf16 a[112:115], a[176:179], v[192:195], a[112:115]
s_waitcnt vmcnt(13)
s_barrier
v_xor_b32 v3, 0x8000, v3
buffer_load_dwordx4 v[160:163], v14, s[44:47], s65 offen offset:1024 sc1
s_waitcnt lgkmcnt(4)
v_mfma_f32_16x16x32_bf16 a[116:119], a[184:187], v[192:195], a[116:119]
v_exp_f32 v147, v147
v_mfma_f32_16x16x32_bf16 a[116:119], a[188:191], v[196:199], a[116:119]
buffer_load_dwordx4 v[168:171], v15, s[44:47], s65 offen offset:0 sc1
v_mfma_f32_16x16x32_bf16 a[84:87], a[188:191], v[188:191], a[84:87]
v_exp_f32 v148, v148
v_mfma_f32_16x16x32_bf16 a[84:87], a[184:187], v[184:187], a[84:87]
s_waitcnt lgkmcnt(2)
buffer_load_dwordx4 v[176:179], v15, s[44:47], s65 offen offset:1024 sc1
v_cvt_pk_bf16_f32 v212, v144, v145
v_mfma_f32_16x16x32_bf16 a[88:91], a[192:195], v[184:187], a[88:91]
s_add_u32 s65, s84, 40960
v_exp_f32 v149, v149
v_mfma_f32_16x16x32_bf16 a[88:91], a[196:199], v[188:191], a[88:91]
buffer_load_dwordx4 v[156:159], v14, s[44:47], s65 offen offset:0 sc1
v_mfma_f32_16x16x32_bf16 a[120:123], a[196:199], v[196:199], a[120:123]
ds_read_b128 a[144:147], v3 offset:0
v_cvt_pk_bf16_f32 v213, v146, v147
v_mfma_f32_16x16x32_bf16 a[120:123], a[192:195], v[192:195], a[120:123]
s_waitcnt lgkmcnt(1)
buffer_load_dwordx4 v[164:167], v14, s[44:47], s65 offen offset:1024 sc1
ds_read_b128 a[148:151], v3 offset:8192
v_exp_f32 v150, v150
v_mfma_f32_16x16x32_bf16 a[124:127], a[200:203], v[192:195], a[124:127]
ds_read_b128 a[152:155], v3 offset:1024
v_cvt_pk_bf16_f32 v214, v148, v149
v_mfma_f32_16x16x32_bf16 a[124:127], a[204:207], v[196:199], a[124:127]
buffer_load_dwordx4 v[172:175], v15, s[44:47], s65 offen offset:0 sc1
ds_read_b128 a[156:159], v3 offset:9216
v_mfma_f32_16x16x32_bf16 a[92:95], a[204:207], v[188:191], a[92:95]
v_exp_f32 v151, v151
v_mfma_f32_16x16x32_bf16 a[92:95], a[200:203], v[184:187], a[92:95]
buffer_load_dwordx4 v[180:183], v15, s[44:47], s65 offen offset:1024 sc1
ds_read_b128 a[160:163], v3 offset:2048
ds_read_b128 a[164:167], v3 offset:10240
ds_read_b128 a[168:171], v3 offset:3072
ds_read_b128 a[172:175], v3 offset:11264
v_cvt_pk_bf16_f32 v215, v150, v151
v_accvgpr_read_b32 v22, a136
v_accvgpr_read_b32 v248, a137
v_add_f32 v22, v22, v248
v_max_f32 v1, v1, v22
v_rcp_f32 v22, v22
v_accvgpr_read_b32 v232, a64
v_accvgpr_read_b32 v233, a65
v_accvgpr_read_b32 v234, a66
v_accvgpr_read_b32 v235, a67
v_accvgpr_read_b32 v236, a68
v_accvgpr_read_b32 v237, a69
v_accvgpr_read_b32 v238, a70
v_accvgpr_read_b32 v239, a71
v_mul_f32 v22, v22, v8
v_mul_f32 v232, v232, v22
v_mul_f32 v233, v233, v22
v_mul_f32 v234, v234, v22
v_mul_f32 v235, v235, v22
v_mul_f32 v236, v236, v22
v_mul_f32 v237, v237, v22
v_mul_f32 v238, v238, v22
v_mul_f32 v239, v239, v22
v_cvt_pk_bf16_f32 v232, v232, v233
v_cvt_pk_bf16_f32 v233, v234, v235
v_cvt_pk_bf16_f32 v234, v236, v237
v_cvt_pk_bf16_f32 v235, v238, v239
s_add_u32 s77, s75, 0
buffer_store_dwordx4 v[232:235], v16, s[44:47], s77 offen sc1
s_branch L_TAIL
L_fallback_11:
s_waitcnt vmcnt(0) lgkmcnt(0)
s_barrier
s_mov_b32 s73, 1
s_mov_b32 s81, 0
v_and_b32 v232, 15, v0
v_lshrrev_b32 v233, 4, v0
v_lshlrev_b32 v233, 2, v233
v_sub_u32 v232, v232, v233
s_lshl_b32 s66, s30, 4
v_add_u32 v232, s66, v232
s_lshl_b32 s66, s16, 7
v_add_u32 v234, s66, v232
s_lshl_b32 s66, s3, 7
v_add_u32 v232, s66, v232
v_add_u32 v233, 64, v232
v_add_u32 v235, 64, v234
s_mov_b32 m0, s76
s_lshl_b32 s64, s30, 14
s_nop 0
buffer_load_dwordx4 v16, s[32:35], s64 offen offset:0 sc1 lds
s_nop 0
buffer_load_dwordx4 v16, s[32:35], s64 offen offset:1024 sc1 lds
s_nop 0
buffer_load_dwordx4 v16, s[32:35], s64 offen offset:2048 sc1 lds
s_nop 0
buffer_load_dwordx4 v16, s[32:35], s64 offen offset:3072 sc1 lds
s_add_u32 m0, s76, 4096
s_add_u32 s64, s64, 4096
s_nop 0
buffer_load_dwordx4 v16, s[32:35], s64 offen offset:0 sc1 lds
s_nop 0
buffer_load_dwordx4 v16, s[32:35], s64 offen offset:1024 sc1 lds
s_nop 0
buffer_load_dwordx4 v16, s[32:35], s64 offen offset:2048 sc1 lds
s_nop 0
buffer_load_dwordx4 v16, s[32:35], s64 offen offset:3072 sc1 lds
s_lshr_b32 s64, s76, 1
s_add_u32 m0, s64, 81920
s_and_b32 s71, s64, 8192
s_add_u32 s64, s64, s71
s_add_u32 s64, s64, 8192
s_nop 0
buffer_load_dwordx4 v16, s[32:35], s64 offen offset:0 sc1 lds
s_nop 0
buffer_load_dwordx4 v16, s[32:35], s64 offen offset:1024 sc1 lds
s_nop 0
buffer_load_dwordx4 v16, s[32:35], s64 offen offset:2048 sc1 lds
s_nop 0
buffer_load_dwordx4 v16, s[32:35], s64 offen offset:3072 sc1 lds
v_mov_b32 v20, 0xff800000
v_mov_b32 v21, 0xff800000
v_mov_b32 v22, 0xff800000
v_mov_b32 v23, 0xff800000
L_fbl_1015:
buffer_load_dwordx4 a[144:147], v16, s[32:35], s81 offen offset:0 sc1
buffer_load_dwordx4 a[148:151], v16, s[32:35], s81 offen offset:1024 sc1
buffer_load_dwordx4 a[152:155], v16, s[32:35], s81 offen offset:2048 sc1
buffer_load_dwordx4 a[156:159], v16, s[32:35], s81 offen offset:3072 sc1
s_add_u32 s64, s81, 4096
buffer_load_dwordx4 a[160:163], v16, s[32:35], s64 offen offset:0 sc1
buffer_load_dwordx4 a[164:167], v16, s[32:35], s64 offen offset:1024 sc1
buffer_load_dwordx4 a[168:171], v16, s[32:35], s64 offen offset:2048 sc1
buffer_load_dwordx4 a[172:175], v16, s[32:35], s64 offen offset:3072 sc1
v_subrev_u32 v88, 0, v232
v_ashrrev_i32 v88, 31, v88
v_and_b32 v88, 0xff800000, v88
v_subrev_u32 v89, 1, v232
v_ashrrev_i32 v89, 31, v89
v_and_b32 v89, 0xff800000, v89
v_subrev_u32 v90, 2, v232
v_ashrrev_i32 v90, 31, v90
v_and_b32 v90, 0xff800000, v90
v_subrev_u32 v91, 3, v232
v_ashrrev_i32 v91, 31, v91
v_and_b32 v91, 0xff800000, v91
v_subrev_u32 v92, 16, v232
v_ashrrev_i32 v92, 31, v92
v_and_b32 v92, 0xff800000, v92
v_subrev_u32 v93, 17, v232
v_ashrrev_i32 v93, 31, v93
v_and_b32 v93, 0xff800000, v93
v_subrev_u32 v94, 18, v232
v_ashrrev_i32 v94, 31, v94
v_and_b32 v94, 0xff800000, v94
v_subrev_u32 v95, 19, v232
v_ashrrev_i32 v95, 31, v95
v_and_b32 v95, 0xff800000, v95
v_subrev_u32 v232, 32, v232
v_subrev_u32 v104, 0, v233
v_ashrrev_i32 v104, 31, v104
v_and_b32 v104, 0xff800000, v104
v_subrev_u32 v105, 1, v233
v_ashrrev_i32 v105, 31, v105
v_and_b32 v105, 0xff800000, v105
v_subrev_u32 v106, 2, v233
v_ashrrev_i32 v106, 31, v106
v_and_b32 v106, 0xff800000, v106
v_subrev_u32 v107, 3, v233
v_ashrrev_i32 v107, 31, v107
v_and_b32 v107, 0xff800000, v107
v_subrev_u32 v108, 16, v233
v_ashrrev_i32 v108, 31, v108
v_and_b32 v108, 0xff800000, v108
v_subrev_u32 v109, 17, v233
v_ashrrev_i32 v109, 31, v109
v_and_b32 v109, 0xff800000, v109
v_subrev_u32 v110, 18, v233
v_ashrrev_i32 v110, 31, v110
v_and_b32 v110, 0xff800000, v110
v_subrev_u32 v111, 19, v233
v_ashrrev_i32 v111, 31, v111
v_and_b32 v111, 0xff800000, v111
v_subrev_u32 v233, 32, v233
v_subrev_u32 v120, 0, v234
v_ashrrev_i32 v120, 31, v120
v_and_b32 v120, 0xff800000, v120
v_subrev_u32 v121, 1, v234
v_ashrrev_i32 v121, 31, v121
v_and_b32 v121, 0xff800000, v121
v_subrev_u32 v122, 2, v234
v_ashrrev_i32 v122, 31, v122
v_and_b32 v122, 0xff800000, v122
v_subrev_u32 v123, 3, v234
v_ashrrev_i32 v123, 31, v123
v_and_b32 v123, 0xff800000, v123
v_subrev_u32 v124, 16, v234
v_ashrrev_i32 v124, 31, v124
v_and_b32 v124, 0xff800000, v124
v_subrev_u32 v125, 17, v234
v_ashrrev_i32 v125, 31, v125
v_and_b32 v125, 0xff800000, v125
v_subrev_u32 v126, 18, v234
v_ashrrev_i32 v126, 31, v126
v_and_b32 v126, 0xff800000, v126
v_subrev_u32 v127, 19, v234
v_ashrrev_i32 v127, 31, v127
v_and_b32 v127, 0xff800000, v127
v_subrev_u32 v234, 32, v234
v_subrev_u32 v136, 0, v235
v_ashrrev_i32 v136, 31, v136
v_and_b32 v136, 0xff800000, v136
v_subrev_u32 v137, 1, v235
v_ashrrev_i32 v137, 31, v137
v_and_b32 v137, 0xff800000, v137
v_subrev_u32 v138, 2, v235
v_ashrrev_i32 v138, 31, v138
v_and_b32 v138, 0xff800000, v138
v_subrev_u32 v139, 3, v235
v_ashrrev_i32 v139, 31, v139
v_and_b32 v139, 0xff800000, v139
v_subrev_u32 v140, 16, v235
v_ashrrev_i32 v140, 31, v140
v_and_b32 v140, 0xff800000, v140
v_subrev_u32 v141, 17, v235
v_ashrrev_i32 v141, 31, v141
v_and_b32 v141, 0xff800000, v141
v_subrev_u32 v142, 18, v235
v_ashrrev_i32 v142, 31, v142
v_and_b32 v142, 0xff800000, v142
v_subrev_u32 v143, 19, v235
v_ashrrev_i32 v143, 31, v143
v_and_b32 v143, 0xff800000, v143
v_subrev_u32 v235, 32, v235
s_waitcnt vmcnt(0)
v_mfma_f32_16x16x32_bf16 v[88:91], a[144:147], v[24:27], v[88:91]
v_mfma_f32_16x16x32_bf16 v[104:107], a[144:147], v[40:43], v[104:107]
v_mfma_f32_16x16x32_bf16 v[120:123], a[144:147], v[56:59], v[120:123]
v_mfma_f32_16x16x32_bf16 v[136:139], a[144:147], v[72:75], v[136:139]
v_mfma_f32_16x16x32_bf16 v[88:91], a[148:151], v[28:31], v[88:91]
v_mfma_f32_16x16x32_bf16 v[104:107], a[148:151], v[44:47], v[104:107]
v_mfma_f32_16x16x32_bf16 v[120:123], a[148:151], v[60:63], v[120:123]
v_mfma_f32_16x16x32_bf16 v[136:139], a[148:151], v[76:79], v[136:139]
v_mfma_f32_16x16x32_bf16 v[88:91], a[152:155], v[32:35], v[88:91]
v_mfma_f32_16x16x32_bf16 v[104:107], a[152:155], v[48:51], v[104:107]
v_mfma_f32_16x16x32_bf16 v[120:123], a[152:155], v[64:67], v[120:123]
v_mfma_f32_16x16x32_bf16 v[136:139], a[152:155], v[80:83], v[136:139]
v_mfma_f32_16x16x32_bf16 v[88:91], a[156:159], v[36:39], v[88:91]
v_mfma_f32_16x16x32_bf16 v[104:107], a[156:159], v[52:55], v[104:107]
v_mfma_f32_16x16x32_bf16 v[120:123], a[156:159], v[68:71], v[120:123]
v_mfma_f32_16x16x32_bf16 v[136:139], a[156:159], v[84:87], v[136:139]
v_mfma_f32_16x16x32_bf16 v[92:95], a[160:163], v[24:27], v[92:95]
v_mfma_f32_16x16x32_bf16 v[108:111], a[160:163], v[40:43], v[108:111]
v_mfma_f32_16x16x32_bf16 v[124:127], a[160:163], v[56:59], v[124:127]
v_mfma_f32_16x16x32_bf16 v[140:143], a[160:163], v[72:75], v[140:143]
v_mfma_f32_16x16x32_bf16 v[92:95], a[164:167], v[28:31], v[92:95]
v_mfma_f32_16x16x32_bf16 v[108:111], a[164:167], v[44:47], v[108:111]
v_mfma_f32_16x16x32_bf16 v[124:127], a[164:167], v[60:63], v[124:127]
v_mfma_f32_16x16x32_bf16 v[140:143], a[164:167], v[76:79], v[140:143]
v_mfma_f32_16x16x32_bf16 v[92:95], a[168:171], v[32:35], v[92:95]
v_mfma_f32_16x16x32_bf16 v[108:111], a[168:171], v[48:51], v[108:111]
v_mfma_f32_16x16x32_bf16 v[124:127], a[168:171], v[64:67], v[124:127]
v_mfma_f32_16x16x32_bf16 v[140:143], a[168:171], v[80:83], v[140:143]
v_mfma_f32_16x16x32_bf16 v[92:95], a[172:175], v[36:39], v[92:95]
v_mfma_f32_16x16x32_bf16 v[108:111], a[172:175], v[52:55], v[108:111]
v_mfma_f32_16x16x32_bf16 v[124:127], a[172:175], v[68:71], v[124:127]
v_mfma_f32_16x16x32_bf16 v[140:143], a[172:175], v[84:87], v[140:143]
s_nop 7
v_max3_f32 v20, v20, v88, v89
v_max3_f32 v20, v20, v90, v91
v_max3_f32 v20, v20, v92, v93
v_max3_f32 v20, v20, v94, v95
v_max3_f32 v21, v21, v104, v105
v_max3_f32 v21, v21, v106, v107
v_max3_f32 v21, v21, v108, v109
v_max3_f32 v21, v21, v110, v111
v_max3_f32 v22, v22, v120, v121
v_max3_f32 v22, v22, v122, v123
v_max3_f32 v22, v22, v124, v125
v_max3_f32 v22, v22, v126, v127
v_max3_f32 v23, v23, v136, v137
v_max3_f32 v23, v23, v138, v139
v_max3_f32 v23, v23, v140, v141
v_max3_f32 v23, v23, v142, v143
s_add_u32 s81, s81, 16384
s_cmp_lt_u32 s81, s34
s_cbranch_scc1 L_fbl_1015
v_mov_b32 v248, v20
v_mov_b32 v249, v21
v_mov_b32 v250, v22
v_mov_b32 v251, v23
v_permlane16_swap_b32 v248, v20
v_permlane16_swap_b32 v249, v21
v_permlane16_swap_b32 v250, v22
v_permlane16_swap_b32 v251, v23
v_max_f32 v20, v20, v248
v_max_f32 v21, v21, v249
v_max_f32 v22, v22, v250
v_max_f32 v23, v23, v251
v_mov_b32 v248, v20
v_mov_b32 v249, v21
v_mov_b32 v250, v22
v_mov_b32 v251, v23
v_permlane32_swap_b32 v248, v20
v_permlane32_swap_b32 v249, v21
v_permlane32_swap_b32 v250, v22
v_permlane32_swap_b32 v251, v23
v_max_f32 v20, v20, v248
v_max_f32 v21, v21, v249
v_max_f32 v22, v22, v250
v_max_f32 v23, v23, v251
v_mov_b32 v252, v20
v_mov_b32 v253, v21
v_mov_b32 v254, v22
v_mov_b32 v255, v23
s_and_b32 s70, s30, 1
s_lshr_b32 s67, s30, 1
s_lshl3_add_u32 s71, s67, s70
s_add_u32 s71, s71, 4
s_lshl_b32 s71, s71, 13
s_lshl_b32 s70, s70, 14
s_mul_i32 s67, s67, 24576
s_sub_u32 s70, s70, s67
s_add_u32 s70, s70, 65536
s_branch L_attstart_7
L_spin_2016:
s_mov_b32 vcc_hi, 0x80000
L_spinlp_2018:
s_sleep 1
buffer_load_dword v19, off, s[52:55], s72 offset:0 sc1
s_waitcnt vmcnt(0)
v_readfirstlane_b32 vcc_lo, v19
s_sub_u32 vcc_hi, vcc_hi, 1
s_cbranch_scc1 L_spinbk_2017
s_cmp_lt_u32 vcc_lo, 8
s_cbranch_scc1 L_spinlp_2018
s_branch L_spinbk_2017
L_spin_3019:
s_mov_b32 vcc_hi, 0x80000
L_spinlp_3021:
s_sleep 1
buffer_load_dword v19, off, s[52:55], s72 offset:0 sc1
s_waitcnt vmcnt(0)
v_readfirstlane_b32 vcc_lo, v19
s_sub_u32 vcc_hi, vcc_hi, 1
s_cbranch_scc1 L_spinbk_3020
s_cmp_lt_u32 vcc_lo, 8
s_cbranch_scc1 L_spinlp_3021
s_branch L_spinbk_3020
.p2align 12
L_pg24:
s_branch L_tr2
L_p5f0:
s_waitcnt lgkmcnt(10)
s_waitcnt vmcnt(28)
v_mfma_f32_16x16x32_bf16 v[136:139], a[144:147], a[232:235], 0
s_waitcnt vmcnt(24)
s_waitcnt lgkmcnt(8)
s_add_u32 m0, s86, 65536
ds_read_b64_tr_b16 a[168:169], v191 offset:32768
v_xor_b32 v192, 0x10000, v184
v_mfma_f32_16x16x32_bf16 v[136:139], a[148:151], a[236:239], v[136:139]
s_add_u32 s64, s85, 524288
ds_read_b64_tr_b16 a[170:171], v191 offset:36864
v_xor_b32 v193, 0x10000, v185
v_mfma_f32_16x16x32_bf16 v[104:107], a[148:151], a[228:231], 0
buffer_load_dwordx4 v12, s[36:39], s64 offen lds
v_mfma_f32_16x16x32_bf16 v[104:107], a[144:147], a[224:227], v[104:107]
s_add_u32 m0, s86, 66560
s_add_u32 s64, s85, 532480
ds_read_b64_tr_b16 a[172:173], v191 offset:40960
v_xor_b32 v194, 0x10000, v186
v_mfma_f32_16x16x32_bf16 v[72:75], a[144:147], a[216:219], 0
s_and_b32 s71, s31, 4
buffer_load_dwordx4 v13, s[36:39], s64 offen lds
v_mfma_f32_16x16x32_bf16 v[72:75], a[148:151], a[220:223], v[72:75]
s_lshl_b32 s71, s71, 5
s_add_u32 s71, s71, s79
s_add_u32 m0, s86, 67584
s_add_u32 s64, s85, 540672
ds_read_b64_tr_b16 a[174:175], v191 offset:45056
v_mfma_f32_16x16x32_bf16 v[40:43], a[148:151], a[212:215], 0
s_add_u32 s71, s71, 4096
buffer_load_dwordx4 v12, s[36:39], s64 offen lds
v_mfma_f32_16x16x32_bf16 v[40:43], a[144:147], a[208:211], v[40:43]
s_waitcnt lgkmcnt(4)
s_add_u32 s72, s80, 4096
s_add_u32 m0, s86, 68608
s_add_u32 s64, s85, 548864
ds_read_b64_tr_b16 a[176:177], v184 offset:32768
v_xor_b32 v195, 0x10000, v187
v_mfma_f32_16x16x32_bf16 v[44:47], a[152:155], a[208:211], 0
buffer_load_dwordx4 v13, s[36:39], s64 offen lds
v_mfma_f32_16x16x32_bf16 v[44:47], a[156:159], a[212:215], v[44:47]
s_add_u32 m0, s86, 69632
ds_read_b64_tr_b16 a[178:179], v184 offset:36864
v_xor_b32 v196, 0x10000, v188
v_mfma_f32_16x16x32_bf16 v[76:79], a[156:159], a[220:223], 0
s_add_u32 s64, s85, 557056
ds_read_b64_tr_b16 a[180:181], v184 offset:40960
v_xor_b32 v197, 0x10000, v189
v_mfma_f32_16x16x32_bf16 v[76:79], a[152:155], a[216:219], v[76:79]
buffer_load_dwordx4 v12, s[36:39], s64 offen lds
v_mfma_f32_16x16x32_bf16 v[108:111], a[152:155], a[224:227], 0
s_add_u32 m0, s86, 70656
s_add_u32 s64, s85, 565248
ds_read_b64_tr_b16 a[182:183], v184 offset:45056
v_xor_b32 v198, 0x10000, v190
v_mfma_f32_16x16x32_bf16 v[108:111], a[156:159], a[228:231], v[108:111]
buffer_load_dwordx4 v13, s[36:39], s64 offen lds
v_mfma_f32_16x16x32_bf16 v[140:143], a[156:159], a[236:239], 0
s_add_u32 m0, s86, 71680
s_add_u32 s64, s85, 573440
ds_read_b64_tr_b16 a[184:185], v185 offset:32768
v_xor_b32 v199, 0x10000, v191
v_mfma_f32_16x16x32_bf16 v[140:143], a[152:155], a[232:235], v[140:143]
buffer_load_dwordx4 v12, s[36:39], s64 offen lds
v_mfma_f32_16x16x32_bf16 v[144:147], a[160:163], a[232:235], 0
s_add_u32 m0, s86, 72704
ds_read_b64_tr_b16 a[186:187], v185 offset:36864
v_mfma_f32_16x16x32_bf16 v[144:147], a[164:167], a[236:239], v[144:147]
s_add_u32 s64, s85, 581632
ds_read_b64_tr_b16 a[188:189], v185 offset:40960
v_mfma_f32_16x16x32_bf16 v[112:115], a[164:167], a[228:231], 0
buffer_load_dwordx4 v13, s[36:39], s64 offen lds
v_mfma_f32_16x16x32_bf16 v[112:115], a[160:163], a[224:227], v[112:115]
s_add_u32 s65, s84, 65536
ds_read_b64_tr_b16 a[190:191], v185 offset:45056
v_mfma_f32_16x16x32_bf16 v[80:83], a[160:163], a[216:219], 0
buffer_load_dwordx4 a[0:3], v14, s[44:47], s65 offen offset:0 sc1
v_mfma_f32_16x16x32_bf16 v[80:83], a[164:167], a[220:223], v[80:83]
ds_read_b64_tr_b16 a[192:193], v186 offset:32768
v_mfma_f32_16x16x32_bf16 v[48:51], a[164:167], a[212:215], 0
buffer_load_dwordx4 a[8:11], v14, s[44:47], s65 offen offset:1024 sc1
v_mfma_f32_16x16x32_bf16 v[48:51], a[160:163], a[208:211], v[48:51]
s_waitcnt lgkmcnt(4)
ds_read_b64_tr_b16 a[194:195], v186 offset:36864
v_mfma_f32_16x16x32_bf16 v[52:55], a[168:171], a[208:211], 0
ds_read_b64_tr_b16 a[196:197], v186 offset:40960
v_mfma_f32_16x16x32_bf16 v[52:55], a[172:175], a[212:215], v[52:55]
buffer_load_dwordx4 a[16:19], v15, s[44:47], s65 offen offset:0 sc1
v_mfma_f32_16x16x32_bf16 v[84:87], a[172:175], a[220:223], 0
ds_read_b64_tr_b16 a[198:199], v186 offset:45056
v_mfma_f32_16x16x32_bf16 v[84:87], a[168:171], a[216:219], v[84:87]
buffer_load_dwordx4 a[24:27], v15, s[44:47], s65 offen offset:1024 sc1
v_mfma_f32_16x16x32_bf16 v[116:119], a[168:171], a[224:227], 0
s_add_u32 s65, s84, 73728
ds_read_b64_tr_b16 a[200:201], v187 offset:32768
v_mfma_f32_16x16x32_bf16 v[116:119], a[172:175], a[228:231], v[116:119]
buffer_load_dwordx4 a[4:7], v14, s[44:47], s65 offen offset:0 sc1
v_mfma_f32_16x16x32_bf16 v[148:151], a[172:175], a[236:239], 0
ds_read_b64_tr_b16 a[202:203], v187 offset:36864
v_mfma_f32_16x16x32_bf16 v[148:151], a[168:171], a[232:235], v[148:151]
ds_read_b64_tr_b16 a[204:205], v187 offset:40960
v_mfma_f32_16x16x32_bf16 v[120:123], a[176:179], a[232:235], 0
buffer_load_dwordx4 a[12:15], v14, s[44:47], s65 offen offset:1024 sc1
v_mfma_f32_16x16x32_bf16 v[120:123], a[180:183], a[236:239], v[120:123]
ds_read_b64_tr_b16 a[206:207], v187 offset:45056
v_mfma_f32_16x16x32_bf16 v[88:91], a[180:183], a[228:231], 0
buffer_load_dwordx4 a[20:23], v15, s[44:47], s65 offen offset:0 sc1
v_mfma_f32_16x16x32_bf16 v[88:91], a[176:179], a[224:227], v[88:91]
v_mfma_f32_16x16x32_bf16 v[56:59], a[176:179], a[216:219], 0
buffer_load_dwordx4 a[28:31], v15, s[44:47], s65 offen offset:1024 sc1
v_mfma_f32_16x16x32_bf16 v[56:59], a[180:183], a[220:223], v[56:59]
v_mfma_f32_16x16x32_bf16 v[24:27], a[180:183], a[212:215], 0
v_mfma_f32_16x16x32_bf16 v[24:27], a[176:179], a[208:211], v[24:27]
s_waitcnt lgkmcnt(1)
v_mfma_f32_16x16x32_bf16 v[28:31], a[184:187], a[208:211], 0
s_waitcnt vmcnt(23)
s_barrier
v_mfma_f32_16x16x32_bf16 v[28:31], a[188:191], a[212:215], v[28:31]
ds_read_b64_tr_b16 a[144:145], v196 offset:0
v_mfma_f32_16x16x32_bf16 v[60:63], a[188:191], a[220:223], 0
ds_read_b64_tr_b16 a[146:147], v196 offset:4096
v_mfma_f32_16x16x32_bf16 v[60:63], a[184:187], a[216:219], v[60:63]
s_add_u32 m0, s86, 0
ds_read_b64_tr_b16 a[148:149], v196 offset:8192
v_mfma_f32_16x16x32_bf16 v[92:95], a[184:187], a[224:227], 0
s_add_u32 s64, s85, 786432
ds_read_b64_tr_b16 a[150:151], v196 offset:12288
v_mfma_f32_16x16x32_bf16 v[92:95], a[188:191], a[228:231], v[92:95]
buffer_load_dwordx4 v12, s[36:39], s64 offen lds
v_mfma_f32_16x16x32_bf16 v[124:127], a[188:191], a[236:239], 0
s_add_u32 m0, s86, 1024
ds_read_b64_tr_b16 a[152:153], v197 offset:0
v_mfma_f32_16x16x32_bf16 v[124:127], a[184:187], a[232:235], v[124:127]
s_add_u32 s64, s85, 794624
ds_read_b64_tr_b16 a[154:155], v197 offset:4096
v_mfma_f32_16x16x32_bf16 v[128:131], a[192:195], a[232:235], 0
buffer_load_dwordx4 v13, s[36:39], s64 offen lds
v_mfma_f32_16x16x32_bf16 v[128:131], a[196:199], a[236:239], v[128:131]
ds_read_b64_tr_b16 a[156:157], v197 offset:8192
v_mfma_f32_16x16x32_bf16 v[96:99], a[196:199], a[228:231], 0
s_add_u32 m0, s86, 2048
ds_read_b64_tr_b16 a[158:159], v197 offset:12288
v_mfma_f32_16x16x32_bf16 v[96:99], a[192:195], a[224:227], v[96:99]
s_add_u32 s64, s85, 802816
ds_read_b64_tr_b16 a[160:161], v198 offset:0
v_mfma_f32_16x16x32_bf16 v[64:67], a[192:195], a[216:219], 0
buffer_load_dwordx4 v12, s[36:39], s64 offen lds
v_mfma_f32_16x16x32_bf16 v[64:67], a[196:199], a[220:223], v[64:67]
ds_read_b64_tr_b16 a[162:163], v198 offset:4096
v_mfma_f32_16x16x32_bf16 v[32:35], a[196:199], a[212:215], 0
s_add_u32 m0, s86, 3072
ds_read_b64_tr_b16 a[164:165], v198 offset:8192
v_mfma_f32_16x16x32_bf16 v[32:35], a[192:195], a[208:211], v[32:35]
s_add_u32 s64, s85, 811008
ds_read_b64_tr_b16 a[166:167], v198 offset:12288
v_mfma_f32_16x16x32_bf16 v[36:39], a[200:203], a[208:211], 0
s_waitcnt lgkmcnt(6)
buffer_load_dwordx4 v13, s[36:39], s64 offen lds
v_mfma_f32_16x16x32_bf16 v[36:39], a[204:207], a[212:215], v[36:39]
v_mfma_f32_16x16x32_bf16 v[68:71], a[204:207], a[220:223], 0
s_add_u32 m0, s86, 4096
v_mfma_f32_16x16x32_bf16 v[68:71], a[200:203], a[216:219], v[68:71]
s_add_u32 s64, s85, 819200
v_mfma_f32_16x16x32_bf16 v[100:103], a[200:203], a[224:227], 0
buffer_load_dwordx4 v12, s[36:39], s64 offen lds
v_mfma_f32_16x16x32_bf16 v[100:103], a[204:207], a[228:231], v[100:103]
v_mfma_f32_16x16x32_bf16 v[132:135], a[204:207], a[236:239], 0
v_mfma_f32_16x16x32_bf16 v[132:135], a[200:203], a[232:235], v[132:135]
v_mfma_f32_16x16x32_bf16 v[136:139], a[144:147], v[176:179], v[136:139]
s_add_u32 m0, s86, 5120
ds_read_b64_tr_b16 a[168:169], v199 offset:0
v_xor_b32 v200, 0x18000, v184
v_mfma_f32_16x16x32_bf16 v[136:139], a[148:151], v[180:183], v[136:139]
s_add_u32 s64, s85, 827392
ds_read_b64_tr_b16 a[170:171], v199 offset:4096
v_xor_b32 v201, 0x18000, v185
v_mfma_f32_16x16x32_bf16 v[104:107], a[148:151], v[172:175], v[104:107]
buffer_load_dwordx4 v13, s[36:39], s64 offen lds
v_mfma_f32_16x16x32_bf16 v[104:107], a[144:147], v[168:171], v[104:107]
s_add_u32 m0, s86, 6144
ds_read_b64_tr_b16 a[172:173], v199 offset:8192
v_xor_b32 v202, 0x18000, v186
v_mfma_f32_16x16x32_bf16 v[72:75], a[144:147], v[160:163], v[72:75]
s_add_u32 s64, s85, 835584
ds_read_b64_tr_b16 a[174:175], v199 offset:12288
v_xor_b32 v203, 0x18000, v187
v_mfma_f32_16x16x32_bf16 v[72:75], a[148:151], v[164:167], v[72:75]
buffer_load_dwordx4 v12, s[36:39], s64 offen lds
v_mfma_f32_16x16x32_bf16 v[40:43], a[148:151], v[156:159], v[40:43]
s_add_u32 m0, s86, 7168
ds_read_b64_tr_b16 a[176:177], v192 offset:0
v_xor_b32 v204, 0x18000, v188
v_mfma_f32_16x16x32_bf16 v[40:43], a[144:147], v[152:155], v[40:43]
s_add_u32 s64, s85, 843776
ds_read_b64_tr_b16 a[178:179], v192 offset:4096
v_xor_b32 v205, 0x18000, v189
v_mfma_f32_16x16x32_bf16 v[44:47], a[152:155], v[152:155], v[44:47]
s_waitcnt lgkmcnt(5)
buffer_load_dwordx4 v13, s[36:39], s64 offen lds
v_mfma_f32_16x16x32_bf16 v[44:47], a[156:159], v[156:159], v[44:47]
ds_read_b64_tr_b16 a[180:181], v192 offset:8192
v_xor_b32 v206, 0x18000, v190
v_mfma_f32_16x16x32_bf16 v[76:79], a[156:159], v[164:167], v[76:79]
ds_read_b64_tr_b16 a[182:183], v192 offset:12288
v_xor_b32 v207, 0x18000, v191
v_mfma_f32_16x16x32_bf16 v[76:79], a[152:155], v[160:163], v[76:79]
s_add_u32 s65, s84, 98304
ds_read_b64_tr_b16 a[184:185], v193 offset:0
v_mfma_f32_16x16x32_bf16 v[108:111], a[152:155], v[168:171], v[108:111]
buffer_load_dwordx4 a[64:67], v14, s[44:47], s65 offen offset:0 sc1
v_mfma_f32_16x16x32_bf16 v[108:111], a[156:159], v[172:175], v[108:111]
ds_read_b64_tr_b16 a[186:187], v193 offset:4096
v_mfma_f32_16x16x32_bf16 v[140:143], a[156:159], v[180:183], v[140:143]
ds_read_b64_tr_b16 a[188:189], v193 offset:8192
v_mfma_f32_16x16x32_bf16 v[140:143], a[152:155], v[176:179], v[140:143]
buffer_load_dwordx4 a[72:75], v14, s[44:47], s65 offen offset:1024 sc1
v_mfma_f32_16x16x32_bf16 v[144:147], a[160:163], v[176:179], v[144:147]
ds_read_b64_tr_b16 a[190:191], v193 offset:12288
v_mfma_f32_16x16x32_bf16 v[144:147], a[164:167], v[180:183], v[144:147]
v_mfma_f32_16x16x32_bf16 v[112:115], a[164:167], v[172:175], v[112:115]
buffer_load_dwordx4 a[80:83], v15, s[44:47], s65 offen offset:0 sc1
v_mfma_f32_16x16x32_bf16 v[112:115], a[160:163], v[168:171], v[112:115]
ds_read_b64_tr_b16 a[192:193], v194 offset:0
v_mfma_f32_16x16x32_bf16 v[80:83], a[160:163], v[160:163], v[80:83]
ds_read_b64_tr_b16 a[194:195], v194 offset:4096
v_mfma_f32_16x16x32_bf16 v[80:83], a[164:167], v[164:167], v[80:83]
ds_read_b64_tr_b16 a[196:197], v194 offset:8192
v_mfma_f32_16x16x32_bf16 v[48:51], a[164:167], v[156:159], v[48:51]
buffer_load_dwordx4 a[88:91], v15, s[44:47], s65 offen offset:1024 sc1
v_mfma_f32_16x16x32_bf16 v[48:51], a[160:163], v[152:155], v[48:51]
s_waitcnt lgkmcnt(4)
ds_read_b64_tr_b16 a[198:199], v194 offset:12288
v_mfma_f32_16x16x32_bf16 v[52:55], a[168:171], v[152:155], v[52:55]
s_add_u32 s65, s84, 106496
v_mfma_f32_16x16x32_bf16 v[52:55], a[172:175], v[156:159], v[52:55]
buffer_load_dwordx4 a[68:71], v14, s[44:47], s65 offen offset:0 sc1
v_mfma_f32_16x16x32_bf16 v[84:87], a[172:175], v[164:167], v[84:87]
ds_read_b64_tr_b16 a[200:201], v195 offset:0
v_mfma_f32_16x16x32_bf16 v[84:87], a[168:171], v[160:163], v[84:87]
ds_read_b64_tr_b16 a[202:203], v195 offset:4096
v_mfma_f32_16x16x32_bf16 v[116:119], a[168:171], v[168:171], v[116:119]
s_lshl_b32 s66, s30, 30
buffer_load_dwordx4 a[76:79], v14, s[44:47], s65 offen offset:1024 sc1
v_mfma_f32_16x16x32_bf16 v[116:119], a[172:175], v[172:175], v[116:119]
ds_read_b64_tr_b16 a[204:205], v195 offset:8192
v_lshl_add_u32 v1, v0, 24, s66
v_mfma_f32_16x16x32_bf16 v[148:151], a[172:175], v[180:183], v[148:151]
ds_read_b64_tr_b16 a[206:207], v195 offset:12288
v_mfma_f32_16x16x32_bf16 v[148:151], a[168:171], v[176:179], v[148:151]
v_mfma_f32_16x16x32_bf16 v[120:123], a[176:179], v[176:179], v[120:123]
buffer_load_dwordx4 a[84:87], v15, s[44:47], s65 offen offset:0 sc1
v_mfma_f32_16x16x32_bf16 v[120:123], a[180:183], v[180:183], v[120:123]
v_mfma_f32_16x16x32_bf16 v[88:91], a[180:183], v[172:175], v[88:91]
v_mfma_f32_16x16x32_bf16 v[88:91], a[176:179], v[168:171], v[88:91]
buffer_load_dwordx4 a[92:95], v15, s[44:47], s65 offen offset:1024 sc1
v_mfma_f32_16x16x32_bf16 v[56:59], a[176:179], v[160:163], v[56:59]
v_mfma_f32_16x16x32_bf16 v[56:59], a[180:183], v[164:167], v[56:59]
v_mfma_f32_16x16x32_bf16 v[24:27], a[180:183], v[156:159], v[24:27]
v_mfma_f32_16x16x32_bf16 v[24:27], a[176:179], v[152:155], v[24:27]
v_mfma_f32_16x16x32_bf16 v[28:31], a[184:187], v[152:155], v[28:31]
s_waitcnt vmcnt(24)
s_barrier
s_waitcnt lgkmcnt(0)
v_mfma_f32_16x16x32_bf16 v[28:31], a[188:191], v[156:159], v[28:31]
s_mov_b64 exec, 1
buffer_atomic_add a251, v1, s[52:55], s71 offen offset:0 sc1
s_mov_b64 exec, -1
v_mfma_f32_16x16x32_bf16 v[60:63], a[188:191], v[164:167], v[60:63]
ds_read_b64_tr_b16 a[144:145], v196 offset:32768
v_mfma_f32_16x16x32_bf16 v[60:63], a[184:187], v[160:163], v[60:63]
s_add_u32 m0, s86, 98304
ds_read_b64_tr_b16 a[146:147], v196 offset:36864
v_mfma_f32_16x16x32_bf16 v[92:95], a[184:187], v[168:171], v[92:95]
s_add_u32 s64, s85, 1048576
ds_read_b64_tr_b16 a[148:149], v196 offset:40960
v_mfma_f32_16x16x32_bf16 v[92:95], a[188:191], v[172:175], v[92:95]
buffer_load_dwordx4 v12, s[36:39], s64 offen lds
v_mfma_f32_16x16x32_bf16 v[124:127], a[188:191], v[180:183], v[124:127]
s_add_u32 m0, s86, 99328
ds_read_b64_tr_b16 a[150:151], v196 offset:45056
v_mfma_f32_16x16x32_bf16 v[124:127], a[184:187], v[176:179], v[124:127]
s_add_u32 s64, s85, 1056768
ds_read_b64_tr_b16 a[152:153], v197 offset:32768
v_mfma_f32_16x16x32_bf16 v[128:131], a[192:195], v[176:179], v[128:131]
buffer_load_dwordx4 v13, s[36:39], s64 offen lds
v_mfma_f32_16x16x32_bf16 v[128:131], a[196:199], v[180:183], v[128:131]
ds_read_b64_tr_b16 a[154:155], v197 offset:36864
v_mfma_f32_16x16x32_bf16 v[96:99], a[196:199], v[172:175], v[96:99]
s_add_u32 m0, s86, 100352
ds_read_b64_tr_b16 a[156:157], v197 offset:40960
v_mfma_f32_16x16x32_bf16 v[96:99], a[192:195], v[168:171], v[96:99]
s_add_u32 s64, s85, 1064960
ds_read_b64_tr_b16 a[158:159], v197 offset:45056
v_mfma_f32_16x16x32_bf16 v[64:67], a[192:195], v[160:163], v[64:67]
buffer_load_dwordx4 v12, s[36:39], s64 offen lds
v_mfma_f32_16x16x32_bf16 v[64:67], a[196:199], v[164:167], v[64:67]
ds_read_b64_tr_b16 a[160:161], v198 offset:32768
v_mfma_f32_16x16x32_bf16 v[32:35], a[196:199], v[156:159], v[32:35]
s_add_u32 m0, s86, 101376
ds_read_b64_tr_b16 a[162:163], v198 offset:36864
v_mfma_f32_16x16x32_bf16 v[32:35], a[192:195], v[152:155], v[32:35]
s_add_u32 s64, s85, 1073152
ds_read_b64_tr_b16 a[164:165], v198 offset:40960
v_mfma_f32_16x16x32_bf16 v[36:39], a[200:203], v[152:155], v[36:39]
buffer_load_dwordx4 v13, s[36:39], s64 offen lds
v_mfma_f32_16x16x32_bf16 v[36:39], a[204:207], v[156:159], v[36:39]
ds_read_b64_tr_b16 a[166:167], v198 offset:45056
v_mfma_f32_16x16x32_bf16 v[68:71], a[204:207], v[164:167], v[68:71]
s_add_u32 m0, s86, 102400
v_mfma_f32_16x16x32_bf16 v[68:71], a[200:203], v[160:163], v[68:71]
s_add_u32 s64, s85, 1081344
v_mfma_f32_16x16x32_bf16 v[100:103], a[200:203], v[168:171], v[100:103]
buffer_load_dwordx4 v12, s[36:39], s64 offen lds
v_mfma_f32_16x16x32_bf16 v[100:103], a[204:207], v[172:175], v[100:103]
v_mfma_f32_16x16x32_bf16 v[132:135], a[204:207], v[180:183], v[132:135]
s_add_u32 m0, s86, 103424
v_mfma_f32_16x16x32_bf16 v[132:135], a[200:203], v[176:179], v[132:135]
s_waitcnt vmcnt(26)
s_waitcnt lgkmcnt(1)
s_add_u32 s64, s85, 1089536
v_mfma_f32_16x16x32_bf16 v[136:139], a[144:147], a[24:27], v[136:139]
s_waitcnt vmcnt(22)
s_and_b32 s68, s82, 3
s_lshl_b32 s68, s68, 11
ds_read_b64_tr_b16 a[168:169], v199 offset:32768
v_mfma_f32_16x16x32_bf16 v[136:139], a[148:151], a[28:31], v[136:139]
s_add_u32 s76, s86, s68
s_lshr_b32 s69, s87, 8
ds_read_b64_tr_b16 a[170:171], v199 offset:36864
v_mfma_f32_16x16x32_bf16 v[104:107], a[148:151], a[20:23], v[104:107]
s_lshr_b32 s67, s82, 1
buffer_load_dwordx4 v13, s[36:39], s64 offen lds
v_mfma_f32_16x16x32_bf16 v[104:107], a[144:147], a[16:19], v[104:107]
s_xor_b32 s69, s69, s67
s_and_b32 s69, s69, 2
s_add_u32 m0, s86, 104448
ds_read_b64_tr_b16 a[172:173], v199 offset:40960
v_mfma_f32_16x16x32_bf16 v[72:75], a[144:147], a[8:11], v[72:75]
s_lshl_b32 s69, s69, 15
s_add_u32 s68, s68, s69
s_add_u32 s64, s85, 1097728
ds_read_b64_tr_b16 a[174:175], v199 offset:45056
v_mfma_f32_16x16x32_bf16 v[72:75], a[148:151], a[12:15], v[72:75]
buffer_load_dwordx4 v12, s[36:39], s64 offen lds
v_mfma_f32_16x16x32_bf16 v[40:43], a[148:151], a[4:7], v[40:43]
s_add_u32 m0, s86, 105472
ds_read_b64_tr_b16 a[176:177], v192 offset:32768
v_mfma_f32_16x16x32_bf16 v[40:43], a[144:147], a[0:3], v[40:43]
s_add_u32 s64, s85, 1105920
ds_read_b64_tr_b16 a[178:179], v192 offset:36864
v_mfma_f32_16x16x32_bf16 v[44:47], a[152:155], a[0:3], v[44:47]
buffer_load_dwordx4 v13, s[36:39], s64 offen lds
v_mfma_f32_16x16x32_bf16 v[44:47], a[156:159], a[4:7], v[44:47]
ds_read_b64_tr_b16 a[180:181], v192 offset:40960
v_mfma_f32_16x16x32_bf16 v[76:79], a[156:159], a[12:15], v[76:79]
ds_read_b64_tr_b16 a[182:183], v192 offset:45056
v_mfma_f32_16x16x32_bf16 v[76:79], a[152:155], a[8:11], v[76:79]
s_add_u32 s65, s84, 131072
ds_read_b64_tr_b16 a[184:185], v193 offset:32768
v_mfma_f32_16x16x32_bf16 v[108:111], a[152:155], a[16:19], v[108:111]
buffer_load_dwordx4 a[32:35], v14, s[44:47], s65 offen offset:0 sc1
v_mfma_f32_16x16x32_bf16 v[108:111], a[156:159], a[20:23], v[108:111]
ds_read_b64_tr_b16 a[186:187], v193 offset:36864
v_mfma_f32_16x16x32_bf16 v[140:143], a[156:159], a[28:31], v[140:143]
ds_read_b64_tr_b16 a[188:189], v193 offset:40960
v_mfma_f32_16x16x32_bf16 v[140:143], a[152:155], a[24:27], v[140:143]
buffer_load_dwordx4 a[40:43], v14, s[44:47], s65 offen offset:1024 sc1
v_mfma_f32_16x16x32_bf16 v[144:147], a[160:163], a[24:27], v[144:147]
s_waitcnt lgkmcnt(5)
ds_read_b64_tr_b16 a[190:191], v193 offset:45056
v_mfma_f32_16x16x32_bf16 v[144:147], a[164:167], a[28:31], v[144:147]
v_mfma_f32_16x16x32_bf16 v[112:115], a[164:167], a[20:23], v[112:115]
buffer_load_dwordx4 a[48:51], v15, s[44:47], s65 offen offset:0 sc1
v_mfma_f32_16x16x32_bf16 v[112:115], a[160:163], a[16:19], v[112:115]
ds_read_b64_tr_b16 a[192:193], v194 offset:32768
v_mfma_f32_16x16x32_bf16 v[80:83], a[160:163], a[8:11], v[80:83]
ds_read_b64_tr_b16 a[194:195], v194 offset:36864
v_mfma_f32_16x16x32_bf16 v[80:83], a[164:167], a[12:15], v[80:83]
ds_read_b64_tr_b16 a[196:197], v194 offset:40960
v_mfma_f32_16x16x32_bf16 v[48:51], a[164:167], a[4:7], v[48:51]
buffer_load_dwordx4 a[56:59], v15, s[44:47], s65 offen offset:1024 sc1
v_mfma_f32_16x16x32_bf16 v[48:51], a[160:163], a[0:3], v[48:51]
ds_read_b64_tr_b16 a[198:199], v194 offset:45056
v_mfma_f32_16x16x32_bf16 v[52:55], a[168:171], a[0:3], v[52:55]
s_add_u32 s65, s84, 139264
v_mfma_f32_16x16x32_bf16 v[52:55], a[172:175], a[4:7], v[52:55]
buffer_load_dwordx4 a[36:39], v14, s[44:47], s65 offen offset:0 sc1
v_mfma_f32_16x16x32_bf16 v[84:87], a[172:175], a[12:15], v[84:87]
ds_read_b64_tr_b16 a[200:201], v195 offset:32768
v_mfma_f32_16x16x32_bf16 v[84:87], a[168:171], a[8:11], v[84:87]
ds_read_b64_tr_b16 a[202:203], v195 offset:36864
v_mfma_f32_16x16x32_bf16 v[116:119], a[168:171], a[16:19], v[116:119]
buffer_load_dwordx4 a[44:47], v14, s[44:47], s65 offen offset:1024 sc1
v_mfma_f32_16x16x32_bf16 v[116:119], a[172:175], a[20:23], v[116:119]
ds_read_b64_tr_b16 a[204:205], v195 offset:40960
v_mfma_f32_16x16x32_bf16 v[148:151], a[172:175], a[28:31], v[148:151]
ds_read_b64_tr_b16 a[206:207], v195 offset:45056
v_mfma_f32_16x16x32_bf16 v[148:151], a[168:171], a[24:27], v[148:151]
v_mfma_f32_16x16x32_bf16 v[120:123], a[176:179], a[24:27], v[120:123]
s_waitcnt lgkmcnt(4)
buffer_load_dwordx4 a[52:55], v15, s[44:47], s65 offen offset:0 sc1
v_mfma_f32_16x16x32_bf16 v[120:123], a[180:183], a[28:31], v[120:123]
v_mfma_f32_16x16x32_bf16 v[88:91], a[180:183], a[20:23], v[88:91]
v_mfma_f32_16x16x32_bf16 v[88:91], a[176:179], a[16:19], v[88:91]
buffer_load_dwordx4 a[60:63], v15, s[44:47], s65 offen offset:1024 sc1
v_mfma_f32_16x16x32_bf16 v[56:59], a[176:179], a[8:11], v[56:59]
v_mfma_f32_16x16x32_bf16 v[56:59], a[180:183], a[12:15], v[56:59]
v_mfma_f32_16x16x32_bf16 v[24:27], a[180:183], a[4:7], v[24:27]
v_mfma_f32_16x16x32_bf16 v[24:27], a[176:179], a[0:3], v[24:27]
s_lshl3_add_u32 s85, s68, s85
v_mfma_f32_16x16x32_bf16 v[28:31], a[184:187], a[0:3], v[28:31]
s_waitcnt vmcnt(25)
s_barrier
v_mfma_f32_16x16x32_bf16 v[28:31], a[188:191], a[4:7], v[28:31]
ds_read_b64_tr_b16 a[144:145], v204 offset:0
v_mfma_f32_16x16x32_bf16 v[60:63], a[188:191], a[12:15], v[60:63]
ds_read_b64_tr_b16 a[146:147], v204 offset:4096
v_mfma_f32_16x16x32_bf16 v[60:63], a[184:187], a[8:11], v[60:63]
s_xor_b32 m0, s76, 131072
ds_read_b64_tr_b16 a[148:149], v204 offset:8192
v_mfma_f32_16x16x32_bf16 v[92:95], a[184:187], a[16:19], v[92:95]
s_xor_b32 s64, s85, 0
ds_read_b64_tr_b16 a[150:151], v204 offset:12288
v_mfma_f32_16x16x32_bf16 v[92:95], a[188:191], a[20:23], v[92:95]
buffer_load_dwordx4 v12, s[40:43], s64 offen lds
v_mfma_f32_16x16x32_bf16 v[124:127], a[188:191], a[28:31], v[124:127]
s_xor_b32 m0, s76, 132096
ds_read_b64_tr_b16 a[152:153], v205 offset:0
v_mfma_f32_16x16x32_bf16 v[124:127], a[184:187], a[24:27], v[124:127]
s_xor_b32 s64, s85, 8192
ds_read_b64_tr_b16 a[154:155], v205 offset:4096
v_mfma_f32_16x16x32_bf16 v[128:131], a[192:195], a[24:27], v[128:131]
buffer_load_dwordx4 v13, s[40:43], s64 offen lds
v_mfma_f32_16x16x32_bf16 v[128:131], a[196:199], a[28:31], v[128:131]
ds_read_b64_tr_b16 a[156:157], v205 offset:8192
v_mfma_f32_16x16x32_bf16 v[96:99], a[196:199], a[20:23], v[96:99]
s_xor_b32 m0, s76, 133120
ds_read_b64_tr_b16 a[158:159], v205 offset:12288
v_mfma_f32_16x16x32_bf16 v[96:99], a[192:195], a[16:19], v[96:99]
s_xor_b32 s64, s85, 16384
ds_read_b64_tr_b16 a[160:161], v206 offset:0
v_mfma_f32_16x16x32_bf16 v[64:67], a[192:195], a[8:11], v[64:67]
buffer_load_dwordx4 v12, s[40:43], s64 offen lds
v_mfma_f32_16x16x32_bf16 v[64:67], a[196:199], a[12:15], v[64:67]
ds_read_b64_tr_b16 a[162:163], v206 offset:4096
v_mfma_f32_16x16x32_bf16 v[32:35], a[196:199], a[4:7], v[32:35]
s_xor_b32 m0, s76, 134144
ds_read_b64_tr_b16 a[164:165], v206 offset:8192
v_mfma_f32_16x16x32_bf16 v[32:35], a[192:195], a[0:3], v[32:35]
s_waitcnt lgkmcnt(5)
s_xor_b32 s64, s85, 24576
ds_read_b64_tr_b16 a[166:167], v206 offset:12288
v_mfma_f32_16x16x32_bf16 v[36:39], a[200:203], a[0:3], v[36:39]
buffer_load_dwordx4 v13, s[40:43], s64 offen lds
v_mfma_f32_16x16x32_bf16 v[36:39], a[204:207], a[4:7], v[36:39]
v_mfma_f32_16x16x32_bf16 v[68:71], a[204:207], a[12:15], v[68:71]
s_xor_b32 m0, s76, 135168
v_mfma_f32_16x16x32_bf16 v[68:71], a[200:203], a[8:11], v[68:71]
s_xor_b32 s64, s85, 32768
v_mfma_f32_16x16x32_bf16 v[100:103], a[200:203], a[16:19], v[100:103]
buffer_load_dwordx4 v12, s[40:43], s64 offen lds
v_mfma_f32_16x16x32_bf16 v[100:103], a[204:207], a[20:23], v[100:103]
v_mfma_f32_16x16x32_bf16 v[132:135], a[204:207], a[28:31], v[132:135]
v_mfma_f32_16x16x32_bf16 v[132:135], a[200:203], a[24:27], v[132:135]
s_waitcnt vmcnt(26)
v_mfma_f32_16x16x32_bf16 v[136:139], a[144:147], a[88:91], v[136:139]
s_waitcnt vmcnt(22)
s_xor_b32 m0, s76, 136192
ds_read_b64_tr_b16 a[168:169], v207 offset:0
v_mfma_f32_16x16x32_bf16 v[136:139], a[148:151], a[92:95], v[136:139]
s_xor_b32 s64, s85, 40960
ds_read_b64_tr_b16 a[170:171], v207 offset:4096
v_mfma_f32_16x16x32_bf16 v[104:107], a[148:151], a[84:87], v[104:107]
buffer_load_dwordx4 v13, s[40:43], s64 offen lds
v_mfma_f32_16x16x32_bf16 v[104:107], a[144:147], a[80:83], v[104:107]
ds_read_b64_tr_b16 a[172:173], v207 offset:8192
v_mfma_f32_16x16x32_bf16 v[72:75], a[144:147], a[72:75], v[72:75]
ds_read_b64_tr_b16 a[174:175], v207 offset:12288
v_mfma_f32_16x16x32_bf16 v[72:75], a[148:151], a[76:79], v[72:75]
ds_read_b64_tr_b16 a[176:177], v200 offset:0
v_mfma_f32_16x16x32_bf16 v[40:43], a[148:151], a[68:71], v[40:43]
ds_read_b64_tr_b16 a[178:179], v200 offset:4096
v_mfma_f32_16x16x32_bf16 v[40:43], a[144:147], a[64:67], v[40:43]
ds_read_b64_tr_b16 a[180:181], v200 offset:8192
v_mfma_f32_16x16x32_bf16 v[44:47], a[152:155], a[64:67], v[44:47]
s_waitcnt lgkmcnt(6)
s_xor_b32 m0, s76, 137216
ds_read_b64_tr_b16 a[182:183], v200 offset:12288
v_mfma_f32_16x16x32_bf16 v[44:47], a[156:159], a[68:71], v[44:47]
s_xor_b32 s64, s85, 49152
v_mfma_f32_16x16x32_bf16 v[76:79], a[156:159], a[76:79], v[76:79]
buffer_load_dwordx4 v12, s[40:43], s64 offen lds
v_mfma_f32_16x16x32_bf16 v[76:79], a[152:155], a[72:75], v[76:79]
ds_read_b64_tr_b16 a[184:185], v201 offset:0
v_mfma_f32_16x16x32_bf16 v[108:111], a[152:155], a[80:83], v[108:111]
ds_read_b64_tr_b16 a[186:187], v201 offset:4096
v_mfma_f32_16x16x32_bf16 v[108:111], a[156:159], a[84:87], v[108:111]
ds_read_b64_tr_b16 a[188:189], v201 offset:8192
v_mfma_f32_16x16x32_bf16 v[140:143], a[156:159], a[92:95], v[140:143]
ds_read_b64_tr_b16 a[190:191], v201 offset:12288
v_mfma_f32_16x16x32_bf16 v[140:143], a[152:155], a[88:91], v[140:143]
v_mfma_f32_16x16x32_bf16 v[144:147], a[160:163], a[88:91], v[144:147]
v_mfma_f32_16x16x32_bf16 v[144:147], a[164:167], a[92:95], v[144:147]
s_xor_b32 m0, s76, 138240
v_mfma_f32_16x16x32_bf16 v[112:115], a[164:167], a[84:87], v[112:115]
s_xor_b32 s64, s85, 57344
ds_read_b64_tr_b16 a[192:193], v202 offset:0
v_mfma_f32_16x16x32_bf16 v[112:115], a[160:163], a[80:83], v[112:115]
buffer_load_dwordx4 v13, s[40:43], s64 offen lds
v_mfma_f32_16x16x32_bf16 v[80:83], a[160:163], a[72:75], v[80:83]
ds_read_b64_tr_b16 a[194:195], v202 offset:4096
v_mfma_f32_16x16x32_bf16 v[80:83], a[164:167], a[76:79], v[80:83]
ds_read_b64_tr_b16 a[196:197], v202 offset:8192
v_mfma_f32_16x16x32_bf16 v[48:51], a[164:167], a[68:71], v[48:51]
ds_read_b64_tr_b16 a[198:199], v202 offset:12288
v_mfma_f32_16x16x32_bf16 v[48:51], a[160:163], a[64:67], v[48:51]
s_waitcnt lgkmcnt(4)
v_mfma_f32_16x16x32_bf16 v[52:55], a[168:171], a[64:67], v[52:55]
v_mfma_f32_16x16x32_bf16 v[52:55], a[172:175], a[68:71], v[52:55]
v_mfma_f32_16x16x32_bf16 v[84:87], a[172:175], a[76:79], v[84:87]
ds_read_b64_tr_b16 a[200:201], v203 offset:0
v_mfma_f32_16x16x32_bf16 v[84:87], a[168:171], a[72:75], v[84:87]
ds_read_b64_tr_b16 a[202:203], v203 offset:4096
v_mfma_f32_16x16x32_bf16 v[116:119], a[168:171], a[80:83], v[116:119]
ds_read_b64_tr_b16 a[204:205], v203 offset:8192
v_mfma_f32_16x16x32_bf16 v[116:119], a[172:175], a[84:87], v[116:119]
ds_read_b64_tr_b16 a[206:207], v203 offset:12288
v_mfma_f32_16x16x32_bf16 v[148:151], a[172:175], a[92:95], v[148:151]
buffer_load_dword v19, off, s[52:55], s72 sc1
v_mfma_f32_16x16x32_bf16 v[148:151], a[168:171], a[88:91], v[148:151]
v_mfma_f32_16x16x32_bf16 v[120:123], a[176:179], a[88:91], v[120:123]
v_mfma_f32_16x16x32_bf16 v[120:123], a[180:183], a[92:95], v[120:123]
v_mfma_f32_16x16x32_bf16 v[88:91], a[180:183], a[84:87], v[88:91]
v_mfma_f32_16x16x32_bf16 v[88:91], a[176:179], a[80:83], v[88:91]
s_branch L_po25
L_pg25:
s_branch L_tr2
L_po25:
v_mfma_f32_16x16x32_bf16 v[56:59], a[176:179], a[72:75], v[56:59]
v_mfma_f32_16x16x32_bf16 v[56:59], a[180:183], a[76:79], v[56:59]
v_mfma_f32_16x16x32_bf16 v[24:27], a[180:183], a[68:71], v[24:27]
v_mfma_f32_16x16x32_bf16 v[24:27], a[176:179], a[64:67], v[24:27]
v_mfma_f32_16x16x32_bf16 v[28:31], a[184:187], a[64:67], v[28:31]
s_waitcnt vmcnt(17)
s_barrier
v_mfma_f32_16x16x32_bf16 v[28:31], a[188:191], a[68:71], v[28:31]
ds_read_b64_tr_b16 a[144:145], v188 offset:0
v_mfma_f32_16x16x32_bf16 v[60:63], a[188:191], a[76:79], v[60:63]
ds_read_b64_tr_b16 a[146:147], v188 offset:4096
v_mfma_f32_16x16x32_bf16 v[60:63], a[184:187], a[72:75], v[60:63]
s_xor_b32 m0, s76, 32768
ds_read_b64_tr_b16 a[148:149], v188 offset:8192
v_mfma_f32_16x16x32_bf16 v[92:95], a[184:187], a[80:83], v[92:95]
s_xor_b32 s64, s85, 262144
ds_read_b64_tr_b16 a[150:151], v188 offset:12288
v_mfma_f32_16x16x32_bf16 v[92:95], a[188:191], a[84:87], v[92:95]
buffer_load_dwordx4 v12, s[40:43], s64 offen lds
v_mfma_f32_16x16x32_bf16 v[124:127], a[188:191], a[92:95], v[124:127]
s_xor_b32 m0, s76, 33792
ds_read_b64_tr_b16 a[152:153], v189 offset:0
v_mfma_f32_16x16x32_bf16 v[124:127], a[184:187], a[88:91], v[124:127]
s_waitcnt lgkmcnt(5)
s_xor_b32 s64, s85, 270336
ds_read_b64_tr_b16 a[154:155], v189 offset:4096
v_mfma_f32_16x16x32_bf16 v[128:131], a[192:195], a[88:91], v[128:131]
buffer_load_dwordx4 v13, s[40:43], s64 offen lds
v_mfma_f32_16x16x32_bf16 v[128:131], a[196:199], a[92:95], v[128:131]
s_xor_b32 m0, s76, 34816
ds_read_b64_tr_b16 a[156:157], v189 offset:8192
v_mfma_f32_16x16x32_bf16 v[96:99], a[196:199], a[84:87], v[96:99]
s_xor_b32 s64, s85, 278528
ds_read_b64_tr_b16 a[158:159], v189 offset:12288
v_mfma_f32_16x16x32_bf16 v[96:99], a[192:195], a[80:83], v[96:99]
buffer_load_dwordx4 v12, s[40:43], s64 offen lds
v_mfma_f32_16x16x32_bf16 v[64:67], a[192:195], a[72:75], v[64:67]
s_xor_b32 m0, s76, 35840
ds_read_b64_tr_b16 a[160:161], v190 offset:0
v_mfma_f32_16x16x32_bf16 v[64:67], a[196:199], a[76:79], v[64:67]
s_xor_b32 s64, s85, 286720
ds_read_b64_tr_b16 a[162:163], v190 offset:4096
v_mfma_f32_16x16x32_bf16 v[32:35], a[196:199], a[68:71], v[32:35]
buffer_load_dwordx4 v13, s[40:43], s64 offen lds
v_mfma_f32_16x16x32_bf16 v[32:35], a[192:195], a[64:67], v[32:35]
s_xor_b32 m0, s76, 36864
ds_read_b64_tr_b16 a[164:165], v190 offset:8192
v_mfma_f32_16x16x32_bf16 v[36:39], a[200:203], a[64:67], v[36:39]
s_xor_b32 s64, s85, 294912
ds_read_b64_tr_b16 a[166:167], v190 offset:12288
v_mfma_f32_16x16x32_bf16 v[36:39], a[204:207], a[68:71], v[36:39]
buffer_load_dwordx4 v12, s[40:43], s64 offen lds
v_mfma_f32_16x16x32_bf16 v[68:71], a[204:207], a[76:79], v[68:71]
s_xor_b32 m0, s76, 37888
v_mfma_f32_16x16x32_bf16 v[68:71], a[200:203], a[72:75], v[68:71]
s_xor_b32 s64, s85, 303104
v_mfma_f32_16x16x32_bf16 v[100:103], a[200:203], a[80:83], v[100:103]
buffer_load_dwordx4 v13, s[40:43], s64 offen lds
v_mfma_f32_16x16x32_bf16 v[100:103], a[204:207], a[84:87], v[100:103]
v_mfma_f32_16x16x32_bf16 v[132:135], a[204:207], a[92:95], v[132:135]
v_mfma_f32_16x16x32_bf16 v[132:135], a[200:203], a[88:91], v[132:135]
s_waitcnt vmcnt(19)
s_waitcnt lgkmcnt(1)
v_mfma_f32_16x16x32_bf16 v[136:139], a[144:147], a[56:59], v[136:139]
s_waitcnt vmcnt(6)
v_readfirstlane_b32 vcc_lo, v19
s_nop 0
s_cmp_lt_u32 vcc_lo, 8
s_cbranch_scc1 L_spin_3019
L_spinbk_3020:
s_sub_u32 s84, s84, 1048576
s_add_u32 s84, s84, s69
v_mfma_f32_16x16x32_bf16 v[136:139], a[148:151], a[60:63], v[136:139]
s_xor_b32 s65, s84, 0
ds_read_b64_tr_b16 a[168:169], v191 offset:0
v_mfma_f32_16x16x32_bf16 v[104:107], a[148:151], a[52:55], v[104:107]
buffer_load_dwordx4 a[208:211], v14, s[44:47], s65 offen offset:0 sc1
v_mfma_f32_16x16x32_bf16 v[104:107], a[144:147], a[48:51], v[104:107]
ds_read_b64_tr_b16 a[170:171], v191 offset:4096
v_mfma_f32_16x16x32_bf16 v[72:75], a[144:147], a[40:43], v[72:75]
buffer_load_dwordx4 a[216:219], v14, s[44:47], s65 offen offset:1024 sc1
v_mfma_f32_16x16x32_bf16 v[72:75], a[148:151], a[44:47], v[72:75]
ds_read_b64_tr_b16 a[172:173], v191 offset:8192
v_mfma_f32_16x16x32_bf16 v[40:43], a[148:151], a[36:39], v[40:43]
buffer_load_dwordx4 a[224:227], v15, s[44:47], s65 offen offset:0 sc1
v_mfma_f32_16x16x32_bf16 v[40:43], a[144:147], a[32:35], v[40:43]
ds_read_b64_tr_b16 a[174:175], v191 offset:12288
v_mfma_f32_16x16x32_bf16 v[44:47], a[152:155], a[32:35], v[44:47]
buffer_load_dwordx4 a[232:235], v15, s[44:47], s65 offen offset:1024 sc1
v_mfma_f32_16x16x32_bf16 v[44:47], a[156:159], a[36:39], v[44:47]
s_xor_b32 s65, s84, 8192
ds_read_b64_tr_b16 a[176:177], v184 offset:0
v_mfma_f32_16x16x32_bf16 v[76:79], a[156:159], a[44:47], v[76:79]
buffer_load_dwordx4 a[212:215], v14, s[44:47], s65 offen offset:0 sc1
v_mfma_f32_16x16x32_bf16 v[76:79], a[152:155], a[40:43], v[76:79]
ds_read_b64_tr_b16 a[178:179], v184 offset:4096
v_mfma_f32_16x16x32_bf16 v[108:111], a[152:155], a[48:51], v[108:111]
buffer_load_dwordx4 a[220:223], v14, s[44:47], s65 offen offset:1024 sc1
v_mfma_f32_16x16x32_bf16 v[108:111], a[156:159], a[52:55], v[108:111]
ds_read_b64_tr_b16 a[180:181], v184 offset:8192
v_mfma_f32_16x16x32_bf16 v[140:143], a[156:159], a[60:63], v[140:143]
buffer_load_dwordx4 a[228:231], v15, s[44:47], s65 offen offset:0 sc1
v_mfma_f32_16x16x32_bf16 v[140:143], a[152:155], a[56:59], v[140:143]
ds_read_b64_tr_b16 a[182:183], v184 offset:12288
v_mfma_f32_16x16x32_bf16 v[144:147], a[160:163], a[56:59], v[144:147]
s_waitcnt lgkmcnt(4)
buffer_load_dwordx4 a[236:239], v15, s[44:47], s65 offen offset:1024 sc1
v_mfma_f32_16x16x32_bf16 v[144:147], a[164:167], a[60:63], v[144:147]
s_xor_b32 m0, s76, 38912
s_xor_b32 s64, s85, 311296
ds_read_b64_tr_b16 a[184:185], v185 offset:0
v_mfma_f32_16x16x32_bf16 v[112:115], a[164:167], a[52:55], v[112:115]
buffer_load_dwordx4 v12, s[40:43], s64 offen lds
v_mfma_f32_16x16x32_bf16 v[112:115], a[160:163], a[48:51], v[112:115]
s_xor_b32 m0, s76, 39936
s_xor_b32 s64, s85, 319488
ds_read_b64_tr_b16 a[186:187], v185 offset:4096
v_mfma_f32_16x16x32_bf16 v[80:83], a[160:163], a[40:43], v[80:83]
buffer_load_dwordx4 v13, s[40:43], s64 offen lds
v_mfma_f32_16x16x32_bf16 v[80:83], a[164:167], a[44:47], v[80:83]
s_xor_b32 s65, s84, 32768
ds_read_b64_tr_b16 a[188:189], v185 offset:8192
v_mfma_f32_16x16x32_bf16 v[48:51], a[164:167], a[36:39], v[48:51]
buffer_load_dwordx4 v[152:155], v14, s[44:47], s65 offen offset:0 sc1
v_mfma_f32_16x16x32_bf16 v[48:51], a[160:163], a[32:35], v[48:51]
ds_read_b64_tr_b16 a[190:191], v185 offset:12288
v_mfma_f32_16x16x32_bf16 v[52:55], a[168:171], a[32:35], v[52:55]
buffer_load_dwordx4 v[160:163], v14, s[44:47], s65 offen offset:1024 sc1
v_mfma_f32_16x16x32_bf16 v[52:55], a[172:175], a[36:39], v[52:55]
ds_read_b64_tr_b16 a[192:193], v186 offset:0
v_mfma_f32_16x16x32_bf16 v[84:87], a[172:175], a[44:47], v[84:87]
buffer_load_dwordx4 v[168:171], v15, s[44:47], s65 offen offset:0 sc1
v_mfma_f32_16x16x32_bf16 v[84:87], a[168:171], a[40:43], v[84:87]
ds_read_b64_tr_b16 a[194:195], v186 offset:4096
v_mfma_f32_16x16x32_bf16 v[116:119], a[168:171], a[48:51], v[116:119]
buffer_load_dwordx4 v[176:179], v15, s[44:47], s65 offen offset:1024 sc1
v_mfma_f32_16x16x32_bf16 v[116:119], a[172:175], a[52:55], v[116:119]
s_xor_b32 s65, s84, 40960
ds_read_b64_tr_b16 a[196:197], v186 offset:8192
v_mfma_f32_16x16x32_bf16 v[148:151], a[172:175], a[60:63], v[148:151]
buffer_load_dwordx4 v[156:159], v14, s[44:47], s65 offen offset:0 sc1
v_mfma_f32_16x16x32_bf16 v[148:151], a[168:171], a[56:59], v[148:151]
s_waitcnt lgkmcnt(3)
ds_read_b64_tr_b16 a[198:199], v186 offset:12288
v_mfma_f32_16x16x32_bf16 v[120:123], a[176:179], a[56:59], v[120:123]
buffer_load_dwordx4 v[164:167], v14, s[44:47], s65 offen offset:1024 sc1
v_mfma_f32_16x16x32_bf16 v[120:123], a[180:183], a[60:63], v[120:123]
ds_read_b64_tr_b16 a[200:201], v187 offset:0
v_mfma_f32_16x16x32_bf16 v[88:91], a[180:183], a[52:55], v[88:91]
buffer_load_dwordx4 v[172:175], v15, s[44:47], s65 offen offset:0 sc1
v_mfma_f32_16x16x32_bf16 v[88:91], a[176:179], a[48:51], v[88:91]
ds_read_b64_tr_b16 a[202:203], v187 offset:4096
v_mfma_f32_16x16x32_bf16 v[56:59], a[176:179], a[40:43], v[56:59]
buffer_load_dwordx4 v[180:183], v15, s[44:47], s65 offen offset:1024 sc1
v_mfma_f32_16x16x32_bf16 v[56:59], a[180:183], a[44:47], v[56:59]
ds_read_b64_tr_b16 a[204:205], v187 offset:8192
v_mfma_f32_16x16x32_bf16 v[24:27], a[180:183], a[36:39], v[24:27]
ds_read_b64_tr_b16 a[206:207], v187 offset:12288
v_mfma_f32_16x16x32_bf16 v[24:27], a[176:179], a[32:35], v[24:27]
v_mfma_f32_16x16x32_bf16 v[28:31], a[184:187], a[32:35], v[28:31]
s_barrier
v_mfma_f32_16x16x32_bf16 v[28:31], a[188:191], a[36:39], v[28:31]
ds_read_b64_tr_b16 a[144:145], v188 offset:32768
v_mfma_f32_16x16x32_bf16 v[60:63], a[188:191], a[44:47], v[60:63]
ds_read_b64_tr_b16 a[146:147], v188 offset:36864
v_mfma_f32_16x16x32_bf16 v[60:63], a[184:187], a[40:43], v[60:63]
s_xor_b32 m0, s76, 65536
ds_read_b64_tr_b16 a[148:149], v188 offset:40960
v_mfma_f32_16x16x32_bf16 v[92:95], a[184:187], a[48:51], v[92:95]
s_xor_b32 s64, s85, 524288
ds_read_b64_tr_b16 a[150:151], v188 offset:45056
v_mfma_f32_16x16x32_bf16 v[92:95], a[188:191], a[52:55], v[92:95]
buffer_load_dwordx4 v12, s[40:43], s64 offen lds
v_mfma_f32_16x16x32_bf16 v[124:127], a[188:191], a[60:63], v[124:127]
s_xor_b32 m0, s76, 66560
ds_read_b64_tr_b16 a[152:153], v189 offset:32768
v_mfma_f32_16x16x32_bf16 v[124:127], a[184:187], a[56:59], v[124:127]
s_waitcnt lgkmcnt(5)
s_xor_b32 s64, s85, 532480
ds_read_b64_tr_b16 a[154:155], v189 offset:36864
v_mfma_f32_16x16x32_bf16 v[128:131], a[192:195], a[56:59], v[128:131]
buffer_load_dwordx4 v13, s[40:43], s64 offen lds
v_mfma_f32_16x16x32_bf16 v[128:131], a[196:199], a[60:63], v[128:131]
ds_read_b64_tr_b16 a[156:157], v189 offset:40960
v_mfma_f32_16x16x32_bf16 v[96:99], a[196:199], a[52:55], v[96:99]
s_xor_b32 m0, s76, 67584
ds_read_b64_tr_b16 a[158:159], v189 offset:45056
v_mfma_f32_16x16x32_bf16 v[96:99], a[192:195], a[48:51], v[96:99]
s_xor_b32 s64, s85, 540672
ds_read_b64_tr_b16 a[160:161], v190 offset:32768
v_mfma_f32_16x16x32_bf16 v[64:67], a[192:195], a[40:43], v[64:67]
buffer_load_dwordx4 v12, s[40:43], s64 offen lds
v_mfma_f32_16x16x32_bf16 v[64:67], a[196:199], a[44:47], v[64:67]
ds_read_b64_tr_b16 a[162:163], v190 offset:36864
v_mfma_f32_16x16x32_bf16 v[32:35], a[196:199], a[36:39], v[32:35]
s_xor_b32 m0, s76, 68608
ds_read_b64_tr_b16 a[164:165], v190 offset:40960
v_mfma_f32_16x16x32_bf16 v[32:35], a[192:195], a[32:35], v[32:35]
s_xor_b32 s64, s85, 548864
ds_read_b64_tr_b16 a[166:167], v190 offset:45056
v_mfma_f32_16x16x32_bf16 v[36:39], a[200:203], a[32:35], v[36:39]
buffer_load_dwordx4 v13, s[40:43], s64 offen lds
v_mfma_f32_16x16x32_bf16 v[36:39], a[204:207], a[36:39], v[36:39]
v_mfma_f32_16x16x32_bf16 v[68:71], a[204:207], a[44:47], v[68:71]
s_xor_b32 m0, s76, 69632
v_mfma_f32_16x16x32_bf16 v[68:71], a[200:203], a[40:43], v[68:71]
s_xor_b32 s64, s85, 557056
v_mfma_f32_16x16x32_bf16 v[100:103], a[200:203], a[48:51], v[100:103]
buffer_load_dwordx4 v12, s[40:43], s64 offen lds
v_mfma_f32_16x16x32_bf16 v[100:103], a[204:207], a[52:55], v[100:103]
s_mov_b32 s70, 3
s_mov_b32 s73, 2
v_mfma_f32_16x16x32_bf16 v[132:135], a[204:207], a[60:63], v[132:135]
v_mfma_f32_16x16x32_bf16 v[132:135], a[200:203], a[56:59], v[132:135]
s_branch L_p5join
L_spin_4022:
s_mov_b32 vcc_hi, 0x80000
L_spinlp_4024:
s_sleep 1
buffer_load_dword v19, off, s[52:55], s72 offset:128 sc1
s_waitcnt vmcnt(0)
v_readfirstlane_b32 vcc_lo, v19
s_sub_u32 vcc_hi, vcc_hi, 1
s_cbranch_scc1 L_spinbk_4023
s_cmp_lt_u32 vcc_lo, s74
s_cbranch_scc1 L_spinlp_4024
s_branch L_spinbk_4023
L_codeend:
.section .rodata,"a"
.p2align 6
.amdhsa_kernel gated_mix__compressed_kv_cla__sliding_local_dilated__prompt_kernel
  .amdhsa_next_free_vgpr 512
  .amdhsa_next_free_sgpr 102
  .amdhsa_accum_offset 256
  .amdhsa_group_segment_fixed_size 0
  .amdhsa_kernarg_size 104
  .amdhsa_user_sgpr_count 2
  .amdhsa_user_sgpr_kernarg_segment_ptr 1
  .amdhsa_system_sgpr_workgroup_id_x 1
.end_amdhsa_kernel
```

```asm
; @launch grid=(256,1,1) block=(256,1,1) lds=163840
.amdgcn_target "amdgcn-amd-amdhsa--gfx950"
.text
.globl gated_mix__compressed_kv_cla__sliding_local_dilated__prompt_kernel
.p2align 8
.type gated_mix__compressed_kv_cla__sliding_local_dilated__prompt_kernel,@function
gated_mix__compressed_kv_cla__sliding_local_dilated__prompt_kernel:
s_cmp_ge_u32 s2, 256
s_cbranch_scc1 L_end
s_load_dwordx16 s[4:19], s[0:1], 0
s_load_dwordx8 s[20:27], s[0:1], 64
s_load_dwordx2 s[28:29], s[0:1], 96
s_getpc_b64 s[88:89]
L_pc:
v_lshrrev_b32 v1, 6, v0
s_lshr_b32 s67, s2, 3
v_lshl_add_u32 v24, s67, 2, v1
s_mov_b32 s90, L_codeend-L_pc
s_mov_b32 s91, 0x20000
v_and_b32 v25, 7, v0
v_lshlrev_b32 v25, 7, v25
v_lshl_add_u32 v24, v24, 10, v25
buffer_load_dword a252, v24, s[88:91], 0 offen
v_and_b32 v0, 63, v0
v_readfirstlane_b32 s30, v1
v_lshrrev_b32 v24, 3, v0
v_lshrrev_b32 v25, 4, v0
v_and_b32 v26, 7, v0
v_xor_b32 v26, v26, v25
v_lshlrev_b32 v26, 4, v26
v_lshl_add_u32 v12, v24, 10, v26
v_xor_b32 v13, 64, v12
v_bfe_u32 v26, v0, 1, 3
v_xor_b32 v26, v26, v25
v_lshlrev_b32 v26, 5, v26
v_and_b32 v24, 1, v0
v_lshl_add_u32 v26, v24, 4, v26
v_lshl_add_u32 v14, v25, 13, v26
v_xor_b32 v15, 128, v14
s_and_b32 s66, s2, 7
s_and_b32 s68, s67, 3
s_lshl2_add_u32 s31, s66, s68
s_cmp_eq_u32 s68, 0
s_cselect_b32 s90, s90, 0
s_lshr_b32 s3, s67, 2
s_lshl2_add_u32 s80, s67, s30
s_lshl_b32 s70, s3, 18
s_lshl_b32 s66, s30, 16
s_add_u32 s70, s70, s66
s_lshl_b32 s71, s30, 17
s_lshl_b32 s66, s31, 8
s_add_u32 s71, s71, s66
s_lshl_b32 s76, s30, 13
s_lshl_b32 s77, s30, 12
s_lshl_b32 s78, s30, 10
s_cmp_eq_u32 s30, 0
s_cbranch_scc1 L_pg1
s_cmp_eq_u32 s30, 1
s_cbranch_scc1 L_tr9
s_cmp_eq_u32 s30, 2
s_cbranch_scc1 L_tr9
s_branch L_tr9
L_tr9:
s_waitcnt lgkmcnt(0)
s_mov_b32 s32, s6
s_mov_b32 s33, s7
s_mov_b32 s34, 2097152
s_mov_b32 s35, 0x20000
s_mov_b32 s36, s10
s_mov_b32 s37, s11
s_mov_b32 s38, 4194304
s_mov_b32 s39, 0x20000
s_mov_b32 s40, s12
s_mov_b32 s41, s13
s_mov_b32 s42, 4194304
s_mov_b32 s43, 0x20000
s_xor_b32 m0, s76, 0
s_xor_b32 s64, s70, 0
buffer_load_dwordx4 v12, s[32:35], s64 offen lds
s_xor_b32 m0, s76, 1024
s_xor_b32 s64, s70, 8192
buffer_load_dwordx4 v13, s[32:35], s64 offen lds
s_xor_b32 m0, s76, 2048
s_xor_b32 s64, s70, 16384
buffer_load_dwordx4 v12, s[32:35], s64 offen lds
s_xor_b32 m0, s76, 3072
s_xor_b32 s64, s70, 24576
buffer_load_dwordx4 v13, s[32:35], s64 offen lds
s_xor_b32 m0, s77, 65536
s_xor_b32 s64, s71, 0
buffer_load_dwordx4 v14, s[36:39], s64 offen lds
s_xor_b32 m0, s77, 66560
s_xor_b32 s64, s71, 32768
buffer_load_dwordx4 v14, s[36:39], s64 offen lds
s_xor_b32 m0, s77, 67584
s_xor_b32 s64, s71, 65536
buffer_load_dwordx4 v15, s[36:39], s64 offen lds
s_xor_b32 m0, s77, 68608
s_xor_b32 s64, s71, 98304
buffer_load_dwordx4 v15, s[36:39], s64 offen lds
s_mov_b32 s44, s28
s_mov_b32 s45, s29
s_mov_b32 s46, 134217728
s_mov_b32 s47, 0x20000
s_mov_b32 s48, s4
s_mov_b32 s49, s5
s_mov_b32 s50, 4194304
s_mov_b32 s51, 0x20000
s_mov_b32 s52, s26
s_mov_b32 s53, s27
s_mov_b32 s54, 256
s_mov_b32 s55, 0x20000
s_mov_b32 s56, s8
s_mov_b32 s57, s9
s_mov_b32 s58, 8388608
s_mov_b32 s59, 0x20000
s_mov_b32 s60, s18
s_mov_b32 s61, s19
s_mov_b32 s62, 6291456
s_mov_b32 s63, 0x20000
v_accvgpr_write_b32 a251, 1
v_and_b32 v24, 15, v0
v_lshrrev_b32 v26, 1, v24
v_xor_b32 v26, v26, v25
v_lshlrev_b32 v26, 4, v26
v_lshl_add_u32 v26, v24, 7, v26
v_add_u32 v2, s76, v26
v_xor_b32 v3, 64, v2
v_bfe_u32 v24, v0, 2, 2
v_lshl_add_u32 v27, v25, 3, v24
v_and_b32 v1, 3, v0
v_cmp_eq_u32 vcc, 0, v1
v_lshlrev_b32 v1, 3, v1
v_lshl_add_u32 v26, v27, 8, v1
v_add_u32 v26, 65536, v26
v_and_b32 v1, 1, v25
v_lshl_add_u32 v24, v1, 2, v24
v_lshlrev_b32 v16, 4, v0
v_mov_b32 v28, 0x3f803f80
v_cndmask_b32 v28, 0, v28, vcc
v_accvgpr_write_b32 a244, v28
v_accvgpr_write_b32 a245, v28
v_accvgpr_write_b32 a246, v28
v_accvgpr_write_b32 a247, v28
v_xor_b32 v1, 0, v24
v_lshl_add_u32 v4, v1, 5, v26
v_xor_b32 v1, 1, v24
v_lshl_add_u32 v5, v1, 5, v26
v_xor_b32 v1, 2, v24
v_lshl_add_u32 v6, v1, 5, v26
v_xor_b32 v1, 3, v24
v_lshl_add_u32 v7, v1, 5, v26
v_xor_b32 v1, 4, v24
v_lshl_add_u32 v8, v1, 5, v26
v_xor_b32 v1, 5, v24
v_lshl_add_u32 v9, v1, 5, v26
v_xor_b32 v1, 6, v24
v_lshl_add_u32 v10, v1, 5, v26
v_xor_b32 v1, 7, v24
v_lshl_add_u32 v11, v1, 5, v26
s_sub_u32 s16, 15, s3
s_lshl_b32 s72, s3, 18
s_lshl_b32 s73, s16, 18
s_cmp_lt_u32 s30, 2
s_cselect_b32 s67, s3, s16
s_lshl4_add_u32 s74, s31, s67
s_and_b32 s66, s30, 1
s_lshl1_add_u32 s74, s74, s66
s_lshl_b32 s74, s74, 10
s_add_u32 s74, s74, 60817408
s_lshl_b32 s66, s30, 15
s_add_u32 s72, s72, s66
s_add_u32 s73, s73, s66
s_mul_i32 s75, s30, 98304
s_lshl_b32 s66, s31, 6
s_add_u32 s75, s75, s66
s_lshl_b32 s79, s31, 20
s_lshl_b32 s66, s3, 17
s_add_u32 s79, s79, s66
s_lshl_b32 s66, s30, 15
s_add_u32 s79, s79, s66
v_bfe_u32 v23, v0, 1, 1
v_lshrrev_b32 v1, 5, v0
v_xor_b32 v23, v23, v1
v_lshlrev_b32 v23, 5, v23
v_and_b32 v1, 1, v0
v_lshl_add_u32 v23, v1, 4, v23
v_lshrrev_b32 v1, 2, v0
v_mul_u32_u24 v1, 6144, v1
v_add_u32 v23, v1, v23
s_lshl_b32 s81, s80, 13
s_and_b32 s67, s2, 7
s_lshl_b32 s82, s67, 8
s_add_u32 s82, s82, s81
s_lshl_b32 s67, s67, 10
s_add_u32 s81, s81, s67
s_add_u32 s83, s81, 1048576
v_mul_u32_u24 v1, 1792, v25
v_add_u32 v1, v1, v16
s_lshl_b32 s68, s2, 3
s_lshl1_add_u32 s68, s30, s68
v_lshrrev_b32 v18, 5, v0
v_add_u32 v18, s68, v18
v_and_b32 v19, 31, v0
v_lshlrev_b32 v19, 4, v19
v_lshl_add_u32 v18, v18, 11, v19
v_mov_b32 v21, 0
v_min_u32 v20, 1, v0
v_lshlrev_b32 v20, 30, v20
v_accvgpr_write_b32 a240, -1
v_accvgpr_write_b32 a241, -1
v_accvgpr_write_b32 a242, -1
v_accvgpr_write_b32 a243, -1
s_lshr_b32 s69, s2, 7
s_or_b32 s69, s69, s30
s_lshl_b32 s69, s69, 21
s_add_u32 s69, s69, s2
s_lshl_b32 s69, s69, 7
s_add_u32 s69, s69, 59768832
s_cmp_eq_u32 s30, 0
s_cbranch_scc1 L_pg2
s_cmp_eq_u32 s30, 1
s_cbranch_scc1 L_pg3
s_cmp_eq_u32 s30, 2
s_cbranch_scc1 L_pg4
s_branch L_pg5
L_tr0:
s_branch L_base
.p2align 12
L_pg1:
s_branch L_tr9
L_base:
s_xor_b32 m0, s76, 4096
s_xor_b32 s64, s70, 32768
buffer_load_dwordx4 v12, s[32:35], s64 offen lds
s_xor_b32 m0, s76, 5120
s_xor_b32 s64, s70, 40960
buffer_load_dwordx4 v13, s[32:35], s64 offen lds
s_xor_b32 m0, s76, 6144
s_xor_b32 s64, s70, 49152
buffer_load_dwordx4 v12, s[32:35], s64 offen lds
s_xor_b32 m0, s76, 7168
s_xor_b32 s64, s70, 57344
buffer_load_dwordx4 v13, s[32:35], s64 offen lds
s_xor_b32 m0, s77, 81920
s_xor_b32 s64, s71, 0
buffer_load_dwordx4 v14, s[40:43], s64 offen lds
s_xor_b32 m0, s77, 82944
s_xor_b32 s64, s71, 32768
buffer_load_dwordx4 v14, s[40:43], s64 offen lds
s_xor_b32 m0, s77, 83968
s_xor_b32 s64, s71, 65536
buffer_load_dwordx4 v15, s[40:43], s64 offen lds
s_xor_b32 m0, s77, 84992
s_xor_b32 s64, s71, 98304
buffer_load_dwordx4 v15, s[40:43], s64 offen lds
s_and_b32 s66, s31, 3
s_lshl_b32 s67, s66, 11
s_add_u32 s84, s76, s67
s_lshl3_add_u32 s70, s67, s70
s_and_b32 s67, s66, 1
s_lshl_b32 s67, s67, 17
s_add_u32 s72, s72, s67
s_add_u32 s67, s73, s67
s_bitcmp1_b32 s66, 1
s_cselect_b32 s73, s72, s67
s_cselect_b32 s72, s67, s72
s_and_b32 s66, s3, 3
s_lshl_b32 s67, s66, 10
s_add_u32 s77, s77, s67
s_lshl_b32 s67, s66, 15
s_add_u32 s71, s71, s67
s_and_b32 s67, s66, 2
s_lshl_b32 s67, s67, 6
v_xor_b32 v14, s67, v14
v_xor_b32 v15, s67, v15
s_and_b32 s66, s3, 4
s_cselect_b64 s[36:37], s[12:13], s[10:11]
s_cselect_b64 s[40:41], s[10:11], s[12:13]
s_lshl_b32 s66, s66, 12
s_add_u32 s77, s77, s66
s_waitcnt vmcnt(8)
s_barrier
ds_read_b128 a[0:3], v2 offset:0
ds_read_b128 a[4:7], v3 offset:0
ds_read_b64_tr_b16 a[176:177], v4 offset:0
ds_read_b64_tr_b16 a[178:179], v4 offset:1024
ds_read_b64_tr_b16 a[180:181], v4 offset:8192
ds_read_b64_tr_b16 a[182:183], v4 offset:9216
ds_read_b128 a[8:11], v2 offset:2048
ds_read_b128 a[12:15], v3 offset:2048
ds_read_b64_tr_b16 a[184:185], v5 offset:0
ds_read_b64_tr_b16 a[186:187], v5 offset:1024
ds_read_b64_tr_b16 a[188:189], v5 offset:8192
ds_read_b64_tr_b16 a[190:191], v5 offset:9216
ds_read_b64_tr_b16 a[88:89], v6 offset:0
ds_read_b64_tr_b16 a[90:91], v6 offset:1024
ds_read_b64_tr_b16 a[92:93], v6 offset:8192
ds_read_b64_tr_b16 a[94:95], v6 offset:9216
s_waitcnt lgkmcnt(12)
v_mfma_f32_16x16x32_bf16 v[184:187], a[176:179], a[0:3], 0
s_waitcnt lgkmcnt(10)
s_xor_b32 m0, s77, 98304
ds_read_b64_tr_b16 a[96:97], v7 offset:0
v_mfma_f32_16x16x32_bf16 v[184:187], a[180:183], a[4:7], v[184:187]
s_waitcnt lgkmcnt(9)
s_xor_b32 s64, s71, 524288
ds_read_b64_tr_b16 a[98:99], v7 offset:1024
v_mfma_f32_16x16x32_bf16 v[192:195], a[180:183], a[12:15], 0
buffer_load_dwordx4 v14, s[36:39], s64 offen lds
v_mfma_f32_16x16x32_bf16 v[192:195], a[176:179], a[8:11], v[192:195]
s_waitcnt lgkmcnt(8)
ds_read_b64_tr_b16 a[100:101], v7 offset:8192
v_mfma_f32_16x16x32_bf16 v[196:199], a[184:187], a[8:11], 0
s_waitcnt lgkmcnt(7)
s_xor_b32 m0, s77, 99328
ds_read_b64_tr_b16 a[102:103], v7 offset:9216
v_mfma_f32_16x16x32_bf16 v[196:199], a[188:191], a[12:15], v[196:199]
s_xor_b32 s64, s71, 557056
ds_read_b64_tr_b16 a[104:105], v8 offset:0
v_mfma_f32_16x16x32_bf16 v[188:191], a[188:191], a[4:7], 0
buffer_load_dwordx4 v14, s[36:39], s64 offen lds
v_mfma_f32_16x16x32_bf16 v[188:191], a[184:187], a[0:3], v[188:191]
s_waitcnt lgkmcnt(7)
ds_read_b64_tr_b16 a[106:107], v8 offset:1024
v_mfma_f32_16x16x32_bf16 v[216:219], a[88:91], a[0:3], 0
s_waitcnt lgkmcnt(6)
s_xor_b32 m0, s77, 100352
ds_read_b64_tr_b16 a[108:109], v8 offset:8192
v_mfma_f32_16x16x32_bf16 v[216:219], a[92:95], a[4:7], v[216:219]
s_xor_b32 s64, s71, 589824
ds_read_b64_tr_b16 a[110:111], v8 offset:9216
v_mfma_f32_16x16x32_bf16 v[224:227], a[92:95], a[12:15], 0
buffer_load_dwordx4 v15, s[36:39], s64 offen lds
v_mfma_f32_16x16x32_bf16 v[224:227], a[88:91], a[8:11], v[224:227]
s_waitcnt lgkmcnt(6)
ds_read_b64_tr_b16 a[112:113], v9 offset:0
v_mfma_f32_16x16x32_bf16 v[228:231], a[96:99], a[8:11], 0
s_waitcnt lgkmcnt(5)
ds_read_b64_tr_b16 a[114:115], v9 offset:1024
v_mfma_f32_16x16x32_bf16 v[228:231], a[100:103], a[12:15], v[228:231]
s_xor_b32 m0, s77, 101376
ds_read_b64_tr_b16 a[116:117], v9 offset:8192
v_mfma_f32_16x16x32_bf16 v[220:223], a[100:103], a[4:7], 0
s_xor_b32 s64, s71, 622592
ds_read_b64_tr_b16 a[118:119], v9 offset:9216
v_mfma_f32_16x16x32_bf16 v[220:223], a[96:99], a[0:3], v[220:223]
s_waitcnt lgkmcnt(6)
buffer_load_dwordx4 v15, s[36:39], s64 offen lds
v_mfma_f32_16x16x32_bf16 v[152:155], a[104:107], a[0:3], 0
s_waitcnt lgkmcnt(4)
ds_read_b64_tr_b16 a[72:73], v10 offset:0
v_mfma_f32_16x16x32_bf16 v[152:155], a[108:111], a[4:7], v[152:155]
s_xor_b32 m0, s77, 114688
ds_read_b64_tr_b16 a[74:75], v10 offset:1024
v_mfma_f32_16x16x32_bf16 v[160:163], a[108:111], a[12:15], 0
s_xor_b32 s64, s71, 524288
ds_read_b64_tr_b16 a[76:77], v10 offset:8192
ds_read_b64_tr_b16 a[78:79], v10 offset:9216
v_mfma_f32_16x16x32_bf16 v[160:163], a[104:107], a[8:11], v[160:163]
s_waitcnt lgkmcnt(6)
buffer_load_dwordx4 v14, s[40:43], s64 offen lds
v_mfma_f32_16x16x32_bf16 v[164:167], a[112:115], a[8:11], 0
s_waitcnt lgkmcnt(4)
s_xor_b32 m0, s77, 115712
ds_read_b64_tr_b16 a[80:81], v11 offset:0
v_mfma_f32_16x16x32_bf16 v[164:167], a[116:119], a[12:15], v[164:167]
s_xor_b32 s64, s71, 557056
ds_read_b64_tr_b16 a[82:83], v11 offset:1024
v_mfma_f32_16x16x32_bf16 v[156:159], a[116:119], a[4:7], 0
ds_read_b64_tr_b16 a[84:85], v11 offset:8192
ds_read_b64_tr_b16 a[86:87], v11 offset:9216
s_waitcnt vmcnt(9)
v_mfma_f32_16x16x32_bf16 v[156:159], a[112:115], a[0:3], v[156:159]
s_waitcnt lgkmcnt(6)
buffer_load_dwordx4 v14, s[40:43], s64 offen lds
v_mfma_f32_16x16x32_bf16 v[24:27], a[72:75], a[0:3], 0
s_waitcnt lgkmcnt(4)
s_xor_b32 m0, s77, 116736
ds_read_b128 a[16:19], v2 offset:4096
ds_read_b128 a[20:23], v3 offset:4096
v_mfma_f32_16x16x32_bf16 v[24:27], a[76:79], a[4:7], v[24:27]
s_xor_b32 s64, s71, 589824
ds_read_b128 a[24:27], v2 offset:6144
ds_read_b128 a[28:31], v3 offset:6144
v_mfma_f32_16x16x32_bf16 v[40:43], a[76:79], a[12:15], 0
buffer_load_dwordx4 v15, s[40:43], s64 offen lds
v_mfma_f32_16x16x32_bf16 v[40:43], a[72:75], a[8:11], v[40:43]
s_waitcnt lgkmcnt(6)
v_mfma_f32_16x16x32_bf16 v[104:107], a[80:83], a[8:11], 0
s_waitcnt lgkmcnt(4)
s_xor_b32 m0, s77, 117760
v_mfma_f32_16x16x32_bf16 v[104:107], a[84:87], a[12:15], v[104:107]
s_xor_b32 s64, s71, 622592
v_mfma_f32_16x16x32_bf16 v[88:91], a[84:87], a[4:7], 0
buffer_load_dwordx4 v15, s[40:43], s64 offen lds
v_mfma_f32_16x16x32_bf16 v[88:91], a[80:83], a[0:3], v[88:91]
s_waitcnt lgkmcnt(3)
v_mfma_f32_16x16x32_bf16 v[232:235], a[88:91], a[16:19], 0
s_waitcnt lgkmcnt(2)
v_mfma_f32_16x16x32_bf16 v[232:235], a[92:95], a[20:23], v[232:235]
s_waitcnt lgkmcnt(0)
s_xor_b32 m0, s84, 32768
v_mfma_f32_16x16x32_bf16 v[240:243], a[92:95], a[28:31], 0
s_xor_b32 s64, s70, 128
v_mfma_f32_16x16x32_bf16 v[240:243], a[88:91], a[24:27], v[240:243]
buffer_load_dwordx4 v12, s[32:35], s64 offen lds
v_mfma_f32_16x16x32_bf16 v[244:247], a[96:99], a[24:27], 0
s_xor_b32 m0, s84, 33792
v_mfma_f32_16x16x32_bf16 v[244:247], a[100:103], a[28:31], v[244:247]
s_xor_b32 s64, s70, 8320
v_mfma_f32_16x16x32_bf16 v[236:239], a[100:103], a[20:23], 0
s_waitcnt vmcnt(9)
s_barrier
v_mfma_f32_16x16x32_bf16 v[236:239], a[96:99], a[16:19], v[236:239]
buffer_load_dwordx4 v13, s[32:35], s64 offen lds
v_mfma_f32_16x16x32_bf16 v[168:171], a[104:107], a[16:19], 0
ds_read_b64_tr_b16 a[88:89], v4 offset:16384
v_mfma_f32_16x16x32_bf16 v[168:171], a[108:111], a[20:23], v[168:171]
s_xor_b32 m0, s84, 34816
ds_read_b64_tr_b16 a[90:91], v4 offset:17408
v_mfma_f32_16x16x32_bf16 v[176:179], a[108:111], a[28:31], 0
s_xor_b32 s64, s70, 16512
ds_read_b64_tr_b16 a[92:93], v4 offset:24576
v_mfma_f32_16x16x32_bf16 v[176:179], a[104:107], a[24:27], v[176:179]
buffer_load_dwordx4 v12, s[32:35], s64 offen lds
v_mfma_f32_16x16x32_bf16 v[180:183], a[112:115], a[24:27], 0
ds_read_b64_tr_b16 a[94:95], v4 offset:25600
v_mfma_f32_16x16x32_bf16 v[180:183], a[116:119], a[28:31], v[180:183]
s_xor_b32 m0, s84, 35840
ds_read_b64_tr_b16 a[96:97], v5 offset:16384
v_mfma_f32_16x16x32_bf16 v[172:175], a[116:119], a[20:23], 0
s_xor_b32 s64, s70, 24704
ds_read_b64_tr_b16 a[98:99], v5 offset:17408
v_mfma_f32_16x16x32_bf16 v[172:175], a[112:115], a[16:19], v[172:175]
buffer_load_dwordx4 v13, s[32:35], s64 offen lds
v_mfma_f32_16x16x32_bf16 v[56:59], a[72:75], a[16:19], 0
ds_read_b64_tr_b16 a[100:101], v5 offset:24576
v_mfma_f32_16x16x32_bf16 v[56:59], a[76:79], a[20:23], v[56:59]
s_xor_b32 m0, s84, 36864
ds_read_b64_tr_b16 a[102:103], v5 offset:25600
v_mfma_f32_16x16x32_bf16 v[72:75], a[76:79], a[28:31], 0
s_xor_b32 s64, s70, 32896
ds_read_b64_tr_b16 a[104:105], v6 offset:16384
v_mfma_f32_16x16x32_bf16 v[72:75], a[72:75], a[24:27], v[72:75]
buffer_load_dwordx4 v12, s[32:35], s64 offen lds
v_mfma_f32_16x16x32_bf16 v[136:139], a[80:83], a[24:27], 0
ds_read_b64_tr_b16 a[106:107], v6 offset:17408
v_mfma_f32_16x16x32_bf16 v[136:139], a[84:87], a[28:31], v[136:139]
s_xor_b32 m0, s84, 37888
ds_read_b64_tr_b16 a[108:109], v6 offset:24576
v_mfma_f32_16x16x32_bf16 v[120:123], a[84:87], a[20:23], 0
s_xor_b32 s64, s70, 41088
ds_read_b64_tr_b16 a[110:111], v6 offset:25600
v_mfma_f32_16x16x32_bf16 v[120:123], a[80:83], a[16:19], v[120:123]
buffer_load_dwordx4 v13, s[32:35], s64 offen lds
v_mfma_f32_16x16x32_bf16 v[200:203], a[176:179], a[16:19], 0
ds_read_b64_tr_b16 a[112:113], v7 offset:16384
v_mfma_f32_16x16x32_bf16 v[200:203], a[180:183], a[20:23], v[200:203]
s_xor_b32 m0, s84, 38912
ds_read_b64_tr_b16 a[114:115], v7 offset:17408
v_mfma_f32_16x16x32_bf16 v[208:211], a[180:183], a[28:31], 0
s_xor_b32 s64, s70, 49280
ds_read_b64_tr_b16 a[116:117], v7 offset:24576
v_mfma_f32_16x16x32_bf16 v[208:211], a[176:179], a[24:27], v[208:211]
buffer_load_dwordx4 v12, s[32:35], s64 offen lds
v_mfma_f32_16x16x32_bf16 v[212:215], a[184:187], a[24:27], 0
ds_read_b64_tr_b16 a[118:119], v7 offset:25600
v_mfma_f32_16x16x32_bf16 v[212:215], a[188:191], a[28:31], v[212:215]
s_xor_b32 m0, s84, 39936
ds_read_b64_tr_b16 a[72:73], v8 offset:16384
v_mfma_f32_16x16x32_bf16 v[204:207], a[188:191], a[20:23], 0
s_xor_b32 s64, s70, 57472
ds_read_b64_tr_b16 a[74:75], v8 offset:17408
v_mfma_f32_16x16x32_bf16 v[204:207], a[184:187], a[16:19], v[204:207]
s_waitcnt lgkmcnt(7)
buffer_load_dwordx4 v13, s[32:35], s64 offen lds
v_mfma_f32_16x16x32_bf16 v[28:31], a[0:3], a[88:91], 0
ds_read_b64_tr_b16 a[76:77], v8 offset:24576
v_mfma_f32_16x16x32_bf16 v[28:31], a[4:7], a[92:95], v[28:31]
ds_read_b64_tr_b16 a[78:79], v8 offset:25600
v_mfma_f32_16x16x32_bf16 v[44:47], a[12:15], a[92:95], 0
ds_read_b64_tr_b16 a[80:81], v9 offset:16384
v_mfma_f32_16x16x32_bf16 v[44:47], a[8:11], a[88:91], v[44:47]
ds_read_b64_tr_b16 a[82:83], v9 offset:17408
v_mfma_f32_16x16x32_bf16 v[60:63], a[16:19], a[88:91], 0
s_xor_b32 m0, s77, 131072
ds_read_b64_tr_b16 a[84:85], v9 offset:24576
v_mfma_f32_16x16x32_bf16 v[60:63], a[20:23], a[92:95], v[60:63]
s_xor_b32 s64, s71, 1048576
ds_read_b64_tr_b16 a[86:87], v9 offset:25600
v_mfma_f32_16x16x32_bf16 v[76:79], a[28:31], a[92:95], 0
buffer_load_dwordx4 v14, s[36:39], s64 offen lds
v_mfma_f32_16x16x32_bf16 v[76:79], a[24:27], a[88:91], v[76:79]
s_xor_b32 m0, s77, 132096
ds_read_b64_tr_b16 a[88:89], v10 offset:16384
v_mfma_f32_16x16x32_bf16 v[140:143], a[24:27], a[96:99], 0
s_xor_b32 s64, s71, 1081344
ds_read_b64_tr_b16 a[90:91], v10 offset:17408
v_mfma_f32_16x16x32_bf16 v[140:143], a[28:31], a[100:103], v[140:143]
buffer_load_dwordx4 v14, s[36:39], s64 offen lds
v_mfma_f32_16x16x32_bf16 v[124:127], a[20:23], a[100:103], 0
ds_read_b64_tr_b16 a[92:93], v10 offset:24576
v_mfma_f32_16x16x32_bf16 v[124:127], a[16:19], a[96:99], v[124:127]
s_xor_b32 m0, s77, 133120
ds_read_b64_tr_b16 a[94:95], v10 offset:25600
v_mfma_f32_16x16x32_bf16 v[108:111], a[8:11], a[96:99], 0
s_xor_b32 s64, s71, 1114112
v_mfma_f32_16x16x32_bf16 v[108:111], a[12:15], a[100:103], v[108:111]
buffer_load_dwordx4 v15, s[36:39], s64 offen lds
v_mfma_f32_16x16x32_bf16 v[92:95], a[4:7], a[100:103], 0
v_mfma_f32_16x16x32_bf16 v[92:95], a[0:3], a[96:99], v[92:95]
s_xor_b32 m0, s77, 134144
ds_read_b64_tr_b16 a[96:97], v11 offset:16384
v_mfma_f32_16x16x32_bf16 v[32:35], a[0:3], a[104:107], 0
s_waitcnt lgkmcnt(5)
s_xor_b32 s64, s71, 1146880
ds_read_b64_tr_b16 a[98:99], v11 offset:17408
v_mfma_f32_16x16x32_bf16 v[32:35], a[4:7], a[108:111], v[32:35]
buffer_load_dwordx4 v15, s[36:39], s64 offen lds
v_mfma_f32_16x16x32_bf16 v[48:51], a[12:15], a[108:111], 0
ds_read_b64_tr_b16 a[100:101], v11 offset:24576
v_mfma_f32_16x16x32_bf16 v[48:51], a[8:11], a[104:107], v[48:51]
s_xor_b32 m0, s77, 147456
ds_read_b64_tr_b16 a[102:103], v11 offset:25600
v_mfma_f32_16x16x32_bf16 v[64:67], a[16:19], a[104:107], 0
s_xor_b32 s64, s71, 1048576
v_mfma_f32_16x16x32_bf16 v[64:67], a[20:23], a[108:111], v[64:67]
buffer_load_dwordx4 v14, s[40:43], s64 offen lds
v_mfma_f32_16x16x32_bf16 v[80:83], a[28:31], a[108:111], 0
s_xor_b32 m0, s77, 148480
v_mfma_f32_16x16x32_bf16 v[80:83], a[24:27], a[104:107], v[80:83]
s_xor_b32 s64, s71, 1081344
v_mfma_f32_16x16x32_bf16 v[144:147], a[24:27], a[112:115], 0
buffer_load_dwordx4 v14, s[40:43], s64 offen lds
v_mfma_f32_16x16x32_bf16 v[144:147], a[28:31], a[116:119], v[144:147]
v_mfma_f32_16x16x32_bf16 v[128:131], a[20:23], a[116:119], 0
s_xor_b32 m0, s77, 149504
v_mfma_f32_16x16x32_bf16 v[128:131], a[16:19], a[112:115], v[128:131]
s_xor_b32 s64, s71, 1114112
v_mfma_f32_16x16x32_bf16 v[112:115], a[8:11], a[112:115], 0
buffer_load_dwordx4 v15, s[40:43], s64 offen lds
v_mfma_f32_16x16x32_bf16 v[112:115], a[12:15], a[116:119], v[112:115]
v_mfma_f32_16x16x32_bf16 v[96:99], a[4:7], a[116:119], 0
s_xor_b32 m0, s77, 150528
v_mfma_f32_16x16x32_bf16 v[96:99], a[0:3], a[112:115], v[96:99]
s_xor_b32 s64, s71, 1146880
v_mfma_f32_16x16x32_bf16 v[36:39], a[0:3], a[72:75], 0
buffer_load_dwordx4 v15, s[40:43], s64 offen lds
v_mfma_f32_16x16x32_bf16 v[36:39], a[4:7], a[76:79], v[36:39]
s_xor_b32 m0, s84, 0
v_mfma_f32_16x16x32_bf16 v[52:55], a[12:15], a[76:79], 0
s_waitcnt vmcnt(16) lgkmcnt(0)
s_barrier
v_mfma_f32_16x16x32_bf16 v[52:55], a[8:11], a[72:75], v[52:55]
s_xor_b32 s64, s70, 256
ds_read_b64_tr_b16 a[104:105], v4 offset:32768
v_mfma_f32_16x16x32_bf16 v[68:71], a[16:19], a[72:75], 0
buffer_load_dwordx4 v12, s[32:35], s64 offen lds
v_mfma_f32_16x16x32_bf16 v[68:71], a[20:23], a[76:79], v[68:71]
s_xor_b32 m0, s84, 1024
global_load_dwordx4 a[144:147], v18, s[4:5] offset:0
v_mfma_f32_16x16x32_bf16 v[84:87], a[28:31], a[76:79], 0
s_xor_b32 s64, s70, 8448
ds_read_b64_tr_b16 a[106:107], v4 offset:33792
v_mfma_f32_16x16x32_bf16 v[84:87], a[24:27], a[72:75], v[84:87]
buffer_load_dwordx4 v13, s[32:35], s64 offen lds
v_mfma_f32_16x16x32_bf16 v[148:151], a[24:27], a[80:83], 0
ds_read_b64_tr_b16 a[108:109], v4 offset:40960
v_mfma_f32_16x16x32_bf16 v[148:151], a[28:31], a[84:87], v[148:151]
s_xor_b32 m0, s84, 2048
ds_read_b64_tr_b16 a[110:111], v4 offset:41984
v_mfma_f32_16x16x32_bf16 v[132:135], a[20:23], a[84:87], 0
s_waitcnt vmcnt(11)
s_xor_b32 s64, s70, 16640
ds_read_b128 a[32:35], v2 offset:32768
v_mfma_f32_16x16x32_bf16 v[132:135], a[16:19], a[80:83], v[132:135]
buffer_load_dwordx4 v12, s[32:35], s64 offen lds
v_mfma_f32_16x16x32_bf16 v[116:119], a[8:11], a[80:83], 0
ds_read_b128 a[36:39], v3 offset:32768
v_mfma_f32_16x16x32_bf16 v[116:119], a[12:15], a[84:87], v[116:119]
s_xor_b32 m0, s84, 3072
ds_read_b128 a[40:43], v2 offset:34816
v_mfma_f32_16x16x32_bf16 v[100:103], a[4:7], a[84:87], 0
s_xor_b32 s64, s70, 24832
ds_read_b128 a[44:47], v3 offset:34816
v_mfma_f32_16x16x32_bf16 v[100:103], a[0:3], a[80:83], v[100:103]
buffer_load_dwordx4 v13, s[32:35], s64 offen lds
v_mfma_f32_16x16x32_bf16 v[248:251], a[0:3], a[88:91], 0
ds_read_b128 a[48:51], v2 offset:36864
v_mfma_f32_16x16x32_bf16 v[248:251], a[4:7], a[92:95], v[248:251]
s_xor_b32 m0, s84, 4096
ds_read_b128 a[52:55], v3 offset:36864
v_mfma_f32_16x16x32_bf16 v[252:255], a[12:15], a[92:95], 0
s_xor_b32 s64, s70, 33024
ds_read_b128 a[56:59], v2 offset:38912
v_mfma_f32_16x16x32_bf16 v[252:255], a[8:11], a[88:91], v[252:255]
buffer_load_dwordx4 v12, s[32:35], s64 offen lds
v_mfma_f32_16x16x32_bf16 a[120:123], a[16:19], a[88:91], 0
s_xor_b32 m0, s84, 5120
ds_read_b128 a[60:63], v3 offset:38912
v_mfma_f32_16x16x32_bf16 a[120:123], a[20:23], a[92:95], a[120:123]
s_xor_b32 s64, s70, 41216
ds_read_b64_tr_b16 a[112:113], v5 offset:32768
v_mfma_f32_16x16x32_bf16 a[124:127], a[28:31], a[92:95], 0
buffer_load_dwordx4 v13, s[32:35], s64 offen lds
v_mfma_f32_16x16x32_bf16 a[124:127], a[24:27], a[88:91], a[124:127]
ds_read_b64_tr_b16 a[114:115], v5 offset:33792
v_mfma_f32_16x16x32_bf16 a[128:131], a[24:27], a[96:99], 0
s_xor_b32 m0, s84, 6144
ds_read_b64_tr_b16 a[116:117], v5 offset:40960
v_mfma_f32_16x16x32_bf16 a[128:131], a[28:31], a[100:103], a[128:131]
s_xor_b32 s64, s70, 49408
ds_read_b64_tr_b16 a[118:119], v5 offset:41984
v_mfma_f32_16x16x32_bf16 a[132:135], a[20:23], a[100:103], 0
buffer_load_dwordx4 v12, s[32:35], s64 offen lds
v_mfma_f32_16x16x32_bf16 a[132:135], a[16:19], a[96:99], a[132:135]
global_load_dwordx4 a[160:163], v19, s[22:23] offset:0
v_mfma_f32_16x16x32_bf16 a[136:139], a[8:11], a[96:99], 0
s_xor_b32 m0, s84, 7168
ds_read_b64_tr_b16 a[72:73], v6 offset:32768
v_mfma_f32_16x16x32_bf16 a[136:139], a[12:15], a[100:103], a[136:139]
s_xor_b32 s64, s70, 57600
ds_read_b64_tr_b16 a[74:75], v6 offset:33792
v_mfma_f32_16x16x32_bf16 a[140:143], a[4:7], a[100:103], 0
buffer_load_dwordx4 v13, s[32:35], s64 offen lds
v_mfma_f32_16x16x32_bf16 a[140:143], a[0:3], a[96:99], a[140:143]
s_waitcnt lgkmcnt(5)
ds_read_b64_tr_b16 a[76:77], v6 offset:40960
v_mfma_f32_16x16x32_bf16 v[184:187], a[104:107], a[32:35], v[184:187]
ds_read_b64_tr_b16 a[78:79], v6 offset:41984
v_mfma_f32_16x16x32_bf16 v[184:187], a[108:111], a[36:39], v[184:187]
ds_read_b64_tr_b16 a[80:81], v7 offset:32768
v_mfma_f32_16x16x32_bf16 v[192:195], a[108:111], a[44:47], v[192:195]
s_xor_b32 m0, s77, 65536
ds_read_b64_tr_b16 a[82:83], v7 offset:33792
v_mfma_f32_16x16x32_bf16 v[192:195], a[104:107], a[40:43], v[192:195]
s_xor_b32 s64, s71, 1572864
ds_read_b64_tr_b16 a[84:85], v7 offset:40960
v_mfma_f32_16x16x32_bf16 v[200:203], a[104:107], a[48:51], v[200:203]
buffer_load_dwordx4 v14, s[36:39], s64 offen lds
v_mfma_f32_16x16x32_bf16 v[200:203], a[108:111], a[52:55], v[200:203]
ds_read_b64_tr_b16 a[86:87], v7 offset:41984
v_mfma_f32_16x16x32_bf16 v[208:211], a[108:111], a[60:63], v[208:211]
s_xor_b32 m0, s77, 66560
ds_read_b64_tr_b16 a[88:89], v8 offset:32768
v_mfma_f32_16x16x32_bf16 v[208:211], a[104:107], a[56:59], v[208:211]
s_waitcnt lgkmcnt(7)
s_xor_b32 s64, s71, 1605632
ds_read_b64_tr_b16 a[90:91], v8 offset:33792
v_mfma_f32_16x16x32_bf16 v[212:215], a[112:115], a[56:59], v[212:215]
buffer_load_dwordx4 v14, s[36:39], s64 offen lds
v_mfma_f32_16x16x32_bf16 v[212:215], a[116:119], a[60:63], v[212:215]
ds_read_b64_tr_b16 a[92:93], v8 offset:40960
v_mfma_f32_16x16x32_bf16 v[204:207], a[116:119], a[52:55], v[204:207]
s_xor_b32 m0, s77, 67584
ds_read_b64_tr_b16 a[94:95], v8 offset:41984
v_mfma_f32_16x16x32_bf16 v[204:207], a[112:115], a[48:51], v[204:207]
s_xor_b32 s64, s71, 1638400
ds_read_b64_tr_b16 a[96:97], v9 offset:32768
v_mfma_f32_16x16x32_bf16 v[196:199], a[112:115], a[40:43], v[196:199]
buffer_load_dwordx4 v15, s[36:39], s64 offen lds
v_mfma_f32_16x16x32_bf16 v[196:199], a[116:119], a[44:47], v[196:199]
ds_read_b64_tr_b16 a[98:99], v9 offset:33792
v_mfma_f32_16x16x32_bf16 v[188:191], a[116:119], a[36:39], v[188:191]
s_xor_b32 m0, s77, 68608
ds_read_b64_tr_b16 a[100:101], v9 offset:40960
v_mfma_f32_16x16x32_bf16 v[188:191], a[112:115], a[32:35], v[188:191]
s_xor_b32 s64, s71, 1671168
ds_read_b64_tr_b16 a[102:103], v9 offset:41984
v_mfma_f32_16x16x32_bf16 v[216:219], a[72:75], a[32:35], v[216:219]
s_waitcnt lgkmcnt(7)
buffer_load_dwordx4 v15, s[36:39], s64 offen lds
v_mfma_f32_16x16x32_bf16 v[216:219], a[76:79], a[36:39], v[216:219]
global_load_dwordx4 a[148:151], v18, s[4:5] offset:512
v_mfma_f32_16x16x32_bf16 v[224:227], a[76:79], a[44:47], v[224:227]
ds_read_b64_tr_b16 a[104:105], v10 offset:32768
v_mfma_f32_16x16x32_bf16 v[224:227], a[72:75], a[40:43], v[224:227]
s_xor_b32 m0, s77, 81920
ds_read_b64_tr_b16 a[106:107], v10 offset:33792
v_mfma_f32_16x16x32_bf16 v[232:235], a[72:75], a[48:51], v[232:235]
s_xor_b32 s64, s71, 1572864
ds_read_b64_tr_b16 a[108:109], v10 offset:40960
v_mfma_f32_16x16x32_bf16 v[232:235], a[76:79], a[52:55], v[232:235]
buffer_load_dwordx4 v14, s[40:43], s64 offen lds
v_mfma_f32_16x16x32_bf16 v[240:243], a[76:79], a[60:63], v[240:243]
ds_read_b64_tr_b16 a[110:111], v10 offset:41984
v_mfma_f32_16x16x32_bf16 v[240:243], a[72:75], a[56:59], v[240:243]
s_xor_b32 m0, s77, 82944
ds_read_b64_tr_b16 a[112:113], v11 offset:32768
v_mfma_f32_16x16x32_bf16 v[244:247], a[80:83], a[56:59], v[244:247]
s_xor_b32 s64, s71, 1605632
ds_read_b64_tr_b16 a[114:115], v11 offset:33792
v_mfma_f32_16x16x32_bf16 v[244:247], a[84:87], a[60:63], v[244:247]
buffer_load_dwordx4 v14, s[40:43], s64 offen lds
v_mfma_f32_16x16x32_bf16 v[236:239], a[84:87], a[52:55], v[236:239]
ds_read_b64_tr_b16 a[116:117], v11 offset:40960
v_mfma_f32_16x16x32_bf16 v[236:239], a[80:83], a[48:51], v[236:239]
s_xor_b32 m0, s77, 83968
ds_read_b64_tr_b16 a[118:119], v11 offset:41984
v_mfma_f32_16x16x32_bf16 v[228:231], a[80:83], a[40:43], v[228:231]
s_xor_b32 s64, s71, 1638400
ds_read_b64_tr_b16 a[72:73], v4 offset:49152
v_mfma_f32_16x16x32_bf16 v[228:231], a[84:87], a[44:47], v[228:231]
buffer_load_dwordx4 v15, s[40:43], s64 offen lds
v_mfma_f32_16x16x32_bf16 v[220:223], a[84:87], a[36:39], v[220:223]
ds_read_b64_tr_b16 a[74:75], v4 offset:50176
v_mfma_f32_16x16x32_bf16 v[220:223], a[80:83], a[32:35], v[220:223]
s_waitcnt lgkmcnt(7)
s_xor_b32 m0, s77, 84992
ds_read_b64_tr_b16 a[76:77], v4 offset:57344
v_mfma_f32_16x16x32_bf16 v[152:155], a[88:91], a[32:35], v[152:155]
s_xor_b32 s64, s71, 1671168
ds_read_b64_tr_b16 a[78:79], v4 offset:58368
v_mfma_f32_16x16x32_bf16 v[152:155], a[92:95], a[36:39], v[152:155]
buffer_load_dwordx4 v15, s[40:43], s64 offen lds
v_mfma_f32_16x16x32_bf16 v[160:163], a[92:95], a[44:47], v[160:163]
ds_read_b64_tr_b16 a[80:81], v5 offset:49152
v_mfma_f32_16x16x32_bf16 v[160:163], a[88:91], a[40:43], v[160:163]
ds_read_b64_tr_b16 a[82:83], v5 offset:50176
v_mfma_f32_16x16x32_bf16 v[168:171], a[88:91], a[48:51], v[168:171]
ds_read_b64_tr_b16 a[84:85], v5 offset:57344
v_mfma_f32_16x16x32_bf16 v[168:171], a[92:95], a[52:55], v[168:171]
ds_read_b64_tr_b16 a[86:87], v5 offset:58368
v_mfma_f32_16x16x32_bf16 v[176:179], a[92:95], a[60:63], v[176:179]
s_xor_b32 m0, s84, 32768
global_load_dwordx4 a[164:167], v19, s[22:23] offset:512
v_mfma_f32_16x16x32_bf16 v[176:179], a[88:91], a[56:59], v[176:179]
s_xor_b32 s64, s70, 384
ds_read_b64_tr_b16 a[88:89], v6 offset:49152
v_mfma_f32_16x16x32_bf16 v[180:183], a[96:99], a[56:59], v[180:183]
buffer_load_dwordx4 v12, s[32:35], s64 offen lds
v_mfma_f32_16x16x32_bf16 v[180:183], a[100:103], a[60:63], v[180:183]
ds_read_b64_tr_b16 a[90:91], v6 offset:50176
v_mfma_f32_16x16x32_bf16 v[172:175], a[100:103], a[52:55], v[172:175]
ds_read_b64_tr_b16 a[92:93], v6 offset:57344
v_mfma_f32_16x16x32_bf16 v[172:175], a[96:99], a[48:51], v[172:175]
ds_read_b64_tr_b16 a[94:95], v6 offset:58368
v_mfma_f32_16x16x32_bf16 v[164:167], a[96:99], a[40:43], v[164:167]
v_mfma_f32_16x16x32_bf16 v[164:167], a[100:103], a[44:47], v[164:167]
s_xor_b32 m0, s84, 33792
v_mfma_f32_16x16x32_bf16 v[156:159], a[100:103], a[36:39], v[156:159]
s_xor_b32 s64, s70, 8576
v_mfma_f32_16x16x32_bf16 v[156:159], a[96:99], a[32:35], v[156:159]
buffer_load_dwordx4 v13, s[32:35], s64 offen lds
v_mfma_f32_16x16x32_bf16 v[24:27], a[104:107], a[32:35], v[24:27]
s_waitcnt lgkmcnt(4)
ds_read_b64_tr_b16 a[96:97], v7 offset:49152
v_mfma_f32_16x16x32_bf16 v[24:27], a[108:111], a[36:39], v[24:27]
ds_read_b64_tr_b16 a[98:99], v7 offset:50176
v_mfma_f32_16x16x32_bf16 v[40:43], a[108:111], a[44:47], v[40:43]
ds_read_b64_tr_b16 a[100:101], v7 offset:57344
v_mfma_f32_16x16x32_bf16 v[40:43], a[104:107], a[40:43], v[40:43]
ds_read_b64_tr_b16 a[102:103], v7 offset:58368
v_mfma_f32_16x16x32_bf16 v[56:59], a[104:107], a[48:51], v[56:59]
s_xor_b32 m0, s84, 34816
v_mfma_f32_16x16x32_bf16 v[56:59], a[108:111], a[52:55], v[56:59]
s_xor_b32 s64, s70, 16768
v_mfma_f32_16x16x32_bf16 v[72:75], a[108:111], a[60:63], v[72:75]
s_waitcnt vmcnt(12)
buffer_load_dwordx4 v12, s[32:35], s64 offen lds
v_mfma_f32_16x16x32_bf16 v[72:75], a[104:107], a[56:59], v[72:75]
ds_read_b64_tr_b16 a[104:105], v8 offset:49152
v_mfma_f32_16x16x32_bf16 v[136:139], a[112:115], a[56:59], v[136:139]
ds_read_b64_tr_b16 a[106:107], v8 offset:50176
v_mfma_f32_16x16x32_bf16 v[136:139], a[116:119], a[60:63], v[136:139]
ds_read_b64_tr_b16 a[108:109], v8 offset:57344
v_add_u32 v4, 0x8000, v4
v_mfma_f32_16x16x32_bf16 v[120:123], a[116:119], a[52:55], v[120:123]
ds_read_b64_tr_b16 a[110:111], v8 offset:58368
v_mfma_f32_16x16x32_bf16 v[120:123], a[112:115], a[48:51], v[120:123]
s_xor_b32 m0, s84, 35840
ds_read_b128 a[0:3], v2 offset:0
v_mfma_f32_16x16x32_bf16 v[104:107], a[112:115], a[40:43], v[104:107]
s_xor_b32 s64, s70, 24960
global_load_dwordx4 a[152:155], v18, s[4:5] offset:1024
v_mfma_f32_16x16x32_bf16 v[104:107], a[116:119], a[44:47], v[104:107]
s_branch L_po2
L_pg2:
s_branch L_tr0
L_po2:
buffer_load_dwordx4 v13, s[32:35], s64 offen lds
v_mfma_f32_16x16x32_bf16 v[88:91], a[116:119], a[36:39], v[88:91]
ds_read_b128 a[4:7], v3 offset:0
v_mfma_f32_16x16x32_bf16 v[88:91], a[112:115], a[32:35], v[88:91]
ds_read_b128 a[8:11], v2 offset:2048
v_mfma_f32_16x16x32_bf16 v[28:31], a[32:35], a[72:75], v[28:31]
ds_read_b128 a[12:15], v3 offset:2048
v_mfma_f32_16x16x32_bf16 v[28:31], a[36:39], a[76:79], v[28:31]
ds_read_b128 a[16:19], v2 offset:4096
v_add_u32 v5, 0x8000, v5
v_mfma_f32_16x16x32_bf16 v[44:47], a[44:47], a[76:79], v[44:47]
s_xor_b32 m0, s84, 36864
ds_read_b128 a[20:23], v3 offset:4096
v_mfma_f32_16x16x32_bf16 v[44:47], a[40:43], a[72:75], v[44:47]
s_xor_b32 s64, s70, 33152
ds_read_b128 a[24:27], v2 offset:6144
v_mfma_f32_16x16x32_bf16 v[60:63], a[48:51], a[72:75], v[60:63]
buffer_load_dwordx4 v12, s[32:35], s64 offen lds
v_mfma_f32_16x16x32_bf16 v[60:63], a[52:55], a[76:79], v[60:63]
ds_read_b128 a[28:31], v3 offset:6144
v_mfma_f32_16x16x32_bf16 v[76:79], a[60:63], a[76:79], v[76:79]
ds_read_b64_tr_b16 a[112:113], v9 offset:49152
v_mfma_f32_16x16x32_bf16 v[76:79], a[56:59], a[72:75], v[76:79]
ds_read_b64_tr_b16 a[114:115], v9 offset:50176
v_mfma_f32_16x16x32_bf16 v[140:143], a[56:59], a[80:83], v[140:143]
ds_read_b64_tr_b16 a[116:117], v9 offset:57344
v_mfma_f32_16x16x32_bf16 v[140:143], a[60:63], a[84:87], v[140:143]
s_xor_b32 m0, s84, 37888
ds_read_b64_tr_b16 a[118:119], v9 offset:58368
v_add_u32 v6, 0x8000, v6
v_mfma_f32_16x16x32_bf16 v[124:127], a[52:55], a[84:87], v[124:127]
s_xor_b32 s64, s70, 41344
ds_read_b64_tr_b16 a[72:73], v10 offset:49152
v_mfma_f32_16x16x32_bf16 v[124:127], a[48:51], a[80:83], v[124:127]
buffer_load_dwordx4 v13, s[32:35], s64 offen lds
v_mfma_f32_16x16x32_bf16 v[108:111], a[40:43], a[80:83], v[108:111]
ds_read_b64_tr_b16 a[74:75], v10 offset:50176
v_mfma_f32_16x16x32_bf16 v[108:111], a[44:47], a[84:87], v[108:111]
ds_read_b64_tr_b16 a[76:77], v10 offset:57344
v_mfma_f32_16x16x32_bf16 v[92:95], a[36:39], a[84:87], v[92:95]
ds_read_b64_tr_b16 a[78:79], v10 offset:58368
v_mfma_f32_16x16x32_bf16 v[92:95], a[32:35], a[80:83], v[92:95]
s_waitcnt lgkmcnt(8)
ds_read_b64_tr_b16 a[80:81], v11 offset:49152
v_mfma_f32_16x16x32_bf16 v[32:35], a[32:35], a[88:91], v[32:35]
s_xor_b32 m0, s84, 38912
ds_read_b64_tr_b16 a[82:83], v11 offset:50176
v_mfma_f32_16x16x32_bf16 v[32:35], a[36:39], a[92:95], v[32:35]
s_xor_b32 s64, s70, 49536
ds_read_b64_tr_b16 a[84:85], v11 offset:57344
v_add_u32 v7, 0x8000, v7
v_mfma_f32_16x16x32_bf16 v[48:51], a[44:47], a[92:95], v[48:51]
buffer_load_dwordx4 v12, s[32:35], s64 offen lds
v_mfma_f32_16x16x32_bf16 v[48:51], a[40:43], a[88:91], v[48:51]
global_load_dwordx4 a[168:171], v19, s[22:23] offset:1024
v_mfma_f32_16x16x32_bf16 v[64:67], a[48:51], a[88:91], v[64:67]
ds_read_b64_tr_b16 a[86:87], v11 offset:58368
v_mfma_f32_16x16x32_bf16 v[64:67], a[52:55], a[92:95], v[64:67]
v_mfma_f32_16x16x32_bf16 v[80:83], a[60:63], a[92:95], v[80:83]
v_mfma_f32_16x16x32_bf16 v[80:83], a[56:59], a[88:91], v[80:83]
s_xor_b32 m0, s84, 39936
v_mfma_f32_16x16x32_bf16 v[144:147], a[56:59], a[96:99], v[144:147]
s_xor_b32 s64, s70, 57728
v_mfma_f32_16x16x32_bf16 v[144:147], a[60:63], a[100:103], v[144:147]
buffer_load_dwordx4 v13, s[32:35], s64 offen lds
v_mfma_f32_16x16x32_bf16 v[128:131], a[52:55], a[100:103], v[128:131]
v_add_u32 v8, 0x8000, v8
v_mfma_f32_16x16x32_bf16 v[128:131], a[48:51], a[96:99], v[128:131]
v_mfma_f32_16x16x32_bf16 v[112:115], a[40:43], a[96:99], v[112:115]
v_mfma_f32_16x16x32_bf16 v[112:115], a[44:47], a[100:103], v[112:115]
v_mfma_f32_16x16x32_bf16 v[96:99], a[36:39], a[100:103], v[96:99]
v_add_u32 v9, 0x8000, v9
v_add_u32 v10, 0x8000, v10
v_mfma_f32_16x16x32_bf16 v[96:99], a[32:35], a[96:99], v[96:99]
v_add_u32 v11, 0x8000, v11
v_mfma_f32_16x16x32_bf16 v[36:39], a[32:35], a[104:107], v[36:39]
v_mfma_f32_16x16x32_bf16 v[36:39], a[36:39], a[108:111], v[36:39]
v_mfma_f32_16x16x32_bf16 v[52:55], a[44:47], a[108:111], v[52:55]
s_cmp_eq_u32 s30, 0
s_cbranch_scc1 L_pg6
s_cmp_eq_u32 s30, 1
s_cbranch_scc1 L_pg7
s_cmp_eq_u32 s30, 2
s_cbranch_scc1 L_pg8
s_branch L_pg9
L_tr1:
s_waitcnt lgkmcnt(0)
s_barrier
v_mfma_f32_16x16x32_bf16 v[52:55], a[40:43], a[104:107], v[52:55]
s_xor_b32 m0, s77, 98304
ds_read_b64_tr_b16 a[88:89], v4 offset:32768
v_mfma_f32_16x16x32_bf16 v[68:71], a[48:51], a[104:107], v[68:71]
s_xor_b32 s64, s71, 2097152
ds_read_b64_tr_b16 a[90:91], v4 offset:33792
v_mfma_f32_16x16x32_bf16 v[68:71], a[52:55], a[108:111], v[68:71]
buffer_load_dwordx4 v14, s[36:39], s64 offen lds
v_mfma_f32_16x16x32_bf16 v[84:87], a[60:63], a[108:111], v[84:87]
ds_read_b64_tr_b16 a[92:93], v4 offset:40960
v_mfma_f32_16x16x32_bf16 v[84:87], a[56:59], a[104:107], v[84:87]
ds_read_b64_tr_b16 a[94:95], v4 offset:41984
v_mfma_f32_16x16x32_bf16 v[148:151], a[56:59], a[112:115], v[148:151]
global_load_dwordx4 a[156:159], v18, s[4:5] offset:1536
v_mfma_f32_16x16x32_bf16 v[148:151], a[60:63], a[116:119], v[148:151]
ds_read_b64_tr_b16 a[96:97], v5 offset:32768
v_mfma_f32_16x16x32_bf16 v[132:135], a[52:55], a[116:119], v[132:135]
ds_read_b64_tr_b16 a[98:99], v5 offset:33792
v_mfma_f32_16x16x32_bf16 v[132:135], a[48:51], a[112:115], v[132:135]
s_xor_b32 m0, s77, 99328
ds_read_b64_tr_b16 a[100:101], v5 offset:40960
v_mfma_f32_16x16x32_bf16 v[116:119], a[40:43], a[112:115], v[116:119]
s_xor_b32 s64, s71, 2129920
ds_read_b64_tr_b16 a[102:103], v5 offset:41984
v_mfma_f32_16x16x32_bf16 v[116:119], a[44:47], a[116:119], v[116:119]
buffer_load_dwordx4 v14, s[36:39], s64 offen lds
v_mfma_f32_16x16x32_bf16 v[100:103], a[36:39], a[116:119], v[100:103]
ds_read_b64_tr_b16 a[104:105], v6 offset:32768
v_mfma_f32_16x16x32_bf16 v[100:103], a[32:35], a[112:115], v[100:103]
ds_read_b64_tr_b16 a[106:107], v6 offset:33792
v_mfma_f32_16x16x32_bf16 v[248:251], a[32:35], a[72:75], v[248:251]
ds_read_b64_tr_b16 a[108:109], v6 offset:40960
v_mfma_f32_16x16x32_bf16 v[248:251], a[36:39], a[76:79], v[248:251]
ds_read_b64_tr_b16 a[110:111], v6 offset:41984
v_mfma_f32_16x16x32_bf16 v[252:255], a[44:47], a[76:79], v[252:255]
ds_read_b64_tr_b16 a[112:113], v7 offset:32768
v_mfma_f32_16x16x32_bf16 v[252:255], a[40:43], a[72:75], v[252:255]
s_xor_b32 m0, s77, 100352
ds_read_b64_tr_b16 a[114:115], v7 offset:33792
v_mfma_f32_16x16x32_bf16 a[120:123], a[48:51], a[72:75], a[120:123]
s_xor_b32 s64, s71, 2162688
ds_read_b64_tr_b16 a[116:117], v7 offset:40960
v_mfma_f32_16x16x32_bf16 a[120:123], a[52:55], a[76:79], a[120:123]
buffer_load_dwordx4 v15, s[36:39], s64 offen lds
v_mfma_f32_16x16x32_bf16 a[124:127], a[60:63], a[76:79], a[124:127]
ds_read_b64_tr_b16 a[118:119], v7 offset:41984
v_mfma_f32_16x16x32_bf16 a[124:127], a[56:59], a[72:75], a[124:127]
ds_read_b64_tr_b16 a[72:73], v8 offset:32768
v_mfma_f32_16x16x32_bf16 a[128:131], a[56:59], a[80:83], a[128:131]
ds_read_b64_tr_b16 a[74:75], v8 offset:33792
v_mfma_f32_16x16x32_bf16 a[128:131], a[60:63], a[84:87], a[128:131]
ds_read_b64_tr_b16 a[76:77], v8 offset:40960
v_mfma_f32_16x16x32_bf16 a[132:135], a[52:55], a[84:87], a[132:135]
ds_read_b64_tr_b16 a[78:79], v8 offset:41984
v_mfma_f32_16x16x32_bf16 a[132:135], a[48:51], a[80:83], a[132:135]
s_xor_b32 m0, s77, 101376
v_mfma_f32_16x16x32_bf16 a[136:139], a[40:43], a[80:83], a[136:139]
s_xor_b32 s64, s71, 2195456
v_mfma_f32_16x16x32_bf16 a[136:139], a[44:47], a[84:87], a[136:139]
buffer_load_dwordx4 v15, s[36:39], s64 offen lds
v_mfma_f32_16x16x32_bf16 a[140:143], a[36:39], a[84:87], a[140:143]
global_load_dwordx4 a[172:175], v19, s[22:23] offset:1536
v_mfma_f32_16x16x32_bf16 a[140:143], a[32:35], a[80:83], a[140:143]
s_waitcnt lgkmcnt(5)
ds_read_b64_tr_b16 a[80:81], v9 offset:32768
v_mfma_f32_16x16x32_bf16 v[184:187], a[88:91], a[0:3], v[184:187]
ds_read_b64_tr_b16 a[82:83], v9 offset:33792
v_mfma_f32_16x16x32_bf16 v[184:187], a[92:95], a[4:7], v[184:187]
ds_read_b64_tr_b16 a[84:85], v9 offset:40960
v_mfma_f32_16x16x32_bf16 v[192:195], a[92:95], a[12:15], v[192:195]
ds_read_b64_tr_b16 a[86:87], v9 offset:41984
v_mfma_f32_16x16x32_bf16 v[192:195], a[88:91], a[8:11], v[192:195]
s_xor_b32 m0, s77, 114688
v_mfma_f32_16x16x32_bf16 v[200:203], a[88:91], a[16:19], v[200:203]
s_xor_b32 s64, s71, 2097152
v_mfma_f32_16x16x32_bf16 v[200:203], a[92:95], a[20:23], v[200:203]
buffer_load_dwordx4 v14, s[40:43], s64 offen lds
v_mfma_f32_16x16x32_bf16 v[208:211], a[92:95], a[28:31], v[208:211]
v_mfma_f32_16x16x32_bf16 v[208:211], a[88:91], a[24:27], v[208:211]
ds_read_b64_tr_b16 a[88:89], v10 offset:32768
v_mfma_f32_16x16x32_bf16 v[212:215], a[96:99], a[24:27], v[212:215]
ds_read_b64_tr_b16 a[90:91], v10 offset:33792
v_mfma_f32_16x16x32_bf16 v[212:215], a[100:103], a[28:31], v[212:215]
ds_read_b64_tr_b16 a[92:93], v10 offset:40960
v_mfma_f32_16x16x32_bf16 v[204:207], a[100:103], a[20:23], v[204:207]
ds_read_b64_tr_b16 a[94:95], v10 offset:41984
v_mfma_f32_16x16x32_bf16 v[204:207], a[96:99], a[16:19], v[204:207]
s_xor_b32 m0, s77, 115712
v_mfma_f32_16x16x32_bf16 v[196:199], a[96:99], a[8:11], v[196:199]
s_xor_b32 s64, s71, 2129920
v_mfma_f32_16x16x32_bf16 v[196:199], a[100:103], a[12:15], v[196:199]
buffer_load_dwordx4 v14, s[40:43], s64 offen lds
v_mfma_f32_16x16x32_bf16 v[188:191], a[100:103], a[4:7], v[188:191]
v_mfma_f32_16x16x32_bf16 v[188:191], a[96:99], a[0:3], v[188:191]
ds_read_b64_tr_b16 a[96:97], v11 offset:32768
v_mfma_f32_16x16x32_bf16 v[216:219], a[104:107], a[0:3], v[216:219]
ds_read_b64_tr_b16 a[98:99], v11 offset:33792
v_mfma_f32_16x16x32_bf16 v[216:219], a[108:111], a[4:7], v[216:219]
ds_read_b64_tr_b16 a[100:101], v11 offset:40960
v_mfma_f32_16x16x32_bf16 v[224:227], a[108:111], a[12:15], v[224:227]
ds_read_b64_tr_b16 a[102:103], v11 offset:41984
v_mfma_f32_16x16x32_bf16 v[224:227], a[104:107], a[8:11], v[224:227]
s_xor_b32 m0, s77, 116736
v_mfma_f32_16x16x32_bf16 v[232:235], a[104:107], a[16:19], v[232:235]
s_xor_b32 s64, s71, 2162688
buffer_store_dword v21, v20, s[44:47], s69 offen sc1
v_mfma_f32_16x16x32_bf16 v[232:235], a[108:111], a[20:23], v[232:235]
buffer_load_dwordx4 v15, s[40:43], s64 offen lds
v_mfma_f32_16x16x32_bf16 v[240:243], a[108:111], a[28:31], v[240:243]
v_mfma_f32_16x16x32_bf16 v[240:243], a[104:107], a[24:27], v[240:243]
ds_read_b64_tr_b16 a[104:105], v4 offset:49152
v_mfma_f32_16x16x32_bf16 v[244:247], a[112:115], a[24:27], v[244:247]
s_waitcnt lgkmcnt(5)
buffer_load_dword a252, v16, s[56:59], s81 offen
v_mfma_f32_16x16x32_bf16 v[244:247], a[116:119], a[28:31], v[244:247]
ds_read_b64_tr_b16 a[106:107], v4 offset:50176
v_mfma_f32_16x16x32_bf16 v[236:239], a[116:119], a[20:23], v[236:239]
ds_read_b64_tr_b16 a[108:109], v4 offset:57344
v_mfma_f32_16x16x32_bf16 v[236:239], a[112:115], a[16:19], v[236:239]
s_xor_b32 m0, s77, 117760
ds_read_b64_tr_b16 a[110:111], v4 offset:58368
v_mfma_f32_16x16x32_bf16 v[228:231], a[112:115], a[8:11], v[228:231]
s_xor_b32 s64, s71, 2195456
v_mfma_f32_16x16x32_bf16 v[228:231], a[116:119], a[12:15], v[228:231]
buffer_load_dwordx4 v15, s[40:43], s64 offen lds
v_mfma_f32_16x16x32_bf16 v[220:223], a[116:119], a[4:7], v[220:223]
v_mfma_f32_16x16x32_bf16 v[220:223], a[112:115], a[0:3], v[220:223]
ds_read_b64_tr_b16 a[112:113], v5 offset:49152
v_mfma_f32_16x16x32_bf16 v[152:155], a[72:75], a[0:3], v[152:155]
ds_read_b64_tr_b16 a[114:115], v5 offset:50176
v_mfma_f32_16x16x32_bf16 v[152:155], a[76:79], a[4:7], v[152:155]
ds_read_b64_tr_b16 a[116:117], v5 offset:57344
v_mfma_f32_16x16x32_bf16 v[160:163], a[76:79], a[12:15], v[160:163]
ds_read_b64_tr_b16 a[118:119], v5 offset:58368
v_mfma_f32_16x16x32_bf16 v[160:163], a[72:75], a[8:11], v[160:163]
v_mfma_f32_16x16x32_bf16 v[168:171], a[72:75], a[16:19], v[168:171]
v_mfma_f32_16x16x32_bf16 v[168:171], a[76:79], a[20:23], v[168:171]
v_mfma_f32_16x16x32_bf16 v[176:179], a[76:79], a[28:31], v[176:179]
s_xor_b32 m0, s84, 0
v_mfma_f32_16x16x32_bf16 v[176:179], a[72:75], a[24:27], v[176:179]
s_xor_b32 s64, s70, 512
ds_read_b64_tr_b16 a[72:73], v6 offset:49152
v_mfma_f32_16x16x32_bf16 v[180:183], a[80:83], a[24:27], v[180:183]
buffer_load_dwordx4 v12, s[32:35], s64 offen lds
v_mfma_f32_16x16x32_bf16 v[180:183], a[84:87], a[28:31], v[180:183]
ds_read_b64_tr_b16 a[74:75], v6 offset:50176
v_mfma_f32_16x16x32_bf16 v[172:175], a[84:87], a[20:23], v[172:175]
ds_read_b64_tr_b16 a[76:77], v6 offset:57344
v_mfma_f32_16x16x32_bf16 v[172:175], a[80:83], a[16:19], v[172:175]
ds_read_b64_tr_b16 a[78:79], v6 offset:58368
v_mfma_f32_16x16x32_bf16 v[164:167], a[80:83], a[8:11], v[164:167]
v_mfma_f32_16x16x32_bf16 v[164:167], a[84:87], a[12:15], v[164:167]
s_xor_b32 m0, s84, 1024
v_mfma_f32_16x16x32_bf16 v[156:159], a[84:87], a[4:7], v[156:159]
s_xor_b32 s64, s70, 8704
v_mfma_f32_16x16x32_bf16 v[156:159], a[80:83], a[0:3], v[156:159]
buffer_load_dwordx4 v13, s[32:35], s64 offen lds
v_mfma_f32_16x16x32_bf16 v[24:27], a[88:91], a[0:3], v[24:27]
ds_read_b64_tr_b16 a[80:81], v7 offset:49152
v_mfma_f32_16x16x32_bf16 v[24:27], a[92:95], a[4:7], v[24:27]
ds_read_b64_tr_b16 a[82:83], v7 offset:50176
v_mfma_f32_16x16x32_bf16 v[40:43], a[92:95], a[12:15], v[40:43]
ds_read_b64_tr_b16 a[84:85], v7 offset:57344
v_mfma_f32_16x16x32_bf16 v[40:43], a[88:91], a[8:11], v[40:43]
ds_read_b64_tr_b16 a[86:87], v7 offset:58368
v_mfma_f32_16x16x32_bf16 v[56:59], a[88:91], a[16:19], v[56:59]
s_xor_b32 m0, s84, 2048
v_mfma_f32_16x16x32_bf16 v[56:59], a[92:95], a[20:23], v[56:59]
s_xor_b32 s64, s70, 16896
v_mfma_f32_16x16x32_bf16 v[72:75], a[92:95], a[28:31], v[72:75]
s_waitcnt vmcnt(14)
buffer_load_dwordx4 v12, s[32:35], s64 offen lds
v_mfma_f32_16x16x32_bf16 v[72:75], a[88:91], a[24:27], v[72:75]
s_waitcnt lgkmcnt(4)
ds_read_b64_tr_b16 a[88:89], v8 offset:49152
v_mfma_f32_16x16x32_bf16 v[136:139], a[96:99], a[24:27], v[136:139]
buffer_load_dword a252, v1, s[60:63], s82 offen
v_mfma_f32_16x16x32_bf16 v[136:139], a[100:103], a[28:31], v[136:139]
ds_read_b64_tr_b16 a[90:91], v8 offset:50176
v_subrev_u32 v4, 0x8000, v4
v_mfma_f32_16x16x32_bf16 v[120:123], a[100:103], a[20:23], v[120:123]
ds_read_b64_tr_b16 a[92:93], v8 offset:57344
v_mfma_f32_16x16x32_bf16 v[120:123], a[96:99], a[16:19], v[120:123]
s_xor_b32 m0, s84, 3072
ds_read_b64_tr_b16 a[94:95], v8 offset:58368
v_mfma_f32_16x16x32_bf16 v[104:107], a[96:99], a[8:11], v[104:107]
s_xor_b32 s64, s70, 25088
ds_read_b128 a[32:35], v2 offset:32768
v_mfma_f32_16x16x32_bf16 v[104:107], a[100:103], a[12:15], v[104:107]
buffer_load_dwordx4 v13, s[32:35], s64 offen lds
v_mfma_f32_16x16x32_bf16 v[88:91], a[100:103], a[4:7], v[88:91]
ds_read_b128 a[36:39], v3 offset:32768
v_mfma_f32_16x16x32_bf16 v[88:91], a[96:99], a[0:3], v[88:91]
ds_read_b128 a[40:43], v2 offset:34816
v_mfma_f32_16x16x32_bf16 v[28:31], a[0:3], a[104:107], v[28:31]
ds_read_b128 a[44:47], v3 offset:34816
v_mfma_f32_16x16x32_bf16 v[28:31], a[4:7], a[108:111], v[28:31]
ds_read_b128 a[48:51], v2 offset:36864
v_subrev_u32 v5, 0x8000, v5
v_mfma_f32_16x16x32_bf16 v[44:47], a[12:15], a[108:111], v[44:47]
s_xor_b32 m0, s84, 4096
ds_read_b128 a[52:55], v3 offset:36864
v_mfma_f32_16x16x32_bf16 v[44:47], a[8:11], a[104:107], v[44:47]
s_xor_b32 s64, s70, 33280
ds_read_b128 a[56:59], v2 offset:38912
v_mfma_f32_16x16x32_bf16 v[60:63], a[16:19], a[104:107], v[60:63]
buffer_load_dwordx4 v12, s[32:35], s64 offen lds
v_mfma_f32_16x16x32_bf16 v[60:63], a[20:23], a[108:111], v[60:63]
ds_read_b128 a[60:63], v3 offset:38912
v_mfma_f32_16x16x32_bf16 v[76:79], a[28:31], a[108:111], v[76:79]
ds_read_b64_tr_b16 a[96:97], v9 offset:49152
v_mfma_f32_16x16x32_bf16 v[76:79], a[24:27], a[104:107], v[76:79]
ds_read_b64_tr_b16 a[98:99], v9 offset:50176
v_mfma_f32_16x16x32_bf16 v[140:143], a[24:27], a[112:115], v[140:143]
ds_read_b64_tr_b16 a[100:101], v9 offset:57344
v_mfma_f32_16x16x32_bf16 v[140:143], a[28:31], a[116:119], v[140:143]
s_xor_b32 m0, s84, 5120
ds_read_b64_tr_b16 a[102:103], v9 offset:58368
v_subrev_u32 v6, 0x8000, v6
v_mfma_f32_16x16x32_bf16 v[124:127], a[20:23], a[116:119], v[124:127]
s_xor_b32 s64, s70, 41472
ds_read_b64_tr_b16 a[104:105], v10 offset:49152
v_mfma_f32_16x16x32_bf16 v[124:127], a[16:19], a[112:115], v[124:127]
buffer_load_dwordx4 v13, s[32:35], s64 offen lds
v_mfma_f32_16x16x32_bf16 v[108:111], a[8:11], a[112:115], v[108:111]
ds_read_b64_tr_b16 a[106:107], v10 offset:50176
v_mfma_f32_16x16x32_bf16 v[108:111], a[12:15], a[116:119], v[108:111]
ds_read_b64_tr_b16 a[108:109], v10 offset:57344
v_mfma_f32_16x16x32_bf16 v[92:95], a[4:7], a[116:119], v[92:95]
ds_read_b64_tr_b16 a[110:111], v10 offset:58368
v_mfma_f32_16x16x32_bf16 v[92:95], a[0:3], a[112:115], v[92:95]
ds_read_b64_tr_b16 a[112:113], v11 offset:49152
v_mfma_f32_16x16x32_bf16 v[32:35], a[0:3], a[72:75], v[32:35]
s_xor_b32 m0, s84, 6144
ds_read_b64_tr_b16 a[114:115], v11 offset:50176
v_mfma_f32_16x16x32_bf16 v[32:35], a[4:7], a[76:79], v[32:35]
s_xor_b32 s64, s70, 49664
ds_read_b64_tr_b16 a[116:117], v11 offset:57344
v_subrev_u32 v7, 0x8000, v7
v_mfma_f32_16x16x32_bf16 v[48:51], a[12:15], a[76:79], v[48:51]
buffer_load_dwordx4 v12, s[32:35], s64 offen lds
v_mfma_f32_16x16x32_bf16 v[48:51], a[8:11], a[72:75], v[48:51]
ds_read_b64_tr_b16 a[118:119], v11 offset:58368
v_mfma_f32_16x16x32_bf16 v[64:67], a[16:19], a[72:75], v[64:67]
v_mfma_f32_16x16x32_bf16 v[64:67], a[20:23], a[76:79], v[64:67]
v_mfma_f32_16x16x32_bf16 v[80:83], a[28:31], a[76:79], v[80:83]
v_mfma_f32_16x16x32_bf16 v[80:83], a[24:27], a[72:75], v[80:83]
s_waitcnt lgkmcnt(5)
s_xor_b32 m0, s84, 7168
s_add_u32 s81, s81, 1048576
v_mfma_f32_16x16x32_bf16 v[144:147], a[24:27], a[80:83], v[144:147]
s_xor_b32 s64, s70, 57856
buffer_load_dword a252, v16, s[56:59], s81 offen
v_mfma_f32_16x16x32_bf16 v[144:147], a[28:31], a[84:87], v[144:147]
buffer_load_dwordx4 v13, s[32:35], s64 offen lds
v_mfma_f32_16x16x32_bf16 v[128:131], a[20:23], a[84:87], v[128:131]
v_subrev_u32 v8, 0x8000, v8
v_mfma_f32_16x16x32_bf16 v[128:131], a[16:19], a[80:83], v[128:131]
v_mfma_f32_16x16x32_bf16 v[112:115], a[8:11], a[80:83], v[112:115]
v_mfma_f32_16x16x32_bf16 v[112:115], a[12:15], a[84:87], v[112:115]
v_mfma_f32_16x16x32_bf16 v[96:99], a[4:7], a[84:87], v[96:99]
v_subrev_u32 v9, 0x8000, v9
v_subrev_u32 v10, 0x8000, v10
v_mfma_f32_16x16x32_bf16 v[96:99], a[0:3], a[80:83], v[96:99]
v_subrev_u32 v11, 0x8000, v11
v_mfma_f32_16x16x32_bf16 v[36:39], a[0:3], a[88:91], v[36:39]
v_mfma_f32_16x16x32_bf16 v[36:39], a[4:7], a[92:95], v[36:39]
v_mfma_f32_16x16x32_bf16 v[52:55], a[12:15], a[92:95], v[52:55]
s_waitcnt lgkmcnt(0)
s_barrier
v_mfma_f32_16x16x32_bf16 v[52:55], a[8:11], a[88:91], v[52:55]
s_xor_b32 m0, s77, 131072
ds_read_b64_tr_b16 a[72:73], v4 offset:0
v_mfma_f32_16x16x32_bf16 v[68:71], a[16:19], a[88:91], v[68:71]
s_xor_b32 s64, s71, 2621440
ds_read_b64_tr_b16 a[74:75], v4 offset:1024
v_mfma_f32_16x16x32_bf16 v[68:71], a[20:23], a[92:95], v[68:71]
buffer_load_dwordx4 v14, s[36:39], s64 offen lds
v_mfma_f32_16x16x32_bf16 v[84:87], a[28:31], a[92:95], v[84:87]
ds_read_b64_tr_b16 a[76:77], v4 offset:8192
v_mfma_f32_16x16x32_bf16 v[84:87], a[24:27], a[88:91], v[84:87]
ds_read_b64_tr_b16 a[78:79], v4 offset:9216
v_mfma_f32_16x16x32_bf16 v[148:151], a[24:27], a[96:99], v[148:151]
ds_read_b64_tr_b16 a[80:81], v5 offset:0
v_mfma_f32_16x16x32_bf16 v[148:151], a[28:31], a[100:103], v[148:151]
ds_read_b64_tr_b16 a[82:83], v5 offset:1024
v_mfma_f32_16x16x32_bf16 v[132:135], a[20:23], a[100:103], v[132:135]
ds_read_b64_tr_b16 a[84:85], v5 offset:8192
v_mfma_f32_16x16x32_bf16 v[132:135], a[16:19], a[96:99], v[132:135]
s_xor_b32 m0, s77, 132096
ds_read_b64_tr_b16 a[86:87], v5 offset:9216
v_mfma_f32_16x16x32_bf16 v[116:119], a[8:11], a[96:99], v[116:119]
s_xor_b32 s64, s71, 2654208
ds_read_b64_tr_b16 a[88:89], v6 offset:0
v_mfma_f32_16x16x32_bf16 v[116:119], a[12:15], a[100:103], v[116:119]
buffer_load_dwordx4 v14, s[36:39], s64 offen lds
v_mfma_f32_16x16x32_bf16 v[100:103], a[4:7], a[100:103], v[100:103]
ds_read_b64_tr_b16 a[90:91], v6 offset:1024
v_mfma_f32_16x16x32_bf16 v[100:103], a[0:3], a[96:99], v[100:103]
ds_read_b64_tr_b16 a[92:93], v6 offset:8192
v_mfma_f32_16x16x32_bf16 v[248:251], a[0:3], a[104:107], v[248:251]
ds_read_b64_tr_b16 a[94:95], v6 offset:9216
v_mfma_f32_16x16x32_bf16 v[248:251], a[4:7], a[108:111], v[248:251]
ds_read_b64_tr_b16 a[96:97], v7 offset:0
v_mfma_f32_16x16x32_bf16 v[252:255], a[12:15], a[108:111], v[252:255]
ds_read_b64_tr_b16 a[98:99], v7 offset:1024
v_mfma_f32_16x16x32_bf16 v[252:255], a[8:11], a[104:107], v[252:255]
s_xor_b32 m0, s77, 133120
ds_read_b64_tr_b16 a[100:101], v7 offset:8192
v_mfma_f32_16x16x32_bf16 a[120:123], a[16:19], a[104:107], a[120:123]
s_xor_b32 s64, s71, 2686976
ds_read_b64_tr_b16 a[102:103], v7 offset:9216
v_mfma_f32_16x16x32_bf16 a[120:123], a[20:23], a[108:111], a[120:123]
buffer_load_dwordx4 v15, s[36:39], s64 offen lds
v_mfma_f32_16x16x32_bf16 a[124:127], a[28:31], a[108:111], a[124:127]
v_mfma_f32_16x16x32_bf16 a[124:127], a[24:27], a[104:107], a[124:127]
s_add_u32 s82, s82, 1048576
ds_read_b64_tr_b16 a[104:105], v8 offset:0
v_mfma_f32_16x16x32_bf16 a[128:131], a[24:27], a[112:115], a[128:131]
buffer_load_dword a252, v1, s[60:63], s82 offen
v_mfma_f32_16x16x32_bf16 a[128:131], a[28:31], a[116:119], a[128:131]
ds_read_b64_tr_b16 a[106:107], v8 offset:1024
v_mfma_f32_16x16x32_bf16 a[132:135], a[20:23], a[116:119], a[132:135]
ds_read_b64_tr_b16 a[108:109], v8 offset:8192
v_mfma_f32_16x16x32_bf16 a[132:135], a[16:19], a[112:115], a[132:135]
s_xor_b32 m0, s77, 134144
ds_read_b64_tr_b16 a[110:111], v8 offset:9216
v_mfma_f32_16x16x32_bf16 a[136:139], a[8:11], a[112:115], a[136:139]
s_xor_b32 s64, s71, 2719744
v_mfma_f32_16x16x32_bf16 a[136:139], a[12:15], a[116:119], a[136:139]
buffer_load_dwordx4 v15, s[36:39], s64 offen lds
v_mfma_f32_16x16x32_bf16 a[140:143], a[4:7], a[116:119], a[140:143]
v_mfma_f32_16x16x32_bf16 a[140:143], a[0:3], a[112:115], a[140:143]
s_waitcnt lgkmcnt(4)
ds_read_b64_tr_b16 a[112:113], v9 offset:0
v_mfma_f32_16x16x32_bf16 v[184:187], a[72:75], a[32:35], v[184:187]
ds_read_b64_tr_b16 a[114:115], v9 offset:1024
v_mov_b32 v17, 0
v_mfma_f32_16x16x32_bf16 v[184:187], a[76:79], a[36:39], v[184:187]
ds_read_b64_tr_b16 a[116:117], v9 offset:8192
v_accvgpr_read_b32 v19, a144
v_mfma_f32_16x16x32_bf16 v[192:195], a[76:79], a[44:47], v[192:195]
ds_read_b64_tr_b16 a[118:119], v9 offset:9216
v_accvgpr_read_b32 v21, a160
v_mfma_f32_16x16x32_bf16 v[192:195], a[72:75], a[40:43], v[192:195]
s_xor_b32 m0, s77, 147456
v_lshlrev_b32 v18, 16, v19
v_and_b32 v19, 0xffff0000, v19
v_mfma_f32_16x16x32_bf16 v[200:203], a[72:75], a[48:51], v[200:203]
s_xor_b32 s64, s71, 2621440
v_lshlrev_b32 v20, 16, v21
v_and_b32 v21, 0xffff0000, v21
v_mfma_f32_16x16x32_bf16 v[200:203], a[76:79], a[52:55], v[200:203]
buffer_load_dwordx4 v14, s[40:43], s64 offen lds
v_mfma_f32_16x16x32_bf16 v[208:211], a[76:79], a[60:63], v[208:211]
v_mul_f32 v18, v18, v20
v_mul_f32 v19, v19, v21
v_mfma_f32_16x16x32_bf16 v[208:211], a[72:75], a[56:59], v[208:211]
ds_read_b64_tr_b16 a[72:73], v10 offset:0
v_cvt_pk_bf16_f32 v18, v18, v19
v_mfma_f32_16x16x32_bf16 v[212:215], a[80:83], a[56:59], v[212:215]
ds_read_b64_tr_b16 a[74:75], v10 offset:1024
v_lshlrev_b32 v19, 16, v18
v_mfma_f32_16x16x32_bf16 v[212:215], a[84:87], a[60:63], v[212:215]
ds_read_b64_tr_b16 a[76:77], v10 offset:8192
v_and_b32 v18, 0xffff0000, v18
v_mfma_f32_16x16x32_bf16 v[204:207], a[84:87], a[52:55], v[204:207]
ds_read_b64_tr_b16 a[78:79], v10 offset:9216
v_add_f32 v17, v17, v19
v_mfma_f32_16x16x32_bf16 v[204:207], a[80:83], a[48:51], v[204:207]
s_xor_b32 m0, s77, 148480
v_add_f32 v17, v17, v18
v_accvgpr_read_b32 v19, a145
v_mfma_f32_16x16x32_bf16 v[196:199], a[80:83], a[40:43], v[196:199]
s_xor_b32 s64, s71, 2654208
v_accvgpr_read_b32 v21, a161
v_lshlrev_b32 v18, 16, v19
v_mfma_f32_16x16x32_bf16 v[196:199], a[84:87], a[44:47], v[196:199]
buffer_load_dwordx4 v14, s[40:43], s64 offen lds
v_mfma_f32_16x16x32_bf16 v[188:191], a[84:87], a[36:39], v[188:191]
v_and_b32 v19, 0xffff0000, v19
v_lshlrev_b32 v20, 16, v21
v_mfma_f32_16x16x32_bf16 v[188:191], a[80:83], a[32:35], v[188:191]
ds_read_b64_tr_b16 a[80:81], v11 offset:0
v_and_b32 v21, 0xffff0000, v21
v_mfma_f32_16x16x32_bf16 v[216:219], a[88:91], a[32:35], v[216:219]
ds_read_b64_tr_b16 a[82:83], v11 offset:1024
v_mul_f32 v18, v18, v20
v_mfma_f32_16x16x32_bf16 v[216:219], a[92:95], a[36:39], v[216:219]
ds_read_b64_tr_b16 a[84:85], v11 offset:8192
v_mul_f32 v19, v19, v21
v_mfma_f32_16x16x32_bf16 v[224:227], a[92:95], a[44:47], v[224:227]
ds_read_b64_tr_b16 a[86:87], v11 offset:9216
v_cvt_pk_bf16_f32 v18, v18, v19
v_mfma_f32_16x16x32_bf16 v[224:227], a[88:91], a[40:43], v[224:227]
s_xor_b32 m0, s77, 149504
v_lshlrev_b32 v19, 16, v18
v_and_b32 v18, 0xffff0000, v18
v_mfma_f32_16x16x32_bf16 v[232:235], a[88:91], a[48:51], v[232:235]
s_xor_b32 s64, s71, 2686976
v_add_f32 v17, v17, v19
v_add_f32 v17, v17, v18
v_mfma_f32_16x16x32_bf16 v[232:235], a[92:95], a[52:55], v[232:235]
buffer_load_dwordx4 v15, s[40:43], s64 offen lds
v_mfma_f32_16x16x32_bf16 v[240:243], a[92:95], a[60:63], v[240:243]
v_accvgpr_read_b32 v19, a146
v_accvgpr_read_b32 v21, a162
v_mfma_f32_16x16x32_bf16 v[240:243], a[88:91], a[56:59], v[240:243]
s_add_u32 s81, s81, 1048576
ds_read_b64_tr_b16 a[88:89], v4 offset:16384
v_lshlrev_b32 v18, 16, v19
v_mfma_f32_16x16x32_bf16 v[244:247], a[96:99], a[56:59], v[244:247]
buffer_load_dword a252, v16, s[56:59], s81 offen
v_mfma_f32_16x16x32_bf16 v[244:247], a[100:103], a[60:63], v[244:247]
ds_read_b64_tr_b16 a[90:91], v4 offset:17408
v_and_b32 v19, 0xffff0000, v19
v_mfma_f32_16x16x32_bf16 v[236:239], a[100:103], a[52:55], v[236:239]
ds_read_b64_tr_b16 a[92:93], v4 offset:24576
v_lshlrev_b32 v20, 16, v21
v_mfma_f32_16x16x32_bf16 v[236:239], a[96:99], a[48:51], v[236:239]
s_xor_b32 m0, s77, 150528
ds_read_b64_tr_b16 a[94:95], v4 offset:25600
v_and_b32 v21, 0xffff0000, v21
v_mfma_f32_16x16x32_bf16 v[228:231], a[96:99], a[40:43], v[228:231]
s_xor_b32 s64, s71, 2719744
v_mul_f32 v18, v18, v20
v_mul_f32 v19, v19, v21
v_mfma_f32_16x16x32_bf16 v[228:231], a[100:103], a[44:47], v[228:231]
buffer_load_dwordx4 v15, s[40:43], s64 offen lds
v_mfma_f32_16x16x32_bf16 v[220:223], a[100:103], a[36:39], v[220:223]
v_cvt_pk_bf16_f32 v18, v18, v19
v_lshlrev_b32 v19, 16, v18
v_mfma_f32_16x16x32_bf16 v[220:223], a[96:99], a[32:35], v[220:223]
s_waitcnt lgkmcnt(4)
ds_read_b64_tr_b16 a[96:97], v5 offset:16384
v_and_b32 v18, 0xffff0000, v18
v_mfma_f32_16x16x32_bf16 v[152:155], a[104:107], a[32:35], v[152:155]
ds_read_b64_tr_b16 a[98:99], v5 offset:17408
v_add_f32 v17, v17, v19
v_mfma_f32_16x16x32_bf16 v[152:155], a[108:111], a[36:39], v[152:155]
ds_read_b64_tr_b16 a[100:101], v5 offset:24576
v_add_f32 v17, v17, v18
v_mfma_f32_16x16x32_bf16 v[160:163], a[108:111], a[44:47], v[160:163]
s_branch L_po3
L_pg3:
s_branch L_tr0
L_po3:
ds_read_b64_tr_b16 a[102:103], v5 offset:25600
v_accvgpr_read_b32 v19, a147
v_mfma_f32_16x16x32_bf16 v[160:163], a[104:107], a[40:43], v[160:163]
v_accvgpr_read_b32 v21, a163
v_lshlrev_b32 v18, 16, v19
v_mfma_f32_16x16x32_bf16 v[168:171], a[104:107], a[48:51], v[168:171]
v_and_b32 v19, 0xffff0000, v19
v_lshlrev_b32 v20, 16, v21
v_mfma_f32_16x16x32_bf16 v[168:171], a[108:111], a[52:55], v[168:171]
v_and_b32 v21, 0xffff0000, v21
v_mul_f32 v18, v18, v20
v_mfma_f32_16x16x32_bf16 v[176:179], a[108:111], a[60:63], v[176:179]
s_xor_b32 m0, s84, 32768
v_mul_f32 v19, v19, v21
v_cvt_pk_bf16_f32 v18, v18, v19
v_mfma_f32_16x16x32_bf16 v[176:179], a[104:107], a[56:59], v[176:179]
s_xor_b32 s64, s70, 640
ds_read_b64_tr_b16 a[104:105], v6 offset:16384
v_lshlrev_b32 v19, 16, v18
v_mfma_f32_16x16x32_bf16 v[180:183], a[112:115], a[56:59], v[180:183]
buffer_load_dwordx4 v12, s[32:35], s64 offen lds
v_mfma_f32_16x16x32_bf16 v[180:183], a[116:119], a[60:63], v[180:183]
ds_read_b64_tr_b16 a[106:107], v6 offset:17408
v_and_b32 v18, 0xffff0000, v18
v_mfma_f32_16x16x32_bf16 v[172:175], a[116:119], a[52:55], v[172:175]
ds_read_b64_tr_b16 a[108:109], v6 offset:24576
v_add_f32 v17, v17, v19
v_mfma_f32_16x16x32_bf16 v[172:175], a[112:115], a[48:51], v[172:175]
ds_read_b64_tr_b16 a[110:111], v6 offset:25600
v_add_f32 v17, v17, v18
v_mfma_f32_16x16x32_bf16 v[164:167], a[112:115], a[40:43], v[164:167]
v_accvgpr_read_b32 v19, a148
v_accvgpr_read_b32 v21, a164
v_mfma_f32_16x16x32_bf16 v[164:167], a[116:119], a[44:47], v[164:167]
s_xor_b32 m0, s84, 33792
v_lshlrev_b32 v18, 16, v19
v_and_b32 v19, 0xffff0000, v19
v_mfma_f32_16x16x32_bf16 v[156:159], a[116:119], a[36:39], v[156:159]
s_xor_b32 s64, s70, 8832
v_lshlrev_b32 v20, 16, v21
v_and_b32 v21, 0xffff0000, v21
v_mfma_f32_16x16x32_bf16 v[156:159], a[112:115], a[32:35], v[156:159]
buffer_load_dwordx4 v13, s[32:35], s64 offen lds
v_mfma_f32_16x16x32_bf16 v[24:27], a[72:75], a[32:35], v[24:27]
ds_read_b64_tr_b16 a[112:113], v7 offset:16384
v_mul_f32 v18, v18, v20
v_mfma_f32_16x16x32_bf16 v[24:27], a[76:79], a[36:39], v[24:27]
ds_read_b64_tr_b16 a[114:115], v7 offset:17408
v_mul_f32 v19, v19, v21
v_mfma_f32_16x16x32_bf16 v[40:43], a[76:79], a[44:47], v[40:43]
ds_read_b64_tr_b16 a[116:117], v7 offset:24576
v_cvt_pk_bf16_f32 v18, v18, v19
v_mfma_f32_16x16x32_bf16 v[40:43], a[72:75], a[40:43], v[40:43]
ds_read_b64_tr_b16 a[118:119], v7 offset:25600
v_lshlrev_b32 v19, 16, v18
v_mfma_f32_16x16x32_bf16 v[56:59], a[72:75], a[48:51], v[56:59]
s_xor_b32 m0, s84, 34816
v_and_b32 v18, 0xffff0000, v18
v_add_f32 v17, v17, v19
v_mfma_f32_16x16x32_bf16 v[56:59], a[76:79], a[52:55], v[56:59]
s_xor_b32 s64, s70, 17024
v_add_f32 v17, v17, v18
v_accvgpr_read_b32 v19, a149
v_mfma_f32_16x16x32_bf16 v[72:75], a[76:79], a[60:63], v[72:75]
s_waitcnt vmcnt(12)
buffer_load_dwordx4 v12, s[32:35], s64 offen lds
v_mfma_f32_16x16x32_bf16 v[72:75], a[72:75], a[56:59], v[72:75]
s_add_u32 s81, s81, 1048576
ds_read_b64_tr_b16 a[72:73], v8 offset:16384
v_accvgpr_read_b32 v21, a165
v_mfma_f32_16x16x32_bf16 v[136:139], a[80:83], a[56:59], v[136:139]
buffer_load_dword a252, v16, s[56:59], s81 offen
v_mfma_f32_16x16x32_bf16 v[136:139], a[84:87], a[60:63], v[136:139]
ds_read_b64_tr_b16 a[74:75], v8 offset:17408
v_lshlrev_b32 v18, 16, v19
v_mfma_f32_16x16x32_bf16 v[120:123], a[84:87], a[52:55], v[120:123]
ds_read_b64_tr_b16 a[76:77], v8 offset:24576
v_and_b32 v19, 0xffff0000, v19
v_mfma_f32_16x16x32_bf16 v[120:123], a[80:83], a[48:51], v[120:123]
s_xor_b32 m0, s84, 35840
ds_read_b64_tr_b16 a[78:79], v8 offset:25600
v_lshlrev_b32 v20, 16, v21
v_mfma_f32_16x16x32_bf16 v[104:107], a[80:83], a[40:43], v[104:107]
s_xor_b32 s64, s70, 25216
ds_read_b128 a[0:3], v2 offset:0
v_and_b32 v21, 0xffff0000, v21
v_mfma_f32_16x16x32_bf16 v[104:107], a[84:87], a[44:47], v[104:107]
buffer_load_dwordx4 v13, s[32:35], s64 offen lds
v_mfma_f32_16x16x32_bf16 v[88:91], a[84:87], a[36:39], v[88:91]
ds_read_b128 a[4:7], v3 offset:0
v_mul_f32 v18, v18, v20
v_mfma_f32_16x16x32_bf16 v[88:91], a[80:83], a[32:35], v[88:91]
s_waitcnt lgkmcnt(6)
ds_read_b128 a[8:11], v2 offset:2048
v_mul_f32 v19, v19, v21
v_mfma_f32_16x16x32_bf16 v[28:31], a[32:35], a[88:91], v[28:31]
ds_read_b128 a[12:15], v3 offset:2048
v_cvt_pk_bf16_f32 v18, v18, v19
v_mfma_f32_16x16x32_bf16 v[28:31], a[36:39], a[92:95], v[28:31]
ds_read_b128 a[16:19], v2 offset:4096
v_lshlrev_b32 v19, 16, v18
v_mfma_f32_16x16x32_bf16 v[44:47], a[44:47], a[92:95], v[44:47]
s_xor_b32 m0, s84, 36864
ds_read_b128 a[20:23], v3 offset:4096
v_and_b32 v18, 0xffff0000, v18
v_mfma_f32_16x16x32_bf16 v[44:47], a[40:43], a[88:91], v[44:47]
s_xor_b32 s64, s70, 33408
ds_read_b128 a[24:27], v2 offset:6144
v_add_f32 v17, v17, v19
v_mfma_f32_16x16x32_bf16 v[60:63], a[48:51], a[88:91], v[60:63]
buffer_load_dwordx4 v12, s[32:35], s64 offen lds
v_mfma_f32_16x16x32_bf16 v[60:63], a[52:55], a[92:95], v[60:63]
ds_read_b128 a[28:31], v3 offset:6144
v_add_f32 v17, v17, v18
v_mfma_f32_16x16x32_bf16 v[76:79], a[60:63], a[92:95], v[76:79]
ds_read_b64_tr_b16 a[80:81], v9 offset:16384
v_accvgpr_read_b32 v19, a150
v_mfma_f32_16x16x32_bf16 v[76:79], a[56:59], a[88:91], v[76:79]
ds_read_b64_tr_b16 a[82:83], v9 offset:17408
v_accvgpr_read_b32 v21, a166
v_mfma_f32_16x16x32_bf16 v[140:143], a[56:59], a[96:99], v[140:143]
ds_read_b64_tr_b16 a[84:85], v9 offset:24576
v_lshlrev_b32 v18, 16, v19
v_mfma_f32_16x16x32_bf16 v[140:143], a[60:63], a[100:103], v[140:143]
s_xor_b32 m0, s84, 37888
ds_read_b64_tr_b16 a[86:87], v9 offset:25600
v_and_b32 v19, 0xffff0000, v19
v_mfma_f32_16x16x32_bf16 v[124:127], a[52:55], a[100:103], v[124:127]
s_xor_b32 s64, s70, 41600
ds_read_b64_tr_b16 a[88:89], v10 offset:16384
v_lshlrev_b32 v20, 16, v21
v_mfma_f32_16x16x32_bf16 v[124:127], a[48:51], a[96:99], v[124:127]
buffer_load_dwordx4 v13, s[32:35], s64 offen lds
v_mfma_f32_16x16x32_bf16 v[108:111], a[40:43], a[96:99], v[108:111]
ds_read_b64_tr_b16 a[90:91], v10 offset:17408
v_and_b32 v21, 0xffff0000, v21
v_mfma_f32_16x16x32_bf16 v[108:111], a[44:47], a[100:103], v[108:111]
ds_read_b64_tr_b16 a[92:93], v10 offset:24576
v_mul_f32 v18, v18, v20
v_mfma_f32_16x16x32_bf16 v[92:95], a[36:39], a[100:103], v[92:95]
ds_read_b64_tr_b16 a[94:95], v10 offset:25600
v_mul_f32 v19, v19, v21
v_mfma_f32_16x16x32_bf16 v[92:95], a[32:35], a[96:99], v[92:95]
ds_read_b64_tr_b16 a[96:97], v11 offset:16384
v_cvt_pk_bf16_f32 v18, v18, v19
v_mfma_f32_16x16x32_bf16 v[32:35], a[32:35], a[104:107], v[32:35]
s_xor_b32 m0, s84, 38912
ds_read_b64_tr_b16 a[98:99], v11 offset:17408
v_lshlrev_b32 v19, 16, v18
v_mfma_f32_16x16x32_bf16 v[32:35], a[36:39], a[108:111], v[32:35]
s_xor_b32 s64, s70, 49792
ds_read_b64_tr_b16 a[100:101], v11 offset:24576
v_and_b32 v18, 0xffff0000, v18
v_mfma_f32_16x16x32_bf16 v[48:51], a[44:47], a[108:111], v[48:51]
buffer_load_dwordx4 v12, s[32:35], s64 offen lds
v_mfma_f32_16x16x32_bf16 v[48:51], a[40:43], a[104:107], v[48:51]
ds_read_b64_tr_b16 a[102:103], v11 offset:25600
v_add_f32 v17, v17, v19
v_mfma_f32_16x16x32_bf16 v[64:67], a[48:51], a[104:107], v[64:67]
v_add_f32 v17, v17, v18
v_accvgpr_read_b32 v19, a151
v_mfma_f32_16x16x32_bf16 v[64:67], a[52:55], a[108:111], v[64:67]
v_accvgpr_read_b32 v21, a167
v_lshlrev_b32 v18, 16, v19
v_mfma_f32_16x16x32_bf16 v[80:83], a[60:63], a[108:111], v[80:83]
s_add_u32 s82, s82, 1048576
v_and_b32 v19, 0xffff0000, v19
v_lshlrev_b32 v20, 16, v21
v_mfma_f32_16x16x32_bf16 v[80:83], a[56:59], a[104:107], v[80:83]
s_xor_b32 m0, s84, 39936
v_and_b32 v21, 0xffff0000, v21
v_mul_f32 v18, v18, v20
v_mfma_f32_16x16x32_bf16 v[144:147], a[56:59], a[112:115], v[144:147]
s_xor_b32 s64, s70, 57984
buffer_load_dword a252, v1, s[60:63], s82 offen
v_mfma_f32_16x16x32_bf16 v[144:147], a[60:63], a[116:119], v[144:147]
buffer_load_dwordx4 v13, s[32:35], s64 offen lds
v_mfma_f32_16x16x32_bf16 v[128:131], a[52:55], a[116:119], v[128:131]
v_mul_f32 v19, v19, v21
v_cvt_pk_bf16_f32 v18, v18, v19
v_mfma_f32_16x16x32_bf16 v[128:131], a[48:51], a[112:115], v[128:131]
v_lshlrev_b32 v19, 16, v18
v_and_b32 v18, 0xffff0000, v18
v_mfma_f32_16x16x32_bf16 v[112:115], a[40:43], a[112:115], v[112:115]
v_add_f32 v17, v17, v19
v_add_f32 v17, v17, v18
v_mfma_f32_16x16x32_bf16 v[112:115], a[44:47], a[116:119], v[112:115]
v_accvgpr_read_b32 v19, a152
v_accvgpr_read_b32 v21, a168
v_mfma_f32_16x16x32_bf16 v[96:99], a[36:39], a[116:119], v[96:99]
v_lshlrev_b32 v18, 16, v19
v_and_b32 v19, 0xffff0000, v19
v_mfma_f32_16x16x32_bf16 v[96:99], a[32:35], a[112:115], v[96:99]
s_waitcnt lgkmcnt(0)
v_lshlrev_b32 v20, 16, v21
v_and_b32 v21, 0xffff0000, v21
v_mfma_f32_16x16x32_bf16 v[36:39], a[32:35], a[72:75], v[36:39]
v_mul_f32 v18, v18, v20
v_mul_f32 v19, v19, v21
v_mfma_f32_16x16x32_bf16 v[36:39], a[36:39], a[76:79], v[36:39]
v_cvt_pk_bf16_f32 v18, v18, v19
v_lshlrev_b32 v19, 16, v18
v_mfma_f32_16x16x32_bf16 v[52:55], a[44:47], a[76:79], v[52:55]
s_waitcnt lgkmcnt(0)
s_barrier
v_mfma_f32_16x16x32_bf16 v[52:55], a[40:43], a[72:75], v[52:55]
s_xor_b32 m0, s77, 65536
ds_read_b64_tr_b16 a[104:105], v4 offset:32768
v_and_b32 v18, 0xffff0000, v18
v_mfma_f32_16x16x32_bf16 v[68:71], a[48:51], a[72:75], v[68:71]
s_xor_b32 s64, s71, 3145728
ds_read_b64_tr_b16 a[106:107], v4 offset:33792
v_add_f32 v17, v17, v19
v_mfma_f32_16x16x32_bf16 v[68:71], a[52:55], a[76:79], v[68:71]
buffer_load_dwordx4 v14, s[36:39], s64 offen lds
v_mfma_f32_16x16x32_bf16 v[84:87], a[60:63], a[76:79], v[84:87]
ds_read_b64_tr_b16 a[108:109], v4 offset:40960
v_add_f32 v17, v17, v18
v_mfma_f32_16x16x32_bf16 v[84:87], a[56:59], a[72:75], v[84:87]
ds_read_b64_tr_b16 a[110:111], v4 offset:41984
v_accvgpr_read_b32 v19, a153
v_mfma_f32_16x16x32_bf16 v[148:151], a[56:59], a[80:83], v[148:151]
ds_read_b64_tr_b16 a[112:113], v5 offset:32768
v_accvgpr_read_b32 v21, a169
v_mfma_f32_16x16x32_bf16 v[148:151], a[60:63], a[84:87], v[148:151]
ds_read_b64_tr_b16 a[114:115], v5 offset:33792
v_lshlrev_b32 v18, 16, v19
v_mfma_f32_16x16x32_bf16 v[132:135], a[52:55], a[84:87], v[132:135]
ds_read_b64_tr_b16 a[116:117], v5 offset:40960
v_and_b32 v19, 0xffff0000, v19
v_mfma_f32_16x16x32_bf16 v[132:135], a[48:51], a[80:83], v[132:135]
s_xor_b32 m0, s77, 66560
ds_read_b64_tr_b16 a[118:119], v5 offset:41984
v_lshlrev_b32 v20, 16, v21
v_mfma_f32_16x16x32_bf16 v[116:119], a[40:43], a[80:83], v[116:119]
s_xor_b32 s64, s71, 3178496
ds_read_b64_tr_b16 a[72:73], v6 offset:32768
v_and_b32 v21, 0xffff0000, v21
v_mfma_f32_16x16x32_bf16 v[116:119], a[44:47], a[84:87], v[116:119]
buffer_load_dwordx4 v14, s[36:39], s64 offen lds
v_mfma_f32_16x16x32_bf16 v[100:103], a[36:39], a[84:87], v[100:103]
ds_read_b64_tr_b16 a[74:75], v6 offset:33792
v_mul_f32 v18, v18, v20
v_mfma_f32_16x16x32_bf16 v[100:103], a[32:35], a[80:83], v[100:103]
ds_read_b64_tr_b16 a[76:77], v6 offset:40960
v_mul_f32 v19, v19, v21
v_mfma_f32_16x16x32_bf16 v[248:251], a[32:35], a[88:91], v[248:251]
ds_read_b64_tr_b16 a[78:79], v6 offset:41984
v_cvt_pk_bf16_f32 v18, v18, v19
v_mfma_f32_16x16x32_bf16 v[248:251], a[36:39], a[92:95], v[248:251]
ds_read_b64_tr_b16 a[80:81], v7 offset:32768
v_lshlrev_b32 v19, 16, v18
v_mfma_f32_16x16x32_bf16 v[252:255], a[44:47], a[92:95], v[252:255]
ds_read_b64_tr_b16 a[82:83], v7 offset:33792
v_and_b32 v18, 0xffff0000, v18
v_mfma_f32_16x16x32_bf16 v[252:255], a[40:43], a[88:91], v[252:255]
s_xor_b32 m0, s77, 67584
ds_read_b64_tr_b16 a[84:85], v7 offset:40960
v_add_f32 v17, v17, v19
v_mfma_f32_16x16x32_bf16 a[120:123], a[48:51], a[88:91], a[120:123]
s_xor_b32 s64, s71, 3211264
ds_read_b64_tr_b16 a[86:87], v7 offset:41984
v_add_f32 v17, v17, v18
v_mfma_f32_16x16x32_bf16 a[120:123], a[52:55], a[92:95], a[120:123]
buffer_load_dwordx4 v15, s[36:39], s64 offen lds
v_mfma_f32_16x16x32_bf16 a[124:127], a[60:63], a[92:95], a[124:127]
v_accvgpr_read_b32 v19, a154
v_accvgpr_read_b32 v21, a170
v_mfma_f32_16x16x32_bf16 a[124:127], a[56:59], a[88:91], a[124:127]
s_add_u32 s81, s81, 1048576
ds_read_b64_tr_b16 a[88:89], v8 offset:32768
v_lshlrev_b32 v18, 16, v19
v_mfma_f32_16x16x32_bf16 a[128:131], a[56:59], a[96:99], a[128:131]
buffer_load_dword a252, v16, s[56:59], s81 offen
v_mfma_f32_16x16x32_bf16 a[128:131], a[60:63], a[100:103], a[128:131]
ds_read_b64_tr_b16 a[90:91], v8 offset:33792
v_and_b32 v19, 0xffff0000, v19
v_mfma_f32_16x16x32_bf16 a[132:135], a[52:55], a[100:103], a[132:135]
ds_read_b64_tr_b16 a[92:93], v8 offset:40960
v_lshlrev_b32 v20, 16, v21
v_mfma_f32_16x16x32_bf16 a[132:135], a[48:51], a[96:99], a[132:135]
s_xor_b32 m0, s77, 68608
ds_read_b64_tr_b16 a[94:95], v8 offset:41984
v_and_b32 v21, 0xffff0000, v21
v_mfma_f32_16x16x32_bf16 a[136:139], a[40:43], a[96:99], a[136:139]
s_xor_b32 s64, s71, 3244032
v_mul_f32 v18, v18, v20
v_mul_f32 v19, v19, v21
v_mfma_f32_16x16x32_bf16 a[136:139], a[44:47], a[100:103], a[136:139]
buffer_load_dwordx4 v15, s[36:39], s64 offen lds
v_mfma_f32_16x16x32_bf16 a[140:143], a[36:39], a[100:103], a[140:143]
v_cvt_pk_bf16_f32 v18, v18, v19
v_lshlrev_b32 v19, 16, v18
v_mfma_f32_16x16x32_bf16 a[140:143], a[32:35], a[96:99], a[140:143]
s_waitcnt lgkmcnt(4)
ds_read_b64_tr_b16 a[96:97], v9 offset:32768
v_and_b32 v18, 0xffff0000, v18
v_mfma_f32_16x16x32_bf16 v[184:187], a[104:107], a[0:3], v[184:187]
ds_read_b64_tr_b16 a[98:99], v9 offset:33792
v_add_f32 v17, v17, v19
v_mfma_f32_16x16x32_bf16 v[184:187], a[108:111], a[4:7], v[184:187]
ds_read_b64_tr_b16 a[100:101], v9 offset:40960
v_add_f32 v17, v17, v18
v_mfma_f32_16x16x32_bf16 v[192:195], a[108:111], a[12:15], v[192:195]
ds_read_b64_tr_b16 a[102:103], v9 offset:41984
v_accvgpr_read_b32 v19, a155
v_mfma_f32_16x16x32_bf16 v[192:195], a[104:107], a[8:11], v[192:195]
s_xor_b32 m0, s77, 81920
v_accvgpr_read_b32 v21, a171
v_lshlrev_b32 v18, 16, v19
v_mfma_f32_16x16x32_bf16 v[200:203], a[104:107], a[16:19], v[200:203]
s_xor_b32 s64, s71, 3145728
v_and_b32 v19, 0xffff0000, v19
v_lshlrev_b32 v20, 16, v21
v_mfma_f32_16x16x32_bf16 v[200:203], a[108:111], a[20:23], v[200:203]
buffer_load_dwordx4 v14, s[40:43], s64 offen lds
v_mfma_f32_16x16x32_bf16 v[208:211], a[108:111], a[28:31], v[208:211]
v_and_b32 v21, 0xffff0000, v21
v_mul_f32 v18, v18, v20
v_mfma_f32_16x16x32_bf16 v[208:211], a[104:107], a[24:27], v[208:211]
ds_read_b64_tr_b16 a[104:105], v10 offset:32768
v_mul_f32 v19, v19, v21
v_mfma_f32_16x16x32_bf16 v[212:215], a[112:115], a[24:27], v[212:215]
ds_read_b64_tr_b16 a[106:107], v10 offset:33792
v_cvt_pk_bf16_f32 v18, v18, v19
v_mfma_f32_16x16x32_bf16 v[212:215], a[116:119], a[28:31], v[212:215]
ds_read_b64_tr_b16 a[108:109], v10 offset:40960
v_lshlrev_b32 v19, 16, v18
v_mfma_f32_16x16x32_bf16 v[204:207], a[116:119], a[20:23], v[204:207]
ds_read_b64_tr_b16 a[110:111], v10 offset:41984
v_and_b32 v18, 0xffff0000, v18
v_mfma_f32_16x16x32_bf16 v[204:207], a[112:115], a[16:19], v[204:207]
s_xor_b32 m0, s77, 82944
v_add_f32 v17, v17, v19
v_add_f32 v17, v17, v18
v_mfma_f32_16x16x32_bf16 v[196:199], a[112:115], a[8:11], v[196:199]
s_xor_b32 s64, s71, 3178496
v_accvgpr_read_b32 v19, a156
v_accvgpr_read_b32 v21, a172
v_mfma_f32_16x16x32_bf16 v[196:199], a[116:119], a[12:15], v[196:199]
buffer_load_dwordx4 v14, s[40:43], s64 offen lds
v_mfma_f32_16x16x32_bf16 v[188:191], a[116:119], a[4:7], v[188:191]
v_lshlrev_b32 v18, 16, v19
v_and_b32 v19, 0xffff0000, v19
v_mfma_f32_16x16x32_bf16 v[188:191], a[112:115], a[0:3], v[188:191]
ds_read_b64_tr_b16 a[112:113], v11 offset:32768
v_lshlrev_b32 v20, 16, v21
v_mfma_f32_16x16x32_bf16 v[216:219], a[72:75], a[0:3], v[216:219]
ds_read_b64_tr_b16 a[114:115], v11 offset:33792
v_and_b32 v21, 0xffff0000, v21
v_mfma_f32_16x16x32_bf16 v[216:219], a[76:79], a[4:7], v[216:219]
ds_read_b64_tr_b16 a[116:117], v11 offset:40960
v_mul_f32 v18, v18, v20
v_mfma_f32_16x16x32_bf16 v[224:227], a[76:79], a[12:15], v[224:227]
ds_read_b64_tr_b16 a[118:119], v11 offset:41984
v_mul_f32 v19, v19, v21
v_mfma_f32_16x16x32_bf16 v[224:227], a[72:75], a[8:11], v[224:227]
s_xor_b32 m0, s77, 83968
v_cvt_pk_bf16_f32 v18, v18, v19
v_lshlrev_b32 v19, 16, v18
v_mfma_f32_16x16x32_bf16 v[232:235], a[72:75], a[16:19], v[232:235]
s_xor_b32 s64, s71, 3211264
v_and_b32 v18, 0xffff0000, v18
v_add_f32 v17, v17, v19
v_mfma_f32_16x16x32_bf16 v[232:235], a[76:79], a[20:23], v[232:235]
buffer_load_dwordx4 v15, s[40:43], s64 offen lds
v_mfma_f32_16x16x32_bf16 v[240:243], a[76:79], a[28:31], v[240:243]
v_add_f32 v17, v17, v18
v_accvgpr_read_b32 v19, a157
v_mfma_f32_16x16x32_bf16 v[240:243], a[72:75], a[24:27], v[240:243]
s_add_u32 s82, s82, 1048576
ds_read_b64_tr_b16 a[72:73], v4 offset:49152
v_accvgpr_read_b32 v21, a173
v_mfma_f32_16x16x32_bf16 v[244:247], a[80:83], a[24:27], v[244:247]
buffer_load_dword a252, v1, s[60:63], s82 offen
v_mfma_f32_16x16x32_bf16 v[244:247], a[84:87], a[28:31], v[244:247]
ds_read_b64_tr_b16 a[74:75], v4 offset:50176
v_lshlrev_b32 v18, 16, v19
v_mfma_f32_16x16x32_bf16 v[236:239], a[84:87], a[20:23], v[236:239]
ds_read_b64_tr_b16 a[76:77], v4 offset:57344
v_and_b32 v19, 0xffff0000, v19
v_mfma_f32_16x16x32_bf16 v[236:239], a[80:83], a[16:19], v[236:239]
s_xor_b32 m0, s77, 84992
ds_read_b64_tr_b16 a[78:79], v4 offset:58368
v_lshlrev_b32 v20, 16, v21
v_mfma_f32_16x16x32_bf16 v[228:231], a[80:83], a[8:11], v[228:231]
s_xor_b32 s64, s71, 3244032
v_and_b32 v21, 0xffff0000, v21
v_mul_f32 v18, v18, v20
v_mfma_f32_16x16x32_bf16 v[228:231], a[84:87], a[12:15], v[228:231]
buffer_load_dwordx4 v15, s[40:43], s64 offen lds
v_mfma_f32_16x16x32_bf16 v[220:223], a[84:87], a[4:7], v[220:223]
v_mul_f32 v19, v19, v21
v_cvt_pk_bf16_f32 v18, v18, v19
v_mfma_f32_16x16x32_bf16 v[220:223], a[80:83], a[0:3], v[220:223]
s_waitcnt lgkmcnt(4)
ds_read_b64_tr_b16 a[80:81], v5 offset:49152
v_lshlrev_b32 v19, 16, v18
v_mfma_f32_16x16x32_bf16 v[152:155], a[88:91], a[0:3], v[152:155]
ds_read_b64_tr_b16 a[82:83], v5 offset:50176
v_and_b32 v18, 0xffff0000, v18
v_mfma_f32_16x16x32_bf16 v[152:155], a[92:95], a[4:7], v[152:155]
ds_read_b64_tr_b16 a[84:85], v5 offset:57344
v_add_f32 v17, v17, v19
v_mfma_f32_16x16x32_bf16 v[160:163], a[92:95], a[12:15], v[160:163]
ds_read_b64_tr_b16 a[86:87], v5 offset:58368
v_add_f32 v17, v17, v18
v_mfma_f32_16x16x32_bf16 v[160:163], a[88:91], a[8:11], v[160:163]
v_accvgpr_read_b32 v19, a158
v_accvgpr_read_b32 v21, a174
v_mfma_f32_16x16x32_bf16 v[168:171], a[88:91], a[16:19], v[168:171]
v_lshlrev_b32 v18, 16, v19
v_and_b32 v19, 0xffff0000, v19
v_mfma_f32_16x16x32_bf16 v[168:171], a[92:95], a[20:23], v[168:171]
v_lshlrev_b32 v20, 16, v21
v_and_b32 v21, 0xffff0000, v21
v_mfma_f32_16x16x32_bf16 v[176:179], a[92:95], a[28:31], v[176:179]
s_xor_b32 m0, s84, 0
v_mul_f32 v18, v18, v20
v_mul_f32 v19, v19, v21
v_mfma_f32_16x16x32_bf16 v[176:179], a[88:91], a[24:27], v[176:179]
s_xor_b32 s64, s70, 768
ds_read_b64_tr_b16 a[88:89], v6 offset:49152
v_cvt_pk_bf16_f32 v18, v18, v19
v_mfma_f32_16x16x32_bf16 v[180:183], a[96:99], a[24:27], v[180:183]
buffer_load_dwordx4 v12, s[32:35], s64 offen lds
v_mfma_f32_16x16x32_bf16 v[180:183], a[100:103], a[28:31], v[180:183]
ds_read_b64_tr_b16 a[90:91], v6 offset:50176
v_lshlrev_b32 v19, 16, v18
v_mfma_f32_16x16x32_bf16 v[172:175], a[100:103], a[20:23], v[172:175]
ds_read_b64_tr_b16 a[92:93], v6 offset:57344
v_and_b32 v18, 0xffff0000, v18
v_mfma_f32_16x16x32_bf16 v[172:175], a[96:99], a[16:19], v[172:175]
ds_read_b64_tr_b16 a[94:95], v6 offset:58368
v_add_f32 v17, v17, v19
v_mfma_f32_16x16x32_bf16 v[164:167], a[96:99], a[8:11], v[164:167]
v_add_f32 v17, v17, v18
v_accvgpr_read_b32 v19, a159
v_mfma_f32_16x16x32_bf16 v[164:167], a[100:103], a[12:15], v[164:167]
s_xor_b32 m0, s84, 1024
v_accvgpr_read_b32 v21, a175
v_lshlrev_b32 v18, 16, v19
v_mfma_f32_16x16x32_bf16 v[156:159], a[100:103], a[4:7], v[156:159]
s_xor_b32 s64, s70, 8960
v_and_b32 v19, 0xffff0000, v19
v_lshlrev_b32 v20, 16, v21
v_mfma_f32_16x16x32_bf16 v[156:159], a[96:99], a[0:3], v[156:159]
buffer_load_dwordx4 v13, s[32:35], s64 offen lds
v_mfma_f32_16x16x32_bf16 v[24:27], a[104:107], a[0:3], v[24:27]
ds_read_b64_tr_b16 a[96:97], v7 offset:49152
v_and_b32 v21, 0xffff0000, v21
v_mfma_f32_16x16x32_bf16 v[24:27], a[108:111], a[4:7], v[24:27]
ds_read_b64_tr_b16 a[98:99], v7 offset:50176
v_mul_f32 v18, v18, v20
v_mfma_f32_16x16x32_bf16 v[40:43], a[108:111], a[12:15], v[40:43]
ds_read_b64_tr_b16 a[100:101], v7 offset:57344
v_mul_f32 v19, v19, v21
v_mfma_f32_16x16x32_bf16 v[40:43], a[104:107], a[8:11], v[40:43]
ds_read_b64_tr_b16 a[102:103], v7 offset:58368
v_cvt_pk_bf16_f32 v18, v18, v19
v_mfma_f32_16x16x32_bf16 v[56:59], a[104:107], a[16:19], v[56:59]
s_xor_b32 m0, s84, 2048
v_lshlrev_b32 v19, 16, v18
v_and_b32 v18, 0xffff0000, v18
v_mfma_f32_16x16x32_bf16 v[56:59], a[108:111], a[20:23], v[56:59]
s_xor_b32 s64, s70, 17152
v_add_f32 v17, v17, v19
v_add_f32 v17, v17, v18
v_mfma_f32_16x16x32_bf16 v[72:75], a[108:111], a[28:31], v[72:75]
s_waitcnt vmcnt(12)
buffer_load_dwordx4 v12, s[32:35], s64 offen lds
v_mfma_f32_16x16x32_bf16 v[72:75], a[104:107], a[24:27], v[72:75]
s_add_u32 s81, s81, 1048576
ds_read_b64_tr_b16 a[104:105], v8 offset:49152
v_add_f32_dpp v17, v17, v17 row_ror:8 row_mask:0xf bank_mask:0xf
v_mfma_f32_16x16x32_bf16 v[136:139], a[112:115], a[24:27], v[136:139]
buffer_load_dword a252, v16, s[56:59], s81 offen
v_mfma_f32_16x16x32_bf16 v[136:139], a[116:119], a[28:31], v[136:139]
ds_read_b64_tr_b16 a[106:107], v8 offset:50176
v_add_u32 v4, 0x8000, v4
v_mfma_f32_16x16x32_bf16 v[120:123], a[116:119], a[20:23], v[120:123]
ds_read_b64_tr_b16 a[108:109], v8 offset:57344
v_add_f32_dpp v17, v17, v17 row_ror:4 row_mask:0xf bank_mask:0xf
v_mfma_f32_16x16x32_bf16 v[120:123], a[112:115], a[16:19], v[120:123]
s_xor_b32 m0, s84, 3072
ds_read_b64_tr_b16 a[110:111], v8 offset:58368
v_mfma_f32_16x16x32_bf16 v[104:107], a[112:115], a[8:11], v[104:107]
s_xor_b32 s64, s70, 25344
ds_read_b128 a[32:35], v2 offset:32768
v_add_f32_dpp v17, v17, v17 row_ror:2 row_mask:0xf bank_mask:0xf
v_mfma_f32_16x16x32_bf16 v[104:107], a[116:119], a[12:15], v[104:107]
buffer_load_dwordx4 v13, s[32:35], s64 offen lds
v_mfma_f32_16x16x32_bf16 v[88:91], a[116:119], a[4:7], v[88:91]
ds_read_b128 a[36:39], v3 offset:32768
v_add_f32_dpp v17, v17, v17 row_ror:1 row_mask:0xf bank_mask:0xf
v_mfma_f32_16x16x32_bf16 v[88:91], a[112:115], a[0:3], v[88:91]
s_waitcnt lgkmcnt(6)
ds_read_b128 a[40:43], v2 offset:34816
v_mov_b32 v18, v17
v_mfma_f32_16x16x32_bf16 v[28:31], a[0:3], a[72:75], v[28:31]
ds_read_b128 a[44:47], v3 offset:34816
v_mfma_f32_16x16x32_bf16 v[28:31], a[4:7], a[76:79], v[28:31]
ds_read_b128 a[48:51], v2 offset:36864
v_add_u32 v5, 0x8000, v5
v_mfma_f32_16x16x32_bf16 v[44:47], a[12:15], a[76:79], v[44:47]
s_xor_b32 m0, s84, 4096
ds_read_b128 a[52:55], v3 offset:36864
v_permlane16_swap_b32 v18, v17
v_mfma_f32_16x16x32_bf16 v[44:47], a[8:11], a[72:75], v[44:47]
s_xor_b32 s64, s70, 33536
ds_read_b128 a[56:59], v2 offset:38912
v_add_f32 v17, v17, v18
v_mfma_f32_16x16x32_bf16 v[60:63], a[16:19], a[72:75], v[60:63]
buffer_load_dwordx4 v12, s[32:35], s64 offen lds
v_mfma_f32_16x16x32_bf16 v[60:63], a[20:23], a[76:79], v[60:63]
ds_read_b128 a[60:63], v3 offset:38912
v_cvt_pk_bf16_f32 v17, v17, v17
v_mfma_f32_16x16x32_bf16 v[76:79], a[28:31], a[76:79], v[76:79]
ds_read_b64_tr_b16 a[112:113], v9 offset:49152
v_and_b32 v17, 0xffff0000, v17
v_mfma_f32_16x16x32_bf16 v[76:79], a[24:27], a[72:75], v[76:79]
ds_read_b64_tr_b16 a[114:115], v9 offset:50176
v_mul_f32 v17, 0xbfb8aa3b, v17
v_mfma_f32_16x16x32_bf16 v[140:143], a[24:27], a[80:83], v[140:143]
ds_read_b64_tr_b16 a[116:117], v9 offset:57344
v_mfma_f32_16x16x32_bf16 v[140:143], a[28:31], a[84:87], v[140:143]
s_xor_b32 m0, s84, 5120
ds_read_b64_tr_b16 a[118:119], v9 offset:58368
v_add_u32 v6, 0x8000, v6
v_mfma_f32_16x16x32_bf16 v[124:127], a[20:23], a[84:87], v[124:127]
s_xor_b32 s64, s70, 41728
ds_read_b64_tr_b16 a[72:73], v10 offset:49152
v_mfma_f32_16x16x32_bf16 v[124:127], a[16:19], a[80:83], v[124:127]
buffer_load_dwordx4 v13, s[32:35], s64 offen lds
v_mfma_f32_16x16x32_bf16 v[108:111], a[8:11], a[80:83], v[108:111]
ds_read_b64_tr_b16 a[74:75], v10 offset:50176
v_mfma_f32_16x16x32_bf16 v[108:111], a[12:15], a[84:87], v[108:111]
ds_read_b64_tr_b16 a[76:77], v10 offset:57344
v_mfma_f32_16x16x32_bf16 v[92:95], a[4:7], a[84:87], v[92:95]
ds_read_b64_tr_b16 a[78:79], v10 offset:58368
v_mfma_f32_16x16x32_bf16 v[92:95], a[0:3], a[80:83], v[92:95]
ds_read_b64_tr_b16 a[80:81], v11 offset:49152
v_mfma_f32_16x16x32_bf16 v[32:35], a[0:3], a[88:91], v[32:35]
s_xor_b32 m0, s84, 6144
ds_read_b64_tr_b16 a[82:83], v11 offset:50176
v_mfma_f32_16x16x32_bf16 v[32:35], a[4:7], a[92:95], v[32:35]
s_xor_b32 s64, s70, 49920
ds_read_b64_tr_b16 a[84:85], v11 offset:57344
v_add_u32 v7, 0x8000, v7
v_mfma_f32_16x16x32_bf16 v[48:51], a[12:15], a[92:95], v[48:51]
buffer_load_dwordx4 v12, s[32:35], s64 offen lds
v_mfma_f32_16x16x32_bf16 v[48:51], a[8:11], a[88:91], v[48:51]
ds_read_b64_tr_b16 a[86:87], v11 offset:58368
v_mfma_f32_16x16x32_bf16 v[64:67], a[16:19], a[88:91], v[64:67]
v_exp_f32 v17, v17
v_mfma_f32_16x16x32_bf16 v[64:67], a[20:23], a[92:95], v[64:67]
v_add_f32 v17, 1.0, v17
v_mfma_f32_16x16x32_bf16 v[80:83], a[28:31], a[92:95], v[80:83]
v_rcp_f32 v17, v17
v_mfma_f32_16x16x32_bf16 v[80:83], a[24:27], a[88:91], v[80:83]
s_xor_b32 m0, s84, 7168
s_add_u32 s81, s81, 1048576
v_cvt_pk_bf16_f32 v18, v17, v17
v_mfma_f32_16x16x32_bf16 v[144:147], a[24:27], a[96:99], v[144:147]
s_xor_b32 s64, s70, 58112
buffer_load_dword a252, v16, s[56:59], s81 offen
v_mfma_f32_16x16x32_bf16 v[144:147], a[28:31], a[100:103], v[144:147]
s_branch L_po4
L_pg4:
s_branch L_tr0
L_po4:
buffer_load_dwordx4 v13, s[32:35], s64 offen lds
v_mfma_f32_16x16x32_bf16 v[128:131], a[20:23], a[100:103], v[128:131]
v_add_u32 v8, 0x8000, v8
v_and_b32 v18, 0xffff0000, v18
v_mfma_f32_16x16x32_bf16 v[128:131], a[16:19], a[96:99], v[128:131]
v_sub_f32 v19, 1.0, v18
v_mfma_f32_16x16x32_bf16 v[112:115], a[8:11], a[96:99], v[112:115]
v_cvt_pk_bf16_f32 v19, v19, v19
v_mfma_f32_16x16x32_bf16 v[112:115], a[12:15], a[100:103], v[112:115]
v_and_b32 v19, 0xffff0000, v19
v_mfma_f32_16x16x32_bf16 v[96:99], a[4:7], a[100:103], v[96:99]
v_add_u32 v9, 0x8000, v9
v_add_u32 v10, 0x8000, v10
v_mfma_f32_16x16x32_bf16 v[96:99], a[0:3], a[96:99], v[96:99]
s_waitcnt lgkmcnt(0)
v_add_u32 v11, 0x8000, v11
v_and_b32 v20, 31, v0
v_mfma_f32_16x16x32_bf16 v[36:39], a[0:3], a[104:107], v[36:39]
v_lshlrev_b32 v20, 27, v20
v_mfma_f32_16x16x32_bf16 v[36:39], a[4:7], a[108:111], v[36:39]
v_lshrrev_b32 v21, 2, v0
v_mfma_f32_16x16x32_bf16 v[52:55], a[12:15], a[108:111], v[52:55]
s_waitcnt lgkmcnt(0)
s_barrier
v_mfma_f32_16x16x32_bf16 v[52:55], a[8:11], a[104:107], v[52:55]
s_xor_b32 m0, s77, 98304
ds_read_b64_tr_b16 a[88:89], v4 offset:32768
v_add_u32 v20, v20, v21
v_mfma_f32_16x16x32_bf16 v[68:71], a[16:19], a[104:107], v[68:71]
s_xor_b32 s64, s71, 3670016
ds_read_b64_tr_b16 a[90:91], v4 offset:33792
v_mfma_f32_16x16x32_bf16 v[68:71], a[20:23], a[108:111], v[68:71]
buffer_load_dwordx4 v14, s[36:39], s64 offen lds
v_mfma_f32_16x16x32_bf16 v[84:87], a[28:31], a[108:111], v[84:87]
ds_read_b64_tr_b16 a[92:93], v4 offset:40960
v_mfma_f32_16x16x32_bf16 v[84:87], a[24:27], a[104:107], v[84:87]
ds_read_b64_tr_b16 a[94:95], v4 offset:41984
v_mfma_f32_16x16x32_bf16 v[148:151], a[24:27], a[112:115], v[148:151]
ds_read_b64_tr_b16 a[96:97], v5 offset:32768
v_mfma_f32_16x16x32_bf16 v[148:151], a[28:31], a[116:119], v[148:151]
ds_read_b64_tr_b16 a[98:99], v5 offset:33792
v_mfma_f32_16x16x32_bf16 v[132:135], a[20:23], a[116:119], v[132:135]
ds_read_b64_tr_b16 a[100:101], v5 offset:40960
v_mfma_f32_16x16x32_bf16 v[132:135], a[16:19], a[112:115], v[132:135]
s_xor_b32 m0, s77, 99328
ds_read_b64_tr_b16 a[102:103], v5 offset:41984
v_mfma_f32_16x16x32_bf16 v[116:119], a[8:11], a[112:115], v[116:119]
s_xor_b32 s64, s71, 3702784
ds_read_b64_tr_b16 a[104:105], v6 offset:32768
v_mfma_f32_16x16x32_bf16 v[116:119], a[12:15], a[116:119], v[116:119]
buffer_load_dwordx4 v14, s[36:39], s64 offen lds
v_mfma_f32_16x16x32_bf16 v[100:103], a[4:7], a[116:119], v[100:103]
ds_read_b64_tr_b16 a[106:107], v6 offset:33792
v_mfma_f32_16x16x32_bf16 v[100:103], a[0:3], a[112:115], v[100:103]
ds_read_b64_tr_b16 a[108:109], v6 offset:40960
v_mfma_f32_16x16x32_bf16 v[248:251], a[0:3], a[72:75], v[248:251]
ds_read_b64_tr_b16 a[110:111], v6 offset:41984
v_mfma_f32_16x16x32_bf16 v[248:251], a[4:7], a[76:79], v[248:251]
ds_read_b64_tr_b16 a[112:113], v7 offset:32768
v_mfma_f32_16x16x32_bf16 v[252:255], a[12:15], a[76:79], v[252:255]
ds_read_b64_tr_b16 a[114:115], v7 offset:33792
v_mfma_f32_16x16x32_bf16 v[252:255], a[8:11], a[72:75], v[252:255]
s_xor_b32 m0, s77, 100352
ds_read_b64_tr_b16 a[116:117], v7 offset:40960
v_mfma_f32_16x16x32_bf16 a[120:123], a[16:19], a[72:75], a[120:123]
s_xor_b32 s64, s71, 3735552
s_lshl2_add_u32 s65, s2, s30
ds_read_b64_tr_b16 a[118:119], v7 offset:41984
v_mfma_f32_16x16x32_bf16 a[120:123], a[20:23], a[76:79], a[120:123]
s_lshl4_add_u32 s65, s65, 58720256
buffer_load_dwordx4 v15, s[36:39], s64 offen lds
v_mfma_f32_16x16x32_bf16 a[124:127], a[28:31], a[76:79], a[124:127]
buffer_store_dwordx2 v[18:19], v20, s[44:47], s65 offen sc1
v_mfma_f32_16x16x32_bf16 a[124:127], a[24:27], a[72:75], a[124:127]
s_add_u32 s82, s82, 1048576
ds_read_b64_tr_b16 a[72:73], v8 offset:32768
v_lshrrev_b32 v21, 4, v0
v_mfma_f32_16x16x32_bf16 a[128:131], a[24:27], a[80:83], a[128:131]
buffer_load_dword a252, v1, s[60:63], s82 offen
v_mfma_f32_16x16x32_bf16 a[128:131], a[28:31], a[84:87], a[128:131]
ds_read_b64_tr_b16 a[74:75], v8 offset:33792
v_bfe_u32 v19, v0, 2, 2
v_mfma_f32_16x16x32_bf16 a[132:135], a[20:23], a[84:87], a[132:135]
ds_read_b64_tr_b16 a[76:77], v8 offset:40960
v_lshl_add_u32 v19, v21, 3, v19
v_mfma_f32_16x16x32_bf16 a[132:135], a[16:19], a[80:83], a[132:135]
s_xor_b32 m0, s77, 101376
ds_read_b64_tr_b16 a[78:79], v8 offset:41984
v_lshlrev_b32 v19, 6, v19
v_mfma_f32_16x16x32_bf16 a[136:139], a[8:11], a[80:83], a[136:139]
s_xor_b32 s64, s71, 3768320
v_and_b32 v21, 1, v21
v_mfma_f32_16x16x32_bf16 a[136:139], a[12:15], a[84:87], a[136:139]
buffer_load_dwordx4 v15, s[36:39], s64 offen lds
v_mfma_f32_16x16x32_bf16 a[140:143], a[4:7], a[84:87], a[140:143]
v_lshl_add_u32 v19, v21, 5, v19
v_mfma_f32_16x16x32_bf16 a[140:143], a[0:3], a[80:83], a[140:143]
s_waitcnt lgkmcnt(4)
ds_read_b64_tr_b16 a[80:81], v9 offset:32768
v_and_b32 v21, 3, v0
v_mfma_f32_16x16x32_bf16 v[184:187], a[88:91], a[32:35], v[184:187]
ds_read_b64_tr_b16 a[82:83], v9 offset:33792
v_lshl_add_u32 v19, v21, 3, v19
v_mfma_f32_16x16x32_bf16 v[184:187], a[92:95], a[36:39], v[184:187]
ds_read_b64_tr_b16 a[84:85], v9 offset:40960
v_add_u32 v19, 114688, v19
v_mfma_f32_16x16x32_bf16 v[192:195], a[92:95], a[44:47], v[192:195]
ds_read_b64_tr_b16 a[86:87], v9 offset:41984
v_xor_b32 v20, 32, v19
v_mfma_f32_16x16x32_bf16 v[192:195], a[88:91], a[40:43], v[192:195]
s_xor_b32 m0, s77, 114688
v_mfma_f32_16x16x32_bf16 v[200:203], a[88:91], a[48:51], v[200:203]
s_xor_b32 s64, s71, 3670016
v_mfma_f32_16x16x32_bf16 v[200:203], a[92:95], a[52:55], v[200:203]
buffer_load_dwordx4 v14, s[40:43], s64 offen lds
v_mfma_f32_16x16x32_bf16 v[208:211], a[92:95], a[60:63], v[208:211]
v_mfma_f32_16x16x32_bf16 v[208:211], a[88:91], a[56:59], v[208:211]
ds_read_b64_tr_b16 a[88:89], v10 offset:32768
v_mfma_f32_16x16x32_bf16 v[212:215], a[96:99], a[56:59], v[212:215]
ds_read_b64_tr_b16 a[90:91], v10 offset:33792
v_mfma_f32_16x16x32_bf16 v[212:215], a[100:103], a[60:63], v[212:215]
ds_read_b64_tr_b16 a[92:93], v10 offset:40960
v_mfma_f32_16x16x32_bf16 v[204:207], a[100:103], a[52:55], v[204:207]
ds_read_b64_tr_b16 a[94:95], v10 offset:41984
v_mfma_f32_16x16x32_bf16 v[204:207], a[96:99], a[48:51], v[204:207]
s_xor_b32 m0, s77, 115712
v_mfma_f32_16x16x32_bf16 v[196:199], a[96:99], a[40:43], v[196:199]
s_xor_b32 s64, s71, 3702784
v_mfma_f32_16x16x32_bf16 v[196:199], a[100:103], a[44:47], v[196:199]
buffer_load_dwordx4 v14, s[40:43], s64 offen lds
v_mfma_f32_16x16x32_bf16 v[188:191], a[100:103], a[36:39], v[188:191]
v_mfma_f32_16x16x32_bf16 v[188:191], a[96:99], a[32:35], v[188:191]
ds_read_b64_tr_b16 a[96:97], v11 offset:32768
v_mfma_f32_16x16x32_bf16 v[216:219], a[104:107], a[32:35], v[216:219]
ds_read_b64_tr_b16 a[98:99], v11 offset:33792
v_mfma_f32_16x16x32_bf16 v[216:219], a[108:111], a[36:39], v[216:219]
ds_read_b64_tr_b16 a[100:101], v11 offset:40960
v_mfma_f32_16x16x32_bf16 v[224:227], a[108:111], a[44:47], v[224:227]
ds_read_b64_tr_b16 a[102:103], v11 offset:41984
v_mfma_f32_16x16x32_bf16 v[224:227], a[104:107], a[40:43], v[224:227]
s_xor_b32 m0, s77, 116736
v_mfma_f32_16x16x32_bf16 v[232:235], a[104:107], a[48:51], v[232:235]
s_xor_b32 s64, s71, 3735552
v_mfma_f32_16x16x32_bf16 v[232:235], a[108:111], a[52:55], v[232:235]
buffer_load_dwordx4 v15, s[40:43], s64 offen lds
v_mfma_f32_16x16x32_bf16 v[240:243], a[108:111], a[60:63], v[240:243]
v_mfma_f32_16x16x32_bf16 v[240:243], a[104:107], a[56:59], v[240:243]
s_add_u32 s81, s81, 1048576
ds_read_b64_tr_b16 a[104:105], v4 offset:49152
v_mfma_f32_16x16x32_bf16 v[244:247], a[112:115], a[56:59], v[244:247]
buffer_load_dword a252, v16, s[56:59], s81 offen
v_mfma_f32_16x16x32_bf16 v[244:247], a[116:119], a[60:63], v[244:247]
ds_read_b64_tr_b16 a[106:107], v4 offset:50176
v_mfma_f32_16x16x32_bf16 v[236:239], a[116:119], a[52:55], v[236:239]
ds_read_b64_tr_b16 a[108:109], v4 offset:57344
v_mfma_f32_16x16x32_bf16 v[236:239], a[112:115], a[48:51], v[236:239]
s_xor_b32 m0, s77, 117760
ds_read_b64_tr_b16 a[110:111], v4 offset:58368
v_mfma_f32_16x16x32_bf16 v[228:231], a[112:115], a[40:43], v[228:231]
s_xor_b32 s64, s71, 3768320
v_mfma_f32_16x16x32_bf16 v[228:231], a[116:119], a[44:47], v[228:231]
buffer_load_dwordx4 v15, s[40:43], s64 offen lds
v_mfma_f32_16x16x32_bf16 v[220:223], a[116:119], a[36:39], v[220:223]
v_mfma_f32_16x16x32_bf16 v[220:223], a[112:115], a[32:35], v[220:223]
s_waitcnt lgkmcnt(4)
ds_read_b64_tr_b16 a[112:113], v5 offset:49152
v_mfma_f32_16x16x32_bf16 v[152:155], a[72:75], a[32:35], v[152:155]
ds_read_b64_tr_b16 a[114:115], v5 offset:50176
v_mfma_f32_16x16x32_bf16 v[152:155], a[76:79], a[36:39], v[152:155]
ds_read_b64_tr_b16 a[116:117], v5 offset:57344
v_mfma_f32_16x16x32_bf16 v[160:163], a[76:79], a[44:47], v[160:163]
ds_read_b64_tr_b16 a[118:119], v5 offset:58368
v_mfma_f32_16x16x32_bf16 v[160:163], a[72:75], a[40:43], v[160:163]
v_mfma_f32_16x16x32_bf16 v[168:171], a[72:75], a[48:51], v[168:171]
v_mfma_f32_16x16x32_bf16 v[168:171], a[76:79], a[52:55], v[168:171]
v_mfma_f32_16x16x32_bf16 v[176:179], a[76:79], a[60:63], v[176:179]
s_xor_b32 m0, s84, 32768
v_mfma_f32_16x16x32_bf16 v[176:179], a[72:75], a[56:59], v[176:179]
s_xor_b32 s64, s70, 896
ds_read_b64_tr_b16 a[72:73], v6 offset:49152
v_mfma_f32_16x16x32_bf16 v[180:183], a[80:83], a[56:59], v[180:183]
buffer_load_dwordx4 v12, s[32:35], s64 offen lds
v_mfma_f32_16x16x32_bf16 v[180:183], a[84:87], a[60:63], v[180:183]
ds_read_b64_tr_b16 a[74:75], v6 offset:50176
v_mfma_f32_16x16x32_bf16 v[172:175], a[84:87], a[52:55], v[172:175]
ds_read_b64_tr_b16 a[76:77], v6 offset:57344
v_mfma_f32_16x16x32_bf16 v[172:175], a[80:83], a[48:51], v[172:175]
ds_read_b64_tr_b16 a[78:79], v6 offset:58368
v_mfma_f32_16x16x32_bf16 v[164:167], a[80:83], a[40:43], v[164:167]
v_mfma_f32_16x16x32_bf16 v[164:167], a[84:87], a[44:47], v[164:167]
s_xor_b32 m0, s84, 33792
v_mfma_f32_16x16x32_bf16 v[156:159], a[84:87], a[36:39], v[156:159]
s_xor_b32 s64, s70, 9088
v_mfma_f32_16x16x32_bf16 v[156:159], a[80:83], a[32:35], v[156:159]
buffer_load_dwordx4 v13, s[32:35], s64 offen lds
v_mfma_f32_16x16x32_bf16 v[24:27], a[88:91], a[32:35], v[24:27]
ds_read_b64_tr_b16 a[80:81], v7 offset:49152
v_mfma_f32_16x16x32_bf16 v[24:27], a[92:95], a[36:39], v[24:27]
ds_read_b64_tr_b16 a[82:83], v7 offset:50176
v_mfma_f32_16x16x32_bf16 v[40:43], a[92:95], a[44:47], v[40:43]
ds_read_b64_tr_b16 a[84:85], v7 offset:57344
v_mfma_f32_16x16x32_bf16 v[40:43], a[88:91], a[40:43], v[40:43]
ds_read_b64_tr_b16 a[86:87], v7 offset:58368
v_mfma_f32_16x16x32_bf16 v[56:59], a[88:91], a[48:51], v[56:59]
s_xor_b32 m0, s84, 34816
v_mfma_f32_16x16x32_bf16 v[56:59], a[92:95], a[52:55], v[56:59]
s_xor_b32 s64, s70, 17280
v_mfma_f32_16x16x32_bf16 v[72:75], a[92:95], a[60:63], v[72:75]
s_waitcnt vmcnt(13)
buffer_load_dwordx4 v12, s[32:35], s64 offen lds
v_mfma_f32_16x16x32_bf16 v[72:75], a[88:91], a[56:59], v[72:75]
s_add_u32 s82, s82, 1048576
ds_read_b64_tr_b16 a[88:89], v8 offset:49152
v_mfma_f32_16x16x32_bf16 v[136:139], a[96:99], a[56:59], v[136:139]
buffer_load_dword a252, v1, s[60:63], s82 offen
v_mfma_f32_16x16x32_bf16 v[136:139], a[100:103], a[60:63], v[136:139]
ds_read_b64_tr_b16 a[90:91], v8 offset:50176
v_subrev_u32 v4, 0x8000, v4
v_mfma_f32_16x16x32_bf16 v[120:123], a[100:103], a[52:55], v[120:123]
ds_read_b64_tr_b16 a[92:93], v8 offset:57344
v_mfma_f32_16x16x32_bf16 v[120:123], a[96:99], a[48:51], v[120:123]
s_xor_b32 m0, s84, 35840
ds_read_b64_tr_b16 a[94:95], v8 offset:58368
v_mfma_f32_16x16x32_bf16 v[104:107], a[96:99], a[40:43], v[104:107]
s_xor_b32 s64, s70, 25472
ds_read_b128 a[0:3], v2 offset:0
v_mfma_f32_16x16x32_bf16 v[104:107], a[100:103], a[44:47], v[104:107]
buffer_load_dwordx4 v13, s[32:35], s64 offen lds
v_mfma_f32_16x16x32_bf16 v[88:91], a[100:103], a[36:39], v[88:91]
ds_read_b128 a[4:7], v3 offset:0
v_mfma_f32_16x16x32_bf16 v[88:91], a[96:99], a[32:35], v[88:91]
s_waitcnt lgkmcnt(6)
ds_read_b128 a[8:11], v2 offset:2048
v_mfma_f32_16x16x32_bf16 v[28:31], a[32:35], a[104:107], v[28:31]
ds_read_b128 a[12:15], v3 offset:2048
v_mfma_f32_16x16x32_bf16 v[28:31], a[36:39], a[108:111], v[28:31]
ds_read_b128 a[16:19], v2 offset:4096
v_subrev_u32 v5, 0x8000, v5
v_mfma_f32_16x16x32_bf16 v[44:47], a[44:47], a[108:111], v[44:47]
s_xor_b32 m0, s84, 36864
ds_read_b128 a[20:23], v3 offset:4096
v_mfma_f32_16x16x32_bf16 v[44:47], a[40:43], a[104:107], v[44:47]
s_xor_b32 s64, s70, 33664
ds_read_b128 a[24:27], v2 offset:6144
v_mfma_f32_16x16x32_bf16 v[60:63], a[48:51], a[104:107], v[60:63]
buffer_load_dwordx4 v12, s[32:35], s64 offen lds
v_mfma_f32_16x16x32_bf16 v[60:63], a[52:55], a[108:111], v[60:63]
ds_read_b128 a[28:31], v3 offset:6144
v_mfma_f32_16x16x32_bf16 v[76:79], a[60:63], a[108:111], v[76:79]
ds_read_b64_tr_b16 a[96:97], v9 offset:49152
v_mfma_f32_16x16x32_bf16 v[76:79], a[56:59], a[104:107], v[76:79]
ds_read_b64_tr_b16 a[98:99], v9 offset:50176
v_mfma_f32_16x16x32_bf16 v[140:143], a[56:59], a[112:115], v[140:143]
ds_read_b64_tr_b16 a[100:101], v9 offset:57344
v_mfma_f32_16x16x32_bf16 v[140:143], a[60:63], a[116:119], v[140:143]
s_xor_b32 m0, s84, 37888
ds_read_b64_tr_b16 a[102:103], v9 offset:58368
v_subrev_u32 v6, 0x8000, v6
v_mfma_f32_16x16x32_bf16 v[124:127], a[52:55], a[116:119], v[124:127]
s_xor_b32 s64, s70, 41856
ds_read_b64_tr_b16 a[104:105], v10 offset:49152
v_mfma_f32_16x16x32_bf16 v[124:127], a[48:51], a[112:115], v[124:127]
buffer_load_dwordx4 v13, s[32:35], s64 offen lds
v_mfma_f32_16x16x32_bf16 v[108:111], a[40:43], a[112:115], v[108:111]
ds_read_b64_tr_b16 a[106:107], v10 offset:50176
v_mfma_f32_16x16x32_bf16 v[108:111], a[44:47], a[116:119], v[108:111]
ds_read_b64_tr_b16 a[108:109], v10 offset:57344
v_mfma_f32_16x16x32_bf16 v[92:95], a[36:39], a[116:119], v[92:95]
ds_read_b64_tr_b16 a[110:111], v10 offset:58368
v_mfma_f32_16x16x32_bf16 v[92:95], a[32:35], a[112:115], v[92:95]
ds_read_b64_tr_b16 a[112:113], v11 offset:49152
v_mfma_f32_16x16x32_bf16 v[32:35], a[32:35], a[72:75], v[32:35]
s_xor_b32 m0, s84, 38912
ds_read_b64_tr_b16 a[114:115], v11 offset:50176
v_mfma_f32_16x16x32_bf16 v[32:35], a[36:39], a[76:79], v[32:35]
s_xor_b32 s64, s70, 50048
ds_read_b64_tr_b16 a[116:117], v11 offset:57344
v_subrev_u32 v7, 0x8000, v7
v_mfma_f32_16x16x32_bf16 v[48:51], a[44:47], a[76:79], v[48:51]
buffer_load_dwordx4 v12, s[32:35], s64 offen lds
v_mfma_f32_16x16x32_bf16 v[48:51], a[40:43], a[72:75], v[48:51]
ds_read_b64_tr_b16 a[118:119], v11 offset:58368
v_mfma_f32_16x16x32_bf16 v[64:67], a[48:51], a[72:75], v[64:67]
v_mfma_f32_16x16x32_bf16 v[64:67], a[52:55], a[76:79], v[64:67]
v_mfma_f32_16x16x32_bf16 v[80:83], a[60:63], a[76:79], v[80:83]
v_mfma_f32_16x16x32_bf16 v[80:83], a[56:59], a[72:75], v[80:83]
s_xor_b32 m0, s84, 39936
v_mfma_f32_16x16x32_bf16 v[144:147], a[56:59], a[80:83], v[144:147]
s_xor_b32 s64, s70, 58240
v_mfma_f32_16x16x32_bf16 v[144:147], a[60:63], a[84:87], v[144:147]
buffer_load_dwordx4 v13, s[32:35], s64 offen lds
v_mfma_f32_16x16x32_bf16 v[128:131], a[52:55], a[84:87], v[128:131]
v_subrev_u32 v8, 0x8000, v8
v_mfma_f32_16x16x32_bf16 v[128:131], a[48:51], a[80:83], v[128:131]
v_mfma_f32_16x16x32_bf16 v[112:115], a[40:43], a[80:83], v[112:115]
v_mfma_f32_16x16x32_bf16 v[112:115], a[44:47], a[84:87], v[112:115]
v_mfma_f32_16x16x32_bf16 v[96:99], a[36:39], a[84:87], v[96:99]
s_and_b32 s77, s77, 0x3fff
v_subrev_u32 v9, 0x8000, v9
v_subrev_u32 v10, 0x8000, v10
v_mfma_f32_16x16x32_bf16 v[96:99], a[32:35], a[80:83], v[96:99]
s_waitcnt lgkmcnt(0)
v_subrev_u32 v11, 0x8000, v11
v_mfma_f32_16x16x32_bf16 v[36:39], a[32:35], a[88:91], v[36:39]
v_mfma_f32_16x16x32_bf16 v[36:39], a[36:39], a[92:95], v[36:39]
v_mfma_f32_16x16x32_bf16 v[52:55], a[44:47], a[92:95], v[52:55]
s_waitcnt lgkmcnt(0)
s_barrier
v_mfma_f32_16x16x32_bf16 v[52:55], a[40:43], a[88:91], v[52:55]
s_xor_b32 m0, s77, 131072
ds_read_b64_tr_b16 a[72:73], v4 offset:0
v_mfma_f32_16x16x32_bf16 v[68:71], a[48:51], a[88:91], v[68:71]
s_xor_b32 s64, s71, 0
ds_read_b64_tr_b16 a[74:75], v4 offset:1024
v_mfma_f32_16x16x32_bf16 v[68:71], a[52:55], a[92:95], v[68:71]
buffer_load_dwordx4 v14, s[56:59], s64 offen lds
v_mfma_f32_16x16x32_bf16 v[84:87], a[60:63], a[92:95], v[84:87]
ds_read_b64_tr_b16 a[76:77], v4 offset:8192
v_mfma_f32_16x16x32_bf16 v[84:87], a[56:59], a[88:91], v[84:87]
ds_read_b64_tr_b16 a[78:79], v4 offset:9216
v_mfma_f32_16x16x32_bf16 v[148:151], a[56:59], a[96:99], v[148:151]
ds_read_b64_tr_b16 a[80:81], v5 offset:0
v_lshrrev_b32 v13, 3, v0
v_mfma_f32_16x16x32_bf16 v[148:151], a[60:63], a[100:103], v[148:151]
ds_read_b64_tr_b16 a[82:83], v5 offset:1024
v_lshl_add_u32 v12, v13, 10, v12
v_mfma_f32_16x16x32_bf16 v[132:135], a[52:55], a[100:103], v[132:135]
ds_read_b64_tr_b16 a[84:85], v5 offset:8192
v_xor_b32 v13, 64, v12
v_mfma_f32_16x16x32_bf16 v[132:135], a[48:51], a[96:99], v[132:135]
ds_read_b64_tr_b16 a[86:87], v5 offset:9216
v_mfma_f32_16x16x32_bf16 v[116:119], a[40:43], a[96:99], v[116:119]
s_add_u32 m0, s78, 147456
ds_read_b64_tr_b16 a[88:89], v6 offset:0
v_mfma_f32_16x16x32_bf16 v[116:119], a[44:47], a[100:103], v[116:119]
s_add_u32 s64, s75, 0
ds_read_b64_tr_b16 a[90:91], v6 offset:1024
v_mfma_f32_16x16x32_bf16 v[100:103], a[36:39], a[100:103], v[100:103]
buffer_load_dwordx4 v23, s[60:63], s64 offen lds
v_mfma_f32_16x16x32_bf16 v[100:103], a[32:35], a[96:99], v[100:103]
ds_read_b64_tr_b16 a[92:93], v6 offset:8192
v_mfma_f32_16x16x32_bf16 v[248:251], a[32:35], a[104:107], v[248:251]
ds_read_b64_tr_b16 a[94:95], v6 offset:9216
v_mfma_f32_16x16x32_bf16 v[248:251], a[36:39], a[108:111], v[248:251]
ds_read_b64_tr_b16 a[96:97], v7 offset:0
v_mfma_f32_16x16x32_bf16 v[252:255], a[44:47], a[108:111], v[252:255]
ds_read_b64_tr_b16 a[98:99], v7 offset:1024
v_mfma_f32_16x16x32_bf16 v[252:255], a[40:43], a[104:107], v[252:255]
ds_read_b64_tr_b16 a[100:101], v7 offset:8192
v_mfma_f32_16x16x32_bf16 a[120:123], a[48:51], a[104:107], a[120:123]
ds_read_b64_tr_b16 a[102:103], v7 offset:9216
v_mfma_f32_16x16x32_bf16 a[120:123], a[52:55], a[108:111], a[120:123]
s_xor_b32 m0, s77, 132096
v_mfma_f32_16x16x32_bf16 a[124:127], a[60:63], a[108:111], a[124:127]
s_xor_b32 s64, s71, 32768
v_mfma_f32_16x16x32_bf16 a[124:127], a[56:59], a[104:107], a[124:127]
buffer_load_dwordx4 v14, s[56:59], s64 offen lds
v_mfma_f32_16x16x32_bf16 a[128:131], a[56:59], a[112:115], a[128:131]
ds_read_b64_tr_b16 a[104:105], v8 offset:0
v_mfma_f32_16x16x32_bf16 a[128:131], a[60:63], a[116:119], a[128:131]
ds_read_b64_tr_b16 a[106:107], v8 offset:1024
v_mfma_f32_16x16x32_bf16 a[132:135], a[52:55], a[116:119], a[132:135]
ds_read_b64_tr_b16 a[108:109], v8 offset:8192
v_mfma_f32_16x16x32_bf16 a[132:135], a[48:51], a[112:115], a[132:135]
ds_read_b64_tr_b16 a[110:111], v8 offset:9216
v_mfma_f32_16x16x32_bf16 a[136:139], a[40:43], a[112:115], a[136:139]
v_mfma_f32_16x16x32_bf16 a[136:139], a[44:47], a[116:119], a[136:139]
v_mfma_f32_16x16x32_bf16 a[140:143], a[36:39], a[116:119], a[140:143]
s_add_u32 m0, s78, 151552
v_mfma_f32_16x16x32_bf16 a[140:143], a[32:35], a[112:115], a[140:143]
s_waitcnt lgkmcnt(4)
s_add_u32 s64, s75, 2048
ds_read_b64_tr_b16 a[112:113], v9 offset:0
v_mfma_f32_16x16x32_bf16 v[184:187], a[72:75], a[0:3], v[184:187]
buffer_load_dwordx4 v23, s[60:63], s64 offen lds
v_mfma_f32_16x16x32_bf16 v[184:187], a[76:79], a[4:7], v[184:187]
ds_read_b64_tr_b16 a[114:115], v9 offset:1024
v_mfma_f32_16x16x32_bf16 v[192:195], a[76:79], a[12:15], v[192:195]
ds_read_b64_tr_b16 a[116:117], v9 offset:8192
v_mfma_f32_16x16x32_bf16 v[192:195], a[72:75], a[8:11], v[192:195]
ds_read_b64_tr_b16 a[118:119], v9 offset:9216
v_mfma_f32_16x16x32_bf16 v[200:203], a[72:75], a[16:19], v[200:203]
v_mfma_f32_16x16x32_bf16 v[200:203], a[76:79], a[20:23], v[200:203]
v_mfma_f32_16x16x32_bf16 v[208:211], a[76:79], a[28:31], v[208:211]
v_mfma_f32_16x16x32_bf16 v[208:211], a[72:75], a[24:27], v[208:211]
ds_read_b64_tr_b16 a[72:73], v10 offset:0
v_mfma_f32_16x16x32_bf16 v[212:215], a[80:83], a[24:27], v[212:215]
s_xor_b32 m0, s77, 133120
ds_read_b64_tr_b16 a[74:75], v10 offset:1024
v_mfma_f32_16x16x32_bf16 v[212:215], a[84:87], a[28:31], v[212:215]
s_xor_b32 s64, s71, 65536
ds_read_b64_tr_b16 a[76:77], v10 offset:8192
v_mfma_f32_16x16x32_bf16 v[204:207], a[84:87], a[20:23], v[204:207]
buffer_load_dwordx4 v15, s[56:59], s64 offen lds
v_mfma_f32_16x16x32_bf16 v[204:207], a[80:83], a[16:19], v[204:207]
ds_read_b64_tr_b16 a[78:79], v10 offset:9216
v_mfma_f32_16x16x32_bf16 v[196:199], a[80:83], a[8:11], v[196:199]
v_mfma_f32_16x16x32_bf16 v[196:199], a[84:87], a[12:15], v[196:199]
v_mfma_f32_16x16x32_bf16 v[188:191], a[84:87], a[4:7], v[188:191]
v_mfma_f32_16x16x32_bf16 v[188:191], a[80:83], a[0:3], v[188:191]
ds_read_b64_tr_b16 a[80:81], v11 offset:0
v_mfma_f32_16x16x32_bf16 v[216:219], a[88:91], a[0:3], v[216:219]
ds_read_b64_tr_b16 a[82:83], v11 offset:1024
v_mfma_f32_16x16x32_bf16 v[216:219], a[92:95], a[4:7], v[216:219]
s_add_u32 m0, s78, 155648
ds_read_b64_tr_b16 a[84:85], v11 offset:8192
v_mfma_f32_16x16x32_bf16 v[224:227], a[92:95], a[12:15], v[224:227]
s_add_u32 s64, s75, 4096
ds_read_b64_tr_b16 a[86:87], v11 offset:9216
v_mfma_f32_16x16x32_bf16 v[224:227], a[88:91], a[8:11], v[224:227]
buffer_load_dwordx4 v23, s[60:63], s64 offen lds
v_mfma_f32_16x16x32_bf16 v[232:235], a[88:91], a[16:19], v[232:235]
v_mfma_f32_16x16x32_bf16 v[232:235], a[92:95], a[20:23], v[232:235]
v_mfma_f32_16x16x32_bf16 v[240:243], a[92:95], a[28:31], v[240:243]
v_mfma_f32_16x16x32_bf16 v[240:243], a[88:91], a[24:27], v[240:243]
ds_read_b64_tr_b16 a[88:89], v4 offset:16384
v_mfma_f32_16x16x32_bf16 v[244:247], a[96:99], a[24:27], v[244:247]
ds_read_b64_tr_b16 a[90:91], v4 offset:17408
v_mfma_f32_16x16x32_bf16 v[244:247], a[100:103], a[28:31], v[244:247]
ds_read_b64_tr_b16 a[92:93], v4 offset:24576
v_mfma_f32_16x16x32_bf16 v[236:239], a[100:103], a[20:23], v[236:239]
s_xor_b32 m0, s77, 134144
ds_read_b64_tr_b16 a[94:95], v4 offset:25600
v_mfma_f32_16x16x32_bf16 v[236:239], a[96:99], a[16:19], v[236:239]
s_xor_b32 s64, s71, 98304
v_mfma_f32_16x16x32_bf16 v[228:231], a[96:99], a[8:11], v[228:231]
buffer_load_dwordx4 v15, s[56:59], s64 offen lds
v_mfma_f32_16x16x32_bf16 v[228:231], a[100:103], a[12:15], v[228:231]
v_mfma_f32_16x16x32_bf16 v[220:223], a[100:103], a[4:7], v[220:223]
v_mfma_f32_16x16x32_bf16 v[220:223], a[96:99], a[0:3], v[220:223]
s_waitcnt lgkmcnt(4)
ds_read_b64_tr_b16 a[96:97], v5 offset:16384
v_mfma_f32_16x16x32_bf16 v[152:155], a[104:107], a[0:3], v[152:155]
ds_read_b64_tr_b16 a[98:99], v5 offset:17408
v_mfma_f32_16x16x32_bf16 v[152:155], a[108:111], a[4:7], v[152:155]
ds_read_b64_tr_b16 a[100:101], v5 offset:24576
v_mfma_f32_16x16x32_bf16 v[160:163], a[108:111], a[12:15], v[160:163]
ds_read_b64_tr_b16 a[102:103], v5 offset:25600
v_mfma_f32_16x16x32_bf16 v[160:163], a[104:107], a[8:11], v[160:163]
v_mfma_f32_16x16x32_bf16 v[168:171], a[104:107], a[16:19], v[168:171]
v_mfma_f32_16x16x32_bf16 v[168:171], a[108:111], a[20:23], v[168:171]
v_mfma_f32_16x16x32_bf16 v[176:179], a[108:111], a[28:31], v[176:179]
s_xor_b32 m0, s84, 0
v_mfma_f32_16x16x32_bf16 v[176:179], a[104:107], a[24:27], v[176:179]
s_xor_b32 s64, s72, 0
ds_read_b64_tr_b16 a[104:105], v6 offset:16384
v_mfma_f32_16x16x32_bf16 v[180:183], a[112:115], a[24:27], v[180:183]
buffer_load_dwordx4 v12, s[48:51], s64 offen lds
v_mfma_f32_16x16x32_bf16 v[180:183], a[116:119], a[28:31], v[180:183]
ds_read_b64_tr_b16 a[106:107], v6 offset:17408
v_mfma_f32_16x16x32_bf16 v[172:175], a[116:119], a[20:23], v[172:175]
ds_read_b64_tr_b16 a[108:109], v6 offset:24576
v_mfma_f32_16x16x32_bf16 v[172:175], a[112:115], a[16:19], v[172:175]
ds_read_b64_tr_b16 a[110:111], v6 offset:25600
v_mfma_f32_16x16x32_bf16 v[164:167], a[112:115], a[8:11], v[164:167]
v_mfma_f32_16x16x32_bf16 v[164:167], a[116:119], a[12:15], v[164:167]
s_xor_b32 m0, s84, 1024
v_mfma_f32_16x16x32_bf16 v[156:159], a[116:119], a[4:7], v[156:159]
s_xor_b32 s64, s72, 16384
v_mfma_f32_16x16x32_bf16 v[156:159], a[112:115], a[0:3], v[156:159]
buffer_load_dwordx4 v13, s[48:51], s64 offen lds
v_mfma_f32_16x16x32_bf16 v[24:27], a[72:75], a[0:3], v[24:27]
ds_read_b64_tr_b16 a[112:113], v7 offset:16384
v_mfma_f32_16x16x32_bf16 v[24:27], a[76:79], a[4:7], v[24:27]
ds_read_b64_tr_b16 a[114:115], v7 offset:17408
v_mfma_f32_16x16x32_bf16 v[40:43], a[76:79], a[12:15], v[40:43]
ds_read_b64_tr_b16 a[116:117], v7 offset:24576
v_mfma_f32_16x16x32_bf16 v[40:43], a[72:75], a[8:11], v[40:43]
ds_read_b64_tr_b16 a[118:119], v7 offset:25600
v_mfma_f32_16x16x32_bf16 v[56:59], a[72:75], a[16:19], v[56:59]
s_xor_b32 m0, s84, 2048
v_mfma_f32_16x16x32_bf16 v[56:59], a[76:79], a[20:23], v[56:59]
s_xor_b32 s64, s72, 131072
v_mfma_f32_16x16x32_bf16 v[72:75], a[76:79], a[28:31], v[72:75]
s_waitcnt vmcnt(9)
buffer_load_dwordx4 v12, s[48:51], s64 offen lds
v_mfma_f32_16x16x32_bf16 v[72:75], a[72:75], a[24:27], v[72:75]
ds_read_b64_tr_b16 a[72:73], v8 offset:16384
v_mfma_f32_16x16x32_bf16 v[136:139], a[80:83], a[24:27], v[136:139]
ds_read_b64_tr_b16 a[74:75], v8 offset:17408
v_mfma_f32_16x16x32_bf16 v[136:139], a[84:87], a[28:31], v[136:139]
ds_read_b64_tr_b16 a[76:77], v8 offset:24576
v_mfma_f32_16x16x32_bf16 v[120:123], a[84:87], a[20:23], v[120:123]
ds_read_b64_tr_b16 a[78:79], v8 offset:25600
v_mfma_f32_16x16x32_bf16 v[120:123], a[80:83], a[16:19], v[120:123]
s_xor_b32 m0, s84, 3072
ds_read_b128 a[32:35], v2 offset:32768
v_mfma_f32_16x16x32_bf16 v[104:107], a[80:83], a[8:11], v[104:107]
s_xor_b32 s64, s72, 147456
ds_read_b128 a[36:39], v3 offset:32768
v_mfma_f32_16x16x32_bf16 v[104:107], a[84:87], a[12:15], v[104:107]
buffer_load_dwordx4 v13, s[48:51], s64 offen lds
v_mfma_f32_16x16x32_bf16 v[88:91], a[84:87], a[4:7], v[88:91]
ds_read_b128 a[40:43], v2 offset:34816
v_mfma_f32_16x16x32_bf16 v[88:91], a[80:83], a[0:3], v[88:91]
s_waitcnt lgkmcnt(7)
ds_read_b128 a[44:47], v3 offset:34816
v_mfma_f32_16x16x32_bf16 v[28:31], a[0:3], a[88:91], v[28:31]
ds_read_b128 a[48:51], v2 offset:36864
v_mfma_f32_16x16x32_bf16 v[28:31], a[4:7], a[92:95], v[28:31]
ds_read_b128 a[52:55], v3 offset:36864
v_mfma_f32_16x16x32_bf16 v[44:47], a[12:15], a[92:95], v[44:47]
s_xor_b32 m0, s84, 4096
ds_read_b128 a[56:59], v2 offset:38912
v_mfma_f32_16x16x32_bf16 v[44:47], a[8:11], a[88:91], v[44:47]
s_xor_b32 s64, s73, 0
ds_read_b128 a[60:63], v3 offset:38912
v_mfma_f32_16x16x32_bf16 v[60:63], a[16:19], a[88:91], v[60:63]
buffer_load_dwordx4 v12, s[48:51], s64 offen lds
v_mfma_f32_16x16x32_bf16 v[60:63], a[20:23], a[92:95], v[60:63]
ds_read_b64_tr_b16 a[80:81], v9 offset:16384
v_mfma_f32_16x16x32_bf16 v[76:79], a[28:31], a[92:95], v[76:79]
ds_read_b64_tr_b16 a[82:83], v9 offset:17408
v_mfma_f32_16x16x32_bf16 v[76:79], a[24:27], a[88:91], v[76:79]
ds_read_b64_tr_b16 a[84:85], v9 offset:24576
v_mfma_f32_16x16x32_bf16 v[140:143], a[24:27], a[96:99], v[140:143]
ds_read_b64_tr_b16 a[86:87], v9 offset:25600
v_mfma_f32_16x16x32_bf16 v[140:143], a[28:31], a[100:103], v[140:143]
s_xor_b32 m0, s84, 5120
ds_read_b64_tr_b16 a[88:89], v10 offset:16384
v_mfma_f32_16x16x32_bf16 v[124:127], a[20:23], a[100:103], v[124:127]
s_xor_b32 s64, s73, 16384
ds_read_b64_tr_b16 a[90:91], v10 offset:17408
v_mfma_f32_16x16x32_bf16 v[124:127], a[16:19], a[96:99], v[124:127]
buffer_load_dwordx4 v13, s[48:51], s64 offen lds
v_mfma_f32_16x16x32_bf16 v[108:111], a[8:11], a[96:99], v[108:111]
s_branch L_po5
L_pg5:
s_branch L_tr0
L_po5:
ds_read_b64_tr_b16 a[92:93], v10 offset:24576
v_mfma_f32_16x16x32_bf16 v[108:111], a[12:15], a[100:103], v[108:111]
ds_read_b64_tr_b16 a[94:95], v10 offset:25600
v_mfma_f32_16x16x32_bf16 v[92:95], a[4:7], a[100:103], v[92:95]
v_mfma_f32_16x16x32_bf16 v[92:95], a[0:3], a[96:99], v[92:95]
ds_read_b64_tr_b16 a[96:97], v11 offset:16384
v_mfma_f32_16x16x32_bf16 v[32:35], a[0:3], a[104:107], v[32:35]
s_xor_b32 m0, s84, 6144
ds_read_b64_tr_b16 a[98:99], v11 offset:17408
v_mfma_f32_16x16x32_bf16 v[32:35], a[4:7], a[108:111], v[32:35]
s_xor_b32 s64, s73, 131072
ds_read_b64_tr_b16 a[100:101], v11 offset:24576
v_mfma_f32_16x16x32_bf16 v[48:51], a[12:15], a[108:111], v[48:51]
buffer_load_dwordx4 v12, s[48:51], s64 offen lds
v_mfma_f32_16x16x32_bf16 v[48:51], a[8:11], a[104:107], v[48:51]
ds_read_b64_tr_b16 a[102:103], v11 offset:25600
v_mfma_f32_16x16x32_bf16 v[64:67], a[16:19], a[104:107], v[64:67]
v_mfma_f32_16x16x32_bf16 v[64:67], a[20:23], a[108:111], v[64:67]
v_mfma_f32_16x16x32_bf16 v[80:83], a[28:31], a[108:111], v[80:83]
v_mfma_f32_16x16x32_bf16 v[80:83], a[24:27], a[104:107], v[80:83]
s_xor_b32 m0, s84, 7168
v_mfma_f32_16x16x32_bf16 v[144:147], a[24:27], a[112:115], v[144:147]
s_xor_b32 s64, s73, 147456
v_mfma_f32_16x16x32_bf16 v[144:147], a[28:31], a[116:119], v[144:147]
buffer_load_dwordx4 v13, s[48:51], s64 offen lds
v_mfma_f32_16x16x32_bf16 v[128:131], a[20:23], a[116:119], v[128:131]
v_mfma_f32_16x16x32_bf16 v[128:131], a[16:19], a[112:115], v[128:131]
v_mfma_f32_16x16x32_bf16 v[112:115], a[8:11], a[112:115], v[112:115]
v_mfma_f32_16x16x32_bf16 v[112:115], a[12:15], a[116:119], v[112:115]
v_mfma_f32_16x16x32_bf16 v[96:99], a[4:7], a[116:119], v[96:99]
v_mfma_f32_16x16x32_bf16 v[96:99], a[0:3], a[112:115], v[96:99]
s_waitcnt lgkmcnt(0)
v_mfma_f32_16x16x32_bf16 v[36:39], a[0:3], a[72:75], v[36:39]
v_mfma_f32_16x16x32_bf16 v[36:39], a[4:7], a[76:79], v[36:39]
v_mfma_f32_16x16x32_bf16 v[52:55], a[12:15], a[76:79], v[52:55]
s_waitcnt lgkmcnt(0)
s_barrier
v_mfma_f32_16x16x32_bf16 v[52:55], a[8:11], a[72:75], v[52:55]
s_xor_b32 m0, s77, 65536
ds_read_b64_tr_b16 a[104:105], v4 offset:32768
v_mfma_f32_16x16x32_bf16 v[68:71], a[16:19], a[72:75], v[68:71]
s_xor_b32 s64, s71, 524288
ds_read_b64_tr_b16 a[106:107], v4 offset:33792
v_mfma_f32_16x16x32_bf16 v[68:71], a[20:23], a[76:79], v[68:71]
buffer_load_dwordx4 v14, s[56:59], s64 offen lds
v_mfma_f32_16x16x32_bf16 v[84:87], a[28:31], a[76:79], v[84:87]
ds_read_b64_tr_b16 a[108:109], v4 offset:40960
v_mfma_f32_16x16x32_bf16 v[84:87], a[24:27], a[72:75], v[84:87]
ds_read_b64_tr_b16 a[110:111], v4 offset:41984
v_mfma_f32_16x16x32_bf16 v[148:151], a[24:27], a[80:83], v[148:151]
ds_read_b64_tr_b16 a[112:113], v5 offset:32768
v_mfma_f32_16x16x32_bf16 v[148:151], a[28:31], a[84:87], v[148:151]
ds_read_b64_tr_b16 a[114:115], v5 offset:33792
v_mfma_f32_16x16x32_bf16 v[132:135], a[20:23], a[84:87], v[132:135]
ds_read_b64_tr_b16 a[116:117], v5 offset:40960
v_mfma_f32_16x16x32_bf16 v[132:135], a[16:19], a[80:83], v[132:135]
ds_read_b64_tr_b16 a[118:119], v5 offset:41984
v_mfma_f32_16x16x32_bf16 v[116:119], a[8:11], a[80:83], v[116:119]
s_add_u32 m0, s78, 81920
ds_read_b64_tr_b16 a[72:73], v6 offset:32768
v_mfma_f32_16x16x32_bf16 v[116:119], a[12:15], a[84:87], v[116:119]
s_add_u32 s64, s75, 393216
ds_read_b64_tr_b16 a[74:75], v6 offset:33792
v_mfma_f32_16x16x32_bf16 v[100:103], a[4:7], a[84:87], v[100:103]
buffer_load_dwordx4 v23, s[60:63], s64 offen lds
v_mfma_f32_16x16x32_bf16 v[100:103], a[0:3], a[80:83], v[100:103]
ds_read_b64_tr_b16 a[76:77], v6 offset:40960
v_mfma_f32_16x16x32_bf16 v[248:251], a[0:3], a[88:91], v[248:251]
ds_read_b64_tr_b16 a[78:79], v6 offset:41984
v_mfma_f32_16x16x32_bf16 v[248:251], a[4:7], a[92:95], v[248:251]
ds_read_b64_tr_b16 a[80:81], v7 offset:32768
v_mfma_f32_16x16x32_bf16 v[252:255], a[12:15], a[92:95], v[252:255]
ds_read_b64_tr_b16 a[82:83], v7 offset:33792
v_mfma_f32_16x16x32_bf16 v[252:255], a[8:11], a[88:91], v[252:255]
ds_read_b64_tr_b16 a[84:85], v7 offset:40960
v_mfma_f32_16x16x32_bf16 a[120:123], a[16:19], a[88:91], a[120:123]
ds_read_b64_tr_b16 a[86:87], v7 offset:41984
v_mfma_f32_16x16x32_bf16 a[120:123], a[20:23], a[92:95], a[120:123]
s_xor_b32 m0, s77, 66560
v_mfma_f32_16x16x32_bf16 a[124:127], a[28:31], a[92:95], a[124:127]
s_xor_b32 s64, s71, 557056
v_mfma_f32_16x16x32_bf16 a[124:127], a[24:27], a[88:91], a[124:127]
buffer_load_dwordx4 v14, s[56:59], s64 offen lds
v_mfma_f32_16x16x32_bf16 a[128:131], a[24:27], a[96:99], a[128:131]
ds_read_b64_tr_b16 a[88:89], v8 offset:32768
v_mfma_f32_16x16x32_bf16 a[128:131], a[28:31], a[100:103], a[128:131]
ds_read_b64_tr_b16 a[90:91], v8 offset:33792
v_mfma_f32_16x16x32_bf16 a[132:135], a[20:23], a[100:103], a[132:135]
ds_read_b64_tr_b16 a[92:93], v8 offset:40960
v_mfma_f32_16x16x32_bf16 a[132:135], a[16:19], a[96:99], a[132:135]
ds_read_b64_tr_b16 a[94:95], v8 offset:41984
v_mfma_f32_16x16x32_bf16 a[136:139], a[8:11], a[96:99], a[136:139]
v_mfma_f32_16x16x32_bf16 a[136:139], a[12:15], a[100:103], a[136:139]
v_mfma_f32_16x16x32_bf16 a[140:143], a[4:7], a[100:103], a[140:143]
s_add_u32 m0, s78, 86016
v_mfma_f32_16x16x32_bf16 a[140:143], a[0:3], a[96:99], a[140:143]
s_waitcnt lgkmcnt(4)
s_add_u32 s64, s75, 395264
ds_read_b64_tr_b16 a[96:97], v9 offset:32768
v_mfma_f32_16x16x32_bf16 v[184:187], a[104:107], a[32:35], v[184:187]
s_lshl_b32 s66, s30, 30
buffer_load_dwordx4 v23, s[60:63], s64 offen lds
v_mfma_f32_16x16x32_bf16 v[184:187], a[108:111], a[36:39], v[184:187]
ds_read_b64_tr_b16 a[98:99], v9 offset:33792
v_lshl_add_u32 v1, v0, 24, s66
v_mfma_f32_16x16x32_bf16 v[192:195], a[108:111], a[44:47], v[192:195]
s_lshr_b32 s66, s3, 1
ds_read_b64_tr_b16 a[100:101], v9 offset:40960
v_mfma_f32_16x16x32_bf16 v[192:195], a[104:107], a[40:43], v[192:195]
s_lshl_b32 s66, s66, 12
ds_read_b64_tr_b16 a[102:103], v9 offset:41984
v_mfma_f32_16x16x32_bf16 v[200:203], a[104:107], a[48:51], v[200:203]
v_mfma_f32_16x16x32_bf16 v[200:203], a[108:111], a[52:55], v[200:203]
v_mfma_f32_16x16x32_bf16 v[208:211], a[108:111], a[60:63], v[208:211]
v_mfma_f32_16x16x32_bf16 v[208:211], a[104:107], a[56:59], v[208:211]
ds_read_b64_tr_b16 a[104:105], v10 offset:32768
v_mfma_f32_16x16x32_bf16 v[212:215], a[112:115], a[56:59], v[212:215]
s_xor_b32 m0, s77, 67584
ds_read_b64_tr_b16 a[106:107], v10 offset:33792
v_mfma_f32_16x16x32_bf16 v[212:215], a[116:119], a[60:63], v[212:215]
s_xor_b32 s64, s71, 589824
ds_read_b64_tr_b16 a[108:109], v10 offset:40960
v_mfma_f32_16x16x32_bf16 v[204:207], a[116:119], a[52:55], v[204:207]
buffer_load_dwordx4 v15, s[56:59], s64 offen lds
v_mfma_f32_16x16x32_bf16 v[204:207], a[112:115], a[48:51], v[204:207]
ds_read_b64_tr_b16 a[110:111], v10 offset:41984
v_mfma_f32_16x16x32_bf16 v[196:199], a[112:115], a[40:43], v[196:199]
v_mfma_f32_16x16x32_bf16 v[196:199], a[116:119], a[44:47], v[196:199]
v_mfma_f32_16x16x32_bf16 v[188:191], a[116:119], a[36:39], v[188:191]
v_mfma_f32_16x16x32_bf16 v[188:191], a[112:115], a[32:35], v[188:191]
s_add_u32 s67, s79, 20480
ds_read_b64_tr_b16 a[112:113], v11 offset:32768
v_mfma_f32_16x16x32_bf16 v[216:219], a[72:75], a[32:35], v[216:219]
ds_read_b64_tr_b16 a[114:115], v11 offset:33792
v_mfma_f32_16x16x32_bf16 v[216:219], a[76:79], a[36:39], v[216:219]
s_add_u32 m0, s78, 90112
ds_read_b64_tr_b16 a[116:117], v11 offset:40960
v_cvt_pk_bf16_f32 v215, v214, v215
v_mfma_f32_16x16x32_bf16 v[224:227], a[76:79], a[44:47], v[224:227]
s_add_u32 s64, s75, 397312
ds_read_b64_tr_b16 a[118:119], v11 offset:41984
v_cvt_pk_bf16_f32 v214, v212, v213
v_mfma_f32_16x16x32_bf16 v[224:227], a[72:75], a[40:43], v[224:227]
buffer_load_dwordx4 v23, s[60:63], s64 offen lds
v_mfma_f32_16x16x32_bf16 v[232:235], a[72:75], a[48:51], v[232:235]
v_cvt_pk_bf16_f32 v212, v208, v209
v_cvt_pk_bf16_f32 v213, v210, v211
v_mfma_f32_16x16x32_bf16 v[232:235], a[76:79], a[52:55], v[232:235]
buffer_store_dwordx4 v[212:215], v16, s[44:47], s67 offen sc1
v_mfma_f32_16x16x32_bf16 v[240:243], a[76:79], a[60:63], v[240:243]
v_cvt_pk_bf16_f32 v207, v206, v207
v_cvt_pk_bf16_f32 v206, v204, v205
v_mfma_f32_16x16x32_bf16 v[240:243], a[72:75], a[56:59], v[240:243]
ds_read_b64_tr_b16 a[72:73], v4 offset:49152
v_cvt_pk_bf16_f32 v204, v200, v201
v_mfma_f32_16x16x32_bf16 v[244:247], a[80:83], a[56:59], v[244:247]
ds_read_b64_tr_b16 a[74:75], v4 offset:50176
v_cvt_pk_bf16_f32 v205, v202, v203
v_mfma_f32_16x16x32_bf16 v[244:247], a[84:87], a[60:63], v[244:247]
ds_read_b64_tr_b16 a[76:77], v4 offset:57344
v_accvgpr_write_b32 a144, v204
v_mfma_f32_16x16x32_bf16 v[236:239], a[84:87], a[52:55], v[236:239]
s_xor_b32 m0, s77, 68608
ds_read_b64_tr_b16 a[78:79], v4 offset:58368
v_accvgpr_write_b32 a145, v205
v_mfma_f32_16x16x32_bf16 v[236:239], a[80:83], a[48:51], v[236:239]
s_xor_b32 s64, s71, 622592
v_accvgpr_write_b32 a146, v206
v_accvgpr_write_b32 a147, v207
v_mfma_f32_16x16x32_bf16 v[228:231], a[80:83], a[40:43], v[228:231]
buffer_load_dwordx4 v15, s[56:59], s64 offen lds
v_mfma_f32_16x16x32_bf16 v[228:231], a[84:87], a[44:47], v[228:231]
v_cvt_pk_bf16_f32 v199, v198, v199
v_cvt_pk_bf16_f32 v198, v196, v197
v_mfma_f32_16x16x32_bf16 v[220:223], a[84:87], a[36:39], v[220:223]
v_cvt_pk_bf16_f32 v196, v192, v193
v_cvt_pk_bf16_f32 v197, v194, v195
v_mfma_f32_16x16x32_bf16 v[220:223], a[80:83], a[32:35], v[220:223]
s_waitcnt lgkmcnt(4)
ds_read_b64_tr_b16 a[80:81], v5 offset:49152
v_accvgpr_write_b32 a148, v196
v_mfma_f32_16x16x32_bf16 v[152:155], a[88:91], a[32:35], v[152:155]
ds_read_b64_tr_b16 a[82:83], v5 offset:50176
v_accvgpr_write_b32 a149, v197
v_mfma_f32_16x16x32_bf16 v[152:155], a[92:95], a[36:39], v[152:155]
ds_read_b64_tr_b16 a[84:85], v5 offset:57344
v_accvgpr_write_b32 a150, v198
v_mfma_f32_16x16x32_bf16 v[160:163], a[92:95], a[44:47], v[160:163]
ds_read_b64_tr_b16 a[86:87], v5 offset:58368
v_accvgpr_write_b32 a151, v199
v_mfma_f32_16x16x32_bf16 v[160:163], a[88:91], a[40:43], v[160:163]
v_cvt_pk_bf16_f32 v191, v190, v191
v_cvt_pk_bf16_f32 v190, v188, v189
v_mfma_f32_16x16x32_bf16 v[168:171], a[88:91], a[48:51], v[168:171]
v_cvt_pk_bf16_f32 v188, v184, v185
v_cvt_pk_bf16_f32 v189, v186, v187
v_mfma_f32_16x16x32_bf16 v[168:171], a[92:95], a[52:55], v[168:171]
v_accvgpr_write_b32 a152, v188
v_accvgpr_write_b32 a153, v189
v_mfma_f32_16x16x32_bf16 v[176:179], a[92:95], a[60:63], v[176:179]
s_xor_b32 m0, s84, 32768
v_accvgpr_write_b32 a154, v190
v_accvgpr_write_b32 a155, v191
v_mfma_f32_16x16x32_bf16 v[176:179], a[88:91], a[56:59], v[176:179]
s_add_u32 s67, s79, 21504
s_xor_b32 s64, s72, 128
ds_read_b64_tr_b16 a[88:89], v6 offset:49152
v_cvt_pk_bf16_f32 v247, v246, v247
v_mfma_f32_16x16x32_bf16 v[180:183], a[96:99], a[56:59], v[180:183]
buffer_load_dwordx4 v12, s[48:51], s64 offen lds
v_mfma_f32_16x16x32_bf16 v[180:183], a[100:103], a[60:63], v[180:183]
ds_read_b64_tr_b16 a[90:91], v6 offset:50176
v_cvt_pk_bf16_f32 v246, v244, v245
v_mfma_f32_16x16x32_bf16 v[172:175], a[100:103], a[52:55], v[172:175]
ds_read_b64_tr_b16 a[92:93], v6 offset:57344
v_cvt_pk_bf16_f32 v244, v240, v241
v_mfma_f32_16x16x32_bf16 v[172:175], a[96:99], a[48:51], v[172:175]
ds_read_b64_tr_b16 a[94:95], v6 offset:58368
v_cvt_pk_bf16_f32 v245, v242, v243
v_mfma_f32_16x16x32_bf16 v[164:167], a[96:99], a[40:43], v[164:167]
buffer_store_dwordx4 v[244:247], v16, s[44:47], s67 offen sc1
v_mfma_f32_16x16x32_bf16 v[164:167], a[100:103], a[44:47], v[164:167]
s_xor_b32 m0, s84, 33792
v_cvt_pk_bf16_f32 v239, v238, v239
v_cvt_pk_bf16_f32 v238, v236, v237
v_mfma_f32_16x16x32_bf16 v[156:159], a[100:103], a[36:39], v[156:159]
s_xor_b32 s64, s72, 16512
v_cvt_pk_bf16_f32 v236, v232, v233
v_cvt_pk_bf16_f32 v237, v234, v235
v_mfma_f32_16x16x32_bf16 v[156:159], a[96:99], a[32:35], v[156:159]
buffer_load_dwordx4 v13, s[48:51], s64 offen lds
v_mfma_f32_16x16x32_bf16 v[24:27], a[104:107], a[32:35], v[24:27]
ds_read_b64_tr_b16 a[96:97], v7 offset:49152
v_accvgpr_write_b32 a156, v236
v_mfma_f32_16x16x32_bf16 v[24:27], a[108:111], a[36:39], v[24:27]
ds_read_b64_tr_b16 a[98:99], v7 offset:50176
v_accvgpr_write_b32 a157, v237
v_mfma_f32_16x16x32_bf16 v[40:43], a[108:111], a[44:47], v[40:43]
ds_read_b64_tr_b16 a[100:101], v7 offset:57344
v_accvgpr_write_b32 a158, v238
v_mfma_f32_16x16x32_bf16 v[40:43], a[104:107], a[40:43], v[40:43]
ds_read_b64_tr_b16 a[102:103], v7 offset:58368
v_accvgpr_write_b32 a159, v239
v_mfma_f32_16x16x32_bf16 v[56:59], a[104:107], a[48:51], v[56:59]
s_xor_b32 m0, s84, 34816
v_cvt_pk_bf16_f32 v231, v230, v231
v_cvt_pk_bf16_f32 v230, v228, v229
v_mfma_f32_16x16x32_bf16 v[56:59], a[108:111], a[52:55], v[56:59]
s_xor_b32 s64, s72, 131200
v_cvt_pk_bf16_f32 v228, v224, v225
v_cvt_pk_bf16_f32 v229, v226, v227
v_mfma_f32_16x16x32_bf16 v[72:75], a[108:111], a[60:63], v[72:75]
s_waitcnt vmcnt(11)
buffer_load_dwordx4 v12, s[48:51], s64 offen lds
v_mfma_f32_16x16x32_bf16 v[72:75], a[104:107], a[56:59], v[72:75]
ds_read_b64_tr_b16 a[104:105], v8 offset:49152
v_accvgpr_write_b32 a160, v228
v_mfma_f32_16x16x32_bf16 v[136:139], a[112:115], a[56:59], v[136:139]
ds_read_b64_tr_b16 a[106:107], v8 offset:50176
v_accvgpr_write_b32 a161, v229
v_mfma_f32_16x16x32_bf16 v[136:139], a[116:119], a[60:63], v[136:139]
ds_read_b64_tr_b16 a[108:109], v8 offset:57344
v_add_u32 v4, 0x8000, v4
v_mfma_f32_16x16x32_bf16 v[120:123], a[116:119], a[52:55], v[120:123]
ds_read_b64_tr_b16 a[110:111], v8 offset:58368
v_accvgpr_write_b32 a162, v230
v_mfma_f32_16x16x32_bf16 v[120:123], a[112:115], a[48:51], v[120:123]
s_xor_b32 m0, s84, 35840
ds_read_b128 a[0:3], v2 offset:0
v_accvgpr_write_b32 a163, v231
v_mfma_f32_16x16x32_bf16 v[104:107], a[112:115], a[40:43], v[104:107]
s_xor_b32 s64, s72, 147584
ds_read_b128 a[4:7], v3 offset:0
v_cvt_pk_bf16_f32 v223, v222, v223
v_mfma_f32_16x16x32_bf16 v[104:107], a[116:119], a[44:47], v[104:107]
buffer_load_dwordx4 v13, s[48:51], s64 offen lds
v_mfma_f32_16x16x32_bf16 v[88:91], a[116:119], a[36:39], v[88:91]
ds_read_b128 a[8:11], v2 offset:2048
v_cvt_pk_bf16_f32 v222, v220, v221
v_mfma_f32_16x16x32_bf16 v[88:91], a[112:115], a[32:35], v[88:91]
s_waitcnt lgkmcnt(7)
ds_read_b128 a[12:15], v3 offset:2048
v_cvt_pk_bf16_f32 v220, v216, v217
v_mfma_f32_16x16x32_bf16 v[28:31], a[32:35], a[72:75], v[28:31]
ds_read_b128 a[16:19], v2 offset:4096
v_cvt_pk_bf16_f32 v221, v218, v219
v_mfma_f32_16x16x32_bf16 v[28:31], a[36:39], a[76:79], v[28:31]
ds_read_b128 a[20:23], v3 offset:4096
v_add_u32 v5, 0x8000, v5
v_mfma_f32_16x16x32_bf16 v[44:47], a[44:47], a[76:79], v[44:47]
s_xor_b32 m0, s84, 36864
ds_read_b128 a[24:27], v2 offset:6144
v_accvgpr_write_b32 a164, v220
v_mfma_f32_16x16x32_bf16 v[44:47], a[40:43], a[72:75], v[44:47]
s_xor_b32 s64, s73, 128
ds_read_b128 a[28:31], v3 offset:6144
v_accvgpr_write_b32 a165, v221
v_mfma_f32_16x16x32_bf16 v[60:63], a[48:51], a[72:75], v[60:63]
buffer_load_dwordx4 v12, s[48:51], s64 offen lds
v_mfma_f32_16x16x32_bf16 v[60:63], a[52:55], a[76:79], v[60:63]
ds_read_b64_tr_b16 a[112:113], v9 offset:49152
v_accvgpr_write_b32 a166, v222
v_mfma_f32_16x16x32_bf16 v[76:79], a[60:63], a[76:79], v[76:79]
ds_read_b64_tr_b16 a[114:115], v9 offset:50176
v_accvgpr_write_b32 a167, v223
v_mfma_f32_16x16x32_bf16 v[76:79], a[56:59], a[72:75], v[76:79]
s_add_u32 s67, s79, 22528
ds_read_b64_tr_b16 a[116:117], v9 offset:57344
v_cvt_pk_bf16_f32 v183, v182, v183
v_mfma_f32_16x16x32_bf16 v[140:143], a[56:59], a[80:83], v[140:143]
ds_read_b64_tr_b16 a[118:119], v9 offset:58368
v_cvt_pk_bf16_f32 v182, v180, v181
v_mfma_f32_16x16x32_bf16 v[140:143], a[60:63], a[84:87], v[140:143]
s_xor_b32 m0, s84, 37888
ds_read_b64_tr_b16 a[72:73], v10 offset:49152
v_add_u32 v6, 0x8000, v6
v_mfma_f32_16x16x32_bf16 v[124:127], a[52:55], a[84:87], v[124:127]
s_xor_b32 s64, s73, 16512
ds_read_b64_tr_b16 a[74:75], v10 offset:50176
v_cvt_pk_bf16_f32 v180, v176, v177
v_mfma_f32_16x16x32_bf16 v[124:127], a[48:51], a[80:83], v[124:127]
buffer_load_dwordx4 v13, s[48:51], s64 offen lds
v_mfma_f32_16x16x32_bf16 v[108:111], a[40:43], a[80:83], v[108:111]
ds_read_b64_tr_b16 a[76:77], v10 offset:57344
v_cvt_pk_bf16_f32 v181, v178, v179
v_mfma_f32_16x16x32_bf16 v[108:111], a[44:47], a[84:87], v[108:111]
ds_read_b64_tr_b16 a[78:79], v10 offset:58368
v_mfma_f32_16x16x32_bf16 v[92:95], a[36:39], a[84:87], v[92:95]
buffer_store_dwordx4 v[180:183], v16, s[44:47], s67 offen sc1
v_mfma_f32_16x16x32_bf16 v[92:95], a[32:35], a[80:83], v[92:95]
ds_read_b64_tr_b16 a[80:81], v11 offset:49152
v_cvt_pk_bf16_f32 v175, v174, v175
v_mfma_f32_16x16x32_bf16 v[32:35], a[32:35], a[88:91], v[32:35]
s_xor_b32 m0, s84, 38912
ds_read_b64_tr_b16 a[82:83], v11 offset:50176
v_cvt_pk_bf16_f32 v174, v172, v173
v_mfma_f32_16x16x32_bf16 v[32:35], a[36:39], a[92:95], v[32:35]
s_xor_b32 s64, s73, 131200
ds_read_b64_tr_b16 a[84:85], v11 offset:57344
v_add_u32 v7, 0x8000, v7
v_mfma_f32_16x16x32_bf16 v[48:51], a[44:47], a[92:95], v[48:51]
buffer_load_dwordx4 v12, s[48:51], s64 offen lds
v_mfma_f32_16x16x32_bf16 v[48:51], a[40:43], a[88:91], v[48:51]
ds_read_b64_tr_b16 a[86:87], v11 offset:58368
v_cvt_pk_bf16_f32 v172, v168, v169
v_mfma_f32_16x16x32_bf16 v[64:67], a[48:51], a[88:91], v[64:67]
v_cvt_pk_bf16_f32 v173, v170, v171
v_accvgpr_write_b32 a168, v172
v_mfma_f32_16x16x32_bf16 v[64:67], a[52:55], a[92:95], v[64:67]
v_accvgpr_write_b32 a169, v173
v_accvgpr_write_b32 a170, v174
v_mfma_f32_16x16x32_bf16 v[80:83], a[60:63], a[92:95], v[80:83]
v_accvgpr_write_b32 a171, v175
v_cvt_pk_bf16_f32 v167, v166, v167
v_mfma_f32_16x16x32_bf16 v[80:83], a[56:59], a[88:91], v[80:83]
s_xor_b32 m0, s84, 39936
v_cvt_pk_bf16_f32 v166, v164, v165
v_cvt_pk_bf16_f32 v164, v160, v161
v_mfma_f32_16x16x32_bf16 v[144:147], a[56:59], a[96:99], v[144:147]
s_xor_b32 s64, s73, 147584
v_cvt_pk_bf16_f32 v165, v162, v163
v_accvgpr_write_b32 a172, v164
v_mfma_f32_16x16x32_bf16 v[144:147], a[60:63], a[100:103], v[144:147]
buffer_load_dwordx4 v13, s[48:51], s64 offen lds
v_mfma_f32_16x16x32_bf16 v[128:131], a[52:55], a[100:103], v[128:131]
v_add_u32 v8, 0x8000, v8
v_accvgpr_write_b32 a173, v165
v_mfma_f32_16x16x32_bf16 v[128:131], a[48:51], a[96:99], v[128:131]
v_accvgpr_write_b32 a174, v166
v_accvgpr_write_b32 a175, v167
v_mfma_f32_16x16x32_bf16 v[112:115], a[40:43], a[96:99], v[112:115]
v_cvt_pk_bf16_f32 v159, v158, v159
v_cvt_pk_bf16_f32 v158, v156, v157
v_mfma_f32_16x16x32_bf16 v[112:115], a[44:47], a[100:103], v[112:115]
v_cvt_pk_bf16_f32 v156, v152, v153
v_cvt_pk_bf16_f32 v157, v154, v155
v_mfma_f32_16x16x32_bf16 v[96:99], a[36:39], a[100:103], v[96:99]
v_add_u32 v9, 0x8000, v9
v_add_u32 v10, 0x8000, v10
v_mfma_f32_16x16x32_bf16 v[96:99], a[32:35], a[96:99], v[96:99]
s_waitcnt lgkmcnt(0)
v_add_u32 v11, 0x8000, v11
v_accvgpr_write_b32 a176, v156
v_mfma_f32_16x16x32_bf16 v[36:39], a[32:35], a[104:107], v[36:39]
v_accvgpr_write_b32 a177, v157
v_accvgpr_write_b32 a178, v158
v_mfma_f32_16x16x32_bf16 v[36:39], a[36:39], a[108:111], v[36:39]
v_accvgpr_write_b32 a179, v159
v_mfma_f32_16x16x32_bf16 v[52:55], a[44:47], a[108:111], v[52:55]
s_add_u32 s67, s79, 23552
s_waitcnt lgkmcnt(0)
s_barrier
v_mfma_f32_16x16x32_bf16 v[52:55], a[40:43], a[104:107], v[52:55]
s_xor_b32 m0, s77, 98304
ds_read_b64_tr_b16 a[88:89], v19 offset:36864
v_cvt_pk_bf16_f32 v139, v138, v139
v_mfma_f32_16x16x32_bf16 v[68:71], a[48:51], a[104:107], v[68:71]
s_xor_b32 s64, s71, 1048576
ds_read_b64_tr_b16 a[90:91], v19 offset:37120
v_cvt_pk_bf16_f32 v138, v136, v137
v_mfma_f32_16x16x32_bf16 v[68:71], a[52:55], a[108:111], v[68:71]
buffer_load_dwordx4 v14, s[56:59], s64 offen lds
v_mfma_f32_16x16x32_bf16 v[84:87], a[60:63], a[108:111], v[84:87]
ds_read_b64_tr_b16 a[92:93], v19 offset:38912
v_cvt_pk_bf16_f32 v136, v72, v73
v_mfma_f32_16x16x32_bf16 v[84:87], a[56:59], a[104:107], v[84:87]
ds_read_b64_tr_b16 a[94:95], v19 offset:39168
v_cvt_pk_bf16_f32 v137, v74, v75
v_mfma_f32_16x16x32_bf16 v[148:151], a[56:59], a[112:115], v[148:151]
ds_read_b64_tr_b16 a[96:97], v20 offset:36864
v_mfma_f32_16x16x32_bf16 v[148:151], a[60:63], a[116:119], v[148:151]
ds_read_b64_tr_b16 a[98:99], v20 offset:37120
v_mfma_f32_16x16x32_bf16 v[132:135], a[52:55], a[116:119], v[132:135]
ds_read_b64_tr_b16 a[100:101], v20 offset:38912
v_mfma_f32_16x16x32_bf16 v[132:135], a[48:51], a[112:115], v[132:135]
ds_read_b64_tr_b16 a[102:103], v20 offset:39168
v_mfma_f32_16x16x32_bf16 v[116:119], a[40:43], a[112:115], v[116:119]
s_add_u32 m0, s78, 114688
ds_read_b64_tr_b16 a[104:105], v19 offset:40960
v_mfma_f32_16x16x32_bf16 v[116:119], a[44:47], a[116:119], v[116:119]
s_add_u32 s64, s75, 786432
ds_read_b64_tr_b16 a[106:107], v19 offset:41216
v_mfma_f32_16x16x32_bf16 v[100:103], a[36:39], a[116:119], v[100:103]
buffer_load_dwordx4 v23, s[60:63], s64 offen lds
v_mfma_f32_16x16x32_bf16 v[100:103], a[32:35], a[112:115], v[100:103]
ds_read_b64_tr_b16 a[108:109], v19 offset:43008
v_mfma_f32_16x16x32_bf16 v[248:251], a[32:35], a[72:75], v[248:251]
ds_read_b64_tr_b16 a[110:111], v19 offset:43264
v_mfma_f32_16x16x32_bf16 v[248:251], a[36:39], a[76:79], v[248:251]
ds_read_b64_tr_b16 a[112:113], v20 offset:40960
v_mfma_f32_16x16x32_bf16 v[252:255], a[44:47], a[76:79], v[252:255]
ds_read_b64_tr_b16 a[114:115], v20 offset:41216
v_mfma_f32_16x16x32_bf16 v[252:255], a[40:43], a[72:75], v[252:255]
ds_read_b64_tr_b16 a[116:117], v20 offset:43008
v_mfma_f32_16x16x32_bf16 a[120:123], a[48:51], a[72:75], a[120:123]
ds_read_b64_tr_b16 a[118:119], v20 offset:43264
v_mfma_f32_16x16x32_bf16 a[120:123], a[52:55], a[76:79], a[120:123]
s_xor_b32 m0, s77, 99328
buffer_store_dwordx4 v[136:139], v16, s[44:47], s67 offen sc1
v_mfma_f32_16x16x32_bf16 a[124:127], a[60:63], a[76:79], a[124:127]
s_xor_b32 s64, s71, 1081344
v_cvt_pk_bf16_f32 v123, v122, v123
v_cvt_pk_bf16_f32 v122, v120, v121
v_mfma_f32_16x16x32_bf16 a[124:127], a[56:59], a[72:75], a[124:127]
buffer_load_dwordx4 v14, s[56:59], s64 offen lds
v_mfma_f32_16x16x32_bf16 a[128:131], a[56:59], a[80:83], a[128:131]
ds_read_b64_tr_b16 a[72:73], v19 offset:32768
v_cvt_pk_bf16_f32 v120, v56, v57
v_mfma_f32_16x16x32_bf16 a[128:131], a[60:63], a[84:87], a[128:131]
ds_read_b64_tr_b16 a[74:75], v19 offset:33024
v_cvt_pk_bf16_f32 v121, v58, v59
v_mfma_f32_16x16x32_bf16 a[132:135], a[52:55], a[84:87], a[132:135]
ds_read_b64_tr_b16 a[76:77], v19 offset:34816
v_accvgpr_write_b32 a180, v120
v_mfma_f32_16x16x32_bf16 a[132:135], a[48:51], a[80:83], a[132:135]
ds_read_b64_tr_b16 a[78:79], v19 offset:35072
v_accvgpr_write_b32 a181, v121
v_mfma_f32_16x16x32_bf16 a[136:139], a[40:43], a[80:83], a[136:139]
v_accvgpr_write_b32 a182, v122
v_accvgpr_write_b32 a183, v123
v_mfma_f32_16x16x32_bf16 a[136:139], a[44:47], a[84:87], a[136:139]
v_cvt_pk_bf16_f32 v107, v106, v107
v_cvt_pk_bf16_f32 v106, v104, v105
v_mfma_f32_16x16x32_bf16 a[140:143], a[36:39], a[84:87], a[140:143]
s_add_u32 m0, s78, 118784
v_cvt_pk_bf16_f32 v104, v40, v41
v_cvt_pk_bf16_f32 v105, v42, v43
v_mfma_f32_16x16x32_bf16 a[140:143], a[32:35], a[80:83], a[140:143]
s_waitcnt lgkmcnt(4)
s_add_u32 s64, s75, 788480
ds_read_b64_tr_b16 a[80:81], v20 offset:32768
v_accvgpr_write_b32 a184, v104
v_mfma_f32_16x16x32_bf16 v[184:187], a[88:91], a[0:3], 0
buffer_load_dwordx4 v23, s[60:63], s64 offen lds
v_mfma_f32_16x16x32_bf16 v[184:187], a[92:95], a[4:7], v[184:187]
ds_read_b64_tr_b16 a[82:83], v20 offset:33024
v_accvgpr_write_b32 a185, v105
v_mfma_f32_16x16x32_bf16 v[192:195], a[92:95], a[12:15], 0
ds_read_b64_tr_b16 a[84:85], v20 offset:34816
v_accvgpr_write_b32 a186, v106
v_mfma_f32_16x16x32_bf16 v[192:195], a[88:91], a[8:11], v[192:195]
ds_read_b64_tr_b16 a[86:87], v20 offset:35072
v_accvgpr_write_b32 a187, v107
v_mfma_f32_16x16x32_bf16 v[200:203], a[88:91], a[16:19], 0
v_cvt_pk_bf16_f32 v91, v90, v91
v_cvt_pk_bf16_f32 v90, v88, v89
v_mfma_f32_16x16x32_bf16 v[200:203], a[92:95], a[20:23], v[200:203]
v_cvt_pk_bf16_f32 v88, v24, v25
v_cvt_pk_bf16_f32 v89, v26, v27
v_mfma_f32_16x16x32_bf16 v[208:211], a[92:95], a[28:31], 0
v_accvgpr_write_b32 a188, v88
v_accvgpr_write_b32 a189, v89
v_mfma_f32_16x16x32_bf16 v[208:211], a[88:91], a[24:27], v[208:211]
s_xor_b32 m0, s77, 100352
ds_read_b64_tr_b16 a[88:89], v4 offset:32768
v_accvgpr_write_b32 a190, v90
v_mfma_f32_16x16x32_bf16 v[212:215], a[96:99], a[24:27], 0
s_xor_b32 s64, s71, 1114112
ds_read_b64_tr_b16 a[90:91], v4 offset:33792
v_accvgpr_write_b32 a191, v91
v_mfma_f32_16x16x32_bf16 v[212:215], a[100:103], a[28:31], v[212:215]
s_add_u32 s67, s79, 8192
ds_read_b64_tr_b16 a[92:93], v4 offset:40960
v_cvt_pk_bf16_f32 v47, v46, v47
v_mfma_f32_16x16x32_bf16 v[204:207], a[100:103], a[20:23], 0
buffer_load_dwordx4 v15, s[56:59], s64 offen lds
v_mfma_f32_16x16x32_bf16 v[204:207], a[96:99], a[16:19], v[204:207]
ds_read_b64_tr_b16 a[94:95], v4 offset:41984
v_cvt_pk_bf16_f32 v46, v44, v45
v_mfma_f32_16x16x32_bf16 v[196:199], a[96:99], a[8:11], 0
v_cvt_pk_bf16_f32 v44, v28, v29
v_cvt_pk_bf16_f32 v45, v30, v31
v_mfma_f32_16x16x32_bf16 v[196:199], a[100:103], a[12:15], v[196:199]
buffer_store_dwordx4 v[44:47], v16, s[44:47], s67 offen sc1
v_mfma_f32_16x16x32_bf16 v[188:191], a[100:103], a[4:7], 0
v_cvt_pk_bf16_f32 v79, v78, v79
v_cvt_pk_bf16_f32 v78, v76, v77
v_mfma_f32_16x16x32_bf16 v[188:191], a[96:99], a[0:3], v[188:191]
s_branch L_po6
L_pg6:
s_branch L_pg10
L_po6:
ds_read_b64_tr_b16 a[96:97], v5 offset:32768
v_cvt_pk_bf16_f32 v76, v60, v61
v_mfma_f32_16x16x32_bf16 v[216:219], a[0:3], a[104:107], 0
ds_read_b64_tr_b16 a[98:99], v5 offset:33792
v_cvt_pk_bf16_f32 v77, v62, v63
v_mfma_f32_16x16x32_bf16 v[216:219], a[4:7], a[108:111], v[216:219]
s_add_u32 m0, s78, 122880
ds_read_b64_tr_b16 a[100:101], v5 offset:40960
v_accvgpr_write_b32 a192, v76
v_mfma_f32_16x16x32_bf16 v[224:227], a[12:15], a[108:111], 0
s_add_u32 s64, s75, 790528
ds_read_b64_tr_b16 a[102:103], v5 offset:41984
v_accvgpr_write_b32 a193, v77
v_mfma_f32_16x16x32_bf16 v[224:227], a[8:11], a[104:107], v[224:227]
buffer_load_dwordx4 v23, s[60:63], s64 offen lds
v_mfma_f32_16x16x32_bf16 v[232:235], a[16:19], a[104:107], 0
v_accvgpr_write_b32 a194, v78
v_accvgpr_write_b32 a195, v79
v_mfma_f32_16x16x32_bf16 v[232:235], a[20:23], a[108:111], v[232:235]
v_cvt_pk_bf16_f32 v124, v124, v125
v_cvt_pk_bf16_f32 v125, v126, v127
v_mfma_f32_16x16x32_bf16 v[240:243], a[28:31], a[108:111], 0
v_cvt_pk_bf16_f32 v126, v140, v141
v_cvt_pk_bf16_f32 v127, v142, v143
v_mfma_f32_16x16x32_bf16 v[240:243], a[24:27], a[104:107], v[240:243]
ds_read_b64_tr_b16 a[104:105], v6 offset:32768
v_accvgpr_write_b32 a196, v124
v_mfma_f32_16x16x32_bf16 v[244:247], a[24:27], a[112:115], 0
ds_read_b64_tr_b16 a[106:107], v6 offset:33792
v_accvgpr_write_b32 a197, v125
v_mfma_f32_16x16x32_bf16 v[244:247], a[28:31], a[116:119], v[244:247]
ds_read_b64_tr_b16 a[108:109], v6 offset:40960
v_accvgpr_write_b32 a198, v126
v_mfma_f32_16x16x32_bf16 v[236:239], a[20:23], a[116:119], 0
s_xor_b32 m0, s77, 101376
ds_read_b64_tr_b16 a[110:111], v6 offset:41984
v_accvgpr_write_b32 a199, v127
v_mfma_f32_16x16x32_bf16 v[236:239], a[16:19], a[112:115], v[236:239]
s_xor_b32 s64, s71, 1146880
v_cvt_pk_bf16_f32 v92, v92, v93
v_cvt_pk_bf16_f32 v93, v94, v95
v_mfma_f32_16x16x32_bf16 v[228:231], a[8:11], a[112:115], 0
buffer_load_dwordx4 v15, s[56:59], s64 offen lds
v_mfma_f32_16x16x32_bf16 v[228:231], a[12:15], a[116:119], v[228:231]
v_cvt_pk_bf16_f32 v94, v108, v109
v_cvt_pk_bf16_f32 v95, v110, v111
v_mfma_f32_16x16x32_bf16 v[220:223], a[4:7], a[116:119], 0
v_accvgpr_write_b32 a200, v92
v_accvgpr_write_b32 a201, v93
v_mfma_f32_16x16x32_bf16 v[220:223], a[0:3], a[112:115], v[220:223]
s_waitcnt lgkmcnt(4)
ds_read_b64_tr_b16 a[112:113], v7 offset:32768
v_accvgpr_write_b32 a202, v94
v_mfma_f32_16x16x32_bf16 v[152:155], a[72:75], a[0:3], 0
ds_read_b64_tr_b16 a[114:115], v7 offset:33792
v_accvgpr_write_b32 a203, v95
v_mfma_f32_16x16x32_bf16 v[152:155], a[76:79], a[4:7], v[152:155]
s_add_u32 s67, s79, 10240
ds_read_b64_tr_b16 a[116:117], v7 offset:40960
v_cvt_pk_bf16_f32 v51, v50, v51
v_mfma_f32_16x16x32_bf16 v[160:163], a[76:79], a[12:15], 0
ds_read_b64_tr_b16 a[118:119], v7 offset:41984
v_cvt_pk_bf16_f32 v50, v48, v49
v_mfma_f32_16x16x32_bf16 v[160:163], a[72:75], a[8:11], v[160:163]
v_cvt_pk_bf16_f32 v48, v32, v33
v_cvt_pk_bf16_f32 v49, v34, v35
v_mfma_f32_16x16x32_bf16 v[168:171], a[72:75], a[16:19], 0
buffer_store_dwordx4 v[48:51], v16, s[44:47], s67 offen sc1
v_mfma_f32_16x16x32_bf16 v[168:171], a[76:79], a[20:23], v[168:171]
v_subrev_u32 v19, 0x8000, v19
v_subrev_u32 v20, 0x8000, v20
v_mfma_f32_16x16x32_bf16 v[176:179], a[76:79], a[28:31], 0
s_xor_b32 m0, s84, 0
v_cvt_pk_bf16_f32 v83, v82, v83
v_cvt_pk_bf16_f32 v82, v80, v81
v_mfma_f32_16x16x32_bf16 v[176:179], a[72:75], a[24:27], v[176:179]
s_xor_b32 s64, s72, 256
ds_read_b64_tr_b16 a[72:73], v8 offset:32768
v_cvt_pk_bf16_f32 v80, v64, v65
v_mfma_f32_16x16x32_bf16 v[180:183], a[80:83], a[24:27], 0
buffer_load_dwordx4 v12, s[48:51], s64 offen lds
v_mfma_f32_16x16x32_bf16 v[180:183], a[84:87], a[28:31], v[180:183]
ds_read_b64_tr_b16 a[74:75], v8 offset:33792
v_subrev_u32 v4, 0x8000, v4
v_mfma_f32_16x16x32_bf16 v[172:175], a[84:87], a[20:23], 0
ds_read_b64_tr_b16 a[76:77], v8 offset:40960
v_cvt_pk_bf16_f32 v81, v66, v67
v_mfma_f32_16x16x32_bf16 v[172:175], a[80:83], a[16:19], v[172:175]
s_xor_b32 m0, s84, 1024
ds_read_b64_tr_b16 a[78:79], v8 offset:41984
v_accvgpr_write_b32 a204, v80
v_mfma_f32_16x16x32_bf16 v[164:167], a[80:83], a[8:11], 0
s_xor_b32 s64, s72, 16640
v_accvgpr_write_b32 a205, v81
v_accvgpr_write_b32 a206, v82
v_mfma_f32_16x16x32_bf16 v[164:167], a[84:87], a[12:15], v[164:167]
buffer_load_dwordx4 v13, s[48:51], s64 offen lds
v_mfma_f32_16x16x32_bf16 v[156:159], a[84:87], a[4:7], 0
v_accvgpr_write_b32 a207, v83
v_cvt_pk_bf16_f32 v128, v128, v129
v_mfma_f32_16x16x32_bf16 v[156:159], a[80:83], a[0:3], v[156:159]
ds_read_b64_tr_b16 a[80:81], v9 offset:32768
v_cvt_pk_bf16_f32 v129, v130, v131
v_mfma_f32_16x16x32_bf16 v[24:27], a[88:91], a[0:3], 0
s_xor_b32 m0, s84, 2048
ds_read_b64_tr_b16 a[82:83], v9 offset:33792
v_cvt_pk_bf16_f32 v130, v144, v145
v_mfma_f32_16x16x32_bf16 v[24:27], a[92:95], a[4:7], v[24:27]
s_xor_b32 s64, s72, 131328
ds_read_b64_tr_b16 a[84:85], v9 offset:40960
v_subrev_u32 v5, 0x8000, v5
v_mfma_f32_16x16x32_bf16 v[40:43], a[92:95], a[12:15], 0
buffer_load_dwordx4 v12, s[48:51], s64 offen lds
v_mfma_f32_16x16x32_bf16 v[40:43], a[88:91], a[8:11], v[40:43]
ds_read_b64_tr_b16 a[86:87], v9 offset:41984
v_cvt_pk_bf16_f32 v131, v146, v147
v_mfma_f32_16x16x32_bf16 v[56:59], a[88:91], a[16:19], 0
s_xor_b32 m0, s84, 3072
v_accvgpr_write_b32 a208, v128
v_accvgpr_write_b32 a209, v129
v_mfma_f32_16x16x32_bf16 v[56:59], a[92:95], a[20:23], v[56:59]
s_xor_b32 s64, s72, 147712
v_accvgpr_write_b32 a210, v130
v_accvgpr_write_b32 a211, v131
v_mfma_f32_16x16x32_bf16 v[72:75], a[92:95], a[28:31], 0
s_waitcnt vmcnt(13)
ds_read_b128 a[32:35], v2 offset:32768
v_cvt_pk_bf16_f32 v96, v96, v97
v_mfma_f32_16x16x32_bf16 v[72:75], a[88:91], a[24:27], v[72:75]
buffer_load_dwordx4 v13, s[48:51], s64 offen lds
v_mfma_f32_16x16x32_bf16 v[136:139], a[96:99], a[24:27], 0
ds_read_b128 a[36:39], v3 offset:32768
v_cvt_pk_bf16_f32 v97, v98, v99
v_mfma_f32_16x16x32_bf16 v[136:139], a[100:103], a[28:31], v[136:139]
ds_read_b128 a[40:43], v2 offset:34816
v_subrev_u32 v6, 0x8000, v6
v_mfma_f32_16x16x32_bf16 v[120:123], a[100:103], a[20:23], 0
s_xor_b32 m0, s84, 4096
ds_read_b128 a[44:47], v3 offset:34816
v_cvt_pk_bf16_f32 v98, v112, v113
v_mfma_f32_16x16x32_bf16 v[120:123], a[96:99], a[16:19], v[120:123]
s_xor_b32 s64, s73, 256
ds_read_b128 a[48:51], v2 offset:36864
v_cvt_pk_bf16_f32 v99, v114, v115
v_mfma_f32_16x16x32_bf16 v[104:107], a[96:99], a[8:11], 0
buffer_load_dwordx4 v12, s[48:51], s64 offen lds
v_mfma_f32_16x16x32_bf16 v[104:107], a[100:103], a[12:15], v[104:107]
ds_read_b128 a[52:55], v3 offset:36864
v_accvgpr_write_b32 a212, v96
v_mfma_f32_16x16x32_bf16 v[88:91], a[100:103], a[4:7], 0
ds_read_b128 a[56:59], v2 offset:38912
v_accvgpr_write_b32 a213, v97
v_mfma_f32_16x16x32_bf16 v[88:91], a[96:99], a[0:3], v[88:91]
s_waitcnt lgkmcnt(7)
s_xor_b32 m0, s84, 5120
ds_read_b128 a[60:63], v3 offset:38912
v_accvgpr_write_b32 a214, v98
v_mfma_f32_16x16x32_bf16 v[28:31], a[104:107], a[0:3], 0
s_xor_b32 s64, s73, 16640
ds_read_b64_tr_b16 a[88:89], v10 offset:32768
v_accvgpr_write_b32 a215, v99
v_mfma_f32_16x16x32_bf16 v[28:31], a[108:111], a[4:7], v[28:31]
s_add_u32 s67, s79, 12288
buffer_load_dwordx4 v13, s[48:51], s64 offen lds
v_mfma_f32_16x16x32_bf16 v[44:47], a[108:111], a[12:15], 0
ds_read_b64_tr_b16 a[90:91], v10 offset:33792
v_subrev_u32 v7, 0x8000, v7
v_mfma_f32_16x16x32_bf16 v[44:47], a[104:107], a[8:11], v[44:47]
ds_read_b64_tr_b16 a[92:93], v10 offset:40960
v_cvt_pk_bf16_f32 v55, v54, v55
v_mfma_f32_16x16x32_bf16 v[60:63], a[104:107], a[16:19], 0
s_xor_b32 m0, s84, 6144
ds_read_b64_tr_b16 a[94:95], v10 offset:41984
v_cvt_pk_bf16_f32 v54, v52, v53
v_mfma_f32_16x16x32_bf16 v[60:63], a[108:111], a[20:23], v[60:63]
s_xor_b32 s64, s73, 131328
ds_read_b64_tr_b16 a[96:97], v11 offset:32768
v_cvt_pk_bf16_f32 v52, v36, v37
v_mfma_f32_16x16x32_bf16 v[76:79], a[108:111], a[28:31], 0
buffer_load_dwordx4 v12, s[48:51], s64 offen lds
v_mfma_f32_16x16x32_bf16 v[76:79], a[104:107], a[24:27], v[76:79]
ds_read_b64_tr_b16 a[98:99], v11 offset:33792
v_cvt_pk_bf16_f32 v53, v38, v39
v_mfma_f32_16x16x32_bf16 v[140:143], a[112:115], a[24:27], 0
ds_read_b64_tr_b16 a[100:101], v11 offset:40960
v_mfma_f32_16x16x32_bf16 v[140:143], a[116:119], a[28:31], v[140:143]
s_xor_b32 m0, s84, 7168
ds_read_b64_tr_b16 a[102:103], v11 offset:41984
v_subrev_u32 v8, 0x8000, v8
v_mfma_f32_16x16x32_bf16 v[124:127], a[116:119], a[20:23], 0
s_xor_b32 s64, s73, 147712
buffer_store_dwordx4 v[52:55], v16, s[44:47], s67 offen sc1
v_mfma_f32_16x16x32_bf16 v[124:127], a[112:115], a[16:19], v[124:127]
buffer_load_dwordx4 v13, s[48:51], s64 offen lds
v_mfma_f32_16x16x32_bf16 v[108:111], a[112:115], a[8:11], 0
v_cvt_pk_bf16_f32 v87, v86, v87
v_cvt_pk_bf16_f32 v86, v84, v85
v_mfma_f32_16x16x32_bf16 v[108:111], a[116:119], a[12:15], v[108:111]
v_cvt_pk_bf16_f32 v84, v68, v69
v_cvt_pk_bf16_f32 v85, v70, v71
v_mfma_f32_16x16x32_bf16 v[92:95], a[116:119], a[4:7], 0
v_subrev_u32 v9, 0x8000, v9
v_subrev_u32 v10, 0x8000, v10
v_mfma_f32_16x16x32_bf16 v[92:95], a[112:115], a[0:3], v[92:95]
v_subrev_u32 v11, 0x8000, v11
v_accvgpr_write_b32 a216, v84
v_mfma_f32_16x16x32_bf16 v[32:35], a[72:75], a[0:3], 0
v_accvgpr_write_b32 a217, v85
v_accvgpr_write_b32 a218, v86
v_mfma_f32_16x16x32_bf16 v[32:35], a[76:79], a[4:7], v[32:35]
v_accvgpr_write_b32 a219, v87
v_cvt_pk_bf16_f32 v132, v132, v133
v_mfma_f32_16x16x32_bf16 v[48:51], a[76:79], a[12:15], 0
s_waitcnt lgkmcnt(0)
s_barrier
v_mfma_f32_16x16x32_bf16 v[48:51], a[72:75], a[8:11], v[48:51]
s_xor_b32 m0, s77, 131072
ds_read_b64_tr_b16 a[104:105], v19 offset:4096
v_cvt_pk_bf16_f32 v133, v134, v135
v_mfma_f32_16x16x32_bf16 v[64:67], a[72:75], a[16:19], 0
s_xor_b32 s64, s71, 1572864
ds_read_b64_tr_b16 a[106:107], v19 offset:4352
v_cvt_pk_bf16_f32 v134, v148, v149
v_mfma_f32_16x16x32_bf16 v[64:67], a[76:79], a[20:23], v[64:67]
buffer_load_dwordx4 v14, s[56:59], s64 offen lds
v_mfma_f32_16x16x32_bf16 v[80:83], a[76:79], a[28:31], 0
ds_read_b64_tr_b16 a[108:109], v19 offset:6144
v_cvt_pk_bf16_f32 v135, v150, v151
v_mfma_f32_16x16x32_bf16 v[80:83], a[72:75], a[24:27], v[80:83]
ds_read_b64_tr_b16 a[110:111], v19 offset:6400
v_accvgpr_write_b32 a220, v132
v_mfma_f32_16x16x32_bf16 v[144:147], a[80:83], a[24:27], 0
ds_read_b64_tr_b16 a[112:113], v20 offset:4096
v_accvgpr_write_b32 a221, v133
v_mfma_f32_16x16x32_bf16 v[144:147], a[84:87], a[28:31], v[144:147]
ds_read_b64_tr_b16 a[114:115], v20 offset:4352
v_accvgpr_write_b32 a222, v134
v_mfma_f32_16x16x32_bf16 v[128:131], a[84:87], a[20:23], 0
ds_read_b64_tr_b16 a[116:117], v20 offset:6144
v_accvgpr_write_b32 a223, v135
v_mfma_f32_16x16x32_bf16 v[128:131], a[80:83], a[16:19], v[128:131]
ds_read_b64_tr_b16 a[118:119], v20 offset:6400
v_cvt_pk_bf16_f32 v100, v100, v101
v_mfma_f32_16x16x32_bf16 v[112:115], a[80:83], a[8:11], 0
s_add_u32 m0, s78, 147456
ds_read_b64_tr_b16 a[72:73], v19 offset:8192
v_cvt_pk_bf16_f32 v101, v102, v103
v_mfma_f32_16x16x32_bf16 v[112:115], a[84:87], a[12:15], v[112:115]
s_add_u32 s64, s75, 1179648
ds_read_b64_tr_b16 a[74:75], v19 offset:8448
v_cvt_pk_bf16_f32 v102, v116, v117
v_mfma_f32_16x16x32_bf16 v[96:99], a[84:87], a[4:7], 0
buffer_load_dwordx4 v23, s[60:63], s64 offen lds
v_mfma_f32_16x16x32_bf16 v[96:99], a[80:83], a[0:3], v[96:99]
ds_read_b64_tr_b16 a[76:77], v19 offset:10240
v_cvt_pk_bf16_f32 v103, v118, v119
v_mfma_f32_16x16x32_bf16 v[36:39], a[88:91], a[0:3], 0
ds_read_b64_tr_b16 a[78:79], v19 offset:10496
v_accvgpr_write_b32 a224, v100
v_mfma_f32_16x16x32_bf16 v[36:39], a[92:95], a[4:7], v[36:39]
ds_read_b64_tr_b16 a[80:81], v20 offset:8192
v_accvgpr_write_b32 a225, v101
v_mfma_f32_16x16x32_bf16 v[52:55], a[92:95], a[12:15], 0
s_xor_b32 s68, s66, 0
ds_read_b64_tr_b16 a[82:83], v20 offset:8448
v_accvgpr_write_b32 a226, v102
v_mfma_f32_16x16x32_bf16 v[52:55], a[88:91], a[8:11], v[52:55]
s_xor_b32 m0, s77, 132096
ds_read_b64_tr_b16 a[84:85], v20 offset:10240
v_accvgpr_write_b32 a227, v103
v_mfma_f32_16x16x32_bf16 v[68:71], a[88:91], a[16:19], 0
s_add_u32 s67, s79, 14336
ds_read_b64_tr_b16 a[86:87], v20 offset:10496
v_cvt_pk_bf16_f32 v255, v254, v255
v_mfma_f32_16x16x32_bf16 v[68:71], a[92:95], a[20:23], v[68:71]
s_xor_b32 s64, s71, 1605632
v_cvt_pk_bf16_f32 v254, v252, v253
v_cvt_pk_bf16_f32 v252, v248, v249
v_mfma_f32_16x16x32_bf16 v[84:87], a[92:95], a[28:31], 0
s_mov_b64 exec, 1
buffer_atomic_add a251, v1, s[52:55], s68 offen offset:0 sc1
s_mov_b64 exec, -1
v_mfma_f32_16x16x32_bf16 v[84:87], a[88:91], a[24:27], v[84:87]
buffer_load_dwordx4 v14, s[56:59], s64 offen lds
v_mfma_f32_16x16x32_bf16 v[148:151], a[96:99], a[24:27], 0
ds_read_b64_tr_b16 a[88:89], v19 offset:0
v_cvt_pk_bf16_f32 v253, v250, v251
v_mfma_f32_16x16x32_bf16 v[148:151], a[100:103], a[28:31], v[148:151]
ds_read_b64_tr_b16 a[90:91], v19 offset:256
v_mfma_f32_16x16x32_bf16 v[132:135], a[100:103], a[20:23], 0
ds_read_b64_tr_b16 a[92:93], v19 offset:2048
v_mfma_f32_16x16x32_bf16 v[132:135], a[96:99], a[16:19], v[132:135]
s_add_u32 s65, s79, 16384
ds_read_b64_tr_b16 a[94:95], v19 offset:2304
v_mfma_f32_16x16x32_bf16 v[116:119], a[96:99], a[8:11], 0
buffer_store_dwordx4 a[144:147], v16, s[44:47], s65 offen sc1
v_mfma_f32_16x16x32_bf16 v[116:119], a[100:103], a[12:15], v[116:119]
buffer_store_dwordx4 v[252:255], v16, s[44:47], s67 offen sc1
v_mfma_f32_16x16x32_bf16 v[100:103], a[100:103], a[4:7], 0
s_add_u32 m0, s78, 151552
v_mfma_f32_16x16x32_bf16 v[100:103], a[96:99], a[0:3], v[100:103]
s_waitcnt lgkmcnt(4)
s_add_u32 s64, s75, 1181696
ds_read_b64_tr_b16 a[96:97], v20 offset:0
v_accvgpr_read_b32 v248, a120
v_mfma_f32_16x16x32_bf16 v[184:187], a[104:107], a[32:35], v[184:187]
buffer_load_dwordx4 v23, s[60:63], s64 offen lds
v_mfma_f32_16x16x32_bf16 v[184:187], a[108:111], a[36:39], v[184:187]
ds_read_b64_tr_b16 a[98:99], v20 offset:256
v_accvgpr_read_b32 v249, a121
v_mfma_f32_16x16x32_bf16 v[192:195], a[108:111], a[44:47], v[192:195]
ds_read_b64_tr_b16 a[100:101], v20 offset:2048
v_accvgpr_read_b32 v250, a122
v_mfma_f32_16x16x32_bf16 v[192:195], a[104:107], a[40:43], v[192:195]
ds_read_b64_tr_b16 a[102:103], v20 offset:2304
v_accvgpr_read_b32 v251, a123
v_mfma_f32_16x16x32_bf16 v[200:203], a[104:107], a[48:51], v[200:203]
v_accvgpr_read_b32 v252, a124
v_accvgpr_read_b32 v253, a125
v_mfma_f32_16x16x32_bf16 v[200:203], a[108:111], a[52:55], v[200:203]
v_accvgpr_read_b32 v254, a126
v_accvgpr_read_b32 v255, a127
v_mfma_f32_16x16x32_bf16 v[208:211], a[108:111], a[60:63], v[208:211]
v_cvt_pk_bf16_f32 v255, v254, v255
v_cvt_pk_bf16_f32 v254, v252, v253
v_mfma_f32_16x16x32_bf16 v[208:211], a[104:107], a[56:59], v[208:211]
ds_read_b64_tr_b16 a[104:105], v4 offset:0
v_cvt_pk_bf16_f32 v252, v248, v249
v_mfma_f32_16x16x32_bf16 v[212:215], a[112:115], a[56:59], v[212:215]
s_xor_b32 m0, s77, 133120
ds_read_b64_tr_b16 a[106:107], v4 offset:1024
v_cvt_pk_bf16_f32 v253, v250, v251
v_mfma_f32_16x16x32_bf16 v[212:215], a[116:119], a[60:63], v[212:215]
s_xor_b32 s64, s71, 1638400
ds_read_b64_tr_b16 a[108:109], v4 offset:8192
v_accvgpr_write_b32 a228, v252
v_mfma_f32_16x16x32_bf16 v[204:207], a[116:119], a[52:55], v[204:207]
buffer_load_dwordx4 v15, s[56:59], s64 offen lds
v_mfma_f32_16x16x32_bf16 v[204:207], a[112:115], a[48:51], v[204:207]
ds_read_b64_tr_b16 a[110:111], v4 offset:9216
v_accvgpr_write_b32 a229, v253
v_mfma_f32_16x16x32_bf16 v[196:199], a[112:115], a[40:43], v[196:199]
v_accvgpr_write_b32 a230, v254
v_accvgpr_write_b32 a231, v255
v_mfma_f32_16x16x32_bf16 v[196:199], a[116:119], a[44:47], v[196:199]
v_mfma_f32_16x16x32_bf16 v[188:191], a[116:119], a[36:39], v[188:191]
v_accvgpr_read_b32 v248, a132
v_accvgpr_read_b32 v249, a133
v_mfma_f32_16x16x32_bf16 v[188:191], a[112:115], a[32:35], v[188:191]
ds_read_b64_tr_b16 a[112:113], v5 offset:0
v_accvgpr_read_b32 v250, a134
v_mfma_f32_16x16x32_bf16 v[216:219], a[32:35], a[72:75], v[216:219]
ds_read_b64_tr_b16 a[114:115], v5 offset:1024
v_accvgpr_read_b32 v251, a135
v_mfma_f32_16x16x32_bf16 v[216:219], a[36:39], a[76:79], v[216:219]
s_add_u32 m0, s78, 155648
ds_read_b64_tr_b16 a[116:117], v5 offset:8192
v_accvgpr_read_b32 v252, a128
v_mfma_f32_16x16x32_bf16 v[224:227], a[44:47], a[76:79], v[224:227]
s_add_u32 s64, s75, 1183744
ds_read_b64_tr_b16 a[118:119], v5 offset:9216
v_accvgpr_read_b32 v253, a129
v_mfma_f32_16x16x32_bf16 v[224:227], a[40:43], a[72:75], v[224:227]
buffer_load_dwordx4 v23, s[60:63], s64 offen lds
v_mfma_f32_16x16x32_bf16 v[232:235], a[48:51], a[72:75], v[232:235]
v_accvgpr_read_b32 v254, a130
v_accvgpr_read_b32 v255, a131
v_mfma_f32_16x16x32_bf16 v[232:235], a[52:55], a[76:79], v[232:235]
v_cvt_pk_bf16_f32 v255, v254, v255
v_cvt_pk_bf16_f32 v254, v252, v253
v_mfma_f32_16x16x32_bf16 v[240:243], a[60:63], a[76:79], v[240:243]
v_cvt_pk_bf16_f32 v252, v248, v249
v_cvt_pk_bf16_f32 v253, v250, v251
v_mfma_f32_16x16x32_bf16 v[240:243], a[56:59], a[72:75], v[240:243]
ds_read_b64_tr_b16 a[72:73], v6 offset:0
v_accvgpr_write_b32 a232, v252
v_mfma_f32_16x16x32_bf16 v[244:247], a[56:59], a[80:83], v[244:247]
ds_read_b64_tr_b16 a[74:75], v6 offset:1024
v_accvgpr_write_b32 a233, v253
v_mfma_f32_16x16x32_bf16 v[244:247], a[60:63], a[84:87], v[244:247]
ds_read_b64_tr_b16 a[76:77], v6 offset:8192
v_accvgpr_write_b32 a234, v254
v_mfma_f32_16x16x32_bf16 v[236:239], a[52:55], a[84:87], v[236:239]
s_xor_b32 m0, s77, 134144
ds_read_b64_tr_b16 a[78:79], v6 offset:9216
v_accvgpr_write_b32 a235, v255
v_mfma_f32_16x16x32_bf16 v[236:239], a[48:51], a[80:83], v[236:239]
s_xor_b32 s64, s71, 1671168
v_mfma_f32_16x16x32_bf16 v[228:231], a[40:43], a[80:83], v[228:231]
buffer_load_dwordx4 v15, s[56:59], s64 offen lds
v_mfma_f32_16x16x32_bf16 v[228:231], a[44:47], a[84:87], v[228:231]
v_accvgpr_read_b32 v248, a140
v_accvgpr_read_b32 v249, a141
v_mfma_f32_16x16x32_bf16 v[220:223], a[36:39], a[84:87], v[220:223]
v_accvgpr_read_b32 v250, a142
v_accvgpr_read_b32 v251, a143
v_mfma_f32_16x16x32_bf16 v[220:223], a[32:35], a[80:83], v[220:223]
s_waitcnt lgkmcnt(4)
ds_read_b64_tr_b16 a[80:81], v7 offset:0
v_accvgpr_read_b32 v252, a136
v_mfma_f32_16x16x32_bf16 v[152:155], a[88:91], a[32:35], v[152:155]
ds_read_b64_tr_b16 a[82:83], v7 offset:1024
v_accvgpr_read_b32 v253, a137
v_mfma_f32_16x16x32_bf16 v[152:155], a[92:95], a[36:39], v[152:155]
ds_read_b64_tr_b16 a[84:85], v7 offset:8192
v_accvgpr_read_b32 v254, a138
v_mfma_f32_16x16x32_bf16 v[160:163], a[92:95], a[44:47], v[160:163]
ds_read_b64_tr_b16 a[86:87], v7 offset:9216
v_accvgpr_read_b32 v255, a139
v_mfma_f32_16x16x32_bf16 v[160:163], a[88:91], a[40:43], v[160:163]
v_cvt_pk_bf16_f32 v255, v254, v255
v_cvt_pk_bf16_f32 v254, v252, v253
v_mfma_f32_16x16x32_bf16 v[168:171], a[88:91], a[48:51], v[168:171]
v_cvt_pk_bf16_f32 v252, v248, v249
v_cvt_pk_bf16_f32 v253, v250, v251
v_mfma_f32_16x16x32_bf16 v[168:171], a[92:95], a[52:55], v[168:171]
v_accvgpr_write_b32 a236, v252
v_accvgpr_write_b32 a237, v253
v_mfma_f32_16x16x32_bf16 v[176:179], a[92:95], a[60:63], v[176:179]
s_xor_b32 m0, s84, 32768
v_accvgpr_write_b32 a238, v254
v_accvgpr_write_b32 a239, v255
v_mfma_f32_16x16x32_bf16 v[176:179], a[88:91], a[56:59], v[176:179]
s_xor_b32 s64, s72, 384
ds_read_b64_tr_b16 a[88:89], v8 offset:0
v_mfma_f32_16x16x32_bf16 v[180:183], a[96:99], a[56:59], v[180:183]
s_add_u32 s65, s79, 4096
buffer_load_dwordx4 v12, s[48:51], s64 offen lds
v_mfma_f32_16x16x32_bf16 v[180:183], a[100:103], a[60:63], v[180:183]
buffer_store_dwordx4 a[148:151], v16, s[44:47], s65 offen sc1
v_mfma_f32_16x16x32_bf16 v[172:175], a[100:103], a[52:55], v[172:175]
ds_read_b64_tr_b16 a[90:91], v8 offset:1024
v_mfma_f32_16x16x32_bf16 v[172:175], a[96:99], a[48:51], v[172:175]
s_xor_b32 m0, s84, 33792
ds_read_b64_tr_b16 a[92:93], v8 offset:8192
v_mfma_f32_16x16x32_bf16 v[164:167], a[96:99], a[40:43], v[164:167]
s_xor_b32 s64, s72, 16768
ds_read_b64_tr_b16 a[94:95], v8 offset:9216
v_mfma_f32_16x16x32_bf16 v[164:167], a[100:103], a[44:47], v[164:167]
buffer_load_dwordx4 v13, s[48:51], s64 offen lds
v_mfma_f32_16x16x32_bf16 v[156:159], a[100:103], a[36:39], v[156:159]
v_mfma_f32_16x16x32_bf16 v[156:159], a[96:99], a[32:35], v[156:159]
ds_read_b64_tr_b16 a[96:97], v9 offset:0
v_mfma_f32_16x16x32_bf16 v[24:27], a[104:107], a[32:35], v[24:27]
s_xor_b32 m0, s84, 34816
ds_read_b64_tr_b16 a[98:99], v9 offset:1024
v_mfma_f32_16x16x32_bf16 v[24:27], a[108:111], a[36:39], v[24:27]
s_xor_b32 s64, s72, 131456
ds_read_b64_tr_b16 a[100:101], v9 offset:8192
v_mfma_f32_16x16x32_bf16 v[40:43], a[108:111], a[44:47], v[40:43]
buffer_load_dwordx4 v12, s[48:51], s64 offen lds
v_mfma_f32_16x16x32_bf16 v[40:43], a[104:107], a[40:43], v[40:43]
ds_read_b64_tr_b16 a[102:103], v9 offset:9216
v_mfma_f32_16x16x32_bf16 v[56:59], a[104:107], a[48:51], v[56:59]
v_mfma_f32_16x16x32_bf16 v[56:59], a[108:111], a[52:55], v[56:59]
s_xor_b32 m0, s84, 35840
v_mfma_f32_16x16x32_bf16 v[72:75], a[108:111], a[60:63], v[72:75]
s_waitcnt vmcnt(14)
s_xor_b32 s64, s72, 147840
ds_read_b128 a[0:3], v2 offset:0
v_mfma_f32_16x16x32_bf16 v[72:75], a[104:107], a[56:59], v[72:75]
buffer_load_dwordx4 v13, s[48:51], s64 offen lds
v_mfma_f32_16x16x32_bf16 v[136:139], a[112:115], a[56:59], v[136:139]
ds_read_b128 a[4:7], v3 offset:0
v_mfma_f32_16x16x32_bf16 v[136:139], a[116:119], a[60:63], v[136:139]
ds_read_b128 a[8:11], v2 offset:2048
v_mfma_f32_16x16x32_bf16 v[120:123], a[116:119], a[52:55], v[120:123]
s_xor_b32 m0, s84, 36864
ds_read_b128 a[12:15], v3 offset:2048
v_mfma_f32_16x16x32_bf16 v[120:123], a[112:115], a[48:51], v[120:123]
s_xor_b32 s64, s73, 384
ds_read_b128 a[16:19], v2 offset:4096
v_mfma_f32_16x16x32_bf16 v[104:107], a[112:115], a[40:43], v[104:107]
buffer_load_dwordx4 v12, s[48:51], s64 offen lds
v_mfma_f32_16x16x32_bf16 v[104:107], a[116:119], a[44:47], v[104:107]
ds_read_b128 a[20:23], v3 offset:4096
v_mfma_f32_16x16x32_bf16 v[88:91], a[116:119], a[36:39], v[88:91]
ds_read_b128 a[24:27], v2 offset:6144
v_mfma_f32_16x16x32_bf16 v[88:91], a[112:115], a[32:35], v[88:91]
s_waitcnt lgkmcnt(7)
s_xor_b32 m0, s84, 37888
ds_read_b128 a[28:31], v3 offset:6144
v_mfma_f32_16x16x32_bf16 v[28:31], a[72:75], a[32:35], v[28:31]
s_xor_b32 s64, s73, 16768
ds_read_b64_tr_b16 a[104:105], v10 offset:0
v_mfma_f32_16x16x32_bf16 v[28:31], a[76:79], a[36:39], v[28:31]
buffer_load_dwordx4 v13, s[48:51], s64 offen lds
v_mfma_f32_16x16x32_bf16 v[44:47], a[76:79], a[44:47], v[44:47]
ds_read_b64_tr_b16 a[106:107], v10 offset:1024
v_mfma_f32_16x16x32_bf16 v[44:47], a[72:75], a[40:43], v[44:47]
ds_read_b64_tr_b16 a[108:109], v10 offset:8192
v_mfma_f32_16x16x32_bf16 v[60:63], a[72:75], a[48:51], v[60:63]
s_xor_b32 m0, s84, 38912
ds_read_b64_tr_b16 a[110:111], v10 offset:9216
v_mfma_f32_16x16x32_bf16 v[60:63], a[76:79], a[52:55], v[60:63]
s_xor_b32 s64, s73, 131456
ds_read_b64_tr_b16 a[112:113], v11 offset:0
v_mfma_f32_16x16x32_bf16 v[76:79], a[76:79], a[60:63], v[76:79]
buffer_load_dwordx4 v12, s[48:51], s64 offen lds
v_mfma_f32_16x16x32_bf16 v[76:79], a[72:75], a[56:59], v[76:79]
ds_read_b64_tr_b16 a[114:115], v11 offset:1024
v_mfma_f32_16x16x32_bf16 v[140:143], a[80:83], a[56:59], v[140:143]
ds_read_b64_tr_b16 a[116:117], v11 offset:8192
v_mfma_f32_16x16x32_bf16 v[140:143], a[84:87], a[60:63], v[140:143]
s_xor_b32 m0, s84, 39936
ds_read_b64_tr_b16 a[118:119], v11 offset:9216
v_mfma_f32_16x16x32_bf16 v[124:127], a[84:87], a[52:55], v[124:127]
s_xor_b32 s64, s73, 147840
v_mfma_f32_16x16x32_bf16 v[124:127], a[80:83], a[48:51], v[124:127]
buffer_load_dwordx4 v13, s[48:51], s64 offen lds
v_mfma_f32_16x16x32_bf16 v[108:111], a[80:83], a[40:43], v[108:111]
v_mfma_f32_16x16x32_bf16 v[108:111], a[84:87], a[44:47], v[108:111]
v_mfma_f32_16x16x32_bf16 v[92:95], a[84:87], a[36:39], v[92:95]
v_mfma_f32_16x16x32_bf16 v[92:95], a[80:83], a[32:35], v[92:95]
v_mfma_f32_16x16x32_bf16 v[32:35], a[88:91], a[32:35], v[32:35]
v_mfma_f32_16x16x32_bf16 v[32:35], a[92:95], a[36:39], v[32:35]
s_branch L_po7
L_pg7:
s_branch L_pg11
L_po7:
v_mfma_f32_16x16x32_bf16 v[48:51], a[92:95], a[44:47], v[48:51]
s_waitcnt lgkmcnt(0)
s_barrier
v_mfma_f32_16x16x32_bf16 v[48:51], a[88:91], a[40:43], v[48:51]
s_xor_b32 m0, s77, 65536
ds_read_b64_tr_b16 a[72:73], v19 offset:36864
v_mfma_f32_16x16x32_bf16 v[64:67], a[88:91], a[48:51], v[64:67]
s_xor_b32 s64, s71, 2097152
ds_read_b64_tr_b16 a[74:75], v19 offset:37120
v_mfma_f32_16x16x32_bf16 v[64:67], a[92:95], a[52:55], v[64:67]
s_add_u32 s65, s79, 0
buffer_load_dwordx4 v14, s[56:59], s64 offen lds
v_mfma_f32_16x16x32_bf16 v[80:83], a[92:95], a[60:63], v[80:83]
buffer_store_dwordx4 a[152:155], v16, s[44:47], s65 offen sc1
v_mfma_f32_16x16x32_bf16 v[80:83], a[88:91], a[56:59], v[80:83]
ds_read_b64_tr_b16 a[76:77], v19 offset:38912
v_mfma_f32_16x16x32_bf16 v[144:147], a[96:99], a[56:59], v[144:147]
ds_read_b64_tr_b16 a[78:79], v19 offset:39168
v_mfma_f32_16x16x32_bf16 v[144:147], a[100:103], a[60:63], v[144:147]
ds_read_b64_tr_b16 a[80:81], v20 offset:36864
v_mfma_f32_16x16x32_bf16 v[128:131], a[100:103], a[52:55], v[128:131]
ds_read_b64_tr_b16 a[82:83], v20 offset:37120
v_mfma_f32_16x16x32_bf16 v[128:131], a[96:99], a[48:51], v[128:131]
ds_read_b64_tr_b16 a[84:85], v20 offset:38912
v_mfma_f32_16x16x32_bf16 v[112:115], a[96:99], a[40:43], v[112:115]
s_add_u32 m0, s78, 81920
ds_read_b64_tr_b16 a[86:87], v20 offset:39168
v_mfma_f32_16x16x32_bf16 v[112:115], a[100:103], a[44:47], v[112:115]
s_add_u32 s64, s75, 1572864
ds_read_b64_tr_b16 a[88:89], v19 offset:40960
v_mfma_f32_16x16x32_bf16 v[96:99], a[100:103], a[36:39], v[96:99]
buffer_load_dwordx4 v23, s[60:63], s64 offen lds
v_mfma_f32_16x16x32_bf16 v[96:99], a[96:99], a[32:35], v[96:99]
ds_read_b64_tr_b16 a[90:91], v19 offset:41216
v_mfma_f32_16x16x32_bf16 v[36:39], a[104:107], a[32:35], v[36:39]
ds_read_b64_tr_b16 a[92:93], v19 offset:43008
v_mfma_f32_16x16x32_bf16 v[36:39], a[108:111], a[36:39], v[36:39]
ds_read_b64_tr_b16 a[94:95], v19 offset:43264
v_mfma_f32_16x16x32_bf16 v[52:55], a[108:111], a[44:47], v[52:55]
ds_read_b64_tr_b16 a[96:97], v20 offset:40960
v_mfma_f32_16x16x32_bf16 v[52:55], a[104:107], a[40:43], v[52:55]
ds_read_b64_tr_b16 a[98:99], v20 offset:41216
v_mfma_f32_16x16x32_bf16 v[68:71], a[104:107], a[48:51], v[68:71]
s_xor_b32 m0, s77, 66560
ds_read_b64_tr_b16 a[100:101], v20 offset:43008
v_mfma_f32_16x16x32_bf16 v[68:71], a[108:111], a[52:55], v[68:71]
s_xor_b32 s64, s71, 2129920
s_xor_b32 s68, s66, 4096
ds_read_b64_tr_b16 a[102:103], v20 offset:43264
v_mfma_f32_16x16x32_bf16 v[84:87], a[108:111], a[60:63], v[84:87]
s_mov_b64 exec, 1
buffer_atomic_add a251, v1, s[52:55], s68 offen offset:0 sc1
s_mov_b64 exec, -1
v_mfma_f32_16x16x32_bf16 v[84:87], a[104:107], a[56:59], v[84:87]
buffer_load_dwordx4 v14, s[56:59], s64 offen lds
v_mfma_f32_16x16x32_bf16 v[148:151], a[112:115], a[56:59], v[148:151]
ds_read_b64_tr_b16 a[104:105], v19 offset:32768
v_mfma_f32_16x16x32_bf16 v[148:151], a[116:119], a[60:63], v[148:151]
ds_read_b64_tr_b16 a[106:107], v19 offset:33024
v_mfma_f32_16x16x32_bf16 v[132:135], a[116:119], a[52:55], v[132:135]
ds_read_b64_tr_b16 a[108:109], v19 offset:34816
v_mfma_f32_16x16x32_bf16 v[132:135], a[112:115], a[48:51], v[132:135]
ds_read_b64_tr_b16 a[110:111], v19 offset:35072
v_mfma_f32_16x16x32_bf16 v[116:119], a[112:115], a[40:43], v[116:119]
v_mfma_f32_16x16x32_bf16 v[116:119], a[116:119], a[44:47], v[116:119]
v_mfma_f32_16x16x32_bf16 v[100:103], a[116:119], a[36:39], v[100:103]
s_add_u32 m0, s78, 86016
v_mfma_f32_16x16x32_bf16 v[100:103], a[112:115], a[32:35], v[100:103]
s_waitcnt lgkmcnt(4)
s_add_u32 s64, s75, 1574912
ds_read_b64_tr_b16 a[112:113], v20 offset:32768
v_mfma_f32_16x16x32_bf16 v[184:187], a[72:75], a[0:3], v[184:187]
buffer_load_dwordx4 v23, s[60:63], s64 offen lds
v_mfma_f32_16x16x32_bf16 v[184:187], a[76:79], a[4:7], v[184:187]
ds_read_b64_tr_b16 a[114:115], v20 offset:33024
v_mfma_f32_16x16x32_bf16 v[192:195], a[76:79], a[12:15], v[192:195]
ds_read_b64_tr_b16 a[116:117], v20 offset:34816
v_mfma_f32_16x16x32_bf16 v[192:195], a[72:75], a[8:11], v[192:195]
ds_read_b64_tr_b16 a[118:119], v20 offset:35072
v_mfma_f32_16x16x32_bf16 v[200:203], a[72:75], a[16:19], v[200:203]
v_mfma_f32_16x16x32_bf16 v[200:203], a[76:79], a[20:23], v[200:203]
v_mfma_f32_16x16x32_bf16 v[208:211], a[76:79], a[28:31], v[208:211]
v_mfma_f32_16x16x32_bf16 v[208:211], a[72:75], a[24:27], v[208:211]
ds_read_b64_tr_b16 a[72:73], v4 offset:32768
v_mfma_f32_16x16x32_bf16 v[212:215], a[80:83], a[24:27], v[212:215]
s_xor_b32 m0, s77, 67584
ds_read_b64_tr_b16 a[74:75], v4 offset:33792
v_mfma_f32_16x16x32_bf16 v[212:215], a[84:87], a[28:31], v[212:215]
s_xor_b32 s64, s71, 2162688
ds_read_b64_tr_b16 a[76:77], v4 offset:40960
v_mfma_f32_16x16x32_bf16 v[204:207], a[84:87], a[20:23], v[204:207]
buffer_load_dwordx4 v15, s[56:59], s64 offen lds
v_mfma_f32_16x16x32_bf16 v[204:207], a[80:83], a[16:19], v[204:207]
ds_read_b64_tr_b16 a[78:79], v4 offset:41984
v_mfma_f32_16x16x32_bf16 v[196:199], a[80:83], a[8:11], v[196:199]
v_mfma_f32_16x16x32_bf16 v[196:199], a[84:87], a[12:15], v[196:199]
v_mfma_f32_16x16x32_bf16 v[188:191], a[84:87], a[4:7], v[188:191]
v_mfma_f32_16x16x32_bf16 v[188:191], a[80:83], a[0:3], v[188:191]
ds_read_b64_tr_b16 a[80:81], v5 offset:32768
v_mfma_f32_16x16x32_bf16 v[216:219], a[0:3], a[88:91], v[216:219]
ds_read_b64_tr_b16 a[82:83], v5 offset:33792
v_mfma_f32_16x16x32_bf16 v[216:219], a[4:7], a[92:95], v[216:219]
s_add_u32 m0, s78, 90112
s_add_u32 s65, s79, 17408
ds_read_b64_tr_b16 a[84:85], v5 offset:40960
v_mfma_f32_16x16x32_bf16 v[224:227], a[12:15], a[92:95], v[224:227]
s_add_u32 s64, s75, 1576960
buffer_store_dwordx4 a[156:159], v16, s[44:47], s65 offen sc1
v_mfma_f32_16x16x32_bf16 v[224:227], a[8:11], a[88:91], v[224:227]
buffer_load_dwordx4 v23, s[60:63], s64 offen lds
v_mfma_f32_16x16x32_bf16 v[232:235], a[16:19], a[88:91], v[232:235]
ds_read_b64_tr_b16 a[86:87], v5 offset:41984
v_mfma_f32_16x16x32_bf16 v[232:235], a[20:23], a[92:95], v[232:235]
v_mfma_f32_16x16x32_bf16 v[240:243], a[28:31], a[92:95], v[240:243]
v_mfma_f32_16x16x32_bf16 v[240:243], a[24:27], a[88:91], v[240:243]
ds_read_b64_tr_b16 a[88:89], v6 offset:32768
v_mfma_f32_16x16x32_bf16 v[244:247], a[24:27], a[96:99], v[244:247]
ds_read_b64_tr_b16 a[90:91], v6 offset:33792
v_mfma_f32_16x16x32_bf16 v[244:247], a[28:31], a[100:103], v[244:247]
ds_read_b64_tr_b16 a[92:93], v6 offset:40960
v_add_u32 v19, 0x8000, v19
v_mfma_f32_16x16x32_bf16 v[236:239], a[20:23], a[100:103], v[236:239]
s_xor_b32 m0, s77, 68608
ds_read_b64_tr_b16 a[94:95], v6 offset:41984
v_mfma_f32_16x16x32_bf16 v[236:239], a[16:19], a[96:99], v[236:239]
s_xor_b32 s64, s71, 2195456
v_mfma_f32_16x16x32_bf16 v[228:231], a[8:11], a[96:99], v[228:231]
buffer_load_dwordx4 v15, s[56:59], s64 offen lds
v_mfma_f32_16x16x32_bf16 v[228:231], a[12:15], a[100:103], v[228:231]
v_mfma_f32_16x16x32_bf16 v[220:223], a[4:7], a[100:103], v[220:223]
v_mfma_f32_16x16x32_bf16 v[220:223], a[0:3], a[96:99], v[220:223]
s_waitcnt lgkmcnt(4)
ds_read_b64_tr_b16 a[96:97], v7 offset:32768
v_mfma_f32_16x16x32_bf16 v[152:155], a[104:107], a[0:3], v[152:155]
ds_read_b64_tr_b16 a[98:99], v7 offset:33792
v_mfma_f32_16x16x32_bf16 v[152:155], a[108:111], a[4:7], v[152:155]
ds_read_b64_tr_b16 a[100:101], v7 offset:40960
v_add_u32 v20, 0x8000, v20
v_mfma_f32_16x16x32_bf16 v[160:163], a[108:111], a[12:15], v[160:163]
ds_read_b64_tr_b16 a[102:103], v7 offset:41984
v_mfma_f32_16x16x32_bf16 v[160:163], a[104:107], a[8:11], v[160:163]
v_mfma_f32_16x16x32_bf16 v[168:171], a[104:107], a[16:19], v[168:171]
v_mfma_f32_16x16x32_bf16 v[168:171], a[108:111], a[20:23], v[168:171]
v_mfma_f32_16x16x32_bf16 v[176:179], a[108:111], a[28:31], v[176:179]
s_xor_b32 m0, s84, 0
v_mfma_f32_16x16x32_bf16 v[176:179], a[104:107], a[24:27], v[176:179]
s_xor_b32 s64, s72, 512
ds_read_b64_tr_b16 a[104:105], v8 offset:32768
v_mfma_f32_16x16x32_bf16 v[180:183], a[112:115], a[24:27], v[180:183]
buffer_load_dwordx4 v12, s[48:51], s64 offen lds
v_mfma_f32_16x16x32_bf16 v[180:183], a[116:119], a[28:31], v[180:183]
ds_read_b64_tr_b16 a[106:107], v8 offset:33792
v_add_u32 v4, 0x8000, v4
v_mfma_f32_16x16x32_bf16 v[172:175], a[116:119], a[20:23], v[172:175]
ds_read_b64_tr_b16 a[108:109], v8 offset:40960
v_mfma_f32_16x16x32_bf16 v[172:175], a[112:115], a[16:19], v[172:175]
s_xor_b32 m0, s84, 1024
ds_read_b64_tr_b16 a[110:111], v8 offset:41984
v_mfma_f32_16x16x32_bf16 v[164:167], a[112:115], a[8:11], v[164:167]
s_xor_b32 s64, s72, 16896
v_mfma_f32_16x16x32_bf16 v[164:167], a[116:119], a[12:15], v[164:167]
buffer_load_dwordx4 v13, s[48:51], s64 offen lds
v_mfma_f32_16x16x32_bf16 v[156:159], a[116:119], a[4:7], v[156:159]
v_mfma_f32_16x16x32_bf16 v[156:159], a[112:115], a[0:3], v[156:159]
ds_read_b64_tr_b16 a[112:113], v9 offset:32768
v_mfma_f32_16x16x32_bf16 v[24:27], a[72:75], a[0:3], v[24:27]
s_xor_b32 m0, s84, 2048
ds_read_b64_tr_b16 a[114:115], v9 offset:33792
v_mfma_f32_16x16x32_bf16 v[24:27], a[76:79], a[4:7], v[24:27]
s_xor_b32 s64, s72, 131584
ds_read_b64_tr_b16 a[116:117], v9 offset:40960
v_add_u32 v5, 0x8000, v5
v_mfma_f32_16x16x32_bf16 v[40:43], a[76:79], a[12:15], v[40:43]
buffer_load_dwordx4 v12, s[48:51], s64 offen lds
v_mfma_f32_16x16x32_bf16 v[40:43], a[72:75], a[8:11], v[40:43]
ds_read_b64_tr_b16 a[118:119], v9 offset:41984
v_mfma_f32_16x16x32_bf16 v[56:59], a[72:75], a[16:19], v[56:59]
v_mfma_f32_16x16x32_bf16 v[56:59], a[76:79], a[20:23], v[56:59]
s_xor_b32 m0, s84, 3072
v_mfma_f32_16x16x32_bf16 v[72:75], a[76:79], a[28:31], v[72:75]
s_waitcnt vmcnt(13)
s_xor_b32 s64, s72, 147968
ds_read_b128 a[32:35], v2 offset:32768
v_mfma_f32_16x16x32_bf16 v[72:75], a[72:75], a[24:27], v[72:75]
buffer_load_dwordx4 v13, s[48:51], s64 offen lds
v_mfma_f32_16x16x32_bf16 v[136:139], a[80:83], a[24:27], v[136:139]
ds_read_b128 a[36:39], v3 offset:32768
v_mfma_f32_16x16x32_bf16 v[136:139], a[84:87], a[28:31], v[136:139]
ds_read_b128 a[40:43], v2 offset:34816
v_add_u32 v6, 0x8000, v6
v_mfma_f32_16x16x32_bf16 v[120:123], a[84:87], a[20:23], v[120:123]
s_xor_b32 m0, s84, 4096
ds_read_b128 a[44:47], v3 offset:34816
v_mfma_f32_16x16x32_bf16 v[120:123], a[80:83], a[16:19], v[120:123]
s_xor_b32 s64, s73, 512
ds_read_b128 a[48:51], v2 offset:36864
v_mfma_f32_16x16x32_bf16 v[104:107], a[80:83], a[8:11], v[104:107]
buffer_load_dwordx4 v12, s[48:51], s64 offen lds
v_mfma_f32_16x16x32_bf16 v[104:107], a[84:87], a[12:15], v[104:107]
ds_read_b128 a[52:55], v3 offset:36864
v_mfma_f32_16x16x32_bf16 v[88:91], a[84:87], a[4:7], v[88:91]
s_add_u32 s65, s79, 5120
ds_read_b128 a[56:59], v2 offset:38912
v_mfma_f32_16x16x32_bf16 v[88:91], a[80:83], a[0:3], v[88:91]
s_waitcnt lgkmcnt(7)
s_xor_b32 m0, s84, 5120
buffer_store_dwordx4 a[160:163], v16, s[44:47], s65 offen sc1
v_mfma_f32_16x16x32_bf16 v[28:31], a[88:91], a[0:3], v[28:31]
s_xor_b32 s64, s73, 16896
ds_read_b128 a[60:63], v3 offset:38912
v_mfma_f32_16x16x32_bf16 v[28:31], a[92:95], a[4:7], v[28:31]
buffer_load_dwordx4 v13, s[48:51], s64 offen lds
v_mfma_f32_16x16x32_bf16 v[44:47], a[92:95], a[12:15], v[44:47]
ds_read_b64_tr_b16 a[72:73], v10 offset:32768
v_add_u32 v7, 0x8000, v7
v_mfma_f32_16x16x32_bf16 v[44:47], a[88:91], a[8:11], v[44:47]
ds_read_b64_tr_b16 a[74:75], v10 offset:33792
v_mfma_f32_16x16x32_bf16 v[60:63], a[88:91], a[16:19], v[60:63]
s_xor_b32 m0, s84, 6144
ds_read_b64_tr_b16 a[76:77], v10 offset:40960
v_mfma_f32_16x16x32_bf16 v[60:63], a[92:95], a[20:23], v[60:63]
s_xor_b32 s64, s73, 131584
ds_read_b64_tr_b16 a[78:79], v10 offset:41984
v_mfma_f32_16x16x32_bf16 v[76:79], a[92:95], a[28:31], v[76:79]
buffer_load_dwordx4 v12, s[48:51], s64 offen lds
v_mfma_f32_16x16x32_bf16 v[76:79], a[88:91], a[24:27], v[76:79]
ds_read_b64_tr_b16 a[80:81], v11 offset:32768
v_mfma_f32_16x16x32_bf16 v[140:143], a[96:99], a[24:27], v[140:143]
ds_read_b64_tr_b16 a[82:83], v11 offset:33792
v_mfma_f32_16x16x32_bf16 v[140:143], a[100:103], a[28:31], v[140:143]
s_xor_b32 m0, s84, 7168
ds_read_b64_tr_b16 a[84:85], v11 offset:40960
v_add_u32 v8, 0x8000, v8
v_mfma_f32_16x16x32_bf16 v[124:127], a[100:103], a[20:23], v[124:127]
s_xor_b32 s64, s73, 147968
ds_read_b64_tr_b16 a[86:87], v11 offset:41984
v_mfma_f32_16x16x32_bf16 v[124:127], a[96:99], a[16:19], v[124:127]
buffer_load_dwordx4 v13, s[48:51], s64 offen lds
v_mfma_f32_16x16x32_bf16 v[108:111], a[96:99], a[8:11], v[108:111]
v_mfma_f32_16x16x32_bf16 v[108:111], a[100:103], a[12:15], v[108:111]
v_mfma_f32_16x16x32_bf16 v[92:95], a[100:103], a[4:7], v[92:95]
v_add_u32 v9, 0x8000, v9
v_add_u32 v10, 0x8000, v10
v_mfma_f32_16x16x32_bf16 v[92:95], a[96:99], a[0:3], v[92:95]
v_add_u32 v11, 0x8000, v11
v_mfma_f32_16x16x32_bf16 v[32:35], a[104:107], a[0:3], v[32:35]
v_mfma_f32_16x16x32_bf16 v[32:35], a[108:111], a[4:7], v[32:35]
v_mfma_f32_16x16x32_bf16 v[48:51], a[108:111], a[12:15], v[48:51]
s_waitcnt lgkmcnt(0)
s_barrier
v_mfma_f32_16x16x32_bf16 v[48:51], a[104:107], a[8:11], v[48:51]
s_xor_b32 m0, s77, 98304
ds_read_b64_tr_b16 a[88:89], v19 offset:36864
v_mfma_f32_16x16x32_bf16 v[64:67], a[104:107], a[16:19], v[64:67]
s_xor_b32 s64, s71, 2621440
ds_read_b64_tr_b16 a[90:91], v19 offset:37120
v_mfma_f32_16x16x32_bf16 v[64:67], a[108:111], a[20:23], v[64:67]
buffer_load_dwordx4 v14, s[56:59], s64 offen lds
v_mfma_f32_16x16x32_bf16 v[80:83], a[108:111], a[28:31], v[80:83]
ds_read_b64_tr_b16 a[92:93], v19 offset:38912
v_mfma_f32_16x16x32_bf16 v[80:83], a[104:107], a[24:27], v[80:83]
ds_read_b64_tr_b16 a[94:95], v19 offset:39168
v_mfma_f32_16x16x32_bf16 v[144:147], a[112:115], a[24:27], v[144:147]
ds_read_b64_tr_b16 a[96:97], v20 offset:36864
v_mfma_f32_16x16x32_bf16 v[144:147], a[116:119], a[28:31], v[144:147]
ds_read_b64_tr_b16 a[98:99], v20 offset:37120
v_mfma_f32_16x16x32_bf16 v[128:131], a[116:119], a[20:23], v[128:131]
ds_read_b64_tr_b16 a[100:101], v20 offset:38912
v_mfma_f32_16x16x32_bf16 v[128:131], a[112:115], a[16:19], v[128:131]
ds_read_b64_tr_b16 a[102:103], v20 offset:39168
v_mfma_f32_16x16x32_bf16 v[112:115], a[112:115], a[8:11], v[112:115]
s_add_u32 m0, s78, 114688
ds_read_b64_tr_b16 a[104:105], v19 offset:40960
v_mfma_f32_16x16x32_bf16 v[112:115], a[116:119], a[12:15], v[112:115]
s_add_u32 s64, s75, 1966080
ds_read_b64_tr_b16 a[106:107], v19 offset:41216
v_mfma_f32_16x16x32_bf16 v[96:99], a[116:119], a[4:7], v[96:99]
buffer_load_dwordx4 v23, s[60:63], s64 offen lds
v_mfma_f32_16x16x32_bf16 v[96:99], a[112:115], a[0:3], v[96:99]
ds_read_b64_tr_b16 a[108:109], v19 offset:43008
v_mfma_f32_16x16x32_bf16 v[36:39], a[72:75], a[0:3], v[36:39]
ds_read_b64_tr_b16 a[110:111], v19 offset:43264
v_mfma_f32_16x16x32_bf16 v[36:39], a[76:79], a[4:7], v[36:39]
ds_read_b64_tr_b16 a[112:113], v20 offset:40960
v_mfma_f32_16x16x32_bf16 v[52:55], a[76:79], a[12:15], v[52:55]
ds_read_b64_tr_b16 a[114:115], v20 offset:41216
v_mfma_f32_16x16x32_bf16 v[52:55], a[72:75], a[8:11], v[52:55]
ds_read_b64_tr_b16 a[116:117], v20 offset:43008
v_mfma_f32_16x16x32_bf16 v[68:71], a[72:75], a[16:19], v[68:71]
s_xor_b32 m0, s77, 99328
ds_read_b64_tr_b16 a[118:119], v20 offset:43264
v_mfma_f32_16x16x32_bf16 v[68:71], a[76:79], a[20:23], v[68:71]
s_xor_b32 s64, s71, 2654208
s_xor_b32 s68, s66, 8192
v_mfma_f32_16x16x32_bf16 v[84:87], a[76:79], a[28:31], v[84:87]
s_mov_b64 exec, 1
buffer_atomic_add a251, v1, s[52:55], s68 offen offset:0 sc1
s_mov_b64 exec, -1
v_mfma_f32_16x16x32_bf16 v[84:87], a[72:75], a[24:27], v[84:87]
buffer_load_dwordx4 v14, s[56:59], s64 offen lds
v_mfma_f32_16x16x32_bf16 v[148:151], a[80:83], a[24:27], v[148:151]
ds_read_b64_tr_b16 a[72:73], v19 offset:32768
v_mfma_f32_16x16x32_bf16 v[148:151], a[84:87], a[28:31], v[148:151]
ds_read_b64_tr_b16 a[74:75], v19 offset:33024
v_mfma_f32_16x16x32_bf16 v[132:135], a[84:87], a[20:23], v[132:135]
s_add_u32 s65, s79, 1024
ds_read_b64_tr_b16 a[76:77], v19 offset:34816
v_mfma_f32_16x16x32_bf16 v[132:135], a[80:83], a[16:19], v[132:135]
buffer_store_dwordx4 a[164:167], v16, s[44:47], s65 offen sc1
v_mfma_f32_16x16x32_bf16 v[116:119], a[80:83], a[8:11], v[116:119]
ds_read_b64_tr_b16 a[78:79], v19 offset:35072
v_mfma_f32_16x16x32_bf16 v[116:119], a[84:87], a[12:15], v[116:119]
v_mfma_f32_16x16x32_bf16 v[100:103], a[84:87], a[4:7], v[100:103]
s_add_u32 m0, s78, 118784
v_mfma_f32_16x16x32_bf16 v[100:103], a[80:83], a[0:3], v[100:103]
s_waitcnt lgkmcnt(4)
s_add_u32 s64, s75, 1968128
ds_read_b64_tr_b16 a[80:81], v20 offset:32768
v_mfma_f32_16x16x32_bf16 v[184:187], a[88:91], a[32:35], v[184:187]
buffer_load_dwordx4 v23, s[60:63], s64 offen lds
v_mfma_f32_16x16x32_bf16 v[184:187], a[92:95], a[36:39], v[184:187]
ds_read_b64_tr_b16 a[82:83], v20 offset:33024
v_mfma_f32_16x16x32_bf16 v[192:195], a[92:95], a[44:47], v[192:195]
ds_read_b64_tr_b16 a[84:85], v20 offset:34816
v_mfma_f32_16x16x32_bf16 v[192:195], a[88:91], a[40:43], v[192:195]
ds_read_b64_tr_b16 a[86:87], v20 offset:35072
v_mfma_f32_16x16x32_bf16 v[200:203], a[88:91], a[48:51], v[200:203]
v_mfma_f32_16x16x32_bf16 v[200:203], a[92:95], a[52:55], v[200:203]
v_mfma_f32_16x16x32_bf16 v[208:211], a[92:95], a[60:63], v[208:211]
v_mfma_f32_16x16x32_bf16 v[208:211], a[88:91], a[56:59], v[208:211]
ds_read_b64_tr_b16 a[88:89], v4 offset:32768
v_mfma_f32_16x16x32_bf16 v[212:215], a[96:99], a[56:59], v[212:215]
s_xor_b32 m0, s77, 100352
ds_read_b64_tr_b16 a[90:91], v4 offset:33792
v_mfma_f32_16x16x32_bf16 v[212:215], a[100:103], a[60:63], v[212:215]
s_xor_b32 s64, s71, 2686976
ds_read_b64_tr_b16 a[92:93], v4 offset:40960
v_mfma_f32_16x16x32_bf16 v[204:207], a[100:103], a[52:55], v[204:207]
buffer_load_dwordx4 v15, s[56:59], s64 offen lds
v_mfma_f32_16x16x32_bf16 v[204:207], a[96:99], a[48:51], v[204:207]
ds_read_b64_tr_b16 a[94:95], v4 offset:41984
v_mfma_f32_16x16x32_bf16 v[196:199], a[96:99], a[40:43], v[196:199]
v_mfma_f32_16x16x32_bf16 v[196:199], a[100:103], a[44:47], v[196:199]
v_mfma_f32_16x16x32_bf16 v[188:191], a[100:103], a[36:39], v[188:191]
v_mfma_f32_16x16x32_bf16 v[188:191], a[96:99], a[32:35], v[188:191]
ds_read_b64_tr_b16 a[96:97], v5 offset:32768
v_mfma_f32_16x16x32_bf16 v[216:219], a[32:35], a[104:107], v[216:219]
ds_read_b64_tr_b16 a[98:99], v5 offset:33792
v_mfma_f32_16x16x32_bf16 v[216:219], a[36:39], a[108:111], v[216:219]
s_add_u32 m0, s78, 122880
ds_read_b64_tr_b16 a[100:101], v5 offset:40960
v_mfma_f32_16x16x32_bf16 v[224:227], a[44:47], a[108:111], v[224:227]
s_add_u32 s64, s75, 1970176
ds_read_b64_tr_b16 a[102:103], v5 offset:41984
v_mfma_f32_16x16x32_bf16 v[224:227], a[40:43], a[104:107], v[224:227]
buffer_load_dwordx4 v23, s[60:63], s64 offen lds
v_mfma_f32_16x16x32_bf16 v[232:235], a[48:51], a[104:107], v[232:235]
v_mfma_f32_16x16x32_bf16 v[232:235], a[52:55], a[108:111], v[232:235]
v_mfma_f32_16x16x32_bf16 v[240:243], a[60:63], a[108:111], v[240:243]
v_mfma_f32_16x16x32_bf16 v[240:243], a[56:59], a[104:107], v[240:243]
ds_read_b64_tr_b16 a[104:105], v6 offset:32768
v_mfma_f32_16x16x32_bf16 v[244:247], a[56:59], a[112:115], v[244:247]
ds_read_b64_tr_b16 a[106:107], v6 offset:33792
v_mfma_f32_16x16x32_bf16 v[244:247], a[60:63], a[116:119], v[244:247]
ds_read_b64_tr_b16 a[108:109], v6 offset:40960
v_subrev_u32 v19, 0x8000, v19
v_mfma_f32_16x16x32_bf16 v[236:239], a[52:55], a[116:119], v[236:239]
s_xor_b32 m0, s77, 101376
ds_read_b64_tr_b16 a[110:111], v6 offset:41984
v_mfma_f32_16x16x32_bf16 v[236:239], a[48:51], a[112:115], v[236:239]
s_xor_b32 s64, s71, 2719744
v_mfma_f32_16x16x32_bf16 v[228:231], a[40:43], a[112:115], v[228:231]
buffer_load_dwordx4 v15, s[56:59], s64 offen lds
v_mfma_f32_16x16x32_bf16 v[228:231], a[44:47], a[116:119], v[228:231]
v_mfma_f32_16x16x32_bf16 v[220:223], a[36:39], a[116:119], v[220:223]
v_mfma_f32_16x16x32_bf16 v[220:223], a[32:35], a[112:115], v[220:223]
s_waitcnt lgkmcnt(4)
ds_read_b64_tr_b16 a[112:113], v7 offset:32768
v_mfma_f32_16x16x32_bf16 v[152:155], a[72:75], a[32:35], v[152:155]
ds_read_b64_tr_b16 a[114:115], v7 offset:33792
v_mfma_f32_16x16x32_bf16 v[152:155], a[76:79], a[36:39], v[152:155]
ds_read_b64_tr_b16 a[116:117], v7 offset:40960
v_subrev_u32 v20, 0x8000, v20
v_mfma_f32_16x16x32_bf16 v[160:163], a[76:79], a[44:47], v[160:163]
ds_read_b64_tr_b16 a[118:119], v7 offset:41984
v_mfma_f32_16x16x32_bf16 v[160:163], a[72:75], a[40:43], v[160:163]
v_mfma_f32_16x16x32_bf16 v[168:171], a[72:75], a[48:51], v[168:171]
v_mfma_f32_16x16x32_bf16 v[168:171], a[76:79], a[52:55], v[168:171]
v_mfma_f32_16x16x32_bf16 v[176:179], a[76:79], a[60:63], v[176:179]
s_xor_b32 m0, s84, 32768
v_mfma_f32_16x16x32_bf16 v[176:179], a[72:75], a[56:59], v[176:179]
s_xor_b32 s64, s72, 640
ds_read_b64_tr_b16 a[72:73], v8 offset:32768
v_mfma_f32_16x16x32_bf16 v[180:183], a[80:83], a[56:59], v[180:183]
s_add_u32 s65, s79, 18432
buffer_load_dwordx4 v12, s[48:51], s64 offen lds
v_mfma_f32_16x16x32_bf16 v[180:183], a[84:87], a[60:63], v[180:183]
buffer_store_dwordx4 a[168:171], v16, s[44:47], s65 offen sc1
v_mfma_f32_16x16x32_bf16 v[172:175], a[84:87], a[52:55], v[172:175]
ds_read_b64_tr_b16 a[74:75], v8 offset:33792
v_subrev_u32 v4, 0x8000, v4
v_mfma_f32_16x16x32_bf16 v[172:175], a[80:83], a[48:51], v[172:175]
s_xor_b32 m0, s84, 33792
ds_read_b64_tr_b16 a[76:77], v8 offset:40960
v_mfma_f32_16x16x32_bf16 v[164:167], a[80:83], a[40:43], v[164:167]
s_xor_b32 s64, s72, 17024
ds_read_b64_tr_b16 a[78:79], v8 offset:41984
v_mfma_f32_16x16x32_bf16 v[164:167], a[84:87], a[44:47], v[164:167]
buffer_load_dwordx4 v13, s[48:51], s64 offen lds
v_mfma_f32_16x16x32_bf16 v[156:159], a[84:87], a[36:39], v[156:159]
v_mfma_f32_16x16x32_bf16 v[156:159], a[80:83], a[32:35], v[156:159]
ds_read_b64_tr_b16 a[80:81], v9 offset:32768
v_mfma_f32_16x16x32_bf16 v[24:27], a[88:91], a[32:35], v[24:27]
s_xor_b32 m0, s84, 34816
ds_read_b64_tr_b16 a[82:83], v9 offset:33792
v_mfma_f32_16x16x32_bf16 v[24:27], a[92:95], a[36:39], v[24:27]
s_xor_b32 s64, s72, 131712
ds_read_b64_tr_b16 a[84:85], v9 offset:40960
v_subrev_u32 v5, 0x8000, v5
v_mfma_f32_16x16x32_bf16 v[40:43], a[92:95], a[44:47], v[40:43]
buffer_load_dwordx4 v12, s[48:51], s64 offen lds
v_mfma_f32_16x16x32_bf16 v[40:43], a[88:91], a[40:43], v[40:43]
ds_read_b64_tr_b16 a[86:87], v9 offset:41984
v_mfma_f32_16x16x32_bf16 v[56:59], a[88:91], a[48:51], v[56:59]
v_mfma_f32_16x16x32_bf16 v[56:59], a[92:95], a[52:55], v[56:59]
s_xor_b32 m0, s84, 35840
v_mfma_f32_16x16x32_bf16 v[72:75], a[92:95], a[60:63], v[72:75]
s_waitcnt vmcnt(13)
s_xor_b32 s64, s72, 148096
ds_read_b128 a[0:3], v2 offset:0
v_mfma_f32_16x16x32_bf16 v[72:75], a[88:91], a[56:59], v[72:75]
buffer_load_dwordx4 v13, s[48:51], s64 offen lds
v_mfma_f32_16x16x32_bf16 v[136:139], a[96:99], a[56:59], v[136:139]
ds_read_b128 a[4:7], v3 offset:0
v_mfma_f32_16x16x32_bf16 v[136:139], a[100:103], a[60:63], v[136:139]
ds_read_b128 a[8:11], v2 offset:2048
v_subrev_u32 v6, 0x8000, v6
v_mfma_f32_16x16x32_bf16 v[120:123], a[100:103], a[52:55], v[120:123]
s_xor_b32 m0, s84, 36864
ds_read_b128 a[12:15], v3 offset:2048
v_mfma_f32_16x16x32_bf16 v[120:123], a[96:99], a[48:51], v[120:123]
s_xor_b32 s64, s73, 640
ds_read_b128 a[16:19], v2 offset:4096
v_mfma_f32_16x16x32_bf16 v[104:107], a[96:99], a[40:43], v[104:107]
buffer_load_dwordx4 v12, s[48:51], s64 offen lds
v_mfma_f32_16x16x32_bf16 v[104:107], a[100:103], a[44:47], v[104:107]
ds_read_b128 a[20:23], v3 offset:4096
v_mfma_f32_16x16x32_bf16 v[88:91], a[100:103], a[36:39], v[88:91]
ds_read_b128 a[24:27], v2 offset:6144
v_mfma_f32_16x16x32_bf16 v[88:91], a[96:99], a[32:35], v[88:91]
s_waitcnt lgkmcnt(7)
s_xor_b32 m0, s84, 37888
ds_read_b128 a[28:31], v3 offset:6144
v_mfma_f32_16x16x32_bf16 v[28:31], a[104:107], a[32:35], v[28:31]
s_xor_b32 s64, s73, 17024
ds_read_b64_tr_b16 a[88:89], v10 offset:32768
v_mfma_f32_16x16x32_bf16 v[28:31], a[108:111], a[36:39], v[28:31]
buffer_load_dwordx4 v13, s[48:51], s64 offen lds
v_mfma_f32_16x16x32_bf16 v[44:47], a[108:111], a[44:47], v[44:47]
ds_read_b64_tr_b16 a[90:91], v10 offset:33792
v_subrev_u32 v7, 0x8000, v7
v_mfma_f32_16x16x32_bf16 v[44:47], a[104:107], a[40:43], v[44:47]
ds_read_b64_tr_b16 a[92:93], v10 offset:40960
v_mfma_f32_16x16x32_bf16 v[60:63], a[104:107], a[48:51], v[60:63]
s_xor_b32 m0, s84, 38912
ds_read_b64_tr_b16 a[94:95], v10 offset:41984
v_mfma_f32_16x16x32_bf16 v[60:63], a[108:111], a[52:55], v[60:63]
s_xor_b32 s64, s73, 131712
ds_read_b64_tr_b16 a[96:97], v11 offset:32768
v_mfma_f32_16x16x32_bf16 v[76:79], a[108:111], a[60:63], v[76:79]
buffer_load_dwordx4 v12, s[48:51], s64 offen lds
v_mfma_f32_16x16x32_bf16 v[76:79], a[104:107], a[56:59], v[76:79]
ds_read_b64_tr_b16 a[98:99], v11 offset:33792
v_mfma_f32_16x16x32_bf16 v[140:143], a[112:115], a[56:59], v[140:143]
ds_read_b64_tr_b16 a[100:101], v11 offset:40960
v_mfma_f32_16x16x32_bf16 v[140:143], a[116:119], a[60:63], v[140:143]
s_xor_b32 m0, s84, 39936
ds_read_b64_tr_b16 a[102:103], v11 offset:41984
v_subrev_u32 v8, 0x8000, v8
v_mfma_f32_16x16x32_bf16 v[124:127], a[116:119], a[52:55], v[124:127]
s_xor_b32 s64, s73, 148096
v_mfma_f32_16x16x32_bf16 v[124:127], a[112:115], a[48:51], v[124:127]
buffer_load_dwordx4 v13, s[48:51], s64 offen lds
v_mfma_f32_16x16x32_bf16 v[108:111], a[112:115], a[40:43], v[108:111]
v_mfma_f32_16x16x32_bf16 v[108:111], a[116:119], a[44:47], v[108:111]
v_mfma_f32_16x16x32_bf16 v[92:95], a[116:119], a[36:39], v[92:95]
v_subrev_u32 v9, 0x8000, v9
v_subrev_u32 v10, 0x8000, v10
v_mfma_f32_16x16x32_bf16 v[92:95], a[112:115], a[32:35], v[92:95]
v_subrev_u32 v11, 0x8000, v11
v_mfma_f32_16x16x32_bf16 v[32:35], a[72:75], a[32:35], v[32:35]
v_mfma_f32_16x16x32_bf16 v[32:35], a[76:79], a[36:39], v[32:35]
v_mfma_f32_16x16x32_bf16 v[48:51], a[76:79], a[44:47], v[48:51]
s_waitcnt lgkmcnt(0)
s_barrier
v_mfma_f32_16x16x32_bf16 v[48:51], a[72:75], a[40:43], v[48:51]
s_xor_b32 m0, s77, 131072
ds_read_b64_tr_b16 a[104:105], v19 offset:4096
v_mfma_f32_16x16x32_bf16 v[64:67], a[72:75], a[48:51], v[64:67]
s_xor_b32 s64, s71, 3145728
ds_read_b64_tr_b16 a[106:107], v19 offset:4352
v_mfma_f32_16x16x32_bf16 v[64:67], a[76:79], a[52:55], v[64:67]
s_add_u32 s65, s79, 6144
buffer_load_dwordx4 v14, s[56:59], s64 offen lds
v_mfma_f32_16x16x32_bf16 v[80:83], a[76:79], a[60:63], v[80:83]
buffer_store_dwordx4 a[172:175], v16, s[44:47], s65 offen sc1
v_mfma_f32_16x16x32_bf16 v[80:83], a[72:75], a[56:59], v[80:83]
ds_read_b64_tr_b16 a[108:109], v19 offset:6144
v_mfma_f32_16x16x32_bf16 v[144:147], a[80:83], a[56:59], v[144:147]
ds_read_b64_tr_b16 a[110:111], v19 offset:6400
v_mfma_f32_16x16x32_bf16 v[144:147], a[84:87], a[60:63], v[144:147]
ds_read_b64_tr_b16 a[112:113], v20 offset:4096
v_mfma_f32_16x16x32_bf16 v[128:131], a[84:87], a[52:55], v[128:131]
ds_read_b64_tr_b16 a[114:115], v20 offset:4352
v_mfma_f32_16x16x32_bf16 v[128:131], a[80:83], a[48:51], v[128:131]
ds_read_b64_tr_b16 a[116:117], v20 offset:6144
v_mfma_f32_16x16x32_bf16 v[112:115], a[80:83], a[40:43], v[112:115]
s_add_u32 m0, s78, 147456
ds_read_b64_tr_b16 a[118:119], v20 offset:6400
v_mfma_f32_16x16x32_bf16 v[112:115], a[84:87], a[44:47], v[112:115]
s_add_u32 s64, s75, 2359296
ds_read_b64_tr_b16 a[72:73], v19 offset:8192
v_mfma_f32_16x16x32_bf16 v[96:99], a[84:87], a[36:39], v[96:99]
s_branch L_po8
L_pg8:
s_branch L_pg12
L_po8:
buffer_load_dwordx4 v23, s[60:63], s64 offen lds
v_mfma_f32_16x16x32_bf16 v[96:99], a[80:83], a[32:35], v[96:99]
ds_read_b64_tr_b16 a[74:75], v19 offset:8448
v_mfma_f32_16x16x32_bf16 v[36:39], a[88:91], a[32:35], v[36:39]
ds_read_b64_tr_b16 a[76:77], v19 offset:10240
v_mfma_f32_16x16x32_bf16 v[36:39], a[92:95], a[36:39], v[36:39]
ds_read_b64_tr_b16 a[78:79], v19 offset:10496
v_mfma_f32_16x16x32_bf16 v[52:55], a[92:95], a[44:47], v[52:55]
ds_read_b64_tr_b16 a[80:81], v20 offset:8192
v_mfma_f32_16x16x32_bf16 v[52:55], a[88:91], a[40:43], v[52:55]
ds_read_b64_tr_b16 a[82:83], v20 offset:8448
v_mfma_f32_16x16x32_bf16 v[68:71], a[88:91], a[48:51], v[68:71]
s_xor_b32 m0, s77, 132096
ds_read_b64_tr_b16 a[84:85], v20 offset:10240
v_mfma_f32_16x16x32_bf16 v[68:71], a[92:95], a[52:55], v[68:71]
s_xor_b32 s64, s71, 3178496
s_xor_b32 s68, s66, 12288
ds_read_b64_tr_b16 a[86:87], v20 offset:10496
v_mfma_f32_16x16x32_bf16 v[84:87], a[92:95], a[60:63], v[84:87]
s_mov_b64 exec, 1
buffer_atomic_add a251, v1, s[52:55], s68 offen offset:0 sc1
s_mov_b64 exec, -1
v_mfma_f32_16x16x32_bf16 v[84:87], a[88:91], a[56:59], v[84:87]
buffer_load_dwordx4 v14, s[56:59], s64 offen lds
v_mfma_f32_16x16x32_bf16 v[148:151], a[96:99], a[56:59], v[148:151]
ds_read_b64_tr_b16 a[88:89], v19 offset:0
v_mfma_f32_16x16x32_bf16 v[148:151], a[100:103], a[60:63], v[148:151]
ds_read_b64_tr_b16 a[90:91], v19 offset:256
v_mfma_f32_16x16x32_bf16 v[132:135], a[100:103], a[52:55], v[132:135]
ds_read_b64_tr_b16 a[92:93], v19 offset:2048
v_mfma_f32_16x16x32_bf16 v[132:135], a[96:99], a[48:51], v[132:135]
ds_read_b64_tr_b16 a[94:95], v19 offset:2304
v_mfma_f32_16x16x32_bf16 v[116:119], a[96:99], a[40:43], v[116:119]
v_mfma_f32_16x16x32_bf16 v[116:119], a[100:103], a[44:47], v[116:119]
v_mfma_f32_16x16x32_bf16 v[100:103], a[100:103], a[36:39], v[100:103]
s_add_u32 m0, s78, 151552
v_mfma_f32_16x16x32_bf16 v[100:103], a[96:99], a[32:35], v[100:103]
s_waitcnt lgkmcnt(4)
s_add_u32 s64, s75, 2361344
ds_read_b64_tr_b16 a[96:97], v20 offset:0
v_mfma_f32_16x16x32_bf16 v[184:187], a[104:107], a[0:3], v[184:187]
s_mov_b32 s36, s20
buffer_load_dwordx4 v23, s[60:63], s64 offen lds
v_mfma_f32_16x16x32_bf16 v[184:187], a[108:111], a[4:7], v[184:187]
s_mov_b32 s37, s21
ds_read_b64_tr_b16 a[98:99], v20 offset:256
v_mfma_f32_16x16x32_bf16 v[192:195], a[108:111], a[12:15], v[192:195]
s_mov_b32 s38, 2097152
ds_read_b64_tr_b16 a[100:101], v20 offset:2048
v_mfma_f32_16x16x32_bf16 v[192:195], a[104:107], a[8:11], v[192:195]
s_mov_b32 s40, s14
ds_read_b64_tr_b16 a[102:103], v20 offset:2304
v_mfma_f32_16x16x32_bf16 v[200:203], a[104:107], a[16:19], v[200:203]
s_mov_b32 s41, s15
v_mfma_f32_16x16x32_bf16 v[200:203], a[108:111], a[20:23], v[200:203]
s_mov_b32 s42, 8388608
v_mfma_f32_16x16x32_bf16 v[208:211], a[108:111], a[28:31], v[208:211]
v_mfma_f32_16x16x32_bf16 v[208:211], a[104:107], a[24:27], v[208:211]
ds_read_b64_tr_b16 a[104:105], v4 offset:0
v_mfma_f32_16x16x32_bf16 v[212:215], a[112:115], a[24:27], v[212:215]
s_xor_b32 m0, s77, 133120
ds_read_b64_tr_b16 a[106:107], v4 offset:1024
v_mfma_f32_16x16x32_bf16 v[212:215], a[116:119], a[28:31], v[212:215]
s_xor_b32 s64, s71, 3211264
ds_read_b64_tr_b16 a[108:109], v4 offset:8192
v_mfma_f32_16x16x32_bf16 v[204:207], a[116:119], a[20:23], v[204:207]
buffer_load_dwordx4 v15, s[56:59], s64 offen lds
v_mfma_f32_16x16x32_bf16 v[204:207], a[112:115], a[16:19], v[204:207]
ds_read_b64_tr_b16 a[110:111], v4 offset:9216
v_mfma_f32_16x16x32_bf16 v[196:199], a[112:115], a[8:11], v[196:199]
v_mfma_f32_16x16x32_bf16 v[196:199], a[116:119], a[12:15], v[196:199]
v_mfma_f32_16x16x32_bf16 v[188:191], a[116:119], a[4:7], v[188:191]
v_mfma_f32_16x16x32_bf16 v[188:191], a[112:115], a[0:3], v[188:191]
ds_read_b64_tr_b16 a[112:113], v5 offset:0
v_mfma_f32_16x16x32_bf16 v[216:219], a[0:3], a[72:75], v[216:219]
ds_read_b64_tr_b16 a[114:115], v5 offset:1024
v_mfma_f32_16x16x32_bf16 v[216:219], a[4:7], a[76:79], v[216:219]
s_add_u32 m0, s78, 155648
s_add_u32 s65, s79, 2048
ds_read_b64_tr_b16 a[116:117], v5 offset:8192
v_mfma_f32_16x16x32_bf16 v[224:227], a[12:15], a[76:79], v[224:227]
s_add_u32 s64, s75, 2363392
buffer_store_dwordx4 a[176:179], v16, s[44:47], s65 offen sc1
v_mfma_f32_16x16x32_bf16 v[224:227], a[8:11], a[72:75], v[224:227]
buffer_load_dwordx4 v23, s[60:63], s64 offen lds
v_mfma_f32_16x16x32_bf16 v[232:235], a[16:19], a[72:75], v[232:235]
ds_read_b64_tr_b16 a[118:119], v5 offset:9216
v_mfma_f32_16x16x32_bf16 v[232:235], a[20:23], a[76:79], v[232:235]
v_mfma_f32_16x16x32_bf16 v[240:243], a[28:31], a[76:79], v[240:243]
v_mfma_f32_16x16x32_bf16 v[240:243], a[24:27], a[72:75], v[240:243]
ds_read_b64_tr_b16 a[72:73], v6 offset:0
v_mfma_f32_16x16x32_bf16 v[244:247], a[24:27], a[80:83], v[244:247]
ds_read_b64_tr_b16 a[74:75], v6 offset:1024
v_mfma_f32_16x16x32_bf16 v[244:247], a[28:31], a[84:87], v[244:247]
ds_read_b64_tr_b16 a[76:77], v6 offset:8192
v_mfma_f32_16x16x32_bf16 v[236:239], a[20:23], a[84:87], v[236:239]
s_xor_b32 m0, s77, 134144
ds_read_b64_tr_b16 a[78:79], v6 offset:9216
v_mfma_f32_16x16x32_bf16 v[236:239], a[16:19], a[80:83], v[236:239]
s_xor_b32 s64, s71, 3244032
v_mfma_f32_16x16x32_bf16 v[228:231], a[8:11], a[80:83], v[228:231]
buffer_load_dwordx4 v15, s[56:59], s64 offen lds
v_mfma_f32_16x16x32_bf16 v[228:231], a[12:15], a[84:87], v[228:231]
v_mfma_f32_16x16x32_bf16 v[220:223], a[4:7], a[84:87], v[220:223]
v_mfma_f32_16x16x32_bf16 v[220:223], a[0:3], a[80:83], v[220:223]
s_waitcnt lgkmcnt(4)
ds_read_b64_tr_b16 a[80:81], v7 offset:0
v_mfma_f32_16x16x32_bf16 v[152:155], a[88:91], a[0:3], v[152:155]
ds_read_b64_tr_b16 a[82:83], v7 offset:1024
v_mfma_f32_16x16x32_bf16 v[152:155], a[92:95], a[4:7], v[152:155]
ds_read_b64_tr_b16 a[84:85], v7 offset:8192
v_mfma_f32_16x16x32_bf16 v[160:163], a[92:95], a[12:15], v[160:163]
ds_read_b64_tr_b16 a[86:87], v7 offset:9216
v_mfma_f32_16x16x32_bf16 v[160:163], a[88:91], a[8:11], v[160:163]
v_mfma_f32_16x16x32_bf16 v[168:171], a[88:91], a[16:19], v[168:171]
v_mfma_f32_16x16x32_bf16 v[168:171], a[92:95], a[20:23], v[168:171]
v_mfma_f32_16x16x32_bf16 v[176:179], a[92:95], a[28:31], v[176:179]
s_xor_b32 m0, s84, 0
v_mfma_f32_16x16x32_bf16 v[176:179], a[88:91], a[24:27], v[176:179]
s_xor_b32 s64, s72, 768
ds_read_b64_tr_b16 a[88:89], v8 offset:0
v_mfma_f32_16x16x32_bf16 v[180:183], a[96:99], a[24:27], v[180:183]
buffer_load_dwordx4 v12, s[48:51], s64 offen lds
v_mfma_f32_16x16x32_bf16 v[180:183], a[100:103], a[28:31], v[180:183]
ds_read_b64_tr_b16 a[90:91], v8 offset:1024
v_mfma_f32_16x16x32_bf16 v[172:175], a[100:103], a[20:23], v[172:175]
ds_read_b64_tr_b16 a[92:93], v8 offset:8192
v_mfma_f32_16x16x32_bf16 v[172:175], a[96:99], a[16:19], v[172:175]
s_xor_b32 m0, s84, 1024
ds_read_b64_tr_b16 a[94:95], v8 offset:9216
v_mfma_f32_16x16x32_bf16 v[164:167], a[96:99], a[8:11], v[164:167]
s_xor_b32 s64, s72, 17152
v_mfma_f32_16x16x32_bf16 v[164:167], a[100:103], a[12:15], v[164:167]
buffer_load_dwordx4 v13, s[48:51], s64 offen lds
v_mfma_f32_16x16x32_bf16 v[156:159], a[100:103], a[4:7], v[156:159]
v_mfma_f32_16x16x32_bf16 v[156:159], a[96:99], a[0:3], v[156:159]
ds_read_b64_tr_b16 a[96:97], v9 offset:0
v_mfma_f32_16x16x32_bf16 v[24:27], a[104:107], a[0:3], v[24:27]
s_xor_b32 m0, s84, 2048
ds_read_b64_tr_b16 a[98:99], v9 offset:1024
v_mfma_f32_16x16x32_bf16 v[24:27], a[108:111], a[4:7], v[24:27]
s_xor_b32 s64, s72, 131840
ds_read_b64_tr_b16 a[100:101], v9 offset:8192
v_mfma_f32_16x16x32_bf16 v[40:43], a[108:111], a[12:15], v[40:43]
buffer_load_dwordx4 v12, s[48:51], s64 offen lds
v_mfma_f32_16x16x32_bf16 v[40:43], a[104:107], a[8:11], v[40:43]
ds_read_b64_tr_b16 a[102:103], v9 offset:9216
v_mfma_f32_16x16x32_bf16 v[56:59], a[104:107], a[16:19], v[56:59]
v_mfma_f32_16x16x32_bf16 v[56:59], a[108:111], a[20:23], v[56:59]
s_xor_b32 m0, s84, 3072
v_mfma_f32_16x16x32_bf16 v[72:75], a[108:111], a[28:31], v[72:75]
s_waitcnt vmcnt(13)
s_xor_b32 s64, s72, 148224
ds_read_b128 a[32:35], v2 offset:32768
v_mfma_f32_16x16x32_bf16 v[72:75], a[104:107], a[24:27], v[72:75]
buffer_load_dwordx4 v13, s[48:51], s64 offen lds
v_mfma_f32_16x16x32_bf16 v[136:139], a[112:115], a[24:27], v[136:139]
ds_read_b128 a[36:39], v3 offset:32768
v_mfma_f32_16x16x32_bf16 v[136:139], a[116:119], a[28:31], v[136:139]
ds_read_b128 a[40:43], v2 offset:34816
v_mfma_f32_16x16x32_bf16 v[120:123], a[116:119], a[20:23], v[120:123]
s_xor_b32 m0, s84, 4096
ds_read_b128 a[44:47], v3 offset:34816
v_mfma_f32_16x16x32_bf16 v[120:123], a[112:115], a[16:19], v[120:123]
s_xor_b32 s64, s73, 768
ds_read_b128 a[48:51], v2 offset:36864
v_mfma_f32_16x16x32_bf16 v[104:107], a[112:115], a[8:11], v[104:107]
buffer_load_dwordx4 v12, s[48:51], s64 offen lds
v_mfma_f32_16x16x32_bf16 v[104:107], a[116:119], a[12:15], v[104:107]
s_add_u32 s65, s79, 19456
ds_read_b128 a[52:55], v3 offset:36864
v_mfma_f32_16x16x32_bf16 v[88:91], a[116:119], a[4:7], v[88:91]
buffer_store_dwordx4 a[180:183], v16, s[44:47], s65 offen sc1
v_mfma_f32_16x16x32_bf16 v[88:91], a[112:115], a[0:3], v[88:91]
s_waitcnt lgkmcnt(6)
s_xor_b32 m0, s84, 5120
ds_read_b128 a[56:59], v2 offset:38912
v_mfma_f32_16x16x32_bf16 v[28:31], a[72:75], a[0:3], v[28:31]
s_xor_b32 s64, s73, 17152
ds_read_b128 a[60:63], v3 offset:38912
v_mfma_f32_16x16x32_bf16 v[28:31], a[76:79], a[4:7], v[28:31]
buffer_load_dwordx4 v13, s[48:51], s64 offen lds
v_mfma_f32_16x16x32_bf16 v[44:47], a[76:79], a[12:15], v[44:47]
ds_read_b64_tr_b16 a[104:105], v10 offset:0
v_mfma_f32_16x16x32_bf16 v[44:47], a[72:75], a[8:11], v[44:47]
ds_read_b64_tr_b16 a[106:107], v10 offset:1024
v_mfma_f32_16x16x32_bf16 v[60:63], a[72:75], a[16:19], v[60:63]
s_xor_b32 m0, s84, 6144
ds_read_b64_tr_b16 a[108:109], v10 offset:8192
v_mfma_f32_16x16x32_bf16 v[60:63], a[76:79], a[20:23], v[60:63]
s_xor_b32 s64, s73, 131840
ds_read_b64_tr_b16 a[110:111], v10 offset:9216
v_mfma_f32_16x16x32_bf16 v[76:79], a[76:79], a[28:31], v[76:79]
buffer_load_dwordx4 v12, s[48:51], s64 offen lds
v_mfma_f32_16x16x32_bf16 v[76:79], a[72:75], a[24:27], v[76:79]
ds_read_b64_tr_b16 a[112:113], v11 offset:0
v_mfma_f32_16x16x32_bf16 v[140:143], a[80:83], a[24:27], v[140:143]
ds_read_b64_tr_b16 a[114:115], v11 offset:1024
v_mfma_f32_16x16x32_bf16 v[140:143], a[84:87], a[28:31], v[140:143]
s_xor_b32 m0, s84, 7168
ds_read_b64_tr_b16 a[116:117], v11 offset:8192
v_mfma_f32_16x16x32_bf16 v[124:127], a[84:87], a[20:23], v[124:127]
s_xor_b32 s64, s73, 148224
ds_read_b64_tr_b16 a[118:119], v11 offset:9216
v_mfma_f32_16x16x32_bf16 v[124:127], a[80:83], a[16:19], v[124:127]
buffer_load_dwordx4 v13, s[48:51], s64 offen lds
v_mfma_f32_16x16x32_bf16 v[108:111], a[80:83], a[8:11], v[108:111]
v_mfma_f32_16x16x32_bf16 v[108:111], a[84:87], a[12:15], v[108:111]
v_mfma_f32_16x16x32_bf16 v[92:95], a[84:87], a[4:7], v[92:95]
v_mfma_f32_16x16x32_bf16 v[92:95], a[80:83], a[0:3], v[92:95]
v_mfma_f32_16x16x32_bf16 v[32:35], a[88:91], a[0:3], v[32:35]
v_mfma_f32_16x16x32_bf16 v[32:35], a[92:95], a[4:7], v[32:35]
v_mfma_f32_16x16x32_bf16 v[48:51], a[92:95], a[12:15], v[48:51]
s_waitcnt lgkmcnt(0)
s_barrier
v_mfma_f32_16x16x32_bf16 v[48:51], a[88:91], a[8:11], v[48:51]
s_xor_b32 m0, s77, 65536
ds_read_b64_tr_b16 a[72:73], v19 offset:36864
v_mfma_f32_16x16x32_bf16 v[64:67], a[88:91], a[16:19], v[64:67]
s_xor_b32 s64, s71, 3670016
ds_read_b64_tr_b16 a[74:75], v19 offset:37120
v_mfma_f32_16x16x32_bf16 v[64:67], a[92:95], a[20:23], v[64:67]
buffer_load_dwordx4 v14, s[56:59], s64 offen lds
v_mfma_f32_16x16x32_bf16 v[80:83], a[92:95], a[28:31], v[80:83]
ds_read_b64_tr_b16 a[76:77], v19 offset:38912
v_mfma_f32_16x16x32_bf16 v[80:83], a[88:91], a[24:27], v[80:83]
ds_read_b64_tr_b16 a[78:79], v19 offset:39168
v_mfma_f32_16x16x32_bf16 v[144:147], a[96:99], a[24:27], v[144:147]
ds_read_b64_tr_b16 a[80:81], v20 offset:36864
v_mfma_f32_16x16x32_bf16 v[144:147], a[100:103], a[28:31], v[144:147]
ds_read_b64_tr_b16 a[82:83], v20 offset:37120
v_mfma_f32_16x16x32_bf16 v[128:131], a[100:103], a[20:23], v[128:131]
ds_read_b64_tr_b16 a[84:85], v20 offset:38912
v_mfma_f32_16x16x32_bf16 v[128:131], a[96:99], a[16:19], v[128:131]
ds_read_b64_tr_b16 a[86:87], v20 offset:39168
v_mfma_f32_16x16x32_bf16 v[112:115], a[96:99], a[8:11], v[112:115]
s_add_u32 m0, s78, 81920
ds_read_b64_tr_b16 a[88:89], v19 offset:40960
v_mfma_f32_16x16x32_bf16 v[112:115], a[100:103], a[12:15], v[112:115]
s_add_u32 s64, s75, 2752512
ds_read_b64_tr_b16 a[90:91], v19 offset:41216
v_mfma_f32_16x16x32_bf16 v[96:99], a[100:103], a[4:7], v[96:99]
buffer_load_dwordx4 v23, s[60:63], s64 offen lds
v_mfma_f32_16x16x32_bf16 v[96:99], a[96:99], a[0:3], v[96:99]
ds_read_b64_tr_b16 a[92:93], v19 offset:43008
v_mfma_f32_16x16x32_bf16 v[36:39], a[104:107], a[0:3], v[36:39]
ds_read_b64_tr_b16 a[94:95], v19 offset:43264
v_mfma_f32_16x16x32_bf16 v[36:39], a[108:111], a[4:7], v[36:39]
ds_read_b64_tr_b16 a[96:97], v20 offset:40960
v_mfma_f32_16x16x32_bf16 v[52:55], a[108:111], a[12:15], v[52:55]
ds_read_b64_tr_b16 a[98:99], v20 offset:41216
v_mfma_f32_16x16x32_bf16 v[52:55], a[104:107], a[8:11], v[52:55]
ds_read_b64_tr_b16 a[100:101], v20 offset:43008
v_mfma_f32_16x16x32_bf16 v[68:71], a[104:107], a[16:19], v[68:71]
ds_read_b64_tr_b16 a[102:103], v20 offset:43264
v_mfma_f32_16x16x32_bf16 v[68:71], a[108:111], a[20:23], v[68:71]
s_xor_b32 m0, s77, 66560
v_mfma_f32_16x16x32_bf16 v[84:87], a[108:111], a[28:31], v[84:87]
s_xor_b32 s64, s71, 3702784
v_mfma_f32_16x16x32_bf16 v[84:87], a[104:107], a[24:27], v[84:87]
buffer_load_dwordx4 v14, s[56:59], s64 offen lds
v_mfma_f32_16x16x32_bf16 v[148:151], a[112:115], a[24:27], v[148:151]
ds_read_b64_tr_b16 a[104:105], v19 offset:32768
v_mfma_f32_16x16x32_bf16 v[148:151], a[116:119], a[28:31], v[148:151]
ds_read_b64_tr_b16 a[106:107], v19 offset:33024
v_mfma_f32_16x16x32_bf16 v[132:135], a[116:119], a[20:23], v[132:135]
s_add_u32 s65, s79, 7168
ds_read_b64_tr_b16 a[108:109], v19 offset:34816
v_mfma_f32_16x16x32_bf16 v[132:135], a[112:115], a[16:19], v[132:135]
buffer_store_dwordx4 a[184:187], v16, s[44:47], s65 offen sc1
v_mfma_f32_16x16x32_bf16 v[116:119], a[112:115], a[8:11], v[116:119]
ds_read_b64_tr_b16 a[110:111], v19 offset:35072
v_mfma_f32_16x16x32_bf16 v[116:119], a[116:119], a[12:15], v[116:119]
v_mfma_f32_16x16x32_bf16 v[100:103], a[116:119], a[4:7], v[100:103]
s_add_u32 m0, s78, 86016
v_mfma_f32_16x16x32_bf16 v[100:103], a[112:115], a[0:3], v[100:103]
s_waitcnt lgkmcnt(4)
s_add_u32 s64, s75, 2754560
ds_read_b64_tr_b16 a[112:113], v20 offset:32768
v_mfma_f32_16x16x32_bf16 v[184:187], a[72:75], a[32:35], v[184:187]
buffer_load_dwordx4 v23, s[60:63], s64 offen lds
v_mfma_f32_16x16x32_bf16 v[184:187], a[76:79], a[36:39], v[184:187]
ds_read_b64_tr_b16 a[114:115], v20 offset:33024
v_mfma_f32_16x16x32_bf16 v[192:195], a[76:79], a[44:47], v[192:195]
ds_read_b64_tr_b16 a[116:117], v20 offset:34816
v_mfma_f32_16x16x32_bf16 v[192:195], a[72:75], a[40:43], v[192:195]
ds_read_b64_tr_b16 a[118:119], v20 offset:35072
v_mfma_f32_16x16x32_bf16 v[200:203], a[72:75], a[48:51], v[200:203]
v_mfma_f32_16x16x32_bf16 v[200:203], a[76:79], a[52:55], v[200:203]
v_mfma_f32_16x16x32_bf16 v[208:211], a[76:79], a[60:63], v[208:211]
v_mfma_f32_16x16x32_bf16 v[208:211], a[72:75], a[56:59], v[208:211]
ds_read_b64_tr_b16 a[72:73], v4 offset:32768
v_mfma_f32_16x16x32_bf16 v[212:215], a[80:83], a[56:59], v[212:215]
s_xor_b32 m0, s77, 67584
ds_read_b64_tr_b16 a[74:75], v4 offset:33792
v_mfma_f32_16x16x32_bf16 v[212:215], a[84:87], a[60:63], v[212:215]
s_xor_b32 s64, s71, 3735552
ds_read_b64_tr_b16 a[76:77], v4 offset:40960
v_mfma_f32_16x16x32_bf16 v[204:207], a[84:87], a[52:55], v[204:207]
buffer_load_dwordx4 v15, s[56:59], s64 offen lds
v_mfma_f32_16x16x32_bf16 v[204:207], a[80:83], a[48:51], v[204:207]
ds_read_b64_tr_b16 a[78:79], v4 offset:41984
v_mfma_f32_16x16x32_bf16 v[196:199], a[80:83], a[40:43], v[196:199]
v_mfma_f32_16x16x32_bf16 v[196:199], a[84:87], a[44:47], v[196:199]
v_mfma_f32_16x16x32_bf16 v[188:191], a[84:87], a[36:39], v[188:191]
v_mfma_f32_16x16x32_bf16 v[188:191], a[80:83], a[32:35], v[188:191]
ds_read_b64_tr_b16 a[80:81], v5 offset:32768
v_mfma_f32_16x16x32_bf16 v[216:219], a[32:35], a[88:91], v[216:219]
ds_read_b64_tr_b16 a[82:83], v5 offset:33792
v_mfma_f32_16x16x32_bf16 v[216:219], a[36:39], a[92:95], v[216:219]
s_add_u32 m0, s78, 90112
ds_read_b64_tr_b16 a[84:85], v5 offset:40960
v_mfma_f32_16x16x32_bf16 v[224:227], a[44:47], a[92:95], v[224:227]
s_add_u32 s64, s75, 2756608
ds_read_b64_tr_b16 a[86:87], v5 offset:41984
v_mfma_f32_16x16x32_bf16 v[224:227], a[40:43], a[88:91], v[224:227]
buffer_load_dwordx4 v23, s[60:63], s64 offen lds
v_mfma_f32_16x16x32_bf16 v[232:235], a[48:51], a[88:91], v[232:235]
v_mfma_f32_16x16x32_bf16 v[232:235], a[52:55], a[92:95], v[232:235]
v_mfma_f32_16x16x32_bf16 v[240:243], a[60:63], a[92:95], v[240:243]
v_mfma_f32_16x16x32_bf16 v[240:243], a[56:59], a[88:91], v[240:243]
ds_read_b64_tr_b16 a[88:89], v6 offset:32768
v_mfma_f32_16x16x32_bf16 v[244:247], a[56:59], a[96:99], v[244:247]
ds_read_b64_tr_b16 a[90:91], v6 offset:33792
v_mfma_f32_16x16x32_bf16 v[244:247], a[60:63], a[100:103], v[244:247]
ds_read_b64_tr_b16 a[92:93], v6 offset:40960
v_add_u32 v19, 0x8000, v19
v_mfma_f32_16x16x32_bf16 v[236:239], a[52:55], a[100:103], v[236:239]
s_xor_b32 m0, s77, 68608
ds_read_b64_tr_b16 a[94:95], v6 offset:41984
v_mfma_f32_16x16x32_bf16 v[236:239], a[48:51], a[96:99], v[236:239]
s_xor_b32 s64, s71, 3768320
v_mfma_f32_16x16x32_bf16 v[228:231], a[40:43], a[96:99], v[228:231]
buffer_load_dwordx4 v15, s[56:59], s64 offen lds
v_mfma_f32_16x16x32_bf16 v[228:231], a[44:47], a[100:103], v[228:231]
v_mfma_f32_16x16x32_bf16 v[220:223], a[36:39], a[100:103], v[220:223]
v_mfma_f32_16x16x32_bf16 v[220:223], a[32:35], a[96:99], v[220:223]
s_waitcnt lgkmcnt(4)
ds_read_b64_tr_b16 a[96:97], v7 offset:32768
v_mfma_f32_16x16x32_bf16 v[152:155], a[104:107], a[32:35], v[152:155]
ds_read_b64_tr_b16 a[98:99], v7 offset:33792
v_mfma_f32_16x16x32_bf16 v[152:155], a[108:111], a[36:39], v[152:155]
ds_read_b64_tr_b16 a[100:101], v7 offset:40960
v_add_u32 v20, 0x8000, v20
v_mfma_f32_16x16x32_bf16 v[160:163], a[108:111], a[44:47], v[160:163]
ds_read_b64_tr_b16 a[102:103], v7 offset:41984
v_mfma_f32_16x16x32_bf16 v[160:163], a[104:107], a[40:43], v[160:163]
v_mfma_f32_16x16x32_bf16 v[168:171], a[104:107], a[48:51], v[168:171]
v_mfma_f32_16x16x32_bf16 v[168:171], a[108:111], a[52:55], v[168:171]
v_mfma_f32_16x16x32_bf16 v[176:179], a[108:111], a[60:63], v[176:179]
s_xor_b32 m0, s84, 32768
v_mfma_f32_16x16x32_bf16 v[176:179], a[104:107], a[56:59], v[176:179]
s_xor_b32 s64, s72, 896
ds_read_b64_tr_b16 a[104:105], v8 offset:32768
v_mfma_f32_16x16x32_bf16 v[180:183], a[112:115], a[56:59], v[180:183]
s_add_u32 s65, s79, 3072
buffer_load_dwordx4 v12, s[48:51], s64 offen lds
v_mfma_f32_16x16x32_bf16 v[180:183], a[116:119], a[60:63], v[180:183]
buffer_store_dwordx4 a[188:191], v16, s[44:47], s65 offen sc1
v_mfma_f32_16x16x32_bf16 v[172:175], a[116:119], a[52:55], v[172:175]
ds_read_b64_tr_b16 a[106:107], v8 offset:33792
v_add_u32 v4, 0x8000, v4
v_mfma_f32_16x16x32_bf16 v[172:175], a[112:115], a[48:51], v[172:175]
s_xor_b32 m0, s84, 33792
ds_read_b64_tr_b16 a[108:109], v8 offset:40960
v_mfma_f32_16x16x32_bf16 v[164:167], a[112:115], a[40:43], v[164:167]
s_xor_b32 s64, s72, 17280
ds_read_b64_tr_b16 a[110:111], v8 offset:41984
v_mfma_f32_16x16x32_bf16 v[164:167], a[116:119], a[44:47], v[164:167]
buffer_load_dwordx4 v13, s[48:51], s64 offen lds
v_mfma_f32_16x16x32_bf16 v[156:159], a[116:119], a[36:39], v[156:159]
v_mfma_f32_16x16x32_bf16 v[156:159], a[112:115], a[32:35], v[156:159]
ds_read_b64_tr_b16 a[112:113], v9 offset:32768
v_mfma_f32_16x16x32_bf16 v[24:27], a[72:75], a[32:35], v[24:27]
s_xor_b32 m0, s84, 34816
ds_read_b64_tr_b16 a[114:115], v9 offset:33792
v_mfma_f32_16x16x32_bf16 v[24:27], a[76:79], a[36:39], v[24:27]
s_xor_b32 s64, s72, 131968
ds_read_b64_tr_b16 a[116:117], v9 offset:40960
v_add_u32 v5, 0x8000, v5
v_mfma_f32_16x16x32_bf16 v[40:43], a[76:79], a[44:47], v[40:43]
buffer_load_dwordx4 v12, s[48:51], s64 offen lds
v_mfma_f32_16x16x32_bf16 v[40:43], a[72:75], a[40:43], v[40:43]
ds_read_b64_tr_b16 a[118:119], v9 offset:41984
v_mfma_f32_16x16x32_bf16 v[56:59], a[72:75], a[48:51], v[56:59]
v_mfma_f32_16x16x32_bf16 v[56:59], a[76:79], a[52:55], v[56:59]
s_xor_b32 m0, s84, 35840
v_mfma_f32_16x16x32_bf16 v[72:75], a[76:79], a[60:63], v[72:75]
s_waitcnt vmcnt(12)
s_xor_b32 s64, s72, 148352
ds_read_b128 a[0:3], v2 offset:0
v_mfma_f32_16x16x32_bf16 v[72:75], a[72:75], a[56:59], v[72:75]
buffer_load_dwordx4 v13, s[48:51], s64 offen lds
v_mfma_f32_16x16x32_bf16 v[136:139], a[80:83], a[56:59], v[136:139]
ds_read_b128 a[4:7], v3 offset:0
v_mfma_f32_16x16x32_bf16 v[136:139], a[84:87], a[60:63], v[136:139]
ds_read_b128 a[8:11], v2 offset:2048
v_add_u32 v6, 0x8000, v6
v_mfma_f32_16x16x32_bf16 v[120:123], a[84:87], a[52:55], v[120:123]
s_xor_b32 m0, s84, 36864
ds_read_b128 a[12:15], v3 offset:2048
v_mfma_f32_16x16x32_bf16 v[120:123], a[80:83], a[48:51], v[120:123]
s_xor_b32 s64, s73, 896
ds_read_b128 a[16:19], v2 offset:4096
v_mfma_f32_16x16x32_bf16 v[104:107], a[80:83], a[40:43], v[104:107]
buffer_load_dwordx4 v12, s[48:51], s64 offen lds
v_mfma_f32_16x16x32_bf16 v[104:107], a[84:87], a[44:47], v[104:107]
ds_read_b128 a[20:23], v3 offset:4096
v_mfma_f32_16x16x32_bf16 v[88:91], a[84:87], a[36:39], v[88:91]
ds_read_b128 a[24:27], v2 offset:6144
v_mfma_f32_16x16x32_bf16 v[88:91], a[80:83], a[32:35], v[88:91]
s_waitcnt lgkmcnt(7)
s_xor_b32 m0, s84, 37888
ds_read_b128 a[28:31], v3 offset:6144
v_mfma_f32_16x16x32_bf16 v[28:31], a[88:91], a[32:35], v[28:31]
s_xor_b32 s64, s73, 17280
ds_read_b64_tr_b16 a[72:73], v10 offset:32768
v_mfma_f32_16x16x32_bf16 v[28:31], a[92:95], a[36:39], v[28:31]
buffer_load_dwordx4 v13, s[48:51], s64 offen lds
v_mfma_f32_16x16x32_bf16 v[44:47], a[92:95], a[44:47], v[44:47]
ds_read_b64_tr_b16 a[74:75], v10 offset:33792
v_add_u32 v7, 0x8000, v7
v_mfma_f32_16x16x32_bf16 v[44:47], a[88:91], a[40:43], v[44:47]
ds_read_b64_tr_b16 a[76:77], v10 offset:40960
v_mfma_f32_16x16x32_bf16 v[60:63], a[88:91], a[48:51], v[60:63]
s_xor_b32 m0, s84, 38912
ds_read_b64_tr_b16 a[78:79], v10 offset:41984
v_mfma_f32_16x16x32_bf16 v[60:63], a[92:95], a[52:55], v[60:63]
s_xor_b32 s64, s73, 131968
ds_read_b64_tr_b16 a[80:81], v11 offset:32768
v_mfma_f32_16x16x32_bf16 v[76:79], a[92:95], a[60:63], v[76:79]
buffer_load_dwordx4 v12, s[48:51], s64 offen lds
v_mfma_f32_16x16x32_bf16 v[76:79], a[88:91], a[56:59], v[76:79]
ds_read_b64_tr_b16 a[82:83], v11 offset:33792
v_mfma_f32_16x16x32_bf16 v[140:143], a[96:99], a[56:59], v[140:143]
ds_read_b64_tr_b16 a[84:85], v11 offset:40960
v_mfma_f32_16x16x32_bf16 v[140:143], a[100:103], a[60:63], v[140:143]
s_xor_b32 m0, s84, 39936
ds_read_b64_tr_b16 a[86:87], v11 offset:41984
v_add_u32 v8, 0x8000, v8
v_mfma_f32_16x16x32_bf16 v[124:127], a[100:103], a[52:55], v[124:127]
s_xor_b32 s64, s73, 148352
v_mfma_f32_16x16x32_bf16 v[124:127], a[96:99], a[48:51], v[124:127]
buffer_load_dwordx4 v13, s[48:51], s64 offen lds
v_mfma_f32_16x16x32_bf16 v[108:111], a[96:99], a[40:43], v[108:111]
v_mfma_f32_16x16x32_bf16 v[108:111], a[100:103], a[44:47], v[108:111]
v_mfma_f32_16x16x32_bf16 v[92:95], a[100:103], a[36:39], v[92:95]
v_add_u32 v9, 0x8000, v9
v_add_u32 v10, 0x8000, v10
v_mfma_f32_16x16x32_bf16 v[92:95], a[96:99], a[32:35], v[92:95]
v_add_u32 v11, 0x8000, v11
v_mfma_f32_16x16x32_bf16 v[32:35], a[104:107], a[32:35], v[32:35]
v_mfma_f32_16x16x32_bf16 v[32:35], a[108:111], a[36:39], v[32:35]
v_mfma_f32_16x16x32_bf16 v[48:51], a[108:111], a[44:47], v[48:51]
s_waitcnt lgkmcnt(0)
s_barrier
v_mfma_f32_16x16x32_bf16 v[48:51], a[104:107], a[40:43], v[48:51]
s_xor_b32 m0, s77, 98304
ds_read_b64_tr_b16 a[88:89], v19 offset:36864
v_mfma_f32_16x16x32_bf16 v[64:67], a[104:107], a[48:51], v[64:67]
s_xor_b32 s64, s71, 4194304
ds_read_b64_tr_b16 a[90:91], v19 offset:37120
v_mfma_f32_16x16x32_bf16 v[64:67], a[108:111], a[52:55], v[64:67]
s_add_u32 s65, s79, 24576
buffer_load_dwordx4 v14, s[56:59], s64 offen lds
v_mfma_f32_16x16x32_bf16 v[80:83], a[108:111], a[60:63], v[80:83]
buffer_store_dwordx4 a[192:195], v16, s[44:47], s65 offen sc1
v_mfma_f32_16x16x32_bf16 v[80:83], a[104:107], a[56:59], v[80:83]
ds_read_b64_tr_b16 a[92:93], v19 offset:38912
v_mfma_f32_16x16x32_bf16 v[144:147], a[112:115], a[56:59], v[144:147]
ds_read_b64_tr_b16 a[94:95], v19 offset:39168
v_mfma_f32_16x16x32_bf16 v[144:147], a[116:119], a[60:63], v[144:147]
ds_read_b64_tr_b16 a[96:97], v20 offset:36864
v_mfma_f32_16x16x32_bf16 v[128:131], a[116:119], a[52:55], v[128:131]
ds_read_b64_tr_b16 a[98:99], v20 offset:37120
v_mfma_f32_16x16x32_bf16 v[128:131], a[112:115], a[48:51], v[128:131]
ds_read_b64_tr_b16 a[100:101], v20 offset:38912
v_mfma_f32_16x16x32_bf16 v[112:115], a[112:115], a[40:43], v[112:115]
s_add_u32 m0, s78, 114688
ds_read_b64_tr_b16 a[102:103], v20 offset:39168
v_mfma_f32_16x16x32_bf16 v[112:115], a[116:119], a[44:47], v[112:115]
s_add_u32 s64, s75, 3145728
ds_read_b64_tr_b16 a[104:105], v19 offset:40960
v_mfma_f32_16x16x32_bf16 v[96:99], a[116:119], a[36:39], v[96:99]
buffer_load_dwordx4 v23, s[60:63], s64 offen lds
v_mfma_f32_16x16x32_bf16 v[96:99], a[112:115], a[32:35], v[96:99]
ds_read_b64_tr_b16 a[106:107], v19 offset:41216
v_mfma_f32_16x16x32_bf16 v[36:39], a[72:75], a[32:35], v[36:39]
ds_read_b64_tr_b16 a[108:109], v19 offset:43008
v_mfma_f32_16x16x32_bf16 v[36:39], a[76:79], a[36:39], v[36:39]
ds_read_b64_tr_b16 a[110:111], v19 offset:43264
v_mfma_f32_16x16x32_bf16 v[52:55], a[76:79], a[44:47], v[52:55]
ds_read_b64_tr_b16 a[112:113], v20 offset:40960
v_mfma_f32_16x16x32_bf16 v[52:55], a[72:75], a[40:43], v[52:55]
ds_read_b64_tr_b16 a[114:115], v20 offset:41216
v_mfma_f32_16x16x32_bf16 v[68:71], a[72:75], a[48:51], v[68:71]
ds_read_b64_tr_b16 a[116:117], v20 offset:43008
v_mfma_f32_16x16x32_bf16 v[68:71], a[76:79], a[52:55], v[68:71]
s_xor_b32 m0, s77, 99328
ds_read_b64_tr_b16 a[118:119], v20 offset:43264
v_mfma_f32_16x16x32_bf16 v[84:87], a[76:79], a[60:63], v[84:87]
s_xor_b32 s64, s71, 4227072
v_mfma_f32_16x16x32_bf16 v[84:87], a[72:75], a[56:59], v[84:87]
buffer_load_dwordx4 v14, s[56:59], s64 offen lds
v_mfma_f32_16x16x32_bf16 v[148:151], a[80:83], a[56:59], v[148:151]
ds_read_b64_tr_b16 a[72:73], v19 offset:32768
v_mfma_f32_16x16x32_bf16 v[148:151], a[84:87], a[60:63], v[148:151]
ds_read_b64_tr_b16 a[74:75], v19 offset:33024
v_mfma_f32_16x16x32_bf16 v[132:135], a[84:87], a[52:55], v[132:135]
ds_read_b64_tr_b16 a[76:77], v19 offset:34816
v_mfma_f32_16x16x32_bf16 v[132:135], a[80:83], a[48:51], v[132:135]
ds_read_b64_tr_b16 a[78:79], v19 offset:35072
v_mfma_f32_16x16x32_bf16 v[116:119], a[80:83], a[40:43], v[116:119]
v_mfma_f32_16x16x32_bf16 v[116:119], a[84:87], a[44:47], v[116:119]
v_mfma_f32_16x16x32_bf16 v[100:103], a[84:87], a[36:39], v[100:103]
s_add_u32 m0, s78, 118784
v_mfma_f32_16x16x32_bf16 v[100:103], a[80:83], a[32:35], v[100:103]
s_waitcnt lgkmcnt(4)
s_add_u32 s64, s75, 3147776
ds_read_b64_tr_b16 a[80:81], v20 offset:32768
v_mfma_f32_16x16x32_bf16 v[184:187], a[88:91], a[0:3], v[184:187]
s_branch L_po9
L_pg9:
s_branch L_pg13
L_po9:
buffer_load_dwordx4 v23, s[60:63], s64 offen lds
v_mfma_f32_16x16x32_bf16 v[184:187], a[92:95], a[4:7], v[184:187]
ds_read_b64_tr_b16 a[82:83], v20 offset:33024
v_mfma_f32_16x16x32_bf16 v[192:195], a[92:95], a[12:15], v[192:195]
ds_read_b64_tr_b16 a[84:85], v20 offset:34816
v_mfma_f32_16x16x32_bf16 v[192:195], a[88:91], a[8:11], v[192:195]
ds_read_b64_tr_b16 a[86:87], v20 offset:35072
v_mfma_f32_16x16x32_bf16 v[200:203], a[88:91], a[16:19], v[200:203]
v_mfma_f32_16x16x32_bf16 v[200:203], a[92:95], a[20:23], v[200:203]
v_mfma_f32_16x16x32_bf16 v[208:211], a[92:95], a[28:31], v[208:211]
v_mfma_f32_16x16x32_bf16 v[208:211], a[88:91], a[24:27], v[208:211]
ds_read_b64_tr_b16 a[88:89], v4 offset:32768
v_mfma_f32_16x16x32_bf16 v[212:215], a[96:99], a[24:27], v[212:215]
s_xor_b32 m0, s77, 100352
ds_read_b64_tr_b16 a[90:91], v4 offset:33792
v_mfma_f32_16x16x32_bf16 v[212:215], a[100:103], a[28:31], v[212:215]
s_xor_b32 s64, s71, 4259840
ds_read_b64_tr_b16 a[92:93], v4 offset:40960
v_mfma_f32_16x16x32_bf16 v[204:207], a[100:103], a[20:23], v[204:207]
buffer_load_dwordx4 v15, s[56:59], s64 offen lds
v_mfma_f32_16x16x32_bf16 v[204:207], a[96:99], a[16:19], v[204:207]
ds_read_b64_tr_b16 a[94:95], v4 offset:41984
v_mfma_f32_16x16x32_bf16 v[196:199], a[96:99], a[8:11], v[196:199]
v_mfma_f32_16x16x32_bf16 v[196:199], a[100:103], a[12:15], v[196:199]
v_mfma_f32_16x16x32_bf16 v[188:191], a[100:103], a[4:7], v[188:191]
v_mfma_f32_16x16x32_bf16 v[188:191], a[96:99], a[0:3], v[188:191]
ds_read_b64_tr_b16 a[96:97], v5 offset:32768
v_mfma_f32_16x16x32_bf16 v[216:219], a[0:3], a[104:107], v[216:219]
s_add_u32 s65, s79, 25600
ds_read_b64_tr_b16 a[98:99], v5 offset:33792
v_mfma_f32_16x16x32_bf16 v[216:219], a[4:7], a[108:111], v[216:219]
s_add_u32 m0, s78, 122880
buffer_store_dwordx4 a[196:199], v16, s[44:47], s65 offen sc1
v_mfma_f32_16x16x32_bf16 v[224:227], a[12:15], a[108:111], v[224:227]
s_add_u32 s64, s75, 3149824
ds_read_b64_tr_b16 a[100:101], v5 offset:40960
v_mfma_f32_16x16x32_bf16 v[224:227], a[8:11], a[104:107], v[224:227]
buffer_load_dwordx4 v23, s[60:63], s64 offen lds
v_mfma_f32_16x16x32_bf16 v[232:235], a[16:19], a[104:107], v[232:235]
ds_read_b64_tr_b16 a[102:103], v5 offset:41984
v_mfma_f32_16x16x32_bf16 v[232:235], a[20:23], a[108:111], v[232:235]
v_mfma_f32_16x16x32_bf16 v[240:243], a[28:31], a[108:111], v[240:243]
v_mfma_f32_16x16x32_bf16 v[240:243], a[24:27], a[104:107], v[240:243]
ds_read_b64_tr_b16 a[104:105], v6 offset:32768
v_mfma_f32_16x16x32_bf16 v[244:247], a[24:27], a[112:115], v[244:247]
ds_read_b64_tr_b16 a[106:107], v6 offset:33792
v_mfma_f32_16x16x32_bf16 v[244:247], a[28:31], a[116:119], v[244:247]
ds_read_b64_tr_b16 a[108:109], v6 offset:40960
v_subrev_u32 v19, 0x8000, v19
v_mfma_f32_16x16x32_bf16 v[236:239], a[20:23], a[116:119], v[236:239]
s_xor_b32 m0, s77, 101376
ds_read_b64_tr_b16 a[110:111], v6 offset:41984
v_mfma_f32_16x16x32_bf16 v[236:239], a[16:19], a[112:115], v[236:239]
s_xor_b32 s64, s71, 4292608
v_mfma_f32_16x16x32_bf16 v[228:231], a[8:11], a[112:115], v[228:231]
buffer_load_dwordx4 v15, s[56:59], s64 offen lds
v_mfma_f32_16x16x32_bf16 v[228:231], a[12:15], a[116:119], v[228:231]
v_mfma_f32_16x16x32_bf16 v[220:223], a[4:7], a[116:119], v[220:223]
v_mfma_f32_16x16x32_bf16 v[220:223], a[0:3], a[112:115], v[220:223]
s_waitcnt lgkmcnt(4)
ds_read_b64_tr_b16 a[112:113], v7 offset:32768
v_mfma_f32_16x16x32_bf16 v[152:155], a[72:75], a[0:3], v[152:155]
ds_read_b64_tr_b16 a[114:115], v7 offset:33792
v_mfma_f32_16x16x32_bf16 v[152:155], a[76:79], a[4:7], v[152:155]
ds_read_b64_tr_b16 a[116:117], v7 offset:40960
v_subrev_u32 v20, 0x8000, v20
v_mfma_f32_16x16x32_bf16 v[160:163], a[76:79], a[12:15], v[160:163]
ds_read_b64_tr_b16 a[118:119], v7 offset:41984
v_mfma_f32_16x16x32_bf16 v[160:163], a[72:75], a[8:11], v[160:163]
v_mfma_f32_16x16x32_bf16 v[168:171], a[72:75], a[16:19], v[168:171]
v_mfma_f32_16x16x32_bf16 v[168:171], a[76:79], a[20:23], v[168:171]
v_mfma_f32_16x16x32_bf16 v[176:179], a[76:79], a[28:31], v[176:179]
s_xor_b32 m0, s84, 0
v_mfma_f32_16x16x32_bf16 v[176:179], a[72:75], a[24:27], v[176:179]
s_xor_b32 s64, s72, 1024
ds_read_b64_tr_b16 a[72:73], v8 offset:32768
v_mfma_f32_16x16x32_bf16 v[180:183], a[80:83], a[24:27], v[180:183]
buffer_load_dwordx4 v12, s[48:51], s64 offen lds
v_mfma_f32_16x16x32_bf16 v[180:183], a[84:87], a[28:31], v[180:183]
ds_read_b64_tr_b16 a[74:75], v8 offset:33792
v_subrev_u32 v4, 0x8000, v4
v_mfma_f32_16x16x32_bf16 v[172:175], a[84:87], a[20:23], v[172:175]
ds_read_b64_tr_b16 a[76:77], v8 offset:40960
v_mfma_f32_16x16x32_bf16 v[172:175], a[80:83], a[16:19], v[172:175]
s_xor_b32 m0, s84, 1024
ds_read_b64_tr_b16 a[78:79], v8 offset:41984
v_mfma_f32_16x16x32_bf16 v[164:167], a[80:83], a[8:11], v[164:167]
s_xor_b32 s64, s72, 17408
v_mfma_f32_16x16x32_bf16 v[164:167], a[84:87], a[12:15], v[164:167]
buffer_load_dwordx4 v13, s[48:51], s64 offen lds
v_mfma_f32_16x16x32_bf16 v[156:159], a[84:87], a[4:7], v[156:159]
v_mfma_f32_16x16x32_bf16 v[156:159], a[80:83], a[0:3], v[156:159]
ds_read_b64_tr_b16 a[80:81], v9 offset:32768
v_mfma_f32_16x16x32_bf16 v[24:27], a[88:91], a[0:3], v[24:27]
s_xor_b32 m0, s84, 2048
ds_read_b64_tr_b16 a[82:83], v9 offset:33792
v_mfma_f32_16x16x32_bf16 v[24:27], a[92:95], a[4:7], v[24:27]
s_xor_b32 s64, s72, 132096
ds_read_b64_tr_b16 a[84:85], v9 offset:40960
v_subrev_u32 v5, 0x8000, v5
v_mfma_f32_16x16x32_bf16 v[40:43], a[92:95], a[12:15], v[40:43]
buffer_load_dwordx4 v12, s[48:51], s64 offen lds
v_mfma_f32_16x16x32_bf16 v[40:43], a[88:91], a[8:11], v[40:43]
ds_read_b64_tr_b16 a[86:87], v9 offset:41984
v_mfma_f32_16x16x32_bf16 v[56:59], a[88:91], a[16:19], v[56:59]
v_mfma_f32_16x16x32_bf16 v[56:59], a[92:95], a[20:23], v[56:59]
s_xor_b32 m0, s84, 3072
v_mfma_f32_16x16x32_bf16 v[72:75], a[92:95], a[28:31], v[72:75]
s_waitcnt vmcnt(12)
s_xor_b32 s64, s72, 148480
ds_read_b128 a[32:35], v2 offset:32768
v_mfma_f32_16x16x32_bf16 v[72:75], a[88:91], a[24:27], v[72:75]
buffer_load_dwordx4 v13, s[48:51], s64 offen lds
v_mfma_f32_16x16x32_bf16 v[136:139], a[96:99], a[24:27], v[136:139]
ds_read_b128 a[36:39], v3 offset:32768
v_mfma_f32_16x16x32_bf16 v[136:139], a[100:103], a[28:31], v[136:139]
ds_read_b128 a[40:43], v2 offset:34816
v_subrev_u32 v6, 0x8000, v6
v_mfma_f32_16x16x32_bf16 v[120:123], a[100:103], a[20:23], v[120:123]
s_xor_b32 m0, s84, 4096
ds_read_b128 a[44:47], v3 offset:34816
v_mfma_f32_16x16x32_bf16 v[120:123], a[96:99], a[16:19], v[120:123]
s_xor_b32 s64, s73, 1024
ds_read_b128 a[48:51], v2 offset:36864
v_mfma_f32_16x16x32_bf16 v[104:107], a[96:99], a[8:11], v[104:107]
buffer_load_dwordx4 v12, s[48:51], s64 offen lds
v_mfma_f32_16x16x32_bf16 v[104:107], a[100:103], a[12:15], v[104:107]
s_add_u32 s65, s79, 9216
ds_read_b128 a[52:55], v3 offset:36864
v_mfma_f32_16x16x32_bf16 v[88:91], a[100:103], a[4:7], v[88:91]
buffer_store_dwordx4 a[200:203], v16, s[44:47], s65 offen sc1
v_mfma_f32_16x16x32_bf16 v[88:91], a[96:99], a[0:3], v[88:91]
s_waitcnt lgkmcnt(6)
s_xor_b32 m0, s84, 5120
ds_read_b128 a[56:59], v2 offset:38912
v_mfma_f32_16x16x32_bf16 v[28:31], a[104:107], a[0:3], v[28:31]
s_xor_b32 s64, s73, 17408
ds_read_b128 a[60:63], v3 offset:38912
v_mfma_f32_16x16x32_bf16 v[28:31], a[108:111], a[4:7], v[28:31]
buffer_load_dwordx4 v13, s[48:51], s64 offen lds
v_mfma_f32_16x16x32_bf16 v[44:47], a[108:111], a[12:15], v[44:47]
ds_read_b64_tr_b16 a[88:89], v10 offset:32768
v_subrev_u32 v7, 0x8000, v7
v_mfma_f32_16x16x32_bf16 v[44:47], a[104:107], a[8:11], v[44:47]
ds_read_b64_tr_b16 a[90:91], v10 offset:33792
v_mfma_f32_16x16x32_bf16 v[60:63], a[104:107], a[16:19], v[60:63]
s_xor_b32 m0, s84, 6144
ds_read_b64_tr_b16 a[92:93], v10 offset:40960
v_mfma_f32_16x16x32_bf16 v[60:63], a[108:111], a[20:23], v[60:63]
s_xor_b32 s64, s73, 132096
ds_read_b64_tr_b16 a[94:95], v10 offset:41984
v_mfma_f32_16x16x32_bf16 v[76:79], a[108:111], a[28:31], v[76:79]
buffer_load_dwordx4 v12, s[48:51], s64 offen lds
v_mfma_f32_16x16x32_bf16 v[76:79], a[104:107], a[24:27], v[76:79]
ds_read_b64_tr_b16 a[96:97], v11 offset:32768
v_mfma_f32_16x16x32_bf16 v[140:143], a[112:115], a[24:27], v[140:143]
ds_read_b64_tr_b16 a[98:99], v11 offset:33792
v_mfma_f32_16x16x32_bf16 v[140:143], a[116:119], a[28:31], v[140:143]
s_xor_b32 m0, s84, 7168
ds_read_b64_tr_b16 a[100:101], v11 offset:40960
v_subrev_u32 v8, 0x8000, v8
v_mfma_f32_16x16x32_bf16 v[124:127], a[116:119], a[20:23], v[124:127]
s_xor_b32 s64, s73, 148480
ds_read_b64_tr_b16 a[102:103], v11 offset:41984
v_mfma_f32_16x16x32_bf16 v[124:127], a[112:115], a[16:19], v[124:127]
buffer_load_dwordx4 v13, s[48:51], s64 offen lds
v_mfma_f32_16x16x32_bf16 v[108:111], a[112:115], a[8:11], v[108:111]
v_mfma_f32_16x16x32_bf16 v[108:111], a[116:119], a[12:15], v[108:111]
v_mfma_f32_16x16x32_bf16 v[92:95], a[116:119], a[4:7], v[92:95]
v_subrev_u32 v9, 0x8000, v9
v_subrev_u32 v10, 0x8000, v10
v_mfma_f32_16x16x32_bf16 v[92:95], a[112:115], a[0:3], v[92:95]
v_subrev_u32 v11, 0x8000, v11
v_mfma_f32_16x16x32_bf16 v[32:35], a[72:75], a[0:3], v[32:35]
v_mfma_f32_16x16x32_bf16 v[32:35], a[76:79], a[4:7], v[32:35]
v_mfma_f32_16x16x32_bf16 v[48:51], a[76:79], a[12:15], v[48:51]
s_waitcnt lgkmcnt(0)
s_barrier
v_mfma_f32_16x16x32_bf16 v[48:51], a[72:75], a[8:11], v[48:51]
s_xor_b32 m0, s77, 131072
ds_read_b64_tr_b16 a[104:105], v19 offset:4096
v_mfma_f32_16x16x32_bf16 v[64:67], a[72:75], a[16:19], v[64:67]
s_xor_b32 s64, s71, 4718592
ds_read_b64_tr_b16 a[106:107], v19 offset:4352
v_mfma_f32_16x16x32_bf16 v[64:67], a[76:79], a[20:23], v[64:67]
buffer_load_dwordx4 v14, s[56:59], s64 offen lds
v_mfma_f32_16x16x32_bf16 v[80:83], a[76:79], a[28:31], v[80:83]
ds_read_b64_tr_b16 a[108:109], v19 offset:6144
v_mfma_f32_16x16x32_bf16 v[80:83], a[72:75], a[24:27], v[80:83]
ds_read_b64_tr_b16 a[110:111], v19 offset:6400
v_mfma_f32_16x16x32_bf16 v[144:147], a[80:83], a[24:27], v[144:147]
ds_read_b64_tr_b16 a[112:113], v20 offset:4096
v_mfma_f32_16x16x32_bf16 v[144:147], a[84:87], a[28:31], v[144:147]
ds_read_b64_tr_b16 a[114:115], v20 offset:4352
v_mfma_f32_16x16x32_bf16 v[128:131], a[84:87], a[20:23], v[128:131]
ds_read_b64_tr_b16 a[116:117], v20 offset:6144
v_mfma_f32_16x16x32_bf16 v[128:131], a[80:83], a[16:19], v[128:131]
ds_read_b64_tr_b16 a[118:119], v20 offset:6400
v_mfma_f32_16x16x32_bf16 v[112:115], a[80:83], a[8:11], v[112:115]
s_add_u32 m0, s78, 147456
ds_read_b64_tr_b16 a[72:73], v19 offset:8192
v_mfma_f32_16x16x32_bf16 v[112:115], a[84:87], a[12:15], v[112:115]
s_add_u32 s64, s75, 3538944
ds_read_b64_tr_b16 a[74:75], v19 offset:8448
v_mfma_f32_16x16x32_bf16 v[96:99], a[84:87], a[4:7], v[96:99]
buffer_load_dwordx4 v23, s[60:63], s64 offen lds
v_mfma_f32_16x16x32_bf16 v[96:99], a[80:83], a[0:3], v[96:99]
ds_read_b64_tr_b16 a[76:77], v19 offset:10240
v_mfma_f32_16x16x32_bf16 v[36:39], a[88:91], a[0:3], v[36:39]
ds_read_b64_tr_b16 a[78:79], v19 offset:10496
v_mfma_f32_16x16x32_bf16 v[36:39], a[92:95], a[4:7], v[36:39]
ds_read_b64_tr_b16 a[80:81], v20 offset:8192
v_mfma_f32_16x16x32_bf16 v[52:55], a[92:95], a[12:15], v[52:55]
ds_read_b64_tr_b16 a[82:83], v20 offset:8448
v_mfma_f32_16x16x32_bf16 v[52:55], a[88:91], a[8:11], v[52:55]
ds_read_b64_tr_b16 a[84:85], v20 offset:10240
v_mfma_f32_16x16x32_bf16 v[68:71], a[88:91], a[16:19], v[68:71]
ds_read_b64_tr_b16 a[86:87], v20 offset:10496
v_mfma_f32_16x16x32_bf16 v[68:71], a[92:95], a[20:23], v[68:71]
s_xor_b32 m0, s77, 132096
v_mfma_f32_16x16x32_bf16 v[84:87], a[92:95], a[28:31], v[84:87]
s_xor_b32 s64, s71, 4751360
v_mfma_f32_16x16x32_bf16 v[84:87], a[88:91], a[24:27], v[84:87]
buffer_load_dwordx4 v14, s[56:59], s64 offen lds
v_mfma_f32_16x16x32_bf16 v[148:151], a[96:99], a[24:27], v[148:151]
ds_read_b64_tr_b16 a[88:89], v19 offset:0
v_mfma_f32_16x16x32_bf16 v[148:151], a[100:103], a[28:31], v[148:151]
ds_read_b64_tr_b16 a[90:91], v19 offset:256
v_mfma_f32_16x16x32_bf16 v[132:135], a[100:103], a[20:23], v[132:135]
s_add_u32 s65, s79, 26624
ds_read_b64_tr_b16 a[92:93], v19 offset:2048
v_mfma_f32_16x16x32_bf16 v[132:135], a[96:99], a[16:19], v[132:135]
buffer_store_dwordx4 a[204:207], v16, s[44:47], s65 offen sc1
v_mfma_f32_16x16x32_bf16 v[116:119], a[96:99], a[8:11], v[116:119]
ds_read_b64_tr_b16 a[94:95], v19 offset:2304
v_mfma_f32_16x16x32_bf16 v[116:119], a[100:103], a[12:15], v[116:119]
v_mfma_f32_16x16x32_bf16 v[100:103], a[100:103], a[4:7], v[100:103]
s_add_u32 m0, s78, 151552
v_mfma_f32_16x16x32_bf16 v[100:103], a[96:99], a[0:3], v[100:103]
s_waitcnt lgkmcnt(4)
s_add_u32 s64, s75, 3540992
ds_read_b64_tr_b16 a[96:97], v20 offset:0
v_mfma_f32_16x16x32_bf16 v[184:187], a[104:107], a[32:35], v[184:187]
buffer_load_dwordx4 v23, s[60:63], s64 offen lds
v_mfma_f32_16x16x32_bf16 v[184:187], a[108:111], a[36:39], v[184:187]
ds_read_b64_tr_b16 a[98:99], v20 offset:256
v_mfma_f32_16x16x32_bf16 v[192:195], a[108:111], a[44:47], v[192:195]
ds_read_b64_tr_b16 a[100:101], v20 offset:2048
v_mfma_f32_16x16x32_bf16 v[192:195], a[104:107], a[40:43], v[192:195]
ds_read_b64_tr_b16 a[102:103], v20 offset:2304
v_mfma_f32_16x16x32_bf16 v[200:203], a[104:107], a[48:51], v[200:203]
s_cmp_eq_u32 s30, 0
s_cselect_b32 s81, 256, 0
v_mfma_f32_16x16x32_bf16 v[200:203], a[108:111], a[52:55], v[200:203]
v_mfma_f32_16x16x32_bf16 v[208:211], a[108:111], a[60:63], v[208:211]
v_mfma_f32_16x16x32_bf16 v[208:211], a[104:107], a[56:59], v[208:211]
ds_read_b64_tr_b16 a[104:105], v4 offset:0
v_mfma_f32_16x16x32_bf16 v[212:215], a[112:115], a[56:59], v[212:215]
s_xor_b32 m0, s77, 133120
ds_read_b64_tr_b16 a[106:107], v4 offset:1024
v_mfma_f32_16x16x32_bf16 v[212:215], a[116:119], a[60:63], v[212:215]
s_xor_b32 s64, s71, 4784128
ds_read_b64_tr_b16 a[108:109], v4 offset:8192
v_mfma_f32_16x16x32_bf16 v[204:207], a[116:119], a[52:55], v[204:207]
buffer_load_dwordx4 v15, s[56:59], s64 offen lds
v_mfma_f32_16x16x32_bf16 v[204:207], a[112:115], a[48:51], v[204:207]
ds_read_b64_tr_b16 a[110:111], v4 offset:9216
v_mfma_f32_16x16x32_bf16 v[196:199], a[112:115], a[40:43], v[196:199]
v_mfma_f32_16x16x32_bf16 v[196:199], a[116:119], a[44:47], v[196:199]
v_mfma_f32_16x16x32_bf16 v[188:191], a[116:119], a[36:39], v[188:191]
v_mfma_f32_16x16x32_bf16 v[188:191], a[112:115], a[32:35], v[188:191]
ds_read_b64_tr_b16 a[112:113], v5 offset:0
v_mfma_f32_16x16x32_bf16 v[216:219], a[32:35], a[72:75], v[216:219]
ds_read_b64_tr_b16 a[114:115], v5 offset:1024
v_mfma_f32_16x16x32_bf16 v[216:219], a[36:39], a[76:79], v[216:219]
s_add_u32 m0, s78, 155648
ds_read_b64_tr_b16 a[116:117], v5 offset:8192
v_mfma_f32_16x16x32_bf16 v[224:227], a[44:47], a[76:79], v[224:227]
s_add_u32 s64, s75, 3543040
ds_read_b64_tr_b16 a[118:119], v5 offset:9216
v_mfma_f32_16x16x32_bf16 v[224:227], a[40:43], a[72:75], v[224:227]
buffer_load_dwordx4 v23, s[60:63], s64 offen lds
v_mfma_f32_16x16x32_bf16 v[232:235], a[48:51], a[72:75], v[232:235]
v_mfma_f32_16x16x32_bf16 v[232:235], a[52:55], a[76:79], v[232:235]
v_mfma_f32_16x16x32_bf16 v[240:243], a[60:63], a[76:79], v[240:243]
v_mfma_f32_16x16x32_bf16 v[240:243], a[56:59], a[72:75], v[240:243]
ds_read_b64_tr_b16 a[72:73], v6 offset:0
v_mfma_f32_16x16x32_bf16 v[244:247], a[56:59], a[80:83], v[244:247]
ds_read_b64_tr_b16 a[74:75], v6 offset:1024
v_mfma_f32_16x16x32_bf16 v[244:247], a[60:63], a[84:87], v[244:247]
ds_read_b64_tr_b16 a[76:77], v6 offset:8192
v_mfma_f32_16x16x32_bf16 v[236:239], a[52:55], a[84:87], v[236:239]
s_xor_b32 m0, s77, 134144
ds_read_b64_tr_b16 a[78:79], v6 offset:9216
v_mfma_f32_16x16x32_bf16 v[236:239], a[48:51], a[80:83], v[236:239]
s_xor_b32 s64, s71, 4816896
v_mfma_f32_16x16x32_bf16 v[228:231], a[40:43], a[80:83], v[228:231]
buffer_load_dwordx4 v15, s[56:59], s64 offen lds
v_mfma_f32_16x16x32_bf16 v[228:231], a[44:47], a[84:87], v[228:231]
v_mfma_f32_16x16x32_bf16 v[220:223], a[36:39], a[84:87], v[220:223]
v_mfma_f32_16x16x32_bf16 v[220:223], a[32:35], a[80:83], v[220:223]
s_waitcnt lgkmcnt(4)
ds_read_b64_tr_b16 a[80:81], v7 offset:0
v_mfma_f32_16x16x32_bf16 v[152:155], a[88:91], a[32:35], v[152:155]
ds_read_b64_tr_b16 a[82:83], v7 offset:1024
v_mfma_f32_16x16x32_bf16 v[152:155], a[92:95], a[36:39], v[152:155]
ds_read_b64_tr_b16 a[84:85], v7 offset:8192
v_mfma_f32_16x16x32_bf16 v[160:163], a[92:95], a[44:47], v[160:163]
ds_read_b64_tr_b16 a[86:87], v7 offset:9216
v_mfma_f32_16x16x32_bf16 v[160:163], a[88:91], a[40:43], v[160:163]
v_mfma_f32_16x16x32_bf16 v[168:171], a[88:91], a[48:51], v[168:171]
v_mfma_f32_16x16x32_bf16 v[168:171], a[92:95], a[52:55], v[168:171]
v_mfma_f32_16x16x32_bf16 v[176:179], a[92:95], a[60:63], v[176:179]
s_xor_b32 m0, s84, 32768
v_mfma_f32_16x16x32_bf16 v[176:179], a[88:91], a[56:59], v[176:179]
s_xor_b32 s64, s72, 1152
ds_read_b64_tr_b16 a[88:89], v8 offset:0
v_mfma_f32_16x16x32_bf16 v[180:183], a[96:99], a[56:59], v[180:183]
s_add_u32 s65, s79, 27648
buffer_load_dwordx4 v12, s[48:51], s64 offen lds
v_mfma_f32_16x16x32_bf16 v[180:183], a[100:103], a[60:63], v[180:183]
buffer_store_dwordx4 a[208:211], v16, s[44:47], s65 offen sc1
v_mfma_f32_16x16x32_bf16 v[172:175], a[100:103], a[52:55], v[172:175]
ds_read_b64_tr_b16 a[90:91], v8 offset:1024
v_mfma_f32_16x16x32_bf16 v[172:175], a[96:99], a[48:51], v[172:175]
s_xor_b32 m0, s84, 33792
ds_read_b64_tr_b16 a[92:93], v8 offset:8192
v_mfma_f32_16x16x32_bf16 v[164:167], a[96:99], a[40:43], v[164:167]
s_xor_b32 s64, s72, 17536
ds_read_b64_tr_b16 a[94:95], v8 offset:9216
v_mfma_f32_16x16x32_bf16 v[164:167], a[100:103], a[44:47], v[164:167]
buffer_load_dwordx4 v13, s[48:51], s64 offen lds
v_mfma_f32_16x16x32_bf16 v[156:159], a[100:103], a[36:39], v[156:159]
v_mfma_f32_16x16x32_bf16 v[156:159], a[96:99], a[32:35], v[156:159]
ds_read_b64_tr_b16 a[96:97], v9 offset:0
v_mfma_f32_16x16x32_bf16 v[24:27], a[104:107], a[32:35], v[24:27]
s_xor_b32 m0, s84, 34816
ds_read_b64_tr_b16 a[98:99], v9 offset:1024
v_mfma_f32_16x16x32_bf16 v[24:27], a[108:111], a[36:39], v[24:27]
s_xor_b32 s64, s72, 132224
ds_read_b64_tr_b16 a[100:101], v9 offset:8192
v_mfma_f32_16x16x32_bf16 v[40:43], a[108:111], a[44:47], v[40:43]
buffer_load_dwordx4 v12, s[48:51], s64 offen lds
v_mfma_f32_16x16x32_bf16 v[40:43], a[104:107], a[40:43], v[40:43]
ds_read_b64_tr_b16 a[102:103], v9 offset:9216
v_mfma_f32_16x16x32_bf16 v[56:59], a[104:107], a[48:51], v[56:59]
v_mfma_f32_16x16x32_bf16 v[56:59], a[108:111], a[52:55], v[56:59]
s_xor_b32 m0, s84, 35840
v_mfma_f32_16x16x32_bf16 v[72:75], a[108:111], a[60:63], v[72:75]
s_waitcnt vmcnt(12)
s_xor_b32 s64, s72, 148608
ds_read_b128 a[0:3], v2 offset:0
v_mfma_f32_16x16x32_bf16 v[72:75], a[104:107], a[56:59], v[72:75]
buffer_load_dwordx4 v13, s[48:51], s64 offen lds
v_mfma_f32_16x16x32_bf16 v[136:139], a[112:115], a[56:59], v[136:139]
ds_read_b128 a[4:7], v3 offset:0
v_mfma_f32_16x16x32_bf16 v[136:139], a[116:119], a[60:63], v[136:139]
ds_read_b128 a[8:11], v2 offset:2048
v_mfma_f32_16x16x32_bf16 v[120:123], a[116:119], a[52:55], v[120:123]
s_xor_b32 m0, s84, 36864
ds_read_b128 a[12:15], v3 offset:2048
v_mfma_f32_16x16x32_bf16 v[120:123], a[112:115], a[48:51], v[120:123]
s_xor_b32 s64, s73, 1152
ds_read_b128 a[16:19], v2 offset:4096
v_mfma_f32_16x16x32_bf16 v[104:107], a[112:115], a[40:43], v[104:107]
buffer_load_dwordx4 v12, s[48:51], s64 offen lds
v_mfma_f32_16x16x32_bf16 v[104:107], a[116:119], a[44:47], v[104:107]
ds_read_b128 a[20:23], v3 offset:4096
v_mfma_f32_16x16x32_bf16 v[88:91], a[116:119], a[36:39], v[88:91]
ds_read_b128 a[24:27], v2 offset:6144
v_mfma_f32_16x16x32_bf16 v[88:91], a[112:115], a[32:35], v[88:91]
s_waitcnt lgkmcnt(7)
s_xor_b32 m0, s84, 37888
ds_read_b128 a[28:31], v3 offset:6144
v_mfma_f32_16x16x32_bf16 v[28:31], a[72:75], a[32:35], v[28:31]
s_xor_b32 s64, s73, 17536
ds_read_b64_tr_b16 a[104:105], v10 offset:0
v_mfma_f32_16x16x32_bf16 v[28:31], a[76:79], a[36:39], v[28:31]
buffer_load_dwordx4 v13, s[48:51], s64 offen lds
v_mfma_f32_16x16x32_bf16 v[44:47], a[76:79], a[44:47], v[44:47]
ds_read_b64_tr_b16 a[106:107], v10 offset:1024
v_mfma_f32_16x16x32_bf16 v[44:47], a[72:75], a[40:43], v[44:47]
ds_read_b64_tr_b16 a[108:109], v10 offset:8192
v_mfma_f32_16x16x32_bf16 v[60:63], a[72:75], a[48:51], v[60:63]
s_xor_b32 m0, s84, 38912
ds_read_b64_tr_b16 a[110:111], v10 offset:9216
v_mfma_f32_16x16x32_bf16 v[60:63], a[76:79], a[52:55], v[60:63]
s_xor_b32 s64, s73, 132224
ds_read_b64_tr_b16 a[112:113], v11 offset:0
v_mfma_f32_16x16x32_bf16 v[76:79], a[76:79], a[60:63], v[76:79]
buffer_load_dwordx4 v12, s[48:51], s64 offen lds
v_mfma_f32_16x16x32_bf16 v[76:79], a[72:75], a[56:59], v[76:79]
ds_read_b64_tr_b16 a[114:115], v11 offset:1024
v_mfma_f32_16x16x32_bf16 v[140:143], a[80:83], a[56:59], v[140:143]
ds_read_b64_tr_b16 a[116:117], v11 offset:8192
v_mfma_f32_16x16x32_bf16 v[140:143], a[84:87], a[60:63], v[140:143]
s_xor_b32 m0, s84, 39936
ds_read_b64_tr_b16 a[118:119], v11 offset:9216
v_mfma_f32_16x16x32_bf16 v[124:127], a[84:87], a[52:55], v[124:127]
s_xor_b32 s64, s73, 148608
v_mfma_f32_16x16x32_bf16 v[124:127], a[80:83], a[48:51], v[124:127]
buffer_load_dwordx4 v13, s[48:51], s64 offen lds
v_mfma_f32_16x16x32_bf16 v[108:111], a[80:83], a[40:43], v[108:111]
v_mfma_f32_16x16x32_bf16 v[108:111], a[84:87], a[44:47], v[108:111]
v_mfma_f32_16x16x32_bf16 v[92:95], a[84:87], a[36:39], v[92:95]
v_mfma_f32_16x16x32_bf16 v[92:95], a[80:83], a[32:35], v[92:95]
v_mfma_f32_16x16x32_bf16 v[32:35], a[88:91], a[32:35], v[32:35]
v_mfma_f32_16x16x32_bf16 v[32:35], a[92:95], a[36:39], v[32:35]
v_mfma_f32_16x16x32_bf16 v[48:51], a[92:95], a[44:47], v[48:51]
s_waitcnt lgkmcnt(0)
s_barrier
v_mfma_f32_16x16x32_bf16 v[48:51], a[88:91], a[40:43], v[48:51]
s_xor_b32 m0, s77, 65536
s_add_u32 s65, s79, 11264
ds_read_b64_tr_b16 a[72:73], v19 offset:36864
v_mfma_f32_16x16x32_bf16 v[64:67], a[88:91], a[48:51], v[64:67]
s_xor_b32 s64, s71, 5242880
buffer_store_dwordx4 a[212:215], v16, s[44:47], s65 offen sc1
v_mfma_f32_16x16x32_bf16 v[64:67], a[92:95], a[52:55], v[64:67]
buffer_load_dwordx4 v14, s[56:59], s64 offen lds
v_mfma_f32_16x16x32_bf16 v[80:83], a[92:95], a[60:63], v[80:83]
ds_read_b64_tr_b16 a[74:75], v19 offset:37120
v_mfma_f32_16x16x32_bf16 v[80:83], a[88:91], a[56:59], v[80:83]
buffer_load_dword v1, off, s[52:55], s78 sc1
v_mfma_f32_16x16x32_bf16 v[144:147], a[96:99], a[56:59], v[144:147]
ds_read_b64_tr_b16 a[76:77], v19 offset:38912
v_mfma_f32_16x16x32_bf16 v[144:147], a[100:103], a[60:63], v[144:147]
ds_read_b64_tr_b16 a[78:79], v19 offset:39168
v_mfma_f32_16x16x32_bf16 v[128:131], a[100:103], a[52:55], v[128:131]
ds_read_b64_tr_b16 a[80:81], v20 offset:36864
v_mfma_f32_16x16x32_bf16 v[128:131], a[96:99], a[48:51], v[128:131]
ds_read_b64_tr_b16 a[82:83], v20 offset:37120
v_mfma_f32_16x16x32_bf16 v[112:115], a[96:99], a[40:43], v[112:115]
s_add_u32 m0, s78, 81920
ds_read_b64_tr_b16 a[84:85], v20 offset:38912
v_mfma_f32_16x16x32_bf16 v[112:115], a[100:103], a[44:47], v[112:115]
s_add_u32 s64, s75, 3932160
ds_read_b64_tr_b16 a[86:87], v20 offset:39168
v_mfma_f32_16x16x32_bf16 v[96:99], a[100:103], a[36:39], v[96:99]
buffer_load_dwordx4 v23, s[60:63], s64 offen lds
v_mfma_f32_16x16x32_bf16 v[96:99], a[96:99], a[32:35], v[96:99]
ds_read_b64_tr_b16 a[88:89], v19 offset:40960
v_mfma_f32_16x16x32_bf16 v[36:39], a[104:107], a[32:35], v[36:39]
ds_read_b64_tr_b16 a[90:91], v19 offset:41216
v_mfma_f32_16x16x32_bf16 v[36:39], a[108:111], a[36:39], v[36:39]
ds_read_b64_tr_b16 a[92:93], v19 offset:43008
v_mfma_f32_16x16x32_bf16 v[52:55], a[108:111], a[44:47], v[52:55]
ds_read_b64_tr_b16 a[94:95], v19 offset:43264
v_mfma_f32_16x16x32_bf16 v[52:55], a[104:107], a[40:43], v[52:55]
ds_read_b64_tr_b16 a[96:97], v20 offset:40960
v_mfma_f32_16x16x32_bf16 v[68:71], a[104:107], a[48:51], v[68:71]
ds_read_b64_tr_b16 a[98:99], v20 offset:41216
v_mfma_f32_16x16x32_bf16 v[68:71], a[108:111], a[52:55], v[68:71]
s_xor_b32 m0, s77, 66560
ds_read_b64_tr_b16 a[100:101], v20 offset:43008
v_mfma_f32_16x16x32_bf16 v[84:87], a[108:111], a[60:63], v[84:87]
s_xor_b32 s64, s71, 5275648
ds_read_b64_tr_b16 a[102:103], v20 offset:43264
v_mfma_f32_16x16x32_bf16 v[84:87], a[104:107], a[56:59], v[84:87]
buffer_load_dwordx4 v14, s[56:59], s64 offen lds
v_mfma_f32_16x16x32_bf16 v[148:151], a[112:115], a[56:59], v[148:151]
ds_read_b64_tr_b16 a[104:105], v19 offset:32768
v_mfma_f32_16x16x32_bf16 v[148:151], a[116:119], a[60:63], v[148:151]
ds_read_b64_tr_b16 a[106:107], v19 offset:33024
v_mfma_f32_16x16x32_bf16 v[132:135], a[116:119], a[52:55], v[132:135]
ds_read_b64_tr_b16 a[108:109], v19 offset:34816
v_mfma_f32_16x16x32_bf16 v[132:135], a[112:115], a[48:51], v[132:135]
ds_read_b64_tr_b16 a[110:111], v19 offset:35072
v_mfma_f32_16x16x32_bf16 v[116:119], a[112:115], a[40:43], v[116:119]
v_mfma_f32_16x16x32_bf16 v[116:119], a[116:119], a[44:47], v[116:119]
v_mfma_f32_16x16x32_bf16 v[100:103], a[116:119], a[36:39], v[100:103]
s_add_u32 m0, s78, 86016
v_mfma_f32_16x16x32_bf16 v[100:103], a[112:115], a[32:35], v[100:103]
s_waitcnt lgkmcnt(5)
s_add_u32 s64, s75, 3934208
ds_read_b64_tr_b16 a[112:113], v20 offset:32768
v_mfma_f32_16x16x32_bf16 v[184:187], a[72:75], a[0:3], v[184:187]
buffer_load_dwordx4 v23, s[60:63], s64 offen lds
v_mfma_f32_16x16x32_bf16 v[184:187], a[76:79], a[4:7], v[184:187]
ds_read_b64_tr_b16 a[114:115], v20 offset:33024
v_mfma_f32_16x16x32_bf16 v[192:195], a[76:79], a[12:15], v[192:195]
ds_read_b64_tr_b16 a[116:117], v20 offset:34816
v_mfma_f32_16x16x32_bf16 v[192:195], a[72:75], a[8:11], v[192:195]
ds_read_b64_tr_b16 a[118:119], v20 offset:35072
v_mfma_f32_16x16x32_bf16 v[200:203], a[72:75], a[16:19], v[200:203]
v_mfma_f32_16x16x32_bf16 v[200:203], a[76:79], a[20:23], v[200:203]
v_mfma_f32_16x16x32_bf16 v[208:211], a[76:79], a[28:31], v[208:211]
v_mfma_f32_16x16x32_bf16 v[208:211], a[72:75], a[24:27], v[208:211]
ds_read_b64_tr_b16 a[72:73], v4 offset:32768
v_mfma_f32_16x16x32_bf16 v[212:215], a[80:83], a[24:27], v[212:215]
s_xor_b32 m0, s77, 67584
ds_read_b64_tr_b16 a[74:75], v4 offset:33792
v_mfma_f32_16x16x32_bf16 v[212:215], a[84:87], a[28:31], v[212:215]
s_xor_b32 s64, s71, 5308416
ds_read_b64_tr_b16 a[76:77], v4 offset:40960
v_mfma_f32_16x16x32_bf16 v[204:207], a[84:87], a[20:23], v[204:207]
buffer_load_dwordx4 v15, s[56:59], s64 offen lds
v_mfma_f32_16x16x32_bf16 v[204:207], a[80:83], a[16:19], v[204:207]
ds_read_b64_tr_b16 a[78:79], v4 offset:41984
v_mfma_f32_16x16x32_bf16 v[196:199], a[80:83], a[8:11], v[196:199]
v_mfma_f32_16x16x32_bf16 v[196:199], a[84:87], a[12:15], v[196:199]
v_mfma_f32_16x16x32_bf16 v[188:191], a[84:87], a[4:7], v[188:191]
v_mfma_f32_16x16x32_bf16 v[188:191], a[80:83], a[0:3], v[188:191]
ds_read_b64_tr_b16 a[80:81], v5 offset:32768
v_mfma_f32_16x16x32_bf16 v[216:219], a[0:3], a[88:91], v[216:219]
s_add_u32 s65, s79, 28672
ds_read_b64_tr_b16 a[82:83], v5 offset:33792
v_mfma_f32_16x16x32_bf16 v[216:219], a[4:7], a[92:95], v[216:219]
s_add_u32 m0, s78, 90112
buffer_store_dwordx4 a[216:219], v16, s[44:47], s65 offen sc1
v_mfma_f32_16x16x32_bf16 v[224:227], a[12:15], a[92:95], v[224:227]
s_add_u32 s64, s75, 3936256
ds_read_b64_tr_b16 a[84:85], v5 offset:40960
v_mfma_f32_16x16x32_bf16 v[224:227], a[8:11], a[88:91], v[224:227]
buffer_load_dwordx4 v23, s[60:63], s64 offen lds
v_mfma_f32_16x16x32_bf16 v[232:235], a[16:19], a[88:91], v[232:235]
s_branch L_po10
L_pg10:
s_branch L_tr1
L_po10:
ds_read_b64_tr_b16 a[86:87], v5 offset:41984
v_mfma_f32_16x16x32_bf16 v[232:235], a[20:23], a[92:95], v[232:235]
v_mfma_f32_16x16x32_bf16 v[240:243], a[28:31], a[92:95], v[240:243]
v_mfma_f32_16x16x32_bf16 v[240:243], a[24:27], a[88:91], v[240:243]
ds_read_b64_tr_b16 a[88:89], v6 offset:32768
v_mfma_f32_16x16x32_bf16 v[244:247], a[24:27], a[96:99], v[244:247]
s_waitcnt lgkmcnt(5)
ds_read_b64_tr_b16 a[90:91], v6 offset:33792
v_mfma_f32_16x16x32_bf16 v[244:247], a[28:31], a[100:103], v[244:247]
ds_read_b64_tr_b16 a[92:93], v6 offset:40960
v_add_u32 v19, 0x8000, v19
v_mfma_f32_16x16x32_bf16 v[236:239], a[20:23], a[100:103], v[236:239]
s_xor_b32 m0, s77, 68608
ds_read_b64_tr_b16 a[94:95], v6 offset:41984
v_mfma_f32_16x16x32_bf16 v[236:239], a[16:19], a[96:99], v[236:239]
s_xor_b32 s64, s71, 5341184
v_mfma_f32_16x16x32_bf16 v[228:231], a[8:11], a[96:99], v[228:231]
buffer_load_dwordx4 v15, s[56:59], s64 offen lds
v_mfma_f32_16x16x32_bf16 v[228:231], a[12:15], a[100:103], v[228:231]
v_mfma_f32_16x16x32_bf16 v[220:223], a[4:7], a[100:103], v[220:223]
v_mfma_f32_16x16x32_bf16 v[220:223], a[0:3], a[96:99], v[220:223]
ds_read_b64_tr_b16 a[96:97], v7 offset:32768
v_mfma_f32_16x16x32_bf16 v[152:155], a[104:107], a[0:3], v[152:155]
ds_read_b64_tr_b16 a[98:99], v7 offset:33792
v_mfma_f32_16x16x32_bf16 v[152:155], a[108:111], a[4:7], v[152:155]
ds_read_b64_tr_b16 a[100:101], v7 offset:40960
v_add_u32 v20, 0x8000, v20
v_mfma_f32_16x16x32_bf16 v[160:163], a[108:111], a[12:15], v[160:163]
ds_read_b64_tr_b16 a[102:103], v7 offset:41984
v_mfma_f32_16x16x32_bf16 v[160:163], a[104:107], a[8:11], v[160:163]
v_mfma_f32_16x16x32_bf16 v[168:171], a[104:107], a[16:19], v[168:171]
v_mfma_f32_16x16x32_bf16 v[168:171], a[108:111], a[20:23], v[168:171]
v_mfma_f32_16x16x32_bf16 v[176:179], a[108:111], a[28:31], v[176:179]
s_xor_b32 m0, s84, 0
v_mfma_f32_16x16x32_bf16 v[176:179], a[104:107], a[24:27], v[176:179]
s_xor_b32 s64, s72, 1280
ds_read_b64_tr_b16 a[104:105], v8 offset:32768
v_mfma_f32_16x16x32_bf16 v[180:183], a[112:115], a[24:27], v[180:183]
buffer_load_dwordx4 v12, s[48:51], s64 offen lds
v_mfma_f32_16x16x32_bf16 v[180:183], a[116:119], a[28:31], v[180:183]
ds_read_b64_tr_b16 a[106:107], v8 offset:33792
v_add_u32 v4, 0x8000, v4
v_mfma_f32_16x16x32_bf16 v[172:175], a[116:119], a[20:23], v[172:175]
ds_read_b64_tr_b16 a[108:109], v8 offset:40960
v_mfma_f32_16x16x32_bf16 v[172:175], a[112:115], a[16:19], v[172:175]
s_xor_b32 m0, s84, 1024
ds_read_b64_tr_b16 a[110:111], v8 offset:41984
v_mfma_f32_16x16x32_bf16 v[164:167], a[112:115], a[8:11], v[164:167]
s_xor_b32 s64, s72, 17664
v_mfma_f32_16x16x32_bf16 v[164:167], a[116:119], a[12:15], v[164:167]
buffer_load_dwordx4 v13, s[48:51], s64 offen lds
v_mfma_f32_16x16x32_bf16 v[156:159], a[116:119], a[4:7], v[156:159]
v_mfma_f32_16x16x32_bf16 v[156:159], a[112:115], a[0:3], v[156:159]
ds_read_b64_tr_b16 a[112:113], v9 offset:32768
v_mfma_f32_16x16x32_bf16 v[24:27], a[72:75], a[0:3], v[24:27]
s_xor_b32 m0, s84, 2048
ds_read_b64_tr_b16 a[114:115], v9 offset:33792
v_mfma_f32_16x16x32_bf16 v[24:27], a[76:79], a[4:7], v[24:27]
s_xor_b32 s64, s72, 132352
ds_read_b64_tr_b16 a[116:117], v9 offset:40960
v_add_u32 v5, 0x8000, v5
v_mfma_f32_16x16x32_bf16 v[40:43], a[76:79], a[12:15], v[40:43]
buffer_load_dwordx4 v12, s[48:51], s64 offen lds
v_mfma_f32_16x16x32_bf16 v[40:43], a[72:75], a[8:11], v[40:43]
ds_read_b64_tr_b16 a[118:119], v9 offset:41984
v_mfma_f32_16x16x32_bf16 v[56:59], a[72:75], a[16:19], v[56:59]
v_mfma_f32_16x16x32_bf16 v[56:59], a[76:79], a[20:23], v[56:59]
s_xor_b32 m0, s84, 3072
v_mfma_f32_16x16x32_bf16 v[72:75], a[76:79], a[28:31], v[72:75]
s_waitcnt vmcnt(13)
s_xor_b32 s64, s72, 148736
ds_read_b128 a[32:35], v2 offset:32768
v_mfma_f32_16x16x32_bf16 v[72:75], a[72:75], a[24:27], v[72:75]
s_waitcnt lgkmcnt(5)
buffer_load_dwordx4 v13, s[48:51], s64 offen lds
v_mfma_f32_16x16x32_bf16 v[136:139], a[80:83], a[24:27], v[136:139]
ds_read_b128 a[36:39], v3 offset:32768
v_mfma_f32_16x16x32_bf16 v[136:139], a[84:87], a[28:31], v[136:139]
ds_read_b128 a[40:43], v2 offset:34816
v_add_u32 v6, 0x8000, v6
v_mfma_f32_16x16x32_bf16 v[120:123], a[84:87], a[20:23], v[120:123]
s_xor_b32 m0, s84, 4096
ds_read_b128 a[44:47], v3 offset:34816
v_mfma_f32_16x16x32_bf16 v[120:123], a[80:83], a[16:19], v[120:123]
s_xor_b32 s64, s73, 1280
ds_read_b128 a[48:51], v2 offset:36864
v_mfma_f32_16x16x32_bf16 v[104:107], a[80:83], a[8:11], v[104:107]
buffer_load_dwordx4 v12, s[48:51], s64 offen lds
v_mfma_f32_16x16x32_bf16 v[104:107], a[84:87], a[12:15], v[104:107]
s_add_u32 s65, s79, 29696
ds_read_b128 a[52:55], v3 offset:36864
v_mfma_f32_16x16x32_bf16 v[88:91], a[84:87], a[4:7], v[88:91]
buffer_store_dwordx4 a[220:223], v16, s[44:47], s65 offen sc1
v_mfma_f32_16x16x32_bf16 v[88:91], a[80:83], a[0:3], v[88:91]
s_xor_b32 m0, s84, 5120
ds_read_b128 a[56:59], v2 offset:38912
v_mfma_f32_16x16x32_bf16 v[28:31], a[88:91], a[0:3], v[28:31]
s_xor_b32 s64, s73, 17664
ds_read_b128 a[60:63], v3 offset:38912
v_mfma_f32_16x16x32_bf16 v[28:31], a[92:95], a[4:7], v[28:31]
buffer_load_dwordx4 v13, s[48:51], s64 offen lds
v_mfma_f32_16x16x32_bf16 v[44:47], a[92:95], a[12:15], v[44:47]
ds_read_b64_tr_b16 a[72:73], v10 offset:32768
v_add_u32 v7, 0x8000, v7
v_mfma_f32_16x16x32_bf16 v[44:47], a[88:91], a[8:11], v[44:47]
ds_read_b64_tr_b16 a[74:75], v10 offset:33792
v_mfma_f32_16x16x32_bf16 v[60:63], a[88:91], a[16:19], v[60:63]
s_xor_b32 m0, s84, 6144
ds_read_b64_tr_b16 a[76:77], v10 offset:40960
v_mfma_f32_16x16x32_bf16 v[60:63], a[92:95], a[20:23], v[60:63]
s_xor_b32 s64, s73, 132352
ds_read_b64_tr_b16 a[78:79], v10 offset:41984
v_mfma_f32_16x16x32_bf16 v[76:79], a[92:95], a[28:31], v[76:79]
buffer_load_dwordx4 v12, s[48:51], s64 offen lds
v_mfma_f32_16x16x32_bf16 v[76:79], a[88:91], a[24:27], v[76:79]
ds_read_b64_tr_b16 a[80:81], v11 offset:32768
v_mfma_f32_16x16x32_bf16 v[140:143], a[96:99], a[24:27], v[140:143]
ds_read_b64_tr_b16 a[82:83], v11 offset:33792
v_mfma_f32_16x16x32_bf16 v[140:143], a[100:103], a[28:31], v[140:143]
s_xor_b32 m0, s84, 7168
ds_read_b64_tr_b16 a[84:85], v11 offset:40960
v_add_u32 v8, 0x8000, v8
v_mfma_f32_16x16x32_bf16 v[124:127], a[100:103], a[20:23], v[124:127]
s_xor_b32 s64, s73, 148736
ds_read_b64_tr_b16 a[86:87], v11 offset:41984
v_mfma_f32_16x16x32_bf16 v[124:127], a[96:99], a[16:19], v[124:127]
buffer_load_dwordx4 v13, s[48:51], s64 offen lds
v_mfma_f32_16x16x32_bf16 v[108:111], a[96:99], a[8:11], v[108:111]
v_mfma_f32_16x16x32_bf16 v[108:111], a[100:103], a[12:15], v[108:111]
v_mfma_f32_16x16x32_bf16 v[92:95], a[100:103], a[4:7], v[92:95]
v_add_u32 v9, 0x8000, v9
v_add_u32 v10, 0x8000, v10
v_mfma_f32_16x16x32_bf16 v[92:95], a[96:99], a[0:3], v[92:95]
v_add_u32 v11, 0x8000, v11
v_mfma_f32_16x16x32_bf16 v[32:35], a[104:107], a[0:3], v[32:35]
v_mfma_f32_16x16x32_bf16 v[32:35], a[108:111], a[4:7], v[32:35]
v_mfma_f32_16x16x32_bf16 v[48:51], a[108:111], a[12:15], v[48:51]
s_waitcnt lgkmcnt(0)
s_barrier
v_mfma_f32_16x16x32_bf16 v[48:51], a[104:107], a[8:11], v[48:51]
s_xor_b32 m0, s77, 98304
ds_read_b64_tr_b16 a[88:89], v19 offset:36864
v_mfma_f32_16x16x32_bf16 v[64:67], a[104:107], a[16:19], v[64:67]
s_xor_b32 s64, s71, 5767168
ds_read_b64_tr_b16 a[90:91], v19 offset:37120
v_mfma_f32_16x16x32_bf16 v[64:67], a[108:111], a[20:23], v[64:67]
buffer_load_dwordx4 v14, s[56:59], s64 offen lds
v_mfma_f32_16x16x32_bf16 v[80:83], a[108:111], a[28:31], v[80:83]
ds_read_b64_tr_b16 a[92:93], v19 offset:38912
v_mfma_f32_16x16x32_bf16 v[80:83], a[104:107], a[24:27], v[80:83]
ds_read_b64_tr_b16 a[94:95], v19 offset:39168
v_mfma_f32_16x16x32_bf16 v[144:147], a[112:115], a[24:27], v[144:147]
ds_read_b64_tr_b16 a[96:97], v20 offset:36864
v_mfma_f32_16x16x32_bf16 v[144:147], a[116:119], a[28:31], v[144:147]
ds_read_b64_tr_b16 a[98:99], v20 offset:37120
v_mfma_f32_16x16x32_bf16 v[128:131], a[116:119], a[20:23], v[128:131]
ds_read_b64_tr_b16 a[100:101], v20 offset:38912
v_mfma_f32_16x16x32_bf16 v[128:131], a[112:115], a[16:19], v[128:131]
ds_read_b64_tr_b16 a[102:103], v20 offset:39168
v_mfma_f32_16x16x32_bf16 v[112:115], a[112:115], a[8:11], v[112:115]
s_add_u32 m0, s78, 114688
ds_read_b64_tr_b16 a[104:105], v19 offset:40960
v_mfma_f32_16x16x32_bf16 v[112:115], a[116:119], a[12:15], v[112:115]
s_add_u32 s64, s75, 4325376
ds_read_b64_tr_b16 a[106:107], v19 offset:41216
v_mfma_f32_16x16x32_bf16 v[96:99], a[116:119], a[4:7], v[96:99]
buffer_load_dwordx4 v23, s[60:63], s64 offen lds
v_mfma_f32_16x16x32_bf16 v[96:99], a[112:115], a[0:3], v[96:99]
ds_read_b64_tr_b16 a[108:109], v19 offset:43008
v_mfma_f32_16x16x32_bf16 v[36:39], a[72:75], a[0:3], v[36:39]
ds_read_b64_tr_b16 a[110:111], v19 offset:43264
v_mfma_f32_16x16x32_bf16 v[36:39], a[76:79], a[4:7], v[36:39]
ds_read_b64_tr_b16 a[112:113], v20 offset:40960
v_mfma_f32_16x16x32_bf16 v[52:55], a[76:79], a[12:15], v[52:55]
ds_read_b64_tr_b16 a[114:115], v20 offset:41216
v_mfma_f32_16x16x32_bf16 v[52:55], a[72:75], a[8:11], v[52:55]
ds_read_b64_tr_b16 a[116:117], v20 offset:43008
v_mfma_f32_16x16x32_bf16 v[68:71], a[72:75], a[16:19], v[68:71]
ds_read_b64_tr_b16 a[118:119], v20 offset:43264
v_mfma_f32_16x16x32_bf16 v[68:71], a[76:79], a[20:23], v[68:71]
s_xor_b32 m0, s77, 99328
v_mfma_f32_16x16x32_bf16 v[84:87], a[76:79], a[28:31], v[84:87]
s_xor_b32 s64, s71, 5799936
v_mfma_f32_16x16x32_bf16 v[84:87], a[72:75], a[24:27], v[84:87]
buffer_load_dwordx4 v14, s[56:59], s64 offen lds
v_mfma_f32_16x16x32_bf16 v[148:151], a[80:83], a[24:27], v[148:151]
ds_read_b64_tr_b16 a[72:73], v19 offset:32768
v_mfma_f32_16x16x32_bf16 v[148:151], a[84:87], a[28:31], v[148:151]
ds_read_b64_tr_b16 a[74:75], v19 offset:33024
v_mfma_f32_16x16x32_bf16 v[132:135], a[84:87], a[20:23], v[132:135]
s_add_u32 s65, s79, 13312
ds_read_b64_tr_b16 a[76:77], v19 offset:34816
v_mfma_f32_16x16x32_bf16 v[132:135], a[80:83], a[16:19], v[132:135]
buffer_store_dwordx4 a[224:227], v16, s[44:47], s65 offen sc1
v_mfma_f32_16x16x32_bf16 v[116:119], a[80:83], a[8:11], v[116:119]
ds_read_b64_tr_b16 a[78:79], v19 offset:35072
v_mfma_f32_16x16x32_bf16 v[116:119], a[84:87], a[12:15], v[116:119]
v_mfma_f32_16x16x32_bf16 v[100:103], a[84:87], a[4:7], v[100:103]
s_add_u32 m0, s78, 118784
v_mfma_f32_16x16x32_bf16 v[100:103], a[80:83], a[0:3], v[100:103]
s_waitcnt lgkmcnt(4)
s_add_u32 s64, s75, 4327424
ds_read_b64_tr_b16 a[80:81], v20 offset:32768
v_mfma_f32_16x16x32_bf16 v[184:187], a[88:91], a[32:35], v[184:187]
buffer_load_dwordx4 v23, s[60:63], s64 offen lds
v_mfma_f32_16x16x32_bf16 v[184:187], a[92:95], a[36:39], v[184:187]
ds_read_b64_tr_b16 a[82:83], v20 offset:33024
v_mfma_f32_16x16x32_bf16 v[192:195], a[92:95], a[44:47], v[192:195]
ds_read_b64_tr_b16 a[84:85], v20 offset:34816
v_mfma_f32_16x16x32_bf16 v[192:195], a[88:91], a[40:43], v[192:195]
ds_read_b64_tr_b16 a[86:87], v20 offset:35072
v_mfma_f32_16x16x32_bf16 v[200:203], a[88:91], a[48:51], v[200:203]
v_mfma_f32_16x16x32_bf16 v[200:203], a[92:95], a[52:55], v[200:203]
v_mfma_f32_16x16x32_bf16 v[208:211], a[92:95], a[60:63], v[208:211]
v_mfma_f32_16x16x32_bf16 v[208:211], a[88:91], a[56:59], v[208:211]
ds_read_b64_tr_b16 a[88:89], v4 offset:32768
v_mfma_f32_16x16x32_bf16 v[212:215], a[96:99], a[56:59], v[212:215]
s_xor_b32 m0, s77, 100352
ds_read_b64_tr_b16 a[90:91], v4 offset:33792
v_mfma_f32_16x16x32_bf16 v[212:215], a[100:103], a[60:63], v[212:215]
s_xor_b32 s64, s71, 5832704
ds_read_b64_tr_b16 a[92:93], v4 offset:40960
v_mfma_f32_16x16x32_bf16 v[204:207], a[100:103], a[52:55], v[204:207]
buffer_load_dwordx4 v15, s[56:59], s64 offen lds
v_mfma_f32_16x16x32_bf16 v[204:207], a[96:99], a[48:51], v[204:207]
ds_read_b64_tr_b16 a[94:95], v4 offset:41984
v_mfma_f32_16x16x32_bf16 v[196:199], a[96:99], a[40:43], v[196:199]
v_mfma_f32_16x16x32_bf16 v[196:199], a[100:103], a[44:47], v[196:199]
v_mfma_f32_16x16x32_bf16 v[188:191], a[100:103], a[36:39], v[188:191]
v_mfma_f32_16x16x32_bf16 v[188:191], a[96:99], a[32:35], v[188:191]
ds_read_b64_tr_b16 a[96:97], v5 offset:32768
v_mfma_f32_16x16x32_bf16 v[216:219], a[32:35], a[104:107], v[216:219]
ds_read_b64_tr_b16 a[98:99], v5 offset:33792
v_mfma_f32_16x16x32_bf16 v[216:219], a[36:39], a[108:111], v[216:219]
s_add_u32 m0, s78, 122880
ds_read_b64_tr_b16 a[100:101], v5 offset:40960
v_mfma_f32_16x16x32_bf16 v[224:227], a[44:47], a[108:111], v[224:227]
s_add_u32 s64, s75, 4329472
ds_read_b64_tr_b16 a[102:103], v5 offset:41984
v_mfma_f32_16x16x32_bf16 v[224:227], a[40:43], a[104:107], v[224:227]
buffer_load_dwordx4 v23, s[60:63], s64 offen lds
v_mfma_f32_16x16x32_bf16 v[232:235], a[48:51], a[104:107], v[232:235]
v_mfma_f32_16x16x32_bf16 v[232:235], a[52:55], a[108:111], v[232:235]
v_mfma_f32_16x16x32_bf16 v[240:243], a[60:63], a[108:111], v[240:243]
v_mfma_f32_16x16x32_bf16 v[240:243], a[56:59], a[104:107], v[240:243]
ds_read_b64_tr_b16 a[104:105], v6 offset:32768
v_mfma_f32_16x16x32_bf16 v[244:247], a[56:59], a[112:115], v[244:247]
ds_read_b64_tr_b16 a[106:107], v6 offset:33792
v_mfma_f32_16x16x32_bf16 v[244:247], a[60:63], a[116:119], v[244:247]
ds_read_b64_tr_b16 a[108:109], v6 offset:40960
v_subrev_u32 v19, 0x8000, v19
v_mfma_f32_16x16x32_bf16 v[236:239], a[52:55], a[116:119], v[236:239]
s_xor_b32 m0, s77, 101376
ds_read_b64_tr_b16 a[110:111], v6 offset:41984
v_mfma_f32_16x16x32_bf16 v[236:239], a[48:51], a[112:115], v[236:239]
s_xor_b32 s64, s71, 5865472
v_mfma_f32_16x16x32_bf16 v[228:231], a[40:43], a[112:115], v[228:231]
buffer_load_dwordx4 v15, s[56:59], s64 offen lds
v_mfma_f32_16x16x32_bf16 v[228:231], a[44:47], a[116:119], v[228:231]
v_mfma_f32_16x16x32_bf16 v[220:223], a[36:39], a[116:119], v[220:223]
v_mfma_f32_16x16x32_bf16 v[220:223], a[32:35], a[112:115], v[220:223]
s_waitcnt lgkmcnt(4)
ds_read_b64_tr_b16 a[112:113], v7 offset:32768
v_mfma_f32_16x16x32_bf16 v[152:155], a[72:75], a[32:35], v[152:155]
ds_read_b64_tr_b16 a[114:115], v7 offset:33792
v_mfma_f32_16x16x32_bf16 v[152:155], a[76:79], a[36:39], v[152:155]
ds_read_b64_tr_b16 a[116:117], v7 offset:40960
v_subrev_u32 v20, 0x8000, v20
v_mfma_f32_16x16x32_bf16 v[160:163], a[76:79], a[44:47], v[160:163]
ds_read_b64_tr_b16 a[118:119], v7 offset:41984
v_mfma_f32_16x16x32_bf16 v[160:163], a[72:75], a[40:43], v[160:163]
v_mfma_f32_16x16x32_bf16 v[168:171], a[72:75], a[48:51], v[168:171]
v_mfma_f32_16x16x32_bf16 v[168:171], a[76:79], a[52:55], v[168:171]
v_mfma_f32_16x16x32_bf16 v[176:179], a[76:79], a[60:63], v[176:179]
s_xor_b32 m0, s84, 32768
s_add_u32 s65, s79, 30720
v_mfma_f32_16x16x32_bf16 v[176:179], a[72:75], a[56:59], v[176:179]
s_xor_b32 s64, s72, 1408
buffer_store_dwordx4 a[228:231], v16, s[44:47], s65 offen sc1
v_mfma_f32_16x16x32_bf16 v[180:183], a[80:83], a[56:59], v[180:183]
buffer_load_dwordx4 v12, s[48:51], s64 offen lds
v_mfma_f32_16x16x32_bf16 v[180:183], a[84:87], a[60:63], v[180:183]
ds_read_b64_tr_b16 a[72:73], v8 offset:32768
v_subrev_u32 v4, 0x8000, v4
v_mfma_f32_16x16x32_bf16 v[172:175], a[84:87], a[52:55], v[172:175]
ds_read_b64_tr_b16 a[74:75], v8 offset:33792
v_mfma_f32_16x16x32_bf16 v[172:175], a[80:83], a[48:51], v[172:175]
s_xor_b32 m0, s84, 33792
ds_read_b64_tr_b16 a[76:77], v8 offset:40960
v_mfma_f32_16x16x32_bf16 v[164:167], a[80:83], a[40:43], v[164:167]
s_xor_b32 s64, s72, 17792
ds_read_b64_tr_b16 a[78:79], v8 offset:41984
v_mfma_f32_16x16x32_bf16 v[164:167], a[84:87], a[44:47], v[164:167]
buffer_load_dwordx4 v13, s[48:51], s64 offen lds
v_mfma_f32_16x16x32_bf16 v[156:159], a[84:87], a[36:39], v[156:159]
v_mfma_f32_16x16x32_bf16 v[156:159], a[80:83], a[32:35], v[156:159]
ds_read_b64_tr_b16 a[80:81], v9 offset:32768
v_mfma_f32_16x16x32_bf16 v[24:27], a[88:91], a[32:35], v[24:27]
s_xor_b32 m0, s84, 34816
ds_read_b64_tr_b16 a[82:83], v9 offset:33792
v_mfma_f32_16x16x32_bf16 v[24:27], a[92:95], a[36:39], v[24:27]
s_xor_b32 s64, s72, 132480
ds_read_b64_tr_b16 a[84:85], v9 offset:40960
v_subrev_u32 v5, 0x8000, v5
v_mfma_f32_16x16x32_bf16 v[40:43], a[92:95], a[44:47], v[40:43]
buffer_load_dwordx4 v12, s[48:51], s64 offen lds
v_mfma_f32_16x16x32_bf16 v[40:43], a[88:91], a[40:43], v[40:43]
ds_read_b64_tr_b16 a[86:87], v9 offset:41984
v_mfma_f32_16x16x32_bf16 v[56:59], a[88:91], a[48:51], v[56:59]
v_mfma_f32_16x16x32_bf16 v[56:59], a[92:95], a[52:55], v[56:59]
s_xor_b32 m0, s84, 35840
v_mfma_f32_16x16x32_bf16 v[72:75], a[92:95], a[60:63], v[72:75]
s_waitcnt vmcnt(12)
s_xor_b32 s64, s72, 148864
ds_read_b128 a[0:3], v2 offset:0
v_mfma_f32_16x16x32_bf16 v[72:75], a[88:91], a[56:59], v[72:75]
buffer_load_dwordx4 v13, s[48:51], s64 offen lds
v_mfma_f32_16x16x32_bf16 v[136:139], a[96:99], a[56:59], v[136:139]
ds_read_b128 a[4:7], v3 offset:0
v_mfma_f32_16x16x32_bf16 v[136:139], a[100:103], a[60:63], v[136:139]
ds_read_b128 a[8:11], v2 offset:2048
v_subrev_u32 v6, 0x8000, v6
v_mfma_f32_16x16x32_bf16 v[120:123], a[100:103], a[52:55], v[120:123]
s_xor_b32 m0, s84, 36864
ds_read_b128 a[12:15], v3 offset:2048
v_mfma_f32_16x16x32_bf16 v[120:123], a[96:99], a[48:51], v[120:123]
s_xor_b32 s64, s73, 1408
ds_read_b128 a[16:19], v2 offset:4096
v_mfma_f32_16x16x32_bf16 v[104:107], a[96:99], a[40:43], v[104:107]
buffer_load_dwordx4 v12, s[48:51], s64 offen lds
v_mfma_f32_16x16x32_bf16 v[104:107], a[100:103], a[44:47], v[104:107]
ds_read_b128 a[20:23], v3 offset:4096
v_mfma_f32_16x16x32_bf16 v[88:91], a[100:103], a[36:39], v[88:91]
ds_read_b128 a[24:27], v2 offset:6144
v_mfma_f32_16x16x32_bf16 v[88:91], a[96:99], a[32:35], v[88:91]
s_waitcnt lgkmcnt(7)
s_xor_b32 m0, s84, 37888
ds_read_b128 a[28:31], v3 offset:6144
v_mfma_f32_16x16x32_bf16 v[28:31], a[104:107], a[32:35], v[28:31]
s_xor_b32 s64, s73, 17792
ds_read_b64_tr_b16 a[88:89], v10 offset:32768
v_mfma_f32_16x16x32_bf16 v[28:31], a[108:111], a[36:39], v[28:31]
buffer_load_dwordx4 v13, s[48:51], s64 offen lds
v_mfma_f32_16x16x32_bf16 v[44:47], a[108:111], a[44:47], v[44:47]
ds_read_b64_tr_b16 a[90:91], v10 offset:33792
v_subrev_u32 v7, 0x8000, v7
v_mfma_f32_16x16x32_bf16 v[44:47], a[104:107], a[40:43], v[44:47]
ds_read_b64_tr_b16 a[92:93], v10 offset:40960
v_mfma_f32_16x16x32_bf16 v[60:63], a[104:107], a[48:51], v[60:63]
s_xor_b32 m0, s84, 38912
ds_read_b64_tr_b16 a[94:95], v10 offset:41984
v_mfma_f32_16x16x32_bf16 v[60:63], a[108:111], a[52:55], v[60:63]
s_xor_b32 s64, s73, 132480
ds_read_b64_tr_b16 a[96:97], v11 offset:32768
v_mfma_f32_16x16x32_bf16 v[76:79], a[108:111], a[60:63], v[76:79]
buffer_load_dwordx4 v12, s[48:51], s64 offen lds
v_mfma_f32_16x16x32_bf16 v[76:79], a[104:107], a[56:59], v[76:79]
ds_read_b64_tr_b16 a[98:99], v11 offset:33792
v_mfma_f32_16x16x32_bf16 v[140:143], a[112:115], a[56:59], v[140:143]
s_xor_b32 m0, s84, 39936
ds_read_b64_tr_b16 a[100:101], v11 offset:40960
v_mfma_f32_16x16x32_bf16 v[140:143], a[116:119], a[60:63], v[140:143]
s_xor_b32 s64, s73, 148864
ds_read_b64_tr_b16 a[102:103], v11 offset:41984
v_subrev_u32 v8, 0x8000, v8
v_mfma_f32_16x16x32_bf16 v[124:127], a[116:119], a[52:55], v[124:127]
v_readfirstlane_b32 vcc_lo, v1
s_nop 0
s_cmp_lt_u32 vcc_lo, s81
s_cbranch_scc1 L_spin_1
L_spinbk_2:
v_mfma_f32_16x16x32_bf16 v[124:127], a[112:115], a[48:51], v[124:127]
buffer_load_dwordx4 v13, s[48:51], s64 offen lds
v_mfma_f32_16x16x32_bf16 v[108:111], a[112:115], a[40:43], v[108:111]
v_mfma_f32_16x16x32_bf16 v[108:111], a[116:119], a[44:47], v[108:111]
v_mfma_f32_16x16x32_bf16 v[92:95], a[116:119], a[36:39], v[92:95]
v_subrev_u32 v9, 0x8000, v9
v_subrev_u32 v10, 0x8000, v10
v_mfma_f32_16x16x32_bf16 v[92:95], a[112:115], a[32:35], v[92:95]
v_subrev_u32 v11, 0x8000, v11
v_mfma_f32_16x16x32_bf16 v[32:35], a[72:75], a[32:35], v[32:35]
s_add_u32 s52, s28, 59768832
s_addc_u32 s53, s29, 0
s_mov_b32 s54, 16384
v_mfma_f32_16x16x32_bf16 v[32:35], a[76:79], a[36:39], v[32:35]
v_mfma_f32_16x16x32_bf16 v[48:51], a[76:79], a[44:47], v[48:51]
s_waitcnt lgkmcnt(0)
s_barrier
v_mfma_f32_16x16x32_bf16 v[48:51], a[72:75], a[40:43], v[48:51]
s_xor_b32 m0, s77, 131072
s_add_u32 s65, s79, 31744
ds_read_b64_tr_b16 a[104:105], v19 offset:4096
v_mfma_f32_16x16x32_bf16 v[64:67], a[72:75], a[48:51], v[64:67]
s_xor_b32 s64, s71, 6291456
buffer_store_dwordx4 a[232:235], v16, s[44:47], s65 offen sc1
v_mfma_f32_16x16x32_bf16 v[64:67], a[76:79], a[52:55], v[64:67]
buffer_load_dwordx4 v14, s[56:59], s64 offen lds
v_mfma_f32_16x16x32_bf16 v[80:83], a[76:79], a[60:63], v[80:83]
ds_read_b64_tr_b16 a[106:107], v19 offset:4352
v_mfma_f32_16x16x32_bf16 v[80:83], a[72:75], a[56:59], v[80:83]
ds_read_b64_tr_b16 a[108:109], v19 offset:6144
v_mfma_f32_16x16x32_bf16 v[144:147], a[80:83], a[56:59], v[144:147]
ds_read_b64_tr_b16 a[110:111], v19 offset:6400
v_mfma_f32_16x16x32_bf16 v[144:147], a[84:87], a[60:63], v[144:147]
ds_read_b64_tr_b16 a[112:113], v20 offset:4096
v_mfma_f32_16x16x32_bf16 v[128:131], a[84:87], a[52:55], v[128:131]
ds_read_b64_tr_b16 a[114:115], v20 offset:4352
v_mfma_f32_16x16x32_bf16 v[128:131], a[80:83], a[48:51], v[128:131]
ds_read_b64_tr_b16 a[116:117], v20 offset:6144
v_mfma_f32_16x16x32_bf16 v[112:115], a[80:83], a[40:43], v[112:115]
s_add_u32 m0, s78, 147456
ds_read_b64_tr_b16 a[118:119], v20 offset:6400
v_mfma_f32_16x16x32_bf16 v[112:115], a[84:87], a[44:47], v[112:115]
s_add_u32 s64, s75, 4718592
ds_read_b64_tr_b16 a[72:73], v19 offset:8192
v_mfma_f32_16x16x32_bf16 v[96:99], a[84:87], a[36:39], v[96:99]
buffer_load_dwordx4 v23, s[60:63], s64 offen lds
v_mfma_f32_16x16x32_bf16 v[96:99], a[80:83], a[32:35], v[96:99]
ds_read_b64_tr_b16 a[74:75], v19 offset:8448
v_mfma_f32_16x16x32_bf16 v[36:39], a[88:91], a[32:35], v[36:39]
ds_read_b64_tr_b16 a[76:77], v19 offset:10240
v_mfma_f32_16x16x32_bf16 v[36:39], a[92:95], a[36:39], v[36:39]
ds_read_b64_tr_b16 a[78:79], v19 offset:10496
v_mfma_f32_16x16x32_bf16 v[52:55], a[92:95], a[44:47], v[52:55]
ds_read_b64_tr_b16 a[80:81], v20 offset:8192
v_mfma_f32_16x16x32_bf16 v[52:55], a[88:91], a[40:43], v[52:55]
ds_read_b64_tr_b16 a[82:83], v20 offset:8448
v_mfma_f32_16x16x32_bf16 v[68:71], a[88:91], a[48:51], v[68:71]
ds_read_b64_tr_b16 a[84:85], v20 offset:10240
v_mfma_f32_16x16x32_bf16 v[68:71], a[92:95], a[52:55], v[68:71]
s_xor_b32 m0, s77, 132096
ds_read_b64_tr_b16 a[86:87], v20 offset:10496
v_mfma_f32_16x16x32_bf16 v[84:87], a[92:95], a[60:63], v[84:87]
s_xor_b32 s64, s71, 6324224
v_mfma_f32_16x16x32_bf16 v[84:87], a[88:91], a[56:59], v[84:87]
buffer_load_dwordx4 v14, s[56:59], s64 offen lds
v_mfma_f32_16x16x32_bf16 v[148:151], a[96:99], a[56:59], v[148:151]
ds_read_b64_tr_b16 a[88:89], v19 offset:0
v_mfma_f32_16x16x32_bf16 v[148:151], a[100:103], a[60:63], v[148:151]
ds_read_b64_tr_b16 a[90:91], v19 offset:256
v_mfma_f32_16x16x32_bf16 v[132:135], a[100:103], a[52:55], v[132:135]
ds_read_b64_tr_b16 a[92:93], v19 offset:2048
v_mfma_f32_16x16x32_bf16 v[132:135], a[96:99], a[48:51], v[132:135]
ds_read_b64_tr_b16 a[94:95], v19 offset:2304
v_mfma_f32_16x16x32_bf16 v[116:119], a[96:99], a[40:43], v[116:119]
v_mfma_f32_16x16x32_bf16 v[116:119], a[100:103], a[44:47], v[116:119]
v_mfma_f32_16x16x32_bf16 v[100:103], a[100:103], a[36:39], v[100:103]
s_add_u32 m0, s78, 151552
v_mfma_f32_16x16x32_bf16 v[100:103], a[96:99], a[32:35], v[100:103]
s_waitcnt lgkmcnt(4)
s_add_u32 s64, s75, 4720640
ds_read_b64_tr_b16 a[96:97], v20 offset:0
v_mfma_f32_16x16x32_bf16 v[184:187], a[104:107], a[0:3], v[184:187]
buffer_load_dwordx4 v23, s[60:63], s64 offen lds
v_mfma_f32_16x16x32_bf16 v[184:187], a[108:111], a[4:7], v[184:187]
ds_read_b64_tr_b16 a[98:99], v20 offset:256
v_mfma_f32_16x16x32_bf16 v[192:195], a[108:111], a[12:15], v[192:195]
ds_read_b64_tr_b16 a[100:101], v20 offset:2048
v_mfma_f32_16x16x32_bf16 v[192:195], a[104:107], a[8:11], v[192:195]
ds_read_b64_tr_b16 a[102:103], v20 offset:2304
v_mfma_f32_16x16x32_bf16 v[200:203], a[104:107], a[16:19], v[200:203]
v_mfma_f32_16x16x32_bf16 v[200:203], a[108:111], a[20:23], v[200:203]
v_mfma_f32_16x16x32_bf16 v[208:211], a[108:111], a[28:31], v[208:211]
v_mfma_f32_16x16x32_bf16 v[208:211], a[104:107], a[24:27], v[208:211]
ds_read_b64_tr_b16 a[104:105], v4 offset:0
v_mfma_f32_16x16x32_bf16 v[212:215], a[112:115], a[24:27], v[212:215]
s_xor_b32 m0, s77, 133120
ds_read_b64_tr_b16 a[106:107], v4 offset:1024
v_mfma_f32_16x16x32_bf16 v[212:215], a[116:119], a[28:31], v[212:215]
s_xor_b32 s64, s71, 6356992
ds_read_b64_tr_b16 a[108:109], v4 offset:8192
v_mfma_f32_16x16x32_bf16 v[204:207], a[116:119], a[20:23], v[204:207]
buffer_load_dwordx4 v15, s[56:59], s64 offen lds
v_mfma_f32_16x16x32_bf16 v[204:207], a[112:115], a[16:19], v[204:207]
ds_read_b64_tr_b16 a[110:111], v4 offset:9216
v_mfma_f32_16x16x32_bf16 v[196:199], a[112:115], a[8:11], v[196:199]
v_mfma_f32_16x16x32_bf16 v[196:199], a[116:119], a[12:15], v[196:199]
v_mfma_f32_16x16x32_bf16 v[188:191], a[116:119], a[4:7], v[188:191]
v_mfma_f32_16x16x32_bf16 v[188:191], a[112:115], a[0:3], v[188:191]
ds_read_b64_tr_b16 a[112:113], v5 offset:0
v_mfma_f32_16x16x32_bf16 v[216:219], a[0:3], a[72:75], v[216:219]
s_add_u32 s65, s79, 15360
ds_read_b64_tr_b16 a[114:115], v5 offset:1024
v_mfma_f32_16x16x32_bf16 v[216:219], a[4:7], a[76:79], v[216:219]
s_add_u32 m0, s78, 155648
buffer_store_dwordx4 a[236:239], v16, s[44:47], s65 offen sc1
v_mfma_f32_16x16x32_bf16 v[224:227], a[12:15], a[76:79], v[224:227]
s_add_u32 s64, s75, 4722688
ds_read_b64_tr_b16 a[116:117], v5 offset:8192
v_mfma_f32_16x16x32_bf16 v[224:227], a[8:11], a[72:75], v[224:227]
buffer_load_dwordx4 v23, s[60:63], s64 offen lds
v_mfma_f32_16x16x32_bf16 v[232:235], a[16:19], a[72:75], v[232:235]
ds_read_b64_tr_b16 a[118:119], v5 offset:9216
v_mfma_f32_16x16x32_bf16 v[232:235], a[20:23], a[76:79], v[232:235]
v_mfma_f32_16x16x32_bf16 v[240:243], a[28:31], a[76:79], v[240:243]
v_mfma_f32_16x16x32_bf16 v[240:243], a[24:27], a[72:75], v[240:243]
ds_read_b64_tr_b16 a[72:73], v6 offset:0
v_mfma_f32_16x16x32_bf16 v[244:247], a[24:27], a[80:83], v[244:247]
ds_read_b64_tr_b16 a[74:75], v6 offset:1024
v_mfma_f32_16x16x32_bf16 v[244:247], a[28:31], a[84:87], v[244:247]
ds_read_b64_tr_b16 a[76:77], v6 offset:8192
v_mfma_f32_16x16x32_bf16 v[236:239], a[20:23], a[84:87], v[236:239]
s_xor_b32 m0, s77, 134144
ds_read_b64_tr_b16 a[78:79], v6 offset:9216
v_mfma_f32_16x16x32_bf16 v[236:239], a[16:19], a[80:83], v[236:239]
s_xor_b32 s64, s71, 6389760
v_mfma_f32_16x16x32_bf16 v[228:231], a[8:11], a[80:83], v[228:231]
buffer_load_dwordx4 v15, s[56:59], s64 offen lds
v_mfma_f32_16x16x32_bf16 v[228:231], a[12:15], a[84:87], v[228:231]
v_mfma_f32_16x16x32_bf16 v[220:223], a[4:7], a[84:87], v[220:223]
v_mfma_f32_16x16x32_bf16 v[220:223], a[0:3], a[80:83], v[220:223]
s_waitcnt lgkmcnt(4)
ds_read_b64_tr_b16 a[80:81], v7 offset:0
v_mfma_f32_16x16x32_bf16 v[152:155], a[88:91], a[0:3], v[152:155]
ds_read_b64_tr_b16 a[82:83], v7 offset:1024
v_mfma_f32_16x16x32_bf16 v[152:155], a[92:95], a[4:7], v[152:155]
ds_read_b64_tr_b16 a[84:85], v7 offset:8192
v_mfma_f32_16x16x32_bf16 v[160:163], a[92:95], a[12:15], v[160:163]
ds_read_b64_tr_b16 a[86:87], v7 offset:9216
v_mfma_f32_16x16x32_bf16 v[160:163], a[88:91], a[8:11], v[160:163]
v_mfma_f32_16x16x32_bf16 v[168:171], a[88:91], a[16:19], v[168:171]
v_mfma_f32_16x16x32_bf16 v[168:171], a[92:95], a[20:23], v[168:171]
s_branch L_po11
L_pg11:
s_branch L_tr1
L_po11:
v_mfma_f32_16x16x32_bf16 v[176:179], a[92:95], a[28:31], v[176:179]
s_xor_b32 m0, s84, 0
v_mfma_f32_16x16x32_bf16 v[176:179], a[88:91], a[24:27], v[176:179]
s_xor_b32 s64, s72, 1536
ds_read_b64_tr_b16 a[88:89], v8 offset:0
v_mfma_f32_16x16x32_bf16 v[180:183], a[96:99], a[24:27], v[180:183]
buffer_load_dwordx4 v12, s[48:51], s64 offen lds
v_mfma_f32_16x16x32_bf16 v[180:183], a[100:103], a[28:31], v[180:183]
ds_read_b64_tr_b16 a[90:91], v8 offset:1024
v_mfma_f32_16x16x32_bf16 v[172:175], a[100:103], a[20:23], v[172:175]
ds_read_b64_tr_b16 a[92:93], v8 offset:8192
v_mfma_f32_16x16x32_bf16 v[172:175], a[96:99], a[16:19], v[172:175]
s_xor_b32 m0, s84, 1024
ds_read_b64_tr_b16 a[94:95], v8 offset:9216
v_mfma_f32_16x16x32_bf16 v[164:167], a[96:99], a[8:11], v[164:167]
s_xor_b32 s64, s72, 17920
v_mfma_f32_16x16x32_bf16 v[164:167], a[100:103], a[12:15], v[164:167]
buffer_load_dwordx4 v13, s[48:51], s64 offen lds
v_mfma_f32_16x16x32_bf16 v[156:159], a[100:103], a[4:7], v[156:159]
v_mfma_f32_16x16x32_bf16 v[156:159], a[96:99], a[0:3], v[156:159]
ds_read_b64_tr_b16 a[96:97], v9 offset:0
v_mfma_f32_16x16x32_bf16 v[24:27], a[104:107], a[0:3], v[24:27]
s_xor_b32 m0, s84, 2048
ds_read_b64_tr_b16 a[98:99], v9 offset:1024
v_mfma_f32_16x16x32_bf16 v[24:27], a[108:111], a[4:7], v[24:27]
s_xor_b32 s64, s72, 132608
ds_read_b64_tr_b16 a[100:101], v9 offset:8192
v_mfma_f32_16x16x32_bf16 v[40:43], a[108:111], a[12:15], v[40:43]
buffer_load_dwordx4 v12, s[48:51], s64 offen lds
v_mfma_f32_16x16x32_bf16 v[40:43], a[104:107], a[8:11], v[40:43]
ds_read_b64_tr_b16 a[102:103], v9 offset:9216
v_mfma_f32_16x16x32_bf16 v[56:59], a[104:107], a[16:19], v[56:59]
v_mfma_f32_16x16x32_bf16 v[56:59], a[108:111], a[20:23], v[56:59]
s_xor_b32 m0, s84, 3072
v_mfma_f32_16x16x32_bf16 v[72:75], a[108:111], a[28:31], v[72:75]
s_waitcnt vmcnt(12)
s_xor_b32 s64, s72, 148992
ds_read_b128 a[32:35], v2 offset:32768
v_mfma_f32_16x16x32_bf16 v[72:75], a[104:107], a[24:27], v[72:75]
buffer_load_dwordx4 v13, s[48:51], s64 offen lds
v_mfma_f32_16x16x32_bf16 v[136:139], a[112:115], a[24:27], v[136:139]
ds_read_b128 a[36:39], v3 offset:32768
v_mfma_f32_16x16x32_bf16 v[136:139], a[116:119], a[28:31], v[136:139]
ds_read_b128 a[40:43], v2 offset:34816
v_mfma_f32_16x16x32_bf16 v[120:123], a[116:119], a[20:23], v[120:123]
s_xor_b32 m0, s84, 4096
ds_read_b128 a[44:47], v3 offset:34816
v_mfma_f32_16x16x32_bf16 v[120:123], a[112:115], a[16:19], v[120:123]
s_xor_b32 s64, s73, 1536
ds_read_b128 a[48:51], v2 offset:36864
v_mfma_f32_16x16x32_bf16 v[104:107], a[112:115], a[8:11], v[104:107]
buffer_load_dwordx4 v12, s[48:51], s64 offen lds
v_mfma_f32_16x16x32_bf16 v[104:107], a[116:119], a[12:15], v[104:107]
ds_read_b128 a[52:55], v3 offset:36864
v_mfma_f32_16x16x32_bf16 v[88:91], a[116:119], a[4:7], v[88:91]
buffer_store_dwordx4 a[240:243], v16, s[44:47], s74 offen sc1
v_mfma_f32_16x16x32_bf16 v[88:91], a[112:115], a[0:3], v[88:91]
s_waitcnt lgkmcnt(6)
s_xor_b32 m0, s84, 5120
ds_read_b128 a[56:59], v2 offset:38912
v_mfma_f32_16x16x32_bf16 v[28:31], a[72:75], a[0:3], v[28:31]
s_xor_b32 s64, s73, 17920
ds_read_b128 a[60:63], v3 offset:38912
v_mfma_f32_16x16x32_bf16 v[28:31], a[76:79], a[4:7], v[28:31]
buffer_load_dwordx4 v13, s[48:51], s64 offen lds
v_mfma_f32_16x16x32_bf16 v[44:47], a[76:79], a[12:15], v[44:47]
ds_read_b64_tr_b16 a[104:105], v10 offset:0
v_mfma_f32_16x16x32_bf16 v[44:47], a[72:75], a[8:11], v[44:47]
ds_read_b64_tr_b16 a[106:107], v10 offset:1024
v_mfma_f32_16x16x32_bf16 v[60:63], a[72:75], a[16:19], v[60:63]
s_xor_b32 m0, s84, 6144
ds_read_b64_tr_b16 a[108:109], v10 offset:8192
v_mfma_f32_16x16x32_bf16 v[60:63], a[76:79], a[20:23], v[60:63]
s_xor_b32 s64, s73, 132608
ds_read_b64_tr_b16 a[110:111], v10 offset:9216
v_mfma_f32_16x16x32_bf16 v[76:79], a[76:79], a[28:31], v[76:79]
buffer_load_dwordx4 v12, s[48:51], s64 offen lds
v_mfma_f32_16x16x32_bf16 v[76:79], a[72:75], a[24:27], v[76:79]
ds_read_b64_tr_b16 a[112:113], v11 offset:0
v_mfma_f32_16x16x32_bf16 v[140:143], a[80:83], a[24:27], v[140:143]
ds_read_b64_tr_b16 a[114:115], v11 offset:1024
v_mfma_f32_16x16x32_bf16 v[140:143], a[84:87], a[28:31], v[140:143]
s_xor_b32 m0, s84, 7168
ds_read_b64_tr_b16 a[116:117], v11 offset:8192
v_mfma_f32_16x16x32_bf16 v[124:127], a[84:87], a[20:23], v[124:127]
s_xor_b32 s64, s73, 148992
ds_read_b64_tr_b16 a[118:119], v11 offset:9216
v_mfma_f32_16x16x32_bf16 v[124:127], a[80:83], a[16:19], v[124:127]
buffer_load_dwordx4 v13, s[48:51], s64 offen lds
v_mfma_f32_16x16x32_bf16 v[108:111], a[80:83], a[8:11], v[108:111]
v_mfma_f32_16x16x32_bf16 v[108:111], a[84:87], a[12:15], v[108:111]
v_mfma_f32_16x16x32_bf16 v[92:95], a[84:87], a[4:7], v[92:95]
v_mfma_f32_16x16x32_bf16 v[92:95], a[80:83], a[0:3], v[92:95]
v_mfma_f32_16x16x32_bf16 v[32:35], a[88:91], a[0:3], v[32:35]
v_mfma_f32_16x16x32_bf16 v[32:35], a[92:95], a[4:7], v[32:35]
v_mfma_f32_16x16x32_bf16 v[48:51], a[92:95], a[12:15], v[48:51]
s_waitcnt lgkmcnt(0)
s_barrier
v_mfma_f32_16x16x32_bf16 v[48:51], a[88:91], a[8:11], v[48:51]
s_xor_b32 m0, s77, 65536
ds_read_b64_tr_b16 a[72:73], v19 offset:36864
v_mfma_f32_16x16x32_bf16 v[64:67], a[88:91], a[16:19], v[64:67]
s_xor_b32 s64, s71, 6815744
ds_read_b64_tr_b16 a[74:75], v19 offset:37120
v_mfma_f32_16x16x32_bf16 v[64:67], a[92:95], a[20:23], v[64:67]
buffer_load_dwordx4 v14, s[56:59], s64 offen lds
v_mfma_f32_16x16x32_bf16 v[80:83], a[92:95], a[28:31], v[80:83]
ds_read_b64_tr_b16 a[76:77], v19 offset:38912
v_mfma_f32_16x16x32_bf16 v[80:83], a[88:91], a[24:27], v[80:83]
ds_read_b64_tr_b16 a[78:79], v19 offset:39168
v_mfma_f32_16x16x32_bf16 v[144:147], a[96:99], a[24:27], v[144:147]
ds_read_b64_tr_b16 a[80:81], v20 offset:36864
v_mfma_f32_16x16x32_bf16 v[144:147], a[100:103], a[28:31], v[144:147]
ds_read_b64_tr_b16 a[82:83], v20 offset:37120
v_mfma_f32_16x16x32_bf16 v[128:131], a[100:103], a[20:23], v[128:131]
ds_read_b64_tr_b16 a[84:85], v20 offset:38912
v_mfma_f32_16x16x32_bf16 v[128:131], a[96:99], a[16:19], v[128:131]
ds_read_b64_tr_b16 a[86:87], v20 offset:39168
v_mfma_f32_16x16x32_bf16 v[112:115], a[96:99], a[8:11], v[112:115]
s_add_u32 m0, s78, 81920
ds_read_b64_tr_b16 a[88:89], v19 offset:40960
v_mfma_f32_16x16x32_bf16 v[112:115], a[100:103], a[12:15], v[112:115]
s_add_u32 s64, s75, 5111808
ds_read_b64_tr_b16 a[90:91], v19 offset:41216
v_mfma_f32_16x16x32_bf16 v[96:99], a[100:103], a[4:7], v[96:99]
buffer_load_dwordx4 v23, s[60:63], s64 offen lds
v_mfma_f32_16x16x32_bf16 v[96:99], a[96:99], a[0:3], v[96:99]
ds_read_b64_tr_b16 a[92:93], v19 offset:43008
v_mfma_f32_16x16x32_bf16 v[36:39], a[104:107], a[0:3], v[36:39]
ds_read_b64_tr_b16 a[94:95], v19 offset:43264
v_mfma_f32_16x16x32_bf16 v[36:39], a[108:111], a[4:7], v[36:39]
ds_read_b64_tr_b16 a[96:97], v20 offset:40960
v_mfma_f32_16x16x32_bf16 v[52:55], a[108:111], a[12:15], v[52:55]
ds_read_b64_tr_b16 a[98:99], v20 offset:41216
v_mfma_f32_16x16x32_bf16 v[52:55], a[104:107], a[8:11], v[52:55]
ds_read_b64_tr_b16 a[100:101], v20 offset:43008
v_mfma_f32_16x16x32_bf16 v[68:71], a[104:107], a[16:19], v[68:71]
ds_read_b64_tr_b16 a[102:103], v20 offset:43264
v_mfma_f32_16x16x32_bf16 v[68:71], a[108:111], a[20:23], v[68:71]
s_xor_b32 m0, s77, 66560
v_mfma_f32_16x16x32_bf16 v[84:87], a[108:111], a[28:31], v[84:87]
s_xor_b32 s64, s71, 6848512
v_mfma_f32_16x16x32_bf16 v[84:87], a[104:107], a[24:27], v[84:87]
buffer_load_dwordx4 v14, s[56:59], s64 offen lds
v_mfma_f32_16x16x32_bf16 v[148:151], a[112:115], a[24:27], v[148:151]
ds_read_b64_tr_b16 a[104:105], v19 offset:32768
v_mfma_f32_16x16x32_bf16 v[148:151], a[116:119], a[28:31], v[148:151]
ds_read_b64_tr_b16 a[106:107], v19 offset:33024
v_mfma_f32_16x16x32_bf16 v[132:135], a[116:119], a[20:23], v[132:135]
ds_read_b64_tr_b16 a[108:109], v19 offset:34816
v_mfma_f32_16x16x32_bf16 v[132:135], a[112:115], a[16:19], v[132:135]
ds_read_b64_tr_b16 a[110:111], v19 offset:35072
v_mfma_f32_16x16x32_bf16 v[116:119], a[112:115], a[8:11], v[116:119]
v_mfma_f32_16x16x32_bf16 v[116:119], a[116:119], a[12:15], v[116:119]
v_mfma_f32_16x16x32_bf16 v[100:103], a[116:119], a[4:7], v[100:103]
s_add_u32 m0, s78, 86016
v_mfma_f32_16x16x32_bf16 v[100:103], a[112:115], a[0:3], v[100:103]
s_waitcnt lgkmcnt(4)
s_add_u32 s64, s75, 5113856
ds_read_b64_tr_b16 a[112:113], v20 offset:32768
v_mfma_f32_16x16x32_bf16 v[184:187], a[72:75], a[32:35], v[184:187]
s_lshl_b32 s66, s30, 30
buffer_load_dwordx4 v23, s[60:63], s64 offen lds
v_mfma_f32_16x16x32_bf16 v[184:187], a[76:79], a[36:39], v[184:187]
ds_read_b64_tr_b16 a[114:115], v20 offset:33024
v_lshl_add_u32 v1, v0, 24, s66
v_mfma_f32_16x16x32_bf16 v[192:195], a[76:79], a[44:47], v[192:195]
s_lshl_b32 s70, s31, 8
ds_read_b64_tr_b16 a[116:117], v20 offset:34816
v_mfma_f32_16x16x32_bf16 v[192:195], a[72:75], a[40:43], v[192:195]
ds_read_b64_tr_b16 a[118:119], v20 offset:35072
v_mfma_f32_16x16x32_bf16 v[200:203], a[72:75], a[48:51], v[200:203]
v_mfma_f32_16x16x32_bf16 v[200:203], a[76:79], a[52:55], v[200:203]
v_mfma_f32_16x16x32_bf16 v[208:211], a[76:79], a[60:63], v[208:211]
v_mfma_f32_16x16x32_bf16 v[208:211], a[72:75], a[56:59], v[208:211]
ds_read_b64_tr_b16 a[72:73], v4 offset:32768
v_mfma_f32_16x16x32_bf16 v[212:215], a[80:83], a[56:59], v[212:215]
s_xor_b32 m0, s77, 67584
ds_read_b64_tr_b16 a[74:75], v4 offset:33792
v_mfma_f32_16x16x32_bf16 v[212:215], a[84:87], a[60:63], v[212:215]
s_xor_b32 s64, s71, 6881280
ds_read_b64_tr_b16 a[76:77], v4 offset:40960
v_mfma_f32_16x16x32_bf16 v[204:207], a[84:87], a[52:55], v[204:207]
buffer_load_dwordx4 v15, s[56:59], s64 offen lds
v_mfma_f32_16x16x32_bf16 v[204:207], a[80:83], a[48:51], v[204:207]
ds_read_b64_tr_b16 a[78:79], v4 offset:41984
v_mfma_f32_16x16x32_bf16 v[196:199], a[80:83], a[40:43], v[196:199]
v_mfma_f32_16x16x32_bf16 v[196:199], a[84:87], a[44:47], v[196:199]
v_mfma_f32_16x16x32_bf16 v[188:191], a[84:87], a[36:39], v[188:191]
v_mfma_f32_16x16x32_bf16 v[188:191], a[80:83], a[32:35], v[188:191]
ds_read_b64_tr_b16 a[80:81], v5 offset:32768
v_mfma_f32_16x16x32_bf16 v[216:219], a[32:35], a[88:91], v[216:219]
ds_read_b64_tr_b16 a[82:83], v5 offset:33792
v_mfma_f32_16x16x32_bf16 v[216:219], a[36:39], a[92:95], v[216:219]
s_add_u32 m0, s78, 90112
ds_read_b64_tr_b16 a[84:85], v5 offset:40960
v_mfma_f32_16x16x32_bf16 v[224:227], a[44:47], a[92:95], v[224:227]
s_add_u32 s64, s75, 5115904
ds_read_b64_tr_b16 a[86:87], v5 offset:41984
v_mfma_f32_16x16x32_bf16 v[224:227], a[40:43], a[88:91], v[224:227]
buffer_load_dwordx4 v23, s[60:63], s64 offen lds
v_mfma_f32_16x16x32_bf16 v[232:235], a[48:51], a[88:91], v[232:235]
v_mfma_f32_16x16x32_bf16 v[232:235], a[52:55], a[92:95], v[232:235]
v_mfma_f32_16x16x32_bf16 v[240:243], a[60:63], a[92:95], v[240:243]
v_mfma_f32_16x16x32_bf16 v[240:243], a[56:59], a[88:91], v[240:243]
ds_read_b64_tr_b16 a[88:89], v6 offset:32768
v_mfma_f32_16x16x32_bf16 v[244:247], a[56:59], a[96:99], v[244:247]
ds_read_b64_tr_b16 a[90:91], v6 offset:33792
v_mfma_f32_16x16x32_bf16 v[244:247], a[60:63], a[100:103], v[244:247]
ds_read_b64_tr_b16 a[92:93], v6 offset:40960
v_add_u32 v19, 0x8000, v19
v_mfma_f32_16x16x32_bf16 v[236:239], a[52:55], a[100:103], v[236:239]
s_xor_b32 m0, s77, 68608
ds_read_b64_tr_b16 a[94:95], v6 offset:41984
v_mfma_f32_16x16x32_bf16 v[236:239], a[48:51], a[96:99], v[236:239]
s_xor_b32 s64, s71, 6914048
v_mfma_f32_16x16x32_bf16 v[228:231], a[40:43], a[96:99], v[228:231]
buffer_load_dwordx4 v15, s[56:59], s64 offen lds
v_mfma_f32_16x16x32_bf16 v[228:231], a[44:47], a[100:103], v[228:231]
v_mfma_f32_16x16x32_bf16 v[220:223], a[36:39], a[100:103], v[220:223]
v_mfma_f32_16x16x32_bf16 v[220:223], a[32:35], a[96:99], v[220:223]
s_waitcnt lgkmcnt(4)
ds_read_b64_tr_b16 a[96:97], v7 offset:32768
v_mfma_f32_16x16x32_bf16 v[152:155], a[104:107], a[32:35], v[152:155]
ds_read_b64_tr_b16 a[98:99], v7 offset:33792
v_mfma_f32_16x16x32_bf16 v[152:155], a[108:111], a[36:39], v[152:155]
ds_read_b64_tr_b16 a[100:101], v7 offset:40960
v_add_u32 v20, 0x8000, v20
v_mfma_f32_16x16x32_bf16 v[160:163], a[108:111], a[44:47], v[160:163]
ds_read_b64_tr_b16 a[102:103], v7 offset:41984
v_mfma_f32_16x16x32_bf16 v[160:163], a[104:107], a[40:43], v[160:163]
v_mfma_f32_16x16x32_bf16 v[168:171], a[104:107], a[48:51], v[168:171]
v_mfma_f32_16x16x32_bf16 v[168:171], a[108:111], a[52:55], v[168:171]
v_mfma_f32_16x16x32_bf16 v[176:179], a[108:111], a[60:63], v[176:179]
s_xor_b32 m0, s84, 32768
v_mfma_f32_16x16x32_bf16 v[176:179], a[104:107], a[56:59], v[176:179]
s_xor_b32 s64, s72, 1664
ds_read_b64_tr_b16 a[104:105], v8 offset:32768
v_mfma_f32_16x16x32_bf16 v[180:183], a[112:115], a[56:59], v[180:183]
buffer_load_dwordx4 v12, s[48:51], s64 offen lds
v_mfma_f32_16x16x32_bf16 v[180:183], a[116:119], a[60:63], v[180:183]
ds_read_b64_tr_b16 a[106:107], v8 offset:33792
v_add_u32 v4, 0x8000, v4
v_mfma_f32_16x16x32_bf16 v[172:175], a[116:119], a[52:55], v[172:175]
ds_read_b64_tr_b16 a[108:109], v8 offset:40960
v_mfma_f32_16x16x32_bf16 v[172:175], a[112:115], a[48:51], v[172:175]
s_xor_b32 m0, s84, 33792
ds_read_b64_tr_b16 a[110:111], v8 offset:41984
v_mfma_f32_16x16x32_bf16 v[164:167], a[112:115], a[40:43], v[164:167]
s_xor_b32 s64, s72, 18048
v_mfma_f32_16x16x32_bf16 v[164:167], a[116:119], a[44:47], v[164:167]
buffer_load_dwordx4 v13, s[48:51], s64 offen lds
v_mfma_f32_16x16x32_bf16 v[156:159], a[116:119], a[36:39], v[156:159]
v_mfma_f32_16x16x32_bf16 v[156:159], a[112:115], a[32:35], v[156:159]
ds_read_b64_tr_b16 a[112:113], v9 offset:32768
v_mfma_f32_16x16x32_bf16 v[24:27], a[72:75], a[32:35], v[24:27]
s_xor_b32 m0, s84, 34816
ds_read_b64_tr_b16 a[114:115], v9 offset:33792
v_mfma_f32_16x16x32_bf16 v[24:27], a[76:79], a[36:39], v[24:27]
s_xor_b32 s64, s72, 132736
ds_read_b64_tr_b16 a[116:117], v9 offset:40960
v_add_u32 v5, 0x8000, v5
v_mfma_f32_16x16x32_bf16 v[40:43], a[76:79], a[44:47], v[40:43]
buffer_load_dwordx4 v12, s[48:51], s64 offen lds
v_mfma_f32_16x16x32_bf16 v[40:43], a[72:75], a[40:43], v[40:43]
ds_read_b64_tr_b16 a[118:119], v9 offset:41984
v_mfma_f32_16x16x32_bf16 v[56:59], a[72:75], a[48:51], v[56:59]
v_mfma_f32_16x16x32_bf16 v[56:59], a[76:79], a[52:55], v[56:59]
s_xor_b32 m0, s84, 35840
v_mfma_f32_16x16x32_bf16 v[72:75], a[76:79], a[60:63], v[72:75]
s_waitcnt vmcnt(10)
s_xor_b32 s64, s72, 149120
ds_read_b128 a[0:3], v2 offset:0
v_mfma_f32_16x16x32_bf16 v[72:75], a[72:75], a[56:59], v[72:75]
buffer_load_dwordx4 v13, s[48:51], s64 offen lds
v_mfma_f32_16x16x32_bf16 v[136:139], a[80:83], a[56:59], v[136:139]
ds_read_b128 a[4:7], v3 offset:0
v_mfma_f32_16x16x32_bf16 v[136:139], a[84:87], a[60:63], v[136:139]
ds_read_b128 a[8:11], v2 offset:2048
v_add_u32 v6, 0x8000, v6
v_mfma_f32_16x16x32_bf16 v[120:123], a[84:87], a[52:55], v[120:123]
s_xor_b32 m0, s84, 36864
ds_read_b128 a[12:15], v3 offset:2048
v_mfma_f32_16x16x32_bf16 v[120:123], a[80:83], a[48:51], v[120:123]
s_xor_b32 s64, s73, 1664
ds_read_b128 a[16:19], v2 offset:4096
v_mfma_f32_16x16x32_bf16 v[104:107], a[80:83], a[40:43], v[104:107]
buffer_load_dwordx4 v12, s[48:51], s64 offen lds
v_mfma_f32_16x16x32_bf16 v[104:107], a[84:87], a[44:47], v[104:107]
ds_read_b128 a[20:23], v3 offset:4096
v_mfma_f32_16x16x32_bf16 v[88:91], a[84:87], a[36:39], v[88:91]
ds_read_b128 a[24:27], v2 offset:6144
v_mfma_f32_16x16x32_bf16 v[88:91], a[80:83], a[32:35], v[88:91]
s_waitcnt lgkmcnt(7)
s_xor_b32 m0, s84, 37888
ds_read_b128 a[28:31], v3 offset:6144
v_mfma_f32_16x16x32_bf16 v[28:31], a[88:91], a[32:35], v[28:31]
s_xor_b32 s64, s73, 18048
ds_read_b64_tr_b16 a[72:73], v10 offset:32768
v_mfma_f32_16x16x32_bf16 v[28:31], a[92:95], a[36:39], v[28:31]
buffer_load_dwordx4 v13, s[48:51], s64 offen lds
v_mfma_f32_16x16x32_bf16 v[44:47], a[92:95], a[44:47], v[44:47]
ds_read_b64_tr_b16 a[74:75], v10 offset:33792
v_add_u32 v7, 0x8000, v7
v_mfma_f32_16x16x32_bf16 v[44:47], a[88:91], a[40:43], v[44:47]
ds_read_b64_tr_b16 a[76:77], v10 offset:40960
v_mfma_f32_16x16x32_bf16 v[60:63], a[88:91], a[48:51], v[60:63]
s_xor_b32 m0, s84, 38912
ds_read_b64_tr_b16 a[78:79], v10 offset:41984
v_mfma_f32_16x16x32_bf16 v[60:63], a[92:95], a[52:55], v[60:63]
s_xor_b32 s64, s73, 132736
ds_read_b64_tr_b16 a[80:81], v11 offset:32768
v_mfma_f32_16x16x32_bf16 v[76:79], a[92:95], a[60:63], v[76:79]
buffer_load_dwordx4 v12, s[48:51], s64 offen lds
v_mfma_f32_16x16x32_bf16 v[76:79], a[88:91], a[56:59], v[76:79]
ds_read_b64_tr_b16 a[82:83], v11 offset:33792
v_mfma_f32_16x16x32_bf16 v[140:143], a[96:99], a[56:59], v[140:143]
ds_read_b64_tr_b16 a[84:85], v11 offset:40960
v_lshrrev_b32 v22, 2, v0
v_mfma_f32_16x16x32_bf16 v[140:143], a[100:103], a[60:63], v[140:143]
s_xor_b32 m0, s84, 39936
ds_read_b64_tr_b16 a[86:87], v11 offset:41984
v_add_u32 v8, 0x8000, v8
v_mfma_f32_16x16x32_bf16 v[124:127], a[100:103], a[52:55], v[124:127]
s_xor_b32 s64, s73, 149120
v_mul_u32_u24 v22, 3584, v22
v_lshl_add_u32 v22, v0, 7, v22
v_mfma_f32_16x16x32_bf16 v[124:127], a[96:99], a[48:51], v[124:127]
buffer_load_dwordx4 v13, s[48:51], s64 offen lds
v_mfma_f32_16x16x32_bf16 v[108:111], a[96:99], a[40:43], v[108:111]
v_mfma_f32_16x16x32_bf16 v[108:111], a[100:103], a[44:47], v[108:111]
v_mfma_f32_16x16x32_bf16 v[92:95], a[100:103], a[36:39], v[92:95]
v_add_u32 v9, 0x8000, v9
v_add_u32 v10, 0x8000, v10
v_mfma_f32_16x16x32_bf16 v[92:95], a[96:99], a[32:35], v[92:95]
v_add_u32 v11, 0x8000, v11
v_mfma_f32_16x16x32_bf16 v[32:35], a[104:107], a[32:35], v[32:35]
v_mfma_f32_16x16x32_bf16 v[32:35], a[108:111], a[36:39], v[32:35]
v_mfma_f32_16x16x32_bf16 v[48:51], a[108:111], a[44:47], v[48:51]
s_waitcnt lgkmcnt(0)
s_barrier
v_mfma_f32_16x16x32_bf16 v[48:51], a[104:107], a[40:43], v[48:51]
s_mov_b64 exec, 1
buffer_atomic_add a251, v1, s[52:55], s70 offen offset:0 sc1
s_mov_b64 exec, -1
s_xor_b32 m0, s77, 98304
v_mfma_f32_16x16x32_bf16 v[64:67], a[104:107], a[48:51], v[64:67]
s_lshl4_add_u32 s70, s78, s70
s_xor_b32 s64, s71, 7340032
ds_read_b64_tr_b16 a[88:89], v19 offset:36864
v_mfma_f32_16x16x32_bf16 v[64:67], a[108:111], a[52:55], v[64:67]
s_lshr_b32 s81, s81, 5
buffer_load_dwordx4 v14, s[56:59], s64 offen lds
v_mfma_f32_16x16x32_bf16 v[80:83], a[108:111], a[60:63], v[80:83]
ds_read_b64_tr_b16 a[90:91], v19 offset:37120
v_mfma_f32_16x16x32_bf16 v[80:83], a[104:107], a[56:59], v[80:83]
ds_read_b64_tr_b16 a[92:93], v19 offset:38912
v_mfma_f32_16x16x32_bf16 v[144:147], a[112:115], a[56:59], v[144:147]
ds_read_b64_tr_b16 a[94:95], v19 offset:39168
v_mfma_f32_16x16x32_bf16 v[144:147], a[116:119], a[60:63], v[144:147]
ds_read_b64_tr_b16 a[96:97], v20 offset:36864
v_mfma_f32_16x16x32_bf16 v[128:131], a[116:119], a[52:55], v[128:131]
ds_read_b64_tr_b16 a[98:99], v20 offset:37120
v_mfma_f32_16x16x32_bf16 v[128:131], a[112:115], a[48:51], v[128:131]
ds_read_b64_tr_b16 a[100:101], v20 offset:38912
v_mfma_f32_16x16x32_bf16 v[112:115], a[112:115], a[40:43], v[112:115]
s_add_u32 m0, s78, 114688
ds_read_b64_tr_b16 a[102:103], v20 offset:39168
v_mfma_f32_16x16x32_bf16 v[112:115], a[116:119], a[44:47], v[112:115]
s_add_u32 s64, s75, 5505024
ds_read_b64_tr_b16 a[104:105], v19 offset:40960
v_mfma_f32_16x16x32_bf16 v[96:99], a[116:119], a[36:39], v[96:99]
buffer_load_dwordx4 v23, s[60:63], s64 offen lds
v_mfma_f32_16x16x32_bf16 v[96:99], a[112:115], a[32:35], v[96:99]
ds_read_b64_tr_b16 a[106:107], v19 offset:41216
v_mfma_f32_16x16x32_bf16 v[36:39], a[72:75], a[32:35], v[36:39]
ds_read_b64_tr_b16 a[108:109], v19 offset:43008
v_mfma_f32_16x16x32_bf16 v[36:39], a[76:79], a[36:39], v[36:39]
ds_read_b64_tr_b16 a[110:111], v19 offset:43264
v_mfma_f32_16x16x32_bf16 v[52:55], a[76:79], a[44:47], v[52:55]
ds_read_b64_tr_b16 a[112:113], v20 offset:40960
v_mfma_f32_16x16x32_bf16 v[52:55], a[72:75], a[40:43], v[52:55]
ds_read_b64_tr_b16 a[114:115], v20 offset:41216
v_mfma_f32_16x16x32_bf16 v[68:71], a[72:75], a[48:51], v[68:71]
s_lshr_b32 s17, s78, 1
ds_read_b64_tr_b16 a[116:117], v20 offset:43008
v_mfma_f32_16x16x32_bf16 v[68:71], a[76:79], a[52:55], v[68:71]
s_xor_b32 m0, s77, 99328
s_add_u32 s17, s17, L_base-L_pc-4+53248
ds_read_b64_tr_b16 a[118:119], v20 offset:43264
v_mfma_f32_16x16x32_bf16 v[84:87], a[76:79], a[60:63], v[84:87]
s_xor_b32 s64, s71, 7372800
buffer_load_dword a252, v22, s[88:91], s17 offen
v_mfma_f32_16x16x32_bf16 v[84:87], a[72:75], a[56:59], v[84:87]
buffer_load_dwordx4 v14, s[56:59], s64 offen lds
v_mfma_f32_16x16x32_bf16 v[148:151], a[80:83], a[56:59], v[148:151]
ds_read_b64_tr_b16 a[72:73], v19 offset:32768
v_mfma_f32_16x16x32_bf16 v[148:151], a[84:87], a[60:63], v[148:151]
ds_read_b64_tr_b16 a[74:75], v19 offset:33024
v_mfma_f32_16x16x32_bf16 v[132:135], a[84:87], a[52:55], v[132:135]
ds_read_b64_tr_b16 a[76:77], v19 offset:34816
v_mfma_f32_16x16x32_bf16 v[132:135], a[80:83], a[48:51], v[132:135]
ds_read_b64_tr_b16 a[78:79], v19 offset:35072
v_mfma_f32_16x16x32_bf16 v[116:119], a[80:83], a[40:43], v[116:119]
v_mfma_f32_16x16x32_bf16 v[116:119], a[84:87], a[44:47], v[116:119]
v_mfma_f32_16x16x32_bf16 v[100:103], a[84:87], a[36:39], v[100:103]
s_add_u32 m0, s78, 118784
v_mfma_f32_16x16x32_bf16 v[100:103], a[80:83], a[32:35], v[100:103]
s_waitcnt lgkmcnt(4)
s_add_u32 s64, s75, 5507072
ds_read_b64_tr_b16 a[80:81], v20 offset:32768
v_mfma_f32_16x16x32_bf16 v[184:187], a[88:91], a[0:3], v[184:187]
buffer_load_dwordx4 v23, s[60:63], s64 offen lds
v_mfma_f32_16x16x32_bf16 v[184:187], a[92:95], a[4:7], v[184:187]
ds_read_b64_tr_b16 a[82:83], v20 offset:33024
v_mfma_f32_16x16x32_bf16 v[192:195], a[92:95], a[12:15], v[192:195]
ds_read_b64_tr_b16 a[84:85], v20 offset:34816
v_mfma_f32_16x16x32_bf16 v[192:195], a[88:91], a[8:11], v[192:195]
ds_read_b64_tr_b16 a[86:87], v20 offset:35072
v_mfma_f32_16x16x32_bf16 v[200:203], a[88:91], a[16:19], v[200:203]
v_mfma_f32_16x16x32_bf16 v[200:203], a[92:95], a[20:23], v[200:203]
v_mfma_f32_16x16x32_bf16 v[208:211], a[92:95], a[28:31], v[208:211]
v_mfma_f32_16x16x32_bf16 v[208:211], a[88:91], a[24:27], v[208:211]
ds_read_b64_tr_b16 a[88:89], v4 offset:32768
v_mfma_f32_16x16x32_bf16 v[212:215], a[96:99], a[24:27], v[212:215]
s_xor_b32 m0, s77, 100352
ds_read_b64_tr_b16 a[90:91], v4 offset:33792
v_mfma_f32_16x16x32_bf16 v[212:215], a[100:103], a[28:31], v[212:215]
s_xor_b32 s64, s71, 7405568
ds_read_b64_tr_b16 a[92:93], v4 offset:40960
v_mfma_f32_16x16x32_bf16 v[204:207], a[100:103], a[20:23], v[204:207]
buffer_load_dwordx4 v15, s[56:59], s64 offen lds
v_mfma_f32_16x16x32_bf16 v[204:207], a[96:99], a[16:19], v[204:207]
ds_read_b64_tr_b16 a[94:95], v4 offset:41984
v_mfma_f32_16x16x32_bf16 v[196:199], a[96:99], a[8:11], v[196:199]
v_mfma_f32_16x16x32_bf16 v[196:199], a[100:103], a[12:15], v[196:199]
v_mfma_f32_16x16x32_bf16 v[188:191], a[100:103], a[4:7], v[188:191]
v_mfma_f32_16x16x32_bf16 v[188:191], a[96:99], a[0:3], v[188:191]
ds_read_b64_tr_b16 a[96:97], v5 offset:32768
v_mfma_f32_16x16x32_bf16 v[216:219], a[0:3], a[104:107], v[216:219]
ds_read_b64_tr_b16 a[98:99], v5 offset:33792
v_mfma_f32_16x16x32_bf16 v[216:219], a[4:7], a[108:111], v[216:219]
s_add_u32 m0, s78, 122880
ds_read_b64_tr_b16 a[100:101], v5 offset:40960
v_mfma_f32_16x16x32_bf16 v[224:227], a[12:15], a[108:111], v[224:227]
s_add_u32 s64, s75, 5509120
ds_read_b64_tr_b16 a[102:103], v5 offset:41984
v_mfma_f32_16x16x32_bf16 v[224:227], a[8:11], a[104:107], v[224:227]
buffer_load_dwordx4 v23, s[60:63], s64 offen lds
v_mfma_f32_16x16x32_bf16 v[232:235], a[16:19], a[104:107], v[232:235]
v_mfma_f32_16x16x32_bf16 v[232:235], a[20:23], a[108:111], v[232:235]
v_mfma_f32_16x16x32_bf16 v[240:243], a[28:31], a[108:111], v[240:243]
v_mfma_f32_16x16x32_bf16 v[240:243], a[24:27], a[104:107], v[240:243]
ds_read_b64_tr_b16 a[104:105], v6 offset:32768
v_mfma_f32_16x16x32_bf16 v[244:247], a[24:27], a[112:115], v[244:247]
ds_read_b64_tr_b16 a[106:107], v6 offset:33792
v_mfma_f32_16x16x32_bf16 v[244:247], a[28:31], a[116:119], v[244:247]
ds_read_b64_tr_b16 a[108:109], v6 offset:40960
v_subrev_u32 v19, 0x8000, v19
v_mfma_f32_16x16x32_bf16 v[236:239], a[20:23], a[116:119], v[236:239]
s_xor_b32 m0, s77, 101376
ds_read_b64_tr_b16 a[110:111], v6 offset:41984
v_mfma_f32_16x16x32_bf16 v[236:239], a[16:19], a[112:115], v[236:239]
s_xor_b32 s64, s71, 7438336
v_mfma_f32_16x16x32_bf16 v[228:231], a[8:11], a[112:115], v[228:231]
buffer_load_dwordx4 v15, s[56:59], s64 offen lds
v_mfma_f32_16x16x32_bf16 v[228:231], a[12:15], a[116:119], v[228:231]
v_mfma_f32_16x16x32_bf16 v[220:223], a[4:7], a[116:119], v[220:223]
v_mfma_f32_16x16x32_bf16 v[220:223], a[0:3], a[112:115], v[220:223]
s_waitcnt lgkmcnt(4)
ds_read_b64_tr_b16 a[112:113], v7 offset:32768
v_mfma_f32_16x16x32_bf16 v[152:155], a[72:75], a[0:3], v[152:155]
ds_read_b64_tr_b16 a[114:115], v7 offset:33792
v_mfma_f32_16x16x32_bf16 v[152:155], a[76:79], a[4:7], v[152:155]
ds_read_b64_tr_b16 a[116:117], v7 offset:40960
v_subrev_u32 v20, 0x8000, v20
v_mfma_f32_16x16x32_bf16 v[160:163], a[76:79], a[12:15], v[160:163]
ds_read_b64_tr_b16 a[118:119], v7 offset:41984
v_mfma_f32_16x16x32_bf16 v[160:163], a[72:75], a[8:11], v[160:163]
v_mfma_f32_16x16x32_bf16 v[168:171], a[72:75], a[16:19], v[168:171]
v_mfma_f32_16x16x32_bf16 v[168:171], a[76:79], a[20:23], v[168:171]
v_mfma_f32_16x16x32_bf16 v[176:179], a[76:79], a[28:31], v[176:179]
s_xor_b32 m0, s84, 0
v_mfma_f32_16x16x32_bf16 v[176:179], a[72:75], a[24:27], v[176:179]
s_xor_b32 s64, s72, 1792
ds_read_b64_tr_b16 a[72:73], v8 offset:32768
v_mfma_f32_16x16x32_bf16 v[180:183], a[80:83], a[24:27], v[180:183]
buffer_load_dwordx4 v12, s[48:51], s64 offen lds
v_mfma_f32_16x16x32_bf16 v[180:183], a[84:87], a[28:31], v[180:183]
ds_read_b64_tr_b16 a[74:75], v8 offset:33792
v_subrev_u32 v4, 0x8000, v4
v_mfma_f32_16x16x32_bf16 v[172:175], a[84:87], a[20:23], v[172:175]
ds_read_b64_tr_b16 a[76:77], v8 offset:40960
v_mfma_f32_16x16x32_bf16 v[172:175], a[80:83], a[16:19], v[172:175]
s_xor_b32 m0, s84, 1024
ds_read_b64_tr_b16 a[78:79], v8 offset:41984
v_mfma_f32_16x16x32_bf16 v[164:167], a[80:83], a[8:11], v[164:167]
s_xor_b32 s64, s72, 18176
v_mfma_f32_16x16x32_bf16 v[164:167], a[84:87], a[12:15], v[164:167]
buffer_load_dwordx4 v13, s[48:51], s64 offen lds
v_mfma_f32_16x16x32_bf16 v[156:159], a[84:87], a[4:7], v[156:159]
v_mfma_f32_16x16x32_bf16 v[156:159], a[80:83], a[0:3], v[156:159]
ds_read_b64_tr_b16 a[80:81], v9 offset:32768
v_mfma_f32_16x16x32_bf16 v[24:27], a[88:91], a[0:3], v[24:27]
s_xor_b32 m0, s84, 2048
ds_read_b64_tr_b16 a[82:83], v9 offset:33792
v_mfma_f32_16x16x32_bf16 v[24:27], a[92:95], a[4:7], v[24:27]
s_xor_b32 s64, s72, 132864
ds_read_b64_tr_b16 a[84:85], v9 offset:40960
v_subrev_u32 v5, 0x8000, v5
v_mfma_f32_16x16x32_bf16 v[40:43], a[92:95], a[12:15], v[40:43]
buffer_load_dwordx4 v12, s[48:51], s64 offen lds
v_mfma_f32_16x16x32_bf16 v[40:43], a[88:91], a[8:11], v[40:43]
ds_read_b64_tr_b16 a[86:87], v9 offset:41984
v_mfma_f32_16x16x32_bf16 v[56:59], a[88:91], a[16:19], v[56:59]
v_mfma_f32_16x16x32_bf16 v[56:59], a[92:95], a[20:23], v[56:59]
s_xor_b32 m0, s84, 3072
v_mfma_f32_16x16x32_bf16 v[72:75], a[92:95], a[28:31], v[72:75]
s_waitcnt vmcnt(12)
s_xor_b32 s64, s72, 149248
ds_read_b128 a[32:35], v2 offset:32768
v_mfma_f32_16x16x32_bf16 v[72:75], a[88:91], a[24:27], v[72:75]
s_branch L_po12
L_pg12:
s_branch L_tr1
L_po12:
buffer_load_dwordx4 v13, s[48:51], s64 offen lds
v_mfma_f32_16x16x32_bf16 v[136:139], a[96:99], a[24:27], v[136:139]
ds_read_b128 a[36:39], v3 offset:32768
v_mfma_f32_16x16x32_bf16 v[136:139], a[100:103], a[28:31], v[136:139]
ds_read_b128 a[40:43], v2 offset:34816
v_subrev_u32 v6, 0x8000, v6
v_mfma_f32_16x16x32_bf16 v[120:123], a[100:103], a[20:23], v[120:123]
s_xor_b32 m0, s84, 4096
ds_read_b128 a[44:47], v3 offset:34816
v_mfma_f32_16x16x32_bf16 v[120:123], a[96:99], a[16:19], v[120:123]
s_xor_b32 s64, s73, 1792
ds_read_b128 a[48:51], v2 offset:36864
v_mfma_f32_16x16x32_bf16 v[104:107], a[96:99], a[8:11], v[104:107]
buffer_load_dwordx4 v12, s[48:51], s64 offen lds
v_mfma_f32_16x16x32_bf16 v[104:107], a[100:103], a[12:15], v[104:107]
ds_read_b128 a[52:55], v3 offset:36864
v_mfma_f32_16x16x32_bf16 v[88:91], a[100:103], a[4:7], v[88:91]
ds_read_b128 a[56:59], v2 offset:38912
v_mfma_f32_16x16x32_bf16 v[88:91], a[96:99], a[0:3], v[88:91]
s_waitcnt lgkmcnt(7)
s_xor_b32 m0, s84, 5120
ds_read_b128 a[60:63], v3 offset:38912
v_mfma_f32_16x16x32_bf16 v[28:31], a[104:107], a[0:3], v[28:31]
s_xor_b32 s64, s73, 18176
ds_read_b64_tr_b16 a[88:89], v10 offset:32768
v_mfma_f32_16x16x32_bf16 v[28:31], a[108:111], a[4:7], v[28:31]
buffer_load_dwordx4 v13, s[48:51], s64 offen lds
v_mfma_f32_16x16x32_bf16 v[44:47], a[108:111], a[12:15], v[44:47]
ds_read_b64_tr_b16 a[90:91], v10 offset:33792
v_subrev_u32 v7, 0x8000, v7
v_mfma_f32_16x16x32_bf16 v[44:47], a[104:107], a[8:11], v[44:47]
ds_read_b64_tr_b16 a[92:93], v10 offset:40960
v_mfma_f32_16x16x32_bf16 v[60:63], a[104:107], a[16:19], v[60:63]
s_xor_b32 m0, s84, 6144
ds_read_b64_tr_b16 a[94:95], v10 offset:41984
v_mfma_f32_16x16x32_bf16 v[60:63], a[108:111], a[20:23], v[60:63]
s_xor_b32 s64, s73, 132864
ds_read_b64_tr_b16 a[96:97], v11 offset:32768
v_mfma_f32_16x16x32_bf16 v[76:79], a[108:111], a[28:31], v[76:79]
buffer_load_dwordx4 v12, s[48:51], s64 offen lds
v_mfma_f32_16x16x32_bf16 v[76:79], a[104:107], a[24:27], v[76:79]
ds_read_b64_tr_b16 a[98:99], v11 offset:33792
v_mfma_f32_16x16x32_bf16 v[140:143], a[112:115], a[24:27], v[140:143]
ds_read_b64_tr_b16 a[100:101], v11 offset:40960
v_mfma_f32_16x16x32_bf16 v[140:143], a[116:119], a[28:31], v[140:143]
s_xor_b32 m0, s84, 7168
ds_read_b64_tr_b16 a[102:103], v11 offset:41984
v_subrev_u32 v8, 0x8000, v8
v_mfma_f32_16x16x32_bf16 v[124:127], a[116:119], a[20:23], v[124:127]
s_xor_b32 s64, s73, 149248
v_mfma_f32_16x16x32_bf16 v[124:127], a[112:115], a[16:19], v[124:127]
buffer_load_dwordx4 v13, s[48:51], s64 offen lds
v_mfma_f32_16x16x32_bf16 v[108:111], a[112:115], a[8:11], v[108:111]
v_mfma_f32_16x16x32_bf16 v[108:111], a[116:119], a[12:15], v[108:111]
v_mfma_f32_16x16x32_bf16 v[92:95], a[116:119], a[4:7], v[92:95]
v_subrev_u32 v9, 0x8000, v9
v_subrev_u32 v10, 0x8000, v10
v_mfma_f32_16x16x32_bf16 v[92:95], a[112:115], a[0:3], v[92:95]
v_subrev_u32 v11, 0x8000, v11
v_mfma_f32_16x16x32_bf16 v[32:35], a[72:75], a[0:3], v[32:35]
v_mfma_f32_16x16x32_bf16 v[32:35], a[76:79], a[4:7], v[32:35]
v_mfma_f32_16x16x32_bf16 v[48:51], a[76:79], a[12:15], v[48:51]
s_cmp_eq_u32 s30, 0
s_cbranch_scc1 L_pg14
s_cmp_eq_u32 s30, 1
s_cbranch_scc1 L_pg15
s_cmp_eq_u32 s30, 2
s_cbranch_scc1 L_pg16
s_branch L_pg17
L_tr2:
s_waitcnt lgkmcnt(0)
s_barrier
v_mfma_f32_16x16x32_bf16 v[48:51], a[72:75], a[8:11], v[48:51]
s_xor_b32 m0, s77, 131072
buffer_load_dword v1, off, s[52:55], s70 sc1
v_mfma_f32_16x16x32_bf16 v[64:67], a[72:75], a[16:19], v[64:67]
s_xor_b32 s64, s71, 7864320
ds_read_b64_tr_b16 a[104:105], v19 offset:4096
v_mfma_f32_16x16x32_bf16 v[64:67], a[76:79], a[20:23], v[64:67]
buffer_load_dwordx4 v14, s[56:59], s64 offen lds
v_mfma_f32_16x16x32_bf16 v[80:83], a[76:79], a[28:31], v[80:83]
ds_read_b64_tr_b16 a[106:107], v19 offset:4352
v_mfma_f32_16x16x32_bf16 v[80:83], a[72:75], a[24:27], v[80:83]
ds_read_b64_tr_b16 a[108:109], v19 offset:6144
v_mfma_f32_16x16x32_bf16 v[144:147], a[80:83], a[24:27], v[144:147]
ds_read_b64_tr_b16 a[110:111], v19 offset:6400
v_mfma_f32_16x16x32_bf16 v[144:147], a[84:87], a[28:31], v[144:147]
ds_read_b64_tr_b16 a[112:113], v20 offset:4096
v_mfma_f32_16x16x32_bf16 v[128:131], a[84:87], a[20:23], v[128:131]
ds_read_b64_tr_b16 a[114:115], v20 offset:4352
v_mfma_f32_16x16x32_bf16 v[128:131], a[80:83], a[16:19], v[128:131]
ds_read_b64_tr_b16 a[116:117], v20 offset:6144
v_mfma_f32_16x16x32_bf16 v[112:115], a[80:83], a[8:11], v[112:115]
s_add_u32 m0, s78, 147456
ds_read_b64_tr_b16 a[118:119], v20 offset:6400
v_mfma_f32_16x16x32_bf16 v[112:115], a[84:87], a[12:15], v[112:115]
s_add_u32 s64, s75, 5898240
ds_read_b64_tr_b16 a[72:73], v19 offset:8192
v_mfma_f32_16x16x32_bf16 v[96:99], a[84:87], a[4:7], v[96:99]
buffer_load_dwordx4 v23, s[60:63], s64 offen lds
v_mfma_f32_16x16x32_bf16 v[96:99], a[80:83], a[0:3], v[96:99]
ds_read_b64_tr_b16 a[74:75], v19 offset:8448
v_mfma_f32_16x16x32_bf16 v[36:39], a[88:91], a[0:3], v[36:39]
ds_read_b64_tr_b16 a[76:77], v19 offset:10240
v_mfma_f32_16x16x32_bf16 v[36:39], a[92:95], a[4:7], v[36:39]
ds_read_b64_tr_b16 a[78:79], v19 offset:10496
v_mfma_f32_16x16x32_bf16 v[52:55], a[92:95], a[12:15], v[52:55]
ds_read_b64_tr_b16 a[80:81], v20 offset:8192
v_mfma_f32_16x16x32_bf16 v[52:55], a[88:91], a[8:11], v[52:55]
ds_read_b64_tr_b16 a[82:83], v20 offset:8448
v_mfma_f32_16x16x32_bf16 v[68:71], a[88:91], a[16:19], v[68:71]
ds_read_b64_tr_b16 a[84:85], v20 offset:10240
v_mfma_f32_16x16x32_bf16 v[68:71], a[92:95], a[20:23], v[68:71]
s_xor_b32 m0, s77, 132096
ds_read_b64_tr_b16 a[86:87], v20 offset:10496
v_mfma_f32_16x16x32_bf16 v[84:87], a[92:95], a[28:31], v[84:87]
s_xor_b32 s64, s71, 7897088
v_mfma_f32_16x16x32_bf16 v[84:87], a[88:91], a[24:27], v[84:87]
buffer_load_dwordx4 v14, s[56:59], s64 offen lds
v_mfma_f32_16x16x32_bf16 v[148:151], a[96:99], a[24:27], v[148:151]
ds_read_b64_tr_b16 a[88:89], v19 offset:0
v_mfma_f32_16x16x32_bf16 v[148:151], a[100:103], a[28:31], v[148:151]
ds_read_b64_tr_b16 a[90:91], v19 offset:256
v_mfma_f32_16x16x32_bf16 v[132:135], a[100:103], a[20:23], v[132:135]
ds_read_b64_tr_b16 a[92:93], v19 offset:2048
v_mfma_f32_16x16x32_bf16 v[132:135], a[96:99], a[16:19], v[132:135]
ds_read_b64_tr_b16 a[94:95], v19 offset:2304
v_mfma_f32_16x16x32_bf16 v[116:119], a[96:99], a[8:11], v[116:119]
v_mfma_f32_16x16x32_bf16 v[116:119], a[100:103], a[12:15], v[116:119]
v_mfma_f32_16x16x32_bf16 v[100:103], a[100:103], a[4:7], v[100:103]
s_add_u32 m0, s78, 151552
v_mfma_f32_16x16x32_bf16 v[100:103], a[96:99], a[0:3], v[100:103]
s_waitcnt lgkmcnt(4)
s_add_u32 s64, s75, 5900288
ds_read_b64_tr_b16 a[96:97], v20 offset:0
v_mfma_f32_16x16x32_bf16 v[184:187], a[104:107], a[32:35], v[184:187]
buffer_load_dwordx4 v23, s[60:63], s64 offen lds
v_mfma_f32_16x16x32_bf16 v[184:187], a[108:111], a[36:39], v[184:187]
ds_read_b64_tr_b16 a[98:99], v20 offset:256
v_and_b32 v22, 15, v0
v_mfma_f32_16x16x32_bf16 v[192:195], a[108:111], a[44:47], v[192:195]
ds_read_b64_tr_b16 a[100:101], v20 offset:2048
v_lshlrev_b32 v22, 3, v22
v_mfma_f32_16x16x32_bf16 v[192:195], a[104:107], a[40:43], v[192:195]
s_lshl_b32 s85, s30, 7
s_add_u32 s85, s85, 58720256
ds_read_b64_tr_b16 a[102:103], v20 offset:2304
v_mfma_f32_16x16x32_bf16 v[200:203], a[104:107], a[48:51], v[200:203]
s_lshl_b32 s86, s3, 10
s_add_u32 s86, s86, s85
s_lshl_b32 s87, s16, 10
s_lshl_b32 s68, s31, 20
s_add_u32 s32, s28, s68
s_addc_u32 s33, s29, 0
v_mfma_f32_16x16x32_bf16 v[200:203], a[108:111], a[52:55], v[200:203]
s_add_u32 s87, s87, s85
s_add_u32 s68, s16, 1
s_lshl_b32 s34, s68, 16
v_mfma_f32_16x16x32_bf16 v[208:211], a[108:111], a[60:63], v[208:211]
v_mfma_f32_16x16x32_bf16 v[208:211], a[104:107], a[56:59], v[208:211]
ds_read_b64_tr_b16 a[104:105], v4 offset:0
v_mfma_f32_16x16x32_bf16 v[212:215], a[112:115], a[56:59], v[212:215]
s_xor_b32 m0, s77, 133120
ds_read_b64_tr_b16 a[106:107], v4 offset:1024
v_mfma_f32_16x16x32_bf16 v[212:215], a[116:119], a[60:63], v[212:215]
s_xor_b32 s64, s71, 7929856
ds_read_b64_tr_b16 a[108:109], v4 offset:8192
v_mfma_f32_16x16x32_bf16 v[204:207], a[116:119], a[52:55], v[204:207]
buffer_load_dwordx4 v15, s[56:59], s64 offen lds
v_mfma_f32_16x16x32_bf16 v[204:207], a[112:115], a[48:51], v[204:207]
ds_read_b64_tr_b16 a[110:111], v4 offset:9216
v_mfma_f32_16x16x32_bf16 v[196:199], a[112:115], a[40:43], v[196:199]
v_mfma_f32_16x16x32_bf16 v[196:199], a[116:119], a[44:47], v[196:199]
v_mfma_f32_16x16x32_bf16 v[188:191], a[116:119], a[36:39], v[188:191]
v_mfma_f32_16x16x32_bf16 v[188:191], a[112:115], a[32:35], v[188:191]
ds_read_b64_tr_b16 a[112:113], v5 offset:0
v_mfma_f32_16x16x32_bf16 v[216:219], a[32:35], a[72:75], v[216:219]
ds_read_b64_tr_b16 a[114:115], v5 offset:1024
v_mfma_f32_16x16x32_bf16 v[216:219], a[36:39], a[76:79], v[216:219]
s_add_u32 m0, s78, 155648
ds_read_b64_tr_b16 a[116:117], v5 offset:8192
v_mfma_f32_16x16x32_bf16 v[224:227], a[44:47], a[76:79], v[224:227]
s_add_u32 s64, s75, 5902336
ds_read_b64_tr_b16 a[118:119], v5 offset:9216
v_mfma_f32_16x16x32_bf16 v[224:227], a[40:43], a[72:75], v[224:227]
buffer_load_dwordx4 v23, s[60:63], s64 offen lds
v_mfma_f32_16x16x32_bf16 v[232:235], a[48:51], a[72:75], v[232:235]
v_mfma_f32_16x16x32_bf16 v[232:235], a[52:55], a[76:79], v[232:235]
v_mfma_f32_16x16x32_bf16 v[240:243], a[60:63], a[76:79], v[240:243]
v_mfma_f32_16x16x32_bf16 v[240:243], a[56:59], a[72:75], v[240:243]
ds_read_b64_tr_b16 a[72:73], v6 offset:0
v_mfma_f32_16x16x32_bf16 v[244:247], a[56:59], a[80:83], v[244:247]
ds_read_b64_tr_b16 a[74:75], v6 offset:1024
v_mfma_f32_16x16x32_bf16 v[244:247], a[60:63], a[84:87], v[244:247]
ds_read_b64_tr_b16 a[76:77], v6 offset:8192
v_mfma_f32_16x16x32_bf16 v[236:239], a[52:55], a[84:87], v[236:239]
s_xor_b32 m0, s77, 134144
ds_read_b64_tr_b16 a[78:79], v6 offset:9216
v_mfma_f32_16x16x32_bf16 v[236:239], a[48:51], a[80:83], v[236:239]
s_xor_b32 s64, s71, 7962624
v_mfma_f32_16x16x32_bf16 v[228:231], a[40:43], a[80:83], v[228:231]
buffer_load_dwordx4 v15, s[56:59], s64 offen lds
v_mfma_f32_16x16x32_bf16 v[228:231], a[44:47], a[84:87], v[228:231]
v_mfma_f32_16x16x32_bf16 v[220:223], a[36:39], a[84:87], v[220:223]
v_mfma_f32_16x16x32_bf16 v[220:223], a[32:35], a[80:83], v[220:223]
s_waitcnt lgkmcnt(4)
ds_read_b64_tr_b16 a[80:81], v7 offset:0
v_mfma_f32_16x16x32_bf16 v[152:155], a[88:91], a[32:35], v[152:155]
ds_read_b64_tr_b16 a[82:83], v7 offset:1024
v_mfma_f32_16x16x32_bf16 v[152:155], a[92:95], a[36:39], v[152:155]
ds_read_b64_tr_b16 a[84:85], v7 offset:8192
v_mfma_f32_16x16x32_bf16 v[160:163], a[92:95], a[44:47], v[160:163]
ds_read_b64_tr_b16 a[86:87], v7 offset:9216
v_mfma_f32_16x16x32_bf16 v[160:163], a[88:91], a[40:43], v[160:163]
v_mfma_f32_16x16x32_bf16 v[168:171], a[88:91], a[48:51], v[168:171]
v_mfma_f32_16x16x32_bf16 v[168:171], a[92:95], a[52:55], v[168:171]
v_mfma_f32_16x16x32_bf16 v[176:179], a[92:95], a[60:63], v[176:179]
s_xor_b32 m0, s84, 32768
v_mfma_f32_16x16x32_bf16 v[176:179], a[88:91], a[56:59], v[176:179]
s_xor_b32 s64, s72, 1920
ds_read_b64_tr_b16 a[88:89], v8 offset:0
v_mfma_f32_16x16x32_bf16 v[180:183], a[96:99], a[56:59], v[180:183]
buffer_load_dwordx4 v12, s[48:51], s64 offen lds
v_mfma_f32_16x16x32_bf16 v[180:183], a[100:103], a[60:63], v[180:183]
ds_read_b64_tr_b16 a[90:91], v8 offset:1024
v_mfma_f32_16x16x32_bf16 v[172:175], a[100:103], a[52:55], v[172:175]
ds_read_b64_tr_b16 a[92:93], v8 offset:8192
v_mfma_f32_16x16x32_bf16 v[172:175], a[96:99], a[48:51], v[172:175]
s_xor_b32 m0, s84, 33792
ds_read_b64_tr_b16 a[94:95], v8 offset:9216
v_mfma_f32_16x16x32_bf16 v[164:167], a[96:99], a[40:43], v[164:167]
s_xor_b32 s64, s72, 18304
v_mfma_f32_16x16x32_bf16 v[164:167], a[100:103], a[44:47], v[164:167]
buffer_load_dwordx4 v13, s[48:51], s64 offen lds
v_mfma_f32_16x16x32_bf16 v[156:159], a[100:103], a[36:39], v[156:159]
v_mfma_f32_16x16x32_bf16 v[156:159], a[96:99], a[32:35], v[156:159]
ds_read_b64_tr_b16 a[96:97], v9 offset:0
v_mfma_f32_16x16x32_bf16 v[24:27], a[104:107], a[32:35], v[24:27]
s_xor_b32 m0, s84, 34816
ds_read_b64_tr_b16 a[98:99], v9 offset:1024
v_mfma_f32_16x16x32_bf16 v[24:27], a[108:111], a[36:39], v[24:27]
s_xor_b32 s64, s72, 132992
ds_read_b64_tr_b16 a[100:101], v9 offset:8192
v_mfma_f32_16x16x32_bf16 v[40:43], a[108:111], a[44:47], v[40:43]
buffer_load_dwordx4 v12, s[48:51], s64 offen lds
v_mfma_f32_16x16x32_bf16 v[40:43], a[104:107], a[40:43], v[40:43]
ds_read_b64_tr_b16 a[102:103], v9 offset:9216
v_mfma_f32_16x16x32_bf16 v[56:59], a[104:107], a[48:51], v[56:59]
v_mfma_f32_16x16x32_bf16 v[56:59], a[108:111], a[52:55], v[56:59]
s_xor_b32 m0, s84, 35840
v_mfma_f32_16x16x32_bf16 v[72:75], a[108:111], a[60:63], v[72:75]
s_waitcnt vmcnt(11)
s_xor_b32 s64, s72, 149376
ds_read_b128 a[0:3], v2 offset:0
v_mfma_f32_16x16x32_bf16 v[72:75], a[104:107], a[56:59], v[72:75]
buffer_load_dwordx4 v13, s[48:51], s64 offen lds
v_mfma_f32_16x16x32_bf16 v[136:139], a[112:115], a[56:59], v[136:139]
ds_read_b128 a[4:7], v3 offset:0
v_mfma_f32_16x16x32_bf16 v[136:139], a[116:119], a[60:63], v[136:139]
ds_read_b128 a[8:11], v2 offset:2048
v_mfma_f32_16x16x32_bf16 v[120:123], a[116:119], a[52:55], v[120:123]
s_xor_b32 m0, s84, 36864
ds_read_b128 a[12:15], v3 offset:2048
v_mfma_f32_16x16x32_bf16 v[120:123], a[112:115], a[48:51], v[120:123]
s_xor_b32 s64, s73, 1920
ds_read_b128 a[16:19], v2 offset:4096
v_mfma_f32_16x16x32_bf16 v[104:107], a[112:115], a[40:43], v[104:107]
buffer_load_dwordx4 v12, s[48:51], s64 offen lds
v_mfma_f32_16x16x32_bf16 v[104:107], a[116:119], a[44:47], v[104:107]
ds_read_b128 a[20:23], v3 offset:4096
v_mfma_f32_16x16x32_bf16 v[88:91], a[116:119], a[36:39], v[88:91]
ds_read_b128 a[24:27], v2 offset:6144
v_mfma_f32_16x16x32_bf16 v[88:91], a[112:115], a[32:35], v[88:91]
s_waitcnt lgkmcnt(7)
s_xor_b32 m0, s84, 37888
ds_read_b128 a[28:31], v3 offset:6144
v_mfma_f32_16x16x32_bf16 v[28:31], a[72:75], a[32:35], v[28:31]
s_xor_b32 s64, s73, 18304
ds_read_b64_tr_b16 a[104:105], v10 offset:0
v_mfma_f32_16x16x32_bf16 v[28:31], a[76:79], a[36:39], v[28:31]
buffer_load_dwordx4 v13, s[48:51], s64 offen lds
v_mfma_f32_16x16x32_bf16 v[44:47], a[76:79], a[44:47], v[44:47]
ds_read_b64_tr_b16 a[106:107], v10 offset:1024
v_mfma_f32_16x16x32_bf16 v[44:47], a[72:75], a[40:43], v[44:47]
ds_read_b64_tr_b16 a[108:109], v10 offset:8192
v_mfma_f32_16x16x32_bf16 v[60:63], a[72:75], a[48:51], v[60:63]
s_xor_b32 m0, s84, 38912
ds_read_b64_tr_b16 a[110:111], v10 offset:9216
v_mfma_f32_16x16x32_bf16 v[60:63], a[76:79], a[52:55], v[60:63]
s_xor_b32 s64, s73, 132992
ds_read_b64_tr_b16 a[112:113], v11 offset:0
v_mfma_f32_16x16x32_bf16 v[76:79], a[76:79], a[60:63], v[76:79]
buffer_load_dwordx4 v12, s[48:51], s64 offen lds
v_mfma_f32_16x16x32_bf16 v[76:79], a[72:75], a[56:59], v[76:79]
ds_read_b64_tr_b16 a[114:115], v11 offset:1024
v_mfma_f32_16x16x32_bf16 v[140:143], a[80:83], a[56:59], v[140:143]
ds_read_b64_tr_b16 a[116:117], v11 offset:8192
v_mfma_f32_16x16x32_bf16 v[140:143], a[84:87], a[60:63], v[140:143]
s_xor_b32 m0, s84, 39936
ds_read_b64_tr_b16 a[118:119], v11 offset:9216
v_mfma_f32_16x16x32_bf16 v[124:127], a[84:87], a[52:55], v[124:127]
s_xor_b32 s64, s73, 149376
v_mfma_f32_16x16x32_bf16 v[124:127], a[80:83], a[48:51], v[124:127]
buffer_load_dwordx4 v13, s[48:51], s64 offen lds
v_mfma_f32_16x16x32_bf16 v[108:111], a[80:83], a[40:43], v[108:111]
v_mfma_f32_16x16x32_bf16 v[108:111], a[84:87], a[44:47], v[108:111]
v_mfma_f32_16x16x32_bf16 v[92:95], a[84:87], a[36:39], v[92:95]
s_waitcnt vmcnt(15)
v_readfirstlane_b32 vcc_lo, v1
s_nop 0
s_cmp_lt_u32 vcc_lo, s81
s_cbranch_scc1 L_spin_4
L_spinbk_5:
v_mfma_f32_16x16x32_bf16 v[92:95], a[80:83], a[32:35], v[92:95]
buffer_load_dwordx2 a[64:65], v22, s[44:47], s86 offen offset:0 sc1
v_mfma_f32_16x16x32_bf16 v[32:35], a[88:91], a[32:35], v[32:35]
buffer_load_dwordx2 a[66:67], v22, s[44:47], s86 offen offset:512 sc1
v_mfma_f32_16x16x32_bf16 v[32:35], a[92:95], a[36:39], v[32:35]
buffer_load_dwordx2 a[68:69], v22, s[44:47], s87 offen offset:0 sc1
v_mfma_f32_16x16x32_bf16 v[48:51], a[92:95], a[44:47], v[48:51]
s_waitcnt lgkmcnt(0)
s_barrier
v_mfma_f32_16x16x32_bf16 v[48:51], a[88:91], a[40:43], v[48:51]
ds_read_b64_tr_b16 a[72:73], v19 offset:36864
v_mfma_f32_16x16x32_bf16 v[64:67], a[88:91], a[48:51], v[64:67]
s_lshl2_add_u32 s72, s2, s30
ds_read_b64_tr_b16 a[74:75], v19 offset:37120
v_mfma_f32_16x16x32_bf16 v[64:67], a[92:95], a[52:55], v[64:67]
s_lshl_b32 s72, s72, 12
s_mov_b32 m0, s76
ds_read_b64_tr_b16 a[76:77], v19 offset:38912
v_mfma_f32_16x16x32_bf16 v[80:83], a[92:95], a[60:63], v[80:83]
s_add_u32 s72, s72, 67108864
s_lshl_b32 s64, s30, 14
ds_read_b64_tr_b16 a[78:79], v19 offset:39168
v_mfma_f32_16x16x32_bf16 v[80:83], a[88:91], a[56:59], v[80:83]
buffer_load_dwordx4 v16, s[32:35], s64 offen offset:0 sc1 lds
v_mfma_f32_16x16x32_bf16 v[144:147], a[96:99], a[56:59], v[144:147]
buffer_load_dwordx2 a[70:71], v22, s[44:47], s87 offen offset:512 sc1
v_mfma_f32_16x16x32_bf16 v[144:147], a[100:103], a[60:63], v[144:147]
ds_read_b64_tr_b16 a[80:81], v20 offset:36864
v_mfma_f32_16x16x32_bf16 v[128:131], a[100:103], a[52:55], v[128:131]
ds_read_b64_tr_b16 a[82:83], v20 offset:37120
v_mfma_f32_16x16x32_bf16 v[128:131], a[96:99], a[48:51], v[128:131]
ds_read_b64_tr_b16 a[84:85], v20 offset:38912
v_mfma_f32_16x16x32_bf16 v[112:115], a[96:99], a[40:43], v[112:115]
ds_read_b64_tr_b16 a[86:87], v20 offset:39168
v_mfma_f32_16x16x32_bf16 v[112:115], a[100:103], a[44:47], v[112:115]
ds_read_b64_tr_b16 a[88:89], v19 offset:40960
v_mfma_f32_16x16x32_bf16 v[96:99], a[100:103], a[36:39], v[96:99]
ds_read_b64_tr_b16 a[90:91], v19 offset:41216
v_mfma_f32_16x16x32_bf16 v[96:99], a[96:99], a[32:35], v[96:99]
buffer_load_dwordx4 v16, s[32:35], s64 offen offset:1024 sc1 lds
v_mfma_f32_16x16x32_bf16 v[36:39], a[104:107], a[32:35], v[36:39]
buffer_store_dwordx4 a[240:243], v16, s[44:47], s72 offen offset:0 sc1
v_mfma_f32_16x16x32_bf16 v[36:39], a[108:111], a[36:39], v[36:39]
ds_read_b64_tr_b16 a[92:93], v19 offset:43008
v_mfma_f32_16x16x32_bf16 v[52:55], a[108:111], a[44:47], v[52:55]
ds_read_b64_tr_b16 a[94:95], v19 offset:43264
v_mfma_f32_16x16x32_bf16 v[52:55], a[104:107], a[40:43], v[52:55]
ds_read_b64_tr_b16 a[96:97], v20 offset:40960
v_mfma_f32_16x16x32_bf16 v[68:71], a[104:107], a[48:51], v[68:71]
ds_read_b64_tr_b16 a[98:99], v20 offset:41216
v_mfma_f32_16x16x32_bf16 v[68:71], a[108:111], a[52:55], v[68:71]
ds_read_b64_tr_b16 a[100:101], v20 offset:43008
v_mfma_f32_16x16x32_bf16 v[84:87], a[108:111], a[60:63], v[84:87]
ds_read_b64_tr_b16 a[102:103], v20 offset:43264
v_mfma_f32_16x16x32_bf16 v[84:87], a[104:107], a[56:59], v[84:87]
buffer_load_dwordx4 v16, s[32:35], s64 offen offset:2048 sc1 lds
v_mfma_f32_16x16x32_bf16 v[148:151], a[112:115], a[56:59], v[148:151]
ds_read_b64_tr_b16 a[104:105], v19 offset:32768
v_mfma_f32_16x16x32_bf16 v[148:151], a[116:119], a[60:63], v[148:151]
ds_read_b64_tr_b16 a[106:107], v19 offset:33024
v_mfma_f32_16x16x32_bf16 v[132:135], a[116:119], a[52:55], v[132:135]
ds_read_b64_tr_b16 a[108:109], v19 offset:34816
v_mfma_f32_16x16x32_bf16 v[132:135], a[112:115], a[48:51], v[132:135]
ds_read_b64_tr_b16 a[110:111], v19 offset:35072
v_mfma_f32_16x16x32_bf16 v[116:119], a[112:115], a[40:43], v[116:119]
v_mfma_f32_16x16x32_bf16 v[116:119], a[116:119], a[44:47], v[116:119]
v_mfma_f32_16x16x32_bf16 v[100:103], a[116:119], a[36:39], v[100:103]
buffer_store_dwordx4 a[240:243], v16, s[44:47], s72 offen offset:1024 sc1
v_mfma_f32_16x16x32_bf16 v[100:103], a[112:115], a[32:35], v[100:103]
s_waitcnt lgkmcnt(5)
buffer_load_dwordx4 v16, s[32:35], s64 offen offset:3072 sc1 lds
v_mfma_f32_16x16x32_bf16 v[184:187], a[72:75], a[0:3], v[184:187]
ds_read_b64_tr_b16 a[112:113], v20 offset:32768
v_and_b32 v12, 15, v0
v_mfma_f32_16x16x32_bf16 v[184:187], a[76:79], a[4:7], v[184:187]
ds_read_b64_tr_b16 a[114:115], v20 offset:33024
v_lshrrev_b32 v13, 4, v0
v_mfma_f32_16x16x32_bf16 v[192:195], a[76:79], a[12:15], v[192:195]
ds_read_b64_tr_b16 a[116:117], v20 offset:34816
v_lshlrev_b32 v13, 2, v13
v_mfma_f32_16x16x32_bf16 v[192:195], a[72:75], a[8:11], v[192:195]
ds_read_b64_tr_b16 a[118:119], v20 offset:35072
v_sub_u32 v12, v12, v13
v_mfma_f32_16x16x32_bf16 v[200:203], a[72:75], a[16:19], v[200:203]
s_lshl_b32 s66, s30, 4
v_mfma_f32_16x16x32_bf16 v[200:203], a[76:79], a[20:23], v[200:203]
s_add_u32 m0, s76, 4096
v_add_u32 v13, s66, v12
v_cmp_gt_i32 s[0:1], 0, v13
v_mfma_f32_16x16x32_bf16 v[208:211], a[76:79], a[28:31], v[208:211]
s_add_u32 s64, s64, 4096
v_cmp_gt_i32 s[4:5], 1, v13
v_cmp_gt_i32 s[6:7], 2, v13
v_mfma_f32_16x16x32_bf16 v[208:211], a[72:75], a[24:27], v[208:211]
buffer_load_dwordx4 v16, s[32:35], s64 offen offset:0 sc1 lds
v_mfma_f32_16x16x32_bf16 v[212:215], a[80:83], a[24:27], v[212:215]
ds_read_b64_tr_b16 a[72:73], v4 offset:32768
v_cmp_gt_i32 s[8:9], 3, v13
v_mfma_f32_16x16x32_bf16 v[212:215], a[84:87], a[28:31], v[212:215]
ds_read_b64_tr_b16 a[74:75], v4 offset:33792
v_cmp_gt_i32 s[10:11], 16, v13
v_mfma_f32_16x16x32_bf16 v[204:207], a[84:87], a[20:23], v[204:207]
ds_read_b64_tr_b16 a[76:77], v4 offset:40960
v_cmp_gt_i32 s[12:13], 17, v13
v_mfma_f32_16x16x32_bf16 v[204:207], a[80:83], a[16:19], v[204:207]
ds_read_b64_tr_b16 a[78:79], v4 offset:41984
v_cmp_gt_i32 s[18:19], 18, v13
v_mfma_f32_16x16x32_bf16 v[196:199], a[80:83], a[8:11], v[196:199]
buffer_store_dwordx4 a[240:243], v16, s[44:47], s72 offen offset:2048 sc1
v_mfma_f32_16x16x32_bf16 v[196:199], a[84:87], a[12:15], v[196:199]
v_cmp_gt_i32 s[22:23], 19, v13
v_cmp_gt_i32 s[26:27], 32, v13
v_mfma_f32_16x16x32_bf16 v[188:191], a[84:87], a[4:7], v[188:191]
v_cmp_gt_i32 s[56:57], 33, v13
v_cmp_gt_i32 s[58:59], 34, v13
v_mfma_f32_16x16x32_bf16 v[188:191], a[80:83], a[0:3], v[188:191]
buffer_load_dwordx4 v16, s[32:35], s64 offen offset:1024 sc1 lds
v_mfma_f32_16x16x32_bf16 v[216:219], a[0:3], a[88:91], v[216:219]
ds_read_b64_tr_b16 a[80:81], v5 offset:32768
v_cmp_gt_i32 s[60:61], 35, v13
v_mfma_f32_16x16x32_bf16 v[216:219], a[4:7], a[92:95], v[216:219]
ds_read_b64_tr_b16 a[82:83], v5 offset:33792
v_cmp_gt_i32 s[62:63], 48, v13
v_mfma_f32_16x16x32_bf16 v[224:227], a[12:15], a[92:95], v[224:227]
ds_read_b64_tr_b16 a[84:85], v5 offset:40960
v_cmp_gt_i32 s[48:49], 49, v13
v_mfma_f32_16x16x32_bf16 v[224:227], a[8:11], a[88:91], v[224:227]
ds_read_b64_tr_b16 a[86:87], v5 offset:41984
v_cmp_gt_i32 s[50:51], 50, v13
v_mfma_f32_16x16x32_bf16 v[232:235], a[16:19], a[88:91], v[232:235]
v_cmp_gt_i32 s[100:101], 51, v13
v_subrev_u32 v17, 0, v12
v_mfma_f32_16x16x32_bf16 v[232:235], a[20:23], a[92:95], v[232:235]
v_lshlrev_b32 v18, 31, v17
v_or_b32 v21, v17, v18
v_mfma_f32_16x16x32_bf16 v[240:243], a[28:31], a[92:95], v[240:243]
v_ashrrev_i32 v21, 31, v21
v_and_b32 v248, 0xff800000, v21
v_mfma_f32_16x16x32_bf16 v[240:243], a[24:27], a[88:91], v[240:243]
buffer_load_dwordx4 v16, s[32:35], s64 offen offset:2048 sc1 lds
v_mfma_f32_16x16x32_bf16 v[244:247], a[24:27], a[96:99], v[244:247]
s_waitcnt lgkmcnt(4)
ds_read_b64_tr_b16 a[88:89], v6 offset:32768
v_not_b32 v17, v17
v_mfma_f32_16x16x32_bf16 v[244:247], a[28:31], a[100:103], v[244:247]
ds_read_b64_tr_b16 a[90:91], v6 offset:33792
v_add_u32 v19, 0x8000, v19
v_mfma_f32_16x16x32_bf16 v[236:239], a[20:23], a[100:103], v[236:239]
buffer_store_dwordx4 a[240:243], v16, s[44:47], s72 offen offset:3072 sc1
v_mfma_f32_16x16x32_bf16 v[236:239], a[16:19], a[96:99], v[236:239]
ds_read_b64_tr_b16 a[92:93], v6 offset:40960
v_or_b32 v21, v17, v18
v_mfma_f32_16x16x32_bf16 v[228:231], a[8:11], a[96:99], v[228:231]
ds_read_b64_tr_b16 a[94:95], v6 offset:41984
v_ashrrev_i32 v21, 31, v21
v_mfma_f32_16x16x32_bf16 v[228:231], a[12:15], a[100:103], v[228:231]
v_and_b32 v252, 0xff800000, v21
v_subrev_u32 v17, 1, v12
v_mfma_f32_16x16x32_bf16 v[220:223], a[4:7], a[100:103], v[220:223]
v_lshlrev_b32 v18, 31, v17
v_or_b32 v21, v17, v18
v_mfma_f32_16x16x32_bf16 v[220:223], a[0:3], a[96:99], v[220:223]
buffer_load_dwordx4 v16, s[32:35], s64 offen offset:3072 sc1 lds
v_mfma_f32_16x16x32_bf16 v[152:155], a[104:107], a[0:3], v[152:155]
ds_read_b64_tr_b16 a[96:97], v7 offset:32768
v_ashrrev_i32 v21, 31, v21
v_mfma_f32_16x16x32_bf16 v[152:155], a[108:111], a[4:7], v[152:155]
ds_read_b64_tr_b16 a[98:99], v7 offset:33792
v_add_u32 v20, 0x8000, v20
v_mfma_f32_16x16x32_bf16 v[160:163], a[108:111], a[12:15], v[160:163]
s_lshr_b32 s64, s76, 1
ds_read_b64_tr_b16 a[100:101], v7 offset:40960
v_and_b32 v249, 0xff800000, v21
v_mfma_f32_16x16x32_bf16 v[160:163], a[104:107], a[8:11], v[160:163]
s_add_u32 m0, s64, 81920
ds_read_b64_tr_b16 a[102:103], v7 offset:41984
v_not_b32 v17, v17
v_mfma_f32_16x16x32_bf16 v[168:171], a[104:107], a[16:19], v[168:171]
s_and_b32 s71, s64, 8192
v_or_b32 v21, v17, v18
v_ashrrev_i32 v21, 31, v21
v_mfma_f32_16x16x32_bf16 v[168:171], a[108:111], a[20:23], v[168:171]
s_add_u32 s64, s64, s71
v_and_b32 v253, 0xff800000, v21
v_subrev_u32 v17, 2, v12
v_mfma_f32_16x16x32_bf16 v[176:179], a[108:111], a[28:31], v[176:179]
s_add_u32 s64, s64, 8192
v_lshlrev_b32 v18, 31, v17
v_or_b32 v21, v17, v18
v_mfma_f32_16x16x32_bf16 v[176:179], a[104:107], a[24:27], v[176:179]
buffer_load_dwordx4 v16, s[32:35], s64 offen offset:0 sc1 lds
v_mfma_f32_16x16x32_bf16 v[180:183], a[112:115], a[24:27], v[180:183]
ds_read_b64_tr_b16 a[104:105], v8 offset:32768
v_ashrrev_i32 v21, 31, v21
v_mfma_f32_16x16x32_bf16 v[180:183], a[116:119], a[28:31], v[180:183]
ds_read_b64_tr_b16 a[106:107], v8 offset:33792
v_add_u32 v4, 0x8000, v4
v_mfma_f32_16x16x32_bf16 v[172:175], a[116:119], a[20:23], v[172:175]
ds_read_b64_tr_b16 a[108:109], v8 offset:40960
v_and_b32 v250, 0xff800000, v21
v_mfma_f32_16x16x32_bf16 v[172:175], a[112:115], a[16:19], v[172:175]
ds_read_b64_tr_b16 a[110:111], v8 offset:41984
v_not_b32 v17, v17
v_mfma_f32_16x16x32_bf16 v[164:167], a[112:115], a[8:11], v[164:167]
v_or_b32 v21, v17, v18
v_ashrrev_i32 v21, 31, v21
v_mfma_f32_16x16x32_bf16 v[164:167], a[116:119], a[12:15], v[164:167]
v_and_b32 v254, 0xff800000, v21
v_subrev_u32 v17, 3, v12
v_mfma_f32_16x16x32_bf16 v[156:159], a[116:119], a[4:7], v[156:159]
v_lshlrev_b32 v18, 31, v17
v_or_b32 v21, v17, v18
v_mfma_f32_16x16x32_bf16 v[156:159], a[112:115], a[0:3], v[156:159]
buffer_load_dwordx4 v16, s[32:35], s64 offen offset:1024 sc1 lds
v_mfma_f32_16x16x32_bf16 v[24:27], a[72:75], a[0:3], v[24:27]
ds_read_b64_tr_b16 a[112:113], v9 offset:32768
v_ashrrev_i32 v21, 31, v21
v_mfma_f32_16x16x32_bf16 v[24:27], a[76:79], a[4:7], v[24:27]
ds_read_b64_tr_b16 a[114:115], v9 offset:33792
v_add_u32 v5, 0x8000, v5
v_mfma_f32_16x16x32_bf16 v[40:43], a[76:79], a[12:15], v[40:43]
ds_read_b64_tr_b16 a[116:117], v9 offset:40960
v_and_b32 v251, 0xff800000, v21
v_mfma_f32_16x16x32_bf16 v[40:43], a[72:75], a[8:11], v[40:43]
ds_read_b64_tr_b16 a[118:119], v9 offset:41984
v_not_b32 v17, v17
v_mfma_f32_16x16x32_bf16 v[56:59], a[72:75], a[16:19], v[56:59]
v_or_b32 v21, v17, v18
v_ashrrev_i32 v21, 31, v21
v_mfma_f32_16x16x32_bf16 v[56:59], a[76:79], a[20:23], v[56:59]
v_and_b32 v255, 0xff800000, v21
v_mfma_f32_16x16x32_bf16 v[72:75], a[76:79], a[28:31], v[72:75]
s_waitcnt vmcnt(18)
s_and_b32 s66, s2, 7
ds_read_b128 a[32:35], v2 offset:32768
v_mfma_f32_16x16x32_bf16 v[72:75], a[72:75], a[24:27], v[72:75]
s_waitcnt lgkmcnt(5)
s_lshr_b32 s67, s2, 3
buffer_load_dwordx4 v16, s[32:35], s64 offen offset:2048 sc1 lds
v_mfma_f32_16x16x32_bf16 v[136:139], a[80:83], a[24:27], v[136:139]
s_branch L_po13
L_pg13:
s_branch L_tr1
L_po13:
s_and_b32 s83, s66, 1
s_and_b32 s68, s66, 2
ds_read_b128 a[36:39], v3 offset:32768
v_mfma_f32_16x16x32_bf16 v[136:139], a[84:87], a[28:31], v[136:139]
s_and_b32 s69, s67, 7
ds_read_b128 a[40:43], v2 offset:34816
v_add_u32 v6, 0x8000, v6
v_mfma_f32_16x16x32_bf16 v[120:123], a[84:87], a[20:23], v[120:123]
s_lshl2_add_u32 s82, s68, s69
s_and_b32 s68, s66, 4
ds_read_b128 a[44:47], v3 offset:34816
v_mfma_f32_16x16x32_bf16 v[120:123], a[80:83], a[16:19], v[120:123]
s_lshr_b32 s69, s67, 3
s_xor_b32 s69, s69, 0
ds_read_b128 a[48:51], v2 offset:36864
v_mfma_f32_16x16x32_bf16 v[104:107], a[80:83], a[8:11], v[104:107]
s_add_u32 s87, s68, s69
s_lshl_b32 s87, s87, 8
ds_read_b128 a[52:55], v3 offset:36864
v_mfma_f32_16x16x32_bf16 v[104:107], a[84:87], a[12:15], v[104:107]
s_lshl_b32 s86, s30, 13
s_lshl_b32 s85, s30, 16
ds_read_b128 a[56:59], v2 offset:38912
v_mfma_f32_16x16x32_bf16 v[88:91], a[84:87], a[4:7], v[88:91]
s_add_u32 s85, s85, s87
s_mul_i32 s66, s83, 1310720
ds_read_b128 a[60:63], v3 offset:38912
v_mfma_f32_16x16x32_bf16 v[88:91], a[80:83], a[0:3], v[88:91]
s_add_u32 s85, s85, s66
buffer_load_dwordx4 v16, s[32:35], s64 offen offset:3072 sc1 lds
v_mfma_f32_16x16x32_bf16 v[28:31], a[88:91], a[0:3], v[28:31]
s_mul_i32 s84, s82, 1310720
s_and_b32 s66, s30, 1
ds_read_b64_tr_b16 a[72:73], v10 offset:32768
v_mfma_f32_16x16x32_bf16 v[28:31], a[92:95], a[4:7], v[28:31]
s_lshl_b32 s66, s66, 14
ds_read_b64_tr_b16 a[74:75], v10 offset:33792
v_add_u32 v7, 0x8000, v7
v_mfma_f32_16x16x32_bf16 v[44:47], a[92:95], a[12:15], v[44:47]
s_add_u32 s84, s84, s66
s_mul_i32 s66, s83, 163840
ds_read_b64_tr_b16 a[76:77], v10 offset:40960
v_mfma_f32_16x16x32_bf16 v[44:47], a[88:91], a[8:11], v[44:47]
s_add_u32 s84, s84, s66
s_add_u32 s84, s84, 34603008
ds_read_b64_tr_b16 a[78:79], v10 offset:41984
v_mfma_f32_16x16x32_bf16 v[60:63], a[88:91], a[16:19], v[60:63]
s_sub_u32 s66, 15, s82
s_min_u32 s66, s66, s82
ds_read_b64_tr_b16 a[80:81], v11 offset:32768
v_mfma_f32_16x16x32_bf16 v[60:63], a[92:95], a[20:23], v[60:63]
s_lshl1_add_u32 s66, s66, s83
s_lshl_b32 s80, s66, 8
ds_read_b64_tr_b16 a[82:83], v11 offset:33792
v_mfma_f32_16x16x32_bf16 v[76:79], a[92:95], a[28:31], v[76:79]
s_add_u32 s80, s80, 8192
s_and_b32 s67, s30, 1
ds_read_b64_tr_b16 a[84:85], v11 offset:40960
v_mfma_f32_16x16x32_bf16 v[76:79], a[88:91], a[24:27], v[76:79]
s_lshl_b32 s67, s67, 7
s_add_u32 s67, s67, s83
ds_read_b64_tr_b16 a[86:87], v11 offset:41984
v_mfma_f32_16x16x32_bf16 v[140:143], a[96:99], a[24:27], v[140:143]
s_lshl_b32 s67, s67, 7
s_add_u32 s67, s67, 98304
s_lshl_b32 s66, s30, 11
v_mfma_f32_16x16x32_bf16 v[140:143], a[100:103], a[28:31], v[140:143]
v_add_u32 v8, 0x8000, v8
v_lshrrev_b32 v14, 4, v0
v_mfma_f32_16x16x32_bf16 v[124:127], a[100:103], a[20:23], v[124:127]
v_bfe_u32 v12, v0, 1, 3
v_xor_b32 v12, v12, v14
v_mfma_f32_16x16x32_bf16 v[124:127], a[96:99], a[16:19], v[124:127]
v_lshlrev_b32 v12, 5, v12
v_lshl_add_u32 v12, v14, 11, v12
v_mfma_f32_16x16x32_bf16 v[108:111], a[96:99], a[8:11], v[108:111]
v_and_b32 v14, 1, v0
v_lshl_add_u32 v12, v14, 4, v12
v_mfma_f32_16x16x32_bf16 v[108:111], a[100:103], a[12:15], v[108:111]
v_xor_b32 v13, 128, v12
v_lshrrev_b32 v14, 4, v0
v_mfma_f32_16x16x32_bf16 v[92:95], a[100:103], a[4:7], v[92:95]
v_add_u32 v9, 0x8000, v9
v_add_u32 v10, 0x8000, v10
v_mfma_f32_16x16x32_bf16 v[92:95], a[96:99], a[0:3], v[92:95]
v_add_u32 v11, 0x8000, v11
v_bfe_u32 v18, v0, 2, 2
v_mfma_f32_16x16x32_bf16 v[32:35], a[104:107], a[0:3], v[32:35]
v_lshl_add_u32 v14, v14, 2, v18
v_and_b32 v18, 3, v0
v_mfma_f32_16x16x32_bf16 v[32:35], a[108:111], a[4:7], v[32:35]
v_lshlrev_b32 v18, 3, v18
v_lshl_add_u32 v18, v14, 8, v18
v_mfma_f32_16x16x32_bf16 v[48:51], a[108:111], a[12:15], v[48:51]
s_waitcnt lgkmcnt(0)
s_barrier
v_mfma_f32_16x16x32_bf16 v[48:51], a[104:107], a[8:11], v[48:51]
ds_read_b64_tr_b16 a[88:89], v19 offset:36864
v_and_b32 v14, 7, v14
v_mfma_f32_16x16x32_bf16 v[64:67], a[104:107], a[16:19], v[64:67]
ds_read_b64_tr_b16 a[90:91], v19 offset:37120
v_lshl_add_u32 v18, v14, 5, v18
v_mfma_f32_16x16x32_bf16 v[64:67], a[108:111], a[20:23], v[64:67]
ds_read_b64_tr_b16 a[92:93], v19 offset:38912
v_xor_b32 v18, s67, v18
v_mfma_f32_16x16x32_bf16 v[80:83], a[108:111], a[28:31], v[80:83]
ds_read_b64_tr_b16 a[94:95], v19 offset:39168
v_add_u32 v14, s66, v16
v_mfma_f32_16x16x32_bf16 v[80:83], a[104:107], a[24:27], v[80:83]
ds_read_b64_tr_b16 a[96:97], v20 offset:36864
v_xor_b32 v15, 0x800, v14
v_mfma_f32_16x16x32_bf16 v[144:147], a[112:115], a[24:27], v[144:147]
s_lshr_b32 s66, s30, 1
s_lshl_b32 s66, s66, 16
s_and_b32 s67, s30, 1
v_mfma_f32_16x16x32_bf16 v[144:147], a[116:119], a[28:31], v[144:147]
s_lshl_b32 s67, s67, 10
s_add_u32 s66, s66, s67
s_add_u32 s66, s66, 32768
v_mfma_f32_16x16x32_bf16 v[128:131], a[116:119], a[20:23], v[128:131]
ds_read_b64_tr_b16 a[98:99], v20 offset:37120
v_add_u32 v17, s66, v16
v_mfma_f32_16x16x32_bf16 v[128:131], a[112:115], a[16:19], v[128:131]
ds_read_b64_tr_b16 a[100:101], v20 offset:38912
v_lshlrev_b32 v21, 5, v0
v_mfma_f32_16x16x32_bf16 v[112:115], a[112:115], a[8:11], v[112:115]
s_lshl2_add_u32 s73, s2, s30
s_lshl_b32 s73, s73, 11
s_lshl_b32 s66, s30, 11
v_mfma_f32_16x16x32_bf16 v[112:115], a[116:119], a[12:15], v[112:115]
s_add_u32 s66, s66, 32768
ds_read_b64_tr_b16 a[102:103], v20 offset:39168
v_add_u32 v2, s66, v16
v_mfma_f32_16x16x32_bf16 v[96:99], a[116:119], a[4:7], v[96:99]
ds_read_b64_tr_b16 a[104:105], v19 offset:40960
v_add_u32 v3, 0x10000, v2
v_mfma_f32_16x16x32_bf16 v[96:99], a[112:115], a[0:3], v[96:99]
ds_read_b64_tr_b16 a[106:107], v19 offset:41216
v_mfma_f32_16x16x32_bf16 v[36:39], a[72:75], a[0:3], v[36:39]
ds_read_b64_tr_b16 a[108:109], v19 offset:43008
v_mfma_f32_16x16x32_bf16 v[36:39], a[76:79], a[4:7], v[36:39]
ds_read_b64_tr_b16 a[110:111], v19 offset:43264
v_mfma_f32_16x16x32_bf16 v[52:55], a[76:79], a[12:15], v[52:55]
ds_read_b64_tr_b16 a[112:113], v20 offset:40960
v_mfma_f32_16x16x32_bf16 v[52:55], a[72:75], a[8:11], v[52:55]
ds_read_b64_tr_b16 a[114:115], v20 offset:41216
v_mfma_f32_16x16x32_bf16 v[68:71], a[72:75], a[16:19], v[68:71]
ds_read_b64_tr_b16 a[116:117], v20 offset:43008
v_mfma_f32_16x16x32_bf16 v[68:71], a[76:79], a[20:23], v[68:71]
ds_read_b64_tr_b16 a[118:119], v20 offset:43264
v_mfma_f32_16x16x32_bf16 v[84:87], a[76:79], a[28:31], v[84:87]
v_mfma_f32_16x16x32_bf16 v[84:87], a[72:75], a[24:27], v[84:87]
ds_read_b64_tr_b16 a[72:73], v19 offset:32768
v_mfma_f32_16x16x32_bf16 v[148:151], a[80:83], a[24:27], v[148:151]
ds_read_b64_tr_b16 a[74:75], v19 offset:33024
v_mfma_f32_16x16x32_bf16 v[148:151], a[84:87], a[28:31], v[148:151]
ds_read_b64_tr_b16 a[76:77], v19 offset:34816
v_mfma_f32_16x16x32_bf16 v[132:135], a[84:87], a[20:23], v[132:135]
ds_read_b64_tr_b16 a[78:79], v19 offset:35072
v_mfma_f32_16x16x32_bf16 v[132:135], a[80:83], a[16:19], v[132:135]
v_mfma_f32_16x16x32_bf16 v[116:119], a[80:83], a[8:11], v[116:119]
v_mfma_f32_16x16x32_bf16 v[116:119], a[84:87], a[12:15], v[116:119]
v_mfma_f32_16x16x32_bf16 v[100:103], a[84:87], a[4:7], v[100:103]
v_mfma_f32_16x16x32_bf16 v[100:103], a[80:83], a[0:3], v[100:103]
s_waitcnt lgkmcnt(4)
ds_read_b64_tr_b16 a[80:81], v20 offset:32768
v_mfma_f32_16x16x32_bf16 v[184:187], a[88:91], a[32:35], v[184:187]
buffer_load_dword a252, v21, s[36:39], s73 offen
v_mfma_f32_16x16x32_bf16 v[184:187], a[92:95], a[36:39], v[184:187]
ds_read_b64_tr_b16 a[82:83], v20 offset:33024
v_bfe_u32 v1, v0, 1, 1
v_mfma_f32_16x16x32_bf16 v[192:195], a[92:95], a[44:47], v[192:195]
ds_read_b64_tr_b16 a[84:85], v20 offset:34816
v_subrev_u32 v1, 1, v1
v_mfma_f32_16x16x32_bf16 v[192:195], a[88:91], a[40:43], v[192:195]
ds_read_b64_tr_b16 a[86:87], v20 offset:35072
v_and_b32 v1, 0x3f803f80, v1
v_mfma_f32_16x16x32_bf16 v[200:203], a[88:91], a[48:51], v[200:203]
v_accvgpr_write_b32 a240, v1
v_accvgpr_write_b32 a241, v1
v_mfma_f32_16x16x32_bf16 v[200:203], a[92:95], a[52:55], v[200:203]
v_accvgpr_write_b32 a242, v1
v_accvgpr_write_b32 a243, v1
v_mfma_f32_16x16x32_bf16 v[208:211], a[92:95], a[60:63], v[208:211]
s_or_b32 s66, s3, s30
s_cmp_eq_u32 s66, 0
s_cselect_b32 s66, 0xff800000, 0
v_mfma_f32_16x16x32_bf16 v[208:211], a[88:91], a[56:59], v[208:211]
ds_read_b64_tr_b16 a[88:89], v4 offset:32768
v_mfma_f32_16x16x32_bf16 v[212:215], a[96:99], a[56:59], v[212:215]
ds_read_b64_tr_b16 a[90:91], v4 offset:33792
v_mfma_f32_16x16x32_bf16 v[212:215], a[100:103], a[60:63], v[212:215]
ds_read_b64_tr_b16 a[92:93], v4 offset:40960
v_mfma_f32_16x16x32_bf16 v[204:207], a[100:103], a[52:55], v[204:207]
ds_read_b64_tr_b16 a[94:95], v4 offset:41984
v_mfma_f32_16x16x32_bf16 v[204:207], a[96:99], a[48:51], v[204:207]
s_and_b32 s67, s74, 0x7800
s_cselect_b32 s67, 0, 0x70000000
s_add_u32 s77, s74, s67
v_mfma_f32_16x16x32_bf16 v[196:199], a[96:99], a[40:43], v[196:199]
s_sub_u32 s77, s77, 2048
v_mfma_f32_16x16x32_bf16 v[196:199], a[100:103], a[44:47], v[196:199]
s_mov_b32 s68, 0x3e0293ee
v_mfma_f32_16x16x32_bf16 v[188:191], a[100:103], a[36:39], v[188:191]
s_mov_b32 s69, s68
v_mfma_f32_16x16x32_bf16 v[188:191], a[96:99], a[32:35], v[188:191]
ds_read_b64_tr_b16 a[96:97], v5 offset:32768
v_mfma_f32_16x16x32_bf16 v[216:219], a[32:35], a[104:107], v[216:219]
ds_read_b64_tr_b16 a[98:99], v5 offset:33792
v_mfma_f32_16x16x32_bf16 v[216:219], a[36:39], a[108:111], v[216:219]
ds_read_b64_tr_b16 a[100:101], v5 offset:40960
v_cvt_pk_bf16_f32 v208, v208, v209
v_mfma_f32_16x16x32_bf16 v[224:227], a[44:47], a[108:111], v[224:227]
ds_read_b64_tr_b16 a[102:103], v5 offset:41984
v_cvt_pk_bf16_f32 v209, v210, v211
v_mfma_f32_16x16x32_bf16 v[224:227], a[40:43], a[104:107], v[224:227]
v_cvt_pk_bf16_f32 v210, v212, v213
v_cvt_pk_bf16_f32 v211, v214, v215
v_mfma_f32_16x16x32_bf16 v[232:235], a[48:51], a[104:107], v[232:235]
ds_write_b128 v3, v[208:211] offset:10240
v_mfma_f32_16x16x32_bf16 v[232:235], a[52:55], a[108:111], v[232:235]
v_cvt_pk_bf16_f32 v200, v200, v201
v_cvt_pk_bf16_f32 v201, v202, v203
v_mfma_f32_16x16x32_bf16 v[240:243], a[60:63], a[108:111], v[240:243]
v_cvt_pk_bf16_f32 v202, v204, v205
v_cvt_pk_bf16_f32 v203, v206, v207
v_mfma_f32_16x16x32_bf16 v[240:243], a[56:59], a[104:107], v[240:243]
ds_write_b128 v3, v[200:203] offset:2048
v_mfma_f32_16x16x32_bf16 v[244:247], a[56:59], a[112:115], v[244:247]
ds_read_b64_tr_b16 a[104:105], v6 offset:32768
v_cvt_pk_bf16_f32 v192, v192, v193
v_mfma_f32_16x16x32_bf16 v[244:247], a[60:63], a[116:119], v[244:247]
ds_read_b64_tr_b16 a[106:107], v6 offset:33792
v_cvt_pk_bf16_f32 v193, v194, v195
v_mfma_f32_16x16x32_bf16 v[236:239], a[52:55], a[116:119], v[236:239]
ds_read_b64_tr_b16 a[108:109], v6 offset:40960
v_cvt_pk_bf16_f32 v194, v196, v197
v_mfma_f32_16x16x32_bf16 v[236:239], a[48:51], a[112:115], v[236:239]
ds_read_b64_tr_b16 a[110:111], v6 offset:41984
v_cvt_pk_bf16_f32 v195, v198, v199
v_mfma_f32_16x16x32_bf16 v[228:231], a[40:43], a[112:115], v[228:231]
ds_write_b128 v2, v[192:195] offset:10240
v_mfma_f32_16x16x32_bf16 v[228:231], a[44:47], a[116:119], v[228:231]
v_cvt_pk_bf16_f32 v184, v184, v185
v_cvt_pk_bf16_f32 v185, v186, v187
v_mfma_f32_16x16x32_bf16 v[220:223], a[36:39], a[116:119], v[220:223]
v_cvt_pk_bf16_f32 v186, v188, v189
v_cvt_pk_bf16_f32 v187, v190, v191
v_mfma_f32_16x16x32_bf16 v[220:223], a[32:35], a[112:115], v[220:223]
s_waitcnt lgkmcnt(6)
ds_write_b128 v2, v[184:187] offset:2048
v_mfma_f32_16x16x32_bf16 v[152:155], a[72:75], a[32:35], v[152:155]
ds_read_b64_tr_b16 a[112:113], v7 offset:32768
v_cvt_pk_bf16_f32 v219, v218, v219
v_mfma_f32_16x16x32_bf16 v[152:155], a[76:79], a[36:39], v[152:155]
ds_read_b64_tr_b16 a[114:115], v7 offset:33792
v_cvt_pk_bf16_f32 v218, v216, v217
v_mfma_f32_16x16x32_bf16 v[160:163], a[76:79], a[44:47], v[160:163]
ds_write_b64 v2, v[218:219] offset:3072
v_mfma_f32_16x16x32_bf16 v[160:163], a[72:75], a[40:43], v[160:163]
ds_read_b64_tr_b16 a[116:117], v7 offset:40960
v_cvt_pk_bf16_f32 v227, v226, v227
v_mfma_f32_16x16x32_bf16 v[168:171], a[72:75], a[48:51], v[168:171]
ds_read_b64_tr_b16 a[118:119], v7 offset:41984
v_cvt_pk_bf16_f32 v226, v224, v225
v_mfma_f32_16x16x32_bf16 v[168:171], a[76:79], a[52:55], v[168:171]
ds_write_b64 v2, v[226:227] offset:11264
v_mfma_f32_16x16x32_bf16 v[176:179], a[76:79], a[60:63], v[176:179]
v_cvt_pk_bf16_f32 v235, v234, v235
v_cvt_pk_bf16_f32 v234, v232, v233
v_mfma_f32_16x16x32_bf16 v[176:179], a[72:75], a[56:59], v[176:179]
ds_write_b64 v3, v[234:235] offset:3072
v_mfma_f32_16x16x32_bf16 v[180:183], a[80:83], a[56:59], v[180:183]
ds_read_b64_tr_b16 a[72:73], v8 offset:32768
v_cvt_pk_bf16_f32 v243, v242, v243
v_mfma_f32_16x16x32_bf16 v[180:183], a[84:87], a[60:63], v[180:183]
ds_read_b64_tr_b16 a[74:75], v8 offset:33792
v_cvt_pk_bf16_f32 v242, v240, v241
v_mfma_f32_16x16x32_bf16 v[172:175], a[84:87], a[52:55], v[172:175]
ds_write_b64 v3, v[242:243] offset:11264
v_mfma_f32_16x16x32_bf16 v[172:175], a[80:83], a[48:51], v[172:175]
ds_read_b64_tr_b16 a[76:77], v8 offset:40960
v_cvt_pk_bf16_f32 v247, v246, v247
v_mfma_f32_16x16x32_bf16 v[164:167], a[80:83], a[40:43], v[164:167]
ds_read_b64_tr_b16 a[78:79], v8 offset:41984
v_cvt_pk_bf16_f32 v246, v244, v245
v_mfma_f32_16x16x32_bf16 v[164:167], a[84:87], a[44:47], v[164:167]
ds_write_b64 v3, v[246:247] offset:11272
v_mfma_f32_16x16x32_bf16 v[156:159], a[84:87], a[36:39], v[156:159]
v_cvt_pk_bf16_f32 v239, v238, v239
v_cvt_pk_bf16_f32 v238, v236, v237
v_mfma_f32_16x16x32_bf16 v[156:159], a[80:83], a[32:35], v[156:159]
ds_write_b64 v3, v[238:239] offset:3080
v_mfma_f32_16x16x32_bf16 v[24:27], a[88:91], a[32:35], v[24:27]
ds_read_b64_tr_b16 a[80:81], v9 offset:32768
v_cvt_pk_bf16_f32 v231, v230, v231
v_mfma_f32_16x16x32_bf16 v[24:27], a[92:95], a[36:39], v[24:27]
ds_read_b64_tr_b16 a[82:83], v9 offset:33792
v_cvt_pk_bf16_f32 v230, v228, v229
v_mfma_f32_16x16x32_bf16 v[40:43], a[92:95], a[44:47], v[40:43]
ds_write_b64 v2, v[230:231] offset:11272
v_mfma_f32_16x16x32_bf16 v[40:43], a[88:91], a[40:43], v[40:43]
ds_read_b64_tr_b16 a[84:85], v9 offset:40960
v_cvt_pk_bf16_f32 v223, v222, v223
v_mfma_f32_16x16x32_bf16 v[56:59], a[88:91], a[48:51], v[56:59]
ds_read_b64_tr_b16 a[86:87], v9 offset:41984
v_cvt_pk_bf16_f32 v222, v220, v221
v_mfma_f32_16x16x32_bf16 v[56:59], a[92:95], a[52:55], v[56:59]
ds_write_b64 v2, v[222:223] offset:3080
v_mfma_f32_16x16x32_bf16 v[72:75], a[92:95], a[60:63], v[72:75]
v_cvt_pk_bf16_f32 v176, v176, v177
v_cvt_pk_bf16_f32 v177, v178, v179
v_mfma_f32_16x16x32_bf16 v[72:75], a[88:91], a[56:59], v[72:75]
s_waitcnt lgkmcnt(0)
s_barrier
v_mfma_f32_16x16x32_bf16 v[136:139], a[96:99], a[56:59], v[136:139]
ds_read_b128 a[16:19], v17 offset:16384
v_cvt_pk_bf16_f32 v178, v180, v181
v_mfma_f32_16x16x32_bf16 v[136:139], a[100:103], a[60:63], v[136:139]
ds_read_b64_tr_b16 a[88:89], v10 offset:32768
v_cvt_pk_bf16_f32 v179, v182, v183
v_mfma_f32_16x16x32_bf16 v[120:123], a[100:103], a[52:55], v[120:123]
ds_read_b64_tr_b16 a[90:91], v10 offset:33792
v_cvt_pk_bf16_f32 v168, v168, v169
v_mfma_f32_16x16x32_bf16 v[120:123], a[96:99], a[48:51], v[120:123]
ds_read_b64_tr_b16 a[92:93], v10 offset:40960
v_cvt_pk_bf16_f32 v169, v170, v171
v_mfma_f32_16x16x32_bf16 v[104:107], a[96:99], a[40:43], v[104:107]
ds_read_b64_tr_b16 a[94:95], v10 offset:41984
v_cvt_pk_bf16_f32 v170, v172, v173
v_mfma_f32_16x16x32_bf16 v[104:107], a[100:103], a[44:47], v[104:107]
v_cvt_pk_bf16_f32 v171, v174, v175
v_cvt_pk_bf16_f32 v160, v160, v161
v_mfma_f32_16x16x32_bf16 v[88:91], a[100:103], a[36:39], v[88:91]
s_waitcnt lgkmcnt(4)
buffer_store_dwordx4 a[16:19], v16, s[44:47], s74 offen sc1
v_mfma_f32_16x16x32_bf16 v[88:91], a[96:99], a[32:35], v[88:91]
ds_read_b64_tr_b16 a[96:97], v11 offset:32768
v_cvt_pk_bf16_f32 v161, v162, v163
v_mfma_f32_16x16x32_bf16 v[28:31], a[104:107], a[32:35], v[28:31]
ds_read_b64_tr_b16 a[98:99], v11 offset:33792
v_cvt_pk_bf16_f32 v162, v164, v165
v_mfma_f32_16x16x32_bf16 v[28:31], a[108:111], a[36:39], v[28:31]
ds_read_b64_tr_b16 a[100:101], v11 offset:40960
v_cvt_pk_bf16_f32 v163, v166, v167
v_mfma_f32_16x16x32_bf16 v[44:47], a[108:111], a[44:47], v[44:47]
ds_read_b64_tr_b16 a[102:103], v11 offset:41984
v_cvt_pk_bf16_f32 v152, v152, v153
v_mfma_f32_16x16x32_bf16 v[44:47], a[104:107], a[40:43], v[44:47]
s_sub_u32 s81, s3, 1
ds_read_b128 a[4:7], v2 offset:8192
v_cvt_pk_bf16_f32 v153, v154, v155
v_mfma_f32_16x16x32_bf16 v[60:63], a[104:107], a[48:51], v[60:63]
s_sub_u32 s67, s3, 2
ds_read_b128 a[12:15], v3 offset:8192
v_cvt_pk_bf16_f32 v154, v156, v157
v_mfma_f32_16x16x32_bf16 v[60:63], a[108:111], a[52:55], v[60:63]
s_mul_i32 s81, s81, s67
ds_read_b64 v[224:225], v2 offset:9216
v_cvt_pk_bf16_f32 v155, v158, v159
v_mfma_f32_16x16x32_bf16 v[76:79], a[108:111], a[60:63], v[76:79]
s_lshl4_add_u32 s81, s81, s31
ds_read_b64 v[228:229], v2 offset:9224
v_or_b32 v20, s66, v252
v_mfma_f32_16x16x32_bf16 v[76:79], a[104:107], a[56:59], v[76:79]
s_lshl2_add_u32 s81, s81, s30
ds_read_b64 v[240:241], v3 offset:9216
v_or_b32 v21, s66, v253
v_mfma_f32_16x16x32_bf16 v[140:143], a[112:115], a[56:59], v[140:143]
s_mul_i32 s81, s81, 3328
ds_read_b64 v[244:245], v3 offset:9224
v_or_b32 v22, s66, v254
v_mfma_f32_16x16x32_bf16 v[140:143], a[116:119], a[60:63], v[140:143]
s_mov_b32 s73, 0
v_or_b32 v23, s66, v255
v_mfma_f32_16x16x32_bf16 v[124:127], a[116:119], a[52:55], v[124:127]
s_mov_b32 s72, 0x20000
s_mov_b32 s66, 0x3e8293ee
v_mul_f32 v72, s68, v72
v_mfma_f32_16x16x32_bf16 v[124:127], a[112:115], a[48:51], v[124:127]
s_lshl_b32 s67, s31, 15
v_mul_f32 v73, s68, v73
v_mul_f32 v74, s68, v74
v_mfma_f32_16x16x32_bf16 v[108:111], a[112:115], a[40:43], v[108:111]
s_add_u32 s67, s67, s78
v_mul_f32 v75, s68, v75
v_mul_f32 v136, s68, v136
v_mfma_f32_16x16x32_bf16 v[108:111], a[116:119], a[44:47], v[108:111]
s_add_u32 s67, s67, 33554432
v_mul_f32 v137, s68, v137
v_mul_f32 v138, s68, v138
v_mfma_f32_16x16x32_bf16 v[92:95], a[116:119], a[36:39], v[92:95]
s_mul_i32 s74, s3, 1310720
v_mul_f32 v139, s68, v139
v_cvt_pk_bf16_f32 v72, v72, v73
v_mfma_f32_16x16x32_bf16 v[92:95], a[112:115], a[32:35], v[92:95]
s_add_u32 s74, s74, s67
v_cvt_pk_bf16_f32 v73, v74, v75
v_cvt_pk_bf16_f32 v74, v136, v137
v_mfma_f32_16x16x32_bf16 v[32:35], a[72:75], a[32:35], v[32:35]
s_mul_i32 s75, s16, 1310720
v_cvt_pk_bf16_f32 v75, v138, v139
v_mul_f32 v56, s68, v56
v_mfma_f32_16x16x32_bf16 v[32:35], a[76:79], a[36:39], v[32:35]
s_add_u32 s75, s75, s67
v_mul_f32 v57, s68, v57
v_mul_f32 v58, s68, v58
v_mfma_f32_16x16x32_bf16 v[48:51], a[76:79], a[44:47], v[48:51]
s_mul_i32 s67, s31, 24576
v_mul_f32 v59, s68, v59
v_mul_f32 v120, s68, v120
v_mfma_f32_16x16x32_bf16 v[48:51], a[72:75], a[40:43], v[48:51]
s_sub_u32 s67, 1052672, s67
v_mul_f32 v121, s68, v121
v_mul_f32 v122, s68, v122
v_mfma_f32_16x16x32_bf16 v[64:67], a[72:75], a[48:51], v[64:67]
s_add_u32 s64, s74, s67
v_mul_f32 v123, s68, v123
v_cvt_pk_bf16_f32 v56, v56, v57
v_mfma_f32_16x16x32_bf16 v[64:67], a[76:79], a[52:55], v[64:67]
s_add_u32 s65, s75, s67
v_cvt_pk_bf16_f32 v57, v58, v59
v_cvt_pk_bf16_f32 v58, v120, v121
v_mfma_f32_16x16x32_bf16 v[80:83], a[76:79], a[60:63], v[80:83]
s_and_b32 s70, s30, 1
v_cvt_pk_bf16_f32 v59, v122, v123
v_mul_f32 v40, s68, v40
v_mfma_f32_16x16x32_bf16 v[80:83], a[72:75], a[56:59], v[80:83]
s_lshr_b32 s67, s30, 1
v_mul_f32 v41, s68, v41
v_mul_f32 v42, s68, v42
v_mfma_f32_16x16x32_bf16 v[144:147], a[80:83], a[56:59], v[144:147]
s_lshl3_add_u32 s71, s67, s70
v_mul_f32 v43, s68, v43
v_mul_f32 v104, s68, v104
v_mfma_f32_16x16x32_bf16 v[144:147], a[84:87], a[60:63], v[144:147]
s_add_u32 s71, s71, 4
v_mul_f32 v105, s68, v105
v_mul_f32 v106, s68, v106
v_mfma_f32_16x16x32_bf16 v[128:131], a[84:87], a[52:55], v[128:131]
s_lshl_b32 s71, s71, 13
v_mul_f32 v107, s68, v107
v_cvt_pk_bf16_f32 v40, v40, v41
v_mfma_f32_16x16x32_bf16 v[128:131], a[80:83], a[48:51], v[128:131]
s_lshl_b32 s70, s70, 14
v_cvt_pk_bf16_f32 v41, v42, v43
v_cvt_pk_bf16_f32 v42, v104, v105
v_mfma_f32_16x16x32_bf16 v[112:115], a[80:83], a[40:43], v[112:115]
s_mul_i32 s67, s67, 24576
v_cvt_pk_bf16_f32 v43, v106, v107
v_mul_f32 v24, s68, v24
v_mfma_f32_16x16x32_bf16 v[112:115], a[84:87], a[44:47], v[112:115]
s_sub_u32 s70, s70, s67
v_mul_f32 v25, s68, v25
v_mul_f32 v26, s68, v26
v_mfma_f32_16x16x32_bf16 v[96:99], a[84:87], a[36:39], v[96:99]
s_add_u32 s70, s70, 65536
v_mul_f32 v27, s68, v27
v_mul_f32 v88, s68, v88
v_mfma_f32_16x16x32_bf16 v[96:99], a[80:83], a[32:35], v[96:99]
s_waitcnt lgkmcnt(0)
v_mul_f32 v89, s68, v89
v_mul_f32 v90, s68, v90
v_mfma_f32_16x16x32_bf16 v[36:39], a[88:91], a[32:35], v[36:39]
v_mul_f32 v91, s68, v91
v_cvt_pk_bf16_f32 v24, v24, v25
v_mfma_f32_16x16x32_bf16 v[36:39], a[92:95], a[36:39], v[36:39]
v_cvt_pk_bf16_f32 v25, v26, v27
v_cvt_pk_bf16_f32 v26, v88, v89
v_mfma_f32_16x16x32_bf16 v[52:55], a[92:95], a[44:47], v[52:55]
v_cvt_pk_bf16_f32 v27, v90, v91
v_mul_f32 v76, s68, v76
v_mfma_f32_16x16x32_bf16 v[52:55], a[88:91], a[40:43], v[52:55]
v_mul_f32 v77, s68, v77
v_mul_f32 v78, s68, v78
v_mfma_f32_16x16x32_bf16 v[68:71], a[88:91], a[48:51], v[68:71]
v_mul_f32 v79, s68, v79
v_mul_f32 v140, s68, v140
v_mfma_f32_16x16x32_bf16 v[68:71], a[92:95], a[52:55], v[68:71]
v_mul_f32 v141, s68, v141
v_mul_f32 v142, s68, v142
v_mfma_f32_16x16x32_bf16 v[84:87], a[92:95], a[60:63], v[84:87]
v_mul_f32 v143, s68, v143
v_cvt_pk_bf16_f32 v76, v76, v77
v_mfma_f32_16x16x32_bf16 v[84:87], a[88:91], a[56:59], v[84:87]
v_cvt_pk_bf16_f32 v77, v78, v79
v_cvt_pk_bf16_f32 v78, v140, v141
v_mfma_f32_16x16x32_bf16 v[148:151], a[96:99], a[56:59], v[148:151]
v_cvt_pk_bf16_f32 v79, v142, v143
v_mul_f32 v60, s68, v60
v_mfma_f32_16x16x32_bf16 v[148:151], a[100:103], a[60:63], v[148:151]
v_mul_f32 v61, s68, v61
v_mul_f32 v62, s68, v62
v_mfma_f32_16x16x32_bf16 v[132:135], a[100:103], a[52:55], v[132:135]
v_mul_f32 v63, s68, v63
v_mul_f32 v124, s68, v124
v_mfma_f32_16x16x32_bf16 v[132:135], a[96:99], a[48:51], v[132:135]
v_mul_f32 v125, s68, v125
v_mul_f32 v126, s68, v126
v_mfma_f32_16x16x32_bf16 v[116:119], a[96:99], a[40:43], v[116:119]
v_mul_f32 v127, s68, v127
v_cvt_pk_bf16_f32 v60, v60, v61
v_mfma_f32_16x16x32_bf16 v[116:119], a[100:103], a[44:47], v[116:119]
v_cvt_pk_bf16_f32 v61, v62, v63
v_cvt_pk_bf16_f32 v62, v124, v125
v_mfma_f32_16x16x32_bf16 v[100:103], a[100:103], a[36:39], v[100:103]
v_cvt_pk_bf16_f32 v63, v126, v127
v_mfma_f32_16x16x32_bf16 v[100:103], a[96:99], a[32:35], v[100:103]
buffer_load_dwordx4 v[88:91], v16, s[44:47], s77 offen sc1
v_mfma_f32_16x16x32_bf16 v[196:199], v[192:195], v[160:163], v[248:251]
v_mfma_f32_16x16x32_bf16 v[212:215], v[208:211], v[176:179], v[248:251]
v_mfma_f32_16x16x32_bf16 v[164:167], a[4:7], v[160:163], v[252:255]
v_mfma_f32_16x16x32_bf16 v[180:183], a[12:15], v[176:179], v[252:255]
s_waitcnt vmcnt(18)
s_waitcnt vmcnt(20)
s_waitcnt vmcnt(21)
s_waitcnt vmcnt(22)
v_accvgpr_read_b32 v4, a64
v_accvgpr_read_b32 v5, a65
v_accvgpr_read_b32 v6, a66
v_accvgpr_read_b32 v7, a67
v_accvgpr_read_b32 v8, a68
v_accvgpr_read_b32 v9, a69
v_accvgpr_read_b32 v10, a70
v_accvgpr_read_b32 v11, a71
v_max3_f32 v121, v196, v197, v198
v_max3_f32 v121, v121, v199, v164
v_max3_f32 v121, v121, v165, v166
v_max_f32 v121, v121, v167
v_max3_f32 v123, v212, v213, v214
v_max3_f32 v123, v123, v215, v180
v_max3_f32 v123, v123, v181, v182
v_max_f32 v123, v123, v183
v_mov_b32 v105, v121
v_mov_b32 v107, v123
v_pk_mul_f32 v[28:29], v[28:29], s[68:69]
v_permlane16_swap_b32 v105, v121
v_permlane16_swap_b32 v107, v123
v_max_f32 v121, v121, v105
v_max_f32 v123, v123, v107
v_mov_b32 v105, v121
v_mov_b32 v107, v123
v_pk_mul_f32 v[30:31], v[30:31], s[68:69]
v_permlane32_swap_b32 v105, v121
v_permlane32_swap_b32 v107, v123
v_max_f32 v121, v121, v105
v_max_f32 v123, v123, v107
v_mul_f32 v121, s66, v121
v_mul_f32 v123, s66, v123
v_fma_f32 v164, v164, s66, -v121
v_fma_f32 v165, v165, s66, -v121
v_fma_f32 v166, v166, s66, -v121
v_fma_f32 v167, v167, s66, -v121
v_fma_f32 v196, v196, s66, -v121
v_fma_f32 v197, v197, s66, -v121
v_fma_f32 v198, v198, s66, -v121
v_fma_f32 v199, v199, s66, -v121
v_exp_f32 v164, v164
v_exp_f32 v165, v165
v_exp_f32 v166, v166
v_exp_f32 v167, v167
v_exp_f32 v196, v196
v_exp_f32 v197, v197
v_exp_f32 v198, v198
v_exp_f32 v199, v199
v_cvt_pk_bf16_f32 v164, v164, v165
v_cvt_pk_bf16_f32 v165, v166, v167
v_cvt_pk_bf16_f32 v166, v196, v197
v_cvt_pk_bf16_f32 v167, v198, v199
v_pk_mul_f32 v[92:93], v[92:93], s[68:69]
v_pk_mul_f32 v[94:95], v[94:95], s[68:69]
v_mfma_f32_16x16x32_bf16 v[196:199], a[244:247], v[164:167], 0
v_mfma_f32_16x16x32_bf16 v[160:163], v[224:227], v[164:167], 0
v_mfma_f32_16x16x32_bf16 v[192:195], v[228:231], v[164:167], 0
v_fma_f32 v180, v180, s66, -v123
v_fma_f32 v181, v181, s66, -v123
v_fma_f32 v182, v182, s66, -v123
v_fma_f32 v183, v183, s66, -v123
v_fma_f32 v212, v212, s66, -v123
v_fma_f32 v213, v213, s66, -v123
v_fma_f32 v214, v214, s66, -v123
v_fma_f32 v215, v215, s66, -v123
v_exp_f32 v180, v180
v_exp_f32 v181, v181
v_exp_f32 v182, v182
v_exp_f32 v183, v183
v_exp_f32 v212, v212
v_exp_f32 v213, v213
v_exp_f32 v214, v214
v_exp_f32 v215, v215
v_cvt_pk_bf16_f32 v180, v180, v181
v_cvt_pk_bf16_f32 v181, v182, v183
v_cvt_pk_bf16_f32 v182, v212, v213
v_cvt_pk_bf16_f32 v183, v214, v215
v_cvt_pk_bf16_f32 v28, v28, v29
v_cvt_pk_bf16_f32 v29, v30, v31
v_mfma_f32_16x16x32_bf16 v[212:215], a[244:247], v[180:183], 0
s_branch L_po14
L_pg14:
s_branch L_pg18
L_po14:
v_mfma_f32_16x16x32_bf16 v[176:179], v[240:243], v[180:183], 0
v_mfma_f32_16x16x32_bf16 v[208:211], v[244:247], v[180:183], 0
v_cvt_pk_bf16_f32 v30, v92, v93
v_cvt_pk_bf16_f32 v31, v94, v95
v_pk_mul_f32 v[44:45], v[44:45], s[68:69]
v_pk_mul_f32 v[46:47], v[46:47], s[68:69]
v_pk_mul_f32 v[108:109], v[108:109], s[68:69]
v_pk_mul_f32 v[110:111], v[110:111], s[68:69]
v_rcp_f32 v121, v196
v_rcp_f32 v123, v212
v_mul_f32 v121, v121, v7
v_mul_f32 v123, v123, v11
v_mul_f32 v160, v160, v121
v_mul_f32 v161, v161, v121
v_mul_f32 v162, v162, v121
v_mul_f32 v163, v163, v121
v_mul_f32 v192, v192, v121
v_mul_f32 v193, v193, v121
v_mul_f32 v194, v194, v121
v_mul_f32 v195, v195, v121
v_cvt_pk_bf16_f32 v160, v160, v161
v_cvt_pk_bf16_f32 v161, v162, v163
v_cvt_pk_bf16_f32 v162, v192, v193
v_cvt_pk_bf16_f32 v163, v194, v195
buffer_store_dwordx4 v[160:163], v16, s[44:47], s64 offen sc1
v_mul_f32 v176, v176, v123
v_mul_f32 v177, v177, v123
v_mul_f32 v178, v178, v123
v_mul_f32 v179, v179, v123
v_mul_f32 v208, v208, v123
v_mul_f32 v209, v209, v123
v_mul_f32 v210, v210, v123
v_mul_f32 v211, v211, v123
v_cvt_pk_bf16_f32 v176, v176, v177
v_cvt_pk_bf16_f32 v177, v178, v179
v_cvt_pk_bf16_f32 v178, v208, v209
v_cvt_pk_bf16_f32 v179, v210, v211
buffer_store_dwordx4 v[176:179], v16, s[44:47], s65 offen sc1
v_cvt_pk_bf16_f32 v44, v44, v45
v_cvt_pk_bf16_f32 v45, v46, v47
v_cvt_pk_bf16_f32 v46, v108, v109
v_cvt_pk_bf16_f32 v47, v110, v111
v_pk_mul_f32 v[32:33], v[32:33], s[68:69]
v_pk_mul_f32 v[34:35], v[34:35], s[68:69]
v_pk_mul_f32 v[96:97], v[96:97], s[68:69]
v_pk_mul_f32 v[98:99], v[98:99], s[68:69]
v_cvt_pk_bf16_f32 v32, v32, v33
v_cvt_pk_bf16_f32 v33, v34, v35
v_cvt_pk_bf16_f32 v34, v96, v97
v_cvt_pk_bf16_f32 v35, v98, v99
v_pk_mul_f32 v[48:49], v[48:49], s[68:69]
v_pk_mul_f32 v[50:51], v[50:51], s[68:69]
v_pk_mul_f32 v[112:113], v[112:113], s[68:69]
v_pk_mul_f32 v[114:115], v[114:115], s[68:69]
v_cvt_pk_bf16_f32 v48, v48, v49
v_cvt_pk_bf16_f32 v49, v50, v51
v_cvt_pk_bf16_f32 v50, v112, v113
v_cvt_pk_bf16_f32 v51, v114, v115
v_pk_mul_f32 v[64:65], v[64:65], s[68:69]
v_pk_mul_f32 v[66:67], v[66:67], s[68:69]
v_pk_mul_f32 v[128:129], v[128:129], s[68:69]
v_pk_mul_f32 v[130:131], v[130:131], s[68:69]
s_waitcnt vmcnt(2)
L_hchk:
v_max3_u32 v1, v88, v89, v90
v_max_u32 v1, v1, v91
v_cmp_eq_u32 vcc, -1, v1
s_cbranch_vccnz L_hretry
L_hgo:
ds_write_b128 v17, v[88:91]
s_sub_u32 s64, s64, 4096
s_sub_u32 s65, s65, 4096
v_cvt_pk_bf16_f32 v64, v64, v65
v_cvt_pk_bf16_f32 v65, v66, v67
v_cvt_pk_bf16_f32 v66, v128, v129
v_cvt_pk_bf16_f32 v67, v130, v131
v_pk_mul_f32 v[80:81], v[80:81], s[68:69]
v_pk_mul_f32 v[82:83], v[82:83], s[68:69]
v_pk_mul_f32 v[144:145], v[144:145], s[68:69]
v_pk_mul_f32 v[146:147], v[146:147], s[68:69]
s_waitcnt lgkmcnt(0)
s_barrier
ds_read_b128 a[0:3], v2 offset:0
ds_read_b128 a[8:11], v3 offset:0
ds_read_b64 v[216:217], v2 offset:1024
ds_read_b64 v[220:221], v2 offset:1032
ds_read_b64 v[232:233], v3 offset:1024
ds_read_b64 v[236:237], v3 offset:1032
v_cvt_pk_bf16_f32 v80, v80, v81
v_cvt_pk_bf16_f32 v81, v82, v83
v_cvt_pk_bf16_f32 v82, v144, v145
v_cvt_pk_bf16_f32 v83, v146, v147
v_pk_mul_f32 v[36:37], v[36:37], s[68:69]
v_pk_mul_f32 v[38:39], v[38:39], s[68:69]
v_pk_mul_f32 v[100:101], v[100:101], s[68:69]
v_pk_mul_f32 v[102:103], v[102:103], s[68:69]
v_cvt_pk_bf16_f32 v36, v36, v37
v_cvt_pk_bf16_f32 v37, v38, v39
v_cvt_pk_bf16_f32 v38, v100, v101
v_cvt_pk_bf16_f32 v39, v102, v103
v_pk_mul_f32 v[52:53], v[52:53], s[68:69]
v_pk_mul_f32 v[54:55], v[54:55], s[68:69]
v_pk_mul_f32 v[116:117], v[116:117], s[68:69]
v_pk_mul_f32 v[118:119], v[118:119], s[68:69]
v_mfma_f32_16x16x32_bf16 v[188:191], v[184:187], v[152:155], v[248:251]
v_mfma_f32_16x16x32_bf16 v[204:207], v[200:203], v[168:171], v[248:251]
s_waitcnt lgkmcnt(5)
v_mfma_f32_16x16x32_bf16 v[156:159], a[0:3], v[152:155], v[20:23]
s_waitcnt lgkmcnt(4)
v_mfma_f32_16x16x32_bf16 v[172:175], a[8:11], v[168:171], v[252:255]
v_cvt_pk_bf16_f32 v52, v52, v53
v_cvt_pk_bf16_f32 v53, v54, v55
v_cvt_pk_bf16_f32 v54, v116, v117
v_cvt_pk_bf16_f32 v55, v118, v119
v_pk_mul_f32 v[68:69], v[68:69], s[68:69]
v_pk_mul_f32 v[70:71], v[70:71], s[68:69]
v_pk_mul_f32 v[132:133], v[132:133], s[68:69]
v_pk_mul_f32 v[134:135], v[134:135], s[68:69]
v_max3_f32 v120, v188, v189, v190
v_max3_f32 v120, v120, v191, v156
v_max3_f32 v120, v120, v157, v158
v_max_f32 v120, v120, v159
v_max3_f32 v122, v204, v205, v206
v_max3_f32 v122, v122, v207, v172
v_max3_f32 v122, v122, v173, v174
v_max_f32 v122, v122, v175
v_mov_b32 v104, v120
v_mov_b32 v106, v122
v_cvt_pk_bf16_f32 v68, v68, v69
v_permlane16_swap_b32 v104, v120
v_permlane16_swap_b32 v106, v122
v_max_f32 v120, v120, v104
v_max_f32 v122, v122, v106
v_mov_b32 v104, v120
v_mov_b32 v106, v122
v_cvt_pk_bf16_f32 v69, v70, v71
v_permlane32_swap_b32 v104, v120
v_permlane32_swap_b32 v106, v122
v_max_f32 v120, v120, v104
v_max_f32 v122, v122, v106
v_mul_f32 v120, s66, v120
v_mul_f32 v122, s66, v122
v_fma_f32 v156, v156, s66, -v120
v_fma_f32 v157, v157, s66, -v120
v_fma_f32 v158, v158, s66, -v120
v_fma_f32 v159, v159, s66, -v120
v_fma_f32 v188, v188, s66, -v120
v_fma_f32 v189, v189, s66, -v120
v_fma_f32 v190, v190, s66, -v120
v_fma_f32 v191, v191, s66, -v120
v_exp_f32 v156, v156
v_exp_f32 v157, v157
v_exp_f32 v158, v158
v_exp_f32 v159, v159
v_exp_f32 v188, v188
v_exp_f32 v189, v189
v_exp_f32 v190, v190
v_exp_f32 v191, v191
v_cvt_pk_bf16_f32 v156, v156, v157
v_cvt_pk_bf16_f32 v157, v158, v159
v_cvt_pk_bf16_f32 v158, v188, v189
v_cvt_pk_bf16_f32 v159, v190, v191
v_cvt_pk_bf16_f32 v70, v132, v133
v_cvt_pk_bf16_f32 v71, v134, v135
v_mfma_f32_16x16x32_bf16 v[188:191], a[244:247], v[156:159], 0
s_waitcnt lgkmcnt(3)
v_mfma_f32_16x16x32_bf16 v[152:155], v[216:219], v[156:159], 0
s_waitcnt lgkmcnt(2)
v_mfma_f32_16x16x32_bf16 v[184:187], v[220:223], v[156:159], 0
v_fma_f32 v172, v172, s66, -v122
v_fma_f32 v173, v173, s66, -v122
v_fma_f32 v174, v174, s66, -v122
v_fma_f32 v175, v175, s66, -v122
v_fma_f32 v204, v204, s66, -v122
v_fma_f32 v205, v205, s66, -v122
v_fma_f32 v206, v206, s66, -v122
v_fma_f32 v207, v207, s66, -v122
v_exp_f32 v172, v172
v_exp_f32 v173, v173
v_exp_f32 v174, v174
v_exp_f32 v175, v175
v_exp_f32 v204, v204
v_exp_f32 v205, v205
v_exp_f32 v206, v206
v_exp_f32 v207, v207
v_cvt_pk_bf16_f32 v172, v172, v173
v_cvt_pk_bf16_f32 v173, v174, v175
v_cvt_pk_bf16_f32 v174, v204, v205
v_cvt_pk_bf16_f32 v175, v206, v207
v_pk_mul_f32 v[84:85], v[84:85], s[68:69]
v_pk_mul_f32 v[86:87], v[86:87], s[68:69]
v_mfma_f32_16x16x32_bf16 v[204:207], a[244:247], v[172:175], 0
s_waitcnt lgkmcnt(1)
v_mfma_f32_16x16x32_bf16 v[168:171], v[232:235], v[172:175], 0
s_waitcnt lgkmcnt(0)
v_mfma_f32_16x16x32_bf16 v[200:203], v[236:239], v[172:175], 0
v_mov_b32 v2, v16
v_add_u32 v3, 0x10000, v16
v_mov_b32 v1, 0
s_mov_b32 m0, s71
s_waitcnt lgkmcnt(0)
s_barrier
ds_read_b128 a[144:147], v2 offset:0
ds_read_b128 a[148:151], v2 offset:1024
ds_read_b128 a[152:155], v2 offset:2048
ds_read_b128 a[156:159], v2 offset:3072
ds_read_b128 a[160:163], v2 offset:4096
ds_read_b128 a[164:167], v2 offset:5120
ds_read_b128 a[168:171], v2 offset:6144
ds_read_b128 a[172:175], v2 offset:7168
buffer_load_dwordx4 v16, s[32:35], s70 offen offset:0 sc1 lds
buffer_load_dwordx4 v16, s[32:35], s70 offen offset:1024 sc1 lds
v_pk_mul_f32 v[148:149], v[148:149], s[68:69]
v_pk_mul_f32 v[150:151], v[150:151], s[68:69]
v_cvt_pk_bf16_f32 v84, v84, v85
v_cvt_pk_bf16_f32 v85, v86, v87
v_cvt_pk_bf16_f32 v86, v148, v149
v_cvt_pk_bf16_f32 v87, v150, v151
v_rcp_f32 v120, v188
v_rcp_f32 v122, v204
v_mul_f32 v120, v120, v5
v_mul_f32 v122, v122, v9
v_mul_f32 v152, v152, v120
v_mul_f32 v153, v153, v120
v_mul_f32 v154, v154, v120
v_mul_f32 v155, v155, v120
v_mul_f32 v184, v184, v120
v_mul_f32 v185, v185, v120
v_mul_f32 v186, v186, v120
v_mul_f32 v187, v187, v120
v_cvt_pk_bf16_f32 v152, v152, v153
v_cvt_pk_bf16_f32 v153, v154, v155
v_cvt_pk_bf16_f32 v154, v184, v185
v_cvt_pk_bf16_f32 v155, v186, v187
buffer_store_dwordx4 v[152:155], v16, s[44:47], s64 offen sc1
v_mul_f32 v168, v168, v122
v_mul_f32 v169, v169, v122
v_mul_f32 v170, v170, v122
v_mul_f32 v171, v171, v122
v_mul_f32 v200, v200, v122
v_mul_f32 v201, v201, v122
v_mul_f32 v202, v202, v122
v_mul_f32 v203, v203, v122
v_cvt_pk_bf16_f32 v168, v168, v169
v_cvt_pk_bf16_f32 v169, v170, v171
v_cvt_pk_bf16_f32 v170, v200, v201
v_cvt_pk_bf16_f32 v171, v202, v203
buffer_store_dwordx4 v[168:171], v16, s[44:47], s65 offen sc1
v_mov_b32 v17, 0xff800000
v_and_b32 v5, 1, v0
v_mul_u32_u24 v5, 0xaaaa, v5
v_add_u32 v5, 0x4444, v5
v_lshl_or_b32 v5, v5, 16, v5
L_attstart_7:
s_cmp_eq_u32 s3, 0
s_cbranch_scc1 L_F1
s_waitcnt lgkmcnt(7)
v_mfma_f32_16x16x32_bf16 v[88:91], a[144:147], v[24:27], 0
s_waitcnt lgkmcnt(6)
ds_read_b128 a[176:179], v2 offset:8192
v_accvgpr_write_b32 a128, 0
v_mfma_f32_16x16x32_bf16 v[88:91], a[148:151], v[28:31], v[88:91]
s_waitcnt lgkmcnt(6)
ds_read_b128 a[180:183], v2 offset:9216
v_accvgpr_write_b32 a129, 0
v_mfma_f32_16x16x32_bf16 v[88:91], a[152:155], v[32:35], v[88:91]
s_waitcnt lgkmcnt(6)
buffer_load_dwordx4 v16, s[32:35], s70 offen offset:2048 sc1 lds
v_mfma_f32_16x16x32_bf16 v[88:91], a[156:159], v[36:39], v[88:91]
ds_read_b128 a[184:187], v2 offset:10240
v_accvgpr_write_b32 a130, 0
v_mfma_f32_16x16x32_bf16 v[104:107], a[156:159], v[52:55], 0
ds_read_b128 a[188:191], v2 offset:11264
v_accvgpr_write_b32 a131, 0
v_mfma_f32_16x16x32_bf16 v[104:107], a[152:155], v[48:51], v[104:107]
ds_read_b128 a[192:195], v2 offset:12288
v_accvgpr_write_b32 a132, 0
v_mfma_f32_16x16x32_bf16 v[104:107], a[148:151], v[44:47], v[104:107]
ds_read_b128 a[196:199], v2 offset:13312
v_accvgpr_write_b32 a133, 0
v_mfma_f32_16x16x32_bf16 v[104:107], a[144:147], v[40:43], v[104:107]
ds_read_b128 a[200:203], v2 offset:14336
v_accvgpr_write_b32 a134, 0
v_mfma_f32_16x16x32_bf16 v[120:123], a[144:147], v[56:59], 0
ds_read_b128 a[204:207], v2 offset:15360
v_accvgpr_write_b32 a135, 0
v_mfma_f32_16x16x32_bf16 v[120:123], a[148:151], v[60:63], v[120:123]
buffer_load_dwordx4 v16, s[32:35], s70 offen offset:3072 sc1 lds
v_mfma_f32_16x16x32_bf16 v[120:123], a[152:155], v[64:67], v[120:123]
v_accvgpr_write_b32 a136, 0
v_accvgpr_write_b32 a137, 0
v_mfma_f32_16x16x32_bf16 v[120:123], a[156:159], v[68:71], v[120:123]
v_accvgpr_write_b32 a138, 0
v_accvgpr_write_b32 a139, 0
v_mfma_f32_16x16x32_bf16 v[136:139], a[156:159], v[84:87], 0
v_accvgpr_write_b32 a140, 0
v_accvgpr_write_b32 a141, 0
v_mfma_f32_16x16x32_bf16 v[136:139], a[152:155], v[80:83], v[136:139]
v_accvgpr_write_b32 a142, 0
v_accvgpr_write_b32 a143, 0
v_mfma_f32_16x16x32_bf16 v[136:139], a[148:151], v[76:79], v[136:139]
v_mfma_f32_16x16x32_bf16 v[136:139], a[144:147], v[72:75], v[136:139]
s_waitcnt lgkmcnt(0)
s_nop 1
v_max3_f32 v20, v88, v89, v90
v_max_f32 v20, v20, v91
v_max3_f32 v21, v104, v105, v106
v_max_f32 v21, v21, v107
v_max3_f32 v22, v120, v121, v122
v_max_f32 v22, v22, v123
v_max3_f32 v23, v136, v137, v138
v_max_f32 v23, v23, v139
v_mov_b32 v248, v20
v_mov_b32 v249, v21
v_mov_b32 v250, v22
v_mov_b32 v251, v23
v_permlane16_swap_b32 v248, v20
v_permlane16_swap_b32 v249, v21
v_permlane16_swap_b32 v250, v22
v_permlane16_swap_b32 v251, v23
v_max_f32 v20, v20, v248
v_max_f32 v21, v21, v249
v_max_f32 v22, v22, v250
v_max_f32 v23, v23, v251
v_mov_b32 v248, v20
v_mov_b32 v249, v21
v_mov_b32 v250, v22
v_mov_b32 v251, v23
v_permlane32_swap_b32 v248, v20
v_permlane32_swap_b32 v249, v21
v_permlane32_swap_b32 v250, v22
v_permlane32_swap_b32 v251, v23
v_max_f32 v20, v20, v248
v_max_f32 v21, v21, v249
v_max_f32 v22, v22, v250
v_max_f32 v23, v23, v251
s_cmp_eq_u32 s73, 0
s_cselect_b64 vcc, 0, -1
v_cndmask_b32 v20, v20, v252, vcc
v_cndmask_b32 v21, v21, v253, vcc
v_cndmask_b32 v22, v22, v254, vcc
v_cndmask_b32 v23, v23, v255, vcc
v_sub_f32 v228, 0, v23
v_sub_f32 v229, 0, v23
v_sub_f32 v230, 0, v23
v_sub_f32 v231, 0, v23
v_sub_f32 v224, 0, v22
v_sub_f32 v225, 0, v22
v_sub_f32 v226, 0, v22
v_sub_f32 v227, 0, v22
v_sub_f32 v220, 0, v21
v_sub_f32 v221, 0, v21
v_sub_f32 v222, 0, v21
v_sub_f32 v223, 0, v21
v_sub_f32 v216, 0, v20
v_sub_f32 v217, 0, v20
v_sub_f32 v218, 0, v20
v_sub_f32 v219, 0, v20
v_mfma_f32_16x16x32_bf16 v[140:143], a[160:163], v[72:75], v[228:231]
s_add_u32 m0, s71, 4096
v_add_f32 v88, v88, v216
v_add_f32 v89, v89, v216
v_mfma_f32_16x16x32_bf16 v[140:143], a[164:167], v[76:79], v[140:143]
v_add_f32 v90, v90, v216
v_add_f32 v91, v91, v216
v_exp_f32 v88, v88
v_mfma_f32_16x16x32_bf16 v[140:143], a[168:171], v[80:83], v[140:143]
s_add_u32 s64, s70, 4096
v_exp_f32 v89, v89
v_mfma_f32_16x16x32_bf16 v[140:143], a[172:175], v[84:87], v[140:143]
buffer_load_dwordx4 v16, s[32:35], s64 offen offset:0 sc1 lds
v_mfma_f32_16x16x32_bf16 v[124:127], a[172:175], v[68:71], v[224:227]
v_exp_f32 v90, v90
v_mfma_f32_16x16x32_bf16 v[124:127], a[168:171], v[64:67], v[124:127]
v_exp_f32 v91, v91
v_mfma_f32_16x16x32_bf16 v[124:127], a[164:167], v[60:63], v[124:127]
v_add_f32 v104, v104, v220
v_add_f32 v105, v105, v220
v_add_f32 v106, v106, v220
v_add_f32 v107, v107, v220
v_exp_f32 v104, v104
v_mfma_f32_16x16x32_bf16 v[124:127], a[160:163], v[56:59], v[124:127]
v_exp_f32 v105, v105
v_mfma_f32_16x16x32_bf16 v[108:111], a[160:163], v[40:43], v[220:223]
v_exp_f32 v106, v106
v_mfma_f32_16x16x32_bf16 v[108:111], a[164:167], v[44:47], v[108:111]
buffer_load_dwordx4 v16, s[32:35], s64 offen offset:1024 sc1 lds
v_mfma_f32_16x16x32_bf16 v[108:111], a[168:171], v[48:51], v[108:111]
v_cvt_pk_bf16_f32 v152, v88, v89
v_add_f32 v120, v120, v224
v_mfma_f32_16x16x32_bf16 v[108:111], a[172:175], v[52:55], v[108:111]
v_exp_f32 v107, v107
v_mfma_f32_16x16x32_bf16 v[92:95], a[172:175], v[36:39], v[216:219]
v_add_f32 v121, v121, v224
v_add_f32 v122, v122, v224
v_add_f32 v123, v123, v224
v_exp_f32 v120, v120
v_mfma_f32_16x16x32_bf16 v[92:95], a[168:171], v[32:35], v[92:95]
v_cvt_pk_bf16_f32 v153, v90, v91
v_exp_f32 v121, v121
v_mfma_f32_16x16x32_bf16 v[92:95], a[164:167], v[28:31], v[92:95]
v_exp_f32 v122, v122
v_mfma_f32_16x16x32_bf16 v[92:95], a[160:163], v[24:27], v[92:95]
v_exp_f32 v123, v123
v_mfma_f32_16x16x32_bf16 v[96:99], a[176:179], v[24:27], v[216:219]
v_cvt_pk_bf16_f32 v160, v104, v105
v_add_f32 v136, v136, v228
v_mfma_f32_16x16x32_bf16 v[96:99], a[180:183], v[28:31], v[96:99]
buffer_load_dwordx4 v16, s[32:35], s64 offen offset:2048 sc1 lds
v_add_f32 v137, v137, v228
v_add_f32 v138, v138, v228
v_add_f32 v139, v139, v228
v_exp_f32 v136, v136
v_mfma_f32_16x16x32_bf16 v[96:99], a[184:187], v[32:35], v[96:99]
v_exp_f32 v137, v137
v_mfma_f32_16x16x32_bf16 v[96:99], a[188:191], v[36:39], v[96:99]
v_cvt_pk_bf16_f32 v161, v106, v107
v_cvt_pk_bf16_f32 v184, v120, v121
v_mfma_f32_16x16x32_bf16 v[112:115], a[188:191], v[52:55], v[220:223]
v_exp_f32 v138, v138
v_mfma_f32_16x16x32_bf16 v[112:115], a[184:187], v[48:51], v[112:115]
v_exp_f32 v139, v139
v_mfma_f32_16x16x32_bf16 v[112:115], a[180:183], v[44:47], v[112:115]
v_exp_f32 v140, v140
v_mfma_f32_16x16x32_bf16 v[112:115], a[176:179], v[40:43], v[112:115]
v_exp_f32 v141, v141
v_mfma_f32_16x16x32_bf16 v[128:131], a[176:179], v[56:59], v[224:227]
buffer_load_dwordx4 v16, s[32:35], s64 offen offset:3072 sc1 lds
v_cvt_pk_bf16_f32 v185, v122, v123
v_mfma_f32_16x16x32_bf16 v[128:131], a[180:183], v[60:63], v[128:131]
v_exp_f32 v142, v142
v_mfma_f32_16x16x32_bf16 v[128:131], a[184:187], v[64:67], v[128:131]
v_exp_f32 v143, v143
v_mfma_f32_16x16x32_bf16 v[128:131], a[188:191], v[68:71], v[128:131]
v_cvt_pk_bf16_f32 v192, v136, v137
v_cvt_pk_bf16_f32 v193, v138, v139
v_mfma_f32_16x16x32_bf16 v[144:147], a[188:191], v[84:87], v[228:231]
v_exp_f32 v124, v124
v_mfma_f32_16x16x32_bf16 v[144:147], a[184:187], v[80:83], v[144:147]
v_exp_f32 v125, v125
v_mfma_f32_16x16x32_bf16 v[144:147], a[180:183], v[76:79], v[144:147]
s_waitcnt vmcnt(6)
s_barrier
v_mfma_f32_16x16x32_bf16 v[144:147], a[176:179], v[72:75], v[144:147]
v_exp_f32 v126, v126
v_mfma_f32_16x16x32_bf16 v[148:151], a[192:195], v[72:75], v[228:231]
v_cvt_pk_bf16_f32 v194, v140, v141
v_cvt_pk_bf16_f32 v195, v142, v143
v_mfma_f32_16x16x32_bf16 v[148:151], a[196:199], v[76:79], v[148:151]
v_exp_f32 v127, v127
v_mfma_f32_16x16x32_bf16 v[148:151], a[200:203], v[80:83], v[148:151]
s_xor_b32 s71, s71, 16384
v_exp_f32 v108, v108
v_mfma_f32_16x16x32_bf16 v[148:151], a[204:207], v[84:87], v[148:151]
s_add_u32 s70, s70, 32768
v_exp_f32 v109, v109
v_mfma_f32_16x16x32_bf16 v[132:135], a[204:207], v[68:71], v[224:227]
s_mov_b32 m0, s71
v_exp_f32 v110, v110
v_mfma_f32_16x16x32_bf16 v[132:135], a[200:203], v[64:67], v[132:135]
buffer_load_dwordx4 v16, s[32:35], s70 offen offset:0 sc1 lds
v_mfma_f32_16x16x32_bf16 v[132:135], a[196:199], v[60:63], v[132:135]
v_cvt_pk_bf16_f32 v186, v124, v125
v_exp_f32 v111, v111
v_mfma_f32_16x16x32_bf16 v[132:135], a[192:195], v[56:59], v[132:135]
v_exp_f32 v92, v92
v_mfma_f32_16x16x32_bf16 v[116:119], a[192:195], v[40:43], v[220:223]
v_exp_f32 v93, v93
v_mfma_f32_16x16x32_bf16 v[116:119], a[196:199], v[44:47], v[116:119]
ds_read_b128 a[144:147], v2 offset:16384
v_cvt_pk_bf16_f32 v187, v126, v127
v_mfma_f32_16x16x32_bf16 v[116:119], a[200:203], v[48:51], v[116:119]
v_exp_f32 v94, v94
v_mfma_f32_16x16x32_bf16 v[116:119], a[204:207], v[52:55], v[116:119]
ds_read_b128 a[148:151], v2 offset:17408
v_cvt_pk_bf16_f32 v162, v108, v109
v_mfma_f32_16x16x32_bf16 v[100:103], a[204:207], v[36:39], v[216:219]
ds_read_b128 a[152:155], v2 offset:18432
buffer_load_dwordx4 v16, s[32:35], s70 offen offset:1024 sc1 lds
v_exp_f32 v95, v95
v_mfma_f32_16x16x32_bf16 v[100:103], a[200:203], v[32:35], v[100:103]
ds_read_b128 a[156:159], v2 offset:19456
v_exp_f32 v96, v96
v_mfma_f32_16x16x32_bf16 v[100:103], a[196:199], v[28:31], v[100:103]
v_cvt_pk_bf16_f32 v163, v110, v111
v_exp_f32 v97, v97
v_mfma_f32_16x16x32_bf16 v[100:103], a[192:195], v[24:27], v[100:103]
s_waitcnt lgkmcnt(3)
ds_read_b128 a[160:163], v2 offset:20480
ds_read_b128 a[164:167], v2 offset:21504
ds_read_b128 a[168:171], v2 offset:22528
ds_read_b128 a[172:175], v2 offset:23552
v_mfma_f32_16x16x32_bf16 v[88:91], a[144:147], v[24:27], v[216:219]
s_waitcnt lgkmcnt(6)
v_exp_f32 v98, v98
v_mfma_f32_16x16x32_bf16 v[88:91], a[148:151], v[28:31], v[88:91]
s_waitcnt lgkmcnt(5)
v_cvt_pk_bf16_f32 v154, v92, v93
v_exp_f32 v99, v99
v_mfma_f32_16x16x32_bf16 v[88:91], a[152:155], v[32:35], v[88:91]
s_waitcnt lgkmcnt(4)
v_exp_f32 v112, v112
v_mfma_f32_16x16x32_bf16 v[88:91], a[156:159], v[36:39], v[88:91]
v_exp_f32 v113, v113
v_mfma_f32_16x16x32_bf16 v[104:107], a[156:159], v[52:55], v[220:223]
v_cvt_pk_bf16_f32 v155, v94, v95
v_cvt_pk_bf16_f32 v156, v96, v97
v_mfma_f32_16x16x32_bf16 v[104:107], a[152:155], v[48:51], v[104:107]
buffer_load_dwordx4 v16, s[32:35], s70 offen offset:2048 sc1 lds
v_exp_f32 v114, v114
v_mfma_f32_16x16x32_bf16 v[104:107], a[148:151], v[44:47], v[104:107]
v_exp_f32 v115, v115
v_mfma_f32_16x16x32_bf16 v[104:107], a[144:147], v[40:43], v[104:107]
v_exp_f32 v128, v128
v_mfma_f32_16x16x32_bf16 v[120:123], a[144:147], v[56:59], v[224:227]
v_exp_f32 v129, v129
v_mfma_f32_16x16x32_bf16 v[120:123], a[148:151], v[60:63], v[120:123]
v_cvt_pk_bf16_f32 v157, v98, v99
v_cvt_pk_bf16_f32 v164, v112, v113
v_mfma_f32_16x16x32_bf16 v[120:123], a[152:155], v[64:67], v[120:123]
v_exp_f32 v130, v130
v_mfma_f32_16x16x32_bf16 v[120:123], a[156:159], v[68:71], v[120:123]
v_exp_f32 v131, v131
v_mfma_f32_16x16x32_bf16 v[136:139], a[156:159], v[84:87], v[228:231]
v_exp_f32 v144, v144
v_mfma_f32_16x16x32_bf16 v[136:139], a[152:155], v[80:83], v[136:139]
v_exp_f32 v145, v145
v_mfma_f32_16x16x32_bf16 v[136:139], a[148:151], v[76:79], v[136:139]
v_exp_f32 v146, v146
v_mfma_f32_16x16x32_bf16 v[136:139], a[144:147], v[72:75], v[136:139]
s_waitcnt lgkmcnt(0)
v_cvt_pk_bf16_f32 v165, v114, v115
v_cvt_pk_bf16_f32 v188, v128, v129
v_mfma_f32_16x16x32_bf16 v[140:143], a[160:163], v[72:75], v[228:231]
v_exp_f32 v147, v147
v_mfma_f32_16x16x32_bf16 v[140:143], a[164:167], v[76:79], v[140:143]
v_exp_f32 v148, v148
v_mfma_f32_16x16x32_bf16 v[140:143], a[168:171], v[80:83], v[140:143]
v_exp_f32 v149, v149
v_mfma_f32_16x16x32_bf16 v[140:143], a[172:175], v[84:87], v[140:143]
buffer_load_dwordx4 v16, s[32:35], s70 offen offset:3072 sc1 lds
v_mfma_f32_16x16x32_bf16 v[124:127], a[172:175], v[68:71], v[224:227]
v_cvt_pk_bf16_f32 v189, v130, v131
v_cvt_pk_bf16_f32 v196, v144, v145
v_mfma_f32_16x16x32_bf16 v[124:127], a[168:171], v[64:67], v[124:127]
v_exp_f32 v150, v150
v_mfma_f32_16x16x32_bf16 v[124:127], a[164:167], v[60:63], v[124:127]
v_exp_f32 v151, v151
v_mfma_f32_16x16x32_bf16 v[124:127], a[160:163], v[56:59], v[124:127]
v_exp_f32 v132, v132
v_mfma_f32_16x16x32_bf16 v[108:111], a[160:163], v[40:43], v[220:223]
ds_read_b128 a[176:179], v2 offset:24576
v_cvt_pk_bf16_f32 v197, v146, v147
v_mfma_f32_16x16x32_bf16 v[108:111], a[164:167], v[44:47], v[108:111]
ds_read_b128 a[180:183], v2 offset:25600
v_cvt_pk_bf16_f32 v198, v148, v149
v_mfma_f32_16x16x32_bf16 v[108:111], a[168:171], v[48:51], v[108:111]
ds_read_b128 a[184:187], v2 offset:26624
v_exp_f32 v133, v133
v_mfma_f32_16x16x32_bf16 v[108:111], a[172:175], v[52:55], v[108:111]
ds_read_b128 a[188:191], v2 offset:27648
v_exp_f32 v134, v134
v_mfma_f32_16x16x32_bf16 v[92:95], a[172:175], v[36:39], v[216:219]
v_exp_f32 v135, v135
v_mfma_f32_16x16x32_bf16 v[92:95], a[168:171], v[32:35], v[92:95]
v_exp_f32 v116, v116
v_mfma_f32_16x16x32_bf16 v[92:95], a[164:167], v[28:31], v[92:95]
v_exp_f32 v117, v117
v_mfma_f32_16x16x32_bf16 v[92:95], a[160:163], v[24:27], v[92:95]
s_waitcnt lgkmcnt(2)
v_cvt_pk_bf16_f32 v199, v150, v151
v_cvt_pk_bf16_f32 v190, v132, v133
v_mfma_f32_16x16x32_bf16 v[96:99], a[176:179], v[24:27], v[216:219]
v_exp_f32 v118, v118
v_mfma_f32_16x16x32_bf16 v[96:99], a[180:183], v[28:31], v[96:99]
s_waitcnt lgkmcnt(0)
s_add_u32 m0, s71, 4096
v_exp_f32 v119, v119
v_mfma_f32_16x16x32_bf16 v[96:99], a[184:187], v[32:35], v[96:99]
s_add_u32 s64, s70, 4096
v_exp_f32 v100, v100
v_mfma_f32_16x16x32_bf16 v[96:99], a[188:191], v[36:39], v[96:99]
buffer_load_dwordx4 v16, s[32:35], s64 offen offset:0 sc1 lds
v_mfma_f32_16x16x32_bf16 v[112:115], a[188:191], v[52:55], v[220:223]
v_exp_f32 v101, v101
v_mfma_f32_16x16x32_bf16 v[112:115], a[184:187], v[48:51], v[112:115]
v_cvt_pk_bf16_f32 v191, v134, v135
v_cvt_pk_bf16_f32 v166, v116, v117
v_mfma_f32_16x16x32_bf16 v[112:115], a[180:183], v[44:47], v[112:115]
v_exp_f32 v102, v102
v_mfma_f32_16x16x32_bf16 v[112:115], a[176:179], v[40:43], v[112:115]
v_exp_f32 v103, v103
v_mfma_f32_16x16x32_bf16 v[128:131], a[176:179], v[56:59], v[224:227]
s_lshl_b32 s66, s30, 30
ds_read_b128 a[192:195], v2 offset:28672
v_cvt_pk_bf16_f32 v167, v118, v119
v_mfma_f32_16x16x32_bf16 v[128:131], a[180:183], v[60:63], v[128:131]
ds_read_b128 a[196:199], v2 offset:29696
v_exp_f32 v88, v88
v_mfma_f32_16x16x32_bf16 v[128:131], a[184:187], v[64:67], v[128:131]
ds_read_b128 a[200:203], v2 offset:30720
v_exp_f32 v89, v89
v_mfma_f32_16x16x32_bf16 v[128:131], a[188:191], v[68:71], v[128:131]
ds_read_b128 a[204:207], v2 offset:31744
v_cvt_pk_bf16_f32 v158, v100, v101
v_mfma_f32_16x16x32_bf16 v[144:147], a[188:191], v[84:87], v[228:231]
v_exp_f32 v90, v90
v_mfma_f32_16x16x32_bf16 v[144:147], a[184:187], v[80:83], v[144:147]
v_exp_f32 v91, v91
v_mfma_f32_16x16x32_bf16 v[144:147], a[180:183], v[76:79], v[144:147]
v_exp_f32 v104, v104
v_mfma_f32_16x16x32_bf16 v[144:147], a[176:179], v[72:75], v[144:147]
s_waitcnt lgkmcnt(2)
v_exp_f32 v105, v105
v_mfma_f32_16x16x32_bf16 v[148:151], a[192:195], v[72:75], v[228:231]
v_cvt_pk_bf16_f32 v159, v102, v103
v_cvt_pk_bf16_f32 v168, v88, v89
v_mfma_f32_16x16x32_bf16 v[148:151], a[196:199], v[76:79], v[148:151]
s_waitcnt lgkmcnt(0)
v_exp_f32 v106, v106
v_mfma_f32_16x16x32_bf16 v[148:151], a[200:203], v[80:83], v[148:151]
v_exp_f32 v107, v107
v_mfma_f32_16x16x32_bf16 v[148:151], a[204:207], v[84:87], v[148:151]
buffer_load_dwordx4 v16, s[32:35], s64 offen offset:1024 sc1 lds
v_mfma_f32_16x16x32_bf16 v[132:135], a[204:207], v[68:71], v[224:227]
v_exp_f32 v120, v120
v_mfma_f32_16x16x32_bf16 v[132:135], a[200:203], v[64:67], v[132:135]
v_cvt_pk_bf16_f32 v169, v90, v91
v_cvt_pk_bf16_f32 v176, v104, v105
v_mfma_f32_16x16x32_bf16 v[132:135], a[196:199], v[60:63], v[132:135]
v_exp_f32 v121, v121
v_mfma_f32_16x16x32_bf16 v[132:135], a[192:195], v[56:59], v[132:135]
v_exp_f32 v122, v122
v_mfma_f32_16x16x32_bf16 v[116:119], a[192:195], v[40:43], v[220:223]
v_exp_f32 v123, v123
v_mfma_f32_16x16x32_bf16 v[116:119], a[196:199], v[44:47], v[116:119]
v_exp_f32 v136, v136
v_mfma_f32_16x16x32_bf16 v[116:119], a[200:203], v[48:51], v[116:119]
s_branch L_po15
L_pg15:
s_branch L_pg19
L_po15:
v_exp_f32 v137, v137
v_mfma_f32_16x16x32_bf16 v[116:119], a[204:207], v[52:55], v[116:119]
ds_read_b128 a[144:147], v3 offset:16384
v_cvt_pk_bf16_f32 v177, v106, v107
v_mfma_f32_16x16x32_bf16 v[100:103], a[204:207], v[36:39], v[216:219]
v_exp_f32 v138, v138
v_mfma_f32_16x16x32_bf16 v[100:103], a[200:203], v[32:35], v[100:103]
ds_read_b128 a[148:151], v3 offset:24576
v_cvt_pk_bf16_f32 v200, v120, v121
v_mfma_f32_16x16x32_bf16 v[100:103], a[196:199], v[28:31], v[100:103]
v_exp_f32 v139, v139
v_mfma_f32_16x16x32_bf16 v[100:103], a[192:195], v[24:27], v[100:103]
v_exp_f32 v140, v140
v_smfmac_f32_16x16x64_bf16 a[128:131], a[240:243], v[152:159], v5
v_cvt_pk_bf16_f32 v201, v122, v123
v_smfmac_f32_16x16x64_bf16 a[132:135], a[240:243], v[160:167], v5
v_exp_f32 v141, v141
v_smfmac_f32_16x16x64_bf16 a[136:139], a[240:243], v[184:191], v5
v_exp_f32 v142, v142
v_smfmac_f32_16x16x64_bf16 a[140:143], a[240:243], v[192:199], v5
s_waitcnt lgkmcnt(0)
buffer_load_dwordx4 v16, s[32:35], s64 offen offset:2048 sc1 lds
v_cvt_pk_bf16_f32 v208, v136, v137
v_mfma_f32_16x16x32_bf16 a[0:3], a[144:147], v[152:155], 0
ds_read_b128 a[152:155], v3 offset:17408
v_exp_f32 v143, v143
v_mfma_f32_16x16x32_bf16 a[0:3], a[148:151], v[156:159], a[0:3]
ds_read_b128 a[156:159], v3 offset:25600
v_exp_f32 v124, v124
v_mfma_f32_16x16x32_bf16 a[32:35], a[148:151], v[164:167], 0
v_cvt_pk_bf16_f32 v209, v138, v139
v_exp_f32 v125, v125
v_mfma_f32_16x16x32_bf16 a[32:35], a[144:147], v[160:163], a[32:35]
v_exp_f32 v126, v126
v_mfma_f32_16x16x32_bf16 a[64:67], a[144:147], v[184:187], 0
v_exp_f32 v127, v127
v_mfma_f32_16x16x32_bf16 a[64:67], a[148:151], v[188:191], a[64:67]
v_cvt_pk_bf16_f32 v210, v140, v141
v_cvt_pk_bf16_f32 v211, v142, v143
v_mfma_f32_16x16x32_bf16 a[96:99], a[148:151], v[196:199], 0
v_exp_f32 v108, v108
v_mfma_f32_16x16x32_bf16 a[96:99], a[144:147], v[192:195], a[96:99]
s_waitcnt lgkmcnt(0)
v_exp_f32 v109, v109
v_mfma_f32_16x16x32_bf16 a[100:103], a[152:155], v[192:195], 0
ds_read_b128 a[160:163], v3 offset:18432
v_cvt_pk_bf16_f32 v202, v124, v125
v_mfma_f32_16x16x32_bf16 a[100:103], a[156:159], v[196:199], a[100:103]
ds_read_b128 a[164:167], v3 offset:26624
v_exp_f32 v110, v110
v_mfma_f32_16x16x32_bf16 a[68:71], a[156:159], v[188:191], 0
v_exp_f32 v111, v111
v_mfma_f32_16x16x32_bf16 a[68:71], a[152:155], v[184:187], a[68:71]
v_exp_f32 v92, v92
v_mfma_f32_16x16x32_bf16 a[36:39], a[152:155], v[160:163], 0
v_exp_f32 v93, v93
v_mfma_f32_16x16x32_bf16 a[36:39], a[156:159], v[164:167], a[36:39]
v_cvt_pk_bf16_f32 v203, v126, v127
v_cvt_pk_bf16_f32 v178, v108, v109
v_mfma_f32_16x16x32_bf16 a[4:7], a[156:159], v[156:159], 0
buffer_load_dwordx4 v16, s[32:35], s64 offen offset:3072 sc1 lds
v_mfma_f32_16x16x32_bf16 a[4:7], a[152:155], v[152:155], a[4:7]
s_waitcnt lgkmcnt(0)
v_exp_f32 v94, v94
v_mfma_f32_16x16x32_bf16 a[8:11], a[160:163], v[152:155], 0
ds_read_b128 a[168:171], v3 offset:19456
v_cvt_pk_bf16_f32 v179, v110, v111
v_mfma_f32_16x16x32_bf16 a[8:11], a[164:167], v[156:159], a[8:11]
ds_read_b128 a[172:175], v3 offset:27648
v_exp_f32 v95, v95
v_mfma_f32_16x16x32_bf16 a[40:43], a[164:167], v[164:167], 0
v_exp_f32 v96, v96
v_mfma_f32_16x16x32_bf16 a[40:43], a[160:163], v[160:163], a[40:43]
v_exp_f32 v97, v97
v_mfma_f32_16x16x32_bf16 a[72:75], a[160:163], v[184:187], 0
v_exp_f32 v98, v98
v_mfma_f32_16x16x32_bf16 a[72:75], a[164:167], v[188:191], a[72:75]
v_exp_f32 v99, v99
v_mfma_f32_16x16x32_bf16 a[104:107], a[164:167], v[196:199], 0
ds_read_b128 a[176:179], v3 offset:20480
v_cvt_pk_bf16_f32 v170, v92, v93
v_mfma_f32_16x16x32_bf16 a[104:107], a[160:163], v[192:195], a[104:107]
s_waitcnt lgkmcnt(1)
v_exp_f32 v112, v112
v_mfma_f32_16x16x32_bf16 a[108:111], a[168:171], v[192:195], 0
v_exp_f32 v113, v113
v_mfma_f32_16x16x32_bf16 a[108:111], a[172:175], v[196:199], a[108:111]
ds_read_b128 a[180:183], v3 offset:28672
v_cvt_pk_bf16_f32 v171, v94, v95
v_mfma_f32_16x16x32_bf16 a[76:79], a[172:175], v[188:191], 0
v_exp_f32 v114, v114
v_mfma_f32_16x16x32_bf16 a[76:79], a[168:171], v[184:187], a[76:79]
v_cvt_pk_bf16_f32 v172, v96, v97
v_xor_b32 v2, 0x8000, v2
v_mfma_f32_16x16x32_bf16 a[44:47], a[168:171], v[160:163], 0
ds_read_b128 a[184:187], v3 offset:21504
ds_read_b128 a[188:191], v3 offset:29696
ds_read_b128 a[192:195], v3 offset:22528
ds_read_b128 a[196:199], v3 offset:30720
ds_read_b128 a[200:203], v3 offset:23552
ds_read_b128 a[204:207], v3 offset:31744
v_exp_f32 v115, v115
v_mfma_f32_16x16x32_bf16 a[44:47], a[172:175], v[164:167], a[44:47]
s_waitcnt vmcnt(8)
s_barrier
v_exp_f32 v128, v128
v_mfma_f32_16x16x32_bf16 a[12:15], a[172:175], v[156:159], 0
v_cvt_pk_bf16_f32 v173, v98, v99
v_cvt_pk_bf16_f32 v180, v112, v113
v_mfma_f32_16x16x32_bf16 a[12:15], a[168:171], v[152:155], a[12:15]
s_waitcnt lgkmcnt(6)
v_exp_f32 v129, v129
v_mfma_f32_16x16x32_bf16 a[16:19], a[176:179], v[152:155], 0
v_exp_f32 v130, v130
v_mfma_f32_16x16x32_bf16 a[16:19], a[180:183], v[156:159], a[16:19]
s_xor_b32 s71, s71, 49152
v_exp_f32 v131, v131
v_mfma_f32_16x16x32_bf16 a[48:51], a[180:183], v[164:167], 0
s_add_u32 s70, s70, 32768
v_exp_f32 v144, v144
v_mfma_f32_16x16x32_bf16 a[48:51], a[176:179], v[160:163], a[48:51]
s_mov_b32 m0, s71
v_exp_f32 v145, v145
v_mfma_f32_16x16x32_bf16 a[80:83], a[176:179], v[184:187], 0
buffer_load_dwordx4 v16, s[32:35], s70 offen offset:0 sc1 lds
v_cvt_pk_bf16_f32 v181, v114, v115
v_mfma_f32_16x16x32_bf16 a[80:83], a[180:183], v[188:191], a[80:83]
v_exp_f32 v146, v146
v_mfma_f32_16x16x32_bf16 a[112:115], a[180:183], v[196:199], 0
v_exp_f32 v147, v147
v_mfma_f32_16x16x32_bf16 a[112:115], a[176:179], v[192:195], a[112:115]
s_waitcnt lgkmcnt(0)
v_cvt_pk_bf16_f32 v204, v128, v129
v_cvt_pk_bf16_f32 v205, v130, v131
v_mfma_f32_16x16x32_bf16 a[116:119], a[184:187], v[192:195], 0
v_exp_f32 v148, v148
v_mfma_f32_16x16x32_bf16 a[116:119], a[188:191], v[196:199], a[116:119]
v_exp_f32 v149, v149
v_mfma_f32_16x16x32_bf16 a[84:87], a[188:191], v[188:191], 0
v_exp_f32 v150, v150
v_mfma_f32_16x16x32_bf16 a[84:87], a[184:187], v[184:187], a[84:87]
v_exp_f32 v151, v151
v_mfma_f32_16x16x32_bf16 a[52:55], a[184:187], v[160:163], 0
v_cvt_pk_bf16_f32 v212, v144, v145
v_cvt_pk_bf16_f32 v213, v146, v147
v_mfma_f32_16x16x32_bf16 a[52:55], a[188:191], v[164:167], a[52:55]
v_exp_f32 v132, v132
v_mfma_f32_16x16x32_bf16 a[20:23], a[188:191], v[156:159], 0
v_exp_f32 v133, v133
v_mfma_f32_16x16x32_bf16 a[20:23], a[184:187], v[152:155], a[20:23]
ds_read_b128 a[144:147], v2 offset:0
v_lshl_add_u32 v19, v0, 24, s66
v_mfma_f32_16x16x32_bf16 a[24:27], a[192:195], v[152:155], 0
s_lshr_b32 s67, s31, 4
v_exp_f32 v134, v134
v_mfma_f32_16x16x32_bf16 a[24:27], a[196:199], v[156:159], a[24:27]
s_lshl1_add_u32 s67, s3, s67
v_exp_f32 v135, v135
v_mfma_f32_16x16x32_bf16 a[56:59], a[196:199], v[164:167], 0
s_lshl_b32 s79, s67, 8
v_cvt_pk_bf16_f32 v214, v148, v149
v_cvt_pk_bf16_f32 v215, v150, v151
v_mfma_f32_16x16x32_bf16 a[56:59], a[192:195], v[160:163], a[56:59]
s_add_u32 s79, s79, 8192
buffer_load_dwordx4 v16, s[32:35], s70 offen offset:1024 sc1 lds
v_mfma_f32_16x16x32_bf16 a[88:91], a[192:195], v[184:187], 0
s_add_u32 s69, s31, 12
v_exp_f32 v116, v116
v_mfma_f32_16x16x32_bf16 a[88:91], a[196:199], v[188:191], a[88:91]
s_lshr_b32 s69, s69, 5
v_exp_f32 v117, v117
v_mfma_f32_16x16x32_bf16 a[120:123], a[196:199], v[196:199], 0
s_lshl1_add_u32 s69, s3, s69
v_exp_f32 v118, v118
v_mfma_f32_16x16x32_bf16 a[120:123], a[192:195], v[192:195], a[120:123]
s_lshl_b32 s69, s69, 8
v_cvt_pk_bf16_f32 v206, v132, v133
v_cvt_pk_bf16_f32 v207, v134, v135
v_mfma_f32_16x16x32_bf16 a[124:127], a[200:203], v[192:195], 0
s_add_u32 s69, s69, 8192
v_exp_f32 v119, v119
v_mfma_f32_16x16x32_bf16 a[124:127], a[204:207], v[196:199], a[124:127]
s_lshl_b32 s67, s73, 16
v_exp_f32 v100, v100
v_mfma_f32_16x16x32_bf16 a[92:95], a[204:207], v[188:191], 0
s_xor_b32 s68, s80, 256
v_exp_f32 v101, v101
v_mfma_f32_16x16x32_bf16 a[92:95], a[200:203], v[184:187], a[92:95]
s_add_u32 s68, s68, s67
ds_read_b128 a[148:151], v2 offset:1024
v_cvt_pk_bf16_f32 v182, v116, v117
v_mfma_f32_16x16x32_bf16 a[60:63], a[200:203], v[160:163], 0
ds_read_b128 a[152:155], v2 offset:2048
v_exp_f32 v102, v102
v_mfma_f32_16x16x32_bf16 a[60:63], a[204:207], v[164:167], a[60:63]
s_add_u32 s67, s67, s69
ds_read_b128 a[156:159], v2 offset:3072
v_cvt_pk_bf16_f32 v183, v118, v119
v_mfma_f32_16x16x32_bf16 a[28:31], a[204:207], v[156:159], 0
s_mov_b64 exec, 1
buffer_atomic_add a251, v19, s[52:55], s67 offen offset:0 sc1
buffer_atomic_add a251, v19, s[52:55], s68 offen offset:0 sc1
s_mov_b64 exec, -1
v_exp_f32 v103, v103
v_mfma_f32_16x16x32_bf16 a[28:31], a[200:203], v[152:155], a[28:31]
ds_read_b128 a[160:163], v2 offset:4096
ds_read_b128 a[164:167], v2 offset:5120
ds_read_b128 a[168:171], v2 offset:6144
ds_read_b128 a[172:175], v2 offset:7168
v_mul_u32_u24 v19, 52, v0
v_cvt_pk_bf16_f32 v174, v100, v101
v_cvt_pk_bf16_f32 v175, v102, v103
v_xor_b32 v3, 0x8000, v3
s_sub_u32 s72, s3, 1
s_cmp_eq_u32 s72, 0
s_cbranch_scc1 L_DD
L_D:
s_waitcnt lgkmcnt(7)
v_mfma_f32_16x16x32_bf16 v[88:91], a[144:147], v[24:27], v[216:219]
s_waitcnt lgkmcnt(6)
ds_read_b128 a[176:179], v2 offset:8192
v_mfma_f32_16x16x32_bf16 v[88:91], a[148:151], v[28:31], v[88:91]
s_waitcnt lgkmcnt(6)
ds_read_b128 a[180:183], v2 offset:9216
v_mfma_f32_16x16x32_bf16 v[88:91], a[152:155], v[32:35], v[88:91]
s_waitcnt lgkmcnt(6)
buffer_load_dwordx4 v16, s[32:35], s70 offen offset:2048 sc1 lds
v_mfma_f32_16x16x32_bf16 v[88:91], a[156:159], v[36:39], v[88:91]
ds_read_b128 a[184:187], v2 offset:10240
v_mfma_f32_16x16x32_bf16 v[104:107], a[156:159], v[52:55], v[220:223]
v_mfma_f32_16x16x32_bf16 v[104:107], a[152:155], v[48:51], v[104:107]
buffer_load_dword a252, v19, s[40:43], s81 offen
v_mfma_f32_16x16x32_bf16 v[104:107], a[148:151], v[44:47], v[104:107]
ds_read_b128 a[188:191], v2 offset:11264
v_mfma_f32_16x16x32_bf16 v[104:107], a[144:147], v[40:43], v[104:107]
v_mfma_f32_16x16x32_bf16 v[120:123], a[144:147], v[56:59], v[224:227]
v_mfma_f32_16x16x32_bf16 v[120:123], a[148:151], v[60:63], v[120:123]
v_mfma_f32_16x16x32_bf16 v[120:123], a[152:155], v[64:67], v[120:123]
v_exp_f32 v88, v88
v_mfma_f32_16x16x32_bf16 v[120:123], a[156:159], v[68:71], v[120:123]
v_exp_f32 v89, v89
v_mfma_f32_16x16x32_bf16 v[136:139], a[156:159], v[84:87], v[228:231]
v_exp_f32 v90, v90
v_mfma_f32_16x16x32_bf16 v[136:139], a[152:155], v[80:83], v[136:139]
v_exp_f32 v91, v91
v_mfma_f32_16x16x32_bf16 v[136:139], a[148:151], v[76:79], v[136:139]
v_exp_f32 v104, v104
v_mfma_f32_16x16x32_bf16 v[136:139], a[144:147], v[72:75], v[136:139]
s_waitcnt lgkmcnt(0)
s_add_u32 s81, s81, 425984
v_exp_f32 v105, v105
v_mfma_f32_16x16x32_bf16 v[140:143], a[160:163], v[72:75], v[228:231]
v_exp_f32 v106, v106
v_mfma_f32_16x16x32_bf16 v[140:143], a[164:167], v[76:79], v[140:143]
buffer_load_dwordx4 v16, s[32:35], s70 offen offset:3072 sc1 lds
v_mfma_f32_16x16x32_bf16 v[140:143], a[168:171], v[80:83], v[140:143]
v_exp_f32 v107, v107
v_mfma_f32_16x16x32_bf16 v[140:143], a[172:175], v[84:87], v[140:143]
v_cvt_pk_bf16_f32 v152, v88, v89
v_cvt_pk_bf16_f32 v153, v90, v91
v_mfma_f32_16x16x32_bf16 v[124:127], a[172:175], v[68:71], v[224:227]
v_exp_f32 v120, v120
v_mfma_f32_16x16x32_bf16 v[124:127], a[168:171], v[64:67], v[124:127]
v_exp_f32 v121, v121
v_mfma_f32_16x16x32_bf16 v[124:127], a[164:167], v[60:63], v[124:127]
v_exp_f32 v122, v122
v_mfma_f32_16x16x32_bf16 v[124:127], a[160:163], v[56:59], v[124:127]
v_exp_f32 v123, v123
v_mfma_f32_16x16x32_bf16 v[108:111], a[160:163], v[40:43], v[220:223]
v_exp_f32 v136, v136
v_mfma_f32_16x16x32_bf16 v[108:111], a[164:167], v[44:47], v[108:111]
v_exp_f32 v137, v137
v_mfma_f32_16x16x32_bf16 v[108:111], a[168:171], v[48:51], v[108:111]
v_exp_f32 v138, v138
v_mfma_f32_16x16x32_bf16 v[108:111], a[172:175], v[52:55], v[108:111]
v_cvt_pk_bf16_f32 v160, v104, v105
v_cvt_pk_bf16_f32 v161, v106, v107
v_mfma_f32_16x16x32_bf16 v[92:95], a[172:175], v[36:39], v[216:219]
v_exp_f32 v139, v139
v_mfma_f32_16x16x32_bf16 v[92:95], a[168:171], v[32:35], v[92:95]
ds_read_b128 a[192:195], v2 offset:12288
v_cvt_pk_bf16_f32 v184, v120, v121
v_mfma_f32_16x16x32_bf16 v[92:95], a[164:167], v[28:31], v[92:95]
v_exp_f32 v140, v140
v_mfma_f32_16x16x32_bf16 v[92:95], a[160:163], v[24:27], v[92:95]
s_add_u32 m0, s71, 4096
ds_read_b128 a[196:199], v2 offset:13312
v_cvt_pk_bf16_f32 v185, v122, v123
v_mfma_f32_16x16x32_bf16 v[96:99], a[176:179], v[24:27], v[216:219]
s_add_u32 s64, s70, 4096
ds_read_b128 a[200:203], v2 offset:14336
v_cvt_pk_bf16_f32 v192, v136, v137
v_mfma_f32_16x16x32_bf16 v[96:99], a[180:183], v[28:31], v[96:99]
buffer_load_dwordx4 v16, s[32:35], s64 offen offset:0 sc1 lds
v_mfma_f32_16x16x32_bf16 v[96:99], a[184:187], v[32:35], v[96:99]
v_exp_f32 v141, v141
v_mfma_f32_16x16x32_bf16 v[96:99], a[188:191], v[36:39], v[96:99]
ds_read_b128 a[204:207], v2 offset:15360
v_cvt_pk_bf16_f32 v193, v138, v139
v_mfma_f32_16x16x32_bf16 v[112:115], a[188:191], v[52:55], v[220:223]
v_exp_f32 v142, v142
v_mfma_f32_16x16x32_bf16 v[112:115], a[184:187], v[48:51], v[112:115]
v_exp_f32 v143, v143
v_mfma_f32_16x16x32_bf16 v[112:115], a[180:183], v[44:47], v[112:115]
v_exp_f32 v124, v124
v_mfma_f32_16x16x32_bf16 v[112:115], a[176:179], v[40:43], v[112:115]
v_exp_f32 v125, v125
v_mfma_f32_16x16x32_bf16 v[128:131], a[176:179], v[56:59], v[224:227]
v_exp_f32 v126, v126
v_mfma_f32_16x16x32_bf16 v[128:131], a[180:183], v[60:63], v[128:131]
v_exp_f32 v127, v127
v_mfma_f32_16x16x32_bf16 v[128:131], a[184:187], v[64:67], v[128:131]
v_exp_f32 v108, v108
v_mfma_f32_16x16x32_bf16 v[128:131], a[188:191], v[68:71], v[128:131]
v_exp_f32 v109, v109
v_mfma_f32_16x16x32_bf16 v[144:147], a[188:191], v[84:87], v[228:231]
v_exp_f32 v110, v110
v_mfma_f32_16x16x32_bf16 v[144:147], a[184:187], v[80:83], v[144:147]
ds_read_b128 a[144:147], v3 offset:0
v_cvt_pk_bf16_f32 v194, v140, v141
v_mfma_f32_16x16x32_bf16 v[144:147], a[180:183], v[76:79], v[144:147]
ds_read_b128 a[148:151], v3 offset:8192
v_cvt_pk_bf16_f32 v195, v142, v143
v_mfma_f32_16x16x32_bf16 v[144:147], a[176:179], v[72:75], v[144:147]
s_waitcnt lgkmcnt(2)
v_exp_f32 v111, v111
v_mfma_f32_16x16x32_bf16 v[148:151], a[192:195], v[72:75], v[228:231]
buffer_load_dwordx4 v16, s[32:35], s64 offen offset:1024 sc1 lds
v_mfma_f32_16x16x32_bf16 v[148:151], a[196:199], v[76:79], v[148:151]
v_exp_f32 v92, v92
v_mfma_f32_16x16x32_bf16 v[148:151], a[200:203], v[80:83], v[148:151]
v_exp_f32 v93, v93
v_mfma_f32_16x16x32_bf16 v[148:151], a[204:207], v[84:87], v[148:151]
v_exp_f32 v94, v94
v_mfma_f32_16x16x32_bf16 v[132:135], a[204:207], v[68:71], v[224:227]
ds_read_b128 a[152:155], v3 offset:1024
v_cvt_pk_bf16_f32 v186, v124, v125
v_mfma_f32_16x16x32_bf16 v[132:135], a[200:203], v[64:67], v[132:135]
ds_read_b128 a[156:159], v3 offset:9216
v_cvt_pk_bf16_f32 v187, v126, v127
v_mfma_f32_16x16x32_bf16 v[132:135], a[196:199], v[60:63], v[132:135]
v_exp_f32 v95, v95
v_mfma_f32_16x16x32_bf16 v[132:135], a[192:195], v[56:59], v[132:135]
v_exp_f32 v96, v96
v_mfma_f32_16x16x32_bf16 v[116:119], a[192:195], v[40:43], v[220:223]
v_exp_f32 v97, v97
v_mfma_f32_16x16x32_bf16 v[116:119], a[196:199], v[44:47], v[116:119]
v_exp_f32 v98, v98
v_mfma_f32_16x16x32_bf16 v[116:119], a[200:203], v[48:51], v[116:119]
ds_read_b128 a[160:163], v3 offset:2048
v_cvt_pk_bf16_f32 v162, v108, v109
v_mfma_f32_16x16x32_bf16 v[116:119], a[204:207], v[52:55], v[116:119]
v_exp_f32 v99, v99
v_mfma_f32_16x16x32_bf16 v[100:103], a[204:207], v[36:39], v[216:219]
ds_read_b128 a[164:167], v3 offset:10240
v_cvt_pk_bf16_f32 v163, v110, v111
v_mfma_f32_16x16x32_bf16 v[100:103], a[200:203], v[32:35], v[100:103]
v_exp_f32 v112, v112
v_mfma_f32_16x16x32_bf16 v[100:103], a[196:199], v[28:31], v[100:103]
v_exp_f32 v113, v113
v_mfma_f32_16x16x32_bf16 v[100:103], a[192:195], v[24:27], v[100:103]
v_exp_f32 v114, v114
v_smfmac_f32_16x16x64_bf16 a[128:131], a[240:243], v[168:175], v5
ds_read_b128 a[168:171], v3 offset:3072
v_smfmac_f32_16x16x64_bf16 a[132:135], a[240:243], v[176:183], v5
ds_read_b128 a[172:175], v3 offset:11264
v_smfmac_f32_16x16x64_bf16 a[136:139], a[240:243], v[200:207], v5
ds_read_b128 a[176:179], v3 offset:4096
v_smfmac_f32_16x16x64_bf16 a[140:143], a[240:243], v[208:215], v5
s_waitcnt lgkmcnt(3)
buffer_load_dwordx4 v16, s[32:35], s64 offen offset:2048 sc1 lds
v_mfma_f32_16x16x32_bf16 a[0:3], a[144:147], v[168:171], a[0:3]
v_exp_f32 v115, v115
v_mfma_f32_16x16x32_bf16 a[0:3], a[148:151], v[172:175], a[0:3]
v_exp_f32 v128, v128
v_mfma_f32_16x16x32_bf16 a[32:35], a[148:151], v[180:183], a[32:35]
v_exp_f32 v129, v129
v_mfma_f32_16x16x32_bf16 a[32:35], a[144:147], v[176:179], a[32:35]
v_exp_f32 v130, v130
v_mfma_f32_16x16x32_bf16 a[64:67], a[144:147], v[200:203], a[64:67]
v_exp_f32 v131, v131
v_mfma_f32_16x16x32_bf16 a[64:67], a[148:151], v[204:207], a[64:67]
v_cvt_pk_bf16_f32 v154, v92, v93
v_cvt_pk_bf16_f32 v155, v94, v95
v_mfma_f32_16x16x32_bf16 a[96:99], a[148:151], v[212:215], a[96:99]
v_exp_f32 v144, v144
v_mfma_f32_16x16x32_bf16 a[96:99], a[144:147], v[208:211], a[96:99]
ds_read_b128 a[180:183], v3 offset:12288
v_cvt_pk_bf16_f32 v156, v96, v97
v_mfma_f32_16x16x32_bf16 a[100:103], a[152:155], v[208:211], a[100:103]
v_exp_f32 v145, v145
v_mfma_f32_16x16x32_bf16 a[100:103], a[156:159], v[212:215], a[100:103]
ds_read_b128 a[184:187], v3 offset:5120
v_cvt_pk_bf16_f32 v157, v98, v99
v_mfma_f32_16x16x32_bf16 a[68:71], a[156:159], v[204:207], a[68:71]
ds_read_b128 a[188:191], v3 offset:13312
v_cvt_pk_bf16_f32 v164, v112, v113
v_mfma_f32_16x16x32_bf16 a[68:71], a[152:155], v[200:203], a[68:71]
buffer_load_dwordx4 v16, s[32:35], s64 offen offset:3072 sc1 lds
v_mfma_f32_16x16x32_bf16 a[36:39], a[152:155], v[176:179], a[36:39]
ds_read_b128 a[192:195], v3 offset:6144
v_cvt_pk_bf16_f32 v165, v114, v115
v_mfma_f32_16x16x32_bf16 a[36:39], a[156:159], v[180:183], a[36:39]
ds_read_b128 a[196:199], v3 offset:14336
v_cvt_pk_bf16_f32 v188, v128, v129
v_mfma_f32_16x16x32_bf16 a[4:7], a[156:159], v[172:175], a[4:7]
ds_read_b128 a[200:203], v3 offset:7168
v_cvt_pk_bf16_f32 v189, v130, v131
v_mfma_f32_16x16x32_bf16 a[4:7], a[152:155], v[168:171], a[4:7]
v_exp_f32 v146, v146
v_mfma_f32_16x16x32_bf16 a[8:11], a[160:163], v[168:171], a[8:11]
v_exp_f32 v147, v147
v_mfma_f32_16x16x32_bf16 a[8:11], a[164:167], v[172:175], a[8:11]
v_exp_f32 v148, v148
v_mfma_f32_16x16x32_bf16 a[40:43], a[164:167], v[180:183], a[40:43]
ds_read_b128 a[204:207], v3 offset:15360
v_cvt_pk_bf16_f32 v196, v144, v145
v_mfma_f32_16x16x32_bf16 a[40:43], a[160:163], v[176:179], a[40:43]
v_exp_f32 v149, v149
v_mfma_f32_16x16x32_bf16 a[72:75], a[160:163], v[200:203], a[72:75]
v_exp_f32 v150, v150
v_mfma_f32_16x16x32_bf16 a[72:75], a[164:167], v[204:207], a[72:75]
v_exp_f32 v151, v151
v_mfma_f32_16x16x32_bf16 a[104:107], a[164:167], v[212:215], a[104:107]
v_exp_f32 v132, v132
v_mfma_f32_16x16x32_bf16 a[104:107], a[160:163], v[208:211], a[104:107]
s_waitcnt lgkmcnt(1)
v_exp_f32 v133, v133
v_mfma_f32_16x16x32_bf16 a[108:111], a[168:171], v[208:211], a[108:111]
v_exp_f32 v134, v134
v_mfma_f32_16x16x32_bf16 a[108:111], a[172:175], v[212:215], a[108:111]
v_exp_f32 v135, v135
v_mfma_f32_16x16x32_bf16 a[76:79], a[172:175], v[204:207], a[76:79]
v_exp_f32 v116, v116
v_mfma_f32_16x16x32_bf16 a[76:79], a[168:171], v[200:203], a[76:79]
v_exp_f32 v117, v117
v_mfma_f32_16x16x32_bf16 a[44:47], a[168:171], v[176:179], a[44:47]
v_exp_f32 v118, v118
v_mfma_f32_16x16x32_bf16 a[44:47], a[172:175], v[180:183], a[44:47]
s_waitcnt vmcnt(9)
s_barrier
v_mfma_f32_16x16x32_bf16 a[12:15], a[172:175], v[172:175], a[12:15]
s_xor_b32 s71, s71, 16384
v_exp_f32 v119, v119
v_mfma_f32_16x16x32_bf16 a[12:15], a[168:171], v[168:171], a[12:15]
s_add_u32 s70, s70, 32768
v_exp_f32 v100, v100
v_mfma_f32_16x16x32_bf16 a[16:19], a[176:179], v[168:171], a[16:19]
s_mov_b32 m0, s71
v_exp_f32 v101, v101
v_mfma_f32_16x16x32_bf16 a[16:19], a[180:183], v[172:175], a[16:19]
buffer_load_dwordx4 v16, s[32:35], s70 offen offset:0 sc1 lds
v_mfma_f32_16x16x32_bf16 a[48:51], a[180:183], v[180:183], a[48:51]
ds_read_b128 a[144:147], v2 offset:16384
v_cvt_pk_bf16_f32 v197, v146, v147
v_mfma_f32_16x16x32_bf16 a[48:51], a[176:179], v[176:179], a[48:51]
ds_read_b128 a[148:151], v2 offset:17408
v_cvt_pk_bf16_f32 v198, v148, v149
v_mfma_f32_16x16x32_bf16 a[80:83], a[176:179], v[200:203], a[80:83]
v_exp_f32 v102, v102
v_mfma_f32_16x16x32_bf16 a[80:83], a[180:183], v[204:207], a[80:83]
ds_read_b128 a[152:155], v2 offset:18432
v_cvt_pk_bf16_f32 v199, v150, v151
v_mfma_f32_16x16x32_bf16 a[112:115], a[180:183], v[212:215], a[112:115]
ds_read_b128 a[156:159], v2 offset:19456
v_cvt_pk_bf16_f32 v190, v132, v133
v_mfma_f32_16x16x32_bf16 a[112:115], a[176:179], v[208:211], a[112:115]
v_exp_f32 v103, v103
v_mfma_f32_16x16x32_bf16 a[116:119], a[184:187], v[208:211], a[116:119]
ds_read_b128 a[160:163], v2 offset:20480
v_cvt_pk_bf16_f32 v191, v134, v135
v_mfma_f32_16x16x32_bf16 a[116:119], a[188:191], v[212:215], a[116:119]
ds_read_b128 a[164:167], v2 offset:21504
v_cvt_pk_bf16_f32 v166, v116, v117
v_mfma_f32_16x16x32_bf16 a[84:87], a[188:191], v[204:207], a[84:87]
ds_read_b128 a[168:171], v2 offset:22528
v_cvt_pk_bf16_f32 v167, v118, v119
v_mfma_f32_16x16x32_bf16 a[84:87], a[184:187], v[200:203], a[84:87]
ds_read_b128 a[172:175], v2 offset:23552
v_cvt_pk_bf16_f32 v158, v100, v101
v_mfma_f32_16x16x32_bf16 a[52:55], a[184:187], v[176:179], a[52:55]
v_cvt_pk_bf16_f32 v159, v102, v103
v_mfma_f32_16x16x32_bf16 a[52:55], a[188:191], v[180:183], a[52:55]
v_mfma_f32_16x16x32_bf16 a[20:23], a[188:191], v[172:175], a[20:23]
v_mfma_f32_16x16x32_bf16 a[20:23], a[184:187], v[168:171], a[20:23]
v_mfma_f32_16x16x32_bf16 a[24:27], a[192:195], v[168:171], a[24:27]
buffer_load_dwordx4 v16, s[32:35], s70 offen offset:1024 sc1 lds
v_mfma_f32_16x16x32_bf16 a[24:27], a[196:199], v[172:175], a[24:27]
v_mfma_f32_16x16x32_bf16 a[56:59], a[196:199], v[180:183], a[56:59]
v_mfma_f32_16x16x32_bf16 a[56:59], a[192:195], v[176:179], a[56:59]
v_mfma_f32_16x16x32_bf16 a[88:91], a[192:195], v[200:203], a[88:91]
v_mfma_f32_16x16x32_bf16 a[88:91], a[196:199], v[204:207], a[88:91]
v_mfma_f32_16x16x32_bf16 a[120:123], a[196:199], v[212:215], a[120:123]
v_mfma_f32_16x16x32_bf16 a[120:123], a[192:195], v[208:211], a[120:123]
v_mfma_f32_16x16x32_bf16 a[124:127], a[200:203], v[208:211], a[124:127]
s_waitcnt lgkmcnt(0)
v_mfma_f32_16x16x32_bf16 a[124:127], a[204:207], v[212:215], a[124:127]
v_mfma_f32_16x16x32_bf16 a[92:95], a[204:207], v[204:207], a[92:95]
v_mfma_f32_16x16x32_bf16 a[92:95], a[200:203], v[200:203], a[92:95]
v_mfma_f32_16x16x32_bf16 a[60:63], a[200:203], v[176:179], a[60:63]
v_mfma_f32_16x16x32_bf16 a[60:63], a[204:207], v[180:183], a[60:63]
v_mfma_f32_16x16x32_bf16 a[28:31], a[204:207], v[172:175], a[28:31]
v_mfma_f32_16x16x32_bf16 a[28:31], a[200:203], v[168:171], a[28:31]
v_mfma_f32_16x16x32_bf16 v[88:91], a[144:147], v[24:27], v[216:219]
ds_read_b128 a[176:179], v2 offset:24576
v_mfma_f32_16x16x32_bf16 v[88:91], a[148:151], v[28:31], v[88:91]
ds_read_b128 a[180:183], v2 offset:25600
v_mfma_f32_16x16x32_bf16 v[88:91], a[152:155], v[32:35], v[88:91]
buffer_load_dwordx4 v16, s[32:35], s70 offen offset:2048 sc1 lds
v_mfma_f32_16x16x32_bf16 v[88:91], a[156:159], v[36:39], v[88:91]
ds_read_b128 a[184:187], v2 offset:26624
v_mfma_f32_16x16x32_bf16 v[104:107], a[156:159], v[52:55], v[220:223]
v_mfma_f32_16x16x32_bf16 v[104:107], a[152:155], v[48:51], v[104:107]
v_mfma_f32_16x16x32_bf16 v[104:107], a[148:151], v[44:47], v[104:107]
ds_read_b128 a[188:191], v2 offset:27648
v_mfma_f32_16x16x32_bf16 v[104:107], a[144:147], v[40:43], v[104:107]
v_mfma_f32_16x16x32_bf16 v[120:123], a[144:147], v[56:59], v[224:227]
v_mfma_f32_16x16x32_bf16 v[120:123], a[148:151], v[60:63], v[120:123]
v_mfma_f32_16x16x32_bf16 v[120:123], a[152:155], v[64:67], v[120:123]
v_exp_f32 v88, v88
v_mfma_f32_16x16x32_bf16 v[120:123], a[156:159], v[68:71], v[120:123]
v_exp_f32 v89, v89
v_mfma_f32_16x16x32_bf16 v[136:139], a[156:159], v[84:87], v[228:231]
v_exp_f32 v90, v90
v_mfma_f32_16x16x32_bf16 v[136:139], a[152:155], v[80:83], v[136:139]
v_exp_f32 v91, v91
v_mfma_f32_16x16x32_bf16 v[136:139], a[148:151], v[76:79], v[136:139]
v_exp_f32 v104, v104
v_mfma_f32_16x16x32_bf16 v[136:139], a[144:147], v[72:75], v[136:139]
v_exp_f32 v105, v105
v_mfma_f32_16x16x32_bf16 v[140:143], a[160:163], v[72:75], v[228:231]
v_exp_f32 v106, v106
v_mfma_f32_16x16x32_bf16 v[140:143], a[164:167], v[76:79], v[140:143]
buffer_load_dwordx4 v16, s[32:35], s70 offen offset:3072 sc1 lds
v_mfma_f32_16x16x32_bf16 v[140:143], a[168:171], v[80:83], v[140:143]
v_exp_f32 v107, v107
v_mfma_f32_16x16x32_bf16 v[140:143], a[172:175], v[84:87], v[140:143]
v_cvt_pk_bf16_f32 v168, v88, v89
v_cvt_pk_bf16_f32 v169, v90, v91
v_mfma_f32_16x16x32_bf16 v[124:127], a[172:175], v[68:71], v[224:227]
v_exp_f32 v120, v120
v_mfma_f32_16x16x32_bf16 v[124:127], a[168:171], v[64:67], v[124:127]
v_exp_f32 v121, v121
v_mfma_f32_16x16x32_bf16 v[124:127], a[164:167], v[60:63], v[124:127]
v_exp_f32 v122, v122
v_mfma_f32_16x16x32_bf16 v[124:127], a[160:163], v[56:59], v[124:127]
v_exp_f32 v123, v123
v_mfma_f32_16x16x32_bf16 v[108:111], a[160:163], v[40:43], v[220:223]
v_exp_f32 v136, v136
v_mfma_f32_16x16x32_bf16 v[108:111], a[164:167], v[44:47], v[108:111]
v_exp_f32 v137, v137
v_mfma_f32_16x16x32_bf16 v[108:111], a[168:171], v[48:51], v[108:111]
v_exp_f32 v138, v138
v_mfma_f32_16x16x32_bf16 v[108:111], a[172:175], v[52:55], v[108:111]
v_cvt_pk_bf16_f32 v176, v104, v105
v_cvt_pk_bf16_f32 v177, v106, v107
v_mfma_f32_16x16x32_bf16 v[92:95], a[172:175], v[36:39], v[216:219]
v_exp_f32 v139, v139
v_mfma_f32_16x16x32_bf16 v[92:95], a[168:171], v[32:35], v[92:95]
ds_read_b128 a[192:195], v2 offset:28672
v_cvt_pk_bf16_f32 v200, v120, v121
v_mfma_f32_16x16x32_bf16 v[92:95], a[164:167], v[28:31], v[92:95]
v_exp_f32 v140, v140
v_mfma_f32_16x16x32_bf16 v[92:95], a[160:163], v[24:27], v[92:95]
s_waitcnt lgkmcnt(1)
s_add_u32 m0, s71, 4096
ds_read_b128 a[196:199], v2 offset:29696
v_cvt_pk_bf16_f32 v201, v122, v123
v_mfma_f32_16x16x32_bf16 v[96:99], a[176:179], v[24:27], v[216:219]
s_add_u32 s64, s70, 4096
ds_read_b128 a[200:203], v2 offset:30720
v_cvt_pk_bf16_f32 v208, v136, v137
v_mfma_f32_16x16x32_bf16 v[96:99], a[180:183], v[28:31], v[96:99]
buffer_load_dwordx4 v16, s[32:35], s64 offen offset:0 sc1 lds
v_mfma_f32_16x16x32_bf16 v[96:99], a[184:187], v[32:35], v[96:99]
v_exp_f32 v141, v141
v_mfma_f32_16x16x32_bf16 v[96:99], a[188:191], v[36:39], v[96:99]
ds_read_b128 a[204:207], v2 offset:31744
v_cvt_pk_bf16_f32 v209, v138, v139
v_mfma_f32_16x16x32_bf16 v[112:115], a[188:191], v[52:55], v[220:223]
v_exp_f32 v142, v142
v_mfma_f32_16x16x32_bf16 v[112:115], a[184:187], v[48:51], v[112:115]
v_exp_f32 v143, v143
v_mfma_f32_16x16x32_bf16 v[112:115], a[180:183], v[44:47], v[112:115]
v_exp_f32 v124, v124
v_mfma_f32_16x16x32_bf16 v[112:115], a[176:179], v[40:43], v[112:115]
v_exp_f32 v125, v125
v_mfma_f32_16x16x32_bf16 v[128:131], a[176:179], v[56:59], v[224:227]
v_exp_f32 v126, v126
v_mfma_f32_16x16x32_bf16 v[128:131], a[180:183], v[60:63], v[128:131]
v_exp_f32 v127, v127
v_mfma_f32_16x16x32_bf16 v[128:131], a[184:187], v[64:67], v[128:131]
v_exp_f32 v108, v108
v_mfma_f32_16x16x32_bf16 v[128:131], a[188:191], v[68:71], v[128:131]
v_exp_f32 v109, v109
v_mfma_f32_16x16x32_bf16 v[144:147], a[188:191], v[84:87], v[228:231]
v_exp_f32 v110, v110
v_mfma_f32_16x16x32_bf16 v[144:147], a[184:187], v[80:83], v[144:147]
ds_read_b128 a[144:147], v3 offset:16384
v_cvt_pk_bf16_f32 v210, v140, v141
v_mfma_f32_16x16x32_bf16 v[144:147], a[180:183], v[76:79], v[144:147]
ds_read_b128 a[148:151], v3 offset:24576
v_cvt_pk_bf16_f32 v211, v142, v143
v_mfma_f32_16x16x32_bf16 v[144:147], a[176:179], v[72:75], v[144:147]
s_branch L_po16
L_pg16:
s_branch L_pg20
L_po16:
s_waitcnt lgkmcnt(2)
v_exp_f32 v111, v111
v_mfma_f32_16x16x32_bf16 v[148:151], a[192:195], v[72:75], v[228:231]
buffer_load_dwordx4 v16, s[32:35], s64 offen offset:1024 sc1 lds
v_mfma_f32_16x16x32_bf16 v[148:151], a[196:199], v[76:79], v[148:151]
v_exp_f32 v92, v92
v_mfma_f32_16x16x32_bf16 v[148:151], a[200:203], v[80:83], v[148:151]
v_exp_f32 v93, v93
v_mfma_f32_16x16x32_bf16 v[148:151], a[204:207], v[84:87], v[148:151]
v_exp_f32 v94, v94
v_mfma_f32_16x16x32_bf16 v[132:135], a[204:207], v[68:71], v[224:227]
ds_read_b128 a[152:155], v3 offset:17408
v_cvt_pk_bf16_f32 v202, v124, v125
v_mfma_f32_16x16x32_bf16 v[132:135], a[200:203], v[64:67], v[132:135]
ds_read_b128 a[156:159], v3 offset:25600
v_cvt_pk_bf16_f32 v203, v126, v127
v_mfma_f32_16x16x32_bf16 v[132:135], a[196:199], v[60:63], v[132:135]
v_exp_f32 v95, v95
v_mfma_f32_16x16x32_bf16 v[132:135], a[192:195], v[56:59], v[132:135]
v_exp_f32 v96, v96
v_mfma_f32_16x16x32_bf16 v[116:119], a[192:195], v[40:43], v[220:223]
v_exp_f32 v97, v97
v_mfma_f32_16x16x32_bf16 v[116:119], a[196:199], v[44:47], v[116:119]
v_exp_f32 v98, v98
v_mfma_f32_16x16x32_bf16 v[116:119], a[200:203], v[48:51], v[116:119]
ds_read_b128 a[160:163], v3 offset:18432
v_cvt_pk_bf16_f32 v178, v108, v109
v_mfma_f32_16x16x32_bf16 v[116:119], a[204:207], v[52:55], v[116:119]
v_exp_f32 v99, v99
v_mfma_f32_16x16x32_bf16 v[100:103], a[204:207], v[36:39], v[216:219]
ds_read_b128 a[164:167], v3 offset:26624
v_cvt_pk_bf16_f32 v179, v110, v111
v_mfma_f32_16x16x32_bf16 v[100:103], a[200:203], v[32:35], v[100:103]
v_exp_f32 v112, v112
v_mfma_f32_16x16x32_bf16 v[100:103], a[196:199], v[28:31], v[100:103]
v_exp_f32 v113, v113
v_mfma_f32_16x16x32_bf16 v[100:103], a[192:195], v[24:27], v[100:103]
v_exp_f32 v114, v114
v_smfmac_f32_16x16x64_bf16 a[128:131], a[240:243], v[152:159], v5
ds_read_b128 a[168:171], v3 offset:19456
v_smfmac_f32_16x16x64_bf16 a[132:135], a[240:243], v[160:167], v5
ds_read_b128 a[172:175], v3 offset:27648
v_smfmac_f32_16x16x64_bf16 a[136:139], a[240:243], v[184:191], v5
ds_read_b128 a[176:179], v3 offset:20480
v_smfmac_f32_16x16x64_bf16 a[140:143], a[240:243], v[192:199], v5
s_waitcnt lgkmcnt(3)
buffer_load_dwordx4 v16, s[32:35], s64 offen offset:2048 sc1 lds
v_mfma_f32_16x16x32_bf16 a[0:3], a[144:147], v[152:155], a[0:3]
v_exp_f32 v115, v115
v_mfma_f32_16x16x32_bf16 a[0:3], a[148:151], v[156:159], a[0:3]
v_exp_f32 v128, v128
v_mfma_f32_16x16x32_bf16 a[32:35], a[148:151], v[164:167], a[32:35]
v_exp_f32 v129, v129
v_mfma_f32_16x16x32_bf16 a[32:35], a[144:147], v[160:163], a[32:35]
v_exp_f32 v130, v130
v_mfma_f32_16x16x32_bf16 a[64:67], a[144:147], v[184:187], a[64:67]
v_exp_f32 v131, v131
v_mfma_f32_16x16x32_bf16 a[64:67], a[148:151], v[188:191], a[64:67]
v_cvt_pk_bf16_f32 v170, v92, v93
v_cvt_pk_bf16_f32 v171, v94, v95
v_mfma_f32_16x16x32_bf16 a[96:99], a[148:151], v[196:199], a[96:99]
v_exp_f32 v144, v144
v_mfma_f32_16x16x32_bf16 a[96:99], a[144:147], v[192:195], a[96:99]
ds_read_b128 a[180:183], v3 offset:28672
v_cvt_pk_bf16_f32 v172, v96, v97
v_mfma_f32_16x16x32_bf16 a[100:103], a[152:155], v[192:195], a[100:103]
v_exp_f32 v145, v145
v_mfma_f32_16x16x32_bf16 a[100:103], a[156:159], v[196:199], a[100:103]
ds_read_b128 a[184:187], v3 offset:21504
v_xor_b32 v2, 0x8000, v2
v_mfma_f32_16x16x32_bf16 a[68:71], a[156:159], v[188:191], a[68:71]
ds_read_b128 a[188:191], v3 offset:29696
v_cvt_pk_bf16_f32 v173, v98, v99
v_mfma_f32_16x16x32_bf16 a[68:71], a[152:155], v[184:187], a[68:71]
buffer_load_dwordx4 v16, s[32:35], s64 offen offset:3072 sc1 lds
v_mfma_f32_16x16x32_bf16 a[36:39], a[152:155], v[160:163], a[36:39]
ds_read_b128 a[192:195], v3 offset:22528
v_cvt_pk_bf16_f32 v180, v112, v113
v_mfma_f32_16x16x32_bf16 a[36:39], a[156:159], v[164:167], a[36:39]
ds_read_b128 a[196:199], v3 offset:30720
v_cvt_pk_bf16_f32 v181, v114, v115
v_mfma_f32_16x16x32_bf16 a[4:7], a[156:159], v[156:159], a[4:7]
ds_read_b128 a[200:203], v3 offset:23552
v_cvt_pk_bf16_f32 v204, v128, v129
v_mfma_f32_16x16x32_bf16 a[4:7], a[152:155], v[152:155], a[4:7]
v_exp_f32 v146, v146
v_mfma_f32_16x16x32_bf16 a[8:11], a[160:163], v[152:155], a[8:11]
v_exp_f32 v147, v147
v_mfma_f32_16x16x32_bf16 a[8:11], a[164:167], v[156:159], a[8:11]
v_exp_f32 v148, v148
v_mfma_f32_16x16x32_bf16 a[40:43], a[164:167], v[164:167], a[40:43]
ds_read_b128 a[204:207], v3 offset:31744
v_cvt_pk_bf16_f32 v205, v130, v131
v_mfma_f32_16x16x32_bf16 a[40:43], a[160:163], v[160:163], a[40:43]
v_exp_f32 v149, v149
v_mfma_f32_16x16x32_bf16 a[72:75], a[160:163], v[184:187], a[72:75]
v_exp_f32 v150, v150
v_mfma_f32_16x16x32_bf16 a[72:75], a[164:167], v[188:191], a[72:75]
v_exp_f32 v151, v151
v_mfma_f32_16x16x32_bf16 a[104:107], a[164:167], v[196:199], a[104:107]
v_exp_f32 v132, v132
v_mfma_f32_16x16x32_bf16 a[104:107], a[160:163], v[192:195], a[104:107]
s_waitcnt lgkmcnt(1)
v_exp_f32 v133, v133
v_mfma_f32_16x16x32_bf16 a[108:111], a[168:171], v[192:195], a[108:111]
v_exp_f32 v134, v134
v_mfma_f32_16x16x32_bf16 a[108:111], a[172:175], v[196:199], a[108:111]
v_exp_f32 v135, v135
v_mfma_f32_16x16x32_bf16 a[76:79], a[172:175], v[188:191], a[76:79]
v_exp_f32 v116, v116
v_mfma_f32_16x16x32_bf16 a[76:79], a[168:171], v[184:187], a[76:79]
v_exp_f32 v117, v117
v_mfma_f32_16x16x32_bf16 a[44:47], a[168:171], v[160:163], a[44:47]
v_exp_f32 v118, v118
v_mfma_f32_16x16x32_bf16 a[44:47], a[172:175], v[164:167], a[44:47]
s_waitcnt vmcnt(8)
s_barrier
v_mfma_f32_16x16x32_bf16 a[12:15], a[172:175], v[156:159], a[12:15]
s_xor_b32 s71, s71, 49152
v_exp_f32 v119, v119
v_mfma_f32_16x16x32_bf16 a[12:15], a[168:171], v[152:155], a[12:15]
s_add_u32 s70, s70, 32768
v_exp_f32 v100, v100
v_mfma_f32_16x16x32_bf16 a[16:19], a[176:179], v[152:155], a[16:19]
s_mov_b32 m0, s71
v_exp_f32 v101, v101
v_mfma_f32_16x16x32_bf16 a[16:19], a[180:183], v[156:159], a[16:19]
buffer_load_dwordx4 v16, s[32:35], s70 offen offset:0 sc1 lds
v_mfma_f32_16x16x32_bf16 a[48:51], a[180:183], v[164:167], a[48:51]
ds_read_b128 a[144:147], v2 offset:0
v_cvt_pk_bf16_f32 v212, v144, v145
v_mfma_f32_16x16x32_bf16 a[48:51], a[176:179], v[160:163], a[48:51]
ds_read_b128 a[148:151], v2 offset:1024
v_cvt_pk_bf16_f32 v213, v146, v147
v_mfma_f32_16x16x32_bf16 a[80:83], a[176:179], v[184:187], a[80:83]
v_exp_f32 v102, v102
v_mfma_f32_16x16x32_bf16 a[80:83], a[180:183], v[188:191], a[80:83]
ds_read_b128 a[152:155], v2 offset:2048
v_cvt_pk_bf16_f32 v214, v148, v149
v_mfma_f32_16x16x32_bf16 a[112:115], a[180:183], v[196:199], a[112:115]
ds_read_b128 a[156:159], v2 offset:3072
v_cvt_pk_bf16_f32 v215, v150, v151
v_mfma_f32_16x16x32_bf16 a[112:115], a[176:179], v[192:195], a[112:115]
v_exp_f32 v103, v103
v_mfma_f32_16x16x32_bf16 a[116:119], a[184:187], v[192:195], a[116:119]
ds_read_b128 a[160:163], v2 offset:4096
v_cvt_pk_bf16_f32 v206, v132, v133
v_mfma_f32_16x16x32_bf16 a[116:119], a[188:191], v[196:199], a[116:119]
ds_read_b128 a[164:167], v2 offset:5120
v_cvt_pk_bf16_f32 v207, v134, v135
v_mfma_f32_16x16x32_bf16 a[84:87], a[188:191], v[188:191], a[84:87]
ds_read_b128 a[168:171], v2 offset:6144
v_xor_b32 v3, 0x8000, v3
v_mfma_f32_16x16x32_bf16 a[84:87], a[184:187], v[184:187], a[84:87]
ds_read_b128 a[172:175], v2 offset:7168
v_cvt_pk_bf16_f32 v182, v116, v117
v_mfma_f32_16x16x32_bf16 a[52:55], a[184:187], v[160:163], a[52:55]
v_cvt_pk_bf16_f32 v183, v118, v119
v_cvt_pk_bf16_f32 v174, v100, v101
v_mfma_f32_16x16x32_bf16 a[52:55], a[188:191], v[164:167], a[52:55]
v_cvt_pk_bf16_f32 v175, v102, v103
v_mfma_f32_16x16x32_bf16 a[20:23], a[188:191], v[156:159], a[20:23]
v_mfma_f32_16x16x32_bf16 a[20:23], a[184:187], v[152:155], a[20:23]
v_mfma_f32_16x16x32_bf16 a[24:27], a[192:195], v[152:155], a[24:27]
buffer_load_dwordx4 v16, s[32:35], s70 offen offset:1024 sc1 lds
v_mfma_f32_16x16x32_bf16 a[24:27], a[196:199], v[156:159], a[24:27]
v_mfma_f32_16x16x32_bf16 a[56:59], a[196:199], v[164:167], a[56:59]
v_mfma_f32_16x16x32_bf16 a[56:59], a[192:195], v[160:163], a[56:59]
v_mfma_f32_16x16x32_bf16 a[88:91], a[192:195], v[184:187], a[88:91]
v_mfma_f32_16x16x32_bf16 a[88:91], a[196:199], v[188:191], a[88:91]
v_mfma_f32_16x16x32_bf16 a[120:123], a[196:199], v[196:199], a[120:123]
s_sub_u32 s72, s72, 1
v_mfma_f32_16x16x32_bf16 a[120:123], a[192:195], v[192:195], a[120:123]
v_mfma_f32_16x16x32_bf16 a[124:127], a[200:203], v[192:195], a[124:127]
s_waitcnt lgkmcnt(0)
v_mfma_f32_16x16x32_bf16 a[124:127], a[204:207], v[196:199], a[124:127]
v_mfma_f32_16x16x32_bf16 a[92:95], a[204:207], v[188:191], a[92:95]
s_cmp_lg_u32 s72, 0
v_mfma_f32_16x16x32_bf16 a[92:95], a[200:203], v[184:187], a[92:95]
v_mfma_f32_16x16x32_bf16 a[60:63], a[200:203], v[160:163], a[60:63]
v_mfma_f32_16x16x32_bf16 a[60:63], a[204:207], v[164:167], a[60:63]
v_mfma_f32_16x16x32_bf16 a[28:31], a[204:207], v[156:159], a[28:31]
v_mfma_f32_16x16x32_bf16 a[28:31], a[200:203], v[152:155], a[28:31]
s_cbranch_scc1 L_D
L_DD:
s_waitcnt lgkmcnt(7)
v_mfma_f32_16x16x32_bf16 v[104:107], a[144:147], v[40:43], v[220:223]
s_waitcnt lgkmcnt(6)
ds_read_b128 a[176:179], v2 offset:8192
v_cndmask_b32 v88, v216, v17, s[0:1]
v_mfma_f32_16x16x32_bf16 v[104:107], a[148:151], v[44:47], v[104:107]
s_waitcnt lgkmcnt(6)
ds_read_b128 a[180:183], v2 offset:9216
v_cndmask_b32 v89, v216, v17, s[4:5]
v_mfma_f32_16x16x32_bf16 v[104:107], a[152:155], v[48:51], v[104:107]
s_waitcnt lgkmcnt(6)
buffer_load_dwordx4 v16, s[32:35], s70 offen offset:2048 sc1 lds
v_mfma_f32_16x16x32_bf16 v[104:107], a[156:159], v[52:55], v[104:107]
ds_read_b128 a[184:187], v2 offset:10240
v_cndmask_b32 v90, v216, v17, s[6:7]
v_mfma_f32_16x16x32_bf16 v[120:123], a[156:159], v[68:71], v[224:227]
ds_read_b128 a[188:191], v2 offset:11264
v_cndmask_b32 v91, v216, v17, s[8:9]
v_mfma_f32_16x16x32_bf16 v[120:123], a[152:155], v[64:67], v[120:123]
ds_read_b128 a[192:195], v2 offset:12288
v_cndmask_b32 v92, v216, v17, s[10:11]
v_mfma_f32_16x16x32_bf16 v[120:123], a[148:151], v[60:63], v[120:123]
ds_read_b128 a[196:199], v2 offset:13312
v_cndmask_b32 v93, v216, v17, s[12:13]
v_mfma_f32_16x16x32_bf16 v[120:123], a[144:147], v[56:59], v[120:123]
ds_read_b128 a[200:203], v2 offset:14336
v_cndmask_b32 v94, v216, v17, s[18:19]
v_mfma_f32_16x16x32_bf16 v[136:139], a[144:147], v[72:75], v[228:231]
ds_read_b128 a[204:207], v2 offset:15360
v_cndmask_b32 v95, v216, v17, s[22:23]
v_mfma_f32_16x16x32_bf16 v[136:139], a[148:151], v[76:79], v[136:139]
v_cndmask_b32 v96, v216, v17, s[26:27]
v_cndmask_b32 v97, v216, v17, s[56:57]
v_mfma_f32_16x16x32_bf16 v[136:139], a[152:155], v[80:83], v[136:139]
v_exp_f32 v104, v104
v_mfma_f32_16x16x32_bf16 v[136:139], a[156:159], v[84:87], v[136:139]
v_exp_f32 v105, v105
v_mfma_f32_16x16x32_bf16 v[88:91], a[156:159], v[36:39], v[88:91]
v_exp_f32 v106, v106
v_mfma_f32_16x16x32_bf16 v[88:91], a[152:155], v[32:35], v[88:91]
v_exp_f32 v107, v107
v_mfma_f32_16x16x32_bf16 v[88:91], a[148:151], v[28:31], v[88:91]
v_exp_f32 v120, v120
v_mfma_f32_16x16x32_bf16 v[88:91], a[144:147], v[24:27], v[88:91]
s_waitcnt lgkmcnt(0)
v_exp_f32 v121, v121
v_mfma_f32_16x16x32_bf16 v[140:143], a[160:163], v[72:75], v[228:231]
v_exp_f32 v122, v122
v_mfma_f32_16x16x32_bf16 v[140:143], a[164:167], v[76:79], v[140:143]
buffer_load_dwordx4 v16, s[32:35], s70 offen offset:3072 sc1 lds
v_mfma_f32_16x16x32_bf16 v[140:143], a[168:171], v[80:83], v[140:143]
s_add_u32 m0, s86, 131072
v_exp_f32 v123, v123
v_mfma_f32_16x16x32_bf16 v[140:143], a[172:175], v[84:87], v[140:143]
s_add_u32 s64, s85, 0
v_cvt_pk_bf16_f32 v160, v104, v105
v_cvt_pk_bf16_f32 v161, v106, v107
v_mfma_f32_16x16x32_bf16 v[124:127], a[172:175], v[68:71], v[224:227]
buffer_load_dwordx4 v12, s[36:39], s64 offen lds
v_mfma_f32_16x16x32_bf16 v[124:127], a[168:171], v[64:67], v[124:127]
s_add_u32 m0, s86, 132096
v_exp_f32 v136, v136
v_mfma_f32_16x16x32_bf16 v[124:127], a[164:167], v[60:63], v[124:127]
s_add_u32 s64, s85, 8192
v_exp_f32 v137, v137
v_mfma_f32_16x16x32_bf16 v[124:127], a[160:163], v[56:59], v[124:127]
buffer_load_dwordx4 v13, s[36:39], s64 offen lds
v_mfma_f32_16x16x32_bf16 v[108:111], a[160:163], v[40:43], v[220:223]
v_exp_f32 v138, v138
v_mfma_f32_16x16x32_bf16 v[108:111], a[164:167], v[44:47], v[108:111]
ds_read_b128 a[144:147], v3 offset:0
v_cndmask_b32 v98, v216, v17, s[58:59]
v_mfma_f32_16x16x32_bf16 v[108:111], a[168:171], v[48:51], v[108:111]
s_add_u32 m0, s86, 133120
ds_read_b128 a[148:151], v3 offset:8192
v_cndmask_b32 v99, v216, v17, s[60:61]
v_mfma_f32_16x16x32_bf16 v[108:111], a[172:175], v[52:55], v[108:111]
s_add_u32 s64, s85, 16384
v_cvt_pk_bf16_f32 v184, v120, v121
v_cvt_pk_bf16_f32 v185, v122, v123
v_mfma_f32_16x16x32_bf16 v[92:95], a[172:175], v[36:39], v[92:95]
buffer_load_dwordx4 v12, s[36:39], s64 offen lds
v_mfma_f32_16x16x32_bf16 v[92:95], a[168:171], v[32:35], v[92:95]
s_add_u32 m0, s86, 134144
v_exp_f32 v139, v139
v_mfma_f32_16x16x32_bf16 v[92:95], a[164:167], v[28:31], v[92:95]
s_add_u32 s64, s85, 24576
v_exp_f32 v88, v88
v_mfma_f32_16x16x32_bf16 v[92:95], a[160:163], v[24:27], v[92:95]
buffer_load_dwordx4 v13, s[36:39], s64 offen lds
v_mfma_f32_16x16x32_bf16 v[96:99], a[176:179], v[24:27], v[96:99]
s_add_u32 m0, s71, 4096
v_exp_f32 v89, v89
v_mfma_f32_16x16x32_bf16 v[96:99], a[180:183], v[28:31], v[96:99]
s_add_u32 s64, s70, 4096
v_exp_f32 v90, v90
v_mfma_f32_16x16x32_bf16 v[96:99], a[184:187], v[32:35], v[96:99]
buffer_load_dwordx4 v16, s[32:35], s64 offen offset:0 sc1 lds
v_mfma_f32_16x16x32_bf16 v[96:99], a[188:191], v[36:39], v[96:99]
v_cvt_pk_bf16_f32 v192, v136, v137
v_cvt_pk_bf16_f32 v193, v138, v139
v_mfma_f32_16x16x32_bf16 v[112:115], a[188:191], v[52:55], v[220:223]
v_exp_f32 v91, v91
v_mfma_f32_16x16x32_bf16 v[112:115], a[184:187], v[48:51], v[112:115]
v_exp_f32 v140, v140
v_mfma_f32_16x16x32_bf16 v[112:115], a[180:183], v[44:47], v[112:115]
v_exp_f32 v141, v141
v_mfma_f32_16x16x32_bf16 v[112:115], a[176:179], v[40:43], v[112:115]
v_exp_f32 v142, v142
v_mfma_f32_16x16x32_bf16 v[128:131], a[176:179], v[56:59], v[224:227]
v_exp_f32 v143, v143
v_mfma_f32_16x16x32_bf16 v[128:131], a[180:183], v[60:63], v[128:131]
v_exp_f32 v124, v124
v_mfma_f32_16x16x32_bf16 v[128:131], a[184:187], v[64:67], v[128:131]
v_cvt_pk_bf16_f32 v152, v88, v89
v_cvt_pk_bf16_f32 v153, v90, v91
v_mfma_f32_16x16x32_bf16 v[128:131], a[188:191], v[68:71], v[128:131]
v_exp_f32 v125, v125
v_mfma_f32_16x16x32_bf16 v[144:147], a[188:191], v[84:87], v[228:231]
v_exp_f32 v126, v126
v_mfma_f32_16x16x32_bf16 v[144:147], a[184:187], v[80:83], v[144:147]
v_exp_f32 v127, v127
v_mfma_f32_16x16x32_bf16 v[144:147], a[180:183], v[76:79], v[144:147]
v_exp_f32 v108, v108
v_mfma_f32_16x16x32_bf16 v[144:147], a[176:179], v[72:75], v[144:147]
ds_read_b128 a[152:155], v3 offset:1024
v_cndmask_b32 v100, v216, v17, s[62:63]
v_mfma_f32_16x16x32_bf16 v[148:151], a[192:195], v[72:75], v[228:231]
buffer_load_dwordx4 v16, s[32:35], s64 offen offset:1024 sc1 lds
v_mfma_f32_16x16x32_bf16 v[148:151], a[196:199], v[76:79], v[148:151]
ds_read_b128 a[156:159], v3 offset:9216
v_cndmask_b32 v101, v216, v17, s[48:49]
v_mfma_f32_16x16x32_bf16 v[148:151], a[200:203], v[80:83], v[148:151]
v_cvt_pk_bf16_f32 v194, v140, v141
v_cvt_pk_bf16_f32 v195, v142, v143
v_mfma_f32_16x16x32_bf16 v[148:151], a[204:207], v[84:87], v[148:151]
ds_read_b128 a[160:163], v3 offset:2048
v_cndmask_b32 v102, v216, v17, s[50:51]
v_mfma_f32_16x16x32_bf16 v[132:135], a[204:207], v[68:71], v[224:227]
ds_read_b128 a[164:167], v3 offset:10240
v_cndmask_b32 v103, v216, v17, s[100:101]
v_mfma_f32_16x16x32_bf16 v[132:135], a[200:203], v[64:67], v[132:135]
v_exp_f32 v109, v109
v_mfma_f32_16x16x32_bf16 v[132:135], a[196:199], v[60:63], v[132:135]
v_exp_f32 v110, v110
v_mfma_f32_16x16x32_bf16 v[132:135], a[192:195], v[56:59], v[132:135]
v_exp_f32 v111, v111
v_mfma_f32_16x16x32_bf16 v[116:119], a[192:195], v[40:43], v[220:223]
v_exp_f32 v92, v92
v_mfma_f32_16x16x32_bf16 v[116:119], a[196:199], v[44:47], v[116:119]
v_cvt_pk_bf16_f32 v186, v124, v125
v_cvt_pk_bf16_f32 v187, v126, v127
v_mfma_f32_16x16x32_bf16 v[116:119], a[200:203], v[48:51], v[116:119]
v_exp_f32 v93, v93
v_mfma_f32_16x16x32_bf16 v[116:119], a[204:207], v[52:55], v[116:119]
v_exp_f32 v94, v94
v_mfma_f32_16x16x32_bf16 v[100:103], a[204:207], v[36:39], v[100:103]
v_exp_f32 v95, v95
v_mfma_f32_16x16x32_bf16 v[100:103], a[200:203], v[32:35], v[100:103]
v_exp_f32 v96, v96
v_mfma_f32_16x16x32_bf16 v[100:103], a[196:199], v[28:31], v[100:103]
v_exp_f32 v97, v97
v_mfma_f32_16x16x32_bf16 v[100:103], a[192:195], v[24:27], v[100:103]
v_exp_f32 v98, v98
v_smfmac_f32_16x16x64_bf16 a[128:131], a[240:243], v[168:175], v5
ds_read_b128 a[168:171], v3 offset:3072
v_smfmac_f32_16x16x64_bf16 a[132:135], a[240:243], v[176:183], v5
v_cvt_pk_bf16_f32 v162, v108, v109
v_smfmac_f32_16x16x64_bf16 a[136:139], a[240:243], v[200:207], v5
ds_read_b128 a[172:175], v3 offset:11264
v_smfmac_f32_16x16x64_bf16 a[140:143], a[240:243], v[208:215], v5
s_waitcnt lgkmcnt(2)
buffer_load_dwordx4 v16, s[32:35], s64 offen offset:2048 sc1 lds
v_mfma_f32_16x16x32_bf16 a[0:3], a[144:147], v[168:171], a[0:3]
v_exp_f32 v99, v99
v_mfma_f32_16x16x32_bf16 a[0:3], a[148:151], v[172:175], a[0:3]
v_cvt_pk_bf16_f32 v163, v110, v111
v_cvt_pk_bf16_f32 v154, v92, v93
v_mfma_f32_16x16x32_bf16 a[32:35], a[148:151], v[180:183], a[32:35]
v_exp_f32 v112, v112
v_mfma_f32_16x16x32_bf16 a[32:35], a[144:147], v[176:179], a[32:35]
v_exp_f32 v113, v113
v_mfma_f32_16x16x32_bf16 a[64:67], a[144:147], v[200:203], a[64:67]
v_exp_f32 v114, v114
v_mfma_f32_16x16x32_bf16 a[64:67], a[148:151], v[204:207], a[64:67]
v_exp_f32 v115, v115
v_mfma_f32_16x16x32_bf16 a[96:99], a[148:151], v[212:215], a[96:99]
v_exp_f32 v128, v128
v_mfma_f32_16x16x32_bf16 a[96:99], a[144:147], v[208:211], a[96:99]
v_exp_f32 v129, v129
v_mfma_f32_16x16x32_bf16 a[100:103], a[152:155], v[208:211], a[100:103]
v_exp_f32 v130, v130
v_mfma_f32_16x16x32_bf16 a[100:103], a[156:159], v[212:215], a[100:103]
v_cvt_pk_bf16_f32 v155, v94, v95
v_cvt_pk_bf16_f32 v156, v96, v97
v_mfma_f32_16x16x32_bf16 a[68:71], a[156:159], v[204:207], a[68:71]
v_exp_f32 v131, v131
v_mfma_f32_16x16x32_bf16 a[68:71], a[152:155], v[200:203], a[68:71]
buffer_load_dwordx4 v16, s[32:35], s64 offen offset:3072 sc1 lds
v_mfma_f32_16x16x32_bf16 a[36:39], a[152:155], v[176:179], a[36:39]
s_add_u32 m0, s86, 135168
ds_read_b128 a[176:179], v3 offset:4096
v_cvt_pk_bf16_f32 v157, v98, v99
v_mfma_f32_16x16x32_bf16 a[36:39], a[156:159], v[180:183], a[36:39]
s_add_u32 s64, s85, 32768
v_exp_f32 v144, v144
v_mfma_f32_16x16x32_bf16 a[4:7], a[156:159], v[172:175], a[4:7]
buffer_load_dwordx4 v12, s[36:39], s64 offen lds
v_mfma_f32_16x16x32_bf16 a[4:7], a[152:155], v[168:171], a[4:7]
s_add_u32 m0, s86, 136192
ds_read_b128 a[180:183], v3 offset:12288
v_cvt_pk_bf16_f32 v164, v112, v113
v_mfma_f32_16x16x32_bf16 a[8:11], a[160:163], v[168:171], a[8:11]
s_add_u32 s64, s85, 40960
v_exp_f32 v145, v145
v_mfma_f32_16x16x32_bf16 a[8:11], a[164:167], v[172:175], a[8:11]
buffer_load_dwordx4 v13, s[36:39], s64 offen lds
v_mfma_f32_16x16x32_bf16 a[40:43], a[164:167], v[180:183], a[40:43]
ds_read_b128 a[184:187], v3 offset:5120
v_cvt_pk_bf16_f32 v165, v114, v115
v_mfma_f32_16x16x32_bf16 a[40:43], a[160:163], v[176:179], a[40:43]
ds_read_b128 a[188:191], v3 offset:13312
v_cvt_pk_bf16_f32 v188, v128, v129
v_mfma_f32_16x16x32_bf16 a[72:75], a[160:163], v[200:203], a[72:75]
ds_read_b128 a[192:195], v3 offset:6144
v_cvt_pk_bf16_f32 v189, v130, v131
v_mfma_f32_16x16x32_bf16 a[72:75], a[164:167], v[204:207], a[72:75]
ds_read_b128 a[196:199], v3 offset:14336
v_cvt_pk_bf16_f32 v196, v144, v145
v_mfma_f32_16x16x32_bf16 a[104:107], a[164:167], v[212:215], a[104:107]
ds_read_b128 a[200:203], v3 offset:7168
v_mfma_f32_16x16x32_bf16 a[104:107], a[160:163], v[208:211], a[104:107]
s_waitcnt lgkmcnt(5)
s_add_u32 m0, s86, 137216
ds_read_b128 a[204:207], v3 offset:15360
v_mfma_f32_16x16x32_bf16 a[108:111], a[168:171], v[208:211], a[108:111]
s_add_u32 s64, s85, 49152
v_exp_f32 v146, v146
v_mfma_f32_16x16x32_bf16 a[108:111], a[172:175], v[212:215], a[108:111]
buffer_load_dwordx4 v12, s[36:39], s64 offen lds
v_mfma_f32_16x16x32_bf16 a[76:79], a[172:175], v[204:207], a[76:79]
s_add_u32 m0, s86, 138240
v_exp_f32 v147, v147
v_mfma_f32_16x16x32_bf16 a[76:79], a[168:171], v[200:203], a[76:79]
s_add_u32 s64, s85, 57344
v_exp_f32 v148, v148
v_mfma_f32_16x16x32_bf16 a[44:47], a[168:171], v[176:179], a[44:47]
buffer_load_dwordx4 v13, s[36:39], s64 offen lds
v_mfma_f32_16x16x32_bf16 a[44:47], a[172:175], v[180:183], a[44:47]
s_waitcnt vmcnt(16)
s_barrier
v_mfma_f32_16x16x32_bf16 a[12:15], a[172:175], v[172:175], a[12:15]
s_xor_b32 s71, s71, 16384
v_exp_f32 v149, v149
v_mfma_f32_16x16x32_bf16 a[12:15], a[168:171], v[168:171], a[12:15]
s_add_u32 s70, s70, 32768
v_exp_f32 v150, v150
v_mfma_f32_16x16x32_bf16 a[16:19], a[176:179], v[168:171], a[16:19]
s_mov_b32 m0, s71
v_exp_f32 v151, v151
v_mfma_f32_16x16x32_bf16 a[16:19], a[180:183], v[172:175], a[16:19]
buffer_load_dwordx4 v16, s[32:35], s70 offen offset:0 sc1 lds
v_mfma_f32_16x16x32_bf16 a[48:51], a[180:183], v[180:183], a[48:51]
v_exp_f32 v132, v132
v_mfma_f32_16x16x32_bf16 a[48:51], a[176:179], v[176:179], a[48:51]
v_exp_f32 v133, v133
v_mfma_f32_16x16x32_bf16 a[80:83], a[176:179], v[200:203], a[80:83]
v_exp_f32 v134, v134
v_mfma_f32_16x16x32_bf16 a[80:83], a[180:183], v[204:207], a[80:83]
v_exp_f32 v135, v135
v_mfma_f32_16x16x32_bf16 a[112:115], a[180:183], v[212:215], a[112:115]
v_exp_f32 v116, v116
v_mfma_f32_16x16x32_bf16 a[112:115], a[176:179], v[208:211], a[112:115]
s_waitcnt lgkmcnt(0)
v_cvt_pk_bf16_f32 v197, v146, v147
v_cvt_pk_bf16_f32 v198, v148, v149
v_mfma_f32_16x16x32_bf16 a[116:119], a[184:187], v[208:211], a[116:119]
v_exp_f32 v117, v117
v_mfma_f32_16x16x32_bf16 a[116:119], a[188:191], v[212:215], a[116:119]
v_exp_f32 v118, v118
v_mfma_f32_16x16x32_bf16 a[84:87], a[188:191], v[204:207], a[84:87]
v_exp_f32 v119, v119
v_mfma_f32_16x16x32_bf16 a[84:87], a[184:187], v[200:203], a[84:87]
v_exp_f32 v100, v100
v_mfma_f32_16x16x32_bf16 a[52:55], a[184:187], v[176:179], a[52:55]
v_exp_f32 v101, v101
v_mfma_f32_16x16x32_bf16 a[52:55], a[188:191], v[180:183], a[52:55]
ds_read_b128 a[144:147], v2 offset:16384
v_cvt_pk_bf16_f32 v199, v150, v151
v_mfma_f32_16x16x32_bf16 a[20:23], a[188:191], v[172:175], a[20:23]
ds_read_b128 a[148:151], v2 offset:17408
v_cvt_pk_bf16_f32 v190, v132, v133
v_mfma_f32_16x16x32_bf16 a[20:23], a[184:187], v[168:171], a[20:23]
v_exp_f32 v102, v102
v_mfma_f32_16x16x32_bf16 a[24:27], a[192:195], v[168:171], a[24:27]
buffer_load_dwordx4 v16, s[32:35], s70 offen offset:1024 sc1 lds
v_mfma_f32_16x16x32_bf16 a[24:27], a[196:199], v[172:175], a[24:27]
ds_read_b128 a[152:155], v2 offset:18432
v_cvt_pk_bf16_f32 v191, v134, v135
v_mfma_f32_16x16x32_bf16 a[56:59], a[196:199], v[180:183], a[56:59]
ds_read_b128 a[156:159], v2 offset:19456
v_cvt_pk_bf16_f32 v166, v116, v117
v_mfma_f32_16x16x32_bf16 a[56:59], a[192:195], v[176:179], a[56:59]
v_exp_f32 v103, v103
v_mfma_f32_16x16x32_bf16 a[88:91], a[192:195], v[200:203], a[88:91]
ds_read_b128 a[160:163], v2 offset:20480
v_cvt_pk_bf16_f32 v167, v118, v119
v_mfma_f32_16x16x32_bf16 a[88:91], a[196:199], v[204:207], a[88:91]
ds_read_b128 a[164:167], v2 offset:21504
v_cvt_pk_bf16_f32 v158, v100, v101
v_mfma_f32_16x16x32_bf16 a[120:123], a[196:199], v[212:215], a[120:123]
ds_read_b128 a[168:171], v2 offset:22528
v_cvt_pk_bf16_f32 v159, v102, v103
v_mfma_f32_16x16x32_bf16 a[120:123], a[192:195], v[208:211], a[120:123]
ds_read_b128 a[172:175], v2 offset:23552
v_cndmask_b32 v104, v220, v17, s[0:1]
v_mfma_f32_16x16x32_bf16 a[124:127], a[200:203], v[208:211], a[124:127]
v_cndmask_b32 v105, v220, v17, s[4:5]
v_cndmask_b32 v106, v220, v17, s[6:7]
v_mfma_f32_16x16x32_bf16 a[124:127], a[204:207], v[212:215], a[124:127]
v_cndmask_b32 v107, v220, v17, s[8:9]
v_cndmask_b32 v108, v220, v17, s[10:11]
v_mfma_f32_16x16x32_bf16 a[92:95], a[204:207], v[204:207], a[92:95]
v_cndmask_b32 v109, v220, v17, s[12:13]
v_cndmask_b32 v110, v220, v17, s[18:19]
v_mfma_f32_16x16x32_bf16 a[92:95], a[200:203], v[200:203], a[92:95]
v_cndmask_b32 v111, v220, v17, s[22:23]
v_cndmask_b32 v112, v220, v17, s[26:27]
v_mfma_f32_16x16x32_bf16 a[60:63], a[200:203], v[176:179], a[60:63]
v_cndmask_b32 v113, v220, v17, s[56:57]
v_cndmask_b32 v114, v220, v17, s[58:59]
v_mfma_f32_16x16x32_bf16 a[60:63], a[204:207], v[180:183], a[60:63]
v_cndmask_b32 v115, v220, v17, s[60:61]
v_cndmask_b32 v116, v220, v17, s[62:63]
v_mfma_f32_16x16x32_bf16 a[28:31], a[204:207], v[172:175], a[28:31]
v_cndmask_b32 v117, v220, v17, s[48:49]
v_cndmask_b32 v118, v220, v17, s[50:51]
v_mfma_f32_16x16x32_bf16 a[28:31], a[200:203], v[168:171], a[28:31]
s_waitcnt lgkmcnt(0)
v_cndmask_b32 v119, v220, v17, s[100:101]
v_mfma_f32_16x16x32_bf16 v[120:123], a[144:147], v[56:59], v[224:227]
ds_read_b128 a[176:179], v2 offset:24576
v_mfma_f32_16x16x32_bf16 v[120:123], a[148:151], v[60:63], v[120:123]
ds_read_b128 a[180:183], v2 offset:25600
v_mfma_f32_16x16x32_bf16 v[120:123], a[152:155], v[64:67], v[120:123]
buffer_load_dwordx4 v16, s[32:35], s70 offen offset:2048 sc1 lds
v_mfma_f32_16x16x32_bf16 v[120:123], a[156:159], v[68:71], v[120:123]
ds_read_b128 a[184:187], v2 offset:26624
v_mfma_f32_16x16x32_bf16 v[136:139], a[156:159], v[84:87], v[228:231]
ds_read_b128 a[188:191], v2 offset:27648
v_mfma_f32_16x16x32_bf16 v[136:139], a[152:155], v[80:83], v[136:139]
v_mfma_f32_16x16x32_bf16 v[136:139], a[148:151], v[76:79], v[136:139]
v_mfma_f32_16x16x32_bf16 v[136:139], a[144:147], v[72:75], v[136:139]
v_mfma_f32_16x16x32_bf16 v[104:107], a[144:147], v[40:43], v[104:107]
ds_read_b128 a[192:195], v2 offset:28672
v_mfma_f32_16x16x32_bf16 v[104:107], a[148:151], v[44:47], v[104:107]
v_mfma_f32_16x16x32_bf16 v[104:107], a[152:155], v[48:51], v[104:107]
v_exp_f32 v120, v120
v_mfma_f32_16x16x32_bf16 v[104:107], a[156:159], v[52:55], v[104:107]
v_exp_f32 v121, v121
v_mfma_f32_16x16x32_bf16 v[140:143], a[172:175], v[84:87], v[228:231]
v_exp_f32 v122, v122
v_mfma_f32_16x16x32_bf16 v[140:143], a[168:171], v[80:83], v[140:143]
v_exp_f32 v123, v123
v_mfma_f32_16x16x32_bf16 v[140:143], a[164:167], v[76:79], v[140:143]
v_exp_f32 v136, v136
v_mfma_f32_16x16x32_bf16 v[140:143], a[160:163], v[72:75], v[140:143]
buffer_load_dwordx4 v16, s[32:35], s70 offen offset:3072 sc1 lds
v_mfma_f32_16x16x32_bf16 v[124:127], a[160:163], v[56:59], v[224:227]
v_exp_f32 v137, v137
v_mfma_f32_16x16x32_bf16 v[124:127], a[164:167], v[60:63], v[124:127]
v_exp_f32 v138, v138
v_mfma_f32_16x16x32_bf16 v[124:127], a[168:171], v[64:67], v[124:127]
v_exp_f32 v139, v139
v_mfma_f32_16x16x32_bf16 v[124:127], a[172:175], v[68:71], v[124:127]
v_exp_f32 v104, v104
v_mfma_f32_16x16x32_bf16 v[108:111], a[172:175], v[52:55], v[108:111]
v_cvt_pk_bf16_f32 v200, v120, v121
v_cvt_pk_bf16_f32 v201, v122, v123
v_mfma_f32_16x16x32_bf16 v[108:111], a[168:171], v[48:51], v[108:111]
ds_read_b128 a[196:199], v2 offset:29696
v_cvt_pk_bf16_f32 v208, v136, v137
v_mfma_f32_16x16x32_bf16 v[108:111], a[164:167], v[44:47], v[108:111]
ds_read_b128 a[200:203], v2 offset:30720
v_cvt_pk_bf16_f32 v209, v138, v139
v_mfma_f32_16x16x32_bf16 v[108:111], a[160:163], v[40:43], v[108:111]
s_waitcnt lgkmcnt(2)
ds_read_b128 a[204:207], v2 offset:31744
v_mfma_f32_16x16x32_bf16 v[112:115], a[176:179], v[40:43], v[112:115]
v_exp_f32 v105, v105
v_mfma_f32_16x16x32_bf16 v[112:115], a[180:183], v[44:47], v[112:115]
v_exp_f32 v106, v106
v_mfma_f32_16x16x32_bf16 v[112:115], a[184:187], v[48:51], v[112:115]
s_branch L_po17
L_pg17:
s_branch L_pg21
L_po17:
v_exp_f32 v107, v107
v_mfma_f32_16x16x32_bf16 v[112:115], a[188:191], v[52:55], v[112:115]
s_add_u32 m0, s71, 4096
v_exp_f32 v140, v140
v_mfma_f32_16x16x32_bf16 v[128:131], a[188:191], v[68:71], v[224:227]
s_add_u32 s64, s70, 4096
v_exp_f32 v141, v141
v_mfma_f32_16x16x32_bf16 v[128:131], a[184:187], v[64:67], v[128:131]
buffer_load_dwordx4 v16, s[32:35], s64 offen offset:0 sc1 lds
v_mfma_f32_16x16x32_bf16 v[128:131], a[180:183], v[60:63], v[128:131]
v_exp_f32 v142, v142
v_mfma_f32_16x16x32_bf16 v[128:131], a[176:179], v[56:59], v[128:131]
v_exp_f32 v143, v143
v_mfma_f32_16x16x32_bf16 v[144:147], a[176:179], v[72:75], v[228:231]
ds_read_b128 a[144:147], v3 offset:16384
v_cvt_pk_bf16_f32 v176, v104, v105
v_mfma_f32_16x16x32_bf16 v[144:147], a[180:183], v[76:79], v[144:147]
ds_read_b128 a[148:151], v3 offset:24576
v_cvt_pk_bf16_f32 v177, v106, v107
v_mfma_f32_16x16x32_bf16 v[144:147], a[184:187], v[80:83], v[144:147]
v_exp_f32 v124, v124
v_mfma_f32_16x16x32_bf16 v[144:147], a[188:191], v[84:87], v[144:147]
s_waitcnt lgkmcnt(2)
v_exp_f32 v125, v125
v_mfma_f32_16x16x32_bf16 v[148:151], a[204:207], v[84:87], v[228:231]
v_exp_f32 v126, v126
v_mfma_f32_16x16x32_bf16 v[148:151], a[200:203], v[80:83], v[148:151]
v_exp_f32 v127, v127
v_mfma_f32_16x16x32_bf16 v[148:151], a[196:199], v[76:79], v[148:151]
ds_read_b128 a[152:155], v3 offset:17408
v_cvt_pk_bf16_f32 v210, v140, v141
v_mfma_f32_16x16x32_bf16 v[148:151], a[192:195], v[72:75], v[148:151]
ds_read_b128 a[156:159], v3 offset:25600
v_cvt_pk_bf16_f32 v211, v142, v143
v_mfma_f32_16x16x32_bf16 v[132:135], a[192:195], v[56:59], v[224:227]
v_exp_f32 v108, v108
v_mfma_f32_16x16x32_bf16 v[132:135], a[196:199], v[60:63], v[132:135]
v_exp_f32 v109, v109
v_mfma_f32_16x16x32_bf16 v[132:135], a[200:203], v[64:67], v[132:135]
buffer_load_dwordx4 v16, s[32:35], s64 offen offset:1024 sc1 lds
v_mfma_f32_16x16x32_bf16 v[132:135], a[204:207], v[68:71], v[132:135]
v_exp_f32 v110, v110
v_mfma_f32_16x16x32_bf16 v[116:119], a[204:207], v[52:55], v[116:119]
ds_read_b128 a[160:163], v3 offset:18432
v_cvt_pk_bf16_f32 v202, v124, v125
v_mfma_f32_16x16x32_bf16 v[116:119], a[200:203], v[48:51], v[116:119]
v_exp_f32 v111, v111
v_mfma_f32_16x16x32_bf16 v[116:119], a[196:199], v[44:47], v[116:119]
ds_read_b128 a[164:167], v3 offset:26624
v_cvt_pk_bf16_f32 v203, v126, v127
v_mfma_f32_16x16x32_bf16 v[116:119], a[192:195], v[40:43], v[116:119]
v_exp_f32 v112, v112
v_smfmac_f32_16x16x64_bf16 a[128:131], a[240:243], v[152:159], v5
ds_read_b128 a[168:171], v3 offset:19456
v_smfmac_f32_16x16x64_bf16 a[132:135], a[240:243], v[160:167], v5
ds_read_b128 a[172:175], v3 offset:27648
v_smfmac_f32_16x16x64_bf16 a[136:139], a[240:243], v[184:191], v5
ds_read_b128 a[176:179], v3 offset:20480
v_smfmac_f32_16x16x64_bf16 a[140:143], a[240:243], v[192:199], v5
s_waitcnt lgkmcnt(4)
ds_read_b128 a[180:183], v3 offset:28672
v_xor_b32 v2, 0x8000, v2
v_mfma_f32_16x16x32_bf16 a[0:3], a[144:147], v[152:155], a[0:3]
v_exp_f32 v113, v113
v_mfma_f32_16x16x32_bf16 a[0:3], a[148:151], v[156:159], a[0:3]
v_exp_f32 v114, v114
v_mfma_f32_16x16x32_bf16 a[32:35], a[148:151], v[164:167], a[32:35]
v_exp_f32 v115, v115
v_mfma_f32_16x16x32_bf16 a[32:35], a[144:147], v[160:163], a[32:35]
v_exp_f32 v128, v128
v_mfma_f32_16x16x32_bf16 a[64:67], a[144:147], v[184:187], a[64:67]
buffer_load_dwordx4 v16, s[32:35], s64 offen offset:2048 sc1 lds
v_mfma_f32_16x16x32_bf16 a[64:67], a[148:151], v[188:191], a[64:67]
v_exp_f32 v129, v129
v_mfma_f32_16x16x32_bf16 a[96:99], a[148:151], v[196:199], a[96:99]
v_exp_f32 v130, v130
v_mfma_f32_16x16x32_bf16 a[96:99], a[144:147], v[192:195], a[96:99]
v_exp_f32 v131, v131
v_mfma_f32_16x16x32_bf16 a[100:103], a[152:155], v[192:195], a[100:103]
v_exp_f32 v144, v144
v_mfma_f32_16x16x32_bf16 a[100:103], a[156:159], v[196:199], a[100:103]
v_exp_f32 v145, v145
v_mfma_f32_16x16x32_bf16 a[68:71], a[156:159], v[188:191], a[68:71]
ds_read_b128 a[184:187], v3 offset:21504
v_cvt_pk_bf16_f32 v178, v108, v109
v_mfma_f32_16x16x32_bf16 a[68:71], a[152:155], v[184:187], a[68:71]
ds_read_b128 a[188:191], v3 offset:29696
v_cvt_pk_bf16_f32 v179, v110, v111
v_mfma_f32_16x16x32_bf16 a[36:39], a[152:155], v[160:163], a[36:39]
ds_read_b128 a[192:195], v3 offset:22528
v_cvt_pk_bf16_f32 v180, v112, v113
v_mfma_f32_16x16x32_bf16 a[36:39], a[156:159], v[164:167], a[36:39]
v_exp_f32 v146, v146
v_mfma_f32_16x16x32_bf16 a[4:7], a[156:159], v[156:159], a[4:7]
v_exp_f32 v147, v147
v_mfma_f32_16x16x32_bf16 a[4:7], a[152:155], v[152:155], a[4:7]
v_exp_f32 v148, v148
v_mfma_f32_16x16x32_bf16 a[8:11], a[160:163], v[152:155], a[8:11]
s_waitcnt lgkmcnt(2)
ds_read_b128 a[196:199], v3 offset:30720
v_cvt_pk_bf16_f32 v181, v114, v115
v_mfma_f32_16x16x32_bf16 a[8:11], a[164:167], v[156:159], a[8:11]
buffer_load_dwordx4 v16, s[32:35], s64 offen offset:3072 sc1 lds
v_mfma_f32_16x16x32_bf16 a[40:43], a[164:167], v[164:167], a[40:43]
v_exp_f32 v149, v149
v_mfma_f32_16x16x32_bf16 a[40:43], a[160:163], v[160:163], a[40:43]
ds_read_b128 a[200:203], v3 offset:23552
v_cvt_pk_bf16_f32 v204, v128, v129
v_mfma_f32_16x16x32_bf16 a[72:75], a[160:163], v[184:187], a[72:75]
v_exp_f32 v150, v150
v_mfma_f32_16x16x32_bf16 a[72:75], a[164:167], v[188:191], a[72:75]
v_exp_f32 v151, v151
v_mfma_f32_16x16x32_bf16 a[104:107], a[164:167], v[196:199], a[104:107]
v_exp_f32 v132, v132
v_mfma_f32_16x16x32_bf16 a[104:107], a[160:163], v[192:195], a[104:107]
ds_read_b128 a[204:207], v3 offset:31744
v_cvt_pk_bf16_f32 v205, v130, v131
v_mfma_f32_16x16x32_bf16 a[108:111], a[168:171], v[192:195], a[108:111]
v_exp_f32 v133, v133
v_mfma_f32_16x16x32_bf16 a[108:111], a[172:175], v[196:199], a[108:111]
v_exp_f32 v134, v134
v_mfma_f32_16x16x32_bf16 a[76:79], a[172:175], v[188:191], a[76:79]
v_exp_f32 v135, v135
v_mfma_f32_16x16x32_bf16 a[76:79], a[168:171], v[184:187], a[76:79]
v_exp_f32 v116, v116
v_mfma_f32_16x16x32_bf16 a[44:47], a[168:171], v[160:163], a[44:47]
v_exp_f32 v117, v117
v_mfma_f32_16x16x32_bf16 a[44:47], a[172:175], v[164:167], a[44:47]
v_exp_f32 v118, v118
v_mfma_f32_16x16x32_bf16 a[12:15], a[172:175], v[156:159], a[12:15]
v_exp_f32 v119, v119
v_mfma_f32_16x16x32_bf16 a[12:15], a[168:171], v[152:155], a[12:15]
v_cvt_pk_bf16_f32 v212, v144, v145
v_cvt_pk_bf16_f32 v213, v146, v147
v_mfma_f32_16x16x32_bf16 a[16:19], a[176:179], v[152:155], a[16:19]
v_cvt_pk_bf16_f32 v214, v148, v149
v_cvt_pk_bf16_f32 v215, v150, v151
v_mfma_f32_16x16x32_bf16 a[16:19], a[180:183], v[156:159], a[16:19]
s_waitcnt vmcnt(12)
s_barrier
v_mfma_f32_16x16x32_bf16 a[48:51], a[180:183], v[164:167], a[48:51]
s_xor_b32 s71, s71, 49152
ds_read_b128 a[144:147], v2 offset:0
v_cvt_pk_bf16_f32 v206, v132, v133
v_mfma_f32_16x16x32_bf16 a[48:51], a[176:179], v[160:163], a[48:51]
s_add_u32 s70, s70, 32768
ds_read_b128 a[148:151], v2 offset:1024
v_cvt_pk_bf16_f32 v207, v134, v135
v_mfma_f32_16x16x32_bf16 a[80:83], a[176:179], v[184:187], a[80:83]
s_mov_b32 m0, s71
ds_read_b128 a[152:155], v2 offset:2048
v_cvt_pk_bf16_f32 v182, v116, v117
v_mfma_f32_16x16x32_bf16 a[80:83], a[180:183], v[188:191], a[80:83]
buffer_load_dwordx4 v16, s[32:35], s70 offen offset:0 sc1 lds
v_mfma_f32_16x16x32_bf16 a[112:115], a[180:183], v[196:199], a[112:115]
ds_read_b128 a[156:159], v2 offset:3072
v_cvt_pk_bf16_f32 v183, v118, v119
v_mfma_f32_16x16x32_bf16 a[112:115], a[176:179], v[192:195], a[112:115]
ds_read_b128 a[160:163], v2 offset:4096
v_xor_b32 v3, 0x8000, v3
v_mfma_f32_16x16x32_bf16 a[116:119], a[184:187], v[192:195], a[116:119]
s_waitcnt lgkmcnt(4)
ds_read_b128 a[164:167], v2 offset:5120
v_accvgpr_read_b32 v20, a128
v_mfma_f32_16x16x32_bf16 a[116:119], a[188:191], v[196:199], a[116:119]
ds_read_b128 a[168:171], v2 offset:6144
v_accvgpr_read_b32 v248, a129
v_mfma_f32_16x16x32_bf16 a[84:87], a[188:191], v[188:191], a[84:87]
ds_read_b128 a[172:175], v2 offset:7168
v_add_f32 v20, v20, v248
v_mfma_f32_16x16x32_bf16 a[84:87], a[184:187], v[184:187], a[84:87]
v_max_f32 v1, v1, v20
v_mfma_f32_16x16x32_bf16 a[52:55], a[184:187], v[160:163], a[52:55]
v_rcp_f32 v20, v20
v_mfma_f32_16x16x32_bf16 a[52:55], a[188:191], v[164:167], a[52:55]
v_accvgpr_read_b32 v232, a0
v_accvgpr_read_b32 v233, a1
v_mfma_f32_16x16x32_bf16 a[20:23], a[188:191], v[156:159], a[20:23]
v_accvgpr_read_b32 v234, a2
v_accvgpr_read_b32 v235, a3
v_mfma_f32_16x16x32_bf16 a[20:23], a[184:187], v[152:155], a[20:23]
v_accvgpr_read_b32 v236, a4
v_accvgpr_read_b32 v237, a5
v_mfma_f32_16x16x32_bf16 a[24:27], a[192:195], v[152:155], a[24:27]
v_accvgpr_read_b32 v238, a6
v_accvgpr_read_b32 v239, a7
v_mfma_f32_16x16x32_bf16 a[24:27], a[196:199], v[156:159], a[24:27]
v_mul_f32 v20, v20, v4
v_mul_f32 v232, v232, v20
v_mfma_f32_16x16x32_bf16 a[56:59], a[196:199], v[164:167], a[56:59]
buffer_load_dwordx4 v16, s[32:35], s70 offen offset:1024 sc1 lds
v_mfma_f32_16x16x32_bf16 a[56:59], a[192:195], v[160:163], a[56:59]
v_mul_f32 v233, v233, v20
v_mul_f32 v234, v234, v20
v_mfma_f32_16x16x32_bf16 a[88:91], a[192:195], v[184:187], a[88:91]
v_mul_f32 v235, v235, v20
v_mul_f32 v236, v236, v20
v_mfma_f32_16x16x32_bf16 a[88:91], a[196:199], v[188:191], a[88:91]
v_mul_f32 v237, v237, v20
v_mul_f32 v238, v238, v20
v_mfma_f32_16x16x32_bf16 a[120:123], a[196:199], v[196:199], a[120:123]
v_mul_f32 v239, v239, v20
v_cvt_pk_bf16_f32 v232, v232, v233
v_mfma_f32_16x16x32_bf16 a[120:123], a[192:195], v[192:195], a[120:123]
v_cvt_pk_bf16_f32 v233, v234, v235
v_cvt_pk_bf16_f32 v234, v236, v237
v_mfma_f32_16x16x32_bf16 a[124:127], a[200:203], v[192:195], a[124:127]
v_cvt_pk_bf16_f32 v235, v238, v239
v_mfma_f32_16x16x32_bf16 a[124:127], a[204:207], v[196:199], a[124:127]
s_add_u32 s77, s74, 0
buffer_store_dwordx4 v[232:235], v16, s[44:47], s77 offen sc1
v_mfma_f32_16x16x32_bf16 a[92:95], a[204:207], v[188:191], a[92:95]
v_accvgpr_read_b32 v240, a8
v_accvgpr_read_b32 v241, a9
v_mfma_f32_16x16x32_bf16 a[92:95], a[200:203], v[184:187], a[92:95]
v_accvgpr_read_b32 v242, a10
v_accvgpr_read_b32 v243, a11
v_mfma_f32_16x16x32_bf16 a[60:63], a[200:203], v[160:163], a[60:63]
v_accvgpr_read_b32 v244, a12
v_accvgpr_read_b32 v245, a13
v_mfma_f32_16x16x32_bf16 a[60:63], a[204:207], v[164:167], a[60:63]
v_accvgpr_read_b32 v246, a14
v_accvgpr_read_b32 v247, a15
v_mfma_f32_16x16x32_bf16 a[28:31], a[204:207], v[156:159], a[28:31]
v_mul_f32 v240, v240, v20
v_mul_f32 v241, v241, v20
v_mfma_f32_16x16x32_bf16 a[28:31], a[200:203], v[152:155], a[28:31]
v_mul_f32 v242, v242, v20
v_mul_f32 v243, v243, v20
v_mul_f32 v244, v244, v20
v_mul_f32 v245, v245, v20
v_mul_f32 v246, v246, v20
v_mul_f32 v247, v247, v20
v_cvt_pk_bf16_f32 v240, v240, v241
v_cvt_pk_bf16_f32 v241, v242, v243
v_cvt_pk_bf16_f32 v242, v244, v245
v_cvt_pk_bf16_f32 v243, v246, v247
s_add_u32 s77, s74, 8192
buffer_store_dwordx4 v[240:243], v16, s[44:47], s77 offen sc1
v_accvgpr_read_b32 v232, a16
v_accvgpr_read_b32 v233, a17
v_accvgpr_read_b32 v234, a18
v_accvgpr_read_b32 v235, a19
v_accvgpr_read_b32 v236, a20
v_accvgpr_read_b32 v237, a21
v_accvgpr_read_b32 v238, a22
v_accvgpr_read_b32 v239, a23
v_mul_f32 v232, v232, v20
v_mul_f32 v233, v233, v20
v_mul_f32 v234, v234, v20
v_mul_f32 v235, v235, v20
v_mul_f32 v236, v236, v20
v_mul_f32 v237, v237, v20
v_mul_f32 v238, v238, v20
v_mul_f32 v239, v239, v20
v_cvt_pk_bf16_f32 v232, v232, v233
v_cvt_pk_bf16_f32 v233, v234, v235
v_cvt_pk_bf16_f32 v234, v236, v237
v_cvt_pk_bf16_f32 v235, v238, v239
s_add_u32 s77, s74, 16384
buffer_store_dwordx4 v[232:235], v16, s[44:47], s77 offen sc1
s_cmp_eq_u32 s3, 7
s_cbranch_scc1 L_T1
L_T:
s_waitcnt lgkmcnt(7)
v_mfma_f32_16x16x32_bf16 v[120:123], a[144:147], v[56:59], v[224:227]
s_waitcnt lgkmcnt(6)
ds_read_b128 a[176:179], v2 offset:8192
v_mfma_f32_16x16x32_bf16 v[120:123], a[148:151], v[60:63], v[120:123]
s_waitcnt lgkmcnt(6)
ds_read_b128 a[180:183], v2 offset:9216
v_mfma_f32_16x16x32_bf16 v[120:123], a[152:155], v[64:67], v[120:123]
s_waitcnt lgkmcnt(6)
buffer_load_dwordx4 v16, s[32:35], s70 offen offset:2048 sc1 lds
v_mfma_f32_16x16x32_bf16 v[120:123], a[156:159], v[68:71], v[120:123]
ds_read_b128 a[184:187], v2 offset:10240
v_mfma_f32_16x16x32_bf16 v[136:139], a[156:159], v[84:87], v[228:231]
ds_read_b128 a[188:191], v2 offset:11264
v_mfma_f32_16x16x32_bf16 v[136:139], a[152:155], v[80:83], v[136:139]
ds_read_b128 a[192:195], v2 offset:12288
v_mfma_f32_16x16x32_bf16 v[136:139], a[148:151], v[76:79], v[136:139]
ds_read_b128 a[196:199], v2 offset:13312
v_mfma_f32_16x16x32_bf16 v[136:139], a[144:147], v[72:75], v[136:139]
s_waitcnt lgkmcnt(4)
v_mfma_f32_16x16x32_bf16 v[140:143], a[160:163], v[72:75], v[228:231]
ds_read_b128 a[200:203], v2 offset:14336
v_accvgpr_read_b32 v240, a24
v_mfma_f32_16x16x32_bf16 v[140:143], a[164:167], v[76:79], v[140:143]
ds_read_b128 a[204:207], v2 offset:15360
v_accvgpr_read_b32 v241, a25
v_mfma_f32_16x16x32_bf16 v[140:143], a[168:171], v[80:83], v[140:143]
v_exp_f32 v120, v120
v_mfma_f32_16x16x32_bf16 v[140:143], a[172:175], v[84:87], v[140:143]
v_exp_f32 v121, v121
v_mfma_f32_16x16x32_bf16 v[124:127], a[172:175], v[68:71], v[224:227]
v_exp_f32 v122, v122
v_mfma_f32_16x16x32_bf16 v[124:127], a[168:171], v[64:67], v[124:127]
buffer_load_dwordx4 v16, s[32:35], s70 offen offset:3072 sc1 lds
v_mfma_f32_16x16x32_bf16 v[124:127], a[164:167], v[60:63], v[124:127]
v_exp_f32 v123, v123
v_mfma_f32_16x16x32_bf16 v[124:127], a[160:163], v[56:59], v[124:127]
v_exp_f32 v136, v136
v_mfma_f32_16x16x32_bf16 v[128:131], a[176:179], v[56:59], v[224:227]
v_exp_f32 v137, v137
v_mfma_f32_16x16x32_bf16 v[128:131], a[180:183], v[60:63], v[128:131]
s_waitcnt lgkmcnt(0)
v_exp_f32 v138, v138
v_mfma_f32_16x16x32_bf16 v[128:131], a[184:187], v[64:67], v[128:131]
v_exp_f32 v139, v139
v_mfma_f32_16x16x32_bf16 v[128:131], a[188:191], v[68:71], v[128:131]
s_add_u32 m0, s71, 4096
ds_read_b128 a[144:147], v3 offset:0
v_cvt_pk_bf16_f32 v184, v120, v121
v_mfma_f32_16x16x32_bf16 v[144:147], a[188:191], v[84:87], v[228:231]
s_add_u32 s64, s70, 4096
ds_read_b128 a[148:151], v3 offset:8192
v_cvt_pk_bf16_f32 v185, v122, v123
v_mfma_f32_16x16x32_bf16 v[144:147], a[184:187], v[80:83], v[144:147]
buffer_load_dwordx4 v16, s[32:35], s64 offen offset:0 sc1 lds
v_mfma_f32_16x16x32_bf16 v[144:147], a[180:183], v[76:79], v[144:147]
v_exp_f32 v140, v140
v_mfma_f32_16x16x32_bf16 v[144:147], a[176:179], v[72:75], v[144:147]
v_exp_f32 v141, v141
v_mfma_f32_16x16x32_bf16 v[148:151], a[192:195], v[72:75], v[228:231]
v_exp_f32 v142, v142
v_mfma_f32_16x16x32_bf16 v[148:151], a[196:199], v[76:79], v[148:151]
ds_read_b128 a[152:155], v3 offset:1024
v_cvt_pk_bf16_f32 v192, v136, v137
v_mfma_f32_16x16x32_bf16 v[148:151], a[200:203], v[80:83], v[148:151]
ds_read_b128 a[156:159], v3 offset:9216
v_cvt_pk_bf16_f32 v193, v138, v139
v_mfma_f32_16x16x32_bf16 v[148:151], a[204:207], v[84:87], v[148:151]
v_exp_f32 v143, v143
v_mfma_f32_16x16x32_bf16 v[132:135], a[204:207], v[68:71], v[224:227]
v_exp_f32 v124, v124
v_mfma_f32_16x16x32_bf16 v[132:135], a[200:203], v[64:67], v[132:135]
v_exp_f32 v125, v125
v_mfma_f32_16x16x32_bf16 v[132:135], a[196:199], v[60:63], v[132:135]
buffer_load_dwordx4 v16, s[32:35], s64 offen offset:1024 sc1 lds
v_mfma_f32_16x16x32_bf16 v[132:135], a[192:195], v[56:59], v[132:135]
ds_read_b128 a[160:163], v3 offset:2048
v_cvt_pk_bf16_f32 v194, v140, v141
v_smfmac_f32_16x16x64_bf16 a[132:135], a[240:243], v[176:183], v5
ds_read_b128 a[164:167], v3 offset:10240
v_smfmac_f32_16x16x64_bf16 a[136:139], a[240:243], v[200:207], v5
ds_read_b128 a[168:171], v3 offset:3072
v_accvgpr_read_b32 v242, a26
v_smfmac_f32_16x16x64_bf16 a[140:143], a[240:243], v[208:215], v5
s_waitcnt lgkmcnt(3)
ds_read_b128 a[172:175], v3 offset:11264
v_accvgpr_read_b32 v243, a27
v_mfma_f32_16x16x32_bf16 a[32:35], a[144:147], v[176:179], a[32:35]
ds_read_b128 a[176:179], v3 offset:4096
v_accvgpr_read_b32 v244, a28
v_mfma_f32_16x16x32_bf16 a[32:35], a[148:151], v[180:183], a[32:35]
ds_read_b128 a[180:183], v3 offset:12288
v_accvgpr_read_b32 v245, a29
v_mfma_f32_16x16x32_bf16 a[64:67], a[148:151], v[204:207], a[64:67]
ds_read_b128 a[184:187], v3 offset:5120
v_accvgpr_read_b32 v246, a30
v_mfma_f32_16x16x32_bf16 a[64:67], a[144:147], v[200:203], a[64:67]
ds_read_b128 a[188:191], v3 offset:13312
v_accvgpr_read_b32 v247, a31
v_mfma_f32_16x16x32_bf16 a[96:99], a[144:147], v[208:211], a[96:99]
ds_read_b128 a[192:195], v3 offset:6144
v_mul_f32 v240, v240, v20
v_mfma_f32_16x16x32_bf16 a[96:99], a[148:151], v[212:215], a[96:99]
ds_read_b128 a[196:199], v3 offset:14336
v_mul_f32 v241, v241, v20
v_mfma_f32_16x16x32_bf16 a[100:103], a[156:159], v[212:215], a[100:103]
ds_read_b128 a[200:203], v3 offset:7168
v_mul_f32 v242, v242, v20
v_mfma_f32_16x16x32_bf16 a[100:103], a[152:155], v[208:211], a[100:103]
ds_read_b128 a[204:207], v3 offset:15360
v_mul_f32 v243, v243, v20
v_mul_f32 v244, v244, v20
v_mul_f32 v245, v245, v20
v_mul_f32 v246, v246, v20
v_mul_f32 v247, v247, v20
v_cvt_pk_bf16_f32 v240, v240, v241
v_cvt_pk_bf16_f32 v241, v242, v243
v_cvt_pk_bf16_f32 v242, v244, v245
v_cvt_pk_bf16_f32 v243, v246, v247
s_add_u32 s77, s74, 24576
buffer_store_dwordx4 v[240:243], v16, s[44:47], s77 offen sc1
v_exp_f32 v126, v126
v_mfma_f32_16x16x32_bf16 a[68:71], a[152:155], v[200:203], a[68:71]
buffer_load_dwordx4 v16, s[32:35], s64 offen offset:2048 sc1 lds
v_cvt_pk_bf16_f32 v195, v142, v143
v_mfma_f32_16x16x32_bf16 a[68:71], a[156:159], v[204:207], a[68:71]
v_exp_f32 v127, v127
v_mfma_f32_16x16x32_bf16 a[36:39], a[156:159], v[180:183], a[36:39]
v_exp_f32 v128, v128
v_mfma_f32_16x16x32_bf16 a[36:39], a[152:155], v[176:179], a[36:39]
s_waitcnt lgkmcnt(2)
v_exp_f32 v129, v129
v_mfma_f32_16x16x32_bf16 a[40:43], a[160:163], v[176:179], a[40:43]
v_cvt_pk_bf16_f32 v186, v124, v125
v_cvt_pk_bf16_f32 v187, v126, v127
v_mfma_f32_16x16x32_bf16 a[40:43], a[164:167], v[180:183], a[40:43]
v_exp_f32 v130, v130
v_mfma_f32_16x16x32_bf16 a[72:75], a[164:167], v[204:207], a[72:75]
buffer_load_dwordx4 v16, s[32:35], s64 offen offset:3072 sc1 lds
v_mfma_f32_16x16x32_bf16 a[72:75], a[160:163], v[200:203], a[72:75]
v_exp_f32 v131, v131
v_mfma_f32_16x16x32_bf16 a[104:107], a[160:163], v[208:211], a[104:107]
v_exp_f32 v144, v144
v_mfma_f32_16x16x32_bf16 a[104:107], a[164:167], v[212:215], a[104:107]
v_exp_f32 v145, v145
v_mfma_f32_16x16x32_bf16 a[108:111], a[172:175], v[212:215], a[108:111]
v_exp_f32 v146, v146
v_mfma_f32_16x16x32_bf16 a[108:111], a[168:171], v[208:211], a[108:111]
v_exp_f32 v147, v147
v_mfma_f32_16x16x32_bf16 a[76:79], a[168:171], v[200:203], a[76:79]
v_exp_f32 v148, v148
v_mfma_f32_16x16x32_bf16 a[76:79], a[172:175], v[204:207], a[76:79]
v_exp_f32 v149, v149
v_mfma_f32_16x16x32_bf16 a[44:47], a[172:175], v[180:183], a[44:47]
v_cvt_pk_bf16_f32 v188, v128, v129
v_cvt_pk_bf16_f32 v189, v130, v131
v_mfma_f32_16x16x32_bf16 a[44:47], a[168:171], v[176:179], a[44:47]
v_exp_f32 v150, v150
v_mfma_f32_16x16x32_bf16 a[48:51], a[176:179], v[176:179], a[48:51]
v_exp_f32 v151, v151
v_mfma_f32_16x16x32_bf16 a[48:51], a[180:183], v[180:183], a[48:51]
v_exp_f32 v132, v132
v_mfma_f32_16x16x32_bf16 a[80:83], a[180:183], v[204:207], a[80:83]
s_waitcnt vmcnt(9)
s_barrier
v_mfma_f32_16x16x32_bf16 a[80:83], a[176:179], v[200:203], a[80:83]
s_xor_b32 s71, s71, 16384
v_exp_f32 v133, v133
v_mfma_f32_16x16x32_bf16 a[112:115], a[176:179], v[208:211], a[112:115]
s_add_u32 s70, s70, 32768
ds_read_b128 a[144:147], v2 offset:16384
v_cvt_pk_bf16_f32 v196, v144, v145
v_mfma_f32_16x16x32_bf16 a[112:115], a[180:183], v[212:215], a[112:115]
s_mov_b32 m0, s71
v_exp_f32 v134, v134
v_mfma_f32_16x16x32_bf16 a[116:119], a[188:191], v[212:215], a[116:119]
buffer_load_dwordx4 v16, s[32:35], s70 offen offset:0 sc1 lds
v_mfma_f32_16x16x32_bf16 a[116:119], a[184:187], v[208:211], a[116:119]
ds_read_b128 a[148:151], v2 offset:17408
v_cvt_pk_bf16_f32 v197, v146, v147
v_mfma_f32_16x16x32_bf16 a[84:87], a[184:187], v[200:203], a[84:87]
ds_read_b128 a[152:155], v2 offset:18432
v_cvt_pk_bf16_f32 v198, v148, v149
v_mfma_f32_16x16x32_bf16 a[84:87], a[188:191], v[204:207], a[84:87]
ds_read_b128 a[156:159], v2 offset:19456
v_cvt_pk_bf16_f32 v199, v150, v151
v_mfma_f32_16x16x32_bf16 a[52:55], a[188:191], v[180:183], a[52:55]
v_exp_f32 v135, v135
v_mfma_f32_16x16x32_bf16 a[52:55], a[184:187], v[176:179], a[52:55]
ds_read_b128 a[160:163], v2 offset:20480
v_cvt_pk_bf16_f32 v190, v132, v133
v_mfma_f32_16x16x32_bf16 a[56:59], a[192:195], v[176:179], a[56:59]
ds_read_b128 a[164:167], v2 offset:21504
v_cvt_pk_bf16_f32 v191, v134, v135
v_mfma_f32_16x16x32_bf16 a[56:59], a[196:199], v[180:183], a[56:59]
ds_read_b128 a[168:171], v2 offset:22528
v_accvgpr_read_b32 v21, a132
v_mfma_f32_16x16x32_bf16 a[88:91], a[196:199], v[204:207], a[88:91]
ds_read_b128 a[172:175], v2 offset:23552
v_accvgpr_read_b32 v248, a133
v_mfma_f32_16x16x32_bf16 a[88:91], a[192:195], v[200:203], a[88:91]
buffer_load_dwordx4 v16, s[32:35], s70 offen offset:1024 sc1 lds
v_mfma_f32_16x16x32_bf16 a[120:123], a[192:195], v[208:211], a[120:123]
v_add_f32 v21, v21, v248
v_max_f32 v1, v1, v21
v_mfma_f32_16x16x32_bf16 a[120:123], a[196:199], v[212:215], a[120:123]
s_waitcnt lgkmcnt(3)
v_rcp_f32 v21, v21
v_mfma_f32_16x16x32_bf16 a[124:127], a[204:207], v[212:215], a[124:127]
v_accvgpr_read_b32 v232, a32
v_accvgpr_read_b32 v233, a33
v_mfma_f32_16x16x32_bf16 a[124:127], a[200:203], v[208:211], a[124:127]
v_accvgpr_read_b32 v234, a34
v_accvgpr_read_b32 v235, a35
v_mfma_f32_16x16x32_bf16 a[92:95], a[200:203], v[200:203], a[92:95]
v_accvgpr_read_b32 v236, a36
v_accvgpr_read_b32 v237, a37
v_mfma_f32_16x16x32_bf16 a[92:95], a[204:207], v[204:207], a[92:95]
v_accvgpr_read_b32 v238, a38
v_accvgpr_read_b32 v239, a39
v_mfma_f32_16x16x32_bf16 a[60:63], a[204:207], v[180:183], a[60:63]
v_mul_f32 v21, v21, v6
v_mul_f32 v232, v232, v21
v_mfma_f32_16x16x32_bf16 a[60:63], a[200:203], v[176:179], a[60:63]
v_mul_f32 v233, v233, v21
v_mul_f32 v234, v234, v21
v_mfma_f32_16x16x32_bf16 v[120:123], a[144:147], v[56:59], v[224:227]
ds_read_b128 a[176:179], v2 offset:24576
ds_read_b128 a[180:183], v2 offset:25600
v_mfma_f32_16x16x32_bf16 v[120:123], a[148:151], v[60:63], v[120:123]
buffer_load_dwordx4 v16, s[32:35], s70 offen offset:2048 sc1 lds
v_mfma_f32_16x16x32_bf16 v[120:123], a[152:155], v[64:67], v[120:123]
s_add_u32 s64, s70, 4096
ds_read_b128 a[184:187], v2 offset:26624
ds_read_b128 a[188:191], v2 offset:27648
v_mfma_f32_16x16x32_bf16 v[120:123], a[156:159], v[68:71], v[120:123]
buffer_load_dwordx4 v16, s[32:35], s70 offen offset:3072 sc1 lds
v_mfma_f32_16x16x32_bf16 v[136:139], a[156:159], v[84:87], v[228:231]
s_add_u32 m0, s71, 4096
ds_read_b128 a[192:195], v2 offset:28672
ds_read_b128 a[196:199], v2 offset:29696
v_mfma_f32_16x16x32_bf16 v[136:139], a[152:155], v[80:83], v[136:139]
buffer_load_dwordx4 v16, s[32:35], s64 offen offset:0 sc1 lds
v_mfma_f32_16x16x32_bf16 v[136:139], a[148:151], v[76:79], v[136:139]
ds_read_b128 a[200:203], v2 offset:30720
ds_read_b128 a[204:207], v2 offset:31744
v_mfma_f32_16x16x32_bf16 v[136:139], a[144:147], v[72:75], v[136:139]
v_exp_f32 v120, v120
v_mfma_f32_16x16x32_bf16 v[140:143], a[160:163], v[72:75], v[228:231]
s_waitcnt lgkmcnt(4)
v_exp_f32 v121, v121
v_mfma_f32_16x16x32_bf16 v[140:143], a[164:167], v[76:79], v[140:143]
v_exp_f32 v122, v122
v_mfma_f32_16x16x32_bf16 v[140:143], a[168:171], v[80:83], v[140:143]
v_mul_f32 v235, v235, v21
v_mul_f32 v236, v236, v21
v_mul_f32 v237, v237, v21
v_mul_f32 v238, v238, v21
v_mul_f32 v239, v239, v21
v_cvt_pk_bf16_f32 v232, v232, v233
v_cvt_pk_bf16_f32 v233, v234, v235
v_cvt_pk_bf16_f32 v234, v236, v237
v_cvt_pk_bf16_f32 v235, v238, v239
s_add_u32 s77, s74, 4096
buffer_store_dwordx4 v[232:235], v16, s[44:47], s77 offen sc1
v_accvgpr_read_b32 v240, a40
v_accvgpr_read_b32 v241, a41
v_accvgpr_read_b32 v242, a42
v_accvgpr_read_b32 v243, a43
v_accvgpr_read_b32 v244, a44
v_accvgpr_read_b32 v245, a45
v_accvgpr_read_b32 v246, a46
v_accvgpr_read_b32 v247, a47
v_mul_f32 v240, v240, v21
v_mul_f32 v241, v241, v21
v_mul_f32 v242, v242, v21
v_mul_f32 v243, v243, v21
v_mul_f32 v244, v244, v21
v_mul_f32 v245, v245, v21
v_mul_f32 v246, v246, v21
v_mul_f32 v247, v247, v21
v_cvt_pk_bf16_f32 v240, v240, v241
v_cvt_pk_bf16_f32 v241, v242, v243
v_cvt_pk_bf16_f32 v242, v244, v245
v_cvt_pk_bf16_f32 v243, v246, v247
s_add_u32 s77, s74, 12288
buffer_store_dwordx4 v[240:243], v16, s[44:47], s77 offen sc1
v_accvgpr_read_b32 v232, a48
v_accvgpr_read_b32 v233, a49
v_accvgpr_read_b32 v234, a50
v_accvgpr_read_b32 v235, a51
v_accvgpr_read_b32 v236, a52
v_accvgpr_read_b32 v237, a53
v_accvgpr_read_b32 v238, a54
v_accvgpr_read_b32 v239, a55
v_mul_f32 v232, v232, v21
v_mul_f32 v233, v233, v21
v_mul_f32 v234, v234, v21
v_mul_f32 v235, v235, v21
v_mul_f32 v236, v236, v21
v_mul_f32 v237, v237, v21
v_mul_f32 v238, v238, v21
v_mul_f32 v239, v239, v21
v_cvt_pk_bf16_f32 v232, v232, v233
v_cvt_pk_bf16_f32 v233, v234, v235
v_cvt_pk_bf16_f32 v234, v236, v237
v_cvt_pk_bf16_f32 v235, v238, v239
s_add_u32 s77, s74, 20480
buffer_store_dwordx4 v[232:235], v16, s[44:47], s77 offen sc1
v_accvgpr_read_b32 v240, a56
v_accvgpr_read_b32 v241, a57
v_accvgpr_read_b32 v242, a58
v_accvgpr_read_b32 v243, a59
v_accvgpr_read_b32 v244, a60
v_accvgpr_read_b32 v245, a61
v_accvgpr_read_b32 v246, a62
v_accvgpr_read_b32 v247, a63
v_mul_f32 v240, v240, v21
v_mul_f32 v241, v241, v21
v_mul_f32 v242, v242, v21
v_mul_f32 v243, v243, v21
v_mul_f32 v244, v244, v21
v_mul_f32 v245, v245, v21
v_mul_f32 v246, v246, v21
v_mul_f32 v247, v247, v21
v_cvt_pk_bf16_f32 v240, v240, v241
v_cvt_pk_bf16_f32 v241, v242, v243
v_cvt_pk_bf16_f32 v242, v244, v245
v_cvt_pk_bf16_f32 v243, v246, v247
s_add_u32 s77, s74, 28672
buffer_store_dwordx4 v[240:243], v16, s[44:47], s77 offen sc1
v_exp_f32 v123, v123
v_mfma_f32_16x16x32_bf16 v[140:143], a[172:175], v[84:87], v[140:143]
s_branch L_po18
L_pg18:
s_branch L_pg22
L_po18:
v_exp_f32 v136, v136
v_mfma_f32_16x16x32_bf16 v[124:127], a[172:175], v[68:71], v[224:227]
ds_read_b128 a[144:147], v3 offset:16384
v_cvt_pk_bf16_f32 v200, v120, v121
v_mfma_f32_16x16x32_bf16 v[124:127], a[168:171], v[64:67], v[124:127]
v_exp_f32 v137, v137
v_mfma_f32_16x16x32_bf16 v[124:127], a[164:167], v[60:63], v[124:127]
ds_read_b128 a[148:151], v3 offset:24576
v_cvt_pk_bf16_f32 v201, v122, v123
v_mfma_f32_16x16x32_bf16 v[124:127], a[160:163], v[56:59], v[124:127]
v_exp_f32 v138, v138
v_mfma_f32_16x16x32_bf16 v[128:131], a[176:179], v[56:59], v[224:227]
ds_read_b128 a[152:155], v3 offset:17408
v_cvt_pk_bf16_f32 v208, v136, v137
v_mfma_f32_16x16x32_bf16 v[128:131], a[180:183], v[60:63], v[128:131]
v_exp_f32 v139, v139
v_mfma_f32_16x16x32_bf16 v[128:131], a[184:187], v[64:67], v[128:131]
ds_read_b128 a[156:159], v3 offset:25600
v_cvt_pk_bf16_f32 v209, v138, v139
v_mfma_f32_16x16x32_bf16 v[128:131], a[188:191], v[68:71], v[128:131]
v_exp_f32 v140, v140
v_mfma_f32_16x16x32_bf16 v[144:147], a[188:191], v[84:87], v[228:231]
buffer_load_dwordx4 v16, s[32:35], s64 offen offset:1024 sc1 lds
v_mfma_f32_16x16x32_bf16 v[144:147], a[184:187], v[80:83], v[144:147]
v_exp_f32 v141, v141
v_mfma_f32_16x16x32_bf16 v[144:147], a[180:183], v[76:79], v[144:147]
ds_read_b128 a[160:163], v3 offset:18432
v_cvt_pk_bf16_f32 v210, v140, v141
v_mfma_f32_16x16x32_bf16 v[144:147], a[176:179], v[72:75], v[144:147]
s_waitcnt lgkmcnt(2)
v_exp_f32 v142, v142
v_mfma_f32_16x16x32_bf16 v[148:151], a[192:195], v[72:75], v[228:231]
ds_read_b128 a[164:167], v3 offset:26624
ds_read_b128 a[168:171], v3 offset:19456
v_mfma_f32_16x16x32_bf16 v[148:151], a[196:199], v[76:79], v[148:151]
v_exp_f32 v143, v143
v_mfma_f32_16x16x32_bf16 v[148:151], a[200:203], v[80:83], v[148:151]
ds_read_b128 a[172:175], v3 offset:27648
v_cvt_pk_bf16_f32 v211, v142, v143
v_mfma_f32_16x16x32_bf16 v[148:151], a[204:207], v[84:87], v[148:151]
v_exp_f32 v124, v124
v_mfma_f32_16x16x32_bf16 v[132:135], a[204:207], v[68:71], v[224:227]
ds_read_b128 a[176:179], v3 offset:20480
buffer_load_dwordx4 v16, s[32:35], s64 offen offset:2048 sc1 lds
v_mfma_f32_16x16x32_bf16 v[132:135], a[200:203], v[64:67], v[132:135]
v_exp_f32 v125, v125
v_mfma_f32_16x16x32_bf16 v[132:135], a[196:199], v[60:63], v[132:135]
ds_read_b128 a[180:183], v3 offset:28672
v_cvt_pk_bf16_f32 v202, v124, v125
v_mfma_f32_16x16x32_bf16 v[132:135], a[192:195], v[56:59], v[132:135]
v_exp_f32 v126, v126
v_smfmac_f32_16x16x64_bf16 a[136:139], a[240:243], v[184:191], v5
ds_read_b128 a[184:187], v3 offset:21504
v_smfmac_f32_16x16x64_bf16 a[140:143], a[240:243], v[192:199], v5
ds_read_b128 a[188:191], v3 offset:29696
v_mfma_f32_16x16x32_bf16 a[64:67], a[144:147], v[184:187], a[64:67]
v_exp_f32 v127, v127
v_mfma_f32_16x16x32_bf16 a[64:67], a[148:151], v[188:191], a[64:67]
v_exp_f32 v128, v128
v_mfma_f32_16x16x32_bf16 a[96:99], a[148:151], v[196:199], a[96:99]
v_exp_f32 v129, v129
v_mfma_f32_16x16x32_bf16 a[96:99], a[144:147], v[192:195], a[96:99]
ds_read_b128 a[192:195], v3 offset:22528
v_cvt_pk_bf16_f32 v203, v126, v127
v_mfma_f32_16x16x32_bf16 a[100:103], a[152:155], v[192:195], a[100:103]
s_waitcnt lgkmcnt(2)
v_exp_f32 v130, v130
v_mfma_f32_16x16x32_bf16 a[100:103], a[156:159], v[196:199], a[100:103]
ds_read_b128 a[196:199], v3 offset:30720
v_cvt_pk_bf16_f32 v204, v128, v129
v_mfma_f32_16x16x32_bf16 a[68:71], a[156:159], v[188:191], a[68:71]
v_exp_f32 v131, v131
v_mfma_f32_16x16x32_bf16 a[68:71], a[152:155], v[184:187], a[68:71]
ds_read_b128 a[200:203], v3 offset:23552
v_cvt_pk_bf16_f32 v205, v130, v131
v_mfma_f32_16x16x32_bf16 a[72:75], a[160:163], v[184:187], a[72:75]
v_exp_f32 v144, v144
v_mfma_f32_16x16x32_bf16 a[72:75], a[164:167], v[188:191], a[72:75]
buffer_load_dwordx4 v16, s[32:35], s64 offen offset:3072 sc1 lds
v_mfma_f32_16x16x32_bf16 a[104:107], a[164:167], v[196:199], a[104:107]
s_xor_b32 s71, s71, 49152
v_exp_f32 v145, v145
v_mfma_f32_16x16x32_bf16 a[104:107], a[160:163], v[192:195], a[104:107]
ds_read_b128 a[204:207], v3 offset:31744
v_cvt_pk_bf16_f32 v212, v144, v145
v_mfma_f32_16x16x32_bf16 a[108:111], a[168:171], v[192:195], a[108:111]
s_add_u32 s70, s70, 32768
v_xor_b32 v2, 0x8000, v2
v_exp_f32 v146, v146
v_mfma_f32_16x16x32_bf16 a[108:111], a[172:175], v[196:199], a[108:111]
s_waitcnt vmcnt(12)
s_barrier
v_mfma_f32_16x16x32_bf16 a[76:79], a[172:175], v[188:191], a[76:79]
s_mov_b32 m0, s71
v_exp_f32 v147, v147
v_mfma_f32_16x16x32_bf16 a[76:79], a[168:171], v[184:187], a[76:79]
ds_read_b128 a[144:147], v2 offset:0
v_cvt_pk_bf16_f32 v213, v146, v147
v_mfma_f32_16x16x32_bf16 a[80:83], a[176:179], v[184:187], a[80:83]
v_exp_f32 v148, v148
v_mfma_f32_16x16x32_bf16 a[80:83], a[180:183], v[188:191], a[80:83]
ds_read_b128 a[148:151], v2 offset:1024
ds_read_b128 a[152:155], v2 offset:2048
v_mfma_f32_16x16x32_bf16 a[112:115], a[180:183], v[196:199], a[112:115]
v_exp_f32 v149, v149
v_mfma_f32_16x16x32_bf16 a[112:115], a[176:179], v[192:195], a[112:115]
ds_read_b128 a[156:159], v2 offset:3072
v_cvt_pk_bf16_f32 v214, v148, v149
v_mfma_f32_16x16x32_bf16 a[116:119], a[184:187], v[192:195], a[116:119]
s_waitcnt lgkmcnt(4)
v_exp_f32 v150, v150
v_mfma_f32_16x16x32_bf16 a[116:119], a[188:191], v[196:199], a[116:119]
buffer_load_dwordx4 v16, s[32:35], s70 offen offset:0 sc1 lds
v_mfma_f32_16x16x32_bf16 a[84:87], a[188:191], v[188:191], a[84:87]
v_exp_f32 v151, v151
v_mfma_f32_16x16x32_bf16 a[84:87], a[184:187], v[184:187], a[84:87]
ds_read_b128 a[160:163], v2 offset:4096
v_cvt_pk_bf16_f32 v215, v150, v151
v_mfma_f32_16x16x32_bf16 a[88:91], a[192:195], v[184:187], a[88:91]
v_exp_f32 v132, v132
v_mfma_f32_16x16x32_bf16 a[88:91], a[196:199], v[188:191], a[88:91]
ds_read_b128 a[164:167], v2 offset:5120
v_xor_b32 v3, 0x8000, v3
v_mfma_f32_16x16x32_bf16 a[120:123], a[196:199], v[196:199], a[120:123]
v_exp_f32 v133, v133
v_mfma_f32_16x16x32_bf16 a[120:123], a[192:195], v[192:195], a[120:123]
ds_read_b128 a[168:171], v2 offset:6144
v_cvt_pk_bf16_f32 v206, v132, v133
v_mfma_f32_16x16x32_bf16 a[124:127], a[200:203], v[192:195], a[124:127]
v_exp_f32 v134, v134
v_mfma_f32_16x16x32_bf16 a[124:127], a[204:207], v[196:199], a[124:127]
buffer_load_dwordx4 v16, s[32:35], s70 offen offset:1024 sc1 lds
v_mfma_f32_16x16x32_bf16 a[92:95], a[204:207], v[188:191], a[92:95]
v_exp_f32 v135, v135
v_mfma_f32_16x16x32_bf16 a[92:95], a[200:203], v[184:187], a[92:95]
ds_read_b128 a[172:175], v2 offset:7168
v_cvt_pk_bf16_f32 v207, v134, v135
s_lshl_b32 s72, s3, 1
s_sub_u32 s72, 13, s72
L_S:
s_waitcnt lgkmcnt(7)
v_mfma_f32_16x16x32_bf16 v[120:123], a[144:147], v[56:59], v[224:227]
s_waitcnt lgkmcnt(6)
ds_read_b128 a[176:179], v2 offset:8192
ds_read_b128 a[180:183], v2 offset:9216
v_mfma_f32_16x16x32_bf16 v[120:123], a[148:151], v[60:63], v[120:123]
s_waitcnt lgkmcnt(7)
buffer_load_dwordx4 v16, s[32:35], s70 offen offset:2048 sc1 lds
v_mfma_f32_16x16x32_bf16 v[120:123], a[152:155], v[64:67], v[120:123]
s_waitcnt lgkmcnt(6)
s_add_u32 s64, s70, 4096
ds_read_b128 a[184:187], v2 offset:10240
ds_read_b128 a[188:191], v2 offset:11264
v_mfma_f32_16x16x32_bf16 v[120:123], a[156:159], v[68:71], v[120:123]
buffer_load_dwordx4 v16, s[32:35], s70 offen offset:3072 sc1 lds
v_mfma_f32_16x16x32_bf16 v[136:139], a[156:159], v[84:87], v[228:231]
s_add_u32 m0, s71, 4096
ds_read_b128 a[192:195], v2 offset:12288
ds_read_b128 a[196:199], v2 offset:13312
v_mfma_f32_16x16x32_bf16 v[136:139], a[152:155], v[80:83], v[136:139]
buffer_load_dwordx4 v16, s[32:35], s64 offen offset:0 sc1 lds
v_mfma_f32_16x16x32_bf16 v[136:139], a[148:151], v[76:79], v[136:139]
ds_read_b128 a[200:203], v2 offset:14336
ds_read_b128 a[204:207], v2 offset:15360
v_mfma_f32_16x16x32_bf16 v[136:139], a[144:147], v[72:75], v[136:139]
s_waitcnt lgkmcnt(6)
v_exp_f32 v120, v120
v_mfma_f32_16x16x32_bf16 v[140:143], a[160:163], v[72:75], v[228:231]
v_exp_f32 v121, v121
v_mfma_f32_16x16x32_bf16 v[140:143], a[164:167], v[76:79], v[140:143]
v_exp_f32 v122, v122
v_mfma_f32_16x16x32_bf16 v[140:143], a[168:171], v[80:83], v[140:143]
v_exp_f32 v123, v123
v_mfma_f32_16x16x32_bf16 v[140:143], a[172:175], v[84:87], v[140:143]
v_exp_f32 v136, v136
v_mfma_f32_16x16x32_bf16 v[124:127], a[172:175], v[68:71], v[224:227]
ds_read_b128 a[144:147], v3 offset:0
v_cvt_pk_bf16_f32 v184, v120, v121
v_mfma_f32_16x16x32_bf16 v[124:127], a[168:171], v[64:67], v[124:127]
v_exp_f32 v137, v137
v_mfma_f32_16x16x32_bf16 v[124:127], a[164:167], v[60:63], v[124:127]
ds_read_b128 a[148:151], v3 offset:8192
v_cvt_pk_bf16_f32 v185, v122, v123
v_mfma_f32_16x16x32_bf16 v[124:127], a[160:163], v[56:59], v[124:127]
v_exp_f32 v138, v138
v_mfma_f32_16x16x32_bf16 v[128:131], a[176:179], v[56:59], v[224:227]
ds_read_b128 a[152:155], v3 offset:1024
v_cvt_pk_bf16_f32 v192, v136, v137
v_mfma_f32_16x16x32_bf16 v[128:131], a[180:183], v[60:63], v[128:131]
s_waitcnt lgkmcnt(3)
v_exp_f32 v139, v139
v_mfma_f32_16x16x32_bf16 v[128:131], a[184:187], v[64:67], v[128:131]
ds_read_b128 a[156:159], v3 offset:9216
v_cvt_pk_bf16_f32 v193, v138, v139
v_mfma_f32_16x16x32_bf16 v[128:131], a[188:191], v[68:71], v[128:131]
v_exp_f32 v140, v140
v_mfma_f32_16x16x32_bf16 v[144:147], a[188:191], v[84:87], v[228:231]
buffer_load_dwordx4 v16, s[32:35], s64 offen offset:1024 sc1 lds
v_mfma_f32_16x16x32_bf16 v[144:147], a[184:187], v[80:83], v[144:147]
v_exp_f32 v141, v141
v_mfma_f32_16x16x32_bf16 v[144:147], a[180:183], v[76:79], v[144:147]
ds_read_b128 a[160:163], v3 offset:2048
v_cvt_pk_bf16_f32 v194, v140, v141
v_mfma_f32_16x16x32_bf16 v[144:147], a[176:179], v[72:75], v[144:147]
v_exp_f32 v142, v142
v_mfma_f32_16x16x32_bf16 v[148:151], a[192:195], v[72:75], v[228:231]
ds_read_b128 a[164:167], v3 offset:10240
ds_read_b128 a[168:171], v3 offset:3072
v_mfma_f32_16x16x32_bf16 v[148:151], a[196:199], v[76:79], v[148:151]
v_exp_f32 v143, v143
v_mfma_f32_16x16x32_bf16 v[148:151], a[200:203], v[80:83], v[148:151]
ds_read_b128 a[172:175], v3 offset:11264
v_cvt_pk_bf16_f32 v195, v142, v143
v_mfma_f32_16x16x32_bf16 v[148:151], a[204:207], v[84:87], v[148:151]
v_exp_f32 v124, v124
v_mfma_f32_16x16x32_bf16 v[132:135], a[204:207], v[68:71], v[224:227]
ds_read_b128 a[176:179], v3 offset:4096
buffer_load_dwordx4 v16, s[32:35], s64 offen offset:2048 sc1 lds
v_mfma_f32_16x16x32_bf16 v[132:135], a[200:203], v[64:67], v[132:135]
v_exp_f32 v125, v125
v_mfma_f32_16x16x32_bf16 v[132:135], a[196:199], v[60:63], v[132:135]
ds_read_b128 a[180:183], v3 offset:12288
v_cvt_pk_bf16_f32 v186, v124, v125
v_mfma_f32_16x16x32_bf16 v[132:135], a[192:195], v[56:59], v[132:135]
v_exp_f32 v126, v126
v_smfmac_f32_16x16x64_bf16 a[136:139], a[240:243], v[200:207], v5
ds_read_b128 a[184:187], v3 offset:5120
v_smfmac_f32_16x16x64_bf16 a[140:143], a[240:243], v[208:215], v5
s_waitcnt lgkmcnt(3)
ds_read_b128 a[188:191], v3 offset:13312
v_mfma_f32_16x16x32_bf16 a[64:67], a[144:147], v[200:203], a[64:67]
v_exp_f32 v127, v127
v_mfma_f32_16x16x32_bf16 a[64:67], a[148:151], v[204:207], a[64:67]
v_exp_f32 v128, v128
v_mfma_f32_16x16x32_bf16 a[96:99], a[148:151], v[212:215], a[96:99]
v_exp_f32 v129, v129
v_mfma_f32_16x16x32_bf16 a[96:99], a[144:147], v[208:211], a[96:99]
ds_read_b128 a[192:195], v3 offset:6144
v_cvt_pk_bf16_f32 v187, v126, v127
v_mfma_f32_16x16x32_bf16 a[100:103], a[152:155], v[208:211], a[100:103]
v_exp_f32 v130, v130
v_mfma_f32_16x16x32_bf16 a[100:103], a[156:159], v[212:215], a[100:103]
ds_read_b128 a[196:199], v3 offset:14336
v_cvt_pk_bf16_f32 v188, v128, v129
v_mfma_f32_16x16x32_bf16 a[68:71], a[156:159], v[204:207], a[68:71]
v_exp_f32 v131, v131
v_mfma_f32_16x16x32_bf16 a[68:71], a[152:155], v[200:203], a[68:71]
ds_read_b128 a[200:203], v3 offset:7168
v_cvt_pk_bf16_f32 v189, v130, v131
v_mfma_f32_16x16x32_bf16 a[72:75], a[160:163], v[200:203], a[72:75]
v_exp_f32 v144, v144
v_mfma_f32_16x16x32_bf16 a[72:75], a[164:167], v[204:207], a[72:75]
buffer_load_dwordx4 v16, s[32:35], s64 offen offset:3072 sc1 lds
v_mfma_f32_16x16x32_bf16 a[104:107], a[164:167], v[212:215], a[104:107]
s_xor_b32 s71, s71, 16384
v_exp_f32 v145, v145
v_mfma_f32_16x16x32_bf16 a[104:107], a[160:163], v[208:211], a[104:107]
ds_read_b128 a[204:207], v3 offset:15360
v_cvt_pk_bf16_f32 v196, v144, v145
v_mfma_f32_16x16x32_bf16 a[108:111], a[168:171], v[208:211], a[108:111]
s_add_u32 s70, s70, 32768
v_exp_f32 v146, v146
v_mfma_f32_16x16x32_bf16 a[108:111], a[172:175], v[212:215], a[108:111]
s_waitcnt vmcnt(8)
s_barrier
v_mfma_f32_16x16x32_bf16 a[76:79], a[172:175], v[204:207], a[76:79]
s_mov_b32 m0, s71
v_exp_f32 v147, v147
v_mfma_f32_16x16x32_bf16 a[76:79], a[168:171], v[200:203], a[76:79]
s_waitcnt lgkmcnt(1)
ds_read_b128 a[144:147], v2 offset:16384
v_cvt_pk_bf16_f32 v197, v146, v147
v_mfma_f32_16x16x32_bf16 a[80:83], a[176:179], v[200:203], a[80:83]
v_exp_f32 v148, v148
v_mfma_f32_16x16x32_bf16 a[80:83], a[180:183], v[204:207], a[80:83]
ds_read_b128 a[148:151], v2 offset:17408
ds_read_b128 a[152:155], v2 offset:18432
v_mfma_f32_16x16x32_bf16 a[112:115], a[180:183], v[212:215], a[112:115]
v_exp_f32 v149, v149
v_mfma_f32_16x16x32_bf16 a[112:115], a[176:179], v[208:211], a[112:115]
ds_read_b128 a[156:159], v2 offset:19456
v_cvt_pk_bf16_f32 v198, v148, v149
v_mfma_f32_16x16x32_bf16 a[116:119], a[184:187], v[208:211], a[116:119]
v_exp_f32 v150, v150
v_mfma_f32_16x16x32_bf16 a[116:119], a[188:191], v[212:215], a[116:119]
buffer_load_dwordx4 v16, s[32:35], s70 offen offset:0 sc1 lds
v_mfma_f32_16x16x32_bf16 a[84:87], a[188:191], v[204:207], a[84:87]
v_exp_f32 v151, v151
v_mfma_f32_16x16x32_bf16 a[84:87], a[184:187], v[200:203], a[84:87]
ds_read_b128 a[160:163], v2 offset:20480
v_cvt_pk_bf16_f32 v199, v150, v151
v_mfma_f32_16x16x32_bf16 a[88:91], a[192:195], v[200:203], a[88:91]
v_exp_f32 v132, v132
v_mfma_f32_16x16x32_bf16 a[88:91], a[196:199], v[204:207], a[88:91]
ds_read_b128 a[164:167], v2 offset:21504
v_mfma_f32_16x16x32_bf16 a[120:123], a[196:199], v[212:215], a[120:123]
v_exp_f32 v133, v133
v_mfma_f32_16x16x32_bf16 a[120:123], a[192:195], v[208:211], a[120:123]
ds_read_b128 a[168:171], v2 offset:22528
v_cvt_pk_bf16_f32 v190, v132, v133
v_mfma_f32_16x16x32_bf16 a[124:127], a[200:203], v[208:211], a[124:127]
s_waitcnt lgkmcnt(3)
v_exp_f32 v134, v134
v_mfma_f32_16x16x32_bf16 a[124:127], a[204:207], v[212:215], a[124:127]
buffer_load_dwordx4 v16, s[32:35], s70 offen offset:1024 sc1 lds
v_mfma_f32_16x16x32_bf16 a[92:95], a[204:207], v[204:207], a[92:95]
v_exp_f32 v135, v135
v_mfma_f32_16x16x32_bf16 a[92:95], a[200:203], v[200:203], a[92:95]
ds_read_b128 a[172:175], v2 offset:23552
v_cvt_pk_bf16_f32 v191, v134, v135
v_mfma_f32_16x16x32_bf16 v[120:123], a[144:147], v[56:59], v[224:227]
ds_read_b128 a[176:179], v2 offset:24576
ds_read_b128 a[180:183], v2 offset:25600
v_mfma_f32_16x16x32_bf16 v[120:123], a[148:151], v[60:63], v[120:123]
buffer_load_dwordx4 v16, s[32:35], s70 offen offset:2048 sc1 lds
v_mfma_f32_16x16x32_bf16 v[120:123], a[152:155], v[64:67], v[120:123]
s_add_u32 s64, s70, 4096
ds_read_b128 a[184:187], v2 offset:26624
ds_read_b128 a[188:191], v2 offset:27648
v_mfma_f32_16x16x32_bf16 v[120:123], a[156:159], v[68:71], v[120:123]
buffer_load_dwordx4 v16, s[32:35], s70 offen offset:3072 sc1 lds
v_mfma_f32_16x16x32_bf16 v[136:139], a[156:159], v[84:87], v[228:231]
s_add_u32 m0, s71, 4096
ds_read_b128 a[192:195], v2 offset:28672
ds_read_b128 a[196:199], v2 offset:29696
v_mfma_f32_16x16x32_bf16 v[136:139], a[152:155], v[80:83], v[136:139]
buffer_load_dwordx4 v16, s[32:35], s64 offen offset:0 sc1 lds
v_mfma_f32_16x16x32_bf16 v[136:139], a[148:151], v[76:79], v[136:139]
ds_read_b128 a[200:203], v2 offset:30720
ds_read_b128 a[204:207], v2 offset:31744
v_mfma_f32_16x16x32_bf16 v[136:139], a[144:147], v[72:75], v[136:139]
s_waitcnt lgkmcnt(6)
v_exp_f32 v120, v120
v_mfma_f32_16x16x32_bf16 v[140:143], a[160:163], v[72:75], v[228:231]
v_exp_f32 v121, v121
v_mfma_f32_16x16x32_bf16 v[140:143], a[164:167], v[76:79], v[140:143]
v_exp_f32 v122, v122
v_mfma_f32_16x16x32_bf16 v[140:143], a[168:171], v[80:83], v[140:143]
v_exp_f32 v123, v123
v_mfma_f32_16x16x32_bf16 v[140:143], a[172:175], v[84:87], v[140:143]
v_exp_f32 v136, v136
v_mfma_f32_16x16x32_bf16 v[124:127], a[172:175], v[68:71], v[224:227]
ds_read_b128 a[144:147], v3 offset:16384
v_cvt_pk_bf16_f32 v200, v120, v121
v_mfma_f32_16x16x32_bf16 v[124:127], a[168:171], v[64:67], v[124:127]
v_exp_f32 v137, v137
v_mfma_f32_16x16x32_bf16 v[124:127], a[164:167], v[60:63], v[124:127]
ds_read_b128 a[148:151], v3 offset:24576
v_cvt_pk_bf16_f32 v201, v122, v123
v_mfma_f32_16x16x32_bf16 v[124:127], a[160:163], v[56:59], v[124:127]
v_exp_f32 v138, v138
v_mfma_f32_16x16x32_bf16 v[128:131], a[176:179], v[56:59], v[224:227]
ds_read_b128 a[152:155], v3 offset:17408
v_cvt_pk_bf16_f32 v208, v136, v137
v_mfma_f32_16x16x32_bf16 v[128:131], a[180:183], v[60:63], v[128:131]
s_waitcnt lgkmcnt(3)
v_exp_f32 v139, v139
v_mfma_f32_16x16x32_bf16 v[128:131], a[184:187], v[64:67], v[128:131]
ds_read_b128 a[156:159], v3 offset:25600
v_cvt_pk_bf16_f32 v209, v138, v139
v_mfma_f32_16x16x32_bf16 v[128:131], a[188:191], v[68:71], v[128:131]
v_exp_f32 v140, v140
v_mfma_f32_16x16x32_bf16 v[144:147], a[188:191], v[84:87], v[228:231]
buffer_load_dwordx4 v16, s[32:35], s64 offen offset:1024 sc1 lds
v_mfma_f32_16x16x32_bf16 v[144:147], a[184:187], v[80:83], v[144:147]
v_exp_f32 v141, v141
v_mfma_f32_16x16x32_bf16 v[144:147], a[180:183], v[76:79], v[144:147]
ds_read_b128 a[160:163], v3 offset:18432
v_cvt_pk_bf16_f32 v210, v140, v141
v_mfma_f32_16x16x32_bf16 v[144:147], a[176:179], v[72:75], v[144:147]
v_exp_f32 v142, v142
v_mfma_f32_16x16x32_bf16 v[148:151], a[192:195], v[72:75], v[228:231]
ds_read_b128 a[164:167], v3 offset:26624
ds_read_b128 a[168:171], v3 offset:19456
v_mfma_f32_16x16x32_bf16 v[148:151], a[196:199], v[76:79], v[148:151]
v_exp_f32 v143, v143
v_mfma_f32_16x16x32_bf16 v[148:151], a[200:203], v[80:83], v[148:151]
ds_read_b128 a[172:175], v3 offset:27648
v_cvt_pk_bf16_f32 v211, v142, v143
v_mfma_f32_16x16x32_bf16 v[148:151], a[204:207], v[84:87], v[148:151]
v_exp_f32 v124, v124
v_mfma_f32_16x16x32_bf16 v[132:135], a[204:207], v[68:71], v[224:227]
ds_read_b128 a[176:179], v3 offset:20480
buffer_load_dwordx4 v16, s[32:35], s64 offen offset:2048 sc1 lds
v_mfma_f32_16x16x32_bf16 v[132:135], a[200:203], v[64:67], v[132:135]
v_exp_f32 v125, v125
v_mfma_f32_16x16x32_bf16 v[132:135], a[196:199], v[60:63], v[132:135]
ds_read_b128 a[180:183], v3 offset:28672
v_cvt_pk_bf16_f32 v202, v124, v125
v_mfma_f32_16x16x32_bf16 v[132:135], a[192:195], v[56:59], v[132:135]
v_exp_f32 v126, v126
v_smfmac_f32_16x16x64_bf16 a[136:139], a[240:243], v[184:191], v5
ds_read_b128 a[184:187], v3 offset:21504
v_smfmac_f32_16x16x64_bf16 a[140:143], a[240:243], v[192:199], v5
s_waitcnt lgkmcnt(3)
ds_read_b128 a[188:191], v3 offset:29696
v_mfma_f32_16x16x32_bf16 a[64:67], a[144:147], v[184:187], a[64:67]
v_exp_f32 v127, v127
v_mfma_f32_16x16x32_bf16 a[64:67], a[148:151], v[188:191], a[64:67]
v_exp_f32 v128, v128
v_mfma_f32_16x16x32_bf16 a[96:99], a[148:151], v[196:199], a[96:99]
v_exp_f32 v129, v129
v_mfma_f32_16x16x32_bf16 a[96:99], a[144:147], v[192:195], a[96:99]
ds_read_b128 a[192:195], v3 offset:22528
v_cvt_pk_bf16_f32 v203, v126, v127
v_mfma_f32_16x16x32_bf16 a[100:103], a[152:155], v[192:195], a[100:103]
v_exp_f32 v130, v130
v_mfma_f32_16x16x32_bf16 a[100:103], a[156:159], v[196:199], a[100:103]
ds_read_b128 a[196:199], v3 offset:30720
v_cvt_pk_bf16_f32 v204, v128, v129
v_mfma_f32_16x16x32_bf16 a[68:71], a[156:159], v[188:191], a[68:71]
v_exp_f32 v131, v131
v_mfma_f32_16x16x32_bf16 a[68:71], a[152:155], v[184:187], a[68:71]
ds_read_b128 a[200:203], v3 offset:23552
v_cvt_pk_bf16_f32 v205, v130, v131
v_mfma_f32_16x16x32_bf16 a[72:75], a[160:163], v[184:187], a[72:75]
v_exp_f32 v144, v144
v_mfma_f32_16x16x32_bf16 a[72:75], a[164:167], v[188:191], a[72:75]
buffer_load_dwordx4 v16, s[32:35], s64 offen offset:3072 sc1 lds
v_mfma_f32_16x16x32_bf16 a[104:107], a[164:167], v[196:199], a[104:107]
s_xor_b32 s71, s71, 49152
v_exp_f32 v145, v145
v_mfma_f32_16x16x32_bf16 a[104:107], a[160:163], v[192:195], a[104:107]
ds_read_b128 a[204:207], v3 offset:31744
v_cvt_pk_bf16_f32 v212, v144, v145
v_mfma_f32_16x16x32_bf16 a[108:111], a[168:171], v[192:195], a[108:111]
s_add_u32 s70, s70, 32768
v_xor_b32 v2, 0x8000, v2
v_exp_f32 v146, v146
v_mfma_f32_16x16x32_bf16 a[108:111], a[172:175], v[196:199], a[108:111]
s_waitcnt vmcnt(8)
s_barrier
v_mfma_f32_16x16x32_bf16 a[76:79], a[172:175], v[188:191], a[76:79]
s_mov_b32 m0, s71
v_exp_f32 v147, v147
v_mfma_f32_16x16x32_bf16 a[76:79], a[168:171], v[184:187], a[76:79]
s_waitcnt lgkmcnt(1)
ds_read_b128 a[144:147], v2 offset:0
v_cvt_pk_bf16_f32 v213, v146, v147
v_mfma_f32_16x16x32_bf16 a[80:83], a[176:179], v[184:187], a[80:83]
v_exp_f32 v148, v148
v_mfma_f32_16x16x32_bf16 a[80:83], a[180:183], v[188:191], a[80:83]
ds_read_b128 a[148:151], v2 offset:1024
ds_read_b128 a[152:155], v2 offset:2048
v_mfma_f32_16x16x32_bf16 a[112:115], a[180:183], v[196:199], a[112:115]
v_exp_f32 v149, v149
v_mfma_f32_16x16x32_bf16 a[112:115], a[176:179], v[192:195], a[112:115]
ds_read_b128 a[156:159], v2 offset:3072
v_cvt_pk_bf16_f32 v214, v148, v149
v_mfma_f32_16x16x32_bf16 a[116:119], a[184:187], v[192:195], a[116:119]
v_exp_f32 v150, v150
v_mfma_f32_16x16x32_bf16 a[116:119], a[188:191], v[196:199], a[116:119]
buffer_load_dwordx4 v16, s[32:35], s70 offen offset:0 sc1 lds
v_mfma_f32_16x16x32_bf16 a[84:87], a[188:191], v[188:191], a[84:87]
s_sub_u32 s72, s72, 1
v_exp_f32 v151, v151
v_mfma_f32_16x16x32_bf16 a[84:87], a[184:187], v[184:187], a[84:87]
ds_read_b128 a[160:163], v2 offset:4096
v_cvt_pk_bf16_f32 v215, v150, v151
v_mfma_f32_16x16x32_bf16 a[88:91], a[192:195], v[184:187], a[88:91]
v_exp_f32 v132, v132
v_mfma_f32_16x16x32_bf16 a[88:91], a[196:199], v[188:191], a[88:91]
ds_read_b128 a[164:167], v2 offset:5120
v_xor_b32 v3, 0x8000, v3
v_mfma_f32_16x16x32_bf16 a[120:123], a[196:199], v[196:199], a[120:123]
s_cmp_lg_u32 s72, 0
v_exp_f32 v133, v133
v_mfma_f32_16x16x32_bf16 a[120:123], a[192:195], v[192:195], a[120:123]
ds_read_b128 a[168:171], v2 offset:6144
v_cvt_pk_bf16_f32 v206, v132, v133
v_mfma_f32_16x16x32_bf16 a[124:127], a[200:203], v[192:195], a[124:127]
s_waitcnt lgkmcnt(3)
v_exp_f32 v134, v134
v_mfma_f32_16x16x32_bf16 a[124:127], a[204:207], v[196:199], a[124:127]
buffer_load_dwordx4 v16, s[32:35], s70 offen offset:1024 sc1 lds
v_mfma_f32_16x16x32_bf16 a[92:95], a[204:207], v[188:191], a[92:95]
v_exp_f32 v135, v135
v_mfma_f32_16x16x32_bf16 a[92:95], a[200:203], v[184:187], a[92:95]
ds_read_b128 a[172:175], v2 offset:7168
v_cvt_pk_bf16_f32 v207, v134, v135
s_cbranch_scc1 L_S
L_SD:
buffer_load_dword v19, off, s[52:55], s80 sc1
s_waitcnt lgkmcnt(7)
v_mfma_f32_16x16x32_bf16 v[136:139], a[144:147], v[72:75], v[228:231]
s_waitcnt lgkmcnt(6)
ds_read_b128 a[176:179], v2 offset:8192
ds_read_b128 a[180:183], v2 offset:9216
v_mfma_f32_16x16x32_bf16 v[136:139], a[148:151], v[76:79], v[136:139]
s_waitcnt lgkmcnt(7)
buffer_load_dwordx4 v16, s[32:35], s70 offen offset:2048 sc1 lds
v_cndmask_b32 v120, v224, v17, s[0:1]
v_cndmask_b32 v121, v224, v17, s[4:5]
v_cndmask_b32 v122, v224, v17, s[6:7]
v_cndmask_b32 v123, v224, v17, s[8:9]
v_mfma_f32_16x16x32_bf16 v[136:139], a[152:155], v[80:83], v[136:139]
s_waitcnt lgkmcnt(6)
s_add_u32 s64, s70, 4096
ds_read_b128 a[184:187], v2 offset:10240
ds_read_b128 a[188:191], v2 offset:11264
v_mfma_f32_16x16x32_bf16 v[136:139], a[156:159], v[84:87], v[136:139]
buffer_load_dwordx4 v16, s[32:35], s70 offen offset:3072 sc1 lds
v_mfma_f32_16x16x32_bf16 v[120:123], a[156:159], v[68:71], v[120:123]
s_add_u32 m0, s71, 4096
ds_read_b128 a[192:195], v2 offset:12288
ds_read_b128 a[196:199], v2 offset:13312
v_mfma_f32_16x16x32_bf16 v[120:123], a[152:155], v[64:67], v[120:123]
buffer_load_dwordx4 v16, s[32:35], s64 offen offset:0 sc1 lds
v_mfma_f32_16x16x32_bf16 v[120:123], a[148:151], v[60:63], v[120:123]
ds_read_b128 a[200:203], v2 offset:14336
ds_read_b128 a[204:207], v2 offset:15360
v_mfma_f32_16x16x32_bf16 v[120:123], a[144:147], v[56:59], v[120:123]
s_waitcnt lgkmcnt(6)
v_exp_f32 v136, v136
v_mfma_f32_16x16x32_bf16 v[140:143], a[160:163], v[72:75], v[228:231]
v_exp_f32 v137, v137
v_mfma_f32_16x16x32_bf16 v[140:143], a[164:167], v[76:79], v[140:143]
v_cndmask_b32 v124, v224, v17, s[10:11]
v_cndmask_b32 v125, v224, v17, s[12:13]
v_cndmask_b32 v126, v224, v17, s[18:19]
v_cndmask_b32 v127, v224, v17, s[22:23]
v_exp_f32 v138, v138
v_mfma_f32_16x16x32_bf16 v[140:143], a[168:171], v[80:83], v[140:143]
v_exp_f32 v139, v139
v_mfma_f32_16x16x32_bf16 v[140:143], a[172:175], v[84:87], v[140:143]
v_exp_f32 v120, v120
v_mfma_f32_16x16x32_bf16 v[124:127], a[172:175], v[68:71], v[124:127]
ds_read_b128 a[144:147], v3 offset:0
v_cvt_pk_bf16_f32 v192, v136, v137
v_mfma_f32_16x16x32_bf16 v[124:127], a[168:171], v[64:67], v[124:127]
v_cndmask_b32 v128, v224, v17, s[26:27]
v_cndmask_b32 v129, v224, v17, s[56:57]
v_cndmask_b32 v130, v224, v17, s[58:59]
v_cndmask_b32 v131, v224, v17, s[60:61]
v_exp_f32 v121, v121
v_mfma_f32_16x16x32_bf16 v[124:127], a[164:167], v[60:63], v[124:127]
s_mul_i32 s69, s83, 8
ds_read_b128 a[148:151], v3 offset:8192
v_cvt_pk_bf16_f32 v193, v138, v139
v_mfma_f32_16x16x32_bf16 v[124:127], a[160:163], v[56:59], v[124:127]
s_sub_u32 s69, 36, s69
v_exp_f32 v122, v122
v_mfma_f32_16x16x32_bf16 v[128:131], a[176:179], v[56:59], v[128:131]
ds_read_b128 a[152:155], v3 offset:1024
v_cvt_pk_bf16_f32 v184, v120, v121
v_mfma_f32_16x16x32_bf16 v[128:131], a[180:183], v[60:63], v[128:131]
s_waitcnt lgkmcnt(3)
v_exp_f32 v123, v123
v_mfma_f32_16x16x32_bf16 v[128:131], a[184:187], v[64:67], v[128:131]
ds_read_b128 a[156:159], v3 offset:9216
v_cvt_pk_bf16_f32 v185, v122, v123
v_mfma_f32_16x16x32_bf16 v[128:131], a[188:191], v[68:71], v[128:131]
v_exp_f32 v140, v140
v_mfma_f32_16x16x32_bf16 v[144:147], a[188:191], v[84:87], v[228:231]
buffer_load_dwordx4 v16, s[32:35], s64 offen offset:1024 sc1 lds
v_mfma_f32_16x16x32_bf16 v[144:147], a[184:187], v[80:83], v[144:147]
v_exp_f32 v141, v141
v_mfma_f32_16x16x32_bf16 v[144:147], a[180:183], v[76:79], v[144:147]
ds_read_b128 a[160:163], v3 offset:2048
v_cvt_pk_bf16_f32 v194, v140, v141
v_mfma_f32_16x16x32_bf16 v[144:147], a[176:179], v[72:75], v[144:147]
v_exp_f32 v142, v142
v_mfma_f32_16x16x32_bf16 v[148:151], a[192:195], v[72:75], v[228:231]
ds_read_b128 a[164:167], v3 offset:10240
ds_read_b128 a[168:171], v3 offset:3072
v_mfma_f32_16x16x32_bf16 v[148:151], a[196:199], v[76:79], v[148:151]
v_cndmask_b32 v132, v224, v17, s[62:63]
v_cndmask_b32 v133, v224, v17, s[48:49]
v_cndmask_b32 v134, v224, v17, s[50:51]
v_cndmask_b32 v135, v224, v17, s[100:101]
v_exp_f32 v143, v143
v_mfma_f32_16x16x32_bf16 v[148:151], a[200:203], v[80:83], v[148:151]
ds_read_b128 a[172:175], v3 offset:11264
v_cvt_pk_bf16_f32 v195, v142, v143
v_mfma_f32_16x16x32_bf16 v[148:151], a[204:207], v[84:87], v[148:151]
v_exp_f32 v124, v124
v_mfma_f32_16x16x32_bf16 v[132:135], a[204:207], v[68:71], v[132:135]
ds_read_b128 a[176:179], v3 offset:4096
buffer_load_dwordx4 v16, s[32:35], s64 offen offset:2048 sc1 lds
v_mfma_f32_16x16x32_bf16 v[132:135], a[200:203], v[64:67], v[132:135]
v_exp_f32 v125, v125
v_mfma_f32_16x16x32_bf16 v[132:135], a[196:199], v[60:63], v[132:135]
ds_read_b128 a[180:183], v3 offset:12288
v_cvt_pk_bf16_f32 v186, v124, v125
v_mfma_f32_16x16x32_bf16 v[132:135], a[192:195], v[56:59], v[132:135]
s_branch L_po19
L_pg19:
s_branch L_pg23
L_po19:
v_exp_f32 v126, v126
v_smfmac_f32_16x16x64_bf16 a[136:139], a[240:243], v[200:207], v5
ds_read_b128 a[184:187], v3 offset:5120
v_smfmac_f32_16x16x64_bf16 a[140:143], a[240:243], v[208:215], v5
s_waitcnt lgkmcnt(3)
ds_read_b128 a[188:191], v3 offset:13312
v_mfma_f32_16x16x32_bf16 a[64:67], a[144:147], v[200:203], a[64:67]
v_exp_f32 v127, v127
v_mfma_f32_16x16x32_bf16 a[64:67], a[148:151], v[204:207], a[64:67]
v_exp_f32 v128, v128
v_mfma_f32_16x16x32_bf16 a[96:99], a[148:151], v[212:215], a[96:99]
v_exp_f32 v129, v129
v_mfma_f32_16x16x32_bf16 a[96:99], a[144:147], v[208:211], a[96:99]
ds_read_b128 a[192:195], v3 offset:6144
v_cvt_pk_bf16_f32 v187, v126, v127
v_mfma_f32_16x16x32_bf16 a[100:103], a[152:155], v[208:211], a[100:103]
v_exp_f32 v130, v130
v_mfma_f32_16x16x32_bf16 a[100:103], a[156:159], v[212:215], a[100:103]
ds_read_b128 a[196:199], v3 offset:14336
v_cvt_pk_bf16_f32 v188, v128, v129
v_mfma_f32_16x16x32_bf16 a[68:71], a[156:159], v[204:207], a[68:71]
v_exp_f32 v131, v131
v_mfma_f32_16x16x32_bf16 a[68:71], a[152:155], v[200:203], a[68:71]
ds_read_b128 a[200:203], v3 offset:7168
v_cvt_pk_bf16_f32 v189, v130, v131
v_mfma_f32_16x16x32_bf16 a[72:75], a[160:163], v[200:203], a[72:75]
v_exp_f32 v144, v144
v_mfma_f32_16x16x32_bf16 a[72:75], a[164:167], v[204:207], a[72:75]
buffer_load_dwordx4 v16, s[32:35], s64 offen offset:3072 sc1 lds
v_mfma_f32_16x16x32_bf16 a[104:107], a[164:167], v[212:215], a[104:107]
v_exp_f32 v145, v145
v_mfma_f32_16x16x32_bf16 a[104:107], a[160:163], v[208:211], a[104:107]
ds_read_b128 a[204:207], v3 offset:15360
v_cvt_pk_bf16_f32 v196, v144, v145
v_mfma_f32_16x16x32_bf16 a[108:111], a[168:171], v[208:211], a[108:111]
v_exp_f32 v146, v146
v_mfma_f32_16x16x32_bf16 a[108:111], a[172:175], v[212:215], a[108:111]
s_waitcnt vmcnt(9)
s_barrier
v_mfma_f32_16x16x32_bf16 a[76:79], a[172:175], v[204:207], a[76:79]
v_exp_f32 v147, v147
v_mfma_f32_16x16x32_bf16 a[76:79], a[168:171], v[200:203], a[76:79]
s_waitcnt lgkmcnt(1)
ds_read_b128 a[144:147], v2 offset:16384
v_cvt_pk_bf16_f32 v197, v146, v147
v_mfma_f32_16x16x32_bf16 a[80:83], a[176:179], v[200:203], a[80:83]
s_waitcnt vmcnt(6)
v_readfirstlane_b32 vcc_lo, v19
s_nop 0
s_cmp_lt_u32 vcc_lo, s69
s_cbranch_scc1 L_spin_8
L_spinbk_9:
v_exp_f32 v148, v148
v_mfma_f32_16x16x32_bf16 a[80:83], a[180:183], v[204:207], a[80:83]
ds_read_b128 a[148:151], v2 offset:17408
ds_read_b128 a[152:155], v2 offset:18432
v_mfma_f32_16x16x32_bf16 a[112:115], a[180:183], v[212:215], a[112:115]
v_exp_f32 v149, v149
v_mfma_f32_16x16x32_bf16 a[112:115], a[176:179], v[208:211], a[112:115]
ds_read_b128 a[156:159], v2 offset:19456
v_cvt_pk_bf16_f32 v198, v148, v149
v_mfma_f32_16x16x32_bf16 a[116:119], a[184:187], v[208:211], a[116:119]
v_exp_f32 v150, v150
v_mfma_f32_16x16x32_bf16 a[116:119], a[188:191], v[212:215], a[116:119]
v_cndmask_b32 v136, v228, v17, s[0:1]
v_cndmask_b32 v137, v228, v17, s[4:5]
v_mfma_f32_16x16x32_bf16 a[84:87], a[188:191], v[204:207], a[84:87]
v_exp_f32 v151, v151
v_mfma_f32_16x16x32_bf16 a[84:87], a[184:187], v[200:203], a[84:87]
ds_read_b128 a[160:163], v2 offset:20480
v_cvt_pk_bf16_f32 v199, v150, v151
v_mfma_f32_16x16x32_bf16 a[88:91], a[192:195], v[200:203], a[88:91]
v_exp_f32 v132, v132
v_mfma_f32_16x16x32_bf16 a[88:91], a[196:199], v[204:207], a[88:91]
ds_read_b128 a[164:167], v2 offset:21504
v_cndmask_b32 v138, v228, v17, s[6:7]
v_mfma_f32_16x16x32_bf16 a[120:123], a[196:199], v[212:215], a[120:123]
v_exp_f32 v133, v133
v_mfma_f32_16x16x32_bf16 a[120:123], a[192:195], v[208:211], a[120:123]
ds_read_b128 a[168:171], v2 offset:22528
v_cvt_pk_bf16_f32 v190, v132, v133
v_mfma_f32_16x16x32_bf16 a[124:127], a[200:203], v[208:211], a[124:127]
s_waitcnt lgkmcnt(3)
v_exp_f32 v134, v134
v_mfma_f32_16x16x32_bf16 a[124:127], a[204:207], v[212:215], a[124:127]
v_cndmask_b32 v139, v228, v17, s[8:9]
v_cndmask_b32 v140, v228, v17, s[10:11]
v_mfma_f32_16x16x32_bf16 a[92:95], a[204:207], v[204:207], a[92:95]
v_exp_f32 v135, v135
v_mfma_f32_16x16x32_bf16 a[92:95], a[200:203], v[200:203], a[92:95]
ds_read_b128 a[172:175], v2 offset:23552
v_cvt_pk_bf16_f32 v191, v134, v135
v_mfma_f32_16x16x32_bf16 v[136:139], a[144:147], v[72:75], v[136:139]
ds_read_b128 a[176:179], v2 offset:24576
v_cndmask_b32 v141, v228, v17, s[12:13]
v_mfma_f32_16x16x32_bf16 v[136:139], a[148:151], v[76:79], v[136:139]
ds_read_b128 a[180:183], v2 offset:25600
v_cndmask_b32 v142, v228, v17, s[18:19]
v_cndmask_b32 v143, v228, v17, s[22:23]
v_mfma_f32_16x16x32_bf16 v[136:139], a[152:155], v[80:83], v[136:139]
ds_read_b128 a[184:187], v2 offset:26624
v_cndmask_b32 v144, v228, v17, s[26:27]
v_mfma_f32_16x16x32_bf16 v[136:139], a[156:159], v[84:87], v[136:139]
s_waitcnt lgkmcnt(3)
ds_read_b128 a[188:191], v2 offset:27648
v_cndmask_b32 v145, v228, v17, s[56:57]
v_mfma_f32_16x16x32_bf16 v[140:143], a[172:175], v[84:87], v[140:143]
ds_read_b128 a[192:195], v2 offset:28672
ds_read_b128 a[196:199], v2 offset:29696
ds_read_b128 a[200:203], v2 offset:30720
ds_read_b128 a[204:207], v2 offset:31744
v_mfma_f32_16x16x32_bf16 v[140:143], a[168:171], v[80:83], v[140:143]
ds_read_b128 a[144:147], v3 offset:16384
v_cndmask_b32 v146, v228, v17, s[58:59]
v_cndmask_b32 v147, v228, v17, s[60:61]
v_mfma_f32_16x16x32_bf16 v[140:143], a[164:167], v[76:79], v[140:143]
ds_read_b128 a[148:151], v3 offset:24576
v_cndmask_b32 v148, v228, v17, s[62:63]
v_mfma_f32_16x16x32_bf16 v[140:143], a[160:163], v[72:75], v[140:143]
s_waitcnt lgkmcnt(8)
ds_read_b128 a[152:155], v3 offset:17408
v_cndmask_b32 v149, v228, v17, s[48:49]
v_mfma_f32_16x16x32_bf16 v[144:147], a[176:179], v[72:75], v[144:147]
ds_read_b128 a[156:159], v3 offset:25600
v_cndmask_b32 v150, v228, v17, s[50:51]
v_mfma_f32_16x16x32_bf16 v[144:147], a[180:183], v[76:79], v[144:147]
s_waitcnt lgkmcnt(8)
ds_read_b128 a[160:163], v3 offset:18432
v_cndmask_b32 v151, v228, v17, s[100:101]
v_mfma_f32_16x16x32_bf16 v[144:147], a[184:187], v[80:83], v[144:147]
v_exp_f32 v136, v136
v_mfma_f32_16x16x32_bf16 v[144:147], a[188:191], v[84:87], v[144:147]
s_waitcnt lgkmcnt(4)
v_exp_f32 v137, v137
v_mfma_f32_16x16x32_bf16 v[148:151], a[204:207], v[84:87], v[148:151]
v_exp_f32 v138, v138
v_mfma_f32_16x16x32_bf16 v[148:151], a[200:203], v[80:83], v[148:151]
s_add_u32 s65, s84, 0
v_exp_f32 v139, v139
v_mfma_f32_16x16x32_bf16 v[148:151], a[196:199], v[76:79], v[148:151]
buffer_load_dwordx4 a[208:211], v14, s[44:47], s65 offen offset:0 sc1
v_mfma_f32_16x16x32_bf16 v[148:151], a[192:195], v[72:75], v[148:151]
ds_read_b128 a[164:167], v3 offset:26624
v_cvt_pk_bf16_f32 v208, v136, v137
v_smfmac_f32_16x16x64_bf16 a[136:139], a[240:243], v[184:191], v5
ds_read_b128 a[168:171], v3 offset:19456
v_smfmac_f32_16x16x64_bf16 a[140:143], a[240:243], v[192:199], v5
ds_read_b128 a[172:175], v3 offset:27648
v_mfma_f32_16x16x32_bf16 a[64:67], a[144:147], v[184:187], a[64:67]
s_waitcnt lgkmcnt(3)
v_exp_f32 v140, v140
v_mfma_f32_16x16x32_bf16 a[64:67], a[148:151], v[188:191], a[64:67]
buffer_load_dwordx4 a[216:219], v14, s[44:47], s65 offen offset:1024 sc1
v_mfma_f32_16x16x32_bf16 a[96:99], a[148:151], v[196:199], a[96:99]
v_exp_f32 v141, v141
v_mfma_f32_16x16x32_bf16 a[96:99], a[144:147], v[192:195], a[96:99]
buffer_load_dwordx4 a[224:227], v15, s[44:47], s65 offen offset:0 sc1
v_mfma_f32_16x16x32_bf16 a[100:103], a[152:155], v[192:195], a[100:103]
v_exp_f32 v142, v142
v_mfma_f32_16x16x32_bf16 a[100:103], a[156:159], v[196:199], a[100:103]
buffer_load_dwordx4 a[232:235], v15, s[44:47], s65 offen offset:1024 sc1
v_mfma_f32_16x16x32_bf16 a[68:71], a[156:159], v[188:191], a[68:71]
s_add_u32 s65, s84, 8192
ds_read_b128 a[176:179], v3 offset:20480
v_cvt_pk_bf16_f32 v209, v138, v139
v_mfma_f32_16x16x32_bf16 a[68:71], a[152:155], v[184:187], a[68:71]
buffer_load_dwordx4 a[212:215], v14, s[44:47], s65 offen offset:0 sc1
v_mfma_f32_16x16x32_bf16 a[72:75], a[160:163], v[184:187], a[72:75]
s_waitcnt lgkmcnt(1)
ds_read_b128 a[180:183], v3 offset:28672
v_cvt_pk_bf16_f32 v210, v140, v141
v_mfma_f32_16x16x32_bf16 a[72:75], a[164:167], v[188:191], a[72:75]
v_exp_f32 v143, v143
v_mfma_f32_16x16x32_bf16 a[104:107], a[164:167], v[196:199], a[104:107]
buffer_load_dwordx4 a[220:223], v14, s[44:47], s65 offen offset:1024 sc1
v_mfma_f32_16x16x32_bf16 a[104:107], a[160:163], v[192:195], a[104:107]
v_exp_f32 v144, v144
v_mfma_f32_16x16x32_bf16 a[108:111], a[168:171], v[192:195], a[108:111]
ds_read_b128 a[184:187], v3 offset:21504
v_xor_b32 v2, 0x8000, v2
v_mfma_f32_16x16x32_bf16 a[108:111], a[172:175], v[196:199], a[108:111]
buffer_load_dwordx4 a[228:231], v15, s[44:47], s65 offen offset:0 sc1
ds_read_b128 a[188:191], v3 offset:29696
v_mfma_f32_16x16x32_bf16 a[76:79], a[172:175], v[188:191], a[76:79]
v_exp_f32 v145, v145
v_mfma_f32_16x16x32_bf16 a[76:79], a[168:171], v[184:187], a[76:79]
s_waitcnt lgkmcnt(2)
buffer_load_dwordx4 a[236:239], v15, s[44:47], s65 offen offset:1024 sc1
v_mfma_f32_16x16x32_bf16 a[80:83], a[176:179], v[184:187], a[80:83]
s_add_u32 s65, s84, 32768
ds_read_b128 a[192:195], v3 offset:22528
v_cvt_pk_bf16_f32 v211, v142, v143
v_mfma_f32_16x16x32_bf16 a[80:83], a[180:183], v[188:191], a[80:83]
buffer_load_dwordx4 v[152:155], v14, s[44:47], s65 offen offset:0 sc1
ds_read_b128 a[196:199], v3 offset:30720
v_exp_f32 v146, v146
v_mfma_f32_16x16x32_bf16 a[112:115], a[180:183], v[196:199], a[112:115]
ds_read_b128 a[200:203], v3 offset:23552
ds_read_b128 a[204:207], v3 offset:31744
v_mfma_f32_16x16x32_bf16 a[112:115], a[176:179], v[192:195], a[112:115]
s_waitcnt vmcnt(9)
s_barrier
v_xor_b32 v3, 0x8000, v3
buffer_load_dwordx4 v[160:163], v14, s[44:47], s65 offen offset:1024 sc1
s_waitcnt lgkmcnt(4)
v_mfma_f32_16x16x32_bf16 a[116:119], a[184:187], v[192:195], a[116:119]
v_exp_f32 v147, v147
v_mfma_f32_16x16x32_bf16 a[116:119], a[188:191], v[196:199], a[116:119]
buffer_load_dwordx4 v[168:171], v15, s[44:47], s65 offen offset:0 sc1
v_mfma_f32_16x16x32_bf16 a[84:87], a[188:191], v[188:191], a[84:87]
v_exp_f32 v148, v148
v_mfma_f32_16x16x32_bf16 a[84:87], a[184:187], v[184:187], a[84:87]
s_waitcnt lgkmcnt(2)
buffer_load_dwordx4 v[176:179], v15, s[44:47], s65 offen offset:1024 sc1
v_cvt_pk_bf16_f32 v212, v144, v145
v_mfma_f32_16x16x32_bf16 a[88:91], a[192:195], v[184:187], a[88:91]
s_add_u32 s65, s84, 40960
v_exp_f32 v149, v149
v_mfma_f32_16x16x32_bf16 a[88:91], a[196:199], v[188:191], a[88:91]
buffer_load_dwordx4 v[156:159], v14, s[44:47], s65 offen offset:0 sc1
v_mfma_f32_16x16x32_bf16 a[120:123], a[196:199], v[196:199], a[120:123]
ds_read_b128 a[144:147], v3 offset:0
v_cvt_pk_bf16_f32 v213, v146, v147
v_mfma_f32_16x16x32_bf16 a[120:123], a[192:195], v[192:195], a[120:123]
s_waitcnt lgkmcnt(1)
buffer_load_dwordx4 v[164:167], v14, s[44:47], s65 offen offset:1024 sc1
ds_read_b128 a[148:151], v3 offset:8192
v_exp_f32 v150, v150
v_mfma_f32_16x16x32_bf16 a[124:127], a[200:203], v[192:195], a[124:127]
ds_read_b128 a[152:155], v3 offset:1024
v_cvt_pk_bf16_f32 v214, v148, v149
v_mfma_f32_16x16x32_bf16 a[124:127], a[204:207], v[196:199], a[124:127]
buffer_load_dwordx4 v[172:175], v15, s[44:47], s65 offen offset:0 sc1
ds_read_b128 a[156:159], v3 offset:9216
v_mfma_f32_16x16x32_bf16 a[92:95], a[204:207], v[188:191], a[92:95]
v_exp_f32 v151, v151
v_mfma_f32_16x16x32_bf16 a[92:95], a[200:203], v[184:187], a[92:95]
buffer_load_dwordx4 v[180:183], v15, s[44:47], s65 offen offset:1024 sc1
ds_read_b128 a[160:163], v3 offset:2048
ds_read_b128 a[164:167], v3 offset:10240
ds_read_b128 a[168:171], v3 offset:3072
ds_read_b128 a[172:175], v3 offset:11264
v_cvt_pk_bf16_f32 v215, v150, v151
v_accvgpr_read_b32 v22, a136
v_accvgpr_read_b32 v248, a137
v_add_f32 v22, v22, v248
v_max_f32 v1, v1, v22
v_rcp_f32 v22, v22
v_accvgpr_read_b32 v232, a64
v_accvgpr_read_b32 v233, a65
v_accvgpr_read_b32 v234, a66
v_accvgpr_read_b32 v235, a67
v_accvgpr_read_b32 v236, a68
v_accvgpr_read_b32 v237, a69
v_accvgpr_read_b32 v238, a70
v_accvgpr_read_b32 v239, a71
v_mul_f32 v22, v22, v8
v_mul_f32 v232, v232, v22
v_mul_f32 v233, v233, v22
v_mul_f32 v234, v234, v22
v_mul_f32 v235, v235, v22
v_mul_f32 v236, v236, v22
v_mul_f32 v237, v237, v22
v_mul_f32 v238, v238, v22
v_mul_f32 v239, v239, v22
v_cvt_pk_bf16_f32 v232, v232, v233
v_cvt_pk_bf16_f32 v233, v234, v235
v_cvt_pk_bf16_f32 v234, v236, v237
v_cvt_pk_bf16_f32 v235, v238, v239
s_add_u32 s77, s75, 0
buffer_store_dwordx4 v[232:235], v16, s[44:47], s77 offen sc1
L_TAIL:
ds_read_b128 a[176:179], v3 offset:4096
ds_read_b128 a[180:183], v3 offset:12288
ds_read_b128 a[184:187], v3 offset:5120
ds_read_b128 a[188:191], v3 offset:13312
v_smfmac_f32_16x16x64_bf16 a[140:143], a[240:243], v[208:215], v5
s_waitcnt lgkmcnt(11)
s_add_u32 m0, s86, 32768
s_add_u32 s64, s85, 262144
ds_read_b128 a[192:195], v3 offset:6144
v_mfma_f32_16x16x32_bf16 a[96:99], a[144:147], v[208:211], a[96:99]
s_waitcnt lgkmcnt(11)
ds_read_b128 a[196:199], v3 offset:14336
ds_read_b128 a[200:203], v3 offset:7168
ds_read_b128 a[204:207], v3 offset:15360
v_mfma_f32_16x16x32_bf16 a[96:99], a[148:151], v[212:215], a[96:99]
s_waitcnt lgkmcnt(12)
buffer_load_dwordx4 v12, s[36:39], s64 offen lds
v_mfma_f32_16x16x32_bf16 a[100:103], a[156:159], v[212:215], a[100:103]
s_add_u32 m0, s86, 33792
s_add_u32 s64, s85, 270336
v_accvgpr_read_b32 v240, a72
v_accvgpr_read_b32 v241, a73
v_mfma_f32_16x16x32_bf16 a[100:103], a[152:155], v[208:211], a[100:103]
s_waitcnt lgkmcnt(11)
buffer_load_dwordx4 v13, s[36:39], s64 offen lds
v_mfma_f32_16x16x32_bf16 a[104:107], a[160:163], v[208:211], a[104:107]
s_waitcnt lgkmcnt(10)
s_add_u32 m0, s86, 34816
s_add_u32 s64, s85, 278528
v_accvgpr_read_b32 v242, a74
v_accvgpr_read_b32 v243, a75
v_mfma_f32_16x16x32_bf16 a[104:107], a[164:167], v[212:215], a[104:107]
s_waitcnt lgkmcnt(8)
buffer_load_dwordx4 v12, s[36:39], s64 offen lds
v_mfma_f32_16x16x32_bf16 a[108:111], a[172:175], v[212:215], a[108:111]
s_add_u32 m0, s86, 35840
s_add_u32 s64, s85, 286720
v_accvgpr_read_b32 v244, a76
v_accvgpr_read_b32 v245, a77
v_mfma_f32_16x16x32_bf16 a[108:111], a[168:171], v[208:211], a[108:111]
s_waitcnt lgkmcnt(7)
buffer_load_dwordx4 v13, s[36:39], s64 offen lds
v_mfma_f32_16x16x32_bf16 a[112:115], a[176:179], v[208:211], a[112:115]
s_waitcnt lgkmcnt(6)
s_add_u32 m0, s86, 36864
s_add_u32 s64, s85, 294912
v_accvgpr_read_b32 v246, a78
v_accvgpr_read_b32 v247, a79
v_mfma_f32_16x16x32_bf16 a[112:115], a[180:183], v[212:215], a[112:115]
s_waitcnt lgkmcnt(4)
buffer_load_dwordx4 v12, s[36:39], s64 offen lds
v_mfma_f32_16x16x32_bf16 a[116:119], a[188:191], v[212:215], a[116:119]
s_add_u32 m0, s86, 37888
s_add_u32 s64, s85, 303104
v_mul_f32 v240, v240, v22
v_mul_f32 v241, v241, v22
v_mfma_f32_16x16x32_bf16 a[116:119], a[184:187], v[208:211], a[116:119]
s_waitcnt lgkmcnt(3)
buffer_load_dwordx4 v13, s[36:39], s64 offen lds
v_mfma_f32_16x16x32_bf16 a[120:123], a[192:195], v[208:211], a[120:123]
s_waitcnt lgkmcnt(2)
s_add_u32 m0, s86, 38912
s_add_u32 s64, s85, 311296
v_mul_f32 v242, v242, v22
v_mul_f32 v243, v243, v22
v_mfma_f32_16x16x32_bf16 a[120:123], a[196:199], v[212:215], a[120:123]
s_waitcnt lgkmcnt(0)
buffer_load_dwordx4 v12, s[36:39], s64 offen lds
v_mfma_f32_16x16x32_bf16 a[124:127], a[204:207], v[212:215], a[124:127]
s_add_u32 m0, s86, 39936
s_add_u32 s64, s85, 319488
v_mul_f32 v244, v244, v22
v_mul_f32 v245, v245, v22
v_mfma_f32_16x16x32_bf16 a[124:127], a[200:203], v[208:211], a[124:127]
buffer_load_dwordx4 v13, s[36:39], s64 offen lds
v_mul_f32 v246, v246, v22
v_mul_f32 v247, v247, v22
v_cvt_pk_bf16_f32 v240, v240, v241
v_cvt_pk_bf16_f32 v241, v242, v243
v_cvt_pk_bf16_f32 v242, v244, v245
v_cvt_pk_bf16_f32 v243, v246, v247
s_add_u32 s77, s75, 8192
buffer_store_dwordx4 v[240:243], v16, s[44:47], s77 offen sc1
v_accvgpr_read_b32 v23, a140
v_accvgpr_read_b32 v248, a141
v_add_f32 v23, v23, v248
v_max_f32 v1, v1, v23
v_rcp_f32 v23, v23
s_mov_b32 s66, 0x5d800000
v_cmp_le_f32 vcc, s66, v1
s_lshl_b32 s67, s30, 2
s_cmp_lg_u64 vcc, 0
s_cselect_b32 s66, 1, 0
v_mov_b32 v248, s67
v_mov_b32 v249, s66
ds_write_b32 v248, v249
v_accvgpr_read_b32 v232, a80
v_accvgpr_read_b32 v233, a81
v_accvgpr_read_b32 v234, a82
v_accvgpr_read_b32 v235, a83
v_accvgpr_read_b32 v236, a84
v_accvgpr_read_b32 v237, a85
v_accvgpr_read_b32 v238, a86
v_accvgpr_read_b32 v239, a87
v_pk_mul_f32 v[232:233], v[232:233], v[22:23] op_sel_hi:[1,0]
v_pk_mul_f32 v[234:235], v[234:235], v[22:23] op_sel_hi:[1,0]
v_pk_mul_f32 v[236:237], v[236:237], v[22:23] op_sel_hi:[1,0]
v_pk_mul_f32 v[238:239], v[238:239], v[22:23] op_sel_hi:[1,0]
v_cvt_pk_bf16_f32 v232, v232, v233
v_cvt_pk_bf16_f32 v233, v234, v235
v_cvt_pk_bf16_f32 v234, v236, v237
v_cvt_pk_bf16_f32 v235, v238, v239
s_add_u32 s77, s75, 16384
buffer_store_dwordx4 v[232:235], v16, s[44:47], s77 offen sc1
v_accvgpr_read_b32 v240, a88
v_accvgpr_read_b32 v241, a89
v_accvgpr_read_b32 v242, a90
v_accvgpr_read_b32 v243, a91
v_accvgpr_read_b32 v244, a92
v_accvgpr_read_b32 v245, a93
v_accvgpr_read_b32 v246, a94
v_accvgpr_read_b32 v247, a95
v_pk_mul_f32 v[240:241], v[240:241], v[22:23] op_sel_hi:[1,0]
v_pk_mul_f32 v[242:243], v[242:243], v[22:23] op_sel_hi:[1,0]
v_pk_mul_f32 v[244:245], v[244:245], v[22:23] op_sel_hi:[1,0]
v_pk_mul_f32 v[246:247], v[246:247], v[22:23] op_sel_hi:[1,0]
v_cvt_pk_bf16_f32 v240, v240, v241
v_cvt_pk_bf16_f32 v241, v242, v243
v_cvt_pk_bf16_f32 v242, v244, v245
v_cvt_pk_bf16_f32 v243, v246, v247
s_add_u32 s77, s75, 24576
buffer_store_dwordx4 v[240:243], v16, s[44:47], s77 offen sc1
v_accvgpr_read_b32 v232, a96
v_accvgpr_read_b32 v233, a97
v_accvgpr_read_b32 v234, a98
v_accvgpr_read_b32 v235, a99
v_accvgpr_read_b32 v236, a100
v_accvgpr_read_b32 v237, a101
v_accvgpr_read_b32 v238, a102
v_accvgpr_read_b32 v239, a103
v_mul_f32 v23, v23, v10
v_pk_mul_f32 v[232:233], v[232:233], v[22:23] op_sel:[0,1]
v_pk_mul_f32 v[234:235], v[234:235], v[22:23] op_sel:[0,1]
v_pk_mul_f32 v[236:237], v[236:237], v[22:23] op_sel:[0,1]
v_pk_mul_f32 v[238:239], v[238:239], v[22:23] op_sel:[0,1]
v_cvt_pk_bf16_f32 v232, v232, v233
v_cvt_pk_bf16_f32 v233, v234, v235
v_cvt_pk_bf16_f32 v234, v236, v237
v_cvt_pk_bf16_f32 v235, v238, v239
s_add_u32 s77, s75, 4096
buffer_store_dwordx4 v[232:235], v16, s[44:47], s77 offen sc1
v_accvgpr_read_b32 v240, a104
v_accvgpr_read_b32 v241, a105
v_accvgpr_read_b32 v242, a106
v_accvgpr_read_b32 v243, a107
v_accvgpr_read_b32 v244, a108
v_accvgpr_read_b32 v245, a109
v_accvgpr_read_b32 v246, a110
v_accvgpr_read_b32 v247, a111
v_pk_mul_f32 v[240:241], v[240:241], v[22:23] op_sel:[0,1]
v_pk_mul_f32 v[242:243], v[242:243], v[22:23] op_sel:[0,1]
v_pk_mul_f32 v[244:245], v[244:245], v[22:23] op_sel:[0,1]
v_pk_mul_f32 v[246:247], v[246:247], v[22:23] op_sel:[0,1]
v_cvt_pk_bf16_f32 v240, v240, v241
v_cvt_pk_bf16_f32 v241, v242, v243
v_cvt_pk_bf16_f32 v242, v244, v245
v_cvt_pk_bf16_f32 v243, v246, v247
s_add_u32 s77, s75, 12288
buffer_store_dwordx4 v[240:243], v16, s[44:47], s77 offen sc1
v_mov_b32 v248, 0
s_waitcnt lgkmcnt(0)
s_barrier
ds_read_b128 v[248:251], v248
v_xor_b32 v188, 128, v18
v_xor_b32 v189, 160, v18
v_xor_b32 v190, 192, v18
ds_read_b64_tr_b16 a[144:145], v188 offset:32768
ds_read_b64_tr_b16 a[146:147], v188 offset:36864
ds_read_b64_tr_b16 a[148:149], v188 offset:40960
ds_read_b64_tr_b16 a[150:151], v188 offset:45056
ds_read_b64_tr_b16 a[152:153], v189 offset:32768
ds_read_b64_tr_b16 a[154:155], v189 offset:36864
ds_read_b64_tr_b16 a[156:157], v189 offset:40960
ds_read_b64_tr_b16 a[158:159], v189 offset:45056
ds_read_b64_tr_b16 a[160:161], v190 offset:32768
ds_read_b64_tr_b16 a[162:163], v190 offset:36864
ds_read_b64_tr_b16 a[164:165], v190 offset:40960
ds_read_b64_tr_b16 a[166:167], v190 offset:45056
v_xor_b32 v191, 224, v18
v_xor_b32 v184, 0, v18
v_xor_b32 v185, 32, v18
v_xor_b32 v186, 64, v18
v_xor_b32 v187, 96, v18
v_accvgpr_read_b32 v232, a112
v_accvgpr_read_b32 v233, a113
v_accvgpr_read_b32 v234, a114
v_accvgpr_read_b32 v235, a115
v_accvgpr_read_b32 v236, a116
v_accvgpr_read_b32 v237, a117
v_accvgpr_read_b32 v238, a118
v_accvgpr_read_b32 v239, a119
v_pk_mul_f32 v[232:233], v[232:233], v[22:23] op_sel:[0,1]
v_pk_mul_f32 v[234:235], v[234:235], v[22:23] op_sel:[0,1]
v_pk_mul_f32 v[236:237], v[236:237], v[22:23] op_sel:[0,1]
v_pk_mul_f32 v[238:239], v[238:239], v[22:23] op_sel:[0,1]
v_cvt_pk_bf16_f32 v232, v232, v233
v_cvt_pk_bf16_f32 v233, v234, v235
v_cvt_pk_bf16_f32 v234, v236, v237
v_cvt_pk_bf16_f32 v235, v238, v239
s_add_u32 s77, s75, 20480
buffer_store_dwordx4 v[232:235], v16, s[44:47], s77 offen sc1
v_accvgpr_read_b32 v240, a120
v_accvgpr_read_b32 v241, a121
v_accvgpr_read_b32 v242, a122
v_accvgpr_read_b32 v243, a123
v_accvgpr_read_b32 v244, a124
v_accvgpr_read_b32 v245, a125
v_accvgpr_read_b32 v246, a126
v_accvgpr_read_b32 v247, a127
v_pk_mul_f32 v[240:241], v[240:241], v[22:23] op_sel:[0,1]
v_pk_mul_f32 v[242:243], v[242:243], v[22:23] op_sel:[0,1]
v_pk_mul_f32 v[244:245], v[244:245], v[22:23] op_sel:[0,1]
v_pk_mul_f32 v[246:247], v[246:247], v[22:23] op_sel:[0,1]
v_cvt_pk_bf16_f32 v240, v240, v241
v_cvt_pk_bf16_f32 v241, v242, v243
v_cvt_pk_bf16_f32 v242, v244, v245
v_cvt_pk_bf16_f32 v243, v246, v247
s_add_u32 s77, s75, 28672
buffer_store_dwordx4 v[240:243], v16, s[44:47], s77 offen sc1
s_waitcnt lgkmcnt(12)
v_or3_b32 v248, v248, v249, v250
v_or_b32 v248, v248, v251
s_nop 0
v_readfirstlane_b32 s66, v248
s_nop 0
s_cmp_gt_u32 s66, s73
s_cbranch_scc1 L_fallback_11
s_cmp_eq_u32 s83, 0
s_cbranch_scc1 L_p5f0
s_waitcnt lgkmcnt(10)
s_waitcnt vmcnt(28)
v_mfma_f32_16x16x32_bf16 v[136:139], a[144:147], a[232:235], 0
s_waitcnt vmcnt(24)
s_waitcnt lgkmcnt(8)
s_add_u32 m0, s86, 98304
ds_read_b64_tr_b16 a[168:169], v191 offset:32768
v_xor_b32 v192, 0x10000, v184
v_mfma_f32_16x16x32_bf16 v[136:139], a[148:151], a[236:239], v[136:139]
s_add_u32 s64, s85, 524288
ds_read_b64_tr_b16 a[170:171], v191 offset:36864
v_xor_b32 v193, 0x10000, v185
v_mfma_f32_16x16x32_bf16 v[104:107], a[148:151], a[228:231], 0
buffer_load_dwordx4 v12, s[36:39], s64 offen lds
v_mfma_f32_16x16x32_bf16 v[104:107], a[144:147], a[224:227], v[104:107]
s_add_u32 m0, s86, 99328
s_add_u32 s64, s85, 532480
ds_read_b64_tr_b16 a[172:173], v191 offset:40960
v_xor_b32 v194, 0x10000, v186
v_mfma_f32_16x16x32_bf16 v[72:75], a[144:147], a[216:219], 0
buffer_load_dwordx4 v13, s[36:39], s64 offen lds
v_mfma_f32_16x16x32_bf16 v[72:75], a[148:151], a[220:223], v[72:75]
s_add_u32 m0, s86, 100352
ds_read_b64_tr_b16 a[174:175], v191 offset:45056
v_xor_b32 v195, 0x10000, v187
v_mfma_f32_16x16x32_bf16 v[40:43], a[148:151], a[212:215], 0
s_add_u32 s64, s85, 540672
ds_read_b64_tr_b16 a[176:177], v184 offset:32768
v_xor_b32 v196, 0x10000, v188
v_mfma_f32_16x16x32_bf16 v[40:43], a[144:147], a[208:211], v[40:43]
s_waitcnt lgkmcnt(5)
buffer_load_dwordx4 v12, s[36:39], s64 offen lds
v_mfma_f32_16x16x32_bf16 v[44:47], a[152:155], a[208:211], 0
s_add_u32 m0, s86, 101376
s_add_u32 s64, s85, 548864
ds_read_b64_tr_b16 a[178:179], v184 offset:36864
v_xor_b32 v197, 0x10000, v189
v_mfma_f32_16x16x32_bf16 v[44:47], a[156:159], a[212:215], v[44:47]
buffer_load_dwordx4 v13, s[36:39], s64 offen lds
v_mfma_f32_16x16x32_bf16 v[76:79], a[156:159], a[220:223], 0
s_add_u32 m0, s86, 102400
ds_read_b64_tr_b16 a[180:181], v184 offset:40960
v_xor_b32 v198, 0x10000, v190
v_mfma_f32_16x16x32_bf16 v[76:79], a[152:155], a[216:219], v[76:79]
s_add_u32 s64, s85, 557056
ds_read_b64_tr_b16 a[182:183], v184 offset:45056
v_xor_b32 v199, 0x10000, v191
v_mfma_f32_16x16x32_bf16 v[108:111], a[152:155], a[224:227], 0
buffer_load_dwordx4 v12, s[36:39], s64 offen lds
v_mfma_f32_16x16x32_bf16 v[108:111], a[156:159], a[228:231], v[108:111]
s_add_u32 m0, s86, 103424
s_add_u32 s64, s85, 565248
ds_read_b64_tr_b16 a[184:185], v185 offset:32768
v_mfma_f32_16x16x32_bf16 v[140:143], a[156:159], a[236:239], 0
buffer_load_dwordx4 v13, s[36:39], s64 offen lds
v_mfma_f32_16x16x32_bf16 v[140:143], a[152:155], a[232:235], v[140:143]
s_add_u32 m0, s86, 104448
s_add_u32 s64, s85, 573440
ds_read_b64_tr_b16 a[186:187], v185 offset:36864
v_mfma_f32_16x16x32_bf16 v[144:147], a[160:163], a[232:235], 0
s_and_b32 s68, s82, 3
s_lshl_b32 s68, s68, 11
ds_read_b64_tr_b16 a[188:189], v185 offset:40960
v_mfma_f32_16x16x32_bf16 v[144:147], a[164:167], a[236:239], v[144:147]
s_branch L_po20
L_pg20:
s_branch L_pg24
L_po20:
s_add_u32 s76, s86, s68
buffer_load_dwordx4 v12, s[36:39], s64 offen lds
v_mfma_f32_16x16x32_bf16 v[112:115], a[164:167], a[228:231], 0
s_and_b32 s71, s31, 4
s_lshl_b32 s71, s71, 5
s_add_u32 m0, s86, 105472
s_add_u32 s64, s85, 581632
ds_read_b64_tr_b16 a[190:191], v185 offset:45056
v_mfma_f32_16x16x32_bf16 v[112:115], a[160:163], a[224:227], v[112:115]
s_add_u32 s71, s71, s79
buffer_load_dwordx4 v13, s[36:39], s64 offen lds
v_mfma_f32_16x16x32_bf16 v[80:83], a[160:163], a[216:219], 0
s_add_u32 s71, s71, 4096
s_add_u32 s72, s80, 4096
ds_read_b64_tr_b16 a[192:193], v186 offset:32768
v_mfma_f32_16x16x32_bf16 v[80:83], a[164:167], a[220:223], v[80:83]
s_lshr_b32 s69, s87, 8
s_lshr_b32 s67, s82, 1
s_add_u32 s65, s84, 65536
ds_read_b64_tr_b16 a[194:195], v186 offset:36864
v_mfma_f32_16x16x32_bf16 v[48:51], a[164:167], a[212:215], 0
s_xor_b32 s69, s69, s67
buffer_load_dwordx4 a[32:35], v14, s[44:47], s65 offen offset:0 sc1
v_mfma_f32_16x16x32_bf16 v[48:51], a[160:163], a[208:211], v[48:51]
s_waitcnt lgkmcnt(4)
s_and_b32 s69, s69, 2
s_lshl_b32 s69, s69, 15
ds_read_b64_tr_b16 a[196:197], v186 offset:40960
v_mfma_f32_16x16x32_bf16 v[52:55], a[168:171], a[208:211], 0
s_add_u32 s68, s68, s69
buffer_load_dwordx4 a[40:43], v14, s[44:47], s65 offen offset:1024 sc1
v_mfma_f32_16x16x32_bf16 v[52:55], a[172:175], a[212:215], v[52:55]
ds_read_b64_tr_b16 a[198:199], v186 offset:45056
v_mfma_f32_16x16x32_bf16 v[84:87], a[172:175], a[220:223], 0
ds_read_b64_tr_b16 a[200:201], v187 offset:32768
v_mfma_f32_16x16x32_bf16 v[84:87], a[168:171], a[216:219], v[84:87]
buffer_load_dwordx4 a[48:51], v15, s[44:47], s65 offen offset:0 sc1
v_mfma_f32_16x16x32_bf16 v[116:119], a[168:171], a[224:227], 0
ds_read_b64_tr_b16 a[202:203], v187 offset:36864
v_mfma_f32_16x16x32_bf16 v[116:119], a[172:175], a[228:231], v[116:119]
buffer_load_dwordx4 a[56:59], v15, s[44:47], s65 offen offset:1024 sc1
v_mfma_f32_16x16x32_bf16 v[148:151], a[172:175], a[236:239], 0
ds_read_b64_tr_b16 a[204:205], v187 offset:40960
v_mfma_f32_16x16x32_bf16 v[148:151], a[168:171], a[232:235], v[148:151]
s_add_u32 s65, s84, 73728
ds_read_b64_tr_b16 a[206:207], v187 offset:45056
v_mfma_f32_16x16x32_bf16 v[120:123], a[176:179], a[232:235], 0
buffer_load_dwordx4 a[36:39], v14, s[44:47], s65 offen offset:0 sc1
v_mfma_f32_16x16x32_bf16 v[120:123], a[180:183], a[236:239], v[120:123]
v_mfma_f32_16x16x32_bf16 v[88:91], a[180:183], a[228:231], 0
buffer_load_dwordx4 a[44:47], v14, s[44:47], s65 offen offset:1024 sc1
v_mfma_f32_16x16x32_bf16 v[88:91], a[176:179], a[224:227], v[88:91]
v_mfma_f32_16x16x32_bf16 v[56:59], a[176:179], a[216:219], 0
v_mfma_f32_16x16x32_bf16 v[56:59], a[180:183], a[220:223], v[56:59]
buffer_load_dwordx4 a[52:55], v15, s[44:47], s65 offen offset:0 sc1
v_mfma_f32_16x16x32_bf16 v[24:27], a[180:183], a[212:215], 0
v_mfma_f32_16x16x32_bf16 v[24:27], a[176:179], a[208:211], v[24:27]
buffer_load_dwordx4 a[60:63], v15, s[44:47], s65 offen offset:1024 sc1
v_mfma_f32_16x16x32_bf16 v[28:31], a[184:187], a[208:211], 0
s_waitcnt lgkmcnt(0)
v_mfma_f32_16x16x32_bf16 v[28:31], a[188:191], a[212:215], v[28:31]
v_mfma_f32_16x16x32_bf16 v[60:63], a[188:191], a[220:223], 0
buffer_load_dword v19, off, s[52:55], s72 sc1
v_mfma_f32_16x16x32_bf16 v[60:63], a[184:187], a[216:219], v[60:63]
s_add_u32 s85, s85, 2883584
s_lshl3_add_u32 s85, s68, s85
s_waitcnt vmcnt(24) lgkmcnt(0)
s_barrier
v_mfma_f32_16x16x32_bf16 v[92:95], a[184:187], a[224:227], 0
ds_read_b64_tr_b16 a[144:145], v196 offset:0
v_mfma_f32_16x16x32_bf16 v[92:95], a[188:191], a[228:231], v[92:95]
ds_read_b64_tr_b16 a[146:147], v196 offset:4096
v_mfma_f32_16x16x32_bf16 v[124:127], a[188:191], a[236:239], 0
s_xor_b32 m0, s76, 131072
ds_read_b64_tr_b16 a[148:149], v196 offset:8192
v_mfma_f32_16x16x32_bf16 v[124:127], a[184:187], a[232:235], v[124:127]
s_xor_b32 s64, s85, 0
ds_read_b64_tr_b16 a[150:151], v196 offset:12288
v_mfma_f32_16x16x32_bf16 v[128:131], a[192:195], a[232:235], 0
buffer_load_dwordx4 v12, s[40:43], s64 offen lds
v_mfma_f32_16x16x32_bf16 v[128:131], a[196:199], a[236:239], v[128:131]
s_xor_b32 m0, s76, 132096
ds_read_b64_tr_b16 a[152:153], v197 offset:0
v_mfma_f32_16x16x32_bf16 v[96:99], a[196:199], a[228:231], 0
s_xor_b32 s64, s85, 8192
ds_read_b64_tr_b16 a[154:155], v197 offset:4096
v_mfma_f32_16x16x32_bf16 v[96:99], a[192:195], a[224:227], v[96:99]
buffer_load_dwordx4 v13, s[40:43], s64 offen lds
v_mfma_f32_16x16x32_bf16 v[64:67], a[192:195], a[216:219], 0
s_xor_b32 m0, s76, 133120
ds_read_b64_tr_b16 a[156:157], v197 offset:8192
v_mfma_f32_16x16x32_bf16 v[64:67], a[196:199], a[220:223], v[64:67]
s_xor_b32 s64, s85, 16384
ds_read_b64_tr_b16 a[158:159], v197 offset:12288
v_mfma_f32_16x16x32_bf16 v[32:35], a[196:199], a[212:215], 0
buffer_load_dwordx4 v12, s[40:43], s64 offen lds
v_mfma_f32_16x16x32_bf16 v[32:35], a[192:195], a[208:211], v[32:35]
s_xor_b32 m0, s76, 134144
ds_read_b64_tr_b16 a[160:161], v198 offset:0
v_mfma_f32_16x16x32_bf16 v[36:39], a[200:203], a[208:211], 0
s_xor_b32 s64, s85, 24576
ds_read_b64_tr_b16 a[162:163], v198 offset:4096
v_mfma_f32_16x16x32_bf16 v[36:39], a[204:207], a[212:215], v[36:39]
buffer_load_dwordx4 v13, s[40:43], s64 offen lds
v_mfma_f32_16x16x32_bf16 v[68:71], a[204:207], a[220:223], 0
s_xor_b32 m0, s76, 135168
ds_read_b64_tr_b16 a[164:165], v198 offset:8192
v_mfma_f32_16x16x32_bf16 v[68:71], a[200:203], a[216:219], v[68:71]
s_xor_b32 s64, s85, 32768
ds_read_b64_tr_b16 a[166:167], v198 offset:12288
v_mfma_f32_16x16x32_bf16 v[100:103], a[200:203], a[224:227], 0
buffer_load_dwordx4 v12, s[40:43], s64 offen lds
v_mfma_f32_16x16x32_bf16 v[100:103], a[204:207], a[228:231], v[100:103]
v_mfma_f32_16x16x32_bf16 v[132:135], a[204:207], a[236:239], 0
v_mfma_f32_16x16x32_bf16 v[132:135], a[200:203], a[232:235], v[132:135]
s_waitcnt lgkmcnt(3)
v_mfma_f32_16x16x32_bf16 v[136:139], a[144:147], v[176:179], v[136:139]
s_waitcnt vmcnt(5)
v_readfirstlane_b32 vcc_lo, v19
s_nop 0
s_cmp_lt_u32 vcc_lo, 8
s_cbranch_scc1 L_spin_2016
L_spinbk_2017:
s_sub_u32 s84, s84, 688128
s_add_u32 s84, s84, s69
v_mfma_f32_16x16x32_bf16 v[136:139], a[148:151], v[180:183], v[136:139]
s_xor_b32 m0, s76, 136192
s_xor_b32 s64, s85, 40960
ds_read_b64_tr_b16 a[168:169], v199 offset:0
v_mfma_f32_16x16x32_bf16 v[104:107], a[148:151], v[172:175], v[104:107]
buffer_load_dwordx4 v13, s[40:43], s64 offen lds
v_mfma_f32_16x16x32_bf16 v[104:107], a[144:147], v[168:171], v[104:107]
s_xor_b32 m0, s76, 137216
ds_read_b64_tr_b16 a[170:171], v199 offset:4096
v_mfma_f32_16x16x32_bf16 v[72:75], a[144:147], v[160:163], v[72:75]
s_xor_b32 s64, s85, 49152
ds_read_b64_tr_b16 a[172:173], v199 offset:8192
v_mfma_f32_16x16x32_bf16 v[72:75], a[148:151], v[164:167], v[72:75]
buffer_load_dwordx4 v12, s[40:43], s64 offen lds
v_mfma_f32_16x16x32_bf16 v[40:43], a[148:151], v[156:159], v[40:43]
ds_read_b64_tr_b16 a[174:175], v199 offset:12288
v_mfma_f32_16x16x32_bf16 v[40:43], a[144:147], v[152:155], v[40:43]
s_xor_b32 m0, s76, 138240
ds_read_b64_tr_b16 a[176:177], v192 offset:0
v_mfma_f32_16x16x32_bf16 v[44:47], a[152:155], v[152:155], v[44:47]
s_xor_b32 s64, s85, 57344
ds_read_b64_tr_b16 a[178:179], v192 offset:4096
v_mfma_f32_16x16x32_bf16 v[44:47], a[156:159], v[156:159], v[44:47]
buffer_load_dwordx4 v13, s[40:43], s64 offen lds
v_mfma_f32_16x16x32_bf16 v[76:79], a[156:159], v[164:167], v[76:79]
ds_read_b64_tr_b16 a[180:181], v192 offset:8192
v_mfma_f32_16x16x32_bf16 v[76:79], a[152:155], v[160:163], v[76:79]
s_xor_b32 s65, s84, 0
ds_read_b64_tr_b16 a[182:183], v192 offset:12288
v_mfma_f32_16x16x32_bf16 v[108:111], a[152:155], v[168:171], v[108:111]
buffer_load_dwordx4 a[208:211], v14, s[44:47], s65 offen offset:0 sc1
v_mfma_f32_16x16x32_bf16 v[108:111], a[156:159], v[172:175], v[108:111]
ds_read_b64_tr_b16 a[184:185], v193 offset:0
v_mfma_f32_16x16x32_bf16 v[140:143], a[156:159], v[180:183], v[140:143]
ds_read_b64_tr_b16 a[186:187], v193 offset:4096
v_mfma_f32_16x16x32_bf16 v[140:143], a[152:155], v[176:179], v[140:143]
s_waitcnt lgkmcnt(5)
ds_read_b64_tr_b16 a[188:189], v193 offset:8192
v_mfma_f32_16x16x32_bf16 v[144:147], a[160:163], v[176:179], v[144:147]
buffer_load_dwordx4 a[216:219], v14, s[44:47], s65 offen offset:1024 sc1
v_mfma_f32_16x16x32_bf16 v[144:147], a[164:167], v[180:183], v[144:147]
ds_read_b64_tr_b16 a[190:191], v193 offset:12288
v_mfma_f32_16x16x32_bf16 v[112:115], a[164:167], v[172:175], v[112:115]
ds_read_b64_tr_b16 a[192:193], v194 offset:0
v_mfma_f32_16x16x32_bf16 v[112:115], a[160:163], v[168:171], v[112:115]
ds_read_b64_tr_b16 a[194:195], v194 offset:4096
v_mfma_f32_16x16x32_bf16 v[80:83], a[160:163], v[160:163], v[80:83]
buffer_load_dwordx4 a[224:227], v15, s[44:47], s65 offen offset:0 sc1
v_mfma_f32_16x16x32_bf16 v[80:83], a[164:167], v[164:167], v[80:83]
ds_read_b64_tr_b16 a[196:197], v194 offset:8192
v_mfma_f32_16x16x32_bf16 v[48:51], a[164:167], v[156:159], v[48:51]
ds_read_b64_tr_b16 a[198:199], v194 offset:12288
v_mfma_f32_16x16x32_bf16 v[48:51], a[160:163], v[152:155], v[48:51]
buffer_load_dwordx4 a[232:235], v15, s[44:47], s65 offen offset:1024 sc1
v_mfma_f32_16x16x32_bf16 v[52:55], a[168:171], v[152:155], v[52:55]
v_mfma_f32_16x16x32_bf16 v[52:55], a[172:175], v[156:159], v[52:55]
v_mfma_f32_16x16x32_bf16 v[84:87], a[172:175], v[164:167], v[84:87]
s_xor_b32 s65, s84, 8192
ds_read_b64_tr_b16 a[200:201], v195 offset:0
v_mfma_f32_16x16x32_bf16 v[84:87], a[168:171], v[160:163], v[84:87]
buffer_load_dwordx4 a[212:215], v14, s[44:47], s65 offen offset:0 sc1
v_mfma_f32_16x16x32_bf16 v[116:119], a[168:171], v[168:171], v[116:119]
ds_read_b64_tr_b16 a[202:203], v195 offset:4096
v_mfma_f32_16x16x32_bf16 v[116:119], a[172:175], v[172:175], v[116:119]
ds_read_b64_tr_b16 a[204:205], v195 offset:8192
v_mfma_f32_16x16x32_bf16 v[148:151], a[172:175], v[180:183], v[148:151]
ds_read_b64_tr_b16 a[206:207], v195 offset:12288
v_mfma_f32_16x16x32_bf16 v[148:151], a[168:171], v[176:179], v[148:151]
s_waitcnt lgkmcnt(4)
s_lshl_b32 s66, s30, 30
buffer_load_dwordx4 a[220:223], v14, s[44:47], s65 offen offset:1024 sc1
v_mfma_f32_16x16x32_bf16 v[120:123], a[176:179], v[176:179], v[120:123]
v_lshl_add_u32 v1, v0, 24, s66
v_mfma_f32_16x16x32_bf16 v[120:123], a[180:183], v[180:183], v[120:123]
v_mfma_f32_16x16x32_bf16 v[88:91], a[180:183], v[172:175], v[88:91]
buffer_load_dwordx4 a[228:231], v15, s[44:47], s65 offen offset:0 sc1
v_mfma_f32_16x16x32_bf16 v[88:91], a[176:179], v[168:171], v[88:91]
v_mfma_f32_16x16x32_bf16 v[56:59], a[176:179], v[160:163], v[56:59]
v_mfma_f32_16x16x32_bf16 v[56:59], a[180:183], v[164:167], v[56:59]
v_mfma_f32_16x16x32_bf16 v[24:27], a[180:183], v[156:159], v[24:27]
buffer_load_dwordx4 a[236:239], v15, s[44:47], s65 offen offset:1024 sc1
v_mfma_f32_16x16x32_bf16 v[24:27], a[176:179], v[152:155], v[24:27]
v_mfma_f32_16x16x32_bf16 v[28:31], a[184:187], v[152:155], v[28:31]
v_mfma_f32_16x16x32_bf16 v[28:31], a[188:191], v[156:159], v[28:31]
v_mfma_f32_16x16x32_bf16 v[60:63], a[188:191], v[164:167], v[60:63]
v_mfma_f32_16x16x32_bf16 v[60:63], a[184:187], v[160:163], v[60:63]
s_waitcnt lgkmcnt(0)
s_barrier
v_mfma_f32_16x16x32_bf16 v[92:95], a[184:187], v[168:171], v[92:95]
s_mov_b64 exec, 1
buffer_atomic_add a251, v1, s[52:55], s71 offen offset:0 sc1
s_mov_b64 exec, -1
v_mfma_f32_16x16x32_bf16 v[92:95], a[188:191], v[172:175], v[92:95]
ds_read_b64_tr_b16 a[144:145], v188 offset:0
v_mfma_f32_16x16x32_bf16 v[124:127], a[188:191], v[180:183], v[124:127]
s_xor_b32 m0, s76, 32768
ds_read_b64_tr_b16 a[146:147], v188 offset:4096
v_mfma_f32_16x16x32_bf16 v[124:127], a[184:187], v[176:179], v[124:127]
s_xor_b32 s64, s85, 262144
ds_read_b64_tr_b16 a[148:149], v188 offset:8192
v_mfma_f32_16x16x32_bf16 v[128:131], a[192:195], v[176:179], v[128:131]
buffer_load_dwordx4 v12, s[40:43], s64 offen lds
v_mfma_f32_16x16x32_bf16 v[128:131], a[196:199], v[180:183], v[128:131]
s_xor_b32 m0, s76, 33792
ds_read_b64_tr_b16 a[150:151], v188 offset:12288
v_mfma_f32_16x16x32_bf16 v[96:99], a[196:199], v[172:175], v[96:99]
s_xor_b32 s64, s85, 270336
ds_read_b64_tr_b16 a[152:153], v189 offset:0
v_mfma_f32_16x16x32_bf16 v[96:99], a[192:195], v[168:171], v[96:99]
buffer_load_dwordx4 v13, s[40:43], s64 offen lds
v_mfma_f32_16x16x32_bf16 v[64:67], a[192:195], v[160:163], v[64:67]
s_xor_b32 m0, s76, 34816
ds_read_b64_tr_b16 a[154:155], v189 offset:4096
v_mfma_f32_16x16x32_bf16 v[64:67], a[196:199], v[164:167], v[64:67]
s_xor_b32 s64, s85, 278528
ds_read_b64_tr_b16 a[156:157], v189 offset:8192
v_mfma_f32_16x16x32_bf16 v[32:35], a[196:199], v[156:159], v[32:35]
buffer_load_dwordx4 v12, s[40:43], s64 offen lds
v_mfma_f32_16x16x32_bf16 v[32:35], a[192:195], v[152:155], v[32:35]
s_xor_b32 m0, s76, 35840
ds_read_b64_tr_b16 a[158:159], v189 offset:12288
v_mfma_f32_16x16x32_bf16 v[36:39], a[200:203], v[152:155], v[36:39]
s_xor_b32 s64, s85, 286720
ds_read_b64_tr_b16 a[160:161], v190 offset:0
v_mfma_f32_16x16x32_bf16 v[36:39], a[204:207], v[156:159], v[36:39]
buffer_load_dwordx4 v13, s[40:43], s64 offen lds
v_mfma_f32_16x16x32_bf16 v[68:71], a[204:207], v[164:167], v[68:71]
s_xor_b32 m0, s76, 36864
ds_read_b64_tr_b16 a[162:163], v190 offset:4096
v_mfma_f32_16x16x32_bf16 v[68:71], a[200:203], v[160:163], v[68:71]
s_xor_b32 s64, s85, 294912
ds_read_b64_tr_b16 a[164:165], v190 offset:8192
v_mfma_f32_16x16x32_bf16 v[100:103], a[200:203], v[168:171], v[100:103]
buffer_load_dwordx4 v12, s[40:43], s64 offen lds
v_mfma_f32_16x16x32_bf16 v[100:103], a[204:207], v[172:175], v[100:103]
ds_read_b64_tr_b16 a[166:167], v190 offset:12288
v_mfma_f32_16x16x32_bf16 v[132:135], a[204:207], v[180:183], v[132:135]
v_mfma_f32_16x16x32_bf16 v[132:135], a[200:203], v[176:179], v[132:135]
s_waitcnt lgkmcnt(4)
v_mfma_f32_16x16x32_bf16 v[136:139], a[144:147], a[56:59], v[136:139]
s_xor_b32 m0, s76, 37888
ds_read_b64_tr_b16 a[168:169], v191 offset:0
v_mfma_f32_16x16x32_bf16 v[136:139], a[148:151], a[60:63], v[136:139]
s_xor_b32 s64, s85, 303104
ds_read_b64_tr_b16 a[170:171], v191 offset:4096
v_mfma_f32_16x16x32_bf16 v[104:107], a[148:151], a[52:55], v[104:107]
buffer_load_dwordx4 v13, s[40:43], s64 offen lds
v_mfma_f32_16x16x32_bf16 v[104:107], a[144:147], a[48:51], v[104:107]
s_xor_b32 m0, s76, 38912
ds_read_b64_tr_b16 a[172:173], v191 offset:8192
v_mfma_f32_16x16x32_bf16 v[72:75], a[144:147], a[40:43], v[72:75]
s_xor_b32 s64, s85, 311296
ds_read_b64_tr_b16 a[174:175], v191 offset:12288
v_mfma_f32_16x16x32_bf16 v[72:75], a[148:151], a[44:47], v[72:75]
buffer_load_dwordx4 v12, s[40:43], s64 offen lds
v_mfma_f32_16x16x32_bf16 v[40:43], a[148:151], a[36:39], v[40:43]
ds_read_b64_tr_b16 a[176:177], v184 offset:0
v_mfma_f32_16x16x32_bf16 v[40:43], a[144:147], a[32:35], v[40:43]
s_xor_b32 m0, s76, 39936
ds_read_b64_tr_b16 a[178:179], v184 offset:4096
v_mfma_f32_16x16x32_bf16 v[44:47], a[152:155], a[32:35], v[44:47]
s_xor_b32 s64, s85, 319488
ds_read_b64_tr_b16 a[180:181], v184 offset:8192
v_mfma_f32_16x16x32_bf16 v[44:47], a[156:159], a[36:39], v[44:47]
buffer_load_dwordx4 v13, s[40:43], s64 offen lds
v_mfma_f32_16x16x32_bf16 v[76:79], a[156:159], a[44:47], v[76:79]
ds_read_b64_tr_b16 a[182:183], v184 offset:12288
v_mfma_f32_16x16x32_bf16 v[76:79], a[152:155], a[40:43], v[76:79]
s_xor_b32 s65, s84, 32768
ds_read_b64_tr_b16 a[184:185], v185 offset:0
v_mfma_f32_16x16x32_bf16 v[108:111], a[152:155], a[48:51], v[108:111]
buffer_load_dwordx4 v[152:155], v14, s[44:47], s65 offen offset:0 sc1
v_mfma_f32_16x16x32_bf16 v[108:111], a[156:159], a[52:55], v[108:111]
ds_read_b64_tr_b16 a[186:187], v185 offset:4096
v_mfma_f32_16x16x32_bf16 v[140:143], a[156:159], a[60:63], v[140:143]
ds_read_b64_tr_b16 a[188:189], v185 offset:8192
v_mfma_f32_16x16x32_bf16 v[140:143], a[152:155], a[56:59], v[140:143]
s_waitcnt lgkmcnt(5)
ds_read_b64_tr_b16 a[190:191], v185 offset:12288
v_mfma_f32_16x16x32_bf16 v[144:147], a[160:163], a[56:59], v[144:147]
buffer_load_dwordx4 v[160:163], v14, s[44:47], s65 offen offset:1024 sc1
v_mfma_f32_16x16x32_bf16 v[144:147], a[164:167], a[60:63], v[144:147]
v_mfma_f32_16x16x32_bf16 v[112:115], a[164:167], a[52:55], v[112:115]
ds_read_b64_tr_b16 a[192:193], v186 offset:0
v_mfma_f32_16x16x32_bf16 v[112:115], a[160:163], a[48:51], v[112:115]
ds_read_b64_tr_b16 a[194:195], v186 offset:4096
v_mfma_f32_16x16x32_bf16 v[80:83], a[160:163], a[40:43], v[80:83]
buffer_load_dwordx4 v[168:171], v15, s[44:47], s65 offen offset:0 sc1
v_mfma_f32_16x16x32_bf16 v[80:83], a[164:167], a[44:47], v[80:83]
ds_read_b64_tr_b16 a[196:197], v186 offset:8192
v_mfma_f32_16x16x32_bf16 v[48:51], a[164:167], a[36:39], v[48:51]
ds_read_b64_tr_b16 a[198:199], v186 offset:12288
v_mfma_f32_16x16x32_bf16 v[48:51], a[160:163], a[32:35], v[48:51]
buffer_load_dwordx4 v[176:179], v15, s[44:47], s65 offen offset:1024 sc1
v_mfma_f32_16x16x32_bf16 v[52:55], a[168:171], a[32:35], v[52:55]
v_mfma_f32_16x16x32_bf16 v[52:55], a[172:175], a[36:39], v[52:55]
v_mfma_f32_16x16x32_bf16 v[84:87], a[172:175], a[44:47], v[84:87]
s_xor_b32 s65, s84, 40960
ds_read_b64_tr_b16 a[200:201], v187 offset:0
v_mfma_f32_16x16x32_bf16 v[84:87], a[168:171], a[40:43], v[84:87]
buffer_load_dwordx4 v[156:159], v14, s[44:47], s65 offen offset:0 sc1
v_mfma_f32_16x16x32_bf16 v[116:119], a[168:171], a[48:51], v[116:119]
ds_read_b64_tr_b16 a[202:203], v187 offset:4096
v_mfma_f32_16x16x32_bf16 v[116:119], a[172:175], a[52:55], v[116:119]
ds_read_b64_tr_b16 a[204:205], v187 offset:8192
v_mfma_f32_16x16x32_bf16 v[148:151], a[172:175], a[60:63], v[148:151]
ds_read_b64_tr_b16 a[206:207], v187 offset:12288
v_mfma_f32_16x16x32_bf16 v[148:151], a[168:171], a[56:59], v[148:151]
buffer_load_dwordx4 v[164:167], v14, s[44:47], s65 offen offset:1024 sc1
v_mfma_f32_16x16x32_bf16 v[120:123], a[176:179], a[56:59], v[120:123]
s_waitcnt lgkmcnt(4)
v_mfma_f32_16x16x32_bf16 v[120:123], a[180:183], a[60:63], v[120:123]
v_mfma_f32_16x16x32_bf16 v[88:91], a[180:183], a[52:55], v[88:91]
buffer_load_dwordx4 v[172:175], v15, s[44:47], s65 offen offset:0 sc1
v_mfma_f32_16x16x32_bf16 v[88:91], a[176:179], a[48:51], v[88:91]
v_mfma_f32_16x16x32_bf16 v[56:59], a[176:179], a[40:43], v[56:59]
v_mfma_f32_16x16x32_bf16 v[56:59], a[180:183], a[44:47], v[56:59]
v_mfma_f32_16x16x32_bf16 v[24:27], a[180:183], a[36:39], v[24:27]
buffer_load_dwordx4 v[180:183], v15, s[44:47], s65 offen offset:1024 sc1
v_mfma_f32_16x16x32_bf16 v[24:27], a[176:179], a[32:35], v[24:27]
v_mfma_f32_16x16x32_bf16 v[28:31], a[184:187], a[32:35], v[28:31]
v_mfma_f32_16x16x32_bf16 v[28:31], a[188:191], a[36:39], v[28:31]
v_mfma_f32_16x16x32_bf16 v[60:63], a[188:191], a[44:47], v[60:63]
v_mfma_f32_16x16x32_bf16 v[60:63], a[184:187], a[40:43], v[60:63]
s_waitcnt vmcnt(25)
s_barrier
v_mfma_f32_16x16x32_bf16 v[92:95], a[184:187], a[48:51], v[92:95]
ds_read_b64_tr_b16 a[144:145], v188 offset:32768
v_mfma_f32_16x16x32_bf16 v[92:95], a[188:191], a[52:55], v[92:95]
ds_read_b64_tr_b16 a[146:147], v188 offset:36864
v_mfma_f32_16x16x32_bf16 v[124:127], a[188:191], a[60:63], v[124:127]
s_xor_b32 m0, s76, 65536
ds_read_b64_tr_b16 a[148:149], v188 offset:40960
v_mfma_f32_16x16x32_bf16 v[124:127], a[184:187], a[56:59], v[124:127]
s_xor_b32 s64, s85, 524288
ds_read_b64_tr_b16 a[150:151], v188 offset:45056
v_mfma_f32_16x16x32_bf16 v[128:131], a[192:195], a[56:59], v[128:131]
buffer_load_dwordx4 v12, s[40:43], s64 offen lds
v_mfma_f32_16x16x32_bf16 v[128:131], a[196:199], a[60:63], v[128:131]
s_xor_b32 m0, s76, 66560
ds_read_b64_tr_b16 a[152:153], v189 offset:32768
v_mfma_f32_16x16x32_bf16 v[96:99], a[196:199], a[52:55], v[96:99]
s_xor_b32 s64, s85, 532480
ds_read_b64_tr_b16 a[154:155], v189 offset:36864
v_mfma_f32_16x16x32_bf16 v[96:99], a[192:195], a[48:51], v[96:99]
buffer_load_dwordx4 v13, s[40:43], s64 offen lds
v_mfma_f32_16x16x32_bf16 v[64:67], a[192:195], a[40:43], v[64:67]
s_xor_b32 m0, s76, 67584
ds_read_b64_tr_b16 a[156:157], v189 offset:40960
v_mfma_f32_16x16x32_bf16 v[64:67], a[196:199], a[44:47], v[64:67]
s_xor_b32 s64, s85, 540672
ds_read_b64_tr_b16 a[158:159], v189 offset:45056
v_mfma_f32_16x16x32_bf16 v[32:35], a[196:199], a[36:39], v[32:35]
buffer_load_dwordx4 v12, s[40:43], s64 offen lds
v_mfma_f32_16x16x32_bf16 v[32:35], a[192:195], a[32:35], v[32:35]
s_waitcnt lgkmcnt(4)
s_xor_b32 m0, s76, 68608
ds_read_b64_tr_b16 a[160:161], v190 offset:32768
v_mfma_f32_16x16x32_bf16 v[36:39], a[200:203], a[32:35], v[36:39]
s_xor_b32 s64, s85, 548864
ds_read_b64_tr_b16 a[162:163], v190 offset:36864
v_mfma_f32_16x16x32_bf16 v[36:39], a[204:207], a[36:39], v[36:39]
buffer_load_dwordx4 v13, s[40:43], s64 offen lds
v_mfma_f32_16x16x32_bf16 v[68:71], a[204:207], a[44:47], v[68:71]
s_xor_b32 m0, s76, 69632
ds_read_b64_tr_b16 a[164:165], v190 offset:40960
v_mfma_f32_16x16x32_bf16 v[68:71], a[200:203], a[40:43], v[68:71]
s_xor_b32 s64, s85, 557056
ds_read_b64_tr_b16 a[166:167], v190 offset:45056
v_mfma_f32_16x16x32_bf16 v[100:103], a[200:203], a[48:51], v[100:103]
buffer_load_dwordx4 v12, s[40:43], s64 offen lds
v_mfma_f32_16x16x32_bf16 v[100:103], a[204:207], a[52:55], v[100:103]
s_mov_b32 s70, 3
s_mov_b32 s73, 2
v_mfma_f32_16x16x32_bf16 v[132:135], a[204:207], a[60:63], v[132:135]
v_mfma_f32_16x16x32_bf16 v[132:135], a[200:203], a[56:59], v[132:135]
s_branch L_p5join
.p2align 12
L_pg21:
s_branch L_pg25
L_p5join:
L_p5loop:
s_waitcnt lgkmcnt(10)
s_waitcnt vmcnt(19)
v_mfma_f32_16x16x32_bf16 v[136:139], a[144:147], a[232:235], v[136:139]
s_waitcnt vmcnt(15)
s_waitcnt lgkmcnt(8)
s_xor_b32 m0, s76, 70656
s_xor_b32 s64, s85, 565248
ds_read_b64_tr_b16 a[168:169], v191 offset:32768
v_mfma_f32_16x16x32_bf16 v[136:139], a[148:151], a[236:239], v[136:139]
buffer_load_dwordx4 v13, s[40:43], s64 offen lds
v_mfma_f32_16x16x32_bf16 v[104:107], a[148:151], a[228:231], v[104:107]
ds_read_b64_tr_b16 a[170:171], v191 offset:36864
v_mfma_f32_16x16x32_bf16 v[104:107], a[144:147], a[224:227], v[104:107]
s_xor_b32 m0, s76, 71680
ds_read_b64_tr_b16 a[172:173], v191 offset:40960
v_mfma_f32_16x16x32_bf16 v[72:75], a[144:147], a[216:219], v[72:75]
s_xor_b32 s64, s85, 573440
ds_read_b64_tr_b16 a[174:175], v191 offset:45056
v_mfma_f32_16x16x32_bf16 v[72:75], a[148:151], a[220:223], v[72:75]
buffer_load_dwordx4 v12, s[40:43], s64 offen lds
v_mfma_f32_16x16x32_bf16 v[40:43], a[148:151], a[212:215], v[40:43]
ds_read_b64_tr_b16 a[176:177], v184 offset:32768
v_mfma_f32_16x16x32_bf16 v[40:43], a[144:147], a[208:211], v[40:43]
s_waitcnt lgkmcnt(5)
s_xor_b32 m0, s76, 72704
ds_read_b64_tr_b16 a[178:179], v184 offset:36864
v_mfma_f32_16x16x32_bf16 v[44:47], a[152:155], a[208:211], v[44:47]
s_xor_b32 s64, s85, 581632
ds_read_b64_tr_b16 a[180:181], v184 offset:40960
v_mfma_f32_16x16x32_bf16 v[44:47], a[156:159], a[212:215], v[44:47]
buffer_load_dwordx4 v13, s[40:43], s64 offen lds
v_mfma_f32_16x16x32_bf16 v[76:79], a[156:159], a[220:223], v[76:79]
ds_read_b64_tr_b16 a[182:183], v184 offset:45056
v_mfma_f32_16x16x32_bf16 v[76:79], a[152:155], a[216:219], v[76:79]
ds_read_b64_tr_b16 a[184:185], v185 offset:32768
v_mfma_f32_16x16x32_bf16 v[108:111], a[152:155], a[224:227], v[108:111]
s_xor_b32 s65, s84, 65536
ds_read_b64_tr_b16 a[186:187], v185 offset:36864
v_mfma_f32_16x16x32_bf16 v[108:111], a[156:159], a[228:231], v[108:111]
buffer_load_dwordx4 a[0:3], v14, s[44:47], s65 offen offset:0 sc1
v_mfma_f32_16x16x32_bf16 v[140:143], a[156:159], a[236:239], v[140:143]
ds_read_b64_tr_b16 a[188:189], v185 offset:40960
v_mfma_f32_16x16x32_bf16 v[140:143], a[152:155], a[232:235], v[140:143]
ds_read_b64_tr_b16 a[190:191], v185 offset:45056
v_mfma_f32_16x16x32_bf16 v[144:147], a[160:163], a[232:235], v[144:147]
v_mfma_f32_16x16x32_bf16 v[144:147], a[164:167], a[236:239], v[144:147]
buffer_load_dwordx4 a[8:11], v14, s[44:47], s65 offen offset:1024 sc1
v_mfma_f32_16x16x32_bf16 v[112:115], a[164:167], a[228:231], v[112:115]
ds_read_b64_tr_b16 a[192:193], v186 offset:32768
v_mfma_f32_16x16x32_bf16 v[112:115], a[160:163], a[224:227], v[112:115]
ds_read_b64_tr_b16 a[194:195], v186 offset:36864
v_mfma_f32_16x16x32_bf16 v[80:83], a[160:163], a[216:219], v[80:83]
ds_read_b64_tr_b16 a[196:197], v186 offset:40960
v_mfma_f32_16x16x32_bf16 v[80:83], a[164:167], a[220:223], v[80:83]
buffer_load_dwordx4 a[16:19], v15, s[44:47], s65 offen offset:0 sc1
v_mfma_f32_16x16x32_bf16 v[48:51], a[164:167], a[212:215], v[48:51]
ds_read_b64_tr_b16 a[198:199], v186 offset:45056
v_mfma_f32_16x16x32_bf16 v[48:51], a[160:163], a[208:211], v[48:51]
s_waitcnt lgkmcnt(4)
v_mfma_f32_16x16x32_bf16 v[52:55], a[168:171], a[208:211], v[52:55]
v_mfma_f32_16x16x32_bf16 v[52:55], a[172:175], a[212:215], v[52:55]
buffer_load_dwordx4 a[24:27], v15, s[44:47], s65 offen offset:1024 sc1
v_mfma_f32_16x16x32_bf16 v[84:87], a[172:175], a[220:223], v[84:87]
ds_read_b64_tr_b16 a[200:201], v187 offset:32768
v_mfma_f32_16x16x32_bf16 v[84:87], a[168:171], a[216:219], v[84:87]
ds_read_b64_tr_b16 a[202:203], v187 offset:36864
v_mfma_f32_16x16x32_bf16 v[116:119], a[168:171], a[224:227], v[116:119]
s_xor_b32 s65, s84, 73728
ds_read_b64_tr_b16 a[204:205], v187 offset:40960
v_mfma_f32_16x16x32_bf16 v[116:119], a[172:175], a[228:231], v[116:119]
buffer_load_dwordx4 a[4:7], v14, s[44:47], s65 offen offset:0 sc1
v_mfma_f32_16x16x32_bf16 v[148:151], a[172:175], a[236:239], v[148:151]
ds_read_b64_tr_b16 a[206:207], v187 offset:45056
v_mfma_f32_16x16x32_bf16 v[148:151], a[168:171], a[232:235], v[148:151]
v_mfma_f32_16x16x32_bf16 v[120:123], a[176:179], a[232:235], v[120:123]
v_mfma_f32_16x16x32_bf16 v[120:123], a[180:183], a[236:239], v[120:123]
buffer_load_dwordx4 a[12:15], v14, s[44:47], s65 offen offset:1024 sc1
v_mfma_f32_16x16x32_bf16 v[88:91], a[180:183], a[228:231], v[88:91]
v_mfma_f32_16x16x32_bf16 v[88:91], a[176:179], a[224:227], v[88:91]
v_mfma_f32_16x16x32_bf16 v[56:59], a[176:179], a[216:219], v[56:59]
v_mfma_f32_16x16x32_bf16 v[56:59], a[180:183], a[220:223], v[56:59]
buffer_load_dwordx4 a[20:23], v15, s[44:47], s65 offen offset:0 sc1
v_mfma_f32_16x16x32_bf16 v[24:27], a[180:183], a[212:215], v[24:27]
v_mfma_f32_16x16x32_bf16 v[24:27], a[176:179], a[208:211], v[24:27]
v_mfma_f32_16x16x32_bf16 v[28:31], a[184:187], a[208:211], v[28:31]
v_mfma_f32_16x16x32_bf16 v[28:31], a[188:191], a[212:215], v[28:31]
buffer_load_dwordx4 a[28:31], v15, s[44:47], s65 offen offset:1024 sc1
v_mfma_f32_16x16x32_bf16 v[60:63], a[188:191], a[220:223], v[60:63]
v_mfma_f32_16x16x32_bf16 v[60:63], a[184:187], a[216:219], v[60:63]
s_waitcnt vmcnt(24)
s_barrier
v_mfma_f32_16x16x32_bf16 v[92:95], a[184:187], a[224:227], v[92:95]
s_xor_b32 m0, s76, 98304
ds_read_b64_tr_b16 a[144:145], v196 offset:0
v_mfma_f32_16x16x32_bf16 v[92:95], a[188:191], a[228:231], v[92:95]
s_xor_b32 s64, s85, 786432
ds_read_b64_tr_b16 a[146:147], v196 offset:4096
v_mfma_f32_16x16x32_bf16 v[124:127], a[188:191], a[236:239], v[124:127]
buffer_load_dwordx4 v12, s[40:43], s64 offen lds
v_mfma_f32_16x16x32_bf16 v[124:127], a[184:187], a[232:235], v[124:127]
s_waitcnt lgkmcnt(2)
s_xor_b32 m0, s76, 99328
ds_read_b64_tr_b16 a[148:149], v196 offset:8192
v_mfma_f32_16x16x32_bf16 v[128:131], a[192:195], a[232:235], v[128:131]
s_xor_b32 s64, s85, 794624
ds_read_b64_tr_b16 a[150:151], v196 offset:12288
v_mfma_f32_16x16x32_bf16 v[128:131], a[196:199], a[236:239], v[128:131]
buffer_load_dwordx4 v13, s[40:43], s64 offen lds
v_mfma_f32_16x16x32_bf16 v[96:99], a[196:199], a[228:231], v[96:99]
ds_read_b64_tr_b16 a[152:153], v197 offset:0
v_mfma_f32_16x16x32_bf16 v[96:99], a[192:195], a[224:227], v[96:99]
s_xor_b32 m0, s76, 100352
ds_read_b64_tr_b16 a[154:155], v197 offset:4096
v_mfma_f32_16x16x32_bf16 v[64:67], a[192:195], a[216:219], v[64:67]
s_xor_b32 s64, s85, 802816
ds_read_b64_tr_b16 a[156:157], v197 offset:8192
v_mfma_f32_16x16x32_bf16 v[64:67], a[196:199], a[220:223], v[64:67]
buffer_load_dwordx4 v12, s[40:43], s64 offen lds
v_mfma_f32_16x16x32_bf16 v[32:35], a[196:199], a[212:215], v[32:35]
ds_read_b64_tr_b16 a[158:159], v197 offset:12288
v_mfma_f32_16x16x32_bf16 v[32:35], a[192:195], a[208:211], v[32:35]
s_xor_b32 m0, s76, 101376
ds_read_b64_tr_b16 a[160:161], v198 offset:0
v_mfma_f32_16x16x32_bf16 v[36:39], a[200:203], a[208:211], v[36:39]
s_xor_b32 s64, s85, 811008
ds_read_b64_tr_b16 a[162:163], v198 offset:4096
v_mfma_f32_16x16x32_bf16 v[36:39], a[204:207], a[212:215], v[36:39]
buffer_load_dwordx4 v13, s[40:43], s64 offen lds
v_mfma_f32_16x16x32_bf16 v[68:71], a[204:207], a[220:223], v[68:71]
ds_read_b64_tr_b16 a[164:165], v198 offset:8192
v_mfma_f32_16x16x32_bf16 v[68:71], a[200:203], a[216:219], v[68:71]
s_xor_b32 m0, s76, 102400
ds_read_b64_tr_b16 a[166:167], v198 offset:12288
v_mfma_f32_16x16x32_bf16 v[100:103], a[200:203], a[224:227], v[100:103]
s_xor_b32 s64, s85, 819200
v_mfma_f32_16x16x32_bf16 v[100:103], a[204:207], a[228:231], v[100:103]
buffer_load_dwordx4 v12, s[40:43], s64 offen lds
v_mfma_f32_16x16x32_bf16 v[132:135], a[204:207], a[236:239], v[132:135]
v_mfma_f32_16x16x32_bf16 v[132:135], a[200:203], a[232:235], v[132:135]
s_waitcnt vmcnt(25)
s_waitcnt lgkmcnt(3)
s_xor_b32 m0, s76, 103424
buffer_load_dword v19, off, s[52:55], s72 offset:128 sc1
v_mfma_f32_16x16x32_bf16 v[136:139], a[144:147], v[176:179], v[136:139]
s_waitcnt vmcnt(22)
s_xor_b32 s64, s85, 827392
ds_read_b64_tr_b16 a[168:169], v199 offset:0
v_mfma_f32_16x16x32_bf16 v[136:139], a[148:151], v[180:183], v[136:139]
buffer_load_dwordx4 v13, s[40:43], s64 offen lds
v_mfma_f32_16x16x32_bf16 v[104:107], a[148:151], v[172:175], v[104:107]
ds_read_b64_tr_b16 a[170:171], v199 offset:4096
v_mfma_f32_16x16x32_bf16 v[104:107], a[144:147], v[168:171], v[104:107]
s_xor_b32 m0, s76, 104448
ds_read_b64_tr_b16 a[172:173], v199 offset:8192
v_mfma_f32_16x16x32_bf16 v[72:75], a[144:147], v[160:163], v[72:75]
s_xor_b32 s64, s85, 835584
ds_read_b64_tr_b16 a[174:175], v199 offset:12288
v_mfma_f32_16x16x32_bf16 v[72:75], a[148:151], v[164:167], v[72:75]
buffer_load_dwordx4 v12, s[40:43], s64 offen lds
v_mfma_f32_16x16x32_bf16 v[40:43], a[148:151], v[156:159], v[40:43]
ds_read_b64_tr_b16 a[176:177], v192 offset:0
v_mfma_f32_16x16x32_bf16 v[40:43], a[144:147], v[152:155], v[40:43]
s_xor_b32 m0, s76, 105472
ds_read_b64_tr_b16 a[178:179], v192 offset:4096
v_mfma_f32_16x16x32_bf16 v[44:47], a[152:155], v[152:155], v[44:47]
s_xor_b32 s64, s85, 843776
ds_read_b64_tr_b16 a[180:181], v192 offset:8192
v_mfma_f32_16x16x32_bf16 v[44:47], a[156:159], v[156:159], v[44:47]
buffer_load_dwordx4 v13, s[40:43], s64 offen lds
v_mfma_f32_16x16x32_bf16 v[76:79], a[156:159], v[164:167], v[76:79]
ds_read_b64_tr_b16 a[182:183], v192 offset:12288
v_mfma_f32_16x16x32_bf16 v[76:79], a[152:155], v[160:163], v[76:79]
ds_read_b64_tr_b16 a[184:185], v193 offset:0
v_mfma_f32_16x16x32_bf16 v[108:111], a[152:155], v[168:171], v[108:111]
s_xor_b32 s65, s84, 98304
ds_read_b64_tr_b16 a[186:187], v193 offset:4096
v_mfma_f32_16x16x32_bf16 v[108:111], a[156:159], v[172:175], v[108:111]
buffer_load_dwordx4 a[32:35], v14, s[44:47], s65 offen offset:0 sc1
v_mfma_f32_16x16x32_bf16 v[140:143], a[156:159], v[180:183], v[140:143]
ds_read_b64_tr_b16 a[188:189], v193 offset:8192
v_mfma_f32_16x16x32_bf16 v[140:143], a[152:155], v[176:179], v[140:143]
s_waitcnt lgkmcnt(5)
ds_read_b64_tr_b16 a[190:191], v193 offset:12288
v_mfma_f32_16x16x32_bf16 v[144:147], a[160:163], v[176:179], v[144:147]
s_lshl_b32 s75, s73, 20
s_add_u32 s85, s85, s75
s_lshr_b32 s74, s73, 28
v_mfma_f32_16x16x32_bf16 v[144:147], a[164:167], v[180:183], v[144:147]
s_and_b32 s74, s74, 8
buffer_load_dwordx4 a[40:43], v14, s[44:47], s65 offen offset:1024 sc1
v_mfma_f32_16x16x32_bf16 v[112:115], a[164:167], v[172:175], v[112:115]
ds_read_b64_tr_b16 a[192:193], v194 offset:0
v_mfma_f32_16x16x32_bf16 v[112:115], a[160:163], v[168:171], v[112:115]
ds_read_b64_tr_b16 a[194:195], v194 offset:4096
v_mfma_f32_16x16x32_bf16 v[80:83], a[160:163], v[160:163], v[80:83]
ds_read_b64_tr_b16 a[196:197], v194 offset:8192
v_mfma_f32_16x16x32_bf16 v[80:83], a[164:167], v[164:167], v[80:83]
buffer_load_dwordx4 a[48:51], v15, s[44:47], s65 offen offset:0 sc1
v_mfma_f32_16x16x32_bf16 v[48:51], a[164:167], v[156:159], v[48:51]
ds_read_b64_tr_b16 a[198:199], v194 offset:12288
v_mfma_f32_16x16x32_bf16 v[48:51], a[160:163], v[152:155], v[48:51]
v_mfma_f32_16x16x32_bf16 v[52:55], a[168:171], v[152:155], v[52:55]
v_mfma_f32_16x16x32_bf16 v[52:55], a[172:175], v[156:159], v[52:55]
buffer_load_dwordx4 a[56:59], v15, s[44:47], s65 offen offset:1024 sc1
v_mfma_f32_16x16x32_bf16 v[84:87], a[172:175], v[164:167], v[84:87]
ds_read_b64_tr_b16 a[200:201], v195 offset:0
v_mfma_f32_16x16x32_bf16 v[84:87], a[168:171], v[160:163], v[84:87]
ds_read_b64_tr_b16 a[202:203], v195 offset:4096
v_mfma_f32_16x16x32_bf16 v[116:119], a[168:171], v[168:171], v[116:119]
s_xor_b32 s65, s84, 106496
ds_read_b64_tr_b16 a[204:205], v195 offset:8192
v_mfma_f32_16x16x32_bf16 v[116:119], a[172:175], v[172:175], v[116:119]
buffer_load_dwordx4 a[36:39], v14, s[44:47], s65 offen offset:0 sc1
v_mfma_f32_16x16x32_bf16 v[148:151], a[172:175], v[180:183], v[148:151]
ds_read_b64_tr_b16 a[206:207], v195 offset:12288
v_mfma_f32_16x16x32_bf16 v[148:151], a[168:171], v[176:179], v[148:151]
v_mfma_f32_16x16x32_bf16 v[120:123], a[176:179], v[176:179], v[120:123]
s_waitcnt lgkmcnt(4)
v_mfma_f32_16x16x32_bf16 v[120:123], a[180:183], v[180:183], v[120:123]
buffer_load_dwordx4 a[44:47], v14, s[44:47], s65 offen offset:1024 sc1
v_mfma_f32_16x16x32_bf16 v[88:91], a[180:183], v[172:175], v[88:91]
v_mfma_f32_16x16x32_bf16 v[88:91], a[176:179], v[168:171], v[88:91]
v_mfma_f32_16x16x32_bf16 v[56:59], a[176:179], v[160:163], v[56:59]
v_mfma_f32_16x16x32_bf16 v[56:59], a[180:183], v[164:167], v[56:59]
buffer_load_dwordx4 a[52:55], v15, s[44:47], s65 offen offset:0 sc1
v_mfma_f32_16x16x32_bf16 v[24:27], a[180:183], v[156:159], v[24:27]
v_mfma_f32_16x16x32_bf16 v[24:27], a[176:179], v[152:155], v[24:27]
v_mfma_f32_16x16x32_bf16 v[28:31], a[184:187], v[152:155], v[28:31]
v_mfma_f32_16x16x32_bf16 v[28:31], a[188:191], v[156:159], v[28:31]
buffer_load_dwordx4 a[60:63], v15, s[44:47], s65 offen offset:1024 sc1
v_mfma_f32_16x16x32_bf16 v[60:63], a[188:191], v[164:167], v[60:63]
v_mfma_f32_16x16x32_bf16 v[60:63], a[184:187], v[160:163], v[60:63]
s_waitcnt vmcnt(25)
s_barrier
v_mfma_f32_16x16x32_bf16 v[92:95], a[184:187], v[168:171], v[92:95]
s_lshl_b32 s75, s73, 17
s_add_u32 s84, s84, s75
s_xor_b32 m0, s76, 131072
ds_read_b64_tr_b16 a[144:145], v196 offset:32768
v_mfma_f32_16x16x32_bf16 v[92:95], a[188:191], v[172:175], v[92:95]
s_xor_b32 s64, s85, 0
ds_read_b64_tr_b16 a[146:147], v196 offset:36864
v_mfma_f32_16x16x32_bf16 v[124:127], a[188:191], v[180:183], v[124:127]
buffer_load_dwordx4 v12, s[40:43], s64 offen lds
v_mfma_f32_16x16x32_bf16 v[124:127], a[184:187], v[176:179], v[124:127]
s_xor_b32 m0, s76, 132096
ds_read_b64_tr_b16 a[148:149], v196 offset:40960
v_mfma_f32_16x16x32_bf16 v[128:131], a[192:195], v[176:179], v[128:131]
s_xor_b32 s64, s85, 8192
ds_read_b64_tr_b16 a[150:151], v196 offset:45056
v_mfma_f32_16x16x32_bf16 v[128:131], a[196:199], v[180:183], v[128:131]
buffer_load_dwordx4 v13, s[40:43], s64 offen lds
v_mfma_f32_16x16x32_bf16 v[96:99], a[196:199], v[172:175], v[96:99]
ds_read_b64_tr_b16 a[152:153], v197 offset:32768
v_mfma_f32_16x16x32_bf16 v[96:99], a[192:195], v[168:171], v[96:99]
s_xor_b32 m0, s76, 133120
ds_read_b64_tr_b16 a[154:155], v197 offset:36864
v_mfma_f32_16x16x32_bf16 v[64:67], a[192:195], v[160:163], v[64:67]
s_xor_b32 s64, s85, 16384
ds_read_b64_tr_b16 a[156:157], v197 offset:40960
v_mfma_f32_16x16x32_bf16 v[64:67], a[196:199], v[164:167], v[64:67]
buffer_load_dwordx4 v12, s[40:43], s64 offen lds
v_mfma_f32_16x16x32_bf16 v[32:35], a[196:199], v[156:159], v[32:35]
ds_read_b64_tr_b16 a[158:159], v197 offset:45056
v_mfma_f32_16x16x32_bf16 v[32:35], a[192:195], v[152:155], v[32:35]
s_waitcnt lgkmcnt(5)
s_xor_b32 m0, s76, 134144
ds_read_b64_tr_b16 a[160:161], v198 offset:32768
v_mfma_f32_16x16x32_bf16 v[36:39], a[200:203], v[152:155], v[36:39]
s_xor_b32 s64, s85, 24576
ds_read_b64_tr_b16 a[162:163], v198 offset:36864
v_mfma_f32_16x16x32_bf16 v[36:39], a[204:207], v[156:159], v[36:39]
buffer_load_dwordx4 v13, s[40:43], s64 offen lds
v_mfma_f32_16x16x32_bf16 v[68:71], a[204:207], v[164:167], v[68:71]
ds_read_b64_tr_b16 a[164:165], v198 offset:40960
v_mfma_f32_16x16x32_bf16 v[68:71], a[200:203], v[160:163], v[68:71]
s_xor_b32 m0, s76, 135168
ds_read_b64_tr_b16 a[166:167], v198 offset:45056
v_mfma_f32_16x16x32_bf16 v[100:103], a[200:203], v[168:171], v[100:103]
s_xor_b32 s64, s85, 32768
v_mfma_f32_16x16x32_bf16 v[100:103], a[204:207], v[172:175], v[100:103]
buffer_load_dwordx4 v12, s[40:43], s64 offen lds
v_mfma_f32_16x16x32_bf16 v[132:135], a[204:207], v[180:183], v[132:135]
v_mfma_f32_16x16x32_bf16 v[132:135], a[200:203], v[176:179], v[132:135]
s_waitcnt vmcnt(26)
v_mfma_f32_16x16x32_bf16 v[136:139], a[144:147], a[24:27], v[136:139]
s_waitcnt vmcnt(16)
v_readfirstlane_b32 vcc_lo, v19
s_nop 0
s_cmp_lt_u32 vcc_lo, s74
s_cbranch_scc1 L_spin_4022
L_spinbk_4023:
s_waitcnt lgkmcnt(2)
v_mfma_f32_16x16x32_bf16 v[136:139], a[148:151], a[28:31], v[136:139]
s_xor_b32 m0, s76, 136192
ds_read_b64_tr_b16 a[168:169], v199 offset:32768
v_mfma_f32_16x16x32_bf16 v[104:107], a[148:151], a[20:23], v[104:107]
s_xor_b32 s64, s85, 40960
ds_read_b64_tr_b16 a[170:171], v199 offset:36864
v_mfma_f32_16x16x32_bf16 v[104:107], a[144:147], a[16:19], v[104:107]
buffer_load_dwordx4 v13, s[40:43], s64 offen lds
v_mfma_f32_16x16x32_bf16 v[72:75], a[144:147], a[8:11], v[72:75]
s_xor_b32 m0, s76, 137216
ds_read_b64_tr_b16 a[172:173], v199 offset:40960
v_mfma_f32_16x16x32_bf16 v[72:75], a[148:151], a[12:15], v[72:75]
s_xor_b32 s64, s85, 49152
ds_read_b64_tr_b16 a[174:175], v199 offset:45056
v_mfma_f32_16x16x32_bf16 v[40:43], a[148:151], a[4:7], v[40:43]
buffer_load_dwordx4 v12, s[40:43], s64 offen lds
v_mfma_f32_16x16x32_bf16 v[40:43], a[144:147], a[0:3], v[40:43]
ds_read_b64_tr_b16 a[176:177], v192 offset:32768
v_mfma_f32_16x16x32_bf16 v[44:47], a[152:155], a[0:3], v[44:47]
s_xor_b32 m0, s76, 138240
ds_read_b64_tr_b16 a[178:179], v192 offset:36864
v_mfma_f32_16x16x32_bf16 v[44:47], a[156:159], a[4:7], v[44:47]
s_xor_b32 s64, s85, 57344
ds_read_b64_tr_b16 a[180:181], v192 offset:40960
v_mfma_f32_16x16x32_bf16 v[76:79], a[156:159], a[12:15], v[76:79]
buffer_load_dwordx4 v13, s[40:43], s64 offen lds
v_mfma_f32_16x16x32_bf16 v[76:79], a[152:155], a[8:11], v[76:79]
ds_read_b64_tr_b16 a[182:183], v192 offset:45056
v_mfma_f32_16x16x32_bf16 v[108:111], a[152:155], a[16:19], v[108:111]
ds_read_b64_tr_b16 a[184:185], v193 offset:32768
v_mfma_f32_16x16x32_bf16 v[108:111], a[156:159], a[20:23], v[108:111]
s_xor_b32 s65, s84, 0
ds_read_b64_tr_b16 a[186:187], v193 offset:36864
v_mfma_f32_16x16x32_bf16 v[140:143], a[156:159], a[28:31], v[140:143]
buffer_load_dwordx4 a[208:211], v14, s[44:47], s65 offen offset:0 sc1
v_mfma_f32_16x16x32_bf16 v[140:143], a[152:155], a[24:27], v[140:143]
ds_read_b64_tr_b16 a[188:189], v193 offset:40960
v_mfma_f32_16x16x32_bf16 v[144:147], a[160:163], a[24:27], v[144:147]
s_waitcnt lgkmcnt(5)
ds_read_b64_tr_b16 a[190:191], v193 offset:45056
v_mfma_f32_16x16x32_bf16 v[144:147], a[164:167], a[28:31], v[144:147]
v_mfma_f32_16x16x32_bf16 v[112:115], a[164:167], a[20:23], v[112:115]
buffer_load_dwordx4 a[216:219], v14, s[44:47], s65 offen offset:1024 sc1
v_mfma_f32_16x16x32_bf16 v[112:115], a[160:163], a[16:19], v[112:115]
ds_read_b64_tr_b16 a[192:193], v194 offset:32768
v_mfma_f32_16x16x32_bf16 v[80:83], a[160:163], a[8:11], v[80:83]
ds_read_b64_tr_b16 a[194:195], v194 offset:36864
v_mfma_f32_16x16x32_bf16 v[80:83], a[164:167], a[12:15], v[80:83]
ds_read_b64_tr_b16 a[196:197], v194 offset:40960
v_mfma_f32_16x16x32_bf16 v[48:51], a[164:167], a[4:7], v[48:51]
buffer_load_dwordx4 a[224:227], v15, s[44:47], s65 offen offset:0 sc1
v_mfma_f32_16x16x32_bf16 v[48:51], a[160:163], a[0:3], v[48:51]
ds_read_b64_tr_b16 a[198:199], v194 offset:45056
v_mfma_f32_16x16x32_bf16 v[52:55], a[168:171], a[0:3], v[52:55]
v_mfma_f32_16x16x32_bf16 v[52:55], a[172:175], a[4:7], v[52:55]
buffer_load_dwordx4 a[232:235], v15, s[44:47], s65 offen offset:1024 sc1
v_mfma_f32_16x16x32_bf16 v[84:87], a[172:175], a[12:15], v[84:87]
ds_read_b64_tr_b16 a[200:201], v195 offset:32768
v_mfma_f32_16x16x32_bf16 v[84:87], a[168:171], a[8:11], v[84:87]
ds_read_b64_tr_b16 a[202:203], v195 offset:36864
v_mfma_f32_16x16x32_bf16 v[116:119], a[168:171], a[16:19], v[116:119]
s_xor_b32 s65, s84, 8192
ds_read_b64_tr_b16 a[204:205], v195 offset:40960
v_mfma_f32_16x16x32_bf16 v[116:119], a[172:175], a[20:23], v[116:119]
buffer_load_dwordx4 a[212:215], v14, s[44:47], s65 offen offset:0 sc1
v_mfma_f32_16x16x32_bf16 v[148:151], a[172:175], a[28:31], v[148:151]
ds_read_b64_tr_b16 a[206:207], v195 offset:45056
v_mfma_f32_16x16x32_bf16 v[148:151], a[168:171], a[24:27], v[148:151]
v_mfma_f32_16x16x32_bf16 v[120:123], a[176:179], a[24:27], v[120:123]
s_waitcnt lgkmcnt(4)
v_mfma_f32_16x16x32_bf16 v[120:123], a[180:183], a[28:31], v[120:123]
buffer_load_dwordx4 a[220:223], v14, s[44:47], s65 offen offset:1024 sc1
v_mfma_f32_16x16x32_bf16 v[88:91], a[180:183], a[20:23], v[88:91]
v_mfma_f32_16x16x32_bf16 v[88:91], a[176:179], a[16:19], v[88:91]
v_mfma_f32_16x16x32_bf16 v[56:59], a[176:179], a[8:11], v[56:59]
v_mfma_f32_16x16x32_bf16 v[56:59], a[180:183], a[12:15], v[56:59]
buffer_load_dwordx4 a[228:231], v15, s[44:47], s65 offen offset:0 sc1
v_mfma_f32_16x16x32_bf16 v[24:27], a[180:183], a[4:7], v[24:27]
v_mfma_f32_16x16x32_bf16 v[24:27], a[176:179], a[0:3], v[24:27]
v_mfma_f32_16x16x32_bf16 v[28:31], a[184:187], a[0:3], v[28:31]
v_mfma_f32_16x16x32_bf16 v[28:31], a[188:191], a[4:7], v[28:31]
buffer_load_dwordx4 a[236:239], v15, s[44:47], s65 offen offset:1024 sc1
v_mfma_f32_16x16x32_bf16 v[60:63], a[188:191], a[12:15], v[60:63]
v_mfma_f32_16x16x32_bf16 v[60:63], a[184:187], a[8:11], v[60:63]
s_waitcnt vmcnt(24)
s_barrier
v_mfma_f32_16x16x32_bf16 v[92:95], a[184:187], a[16:19], v[92:95]
s_xor_b32 m0, s76, 32768
ds_read_b64_tr_b16 a[144:145], v188 offset:0
v_mfma_f32_16x16x32_bf16 v[92:95], a[188:191], a[20:23], v[92:95]
s_xor_b32 s64, s85, 262144
ds_read_b64_tr_b16 a[146:147], v188 offset:4096
v_mfma_f32_16x16x32_bf16 v[124:127], a[188:191], a[28:31], v[124:127]
buffer_load_dwordx4 v12, s[40:43], s64 offen lds
v_mfma_f32_16x16x32_bf16 v[124:127], a[184:187], a[24:27], v[124:127]
s_xor_b32 m0, s76, 33792
ds_read_b64_tr_b16 a[148:149], v188 offset:8192
v_mfma_f32_16x16x32_bf16 v[128:131], a[192:195], a[24:27], v[128:131]
s_xor_b32 s64, s85, 270336
ds_read_b64_tr_b16 a[150:151], v188 offset:12288
v_mfma_f32_16x16x32_bf16 v[128:131], a[196:199], a[28:31], v[128:131]
buffer_load_dwordx4 v13, s[40:43], s64 offen lds
v_mfma_f32_16x16x32_bf16 v[96:99], a[196:199], a[20:23], v[96:99]
ds_read_b64_tr_b16 a[152:153], v189 offset:0
v_mfma_f32_16x16x32_bf16 v[96:99], a[192:195], a[16:19], v[96:99]
s_xor_b32 m0, s76, 34816
ds_read_b64_tr_b16 a[154:155], v189 offset:4096
v_mfma_f32_16x16x32_bf16 v[64:67], a[192:195], a[8:11], v[64:67]
s_xor_b32 s64, s85, 278528
ds_read_b64_tr_b16 a[156:157], v189 offset:8192
v_mfma_f32_16x16x32_bf16 v[64:67], a[196:199], a[12:15], v[64:67]
buffer_load_dwordx4 v12, s[40:43], s64 offen lds
v_mfma_f32_16x16x32_bf16 v[32:35], a[196:199], a[4:7], v[32:35]
ds_read_b64_tr_b16 a[158:159], v189 offset:12288
v_mfma_f32_16x16x32_bf16 v[32:35], a[192:195], a[0:3], v[32:35]
s_waitcnt lgkmcnt(5)
s_xor_b32 m0, s76, 35840
ds_read_b64_tr_b16 a[160:161], v190 offset:0
v_mfma_f32_16x16x32_bf16 v[36:39], a[200:203], a[0:3], v[36:39]
s_xor_b32 s64, s85, 286720
ds_read_b64_tr_b16 a[162:163], v190 offset:4096
v_mfma_f32_16x16x32_bf16 v[36:39], a[204:207], a[4:7], v[36:39]
buffer_load_dwordx4 v13, s[40:43], s64 offen lds
v_mfma_f32_16x16x32_bf16 v[68:71], a[204:207], a[12:15], v[68:71]
ds_read_b64_tr_b16 a[164:165], v190 offset:8192
v_mfma_f32_16x16x32_bf16 v[68:71], a[200:203], a[8:11], v[68:71]
s_xor_b32 m0, s76, 36864
ds_read_b64_tr_b16 a[166:167], v190 offset:12288
v_mfma_f32_16x16x32_bf16 v[100:103], a[200:203], a[16:19], v[100:103]
s_xor_b32 s64, s85, 294912
v_mfma_f32_16x16x32_bf16 v[100:103], a[204:207], a[20:23], v[100:103]
buffer_load_dwordx4 v12, s[40:43], s64 offen lds
v_mfma_f32_16x16x32_bf16 v[132:135], a[204:207], a[28:31], v[132:135]
v_mfma_f32_16x16x32_bf16 v[132:135], a[200:203], a[24:27], v[132:135]
s_waitcnt vmcnt(25)
s_xor_b32 m0, s76, 37888
v_mfma_f32_16x16x32_bf16 v[136:139], a[144:147], a[56:59], v[136:139]
s_waitcnt vmcnt(21)
s_waitcnt lgkmcnt(2)
s_xor_b32 s64, s85, 303104
ds_read_b64_tr_b16 a[168:169], v191 offset:0
v_mfma_f32_16x16x32_bf16 v[136:139], a[148:151], a[60:63], v[136:139]
buffer_load_dwordx4 v13, s[40:43], s64 offen lds
v_mfma_f32_16x16x32_bf16 v[104:107], a[148:151], a[52:55], v[104:107]
ds_read_b64_tr_b16 a[170:171], v191 offset:4096
v_mfma_f32_16x16x32_bf16 v[104:107], a[144:147], a[48:51], v[104:107]
s_xor_b32 m0, s76, 38912
ds_read_b64_tr_b16 a[172:173], v191 offset:8192
v_mfma_f32_16x16x32_bf16 v[72:75], a[144:147], a[40:43], v[72:75]
s_xor_b32 s64, s85, 311296
ds_read_b64_tr_b16 a[174:175], v191 offset:12288
v_mfma_f32_16x16x32_bf16 v[72:75], a[148:151], a[44:47], v[72:75]
buffer_load_dwordx4 v12, s[40:43], s64 offen lds
v_mfma_f32_16x16x32_bf16 v[40:43], a[148:151], a[36:39], v[40:43]
ds_read_b64_tr_b16 a[176:177], v184 offset:0
v_mfma_f32_16x16x32_bf16 v[40:43], a[144:147], a[32:35], v[40:43]
s_xor_b32 m0, s76, 39936
ds_read_b64_tr_b16 a[178:179], v184 offset:4096
v_mfma_f32_16x16x32_bf16 v[44:47], a[152:155], a[32:35], v[44:47]
s_xor_b32 s64, s85, 319488
ds_read_b64_tr_b16 a[180:181], v184 offset:8192
v_mfma_f32_16x16x32_bf16 v[44:47], a[156:159], a[36:39], v[44:47]
buffer_load_dwordx4 v13, s[40:43], s64 offen lds
v_mfma_f32_16x16x32_bf16 v[76:79], a[156:159], a[44:47], v[76:79]
ds_read_b64_tr_b16 a[182:183], v184 offset:12288
v_mfma_f32_16x16x32_bf16 v[76:79], a[152:155], a[40:43], v[76:79]
ds_read_b64_tr_b16 a[184:185], v185 offset:0
v_mfma_f32_16x16x32_bf16 v[108:111], a[152:155], a[48:51], v[108:111]
s_xor_b32 s65, s84, 32768
ds_read_b64_tr_b16 a[186:187], v185 offset:4096
v_mfma_f32_16x16x32_bf16 v[108:111], a[156:159], a[52:55], v[108:111]
buffer_load_dwordx4 v[152:155], v14, s[44:47], s65 offen offset:0 sc1
v_mfma_f32_16x16x32_bf16 v[140:143], a[156:159], a[60:63], v[140:143]
ds_read_b64_tr_b16 a[188:189], v185 offset:8192
v_mfma_f32_16x16x32_bf16 v[140:143], a[152:155], a[56:59], v[140:143]
ds_read_b64_tr_b16 a[190:191], v185 offset:12288
v_mfma_f32_16x16x32_bf16 v[144:147], a[160:163], a[56:59], v[144:147]
s_waitcnt lgkmcnt(5)
v_mfma_f32_16x16x32_bf16 v[144:147], a[164:167], a[60:63], v[144:147]
buffer_load_dwordx4 v[160:163], v14, s[44:47], s65 offen offset:1024 sc1
v_mfma_f32_16x16x32_bf16 v[112:115], a[164:167], a[52:55], v[112:115]
ds_read_b64_tr_b16 a[192:193], v186 offset:0
v_mfma_f32_16x16x32_bf16 v[112:115], a[160:163], a[48:51], v[112:115]
ds_read_b64_tr_b16 a[194:195], v186 offset:4096
v_mfma_f32_16x16x32_bf16 v[80:83], a[160:163], a[40:43], v[80:83]
ds_read_b64_tr_b16 a[196:197], v186 offset:8192
v_mfma_f32_16x16x32_bf16 v[80:83], a[164:167], a[44:47], v[80:83]
buffer_load_dwordx4 v[168:171], v15, s[44:47], s65 offen offset:0 sc1
v_mfma_f32_16x16x32_bf16 v[48:51], a[164:167], a[36:39], v[48:51]
ds_read_b64_tr_b16 a[198:199], v186 offset:12288
v_mfma_f32_16x16x32_bf16 v[48:51], a[160:163], a[32:35], v[48:51]
v_mfma_f32_16x16x32_bf16 v[52:55], a[168:171], a[32:35], v[52:55]
v_mfma_f32_16x16x32_bf16 v[52:55], a[172:175], a[36:39], v[52:55]
buffer_load_dwordx4 v[176:179], v15, s[44:47], s65 offen offset:1024 sc1
v_mfma_f32_16x16x32_bf16 v[84:87], a[172:175], a[44:47], v[84:87]
ds_read_b64_tr_b16 a[200:201], v187 offset:0
v_mfma_f32_16x16x32_bf16 v[84:87], a[168:171], a[40:43], v[84:87]
ds_read_b64_tr_b16 a[202:203], v187 offset:4096
v_mfma_f32_16x16x32_bf16 v[116:119], a[168:171], a[48:51], v[116:119]
s_xor_b32 s65, s84, 40960
ds_read_b64_tr_b16 a[204:205], v187 offset:8192
v_mfma_f32_16x16x32_bf16 v[116:119], a[172:175], a[52:55], v[116:119]
buffer_load_dwordx4 v[156:159], v14, s[44:47], s65 offen offset:0 sc1
v_mfma_f32_16x16x32_bf16 v[148:151], a[172:175], a[60:63], v[148:151]
ds_read_b64_tr_b16 a[206:207], v187 offset:12288
v_mfma_f32_16x16x32_bf16 v[148:151], a[168:171], a[56:59], v[148:151]
v_mfma_f32_16x16x32_bf16 v[120:123], a[176:179], a[56:59], v[120:123]
s_waitcnt lgkmcnt(4)
v_mfma_f32_16x16x32_bf16 v[120:123], a[180:183], a[60:63], v[120:123]
buffer_load_dwordx4 v[164:167], v14, s[44:47], s65 offen offset:1024 sc1
v_mfma_f32_16x16x32_bf16 v[88:91], a[180:183], a[52:55], v[88:91]
v_mfma_f32_16x16x32_bf16 v[88:91], a[176:179], a[48:51], v[88:91]
v_mfma_f32_16x16x32_bf16 v[56:59], a[176:179], a[40:43], v[56:59]
v_mfma_f32_16x16x32_bf16 v[56:59], a[180:183], a[44:47], v[56:59]
buffer_load_dwordx4 v[172:175], v15, s[44:47], s65 offen offset:0 sc1
v_mfma_f32_16x16x32_bf16 v[24:27], a[180:183], a[36:39], v[24:27]
v_mfma_f32_16x16x32_bf16 v[24:27], a[176:179], a[32:35], v[24:27]
v_mfma_f32_16x16x32_bf16 v[28:31], a[184:187], a[32:35], v[28:31]
v_mfma_f32_16x16x32_bf16 v[28:31], a[188:191], a[36:39], v[28:31]
buffer_load_dwordx4 v[180:183], v15, s[44:47], s65 offen offset:1024 sc1
v_mfma_f32_16x16x32_bf16 v[60:63], a[188:191], a[44:47], v[60:63]
v_mfma_f32_16x16x32_bf16 v[60:63], a[184:187], a[40:43], v[60:63]
s_waitcnt vmcnt(24)
s_barrier
v_mfma_f32_16x16x32_bf16 v[92:95], a[184:187], a[48:51], v[92:95]
s_xor_b32 m0, s76, 65536
ds_read_b64_tr_b16 a[144:145], v188 offset:32768
v_mfma_f32_16x16x32_bf16 v[92:95], a[188:191], a[52:55], v[92:95]
s_xor_b32 s64, s85, 524288
ds_read_b64_tr_b16 a[146:147], v188 offset:36864
v_mfma_f32_16x16x32_bf16 v[124:127], a[188:191], a[60:63], v[124:127]
buffer_load_dwordx4 v12, s[40:43], s64 offen lds
v_mfma_f32_16x16x32_bf16 v[124:127], a[184:187], a[56:59], v[124:127]
s_xor_b32 m0, s76, 66560
ds_read_b64_tr_b16 a[148:149], v188 offset:40960
v_mfma_f32_16x16x32_bf16 v[128:131], a[192:195], a[56:59], v[128:131]
s_xor_b32 s64, s85, 532480
ds_read_b64_tr_b16 a[150:151], v188 offset:45056
v_mfma_f32_16x16x32_bf16 v[128:131], a[196:199], a[60:63], v[128:131]
buffer_load_dwordx4 v13, s[40:43], s64 offen lds
v_mfma_f32_16x16x32_bf16 v[96:99], a[196:199], a[52:55], v[96:99]
ds_read_b64_tr_b16 a[152:153], v189 offset:32768
v_mfma_f32_16x16x32_bf16 v[96:99], a[192:195], a[48:51], v[96:99]
s_branch L_po22
L_pg22:
s_branch L_tr2
L_po22:
s_xor_b32 m0, s76, 67584
ds_read_b64_tr_b16 a[154:155], v189 offset:36864
v_mfma_f32_16x16x32_bf16 v[64:67], a[192:195], a[40:43], v[64:67]
s_xor_b32 s64, s85, 540672
ds_read_b64_tr_b16 a[156:157], v189 offset:40960
v_mfma_f32_16x16x32_bf16 v[64:67], a[196:199], a[44:47], v[64:67]
buffer_load_dwordx4 v12, s[40:43], s64 offen lds
v_mfma_f32_16x16x32_bf16 v[32:35], a[196:199], a[36:39], v[32:35]
ds_read_b64_tr_b16 a[158:159], v189 offset:45056
v_mfma_f32_16x16x32_bf16 v[32:35], a[192:195], a[32:35], v[32:35]
s_waitcnt lgkmcnt(5)
s_xor_b32 m0, s76, 68608
ds_read_b64_tr_b16 a[160:161], v190 offset:32768
v_mfma_f32_16x16x32_bf16 v[36:39], a[200:203], a[32:35], v[36:39]
s_xor_b32 s64, s85, 548864
ds_read_b64_tr_b16 a[162:163], v190 offset:36864
v_mfma_f32_16x16x32_bf16 v[36:39], a[204:207], a[36:39], v[36:39]
buffer_load_dwordx4 v13, s[40:43], s64 offen lds
v_mfma_f32_16x16x32_bf16 v[68:71], a[204:207], a[44:47], v[68:71]
ds_read_b64_tr_b16 a[164:165], v190 offset:40960
v_mfma_f32_16x16x32_bf16 v[68:71], a[200:203], a[40:43], v[68:71]
s_xor_b32 m0, s76, 69632
ds_read_b64_tr_b16 a[166:167], v190 offset:45056
v_mfma_f32_16x16x32_bf16 v[100:103], a[200:203], a[48:51], v[100:103]
s_xor_b32 s64, s85, 557056
v_mfma_f32_16x16x32_bf16 v[100:103], a[204:207], a[52:55], v[100:103]
buffer_load_dwordx4 v12, s[40:43], s64 offen lds
v_mfma_f32_16x16x32_bf16 v[132:135], a[204:207], a[60:63], v[132:135]
s_sub_u32 s73, 1, s73
s_sub_u32 s70, s70, 1
s_cmp_lg_u32 s70, 0
v_mfma_f32_16x16x32_bf16 v[132:135], a[200:203], a[56:59], v[132:135]
s_cbranch_scc1 L_p5loop
L_p5last:
s_waitcnt lgkmcnt(10)
s_waitcnt vmcnt(25)
v_mfma_f32_16x16x32_bf16 v[136:139], a[144:147], a[232:235], v[136:139]
s_waitcnt vmcnt(21)
s_waitcnt lgkmcnt(8)
s_xor_b32 m0, s76, 70656
s_xor_b32 s64, s85, 565248
ds_read_b64_tr_b16 a[168:169], v191 offset:32768
v_mfma_f32_16x16x32_bf16 v[136:139], a[148:151], a[236:239], v[136:139]
buffer_load_dwordx4 v13, s[40:43], s64 offen lds
v_mfma_f32_16x16x32_bf16 v[104:107], a[148:151], a[228:231], v[104:107]
ds_read_b64_tr_b16 a[170:171], v191 offset:36864
v_mfma_f32_16x16x32_bf16 v[104:107], a[144:147], a[224:227], v[104:107]
s_xor_b32 m0, s76, 71680
ds_read_b64_tr_b16 a[172:173], v191 offset:40960
v_mfma_f32_16x16x32_bf16 v[72:75], a[144:147], a[216:219], v[72:75]
s_xor_b32 s64, s85, 573440
ds_read_b64_tr_b16 a[174:175], v191 offset:45056
v_mfma_f32_16x16x32_bf16 v[72:75], a[148:151], a[220:223], v[72:75]
buffer_load_dwordx4 v12, s[40:43], s64 offen lds
v_mfma_f32_16x16x32_bf16 v[40:43], a[148:151], a[212:215], v[40:43]
ds_read_b64_tr_b16 a[176:177], v184 offset:32768
v_mfma_f32_16x16x32_bf16 v[40:43], a[144:147], a[208:211], v[40:43]
s_waitcnt lgkmcnt(5)
s_xor_b32 m0, s76, 72704
ds_read_b64_tr_b16 a[178:179], v184 offset:36864
v_mfma_f32_16x16x32_bf16 v[44:47], a[152:155], a[208:211], v[44:47]
s_xor_b32 s64, s85, 581632
ds_read_b64_tr_b16 a[180:181], v184 offset:40960
v_mfma_f32_16x16x32_bf16 v[44:47], a[156:159], a[212:215], v[44:47]
buffer_load_dwordx4 v13, s[40:43], s64 offen lds
v_mfma_f32_16x16x32_bf16 v[76:79], a[156:159], a[220:223], v[76:79]
ds_read_b64_tr_b16 a[182:183], v184 offset:45056
v_mfma_f32_16x16x32_bf16 v[76:79], a[152:155], a[216:219], v[76:79]
ds_read_b64_tr_b16 a[184:185], v185 offset:32768
v_mfma_f32_16x16x32_bf16 v[108:111], a[152:155], a[224:227], v[108:111]
s_xor_b32 s65, s84, 65536
ds_read_b64_tr_b16 a[186:187], v185 offset:36864
v_mfma_f32_16x16x32_bf16 v[108:111], a[156:159], a[228:231], v[108:111]
buffer_load_dwordx4 a[0:3], v14, s[44:47], s65 offen offset:0 sc1
v_mfma_f32_16x16x32_bf16 v[140:143], a[156:159], a[236:239], v[140:143]
ds_read_b64_tr_b16 a[188:189], v185 offset:40960
v_mfma_f32_16x16x32_bf16 v[140:143], a[152:155], a[232:235], v[140:143]
ds_read_b64_tr_b16 a[190:191], v185 offset:45056
v_mfma_f32_16x16x32_bf16 v[144:147], a[160:163], a[232:235], v[144:147]
v_mfma_f32_16x16x32_bf16 v[144:147], a[164:167], a[236:239], v[144:147]
buffer_load_dwordx4 a[8:11], v14, s[44:47], s65 offen offset:1024 sc1
v_mfma_f32_16x16x32_bf16 v[112:115], a[164:167], a[228:231], v[112:115]
ds_read_b64_tr_b16 a[192:193], v186 offset:32768
v_mfma_f32_16x16x32_bf16 v[112:115], a[160:163], a[224:227], v[112:115]
ds_read_b64_tr_b16 a[194:195], v186 offset:36864
v_mfma_f32_16x16x32_bf16 v[80:83], a[160:163], a[216:219], v[80:83]
ds_read_b64_tr_b16 a[196:197], v186 offset:40960
v_mfma_f32_16x16x32_bf16 v[80:83], a[164:167], a[220:223], v[80:83]
buffer_load_dwordx4 a[16:19], v15, s[44:47], s65 offen offset:0 sc1
v_mfma_f32_16x16x32_bf16 v[48:51], a[164:167], a[212:215], v[48:51]
ds_read_b64_tr_b16 a[198:199], v186 offset:45056
v_mfma_f32_16x16x32_bf16 v[48:51], a[160:163], a[208:211], v[48:51]
s_waitcnt lgkmcnt(4)
v_mfma_f32_16x16x32_bf16 v[52:55], a[168:171], a[208:211], v[52:55]
v_mfma_f32_16x16x32_bf16 v[52:55], a[172:175], a[212:215], v[52:55]
buffer_load_dwordx4 a[24:27], v15, s[44:47], s65 offen offset:1024 sc1
v_mfma_f32_16x16x32_bf16 v[84:87], a[172:175], a[220:223], v[84:87]
ds_read_b64_tr_b16 a[200:201], v187 offset:32768
v_mfma_f32_16x16x32_bf16 v[84:87], a[168:171], a[216:219], v[84:87]
ds_read_b64_tr_b16 a[202:203], v187 offset:36864
v_mfma_f32_16x16x32_bf16 v[116:119], a[168:171], a[224:227], v[116:119]
s_xor_b32 s65, s84, 73728
ds_read_b64_tr_b16 a[204:205], v187 offset:40960
v_mfma_f32_16x16x32_bf16 v[116:119], a[172:175], a[228:231], v[116:119]
buffer_load_dwordx4 a[4:7], v14, s[44:47], s65 offen offset:0 sc1
v_mfma_f32_16x16x32_bf16 v[148:151], a[172:175], a[236:239], v[148:151]
ds_read_b64_tr_b16 a[206:207], v187 offset:45056
v_mfma_f32_16x16x32_bf16 v[148:151], a[168:171], a[232:235], v[148:151]
v_mfma_f32_16x16x32_bf16 v[120:123], a[176:179], a[232:235], v[120:123]
v_mfma_f32_16x16x32_bf16 v[120:123], a[180:183], a[236:239], v[120:123]
buffer_load_dwordx4 a[12:15], v14, s[44:47], s65 offen offset:1024 sc1
v_mfma_f32_16x16x32_bf16 v[88:91], a[180:183], a[228:231], v[88:91]
v_mfma_f32_16x16x32_bf16 v[88:91], a[176:179], a[224:227], v[88:91]
v_mfma_f32_16x16x32_bf16 v[56:59], a[176:179], a[216:219], v[56:59]
v_mfma_f32_16x16x32_bf16 v[56:59], a[180:183], a[220:223], v[56:59]
buffer_load_dwordx4 a[20:23], v15, s[44:47], s65 offen offset:0 sc1
v_mfma_f32_16x16x32_bf16 v[24:27], a[180:183], a[212:215], v[24:27]
v_mfma_f32_16x16x32_bf16 v[24:27], a[176:179], a[208:211], v[24:27]
v_mfma_f32_16x16x32_bf16 v[28:31], a[184:187], a[208:211], v[28:31]
v_mfma_f32_16x16x32_bf16 v[28:31], a[188:191], a[212:215], v[28:31]
buffer_load_dwordx4 a[28:31], v15, s[44:47], s65 offen offset:1024 sc1
v_mfma_f32_16x16x32_bf16 v[60:63], a[188:191], a[220:223], v[60:63]
v_mfma_f32_16x16x32_bf16 v[60:63], a[184:187], a[216:219], v[60:63]
s_waitcnt vmcnt(24)
s_barrier
v_mfma_f32_16x16x32_bf16 v[92:95], a[184:187], a[224:227], v[92:95]
s_xor_b32 m0, s76, 98304
ds_read_b64_tr_b16 a[144:145], v196 offset:0
v_mfma_f32_16x16x32_bf16 v[92:95], a[188:191], a[228:231], v[92:95]
s_xor_b32 s64, s85, 786432
ds_read_b64_tr_b16 a[146:147], v196 offset:4096
v_mfma_f32_16x16x32_bf16 v[124:127], a[188:191], a[236:239], v[124:127]
buffer_load_dwordx4 v12, s[40:43], s64 offen lds
v_mfma_f32_16x16x32_bf16 v[124:127], a[184:187], a[232:235], v[124:127]
s_waitcnt lgkmcnt(2)
s_xor_b32 m0, s76, 99328
ds_read_b64_tr_b16 a[148:149], v196 offset:8192
v_mfma_f32_16x16x32_bf16 v[128:131], a[192:195], a[232:235], v[128:131]
s_xor_b32 s64, s85, 794624
ds_read_b64_tr_b16 a[150:151], v196 offset:12288
v_mfma_f32_16x16x32_bf16 v[128:131], a[196:199], a[236:239], v[128:131]
buffer_load_dwordx4 v13, s[40:43], s64 offen lds
v_mfma_f32_16x16x32_bf16 v[96:99], a[196:199], a[228:231], v[96:99]
ds_read_b64_tr_b16 a[152:153], v197 offset:0
v_mfma_f32_16x16x32_bf16 v[96:99], a[192:195], a[224:227], v[96:99]
s_xor_b32 m0, s76, 100352
ds_read_b64_tr_b16 a[154:155], v197 offset:4096
v_mfma_f32_16x16x32_bf16 v[64:67], a[192:195], a[216:219], v[64:67]
s_xor_b32 s64, s85, 802816
ds_read_b64_tr_b16 a[156:157], v197 offset:8192
v_mfma_f32_16x16x32_bf16 v[64:67], a[196:199], a[220:223], v[64:67]
buffer_load_dwordx4 v12, s[40:43], s64 offen lds
v_mfma_f32_16x16x32_bf16 v[32:35], a[196:199], a[212:215], v[32:35]
ds_read_b64_tr_b16 a[158:159], v197 offset:12288
v_mfma_f32_16x16x32_bf16 v[32:35], a[192:195], a[208:211], v[32:35]
s_xor_b32 m0, s76, 101376
ds_read_b64_tr_b16 a[160:161], v198 offset:0
v_mfma_f32_16x16x32_bf16 v[36:39], a[200:203], a[208:211], v[36:39]
s_xor_b32 s64, s85, 811008
ds_read_b64_tr_b16 a[162:163], v198 offset:4096
v_mfma_f32_16x16x32_bf16 v[36:39], a[204:207], a[212:215], v[36:39]
buffer_load_dwordx4 v13, s[40:43], s64 offen lds
v_mfma_f32_16x16x32_bf16 v[68:71], a[204:207], a[220:223], v[68:71]
s_xor_b32 m0, s76, 102400
ds_read_b64_tr_b16 a[164:165], v198 offset:8192
v_mfma_f32_16x16x32_bf16 v[68:71], a[200:203], a[216:219], v[68:71]
s_xor_b32 s64, s85, 819200
ds_read_b64_tr_b16 a[166:167], v198 offset:12288
v_mfma_f32_16x16x32_bf16 v[100:103], a[200:203], a[224:227], v[100:103]
s_xor_b32 s66, s2, 1
s_lshl2_add_u32 s66, s66, s30
s_lshl_b32 s73, s66, 12
v_mfma_f32_16x16x32_bf16 v[100:103], a[204:207], a[228:231], v[100:103]
s_add_u32 s73, s73, 67108864
buffer_load_dwordx4 v12, s[40:43], s64 offen lds
v_mfma_f32_16x16x32_bf16 v[132:135], a[204:207], a[236:239], v[132:135]
s_lshl2_add_u32 s66, s2, s30
s_lshl_b32 s75, s66, 12
s_add_u32 s75, s75, 67108864
v_mfma_f32_16x16x32_bf16 v[132:135], a[200:203], a[232:235], v[132:135]
s_waitcnt vmcnt(25)
s_waitcnt lgkmcnt(3)
s_lshl_b32 s77, s82, 18
s_lshl_b32 s66, s30, 16
s_add_u32 s77, s77, s66
s_xor_b32 m0, s76, 103424
v_mfma_f32_16x16x32_bf16 v[136:139], a[144:147], v[176:179], v[136:139]
s_waitcnt vmcnt(21)
s_add_u32 s77, s77, s87
s_lshl_b32 s66, s83, 7
s_xor_b32 s64, s85, 827392
ds_read_b64_tr_b16 a[168:169], v199 offset:0
v_mfma_f32_16x16x32_bf16 v[136:139], a[148:151], v[180:183], v[136:139]
s_add_u32 s77, s77, s66
buffer_load_dwordx4 v13, s[40:43], s64 offen lds
v_mfma_f32_16x16x32_bf16 v[104:107], a[148:151], v[172:175], v[104:107]
ds_read_b64_tr_b16 a[170:171], v199 offset:4096
v_lshlrev_b32 v1, 24, v0
v_mfma_f32_16x16x32_bf16 v[104:107], a[144:147], v[168:171], v[104:107]
s_xor_b32 m0, s76, 104448
ds_read_b64_tr_b16 a[172:173], v199 offset:8192
v_and_b32 v8, 7, v0
v_mfma_f32_16x16x32_bf16 v[72:75], a[144:147], v[160:163], v[72:75]
s_xor_b32 s64, s85, 835584
ds_read_b64_tr_b16 a[174:175], v199 offset:12288
v_lshlrev_b32 v8, 11, v8
v_mfma_f32_16x16x32_bf16 v[72:75], a[148:151], v[164:167], v[72:75]
buffer_load_dwordx4 v12, s[40:43], s64 offen lds
v_mfma_f32_16x16x32_bf16 v[40:43], a[148:151], v[156:159], v[40:43]
ds_read_b64_tr_b16 a[176:177], v192 offset:0
v_bfe_u32 v10, v0, 3, 1
v_mfma_f32_16x16x32_bf16 v[40:43], a[144:147], v[152:155], v[40:43]
s_xor_b32 m0, s76, 105472
ds_read_b64_tr_b16 a[178:179], v192 offset:4096
v_lshl_add_u32 v8, v10, 6, v8
v_mfma_f32_16x16x32_bf16 v[44:47], a[152:155], v[152:155], v[44:47]
s_xor_b32 s64, s85, 843776
ds_read_b64_tr_b16 a[180:181], v192 offset:8192
v_bfe_u32 v10, v0, 4, 1
v_mfma_f32_16x16x32_bf16 v[44:47], a[156:159], v[156:159], v[44:47]
buffer_load_dwordx4 v13, s[40:43], s64 offen lds
v_mfma_f32_16x16x32_bf16 v[76:79], a[156:159], v[164:167], v[76:79]
ds_read_b64_tr_b16 a[182:183], v192 offset:12288
v_lshl_add_u32 v8, v10, 5, v8
v_mfma_f32_16x16x32_bf16 v[76:79], a[152:155], v[160:163], v[76:79]
ds_read_b64_tr_b16 a[184:185], v193 offset:0
v_lshrrev_b32 v10, 5, v0
v_mfma_f32_16x16x32_bf16 v[108:111], a[152:155], v[168:171], v[108:111]
s_xor_b32 s65, s84, 98304
ds_read_b64_tr_b16 a[186:187], v193 offset:4096
v_lshl_add_u32 v8, v10, 4, v8
v_mfma_f32_16x16x32_bf16 v[108:111], a[156:159], v[172:175], v[108:111]
buffer_load_dwordx4 a[32:35], v14, s[44:47], s65 offen offset:0 sc1
v_mfma_f32_16x16x32_bf16 v[140:143], a[156:159], v[180:183], v[140:143]
ds_read_b64_tr_b16 a[188:189], v193 offset:8192
v_add_u32 v2, s86, v16
v_mfma_f32_16x16x32_bf16 v[140:143], a[152:155], v[176:179], v[140:143]
s_waitcnt lgkmcnt(5)
ds_read_b64_tr_b16 a[190:191], v193 offset:12288
v_xor_b32 v3, 0x2000, v2
v_mfma_f32_16x16x32_bf16 v[144:147], a[160:163], v[176:179], v[144:147]
v_mov_b32 v232, 0
v_mov_b32 v233, 0
v_mfma_f32_16x16x32_bf16 v[144:147], a[164:167], v[180:183], v[144:147]
buffer_load_dwordx4 a[40:43], v14, s[44:47], s65 offen offset:1024 sc1
v_mfma_f32_16x16x32_bf16 v[112:115], a[164:167], v[172:175], v[112:115]
ds_read_b64_tr_b16 a[192:193], v194 offset:0
v_mov_b32 v236, 0
v_mfma_f32_16x16x32_bf16 v[112:115], a[160:163], v[168:171], v[112:115]
ds_read_b64_tr_b16 a[194:195], v194 offset:4096
v_mov_b32 v237, 0
v_mfma_f32_16x16x32_bf16 v[80:83], a[160:163], v[160:163], v[80:83]
ds_read_b64_tr_b16 a[196:197], v194 offset:8192
v_and_b32 v9, 1, v0
v_mfma_f32_16x16x32_bf16 v[80:83], a[164:167], v[164:167], v[80:83]
buffer_load_dwordx4 a[48:51], v15, s[44:47], s65 offen offset:0 sc1
v_mfma_f32_16x16x32_bf16 v[48:51], a[164:167], v[156:159], v[48:51]
ds_read_b64_tr_b16 a[198:199], v194 offset:12288
v_lshlrev_b32 v9, 4, v9
v_mfma_f32_16x16x32_bf16 v[48:51], a[160:163], v[152:155], v[48:51]
v_mov_b32 v10, 0x3f80
v_lshlrev_b32 v9, v9, v10
v_mfma_f32_16x16x32_bf16 v[52:55], a[168:171], v[152:155], v[52:55]
v_lshrrev_b32 v10, 4, v0
v_lshlrev_b32 v10, 1, v10
v_mfma_f32_16x16x32_bf16 v[52:55], a[172:175], v[156:159], v[52:55]
buffer_load_dwordx4 a[56:59], v15, s[44:47], s65 offen offset:1024 sc1
v_mfma_f32_16x16x32_bf16 v[84:87], a[172:175], v[164:167], v[84:87]
ds_read_b64_tr_b16 a[200:201], v195 offset:0
v_bfe_u32 v11, v0, 1, 3
v_mfma_f32_16x16x32_bf16 v[84:87], a[168:171], v[160:163], v[84:87]
ds_read_b64_tr_b16 a[202:203], v195 offset:4096
v_xor_b32 v10, v10, v11
v_mfma_f32_16x16x32_bf16 v[116:119], a[168:171], v[168:171], v[116:119]
s_xor_b32 s65, s84, 106496
ds_read_b64_tr_b16 a[204:205], v195 offset:8192
v_subrev_u32 v11, 1, v10
v_mfma_f32_16x16x32_bf16 v[116:119], a[172:175], v[172:175], v[116:119]
buffer_load_dwordx4 a[36:39], v14, s[44:47], s65 offen offset:0 sc1
v_mfma_f32_16x16x32_bf16 v[148:151], a[172:175], v[180:183], v[148:151]
ds_read_b64_tr_b16 a[206:207], v195 offset:12288
v_ashrrev_i32 v11, 31, v11
v_mfma_f32_16x16x32_bf16 v[148:151], a[168:171], v[176:179], v[148:151]
v_and_b32 v234, v11, v9
v_xor_b32 v10, 1, v10
v_mfma_f32_16x16x32_bf16 v[120:123], a[176:179], v[176:179], v[120:123]
s_waitcnt lgkmcnt(4)
v_subrev_u32 v11, 1, v10
v_ashrrev_i32 v11, 31, v11
v_mfma_f32_16x16x32_bf16 v[120:123], a[180:183], v[180:183], v[120:123]
buffer_load_dwordx4 a[44:47], v14, s[44:47], s65 offen offset:1024 sc1
v_mfma_f32_16x16x32_bf16 v[88:91], a[180:183], v[172:175], v[88:91]
v_and_b32 v235, v11, v9
v_mfma_f32_16x16x32_bf16 v[88:91], a[176:179], v[168:171], v[88:91]
s_mov_b32 s48, s24
s_mov_b32 s49, s25
s_mov_b32 s50, 4194304
v_mfma_f32_16x16x32_bf16 v[56:59], a[176:179], v[160:163], v[56:59]
s_mov_b32 s51, 0x20000
v_mfma_f32_16x16x32_bf16 v[56:59], a[180:183], v[164:167], v[56:59]
buffer_load_dwordx4 a[52:55], v15, s[44:47], s65 offen offset:0 sc1
v_mfma_f32_16x16x32_bf16 v[24:27], a[180:183], v[156:159], v[24:27]
v_mfma_f32_16x16x32_bf16 v[24:27], a[176:179], v[152:155], v[24:27]
v_mfma_f32_16x16x32_bf16 v[28:31], a[184:187], v[152:155], v[28:31]
v_mfma_f32_16x16x32_bf16 v[28:31], a[188:191], v[156:159], v[28:31]
buffer_load_dwordx4 a[60:63], v15, s[44:47], s65 offen offset:1024 sc1
v_mfma_f32_16x16x32_bf16 v[60:63], a[188:191], v[164:167], v[60:63]
v_mfma_f32_16x16x32_bf16 v[60:63], a[184:187], v[160:163], v[60:63]
s_waitcnt vmcnt(24)
s_barrier
v_mfma_f32_16x16x32_bf16 v[92:95], a[184:187], v[168:171], v[92:95]
ds_read_b64_tr_b16 a[144:145], v196 offset:32768
v_mfma_f32_16x16x32_bf16 v[92:95], a[188:191], v[172:175], v[92:95]
ds_read_b64_tr_b16 a[146:147], v196 offset:36864
v_mfma_f32_16x16x32_bf16 v[124:127], a[188:191], v[180:183], v[124:127]
ds_read_b64_tr_b16 a[148:149], v196 offset:40960
v_mfma_f32_16x16x32_bf16 v[124:127], a[184:187], v[176:179], v[124:127]
ds_read_b64_tr_b16 a[150:151], v196 offset:45056
v_mfma_f32_16x16x32_bf16 v[128:131], a[192:195], v[176:179], v[128:131]
ds_read_b64_tr_b16 a[152:153], v197 offset:32768
v_mfma_f32_16x16x32_bf16 v[128:131], a[196:199], v[180:183], v[128:131]
ds_read_b64_tr_b16 a[154:155], v197 offset:36864
v_mfma_f32_16x16x32_bf16 v[96:99], a[196:199], v[172:175], v[96:99]
ds_read_b64_tr_b16 a[156:157], v197 offset:40960
v_mfma_f32_16x16x32_bf16 v[96:99], a[192:195], v[168:171], v[96:99]
ds_read_b64_tr_b16 a[158:159], v197 offset:45056
v_mfma_f32_16x16x32_bf16 v[64:67], a[192:195], v[160:163], v[64:67]
ds_read_b64_tr_b16 a[160:161], v198 offset:32768
v_mfma_f32_16x16x32_bf16 v[64:67], a[196:199], v[164:167], v[64:67]
ds_read_b64_tr_b16 a[162:163], v198 offset:36864
v_mfma_f32_16x16x32_bf16 v[32:35], a[196:199], v[156:159], v[32:35]
ds_read_b64_tr_b16 a[164:165], v198 offset:40960
v_mfma_f32_16x16x32_bf16 v[32:35], a[192:195], v[152:155], v[32:35]
s_waitcnt lgkmcnt(7)
ds_read_b64_tr_b16 a[166:167], v198 offset:45056
v_mfma_f32_16x16x32_bf16 v[36:39], a[200:203], v[152:155], v[36:39]
v_mfma_f32_16x16x32_bf16 v[36:39], a[204:207], v[156:159], v[36:39]
v_mfma_f32_16x16x32_bf16 v[68:71], a[204:207], v[164:167], v[68:71]
v_mfma_f32_16x16x32_bf16 v[68:71], a[200:203], v[160:163], v[68:71]
v_mfma_f32_16x16x32_bf16 v[100:103], a[200:203], v[168:171], v[100:103]
v_mfma_f32_16x16x32_bf16 v[100:103], a[204:207], v[172:175], v[100:103]
v_mfma_f32_16x16x32_bf16 v[132:135], a[204:207], v[180:183], v[132:135]
v_mfma_f32_16x16x32_bf16 v[132:135], a[200:203], v[176:179], v[132:135]
s_waitcnt vmcnt(20)
v_mfma_f32_16x16x32_bf16 v[136:139], a[144:147], a[24:27], v[136:139]
s_waitcnt vmcnt(16)
ds_read_b64_tr_b16 a[168:169], v199 offset:32768
v_mfma_f32_16x16x32_bf16 v[136:139], a[148:151], a[28:31], v[136:139]
ds_read_b64_tr_b16 a[170:171], v199 offset:36864
v_mfma_f32_16x16x32_bf16 v[104:107], a[148:151], a[20:23], v[104:107]
ds_read_b64_tr_b16 a[172:173], v199 offset:40960
v_mfma_f32_16x16x32_bf16 v[104:107], a[144:147], a[16:19], v[104:107]
ds_read_b64_tr_b16 a[174:175], v199 offset:45056
v_mfma_f32_16x16x32_bf16 v[72:75], a[144:147], a[8:11], v[72:75]
v_mfma_f32_16x16x32_bf16 v[72:75], a[148:151], a[12:15], v[72:75]
v_mfma_f32_16x16x32_bf16 v[40:43], a[148:151], a[4:7], v[40:43]
s_waitcnt vmcnt(8)
s_barrier
v_mfma_f32_16x16x32_bf16 v[40:43], a[144:147], a[0:3], v[40:43]
s_waitcnt lgkmcnt(4)
ds_read_b64_tr_b16 a[176:177], v188 offset:0
v_mfma_f32_16x16x32_bf16 v[44:47], a[152:155], a[0:3], v[44:47]
ds_read_b64_tr_b16 a[178:179], v188 offset:4096
v_mfma_f32_16x16x32_bf16 v[44:47], a[156:159], a[4:7], v[44:47]
ds_read_b64_tr_b16 a[180:181], v188 offset:8192
v_mfma_f32_16x16x32_bf16 v[76:79], a[156:159], a[12:15], v[76:79]
ds_read_b64_tr_b16 a[182:183], v188 offset:12288
v_mfma_f32_16x16x32_bf16 v[76:79], a[152:155], a[8:11], v[76:79]
ds_read_b64_tr_b16 a[184:185], v189 offset:0
v_mfma_f32_16x16x32_bf16 v[108:111], a[152:155], a[16:19], v[108:111]
ds_read_b64_tr_b16 a[186:187], v189 offset:4096
v_mfma_f32_16x16x32_bf16 v[108:111], a[156:159], a[20:23], v[108:111]
ds_read_b64_tr_b16 a[188:189], v189 offset:8192
v_mfma_f32_16x16x32_bf16 v[140:143], a[156:159], a[28:31], v[140:143]
ds_read_b64_tr_b16 a[190:191], v189 offset:12288
v_mfma_f32_16x16x32_bf16 v[140:143], a[152:155], a[24:27], v[140:143]
v_mfma_f32_16x16x32_bf16 v[144:147], a[160:163], a[24:27], v[144:147]
v_mfma_f32_16x16x32_bf16 v[144:147], a[164:167], a[28:31], v[144:147]
v_mfma_f32_16x16x32_bf16 v[112:115], a[164:167], a[20:23], v[112:115]
ds_read_b64_tr_b16 a[192:193], v190 offset:0
v_mfma_f32_16x16x32_bf16 v[112:115], a[160:163], a[16:19], v[112:115]
ds_read_b64_tr_b16 a[194:195], v190 offset:4096
v_mfma_f32_16x16x32_bf16 v[80:83], a[160:163], a[8:11], v[80:83]
ds_read_b64_tr_b16 a[196:197], v190 offset:8192
v_mfma_f32_16x16x32_bf16 v[80:83], a[164:167], a[12:15], v[80:83]
ds_read_b64_tr_b16 a[198:199], v190 offset:12288
v_mfma_f32_16x16x32_bf16 v[48:51], a[164:167], a[4:7], v[48:51]
v_mfma_f32_16x16x32_bf16 v[48:51], a[160:163], a[0:3], v[48:51]
s_waitcnt lgkmcnt(4)
v_mfma_f32_16x16x32_bf16 v[52:55], a[168:171], a[0:3], v[52:55]
v_mfma_f32_16x16x32_bf16 v[52:55], a[172:175], a[4:7], v[52:55]
v_mfma_f32_16x16x32_bf16 v[84:87], a[172:175], a[12:15], v[84:87]
ds_read_b64_tr_b16 a[200:201], v191 offset:0
v_mfma_f32_16x16x32_bf16 v[84:87], a[168:171], a[8:11], v[84:87]
ds_read_b64_tr_b16 a[202:203], v191 offset:4096
v_mfma_f32_16x16x32_bf16 v[116:119], a[168:171], a[16:19], v[116:119]
ds_read_b64_tr_b16 a[204:205], v191 offset:8192
v_mfma_f32_16x16x32_bf16 v[116:119], a[172:175], a[20:23], v[116:119]
ds_read_b64_tr_b16 a[206:207], v191 offset:12288
v_mfma_f32_16x16x32_bf16 v[148:151], a[172:175], a[28:31], v[148:151]
v_mfma_f32_16x16x32_bf16 v[148:151], a[168:171], a[24:27], v[148:151]
s_waitcnt vmcnt(4)
v_mfma_f32_16x16x32_bf16 v[136:139], a[176:179], a[56:59], v[136:139]
s_waitcnt vmcnt(0)
v_mfma_f32_16x16x32_bf16 v[136:139], a[180:183], a[60:63], v[136:139]
v_mfma_f32_16x16x32_bf16 v[104:107], a[180:183], a[52:55], v[104:107]
ds_read_b64_tr_b16 a[144:145], v192 offset:32768
v_mfma_f32_16x16x32_bf16 v[104:107], a[176:179], a[48:51], v[104:107]
ds_read_b64_tr_b16 a[146:147], v192 offset:36864
v_mfma_f32_16x16x32_bf16 v[72:75], a[176:179], a[40:43], v[72:75]
ds_read_b64_tr_b16 a[148:149], v192 offset:40960
v_mfma_f32_16x16x32_bf16 v[72:75], a[180:183], a[44:47], v[72:75]
ds_read_b64_tr_b16 a[150:151], v192 offset:45056
v_mfma_f32_16x16x32_bf16 v[40:43], a[180:183], a[36:39], v[40:43]
v_mfma_f32_16x16x32_bf16 v[40:43], a[176:179], a[32:35], v[40:43]
v_mfma_f32_16x16x32_bf16 v[44:47], a[184:187], a[32:35], v[44:47]
v_mfma_f32_16x16x32_bf16 v[44:47], a[188:191], a[36:39], v[44:47]
ds_write_b128 v3, v[136:139] offset:4096
v_mfma_f32_16x16x32_bf16 v[76:79], a[188:191], a[44:47], v[76:79]
ds_read_b64_tr_b16 a[152:153], v193 offset:32768
v_mfma_f32_16x16x32_bf16 v[76:79], a[184:187], a[40:43], v[76:79]
ds_write_b128 v3, v[104:107] offset:0
v_mfma_f32_16x16x32_bf16 v[108:111], a[184:187], a[48:51], v[108:111]
ds_read_b64_tr_b16 a[154:155], v193 offset:36864
v_mfma_f32_16x16x32_bf16 v[108:111], a[188:191], a[52:55], v[108:111]
ds_read_b64_tr_b16 a[156:157], v193 offset:40960
v_mfma_f32_16x16x32_bf16 v[140:143], a[188:191], a[60:63], v[140:143]
ds_read_b64_tr_b16 a[158:159], v193 offset:45056
v_mfma_f32_16x16x32_bf16 v[140:143], a[184:187], a[56:59], v[140:143]
s_waitcnt lgkmcnt(6)
v_mfma_f32_16x16x32_bf16 v[144:147], a[192:195], a[56:59], v[144:147]
v_mfma_f32_16x16x32_bf16 v[144:147], a[196:199], a[60:63], v[144:147]
v_mfma_f32_16x16x32_bf16 v[112:115], a[196:199], a[52:55], v[112:115]
ds_read_b64_tr_b16 a[160:161], v194 offset:32768
v_mfma_f32_16x16x32_bf16 v[112:115], a[192:195], a[48:51], v[112:115]
ds_read_b64_tr_b16 a[162:163], v194 offset:36864
v_mfma_f32_16x16x32_bf16 v[80:83], a[192:195], a[40:43], v[80:83]
ds_read_b64_tr_b16 a[164:165], v194 offset:40960
v_mfma_f32_16x16x32_bf16 v[80:83], a[196:199], a[44:47], v[80:83]
ds_write_b128 v3, v[108:111] offset:1024
v_mfma_f32_16x16x32_bf16 v[48:51], a[196:199], a[36:39], v[48:51]
ds_read_b64_tr_b16 a[166:167], v194 offset:45056
v_mfma_f32_16x16x32_bf16 v[48:51], a[192:195], a[32:35], v[48:51]
ds_write_b128 v3, v[140:143] offset:5120
v_mfma_f32_16x16x32_bf16 v[52:55], a[200:203], a[32:35], v[52:55]
v_mfma_f32_16x16x32_bf16 v[52:55], a[204:207], a[36:39], v[52:55]
ds_write_b128 v3, v[144:147] offset:6144
v_mfma_f32_16x16x32_bf16 v[84:87], a[204:207], a[44:47], v[84:87]
ds_read_b64_tr_b16 a[168:169], v195 offset:32768
v_mfma_f32_16x16x32_bf16 v[84:87], a[200:203], a[40:43], v[84:87]
ds_write_b128 v3, v[112:115] offset:2048
v_mfma_f32_16x16x32_bf16 v[116:119], a[200:203], a[48:51], v[116:119]
ds_read_b64_tr_b16 a[170:171], v195 offset:36864
v_mfma_f32_16x16x32_bf16 v[116:119], a[204:207], a[52:55], v[116:119]
ds_read_b64_tr_b16 a[172:173], v195 offset:40960
v_mfma_f32_16x16x32_bf16 v[148:151], a[204:207], a[60:63], v[148:151]
ds_read_b64_tr_b16 a[174:175], v195 offset:45056
v_mfma_f32_16x16x32_bf16 v[148:151], a[200:203], a[56:59], v[148:151]
v_mfma_f32_16x16x32_bf16 v[120:123], a[144:147], a[24:27], v[120:123]
v_mfma_f32_16x16x32_bf16 v[120:123], a[148:151], a[28:31], v[120:123]
v_mfma_f32_16x16x32_bf16 v[88:91], a[148:151], a[20:23], v[88:91]
ds_read_b64_tr_b16 a[176:177], v184 offset:0
v_mfma_f32_16x16x32_bf16 v[88:91], a[144:147], a[16:19], v[88:91]
ds_read_b64_tr_b16 a[178:179], v184 offset:4096
v_mfma_f32_16x16x32_bf16 v[56:59], a[144:147], a[8:11], v[56:59]
ds_read_b64_tr_b16 a[180:181], v184 offset:8192
v_mfma_f32_16x16x32_bf16 v[56:59], a[148:151], a[12:15], v[56:59]
ds_write_b128 v3, v[116:119] offset:3072
v_mfma_f32_16x16x32_bf16 v[24:27], a[148:151], a[4:7], v[24:27]
ds_read_b64_tr_b16 a[182:183], v184 offset:12288
v_mfma_f32_16x16x32_bf16 v[24:27], a[144:147], a[0:3], v[24:27]
s_waitcnt lgkmcnt(5)
ds_write_b128 v3, v[148:151] offset:7168
v_mfma_f32_16x16x32_bf16 v[28:31], a[152:155], a[0:3], v[28:31]
v_mfma_f32_16x16x32_bf16 v[28:31], a[156:159], a[4:7], v[28:31]
v_mfma_f32_16x16x32_bf16 v[60:63], a[156:159], a[12:15], v[60:63]
s_waitcnt lgkmcnt(0)
s_barrier
v_mfma_f32_16x16x32_bf16 v[60:63], a[152:155], a[8:11], v[60:63]
ds_read_b128 v[200:203], v2 offset:0
ds_read_b128 v[204:207], v2 offset:1024
v_mfma_f32_16x16x32_bf16 v[92:95], a[152:155], a[16:19], v[92:95]
ds_read_b128 v[208:211], v2 offset:2048
ds_read_b128 v[212:215], v2 offset:3072
v_mfma_f32_16x16x32_bf16 v[92:95], a[156:159], a[20:23], v[92:95]
ds_read_b128 v[216:219], v2 offset:4096
ds_read_b128 v[220:223], v2 offset:5120
v_mfma_f32_16x16x32_bf16 v[124:127], a[156:159], a[28:31], v[124:127]
ds_read_b128 v[224:227], v2 offset:6144
ds_read_b128 v[228:231], v2 offset:7168
v_mfma_f32_16x16x32_bf16 v[124:127], a[152:155], a[24:27], v[124:127]
ds_read_b64_tr_b16 a[184:185], v185 offset:0
v_mfma_f32_16x16x32_bf16 v[128:131], a[160:163], a[24:27], v[128:131]
ds_read_b64_tr_b16 a[186:187], v185 offset:4096
v_mfma_f32_16x16x32_bf16 v[128:131], a[164:167], a[28:31], v[128:131]
ds_read_b64_tr_b16 a[188:189], v185 offset:8192
v_mfma_f32_16x16x32_bf16 v[96:99], a[164:167], a[20:23], v[96:99]
s_waitcnt lgkmcnt(10)
ds_read_b64_tr_b16 a[190:191], v185 offset:12288
v_add_f32 v200, v200, v40
v_mfma_f32_16x16x32_bf16 v[96:99], a[160:163], a[16:19], v[96:99]
ds_read_b64_tr_b16 a[192:193], v186 offset:0
v_add_f32 v201, v201, v41
v_mfma_f32_16x16x32_bf16 v[64:67], a[160:163], a[8:11], v[64:67]
ds_read_b64_tr_b16 a[194:195], v186 offset:4096
v_add_f32 v202, v202, v42
v_mfma_f32_16x16x32_bf16 v[64:67], a[164:167], a[12:15], v[64:67]
ds_read_b64_tr_b16 a[196:197], v186 offset:8192
v_add_f32 v203, v203, v43
v_mfma_f32_16x16x32_bf16 v[32:35], a[164:167], a[4:7], v[32:35]
s_waitcnt lgkmcnt(7)
ds_read_b64_tr_b16 a[198:199], v186 offset:12288
v_add_f32 v204, v204, v44
v_mfma_f32_16x16x32_bf16 v[32:35], a[160:163], a[0:3], v[32:35]
v_add_f32 v205, v205, v45
v_add_f32 v206, v206, v46
v_mfma_f32_16x16x32_bf16 v[36:39], a[168:171], a[0:3], v[36:39]
v_add_f32 v207, v207, v47
v_cvt_pk_bf16_f32 v200, v200, v201
v_mfma_f32_16x16x32_bf16 v[36:39], a[172:175], a[4:7], v[36:39]
v_cvt_pk_bf16_f32 v201, v202, v203
v_cvt_pk_bf16_f32 v202, v204, v205
v_cvt_pk_bf16_f32 v203, v206, v207
v_mfma_f32_16x16x32_bf16 v[68:71], a[172:175], a[12:15], v[68:71]
buffer_store_dwordx4 v[200:203], v16, s[44:47], s73 offen offset:0 sc1
v_mfma_f32_16x16x32_bf16 v[68:71], a[168:171], a[8:11], v[68:71]
ds_read_b64_tr_b16 a[200:201], v187 offset:0
v_add_f32 v208, v208, v48
v_mfma_f32_16x16x32_bf16 v[100:103], a[168:171], a[16:19], v[100:103]
ds_read_b64_tr_b16 a[202:203], v187 offset:4096
v_add_f32 v209, v209, v49
v_mfma_f32_16x16x32_bf16 v[100:103], a[172:175], a[20:23], v[100:103]
ds_read_b64_tr_b16 a[204:205], v187 offset:8192
v_add_f32 v210, v210, v50
v_mfma_f32_16x16x32_bf16 v[132:135], a[172:175], a[28:31], v[132:135]
ds_read_b64_tr_b16 a[206:207], v187 offset:12288
v_add_f32 v211, v211, v51
v_mfma_f32_16x16x32_bf16 v[132:135], a[168:171], a[24:27], v[132:135]
v_add_f32 v212, v212, v52
v_add_f32 v213, v213, v53
v_mfma_f32_16x16x32_bf16 v[120:123], a[176:179], a[56:59], v[120:123]
v_add_f32 v214, v214, v54
v_add_f32 v215, v215, v55
v_mfma_f32_16x16x32_bf16 v[120:123], a[180:183], a[60:63], v[120:123]
v_cvt_pk_bf16_f32 v208, v208, v209
v_cvt_pk_bf16_f32 v209, v210, v211
v_cvt_pk_bf16_f32 v210, v212, v213
v_cvt_pk_bf16_f32 v211, v214, v215
v_mfma_f32_16x16x32_bf16 v[88:91], a[180:183], a[52:55], v[88:91]
buffer_store_dwordx4 v[208:211], v16, s[44:47], s73 offen offset:1024 sc1
v_mfma_f32_16x16x32_bf16 v[88:91], a[176:179], a[48:51], v[88:91]
v_add_f32 v216, v216, v72
v_add_f32 v217, v217, v73
v_mfma_f32_16x16x32_bf16 v[56:59], a[176:179], a[40:43], v[56:59]
v_add_f32 v218, v218, v74
v_add_f32 v219, v219, v75
v_mfma_f32_16x16x32_bf16 v[56:59], a[180:183], a[44:47], v[56:59]
s_branch L_po23
L_pg23:
s_branch L_tr2
L_po23:
v_add_f32 v220, v220, v76
v_add_f32 v221, v221, v77
v_mfma_f32_16x16x32_bf16 v[24:27], a[180:183], a[36:39], v[24:27]
v_add_f32 v222, v222, v78
v_add_f32 v223, v223, v79
v_mfma_f32_16x16x32_bf16 v[24:27], a[176:179], a[32:35], v[24:27]
s_waitcnt lgkmcnt(0)
v_cvt_pk_bf16_f32 v216, v216, v217
v_cvt_pk_bf16_f32 v217, v218, v219
v_mfma_f32_16x16x32_bf16 v[28:31], a[184:187], a[32:35], v[28:31]
v_cvt_pk_bf16_f32 v218, v220, v221
v_cvt_pk_bf16_f32 v219, v222, v223
v_mfma_f32_16x16x32_bf16 v[28:31], a[188:191], a[36:39], v[28:31]
buffer_store_dwordx4 v[216:219], v16, s[44:47], s73 offen offset:2048 sc1
v_mfma_f32_16x16x32_bf16 v[60:63], a[188:191], a[44:47], v[60:63]
v_add_f32 v224, v224, v80
v_add_f32 v225, v225, v81
v_mfma_f32_16x16x32_bf16 v[60:63], a[184:187], a[40:43], v[60:63]
v_add_f32 v226, v226, v82
v_add_f32 v227, v227, v83
v_mfma_f32_16x16x32_bf16 v[92:95], a[184:187], a[48:51], v[92:95]
v_add_f32 v228, v228, v84
v_add_f32 v229, v229, v85
v_mfma_f32_16x16x32_bf16 v[92:95], a[188:191], a[52:55], v[92:95]
v_add_f32 v230, v230, v86
v_add_f32 v231, v231, v87
v_mfma_f32_16x16x32_bf16 v[124:127], a[188:191], a[60:63], v[124:127]
v_cvt_pk_bf16_f32 v224, v224, v225
v_cvt_pk_bf16_f32 v225, v226, v227
v_mfma_f32_16x16x32_bf16 v[124:127], a[184:187], a[56:59], v[124:127]
v_cvt_pk_bf16_f32 v226, v228, v229
v_cvt_pk_bf16_f32 v227, v230, v231
v_mfma_f32_16x16x32_bf16 v[128:131], a[192:195], a[56:59], v[128:131]
buffer_store_dwordx4 v[224:227], v16, s[44:47], s73 offen offset:3072 sc1
v_mfma_f32_16x16x32_bf16 v[128:131], a[196:199], a[60:63], v[128:131]
ds_write_b128 v3, v[120:123] offset:36864
v_mfma_f32_16x16x32_bf16 v[96:99], a[196:199], a[52:55], v[96:99]
ds_write_b128 v3, v[88:91] offset:32768
v_mfma_f32_16x16x32_bf16 v[96:99], a[192:195], a[48:51], v[96:99]
v_mfma_f32_16x16x32_bf16 v[64:67], a[192:195], a[40:43], v[64:67]
v_mfma_f32_16x16x32_bf16 v[64:67], a[196:199], a[44:47], v[64:67]
ds_write_b128 v3, v[92:95] offset:33792
v_mfma_f32_16x16x32_bf16 v[32:35], a[196:199], a[36:39], v[32:35]
v_mfma_f32_16x16x32_bf16 v[32:35], a[192:195], a[32:35], v[32:35]
ds_write_b128 v3, v[124:127] offset:37888
v_mfma_f32_16x16x32_bf16 v[36:39], a[200:203], a[32:35], v[36:39]
v_mfma_f32_16x16x32_bf16 v[36:39], a[204:207], a[36:39], v[36:39]
ds_write_b128 v3, v[128:131] offset:38912
v_mfma_f32_16x16x32_bf16 v[68:71], a[204:207], a[44:47], v[68:71]
v_mfma_f32_16x16x32_bf16 v[68:71], a[200:203], a[40:43], v[68:71]
ds_write_b128 v3, v[96:99] offset:34816
v_mfma_f32_16x16x32_bf16 v[100:103], a[200:203], a[48:51], v[100:103]
v_mfma_f32_16x16x32_bf16 v[100:103], a[204:207], a[52:55], v[100:103]
v_mfma_f32_16x16x32_bf16 v[132:135], a[204:207], a[60:63], v[132:135]
v_mfma_f32_16x16x32_bf16 v[132:135], a[200:203], a[56:59], v[132:135]
buffer_load_dwordx4 v[152:155], v16, s[44:47], s75 offen offset:0 sc1
buffer_load_dwordx4 v[156:159], v16, s[44:47], s75 offen offset:1024 sc1
buffer_load_dwordx4 v[160:163], v16, s[44:47], s75 offen offset:2048 sc1
buffer_load_dwordx4 v[164:167], v16, s[44:47], s75 offen offset:3072 sc1
s_nop 3
ds_write_b128 v3, v[100:103] offset:35840
ds_write_b128 v3, v[132:135] offset:39936
s_mov_b32 s72, 0x20000
s_waitcnt lgkmcnt(0)
s_barrier
ds_read_b128 v[88:91], v2 offset:32768
ds_read_b128 v[92:95], v2 offset:33792
ds_read_b128 v[96:99], v2 offset:34816
ds_read_b128 v[100:103], v2 offset:35840
ds_read_b128 v[120:123], v2 offset:36864
ds_read_b128 v[124:127], v2 offset:37888
ds_read_b128 v[128:131], v2 offset:38912
ds_read_b128 v[132:135], v2 offset:39936
s_waitcnt lgkmcnt(7)
v_add_f32 v24, v24, v88
v_add_f32 v25, v25, v89
v_add_f32 v26, v26, v90
v_add_f32 v27, v27, v91
s_waitcnt lgkmcnt(6)
v_add_f32 v28, v28, v92
v_add_f32 v29, v29, v93
v_add_f32 v30, v30, v94
v_add_f32 v31, v31, v95
s_waitcnt lgkmcnt(5)
v_add_f32 v32, v32, v96
v_add_f32 v33, v33, v97
v_add_f32 v34, v34, v98
v_add_f32 v35, v35, v99
s_waitcnt lgkmcnt(4)
v_add_f32 v36, v36, v100
v_add_f32 v37, v37, v101
v_add_f32 v38, v38, v102
v_add_f32 v39, v39, v103
s_waitcnt lgkmcnt(3)
v_add_f32 v56, v56, v120
v_add_f32 v57, v57, v121
v_add_f32 v58, v58, v122
v_add_f32 v59, v59, v123
s_waitcnt lgkmcnt(2)
v_add_f32 v60, v60, v124
v_add_f32 v61, v61, v125
v_add_f32 v62, v62, v126
v_add_f32 v63, v63, v127
s_waitcnt lgkmcnt(1)
v_add_f32 v64, v64, v128
v_add_f32 v65, v65, v129
v_add_f32 v66, v66, v130
v_add_f32 v67, v67, v131
s_waitcnt lgkmcnt(0)
v_add_f32 v68, v68, v132
v_add_f32 v69, v69, v133
v_add_f32 v70, v70, v134
v_add_f32 v71, v71, v135
L_xchk:
s_waitcnt vmcnt(0)
v_max3_u32 v9, v152, v153, v154
v_max3_u32 v9, v9, v155, v156
v_max3_u32 v9, v9, v157, v158
v_max3_u32 v9, v9, v159, v160
v_max3_u32 v9, v9, v161, v162
v_max3_u32 v9, v9, v163, v164
v_max3_u32 v9, v9, v165, v166
v_max_u32 v9, v9, v167
v_cmp_eq_u32 vcc, -1, v9
s_cbranch_vccnz L_xretry
L_xgo:
v_mfma_f32_16x16x32_bf16 v[24:27], v[234:237], v[152:155], v[24:27]
v_mfma_f32_16x16x32_bf16 v[28:31], v[232:235], v[152:155], v[28:31]
v_mfma_f32_16x16x32_bf16 v[32:35], v[234:237], v[156:159], v[32:35]
v_mfma_f32_16x16x32_bf16 v[36:39], v[232:235], v[156:159], v[36:39]
v_mfma_f32_16x16x32_bf16 v[56:59], v[234:237], v[160:163], v[56:59]
v_mfma_f32_16x16x32_bf16 v[60:63], v[232:235], v[160:163], v[60:63]
v_mfma_f32_16x16x32_bf16 v[64:67], v[234:237], v[164:167], v[64:67]
v_mfma_f32_16x16x32_bf16 v[68:71], v[232:235], v[164:167], v[68:71]
s_nop 1
v_cvt_pk_bf16_f32 v24, v24, v25
v_cvt_pk_bf16_f32 v25, v26, v27
v_cvt_pk_bf16_f32 v26, v28, v29
v_cvt_pk_bf16_f32 v27, v30, v31
v_cvt_pk_bf16_f32 v32, v32, v33
v_cvt_pk_bf16_f32 v33, v34, v35
v_cvt_pk_bf16_f32 v34, v36, v37
v_cvt_pk_bf16_f32 v35, v38, v39
v_permlane16_swap_b32 v24, v26
v_permlane16_swap_b32 v25, v27
v_permlane16_swap_b32 v32, v34
v_permlane16_swap_b32 v33, v35
v_mov_b32 v28, v24
v_mov_b32 v29, v25
v_mov_b32 v30, v26
v_mov_b32 v31, v27
v_mov_b32_dpp v24, v32 row_ror:8 row_mask:0xf bank_mask:0xc
v_mov_b32_dpp v25, v33 row_ror:8 row_mask:0xf bank_mask:0xc
v_mov_b32_dpp v26, v34 row_ror:8 row_mask:0xf bank_mask:0xc
v_mov_b32_dpp v27, v35 row_ror:8 row_mask:0xf bank_mask:0xc
v_mov_b32_dpp v32, v28 row_ror:8 row_mask:0xf bank_mask:0x3
v_mov_b32_dpp v33, v29 row_ror:8 row_mask:0xf bank_mask:0x3
v_mov_b32_dpp v34, v30 row_ror:8 row_mask:0xf bank_mask:0x3
v_mov_b32_dpp v35, v31 row_ror:8 row_mask:0xf bank_mask:0x3
buffer_store_dwordx4 v[24:27], v8, s[48:51], s77 offen sc1
s_add_u32 s77, s77, 16384
buffer_store_dwordx4 v[32:35], v8, s[48:51], s77 offen sc1
s_add_u32 s77, s77, 16384
v_cvt_pk_bf16_f32 v56, v56, v57
v_cvt_pk_bf16_f32 v57, v58, v59
v_cvt_pk_bf16_f32 v58, v60, v61
v_cvt_pk_bf16_f32 v59, v62, v63
v_cvt_pk_bf16_f32 v64, v64, v65
v_cvt_pk_bf16_f32 v65, v66, v67
v_cvt_pk_bf16_f32 v66, v68, v69
v_cvt_pk_bf16_f32 v67, v70, v71
v_permlane16_swap_b32 v56, v58
v_permlane16_swap_b32 v57, v59
v_permlane16_swap_b32 v64, v66
v_permlane16_swap_b32 v65, v67
v_mov_b32 v60, v56
v_mov_b32 v61, v57
v_mov_b32 v62, v58
v_mov_b32 v63, v59
v_mov_b32_dpp v56, v64 row_ror:8 row_mask:0xf bank_mask:0xc
v_mov_b32_dpp v57, v65 row_ror:8 row_mask:0xf bank_mask:0xc
v_mov_b32_dpp v58, v66 row_ror:8 row_mask:0xf bank_mask:0xc
v_mov_b32_dpp v59, v67 row_ror:8 row_mask:0xf bank_mask:0xc
v_mov_b32_dpp v64, v60 row_ror:8 row_mask:0xf bank_mask:0x3
v_mov_b32_dpp v65, v61 row_ror:8 row_mask:0xf bank_mask:0x3
v_mov_b32_dpp v66, v62 row_ror:8 row_mask:0xf bank_mask:0x3
v_mov_b32_dpp v67, v63 row_ror:8 row_mask:0xf bank_mask:0x3
buffer_store_dwordx4 v[56:59], v8, s[48:51], s77 offen sc1
s_add_u32 s77, s77, 16384
buffer_store_dwordx4 v[64:67], v8, s[48:51], s77 offen sc1
s_add_u32 s77, s77, 16384
L_end:
s_endpgm
L_xretry:
s_sub_u32 s72, s72, 1
s_cbranch_scc1 L_xgo
buffer_load_dwordx4 v[152:155], v16, s[44:47], s75 offen offset:0 sc1
buffer_load_dwordx4 v[156:159], v16, s[44:47], s75 offen offset:1024 sc1
buffer_load_dwordx4 v[160:163], v16, s[44:47], s75 offen offset:2048 sc1
buffer_load_dwordx4 v[164:167], v16, s[44:47], s75 offen offset:3072 sc1
s_branch L_xchk
L_spin_1:
s_mov_b32 vcc_hi, 0x80000
L_spinlp_3:
s_sleep 1
buffer_load_dword v1, off, s[52:55], s78 offset:0 sc1
s_waitcnt vmcnt(0)
v_readfirstlane_b32 vcc_lo, v1
s_sub_u32 vcc_hi, vcc_hi, 1
s_cbranch_scc1 L_spinbk_2
s_cmp_lt_u32 vcc_lo, s81
s_cbranch_scc1 L_spinlp_3
s_branch L_spinbk_2
L_spin_4:
s_mov_b32 vcc_hi, 0x80000
L_spinlp_6:
s_sleep 1
buffer_load_dword v1, off, s[52:55], s70 offset:0 sc1
s_waitcnt vmcnt(0)
v_readfirstlane_b32 vcc_lo, v1
s_sub_u32 vcc_hi, vcc_hi, 1
s_cbranch_scc1 L_spinbk_5
s_cmp_lt_u32 vcc_lo, s81
s_cbranch_scc1 L_spinlp_6
s_branch L_spinbk_5
L_hretry:
s_sub_u32 s72, s72, 1
s_cbranch_scc1 L_hgo
buffer_load_dwordx4 v[88:91], v16, s[44:47], s77 offen sc1
s_waitcnt vmcnt(0)
s_branch L_hchk
L_spin_8:
s_mov_b32 vcc_hi, 0x80000
L_spinlp_10:
s_sleep 1
buffer_load_dword v19, off, s[52:55], s80 offset:0 sc1
s_waitcnt vmcnt(0)
v_readfirstlane_b32 vcc_lo, v19
s_sub_u32 vcc_hi, vcc_hi, 1
s_cbranch_scc1 L_spinbk_9
s_cmp_lt_u32 vcc_lo, s69
s_cbranch_scc1 L_spinlp_10
s_branch L_spinbk_9
L_spin_1012:
s_mov_b32 vcc_hi, 0x80000
L_spinlp_1014:
s_sleep 1
buffer_load_dword v19, off, s[52:55], s80 offset:0 sc1
s_waitcnt vmcnt(0)
v_readfirstlane_b32 vcc_lo, v19
s_sub_u32 vcc_hi, vcc_hi, 1
s_cbranch_scc1 L_spinbk_1013
s_cmp_lt_u32 vcc_lo, s69
s_cbranch_scc1 L_spinlp_1014
s_branch L_spinbk_1013
L_F1:
s_waitcnt lgkmcnt(7)
v_mfma_f32_16x16x32_bf16 v[104:107], a[144:147], v[40:43], 0
s_waitcnt lgkmcnt(6)
ds_read_b128 a[176:179], v2 offset:8192
v_cndmask_b32 v88, 0, v17, s[0:1]
v_mfma_f32_16x16x32_bf16 v[104:107], a[148:151], v[44:47], v[104:107]
s_waitcnt lgkmcnt(6)
ds_read_b128 a[180:183], v2 offset:9216
v_cndmask_b32 v89, 0, v17, s[4:5]
v_mfma_f32_16x16x32_bf16 v[104:107], a[152:155], v[48:51], v[104:107]
s_waitcnt lgkmcnt(6)
buffer_load_dwordx4 v16, s[32:35], s70 offen offset:2048 sc1 lds
v_mfma_f32_16x16x32_bf16 v[104:107], a[156:159], v[52:55], v[104:107]
ds_read_b128 a[184:187], v2 offset:10240
v_cndmask_b32 v90, 0, v17, s[6:7]
v_mfma_f32_16x16x32_bf16 v[120:123], a[156:159], v[68:71], 0
ds_read_b128 a[188:191], v2 offset:11264
v_cndmask_b32 v91, 0, v17, s[8:9]
v_mfma_f32_16x16x32_bf16 v[120:123], a[152:155], v[64:67], v[120:123]
ds_read_b128 a[192:195], v2 offset:12288
v_accvgpr_write_b32 a128, 0
v_mfma_f32_16x16x32_bf16 v[120:123], a[148:151], v[60:63], v[120:123]
ds_read_b128 a[196:199], v2 offset:13312
v_accvgpr_write_b32 a129, 0
v_mfma_f32_16x16x32_bf16 v[120:123], a[144:147], v[56:59], v[120:123]
ds_read_b128 a[200:203], v2 offset:14336
v_accvgpr_write_b32 a130, 0
v_mfma_f32_16x16x32_bf16 v[136:139], a[144:147], v[72:75], 0
ds_read_b128 a[204:207], v2 offset:15360
v_accvgpr_write_b32 a131, 0
v_mfma_f32_16x16x32_bf16 v[136:139], a[148:151], v[76:79], v[136:139]
buffer_load_dwordx4 v16, s[32:35], s70 offen offset:3072 sc1 lds
v_mfma_f32_16x16x32_bf16 v[136:139], a[152:155], v[80:83], v[136:139]
v_accvgpr_write_b32 a132, 0
v_accvgpr_write_b32 a133, 0
v_mfma_f32_16x16x32_bf16 v[136:139], a[156:159], v[84:87], v[136:139]
v_accvgpr_write_b32 a134, 0
v_accvgpr_write_b32 a135, 0
v_mfma_f32_16x16x32_bf16 v[88:91], a[156:159], v[36:39], v[88:91]
v_accvgpr_write_b32 a136, 0
v_accvgpr_write_b32 a137, 0
v_mfma_f32_16x16x32_bf16 v[88:91], a[152:155], v[32:35], v[88:91]
v_accvgpr_write_b32 a138, 0
v_accvgpr_write_b32 a139, 0
v_mfma_f32_16x16x32_bf16 v[88:91], a[148:151], v[28:31], v[88:91]
v_accvgpr_write_b32 a140, 0
v_accvgpr_write_b32 a141, 0
v_mfma_f32_16x16x32_bf16 v[88:91], a[144:147], v[24:27], v[88:91]
s_waitcnt lgkmcnt(0)
s_nop 1
v_max3_f32 v21, v104, v105, v106
v_max_f32 v21, v21, v107
v_max3_f32 v22, v120, v121, v122
v_max_f32 v22, v22, v123
v_max3_f32 v23, v136, v137, v138
v_max_f32 v23, v23, v139
v_max3_f32 v20, v88, v89, v90
v_max_f32 v20, v20, v91
v_mov_b32 v248, v20
v_mov_b32 v249, v21
v_mov_b32 v250, v22
v_mov_b32 v251, v23
v_permlane16_swap_b32 v248, v20
v_permlane16_swap_b32 v249, v21
v_permlane16_swap_b32 v250, v22
v_permlane16_swap_b32 v251, v23
v_max_f32 v20, v20, v248
v_max_f32 v21, v21, v249
v_max_f32 v22, v22, v250
v_max_f32 v23, v23, v251
v_mov_b32 v248, v20
v_mov_b32 v249, v21
v_mov_b32 v250, v22
v_mov_b32 v251, v23
v_permlane32_swap_b32 v248, v20
v_permlane32_swap_b32 v249, v21
v_permlane32_swap_b32 v250, v22
v_permlane32_swap_b32 v251, v23
v_max_f32 v20, v20, v248
v_max_f32 v21, v21, v249
v_max_f32 v22, v22, v250
v_max_f32 v23, v23, v251
s_cmp_eq_u32 s73, 0
s_cselect_b64 vcc, 0, -1
v_cndmask_b32 v20, v20, v252, vcc
v_cndmask_b32 v21, v21, v253, vcc
v_cndmask_b32 v22, v22, v254, vcc
v_cndmask_b32 v23, v23, v255, vcc
v_sub_f32 v228, 0, v23
v_sub_f32 v229, 0, v23
v_sub_f32 v230, 0, v23
v_sub_f32 v231, 0, v23
v_sub_f32 v224, 0, v22
v_sub_f32 v225, 0, v22
v_sub_f32 v226, 0, v22
v_sub_f32 v227, 0, v22
v_sub_f32 v220, 0, v21
v_sub_f32 v221, 0, v21
v_sub_f32 v222, 0, v21
v_sub_f32 v223, 0, v21
v_sub_f32 v216, 0, v20
v_sub_f32 v217, 0, v20
v_sub_f32 v218, 0, v20
v_sub_f32 v219, 0, v20
v_mfma_f32_16x16x32_bf16 v[140:143], a[160:163], v[72:75], v[228:231]
s_add_u32 m0, s71, 4096
v_add_f32 v104, v104, v220
v_add_f32 v105, v105, v220
v_mfma_f32_16x16x32_bf16 v[140:143], a[164:167], v[76:79], v[140:143]
v_add_f32 v106, v106, v220
v_add_f32 v107, v107, v220
v_exp_f32 v104, v104
v_mfma_f32_16x16x32_bf16 v[140:143], a[168:171], v[80:83], v[140:143]
s_add_u32 s64, s70, 4096
v_exp_f32 v105, v105
v_mfma_f32_16x16x32_bf16 v[140:143], a[172:175], v[84:87], v[140:143]
buffer_load_dwordx4 v16, s[32:35], s64 offen offset:0 sc1 lds
v_mfma_f32_16x16x32_bf16 v[124:127], a[172:175], v[68:71], v[224:227]
v_exp_f32 v106, v106
v_mfma_f32_16x16x32_bf16 v[124:127], a[168:171], v[64:67], v[124:127]
v_exp_f32 v107, v107
v_mfma_f32_16x16x32_bf16 v[124:127], a[164:167], v[60:63], v[124:127]
v_add_f32 v120, v120, v224
v_add_f32 v121, v121, v224
v_add_f32 v122, v122, v224
v_add_f32 v123, v123, v224
v_exp_f32 v120, v120
v_mfma_f32_16x16x32_bf16 v[124:127], a[160:163], v[56:59], v[124:127]
v_exp_f32 v121, v121
v_mfma_f32_16x16x32_bf16 v[108:111], a[160:163], v[40:43], v[220:223]
v_exp_f32 v122, v122
v_mfma_f32_16x16x32_bf16 v[108:111], a[164:167], v[44:47], v[108:111]
v_cndmask_b32 v92, v216, v17, s[10:11]
v_cndmask_b32 v93, v216, v17, s[12:13]
v_cndmask_b32 v94, v216, v17, s[18:19]
v_cndmask_b32 v95, v216, v17, s[22:23]
v_mfma_f32_16x16x32_bf16 v[108:111], a[168:171], v[48:51], v[108:111]
buffer_load_dwordx4 v16, s[32:35], s64 offen offset:1024 sc1 lds
v_cvt_pk_bf16_f32 v160, v104, v105
v_mfma_f32_16x16x32_bf16 v[108:111], a[172:175], v[52:55], v[108:111]
v_exp_f32 v123, v123
v_mfma_f32_16x16x32_bf16 v[92:95], a[172:175], v[36:39], v[92:95]
v_add_f32 v136, v136, v228
v_add_f32 v137, v137, v228
v_add_f32 v138, v138, v228
v_add_f32 v139, v139, v228
v_exp_f32 v136, v136
v_mfma_f32_16x16x32_bf16 v[92:95], a[168:171], v[32:35], v[92:95]
v_cvt_pk_bf16_f32 v161, v106, v107
v_exp_f32 v137, v137
v_cndmask_b32 v96, v216, v17, s[26:27]
v_cndmask_b32 v97, v216, v17, s[56:57]
v_cndmask_b32 v98, v216, v17, s[58:59]
v_cndmask_b32 v99, v216, v17, s[60:61]
v_mfma_f32_16x16x32_bf16 v[92:95], a[164:167], v[28:31], v[92:95]
v_exp_f32 v138, v138
v_mfma_f32_16x16x32_bf16 v[92:95], a[160:163], v[24:27], v[92:95]
v_exp_f32 v139, v139
v_mfma_f32_16x16x32_bf16 v[96:99], a[176:179], v[24:27], v[96:99]
v_cvt_pk_bf16_f32 v184, v120, v121
v_add_f32 v88, v88, v216
v_mfma_f32_16x16x32_bf16 v[96:99], a[180:183], v[28:31], v[96:99]
buffer_load_dwordx4 v16, s[32:35], s64 offen offset:2048 sc1 lds
v_add_f32 v89, v89, v216
v_add_f32 v90, v90, v216
v_add_f32 v91, v91, v216
v_exp_f32 v88, v88
v_mfma_f32_16x16x32_bf16 v[96:99], a[184:187], v[32:35], v[96:99]
v_exp_f32 v89, v89
v_mfma_f32_16x16x32_bf16 v[96:99], a[188:191], v[36:39], v[96:99]
v_cvt_pk_bf16_f32 v185, v122, v123
v_cvt_pk_bf16_f32 v192, v136, v137
v_mfma_f32_16x16x32_bf16 v[112:115], a[188:191], v[52:55], v[220:223]
v_exp_f32 v90, v90
v_mfma_f32_16x16x32_bf16 v[112:115], a[184:187], v[48:51], v[112:115]
v_exp_f32 v91, v91
v_mfma_f32_16x16x32_bf16 v[112:115], a[180:183], v[44:47], v[112:115]
v_exp_f32 v140, v140
v_mfma_f32_16x16x32_bf16 v[112:115], a[176:179], v[40:43], v[112:115]
v_exp_f32 v141, v141
v_mfma_f32_16x16x32_bf16 v[128:131], a[176:179], v[56:59], v[224:227]
buffer_load_dwordx4 v16, s[32:35], s64 offen offset:3072 sc1 lds
v_cvt_pk_bf16_f32 v193, v138, v139
v_mfma_f32_16x16x32_bf16 v[128:131], a[180:183], v[60:63], v[128:131]
v_exp_f32 v142, v142
v_mfma_f32_16x16x32_bf16 v[128:131], a[184:187], v[64:67], v[128:131]
v_exp_f32 v143, v143
v_mfma_f32_16x16x32_bf16 v[128:131], a[188:191], v[68:71], v[128:131]
v_cvt_pk_bf16_f32 v152, v88, v89
v_cvt_pk_bf16_f32 v153, v90, v91
v_mfma_f32_16x16x32_bf16 v[144:147], a[188:191], v[84:87], v[228:231]
v_exp_f32 v124, v124
v_mfma_f32_16x16x32_bf16 v[144:147], a[184:187], v[80:83], v[144:147]
v_exp_f32 v125, v125
v_mfma_f32_16x16x32_bf16 v[144:147], a[180:183], v[76:79], v[144:147]
s_waitcnt vmcnt(6)
s_barrier
v_mfma_f32_16x16x32_bf16 v[144:147], a[176:179], v[72:75], v[144:147]
v_exp_f32 v126, v126
v_mfma_f32_16x16x32_bf16 v[148:151], a[192:195], v[72:75], v[228:231]
v_cvt_pk_bf16_f32 v194, v140, v141
v_cvt_pk_bf16_f32 v195, v142, v143
v_mfma_f32_16x16x32_bf16 v[148:151], a[196:199], v[76:79], v[148:151]
v_exp_f32 v127, v127
v_mfma_f32_16x16x32_bf16 v[148:151], a[200:203], v[80:83], v[148:151]
s_xor_b32 s71, s71, 16384
v_exp_f32 v108, v108
v_mfma_f32_16x16x32_bf16 v[148:151], a[204:207], v[84:87], v[148:151]
s_add_u32 s70, s70, 32768
v_exp_f32 v109, v109
v_mfma_f32_16x16x32_bf16 v[132:135], a[204:207], v[68:71], v[224:227]
s_mov_b32 m0, s71
v_exp_f32 v110, v110
v_mfma_f32_16x16x32_bf16 v[132:135], a[200:203], v[64:67], v[132:135]
buffer_load_dwordx4 v16, s[32:35], s70 offen offset:0 sc1 lds
v_mfma_f32_16x16x32_bf16 v[132:135], a[196:199], v[60:63], v[132:135]
v_cvt_pk_bf16_f32 v186, v124, v125
v_exp_f32 v111, v111
v_mfma_f32_16x16x32_bf16 v[132:135], a[192:195], v[56:59], v[132:135]
v_exp_f32 v92, v92
v_mfma_f32_16x16x32_bf16 v[116:119], a[192:195], v[40:43], v[220:223]
ds_read_b128 a[144:147], v2 offset:16384
v_cndmask_b32 v100, v216, v17, s[62:63]
v_mfma_f32_16x16x32_bf16 v[116:119], a[196:199], v[44:47], v[116:119]
ds_read_b128 a[148:151], v2 offset:17408
v_cndmask_b32 v101, v216, v17, s[48:49]
v_cndmask_b32 v102, v216, v17, s[50:51]
v_cndmask_b32 v103, v216, v17, s[100:101]
v_cvt_pk_bf16_f32 v187, v126, v127
v_exp_f32 v93, v93
v_mfma_f32_16x16x32_bf16 v[116:119], a[200:203], v[48:51], v[116:119]
v_exp_f32 v94, v94
v_mfma_f32_16x16x32_bf16 v[116:119], a[204:207], v[52:55], v[116:119]
ds_read_b128 a[152:155], v2 offset:18432
v_cvt_pk_bf16_f32 v162, v108, v109
v_mfma_f32_16x16x32_bf16 v[100:103], a[204:207], v[36:39], v[100:103]
buffer_load_dwordx4 v16, s[32:35], s70 offen offset:1024 sc1 lds
v_exp_f32 v95, v95
v_mfma_f32_16x16x32_bf16 v[100:103], a[200:203], v[32:35], v[100:103]
ds_read_b128 a[156:159], v2 offset:19456
v_exp_f32 v96, v96
v_mfma_f32_16x16x32_bf16 v[100:103], a[196:199], v[28:31], v[100:103]
v_cvt_pk_bf16_f32 v163, v110, v111
v_exp_f32 v97, v97
v_mfma_f32_16x16x32_bf16 v[100:103], a[192:195], v[24:27], v[100:103]
s_waitcnt lgkmcnt(2)
ds_read_b128 a[160:163], v2 offset:20480
ds_read_b128 a[164:167], v2 offset:21504
ds_read_b128 a[168:171], v2 offset:22528
ds_read_b128 a[172:175], v2 offset:23552
v_mfma_f32_16x16x32_bf16 v[120:123], a[144:147], v[56:59], v[224:227]
v_exp_f32 v98, v98
v_mfma_f32_16x16x32_bf16 v[120:123], a[148:151], v[60:63], v[120:123]
s_waitcnt lgkmcnt(5)
v_cvt_pk_bf16_f32 v154, v92, v93
v_exp_f32 v99, v99
v_mfma_f32_16x16x32_bf16 v[120:123], a[152:155], v[64:67], v[120:123]
s_waitcnt lgkmcnt(4)
v_exp_f32 v112, v112
v_mfma_f32_16x16x32_bf16 v[120:123], a[156:159], v[68:71], v[120:123]
v_exp_f32 v113, v113
v_mfma_f32_16x16x32_bf16 v[136:139], a[156:159], v[84:87], v[228:231]
v_cvt_pk_bf16_f32 v155, v94, v95
v_cndmask_b32 v104, v220, v17, s[0:1]
v_mfma_f32_16x16x32_bf16 v[136:139], a[152:155], v[80:83], v[136:139]
ds_read_b128 a[176:179], v2 offset:24576
buffer_load_dwordx4 v16, s[32:35], s70 offen offset:2048 sc1 lds
v_cndmask_b32 v105, v220, v17, s[4:5]
v_cndmask_b32 v106, v220, v17, s[6:7]
v_cndmask_b32 v107, v220, v17, s[8:9]
v_exp_f32 v114, v114
v_mfma_f32_16x16x32_bf16 v[136:139], a[148:151], v[76:79], v[136:139]
v_cvt_pk_bf16_f32 v156, v96, v97
v_cvt_pk_bf16_f32 v157, v98, v99
v_mfma_f32_16x16x32_bf16 v[136:139], a[144:147], v[72:75], v[136:139]
v_exp_f32 v115, v115
v_mfma_f32_16x16x32_bf16 v[104:107], a[144:147], v[40:43], v[104:107]
v_exp_f32 v128, v128
v_mfma_f32_16x16x32_bf16 v[104:107], a[148:151], v[44:47], v[104:107]
v_exp_f32 v129, v129
v_mfma_f32_16x16x32_bf16 v[104:107], a[152:155], v[48:51], v[104:107]
v_exp_f32 v130, v130
v_mfma_f32_16x16x32_bf16 v[104:107], a[156:159], v[52:55], v[104:107]
s_waitcnt lgkmcnt(0)
v_exp_f32 v131, v131
v_mfma_f32_16x16x32_bf16 v[140:143], a[172:175], v[84:87], v[228:231]
v_cvt_pk_bf16_f32 v164, v112, v113
v_cvt_pk_bf16_f32 v165, v114, v115
v_mfma_f32_16x16x32_bf16 v[140:143], a[168:171], v[80:83], v[140:143]
v_exp_f32 v144, v144
v_mfma_f32_16x16x32_bf16 v[140:143], a[164:167], v[76:79], v[140:143]
v_exp_f32 v145, v145
v_mfma_f32_16x16x32_bf16 v[140:143], a[160:163], v[72:75], v[140:143]
v_exp_f32 v146, v146
v_mfma_f32_16x16x32_bf16 v[124:127], a[160:163], v[56:59], v[224:227]
ds_read_b128 a[180:183], v2 offset:25600
v_cndmask_b32 v108, v220, v17, s[10:11]
v_mfma_f32_16x16x32_bf16 v[124:127], a[164:167], v[60:63], v[124:127]
ds_read_b128 a[184:187], v2 offset:26624
buffer_load_dwordx4 v16, s[32:35], s70 offen offset:3072 sc1 lds
v_cndmask_b32 v109, v220, v17, s[12:13]
v_cndmask_b32 v110, v220, v17, s[18:19]
v_cndmask_b32 v111, v220, v17, s[22:23]
v_cvt_pk_bf16_f32 v188, v128, v129
v_mfma_f32_16x16x32_bf16 v[124:127], a[168:171], v[64:67], v[124:127]
s_add_u32 m0, s86, 131072
v_exp_f32 v147, v147
v_mfma_f32_16x16x32_bf16 v[124:127], a[172:175], v[68:71], v[124:127]
s_add_u32 s64, s85, 0
ds_read_b128 a[188:191], v2 offset:27648
v_exp_f32 v148, v148
v_mfma_f32_16x16x32_bf16 v[108:111], a[172:175], v[52:55], v[108:111]
buffer_load_dwordx4 v12, s[36:39], s64 offen lds
v_cvt_pk_bf16_f32 v189, v130, v131
v_exp_f32 v149, v149
v_mfma_f32_16x16x32_bf16 v[108:111], a[168:171], v[48:51], v[108:111]
s_add_u32 m0, s86, 132096
ds_read_b128 a[192:195], v2 offset:28672
v_cndmask_b32 v112, v220, v17, s[26:27]
v_cndmask_b32 v113, v220, v17, s[56:57]
v_cndmask_b32 v114, v220, v17, s[58:59]
v_cndmask_b32 v115, v220, v17, s[60:61]
v_mfma_f32_16x16x32_bf16 v[108:111], a[164:167], v[44:47], v[108:111]
s_add_u32 s64, s85, 8192
v_exp_f32 v150, v150
v_mfma_f32_16x16x32_bf16 v[108:111], a[160:163], v[40:43], v[108:111]
buffer_load_dwordx4 v13, s[36:39], s64 offen lds
v_cvt_pk_bf16_f32 v196, v144, v145
v_exp_f32 v151, v151
v_mfma_f32_16x16x32_bf16 v[112:115], a[176:179], v[40:43], v[112:115]
s_waitcnt lgkmcnt(2)
s_add_u32 m0, s86, 133120
v_exp_f32 v132, v132
v_mfma_f32_16x16x32_bf16 v[112:115], a[180:183], v[44:47], v[112:115]
s_add_u32 s64, s85, 16384
v_exp_f32 v133, v133
v_mfma_f32_16x16x32_bf16 v[112:115], a[184:187], v[48:51], v[112:115]
s_waitcnt lgkmcnt(1)
buffer_load_dwordx4 v12, s[36:39], s64 offen lds
v_cvt_pk_bf16_f32 v197, v146, v147
v_mfma_f32_16x16x32_bf16 v[112:115], a[188:191], v[52:55], v[112:115]
s_add_u32 m0, s86, 134144
v_exp_f32 v134, v134
v_mfma_f32_16x16x32_bf16 v[128:131], a[188:191], v[68:71], v[224:227]
s_add_u32 s64, s85, 24576
ds_read_b128 a[196:199], v2 offset:29696
ds_read_b128 a[200:203], v2 offset:30720
ds_read_b128 a[204:207], v2 offset:31744
v_cvt_pk_bf16_f32 v198, v148, v149
v_mfma_f32_16x16x32_bf16 v[128:131], a[184:187], v[64:67], v[128:131]
buffer_load_dwordx4 v13, s[36:39], s64 offen lds
v_exp_f32 v135, v135
v_mfma_f32_16x16x32_bf16 v[128:131], a[180:183], v[60:63], v[128:131]
s_add_u32 m0, s71, 4096
v_exp_f32 v116, v116
v_mfma_f32_16x16x32_bf16 v[128:131], a[176:179], v[56:59], v[128:131]
s_add_u32 s64, s70, 4096
v_cvt_pk_bf16_f32 v199, v150, v151
v_exp_f32 v117, v117
v_mfma_f32_16x16x32_bf16 v[144:147], a[176:179], v[72:75], v[228:231]
buffer_load_dwordx4 v16, s[32:35], s64 offen offset:0 sc1 lds
v_mfma_f32_16x16x32_bf16 v[144:147], a[180:183], v[76:79], v[144:147]
v_exp_f32 v118, v118
v_mfma_f32_16x16x32_bf16 v[144:147], a[184:187], v[80:83], v[144:147]
v_cvt_pk_bf16_f32 v190, v132, v133
v_exp_f32 v119, v119
v_mfma_f32_16x16x32_bf16 v[144:147], a[188:191], v[84:87], v[144:147]
s_waitcnt lgkmcnt(0)
v_exp_f32 v100, v100
v_mfma_f32_16x16x32_bf16 v[148:151], a[204:207], v[84:87], v[228:231]
v_exp_f32 v101, v101
v_mfma_f32_16x16x32_bf16 v[148:151], a[200:203], v[80:83], v[148:151]
v_cvt_pk_bf16_f32 v191, v134, v135
v_cvt_pk_bf16_f32 v166, v116, v117
v_cvt_pk_bf16_f32 v167, v118, v119
v_mfma_f32_16x16x32_bf16 v[148:151], a[196:199], v[76:79], v[148:151]
v_exp_f32 v102, v102
v_mfma_f32_16x16x32_bf16 v[148:151], a[192:195], v[72:75], v[148:151]
v_exp_f32 v103, v103
v_mfma_f32_16x16x32_bf16 v[132:135], a[192:195], v[56:59], v[224:227]
s_lshl_b32 s66, s30, 30
ds_read_b128 a[144:147], v3 offset:16384
v_cndmask_b32 v116, v220, v17, s[62:63]
v_mfma_f32_16x16x32_bf16 v[132:135], a[196:199], v[60:63], v[132:135]
ds_read_b128 a[148:151], v3 offset:24576
v_cndmask_b32 v117, v220, v17, s[48:49]
v_cndmask_b32 v118, v220, v17, s[50:51]
v_cndmask_b32 v119, v220, v17, s[100:101]
v_exp_f32 v120, v120
v_mfma_f32_16x16x32_bf16 v[132:135], a[200:203], v[64:67], v[132:135]
v_exp_f32 v121, v121
v_mfma_f32_16x16x32_bf16 v[132:135], a[204:207], v[68:71], v[132:135]
v_exp_f32 v122, v122
v_mfma_f32_16x16x32_bf16 v[116:119], a[204:207], v[52:55], v[116:119]
ds_read_b128 a[152:155], v3 offset:17408
v_accvgpr_write_b32 a142, 0
v_mfma_f32_16x16x32_bf16 v[116:119], a[200:203], v[48:51], v[116:119]
ds_read_b128 a[156:159], v3 offset:25600
buffer_load_dwordx4 v16, s[32:35], s64 offen offset:1024 sc1 lds
v_accvgpr_write_b32 a143, 0
v_cvt_pk_bf16_f32 v158, v100, v101
v_cvt_pk_bf16_f32 v159, v102, v103
v_mfma_f32_16x16x32_bf16 v[116:119], a[196:199], v[44:47], v[116:119]
v_exp_f32 v123, v123
v_mfma_f32_16x16x32_bf16 v[116:119], a[192:195], v[40:43], v[116:119]
v_exp_f32 v136, v136
v_smfmac_f32_16x16x64_bf16 a[128:131], a[240:243], v[152:159], v5
ds_read_b128 a[160:163], v3 offset:18432
v_smfmac_f32_16x16x64_bf16 a[132:135], a[240:243], v[160:167], v5
v_exp_f32 v137, v137
v_smfmac_f32_16x16x64_bf16 a[136:139], a[240:243], v[184:191], v5
v_exp_f32 v138, v138
v_smfmac_f32_16x16x64_bf16 a[140:143], a[240:243], v[192:199], v5
s_waitcnt lgkmcnt(1)
v_cvt_pk_bf16_f32 v200, v120, v121
v_mfma_f32_16x16x32_bf16 a[0:3], a[144:147], v[152:155], 0
v_exp_f32 v139, v139
v_mfma_f32_16x16x32_bf16 a[0:3], a[148:151], v[156:159], a[0:3]
v_exp_f32 v104, v104
v_mfma_f32_16x16x32_bf16 a[32:35], a[148:151], v[164:167], 0
v_cvt_pk_bf16_f32 v201, v122, v123
v_cvt_pk_bf16_f32 v208, v136, v137
v_mfma_f32_16x16x32_bf16 a[32:35], a[144:147], v[160:163], a[32:35]
v_exp_f32 v105, v105
v_mfma_f32_16x16x32_bf16 a[64:67], a[144:147], v[184:187], 0
v_exp_f32 v106, v106
v_mfma_f32_16x16x32_bf16 a[64:67], a[148:151], v[188:191], a[64:67]
v_exp_f32 v107, v107
v_mfma_f32_16x16x32_bf16 a[96:99], a[148:151], v[196:199], 0
buffer_load_dwordx4 v16, s[32:35], s64 offen offset:2048 sc1 lds
v_mfma_f32_16x16x32_bf16 a[96:99], a[144:147], v[192:195], a[96:99]
v_exp_f32 v140, v140
v_mfma_f32_16x16x32_bf16 a[100:103], a[152:155], v[192:195], 0
ds_read_b128 a[164:167], v3 offset:26624
v_cvt_pk_bf16_f32 v209, v138, v139
v_mfma_f32_16x16x32_bf16 a[100:103], a[156:159], v[196:199], a[100:103]
v_exp_f32 v141, v141
v_mfma_f32_16x16x32_bf16 a[68:71], a[156:159], v[188:191], 0
v_exp_f32 v142, v142
v_mfma_f32_16x16x32_bf16 a[68:71], a[152:155], v[184:187], a[68:71]
v_cvt_pk_bf16_f32 v176, v104, v105
v_cvt_pk_bf16_f32 v177, v106, v107
v_mfma_f32_16x16x32_bf16 a[36:39], a[152:155], v[160:163], 0
v_exp_f32 v143, v143
v_mfma_f32_16x16x32_bf16 a[36:39], a[156:159], v[164:167], a[36:39]
v_exp_f32 v124, v124
v_mfma_f32_16x16x32_bf16 a[4:7], a[156:159], v[156:159], 0
v_exp_f32 v125, v125
v_mfma_f32_16x16x32_bf16 a[4:7], a[152:155], v[152:155], a[4:7]
s_waitcnt lgkmcnt(0)
ds_read_b128 a[168:171], v3 offset:19456
v_cvt_pk_bf16_f32 v210, v140, v141
v_mfma_f32_16x16x32_bf16 a[8:11], a[160:163], v[152:155], 0
v_exp_f32 v126, v126
v_mfma_f32_16x16x32_bf16 a[8:11], a[164:167], v[156:159], a[8:11]
ds_read_b128 a[172:175], v3 offset:27648
v_cvt_pk_bf16_f32 v211, v142, v143
v_mfma_f32_16x16x32_bf16 a[40:43], a[164:167], v[164:167], 0
v_exp_f32 v127, v127
v_mfma_f32_16x16x32_bf16 a[40:43], a[160:163], v[160:163], a[40:43]
v_exp_f32 v108, v108
v_mfma_f32_16x16x32_bf16 a[72:75], a[160:163], v[184:187], 0
buffer_load_dwordx4 v16, s[32:35], s64 offen offset:3072 sc1 lds
v_mfma_f32_16x16x32_bf16 a[72:75], a[164:167], v[188:191], a[72:75]
v_exp_f32 v109, v109
v_mfma_f32_16x16x32_bf16 a[104:107], a[164:167], v[196:199], 0
v_exp_f32 v110, v110
v_mfma_f32_16x16x32_bf16 a[104:107], a[160:163], v[192:195], a[104:107]
s_waitcnt lgkmcnt(0)
ds_read_b128 a[176:179], v3 offset:20480
v_cvt_pk_bf16_f32 v202, v124, v125
v_mfma_f32_16x16x32_bf16 a[108:111], a[168:171], v[192:195], 0
v_exp_f32 v111, v111
v_mfma_f32_16x16x32_bf16 a[108:111], a[172:175], v[196:199], a[108:111]
ds_read_b128 a[180:183], v3 offset:28672
v_cvt_pk_bf16_f32 v203, v126, v127
v_mfma_f32_16x16x32_bf16 a[76:79], a[172:175], v[188:191], 0
s_add_u32 m0, s86, 135168
v_exp_f32 v112, v112
v_mfma_f32_16x16x32_bf16 a[76:79], a[168:171], v[184:187], a[76:79]
s_add_u32 s64, s85, 32768
v_exp_f32 v113, v113
v_mfma_f32_16x16x32_bf16 a[44:47], a[168:171], v[160:163], 0
buffer_load_dwordx4 v12, s[36:39], s64 offen lds
v_mfma_f32_16x16x32_bf16 a[44:47], a[172:175], v[164:167], a[44:47]
s_add_u32 m0, s86, 136192
v_cvt_pk_bf16_f32 v178, v108, v109
v_exp_f32 v114, v114
v_mfma_f32_16x16x32_bf16 a[12:15], a[172:175], v[156:159], 0
s_add_u32 s64, s85, 40960
v_exp_f32 v115, v115
v_mfma_f32_16x16x32_bf16 a[12:15], a[168:171], v[152:155], a[12:15]
s_waitcnt lgkmcnt(0)
buffer_load_dwordx4 v13, s[36:39], s64 offen lds
v_mfma_f32_16x16x32_bf16 a[16:19], a[176:179], v[152:155], 0
s_add_u32 m0, s86, 137216
ds_read_b128 a[184:187], v3 offset:21504
ds_read_b128 a[188:191], v3 offset:29696
ds_read_b128 a[192:195], v3 offset:22528
ds_read_b128 a[196:199], v3 offset:30720
ds_read_b128 a[200:203], v3 offset:23552
ds_read_b128 a[204:207], v3 offset:31744
v_xor_b32 v2, 0x8000, v2
v_exp_f32 v128, v128
v_mfma_f32_16x16x32_bf16 a[16:19], a[180:183], v[156:159], a[16:19]
s_waitcnt vmcnt(14)
s_barrier
s_add_u32 s64, s85, 49152
v_cvt_pk_bf16_f32 v179, v110, v111
v_mfma_f32_16x16x32_bf16 a[48:51], a[180:183], v[164:167], 0
buffer_load_dwordx4 v12, s[36:39], s64 offen lds
v_exp_f32 v129, v129
v_mfma_f32_16x16x32_bf16 a[48:51], a[176:179], v[160:163], a[48:51]
s_add_u32 m0, s86, 138240
v_exp_f32 v130, v130
v_mfma_f32_16x16x32_bf16 a[80:83], a[176:179], v[184:187], 0
s_add_u32 s64, s85, 57344
v_cvt_pk_bf16_f32 v180, v112, v113
v_cvt_pk_bf16_f32 v181, v114, v115
v_mfma_f32_16x16x32_bf16 a[80:83], a[180:183], v[188:191], a[80:83]
buffer_load_dwordx4 v13, s[36:39], s64 offen lds
v_exp_f32 v131, v131
v_mfma_f32_16x16x32_bf16 a[112:115], a[180:183], v[196:199], 0
v_exp_f32 v144, v144
v_mfma_f32_16x16x32_bf16 a[112:115], a[176:179], v[192:195], a[112:115]
s_waitcnt lgkmcnt(0)
s_xor_b32 s71, s71, 49152
s_add_u32 s70, s70, 32768
s_mov_b32 m0, s71
v_exp_f32 v145, v145
v_mfma_f32_16x16x32_bf16 a[116:119], a[184:187], v[192:195], 0
buffer_load_dwordx4 v16, s[32:35], s70 offen offset:0 sc1 lds
v_mfma_f32_16x16x32_bf16 a[116:119], a[188:191], v[196:199], a[116:119]
v_exp_f32 v146, v146
v_mfma_f32_16x16x32_bf16 a[84:87], a[188:191], v[188:191], 0
v_cvt_pk_bf16_f32 v204, v128, v129
v_cvt_pk_bf16_f32 v205, v130, v131
v_mfma_f32_16x16x32_bf16 a[84:87], a[184:187], v[184:187], a[84:87]
v_exp_f32 v147, v147
v_mfma_f32_16x16x32_bf16 a[52:55], a[184:187], v[160:163], 0
v_exp_f32 v148, v148
v_mfma_f32_16x16x32_bf16 a[52:55], a[188:191], v[164:167], a[52:55]
v_exp_f32 v149, v149
v_mfma_f32_16x16x32_bf16 a[20:23], a[188:191], v[156:159], 0
ds_read_b128 a[144:147], v2 offset:0
v_lshl_add_u32 v19, v0, 24, s66
v_mfma_f32_16x16x32_bf16 a[20:23], a[184:187], v[152:155], a[20:23]
s_lshr_b32 s67, s31, 4
v_exp_f32 v150, v150
v_mfma_f32_16x16x32_bf16 a[24:27], a[192:195], v[152:155], 0
s_lshl1_add_u32 s67, s3, s67
v_cvt_pk_bf16_f32 v212, v144, v145
v_cvt_pk_bf16_f32 v213, v146, v147
v_mfma_f32_16x16x32_bf16 a[24:27], a[196:199], v[156:159], a[24:27]
s_lshl_b32 s79, s67, 8
v_exp_f32 v151, v151
v_mfma_f32_16x16x32_bf16 a[56:59], a[196:199], v[164:167], 0
s_add_u32 s79, s79, 8192
v_exp_f32 v132, v132
v_mfma_f32_16x16x32_bf16 a[56:59], a[192:195], v[160:163], a[56:59]
s_add_u32 s69, s31, 12
v_exp_f32 v133, v133
v_mfma_f32_16x16x32_bf16 a[88:91], a[192:195], v[184:187], 0
s_lshr_b32 s69, s69, 5
buffer_load_dwordx4 v16, s[32:35], s70 offen offset:1024 sc1 lds
v_mfma_f32_16x16x32_bf16 a[88:91], a[196:199], v[188:191], a[88:91]
s_lshl1_add_u32 s69, s3, s69
v_exp_f32 v134, v134
v_mfma_f32_16x16x32_bf16 a[120:123], a[196:199], v[196:199], 0
s_lshl_b32 s69, s69, 8
v_cvt_pk_bf16_f32 v214, v148, v149
v_cvt_pk_bf16_f32 v215, v150, v151
v_mfma_f32_16x16x32_bf16 a[120:123], a[192:195], v[192:195], a[120:123]
s_add_u32 s69, s69, 8192
v_exp_f32 v135, v135
v_mfma_f32_16x16x32_bf16 a[124:127], a[200:203], v[192:195], 0
s_lshl_b32 s67, s73, 16
v_exp_f32 v116, v116
v_mfma_f32_16x16x32_bf16 a[124:127], a[204:207], v[196:199], a[124:127]
s_xor_b32 s68, s80, 256
v_exp_f32 v117, v117
v_mfma_f32_16x16x32_bf16 a[92:95], a[204:207], v[188:191], 0
s_add_u32 s68, s68, s67
ds_read_b128 a[148:151], v2 offset:1024
v_cvt_pk_bf16_f32 v206, v132, v133
v_mfma_f32_16x16x32_bf16 a[92:95], a[200:203], v[184:187], a[92:95]
s_add_u32 s67, s67, s69
v_exp_f32 v118, v118
v_mfma_f32_16x16x32_bf16 a[60:63], a[200:203], v[160:163], 0
ds_read_b128 a[152:155], v2 offset:2048
v_cvt_pk_bf16_f32 v207, v134, v135
v_mfma_f32_16x16x32_bf16 a[60:63], a[204:207], v[164:167], a[60:63]
ds_read_b128 a[156:159], v2 offset:3072
v_cvt_pk_bf16_f32 v182, v116, v117
v_mfma_f32_16x16x32_bf16 a[28:31], a[204:207], v[156:159], 0
s_mov_b64 exec, 1
buffer_atomic_add a251, v19, s[52:55], s67 offen offset:0 sc1
buffer_atomic_add a251, v19, s[52:55], s68 offen offset:0 sc1
s_mov_b64 exec, -1
v_exp_f32 v119, v119
v_mfma_f32_16x16x32_bf16 a[28:31], a[200:203], v[152:155], a[28:31]
ds_read_b128 a[160:163], v2 offset:4096
ds_read_b128 a[164:167], v2 offset:5120
ds_read_b128 a[168:171], v2 offset:6144
ds_read_b128 a[172:175], v2 offset:7168
v_mul_u32_u24 v19, 52, v0
v_cvt_pk_bf16_f32 v183, v118, v119
v_xor_b32 v3, 0x8000, v3
v_accvgpr_read_b32 v20, a128
v_accvgpr_read_b32 v248, a129
v_add_f32 v20, v20, v248
v_max_f32 v1, v1, v20
v_rcp_f32 v20, v20
v_accvgpr_read_b32 v232, a0
v_accvgpr_read_b32 v233, a1
v_accvgpr_read_b32 v234, a2
v_accvgpr_read_b32 v235, a3
v_accvgpr_read_b32 v236, a4
v_accvgpr_read_b32 v237, a5
v_accvgpr_read_b32 v238, a6
v_accvgpr_read_b32 v239, a7
v_mul_f32 v20, v20, v4
v_mul_f32 v232, v232, v20
v_mul_f32 v233, v233, v20
v_mul_f32 v234, v234, v20
v_mul_f32 v235, v235, v20
v_mul_f32 v236, v236, v20
v_mul_f32 v237, v237, v20
v_mul_f32 v238, v238, v20
v_mul_f32 v239, v239, v20
v_cvt_pk_bf16_f32 v232, v232, v233
v_cvt_pk_bf16_f32 v233, v234, v235
v_cvt_pk_bf16_f32 v234, v236, v237
v_cvt_pk_bf16_f32 v235, v238, v239
s_add_u32 s77, s74, 0
buffer_store_dwordx4 v[232:235], v16, s[44:47], s77 offen sc1
v_accvgpr_read_b32 v240, a8
v_accvgpr_read_b32 v241, a9
v_accvgpr_read_b32 v242, a10
v_accvgpr_read_b32 v243, a11
v_accvgpr_read_b32 v244, a12
v_accvgpr_read_b32 v245, a13
v_accvgpr_read_b32 v246, a14
v_accvgpr_read_b32 v247, a15
v_mul_f32 v240, v240, v20
v_mul_f32 v241, v241, v20
v_mul_f32 v242, v242, v20
v_mul_f32 v243, v243, v20
v_mul_f32 v244, v244, v20
v_mul_f32 v245, v245, v20
v_mul_f32 v246, v246, v20
v_mul_f32 v247, v247, v20
v_cvt_pk_bf16_f32 v240, v240, v241
v_cvt_pk_bf16_f32 v241, v242, v243
v_cvt_pk_bf16_f32 v242, v244, v245
v_cvt_pk_bf16_f32 v243, v246, v247
s_add_u32 s77, s74, 8192
buffer_store_dwordx4 v[240:243], v16, s[44:47], s77 offen sc1
v_accvgpr_read_b32 v232, a16
v_accvgpr_read_b32 v233, a17
v_accvgpr_read_b32 v234, a18
v_accvgpr_read_b32 v235, a19
v_accvgpr_read_b32 v236, a20
v_accvgpr_read_b32 v237, a21
v_accvgpr_read_b32 v238, a22
v_accvgpr_read_b32 v239, a23
v_mul_f32 v232, v232, v20
v_mul_f32 v233, v233, v20
v_mul_f32 v234, v234, v20
v_mul_f32 v235, v235, v20
v_mul_f32 v236, v236, v20
v_mul_f32 v237, v237, v20
v_mul_f32 v238, v238, v20
v_mul_f32 v239, v239, v20
v_cvt_pk_bf16_f32 v232, v232, v233
v_cvt_pk_bf16_f32 v233, v234, v235
v_cvt_pk_bf16_f32 v234, v236, v237
v_cvt_pk_bf16_f32 v235, v238, v239
s_add_u32 s77, s74, 16384
buffer_store_dwordx4 v[232:235], v16, s[44:47], s77 offen sc1
s_branch L_T
L_T1:
buffer_load_dword v19, off, s[52:55], s80 sc1
s_waitcnt lgkmcnt(7)
v_mfma_f32_16x16x32_bf16 v[136:139], a[144:147], v[72:75], v[228:231]
s_waitcnt lgkmcnt(6)
ds_read_b128 a[176:179], v2 offset:8192
v_cndmask_b32 v120, v224, v17, s[0:1]
v_mfma_f32_16x16x32_bf16 v[136:139], a[148:151], v[76:79], v[136:139]
s_waitcnt lgkmcnt(6)
ds_read_b128 a[180:183], v2 offset:9216
v_cndmask_b32 v121, v224, v17, s[4:5]
v_cndmask_b32 v122, v224, v17, s[6:7]
v_cndmask_b32 v123, v224, v17, s[8:9]
v_mfma_f32_16x16x32_bf16 v[136:139], a[152:155], v[80:83], v[136:139]
s_waitcnt lgkmcnt(6)
buffer_load_dwordx4 v16, s[32:35], s70 offen offset:2048 sc1 lds
v_mfma_f32_16x16x32_bf16 v[136:139], a[156:159], v[84:87], v[136:139]
ds_read_b128 a[184:187], v2 offset:10240
v_cndmask_b32 v124, v224, v17, s[10:11]
v_mfma_f32_16x16x32_bf16 v[120:123], a[156:159], v[68:71], v[120:123]
ds_read_b128 a[188:191], v2 offset:11264
v_cndmask_b32 v125, v224, v17, s[12:13]
v_mfma_f32_16x16x32_bf16 v[120:123], a[152:155], v[64:67], v[120:123]
ds_read_b128 a[192:195], v2 offset:12288
v_cndmask_b32 v126, v224, v17, s[18:19]
v_mfma_f32_16x16x32_bf16 v[120:123], a[148:151], v[60:63], v[120:123]
ds_read_b128 a[196:199], v2 offset:13312
v_cndmask_b32 v127, v224, v17, s[22:23]
v_mfma_f32_16x16x32_bf16 v[120:123], a[144:147], v[56:59], v[120:123]
s_waitcnt lgkmcnt(4)
ds_read_b128 a[200:203], v2 offset:14336
v_cndmask_b32 v128, v224, v17, s[26:27]
v_mfma_f32_16x16x32_bf16 v[140:143], a[160:163], v[72:75], v[228:231]
ds_read_b128 a[204:207], v2 offset:15360
v_cndmask_b32 v129, v224, v17, s[56:57]
v_mfma_f32_16x16x32_bf16 v[140:143], a[164:167], v[76:79], v[140:143]
ds_read_b128 a[144:147], v3 offset:0
v_cndmask_b32 v130, v224, v17, s[58:59]
v_mfma_f32_16x16x32_bf16 v[140:143], a[168:171], v[80:83], v[140:143]
v_exp_f32 v136, v136
v_mfma_f32_16x16x32_bf16 v[140:143], a[172:175], v[84:87], v[140:143]
v_exp_f32 v137, v137
v_mfma_f32_16x16x32_bf16 v[124:127], a[172:175], v[68:71], v[124:127]
ds_read_b128 a[148:151], v3 offset:8192
v_cndmask_b32 v131, v224, v17, s[60:61]
v_mfma_f32_16x16x32_bf16 v[124:127], a[168:171], v[64:67], v[124:127]
v_exp_f32 v138, v138
v_mfma_f32_16x16x32_bf16 v[124:127], a[164:167], v[60:63], v[124:127]
s_mul_i32 s69, s83, 8
buffer_load_dwordx4 v16, s[32:35], s70 offen offset:3072 sc1 lds
v_mfma_f32_16x16x32_bf16 v[124:127], a[160:163], v[56:59], v[124:127]
s_sub_u32 s69, 36, s69
v_exp_f32 v139, v139
v_mfma_f32_16x16x32_bf16 v[128:131], a[176:179], v[56:59], v[128:131]
v_exp_f32 v120, v120
v_mfma_f32_16x16x32_bf16 v[128:131], a[180:183], v[60:63], v[128:131]
s_waitcnt lgkmcnt(1)
v_exp_f32 v121, v121
v_mfma_f32_16x16x32_bf16 v[128:131], a[184:187], v[64:67], v[128:131]
v_exp_f32 v122, v122
v_mfma_f32_16x16x32_bf16 v[128:131], a[188:191], v[68:71], v[128:131]
s_add_u32 m0, s71, 4096
ds_read_b128 a[152:155], v3 offset:1024
v_cndmask_b32 v132, v224, v17, s[62:63]
v_mfma_f32_16x16x32_bf16 v[144:147], a[188:191], v[84:87], v[228:231]
s_add_u32 s64, s70, 4096
v_cvt_pk_bf16_f32 v192, v136, v137
v_cndmask_b32 v133, v224, v17, s[48:49]
v_mfma_f32_16x16x32_bf16 v[144:147], a[184:187], v[80:83], v[144:147]
buffer_load_dwordx4 v16, s[32:35], s64 offen offset:0 sc1 lds
v_mfma_f32_16x16x32_bf16 v[144:147], a[180:183], v[76:79], v[144:147]
ds_read_b128 a[156:159], v3 offset:9216
v_cndmask_b32 v134, v224, v17, s[50:51]
v_mfma_f32_16x16x32_bf16 v[144:147], a[176:179], v[72:75], v[144:147]
ds_read_b128 a[160:163], v3 offset:2048
v_cndmask_b32 v135, v224, v17, s[100:101]
v_mfma_f32_16x16x32_bf16 v[148:151], a[192:195], v[72:75], v[228:231]
v_exp_f32 v123, v123
v_mfma_f32_16x16x32_bf16 v[148:151], a[196:199], v[76:79], v[148:151]
v_cvt_pk_bf16_f32 v193, v138, v139
v_cvt_pk_bf16_f32 v184, v120, v121
v_mfma_f32_16x16x32_bf16 v[148:151], a[200:203], v[80:83], v[148:151]
v_exp_f32 v140, v140
v_mfma_f32_16x16x32_bf16 v[148:151], a[204:207], v[84:87], v[148:151]
v_exp_f32 v141, v141
v_mfma_f32_16x16x32_bf16 v[132:135], a[204:207], v[68:71], v[132:135]
v_exp_f32 v142, v142
v_mfma_f32_16x16x32_bf16 v[132:135], a[200:203], v[64:67], v[132:135]
v_exp_f32 v143, v143
v_mfma_f32_16x16x32_bf16 v[132:135], a[196:199], v[60:63], v[132:135]
buffer_load_dwordx4 v16, s[32:35], s64 offen offset:1024 sc1 lds
v_mfma_f32_16x16x32_bf16 v[132:135], a[192:195], v[56:59], v[132:135]
v_exp_f32 v124, v124
v_smfmac_f32_16x16x64_bf16 a[132:135], a[240:243], v[176:183], v5
ds_read_b128 a[164:167], v3 offset:10240
v_smfmac_f32_16x16x64_bf16 a[136:139], a[240:243], v[200:207], v5
ds_read_b128 a[168:171], v3 offset:3072
v_accvgpr_read_b32 v240, a24
v_smfmac_f32_16x16x64_bf16 a[140:143], a[240:243], v[208:215], v5
v_cvt_pk_bf16_f32 v185, v122, v123
v_mfma_f32_16x16x32_bf16 a[32:35], a[144:147], v[176:179], a[32:35]
s_waitcnt lgkmcnt(2)
v_exp_f32 v125, v125
v_mfma_f32_16x16x32_bf16 a[32:35], a[148:151], v[180:183], a[32:35]
ds_read_b128 a[172:175], v3 offset:11264
v_accvgpr_read_b32 v241, a25
v_mfma_f32_16x16x32_bf16 a[64:67], a[148:151], v[204:207], a[64:67]
ds_read_b128 a[176:179], v3 offset:4096
v_accvgpr_read_b32 v242, a26
v_mfma_f32_16x16x32_bf16 a[64:67], a[144:147], v[200:203], a[64:67]
v_cvt_pk_bf16_f32 v194, v140, v141
v_accvgpr_read_b32 v243, a27
v_mfma_f32_16x16x32_bf16 a[96:99], a[144:147], v[208:211], a[96:99]
ds_read_b128 a[180:183], v3 offset:12288
v_accvgpr_read_b32 v244, a28
v_mfma_f32_16x16x32_bf16 a[96:99], a[148:151], v[212:215], a[96:99]
ds_read_b128 a[184:187], v3 offset:5120
v_accvgpr_read_b32 v245, a29
v_mfma_f32_16x16x32_bf16 a[100:103], a[156:159], v[212:215], a[100:103]
ds_read_b128 a[188:191], v3 offset:13312
v_accvgpr_read_b32 v246, a30
v_mfma_f32_16x16x32_bf16 a[100:103], a[152:155], v[208:211], a[100:103]
ds_read_b128 a[192:195], v3 offset:6144
v_accvgpr_read_b32 v247, a31
v_mul_f32 v240, v240, v20
v_mul_f32 v241, v241, v20
v_mul_f32 v242, v242, v20
v_mul_f32 v243, v243, v20
v_mul_f32 v244, v244, v20
v_mul_f32 v245, v245, v20
v_mul_f32 v246, v246, v20
v_mul_f32 v247, v247, v20
v_cvt_pk_bf16_f32 v240, v240, v241
v_cvt_pk_bf16_f32 v241, v242, v243
v_cvt_pk_bf16_f32 v242, v244, v245
v_cvt_pk_bf16_f32 v243, v246, v247
s_add_u32 s77, s74, 24576
buffer_store_dwordx4 v[240:243], v16, s[44:47], s77 offen sc1
v_exp_f32 v126, v126
v_mfma_f32_16x16x32_bf16 a[68:71], a[152:155], v[200:203], a[68:71]
buffer_load_dwordx4 v16, s[32:35], s64 offen offset:2048 sc1 lds
v_cvt_pk_bf16_f32 v195, v142, v143
v_mfma_f32_16x16x32_bf16 a[68:71], a[156:159], v[204:207], a[68:71]
v_exp_f32 v127, v127
v_mfma_f32_16x16x32_bf16 a[36:39], a[156:159], v[180:183], a[36:39]
v_exp_f32 v128, v128
v_mfma_f32_16x16x32_bf16 a[36:39], a[152:155], v[176:179], a[36:39]
v_exp_f32 v129, v129
v_mfma_f32_16x16x32_bf16 a[40:43], a[160:163], v[176:179], a[40:43]
s_waitcnt lgkmcnt(1)
v_cvt_pk_bf16_f32 v186, v124, v125
v_cvt_pk_bf16_f32 v187, v126, v127
v_mfma_f32_16x16x32_bf16 a[40:43], a[164:167], v[180:183], a[40:43]
v_exp_f32 v130, v130
v_mfma_f32_16x16x32_bf16 a[72:75], a[164:167], v[204:207], a[72:75]
buffer_load_dwordx4 v16, s[32:35], s64 offen offset:3072 sc1 lds
v_mfma_f32_16x16x32_bf16 a[72:75], a[160:163], v[200:203], a[72:75]
v_exp_f32 v131, v131
v_mfma_f32_16x16x32_bf16 a[104:107], a[160:163], v[208:211], a[104:107]
v_exp_f32 v144, v144
v_mfma_f32_16x16x32_bf16 a[104:107], a[164:167], v[212:215], a[104:107]
v_exp_f32 v145, v145
v_mfma_f32_16x16x32_bf16 a[108:111], a[172:175], v[212:215], a[108:111]
v_exp_f32 v146, v146
v_mfma_f32_16x16x32_bf16 a[108:111], a[168:171], v[208:211], a[108:111]
ds_read_b128 a[196:199], v3 offset:14336
v_cvt_pk_bf16_f32 v188, v128, v129
v_mfma_f32_16x16x32_bf16 a[76:79], a[168:171], v[200:203], a[76:79]
ds_read_b128 a[200:203], v3 offset:7168
v_cvt_pk_bf16_f32 v189, v130, v131
v_mfma_f32_16x16x32_bf16 a[76:79], a[172:175], v[204:207], a[76:79]
ds_read_b128 a[204:207], v3 offset:15360
v_cvt_pk_bf16_f32 v196, v144, v145
v_mfma_f32_16x16x32_bf16 a[44:47], a[172:175], v[180:183], a[44:47]
v_exp_f32 v147, v147
v_mfma_f32_16x16x32_bf16 a[44:47], a[168:171], v[176:179], a[44:47]
v_exp_f32 v148, v148
v_mfma_f32_16x16x32_bf16 a[48:51], a[176:179], v[176:179], a[48:51]
v_exp_f32 v149, v149
v_mfma_f32_16x16x32_bf16 a[48:51], a[180:183], v[180:183], a[48:51]
v_exp_f32 v150, v150
v_mfma_f32_16x16x32_bf16 a[80:83], a[180:183], v[204:207], a[80:83]
s_waitcnt vmcnt(10)
s_barrier
v_mfma_f32_16x16x32_bf16 a[80:83], a[176:179], v[200:203], a[80:83]
v_exp_f32 v151, v151
v_mfma_f32_16x16x32_bf16 a[112:115], a[176:179], v[208:211], a[112:115]
v_exp_f32 v132, v132
v_mfma_f32_16x16x32_bf16 a[112:115], a[180:183], v[212:215], a[112:115]
v_exp_f32 v133, v133
v_mfma_f32_16x16x32_bf16 a[116:119], a[188:191], v[212:215], a[116:119]
ds_read_b128 a[144:147], v2 offset:16384
v_cvt_pk_bf16_f32 v197, v146, v147
v_mfma_f32_16x16x32_bf16 a[116:119], a[184:187], v[208:211], a[116:119]
v_exp_f32 v134, v134
v_mfma_f32_16x16x32_bf16 a[84:87], a[184:187], v[200:203], a[84:87]
s_waitcnt vmcnt(7)
v_readfirstlane_b32 vcc_lo, v19
s_nop 0
s_cmp_lt_u32 vcc_lo, s69
s_cbranch_scc1 L_spin_1012
L_spinbk_1013:
v_mfma_f32_16x16x32_bf16 a[84:87], a[188:191], v[204:207], a[84:87]
ds_read_b128 a[148:151], v2 offset:17408
v_cvt_pk_bf16_f32 v198, v148, v149
v_mfma_f32_16x16x32_bf16 a[52:55], a[188:191], v[180:183], a[52:55]
ds_read_b128 a[152:155], v2 offset:18432
v_cvt_pk_bf16_f32 v199, v150, v151
v_mfma_f32_16x16x32_bf16 a[52:55], a[184:187], v[176:179], a[52:55]
s_waitcnt lgkmcnt(3)
ds_read_b128 a[156:159], v2 offset:19456
v_cndmask_b32 v136, v228, v17, s[0:1]
v_mfma_f32_16x16x32_bf16 a[56:59], a[192:195], v[176:179], a[56:59]
ds_read_b128 a[160:163], v2 offset:20480
v_cndmask_b32 v137, v228, v17, s[4:5]
v_mfma_f32_16x16x32_bf16 a[56:59], a[196:199], v[180:183], a[56:59]
ds_read_b128 a[164:167], v2 offset:21504
v_cndmask_b32 v138, v228, v17, s[6:7]
v_mfma_f32_16x16x32_bf16 a[88:91], a[196:199], v[204:207], a[88:91]
ds_read_b128 a[168:171], v2 offset:22528
v_cndmask_b32 v139, v228, v17, s[8:9]
v_mfma_f32_16x16x32_bf16 a[88:91], a[192:195], v[200:203], a[88:91]
v_exp_f32 v135, v135
v_mfma_f32_16x16x32_bf16 a[120:123], a[192:195], v[208:211], a[120:123]
ds_read_b128 a[172:175], v2 offset:23552
v_cvt_pk_bf16_f32 v190, v132, v133
v_mfma_f32_16x16x32_bf16 a[120:123], a[196:199], v[212:215], a[120:123]
v_cndmask_b32 v140, v228, v17, s[10:11]
v_cvt_pk_bf16_f32 v191, v134, v135
v_mfma_f32_16x16x32_bf16 a[124:127], a[204:207], v[212:215], a[124:127]
v_cndmask_b32 v141, v228, v17, s[12:13]
v_cndmask_b32 v142, v228, v17, s[18:19]
v_mfma_f32_16x16x32_bf16 a[124:127], a[200:203], v[208:211], a[124:127]
v_cndmask_b32 v143, v228, v17, s[22:23]
v_cndmask_b32 v144, v228, v17, s[26:27]
v_mfma_f32_16x16x32_bf16 a[92:95], a[200:203], v[200:203], a[92:95]
v_cndmask_b32 v145, v228, v17, s[56:57]
v_cndmask_b32 v146, v228, v17, s[58:59]
v_mfma_f32_16x16x32_bf16 a[92:95], a[204:207], v[204:207], a[92:95]
v_cndmask_b32 v147, v228, v17, s[60:61]
v_cndmask_b32 v148, v228, v17, s[62:63]
v_mfma_f32_16x16x32_bf16 a[60:63], a[204:207], v[180:183], a[60:63]
v_cndmask_b32 v149, v228, v17, s[48:49]
v_cndmask_b32 v150, v228, v17, s[50:51]
v_mfma_f32_16x16x32_bf16 a[60:63], a[200:203], v[176:179], a[60:63]
s_waitcnt lgkmcnt(0)
v_cndmask_b32 v151, v228, v17, s[100:101]
v_accvgpr_read_b32 v21, a132
v_mfma_f32_16x16x32_bf16 v[136:139], a[144:147], v[72:75], v[136:139]
ds_read_b128 a[176:179], v2 offset:24576
v_accvgpr_read_b32 v248, a133
v_mfma_f32_16x16x32_bf16 v[136:139], a[148:151], v[76:79], v[136:139]
ds_read_b128 a[180:183], v2 offset:25600
v_add_f32 v21, v21, v248
v_mfma_f32_16x16x32_bf16 v[136:139], a[152:155], v[80:83], v[136:139]
ds_read_b128 a[184:187], v2 offset:26624
v_max_f32 v1, v1, v21
v_mfma_f32_16x16x32_bf16 v[136:139], a[156:159], v[84:87], v[136:139]
ds_read_b128 a[188:191], v2 offset:27648
ds_read_b128 a[192:195], v2 offset:28672
v_mfma_f32_16x16x32_bf16 v[140:143], a[172:175], v[84:87], v[140:143]
ds_read_b128 a[196:199], v2 offset:29696
ds_read_b128 a[200:203], v2 offset:30720
ds_read_b128 a[204:207], v2 offset:31744
v_mfma_f32_16x16x32_bf16 v[140:143], a[168:171], v[80:83], v[140:143]
v_rcp_f32 v21, v21
v_mfma_f32_16x16x32_bf16 v[140:143], a[164:167], v[76:79], v[140:143]
ds_read_b128 a[144:147], v3 offset:16384
v_accvgpr_read_b32 v232, a32
v_mfma_f32_16x16x32_bf16 v[140:143], a[160:163], v[72:75], v[140:143]
s_waitcnt lgkmcnt(7)
ds_read_b128 a[148:151], v3 offset:24576
v_accvgpr_read_b32 v233, a33
v_mfma_f32_16x16x32_bf16 v[144:147], a[176:179], v[72:75], v[144:147]
ds_read_b128 a[152:155], v3 offset:17408
v_accvgpr_read_b32 v234, a34
v_mfma_f32_16x16x32_bf16 v[144:147], a[180:183], v[76:79], v[144:147]
s_waitcnt lgkmcnt(6)
ds_read_b128 a[156:159], v3 offset:25600
v_accvgpr_read_b32 v235, a35
v_mfma_f32_16x16x32_bf16 v[144:147], a[184:187], v[80:83], v[144:147]
ds_read_b128 a[160:163], v3 offset:18432
v_accvgpr_read_b32 v236, a36
v_accvgpr_read_b32 v237, a37
v_accvgpr_read_b32 v238, a38
v_accvgpr_read_b32 v239, a39
v_mul_f32 v21, v21, v6
v_mul_f32 v232, v232, v21
v_mul_f32 v233, v233, v21
v_mul_f32 v234, v234, v21
v_mul_f32 v235, v235, v21
v_mul_f32 v236, v236, v21
v_mul_f32 v237, v237, v21
v_mul_f32 v238, v238, v21
v_mul_f32 v239, v239, v21
v_cvt_pk_bf16_f32 v232, v232, v233
v_cvt_pk_bf16_f32 v233, v234, v235
v_cvt_pk_bf16_f32 v234, v236, v237
v_cvt_pk_bf16_f32 v235, v238, v239
s_add_u32 s77, s74, 4096
buffer_store_dwordx4 v[232:235], v16, s[44:47], s77 offen sc1
v_accvgpr_read_b32 v240, a40
v_accvgpr_read_b32 v241, a41
v_accvgpr_read_b32 v242, a42
v_accvgpr_read_b32 v243, a43
v_accvgpr_read_b32 v244, a44
v_accvgpr_read_b32 v245, a45
v_accvgpr_read_b32 v246, a46
v_accvgpr_read_b32 v247, a47
v_mul_f32 v240, v240, v21
v_mul_f32 v241, v241, v21
v_mul_f32 v242, v242, v21
v_mul_f32 v243, v243, v21
v_mul_f32 v244, v244, v21
v_mul_f32 v245, v245, v21
v_mul_f32 v246, v246, v21
v_mul_f32 v247, v247, v21
v_cvt_pk_bf16_f32 v240, v240, v241
v_cvt_pk_bf16_f32 v241, v242, v243
v_cvt_pk_bf16_f32 v242, v244, v245
v_cvt_pk_bf16_f32 v243, v246, v247
s_add_u32 s77, s74, 12288
buffer_store_dwordx4 v[240:243], v16, s[44:47], s77 offen sc1
v_accvgpr_read_b32 v232, a48
v_accvgpr_read_b32 v233, a49
v_accvgpr_read_b32 v234, a50
v_accvgpr_read_b32 v235, a51
v_accvgpr_read_b32 v236, a52
v_accvgpr_read_b32 v237, a53
v_accvgpr_read_b32 v238, a54
v_accvgpr_read_b32 v239, a55
v_mul_f32 v232, v232, v21
v_mul_f32 v233, v233, v21
v_mul_f32 v234, v234, v21
v_mul_f32 v235, v235, v21
v_mul_f32 v236, v236, v21
v_mul_f32 v237, v237, v21
v_mul_f32 v238, v238, v21
v_mul_f32 v239, v239, v21
v_cvt_pk_bf16_f32 v232, v232, v233
v_cvt_pk_bf16_f32 v233, v234, v235
v_cvt_pk_bf16_f32 v234, v236, v237
v_cvt_pk_bf16_f32 v235, v238, v239
s_add_u32 s77, s74, 20480
buffer_store_dwordx4 v[232:235], v16, s[44:47], s77 offen sc1
v_accvgpr_read_b32 v240, a56
v_accvgpr_read_b32 v241, a57
v_accvgpr_read_b32 v242, a58
v_accvgpr_read_b32 v243, a59
v_accvgpr_read_b32 v244, a60
v_accvgpr_read_b32 v245, a61
v_accvgpr_read_b32 v246, a62
v_accvgpr_read_b32 v247, a63
v_mul_f32 v240, v240, v21
v_mul_f32 v241, v241, v21
v_mul_f32 v242, v242, v21
v_mul_f32 v243, v243, v21
v_mul_f32 v244, v244, v21
v_mul_f32 v245, v245, v21
v_mul_f32 v246, v246, v21
v_mul_f32 v247, v247, v21
v_cvt_pk_bf16_f32 v240, v240, v241
v_cvt_pk_bf16_f32 v241, v242, v243
v_cvt_pk_bf16_f32 v242, v244, v245
v_cvt_pk_bf16_f32 v243, v246, v247
s_add_u32 s77, s74, 28672
buffer_store_dwordx4 v[240:243], v16, s[44:47], s77 offen sc1
v_exp_f32 v136, v136
v_mfma_f32_16x16x32_bf16 v[144:147], a[188:191], v[84:87], v[144:147]
s_waitcnt lgkmcnt(5)
v_exp_f32 v137, v137
v_mfma_f32_16x16x32_bf16 v[148:151], a[204:207], v[84:87], v[148:151]
v_exp_f32 v138, v138
v_mfma_f32_16x16x32_bf16 v[148:151], a[200:203], v[80:83], v[148:151]
s_add_u32 s65, s84, 0
v_exp_f32 v139, v139
v_mfma_f32_16x16x32_bf16 v[148:151], a[196:199], v[76:79], v[148:151]
buffer_load_dwordx4 a[208:211], v14, s[44:47], s65 offen offset:0 sc1
v_mfma_f32_16x16x32_bf16 v[148:151], a[192:195], v[72:75], v[148:151]
ds_read_b128 a[164:167], v3 offset:26624
v_cvt_pk_bf16_f32 v208, v136, v137
v_smfmac_f32_16x16x64_bf16 a[136:139], a[240:243], v[184:191], v5
ds_read_b128 a[168:171], v3 offset:19456
v_smfmac_f32_16x16x64_bf16 a[140:143], a[240:243], v[192:199], v5
s_waitcnt lgkmcnt(2)
ds_read_b128 a[172:175], v3 offset:27648
v_mfma_f32_16x16x32_bf16 a[64:67], a[144:147], v[184:187], a[64:67]
v_exp_f32 v140, v140
v_mfma_f32_16x16x32_bf16 a[64:67], a[148:151], v[188:191], a[64:67]
buffer_load_dwordx4 a[216:219], v14, s[44:47], s65 offen offset:1024 sc1
v_mfma_f32_16x16x32_bf16 a[96:99], a[148:151], v[196:199], a[96:99]
v_exp_f32 v141, v141
v_mfma_f32_16x16x32_bf16 a[96:99], a[144:147], v[192:195], a[96:99]
buffer_load_dwordx4 a[224:227], v15, s[44:47], s65 offen offset:0 sc1
v_mfma_f32_16x16x32_bf16 a[100:103], a[152:155], v[192:195], a[100:103]
v_exp_f32 v142, v142
v_mfma_f32_16x16x32_bf16 a[100:103], a[156:159], v[196:199], a[100:103]
buffer_load_dwordx4 a[232:235], v15, s[44:47], s65 offen offset:1024 sc1
v_mfma_f32_16x16x32_bf16 a[68:71], a[156:159], v[188:191], a[68:71]
s_add_u32 s65, s84, 8192
ds_read_b128 a[176:179], v3 offset:20480
v_cvt_pk_bf16_f32 v209, v138, v139
v_mfma_f32_16x16x32_bf16 a[68:71], a[152:155], v[184:187], a[68:71]
buffer_load_dwordx4 a[212:215], v14, s[44:47], s65 offen offset:0 sc1
v_mfma_f32_16x16x32_bf16 a[72:75], a[160:163], v[184:187], a[72:75]
s_waitcnt lgkmcnt(1)
ds_read_b128 a[180:183], v3 offset:28672
v_cvt_pk_bf16_f32 v210, v140, v141
v_mfma_f32_16x16x32_bf16 a[72:75], a[164:167], v[188:191], a[72:75]
v_exp_f32 v143, v143
v_mfma_f32_16x16x32_bf16 a[104:107], a[164:167], v[196:199], a[104:107]
buffer_load_dwordx4 a[220:223], v14, s[44:47], s65 offen offset:1024 sc1
v_mfma_f32_16x16x32_bf16 a[104:107], a[160:163], v[192:195], a[104:107]
v_exp_f32 v144, v144
v_mfma_f32_16x16x32_bf16 a[108:111], a[168:171], v[192:195], a[108:111]
ds_read_b128 a[184:187], v3 offset:21504
v_xor_b32 v2, 0x8000, v2
v_mfma_f32_16x16x32_bf16 a[108:111], a[172:175], v[196:199], a[108:111]
buffer_load_dwordx4 a[228:231], v15, s[44:47], s65 offen offset:0 sc1
ds_read_b128 a[188:191], v3 offset:29696
v_mfma_f32_16x16x32_bf16 a[76:79], a[172:175], v[188:191], a[76:79]
v_exp_f32 v145, v145
v_mfma_f32_16x16x32_bf16 a[76:79], a[168:171], v[184:187], a[76:79]
s_waitcnt lgkmcnt(2)
buffer_load_dwordx4 a[236:239], v15, s[44:47], s65 offen offset:1024 sc1
v_mfma_f32_16x16x32_bf16 a[80:83], a[176:179], v[184:187], a[80:83]
s_add_u32 s65, s84, 32768
ds_read_b128 a[192:195], v3 offset:22528
v_cvt_pk_bf16_f32 v211, v142, v143
v_mfma_f32_16x16x32_bf16 a[80:83], a[180:183], v[188:191], a[80:83]
buffer_load_dwordx4 v[152:155], v14, s[44:47], s65 offen offset:0 sc1
ds_read_b128 a[196:199], v3 offset:30720
v_exp_f32 v146, v146
v_mfma_f32_16x16x32_bf16 a[112:115], a[180:183], v[196:199], a[112:115]
ds_read_b128 a[200:203], v3 offset:23552
ds_read_b128 a[204:207], v3 offset:31744
v_mfma_f32_16x16x32_bf16 a[112:115], a[176:179], v[192:195], a[112:115]
s_waitcnt vmcnt(13)
s_barrier
v_xor_b32 v3, 0x8000, v3
buffer_load_dwordx4 v[160:163], v14, s[44:47], s65 offen offset:1024 sc1
s_waitcnt lgkmcnt(4)
v_mfma_f32_16x16x32_bf16 a[116:119], a[184:187], v[192:195], a[116:119]
v_exp_f32 v147, v147
v_mfma_f32_16x16x32_bf16 a[116:119], a[188:191], v[196:199], a[116:119]
buffer_load_dwordx4 v[168:171], v15, s[44:47], s65 offen offset:0 sc1
v_mfma_f32_16x16x32_bf16 a[84:87], a[188:191], v[188:191], a[84:87]
v_exp_f32 v148, v148
v_mfma_f32_16x16x32_bf16 a[84:87], a[184:187], v[184:187], a[84:87]
s_waitcnt lgkmcnt(2)
buffer_load_dwordx4 v[176:179], v15, s[44:47], s65 offen offset:1024 sc1
v_cvt_pk_bf16_f32 v212, v144, v145
v_mfma_f32_16x16x32_bf16 a[88:91], a[192:195], v[184:187], a[88:91]
s_add_u32 s65, s84, 40960
v_exp_f32 v149, v149
v_mfma_f32_16x16x32_bf16 a[88:91], a[196:199], v[188:191], a[88:91]
buffer_load_dwordx4 v[156:159], v14, s[44:47], s65 offen offset:0 sc1
v_mfma_f32_16x16x32_bf16 a[120:123], a[196:199], v[196:199], a[120:123]
ds_read_b128 a[144:147], v3 offset:0
v_cvt_pk_bf16_f32 v213, v146, v147
v_mfma_f32_16x16x32_bf16 a[120:123], a[192:195], v[192:195], a[120:123]
s_waitcnt lgkmcnt(1)
buffer_load_dwordx4 v[164:167], v14, s[44:47], s65 offen offset:1024 sc1
ds_read_b128 a[148:151], v3 offset:8192
v_exp_f32 v150, v150
v_mfma_f32_16x16x32_bf16 a[124:127], a[200:203], v[192:195], a[124:127]
ds_read_b128 a[152:155], v3 offset:1024
v_cvt_pk_bf16_f32 v214, v148, v149
v_mfma_f32_16x16x32_bf16 a[124:127], a[204:207], v[196:199], a[124:127]
buffer_load_dwordx4 v[172:175], v15, s[44:47], s65 offen offset:0 sc1
ds_read_b128 a[156:159], v3 offset:9216
v_mfma_f32_16x16x32_bf16 a[92:95], a[204:207], v[188:191], a[92:95]
v_exp_f32 v151, v151
v_mfma_f32_16x16x32_bf16 a[92:95], a[200:203], v[184:187], a[92:95]
buffer_load_dwordx4 v[180:183], v15, s[44:47], s65 offen offset:1024 sc1
ds_read_b128 a[160:163], v3 offset:2048
ds_read_b128 a[164:167], v3 offset:10240
ds_read_b128 a[168:171], v3 offset:3072
ds_read_b128 a[172:175], v3 offset:11264
v_cvt_pk_bf16_f32 v215, v150, v151
v_accvgpr_read_b32 v22, a136
v_accvgpr_read_b32 v248, a137
v_add_f32 v22, v22, v248
v_max_f32 v1, v1, v22
v_rcp_f32 v22, v22
v_accvgpr_read_b32 v232, a64
v_accvgpr_read_b32 v233, a65
v_accvgpr_read_b32 v234, a66
v_accvgpr_read_b32 v235, a67
v_accvgpr_read_b32 v236, a68
v_accvgpr_read_b32 v237, a69
v_accvgpr_read_b32 v238, a70
v_accvgpr_read_b32 v239, a71
v_mul_f32 v22, v22, v8
v_mul_f32 v232, v232, v22
v_mul_f32 v233, v233, v22
v_mul_f32 v234, v234, v22
v_mul_f32 v235, v235, v22
v_mul_f32 v236, v236, v22
v_mul_f32 v237, v237, v22
v_mul_f32 v238, v238, v22
v_mul_f32 v239, v239, v22
v_cvt_pk_bf16_f32 v232, v232, v233
v_cvt_pk_bf16_f32 v233, v234, v235
v_cvt_pk_bf16_f32 v234, v236, v237
v_cvt_pk_bf16_f32 v235, v238, v239
s_add_u32 s77, s75, 0
buffer_store_dwordx4 v[232:235], v16, s[44:47], s77 offen sc1
s_branch L_TAIL
L_fallback_11:
s_waitcnt vmcnt(0) lgkmcnt(0)
s_barrier
s_mov_b32 s73, 1
s_mov_b32 s81, 0
v_and_b32 v232, 15, v0
v_lshrrev_b32 v233, 4, v0
v_lshlrev_b32 v233, 2, v233
v_sub_u32 v232, v232, v233
s_lshl_b32 s66, s30, 4
v_add_u32 v232, s66, v232
s_lshl_b32 s66, s16, 7
v_add_u32 v234, s66, v232
s_lshl_b32 s66, s3, 7
v_add_u32 v232, s66, v232
v_add_u32 v233, 64, v232
v_add_u32 v235, 64, v234
s_mov_b32 m0, s76
s_lshl_b32 s64, s30, 14
s_nop 0
buffer_load_dwordx4 v16, s[32:35], s64 offen offset:0 sc1 lds
s_nop 0
buffer_load_dwordx4 v16, s[32:35], s64 offen offset:1024 sc1 lds
s_nop 0
buffer_load_dwordx4 v16, s[32:35], s64 offen offset:2048 sc1 lds
s_nop 0
buffer_load_dwordx4 v16, s[32:35], s64 offen offset:3072 sc1 lds
s_add_u32 m0, s76, 4096
s_add_u32 s64, s64, 4096
s_nop 0
buffer_load_dwordx4 v16, s[32:35], s64 offen offset:0 sc1 lds
s_nop 0
buffer_load_dwordx4 v16, s[32:35], s64 offen offset:1024 sc1 lds
s_nop 0
buffer_load_dwordx4 v16, s[32:35], s64 offen offset:2048 sc1 lds
s_nop 0
buffer_load_dwordx4 v16, s[32:35], s64 offen offset:3072 sc1 lds
s_lshr_b32 s64, s76, 1
s_add_u32 m0, s64, 81920
s_and_b32 s71, s64, 8192
s_add_u32 s64, s64, s71
s_add_u32 s64, s64, 8192
s_nop 0
buffer_load_dwordx4 v16, s[32:35], s64 offen offset:0 sc1 lds
s_nop 0
buffer_load_dwordx4 v16, s[32:35], s64 offen offset:1024 sc1 lds
s_nop 0
buffer_load_dwordx4 v16, s[32:35], s64 offen offset:2048 sc1 lds
s_nop 0
buffer_load_dwordx4 v16, s[32:35], s64 offen offset:3072 sc1 lds
v_mov_b32 v20, 0xff800000
v_mov_b32 v21, 0xff800000
v_mov_b32 v22, 0xff800000
v_mov_b32 v23, 0xff800000
L_fbl_1015:
buffer_load_dwordx4 a[144:147], v16, s[32:35], s81 offen offset:0 sc1
buffer_load_dwordx4 a[148:151], v16, s[32:35], s81 offen offset:1024 sc1
buffer_load_dwordx4 a[152:155], v16, s[32:35], s81 offen offset:2048 sc1
buffer_load_dwordx4 a[156:159], v16, s[32:35], s81 offen offset:3072 sc1
s_add_u32 s64, s81, 4096
buffer_load_dwordx4 a[160:163], v16, s[32:35], s64 offen offset:0 sc1
buffer_load_dwordx4 a[164:167], v16, s[32:35], s64 offen offset:1024 sc1
buffer_load_dwordx4 a[168:171], v16, s[32:35], s64 offen offset:2048 sc1
buffer_load_dwordx4 a[172:175], v16, s[32:35], s64 offen offset:3072 sc1
v_subrev_u32 v88, 0, v232
v_ashrrev_i32 v88, 31, v88
v_and_b32 v88, 0xff800000, v88
v_subrev_u32 v89, 1, v232
v_ashrrev_i32 v89, 31, v89
v_and_b32 v89, 0xff800000, v89
v_subrev_u32 v90, 2, v232
v_ashrrev_i32 v90, 31, v90
v_and_b32 v90, 0xff800000, v90
v_subrev_u32 v91, 3, v232
v_ashrrev_i32 v91, 31, v91
v_and_b32 v91, 0xff800000, v91
v_subrev_u32 v92, 16, v232
v_ashrrev_i32 v92, 31, v92
v_and_b32 v92, 0xff800000, v92
v_subrev_u32 v93, 17, v232
v_ashrrev_i32 v93, 31, v93
v_and_b32 v93, 0xff800000, v93
v_subrev_u32 v94, 18, v232
v_ashrrev_i32 v94, 31, v94
v_and_b32 v94, 0xff800000, v94
v_subrev_u32 v95, 19, v232
v_ashrrev_i32 v95, 31, v95
v_and_b32 v95, 0xff800000, v95
v_subrev_u32 v232, 32, v232
v_subrev_u32 v104, 0, v233
v_ashrrev_i32 v104, 31, v104
v_and_b32 v104, 0xff800000, v104
v_subrev_u32 v105, 1, v233
v_ashrrev_i32 v105, 31, v105
v_and_b32 v105, 0xff800000, v105
v_subrev_u32 v106, 2, v233
v_ashrrev_i32 v106, 31, v106
v_and_b32 v106, 0xff800000, v106
v_subrev_u32 v107, 3, v233
v_ashrrev_i32 v107, 31, v107
v_and_b32 v107, 0xff800000, v107
v_subrev_u32 v108, 16, v233
v_ashrrev_i32 v108, 31, v108
v_and_b32 v108, 0xff800000, v108
v_subrev_u32 v109, 17, v233
v_ashrrev_i32 v109, 31, v109
v_and_b32 v109, 0xff800000, v109
v_subrev_u32 v110, 18, v233
v_ashrrev_i32 v110, 31, v110
v_and_b32 v110, 0xff800000, v110
v_subrev_u32 v111, 19, v233
v_ashrrev_i32 v111, 31, v111
v_and_b32 v111, 0xff800000, v111
v_subrev_u32 v233, 32, v233
v_subrev_u32 v120, 0, v234
v_ashrrev_i32 v120, 31, v120
v_and_b32 v120, 0xff800000, v120
v_subrev_u32 v121, 1, v234
v_ashrrev_i32 v121, 31, v121
v_and_b32 v121, 0xff800000, v121
v_subrev_u32 v122, 2, v234
v_ashrrev_i32 v122, 31, v122
v_and_b32 v122, 0xff800000, v122
v_subrev_u32 v123, 3, v234
v_ashrrev_i32 v123, 31, v123
v_and_b32 v123, 0xff800000, v123
v_subrev_u32 v124, 16, v234
v_ashrrev_i32 v124, 31, v124
v_and_b32 v124, 0xff800000, v124
v_subrev_u32 v125, 17, v234
v_ashrrev_i32 v125, 31, v125
v_and_b32 v125, 0xff800000, v125
v_subrev_u32 v126, 18, v234
v_ashrrev_i32 v126, 31, v126
v_and_b32 v126, 0xff800000, v126
v_subrev_u32 v127, 19, v234
v_ashrrev_i32 v127, 31, v127
v_and_b32 v127, 0xff800000, v127
v_subrev_u32 v234, 32, v234
v_subrev_u32 v136, 0, v235
v_ashrrev_i32 v136, 31, v136
v_and_b32 v136, 0xff800000, v136
v_subrev_u32 v137, 1, v235
v_ashrrev_i32 v137, 31, v137
v_and_b32 v137, 0xff800000, v137
v_subrev_u32 v138, 2, v235
v_ashrrev_i32 v138, 31, v138
v_and_b32 v138, 0xff800000, v138
v_subrev_u32 v139, 3, v235
v_ashrrev_i32 v139, 31, v139
v_and_b32 v139, 0xff800000, v139
v_subrev_u32 v140, 16, v235
v_ashrrev_i32 v140, 31, v140
v_and_b32 v140, 0xff800000, v140
v_subrev_u32 v141, 17, v235
v_ashrrev_i32 v141, 31, v141
v_and_b32 v141, 0xff800000, v141
v_subrev_u32 v142, 18, v235
v_ashrrev_i32 v142, 31, v142
v_and_b32 v142, 0xff800000, v142
v_subrev_u32 v143, 19, v235
v_ashrrev_i32 v143, 31, v143
v_and_b32 v143, 0xff800000, v143
v_subrev_u32 v235, 32, v235
s_waitcnt vmcnt(0)
v_mfma_f32_16x16x32_bf16 v[88:91], a[144:147], v[24:27], v[88:91]
v_mfma_f32_16x16x32_bf16 v[104:107], a[144:147], v[40:43], v[104:107]
v_mfma_f32_16x16x32_bf16 v[120:123], a[144:147], v[56:59], v[120:123]
v_mfma_f32_16x16x32_bf16 v[136:139], a[144:147], v[72:75], v[136:139]
v_mfma_f32_16x16x32_bf16 v[88:91], a[148:151], v[28:31], v[88:91]
v_mfma_f32_16x16x32_bf16 v[104:107], a[148:151], v[44:47], v[104:107]
v_mfma_f32_16x16x32_bf16 v[120:123], a[148:151], v[60:63], v[120:123]
v_mfma_f32_16x16x32_bf16 v[136:139], a[148:151], v[76:79], v[136:139]
v_mfma_f32_16x16x32_bf16 v[88:91], a[152:155], v[32:35], v[88:91]
v_mfma_f32_16x16x32_bf16 v[104:107], a[152:155], v[48:51], v[104:107]
v_mfma_f32_16x16x32_bf16 v[120:123], a[152:155], v[64:67], v[120:123]
v_mfma_f32_16x16x32_bf16 v[136:139], a[152:155], v[80:83], v[136:139]
v_mfma_f32_16x16x32_bf16 v[88:91], a[156:159], v[36:39], v[88:91]
v_mfma_f32_16x16x32_bf16 v[104:107], a[156:159], v[52:55], v[104:107]
v_mfma_f32_16x16x32_bf16 v[120:123], a[156:159], v[68:71], v[120:123]
v_mfma_f32_16x16x32_bf16 v[136:139], a[156:159], v[84:87], v[136:139]
v_mfma_f32_16x16x32_bf16 v[92:95], a[160:163], v[24:27], v[92:95]
v_mfma_f32_16x16x32_bf16 v[108:111], a[160:163], v[40:43], v[108:111]
v_mfma_f32_16x16x32_bf16 v[124:127], a[160:163], v[56:59], v[124:127]
v_mfma_f32_16x16x32_bf16 v[140:143], a[160:163], v[72:75], v[140:143]
v_mfma_f32_16x16x32_bf16 v[92:95], a[164:167], v[28:31], v[92:95]
v_mfma_f32_16x16x32_bf16 v[108:111], a[164:167], v[44:47], v[108:111]
v_mfma_f32_16x16x32_bf16 v[124:127], a[164:167], v[60:63], v[124:127]
v_mfma_f32_16x16x32_bf16 v[140:143], a[164:167], v[76:79], v[140:143]
v_mfma_f32_16x16x32_bf16 v[92:95], a[168:171], v[32:35], v[92:95]
v_mfma_f32_16x16x32_bf16 v[108:111], a[168:171], v[48:51], v[108:111]
v_mfma_f32_16x16x32_bf16 v[124:127], a[168:171], v[64:67], v[124:127]
v_mfma_f32_16x16x32_bf16 v[140:143], a[168:171], v[80:83], v[140:143]
v_mfma_f32_16x16x32_bf16 v[92:95], a[172:175], v[36:39], v[92:95]
v_mfma_f32_16x16x32_bf16 v[108:111], a[172:175], v[52:55], v[108:111]
v_mfma_f32_16x16x32_bf16 v[124:127], a[172:175], v[68:71], v[124:127]
v_mfma_f32_16x16x32_bf16 v[140:143], a[172:175], v[84:87], v[140:143]
s_nop 7
v_max3_f32 v20, v20, v88, v89
v_max3_f32 v20, v20, v90, v91
v_max3_f32 v20, v20, v92, v93
v_max3_f32 v20, v20, v94, v95
v_max3_f32 v21, v21, v104, v105
v_max3_f32 v21, v21, v106, v107
v_max3_f32 v21, v21, v108, v109
v_max3_f32 v21, v21, v110, v111
v_max3_f32 v22, v22, v120, v121
v_max3_f32 v22, v22, v122, v123
v_max3_f32 v22, v22, v124, v125
v_max3_f32 v22, v22, v126, v127
v_max3_f32 v23, v23, v136, v137
v_max3_f32 v23, v23, v138, v139
v_max3_f32 v23, v23, v140, v141
v_max3_f32 v23, v23, v142, v143
s_add_u32 s81, s81, 16384
s_cmp_lt_u32 s81, s34
s_cbranch_scc1 L_fbl_1015
v_mov_b32 v248, v20
v_mov_b32 v249, v21
v_mov_b32 v250, v22
v_mov_b32 v251, v23
v_permlane16_swap_b32 v248, v20
v_permlane16_swap_b32 v249, v21
v_permlane16_swap_b32 v250, v22
v_permlane16_swap_b32 v251, v23
v_max_f32 v20, v20, v248
v_max_f32 v21, v21, v249
v_max_f32 v22, v22, v250
v_max_f32 v23, v23, v251
v_mov_b32 v248, v20
v_mov_b32 v249, v21
v_mov_b32 v250, v22
v_mov_b32 v251, v23
v_permlane32_swap_b32 v248, v20
v_permlane32_swap_b32 v249, v21
v_permlane32_swap_b32 v250, v22
v_permlane32_swap_b32 v251, v23
v_max_f32 v20, v20, v248
v_max_f32 v21, v21, v249
v_max_f32 v22, v22, v250
v_max_f32 v23, v23, v251
v_mov_b32 v252, v20
v_mov_b32 v253, v21
v_mov_b32 v254, v22
v_mov_b32 v255, v23
s_and_b32 s70, s30, 1
s_lshr_b32 s67, s30, 1
s_lshl3_add_u32 s71, s67, s70
s_add_u32 s71, s71, 4
s_lshl_b32 s71, s71, 13
s_lshl_b32 s70, s70, 14
s_mul_i32 s67, s67, 24576
s_sub_u32 s70, s70, s67
s_add_u32 s70, s70, 65536
v_mov_b32 v2, v16
v_add_u32 v3, 0x10000, v16
v_mov_b32 v1, 0
s_mov_b32 m0, s71
s_waitcnt lgkmcnt(0)
s_barrier
ds_read_b128 a[144:147], v2 offset:0
ds_read_b128 a[148:151], v2 offset:1024
ds_read_b128 a[152:155], v2 offset:2048
ds_read_b128 a[156:159], v2 offset:3072
ds_read_b128 a[160:163], v2 offset:4096
ds_read_b128 a[164:167], v2 offset:5120
ds_read_b128 a[168:171], v2 offset:6144
ds_read_b128 a[172:175], v2 offset:7168
buffer_load_dwordx4 v16, s[32:35], s70 offen offset:0 sc1 lds
buffer_load_dwordx4 v16, s[32:35], s70 offen offset:1024 sc1 lds
s_waitcnt vmcnt(0) lgkmcnt(0)
s_branch L_attstart_7
L_spin_2016:
s_mov_b32 vcc_hi, 0x80000
L_spinlp_2018:
s_sleep 1
buffer_load_dword v19, off, s[52:55], s72 offset:0 sc1
s_waitcnt vmcnt(0)
v_readfirstlane_b32 vcc_lo, v19
s_sub_u32 vcc_hi, vcc_hi, 1
s_cbranch_scc1 L_spinbk_2017
s_cmp_lt_u32 vcc_lo, 8
s_cbranch_scc1 L_spinlp_2018
s_branch L_spinbk_2017
L_spin_3019:
s_mov_b32 vcc_hi, 0x80000
L_spinlp_3021:
s_sleep 1
buffer_load_dword v19, off, s[52:55], s72 offset:0 sc1
s_waitcnt vmcnt(0)
v_readfirstlane_b32 vcc_lo, v19
s_sub_u32 vcc_hi, vcc_hi, 1
s_cbranch_scc1 L_spinbk_3020
s_cmp_lt_u32 vcc_lo, 8
s_cbranch_scc1 L_spinlp_3021
s_branch L_spinbk_3020
.p2align 12
L_pg24:
s_branch L_tr2
L_p5f0:
s_waitcnt lgkmcnt(10)
s_waitcnt vmcnt(28)
v_mfma_f32_16x16x32_bf16 v[136:139], a[144:147], a[232:235], 0
s_waitcnt vmcnt(24)
s_waitcnt lgkmcnt(8)
s_add_u32 m0, s86, 65536
ds_read_b64_tr_b16 a[168:169], v191 offset:32768
v_xor_b32 v192, 0x10000, v184
v_mfma_f32_16x16x32_bf16 v[136:139], a[148:151], a[236:239], v[136:139]
s_add_u32 s64, s85, 524288
ds_read_b64_tr_b16 a[170:171], v191 offset:36864
v_xor_b32 v193, 0x10000, v185
v_mfma_f32_16x16x32_bf16 v[104:107], a[148:151], a[228:231], 0
buffer_load_dwordx4 v12, s[36:39], s64 offen lds
v_mfma_f32_16x16x32_bf16 v[104:107], a[144:147], a[224:227], v[104:107]
s_add_u32 m0, s86, 66560
s_add_u32 s64, s85, 532480
ds_read_b64_tr_b16 a[172:173], v191 offset:40960
v_xor_b32 v194, 0x10000, v186
v_mfma_f32_16x16x32_bf16 v[72:75], a[144:147], a[216:219], 0
buffer_load_dwordx4 v13, s[36:39], s64 offen lds
v_mfma_f32_16x16x32_bf16 v[72:75], a[148:151], a[220:223], v[72:75]
s_add_u32 m0, s86, 67584
ds_read_b64_tr_b16 a[174:175], v191 offset:45056
v_xor_b32 v195, 0x10000, v187
v_mfma_f32_16x16x32_bf16 v[40:43], a[148:151], a[212:215], 0
s_add_u32 s64, s85, 540672
ds_read_b64_tr_b16 a[176:177], v184 offset:32768
v_xor_b32 v196, 0x10000, v188
v_mfma_f32_16x16x32_bf16 v[40:43], a[144:147], a[208:211], v[40:43]
s_waitcnt lgkmcnt(5)
buffer_load_dwordx4 v12, s[36:39], s64 offen lds
v_mfma_f32_16x16x32_bf16 v[44:47], a[152:155], a[208:211], 0
s_add_u32 m0, s86, 68608
s_add_u32 s64, s85, 548864
ds_read_b64_tr_b16 a[178:179], v184 offset:36864
v_xor_b32 v197, 0x10000, v189
v_mfma_f32_16x16x32_bf16 v[44:47], a[156:159], a[212:215], v[44:47]
buffer_load_dwordx4 v13, s[36:39], s64 offen lds
v_mfma_f32_16x16x32_bf16 v[76:79], a[156:159], a[220:223], 0
s_add_u32 m0, s86, 69632
ds_read_b64_tr_b16 a[180:181], v184 offset:40960
v_xor_b32 v198, 0x10000, v190
v_mfma_f32_16x16x32_bf16 v[76:79], a[152:155], a[216:219], v[76:79]
s_add_u32 s64, s85, 557056
ds_read_b64_tr_b16 a[182:183], v184 offset:45056
v_xor_b32 v199, 0x10000, v191
v_mfma_f32_16x16x32_bf16 v[108:111], a[152:155], a[224:227], 0
buffer_load_dwordx4 v12, s[36:39], s64 offen lds
v_mfma_f32_16x16x32_bf16 v[108:111], a[156:159], a[228:231], v[108:111]
s_add_u32 m0, s86, 70656
s_add_u32 s64, s85, 565248
ds_read_b64_tr_b16 a[184:185], v185 offset:32768
v_mfma_f32_16x16x32_bf16 v[140:143], a[156:159], a[236:239], 0
buffer_load_dwordx4 v13, s[36:39], s64 offen lds
v_mfma_f32_16x16x32_bf16 v[140:143], a[152:155], a[232:235], v[140:143]
s_add_u32 m0, s86, 71680
ds_read_b64_tr_b16 a[186:187], v185 offset:36864
v_mfma_f32_16x16x32_bf16 v[144:147], a[160:163], a[232:235], 0
s_add_u32 s64, s85, 573440
ds_read_b64_tr_b16 a[188:189], v185 offset:40960
v_mfma_f32_16x16x32_bf16 v[144:147], a[164:167], a[236:239], v[144:147]
buffer_load_dwordx4 v12, s[36:39], s64 offen lds
v_mfma_f32_16x16x32_bf16 v[112:115], a[164:167], a[228:231], 0
s_and_b32 s71, s31, 4
s_lshl_b32 s71, s71, 5
s_add_u32 m0, s86, 72704
s_add_u32 s64, s85, 581632
ds_read_b64_tr_b16 a[190:191], v185 offset:45056
v_mfma_f32_16x16x32_bf16 v[112:115], a[160:163], a[224:227], v[112:115]
s_add_u32 s71, s71, s79
buffer_load_dwordx4 v13, s[36:39], s64 offen lds
v_mfma_f32_16x16x32_bf16 v[80:83], a[160:163], a[216:219], 0
s_add_u32 s71, s71, 4096
s_add_u32 s72, s80, 4096
ds_read_b64_tr_b16 a[192:193], v186 offset:32768
v_mfma_f32_16x16x32_bf16 v[80:83], a[164:167], a[220:223], v[80:83]
s_add_u32 s65, s84, 65536
ds_read_b64_tr_b16 a[194:195], v186 offset:36864
v_mfma_f32_16x16x32_bf16 v[48:51], a[164:167], a[212:215], 0
buffer_load_dwordx4 a[0:3], v14, s[44:47], s65 offen offset:0 sc1
v_mfma_f32_16x16x32_bf16 v[48:51], a[160:163], a[208:211], v[48:51]
s_waitcnt lgkmcnt(4)
ds_read_b64_tr_b16 a[196:197], v186 offset:40960
v_mfma_f32_16x16x32_bf16 v[52:55], a[168:171], a[208:211], 0
buffer_load_dwordx4 a[8:11], v14, s[44:47], s65 offen offset:1024 sc1
v_mfma_f32_16x16x32_bf16 v[52:55], a[172:175], a[212:215], v[52:55]
ds_read_b64_tr_b16 a[198:199], v186 offset:45056
v_mfma_f32_16x16x32_bf16 v[84:87], a[172:175], a[220:223], 0
ds_read_b64_tr_b16 a[200:201], v187 offset:32768
v_mfma_f32_16x16x32_bf16 v[84:87], a[168:171], a[216:219], v[84:87]
buffer_load_dwordx4 a[16:19], v15, s[44:47], s65 offen offset:0 sc1
v_mfma_f32_16x16x32_bf16 v[116:119], a[168:171], a[224:227], 0
ds_read_b64_tr_b16 a[202:203], v187 offset:36864
v_mfma_f32_16x16x32_bf16 v[116:119], a[172:175], a[228:231], v[116:119]
buffer_load_dwordx4 a[24:27], v15, s[44:47], s65 offen offset:1024 sc1
v_mfma_f32_16x16x32_bf16 v[148:151], a[172:175], a[236:239], 0
ds_read_b64_tr_b16 a[204:205], v187 offset:40960
v_mfma_f32_16x16x32_bf16 v[148:151], a[168:171], a[232:235], v[148:151]
s_add_u32 s65, s84, 73728
ds_read_b64_tr_b16 a[206:207], v187 offset:45056
v_mfma_f32_16x16x32_bf16 v[120:123], a[176:179], a[232:235], 0
buffer_load_dwordx4 a[4:7], v14, s[44:47], s65 offen offset:0 sc1
v_mfma_f32_16x16x32_bf16 v[120:123], a[180:183], a[236:239], v[120:123]
v_mfma_f32_16x16x32_bf16 v[88:91], a[180:183], a[228:231], 0
buffer_load_dwordx4 a[12:15], v14, s[44:47], s65 offen offset:1024 sc1
v_mfma_f32_16x16x32_bf16 v[88:91], a[176:179], a[224:227], v[88:91]
v_mfma_f32_16x16x32_bf16 v[56:59], a[176:179], a[216:219], 0
v_mfma_f32_16x16x32_bf16 v[56:59], a[180:183], a[220:223], v[56:59]
buffer_load_dwordx4 a[20:23], v15, s[44:47], s65 offen offset:0 sc1
v_mfma_f32_16x16x32_bf16 v[24:27], a[180:183], a[212:215], 0
v_mfma_f32_16x16x32_bf16 v[24:27], a[176:179], a[208:211], v[24:27]
buffer_load_dwordx4 a[28:31], v15, s[44:47], s65 offen offset:1024 sc1
v_mfma_f32_16x16x32_bf16 v[28:31], a[184:187], a[208:211], 0
s_waitcnt lgkmcnt(0)
v_mfma_f32_16x16x32_bf16 v[28:31], a[188:191], a[212:215], v[28:31]
v_mfma_f32_16x16x32_bf16 v[60:63], a[188:191], a[220:223], 0
v_mfma_f32_16x16x32_bf16 v[60:63], a[184:187], a[216:219], v[60:63]
s_waitcnt vmcnt(23)
s_barrier
v_mfma_f32_16x16x32_bf16 v[92:95], a[184:187], a[224:227], 0
ds_read_b64_tr_b16 a[144:145], v196 offset:0
v_mfma_f32_16x16x32_bf16 v[92:95], a[188:191], a[228:231], v[92:95]
ds_read_b64_tr_b16 a[146:147], v196 offset:4096
v_mfma_f32_16x16x32_bf16 v[124:127], a[188:191], a[236:239], 0
s_add_u32 m0, s86, 0
ds_read_b64_tr_b16 a[148:149], v196 offset:8192
v_mfma_f32_16x16x32_bf16 v[124:127], a[184:187], a[232:235], v[124:127]
s_add_u32 s64, s85, 786432
ds_read_b64_tr_b16 a[150:151], v196 offset:12288
v_mfma_f32_16x16x32_bf16 v[128:131], a[192:195], a[232:235], 0
buffer_load_dwordx4 v12, s[36:39], s64 offen lds
v_mfma_f32_16x16x32_bf16 v[128:131], a[196:199], a[236:239], v[128:131]
s_add_u32 m0, s86, 1024
ds_read_b64_tr_b16 a[152:153], v197 offset:0
v_mfma_f32_16x16x32_bf16 v[96:99], a[196:199], a[228:231], 0
s_add_u32 s64, s85, 794624
ds_read_b64_tr_b16 a[154:155], v197 offset:4096
v_mfma_f32_16x16x32_bf16 v[96:99], a[192:195], a[224:227], v[96:99]
buffer_load_dwordx4 v13, s[36:39], s64 offen lds
v_mfma_f32_16x16x32_bf16 v[64:67], a[192:195], a[216:219], 0
s_add_u32 m0, s86, 2048
ds_read_b64_tr_b16 a[156:157], v197 offset:8192
v_mfma_f32_16x16x32_bf16 v[64:67], a[196:199], a[220:223], v[64:67]
s_add_u32 s64, s85, 802816
ds_read_b64_tr_b16 a[158:159], v197 offset:12288
v_mfma_f32_16x16x32_bf16 v[32:35], a[196:199], a[212:215], 0
buffer_load_dwordx4 v12, s[36:39], s64 offen lds
v_mfma_f32_16x16x32_bf16 v[32:35], a[192:195], a[208:211], v[32:35]
s_add_u32 m0, s86, 3072
ds_read_b64_tr_b16 a[160:161], v198 offset:0
v_mfma_f32_16x16x32_bf16 v[36:39], a[200:203], a[208:211], 0
s_add_u32 s64, s85, 811008
ds_read_b64_tr_b16 a[162:163], v198 offset:4096
v_mfma_f32_16x16x32_bf16 v[36:39], a[204:207], a[212:215], v[36:39]
buffer_load_dwordx4 v13, s[36:39], s64 offen lds
v_mfma_f32_16x16x32_bf16 v[68:71], a[204:207], a[220:223], 0
s_add_u32 m0, s86, 4096
ds_read_b64_tr_b16 a[164:165], v198 offset:8192
v_mfma_f32_16x16x32_bf16 v[68:71], a[200:203], a[216:219], v[68:71]
s_add_u32 s64, s85, 819200
ds_read_b64_tr_b16 a[166:167], v198 offset:12288
v_mfma_f32_16x16x32_bf16 v[100:103], a[200:203], a[224:227], 0
buffer_load_dwordx4 v12, s[36:39], s64 offen lds
v_mfma_f32_16x16x32_bf16 v[100:103], a[204:207], a[228:231], v[100:103]
v_mfma_f32_16x16x32_bf16 v[132:135], a[204:207], a[236:239], 0
v_mfma_f32_16x16x32_bf16 v[132:135], a[200:203], a[232:235], v[132:135]
s_waitcnt lgkmcnt(3)
v_mfma_f32_16x16x32_bf16 v[136:139], a[144:147], v[176:179], v[136:139]
s_add_u32 m0, s86, 5120
ds_read_b64_tr_b16 a[168:169], v199 offset:0
v_xor_b32 v200, 0x18000, v184
v_mfma_f32_16x16x32_bf16 v[136:139], a[148:151], v[180:183], v[136:139]
s_add_u32 s64, s85, 827392
ds_read_b64_tr_b16 a[170:171], v199 offset:4096
v_xor_b32 v201, 0x18000, v185
v_mfma_f32_16x16x32_bf16 v[104:107], a[148:151], v[172:175], v[104:107]
buffer_load_dwordx4 v13, s[36:39], s64 offen lds
v_mfma_f32_16x16x32_bf16 v[104:107], a[144:147], v[168:171], v[104:107]
s_add_u32 m0, s86, 6144
ds_read_b64_tr_b16 a[172:173], v199 offset:8192
v_xor_b32 v202, 0x18000, v186
v_mfma_f32_16x16x32_bf16 v[72:75], a[144:147], v[160:163], v[72:75]
s_add_u32 s64, s85, 835584
ds_read_b64_tr_b16 a[174:175], v199 offset:12288
v_xor_b32 v203, 0x18000, v187
v_mfma_f32_16x16x32_bf16 v[72:75], a[148:151], v[164:167], v[72:75]
buffer_load_dwordx4 v12, s[36:39], s64 offen lds
v_mfma_f32_16x16x32_bf16 v[40:43], a[148:151], v[156:159], v[40:43]
ds_read_b64_tr_b16 a[176:177], v192 offset:0
v_xor_b32 v204, 0x18000, v188
v_mfma_f32_16x16x32_bf16 v[40:43], a[144:147], v[152:155], v[40:43]
s_add_u32 m0, s86, 7168
ds_read_b64_tr_b16 a[178:179], v192 offset:4096
v_xor_b32 v205, 0x18000, v189
v_mfma_f32_16x16x32_bf16 v[44:47], a[152:155], v[152:155], v[44:47]
s_add_u32 s64, s85, 843776
ds_read_b64_tr_b16 a[180:181], v192 offset:8192
v_xor_b32 v206, 0x18000, v190
v_mfma_f32_16x16x32_bf16 v[44:47], a[156:159], v[156:159], v[44:47]
buffer_load_dwordx4 v13, s[36:39], s64 offen lds
v_mfma_f32_16x16x32_bf16 v[76:79], a[156:159], v[164:167], v[76:79]
ds_read_b64_tr_b16 a[182:183], v192 offset:12288
v_xor_b32 v207, 0x18000, v191
v_mfma_f32_16x16x32_bf16 v[76:79], a[152:155], v[160:163], v[76:79]
s_add_u32 s65, s84, 98304
ds_read_b64_tr_b16 a[184:185], v193 offset:0
v_mfma_f32_16x16x32_bf16 v[108:111], a[152:155], v[168:171], v[108:111]
buffer_load_dwordx4 a[64:67], v14, s[44:47], s65 offen offset:0 sc1
v_mfma_f32_16x16x32_bf16 v[108:111], a[156:159], v[172:175], v[108:111]
ds_read_b64_tr_b16 a[186:187], v193 offset:4096
v_mfma_f32_16x16x32_bf16 v[140:143], a[156:159], v[180:183], v[140:143]
ds_read_b64_tr_b16 a[188:189], v193 offset:8192
v_mfma_f32_16x16x32_bf16 v[140:143], a[152:155], v[176:179], v[140:143]
s_waitcnt lgkmcnt(5)
ds_read_b64_tr_b16 a[190:191], v193 offset:12288
v_mfma_f32_16x16x32_bf16 v[144:147], a[160:163], v[176:179], v[144:147]
buffer_load_dwordx4 a[72:75], v14, s[44:47], s65 offen offset:1024 sc1
v_mfma_f32_16x16x32_bf16 v[144:147], a[164:167], v[180:183], v[144:147]
v_mfma_f32_16x16x32_bf16 v[112:115], a[164:167], v[172:175], v[112:115]
ds_read_b64_tr_b16 a[192:193], v194 offset:0
v_mfma_f32_16x16x32_bf16 v[112:115], a[160:163], v[168:171], v[112:115]
ds_read_b64_tr_b16 a[194:195], v194 offset:4096
v_mfma_f32_16x16x32_bf16 v[80:83], a[160:163], v[160:163], v[80:83]
buffer_load_dwordx4 a[80:83], v15, s[44:47], s65 offen offset:0 sc1
v_mfma_f32_16x16x32_bf16 v[80:83], a[164:167], v[164:167], v[80:83]
ds_read_b64_tr_b16 a[196:197], v194 offset:8192
v_mfma_f32_16x16x32_bf16 v[48:51], a[164:167], v[156:159], v[48:51]
ds_read_b64_tr_b16 a[198:199], v194 offset:12288
v_mfma_f32_16x16x32_bf16 v[48:51], a[160:163], v[152:155], v[48:51]
buffer_load_dwordx4 a[88:91], v15, s[44:47], s65 offen offset:1024 sc1
v_mfma_f32_16x16x32_bf16 v[52:55], a[168:171], v[152:155], v[52:55]
v_mfma_f32_16x16x32_bf16 v[52:55], a[172:175], v[156:159], v[52:55]
v_mfma_f32_16x16x32_bf16 v[84:87], a[172:175], v[164:167], v[84:87]
s_add_u32 s65, s84, 106496
ds_read_b64_tr_b16 a[200:201], v195 offset:0
v_mfma_f32_16x16x32_bf16 v[84:87], a[168:171], v[160:163], v[84:87]
buffer_load_dwordx4 a[68:71], v14, s[44:47], s65 offen offset:0 sc1
v_mfma_f32_16x16x32_bf16 v[116:119], a[168:171], v[168:171], v[116:119]
ds_read_b64_tr_b16 a[202:203], v195 offset:4096
v_mfma_f32_16x16x32_bf16 v[116:119], a[172:175], v[172:175], v[116:119]
ds_read_b64_tr_b16 a[204:205], v195 offset:8192
v_mfma_f32_16x16x32_bf16 v[148:151], a[172:175], v[180:183], v[148:151]
ds_read_b64_tr_b16 a[206:207], v195 offset:12288
v_mfma_f32_16x16x32_bf16 v[148:151], a[168:171], v[176:179], v[148:151]
s_lshl_b32 s66, s30, 30
buffer_load_dwordx4 a[76:79], v14, s[44:47], s65 offen offset:1024 sc1
v_mfma_f32_16x16x32_bf16 v[120:123], a[176:179], v[176:179], v[120:123]
s_waitcnt lgkmcnt(4)
v_lshl_add_u32 v1, v0, 24, s66
v_mfma_f32_16x16x32_bf16 v[120:123], a[180:183], v[180:183], v[120:123]
v_mfma_f32_16x16x32_bf16 v[88:91], a[180:183], v[172:175], v[88:91]
buffer_load_dwordx4 a[84:87], v15, s[44:47], s65 offen offset:0 sc1
v_mfma_f32_16x16x32_bf16 v[88:91], a[176:179], v[168:171], v[88:91]
v_mfma_f32_16x16x32_bf16 v[56:59], a[176:179], v[160:163], v[56:59]
v_mfma_f32_16x16x32_bf16 v[56:59], a[180:183], v[164:167], v[56:59]
v_mfma_f32_16x16x32_bf16 v[24:27], a[180:183], v[156:159], v[24:27]
buffer_load_dwordx4 a[92:95], v15, s[44:47], s65 offen offset:1024 sc1
v_mfma_f32_16x16x32_bf16 v[24:27], a[176:179], v[152:155], v[24:27]
v_mfma_f32_16x16x32_bf16 v[28:31], a[184:187], v[152:155], v[28:31]
v_mfma_f32_16x16x32_bf16 v[28:31], a[188:191], v[156:159], v[28:31]
v_mfma_f32_16x16x32_bf16 v[60:63], a[188:191], v[164:167], v[60:63]
v_mfma_f32_16x16x32_bf16 v[60:63], a[184:187], v[160:163], v[60:63]
s_waitcnt vmcnt(24)
s_barrier
v_mfma_f32_16x16x32_bf16 v[92:95], a[184:187], v[168:171], v[92:95]
s_mov_b64 exec, 1
buffer_atomic_add a251, v1, s[52:55], s71 offen offset:0 sc1
s_mov_b64 exec, -1
v_mfma_f32_16x16x32_bf16 v[92:95], a[188:191], v[172:175], v[92:95]
ds_read_b64_tr_b16 a[144:145], v196 offset:32768
v_mfma_f32_16x16x32_bf16 v[124:127], a[188:191], v[180:183], v[124:127]
s_add_u32 m0, s86, 98304
ds_read_b64_tr_b16 a[146:147], v196 offset:36864
v_mfma_f32_16x16x32_bf16 v[124:127], a[184:187], v[176:179], v[124:127]
s_add_u32 s64, s85, 1048576
ds_read_b64_tr_b16 a[148:149], v196 offset:40960
v_mfma_f32_16x16x32_bf16 v[128:131], a[192:195], v[176:179], v[128:131]
buffer_load_dwordx4 v12, s[36:39], s64 offen lds
v_mfma_f32_16x16x32_bf16 v[128:131], a[196:199], v[180:183], v[128:131]
s_add_u32 m0, s86, 99328
ds_read_b64_tr_b16 a[150:151], v196 offset:45056
v_mfma_f32_16x16x32_bf16 v[96:99], a[196:199], v[172:175], v[96:99]
s_add_u32 s64, s85, 1056768
ds_read_b64_tr_b16 a[152:153], v197 offset:32768
v_mfma_f32_16x16x32_bf16 v[96:99], a[192:195], v[168:171], v[96:99]
buffer_load_dwordx4 v13, s[36:39], s64 offen lds
v_mfma_f32_16x16x32_bf16 v[64:67], a[192:195], v[160:163], v[64:67]
s_add_u32 m0, s86, 100352
ds_read_b64_tr_b16 a[154:155], v197 offset:36864
v_mfma_f32_16x16x32_bf16 v[64:67], a[196:199], v[164:167], v[64:67]
s_add_u32 s64, s85, 1064960
ds_read_b64_tr_b16 a[156:157], v197 offset:40960
v_mfma_f32_16x16x32_bf16 v[32:35], a[196:199], v[156:159], v[32:35]
buffer_load_dwordx4 v12, s[36:39], s64 offen lds
v_mfma_f32_16x16x32_bf16 v[32:35], a[192:195], v[152:155], v[32:35]
s_waitcnt lgkmcnt(4)
s_add_u32 m0, s86, 101376
ds_read_b64_tr_b16 a[158:159], v197 offset:45056
v_mfma_f32_16x16x32_bf16 v[36:39], a[200:203], v[152:155], v[36:39]
s_add_u32 s64, s85, 1073152
ds_read_b64_tr_b16 a[160:161], v198 offset:32768
v_mfma_f32_16x16x32_bf16 v[36:39], a[204:207], v[156:159], v[36:39]
buffer_load_dwordx4 v13, s[36:39], s64 offen lds
v_mfma_f32_16x16x32_bf16 v[68:71], a[204:207], v[164:167], v[68:71]
s_add_u32 m0, s86, 102400
ds_read_b64_tr_b16 a[162:163], v198 offset:36864
v_mfma_f32_16x16x32_bf16 v[68:71], a[200:203], v[160:163], v[68:71]
s_add_u32 s64, s85, 1081344
ds_read_b64_tr_b16 a[164:165], v198 offset:40960
v_mfma_f32_16x16x32_bf16 v[100:103], a[200:203], v[168:171], v[100:103]
buffer_load_dwordx4 v12, s[36:39], s64 offen lds
v_mfma_f32_16x16x32_bf16 v[100:103], a[204:207], v[172:175], v[100:103]
ds_read_b64_tr_b16 a[166:167], v198 offset:45056
v_mfma_f32_16x16x32_bf16 v[132:135], a[204:207], v[180:183], v[132:135]
v_mfma_f32_16x16x32_bf16 v[132:135], a[200:203], v[176:179], v[132:135]
s_waitcnt vmcnt(26)
v_mfma_f32_16x16x32_bf16 v[136:139], a[144:147], a[24:27], v[136:139]
s_waitcnt vmcnt(22)
s_waitcnt lgkmcnt(3)
s_add_u32 m0, s86, 103424
ds_read_b64_tr_b16 a[168:169], v199 offset:32768
v_mfma_f32_16x16x32_bf16 v[136:139], a[148:151], a[28:31], v[136:139]
s_add_u32 s64, s85, 1089536
ds_read_b64_tr_b16 a[170:171], v199 offset:36864
v_mfma_f32_16x16x32_bf16 v[104:107], a[148:151], a[20:23], v[104:107]
buffer_load_dwordx4 v13, s[36:39], s64 offen lds
v_mfma_f32_16x16x32_bf16 v[104:107], a[144:147], a[16:19], v[104:107]
s_add_u32 m0, s86, 104448
ds_read_b64_tr_b16 a[172:173], v199 offset:40960
v_mfma_f32_16x16x32_bf16 v[72:75], a[144:147], a[8:11], v[72:75]
s_add_u32 s64, s85, 1097728
ds_read_b64_tr_b16 a[174:175], v199 offset:45056
v_mfma_f32_16x16x32_bf16 v[72:75], a[148:151], a[12:15], v[72:75]
buffer_load_dwordx4 v12, s[36:39], s64 offen lds
v_mfma_f32_16x16x32_bf16 v[40:43], a[148:151], a[4:7], v[40:43]
ds_read_b64_tr_b16 a[176:177], v192 offset:32768
v_mfma_f32_16x16x32_bf16 v[40:43], a[144:147], a[0:3], v[40:43]
s_add_u32 m0, s86, 105472
ds_read_b64_tr_b16 a[178:179], v192 offset:36864
v_mfma_f32_16x16x32_bf16 v[44:47], a[152:155], a[0:3], v[44:47]
s_add_u32 s64, s85, 1105920
ds_read_b64_tr_b16 a[180:181], v192 offset:40960
v_mfma_f32_16x16x32_bf16 v[44:47], a[156:159], a[4:7], v[44:47]
buffer_load_dwordx4 v13, s[36:39], s64 offen lds
v_mfma_f32_16x16x32_bf16 v[76:79], a[156:159], a[12:15], v[76:79]
ds_read_b64_tr_b16 a[182:183], v192 offset:45056
v_mfma_f32_16x16x32_bf16 v[76:79], a[152:155], a[8:11], v[76:79]
s_add_u32 s65, s84, 131072
ds_read_b64_tr_b16 a[184:185], v193 offset:32768
v_mfma_f32_16x16x32_bf16 v[108:111], a[152:155], a[16:19], v[108:111]
buffer_load_dwordx4 a[32:35], v14, s[44:47], s65 offen offset:0 sc1
v_mfma_f32_16x16x32_bf16 v[108:111], a[156:159], a[20:23], v[108:111]
ds_read_b64_tr_b16 a[186:187], v193 offset:36864
v_mfma_f32_16x16x32_bf16 v[140:143], a[156:159], a[28:31], v[140:143]
ds_read_b64_tr_b16 a[188:189], v193 offset:40960
v_mfma_f32_16x16x32_bf16 v[140:143], a[152:155], a[24:27], v[140:143]
s_waitcnt lgkmcnt(5)
ds_read_b64_tr_b16 a[190:191], v193 offset:45056
v_mfma_f32_16x16x32_bf16 v[144:147], a[160:163], a[24:27], v[144:147]
s_and_b32 s68, s82, 3
buffer_load_dwordx4 a[40:43], v14, s[44:47], s65 offen offset:1024 sc1
v_mfma_f32_16x16x32_bf16 v[144:147], a[164:167], a[28:31], v[144:147]
s_lshl_b32 s68, s68, 11
s_add_u32 s76, s86, s68
s_lshr_b32 s69, s87, 8
v_mfma_f32_16x16x32_bf16 v[112:115], a[164:167], a[20:23], v[112:115]
s_lshr_b32 s67, s82, 1
s_xor_b32 s69, s69, s67
ds_read_b64_tr_b16 a[192:193], v194 offset:32768
v_mfma_f32_16x16x32_bf16 v[112:115], a[160:163], a[16:19], v[112:115]
s_and_b32 s69, s69, 2
s_lshl_b32 s69, s69, 15
ds_read_b64_tr_b16 a[194:195], v194 offset:36864
v_mfma_f32_16x16x32_bf16 v[80:83], a[160:163], a[8:11], v[80:83]
s_add_u32 s68, s68, s69
buffer_load_dwordx4 a[48:51], v15, s[44:47], s65 offen offset:0 sc1
v_mfma_f32_16x16x32_bf16 v[80:83], a[164:167], a[12:15], v[80:83]
ds_read_b64_tr_b16 a[196:197], v194 offset:40960
v_mfma_f32_16x16x32_bf16 v[48:51], a[164:167], a[4:7], v[48:51]
ds_read_b64_tr_b16 a[198:199], v194 offset:45056
v_mfma_f32_16x16x32_bf16 v[48:51], a[160:163], a[0:3], v[48:51]
buffer_load_dwordx4 a[56:59], v15, s[44:47], s65 offen offset:1024 sc1
v_mfma_f32_16x16x32_bf16 v[52:55], a[168:171], a[0:3], v[52:55]
v_mfma_f32_16x16x32_bf16 v[52:55], a[172:175], a[4:7], v[52:55]
v_mfma_f32_16x16x32_bf16 v[84:87], a[172:175], a[12:15], v[84:87]
s_add_u32 s65, s84, 139264
ds_read_b64_tr_b16 a[200:201], v195 offset:32768
v_mfma_f32_16x16x32_bf16 v[84:87], a[168:171], a[8:11], v[84:87]
buffer_load_dwordx4 a[36:39], v14, s[44:47], s65 offen offset:0 sc1
v_mfma_f32_16x16x32_bf16 v[116:119], a[168:171], a[16:19], v[116:119]
ds_read_b64_tr_b16 a[202:203], v195 offset:36864
v_mfma_f32_16x16x32_bf16 v[116:119], a[172:175], a[20:23], v[116:119]
ds_read_b64_tr_b16 a[204:205], v195 offset:40960
v_mfma_f32_16x16x32_bf16 v[148:151], a[172:175], a[28:31], v[148:151]
ds_read_b64_tr_b16 a[206:207], v195 offset:45056
v_mfma_f32_16x16x32_bf16 v[148:151], a[168:171], a[24:27], v[148:151]
buffer_load_dwordx4 a[44:47], v14, s[44:47], s65 offen offset:1024 sc1
v_mfma_f32_16x16x32_bf16 v[120:123], a[176:179], a[24:27], v[120:123]
s_waitcnt lgkmcnt(4)
v_mfma_f32_16x16x32_bf16 v[120:123], a[180:183], a[28:31], v[120:123]
v_mfma_f32_16x16x32_bf16 v[88:91], a[180:183], a[20:23], v[88:91]
buffer_load_dwordx4 a[52:55], v15, s[44:47], s65 offen offset:0 sc1
v_mfma_f32_16x16x32_bf16 v[88:91], a[176:179], a[16:19], v[88:91]
v_mfma_f32_16x16x32_bf16 v[56:59], a[176:179], a[8:11], v[56:59]
v_mfma_f32_16x16x32_bf16 v[56:59], a[180:183], a[12:15], v[56:59]
v_mfma_f32_16x16x32_bf16 v[24:27], a[180:183], a[4:7], v[24:27]
buffer_load_dwordx4 a[60:63], v15, s[44:47], s65 offen offset:1024 sc1
v_mfma_f32_16x16x32_bf16 v[24:27], a[176:179], a[0:3], v[24:27]
v_mfma_f32_16x16x32_bf16 v[28:31], a[184:187], a[0:3], v[28:31]
v_mfma_f32_16x16x32_bf16 v[28:31], a[188:191], a[4:7], v[28:31]
v_mfma_f32_16x16x32_bf16 v[60:63], a[188:191], a[12:15], v[60:63]
s_lshl3_add_u32 s85, s68, s85
v_mfma_f32_16x16x32_bf16 v[60:63], a[184:187], a[8:11], v[60:63]
s_waitcnt vmcnt(25)
s_barrier
v_mfma_f32_16x16x32_bf16 v[92:95], a[184:187], a[16:19], v[92:95]
ds_read_b64_tr_b16 a[144:145], v204 offset:0
v_mfma_f32_16x16x32_bf16 v[92:95], a[188:191], a[20:23], v[92:95]
ds_read_b64_tr_b16 a[146:147], v204 offset:4096
v_mfma_f32_16x16x32_bf16 v[124:127], a[188:191], a[28:31], v[124:127]
s_xor_b32 m0, s76, 131072
ds_read_b64_tr_b16 a[148:149], v204 offset:8192
v_mfma_f32_16x16x32_bf16 v[124:127], a[184:187], a[24:27], v[124:127]
s_xor_b32 s64, s85, 0
ds_read_b64_tr_b16 a[150:151], v204 offset:12288
v_mfma_f32_16x16x32_bf16 v[128:131], a[192:195], a[24:27], v[128:131]
buffer_load_dwordx4 v12, s[40:43], s64 offen lds
v_mfma_f32_16x16x32_bf16 v[128:131], a[196:199], a[28:31], v[128:131]
s_xor_b32 m0, s76, 132096
ds_read_b64_tr_b16 a[152:153], v205 offset:0
v_mfma_f32_16x16x32_bf16 v[96:99], a[196:199], a[20:23], v[96:99]
s_xor_b32 s64, s85, 8192
ds_read_b64_tr_b16 a[154:155], v205 offset:4096
v_mfma_f32_16x16x32_bf16 v[96:99], a[192:195], a[16:19], v[96:99]
buffer_load_dwordx4 v13, s[40:43], s64 offen lds
v_mfma_f32_16x16x32_bf16 v[64:67], a[192:195], a[8:11], v[64:67]
s_xor_b32 m0, s76, 133120
ds_read_b64_tr_b16 a[156:157], v205 offset:8192
v_mfma_f32_16x16x32_bf16 v[64:67], a[196:199], a[12:15], v[64:67]
s_xor_b32 s64, s85, 16384
ds_read_b64_tr_b16 a[158:159], v205 offset:12288
v_mfma_f32_16x16x32_bf16 v[32:35], a[196:199], a[4:7], v[32:35]
buffer_load_dwordx4 v12, s[40:43], s64 offen lds
v_mfma_f32_16x16x32_bf16 v[32:35], a[192:195], a[0:3], v[32:35]
s_waitcnt lgkmcnt(4)
s_xor_b32 m0, s76, 134144
ds_read_b64_tr_b16 a[160:161], v206 offset:0
v_mfma_f32_16x16x32_bf16 v[36:39], a[200:203], a[0:3], v[36:39]
s_xor_b32 s64, s85, 24576
ds_read_b64_tr_b16 a[162:163], v206 offset:4096
v_mfma_f32_16x16x32_bf16 v[36:39], a[204:207], a[4:7], v[36:39]
buffer_load_dwordx4 v13, s[40:43], s64 offen lds
v_mfma_f32_16x16x32_bf16 v[68:71], a[204:207], a[12:15], v[68:71]
s_xor_b32 m0, s76, 135168
ds_read_b64_tr_b16 a[164:165], v206 offset:8192
v_mfma_f32_16x16x32_bf16 v[68:71], a[200:203], a[8:11], v[68:71]
s_xor_b32 s64, s85, 32768
ds_read_b64_tr_b16 a[166:167], v206 offset:12288
v_mfma_f32_16x16x32_bf16 v[100:103], a[200:203], a[16:19], v[100:103]
buffer_load_dwordx4 v12, s[40:43], s64 offen lds
v_mfma_f32_16x16x32_bf16 v[100:103], a[204:207], a[20:23], v[100:103]
v_mfma_f32_16x16x32_bf16 v[132:135], a[204:207], a[28:31], v[132:135]
v_mfma_f32_16x16x32_bf16 v[132:135], a[200:203], a[24:27], v[132:135]
s_waitcnt vmcnt(26)
v_mfma_f32_16x16x32_bf16 v[136:139], a[144:147], a[88:91], v[136:139]
s_waitcnt vmcnt(22)
s_xor_b32 m0, s76, 136192
ds_read_b64_tr_b16 a[168:169], v207 offset:0
v_mfma_f32_16x16x32_bf16 v[136:139], a[148:151], a[92:95], v[136:139]
s_xor_b32 s64, s85, 40960
ds_read_b64_tr_b16 a[170:171], v207 offset:4096
v_mfma_f32_16x16x32_bf16 v[104:107], a[148:151], a[84:87], v[104:107]
buffer_load_dwordx4 v13, s[40:43], s64 offen lds
v_mfma_f32_16x16x32_bf16 v[104:107], a[144:147], a[80:83], v[104:107]
ds_read_b64_tr_b16 a[172:173], v207 offset:8192
v_mfma_f32_16x16x32_bf16 v[72:75], a[144:147], a[72:75], v[72:75]
ds_read_b64_tr_b16 a[174:175], v207 offset:12288
v_mfma_f32_16x16x32_bf16 v[72:75], a[148:151], a[76:79], v[72:75]
ds_read_b64_tr_b16 a[176:177], v200 offset:0
v_mfma_f32_16x16x32_bf16 v[40:43], a[148:151], a[68:71], v[40:43]
ds_read_b64_tr_b16 a[178:179], v200 offset:4096
v_mfma_f32_16x16x32_bf16 v[40:43], a[144:147], a[64:67], v[40:43]
s_waitcnt lgkmcnt(6)
ds_read_b64_tr_b16 a[180:181], v200 offset:8192
v_mfma_f32_16x16x32_bf16 v[44:47], a[152:155], a[64:67], v[44:47]
s_xor_b32 m0, s76, 137216
ds_read_b64_tr_b16 a[182:183], v200 offset:12288
v_mfma_f32_16x16x32_bf16 v[44:47], a[156:159], a[68:71], v[44:47]
s_xor_b32 s64, s85, 49152
v_mfma_f32_16x16x32_bf16 v[76:79], a[156:159], a[76:79], v[76:79]
buffer_load_dwordx4 v12, s[40:43], s64 offen lds
v_mfma_f32_16x16x32_bf16 v[76:79], a[152:155], a[72:75], v[76:79]
ds_read_b64_tr_b16 a[184:185], v201 offset:0
v_mfma_f32_16x16x32_bf16 v[108:111], a[152:155], a[80:83], v[108:111]
ds_read_b64_tr_b16 a[186:187], v201 offset:4096
v_mfma_f32_16x16x32_bf16 v[108:111], a[156:159], a[84:87], v[108:111]
ds_read_b64_tr_b16 a[188:189], v201 offset:8192
v_mfma_f32_16x16x32_bf16 v[140:143], a[156:159], a[92:95], v[140:143]
ds_read_b64_tr_b16 a[190:191], v201 offset:12288
v_mfma_f32_16x16x32_bf16 v[140:143], a[152:155], a[88:91], v[140:143]
v_mfma_f32_16x16x32_bf16 v[144:147], a[160:163], a[88:91], v[144:147]
v_mfma_f32_16x16x32_bf16 v[144:147], a[164:167], a[92:95], v[144:147]
s_xor_b32 m0, s76, 138240
v_mfma_f32_16x16x32_bf16 v[112:115], a[164:167], a[84:87], v[112:115]
s_xor_b32 s64, s85, 57344
ds_read_b64_tr_b16 a[192:193], v202 offset:0
v_mfma_f32_16x16x32_bf16 v[112:115], a[160:163], a[80:83], v[112:115]
buffer_load_dwordx4 v13, s[40:43], s64 offen lds
v_mfma_f32_16x16x32_bf16 v[80:83], a[160:163], a[72:75], v[80:83]
ds_read_b64_tr_b16 a[194:195], v202 offset:4096
v_mfma_f32_16x16x32_bf16 v[80:83], a[164:167], a[76:79], v[80:83]
ds_read_b64_tr_b16 a[196:197], v202 offset:8192
v_mfma_f32_16x16x32_bf16 v[48:51], a[164:167], a[68:71], v[48:51]
ds_read_b64_tr_b16 a[198:199], v202 offset:12288
v_mfma_f32_16x16x32_bf16 v[48:51], a[160:163], a[64:67], v[48:51]
s_waitcnt lgkmcnt(4)
v_mfma_f32_16x16x32_bf16 v[52:55], a[168:171], a[64:67], v[52:55]
v_mfma_f32_16x16x32_bf16 v[52:55], a[172:175], a[68:71], v[52:55]
v_mfma_f32_16x16x32_bf16 v[84:87], a[172:175], a[76:79], v[84:87]
ds_read_b64_tr_b16 a[200:201], v203 offset:0
v_mfma_f32_16x16x32_bf16 v[84:87], a[168:171], a[72:75], v[84:87]
ds_read_b64_tr_b16 a[202:203], v203 offset:4096
v_mfma_f32_16x16x32_bf16 v[116:119], a[168:171], a[80:83], v[116:119]
ds_read_b64_tr_b16 a[204:205], v203 offset:8192
v_mfma_f32_16x16x32_bf16 v[116:119], a[172:175], a[84:87], v[116:119]
ds_read_b64_tr_b16 a[206:207], v203 offset:12288
v_mfma_f32_16x16x32_bf16 v[148:151], a[172:175], a[92:95], v[148:151]
buffer_load_dword v19, off, s[52:55], s72 sc1
v_mfma_f32_16x16x32_bf16 v[148:151], a[168:171], a[88:91], v[148:151]
v_mfma_f32_16x16x32_bf16 v[120:123], a[176:179], a[88:91], v[120:123]
v_mfma_f32_16x16x32_bf16 v[120:123], a[180:183], a[92:95], v[120:123]
v_mfma_f32_16x16x32_bf16 v[88:91], a[180:183], a[84:87], v[88:91]
v_mfma_f32_16x16x32_bf16 v[88:91], a[176:179], a[80:83], v[88:91]
s_branch L_po25
L_pg25:
s_branch L_tr2
L_po25:
v_mfma_f32_16x16x32_bf16 v[56:59], a[176:179], a[72:75], v[56:59]
v_mfma_f32_16x16x32_bf16 v[56:59], a[180:183], a[76:79], v[56:59]
v_mfma_f32_16x16x32_bf16 v[24:27], a[180:183], a[68:71], v[24:27]
v_mfma_f32_16x16x32_bf16 v[24:27], a[176:179], a[64:67], v[24:27]
v_mfma_f32_16x16x32_bf16 v[28:31], a[184:187], a[64:67], v[28:31]
v_mfma_f32_16x16x32_bf16 v[28:31], a[188:191], a[68:71], v[28:31]
v_mfma_f32_16x16x32_bf16 v[60:63], a[188:191], a[76:79], v[60:63]
v_mfma_f32_16x16x32_bf16 v[60:63], a[184:187], a[72:75], v[60:63]
s_waitcnt vmcnt(17)
s_barrier
v_mfma_f32_16x16x32_bf16 v[92:95], a[184:187], a[80:83], v[92:95]
ds_read_b64_tr_b16 a[144:145], v188 offset:0
v_mfma_f32_16x16x32_bf16 v[92:95], a[188:191], a[84:87], v[92:95]
ds_read_b64_tr_b16 a[146:147], v188 offset:4096
v_mfma_f32_16x16x32_bf16 v[124:127], a[188:191], a[92:95], v[124:127]
s_xor_b32 m0, s76, 32768
ds_read_b64_tr_b16 a[148:149], v188 offset:8192
v_mfma_f32_16x16x32_bf16 v[124:127], a[184:187], a[88:91], v[124:127]
s_waitcnt lgkmcnt(3)
s_xor_b32 s64, s85, 262144
ds_read_b64_tr_b16 a[150:151], v188 offset:12288
v_mfma_f32_16x16x32_bf16 v[128:131], a[192:195], a[88:91], v[128:131]
buffer_load_dwordx4 v12, s[40:43], s64 offen lds
v_mfma_f32_16x16x32_bf16 v[128:131], a[196:199], a[92:95], v[128:131]
s_xor_b32 m0, s76, 33792
s_xor_b32 s64, s85, 270336
ds_read_b64_tr_b16 a[152:153], v189 offset:0
v_mfma_f32_16x16x32_bf16 v[96:99], a[196:199], a[84:87], v[96:99]
buffer_load_dwordx4 v13, s[40:43], s64 offen lds
v_mfma_f32_16x16x32_bf16 v[96:99], a[192:195], a[80:83], v[96:99]
s_xor_b32 m0, s76, 34816
ds_read_b64_tr_b16 a[154:155], v189 offset:4096
v_mfma_f32_16x16x32_bf16 v[64:67], a[192:195], a[72:75], v[64:67]
s_xor_b32 s64, s85, 278528
ds_read_b64_tr_b16 a[156:157], v189 offset:8192
v_mfma_f32_16x16x32_bf16 v[64:67], a[196:199], a[76:79], v[64:67]
buffer_load_dwordx4 v12, s[40:43], s64 offen lds
v_mfma_f32_16x16x32_bf16 v[32:35], a[196:199], a[68:71], v[32:35]
s_xor_b32 m0, s76, 35840
ds_read_b64_tr_b16 a[158:159], v189 offset:12288
v_mfma_f32_16x16x32_bf16 v[32:35], a[192:195], a[64:67], v[32:35]
s_xor_b32 s64, s85, 286720
ds_read_b64_tr_b16 a[160:161], v190 offset:0
v_mfma_f32_16x16x32_bf16 v[36:39], a[200:203], a[64:67], v[36:39]
buffer_load_dwordx4 v13, s[40:43], s64 offen lds
v_mfma_f32_16x16x32_bf16 v[36:39], a[204:207], a[68:71], v[36:39]
s_xor_b32 m0, s76, 36864
s_xor_b32 s64, s85, 294912
ds_read_b64_tr_b16 a[162:163], v190 offset:4096
v_mfma_f32_16x16x32_bf16 v[68:71], a[204:207], a[76:79], v[68:71]
buffer_load_dwordx4 v12, s[40:43], s64 offen lds
v_mfma_f32_16x16x32_bf16 v[68:71], a[200:203], a[72:75], v[68:71]
s_xor_b32 m0, s76, 37888
ds_read_b64_tr_b16 a[164:165], v190 offset:8192
v_mfma_f32_16x16x32_bf16 v[100:103], a[200:203], a[80:83], v[100:103]
s_xor_b32 s64, s85, 303104
ds_read_b64_tr_b16 a[166:167], v190 offset:12288
v_mfma_f32_16x16x32_bf16 v[100:103], a[204:207], a[84:87], v[100:103]
buffer_load_dwordx4 v13, s[40:43], s64 offen lds
v_mfma_f32_16x16x32_bf16 v[132:135], a[204:207], a[92:95], v[132:135]
v_mfma_f32_16x16x32_bf16 v[132:135], a[200:203], a[88:91], v[132:135]
s_waitcnt vmcnt(19)
s_waitcnt lgkmcnt(3)
v_mfma_f32_16x16x32_bf16 v[136:139], a[144:147], a[56:59], v[136:139]
s_waitcnt vmcnt(6)
v_readfirstlane_b32 vcc_lo, v19
s_nop 0
s_cmp_lt_u32 vcc_lo, 8
s_cbranch_scc1 L_spin_3019
L_spinbk_3020:
s_sub_u32 s84, s84, 1048576
s_add_u32 s84, s84, s69
v_mfma_f32_16x16x32_bf16 v[136:139], a[148:151], a[60:63], v[136:139]
s_xor_b32 s65, s84, 0
ds_read_b64_tr_b16 a[168:169], v191 offset:0
v_mfma_f32_16x16x32_bf16 v[104:107], a[148:151], a[52:55], v[104:107]
buffer_load_dwordx4 a[208:211], v14, s[44:47], s65 offen offset:0 sc1
v_mfma_f32_16x16x32_bf16 v[104:107], a[144:147], a[48:51], v[104:107]
ds_read_b64_tr_b16 a[170:171], v191 offset:4096
v_mfma_f32_16x16x32_bf16 v[72:75], a[144:147], a[40:43], v[72:75]
buffer_load_dwordx4 a[216:219], v14, s[44:47], s65 offen offset:1024 sc1
v_mfma_f32_16x16x32_bf16 v[72:75], a[148:151], a[44:47], v[72:75]
ds_read_b64_tr_b16 a[172:173], v191 offset:8192
v_mfma_f32_16x16x32_bf16 v[40:43], a[148:151], a[36:39], v[40:43]
buffer_load_dwordx4 a[224:227], v15, s[44:47], s65 offen offset:0 sc1
v_mfma_f32_16x16x32_bf16 v[40:43], a[144:147], a[32:35], v[40:43]
ds_read_b64_tr_b16 a[174:175], v191 offset:12288
v_mfma_f32_16x16x32_bf16 v[44:47], a[152:155], a[32:35], v[44:47]
buffer_load_dwordx4 a[232:235], v15, s[44:47], s65 offen offset:1024 sc1
v_mfma_f32_16x16x32_bf16 v[44:47], a[156:159], a[36:39], v[44:47]
s_xor_b32 s65, s84, 8192
ds_read_b64_tr_b16 a[176:177], v184 offset:0
v_mfma_f32_16x16x32_bf16 v[76:79], a[156:159], a[44:47], v[76:79]
buffer_load_dwordx4 a[212:215], v14, s[44:47], s65 offen offset:0 sc1
v_mfma_f32_16x16x32_bf16 v[76:79], a[152:155], a[40:43], v[76:79]
ds_read_b64_tr_b16 a[178:179], v184 offset:4096
v_mfma_f32_16x16x32_bf16 v[108:111], a[152:155], a[48:51], v[108:111]
ds_read_b64_tr_b16 a[180:181], v184 offset:8192
v_mfma_f32_16x16x32_bf16 v[108:111], a[156:159], a[52:55], v[108:111]
buffer_load_dwordx4 a[220:223], v14, s[44:47], s65 offen offset:1024 sc1
v_mfma_f32_16x16x32_bf16 v[140:143], a[156:159], a[60:63], v[140:143]
ds_read_b64_tr_b16 a[182:183], v184 offset:12288
v_mfma_f32_16x16x32_bf16 v[140:143], a[152:155], a[56:59], v[140:143]
s_waitcnt lgkmcnt(4)
buffer_load_dwordx4 a[228:231], v15, s[44:47], s65 offen offset:0 sc1
v_mfma_f32_16x16x32_bf16 v[144:147], a[160:163], a[56:59], v[144:147]
ds_read_b64_tr_b16 a[184:185], v185 offset:0
v_mfma_f32_16x16x32_bf16 v[144:147], a[164:167], a[60:63], v[144:147]
buffer_load_dwordx4 a[236:239], v15, s[44:47], s65 offen offset:1024 sc1
v_mfma_f32_16x16x32_bf16 v[112:115], a[164:167], a[52:55], v[112:115]
s_xor_b32 m0, s76, 38912
s_xor_b32 s64, s85, 311296
ds_read_b64_tr_b16 a[186:187], v185 offset:4096
v_mfma_f32_16x16x32_bf16 v[112:115], a[160:163], a[48:51], v[112:115]
buffer_load_dwordx4 v12, s[40:43], s64 offen lds
v_mfma_f32_16x16x32_bf16 v[80:83], a[160:163], a[40:43], v[80:83]
s_xor_b32 m0, s76, 39936
ds_read_b64_tr_b16 a[188:189], v185 offset:8192
v_mfma_f32_16x16x32_bf16 v[80:83], a[164:167], a[44:47], v[80:83]
s_xor_b32 s64, s85, 319488
ds_read_b64_tr_b16 a[190:191], v185 offset:12288
v_mfma_f32_16x16x32_bf16 v[48:51], a[164:167], a[36:39], v[48:51]
buffer_load_dwordx4 v13, s[40:43], s64 offen lds
v_mfma_f32_16x16x32_bf16 v[48:51], a[160:163], a[32:35], v[48:51]
s_xor_b32 s65, s84, 32768
ds_read_b64_tr_b16 a[192:193], v186 offset:0
v_mfma_f32_16x16x32_bf16 v[52:55], a[168:171], a[32:35], v[52:55]
buffer_load_dwordx4 v[152:155], v14, s[44:47], s65 offen offset:0 sc1
v_mfma_f32_16x16x32_bf16 v[52:55], a[172:175], a[36:39], v[52:55]
ds_read_b64_tr_b16 a[194:195], v186 offset:4096
v_mfma_f32_16x16x32_bf16 v[84:87], a[172:175], a[44:47], v[84:87]
buffer_load_dwordx4 v[160:163], v14, s[44:47], s65 offen offset:1024 sc1
v_mfma_f32_16x16x32_bf16 v[84:87], a[168:171], a[40:43], v[84:87]
ds_read_b64_tr_b16 a[196:197], v186 offset:8192
v_mfma_f32_16x16x32_bf16 v[116:119], a[168:171], a[48:51], v[116:119]
buffer_load_dwordx4 v[168:171], v15, s[44:47], s65 offen offset:0 sc1
v_mfma_f32_16x16x32_bf16 v[116:119], a[172:175], a[52:55], v[116:119]
ds_read_b64_tr_b16 a[198:199], v186 offset:12288
v_mfma_f32_16x16x32_bf16 v[148:151], a[172:175], a[60:63], v[148:151]
buffer_load_dwordx4 v[176:179], v15, s[44:47], s65 offen offset:1024 sc1
v_mfma_f32_16x16x32_bf16 v[148:151], a[168:171], a[56:59], v[148:151]
s_waitcnt lgkmcnt(3)
ds_read_b64_tr_b16 a[200:201], v187 offset:0
v_mfma_f32_16x16x32_bf16 v[120:123], a[176:179], a[56:59], v[120:123]
s_xor_b32 s65, s84, 40960
ds_read_b64_tr_b16 a[202:203], v187 offset:4096
v_mfma_f32_16x16x32_bf16 v[120:123], a[180:183], a[60:63], v[120:123]
buffer_load_dwordx4 v[156:159], v14, s[44:47], s65 offen offset:0 sc1
v_mfma_f32_16x16x32_bf16 v[88:91], a[180:183], a[52:55], v[88:91]
ds_read_b64_tr_b16 a[204:205], v187 offset:8192
v_mfma_f32_16x16x32_bf16 v[88:91], a[176:179], a[48:51], v[88:91]
buffer_load_dwordx4 v[164:167], v14, s[44:47], s65 offen offset:1024 sc1
v_mfma_f32_16x16x32_bf16 v[56:59], a[176:179], a[40:43], v[56:59]
ds_read_b64_tr_b16 a[206:207], v187 offset:12288
v_mfma_f32_16x16x32_bf16 v[56:59], a[180:183], a[44:47], v[56:59]
buffer_load_dwordx4 v[172:175], v15, s[44:47], s65 offen offset:0 sc1
v_mfma_f32_16x16x32_bf16 v[24:27], a[180:183], a[36:39], v[24:27]
v_mfma_f32_16x16x32_bf16 v[24:27], a[176:179], a[32:35], v[24:27]
buffer_load_dwordx4 v[180:183], v15, s[44:47], s65 offen offset:1024 sc1
v_mfma_f32_16x16x32_bf16 v[28:31], a[184:187], a[32:35], v[28:31]
v_mfma_f32_16x16x32_bf16 v[28:31], a[188:191], a[36:39], v[28:31]
v_mfma_f32_16x16x32_bf16 v[60:63], a[188:191], a[44:47], v[60:63]
v_mfma_f32_16x16x32_bf16 v[60:63], a[184:187], a[40:43], v[60:63]
s_barrier
v_mfma_f32_16x16x32_bf16 v[92:95], a[184:187], a[48:51], v[92:95]
ds_read_b64_tr_b16 a[144:145], v188 offset:32768
v_mfma_f32_16x16x32_bf16 v[92:95], a[188:191], a[52:55], v[92:95]
ds_read_b64_tr_b16 a[146:147], v188 offset:36864
v_mfma_f32_16x16x32_bf16 v[124:127], a[188:191], a[60:63], v[124:127]
s_xor_b32 m0, s76, 65536
ds_read_b64_tr_b16 a[148:149], v188 offset:40960
v_mfma_f32_16x16x32_bf16 v[124:127], a[184:187], a[56:59], v[124:127]
s_waitcnt lgkmcnt(3)
s_xor_b32 s64, s85, 524288
ds_read_b64_tr_b16 a[150:151], v188 offset:45056
v_mfma_f32_16x16x32_bf16 v[128:131], a[192:195], a[56:59], v[128:131]
buffer_load_dwordx4 v12, s[40:43], s64 offen lds
v_mfma_f32_16x16x32_bf16 v[128:131], a[196:199], a[60:63], v[128:131]
s_xor_b32 m0, s76, 66560
ds_read_b64_tr_b16 a[152:153], v189 offset:32768
v_mfma_f32_16x16x32_bf16 v[96:99], a[196:199], a[52:55], v[96:99]
s_xor_b32 s64, s85, 532480
ds_read_b64_tr_b16 a[154:155], v189 offset:36864
v_mfma_f32_16x16x32_bf16 v[96:99], a[192:195], a[48:51], v[96:99]
buffer_load_dwordx4 v13, s[40:43], s64 offen lds
v_mfma_f32_16x16x32_bf16 v[64:67], a[192:195], a[40:43], v[64:67]
s_xor_b32 m0, s76, 67584
ds_read_b64_tr_b16 a[156:157], v189 offset:40960
v_mfma_f32_16x16x32_bf16 v[64:67], a[196:199], a[44:47], v[64:67]
s_xor_b32 s64, s85, 540672
ds_read_b64_tr_b16 a[158:159], v189 offset:45056
v_mfma_f32_16x16x32_bf16 v[32:35], a[196:199], a[36:39], v[32:35]
buffer_load_dwordx4 v12, s[40:43], s64 offen lds
v_mfma_f32_16x16x32_bf16 v[32:35], a[192:195], a[32:35], v[32:35]
s_xor_b32 m0, s76, 68608
ds_read_b64_tr_b16 a[160:161], v190 offset:32768
v_mfma_f32_16x16x32_bf16 v[36:39], a[200:203], a[32:35], v[36:39]
s_xor_b32 s64, s85, 548864
ds_read_b64_tr_b16 a[162:163], v190 offset:36864
v_mfma_f32_16x16x32_bf16 v[36:39], a[204:207], a[36:39], v[36:39]
buffer_load_dwordx4 v13, s[40:43], s64 offen lds
v_mfma_f32_16x16x32_bf16 v[68:71], a[204:207], a[44:47], v[68:71]
s_xor_b32 m0, s76, 69632
ds_read_b64_tr_b16 a[164:165], v190 offset:40960
v_mfma_f32_16x16x32_bf16 v[68:71], a[200:203], a[40:43], v[68:71]
s_xor_b32 s64, s85, 557056
ds_read_b64_tr_b16 a[166:167], v190 offset:45056
v_mfma_f32_16x16x32_bf16 v[100:103], a[200:203], a[48:51], v[100:103]
buffer_load_dwordx4 v12, s[40:43], s64 offen lds
v_mfma_f32_16x16x32_bf16 v[100:103], a[204:207], a[52:55], v[100:103]
s_mov_b32 s70, 3
s_mov_b32 s73, 2
v_mfma_f32_16x16x32_bf16 v[132:135], a[204:207], a[60:63], v[132:135]
v_mfma_f32_16x16x32_bf16 v[132:135], a[200:203], a[56:59], v[132:135]
s_branch L_p5join
L_spin_4022:
s_mov_b32 vcc_hi, 0x80000
L_spinlp_4024:
s_sleep 1
buffer_load_dword v19, off, s[52:55], s72 offset:128 sc1
s_waitcnt vmcnt(0)
v_readfirstlane_b32 vcc_lo, v19
s_sub_u32 vcc_hi, vcc_hi, 1
s_cbranch_scc1 L_spinbk_4023
s_cmp_lt_u32 vcc_lo, s74
s_cbranch_scc1 L_spinlp_4024
s_branch L_spinbk_4023
L_codeend:
.section .rodata,"a"
.p2align 6
.amdhsa_kernel gated_mix__compressed_kv_cla__sliding_local_dilated__prompt_kernel
  .amdhsa_next_free_vgpr 512
  .amdhsa_next_free_sgpr 102
  .amdhsa_accum_offset 256
  .amdhsa_group_segment_fixed_size 0
  .amdhsa_kernarg_size 104
  .amdhsa_user_sgpr_count 2
  .amdhsa_user_sgpr_kernarg_segment_ptr 1
  .amdhsa_system_sgpr_workgroup_id_x 1
.end_amdhsa_kernel
```

```asm
; @launch grid=(256,1,1) block=(256,1,1) lds=163840
.amdgcn_target "amdgcn-amd-amdhsa--gfx950"
.text
.globl gated_mix__compressed_kv_cla__sliding_local_dilated__prompt_kernel
.p2align 8
.type gated_mix__compressed_kv_cla__sliding_local_dilated__prompt_kernel,@function
gated_mix__compressed_kv_cla__sliding_local_dilated__prompt_kernel:
s_cmp_ge_u32 s2, 256
s_cbranch_scc1 L_end
s_load_dwordx16 s[4:19], s[0:1], 0
s_load_dwordx8 s[20:27], s[0:1], 64
s_load_dwordx2 s[28:29], s[0:1], 96
s_getpc_b64 s[88:89]
L_pc:
v_lshrrev_b32 v1, 6, v0
s_lshr_b32 s67, s2, 3
v_lshl_add_u32 v24, s67, 2, v1
s_mov_b32 s90, L_codeend-L_pc
s_mov_b32 s91, 0x20000
v_and_b32 v25, 7, v0
v_lshlrev_b32 v25, 7, v25
v_lshl_add_u32 v24, v24, 10, v25
buffer_load_dword a252, v24, s[88:91], 0 offen
v_and_b32 v0, 63, v0
v_readfirstlane_b32 s30, v1
v_lshrrev_b32 v24, 3, v0
v_lshrrev_b32 v25, 4, v0
v_and_b32 v26, 7, v0
v_xor_b32 v26, v26, v25
v_lshlrev_b32 v26, 4, v26
v_lshl_add_u32 v12, v24, 10, v26
v_xor_b32 v13, 64, v12
v_bfe_u32 v26, v0, 1, 3
v_xor_b32 v26, v26, v25
v_lshlrev_b32 v26, 5, v26
v_and_b32 v24, 1, v0
v_lshl_add_u32 v26, v24, 4, v26
v_lshl_add_u32 v14, v25, 13, v26
v_xor_b32 v15, 128, v14
s_and_b32 s66, s2, 7
s_and_b32 s68, s67, 3
s_lshl2_add_u32 s31, s66, s68
s_cmp_eq_u32 s68, 0
s_cselect_b32 s90, s90, 0
s_lshr_b32 s3, s67, 2
s_lshl2_add_u32 s80, s67, s30
s_lshl_b32 s70, s3, 18
s_lshl_b32 s66, s30, 16
s_add_u32 s70, s70, s66
s_lshl_b32 s71, s30, 17
s_lshl_b32 s66, s31, 8
s_add_u32 s71, s71, s66
s_lshl_b32 s76, s30, 13
s_lshl_b32 s77, s30, 12
s_lshl_b32 s78, s30, 10
s_cmp_eq_u32 s30, 0
s_cbranch_scc1 L_pg1
s_cmp_eq_u32 s30, 1
s_cbranch_scc1 L_tr9
s_cmp_eq_u32 s30, 2
s_cbranch_scc1 L_tr9
s_branch L_tr9
L_tr9:
s_waitcnt lgkmcnt(0)
s_mov_b32 s32, s6
s_mov_b32 s33, s7
s_mov_b32 s34, 2097152
s_mov_b32 s35, 0x20000
s_mov_b32 s36, s10
s_mov_b32 s37, s11
s_mov_b32 s38, 4194304
s_mov_b32 s39, 0x20000
s_mov_b32 s40, s12
s_mov_b32 s41, s13
s_mov_b32 s42, 4194304
s_mov_b32 s43, 0x20000
s_xor_b32 m0, s76, 0
s_xor_b32 s64, s70, 0
buffer_load_dwordx4 v12, s[32:35], s64 offen lds
s_xor_b32 m0, s76, 1024
s_xor_b32 s64, s70, 8192
buffer_load_dwordx4 v13, s[32:35], s64 offen lds
s_xor_b32 m0, s76, 2048
s_xor_b32 s64, s70, 16384
buffer_load_dwordx4 v12, s[32:35], s64 offen lds
s_xor_b32 m0, s76, 3072
s_xor_b32 s64, s70, 24576
buffer_load_dwordx4 v13, s[32:35], s64 offen lds
s_xor_b32 m0, s77, 65536
s_xor_b32 s64, s71, 0
buffer_load_dwordx4 v14, s[36:39], s64 offen lds
s_xor_b32 m0, s77, 66560
s_xor_b32 s64, s71, 32768
buffer_load_dwordx4 v14, s[36:39], s64 offen lds
s_xor_b32 m0, s77, 67584
s_xor_b32 s64, s71, 65536
buffer_load_dwordx4 v15, s[36:39], s64 offen lds
s_xor_b32 m0, s77, 68608
s_xor_b32 s64, s71, 98304
buffer_load_dwordx4 v15, s[36:39], s64 offen lds
s_mov_b32 s44, s28
s_mov_b32 s45, s29
s_mov_b32 s46, 134217728
s_mov_b32 s47, 0x20000
s_mov_b32 s48, s4
s_mov_b32 s49, s5
s_mov_b32 s50, 4194304
s_mov_b32 s51, 0x20000
s_mov_b32 s52, s26
s_mov_b32 s53, s27
s_mov_b32 s54, 256
s_mov_b32 s55, 0x20000
s_mov_b32 s56, s8
s_mov_b32 s57, s9
s_mov_b32 s58, 8388608
s_mov_b32 s59, 0x20000
s_mov_b32 s60, s18
s_mov_b32 s61, s19
s_mov_b32 s62, 6291456
s_mov_b32 s63, 0x20000
v_accvgpr_write_b32 a251, 1
v_and_b32 v24, 15, v0
v_lshrrev_b32 v26, 1, v24
v_xor_b32 v26, v26, v25
v_lshlrev_b32 v26, 4, v26
v_lshl_add_u32 v26, v24, 7, v26
v_add_u32 v2, s76, v26
v_xor_b32 v3, 64, v2
v_bfe_u32 v24, v0, 2, 2
v_lshl_add_u32 v27, v25, 3, v24
v_and_b32 v1, 3, v0
v_cmp_eq_u32 vcc, 0, v1
v_lshlrev_b32 v1, 3, v1
v_lshl_add_u32 v26, v27, 8, v1
v_add_u32 v26, 65536, v26
v_and_b32 v1, 1, v25
v_lshl_add_u32 v24, v1, 2, v24
v_lshlrev_b32 v16, 4, v0
v_mov_b32 v28, 0x3f803f80
v_cndmask_b32 v28, 0, v28, vcc
v_accvgpr_write_b32 a244, v28
v_accvgpr_write_b32 a245, v28
v_accvgpr_write_b32 a246, v28
v_accvgpr_write_b32 a247, v28
v_xor_b32 v1, 0, v24
v_lshl_add_u32 v4, v1, 5, v26
v_xor_b32 v1, 1, v24
v_lshl_add_u32 v5, v1, 5, v26
v_xor_b32 v1, 2, v24
v_lshl_add_u32 v6, v1, 5, v26
v_xor_b32 v1, 3, v24
v_lshl_add_u32 v7, v1, 5, v26
v_xor_b32 v1, 4, v24
v_lshl_add_u32 v8, v1, 5, v26
v_xor_b32 v1, 5, v24
v_lshl_add_u32 v9, v1, 5, v26
v_xor_b32 v1, 6, v24
v_lshl_add_u32 v10, v1, 5, v26
v_xor_b32 v1, 7, v24
v_lshl_add_u32 v11, v1, 5, v26
s_sub_u32 s16, 15, s3
s_lshl_b32 s72, s3, 18
s_lshl_b32 s73, s16, 18
s_cmp_lt_u32 s30, 2
s_cselect_b32 s67, s3, s16
s_lshl4_add_u32 s74, s31, s67
s_and_b32 s66, s30, 1
s_lshl1_add_u32 s74, s74, s66
s_lshl_b32 s74, s74, 10
s_add_u32 s74, s74, 60817408
s_lshl_b32 s66, s30, 15
s_add_u32 s72, s72, s66
s_add_u32 s73, s73, s66
s_mul_i32 s75, s30, 98304
s_lshl_b32 s66, s31, 6
s_add_u32 s75, s75, s66
s_lshl_b32 s79, s31, 20
s_lshl_b32 s66, s3, 17
s_add_u32 s79, s79, s66
s_lshl_b32 s66, s30, 15
s_add_u32 s79, s79, s66
v_bfe_u32 v23, v0, 1, 1
v_lshrrev_b32 v1, 5, v0
v_xor_b32 v23, v23, v1
v_lshlrev_b32 v23, 5, v23
v_and_b32 v1, 1, v0
v_lshl_add_u32 v23, v1, 4, v23
v_lshrrev_b32 v1, 2, v0
v_mul_u32_u24 v1, 6144, v1
v_add_u32 v23, v1, v23
s_lshl_b32 s81, s80, 13
s_and_b32 s67, s2, 7
s_lshl_b32 s82, s67, 8
s_add_u32 s82, s82, s81
s_lshl_b32 s67, s67, 10
s_add_u32 s81, s81, s67
s_add_u32 s83, s81, 1048576
v_mul_u32_u24 v1, 1792, v25
v_add_u32 v1, v1, v16
s_lshl_b32 s68, s2, 3
s_lshl1_add_u32 s68, s30, s68
v_lshrrev_b32 v18, 5, v0
v_add_u32 v18, s68, v18
v_and_b32 v19, 31, v0
v_lshlrev_b32 v19, 4, v19
v_lshl_add_u32 v18, v18, 11, v19
v_mov_b32 v21, 0
v_min_u32 v20, 1, v0
v_lshlrev_b32 v20, 30, v20
v_accvgpr_write_b32 a240, -1
v_accvgpr_write_b32 a241, -1
v_accvgpr_write_b32 a242, -1
v_accvgpr_write_b32 a243, -1
s_lshr_b32 s69, s2, 7
s_or_b32 s69, s69, s30
s_lshl_b32 s69, s69, 21
s_add_u32 s69, s69, s2
s_lshl_b32 s69, s69, 7
s_add_u32 s69, s69, 59768832
s_cmp_eq_u32 s30, 0
s_cbranch_scc1 L_pg2
s_cmp_eq_u32 s30, 1
s_cbranch_scc1 L_pg3
s_cmp_eq_u32 s30, 2
s_cbranch_scc1 L_pg4
s_branch L_pg5
L_tr0:
s_branch L_base
.p2align 12
L_pg1:
s_branch L_tr9
L_base:
s_xor_b32 m0, s76, 4096
s_xor_b32 s64, s70, 32768
buffer_load_dwordx4 v12, s[32:35], s64 offen lds
s_xor_b32 m0, s76, 5120
s_xor_b32 s64, s70, 40960
buffer_load_dwordx4 v13, s[32:35], s64 offen lds
s_xor_b32 m0, s76, 6144
s_xor_b32 s64, s70, 49152
buffer_load_dwordx4 v12, s[32:35], s64 offen lds
s_xor_b32 m0, s76, 7168
s_xor_b32 s64, s70, 57344
buffer_load_dwordx4 v13, s[32:35], s64 offen lds
s_xor_b32 m0, s77, 81920
s_xor_b32 s64, s71, 0
buffer_load_dwordx4 v14, s[40:43], s64 offen lds
s_xor_b32 m0, s77, 82944
s_xor_b32 s64, s71, 32768
buffer_load_dwordx4 v14, s[40:43], s64 offen lds
s_xor_b32 m0, s77, 83968
s_xor_b32 s64, s71, 65536
buffer_load_dwordx4 v15, s[40:43], s64 offen lds
s_xor_b32 m0, s77, 84992
s_xor_b32 s64, s71, 98304
buffer_load_dwordx4 v15, s[40:43], s64 offen lds
s_and_b32 s66, s31, 3
s_lshl_b32 s67, s66, 11
s_add_u32 s84, s76, s67
s_lshl3_add_u32 s70, s67, s70
s_and_b32 s67, s66, 1
s_lshl_b32 s67, s67, 17
s_add_u32 s72, s72, s67
s_add_u32 s67, s73, s67
s_bitcmp1_b32 s66, 1
s_cselect_b32 s73, s72, s67
s_cselect_b32 s72, s67, s72
s_and_b32 s66, s3, 3
s_lshl_b32 s67, s66, 10
s_add_u32 s77, s77, s67
s_lshl_b32 s67, s66, 15
s_add_u32 s71, s71, s67
s_and_b32 s67, s66, 2
s_lshl_b32 s67, s67, 6
v_xor_b32 v14, s67, v14
v_xor_b32 v15, s67, v15
s_and_b32 s66, s3, 4
s_cselect_b64 s[36:37], s[12:13], s[10:11]
s_cselect_b64 s[40:41], s[10:11], s[12:13]
s_lshl_b32 s66, s66, 12
s_add_u32 s77, s77, s66
s_waitcnt vmcnt(8)
s_barrier
ds_read_b128 a[0:3], v2 offset:0
ds_read_b128 a[4:7], v3 offset:0
ds_read_b64_tr_b16 a[176:177], v4 offset:0
ds_read_b64_tr_b16 a[178:179], v4 offset:1024
ds_read_b64_tr_b16 a[180:181], v4 offset:8192
ds_read_b64_tr_b16 a[182:183], v4 offset:9216
ds_read_b128 a[8:11], v2 offset:2048
ds_read_b128 a[12:15], v3 offset:2048
ds_read_b64_tr_b16 a[184:185], v5 offset:0
ds_read_b64_tr_b16 a[186:187], v5 offset:1024
ds_read_b64_tr_b16 a[188:189], v5 offset:8192
ds_read_b64_tr_b16 a[190:191], v5 offset:9216
ds_read_b64_tr_b16 a[88:89], v6 offset:0
ds_read_b64_tr_b16 a[90:91], v6 offset:1024
ds_read_b64_tr_b16 a[92:93], v6 offset:8192
ds_read_b64_tr_b16 a[94:95], v6 offset:9216
s_waitcnt lgkmcnt(12)
v_mfma_f32_16x16x32_bf16 v[184:187], a[176:179], a[0:3], 0
s_waitcnt lgkmcnt(10)
s_xor_b32 m0, s77, 98304
ds_read_b64_tr_b16 a[96:97], v7 offset:0
v_mfma_f32_16x16x32_bf16 v[184:187], a[180:183], a[4:7], v[184:187]
s_waitcnt lgkmcnt(9)
s_xor_b32 s64, s71, 524288
ds_read_b64_tr_b16 a[98:99], v7 offset:1024
v_mfma_f32_16x16x32_bf16 v[192:195], a[180:183], a[12:15], 0
buffer_load_dwordx4 v14, s[36:39], s64 offen lds
v_mfma_f32_16x16x32_bf16 v[192:195], a[176:179], a[8:11], v[192:195]
s_waitcnt lgkmcnt(8)
ds_read_b64_tr_b16 a[100:101], v7 offset:8192
v_mfma_f32_16x16x32_bf16 v[196:199], a[184:187], a[8:11], 0
s_waitcnt lgkmcnt(7)
s_xor_b32 m0, s77, 99328
ds_read_b64_tr_b16 a[102:103], v7 offset:9216
v_mfma_f32_16x16x32_bf16 v[196:199], a[188:191], a[12:15], v[196:199]
s_xor_b32 s64, s71, 557056
ds_read_b64_tr_b16 a[104:105], v8 offset:0
v_mfma_f32_16x16x32_bf16 v[188:191], a[188:191], a[4:7], 0
buffer_load_dwordx4 v14, s[36:39], s64 offen lds
v_mfma_f32_16x16x32_bf16 v[188:191], a[184:187], a[0:3], v[188:191]
s_waitcnt lgkmcnt(7)
ds_read_b64_tr_b16 a[106:107], v8 offset:1024
v_mfma_f32_16x16x32_bf16 v[216:219], a[88:91], a[0:3], 0
s_waitcnt lgkmcnt(6)
s_xor_b32 m0, s77, 100352
ds_read_b64_tr_b16 a[108:109], v8 offset:8192
v_mfma_f32_16x16x32_bf16 v[216:219], a[92:95], a[4:7], v[216:219]
s_xor_b32 s64, s71, 589824
ds_read_b64_tr_b16 a[110:111], v8 offset:9216
v_mfma_f32_16x16x32_bf16 v[224:227], a[92:95], a[12:15], 0
buffer_load_dwordx4 v15, s[36:39], s64 offen lds
v_mfma_f32_16x16x32_bf16 v[224:227], a[88:91], a[8:11], v[224:227]
s_waitcnt lgkmcnt(6)
ds_read_b64_tr_b16 a[112:113], v9 offset:0
v_mfma_f32_16x16x32_bf16 v[228:231], a[96:99], a[8:11], 0
s_waitcnt lgkmcnt(5)
ds_read_b64_tr_b16 a[114:115], v9 offset:1024
v_mfma_f32_16x16x32_bf16 v[228:231], a[100:103], a[12:15], v[228:231]
s_xor_b32 m0, s77, 101376
ds_read_b64_tr_b16 a[116:117], v9 offset:8192
v_mfma_f32_16x16x32_bf16 v[220:223], a[100:103], a[4:7], 0
s_xor_b32 s64, s71, 622592
ds_read_b64_tr_b16 a[118:119], v9 offset:9216
v_mfma_f32_16x16x32_bf16 v[220:223], a[96:99], a[0:3], v[220:223]
s_waitcnt lgkmcnt(6)
buffer_load_dwordx4 v15, s[36:39], s64 offen lds
v_mfma_f32_16x16x32_bf16 v[152:155], a[104:107], a[0:3], 0
s_waitcnt lgkmcnt(4)
ds_read_b64_tr_b16 a[72:73], v10 offset:0
v_mfma_f32_16x16x32_bf16 v[152:155], a[108:111], a[4:7], v[152:155]
s_xor_b32 m0, s77, 114688
ds_read_b64_tr_b16 a[74:75], v10 offset:1024
v_mfma_f32_16x16x32_bf16 v[160:163], a[108:111], a[12:15], 0
s_xor_b32 s64, s71, 524288
ds_read_b64_tr_b16 a[76:77], v10 offset:8192
ds_read_b64_tr_b16 a[78:79], v10 offset:9216
v_mfma_f32_16x16x32_bf16 v[160:163], a[104:107], a[8:11], v[160:163]
s_waitcnt lgkmcnt(6)
buffer_load_dwordx4 v14, s[40:43], s64 offen lds
v_mfma_f32_16x16x32_bf16 v[164:167], a[112:115], a[8:11], 0
s_waitcnt lgkmcnt(4)
s_xor_b32 m0, s77, 115712
ds_read_b64_tr_b16 a[80:81], v11 offset:0
v_mfma_f32_16x16x32_bf16 v[164:167], a[116:119], a[12:15], v[164:167]
s_xor_b32 s64, s71, 557056
ds_read_b64_tr_b16 a[82:83], v11 offset:1024
v_mfma_f32_16x16x32_bf16 v[156:159], a[116:119], a[4:7], 0
ds_read_b64_tr_b16 a[84:85], v11 offset:8192
ds_read_b64_tr_b16 a[86:87], v11 offset:9216
s_waitcnt vmcnt(9)
v_mfma_f32_16x16x32_bf16 v[156:159], a[112:115], a[0:3], v[156:159]
s_waitcnt lgkmcnt(6)
buffer_load_dwordx4 v14, s[40:43], s64 offen lds
v_mfma_f32_16x16x32_bf16 v[24:27], a[72:75], a[0:3], 0
s_waitcnt lgkmcnt(4)
s_xor_b32 m0, s77, 116736
ds_read_b128 a[16:19], v2 offset:4096
ds_read_b128 a[20:23], v3 offset:4096
v_mfma_f32_16x16x32_bf16 v[24:27], a[76:79], a[4:7], v[24:27]
s_xor_b32 s64, s71, 589824
ds_read_b128 a[24:27], v2 offset:6144
ds_read_b128 a[28:31], v3 offset:6144
v_mfma_f32_16x16x32_bf16 v[40:43], a[76:79], a[12:15], 0
buffer_load_dwordx4 v15, s[40:43], s64 offen lds
v_mfma_f32_16x16x32_bf16 v[40:43], a[72:75], a[8:11], v[40:43]
s_waitcnt lgkmcnt(6)
v_mfma_f32_16x16x32_bf16 v[104:107], a[80:83], a[8:11], 0
s_waitcnt lgkmcnt(4)
s_xor_b32 m0, s77, 117760
v_mfma_f32_16x16x32_bf16 v[104:107], a[84:87], a[12:15], v[104:107]
s_xor_b32 s64, s71, 622592
v_mfma_f32_16x16x32_bf16 v[88:91], a[84:87], a[4:7], 0
buffer_load_dwordx4 v15, s[40:43], s64 offen lds
v_mfma_f32_16x16x32_bf16 v[88:91], a[80:83], a[0:3], v[88:91]
s_waitcnt lgkmcnt(3)
v_mfma_f32_16x16x32_bf16 v[232:235], a[88:91], a[16:19], 0
s_waitcnt lgkmcnt(2)
v_mfma_f32_16x16x32_bf16 v[232:235], a[92:95], a[20:23], v[232:235]
s_waitcnt lgkmcnt(0)
s_xor_b32 m0, s84, 32768
v_mfma_f32_16x16x32_bf16 v[240:243], a[92:95], a[28:31], 0
s_xor_b32 s64, s70, 128
v_mfma_f32_16x16x32_bf16 v[240:243], a[88:91], a[24:27], v[240:243]
buffer_load_dwordx4 v12, s[32:35], s64 offen lds
v_mfma_f32_16x16x32_bf16 v[244:247], a[96:99], a[24:27], 0
s_xor_b32 m0, s84, 33792
v_mfma_f32_16x16x32_bf16 v[244:247], a[100:103], a[28:31], v[244:247]
s_xor_b32 s64, s70, 8320
v_mfma_f32_16x16x32_bf16 v[236:239], a[100:103], a[20:23], 0
s_waitcnt vmcnt(9)
s_barrier
v_mfma_f32_16x16x32_bf16 v[236:239], a[96:99], a[16:19], v[236:239]
buffer_load_dwordx4 v13, s[32:35], s64 offen lds
v_mfma_f32_16x16x32_bf16 v[168:171], a[104:107], a[16:19], 0
ds_read_b64_tr_b16 a[88:89], v4 offset:16384
v_mfma_f32_16x16x32_bf16 v[168:171], a[108:111], a[20:23], v[168:171]
s_xor_b32 m0, s84, 34816
ds_read_b64_tr_b16 a[90:91], v4 offset:17408
v_mfma_f32_16x16x32_bf16 v[176:179], a[108:111], a[28:31], 0
s_xor_b32 s64, s70, 16512
ds_read_b64_tr_b16 a[92:93], v4 offset:24576
v_mfma_f32_16x16x32_bf16 v[176:179], a[104:107], a[24:27], v[176:179]
buffer_load_dwordx4 v12, s[32:35], s64 offen lds
v_mfma_f32_16x16x32_bf16 v[180:183], a[112:115], a[24:27], 0
ds_read_b64_tr_b16 a[94:95], v4 offset:25600
v_mfma_f32_16x16x32_bf16 v[180:183], a[116:119], a[28:31], v[180:183]
s_xor_b32 m0, s84, 35840
ds_read_b64_tr_b16 a[96:97], v5 offset:16384
v_mfma_f32_16x16x32_bf16 v[172:175], a[116:119], a[20:23], 0
s_xor_b32 s64, s70, 24704
ds_read_b64_tr_b16 a[98:99], v5 offset:17408
v_mfma_f32_16x16x32_bf16 v[172:175], a[112:115], a[16:19], v[172:175]
buffer_load_dwordx4 v13, s[32:35], s64 offen lds
v_mfma_f32_16x16x32_bf16 v[56:59], a[72:75], a[16:19], 0
ds_read_b64_tr_b16 a[100:101], v5 offset:24576
v_mfma_f32_16x16x32_bf16 v[56:59], a[76:79], a[20:23], v[56:59]
s_xor_b32 m0, s84, 36864
ds_read_b64_tr_b16 a[102:103], v5 offset:25600
v_mfma_f32_16x16x32_bf16 v[72:75], a[76:79], a[28:31], 0
s_xor_b32 s64, s70, 32896
ds_read_b64_tr_b16 a[104:105], v6 offset:16384
v_mfma_f32_16x16x32_bf16 v[72:75], a[72:75], a[24:27], v[72:75]
buffer_load_dwordx4 v12, s[32:35], s64 offen lds
v_mfma_f32_16x16x32_bf16 v[136:139], a[80:83], a[24:27], 0
ds_read_b64_tr_b16 a[106:107], v6 offset:17408
v_mfma_f32_16x16x32_bf16 v[136:139], a[84:87], a[28:31], v[136:139]
s_xor_b32 m0, s84, 37888
ds_read_b64_tr_b16 a[108:109], v6 offset:24576
v_mfma_f32_16x16x32_bf16 v[120:123], a[84:87], a[20:23], 0
s_xor_b32 s64, s70, 41088
ds_read_b64_tr_b16 a[110:111], v6 offset:25600
v_mfma_f32_16x16x32_bf16 v[120:123], a[80:83], a[16:19], v[120:123]
buffer_load_dwordx4 v13, s[32:35], s64 offen lds
v_mfma_f32_16x16x32_bf16 v[200:203], a[176:179], a[16:19], 0
ds_read_b64_tr_b16 a[112:113], v7 offset:16384
v_mfma_f32_16x16x32_bf16 v[200:203], a[180:183], a[20:23], v[200:203]
s_xor_b32 m0, s84, 38912
ds_read_b64_tr_b16 a[114:115], v7 offset:17408
v_mfma_f32_16x16x32_bf16 v[208:211], a[180:183], a[28:31], 0
s_xor_b32 s64, s70, 49280
ds_read_b64_tr_b16 a[116:117], v7 offset:24576
v_mfma_f32_16x16x32_bf16 v[208:211], a[176:179], a[24:27], v[208:211]
buffer_load_dwordx4 v12, s[32:35], s64 offen lds
v_mfma_f32_16x16x32_bf16 v[212:215], a[184:187], a[24:27], 0
ds_read_b64_tr_b16 a[118:119], v7 offset:25600
v_mfma_f32_16x16x32_bf16 v[212:215], a[188:191], a[28:31], v[212:215]
s_xor_b32 m0, s84, 39936
ds_read_b64_tr_b16 a[72:73], v8 offset:16384
v_mfma_f32_16x16x32_bf16 v[204:207], a[188:191], a[20:23], 0
s_xor_b32 s64, s70, 57472
ds_read_b64_tr_b16 a[74:75], v8 offset:17408
v_mfma_f32_16x16x32_bf16 v[204:207], a[184:187], a[16:19], v[204:207]
s_waitcnt lgkmcnt(7)
buffer_load_dwordx4 v13, s[32:35], s64 offen lds
v_mfma_f32_16x16x32_bf16 v[28:31], a[0:3], a[88:91], 0
ds_read_b64_tr_b16 a[76:77], v8 offset:24576
v_mfma_f32_16x16x32_bf16 v[28:31], a[4:7], a[92:95], v[28:31]
ds_read_b64_tr_b16 a[78:79], v8 offset:25600
v_mfma_f32_16x16x32_bf16 v[44:47], a[12:15], a[92:95], 0
ds_read_b64_tr_b16 a[80:81], v9 offset:16384
v_mfma_f32_16x16x32_bf16 v[44:47], a[8:11], a[88:91], v[44:47]
ds_read_b64_tr_b16 a[82:83], v9 offset:17408
v_mfma_f32_16x16x32_bf16 v[60:63], a[16:19], a[88:91], 0
s_xor_b32 m0, s77, 131072
ds_read_b64_tr_b16 a[84:85], v9 offset:24576
v_mfma_f32_16x16x32_bf16 v[60:63], a[20:23], a[92:95], v[60:63]
s_xor_b32 s64, s71, 1048576
ds_read_b64_tr_b16 a[86:87], v9 offset:25600
v_mfma_f32_16x16x32_bf16 v[76:79], a[28:31], a[92:95], 0
buffer_load_dwordx4 v14, s[36:39], s64 offen lds
v_mfma_f32_16x16x32_bf16 v[76:79], a[24:27], a[88:91], v[76:79]
s_xor_b32 m0, s77, 132096
ds_read_b64_tr_b16 a[88:89], v10 offset:16384
v_mfma_f32_16x16x32_bf16 v[140:143], a[24:27], a[96:99], 0
s_xor_b32 s64, s71, 1081344
ds_read_b64_tr_b16 a[90:91], v10 offset:17408
v_mfma_f32_16x16x32_bf16 v[140:143], a[28:31], a[100:103], v[140:143]
buffer_load_dwordx4 v14, s[36:39], s64 offen lds
v_mfma_f32_16x16x32_bf16 v[124:127], a[20:23], a[100:103], 0
ds_read_b64_tr_b16 a[92:93], v10 offset:24576
v_mfma_f32_16x16x32_bf16 v[124:127], a[16:19], a[96:99], v[124:127]
s_xor_b32 m0, s77, 133120
ds_read_b64_tr_b16 a[94:95], v10 offset:25600
v_mfma_f32_16x16x32_bf16 v[108:111], a[8:11], a[96:99], 0
s_xor_b32 s64, s71, 1114112
v_mfma_f32_16x16x32_bf16 v[108:111], a[12:15], a[100:103], v[108:111]
buffer_load_dwordx4 v15, s[36:39], s64 offen lds
v_mfma_f32_16x16x32_bf16 v[92:95], a[4:7], a[100:103], 0
v_mfma_f32_16x16x32_bf16 v[92:95], a[0:3], a[96:99], v[92:95]
s_xor_b32 m0, s77, 134144
ds_read_b64_tr_b16 a[96:97], v11 offset:16384
v_mfma_f32_16x16x32_bf16 v[32:35], a[0:3], a[104:107], 0
s_waitcnt lgkmcnt(5)
s_xor_b32 s64, s71, 1146880
ds_read_b64_tr_b16 a[98:99], v11 offset:17408
v_mfma_f32_16x16x32_bf16 v[32:35], a[4:7], a[108:111], v[32:35]
buffer_load_dwordx4 v15, s[36:39], s64 offen lds
v_mfma_f32_16x16x32_bf16 v[48:51], a[12:15], a[108:111], 0
ds_read_b64_tr_b16 a[100:101], v11 offset:24576
v_mfma_f32_16x16x32_bf16 v[48:51], a[8:11], a[104:107], v[48:51]
s_xor_b32 m0, s77, 147456
ds_read_b64_tr_b16 a[102:103], v11 offset:25600
v_mfma_f32_16x16x32_bf16 v[64:67], a[16:19], a[104:107], 0
s_xor_b32 s64, s71, 1048576
v_mfma_f32_16x16x32_bf16 v[64:67], a[20:23], a[108:111], v[64:67]
buffer_load_dwordx4 v14, s[40:43], s64 offen lds
v_mfma_f32_16x16x32_bf16 v[80:83], a[28:31], a[108:111], 0
s_xor_b32 m0, s77, 148480
v_mfma_f32_16x16x32_bf16 v[80:83], a[24:27], a[104:107], v[80:83]
s_xor_b32 s64, s71, 1081344
v_mfma_f32_16x16x32_bf16 v[144:147], a[24:27], a[112:115], 0
buffer_load_dwordx4 v14, s[40:43], s64 offen lds
v_mfma_f32_16x16x32_bf16 v[144:147], a[28:31], a[116:119], v[144:147]
v_mfma_f32_16x16x32_bf16 v[128:131], a[20:23], a[116:119], 0
s_xor_b32 m0, s77, 149504
v_mfma_f32_16x16x32_bf16 v[128:131], a[16:19], a[112:115], v[128:131]
s_xor_b32 s64, s71, 1114112
v_mfma_f32_16x16x32_bf16 v[112:115], a[8:11], a[112:115], 0
buffer_load_dwordx4 v15, s[40:43], s64 offen lds
v_mfma_f32_16x16x32_bf16 v[112:115], a[12:15], a[116:119], v[112:115]
v_mfma_f32_16x16x32_bf16 v[96:99], a[4:7], a[116:119], 0
s_xor_b32 m0, s77, 150528
v_mfma_f32_16x16x32_bf16 v[96:99], a[0:3], a[112:115], v[96:99]
s_xor_b32 s64, s71, 1146880
v_mfma_f32_16x16x32_bf16 v[36:39], a[0:3], a[72:75], 0
buffer_load_dwordx4 v15, s[40:43], s64 offen lds
v_mfma_f32_16x16x32_bf16 v[36:39], a[4:7], a[76:79], v[36:39]
s_xor_b32 m0, s84, 0
v_mfma_f32_16x16x32_bf16 v[52:55], a[12:15], a[76:79], 0
s_waitcnt vmcnt(16) lgkmcnt(0)
s_barrier
v_mfma_f32_16x16x32_bf16 v[52:55], a[8:11], a[72:75], v[52:55]
s_xor_b32 s64, s70, 256
ds_read_b64_tr_b16 a[104:105], v4 offset:32768
v_mfma_f32_16x16x32_bf16 v[68:71], a[16:19], a[72:75], 0
buffer_load_dwordx4 v12, s[32:35], s64 offen lds
v_mfma_f32_16x16x32_bf16 v[68:71], a[20:23], a[76:79], v[68:71]
s_xor_b32 m0, s84, 1024
global_load_dwordx4 a[144:147], v18, s[4:5] offset:0
v_mfma_f32_16x16x32_bf16 v[84:87], a[28:31], a[76:79], 0
s_xor_b32 s64, s70, 8448
ds_read_b64_tr_b16 a[106:107], v4 offset:33792
v_mfma_f32_16x16x32_bf16 v[84:87], a[24:27], a[72:75], v[84:87]
buffer_load_dwordx4 v13, s[32:35], s64 offen lds
v_mfma_f32_16x16x32_bf16 v[148:151], a[24:27], a[80:83], 0
ds_read_b64_tr_b16 a[108:109], v4 offset:40960
v_mfma_f32_16x16x32_bf16 v[148:151], a[28:31], a[84:87], v[148:151]
s_xor_b32 m0, s84, 2048
ds_read_b64_tr_b16 a[110:111], v4 offset:41984
v_mfma_f32_16x16x32_bf16 v[132:135], a[20:23], a[84:87], 0
s_waitcnt vmcnt(11)
s_xor_b32 s64, s70, 16640
ds_read_b128 a[32:35], v2 offset:32768
v_mfma_f32_16x16x32_bf16 v[132:135], a[16:19], a[80:83], v[132:135]
buffer_load_dwordx4 v12, s[32:35], s64 offen lds
v_mfma_f32_16x16x32_bf16 v[116:119], a[8:11], a[80:83], 0
ds_read_b128 a[36:39], v3 offset:32768
v_mfma_f32_16x16x32_bf16 v[116:119], a[12:15], a[84:87], v[116:119]
s_xor_b32 m0, s84, 3072
ds_read_b128 a[40:43], v2 offset:34816
v_mfma_f32_16x16x32_bf16 v[100:103], a[4:7], a[84:87], 0
s_xor_b32 s64, s70, 24832
ds_read_b128 a[44:47], v3 offset:34816
v_mfma_f32_16x16x32_bf16 v[100:103], a[0:3], a[80:83], v[100:103]
buffer_load_dwordx4 v13, s[32:35], s64 offen lds
v_mfma_f32_16x16x32_bf16 v[248:251], a[0:3], a[88:91], 0
ds_read_b128 a[48:51], v2 offset:36864
v_mfma_f32_16x16x32_bf16 v[248:251], a[4:7], a[92:95], v[248:251]
s_xor_b32 m0, s84, 4096
ds_read_b128 a[52:55], v3 offset:36864
v_mfma_f32_16x16x32_bf16 v[252:255], a[12:15], a[92:95], 0
s_xor_b32 s64, s70, 33024
ds_read_b128 a[56:59], v2 offset:38912
v_mfma_f32_16x16x32_bf16 v[252:255], a[8:11], a[88:91], v[252:255]
buffer_load_dwordx4 v12, s[32:35], s64 offen lds
v_mfma_f32_16x16x32_bf16 a[120:123], a[16:19], a[88:91], 0
s_xor_b32 m0, s84, 5120
ds_read_b128 a[60:63], v3 offset:38912
v_mfma_f32_16x16x32_bf16 a[120:123], a[20:23], a[92:95], a[120:123]
s_xor_b32 s64, s70, 41216
ds_read_b64_tr_b16 a[112:113], v5 offset:32768
v_mfma_f32_16x16x32_bf16 a[124:127], a[28:31], a[92:95], 0
buffer_load_dwordx4 v13, s[32:35], s64 offen lds
v_mfma_f32_16x16x32_bf16 a[124:127], a[24:27], a[88:91], a[124:127]
ds_read_b64_tr_b16 a[114:115], v5 offset:33792
v_mfma_f32_16x16x32_bf16 a[128:131], a[24:27], a[96:99], 0
s_xor_b32 m0, s84, 6144
ds_read_b64_tr_b16 a[116:117], v5 offset:40960
v_mfma_f32_16x16x32_bf16 a[128:131], a[28:31], a[100:103], a[128:131]
s_xor_b32 s64, s70, 49408
ds_read_b64_tr_b16 a[118:119], v5 offset:41984
v_mfma_f32_16x16x32_bf16 a[132:135], a[20:23], a[100:103], 0
buffer_load_dwordx4 v12, s[32:35], s64 offen lds
v_mfma_f32_16x16x32_bf16 a[132:135], a[16:19], a[96:99], a[132:135]
global_load_dwordx4 a[160:163], v19, s[22:23] offset:0
v_mfma_f32_16x16x32_bf16 a[136:139], a[8:11], a[96:99], 0
s_xor_b32 m0, s84, 7168
ds_read_b64_tr_b16 a[72:73], v6 offset:32768
v_mfma_f32_16x16x32_bf16 a[136:139], a[12:15], a[100:103], a[136:139]
s_xor_b32 s64, s70, 57600
ds_read_b64_tr_b16 a[74:75], v6 offset:33792
v_mfma_f32_16x16x32_bf16 a[140:143], a[4:7], a[100:103], 0
buffer_load_dwordx4 v13, s[32:35], s64 offen lds
v_mfma_f32_16x16x32_bf16 a[140:143], a[0:3], a[96:99], a[140:143]
s_waitcnt lgkmcnt(5)
ds_read_b64_tr_b16 a[76:77], v6 offset:40960
v_mfma_f32_16x16x32_bf16 v[184:187], a[104:107], a[32:35], v[184:187]
ds_read_b64_tr_b16 a[78:79], v6 offset:41984
v_mfma_f32_16x16x32_bf16 v[184:187], a[108:111], a[36:39], v[184:187]
ds_read_b64_tr_b16 a[80:81], v7 offset:32768
v_mfma_f32_16x16x32_bf16 v[192:195], a[108:111], a[44:47], v[192:195]
s_xor_b32 m0, s77, 65536
ds_read_b64_tr_b16 a[82:83], v7 offset:33792
v_mfma_f32_16x16x32_bf16 v[192:195], a[104:107], a[40:43], v[192:195]
s_xor_b32 s64, s71, 1572864
ds_read_b64_tr_b16 a[84:85], v7 offset:40960
v_mfma_f32_16x16x32_bf16 v[200:203], a[104:107], a[48:51], v[200:203]
buffer_load_dwordx4 v14, s[36:39], s64 offen lds
v_mfma_f32_16x16x32_bf16 v[200:203], a[108:111], a[52:55], v[200:203]
ds_read_b64_tr_b16 a[86:87], v7 offset:41984
v_mfma_f32_16x16x32_bf16 v[208:211], a[108:111], a[60:63], v[208:211]
s_xor_b32 m0, s77, 66560
ds_read_b64_tr_b16 a[88:89], v8 offset:32768
v_mfma_f32_16x16x32_bf16 v[208:211], a[104:107], a[56:59], v[208:211]
s_waitcnt lgkmcnt(7)
s_xor_b32 s64, s71, 1605632
ds_read_b64_tr_b16 a[90:91], v8 offset:33792
v_mfma_f32_16x16x32_bf16 v[212:215], a[112:115], a[56:59], v[212:215]
buffer_load_dwordx4 v14, s[36:39], s64 offen lds
v_mfma_f32_16x16x32_bf16 v[212:215], a[116:119], a[60:63], v[212:215]
ds_read_b64_tr_b16 a[92:93], v8 offset:40960
v_mfma_f32_16x16x32_bf16 v[204:207], a[116:119], a[52:55], v[204:207]
s_xor_b32 m0, s77, 67584
ds_read_b64_tr_b16 a[94:95], v8 offset:41984
v_mfma_f32_16x16x32_bf16 v[204:207], a[112:115], a[48:51], v[204:207]
s_xor_b32 s64, s71, 1638400
ds_read_b64_tr_b16 a[96:97], v9 offset:32768
v_mfma_f32_16x16x32_bf16 v[196:199], a[112:115], a[40:43], v[196:199]
buffer_load_dwordx4 v15, s[36:39], s64 offen lds
v_mfma_f32_16x16x32_bf16 v[196:199], a[116:119], a[44:47], v[196:199]
ds_read_b64_tr_b16 a[98:99], v9 offset:33792
v_mfma_f32_16x16x32_bf16 v[188:191], a[116:119], a[36:39], v[188:191]
s_xor_b32 m0, s77, 68608
ds_read_b64_tr_b16 a[100:101], v9 offset:40960
v_mfma_f32_16x16x32_bf16 v[188:191], a[112:115], a[32:35], v[188:191]
s_xor_b32 s64, s71, 1671168
ds_read_b64_tr_b16 a[102:103], v9 offset:41984
v_mfma_f32_16x16x32_bf16 v[216:219], a[72:75], a[32:35], v[216:219]
s_waitcnt lgkmcnt(7)
buffer_load_dwordx4 v15, s[36:39], s64 offen lds
v_mfma_f32_16x16x32_bf16 v[216:219], a[76:79], a[36:39], v[216:219]
global_load_dwordx4 a[148:151], v18, s[4:5] offset:512
v_mfma_f32_16x16x32_bf16 v[224:227], a[76:79], a[44:47], v[224:227]
ds_read_b64_tr_b16 a[104:105], v10 offset:32768
v_mfma_f32_16x16x32_bf16 v[224:227], a[72:75], a[40:43], v[224:227]
s_xor_b32 m0, s77, 81920
ds_read_b64_tr_b16 a[106:107], v10 offset:33792
v_mfma_f32_16x16x32_bf16 v[232:235], a[72:75], a[48:51], v[232:235]
s_xor_b32 s64, s71, 1572864
ds_read_b64_tr_b16 a[108:109], v10 offset:40960
v_mfma_f32_16x16x32_bf16 v[232:235], a[76:79], a[52:55], v[232:235]
buffer_load_dwordx4 v14, s[40:43], s64 offen lds
v_mfma_f32_16x16x32_bf16 v[240:243], a[76:79], a[60:63], v[240:243]
ds_read_b64_tr_b16 a[110:111], v10 offset:41984
v_mfma_f32_16x16x32_bf16 v[240:243], a[72:75], a[56:59], v[240:243]
s_xor_b32 m0, s77, 82944
ds_read_b64_tr_b16 a[112:113], v11 offset:32768
v_mfma_f32_16x16x32_bf16 v[244:247], a[80:83], a[56:59], v[244:247]
s_xor_b32 s64, s71, 1605632
ds_read_b64_tr_b16 a[114:115], v11 offset:33792
v_mfma_f32_16x16x32_bf16 v[244:247], a[84:87], a[60:63], v[244:247]
buffer_load_dwordx4 v14, s[40:43], s64 offen lds
v_mfma_f32_16x16x32_bf16 v[236:239], a[84:87], a[52:55], v[236:239]
ds_read_b64_tr_b16 a[116:117], v11 offset:40960
v_mfma_f32_16x16x32_bf16 v[236:239], a[80:83], a[48:51], v[236:239]
s_xor_b32 m0, s77, 83968
ds_read_b64_tr_b16 a[118:119], v11 offset:41984
v_mfma_f32_16x16x32_bf16 v[228:231], a[80:83], a[40:43], v[228:231]
s_xor_b32 s64, s71, 1638400
ds_read_b64_tr_b16 a[72:73], v4 offset:49152
v_mfma_f32_16x16x32_bf16 v[228:231], a[84:87], a[44:47], v[228:231]
buffer_load_dwordx4 v15, s[40:43], s64 offen lds
v_mfma_f32_16x16x32_bf16 v[220:223], a[84:87], a[36:39], v[220:223]
ds_read_b64_tr_b16 a[74:75], v4 offset:50176
v_mfma_f32_16x16x32_bf16 v[220:223], a[80:83], a[32:35], v[220:223]
s_waitcnt lgkmcnt(7)
s_xor_b32 m0, s77, 84992
ds_read_b64_tr_b16 a[76:77], v4 offset:57344
v_mfma_f32_16x16x32_bf16 v[152:155], a[88:91], a[32:35], v[152:155]
s_xor_b32 s64, s71, 1671168
ds_read_b64_tr_b16 a[78:79], v4 offset:58368
v_mfma_f32_16x16x32_bf16 v[152:155], a[92:95], a[36:39], v[152:155]
buffer_load_dwordx4 v15, s[40:43], s64 offen lds
v_mfma_f32_16x16x32_bf16 v[160:163], a[92:95], a[44:47], v[160:163]
ds_read_b64_tr_b16 a[80:81], v5 offset:49152
v_mfma_f32_16x16x32_bf16 v[160:163], a[88:91], a[40:43], v[160:163]
ds_read_b64_tr_b16 a[82:83], v5 offset:50176
v_mfma_f32_16x16x32_bf16 v[168:171], a[88:91], a[48:51], v[168:171]
ds_read_b64_tr_b16 a[84:85], v5 offset:57344
v_mfma_f32_16x16x32_bf16 v[168:171], a[92:95], a[52:55], v[168:171]
ds_read_b64_tr_b16 a[86:87], v5 offset:58368
v_mfma_f32_16x16x32_bf16 v[176:179], a[92:95], a[60:63], v[176:179]
s_xor_b32 m0, s84, 32768
global_load_dwordx4 a[164:167], v19, s[22:23] offset:512
v_mfma_f32_16x16x32_bf16 v[176:179], a[88:91], a[56:59], v[176:179]
s_xor_b32 s64, s70, 384
ds_read_b64_tr_b16 a[88:89], v6 offset:49152
v_mfma_f32_16x16x32_bf16 v[180:183], a[96:99], a[56:59], v[180:183]
buffer_load_dwordx4 v12, s[32:35], s64 offen lds
v_mfma_f32_16x16x32_bf16 v[180:183], a[100:103], a[60:63], v[180:183]
ds_read_b64_tr_b16 a[90:91], v6 offset:50176
v_mfma_f32_16x16x32_bf16 v[172:175], a[100:103], a[52:55], v[172:175]
ds_read_b64_tr_b16 a[92:93], v6 offset:57344
v_mfma_f32_16x16x32_bf16 v[172:175], a[96:99], a[48:51], v[172:175]
ds_read_b64_tr_b16 a[94:95], v6 offset:58368
v_mfma_f32_16x16x32_bf16 v[164:167], a[96:99], a[40:43], v[164:167]
v_mfma_f32_16x16x32_bf16 v[164:167], a[100:103], a[44:47], v[164:167]
s_xor_b32 m0, s84, 33792
v_mfma_f32_16x16x32_bf16 v[156:159], a[100:103], a[36:39], v[156:159]
s_xor_b32 s64, s70, 8576
v_mfma_f32_16x16x32_bf16 v[156:159], a[96:99], a[32:35], v[156:159]
buffer_load_dwordx4 v13, s[32:35], s64 offen lds
v_mfma_f32_16x16x32_bf16 v[24:27], a[104:107], a[32:35], v[24:27]
s_waitcnt lgkmcnt(4)
ds_read_b64_tr_b16 a[96:97], v7 offset:49152
v_mfma_f32_16x16x32_bf16 v[24:27], a[108:111], a[36:39], v[24:27]
ds_read_b64_tr_b16 a[98:99], v7 offset:50176
v_mfma_f32_16x16x32_bf16 v[40:43], a[108:111], a[44:47], v[40:43]
ds_read_b64_tr_b16 a[100:101], v7 offset:57344
v_mfma_f32_16x16x32_bf16 v[40:43], a[104:107], a[40:43], v[40:43]
ds_read_b64_tr_b16 a[102:103], v7 offset:58368
v_mfma_f32_16x16x32_bf16 v[56:59], a[104:107], a[48:51], v[56:59]
s_xor_b32 m0, s84, 34816
v_mfma_f32_16x16x32_bf16 v[56:59], a[108:111], a[52:55], v[56:59]
s_xor_b32 s64, s70, 16768
v_mfma_f32_16x16x32_bf16 v[72:75], a[108:111], a[60:63], v[72:75]
s_waitcnt vmcnt(12)
buffer_load_dwordx4 v12, s[32:35], s64 offen lds
v_mfma_f32_16x16x32_bf16 v[72:75], a[104:107], a[56:59], v[72:75]
ds_read_b64_tr_b16 a[104:105], v8 offset:49152
v_mfma_f32_16x16x32_bf16 v[136:139], a[112:115], a[56:59], v[136:139]
ds_read_b64_tr_b16 a[106:107], v8 offset:50176
v_mfma_f32_16x16x32_bf16 v[136:139], a[116:119], a[60:63], v[136:139]
ds_read_b64_tr_b16 a[108:109], v8 offset:57344
v_add_u32 v4, 0x8000, v4
v_mfma_f32_16x16x32_bf16 v[120:123], a[116:119], a[52:55], v[120:123]
ds_read_b64_tr_b16 a[110:111], v8 offset:58368
v_mfma_f32_16x16x32_bf16 v[120:123], a[112:115], a[48:51], v[120:123]
s_xor_b32 m0, s84, 35840
ds_read_b128 a[0:3], v2 offset:0
v_mfma_f32_16x16x32_bf16 v[104:107], a[112:115], a[40:43], v[104:107]
s_xor_b32 s64, s70, 24960
global_load_dwordx4 a[152:155], v18, s[4:5] offset:1024
v_mfma_f32_16x16x32_bf16 v[104:107], a[116:119], a[44:47], v[104:107]
s_branch L_po2
L_pg2:
s_branch L_tr0
L_po2:
buffer_load_dwordx4 v13, s[32:35], s64 offen lds
v_mfma_f32_16x16x32_bf16 v[88:91], a[116:119], a[36:39], v[88:91]
ds_read_b128 a[4:7], v3 offset:0
v_mfma_f32_16x16x32_bf16 v[88:91], a[112:115], a[32:35], v[88:91]
ds_read_b128 a[8:11], v2 offset:2048
v_mfma_f32_16x16x32_bf16 v[28:31], a[32:35], a[72:75], v[28:31]
ds_read_b128 a[12:15], v3 offset:2048
v_mfma_f32_16x16x32_bf16 v[28:31], a[36:39], a[76:79], v[28:31]
ds_read_b128 a[16:19], v2 offset:4096
v_add_u32 v5, 0x8000, v5
v_mfma_f32_16x16x32_bf16 v[44:47], a[44:47], a[76:79], v[44:47]
s_xor_b32 m0, s84, 36864
ds_read_b128 a[20:23], v3 offset:4096
v_mfma_f32_16x16x32_bf16 v[44:47], a[40:43], a[72:75], v[44:47]
s_xor_b32 s64, s70, 33152
ds_read_b128 a[24:27], v2 offset:6144
v_mfma_f32_16x16x32_bf16 v[60:63], a[48:51], a[72:75], v[60:63]
buffer_load_dwordx4 v12, s[32:35], s64 offen lds
v_mfma_f32_16x16x32_bf16 v[60:63], a[52:55], a[76:79], v[60:63]
ds_read_b128 a[28:31], v3 offset:6144
v_mfma_f32_16x16x32_bf16 v[76:79], a[60:63], a[76:79], v[76:79]
ds_read_b64_tr_b16 a[112:113], v9 offset:49152
v_mfma_f32_16x16x32_bf16 v[76:79], a[56:59], a[72:75], v[76:79]
ds_read_b64_tr_b16 a[114:115], v9 offset:50176
v_mfma_f32_16x16x32_bf16 v[140:143], a[56:59], a[80:83], v[140:143]
ds_read_b64_tr_b16 a[116:117], v9 offset:57344
v_mfma_f32_16x16x32_bf16 v[140:143], a[60:63], a[84:87], v[140:143]
s_xor_b32 m0, s84, 37888
ds_read_b64_tr_b16 a[118:119], v9 offset:58368
v_add_u32 v6, 0x8000, v6
v_mfma_f32_16x16x32_bf16 v[124:127], a[52:55], a[84:87], v[124:127]
s_xor_b32 s64, s70, 41344
ds_read_b64_tr_b16 a[72:73], v10 offset:49152
v_mfma_f32_16x16x32_bf16 v[124:127], a[48:51], a[80:83], v[124:127]
buffer_load_dwordx4 v13, s[32:35], s64 offen lds
v_mfma_f32_16x16x32_bf16 v[108:111], a[40:43], a[80:83], v[108:111]
ds_read_b64_tr_b16 a[74:75], v10 offset:50176
v_mfma_f32_16x16x32_bf16 v[108:111], a[44:47], a[84:87], v[108:111]
ds_read_b64_tr_b16 a[76:77], v10 offset:57344
v_mfma_f32_16x16x32_bf16 v[92:95], a[36:39], a[84:87], v[92:95]
ds_read_b64_tr_b16 a[78:79], v10 offset:58368
v_mfma_f32_16x16x32_bf16 v[92:95], a[32:35], a[80:83], v[92:95]
s_waitcnt lgkmcnt(8)
ds_read_b64_tr_b16 a[80:81], v11 offset:49152
v_mfma_f32_16x16x32_bf16 v[32:35], a[32:35], a[88:91], v[32:35]
s_xor_b32 m0, s84, 38912
ds_read_b64_tr_b16 a[82:83], v11 offset:50176
v_mfma_f32_16x16x32_bf16 v[32:35], a[36:39], a[92:95], v[32:35]
s_xor_b32 s64, s70, 49536
ds_read_b64_tr_b16 a[84:85], v11 offset:57344
v_add_u32 v7, 0x8000, v7
v_mfma_f32_16x16x32_bf16 v[48:51], a[44:47], a[92:95], v[48:51]
buffer_load_dwordx4 v12, s[32:35], s64 offen lds
v_mfma_f32_16x16x32_bf16 v[48:51], a[40:43], a[88:91], v[48:51]
global_load_dwordx4 a[168:171], v19, s[22:23] offset:1024
v_mfma_f32_16x16x32_bf16 v[64:67], a[48:51], a[88:91], v[64:67]
ds_read_b64_tr_b16 a[86:87], v11 offset:58368
v_mfma_f32_16x16x32_bf16 v[64:67], a[52:55], a[92:95], v[64:67]
v_mfma_f32_16x16x32_bf16 v[80:83], a[60:63], a[92:95], v[80:83]
v_mfma_f32_16x16x32_bf16 v[80:83], a[56:59], a[88:91], v[80:83]
s_xor_b32 m0, s84, 39936
v_mfma_f32_16x16x32_bf16 v[144:147], a[56:59], a[96:99], v[144:147]
s_xor_b32 s64, s70, 57728
v_mfma_f32_16x16x32_bf16 v[144:147], a[60:63], a[100:103], v[144:147]
buffer_load_dwordx4 v13, s[32:35], s64 offen lds
v_mfma_f32_16x16x32_bf16 v[128:131], a[52:55], a[100:103], v[128:131]
v_add_u32 v8, 0x8000, v8
v_mfma_f32_16x16x32_bf16 v[128:131], a[48:51], a[96:99], v[128:131]
v_mfma_f32_16x16x32_bf16 v[112:115], a[40:43], a[96:99], v[112:115]
v_mfma_f32_16x16x32_bf16 v[112:115], a[44:47], a[100:103], v[112:115]
v_mfma_f32_16x16x32_bf16 v[96:99], a[36:39], a[100:103], v[96:99]
v_add_u32 v9, 0x8000, v9
v_add_u32 v10, 0x8000, v10
v_mfma_f32_16x16x32_bf16 v[96:99], a[32:35], a[96:99], v[96:99]
v_add_u32 v11, 0x8000, v11
v_mfma_f32_16x16x32_bf16 v[36:39], a[32:35], a[104:107], v[36:39]
v_mfma_f32_16x16x32_bf16 v[36:39], a[36:39], a[108:111], v[36:39]
v_mfma_f32_16x16x32_bf16 v[52:55], a[44:47], a[108:111], v[52:55]
s_cmp_eq_u32 s30, 0
s_cbranch_scc1 L_pg6
s_cmp_eq_u32 s30, 1
s_cbranch_scc1 L_pg7
s_cmp_eq_u32 s30, 2
s_cbranch_scc1 L_pg8
s_branch L_pg9
L_tr1:
s_waitcnt lgkmcnt(0)
s_barrier
v_mfma_f32_16x16x32_bf16 v[52:55], a[40:43], a[104:107], v[52:55]
s_xor_b32 m0, s77, 98304
ds_read_b64_tr_b16 a[88:89], v4 offset:32768
v_mfma_f32_16x16x32_bf16 v[68:71], a[48:51], a[104:107], v[68:71]
s_xor_b32 s64, s71, 2097152
ds_read_b64_tr_b16 a[90:91], v4 offset:33792
v_mfma_f32_16x16x32_bf16 v[68:71], a[52:55], a[108:111], v[68:71]
buffer_load_dwordx4 v14, s[36:39], s64 offen lds
v_mfma_f32_16x16x32_bf16 v[84:87], a[60:63], a[108:111], v[84:87]
ds_read_b64_tr_b16 a[92:93], v4 offset:40960
v_mfma_f32_16x16x32_bf16 v[84:87], a[56:59], a[104:107], v[84:87]
ds_read_b64_tr_b16 a[94:95], v4 offset:41984
v_mfma_f32_16x16x32_bf16 v[148:151], a[56:59], a[112:115], v[148:151]
global_load_dwordx4 a[156:159], v18, s[4:5] offset:1536
v_mfma_f32_16x16x32_bf16 v[148:151], a[60:63], a[116:119], v[148:151]
ds_read_b64_tr_b16 a[96:97], v5 offset:32768
v_mfma_f32_16x16x32_bf16 v[132:135], a[52:55], a[116:119], v[132:135]
ds_read_b64_tr_b16 a[98:99], v5 offset:33792
v_mfma_f32_16x16x32_bf16 v[132:135], a[48:51], a[112:115], v[132:135]
s_xor_b32 m0, s77, 99328
ds_read_b64_tr_b16 a[100:101], v5 offset:40960
v_mfma_f32_16x16x32_bf16 v[116:119], a[40:43], a[112:115], v[116:119]
s_xor_b32 s64, s71, 2129920
ds_read_b64_tr_b16 a[102:103], v5 offset:41984
v_mfma_f32_16x16x32_bf16 v[116:119], a[44:47], a[116:119], v[116:119]
buffer_load_dwordx4 v14, s[36:39], s64 offen lds
v_mfma_f32_16x16x32_bf16 v[100:103], a[36:39], a[116:119], v[100:103]
ds_read_b64_tr_b16 a[104:105], v6 offset:32768
v_mfma_f32_16x16x32_bf16 v[100:103], a[32:35], a[112:115], v[100:103]
ds_read_b64_tr_b16 a[106:107], v6 offset:33792
v_mfma_f32_16x16x32_bf16 v[248:251], a[32:35], a[72:75], v[248:251]
ds_read_b64_tr_b16 a[108:109], v6 offset:40960
v_mfma_f32_16x16x32_bf16 v[248:251], a[36:39], a[76:79], v[248:251]
ds_read_b64_tr_b16 a[110:111], v6 offset:41984
v_mfma_f32_16x16x32_bf16 v[252:255], a[44:47], a[76:79], v[252:255]
ds_read_b64_tr_b16 a[112:113], v7 offset:32768
v_mfma_f32_16x16x32_bf16 v[252:255], a[40:43], a[72:75], v[252:255]
s_xor_b32 m0, s77, 100352
ds_read_b64_tr_b16 a[114:115], v7 offset:33792
v_mfma_f32_16x16x32_bf16 a[120:123], a[48:51], a[72:75], a[120:123]
s_xor_b32 s64, s71, 2162688
ds_read_b64_tr_b16 a[116:117], v7 offset:40960
v_mfma_f32_16x16x32_bf16 a[120:123], a[52:55], a[76:79], a[120:123]
buffer_load_dwordx4 v15, s[36:39], s64 offen lds
v_mfma_f32_16x16x32_bf16 a[124:127], a[60:63], a[76:79], a[124:127]
ds_read_b64_tr_b16 a[118:119], v7 offset:41984
v_mfma_f32_16x16x32_bf16 a[124:127], a[56:59], a[72:75], a[124:127]
ds_read_b64_tr_b16 a[72:73], v8 offset:32768
v_mfma_f32_16x16x32_bf16 a[128:131], a[56:59], a[80:83], a[128:131]
ds_read_b64_tr_b16 a[74:75], v8 offset:33792
v_mfma_f32_16x16x32_bf16 a[128:131], a[60:63], a[84:87], a[128:131]
ds_read_b64_tr_b16 a[76:77], v8 offset:40960
v_mfma_f32_16x16x32_bf16 a[132:135], a[52:55], a[84:87], a[132:135]
ds_read_b64_tr_b16 a[78:79], v8 offset:41984
v_mfma_f32_16x16x32_bf16 a[132:135], a[48:51], a[80:83], a[132:135]
s_xor_b32 m0, s77, 101376
v_mfma_f32_16x16x32_bf16 a[136:139], a[40:43], a[80:83], a[136:139]
s_xor_b32 s64, s71, 2195456
v_mfma_f32_16x16x32_bf16 a[136:139], a[44:47], a[84:87], a[136:139]
buffer_load_dwordx4 v15, s[36:39], s64 offen lds
v_mfma_f32_16x16x32_bf16 a[140:143], a[36:39], a[84:87], a[140:143]
global_load_dwordx4 a[172:175], v19, s[22:23] offset:1536
v_mfma_f32_16x16x32_bf16 a[140:143], a[32:35], a[80:83], a[140:143]
s_waitcnt lgkmcnt(5)
ds_read_b64_tr_b16 a[80:81], v9 offset:32768
v_mfma_f32_16x16x32_bf16 v[184:187], a[88:91], a[0:3], v[184:187]
ds_read_b64_tr_b16 a[82:83], v9 offset:33792
v_mfma_f32_16x16x32_bf16 v[184:187], a[92:95], a[4:7], v[184:187]
ds_read_b64_tr_b16 a[84:85], v9 offset:40960
v_mfma_f32_16x16x32_bf16 v[192:195], a[92:95], a[12:15], v[192:195]
ds_read_b64_tr_b16 a[86:87], v9 offset:41984
v_mfma_f32_16x16x32_bf16 v[192:195], a[88:91], a[8:11], v[192:195]
s_xor_b32 m0, s77, 114688
v_mfma_f32_16x16x32_bf16 v[200:203], a[88:91], a[16:19], v[200:203]
s_xor_b32 s64, s71, 2097152
v_mfma_f32_16x16x32_bf16 v[200:203], a[92:95], a[20:23], v[200:203]
buffer_load_dwordx4 v14, s[40:43], s64 offen lds
v_mfma_f32_16x16x32_bf16 v[208:211], a[92:95], a[28:31], v[208:211]
v_mfma_f32_16x16x32_bf16 v[208:211], a[88:91], a[24:27], v[208:211]
ds_read_b64_tr_b16 a[88:89], v10 offset:32768
v_mfma_f32_16x16x32_bf16 v[212:215], a[96:99], a[24:27], v[212:215]
ds_read_b64_tr_b16 a[90:91], v10 offset:33792
v_mfma_f32_16x16x32_bf16 v[212:215], a[100:103], a[28:31], v[212:215]
ds_read_b64_tr_b16 a[92:93], v10 offset:40960
v_mfma_f32_16x16x32_bf16 v[204:207], a[100:103], a[20:23], v[204:207]
ds_read_b64_tr_b16 a[94:95], v10 offset:41984
v_mfma_f32_16x16x32_bf16 v[204:207], a[96:99], a[16:19], v[204:207]
s_xor_b32 m0, s77, 115712
v_mfma_f32_16x16x32_bf16 v[196:199], a[96:99], a[8:11], v[196:199]
s_xor_b32 s64, s71, 2129920
v_mfma_f32_16x16x32_bf16 v[196:199], a[100:103], a[12:15], v[196:199]
buffer_load_dwordx4 v14, s[40:43], s64 offen lds
v_mfma_f32_16x16x32_bf16 v[188:191], a[100:103], a[4:7], v[188:191]
v_mfma_f32_16x16x32_bf16 v[188:191], a[96:99], a[0:3], v[188:191]
ds_read_b64_tr_b16 a[96:97], v11 offset:32768
v_mfma_f32_16x16x32_bf16 v[216:219], a[104:107], a[0:3], v[216:219]
ds_read_b64_tr_b16 a[98:99], v11 offset:33792
v_mfma_f32_16x16x32_bf16 v[216:219], a[108:111], a[4:7], v[216:219]
ds_read_b64_tr_b16 a[100:101], v11 offset:40960
v_mfma_f32_16x16x32_bf16 v[224:227], a[108:111], a[12:15], v[224:227]
ds_read_b64_tr_b16 a[102:103], v11 offset:41984
v_mfma_f32_16x16x32_bf16 v[224:227], a[104:107], a[8:11], v[224:227]
s_xor_b32 m0, s77, 116736
v_mfma_f32_16x16x32_bf16 v[232:235], a[104:107], a[16:19], v[232:235]
s_xor_b32 s64, s71, 2162688
buffer_store_dword v21, v20, s[44:47], s69 offen sc1
v_mfma_f32_16x16x32_bf16 v[232:235], a[108:111], a[20:23], v[232:235]
buffer_load_dwordx4 v15, s[40:43], s64 offen lds
v_mfma_f32_16x16x32_bf16 v[240:243], a[108:111], a[28:31], v[240:243]
v_mfma_f32_16x16x32_bf16 v[240:243], a[104:107], a[24:27], v[240:243]
ds_read_b64_tr_b16 a[104:105], v4 offset:49152
v_mfma_f32_16x16x32_bf16 v[244:247], a[112:115], a[24:27], v[244:247]
s_waitcnt lgkmcnt(5)
buffer_load_dword a252, v16, s[56:59], s81 offen
v_mfma_f32_16x16x32_bf16 v[244:247], a[116:119], a[28:31], v[244:247]
ds_read_b64_tr_b16 a[106:107], v4 offset:50176
v_mfma_f32_16x16x32_bf16 v[236:239], a[116:119], a[20:23], v[236:239]
ds_read_b64_tr_b16 a[108:109], v4 offset:57344
v_mfma_f32_16x16x32_bf16 v[236:239], a[112:115], a[16:19], v[236:239]
s_xor_b32 m0, s77, 117760
ds_read_b64_tr_b16 a[110:111], v4 offset:58368
v_mfma_f32_16x16x32_bf16 v[228:231], a[112:115], a[8:11], v[228:231]
s_xor_b32 s64, s71, 2195456
v_mfma_f32_16x16x32_bf16 v[228:231], a[116:119], a[12:15], v[228:231]
buffer_load_dwordx4 v15, s[40:43], s64 offen lds
v_mfma_f32_16x16x32_bf16 v[220:223], a[116:119], a[4:7], v[220:223]
v_mfma_f32_16x16x32_bf16 v[220:223], a[112:115], a[0:3], v[220:223]
ds_read_b64_tr_b16 a[112:113], v5 offset:49152
v_mfma_f32_16x16x32_bf16 v[152:155], a[72:75], a[0:3], v[152:155]
ds_read_b64_tr_b16 a[114:115], v5 offset:50176
v_mfma_f32_16x16x32_bf16 v[152:155], a[76:79], a[4:7], v[152:155]
ds_read_b64_tr_b16 a[116:117], v5 offset:57344
v_mfma_f32_16x16x32_bf16 v[160:163], a[76:79], a[12:15], v[160:163]
ds_read_b64_tr_b16 a[118:119], v5 offset:58368
v_mfma_f32_16x16x32_bf16 v[160:163], a[72:75], a[8:11], v[160:163]
v_mfma_f32_16x16x32_bf16 v[168:171], a[72:75], a[16:19], v[168:171]
v_mfma_f32_16x16x32_bf16 v[168:171], a[76:79], a[20:23], v[168:171]
v_mfma_f32_16x16x32_bf16 v[176:179], a[76:79], a[28:31], v[176:179]
s_xor_b32 m0, s84, 0
v_mfma_f32_16x16x32_bf16 v[176:179], a[72:75], a[24:27], v[176:179]
s_xor_b32 s64, s70, 512
ds_read_b64_tr_b16 a[72:73], v6 offset:49152
v_mfma_f32_16x16x32_bf16 v[180:183], a[80:83], a[24:27], v[180:183]
buffer_load_dwordx4 v12, s[32:35], s64 offen lds
v_mfma_f32_16x16x32_bf16 v[180:183], a[84:87], a[28:31], v[180:183]
ds_read_b64_tr_b16 a[74:75], v6 offset:50176
v_mfma_f32_16x16x32_bf16 v[172:175], a[84:87], a[20:23], v[172:175]
ds_read_b64_tr_b16 a[76:77], v6 offset:57344
v_mfma_f32_16x16x32_bf16 v[172:175], a[80:83], a[16:19], v[172:175]
ds_read_b64_tr_b16 a[78:79], v6 offset:58368
v_mfma_f32_16x16x32_bf16 v[164:167], a[80:83], a[8:11], v[164:167]
v_mfma_f32_16x16x32_bf16 v[164:167], a[84:87], a[12:15], v[164:167]
s_xor_b32 m0, s84, 1024
v_mfma_f32_16x16x32_bf16 v[156:159], a[84:87], a[4:7], v[156:159]
s_xor_b32 s64, s70, 8704
v_mfma_f32_16x16x32_bf16 v[156:159], a[80:83], a[0:3], v[156:159]
buffer_load_dwordx4 v13, s[32:35], s64 offen lds
v_mfma_f32_16x16x32_bf16 v[24:27], a[88:91], a[0:3], v[24:27]
ds_read_b64_tr_b16 a[80:81], v7 offset:49152
v_mfma_f32_16x16x32_bf16 v[24:27], a[92:95], a[4:7], v[24:27]
ds_read_b64_tr_b16 a[82:83], v7 offset:50176
v_mfma_f32_16x16x32_bf16 v[40:43], a[92:95], a[12:15], v[40:43]
ds_read_b64_tr_b16 a[84:85], v7 offset:57344
v_mfma_f32_16x16x32_bf16 v[40:43], a[88:91], a[8:11], v[40:43]
ds_read_b64_tr_b16 a[86:87], v7 offset:58368
v_mfma_f32_16x16x32_bf16 v[56:59], a[88:91], a[16:19], v[56:59]
s_xor_b32 m0, s84, 2048
v_mfma_f32_16x16x32_bf16 v[56:59], a[92:95], a[20:23], v[56:59]
s_xor_b32 s64, s70, 16896
v_mfma_f32_16x16x32_bf16 v[72:75], a[92:95], a[28:31], v[72:75]
s_waitcnt vmcnt(14)
buffer_load_dwordx4 v12, s[32:35], s64 offen lds
v_mfma_f32_16x16x32_bf16 v[72:75], a[88:91], a[24:27], v[72:75]
s_waitcnt lgkmcnt(4)
ds_read_b64_tr_b16 a[88:89], v8 offset:49152
v_mfma_f32_16x16x32_bf16 v[136:139], a[96:99], a[24:27], v[136:139]
buffer_load_dword a252, v1, s[60:63], s82 offen
v_mfma_f32_16x16x32_bf16 v[136:139], a[100:103], a[28:31], v[136:139]
ds_read_b64_tr_b16 a[90:91], v8 offset:50176
v_subrev_u32 v4, 0x8000, v4
v_mfma_f32_16x16x32_bf16 v[120:123], a[100:103], a[20:23], v[120:123]
ds_read_b64_tr_b16 a[92:93], v8 offset:57344
v_mfma_f32_16x16x32_bf16 v[120:123], a[96:99], a[16:19], v[120:123]
s_xor_b32 m0, s84, 3072
ds_read_b64_tr_b16 a[94:95], v8 offset:58368
v_mfma_f32_16x16x32_bf16 v[104:107], a[96:99], a[8:11], v[104:107]
s_xor_b32 s64, s70, 25088
ds_read_b128 a[32:35], v2 offset:32768
v_mfma_f32_16x16x32_bf16 v[104:107], a[100:103], a[12:15], v[104:107]
buffer_load_dwordx4 v13, s[32:35], s64 offen lds
v_mfma_f32_16x16x32_bf16 v[88:91], a[100:103], a[4:7], v[88:91]
ds_read_b128 a[36:39], v3 offset:32768
v_mfma_f32_16x16x32_bf16 v[88:91], a[96:99], a[0:3], v[88:91]
ds_read_b128 a[40:43], v2 offset:34816
v_mfma_f32_16x16x32_bf16 v[28:31], a[0:3], a[104:107], v[28:31]
ds_read_b128 a[44:47], v3 offset:34816
v_mfma_f32_16x16x32_bf16 v[28:31], a[4:7], a[108:111], v[28:31]
ds_read_b128 a[48:51], v2 offset:36864
v_subrev_u32 v5, 0x8000, v5
v_mfma_f32_16x16x32_bf16 v[44:47], a[12:15], a[108:111], v[44:47]
s_xor_b32 m0, s84, 4096
ds_read_b128 a[52:55], v3 offset:36864
v_mfma_f32_16x16x32_bf16 v[44:47], a[8:11], a[104:107], v[44:47]
s_xor_b32 s64, s70, 33280
ds_read_b128 a[56:59], v2 offset:38912
v_mfma_f32_16x16x32_bf16 v[60:63], a[16:19], a[104:107], v[60:63]
buffer_load_dwordx4 v12, s[32:35], s64 offen lds
v_mfma_f32_16x16x32_bf16 v[60:63], a[20:23], a[108:111], v[60:63]
ds_read_b128 a[60:63], v3 offset:38912
v_mfma_f32_16x16x32_bf16 v[76:79], a[28:31], a[108:111], v[76:79]
ds_read_b64_tr_b16 a[96:97], v9 offset:49152
v_mfma_f32_16x16x32_bf16 v[76:79], a[24:27], a[104:107], v[76:79]
ds_read_b64_tr_b16 a[98:99], v9 offset:50176
v_mfma_f32_16x16x32_bf16 v[140:143], a[24:27], a[112:115], v[140:143]
ds_read_b64_tr_b16 a[100:101], v9 offset:57344
v_mfma_f32_16x16x32_bf16 v[140:143], a[28:31], a[116:119], v[140:143]
s_xor_b32 m0, s84, 5120
ds_read_b64_tr_b16 a[102:103], v9 offset:58368
v_subrev_u32 v6, 0x8000, v6
v_mfma_f32_16x16x32_bf16 v[124:127], a[20:23], a[116:119], v[124:127]
s_xor_b32 s64, s70, 41472
ds_read_b64_tr_b16 a[104:105], v10 offset:49152
v_mfma_f32_16x16x32_bf16 v[124:127], a[16:19], a[112:115], v[124:127]
buffer_load_dwordx4 v13, s[32:35], s64 offen lds
v_mfma_f32_16x16x32_bf16 v[108:111], a[8:11], a[112:115], v[108:111]
ds_read_b64_tr_b16 a[106:107], v10 offset:50176
v_mfma_f32_16x16x32_bf16 v[108:111], a[12:15], a[116:119], v[108:111]
ds_read_b64_tr_b16 a[108:109], v10 offset:57344
v_mfma_f32_16x16x32_bf16 v[92:95], a[4:7], a[116:119], v[92:95]
ds_read_b64_tr_b16 a[110:111], v10 offset:58368
v_mfma_f32_16x16x32_bf16 v[92:95], a[0:3], a[112:115], v[92:95]
ds_read_b64_tr_b16 a[112:113], v11 offset:49152
v_mfma_f32_16x16x32_bf16 v[32:35], a[0:3], a[72:75], v[32:35]
s_xor_b32 m0, s84, 6144
ds_read_b64_tr_b16 a[114:115], v11 offset:50176
v_mfma_f32_16x16x32_bf16 v[32:35], a[4:7], a[76:79], v[32:35]
s_xor_b32 s64, s70, 49664
ds_read_b64_tr_b16 a[116:117], v11 offset:57344
v_subrev_u32 v7, 0x8000, v7
v_mfma_f32_16x16x32_bf16 v[48:51], a[12:15], a[76:79], v[48:51]
buffer_load_dwordx4 v12, s[32:35], s64 offen lds
v_mfma_f32_16x16x32_bf16 v[48:51], a[8:11], a[72:75], v[48:51]
ds_read_b64_tr_b16 a[118:119], v11 offset:58368
v_mfma_f32_16x16x32_bf16 v[64:67], a[16:19], a[72:75], v[64:67]
v_mfma_f32_16x16x32_bf16 v[64:67], a[20:23], a[76:79], v[64:67]
v_mfma_f32_16x16x32_bf16 v[80:83], a[28:31], a[76:79], v[80:83]
v_mfma_f32_16x16x32_bf16 v[80:83], a[24:27], a[72:75], v[80:83]
s_waitcnt lgkmcnt(5)
s_xor_b32 m0, s84, 7168
s_add_u32 s81, s81, 1048576
v_mfma_f32_16x16x32_bf16 v[144:147], a[24:27], a[80:83], v[144:147]
s_xor_b32 s64, s70, 57856
buffer_load_dword a252, v16, s[56:59], s81 offen
v_mfma_f32_16x16x32_bf16 v[144:147], a[28:31], a[84:87], v[144:147]
buffer_load_dwordx4 v13, s[32:35], s64 offen lds
v_mfma_f32_16x16x32_bf16 v[128:131], a[20:23], a[84:87], v[128:131]
v_subrev_u32 v8, 0x8000, v8
v_mfma_f32_16x16x32_bf16 v[128:131], a[16:19], a[80:83], v[128:131]
v_mfma_f32_16x16x32_bf16 v[112:115], a[8:11], a[80:83], v[112:115]
v_mfma_f32_16x16x32_bf16 v[112:115], a[12:15], a[84:87], v[112:115]
v_mfma_f32_16x16x32_bf16 v[96:99], a[4:7], a[84:87], v[96:99]
v_subrev_u32 v9, 0x8000, v9
v_subrev_u32 v10, 0x8000, v10
v_mfma_f32_16x16x32_bf16 v[96:99], a[0:3], a[80:83], v[96:99]
v_subrev_u32 v11, 0x8000, v11
v_mfma_f32_16x16x32_bf16 v[36:39], a[0:3], a[88:91], v[36:39]
v_mfma_f32_16x16x32_bf16 v[36:39], a[4:7], a[92:95], v[36:39]
v_mfma_f32_16x16x32_bf16 v[52:55], a[12:15], a[92:95], v[52:55]
s_waitcnt lgkmcnt(0)
s_barrier
v_mfma_f32_16x16x32_bf16 v[52:55], a[8:11], a[88:91], v[52:55]
s_xor_b32 m0, s77, 131072
ds_read_b64_tr_b16 a[72:73], v4 offset:0
v_mfma_f32_16x16x32_bf16 v[68:71], a[16:19], a[88:91], v[68:71]
s_xor_b32 s64, s71, 2621440
ds_read_b64_tr_b16 a[74:75], v4 offset:1024
v_mfma_f32_16x16x32_bf16 v[68:71], a[20:23], a[92:95], v[68:71]
buffer_load_dwordx4 v14, s[36:39], s64 offen lds
v_mfma_f32_16x16x32_bf16 v[84:87], a[28:31], a[92:95], v[84:87]
ds_read_b64_tr_b16 a[76:77], v4 offset:8192
v_mfma_f32_16x16x32_bf16 v[84:87], a[24:27], a[88:91], v[84:87]
ds_read_b64_tr_b16 a[78:79], v4 offset:9216
v_mfma_f32_16x16x32_bf16 v[148:151], a[24:27], a[96:99], v[148:151]
ds_read_b64_tr_b16 a[80:81], v5 offset:0
v_mfma_f32_16x16x32_bf16 v[148:151], a[28:31], a[100:103], v[148:151]
ds_read_b64_tr_b16 a[82:83], v5 offset:1024
v_mfma_f32_16x16x32_bf16 v[132:135], a[20:23], a[100:103], v[132:135]
ds_read_b64_tr_b16 a[84:85], v5 offset:8192
v_mfma_f32_16x16x32_bf16 v[132:135], a[16:19], a[96:99], v[132:135]
s_xor_b32 m0, s77, 132096
ds_read_b64_tr_b16 a[86:87], v5 offset:9216
v_mfma_f32_16x16x32_bf16 v[116:119], a[8:11], a[96:99], v[116:119]
s_xor_b32 s64, s71, 2654208
ds_read_b64_tr_b16 a[88:89], v6 offset:0
v_mfma_f32_16x16x32_bf16 v[116:119], a[12:15], a[100:103], v[116:119]
buffer_load_dwordx4 v14, s[36:39], s64 offen lds
v_mfma_f32_16x16x32_bf16 v[100:103], a[4:7], a[100:103], v[100:103]
ds_read_b64_tr_b16 a[90:91], v6 offset:1024
v_mfma_f32_16x16x32_bf16 v[100:103], a[0:3], a[96:99], v[100:103]
ds_read_b64_tr_b16 a[92:93], v6 offset:8192
v_mfma_f32_16x16x32_bf16 v[248:251], a[0:3], a[104:107], v[248:251]
ds_read_b64_tr_b16 a[94:95], v6 offset:9216
v_mfma_f32_16x16x32_bf16 v[248:251], a[4:7], a[108:111], v[248:251]
ds_read_b64_tr_b16 a[96:97], v7 offset:0
v_mfma_f32_16x16x32_bf16 v[252:255], a[12:15], a[108:111], v[252:255]
ds_read_b64_tr_b16 a[98:99], v7 offset:1024
v_mfma_f32_16x16x32_bf16 v[252:255], a[8:11], a[104:107], v[252:255]
s_xor_b32 m0, s77, 133120
ds_read_b64_tr_b16 a[100:101], v7 offset:8192
v_mfma_f32_16x16x32_bf16 a[120:123], a[16:19], a[104:107], a[120:123]
s_xor_b32 s64, s71, 2686976
ds_read_b64_tr_b16 a[102:103], v7 offset:9216
v_mfma_f32_16x16x32_bf16 a[120:123], a[20:23], a[108:111], a[120:123]
buffer_load_dwordx4 v15, s[36:39], s64 offen lds
v_mfma_f32_16x16x32_bf16 a[124:127], a[28:31], a[108:111], a[124:127]
v_mfma_f32_16x16x32_bf16 a[124:127], a[24:27], a[104:107], a[124:127]
s_add_u32 s82, s82, 1048576
ds_read_b64_tr_b16 a[104:105], v8 offset:0
v_mfma_f32_16x16x32_bf16 a[128:131], a[24:27], a[112:115], a[128:131]
buffer_load_dword a252, v1, s[60:63], s82 offen
v_mfma_f32_16x16x32_bf16 a[128:131], a[28:31], a[116:119], a[128:131]
ds_read_b64_tr_b16 a[106:107], v8 offset:1024
v_mfma_f32_16x16x32_bf16 a[132:135], a[20:23], a[116:119], a[132:135]
ds_read_b64_tr_b16 a[108:109], v8 offset:8192
v_mfma_f32_16x16x32_bf16 a[132:135], a[16:19], a[112:115], a[132:135]
s_xor_b32 m0, s77, 134144
ds_read_b64_tr_b16 a[110:111], v8 offset:9216
v_mfma_f32_16x16x32_bf16 a[136:139], a[8:11], a[112:115], a[136:139]
s_xor_b32 s64, s71, 2719744
v_mfma_f32_16x16x32_bf16 a[136:139], a[12:15], a[116:119], a[136:139]
buffer_load_dwordx4 v15, s[36:39], s64 offen lds
v_mfma_f32_16x16x32_bf16 a[140:143], a[4:7], a[116:119], a[140:143]
v_mfma_f32_16x16x32_bf16 a[140:143], a[0:3], a[112:115], a[140:143]
s_waitcnt lgkmcnt(4)
ds_read_b64_tr_b16 a[112:113], v9 offset:0
v_mfma_f32_16x16x32_bf16 v[184:187], a[72:75], a[32:35], v[184:187]
ds_read_b64_tr_b16 a[114:115], v9 offset:1024
v_mov_b32 v17, 0
v_mfma_f32_16x16x32_bf16 v[184:187], a[76:79], a[36:39], v[184:187]
ds_read_b64_tr_b16 a[116:117], v9 offset:8192
v_accvgpr_read_b32 v19, a144
v_mfma_f32_16x16x32_bf16 v[192:195], a[76:79], a[44:47], v[192:195]
ds_read_b64_tr_b16 a[118:119], v9 offset:9216
v_accvgpr_read_b32 v21, a160
v_mfma_f32_16x16x32_bf16 v[192:195], a[72:75], a[40:43], v[192:195]
s_xor_b32 m0, s77, 147456
v_lshlrev_b32 v18, 16, v19
v_and_b32 v19, 0xffff0000, v19
v_mfma_f32_16x16x32_bf16 v[200:203], a[72:75], a[48:51], v[200:203]
s_xor_b32 s64, s71, 2621440
v_lshlrev_b32 v20, 16, v21
v_and_b32 v21, 0xffff0000, v21
v_mfma_f32_16x16x32_bf16 v[200:203], a[76:79], a[52:55], v[200:203]
buffer_load_dwordx4 v14, s[40:43], s64 offen lds
v_mfma_f32_16x16x32_bf16 v[208:211], a[76:79], a[60:63], v[208:211]
v_mul_f32 v18, v18, v20
v_mul_f32 v19, v19, v21
v_mfma_f32_16x16x32_bf16 v[208:211], a[72:75], a[56:59], v[208:211]
ds_read_b64_tr_b16 a[72:73], v10 offset:0
v_cvt_pk_bf16_f32 v18, v18, v19
v_mfma_f32_16x16x32_bf16 v[212:215], a[80:83], a[56:59], v[212:215]
ds_read_b64_tr_b16 a[74:75], v10 offset:1024
v_lshlrev_b32 v19, 16, v18
v_mfma_f32_16x16x32_bf16 v[212:215], a[84:87], a[60:63], v[212:215]
ds_read_b64_tr_b16 a[76:77], v10 offset:8192
v_and_b32 v18, 0xffff0000, v18
v_mfma_f32_16x16x32_bf16 v[204:207], a[84:87], a[52:55], v[204:207]
ds_read_b64_tr_b16 a[78:79], v10 offset:9216
v_add_f32 v17, v17, v19
v_mfma_f32_16x16x32_bf16 v[204:207], a[80:83], a[48:51], v[204:207]
s_xor_b32 m0, s77, 148480
v_add_f32 v17, v17, v18
v_accvgpr_read_b32 v19, a145
v_mfma_f32_16x16x32_bf16 v[196:199], a[80:83], a[40:43], v[196:199]
s_xor_b32 s64, s71, 2654208
v_accvgpr_read_b32 v21, a161
v_lshlrev_b32 v18, 16, v19
v_mfma_f32_16x16x32_bf16 v[196:199], a[84:87], a[44:47], v[196:199]
buffer_load_dwordx4 v14, s[40:43], s64 offen lds
v_mfma_f32_16x16x32_bf16 v[188:191], a[84:87], a[36:39], v[188:191]
v_and_b32 v19, 0xffff0000, v19
v_lshlrev_b32 v20, 16, v21
v_mfma_f32_16x16x32_bf16 v[188:191], a[80:83], a[32:35], v[188:191]
ds_read_b64_tr_b16 a[80:81], v11 offset:0
v_and_b32 v21, 0xffff0000, v21
v_mfma_f32_16x16x32_bf16 v[216:219], a[88:91], a[32:35], v[216:219]
ds_read_b64_tr_b16 a[82:83], v11 offset:1024
v_mul_f32 v18, v18, v20
v_mfma_f32_16x16x32_bf16 v[216:219], a[92:95], a[36:39], v[216:219]
ds_read_b64_tr_b16 a[84:85], v11 offset:8192
v_mul_f32 v19, v19, v21
v_mfma_f32_16x16x32_bf16 v[224:227], a[92:95], a[44:47], v[224:227]
ds_read_b64_tr_b16 a[86:87], v11 offset:9216
v_cvt_pk_bf16_f32 v18, v18, v19
v_mfma_f32_16x16x32_bf16 v[224:227], a[88:91], a[40:43], v[224:227]
s_xor_b32 m0, s77, 149504
v_lshlrev_b32 v19, 16, v18
v_and_b32 v18, 0xffff0000, v18
v_mfma_f32_16x16x32_bf16 v[232:235], a[88:91], a[48:51], v[232:235]
s_xor_b32 s64, s71, 2686976
v_add_f32 v17, v17, v19
v_add_f32 v17, v17, v18
v_mfma_f32_16x16x32_bf16 v[232:235], a[92:95], a[52:55], v[232:235]
buffer_load_dwordx4 v15, s[40:43], s64 offen lds
v_mfma_f32_16x16x32_bf16 v[240:243], a[92:95], a[60:63], v[240:243]
v_accvgpr_read_b32 v19, a146
v_accvgpr_read_b32 v21, a162
v_mfma_f32_16x16x32_bf16 v[240:243], a[88:91], a[56:59], v[240:243]
s_add_u32 s81, s81, 1048576
ds_read_b64_tr_b16 a[88:89], v4 offset:16384
v_lshlrev_b32 v18, 16, v19
v_mfma_f32_16x16x32_bf16 v[244:247], a[96:99], a[56:59], v[244:247]
buffer_load_dword a252, v16, s[56:59], s81 offen
v_mfma_f32_16x16x32_bf16 v[244:247], a[100:103], a[60:63], v[244:247]
ds_read_b64_tr_b16 a[90:91], v4 offset:17408
v_and_b32 v19, 0xffff0000, v19
v_mfma_f32_16x16x32_bf16 v[236:239], a[100:103], a[52:55], v[236:239]
ds_read_b64_tr_b16 a[92:93], v4 offset:24576
v_lshlrev_b32 v20, 16, v21
v_mfma_f32_16x16x32_bf16 v[236:239], a[96:99], a[48:51], v[236:239]
s_xor_b32 m0, s77, 150528
ds_read_b64_tr_b16 a[94:95], v4 offset:25600
v_and_b32 v21, 0xffff0000, v21
v_mfma_f32_16x16x32_bf16 v[228:231], a[96:99], a[40:43], v[228:231]
s_xor_b32 s64, s71, 2719744
v_mul_f32 v18, v18, v20
v_mul_f32 v19, v19, v21
v_mfma_f32_16x16x32_bf16 v[228:231], a[100:103], a[44:47], v[228:231]
buffer_load_dwordx4 v15, s[40:43], s64 offen lds
v_mfma_f32_16x16x32_bf16 v[220:223], a[100:103], a[36:39], v[220:223]
v_cvt_pk_bf16_f32 v18, v18, v19
v_lshlrev_b32 v19, 16, v18
v_mfma_f32_16x16x32_bf16 v[220:223], a[96:99], a[32:35], v[220:223]
s_waitcnt lgkmcnt(4)
ds_read_b64_tr_b16 a[96:97], v5 offset:16384
v_and_b32 v18, 0xffff0000, v18
v_mfma_f32_16x16x32_bf16 v[152:155], a[104:107], a[32:35], v[152:155]
ds_read_b64_tr_b16 a[98:99], v5 offset:17408
v_add_f32 v17, v17, v19
v_mfma_f32_16x16x32_bf16 v[152:155], a[108:111], a[36:39], v[152:155]
ds_read_b64_tr_b16 a[100:101], v5 offset:24576
v_add_f32 v17, v17, v18
v_mfma_f32_16x16x32_bf16 v[160:163], a[108:111], a[44:47], v[160:163]
s_branch L_po3
L_pg3:
s_branch L_tr0
L_po3:
ds_read_b64_tr_b16 a[102:103], v5 offset:25600
v_accvgpr_read_b32 v19, a147
v_mfma_f32_16x16x32_bf16 v[160:163], a[104:107], a[40:43], v[160:163]
v_accvgpr_read_b32 v21, a163
v_lshlrev_b32 v18, 16, v19
v_mfma_f32_16x16x32_bf16 v[168:171], a[104:107], a[48:51], v[168:171]
v_and_b32 v19, 0xffff0000, v19
v_lshlrev_b32 v20, 16, v21
v_mfma_f32_16x16x32_bf16 v[168:171], a[108:111], a[52:55], v[168:171]
v_and_b32 v21, 0xffff0000, v21
v_mul_f32 v18, v18, v20
v_mfma_f32_16x16x32_bf16 v[176:179], a[108:111], a[60:63], v[176:179]
s_xor_b32 m0, s84, 32768
v_mul_f32 v19, v19, v21
v_cvt_pk_bf16_f32 v18, v18, v19
v_mfma_f32_16x16x32_bf16 v[176:179], a[104:107], a[56:59], v[176:179]
s_xor_b32 s64, s70, 640
ds_read_b64_tr_b16 a[104:105], v6 offset:16384
v_lshlrev_b32 v19, 16, v18
v_mfma_f32_16x16x32_bf16 v[180:183], a[112:115], a[56:59], v[180:183]
buffer_load_dwordx4 v12, s[32:35], s64 offen lds
v_mfma_f32_16x16x32_bf16 v[180:183], a[116:119], a[60:63], v[180:183]
ds_read_b64_tr_b16 a[106:107], v6 offset:17408
v_and_b32 v18, 0xffff0000, v18
v_mfma_f32_16x16x32_bf16 v[172:175], a[116:119], a[52:55], v[172:175]
ds_read_b64_tr_b16 a[108:109], v6 offset:24576
v_add_f32 v17, v17, v19
v_mfma_f32_16x16x32_bf16 v[172:175], a[112:115], a[48:51], v[172:175]
ds_read_b64_tr_b16 a[110:111], v6 offset:25600
v_add_f32 v17, v17, v18
v_mfma_f32_16x16x32_bf16 v[164:167], a[112:115], a[40:43], v[164:167]
v_accvgpr_read_b32 v19, a148
v_accvgpr_read_b32 v21, a164
v_mfma_f32_16x16x32_bf16 v[164:167], a[116:119], a[44:47], v[164:167]
s_xor_b32 m0, s84, 33792
v_lshlrev_b32 v18, 16, v19
v_and_b32 v19, 0xffff0000, v19
v_mfma_f32_16x16x32_bf16 v[156:159], a[116:119], a[36:39], v[156:159]
s_xor_b32 s64, s70, 8832
v_lshlrev_b32 v20, 16, v21
v_and_b32 v21, 0xffff0000, v21
v_mfma_f32_16x16x32_bf16 v[156:159], a[112:115], a[32:35], v[156:159]
buffer_load_dwordx4 v13, s[32:35], s64 offen lds
v_mfma_f32_16x16x32_bf16 v[24:27], a[72:75], a[32:35], v[24:27]
ds_read_b64_tr_b16 a[112:113], v7 offset:16384
v_mul_f32 v18, v18, v20
v_mfma_f32_16x16x32_bf16 v[24:27], a[76:79], a[36:39], v[24:27]
ds_read_b64_tr_b16 a[114:115], v7 offset:17408
v_mul_f32 v19, v19, v21
v_mfma_f32_16x16x32_bf16 v[40:43], a[76:79], a[44:47], v[40:43]
ds_read_b64_tr_b16 a[116:117], v7 offset:24576
v_cvt_pk_bf16_f32 v18, v18, v19
v_mfma_f32_16x16x32_bf16 v[40:43], a[72:75], a[40:43], v[40:43]
ds_read_b64_tr_b16 a[118:119], v7 offset:25600
v_lshlrev_b32 v19, 16, v18
v_mfma_f32_16x16x32_bf16 v[56:59], a[72:75], a[48:51], v[56:59]
s_xor_b32 m0, s84, 34816
v_and_b32 v18, 0xffff0000, v18
v_add_f32 v17, v17, v19
v_mfma_f32_16x16x32_bf16 v[56:59], a[76:79], a[52:55], v[56:59]
s_xor_b32 s64, s70, 17024
v_add_f32 v17, v17, v18
v_accvgpr_read_b32 v19, a149
v_mfma_f32_16x16x32_bf16 v[72:75], a[76:79], a[60:63], v[72:75]
s_waitcnt vmcnt(12)
buffer_load_dwordx4 v12, s[32:35], s64 offen lds
v_mfma_f32_16x16x32_bf16 v[72:75], a[72:75], a[56:59], v[72:75]
s_add_u32 s81, s81, 1048576
ds_read_b64_tr_b16 a[72:73], v8 offset:16384
v_accvgpr_read_b32 v21, a165
v_mfma_f32_16x16x32_bf16 v[136:139], a[80:83], a[56:59], v[136:139]
buffer_load_dword a252, v16, s[56:59], s81 offen
v_mfma_f32_16x16x32_bf16 v[136:139], a[84:87], a[60:63], v[136:139]
ds_read_b64_tr_b16 a[74:75], v8 offset:17408
v_lshlrev_b32 v18, 16, v19
v_mfma_f32_16x16x32_bf16 v[120:123], a[84:87], a[52:55], v[120:123]
ds_read_b64_tr_b16 a[76:77], v8 offset:24576
v_and_b32 v19, 0xffff0000, v19
v_mfma_f32_16x16x32_bf16 v[120:123], a[80:83], a[48:51], v[120:123]
s_xor_b32 m0, s84, 35840
ds_read_b64_tr_b16 a[78:79], v8 offset:25600
v_lshlrev_b32 v20, 16, v21
v_mfma_f32_16x16x32_bf16 v[104:107], a[80:83], a[40:43], v[104:107]
s_xor_b32 s64, s70, 25216
ds_read_b128 a[0:3], v2 offset:0
v_and_b32 v21, 0xffff0000, v21
v_mfma_f32_16x16x32_bf16 v[104:107], a[84:87], a[44:47], v[104:107]
buffer_load_dwordx4 v13, s[32:35], s64 offen lds
v_mfma_f32_16x16x32_bf16 v[88:91], a[84:87], a[36:39], v[88:91]
ds_read_b128 a[4:7], v3 offset:0
v_mul_f32 v18, v18, v20
v_mfma_f32_16x16x32_bf16 v[88:91], a[80:83], a[32:35], v[88:91]
s_waitcnt lgkmcnt(6)
ds_read_b128 a[8:11], v2 offset:2048
v_mul_f32 v19, v19, v21
v_mfma_f32_16x16x32_bf16 v[28:31], a[32:35], a[88:91], v[28:31]
ds_read_b128 a[12:15], v3 offset:2048
v_cvt_pk_bf16_f32 v18, v18, v19
v_mfma_f32_16x16x32_bf16 v[28:31], a[36:39], a[92:95], v[28:31]
ds_read_b128 a[16:19], v2 offset:4096
v_lshlrev_b32 v19, 16, v18
v_mfma_f32_16x16x32_bf16 v[44:47], a[44:47], a[92:95], v[44:47]
s_xor_b32 m0, s84, 36864
ds_read_b128 a[20:23], v3 offset:4096
v_and_b32 v18, 0xffff0000, v18
v_mfma_f32_16x16x32_bf16 v[44:47], a[40:43], a[88:91], v[44:47]
s_xor_b32 s64, s70, 33408
ds_read_b128 a[24:27], v2 offset:6144
v_add_f32 v17, v17, v19
v_mfma_f32_16x16x32_bf16 v[60:63], a[48:51], a[88:91], v[60:63]
buffer_load_dwordx4 v12, s[32:35], s64 offen lds
v_mfma_f32_16x16x32_bf16 v[60:63], a[52:55], a[92:95], v[60:63]
ds_read_b128 a[28:31], v3 offset:6144
v_add_f32 v17, v17, v18
v_mfma_f32_16x16x32_bf16 v[76:79], a[60:63], a[92:95], v[76:79]
ds_read_b64_tr_b16 a[80:81], v9 offset:16384
v_accvgpr_read_b32 v19, a150
v_mfma_f32_16x16x32_bf16 v[76:79], a[56:59], a[88:91], v[76:79]
ds_read_b64_tr_b16 a[82:83], v9 offset:17408
v_accvgpr_read_b32 v21, a166
v_mfma_f32_16x16x32_bf16 v[140:143], a[56:59], a[96:99], v[140:143]
ds_read_b64_tr_b16 a[84:85], v9 offset:24576
v_lshlrev_b32 v18, 16, v19
v_mfma_f32_16x16x32_bf16 v[140:143], a[60:63], a[100:103], v[140:143]
s_xor_b32 m0, s84, 37888
ds_read_b64_tr_b16 a[86:87], v9 offset:25600
v_and_b32 v19, 0xffff0000, v19
v_mfma_f32_16x16x32_bf16 v[124:127], a[52:55], a[100:103], v[124:127]
s_xor_b32 s64, s70, 41600
ds_read_b64_tr_b16 a[88:89], v10 offset:16384
v_lshlrev_b32 v20, 16, v21
v_mfma_f32_16x16x32_bf16 v[124:127], a[48:51], a[96:99], v[124:127]
buffer_load_dwordx4 v13, s[32:35], s64 offen lds
v_mfma_f32_16x16x32_bf16 v[108:111], a[40:43], a[96:99], v[108:111]
ds_read_b64_tr_b16 a[90:91], v10 offset:17408
v_and_b32 v21, 0xffff0000, v21
v_mfma_f32_16x16x32_bf16 v[108:111], a[44:47], a[100:103], v[108:111]
ds_read_b64_tr_b16 a[92:93], v10 offset:24576
v_mul_f32 v18, v18, v20
v_mfma_f32_16x16x32_bf16 v[92:95], a[36:39], a[100:103], v[92:95]
ds_read_b64_tr_b16 a[94:95], v10 offset:25600
v_mul_f32 v19, v19, v21
v_mfma_f32_16x16x32_bf16 v[92:95], a[32:35], a[96:99], v[92:95]
ds_read_b64_tr_b16 a[96:97], v11 offset:16384
v_cvt_pk_bf16_f32 v18, v18, v19
v_mfma_f32_16x16x32_bf16 v[32:35], a[32:35], a[104:107], v[32:35]
s_xor_b32 m0, s84, 38912
ds_read_b64_tr_b16 a[98:99], v11 offset:17408
v_lshlrev_b32 v19, 16, v18
v_mfma_f32_16x16x32_bf16 v[32:35], a[36:39], a[108:111], v[32:35]
s_xor_b32 s64, s70, 49792
ds_read_b64_tr_b16 a[100:101], v11 offset:24576
v_and_b32 v18, 0xffff0000, v18
v_mfma_f32_16x16x32_bf16 v[48:51], a[44:47], a[108:111], v[48:51]
buffer_load_dwordx4 v12, s[32:35], s64 offen lds
v_mfma_f32_16x16x32_bf16 v[48:51], a[40:43], a[104:107], v[48:51]
ds_read_b64_tr_b16 a[102:103], v11 offset:25600
v_add_f32 v17, v17, v19
v_mfma_f32_16x16x32_bf16 v[64:67], a[48:51], a[104:107], v[64:67]
v_add_f32 v17, v17, v18
v_accvgpr_read_b32 v19, a151
v_mfma_f32_16x16x32_bf16 v[64:67], a[52:55], a[108:111], v[64:67]
v_accvgpr_read_b32 v21, a167
v_lshlrev_b32 v18, 16, v19
v_mfma_f32_16x16x32_bf16 v[80:83], a[60:63], a[108:111], v[80:83]
s_add_u32 s82, s82, 1048576
v_and_b32 v19, 0xffff0000, v19
v_lshlrev_b32 v20, 16, v21
v_mfma_f32_16x16x32_bf16 v[80:83], a[56:59], a[104:107], v[80:83]
s_xor_b32 m0, s84, 39936
v_and_b32 v21, 0xffff0000, v21
v_mul_f32 v18, v18, v20
v_mfma_f32_16x16x32_bf16 v[144:147], a[56:59], a[112:115], v[144:147]
s_xor_b32 s64, s70, 57984
buffer_load_dword a252, v1, s[60:63], s82 offen
v_mfma_f32_16x16x32_bf16 v[144:147], a[60:63], a[116:119], v[144:147]
buffer_load_dwordx4 v13, s[32:35], s64 offen lds
v_mfma_f32_16x16x32_bf16 v[128:131], a[52:55], a[116:119], v[128:131]
v_mul_f32 v19, v19, v21
v_cvt_pk_bf16_f32 v18, v18, v19
v_mfma_f32_16x16x32_bf16 v[128:131], a[48:51], a[112:115], v[128:131]
v_lshlrev_b32 v19, 16, v18
v_and_b32 v18, 0xffff0000, v18
v_mfma_f32_16x16x32_bf16 v[112:115], a[40:43], a[112:115], v[112:115]
v_add_f32 v17, v17, v19
v_add_f32 v17, v17, v18
v_mfma_f32_16x16x32_bf16 v[112:115], a[44:47], a[116:119], v[112:115]
v_accvgpr_read_b32 v19, a152
v_accvgpr_read_b32 v21, a168
v_mfma_f32_16x16x32_bf16 v[96:99], a[36:39], a[116:119], v[96:99]
v_lshlrev_b32 v18, 16, v19
v_and_b32 v19, 0xffff0000, v19
v_mfma_f32_16x16x32_bf16 v[96:99], a[32:35], a[112:115], v[96:99]
s_waitcnt lgkmcnt(0)
v_lshlrev_b32 v20, 16, v21
v_and_b32 v21, 0xffff0000, v21
v_mfma_f32_16x16x32_bf16 v[36:39], a[32:35], a[72:75], v[36:39]
v_mul_f32 v18, v18, v20
v_mul_f32 v19, v19, v21
v_mfma_f32_16x16x32_bf16 v[36:39], a[36:39], a[76:79], v[36:39]
v_cvt_pk_bf16_f32 v18, v18, v19
v_lshlrev_b32 v19, 16, v18
v_mfma_f32_16x16x32_bf16 v[52:55], a[44:47], a[76:79], v[52:55]
s_waitcnt lgkmcnt(0)
s_barrier
v_mfma_f32_16x16x32_bf16 v[52:55], a[40:43], a[72:75], v[52:55]
s_xor_b32 m0, s77, 65536
ds_read_b64_tr_b16 a[104:105], v4 offset:32768
v_and_b32 v18, 0xffff0000, v18
v_mfma_f32_16x16x32_bf16 v[68:71], a[48:51], a[72:75], v[68:71]
s_xor_b32 s64, s71, 3145728
ds_read_b64_tr_b16 a[106:107], v4 offset:33792
v_add_f32 v17, v17, v19
v_mfma_f32_16x16x32_bf16 v[68:71], a[52:55], a[76:79], v[68:71]
buffer_load_dwordx4 v14, s[36:39], s64 offen lds
v_mfma_f32_16x16x32_bf16 v[84:87], a[60:63], a[76:79], v[84:87]
ds_read_b64_tr_b16 a[108:109], v4 offset:40960
v_add_f32 v17, v17, v18
v_mfma_f32_16x16x32_bf16 v[84:87], a[56:59], a[72:75], v[84:87]
ds_read_b64_tr_b16 a[110:111], v4 offset:41984
v_accvgpr_read_b32 v19, a153
v_mfma_f32_16x16x32_bf16 v[148:151], a[56:59], a[80:83], v[148:151]
ds_read_b64_tr_b16 a[112:113], v5 offset:32768
v_accvgpr_read_b32 v21, a169
v_mfma_f32_16x16x32_bf16 v[148:151], a[60:63], a[84:87], v[148:151]
ds_read_b64_tr_b16 a[114:115], v5 offset:33792
v_lshlrev_b32 v18, 16, v19
v_mfma_f32_16x16x32_bf16 v[132:135], a[52:55], a[84:87], v[132:135]
ds_read_b64_tr_b16 a[116:117], v5 offset:40960
v_and_b32 v19, 0xffff0000, v19
v_mfma_f32_16x16x32_bf16 v[132:135], a[48:51], a[80:83], v[132:135]
s_xor_b32 m0, s77, 66560
ds_read_b64_tr_b16 a[118:119], v5 offset:41984
v_lshlrev_b32 v20, 16, v21
v_mfma_f32_16x16x32_bf16 v[116:119], a[40:43], a[80:83], v[116:119]
s_xor_b32 s64, s71, 3178496
ds_read_b64_tr_b16 a[72:73], v6 offset:32768
v_and_b32 v21, 0xffff0000, v21
v_mfma_f32_16x16x32_bf16 v[116:119], a[44:47], a[84:87], v[116:119]
buffer_load_dwordx4 v14, s[36:39], s64 offen lds
v_mfma_f32_16x16x32_bf16 v[100:103], a[36:39], a[84:87], v[100:103]
ds_read_b64_tr_b16 a[74:75], v6 offset:33792
v_mul_f32 v18, v18, v20
v_mfma_f32_16x16x32_bf16 v[100:103], a[32:35], a[80:83], v[100:103]
ds_read_b64_tr_b16 a[76:77], v6 offset:40960
v_mul_f32 v19, v19, v21
v_mfma_f32_16x16x32_bf16 v[248:251], a[32:35], a[88:91], v[248:251]
ds_read_b64_tr_b16 a[78:79], v6 offset:41984
v_cvt_pk_bf16_f32 v18, v18, v19
v_mfma_f32_16x16x32_bf16 v[248:251], a[36:39], a[92:95], v[248:251]
ds_read_b64_tr_b16 a[80:81], v7 offset:32768
v_lshlrev_b32 v19, 16, v18
v_mfma_f32_16x16x32_bf16 v[252:255], a[44:47], a[92:95], v[252:255]
ds_read_b64_tr_b16 a[82:83], v7 offset:33792
v_and_b32 v18, 0xffff0000, v18
v_mfma_f32_16x16x32_bf16 v[252:255], a[40:43], a[88:91], v[252:255]
s_xor_b32 m0, s77, 67584
ds_read_b64_tr_b16 a[84:85], v7 offset:40960
v_add_f32 v17, v17, v19
v_mfma_f32_16x16x32_bf16 a[120:123], a[48:51], a[88:91], a[120:123]
s_xor_b32 s64, s71, 3211264
ds_read_b64_tr_b16 a[86:87], v7 offset:41984
v_add_f32 v17, v17, v18
v_mfma_f32_16x16x32_bf16 a[120:123], a[52:55], a[92:95], a[120:123]
buffer_load_dwordx4 v15, s[36:39], s64 offen lds
v_mfma_f32_16x16x32_bf16 a[124:127], a[60:63], a[92:95], a[124:127]
v_accvgpr_read_b32 v19, a154
v_accvgpr_read_b32 v21, a170
v_mfma_f32_16x16x32_bf16 a[124:127], a[56:59], a[88:91], a[124:127]
s_add_u32 s81, s81, 1048576
ds_read_b64_tr_b16 a[88:89], v8 offset:32768
v_lshlrev_b32 v18, 16, v19
v_mfma_f32_16x16x32_bf16 a[128:131], a[56:59], a[96:99], a[128:131]
buffer_load_dword a252, v16, s[56:59], s81 offen
v_mfma_f32_16x16x32_bf16 a[128:131], a[60:63], a[100:103], a[128:131]
ds_read_b64_tr_b16 a[90:91], v8 offset:33792
v_and_b32 v19, 0xffff0000, v19
v_mfma_f32_16x16x32_bf16 a[132:135], a[52:55], a[100:103], a[132:135]
ds_read_b64_tr_b16 a[92:93], v8 offset:40960
v_lshlrev_b32 v20, 16, v21
v_mfma_f32_16x16x32_bf16 a[132:135], a[48:51], a[96:99], a[132:135]
s_xor_b32 m0, s77, 68608
ds_read_b64_tr_b16 a[94:95], v8 offset:41984
v_and_b32 v21, 0xffff0000, v21
v_mfma_f32_16x16x32_bf16 a[136:139], a[40:43], a[96:99], a[136:139]
s_xor_b32 s64, s71, 3244032
v_mul_f32 v18, v18, v20
v_mul_f32 v19, v19, v21
v_mfma_f32_16x16x32_bf16 a[136:139], a[44:47], a[100:103], a[136:139]
buffer_load_dwordx4 v15, s[36:39], s64 offen lds
v_mfma_f32_16x16x32_bf16 a[140:143], a[36:39], a[100:103], a[140:143]
v_cvt_pk_bf16_f32 v18, v18, v19
v_lshlrev_b32 v19, 16, v18
v_mfma_f32_16x16x32_bf16 a[140:143], a[32:35], a[96:99], a[140:143]
s_waitcnt lgkmcnt(4)
ds_read_b64_tr_b16 a[96:97], v9 offset:32768
v_and_b32 v18, 0xffff0000, v18
v_mfma_f32_16x16x32_bf16 v[184:187], a[104:107], a[0:3], v[184:187]
ds_read_b64_tr_b16 a[98:99], v9 offset:33792
v_add_f32 v17, v17, v19
v_mfma_f32_16x16x32_bf16 v[184:187], a[108:111], a[4:7], v[184:187]
ds_read_b64_tr_b16 a[100:101], v9 offset:40960
v_add_f32 v17, v17, v18
v_mfma_f32_16x16x32_bf16 v[192:195], a[108:111], a[12:15], v[192:195]
ds_read_b64_tr_b16 a[102:103], v9 offset:41984
v_accvgpr_read_b32 v19, a155
v_mfma_f32_16x16x32_bf16 v[192:195], a[104:107], a[8:11], v[192:195]
s_xor_b32 m0, s77, 81920
v_accvgpr_read_b32 v21, a171
v_lshlrev_b32 v18, 16, v19
v_mfma_f32_16x16x32_bf16 v[200:203], a[104:107], a[16:19], v[200:203]
s_xor_b32 s64, s71, 3145728
v_and_b32 v19, 0xffff0000, v19
v_lshlrev_b32 v20, 16, v21
v_mfma_f32_16x16x32_bf16 v[200:203], a[108:111], a[20:23], v[200:203]
buffer_load_dwordx4 v14, s[40:43], s64 offen lds
v_mfma_f32_16x16x32_bf16 v[208:211], a[108:111], a[28:31], v[208:211]
v_and_b32 v21, 0xffff0000, v21
v_mul_f32 v18, v18, v20
v_mfma_f32_16x16x32_bf16 v[208:211], a[104:107], a[24:27], v[208:211]
ds_read_b64_tr_b16 a[104:105], v10 offset:32768
v_mul_f32 v19, v19, v21
v_mfma_f32_16x16x32_bf16 v[212:215], a[112:115], a[24:27], v[212:215]
ds_read_b64_tr_b16 a[106:107], v10 offset:33792
v_cvt_pk_bf16_f32 v18, v18, v19
v_mfma_f32_16x16x32_bf16 v[212:215], a[116:119], a[28:31], v[212:215]
ds_read_b64_tr_b16 a[108:109], v10 offset:40960
v_lshlrev_b32 v19, 16, v18
v_mfma_f32_16x16x32_bf16 v[204:207], a[116:119], a[20:23], v[204:207]
ds_read_b64_tr_b16 a[110:111], v10 offset:41984
v_and_b32 v18, 0xffff0000, v18
v_mfma_f32_16x16x32_bf16 v[204:207], a[112:115], a[16:19], v[204:207]
s_xor_b32 m0, s77, 82944
v_add_f32 v17, v17, v19
v_add_f32 v17, v17, v18
v_mfma_f32_16x16x32_bf16 v[196:199], a[112:115], a[8:11], v[196:199]
s_xor_b32 s64, s71, 3178496
v_accvgpr_read_b32 v19, a156
v_accvgpr_read_b32 v21, a172
v_mfma_f32_16x16x32_bf16 v[196:199], a[116:119], a[12:15], v[196:199]
buffer_load_dwordx4 v14, s[40:43], s64 offen lds
v_mfma_f32_16x16x32_bf16 v[188:191], a[116:119], a[4:7], v[188:191]
v_lshlrev_b32 v18, 16, v19
v_and_b32 v19, 0xffff0000, v19
v_mfma_f32_16x16x32_bf16 v[188:191], a[112:115], a[0:3], v[188:191]
ds_read_b64_tr_b16 a[112:113], v11 offset:32768
v_lshlrev_b32 v20, 16, v21
v_mfma_f32_16x16x32_bf16 v[216:219], a[72:75], a[0:3], v[216:219]
ds_read_b64_tr_b16 a[114:115], v11 offset:33792
v_and_b32 v21, 0xffff0000, v21
v_mfma_f32_16x16x32_bf16 v[216:219], a[76:79], a[4:7], v[216:219]
ds_read_b64_tr_b16 a[116:117], v11 offset:40960
v_mul_f32 v18, v18, v20
v_mfma_f32_16x16x32_bf16 v[224:227], a[76:79], a[12:15], v[224:227]
ds_read_b64_tr_b16 a[118:119], v11 offset:41984
v_mul_f32 v19, v19, v21
v_mfma_f32_16x16x32_bf16 v[224:227], a[72:75], a[8:11], v[224:227]
s_xor_b32 m0, s77, 83968
v_cvt_pk_bf16_f32 v18, v18, v19
v_lshlrev_b32 v19, 16, v18
v_mfma_f32_16x16x32_bf16 v[232:235], a[72:75], a[16:19], v[232:235]
s_xor_b32 s64, s71, 3211264
v_and_b32 v18, 0xffff0000, v18
v_add_f32 v17, v17, v19
v_mfma_f32_16x16x32_bf16 v[232:235], a[76:79], a[20:23], v[232:235]
buffer_load_dwordx4 v15, s[40:43], s64 offen lds
v_mfma_f32_16x16x32_bf16 v[240:243], a[76:79], a[28:31], v[240:243]
v_add_f32 v17, v17, v18
v_accvgpr_read_b32 v19, a157
v_mfma_f32_16x16x32_bf16 v[240:243], a[72:75], a[24:27], v[240:243]
s_add_u32 s82, s82, 1048576
ds_read_b64_tr_b16 a[72:73], v4 offset:49152
v_accvgpr_read_b32 v21, a173
v_mfma_f32_16x16x32_bf16 v[244:247], a[80:83], a[24:27], v[244:247]
buffer_load_dword a252, v1, s[60:63], s82 offen
v_mfma_f32_16x16x32_bf16 v[244:247], a[84:87], a[28:31], v[244:247]
ds_read_b64_tr_b16 a[74:75], v4 offset:50176
v_lshlrev_b32 v18, 16, v19
v_mfma_f32_16x16x32_bf16 v[236:239], a[84:87], a[20:23], v[236:239]
ds_read_b64_tr_b16 a[76:77], v4 offset:57344
v_and_b32 v19, 0xffff0000, v19
v_mfma_f32_16x16x32_bf16 v[236:239], a[80:83], a[16:19], v[236:239]
s_xor_b32 m0, s77, 84992
ds_read_b64_tr_b16 a[78:79], v4 offset:58368
v_lshlrev_b32 v20, 16, v21
v_mfma_f32_16x16x32_bf16 v[228:231], a[80:83], a[8:11], v[228:231]
s_xor_b32 s64, s71, 3244032
v_and_b32 v21, 0xffff0000, v21
v_mul_f32 v18, v18, v20
v_mfma_f32_16x16x32_bf16 v[228:231], a[84:87], a[12:15], v[228:231]
buffer_load_dwordx4 v15, s[40:43], s64 offen lds
v_mfma_f32_16x16x32_bf16 v[220:223], a[84:87], a[4:7], v[220:223]
v_mul_f32 v19, v19, v21
v_cvt_pk_bf16_f32 v18, v18, v19
v_mfma_f32_16x16x32_bf16 v[220:223], a[80:83], a[0:3], v[220:223]
s_waitcnt lgkmcnt(4)
ds_read_b64_tr_b16 a[80:81], v5 offset:49152
v_lshlrev_b32 v19, 16, v18
v_mfma_f32_16x16x32_bf16 v[152:155], a[88:91], a[0:3], v[152:155]
ds_read_b64_tr_b16 a[82:83], v5 offset:50176
v_and_b32 v18, 0xffff0000, v18
v_mfma_f32_16x16x32_bf16 v[152:155], a[92:95], a[4:7], v[152:155]
ds_read_b64_tr_b16 a[84:85], v5 offset:57344
v_add_f32 v17, v17, v19
v_mfma_f32_16x16x32_bf16 v[160:163], a[92:95], a[12:15], v[160:163]
ds_read_b64_tr_b16 a[86:87], v5 offset:58368
v_add_f32 v17, v17, v18
v_mfma_f32_16x16x32_bf16 v[160:163], a[88:91], a[8:11], v[160:163]
v_accvgpr_read_b32 v19, a158
v_accvgpr_read_b32 v21, a174
v_mfma_f32_16x16x32_bf16 v[168:171], a[88:91], a[16:19], v[168:171]
v_lshlrev_b32 v18, 16, v19
v_and_b32 v19, 0xffff0000, v19
v_mfma_f32_16x16x32_bf16 v[168:171], a[92:95], a[20:23], v[168:171]
v_lshlrev_b32 v20, 16, v21
v_and_b32 v21, 0xffff0000, v21
v_mfma_f32_16x16x32_bf16 v[176:179], a[92:95], a[28:31], v[176:179]
s_xor_b32 m0, s84, 0
v_mul_f32 v18, v18, v20
v_mul_f32 v19, v19, v21
v_mfma_f32_16x16x32_bf16 v[176:179], a[88:91], a[24:27], v[176:179]
s_xor_b32 s64, s70, 768
ds_read_b64_tr_b16 a[88:89], v6 offset:49152
v_cvt_pk_bf16_f32 v18, v18, v19
v_mfma_f32_16x16x32_bf16 v[180:183], a[96:99], a[24:27], v[180:183]
buffer_load_dwordx4 v12, s[32:35], s64 offen lds
v_mfma_f32_16x16x32_bf16 v[180:183], a[100:103], a[28:31], v[180:183]
ds_read_b64_tr_b16 a[90:91], v6 offset:50176
v_lshlrev_b32 v19, 16, v18
v_mfma_f32_16x16x32_bf16 v[172:175], a[100:103], a[20:23], v[172:175]
ds_read_b64_tr_b16 a[92:93], v6 offset:57344
v_and_b32 v18, 0xffff0000, v18
v_mfma_f32_16x16x32_bf16 v[172:175], a[96:99], a[16:19], v[172:175]
ds_read_b64_tr_b16 a[94:95], v6 offset:58368
v_add_f32 v17, v17, v19
v_mfma_f32_16x16x32_bf16 v[164:167], a[96:99], a[8:11], v[164:167]
v_add_f32 v17, v17, v18
v_accvgpr_read_b32 v19, a159
v_mfma_f32_16x16x32_bf16 v[164:167], a[100:103], a[12:15], v[164:167]
s_xor_b32 m0, s84, 1024
v_accvgpr_read_b32 v21, a175
v_lshlrev_b32 v18, 16, v19
v_mfma_f32_16x16x32_bf16 v[156:159], a[100:103], a[4:7], v[156:159]
s_xor_b32 s64, s70, 8960
v_and_b32 v19, 0xffff0000, v19
v_lshlrev_b32 v20, 16, v21
v_mfma_f32_16x16x32_bf16 v[156:159], a[96:99], a[0:3], v[156:159]
buffer_load_dwordx4 v13, s[32:35], s64 offen lds
v_mfma_f32_16x16x32_bf16 v[24:27], a[104:107], a[0:3], v[24:27]
ds_read_b64_tr_b16 a[96:97], v7 offset:49152
v_and_b32 v21, 0xffff0000, v21
v_mfma_f32_16x16x32_bf16 v[24:27], a[108:111], a[4:7], v[24:27]
ds_read_b64_tr_b16 a[98:99], v7 offset:50176
v_mul_f32 v18, v18, v20
v_mfma_f32_16x16x32_bf16 v[40:43], a[108:111], a[12:15], v[40:43]
ds_read_b64_tr_b16 a[100:101], v7 offset:57344
v_mul_f32 v19, v19, v21
v_mfma_f32_16x16x32_bf16 v[40:43], a[104:107], a[8:11], v[40:43]
ds_read_b64_tr_b16 a[102:103], v7 offset:58368
v_cvt_pk_bf16_f32 v18, v18, v19
v_mfma_f32_16x16x32_bf16 v[56:59], a[104:107], a[16:19], v[56:59]
s_xor_b32 m0, s84, 2048
v_lshlrev_b32 v19, 16, v18
v_and_b32 v18, 0xffff0000, v18
v_mfma_f32_16x16x32_bf16 v[56:59], a[108:111], a[20:23], v[56:59]
s_xor_b32 s64, s70, 17152
v_add_f32 v17, v17, v19
v_add_f32 v17, v17, v18
v_mfma_f32_16x16x32_bf16 v[72:75], a[108:111], a[28:31], v[72:75]
s_waitcnt vmcnt(12)
buffer_load_dwordx4 v12, s[32:35], s64 offen lds
v_mfma_f32_16x16x32_bf16 v[72:75], a[104:107], a[24:27], v[72:75]
s_add_u32 s81, s81, 1048576
ds_read_b64_tr_b16 a[104:105], v8 offset:49152
v_add_f32_dpp v17, v17, v17 row_ror:8 row_mask:0xf bank_mask:0xf
v_mfma_f32_16x16x32_bf16 v[136:139], a[112:115], a[24:27], v[136:139]
buffer_load_dword a252, v16, s[56:59], s81 offen
v_mfma_f32_16x16x32_bf16 v[136:139], a[116:119], a[28:31], v[136:139]
ds_read_b64_tr_b16 a[106:107], v8 offset:50176
v_add_u32 v4, 0x8000, v4
v_mfma_f32_16x16x32_bf16 v[120:123], a[116:119], a[20:23], v[120:123]
ds_read_b64_tr_b16 a[108:109], v8 offset:57344
v_add_f32_dpp v17, v17, v17 row_ror:4 row_mask:0xf bank_mask:0xf
v_mfma_f32_16x16x32_bf16 v[120:123], a[112:115], a[16:19], v[120:123]
s_xor_b32 m0, s84, 3072
ds_read_b64_tr_b16 a[110:111], v8 offset:58368
v_mfma_f32_16x16x32_bf16 v[104:107], a[112:115], a[8:11], v[104:107]
s_xor_b32 s64, s70, 25344
ds_read_b128 a[32:35], v2 offset:32768
v_add_f32_dpp v17, v17, v17 row_ror:2 row_mask:0xf bank_mask:0xf
v_mfma_f32_16x16x32_bf16 v[104:107], a[116:119], a[12:15], v[104:107]
buffer_load_dwordx4 v13, s[32:35], s64 offen lds
v_mfma_f32_16x16x32_bf16 v[88:91], a[116:119], a[4:7], v[88:91]
ds_read_b128 a[36:39], v3 offset:32768
v_add_f32_dpp v17, v17, v17 row_ror:1 row_mask:0xf bank_mask:0xf
v_mfma_f32_16x16x32_bf16 v[88:91], a[112:115], a[0:3], v[88:91]
s_waitcnt lgkmcnt(6)
ds_read_b128 a[40:43], v2 offset:34816
v_mov_b32 v18, v17
v_mfma_f32_16x16x32_bf16 v[28:31], a[0:3], a[72:75], v[28:31]
ds_read_b128 a[44:47], v3 offset:34816
v_mfma_f32_16x16x32_bf16 v[28:31], a[4:7], a[76:79], v[28:31]
ds_read_b128 a[48:51], v2 offset:36864
v_add_u32 v5, 0x8000, v5
v_mfma_f32_16x16x32_bf16 v[44:47], a[12:15], a[76:79], v[44:47]
s_xor_b32 m0, s84, 4096
ds_read_b128 a[52:55], v3 offset:36864
v_permlane16_swap_b32 v18, v17
v_mfma_f32_16x16x32_bf16 v[44:47], a[8:11], a[72:75], v[44:47]
s_xor_b32 s64, s70, 33536
ds_read_b128 a[56:59], v2 offset:38912
v_add_f32 v17, v17, v18
v_mfma_f32_16x16x32_bf16 v[60:63], a[16:19], a[72:75], v[60:63]
buffer_load_dwordx4 v12, s[32:35], s64 offen lds
v_mfma_f32_16x16x32_bf16 v[60:63], a[20:23], a[76:79], v[60:63]
ds_read_b128 a[60:63], v3 offset:38912
v_cvt_pk_bf16_f32 v17, v17, v17
v_mfma_f32_16x16x32_bf16 v[76:79], a[28:31], a[76:79], v[76:79]
ds_read_b64_tr_b16 a[112:113], v9 offset:49152
v_and_b32 v17, 0xffff0000, v17
v_mfma_f32_16x16x32_bf16 v[76:79], a[24:27], a[72:75], v[76:79]
ds_read_b64_tr_b16 a[114:115], v9 offset:50176
v_mul_f32 v17, 0xbfb8aa3b, v17
v_mfma_f32_16x16x32_bf16 v[140:143], a[24:27], a[80:83], v[140:143]
ds_read_b64_tr_b16 a[116:117], v9 offset:57344
v_mfma_f32_16x16x32_bf16 v[140:143], a[28:31], a[84:87], v[140:143]
s_xor_b32 m0, s84, 5120
ds_read_b64_tr_b16 a[118:119], v9 offset:58368
v_add_u32 v6, 0x8000, v6
v_mfma_f32_16x16x32_bf16 v[124:127], a[20:23], a[84:87], v[124:127]
s_xor_b32 s64, s70, 41728
ds_read_b64_tr_b16 a[72:73], v10 offset:49152
v_mfma_f32_16x16x32_bf16 v[124:127], a[16:19], a[80:83], v[124:127]
buffer_load_dwordx4 v13, s[32:35], s64 offen lds
v_mfma_f32_16x16x32_bf16 v[108:111], a[8:11], a[80:83], v[108:111]
ds_read_b64_tr_b16 a[74:75], v10 offset:50176
v_mfma_f32_16x16x32_bf16 v[108:111], a[12:15], a[84:87], v[108:111]
ds_read_b64_tr_b16 a[76:77], v10 offset:57344
v_mfma_f32_16x16x32_bf16 v[92:95], a[4:7], a[84:87], v[92:95]
ds_read_b64_tr_b16 a[78:79], v10 offset:58368
v_mfma_f32_16x16x32_bf16 v[92:95], a[0:3], a[80:83], v[92:95]
ds_read_b64_tr_b16 a[80:81], v11 offset:49152
v_mfma_f32_16x16x32_bf16 v[32:35], a[0:3], a[88:91], v[32:35]
s_xor_b32 m0, s84, 6144
ds_read_b64_tr_b16 a[82:83], v11 offset:50176
v_mfma_f32_16x16x32_bf16 v[32:35], a[4:7], a[92:95], v[32:35]
s_xor_b32 s64, s70, 49920
ds_read_b64_tr_b16 a[84:85], v11 offset:57344
v_add_u32 v7, 0x8000, v7
v_mfma_f32_16x16x32_bf16 v[48:51], a[12:15], a[92:95], v[48:51]
buffer_load_dwordx4 v12, s[32:35], s64 offen lds
v_mfma_f32_16x16x32_bf16 v[48:51], a[8:11], a[88:91], v[48:51]
ds_read_b64_tr_b16 a[86:87], v11 offset:58368
v_mfma_f32_16x16x32_bf16 v[64:67], a[16:19], a[88:91], v[64:67]
v_exp_f32 v17, v17
v_mfma_f32_16x16x32_bf16 v[64:67], a[20:23], a[92:95], v[64:67]
v_add_f32 v17, 1.0, v17
v_mfma_f32_16x16x32_bf16 v[80:83], a[28:31], a[92:95], v[80:83]
v_rcp_f32 v17, v17
v_mfma_f32_16x16x32_bf16 v[80:83], a[24:27], a[88:91], v[80:83]
s_xor_b32 m0, s84, 7168
s_add_u32 s81, s81, 1048576
v_cvt_pk_bf16_f32 v18, v17, v17
v_mfma_f32_16x16x32_bf16 v[144:147], a[24:27], a[96:99], v[144:147]
s_xor_b32 s64, s70, 58112
buffer_load_dword a252, v16, s[56:59], s81 offen
v_mfma_f32_16x16x32_bf16 v[144:147], a[28:31], a[100:103], v[144:147]
s_branch L_po4
L_pg4:
s_branch L_tr0
L_po4:
buffer_load_dwordx4 v13, s[32:35], s64 offen lds
v_mfma_f32_16x16x32_bf16 v[128:131], a[20:23], a[100:103], v[128:131]
v_add_u32 v8, 0x8000, v8
v_and_b32 v18, 0xffff0000, v18
v_mfma_f32_16x16x32_bf16 v[128:131], a[16:19], a[96:99], v[128:131]
v_sub_f32 v19, 1.0, v18
v_mfma_f32_16x16x32_bf16 v[112:115], a[8:11], a[96:99], v[112:115]
v_cvt_pk_bf16_f32 v19, v19, v19
v_mfma_f32_16x16x32_bf16 v[112:115], a[12:15], a[100:103], v[112:115]
v_and_b32 v19, 0xffff0000, v19
v_mfma_f32_16x16x32_bf16 v[96:99], a[4:7], a[100:103], v[96:99]
v_add_u32 v9, 0x8000, v9
v_add_u32 v10, 0x8000, v10
v_mfma_f32_16x16x32_bf16 v[96:99], a[0:3], a[96:99], v[96:99]
s_waitcnt lgkmcnt(0)
v_add_u32 v11, 0x8000, v11
v_and_b32 v20, 31, v0
v_mfma_f32_16x16x32_bf16 v[36:39], a[0:3], a[104:107], v[36:39]
v_lshlrev_b32 v20, 27, v20
v_mfma_f32_16x16x32_bf16 v[36:39], a[4:7], a[108:111], v[36:39]
v_lshrrev_b32 v21, 2, v0
v_mfma_f32_16x16x32_bf16 v[52:55], a[12:15], a[108:111], v[52:55]
s_waitcnt lgkmcnt(0)
s_barrier
v_mfma_f32_16x16x32_bf16 v[52:55], a[8:11], a[104:107], v[52:55]
s_xor_b32 m0, s77, 98304
ds_read_b64_tr_b16 a[88:89], v4 offset:32768
v_add_u32 v20, v20, v21
v_mfma_f32_16x16x32_bf16 v[68:71], a[16:19], a[104:107], v[68:71]
s_xor_b32 s64, s71, 3670016
ds_read_b64_tr_b16 a[90:91], v4 offset:33792
v_mfma_f32_16x16x32_bf16 v[68:71], a[20:23], a[108:111], v[68:71]
buffer_load_dwordx4 v14, s[36:39], s64 offen lds
v_mfma_f32_16x16x32_bf16 v[84:87], a[28:31], a[108:111], v[84:87]
ds_read_b64_tr_b16 a[92:93], v4 offset:40960
v_mfma_f32_16x16x32_bf16 v[84:87], a[24:27], a[104:107], v[84:87]
ds_read_b64_tr_b16 a[94:95], v4 offset:41984
v_mfma_f32_16x16x32_bf16 v[148:151], a[24:27], a[112:115], v[148:151]
ds_read_b64_tr_b16 a[96:97], v5 offset:32768
v_mfma_f32_16x16x32_bf16 v[148:151], a[28:31], a[116:119], v[148:151]
ds_read_b64_tr_b16 a[98:99], v5 offset:33792
v_mfma_f32_16x16x32_bf16 v[132:135], a[20:23], a[116:119], v[132:135]
ds_read_b64_tr_b16 a[100:101], v5 offset:40960
v_mfma_f32_16x16x32_bf16 v[132:135], a[16:19], a[112:115], v[132:135]
s_xor_b32 m0, s77, 99328
ds_read_b64_tr_b16 a[102:103], v5 offset:41984
v_mfma_f32_16x16x32_bf16 v[116:119], a[8:11], a[112:115], v[116:119]
s_xor_b32 s64, s71, 3702784
ds_read_b64_tr_b16 a[104:105], v6 offset:32768
v_mfma_f32_16x16x32_bf16 v[116:119], a[12:15], a[116:119], v[116:119]
buffer_load_dwordx4 v14, s[36:39], s64 offen lds
v_mfma_f32_16x16x32_bf16 v[100:103], a[4:7], a[116:119], v[100:103]
ds_read_b64_tr_b16 a[106:107], v6 offset:33792
v_mfma_f32_16x16x32_bf16 v[100:103], a[0:3], a[112:115], v[100:103]
ds_read_b64_tr_b16 a[108:109], v6 offset:40960
v_mfma_f32_16x16x32_bf16 v[248:251], a[0:3], a[72:75], v[248:251]
ds_read_b64_tr_b16 a[110:111], v6 offset:41984
v_mfma_f32_16x16x32_bf16 v[248:251], a[4:7], a[76:79], v[248:251]
ds_read_b64_tr_b16 a[112:113], v7 offset:32768
v_mfma_f32_16x16x32_bf16 v[252:255], a[12:15], a[76:79], v[252:255]
ds_read_b64_tr_b16 a[114:115], v7 offset:33792
v_mfma_f32_16x16x32_bf16 v[252:255], a[8:11], a[72:75], v[252:255]
s_xor_b32 m0, s77, 100352
ds_read_b64_tr_b16 a[116:117], v7 offset:40960
v_mfma_f32_16x16x32_bf16 a[120:123], a[16:19], a[72:75], a[120:123]
s_xor_b32 s64, s71, 3735552
s_lshl2_add_u32 s65, s2, s30
ds_read_b64_tr_b16 a[118:119], v7 offset:41984
v_mfma_f32_16x16x32_bf16 a[120:123], a[20:23], a[76:79], a[120:123]
s_lshl4_add_u32 s65, s65, 58720256
buffer_load_dwordx4 v15, s[36:39], s64 offen lds
v_mfma_f32_16x16x32_bf16 a[124:127], a[28:31], a[76:79], a[124:127]
buffer_store_dwordx2 v[18:19], v20, s[44:47], s65 offen sc1
v_mfma_f32_16x16x32_bf16 a[124:127], a[24:27], a[72:75], a[124:127]
s_add_u32 s82, s82, 1048576
ds_read_b64_tr_b16 a[72:73], v8 offset:32768
v_lshrrev_b32 v21, 4, v0
v_mfma_f32_16x16x32_bf16 a[128:131], a[24:27], a[80:83], a[128:131]
buffer_load_dword a252, v1, s[60:63], s82 offen
v_mfma_f32_16x16x32_bf16 a[128:131], a[28:31], a[84:87], a[128:131]
ds_read_b64_tr_b16 a[74:75], v8 offset:33792
v_bfe_u32 v19, v0, 2, 2
v_mfma_f32_16x16x32_bf16 a[132:135], a[20:23], a[84:87], a[132:135]
ds_read_b64_tr_b16 a[76:77], v8 offset:40960
v_lshl_add_u32 v19, v21, 3, v19
v_mfma_f32_16x16x32_bf16 a[132:135], a[16:19], a[80:83], a[132:135]
s_xor_b32 m0, s77, 101376
ds_read_b64_tr_b16 a[78:79], v8 offset:41984
v_lshlrev_b32 v19, 6, v19
v_mfma_f32_16x16x32_bf16 a[136:139], a[8:11], a[80:83], a[136:139]
s_xor_b32 s64, s71, 3768320
v_and_b32 v21, 1, v21
v_mfma_f32_16x16x32_bf16 a[136:139], a[12:15], a[84:87], a[136:139]
buffer_load_dwordx4 v15, s[36:39], s64 offen lds
v_mfma_f32_16x16x32_bf16 a[140:143], a[4:7], a[84:87], a[140:143]
v_lshl_add_u32 v19, v21, 5, v19
v_mfma_f32_16x16x32_bf16 a[140:143], a[0:3], a[80:83], a[140:143]
s_waitcnt lgkmcnt(4)
ds_read_b64_tr_b16 a[80:81], v9 offset:32768
v_and_b32 v21, 3, v0
v_mfma_f32_16x16x32_bf16 v[184:187], a[88:91], a[32:35], v[184:187]
ds_read_b64_tr_b16 a[82:83], v9 offset:33792
v_lshl_add_u32 v19, v21, 3, v19
v_mfma_f32_16x16x32_bf16 v[184:187], a[92:95], a[36:39], v[184:187]
ds_read_b64_tr_b16 a[84:85], v9 offset:40960
v_add_u32 v19, 114688, v19
v_mfma_f32_16x16x32_bf16 v[192:195], a[92:95], a[44:47], v[192:195]
ds_read_b64_tr_b16 a[86:87], v9 offset:41984
v_xor_b32 v20, 32, v19
v_mfma_f32_16x16x32_bf16 v[192:195], a[88:91], a[40:43], v[192:195]
s_xor_b32 m0, s77, 114688
v_mfma_f32_16x16x32_bf16 v[200:203], a[88:91], a[48:51], v[200:203]
s_xor_b32 s64, s71, 3670016
v_mfma_f32_16x16x32_bf16 v[200:203], a[92:95], a[52:55], v[200:203]
buffer_load_dwordx4 v14, s[40:43], s64 offen lds
v_mfma_f32_16x16x32_bf16 v[208:211], a[92:95], a[60:63], v[208:211]
v_mfma_f32_16x16x32_bf16 v[208:211], a[88:91], a[56:59], v[208:211]
ds_read_b64_tr_b16 a[88:89], v10 offset:32768
v_mfma_f32_16x16x32_bf16 v[212:215], a[96:99], a[56:59], v[212:215]
ds_read_b64_tr_b16 a[90:91], v10 offset:33792
v_mfma_f32_16x16x32_bf16 v[212:215], a[100:103], a[60:63], v[212:215]
ds_read_b64_tr_b16 a[92:93], v10 offset:40960
v_mfma_f32_16x16x32_bf16 v[204:207], a[100:103], a[52:55], v[204:207]
ds_read_b64_tr_b16 a[94:95], v10 offset:41984
v_mfma_f32_16x16x32_bf16 v[204:207], a[96:99], a[48:51], v[204:207]
s_xor_b32 m0, s77, 115712
v_mfma_f32_16x16x32_bf16 v[196:199], a[96:99], a[40:43], v[196:199]
s_xor_b32 s64, s71, 3702784
v_mfma_f32_16x16x32_bf16 v[196:199], a[100:103], a[44:47], v[196:199]
buffer_load_dwordx4 v14, s[40:43], s64 offen lds
v_mfma_f32_16x16x32_bf16 v[188:191], a[100:103], a[36:39], v[188:191]
v_mfma_f32_16x16x32_bf16 v[188:191], a[96:99], a[32:35], v[188:191]
ds_read_b64_tr_b16 a[96:97], v11 offset:32768
v_mfma_f32_16x16x32_bf16 v[216:219], a[104:107], a[32:35], v[216:219]
ds_read_b64_tr_b16 a[98:99], v11 offset:33792
v_mfma_f32_16x16x32_bf16 v[216:219], a[108:111], a[36:39], v[216:219]
ds_read_b64_tr_b16 a[100:101], v11 offset:40960
v_mfma_f32_16x16x32_bf16 v[224:227], a[108:111], a[44:47], v[224:227]
ds_read_b64_tr_b16 a[102:103], v11 offset:41984
v_mfma_f32_16x16x32_bf16 v[224:227], a[104:107], a[40:43], v[224:227]
s_xor_b32 m0, s77, 116736
v_mfma_f32_16x16x32_bf16 v[232:235], a[104:107], a[48:51], v[232:235]
s_xor_b32 s64, s71, 3735552
v_mfma_f32_16x16x32_bf16 v[232:235], a[108:111], a[52:55], v[232:235]
buffer_load_dwordx4 v15, s[40:43], s64 offen lds
v_mfma_f32_16x16x32_bf16 v[240:243], a[108:111], a[60:63], v[240:243]
v_mfma_f32_16x16x32_bf16 v[240:243], a[104:107], a[56:59], v[240:243]
s_add_u32 s81, s81, 1048576
ds_read_b64_tr_b16 a[104:105], v4 offset:49152
v_mfma_f32_16x16x32_bf16 v[244:247], a[112:115], a[56:59], v[244:247]
buffer_load_dword a252, v16, s[56:59], s81 offen
v_mfma_f32_16x16x32_bf16 v[244:247], a[116:119], a[60:63], v[244:247]
ds_read_b64_tr_b16 a[106:107], v4 offset:50176
v_mfma_f32_16x16x32_bf16 v[236:239], a[116:119], a[52:55], v[236:239]
ds_read_b64_tr_b16 a[108:109], v4 offset:57344
v_mfma_f32_16x16x32_bf16 v[236:239], a[112:115], a[48:51], v[236:239]
s_xor_b32 m0, s77, 117760
ds_read_b64_tr_b16 a[110:111], v4 offset:58368
v_mfma_f32_16x16x32_bf16 v[228:231], a[112:115], a[40:43], v[228:231]
s_xor_b32 s64, s71, 3768320
v_mfma_f32_16x16x32_bf16 v[228:231], a[116:119], a[44:47], v[228:231]
buffer_load_dwordx4 v15, s[40:43], s64 offen lds
v_mfma_f32_16x16x32_bf16 v[220:223], a[116:119], a[36:39], v[220:223]
v_mfma_f32_16x16x32_bf16 v[220:223], a[112:115], a[32:35], v[220:223]
s_waitcnt lgkmcnt(4)
ds_read_b64_tr_b16 a[112:113], v5 offset:49152
v_mfma_f32_16x16x32_bf16 v[152:155], a[72:75], a[32:35], v[152:155]
ds_read_b64_tr_b16 a[114:115], v5 offset:50176
v_mfma_f32_16x16x32_bf16 v[152:155], a[76:79], a[36:39], v[152:155]
ds_read_b64_tr_b16 a[116:117], v5 offset:57344
v_mfma_f32_16x16x32_bf16 v[160:163], a[76:79], a[44:47], v[160:163]
ds_read_b64_tr_b16 a[118:119], v5 offset:58368
v_mfma_f32_16x16x32_bf16 v[160:163], a[72:75], a[40:43], v[160:163]
v_mfma_f32_16x16x32_bf16 v[168:171], a[72:75], a[48:51], v[168:171]
v_mfma_f32_16x16x32_bf16 v[168:171], a[76:79], a[52:55], v[168:171]
v_mfma_f32_16x16x32_bf16 v[176:179], a[76:79], a[60:63], v[176:179]
s_xor_b32 m0, s84, 32768
v_mfma_f32_16x16x32_bf16 v[176:179], a[72:75], a[56:59], v[176:179]
s_xor_b32 s64, s70, 896
ds_read_b64_tr_b16 a[72:73], v6 offset:49152
v_mfma_f32_16x16x32_bf16 v[180:183], a[80:83], a[56:59], v[180:183]
buffer_load_dwordx4 v12, s[32:35], s64 offen lds
v_mfma_f32_16x16x32_bf16 v[180:183], a[84:87], a[60:63], v[180:183]
ds_read_b64_tr_b16 a[74:75], v6 offset:50176
v_mfma_f32_16x16x32_bf16 v[172:175], a[84:87], a[52:55], v[172:175]
ds_read_b64_tr_b16 a[76:77], v6 offset:57344
v_mfma_f32_16x16x32_bf16 v[172:175], a[80:83], a[48:51], v[172:175]
ds_read_b64_tr_b16 a[78:79], v6 offset:58368
v_mfma_f32_16x16x32_bf16 v[164:167], a[80:83], a[40:43], v[164:167]
v_mfma_f32_16x16x32_bf16 v[164:167], a[84:87], a[44:47], v[164:167]
s_xor_b32 m0, s84, 33792
v_mfma_f32_16x16x32_bf16 v[156:159], a[84:87], a[36:39], v[156:159]
s_xor_b32 s64, s70, 9088
v_mfma_f32_16x16x32_bf16 v[156:159], a[80:83], a[32:35], v[156:159]
buffer_load_dwordx4 v13, s[32:35], s64 offen lds
v_mfma_f32_16x16x32_bf16 v[24:27], a[88:91], a[32:35], v[24:27]
ds_read_b64_tr_b16 a[80:81], v7 offset:49152
v_mfma_f32_16x16x32_bf16 v[24:27], a[92:95], a[36:39], v[24:27]
ds_read_b64_tr_b16 a[82:83], v7 offset:50176
v_mfma_f32_16x16x32_bf16 v[40:43], a[92:95], a[44:47], v[40:43]
ds_read_b64_tr_b16 a[84:85], v7 offset:57344
v_mfma_f32_16x16x32_bf16 v[40:43], a[88:91], a[40:43], v[40:43]
ds_read_b64_tr_b16 a[86:87], v7 offset:58368
v_mfma_f32_16x16x32_bf16 v[56:59], a[88:91], a[48:51], v[56:59]
s_xor_b32 m0, s84, 34816
v_mfma_f32_16x16x32_bf16 v[56:59], a[92:95], a[52:55], v[56:59]
s_xor_b32 s64, s70, 17280
v_mfma_f32_16x16x32_bf16 v[72:75], a[92:95], a[60:63], v[72:75]
s_waitcnt vmcnt(13)
buffer_load_dwordx4 v12, s[32:35], s64 offen lds
v_mfma_f32_16x16x32_bf16 v[72:75], a[88:91], a[56:59], v[72:75]
s_add_u32 s82, s82, 1048576
ds_read_b64_tr_b16 a[88:89], v8 offset:49152
v_mfma_f32_16x16x32_bf16 v[136:139], a[96:99], a[56:59], v[136:139]
buffer_load_dword a252, v1, s[60:63], s82 offen
v_mfma_f32_16x16x32_bf16 v[136:139], a[100:103], a[60:63], v[136:139]
ds_read_b64_tr_b16 a[90:91], v8 offset:50176
v_subrev_u32 v4, 0x8000, v4
v_mfma_f32_16x16x32_bf16 v[120:123], a[100:103], a[52:55], v[120:123]
ds_read_b64_tr_b16 a[92:93], v8 offset:57344
v_mfma_f32_16x16x32_bf16 v[120:123], a[96:99], a[48:51], v[120:123]
s_xor_b32 m0, s84, 35840
ds_read_b64_tr_b16 a[94:95], v8 offset:58368
v_mfma_f32_16x16x32_bf16 v[104:107], a[96:99], a[40:43], v[104:107]
s_xor_b32 s64, s70, 25472
ds_read_b128 a[0:3], v2 offset:0
v_mfma_f32_16x16x32_bf16 v[104:107], a[100:103], a[44:47], v[104:107]
buffer_load_dwordx4 v13, s[32:35], s64 offen lds
v_mfma_f32_16x16x32_bf16 v[88:91], a[100:103], a[36:39], v[88:91]
ds_read_b128 a[4:7], v3 offset:0
v_mfma_f32_16x16x32_bf16 v[88:91], a[96:99], a[32:35], v[88:91]
s_waitcnt lgkmcnt(6)
ds_read_b128 a[8:11], v2 offset:2048
v_mfma_f32_16x16x32_bf16 v[28:31], a[32:35], a[104:107], v[28:31]
ds_read_b128 a[12:15], v3 offset:2048
v_mfma_f32_16x16x32_bf16 v[28:31], a[36:39], a[108:111], v[28:31]
ds_read_b128 a[16:19], v2 offset:4096
v_subrev_u32 v5, 0x8000, v5
v_mfma_f32_16x16x32_bf16 v[44:47], a[44:47], a[108:111], v[44:47]
s_xor_b32 m0, s84, 36864
ds_read_b128 a[20:23], v3 offset:4096
v_mfma_f32_16x16x32_bf16 v[44:47], a[40:43], a[104:107], v[44:47]
s_xor_b32 s64, s70, 33664
ds_read_b128 a[24:27], v2 offset:6144
v_mfma_f32_16x16x32_bf16 v[60:63], a[48:51], a[104:107], v[60:63]
buffer_load_dwordx4 v12, s[32:35], s64 offen lds
v_mfma_f32_16x16x32_bf16 v[60:63], a[52:55], a[108:111], v[60:63]
ds_read_b128 a[28:31], v3 offset:6144
v_mfma_f32_16x16x32_bf16 v[76:79], a[60:63], a[108:111], v[76:79]
ds_read_b64_tr_b16 a[96:97], v9 offset:49152
v_mfma_f32_16x16x32_bf16 v[76:79], a[56:59], a[104:107], v[76:79]
ds_read_b64_tr_b16 a[98:99], v9 offset:50176
v_mfma_f32_16x16x32_bf16 v[140:143], a[56:59], a[112:115], v[140:143]
ds_read_b64_tr_b16 a[100:101], v9 offset:57344
v_mfma_f32_16x16x32_bf16 v[140:143], a[60:63], a[116:119], v[140:143]
s_xor_b32 m0, s84, 37888
ds_read_b64_tr_b16 a[102:103], v9 offset:58368
v_subrev_u32 v6, 0x8000, v6
v_mfma_f32_16x16x32_bf16 v[124:127], a[52:55], a[116:119], v[124:127]
s_xor_b32 s64, s70, 41856
ds_read_b64_tr_b16 a[104:105], v10 offset:49152
v_mfma_f32_16x16x32_bf16 v[124:127], a[48:51], a[112:115], v[124:127]
buffer_load_dwordx4 v13, s[32:35], s64 offen lds
v_mfma_f32_16x16x32_bf16 v[108:111], a[40:43], a[112:115], v[108:111]
ds_read_b64_tr_b16 a[106:107], v10 offset:50176
v_mfma_f32_16x16x32_bf16 v[108:111], a[44:47], a[116:119], v[108:111]
ds_read_b64_tr_b16 a[108:109], v10 offset:57344
v_mfma_f32_16x16x32_bf16 v[92:95], a[36:39], a[116:119], v[92:95]
ds_read_b64_tr_b16 a[110:111], v10 offset:58368
v_mfma_f32_16x16x32_bf16 v[92:95], a[32:35], a[112:115], v[92:95]
ds_read_b64_tr_b16 a[112:113], v11 offset:49152
v_mfma_f32_16x16x32_bf16 v[32:35], a[32:35], a[72:75], v[32:35]
s_xor_b32 m0, s84, 38912
ds_read_b64_tr_b16 a[114:115], v11 offset:50176
v_mfma_f32_16x16x32_bf16 v[32:35], a[36:39], a[76:79], v[32:35]
s_xor_b32 s64, s70, 50048
ds_read_b64_tr_b16 a[116:117], v11 offset:57344
v_subrev_u32 v7, 0x8000, v7
v_mfma_f32_16x16x32_bf16 v[48:51], a[44:47], a[76:79], v[48:51]
buffer_load_dwordx4 v12, s[32:35], s64 offen lds
v_mfma_f32_16x16x32_bf16 v[48:51], a[40:43], a[72:75], v[48:51]
ds_read_b64_tr_b16 a[118:119], v11 offset:58368
v_mfma_f32_16x16x32_bf16 v[64:67], a[48:51], a[72:75], v[64:67]
v_mfma_f32_16x16x32_bf16 v[64:67], a[52:55], a[76:79], v[64:67]
v_mfma_f32_16x16x32_bf16 v[80:83], a[60:63], a[76:79], v[80:83]
v_mfma_f32_16x16x32_bf16 v[80:83], a[56:59], a[72:75], v[80:83]
s_xor_b32 m0, s84, 39936
v_mfma_f32_16x16x32_bf16 v[144:147], a[56:59], a[80:83], v[144:147]
s_xor_b32 s64, s70, 58240
v_mfma_f32_16x16x32_bf16 v[144:147], a[60:63], a[84:87], v[144:147]
buffer_load_dwordx4 v13, s[32:35], s64 offen lds
v_mfma_f32_16x16x32_bf16 v[128:131], a[52:55], a[84:87], v[128:131]
v_subrev_u32 v8, 0x8000, v8
v_mfma_f32_16x16x32_bf16 v[128:131], a[48:51], a[80:83], v[128:131]
v_mfma_f32_16x16x32_bf16 v[112:115], a[40:43], a[80:83], v[112:115]
v_mfma_f32_16x16x32_bf16 v[112:115], a[44:47], a[84:87], v[112:115]
v_mfma_f32_16x16x32_bf16 v[96:99], a[36:39], a[84:87], v[96:99]
s_and_b32 s77, s77, 0x3fff
v_subrev_u32 v9, 0x8000, v9
v_subrev_u32 v10, 0x8000, v10
v_mfma_f32_16x16x32_bf16 v[96:99], a[32:35], a[80:83], v[96:99]
s_waitcnt lgkmcnt(0)
v_subrev_u32 v11, 0x8000, v11
v_mfma_f32_16x16x32_bf16 v[36:39], a[32:35], a[88:91], v[36:39]
v_mfma_f32_16x16x32_bf16 v[36:39], a[36:39], a[92:95], v[36:39]
v_mfma_f32_16x16x32_bf16 v[52:55], a[44:47], a[92:95], v[52:55]
s_waitcnt lgkmcnt(0)
s_barrier
v_mfma_f32_16x16x32_bf16 v[52:55], a[40:43], a[88:91], v[52:55]
s_xor_b32 m0, s77, 131072
ds_read_b64_tr_b16 a[72:73], v4 offset:0
v_mfma_f32_16x16x32_bf16 v[68:71], a[48:51], a[88:91], v[68:71]
s_xor_b32 s64, s71, 0
ds_read_b64_tr_b16 a[74:75], v4 offset:1024
v_mfma_f32_16x16x32_bf16 v[68:71], a[52:55], a[92:95], v[68:71]
buffer_load_dwordx4 v14, s[56:59], s64 offen lds
v_mfma_f32_16x16x32_bf16 v[84:87], a[60:63], a[92:95], v[84:87]
ds_read_b64_tr_b16 a[76:77], v4 offset:8192
v_mfma_f32_16x16x32_bf16 v[84:87], a[56:59], a[88:91], v[84:87]
ds_read_b64_tr_b16 a[78:79], v4 offset:9216
v_mfma_f32_16x16x32_bf16 v[148:151], a[56:59], a[96:99], v[148:151]
ds_read_b64_tr_b16 a[80:81], v5 offset:0
v_lshrrev_b32 v13, 3, v0
v_mfma_f32_16x16x32_bf16 v[148:151], a[60:63], a[100:103], v[148:151]
ds_read_b64_tr_b16 a[82:83], v5 offset:1024
v_lshl_add_u32 v12, v13, 10, v12
v_mfma_f32_16x16x32_bf16 v[132:135], a[52:55], a[100:103], v[132:135]
ds_read_b64_tr_b16 a[84:85], v5 offset:8192
v_xor_b32 v13, 64, v12
v_mfma_f32_16x16x32_bf16 v[132:135], a[48:51], a[96:99], v[132:135]
ds_read_b64_tr_b16 a[86:87], v5 offset:9216
v_mfma_f32_16x16x32_bf16 v[116:119], a[40:43], a[96:99], v[116:119]
s_add_u32 m0, s78, 147456
ds_read_b64_tr_b16 a[88:89], v6 offset:0
v_mfma_f32_16x16x32_bf16 v[116:119], a[44:47], a[100:103], v[116:119]
s_add_u32 s64, s75, 0
ds_read_b64_tr_b16 a[90:91], v6 offset:1024
v_mfma_f32_16x16x32_bf16 v[100:103], a[36:39], a[100:103], v[100:103]
buffer_load_dwordx4 v23, s[60:63], s64 offen lds
v_mfma_f32_16x16x32_bf16 v[100:103], a[32:35], a[96:99], v[100:103]
ds_read_b64_tr_b16 a[92:93], v6 offset:8192
v_mfma_f32_16x16x32_bf16 v[248:251], a[32:35], a[104:107], v[248:251]
ds_read_b64_tr_b16 a[94:95], v6 offset:9216
v_mfma_f32_16x16x32_bf16 v[248:251], a[36:39], a[108:111], v[248:251]
ds_read_b64_tr_b16 a[96:97], v7 offset:0
v_mfma_f32_16x16x32_bf16 v[252:255], a[44:47], a[108:111], v[252:255]
ds_read_b64_tr_b16 a[98:99], v7 offset:1024
v_mfma_f32_16x16x32_bf16 v[252:255], a[40:43], a[104:107], v[252:255]
ds_read_b64_tr_b16 a[100:101], v7 offset:8192
v_mfma_f32_16x16x32_bf16 a[120:123], a[48:51], a[104:107], a[120:123]
ds_read_b64_tr_b16 a[102:103], v7 offset:9216
v_mfma_f32_16x16x32_bf16 a[120:123], a[52:55], a[108:111], a[120:123]
s_xor_b32 m0, s77, 132096
v_mfma_f32_16x16x32_bf16 a[124:127], a[60:63], a[108:111], a[124:127]
s_xor_b32 s64, s71, 32768
v_mfma_f32_16x16x32_bf16 a[124:127], a[56:59], a[104:107], a[124:127]
buffer_load_dwordx4 v14, s[56:59], s64 offen lds
v_mfma_f32_16x16x32_bf16 a[128:131], a[56:59], a[112:115], a[128:131]
ds_read_b64_tr_b16 a[104:105], v8 offset:0
v_mfma_f32_16x16x32_bf16 a[128:131], a[60:63], a[116:119], a[128:131]
ds_read_b64_tr_b16 a[106:107], v8 offset:1024
v_mfma_f32_16x16x32_bf16 a[132:135], a[52:55], a[116:119], a[132:135]
ds_read_b64_tr_b16 a[108:109], v8 offset:8192
v_mfma_f32_16x16x32_bf16 a[132:135], a[48:51], a[112:115], a[132:135]
ds_read_b64_tr_b16 a[110:111], v8 offset:9216
v_mfma_f32_16x16x32_bf16 a[136:139], a[40:43], a[112:115], a[136:139]
v_mfma_f32_16x16x32_bf16 a[136:139], a[44:47], a[116:119], a[136:139]
v_mfma_f32_16x16x32_bf16 a[140:143], a[36:39], a[116:119], a[140:143]
s_add_u32 m0, s78, 151552
v_mfma_f32_16x16x32_bf16 a[140:143], a[32:35], a[112:115], a[140:143]
s_waitcnt lgkmcnt(4)
s_add_u32 s64, s75, 2048
ds_read_b64_tr_b16 a[112:113], v9 offset:0
v_mfma_f32_16x16x32_bf16 v[184:187], a[72:75], a[0:3], v[184:187]
buffer_load_dwordx4 v23, s[60:63], s64 offen lds
v_mfma_f32_16x16x32_bf16 v[184:187], a[76:79], a[4:7], v[184:187]
ds_read_b64_tr_b16 a[114:115], v9 offset:1024
v_mfma_f32_16x16x32_bf16 v[192:195], a[76:79], a[12:15], v[192:195]
ds_read_b64_tr_b16 a[116:117], v9 offset:8192
v_mfma_f32_16x16x32_bf16 v[192:195], a[72:75], a[8:11], v[192:195]
ds_read_b64_tr_b16 a[118:119], v9 offset:9216
v_mfma_f32_16x16x32_bf16 v[200:203], a[72:75], a[16:19], v[200:203]
v_mfma_f32_16x16x32_bf16 v[200:203], a[76:79], a[20:23], v[200:203]
v_mfma_f32_16x16x32_bf16 v[208:211], a[76:79], a[28:31], v[208:211]
v_mfma_f32_16x16x32_bf16 v[208:211], a[72:75], a[24:27], v[208:211]
ds_read_b64_tr_b16 a[72:73], v10 offset:0
v_mfma_f32_16x16x32_bf16 v[212:215], a[80:83], a[24:27], v[212:215]
s_xor_b32 m0, s77, 133120
ds_read_b64_tr_b16 a[74:75], v10 offset:1024
v_mfma_f32_16x16x32_bf16 v[212:215], a[84:87], a[28:31], v[212:215]
s_xor_b32 s64, s71, 65536
ds_read_b64_tr_b16 a[76:77], v10 offset:8192
v_mfma_f32_16x16x32_bf16 v[204:207], a[84:87], a[20:23], v[204:207]
buffer_load_dwordx4 v15, s[56:59], s64 offen lds
v_mfma_f32_16x16x32_bf16 v[204:207], a[80:83], a[16:19], v[204:207]
ds_read_b64_tr_b16 a[78:79], v10 offset:9216
v_mfma_f32_16x16x32_bf16 v[196:199], a[80:83], a[8:11], v[196:199]
v_mfma_f32_16x16x32_bf16 v[196:199], a[84:87], a[12:15], v[196:199]
v_mfma_f32_16x16x32_bf16 v[188:191], a[84:87], a[4:7], v[188:191]
v_mfma_f32_16x16x32_bf16 v[188:191], a[80:83], a[0:3], v[188:191]
ds_read_b64_tr_b16 a[80:81], v11 offset:0
v_mfma_f32_16x16x32_bf16 v[216:219], a[88:91], a[0:3], v[216:219]
ds_read_b64_tr_b16 a[82:83], v11 offset:1024
v_mfma_f32_16x16x32_bf16 v[216:219], a[92:95], a[4:7], v[216:219]
s_add_u32 m0, s78, 155648
ds_read_b64_tr_b16 a[84:85], v11 offset:8192
v_mfma_f32_16x16x32_bf16 v[224:227], a[92:95], a[12:15], v[224:227]
s_add_u32 s64, s75, 4096
ds_read_b64_tr_b16 a[86:87], v11 offset:9216
v_mfma_f32_16x16x32_bf16 v[224:227], a[88:91], a[8:11], v[224:227]
buffer_load_dwordx4 v23, s[60:63], s64 offen lds
v_mfma_f32_16x16x32_bf16 v[232:235], a[88:91], a[16:19], v[232:235]
v_mfma_f32_16x16x32_bf16 v[232:235], a[92:95], a[20:23], v[232:235]
v_mfma_f32_16x16x32_bf16 v[240:243], a[92:95], a[28:31], v[240:243]
v_mfma_f32_16x16x32_bf16 v[240:243], a[88:91], a[24:27], v[240:243]
ds_read_b64_tr_b16 a[88:89], v4 offset:16384
v_mfma_f32_16x16x32_bf16 v[244:247], a[96:99], a[24:27], v[244:247]
ds_read_b64_tr_b16 a[90:91], v4 offset:17408
v_mfma_f32_16x16x32_bf16 v[244:247], a[100:103], a[28:31], v[244:247]
ds_read_b64_tr_b16 a[92:93], v4 offset:24576
v_mfma_f32_16x16x32_bf16 v[236:239], a[100:103], a[20:23], v[236:239]
s_xor_b32 m0, s77, 134144
ds_read_b64_tr_b16 a[94:95], v4 offset:25600
v_mfma_f32_16x16x32_bf16 v[236:239], a[96:99], a[16:19], v[236:239]
s_xor_b32 s64, s71, 98304
v_mfma_f32_16x16x32_bf16 v[228:231], a[96:99], a[8:11], v[228:231]
buffer_load_dwordx4 v15, s[56:59], s64 offen lds
v_mfma_f32_16x16x32_bf16 v[228:231], a[100:103], a[12:15], v[228:231]
v_mfma_f32_16x16x32_bf16 v[220:223], a[100:103], a[4:7], v[220:223]
v_mfma_f32_16x16x32_bf16 v[220:223], a[96:99], a[0:3], v[220:223]
s_waitcnt lgkmcnt(4)
ds_read_b64_tr_b16 a[96:97], v5 offset:16384
v_mfma_f32_16x16x32_bf16 v[152:155], a[104:107], a[0:3], v[152:155]
ds_read_b64_tr_b16 a[98:99], v5 offset:17408
v_mfma_f32_16x16x32_bf16 v[152:155], a[108:111], a[4:7], v[152:155]
ds_read_b64_tr_b16 a[100:101], v5 offset:24576
v_mfma_f32_16x16x32_bf16 v[160:163], a[108:111], a[12:15], v[160:163]
ds_read_b64_tr_b16 a[102:103], v5 offset:25600
v_mfma_f32_16x16x32_bf16 v[160:163], a[104:107], a[8:11], v[160:163]
v_mfma_f32_16x16x32_bf16 v[168:171], a[104:107], a[16:19], v[168:171]
v_mfma_f32_16x16x32_bf16 v[168:171], a[108:111], a[20:23], v[168:171]
v_mfma_f32_16x16x32_bf16 v[176:179], a[108:111], a[28:31], v[176:179]
s_xor_b32 m0, s84, 0
v_mfma_f32_16x16x32_bf16 v[176:179], a[104:107], a[24:27], v[176:179]
s_xor_b32 s64, s72, 0
ds_read_b64_tr_b16 a[104:105], v6 offset:16384
v_mfma_f32_16x16x32_bf16 v[180:183], a[112:115], a[24:27], v[180:183]
buffer_load_dwordx4 v12, s[48:51], s64 offen lds
v_mfma_f32_16x16x32_bf16 v[180:183], a[116:119], a[28:31], v[180:183]
ds_read_b64_tr_b16 a[106:107], v6 offset:17408
v_mfma_f32_16x16x32_bf16 v[172:175], a[116:119], a[20:23], v[172:175]
ds_read_b64_tr_b16 a[108:109], v6 offset:24576
v_mfma_f32_16x16x32_bf16 v[172:175], a[112:115], a[16:19], v[172:175]
ds_read_b64_tr_b16 a[110:111], v6 offset:25600
v_mfma_f32_16x16x32_bf16 v[164:167], a[112:115], a[8:11], v[164:167]
v_mfma_f32_16x16x32_bf16 v[164:167], a[116:119], a[12:15], v[164:167]
s_xor_b32 m0, s84, 1024
v_mfma_f32_16x16x32_bf16 v[156:159], a[116:119], a[4:7], v[156:159]
s_xor_b32 s64, s72, 16384
v_mfma_f32_16x16x32_bf16 v[156:159], a[112:115], a[0:3], v[156:159]
buffer_load_dwordx4 v13, s[48:51], s64 offen lds
v_mfma_f32_16x16x32_bf16 v[24:27], a[72:75], a[0:3], v[24:27]
ds_read_b64_tr_b16 a[112:113], v7 offset:16384
v_mfma_f32_16x16x32_bf16 v[24:27], a[76:79], a[4:7], v[24:27]
ds_read_b64_tr_b16 a[114:115], v7 offset:17408
v_mfma_f32_16x16x32_bf16 v[40:43], a[76:79], a[12:15], v[40:43]
ds_read_b64_tr_b16 a[116:117], v7 offset:24576
v_mfma_f32_16x16x32_bf16 v[40:43], a[72:75], a[8:11], v[40:43]
ds_read_b64_tr_b16 a[118:119], v7 offset:25600
v_mfma_f32_16x16x32_bf16 v[56:59], a[72:75], a[16:19], v[56:59]
s_xor_b32 m0, s84, 2048
v_mfma_f32_16x16x32_bf16 v[56:59], a[76:79], a[20:23], v[56:59]
s_xor_b32 s64, s72, 131072
v_mfma_f32_16x16x32_bf16 v[72:75], a[76:79], a[28:31], v[72:75]
s_waitcnt vmcnt(9)
buffer_load_dwordx4 v12, s[48:51], s64 offen lds
v_mfma_f32_16x16x32_bf16 v[72:75], a[72:75], a[24:27], v[72:75]
ds_read_b64_tr_b16 a[72:73], v8 offset:16384
v_mfma_f32_16x16x32_bf16 v[136:139], a[80:83], a[24:27], v[136:139]
ds_read_b64_tr_b16 a[74:75], v8 offset:17408
v_mfma_f32_16x16x32_bf16 v[136:139], a[84:87], a[28:31], v[136:139]
ds_read_b64_tr_b16 a[76:77], v8 offset:24576
v_mfma_f32_16x16x32_bf16 v[120:123], a[84:87], a[20:23], v[120:123]
ds_read_b64_tr_b16 a[78:79], v8 offset:25600
v_mfma_f32_16x16x32_bf16 v[120:123], a[80:83], a[16:19], v[120:123]
s_xor_b32 m0, s84, 3072
ds_read_b128 a[32:35], v2 offset:32768
v_mfma_f32_16x16x32_bf16 v[104:107], a[80:83], a[8:11], v[104:107]
s_xor_b32 s64, s72, 147456
ds_read_b128 a[36:39], v3 offset:32768
v_mfma_f32_16x16x32_bf16 v[104:107], a[84:87], a[12:15], v[104:107]
buffer_load_dwordx4 v13, s[48:51], s64 offen lds
v_mfma_f32_16x16x32_bf16 v[88:91], a[84:87], a[4:7], v[88:91]
ds_read_b128 a[40:43], v2 offset:34816
v_mfma_f32_16x16x32_bf16 v[88:91], a[80:83], a[0:3], v[88:91]
s_waitcnt lgkmcnt(7)
ds_read_b128 a[44:47], v3 offset:34816
v_mfma_f32_16x16x32_bf16 v[28:31], a[0:3], a[88:91], v[28:31]
ds_read_b128 a[48:51], v2 offset:36864
v_mfma_f32_16x16x32_bf16 v[28:31], a[4:7], a[92:95], v[28:31]
ds_read_b128 a[52:55], v3 offset:36864
v_mfma_f32_16x16x32_bf16 v[44:47], a[12:15], a[92:95], v[44:47]
s_xor_b32 m0, s84, 4096
ds_read_b128 a[56:59], v2 offset:38912
v_mfma_f32_16x16x32_bf16 v[44:47], a[8:11], a[88:91], v[44:47]
s_xor_b32 s64, s73, 0
ds_read_b128 a[60:63], v3 offset:38912
v_mfma_f32_16x16x32_bf16 v[60:63], a[16:19], a[88:91], v[60:63]
buffer_load_dwordx4 v12, s[48:51], s64 offen lds
v_mfma_f32_16x16x32_bf16 v[60:63], a[20:23], a[92:95], v[60:63]
ds_read_b64_tr_b16 a[80:81], v9 offset:16384
v_mfma_f32_16x16x32_bf16 v[76:79], a[28:31], a[92:95], v[76:79]
ds_read_b64_tr_b16 a[82:83], v9 offset:17408
v_mfma_f32_16x16x32_bf16 v[76:79], a[24:27], a[88:91], v[76:79]
ds_read_b64_tr_b16 a[84:85], v9 offset:24576
v_mfma_f32_16x16x32_bf16 v[140:143], a[24:27], a[96:99], v[140:143]
ds_read_b64_tr_b16 a[86:87], v9 offset:25600
v_mfma_f32_16x16x32_bf16 v[140:143], a[28:31], a[100:103], v[140:143]
s_xor_b32 m0, s84, 5120
ds_read_b64_tr_b16 a[88:89], v10 offset:16384
v_mfma_f32_16x16x32_bf16 v[124:127], a[20:23], a[100:103], v[124:127]
s_xor_b32 s64, s73, 16384
ds_read_b64_tr_b16 a[90:91], v10 offset:17408
v_mfma_f32_16x16x32_bf16 v[124:127], a[16:19], a[96:99], v[124:127]
buffer_load_dwordx4 v13, s[48:51], s64 offen lds
v_mfma_f32_16x16x32_bf16 v[108:111], a[8:11], a[96:99], v[108:111]
s_branch L_po5
L_pg5:
s_branch L_tr0
L_po5:
ds_read_b64_tr_b16 a[92:93], v10 offset:24576
v_mfma_f32_16x16x32_bf16 v[108:111], a[12:15], a[100:103], v[108:111]
ds_read_b64_tr_b16 a[94:95], v10 offset:25600
v_mfma_f32_16x16x32_bf16 v[92:95], a[4:7], a[100:103], v[92:95]
v_mfma_f32_16x16x32_bf16 v[92:95], a[0:3], a[96:99], v[92:95]
ds_read_b64_tr_b16 a[96:97], v11 offset:16384
v_mfma_f32_16x16x32_bf16 v[32:35], a[0:3], a[104:107], v[32:35]
s_xor_b32 m0, s84, 6144
ds_read_b64_tr_b16 a[98:99], v11 offset:17408
v_mfma_f32_16x16x32_bf16 v[32:35], a[4:7], a[108:111], v[32:35]
s_xor_b32 s64, s73, 131072
ds_read_b64_tr_b16 a[100:101], v11 offset:24576
v_mfma_f32_16x16x32_bf16 v[48:51], a[12:15], a[108:111], v[48:51]
buffer_load_dwordx4 v12, s[48:51], s64 offen lds
v_mfma_f32_16x16x32_bf16 v[48:51], a[8:11], a[104:107], v[48:51]
ds_read_b64_tr_b16 a[102:103], v11 offset:25600
v_mfma_f32_16x16x32_bf16 v[64:67], a[16:19], a[104:107], v[64:67]
v_mfma_f32_16x16x32_bf16 v[64:67], a[20:23], a[108:111], v[64:67]
v_mfma_f32_16x16x32_bf16 v[80:83], a[28:31], a[108:111], v[80:83]
v_mfma_f32_16x16x32_bf16 v[80:83], a[24:27], a[104:107], v[80:83]
s_xor_b32 m0, s84, 7168
v_mfma_f32_16x16x32_bf16 v[144:147], a[24:27], a[112:115], v[144:147]
s_xor_b32 s64, s73, 147456
v_mfma_f32_16x16x32_bf16 v[144:147], a[28:31], a[116:119], v[144:147]
buffer_load_dwordx4 v13, s[48:51], s64 offen lds
v_mfma_f32_16x16x32_bf16 v[128:131], a[20:23], a[116:119], v[128:131]
v_mfma_f32_16x16x32_bf16 v[128:131], a[16:19], a[112:115], v[128:131]
v_mfma_f32_16x16x32_bf16 v[112:115], a[8:11], a[112:115], v[112:115]
v_mfma_f32_16x16x32_bf16 v[112:115], a[12:15], a[116:119], v[112:115]
v_mfma_f32_16x16x32_bf16 v[96:99], a[4:7], a[116:119], v[96:99]
v_mfma_f32_16x16x32_bf16 v[96:99], a[0:3], a[112:115], v[96:99]
s_waitcnt lgkmcnt(0)
v_mfma_f32_16x16x32_bf16 v[36:39], a[0:3], a[72:75], v[36:39]
v_mfma_f32_16x16x32_bf16 v[36:39], a[4:7], a[76:79], v[36:39]
v_mfma_f32_16x16x32_bf16 v[52:55], a[12:15], a[76:79], v[52:55]
s_waitcnt lgkmcnt(0)
s_barrier
v_mfma_f32_16x16x32_bf16 v[52:55], a[8:11], a[72:75], v[52:55]
s_xor_b32 m0, s77, 65536
ds_read_b64_tr_b16 a[104:105], v4 offset:32768
v_mfma_f32_16x16x32_bf16 v[68:71], a[16:19], a[72:75], v[68:71]
s_xor_b32 s64, s71, 524288
ds_read_b64_tr_b16 a[106:107], v4 offset:33792
v_mfma_f32_16x16x32_bf16 v[68:71], a[20:23], a[76:79], v[68:71]
buffer_load_dwordx4 v14, s[56:59], s64 offen lds
v_mfma_f32_16x16x32_bf16 v[84:87], a[28:31], a[76:79], v[84:87]
ds_read_b64_tr_b16 a[108:109], v4 offset:40960
v_mfma_f32_16x16x32_bf16 v[84:87], a[24:27], a[72:75], v[84:87]
ds_read_b64_tr_b16 a[110:111], v4 offset:41984
v_mfma_f32_16x16x32_bf16 v[148:151], a[24:27], a[80:83], v[148:151]
ds_read_b64_tr_b16 a[112:113], v5 offset:32768
v_mfma_f32_16x16x32_bf16 v[148:151], a[28:31], a[84:87], v[148:151]
ds_read_b64_tr_b16 a[114:115], v5 offset:33792
v_mfma_f32_16x16x32_bf16 v[132:135], a[20:23], a[84:87], v[132:135]
ds_read_b64_tr_b16 a[116:117], v5 offset:40960
v_mfma_f32_16x16x32_bf16 v[132:135], a[16:19], a[80:83], v[132:135]
ds_read_b64_tr_b16 a[118:119], v5 offset:41984
v_mfma_f32_16x16x32_bf16 v[116:119], a[8:11], a[80:83], v[116:119]
s_add_u32 m0, s78, 81920
ds_read_b64_tr_b16 a[72:73], v6 offset:32768
v_mfma_f32_16x16x32_bf16 v[116:119], a[12:15], a[84:87], v[116:119]
s_add_u32 s64, s75, 393216
ds_read_b64_tr_b16 a[74:75], v6 offset:33792
v_mfma_f32_16x16x32_bf16 v[100:103], a[4:7], a[84:87], v[100:103]
buffer_load_dwordx4 v23, s[60:63], s64 offen lds
v_mfma_f32_16x16x32_bf16 v[100:103], a[0:3], a[80:83], v[100:103]
ds_read_b64_tr_b16 a[76:77], v6 offset:40960
v_mfma_f32_16x16x32_bf16 v[248:251], a[0:3], a[88:91], v[248:251]
ds_read_b64_tr_b16 a[78:79], v6 offset:41984
v_mfma_f32_16x16x32_bf16 v[248:251], a[4:7], a[92:95], v[248:251]
ds_read_b64_tr_b16 a[80:81], v7 offset:32768
v_mfma_f32_16x16x32_bf16 v[252:255], a[12:15], a[92:95], v[252:255]
ds_read_b64_tr_b16 a[82:83], v7 offset:33792
v_mfma_f32_16x16x32_bf16 v[252:255], a[8:11], a[88:91], v[252:255]
ds_read_b64_tr_b16 a[84:85], v7 offset:40960
v_mfma_f32_16x16x32_bf16 a[120:123], a[16:19], a[88:91], a[120:123]
ds_read_b64_tr_b16 a[86:87], v7 offset:41984
v_mfma_f32_16x16x32_bf16 a[120:123], a[20:23], a[92:95], a[120:123]
s_xor_b32 m0, s77, 66560
v_mfma_f32_16x16x32_bf16 a[124:127], a[28:31], a[92:95], a[124:127]
s_xor_b32 s64, s71, 557056
v_mfma_f32_16x16x32_bf16 a[124:127], a[24:27], a[88:91], a[124:127]
buffer_load_dwordx4 v14, s[56:59], s64 offen lds
v_mfma_f32_16x16x32_bf16 a[128:131], a[24:27], a[96:99], a[128:131]
ds_read_b64_tr_b16 a[88:89], v8 offset:32768
v_mfma_f32_16x16x32_bf16 a[128:131], a[28:31], a[100:103], a[128:131]
ds_read_b64_tr_b16 a[90:91], v8 offset:33792
v_mfma_f32_16x16x32_bf16 a[132:135], a[20:23], a[100:103], a[132:135]
ds_read_b64_tr_b16 a[92:93], v8 offset:40960
v_mfma_f32_16x16x32_bf16 a[132:135], a[16:19], a[96:99], a[132:135]
ds_read_b64_tr_b16 a[94:95], v8 offset:41984
v_mfma_f32_16x16x32_bf16 a[136:139], a[8:11], a[96:99], a[136:139]
v_mfma_f32_16x16x32_bf16 a[136:139], a[12:15], a[100:103], a[136:139]
v_mfma_f32_16x16x32_bf16 a[140:143], a[4:7], a[100:103], a[140:143]
s_add_u32 m0, s78, 86016
v_mfma_f32_16x16x32_bf16 a[140:143], a[0:3], a[96:99], a[140:143]
s_waitcnt lgkmcnt(4)
s_add_u32 s64, s75, 395264
ds_read_b64_tr_b16 a[96:97], v9 offset:32768
v_mfma_f32_16x16x32_bf16 v[184:187], a[104:107], a[32:35], v[184:187]
s_lshl_b32 s66, s30, 30
buffer_load_dwordx4 v23, s[60:63], s64 offen lds
v_mfma_f32_16x16x32_bf16 v[184:187], a[108:111], a[36:39], v[184:187]
ds_read_b64_tr_b16 a[98:99], v9 offset:33792
v_lshl_add_u32 v1, v0, 24, s66
v_mfma_f32_16x16x32_bf16 v[192:195], a[108:111], a[44:47], v[192:195]
s_lshr_b32 s66, s3, 1
ds_read_b64_tr_b16 a[100:101], v9 offset:40960
v_mfma_f32_16x16x32_bf16 v[192:195], a[104:107], a[40:43], v[192:195]
s_lshl_b32 s66, s66, 12
ds_read_b64_tr_b16 a[102:103], v9 offset:41984
v_mfma_f32_16x16x32_bf16 v[200:203], a[104:107], a[48:51], v[200:203]
v_mfma_f32_16x16x32_bf16 v[200:203], a[108:111], a[52:55], v[200:203]
v_mfma_f32_16x16x32_bf16 v[208:211], a[108:111], a[60:63], v[208:211]
v_mfma_f32_16x16x32_bf16 v[208:211], a[104:107], a[56:59], v[208:211]
ds_read_b64_tr_b16 a[104:105], v10 offset:32768
v_mfma_f32_16x16x32_bf16 v[212:215], a[112:115], a[56:59], v[212:215]
s_xor_b32 m0, s77, 67584
ds_read_b64_tr_b16 a[106:107], v10 offset:33792
v_mfma_f32_16x16x32_bf16 v[212:215], a[116:119], a[60:63], v[212:215]
s_xor_b32 s64, s71, 589824
ds_read_b64_tr_b16 a[108:109], v10 offset:40960
v_mfma_f32_16x16x32_bf16 v[204:207], a[116:119], a[52:55], v[204:207]
buffer_load_dwordx4 v15, s[56:59], s64 offen lds
v_mfma_f32_16x16x32_bf16 v[204:207], a[112:115], a[48:51], v[204:207]
ds_read_b64_tr_b16 a[110:111], v10 offset:41984
v_mfma_f32_16x16x32_bf16 v[196:199], a[112:115], a[40:43], v[196:199]
v_mfma_f32_16x16x32_bf16 v[196:199], a[116:119], a[44:47], v[196:199]
v_mfma_f32_16x16x32_bf16 v[188:191], a[116:119], a[36:39], v[188:191]
v_mfma_f32_16x16x32_bf16 v[188:191], a[112:115], a[32:35], v[188:191]
s_add_u32 s67, s79, 20480
ds_read_b64_tr_b16 a[112:113], v11 offset:32768
v_mfma_f32_16x16x32_bf16 v[216:219], a[72:75], a[32:35], v[216:219]
ds_read_b64_tr_b16 a[114:115], v11 offset:33792
v_mfma_f32_16x16x32_bf16 v[216:219], a[76:79], a[36:39], v[216:219]
s_add_u32 m0, s78, 90112
ds_read_b64_tr_b16 a[116:117], v11 offset:40960
v_cvt_pk_bf16_f32 v215, v214, v215
v_mfma_f32_16x16x32_bf16 v[224:227], a[76:79], a[44:47], v[224:227]
s_add_u32 s64, s75, 397312
ds_read_b64_tr_b16 a[118:119], v11 offset:41984
v_cvt_pk_bf16_f32 v214, v212, v213
v_mfma_f32_16x16x32_bf16 v[224:227], a[72:75], a[40:43], v[224:227]
buffer_load_dwordx4 v23, s[60:63], s64 offen lds
v_mfma_f32_16x16x32_bf16 v[232:235], a[72:75], a[48:51], v[232:235]
v_cvt_pk_bf16_f32 v212, v208, v209
v_cvt_pk_bf16_f32 v213, v210, v211
v_mfma_f32_16x16x32_bf16 v[232:235], a[76:79], a[52:55], v[232:235]
buffer_store_dwordx4 v[212:215], v16, s[44:47], s67 offen sc1
v_mfma_f32_16x16x32_bf16 v[240:243], a[76:79], a[60:63], v[240:243]
v_cvt_pk_bf16_f32 v207, v206, v207
v_cvt_pk_bf16_f32 v206, v204, v205
v_mfma_f32_16x16x32_bf16 v[240:243], a[72:75], a[56:59], v[240:243]
ds_read_b64_tr_b16 a[72:73], v4 offset:49152
v_cvt_pk_bf16_f32 v204, v200, v201
v_mfma_f32_16x16x32_bf16 v[244:247], a[80:83], a[56:59], v[244:247]
ds_read_b64_tr_b16 a[74:75], v4 offset:50176
v_cvt_pk_bf16_f32 v205, v202, v203
v_mfma_f32_16x16x32_bf16 v[244:247], a[84:87], a[60:63], v[244:247]
ds_read_b64_tr_b16 a[76:77], v4 offset:57344
v_accvgpr_write_b32 a144, v204
v_mfma_f32_16x16x32_bf16 v[236:239], a[84:87], a[52:55], v[236:239]
s_xor_b32 m0, s77, 68608
ds_read_b64_tr_b16 a[78:79], v4 offset:58368
v_accvgpr_write_b32 a145, v205
v_mfma_f32_16x16x32_bf16 v[236:239], a[80:83], a[48:51], v[236:239]
s_xor_b32 s64, s71, 622592
v_accvgpr_write_b32 a146, v206
v_accvgpr_write_b32 a147, v207
v_mfma_f32_16x16x32_bf16 v[228:231], a[80:83], a[40:43], v[228:231]
buffer_load_dwordx4 v15, s[56:59], s64 offen lds
v_mfma_f32_16x16x32_bf16 v[228:231], a[84:87], a[44:47], v[228:231]
v_cvt_pk_bf16_f32 v199, v198, v199
v_cvt_pk_bf16_f32 v198, v196, v197
v_mfma_f32_16x16x32_bf16 v[220:223], a[84:87], a[36:39], v[220:223]
v_cvt_pk_bf16_f32 v196, v192, v193
v_cvt_pk_bf16_f32 v197, v194, v195
v_mfma_f32_16x16x32_bf16 v[220:223], a[80:83], a[32:35], v[220:223]
s_waitcnt lgkmcnt(4)
ds_read_b64_tr_b16 a[80:81], v5 offset:49152
v_accvgpr_write_b32 a148, v196
v_mfma_f32_16x16x32_bf16 v[152:155], a[88:91], a[32:35], v[152:155]
ds_read_b64_tr_b16 a[82:83], v5 offset:50176
v_accvgpr_write_b32 a149, v197
v_mfma_f32_16x16x32_bf16 v[152:155], a[92:95], a[36:39], v[152:155]
ds_read_b64_tr_b16 a[84:85], v5 offset:57344
v_accvgpr_write_b32 a150, v198
v_mfma_f32_16x16x32_bf16 v[160:163], a[92:95], a[44:47], v[160:163]
ds_read_b64_tr_b16 a[86:87], v5 offset:58368
v_accvgpr_write_b32 a151, v199
v_mfma_f32_16x16x32_bf16 v[160:163], a[88:91], a[40:43], v[160:163]
v_cvt_pk_bf16_f32 v191, v190, v191
v_cvt_pk_bf16_f32 v190, v188, v189
v_mfma_f32_16x16x32_bf16 v[168:171], a[88:91], a[48:51], v[168:171]
v_cvt_pk_bf16_f32 v188, v184, v185
v_cvt_pk_bf16_f32 v189, v186, v187
v_mfma_f32_16x16x32_bf16 v[168:171], a[92:95], a[52:55], v[168:171]
v_accvgpr_write_b32 a152, v188
v_accvgpr_write_b32 a153, v189
v_mfma_f32_16x16x32_bf16 v[176:179], a[92:95], a[60:63], v[176:179]
s_xor_b32 m0, s84, 32768
v_accvgpr_write_b32 a154, v190
v_accvgpr_write_b32 a155, v191
v_mfma_f32_16x16x32_bf16 v[176:179], a[88:91], a[56:59], v[176:179]
s_add_u32 s67, s79, 21504
s_xor_b32 s64, s72, 128
ds_read_b64_tr_b16 a[88:89], v6 offset:49152
v_cvt_pk_bf16_f32 v247, v246, v247
v_mfma_f32_16x16x32_bf16 v[180:183], a[96:99], a[56:59], v[180:183]
buffer_load_dwordx4 v12, s[48:51], s64 offen lds
v_mfma_f32_16x16x32_bf16 v[180:183], a[100:103], a[60:63], v[180:183]
ds_read_b64_tr_b16 a[90:91], v6 offset:50176
v_cvt_pk_bf16_f32 v246, v244, v245
v_mfma_f32_16x16x32_bf16 v[172:175], a[100:103], a[52:55], v[172:175]
ds_read_b64_tr_b16 a[92:93], v6 offset:57344
v_cvt_pk_bf16_f32 v244, v240, v241
v_mfma_f32_16x16x32_bf16 v[172:175], a[96:99], a[48:51], v[172:175]
ds_read_b64_tr_b16 a[94:95], v6 offset:58368
v_cvt_pk_bf16_f32 v245, v242, v243
v_mfma_f32_16x16x32_bf16 v[164:167], a[96:99], a[40:43], v[164:167]
buffer_store_dwordx4 v[244:247], v16, s[44:47], s67 offen sc1
v_mfma_f32_16x16x32_bf16 v[164:167], a[100:103], a[44:47], v[164:167]
s_xor_b32 m0, s84, 33792
v_cvt_pk_bf16_f32 v239, v238, v239
v_cvt_pk_bf16_f32 v238, v236, v237
v_mfma_f32_16x16x32_bf16 v[156:159], a[100:103], a[36:39], v[156:159]
s_xor_b32 s64, s72, 16512
v_cvt_pk_bf16_f32 v236, v232, v233
v_cvt_pk_bf16_f32 v237, v234, v235
v_mfma_f32_16x16x32_bf16 v[156:159], a[96:99], a[32:35], v[156:159]
buffer_load_dwordx4 v13, s[48:51], s64 offen lds
v_mfma_f32_16x16x32_bf16 v[24:27], a[104:107], a[32:35], v[24:27]
ds_read_b64_tr_b16 a[96:97], v7 offset:49152
v_accvgpr_write_b32 a156, v236
v_mfma_f32_16x16x32_bf16 v[24:27], a[108:111], a[36:39], v[24:27]
ds_read_b64_tr_b16 a[98:99], v7 offset:50176
v_accvgpr_write_b32 a157, v237
v_mfma_f32_16x16x32_bf16 v[40:43], a[108:111], a[44:47], v[40:43]
ds_read_b64_tr_b16 a[100:101], v7 offset:57344
v_accvgpr_write_b32 a158, v238
v_mfma_f32_16x16x32_bf16 v[40:43], a[104:107], a[40:43], v[40:43]
ds_read_b64_tr_b16 a[102:103], v7 offset:58368
v_accvgpr_write_b32 a159, v239
v_mfma_f32_16x16x32_bf16 v[56:59], a[104:107], a[48:51], v[56:59]
s_xor_b32 m0, s84, 34816
v_cvt_pk_bf16_f32 v231, v230, v231
v_cvt_pk_bf16_f32 v230, v228, v229
v_mfma_f32_16x16x32_bf16 v[56:59], a[108:111], a[52:55], v[56:59]
s_xor_b32 s64, s72, 131200
v_cvt_pk_bf16_f32 v228, v224, v225
v_cvt_pk_bf16_f32 v229, v226, v227
v_mfma_f32_16x16x32_bf16 v[72:75], a[108:111], a[60:63], v[72:75]
s_waitcnt vmcnt(11)
buffer_load_dwordx4 v12, s[48:51], s64 offen lds
v_mfma_f32_16x16x32_bf16 v[72:75], a[104:107], a[56:59], v[72:75]
ds_read_b64_tr_b16 a[104:105], v8 offset:49152
v_accvgpr_write_b32 a160, v228
v_mfma_f32_16x16x32_bf16 v[136:139], a[112:115], a[56:59], v[136:139]
ds_read_b64_tr_b16 a[106:107], v8 offset:50176
v_accvgpr_write_b32 a161, v229
v_mfma_f32_16x16x32_bf16 v[136:139], a[116:119], a[60:63], v[136:139]
ds_read_b64_tr_b16 a[108:109], v8 offset:57344
v_add_u32 v4, 0x8000, v4
v_mfma_f32_16x16x32_bf16 v[120:123], a[116:119], a[52:55], v[120:123]
ds_read_b64_tr_b16 a[110:111], v8 offset:58368
v_accvgpr_write_b32 a162, v230
v_mfma_f32_16x16x32_bf16 v[120:123], a[112:115], a[48:51], v[120:123]
s_xor_b32 m0, s84, 35840
ds_read_b128 a[0:3], v2 offset:0
v_accvgpr_write_b32 a163, v231
v_mfma_f32_16x16x32_bf16 v[104:107], a[112:115], a[40:43], v[104:107]
s_xor_b32 s64, s72, 147584
ds_read_b128 a[4:7], v3 offset:0
v_cvt_pk_bf16_f32 v223, v222, v223
v_mfma_f32_16x16x32_bf16 v[104:107], a[116:119], a[44:47], v[104:107]
buffer_load_dwordx4 v13, s[48:51], s64 offen lds
v_mfma_f32_16x16x32_bf16 v[88:91], a[116:119], a[36:39], v[88:91]
ds_read_b128 a[8:11], v2 offset:2048
v_cvt_pk_bf16_f32 v222, v220, v221
v_mfma_f32_16x16x32_bf16 v[88:91], a[112:115], a[32:35], v[88:91]
s_waitcnt lgkmcnt(7)
ds_read_b128 a[12:15], v3 offset:2048
v_cvt_pk_bf16_f32 v220, v216, v217
v_mfma_f32_16x16x32_bf16 v[28:31], a[32:35], a[72:75], v[28:31]
ds_read_b128 a[16:19], v2 offset:4096
v_cvt_pk_bf16_f32 v221, v218, v219
v_mfma_f32_16x16x32_bf16 v[28:31], a[36:39], a[76:79], v[28:31]
ds_read_b128 a[20:23], v3 offset:4096
v_add_u32 v5, 0x8000, v5
v_mfma_f32_16x16x32_bf16 v[44:47], a[44:47], a[76:79], v[44:47]
s_xor_b32 m0, s84, 36864
ds_read_b128 a[24:27], v2 offset:6144
v_accvgpr_write_b32 a164, v220
v_mfma_f32_16x16x32_bf16 v[44:47], a[40:43], a[72:75], v[44:47]
s_xor_b32 s64, s73, 128
ds_read_b128 a[28:31], v3 offset:6144
v_accvgpr_write_b32 a165, v221
v_mfma_f32_16x16x32_bf16 v[60:63], a[48:51], a[72:75], v[60:63]
buffer_load_dwordx4 v12, s[48:51], s64 offen lds
v_mfma_f32_16x16x32_bf16 v[60:63], a[52:55], a[76:79], v[60:63]
ds_read_b64_tr_b16 a[112:113], v9 offset:49152
v_accvgpr_write_b32 a166, v222
v_mfma_f32_16x16x32_bf16 v[76:79], a[60:63], a[76:79], v[76:79]
ds_read_b64_tr_b16 a[114:115], v9 offset:50176
v_accvgpr_write_b32 a167, v223
v_mfma_f32_16x16x32_bf16 v[76:79], a[56:59], a[72:75], v[76:79]
s_add_u32 s67, s79, 22528
ds_read_b64_tr_b16 a[116:117], v9 offset:57344
v_cvt_pk_bf16_f32 v183, v182, v183
v_mfma_f32_16x16x32_bf16 v[140:143], a[56:59], a[80:83], v[140:143]
ds_read_b64_tr_b16 a[118:119], v9 offset:58368
v_cvt_pk_bf16_f32 v182, v180, v181
v_mfma_f32_16x16x32_bf16 v[140:143], a[60:63], a[84:87], v[140:143]
s_xor_b32 m0, s84, 37888
ds_read_b64_tr_b16 a[72:73], v10 offset:49152
v_add_u32 v6, 0x8000, v6
v_mfma_f32_16x16x32_bf16 v[124:127], a[52:55], a[84:87], v[124:127]
s_xor_b32 s64, s73, 16512
ds_read_b64_tr_b16 a[74:75], v10 offset:50176
v_cvt_pk_bf16_f32 v180, v176, v177
v_mfma_f32_16x16x32_bf16 v[124:127], a[48:51], a[80:83], v[124:127]
buffer_load_dwordx4 v13, s[48:51], s64 offen lds
v_mfma_f32_16x16x32_bf16 v[108:111], a[40:43], a[80:83], v[108:111]
ds_read_b64_tr_b16 a[76:77], v10 offset:57344
v_cvt_pk_bf16_f32 v181, v178, v179
v_mfma_f32_16x16x32_bf16 v[108:111], a[44:47], a[84:87], v[108:111]
ds_read_b64_tr_b16 a[78:79], v10 offset:58368
v_mfma_f32_16x16x32_bf16 v[92:95], a[36:39], a[84:87], v[92:95]
buffer_store_dwordx4 v[180:183], v16, s[44:47], s67 offen sc1
v_mfma_f32_16x16x32_bf16 v[92:95], a[32:35], a[80:83], v[92:95]
ds_read_b64_tr_b16 a[80:81], v11 offset:49152
v_cvt_pk_bf16_f32 v175, v174, v175
v_mfma_f32_16x16x32_bf16 v[32:35], a[32:35], a[88:91], v[32:35]
s_xor_b32 m0, s84, 38912
ds_read_b64_tr_b16 a[82:83], v11 offset:50176
v_cvt_pk_bf16_f32 v174, v172, v173
v_mfma_f32_16x16x32_bf16 v[32:35], a[36:39], a[92:95], v[32:35]
s_xor_b32 s64, s73, 131200
ds_read_b64_tr_b16 a[84:85], v11 offset:57344
v_add_u32 v7, 0x8000, v7
v_mfma_f32_16x16x32_bf16 v[48:51], a[44:47], a[92:95], v[48:51]
buffer_load_dwordx4 v12, s[48:51], s64 offen lds
v_mfma_f32_16x16x32_bf16 v[48:51], a[40:43], a[88:91], v[48:51]
ds_read_b64_tr_b16 a[86:87], v11 offset:58368
v_cvt_pk_bf16_f32 v172, v168, v169
v_mfma_f32_16x16x32_bf16 v[64:67], a[48:51], a[88:91], v[64:67]
v_cvt_pk_bf16_f32 v173, v170, v171
v_accvgpr_write_b32 a168, v172
v_mfma_f32_16x16x32_bf16 v[64:67], a[52:55], a[92:95], v[64:67]
v_accvgpr_write_b32 a169, v173
v_accvgpr_write_b32 a170, v174
v_mfma_f32_16x16x32_bf16 v[80:83], a[60:63], a[92:95], v[80:83]
v_accvgpr_write_b32 a171, v175
v_cvt_pk_bf16_f32 v167, v166, v167
v_mfma_f32_16x16x32_bf16 v[80:83], a[56:59], a[88:91], v[80:83]
s_xor_b32 m0, s84, 39936
v_cvt_pk_bf16_f32 v166, v164, v165
v_cvt_pk_bf16_f32 v164, v160, v161
v_mfma_f32_16x16x32_bf16 v[144:147], a[56:59], a[96:99], v[144:147]
s_xor_b32 s64, s73, 147584
v_cvt_pk_bf16_f32 v165, v162, v163
v_accvgpr_write_b32 a172, v164
v_mfma_f32_16x16x32_bf16 v[144:147], a[60:63], a[100:103], v[144:147]
buffer_load_dwordx4 v13, s[48:51], s64 offen lds
v_mfma_f32_16x16x32_bf16 v[128:131], a[52:55], a[100:103], v[128:131]
v_add_u32 v8, 0x8000, v8
v_accvgpr_write_b32 a173, v165
v_mfma_f32_16x16x32_bf16 v[128:131], a[48:51], a[96:99], v[128:131]
v_accvgpr_write_b32 a174, v166
v_accvgpr_write_b32 a175, v167
v_mfma_f32_16x16x32_bf16 v[112:115], a[40:43], a[96:99], v[112:115]
v_cvt_pk_bf16_f32 v159, v158, v159
v_cvt_pk_bf16_f32 v158, v156, v157
v_mfma_f32_16x16x32_bf16 v[112:115], a[44:47], a[100:103], v[112:115]
v_cvt_pk_bf16_f32 v156, v152, v153
v_cvt_pk_bf16_f32 v157, v154, v155
v_mfma_f32_16x16x32_bf16 v[96:99], a[36:39], a[100:103], v[96:99]
v_add_u32 v9, 0x8000, v9
v_add_u32 v10, 0x8000, v10
v_mfma_f32_16x16x32_bf16 v[96:99], a[32:35], a[96:99], v[96:99]
s_waitcnt lgkmcnt(0)
v_add_u32 v11, 0x8000, v11
v_accvgpr_write_b32 a176, v156
v_mfma_f32_16x16x32_bf16 v[36:39], a[32:35], a[104:107], v[36:39]
v_accvgpr_write_b32 a177, v157
v_accvgpr_write_b32 a178, v158
v_mfma_f32_16x16x32_bf16 v[36:39], a[36:39], a[108:111], v[36:39]
v_accvgpr_write_b32 a179, v159
v_mfma_f32_16x16x32_bf16 v[52:55], a[44:47], a[108:111], v[52:55]
s_add_u32 s67, s79, 23552
s_waitcnt lgkmcnt(0)
s_barrier
v_mfma_f32_16x16x32_bf16 v[52:55], a[40:43], a[104:107], v[52:55]
s_xor_b32 m0, s77, 98304
ds_read_b64_tr_b16 a[88:89], v19 offset:36864
v_cvt_pk_bf16_f32 v139, v138, v139
v_mfma_f32_16x16x32_bf16 v[68:71], a[48:51], a[104:107], v[68:71]
s_xor_b32 s64, s71, 1048576
ds_read_b64_tr_b16 a[90:91], v19 offset:37120
v_cvt_pk_bf16_f32 v138, v136, v137
v_mfma_f32_16x16x32_bf16 v[68:71], a[52:55], a[108:111], v[68:71]
buffer_load_dwordx4 v14, s[56:59], s64 offen lds
v_mfma_f32_16x16x32_bf16 v[84:87], a[60:63], a[108:111], v[84:87]
ds_read_b64_tr_b16 a[92:93], v19 offset:38912
v_cvt_pk_bf16_f32 v136, v72, v73
v_mfma_f32_16x16x32_bf16 v[84:87], a[56:59], a[104:107], v[84:87]
ds_read_b64_tr_b16 a[94:95], v19 offset:39168
v_cvt_pk_bf16_f32 v137, v74, v75
v_mfma_f32_16x16x32_bf16 v[148:151], a[56:59], a[112:115], v[148:151]
ds_read_b64_tr_b16 a[96:97], v20 offset:36864
v_mfma_f32_16x16x32_bf16 v[148:151], a[60:63], a[116:119], v[148:151]
ds_read_b64_tr_b16 a[98:99], v20 offset:37120
v_mfma_f32_16x16x32_bf16 v[132:135], a[52:55], a[116:119], v[132:135]
ds_read_b64_tr_b16 a[100:101], v20 offset:38912
v_mfma_f32_16x16x32_bf16 v[132:135], a[48:51], a[112:115], v[132:135]
ds_read_b64_tr_b16 a[102:103], v20 offset:39168
v_mfma_f32_16x16x32_bf16 v[116:119], a[40:43], a[112:115], v[116:119]
s_add_u32 m0, s78, 114688
ds_read_b64_tr_b16 a[104:105], v19 offset:40960
v_mfma_f32_16x16x32_bf16 v[116:119], a[44:47], a[116:119], v[116:119]
s_add_u32 s64, s75, 786432
ds_read_b64_tr_b16 a[106:107], v19 offset:41216
v_mfma_f32_16x16x32_bf16 v[100:103], a[36:39], a[116:119], v[100:103]
buffer_load_dwordx4 v23, s[60:63], s64 offen lds
v_mfma_f32_16x16x32_bf16 v[100:103], a[32:35], a[112:115], v[100:103]
ds_read_b64_tr_b16 a[108:109], v19 offset:43008
v_mfma_f32_16x16x32_bf16 v[248:251], a[32:35], a[72:75], v[248:251]
ds_read_b64_tr_b16 a[110:111], v19 offset:43264
v_mfma_f32_16x16x32_bf16 v[248:251], a[36:39], a[76:79], v[248:251]
ds_read_b64_tr_b16 a[112:113], v20 offset:40960
v_mfma_f32_16x16x32_bf16 v[252:255], a[44:47], a[76:79], v[252:255]
ds_read_b64_tr_b16 a[114:115], v20 offset:41216
v_mfma_f32_16x16x32_bf16 v[252:255], a[40:43], a[72:75], v[252:255]
ds_read_b64_tr_b16 a[116:117], v20 offset:43008
v_mfma_f32_16x16x32_bf16 a[120:123], a[48:51], a[72:75], a[120:123]
ds_read_b64_tr_b16 a[118:119], v20 offset:43264
v_mfma_f32_16x16x32_bf16 a[120:123], a[52:55], a[76:79], a[120:123]
s_xor_b32 m0, s77, 99328
buffer_store_dwordx4 v[136:139], v16, s[44:47], s67 offen sc1
v_mfma_f32_16x16x32_bf16 a[124:127], a[60:63], a[76:79], a[124:127]
s_xor_b32 s64, s71, 1081344
v_cvt_pk_bf16_f32 v123, v122, v123
v_cvt_pk_bf16_f32 v122, v120, v121
v_mfma_f32_16x16x32_bf16 a[124:127], a[56:59], a[72:75], a[124:127]
buffer_load_dwordx4 v14, s[56:59], s64 offen lds
v_mfma_f32_16x16x32_bf16 a[128:131], a[56:59], a[80:83], a[128:131]
ds_read_b64_tr_b16 a[72:73], v19 offset:32768
v_cvt_pk_bf16_f32 v120, v56, v57
v_mfma_f32_16x16x32_bf16 a[128:131], a[60:63], a[84:87], a[128:131]
ds_read_b64_tr_b16 a[74:75], v19 offset:33024
v_cvt_pk_bf16_f32 v121, v58, v59
v_mfma_f32_16x16x32_bf16 a[132:135], a[52:55], a[84:87], a[132:135]
ds_read_b64_tr_b16 a[76:77], v19 offset:34816
v_accvgpr_write_b32 a180, v120
v_mfma_f32_16x16x32_bf16 a[132:135], a[48:51], a[80:83], a[132:135]
ds_read_b64_tr_b16 a[78:79], v19 offset:35072
v_accvgpr_write_b32 a181, v121
v_mfma_f32_16x16x32_bf16 a[136:139], a[40:43], a[80:83], a[136:139]
v_accvgpr_write_b32 a182, v122
v_accvgpr_write_b32 a183, v123
v_mfma_f32_16x16x32_bf16 a[136:139], a[44:47], a[84:87], a[136:139]
v_cvt_pk_bf16_f32 v107, v106, v107
v_cvt_pk_bf16_f32 v106, v104, v105
v_mfma_f32_16x16x32_bf16 a[140:143], a[36:39], a[84:87], a[140:143]
s_add_u32 m0, s78, 118784
v_cvt_pk_bf16_f32 v104, v40, v41
v_cvt_pk_bf16_f32 v105, v42, v43
v_mfma_f32_16x16x32_bf16 a[140:143], a[32:35], a[80:83], a[140:143]
s_waitcnt lgkmcnt(4)
s_add_u32 s64, s75, 788480
ds_read_b64_tr_b16 a[80:81], v20 offset:32768
v_accvgpr_write_b32 a184, v104
v_mfma_f32_16x16x32_bf16 v[184:187], a[88:91], a[0:3], 0
buffer_load_dwordx4 v23, s[60:63], s64 offen lds
v_mfma_f32_16x16x32_bf16 v[184:187], a[92:95], a[4:7], v[184:187]
ds_read_b64_tr_b16 a[82:83], v20 offset:33024
v_accvgpr_write_b32 a185, v105
v_mfma_f32_16x16x32_bf16 v[192:195], a[92:95], a[12:15], 0
ds_read_b64_tr_b16 a[84:85], v20 offset:34816
v_accvgpr_write_b32 a186, v106
v_mfma_f32_16x16x32_bf16 v[192:195], a[88:91], a[8:11], v[192:195]
ds_read_b64_tr_b16 a[86:87], v20 offset:35072
v_accvgpr_write_b32 a187, v107
v_mfma_f32_16x16x32_bf16 v[200:203], a[88:91], a[16:19], 0
v_cvt_pk_bf16_f32 v91, v90, v91
v_cvt_pk_bf16_f32 v90, v88, v89
v_mfma_f32_16x16x32_bf16 v[200:203], a[92:95], a[20:23], v[200:203]
v_cvt_pk_bf16_f32 v88, v24, v25
v_cvt_pk_bf16_f32 v89, v26, v27
v_mfma_f32_16x16x32_bf16 v[208:211], a[92:95], a[28:31], 0
v_accvgpr_write_b32 a188, v88
v_accvgpr_write_b32 a189, v89
v_mfma_f32_16x16x32_bf16 v[208:211], a[88:91], a[24:27], v[208:211]
s_xor_b32 m0, s77, 100352
ds_read_b64_tr_b16 a[88:89], v4 offset:32768
v_accvgpr_write_b32 a190, v90
v_mfma_f32_16x16x32_bf16 v[212:215], a[96:99], a[24:27], 0
s_xor_b32 s64, s71, 1114112
ds_read_b64_tr_b16 a[90:91], v4 offset:33792
v_accvgpr_write_b32 a191, v91
v_mfma_f32_16x16x32_bf16 v[212:215], a[100:103], a[28:31], v[212:215]
s_add_u32 s67, s79, 8192
ds_read_b64_tr_b16 a[92:93], v4 offset:40960
v_cvt_pk_bf16_f32 v47, v46, v47
v_mfma_f32_16x16x32_bf16 v[204:207], a[100:103], a[20:23], 0
buffer_load_dwordx4 v15, s[56:59], s64 offen lds
v_mfma_f32_16x16x32_bf16 v[204:207], a[96:99], a[16:19], v[204:207]
ds_read_b64_tr_b16 a[94:95], v4 offset:41984
v_cvt_pk_bf16_f32 v46, v44, v45
v_mfma_f32_16x16x32_bf16 v[196:199], a[96:99], a[8:11], 0
v_cvt_pk_bf16_f32 v44, v28, v29
v_cvt_pk_bf16_f32 v45, v30, v31
v_mfma_f32_16x16x32_bf16 v[196:199], a[100:103], a[12:15], v[196:199]
buffer_store_dwordx4 v[44:47], v16, s[44:47], s67 offen sc1
v_mfma_f32_16x16x32_bf16 v[188:191], a[100:103], a[4:7], 0
v_cvt_pk_bf16_f32 v79, v78, v79
v_cvt_pk_bf16_f32 v78, v76, v77
v_mfma_f32_16x16x32_bf16 v[188:191], a[96:99], a[0:3], v[188:191]
s_branch L_po6
L_pg6:
s_branch L_pg10
L_po6:
ds_read_b64_tr_b16 a[96:97], v5 offset:32768
v_cvt_pk_bf16_f32 v76, v60, v61
v_mfma_f32_16x16x32_bf16 v[216:219], a[0:3], a[104:107], 0
ds_read_b64_tr_b16 a[98:99], v5 offset:33792
v_cvt_pk_bf16_f32 v77, v62, v63
v_mfma_f32_16x16x32_bf16 v[216:219], a[4:7], a[108:111], v[216:219]
s_add_u32 m0, s78, 122880
ds_read_b64_tr_b16 a[100:101], v5 offset:40960
v_accvgpr_write_b32 a192, v76
v_mfma_f32_16x16x32_bf16 v[224:227], a[12:15], a[108:111], 0
s_add_u32 s64, s75, 790528
ds_read_b64_tr_b16 a[102:103], v5 offset:41984
v_accvgpr_write_b32 a193, v77
v_mfma_f32_16x16x32_bf16 v[224:227], a[8:11], a[104:107], v[224:227]
buffer_load_dwordx4 v23, s[60:63], s64 offen lds
v_mfma_f32_16x16x32_bf16 v[232:235], a[16:19], a[104:107], 0
v_accvgpr_write_b32 a194, v78
v_accvgpr_write_b32 a195, v79
v_mfma_f32_16x16x32_bf16 v[232:235], a[20:23], a[108:111], v[232:235]
v_cvt_pk_bf16_f32 v124, v124, v125
v_cvt_pk_bf16_f32 v125, v126, v127
v_mfma_f32_16x16x32_bf16 v[240:243], a[28:31], a[108:111], 0
v_cvt_pk_bf16_f32 v126, v140, v141
v_cvt_pk_bf16_f32 v127, v142, v143
v_mfma_f32_16x16x32_bf16 v[240:243], a[24:27], a[104:107], v[240:243]
ds_read_b64_tr_b16 a[104:105], v6 offset:32768
v_accvgpr_write_b32 a196, v124
v_mfma_f32_16x16x32_bf16 v[244:247], a[24:27], a[112:115], 0
ds_read_b64_tr_b16 a[106:107], v6 offset:33792
v_accvgpr_write_b32 a197, v125
v_mfma_f32_16x16x32_bf16 v[244:247], a[28:31], a[116:119], v[244:247]
ds_read_b64_tr_b16 a[108:109], v6 offset:40960
v_accvgpr_write_b32 a198, v126
v_mfma_f32_16x16x32_bf16 v[236:239], a[20:23], a[116:119], 0
s_xor_b32 m0, s77, 101376
ds_read_b64_tr_b16 a[110:111], v6 offset:41984
v_accvgpr_write_b32 a199, v127
v_mfma_f32_16x16x32_bf16 v[236:239], a[16:19], a[112:115], v[236:239]
s_xor_b32 s64, s71, 1146880
v_cvt_pk_bf16_f32 v92, v92, v93
v_cvt_pk_bf16_f32 v93, v94, v95
v_mfma_f32_16x16x32_bf16 v[228:231], a[8:11], a[112:115], 0
buffer_load_dwordx4 v15, s[56:59], s64 offen lds
v_mfma_f32_16x16x32_bf16 v[228:231], a[12:15], a[116:119], v[228:231]
v_cvt_pk_bf16_f32 v94, v108, v109
v_cvt_pk_bf16_f32 v95, v110, v111
v_mfma_f32_16x16x32_bf16 v[220:223], a[4:7], a[116:119], 0
v_accvgpr_write_b32 a200, v92
v_accvgpr_write_b32 a201, v93
v_mfma_f32_16x16x32_bf16 v[220:223], a[0:3], a[112:115], v[220:223]
s_waitcnt lgkmcnt(4)
ds_read_b64_tr_b16 a[112:113], v7 offset:32768
v_accvgpr_write_b32 a202, v94
v_mfma_f32_16x16x32_bf16 v[152:155], a[72:75], a[0:3], 0
ds_read_b64_tr_b16 a[114:115], v7 offset:33792
v_accvgpr_write_b32 a203, v95
v_mfma_f32_16x16x32_bf16 v[152:155], a[76:79], a[4:7], v[152:155]
s_add_u32 s67, s79, 10240
ds_read_b64_tr_b16 a[116:117], v7 offset:40960
v_cvt_pk_bf16_f32 v51, v50, v51
v_mfma_f32_16x16x32_bf16 v[160:163], a[76:79], a[12:15], 0
ds_read_b64_tr_b16 a[118:119], v7 offset:41984
v_cvt_pk_bf16_f32 v50, v48, v49
v_mfma_f32_16x16x32_bf16 v[160:163], a[72:75], a[8:11], v[160:163]
v_cvt_pk_bf16_f32 v48, v32, v33
v_cvt_pk_bf16_f32 v49, v34, v35
v_mfma_f32_16x16x32_bf16 v[168:171], a[72:75], a[16:19], 0
buffer_store_dwordx4 v[48:51], v16, s[44:47], s67 offen sc1
v_mfma_f32_16x16x32_bf16 v[168:171], a[76:79], a[20:23], v[168:171]
v_subrev_u32 v19, 0x8000, v19
v_subrev_u32 v20, 0x8000, v20
v_mfma_f32_16x16x32_bf16 v[176:179], a[76:79], a[28:31], 0
s_xor_b32 m0, s84, 0
v_cvt_pk_bf16_f32 v83, v82, v83
v_cvt_pk_bf16_f32 v82, v80, v81
v_mfma_f32_16x16x32_bf16 v[176:179], a[72:75], a[24:27], v[176:179]
s_xor_b32 s64, s72, 256
ds_read_b64_tr_b16 a[72:73], v8 offset:32768
v_cvt_pk_bf16_f32 v80, v64, v65
v_mfma_f32_16x16x32_bf16 v[180:183], a[80:83], a[24:27], 0
buffer_load_dwordx4 v12, s[48:51], s64 offen lds
v_mfma_f32_16x16x32_bf16 v[180:183], a[84:87], a[28:31], v[180:183]
ds_read_b64_tr_b16 a[74:75], v8 offset:33792
v_subrev_u32 v4, 0x8000, v4
v_mfma_f32_16x16x32_bf16 v[172:175], a[84:87], a[20:23], 0
ds_read_b64_tr_b16 a[76:77], v8 offset:40960
v_cvt_pk_bf16_f32 v81, v66, v67
v_mfma_f32_16x16x32_bf16 v[172:175], a[80:83], a[16:19], v[172:175]
s_xor_b32 m0, s84, 1024
ds_read_b64_tr_b16 a[78:79], v8 offset:41984
v_accvgpr_write_b32 a204, v80
v_mfma_f32_16x16x32_bf16 v[164:167], a[80:83], a[8:11], 0
s_xor_b32 s64, s72, 16640
v_accvgpr_write_b32 a205, v81
v_accvgpr_write_b32 a206, v82
v_mfma_f32_16x16x32_bf16 v[164:167], a[84:87], a[12:15], v[164:167]
buffer_load_dwordx4 v13, s[48:51], s64 offen lds
v_mfma_f32_16x16x32_bf16 v[156:159], a[84:87], a[4:7], 0
v_accvgpr_write_b32 a207, v83
v_cvt_pk_bf16_f32 v128, v128, v129
v_mfma_f32_16x16x32_bf16 v[156:159], a[80:83], a[0:3], v[156:159]
ds_read_b64_tr_b16 a[80:81], v9 offset:32768
v_cvt_pk_bf16_f32 v129, v130, v131
v_mfma_f32_16x16x32_bf16 v[24:27], a[88:91], a[0:3], 0
s_xor_b32 m0, s84, 2048
ds_read_b64_tr_b16 a[82:83], v9 offset:33792
v_cvt_pk_bf16_f32 v130, v144, v145
v_mfma_f32_16x16x32_bf16 v[24:27], a[92:95], a[4:7], v[24:27]
s_xor_b32 s64, s72, 131328
ds_read_b64_tr_b16 a[84:85], v9 offset:40960
v_subrev_u32 v5, 0x8000, v5
v_mfma_f32_16x16x32_bf16 v[40:43], a[92:95], a[12:15], 0
buffer_load_dwordx4 v12, s[48:51], s64 offen lds
v_mfma_f32_16x16x32_bf16 v[40:43], a[88:91], a[8:11], v[40:43]
ds_read_b64_tr_b16 a[86:87], v9 offset:41984
v_cvt_pk_bf16_f32 v131, v146, v147
v_mfma_f32_16x16x32_bf16 v[56:59], a[88:91], a[16:19], 0
s_xor_b32 m0, s84, 3072
v_accvgpr_write_b32 a208, v128
v_accvgpr_write_b32 a209, v129
v_mfma_f32_16x16x32_bf16 v[56:59], a[92:95], a[20:23], v[56:59]
s_xor_b32 s64, s72, 147712
v_accvgpr_write_b32 a210, v130
v_accvgpr_write_b32 a211, v131
v_mfma_f32_16x16x32_bf16 v[72:75], a[92:95], a[28:31], 0
s_waitcnt vmcnt(13)
ds_read_b128 a[32:35], v2 offset:32768
v_cvt_pk_bf16_f32 v96, v96, v97
v_mfma_f32_16x16x32_bf16 v[72:75], a[88:91], a[24:27], v[72:75]
buffer_load_dwordx4 v13, s[48:51], s64 offen lds
v_mfma_f32_16x16x32_bf16 v[136:139], a[96:99], a[24:27], 0
ds_read_b128 a[36:39], v3 offset:32768
v_cvt_pk_bf16_f32 v97, v98, v99
v_mfma_f32_16x16x32_bf16 v[136:139], a[100:103], a[28:31], v[136:139]
ds_read_b128 a[40:43], v2 offset:34816
v_subrev_u32 v6, 0x8000, v6
v_mfma_f32_16x16x32_bf16 v[120:123], a[100:103], a[20:23], 0
s_xor_b32 m0, s84, 4096
ds_read_b128 a[44:47], v3 offset:34816
v_cvt_pk_bf16_f32 v98, v112, v113
v_mfma_f32_16x16x32_bf16 v[120:123], a[96:99], a[16:19], v[120:123]
s_xor_b32 s64, s73, 256
ds_read_b128 a[48:51], v2 offset:36864
v_cvt_pk_bf16_f32 v99, v114, v115
v_mfma_f32_16x16x32_bf16 v[104:107], a[96:99], a[8:11], 0
buffer_load_dwordx4 v12, s[48:51], s64 offen lds
v_mfma_f32_16x16x32_bf16 v[104:107], a[100:103], a[12:15], v[104:107]
ds_read_b128 a[52:55], v3 offset:36864
v_accvgpr_write_b32 a212, v96
v_mfma_f32_16x16x32_bf16 v[88:91], a[100:103], a[4:7], 0
ds_read_b128 a[56:59], v2 offset:38912
v_accvgpr_write_b32 a213, v97
v_mfma_f32_16x16x32_bf16 v[88:91], a[96:99], a[0:3], v[88:91]
s_waitcnt lgkmcnt(7)
s_xor_b32 m0, s84, 5120
ds_read_b128 a[60:63], v3 offset:38912
v_accvgpr_write_b32 a214, v98
v_mfma_f32_16x16x32_bf16 v[28:31], a[104:107], a[0:3], 0
s_xor_b32 s64, s73, 16640
ds_read_b64_tr_b16 a[88:89], v10 offset:32768
v_accvgpr_write_b32 a215, v99
v_mfma_f32_16x16x32_bf16 v[28:31], a[108:111], a[4:7], v[28:31]
s_add_u32 s67, s79, 12288
buffer_load_dwordx4 v13, s[48:51], s64 offen lds
v_mfma_f32_16x16x32_bf16 v[44:47], a[108:111], a[12:15], 0
ds_read_b64_tr_b16 a[90:91], v10 offset:33792
v_subrev_u32 v7, 0x8000, v7
v_mfma_f32_16x16x32_bf16 v[44:47], a[104:107], a[8:11], v[44:47]
ds_read_b64_tr_b16 a[92:93], v10 offset:40960
v_cvt_pk_bf16_f32 v55, v54, v55
v_mfma_f32_16x16x32_bf16 v[60:63], a[104:107], a[16:19], 0
s_xor_b32 m0, s84, 6144
ds_read_b64_tr_b16 a[94:95], v10 offset:41984
v_cvt_pk_bf16_f32 v54, v52, v53
v_mfma_f32_16x16x32_bf16 v[60:63], a[108:111], a[20:23], v[60:63]
s_xor_b32 s64, s73, 131328
ds_read_b64_tr_b16 a[96:97], v11 offset:32768
v_cvt_pk_bf16_f32 v52, v36, v37
v_mfma_f32_16x16x32_bf16 v[76:79], a[108:111], a[28:31], 0
buffer_load_dwordx4 v12, s[48:51], s64 offen lds
v_mfma_f32_16x16x32_bf16 v[76:79], a[104:107], a[24:27], v[76:79]
ds_read_b64_tr_b16 a[98:99], v11 offset:33792
v_cvt_pk_bf16_f32 v53, v38, v39
v_mfma_f32_16x16x32_bf16 v[140:143], a[112:115], a[24:27], 0
ds_read_b64_tr_b16 a[100:101], v11 offset:40960
v_mfma_f32_16x16x32_bf16 v[140:143], a[116:119], a[28:31], v[140:143]
s_xor_b32 m0, s84, 7168
ds_read_b64_tr_b16 a[102:103], v11 offset:41984
v_subrev_u32 v8, 0x8000, v8
v_mfma_f32_16x16x32_bf16 v[124:127], a[116:119], a[20:23], 0
s_xor_b32 s64, s73, 147712
buffer_store_dwordx4 v[52:55], v16, s[44:47], s67 offen sc1
v_mfma_f32_16x16x32_bf16 v[124:127], a[112:115], a[16:19], v[124:127]
buffer_load_dwordx4 v13, s[48:51], s64 offen lds
v_mfma_f32_16x16x32_bf16 v[108:111], a[112:115], a[8:11], 0
v_cvt_pk_bf16_f32 v87, v86, v87
v_cvt_pk_bf16_f32 v86, v84, v85
v_mfma_f32_16x16x32_bf16 v[108:111], a[116:119], a[12:15], v[108:111]
v_cvt_pk_bf16_f32 v84, v68, v69
v_cvt_pk_bf16_f32 v85, v70, v71
v_mfma_f32_16x16x32_bf16 v[92:95], a[116:119], a[4:7], 0
v_subrev_u32 v9, 0x8000, v9
v_subrev_u32 v10, 0x8000, v10
v_mfma_f32_16x16x32_bf16 v[92:95], a[112:115], a[0:3], v[92:95]
v_subrev_u32 v11, 0x8000, v11
v_accvgpr_write_b32 a216, v84
v_mfma_f32_16x16x32_bf16 v[32:35], a[72:75], a[0:3], 0
v_accvgpr_write_b32 a217, v85
v_accvgpr_write_b32 a218, v86
v_mfma_f32_16x16x32_bf16 v[32:35], a[76:79], a[4:7], v[32:35]
v_accvgpr_write_b32 a219, v87
v_cvt_pk_bf16_f32 v132, v132, v133
v_mfma_f32_16x16x32_bf16 v[48:51], a[76:79], a[12:15], 0
s_waitcnt lgkmcnt(0)
s_barrier
v_mfma_f32_16x16x32_bf16 v[48:51], a[72:75], a[8:11], v[48:51]
s_xor_b32 m0, s77, 131072
ds_read_b64_tr_b16 a[104:105], v19 offset:4096
v_cvt_pk_bf16_f32 v133, v134, v135
v_mfma_f32_16x16x32_bf16 v[64:67], a[72:75], a[16:19], 0
s_xor_b32 s64, s71, 1572864
ds_read_b64_tr_b16 a[106:107], v19 offset:4352
v_cvt_pk_bf16_f32 v134, v148, v149
v_mfma_f32_16x16x32_bf16 v[64:67], a[76:79], a[20:23], v[64:67]
buffer_load_dwordx4 v14, s[56:59], s64 offen lds
v_mfma_f32_16x16x32_bf16 v[80:83], a[76:79], a[28:31], 0
ds_read_b64_tr_b16 a[108:109], v19 offset:6144
v_cvt_pk_bf16_f32 v135, v150, v151
v_mfma_f32_16x16x32_bf16 v[80:83], a[72:75], a[24:27], v[80:83]
ds_read_b64_tr_b16 a[110:111], v19 offset:6400
v_accvgpr_write_b32 a220, v132
v_mfma_f32_16x16x32_bf16 v[144:147], a[80:83], a[24:27], 0
ds_read_b64_tr_b16 a[112:113], v20 offset:4096
v_accvgpr_write_b32 a221, v133
v_mfma_f32_16x16x32_bf16 v[144:147], a[84:87], a[28:31], v[144:147]
ds_read_b64_tr_b16 a[114:115], v20 offset:4352
v_accvgpr_write_b32 a222, v134
v_mfma_f32_16x16x32_bf16 v[128:131], a[84:87], a[20:23], 0
ds_read_b64_tr_b16 a[116:117], v20 offset:6144
v_accvgpr_write_b32 a223, v135
v_mfma_f32_16x16x32_bf16 v[128:131], a[80:83], a[16:19], v[128:131]
ds_read_b64_tr_b16 a[118:119], v20 offset:6400
v_cvt_pk_bf16_f32 v100, v100, v101
v_mfma_f32_16x16x32_bf16 v[112:115], a[80:83], a[8:11], 0
s_add_u32 m0, s78, 147456
ds_read_b64_tr_b16 a[72:73], v19 offset:8192
v_cvt_pk_bf16_f32 v101, v102, v103
v_mfma_f32_16x16x32_bf16 v[112:115], a[84:87], a[12:15], v[112:115]
s_add_u32 s64, s75, 1179648
ds_read_b64_tr_b16 a[74:75], v19 offset:8448
v_cvt_pk_bf16_f32 v102, v116, v117
v_mfma_f32_16x16x32_bf16 v[96:99], a[84:87], a[4:7], 0
buffer_load_dwordx4 v23, s[60:63], s64 offen lds
v_mfma_f32_16x16x32_bf16 v[96:99], a[80:83], a[0:3], v[96:99]
ds_read_b64_tr_b16 a[76:77], v19 offset:10240
v_cvt_pk_bf16_f32 v103, v118, v119
v_mfma_f32_16x16x32_bf16 v[36:39], a[88:91], a[0:3], 0
ds_read_b64_tr_b16 a[78:79], v19 offset:10496
v_accvgpr_write_b32 a224, v100
v_mfma_f32_16x16x32_bf16 v[36:39], a[92:95], a[4:7], v[36:39]
ds_read_b64_tr_b16 a[80:81], v20 offset:8192
v_accvgpr_write_b32 a225, v101
v_mfma_f32_16x16x32_bf16 v[52:55], a[92:95], a[12:15], 0
s_xor_b32 s68, s66, 0
ds_read_b64_tr_b16 a[82:83], v20 offset:8448
v_accvgpr_write_b32 a226, v102
v_mfma_f32_16x16x32_bf16 v[52:55], a[88:91], a[8:11], v[52:55]
s_xor_b32 m0, s77, 132096
ds_read_b64_tr_b16 a[84:85], v20 offset:10240
v_accvgpr_write_b32 a227, v103
v_mfma_f32_16x16x32_bf16 v[68:71], a[88:91], a[16:19], 0
s_add_u32 s67, s79, 14336
ds_read_b64_tr_b16 a[86:87], v20 offset:10496
v_cvt_pk_bf16_f32 v255, v254, v255
v_mfma_f32_16x16x32_bf16 v[68:71], a[92:95], a[20:23], v[68:71]
s_xor_b32 s64, s71, 1605632
v_cvt_pk_bf16_f32 v254, v252, v253
v_cvt_pk_bf16_f32 v252, v248, v249
v_mfma_f32_16x16x32_bf16 v[84:87], a[92:95], a[28:31], 0
s_mov_b64 exec, 1
buffer_atomic_add a251, v1, s[52:55], s68 offen offset:0 sc1
s_mov_b64 exec, -1
v_mfma_f32_16x16x32_bf16 v[84:87], a[88:91], a[24:27], v[84:87]
buffer_load_dwordx4 v14, s[56:59], s64 offen lds
v_mfma_f32_16x16x32_bf16 v[148:151], a[96:99], a[24:27], 0
ds_read_b64_tr_b16 a[88:89], v19 offset:0
v_cvt_pk_bf16_f32 v253, v250, v251
v_mfma_f32_16x16x32_bf16 v[148:151], a[100:103], a[28:31], v[148:151]
ds_read_b64_tr_b16 a[90:91], v19 offset:256
v_mfma_f32_16x16x32_bf16 v[132:135], a[100:103], a[20:23], 0
ds_read_b64_tr_b16 a[92:93], v19 offset:2048
v_mfma_f32_16x16x32_bf16 v[132:135], a[96:99], a[16:19], v[132:135]
s_add_u32 s65, s79, 16384
ds_read_b64_tr_b16 a[94:95], v19 offset:2304
v_mfma_f32_16x16x32_bf16 v[116:119], a[96:99], a[8:11], 0
buffer_store_dwordx4 a[144:147], v16, s[44:47], s65 offen sc1
v_mfma_f32_16x16x32_bf16 v[116:119], a[100:103], a[12:15], v[116:119]
buffer_store_dwordx4 v[252:255], v16, s[44:47], s67 offen sc1
v_mfma_f32_16x16x32_bf16 v[100:103], a[100:103], a[4:7], 0
s_add_u32 m0, s78, 151552
v_mfma_f32_16x16x32_bf16 v[100:103], a[96:99], a[0:3], v[100:103]
s_waitcnt lgkmcnt(4)
s_add_u32 s64, s75, 1181696
ds_read_b64_tr_b16 a[96:97], v20 offset:0
v_accvgpr_read_b32 v248, a120
v_mfma_f32_16x16x32_bf16 v[184:187], a[104:107], a[32:35], v[184:187]
buffer_load_dwordx4 v23, s[60:63], s64 offen lds
v_mfma_f32_16x16x32_bf16 v[184:187], a[108:111], a[36:39], v[184:187]
ds_read_b64_tr_b16 a[98:99], v20 offset:256
v_accvgpr_read_b32 v249, a121
v_mfma_f32_16x16x32_bf16 v[192:195], a[108:111], a[44:47], v[192:195]
ds_read_b64_tr_b16 a[100:101], v20 offset:2048
v_accvgpr_read_b32 v250, a122
v_mfma_f32_16x16x32_bf16 v[192:195], a[104:107], a[40:43], v[192:195]
ds_read_b64_tr_b16 a[102:103], v20 offset:2304
v_accvgpr_read_b32 v251, a123
v_mfma_f32_16x16x32_bf16 v[200:203], a[104:107], a[48:51], v[200:203]
v_accvgpr_read_b32 v252, a124
v_accvgpr_read_b32 v253, a125
v_mfma_f32_16x16x32_bf16 v[200:203], a[108:111], a[52:55], v[200:203]
v_accvgpr_read_b32 v254, a126
v_accvgpr_read_b32 v255, a127
v_mfma_f32_16x16x32_bf16 v[208:211], a[108:111], a[60:63], v[208:211]
v_cvt_pk_bf16_f32 v255, v254, v255
v_cvt_pk_bf16_f32 v254, v252, v253
v_mfma_f32_16x16x32_bf16 v[208:211], a[104:107], a[56:59], v[208:211]
ds_read_b64_tr_b16 a[104:105], v4 offset:0
v_cvt_pk_bf16_f32 v252, v248, v249
v_mfma_f32_16x16x32_bf16 v[212:215], a[112:115], a[56:59], v[212:215]
s_xor_b32 m0, s77, 133120
ds_read_b64_tr_b16 a[106:107], v4 offset:1024
v_cvt_pk_bf16_f32 v253, v250, v251
v_mfma_f32_16x16x32_bf16 v[212:215], a[116:119], a[60:63], v[212:215]
s_xor_b32 s64, s71, 1638400
ds_read_b64_tr_b16 a[108:109], v4 offset:8192
v_accvgpr_write_b32 a228, v252
v_mfma_f32_16x16x32_bf16 v[204:207], a[116:119], a[52:55], v[204:207]
buffer_load_dwordx4 v15, s[56:59], s64 offen lds
v_mfma_f32_16x16x32_bf16 v[204:207], a[112:115], a[48:51], v[204:207]
ds_read_b64_tr_b16 a[110:111], v4 offset:9216
v_accvgpr_write_b32 a229, v253
v_mfma_f32_16x16x32_bf16 v[196:199], a[112:115], a[40:43], v[196:199]
v_accvgpr_write_b32 a230, v254
v_accvgpr_write_b32 a231, v255
v_mfma_f32_16x16x32_bf16 v[196:199], a[116:119], a[44:47], v[196:199]
v_mfma_f32_16x16x32_bf16 v[188:191], a[116:119], a[36:39], v[188:191]
v_accvgpr_read_b32 v248, a132
v_accvgpr_read_b32 v249, a133
v_mfma_f32_16x16x32_bf16 v[188:191], a[112:115], a[32:35], v[188:191]
ds_read_b64_tr_b16 a[112:113], v5 offset:0
v_accvgpr_read_b32 v250, a134
v_mfma_f32_16x16x32_bf16 v[216:219], a[32:35], a[72:75], v[216:219]
ds_read_b64_tr_b16 a[114:115], v5 offset:1024
v_accvgpr_read_b32 v251, a135
v_mfma_f32_16x16x32_bf16 v[216:219], a[36:39], a[76:79], v[216:219]
s_add_u32 m0, s78, 155648
ds_read_b64_tr_b16 a[116:117], v5 offset:8192
v_accvgpr_read_b32 v252, a128
v_mfma_f32_16x16x32_bf16 v[224:227], a[44:47], a[76:79], v[224:227]
s_add_u32 s64, s75, 1183744
ds_read_b64_tr_b16 a[118:119], v5 offset:9216
v_accvgpr_read_b32 v253, a129
v_mfma_f32_16x16x32_bf16 v[224:227], a[40:43], a[72:75], v[224:227]
buffer_load_dwordx4 v23, s[60:63], s64 offen lds
v_mfma_f32_16x16x32_bf16 v[232:235], a[48:51], a[72:75], v[232:235]
v_accvgpr_read_b32 v254, a130
v_accvgpr_read_b32 v255, a131
v_mfma_f32_16x16x32_bf16 v[232:235], a[52:55], a[76:79], v[232:235]
v_cvt_pk_bf16_f32 v255, v254, v255
v_cvt_pk_bf16_f32 v254, v252, v253
v_mfma_f32_16x16x32_bf16 v[240:243], a[60:63], a[76:79], v[240:243]
v_cvt_pk_bf16_f32 v252, v248, v249
v_cvt_pk_bf16_f32 v253, v250, v251
v_mfma_f32_16x16x32_bf16 v[240:243], a[56:59], a[72:75], v[240:243]
ds_read_b64_tr_b16 a[72:73], v6 offset:0
v_accvgpr_write_b32 a232, v252
v_mfma_f32_16x16x32_bf16 v[244:247], a[56:59], a[80:83], v[244:247]
ds_read_b64_tr_b16 a[74:75], v6 offset:1024
v_accvgpr_write_b32 a233, v253
v_mfma_f32_16x16x32_bf16 v[244:247], a[60:63], a[84:87], v[244:247]
ds_read_b64_tr_b16 a[76:77], v6 offset:8192
v_accvgpr_write_b32 a234, v254
v_mfma_f32_16x16x32_bf16 v[236:239], a[52:55], a[84:87], v[236:239]
s_xor_b32 m0, s77, 134144
ds_read_b64_tr_b16 a[78:79], v6 offset:9216
v_accvgpr_write_b32 a235, v255
v_mfma_f32_16x16x32_bf16 v[236:239], a[48:51], a[80:83], v[236:239]
s_xor_b32 s64, s71, 1671168
v_mfma_f32_16x16x32_bf16 v[228:231], a[40:43], a[80:83], v[228:231]
buffer_load_dwordx4 v15, s[56:59], s64 offen lds
v_mfma_f32_16x16x32_bf16 v[228:231], a[44:47], a[84:87], v[228:231]
v_accvgpr_read_b32 v248, a140
v_accvgpr_read_b32 v249, a141
v_mfma_f32_16x16x32_bf16 v[220:223], a[36:39], a[84:87], v[220:223]
v_accvgpr_read_b32 v250, a142
v_accvgpr_read_b32 v251, a143
v_mfma_f32_16x16x32_bf16 v[220:223], a[32:35], a[80:83], v[220:223]
s_waitcnt lgkmcnt(4)
ds_read_b64_tr_b16 a[80:81], v7 offset:0
v_accvgpr_read_b32 v252, a136
v_mfma_f32_16x16x32_bf16 v[152:155], a[88:91], a[32:35], v[152:155]
ds_read_b64_tr_b16 a[82:83], v7 offset:1024
v_accvgpr_read_b32 v253, a137
v_mfma_f32_16x16x32_bf16 v[152:155], a[92:95], a[36:39], v[152:155]
ds_read_b64_tr_b16 a[84:85], v7 offset:8192
v_accvgpr_read_b32 v254, a138
v_mfma_f32_16x16x32_bf16 v[160:163], a[92:95], a[44:47], v[160:163]
ds_read_b64_tr_b16 a[86:87], v7 offset:9216
v_accvgpr_read_b32 v255, a139
v_mfma_f32_16x16x32_bf16 v[160:163], a[88:91], a[40:43], v[160:163]
v_cvt_pk_bf16_f32 v255, v254, v255
v_cvt_pk_bf16_f32 v254, v252, v253
v_mfma_f32_16x16x32_bf16 v[168:171], a[88:91], a[48:51], v[168:171]
v_cvt_pk_bf16_f32 v252, v248, v249
v_cvt_pk_bf16_f32 v253, v250, v251
v_mfma_f32_16x16x32_bf16 v[168:171], a[92:95], a[52:55], v[168:171]
v_accvgpr_write_b32 a236, v252
v_accvgpr_write_b32 a237, v253
v_mfma_f32_16x16x32_bf16 v[176:179], a[92:95], a[60:63], v[176:179]
s_xor_b32 m0, s84, 32768
v_accvgpr_write_b32 a238, v254
v_accvgpr_write_b32 a239, v255
v_mfma_f32_16x16x32_bf16 v[176:179], a[88:91], a[56:59], v[176:179]
s_xor_b32 s64, s72, 384
ds_read_b64_tr_b16 a[88:89], v8 offset:0
v_mfma_f32_16x16x32_bf16 v[180:183], a[96:99], a[56:59], v[180:183]
s_add_u32 s65, s79, 4096
buffer_load_dwordx4 v12, s[48:51], s64 offen lds
v_mfma_f32_16x16x32_bf16 v[180:183], a[100:103], a[60:63], v[180:183]
buffer_store_dwordx4 a[148:151], v16, s[44:47], s65 offen sc1
v_mfma_f32_16x16x32_bf16 v[172:175], a[100:103], a[52:55], v[172:175]
ds_read_b64_tr_b16 a[90:91], v8 offset:1024
v_mfma_f32_16x16x32_bf16 v[172:175], a[96:99], a[48:51], v[172:175]
s_xor_b32 m0, s84, 33792
ds_read_b64_tr_b16 a[92:93], v8 offset:8192
v_mfma_f32_16x16x32_bf16 v[164:167], a[96:99], a[40:43], v[164:167]
s_xor_b32 s64, s72, 16768
ds_read_b64_tr_b16 a[94:95], v8 offset:9216
v_mfma_f32_16x16x32_bf16 v[164:167], a[100:103], a[44:47], v[164:167]
buffer_load_dwordx4 v13, s[48:51], s64 offen lds
v_mfma_f32_16x16x32_bf16 v[156:159], a[100:103], a[36:39], v[156:159]
v_mfma_f32_16x16x32_bf16 v[156:159], a[96:99], a[32:35], v[156:159]
ds_read_b64_tr_b16 a[96:97], v9 offset:0
v_mfma_f32_16x16x32_bf16 v[24:27], a[104:107], a[32:35], v[24:27]
s_xor_b32 m0, s84, 34816
ds_read_b64_tr_b16 a[98:99], v9 offset:1024
v_mfma_f32_16x16x32_bf16 v[24:27], a[108:111], a[36:39], v[24:27]
s_xor_b32 s64, s72, 131456
ds_read_b64_tr_b16 a[100:101], v9 offset:8192
v_mfma_f32_16x16x32_bf16 v[40:43], a[108:111], a[44:47], v[40:43]
buffer_load_dwordx4 v12, s[48:51], s64 offen lds
v_mfma_f32_16x16x32_bf16 v[40:43], a[104:107], a[40:43], v[40:43]
ds_read_b64_tr_b16 a[102:103], v9 offset:9216
v_mfma_f32_16x16x32_bf16 v[56:59], a[104:107], a[48:51], v[56:59]
v_mfma_f32_16x16x32_bf16 v[56:59], a[108:111], a[52:55], v[56:59]
s_xor_b32 m0, s84, 35840
v_mfma_f32_16x16x32_bf16 v[72:75], a[108:111], a[60:63], v[72:75]
s_waitcnt vmcnt(14)
s_xor_b32 s64, s72, 147840
ds_read_b128 a[0:3], v2 offset:0
v_mfma_f32_16x16x32_bf16 v[72:75], a[104:107], a[56:59], v[72:75]
buffer_load_dwordx4 v13, s[48:51], s64 offen lds
v_mfma_f32_16x16x32_bf16 v[136:139], a[112:115], a[56:59], v[136:139]
ds_read_b128 a[4:7], v3 offset:0
v_mfma_f32_16x16x32_bf16 v[136:139], a[116:119], a[60:63], v[136:139]
ds_read_b128 a[8:11], v2 offset:2048
v_mfma_f32_16x16x32_bf16 v[120:123], a[116:119], a[52:55], v[120:123]
s_xor_b32 m0, s84, 36864
ds_read_b128 a[12:15], v3 offset:2048
v_mfma_f32_16x16x32_bf16 v[120:123], a[112:115], a[48:51], v[120:123]
s_xor_b32 s64, s73, 384
ds_read_b128 a[16:19], v2 offset:4096
v_mfma_f32_16x16x32_bf16 v[104:107], a[112:115], a[40:43], v[104:107]
buffer_load_dwordx4 v12, s[48:51], s64 offen lds
v_mfma_f32_16x16x32_bf16 v[104:107], a[116:119], a[44:47], v[104:107]
ds_read_b128 a[20:23], v3 offset:4096
v_mfma_f32_16x16x32_bf16 v[88:91], a[116:119], a[36:39], v[88:91]
ds_read_b128 a[24:27], v2 offset:6144
v_mfma_f32_16x16x32_bf16 v[88:91], a[112:115], a[32:35], v[88:91]
s_waitcnt lgkmcnt(7)
s_xor_b32 m0, s84, 37888
ds_read_b128 a[28:31], v3 offset:6144
v_mfma_f32_16x16x32_bf16 v[28:31], a[72:75], a[32:35], v[28:31]
s_xor_b32 s64, s73, 16768
ds_read_b64_tr_b16 a[104:105], v10 offset:0
v_mfma_f32_16x16x32_bf16 v[28:31], a[76:79], a[36:39], v[28:31]
buffer_load_dwordx4 v13, s[48:51], s64 offen lds
v_mfma_f32_16x16x32_bf16 v[44:47], a[76:79], a[44:47], v[44:47]
ds_read_b64_tr_b16 a[106:107], v10 offset:1024
v_mfma_f32_16x16x32_bf16 v[44:47], a[72:75], a[40:43], v[44:47]
ds_read_b64_tr_b16 a[108:109], v10 offset:8192
v_mfma_f32_16x16x32_bf16 v[60:63], a[72:75], a[48:51], v[60:63]
s_xor_b32 m0, s84, 38912
ds_read_b64_tr_b16 a[110:111], v10 offset:9216
v_mfma_f32_16x16x32_bf16 v[60:63], a[76:79], a[52:55], v[60:63]
s_xor_b32 s64, s73, 131456
ds_read_b64_tr_b16 a[112:113], v11 offset:0
v_mfma_f32_16x16x32_bf16 v[76:79], a[76:79], a[60:63], v[76:79]
buffer_load_dwordx4 v12, s[48:51], s64 offen lds
v_mfma_f32_16x16x32_bf16 v[76:79], a[72:75], a[56:59], v[76:79]
ds_read_b64_tr_b16 a[114:115], v11 offset:1024
v_mfma_f32_16x16x32_bf16 v[140:143], a[80:83], a[56:59], v[140:143]
ds_read_b64_tr_b16 a[116:117], v11 offset:8192
v_mfma_f32_16x16x32_bf16 v[140:143], a[84:87], a[60:63], v[140:143]
s_xor_b32 m0, s84, 39936
ds_read_b64_tr_b16 a[118:119], v11 offset:9216
v_mfma_f32_16x16x32_bf16 v[124:127], a[84:87], a[52:55], v[124:127]
s_xor_b32 s64, s73, 147840
v_mfma_f32_16x16x32_bf16 v[124:127], a[80:83], a[48:51], v[124:127]
buffer_load_dwordx4 v13, s[48:51], s64 offen lds
v_mfma_f32_16x16x32_bf16 v[108:111], a[80:83], a[40:43], v[108:111]
v_mfma_f32_16x16x32_bf16 v[108:111], a[84:87], a[44:47], v[108:111]
v_mfma_f32_16x16x32_bf16 v[92:95], a[84:87], a[36:39], v[92:95]
v_mfma_f32_16x16x32_bf16 v[92:95], a[80:83], a[32:35], v[92:95]
v_mfma_f32_16x16x32_bf16 v[32:35], a[88:91], a[32:35], v[32:35]
v_mfma_f32_16x16x32_bf16 v[32:35], a[92:95], a[36:39], v[32:35]
s_branch L_po7
L_pg7:
s_branch L_pg11
L_po7:
v_mfma_f32_16x16x32_bf16 v[48:51], a[92:95], a[44:47], v[48:51]
s_waitcnt lgkmcnt(0)
s_barrier
v_mfma_f32_16x16x32_bf16 v[48:51], a[88:91], a[40:43], v[48:51]
s_xor_b32 m0, s77, 65536
ds_read_b64_tr_b16 a[72:73], v19 offset:36864
v_mfma_f32_16x16x32_bf16 v[64:67], a[88:91], a[48:51], v[64:67]
s_xor_b32 s64, s71, 2097152
ds_read_b64_tr_b16 a[74:75], v19 offset:37120
v_mfma_f32_16x16x32_bf16 v[64:67], a[92:95], a[52:55], v[64:67]
s_add_u32 s65, s79, 0
buffer_load_dwordx4 v14, s[56:59], s64 offen lds
v_mfma_f32_16x16x32_bf16 v[80:83], a[92:95], a[60:63], v[80:83]
buffer_store_dwordx4 a[152:155], v16, s[44:47], s65 offen sc1
v_mfma_f32_16x16x32_bf16 v[80:83], a[88:91], a[56:59], v[80:83]
ds_read_b64_tr_b16 a[76:77], v19 offset:38912
v_mfma_f32_16x16x32_bf16 v[144:147], a[96:99], a[56:59], v[144:147]
ds_read_b64_tr_b16 a[78:79], v19 offset:39168
v_mfma_f32_16x16x32_bf16 v[144:147], a[100:103], a[60:63], v[144:147]
ds_read_b64_tr_b16 a[80:81], v20 offset:36864
v_mfma_f32_16x16x32_bf16 v[128:131], a[100:103], a[52:55], v[128:131]
ds_read_b64_tr_b16 a[82:83], v20 offset:37120
v_mfma_f32_16x16x32_bf16 v[128:131], a[96:99], a[48:51], v[128:131]
ds_read_b64_tr_b16 a[84:85], v20 offset:38912
v_mfma_f32_16x16x32_bf16 v[112:115], a[96:99], a[40:43], v[112:115]
s_add_u32 m0, s78, 81920
ds_read_b64_tr_b16 a[86:87], v20 offset:39168
v_mfma_f32_16x16x32_bf16 v[112:115], a[100:103], a[44:47], v[112:115]
s_add_u32 s64, s75, 1572864
ds_read_b64_tr_b16 a[88:89], v19 offset:40960
v_mfma_f32_16x16x32_bf16 v[96:99], a[100:103], a[36:39], v[96:99]
buffer_load_dwordx4 v23, s[60:63], s64 offen lds
v_mfma_f32_16x16x32_bf16 v[96:99], a[96:99], a[32:35], v[96:99]
ds_read_b64_tr_b16 a[90:91], v19 offset:41216
v_mfma_f32_16x16x32_bf16 v[36:39], a[104:107], a[32:35], v[36:39]
ds_read_b64_tr_b16 a[92:93], v19 offset:43008
v_mfma_f32_16x16x32_bf16 v[36:39], a[108:111], a[36:39], v[36:39]
ds_read_b64_tr_b16 a[94:95], v19 offset:43264
v_mfma_f32_16x16x32_bf16 v[52:55], a[108:111], a[44:47], v[52:55]
ds_read_b64_tr_b16 a[96:97], v20 offset:40960
v_mfma_f32_16x16x32_bf16 v[52:55], a[104:107], a[40:43], v[52:55]
ds_read_b64_tr_b16 a[98:99], v20 offset:41216
v_mfma_f32_16x16x32_bf16 v[68:71], a[104:107], a[48:51], v[68:71]
s_xor_b32 m0, s77, 66560
ds_read_b64_tr_b16 a[100:101], v20 offset:43008
v_mfma_f32_16x16x32_bf16 v[68:71], a[108:111], a[52:55], v[68:71]
s_xor_b32 s64, s71, 2129920
s_xor_b32 s68, s66, 4096
ds_read_b64_tr_b16 a[102:103], v20 offset:43264
v_mfma_f32_16x16x32_bf16 v[84:87], a[108:111], a[60:63], v[84:87]
s_mov_b64 exec, 1
buffer_atomic_add a251, v1, s[52:55], s68 offen offset:0 sc1
s_mov_b64 exec, -1
v_mfma_f32_16x16x32_bf16 v[84:87], a[104:107], a[56:59], v[84:87]
buffer_load_dwordx4 v14, s[56:59], s64 offen lds
v_mfma_f32_16x16x32_bf16 v[148:151], a[112:115], a[56:59], v[148:151]
ds_read_b64_tr_b16 a[104:105], v19 offset:32768
v_mfma_f32_16x16x32_bf16 v[148:151], a[116:119], a[60:63], v[148:151]
ds_read_b64_tr_b16 a[106:107], v19 offset:33024
v_mfma_f32_16x16x32_bf16 v[132:135], a[116:119], a[52:55], v[132:135]
ds_read_b64_tr_b16 a[108:109], v19 offset:34816
v_mfma_f32_16x16x32_bf16 v[132:135], a[112:115], a[48:51], v[132:135]
ds_read_b64_tr_b16 a[110:111], v19 offset:35072
v_mfma_f32_16x16x32_bf16 v[116:119], a[112:115], a[40:43], v[116:119]
v_mfma_f32_16x16x32_bf16 v[116:119], a[116:119], a[44:47], v[116:119]
v_mfma_f32_16x16x32_bf16 v[100:103], a[116:119], a[36:39], v[100:103]
s_add_u32 m0, s78, 86016
v_mfma_f32_16x16x32_bf16 v[100:103], a[112:115], a[32:35], v[100:103]
s_waitcnt lgkmcnt(4)
s_add_u32 s64, s75, 1574912
ds_read_b64_tr_b16 a[112:113], v20 offset:32768
v_mfma_f32_16x16x32_bf16 v[184:187], a[72:75], a[0:3], v[184:187]
buffer_load_dwordx4 v23, s[60:63], s64 offen lds
v_mfma_f32_16x16x32_bf16 v[184:187], a[76:79], a[4:7], v[184:187]
ds_read_b64_tr_b16 a[114:115], v20 offset:33024
v_mfma_f32_16x16x32_bf16 v[192:195], a[76:79], a[12:15], v[192:195]
ds_read_b64_tr_b16 a[116:117], v20 offset:34816
v_mfma_f32_16x16x32_bf16 v[192:195], a[72:75], a[8:11], v[192:195]
ds_read_b64_tr_b16 a[118:119], v20 offset:35072
v_mfma_f32_16x16x32_bf16 v[200:203], a[72:75], a[16:19], v[200:203]
v_mfma_f32_16x16x32_bf16 v[200:203], a[76:79], a[20:23], v[200:203]
v_mfma_f32_16x16x32_bf16 v[208:211], a[76:79], a[28:31], v[208:211]
v_mfma_f32_16x16x32_bf16 v[208:211], a[72:75], a[24:27], v[208:211]
ds_read_b64_tr_b16 a[72:73], v4 offset:32768
v_mfma_f32_16x16x32_bf16 v[212:215], a[80:83], a[24:27], v[212:215]
s_xor_b32 m0, s77, 67584
ds_read_b64_tr_b16 a[74:75], v4 offset:33792
v_mfma_f32_16x16x32_bf16 v[212:215], a[84:87], a[28:31], v[212:215]
s_xor_b32 s64, s71, 2162688
ds_read_b64_tr_b16 a[76:77], v4 offset:40960
v_mfma_f32_16x16x32_bf16 v[204:207], a[84:87], a[20:23], v[204:207]
buffer_load_dwordx4 v15, s[56:59], s64 offen lds
v_mfma_f32_16x16x32_bf16 v[204:207], a[80:83], a[16:19], v[204:207]
ds_read_b64_tr_b16 a[78:79], v4 offset:41984
v_mfma_f32_16x16x32_bf16 v[196:199], a[80:83], a[8:11], v[196:199]
v_mfma_f32_16x16x32_bf16 v[196:199], a[84:87], a[12:15], v[196:199]
v_mfma_f32_16x16x32_bf16 v[188:191], a[84:87], a[4:7], v[188:191]
v_mfma_f32_16x16x32_bf16 v[188:191], a[80:83], a[0:3], v[188:191]
ds_read_b64_tr_b16 a[80:81], v5 offset:32768
v_mfma_f32_16x16x32_bf16 v[216:219], a[0:3], a[88:91], v[216:219]
ds_read_b64_tr_b16 a[82:83], v5 offset:33792
v_mfma_f32_16x16x32_bf16 v[216:219], a[4:7], a[92:95], v[216:219]
s_add_u32 m0, s78, 90112
s_add_u32 s65, s79, 17408
ds_read_b64_tr_b16 a[84:85], v5 offset:40960
v_mfma_f32_16x16x32_bf16 v[224:227], a[12:15], a[92:95], v[224:227]
s_add_u32 s64, s75, 1576960
buffer_store_dwordx4 a[156:159], v16, s[44:47], s65 offen sc1
v_mfma_f32_16x16x32_bf16 v[224:227], a[8:11], a[88:91], v[224:227]
buffer_load_dwordx4 v23, s[60:63], s64 offen lds
v_mfma_f32_16x16x32_bf16 v[232:235], a[16:19], a[88:91], v[232:235]
ds_read_b64_tr_b16 a[86:87], v5 offset:41984
v_mfma_f32_16x16x32_bf16 v[232:235], a[20:23], a[92:95], v[232:235]
v_mfma_f32_16x16x32_bf16 v[240:243], a[28:31], a[92:95], v[240:243]
v_mfma_f32_16x16x32_bf16 v[240:243], a[24:27], a[88:91], v[240:243]
ds_read_b64_tr_b16 a[88:89], v6 offset:32768
v_mfma_f32_16x16x32_bf16 v[244:247], a[24:27], a[96:99], v[244:247]
ds_read_b64_tr_b16 a[90:91], v6 offset:33792
v_mfma_f32_16x16x32_bf16 v[244:247], a[28:31], a[100:103], v[244:247]
ds_read_b64_tr_b16 a[92:93], v6 offset:40960
v_add_u32 v19, 0x8000, v19
v_mfma_f32_16x16x32_bf16 v[236:239], a[20:23], a[100:103], v[236:239]
s_xor_b32 m0, s77, 68608
ds_read_b64_tr_b16 a[94:95], v6 offset:41984
v_mfma_f32_16x16x32_bf16 v[236:239], a[16:19], a[96:99], v[236:239]
s_xor_b32 s64, s71, 2195456
v_mfma_f32_16x16x32_bf16 v[228:231], a[8:11], a[96:99], v[228:231]
buffer_load_dwordx4 v15, s[56:59], s64 offen lds
v_mfma_f32_16x16x32_bf16 v[228:231], a[12:15], a[100:103], v[228:231]
v_mfma_f32_16x16x32_bf16 v[220:223], a[4:7], a[100:103], v[220:223]
v_mfma_f32_16x16x32_bf16 v[220:223], a[0:3], a[96:99], v[220:223]
s_waitcnt lgkmcnt(4)
ds_read_b64_tr_b16 a[96:97], v7 offset:32768
v_mfma_f32_16x16x32_bf16 v[152:155], a[104:107], a[0:3], v[152:155]
ds_read_b64_tr_b16 a[98:99], v7 offset:33792
v_mfma_f32_16x16x32_bf16 v[152:155], a[108:111], a[4:7], v[152:155]
ds_read_b64_tr_b16 a[100:101], v7 offset:40960
v_add_u32 v20, 0x8000, v20
v_mfma_f32_16x16x32_bf16 v[160:163], a[108:111], a[12:15], v[160:163]
ds_read_b64_tr_b16 a[102:103], v7 offset:41984
v_mfma_f32_16x16x32_bf16 v[160:163], a[104:107], a[8:11], v[160:163]
v_mfma_f32_16x16x32_bf16 v[168:171], a[104:107], a[16:19], v[168:171]
v_mfma_f32_16x16x32_bf16 v[168:171], a[108:111], a[20:23], v[168:171]
v_mfma_f32_16x16x32_bf16 v[176:179], a[108:111], a[28:31], v[176:179]
s_xor_b32 m0, s84, 0
v_mfma_f32_16x16x32_bf16 v[176:179], a[104:107], a[24:27], v[176:179]
s_xor_b32 s64, s72, 512
ds_read_b64_tr_b16 a[104:105], v8 offset:32768
v_mfma_f32_16x16x32_bf16 v[180:183], a[112:115], a[24:27], v[180:183]
buffer_load_dwordx4 v12, s[48:51], s64 offen lds
v_mfma_f32_16x16x32_bf16 v[180:183], a[116:119], a[28:31], v[180:183]
ds_read_b64_tr_b16 a[106:107], v8 offset:33792
v_add_u32 v4, 0x8000, v4
v_mfma_f32_16x16x32_bf16 v[172:175], a[116:119], a[20:23], v[172:175]
ds_read_b64_tr_b16 a[108:109], v8 offset:40960
v_mfma_f32_16x16x32_bf16 v[172:175], a[112:115], a[16:19], v[172:175]
s_xor_b32 m0, s84, 1024
ds_read_b64_tr_b16 a[110:111], v8 offset:41984
v_mfma_f32_16x16x32_bf16 v[164:167], a[112:115], a[8:11], v[164:167]
s_xor_b32 s64, s72, 16896
v_mfma_f32_16x16x32_bf16 v[164:167], a[116:119], a[12:15], v[164:167]
buffer_load_dwordx4 v13, s[48:51], s64 offen lds
v_mfma_f32_16x16x32_bf16 v[156:159], a[116:119], a[4:7], v[156:159]
v_mfma_f32_16x16x32_bf16 v[156:159], a[112:115], a[0:3], v[156:159]
ds_read_b64_tr_b16 a[112:113], v9 offset:32768
v_mfma_f32_16x16x32_bf16 v[24:27], a[72:75], a[0:3], v[24:27]
s_xor_b32 m0, s84, 2048
ds_read_b64_tr_b16 a[114:115], v9 offset:33792
v_mfma_f32_16x16x32_bf16 v[24:27], a[76:79], a[4:7], v[24:27]
s_xor_b32 s64, s72, 131584
ds_read_b64_tr_b16 a[116:117], v9 offset:40960
v_add_u32 v5, 0x8000, v5
v_mfma_f32_16x16x32_bf16 v[40:43], a[76:79], a[12:15], v[40:43]
buffer_load_dwordx4 v12, s[48:51], s64 offen lds
v_mfma_f32_16x16x32_bf16 v[40:43], a[72:75], a[8:11], v[40:43]
ds_read_b64_tr_b16 a[118:119], v9 offset:41984
v_mfma_f32_16x16x32_bf16 v[56:59], a[72:75], a[16:19], v[56:59]
v_mfma_f32_16x16x32_bf16 v[56:59], a[76:79], a[20:23], v[56:59]
s_xor_b32 m0, s84, 3072
v_mfma_f32_16x16x32_bf16 v[72:75], a[76:79], a[28:31], v[72:75]
s_waitcnt vmcnt(13)
s_xor_b32 s64, s72, 147968
ds_read_b128 a[32:35], v2 offset:32768
v_mfma_f32_16x16x32_bf16 v[72:75], a[72:75], a[24:27], v[72:75]
buffer_load_dwordx4 v13, s[48:51], s64 offen lds
v_mfma_f32_16x16x32_bf16 v[136:139], a[80:83], a[24:27], v[136:139]
ds_read_b128 a[36:39], v3 offset:32768
v_mfma_f32_16x16x32_bf16 v[136:139], a[84:87], a[28:31], v[136:139]
ds_read_b128 a[40:43], v2 offset:34816
v_add_u32 v6, 0x8000, v6
v_mfma_f32_16x16x32_bf16 v[120:123], a[84:87], a[20:23], v[120:123]
s_xor_b32 m0, s84, 4096
ds_read_b128 a[44:47], v3 offset:34816
v_mfma_f32_16x16x32_bf16 v[120:123], a[80:83], a[16:19], v[120:123]
s_xor_b32 s64, s73, 512
ds_read_b128 a[48:51], v2 offset:36864
v_mfma_f32_16x16x32_bf16 v[104:107], a[80:83], a[8:11], v[104:107]
buffer_load_dwordx4 v12, s[48:51], s64 offen lds
v_mfma_f32_16x16x32_bf16 v[104:107], a[84:87], a[12:15], v[104:107]
ds_read_b128 a[52:55], v3 offset:36864
v_mfma_f32_16x16x32_bf16 v[88:91], a[84:87], a[4:7], v[88:91]
s_add_u32 s65, s79, 5120
ds_read_b128 a[56:59], v2 offset:38912
v_mfma_f32_16x16x32_bf16 v[88:91], a[80:83], a[0:3], v[88:91]
s_waitcnt lgkmcnt(7)
s_xor_b32 m0, s84, 5120
buffer_store_dwordx4 a[160:163], v16, s[44:47], s65 offen sc1
v_mfma_f32_16x16x32_bf16 v[28:31], a[88:91], a[0:3], v[28:31]
s_xor_b32 s64, s73, 16896
ds_read_b128 a[60:63], v3 offset:38912
v_mfma_f32_16x16x32_bf16 v[28:31], a[92:95], a[4:7], v[28:31]
buffer_load_dwordx4 v13, s[48:51], s64 offen lds
v_mfma_f32_16x16x32_bf16 v[44:47], a[92:95], a[12:15], v[44:47]
ds_read_b64_tr_b16 a[72:73], v10 offset:32768
v_add_u32 v7, 0x8000, v7
v_mfma_f32_16x16x32_bf16 v[44:47], a[88:91], a[8:11], v[44:47]
ds_read_b64_tr_b16 a[74:75], v10 offset:33792
v_mfma_f32_16x16x32_bf16 v[60:63], a[88:91], a[16:19], v[60:63]
s_xor_b32 m0, s84, 6144
ds_read_b64_tr_b16 a[76:77], v10 offset:40960
v_mfma_f32_16x16x32_bf16 v[60:63], a[92:95], a[20:23], v[60:63]
s_xor_b32 s64, s73, 131584
ds_read_b64_tr_b16 a[78:79], v10 offset:41984
v_mfma_f32_16x16x32_bf16 v[76:79], a[92:95], a[28:31], v[76:79]
buffer_load_dwordx4 v12, s[48:51], s64 offen lds
v_mfma_f32_16x16x32_bf16 v[76:79], a[88:91], a[24:27], v[76:79]
ds_read_b64_tr_b16 a[80:81], v11 offset:32768
v_mfma_f32_16x16x32_bf16 v[140:143], a[96:99], a[24:27], v[140:143]
ds_read_b64_tr_b16 a[82:83], v11 offset:33792
v_mfma_f32_16x16x32_bf16 v[140:143], a[100:103], a[28:31], v[140:143]
s_xor_b32 m0, s84, 7168
ds_read_b64_tr_b16 a[84:85], v11 offset:40960
v_add_u32 v8, 0x8000, v8
v_mfma_f32_16x16x32_bf16 v[124:127], a[100:103], a[20:23], v[124:127]
s_xor_b32 s64, s73, 147968
ds_read_b64_tr_b16 a[86:87], v11 offset:41984
v_mfma_f32_16x16x32_bf16 v[124:127], a[96:99], a[16:19], v[124:127]
buffer_load_dwordx4 v13, s[48:51], s64 offen lds
v_mfma_f32_16x16x32_bf16 v[108:111], a[96:99], a[8:11], v[108:111]
v_mfma_f32_16x16x32_bf16 v[108:111], a[100:103], a[12:15], v[108:111]
v_mfma_f32_16x16x32_bf16 v[92:95], a[100:103], a[4:7], v[92:95]
v_add_u32 v9, 0x8000, v9
v_add_u32 v10, 0x8000, v10
v_mfma_f32_16x16x32_bf16 v[92:95], a[96:99], a[0:3], v[92:95]
v_add_u32 v11, 0x8000, v11
v_mfma_f32_16x16x32_bf16 v[32:35], a[104:107], a[0:3], v[32:35]
v_mfma_f32_16x16x32_bf16 v[32:35], a[108:111], a[4:7], v[32:35]
v_mfma_f32_16x16x32_bf16 v[48:51], a[108:111], a[12:15], v[48:51]
s_waitcnt lgkmcnt(0)
s_barrier
v_mfma_f32_16x16x32_bf16 v[48:51], a[104:107], a[8:11], v[48:51]
s_xor_b32 m0, s77, 98304
ds_read_b64_tr_b16 a[88:89], v19 offset:36864
v_mfma_f32_16x16x32_bf16 v[64:67], a[104:107], a[16:19], v[64:67]
s_xor_b32 s64, s71, 2621440
ds_read_b64_tr_b16 a[90:91], v19 offset:37120
v_mfma_f32_16x16x32_bf16 v[64:67], a[108:111], a[20:23], v[64:67]
buffer_load_dwordx4 v14, s[56:59], s64 offen lds
v_mfma_f32_16x16x32_bf16 v[80:83], a[108:111], a[28:31], v[80:83]
ds_read_b64_tr_b16 a[92:93], v19 offset:38912
v_mfma_f32_16x16x32_bf16 v[80:83], a[104:107], a[24:27], v[80:83]
ds_read_b64_tr_b16 a[94:95], v19 offset:39168
v_mfma_f32_16x16x32_bf16 v[144:147], a[112:115], a[24:27], v[144:147]
ds_read_b64_tr_b16 a[96:97], v20 offset:36864
v_mfma_f32_16x16x32_bf16 v[144:147], a[116:119], a[28:31], v[144:147]
ds_read_b64_tr_b16 a[98:99], v20 offset:37120
v_mfma_f32_16x16x32_bf16 v[128:131], a[116:119], a[20:23], v[128:131]
ds_read_b64_tr_b16 a[100:101], v20 offset:38912
v_mfma_f32_16x16x32_bf16 v[128:131], a[112:115], a[16:19], v[128:131]
ds_read_b64_tr_b16 a[102:103], v20 offset:39168
v_mfma_f32_16x16x32_bf16 v[112:115], a[112:115], a[8:11], v[112:115]
s_add_u32 m0, s78, 114688
ds_read_b64_tr_b16 a[104:105], v19 offset:40960
v_mfma_f32_16x16x32_bf16 v[112:115], a[116:119], a[12:15], v[112:115]
s_add_u32 s64, s75, 1966080
ds_read_b64_tr_b16 a[106:107], v19 offset:41216
v_mfma_f32_16x16x32_bf16 v[96:99], a[116:119], a[4:7], v[96:99]
buffer_load_dwordx4 v23, s[60:63], s64 offen lds
v_mfma_f32_16x16x32_bf16 v[96:99], a[112:115], a[0:3], v[96:99]
ds_read_b64_tr_b16 a[108:109], v19 offset:43008
v_mfma_f32_16x16x32_bf16 v[36:39], a[72:75], a[0:3], v[36:39]
ds_read_b64_tr_b16 a[110:111], v19 offset:43264
v_mfma_f32_16x16x32_bf16 v[36:39], a[76:79], a[4:7], v[36:39]
ds_read_b64_tr_b16 a[112:113], v20 offset:40960
v_mfma_f32_16x16x32_bf16 v[52:55], a[76:79], a[12:15], v[52:55]
ds_read_b64_tr_b16 a[114:115], v20 offset:41216
v_mfma_f32_16x16x32_bf16 v[52:55], a[72:75], a[8:11], v[52:55]
ds_read_b64_tr_b16 a[116:117], v20 offset:43008
v_mfma_f32_16x16x32_bf16 v[68:71], a[72:75], a[16:19], v[68:71]
s_xor_b32 m0, s77, 99328
ds_read_b64_tr_b16 a[118:119], v20 offset:43264
v_mfma_f32_16x16x32_bf16 v[68:71], a[76:79], a[20:23], v[68:71]
s_xor_b32 s64, s71, 2654208
s_xor_b32 s68, s66, 8192
v_mfma_f32_16x16x32_bf16 v[84:87], a[76:79], a[28:31], v[84:87]
s_mov_b64 exec, 1
buffer_atomic_add a251, v1, s[52:55], s68 offen offset:0 sc1
s_mov_b64 exec, -1
v_mfma_f32_16x16x32_bf16 v[84:87], a[72:75], a[24:27], v[84:87]
buffer_load_dwordx4 v14, s[56:59], s64 offen lds
v_mfma_f32_16x16x32_bf16 v[148:151], a[80:83], a[24:27], v[148:151]
ds_read_b64_tr_b16 a[72:73], v19 offset:32768
v_mfma_f32_16x16x32_bf16 v[148:151], a[84:87], a[28:31], v[148:151]
ds_read_b64_tr_b16 a[74:75], v19 offset:33024
v_mfma_f32_16x16x32_bf16 v[132:135], a[84:87], a[20:23], v[132:135]
s_add_u32 s65, s79, 1024
ds_read_b64_tr_b16 a[76:77], v19 offset:34816
v_mfma_f32_16x16x32_bf16 v[132:135], a[80:83], a[16:19], v[132:135]
buffer_store_dwordx4 a[164:167], v16, s[44:47], s65 offen sc1
v_mfma_f32_16x16x32_bf16 v[116:119], a[80:83], a[8:11], v[116:119]
ds_read_b64_tr_b16 a[78:79], v19 offset:35072
v_mfma_f32_16x16x32_bf16 v[116:119], a[84:87], a[12:15], v[116:119]
v_mfma_f32_16x16x32_bf16 v[100:103], a[84:87], a[4:7], v[100:103]
s_add_u32 m0, s78, 118784
v_mfma_f32_16x16x32_bf16 v[100:103], a[80:83], a[0:3], v[100:103]
s_waitcnt lgkmcnt(4)
s_add_u32 s64, s75, 1968128
ds_read_b64_tr_b16 a[80:81], v20 offset:32768
v_mfma_f32_16x16x32_bf16 v[184:187], a[88:91], a[32:35], v[184:187]
buffer_load_dwordx4 v23, s[60:63], s64 offen lds
v_mfma_f32_16x16x32_bf16 v[184:187], a[92:95], a[36:39], v[184:187]
ds_read_b64_tr_b16 a[82:83], v20 offset:33024
v_mfma_f32_16x16x32_bf16 v[192:195], a[92:95], a[44:47], v[192:195]
ds_read_b64_tr_b16 a[84:85], v20 offset:34816
v_mfma_f32_16x16x32_bf16 v[192:195], a[88:91], a[40:43], v[192:195]
ds_read_b64_tr_b16 a[86:87], v20 offset:35072
v_mfma_f32_16x16x32_bf16 v[200:203], a[88:91], a[48:51], v[200:203]
v_mfma_f32_16x16x32_bf16 v[200:203], a[92:95], a[52:55], v[200:203]
v_mfma_f32_16x16x32_bf16 v[208:211], a[92:95], a[60:63], v[208:211]
v_mfma_f32_16x16x32_bf16 v[208:211], a[88:91], a[56:59], v[208:211]
ds_read_b64_tr_b16 a[88:89], v4 offset:32768
v_mfma_f32_16x16x32_bf16 v[212:215], a[96:99], a[56:59], v[212:215]
s_xor_b32 m0, s77, 100352
ds_read_b64_tr_b16 a[90:91], v4 offset:33792
v_mfma_f32_16x16x32_bf16 v[212:215], a[100:103], a[60:63], v[212:215]
s_xor_b32 s64, s71, 2686976
ds_read_b64_tr_b16 a[92:93], v4 offset:40960
v_mfma_f32_16x16x32_bf16 v[204:207], a[100:103], a[52:55], v[204:207]
buffer_load_dwordx4 v15, s[56:59], s64 offen lds
v_mfma_f32_16x16x32_bf16 v[204:207], a[96:99], a[48:51], v[204:207]
ds_read_b64_tr_b16 a[94:95], v4 offset:41984
v_mfma_f32_16x16x32_bf16 v[196:199], a[96:99], a[40:43], v[196:199]
v_mfma_f32_16x16x32_bf16 v[196:199], a[100:103], a[44:47], v[196:199]
v_mfma_f32_16x16x32_bf16 v[188:191], a[100:103], a[36:39], v[188:191]
v_mfma_f32_16x16x32_bf16 v[188:191], a[96:99], a[32:35], v[188:191]
ds_read_b64_tr_b16 a[96:97], v5 offset:32768
v_mfma_f32_16x16x32_bf16 v[216:219], a[32:35], a[104:107], v[216:219]
ds_read_b64_tr_b16 a[98:99], v5 offset:33792
v_mfma_f32_16x16x32_bf16 v[216:219], a[36:39], a[108:111], v[216:219]
s_add_u32 m0, s78, 122880
ds_read_b64_tr_b16 a[100:101], v5 offset:40960
v_mfma_f32_16x16x32_bf16 v[224:227], a[44:47], a[108:111], v[224:227]
s_add_u32 s64, s75, 1970176
ds_read_b64_tr_b16 a[102:103], v5 offset:41984
v_mfma_f32_16x16x32_bf16 v[224:227], a[40:43], a[104:107], v[224:227]
buffer_load_dwordx4 v23, s[60:63], s64 offen lds
v_mfma_f32_16x16x32_bf16 v[232:235], a[48:51], a[104:107], v[232:235]
v_mfma_f32_16x16x32_bf16 v[232:235], a[52:55], a[108:111], v[232:235]
v_mfma_f32_16x16x32_bf16 v[240:243], a[60:63], a[108:111], v[240:243]
v_mfma_f32_16x16x32_bf16 v[240:243], a[56:59], a[104:107], v[240:243]
ds_read_b64_tr_b16 a[104:105], v6 offset:32768
v_mfma_f32_16x16x32_bf16 v[244:247], a[56:59], a[112:115], v[244:247]
ds_read_b64_tr_b16 a[106:107], v6 offset:33792
v_mfma_f32_16x16x32_bf16 v[244:247], a[60:63], a[116:119], v[244:247]
ds_read_b64_tr_b16 a[108:109], v6 offset:40960
v_subrev_u32 v19, 0x8000, v19
v_mfma_f32_16x16x32_bf16 v[236:239], a[52:55], a[116:119], v[236:239]
s_xor_b32 m0, s77, 101376
ds_read_b64_tr_b16 a[110:111], v6 offset:41984
v_mfma_f32_16x16x32_bf16 v[236:239], a[48:51], a[112:115], v[236:239]
s_xor_b32 s64, s71, 2719744
v_mfma_f32_16x16x32_bf16 v[228:231], a[40:43], a[112:115], v[228:231]
buffer_load_dwordx4 v15, s[56:59], s64 offen lds
v_mfma_f32_16x16x32_bf16 v[228:231], a[44:47], a[116:119], v[228:231]
v_mfma_f32_16x16x32_bf16 v[220:223], a[36:39], a[116:119], v[220:223]
v_mfma_f32_16x16x32_bf16 v[220:223], a[32:35], a[112:115], v[220:223]
s_waitcnt lgkmcnt(4)
ds_read_b64_tr_b16 a[112:113], v7 offset:32768
v_mfma_f32_16x16x32_bf16 v[152:155], a[72:75], a[32:35], v[152:155]
ds_read_b64_tr_b16 a[114:115], v7 offset:33792
v_mfma_f32_16x16x32_bf16 v[152:155], a[76:79], a[36:39], v[152:155]
ds_read_b64_tr_b16 a[116:117], v7 offset:40960
v_subrev_u32 v20, 0x8000, v20
v_mfma_f32_16x16x32_bf16 v[160:163], a[76:79], a[44:47], v[160:163]
ds_read_b64_tr_b16 a[118:119], v7 offset:41984
v_mfma_f32_16x16x32_bf16 v[160:163], a[72:75], a[40:43], v[160:163]
v_mfma_f32_16x16x32_bf16 v[168:171], a[72:75], a[48:51], v[168:171]
v_mfma_f32_16x16x32_bf16 v[168:171], a[76:79], a[52:55], v[168:171]
v_mfma_f32_16x16x32_bf16 v[176:179], a[76:79], a[60:63], v[176:179]
s_xor_b32 m0, s84, 32768
v_mfma_f32_16x16x32_bf16 v[176:179], a[72:75], a[56:59], v[176:179]
s_xor_b32 s64, s72, 640
ds_read_b64_tr_b16 a[72:73], v8 offset:32768
v_mfma_f32_16x16x32_bf16 v[180:183], a[80:83], a[56:59], v[180:183]
s_add_u32 s65, s79, 18432
buffer_load_dwordx4 v12, s[48:51], s64 offen lds
v_mfma_f32_16x16x32_bf16 v[180:183], a[84:87], a[60:63], v[180:183]
buffer_store_dwordx4 a[168:171], v16, s[44:47], s65 offen sc1
v_mfma_f32_16x16x32_bf16 v[172:175], a[84:87], a[52:55], v[172:175]
ds_read_b64_tr_b16 a[74:75], v8 offset:33792
v_subrev_u32 v4, 0x8000, v4
v_mfma_f32_16x16x32_bf16 v[172:175], a[80:83], a[48:51], v[172:175]
s_xor_b32 m0, s84, 33792
ds_read_b64_tr_b16 a[76:77], v8 offset:40960
v_mfma_f32_16x16x32_bf16 v[164:167], a[80:83], a[40:43], v[164:167]
s_xor_b32 s64, s72, 17024
ds_read_b64_tr_b16 a[78:79], v8 offset:41984
v_mfma_f32_16x16x32_bf16 v[164:167], a[84:87], a[44:47], v[164:167]
buffer_load_dwordx4 v13, s[48:51], s64 offen lds
v_mfma_f32_16x16x32_bf16 v[156:159], a[84:87], a[36:39], v[156:159]
v_mfma_f32_16x16x32_bf16 v[156:159], a[80:83], a[32:35], v[156:159]
ds_read_b64_tr_b16 a[80:81], v9 offset:32768
v_mfma_f32_16x16x32_bf16 v[24:27], a[88:91], a[32:35], v[24:27]
s_xor_b32 m0, s84, 34816
ds_read_b64_tr_b16 a[82:83], v9 offset:33792
v_mfma_f32_16x16x32_bf16 v[24:27], a[92:95], a[36:39], v[24:27]
s_xor_b32 s64, s72, 131712
ds_read_b64_tr_b16 a[84:85], v9 offset:40960
v_subrev_u32 v5, 0x8000, v5
v_mfma_f32_16x16x32_bf16 v[40:43], a[92:95], a[44:47], v[40:43]
buffer_load_dwordx4 v12, s[48:51], s64 offen lds
v_mfma_f32_16x16x32_bf16 v[40:43], a[88:91], a[40:43], v[40:43]
ds_read_b64_tr_b16 a[86:87], v9 offset:41984
v_mfma_f32_16x16x32_bf16 v[56:59], a[88:91], a[48:51], v[56:59]
v_mfma_f32_16x16x32_bf16 v[56:59], a[92:95], a[52:55], v[56:59]
s_xor_b32 m0, s84, 35840
v_mfma_f32_16x16x32_bf16 v[72:75], a[92:95], a[60:63], v[72:75]
s_waitcnt vmcnt(13)
s_xor_b32 s64, s72, 148096
ds_read_b128 a[0:3], v2 offset:0
v_mfma_f32_16x16x32_bf16 v[72:75], a[88:91], a[56:59], v[72:75]
buffer_load_dwordx4 v13, s[48:51], s64 offen lds
v_mfma_f32_16x16x32_bf16 v[136:139], a[96:99], a[56:59], v[136:139]
ds_read_b128 a[4:7], v3 offset:0
v_mfma_f32_16x16x32_bf16 v[136:139], a[100:103], a[60:63], v[136:139]
ds_read_b128 a[8:11], v2 offset:2048
v_subrev_u32 v6, 0x8000, v6
v_mfma_f32_16x16x32_bf16 v[120:123], a[100:103], a[52:55], v[120:123]
s_xor_b32 m0, s84, 36864
ds_read_b128 a[12:15], v3 offset:2048
v_mfma_f32_16x16x32_bf16 v[120:123], a[96:99], a[48:51], v[120:123]
s_xor_b32 s64, s73, 640
ds_read_b128 a[16:19], v2 offset:4096
v_mfma_f32_16x16x32_bf16 v[104:107], a[96:99], a[40:43], v[104:107]
buffer_load_dwordx4 v12, s[48:51], s64 offen lds
v_mfma_f32_16x16x32_bf16 v[104:107], a[100:103], a[44:47], v[104:107]
ds_read_b128 a[20:23], v3 offset:4096
v_mfma_f32_16x16x32_bf16 v[88:91], a[100:103], a[36:39], v[88:91]
ds_read_b128 a[24:27], v2 offset:6144
v_mfma_f32_16x16x32_bf16 v[88:91], a[96:99], a[32:35], v[88:91]
s_waitcnt lgkmcnt(7)
s_xor_b32 m0, s84, 37888
ds_read_b128 a[28:31], v3 offset:6144
v_mfma_f32_16x16x32_bf16 v[28:31], a[104:107], a[32:35], v[28:31]
s_xor_b32 s64, s73, 17024
ds_read_b64_tr_b16 a[88:89], v10 offset:32768
v_mfma_f32_16x16x32_bf16 v[28:31], a[108:111], a[36:39], v[28:31]
buffer_load_dwordx4 v13, s[48:51], s64 offen lds
v_mfma_f32_16x16x32_bf16 v[44:47], a[108:111], a[44:47], v[44:47]
ds_read_b64_tr_b16 a[90:91], v10 offset:33792
v_subrev_u32 v7, 0x8000, v7
v_mfma_f32_16x16x32_bf16 v[44:47], a[104:107], a[40:43], v[44:47]
ds_read_b64_tr_b16 a[92:93], v10 offset:40960
v_mfma_f32_16x16x32_bf16 v[60:63], a[104:107], a[48:51], v[60:63]
s_xor_b32 m0, s84, 38912
ds_read_b64_tr_b16 a[94:95], v10 offset:41984
v_mfma_f32_16x16x32_bf16 v[60:63], a[108:111], a[52:55], v[60:63]
s_xor_b32 s64, s73, 131712
ds_read_b64_tr_b16 a[96:97], v11 offset:32768
v_mfma_f32_16x16x32_bf16 v[76:79], a[108:111], a[60:63], v[76:79]
buffer_load_dwordx4 v12, s[48:51], s64 offen lds
v_mfma_f32_16x16x32_bf16 v[76:79], a[104:107], a[56:59], v[76:79]
ds_read_b64_tr_b16 a[98:99], v11 offset:33792
v_mfma_f32_16x16x32_bf16 v[140:143], a[112:115], a[56:59], v[140:143]
ds_read_b64_tr_b16 a[100:101], v11 offset:40960
v_mfma_f32_16x16x32_bf16 v[140:143], a[116:119], a[60:63], v[140:143]
s_xor_b32 m0, s84, 39936
ds_read_b64_tr_b16 a[102:103], v11 offset:41984
v_subrev_u32 v8, 0x8000, v8
v_mfma_f32_16x16x32_bf16 v[124:127], a[116:119], a[52:55], v[124:127]
s_xor_b32 s64, s73, 148096
v_mfma_f32_16x16x32_bf16 v[124:127], a[112:115], a[48:51], v[124:127]
buffer_load_dwordx4 v13, s[48:51], s64 offen lds
v_mfma_f32_16x16x32_bf16 v[108:111], a[112:115], a[40:43], v[108:111]
v_mfma_f32_16x16x32_bf16 v[108:111], a[116:119], a[44:47], v[108:111]
v_mfma_f32_16x16x32_bf16 v[92:95], a[116:119], a[36:39], v[92:95]
v_subrev_u32 v9, 0x8000, v9
v_subrev_u32 v10, 0x8000, v10
v_mfma_f32_16x16x32_bf16 v[92:95], a[112:115], a[32:35], v[92:95]
v_subrev_u32 v11, 0x8000, v11
v_mfma_f32_16x16x32_bf16 v[32:35], a[72:75], a[32:35], v[32:35]
v_mfma_f32_16x16x32_bf16 v[32:35], a[76:79], a[36:39], v[32:35]
v_mfma_f32_16x16x32_bf16 v[48:51], a[76:79], a[44:47], v[48:51]
s_waitcnt lgkmcnt(0)
s_barrier
v_mfma_f32_16x16x32_bf16 v[48:51], a[72:75], a[40:43], v[48:51]
s_xor_b32 m0, s77, 131072
ds_read_b64_tr_b16 a[104:105], v19 offset:4096
v_mfma_f32_16x16x32_bf16 v[64:67], a[72:75], a[48:51], v[64:67]
s_xor_b32 s64, s71, 3145728
ds_read_b64_tr_b16 a[106:107], v19 offset:4352
v_mfma_f32_16x16x32_bf16 v[64:67], a[76:79], a[52:55], v[64:67]
s_add_u32 s65, s79, 6144
buffer_load_dwordx4 v14, s[56:59], s64 offen lds
v_mfma_f32_16x16x32_bf16 v[80:83], a[76:79], a[60:63], v[80:83]
buffer_store_dwordx4 a[172:175], v16, s[44:47], s65 offen sc1
v_mfma_f32_16x16x32_bf16 v[80:83], a[72:75], a[56:59], v[80:83]
ds_read_b64_tr_b16 a[108:109], v19 offset:6144
v_mfma_f32_16x16x32_bf16 v[144:147], a[80:83], a[56:59], v[144:147]
ds_read_b64_tr_b16 a[110:111], v19 offset:6400
v_mfma_f32_16x16x32_bf16 v[144:147], a[84:87], a[60:63], v[144:147]
ds_read_b64_tr_b16 a[112:113], v20 offset:4096
v_mfma_f32_16x16x32_bf16 v[128:131], a[84:87], a[52:55], v[128:131]
ds_read_b64_tr_b16 a[114:115], v20 offset:4352
v_mfma_f32_16x16x32_bf16 v[128:131], a[80:83], a[48:51], v[128:131]
ds_read_b64_tr_b16 a[116:117], v20 offset:6144
v_mfma_f32_16x16x32_bf16 v[112:115], a[80:83], a[40:43], v[112:115]
s_add_u32 m0, s78, 147456
ds_read_b64_tr_b16 a[118:119], v20 offset:6400
v_mfma_f32_16x16x32_bf16 v[112:115], a[84:87], a[44:47], v[112:115]
s_add_u32 s64, s75, 2359296
ds_read_b64_tr_b16 a[72:73], v19 offset:8192
v_mfma_f32_16x16x32_bf16 v[96:99], a[84:87], a[36:39], v[96:99]
s_branch L_po8
L_pg8:
s_branch L_pg12
L_po8:
buffer_load_dwordx4 v23, s[60:63], s64 offen lds
v_mfma_f32_16x16x32_bf16 v[96:99], a[80:83], a[32:35], v[96:99]
ds_read_b64_tr_b16 a[74:75], v19 offset:8448
v_mfma_f32_16x16x32_bf16 v[36:39], a[88:91], a[32:35], v[36:39]
ds_read_b64_tr_b16 a[76:77], v19 offset:10240
v_mfma_f32_16x16x32_bf16 v[36:39], a[92:95], a[36:39], v[36:39]
ds_read_b64_tr_b16 a[78:79], v19 offset:10496
v_mfma_f32_16x16x32_bf16 v[52:55], a[92:95], a[44:47], v[52:55]
ds_read_b64_tr_b16 a[80:81], v20 offset:8192
v_mfma_f32_16x16x32_bf16 v[52:55], a[88:91], a[40:43], v[52:55]
ds_read_b64_tr_b16 a[82:83], v20 offset:8448
v_mfma_f32_16x16x32_bf16 v[68:71], a[88:91], a[48:51], v[68:71]
s_xor_b32 m0, s77, 132096
ds_read_b64_tr_b16 a[84:85], v20 offset:10240
v_mfma_f32_16x16x32_bf16 v[68:71], a[92:95], a[52:55], v[68:71]
s_xor_b32 s64, s71, 3178496
s_xor_b32 s68, s66, 12288
ds_read_b64_tr_b16 a[86:87], v20 offset:10496
v_mfma_f32_16x16x32_bf16 v[84:87], a[92:95], a[60:63], v[84:87]
s_mov_b64 exec, 1
buffer_atomic_add a251, v1, s[52:55], s68 offen offset:0 sc1
s_mov_b64 exec, -1
v_mfma_f32_16x16x32_bf16 v[84:87], a[88:91], a[56:59], v[84:87]
buffer_load_dwordx4 v14, s[56:59], s64 offen lds
v_mfma_f32_16x16x32_bf16 v[148:151], a[96:99], a[56:59], v[148:151]
ds_read_b64_tr_b16 a[88:89], v19 offset:0
v_mfma_f32_16x16x32_bf16 v[148:151], a[100:103], a[60:63], v[148:151]
ds_read_b64_tr_b16 a[90:91], v19 offset:256
v_mfma_f32_16x16x32_bf16 v[132:135], a[100:103], a[52:55], v[132:135]
ds_read_b64_tr_b16 a[92:93], v19 offset:2048
v_mfma_f32_16x16x32_bf16 v[132:135], a[96:99], a[48:51], v[132:135]
ds_read_b64_tr_b16 a[94:95], v19 offset:2304
v_mfma_f32_16x16x32_bf16 v[116:119], a[96:99], a[40:43], v[116:119]
v_mfma_f32_16x16x32_bf16 v[116:119], a[100:103], a[44:47], v[116:119]
v_mfma_f32_16x16x32_bf16 v[100:103], a[100:103], a[36:39], v[100:103]
s_add_u32 m0, s78, 151552
v_mfma_f32_16x16x32_bf16 v[100:103], a[96:99], a[32:35], v[100:103]
s_waitcnt lgkmcnt(4)
s_add_u32 s64, s75, 2361344
ds_read_b64_tr_b16 a[96:97], v20 offset:0
v_mfma_f32_16x16x32_bf16 v[184:187], a[104:107], a[0:3], v[184:187]
s_mov_b32 s36, s20
buffer_load_dwordx4 v23, s[60:63], s64 offen lds
v_mfma_f32_16x16x32_bf16 v[184:187], a[108:111], a[4:7], v[184:187]
s_mov_b32 s37, s21
ds_read_b64_tr_b16 a[98:99], v20 offset:256
v_mfma_f32_16x16x32_bf16 v[192:195], a[108:111], a[12:15], v[192:195]
s_mov_b32 s38, 2097152
ds_read_b64_tr_b16 a[100:101], v20 offset:2048
v_mfma_f32_16x16x32_bf16 v[192:195], a[104:107], a[8:11], v[192:195]
s_mov_b32 s40, s14
ds_read_b64_tr_b16 a[102:103], v20 offset:2304
v_mfma_f32_16x16x32_bf16 v[200:203], a[104:107], a[16:19], v[200:203]
s_mov_b32 s41, s15
v_mfma_f32_16x16x32_bf16 v[200:203], a[108:111], a[20:23], v[200:203]
s_mov_b32 s42, 8388608
v_mfma_f32_16x16x32_bf16 v[208:211], a[108:111], a[28:31], v[208:211]
v_mfma_f32_16x16x32_bf16 v[208:211], a[104:107], a[24:27], v[208:211]
ds_read_b64_tr_b16 a[104:105], v4 offset:0
v_mfma_f32_16x16x32_bf16 v[212:215], a[112:115], a[24:27], v[212:215]
s_xor_b32 m0, s77, 133120
ds_read_b64_tr_b16 a[106:107], v4 offset:1024
v_mfma_f32_16x16x32_bf16 v[212:215], a[116:119], a[28:31], v[212:215]
s_xor_b32 s64, s71, 3211264
ds_read_b64_tr_b16 a[108:109], v4 offset:8192
v_mfma_f32_16x16x32_bf16 v[204:207], a[116:119], a[20:23], v[204:207]
buffer_load_dwordx4 v15, s[56:59], s64 offen lds
v_mfma_f32_16x16x32_bf16 v[204:207], a[112:115], a[16:19], v[204:207]
ds_read_b64_tr_b16 a[110:111], v4 offset:9216
v_mfma_f32_16x16x32_bf16 v[196:199], a[112:115], a[8:11], v[196:199]
v_mfma_f32_16x16x32_bf16 v[196:199], a[116:119], a[12:15], v[196:199]
v_mfma_f32_16x16x32_bf16 v[188:191], a[116:119], a[4:7], v[188:191]
v_mfma_f32_16x16x32_bf16 v[188:191], a[112:115], a[0:3], v[188:191]
ds_read_b64_tr_b16 a[112:113], v5 offset:0
v_mfma_f32_16x16x32_bf16 v[216:219], a[0:3], a[72:75], v[216:219]
ds_read_b64_tr_b16 a[114:115], v5 offset:1024
v_mfma_f32_16x16x32_bf16 v[216:219], a[4:7], a[76:79], v[216:219]
s_add_u32 m0, s78, 155648
s_add_u32 s65, s79, 2048
ds_read_b64_tr_b16 a[116:117], v5 offset:8192
v_mfma_f32_16x16x32_bf16 v[224:227], a[12:15], a[76:79], v[224:227]
s_add_u32 s64, s75, 2363392
buffer_store_dwordx4 a[176:179], v16, s[44:47], s65 offen sc1
v_mfma_f32_16x16x32_bf16 v[224:227], a[8:11], a[72:75], v[224:227]
buffer_load_dwordx4 v23, s[60:63], s64 offen lds
v_mfma_f32_16x16x32_bf16 v[232:235], a[16:19], a[72:75], v[232:235]
ds_read_b64_tr_b16 a[118:119], v5 offset:9216
v_mfma_f32_16x16x32_bf16 v[232:235], a[20:23], a[76:79], v[232:235]
v_mfma_f32_16x16x32_bf16 v[240:243], a[28:31], a[76:79], v[240:243]
v_mfma_f32_16x16x32_bf16 v[240:243], a[24:27], a[72:75], v[240:243]
ds_read_b64_tr_b16 a[72:73], v6 offset:0
v_mfma_f32_16x16x32_bf16 v[244:247], a[24:27], a[80:83], v[244:247]
ds_read_b64_tr_b16 a[74:75], v6 offset:1024
v_mfma_f32_16x16x32_bf16 v[244:247], a[28:31], a[84:87], v[244:247]
ds_read_b64_tr_b16 a[76:77], v6 offset:8192
v_mfma_f32_16x16x32_bf16 v[236:239], a[20:23], a[84:87], v[236:239]
s_xor_b32 m0, s77, 134144
ds_read_b64_tr_b16 a[78:79], v6 offset:9216
v_mfma_f32_16x16x32_bf16 v[236:239], a[16:19], a[80:83], v[236:239]
s_xor_b32 s64, s71, 3244032
v_mfma_f32_16x16x32_bf16 v[228:231], a[8:11], a[80:83], v[228:231]
buffer_load_dwordx4 v15, s[56:59], s64 offen lds
v_mfma_f32_16x16x32_bf16 v[228:231], a[12:15], a[84:87], v[228:231]
v_mfma_f32_16x16x32_bf16 v[220:223], a[4:7], a[84:87], v[220:223]
v_mfma_f32_16x16x32_bf16 v[220:223], a[0:3], a[80:83], v[220:223]
s_waitcnt lgkmcnt(4)
ds_read_b64_tr_b16 a[80:81], v7 offset:0
v_mfma_f32_16x16x32_bf16 v[152:155], a[88:91], a[0:3], v[152:155]
ds_read_b64_tr_b16 a[82:83], v7 offset:1024
v_mfma_f32_16x16x32_bf16 v[152:155], a[92:95], a[4:7], v[152:155]
ds_read_b64_tr_b16 a[84:85], v7 offset:8192
v_mfma_f32_16x16x32_bf16 v[160:163], a[92:95], a[12:15], v[160:163]
ds_read_b64_tr_b16 a[86:87], v7 offset:9216
v_mfma_f32_16x16x32_bf16 v[160:163], a[88:91], a[8:11], v[160:163]
v_mfma_f32_16x16x32_bf16 v[168:171], a[88:91], a[16:19], v[168:171]
v_mfma_f32_16x16x32_bf16 v[168:171], a[92:95], a[20:23], v[168:171]
v_mfma_f32_16x16x32_bf16 v[176:179], a[92:95], a[28:31], v[176:179]
s_xor_b32 m0, s84, 0
v_mfma_f32_16x16x32_bf16 v[176:179], a[88:91], a[24:27], v[176:179]
s_xor_b32 s64, s72, 768
ds_read_b64_tr_b16 a[88:89], v8 offset:0
v_mfma_f32_16x16x32_bf16 v[180:183], a[96:99], a[24:27], v[180:183]
buffer_load_dwordx4 v12, s[48:51], s64 offen lds
v_mfma_f32_16x16x32_bf16 v[180:183], a[100:103], a[28:31], v[180:183]
ds_read_b64_tr_b16 a[90:91], v8 offset:1024
v_mfma_f32_16x16x32_bf16 v[172:175], a[100:103], a[20:23], v[172:175]
ds_read_b64_tr_b16 a[92:93], v8 offset:8192
v_mfma_f32_16x16x32_bf16 v[172:175], a[96:99], a[16:19], v[172:175]
s_xor_b32 m0, s84, 1024
ds_read_b64_tr_b16 a[94:95], v8 offset:9216
v_mfma_f32_16x16x32_bf16 v[164:167], a[96:99], a[8:11], v[164:167]
s_xor_b32 s64, s72, 17152
v_mfma_f32_16x16x32_bf16 v[164:167], a[100:103], a[12:15], v[164:167]
buffer_load_dwordx4 v13, s[48:51], s64 offen lds
v_mfma_f32_16x16x32_bf16 v[156:159], a[100:103], a[4:7], v[156:159]
v_mfma_f32_16x16x32_bf16 v[156:159], a[96:99], a[0:3], v[156:159]
ds_read_b64_tr_b16 a[96:97], v9 offset:0
v_mfma_f32_16x16x32_bf16 v[24:27], a[104:107], a[0:3], v[24:27]
s_xor_b32 m0, s84, 2048
ds_read_b64_tr_b16 a[98:99], v9 offset:1024
v_mfma_f32_16x16x32_bf16 v[24:27], a[108:111], a[4:7], v[24:27]
s_xor_b32 s64, s72, 131840
ds_read_b64_tr_b16 a[100:101], v9 offset:8192
v_mfma_f32_16x16x32_bf16 v[40:43], a[108:111], a[12:15], v[40:43]
buffer_load_dwordx4 v12, s[48:51], s64 offen lds
v_mfma_f32_16x16x32_bf16 v[40:43], a[104:107], a[8:11], v[40:43]
ds_read_b64_tr_b16 a[102:103], v9 offset:9216
v_mfma_f32_16x16x32_bf16 v[56:59], a[104:107], a[16:19], v[56:59]
v_mfma_f32_16x16x32_bf16 v[56:59], a[108:111], a[20:23], v[56:59]
s_xor_b32 m0, s84, 3072
v_mfma_f32_16x16x32_bf16 v[72:75], a[108:111], a[28:31], v[72:75]
s_waitcnt vmcnt(13)
s_xor_b32 s64, s72, 148224
ds_read_b128 a[32:35], v2 offset:32768
v_mfma_f32_16x16x32_bf16 v[72:75], a[104:107], a[24:27], v[72:75]
buffer_load_dwordx4 v13, s[48:51], s64 offen lds
v_mfma_f32_16x16x32_bf16 v[136:139], a[112:115], a[24:27], v[136:139]
ds_read_b128 a[36:39], v3 offset:32768
v_mfma_f32_16x16x32_bf16 v[136:139], a[116:119], a[28:31], v[136:139]
ds_read_b128 a[40:43], v2 offset:34816
v_mfma_f32_16x16x32_bf16 v[120:123], a[116:119], a[20:23], v[120:123]
s_xor_b32 m0, s84, 4096
ds_read_b128 a[44:47], v3 offset:34816
v_mfma_f32_16x16x32_bf16 v[120:123], a[112:115], a[16:19], v[120:123]
s_xor_b32 s64, s73, 768
ds_read_b128 a[48:51], v2 offset:36864
v_mfma_f32_16x16x32_bf16 v[104:107], a[112:115], a[8:11], v[104:107]
buffer_load_dwordx4 v12, s[48:51], s64 offen lds
v_mfma_f32_16x16x32_bf16 v[104:107], a[116:119], a[12:15], v[104:107]
s_add_u32 s65, s79, 19456
ds_read_b128 a[52:55], v3 offset:36864
v_mfma_f32_16x16x32_bf16 v[88:91], a[116:119], a[4:7], v[88:91]
buffer_store_dwordx4 a[180:183], v16, s[44:47], s65 offen sc1
v_mfma_f32_16x16x32_bf16 v[88:91], a[112:115], a[0:3], v[88:91]
s_waitcnt lgkmcnt(6)
s_xor_b32 m0, s84, 5120
ds_read_b128 a[56:59], v2 offset:38912
v_mfma_f32_16x16x32_bf16 v[28:31], a[72:75], a[0:3], v[28:31]
s_xor_b32 s64, s73, 17152
ds_read_b128 a[60:63], v3 offset:38912
v_mfma_f32_16x16x32_bf16 v[28:31], a[76:79], a[4:7], v[28:31]
buffer_load_dwordx4 v13, s[48:51], s64 offen lds
v_mfma_f32_16x16x32_bf16 v[44:47], a[76:79], a[12:15], v[44:47]
ds_read_b64_tr_b16 a[104:105], v10 offset:0
v_mfma_f32_16x16x32_bf16 v[44:47], a[72:75], a[8:11], v[44:47]
ds_read_b64_tr_b16 a[106:107], v10 offset:1024
v_mfma_f32_16x16x32_bf16 v[60:63], a[72:75], a[16:19], v[60:63]
s_xor_b32 m0, s84, 6144
ds_read_b64_tr_b16 a[108:109], v10 offset:8192
v_mfma_f32_16x16x32_bf16 v[60:63], a[76:79], a[20:23], v[60:63]
s_xor_b32 s64, s73, 131840
ds_read_b64_tr_b16 a[110:111], v10 offset:9216
v_mfma_f32_16x16x32_bf16 v[76:79], a[76:79], a[28:31], v[76:79]
buffer_load_dwordx4 v12, s[48:51], s64 offen lds
v_mfma_f32_16x16x32_bf16 v[76:79], a[72:75], a[24:27], v[76:79]
ds_read_b64_tr_b16 a[112:113], v11 offset:0
v_mfma_f32_16x16x32_bf16 v[140:143], a[80:83], a[24:27], v[140:143]
ds_read_b64_tr_b16 a[114:115], v11 offset:1024
v_mfma_f32_16x16x32_bf16 v[140:143], a[84:87], a[28:31], v[140:143]
s_xor_b32 m0, s84, 7168
ds_read_b64_tr_b16 a[116:117], v11 offset:8192
v_mfma_f32_16x16x32_bf16 v[124:127], a[84:87], a[20:23], v[124:127]
s_xor_b32 s64, s73, 148224
ds_read_b64_tr_b16 a[118:119], v11 offset:9216
v_mfma_f32_16x16x32_bf16 v[124:127], a[80:83], a[16:19], v[124:127]
buffer_load_dwordx4 v13, s[48:51], s64 offen lds
v_mfma_f32_16x16x32_bf16 v[108:111], a[80:83], a[8:11], v[108:111]
v_mfma_f32_16x16x32_bf16 v[108:111], a[84:87], a[12:15], v[108:111]
v_mfma_f32_16x16x32_bf16 v[92:95], a[84:87], a[4:7], v[92:95]
v_mfma_f32_16x16x32_bf16 v[92:95], a[80:83], a[0:3], v[92:95]
v_mfma_f32_16x16x32_bf16 v[32:35], a[88:91], a[0:3], v[32:35]
v_mfma_f32_16x16x32_bf16 v[32:35], a[92:95], a[4:7], v[32:35]
v_mfma_f32_16x16x32_bf16 v[48:51], a[92:95], a[12:15], v[48:51]
s_waitcnt lgkmcnt(0)
s_barrier
v_mfma_f32_16x16x32_bf16 v[48:51], a[88:91], a[8:11], v[48:51]
s_xor_b32 m0, s77, 65536
ds_read_b64_tr_b16 a[72:73], v19 offset:36864
v_mfma_f32_16x16x32_bf16 v[64:67], a[88:91], a[16:19], v[64:67]
s_xor_b32 s64, s71, 3670016
ds_read_b64_tr_b16 a[74:75], v19 offset:37120
v_mfma_f32_16x16x32_bf16 v[64:67], a[92:95], a[20:23], v[64:67]
buffer_load_dwordx4 v14, s[56:59], s64 offen lds
v_mfma_f32_16x16x32_bf16 v[80:83], a[92:95], a[28:31], v[80:83]
ds_read_b64_tr_b16 a[76:77], v19 offset:38912
v_mfma_f32_16x16x32_bf16 v[80:83], a[88:91], a[24:27], v[80:83]
ds_read_b64_tr_b16 a[78:79], v19 offset:39168
v_mfma_f32_16x16x32_bf16 v[144:147], a[96:99], a[24:27], v[144:147]
ds_read_b64_tr_b16 a[80:81], v20 offset:36864
v_mfma_f32_16x16x32_bf16 v[144:147], a[100:103], a[28:31], v[144:147]
ds_read_b64_tr_b16 a[82:83], v20 offset:37120
v_mfma_f32_16x16x32_bf16 v[128:131], a[100:103], a[20:23], v[128:131]
ds_read_b64_tr_b16 a[84:85], v20 offset:38912
v_mfma_f32_16x16x32_bf16 v[128:131], a[96:99], a[16:19], v[128:131]
ds_read_b64_tr_b16 a[86:87], v20 offset:39168
v_mfma_f32_16x16x32_bf16 v[112:115], a[96:99], a[8:11], v[112:115]
s_add_u32 m0, s78, 81920
ds_read_b64_tr_b16 a[88:89], v19 offset:40960
v_mfma_f32_16x16x32_bf16 v[112:115], a[100:103], a[12:15], v[112:115]
s_add_u32 s64, s75, 2752512
ds_read_b64_tr_b16 a[90:91], v19 offset:41216
v_mfma_f32_16x16x32_bf16 v[96:99], a[100:103], a[4:7], v[96:99]
buffer_load_dwordx4 v23, s[60:63], s64 offen lds
v_mfma_f32_16x16x32_bf16 v[96:99], a[96:99], a[0:3], v[96:99]
ds_read_b64_tr_b16 a[92:93], v19 offset:43008
v_mfma_f32_16x16x32_bf16 v[36:39], a[104:107], a[0:3], v[36:39]
ds_read_b64_tr_b16 a[94:95], v19 offset:43264
v_mfma_f32_16x16x32_bf16 v[36:39], a[108:111], a[4:7], v[36:39]
ds_read_b64_tr_b16 a[96:97], v20 offset:40960
v_mfma_f32_16x16x32_bf16 v[52:55], a[108:111], a[12:15], v[52:55]
ds_read_b64_tr_b16 a[98:99], v20 offset:41216
v_mfma_f32_16x16x32_bf16 v[52:55], a[104:107], a[8:11], v[52:55]
ds_read_b64_tr_b16 a[100:101], v20 offset:43008
v_mfma_f32_16x16x32_bf16 v[68:71], a[104:107], a[16:19], v[68:71]
ds_read_b64_tr_b16 a[102:103], v20 offset:43264
v_mfma_f32_16x16x32_bf16 v[68:71], a[108:111], a[20:23], v[68:71]
s_xor_b32 m0, s77, 66560
v_mfma_f32_16x16x32_bf16 v[84:87], a[108:111], a[28:31], v[84:87]
s_xor_b32 s64, s71, 3702784
v_mfma_f32_16x16x32_bf16 v[84:87], a[104:107], a[24:27], v[84:87]
buffer_load_dwordx4 v14, s[56:59], s64 offen lds
v_mfma_f32_16x16x32_bf16 v[148:151], a[112:115], a[24:27], v[148:151]
ds_read_b64_tr_b16 a[104:105], v19 offset:32768
v_mfma_f32_16x16x32_bf16 v[148:151], a[116:119], a[28:31], v[148:151]
ds_read_b64_tr_b16 a[106:107], v19 offset:33024
v_mfma_f32_16x16x32_bf16 v[132:135], a[116:119], a[20:23], v[132:135]
s_add_u32 s65, s79, 7168
ds_read_b64_tr_b16 a[108:109], v19 offset:34816
v_mfma_f32_16x16x32_bf16 v[132:135], a[112:115], a[16:19], v[132:135]
buffer_store_dwordx4 a[184:187], v16, s[44:47], s65 offen sc1
v_mfma_f32_16x16x32_bf16 v[116:119], a[112:115], a[8:11], v[116:119]
ds_read_b64_tr_b16 a[110:111], v19 offset:35072
v_mfma_f32_16x16x32_bf16 v[116:119], a[116:119], a[12:15], v[116:119]
v_mfma_f32_16x16x32_bf16 v[100:103], a[116:119], a[4:7], v[100:103]
s_add_u32 m0, s78, 86016
v_mfma_f32_16x16x32_bf16 v[100:103], a[112:115], a[0:3], v[100:103]
s_waitcnt lgkmcnt(4)
s_add_u32 s64, s75, 2754560
ds_read_b64_tr_b16 a[112:113], v20 offset:32768
v_mfma_f32_16x16x32_bf16 v[184:187], a[72:75], a[32:35], v[184:187]
buffer_load_dwordx4 v23, s[60:63], s64 offen lds
v_mfma_f32_16x16x32_bf16 v[184:187], a[76:79], a[36:39], v[184:187]
ds_read_b64_tr_b16 a[114:115], v20 offset:33024
v_and_b32 v22, 15, v0
v_mfma_f32_16x16x32_bf16 v[192:195], a[76:79], a[44:47], v[192:195]
ds_read_b64_tr_b16 a[116:117], v20 offset:34816
v_lshrrev_b32 v17, 4, v0
v_mfma_f32_16x16x32_bf16 v[192:195], a[72:75], a[40:43], v[192:195]
ds_read_b64_tr_b16 a[118:119], v20 offset:35072
v_lshlrev_b32 v17, 2, v17
v_mfma_f32_16x16x32_bf16 v[200:203], a[72:75], a[48:51], v[200:203]
v_sub_u32 v22, v22, v17
v_subrev_u32 v17, 0, v22
v_mfma_f32_16x16x32_bf16 v[200:203], a[76:79], a[52:55], v[200:203]
v_lshlrev_b32 v18, 31, v17
v_or_b32 v21, v17, v18
v_mfma_f32_16x16x32_bf16 v[208:211], a[76:79], a[60:63], v[208:211]
v_ashrrev_i32 v21, 31, v21
v_and_b32 v248, 0xff800000, v21
v_mfma_f32_16x16x32_bf16 v[208:211], a[72:75], a[56:59], v[208:211]
ds_read_b64_tr_b16 a[72:73], v4 offset:32768
v_not_b32 v17, v17
v_mfma_f32_16x16x32_bf16 v[212:215], a[80:83], a[56:59], v[212:215]
s_xor_b32 m0, s77, 67584
ds_read_b64_tr_b16 a[74:75], v4 offset:33792
v_or_b32 v21, v17, v18
v_mfma_f32_16x16x32_bf16 v[212:215], a[84:87], a[60:63], v[212:215]
s_xor_b32 s64, s71, 3735552
ds_read_b64_tr_b16 a[76:77], v4 offset:40960
v_ashrrev_i32 v21, 31, v21
v_mfma_f32_16x16x32_bf16 v[204:207], a[84:87], a[52:55], v[204:207]
buffer_load_dwordx4 v15, s[56:59], s64 offen lds
v_mfma_f32_16x16x32_bf16 v[204:207], a[80:83], a[48:51], v[204:207]
ds_read_b64_tr_b16 a[78:79], v4 offset:41984
v_and_b32 v252, 0xff800000, v21
v_mfma_f32_16x16x32_bf16 v[196:199], a[80:83], a[40:43], v[196:199]
v_subrev_u32 v17, 1, v22
v_lshlrev_b32 v18, 31, v17
v_mfma_f32_16x16x32_bf16 v[196:199], a[84:87], a[44:47], v[196:199]
v_or_b32 v21, v17, v18
v_ashrrev_i32 v21, 31, v21
v_mfma_f32_16x16x32_bf16 v[188:191], a[84:87], a[36:39], v[188:191]
v_and_b32 v249, 0xff800000, v21
v_not_b32 v17, v17
v_mfma_f32_16x16x32_bf16 v[188:191], a[80:83], a[32:35], v[188:191]
ds_read_b64_tr_b16 a[80:81], v5 offset:32768
v_or_b32 v21, v17, v18
v_mfma_f32_16x16x32_bf16 v[216:219], a[32:35], a[88:91], v[216:219]
ds_read_b64_tr_b16 a[82:83], v5 offset:33792
v_ashrrev_i32 v21, 31, v21
v_mfma_f32_16x16x32_bf16 v[216:219], a[36:39], a[92:95], v[216:219]
s_add_u32 m0, s78, 90112
ds_read_b64_tr_b16 a[84:85], v5 offset:40960
v_and_b32 v253, 0xff800000, v21
v_mfma_f32_16x16x32_bf16 v[224:227], a[44:47], a[92:95], v[224:227]
s_add_u32 s64, s75, 2756608
ds_read_b64_tr_b16 a[86:87], v5 offset:41984
v_subrev_u32 v17, 2, v22
v_mfma_f32_16x16x32_bf16 v[224:227], a[40:43], a[88:91], v[224:227]
buffer_load_dwordx4 v23, s[60:63], s64 offen lds
v_mfma_f32_16x16x32_bf16 v[232:235], a[48:51], a[88:91], v[232:235]
v_lshlrev_b32 v18, 31, v17
v_or_b32 v21, v17, v18
v_mfma_f32_16x16x32_bf16 v[232:235], a[52:55], a[92:95], v[232:235]
v_ashrrev_i32 v21, 31, v21
v_and_b32 v250, 0xff800000, v21
v_mfma_f32_16x16x32_bf16 v[240:243], a[60:63], a[92:95], v[240:243]
v_not_b32 v17, v17
v_or_b32 v21, v17, v18
v_mfma_f32_16x16x32_bf16 v[240:243], a[56:59], a[88:91], v[240:243]
ds_read_b64_tr_b16 a[88:89], v6 offset:32768
v_ashrrev_i32 v21, 31, v21
v_mfma_f32_16x16x32_bf16 v[244:247], a[56:59], a[96:99], v[244:247]
ds_read_b64_tr_b16 a[90:91], v6 offset:33792
v_and_b32 v254, 0xff800000, v21
v_mfma_f32_16x16x32_bf16 v[244:247], a[60:63], a[100:103], v[244:247]
ds_read_b64_tr_b16 a[92:93], v6 offset:40960
v_add_u32 v19, 0x8000, v19
v_mfma_f32_16x16x32_bf16 v[236:239], a[52:55], a[100:103], v[236:239]
s_xor_b32 m0, s77, 68608
ds_read_b64_tr_b16 a[94:95], v6 offset:41984
v_subrev_u32 v17, 3, v22
v_mfma_f32_16x16x32_bf16 v[236:239], a[48:51], a[96:99], v[236:239]
s_xor_b32 s64, s71, 3768320
v_lshlrev_b32 v18, 31, v17
v_or_b32 v21, v17, v18
v_mfma_f32_16x16x32_bf16 v[228:231], a[40:43], a[96:99], v[228:231]
buffer_load_dwordx4 v15, s[56:59], s64 offen lds
v_mfma_f32_16x16x32_bf16 v[228:231], a[44:47], a[100:103], v[228:231]
v_ashrrev_i32 v21, 31, v21
v_and_b32 v251, 0xff800000, v21
v_mfma_f32_16x16x32_bf16 v[220:223], a[36:39], a[100:103], v[220:223]
v_not_b32 v17, v17
v_or_b32 v21, v17, v18
v_mfma_f32_16x16x32_bf16 v[220:223], a[32:35], a[96:99], v[220:223]
s_waitcnt lgkmcnt(4)
ds_read_b64_tr_b16 a[96:97], v7 offset:32768
v_ashrrev_i32 v21, 31, v21
v_mfma_f32_16x16x32_bf16 v[152:155], a[104:107], a[32:35], v[152:155]
ds_read_b64_tr_b16 a[98:99], v7 offset:33792
v_and_b32 v255, 0xff800000, v21
v_mfma_f32_16x16x32_bf16 v[152:155], a[108:111], a[36:39], v[152:155]
s_lshl_b32 s69, s30, 4
ds_read_b64_tr_b16 a[100:101], v7 offset:40960
v_add_u32 v20, 0x8000, v20
v_mfma_f32_16x16x32_bf16 v[160:163], a[108:111], a[44:47], v[160:163]
ds_read_b64_tr_b16 a[102:103], v7 offset:41984
v_add_u32 v18, s69, v22
v_mfma_f32_16x16x32_bf16 v[160:163], a[104:107], a[40:43], v[160:163]
s_lshr_b32 s69, s30, 1
v_mfma_f32_16x16x32_bf16 v[168:171], a[104:107], a[48:51], v[168:171]
s_mul_i32 s69, s69, 18432
v_mfma_f32_16x16x32_bf16 v[168:171], a[108:111], a[52:55], v[168:171]
s_add_u32 s69, s69, s78
v_mfma_f32_16x16x32_bf16 v[176:179], a[108:111], a[60:63], v[176:179]
s_add_u32 s69, s69, 32768
s_xor_b32 m0, s84, 32768
v_mfma_f32_16x16x32_bf16 v[176:179], a[104:107], a[56:59], v[176:179]
s_xor_b32 s64, s72, 896
ds_read_b64_tr_b16 a[104:105], v8 offset:32768
v_add_u32 v17, s69, v16
v_mfma_f32_16x16x32_bf16 v[180:183], a[112:115], a[56:59], v[180:183]
s_add_u32 s65, s79, 3072
buffer_load_dwordx4 v12, s[48:51], s64 offen lds
v_mfma_f32_16x16x32_bf16 v[180:183], a[116:119], a[60:63], v[180:183]
buffer_store_dwordx4 a[188:191], v16, s[44:47], s65 offen sc1
v_mfma_f32_16x16x32_bf16 v[172:175], a[116:119], a[52:55], v[172:175]
ds_read_b64_tr_b16 a[106:107], v8 offset:33792
v_add_u32 v4, 0x8000, v4
v_mfma_f32_16x16x32_bf16 v[172:175], a[112:115], a[48:51], v[172:175]
s_xor_b32 m0, s84, 33792
ds_read_b64_tr_b16 a[108:109], v8 offset:40960
v_lshlrev_b32 v21, 5, v0
v_mfma_f32_16x16x32_bf16 v[164:167], a[112:115], a[40:43], v[164:167]
s_xor_b32 s64, s72, 17280
ds_read_b64_tr_b16 a[110:111], v8 offset:41984
v_mfma_f32_16x16x32_bf16 v[164:167], a[116:119], a[44:47], v[164:167]
buffer_load_dwordx4 v13, s[48:51], s64 offen lds
v_mfma_f32_16x16x32_bf16 v[156:159], a[116:119], a[36:39], v[156:159]
v_mfma_f32_16x16x32_bf16 v[156:159], a[112:115], a[32:35], v[156:159]
ds_read_b64_tr_b16 a[112:113], v9 offset:32768
v_mfma_f32_16x16x32_bf16 v[24:27], a[72:75], a[32:35], v[24:27]
s_xor_b32 m0, s84, 34816
ds_read_b64_tr_b16 a[114:115], v9 offset:33792
v_mfma_f32_16x16x32_bf16 v[24:27], a[76:79], a[36:39], v[24:27]
s_xor_b32 s64, s72, 131968
ds_read_b64_tr_b16 a[116:117], v9 offset:40960
v_add_u32 v5, 0x8000, v5
v_mfma_f32_16x16x32_bf16 v[40:43], a[76:79], a[44:47], v[40:43]
buffer_load_dwordx4 v12, s[48:51], s64 offen lds
v_mfma_f32_16x16x32_bf16 v[40:43], a[72:75], a[40:43], v[40:43]
ds_read_b64_tr_b16 a[118:119], v9 offset:41984
v_mfma_f32_16x16x32_bf16 v[56:59], a[72:75], a[48:51], v[56:59]
v_mfma_f32_16x16x32_bf16 v[56:59], a[76:79], a[52:55], v[56:59]
s_xor_b32 m0, s84, 35840
v_mfma_f32_16x16x32_bf16 v[72:75], a[76:79], a[60:63], v[72:75]
s_waitcnt vmcnt(12)
s_xor_b32 s64, s72, 148352
ds_read_b128 a[0:3], v2 offset:0
v_mfma_f32_16x16x32_bf16 v[72:75], a[72:75], a[56:59], v[72:75]
buffer_load_dwordx4 v13, s[48:51], s64 offen lds
v_mfma_f32_16x16x32_bf16 v[136:139], a[80:83], a[56:59], v[136:139]
ds_read_b128 a[4:7], v3 offset:0
v_mfma_f32_16x16x32_bf16 v[136:139], a[84:87], a[60:63], v[136:139]
ds_read_b128 a[8:11], v2 offset:2048
v_add_u32 v6, 0x8000, v6
v_mfma_f32_16x16x32_bf16 v[120:123], a[84:87], a[52:55], v[120:123]
s_xor_b32 m0, s84, 36864
ds_read_b128 a[12:15], v3 offset:2048
v_mfma_f32_16x16x32_bf16 v[120:123], a[80:83], a[48:51], v[120:123]
s_xor_b32 s64, s73, 896
ds_read_b128 a[16:19], v2 offset:4096
v_mfma_f32_16x16x32_bf16 v[104:107], a[80:83], a[40:43], v[104:107]
buffer_load_dwordx4 v12, s[48:51], s64 offen lds
v_mfma_f32_16x16x32_bf16 v[104:107], a[84:87], a[44:47], v[104:107]
ds_read_b128 a[20:23], v3 offset:4096
v_mfma_f32_16x16x32_bf16 v[88:91], a[84:87], a[36:39], v[88:91]
ds_read_b128 a[24:27], v2 offset:6144
v_mfma_f32_16x16x32_bf16 v[88:91], a[80:83], a[32:35], v[88:91]
s_waitcnt lgkmcnt(7)
s_xor_b32 m0, s84, 37888
ds_read_b128 a[28:31], v3 offset:6144
v_mfma_f32_16x16x32_bf16 v[28:31], a[88:91], a[32:35], v[28:31]
s_xor_b32 s64, s73, 17280
ds_read_b64_tr_b16 a[72:73], v10 offset:32768
v_mfma_f32_16x16x32_bf16 v[28:31], a[92:95], a[36:39], v[28:31]
buffer_load_dwordx4 v13, s[48:51], s64 offen lds
v_mfma_f32_16x16x32_bf16 v[44:47], a[92:95], a[44:47], v[44:47]
ds_read_b64_tr_b16 a[74:75], v10 offset:33792
v_add_u32 v7, 0x8000, v7
v_mfma_f32_16x16x32_bf16 v[44:47], a[88:91], a[40:43], v[44:47]
ds_read_b64_tr_b16 a[76:77], v10 offset:40960
v_mfma_f32_16x16x32_bf16 v[60:63], a[88:91], a[48:51], v[60:63]
s_xor_b32 m0, s84, 38912
ds_read_b64_tr_b16 a[78:79], v10 offset:41984
v_mfma_f32_16x16x32_bf16 v[60:63], a[92:95], a[52:55], v[60:63]
s_xor_b32 s64, s73, 131968
ds_read_b64_tr_b16 a[80:81], v11 offset:32768
v_mfma_f32_16x16x32_bf16 v[76:79], a[92:95], a[60:63], v[76:79]
buffer_load_dwordx4 v12, s[48:51], s64 offen lds
v_mfma_f32_16x16x32_bf16 v[76:79], a[88:91], a[56:59], v[76:79]
ds_read_b64_tr_b16 a[82:83], v11 offset:33792
v_mfma_f32_16x16x32_bf16 v[140:143], a[96:99], a[56:59], v[140:143]
ds_read_b64_tr_b16 a[84:85], v11 offset:40960
v_mfma_f32_16x16x32_bf16 v[140:143], a[100:103], a[60:63], v[140:143]
s_xor_b32 m0, s84, 39936
ds_read_b64_tr_b16 a[86:87], v11 offset:41984
v_add_u32 v8, 0x8000, v8
v_mfma_f32_16x16x32_bf16 v[124:127], a[100:103], a[52:55], v[124:127]
s_xor_b32 s64, s73, 148352
v_mfma_f32_16x16x32_bf16 v[124:127], a[96:99], a[48:51], v[124:127]
buffer_load_dwordx4 v13, s[48:51], s64 offen lds
v_mfma_f32_16x16x32_bf16 v[108:111], a[96:99], a[40:43], v[108:111]
v_mfma_f32_16x16x32_bf16 v[108:111], a[100:103], a[44:47], v[108:111]
v_mfma_f32_16x16x32_bf16 v[92:95], a[100:103], a[36:39], v[92:95]
v_add_u32 v9, 0x8000, v9
v_add_u32 v10, 0x8000, v10
v_mfma_f32_16x16x32_bf16 v[92:95], a[96:99], a[32:35], v[92:95]
v_add_u32 v11, 0x8000, v11
v_mfma_f32_16x16x32_bf16 v[32:35], a[104:107], a[32:35], v[32:35]
v_mfma_f32_16x16x32_bf16 v[32:35], a[108:111], a[36:39], v[32:35]
v_mfma_f32_16x16x32_bf16 v[48:51], a[108:111], a[44:47], v[48:51]
s_waitcnt lgkmcnt(0)
s_barrier
v_mfma_f32_16x16x32_bf16 v[48:51], a[104:107], a[40:43], v[48:51]
s_xor_b32 m0, s77, 98304
ds_read_b64_tr_b16 a[88:89], v19 offset:36864
v_mfma_f32_16x16x32_bf16 v[64:67], a[104:107], a[48:51], v[64:67]
s_xor_b32 s64, s71, 4194304
ds_read_b64_tr_b16 a[90:91], v19 offset:37120
v_mfma_f32_16x16x32_bf16 v[64:67], a[108:111], a[52:55], v[64:67]
s_add_u32 s65, s79, 24576
buffer_load_dwordx4 v14, s[56:59], s64 offen lds
v_mfma_f32_16x16x32_bf16 v[80:83], a[108:111], a[60:63], v[80:83]
buffer_store_dwordx4 a[192:195], v16, s[44:47], s65 offen sc1
v_mfma_f32_16x16x32_bf16 v[80:83], a[104:107], a[56:59], v[80:83]
ds_read_b64_tr_b16 a[92:93], v19 offset:38912
v_mfma_f32_16x16x32_bf16 v[144:147], a[112:115], a[56:59], v[144:147]
ds_read_b64_tr_b16 a[94:95], v19 offset:39168
v_mfma_f32_16x16x32_bf16 v[144:147], a[116:119], a[60:63], v[144:147]
ds_read_b64_tr_b16 a[96:97], v20 offset:36864
v_mfma_f32_16x16x32_bf16 v[128:131], a[116:119], a[52:55], v[128:131]
ds_read_b64_tr_b16 a[98:99], v20 offset:37120
v_mfma_f32_16x16x32_bf16 v[128:131], a[112:115], a[48:51], v[128:131]
ds_read_b64_tr_b16 a[100:101], v20 offset:38912
v_mfma_f32_16x16x32_bf16 v[112:115], a[112:115], a[40:43], v[112:115]
s_add_u32 m0, s78, 114688
ds_read_b64_tr_b16 a[102:103], v20 offset:39168
v_mfma_f32_16x16x32_bf16 v[112:115], a[116:119], a[44:47], v[112:115]
s_add_u32 s64, s75, 3145728
ds_read_b64_tr_b16 a[104:105], v19 offset:40960
v_mfma_f32_16x16x32_bf16 v[96:99], a[116:119], a[36:39], v[96:99]
buffer_load_dwordx4 v23, s[60:63], s64 offen lds
v_mfma_f32_16x16x32_bf16 v[96:99], a[112:115], a[32:35], v[96:99]
ds_read_b64_tr_b16 a[106:107], v19 offset:41216
v_mfma_f32_16x16x32_bf16 v[36:39], a[72:75], a[32:35], v[36:39]
ds_read_b64_tr_b16 a[108:109], v19 offset:43008
v_mfma_f32_16x16x32_bf16 v[36:39], a[76:79], a[36:39], v[36:39]
s_branch L_po9
L_pg9:
s_branch L_pg13
L_po9:
ds_read_b64_tr_b16 a[110:111], v19 offset:43264
v_mfma_f32_16x16x32_bf16 v[52:55], a[76:79], a[44:47], v[52:55]
ds_read_b64_tr_b16 a[112:113], v20 offset:40960
v_mfma_f32_16x16x32_bf16 v[52:55], a[72:75], a[40:43], v[52:55]
ds_read_b64_tr_b16 a[114:115], v20 offset:41216
v_mfma_f32_16x16x32_bf16 v[68:71], a[72:75], a[48:51], v[68:71]
ds_read_b64_tr_b16 a[116:117], v20 offset:43008
v_mfma_f32_16x16x32_bf16 v[68:71], a[76:79], a[52:55], v[68:71]
s_xor_b32 m0, s77, 99328
ds_read_b64_tr_b16 a[118:119], v20 offset:43264
v_mfma_f32_16x16x32_bf16 v[84:87], a[76:79], a[60:63], v[84:87]
s_xor_b32 s64, s71, 4227072
v_mfma_f32_16x16x32_bf16 v[84:87], a[72:75], a[56:59], v[84:87]
buffer_load_dwordx4 v14, s[56:59], s64 offen lds
v_mfma_f32_16x16x32_bf16 v[148:151], a[80:83], a[56:59], v[148:151]
ds_read_b64_tr_b16 a[72:73], v19 offset:32768
v_mfma_f32_16x16x32_bf16 v[148:151], a[84:87], a[60:63], v[148:151]
ds_read_b64_tr_b16 a[74:75], v19 offset:33024
v_mfma_f32_16x16x32_bf16 v[132:135], a[84:87], a[52:55], v[132:135]
ds_read_b64_tr_b16 a[76:77], v19 offset:34816
v_mfma_f32_16x16x32_bf16 v[132:135], a[80:83], a[48:51], v[132:135]
ds_read_b64_tr_b16 a[78:79], v19 offset:35072
v_mfma_f32_16x16x32_bf16 v[116:119], a[80:83], a[40:43], v[116:119]
v_mfma_f32_16x16x32_bf16 v[116:119], a[84:87], a[44:47], v[116:119]
v_mfma_f32_16x16x32_bf16 v[100:103], a[84:87], a[36:39], v[100:103]
s_add_u32 m0, s78, 118784
v_mfma_f32_16x16x32_bf16 v[100:103], a[80:83], a[32:35], v[100:103]
s_waitcnt lgkmcnt(4)
s_add_u32 s64, s75, 3147776
ds_read_b64_tr_b16 a[80:81], v20 offset:32768
v_mfma_f32_16x16x32_bf16 v[184:187], a[88:91], a[0:3], v[184:187]
buffer_load_dwordx4 v23, s[60:63], s64 offen lds
v_mfma_f32_16x16x32_bf16 v[184:187], a[92:95], a[4:7], v[184:187]
ds_read_b64_tr_b16 a[82:83], v20 offset:33024
v_mfma_f32_16x16x32_bf16 v[192:195], a[92:95], a[12:15], v[192:195]
ds_read_b64_tr_b16 a[84:85], v20 offset:34816
v_mfma_f32_16x16x32_bf16 v[192:195], a[88:91], a[8:11], v[192:195]
ds_read_b64_tr_b16 a[86:87], v20 offset:35072
v_mfma_f32_16x16x32_bf16 v[200:203], a[88:91], a[16:19], v[200:203]
v_mfma_f32_16x16x32_bf16 v[200:203], a[92:95], a[20:23], v[200:203]
v_mfma_f32_16x16x32_bf16 v[208:211], a[92:95], a[28:31], v[208:211]
v_mfma_f32_16x16x32_bf16 v[208:211], a[88:91], a[24:27], v[208:211]
ds_read_b64_tr_b16 a[88:89], v4 offset:32768
v_mfma_f32_16x16x32_bf16 v[212:215], a[96:99], a[24:27], v[212:215]
s_xor_b32 m0, s77, 100352
ds_read_b64_tr_b16 a[90:91], v4 offset:33792
v_mfma_f32_16x16x32_bf16 v[212:215], a[100:103], a[28:31], v[212:215]
s_xor_b32 s64, s71, 4259840
ds_read_b64_tr_b16 a[92:93], v4 offset:40960
v_mfma_f32_16x16x32_bf16 v[204:207], a[100:103], a[20:23], v[204:207]
buffer_load_dwordx4 v15, s[56:59], s64 offen lds
v_mfma_f32_16x16x32_bf16 v[204:207], a[96:99], a[16:19], v[204:207]
ds_read_b64_tr_b16 a[94:95], v4 offset:41984
v_mfma_f32_16x16x32_bf16 v[196:199], a[96:99], a[8:11], v[196:199]
v_mfma_f32_16x16x32_bf16 v[196:199], a[100:103], a[12:15], v[196:199]
v_mfma_f32_16x16x32_bf16 v[188:191], a[100:103], a[4:7], v[188:191]
v_mfma_f32_16x16x32_bf16 v[188:191], a[96:99], a[0:3], v[188:191]
ds_read_b64_tr_b16 a[96:97], v5 offset:32768
v_mfma_f32_16x16x32_bf16 v[216:219], a[0:3], a[104:107], v[216:219]
s_add_u32 s65, s79, 25600
ds_read_b64_tr_b16 a[98:99], v5 offset:33792
v_mfma_f32_16x16x32_bf16 v[216:219], a[4:7], a[108:111], v[216:219]
s_add_u32 m0, s78, 122880
buffer_store_dwordx4 a[196:199], v16, s[44:47], s65 offen sc1
v_mfma_f32_16x16x32_bf16 v[224:227], a[12:15], a[108:111], v[224:227]
s_add_u32 s64, s75, 3149824
ds_read_b64_tr_b16 a[100:101], v5 offset:40960
v_mfma_f32_16x16x32_bf16 v[224:227], a[8:11], a[104:107], v[224:227]
buffer_load_dwordx4 v23, s[60:63], s64 offen lds
v_mfma_f32_16x16x32_bf16 v[232:235], a[16:19], a[104:107], v[232:235]
ds_read_b64_tr_b16 a[102:103], v5 offset:41984
v_mfma_f32_16x16x32_bf16 v[232:235], a[20:23], a[108:111], v[232:235]
v_mfma_f32_16x16x32_bf16 v[240:243], a[28:31], a[108:111], v[240:243]
v_mfma_f32_16x16x32_bf16 v[240:243], a[24:27], a[104:107], v[240:243]
ds_read_b64_tr_b16 a[104:105], v6 offset:32768
v_mfma_f32_16x16x32_bf16 v[244:247], a[24:27], a[112:115], v[244:247]
ds_read_b64_tr_b16 a[106:107], v6 offset:33792
v_mfma_f32_16x16x32_bf16 v[244:247], a[28:31], a[116:119], v[244:247]
ds_read_b64_tr_b16 a[108:109], v6 offset:40960
v_subrev_u32 v19, 0x8000, v19
v_mfma_f32_16x16x32_bf16 v[236:239], a[20:23], a[116:119], v[236:239]
s_xor_b32 m0, s77, 101376
ds_read_b64_tr_b16 a[110:111], v6 offset:41984
v_mfma_f32_16x16x32_bf16 v[236:239], a[16:19], a[112:115], v[236:239]
s_xor_b32 s64, s71, 4292608
v_mfma_f32_16x16x32_bf16 v[228:231], a[8:11], a[112:115], v[228:231]
buffer_load_dwordx4 v15, s[56:59], s64 offen lds
v_mfma_f32_16x16x32_bf16 v[228:231], a[12:15], a[116:119], v[228:231]
v_mfma_f32_16x16x32_bf16 v[220:223], a[4:7], a[116:119], v[220:223]
v_mfma_f32_16x16x32_bf16 v[220:223], a[0:3], a[112:115], v[220:223]
s_waitcnt lgkmcnt(4)
ds_read_b64_tr_b16 a[112:113], v7 offset:32768
v_mfma_f32_16x16x32_bf16 v[152:155], a[72:75], a[0:3], v[152:155]
ds_read_b64_tr_b16 a[114:115], v7 offset:33792
v_mfma_f32_16x16x32_bf16 v[152:155], a[76:79], a[4:7], v[152:155]
ds_read_b64_tr_b16 a[116:117], v7 offset:40960
v_subrev_u32 v20, 0x8000, v20
v_mfma_f32_16x16x32_bf16 v[160:163], a[76:79], a[12:15], v[160:163]
ds_read_b64_tr_b16 a[118:119], v7 offset:41984
v_mfma_f32_16x16x32_bf16 v[160:163], a[72:75], a[8:11], v[160:163]
v_mfma_f32_16x16x32_bf16 v[168:171], a[72:75], a[16:19], v[168:171]
v_mfma_f32_16x16x32_bf16 v[168:171], a[76:79], a[20:23], v[168:171]
v_mfma_f32_16x16x32_bf16 v[176:179], a[76:79], a[28:31], v[176:179]
s_xor_b32 m0, s84, 0
v_mfma_f32_16x16x32_bf16 v[176:179], a[72:75], a[24:27], v[176:179]
s_xor_b32 s64, s72, 1024
ds_read_b64_tr_b16 a[72:73], v8 offset:32768
v_mfma_f32_16x16x32_bf16 v[180:183], a[80:83], a[24:27], v[180:183]
buffer_load_dwordx4 v12, s[48:51], s64 offen lds
v_mfma_f32_16x16x32_bf16 v[180:183], a[84:87], a[28:31], v[180:183]
ds_read_b64_tr_b16 a[74:75], v8 offset:33792
v_subrev_u32 v4, 0x8000, v4
v_mfma_f32_16x16x32_bf16 v[172:175], a[84:87], a[20:23], v[172:175]
ds_read_b64_tr_b16 a[76:77], v8 offset:40960
v_mfma_f32_16x16x32_bf16 v[172:175], a[80:83], a[16:19], v[172:175]
s_xor_b32 m0, s84, 1024
ds_read_b64_tr_b16 a[78:79], v8 offset:41984
v_mfma_f32_16x16x32_bf16 v[164:167], a[80:83], a[8:11], v[164:167]
s_xor_b32 s64, s72, 17408
v_mfma_f32_16x16x32_bf16 v[164:167], a[84:87], a[12:15], v[164:167]
buffer_load_dwordx4 v13, s[48:51], s64 offen lds
v_mfma_f32_16x16x32_bf16 v[156:159], a[84:87], a[4:7], v[156:159]
v_mfma_f32_16x16x32_bf16 v[156:159], a[80:83], a[0:3], v[156:159]
ds_read_b64_tr_b16 a[80:81], v9 offset:32768
v_mfma_f32_16x16x32_bf16 v[24:27], a[88:91], a[0:3], v[24:27]
s_xor_b32 m0, s84, 2048
ds_read_b64_tr_b16 a[82:83], v9 offset:33792
v_mfma_f32_16x16x32_bf16 v[24:27], a[92:95], a[4:7], v[24:27]
s_xor_b32 s64, s72, 132096
ds_read_b64_tr_b16 a[84:85], v9 offset:40960
v_subrev_u32 v5, 0x8000, v5
v_mfma_f32_16x16x32_bf16 v[40:43], a[92:95], a[12:15], v[40:43]
buffer_load_dwordx4 v12, s[48:51], s64 offen lds
v_mfma_f32_16x16x32_bf16 v[40:43], a[88:91], a[8:11], v[40:43]
ds_read_b64_tr_b16 a[86:87], v9 offset:41984
v_mfma_f32_16x16x32_bf16 v[56:59], a[88:91], a[16:19], v[56:59]
v_mfma_f32_16x16x32_bf16 v[56:59], a[92:95], a[20:23], v[56:59]
s_xor_b32 m0, s84, 3072
v_mfma_f32_16x16x32_bf16 v[72:75], a[92:95], a[28:31], v[72:75]
s_waitcnt vmcnt(12)
s_xor_b32 s64, s72, 148480
ds_read_b128 a[32:35], v2 offset:32768
v_mfma_f32_16x16x32_bf16 v[72:75], a[88:91], a[24:27], v[72:75]
buffer_load_dwordx4 v13, s[48:51], s64 offen lds
v_mfma_f32_16x16x32_bf16 v[136:139], a[96:99], a[24:27], v[136:139]
ds_read_b128 a[36:39], v3 offset:32768
v_mfma_f32_16x16x32_bf16 v[136:139], a[100:103], a[28:31], v[136:139]
ds_read_b128 a[40:43], v2 offset:34816
v_subrev_u32 v6, 0x8000, v6
v_mfma_f32_16x16x32_bf16 v[120:123], a[100:103], a[20:23], v[120:123]
s_xor_b32 m0, s84, 4096
ds_read_b128 a[44:47], v3 offset:34816
v_mfma_f32_16x16x32_bf16 v[120:123], a[96:99], a[16:19], v[120:123]
s_xor_b32 s64, s73, 1024
ds_read_b128 a[48:51], v2 offset:36864
v_mfma_f32_16x16x32_bf16 v[104:107], a[96:99], a[8:11], v[104:107]
buffer_load_dwordx4 v12, s[48:51], s64 offen lds
v_mfma_f32_16x16x32_bf16 v[104:107], a[100:103], a[12:15], v[104:107]
s_add_u32 s65, s79, 9216
ds_read_b128 a[52:55], v3 offset:36864
v_mfma_f32_16x16x32_bf16 v[88:91], a[100:103], a[4:7], v[88:91]
buffer_store_dwordx4 a[200:203], v16, s[44:47], s65 offen sc1
v_mfma_f32_16x16x32_bf16 v[88:91], a[96:99], a[0:3], v[88:91]
s_waitcnt lgkmcnt(6)
s_xor_b32 m0, s84, 5120
ds_read_b128 a[56:59], v2 offset:38912
v_mfma_f32_16x16x32_bf16 v[28:31], a[104:107], a[0:3], v[28:31]
s_xor_b32 s64, s73, 17408
ds_read_b128 a[60:63], v3 offset:38912
v_mfma_f32_16x16x32_bf16 v[28:31], a[108:111], a[4:7], v[28:31]
buffer_load_dwordx4 v13, s[48:51], s64 offen lds
v_mfma_f32_16x16x32_bf16 v[44:47], a[108:111], a[12:15], v[44:47]
ds_read_b64_tr_b16 a[88:89], v10 offset:32768
v_subrev_u32 v7, 0x8000, v7
v_mfma_f32_16x16x32_bf16 v[44:47], a[104:107], a[8:11], v[44:47]
ds_read_b64_tr_b16 a[90:91], v10 offset:33792
v_mfma_f32_16x16x32_bf16 v[60:63], a[104:107], a[16:19], v[60:63]
s_xor_b32 m0, s84, 6144
ds_read_b64_tr_b16 a[92:93], v10 offset:40960
v_mfma_f32_16x16x32_bf16 v[60:63], a[108:111], a[20:23], v[60:63]
s_xor_b32 s64, s73, 132096
ds_read_b64_tr_b16 a[94:95], v10 offset:41984
v_mfma_f32_16x16x32_bf16 v[76:79], a[108:111], a[28:31], v[76:79]
buffer_load_dwordx4 v12, s[48:51], s64 offen lds
v_mfma_f32_16x16x32_bf16 v[76:79], a[104:107], a[24:27], v[76:79]
ds_read_b64_tr_b16 a[96:97], v11 offset:32768
v_mfma_f32_16x16x32_bf16 v[140:143], a[112:115], a[24:27], v[140:143]
ds_read_b64_tr_b16 a[98:99], v11 offset:33792
v_mfma_f32_16x16x32_bf16 v[140:143], a[116:119], a[28:31], v[140:143]
s_xor_b32 m0, s84, 7168
ds_read_b64_tr_b16 a[100:101], v11 offset:40960
v_subrev_u32 v8, 0x8000, v8
v_mfma_f32_16x16x32_bf16 v[124:127], a[116:119], a[20:23], v[124:127]
s_xor_b32 s64, s73, 148480
ds_read_b64_tr_b16 a[102:103], v11 offset:41984
v_mfma_f32_16x16x32_bf16 v[124:127], a[112:115], a[16:19], v[124:127]
buffer_load_dwordx4 v13, s[48:51], s64 offen lds
v_mfma_f32_16x16x32_bf16 v[108:111], a[112:115], a[8:11], v[108:111]
v_mfma_f32_16x16x32_bf16 v[108:111], a[116:119], a[12:15], v[108:111]
v_mfma_f32_16x16x32_bf16 v[92:95], a[116:119], a[4:7], v[92:95]
v_subrev_u32 v9, 0x8000, v9
v_subrev_u32 v10, 0x8000, v10
v_mfma_f32_16x16x32_bf16 v[92:95], a[112:115], a[0:3], v[92:95]
v_subrev_u32 v11, 0x8000, v11
v_mfma_f32_16x16x32_bf16 v[32:35], a[72:75], a[0:3], v[32:35]
v_mfma_f32_16x16x32_bf16 v[32:35], a[76:79], a[4:7], v[32:35]
v_mfma_f32_16x16x32_bf16 v[48:51], a[76:79], a[12:15], v[48:51]
s_waitcnt lgkmcnt(0)
s_barrier
v_mfma_f32_16x16x32_bf16 v[48:51], a[72:75], a[8:11], v[48:51]
s_xor_b32 m0, s77, 131072
ds_read_b64_tr_b16 a[104:105], v19 offset:4096
v_mfma_f32_16x16x32_bf16 v[64:67], a[72:75], a[16:19], v[64:67]
s_xor_b32 s64, s71, 4718592
ds_read_b64_tr_b16 a[106:107], v19 offset:4352
v_mfma_f32_16x16x32_bf16 v[64:67], a[76:79], a[20:23], v[64:67]
buffer_load_dwordx4 v14, s[56:59], s64 offen lds
v_mfma_f32_16x16x32_bf16 v[80:83], a[76:79], a[28:31], v[80:83]
ds_read_b64_tr_b16 a[108:109], v19 offset:6144
v_mfma_f32_16x16x32_bf16 v[80:83], a[72:75], a[24:27], v[80:83]
ds_read_b64_tr_b16 a[110:111], v19 offset:6400
v_mfma_f32_16x16x32_bf16 v[144:147], a[80:83], a[24:27], v[144:147]
ds_read_b64_tr_b16 a[112:113], v20 offset:4096
v_mfma_f32_16x16x32_bf16 v[144:147], a[84:87], a[28:31], v[144:147]
ds_read_b64_tr_b16 a[114:115], v20 offset:4352
v_mfma_f32_16x16x32_bf16 v[128:131], a[84:87], a[20:23], v[128:131]
ds_read_b64_tr_b16 a[116:117], v20 offset:6144
v_mfma_f32_16x16x32_bf16 v[128:131], a[80:83], a[16:19], v[128:131]
ds_read_b64_tr_b16 a[118:119], v20 offset:6400
v_mfma_f32_16x16x32_bf16 v[112:115], a[80:83], a[8:11], v[112:115]
s_add_u32 m0, s78, 147456
ds_read_b64_tr_b16 a[72:73], v19 offset:8192
v_mfma_f32_16x16x32_bf16 v[112:115], a[84:87], a[12:15], v[112:115]
s_add_u32 s64, s75, 3538944
ds_read_b64_tr_b16 a[74:75], v19 offset:8448
v_mfma_f32_16x16x32_bf16 v[96:99], a[84:87], a[4:7], v[96:99]
buffer_load_dwordx4 v23, s[60:63], s64 offen lds
v_mfma_f32_16x16x32_bf16 v[96:99], a[80:83], a[0:3], v[96:99]
ds_read_b64_tr_b16 a[76:77], v19 offset:10240
v_mfma_f32_16x16x32_bf16 v[36:39], a[88:91], a[0:3], v[36:39]
ds_read_b64_tr_b16 a[78:79], v19 offset:10496
v_mfma_f32_16x16x32_bf16 v[36:39], a[92:95], a[4:7], v[36:39]
ds_read_b64_tr_b16 a[80:81], v20 offset:8192
v_mfma_f32_16x16x32_bf16 v[52:55], a[92:95], a[12:15], v[52:55]
ds_read_b64_tr_b16 a[82:83], v20 offset:8448
v_mfma_f32_16x16x32_bf16 v[52:55], a[88:91], a[8:11], v[52:55]
ds_read_b64_tr_b16 a[84:85], v20 offset:10240
v_mfma_f32_16x16x32_bf16 v[68:71], a[88:91], a[16:19], v[68:71]
ds_read_b64_tr_b16 a[86:87], v20 offset:10496
v_mfma_f32_16x16x32_bf16 v[68:71], a[92:95], a[20:23], v[68:71]
s_xor_b32 m0, s77, 132096
v_mfma_f32_16x16x32_bf16 v[84:87], a[92:95], a[28:31], v[84:87]
s_xor_b32 s64, s71, 4751360
v_mfma_f32_16x16x32_bf16 v[84:87], a[88:91], a[24:27], v[84:87]
buffer_load_dwordx4 v14, s[56:59], s64 offen lds
v_mfma_f32_16x16x32_bf16 v[148:151], a[96:99], a[24:27], v[148:151]
ds_read_b64_tr_b16 a[88:89], v19 offset:0
v_mfma_f32_16x16x32_bf16 v[148:151], a[100:103], a[28:31], v[148:151]
ds_read_b64_tr_b16 a[90:91], v19 offset:256
v_mfma_f32_16x16x32_bf16 v[132:135], a[100:103], a[20:23], v[132:135]
s_add_u32 s65, s79, 26624
ds_read_b64_tr_b16 a[92:93], v19 offset:2048
v_mfma_f32_16x16x32_bf16 v[132:135], a[96:99], a[16:19], v[132:135]
buffer_store_dwordx4 a[204:207], v16, s[44:47], s65 offen sc1
v_mfma_f32_16x16x32_bf16 v[116:119], a[96:99], a[8:11], v[116:119]
ds_read_b64_tr_b16 a[94:95], v19 offset:2304
v_mfma_f32_16x16x32_bf16 v[116:119], a[100:103], a[12:15], v[116:119]
v_mfma_f32_16x16x32_bf16 v[100:103], a[100:103], a[4:7], v[100:103]
s_add_u32 m0, s78, 151552
v_mfma_f32_16x16x32_bf16 v[100:103], a[96:99], a[0:3], v[100:103]
s_waitcnt lgkmcnt(4)
s_add_u32 s64, s75, 3540992
ds_read_b64_tr_b16 a[96:97], v20 offset:0
v_mfma_f32_16x16x32_bf16 v[184:187], a[104:107], a[32:35], v[184:187]
buffer_load_dwordx4 v23, s[60:63], s64 offen lds
v_mfma_f32_16x16x32_bf16 v[184:187], a[108:111], a[36:39], v[184:187]
ds_read_b64_tr_b16 a[98:99], v20 offset:256
v_mfma_f32_16x16x32_bf16 v[192:195], a[108:111], a[44:47], v[192:195]
ds_read_b64_tr_b16 a[100:101], v20 offset:2048
v_mfma_f32_16x16x32_bf16 v[192:195], a[104:107], a[40:43], v[192:195]
ds_read_b64_tr_b16 a[102:103], v20 offset:2304
v_mfma_f32_16x16x32_bf16 v[200:203], a[104:107], a[48:51], v[200:203]
s_cmp_eq_u32 s30, 0
s_cselect_b32 s81, 256, 0
v_mfma_f32_16x16x32_bf16 v[200:203], a[108:111], a[52:55], v[200:203]
v_mfma_f32_16x16x32_bf16 v[208:211], a[108:111], a[60:63], v[208:211]
v_mfma_f32_16x16x32_bf16 v[208:211], a[104:107], a[56:59], v[208:211]
ds_read_b64_tr_b16 a[104:105], v4 offset:0
v_mfma_f32_16x16x32_bf16 v[212:215], a[112:115], a[56:59], v[212:215]
s_xor_b32 m0, s77, 133120
ds_read_b64_tr_b16 a[106:107], v4 offset:1024
v_mfma_f32_16x16x32_bf16 v[212:215], a[116:119], a[60:63], v[212:215]
s_xor_b32 s64, s71, 4784128
ds_read_b64_tr_b16 a[108:109], v4 offset:8192
v_mfma_f32_16x16x32_bf16 v[204:207], a[116:119], a[52:55], v[204:207]
buffer_load_dwordx4 v15, s[56:59], s64 offen lds
v_mfma_f32_16x16x32_bf16 v[204:207], a[112:115], a[48:51], v[204:207]
ds_read_b64_tr_b16 a[110:111], v4 offset:9216
v_mfma_f32_16x16x32_bf16 v[196:199], a[112:115], a[40:43], v[196:199]
v_mfma_f32_16x16x32_bf16 v[196:199], a[116:119], a[44:47], v[196:199]
v_mfma_f32_16x16x32_bf16 v[188:191], a[116:119], a[36:39], v[188:191]
v_mfma_f32_16x16x32_bf16 v[188:191], a[112:115], a[32:35], v[188:191]
ds_read_b64_tr_b16 a[112:113], v5 offset:0
v_mfma_f32_16x16x32_bf16 v[216:219], a[32:35], a[72:75], v[216:219]
ds_read_b64_tr_b16 a[114:115], v5 offset:1024
v_mfma_f32_16x16x32_bf16 v[216:219], a[36:39], a[76:79], v[216:219]
s_add_u32 m0, s78, 155648
ds_read_b64_tr_b16 a[116:117], v5 offset:8192
v_mfma_f32_16x16x32_bf16 v[224:227], a[44:47], a[76:79], v[224:227]
s_add_u32 s64, s75, 3543040
ds_read_b64_tr_b16 a[118:119], v5 offset:9216
v_mfma_f32_16x16x32_bf16 v[224:227], a[40:43], a[72:75], v[224:227]
buffer_load_dwordx4 v23, s[60:63], s64 offen lds
v_mfma_f32_16x16x32_bf16 v[232:235], a[48:51], a[72:75], v[232:235]
v_mfma_f32_16x16x32_bf16 v[232:235], a[52:55], a[76:79], v[232:235]
v_mfma_f32_16x16x32_bf16 v[240:243], a[60:63], a[76:79], v[240:243]
v_mfma_f32_16x16x32_bf16 v[240:243], a[56:59], a[72:75], v[240:243]
ds_read_b64_tr_b16 a[72:73], v6 offset:0
v_mfma_f32_16x16x32_bf16 v[244:247], a[56:59], a[80:83], v[244:247]
ds_read_b64_tr_b16 a[74:75], v6 offset:1024
v_mfma_f32_16x16x32_bf16 v[244:247], a[60:63], a[84:87], v[244:247]
ds_read_b64_tr_b16 a[76:77], v6 offset:8192
v_mfma_f32_16x16x32_bf16 v[236:239], a[52:55], a[84:87], v[236:239]
s_xor_b32 m0, s77, 134144
ds_read_b64_tr_b16 a[78:79], v6 offset:9216
v_mfma_f32_16x16x32_bf16 v[236:239], a[48:51], a[80:83], v[236:239]
s_xor_b32 s64, s71, 4816896
v_mfma_f32_16x16x32_bf16 v[228:231], a[40:43], a[80:83], v[228:231]
buffer_load_dwordx4 v15, s[56:59], s64 offen lds
v_mfma_f32_16x16x32_bf16 v[228:231], a[44:47], a[84:87], v[228:231]
v_mfma_f32_16x16x32_bf16 v[220:223], a[36:39], a[84:87], v[220:223]
v_mfma_f32_16x16x32_bf16 v[220:223], a[32:35], a[80:83], v[220:223]
s_waitcnt lgkmcnt(4)
ds_read_b64_tr_b16 a[80:81], v7 offset:0
v_mfma_f32_16x16x32_bf16 v[152:155], a[88:91], a[32:35], v[152:155]
ds_read_b64_tr_b16 a[82:83], v7 offset:1024
v_mfma_f32_16x16x32_bf16 v[152:155], a[92:95], a[36:39], v[152:155]
ds_read_b64_tr_b16 a[84:85], v7 offset:8192
v_mfma_f32_16x16x32_bf16 v[160:163], a[92:95], a[44:47], v[160:163]
ds_read_b64_tr_b16 a[86:87], v7 offset:9216
v_mfma_f32_16x16x32_bf16 v[160:163], a[88:91], a[40:43], v[160:163]
v_mfma_f32_16x16x32_bf16 v[168:171], a[88:91], a[48:51], v[168:171]
v_mfma_f32_16x16x32_bf16 v[168:171], a[92:95], a[52:55], v[168:171]
v_mfma_f32_16x16x32_bf16 v[176:179], a[92:95], a[60:63], v[176:179]
s_xor_b32 m0, s84, 32768
v_mfma_f32_16x16x32_bf16 v[176:179], a[88:91], a[56:59], v[176:179]
s_xor_b32 s64, s72, 1152
ds_read_b64_tr_b16 a[88:89], v8 offset:0
v_mfma_f32_16x16x32_bf16 v[180:183], a[96:99], a[56:59], v[180:183]
s_add_u32 s65, s79, 27648
buffer_load_dwordx4 v12, s[48:51], s64 offen lds
v_mfma_f32_16x16x32_bf16 v[180:183], a[100:103], a[60:63], v[180:183]
buffer_store_dwordx4 a[208:211], v16, s[44:47], s65 offen sc1
v_mfma_f32_16x16x32_bf16 v[172:175], a[100:103], a[52:55], v[172:175]
ds_read_b64_tr_b16 a[90:91], v8 offset:1024
v_mfma_f32_16x16x32_bf16 v[172:175], a[96:99], a[48:51], v[172:175]
s_xor_b32 m0, s84, 33792
ds_read_b64_tr_b16 a[92:93], v8 offset:8192
v_mfma_f32_16x16x32_bf16 v[164:167], a[96:99], a[40:43], v[164:167]
s_xor_b32 s64, s72, 17536
ds_read_b64_tr_b16 a[94:95], v8 offset:9216
v_mfma_f32_16x16x32_bf16 v[164:167], a[100:103], a[44:47], v[164:167]
buffer_load_dwordx4 v13, s[48:51], s64 offen lds
v_mfma_f32_16x16x32_bf16 v[156:159], a[100:103], a[36:39], v[156:159]
v_mfma_f32_16x16x32_bf16 v[156:159], a[96:99], a[32:35], v[156:159]
ds_read_b64_tr_b16 a[96:97], v9 offset:0
v_mfma_f32_16x16x32_bf16 v[24:27], a[104:107], a[32:35], v[24:27]
s_xor_b32 m0, s84, 34816
ds_read_b64_tr_b16 a[98:99], v9 offset:1024
v_mfma_f32_16x16x32_bf16 v[24:27], a[108:111], a[36:39], v[24:27]
s_xor_b32 s64, s72, 132224
ds_read_b64_tr_b16 a[100:101], v9 offset:8192
v_mfma_f32_16x16x32_bf16 v[40:43], a[108:111], a[44:47], v[40:43]
buffer_load_dwordx4 v12, s[48:51], s64 offen lds
v_mfma_f32_16x16x32_bf16 v[40:43], a[104:107], a[40:43], v[40:43]
ds_read_b64_tr_b16 a[102:103], v9 offset:9216
v_mfma_f32_16x16x32_bf16 v[56:59], a[104:107], a[48:51], v[56:59]
v_mfma_f32_16x16x32_bf16 v[56:59], a[108:111], a[52:55], v[56:59]
s_xor_b32 m0, s84, 35840
v_mfma_f32_16x16x32_bf16 v[72:75], a[108:111], a[60:63], v[72:75]
s_waitcnt vmcnt(12)
s_xor_b32 s64, s72, 148608
ds_read_b128 a[0:3], v2 offset:0
v_mfma_f32_16x16x32_bf16 v[72:75], a[104:107], a[56:59], v[72:75]
buffer_load_dwordx4 v13, s[48:51], s64 offen lds
v_mfma_f32_16x16x32_bf16 v[136:139], a[112:115], a[56:59], v[136:139]
ds_read_b128 a[4:7], v3 offset:0
v_mfma_f32_16x16x32_bf16 v[136:139], a[116:119], a[60:63], v[136:139]
ds_read_b128 a[8:11], v2 offset:2048
v_mfma_f32_16x16x32_bf16 v[120:123], a[116:119], a[52:55], v[120:123]
s_xor_b32 m0, s84, 36864
ds_read_b128 a[12:15], v3 offset:2048
v_mfma_f32_16x16x32_bf16 v[120:123], a[112:115], a[48:51], v[120:123]
s_xor_b32 s64, s73, 1152
ds_read_b128 a[16:19], v2 offset:4096
v_mfma_f32_16x16x32_bf16 v[104:107], a[112:115], a[40:43], v[104:107]
buffer_load_dwordx4 v12, s[48:51], s64 offen lds
v_mfma_f32_16x16x32_bf16 v[104:107], a[116:119], a[44:47], v[104:107]
ds_read_b128 a[20:23], v3 offset:4096
v_mfma_f32_16x16x32_bf16 v[88:91], a[116:119], a[36:39], v[88:91]
ds_read_b128 a[24:27], v2 offset:6144
v_mfma_f32_16x16x32_bf16 v[88:91], a[112:115], a[32:35], v[88:91]
s_waitcnt lgkmcnt(7)
s_xor_b32 m0, s84, 37888
ds_read_b128 a[28:31], v3 offset:6144
v_mfma_f32_16x16x32_bf16 v[28:31], a[72:75], a[32:35], v[28:31]
s_xor_b32 s64, s73, 17536
ds_read_b64_tr_b16 a[104:105], v10 offset:0
v_mfma_f32_16x16x32_bf16 v[28:31], a[76:79], a[36:39], v[28:31]
buffer_load_dwordx4 v13, s[48:51], s64 offen lds
v_mfma_f32_16x16x32_bf16 v[44:47], a[76:79], a[44:47], v[44:47]
ds_read_b64_tr_b16 a[106:107], v10 offset:1024
v_mfma_f32_16x16x32_bf16 v[44:47], a[72:75], a[40:43], v[44:47]
ds_read_b64_tr_b16 a[108:109], v10 offset:8192
v_mfma_f32_16x16x32_bf16 v[60:63], a[72:75], a[48:51], v[60:63]
s_xor_b32 m0, s84, 38912
ds_read_b64_tr_b16 a[110:111], v10 offset:9216
v_mfma_f32_16x16x32_bf16 v[60:63], a[76:79], a[52:55], v[60:63]
s_xor_b32 s64, s73, 132224
ds_read_b64_tr_b16 a[112:113], v11 offset:0
v_mfma_f32_16x16x32_bf16 v[76:79], a[76:79], a[60:63], v[76:79]
buffer_load_dwordx4 v12, s[48:51], s64 offen lds
v_mfma_f32_16x16x32_bf16 v[76:79], a[72:75], a[56:59], v[76:79]
ds_read_b64_tr_b16 a[114:115], v11 offset:1024
v_mfma_f32_16x16x32_bf16 v[140:143], a[80:83], a[56:59], v[140:143]
ds_read_b64_tr_b16 a[116:117], v11 offset:8192
v_mfma_f32_16x16x32_bf16 v[140:143], a[84:87], a[60:63], v[140:143]
s_xor_b32 m0, s84, 39936
ds_read_b64_tr_b16 a[118:119], v11 offset:9216
v_mfma_f32_16x16x32_bf16 v[124:127], a[84:87], a[52:55], v[124:127]
s_xor_b32 s64, s73, 148608
v_mfma_f32_16x16x32_bf16 v[124:127], a[80:83], a[48:51], v[124:127]
buffer_load_dwordx4 v13, s[48:51], s64 offen lds
v_mfma_f32_16x16x32_bf16 v[108:111], a[80:83], a[40:43], v[108:111]
v_mfma_f32_16x16x32_bf16 v[108:111], a[84:87], a[44:47], v[108:111]
v_mfma_f32_16x16x32_bf16 v[92:95], a[84:87], a[36:39], v[92:95]
v_mfma_f32_16x16x32_bf16 v[92:95], a[80:83], a[32:35], v[92:95]
v_mfma_f32_16x16x32_bf16 v[32:35], a[88:91], a[32:35], v[32:35]
v_mfma_f32_16x16x32_bf16 v[32:35], a[92:95], a[36:39], v[32:35]
v_mfma_f32_16x16x32_bf16 v[48:51], a[92:95], a[44:47], v[48:51]
s_waitcnt lgkmcnt(0)
s_barrier
v_mfma_f32_16x16x32_bf16 v[48:51], a[88:91], a[40:43], v[48:51]
s_xor_b32 m0, s77, 65536
s_add_u32 s65, s79, 11264
ds_read_b64_tr_b16 a[72:73], v19 offset:36864
v_mfma_f32_16x16x32_bf16 v[64:67], a[88:91], a[48:51], v[64:67]
s_xor_b32 s64, s71, 5242880
buffer_store_dwordx4 a[212:215], v16, s[44:47], s65 offen sc1
v_mfma_f32_16x16x32_bf16 v[64:67], a[92:95], a[52:55], v[64:67]
buffer_load_dwordx4 v14, s[56:59], s64 offen lds
v_mfma_f32_16x16x32_bf16 v[80:83], a[92:95], a[60:63], v[80:83]
ds_read_b64_tr_b16 a[74:75], v19 offset:37120
v_mfma_f32_16x16x32_bf16 v[80:83], a[88:91], a[56:59], v[80:83]
buffer_load_dword v1, off, s[52:55], s78 sc1
v_mfma_f32_16x16x32_bf16 v[144:147], a[96:99], a[56:59], v[144:147]
ds_read_b64_tr_b16 a[76:77], v19 offset:38912
v_mfma_f32_16x16x32_bf16 v[144:147], a[100:103], a[60:63], v[144:147]
ds_read_b64_tr_b16 a[78:79], v19 offset:39168
v_mfma_f32_16x16x32_bf16 v[128:131], a[100:103], a[52:55], v[128:131]
ds_read_b64_tr_b16 a[80:81], v20 offset:36864
v_mfma_f32_16x16x32_bf16 v[128:131], a[96:99], a[48:51], v[128:131]
ds_read_b64_tr_b16 a[82:83], v20 offset:37120
v_mfma_f32_16x16x32_bf16 v[112:115], a[96:99], a[40:43], v[112:115]
s_add_u32 m0, s78, 81920
ds_read_b64_tr_b16 a[84:85], v20 offset:38912
v_mfma_f32_16x16x32_bf16 v[112:115], a[100:103], a[44:47], v[112:115]
s_add_u32 s64, s75, 3932160
ds_read_b64_tr_b16 a[86:87], v20 offset:39168
v_mfma_f32_16x16x32_bf16 v[96:99], a[100:103], a[36:39], v[96:99]
buffer_load_dwordx4 v23, s[60:63], s64 offen lds
v_mfma_f32_16x16x32_bf16 v[96:99], a[96:99], a[32:35], v[96:99]
ds_read_b64_tr_b16 a[88:89], v19 offset:40960
v_mfma_f32_16x16x32_bf16 v[36:39], a[104:107], a[32:35], v[36:39]
ds_read_b64_tr_b16 a[90:91], v19 offset:41216
v_mfma_f32_16x16x32_bf16 v[36:39], a[108:111], a[36:39], v[36:39]
ds_read_b64_tr_b16 a[92:93], v19 offset:43008
v_mfma_f32_16x16x32_bf16 v[52:55], a[108:111], a[44:47], v[52:55]
ds_read_b64_tr_b16 a[94:95], v19 offset:43264
v_mfma_f32_16x16x32_bf16 v[52:55], a[104:107], a[40:43], v[52:55]
ds_read_b64_tr_b16 a[96:97], v20 offset:40960
v_mfma_f32_16x16x32_bf16 v[68:71], a[104:107], a[48:51], v[68:71]
ds_read_b64_tr_b16 a[98:99], v20 offset:41216
v_mfma_f32_16x16x32_bf16 v[68:71], a[108:111], a[52:55], v[68:71]
s_xor_b32 m0, s77, 66560
ds_read_b64_tr_b16 a[100:101], v20 offset:43008
v_mfma_f32_16x16x32_bf16 v[84:87], a[108:111], a[60:63], v[84:87]
s_xor_b32 s64, s71, 5275648
ds_read_b64_tr_b16 a[102:103], v20 offset:43264
v_mfma_f32_16x16x32_bf16 v[84:87], a[104:107], a[56:59], v[84:87]
buffer_load_dwordx4 v14, s[56:59], s64 offen lds
v_mfma_f32_16x16x32_bf16 v[148:151], a[112:115], a[56:59], v[148:151]
ds_read_b64_tr_b16 a[104:105], v19 offset:32768
v_mfma_f32_16x16x32_bf16 v[148:151], a[116:119], a[60:63], v[148:151]
ds_read_b64_tr_b16 a[106:107], v19 offset:33024
v_mfma_f32_16x16x32_bf16 v[132:135], a[116:119], a[52:55], v[132:135]
ds_read_b64_tr_b16 a[108:109], v19 offset:34816
v_mfma_f32_16x16x32_bf16 v[132:135], a[112:115], a[48:51], v[132:135]
ds_read_b64_tr_b16 a[110:111], v19 offset:35072
v_mfma_f32_16x16x32_bf16 v[116:119], a[112:115], a[40:43], v[116:119]
v_mfma_f32_16x16x32_bf16 v[116:119], a[116:119], a[44:47], v[116:119]
v_mfma_f32_16x16x32_bf16 v[100:103], a[116:119], a[36:39], v[100:103]
s_add_u32 m0, s78, 86016
v_mfma_f32_16x16x32_bf16 v[100:103], a[112:115], a[32:35], v[100:103]
s_waitcnt lgkmcnt(5)
s_add_u32 s64, s75, 3934208
ds_read_b64_tr_b16 a[112:113], v20 offset:32768
v_mfma_f32_16x16x32_bf16 v[184:187], a[72:75], a[0:3], v[184:187]
buffer_load_dwordx4 v23, s[60:63], s64 offen lds
v_mfma_f32_16x16x32_bf16 v[184:187], a[76:79], a[4:7], v[184:187]
ds_read_b64_tr_b16 a[114:115], v20 offset:33024
v_mfma_f32_16x16x32_bf16 v[192:195], a[76:79], a[12:15], v[192:195]
ds_read_b64_tr_b16 a[116:117], v20 offset:34816
v_mfma_f32_16x16x32_bf16 v[192:195], a[72:75], a[8:11], v[192:195]
ds_read_b64_tr_b16 a[118:119], v20 offset:35072
v_mfma_f32_16x16x32_bf16 v[200:203], a[72:75], a[16:19], v[200:203]
v_mfma_f32_16x16x32_bf16 v[200:203], a[76:79], a[20:23], v[200:203]
v_mfma_f32_16x16x32_bf16 v[208:211], a[76:79], a[28:31], v[208:211]
s_branch L_po10
L_pg10:
s_branch L_tr1
L_po10:
v_mfma_f32_16x16x32_bf16 v[208:211], a[72:75], a[24:27], v[208:211]
ds_read_b64_tr_b16 a[72:73], v4 offset:32768
v_mfma_f32_16x16x32_bf16 v[212:215], a[80:83], a[24:27], v[212:215]
s_xor_b32 m0, s77, 67584
ds_read_b64_tr_b16 a[74:75], v4 offset:33792
v_mfma_f32_16x16x32_bf16 v[212:215], a[84:87], a[28:31], v[212:215]
s_xor_b32 s64, s71, 5308416
ds_read_b64_tr_b16 a[76:77], v4 offset:40960
v_mfma_f32_16x16x32_bf16 v[204:207], a[84:87], a[20:23], v[204:207]
buffer_load_dwordx4 v15, s[56:59], s64 offen lds
v_mfma_f32_16x16x32_bf16 v[204:207], a[80:83], a[16:19], v[204:207]
ds_read_b64_tr_b16 a[78:79], v4 offset:41984
v_mfma_f32_16x16x32_bf16 v[196:199], a[80:83], a[8:11], v[196:199]
v_mfma_f32_16x16x32_bf16 v[196:199], a[84:87], a[12:15], v[196:199]
v_mfma_f32_16x16x32_bf16 v[188:191], a[84:87], a[4:7], v[188:191]
v_mfma_f32_16x16x32_bf16 v[188:191], a[80:83], a[0:3], v[188:191]
ds_read_b64_tr_b16 a[80:81], v5 offset:32768
v_mfma_f32_16x16x32_bf16 v[216:219], a[0:3], a[88:91], v[216:219]
s_add_u32 s65, s79, 28672
ds_read_b64_tr_b16 a[82:83], v5 offset:33792
v_mfma_f32_16x16x32_bf16 v[216:219], a[4:7], a[92:95], v[216:219]
s_add_u32 m0, s78, 90112
buffer_store_dwordx4 a[216:219], v16, s[44:47], s65 offen sc1
v_mfma_f32_16x16x32_bf16 v[224:227], a[12:15], a[92:95], v[224:227]
s_add_u32 s64, s75, 3936256
ds_read_b64_tr_b16 a[84:85], v5 offset:40960
v_mfma_f32_16x16x32_bf16 v[224:227], a[8:11], a[88:91], v[224:227]
buffer_load_dwordx4 v23, s[60:63], s64 offen lds
v_mfma_f32_16x16x32_bf16 v[232:235], a[16:19], a[88:91], v[232:235]
ds_read_b64_tr_b16 a[86:87], v5 offset:41984
v_mfma_f32_16x16x32_bf16 v[232:235], a[20:23], a[92:95], v[232:235]
v_mfma_f32_16x16x32_bf16 v[240:243], a[28:31], a[92:95], v[240:243]
v_mfma_f32_16x16x32_bf16 v[240:243], a[24:27], a[88:91], v[240:243]
ds_read_b64_tr_b16 a[88:89], v6 offset:32768
v_mfma_f32_16x16x32_bf16 v[244:247], a[24:27], a[96:99], v[244:247]
s_waitcnt lgkmcnt(5)
ds_read_b64_tr_b16 a[90:91], v6 offset:33792
v_mfma_f32_16x16x32_bf16 v[244:247], a[28:31], a[100:103], v[244:247]
ds_read_b64_tr_b16 a[92:93], v6 offset:40960
v_add_u32 v19, 0x8000, v19
v_mfma_f32_16x16x32_bf16 v[236:239], a[20:23], a[100:103], v[236:239]
s_xor_b32 m0, s77, 68608
ds_read_b64_tr_b16 a[94:95], v6 offset:41984
v_mfma_f32_16x16x32_bf16 v[236:239], a[16:19], a[96:99], v[236:239]
s_xor_b32 s64, s71, 5341184
v_mfma_f32_16x16x32_bf16 v[228:231], a[8:11], a[96:99], v[228:231]
buffer_load_dwordx4 v15, s[56:59], s64 offen lds
v_mfma_f32_16x16x32_bf16 v[228:231], a[12:15], a[100:103], v[228:231]
v_mfma_f32_16x16x32_bf16 v[220:223], a[4:7], a[100:103], v[220:223]
v_mfma_f32_16x16x32_bf16 v[220:223], a[0:3], a[96:99], v[220:223]
ds_read_b64_tr_b16 a[96:97], v7 offset:32768
v_mfma_f32_16x16x32_bf16 v[152:155], a[104:107], a[0:3], v[152:155]
ds_read_b64_tr_b16 a[98:99], v7 offset:33792
v_mfma_f32_16x16x32_bf16 v[152:155], a[108:111], a[4:7], v[152:155]
ds_read_b64_tr_b16 a[100:101], v7 offset:40960
v_add_u32 v20, 0x8000, v20
v_mfma_f32_16x16x32_bf16 v[160:163], a[108:111], a[12:15], v[160:163]
ds_read_b64_tr_b16 a[102:103], v7 offset:41984
v_mfma_f32_16x16x32_bf16 v[160:163], a[104:107], a[8:11], v[160:163]
v_mfma_f32_16x16x32_bf16 v[168:171], a[104:107], a[16:19], v[168:171]
v_mfma_f32_16x16x32_bf16 v[168:171], a[108:111], a[20:23], v[168:171]
v_mfma_f32_16x16x32_bf16 v[176:179], a[108:111], a[28:31], v[176:179]
s_xor_b32 m0, s84, 0
v_mfma_f32_16x16x32_bf16 v[176:179], a[104:107], a[24:27], v[176:179]
s_xor_b32 s64, s72, 1280
ds_read_b64_tr_b16 a[104:105], v8 offset:32768
v_mfma_f32_16x16x32_bf16 v[180:183], a[112:115], a[24:27], v[180:183]
buffer_load_dwordx4 v12, s[48:51], s64 offen lds
v_mfma_f32_16x16x32_bf16 v[180:183], a[116:119], a[28:31], v[180:183]
ds_read_b64_tr_b16 a[106:107], v8 offset:33792
v_add_u32 v4, 0x8000, v4
v_mfma_f32_16x16x32_bf16 v[172:175], a[116:119], a[20:23], v[172:175]
ds_read_b64_tr_b16 a[108:109], v8 offset:40960
v_mfma_f32_16x16x32_bf16 v[172:175], a[112:115], a[16:19], v[172:175]
s_xor_b32 m0, s84, 1024
ds_read_b64_tr_b16 a[110:111], v8 offset:41984
v_mfma_f32_16x16x32_bf16 v[164:167], a[112:115], a[8:11], v[164:167]
s_xor_b32 s64, s72, 17664
v_mfma_f32_16x16x32_bf16 v[164:167], a[116:119], a[12:15], v[164:167]
buffer_load_dwordx4 v13, s[48:51], s64 offen lds
v_mfma_f32_16x16x32_bf16 v[156:159], a[116:119], a[4:7], v[156:159]
v_mfma_f32_16x16x32_bf16 v[156:159], a[112:115], a[0:3], v[156:159]
ds_read_b64_tr_b16 a[112:113], v9 offset:32768
v_mfma_f32_16x16x32_bf16 v[24:27], a[72:75], a[0:3], v[24:27]
s_xor_b32 m0, s84, 2048
ds_read_b64_tr_b16 a[114:115], v9 offset:33792
v_mfma_f32_16x16x32_bf16 v[24:27], a[76:79], a[4:7], v[24:27]
s_xor_b32 s64, s72, 132352
ds_read_b64_tr_b16 a[116:117], v9 offset:40960
v_add_u32 v5, 0x8000, v5
v_mfma_f32_16x16x32_bf16 v[40:43], a[76:79], a[12:15], v[40:43]
buffer_load_dwordx4 v12, s[48:51], s64 offen lds
v_mfma_f32_16x16x32_bf16 v[40:43], a[72:75], a[8:11], v[40:43]
ds_read_b64_tr_b16 a[118:119], v9 offset:41984
v_mfma_f32_16x16x32_bf16 v[56:59], a[72:75], a[16:19], v[56:59]
v_mfma_f32_16x16x32_bf16 v[56:59], a[76:79], a[20:23], v[56:59]
s_xor_b32 m0, s84, 3072
v_mfma_f32_16x16x32_bf16 v[72:75], a[76:79], a[28:31], v[72:75]
s_waitcnt vmcnt(13)
s_xor_b32 s64, s72, 148736
ds_read_b128 a[32:35], v2 offset:32768
v_mfma_f32_16x16x32_bf16 v[72:75], a[72:75], a[24:27], v[72:75]
s_waitcnt lgkmcnt(5)
buffer_load_dwordx4 v13, s[48:51], s64 offen lds
v_mfma_f32_16x16x32_bf16 v[136:139], a[80:83], a[24:27], v[136:139]
ds_read_b128 a[36:39], v3 offset:32768
v_mfma_f32_16x16x32_bf16 v[136:139], a[84:87], a[28:31], v[136:139]
ds_read_b128 a[40:43], v2 offset:34816
v_add_u32 v6, 0x8000, v6
v_mfma_f32_16x16x32_bf16 v[120:123], a[84:87], a[20:23], v[120:123]
s_xor_b32 m0, s84, 4096
ds_read_b128 a[44:47], v3 offset:34816
v_mfma_f32_16x16x32_bf16 v[120:123], a[80:83], a[16:19], v[120:123]
s_xor_b32 s64, s73, 1280
ds_read_b128 a[48:51], v2 offset:36864
v_mfma_f32_16x16x32_bf16 v[104:107], a[80:83], a[8:11], v[104:107]
buffer_load_dwordx4 v12, s[48:51], s64 offen lds
v_mfma_f32_16x16x32_bf16 v[104:107], a[84:87], a[12:15], v[104:107]
s_add_u32 s65, s79, 29696
ds_read_b128 a[52:55], v3 offset:36864
v_mfma_f32_16x16x32_bf16 v[88:91], a[84:87], a[4:7], v[88:91]
buffer_store_dwordx4 a[220:223], v16, s[44:47], s65 offen sc1
v_mfma_f32_16x16x32_bf16 v[88:91], a[80:83], a[0:3], v[88:91]
s_xor_b32 m0, s84, 5120
ds_read_b128 a[56:59], v2 offset:38912
v_mfma_f32_16x16x32_bf16 v[28:31], a[88:91], a[0:3], v[28:31]
s_xor_b32 s64, s73, 17664
ds_read_b128 a[60:63], v3 offset:38912
v_mfma_f32_16x16x32_bf16 v[28:31], a[92:95], a[4:7], v[28:31]
buffer_load_dwordx4 v13, s[48:51], s64 offen lds
v_mfma_f32_16x16x32_bf16 v[44:47], a[92:95], a[12:15], v[44:47]
ds_read_b64_tr_b16 a[72:73], v10 offset:32768
v_add_u32 v7, 0x8000, v7
v_mfma_f32_16x16x32_bf16 v[44:47], a[88:91], a[8:11], v[44:47]
ds_read_b64_tr_b16 a[74:75], v10 offset:33792
v_mfma_f32_16x16x32_bf16 v[60:63], a[88:91], a[16:19], v[60:63]
s_xor_b32 m0, s84, 6144
ds_read_b64_tr_b16 a[76:77], v10 offset:40960
v_mfma_f32_16x16x32_bf16 v[60:63], a[92:95], a[20:23], v[60:63]
s_xor_b32 s64, s73, 132352
ds_read_b64_tr_b16 a[78:79], v10 offset:41984
v_mfma_f32_16x16x32_bf16 v[76:79], a[92:95], a[28:31], v[76:79]
buffer_load_dwordx4 v12, s[48:51], s64 offen lds
v_mfma_f32_16x16x32_bf16 v[76:79], a[88:91], a[24:27], v[76:79]
ds_read_b64_tr_b16 a[80:81], v11 offset:32768
v_mfma_f32_16x16x32_bf16 v[140:143], a[96:99], a[24:27], v[140:143]
ds_read_b64_tr_b16 a[82:83], v11 offset:33792
v_mfma_f32_16x16x32_bf16 v[140:143], a[100:103], a[28:31], v[140:143]
s_xor_b32 m0, s84, 7168
ds_read_b64_tr_b16 a[84:85], v11 offset:40960
v_add_u32 v8, 0x8000, v8
v_mfma_f32_16x16x32_bf16 v[124:127], a[100:103], a[20:23], v[124:127]
s_xor_b32 s64, s73, 148736
ds_read_b64_tr_b16 a[86:87], v11 offset:41984
v_mfma_f32_16x16x32_bf16 v[124:127], a[96:99], a[16:19], v[124:127]
buffer_load_dwordx4 v13, s[48:51], s64 offen lds
v_mfma_f32_16x16x32_bf16 v[108:111], a[96:99], a[8:11], v[108:111]
v_mfma_f32_16x16x32_bf16 v[108:111], a[100:103], a[12:15], v[108:111]
v_mfma_f32_16x16x32_bf16 v[92:95], a[100:103], a[4:7], v[92:95]
v_add_u32 v9, 0x8000, v9
v_add_u32 v10, 0x8000, v10
v_mfma_f32_16x16x32_bf16 v[92:95], a[96:99], a[0:3], v[92:95]
v_add_u32 v11, 0x8000, v11
v_mfma_f32_16x16x32_bf16 v[32:35], a[104:107], a[0:3], v[32:35]
v_mfma_f32_16x16x32_bf16 v[32:35], a[108:111], a[4:7], v[32:35]
v_mfma_f32_16x16x32_bf16 v[48:51], a[108:111], a[12:15], v[48:51]
s_waitcnt lgkmcnt(0)
s_barrier
v_mfma_f32_16x16x32_bf16 v[48:51], a[104:107], a[8:11], v[48:51]
s_xor_b32 m0, s77, 98304
ds_read_b64_tr_b16 a[88:89], v19 offset:36864
v_mfma_f32_16x16x32_bf16 v[64:67], a[104:107], a[16:19], v[64:67]
s_xor_b32 s64, s71, 5767168
ds_read_b64_tr_b16 a[90:91], v19 offset:37120
v_mfma_f32_16x16x32_bf16 v[64:67], a[108:111], a[20:23], v[64:67]
buffer_load_dwordx4 v14, s[56:59], s64 offen lds
v_mfma_f32_16x16x32_bf16 v[80:83], a[108:111], a[28:31], v[80:83]
ds_read_b64_tr_b16 a[92:93], v19 offset:38912
v_mfma_f32_16x16x32_bf16 v[80:83], a[104:107], a[24:27], v[80:83]
ds_read_b64_tr_b16 a[94:95], v19 offset:39168
v_mfma_f32_16x16x32_bf16 v[144:147], a[112:115], a[24:27], v[144:147]
ds_read_b64_tr_b16 a[96:97], v20 offset:36864
v_mfma_f32_16x16x32_bf16 v[144:147], a[116:119], a[28:31], v[144:147]
ds_read_b64_tr_b16 a[98:99], v20 offset:37120
v_mfma_f32_16x16x32_bf16 v[128:131], a[116:119], a[20:23], v[128:131]
ds_read_b64_tr_b16 a[100:101], v20 offset:38912
v_mfma_f32_16x16x32_bf16 v[128:131], a[112:115], a[16:19], v[128:131]
ds_read_b64_tr_b16 a[102:103], v20 offset:39168
v_mfma_f32_16x16x32_bf16 v[112:115], a[112:115], a[8:11], v[112:115]
s_add_u32 m0, s78, 114688
ds_read_b64_tr_b16 a[104:105], v19 offset:40960
v_mfma_f32_16x16x32_bf16 v[112:115], a[116:119], a[12:15], v[112:115]
s_add_u32 s64, s75, 4325376
ds_read_b64_tr_b16 a[106:107], v19 offset:41216
v_mfma_f32_16x16x32_bf16 v[96:99], a[116:119], a[4:7], v[96:99]
buffer_load_dwordx4 v23, s[60:63], s64 offen lds
v_mfma_f32_16x16x32_bf16 v[96:99], a[112:115], a[0:3], v[96:99]
ds_read_b64_tr_b16 a[108:109], v19 offset:43008
v_mfma_f32_16x16x32_bf16 v[36:39], a[72:75], a[0:3], v[36:39]
ds_read_b64_tr_b16 a[110:111], v19 offset:43264
v_mfma_f32_16x16x32_bf16 v[36:39], a[76:79], a[4:7], v[36:39]
ds_read_b64_tr_b16 a[112:113], v20 offset:40960
v_mfma_f32_16x16x32_bf16 v[52:55], a[76:79], a[12:15], v[52:55]
ds_read_b64_tr_b16 a[114:115], v20 offset:41216
v_mfma_f32_16x16x32_bf16 v[52:55], a[72:75], a[8:11], v[52:55]
ds_read_b64_tr_b16 a[116:117], v20 offset:43008
v_mfma_f32_16x16x32_bf16 v[68:71], a[72:75], a[16:19], v[68:71]
ds_read_b64_tr_b16 a[118:119], v20 offset:43264
v_mfma_f32_16x16x32_bf16 v[68:71], a[76:79], a[20:23], v[68:71]
s_xor_b32 m0, s77, 99328
v_mfma_f32_16x16x32_bf16 v[84:87], a[76:79], a[28:31], v[84:87]
s_xor_b32 s64, s71, 5799936
v_mfma_f32_16x16x32_bf16 v[84:87], a[72:75], a[24:27], v[84:87]
buffer_load_dwordx4 v14, s[56:59], s64 offen lds
v_mfma_f32_16x16x32_bf16 v[148:151], a[80:83], a[24:27], v[148:151]
ds_read_b64_tr_b16 a[72:73], v19 offset:32768
v_mfma_f32_16x16x32_bf16 v[148:151], a[84:87], a[28:31], v[148:151]
ds_read_b64_tr_b16 a[74:75], v19 offset:33024
v_mfma_f32_16x16x32_bf16 v[132:135], a[84:87], a[20:23], v[132:135]
s_add_u32 s65, s79, 13312
ds_read_b64_tr_b16 a[76:77], v19 offset:34816
v_mfma_f32_16x16x32_bf16 v[132:135], a[80:83], a[16:19], v[132:135]
buffer_store_dwordx4 a[224:227], v16, s[44:47], s65 offen sc1
v_mfma_f32_16x16x32_bf16 v[116:119], a[80:83], a[8:11], v[116:119]
ds_read_b64_tr_b16 a[78:79], v19 offset:35072
v_mfma_f32_16x16x32_bf16 v[116:119], a[84:87], a[12:15], v[116:119]
v_mfma_f32_16x16x32_bf16 v[100:103], a[84:87], a[4:7], v[100:103]
s_add_u32 m0, s78, 118784
v_mfma_f32_16x16x32_bf16 v[100:103], a[80:83], a[0:3], v[100:103]
s_waitcnt lgkmcnt(4)
s_add_u32 s64, s75, 4327424
ds_read_b64_tr_b16 a[80:81], v20 offset:32768
v_mfma_f32_16x16x32_bf16 v[184:187], a[88:91], a[32:35], v[184:187]
buffer_load_dwordx4 v23, s[60:63], s64 offen lds
v_mfma_f32_16x16x32_bf16 v[184:187], a[92:95], a[36:39], v[184:187]
ds_read_b64_tr_b16 a[82:83], v20 offset:33024
v_mfma_f32_16x16x32_bf16 v[192:195], a[92:95], a[44:47], v[192:195]
ds_read_b64_tr_b16 a[84:85], v20 offset:34816
v_mfma_f32_16x16x32_bf16 v[192:195], a[88:91], a[40:43], v[192:195]
ds_read_b64_tr_b16 a[86:87], v20 offset:35072
v_mfma_f32_16x16x32_bf16 v[200:203], a[88:91], a[48:51], v[200:203]
v_mfma_f32_16x16x32_bf16 v[200:203], a[92:95], a[52:55], v[200:203]
v_mfma_f32_16x16x32_bf16 v[208:211], a[92:95], a[60:63], v[208:211]
v_mfma_f32_16x16x32_bf16 v[208:211], a[88:91], a[56:59], v[208:211]
ds_read_b64_tr_b16 a[88:89], v4 offset:32768
v_mfma_f32_16x16x32_bf16 v[212:215], a[96:99], a[56:59], v[212:215]
s_xor_b32 m0, s77, 100352
ds_read_b64_tr_b16 a[90:91], v4 offset:33792
v_mfma_f32_16x16x32_bf16 v[212:215], a[100:103], a[60:63], v[212:215]
s_xor_b32 s64, s71, 5832704
ds_read_b64_tr_b16 a[92:93], v4 offset:40960
v_mfma_f32_16x16x32_bf16 v[204:207], a[100:103], a[52:55], v[204:207]
buffer_load_dwordx4 v15, s[56:59], s64 offen lds
v_mfma_f32_16x16x32_bf16 v[204:207], a[96:99], a[48:51], v[204:207]
ds_read_b64_tr_b16 a[94:95], v4 offset:41984
v_mfma_f32_16x16x32_bf16 v[196:199], a[96:99], a[40:43], v[196:199]
v_mfma_f32_16x16x32_bf16 v[196:199], a[100:103], a[44:47], v[196:199]
v_mfma_f32_16x16x32_bf16 v[188:191], a[100:103], a[36:39], v[188:191]
v_mfma_f32_16x16x32_bf16 v[188:191], a[96:99], a[32:35], v[188:191]
ds_read_b64_tr_b16 a[96:97], v5 offset:32768
v_mfma_f32_16x16x32_bf16 v[216:219], a[32:35], a[104:107], v[216:219]
ds_read_b64_tr_b16 a[98:99], v5 offset:33792
v_mfma_f32_16x16x32_bf16 v[216:219], a[36:39], a[108:111], v[216:219]
s_add_u32 m0, s78, 122880
ds_read_b64_tr_b16 a[100:101], v5 offset:40960
v_mfma_f32_16x16x32_bf16 v[224:227], a[44:47], a[108:111], v[224:227]
s_add_u32 s64, s75, 4329472
ds_read_b64_tr_b16 a[102:103], v5 offset:41984
v_mfma_f32_16x16x32_bf16 v[224:227], a[40:43], a[104:107], v[224:227]
buffer_load_dwordx4 v23, s[60:63], s64 offen lds
v_mfma_f32_16x16x32_bf16 v[232:235], a[48:51], a[104:107], v[232:235]
v_mfma_f32_16x16x32_bf16 v[232:235], a[52:55], a[108:111], v[232:235]
v_mfma_f32_16x16x32_bf16 v[240:243], a[60:63], a[108:111], v[240:243]
v_mfma_f32_16x16x32_bf16 v[240:243], a[56:59], a[104:107], v[240:243]
ds_read_b64_tr_b16 a[104:105], v6 offset:32768
v_mfma_f32_16x16x32_bf16 v[244:247], a[56:59], a[112:115], v[244:247]
ds_read_b64_tr_b16 a[106:107], v6 offset:33792
v_mfma_f32_16x16x32_bf16 v[244:247], a[60:63], a[116:119], v[244:247]
ds_read_b64_tr_b16 a[108:109], v6 offset:40960
v_subrev_u32 v19, 0x8000, v19
v_mfma_f32_16x16x32_bf16 v[236:239], a[52:55], a[116:119], v[236:239]
s_xor_b32 m0, s77, 101376
ds_read_b64_tr_b16 a[110:111], v6 offset:41984
v_mfma_f32_16x16x32_bf16 v[236:239], a[48:51], a[112:115], v[236:239]
s_xor_b32 s64, s71, 5865472
v_mfma_f32_16x16x32_bf16 v[228:231], a[40:43], a[112:115], v[228:231]
buffer_load_dwordx4 v15, s[56:59], s64 offen lds
v_mfma_f32_16x16x32_bf16 v[228:231], a[44:47], a[116:119], v[228:231]
v_mfma_f32_16x16x32_bf16 v[220:223], a[36:39], a[116:119], v[220:223]
v_mfma_f32_16x16x32_bf16 v[220:223], a[32:35], a[112:115], v[220:223]
s_waitcnt lgkmcnt(4)
ds_read_b64_tr_b16 a[112:113], v7 offset:32768
v_mfma_f32_16x16x32_bf16 v[152:155], a[72:75], a[32:35], v[152:155]
ds_read_b64_tr_b16 a[114:115], v7 offset:33792
v_mfma_f32_16x16x32_bf16 v[152:155], a[76:79], a[36:39], v[152:155]
ds_read_b64_tr_b16 a[116:117], v7 offset:40960
v_subrev_u32 v20, 0x8000, v20
v_mfma_f32_16x16x32_bf16 v[160:163], a[76:79], a[44:47], v[160:163]
ds_read_b64_tr_b16 a[118:119], v7 offset:41984
v_mfma_f32_16x16x32_bf16 v[160:163], a[72:75], a[40:43], v[160:163]
v_mfma_f32_16x16x32_bf16 v[168:171], a[72:75], a[48:51], v[168:171]
v_mfma_f32_16x16x32_bf16 v[168:171], a[76:79], a[52:55], v[168:171]
v_mfma_f32_16x16x32_bf16 v[176:179], a[76:79], a[60:63], v[176:179]
s_xor_b32 m0, s84, 32768
s_add_u32 s65, s79, 30720
v_mfma_f32_16x16x32_bf16 v[176:179], a[72:75], a[56:59], v[176:179]
s_xor_b32 s64, s72, 1408
buffer_store_dwordx4 a[228:231], v16, s[44:47], s65 offen sc1
v_mfma_f32_16x16x32_bf16 v[180:183], a[80:83], a[56:59], v[180:183]
buffer_load_dwordx4 v12, s[48:51], s64 offen lds
v_mfma_f32_16x16x32_bf16 v[180:183], a[84:87], a[60:63], v[180:183]
ds_read_b64_tr_b16 a[72:73], v8 offset:32768
v_subrev_u32 v4, 0x8000, v4
v_mfma_f32_16x16x32_bf16 v[172:175], a[84:87], a[52:55], v[172:175]
ds_read_b64_tr_b16 a[74:75], v8 offset:33792
v_mfma_f32_16x16x32_bf16 v[172:175], a[80:83], a[48:51], v[172:175]
s_xor_b32 m0, s84, 33792
ds_read_b64_tr_b16 a[76:77], v8 offset:40960
v_mfma_f32_16x16x32_bf16 v[164:167], a[80:83], a[40:43], v[164:167]
s_xor_b32 s64, s72, 17792
ds_read_b64_tr_b16 a[78:79], v8 offset:41984
v_mfma_f32_16x16x32_bf16 v[164:167], a[84:87], a[44:47], v[164:167]
buffer_load_dwordx4 v13, s[48:51], s64 offen lds
v_mfma_f32_16x16x32_bf16 v[156:159], a[84:87], a[36:39], v[156:159]
v_mfma_f32_16x16x32_bf16 v[156:159], a[80:83], a[32:35], v[156:159]
ds_read_b64_tr_b16 a[80:81], v9 offset:32768
v_mfma_f32_16x16x32_bf16 v[24:27], a[88:91], a[32:35], v[24:27]
s_xor_b32 m0, s84, 34816
ds_read_b64_tr_b16 a[82:83], v9 offset:33792
v_mfma_f32_16x16x32_bf16 v[24:27], a[92:95], a[36:39], v[24:27]
s_xor_b32 s64, s72, 132480
ds_read_b64_tr_b16 a[84:85], v9 offset:40960
v_subrev_u32 v5, 0x8000, v5
v_mfma_f32_16x16x32_bf16 v[40:43], a[92:95], a[44:47], v[40:43]
buffer_load_dwordx4 v12, s[48:51], s64 offen lds
v_mfma_f32_16x16x32_bf16 v[40:43], a[88:91], a[40:43], v[40:43]
ds_read_b64_tr_b16 a[86:87], v9 offset:41984
v_mfma_f32_16x16x32_bf16 v[56:59], a[88:91], a[48:51], v[56:59]
v_mfma_f32_16x16x32_bf16 v[56:59], a[92:95], a[52:55], v[56:59]
s_xor_b32 m0, s84, 35840
v_mfma_f32_16x16x32_bf16 v[72:75], a[92:95], a[60:63], v[72:75]
s_waitcnt vmcnt(12)
s_xor_b32 s64, s72, 148864
ds_read_b128 a[0:3], v2 offset:0
v_mfma_f32_16x16x32_bf16 v[72:75], a[88:91], a[56:59], v[72:75]
buffer_load_dwordx4 v13, s[48:51], s64 offen lds
v_mfma_f32_16x16x32_bf16 v[136:139], a[96:99], a[56:59], v[136:139]
ds_read_b128 a[4:7], v3 offset:0
v_mfma_f32_16x16x32_bf16 v[136:139], a[100:103], a[60:63], v[136:139]
ds_read_b128 a[8:11], v2 offset:2048
v_subrev_u32 v6, 0x8000, v6
v_mfma_f32_16x16x32_bf16 v[120:123], a[100:103], a[52:55], v[120:123]
s_xor_b32 m0, s84, 36864
ds_read_b128 a[12:15], v3 offset:2048
v_mfma_f32_16x16x32_bf16 v[120:123], a[96:99], a[48:51], v[120:123]
s_xor_b32 s64, s73, 1408
ds_read_b128 a[16:19], v2 offset:4096
v_mfma_f32_16x16x32_bf16 v[104:107], a[96:99], a[40:43], v[104:107]
buffer_load_dwordx4 v12, s[48:51], s64 offen lds
v_mfma_f32_16x16x32_bf16 v[104:107], a[100:103], a[44:47], v[104:107]
ds_read_b128 a[20:23], v3 offset:4096
v_mfma_f32_16x16x32_bf16 v[88:91], a[100:103], a[36:39], v[88:91]
ds_read_b128 a[24:27], v2 offset:6144
v_mfma_f32_16x16x32_bf16 v[88:91], a[96:99], a[32:35], v[88:91]
s_waitcnt lgkmcnt(7)
s_xor_b32 m0, s84, 37888
ds_read_b128 a[28:31], v3 offset:6144
v_mfma_f32_16x16x32_bf16 v[28:31], a[104:107], a[32:35], v[28:31]
s_xor_b32 s64, s73, 17792
ds_read_b64_tr_b16 a[88:89], v10 offset:32768
v_mfma_f32_16x16x32_bf16 v[28:31], a[108:111], a[36:39], v[28:31]
buffer_load_dwordx4 v13, s[48:51], s64 offen lds
v_mfma_f32_16x16x32_bf16 v[44:47], a[108:111], a[44:47], v[44:47]
ds_read_b64_tr_b16 a[90:91], v10 offset:33792
v_subrev_u32 v7, 0x8000, v7
v_mfma_f32_16x16x32_bf16 v[44:47], a[104:107], a[40:43], v[44:47]
ds_read_b64_tr_b16 a[92:93], v10 offset:40960
v_mfma_f32_16x16x32_bf16 v[60:63], a[104:107], a[48:51], v[60:63]
s_xor_b32 m0, s84, 38912
ds_read_b64_tr_b16 a[94:95], v10 offset:41984
v_mfma_f32_16x16x32_bf16 v[60:63], a[108:111], a[52:55], v[60:63]
s_xor_b32 s64, s73, 132480
ds_read_b64_tr_b16 a[96:97], v11 offset:32768
v_mfma_f32_16x16x32_bf16 v[76:79], a[108:111], a[60:63], v[76:79]
buffer_load_dwordx4 v12, s[48:51], s64 offen lds
v_mfma_f32_16x16x32_bf16 v[76:79], a[104:107], a[56:59], v[76:79]
ds_read_b64_tr_b16 a[98:99], v11 offset:33792
v_mfma_f32_16x16x32_bf16 v[140:143], a[112:115], a[56:59], v[140:143]
s_xor_b32 m0, s84, 39936
ds_read_b64_tr_b16 a[100:101], v11 offset:40960
v_mfma_f32_16x16x32_bf16 v[140:143], a[116:119], a[60:63], v[140:143]
s_xor_b32 s64, s73, 148864
ds_read_b64_tr_b16 a[102:103], v11 offset:41984
v_subrev_u32 v8, 0x8000, v8
v_mfma_f32_16x16x32_bf16 v[124:127], a[116:119], a[52:55], v[124:127]
v_readfirstlane_b32 vcc_lo, v1
s_nop 0
s_cmp_lt_u32 vcc_lo, s81
s_cbranch_scc1 L_spin_1
L_spinbk_2:
v_mfma_f32_16x16x32_bf16 v[124:127], a[112:115], a[48:51], v[124:127]
buffer_load_dwordx4 v13, s[48:51], s64 offen lds
v_mfma_f32_16x16x32_bf16 v[108:111], a[112:115], a[40:43], v[108:111]
v_mfma_f32_16x16x32_bf16 v[108:111], a[116:119], a[44:47], v[108:111]
v_mfma_f32_16x16x32_bf16 v[92:95], a[116:119], a[36:39], v[92:95]
v_subrev_u32 v9, 0x8000, v9
v_subrev_u32 v10, 0x8000, v10
v_mfma_f32_16x16x32_bf16 v[92:95], a[112:115], a[32:35], v[92:95]
v_subrev_u32 v11, 0x8000, v11
v_mfma_f32_16x16x32_bf16 v[32:35], a[72:75], a[32:35], v[32:35]
s_add_u32 s52, s28, 59768832
s_addc_u32 s53, s29, 0
s_mov_b32 s54, 16384
v_mfma_f32_16x16x32_bf16 v[32:35], a[76:79], a[36:39], v[32:35]
v_mfma_f32_16x16x32_bf16 v[48:51], a[76:79], a[44:47], v[48:51]
s_waitcnt lgkmcnt(0)
s_barrier
v_mfma_f32_16x16x32_bf16 v[48:51], a[72:75], a[40:43], v[48:51]
s_xor_b32 m0, s77, 131072
s_add_u32 s65, s79, 31744
ds_read_b64_tr_b16 a[104:105], v19 offset:4096
v_mfma_f32_16x16x32_bf16 v[64:67], a[72:75], a[48:51], v[64:67]
s_xor_b32 s64, s71, 6291456
buffer_store_dwordx4 a[232:235], v16, s[44:47], s65 offen sc1
v_mfma_f32_16x16x32_bf16 v[64:67], a[76:79], a[52:55], v[64:67]
buffer_load_dwordx4 v14, s[56:59], s64 offen lds
v_mfma_f32_16x16x32_bf16 v[80:83], a[76:79], a[60:63], v[80:83]
ds_read_b64_tr_b16 a[106:107], v19 offset:4352
v_mfma_f32_16x16x32_bf16 v[80:83], a[72:75], a[56:59], v[80:83]
ds_read_b64_tr_b16 a[108:109], v19 offset:6144
v_mfma_f32_16x16x32_bf16 v[144:147], a[80:83], a[56:59], v[144:147]
ds_read_b64_tr_b16 a[110:111], v19 offset:6400
v_mfma_f32_16x16x32_bf16 v[144:147], a[84:87], a[60:63], v[144:147]
ds_read_b64_tr_b16 a[112:113], v20 offset:4096
v_mfma_f32_16x16x32_bf16 v[128:131], a[84:87], a[52:55], v[128:131]
ds_read_b64_tr_b16 a[114:115], v20 offset:4352
v_mfma_f32_16x16x32_bf16 v[128:131], a[80:83], a[48:51], v[128:131]
ds_read_b64_tr_b16 a[116:117], v20 offset:6144
v_mfma_f32_16x16x32_bf16 v[112:115], a[80:83], a[40:43], v[112:115]
s_add_u32 m0, s78, 147456
ds_read_b64_tr_b16 a[118:119], v20 offset:6400
v_mfma_f32_16x16x32_bf16 v[112:115], a[84:87], a[44:47], v[112:115]
s_add_u32 s64, s75, 4718592
ds_read_b64_tr_b16 a[72:73], v19 offset:8192
v_mfma_f32_16x16x32_bf16 v[96:99], a[84:87], a[36:39], v[96:99]
buffer_load_dwordx4 v23, s[60:63], s64 offen lds
v_mfma_f32_16x16x32_bf16 v[96:99], a[80:83], a[32:35], v[96:99]
ds_read_b64_tr_b16 a[74:75], v19 offset:8448
v_mfma_f32_16x16x32_bf16 v[36:39], a[88:91], a[32:35], v[36:39]
ds_read_b64_tr_b16 a[76:77], v19 offset:10240
v_mfma_f32_16x16x32_bf16 v[36:39], a[92:95], a[36:39], v[36:39]
ds_read_b64_tr_b16 a[78:79], v19 offset:10496
v_mfma_f32_16x16x32_bf16 v[52:55], a[92:95], a[44:47], v[52:55]
ds_read_b64_tr_b16 a[80:81], v20 offset:8192
v_mfma_f32_16x16x32_bf16 v[52:55], a[88:91], a[40:43], v[52:55]
ds_read_b64_tr_b16 a[82:83], v20 offset:8448
v_mfma_f32_16x16x32_bf16 v[68:71], a[88:91], a[48:51], v[68:71]
ds_read_b64_tr_b16 a[84:85], v20 offset:10240
v_mfma_f32_16x16x32_bf16 v[68:71], a[92:95], a[52:55], v[68:71]
s_xor_b32 m0, s77, 132096
ds_read_b64_tr_b16 a[86:87], v20 offset:10496
v_mfma_f32_16x16x32_bf16 v[84:87], a[92:95], a[60:63], v[84:87]
s_xor_b32 s64, s71, 6324224
v_mfma_f32_16x16x32_bf16 v[84:87], a[88:91], a[56:59], v[84:87]
buffer_load_dwordx4 v14, s[56:59], s64 offen lds
v_mfma_f32_16x16x32_bf16 v[148:151], a[96:99], a[56:59], v[148:151]
ds_read_b64_tr_b16 a[88:89], v19 offset:0
v_mfma_f32_16x16x32_bf16 v[148:151], a[100:103], a[60:63], v[148:151]
ds_read_b64_tr_b16 a[90:91], v19 offset:256
v_mfma_f32_16x16x32_bf16 v[132:135], a[100:103], a[52:55], v[132:135]
ds_read_b64_tr_b16 a[92:93], v19 offset:2048
v_mfma_f32_16x16x32_bf16 v[132:135], a[96:99], a[48:51], v[132:135]
ds_read_b64_tr_b16 a[94:95], v19 offset:2304
v_mfma_f32_16x16x32_bf16 v[116:119], a[96:99], a[40:43], v[116:119]
v_mfma_f32_16x16x32_bf16 v[116:119], a[100:103], a[44:47], v[116:119]
v_mfma_f32_16x16x32_bf16 v[100:103], a[100:103], a[36:39], v[100:103]
s_add_u32 m0, s78, 151552
v_mfma_f32_16x16x32_bf16 v[100:103], a[96:99], a[32:35], v[100:103]
s_waitcnt lgkmcnt(4)
s_add_u32 s64, s75, 4720640
ds_read_b64_tr_b16 a[96:97], v20 offset:0
v_mfma_f32_16x16x32_bf16 v[184:187], a[104:107], a[0:3], v[184:187]
buffer_load_dwordx4 v23, s[60:63], s64 offen lds
v_mfma_f32_16x16x32_bf16 v[184:187], a[108:111], a[4:7], v[184:187]
ds_read_b64_tr_b16 a[98:99], v20 offset:256
v_mfma_f32_16x16x32_bf16 v[192:195], a[108:111], a[12:15], v[192:195]
ds_read_b64_tr_b16 a[100:101], v20 offset:2048
v_mfma_f32_16x16x32_bf16 v[192:195], a[104:107], a[8:11], v[192:195]
ds_read_b64_tr_b16 a[102:103], v20 offset:2304
v_mfma_f32_16x16x32_bf16 v[200:203], a[104:107], a[16:19], v[200:203]
v_mfma_f32_16x16x32_bf16 v[200:203], a[108:111], a[20:23], v[200:203]
v_mfma_f32_16x16x32_bf16 v[208:211], a[108:111], a[28:31], v[208:211]
v_mfma_f32_16x16x32_bf16 v[208:211], a[104:107], a[24:27], v[208:211]
ds_read_b64_tr_b16 a[104:105], v4 offset:0
v_mfma_f32_16x16x32_bf16 v[212:215], a[112:115], a[24:27], v[212:215]
s_xor_b32 m0, s77, 133120
ds_read_b64_tr_b16 a[106:107], v4 offset:1024
v_mfma_f32_16x16x32_bf16 v[212:215], a[116:119], a[28:31], v[212:215]
s_xor_b32 s64, s71, 6356992
ds_read_b64_tr_b16 a[108:109], v4 offset:8192
v_mfma_f32_16x16x32_bf16 v[204:207], a[116:119], a[20:23], v[204:207]
buffer_load_dwordx4 v15, s[56:59], s64 offen lds
v_mfma_f32_16x16x32_bf16 v[204:207], a[112:115], a[16:19], v[204:207]
ds_read_b64_tr_b16 a[110:111], v4 offset:9216
v_mfma_f32_16x16x32_bf16 v[196:199], a[112:115], a[8:11], v[196:199]
v_mfma_f32_16x16x32_bf16 v[196:199], a[116:119], a[12:15], v[196:199]
v_mfma_f32_16x16x32_bf16 v[188:191], a[116:119], a[4:7], v[188:191]
v_mfma_f32_16x16x32_bf16 v[188:191], a[112:115], a[0:3], v[188:191]
ds_read_b64_tr_b16 a[112:113], v5 offset:0
v_mfma_f32_16x16x32_bf16 v[216:219], a[0:3], a[72:75], v[216:219]
s_add_u32 s65, s79, 15360
ds_read_b64_tr_b16 a[114:115], v5 offset:1024
v_mfma_f32_16x16x32_bf16 v[216:219], a[4:7], a[76:79], v[216:219]
s_add_u32 m0, s78, 155648
buffer_store_dwordx4 a[236:239], v16, s[44:47], s65 offen sc1
v_mfma_f32_16x16x32_bf16 v[224:227], a[12:15], a[76:79], v[224:227]
s_add_u32 s64, s75, 4722688
ds_read_b64_tr_b16 a[116:117], v5 offset:8192
v_mfma_f32_16x16x32_bf16 v[224:227], a[8:11], a[72:75], v[224:227]
buffer_load_dwordx4 v23, s[60:63], s64 offen lds
v_mfma_f32_16x16x32_bf16 v[232:235], a[16:19], a[72:75], v[232:235]
s_branch L_po11
L_pg11:
s_branch L_tr1
L_po11:
ds_read_b64_tr_b16 a[118:119], v5 offset:9216
v_mfma_f32_16x16x32_bf16 v[232:235], a[20:23], a[76:79], v[232:235]
v_mfma_f32_16x16x32_bf16 v[240:243], a[28:31], a[76:79], v[240:243]
v_mfma_f32_16x16x32_bf16 v[240:243], a[24:27], a[72:75], v[240:243]
ds_read_b64_tr_b16 a[72:73], v6 offset:0
v_mfma_f32_16x16x32_bf16 v[244:247], a[24:27], a[80:83], v[244:247]
ds_read_b64_tr_b16 a[74:75], v6 offset:1024
v_mfma_f32_16x16x32_bf16 v[244:247], a[28:31], a[84:87], v[244:247]
ds_read_b64_tr_b16 a[76:77], v6 offset:8192
v_mfma_f32_16x16x32_bf16 v[236:239], a[20:23], a[84:87], v[236:239]
s_xor_b32 m0, s77, 134144
ds_read_b64_tr_b16 a[78:79], v6 offset:9216
v_mfma_f32_16x16x32_bf16 v[236:239], a[16:19], a[80:83], v[236:239]
s_xor_b32 s64, s71, 6389760
v_mfma_f32_16x16x32_bf16 v[228:231], a[8:11], a[80:83], v[228:231]
buffer_load_dwordx4 v15, s[56:59], s64 offen lds
v_mfma_f32_16x16x32_bf16 v[228:231], a[12:15], a[84:87], v[228:231]
v_mfma_f32_16x16x32_bf16 v[220:223], a[4:7], a[84:87], v[220:223]
v_mfma_f32_16x16x32_bf16 v[220:223], a[0:3], a[80:83], v[220:223]
s_waitcnt lgkmcnt(4)
ds_read_b64_tr_b16 a[80:81], v7 offset:0
v_mfma_f32_16x16x32_bf16 v[152:155], a[88:91], a[0:3], v[152:155]
ds_read_b64_tr_b16 a[82:83], v7 offset:1024
v_mfma_f32_16x16x32_bf16 v[152:155], a[92:95], a[4:7], v[152:155]
ds_read_b64_tr_b16 a[84:85], v7 offset:8192
v_mfma_f32_16x16x32_bf16 v[160:163], a[92:95], a[12:15], v[160:163]
ds_read_b64_tr_b16 a[86:87], v7 offset:9216
v_mfma_f32_16x16x32_bf16 v[160:163], a[88:91], a[8:11], v[160:163]
v_mfma_f32_16x16x32_bf16 v[168:171], a[88:91], a[16:19], v[168:171]
v_mfma_f32_16x16x32_bf16 v[168:171], a[92:95], a[20:23], v[168:171]
v_mfma_f32_16x16x32_bf16 v[176:179], a[92:95], a[28:31], v[176:179]
s_xor_b32 m0, s84, 0
v_mfma_f32_16x16x32_bf16 v[176:179], a[88:91], a[24:27], v[176:179]
s_xor_b32 s64, s72, 1536
ds_read_b64_tr_b16 a[88:89], v8 offset:0
v_mfma_f32_16x16x32_bf16 v[180:183], a[96:99], a[24:27], v[180:183]
buffer_load_dwordx4 v12, s[48:51], s64 offen lds
v_mfma_f32_16x16x32_bf16 v[180:183], a[100:103], a[28:31], v[180:183]
ds_read_b64_tr_b16 a[90:91], v8 offset:1024
v_mfma_f32_16x16x32_bf16 v[172:175], a[100:103], a[20:23], v[172:175]
ds_read_b64_tr_b16 a[92:93], v8 offset:8192
v_mfma_f32_16x16x32_bf16 v[172:175], a[96:99], a[16:19], v[172:175]
s_xor_b32 m0, s84, 1024
ds_read_b64_tr_b16 a[94:95], v8 offset:9216
v_mfma_f32_16x16x32_bf16 v[164:167], a[96:99], a[8:11], v[164:167]
s_xor_b32 s64, s72, 17920
v_mfma_f32_16x16x32_bf16 v[164:167], a[100:103], a[12:15], v[164:167]
buffer_load_dwordx4 v13, s[48:51], s64 offen lds
v_mfma_f32_16x16x32_bf16 v[156:159], a[100:103], a[4:7], v[156:159]
v_mfma_f32_16x16x32_bf16 v[156:159], a[96:99], a[0:3], v[156:159]
ds_read_b64_tr_b16 a[96:97], v9 offset:0
v_mfma_f32_16x16x32_bf16 v[24:27], a[104:107], a[0:3], v[24:27]
s_xor_b32 m0, s84, 2048
ds_read_b64_tr_b16 a[98:99], v9 offset:1024
v_mfma_f32_16x16x32_bf16 v[24:27], a[108:111], a[4:7], v[24:27]
s_xor_b32 s64, s72, 132608
ds_read_b64_tr_b16 a[100:101], v9 offset:8192
v_mfma_f32_16x16x32_bf16 v[40:43], a[108:111], a[12:15], v[40:43]
buffer_load_dwordx4 v12, s[48:51], s64 offen lds
v_mfma_f32_16x16x32_bf16 v[40:43], a[104:107], a[8:11], v[40:43]
ds_read_b64_tr_b16 a[102:103], v9 offset:9216
v_mfma_f32_16x16x32_bf16 v[56:59], a[104:107], a[16:19], v[56:59]
v_mfma_f32_16x16x32_bf16 v[56:59], a[108:111], a[20:23], v[56:59]
s_xor_b32 m0, s84, 3072
v_mfma_f32_16x16x32_bf16 v[72:75], a[108:111], a[28:31], v[72:75]
s_waitcnt vmcnt(12)
s_xor_b32 s64, s72, 148992
ds_read_b128 a[32:35], v2 offset:32768
v_mfma_f32_16x16x32_bf16 v[72:75], a[104:107], a[24:27], v[72:75]
buffer_load_dwordx4 v13, s[48:51], s64 offen lds
v_mfma_f32_16x16x32_bf16 v[136:139], a[112:115], a[24:27], v[136:139]
ds_read_b128 a[36:39], v3 offset:32768
v_mfma_f32_16x16x32_bf16 v[136:139], a[116:119], a[28:31], v[136:139]
ds_read_b128 a[40:43], v2 offset:34816
v_mfma_f32_16x16x32_bf16 v[120:123], a[116:119], a[20:23], v[120:123]
s_xor_b32 m0, s84, 4096
ds_read_b128 a[44:47], v3 offset:34816
v_mfma_f32_16x16x32_bf16 v[120:123], a[112:115], a[16:19], v[120:123]
s_xor_b32 s64, s73, 1536
ds_read_b128 a[48:51], v2 offset:36864
v_mfma_f32_16x16x32_bf16 v[104:107], a[112:115], a[8:11], v[104:107]
buffer_load_dwordx4 v12, s[48:51], s64 offen lds
v_mfma_f32_16x16x32_bf16 v[104:107], a[116:119], a[12:15], v[104:107]
ds_read_b128 a[52:55], v3 offset:36864
v_mfma_f32_16x16x32_bf16 v[88:91], a[116:119], a[4:7], v[88:91]
buffer_store_dwordx4 a[240:243], v16, s[44:47], s74 offen sc1
v_mfma_f32_16x16x32_bf16 v[88:91], a[112:115], a[0:3], v[88:91]
s_waitcnt lgkmcnt(6)
s_xor_b32 m0, s84, 5120
ds_read_b128 a[56:59], v2 offset:38912
v_mfma_f32_16x16x32_bf16 v[28:31], a[72:75], a[0:3], v[28:31]
s_xor_b32 s64, s73, 17920
ds_read_b128 a[60:63], v3 offset:38912
v_mfma_f32_16x16x32_bf16 v[28:31], a[76:79], a[4:7], v[28:31]
buffer_load_dwordx4 v13, s[48:51], s64 offen lds
v_mfma_f32_16x16x32_bf16 v[44:47], a[76:79], a[12:15], v[44:47]
ds_read_b64_tr_b16 a[104:105], v10 offset:0
v_mfma_f32_16x16x32_bf16 v[44:47], a[72:75], a[8:11], v[44:47]
ds_read_b64_tr_b16 a[106:107], v10 offset:1024
v_mfma_f32_16x16x32_bf16 v[60:63], a[72:75], a[16:19], v[60:63]
s_xor_b32 m0, s84, 6144
ds_read_b64_tr_b16 a[108:109], v10 offset:8192
v_mfma_f32_16x16x32_bf16 v[60:63], a[76:79], a[20:23], v[60:63]
s_xor_b32 s64, s73, 132608
ds_read_b64_tr_b16 a[110:111], v10 offset:9216
v_mfma_f32_16x16x32_bf16 v[76:79], a[76:79], a[28:31], v[76:79]
buffer_load_dwordx4 v12, s[48:51], s64 offen lds
v_mfma_f32_16x16x32_bf16 v[76:79], a[72:75], a[24:27], v[76:79]
ds_read_b64_tr_b16 a[112:113], v11 offset:0
v_mfma_f32_16x16x32_bf16 v[140:143], a[80:83], a[24:27], v[140:143]
ds_read_b64_tr_b16 a[114:115], v11 offset:1024
v_mfma_f32_16x16x32_bf16 v[140:143], a[84:87], a[28:31], v[140:143]
s_xor_b32 m0, s84, 7168
ds_read_b64_tr_b16 a[116:117], v11 offset:8192
v_mfma_f32_16x16x32_bf16 v[124:127], a[84:87], a[20:23], v[124:127]
s_xor_b32 s64, s73, 148992
ds_read_b64_tr_b16 a[118:119], v11 offset:9216
v_mfma_f32_16x16x32_bf16 v[124:127], a[80:83], a[16:19], v[124:127]
buffer_load_dwordx4 v13, s[48:51], s64 offen lds
v_mfma_f32_16x16x32_bf16 v[108:111], a[80:83], a[8:11], v[108:111]
v_mfma_f32_16x16x32_bf16 v[108:111], a[84:87], a[12:15], v[108:111]
v_mfma_f32_16x16x32_bf16 v[92:95], a[84:87], a[4:7], v[92:95]
v_mfma_f32_16x16x32_bf16 v[92:95], a[80:83], a[0:3], v[92:95]
v_mfma_f32_16x16x32_bf16 v[32:35], a[88:91], a[0:3], v[32:35]
v_mfma_f32_16x16x32_bf16 v[32:35], a[92:95], a[4:7], v[32:35]
v_mfma_f32_16x16x32_bf16 v[48:51], a[92:95], a[12:15], v[48:51]
s_waitcnt lgkmcnt(0)
s_barrier
v_mfma_f32_16x16x32_bf16 v[48:51], a[88:91], a[8:11], v[48:51]
s_xor_b32 m0, s77, 65536
ds_read_b64_tr_b16 a[72:73], v19 offset:36864
v_mfma_f32_16x16x32_bf16 v[64:67], a[88:91], a[16:19], v[64:67]
s_xor_b32 s64, s71, 6815744
ds_read_b64_tr_b16 a[74:75], v19 offset:37120
v_mfma_f32_16x16x32_bf16 v[64:67], a[92:95], a[20:23], v[64:67]
buffer_load_dwordx4 v14, s[56:59], s64 offen lds
v_mfma_f32_16x16x32_bf16 v[80:83], a[92:95], a[28:31], v[80:83]
ds_read_b64_tr_b16 a[76:77], v19 offset:38912
v_mfma_f32_16x16x32_bf16 v[80:83], a[88:91], a[24:27], v[80:83]
ds_read_b64_tr_b16 a[78:79], v19 offset:39168
v_mfma_f32_16x16x32_bf16 v[144:147], a[96:99], a[24:27], v[144:147]
ds_read_b64_tr_b16 a[80:81], v20 offset:36864
v_mfma_f32_16x16x32_bf16 v[144:147], a[100:103], a[28:31], v[144:147]
ds_read_b64_tr_b16 a[82:83], v20 offset:37120
v_mfma_f32_16x16x32_bf16 v[128:131], a[100:103], a[20:23], v[128:131]
ds_read_b64_tr_b16 a[84:85], v20 offset:38912
v_mfma_f32_16x16x32_bf16 v[128:131], a[96:99], a[16:19], v[128:131]
ds_read_b64_tr_b16 a[86:87], v20 offset:39168
v_mfma_f32_16x16x32_bf16 v[112:115], a[96:99], a[8:11], v[112:115]
s_add_u32 m0, s78, 81920
ds_read_b64_tr_b16 a[88:89], v19 offset:40960
v_mfma_f32_16x16x32_bf16 v[112:115], a[100:103], a[12:15], v[112:115]
s_add_u32 s64, s75, 5111808
ds_read_b64_tr_b16 a[90:91], v19 offset:41216
v_mfma_f32_16x16x32_bf16 v[96:99], a[100:103], a[4:7], v[96:99]
buffer_load_dwordx4 v23, s[60:63], s64 offen lds
v_mfma_f32_16x16x32_bf16 v[96:99], a[96:99], a[0:3], v[96:99]
ds_read_b64_tr_b16 a[92:93], v19 offset:43008
v_mfma_f32_16x16x32_bf16 v[36:39], a[104:107], a[0:3], v[36:39]
ds_read_b64_tr_b16 a[94:95], v19 offset:43264
v_mfma_f32_16x16x32_bf16 v[36:39], a[108:111], a[4:7], v[36:39]
ds_read_b64_tr_b16 a[96:97], v20 offset:40960
v_mfma_f32_16x16x32_bf16 v[52:55], a[108:111], a[12:15], v[52:55]
ds_read_b64_tr_b16 a[98:99], v20 offset:41216
v_mfma_f32_16x16x32_bf16 v[52:55], a[104:107], a[8:11], v[52:55]
ds_read_b64_tr_b16 a[100:101], v20 offset:43008
v_mfma_f32_16x16x32_bf16 v[68:71], a[104:107], a[16:19], v[68:71]
ds_read_b64_tr_b16 a[102:103], v20 offset:43264
v_mfma_f32_16x16x32_bf16 v[68:71], a[108:111], a[20:23], v[68:71]
s_xor_b32 m0, s77, 66560
v_mfma_f32_16x16x32_bf16 v[84:87], a[108:111], a[28:31], v[84:87]
s_xor_b32 s64, s71, 6848512
v_mfma_f32_16x16x32_bf16 v[84:87], a[104:107], a[24:27], v[84:87]
buffer_load_dwordx4 v14, s[56:59], s64 offen lds
v_mfma_f32_16x16x32_bf16 v[148:151], a[112:115], a[24:27], v[148:151]
ds_read_b64_tr_b16 a[104:105], v19 offset:32768
v_mfma_f32_16x16x32_bf16 v[148:151], a[116:119], a[28:31], v[148:151]
ds_read_b64_tr_b16 a[106:107], v19 offset:33024
v_mfma_f32_16x16x32_bf16 v[132:135], a[116:119], a[20:23], v[132:135]
ds_read_b64_tr_b16 a[108:109], v19 offset:34816
v_mfma_f32_16x16x32_bf16 v[132:135], a[112:115], a[16:19], v[132:135]
ds_read_b64_tr_b16 a[110:111], v19 offset:35072
v_mfma_f32_16x16x32_bf16 v[116:119], a[112:115], a[8:11], v[116:119]
v_mfma_f32_16x16x32_bf16 v[116:119], a[116:119], a[12:15], v[116:119]
v_mfma_f32_16x16x32_bf16 v[100:103], a[116:119], a[4:7], v[100:103]
s_add_u32 m0, s78, 86016
v_mfma_f32_16x16x32_bf16 v[100:103], a[112:115], a[0:3], v[100:103]
s_waitcnt lgkmcnt(4)
s_add_u32 s64, s75, 5113856
ds_read_b64_tr_b16 a[112:113], v20 offset:32768
v_mfma_f32_16x16x32_bf16 v[184:187], a[72:75], a[32:35], v[184:187]
s_lshl_b32 s66, s30, 30
buffer_load_dwordx4 v23, s[60:63], s64 offen lds
v_mfma_f32_16x16x32_bf16 v[184:187], a[76:79], a[36:39], v[184:187]
ds_read_b64_tr_b16 a[114:115], v20 offset:33024
v_lshl_add_u32 v1, v0, 24, s66
v_mfma_f32_16x16x32_bf16 v[192:195], a[76:79], a[44:47], v[192:195]
s_lshl_b32 s70, s31, 8
ds_read_b64_tr_b16 a[116:117], v20 offset:34816
v_mfma_f32_16x16x32_bf16 v[192:195], a[72:75], a[40:43], v[192:195]
ds_read_b64_tr_b16 a[118:119], v20 offset:35072
v_mfma_f32_16x16x32_bf16 v[200:203], a[72:75], a[48:51], v[200:203]
v_mfma_f32_16x16x32_bf16 v[200:203], a[76:79], a[52:55], v[200:203]
v_mfma_f32_16x16x32_bf16 v[208:211], a[76:79], a[60:63], v[208:211]
v_mfma_f32_16x16x32_bf16 v[208:211], a[72:75], a[56:59], v[208:211]
ds_read_b64_tr_b16 a[72:73], v4 offset:32768
v_mfma_f32_16x16x32_bf16 v[212:215], a[80:83], a[56:59], v[212:215]
s_xor_b32 m0, s77, 67584
ds_read_b64_tr_b16 a[74:75], v4 offset:33792
v_mfma_f32_16x16x32_bf16 v[212:215], a[84:87], a[60:63], v[212:215]
s_xor_b32 s64, s71, 6881280
ds_read_b64_tr_b16 a[76:77], v4 offset:40960
v_mfma_f32_16x16x32_bf16 v[204:207], a[84:87], a[52:55], v[204:207]
buffer_load_dwordx4 v15, s[56:59], s64 offen lds
v_mfma_f32_16x16x32_bf16 v[204:207], a[80:83], a[48:51], v[204:207]
ds_read_b64_tr_b16 a[78:79], v4 offset:41984
v_mfma_f32_16x16x32_bf16 v[196:199], a[80:83], a[40:43], v[196:199]
v_mfma_f32_16x16x32_bf16 v[196:199], a[84:87], a[44:47], v[196:199]
v_mfma_f32_16x16x32_bf16 v[188:191], a[84:87], a[36:39], v[188:191]
v_mfma_f32_16x16x32_bf16 v[188:191], a[80:83], a[32:35], v[188:191]
ds_read_b64_tr_b16 a[80:81], v5 offset:32768
v_mfma_f32_16x16x32_bf16 v[216:219], a[32:35], a[88:91], v[216:219]
ds_read_b64_tr_b16 a[82:83], v5 offset:33792
v_mfma_f32_16x16x32_bf16 v[216:219], a[36:39], a[92:95], v[216:219]
s_add_u32 m0, s78, 90112
ds_read_b64_tr_b16 a[84:85], v5 offset:40960
v_mfma_f32_16x16x32_bf16 v[224:227], a[44:47], a[92:95], v[224:227]
s_add_u32 s64, s75, 5115904
ds_read_b64_tr_b16 a[86:87], v5 offset:41984
v_mfma_f32_16x16x32_bf16 v[224:227], a[40:43], a[88:91], v[224:227]
buffer_load_dwordx4 v23, s[60:63], s64 offen lds
v_mfma_f32_16x16x32_bf16 v[232:235], a[48:51], a[88:91], v[232:235]
v_mfma_f32_16x16x32_bf16 v[232:235], a[52:55], a[92:95], v[232:235]
v_mfma_f32_16x16x32_bf16 v[240:243], a[60:63], a[92:95], v[240:243]
v_mfma_f32_16x16x32_bf16 v[240:243], a[56:59], a[88:91], v[240:243]
ds_read_b64_tr_b16 a[88:89], v6 offset:32768
v_mfma_f32_16x16x32_bf16 v[244:247], a[56:59], a[96:99], v[244:247]
ds_read_b64_tr_b16 a[90:91], v6 offset:33792
v_mfma_f32_16x16x32_bf16 v[244:247], a[60:63], a[100:103], v[244:247]
ds_read_b64_tr_b16 a[92:93], v6 offset:40960
v_add_u32 v19, 0x8000, v19
v_mfma_f32_16x16x32_bf16 v[236:239], a[52:55], a[100:103], v[236:239]
s_xor_b32 m0, s77, 68608
ds_read_b64_tr_b16 a[94:95], v6 offset:41984
v_mfma_f32_16x16x32_bf16 v[236:239], a[48:51], a[96:99], v[236:239]
s_xor_b32 s64, s71, 6914048
v_mfma_f32_16x16x32_bf16 v[228:231], a[40:43], a[96:99], v[228:231]
buffer_load_dwordx4 v15, s[56:59], s64 offen lds
v_mfma_f32_16x16x32_bf16 v[228:231], a[44:47], a[100:103], v[228:231]
v_mfma_f32_16x16x32_bf16 v[220:223], a[36:39], a[100:103], v[220:223]
v_mfma_f32_16x16x32_bf16 v[220:223], a[32:35], a[96:99], v[220:223]
s_waitcnt lgkmcnt(4)
ds_read_b64_tr_b16 a[96:97], v7 offset:32768
v_mfma_f32_16x16x32_bf16 v[152:155], a[104:107], a[32:35], v[152:155]
ds_read_b64_tr_b16 a[98:99], v7 offset:33792
v_mfma_f32_16x16x32_bf16 v[152:155], a[108:111], a[36:39], v[152:155]
ds_read_b64_tr_b16 a[100:101], v7 offset:40960
v_add_u32 v20, 0x8000, v20
v_mfma_f32_16x16x32_bf16 v[160:163], a[108:111], a[44:47], v[160:163]
ds_read_b64_tr_b16 a[102:103], v7 offset:41984
v_mfma_f32_16x16x32_bf16 v[160:163], a[104:107], a[40:43], v[160:163]
v_mfma_f32_16x16x32_bf16 v[168:171], a[104:107], a[48:51], v[168:171]
v_mfma_f32_16x16x32_bf16 v[168:171], a[108:111], a[52:55], v[168:171]
v_mfma_f32_16x16x32_bf16 v[176:179], a[108:111], a[60:63], v[176:179]
s_xor_b32 m0, s84, 32768
v_mfma_f32_16x16x32_bf16 v[176:179], a[104:107], a[56:59], v[176:179]
s_xor_b32 s64, s72, 1664
ds_read_b64_tr_b16 a[104:105], v8 offset:32768
v_mfma_f32_16x16x32_bf16 v[180:183], a[112:115], a[56:59], v[180:183]
buffer_load_dwordx4 v12, s[48:51], s64 offen lds
v_mfma_f32_16x16x32_bf16 v[180:183], a[116:119], a[60:63], v[180:183]
ds_read_b64_tr_b16 a[106:107], v8 offset:33792
v_add_u32 v4, 0x8000, v4
v_mfma_f32_16x16x32_bf16 v[172:175], a[116:119], a[52:55], v[172:175]
ds_read_b64_tr_b16 a[108:109], v8 offset:40960
v_mfma_f32_16x16x32_bf16 v[172:175], a[112:115], a[48:51], v[172:175]
s_xor_b32 m0, s84, 33792
ds_read_b64_tr_b16 a[110:111], v8 offset:41984
v_mfma_f32_16x16x32_bf16 v[164:167], a[112:115], a[40:43], v[164:167]
s_xor_b32 s64, s72, 18048
v_mfma_f32_16x16x32_bf16 v[164:167], a[116:119], a[44:47], v[164:167]
buffer_load_dwordx4 v13, s[48:51], s64 offen lds
v_mfma_f32_16x16x32_bf16 v[156:159], a[116:119], a[36:39], v[156:159]
v_mfma_f32_16x16x32_bf16 v[156:159], a[112:115], a[32:35], v[156:159]
ds_read_b64_tr_b16 a[112:113], v9 offset:32768
v_mfma_f32_16x16x32_bf16 v[24:27], a[72:75], a[32:35], v[24:27]
s_xor_b32 m0, s84, 34816
ds_read_b64_tr_b16 a[114:115], v9 offset:33792
v_mfma_f32_16x16x32_bf16 v[24:27], a[76:79], a[36:39], v[24:27]
s_xor_b32 s64, s72, 132736
ds_read_b64_tr_b16 a[116:117], v9 offset:40960
v_add_u32 v5, 0x8000, v5
v_mfma_f32_16x16x32_bf16 v[40:43], a[76:79], a[44:47], v[40:43]
buffer_load_dwordx4 v12, s[48:51], s64 offen lds
v_mfma_f32_16x16x32_bf16 v[40:43], a[72:75], a[40:43], v[40:43]
ds_read_b64_tr_b16 a[118:119], v9 offset:41984
v_mfma_f32_16x16x32_bf16 v[56:59], a[72:75], a[48:51], v[56:59]
v_mfma_f32_16x16x32_bf16 v[56:59], a[76:79], a[52:55], v[56:59]
s_xor_b32 m0, s84, 35840
v_mfma_f32_16x16x32_bf16 v[72:75], a[76:79], a[60:63], v[72:75]
s_waitcnt vmcnt(10)
s_xor_b32 s64, s72, 149120
ds_read_b128 a[0:3], v2 offset:0
v_mfma_f32_16x16x32_bf16 v[72:75], a[72:75], a[56:59], v[72:75]
buffer_load_dwordx4 v13, s[48:51], s64 offen lds
v_mfma_f32_16x16x32_bf16 v[136:139], a[80:83], a[56:59], v[136:139]
ds_read_b128 a[4:7], v3 offset:0
v_mfma_f32_16x16x32_bf16 v[136:139], a[84:87], a[60:63], v[136:139]
ds_read_b128 a[8:11], v2 offset:2048
v_add_u32 v6, 0x8000, v6
v_mfma_f32_16x16x32_bf16 v[120:123], a[84:87], a[52:55], v[120:123]
s_xor_b32 m0, s84, 36864
ds_read_b128 a[12:15], v3 offset:2048
v_mfma_f32_16x16x32_bf16 v[120:123], a[80:83], a[48:51], v[120:123]
s_xor_b32 s64, s73, 1664
ds_read_b128 a[16:19], v2 offset:4096
v_mfma_f32_16x16x32_bf16 v[104:107], a[80:83], a[40:43], v[104:107]
buffer_load_dwordx4 v12, s[48:51], s64 offen lds
v_mfma_f32_16x16x32_bf16 v[104:107], a[84:87], a[44:47], v[104:107]
ds_read_b128 a[20:23], v3 offset:4096
v_mfma_f32_16x16x32_bf16 v[88:91], a[84:87], a[36:39], v[88:91]
ds_read_b128 a[24:27], v2 offset:6144
v_mfma_f32_16x16x32_bf16 v[88:91], a[80:83], a[32:35], v[88:91]
s_waitcnt lgkmcnt(7)
s_xor_b32 m0, s84, 37888
ds_read_b128 a[28:31], v3 offset:6144
v_mfma_f32_16x16x32_bf16 v[28:31], a[88:91], a[32:35], v[28:31]
s_xor_b32 s64, s73, 18048
ds_read_b64_tr_b16 a[72:73], v10 offset:32768
v_mfma_f32_16x16x32_bf16 v[28:31], a[92:95], a[36:39], v[28:31]
buffer_load_dwordx4 v13, s[48:51], s64 offen lds
v_mfma_f32_16x16x32_bf16 v[44:47], a[92:95], a[44:47], v[44:47]
ds_read_b64_tr_b16 a[74:75], v10 offset:33792
v_add_u32 v7, 0x8000, v7
v_mfma_f32_16x16x32_bf16 v[44:47], a[88:91], a[40:43], v[44:47]
ds_read_b64_tr_b16 a[76:77], v10 offset:40960
v_mfma_f32_16x16x32_bf16 v[60:63], a[88:91], a[48:51], v[60:63]
s_xor_b32 m0, s84, 38912
ds_read_b64_tr_b16 a[78:79], v10 offset:41984
v_mfma_f32_16x16x32_bf16 v[60:63], a[92:95], a[52:55], v[60:63]
s_xor_b32 s64, s73, 132736
ds_read_b64_tr_b16 a[80:81], v11 offset:32768
v_mfma_f32_16x16x32_bf16 v[76:79], a[92:95], a[60:63], v[76:79]
buffer_load_dwordx4 v12, s[48:51], s64 offen lds
v_mfma_f32_16x16x32_bf16 v[76:79], a[88:91], a[56:59], v[76:79]
ds_read_b64_tr_b16 a[82:83], v11 offset:33792
v_mfma_f32_16x16x32_bf16 v[140:143], a[96:99], a[56:59], v[140:143]
ds_read_b64_tr_b16 a[84:85], v11 offset:40960
v_mfma_f32_16x16x32_bf16 v[140:143], a[100:103], a[60:63], v[140:143]
s_xor_b32 m0, s84, 39936
ds_read_b64_tr_b16 a[86:87], v11 offset:41984
v_add_u32 v8, 0x8000, v8
v_mfma_f32_16x16x32_bf16 v[124:127], a[100:103], a[52:55], v[124:127]
s_xor_b32 s64, s73, 149120
v_mfma_f32_16x16x32_bf16 v[124:127], a[96:99], a[48:51], v[124:127]
buffer_load_dwordx4 v13, s[48:51], s64 offen lds
v_mfma_f32_16x16x32_bf16 v[108:111], a[96:99], a[40:43], v[108:111]
v_mfma_f32_16x16x32_bf16 v[108:111], a[100:103], a[44:47], v[108:111]
v_mfma_f32_16x16x32_bf16 v[92:95], a[100:103], a[36:39], v[92:95]
v_add_u32 v9, 0x8000, v9
v_add_u32 v10, 0x8000, v10
v_mfma_f32_16x16x32_bf16 v[92:95], a[96:99], a[32:35], v[92:95]
v_add_u32 v11, 0x8000, v11
v_mfma_f32_16x16x32_bf16 v[32:35], a[104:107], a[32:35], v[32:35]
v_mfma_f32_16x16x32_bf16 v[32:35], a[108:111], a[36:39], v[32:35]
v_mfma_f32_16x16x32_bf16 v[48:51], a[108:111], a[44:47], v[48:51]
s_waitcnt lgkmcnt(0)
s_barrier
v_mfma_f32_16x16x32_bf16 v[48:51], a[104:107], a[40:43], v[48:51]
s_mov_b64 exec, 1
buffer_atomic_add a251, v1, s[52:55], s70 offen offset:0 sc1
s_mov_b64 exec, -1
s_xor_b32 m0, s77, 98304
v_mfma_f32_16x16x32_bf16 v[64:67], a[104:107], a[48:51], v[64:67]
s_lshl4_add_u32 s70, s78, s70
s_xor_b32 s64, s71, 7340032
ds_read_b64_tr_b16 a[88:89], v19 offset:36864
v_mfma_f32_16x16x32_bf16 v[64:67], a[108:111], a[52:55], v[64:67]
s_lshr_b32 s81, s81, 5
buffer_load_dwordx4 v14, s[56:59], s64 offen lds
v_mfma_f32_16x16x32_bf16 v[80:83], a[108:111], a[60:63], v[80:83]
ds_read_b64_tr_b16 a[90:91], v19 offset:37120
v_mfma_f32_16x16x32_bf16 v[80:83], a[104:107], a[56:59], v[80:83]
ds_read_b64_tr_b16 a[92:93], v19 offset:38912
v_mfma_f32_16x16x32_bf16 v[144:147], a[112:115], a[56:59], v[144:147]
ds_read_b64_tr_b16 a[94:95], v19 offset:39168
v_mfma_f32_16x16x32_bf16 v[144:147], a[116:119], a[60:63], v[144:147]
ds_read_b64_tr_b16 a[96:97], v20 offset:36864
v_mfma_f32_16x16x32_bf16 v[128:131], a[116:119], a[52:55], v[128:131]
ds_read_b64_tr_b16 a[98:99], v20 offset:37120
v_mfma_f32_16x16x32_bf16 v[128:131], a[112:115], a[48:51], v[128:131]
ds_read_b64_tr_b16 a[100:101], v20 offset:38912
v_mfma_f32_16x16x32_bf16 v[112:115], a[112:115], a[40:43], v[112:115]
s_add_u32 m0, s78, 114688
ds_read_b64_tr_b16 a[102:103], v20 offset:39168
v_mfma_f32_16x16x32_bf16 v[112:115], a[116:119], a[44:47], v[112:115]
s_add_u32 s64, s75, 5505024
ds_read_b64_tr_b16 a[104:105], v19 offset:40960
v_mfma_f32_16x16x32_bf16 v[96:99], a[116:119], a[36:39], v[96:99]
buffer_load_dwordx4 v23, s[60:63], s64 offen lds
v_mfma_f32_16x16x32_bf16 v[96:99], a[112:115], a[32:35], v[96:99]
ds_read_b64_tr_b16 a[106:107], v19 offset:41216
v_mfma_f32_16x16x32_bf16 v[36:39], a[72:75], a[32:35], v[36:39]
ds_read_b64_tr_b16 a[108:109], v19 offset:43008
v_mfma_f32_16x16x32_bf16 v[36:39], a[76:79], a[36:39], v[36:39]
ds_read_b64_tr_b16 a[110:111], v19 offset:43264
v_mfma_f32_16x16x32_bf16 v[52:55], a[76:79], a[44:47], v[52:55]
ds_read_b64_tr_b16 a[112:113], v20 offset:40960
v_mfma_f32_16x16x32_bf16 v[52:55], a[72:75], a[40:43], v[52:55]
ds_read_b64_tr_b16 a[114:115], v20 offset:41216
v_mfma_f32_16x16x32_bf16 v[68:71], a[72:75], a[48:51], v[68:71]
ds_read_b64_tr_b16 a[116:117], v20 offset:43008
v_mfma_f32_16x16x32_bf16 v[68:71], a[76:79], a[52:55], v[68:71]
s_xor_b32 m0, s77, 99328
ds_read_b64_tr_b16 a[118:119], v20 offset:43264
v_mfma_f32_16x16x32_bf16 v[84:87], a[76:79], a[60:63], v[84:87]
s_xor_b32 s64, s71, 7372800
v_mfma_f32_16x16x32_bf16 v[84:87], a[72:75], a[56:59], v[84:87]
buffer_load_dwordx4 v14, s[56:59], s64 offen lds
v_mfma_f32_16x16x32_bf16 v[148:151], a[80:83], a[56:59], v[148:151]
ds_read_b64_tr_b16 a[72:73], v19 offset:32768
v_mfma_f32_16x16x32_bf16 v[148:151], a[84:87], a[60:63], v[148:151]
ds_read_b64_tr_b16 a[74:75], v19 offset:33024
v_mfma_f32_16x16x32_bf16 v[132:135], a[84:87], a[52:55], v[132:135]
ds_read_b64_tr_b16 a[76:77], v19 offset:34816
v_mfma_f32_16x16x32_bf16 v[132:135], a[80:83], a[48:51], v[132:135]
ds_read_b64_tr_b16 a[78:79], v19 offset:35072
v_mfma_f32_16x16x32_bf16 v[116:119], a[80:83], a[40:43], v[116:119]
v_mfma_f32_16x16x32_bf16 v[116:119], a[84:87], a[44:47], v[116:119]
v_mfma_f32_16x16x32_bf16 v[100:103], a[84:87], a[36:39], v[100:103]
s_add_u32 m0, s78, 118784
v_mfma_f32_16x16x32_bf16 v[100:103], a[80:83], a[32:35], v[100:103]
s_waitcnt lgkmcnt(4)
s_add_u32 s64, s75, 5507072
ds_read_b64_tr_b16 a[80:81], v20 offset:32768
v_mfma_f32_16x16x32_bf16 v[184:187], a[88:91], a[0:3], v[184:187]
buffer_load_dwordx4 v23, s[60:63], s64 offen lds
v_mfma_f32_16x16x32_bf16 v[184:187], a[92:95], a[4:7], v[184:187]
ds_read_b64_tr_b16 a[82:83], v20 offset:33024
v_mfma_f32_16x16x32_bf16 v[192:195], a[92:95], a[12:15], v[192:195]
ds_read_b64_tr_b16 a[84:85], v20 offset:34816
v_mfma_f32_16x16x32_bf16 v[192:195], a[88:91], a[8:11], v[192:195]
ds_read_b64_tr_b16 a[86:87], v20 offset:35072
v_mfma_f32_16x16x32_bf16 v[200:203], a[88:91], a[16:19], v[200:203]
v_mfma_f32_16x16x32_bf16 v[200:203], a[92:95], a[20:23], v[200:203]
v_mfma_f32_16x16x32_bf16 v[208:211], a[92:95], a[28:31], v[208:211]
v_mfma_f32_16x16x32_bf16 v[208:211], a[88:91], a[24:27], v[208:211]
ds_read_b64_tr_b16 a[88:89], v4 offset:32768
v_mfma_f32_16x16x32_bf16 v[212:215], a[96:99], a[24:27], v[212:215]
s_xor_b32 m0, s77, 100352
ds_read_b64_tr_b16 a[90:91], v4 offset:33792
v_mfma_f32_16x16x32_bf16 v[212:215], a[100:103], a[28:31], v[212:215]
s_xor_b32 s64, s71, 7405568
ds_read_b64_tr_b16 a[92:93], v4 offset:40960
v_mfma_f32_16x16x32_bf16 v[204:207], a[100:103], a[20:23], v[204:207]
buffer_load_dwordx4 v15, s[56:59], s64 offen lds
v_mfma_f32_16x16x32_bf16 v[204:207], a[96:99], a[16:19], v[204:207]
ds_read_b64_tr_b16 a[94:95], v4 offset:41984
v_mfma_f32_16x16x32_bf16 v[196:199], a[96:99], a[8:11], v[196:199]
v_mfma_f32_16x16x32_bf16 v[196:199], a[100:103], a[12:15], v[196:199]
v_mfma_f32_16x16x32_bf16 v[188:191], a[100:103], a[4:7], v[188:191]
v_mfma_f32_16x16x32_bf16 v[188:191], a[96:99], a[0:3], v[188:191]
ds_read_b64_tr_b16 a[96:97], v5 offset:32768
v_mfma_f32_16x16x32_bf16 v[216:219], a[0:3], a[104:107], v[216:219]
ds_read_b64_tr_b16 a[98:99], v5 offset:33792
v_mfma_f32_16x16x32_bf16 v[216:219], a[4:7], a[108:111], v[216:219]
s_add_u32 m0, s78, 122880
ds_read_b64_tr_b16 a[100:101], v5 offset:40960
v_mfma_f32_16x16x32_bf16 v[224:227], a[12:15], a[108:111], v[224:227]
s_add_u32 s64, s75, 5509120
ds_read_b64_tr_b16 a[102:103], v5 offset:41984
v_mfma_f32_16x16x32_bf16 v[224:227], a[8:11], a[104:107], v[224:227]
buffer_load_dwordx4 v23, s[60:63], s64 offen lds
v_mfma_f32_16x16x32_bf16 v[232:235], a[16:19], a[104:107], v[232:235]
v_mfma_f32_16x16x32_bf16 v[232:235], a[20:23], a[108:111], v[232:235]
v_mfma_f32_16x16x32_bf16 v[240:243], a[28:31], a[108:111], v[240:243]
v_mfma_f32_16x16x32_bf16 v[240:243], a[24:27], a[104:107], v[240:243]
ds_read_b64_tr_b16 a[104:105], v6 offset:32768
v_mfma_f32_16x16x32_bf16 v[244:247], a[24:27], a[112:115], v[244:247]
ds_read_b64_tr_b16 a[106:107], v6 offset:33792
v_mfma_f32_16x16x32_bf16 v[244:247], a[28:31], a[116:119], v[244:247]
ds_read_b64_tr_b16 a[108:109], v6 offset:40960
v_subrev_u32 v19, 0x8000, v19
v_mfma_f32_16x16x32_bf16 v[236:239], a[20:23], a[116:119], v[236:239]
s_xor_b32 m0, s77, 101376
ds_read_b64_tr_b16 a[110:111], v6 offset:41984
v_mfma_f32_16x16x32_bf16 v[236:239], a[16:19], a[112:115], v[236:239]
s_xor_b32 s64, s71, 7438336
v_mfma_f32_16x16x32_bf16 v[228:231], a[8:11], a[112:115], v[228:231]
buffer_load_dwordx4 v15, s[56:59], s64 offen lds
v_mfma_f32_16x16x32_bf16 v[228:231], a[12:15], a[116:119], v[228:231]
v_mfma_f32_16x16x32_bf16 v[220:223], a[4:7], a[116:119], v[220:223]
v_mfma_f32_16x16x32_bf16 v[220:223], a[0:3], a[112:115], v[220:223]
s_waitcnt lgkmcnt(4)
ds_read_b64_tr_b16 a[112:113], v7 offset:32768
v_mfma_f32_16x16x32_bf16 v[152:155], a[72:75], a[0:3], v[152:155]
ds_read_b64_tr_b16 a[114:115], v7 offset:33792
v_mfma_f32_16x16x32_bf16 v[152:155], a[76:79], a[4:7], v[152:155]
ds_read_b64_tr_b16 a[116:117], v7 offset:40960
v_subrev_u32 v20, 0x8000, v20
v_mfma_f32_16x16x32_bf16 v[160:163], a[76:79], a[12:15], v[160:163]
ds_read_b64_tr_b16 a[118:119], v7 offset:41984
v_mfma_f32_16x16x32_bf16 v[160:163], a[72:75], a[8:11], v[160:163]
v_mfma_f32_16x16x32_bf16 v[168:171], a[72:75], a[16:19], v[168:171]
v_mfma_f32_16x16x32_bf16 v[168:171], a[76:79], a[20:23], v[168:171]
v_mfma_f32_16x16x32_bf16 v[176:179], a[76:79], a[28:31], v[176:179]
s_xor_b32 m0, s84, 0
v_mfma_f32_16x16x32_bf16 v[176:179], a[72:75], a[24:27], v[176:179]
s_xor_b32 s64, s72, 1792
ds_read_b64_tr_b16 a[72:73], v8 offset:32768
v_mfma_f32_16x16x32_bf16 v[180:183], a[80:83], a[24:27], v[180:183]
buffer_load_dwordx4 v12, s[48:51], s64 offen lds
v_mfma_f32_16x16x32_bf16 v[180:183], a[84:87], a[28:31], v[180:183]
ds_read_b64_tr_b16 a[74:75], v8 offset:33792
v_subrev_u32 v4, 0x8000, v4
v_mfma_f32_16x16x32_bf16 v[172:175], a[84:87], a[20:23], v[172:175]
ds_read_b64_tr_b16 a[76:77], v8 offset:40960
v_mfma_f32_16x16x32_bf16 v[172:175], a[80:83], a[16:19], v[172:175]
s_xor_b32 m0, s84, 1024
ds_read_b64_tr_b16 a[78:79], v8 offset:41984
v_mfma_f32_16x16x32_bf16 v[164:167], a[80:83], a[8:11], v[164:167]
s_xor_b32 s64, s72, 18176
v_mfma_f32_16x16x32_bf16 v[164:167], a[84:87], a[12:15], v[164:167]
s_branch L_po12
L_pg12:
s_branch L_tr1
L_po12:
buffer_load_dwordx4 v13, s[48:51], s64 offen lds
v_mfma_f32_16x16x32_bf16 v[156:159], a[84:87], a[4:7], v[156:159]
v_mfma_f32_16x16x32_bf16 v[156:159], a[80:83], a[0:3], v[156:159]
ds_read_b64_tr_b16 a[80:81], v9 offset:32768
v_mfma_f32_16x16x32_bf16 v[24:27], a[88:91], a[0:3], v[24:27]
s_xor_b32 m0, s84, 2048
ds_read_b64_tr_b16 a[82:83], v9 offset:33792
v_mfma_f32_16x16x32_bf16 v[24:27], a[92:95], a[4:7], v[24:27]
s_xor_b32 s64, s72, 132864
ds_read_b64_tr_b16 a[84:85], v9 offset:40960
v_subrev_u32 v5, 0x8000, v5
v_mfma_f32_16x16x32_bf16 v[40:43], a[92:95], a[12:15], v[40:43]
buffer_load_dwordx4 v12, s[48:51], s64 offen lds
v_mfma_f32_16x16x32_bf16 v[40:43], a[88:91], a[8:11], v[40:43]
ds_read_b64_tr_b16 a[86:87], v9 offset:41984
v_mfma_f32_16x16x32_bf16 v[56:59], a[88:91], a[16:19], v[56:59]
v_mfma_f32_16x16x32_bf16 v[56:59], a[92:95], a[20:23], v[56:59]
s_xor_b32 m0, s84, 3072
v_mfma_f32_16x16x32_bf16 v[72:75], a[92:95], a[28:31], v[72:75]
s_waitcnt vmcnt(11)
s_xor_b32 s64, s72, 149248
ds_read_b128 a[32:35], v2 offset:32768
v_mfma_f32_16x16x32_bf16 v[72:75], a[88:91], a[24:27], v[72:75]
buffer_load_dwordx4 v13, s[48:51], s64 offen lds
v_mfma_f32_16x16x32_bf16 v[136:139], a[96:99], a[24:27], v[136:139]
ds_read_b128 a[36:39], v3 offset:32768
v_mfma_f32_16x16x32_bf16 v[136:139], a[100:103], a[28:31], v[136:139]
ds_read_b128 a[40:43], v2 offset:34816
v_subrev_u32 v6, 0x8000, v6
v_mfma_f32_16x16x32_bf16 v[120:123], a[100:103], a[20:23], v[120:123]
s_xor_b32 m0, s84, 4096
ds_read_b128 a[44:47], v3 offset:34816
v_mfma_f32_16x16x32_bf16 v[120:123], a[96:99], a[16:19], v[120:123]
s_xor_b32 s64, s73, 1792
ds_read_b128 a[48:51], v2 offset:36864
v_mfma_f32_16x16x32_bf16 v[104:107], a[96:99], a[8:11], v[104:107]
buffer_load_dwordx4 v12, s[48:51], s64 offen lds
v_mfma_f32_16x16x32_bf16 v[104:107], a[100:103], a[12:15], v[104:107]
ds_read_b128 a[52:55], v3 offset:36864
v_mfma_f32_16x16x32_bf16 v[88:91], a[100:103], a[4:7], v[88:91]
ds_read_b128 a[56:59], v2 offset:38912
v_mfma_f32_16x16x32_bf16 v[88:91], a[96:99], a[0:3], v[88:91]
s_waitcnt lgkmcnt(7)
s_xor_b32 m0, s84, 5120
ds_read_b128 a[60:63], v3 offset:38912
v_mfma_f32_16x16x32_bf16 v[28:31], a[104:107], a[0:3], v[28:31]
s_xor_b32 s64, s73, 18176
ds_read_b64_tr_b16 a[88:89], v10 offset:32768
v_mfma_f32_16x16x32_bf16 v[28:31], a[108:111], a[4:7], v[28:31]
buffer_load_dwordx4 v13, s[48:51], s64 offen lds
v_mfma_f32_16x16x32_bf16 v[44:47], a[108:111], a[12:15], v[44:47]
ds_read_b64_tr_b16 a[90:91], v10 offset:33792
v_subrev_u32 v7, 0x8000, v7
v_mfma_f32_16x16x32_bf16 v[44:47], a[104:107], a[8:11], v[44:47]
ds_read_b64_tr_b16 a[92:93], v10 offset:40960
v_mfma_f32_16x16x32_bf16 v[60:63], a[104:107], a[16:19], v[60:63]
s_xor_b32 m0, s84, 6144
ds_read_b64_tr_b16 a[94:95], v10 offset:41984
v_mfma_f32_16x16x32_bf16 v[60:63], a[108:111], a[20:23], v[60:63]
s_xor_b32 s64, s73, 132864
ds_read_b64_tr_b16 a[96:97], v11 offset:32768
v_mfma_f32_16x16x32_bf16 v[76:79], a[108:111], a[28:31], v[76:79]
buffer_load_dwordx4 v12, s[48:51], s64 offen lds
v_mfma_f32_16x16x32_bf16 v[76:79], a[104:107], a[24:27], v[76:79]
ds_read_b64_tr_b16 a[98:99], v11 offset:33792
v_mfma_f32_16x16x32_bf16 v[140:143], a[112:115], a[24:27], v[140:143]
ds_read_b64_tr_b16 a[100:101], v11 offset:40960
v_mfma_f32_16x16x32_bf16 v[140:143], a[116:119], a[28:31], v[140:143]
s_xor_b32 m0, s84, 7168
ds_read_b64_tr_b16 a[102:103], v11 offset:41984
v_subrev_u32 v8, 0x8000, v8
v_mfma_f32_16x16x32_bf16 v[124:127], a[116:119], a[20:23], v[124:127]
s_xor_b32 s64, s73, 149248
v_mfma_f32_16x16x32_bf16 v[124:127], a[112:115], a[16:19], v[124:127]
buffer_load_dwordx4 v13, s[48:51], s64 offen lds
v_mfma_f32_16x16x32_bf16 v[108:111], a[112:115], a[8:11], v[108:111]
v_mfma_f32_16x16x32_bf16 v[108:111], a[116:119], a[12:15], v[108:111]
v_mfma_f32_16x16x32_bf16 v[92:95], a[116:119], a[4:7], v[92:95]
v_subrev_u32 v9, 0x8000, v9
v_subrev_u32 v10, 0x8000, v10
v_mfma_f32_16x16x32_bf16 v[92:95], a[112:115], a[0:3], v[92:95]
v_subrev_u32 v11, 0x8000, v11
v_mfma_f32_16x16x32_bf16 v[32:35], a[72:75], a[0:3], v[32:35]
v_mfma_f32_16x16x32_bf16 v[32:35], a[76:79], a[4:7], v[32:35]
v_mfma_f32_16x16x32_bf16 v[48:51], a[76:79], a[12:15], v[48:51]
s_waitcnt lgkmcnt(0)
s_barrier
v_mfma_f32_16x16x32_bf16 v[48:51], a[72:75], a[8:11], v[48:51]
s_xor_b32 m0, s84, 32768
buffer_load_dword v1, off, s[52:55], s70 sc1
v_mfma_f32_16x16x32_bf16 v[64:67], a[72:75], a[16:19], v[64:67]
s_xor_b32 s64, s72, 1920
ds_read_b64_tr_b16 a[104:105], v19 offset:4096
v_mfma_f32_16x16x32_bf16 v[64:67], a[76:79], a[20:23], v[64:67]
buffer_load_dwordx4 v12, s[48:51], s64 offen lds
v_mfma_f32_16x16x32_bf16 v[80:83], a[76:79], a[28:31], v[80:83]
ds_read_b64_tr_b16 a[106:107], v19 offset:4352
v_mfma_f32_16x16x32_bf16 v[80:83], a[72:75], a[24:27], v[80:83]
ds_read_b64_tr_b16 a[108:109], v19 offset:6144
v_mfma_f32_16x16x32_bf16 v[144:147], a[80:83], a[24:27], v[144:147]
ds_read_b64_tr_b16 a[110:111], v19 offset:6400
v_mfma_f32_16x16x32_bf16 v[144:147], a[84:87], a[28:31], v[144:147]
s_xor_b32 m0, s84, 33792
ds_read_b64_tr_b16 a[112:113], v20 offset:4096
v_mfma_f32_16x16x32_bf16 v[128:131], a[84:87], a[20:23], v[128:131]
s_xor_b32 s64, s72, 18304
ds_read_b64_tr_b16 a[114:115], v20 offset:4352
v_mfma_f32_16x16x32_bf16 v[128:131], a[80:83], a[16:19], v[128:131]
buffer_load_dwordx4 v13, s[48:51], s64 offen lds
v_mfma_f32_16x16x32_bf16 v[112:115], a[80:83], a[8:11], v[112:115]
ds_read_b64_tr_b16 a[116:117], v20 offset:6144
v_mfma_f32_16x16x32_bf16 v[112:115], a[84:87], a[12:15], v[112:115]
ds_read_b64_tr_b16 a[118:119], v20 offset:6400
v_mfma_f32_16x16x32_bf16 v[96:99], a[84:87], a[4:7], v[96:99]
ds_read_b64_tr_b16 a[72:73], v19 offset:8192
v_mfma_f32_16x16x32_bf16 v[96:99], a[80:83], a[0:3], v[96:99]
s_xor_b32 m0, s84, 34816
ds_read_b64_tr_b16 a[74:75], v19 offset:8448
v_mfma_f32_16x16x32_bf16 v[36:39], a[88:91], a[0:3], v[36:39]
s_xor_b32 s64, s72, 132992
ds_read_b64_tr_b16 a[76:77], v19 offset:10240
v_mfma_f32_16x16x32_bf16 v[36:39], a[92:95], a[4:7], v[36:39]
buffer_load_dwordx4 v12, s[48:51], s64 offen lds
v_mfma_f32_16x16x32_bf16 v[52:55], a[92:95], a[12:15], v[52:55]
ds_read_b64_tr_b16 a[78:79], v19 offset:10496
v_mfma_f32_16x16x32_bf16 v[52:55], a[88:91], a[8:11], v[52:55]
ds_read_b64_tr_b16 a[80:81], v20 offset:8192
v_mfma_f32_16x16x32_bf16 v[68:71], a[88:91], a[16:19], v[68:71]
ds_read_b64_tr_b16 a[82:83], v20 offset:8448
v_mfma_f32_16x16x32_bf16 v[68:71], a[92:95], a[20:23], v[68:71]
s_xor_b32 m0, s84, 35840
ds_read_b64_tr_b16 a[84:85], v20 offset:10240
v_mfma_f32_16x16x32_bf16 v[84:87], a[92:95], a[28:31], v[84:87]
s_xor_b32 s64, s72, 149376
ds_read_b64_tr_b16 a[86:87], v20 offset:10496
v_mfma_f32_16x16x32_bf16 v[84:87], a[88:91], a[24:27], v[84:87]
buffer_load_dwordx4 v13, s[48:51], s64 offen lds
v_mfma_f32_16x16x32_bf16 v[148:151], a[96:99], a[24:27], v[148:151]
ds_read_b64_tr_b16 a[88:89], v19 offset:0
v_mfma_f32_16x16x32_bf16 v[148:151], a[100:103], a[28:31], v[148:151]
ds_read_b64_tr_b16 a[90:91], v19 offset:256
v_mfma_f32_16x16x32_bf16 v[132:135], a[100:103], a[20:23], v[132:135]
ds_read_b64_tr_b16 a[92:93], v19 offset:2048
v_mfma_f32_16x16x32_bf16 v[132:135], a[96:99], a[16:19], v[132:135]
s_xor_b32 m0, s84, 36864
ds_read_b64_tr_b16 a[94:95], v19 offset:2304
v_mfma_f32_16x16x32_bf16 v[116:119], a[96:99], a[8:11], v[116:119]
s_xor_b32 s64, s73, 1920
v_mfma_f32_16x16x32_bf16 v[116:119], a[100:103], a[12:15], v[116:119]
buffer_load_dwordx4 v12, s[48:51], s64 offen lds
v_mfma_f32_16x16x32_bf16 v[100:103], a[100:103], a[4:7], v[100:103]
v_mfma_f32_16x16x32_bf16 v[100:103], a[96:99], a[0:3], v[100:103]
s_waitcnt lgkmcnt(5)
ds_read_b64_tr_b16 a[96:97], v20 offset:0
v_mfma_f32_16x16x32_bf16 v[184:187], a[104:107], a[32:35], v[184:187]
s_xor_b32 m0, s84, 37888
ds_read_b64_tr_b16 a[98:99], v20 offset:256
v_and_b32 v22, 15, v0
v_mfma_f32_16x16x32_bf16 v[184:187], a[108:111], a[36:39], v[184:187]
s_xor_b32 s64, s73, 18304
ds_read_b64_tr_b16 a[100:101], v20 offset:2048
v_lshlrev_b32 v22, 3, v22
v_mfma_f32_16x16x32_bf16 v[192:195], a[108:111], a[44:47], v[192:195]
s_lshl_b32 s85, s30, 7
s_add_u32 s85, s85, 58720256
ds_read_b64_tr_b16 a[102:103], v20 offset:2304
v_mfma_f32_16x16x32_bf16 v[192:195], a[104:107], a[40:43], v[192:195]
s_lshl_b32 s86, s3, 10
s_add_u32 s86, s86, s85
s_lshl_b32 s87, s16, 10
s_lshl_b32 s68, s31, 20
s_add_u32 s32, s28, s68
s_addc_u32 s33, s29, 0
v_mfma_f32_16x16x32_bf16 v[200:203], a[104:107], a[48:51], v[200:203]
s_add_u32 s87, s87, s85
buffer_load_dwordx4 v13, s[48:51], s64 offen lds
v_mfma_f32_16x16x32_bf16 v[200:203], a[108:111], a[52:55], v[200:203]
s_add_u32 s68, s16, 1
s_lshl_b32 s34, s68, 16
v_mfma_f32_16x16x32_bf16 v[208:211], a[108:111], a[60:63], v[208:211]
v_mfma_f32_16x16x32_bf16 v[208:211], a[104:107], a[56:59], v[208:211]
ds_read_b64_tr_b16 a[104:105], v4 offset:0
v_mfma_f32_16x16x32_bf16 v[212:215], a[112:115], a[56:59], v[212:215]
s_xor_b32 m0, s84, 38912
ds_read_b64_tr_b16 a[106:107], v4 offset:1024
v_mfma_f32_16x16x32_bf16 v[212:215], a[116:119], a[60:63], v[212:215]
s_xor_b32 s64, s73, 132992
ds_read_b64_tr_b16 a[108:109], v4 offset:8192
v_mfma_f32_16x16x32_bf16 v[204:207], a[116:119], a[52:55], v[204:207]
buffer_load_dwordx4 v12, s[48:51], s64 offen lds
v_mfma_f32_16x16x32_bf16 v[204:207], a[112:115], a[48:51], v[204:207]
ds_read_b64_tr_b16 a[110:111], v4 offset:9216
v_mfma_f32_16x16x32_bf16 v[196:199], a[112:115], a[40:43], v[196:199]
v_mfma_f32_16x16x32_bf16 v[196:199], a[116:119], a[44:47], v[196:199]
v_mfma_f32_16x16x32_bf16 v[188:191], a[116:119], a[36:39], v[188:191]
s_xor_b32 m0, s84, 39936
v_mfma_f32_16x16x32_bf16 v[188:191], a[112:115], a[32:35], v[188:191]
s_xor_b32 s64, s73, 149376
ds_read_b64_tr_b16 a[112:113], v5 offset:0
v_mfma_f32_16x16x32_bf16 v[216:219], a[32:35], a[72:75], v[216:219]
buffer_load_dwordx4 v13, s[48:51], s64 offen lds
v_mfma_f32_16x16x32_bf16 v[216:219], a[36:39], a[76:79], v[216:219]
ds_read_b64_tr_b16 a[114:115], v5 offset:1024
v_mfma_f32_16x16x32_bf16 v[224:227], a[44:47], a[76:79], v[224:227]
ds_read_b64_tr_b16 a[116:117], v5 offset:8192
v_mfma_f32_16x16x32_bf16 v[224:227], a[40:43], a[72:75], v[224:227]
ds_read_b64_tr_b16 a[118:119], v5 offset:9216
v_mfma_f32_16x16x32_bf16 v[232:235], a[48:51], a[72:75], v[232:235]
s_xor_b32 m0, s77, 131072
v_mfma_f32_16x16x32_bf16 v[232:235], a[52:55], a[76:79], v[232:235]
s_xor_b32 s64, s71, 7864320
v_mfma_f32_16x16x32_bf16 v[240:243], a[60:63], a[76:79], v[240:243]
buffer_load_dwordx4 v14, s[56:59], s64 offen lds
v_mfma_f32_16x16x32_bf16 v[240:243], a[56:59], a[72:75], v[240:243]
ds_read_b64_tr_b16 a[72:73], v6 offset:0
v_mfma_f32_16x16x32_bf16 v[244:247], a[56:59], a[80:83], v[244:247]
s_waitcnt lgkmcnt(5)
ds_read_b64_tr_b16 a[74:75], v6 offset:1024
v_mfma_f32_16x16x32_bf16 v[244:247], a[60:63], a[84:87], v[244:247]
ds_read_b64_tr_b16 a[76:77], v6 offset:8192
v_add_u32 v19, 0x8000, v19
v_mfma_f32_16x16x32_bf16 v[236:239], a[52:55], a[84:87], v[236:239]
s_add_u32 m0, s78, 147456
ds_read_b64_tr_b16 a[78:79], v6 offset:9216
v_mfma_f32_16x16x32_bf16 v[236:239], a[48:51], a[80:83], v[236:239]
s_add_u32 s64, s75, 5898240
v_mfma_f32_16x16x32_bf16 v[228:231], a[40:43], a[80:83], v[228:231]
buffer_load_dwordx4 v23, s[60:63], s64 offen lds
v_mfma_f32_16x16x32_bf16 v[228:231], a[44:47], a[84:87], v[228:231]
v_mfma_f32_16x16x32_bf16 v[220:223], a[36:39], a[84:87], v[220:223]
v_mfma_f32_16x16x32_bf16 v[220:223], a[32:35], a[80:83], v[220:223]
ds_read_b64_tr_b16 a[80:81], v7 offset:0
v_mfma_f32_16x16x32_bf16 v[152:155], a[88:91], a[32:35], v[152:155]
ds_read_b64_tr_b16 a[82:83], v7 offset:1024
v_mfma_f32_16x16x32_bf16 v[152:155], a[92:95], a[36:39], v[152:155]
s_xor_b32 m0, s77, 132096
ds_read_b64_tr_b16 a[84:85], v7 offset:8192
v_add_u32 v20, 0x8000, v20
v_mfma_f32_16x16x32_bf16 v[160:163], a[92:95], a[44:47], v[160:163]
s_xor_b32 s64, s71, 7897088
ds_read_b64_tr_b16 a[86:87], v7 offset:9216
v_mfma_f32_16x16x32_bf16 v[160:163], a[88:91], a[40:43], v[160:163]
buffer_load_dwordx4 v14, s[56:59], s64 offen lds
v_mfma_f32_16x16x32_bf16 v[168:171], a[88:91], a[48:51], v[168:171]
v_mfma_f32_16x16x32_bf16 v[168:171], a[92:95], a[52:55], v[168:171]
v_mfma_f32_16x16x32_bf16 v[176:179], a[92:95], a[60:63], v[176:179]
v_mfma_f32_16x16x32_bf16 v[176:179], a[88:91], a[56:59], v[176:179]
s_add_u32 m0, s78, 151552
ds_read_b64_tr_b16 a[88:89], v8 offset:0
v_mfma_f32_16x16x32_bf16 v[180:183], a[96:99], a[56:59], v[180:183]
s_add_u32 s64, s75, 5900288
ds_read_b64_tr_b16 a[90:91], v8 offset:1024
v_mfma_f32_16x16x32_bf16 v[180:183], a[100:103], a[60:63], v[180:183]
buffer_load_dwordx4 v23, s[60:63], s64 offen lds
v_mfma_f32_16x16x32_bf16 v[172:175], a[100:103], a[52:55], v[172:175]
ds_read_b64_tr_b16 a[92:93], v8 offset:8192
v_add_u32 v4, 0x8000, v4
v_mfma_f32_16x16x32_bf16 v[172:175], a[96:99], a[48:51], v[172:175]
ds_read_b64_tr_b16 a[94:95], v8 offset:9216
v_mfma_f32_16x16x32_bf16 v[164:167], a[96:99], a[40:43], v[164:167]
v_mfma_f32_16x16x32_bf16 v[164:167], a[100:103], a[44:47], v[164:167]
s_xor_b32 m0, s77, 133120
v_mfma_f32_16x16x32_bf16 v[156:159], a[100:103], a[36:39], v[156:159]
s_xor_b32 s64, s71, 7929856
v_mfma_f32_16x16x32_bf16 v[156:159], a[96:99], a[32:35], v[156:159]
buffer_load_dwordx4 v15, s[56:59], s64 offen lds
v_mfma_f32_16x16x32_bf16 v[24:27], a[104:107], a[32:35], v[24:27]
ds_read_b64_tr_b16 a[96:97], v9 offset:0
v_mfma_f32_16x16x32_bf16 v[24:27], a[108:111], a[36:39], v[24:27]
ds_read_b64_tr_b16 a[98:99], v9 offset:1024
v_add_u32 v5, 0x8000, v5
v_mfma_f32_16x16x32_bf16 v[40:43], a[108:111], a[44:47], v[40:43]
ds_read_b64_tr_b16 a[100:101], v9 offset:8192
v_mfma_f32_16x16x32_bf16 v[40:43], a[104:107], a[40:43], v[40:43]
s_add_u32 m0, s78, 155648
ds_read_b64_tr_b16 a[102:103], v9 offset:9216
v_mfma_f32_16x16x32_bf16 v[56:59], a[104:107], a[48:51], v[56:59]
s_add_u32 s64, s75, 5902336
v_mfma_f32_16x16x32_bf16 v[56:59], a[108:111], a[52:55], v[56:59]
buffer_load_dwordx4 v23, s[60:63], s64 offen lds
v_mfma_f32_16x16x32_bf16 v[72:75], a[108:111], a[60:63], v[72:75]
s_waitcnt vmcnt(15)
ds_read_b128 a[0:3], v2 offset:0
v_mfma_f32_16x16x32_bf16 v[72:75], a[104:107], a[56:59], v[72:75]
s_waitcnt lgkmcnt(5)
ds_read_b128 a[4:7], v3 offset:0
v_mfma_f32_16x16x32_bf16 v[136:139], a[112:115], a[56:59], v[136:139]
ds_read_b128 a[8:11], v2 offset:2048
v_mfma_f32_16x16x32_bf16 v[136:139], a[116:119], a[60:63], v[136:139]
s_xor_b32 m0, s77, 134144
ds_read_b128 a[12:15], v3 offset:2048
v_add_u32 v6, 0x8000, v6
v_mfma_f32_16x16x32_bf16 v[120:123], a[116:119], a[52:55], v[120:123]
s_xor_b32 s64, s71, 7962624
ds_read_b128 a[16:19], v2 offset:4096
v_mfma_f32_16x16x32_bf16 v[120:123], a[112:115], a[48:51], v[120:123]
buffer_load_dwordx4 v15, s[56:59], s64 offen lds
v_mfma_f32_16x16x32_bf16 v[104:107], a[112:115], a[40:43], v[104:107]
ds_read_b128 a[20:23], v3 offset:4096
v_mfma_f32_16x16x32_bf16 v[104:107], a[116:119], a[44:47], v[104:107]
ds_read_b128 a[24:27], v2 offset:6144
v_mfma_f32_16x16x32_bf16 v[88:91], a[116:119], a[36:39], v[88:91]
ds_read_b128 a[28:31], v3 offset:6144
v_mfma_f32_16x16x32_bf16 v[88:91], a[112:115], a[32:35], v[88:91]
ds_read_b64_tr_b16 a[104:105], v10 offset:0
v_mfma_f32_16x16x32_bf16 v[28:31], a[72:75], a[32:35], v[28:31]
ds_read_b64_tr_b16 a[106:107], v10 offset:1024
v_mfma_f32_16x16x32_bf16 v[28:31], a[76:79], a[36:39], v[28:31]
ds_read_b64_tr_b16 a[108:109], v10 offset:8192
v_add_u32 v7, 0x8000, v7
v_mfma_f32_16x16x32_bf16 v[44:47], a[76:79], a[44:47], v[44:47]
ds_read_b64_tr_b16 a[110:111], v10 offset:9216
v_mfma_f32_16x16x32_bf16 v[44:47], a[72:75], a[40:43], v[44:47]
ds_read_b64_tr_b16 a[112:113], v11 offset:0
v_mfma_f32_16x16x32_bf16 v[60:63], a[72:75], a[48:51], v[60:63]
ds_read_b64_tr_b16 a[114:115], v11 offset:1024
v_mfma_f32_16x16x32_bf16 v[60:63], a[76:79], a[52:55], v[60:63]
ds_read_b64_tr_b16 a[116:117], v11 offset:8192
v_mfma_f32_16x16x32_bf16 v[76:79], a[76:79], a[60:63], v[76:79]
ds_read_b64_tr_b16 a[118:119], v11 offset:9216
v_mfma_f32_16x16x32_bf16 v[76:79], a[72:75], a[56:59], v[76:79]
v_mfma_f32_16x16x32_bf16 v[140:143], a[80:83], a[56:59], v[140:143]
v_mfma_f32_16x16x32_bf16 v[140:143], a[84:87], a[60:63], v[140:143]
v_add_u32 v8, 0x8000, v8
v_mfma_f32_16x16x32_bf16 v[124:127], a[84:87], a[52:55], v[124:127]
v_lshrrev_b32 v23, 2, v0
v_mul_u32_u24 v23, 3584, v23
v_mfma_f32_16x16x32_bf16 v[124:127], a[80:83], a[48:51], v[124:127]
v_lshl_add_u32 v23, v0, 7, v23
v_mfma_f32_16x16x32_bf16 v[108:111], a[80:83], a[40:43], v[108:111]
v_mfma_f32_16x16x32_bf16 v[108:111], a[84:87], a[44:47], v[108:111]
v_mfma_f32_16x16x32_bf16 v[92:95], a[84:87], a[36:39], v[92:95]
v_add_u32 v9, 0x8000, v9
v_add_u32 v10, 0x8000, v10
v_mfma_f32_16x16x32_bf16 v[92:95], a[80:83], a[32:35], v[92:95]
v_add_u32 v11, 0x8000, v11
v_mfma_f32_16x16x32_bf16 v[32:35], a[88:91], a[32:35], v[32:35]
s_waitcnt vmcnt(15)
v_readfirstlane_b32 vcc_lo, v1
s_nop 0
s_cmp_lt_u32 vcc_lo, s81
s_cbranch_scc1 L_spin_4
L_spinbk_5:
v_mfma_f32_16x16x32_bf16 v[32:35], a[92:95], a[36:39], v[32:35]
buffer_load_dwordx2 a[64:65], v22, s[44:47], s86 offen offset:0 sc1
v_mfma_f32_16x16x32_bf16 v[48:51], a[92:95], a[44:47], v[48:51]
s_waitcnt lgkmcnt(0)
s_barrier
v_mfma_f32_16x16x32_bf16 v[48:51], a[88:91], a[40:43], v[48:51]
ds_read_b64_tr_b16 a[72:73], v19 offset:4096
v_cmp_gt_i32 s[0:1], 0, v18
v_mfma_f32_16x16x32_bf16 v[64:67], a[88:91], a[48:51], v[64:67]
s_lshl2_add_u32 s72, s2, s30
ds_read_b64_tr_b16 a[74:75], v19 offset:4352
v_cmp_gt_i32 s[4:5], 1, v18
v_mfma_f32_16x16x32_bf16 v[64:67], a[92:95], a[52:55], v[64:67]
s_lshl_b32 s72, s72, 12
s_mov_b32 m0, s76
ds_read_b64_tr_b16 a[76:77], v19 offset:6144
v_cmp_gt_i32 s[6:7], 2, v18
v_mfma_f32_16x16x32_bf16 v[80:83], a[92:95], a[60:63], v[80:83]
s_add_u32 s72, s72, 67108864
s_lshl_b32 s64, s30, 14
ds_read_b64_tr_b16 a[78:79], v19 offset:6400
v_cmp_gt_i32 s[8:9], 3, v18
v_mfma_f32_16x16x32_bf16 v[80:83], a[88:91], a[56:59], v[80:83]
s_lshr_b32 s17, s78, 1
buffer_load_dwordx4 v16, s[32:35], s64 offen offset:0 sc1 lds
v_mfma_f32_16x16x32_bf16 v[144:147], a[96:99], a[56:59], v[144:147]
s_add_u32 s17, s17, L_base-L_pc-4+53248
buffer_load_dwordx2 a[66:67], v22, s[44:47], s86 offen offset:512 sc1
v_mfma_f32_16x16x32_bf16 v[144:147], a[100:103], a[60:63], v[144:147]
buffer_load_dword a252, v23, s[88:91], s17 offen
v_mfma_f32_16x16x32_bf16 v[128:131], a[100:103], a[52:55], v[128:131]
buffer_load_dwordx2 a[68:69], v22, s[44:47], s87 offen offset:0 sc1
v_mfma_f32_16x16x32_bf16 v[128:131], a[96:99], a[48:51], v[128:131]
buffer_load_dwordx2 a[70:71], v22, s[44:47], s87 offen offset:512 sc1
v_mfma_f32_16x16x32_bf16 v[112:115], a[96:99], a[40:43], v[112:115]
ds_read_b64_tr_b16 a[80:81], v20 offset:4096
v_cmp_gt_i32 s[10:11], 16, v18
v_mfma_f32_16x16x32_bf16 v[112:115], a[100:103], a[44:47], v[112:115]
ds_read_b64_tr_b16 a[82:83], v20 offset:4352
v_cmp_gt_i32 s[12:13], 17, v18
v_mfma_f32_16x16x32_bf16 v[96:99], a[100:103], a[36:39], v[96:99]
ds_read_b64_tr_b16 a[84:85], v20 offset:6144
v_cmp_gt_i32 s[18:19], 18, v18
v_mfma_f32_16x16x32_bf16 v[96:99], a[96:99], a[32:35], v[96:99]
buffer_load_dwordx4 v16, s[32:35], s64 offen offset:1024 sc1 lds
v_mfma_f32_16x16x32_bf16 v[36:39], a[104:107], a[32:35], v[36:39]
buffer_store_dwordx4 a[240:243], v16, s[44:47], s72 offen offset:0 sc1
v_mfma_f32_16x16x32_bf16 v[36:39], a[108:111], a[36:39], v[36:39]
ds_read_b64_tr_b16 a[86:87], v20 offset:6400
v_cmp_gt_i32 s[22:23], 19, v18
v_mfma_f32_16x16x32_bf16 v[52:55], a[108:111], a[44:47], v[52:55]
ds_read_b64_tr_b16 a[88:89], v19 offset:8192
v_cmp_gt_i32 s[26:27], 32, v18
v_mfma_f32_16x16x32_bf16 v[52:55], a[104:107], a[40:43], v[52:55]
ds_read_b64_tr_b16 a[90:91], v19 offset:8448
v_cmp_gt_i32 s[56:57], 33, v18
v_mfma_f32_16x16x32_bf16 v[68:71], a[104:107], a[48:51], v[68:71]
ds_read_b64_tr_b16 a[92:93], v19 offset:10240
v_cmp_gt_i32 s[58:59], 34, v18
v_mfma_f32_16x16x32_bf16 v[68:71], a[108:111], a[52:55], v[68:71]
ds_read_b64_tr_b16 a[94:95], v19 offset:10496
v_cmp_gt_i32 s[60:61], 35, v18
v_mfma_f32_16x16x32_bf16 v[84:87], a[108:111], a[60:63], v[84:87]
ds_read_b64_tr_b16 a[96:97], v20 offset:8192
v_cmp_gt_i32 s[62:63], 48, v18
v_mfma_f32_16x16x32_bf16 v[84:87], a[104:107], a[56:59], v[84:87]
buffer_load_dwordx4 v16, s[32:35], s64 offen offset:2048 sc1 lds
v_mfma_f32_16x16x32_bf16 v[148:151], a[112:115], a[56:59], v[148:151]
ds_read_b64_tr_b16 a[98:99], v20 offset:8448
v_cmp_gt_i32 s[48:49], 49, v18
v_mfma_f32_16x16x32_bf16 v[148:151], a[116:119], a[60:63], v[148:151]
ds_read_b64_tr_b16 a[100:101], v20 offset:10240
v_cmp_gt_i32 s[50:51], 50, v18
v_mfma_f32_16x16x32_bf16 v[132:135], a[116:119], a[52:55], v[132:135]
ds_read_b64_tr_b16 a[102:103], v20 offset:10496
v_cmp_gt_i32 s[100:101], 51, v18
v_mfma_f32_16x16x32_bf16 v[132:135], a[112:115], a[48:51], v[132:135]
ds_read_b64_tr_b16 a[104:105], v19 offset:0
v_mfma_f32_16x16x32_bf16 v[116:119], a[112:115], a[40:43], v[116:119]
ds_read_b64_tr_b16 a[106:107], v19 offset:256
v_mfma_f32_16x16x32_bf16 v[116:119], a[116:119], a[44:47], v[116:119]
ds_read_b64_tr_b16 a[108:109], v19 offset:2048
v_mfma_f32_16x16x32_bf16 v[100:103], a[116:119], a[36:39], v[100:103]
buffer_store_dwordx4 a[240:243], v16, s[44:47], s72 offen offset:1024 sc1
v_mfma_f32_16x16x32_bf16 v[100:103], a[112:115], a[32:35], v[100:103]
s_waitcnt lgkmcnt(7)
buffer_load_dwordx4 v16, s[32:35], s64 offen offset:3072 sc1 lds
v_mfma_f32_16x16x32_bf16 v[184:187], a[72:75], a[0:3], v[184:187]
s_waitcnt vmcnt(18)
s_and_b32 s66, s2, 7
ds_read_b128 a[32:35], v2 offset:32768
v_mfma_f32_16x16x32_bf16 v[184:187], a[76:79], a[4:7], v[184:187]
s_lshr_b32 s67, s2, 3
s_and_b32 s83, s66, 1
ds_read_b128 a[36:39], v3 offset:32768
v_mfma_f32_16x16x32_bf16 v[192:195], a[76:79], a[12:15], v[192:195]
s_and_b32 s68, s66, 2
s_and_b32 s69, s67, 7
ds_read_b128 a[40:43], v2 offset:34816
v_mfma_f32_16x16x32_bf16 v[192:195], a[72:75], a[8:11], v[192:195]
s_lshl2_add_u32 s82, s68, s69
s_and_b32 s68, s66, 4
ds_read_b128 a[44:47], v3 offset:34816
v_mfma_f32_16x16x32_bf16 v[200:203], a[72:75], a[16:19], v[200:203]
s_lshr_b32 s69, s67, 3
s_xor_b32 s69, s69, 0
ds_read_b128 a[48:51], v2 offset:36864
v_mfma_f32_16x16x32_bf16 v[200:203], a[76:79], a[20:23], v[200:203]
s_add_u32 s87, s68, s69
s_lshl_b32 s87, s87, 8
s_add_u32 m0, s76, 4096
ds_read_b128 a[52:55], v3 offset:36864
v_mfma_f32_16x16x32_bf16 v[208:211], a[76:79], a[28:31], v[208:211]
s_lshl_b32 s86, s30, 13
s_lshl_b32 s85, s30, 16
s_add_u32 s64, s64, 4096
ds_read_b128 a[56:59], v2 offset:38912
v_mfma_f32_16x16x32_bf16 v[208:211], a[72:75], a[24:27], v[208:211]
s_add_u32 s85, s85, s87
buffer_load_dwordx4 v16, s[32:35], s64 offen offset:0 sc1 lds
v_mfma_f32_16x16x32_bf16 v[212:215], a[80:83], a[24:27], v[212:215]
s_mul_i32 s66, s83, 1310720
s_add_u32 s85, s85, s66
ds_read_b128 a[60:63], v3 offset:38912
v_mfma_f32_16x16x32_bf16 v[212:215], a[84:87], a[28:31], v[212:215]
s_mul_i32 s84, s82, 1310720
s_and_b32 s66, s30, 1
ds_read_b64_tr_b16 a[110:111], v19 offset:2304
v_mfma_f32_16x16x32_bf16 v[204:207], a[84:87], a[20:23], v[204:207]
s_lshl_b32 s66, s66, 14
s_add_u32 s84, s84, s66
ds_read_b64_tr_b16 a[112:113], v20 offset:0
v_mfma_f32_16x16x32_bf16 v[204:207], a[80:83], a[16:19], v[204:207]
s_mul_i32 s66, s83, 163840
s_add_u32 s84, s84, s66
ds_read_b64_tr_b16 a[114:115], v20 offset:256
v_mfma_f32_16x16x32_bf16 v[196:199], a[80:83], a[8:11], v[196:199]
s_add_u32 s84, s84, 34603008
s_sub_u32 s66, 15, s82
ds_read_b64_tr_b16 a[116:117], v20 offset:2048
v_mfma_f32_16x16x32_bf16 v[196:199], a[84:87], a[12:15], v[196:199]
s_min_u32 s66, s66, s82
s_lshl1_add_u32 s66, s66, s83
ds_read_b64_tr_b16 a[118:119], v20 offset:2304
v_mfma_f32_16x16x32_bf16 v[188:191], a[84:87], a[4:7], v[188:191]
s_lshl_b32 s80, s66, 8
buffer_store_dwordx4 a[240:243], v16, s[44:47], s72 offen offset:2048 sc1
v_mfma_f32_16x16x32_bf16 v[188:191], a[80:83], a[0:3], v[188:191]
s_add_u32 s80, s80, 8192
buffer_load_dwordx4 v16, s[32:35], s64 offen offset:1024 sc1 lds
v_mfma_f32_16x16x32_bf16 v[216:219], a[0:3], a[88:91], v[216:219]
s_and_b32 s67, s30, 1
s_lshl_b32 s67, s67, 7
s_add_u32 s67, s67, s83
v_mfma_f32_16x16x32_bf16 v[216:219], a[4:7], a[92:95], v[216:219]
s_lshl_b32 s67, s67, 7
s_add_u32 s67, s67, 98304
s_lshl_b32 s66, s30, 11
v_mfma_f32_16x16x32_bf16 v[224:227], a[12:15], a[92:95], v[224:227]
s_waitcnt vmcnt(14) lgkmcnt(0)
s_barrier
v_mfma_f32_16x16x32_bf16 v[224:227], a[8:11], a[88:91], v[224:227]
ds_read_b64_tr_b16 a[72:73], v19 offset:36864
v_lshrrev_b32 v14, 4, v0
v_mfma_f32_16x16x32_bf16 v[232:235], a[16:19], a[88:91], v[232:235]
ds_read_b64_tr_b16 a[74:75], v19 offset:37120
v_bfe_u32 v12, v0, 1, 3
v_mfma_f32_16x16x32_bf16 v[232:235], a[20:23], a[92:95], v[232:235]
ds_read_b64_tr_b16 a[76:77], v19 offset:38912
v_xor_b32 v12, v12, v14
v_mfma_f32_16x16x32_bf16 v[240:243], a[28:31], a[92:95], v[240:243]
ds_read_b64_tr_b16 a[78:79], v19 offset:39168
v_lshlrev_b32 v12, 5, v12
v_mfma_f32_16x16x32_bf16 v[240:243], a[24:27], a[88:91], v[240:243]
buffer_load_dwordx4 v16, s[32:35], s64 offen offset:2048 sc1 lds
v_mfma_f32_16x16x32_bf16 v[244:247], a[24:27], a[96:99], v[244:247]
ds_read_b64_tr_b16 a[80:81], v20 offset:36864
v_lshl_add_u32 v12, v14, 11, v12
v_mfma_f32_16x16x32_bf16 v[244:247], a[28:31], a[100:103], v[244:247]
ds_read_b64_tr_b16 a[82:83], v20 offset:37120
v_and_b32 v14, 1, v0
v_mfma_f32_16x16x32_bf16 v[236:239], a[20:23], a[100:103], v[236:239]
buffer_store_dwordx4 a[240:243], v16, s[44:47], s72 offen offset:3072 sc1
v_mfma_f32_16x16x32_bf16 v[236:239], a[16:19], a[96:99], v[236:239]
ds_read_b64_tr_b16 a[84:85], v20 offset:38912
v_lshl_add_u32 v12, v14, 4, v12
v_mfma_f32_16x16x32_bf16 v[228:231], a[8:11], a[96:99], v[228:231]
ds_read_b64_tr_b16 a[86:87], v20 offset:39168
v_xor_b32 v13, 128, v12
v_mfma_f32_16x16x32_bf16 v[228:231], a[12:15], a[100:103], v[228:231]
ds_read_b64_tr_b16 a[88:89], v19 offset:40960
v_lshrrev_b32 v14, 4, v0
v_mfma_f32_16x16x32_bf16 v[220:223], a[4:7], a[100:103], v[220:223]
ds_read_b64_tr_b16 a[90:91], v19 offset:41216
v_bfe_u32 v18, v0, 2, 2
v_mfma_f32_16x16x32_bf16 v[220:223], a[0:3], a[96:99], v[220:223]
buffer_load_dwordx4 v16, s[32:35], s64 offen offset:3072 sc1 lds
v_mfma_f32_16x16x32_bf16 v[152:155], a[104:107], a[0:3], v[152:155]
ds_read_b64_tr_b16 a[92:93], v19 offset:43008
v_lshl_add_u32 v14, v14, 2, v18
v_mfma_f32_16x16x32_bf16 v[152:155], a[108:111], a[4:7], v[152:155]
ds_read_b64_tr_b16 a[94:95], v19 offset:43264
v_and_b32 v18, 3, v0
v_mfma_f32_16x16x32_bf16 v[160:163], a[108:111], a[12:15], v[160:163]
s_branch L_po13
L_pg13:
s_branch L_tr1
L_po13:
s_lshr_b32 s64, s76, 1
ds_read_b64_tr_b16 a[96:97], v20 offset:40960
v_lshlrev_b32 v18, 3, v18
v_mfma_f32_16x16x32_bf16 v[160:163], a[104:107], a[8:11], v[160:163]
s_add_u32 m0, s64, 81920
ds_read_b64_tr_b16 a[98:99], v20 offset:41216
v_lshl_add_u32 v18, v14, 8, v18
v_mfma_f32_16x16x32_bf16 v[168:171], a[104:107], a[16:19], v[168:171]
s_and_b32 s71, s64, 8192
ds_read_b64_tr_b16 a[100:101], v20 offset:43008
v_and_b32 v14, 7, v14
v_mfma_f32_16x16x32_bf16 v[168:171], a[108:111], a[20:23], v[168:171]
s_add_u32 s64, s64, s71
ds_read_b64_tr_b16 a[102:103], v20 offset:43264
v_lshl_add_u32 v18, v14, 5, v18
v_mfma_f32_16x16x32_bf16 v[176:179], a[108:111], a[28:31], v[176:179]
s_add_u32 s64, s64, 8192
v_xor_b32 v18, s67, v18
v_add_u32 v14, s66, v16
v_mfma_f32_16x16x32_bf16 v[176:179], a[104:107], a[24:27], v[176:179]
buffer_load_dwordx4 v16, s[32:35], s64 offen offset:0 sc1 lds
v_mfma_f32_16x16x32_bf16 v[180:183], a[112:115], a[24:27], v[180:183]
s_cmp_eq_u32 s30, 0
s_cbranch_scc1 L_pg14
s_cmp_eq_u32 s30, 1
s_cbranch_scc1 L_pg15
s_cmp_eq_u32 s30, 2
s_cbranch_scc1 L_pg16
s_branch L_pg17
L_tr2:
v_mfma_f32_16x16x32_bf16 v[180:183], a[116:119], a[28:31], v[180:183]
ds_read_b64_tr_b16 a[104:105], v19 offset:32768
v_xor_b32 v15, 0x800, v14
v_mfma_f32_16x16x32_bf16 v[172:175], a[116:119], a[20:23], v[172:175]
s_lshl2_add_u32 s73, s2, s30
s_lshl_b32 s73, s73, 11
s_lshl1_add_u32 s66, s78, 32768
v_mfma_f32_16x16x32_bf16 v[172:175], a[112:115], a[16:19], v[172:175]
ds_read_b64_tr_b16 a[106:107], v19 offset:33024
v_add_u32 v2, s66, v16
v_mfma_f32_16x16x32_bf16 v[164:167], a[112:115], a[8:11], v[164:167]
ds_read_b64_tr_b16 a[108:109], v19 offset:34816
v_bfe_u32 v1, v0, 1, 1
v_mfma_f32_16x16x32_bf16 v[164:167], a[116:119], a[12:15], v[164:167]
ds_read_b64_tr_b16 a[110:111], v19 offset:35072
v_subrev_u32 v1, 1, v1
v_mfma_f32_16x16x32_bf16 v[156:159], a[116:119], a[4:7], v[156:159]
s_or_b32 s66, s3, s30
s_cmp_eq_u32 s66, 0
s_cselect_b32 s66, 0xff800000, 0
v_mfma_f32_16x16x32_bf16 v[156:159], a[112:115], a[0:3], v[156:159]
s_waitcnt lgkmcnt(4)
buffer_load_dwordx4 v16, s[32:35], s64 offen offset:1024 sc1 lds
v_mfma_f32_16x16x32_bf16 v[184:187], a[72:75], a[32:35], v[184:187]
ds_read_b64_tr_b16 a[112:113], v20 offset:32768
v_and_b32 v1, 0x3f803f80, v1
v_mfma_f32_16x16x32_bf16 v[184:187], a[76:79], a[36:39], v[184:187]
ds_read_b64_tr_b16 a[114:115], v20 offset:33024
v_accvgpr_write_b32 a240, v1
v_mfma_f32_16x16x32_bf16 v[192:195], a[76:79], a[44:47], v[192:195]
ds_read_b64_tr_b16 a[116:117], v20 offset:34816
v_accvgpr_write_b32 a241, v1
v_mfma_f32_16x16x32_bf16 v[192:195], a[72:75], a[40:43], v[192:195]
ds_read_b64_tr_b16 a[118:119], v20 offset:35072
v_accvgpr_write_b32 a242, v1
v_mfma_f32_16x16x32_bf16 v[200:203], a[72:75], a[48:51], v[200:203]
s_and_b32 s67, s74, 0x7800
s_cselect_b32 s67, 0, 0x70000000
s_add_u32 s77, s74, s67
v_mfma_f32_16x16x32_bf16 v[200:203], a[76:79], a[52:55], v[200:203]
s_sub_u32 s77, s77, 2048
v_accvgpr_write_b32 a243, v1
v_mfma_f32_16x16x32_bf16 v[208:211], a[76:79], a[60:63], v[208:211]
s_mov_b32 s68, 0x3e0293ee
v_mfma_f32_16x16x32_bf16 v[208:211], a[72:75], a[56:59], v[208:211]
s_mov_b32 s69, s68
buffer_load_dwordx4 v16, s[32:35], s64 offen offset:2048 sc1 lds
v_mfma_f32_16x16x32_bf16 v[212:215], a[80:83], a[56:59], v[212:215]
ds_read_b64_tr_b16 a[72:73], v4 offset:0
v_mfma_f32_16x16x32_bf16 v[212:215], a[84:87], a[60:63], v[212:215]
ds_read_b64_tr_b16 a[74:75], v4 offset:1024
v_mfma_f32_16x16x32_bf16 v[204:207], a[84:87], a[52:55], v[204:207]
ds_read_b64_tr_b16 a[76:77], v4 offset:8192
v_mfma_f32_16x16x32_bf16 v[204:207], a[80:83], a[48:51], v[204:207]
ds_read_b64_tr_b16 a[78:79], v4 offset:9216
v_mfma_f32_16x16x32_bf16 v[196:199], a[80:83], a[40:43], v[196:199]
v_mfma_f32_16x16x32_bf16 v[196:199], a[84:87], a[44:47], v[196:199]
v_mfma_f32_16x16x32_bf16 v[188:191], a[84:87], a[36:39], v[188:191]
v_mfma_f32_16x16x32_bf16 v[188:191], a[80:83], a[32:35], v[188:191]
buffer_load_dwordx4 v16, s[32:35], s64 offen offset:3072 sc1 lds
v_mfma_f32_16x16x32_bf16 v[216:219], a[32:35], a[88:91], v[216:219]
ds_read_b64_tr_b16 a[80:81], v4 offset:32768
v_mfma_f32_16x16x32_bf16 v[216:219], a[36:39], a[92:95], v[216:219]
ds_read_b64_tr_b16 a[82:83], v4 offset:33792
v_cvt_pk_bf16_f32 v208, v208, v209
v_mfma_f32_16x16x32_bf16 v[224:227], a[44:47], a[92:95], v[224:227]
ds_read_b64_tr_b16 a[84:85], v4 offset:40960
v_cvt_pk_bf16_f32 v209, v210, v211
v_mfma_f32_16x16x32_bf16 v[224:227], a[40:43], a[88:91], v[224:227]
ds_read_b64_tr_b16 a[86:87], v4 offset:41984
v_cvt_pk_bf16_f32 v210, v212, v213
v_mfma_f32_16x16x32_bf16 v[232:235], a[48:51], a[88:91], v[232:235]
v_cvt_pk_bf16_f32 v211, v214, v215
v_mfma_f32_16x16x32_bf16 v[232:235], a[52:55], a[92:95], v[232:235]
ds_write_b128 v2, v[208:211] offset:30720
v_mfma_f32_16x16x32_bf16 v[240:243], a[60:63], a[92:95], v[240:243]
v_cvt_pk_bf16_f32 v200, v200, v201
v_cvt_pk_bf16_f32 v201, v202, v203
v_mfma_f32_16x16x32_bf16 v[240:243], a[56:59], a[88:91], v[240:243]
ds_read_b64_tr_b16 a[88:89], v5 offset:0
v_cvt_pk_bf16_f32 v202, v204, v205
v_mfma_f32_16x16x32_bf16 v[244:247], a[56:59], a[96:99], v[244:247]
ds_read_b64_tr_b16 a[90:91], v5 offset:1024
v_cvt_pk_bf16_f32 v203, v206, v207
v_mfma_f32_16x16x32_bf16 v[244:247], a[60:63], a[100:103], v[244:247]
ds_write_b128 v2, v[200:203] offset:22528
v_mfma_f32_16x16x32_bf16 v[236:239], a[52:55], a[100:103], v[236:239]
ds_read_b64_tr_b16 a[92:93], v5 offset:8192
v_cvt_pk_bf16_f32 v192, v192, v193
v_mfma_f32_16x16x32_bf16 v[236:239], a[48:51], a[96:99], v[236:239]
ds_read_b64_tr_b16 a[94:95], v5 offset:9216
v_cvt_pk_bf16_f32 v193, v194, v195
v_mfma_f32_16x16x32_bf16 v[228:231], a[40:43], a[96:99], v[228:231]
v_cvt_pk_bf16_f32 v194, v196, v197
v_cvt_pk_bf16_f32 v195, v198, v199
v_mfma_f32_16x16x32_bf16 v[228:231], a[44:47], a[100:103], v[228:231]
ds_write_b128 v2, v[192:195] offset:10240
v_mfma_f32_16x16x32_bf16 v[220:223], a[36:39], a[100:103], v[220:223]
v_cvt_pk_bf16_f32 v184, v184, v185
v_cvt_pk_bf16_f32 v185, v186, v187
v_mfma_f32_16x16x32_bf16 v[220:223], a[32:35], a[96:99], v[220:223]
s_waitcnt lgkmcnt(6)
ds_read_b64_tr_b16 a[96:97], v5 offset:32768
v_cvt_pk_bf16_f32 v186, v188, v189
v_mfma_f32_16x16x32_bf16 v[152:155], a[104:107], a[32:35], v[152:155]
ds_read_b64_tr_b16 a[98:99], v5 offset:33792
v_cvt_pk_bf16_f32 v187, v190, v191
v_mfma_f32_16x16x32_bf16 v[152:155], a[108:111], a[36:39], v[152:155]
ds_write_b128 v2, v[184:187] offset:2048
v_mfma_f32_16x16x32_bf16 v[160:163], a[108:111], a[44:47], v[160:163]
buffer_load_dword a252, v21, s[36:39], s73 offen
v_mfma_f32_16x16x32_bf16 v[160:163], a[104:107], a[40:43], v[160:163]
ds_read_b64_tr_b16 a[100:101], v5 offset:40960
v_cvt_pk_bf16_f32 v243, v242, v243
v_mfma_f32_16x16x32_bf16 v[168:171], a[104:107], a[48:51], v[168:171]
ds_read_b64_tr_b16 a[102:103], v5 offset:41984
v_cvt_pk_bf16_f32 v242, v240, v241
v_mfma_f32_16x16x32_bf16 v[168:171], a[108:111], a[52:55], v[168:171]
v_cvt_pk_bf16_f32 v240, v244, v245
v_cvt_pk_bf16_f32 v241, v246, v247
v_mfma_f32_16x16x32_bf16 v[176:179], a[108:111], a[60:63], v[176:179]
ds_write_b128 v2, v[240:243] offset:31744
v_mfma_f32_16x16x32_bf16 v[176:179], a[104:107], a[56:59], v[176:179]
ds_read_b64_tr_b16 a[104:105], v6 offset:0
v_mov_b32 v246, v240
v_mfma_f32_16x16x32_bf16 v[180:183], a[112:115], a[56:59], v[180:183]
ds_read_b64_tr_b16 a[106:107], v6 offset:1024
v_mov_b32 v247, v241
v_mfma_f32_16x16x32_bf16 v[180:183], a[116:119], a[60:63], v[180:183]
ds_read_b64_tr_b16 a[108:109], v6 offset:8192
v_cvt_pk_bf16_f32 v235, v234, v235
v_mfma_f32_16x16x32_bf16 v[172:175], a[116:119], a[52:55], v[172:175]
ds_read_b64_tr_b16 a[110:111], v6 offset:9216
v_cvt_pk_bf16_f32 v234, v232, v233
v_mfma_f32_16x16x32_bf16 v[172:175], a[112:115], a[48:51], v[172:175]
v_cvt_pk_bf16_f32 v232, v236, v237
v_cvt_pk_bf16_f32 v233, v238, v239
v_mfma_f32_16x16x32_bf16 v[164:167], a[112:115], a[40:43], v[164:167]
ds_write_b128 v2, v[232:235] offset:23552
v_mfma_f32_16x16x32_bf16 v[164:167], a[116:119], a[44:47], v[164:167]
v_mov_b32 v238, v232
v_mov_b32 v239, v233
v_mfma_f32_16x16x32_bf16 v[156:159], a[116:119], a[36:39], v[156:159]
v_cvt_pk_bf16_f32 v227, v226, v227
v_cvt_pk_bf16_f32 v226, v224, v225
v_mfma_f32_16x16x32_bf16 v[156:159], a[112:115], a[32:35], v[156:159]
ds_read_b64_tr_b16 a[112:113], v6 offset:32768
v_cvt_pk_bf16_f32 v224, v228, v229
v_mfma_f32_16x16x32_bf16 v[24:27], a[72:75], a[0:3], v[24:27]
ds_read_b64_tr_b16 a[114:115], v6 offset:33792
v_cvt_pk_bf16_f32 v225, v230, v231
v_mfma_f32_16x16x32_bf16 v[24:27], a[76:79], a[4:7], v[24:27]
ds_write_b128 v2, v[224:227] offset:11264
v_mfma_f32_16x16x32_bf16 v[24:27], a[80:83], a[32:35], v[24:27]
ds_read_b64_tr_b16 a[116:117], v6 offset:40960
v_mov_b32 v230, v224
v_mfma_f32_16x16x32_bf16 v[24:27], a[84:87], a[36:39], v[24:27]
ds_read_b64_tr_b16 a[118:119], v6 offset:41984
v_mov_b32 v231, v225
v_mfma_f32_16x16x32_bf16 v[40:43], a[84:87], a[44:47], v[40:43]
v_cvt_pk_bf16_f32 v219, v218, v219
v_cvt_pk_bf16_f32 v218, v216, v217
v_mfma_f32_16x16x32_bf16 v[40:43], a[80:83], a[40:43], v[40:43]
v_cvt_pk_bf16_f32 v216, v220, v221
v_cvt_pk_bf16_f32 v217, v222, v223
v_mfma_f32_16x16x32_bf16 v[40:43], a[76:79], a[12:15], v[40:43]
ds_write_b128 v2, v[216:219] offset:3072
v_mfma_f32_16x16x32_bf16 v[40:43], a[72:75], a[8:11], v[40:43]
v_mov_b32 v222, v216
v_mov_b32 v223, v217
v_mfma_f32_16x16x32_bf16 v[56:59], a[72:75], a[16:19], v[56:59]
v_mfma_f32_16x16x32_bf16 v[56:59], a[76:79], a[20:23], v[56:59]
s_waitcnt lgkmcnt(0)
s_barrier
v_mfma_f32_16x16x32_bf16 v[56:59], a[80:83], a[48:51], v[56:59]
ds_read_b128 a[192:195], v17 offset:16384
v_cvt_pk_bf16_f32 v176, v176, v177
v_mfma_f32_16x16x32_bf16 v[56:59], a[84:87], a[52:55], v[56:59]
v_cvt_pk_bf16_f32 v177, v178, v179
v_cvt_pk_bf16_f32 v178, v180, v181
v_mfma_f32_16x16x32_bf16 v[72:75], a[84:87], a[60:63], v[72:75]
v_cvt_pk_bf16_f32 v179, v182, v183
v_cvt_pk_bf16_f32 v168, v168, v169
v_mfma_f32_16x16x32_bf16 v[72:75], a[80:83], a[56:59], v[72:75]
v_cvt_pk_bf16_f32 v169, v170, v171
v_cvt_pk_bf16_f32 v170, v172, v173
v_mfma_f32_16x16x32_bf16 v[72:75], a[76:79], a[28:31], v[72:75]
v_cvt_pk_bf16_f32 v171, v174, v175
v_cvt_pk_bf16_f32 v160, v160, v161
v_mfma_f32_16x16x32_bf16 v[72:75], a[72:75], a[24:27], v[72:75]
ds_read_b64_tr_b16 a[72:73], v7 offset:0
v_cvt_pk_bf16_f32 v161, v162, v163
v_mfma_f32_16x16x32_bf16 v[136:139], a[88:91], a[24:27], v[136:139]
s_waitcnt lgkmcnt(1)
buffer_store_dwordx4 a[192:195], v16, s[44:47], s74 offen sc1
v_mfma_f32_16x16x32_bf16 v[136:139], a[92:95], a[28:31], v[136:139]
ds_read_b64_tr_b16 a[74:75], v7 offset:1024
v_cvt_pk_bf16_f32 v162, v164, v165
v_mfma_f32_16x16x32_bf16 v[136:139], a[96:99], a[56:59], v[136:139]
ds_read_b64_tr_b16 a[76:77], v7 offset:8192
v_cvt_pk_bf16_f32 v163, v166, v167
v_mfma_f32_16x16x32_bf16 v[136:139], a[100:103], a[60:63], v[136:139]
s_sub_u32 s81, s3, 1
ds_read_b64_tr_b16 a[78:79], v7 offset:9216
v_cvt_pk_bf16_f32 v152, v152, v153
v_mfma_f32_16x16x32_bf16 v[120:123], a[100:103], a[52:55], v[120:123]
s_sub_u32 s67, s3, 2
ds_read_b64_tr_b16 a[80:81], v7 offset:32768
v_cvt_pk_bf16_f32 v153, v154, v155
v_mfma_f32_16x16x32_bf16 v[120:123], a[96:99], a[48:51], v[120:123]
s_mul_i32 s81, s81, s67
ds_read_b64_tr_b16 a[82:83], v7 offset:33792
v_cvt_pk_bf16_f32 v154, v156, v157
v_mfma_f32_16x16x32_bf16 v[120:123], a[92:95], a[20:23], v[120:123]
s_lshl4_add_u32 s81, s81, s31
ds_read_b64_tr_b16 a[84:85], v7 offset:40960
v_cvt_pk_bf16_f32 v155, v158, v159
v_mfma_f32_16x16x32_bf16 v[120:123], a[88:91], a[16:19], v[120:123]
s_lshl2_add_u32 s81, s81, s30
ds_read_b64_tr_b16 a[86:87], v7 offset:41984
v_or_b32 v20, s66, v252
v_mfma_f32_16x16x32_bf16 v[104:107], a[88:91], a[8:11], v[104:107]
s_mul_i32 s81, s81, 3328
ds_read_b128 a[180:183], v2 offset:8192
v_or_b32 v21, s66, v253
v_mfma_f32_16x16x32_bf16 v[104:107], a[92:95], a[12:15], v[104:107]
s_mov_b32 s73, 0
ds_read_b128 a[188:191], v2 offset:28672
v_or_b32 v22, s66, v254
v_mfma_f32_16x16x32_bf16 v[104:107], a[96:99], a[40:43], v[104:107]
s_mov_b32 s72, 0x20000
ds_read_b64 v[224:225], v2 offset:9224
v_or_b32 v23, s66, v255
v_mfma_f32_16x16x32_bf16 v[104:107], a[100:103], a[44:47], v[104:107]
s_mov_b32 s66, 0x3e8293ee
ds_read_b64 v[228:229], v2 offset:9216
v_mul_f32 v72, s68, v72
v_mfma_f32_16x16x32_bf16 v[88:91], a[100:103], a[36:39], v[88:91]
s_lshl_b32 s67, s31, 15
ds_read_b64 v[240:241], v2 offset:29704
v_mul_f32 v73, s68, v73
v_mfma_f32_16x16x32_bf16 v[88:91], a[96:99], a[32:35], v[88:91]
s_add_u32 s67, s67, s78
ds_read_b64 v[244:245], v2 offset:29696
v_mul_f32 v74, s68, v74
v_mfma_f32_16x16x32_bf16 v[88:91], a[92:95], a[4:7], v[88:91]
s_add_u32 s67, s67, 33554432
v_mul_f32 v75, s68, v75
v_mul_f32 v136, s68, v136
v_mfma_f32_16x16x32_bf16 v[88:91], a[88:91], a[0:3], v[88:91]
s_mul_i32 s74, s3, 1310720
ds_read_b64_tr_b16 a[88:89], v8 offset:0
v_mul_f32 v137, s68, v137
v_mfma_f32_16x16x32_bf16 v[28:31], a[104:107], a[0:3], v[28:31]
s_add_u32 s74, s74, s67
ds_read_b64_tr_b16 a[90:91], v8 offset:1024
v_mul_f32 v138, s68, v138
v_mfma_f32_16x16x32_bf16 v[28:31], a[108:111], a[4:7], v[28:31]
s_mul_i32 s75, s16, 1310720
ds_read_b64_tr_b16 a[92:93], v8 offset:8192
v_mul_f32 v139, s68, v139
v_mfma_f32_16x16x32_bf16 v[28:31], a[112:115], a[32:35], v[28:31]
s_add_u32 s75, s75, s67
ds_read_b64_tr_b16 a[94:95], v8 offset:9216
v_cvt_pk_bf16_f32 v72, v72, v73
v_mfma_f32_16x16x32_bf16 v[28:31], a[116:119], a[36:39], v[28:31]
s_mul_i32 s67, s31, 24576
ds_read_b64_tr_b16 a[96:97], v8 offset:32768
v_cvt_pk_bf16_f32 v73, v74, v75
v_mfma_f32_16x16x32_bf16 v[44:47], a[116:119], a[44:47], v[44:47]
s_sub_u32 s67, 1048576, s67
ds_read_b64_tr_b16 a[98:99], v8 offset:33792
v_cvt_pk_bf16_f32 v74, v136, v137
v_mfma_f32_16x16x32_bf16 v[44:47], a[112:115], a[40:43], v[44:47]
s_add_u32 s64, s74, s67
ds_read_b64_tr_b16 a[100:101], v8 offset:40960
v_cvt_pk_bf16_f32 v75, v138, v139
v_mfma_f32_16x16x32_bf16 v[44:47], a[108:111], a[12:15], v[44:47]
s_add_u32 s65, s75, s67
ds_read_b64_tr_b16 a[102:103], v8 offset:41984
v_mul_f32 v56, s68, v56
v_mfma_f32_16x16x32_bf16 v[44:47], a[104:107], a[8:11], v[44:47]
s_and_b32 s70, s30, 1
v_mul_f32 v57, s68, v57
v_mul_f32 v58, s68, v58
v_mfma_f32_16x16x32_bf16 v[60:63], a[104:107], a[16:19], v[60:63]
s_lshr_b32 s67, s30, 1
v_mul_f32 v59, s68, v59
v_mul_f32 v120, s68, v120
v_mfma_f32_16x16x32_bf16 v[60:63], a[108:111], a[20:23], v[60:63]
s_lshl3_add_u32 s71, s67, s70
v_mul_f32 v121, s68, v121
v_mul_f32 v122, s68, v122
v_mfma_f32_16x16x32_bf16 v[60:63], a[112:115], a[48:51], v[60:63]
s_add_u32 s71, s71, 4
v_mul_f32 v123, s68, v123
v_cvt_pk_bf16_f32 v56, v56, v57
v_mfma_f32_16x16x32_bf16 v[60:63], a[116:119], a[52:55], v[60:63]
s_lshl_b32 s71, s71, 13
v_cvt_pk_bf16_f32 v57, v58, v59
v_cvt_pk_bf16_f32 v58, v120, v121
v_mfma_f32_16x16x32_bf16 v[76:79], a[116:119], a[60:63], v[76:79]
s_lshl_b32 s70, s70, 14
v_cvt_pk_bf16_f32 v59, v122, v123
v_mul_f32 v40, s68, v40
v_mfma_f32_16x16x32_bf16 v[76:79], a[112:115], a[56:59], v[76:79]
s_mul_i32 s67, s67, 24576
v_mul_f32 v41, s68, v41
v_mul_f32 v42, s68, v42
v_mfma_f32_16x16x32_bf16 v[76:79], a[108:111], a[28:31], v[76:79]
s_sub_u32 s70, s70, s67
v_mul_f32 v43, s68, v43
v_mul_f32 v104, s68, v104
v_mfma_f32_16x16x32_bf16 v[76:79], a[104:107], a[24:27], v[76:79]
s_waitcnt lgkmcnt(1)
s_add_u32 s70, s70, 65536
ds_read_b64_tr_b16 a[104:105], v9 offset:0
v_mul_f32 v105, s68, v105
v_mfma_f32_16x16x32_bf16 v[140:143], a[72:75], a[24:27], v[140:143]
ds_read_b64_tr_b16 a[106:107], v9 offset:1024
v_mul_f32 v106, s68, v106
v_mfma_f32_16x16x32_bf16 v[140:143], a[76:79], a[28:31], v[140:143]
ds_read_b64_tr_b16 a[108:109], v9 offset:8192
v_mul_f32 v107, s68, v107
v_mfma_f32_16x16x32_bf16 v[140:143], a[80:83], a[56:59], v[140:143]
ds_read_b64_tr_b16 a[110:111], v9 offset:9216
v_cvt_pk_bf16_f32 v40, v40, v41
v_mfma_f32_16x16x32_bf16 v[140:143], a[84:87], a[60:63], v[140:143]
ds_read_b64_tr_b16 a[112:113], v9 offset:32768
v_cvt_pk_bf16_f32 v41, v42, v43
v_mfma_f32_16x16x32_bf16 v[124:127], a[84:87], a[52:55], v[124:127]
ds_read_b64_tr_b16 a[114:115], v9 offset:33792
v_cvt_pk_bf16_f32 v42, v104, v105
v_mfma_f32_16x16x32_bf16 v[124:127], a[80:83], a[48:51], v[124:127]
ds_read_b64_tr_b16 a[116:117], v9 offset:40960
v_cvt_pk_bf16_f32 v43, v106, v107
v_mfma_f32_16x16x32_bf16 v[124:127], a[76:79], a[20:23], v[124:127]
ds_read_b64_tr_b16 a[118:119], v9 offset:41984
v_mul_f32 v24, s68, v24
v_mfma_f32_16x16x32_bf16 v[124:127], a[72:75], a[16:19], v[124:127]
v_mul_f32 v25, s68, v25
v_mul_f32 v26, s68, v26
v_mfma_f32_16x16x32_bf16 v[108:111], a[72:75], a[8:11], v[108:111]
v_mul_f32 v27, s68, v27
v_mul_f32 v88, s68, v88
v_mfma_f32_16x16x32_bf16 v[108:111], a[76:79], a[12:15], v[108:111]
v_mul_f32 v89, s68, v89
v_mul_f32 v90, s68, v90
v_mfma_f32_16x16x32_bf16 v[108:111], a[80:83], a[40:43], v[108:111]
v_mul_f32 v91, s68, v91
v_cvt_pk_bf16_f32 v24, v24, v25
v_mfma_f32_16x16x32_bf16 v[108:111], a[84:87], a[44:47], v[108:111]
v_cvt_pk_bf16_f32 v25, v26, v27
v_cvt_pk_bf16_f32 v26, v88, v89
v_mfma_f32_16x16x32_bf16 v[92:95], a[84:87], a[36:39], v[92:95]
v_cvt_pk_bf16_f32 v27, v90, v91
v_mul_f32 v76, s68, v76
v_mfma_f32_16x16x32_bf16 v[92:95], a[80:83], a[32:35], v[92:95]
v_mul_f32 v77, s68, v77
v_mul_f32 v78, s68, v78
v_mfma_f32_16x16x32_bf16 v[92:95], a[76:79], a[4:7], v[92:95]
v_mul_f32 v79, s68, v79
v_mul_f32 v140, s68, v140
v_mfma_f32_16x16x32_bf16 v[92:95], a[72:75], a[0:3], v[92:95]
ds_read_b64_tr_b16 a[72:73], v10 offset:0
v_mul_f32 v141, s68, v141
v_mfma_f32_16x16x32_bf16 v[32:35], a[88:91], a[0:3], v[32:35]
ds_read_b64_tr_b16 a[74:75], v10 offset:1024
v_mul_f32 v142, s68, v142
v_mfma_f32_16x16x32_bf16 v[32:35], a[92:95], a[4:7], v[32:35]
ds_read_b64_tr_b16 a[76:77], v10 offset:8192
v_mul_f32 v143, s68, v143
v_mfma_f32_16x16x32_bf16 v[32:35], a[96:99], a[32:35], v[32:35]
s_waitcnt lgkmcnt(3)
ds_read_b64_tr_b16 a[78:79], v10 offset:9216
v_cvt_pk_bf16_f32 v76, v76, v77
v_mfma_f32_16x16x32_bf16 v[32:35], a[100:103], a[36:39], v[32:35]
ds_read_b64_tr_b16 a[80:81], v10 offset:32768
v_cvt_pk_bf16_f32 v77, v78, v79
v_mfma_f32_16x16x32_bf16 v[48:51], a[100:103], a[44:47], v[48:51]
ds_read_b64_tr_b16 a[82:83], v10 offset:33792
v_cvt_pk_bf16_f32 v78, v140, v141
v_mfma_f32_16x16x32_bf16 v[48:51], a[96:99], a[40:43], v[48:51]
ds_read_b64_tr_b16 a[84:85], v10 offset:40960
v_cvt_pk_bf16_f32 v79, v142, v143
v_mfma_f32_16x16x32_bf16 v[48:51], a[92:95], a[12:15], v[48:51]
ds_read_b64_tr_b16 a[86:87], v10 offset:41984
v_mul_f32 v60, s68, v60
v_mfma_f32_16x16x32_bf16 v[48:51], a[88:91], a[8:11], v[48:51]
v_mul_f32 v61, s68, v61
v_mul_f32 v62, s68, v62
v_mfma_f32_16x16x32_bf16 v[64:67], a[88:91], a[16:19], v[64:67]
v_mul_f32 v63, s68, v63
v_mul_f32 v124, s68, v124
v_mfma_f32_16x16x32_bf16 v[64:67], a[92:95], a[20:23], v[64:67]
v_mul_f32 v125, s68, v125
v_mul_f32 v126, s68, v126
v_mfma_f32_16x16x32_bf16 v[64:67], a[96:99], a[48:51], v[64:67]
buffer_load_dwordx4 v[136:139], v16, s[44:47], s77 offen sc1
v_mfma_f32_16x16x32_bf16 v[64:67], a[100:103], a[52:55], v[64:67]
v_mul_f32 v127, s68, v127
v_cvt_pk_bf16_f32 v60, v60, v61
v_mfma_f32_16x16x32_bf16 v[80:83], a[100:103], a[60:63], v[80:83]
v_cvt_pk_bf16_f32 v61, v62, v63
v_cvt_pk_bf16_f32 v62, v124, v125
v_mfma_f32_16x16x32_bf16 v[80:83], a[96:99], a[56:59], v[80:83]
v_cvt_pk_bf16_f32 v63, v126, v127
v_mul_f32 v44, s68, v44
v_mfma_f32_16x16x32_bf16 v[80:83], a[92:95], a[28:31], v[80:83]
v_mul_f32 v45, s68, v45
v_mul_f32 v46, s68, v46
v_mfma_f32_16x16x32_bf16 v[80:83], a[88:91], a[24:27], v[80:83]
ds_read_b64_tr_b16 a[88:89], v11 offset:0
v_mul_f32 v47, s68, v47
v_mfma_f32_16x16x32_bf16 v[144:147], a[104:107], a[24:27], v[144:147]
ds_read_b64_tr_b16 a[90:91], v11 offset:1024
v_mul_f32 v108, s68, v108
v_mfma_f32_16x16x32_bf16 v[144:147], a[108:111], a[28:31], v[144:147]
ds_read_b64_tr_b16 a[92:93], v11 offset:8192
v_mul_f32 v109, s68, v109
v_mfma_f32_16x16x32_bf16 v[144:147], a[112:115], a[56:59], v[144:147]
ds_read_b64_tr_b16 a[94:95], v11 offset:9216
v_mul_f32 v110, s68, v110
v_mfma_f32_16x16x32_bf16 v[144:147], a[116:119], a[60:63], v[144:147]
ds_read_b64_tr_b16 a[96:97], v11 offset:32768
v_mul_f32 v111, s68, v111
v_mfma_f32_16x16x32_bf16 v[128:131], a[116:119], a[52:55], v[128:131]
ds_read_b64_tr_b16 a[98:99], v11 offset:33792
v_cvt_pk_bf16_f32 v44, v44, v45
v_mfma_f32_16x16x32_bf16 v[128:131], a[112:115], a[48:51], v[128:131]
ds_read_b64_tr_b16 a[100:101], v11 offset:40960
v_cvt_pk_bf16_f32 v45, v46, v47
v_mfma_f32_16x16x32_bf16 v[128:131], a[108:111], a[20:23], v[128:131]
ds_read_b64_tr_b16 a[102:103], v11 offset:41984
v_cvt_pk_bf16_f32 v46, v108, v109
v_mfma_f32_16x16x32_bf16 v[128:131], a[104:107], a[16:19], v[128:131]
v_cvt_pk_bf16_f32 v47, v110, v111
v_mul_f32 v28, s68, v28
v_mfma_f32_16x16x32_bf16 v[112:115], a[104:107], a[8:11], v[112:115]
v_mul_f32 v29, s68, v29
v_mul_f32 v30, s68, v30
v_mfma_f32_16x16x32_bf16 v[112:115], a[108:111], a[12:15], v[112:115]
v_mul_f32 v31, s68, v31
v_mul_f32 v92, s68, v92
v_mfma_f32_16x16x32_bf16 v[112:115], a[112:115], a[40:43], v[112:115]
v_mul_f32 v93, s68, v93
v_mul_f32 v94, s68, v94
v_mfma_f32_16x16x32_bf16 v[112:115], a[116:119], a[44:47], v[112:115]
v_mul_f32 v95, s68, v95
v_cvt_pk_bf16_f32 v28, v28, v29
v_mfma_f32_16x16x32_bf16 v[96:99], a[116:119], a[36:39], v[96:99]
v_cvt_pk_bf16_f32 v29, v30, v31
v_cvt_pk_bf16_f32 v30, v92, v93
v_mfma_f32_16x16x32_bf16 v[96:99], a[112:115], a[32:35], v[96:99]
v_cvt_pk_bf16_f32 v31, v94, v95
v_mul_f32 v80, s68, v80
v_mfma_f32_16x16x32_bf16 v[96:99], a[108:111], a[4:7], v[96:99]
v_mul_f32 v81, s68, v81
v_mul_f32 v82, s68, v82
v_mfma_f32_16x16x32_bf16 v[96:99], a[104:107], a[0:3], v[96:99]
s_waitcnt lgkmcnt(1)
v_mul_f32 v83, s68, v83
v_mul_f32 v144, s68, v144
v_mfma_f32_16x16x32_bf16 v[36:39], a[72:75], a[0:3], v[36:39]
v_mul_f32 v145, s68, v145
v_mul_f32 v146, s68, v146
v_mfma_f32_16x16x32_bf16 v[36:39], a[76:79], a[4:7], v[36:39]
v_mul_f32 v147, s68, v147
v_cvt_pk_bf16_f32 v80, v80, v81
v_mfma_f32_16x16x32_bf16 v[36:39], a[80:83], a[32:35], v[36:39]
v_cvt_pk_bf16_f32 v81, v82, v83
v_cvt_pk_bf16_f32 v82, v144, v145
v_mfma_f32_16x16x32_bf16 v[36:39], a[84:87], a[36:39], v[36:39]
v_cvt_pk_bf16_f32 v83, v146, v147
v_mul_f32 v64, s68, v64
v_mfma_f32_16x16x32_bf16 v[52:55], a[84:87], a[44:47], v[52:55]
v_mul_f32 v65, s68, v65
v_mul_f32 v66, s68, v66
v_mfma_f32_16x16x32_bf16 v[52:55], a[80:83], a[40:43], v[52:55]
v_mul_f32 v67, s68, v67
v_mul_f32 v128, s68, v128
v_mfma_f32_16x16x32_bf16 v[52:55], a[76:79], a[12:15], v[52:55]
v_mul_f32 v129, s68, v129
v_mul_f32 v130, s68, v130
v_mfma_f32_16x16x32_bf16 v[52:55], a[72:75], a[8:11], v[52:55]
v_mul_f32 v131, s68, v131
v_cvt_pk_bf16_f32 v64, v64, v65
v_mfma_f32_16x16x32_bf16 v[68:71], a[72:75], a[16:19], v[68:71]
v_cvt_pk_bf16_f32 v65, v66, v67
v_cvt_pk_bf16_f32 v66, v128, v129
v_mfma_f32_16x16x32_bf16 v[68:71], a[76:79], a[20:23], v[68:71]
v_cvt_pk_bf16_f32 v67, v130, v131
v_mul_f32 v48, s68, v48
v_mfma_f32_16x16x32_bf16 v[68:71], a[80:83], a[48:51], v[68:71]
v_mul_f32 v49, s68, v49
v_mul_f32 v50, s68, v50
v_mfma_f32_16x16x32_bf16 v[68:71], a[84:87], a[52:55], v[68:71]
v_mul_f32 v51, s68, v51
v_mul_f32 v112, s68, v112
v_mfma_f32_16x16x32_bf16 v[84:87], a[84:87], a[60:63], v[84:87]
v_mul_f32 v113, s68, v113
v_mul_f32 v114, s68, v114
v_mfma_f32_16x16x32_bf16 v[84:87], a[80:83], a[56:59], v[84:87]
v_mul_f32 v115, s68, v115
v_cvt_pk_bf16_f32 v48, v48, v49
v_mfma_f32_16x16x32_bf16 v[84:87], a[76:79], a[28:31], v[84:87]
v_cvt_pk_bf16_f32 v49, v50, v51
v_cvt_pk_bf16_f32 v50, v112, v113
v_mfma_f32_16x16x32_bf16 v[84:87], a[72:75], a[24:27], v[84:87]
v_cvt_pk_bf16_f32 v51, v114, v115
v_mul_f32 v32, s68, v32
v_mfma_f32_16x16x32_bf16 v[148:151], a[88:91], a[24:27], v[148:151]
v_mul_f32 v33, s68, v33
v_mul_f32 v34, s68, v34
v_mfma_f32_16x16x32_bf16 v[148:151], a[92:95], a[28:31], v[148:151]
v_mul_f32 v35, s68, v35
v_mul_f32 v96, s68, v96
v_mfma_f32_16x16x32_bf16 v[148:151], a[96:99], a[56:59], v[148:151]
s_waitcnt lgkmcnt(0)
s_waitcnt vmcnt(0)
v_max3_u32 v1, v136, v137, v138
v_max_u32 v1, v1, v139
v_mfma_f32_16x16x32_bf16 v[148:151], a[100:103], a[60:63], v[148:151]
v_cmp_eq_u32 vcc, -1, v1
s_cbranch_vccnz L_hretry
L_hgo:
v_mfma_f32_16x16x32_bf16 v[132:135], a[100:103], a[52:55], v[132:135]
ds_write_b128 v17, v[136:139]
v_mfma_f32_16x16x32_bf16 v[132:135], a[96:99], a[48:51], v[132:135]
v_mul_f32 v97, s68, v97
v_mul_f32 v98, s68, v98
v_mfma_f32_16x16x32_bf16 v[132:135], a[92:95], a[20:23], v[132:135]
v_mul_f32 v99, s68, v99
v_cvt_pk_bf16_f32 v32, v32, v33
v_mfma_f32_16x16x32_bf16 v[132:135], a[88:91], a[16:19], v[132:135]
v_cvt_pk_bf16_f32 v33, v34, v35
v_cvt_pk_bf16_f32 v34, v96, v97
v_mfma_f32_16x16x32_bf16 v[116:119], a[88:91], a[8:11], v[116:119]
s_waitcnt lgkmcnt(0)
s_barrier
v_mfma_f32_16x16x32_bf16 v[116:119], a[92:95], a[12:15], v[116:119]
ds_read_b128 a[176:179], v2 offset:0
v_cvt_pk_bf16_f32 v35, v98, v99
v_mfma_f32_16x16x32_bf16 v[116:119], a[96:99], a[40:43], v[116:119]
ds_read_b128 a[184:187], v2 offset:20480
v_mfma_f32_16x16x32_bf16 v[116:119], a[100:103], a[44:47], v[116:119]
ds_read_b64 v[216:217], v2 offset:1032
v_mfma_f32_16x16x32_bf16 v[100:103], a[100:103], a[36:39], v[100:103]
ds_read_b64 v[220:221], v2 offset:1024
v_mfma_f32_16x16x32_bf16 v[100:103], a[96:99], a[32:35], v[100:103]
ds_read_b64 v[232:233], v2 offset:21512
v_mfma_f32_16x16x32_bf16 v[100:103], a[92:95], a[4:7], v[100:103]
ds_read_b64 v[236:237], v2 offset:21504
v_mfma_f32_16x16x32_bf16 v[100:103], a[88:91], a[0:3], v[100:103]
v_mfma_f32_16x16x32_bf16 v[196:199], v[192:195], v[160:163], v[248:251]
v_mfma_f32_16x16x32_bf16 v[212:215], v[208:211], v[176:179], v[248:251]
v_mfma_f32_16x16x32_bf16 v[188:191], v[184:187], v[152:155], v[248:251]
v_mfma_f32_16x16x32_bf16 v[204:207], v[200:203], v[168:171], v[248:251]
v_mfma_f32_16x16x32_bf16 v[164:167], a[180:183], v[160:163], v[252:255]
v_mfma_f32_16x16x32_bf16 v[180:183], a[188:191], v[176:179], v[252:255]
s_waitcnt lgkmcnt(5)
v_mfma_f32_16x16x32_bf16 v[156:159], a[176:179], v[152:155], v[20:23]
s_waitcnt lgkmcnt(4)
v_mfma_f32_16x16x32_bf16 v[172:175], a[184:187], v[168:171], v[252:255]
v_accvgpr_read_b32 v4, a64
v_accvgpr_read_b32 v5, a65
v_accvgpr_read_b32 v6, a66
v_accvgpr_read_b32 v7, a67
v_accvgpr_read_b32 v8, a68
s_branch L_po14
L_pg14:
s_branch L_pg18
L_po14:
v_accvgpr_read_b32 v9, a69
v_accvgpr_read_b32 v10, a70
v_accvgpr_read_b32 v11, a71
v_max3_f32 v121, v196, v197, v198
v_max3_f32 v121, v121, v199, v164
v_max3_f32 v121, v121, v165, v166
v_max_f32 v121, v121, v167
v_max3_f32 v123, v212, v213, v214
v_max3_f32 v123, v123, v215, v180
v_max3_f32 v123, v123, v181, v182
v_max_f32 v123, v123, v183
v_max3_f32 v120, v188, v189, v190
v_max3_f32 v120, v120, v191, v156
v_max3_f32 v120, v120, v157, v158
v_max_f32 v120, v120, v159
v_max3_f32 v122, v204, v205, v206
v_max3_f32 v122, v122, v207, v172
v_max3_f32 v122, v122, v173, v174
v_max_f32 v122, v122, v175
v_mov_b32 v105, v121
v_mov_b32 v107, v123
v_mov_b32 v104, v120
v_mov_b32 v106, v122
v_permlane16_swap_b32 v105, v121
v_permlane16_swap_b32 v107, v123
v_permlane16_swap_b32 v104, v120
v_permlane16_swap_b32 v106, v122
v_max_f32 v121, v121, v105
v_max_f32 v123, v123, v107
v_max_f32 v120, v120, v104
v_max_f32 v122, v122, v106
v_mov_b32 v105, v121
v_mov_b32 v107, v123
v_mov_b32 v104, v120
v_mov_b32 v106, v122
v_permlane32_swap_b32 v105, v121
v_permlane32_swap_b32 v107, v123
v_permlane32_swap_b32 v104, v120
v_permlane32_swap_b32 v106, v122
v_max_f32 v121, v121, v105
v_max_f32 v123, v123, v107
v_max_f32 v120, v120, v104
v_max_f32 v122, v122, v106
v_mul_f32 v121, s66, v121
v_mul_f32 v123, s66, v123
v_mul_f32 v120, s66, v120
v_mul_f32 v122, s66, v122
v_fma_f32 v164, v164, s66, -v121
v_fma_f32 v165, v165, s66, -v121
v_fma_f32 v166, v166, s66, -v121
v_fma_f32 v167, v167, s66, -v121
v_fma_f32 v196, v196, s66, -v121
v_fma_f32 v197, v197, s66, -v121
v_fma_f32 v198, v198, s66, -v121
v_fma_f32 v199, v199, s66, -v121
v_exp_f32 v164, v164
v_exp_f32 v165, v165
v_exp_f32 v166, v166
v_exp_f32 v167, v167
v_exp_f32 v196, v196
v_exp_f32 v197, v197
v_exp_f32 v198, v198
v_exp_f32 v199, v199
v_cvt_pk_bf16_f32 v164, v164, v165
v_cvt_pk_bf16_f32 v165, v166, v167
v_cvt_pk_bf16_f32 v166, v196, v197
v_cvt_pk_bf16_f32 v167, v198, v199
v_pk_mul_f32 v[36:37], v[36:37], s[68:69]
v_pk_mul_f32 v[38:39], v[38:39], s[68:69]
v_mfma_f32_16x16x32_bf16 v[196:199], a[244:247], v[164:167], 0
v_mfma_f32_16x16x32_bf16 v[160:163], v[224:227], v[164:167], 0
v_mfma_f32_16x16x32_bf16 v[192:195], v[228:231], v[164:167], 0
v_fma_f32 v180, v180, s66, -v123
v_fma_f32 v181, v181, s66, -v123
v_fma_f32 v182, v182, s66, -v123
v_fma_f32 v183, v183, s66, -v123
v_fma_f32 v212, v212, s66, -v123
v_fma_f32 v213, v213, s66, -v123
v_fma_f32 v214, v214, s66, -v123
v_fma_f32 v215, v215, s66, -v123
v_exp_f32 v180, v180
v_exp_f32 v181, v181
v_exp_f32 v182, v182
v_exp_f32 v183, v183
v_exp_f32 v212, v212
v_exp_f32 v213, v213
v_exp_f32 v214, v214
v_exp_f32 v215, v215
v_cvt_pk_bf16_f32 v180, v180, v181
v_cvt_pk_bf16_f32 v181, v182, v183
v_cvt_pk_bf16_f32 v182, v212, v213
v_cvt_pk_bf16_f32 v183, v214, v215
v_pk_mul_f32 v[100:101], v[100:101], s[68:69]
v_pk_mul_f32 v[102:103], v[102:103], s[68:69]
v_mfma_f32_16x16x32_bf16 v[212:215], a[244:247], v[180:183], 0
v_mfma_f32_16x16x32_bf16 v[176:179], v[240:243], v[180:183], 0
v_mfma_f32_16x16x32_bf16 v[208:211], v[244:247], v[180:183], 0
v_fma_f32 v156, v156, s66, -v120
v_fma_f32 v157, v157, s66, -v120
v_fma_f32 v158, v158, s66, -v120
v_fma_f32 v159, v159, s66, -v120
v_fma_f32 v188, v188, s66, -v120
v_fma_f32 v189, v189, s66, -v120
v_fma_f32 v190, v190, s66, -v120
v_fma_f32 v191, v191, s66, -v120
v_exp_f32 v156, v156
v_exp_f32 v157, v157
v_exp_f32 v158, v158
v_exp_f32 v159, v159
v_exp_f32 v188, v188
v_exp_f32 v189, v189
v_exp_f32 v190, v190
v_exp_f32 v191, v191
v_cvt_pk_bf16_f32 v156, v156, v157
v_cvt_pk_bf16_f32 v157, v158, v159
v_cvt_pk_bf16_f32 v158, v188, v189
v_cvt_pk_bf16_f32 v159, v190, v191
v_cvt_pk_bf16_f32 v36, v36, v37
v_cvt_pk_bf16_f32 v37, v38, v39
v_mfma_f32_16x16x32_bf16 v[188:191], a[244:247], v[156:159], 0
s_waitcnt lgkmcnt(3)
v_mfma_f32_16x16x32_bf16 v[152:155], v[216:219], v[156:159], 0
s_waitcnt lgkmcnt(2)
v_mfma_f32_16x16x32_bf16 v[184:187], v[220:223], v[156:159], 0
v_fma_f32 v172, v172, s66, -v122
v_fma_f32 v173, v173, s66, -v122
v_fma_f32 v174, v174, s66, -v122
v_fma_f32 v175, v175, s66, -v122
v_fma_f32 v204, v204, s66, -v122
v_fma_f32 v205, v205, s66, -v122
v_fma_f32 v206, v206, s66, -v122
v_fma_f32 v207, v207, s66, -v122
v_exp_f32 v172, v172
v_exp_f32 v173, v173
v_exp_f32 v174, v174
v_exp_f32 v175, v175
v_exp_f32 v204, v204
v_exp_f32 v205, v205
v_exp_f32 v206, v206
v_exp_f32 v207, v207
v_cvt_pk_bf16_f32 v172, v172, v173
v_cvt_pk_bf16_f32 v173, v174, v175
v_cvt_pk_bf16_f32 v174, v204, v205
v_cvt_pk_bf16_f32 v175, v206, v207
v_cvt_pk_bf16_f32 v38, v100, v101
v_cvt_pk_bf16_f32 v39, v102, v103
v_mfma_f32_16x16x32_bf16 v[204:207], a[244:247], v[172:175], 0
s_waitcnt lgkmcnt(1)
v_mfma_f32_16x16x32_bf16 v[168:171], v[232:235], v[172:175], 0
s_waitcnt lgkmcnt(0)
v_mfma_f32_16x16x32_bf16 v[200:203], v[236:239], v[172:175], 0
v_pk_mul_f32 v[52:53], v[52:53], s[68:69]
v_pk_mul_f32 v[54:55], v[54:55], s[68:69]
v_pk_mul_f32 v[116:117], v[116:117], s[68:69]
v_pk_mul_f32 v[118:119], v[118:119], s[68:69]
v_cvt_pk_bf16_f32 v52, v52, v53
v_cvt_pk_bf16_f32 v53, v54, v55
v_cvt_pk_bf16_f32 v54, v116, v117
v_cvt_pk_bf16_f32 v55, v118, v119
v_pk_mul_f32 v[68:69], v[68:69], s[68:69]
v_pk_mul_f32 v[70:71], v[70:71], s[68:69]
v_pk_mul_f32 v[132:133], v[132:133], s[68:69]
v_pk_mul_f32 v[134:135], v[134:135], s[68:69]
v_cvt_pk_bf16_f32 v68, v68, v69
v_cvt_pk_bf16_f32 v69, v70, v71
v_cvt_pk_bf16_f32 v70, v132, v133
v_cvt_pk_bf16_f32 v71, v134, v135
v_pk_mul_f32 v[84:85], v[84:85], s[68:69]
v_pk_mul_f32 v[86:87], v[86:87], s[68:69]
v_pk_mul_f32 v[148:149], v[148:149], s[68:69]
v_pk_mul_f32 v[150:151], v[150:151], s[68:69]
v_cvt_pk_bf16_f32 v84, v84, v85
v_cvt_pk_bf16_f32 v85, v86, v87
v_cvt_pk_bf16_f32 v86, v148, v149
v_cvt_pk_bf16_f32 v87, v150, v151
v_rcp_f32 v121, v196
v_rcp_f32 v123, v212
v_rcp_f32 v120, v188
v_rcp_f32 v122, v204
v_mul_f32 v121, v121, v7
v_mul_f32 v123, v123, v11
v_mul_f32 v120, v120, v5
v_mul_f32 v122, v122, v9
v_pk_mul_f32 v[152:153], v[152:153], v[120:121] op_sel_hi:[1,0]
v_pk_mul_f32 v[154:155], v[154:155], v[120:121] op_sel_hi:[1,0]
v_pk_mul_f32 v[184:185], v[184:185], v[120:121] op_sel_hi:[1,0]
v_pk_mul_f32 v[186:187], v[186:187], v[120:121] op_sel_hi:[1,0]
v_cvt_pk_bf16_f32 v152, v152, v153
v_cvt_pk_bf16_f32 v153, v154, v155
v_cvt_pk_bf16_f32 v154, v184, v185
v_cvt_pk_bf16_f32 v155, v186, v187
buffer_store_dwordx4 v[152:155], v16, s[44:47], s64 offen sc1
v_mov_b32 v2, v16
v_add_u32 v3, 0x10000, v16
v_mov_b32 v1, 0
s_mov_b32 m0, s71
s_waitcnt lgkmcnt(0)
s_barrier
ds_read_b128 a[144:147], v2 offset:0
ds_read_b128 a[148:151], v2 offset:1024
ds_read_b128 a[152:155], v2 offset:2048
ds_read_b128 a[156:159], v2 offset:3072
ds_read_b128 a[160:163], v2 offset:4096
ds_read_b128 a[164:167], v2 offset:5120
ds_read_b128 a[168:171], v2 offset:6144
ds_read_b128 a[172:175], v2 offset:7168
buffer_load_dwordx4 v16, s[32:35], s70 offen offset:0 sc1 lds
buffer_load_dwordx4 v16, s[32:35], s70 offen offset:1024 sc1 lds
v_pk_mul_f32 v[168:169], v[168:169], v[122:123] op_sel_hi:[1,0]
v_pk_mul_f32 v[170:171], v[170:171], v[122:123] op_sel_hi:[1,0]
v_pk_mul_f32 v[200:201], v[200:201], v[122:123] op_sel_hi:[1,0]
v_pk_mul_f32 v[202:203], v[202:203], v[122:123] op_sel_hi:[1,0]
v_cvt_pk_bf16_f32 v168, v168, v169
v_cvt_pk_bf16_f32 v169, v170, v171
v_cvt_pk_bf16_f32 v170, v200, v201
v_cvt_pk_bf16_f32 v171, v202, v203
buffer_store_dwordx4 v[168:171], v16, s[44:47], s65 offen sc1
v_pk_mul_f32 v[160:161], v[160:161], v[120:121] op_sel:[0,1]
v_pk_mul_f32 v[162:163], v[162:163], v[120:121] op_sel:[0,1]
v_pk_mul_f32 v[192:193], v[192:193], v[120:121] op_sel:[0,1]
v_pk_mul_f32 v[194:195], v[194:195], v[120:121] op_sel:[0,1]
v_cvt_pk_bf16_f32 v160, v160, v161
v_cvt_pk_bf16_f32 v161, v162, v163
v_cvt_pk_bf16_f32 v162, v192, v193
v_cvt_pk_bf16_f32 v163, v194, v195
s_add_u32 s64, s64, 4096
buffer_store_dwordx4 v[160:163], v16, s[44:47], s64 offen sc1
v_pk_mul_f32 v[176:177], v[176:177], v[122:123] op_sel:[0,1]
v_pk_mul_f32 v[178:179], v[178:179], v[122:123] op_sel:[0,1]
v_pk_mul_f32 v[208:209], v[208:209], v[122:123] op_sel:[0,1]
v_pk_mul_f32 v[210:211], v[210:211], v[122:123] op_sel:[0,1]
v_cvt_pk_bf16_f32 v176, v176, v177
v_cvt_pk_bf16_f32 v177, v178, v179
v_cvt_pk_bf16_f32 v178, v208, v209
v_cvt_pk_bf16_f32 v179, v210, v211
s_add_u32 s65, s65, 4096
buffer_store_dwordx4 v[176:179], v16, s[44:47], s65 offen sc1
v_mov_b32 v17, 0xff800000
v_and_b32 v5, 1, v0
v_mul_u32_u24 v5, 0xaaaa, v5
v_add_u32 v5, 0x4444, v5
v_lshl_or_b32 v5, v5, 16, v5
L_attstart_7:
s_cmp_eq_u32 s3, 0
s_cbranch_scc1 L_F1
s_waitcnt lgkmcnt(7)
v_mfma_f32_16x16x32_bf16 v[88:91], a[144:147], v[24:27], 0
s_waitcnt lgkmcnt(6)
ds_read_b128 a[176:179], v2 offset:8192
v_accvgpr_write_b32 a128, 0
v_mfma_f32_16x16x32_bf16 v[88:91], a[148:151], v[28:31], v[88:91]
s_waitcnt lgkmcnt(6)
ds_read_b128 a[180:183], v2 offset:9216
v_accvgpr_write_b32 a129, 0
v_mfma_f32_16x16x32_bf16 v[88:91], a[152:155], v[32:35], v[88:91]
s_waitcnt lgkmcnt(6)
buffer_load_dwordx4 v16, s[32:35], s70 offen offset:2048 sc1 lds
v_mfma_f32_16x16x32_bf16 v[88:91], a[156:159], v[36:39], v[88:91]
ds_read_b128 a[184:187], v2 offset:10240
v_accvgpr_write_b32 a130, 0
v_mfma_f32_16x16x32_bf16 v[104:107], a[156:159], v[52:55], 0
ds_read_b128 a[188:191], v2 offset:11264
v_accvgpr_write_b32 a131, 0
v_mfma_f32_16x16x32_bf16 v[104:107], a[152:155], v[48:51], v[104:107]
ds_read_b128 a[192:195], v2 offset:12288
v_accvgpr_write_b32 a132, 0
v_mfma_f32_16x16x32_bf16 v[104:107], a[148:151], v[44:47], v[104:107]
ds_read_b128 a[196:199], v2 offset:13312
v_accvgpr_write_b32 a133, 0
v_mfma_f32_16x16x32_bf16 v[104:107], a[144:147], v[40:43], v[104:107]
ds_read_b128 a[200:203], v2 offset:14336
v_accvgpr_write_b32 a134, 0
v_mfma_f32_16x16x32_bf16 v[120:123], a[144:147], v[56:59], 0
ds_read_b128 a[204:207], v2 offset:15360
v_accvgpr_write_b32 a135, 0
v_mfma_f32_16x16x32_bf16 v[120:123], a[148:151], v[60:63], v[120:123]
buffer_load_dwordx4 v16, s[32:35], s70 offen offset:3072 sc1 lds
v_mfma_f32_16x16x32_bf16 v[120:123], a[152:155], v[64:67], v[120:123]
v_accvgpr_write_b32 a136, 0
v_accvgpr_write_b32 a137, 0
v_mfma_f32_16x16x32_bf16 v[120:123], a[156:159], v[68:71], v[120:123]
v_accvgpr_write_b32 a138, 0
v_accvgpr_write_b32 a139, 0
v_mfma_f32_16x16x32_bf16 v[136:139], a[156:159], v[84:87], 0
v_accvgpr_write_b32 a140, 0
v_accvgpr_write_b32 a141, 0
v_mfma_f32_16x16x32_bf16 v[136:139], a[152:155], v[80:83], v[136:139]
v_accvgpr_write_b32 a142, 0
v_accvgpr_write_b32 a143, 0
v_mfma_f32_16x16x32_bf16 v[136:139], a[148:151], v[76:79], v[136:139]
v_mfma_f32_16x16x32_bf16 v[136:139], a[144:147], v[72:75], v[136:139]
s_waitcnt lgkmcnt(0)
s_nop 1
v_max3_f32 v20, v88, v89, v90
v_max_f32 v20, v20, v91
v_max3_f32 v21, v104, v105, v106
v_max_f32 v21, v21, v107
v_max3_f32 v22, v120, v121, v122
v_max_f32 v22, v22, v123
v_max3_f32 v23, v136, v137, v138
v_max_f32 v23, v23, v139
v_mov_b32 v248, v20
v_mov_b32 v249, v21
v_mov_b32 v250, v22
v_mov_b32 v251, v23
v_permlane16_swap_b32 v248, v20
v_permlane16_swap_b32 v249, v21
v_permlane16_swap_b32 v250, v22
v_permlane16_swap_b32 v251, v23
v_max_f32 v20, v20, v248
v_max_f32 v21, v21, v249
v_max_f32 v22, v22, v250
v_max_f32 v23, v23, v251
v_mov_b32 v248, v20
v_mov_b32 v249, v21
v_mov_b32 v250, v22
v_mov_b32 v251, v23
v_permlane32_swap_b32 v248, v20
v_permlane32_swap_b32 v249, v21
v_permlane32_swap_b32 v250, v22
v_permlane32_swap_b32 v251, v23
v_max_f32 v20, v20, v248
v_max_f32 v21, v21, v249
v_max_f32 v22, v22, v250
v_max_f32 v23, v23, v251
s_cmp_eq_u32 s73, 0
s_cselect_b64 vcc, 0, -1
v_cndmask_b32 v20, v20, v252, vcc
v_cndmask_b32 v21, v21, v253, vcc
v_cndmask_b32 v22, v22, v254, vcc
v_cndmask_b32 v23, v23, v255, vcc
v_sub_f32 v228, 0, v23
v_sub_f32 v229, 0, v23
v_sub_f32 v230, 0, v23
v_sub_f32 v231, 0, v23
v_sub_f32 v224, 0, v22
v_sub_f32 v225, 0, v22
v_sub_f32 v226, 0, v22
v_sub_f32 v227, 0, v22
v_sub_f32 v220, 0, v21
v_sub_f32 v221, 0, v21
v_sub_f32 v222, 0, v21
v_sub_f32 v223, 0, v21
v_sub_f32 v216, 0, v20
v_sub_f32 v217, 0, v20
v_sub_f32 v218, 0, v20
v_sub_f32 v219, 0, v20
v_mfma_f32_16x16x32_bf16 v[140:143], a[160:163], v[72:75], v[228:231]
s_add_u32 m0, s71, 4096
v_add_f32 v88, v88, v216
v_add_f32 v89, v89, v216
v_mfma_f32_16x16x32_bf16 v[140:143], a[164:167], v[76:79], v[140:143]
v_add_f32 v90, v90, v216
v_add_f32 v91, v91, v216
v_exp_f32 v88, v88
v_mfma_f32_16x16x32_bf16 v[140:143], a[168:171], v[80:83], v[140:143]
s_add_u32 s64, s70, 4096
v_exp_f32 v89, v89
v_mfma_f32_16x16x32_bf16 v[140:143], a[172:175], v[84:87], v[140:143]
buffer_load_dwordx4 v16, s[32:35], s64 offen offset:0 sc1 lds
v_mfma_f32_16x16x32_bf16 v[124:127], a[172:175], v[68:71], v[224:227]
v_exp_f32 v90, v90
v_mfma_f32_16x16x32_bf16 v[124:127], a[168:171], v[64:67], v[124:127]
v_exp_f32 v91, v91
v_mfma_f32_16x16x32_bf16 v[124:127], a[164:167], v[60:63], v[124:127]
v_add_f32 v104, v104, v220
v_add_f32 v105, v105, v220
v_add_f32 v106, v106, v220
v_add_f32 v107, v107, v220
v_exp_f32 v104, v104
v_mfma_f32_16x16x32_bf16 v[124:127], a[160:163], v[56:59], v[124:127]
v_exp_f32 v105, v105
v_mfma_f32_16x16x32_bf16 v[108:111], a[160:163], v[40:43], v[220:223]
v_exp_f32 v106, v106
v_mfma_f32_16x16x32_bf16 v[108:111], a[164:167], v[44:47], v[108:111]
buffer_load_dwordx4 v16, s[32:35], s64 offen offset:1024 sc1 lds
v_mfma_f32_16x16x32_bf16 v[108:111], a[168:171], v[48:51], v[108:111]
v_cvt_pk_bf16_f32 v152, v88, v89
v_add_f32 v120, v120, v224
v_mfma_f32_16x16x32_bf16 v[108:111], a[172:175], v[52:55], v[108:111]
v_exp_f32 v107, v107
v_mfma_f32_16x16x32_bf16 v[92:95], a[172:175], v[36:39], v[216:219]
v_add_f32 v121, v121, v224
v_add_f32 v122, v122, v224
v_add_f32 v123, v123, v224
v_exp_f32 v120, v120
v_mfma_f32_16x16x32_bf16 v[92:95], a[168:171], v[32:35], v[92:95]
v_cvt_pk_bf16_f32 v153, v90, v91
v_exp_f32 v121, v121
v_mfma_f32_16x16x32_bf16 v[92:95], a[164:167], v[28:31], v[92:95]
v_exp_f32 v122, v122
v_mfma_f32_16x16x32_bf16 v[92:95], a[160:163], v[24:27], v[92:95]
v_exp_f32 v123, v123
v_mfma_f32_16x16x32_bf16 v[96:99], a[176:179], v[24:27], v[216:219]
v_cvt_pk_bf16_f32 v160, v104, v105
v_add_f32 v136, v136, v228
v_mfma_f32_16x16x32_bf16 v[96:99], a[180:183], v[28:31], v[96:99]
buffer_load_dwordx4 v16, s[32:35], s64 offen offset:2048 sc1 lds
v_add_f32 v137, v137, v228
v_add_f32 v138, v138, v228
v_add_f32 v139, v139, v228
v_exp_f32 v136, v136
v_mfma_f32_16x16x32_bf16 v[96:99], a[184:187], v[32:35], v[96:99]
v_exp_f32 v137, v137
v_mfma_f32_16x16x32_bf16 v[96:99], a[188:191], v[36:39], v[96:99]
v_cvt_pk_bf16_f32 v161, v106, v107
v_cvt_pk_bf16_f32 v184, v120, v121
v_mfma_f32_16x16x32_bf16 v[112:115], a[188:191], v[52:55], v[220:223]
v_exp_f32 v138, v138
v_mfma_f32_16x16x32_bf16 v[112:115], a[184:187], v[48:51], v[112:115]
v_exp_f32 v139, v139
v_mfma_f32_16x16x32_bf16 v[112:115], a[180:183], v[44:47], v[112:115]
v_exp_f32 v140, v140
v_mfma_f32_16x16x32_bf16 v[112:115], a[176:179], v[40:43], v[112:115]
v_exp_f32 v141, v141
v_mfma_f32_16x16x32_bf16 v[128:131], a[176:179], v[56:59], v[224:227]
buffer_load_dwordx4 v16, s[32:35], s64 offen offset:3072 sc1 lds
v_cvt_pk_bf16_f32 v185, v122, v123
v_mfma_f32_16x16x32_bf16 v[128:131], a[180:183], v[60:63], v[128:131]
v_exp_f32 v142, v142
v_mfma_f32_16x16x32_bf16 v[128:131], a[184:187], v[64:67], v[128:131]
v_exp_f32 v143, v143
v_mfma_f32_16x16x32_bf16 v[128:131], a[188:191], v[68:71], v[128:131]
v_cvt_pk_bf16_f32 v192, v136, v137
v_cvt_pk_bf16_f32 v193, v138, v139
v_mfma_f32_16x16x32_bf16 v[144:147], a[188:191], v[84:87], v[228:231]
v_exp_f32 v124, v124
v_mfma_f32_16x16x32_bf16 v[144:147], a[184:187], v[80:83], v[144:147]
v_exp_f32 v125, v125
v_mfma_f32_16x16x32_bf16 v[144:147], a[180:183], v[76:79], v[144:147]
s_waitcnt vmcnt(6)
s_barrier
v_mfma_f32_16x16x32_bf16 v[144:147], a[176:179], v[72:75], v[144:147]
v_exp_f32 v126, v126
v_mfma_f32_16x16x32_bf16 v[148:151], a[192:195], v[72:75], v[228:231]
v_cvt_pk_bf16_f32 v194, v140, v141
v_cvt_pk_bf16_f32 v195, v142, v143
v_mfma_f32_16x16x32_bf16 v[148:151], a[196:199], v[76:79], v[148:151]
v_exp_f32 v127, v127
v_mfma_f32_16x16x32_bf16 v[148:151], a[200:203], v[80:83], v[148:151]
s_xor_b32 s71, s71, 16384
v_exp_f32 v108, v108
v_mfma_f32_16x16x32_bf16 v[148:151], a[204:207], v[84:87], v[148:151]
s_add_u32 s70, s70, 32768
v_exp_f32 v109, v109
v_mfma_f32_16x16x32_bf16 v[132:135], a[204:207], v[68:71], v[224:227]
s_mov_b32 m0, s71
v_exp_f32 v110, v110
v_mfma_f32_16x16x32_bf16 v[132:135], a[200:203], v[64:67], v[132:135]
buffer_load_dwordx4 v16, s[32:35], s70 offen offset:0 sc1 lds
v_mfma_f32_16x16x32_bf16 v[132:135], a[196:199], v[60:63], v[132:135]
v_cvt_pk_bf16_f32 v186, v124, v125
v_exp_f32 v111, v111
v_mfma_f32_16x16x32_bf16 v[132:135], a[192:195], v[56:59], v[132:135]
v_exp_f32 v92, v92
v_mfma_f32_16x16x32_bf16 v[116:119], a[192:195], v[40:43], v[220:223]
v_exp_f32 v93, v93
v_mfma_f32_16x16x32_bf16 v[116:119], a[196:199], v[44:47], v[116:119]
ds_read_b128 a[144:147], v2 offset:16384
v_cvt_pk_bf16_f32 v187, v126, v127
v_mfma_f32_16x16x32_bf16 v[116:119], a[200:203], v[48:51], v[116:119]
v_exp_f32 v94, v94
v_mfma_f32_16x16x32_bf16 v[116:119], a[204:207], v[52:55], v[116:119]
ds_read_b128 a[148:151], v2 offset:17408
v_cvt_pk_bf16_f32 v162, v108, v109
v_mfma_f32_16x16x32_bf16 v[100:103], a[204:207], v[36:39], v[216:219]
ds_read_b128 a[152:155], v2 offset:18432
buffer_load_dwordx4 v16, s[32:35], s70 offen offset:1024 sc1 lds
v_exp_f32 v95, v95
v_mfma_f32_16x16x32_bf16 v[100:103], a[200:203], v[32:35], v[100:103]
ds_read_b128 a[156:159], v2 offset:19456
v_exp_f32 v96, v96
v_mfma_f32_16x16x32_bf16 v[100:103], a[196:199], v[28:31], v[100:103]
v_cvt_pk_bf16_f32 v163, v110, v111
v_exp_f32 v97, v97
v_mfma_f32_16x16x32_bf16 v[100:103], a[192:195], v[24:27], v[100:103]
s_waitcnt lgkmcnt(3)
ds_read_b128 a[160:163], v2 offset:20480
ds_read_b128 a[164:167], v2 offset:21504
ds_read_b128 a[168:171], v2 offset:22528
ds_read_b128 a[172:175], v2 offset:23552
v_mfma_f32_16x16x32_bf16 v[88:91], a[144:147], v[24:27], v[216:219]
s_waitcnt lgkmcnt(6)
v_exp_f32 v98, v98
v_mfma_f32_16x16x32_bf16 v[88:91], a[148:151], v[28:31], v[88:91]
s_waitcnt lgkmcnt(5)
v_cvt_pk_bf16_f32 v154, v92, v93
v_exp_f32 v99, v99
v_mfma_f32_16x16x32_bf16 v[88:91], a[152:155], v[32:35], v[88:91]
s_waitcnt lgkmcnt(4)
v_exp_f32 v112, v112
v_mfma_f32_16x16x32_bf16 v[88:91], a[156:159], v[36:39], v[88:91]
v_exp_f32 v113, v113
v_mfma_f32_16x16x32_bf16 v[104:107], a[156:159], v[52:55], v[220:223]
v_cvt_pk_bf16_f32 v155, v94, v95
v_cvt_pk_bf16_f32 v156, v96, v97
v_mfma_f32_16x16x32_bf16 v[104:107], a[152:155], v[48:51], v[104:107]
buffer_load_dwordx4 v16, s[32:35], s70 offen offset:2048 sc1 lds
v_exp_f32 v114, v114
v_mfma_f32_16x16x32_bf16 v[104:107], a[148:151], v[44:47], v[104:107]
v_exp_f32 v115, v115
v_mfma_f32_16x16x32_bf16 v[104:107], a[144:147], v[40:43], v[104:107]
v_exp_f32 v128, v128
v_mfma_f32_16x16x32_bf16 v[120:123], a[144:147], v[56:59], v[224:227]
v_exp_f32 v129, v129
v_mfma_f32_16x16x32_bf16 v[120:123], a[148:151], v[60:63], v[120:123]
v_cvt_pk_bf16_f32 v157, v98, v99
v_cvt_pk_bf16_f32 v164, v112, v113
v_mfma_f32_16x16x32_bf16 v[120:123], a[152:155], v[64:67], v[120:123]
v_exp_f32 v130, v130
v_mfma_f32_16x16x32_bf16 v[120:123], a[156:159], v[68:71], v[120:123]
v_exp_f32 v131, v131
v_mfma_f32_16x16x32_bf16 v[136:139], a[156:159], v[84:87], v[228:231]
v_exp_f32 v144, v144
v_mfma_f32_16x16x32_bf16 v[136:139], a[152:155], v[80:83], v[136:139]
v_exp_f32 v145, v145
v_mfma_f32_16x16x32_bf16 v[136:139], a[148:151], v[76:79], v[136:139]
v_exp_f32 v146, v146
v_mfma_f32_16x16x32_bf16 v[136:139], a[144:147], v[72:75], v[136:139]
s_waitcnt lgkmcnt(0)
v_cvt_pk_bf16_f32 v165, v114, v115
v_cvt_pk_bf16_f32 v188, v128, v129
v_mfma_f32_16x16x32_bf16 v[140:143], a[160:163], v[72:75], v[228:231]
v_exp_f32 v147, v147
v_mfma_f32_16x16x32_bf16 v[140:143], a[164:167], v[76:79], v[140:143]
v_exp_f32 v148, v148
v_mfma_f32_16x16x32_bf16 v[140:143], a[168:171], v[80:83], v[140:143]
v_exp_f32 v149, v149
v_mfma_f32_16x16x32_bf16 v[140:143], a[172:175], v[84:87], v[140:143]
buffer_load_dwordx4 v16, s[32:35], s70 offen offset:3072 sc1 lds
v_mfma_f32_16x16x32_bf16 v[124:127], a[172:175], v[68:71], v[224:227]
v_cvt_pk_bf16_f32 v189, v130, v131
v_cvt_pk_bf16_f32 v196, v144, v145
v_mfma_f32_16x16x32_bf16 v[124:127], a[168:171], v[64:67], v[124:127]
v_exp_f32 v150, v150
v_mfma_f32_16x16x32_bf16 v[124:127], a[164:167], v[60:63], v[124:127]
v_exp_f32 v151, v151
v_mfma_f32_16x16x32_bf16 v[124:127], a[160:163], v[56:59], v[124:127]
v_exp_f32 v132, v132
v_mfma_f32_16x16x32_bf16 v[108:111], a[160:163], v[40:43], v[220:223]
ds_read_b128 a[176:179], v2 offset:24576
v_cvt_pk_bf16_f32 v197, v146, v147
v_mfma_f32_16x16x32_bf16 v[108:111], a[164:167], v[44:47], v[108:111]
ds_read_b128 a[180:183], v2 offset:25600
v_cvt_pk_bf16_f32 v198, v148, v149
v_mfma_f32_16x16x32_bf16 v[108:111], a[168:171], v[48:51], v[108:111]
ds_read_b128 a[184:187], v2 offset:26624
v_exp_f32 v133, v133
v_mfma_f32_16x16x32_bf16 v[108:111], a[172:175], v[52:55], v[108:111]
ds_read_b128 a[188:191], v2 offset:27648
v_exp_f32 v134, v134
v_mfma_f32_16x16x32_bf16 v[92:95], a[172:175], v[36:39], v[216:219]
v_exp_f32 v135, v135
v_mfma_f32_16x16x32_bf16 v[92:95], a[168:171], v[32:35], v[92:95]
v_exp_f32 v116, v116
v_mfma_f32_16x16x32_bf16 v[92:95], a[164:167], v[28:31], v[92:95]
v_exp_f32 v117, v117
v_mfma_f32_16x16x32_bf16 v[92:95], a[160:163], v[24:27], v[92:95]
s_waitcnt lgkmcnt(2)
v_cvt_pk_bf16_f32 v199, v150, v151
v_cvt_pk_bf16_f32 v190, v132, v133
v_mfma_f32_16x16x32_bf16 v[96:99], a[176:179], v[24:27], v[216:219]
v_exp_f32 v118, v118
v_mfma_f32_16x16x32_bf16 v[96:99], a[180:183], v[28:31], v[96:99]
s_waitcnt lgkmcnt(0)
s_add_u32 m0, s71, 4096
v_exp_f32 v119, v119
v_mfma_f32_16x16x32_bf16 v[96:99], a[184:187], v[32:35], v[96:99]
s_add_u32 s64, s70, 4096
v_exp_f32 v100, v100
v_mfma_f32_16x16x32_bf16 v[96:99], a[188:191], v[36:39], v[96:99]
buffer_load_dwordx4 v16, s[32:35], s64 offen offset:0 sc1 lds
v_mfma_f32_16x16x32_bf16 v[112:115], a[188:191], v[52:55], v[220:223]
v_exp_f32 v101, v101
v_mfma_f32_16x16x32_bf16 v[112:115], a[184:187], v[48:51], v[112:115]
v_cvt_pk_bf16_f32 v191, v134, v135
v_cvt_pk_bf16_f32 v166, v116, v117
v_mfma_f32_16x16x32_bf16 v[112:115], a[180:183], v[44:47], v[112:115]
v_exp_f32 v102, v102
v_mfma_f32_16x16x32_bf16 v[112:115], a[176:179], v[40:43], v[112:115]
v_exp_f32 v103, v103
v_mfma_f32_16x16x32_bf16 v[128:131], a[176:179], v[56:59], v[224:227]
s_lshl_b32 s66, s30, 30
ds_read_b128 a[192:195], v2 offset:28672
v_cvt_pk_bf16_f32 v167, v118, v119
v_mfma_f32_16x16x32_bf16 v[128:131], a[180:183], v[60:63], v[128:131]
ds_read_b128 a[196:199], v2 offset:29696
v_exp_f32 v88, v88
v_mfma_f32_16x16x32_bf16 v[128:131], a[184:187], v[64:67], v[128:131]
ds_read_b128 a[200:203], v2 offset:30720
v_exp_f32 v89, v89
v_mfma_f32_16x16x32_bf16 v[128:131], a[188:191], v[68:71], v[128:131]
ds_read_b128 a[204:207], v2 offset:31744
v_cvt_pk_bf16_f32 v158, v100, v101
v_mfma_f32_16x16x32_bf16 v[144:147], a[188:191], v[84:87], v[228:231]
v_exp_f32 v90, v90
v_mfma_f32_16x16x32_bf16 v[144:147], a[184:187], v[80:83], v[144:147]
v_exp_f32 v91, v91
v_mfma_f32_16x16x32_bf16 v[144:147], a[180:183], v[76:79], v[144:147]
v_exp_f32 v104, v104
v_mfma_f32_16x16x32_bf16 v[144:147], a[176:179], v[72:75], v[144:147]
s_waitcnt lgkmcnt(2)
v_exp_f32 v105, v105
v_mfma_f32_16x16x32_bf16 v[148:151], a[192:195], v[72:75], v[228:231]
v_cvt_pk_bf16_f32 v159, v102, v103
v_cvt_pk_bf16_f32 v168, v88, v89
v_mfma_f32_16x16x32_bf16 v[148:151], a[196:199], v[76:79], v[148:151]
s_waitcnt lgkmcnt(0)
v_exp_f32 v106, v106
v_mfma_f32_16x16x32_bf16 v[148:151], a[200:203], v[80:83], v[148:151]
v_exp_f32 v107, v107
v_mfma_f32_16x16x32_bf16 v[148:151], a[204:207], v[84:87], v[148:151]
buffer_load_dwordx4 v16, s[32:35], s64 offen offset:1024 sc1 lds
v_mfma_f32_16x16x32_bf16 v[132:135], a[204:207], v[68:71], v[224:227]
v_exp_f32 v120, v120
v_mfma_f32_16x16x32_bf16 v[132:135], a[200:203], v[64:67], v[132:135]
v_cvt_pk_bf16_f32 v169, v90, v91
v_cvt_pk_bf16_f32 v176, v104, v105
v_mfma_f32_16x16x32_bf16 v[132:135], a[196:199], v[60:63], v[132:135]
v_exp_f32 v121, v121
v_mfma_f32_16x16x32_bf16 v[132:135], a[192:195], v[56:59], v[132:135]
v_exp_f32 v122, v122
v_mfma_f32_16x16x32_bf16 v[116:119], a[192:195], v[40:43], v[220:223]
v_exp_f32 v123, v123
v_mfma_f32_16x16x32_bf16 v[116:119], a[196:199], v[44:47], v[116:119]
v_exp_f32 v136, v136
v_mfma_f32_16x16x32_bf16 v[116:119], a[200:203], v[48:51], v[116:119]
v_exp_f32 v137, v137
v_mfma_f32_16x16x32_bf16 v[116:119], a[204:207], v[52:55], v[116:119]
ds_read_b128 a[144:147], v3 offset:16384
v_cvt_pk_bf16_f32 v177, v106, v107
v_mfma_f32_16x16x32_bf16 v[100:103], a[204:207], v[36:39], v[216:219]
s_branch L_po15
L_pg15:
s_branch L_pg19
L_po15:
v_exp_f32 v138, v138
v_mfma_f32_16x16x32_bf16 v[100:103], a[200:203], v[32:35], v[100:103]
ds_read_b128 a[148:151], v3 offset:24576
v_cvt_pk_bf16_f32 v200, v120, v121
v_mfma_f32_16x16x32_bf16 v[100:103], a[196:199], v[28:31], v[100:103]
v_exp_f32 v139, v139
v_mfma_f32_16x16x32_bf16 v[100:103], a[192:195], v[24:27], v[100:103]
v_exp_f32 v140, v140
v_smfmac_f32_16x16x64_bf16 a[128:131], a[240:243], v[152:159], v5
v_cvt_pk_bf16_f32 v201, v122, v123
v_smfmac_f32_16x16x64_bf16 a[132:135], a[240:243], v[160:167], v5
v_exp_f32 v141, v141
v_smfmac_f32_16x16x64_bf16 a[136:139], a[240:243], v[184:191], v5
v_exp_f32 v142, v142
v_smfmac_f32_16x16x64_bf16 a[140:143], a[240:243], v[192:199], v5
s_waitcnt lgkmcnt(0)
buffer_load_dwordx4 v16, s[32:35], s64 offen offset:2048 sc1 lds
v_cvt_pk_bf16_f32 v208, v136, v137
v_mfma_f32_16x16x32_bf16 a[0:3], a[144:147], v[152:155], 0
ds_read_b128 a[152:155], v3 offset:17408
v_exp_f32 v143, v143
v_mfma_f32_16x16x32_bf16 a[0:3], a[148:151], v[156:159], a[0:3]
ds_read_b128 a[156:159], v3 offset:25600
v_exp_f32 v124, v124
v_mfma_f32_16x16x32_bf16 a[32:35], a[148:151], v[164:167], 0
v_cvt_pk_bf16_f32 v209, v138, v139
v_exp_f32 v125, v125
v_mfma_f32_16x16x32_bf16 a[32:35], a[144:147], v[160:163], a[32:35]
v_exp_f32 v126, v126
v_mfma_f32_16x16x32_bf16 a[64:67], a[144:147], v[184:187], 0
v_exp_f32 v127, v127
v_mfma_f32_16x16x32_bf16 a[64:67], a[148:151], v[188:191], a[64:67]
v_cvt_pk_bf16_f32 v210, v140, v141
v_cvt_pk_bf16_f32 v211, v142, v143
v_mfma_f32_16x16x32_bf16 a[96:99], a[148:151], v[196:199], 0
v_exp_f32 v108, v108
v_mfma_f32_16x16x32_bf16 a[96:99], a[144:147], v[192:195], a[96:99]
s_waitcnt lgkmcnt(0)
v_exp_f32 v109, v109
v_mfma_f32_16x16x32_bf16 a[100:103], a[152:155], v[192:195], 0
ds_read_b128 a[160:163], v3 offset:18432
v_cvt_pk_bf16_f32 v202, v124, v125
v_mfma_f32_16x16x32_bf16 a[100:103], a[156:159], v[196:199], a[100:103]
ds_read_b128 a[164:167], v3 offset:26624
v_exp_f32 v110, v110
v_mfma_f32_16x16x32_bf16 a[68:71], a[156:159], v[188:191], 0
v_exp_f32 v111, v111
v_mfma_f32_16x16x32_bf16 a[68:71], a[152:155], v[184:187], a[68:71]
v_exp_f32 v92, v92
v_mfma_f32_16x16x32_bf16 a[36:39], a[152:155], v[160:163], 0
v_exp_f32 v93, v93
v_mfma_f32_16x16x32_bf16 a[36:39], a[156:159], v[164:167], a[36:39]
v_cvt_pk_bf16_f32 v203, v126, v127
v_cvt_pk_bf16_f32 v178, v108, v109
v_mfma_f32_16x16x32_bf16 a[4:7], a[156:159], v[156:159], 0
buffer_load_dwordx4 v16, s[32:35], s64 offen offset:3072 sc1 lds
v_mfma_f32_16x16x32_bf16 a[4:7], a[152:155], v[152:155], a[4:7]
s_waitcnt lgkmcnt(0)
v_exp_f32 v94, v94
v_mfma_f32_16x16x32_bf16 a[8:11], a[160:163], v[152:155], 0
ds_read_b128 a[168:171], v3 offset:19456
v_cvt_pk_bf16_f32 v179, v110, v111
v_mfma_f32_16x16x32_bf16 a[8:11], a[164:167], v[156:159], a[8:11]
ds_read_b128 a[172:175], v3 offset:27648
v_exp_f32 v95, v95
v_mfma_f32_16x16x32_bf16 a[40:43], a[164:167], v[164:167], 0
v_exp_f32 v96, v96
v_mfma_f32_16x16x32_bf16 a[40:43], a[160:163], v[160:163], a[40:43]
v_exp_f32 v97, v97
v_mfma_f32_16x16x32_bf16 a[72:75], a[160:163], v[184:187], 0
v_exp_f32 v98, v98
v_mfma_f32_16x16x32_bf16 a[72:75], a[164:167], v[188:191], a[72:75]
v_exp_f32 v99, v99
v_mfma_f32_16x16x32_bf16 a[104:107], a[164:167], v[196:199], 0
ds_read_b128 a[176:179], v3 offset:20480
v_cvt_pk_bf16_f32 v170, v92, v93
v_mfma_f32_16x16x32_bf16 a[104:107], a[160:163], v[192:195], a[104:107]
s_waitcnt lgkmcnt(1)
v_exp_f32 v112, v112
v_mfma_f32_16x16x32_bf16 a[108:111], a[168:171], v[192:195], 0
v_exp_f32 v113, v113
v_mfma_f32_16x16x32_bf16 a[108:111], a[172:175], v[196:199], a[108:111]
ds_read_b128 a[180:183], v3 offset:28672
v_cvt_pk_bf16_f32 v171, v94, v95
v_mfma_f32_16x16x32_bf16 a[76:79], a[172:175], v[188:191], 0
v_exp_f32 v114, v114
v_mfma_f32_16x16x32_bf16 a[76:79], a[168:171], v[184:187], a[76:79]
v_cvt_pk_bf16_f32 v172, v96, v97
v_xor_b32 v2, 0x8000, v2
v_mfma_f32_16x16x32_bf16 a[44:47], a[168:171], v[160:163], 0
ds_read_b128 a[184:187], v3 offset:21504
ds_read_b128 a[188:191], v3 offset:29696
ds_read_b128 a[192:195], v3 offset:22528
ds_read_b128 a[196:199], v3 offset:30720
ds_read_b128 a[200:203], v3 offset:23552
ds_read_b128 a[204:207], v3 offset:31744
v_exp_f32 v115, v115
v_mfma_f32_16x16x32_bf16 a[44:47], a[172:175], v[164:167], a[44:47]
s_waitcnt vmcnt(8)
s_barrier
v_exp_f32 v128, v128
v_mfma_f32_16x16x32_bf16 a[12:15], a[172:175], v[156:159], 0
v_cvt_pk_bf16_f32 v173, v98, v99
v_cvt_pk_bf16_f32 v180, v112, v113
v_mfma_f32_16x16x32_bf16 a[12:15], a[168:171], v[152:155], a[12:15]
s_waitcnt lgkmcnt(6)
v_exp_f32 v129, v129
v_mfma_f32_16x16x32_bf16 a[16:19], a[176:179], v[152:155], 0
v_exp_f32 v130, v130
v_mfma_f32_16x16x32_bf16 a[16:19], a[180:183], v[156:159], a[16:19]
s_xor_b32 s71, s71, 49152
v_exp_f32 v131, v131
v_mfma_f32_16x16x32_bf16 a[48:51], a[180:183], v[164:167], 0
s_add_u32 s70, s70, 32768
v_exp_f32 v144, v144
v_mfma_f32_16x16x32_bf16 a[48:51], a[176:179], v[160:163], a[48:51]
s_mov_b32 m0, s71
v_exp_f32 v145, v145
v_mfma_f32_16x16x32_bf16 a[80:83], a[176:179], v[184:187], 0
buffer_load_dwordx4 v16, s[32:35], s70 offen offset:0 sc1 lds
v_cvt_pk_bf16_f32 v181, v114, v115
v_mfma_f32_16x16x32_bf16 a[80:83], a[180:183], v[188:191], a[80:83]
v_exp_f32 v146, v146
v_mfma_f32_16x16x32_bf16 a[112:115], a[180:183], v[196:199], 0
v_exp_f32 v147, v147
v_mfma_f32_16x16x32_bf16 a[112:115], a[176:179], v[192:195], a[112:115]
s_waitcnt lgkmcnt(0)
v_cvt_pk_bf16_f32 v204, v128, v129
v_cvt_pk_bf16_f32 v205, v130, v131
v_mfma_f32_16x16x32_bf16 a[116:119], a[184:187], v[192:195], 0
v_exp_f32 v148, v148
v_mfma_f32_16x16x32_bf16 a[116:119], a[188:191], v[196:199], a[116:119]
v_exp_f32 v149, v149
v_mfma_f32_16x16x32_bf16 a[84:87], a[188:191], v[188:191], 0
v_exp_f32 v150, v150
v_mfma_f32_16x16x32_bf16 a[84:87], a[184:187], v[184:187], a[84:87]
v_exp_f32 v151, v151
v_mfma_f32_16x16x32_bf16 a[52:55], a[184:187], v[160:163], 0
v_cvt_pk_bf16_f32 v212, v144, v145
v_cvt_pk_bf16_f32 v213, v146, v147
v_mfma_f32_16x16x32_bf16 a[52:55], a[188:191], v[164:167], a[52:55]
v_exp_f32 v132, v132
v_mfma_f32_16x16x32_bf16 a[20:23], a[188:191], v[156:159], 0
v_exp_f32 v133, v133
v_mfma_f32_16x16x32_bf16 a[20:23], a[184:187], v[152:155], a[20:23]
ds_read_b128 a[144:147], v2 offset:0
v_lshl_add_u32 v19, v0, 24, s66
v_mfma_f32_16x16x32_bf16 a[24:27], a[192:195], v[152:155], 0
s_lshr_b32 s67, s31, 4
v_exp_f32 v134, v134
v_mfma_f32_16x16x32_bf16 a[24:27], a[196:199], v[156:159], a[24:27]
s_lshl1_add_u32 s67, s3, s67
v_exp_f32 v135, v135
v_mfma_f32_16x16x32_bf16 a[56:59], a[196:199], v[164:167], 0
s_lshl_b32 s79, s67, 8
v_cvt_pk_bf16_f32 v214, v148, v149
v_cvt_pk_bf16_f32 v215, v150, v151
v_mfma_f32_16x16x32_bf16 a[56:59], a[192:195], v[160:163], a[56:59]
s_add_u32 s79, s79, 8192
buffer_load_dwordx4 v16, s[32:35], s70 offen offset:1024 sc1 lds
v_mfma_f32_16x16x32_bf16 a[88:91], a[192:195], v[184:187], 0
s_add_u32 s69, s31, 12
v_exp_f32 v116, v116
v_mfma_f32_16x16x32_bf16 a[88:91], a[196:199], v[188:191], a[88:91]
s_lshr_b32 s69, s69, 5
v_exp_f32 v117, v117
v_mfma_f32_16x16x32_bf16 a[120:123], a[196:199], v[196:199], 0
s_lshl1_add_u32 s69, s3, s69
v_exp_f32 v118, v118
v_mfma_f32_16x16x32_bf16 a[120:123], a[192:195], v[192:195], a[120:123]
s_lshl_b32 s69, s69, 8
v_cvt_pk_bf16_f32 v206, v132, v133
v_cvt_pk_bf16_f32 v207, v134, v135
v_mfma_f32_16x16x32_bf16 a[124:127], a[200:203], v[192:195], 0
s_add_u32 s69, s69, 8192
v_exp_f32 v119, v119
v_mfma_f32_16x16x32_bf16 a[124:127], a[204:207], v[196:199], a[124:127]
s_lshl_b32 s67, s73, 16
v_exp_f32 v100, v100
v_mfma_f32_16x16x32_bf16 a[92:95], a[204:207], v[188:191], 0
s_xor_b32 s68, s80, 256
v_exp_f32 v101, v101
v_mfma_f32_16x16x32_bf16 a[92:95], a[200:203], v[184:187], a[92:95]
s_add_u32 s68, s68, s67
ds_read_b128 a[148:151], v2 offset:1024
v_cvt_pk_bf16_f32 v182, v116, v117
v_mfma_f32_16x16x32_bf16 a[60:63], a[200:203], v[160:163], 0
ds_read_b128 a[152:155], v2 offset:2048
v_exp_f32 v102, v102
v_mfma_f32_16x16x32_bf16 a[60:63], a[204:207], v[164:167], a[60:63]
s_add_u32 s67, s67, s69
ds_read_b128 a[156:159], v2 offset:3072
v_cvt_pk_bf16_f32 v183, v118, v119
v_mfma_f32_16x16x32_bf16 a[28:31], a[204:207], v[156:159], 0
s_mov_b64 exec, 1
buffer_atomic_add a251, v19, s[52:55], s67 offen offset:0 sc1
buffer_atomic_add a251, v19, s[52:55], s68 offen offset:0 sc1
s_mov_b64 exec, -1
v_exp_f32 v103, v103
v_mfma_f32_16x16x32_bf16 a[28:31], a[200:203], v[152:155], a[28:31]
ds_read_b128 a[160:163], v2 offset:4096
ds_read_b128 a[164:167], v2 offset:5120
ds_read_b128 a[168:171], v2 offset:6144
ds_read_b128 a[172:175], v2 offset:7168
v_mul_u32_u24 v19, 52, v0
v_cvt_pk_bf16_f32 v174, v100, v101
v_cvt_pk_bf16_f32 v175, v102, v103
v_xor_b32 v3, 0x8000, v3
s_sub_u32 s72, s3, 1
s_cmp_eq_u32 s72, 0
s_cbranch_scc1 L_DD
L_D:
s_waitcnt lgkmcnt(7)
v_mfma_f32_16x16x32_bf16 v[88:91], a[144:147], v[24:27], v[216:219]
s_waitcnt lgkmcnt(6)
ds_read_b128 a[176:179], v2 offset:8192
v_mfma_f32_16x16x32_bf16 v[88:91], a[148:151], v[28:31], v[88:91]
s_waitcnt lgkmcnt(6)
ds_read_b128 a[180:183], v2 offset:9216
v_mfma_f32_16x16x32_bf16 v[88:91], a[152:155], v[32:35], v[88:91]
s_waitcnt lgkmcnt(6)
buffer_load_dwordx4 v16, s[32:35], s70 offen offset:2048 sc1 lds
v_mfma_f32_16x16x32_bf16 v[88:91], a[156:159], v[36:39], v[88:91]
ds_read_b128 a[184:187], v2 offset:10240
v_mfma_f32_16x16x32_bf16 v[104:107], a[156:159], v[52:55], v[220:223]
v_mfma_f32_16x16x32_bf16 v[104:107], a[152:155], v[48:51], v[104:107]
buffer_load_dword a252, v19, s[40:43], s81 offen
v_mfma_f32_16x16x32_bf16 v[104:107], a[148:151], v[44:47], v[104:107]
ds_read_b128 a[188:191], v2 offset:11264
v_mfma_f32_16x16x32_bf16 v[104:107], a[144:147], v[40:43], v[104:107]
v_mfma_f32_16x16x32_bf16 v[120:123], a[144:147], v[56:59], v[224:227]
v_mfma_f32_16x16x32_bf16 v[120:123], a[148:151], v[60:63], v[120:123]
v_mfma_f32_16x16x32_bf16 v[120:123], a[152:155], v[64:67], v[120:123]
v_exp_f32 v88, v88
v_mfma_f32_16x16x32_bf16 v[120:123], a[156:159], v[68:71], v[120:123]
v_exp_f32 v89, v89
v_mfma_f32_16x16x32_bf16 v[136:139], a[156:159], v[84:87], v[228:231]
v_exp_f32 v90, v90
v_mfma_f32_16x16x32_bf16 v[136:139], a[152:155], v[80:83], v[136:139]
v_exp_f32 v91, v91
v_mfma_f32_16x16x32_bf16 v[136:139], a[148:151], v[76:79], v[136:139]
v_exp_f32 v104, v104
v_mfma_f32_16x16x32_bf16 v[136:139], a[144:147], v[72:75], v[136:139]
s_waitcnt lgkmcnt(0)
s_add_u32 s81, s81, 425984
v_exp_f32 v105, v105
v_mfma_f32_16x16x32_bf16 v[140:143], a[160:163], v[72:75], v[228:231]
v_exp_f32 v106, v106
v_mfma_f32_16x16x32_bf16 v[140:143], a[164:167], v[76:79], v[140:143]
buffer_load_dwordx4 v16, s[32:35], s70 offen offset:3072 sc1 lds
v_mfma_f32_16x16x32_bf16 v[140:143], a[168:171], v[80:83], v[140:143]
v_exp_f32 v107, v107
v_mfma_f32_16x16x32_bf16 v[140:143], a[172:175], v[84:87], v[140:143]
v_cvt_pk_bf16_f32 v152, v88, v89
v_cvt_pk_bf16_f32 v153, v90, v91
v_mfma_f32_16x16x32_bf16 v[124:127], a[172:175], v[68:71], v[224:227]
v_exp_f32 v120, v120
v_mfma_f32_16x16x32_bf16 v[124:127], a[168:171], v[64:67], v[124:127]
v_exp_f32 v121, v121
v_mfma_f32_16x16x32_bf16 v[124:127], a[164:167], v[60:63], v[124:127]
v_exp_f32 v122, v122
v_mfma_f32_16x16x32_bf16 v[124:127], a[160:163], v[56:59], v[124:127]
v_exp_f32 v123, v123
v_mfma_f32_16x16x32_bf16 v[108:111], a[160:163], v[40:43], v[220:223]
v_exp_f32 v136, v136
v_mfma_f32_16x16x32_bf16 v[108:111], a[164:167], v[44:47], v[108:111]
v_exp_f32 v137, v137
v_mfma_f32_16x16x32_bf16 v[108:111], a[168:171], v[48:51], v[108:111]
v_exp_f32 v138, v138
v_mfma_f32_16x16x32_bf16 v[108:111], a[172:175], v[52:55], v[108:111]
v_cvt_pk_bf16_f32 v160, v104, v105
v_cvt_pk_bf16_f32 v161, v106, v107
v_mfma_f32_16x16x32_bf16 v[92:95], a[172:175], v[36:39], v[216:219]
v_exp_f32 v139, v139
v_mfma_f32_16x16x32_bf16 v[92:95], a[168:171], v[32:35], v[92:95]
ds_read_b128 a[192:195], v2 offset:12288
v_cvt_pk_bf16_f32 v184, v120, v121
v_mfma_f32_16x16x32_bf16 v[92:95], a[164:167], v[28:31], v[92:95]
v_exp_f32 v140, v140
v_mfma_f32_16x16x32_bf16 v[92:95], a[160:163], v[24:27], v[92:95]
s_add_u32 m0, s71, 4096
ds_read_b128 a[196:199], v2 offset:13312
v_cvt_pk_bf16_f32 v185, v122, v123
v_mfma_f32_16x16x32_bf16 v[96:99], a[176:179], v[24:27], v[216:219]
s_add_u32 s64, s70, 4096
ds_read_b128 a[200:203], v2 offset:14336
v_cvt_pk_bf16_f32 v192, v136, v137
v_mfma_f32_16x16x32_bf16 v[96:99], a[180:183], v[28:31], v[96:99]
buffer_load_dwordx4 v16, s[32:35], s64 offen offset:0 sc1 lds
v_mfma_f32_16x16x32_bf16 v[96:99], a[184:187], v[32:35], v[96:99]
v_exp_f32 v141, v141
v_mfma_f32_16x16x32_bf16 v[96:99], a[188:191], v[36:39], v[96:99]
ds_read_b128 a[204:207], v2 offset:15360
v_cvt_pk_bf16_f32 v193, v138, v139
v_mfma_f32_16x16x32_bf16 v[112:115], a[188:191], v[52:55], v[220:223]
v_exp_f32 v142, v142
v_mfma_f32_16x16x32_bf16 v[112:115], a[184:187], v[48:51], v[112:115]
v_exp_f32 v143, v143
v_mfma_f32_16x16x32_bf16 v[112:115], a[180:183], v[44:47], v[112:115]
v_exp_f32 v124, v124
v_mfma_f32_16x16x32_bf16 v[112:115], a[176:179], v[40:43], v[112:115]
v_exp_f32 v125, v125
v_mfma_f32_16x16x32_bf16 v[128:131], a[176:179], v[56:59], v[224:227]
v_exp_f32 v126, v126
v_mfma_f32_16x16x32_bf16 v[128:131], a[180:183], v[60:63], v[128:131]
v_exp_f32 v127, v127
v_mfma_f32_16x16x32_bf16 v[128:131], a[184:187], v[64:67], v[128:131]
v_exp_f32 v108, v108
v_mfma_f32_16x16x32_bf16 v[128:131], a[188:191], v[68:71], v[128:131]
v_exp_f32 v109, v109
v_mfma_f32_16x16x32_bf16 v[144:147], a[188:191], v[84:87], v[228:231]
v_exp_f32 v110, v110
v_mfma_f32_16x16x32_bf16 v[144:147], a[184:187], v[80:83], v[144:147]
ds_read_b128 a[144:147], v3 offset:0
v_cvt_pk_bf16_f32 v194, v140, v141
v_mfma_f32_16x16x32_bf16 v[144:147], a[180:183], v[76:79], v[144:147]
ds_read_b128 a[148:151], v3 offset:8192
v_cvt_pk_bf16_f32 v195, v142, v143
v_mfma_f32_16x16x32_bf16 v[144:147], a[176:179], v[72:75], v[144:147]
s_waitcnt lgkmcnt(2)
v_exp_f32 v111, v111
v_mfma_f32_16x16x32_bf16 v[148:151], a[192:195], v[72:75], v[228:231]
buffer_load_dwordx4 v16, s[32:35], s64 offen offset:1024 sc1 lds
v_mfma_f32_16x16x32_bf16 v[148:151], a[196:199], v[76:79], v[148:151]
v_exp_f32 v92, v92
v_mfma_f32_16x16x32_bf16 v[148:151], a[200:203], v[80:83], v[148:151]
v_exp_f32 v93, v93
v_mfma_f32_16x16x32_bf16 v[148:151], a[204:207], v[84:87], v[148:151]
v_exp_f32 v94, v94
v_mfma_f32_16x16x32_bf16 v[132:135], a[204:207], v[68:71], v[224:227]
ds_read_b128 a[152:155], v3 offset:1024
v_cvt_pk_bf16_f32 v186, v124, v125
v_mfma_f32_16x16x32_bf16 v[132:135], a[200:203], v[64:67], v[132:135]
ds_read_b128 a[156:159], v3 offset:9216
v_cvt_pk_bf16_f32 v187, v126, v127
v_mfma_f32_16x16x32_bf16 v[132:135], a[196:199], v[60:63], v[132:135]
v_exp_f32 v95, v95
v_mfma_f32_16x16x32_bf16 v[132:135], a[192:195], v[56:59], v[132:135]
v_exp_f32 v96, v96
v_mfma_f32_16x16x32_bf16 v[116:119], a[192:195], v[40:43], v[220:223]
v_exp_f32 v97, v97
v_mfma_f32_16x16x32_bf16 v[116:119], a[196:199], v[44:47], v[116:119]
v_exp_f32 v98, v98
v_mfma_f32_16x16x32_bf16 v[116:119], a[200:203], v[48:51], v[116:119]
ds_read_b128 a[160:163], v3 offset:2048
v_cvt_pk_bf16_f32 v162, v108, v109
v_mfma_f32_16x16x32_bf16 v[116:119], a[204:207], v[52:55], v[116:119]
v_exp_f32 v99, v99
v_mfma_f32_16x16x32_bf16 v[100:103], a[204:207], v[36:39], v[216:219]
ds_read_b128 a[164:167], v3 offset:10240
v_cvt_pk_bf16_f32 v163, v110, v111
v_mfma_f32_16x16x32_bf16 v[100:103], a[200:203], v[32:35], v[100:103]
v_exp_f32 v112, v112
v_mfma_f32_16x16x32_bf16 v[100:103], a[196:199], v[28:31], v[100:103]
v_exp_f32 v113, v113
v_mfma_f32_16x16x32_bf16 v[100:103], a[192:195], v[24:27], v[100:103]
v_exp_f32 v114, v114
v_smfmac_f32_16x16x64_bf16 a[128:131], a[240:243], v[168:175], v5
ds_read_b128 a[168:171], v3 offset:3072
v_smfmac_f32_16x16x64_bf16 a[132:135], a[240:243], v[176:183], v5
ds_read_b128 a[172:175], v3 offset:11264
v_smfmac_f32_16x16x64_bf16 a[136:139], a[240:243], v[200:207], v5
ds_read_b128 a[176:179], v3 offset:4096
v_smfmac_f32_16x16x64_bf16 a[140:143], a[240:243], v[208:215], v5
s_waitcnt lgkmcnt(3)
buffer_load_dwordx4 v16, s[32:35], s64 offen offset:2048 sc1 lds
v_mfma_f32_16x16x32_bf16 a[0:3], a[144:147], v[168:171], a[0:3]
v_exp_f32 v115, v115
v_mfma_f32_16x16x32_bf16 a[0:3], a[148:151], v[172:175], a[0:3]
v_exp_f32 v128, v128
v_mfma_f32_16x16x32_bf16 a[32:35], a[148:151], v[180:183], a[32:35]
v_exp_f32 v129, v129
v_mfma_f32_16x16x32_bf16 a[32:35], a[144:147], v[176:179], a[32:35]
v_exp_f32 v130, v130
v_mfma_f32_16x16x32_bf16 a[64:67], a[144:147], v[200:203], a[64:67]
v_exp_f32 v131, v131
v_mfma_f32_16x16x32_bf16 a[64:67], a[148:151], v[204:207], a[64:67]
v_cvt_pk_bf16_f32 v154, v92, v93
v_cvt_pk_bf16_f32 v155, v94, v95
v_mfma_f32_16x16x32_bf16 a[96:99], a[148:151], v[212:215], a[96:99]
v_exp_f32 v144, v144
v_mfma_f32_16x16x32_bf16 a[96:99], a[144:147], v[208:211], a[96:99]
ds_read_b128 a[180:183], v3 offset:12288
v_cvt_pk_bf16_f32 v156, v96, v97
v_mfma_f32_16x16x32_bf16 a[100:103], a[152:155], v[208:211], a[100:103]
v_exp_f32 v145, v145
v_mfma_f32_16x16x32_bf16 a[100:103], a[156:159], v[212:215], a[100:103]
ds_read_b128 a[184:187], v3 offset:5120
v_cvt_pk_bf16_f32 v157, v98, v99
v_mfma_f32_16x16x32_bf16 a[68:71], a[156:159], v[204:207], a[68:71]
ds_read_b128 a[188:191], v3 offset:13312
v_cvt_pk_bf16_f32 v164, v112, v113
v_mfma_f32_16x16x32_bf16 a[68:71], a[152:155], v[200:203], a[68:71]
buffer_load_dwordx4 v16, s[32:35], s64 offen offset:3072 sc1 lds
v_mfma_f32_16x16x32_bf16 a[36:39], a[152:155], v[176:179], a[36:39]
ds_read_b128 a[192:195], v3 offset:6144
v_cvt_pk_bf16_f32 v165, v114, v115
v_mfma_f32_16x16x32_bf16 a[36:39], a[156:159], v[180:183], a[36:39]
ds_read_b128 a[196:199], v3 offset:14336
v_cvt_pk_bf16_f32 v188, v128, v129
v_mfma_f32_16x16x32_bf16 a[4:7], a[156:159], v[172:175], a[4:7]
ds_read_b128 a[200:203], v3 offset:7168
v_cvt_pk_bf16_f32 v189, v130, v131
v_mfma_f32_16x16x32_bf16 a[4:7], a[152:155], v[168:171], a[4:7]
v_exp_f32 v146, v146
v_mfma_f32_16x16x32_bf16 a[8:11], a[160:163], v[168:171], a[8:11]
v_exp_f32 v147, v147
v_mfma_f32_16x16x32_bf16 a[8:11], a[164:167], v[172:175], a[8:11]
v_exp_f32 v148, v148
v_mfma_f32_16x16x32_bf16 a[40:43], a[164:167], v[180:183], a[40:43]
ds_read_b128 a[204:207], v3 offset:15360
v_cvt_pk_bf16_f32 v196, v144, v145
v_mfma_f32_16x16x32_bf16 a[40:43], a[160:163], v[176:179], a[40:43]
v_exp_f32 v149, v149
v_mfma_f32_16x16x32_bf16 a[72:75], a[160:163], v[200:203], a[72:75]
v_exp_f32 v150, v150
v_mfma_f32_16x16x32_bf16 a[72:75], a[164:167], v[204:207], a[72:75]
v_exp_f32 v151, v151
v_mfma_f32_16x16x32_bf16 a[104:107], a[164:167], v[212:215], a[104:107]
v_exp_f32 v132, v132
v_mfma_f32_16x16x32_bf16 a[104:107], a[160:163], v[208:211], a[104:107]
s_waitcnt lgkmcnt(1)
v_exp_f32 v133, v133
v_mfma_f32_16x16x32_bf16 a[108:111], a[168:171], v[208:211], a[108:111]
v_exp_f32 v134, v134
v_mfma_f32_16x16x32_bf16 a[108:111], a[172:175], v[212:215], a[108:111]
v_exp_f32 v135, v135
v_mfma_f32_16x16x32_bf16 a[76:79], a[172:175], v[204:207], a[76:79]
v_exp_f32 v116, v116
v_mfma_f32_16x16x32_bf16 a[76:79], a[168:171], v[200:203], a[76:79]
v_exp_f32 v117, v117
v_mfma_f32_16x16x32_bf16 a[44:47], a[168:171], v[176:179], a[44:47]
v_exp_f32 v118, v118
v_mfma_f32_16x16x32_bf16 a[44:47], a[172:175], v[180:183], a[44:47]
s_waitcnt vmcnt(9)
s_barrier
v_mfma_f32_16x16x32_bf16 a[12:15], a[172:175], v[172:175], a[12:15]
s_xor_b32 s71, s71, 16384
v_exp_f32 v119, v119
v_mfma_f32_16x16x32_bf16 a[12:15], a[168:171], v[168:171], a[12:15]
s_add_u32 s70, s70, 32768
v_exp_f32 v100, v100
v_mfma_f32_16x16x32_bf16 a[16:19], a[176:179], v[168:171], a[16:19]
s_mov_b32 m0, s71
v_exp_f32 v101, v101
v_mfma_f32_16x16x32_bf16 a[16:19], a[180:183], v[172:175], a[16:19]
buffer_load_dwordx4 v16, s[32:35], s70 offen offset:0 sc1 lds
v_mfma_f32_16x16x32_bf16 a[48:51], a[180:183], v[180:183], a[48:51]
ds_read_b128 a[144:147], v2 offset:16384
v_cvt_pk_bf16_f32 v197, v146, v147
v_mfma_f32_16x16x32_bf16 a[48:51], a[176:179], v[176:179], a[48:51]
ds_read_b128 a[148:151], v2 offset:17408
v_cvt_pk_bf16_f32 v198, v148, v149
v_mfma_f32_16x16x32_bf16 a[80:83], a[176:179], v[200:203], a[80:83]
v_exp_f32 v102, v102
v_mfma_f32_16x16x32_bf16 a[80:83], a[180:183], v[204:207], a[80:83]
ds_read_b128 a[152:155], v2 offset:18432
v_cvt_pk_bf16_f32 v199, v150, v151
v_mfma_f32_16x16x32_bf16 a[112:115], a[180:183], v[212:215], a[112:115]
ds_read_b128 a[156:159], v2 offset:19456
v_cvt_pk_bf16_f32 v190, v132, v133
v_mfma_f32_16x16x32_bf16 a[112:115], a[176:179], v[208:211], a[112:115]
v_exp_f32 v103, v103
v_mfma_f32_16x16x32_bf16 a[116:119], a[184:187], v[208:211], a[116:119]
ds_read_b128 a[160:163], v2 offset:20480
v_cvt_pk_bf16_f32 v191, v134, v135
v_mfma_f32_16x16x32_bf16 a[116:119], a[188:191], v[212:215], a[116:119]
ds_read_b128 a[164:167], v2 offset:21504
v_cvt_pk_bf16_f32 v166, v116, v117
v_mfma_f32_16x16x32_bf16 a[84:87], a[188:191], v[204:207], a[84:87]
ds_read_b128 a[168:171], v2 offset:22528
v_cvt_pk_bf16_f32 v167, v118, v119
v_mfma_f32_16x16x32_bf16 a[84:87], a[184:187], v[200:203], a[84:87]
ds_read_b128 a[172:175], v2 offset:23552
v_cvt_pk_bf16_f32 v158, v100, v101
v_mfma_f32_16x16x32_bf16 a[52:55], a[184:187], v[176:179], a[52:55]
v_cvt_pk_bf16_f32 v159, v102, v103
v_mfma_f32_16x16x32_bf16 a[52:55], a[188:191], v[180:183], a[52:55]
v_mfma_f32_16x16x32_bf16 a[20:23], a[188:191], v[172:175], a[20:23]
v_mfma_f32_16x16x32_bf16 a[20:23], a[184:187], v[168:171], a[20:23]
v_mfma_f32_16x16x32_bf16 a[24:27], a[192:195], v[168:171], a[24:27]
buffer_load_dwordx4 v16, s[32:35], s70 offen offset:1024 sc1 lds
v_mfma_f32_16x16x32_bf16 a[24:27], a[196:199], v[172:175], a[24:27]
v_mfma_f32_16x16x32_bf16 a[56:59], a[196:199], v[180:183], a[56:59]
v_mfma_f32_16x16x32_bf16 a[56:59], a[192:195], v[176:179], a[56:59]
v_mfma_f32_16x16x32_bf16 a[88:91], a[192:195], v[200:203], a[88:91]
v_mfma_f32_16x16x32_bf16 a[88:91], a[196:199], v[204:207], a[88:91]
v_mfma_f32_16x16x32_bf16 a[120:123], a[196:199], v[212:215], a[120:123]
v_mfma_f32_16x16x32_bf16 a[120:123], a[192:195], v[208:211], a[120:123]
v_mfma_f32_16x16x32_bf16 a[124:127], a[200:203], v[208:211], a[124:127]
s_waitcnt lgkmcnt(0)
v_mfma_f32_16x16x32_bf16 a[124:127], a[204:207], v[212:215], a[124:127]
v_mfma_f32_16x16x32_bf16 a[92:95], a[204:207], v[204:207], a[92:95]
v_mfma_f32_16x16x32_bf16 a[92:95], a[200:203], v[200:203], a[92:95]
v_mfma_f32_16x16x32_bf16 a[60:63], a[200:203], v[176:179], a[60:63]
v_mfma_f32_16x16x32_bf16 a[60:63], a[204:207], v[180:183], a[60:63]
v_mfma_f32_16x16x32_bf16 a[28:31], a[204:207], v[172:175], a[28:31]
v_mfma_f32_16x16x32_bf16 a[28:31], a[200:203], v[168:171], a[28:31]
v_mfma_f32_16x16x32_bf16 v[88:91], a[144:147], v[24:27], v[216:219]
ds_read_b128 a[176:179], v2 offset:24576
v_mfma_f32_16x16x32_bf16 v[88:91], a[148:151], v[28:31], v[88:91]
ds_read_b128 a[180:183], v2 offset:25600
v_mfma_f32_16x16x32_bf16 v[88:91], a[152:155], v[32:35], v[88:91]
buffer_load_dwordx4 v16, s[32:35], s70 offen offset:2048 sc1 lds
v_mfma_f32_16x16x32_bf16 v[88:91], a[156:159], v[36:39], v[88:91]
ds_read_b128 a[184:187], v2 offset:26624
v_mfma_f32_16x16x32_bf16 v[104:107], a[156:159], v[52:55], v[220:223]
v_mfma_f32_16x16x32_bf16 v[104:107], a[152:155], v[48:51], v[104:107]
v_mfma_f32_16x16x32_bf16 v[104:107], a[148:151], v[44:47], v[104:107]
ds_read_b128 a[188:191], v2 offset:27648
v_mfma_f32_16x16x32_bf16 v[104:107], a[144:147], v[40:43], v[104:107]
v_mfma_f32_16x16x32_bf16 v[120:123], a[144:147], v[56:59], v[224:227]
v_mfma_f32_16x16x32_bf16 v[120:123], a[148:151], v[60:63], v[120:123]
v_mfma_f32_16x16x32_bf16 v[120:123], a[152:155], v[64:67], v[120:123]
v_exp_f32 v88, v88
v_mfma_f32_16x16x32_bf16 v[120:123], a[156:159], v[68:71], v[120:123]
v_exp_f32 v89, v89
v_mfma_f32_16x16x32_bf16 v[136:139], a[156:159], v[84:87], v[228:231]
v_exp_f32 v90, v90
v_mfma_f32_16x16x32_bf16 v[136:139], a[152:155], v[80:83], v[136:139]
v_exp_f32 v91, v91
v_mfma_f32_16x16x32_bf16 v[136:139], a[148:151], v[76:79], v[136:139]
v_exp_f32 v104, v104
v_mfma_f32_16x16x32_bf16 v[136:139], a[144:147], v[72:75], v[136:139]
v_exp_f32 v105, v105
v_mfma_f32_16x16x32_bf16 v[140:143], a[160:163], v[72:75], v[228:231]
v_exp_f32 v106, v106
v_mfma_f32_16x16x32_bf16 v[140:143], a[164:167], v[76:79], v[140:143]
buffer_load_dwordx4 v16, s[32:35], s70 offen offset:3072 sc1 lds
v_mfma_f32_16x16x32_bf16 v[140:143], a[168:171], v[80:83], v[140:143]
v_exp_f32 v107, v107
v_mfma_f32_16x16x32_bf16 v[140:143], a[172:175], v[84:87], v[140:143]
v_cvt_pk_bf16_f32 v168, v88, v89
v_cvt_pk_bf16_f32 v169, v90, v91
v_mfma_f32_16x16x32_bf16 v[124:127], a[172:175], v[68:71], v[224:227]
v_exp_f32 v120, v120
v_mfma_f32_16x16x32_bf16 v[124:127], a[168:171], v[64:67], v[124:127]
v_exp_f32 v121, v121
v_mfma_f32_16x16x32_bf16 v[124:127], a[164:167], v[60:63], v[124:127]
v_exp_f32 v122, v122
v_mfma_f32_16x16x32_bf16 v[124:127], a[160:163], v[56:59], v[124:127]
v_exp_f32 v123, v123
v_mfma_f32_16x16x32_bf16 v[108:111], a[160:163], v[40:43], v[220:223]
v_exp_f32 v136, v136
v_mfma_f32_16x16x32_bf16 v[108:111], a[164:167], v[44:47], v[108:111]
v_exp_f32 v137, v137
v_mfma_f32_16x16x32_bf16 v[108:111], a[168:171], v[48:51], v[108:111]
v_exp_f32 v138, v138
v_mfma_f32_16x16x32_bf16 v[108:111], a[172:175], v[52:55], v[108:111]
v_cvt_pk_bf16_f32 v176, v104, v105
v_cvt_pk_bf16_f32 v177, v106, v107
v_mfma_f32_16x16x32_bf16 v[92:95], a[172:175], v[36:39], v[216:219]
v_exp_f32 v139, v139
v_mfma_f32_16x16x32_bf16 v[92:95], a[168:171], v[32:35], v[92:95]
ds_read_b128 a[192:195], v2 offset:28672
v_cvt_pk_bf16_f32 v200, v120, v121
v_mfma_f32_16x16x32_bf16 v[92:95], a[164:167], v[28:31], v[92:95]
v_exp_f32 v140, v140
v_mfma_f32_16x16x32_bf16 v[92:95], a[160:163], v[24:27], v[92:95]
s_waitcnt lgkmcnt(1)
s_add_u32 m0, s71, 4096
ds_read_b128 a[196:199], v2 offset:29696
v_cvt_pk_bf16_f32 v201, v122, v123
v_mfma_f32_16x16x32_bf16 v[96:99], a[176:179], v[24:27], v[216:219]
s_add_u32 s64, s70, 4096
ds_read_b128 a[200:203], v2 offset:30720
v_cvt_pk_bf16_f32 v208, v136, v137
v_mfma_f32_16x16x32_bf16 v[96:99], a[180:183], v[28:31], v[96:99]
buffer_load_dwordx4 v16, s[32:35], s64 offen offset:0 sc1 lds
v_mfma_f32_16x16x32_bf16 v[96:99], a[184:187], v[32:35], v[96:99]
v_exp_f32 v141, v141
v_mfma_f32_16x16x32_bf16 v[96:99], a[188:191], v[36:39], v[96:99]
ds_read_b128 a[204:207], v2 offset:31744
v_cvt_pk_bf16_f32 v209, v138, v139
v_mfma_f32_16x16x32_bf16 v[112:115], a[188:191], v[52:55], v[220:223]
v_exp_f32 v142, v142
v_mfma_f32_16x16x32_bf16 v[112:115], a[184:187], v[48:51], v[112:115]
v_exp_f32 v143, v143
v_mfma_f32_16x16x32_bf16 v[112:115], a[180:183], v[44:47], v[112:115]
v_exp_f32 v124, v124
v_mfma_f32_16x16x32_bf16 v[112:115], a[176:179], v[40:43], v[112:115]
v_exp_f32 v125, v125
v_mfma_f32_16x16x32_bf16 v[128:131], a[176:179], v[56:59], v[224:227]
v_exp_f32 v126, v126
v_mfma_f32_16x16x32_bf16 v[128:131], a[180:183], v[60:63], v[128:131]
v_exp_f32 v127, v127
v_mfma_f32_16x16x32_bf16 v[128:131], a[184:187], v[64:67], v[128:131]
v_exp_f32 v108, v108
v_mfma_f32_16x16x32_bf16 v[128:131], a[188:191], v[68:71], v[128:131]
v_exp_f32 v109, v109
v_mfma_f32_16x16x32_bf16 v[144:147], a[188:191], v[84:87], v[228:231]
v_exp_f32 v110, v110
v_mfma_f32_16x16x32_bf16 v[144:147], a[184:187], v[80:83], v[144:147]
ds_read_b128 a[144:147], v3 offset:16384
v_cvt_pk_bf16_f32 v210, v140, v141
v_mfma_f32_16x16x32_bf16 v[144:147], a[180:183], v[76:79], v[144:147]
ds_read_b128 a[148:151], v3 offset:24576
v_cvt_pk_bf16_f32 v211, v142, v143
v_mfma_f32_16x16x32_bf16 v[144:147], a[176:179], v[72:75], v[144:147]
s_waitcnt lgkmcnt(2)
v_exp_f32 v111, v111
v_mfma_f32_16x16x32_bf16 v[148:151], a[192:195], v[72:75], v[228:231]
s_branch L_po16
L_pg16:
s_branch L_pg20
L_po16:
buffer_load_dwordx4 v16, s[32:35], s64 offen offset:1024 sc1 lds
v_mfma_f32_16x16x32_bf16 v[148:151], a[196:199], v[76:79], v[148:151]
v_exp_f32 v92, v92
v_mfma_f32_16x16x32_bf16 v[148:151], a[200:203], v[80:83], v[148:151]
v_exp_f32 v93, v93
v_mfma_f32_16x16x32_bf16 v[148:151], a[204:207], v[84:87], v[148:151]
v_exp_f32 v94, v94
v_mfma_f32_16x16x32_bf16 v[132:135], a[204:207], v[68:71], v[224:227]
ds_read_b128 a[152:155], v3 offset:17408
v_cvt_pk_bf16_f32 v202, v124, v125
v_mfma_f32_16x16x32_bf16 v[132:135], a[200:203], v[64:67], v[132:135]
ds_read_b128 a[156:159], v3 offset:25600
v_cvt_pk_bf16_f32 v203, v126, v127
v_mfma_f32_16x16x32_bf16 v[132:135], a[196:199], v[60:63], v[132:135]
v_exp_f32 v95, v95
v_mfma_f32_16x16x32_bf16 v[132:135], a[192:195], v[56:59], v[132:135]
v_exp_f32 v96, v96
v_mfma_f32_16x16x32_bf16 v[116:119], a[192:195], v[40:43], v[220:223]
v_exp_f32 v97, v97
v_mfma_f32_16x16x32_bf16 v[116:119], a[196:199], v[44:47], v[116:119]
v_exp_f32 v98, v98
v_mfma_f32_16x16x32_bf16 v[116:119], a[200:203], v[48:51], v[116:119]
ds_read_b128 a[160:163], v3 offset:18432
v_cvt_pk_bf16_f32 v178, v108, v109
v_mfma_f32_16x16x32_bf16 v[116:119], a[204:207], v[52:55], v[116:119]
v_exp_f32 v99, v99
v_mfma_f32_16x16x32_bf16 v[100:103], a[204:207], v[36:39], v[216:219]
ds_read_b128 a[164:167], v3 offset:26624
v_cvt_pk_bf16_f32 v179, v110, v111
v_mfma_f32_16x16x32_bf16 v[100:103], a[200:203], v[32:35], v[100:103]
v_exp_f32 v112, v112
v_mfma_f32_16x16x32_bf16 v[100:103], a[196:199], v[28:31], v[100:103]
v_exp_f32 v113, v113
v_mfma_f32_16x16x32_bf16 v[100:103], a[192:195], v[24:27], v[100:103]
v_exp_f32 v114, v114
v_smfmac_f32_16x16x64_bf16 a[128:131], a[240:243], v[152:159], v5
ds_read_b128 a[168:171], v3 offset:19456
v_smfmac_f32_16x16x64_bf16 a[132:135], a[240:243], v[160:167], v5
ds_read_b128 a[172:175], v3 offset:27648
v_smfmac_f32_16x16x64_bf16 a[136:139], a[240:243], v[184:191], v5
ds_read_b128 a[176:179], v3 offset:20480
v_smfmac_f32_16x16x64_bf16 a[140:143], a[240:243], v[192:199], v5
s_waitcnt lgkmcnt(3)
buffer_load_dwordx4 v16, s[32:35], s64 offen offset:2048 sc1 lds
v_mfma_f32_16x16x32_bf16 a[0:3], a[144:147], v[152:155], a[0:3]
v_exp_f32 v115, v115
v_mfma_f32_16x16x32_bf16 a[0:3], a[148:151], v[156:159], a[0:3]
v_exp_f32 v128, v128
v_mfma_f32_16x16x32_bf16 a[32:35], a[148:151], v[164:167], a[32:35]
v_exp_f32 v129, v129
v_mfma_f32_16x16x32_bf16 a[32:35], a[144:147], v[160:163], a[32:35]
v_exp_f32 v130, v130
v_mfma_f32_16x16x32_bf16 a[64:67], a[144:147], v[184:187], a[64:67]
v_exp_f32 v131, v131
v_mfma_f32_16x16x32_bf16 a[64:67], a[148:151], v[188:191], a[64:67]
v_cvt_pk_bf16_f32 v170, v92, v93
v_cvt_pk_bf16_f32 v171, v94, v95
v_mfma_f32_16x16x32_bf16 a[96:99], a[148:151], v[196:199], a[96:99]
v_exp_f32 v144, v144
v_mfma_f32_16x16x32_bf16 a[96:99], a[144:147], v[192:195], a[96:99]
ds_read_b128 a[180:183], v3 offset:28672
v_cvt_pk_bf16_f32 v172, v96, v97
v_mfma_f32_16x16x32_bf16 a[100:103], a[152:155], v[192:195], a[100:103]
v_exp_f32 v145, v145
v_mfma_f32_16x16x32_bf16 a[100:103], a[156:159], v[196:199], a[100:103]
ds_read_b128 a[184:187], v3 offset:21504
v_xor_b32 v2, 0x8000, v2
v_mfma_f32_16x16x32_bf16 a[68:71], a[156:159], v[188:191], a[68:71]
ds_read_b128 a[188:191], v3 offset:29696
v_cvt_pk_bf16_f32 v173, v98, v99
v_mfma_f32_16x16x32_bf16 a[68:71], a[152:155], v[184:187], a[68:71]
buffer_load_dwordx4 v16, s[32:35], s64 offen offset:3072 sc1 lds
v_mfma_f32_16x16x32_bf16 a[36:39], a[152:155], v[160:163], a[36:39]
ds_read_b128 a[192:195], v3 offset:22528
v_cvt_pk_bf16_f32 v180, v112, v113
v_mfma_f32_16x16x32_bf16 a[36:39], a[156:159], v[164:167], a[36:39]
ds_read_b128 a[196:199], v3 offset:30720
v_cvt_pk_bf16_f32 v181, v114, v115
v_mfma_f32_16x16x32_bf16 a[4:7], a[156:159], v[156:159], a[4:7]
ds_read_b128 a[200:203], v3 offset:23552
v_cvt_pk_bf16_f32 v204, v128, v129
v_mfma_f32_16x16x32_bf16 a[4:7], a[152:155], v[152:155], a[4:7]
v_exp_f32 v146, v146
v_mfma_f32_16x16x32_bf16 a[8:11], a[160:163], v[152:155], a[8:11]
v_exp_f32 v147, v147
v_mfma_f32_16x16x32_bf16 a[8:11], a[164:167], v[156:159], a[8:11]
v_exp_f32 v148, v148
v_mfma_f32_16x16x32_bf16 a[40:43], a[164:167], v[164:167], a[40:43]
ds_read_b128 a[204:207], v3 offset:31744
v_cvt_pk_bf16_f32 v205, v130, v131
v_mfma_f32_16x16x32_bf16 a[40:43], a[160:163], v[160:163], a[40:43]
v_exp_f32 v149, v149
v_mfma_f32_16x16x32_bf16 a[72:75], a[160:163], v[184:187], a[72:75]
v_exp_f32 v150, v150
v_mfma_f32_16x16x32_bf16 a[72:75], a[164:167], v[188:191], a[72:75]
v_exp_f32 v151, v151
v_mfma_f32_16x16x32_bf16 a[104:107], a[164:167], v[196:199], a[104:107]
v_exp_f32 v132, v132
v_mfma_f32_16x16x32_bf16 a[104:107], a[160:163], v[192:195], a[104:107]
s_waitcnt lgkmcnt(1)
v_exp_f32 v133, v133
v_mfma_f32_16x16x32_bf16 a[108:111], a[168:171], v[192:195], a[108:111]
v_exp_f32 v134, v134
v_mfma_f32_16x16x32_bf16 a[108:111], a[172:175], v[196:199], a[108:111]
v_exp_f32 v135, v135
v_mfma_f32_16x16x32_bf16 a[76:79], a[172:175], v[188:191], a[76:79]
v_exp_f32 v116, v116
v_mfma_f32_16x16x32_bf16 a[76:79], a[168:171], v[184:187], a[76:79]
v_exp_f32 v117, v117
v_mfma_f32_16x16x32_bf16 a[44:47], a[168:171], v[160:163], a[44:47]
v_exp_f32 v118, v118
v_mfma_f32_16x16x32_bf16 a[44:47], a[172:175], v[164:167], a[44:47]
s_waitcnt vmcnt(8)
s_barrier
v_mfma_f32_16x16x32_bf16 a[12:15], a[172:175], v[156:159], a[12:15]
s_xor_b32 s71, s71, 49152
v_exp_f32 v119, v119
v_mfma_f32_16x16x32_bf16 a[12:15], a[168:171], v[152:155], a[12:15]
s_add_u32 s70, s70, 32768
v_exp_f32 v100, v100
v_mfma_f32_16x16x32_bf16 a[16:19], a[176:179], v[152:155], a[16:19]
s_mov_b32 m0, s71
v_exp_f32 v101, v101
v_mfma_f32_16x16x32_bf16 a[16:19], a[180:183], v[156:159], a[16:19]
buffer_load_dwordx4 v16, s[32:35], s70 offen offset:0 sc1 lds
v_mfma_f32_16x16x32_bf16 a[48:51], a[180:183], v[164:167], a[48:51]
ds_read_b128 a[144:147], v2 offset:0
v_cvt_pk_bf16_f32 v212, v144, v145
v_mfma_f32_16x16x32_bf16 a[48:51], a[176:179], v[160:163], a[48:51]
ds_read_b128 a[148:151], v2 offset:1024
v_cvt_pk_bf16_f32 v213, v146, v147
v_mfma_f32_16x16x32_bf16 a[80:83], a[176:179], v[184:187], a[80:83]
v_exp_f32 v102, v102
v_mfma_f32_16x16x32_bf16 a[80:83], a[180:183], v[188:191], a[80:83]
ds_read_b128 a[152:155], v2 offset:2048
v_cvt_pk_bf16_f32 v214, v148, v149
v_mfma_f32_16x16x32_bf16 a[112:115], a[180:183], v[196:199], a[112:115]
ds_read_b128 a[156:159], v2 offset:3072
v_cvt_pk_bf16_f32 v215, v150, v151
v_mfma_f32_16x16x32_bf16 a[112:115], a[176:179], v[192:195], a[112:115]
v_exp_f32 v103, v103
v_mfma_f32_16x16x32_bf16 a[116:119], a[184:187], v[192:195], a[116:119]
ds_read_b128 a[160:163], v2 offset:4096
v_cvt_pk_bf16_f32 v206, v132, v133
v_mfma_f32_16x16x32_bf16 a[116:119], a[188:191], v[196:199], a[116:119]
ds_read_b128 a[164:167], v2 offset:5120
v_cvt_pk_bf16_f32 v207, v134, v135
v_mfma_f32_16x16x32_bf16 a[84:87], a[188:191], v[188:191], a[84:87]
ds_read_b128 a[168:171], v2 offset:6144
v_xor_b32 v3, 0x8000, v3
v_mfma_f32_16x16x32_bf16 a[84:87], a[184:187], v[184:187], a[84:87]
ds_read_b128 a[172:175], v2 offset:7168
v_cvt_pk_bf16_f32 v182, v116, v117
v_mfma_f32_16x16x32_bf16 a[52:55], a[184:187], v[160:163], a[52:55]
v_cvt_pk_bf16_f32 v183, v118, v119
v_cvt_pk_bf16_f32 v174, v100, v101
v_mfma_f32_16x16x32_bf16 a[52:55], a[188:191], v[164:167], a[52:55]
v_cvt_pk_bf16_f32 v175, v102, v103
v_mfma_f32_16x16x32_bf16 a[20:23], a[188:191], v[156:159], a[20:23]
v_mfma_f32_16x16x32_bf16 a[20:23], a[184:187], v[152:155], a[20:23]
v_mfma_f32_16x16x32_bf16 a[24:27], a[192:195], v[152:155], a[24:27]
buffer_load_dwordx4 v16, s[32:35], s70 offen offset:1024 sc1 lds
v_mfma_f32_16x16x32_bf16 a[24:27], a[196:199], v[156:159], a[24:27]
v_mfma_f32_16x16x32_bf16 a[56:59], a[196:199], v[164:167], a[56:59]
v_mfma_f32_16x16x32_bf16 a[56:59], a[192:195], v[160:163], a[56:59]
v_mfma_f32_16x16x32_bf16 a[88:91], a[192:195], v[184:187], a[88:91]
v_mfma_f32_16x16x32_bf16 a[88:91], a[196:199], v[188:191], a[88:91]
v_mfma_f32_16x16x32_bf16 a[120:123], a[196:199], v[196:199], a[120:123]
s_sub_u32 s72, s72, 1
v_mfma_f32_16x16x32_bf16 a[120:123], a[192:195], v[192:195], a[120:123]
v_mfma_f32_16x16x32_bf16 a[124:127], a[200:203], v[192:195], a[124:127]
s_waitcnt lgkmcnt(0)
v_mfma_f32_16x16x32_bf16 a[124:127], a[204:207], v[196:199], a[124:127]
v_mfma_f32_16x16x32_bf16 a[92:95], a[204:207], v[188:191], a[92:95]
s_cmp_lg_u32 s72, 0
v_mfma_f32_16x16x32_bf16 a[92:95], a[200:203], v[184:187], a[92:95]
v_mfma_f32_16x16x32_bf16 a[60:63], a[200:203], v[160:163], a[60:63]
v_mfma_f32_16x16x32_bf16 a[60:63], a[204:207], v[164:167], a[60:63]
v_mfma_f32_16x16x32_bf16 a[28:31], a[204:207], v[156:159], a[28:31]
v_mfma_f32_16x16x32_bf16 a[28:31], a[200:203], v[152:155], a[28:31]
s_cbranch_scc1 L_D
L_DD:
s_waitcnt lgkmcnt(7)
v_mfma_f32_16x16x32_bf16 v[104:107], a[144:147], v[40:43], v[220:223]
s_waitcnt lgkmcnt(6)
ds_read_b128 a[176:179], v2 offset:8192
v_cndmask_b32 v88, v216, v17, s[0:1]
v_mfma_f32_16x16x32_bf16 v[104:107], a[148:151], v[44:47], v[104:107]
s_waitcnt lgkmcnt(6)
ds_read_b128 a[180:183], v2 offset:9216
v_cndmask_b32 v89, v216, v17, s[4:5]
v_mfma_f32_16x16x32_bf16 v[104:107], a[152:155], v[48:51], v[104:107]
s_waitcnt lgkmcnt(6)
buffer_load_dwordx4 v16, s[32:35], s70 offen offset:2048 sc1 lds
v_mfma_f32_16x16x32_bf16 v[104:107], a[156:159], v[52:55], v[104:107]
ds_read_b128 a[184:187], v2 offset:10240
v_cndmask_b32 v90, v216, v17, s[6:7]
v_mfma_f32_16x16x32_bf16 v[120:123], a[156:159], v[68:71], v[224:227]
ds_read_b128 a[188:191], v2 offset:11264
v_cndmask_b32 v91, v216, v17, s[8:9]
v_mfma_f32_16x16x32_bf16 v[120:123], a[152:155], v[64:67], v[120:123]
ds_read_b128 a[192:195], v2 offset:12288
v_cndmask_b32 v92, v216, v17, s[10:11]
v_mfma_f32_16x16x32_bf16 v[120:123], a[148:151], v[60:63], v[120:123]
ds_read_b128 a[196:199], v2 offset:13312
v_cndmask_b32 v93, v216, v17, s[12:13]
v_mfma_f32_16x16x32_bf16 v[120:123], a[144:147], v[56:59], v[120:123]
ds_read_b128 a[200:203], v2 offset:14336
v_cndmask_b32 v94, v216, v17, s[18:19]
v_mfma_f32_16x16x32_bf16 v[136:139], a[144:147], v[72:75], v[228:231]
ds_read_b128 a[204:207], v2 offset:15360
v_cndmask_b32 v95, v216, v17, s[22:23]
v_mfma_f32_16x16x32_bf16 v[136:139], a[148:151], v[76:79], v[136:139]
v_cndmask_b32 v96, v216, v17, s[26:27]
v_cndmask_b32 v97, v216, v17, s[56:57]
v_mfma_f32_16x16x32_bf16 v[136:139], a[152:155], v[80:83], v[136:139]
v_exp_f32 v104, v104
v_mfma_f32_16x16x32_bf16 v[136:139], a[156:159], v[84:87], v[136:139]
v_exp_f32 v105, v105
v_mfma_f32_16x16x32_bf16 v[88:91], a[156:159], v[36:39], v[88:91]
v_exp_f32 v106, v106
v_mfma_f32_16x16x32_bf16 v[88:91], a[152:155], v[32:35], v[88:91]
v_exp_f32 v107, v107
v_mfma_f32_16x16x32_bf16 v[88:91], a[148:151], v[28:31], v[88:91]
v_exp_f32 v120, v120
v_mfma_f32_16x16x32_bf16 v[88:91], a[144:147], v[24:27], v[88:91]
s_waitcnt lgkmcnt(0)
v_exp_f32 v121, v121
v_mfma_f32_16x16x32_bf16 v[140:143], a[160:163], v[72:75], v[228:231]
v_exp_f32 v122, v122
v_mfma_f32_16x16x32_bf16 v[140:143], a[164:167], v[76:79], v[140:143]
buffer_load_dwordx4 v16, s[32:35], s70 offen offset:3072 sc1 lds
v_mfma_f32_16x16x32_bf16 v[140:143], a[168:171], v[80:83], v[140:143]
s_add_u32 m0, s86, 131072
v_exp_f32 v123, v123
v_mfma_f32_16x16x32_bf16 v[140:143], a[172:175], v[84:87], v[140:143]
s_add_u32 s64, s85, 0
v_cvt_pk_bf16_f32 v160, v104, v105
v_cvt_pk_bf16_f32 v161, v106, v107
v_mfma_f32_16x16x32_bf16 v[124:127], a[172:175], v[68:71], v[224:227]
buffer_load_dwordx4 v12, s[36:39], s64 offen lds
v_mfma_f32_16x16x32_bf16 v[124:127], a[168:171], v[64:67], v[124:127]
s_add_u32 m0, s86, 132096
v_exp_f32 v136, v136
v_mfma_f32_16x16x32_bf16 v[124:127], a[164:167], v[60:63], v[124:127]
s_add_u32 s64, s85, 8192
v_exp_f32 v137, v137
v_mfma_f32_16x16x32_bf16 v[124:127], a[160:163], v[56:59], v[124:127]
buffer_load_dwordx4 v13, s[36:39], s64 offen lds
v_mfma_f32_16x16x32_bf16 v[108:111], a[160:163], v[40:43], v[220:223]
v_exp_f32 v138, v138
v_mfma_f32_16x16x32_bf16 v[108:111], a[164:167], v[44:47], v[108:111]
ds_read_b128 a[144:147], v3 offset:0
v_cndmask_b32 v98, v216, v17, s[58:59]
v_mfma_f32_16x16x32_bf16 v[108:111], a[168:171], v[48:51], v[108:111]
s_add_u32 m0, s86, 133120
ds_read_b128 a[148:151], v3 offset:8192
v_cndmask_b32 v99, v216, v17, s[60:61]
v_mfma_f32_16x16x32_bf16 v[108:111], a[172:175], v[52:55], v[108:111]
s_add_u32 s64, s85, 16384
v_cvt_pk_bf16_f32 v184, v120, v121
v_cvt_pk_bf16_f32 v185, v122, v123
v_mfma_f32_16x16x32_bf16 v[92:95], a[172:175], v[36:39], v[92:95]
buffer_load_dwordx4 v12, s[36:39], s64 offen lds
v_mfma_f32_16x16x32_bf16 v[92:95], a[168:171], v[32:35], v[92:95]
s_add_u32 m0, s86, 134144
v_exp_f32 v139, v139
v_mfma_f32_16x16x32_bf16 v[92:95], a[164:167], v[28:31], v[92:95]
s_add_u32 s64, s85, 24576
v_exp_f32 v88, v88
v_mfma_f32_16x16x32_bf16 v[92:95], a[160:163], v[24:27], v[92:95]
buffer_load_dwordx4 v13, s[36:39], s64 offen lds
v_mfma_f32_16x16x32_bf16 v[96:99], a[176:179], v[24:27], v[96:99]
s_add_u32 m0, s71, 4096
v_exp_f32 v89, v89
v_mfma_f32_16x16x32_bf16 v[96:99], a[180:183], v[28:31], v[96:99]
s_add_u32 s64, s70, 4096
v_exp_f32 v90, v90
v_mfma_f32_16x16x32_bf16 v[96:99], a[184:187], v[32:35], v[96:99]
buffer_load_dwordx4 v16, s[32:35], s64 offen offset:0 sc1 lds
v_mfma_f32_16x16x32_bf16 v[96:99], a[188:191], v[36:39], v[96:99]
v_cvt_pk_bf16_f32 v192, v136, v137
v_cvt_pk_bf16_f32 v193, v138, v139
v_mfma_f32_16x16x32_bf16 v[112:115], a[188:191], v[52:55], v[220:223]
v_exp_f32 v91, v91
v_mfma_f32_16x16x32_bf16 v[112:115], a[184:187], v[48:51], v[112:115]
v_exp_f32 v140, v140
v_mfma_f32_16x16x32_bf16 v[112:115], a[180:183], v[44:47], v[112:115]
v_exp_f32 v141, v141
v_mfma_f32_16x16x32_bf16 v[112:115], a[176:179], v[40:43], v[112:115]
v_exp_f32 v142, v142
v_mfma_f32_16x16x32_bf16 v[128:131], a[176:179], v[56:59], v[224:227]
v_exp_f32 v143, v143
v_mfma_f32_16x16x32_bf16 v[128:131], a[180:183], v[60:63], v[128:131]
v_exp_f32 v124, v124
v_mfma_f32_16x16x32_bf16 v[128:131], a[184:187], v[64:67], v[128:131]
v_cvt_pk_bf16_f32 v152, v88, v89
v_cvt_pk_bf16_f32 v153, v90, v91
v_mfma_f32_16x16x32_bf16 v[128:131], a[188:191], v[68:71], v[128:131]
v_exp_f32 v125, v125
v_mfma_f32_16x16x32_bf16 v[144:147], a[188:191], v[84:87], v[228:231]
v_exp_f32 v126, v126
v_mfma_f32_16x16x32_bf16 v[144:147], a[184:187], v[80:83], v[144:147]
v_exp_f32 v127, v127
v_mfma_f32_16x16x32_bf16 v[144:147], a[180:183], v[76:79], v[144:147]
v_exp_f32 v108, v108
v_mfma_f32_16x16x32_bf16 v[144:147], a[176:179], v[72:75], v[144:147]
ds_read_b128 a[152:155], v3 offset:1024
v_cndmask_b32 v100, v216, v17, s[62:63]
v_mfma_f32_16x16x32_bf16 v[148:151], a[192:195], v[72:75], v[228:231]
buffer_load_dwordx4 v16, s[32:35], s64 offen offset:1024 sc1 lds
v_mfma_f32_16x16x32_bf16 v[148:151], a[196:199], v[76:79], v[148:151]
ds_read_b128 a[156:159], v3 offset:9216
v_cndmask_b32 v101, v216, v17, s[48:49]
v_mfma_f32_16x16x32_bf16 v[148:151], a[200:203], v[80:83], v[148:151]
v_cvt_pk_bf16_f32 v194, v140, v141
v_cvt_pk_bf16_f32 v195, v142, v143
v_mfma_f32_16x16x32_bf16 v[148:151], a[204:207], v[84:87], v[148:151]
ds_read_b128 a[160:163], v3 offset:2048
v_cndmask_b32 v102, v216, v17, s[50:51]
v_mfma_f32_16x16x32_bf16 v[132:135], a[204:207], v[68:71], v[224:227]
ds_read_b128 a[164:167], v3 offset:10240
v_cndmask_b32 v103, v216, v17, s[100:101]
v_mfma_f32_16x16x32_bf16 v[132:135], a[200:203], v[64:67], v[132:135]
v_exp_f32 v109, v109
v_mfma_f32_16x16x32_bf16 v[132:135], a[196:199], v[60:63], v[132:135]
v_exp_f32 v110, v110
v_mfma_f32_16x16x32_bf16 v[132:135], a[192:195], v[56:59], v[132:135]
v_exp_f32 v111, v111
v_mfma_f32_16x16x32_bf16 v[116:119], a[192:195], v[40:43], v[220:223]
v_exp_f32 v92, v92
v_mfma_f32_16x16x32_bf16 v[116:119], a[196:199], v[44:47], v[116:119]
v_cvt_pk_bf16_f32 v186, v124, v125
v_cvt_pk_bf16_f32 v187, v126, v127
v_mfma_f32_16x16x32_bf16 v[116:119], a[200:203], v[48:51], v[116:119]
v_exp_f32 v93, v93
v_mfma_f32_16x16x32_bf16 v[116:119], a[204:207], v[52:55], v[116:119]
v_exp_f32 v94, v94
v_mfma_f32_16x16x32_bf16 v[100:103], a[204:207], v[36:39], v[100:103]
v_exp_f32 v95, v95
v_mfma_f32_16x16x32_bf16 v[100:103], a[200:203], v[32:35], v[100:103]
v_exp_f32 v96, v96
v_mfma_f32_16x16x32_bf16 v[100:103], a[196:199], v[28:31], v[100:103]
v_exp_f32 v97, v97
v_mfma_f32_16x16x32_bf16 v[100:103], a[192:195], v[24:27], v[100:103]
v_exp_f32 v98, v98
v_smfmac_f32_16x16x64_bf16 a[128:131], a[240:243], v[168:175], v5
ds_read_b128 a[168:171], v3 offset:3072
v_smfmac_f32_16x16x64_bf16 a[132:135], a[240:243], v[176:183], v5
v_cvt_pk_bf16_f32 v162, v108, v109
v_smfmac_f32_16x16x64_bf16 a[136:139], a[240:243], v[200:207], v5
ds_read_b128 a[172:175], v3 offset:11264
v_smfmac_f32_16x16x64_bf16 a[140:143], a[240:243], v[208:215], v5
s_waitcnt lgkmcnt(2)
buffer_load_dwordx4 v16, s[32:35], s64 offen offset:2048 sc1 lds
v_mfma_f32_16x16x32_bf16 a[0:3], a[144:147], v[168:171], a[0:3]
v_exp_f32 v99, v99
v_mfma_f32_16x16x32_bf16 a[0:3], a[148:151], v[172:175], a[0:3]
v_cvt_pk_bf16_f32 v163, v110, v111
v_cvt_pk_bf16_f32 v154, v92, v93
v_mfma_f32_16x16x32_bf16 a[32:35], a[148:151], v[180:183], a[32:35]
v_exp_f32 v112, v112
v_mfma_f32_16x16x32_bf16 a[32:35], a[144:147], v[176:179], a[32:35]
v_exp_f32 v113, v113
v_mfma_f32_16x16x32_bf16 a[64:67], a[144:147], v[200:203], a[64:67]
v_exp_f32 v114, v114
v_mfma_f32_16x16x32_bf16 a[64:67], a[148:151], v[204:207], a[64:67]
v_exp_f32 v115, v115
v_mfma_f32_16x16x32_bf16 a[96:99], a[148:151], v[212:215], a[96:99]
v_exp_f32 v128, v128
v_mfma_f32_16x16x32_bf16 a[96:99], a[144:147], v[208:211], a[96:99]
v_exp_f32 v129, v129
v_mfma_f32_16x16x32_bf16 a[100:103], a[152:155], v[208:211], a[100:103]
v_exp_f32 v130, v130
v_mfma_f32_16x16x32_bf16 a[100:103], a[156:159], v[212:215], a[100:103]
v_cvt_pk_bf16_f32 v155, v94, v95
v_cvt_pk_bf16_f32 v156, v96, v97
v_mfma_f32_16x16x32_bf16 a[68:71], a[156:159], v[204:207], a[68:71]
v_exp_f32 v131, v131
v_mfma_f32_16x16x32_bf16 a[68:71], a[152:155], v[200:203], a[68:71]
buffer_load_dwordx4 v16, s[32:35], s64 offen offset:3072 sc1 lds
v_mfma_f32_16x16x32_bf16 a[36:39], a[152:155], v[176:179], a[36:39]
s_add_u32 m0, s86, 135168
ds_read_b128 a[176:179], v3 offset:4096
v_cvt_pk_bf16_f32 v157, v98, v99
v_mfma_f32_16x16x32_bf16 a[36:39], a[156:159], v[180:183], a[36:39]
s_add_u32 s64, s85, 32768
v_exp_f32 v144, v144
v_mfma_f32_16x16x32_bf16 a[4:7], a[156:159], v[172:175], a[4:7]
buffer_load_dwordx4 v12, s[36:39], s64 offen lds
v_mfma_f32_16x16x32_bf16 a[4:7], a[152:155], v[168:171], a[4:7]
s_add_u32 m0, s86, 136192
ds_read_b128 a[180:183], v3 offset:12288
v_cvt_pk_bf16_f32 v164, v112, v113
v_mfma_f32_16x16x32_bf16 a[8:11], a[160:163], v[168:171], a[8:11]
s_add_u32 s64, s85, 40960
v_exp_f32 v145, v145
v_mfma_f32_16x16x32_bf16 a[8:11], a[164:167], v[172:175], a[8:11]
buffer_load_dwordx4 v13, s[36:39], s64 offen lds
v_mfma_f32_16x16x32_bf16 a[40:43], a[164:167], v[180:183], a[40:43]
ds_read_b128 a[184:187], v3 offset:5120
v_cvt_pk_bf16_f32 v165, v114, v115
v_mfma_f32_16x16x32_bf16 a[40:43], a[160:163], v[176:179], a[40:43]
ds_read_b128 a[188:191], v3 offset:13312
v_cvt_pk_bf16_f32 v188, v128, v129
v_mfma_f32_16x16x32_bf16 a[72:75], a[160:163], v[200:203], a[72:75]
ds_read_b128 a[192:195], v3 offset:6144
v_cvt_pk_bf16_f32 v189, v130, v131
v_mfma_f32_16x16x32_bf16 a[72:75], a[164:167], v[204:207], a[72:75]
ds_read_b128 a[196:199], v3 offset:14336
v_cvt_pk_bf16_f32 v196, v144, v145
v_mfma_f32_16x16x32_bf16 a[104:107], a[164:167], v[212:215], a[104:107]
ds_read_b128 a[200:203], v3 offset:7168
v_mfma_f32_16x16x32_bf16 a[104:107], a[160:163], v[208:211], a[104:107]
s_waitcnt lgkmcnt(5)
s_add_u32 m0, s86, 137216
ds_read_b128 a[204:207], v3 offset:15360
v_mfma_f32_16x16x32_bf16 a[108:111], a[168:171], v[208:211], a[108:111]
s_add_u32 s64, s85, 49152
v_exp_f32 v146, v146
v_mfma_f32_16x16x32_bf16 a[108:111], a[172:175], v[212:215], a[108:111]
buffer_load_dwordx4 v12, s[36:39], s64 offen lds
v_mfma_f32_16x16x32_bf16 a[76:79], a[172:175], v[204:207], a[76:79]
s_add_u32 m0, s86, 138240
v_exp_f32 v147, v147
v_mfma_f32_16x16x32_bf16 a[76:79], a[168:171], v[200:203], a[76:79]
s_add_u32 s64, s85, 57344
v_exp_f32 v148, v148
v_mfma_f32_16x16x32_bf16 a[44:47], a[168:171], v[176:179], a[44:47]
buffer_load_dwordx4 v13, s[36:39], s64 offen lds
v_mfma_f32_16x16x32_bf16 a[44:47], a[172:175], v[180:183], a[44:47]
s_waitcnt vmcnt(16)
s_barrier
v_mfma_f32_16x16x32_bf16 a[12:15], a[172:175], v[172:175], a[12:15]
s_xor_b32 s71, s71, 16384
v_exp_f32 v149, v149
v_mfma_f32_16x16x32_bf16 a[12:15], a[168:171], v[168:171], a[12:15]
s_add_u32 s70, s70, 32768
v_exp_f32 v150, v150
v_mfma_f32_16x16x32_bf16 a[16:19], a[176:179], v[168:171], a[16:19]
s_mov_b32 m0, s71
v_exp_f32 v151, v151
v_mfma_f32_16x16x32_bf16 a[16:19], a[180:183], v[172:175], a[16:19]
buffer_load_dwordx4 v16, s[32:35], s70 offen offset:0 sc1 lds
v_mfma_f32_16x16x32_bf16 a[48:51], a[180:183], v[180:183], a[48:51]
v_exp_f32 v132, v132
v_mfma_f32_16x16x32_bf16 a[48:51], a[176:179], v[176:179], a[48:51]
v_exp_f32 v133, v133
v_mfma_f32_16x16x32_bf16 a[80:83], a[176:179], v[200:203], a[80:83]
v_exp_f32 v134, v134
v_mfma_f32_16x16x32_bf16 a[80:83], a[180:183], v[204:207], a[80:83]
v_exp_f32 v135, v135
v_mfma_f32_16x16x32_bf16 a[112:115], a[180:183], v[212:215], a[112:115]
v_exp_f32 v116, v116
v_mfma_f32_16x16x32_bf16 a[112:115], a[176:179], v[208:211], a[112:115]
s_waitcnt lgkmcnt(0)
v_cvt_pk_bf16_f32 v197, v146, v147
v_cvt_pk_bf16_f32 v198, v148, v149
v_mfma_f32_16x16x32_bf16 a[116:119], a[184:187], v[208:211], a[116:119]
v_exp_f32 v117, v117
v_mfma_f32_16x16x32_bf16 a[116:119], a[188:191], v[212:215], a[116:119]
v_exp_f32 v118, v118
v_mfma_f32_16x16x32_bf16 a[84:87], a[188:191], v[204:207], a[84:87]
v_exp_f32 v119, v119
v_mfma_f32_16x16x32_bf16 a[84:87], a[184:187], v[200:203], a[84:87]
v_exp_f32 v100, v100
v_mfma_f32_16x16x32_bf16 a[52:55], a[184:187], v[176:179], a[52:55]
v_exp_f32 v101, v101
v_mfma_f32_16x16x32_bf16 a[52:55], a[188:191], v[180:183], a[52:55]
ds_read_b128 a[144:147], v2 offset:16384
v_cvt_pk_bf16_f32 v199, v150, v151
v_mfma_f32_16x16x32_bf16 a[20:23], a[188:191], v[172:175], a[20:23]
ds_read_b128 a[148:151], v2 offset:17408
v_cvt_pk_bf16_f32 v190, v132, v133
v_mfma_f32_16x16x32_bf16 a[20:23], a[184:187], v[168:171], a[20:23]
v_exp_f32 v102, v102
v_mfma_f32_16x16x32_bf16 a[24:27], a[192:195], v[168:171], a[24:27]
buffer_load_dwordx4 v16, s[32:35], s70 offen offset:1024 sc1 lds
v_mfma_f32_16x16x32_bf16 a[24:27], a[196:199], v[172:175], a[24:27]
ds_read_b128 a[152:155], v2 offset:18432
v_cvt_pk_bf16_f32 v191, v134, v135
v_mfma_f32_16x16x32_bf16 a[56:59], a[196:199], v[180:183], a[56:59]
ds_read_b128 a[156:159], v2 offset:19456
v_cvt_pk_bf16_f32 v166, v116, v117
v_mfma_f32_16x16x32_bf16 a[56:59], a[192:195], v[176:179], a[56:59]
v_exp_f32 v103, v103
v_mfma_f32_16x16x32_bf16 a[88:91], a[192:195], v[200:203], a[88:91]
ds_read_b128 a[160:163], v2 offset:20480
v_cvt_pk_bf16_f32 v167, v118, v119
v_mfma_f32_16x16x32_bf16 a[88:91], a[196:199], v[204:207], a[88:91]
ds_read_b128 a[164:167], v2 offset:21504
v_cvt_pk_bf16_f32 v158, v100, v101
v_mfma_f32_16x16x32_bf16 a[120:123], a[196:199], v[212:215], a[120:123]
ds_read_b128 a[168:171], v2 offset:22528
v_cvt_pk_bf16_f32 v159, v102, v103
v_mfma_f32_16x16x32_bf16 a[120:123], a[192:195], v[208:211], a[120:123]
ds_read_b128 a[172:175], v2 offset:23552
v_cndmask_b32 v104, v220, v17, s[0:1]
v_mfma_f32_16x16x32_bf16 a[124:127], a[200:203], v[208:211], a[124:127]
v_cndmask_b32 v105, v220, v17, s[4:5]
v_cndmask_b32 v106, v220, v17, s[6:7]
v_mfma_f32_16x16x32_bf16 a[124:127], a[204:207], v[212:215], a[124:127]
v_cndmask_b32 v107, v220, v17, s[8:9]
v_cndmask_b32 v108, v220, v17, s[10:11]
v_mfma_f32_16x16x32_bf16 a[92:95], a[204:207], v[204:207], a[92:95]
v_cndmask_b32 v109, v220, v17, s[12:13]
v_cndmask_b32 v110, v220, v17, s[18:19]
v_mfma_f32_16x16x32_bf16 a[92:95], a[200:203], v[200:203], a[92:95]
v_cndmask_b32 v111, v220, v17, s[22:23]
v_cndmask_b32 v112, v220, v17, s[26:27]
v_mfma_f32_16x16x32_bf16 a[60:63], a[200:203], v[176:179], a[60:63]
v_cndmask_b32 v113, v220, v17, s[56:57]
v_cndmask_b32 v114, v220, v17, s[58:59]
v_mfma_f32_16x16x32_bf16 a[60:63], a[204:207], v[180:183], a[60:63]
v_cndmask_b32 v115, v220, v17, s[60:61]
v_cndmask_b32 v116, v220, v17, s[62:63]
v_mfma_f32_16x16x32_bf16 a[28:31], a[204:207], v[172:175], a[28:31]
v_cndmask_b32 v117, v220, v17, s[48:49]
v_cndmask_b32 v118, v220, v17, s[50:51]
v_mfma_f32_16x16x32_bf16 a[28:31], a[200:203], v[168:171], a[28:31]
s_waitcnt lgkmcnt(0)
v_cndmask_b32 v119, v220, v17, s[100:101]
v_mfma_f32_16x16x32_bf16 v[120:123], a[144:147], v[56:59], v[224:227]
ds_read_b128 a[176:179], v2 offset:24576
v_mfma_f32_16x16x32_bf16 v[120:123], a[148:151], v[60:63], v[120:123]
ds_read_b128 a[180:183], v2 offset:25600
v_mfma_f32_16x16x32_bf16 v[120:123], a[152:155], v[64:67], v[120:123]
buffer_load_dwordx4 v16, s[32:35], s70 offen offset:2048 sc1 lds
v_mfma_f32_16x16x32_bf16 v[120:123], a[156:159], v[68:71], v[120:123]
ds_read_b128 a[184:187], v2 offset:26624
v_mfma_f32_16x16x32_bf16 v[136:139], a[156:159], v[84:87], v[228:231]
ds_read_b128 a[188:191], v2 offset:27648
v_mfma_f32_16x16x32_bf16 v[136:139], a[152:155], v[80:83], v[136:139]
v_mfma_f32_16x16x32_bf16 v[136:139], a[148:151], v[76:79], v[136:139]
v_mfma_f32_16x16x32_bf16 v[136:139], a[144:147], v[72:75], v[136:139]
v_mfma_f32_16x16x32_bf16 v[104:107], a[144:147], v[40:43], v[104:107]
ds_read_b128 a[192:195], v2 offset:28672
v_mfma_f32_16x16x32_bf16 v[104:107], a[148:151], v[44:47], v[104:107]
v_mfma_f32_16x16x32_bf16 v[104:107], a[152:155], v[48:51], v[104:107]
v_exp_f32 v120, v120
v_mfma_f32_16x16x32_bf16 v[104:107], a[156:159], v[52:55], v[104:107]
v_exp_f32 v121, v121
v_mfma_f32_16x16x32_bf16 v[140:143], a[172:175], v[84:87], v[228:231]
v_exp_f32 v122, v122
v_mfma_f32_16x16x32_bf16 v[140:143], a[168:171], v[80:83], v[140:143]
v_exp_f32 v123, v123
v_mfma_f32_16x16x32_bf16 v[140:143], a[164:167], v[76:79], v[140:143]
v_exp_f32 v136, v136
v_mfma_f32_16x16x32_bf16 v[140:143], a[160:163], v[72:75], v[140:143]
buffer_load_dwordx4 v16, s[32:35], s70 offen offset:3072 sc1 lds
v_mfma_f32_16x16x32_bf16 v[124:127], a[160:163], v[56:59], v[224:227]
v_exp_f32 v137, v137
v_mfma_f32_16x16x32_bf16 v[124:127], a[164:167], v[60:63], v[124:127]
v_exp_f32 v138, v138
v_mfma_f32_16x16x32_bf16 v[124:127], a[168:171], v[64:67], v[124:127]
v_exp_f32 v139, v139
v_mfma_f32_16x16x32_bf16 v[124:127], a[172:175], v[68:71], v[124:127]
v_exp_f32 v104, v104
v_mfma_f32_16x16x32_bf16 v[108:111], a[172:175], v[52:55], v[108:111]
v_cvt_pk_bf16_f32 v200, v120, v121
v_cvt_pk_bf16_f32 v201, v122, v123
v_mfma_f32_16x16x32_bf16 v[108:111], a[168:171], v[48:51], v[108:111]
ds_read_b128 a[196:199], v2 offset:29696
v_cvt_pk_bf16_f32 v208, v136, v137
v_mfma_f32_16x16x32_bf16 v[108:111], a[164:167], v[44:47], v[108:111]
ds_read_b128 a[200:203], v2 offset:30720
v_cvt_pk_bf16_f32 v209, v138, v139
v_mfma_f32_16x16x32_bf16 v[108:111], a[160:163], v[40:43], v[108:111]
s_waitcnt lgkmcnt(2)
ds_read_b128 a[204:207], v2 offset:31744
v_mfma_f32_16x16x32_bf16 v[112:115], a[176:179], v[40:43], v[112:115]
v_exp_f32 v105, v105
v_mfma_f32_16x16x32_bf16 v[112:115], a[180:183], v[44:47], v[112:115]
v_exp_f32 v106, v106
v_mfma_f32_16x16x32_bf16 v[112:115], a[184:187], v[48:51], v[112:115]
v_exp_f32 v107, v107
v_mfma_f32_16x16x32_bf16 v[112:115], a[188:191], v[52:55], v[112:115]
s_add_u32 m0, s71, 4096
v_exp_f32 v140, v140
v_mfma_f32_16x16x32_bf16 v[128:131], a[188:191], v[68:71], v[224:227]
s_branch L_po17
L_pg17:
s_branch L_pg21
L_po17:
s_add_u32 s64, s70, 4096
v_exp_f32 v141, v141
v_mfma_f32_16x16x32_bf16 v[128:131], a[184:187], v[64:67], v[128:131]
buffer_load_dwordx4 v16, s[32:35], s64 offen offset:0 sc1 lds
v_mfma_f32_16x16x32_bf16 v[128:131], a[180:183], v[60:63], v[128:131]
v_exp_f32 v142, v142
v_mfma_f32_16x16x32_bf16 v[128:131], a[176:179], v[56:59], v[128:131]
v_exp_f32 v143, v143
v_mfma_f32_16x16x32_bf16 v[144:147], a[176:179], v[72:75], v[228:231]
ds_read_b128 a[144:147], v3 offset:16384
v_cvt_pk_bf16_f32 v176, v104, v105
v_mfma_f32_16x16x32_bf16 v[144:147], a[180:183], v[76:79], v[144:147]
ds_read_b128 a[148:151], v3 offset:24576
v_cvt_pk_bf16_f32 v177, v106, v107
v_mfma_f32_16x16x32_bf16 v[144:147], a[184:187], v[80:83], v[144:147]
v_exp_f32 v124, v124
v_mfma_f32_16x16x32_bf16 v[144:147], a[188:191], v[84:87], v[144:147]
s_waitcnt lgkmcnt(2)
v_exp_f32 v125, v125
v_mfma_f32_16x16x32_bf16 v[148:151], a[204:207], v[84:87], v[228:231]
v_exp_f32 v126, v126
v_mfma_f32_16x16x32_bf16 v[148:151], a[200:203], v[80:83], v[148:151]
v_exp_f32 v127, v127
v_mfma_f32_16x16x32_bf16 v[148:151], a[196:199], v[76:79], v[148:151]
ds_read_b128 a[152:155], v3 offset:17408
v_cvt_pk_bf16_f32 v210, v140, v141
v_mfma_f32_16x16x32_bf16 v[148:151], a[192:195], v[72:75], v[148:151]
ds_read_b128 a[156:159], v3 offset:25600
v_cvt_pk_bf16_f32 v211, v142, v143
v_mfma_f32_16x16x32_bf16 v[132:135], a[192:195], v[56:59], v[224:227]
v_exp_f32 v108, v108
v_mfma_f32_16x16x32_bf16 v[132:135], a[196:199], v[60:63], v[132:135]
v_exp_f32 v109, v109
v_mfma_f32_16x16x32_bf16 v[132:135], a[200:203], v[64:67], v[132:135]
buffer_load_dwordx4 v16, s[32:35], s64 offen offset:1024 sc1 lds
v_mfma_f32_16x16x32_bf16 v[132:135], a[204:207], v[68:71], v[132:135]
v_exp_f32 v110, v110
v_mfma_f32_16x16x32_bf16 v[116:119], a[204:207], v[52:55], v[116:119]
ds_read_b128 a[160:163], v3 offset:18432
v_cvt_pk_bf16_f32 v202, v124, v125
v_mfma_f32_16x16x32_bf16 v[116:119], a[200:203], v[48:51], v[116:119]
v_exp_f32 v111, v111
v_mfma_f32_16x16x32_bf16 v[116:119], a[196:199], v[44:47], v[116:119]
ds_read_b128 a[164:167], v3 offset:26624
v_cvt_pk_bf16_f32 v203, v126, v127
v_mfma_f32_16x16x32_bf16 v[116:119], a[192:195], v[40:43], v[116:119]
v_exp_f32 v112, v112
v_smfmac_f32_16x16x64_bf16 a[128:131], a[240:243], v[152:159], v5
ds_read_b128 a[168:171], v3 offset:19456
v_smfmac_f32_16x16x64_bf16 a[132:135], a[240:243], v[160:167], v5
ds_read_b128 a[172:175], v3 offset:27648
v_smfmac_f32_16x16x64_bf16 a[136:139], a[240:243], v[184:191], v5
ds_read_b128 a[176:179], v3 offset:20480
v_smfmac_f32_16x16x64_bf16 a[140:143], a[240:243], v[192:199], v5
s_waitcnt lgkmcnt(4)
ds_read_b128 a[180:183], v3 offset:28672
v_xor_b32 v2, 0x8000, v2
v_mfma_f32_16x16x32_bf16 a[0:3], a[144:147], v[152:155], a[0:3]
v_exp_f32 v113, v113
v_mfma_f32_16x16x32_bf16 a[0:3], a[148:151], v[156:159], a[0:3]
v_exp_f32 v114, v114
v_mfma_f32_16x16x32_bf16 a[32:35], a[148:151], v[164:167], a[32:35]
v_exp_f32 v115, v115
v_mfma_f32_16x16x32_bf16 a[32:35], a[144:147], v[160:163], a[32:35]
v_exp_f32 v128, v128
v_mfma_f32_16x16x32_bf16 a[64:67], a[144:147], v[184:187], a[64:67]
buffer_load_dwordx4 v16, s[32:35], s64 offen offset:2048 sc1 lds
v_mfma_f32_16x16x32_bf16 a[64:67], a[148:151], v[188:191], a[64:67]
v_exp_f32 v129, v129
v_mfma_f32_16x16x32_bf16 a[96:99], a[148:151], v[196:199], a[96:99]
v_exp_f32 v130, v130
v_mfma_f32_16x16x32_bf16 a[96:99], a[144:147], v[192:195], a[96:99]
v_exp_f32 v131, v131
v_mfma_f32_16x16x32_bf16 a[100:103], a[152:155], v[192:195], a[100:103]
v_exp_f32 v144, v144
v_mfma_f32_16x16x32_bf16 a[100:103], a[156:159], v[196:199], a[100:103]
v_exp_f32 v145, v145
v_mfma_f32_16x16x32_bf16 a[68:71], a[156:159], v[188:191], a[68:71]
ds_read_b128 a[184:187], v3 offset:21504
v_cvt_pk_bf16_f32 v178, v108, v109
v_mfma_f32_16x16x32_bf16 a[68:71], a[152:155], v[184:187], a[68:71]
ds_read_b128 a[188:191], v3 offset:29696
v_cvt_pk_bf16_f32 v179, v110, v111
v_mfma_f32_16x16x32_bf16 a[36:39], a[152:155], v[160:163], a[36:39]
ds_read_b128 a[192:195], v3 offset:22528
v_cvt_pk_bf16_f32 v180, v112, v113
v_mfma_f32_16x16x32_bf16 a[36:39], a[156:159], v[164:167], a[36:39]
v_exp_f32 v146, v146
v_mfma_f32_16x16x32_bf16 a[4:7], a[156:159], v[156:159], a[4:7]
v_exp_f32 v147, v147
v_mfma_f32_16x16x32_bf16 a[4:7], a[152:155], v[152:155], a[4:7]
v_exp_f32 v148, v148
v_mfma_f32_16x16x32_bf16 a[8:11], a[160:163], v[152:155], a[8:11]
s_waitcnt lgkmcnt(2)
ds_read_b128 a[196:199], v3 offset:30720
v_cvt_pk_bf16_f32 v181, v114, v115
v_mfma_f32_16x16x32_bf16 a[8:11], a[164:167], v[156:159], a[8:11]
buffer_load_dwordx4 v16, s[32:35], s64 offen offset:3072 sc1 lds
v_mfma_f32_16x16x32_bf16 a[40:43], a[164:167], v[164:167], a[40:43]
v_exp_f32 v149, v149
v_mfma_f32_16x16x32_bf16 a[40:43], a[160:163], v[160:163], a[40:43]
ds_read_b128 a[200:203], v3 offset:23552
v_cvt_pk_bf16_f32 v204, v128, v129
v_mfma_f32_16x16x32_bf16 a[72:75], a[160:163], v[184:187], a[72:75]
v_exp_f32 v150, v150
v_mfma_f32_16x16x32_bf16 a[72:75], a[164:167], v[188:191], a[72:75]
v_exp_f32 v151, v151
v_mfma_f32_16x16x32_bf16 a[104:107], a[164:167], v[196:199], a[104:107]
v_exp_f32 v132, v132
v_mfma_f32_16x16x32_bf16 a[104:107], a[160:163], v[192:195], a[104:107]
ds_read_b128 a[204:207], v3 offset:31744
v_cvt_pk_bf16_f32 v205, v130, v131
v_mfma_f32_16x16x32_bf16 a[108:111], a[168:171], v[192:195], a[108:111]
v_exp_f32 v133, v133
v_mfma_f32_16x16x32_bf16 a[108:111], a[172:175], v[196:199], a[108:111]
v_exp_f32 v134, v134
v_mfma_f32_16x16x32_bf16 a[76:79], a[172:175], v[188:191], a[76:79]
v_exp_f32 v135, v135
v_mfma_f32_16x16x32_bf16 a[76:79], a[168:171], v[184:187], a[76:79]
v_exp_f32 v116, v116
v_mfma_f32_16x16x32_bf16 a[44:47], a[168:171], v[160:163], a[44:47]
v_exp_f32 v117, v117
v_mfma_f32_16x16x32_bf16 a[44:47], a[172:175], v[164:167], a[44:47]
v_exp_f32 v118, v118
v_mfma_f32_16x16x32_bf16 a[12:15], a[172:175], v[156:159], a[12:15]
v_exp_f32 v119, v119
v_mfma_f32_16x16x32_bf16 a[12:15], a[168:171], v[152:155], a[12:15]
v_cvt_pk_bf16_f32 v212, v144, v145
v_cvt_pk_bf16_f32 v213, v146, v147
v_mfma_f32_16x16x32_bf16 a[16:19], a[176:179], v[152:155], a[16:19]
v_cvt_pk_bf16_f32 v214, v148, v149
v_cvt_pk_bf16_f32 v215, v150, v151
v_mfma_f32_16x16x32_bf16 a[16:19], a[180:183], v[156:159], a[16:19]
s_waitcnt vmcnt(12)
s_barrier
v_mfma_f32_16x16x32_bf16 a[48:51], a[180:183], v[164:167], a[48:51]
s_xor_b32 s71, s71, 49152
ds_read_b128 a[144:147], v2 offset:0
v_cvt_pk_bf16_f32 v206, v132, v133
v_mfma_f32_16x16x32_bf16 a[48:51], a[176:179], v[160:163], a[48:51]
s_add_u32 s70, s70, 32768
ds_read_b128 a[148:151], v2 offset:1024
v_cvt_pk_bf16_f32 v207, v134, v135
v_mfma_f32_16x16x32_bf16 a[80:83], a[176:179], v[184:187], a[80:83]
s_mov_b32 m0, s71
ds_read_b128 a[152:155], v2 offset:2048
v_cvt_pk_bf16_f32 v182, v116, v117
v_mfma_f32_16x16x32_bf16 a[80:83], a[180:183], v[188:191], a[80:83]
buffer_load_dwordx4 v16, s[32:35], s70 offen offset:0 sc1 lds
v_mfma_f32_16x16x32_bf16 a[112:115], a[180:183], v[196:199], a[112:115]
ds_read_b128 a[156:159], v2 offset:3072
v_cvt_pk_bf16_f32 v183, v118, v119
v_mfma_f32_16x16x32_bf16 a[112:115], a[176:179], v[192:195], a[112:115]
ds_read_b128 a[160:163], v2 offset:4096
v_xor_b32 v3, 0x8000, v3
v_mfma_f32_16x16x32_bf16 a[116:119], a[184:187], v[192:195], a[116:119]
s_waitcnt lgkmcnt(4)
ds_read_b128 a[164:167], v2 offset:5120
v_accvgpr_read_b32 v20, a128
v_mfma_f32_16x16x32_bf16 a[116:119], a[188:191], v[196:199], a[116:119]
ds_read_b128 a[168:171], v2 offset:6144
v_accvgpr_read_b32 v248, a129
v_mfma_f32_16x16x32_bf16 a[84:87], a[188:191], v[188:191], a[84:87]
ds_read_b128 a[172:175], v2 offset:7168
v_add_f32 v20, v20, v248
v_mfma_f32_16x16x32_bf16 a[84:87], a[184:187], v[184:187], a[84:87]
v_max_f32 v1, v1, v20
v_mfma_f32_16x16x32_bf16 a[52:55], a[184:187], v[160:163], a[52:55]
v_rcp_f32 v20, v20
v_mfma_f32_16x16x32_bf16 a[52:55], a[188:191], v[164:167], a[52:55]
v_accvgpr_read_b32 v232, a0
v_accvgpr_read_b32 v233, a1
v_mfma_f32_16x16x32_bf16 a[20:23], a[188:191], v[156:159], a[20:23]
v_accvgpr_read_b32 v234, a2
v_accvgpr_read_b32 v235, a3
v_mfma_f32_16x16x32_bf16 a[20:23], a[184:187], v[152:155], a[20:23]
v_accvgpr_read_b32 v236, a4
v_accvgpr_read_b32 v237, a5
v_mfma_f32_16x16x32_bf16 a[24:27], a[192:195], v[152:155], a[24:27]
v_accvgpr_read_b32 v238, a6
v_accvgpr_read_b32 v239, a7
v_mfma_f32_16x16x32_bf16 a[24:27], a[196:199], v[156:159], a[24:27]
v_mul_f32 v20, v20, v4
v_mul_f32 v232, v232, v20
v_mfma_f32_16x16x32_bf16 a[56:59], a[196:199], v[164:167], a[56:59]
buffer_load_dwordx4 v16, s[32:35], s70 offen offset:1024 sc1 lds
v_mfma_f32_16x16x32_bf16 a[56:59], a[192:195], v[160:163], a[56:59]
v_mul_f32 v233, v233, v20
v_mul_f32 v234, v234, v20
v_mfma_f32_16x16x32_bf16 a[88:91], a[192:195], v[184:187], a[88:91]
v_mul_f32 v235, v235, v20
v_mul_f32 v236, v236, v20
v_mfma_f32_16x16x32_bf16 a[88:91], a[196:199], v[188:191], a[88:91]
v_mul_f32 v237, v237, v20
v_mul_f32 v238, v238, v20
v_mfma_f32_16x16x32_bf16 a[120:123], a[196:199], v[196:199], a[120:123]
v_mul_f32 v239, v239, v20
v_cvt_pk_bf16_f32 v232, v232, v233
v_mfma_f32_16x16x32_bf16 a[120:123], a[192:195], v[192:195], a[120:123]
v_cvt_pk_bf16_f32 v233, v234, v235
v_cvt_pk_bf16_f32 v234, v236, v237
v_mfma_f32_16x16x32_bf16 a[124:127], a[200:203], v[192:195], a[124:127]
v_cvt_pk_bf16_f32 v235, v238, v239
v_mfma_f32_16x16x32_bf16 a[124:127], a[204:207], v[196:199], a[124:127]
s_add_u32 s77, s74, 0
buffer_store_dwordx4 v[232:235], v16, s[44:47], s77 offen sc1
v_mfma_f32_16x16x32_bf16 a[92:95], a[204:207], v[188:191], a[92:95]
v_accvgpr_read_b32 v240, a8
v_accvgpr_read_b32 v241, a9
v_mfma_f32_16x16x32_bf16 a[92:95], a[200:203], v[184:187], a[92:95]
v_accvgpr_read_b32 v242, a10
v_accvgpr_read_b32 v243, a11
v_mfma_f32_16x16x32_bf16 a[60:63], a[200:203], v[160:163], a[60:63]
v_accvgpr_read_b32 v244, a12
v_accvgpr_read_b32 v245, a13
v_mfma_f32_16x16x32_bf16 a[60:63], a[204:207], v[164:167], a[60:63]
v_accvgpr_read_b32 v246, a14
v_accvgpr_read_b32 v247, a15
v_mfma_f32_16x16x32_bf16 a[28:31], a[204:207], v[156:159], a[28:31]
v_mul_f32 v240, v240, v20
v_mul_f32 v241, v241, v20
v_mfma_f32_16x16x32_bf16 a[28:31], a[200:203], v[152:155], a[28:31]
v_mul_f32 v242, v242, v20
v_mul_f32 v243, v243, v20
v_mul_f32 v244, v244, v20
v_mul_f32 v245, v245, v20
v_mul_f32 v246, v246, v20
v_mul_f32 v247, v247, v20
v_cvt_pk_bf16_f32 v240, v240, v241
v_cvt_pk_bf16_f32 v241, v242, v243
v_cvt_pk_bf16_f32 v242, v244, v245
v_cvt_pk_bf16_f32 v243, v246, v247
s_add_u32 s77, s74, 8192
buffer_store_dwordx4 v[240:243], v16, s[44:47], s77 offen sc1
v_accvgpr_read_b32 v232, a16
v_accvgpr_read_b32 v233, a17
v_accvgpr_read_b32 v234, a18
v_accvgpr_read_b32 v235, a19
v_accvgpr_read_b32 v236, a20
v_accvgpr_read_b32 v237, a21
v_accvgpr_read_b32 v238, a22
v_accvgpr_read_b32 v239, a23
v_mul_f32 v232, v232, v20
v_mul_f32 v233, v233, v20
v_mul_f32 v234, v234, v20
v_mul_f32 v235, v235, v20
v_mul_f32 v236, v236, v20
v_mul_f32 v237, v237, v20
v_mul_f32 v238, v238, v20
v_mul_f32 v239, v239, v20
v_cvt_pk_bf16_f32 v232, v232, v233
v_cvt_pk_bf16_f32 v233, v234, v235
v_cvt_pk_bf16_f32 v234, v236, v237
v_cvt_pk_bf16_f32 v235, v238, v239
s_add_u32 s77, s74, 16384
buffer_store_dwordx4 v[232:235], v16, s[44:47], s77 offen sc1
s_cmp_eq_u32 s3, 7
s_cbranch_scc1 L_T1
L_T:
s_waitcnt lgkmcnt(7)
v_mfma_f32_16x16x32_bf16 v[120:123], a[144:147], v[56:59], v[224:227]
s_waitcnt lgkmcnt(6)
ds_read_b128 a[176:179], v2 offset:8192
v_mfma_f32_16x16x32_bf16 v[120:123], a[148:151], v[60:63], v[120:123]
s_waitcnt lgkmcnt(6)
ds_read_b128 a[180:183], v2 offset:9216
v_mfma_f32_16x16x32_bf16 v[120:123], a[152:155], v[64:67], v[120:123]
s_waitcnt lgkmcnt(6)
buffer_load_dwordx4 v16, s[32:35], s70 offen offset:2048 sc1 lds
v_mfma_f32_16x16x32_bf16 v[120:123], a[156:159], v[68:71], v[120:123]
ds_read_b128 a[184:187], v2 offset:10240
v_mfma_f32_16x16x32_bf16 v[136:139], a[156:159], v[84:87], v[228:231]
ds_read_b128 a[188:191], v2 offset:11264
v_mfma_f32_16x16x32_bf16 v[136:139], a[152:155], v[80:83], v[136:139]
ds_read_b128 a[192:195], v2 offset:12288
v_mfma_f32_16x16x32_bf16 v[136:139], a[148:151], v[76:79], v[136:139]
ds_read_b128 a[196:199], v2 offset:13312
v_mfma_f32_16x16x32_bf16 v[136:139], a[144:147], v[72:75], v[136:139]
s_waitcnt lgkmcnt(4)
v_mfma_f32_16x16x32_bf16 v[140:143], a[160:163], v[72:75], v[228:231]
ds_read_b128 a[200:203], v2 offset:14336
v_accvgpr_read_b32 v240, a24
v_mfma_f32_16x16x32_bf16 v[140:143], a[164:167], v[76:79], v[140:143]
ds_read_b128 a[204:207], v2 offset:15360
v_accvgpr_read_b32 v241, a25
v_mfma_f32_16x16x32_bf16 v[140:143], a[168:171], v[80:83], v[140:143]
v_exp_f32 v120, v120
v_mfma_f32_16x16x32_bf16 v[140:143], a[172:175], v[84:87], v[140:143]
v_exp_f32 v121, v121
v_mfma_f32_16x16x32_bf16 v[124:127], a[172:175], v[68:71], v[224:227]
v_exp_f32 v122, v122
v_mfma_f32_16x16x32_bf16 v[124:127], a[168:171], v[64:67], v[124:127]
buffer_load_dwordx4 v16, s[32:35], s70 offen offset:3072 sc1 lds
v_mfma_f32_16x16x32_bf16 v[124:127], a[164:167], v[60:63], v[124:127]
v_exp_f32 v123, v123
v_mfma_f32_16x16x32_bf16 v[124:127], a[160:163], v[56:59], v[124:127]
v_exp_f32 v136, v136
v_mfma_f32_16x16x32_bf16 v[128:131], a[176:179], v[56:59], v[224:227]
v_exp_f32 v137, v137
v_mfma_f32_16x16x32_bf16 v[128:131], a[180:183], v[60:63], v[128:131]
s_waitcnt lgkmcnt(0)
v_exp_f32 v138, v138
v_mfma_f32_16x16x32_bf16 v[128:131], a[184:187], v[64:67], v[128:131]
v_exp_f32 v139, v139
v_mfma_f32_16x16x32_bf16 v[128:131], a[188:191], v[68:71], v[128:131]
s_add_u32 m0, s71, 4096
ds_read_b128 a[144:147], v3 offset:0
v_cvt_pk_bf16_f32 v184, v120, v121
v_mfma_f32_16x16x32_bf16 v[144:147], a[188:191], v[84:87], v[228:231]
s_add_u32 s64, s70, 4096
ds_read_b128 a[148:151], v3 offset:8192
v_cvt_pk_bf16_f32 v185, v122, v123
v_mfma_f32_16x16x32_bf16 v[144:147], a[184:187], v[80:83], v[144:147]
buffer_load_dwordx4 v16, s[32:35], s64 offen offset:0 sc1 lds
v_mfma_f32_16x16x32_bf16 v[144:147], a[180:183], v[76:79], v[144:147]
v_exp_f32 v140, v140
v_mfma_f32_16x16x32_bf16 v[144:147], a[176:179], v[72:75], v[144:147]
v_exp_f32 v141, v141
v_mfma_f32_16x16x32_bf16 v[148:151], a[192:195], v[72:75], v[228:231]
v_exp_f32 v142, v142
v_mfma_f32_16x16x32_bf16 v[148:151], a[196:199], v[76:79], v[148:151]
ds_read_b128 a[152:155], v3 offset:1024
v_cvt_pk_bf16_f32 v192, v136, v137
v_mfma_f32_16x16x32_bf16 v[148:151], a[200:203], v[80:83], v[148:151]
ds_read_b128 a[156:159], v3 offset:9216
v_cvt_pk_bf16_f32 v193, v138, v139
v_mfma_f32_16x16x32_bf16 v[148:151], a[204:207], v[84:87], v[148:151]
v_exp_f32 v143, v143
v_mfma_f32_16x16x32_bf16 v[132:135], a[204:207], v[68:71], v[224:227]
v_exp_f32 v124, v124
v_mfma_f32_16x16x32_bf16 v[132:135], a[200:203], v[64:67], v[132:135]
v_exp_f32 v125, v125
v_mfma_f32_16x16x32_bf16 v[132:135], a[196:199], v[60:63], v[132:135]
buffer_load_dwordx4 v16, s[32:35], s64 offen offset:1024 sc1 lds
v_mfma_f32_16x16x32_bf16 v[132:135], a[192:195], v[56:59], v[132:135]
ds_read_b128 a[160:163], v3 offset:2048
v_cvt_pk_bf16_f32 v194, v140, v141
v_smfmac_f32_16x16x64_bf16 a[132:135], a[240:243], v[176:183], v5
ds_read_b128 a[164:167], v3 offset:10240
v_smfmac_f32_16x16x64_bf16 a[136:139], a[240:243], v[200:207], v5
ds_read_b128 a[168:171], v3 offset:3072
v_accvgpr_read_b32 v242, a26
v_smfmac_f32_16x16x64_bf16 a[140:143], a[240:243], v[208:215], v5
s_waitcnt lgkmcnt(3)
ds_read_b128 a[172:175], v3 offset:11264
v_accvgpr_read_b32 v243, a27
v_mfma_f32_16x16x32_bf16 a[32:35], a[144:147], v[176:179], a[32:35]
ds_read_b128 a[176:179], v3 offset:4096
v_accvgpr_read_b32 v244, a28
v_mfma_f32_16x16x32_bf16 a[32:35], a[148:151], v[180:183], a[32:35]
ds_read_b128 a[180:183], v3 offset:12288
v_accvgpr_read_b32 v245, a29
v_mfma_f32_16x16x32_bf16 a[64:67], a[148:151], v[204:207], a[64:67]
ds_read_b128 a[184:187], v3 offset:5120
v_accvgpr_read_b32 v246, a30
v_mfma_f32_16x16x32_bf16 a[64:67], a[144:147], v[200:203], a[64:67]
ds_read_b128 a[188:191], v3 offset:13312
v_accvgpr_read_b32 v247, a31
v_mfma_f32_16x16x32_bf16 a[96:99], a[144:147], v[208:211], a[96:99]
ds_read_b128 a[192:195], v3 offset:6144
v_mul_f32 v240, v240, v20
v_mfma_f32_16x16x32_bf16 a[96:99], a[148:151], v[212:215], a[96:99]
ds_read_b128 a[196:199], v3 offset:14336
v_mul_f32 v241, v241, v20
v_mfma_f32_16x16x32_bf16 a[100:103], a[156:159], v[212:215], a[100:103]
ds_read_b128 a[200:203], v3 offset:7168
v_mul_f32 v242, v242, v20
v_mfma_f32_16x16x32_bf16 a[100:103], a[152:155], v[208:211], a[100:103]
ds_read_b128 a[204:207], v3 offset:15360
v_mul_f32 v243, v243, v20
v_mul_f32 v244, v244, v20
v_mul_f32 v245, v245, v20
v_mul_f32 v246, v246, v20
v_mul_f32 v247, v247, v20
v_cvt_pk_bf16_f32 v240, v240, v241
v_cvt_pk_bf16_f32 v241, v242, v243
v_cvt_pk_bf16_f32 v242, v244, v245
v_cvt_pk_bf16_f32 v243, v246, v247
s_add_u32 s77, s74, 24576
buffer_store_dwordx4 v[240:243], v16, s[44:47], s77 offen sc1
v_exp_f32 v126, v126
v_mfma_f32_16x16x32_bf16 a[68:71], a[152:155], v[200:203], a[68:71]
buffer_load_dwordx4 v16, s[32:35], s64 offen offset:2048 sc1 lds
v_cvt_pk_bf16_f32 v195, v142, v143
v_mfma_f32_16x16x32_bf16 a[68:71], a[156:159], v[204:207], a[68:71]
v_exp_f32 v127, v127
v_mfma_f32_16x16x32_bf16 a[36:39], a[156:159], v[180:183], a[36:39]
v_exp_f32 v128, v128
v_mfma_f32_16x16x32_bf16 a[36:39], a[152:155], v[176:179], a[36:39]
s_waitcnt lgkmcnt(2)
v_exp_f32 v129, v129
v_mfma_f32_16x16x32_bf16 a[40:43], a[160:163], v[176:179], a[40:43]
v_cvt_pk_bf16_f32 v186, v124, v125
v_cvt_pk_bf16_f32 v187, v126, v127
v_mfma_f32_16x16x32_bf16 a[40:43], a[164:167], v[180:183], a[40:43]
v_exp_f32 v130, v130
v_mfma_f32_16x16x32_bf16 a[72:75], a[164:167], v[204:207], a[72:75]
buffer_load_dwordx4 v16, s[32:35], s64 offen offset:3072 sc1 lds
v_mfma_f32_16x16x32_bf16 a[72:75], a[160:163], v[200:203], a[72:75]
v_exp_f32 v131, v131
v_mfma_f32_16x16x32_bf16 a[104:107], a[160:163], v[208:211], a[104:107]
v_exp_f32 v144, v144
v_mfma_f32_16x16x32_bf16 a[104:107], a[164:167], v[212:215], a[104:107]
v_exp_f32 v145, v145
v_mfma_f32_16x16x32_bf16 a[108:111], a[172:175], v[212:215], a[108:111]
v_exp_f32 v146, v146
v_mfma_f32_16x16x32_bf16 a[108:111], a[168:171], v[208:211], a[108:111]
v_exp_f32 v147, v147
v_mfma_f32_16x16x32_bf16 a[76:79], a[168:171], v[200:203], a[76:79]
v_exp_f32 v148, v148
v_mfma_f32_16x16x32_bf16 a[76:79], a[172:175], v[204:207], a[76:79]
v_exp_f32 v149, v149
v_mfma_f32_16x16x32_bf16 a[44:47], a[172:175], v[180:183], a[44:47]
v_cvt_pk_bf16_f32 v188, v128, v129
v_cvt_pk_bf16_f32 v189, v130, v131
v_mfma_f32_16x16x32_bf16 a[44:47], a[168:171], v[176:179], a[44:47]
v_exp_f32 v150, v150
v_mfma_f32_16x16x32_bf16 a[48:51], a[176:179], v[176:179], a[48:51]
v_exp_f32 v151, v151
v_mfma_f32_16x16x32_bf16 a[48:51], a[180:183], v[180:183], a[48:51]
v_exp_f32 v132, v132
v_mfma_f32_16x16x32_bf16 a[80:83], a[180:183], v[204:207], a[80:83]
s_waitcnt vmcnt(9)
s_barrier
v_mfma_f32_16x16x32_bf16 a[80:83], a[176:179], v[200:203], a[80:83]
s_xor_b32 s71, s71, 16384
v_exp_f32 v133, v133
v_mfma_f32_16x16x32_bf16 a[112:115], a[176:179], v[208:211], a[112:115]
s_add_u32 s70, s70, 32768
ds_read_b128 a[144:147], v2 offset:16384
v_cvt_pk_bf16_f32 v196, v144, v145
v_mfma_f32_16x16x32_bf16 a[112:115], a[180:183], v[212:215], a[112:115]
s_mov_b32 m0, s71
v_exp_f32 v134, v134
v_mfma_f32_16x16x32_bf16 a[116:119], a[188:191], v[212:215], a[116:119]
buffer_load_dwordx4 v16, s[32:35], s70 offen offset:0 sc1 lds
v_mfma_f32_16x16x32_bf16 a[116:119], a[184:187], v[208:211], a[116:119]
ds_read_b128 a[148:151], v2 offset:17408
v_cvt_pk_bf16_f32 v197, v146, v147
v_mfma_f32_16x16x32_bf16 a[84:87], a[184:187], v[200:203], a[84:87]
ds_read_b128 a[152:155], v2 offset:18432
v_cvt_pk_bf16_f32 v198, v148, v149
v_mfma_f32_16x16x32_bf16 a[84:87], a[188:191], v[204:207], a[84:87]
ds_read_b128 a[156:159], v2 offset:19456
v_cvt_pk_bf16_f32 v199, v150, v151
v_mfma_f32_16x16x32_bf16 a[52:55], a[188:191], v[180:183], a[52:55]
v_exp_f32 v135, v135
v_mfma_f32_16x16x32_bf16 a[52:55], a[184:187], v[176:179], a[52:55]
ds_read_b128 a[160:163], v2 offset:20480
v_cvt_pk_bf16_f32 v190, v132, v133
v_mfma_f32_16x16x32_bf16 a[56:59], a[192:195], v[176:179], a[56:59]
ds_read_b128 a[164:167], v2 offset:21504
v_cvt_pk_bf16_f32 v191, v134, v135
v_mfma_f32_16x16x32_bf16 a[56:59], a[196:199], v[180:183], a[56:59]
ds_read_b128 a[168:171], v2 offset:22528
v_accvgpr_read_b32 v21, a132
v_mfma_f32_16x16x32_bf16 a[88:91], a[196:199], v[204:207], a[88:91]
ds_read_b128 a[172:175], v2 offset:23552
v_accvgpr_read_b32 v248, a133
v_mfma_f32_16x16x32_bf16 a[88:91], a[192:195], v[200:203], a[88:91]
buffer_load_dwordx4 v16, s[32:35], s70 offen offset:1024 sc1 lds
v_mfma_f32_16x16x32_bf16 a[120:123], a[192:195], v[208:211], a[120:123]
v_add_f32 v21, v21, v248
v_max_f32 v1, v1, v21
v_mfma_f32_16x16x32_bf16 a[120:123], a[196:199], v[212:215], a[120:123]
s_waitcnt lgkmcnt(3)
v_rcp_f32 v21, v21
v_mfma_f32_16x16x32_bf16 a[124:127], a[204:207], v[212:215], a[124:127]
v_accvgpr_read_b32 v232, a32
v_accvgpr_read_b32 v233, a33
v_mfma_f32_16x16x32_bf16 a[124:127], a[200:203], v[208:211], a[124:127]
v_accvgpr_read_b32 v234, a34
v_accvgpr_read_b32 v235, a35
v_mfma_f32_16x16x32_bf16 a[92:95], a[200:203], v[200:203], a[92:95]
v_accvgpr_read_b32 v236, a36
v_accvgpr_read_b32 v237, a37
v_mfma_f32_16x16x32_bf16 a[92:95], a[204:207], v[204:207], a[92:95]
v_accvgpr_read_b32 v238, a38
v_accvgpr_read_b32 v239, a39
v_mfma_f32_16x16x32_bf16 a[60:63], a[204:207], v[180:183], a[60:63]
v_mul_f32 v21, v21, v6
v_mul_f32 v232, v232, v21
v_mfma_f32_16x16x32_bf16 a[60:63], a[200:203], v[176:179], a[60:63]
v_mul_f32 v233, v233, v21
v_mul_f32 v234, v234, v21
v_mfma_f32_16x16x32_bf16 v[120:123], a[144:147], v[56:59], v[224:227]
ds_read_b128 a[176:179], v2 offset:24576
ds_read_b128 a[180:183], v2 offset:25600
v_mfma_f32_16x16x32_bf16 v[120:123], a[148:151], v[60:63], v[120:123]
buffer_load_dwordx4 v16, s[32:35], s70 offen offset:2048 sc1 lds
v_mfma_f32_16x16x32_bf16 v[120:123], a[152:155], v[64:67], v[120:123]
s_add_u32 s64, s70, 4096
ds_read_b128 a[184:187], v2 offset:26624
ds_read_b128 a[188:191], v2 offset:27648
v_mfma_f32_16x16x32_bf16 v[120:123], a[156:159], v[68:71], v[120:123]
buffer_load_dwordx4 v16, s[32:35], s70 offen offset:3072 sc1 lds
v_mfma_f32_16x16x32_bf16 v[136:139], a[156:159], v[84:87], v[228:231]
s_add_u32 m0, s71, 4096
ds_read_b128 a[192:195], v2 offset:28672
ds_read_b128 a[196:199], v2 offset:29696
v_mfma_f32_16x16x32_bf16 v[136:139], a[152:155], v[80:83], v[136:139]
buffer_load_dwordx4 v16, s[32:35], s64 offen offset:0 sc1 lds
v_mfma_f32_16x16x32_bf16 v[136:139], a[148:151], v[76:79], v[136:139]
ds_read_b128 a[200:203], v2 offset:30720
ds_read_b128 a[204:207], v2 offset:31744
v_mfma_f32_16x16x32_bf16 v[136:139], a[144:147], v[72:75], v[136:139]
v_exp_f32 v120, v120
v_mfma_f32_16x16x32_bf16 v[140:143], a[160:163], v[72:75], v[228:231]
s_waitcnt lgkmcnt(4)
v_exp_f32 v121, v121
v_mfma_f32_16x16x32_bf16 v[140:143], a[164:167], v[76:79], v[140:143]
v_exp_f32 v122, v122
v_mfma_f32_16x16x32_bf16 v[140:143], a[168:171], v[80:83], v[140:143]
v_mul_f32 v235, v235, v21
v_mul_f32 v236, v236, v21
v_mul_f32 v237, v237, v21
v_mul_f32 v238, v238, v21
v_mul_f32 v239, v239, v21
v_cvt_pk_bf16_f32 v232, v232, v233
v_cvt_pk_bf16_f32 v233, v234, v235
v_cvt_pk_bf16_f32 v234, v236, v237
v_cvt_pk_bf16_f32 v235, v238, v239
s_add_u32 s77, s74, 4096
buffer_store_dwordx4 v[232:235], v16, s[44:47], s77 offen sc1
v_accvgpr_read_b32 v240, a40
v_accvgpr_read_b32 v241, a41
v_accvgpr_read_b32 v242, a42
v_accvgpr_read_b32 v243, a43
v_accvgpr_read_b32 v244, a44
v_accvgpr_read_b32 v245, a45
v_accvgpr_read_b32 v246, a46
v_accvgpr_read_b32 v247, a47
v_mul_f32 v240, v240, v21
v_mul_f32 v241, v241, v21
v_mul_f32 v242, v242, v21
v_mul_f32 v243, v243, v21
v_mul_f32 v244, v244, v21
v_mul_f32 v245, v245, v21
v_mul_f32 v246, v246, v21
v_mul_f32 v247, v247, v21
v_cvt_pk_bf16_f32 v240, v240, v241
v_cvt_pk_bf16_f32 v241, v242, v243
v_cvt_pk_bf16_f32 v242, v244, v245
v_cvt_pk_bf16_f32 v243, v246, v247
s_add_u32 s77, s74, 12288
buffer_store_dwordx4 v[240:243], v16, s[44:47], s77 offen sc1
v_accvgpr_read_b32 v232, a48
v_accvgpr_read_b32 v233, a49
v_accvgpr_read_b32 v234, a50
v_accvgpr_read_b32 v235, a51
v_accvgpr_read_b32 v236, a52
v_accvgpr_read_b32 v237, a53
v_accvgpr_read_b32 v238, a54
v_accvgpr_read_b32 v239, a55
v_mul_f32 v232, v232, v21
v_mul_f32 v233, v233, v21
v_mul_f32 v234, v234, v21
v_mul_f32 v235, v235, v21
v_mul_f32 v236, v236, v21
v_mul_f32 v237, v237, v21
v_mul_f32 v238, v238, v21
v_mul_f32 v239, v239, v21
v_cvt_pk_bf16_f32 v232, v232, v233
v_cvt_pk_bf16_f32 v233, v234, v235
v_cvt_pk_bf16_f32 v234, v236, v237
v_cvt_pk_bf16_f32 v235, v238, v239
s_add_u32 s77, s74, 20480
buffer_store_dwordx4 v[232:235], v16, s[44:47], s77 offen sc1
v_accvgpr_read_b32 v240, a56
v_accvgpr_read_b32 v241, a57
v_accvgpr_read_b32 v242, a58
v_accvgpr_read_b32 v243, a59
v_accvgpr_read_b32 v244, a60
v_accvgpr_read_b32 v245, a61
v_accvgpr_read_b32 v246, a62
v_accvgpr_read_b32 v247, a63
v_mul_f32 v240, v240, v21
v_mul_f32 v241, v241, v21
v_mul_f32 v242, v242, v21
v_mul_f32 v243, v243, v21
v_mul_f32 v244, v244, v21
v_mul_f32 v245, v245, v21
v_mul_f32 v246, v246, v21
v_mul_f32 v247, v247, v21
v_cvt_pk_bf16_f32 v240, v240, v241
v_cvt_pk_bf16_f32 v241, v242, v243
v_cvt_pk_bf16_f32 v242, v244, v245
v_cvt_pk_bf16_f32 v243, v246, v247
s_add_u32 s77, s74, 28672
buffer_store_dwordx4 v[240:243], v16, s[44:47], s77 offen sc1
v_exp_f32 v123, v123
v_mfma_f32_16x16x32_bf16 v[140:143], a[172:175], v[84:87], v[140:143]
v_exp_f32 v136, v136
v_mfma_f32_16x16x32_bf16 v[124:127], a[172:175], v[68:71], v[224:227]
ds_read_b128 a[144:147], v3 offset:16384
v_cvt_pk_bf16_f32 v200, v120, v121
v_mfma_f32_16x16x32_bf16 v[124:127], a[168:171], v[64:67], v[124:127]
s_branch L_po18
L_pg18:
s_branch L_pg22
L_po18:
v_exp_f32 v137, v137
v_mfma_f32_16x16x32_bf16 v[124:127], a[164:167], v[60:63], v[124:127]
ds_read_b128 a[148:151], v3 offset:24576
v_cvt_pk_bf16_f32 v201, v122, v123
v_mfma_f32_16x16x32_bf16 v[124:127], a[160:163], v[56:59], v[124:127]
v_exp_f32 v138, v138
v_mfma_f32_16x16x32_bf16 v[128:131], a[176:179], v[56:59], v[224:227]
ds_read_b128 a[152:155], v3 offset:17408
v_cvt_pk_bf16_f32 v208, v136, v137
v_mfma_f32_16x16x32_bf16 v[128:131], a[180:183], v[60:63], v[128:131]
v_exp_f32 v139, v139
v_mfma_f32_16x16x32_bf16 v[128:131], a[184:187], v[64:67], v[128:131]
ds_read_b128 a[156:159], v3 offset:25600
v_cvt_pk_bf16_f32 v209, v138, v139
v_mfma_f32_16x16x32_bf16 v[128:131], a[188:191], v[68:71], v[128:131]
v_exp_f32 v140, v140
v_mfma_f32_16x16x32_bf16 v[144:147], a[188:191], v[84:87], v[228:231]
buffer_load_dwordx4 v16, s[32:35], s64 offen offset:1024 sc1 lds
v_mfma_f32_16x16x32_bf16 v[144:147], a[184:187], v[80:83], v[144:147]
v_exp_f32 v141, v141
v_mfma_f32_16x16x32_bf16 v[144:147], a[180:183], v[76:79], v[144:147]
ds_read_b128 a[160:163], v3 offset:18432
v_cvt_pk_bf16_f32 v210, v140, v141
v_mfma_f32_16x16x32_bf16 v[144:147], a[176:179], v[72:75], v[144:147]
s_waitcnt lgkmcnt(2)
v_exp_f32 v142, v142
v_mfma_f32_16x16x32_bf16 v[148:151], a[192:195], v[72:75], v[228:231]
ds_read_b128 a[164:167], v3 offset:26624
ds_read_b128 a[168:171], v3 offset:19456
v_mfma_f32_16x16x32_bf16 v[148:151], a[196:199], v[76:79], v[148:151]
v_exp_f32 v143, v143
v_mfma_f32_16x16x32_bf16 v[148:151], a[200:203], v[80:83], v[148:151]
ds_read_b128 a[172:175], v3 offset:27648
v_cvt_pk_bf16_f32 v211, v142, v143
v_mfma_f32_16x16x32_bf16 v[148:151], a[204:207], v[84:87], v[148:151]
v_exp_f32 v124, v124
v_mfma_f32_16x16x32_bf16 v[132:135], a[204:207], v[68:71], v[224:227]
ds_read_b128 a[176:179], v3 offset:20480
buffer_load_dwordx4 v16, s[32:35], s64 offen offset:2048 sc1 lds
v_mfma_f32_16x16x32_bf16 v[132:135], a[200:203], v[64:67], v[132:135]
v_exp_f32 v125, v125
v_mfma_f32_16x16x32_bf16 v[132:135], a[196:199], v[60:63], v[132:135]
ds_read_b128 a[180:183], v3 offset:28672
v_cvt_pk_bf16_f32 v202, v124, v125
v_mfma_f32_16x16x32_bf16 v[132:135], a[192:195], v[56:59], v[132:135]
v_exp_f32 v126, v126
v_smfmac_f32_16x16x64_bf16 a[136:139], a[240:243], v[184:191], v5
ds_read_b128 a[184:187], v3 offset:21504
v_smfmac_f32_16x16x64_bf16 a[140:143], a[240:243], v[192:199], v5
ds_read_b128 a[188:191], v3 offset:29696
v_mfma_f32_16x16x32_bf16 a[64:67], a[144:147], v[184:187], a[64:67]
v_exp_f32 v127, v127
v_mfma_f32_16x16x32_bf16 a[64:67], a[148:151], v[188:191], a[64:67]
v_exp_f32 v128, v128
v_mfma_f32_16x16x32_bf16 a[96:99], a[148:151], v[196:199], a[96:99]
v_exp_f32 v129, v129
v_mfma_f32_16x16x32_bf16 a[96:99], a[144:147], v[192:195], a[96:99]
ds_read_b128 a[192:195], v3 offset:22528
v_cvt_pk_bf16_f32 v203, v126, v127
v_mfma_f32_16x16x32_bf16 a[100:103], a[152:155], v[192:195], a[100:103]
s_waitcnt lgkmcnt(2)
v_exp_f32 v130, v130
v_mfma_f32_16x16x32_bf16 a[100:103], a[156:159], v[196:199], a[100:103]
ds_read_b128 a[196:199], v3 offset:30720
v_cvt_pk_bf16_f32 v204, v128, v129
v_mfma_f32_16x16x32_bf16 a[68:71], a[156:159], v[188:191], a[68:71]
v_exp_f32 v131, v131
v_mfma_f32_16x16x32_bf16 a[68:71], a[152:155], v[184:187], a[68:71]
ds_read_b128 a[200:203], v3 offset:23552
v_cvt_pk_bf16_f32 v205, v130, v131
v_mfma_f32_16x16x32_bf16 a[72:75], a[160:163], v[184:187], a[72:75]
v_exp_f32 v144, v144
v_mfma_f32_16x16x32_bf16 a[72:75], a[164:167], v[188:191], a[72:75]
buffer_load_dwordx4 v16, s[32:35], s64 offen offset:3072 sc1 lds
v_mfma_f32_16x16x32_bf16 a[104:107], a[164:167], v[196:199], a[104:107]
s_xor_b32 s71, s71, 49152
v_exp_f32 v145, v145
v_mfma_f32_16x16x32_bf16 a[104:107], a[160:163], v[192:195], a[104:107]
ds_read_b128 a[204:207], v3 offset:31744
v_cvt_pk_bf16_f32 v212, v144, v145
v_mfma_f32_16x16x32_bf16 a[108:111], a[168:171], v[192:195], a[108:111]
s_add_u32 s70, s70, 32768
v_xor_b32 v2, 0x8000, v2
v_exp_f32 v146, v146
v_mfma_f32_16x16x32_bf16 a[108:111], a[172:175], v[196:199], a[108:111]
s_waitcnt vmcnt(12)
s_barrier
v_mfma_f32_16x16x32_bf16 a[76:79], a[172:175], v[188:191], a[76:79]
s_mov_b32 m0, s71
v_exp_f32 v147, v147
v_mfma_f32_16x16x32_bf16 a[76:79], a[168:171], v[184:187], a[76:79]
ds_read_b128 a[144:147], v2 offset:0
v_cvt_pk_bf16_f32 v213, v146, v147
v_mfma_f32_16x16x32_bf16 a[80:83], a[176:179], v[184:187], a[80:83]
v_exp_f32 v148, v148
v_mfma_f32_16x16x32_bf16 a[80:83], a[180:183], v[188:191], a[80:83]
ds_read_b128 a[148:151], v2 offset:1024
ds_read_b128 a[152:155], v2 offset:2048
v_mfma_f32_16x16x32_bf16 a[112:115], a[180:183], v[196:199], a[112:115]
v_exp_f32 v149, v149
v_mfma_f32_16x16x32_bf16 a[112:115], a[176:179], v[192:195], a[112:115]
ds_read_b128 a[156:159], v2 offset:3072
v_cvt_pk_bf16_f32 v214, v148, v149
v_mfma_f32_16x16x32_bf16 a[116:119], a[184:187], v[192:195], a[116:119]
s_waitcnt lgkmcnt(4)
v_exp_f32 v150, v150
v_mfma_f32_16x16x32_bf16 a[116:119], a[188:191], v[196:199], a[116:119]
buffer_load_dwordx4 v16, s[32:35], s70 offen offset:0 sc1 lds
v_mfma_f32_16x16x32_bf16 a[84:87], a[188:191], v[188:191], a[84:87]
v_exp_f32 v151, v151
v_mfma_f32_16x16x32_bf16 a[84:87], a[184:187], v[184:187], a[84:87]
ds_read_b128 a[160:163], v2 offset:4096
v_cvt_pk_bf16_f32 v215, v150, v151
v_mfma_f32_16x16x32_bf16 a[88:91], a[192:195], v[184:187], a[88:91]
v_exp_f32 v132, v132
v_mfma_f32_16x16x32_bf16 a[88:91], a[196:199], v[188:191], a[88:91]
ds_read_b128 a[164:167], v2 offset:5120
v_xor_b32 v3, 0x8000, v3
v_mfma_f32_16x16x32_bf16 a[120:123], a[196:199], v[196:199], a[120:123]
v_exp_f32 v133, v133
v_mfma_f32_16x16x32_bf16 a[120:123], a[192:195], v[192:195], a[120:123]
ds_read_b128 a[168:171], v2 offset:6144
v_cvt_pk_bf16_f32 v206, v132, v133
v_mfma_f32_16x16x32_bf16 a[124:127], a[200:203], v[192:195], a[124:127]
v_exp_f32 v134, v134
v_mfma_f32_16x16x32_bf16 a[124:127], a[204:207], v[196:199], a[124:127]
buffer_load_dwordx4 v16, s[32:35], s70 offen offset:1024 sc1 lds
v_mfma_f32_16x16x32_bf16 a[92:95], a[204:207], v[188:191], a[92:95]
v_exp_f32 v135, v135
v_mfma_f32_16x16x32_bf16 a[92:95], a[200:203], v[184:187], a[92:95]
ds_read_b128 a[172:175], v2 offset:7168
v_cvt_pk_bf16_f32 v207, v134, v135
s_lshl_b32 s72, s3, 1
s_sub_u32 s72, 13, s72
L_S:
s_waitcnt lgkmcnt(7)
v_mfma_f32_16x16x32_bf16 v[120:123], a[144:147], v[56:59], v[224:227]
s_waitcnt lgkmcnt(6)
ds_read_b128 a[176:179], v2 offset:8192
ds_read_b128 a[180:183], v2 offset:9216
v_mfma_f32_16x16x32_bf16 v[120:123], a[148:151], v[60:63], v[120:123]
s_waitcnt lgkmcnt(7)
buffer_load_dwordx4 v16, s[32:35], s70 offen offset:2048 sc1 lds
v_mfma_f32_16x16x32_bf16 v[120:123], a[152:155], v[64:67], v[120:123]
s_waitcnt lgkmcnt(6)
s_add_u32 s64, s70, 4096
ds_read_b128 a[184:187], v2 offset:10240
ds_read_b128 a[188:191], v2 offset:11264
v_mfma_f32_16x16x32_bf16 v[120:123], a[156:159], v[68:71], v[120:123]
buffer_load_dwordx4 v16, s[32:35], s70 offen offset:3072 sc1 lds
v_mfma_f32_16x16x32_bf16 v[136:139], a[156:159], v[84:87], v[228:231]
s_add_u32 m0, s71, 4096
ds_read_b128 a[192:195], v2 offset:12288
ds_read_b128 a[196:199], v2 offset:13312
v_mfma_f32_16x16x32_bf16 v[136:139], a[152:155], v[80:83], v[136:139]
buffer_load_dwordx4 v16, s[32:35], s64 offen offset:0 sc1 lds
v_mfma_f32_16x16x32_bf16 v[136:139], a[148:151], v[76:79], v[136:139]
ds_read_b128 a[200:203], v2 offset:14336
ds_read_b128 a[204:207], v2 offset:15360
v_mfma_f32_16x16x32_bf16 v[136:139], a[144:147], v[72:75], v[136:139]
s_waitcnt lgkmcnt(6)
v_exp_f32 v120, v120
v_mfma_f32_16x16x32_bf16 v[140:143], a[160:163], v[72:75], v[228:231]
v_exp_f32 v121, v121
v_mfma_f32_16x16x32_bf16 v[140:143], a[164:167], v[76:79], v[140:143]
v_exp_f32 v122, v122
v_mfma_f32_16x16x32_bf16 v[140:143], a[168:171], v[80:83], v[140:143]
v_exp_f32 v123, v123
v_mfma_f32_16x16x32_bf16 v[140:143], a[172:175], v[84:87], v[140:143]
v_exp_f32 v136, v136
v_mfma_f32_16x16x32_bf16 v[124:127], a[172:175], v[68:71], v[224:227]
ds_read_b128 a[144:147], v3 offset:0
v_cvt_pk_bf16_f32 v184, v120, v121
v_mfma_f32_16x16x32_bf16 v[124:127], a[168:171], v[64:67], v[124:127]
v_exp_f32 v137, v137
v_mfma_f32_16x16x32_bf16 v[124:127], a[164:167], v[60:63], v[124:127]
ds_read_b128 a[148:151], v3 offset:8192
v_cvt_pk_bf16_f32 v185, v122, v123
v_mfma_f32_16x16x32_bf16 v[124:127], a[160:163], v[56:59], v[124:127]
v_exp_f32 v138, v138
v_mfma_f32_16x16x32_bf16 v[128:131], a[176:179], v[56:59], v[224:227]
ds_read_b128 a[152:155], v3 offset:1024
v_cvt_pk_bf16_f32 v192, v136, v137
v_mfma_f32_16x16x32_bf16 v[128:131], a[180:183], v[60:63], v[128:131]
s_waitcnt lgkmcnt(3)
v_exp_f32 v139, v139
v_mfma_f32_16x16x32_bf16 v[128:131], a[184:187], v[64:67], v[128:131]
ds_read_b128 a[156:159], v3 offset:9216
v_cvt_pk_bf16_f32 v193, v138, v139
v_mfma_f32_16x16x32_bf16 v[128:131], a[188:191], v[68:71], v[128:131]
v_exp_f32 v140, v140
v_mfma_f32_16x16x32_bf16 v[144:147], a[188:191], v[84:87], v[228:231]
buffer_load_dwordx4 v16, s[32:35], s64 offen offset:1024 sc1 lds
v_mfma_f32_16x16x32_bf16 v[144:147], a[184:187], v[80:83], v[144:147]
v_exp_f32 v141, v141
v_mfma_f32_16x16x32_bf16 v[144:147], a[180:183], v[76:79], v[144:147]
ds_read_b128 a[160:163], v3 offset:2048
v_cvt_pk_bf16_f32 v194, v140, v141
v_mfma_f32_16x16x32_bf16 v[144:147], a[176:179], v[72:75], v[144:147]
v_exp_f32 v142, v142
v_mfma_f32_16x16x32_bf16 v[148:151], a[192:195], v[72:75], v[228:231]
ds_read_b128 a[164:167], v3 offset:10240
ds_read_b128 a[168:171], v3 offset:3072
v_mfma_f32_16x16x32_bf16 v[148:151], a[196:199], v[76:79], v[148:151]
v_exp_f32 v143, v143
v_mfma_f32_16x16x32_bf16 v[148:151], a[200:203], v[80:83], v[148:151]
ds_read_b128 a[172:175], v3 offset:11264
v_cvt_pk_bf16_f32 v195, v142, v143
v_mfma_f32_16x16x32_bf16 v[148:151], a[204:207], v[84:87], v[148:151]
v_exp_f32 v124, v124
v_mfma_f32_16x16x32_bf16 v[132:135], a[204:207], v[68:71], v[224:227]
ds_read_b128 a[176:179], v3 offset:4096
buffer_load_dwordx4 v16, s[32:35], s64 offen offset:2048 sc1 lds
v_mfma_f32_16x16x32_bf16 v[132:135], a[200:203], v[64:67], v[132:135]
v_exp_f32 v125, v125
v_mfma_f32_16x16x32_bf16 v[132:135], a[196:199], v[60:63], v[132:135]
ds_read_b128 a[180:183], v3 offset:12288
v_cvt_pk_bf16_f32 v186, v124, v125
v_mfma_f32_16x16x32_bf16 v[132:135], a[192:195], v[56:59], v[132:135]
v_exp_f32 v126, v126
v_smfmac_f32_16x16x64_bf16 a[136:139], a[240:243], v[200:207], v5
ds_read_b128 a[184:187], v3 offset:5120
v_smfmac_f32_16x16x64_bf16 a[140:143], a[240:243], v[208:215], v5
s_waitcnt lgkmcnt(3)
ds_read_b128 a[188:191], v3 offset:13312
v_mfma_f32_16x16x32_bf16 a[64:67], a[144:147], v[200:203], a[64:67]
v_exp_f32 v127, v127
v_mfma_f32_16x16x32_bf16 a[64:67], a[148:151], v[204:207], a[64:67]
v_exp_f32 v128, v128
v_mfma_f32_16x16x32_bf16 a[96:99], a[148:151], v[212:215], a[96:99]
v_exp_f32 v129, v129
v_mfma_f32_16x16x32_bf16 a[96:99], a[144:147], v[208:211], a[96:99]
ds_read_b128 a[192:195], v3 offset:6144
v_cvt_pk_bf16_f32 v187, v126, v127
v_mfma_f32_16x16x32_bf16 a[100:103], a[152:155], v[208:211], a[100:103]
v_exp_f32 v130, v130
v_mfma_f32_16x16x32_bf16 a[100:103], a[156:159], v[212:215], a[100:103]
ds_read_b128 a[196:199], v3 offset:14336
v_cvt_pk_bf16_f32 v188, v128, v129
v_mfma_f32_16x16x32_bf16 a[68:71], a[156:159], v[204:207], a[68:71]
v_exp_f32 v131, v131
v_mfma_f32_16x16x32_bf16 a[68:71], a[152:155], v[200:203], a[68:71]
ds_read_b128 a[200:203], v3 offset:7168
v_cvt_pk_bf16_f32 v189, v130, v131
v_mfma_f32_16x16x32_bf16 a[72:75], a[160:163], v[200:203], a[72:75]
v_exp_f32 v144, v144
v_mfma_f32_16x16x32_bf16 a[72:75], a[164:167], v[204:207], a[72:75]
buffer_load_dwordx4 v16, s[32:35], s64 offen offset:3072 sc1 lds
v_mfma_f32_16x16x32_bf16 a[104:107], a[164:167], v[212:215], a[104:107]
s_xor_b32 s71, s71, 16384
v_exp_f32 v145, v145
v_mfma_f32_16x16x32_bf16 a[104:107], a[160:163], v[208:211], a[104:107]
ds_read_b128 a[204:207], v3 offset:15360
v_cvt_pk_bf16_f32 v196, v144, v145
v_mfma_f32_16x16x32_bf16 a[108:111], a[168:171], v[208:211], a[108:111]
s_add_u32 s70, s70, 32768
v_exp_f32 v146, v146
v_mfma_f32_16x16x32_bf16 a[108:111], a[172:175], v[212:215], a[108:111]
s_waitcnt vmcnt(8)
s_barrier
v_mfma_f32_16x16x32_bf16 a[76:79], a[172:175], v[204:207], a[76:79]
s_mov_b32 m0, s71
v_exp_f32 v147, v147
v_mfma_f32_16x16x32_bf16 a[76:79], a[168:171], v[200:203], a[76:79]
s_waitcnt lgkmcnt(1)
ds_read_b128 a[144:147], v2 offset:16384
v_cvt_pk_bf16_f32 v197, v146, v147
v_mfma_f32_16x16x32_bf16 a[80:83], a[176:179], v[200:203], a[80:83]
v_exp_f32 v148, v148
v_mfma_f32_16x16x32_bf16 a[80:83], a[180:183], v[204:207], a[80:83]
ds_read_b128 a[148:151], v2 offset:17408
ds_read_b128 a[152:155], v2 offset:18432
v_mfma_f32_16x16x32_bf16 a[112:115], a[180:183], v[212:215], a[112:115]
v_exp_f32 v149, v149
v_mfma_f32_16x16x32_bf16 a[112:115], a[176:179], v[208:211], a[112:115]
ds_read_b128 a[156:159], v2 offset:19456
v_cvt_pk_bf16_f32 v198, v148, v149
v_mfma_f32_16x16x32_bf16 a[116:119], a[184:187], v[208:211], a[116:119]
v_exp_f32 v150, v150
v_mfma_f32_16x16x32_bf16 a[116:119], a[188:191], v[212:215], a[116:119]
buffer_load_dwordx4 v16, s[32:35], s70 offen offset:0 sc1 lds
v_mfma_f32_16x16x32_bf16 a[84:87], a[188:191], v[204:207], a[84:87]
v_exp_f32 v151, v151
v_mfma_f32_16x16x32_bf16 a[84:87], a[184:187], v[200:203], a[84:87]
ds_read_b128 a[160:163], v2 offset:20480
v_cvt_pk_bf16_f32 v199, v150, v151
v_mfma_f32_16x16x32_bf16 a[88:91], a[192:195], v[200:203], a[88:91]
v_exp_f32 v132, v132
v_mfma_f32_16x16x32_bf16 a[88:91], a[196:199], v[204:207], a[88:91]
ds_read_b128 a[164:167], v2 offset:21504
v_mfma_f32_16x16x32_bf16 a[120:123], a[196:199], v[212:215], a[120:123]
v_exp_f32 v133, v133
v_mfma_f32_16x16x32_bf16 a[120:123], a[192:195], v[208:211], a[120:123]
ds_read_b128 a[168:171], v2 offset:22528
v_cvt_pk_bf16_f32 v190, v132, v133
v_mfma_f32_16x16x32_bf16 a[124:127], a[200:203], v[208:211], a[124:127]
s_waitcnt lgkmcnt(3)
v_exp_f32 v134, v134
v_mfma_f32_16x16x32_bf16 a[124:127], a[204:207], v[212:215], a[124:127]
buffer_load_dwordx4 v16, s[32:35], s70 offen offset:1024 sc1 lds
v_mfma_f32_16x16x32_bf16 a[92:95], a[204:207], v[204:207], a[92:95]
v_exp_f32 v135, v135
v_mfma_f32_16x16x32_bf16 a[92:95], a[200:203], v[200:203], a[92:95]
ds_read_b128 a[172:175], v2 offset:23552
v_cvt_pk_bf16_f32 v191, v134, v135
v_mfma_f32_16x16x32_bf16 v[120:123], a[144:147], v[56:59], v[224:227]
ds_read_b128 a[176:179], v2 offset:24576
ds_read_b128 a[180:183], v2 offset:25600
v_mfma_f32_16x16x32_bf16 v[120:123], a[148:151], v[60:63], v[120:123]
buffer_load_dwordx4 v16, s[32:35], s70 offen offset:2048 sc1 lds
v_mfma_f32_16x16x32_bf16 v[120:123], a[152:155], v[64:67], v[120:123]
s_add_u32 s64, s70, 4096
ds_read_b128 a[184:187], v2 offset:26624
ds_read_b128 a[188:191], v2 offset:27648
v_mfma_f32_16x16x32_bf16 v[120:123], a[156:159], v[68:71], v[120:123]
buffer_load_dwordx4 v16, s[32:35], s70 offen offset:3072 sc1 lds
v_mfma_f32_16x16x32_bf16 v[136:139], a[156:159], v[84:87], v[228:231]
s_add_u32 m0, s71, 4096
ds_read_b128 a[192:195], v2 offset:28672
ds_read_b128 a[196:199], v2 offset:29696
v_mfma_f32_16x16x32_bf16 v[136:139], a[152:155], v[80:83], v[136:139]
buffer_load_dwordx4 v16, s[32:35], s64 offen offset:0 sc1 lds
v_mfma_f32_16x16x32_bf16 v[136:139], a[148:151], v[76:79], v[136:139]
ds_read_b128 a[200:203], v2 offset:30720
ds_read_b128 a[204:207], v2 offset:31744
v_mfma_f32_16x16x32_bf16 v[136:139], a[144:147], v[72:75], v[136:139]
s_waitcnt lgkmcnt(6)
v_exp_f32 v120, v120
v_mfma_f32_16x16x32_bf16 v[140:143], a[160:163], v[72:75], v[228:231]
v_exp_f32 v121, v121
v_mfma_f32_16x16x32_bf16 v[140:143], a[164:167], v[76:79], v[140:143]
v_exp_f32 v122, v122
v_mfma_f32_16x16x32_bf16 v[140:143], a[168:171], v[80:83], v[140:143]
v_exp_f32 v123, v123
v_mfma_f32_16x16x32_bf16 v[140:143], a[172:175], v[84:87], v[140:143]
v_exp_f32 v136, v136
v_mfma_f32_16x16x32_bf16 v[124:127], a[172:175], v[68:71], v[224:227]
ds_read_b128 a[144:147], v3 offset:16384
v_cvt_pk_bf16_f32 v200, v120, v121
v_mfma_f32_16x16x32_bf16 v[124:127], a[168:171], v[64:67], v[124:127]
v_exp_f32 v137, v137
v_mfma_f32_16x16x32_bf16 v[124:127], a[164:167], v[60:63], v[124:127]
ds_read_b128 a[148:151], v3 offset:24576
v_cvt_pk_bf16_f32 v201, v122, v123
v_mfma_f32_16x16x32_bf16 v[124:127], a[160:163], v[56:59], v[124:127]
v_exp_f32 v138, v138
v_mfma_f32_16x16x32_bf16 v[128:131], a[176:179], v[56:59], v[224:227]
ds_read_b128 a[152:155], v3 offset:17408
v_cvt_pk_bf16_f32 v208, v136, v137
v_mfma_f32_16x16x32_bf16 v[128:131], a[180:183], v[60:63], v[128:131]
s_waitcnt lgkmcnt(3)
v_exp_f32 v139, v139
v_mfma_f32_16x16x32_bf16 v[128:131], a[184:187], v[64:67], v[128:131]
ds_read_b128 a[156:159], v3 offset:25600
v_cvt_pk_bf16_f32 v209, v138, v139
v_mfma_f32_16x16x32_bf16 v[128:131], a[188:191], v[68:71], v[128:131]
v_exp_f32 v140, v140
v_mfma_f32_16x16x32_bf16 v[144:147], a[188:191], v[84:87], v[228:231]
buffer_load_dwordx4 v16, s[32:35], s64 offen offset:1024 sc1 lds
v_mfma_f32_16x16x32_bf16 v[144:147], a[184:187], v[80:83], v[144:147]
v_exp_f32 v141, v141
v_mfma_f32_16x16x32_bf16 v[144:147], a[180:183], v[76:79], v[144:147]
ds_read_b128 a[160:163], v3 offset:18432
v_cvt_pk_bf16_f32 v210, v140, v141
v_mfma_f32_16x16x32_bf16 v[144:147], a[176:179], v[72:75], v[144:147]
v_exp_f32 v142, v142
v_mfma_f32_16x16x32_bf16 v[148:151], a[192:195], v[72:75], v[228:231]
ds_read_b128 a[164:167], v3 offset:26624
ds_read_b128 a[168:171], v3 offset:19456
v_mfma_f32_16x16x32_bf16 v[148:151], a[196:199], v[76:79], v[148:151]
v_exp_f32 v143, v143
v_mfma_f32_16x16x32_bf16 v[148:151], a[200:203], v[80:83], v[148:151]
ds_read_b128 a[172:175], v3 offset:27648
v_cvt_pk_bf16_f32 v211, v142, v143
v_mfma_f32_16x16x32_bf16 v[148:151], a[204:207], v[84:87], v[148:151]
v_exp_f32 v124, v124
v_mfma_f32_16x16x32_bf16 v[132:135], a[204:207], v[68:71], v[224:227]
ds_read_b128 a[176:179], v3 offset:20480
buffer_load_dwordx4 v16, s[32:35], s64 offen offset:2048 sc1 lds
v_mfma_f32_16x16x32_bf16 v[132:135], a[200:203], v[64:67], v[132:135]
v_exp_f32 v125, v125
v_mfma_f32_16x16x32_bf16 v[132:135], a[196:199], v[60:63], v[132:135]
ds_read_b128 a[180:183], v3 offset:28672
v_cvt_pk_bf16_f32 v202, v124, v125
v_mfma_f32_16x16x32_bf16 v[132:135], a[192:195], v[56:59], v[132:135]
v_exp_f32 v126, v126
v_smfmac_f32_16x16x64_bf16 a[136:139], a[240:243], v[184:191], v5
ds_read_b128 a[184:187], v3 offset:21504
v_smfmac_f32_16x16x64_bf16 a[140:143], a[240:243], v[192:199], v5
s_waitcnt lgkmcnt(3)
ds_read_b128 a[188:191], v3 offset:29696
v_mfma_f32_16x16x32_bf16 a[64:67], a[144:147], v[184:187], a[64:67]
v_exp_f32 v127, v127
v_mfma_f32_16x16x32_bf16 a[64:67], a[148:151], v[188:191], a[64:67]
v_exp_f32 v128, v128
v_mfma_f32_16x16x32_bf16 a[96:99], a[148:151], v[196:199], a[96:99]
v_exp_f32 v129, v129
v_mfma_f32_16x16x32_bf16 a[96:99], a[144:147], v[192:195], a[96:99]
ds_read_b128 a[192:195], v3 offset:22528
v_cvt_pk_bf16_f32 v203, v126, v127
v_mfma_f32_16x16x32_bf16 a[100:103], a[152:155], v[192:195], a[100:103]
v_exp_f32 v130, v130
v_mfma_f32_16x16x32_bf16 a[100:103], a[156:159], v[196:199], a[100:103]
ds_read_b128 a[196:199], v3 offset:30720
v_cvt_pk_bf16_f32 v204, v128, v129
v_mfma_f32_16x16x32_bf16 a[68:71], a[156:159], v[188:191], a[68:71]
v_exp_f32 v131, v131
v_mfma_f32_16x16x32_bf16 a[68:71], a[152:155], v[184:187], a[68:71]
ds_read_b128 a[200:203], v3 offset:23552
v_cvt_pk_bf16_f32 v205, v130, v131
v_mfma_f32_16x16x32_bf16 a[72:75], a[160:163], v[184:187], a[72:75]
v_exp_f32 v144, v144
v_mfma_f32_16x16x32_bf16 a[72:75], a[164:167], v[188:191], a[72:75]
buffer_load_dwordx4 v16, s[32:35], s64 offen offset:3072 sc1 lds
v_mfma_f32_16x16x32_bf16 a[104:107], a[164:167], v[196:199], a[104:107]
s_xor_b32 s71, s71, 49152
v_exp_f32 v145, v145
v_mfma_f32_16x16x32_bf16 a[104:107], a[160:163], v[192:195], a[104:107]
ds_read_b128 a[204:207], v3 offset:31744
v_cvt_pk_bf16_f32 v212, v144, v145
v_mfma_f32_16x16x32_bf16 a[108:111], a[168:171], v[192:195], a[108:111]
s_add_u32 s70, s70, 32768
v_xor_b32 v2, 0x8000, v2
v_exp_f32 v146, v146
v_mfma_f32_16x16x32_bf16 a[108:111], a[172:175], v[196:199], a[108:111]
s_waitcnt vmcnt(8)
s_barrier
v_mfma_f32_16x16x32_bf16 a[76:79], a[172:175], v[188:191], a[76:79]
s_mov_b32 m0, s71
v_exp_f32 v147, v147
v_mfma_f32_16x16x32_bf16 a[76:79], a[168:171], v[184:187], a[76:79]
s_waitcnt lgkmcnt(1)
ds_read_b128 a[144:147], v2 offset:0
v_cvt_pk_bf16_f32 v213, v146, v147
v_mfma_f32_16x16x32_bf16 a[80:83], a[176:179], v[184:187], a[80:83]
v_exp_f32 v148, v148
v_mfma_f32_16x16x32_bf16 a[80:83], a[180:183], v[188:191], a[80:83]
ds_read_b128 a[148:151], v2 offset:1024
ds_read_b128 a[152:155], v2 offset:2048
v_mfma_f32_16x16x32_bf16 a[112:115], a[180:183], v[196:199], a[112:115]
v_exp_f32 v149, v149
v_mfma_f32_16x16x32_bf16 a[112:115], a[176:179], v[192:195], a[112:115]
ds_read_b128 a[156:159], v2 offset:3072
v_cvt_pk_bf16_f32 v214, v148, v149
v_mfma_f32_16x16x32_bf16 a[116:119], a[184:187], v[192:195], a[116:119]
v_exp_f32 v150, v150
v_mfma_f32_16x16x32_bf16 a[116:119], a[188:191], v[196:199], a[116:119]
buffer_load_dwordx4 v16, s[32:35], s70 offen offset:0 sc1 lds
v_mfma_f32_16x16x32_bf16 a[84:87], a[188:191], v[188:191], a[84:87]
s_sub_u32 s72, s72, 1
v_exp_f32 v151, v151
v_mfma_f32_16x16x32_bf16 a[84:87], a[184:187], v[184:187], a[84:87]
ds_read_b128 a[160:163], v2 offset:4096
v_cvt_pk_bf16_f32 v215, v150, v151
v_mfma_f32_16x16x32_bf16 a[88:91], a[192:195], v[184:187], a[88:91]
v_exp_f32 v132, v132
v_mfma_f32_16x16x32_bf16 a[88:91], a[196:199], v[188:191], a[88:91]
ds_read_b128 a[164:167], v2 offset:5120
v_xor_b32 v3, 0x8000, v3
v_mfma_f32_16x16x32_bf16 a[120:123], a[196:199], v[196:199], a[120:123]
s_cmp_lg_u32 s72, 0
v_exp_f32 v133, v133
v_mfma_f32_16x16x32_bf16 a[120:123], a[192:195], v[192:195], a[120:123]
ds_read_b128 a[168:171], v2 offset:6144
v_cvt_pk_bf16_f32 v206, v132, v133
v_mfma_f32_16x16x32_bf16 a[124:127], a[200:203], v[192:195], a[124:127]
s_waitcnt lgkmcnt(3)
v_exp_f32 v134, v134
v_mfma_f32_16x16x32_bf16 a[124:127], a[204:207], v[196:199], a[124:127]
buffer_load_dwordx4 v16, s[32:35], s70 offen offset:1024 sc1 lds
v_mfma_f32_16x16x32_bf16 a[92:95], a[204:207], v[188:191], a[92:95]
v_exp_f32 v135, v135
v_mfma_f32_16x16x32_bf16 a[92:95], a[200:203], v[184:187], a[92:95]
ds_read_b128 a[172:175], v2 offset:7168
v_cvt_pk_bf16_f32 v207, v134, v135
s_cbranch_scc1 L_S
L_SD:
buffer_load_dword v19, off, s[52:55], s80 sc1
s_waitcnt lgkmcnt(7)
v_mfma_f32_16x16x32_bf16 v[136:139], a[144:147], v[72:75], v[228:231]
s_waitcnt lgkmcnt(6)
ds_read_b128 a[176:179], v2 offset:8192
ds_read_b128 a[180:183], v2 offset:9216
v_mfma_f32_16x16x32_bf16 v[136:139], a[148:151], v[76:79], v[136:139]
s_waitcnt lgkmcnt(7)
buffer_load_dwordx4 v16, s[32:35], s70 offen offset:2048 sc1 lds
v_cndmask_b32 v120, v224, v17, s[0:1]
v_cndmask_b32 v121, v224, v17, s[4:5]
v_cndmask_b32 v122, v224, v17, s[6:7]
v_cndmask_b32 v123, v224, v17, s[8:9]
v_mfma_f32_16x16x32_bf16 v[136:139], a[152:155], v[80:83], v[136:139]
s_waitcnt lgkmcnt(6)
s_add_u32 s64, s70, 4096
ds_read_b128 a[184:187], v2 offset:10240
ds_read_b128 a[188:191], v2 offset:11264
v_mfma_f32_16x16x32_bf16 v[136:139], a[156:159], v[84:87], v[136:139]
buffer_load_dwordx4 v16, s[32:35], s70 offen offset:3072 sc1 lds
v_mfma_f32_16x16x32_bf16 v[120:123], a[156:159], v[68:71], v[120:123]
s_add_u32 m0, s71, 4096
ds_read_b128 a[192:195], v2 offset:12288
ds_read_b128 a[196:199], v2 offset:13312
v_mfma_f32_16x16x32_bf16 v[120:123], a[152:155], v[64:67], v[120:123]
buffer_load_dwordx4 v16, s[32:35], s64 offen offset:0 sc1 lds
v_mfma_f32_16x16x32_bf16 v[120:123], a[148:151], v[60:63], v[120:123]
ds_read_b128 a[200:203], v2 offset:14336
ds_read_b128 a[204:207], v2 offset:15360
v_mfma_f32_16x16x32_bf16 v[120:123], a[144:147], v[56:59], v[120:123]
s_waitcnt lgkmcnt(6)
v_exp_f32 v136, v136
v_mfma_f32_16x16x32_bf16 v[140:143], a[160:163], v[72:75], v[228:231]
v_exp_f32 v137, v137
v_mfma_f32_16x16x32_bf16 v[140:143], a[164:167], v[76:79], v[140:143]
v_cndmask_b32 v124, v224, v17, s[10:11]
v_cndmask_b32 v125, v224, v17, s[12:13]
v_cndmask_b32 v126, v224, v17, s[18:19]
v_cndmask_b32 v127, v224, v17, s[22:23]
v_exp_f32 v138, v138
v_mfma_f32_16x16x32_bf16 v[140:143], a[168:171], v[80:83], v[140:143]
v_exp_f32 v139, v139
v_mfma_f32_16x16x32_bf16 v[140:143], a[172:175], v[84:87], v[140:143]
v_exp_f32 v120, v120
v_mfma_f32_16x16x32_bf16 v[124:127], a[172:175], v[68:71], v[124:127]
ds_read_b128 a[144:147], v3 offset:0
v_cvt_pk_bf16_f32 v192, v136, v137
v_mfma_f32_16x16x32_bf16 v[124:127], a[168:171], v[64:67], v[124:127]
v_cndmask_b32 v128, v224, v17, s[26:27]
v_cndmask_b32 v129, v224, v17, s[56:57]
v_cndmask_b32 v130, v224, v17, s[58:59]
v_cndmask_b32 v131, v224, v17, s[60:61]
v_exp_f32 v121, v121
v_mfma_f32_16x16x32_bf16 v[124:127], a[164:167], v[60:63], v[124:127]
s_mul_i32 s69, s83, 8
ds_read_b128 a[148:151], v3 offset:8192
v_cvt_pk_bf16_f32 v193, v138, v139
v_mfma_f32_16x16x32_bf16 v[124:127], a[160:163], v[56:59], v[124:127]
s_sub_u32 s69, 36, s69
v_exp_f32 v122, v122
v_mfma_f32_16x16x32_bf16 v[128:131], a[176:179], v[56:59], v[128:131]
ds_read_b128 a[152:155], v3 offset:1024
v_cvt_pk_bf16_f32 v184, v120, v121
v_mfma_f32_16x16x32_bf16 v[128:131], a[180:183], v[60:63], v[128:131]
s_waitcnt lgkmcnt(3)
v_exp_f32 v123, v123
v_mfma_f32_16x16x32_bf16 v[128:131], a[184:187], v[64:67], v[128:131]
ds_read_b128 a[156:159], v3 offset:9216
v_cvt_pk_bf16_f32 v185, v122, v123
v_mfma_f32_16x16x32_bf16 v[128:131], a[188:191], v[68:71], v[128:131]
v_exp_f32 v140, v140
v_mfma_f32_16x16x32_bf16 v[144:147], a[188:191], v[84:87], v[228:231]
buffer_load_dwordx4 v16, s[32:35], s64 offen offset:1024 sc1 lds
v_mfma_f32_16x16x32_bf16 v[144:147], a[184:187], v[80:83], v[144:147]
v_exp_f32 v141, v141
v_mfma_f32_16x16x32_bf16 v[144:147], a[180:183], v[76:79], v[144:147]
ds_read_b128 a[160:163], v3 offset:2048
v_cvt_pk_bf16_f32 v194, v140, v141
v_mfma_f32_16x16x32_bf16 v[144:147], a[176:179], v[72:75], v[144:147]
v_exp_f32 v142, v142
v_mfma_f32_16x16x32_bf16 v[148:151], a[192:195], v[72:75], v[228:231]
ds_read_b128 a[164:167], v3 offset:10240
ds_read_b128 a[168:171], v3 offset:3072
v_mfma_f32_16x16x32_bf16 v[148:151], a[196:199], v[76:79], v[148:151]
v_cndmask_b32 v132, v224, v17, s[62:63]
v_cndmask_b32 v133, v224, v17, s[48:49]
v_cndmask_b32 v134, v224, v17, s[50:51]
v_cndmask_b32 v135, v224, v17, s[100:101]
v_exp_f32 v143, v143
v_mfma_f32_16x16x32_bf16 v[148:151], a[200:203], v[80:83], v[148:151]
ds_read_b128 a[172:175], v3 offset:11264
v_cvt_pk_bf16_f32 v195, v142, v143
v_mfma_f32_16x16x32_bf16 v[148:151], a[204:207], v[84:87], v[148:151]
v_exp_f32 v124, v124
v_mfma_f32_16x16x32_bf16 v[132:135], a[204:207], v[68:71], v[132:135]
ds_read_b128 a[176:179], v3 offset:4096
buffer_load_dwordx4 v16, s[32:35], s64 offen offset:2048 sc1 lds
v_mfma_f32_16x16x32_bf16 v[132:135], a[200:203], v[64:67], v[132:135]
v_exp_f32 v125, v125
v_mfma_f32_16x16x32_bf16 v[132:135], a[196:199], v[60:63], v[132:135]
ds_read_b128 a[180:183], v3 offset:12288
v_cvt_pk_bf16_f32 v186, v124, v125
v_mfma_f32_16x16x32_bf16 v[132:135], a[192:195], v[56:59], v[132:135]
v_exp_f32 v126, v126
v_smfmac_f32_16x16x64_bf16 a[136:139], a[240:243], v[200:207], v5
ds_read_b128 a[184:187], v3 offset:5120
v_smfmac_f32_16x16x64_bf16 a[140:143], a[240:243], v[208:215], v5
s_branch L_po19
L_pg19:
s_branch L_pg23
L_po19:
s_waitcnt lgkmcnt(3)
ds_read_b128 a[188:191], v3 offset:13312
v_mfma_f32_16x16x32_bf16 a[64:67], a[144:147], v[200:203], a[64:67]
v_exp_f32 v127, v127
v_mfma_f32_16x16x32_bf16 a[64:67], a[148:151], v[204:207], a[64:67]
v_exp_f32 v128, v128
v_mfma_f32_16x16x32_bf16 a[96:99], a[148:151], v[212:215], a[96:99]
v_exp_f32 v129, v129
v_mfma_f32_16x16x32_bf16 a[96:99], a[144:147], v[208:211], a[96:99]
ds_read_b128 a[192:195], v3 offset:6144
v_cvt_pk_bf16_f32 v187, v126, v127
v_mfma_f32_16x16x32_bf16 a[100:103], a[152:155], v[208:211], a[100:103]
v_exp_f32 v130, v130
v_mfma_f32_16x16x32_bf16 a[100:103], a[156:159], v[212:215], a[100:103]
ds_read_b128 a[196:199], v3 offset:14336
v_cvt_pk_bf16_f32 v188, v128, v129
v_mfma_f32_16x16x32_bf16 a[68:71], a[156:159], v[204:207], a[68:71]
v_exp_f32 v131, v131
v_mfma_f32_16x16x32_bf16 a[68:71], a[152:155], v[200:203], a[68:71]
ds_read_b128 a[200:203], v3 offset:7168
v_cvt_pk_bf16_f32 v189, v130, v131
v_mfma_f32_16x16x32_bf16 a[72:75], a[160:163], v[200:203], a[72:75]
v_exp_f32 v144, v144
v_mfma_f32_16x16x32_bf16 a[72:75], a[164:167], v[204:207], a[72:75]
buffer_load_dwordx4 v16, s[32:35], s64 offen offset:3072 sc1 lds
v_mfma_f32_16x16x32_bf16 a[104:107], a[164:167], v[212:215], a[104:107]
v_exp_f32 v145, v145
v_mfma_f32_16x16x32_bf16 a[104:107], a[160:163], v[208:211], a[104:107]
ds_read_b128 a[204:207], v3 offset:15360
v_cvt_pk_bf16_f32 v196, v144, v145
v_mfma_f32_16x16x32_bf16 a[108:111], a[168:171], v[208:211], a[108:111]
v_exp_f32 v146, v146
v_mfma_f32_16x16x32_bf16 a[108:111], a[172:175], v[212:215], a[108:111]
s_waitcnt vmcnt(9)
s_barrier
v_mfma_f32_16x16x32_bf16 a[76:79], a[172:175], v[204:207], a[76:79]
v_exp_f32 v147, v147
v_mfma_f32_16x16x32_bf16 a[76:79], a[168:171], v[200:203], a[76:79]
s_waitcnt lgkmcnt(1)
ds_read_b128 a[144:147], v2 offset:16384
v_cvt_pk_bf16_f32 v197, v146, v147
v_mfma_f32_16x16x32_bf16 a[80:83], a[176:179], v[200:203], a[80:83]
s_waitcnt vmcnt(6)
v_readfirstlane_b32 vcc_lo, v19
s_nop 0
s_cmp_lt_u32 vcc_lo, s69
s_cbranch_scc1 L_spin_8
L_spinbk_9:
v_exp_f32 v148, v148
v_mfma_f32_16x16x32_bf16 a[80:83], a[180:183], v[204:207], a[80:83]
ds_read_b128 a[148:151], v2 offset:17408
ds_read_b128 a[152:155], v2 offset:18432
v_mfma_f32_16x16x32_bf16 a[112:115], a[180:183], v[212:215], a[112:115]
v_exp_f32 v149, v149
v_mfma_f32_16x16x32_bf16 a[112:115], a[176:179], v[208:211], a[112:115]
ds_read_b128 a[156:159], v2 offset:19456
v_cvt_pk_bf16_f32 v198, v148, v149
v_mfma_f32_16x16x32_bf16 a[116:119], a[184:187], v[208:211], a[116:119]
v_exp_f32 v150, v150
v_mfma_f32_16x16x32_bf16 a[116:119], a[188:191], v[212:215], a[116:119]
v_cndmask_b32 v136, v228, v17, s[0:1]
v_cndmask_b32 v137, v228, v17, s[4:5]
v_mfma_f32_16x16x32_bf16 a[84:87], a[188:191], v[204:207], a[84:87]
v_exp_f32 v151, v151
v_mfma_f32_16x16x32_bf16 a[84:87], a[184:187], v[200:203], a[84:87]
ds_read_b128 a[160:163], v2 offset:20480
v_cvt_pk_bf16_f32 v199, v150, v151
v_mfma_f32_16x16x32_bf16 a[88:91], a[192:195], v[200:203], a[88:91]
v_exp_f32 v132, v132
v_mfma_f32_16x16x32_bf16 a[88:91], a[196:199], v[204:207], a[88:91]
ds_read_b128 a[164:167], v2 offset:21504
v_cndmask_b32 v138, v228, v17, s[6:7]
v_mfma_f32_16x16x32_bf16 a[120:123], a[196:199], v[212:215], a[120:123]
v_exp_f32 v133, v133
v_mfma_f32_16x16x32_bf16 a[120:123], a[192:195], v[208:211], a[120:123]
ds_read_b128 a[168:171], v2 offset:22528
v_cvt_pk_bf16_f32 v190, v132, v133
v_mfma_f32_16x16x32_bf16 a[124:127], a[200:203], v[208:211], a[124:127]
s_waitcnt lgkmcnt(3)
v_exp_f32 v134, v134
v_mfma_f32_16x16x32_bf16 a[124:127], a[204:207], v[212:215], a[124:127]
v_cndmask_b32 v139, v228, v17, s[8:9]
v_cndmask_b32 v140, v228, v17, s[10:11]
v_mfma_f32_16x16x32_bf16 a[92:95], a[204:207], v[204:207], a[92:95]
v_exp_f32 v135, v135
v_mfma_f32_16x16x32_bf16 a[92:95], a[200:203], v[200:203], a[92:95]
ds_read_b128 a[172:175], v2 offset:23552
v_cvt_pk_bf16_f32 v191, v134, v135
v_mfma_f32_16x16x32_bf16 v[136:139], a[144:147], v[72:75], v[136:139]
ds_read_b128 a[176:179], v2 offset:24576
v_cndmask_b32 v141, v228, v17, s[12:13]
v_mfma_f32_16x16x32_bf16 v[136:139], a[148:151], v[76:79], v[136:139]
ds_read_b128 a[180:183], v2 offset:25600
v_cndmask_b32 v142, v228, v17, s[18:19]
v_cndmask_b32 v143, v228, v17, s[22:23]
v_mfma_f32_16x16x32_bf16 v[136:139], a[152:155], v[80:83], v[136:139]
ds_read_b128 a[184:187], v2 offset:26624
v_cndmask_b32 v144, v228, v17, s[26:27]
v_mfma_f32_16x16x32_bf16 v[136:139], a[156:159], v[84:87], v[136:139]
s_waitcnt lgkmcnt(3)
ds_read_b128 a[188:191], v2 offset:27648
v_cndmask_b32 v145, v228, v17, s[56:57]
v_mfma_f32_16x16x32_bf16 v[140:143], a[172:175], v[84:87], v[140:143]
ds_read_b128 a[192:195], v2 offset:28672
ds_read_b128 a[196:199], v2 offset:29696
ds_read_b128 a[200:203], v2 offset:30720
ds_read_b128 a[204:207], v2 offset:31744
v_mfma_f32_16x16x32_bf16 v[140:143], a[168:171], v[80:83], v[140:143]
ds_read_b128 a[144:147], v3 offset:16384
v_cndmask_b32 v146, v228, v17, s[58:59]
v_cndmask_b32 v147, v228, v17, s[60:61]
v_mfma_f32_16x16x32_bf16 v[140:143], a[164:167], v[76:79], v[140:143]
ds_read_b128 a[148:151], v3 offset:24576
v_cndmask_b32 v148, v228, v17, s[62:63]
v_mfma_f32_16x16x32_bf16 v[140:143], a[160:163], v[72:75], v[140:143]
s_waitcnt lgkmcnt(8)
ds_read_b128 a[152:155], v3 offset:17408
v_cndmask_b32 v149, v228, v17, s[48:49]
v_mfma_f32_16x16x32_bf16 v[144:147], a[176:179], v[72:75], v[144:147]
ds_read_b128 a[156:159], v3 offset:25600
v_cndmask_b32 v150, v228, v17, s[50:51]
v_mfma_f32_16x16x32_bf16 v[144:147], a[180:183], v[76:79], v[144:147]
s_waitcnt lgkmcnt(8)
ds_read_b128 a[160:163], v3 offset:18432
v_cndmask_b32 v151, v228, v17, s[100:101]
v_mfma_f32_16x16x32_bf16 v[144:147], a[184:187], v[80:83], v[144:147]
v_exp_f32 v136, v136
v_mfma_f32_16x16x32_bf16 v[144:147], a[188:191], v[84:87], v[144:147]
s_waitcnt lgkmcnt(4)
v_exp_f32 v137, v137
v_mfma_f32_16x16x32_bf16 v[148:151], a[204:207], v[84:87], v[148:151]
v_exp_f32 v138, v138
v_mfma_f32_16x16x32_bf16 v[148:151], a[200:203], v[80:83], v[148:151]
s_add_u32 s65, s84, 0
v_exp_f32 v139, v139
v_mfma_f32_16x16x32_bf16 v[148:151], a[196:199], v[76:79], v[148:151]
buffer_load_dwordx4 a[208:211], v14, s[44:47], s65 offen offset:0 sc1
v_mfma_f32_16x16x32_bf16 v[148:151], a[192:195], v[72:75], v[148:151]
ds_read_b128 a[164:167], v3 offset:26624
v_cvt_pk_bf16_f32 v208, v136, v137
v_smfmac_f32_16x16x64_bf16 a[136:139], a[240:243], v[184:191], v5
ds_read_b128 a[168:171], v3 offset:19456
v_smfmac_f32_16x16x64_bf16 a[140:143], a[240:243], v[192:199], v5
ds_read_b128 a[172:175], v3 offset:27648
v_mfma_f32_16x16x32_bf16 a[64:67], a[144:147], v[184:187], a[64:67]
s_waitcnt lgkmcnt(3)
v_exp_f32 v140, v140
v_mfma_f32_16x16x32_bf16 a[64:67], a[148:151], v[188:191], a[64:67]
buffer_load_dwordx4 a[216:219], v14, s[44:47], s65 offen offset:1024 sc1
v_mfma_f32_16x16x32_bf16 a[96:99], a[148:151], v[196:199], a[96:99]
v_exp_f32 v141, v141
v_mfma_f32_16x16x32_bf16 a[96:99], a[144:147], v[192:195], a[96:99]
buffer_load_dwordx4 a[224:227], v15, s[44:47], s65 offen offset:0 sc1
v_mfma_f32_16x16x32_bf16 a[100:103], a[152:155], v[192:195], a[100:103]
v_exp_f32 v142, v142
v_mfma_f32_16x16x32_bf16 a[100:103], a[156:159], v[196:199], a[100:103]
buffer_load_dwordx4 a[232:235], v15, s[44:47], s65 offen offset:1024 sc1
v_mfma_f32_16x16x32_bf16 a[68:71], a[156:159], v[188:191], a[68:71]
s_add_u32 s65, s84, 8192
ds_read_b128 a[176:179], v3 offset:20480
v_cvt_pk_bf16_f32 v209, v138, v139
v_mfma_f32_16x16x32_bf16 a[68:71], a[152:155], v[184:187], a[68:71]
buffer_load_dwordx4 a[212:215], v14, s[44:47], s65 offen offset:0 sc1
v_mfma_f32_16x16x32_bf16 a[72:75], a[160:163], v[184:187], a[72:75]
s_waitcnt lgkmcnt(1)
ds_read_b128 a[180:183], v3 offset:28672
v_cvt_pk_bf16_f32 v210, v140, v141
v_mfma_f32_16x16x32_bf16 a[72:75], a[164:167], v[188:191], a[72:75]
v_exp_f32 v143, v143
v_mfma_f32_16x16x32_bf16 a[104:107], a[164:167], v[196:199], a[104:107]
buffer_load_dwordx4 a[220:223], v14, s[44:47], s65 offen offset:1024 sc1
v_mfma_f32_16x16x32_bf16 a[104:107], a[160:163], v[192:195], a[104:107]
v_exp_f32 v144, v144
v_mfma_f32_16x16x32_bf16 a[108:111], a[168:171], v[192:195], a[108:111]
ds_read_b128 a[184:187], v3 offset:21504
v_xor_b32 v2, 0x8000, v2
v_mfma_f32_16x16x32_bf16 a[108:111], a[172:175], v[196:199], a[108:111]
buffer_load_dwordx4 a[228:231], v15, s[44:47], s65 offen offset:0 sc1
ds_read_b128 a[188:191], v3 offset:29696
v_mfma_f32_16x16x32_bf16 a[76:79], a[172:175], v[188:191], a[76:79]
v_exp_f32 v145, v145
v_mfma_f32_16x16x32_bf16 a[76:79], a[168:171], v[184:187], a[76:79]
s_waitcnt lgkmcnt(2)
buffer_load_dwordx4 a[236:239], v15, s[44:47], s65 offen offset:1024 sc1
v_mfma_f32_16x16x32_bf16 a[80:83], a[176:179], v[184:187], a[80:83]
s_add_u32 s65, s84, 32768
ds_read_b128 a[192:195], v3 offset:22528
v_cvt_pk_bf16_f32 v211, v142, v143
v_mfma_f32_16x16x32_bf16 a[80:83], a[180:183], v[188:191], a[80:83]
buffer_load_dwordx4 v[152:155], v14, s[44:47], s65 offen offset:0 sc1
ds_read_b128 a[196:199], v3 offset:30720
v_exp_f32 v146, v146
v_mfma_f32_16x16x32_bf16 a[112:115], a[180:183], v[196:199], a[112:115]
ds_read_b128 a[200:203], v3 offset:23552
ds_read_b128 a[204:207], v3 offset:31744
v_mfma_f32_16x16x32_bf16 a[112:115], a[176:179], v[192:195], a[112:115]
s_waitcnt vmcnt(9)
s_barrier
v_xor_b32 v3, 0x8000, v3
buffer_load_dwordx4 v[160:163], v14, s[44:47], s65 offen offset:1024 sc1
s_waitcnt lgkmcnt(4)
v_mfma_f32_16x16x32_bf16 a[116:119], a[184:187], v[192:195], a[116:119]
v_exp_f32 v147, v147
v_mfma_f32_16x16x32_bf16 a[116:119], a[188:191], v[196:199], a[116:119]
buffer_load_dwordx4 v[168:171], v15, s[44:47], s65 offen offset:0 sc1
v_mfma_f32_16x16x32_bf16 a[84:87], a[188:191], v[188:191], a[84:87]
v_exp_f32 v148, v148
v_mfma_f32_16x16x32_bf16 a[84:87], a[184:187], v[184:187], a[84:87]
s_waitcnt lgkmcnt(2)
buffer_load_dwordx4 v[176:179], v15, s[44:47], s65 offen offset:1024 sc1
v_cvt_pk_bf16_f32 v212, v144, v145
v_mfma_f32_16x16x32_bf16 a[88:91], a[192:195], v[184:187], a[88:91]
s_add_u32 s65, s84, 40960
v_exp_f32 v149, v149
v_mfma_f32_16x16x32_bf16 a[88:91], a[196:199], v[188:191], a[88:91]
buffer_load_dwordx4 v[156:159], v14, s[44:47], s65 offen offset:0 sc1
v_mfma_f32_16x16x32_bf16 a[120:123], a[196:199], v[196:199], a[120:123]
ds_read_b128 a[144:147], v3 offset:0
v_cvt_pk_bf16_f32 v213, v146, v147
v_mfma_f32_16x16x32_bf16 a[120:123], a[192:195], v[192:195], a[120:123]
s_waitcnt lgkmcnt(1)
buffer_load_dwordx4 v[164:167], v14, s[44:47], s65 offen offset:1024 sc1
ds_read_b128 a[148:151], v3 offset:8192
v_exp_f32 v150, v150
v_mfma_f32_16x16x32_bf16 a[124:127], a[200:203], v[192:195], a[124:127]
ds_read_b128 a[152:155], v3 offset:1024
v_cvt_pk_bf16_f32 v214, v148, v149
v_mfma_f32_16x16x32_bf16 a[124:127], a[204:207], v[196:199], a[124:127]
buffer_load_dwordx4 v[172:175], v15, s[44:47], s65 offen offset:0 sc1
ds_read_b128 a[156:159], v3 offset:9216
v_mfma_f32_16x16x32_bf16 a[92:95], a[204:207], v[188:191], a[92:95]
v_exp_f32 v151, v151
v_mfma_f32_16x16x32_bf16 a[92:95], a[200:203], v[184:187], a[92:95]
buffer_load_dwordx4 v[180:183], v15, s[44:47], s65 offen offset:1024 sc1
ds_read_b128 a[160:163], v3 offset:2048
ds_read_b128 a[164:167], v3 offset:10240
ds_read_b128 a[168:171], v3 offset:3072
ds_read_b128 a[172:175], v3 offset:11264
v_cvt_pk_bf16_f32 v215, v150, v151
v_accvgpr_read_b32 v22, a136
v_accvgpr_read_b32 v248, a137
v_add_f32 v22, v22, v248
v_max_f32 v1, v1, v22
v_rcp_f32 v22, v22
v_accvgpr_read_b32 v232, a64
v_accvgpr_read_b32 v233, a65
v_accvgpr_read_b32 v234, a66
v_accvgpr_read_b32 v235, a67
v_accvgpr_read_b32 v236, a68
v_accvgpr_read_b32 v237, a69
v_accvgpr_read_b32 v238, a70
v_accvgpr_read_b32 v239, a71
v_mul_f32 v22, v22, v8
v_mul_f32 v232, v232, v22
v_mul_f32 v233, v233, v22
v_mul_f32 v234, v234, v22
v_mul_f32 v235, v235, v22
v_mul_f32 v236, v236, v22
v_mul_f32 v237, v237, v22
v_mul_f32 v238, v238, v22
v_mul_f32 v239, v239, v22
v_cvt_pk_bf16_f32 v232, v232, v233
v_cvt_pk_bf16_f32 v233, v234, v235
v_cvt_pk_bf16_f32 v234, v236, v237
v_cvt_pk_bf16_f32 v235, v238, v239
s_add_u32 s77, s75, 0
buffer_store_dwordx4 v[232:235], v16, s[44:47], s77 offen sc1
L_TAIL:
ds_read_b128 a[176:179], v3 offset:4096
ds_read_b128 a[180:183], v3 offset:12288
ds_read_b128 a[184:187], v3 offset:5120
ds_read_b128 a[188:191], v3 offset:13312
v_smfmac_f32_16x16x64_bf16 a[140:143], a[240:243], v[208:215], v5
s_waitcnt lgkmcnt(11)
s_add_u32 m0, s86, 32768
s_add_u32 s64, s85, 262144
ds_read_b128 a[192:195], v3 offset:6144
v_mfma_f32_16x16x32_bf16 a[96:99], a[144:147], v[208:211], a[96:99]
s_waitcnt lgkmcnt(11)
ds_read_b128 a[196:199], v3 offset:14336
ds_read_b128 a[200:203], v3 offset:7168
ds_read_b128 a[204:207], v3 offset:15360
v_mfma_f32_16x16x32_bf16 a[96:99], a[148:151], v[212:215], a[96:99]
s_waitcnt lgkmcnt(12)
buffer_load_dwordx4 v12, s[36:39], s64 offen lds
v_mfma_f32_16x16x32_bf16 a[100:103], a[156:159], v[212:215], a[100:103]
s_add_u32 m0, s86, 33792
s_add_u32 s64, s85, 270336
v_accvgpr_read_b32 v240, a72
v_accvgpr_read_b32 v241, a73
v_mfma_f32_16x16x32_bf16 a[100:103], a[152:155], v[208:211], a[100:103]
s_waitcnt lgkmcnt(11)
buffer_load_dwordx4 v13, s[36:39], s64 offen lds
v_mfma_f32_16x16x32_bf16 a[104:107], a[160:163], v[208:211], a[104:107]
s_waitcnt lgkmcnt(10)
s_add_u32 m0, s86, 34816
s_add_u32 s64, s85, 278528
v_accvgpr_read_b32 v242, a74
v_accvgpr_read_b32 v243, a75
v_mfma_f32_16x16x32_bf16 a[104:107], a[164:167], v[212:215], a[104:107]
s_waitcnt lgkmcnt(8)
buffer_load_dwordx4 v12, s[36:39], s64 offen lds
v_mfma_f32_16x16x32_bf16 a[108:111], a[172:175], v[212:215], a[108:111]
s_add_u32 m0, s86, 35840
s_add_u32 s64, s85, 286720
v_accvgpr_read_b32 v244, a76
v_accvgpr_read_b32 v245, a77
v_mfma_f32_16x16x32_bf16 a[108:111], a[168:171], v[208:211], a[108:111]
s_waitcnt lgkmcnt(7)
buffer_load_dwordx4 v13, s[36:39], s64 offen lds
v_mfma_f32_16x16x32_bf16 a[112:115], a[176:179], v[208:211], a[112:115]
s_waitcnt lgkmcnt(6)
s_add_u32 m0, s86, 36864
s_add_u32 s64, s85, 294912
v_accvgpr_read_b32 v246, a78
v_accvgpr_read_b32 v247, a79
v_mfma_f32_16x16x32_bf16 a[112:115], a[180:183], v[212:215], a[112:115]
s_waitcnt lgkmcnt(4)
buffer_load_dwordx4 v12, s[36:39], s64 offen lds
v_mfma_f32_16x16x32_bf16 a[116:119], a[188:191], v[212:215], a[116:119]
s_add_u32 m0, s86, 37888
s_add_u32 s64, s85, 303104
v_mul_f32 v240, v240, v22
v_mul_f32 v241, v241, v22
v_mfma_f32_16x16x32_bf16 a[116:119], a[184:187], v[208:211], a[116:119]
s_waitcnt lgkmcnt(3)
buffer_load_dwordx4 v13, s[36:39], s64 offen lds
v_mfma_f32_16x16x32_bf16 a[120:123], a[192:195], v[208:211], a[120:123]
s_waitcnt lgkmcnt(2)
s_add_u32 m0, s86, 38912
s_add_u32 s64, s85, 311296
v_mul_f32 v242, v242, v22
v_mul_f32 v243, v243, v22
v_mfma_f32_16x16x32_bf16 a[120:123], a[196:199], v[212:215], a[120:123]
s_waitcnt lgkmcnt(0)
buffer_load_dwordx4 v12, s[36:39], s64 offen lds
v_mfma_f32_16x16x32_bf16 a[124:127], a[204:207], v[212:215], a[124:127]
s_add_u32 m0, s86, 39936
s_add_u32 s64, s85, 319488
v_mul_f32 v244, v244, v22
v_mul_f32 v245, v245, v22
v_mfma_f32_16x16x32_bf16 a[124:127], a[200:203], v[208:211], a[124:127]
buffer_load_dwordx4 v13, s[36:39], s64 offen lds
v_mul_f32 v246, v246, v22
v_mul_f32 v247, v247, v22
v_cvt_pk_bf16_f32 v240, v240, v241
v_cvt_pk_bf16_f32 v241, v242, v243
v_cvt_pk_bf16_f32 v242, v244, v245
v_cvt_pk_bf16_f32 v243, v246, v247
s_add_u32 s77, s75, 8192
buffer_store_dwordx4 v[240:243], v16, s[44:47], s77 offen sc1
v_accvgpr_read_b32 v23, a140
v_accvgpr_read_b32 v248, a141
v_add_f32 v23, v23, v248
v_max_f32 v1, v1, v23
v_rcp_f32 v23, v23
s_mov_b32 s66, 0x5d800000
v_cmp_le_f32 vcc, s66, v1
s_lshl_b32 s67, s30, 2
s_cmp_lg_u64 vcc, 0
s_cselect_b32 s66, 1, 0
v_mov_b32 v248, s67
v_mov_b32 v249, s66
ds_write_b32 v248, v249
v_accvgpr_read_b32 v232, a80
v_accvgpr_read_b32 v233, a81
v_accvgpr_read_b32 v234, a82
v_accvgpr_read_b32 v235, a83
v_accvgpr_read_b32 v236, a84
v_accvgpr_read_b32 v237, a85
v_accvgpr_read_b32 v238, a86
v_accvgpr_read_b32 v239, a87
v_pk_mul_f32 v[232:233], v[232:233], v[22:23] op_sel_hi:[1,0]
v_pk_mul_f32 v[234:235], v[234:235], v[22:23] op_sel_hi:[1,0]
v_pk_mul_f32 v[236:237], v[236:237], v[22:23] op_sel_hi:[1,0]
v_pk_mul_f32 v[238:239], v[238:239], v[22:23] op_sel_hi:[1,0]
v_cvt_pk_bf16_f32 v232, v232, v233
v_cvt_pk_bf16_f32 v233, v234, v235
v_cvt_pk_bf16_f32 v234, v236, v237
v_cvt_pk_bf16_f32 v235, v238, v239
s_add_u32 s77, s75, 16384
buffer_store_dwordx4 v[232:235], v16, s[44:47], s77 offen sc1
v_accvgpr_read_b32 v240, a88
v_accvgpr_read_b32 v241, a89
v_accvgpr_read_b32 v242, a90
v_accvgpr_read_b32 v243, a91
v_accvgpr_read_b32 v244, a92
v_accvgpr_read_b32 v245, a93
v_accvgpr_read_b32 v246, a94
v_accvgpr_read_b32 v247, a95
v_pk_mul_f32 v[240:241], v[240:241], v[22:23] op_sel_hi:[1,0]
v_pk_mul_f32 v[242:243], v[242:243], v[22:23] op_sel_hi:[1,0]
v_pk_mul_f32 v[244:245], v[244:245], v[22:23] op_sel_hi:[1,0]
v_pk_mul_f32 v[246:247], v[246:247], v[22:23] op_sel_hi:[1,0]
v_cvt_pk_bf16_f32 v240, v240, v241
v_cvt_pk_bf16_f32 v241, v242, v243
v_cvt_pk_bf16_f32 v242, v244, v245
v_cvt_pk_bf16_f32 v243, v246, v247
s_add_u32 s77, s75, 24576
buffer_store_dwordx4 v[240:243], v16, s[44:47], s77 offen sc1
v_accvgpr_read_b32 v232, a96
v_accvgpr_read_b32 v233, a97
v_accvgpr_read_b32 v234, a98
v_accvgpr_read_b32 v235, a99
v_accvgpr_read_b32 v236, a100
v_accvgpr_read_b32 v237, a101
v_accvgpr_read_b32 v238, a102
v_accvgpr_read_b32 v239, a103
v_mul_f32 v23, v23, v10
v_pk_mul_f32 v[232:233], v[232:233], v[22:23] op_sel:[0,1]
v_pk_mul_f32 v[234:235], v[234:235], v[22:23] op_sel:[0,1]
v_pk_mul_f32 v[236:237], v[236:237], v[22:23] op_sel:[0,1]
v_pk_mul_f32 v[238:239], v[238:239], v[22:23] op_sel:[0,1]
v_cvt_pk_bf16_f32 v232, v232, v233
v_cvt_pk_bf16_f32 v233, v234, v235
v_cvt_pk_bf16_f32 v234, v236, v237
v_cvt_pk_bf16_f32 v235, v238, v239
s_add_u32 s77, s75, 4096
buffer_store_dwordx4 v[232:235], v16, s[44:47], s77 offen sc1
v_accvgpr_read_b32 v240, a104
v_accvgpr_read_b32 v241, a105
v_accvgpr_read_b32 v242, a106
v_accvgpr_read_b32 v243, a107
v_accvgpr_read_b32 v244, a108
v_accvgpr_read_b32 v245, a109
v_accvgpr_read_b32 v246, a110
v_accvgpr_read_b32 v247, a111
v_pk_mul_f32 v[240:241], v[240:241], v[22:23] op_sel:[0,1]
v_pk_mul_f32 v[242:243], v[242:243], v[22:23] op_sel:[0,1]
v_pk_mul_f32 v[244:245], v[244:245], v[22:23] op_sel:[0,1]
v_pk_mul_f32 v[246:247], v[246:247], v[22:23] op_sel:[0,1]
v_cvt_pk_bf16_f32 v240, v240, v241
v_cvt_pk_bf16_f32 v241, v242, v243
v_cvt_pk_bf16_f32 v242, v244, v245
v_cvt_pk_bf16_f32 v243, v246, v247
s_add_u32 s77, s75, 12288
buffer_store_dwordx4 v[240:243], v16, s[44:47], s77 offen sc1
v_mov_b32 v248, 0
s_waitcnt lgkmcnt(0)
s_barrier
ds_read_b128 v[248:251], v248
v_xor_b32 v188, 128, v18
v_xor_b32 v189, 160, v18
v_xor_b32 v190, 192, v18
ds_read_b64_tr_b16 a[144:145], v188 offset:32768
ds_read_b64_tr_b16 a[146:147], v188 offset:36864
ds_read_b64_tr_b16 a[148:149], v188 offset:40960
ds_read_b64_tr_b16 a[150:151], v188 offset:45056
ds_read_b64_tr_b16 a[152:153], v189 offset:32768
ds_read_b64_tr_b16 a[154:155], v189 offset:36864
ds_read_b64_tr_b16 a[156:157], v189 offset:40960
ds_read_b64_tr_b16 a[158:159], v189 offset:45056
ds_read_b64_tr_b16 a[160:161], v190 offset:32768
ds_read_b64_tr_b16 a[162:163], v190 offset:36864
ds_read_b64_tr_b16 a[164:165], v190 offset:40960
ds_read_b64_tr_b16 a[166:167], v190 offset:45056
v_xor_b32 v191, 224, v18
v_xor_b32 v184, 0, v18
v_xor_b32 v185, 32, v18
v_xor_b32 v186, 64, v18
v_xor_b32 v187, 96, v18
v_accvgpr_read_b32 v232, a112
v_accvgpr_read_b32 v233, a113
v_accvgpr_read_b32 v234, a114
v_accvgpr_read_b32 v235, a115
v_accvgpr_read_b32 v236, a116
v_accvgpr_read_b32 v237, a117
v_accvgpr_read_b32 v238, a118
v_accvgpr_read_b32 v239, a119
v_pk_mul_f32 v[232:233], v[232:233], v[22:23] op_sel:[0,1]
v_pk_mul_f32 v[234:235], v[234:235], v[22:23] op_sel:[0,1]
v_pk_mul_f32 v[236:237], v[236:237], v[22:23] op_sel:[0,1]
v_pk_mul_f32 v[238:239], v[238:239], v[22:23] op_sel:[0,1]
v_cvt_pk_bf16_f32 v232, v232, v233
v_cvt_pk_bf16_f32 v233, v234, v235
v_cvt_pk_bf16_f32 v234, v236, v237
v_cvt_pk_bf16_f32 v235, v238, v239
s_add_u32 s77, s75, 20480
buffer_store_dwordx4 v[232:235], v16, s[44:47], s77 offen sc1
v_accvgpr_read_b32 v240, a120
v_accvgpr_read_b32 v241, a121
v_accvgpr_read_b32 v242, a122
v_accvgpr_read_b32 v243, a123
v_accvgpr_read_b32 v244, a124
v_accvgpr_read_b32 v245, a125
v_accvgpr_read_b32 v246, a126
v_accvgpr_read_b32 v247, a127
v_pk_mul_f32 v[240:241], v[240:241], v[22:23] op_sel:[0,1]
v_pk_mul_f32 v[242:243], v[242:243], v[22:23] op_sel:[0,1]
v_pk_mul_f32 v[244:245], v[244:245], v[22:23] op_sel:[0,1]
v_pk_mul_f32 v[246:247], v[246:247], v[22:23] op_sel:[0,1]
v_cvt_pk_bf16_f32 v240, v240, v241
v_cvt_pk_bf16_f32 v241, v242, v243
v_cvt_pk_bf16_f32 v242, v244, v245
v_cvt_pk_bf16_f32 v243, v246, v247
s_add_u32 s77, s75, 28672
buffer_store_dwordx4 v[240:243], v16, s[44:47], s77 offen sc1
s_waitcnt lgkmcnt(12)
v_or3_b32 v248, v248, v249, v250
v_or_b32 v248, v248, v251
s_nop 0
v_readfirstlane_b32 s66, v248
s_nop 0
s_cmp_gt_u32 s66, s73
s_cbranch_scc1 L_fallback_11
s_cmp_eq_u32 s83, 0
s_cbranch_scc1 L_p5f0
s_waitcnt lgkmcnt(10)
s_waitcnt vmcnt(28)
v_mfma_f32_16x16x32_bf16 v[136:139], a[144:147], a[232:235], 0
s_waitcnt vmcnt(24)
s_waitcnt lgkmcnt(8)
s_add_u32 m0, s86, 98304
ds_read_b64_tr_b16 a[168:169], v191 offset:32768
v_xor_b32 v192, 0x10000, v184
v_mfma_f32_16x16x32_bf16 v[136:139], a[148:151], a[236:239], v[136:139]
s_add_u32 s64, s85, 524288
ds_read_b64_tr_b16 a[170:171], v191 offset:36864
v_xor_b32 v193, 0x10000, v185
v_mfma_f32_16x16x32_bf16 v[104:107], a[148:151], a[228:231], 0
buffer_load_dwordx4 v12, s[36:39], s64 offen lds
v_mfma_f32_16x16x32_bf16 v[104:107], a[144:147], a[224:227], v[104:107]
s_add_u32 m0, s86, 99328
s_add_u32 s64, s85, 532480
ds_read_b64_tr_b16 a[172:173], v191 offset:40960
v_xor_b32 v194, 0x10000, v186
v_mfma_f32_16x16x32_bf16 v[72:75], a[144:147], a[216:219], 0
buffer_load_dwordx4 v13, s[36:39], s64 offen lds
v_mfma_f32_16x16x32_bf16 v[72:75], a[148:151], a[220:223], v[72:75]
s_add_u32 m0, s86, 100352
ds_read_b64_tr_b16 a[174:175], v191 offset:45056
v_xor_b32 v195, 0x10000, v187
v_mfma_f32_16x16x32_bf16 v[40:43], a[148:151], a[212:215], 0
s_add_u32 s64, s85, 540672
ds_read_b64_tr_b16 a[176:177], v184 offset:32768
v_xor_b32 v196, 0x10000, v188
v_mfma_f32_16x16x32_bf16 v[40:43], a[144:147], a[208:211], v[40:43]
s_waitcnt lgkmcnt(5)
buffer_load_dwordx4 v12, s[36:39], s64 offen lds
v_mfma_f32_16x16x32_bf16 v[44:47], a[152:155], a[208:211], 0
s_add_u32 m0, s86, 101376
s_add_u32 s64, s85, 548864
ds_read_b64_tr_b16 a[178:179], v184 offset:36864
v_xor_b32 v197, 0x10000, v189
v_mfma_f32_16x16x32_bf16 v[44:47], a[156:159], a[212:215], v[44:47]
buffer_load_dwordx4 v13, s[36:39], s64 offen lds
v_mfma_f32_16x16x32_bf16 v[76:79], a[156:159], a[220:223], 0
s_add_u32 m0, s86, 102400
ds_read_b64_tr_b16 a[180:181], v184 offset:40960
v_xor_b32 v198, 0x10000, v190
v_mfma_f32_16x16x32_bf16 v[76:79], a[152:155], a[216:219], v[76:79]
s_add_u32 s64, s85, 557056
ds_read_b64_tr_b16 a[182:183], v184 offset:45056
v_xor_b32 v199, 0x10000, v191
v_mfma_f32_16x16x32_bf16 v[108:111], a[152:155], a[224:227], 0
buffer_load_dwordx4 v12, s[36:39], s64 offen lds
v_mfma_f32_16x16x32_bf16 v[108:111], a[156:159], a[228:231], v[108:111]
s_add_u32 m0, s86, 103424
s_add_u32 s64, s85, 565248
ds_read_b64_tr_b16 a[184:185], v185 offset:32768
v_mfma_f32_16x16x32_bf16 v[140:143], a[156:159], a[236:239], 0
buffer_load_dwordx4 v13, s[36:39], s64 offen lds
v_mfma_f32_16x16x32_bf16 v[140:143], a[152:155], a[232:235], v[140:143]
s_add_u32 m0, s86, 104448
s_add_u32 s64, s85, 573440
ds_read_b64_tr_b16 a[186:187], v185 offset:36864
v_mfma_f32_16x16x32_bf16 v[144:147], a[160:163], a[232:235], 0
s_and_b32 s68, s82, 3
s_lshl_b32 s68, s68, 11
ds_read_b64_tr_b16 a[188:189], v185 offset:40960
v_mfma_f32_16x16x32_bf16 v[144:147], a[164:167], a[236:239], v[144:147]
s_add_u32 s76, s86, s68
buffer_load_dwordx4 v12, s[36:39], s64 offen lds
v_mfma_f32_16x16x32_bf16 v[112:115], a[164:167], a[228:231], 0
s_branch L_po20
L_pg20:
s_branch L_pg24
L_po20:
s_and_b32 s71, s31, 4
s_lshl_b32 s71, s71, 5
s_add_u32 m0, s86, 105472
s_add_u32 s64, s85, 581632
ds_read_b64_tr_b16 a[190:191], v185 offset:45056
v_mfma_f32_16x16x32_bf16 v[112:115], a[160:163], a[224:227], v[112:115]
s_add_u32 s71, s71, s79
buffer_load_dwordx4 v13, s[36:39], s64 offen lds
v_mfma_f32_16x16x32_bf16 v[80:83], a[160:163], a[216:219], 0
s_add_u32 s71, s71, 4096
s_add_u32 s72, s80, 4096
ds_read_b64_tr_b16 a[192:193], v186 offset:32768
v_mfma_f32_16x16x32_bf16 v[80:83], a[164:167], a[220:223], v[80:83]
s_lshr_b32 s69, s87, 8
s_lshr_b32 s67, s82, 1
s_add_u32 s65, s84, 65536
ds_read_b64_tr_b16 a[194:195], v186 offset:36864
v_mfma_f32_16x16x32_bf16 v[48:51], a[164:167], a[212:215], 0
s_xor_b32 s69, s69, s67
buffer_load_dwordx4 a[32:35], v14, s[44:47], s65 offen offset:0 sc1
v_mfma_f32_16x16x32_bf16 v[48:51], a[160:163], a[208:211], v[48:51]
s_waitcnt lgkmcnt(4)
s_and_b32 s69, s69, 2
s_lshl_b32 s69, s69, 15
ds_read_b64_tr_b16 a[196:197], v186 offset:40960
v_mfma_f32_16x16x32_bf16 v[52:55], a[168:171], a[208:211], 0
s_add_u32 s68, s68, s69
buffer_load_dwordx4 a[40:43], v14, s[44:47], s65 offen offset:1024 sc1
v_mfma_f32_16x16x32_bf16 v[52:55], a[172:175], a[212:215], v[52:55]
ds_read_b64_tr_b16 a[198:199], v186 offset:45056
v_mfma_f32_16x16x32_bf16 v[84:87], a[172:175], a[220:223], 0
ds_read_b64_tr_b16 a[200:201], v187 offset:32768
v_mfma_f32_16x16x32_bf16 v[84:87], a[168:171], a[216:219], v[84:87]
buffer_load_dwordx4 a[48:51], v15, s[44:47], s65 offen offset:0 sc1
v_mfma_f32_16x16x32_bf16 v[116:119], a[168:171], a[224:227], 0
ds_read_b64_tr_b16 a[202:203], v187 offset:36864
v_mfma_f32_16x16x32_bf16 v[116:119], a[172:175], a[228:231], v[116:119]
buffer_load_dwordx4 a[56:59], v15, s[44:47], s65 offen offset:1024 sc1
v_mfma_f32_16x16x32_bf16 v[148:151], a[172:175], a[236:239], 0
ds_read_b64_tr_b16 a[204:205], v187 offset:40960
v_mfma_f32_16x16x32_bf16 v[148:151], a[168:171], a[232:235], v[148:151]
s_add_u32 s65, s84, 73728
ds_read_b64_tr_b16 a[206:207], v187 offset:45056
v_mfma_f32_16x16x32_bf16 v[120:123], a[176:179], a[232:235], 0
buffer_load_dwordx4 a[36:39], v14, s[44:47], s65 offen offset:0 sc1
v_mfma_f32_16x16x32_bf16 v[120:123], a[180:183], a[236:239], v[120:123]
v_mfma_f32_16x16x32_bf16 v[88:91], a[180:183], a[228:231], 0
buffer_load_dwordx4 a[44:47], v14, s[44:47], s65 offen offset:1024 sc1
v_mfma_f32_16x16x32_bf16 v[88:91], a[176:179], a[224:227], v[88:91]
v_mfma_f32_16x16x32_bf16 v[56:59], a[176:179], a[216:219], 0
v_mfma_f32_16x16x32_bf16 v[56:59], a[180:183], a[220:223], v[56:59]
buffer_load_dwordx4 a[52:55], v15, s[44:47], s65 offen offset:0 sc1
v_mfma_f32_16x16x32_bf16 v[24:27], a[180:183], a[212:215], 0
v_mfma_f32_16x16x32_bf16 v[24:27], a[176:179], a[208:211], v[24:27]
buffer_load_dwordx4 a[60:63], v15, s[44:47], s65 offen offset:1024 sc1
v_mfma_f32_16x16x32_bf16 v[28:31], a[184:187], a[208:211], 0
s_waitcnt lgkmcnt(0)
v_mfma_f32_16x16x32_bf16 v[28:31], a[188:191], a[212:215], v[28:31]
v_mfma_f32_16x16x32_bf16 v[60:63], a[188:191], a[220:223], 0
buffer_load_dword v19, off, s[52:55], s72 sc1
v_mfma_f32_16x16x32_bf16 v[60:63], a[184:187], a[216:219], v[60:63]
s_add_u32 s85, s85, 2883584
s_lshl3_add_u32 s85, s68, s85
s_waitcnt vmcnt(24) lgkmcnt(0)
s_barrier
v_mfma_f32_16x16x32_bf16 v[92:95], a[184:187], a[224:227], 0
ds_read_b64_tr_b16 a[144:145], v196 offset:0
v_mfma_f32_16x16x32_bf16 v[92:95], a[188:191], a[228:231], v[92:95]
ds_read_b64_tr_b16 a[146:147], v196 offset:4096
v_mfma_f32_16x16x32_bf16 v[124:127], a[188:191], a[236:239], 0
s_xor_b32 m0, s76, 131072
ds_read_b64_tr_b16 a[148:149], v196 offset:8192
v_mfma_f32_16x16x32_bf16 v[124:127], a[184:187], a[232:235], v[124:127]
s_xor_b32 s64, s85, 0
ds_read_b64_tr_b16 a[150:151], v196 offset:12288
v_mfma_f32_16x16x32_bf16 v[128:131], a[192:195], a[232:235], 0
buffer_load_dwordx4 v12, s[40:43], s64 offen lds
v_mfma_f32_16x16x32_bf16 v[128:131], a[196:199], a[236:239], v[128:131]
s_xor_b32 m0, s76, 132096
ds_read_b64_tr_b16 a[152:153], v197 offset:0
v_mfma_f32_16x16x32_bf16 v[96:99], a[196:199], a[228:231], 0
s_xor_b32 s64, s85, 8192
ds_read_b64_tr_b16 a[154:155], v197 offset:4096
v_mfma_f32_16x16x32_bf16 v[96:99], a[192:195], a[224:227], v[96:99]
buffer_load_dwordx4 v13, s[40:43], s64 offen lds
v_mfma_f32_16x16x32_bf16 v[64:67], a[192:195], a[216:219], 0
s_xor_b32 m0, s76, 133120
ds_read_b64_tr_b16 a[156:157], v197 offset:8192
v_mfma_f32_16x16x32_bf16 v[64:67], a[196:199], a[220:223], v[64:67]
s_xor_b32 s64, s85, 16384
ds_read_b64_tr_b16 a[158:159], v197 offset:12288
v_mfma_f32_16x16x32_bf16 v[32:35], a[196:199], a[212:215], 0
buffer_load_dwordx4 v12, s[40:43], s64 offen lds
v_mfma_f32_16x16x32_bf16 v[32:35], a[192:195], a[208:211], v[32:35]
s_xor_b32 m0, s76, 134144
ds_read_b64_tr_b16 a[160:161], v198 offset:0
v_mfma_f32_16x16x32_bf16 v[36:39], a[200:203], a[208:211], 0
s_xor_b32 s64, s85, 24576
ds_read_b64_tr_b16 a[162:163], v198 offset:4096
v_mfma_f32_16x16x32_bf16 v[36:39], a[204:207], a[212:215], v[36:39]
buffer_load_dwordx4 v13, s[40:43], s64 offen lds
v_mfma_f32_16x16x32_bf16 v[68:71], a[204:207], a[220:223], 0
s_xor_b32 m0, s76, 135168
ds_read_b64_tr_b16 a[164:165], v198 offset:8192
v_mfma_f32_16x16x32_bf16 v[68:71], a[200:203], a[216:219], v[68:71]
s_xor_b32 s64, s85, 32768
ds_read_b64_tr_b16 a[166:167], v198 offset:12288
v_mfma_f32_16x16x32_bf16 v[100:103], a[200:203], a[224:227], 0
buffer_load_dwordx4 v12, s[40:43], s64 offen lds
v_mfma_f32_16x16x32_bf16 v[100:103], a[204:207], a[228:231], v[100:103]
v_mfma_f32_16x16x32_bf16 v[132:135], a[204:207], a[236:239], 0
v_mfma_f32_16x16x32_bf16 v[132:135], a[200:203], a[232:235], v[132:135]
s_waitcnt lgkmcnt(3)
v_mfma_f32_16x16x32_bf16 v[136:139], a[144:147], v[176:179], v[136:139]
s_waitcnt vmcnt(5)
v_readfirstlane_b32 vcc_lo, v19
s_nop 0
s_cmp_lt_u32 vcc_lo, 8
s_cbranch_scc1 L_spin_2016
L_spinbk_2017:
s_sub_u32 s84, s84, 688128
s_add_u32 s84, s84, s69
v_mfma_f32_16x16x32_bf16 v[136:139], a[148:151], v[180:183], v[136:139]
s_xor_b32 m0, s76, 136192
s_xor_b32 s64, s85, 40960
ds_read_b64_tr_b16 a[168:169], v199 offset:0
v_mfma_f32_16x16x32_bf16 v[104:107], a[148:151], v[172:175], v[104:107]
buffer_load_dwordx4 v13, s[40:43], s64 offen lds
v_mfma_f32_16x16x32_bf16 v[104:107], a[144:147], v[168:171], v[104:107]
s_xor_b32 m0, s76, 137216
ds_read_b64_tr_b16 a[170:171], v199 offset:4096
v_mfma_f32_16x16x32_bf16 v[72:75], a[144:147], v[160:163], v[72:75]
s_xor_b32 s64, s85, 49152
ds_read_b64_tr_b16 a[172:173], v199 offset:8192
v_mfma_f32_16x16x32_bf16 v[72:75], a[148:151], v[164:167], v[72:75]
buffer_load_dwordx4 v12, s[40:43], s64 offen lds
v_mfma_f32_16x16x32_bf16 v[40:43], a[148:151], v[156:159], v[40:43]
ds_read_b64_tr_b16 a[174:175], v199 offset:12288
v_mfma_f32_16x16x32_bf16 v[40:43], a[144:147], v[152:155], v[40:43]
s_xor_b32 m0, s76, 138240
ds_read_b64_tr_b16 a[176:177], v192 offset:0
v_mfma_f32_16x16x32_bf16 v[44:47], a[152:155], v[152:155], v[44:47]
s_xor_b32 s64, s85, 57344
ds_read_b64_tr_b16 a[178:179], v192 offset:4096
v_mfma_f32_16x16x32_bf16 v[44:47], a[156:159], v[156:159], v[44:47]
buffer_load_dwordx4 v13, s[40:43], s64 offen lds
v_mfma_f32_16x16x32_bf16 v[76:79], a[156:159], v[164:167], v[76:79]
ds_read_b64_tr_b16 a[180:181], v192 offset:8192
v_mfma_f32_16x16x32_bf16 v[76:79], a[152:155], v[160:163], v[76:79]
s_xor_b32 s65, s84, 0
ds_read_b64_tr_b16 a[182:183], v192 offset:12288
v_mfma_f32_16x16x32_bf16 v[108:111], a[152:155], v[168:171], v[108:111]
buffer_load_dwordx4 a[208:211], v14, s[44:47], s65 offen offset:0 sc1
v_mfma_f32_16x16x32_bf16 v[108:111], a[156:159], v[172:175], v[108:111]
ds_read_b64_tr_b16 a[184:185], v193 offset:0
v_mfma_f32_16x16x32_bf16 v[140:143], a[156:159], v[180:183], v[140:143]
ds_read_b64_tr_b16 a[186:187], v193 offset:4096
v_mfma_f32_16x16x32_bf16 v[140:143], a[152:155], v[176:179], v[140:143]
s_waitcnt lgkmcnt(5)
ds_read_b64_tr_b16 a[188:189], v193 offset:8192
v_mfma_f32_16x16x32_bf16 v[144:147], a[160:163], v[176:179], v[144:147]
buffer_load_dwordx4 a[216:219], v14, s[44:47], s65 offen offset:1024 sc1
v_mfma_f32_16x16x32_bf16 v[144:147], a[164:167], v[180:183], v[144:147]
ds_read_b64_tr_b16 a[190:191], v193 offset:12288
v_mfma_f32_16x16x32_bf16 v[112:115], a[164:167], v[172:175], v[112:115]
ds_read_b64_tr_b16 a[192:193], v194 offset:0
v_mfma_f32_16x16x32_bf16 v[112:115], a[160:163], v[168:171], v[112:115]
ds_read_b64_tr_b16 a[194:195], v194 offset:4096
v_mfma_f32_16x16x32_bf16 v[80:83], a[160:163], v[160:163], v[80:83]
buffer_load_dwordx4 a[224:227], v15, s[44:47], s65 offen offset:0 sc1
v_mfma_f32_16x16x32_bf16 v[80:83], a[164:167], v[164:167], v[80:83]
ds_read_b64_tr_b16 a[196:197], v194 offset:8192
v_mfma_f32_16x16x32_bf16 v[48:51], a[164:167], v[156:159], v[48:51]
ds_read_b64_tr_b16 a[198:199], v194 offset:12288
v_mfma_f32_16x16x32_bf16 v[48:51], a[160:163], v[152:155], v[48:51]
buffer_load_dwordx4 a[232:235], v15, s[44:47], s65 offen offset:1024 sc1
v_mfma_f32_16x16x32_bf16 v[52:55], a[168:171], v[152:155], v[52:55]
v_mfma_f32_16x16x32_bf16 v[52:55], a[172:175], v[156:159], v[52:55]
v_mfma_f32_16x16x32_bf16 v[84:87], a[172:175], v[164:167], v[84:87]
s_xor_b32 s65, s84, 8192
ds_read_b64_tr_b16 a[200:201], v195 offset:0
v_mfma_f32_16x16x32_bf16 v[84:87], a[168:171], v[160:163], v[84:87]
buffer_load_dwordx4 a[212:215], v14, s[44:47], s65 offen offset:0 sc1
v_mfma_f32_16x16x32_bf16 v[116:119], a[168:171], v[168:171], v[116:119]
ds_read_b64_tr_b16 a[202:203], v195 offset:4096
v_mfma_f32_16x16x32_bf16 v[116:119], a[172:175], v[172:175], v[116:119]
ds_read_b64_tr_b16 a[204:205], v195 offset:8192
v_mfma_f32_16x16x32_bf16 v[148:151], a[172:175], v[180:183], v[148:151]
ds_read_b64_tr_b16 a[206:207], v195 offset:12288
v_mfma_f32_16x16x32_bf16 v[148:151], a[168:171], v[176:179], v[148:151]
s_waitcnt lgkmcnt(4)
s_lshl_b32 s66, s30, 30
buffer_load_dwordx4 a[220:223], v14, s[44:47], s65 offen offset:1024 sc1
v_mfma_f32_16x16x32_bf16 v[120:123], a[176:179], v[176:179], v[120:123]
v_lshl_add_u32 v1, v0, 24, s66
v_mfma_f32_16x16x32_bf16 v[120:123], a[180:183], v[180:183], v[120:123]
v_mfma_f32_16x16x32_bf16 v[88:91], a[180:183], v[172:175], v[88:91]
buffer_load_dwordx4 a[228:231], v15, s[44:47], s65 offen offset:0 sc1
v_mfma_f32_16x16x32_bf16 v[88:91], a[176:179], v[168:171], v[88:91]
v_mfma_f32_16x16x32_bf16 v[56:59], a[176:179], v[160:163], v[56:59]
v_mfma_f32_16x16x32_bf16 v[56:59], a[180:183], v[164:167], v[56:59]
v_mfma_f32_16x16x32_bf16 v[24:27], a[180:183], v[156:159], v[24:27]
buffer_load_dwordx4 a[236:239], v15, s[44:47], s65 offen offset:1024 sc1
v_mfma_f32_16x16x32_bf16 v[24:27], a[176:179], v[152:155], v[24:27]
v_mfma_f32_16x16x32_bf16 v[28:31], a[184:187], v[152:155], v[28:31]
v_mfma_f32_16x16x32_bf16 v[28:31], a[188:191], v[156:159], v[28:31]
v_mfma_f32_16x16x32_bf16 v[60:63], a[188:191], v[164:167], v[60:63]
v_mfma_f32_16x16x32_bf16 v[60:63], a[184:187], v[160:163], v[60:63]
s_waitcnt lgkmcnt(0)
s_barrier
v_mfma_f32_16x16x32_bf16 v[92:95], a[184:187], v[168:171], v[92:95]
s_mov_b64 exec, 1
buffer_atomic_add a251, v1, s[52:55], s71 offen offset:0 sc1
s_mov_b64 exec, -1
v_mfma_f32_16x16x32_bf16 v[92:95], a[188:191], v[172:175], v[92:95]
ds_read_b64_tr_b16 a[144:145], v188 offset:0
v_mfma_f32_16x16x32_bf16 v[124:127], a[188:191], v[180:183], v[124:127]
s_xor_b32 m0, s76, 32768
ds_read_b64_tr_b16 a[146:147], v188 offset:4096
v_mfma_f32_16x16x32_bf16 v[124:127], a[184:187], v[176:179], v[124:127]
s_xor_b32 s64, s85, 262144
ds_read_b64_tr_b16 a[148:149], v188 offset:8192
v_mfma_f32_16x16x32_bf16 v[128:131], a[192:195], v[176:179], v[128:131]
buffer_load_dwordx4 v12, s[40:43], s64 offen lds
v_mfma_f32_16x16x32_bf16 v[128:131], a[196:199], v[180:183], v[128:131]
s_xor_b32 m0, s76, 33792
ds_read_b64_tr_b16 a[150:151], v188 offset:12288
v_mfma_f32_16x16x32_bf16 v[96:99], a[196:199], v[172:175], v[96:99]
s_xor_b32 s64, s85, 270336
ds_read_b64_tr_b16 a[152:153], v189 offset:0
v_mfma_f32_16x16x32_bf16 v[96:99], a[192:195], v[168:171], v[96:99]
buffer_load_dwordx4 v13, s[40:43], s64 offen lds
v_mfma_f32_16x16x32_bf16 v[64:67], a[192:195], v[160:163], v[64:67]
s_xor_b32 m0, s76, 34816
ds_read_b64_tr_b16 a[154:155], v189 offset:4096
v_mfma_f32_16x16x32_bf16 v[64:67], a[196:199], v[164:167], v[64:67]
s_xor_b32 s64, s85, 278528
ds_read_b64_tr_b16 a[156:157], v189 offset:8192
v_mfma_f32_16x16x32_bf16 v[32:35], a[196:199], v[156:159], v[32:35]
buffer_load_dwordx4 v12, s[40:43], s64 offen lds
v_mfma_f32_16x16x32_bf16 v[32:35], a[192:195], v[152:155], v[32:35]
s_xor_b32 m0, s76, 35840
ds_read_b64_tr_b16 a[158:159], v189 offset:12288
v_mfma_f32_16x16x32_bf16 v[36:39], a[200:203], v[152:155], v[36:39]
s_xor_b32 s64, s85, 286720
ds_read_b64_tr_b16 a[160:161], v190 offset:0
v_mfma_f32_16x16x32_bf16 v[36:39], a[204:207], v[156:159], v[36:39]
buffer_load_dwordx4 v13, s[40:43], s64 offen lds
v_mfma_f32_16x16x32_bf16 v[68:71], a[204:207], v[164:167], v[68:71]
s_xor_b32 m0, s76, 36864
ds_read_b64_tr_b16 a[162:163], v190 offset:4096
v_mfma_f32_16x16x32_bf16 v[68:71], a[200:203], v[160:163], v[68:71]
s_xor_b32 s64, s85, 294912
ds_read_b64_tr_b16 a[164:165], v190 offset:8192
v_mfma_f32_16x16x32_bf16 v[100:103], a[200:203], v[168:171], v[100:103]
buffer_load_dwordx4 v12, s[40:43], s64 offen lds
v_mfma_f32_16x16x32_bf16 v[100:103], a[204:207], v[172:175], v[100:103]
ds_read_b64_tr_b16 a[166:167], v190 offset:12288
v_mfma_f32_16x16x32_bf16 v[132:135], a[204:207], v[180:183], v[132:135]
v_mfma_f32_16x16x32_bf16 v[132:135], a[200:203], v[176:179], v[132:135]
s_waitcnt lgkmcnt(4)
v_mfma_f32_16x16x32_bf16 v[136:139], a[144:147], a[56:59], v[136:139]
s_xor_b32 m0, s76, 37888
ds_read_b64_tr_b16 a[168:169], v191 offset:0
v_mfma_f32_16x16x32_bf16 v[136:139], a[148:151], a[60:63], v[136:139]
s_xor_b32 s64, s85, 303104
ds_read_b64_tr_b16 a[170:171], v191 offset:4096
v_mfma_f32_16x16x32_bf16 v[104:107], a[148:151], a[52:55], v[104:107]
buffer_load_dwordx4 v13, s[40:43], s64 offen lds
v_mfma_f32_16x16x32_bf16 v[104:107], a[144:147], a[48:51], v[104:107]
s_xor_b32 m0, s76, 38912
ds_read_b64_tr_b16 a[172:173], v191 offset:8192
v_mfma_f32_16x16x32_bf16 v[72:75], a[144:147], a[40:43], v[72:75]
s_xor_b32 s64, s85, 311296
ds_read_b64_tr_b16 a[174:175], v191 offset:12288
v_mfma_f32_16x16x32_bf16 v[72:75], a[148:151], a[44:47], v[72:75]
buffer_load_dwordx4 v12, s[40:43], s64 offen lds
v_mfma_f32_16x16x32_bf16 v[40:43], a[148:151], a[36:39], v[40:43]
ds_read_b64_tr_b16 a[176:177], v184 offset:0
v_mfma_f32_16x16x32_bf16 v[40:43], a[144:147], a[32:35], v[40:43]
s_xor_b32 m0, s76, 39936
ds_read_b64_tr_b16 a[178:179], v184 offset:4096
v_mfma_f32_16x16x32_bf16 v[44:47], a[152:155], a[32:35], v[44:47]
s_xor_b32 s64, s85, 319488
ds_read_b64_tr_b16 a[180:181], v184 offset:8192
v_mfma_f32_16x16x32_bf16 v[44:47], a[156:159], a[36:39], v[44:47]
buffer_load_dwordx4 v13, s[40:43], s64 offen lds
v_mfma_f32_16x16x32_bf16 v[76:79], a[156:159], a[44:47], v[76:79]
ds_read_b64_tr_b16 a[182:183], v184 offset:12288
v_mfma_f32_16x16x32_bf16 v[76:79], a[152:155], a[40:43], v[76:79]
s_xor_b32 s65, s84, 32768
ds_read_b64_tr_b16 a[184:185], v185 offset:0
v_mfma_f32_16x16x32_bf16 v[108:111], a[152:155], a[48:51], v[108:111]
buffer_load_dwordx4 v[152:155], v14, s[44:47], s65 offen offset:0 sc1
v_mfma_f32_16x16x32_bf16 v[108:111], a[156:159], a[52:55], v[108:111]
ds_read_b64_tr_b16 a[186:187], v185 offset:4096
v_mfma_f32_16x16x32_bf16 v[140:143], a[156:159], a[60:63], v[140:143]
ds_read_b64_tr_b16 a[188:189], v185 offset:8192
v_mfma_f32_16x16x32_bf16 v[140:143], a[152:155], a[56:59], v[140:143]
s_waitcnt lgkmcnt(5)
ds_read_b64_tr_b16 a[190:191], v185 offset:12288
v_mfma_f32_16x16x32_bf16 v[144:147], a[160:163], a[56:59], v[144:147]
buffer_load_dwordx4 v[160:163], v14, s[44:47], s65 offen offset:1024 sc1
v_mfma_f32_16x16x32_bf16 v[144:147], a[164:167], a[60:63], v[144:147]
v_mfma_f32_16x16x32_bf16 v[112:115], a[164:167], a[52:55], v[112:115]
ds_read_b64_tr_b16 a[192:193], v186 offset:0
v_mfma_f32_16x16x32_bf16 v[112:115], a[160:163], a[48:51], v[112:115]
ds_read_b64_tr_b16 a[194:195], v186 offset:4096
v_mfma_f32_16x16x32_bf16 v[80:83], a[160:163], a[40:43], v[80:83]
buffer_load_dwordx4 v[168:171], v15, s[44:47], s65 offen offset:0 sc1
v_mfma_f32_16x16x32_bf16 v[80:83], a[164:167], a[44:47], v[80:83]
ds_read_b64_tr_b16 a[196:197], v186 offset:8192
v_mfma_f32_16x16x32_bf16 v[48:51], a[164:167], a[36:39], v[48:51]
ds_read_b64_tr_b16 a[198:199], v186 offset:12288
v_mfma_f32_16x16x32_bf16 v[48:51], a[160:163], a[32:35], v[48:51]
buffer_load_dwordx4 v[176:179], v15, s[44:47], s65 offen offset:1024 sc1
v_mfma_f32_16x16x32_bf16 v[52:55], a[168:171], a[32:35], v[52:55]
v_mfma_f32_16x16x32_bf16 v[52:55], a[172:175], a[36:39], v[52:55]
v_mfma_f32_16x16x32_bf16 v[84:87], a[172:175], a[44:47], v[84:87]
s_xor_b32 s65, s84, 40960
ds_read_b64_tr_b16 a[200:201], v187 offset:0
v_mfma_f32_16x16x32_bf16 v[84:87], a[168:171], a[40:43], v[84:87]
buffer_load_dwordx4 v[156:159], v14, s[44:47], s65 offen offset:0 sc1
v_mfma_f32_16x16x32_bf16 v[116:119], a[168:171], a[48:51], v[116:119]
ds_read_b64_tr_b16 a[202:203], v187 offset:4096
v_mfma_f32_16x16x32_bf16 v[116:119], a[172:175], a[52:55], v[116:119]
ds_read_b64_tr_b16 a[204:205], v187 offset:8192
v_mfma_f32_16x16x32_bf16 v[148:151], a[172:175], a[60:63], v[148:151]
ds_read_b64_tr_b16 a[206:207], v187 offset:12288
v_mfma_f32_16x16x32_bf16 v[148:151], a[168:171], a[56:59], v[148:151]
buffer_load_dwordx4 v[164:167], v14, s[44:47], s65 offen offset:1024 sc1
v_mfma_f32_16x16x32_bf16 v[120:123], a[176:179], a[56:59], v[120:123]
s_waitcnt lgkmcnt(4)
v_mfma_f32_16x16x32_bf16 v[120:123], a[180:183], a[60:63], v[120:123]
v_mfma_f32_16x16x32_bf16 v[88:91], a[180:183], a[52:55], v[88:91]
buffer_load_dwordx4 v[172:175], v15, s[44:47], s65 offen offset:0 sc1
v_mfma_f32_16x16x32_bf16 v[88:91], a[176:179], a[48:51], v[88:91]
v_mfma_f32_16x16x32_bf16 v[56:59], a[176:179], a[40:43], v[56:59]
v_mfma_f32_16x16x32_bf16 v[56:59], a[180:183], a[44:47], v[56:59]
v_mfma_f32_16x16x32_bf16 v[24:27], a[180:183], a[36:39], v[24:27]
buffer_load_dwordx4 v[180:183], v15, s[44:47], s65 offen offset:1024 sc1
v_mfma_f32_16x16x32_bf16 v[24:27], a[176:179], a[32:35], v[24:27]
v_mfma_f32_16x16x32_bf16 v[28:31], a[184:187], a[32:35], v[28:31]
v_mfma_f32_16x16x32_bf16 v[28:31], a[188:191], a[36:39], v[28:31]
v_mfma_f32_16x16x32_bf16 v[60:63], a[188:191], a[44:47], v[60:63]
v_mfma_f32_16x16x32_bf16 v[60:63], a[184:187], a[40:43], v[60:63]
s_waitcnt vmcnt(25)
s_barrier
v_mfma_f32_16x16x32_bf16 v[92:95], a[184:187], a[48:51], v[92:95]
ds_read_b64_tr_b16 a[144:145], v188 offset:32768
v_mfma_f32_16x16x32_bf16 v[92:95], a[188:191], a[52:55], v[92:95]
ds_read_b64_tr_b16 a[146:147], v188 offset:36864
v_mfma_f32_16x16x32_bf16 v[124:127], a[188:191], a[60:63], v[124:127]
s_xor_b32 m0, s76, 65536
ds_read_b64_tr_b16 a[148:149], v188 offset:40960
v_mfma_f32_16x16x32_bf16 v[124:127], a[184:187], a[56:59], v[124:127]
s_xor_b32 s64, s85, 524288
ds_read_b64_tr_b16 a[150:151], v188 offset:45056
v_mfma_f32_16x16x32_bf16 v[128:131], a[192:195], a[56:59], v[128:131]
buffer_load_dwordx4 v12, s[40:43], s64 offen lds
v_mfma_f32_16x16x32_bf16 v[128:131], a[196:199], a[60:63], v[128:131]
s_xor_b32 m0, s76, 66560
ds_read_b64_tr_b16 a[152:153], v189 offset:32768
v_mfma_f32_16x16x32_bf16 v[96:99], a[196:199], a[52:55], v[96:99]
s_xor_b32 s64, s85, 532480
ds_read_b64_tr_b16 a[154:155], v189 offset:36864
v_mfma_f32_16x16x32_bf16 v[96:99], a[192:195], a[48:51], v[96:99]
buffer_load_dwordx4 v13, s[40:43], s64 offen lds
v_mfma_f32_16x16x32_bf16 v[64:67], a[192:195], a[40:43], v[64:67]
s_xor_b32 m0, s76, 67584
ds_read_b64_tr_b16 a[156:157], v189 offset:40960
v_mfma_f32_16x16x32_bf16 v[64:67], a[196:199], a[44:47], v[64:67]
s_xor_b32 s64, s85, 540672
ds_read_b64_tr_b16 a[158:159], v189 offset:45056
v_mfma_f32_16x16x32_bf16 v[32:35], a[196:199], a[36:39], v[32:35]
buffer_load_dwordx4 v12, s[40:43], s64 offen lds
v_mfma_f32_16x16x32_bf16 v[32:35], a[192:195], a[32:35], v[32:35]
s_waitcnt lgkmcnt(4)
s_xor_b32 m0, s76, 68608
ds_read_b64_tr_b16 a[160:161], v190 offset:32768
v_mfma_f32_16x16x32_bf16 v[36:39], a[200:203], a[32:35], v[36:39]
s_xor_b32 s64, s85, 548864
ds_read_b64_tr_b16 a[162:163], v190 offset:36864
v_mfma_f32_16x16x32_bf16 v[36:39], a[204:207], a[36:39], v[36:39]
buffer_load_dwordx4 v13, s[40:43], s64 offen lds
v_mfma_f32_16x16x32_bf16 v[68:71], a[204:207], a[44:47], v[68:71]
s_xor_b32 m0, s76, 69632
ds_read_b64_tr_b16 a[164:165], v190 offset:40960
v_mfma_f32_16x16x32_bf16 v[68:71], a[200:203], a[40:43], v[68:71]
s_xor_b32 s64, s85, 557056
ds_read_b64_tr_b16 a[166:167], v190 offset:45056
v_mfma_f32_16x16x32_bf16 v[100:103], a[200:203], a[48:51], v[100:103]
buffer_load_dwordx4 v12, s[40:43], s64 offen lds
v_mfma_f32_16x16x32_bf16 v[100:103], a[204:207], a[52:55], v[100:103]
s_mov_b32 s70, 3
s_mov_b32 s73, 2
v_mfma_f32_16x16x32_bf16 v[132:135], a[204:207], a[60:63], v[132:135]
v_mfma_f32_16x16x32_bf16 v[132:135], a[200:203], a[56:59], v[132:135]
s_branch L_p5join
.p2align 12
L_pg21:
s_branch L_pg25
L_p5join:
L_p5loop:
s_waitcnt lgkmcnt(10)
s_waitcnt vmcnt(19)
v_mfma_f32_16x16x32_bf16 v[136:139], a[144:147], a[232:235], v[136:139]
s_waitcnt vmcnt(15)
s_waitcnt lgkmcnt(8)
s_xor_b32 m0, s76, 70656
s_xor_b32 s64, s85, 565248
ds_read_b64_tr_b16 a[168:169], v191 offset:32768
v_mfma_f32_16x16x32_bf16 v[136:139], a[148:151], a[236:239], v[136:139]
buffer_load_dwordx4 v13, s[40:43], s64 offen lds
v_mfma_f32_16x16x32_bf16 v[104:107], a[148:151], a[228:231], v[104:107]
ds_read_b64_tr_b16 a[170:171], v191 offset:36864
v_mfma_f32_16x16x32_bf16 v[104:107], a[144:147], a[224:227], v[104:107]
s_xor_b32 m0, s76, 71680
ds_read_b64_tr_b16 a[172:173], v191 offset:40960
v_mfma_f32_16x16x32_bf16 v[72:75], a[144:147], a[216:219], v[72:75]
s_xor_b32 s64, s85, 573440
ds_read_b64_tr_b16 a[174:175], v191 offset:45056
v_mfma_f32_16x16x32_bf16 v[72:75], a[148:151], a[220:223], v[72:75]
buffer_load_dwordx4 v12, s[40:43], s64 offen lds
v_mfma_f32_16x16x32_bf16 v[40:43], a[148:151], a[212:215], v[40:43]
ds_read_b64_tr_b16 a[176:177], v184 offset:32768
v_mfma_f32_16x16x32_bf16 v[40:43], a[144:147], a[208:211], v[40:43]
s_waitcnt lgkmcnt(5)
s_xor_b32 m0, s76, 72704
ds_read_b64_tr_b16 a[178:179], v184 offset:36864
v_mfma_f32_16x16x32_bf16 v[44:47], a[152:155], a[208:211], v[44:47]
s_xor_b32 s64, s85, 581632
ds_read_b64_tr_b16 a[180:181], v184 offset:40960
v_mfma_f32_16x16x32_bf16 v[44:47], a[156:159], a[212:215], v[44:47]
buffer_load_dwordx4 v13, s[40:43], s64 offen lds
v_mfma_f32_16x16x32_bf16 v[76:79], a[156:159], a[220:223], v[76:79]
ds_read_b64_tr_b16 a[182:183], v184 offset:45056
v_mfma_f32_16x16x32_bf16 v[76:79], a[152:155], a[216:219], v[76:79]
ds_read_b64_tr_b16 a[184:185], v185 offset:32768
v_mfma_f32_16x16x32_bf16 v[108:111], a[152:155], a[224:227], v[108:111]
s_xor_b32 s65, s84, 65536
ds_read_b64_tr_b16 a[186:187], v185 offset:36864
v_mfma_f32_16x16x32_bf16 v[108:111], a[156:159], a[228:231], v[108:111]
buffer_load_dwordx4 a[0:3], v14, s[44:47], s65 offen offset:0 sc1
v_mfma_f32_16x16x32_bf16 v[140:143], a[156:159], a[236:239], v[140:143]
ds_read_b64_tr_b16 a[188:189], v185 offset:40960
v_mfma_f32_16x16x32_bf16 v[140:143], a[152:155], a[232:235], v[140:143]
ds_read_b64_tr_b16 a[190:191], v185 offset:45056
v_mfma_f32_16x16x32_bf16 v[144:147], a[160:163], a[232:235], v[144:147]
v_mfma_f32_16x16x32_bf16 v[144:147], a[164:167], a[236:239], v[144:147]
buffer_load_dwordx4 a[8:11], v14, s[44:47], s65 offen offset:1024 sc1
v_mfma_f32_16x16x32_bf16 v[112:115], a[164:167], a[228:231], v[112:115]
ds_read_b64_tr_b16 a[192:193], v186 offset:32768
v_mfma_f32_16x16x32_bf16 v[112:115], a[160:163], a[224:227], v[112:115]
ds_read_b64_tr_b16 a[194:195], v186 offset:36864
v_mfma_f32_16x16x32_bf16 v[80:83], a[160:163], a[216:219], v[80:83]
ds_read_b64_tr_b16 a[196:197], v186 offset:40960
v_mfma_f32_16x16x32_bf16 v[80:83], a[164:167], a[220:223], v[80:83]
buffer_load_dwordx4 a[16:19], v15, s[44:47], s65 offen offset:0 sc1
v_mfma_f32_16x16x32_bf16 v[48:51], a[164:167], a[212:215], v[48:51]
ds_read_b64_tr_b16 a[198:199], v186 offset:45056
v_mfma_f32_16x16x32_bf16 v[48:51], a[160:163], a[208:211], v[48:51]
s_waitcnt lgkmcnt(4)
v_mfma_f32_16x16x32_bf16 v[52:55], a[168:171], a[208:211], v[52:55]
v_mfma_f32_16x16x32_bf16 v[52:55], a[172:175], a[212:215], v[52:55]
buffer_load_dwordx4 a[24:27], v15, s[44:47], s65 offen offset:1024 sc1
v_mfma_f32_16x16x32_bf16 v[84:87], a[172:175], a[220:223], v[84:87]
ds_read_b64_tr_b16 a[200:201], v187 offset:32768
v_mfma_f32_16x16x32_bf16 v[84:87], a[168:171], a[216:219], v[84:87]
ds_read_b64_tr_b16 a[202:203], v187 offset:36864
v_mfma_f32_16x16x32_bf16 v[116:119], a[168:171], a[224:227], v[116:119]
s_xor_b32 s65, s84, 73728
ds_read_b64_tr_b16 a[204:205], v187 offset:40960
v_mfma_f32_16x16x32_bf16 v[116:119], a[172:175], a[228:231], v[116:119]
buffer_load_dwordx4 a[4:7], v14, s[44:47], s65 offen offset:0 sc1
v_mfma_f32_16x16x32_bf16 v[148:151], a[172:175], a[236:239], v[148:151]
ds_read_b64_tr_b16 a[206:207], v187 offset:45056
v_mfma_f32_16x16x32_bf16 v[148:151], a[168:171], a[232:235], v[148:151]
v_mfma_f32_16x16x32_bf16 v[120:123], a[176:179], a[232:235], v[120:123]
v_mfma_f32_16x16x32_bf16 v[120:123], a[180:183], a[236:239], v[120:123]
buffer_load_dwordx4 a[12:15], v14, s[44:47], s65 offen offset:1024 sc1
v_mfma_f32_16x16x32_bf16 v[88:91], a[180:183], a[228:231], v[88:91]
v_mfma_f32_16x16x32_bf16 v[88:91], a[176:179], a[224:227], v[88:91]
v_mfma_f32_16x16x32_bf16 v[56:59], a[176:179], a[216:219], v[56:59]
v_mfma_f32_16x16x32_bf16 v[56:59], a[180:183], a[220:223], v[56:59]
buffer_load_dwordx4 a[20:23], v15, s[44:47], s65 offen offset:0 sc1
v_mfma_f32_16x16x32_bf16 v[24:27], a[180:183], a[212:215], v[24:27]
v_mfma_f32_16x16x32_bf16 v[24:27], a[176:179], a[208:211], v[24:27]
v_mfma_f32_16x16x32_bf16 v[28:31], a[184:187], a[208:211], v[28:31]
v_mfma_f32_16x16x32_bf16 v[28:31], a[188:191], a[212:215], v[28:31]
buffer_load_dwordx4 a[28:31], v15, s[44:47], s65 offen offset:1024 sc1
v_mfma_f32_16x16x32_bf16 v[60:63], a[188:191], a[220:223], v[60:63]
v_mfma_f32_16x16x32_bf16 v[60:63], a[184:187], a[216:219], v[60:63]
s_waitcnt vmcnt(24)
s_barrier
v_mfma_f32_16x16x32_bf16 v[92:95], a[184:187], a[224:227], v[92:95]
s_xor_b32 m0, s76, 98304
ds_read_b64_tr_b16 a[144:145], v196 offset:0
v_mfma_f32_16x16x32_bf16 v[92:95], a[188:191], a[228:231], v[92:95]
s_xor_b32 s64, s85, 786432
ds_read_b64_tr_b16 a[146:147], v196 offset:4096
v_mfma_f32_16x16x32_bf16 v[124:127], a[188:191], a[236:239], v[124:127]
buffer_load_dwordx4 v12, s[40:43], s64 offen lds
v_mfma_f32_16x16x32_bf16 v[124:127], a[184:187], a[232:235], v[124:127]
s_waitcnt lgkmcnt(2)
s_xor_b32 m0, s76, 99328
ds_read_b64_tr_b16 a[148:149], v196 offset:8192
v_mfma_f32_16x16x32_bf16 v[128:131], a[192:195], a[232:235], v[128:131]
s_xor_b32 s64, s85, 794624
ds_read_b64_tr_b16 a[150:151], v196 offset:12288
v_mfma_f32_16x16x32_bf16 v[128:131], a[196:199], a[236:239], v[128:131]
buffer_load_dwordx4 v13, s[40:43], s64 offen lds
v_mfma_f32_16x16x32_bf16 v[96:99], a[196:199], a[228:231], v[96:99]
ds_read_b64_tr_b16 a[152:153], v197 offset:0
v_mfma_f32_16x16x32_bf16 v[96:99], a[192:195], a[224:227], v[96:99]
s_xor_b32 m0, s76, 100352
ds_read_b64_tr_b16 a[154:155], v197 offset:4096
v_mfma_f32_16x16x32_bf16 v[64:67], a[192:195], a[216:219], v[64:67]
s_xor_b32 s64, s85, 802816
ds_read_b64_tr_b16 a[156:157], v197 offset:8192
v_mfma_f32_16x16x32_bf16 v[64:67], a[196:199], a[220:223], v[64:67]
buffer_load_dwordx4 v12, s[40:43], s64 offen lds
v_mfma_f32_16x16x32_bf16 v[32:35], a[196:199], a[212:215], v[32:35]
ds_read_b64_tr_b16 a[158:159], v197 offset:12288
v_mfma_f32_16x16x32_bf16 v[32:35], a[192:195], a[208:211], v[32:35]
s_xor_b32 m0, s76, 101376
ds_read_b64_tr_b16 a[160:161], v198 offset:0
v_mfma_f32_16x16x32_bf16 v[36:39], a[200:203], a[208:211], v[36:39]
s_xor_b32 s64, s85, 811008
ds_read_b64_tr_b16 a[162:163], v198 offset:4096
v_mfma_f32_16x16x32_bf16 v[36:39], a[204:207], a[212:215], v[36:39]
buffer_load_dwordx4 v13, s[40:43], s64 offen lds
v_mfma_f32_16x16x32_bf16 v[68:71], a[204:207], a[220:223], v[68:71]
ds_read_b64_tr_b16 a[164:165], v198 offset:8192
v_mfma_f32_16x16x32_bf16 v[68:71], a[200:203], a[216:219], v[68:71]
s_xor_b32 m0, s76, 102400
ds_read_b64_tr_b16 a[166:167], v198 offset:12288
v_mfma_f32_16x16x32_bf16 v[100:103], a[200:203], a[224:227], v[100:103]
s_xor_b32 s64, s85, 819200
v_mfma_f32_16x16x32_bf16 v[100:103], a[204:207], a[228:231], v[100:103]
buffer_load_dwordx4 v12, s[40:43], s64 offen lds
v_mfma_f32_16x16x32_bf16 v[132:135], a[204:207], a[236:239], v[132:135]
v_mfma_f32_16x16x32_bf16 v[132:135], a[200:203], a[232:235], v[132:135]
s_waitcnt vmcnt(25)
s_waitcnt lgkmcnt(3)
s_xor_b32 m0, s76, 103424
buffer_load_dword v19, off, s[52:55], s72 offset:128 sc1
v_mfma_f32_16x16x32_bf16 v[136:139], a[144:147], v[176:179], v[136:139]
s_waitcnt vmcnt(22)
s_xor_b32 s64, s85, 827392
ds_read_b64_tr_b16 a[168:169], v199 offset:0
v_mfma_f32_16x16x32_bf16 v[136:139], a[148:151], v[180:183], v[136:139]
buffer_load_dwordx4 v13, s[40:43], s64 offen lds
v_mfma_f32_16x16x32_bf16 v[104:107], a[148:151], v[172:175], v[104:107]
ds_read_b64_tr_b16 a[170:171], v199 offset:4096
v_mfma_f32_16x16x32_bf16 v[104:107], a[144:147], v[168:171], v[104:107]
s_xor_b32 m0, s76, 104448
ds_read_b64_tr_b16 a[172:173], v199 offset:8192
v_mfma_f32_16x16x32_bf16 v[72:75], a[144:147], v[160:163], v[72:75]
s_xor_b32 s64, s85, 835584
ds_read_b64_tr_b16 a[174:175], v199 offset:12288
v_mfma_f32_16x16x32_bf16 v[72:75], a[148:151], v[164:167], v[72:75]
buffer_load_dwordx4 v12, s[40:43], s64 offen lds
v_mfma_f32_16x16x32_bf16 v[40:43], a[148:151], v[156:159], v[40:43]
ds_read_b64_tr_b16 a[176:177], v192 offset:0
v_mfma_f32_16x16x32_bf16 v[40:43], a[144:147], v[152:155], v[40:43]
s_xor_b32 m0, s76, 105472
ds_read_b64_tr_b16 a[178:179], v192 offset:4096
v_mfma_f32_16x16x32_bf16 v[44:47], a[152:155], v[152:155], v[44:47]
s_xor_b32 s64, s85, 843776
ds_read_b64_tr_b16 a[180:181], v192 offset:8192
v_mfma_f32_16x16x32_bf16 v[44:47], a[156:159], v[156:159], v[44:47]
buffer_load_dwordx4 v13, s[40:43], s64 offen lds
v_mfma_f32_16x16x32_bf16 v[76:79], a[156:159], v[164:167], v[76:79]
ds_read_b64_tr_b16 a[182:183], v192 offset:12288
v_mfma_f32_16x16x32_bf16 v[76:79], a[152:155], v[160:163], v[76:79]
ds_read_b64_tr_b16 a[184:185], v193 offset:0
v_mfma_f32_16x16x32_bf16 v[108:111], a[152:155], v[168:171], v[108:111]
s_xor_b32 s65, s84, 98304
ds_read_b64_tr_b16 a[186:187], v193 offset:4096
v_mfma_f32_16x16x32_bf16 v[108:111], a[156:159], v[172:175], v[108:111]
buffer_load_dwordx4 a[32:35], v14, s[44:47], s65 offen offset:0 sc1
v_mfma_f32_16x16x32_bf16 v[140:143], a[156:159], v[180:183], v[140:143]
ds_read_b64_tr_b16 a[188:189], v193 offset:8192
v_mfma_f32_16x16x32_bf16 v[140:143], a[152:155], v[176:179], v[140:143]
s_waitcnt lgkmcnt(5)
ds_read_b64_tr_b16 a[190:191], v193 offset:12288
v_mfma_f32_16x16x32_bf16 v[144:147], a[160:163], v[176:179], v[144:147]
s_lshl_b32 s75, s73, 20
s_add_u32 s85, s85, s75
s_lshr_b32 s74, s73, 28
v_mfma_f32_16x16x32_bf16 v[144:147], a[164:167], v[180:183], v[144:147]
s_and_b32 s74, s74, 8
buffer_load_dwordx4 a[40:43], v14, s[44:47], s65 offen offset:1024 sc1
v_mfma_f32_16x16x32_bf16 v[112:115], a[164:167], v[172:175], v[112:115]
ds_read_b64_tr_b16 a[192:193], v194 offset:0
v_mfma_f32_16x16x32_bf16 v[112:115], a[160:163], v[168:171], v[112:115]
ds_read_b64_tr_b16 a[194:195], v194 offset:4096
v_mfma_f32_16x16x32_bf16 v[80:83], a[160:163], v[160:163], v[80:83]
ds_read_b64_tr_b16 a[196:197], v194 offset:8192
v_mfma_f32_16x16x32_bf16 v[80:83], a[164:167], v[164:167], v[80:83]
buffer_load_dwordx4 a[48:51], v15, s[44:47], s65 offen offset:0 sc1
v_mfma_f32_16x16x32_bf16 v[48:51], a[164:167], v[156:159], v[48:51]
ds_read_b64_tr_b16 a[198:199], v194 offset:12288
v_mfma_f32_16x16x32_bf16 v[48:51], a[160:163], v[152:155], v[48:51]
v_mfma_f32_16x16x32_bf16 v[52:55], a[168:171], v[152:155], v[52:55]
v_mfma_f32_16x16x32_bf16 v[52:55], a[172:175], v[156:159], v[52:55]
buffer_load_dwordx4 a[56:59], v15, s[44:47], s65 offen offset:1024 sc1
v_mfma_f32_16x16x32_bf16 v[84:87], a[172:175], v[164:167], v[84:87]
ds_read_b64_tr_b16 a[200:201], v195 offset:0
v_mfma_f32_16x16x32_bf16 v[84:87], a[168:171], v[160:163], v[84:87]
ds_read_b64_tr_b16 a[202:203], v195 offset:4096
v_mfma_f32_16x16x32_bf16 v[116:119], a[168:171], v[168:171], v[116:119]
s_xor_b32 s65, s84, 106496
ds_read_b64_tr_b16 a[204:205], v195 offset:8192
v_mfma_f32_16x16x32_bf16 v[116:119], a[172:175], v[172:175], v[116:119]
buffer_load_dwordx4 a[36:39], v14, s[44:47], s65 offen offset:0 sc1
v_mfma_f32_16x16x32_bf16 v[148:151], a[172:175], v[180:183], v[148:151]
ds_read_b64_tr_b16 a[206:207], v195 offset:12288
v_mfma_f32_16x16x32_bf16 v[148:151], a[168:171], v[176:179], v[148:151]
v_mfma_f32_16x16x32_bf16 v[120:123], a[176:179], v[176:179], v[120:123]
s_waitcnt lgkmcnt(4)
v_mfma_f32_16x16x32_bf16 v[120:123], a[180:183], v[180:183], v[120:123]
buffer_load_dwordx4 a[44:47], v14, s[44:47], s65 offen offset:1024 sc1
v_mfma_f32_16x16x32_bf16 v[88:91], a[180:183], v[172:175], v[88:91]
v_mfma_f32_16x16x32_bf16 v[88:91], a[176:179], v[168:171], v[88:91]
v_mfma_f32_16x16x32_bf16 v[56:59], a[176:179], v[160:163], v[56:59]
v_mfma_f32_16x16x32_bf16 v[56:59], a[180:183], v[164:167], v[56:59]
buffer_load_dwordx4 a[52:55], v15, s[44:47], s65 offen offset:0 sc1
v_mfma_f32_16x16x32_bf16 v[24:27], a[180:183], v[156:159], v[24:27]
v_mfma_f32_16x16x32_bf16 v[24:27], a[176:179], v[152:155], v[24:27]
v_mfma_f32_16x16x32_bf16 v[28:31], a[184:187], v[152:155], v[28:31]
v_mfma_f32_16x16x32_bf16 v[28:31], a[188:191], v[156:159], v[28:31]
buffer_load_dwordx4 a[60:63], v15, s[44:47], s65 offen offset:1024 sc1
v_mfma_f32_16x16x32_bf16 v[60:63], a[188:191], v[164:167], v[60:63]
v_mfma_f32_16x16x32_bf16 v[60:63], a[184:187], v[160:163], v[60:63]
s_waitcnt vmcnt(25)
s_barrier
v_mfma_f32_16x16x32_bf16 v[92:95], a[184:187], v[168:171], v[92:95]
s_lshl_b32 s75, s73, 17
s_add_u32 s84, s84, s75
s_xor_b32 m0, s76, 131072
ds_read_b64_tr_b16 a[144:145], v196 offset:32768
v_mfma_f32_16x16x32_bf16 v[92:95], a[188:191], v[172:175], v[92:95]
s_xor_b32 s64, s85, 0
ds_read_b64_tr_b16 a[146:147], v196 offset:36864
v_mfma_f32_16x16x32_bf16 v[124:127], a[188:191], v[180:183], v[124:127]
buffer_load_dwordx4 v12, s[40:43], s64 offen lds
v_mfma_f32_16x16x32_bf16 v[124:127], a[184:187], v[176:179], v[124:127]
s_xor_b32 m0, s76, 132096
ds_read_b64_tr_b16 a[148:149], v196 offset:40960
v_mfma_f32_16x16x32_bf16 v[128:131], a[192:195], v[176:179], v[128:131]
s_xor_b32 s64, s85, 8192
ds_read_b64_tr_b16 a[150:151], v196 offset:45056
v_mfma_f32_16x16x32_bf16 v[128:131], a[196:199], v[180:183], v[128:131]
buffer_load_dwordx4 v13, s[40:43], s64 offen lds
v_mfma_f32_16x16x32_bf16 v[96:99], a[196:199], v[172:175], v[96:99]
ds_read_b64_tr_b16 a[152:153], v197 offset:32768
v_mfma_f32_16x16x32_bf16 v[96:99], a[192:195], v[168:171], v[96:99]
s_xor_b32 m0, s76, 133120
ds_read_b64_tr_b16 a[154:155], v197 offset:36864
v_mfma_f32_16x16x32_bf16 v[64:67], a[192:195], v[160:163], v[64:67]
s_xor_b32 s64, s85, 16384
ds_read_b64_tr_b16 a[156:157], v197 offset:40960
v_mfma_f32_16x16x32_bf16 v[64:67], a[196:199], v[164:167], v[64:67]
buffer_load_dwordx4 v12, s[40:43], s64 offen lds
v_mfma_f32_16x16x32_bf16 v[32:35], a[196:199], v[156:159], v[32:35]
ds_read_b64_tr_b16 a[158:159], v197 offset:45056
v_mfma_f32_16x16x32_bf16 v[32:35], a[192:195], v[152:155], v[32:35]
s_waitcnt lgkmcnt(5)
s_xor_b32 m0, s76, 134144
ds_read_b64_tr_b16 a[160:161], v198 offset:32768
v_mfma_f32_16x16x32_bf16 v[36:39], a[200:203], v[152:155], v[36:39]
s_xor_b32 s64, s85, 24576
ds_read_b64_tr_b16 a[162:163], v198 offset:36864
v_mfma_f32_16x16x32_bf16 v[36:39], a[204:207], v[156:159], v[36:39]
buffer_load_dwordx4 v13, s[40:43], s64 offen lds
v_mfma_f32_16x16x32_bf16 v[68:71], a[204:207], v[164:167], v[68:71]
ds_read_b64_tr_b16 a[164:165], v198 offset:40960
v_mfma_f32_16x16x32_bf16 v[68:71], a[200:203], v[160:163], v[68:71]
s_xor_b32 m0, s76, 135168
ds_read_b64_tr_b16 a[166:167], v198 offset:45056
v_mfma_f32_16x16x32_bf16 v[100:103], a[200:203], v[168:171], v[100:103]
s_xor_b32 s64, s85, 32768
v_mfma_f32_16x16x32_bf16 v[100:103], a[204:207], v[172:175], v[100:103]
buffer_load_dwordx4 v12, s[40:43], s64 offen lds
v_mfma_f32_16x16x32_bf16 v[132:135], a[204:207], v[180:183], v[132:135]
v_mfma_f32_16x16x32_bf16 v[132:135], a[200:203], v[176:179], v[132:135]
s_waitcnt vmcnt(26)
v_mfma_f32_16x16x32_bf16 v[136:139], a[144:147], a[24:27], v[136:139]
s_waitcnt vmcnt(16)
v_readfirstlane_b32 vcc_lo, v19
s_nop 0
s_cmp_lt_u32 vcc_lo, s74
s_cbranch_scc1 L_spin_4022
L_spinbk_4023:
s_waitcnt lgkmcnt(2)
v_mfma_f32_16x16x32_bf16 v[136:139], a[148:151], a[28:31], v[136:139]
s_xor_b32 m0, s76, 136192
ds_read_b64_tr_b16 a[168:169], v199 offset:32768
v_mfma_f32_16x16x32_bf16 v[104:107], a[148:151], a[20:23], v[104:107]
s_xor_b32 s64, s85, 40960
ds_read_b64_tr_b16 a[170:171], v199 offset:36864
v_mfma_f32_16x16x32_bf16 v[104:107], a[144:147], a[16:19], v[104:107]
buffer_load_dwordx4 v13, s[40:43], s64 offen lds
v_mfma_f32_16x16x32_bf16 v[72:75], a[144:147], a[8:11], v[72:75]
s_xor_b32 m0, s76, 137216
ds_read_b64_tr_b16 a[172:173], v199 offset:40960
v_mfma_f32_16x16x32_bf16 v[72:75], a[148:151], a[12:15], v[72:75]
s_xor_b32 s64, s85, 49152
ds_read_b64_tr_b16 a[174:175], v199 offset:45056
v_mfma_f32_16x16x32_bf16 v[40:43], a[148:151], a[4:7], v[40:43]
buffer_load_dwordx4 v12, s[40:43], s64 offen lds
v_mfma_f32_16x16x32_bf16 v[40:43], a[144:147], a[0:3], v[40:43]
ds_read_b64_tr_b16 a[176:177], v192 offset:32768
v_mfma_f32_16x16x32_bf16 v[44:47], a[152:155], a[0:3], v[44:47]
s_xor_b32 m0, s76, 138240
ds_read_b64_tr_b16 a[178:179], v192 offset:36864
v_mfma_f32_16x16x32_bf16 v[44:47], a[156:159], a[4:7], v[44:47]
s_xor_b32 s64, s85, 57344
ds_read_b64_tr_b16 a[180:181], v192 offset:40960
v_mfma_f32_16x16x32_bf16 v[76:79], a[156:159], a[12:15], v[76:79]
buffer_load_dwordx4 v13, s[40:43], s64 offen lds
v_mfma_f32_16x16x32_bf16 v[76:79], a[152:155], a[8:11], v[76:79]
ds_read_b64_tr_b16 a[182:183], v192 offset:45056
v_mfma_f32_16x16x32_bf16 v[108:111], a[152:155], a[16:19], v[108:111]
ds_read_b64_tr_b16 a[184:185], v193 offset:32768
v_mfma_f32_16x16x32_bf16 v[108:111], a[156:159], a[20:23], v[108:111]
s_xor_b32 s65, s84, 0
ds_read_b64_tr_b16 a[186:187], v193 offset:36864
v_mfma_f32_16x16x32_bf16 v[140:143], a[156:159], a[28:31], v[140:143]
buffer_load_dwordx4 a[208:211], v14, s[44:47], s65 offen offset:0 sc1
v_mfma_f32_16x16x32_bf16 v[140:143], a[152:155], a[24:27], v[140:143]
ds_read_b64_tr_b16 a[188:189], v193 offset:40960
v_mfma_f32_16x16x32_bf16 v[144:147], a[160:163], a[24:27], v[144:147]
s_waitcnt lgkmcnt(5)
ds_read_b64_tr_b16 a[190:191], v193 offset:45056
v_mfma_f32_16x16x32_bf16 v[144:147], a[164:167], a[28:31], v[144:147]
v_mfma_f32_16x16x32_bf16 v[112:115], a[164:167], a[20:23], v[112:115]
buffer_load_dwordx4 a[216:219], v14, s[44:47], s65 offen offset:1024 sc1
v_mfma_f32_16x16x32_bf16 v[112:115], a[160:163], a[16:19], v[112:115]
ds_read_b64_tr_b16 a[192:193], v194 offset:32768
v_mfma_f32_16x16x32_bf16 v[80:83], a[160:163], a[8:11], v[80:83]
ds_read_b64_tr_b16 a[194:195], v194 offset:36864
v_mfma_f32_16x16x32_bf16 v[80:83], a[164:167], a[12:15], v[80:83]
ds_read_b64_tr_b16 a[196:197], v194 offset:40960
v_mfma_f32_16x16x32_bf16 v[48:51], a[164:167], a[4:7], v[48:51]
buffer_load_dwordx4 a[224:227], v15, s[44:47], s65 offen offset:0 sc1
v_mfma_f32_16x16x32_bf16 v[48:51], a[160:163], a[0:3], v[48:51]
ds_read_b64_tr_b16 a[198:199], v194 offset:45056
v_mfma_f32_16x16x32_bf16 v[52:55], a[168:171], a[0:3], v[52:55]
v_mfma_f32_16x16x32_bf16 v[52:55], a[172:175], a[4:7], v[52:55]
buffer_load_dwordx4 a[232:235], v15, s[44:47], s65 offen offset:1024 sc1
v_mfma_f32_16x16x32_bf16 v[84:87], a[172:175], a[12:15], v[84:87]
ds_read_b64_tr_b16 a[200:201], v195 offset:32768
v_mfma_f32_16x16x32_bf16 v[84:87], a[168:171], a[8:11], v[84:87]
ds_read_b64_tr_b16 a[202:203], v195 offset:36864
v_mfma_f32_16x16x32_bf16 v[116:119], a[168:171], a[16:19], v[116:119]
s_xor_b32 s65, s84, 8192
ds_read_b64_tr_b16 a[204:205], v195 offset:40960
v_mfma_f32_16x16x32_bf16 v[116:119], a[172:175], a[20:23], v[116:119]
buffer_load_dwordx4 a[212:215], v14, s[44:47], s65 offen offset:0 sc1
v_mfma_f32_16x16x32_bf16 v[148:151], a[172:175], a[28:31], v[148:151]
ds_read_b64_tr_b16 a[206:207], v195 offset:45056
v_mfma_f32_16x16x32_bf16 v[148:151], a[168:171], a[24:27], v[148:151]
v_mfma_f32_16x16x32_bf16 v[120:123], a[176:179], a[24:27], v[120:123]
s_waitcnt lgkmcnt(4)
v_mfma_f32_16x16x32_bf16 v[120:123], a[180:183], a[28:31], v[120:123]
buffer_load_dwordx4 a[220:223], v14, s[44:47], s65 offen offset:1024 sc1
v_mfma_f32_16x16x32_bf16 v[88:91], a[180:183], a[20:23], v[88:91]
v_mfma_f32_16x16x32_bf16 v[88:91], a[176:179], a[16:19], v[88:91]
v_mfma_f32_16x16x32_bf16 v[56:59], a[176:179], a[8:11], v[56:59]
v_mfma_f32_16x16x32_bf16 v[56:59], a[180:183], a[12:15], v[56:59]
buffer_load_dwordx4 a[228:231], v15, s[44:47], s65 offen offset:0 sc1
v_mfma_f32_16x16x32_bf16 v[24:27], a[180:183], a[4:7], v[24:27]
v_mfma_f32_16x16x32_bf16 v[24:27], a[176:179], a[0:3], v[24:27]
v_mfma_f32_16x16x32_bf16 v[28:31], a[184:187], a[0:3], v[28:31]
v_mfma_f32_16x16x32_bf16 v[28:31], a[188:191], a[4:7], v[28:31]
buffer_load_dwordx4 a[236:239], v15, s[44:47], s65 offen offset:1024 sc1
v_mfma_f32_16x16x32_bf16 v[60:63], a[188:191], a[12:15], v[60:63]
v_mfma_f32_16x16x32_bf16 v[60:63], a[184:187], a[8:11], v[60:63]
s_waitcnt vmcnt(24)
s_barrier
v_mfma_f32_16x16x32_bf16 v[92:95], a[184:187], a[16:19], v[92:95]
s_xor_b32 m0, s76, 32768
ds_read_b64_tr_b16 a[144:145], v188 offset:0
v_mfma_f32_16x16x32_bf16 v[92:95], a[188:191], a[20:23], v[92:95]
s_xor_b32 s64, s85, 262144
ds_read_b64_tr_b16 a[146:147], v188 offset:4096
v_mfma_f32_16x16x32_bf16 v[124:127], a[188:191], a[28:31], v[124:127]
buffer_load_dwordx4 v12, s[40:43], s64 offen lds
v_mfma_f32_16x16x32_bf16 v[124:127], a[184:187], a[24:27], v[124:127]
s_xor_b32 m0, s76, 33792
ds_read_b64_tr_b16 a[148:149], v188 offset:8192
v_mfma_f32_16x16x32_bf16 v[128:131], a[192:195], a[24:27], v[128:131]
s_xor_b32 s64, s85, 270336
ds_read_b64_tr_b16 a[150:151], v188 offset:12288
v_mfma_f32_16x16x32_bf16 v[128:131], a[196:199], a[28:31], v[128:131]
buffer_load_dwordx4 v13, s[40:43], s64 offen lds
v_mfma_f32_16x16x32_bf16 v[96:99], a[196:199], a[20:23], v[96:99]
ds_read_b64_tr_b16 a[152:153], v189 offset:0
v_mfma_f32_16x16x32_bf16 v[96:99], a[192:195], a[16:19], v[96:99]
s_xor_b32 m0, s76, 34816
ds_read_b64_tr_b16 a[154:155], v189 offset:4096
v_mfma_f32_16x16x32_bf16 v[64:67], a[192:195], a[8:11], v[64:67]
s_xor_b32 s64, s85, 278528
ds_read_b64_tr_b16 a[156:157], v189 offset:8192
v_mfma_f32_16x16x32_bf16 v[64:67], a[196:199], a[12:15], v[64:67]
buffer_load_dwordx4 v12, s[40:43], s64 offen lds
v_mfma_f32_16x16x32_bf16 v[32:35], a[196:199], a[4:7], v[32:35]
ds_read_b64_tr_b16 a[158:159], v189 offset:12288
v_mfma_f32_16x16x32_bf16 v[32:35], a[192:195], a[0:3], v[32:35]
s_waitcnt lgkmcnt(5)
s_xor_b32 m0, s76, 35840
ds_read_b64_tr_b16 a[160:161], v190 offset:0
v_mfma_f32_16x16x32_bf16 v[36:39], a[200:203], a[0:3], v[36:39]
s_xor_b32 s64, s85, 286720
ds_read_b64_tr_b16 a[162:163], v190 offset:4096
v_mfma_f32_16x16x32_bf16 v[36:39], a[204:207], a[4:7], v[36:39]
buffer_load_dwordx4 v13, s[40:43], s64 offen lds
v_mfma_f32_16x16x32_bf16 v[68:71], a[204:207], a[12:15], v[68:71]
ds_read_b64_tr_b16 a[164:165], v190 offset:8192
v_mfma_f32_16x16x32_bf16 v[68:71], a[200:203], a[8:11], v[68:71]
s_xor_b32 m0, s76, 36864
ds_read_b64_tr_b16 a[166:167], v190 offset:12288
v_mfma_f32_16x16x32_bf16 v[100:103], a[200:203], a[16:19], v[100:103]
s_xor_b32 s64, s85, 294912
v_mfma_f32_16x16x32_bf16 v[100:103], a[204:207], a[20:23], v[100:103]
buffer_load_dwordx4 v12, s[40:43], s64 offen lds
v_mfma_f32_16x16x32_bf16 v[132:135], a[204:207], a[28:31], v[132:135]
v_mfma_f32_16x16x32_bf16 v[132:135], a[200:203], a[24:27], v[132:135]
s_waitcnt vmcnt(25)
s_xor_b32 m0, s76, 37888
v_mfma_f32_16x16x32_bf16 v[136:139], a[144:147], a[56:59], v[136:139]
s_waitcnt vmcnt(21)
s_waitcnt lgkmcnt(2)
s_xor_b32 s64, s85, 303104
ds_read_b64_tr_b16 a[168:169], v191 offset:0
v_mfma_f32_16x16x32_bf16 v[136:139], a[148:151], a[60:63], v[136:139]
buffer_load_dwordx4 v13, s[40:43], s64 offen lds
v_mfma_f32_16x16x32_bf16 v[104:107], a[148:151], a[52:55], v[104:107]
ds_read_b64_tr_b16 a[170:171], v191 offset:4096
v_mfma_f32_16x16x32_bf16 v[104:107], a[144:147], a[48:51], v[104:107]
s_xor_b32 m0, s76, 38912
ds_read_b64_tr_b16 a[172:173], v191 offset:8192
v_mfma_f32_16x16x32_bf16 v[72:75], a[144:147], a[40:43], v[72:75]
s_xor_b32 s64, s85, 311296
ds_read_b64_tr_b16 a[174:175], v191 offset:12288
v_mfma_f32_16x16x32_bf16 v[72:75], a[148:151], a[44:47], v[72:75]
buffer_load_dwordx4 v12, s[40:43], s64 offen lds
v_mfma_f32_16x16x32_bf16 v[40:43], a[148:151], a[36:39], v[40:43]
ds_read_b64_tr_b16 a[176:177], v184 offset:0
v_mfma_f32_16x16x32_bf16 v[40:43], a[144:147], a[32:35], v[40:43]
s_xor_b32 m0, s76, 39936
ds_read_b64_tr_b16 a[178:179], v184 offset:4096
v_mfma_f32_16x16x32_bf16 v[44:47], a[152:155], a[32:35], v[44:47]
s_xor_b32 s64, s85, 319488
ds_read_b64_tr_b16 a[180:181], v184 offset:8192
v_mfma_f32_16x16x32_bf16 v[44:47], a[156:159], a[36:39], v[44:47]
buffer_load_dwordx4 v13, s[40:43], s64 offen lds
v_mfma_f32_16x16x32_bf16 v[76:79], a[156:159], a[44:47], v[76:79]
ds_read_b64_tr_b16 a[182:183], v184 offset:12288
v_mfma_f32_16x16x32_bf16 v[76:79], a[152:155], a[40:43], v[76:79]
ds_read_b64_tr_b16 a[184:185], v185 offset:0
v_mfma_f32_16x16x32_bf16 v[108:111], a[152:155], a[48:51], v[108:111]
s_xor_b32 s65, s84, 32768
ds_read_b64_tr_b16 a[186:187], v185 offset:4096
v_mfma_f32_16x16x32_bf16 v[108:111], a[156:159], a[52:55], v[108:111]
buffer_load_dwordx4 v[152:155], v14, s[44:47], s65 offen offset:0 sc1
v_mfma_f32_16x16x32_bf16 v[140:143], a[156:159], a[60:63], v[140:143]
ds_read_b64_tr_b16 a[188:189], v185 offset:8192
v_mfma_f32_16x16x32_bf16 v[140:143], a[152:155], a[56:59], v[140:143]
ds_read_b64_tr_b16 a[190:191], v185 offset:12288
v_mfma_f32_16x16x32_bf16 v[144:147], a[160:163], a[56:59], v[144:147]
s_waitcnt lgkmcnt(5)
v_mfma_f32_16x16x32_bf16 v[144:147], a[164:167], a[60:63], v[144:147]
buffer_load_dwordx4 v[160:163], v14, s[44:47], s65 offen offset:1024 sc1
v_mfma_f32_16x16x32_bf16 v[112:115], a[164:167], a[52:55], v[112:115]
ds_read_b64_tr_b16 a[192:193], v186 offset:0
v_mfma_f32_16x16x32_bf16 v[112:115], a[160:163], a[48:51], v[112:115]
ds_read_b64_tr_b16 a[194:195], v186 offset:4096
v_mfma_f32_16x16x32_bf16 v[80:83], a[160:163], a[40:43], v[80:83]
ds_read_b64_tr_b16 a[196:197], v186 offset:8192
v_mfma_f32_16x16x32_bf16 v[80:83], a[164:167], a[44:47], v[80:83]
buffer_load_dwordx4 v[168:171], v15, s[44:47], s65 offen offset:0 sc1
v_mfma_f32_16x16x32_bf16 v[48:51], a[164:167], a[36:39], v[48:51]
ds_read_b64_tr_b16 a[198:199], v186 offset:12288
v_mfma_f32_16x16x32_bf16 v[48:51], a[160:163], a[32:35], v[48:51]
v_mfma_f32_16x16x32_bf16 v[52:55], a[168:171], a[32:35], v[52:55]
v_mfma_f32_16x16x32_bf16 v[52:55], a[172:175], a[36:39], v[52:55]
buffer_load_dwordx4 v[176:179], v15, s[44:47], s65 offen offset:1024 sc1
v_mfma_f32_16x16x32_bf16 v[84:87], a[172:175], a[44:47], v[84:87]
ds_read_b64_tr_b16 a[200:201], v187 offset:0
v_mfma_f32_16x16x32_bf16 v[84:87], a[168:171], a[40:43], v[84:87]
ds_read_b64_tr_b16 a[202:203], v187 offset:4096
v_mfma_f32_16x16x32_bf16 v[116:119], a[168:171], a[48:51], v[116:119]
s_xor_b32 s65, s84, 40960
ds_read_b64_tr_b16 a[204:205], v187 offset:8192
v_mfma_f32_16x16x32_bf16 v[116:119], a[172:175], a[52:55], v[116:119]
buffer_load_dwordx4 v[156:159], v14, s[44:47], s65 offen offset:0 sc1
v_mfma_f32_16x16x32_bf16 v[148:151], a[172:175], a[60:63], v[148:151]
ds_read_b64_tr_b16 a[206:207], v187 offset:12288
v_mfma_f32_16x16x32_bf16 v[148:151], a[168:171], a[56:59], v[148:151]
v_mfma_f32_16x16x32_bf16 v[120:123], a[176:179], a[56:59], v[120:123]
s_waitcnt lgkmcnt(4)
v_mfma_f32_16x16x32_bf16 v[120:123], a[180:183], a[60:63], v[120:123]
buffer_load_dwordx4 v[164:167], v14, s[44:47], s65 offen offset:1024 sc1
v_mfma_f32_16x16x32_bf16 v[88:91], a[180:183], a[52:55], v[88:91]
v_mfma_f32_16x16x32_bf16 v[88:91], a[176:179], a[48:51], v[88:91]
v_mfma_f32_16x16x32_bf16 v[56:59], a[176:179], a[40:43], v[56:59]
v_mfma_f32_16x16x32_bf16 v[56:59], a[180:183], a[44:47], v[56:59]
buffer_load_dwordx4 v[172:175], v15, s[44:47], s65 offen offset:0 sc1
v_mfma_f32_16x16x32_bf16 v[24:27], a[180:183], a[36:39], v[24:27]
v_mfma_f32_16x16x32_bf16 v[24:27], a[176:179], a[32:35], v[24:27]
v_mfma_f32_16x16x32_bf16 v[28:31], a[184:187], a[32:35], v[28:31]
v_mfma_f32_16x16x32_bf16 v[28:31], a[188:191], a[36:39], v[28:31]
buffer_load_dwordx4 v[180:183], v15, s[44:47], s65 offen offset:1024 sc1
v_mfma_f32_16x16x32_bf16 v[60:63], a[188:191], a[44:47], v[60:63]
v_mfma_f32_16x16x32_bf16 v[60:63], a[184:187], a[40:43], v[60:63]
s_waitcnt vmcnt(24)
s_barrier
v_mfma_f32_16x16x32_bf16 v[92:95], a[184:187], a[48:51], v[92:95]
s_xor_b32 m0, s76, 65536
ds_read_b64_tr_b16 a[144:145], v188 offset:32768
v_mfma_f32_16x16x32_bf16 v[92:95], a[188:191], a[52:55], v[92:95]
s_xor_b32 s64, s85, 524288
ds_read_b64_tr_b16 a[146:147], v188 offset:36864
v_mfma_f32_16x16x32_bf16 v[124:127], a[188:191], a[60:63], v[124:127]
buffer_load_dwordx4 v12, s[40:43], s64 offen lds
v_mfma_f32_16x16x32_bf16 v[124:127], a[184:187], a[56:59], v[124:127]
s_xor_b32 m0, s76, 66560
ds_read_b64_tr_b16 a[148:149], v188 offset:40960
v_mfma_f32_16x16x32_bf16 v[128:131], a[192:195], a[56:59], v[128:131]
s_xor_b32 s64, s85, 532480
ds_read_b64_tr_b16 a[150:151], v188 offset:45056
v_mfma_f32_16x16x32_bf16 v[128:131], a[196:199], a[60:63], v[128:131]
buffer_load_dwordx4 v13, s[40:43], s64 offen lds
v_mfma_f32_16x16x32_bf16 v[96:99], a[196:199], a[52:55], v[96:99]
ds_read_b64_tr_b16 a[152:153], v189 offset:32768
v_mfma_f32_16x16x32_bf16 v[96:99], a[192:195], a[48:51], v[96:99]
s_branch L_po22
L_pg22:
s_branch L_tr2
L_po22:
s_xor_b32 m0, s76, 67584
ds_read_b64_tr_b16 a[154:155], v189 offset:36864
v_mfma_f32_16x16x32_bf16 v[64:67], a[192:195], a[40:43], v[64:67]
s_xor_b32 s64, s85, 540672
ds_read_b64_tr_b16 a[156:157], v189 offset:40960
v_mfma_f32_16x16x32_bf16 v[64:67], a[196:199], a[44:47], v[64:67]
buffer_load_dwordx4 v12, s[40:43], s64 offen lds
v_mfma_f32_16x16x32_bf16 v[32:35], a[196:199], a[36:39], v[32:35]
ds_read_b64_tr_b16 a[158:159], v189 offset:45056
v_mfma_f32_16x16x32_bf16 v[32:35], a[192:195], a[32:35], v[32:35]
s_waitcnt lgkmcnt(5)
s_xor_b32 m0, s76, 68608
ds_read_b64_tr_b16 a[160:161], v190 offset:32768
v_mfma_f32_16x16x32_bf16 v[36:39], a[200:203], a[32:35], v[36:39]
s_xor_b32 s64, s85, 548864
ds_read_b64_tr_b16 a[162:163], v190 offset:36864
v_mfma_f32_16x16x32_bf16 v[36:39], a[204:207], a[36:39], v[36:39]
buffer_load_dwordx4 v13, s[40:43], s64 offen lds
v_mfma_f32_16x16x32_bf16 v[68:71], a[204:207], a[44:47], v[68:71]
ds_read_b64_tr_b16 a[164:165], v190 offset:40960
v_mfma_f32_16x16x32_bf16 v[68:71], a[200:203], a[40:43], v[68:71]
s_xor_b32 m0, s76, 69632
ds_read_b64_tr_b16 a[166:167], v190 offset:45056
v_mfma_f32_16x16x32_bf16 v[100:103], a[200:203], a[48:51], v[100:103]
s_xor_b32 s64, s85, 557056
v_mfma_f32_16x16x32_bf16 v[100:103], a[204:207], a[52:55], v[100:103]
buffer_load_dwordx4 v12, s[40:43], s64 offen lds
v_mfma_f32_16x16x32_bf16 v[132:135], a[204:207], a[60:63], v[132:135]
s_sub_u32 s73, 1, s73
s_sub_u32 s70, s70, 1
s_cmp_lg_u32 s70, 0
v_mfma_f32_16x16x32_bf16 v[132:135], a[200:203], a[56:59], v[132:135]
s_cbranch_scc1 L_p5loop
L_p5last:
s_waitcnt lgkmcnt(10)
s_waitcnt vmcnt(25)
v_mfma_f32_16x16x32_bf16 v[136:139], a[144:147], a[232:235], v[136:139]
s_waitcnt vmcnt(21)
s_waitcnt lgkmcnt(8)
s_xor_b32 m0, s76, 70656
s_xor_b32 s64, s85, 565248
ds_read_b64_tr_b16 a[168:169], v191 offset:32768
v_mfma_f32_16x16x32_bf16 v[136:139], a[148:151], a[236:239], v[136:139]
buffer_load_dwordx4 v13, s[40:43], s64 offen lds
v_mfma_f32_16x16x32_bf16 v[104:107], a[148:151], a[228:231], v[104:107]
ds_read_b64_tr_b16 a[170:171], v191 offset:36864
v_mfma_f32_16x16x32_bf16 v[104:107], a[144:147], a[224:227], v[104:107]
s_xor_b32 m0, s76, 71680
ds_read_b64_tr_b16 a[172:173], v191 offset:40960
v_mfma_f32_16x16x32_bf16 v[72:75], a[144:147], a[216:219], v[72:75]
s_xor_b32 s64, s85, 573440
ds_read_b64_tr_b16 a[174:175], v191 offset:45056
v_mfma_f32_16x16x32_bf16 v[72:75], a[148:151], a[220:223], v[72:75]
buffer_load_dwordx4 v12, s[40:43], s64 offen lds
v_mfma_f32_16x16x32_bf16 v[40:43], a[148:151], a[212:215], v[40:43]
ds_read_b64_tr_b16 a[176:177], v184 offset:32768
v_mfma_f32_16x16x32_bf16 v[40:43], a[144:147], a[208:211], v[40:43]
s_waitcnt lgkmcnt(5)
s_xor_b32 m0, s76, 72704
ds_read_b64_tr_b16 a[178:179], v184 offset:36864
v_mfma_f32_16x16x32_bf16 v[44:47], a[152:155], a[208:211], v[44:47]
s_xor_b32 s64, s85, 581632
ds_read_b64_tr_b16 a[180:181], v184 offset:40960
v_mfma_f32_16x16x32_bf16 v[44:47], a[156:159], a[212:215], v[44:47]
buffer_load_dwordx4 v13, s[40:43], s64 offen lds
v_mfma_f32_16x16x32_bf16 v[76:79], a[156:159], a[220:223], v[76:79]
ds_read_b64_tr_b16 a[182:183], v184 offset:45056
v_mfma_f32_16x16x32_bf16 v[76:79], a[152:155], a[216:219], v[76:79]
ds_read_b64_tr_b16 a[184:185], v185 offset:32768
v_mfma_f32_16x16x32_bf16 v[108:111], a[152:155], a[224:227], v[108:111]
s_xor_b32 s65, s84, 65536
ds_read_b64_tr_b16 a[186:187], v185 offset:36864
v_mfma_f32_16x16x32_bf16 v[108:111], a[156:159], a[228:231], v[108:111]
buffer_load_dwordx4 a[0:3], v14, s[44:47], s65 offen offset:0 sc1
v_mfma_f32_16x16x32_bf16 v[140:143], a[156:159], a[236:239], v[140:143]
ds_read_b64_tr_b16 a[188:189], v185 offset:40960
v_mfma_f32_16x16x32_bf16 v[140:143], a[152:155], a[232:235], v[140:143]
ds_read_b64_tr_b16 a[190:191], v185 offset:45056
v_mfma_f32_16x16x32_bf16 v[144:147], a[160:163], a[232:235], v[144:147]
v_mfma_f32_16x16x32_bf16 v[144:147], a[164:167], a[236:239], v[144:147]
buffer_load_dwordx4 a[8:11], v14, s[44:47], s65 offen offset:1024 sc1
v_mfma_f32_16x16x32_bf16 v[112:115], a[164:167], a[228:231], v[112:115]
ds_read_b64_tr_b16 a[192:193], v186 offset:32768
v_mfma_f32_16x16x32_bf16 v[112:115], a[160:163], a[224:227], v[112:115]
ds_read_b64_tr_b16 a[194:195], v186 offset:36864
v_mfma_f32_16x16x32_bf16 v[80:83], a[160:163], a[216:219], v[80:83]
ds_read_b64_tr_b16 a[196:197], v186 offset:40960
v_mfma_f32_16x16x32_bf16 v[80:83], a[164:167], a[220:223], v[80:83]
buffer_load_dwordx4 a[16:19], v15, s[44:47], s65 offen offset:0 sc1
v_mfma_f32_16x16x32_bf16 v[48:51], a[164:167], a[212:215], v[48:51]
ds_read_b64_tr_b16 a[198:199], v186 offset:45056
v_mfma_f32_16x16x32_bf16 v[48:51], a[160:163], a[208:211], v[48:51]
s_waitcnt lgkmcnt(4)
v_mfma_f32_16x16x32_bf16 v[52:55], a[168:171], a[208:211], v[52:55]
v_mfma_f32_16x16x32_bf16 v[52:55], a[172:175], a[212:215], v[52:55]
buffer_load_dwordx4 a[24:27], v15, s[44:47], s65 offen offset:1024 sc1
v_mfma_f32_16x16x32_bf16 v[84:87], a[172:175], a[220:223], v[84:87]
ds_read_b64_tr_b16 a[200:201], v187 offset:32768
v_mfma_f32_16x16x32_bf16 v[84:87], a[168:171], a[216:219], v[84:87]
ds_read_b64_tr_b16 a[202:203], v187 offset:36864
v_mfma_f32_16x16x32_bf16 v[116:119], a[168:171], a[224:227], v[116:119]
s_xor_b32 s65, s84, 73728
ds_read_b64_tr_b16 a[204:205], v187 offset:40960
v_mfma_f32_16x16x32_bf16 v[116:119], a[172:175], a[228:231], v[116:119]
buffer_load_dwordx4 a[4:7], v14, s[44:47], s65 offen offset:0 sc1
v_mfma_f32_16x16x32_bf16 v[148:151], a[172:175], a[236:239], v[148:151]
ds_read_b64_tr_b16 a[206:207], v187 offset:45056
v_mfma_f32_16x16x32_bf16 v[148:151], a[168:171], a[232:235], v[148:151]
v_mfma_f32_16x16x32_bf16 v[120:123], a[176:179], a[232:235], v[120:123]
v_mfma_f32_16x16x32_bf16 v[120:123], a[180:183], a[236:239], v[120:123]
buffer_load_dwordx4 a[12:15], v14, s[44:47], s65 offen offset:1024 sc1
v_mfma_f32_16x16x32_bf16 v[88:91], a[180:183], a[228:231], v[88:91]
v_mfma_f32_16x16x32_bf16 v[88:91], a[176:179], a[224:227], v[88:91]
v_mfma_f32_16x16x32_bf16 v[56:59], a[176:179], a[216:219], v[56:59]
v_mfma_f32_16x16x32_bf16 v[56:59], a[180:183], a[220:223], v[56:59]
buffer_load_dwordx4 a[20:23], v15, s[44:47], s65 offen offset:0 sc1
v_mfma_f32_16x16x32_bf16 v[24:27], a[180:183], a[212:215], v[24:27]
v_mfma_f32_16x16x32_bf16 v[24:27], a[176:179], a[208:211], v[24:27]
v_mfma_f32_16x16x32_bf16 v[28:31], a[184:187], a[208:211], v[28:31]
v_mfma_f32_16x16x32_bf16 v[28:31], a[188:191], a[212:215], v[28:31]
buffer_load_dwordx4 a[28:31], v15, s[44:47], s65 offen offset:1024 sc1
v_mfma_f32_16x16x32_bf16 v[60:63], a[188:191], a[220:223], v[60:63]
v_mfma_f32_16x16x32_bf16 v[60:63], a[184:187], a[216:219], v[60:63]
s_waitcnt vmcnt(24)
s_barrier
v_mfma_f32_16x16x32_bf16 v[92:95], a[184:187], a[224:227], v[92:95]
s_xor_b32 m0, s76, 98304
ds_read_b64_tr_b16 a[144:145], v196 offset:0
v_mfma_f32_16x16x32_bf16 v[92:95], a[188:191], a[228:231], v[92:95]
s_xor_b32 s64, s85, 786432
ds_read_b64_tr_b16 a[146:147], v196 offset:4096
v_mfma_f32_16x16x32_bf16 v[124:127], a[188:191], a[236:239], v[124:127]
buffer_load_dwordx4 v12, s[40:43], s64 offen lds
v_mfma_f32_16x16x32_bf16 v[124:127], a[184:187], a[232:235], v[124:127]
s_waitcnt lgkmcnt(2)
s_xor_b32 m0, s76, 99328
ds_read_b64_tr_b16 a[148:149], v196 offset:8192
v_mfma_f32_16x16x32_bf16 v[128:131], a[192:195], a[232:235], v[128:131]
s_xor_b32 s64, s85, 794624
ds_read_b64_tr_b16 a[150:151], v196 offset:12288
v_mfma_f32_16x16x32_bf16 v[128:131], a[196:199], a[236:239], v[128:131]
buffer_load_dwordx4 v13, s[40:43], s64 offen lds
v_mfma_f32_16x16x32_bf16 v[96:99], a[196:199], a[228:231], v[96:99]
ds_read_b64_tr_b16 a[152:153], v197 offset:0
v_mfma_f32_16x16x32_bf16 v[96:99], a[192:195], a[224:227], v[96:99]
s_xor_b32 m0, s76, 100352
ds_read_b64_tr_b16 a[154:155], v197 offset:4096
v_mfma_f32_16x16x32_bf16 v[64:67], a[192:195], a[216:219], v[64:67]
s_xor_b32 s64, s85, 802816
ds_read_b64_tr_b16 a[156:157], v197 offset:8192
v_mfma_f32_16x16x32_bf16 v[64:67], a[196:199], a[220:223], v[64:67]
buffer_load_dwordx4 v12, s[40:43], s64 offen lds
v_mfma_f32_16x16x32_bf16 v[32:35], a[196:199], a[212:215], v[32:35]
ds_read_b64_tr_b16 a[158:159], v197 offset:12288
v_mfma_f32_16x16x32_bf16 v[32:35], a[192:195], a[208:211], v[32:35]
s_xor_b32 m0, s76, 101376
ds_read_b64_tr_b16 a[160:161], v198 offset:0
v_mfma_f32_16x16x32_bf16 v[36:39], a[200:203], a[208:211], v[36:39]
s_xor_b32 s64, s85, 811008
ds_read_b64_tr_b16 a[162:163], v198 offset:4096
v_mfma_f32_16x16x32_bf16 v[36:39], a[204:207], a[212:215], v[36:39]
buffer_load_dwordx4 v13, s[40:43], s64 offen lds
v_mfma_f32_16x16x32_bf16 v[68:71], a[204:207], a[220:223], v[68:71]
s_xor_b32 m0, s76, 102400
ds_read_b64_tr_b16 a[164:165], v198 offset:8192
v_mfma_f32_16x16x32_bf16 v[68:71], a[200:203], a[216:219], v[68:71]
s_xor_b32 s64, s85, 819200
ds_read_b64_tr_b16 a[166:167], v198 offset:12288
v_mfma_f32_16x16x32_bf16 v[100:103], a[200:203], a[224:227], v[100:103]
s_xor_b32 s66, s2, 1
s_lshl2_add_u32 s66, s66, s30
s_lshl_b32 s73, s66, 12
v_mfma_f32_16x16x32_bf16 v[100:103], a[204:207], a[228:231], v[100:103]
s_add_u32 s73, s73, 67108864
buffer_load_dwordx4 v12, s[40:43], s64 offen lds
v_mfma_f32_16x16x32_bf16 v[132:135], a[204:207], a[236:239], v[132:135]
s_lshl2_add_u32 s66, s2, s30
s_lshl_b32 s75, s66, 12
s_add_u32 s75, s75, 67108864
v_mfma_f32_16x16x32_bf16 v[132:135], a[200:203], a[232:235], v[132:135]
s_waitcnt vmcnt(25)
s_waitcnt lgkmcnt(3)
s_lshl_b32 s77, s82, 18
s_lshl_b32 s66, s30, 16
s_add_u32 s77, s77, s66
s_xor_b32 m0, s76, 103424
v_mfma_f32_16x16x32_bf16 v[136:139], a[144:147], v[176:179], v[136:139]
s_waitcnt vmcnt(21)
s_add_u32 s77, s77, s87
s_lshl_b32 s66, s83, 7
s_xor_b32 s64, s85, 827392
ds_read_b64_tr_b16 a[168:169], v199 offset:0
v_mfma_f32_16x16x32_bf16 v[136:139], a[148:151], v[180:183], v[136:139]
s_add_u32 s77, s77, s66
buffer_load_dwordx4 v13, s[40:43], s64 offen lds
v_mfma_f32_16x16x32_bf16 v[104:107], a[148:151], v[172:175], v[104:107]
ds_read_b64_tr_b16 a[170:171], v199 offset:4096
v_lshlrev_b32 v1, 24, v0
v_mfma_f32_16x16x32_bf16 v[104:107], a[144:147], v[168:171], v[104:107]
s_xor_b32 m0, s76, 104448
ds_read_b64_tr_b16 a[172:173], v199 offset:8192
v_and_b32 v8, 7, v0
v_mfma_f32_16x16x32_bf16 v[72:75], a[144:147], v[160:163], v[72:75]
s_xor_b32 s64, s85, 835584
ds_read_b64_tr_b16 a[174:175], v199 offset:12288
v_lshlrev_b32 v8, 11, v8
v_mfma_f32_16x16x32_bf16 v[72:75], a[148:151], v[164:167], v[72:75]
buffer_load_dwordx4 v12, s[40:43], s64 offen lds
v_mfma_f32_16x16x32_bf16 v[40:43], a[148:151], v[156:159], v[40:43]
ds_read_b64_tr_b16 a[176:177], v192 offset:0
v_bfe_u32 v10, v0, 3, 1
v_mfma_f32_16x16x32_bf16 v[40:43], a[144:147], v[152:155], v[40:43]
s_xor_b32 m0, s76, 105472
ds_read_b64_tr_b16 a[178:179], v192 offset:4096
v_lshl_add_u32 v8, v10, 6, v8
v_mfma_f32_16x16x32_bf16 v[44:47], a[152:155], v[152:155], v[44:47]
s_xor_b32 s64, s85, 843776
ds_read_b64_tr_b16 a[180:181], v192 offset:8192
v_bfe_u32 v10, v0, 4, 1
v_mfma_f32_16x16x32_bf16 v[44:47], a[156:159], v[156:159], v[44:47]
buffer_load_dwordx4 v13, s[40:43], s64 offen lds
v_mfma_f32_16x16x32_bf16 v[76:79], a[156:159], v[164:167], v[76:79]
ds_read_b64_tr_b16 a[182:183], v192 offset:12288
v_lshl_add_u32 v8, v10, 5, v8
v_mfma_f32_16x16x32_bf16 v[76:79], a[152:155], v[160:163], v[76:79]
ds_read_b64_tr_b16 a[184:185], v193 offset:0
v_lshrrev_b32 v10, 5, v0
v_mfma_f32_16x16x32_bf16 v[108:111], a[152:155], v[168:171], v[108:111]
s_xor_b32 s65, s84, 98304
ds_read_b64_tr_b16 a[186:187], v193 offset:4096
v_lshl_add_u32 v8, v10, 4, v8
v_mfma_f32_16x16x32_bf16 v[108:111], a[156:159], v[172:175], v[108:111]
buffer_load_dwordx4 a[32:35], v14, s[44:47], s65 offen offset:0 sc1
v_mfma_f32_16x16x32_bf16 v[140:143], a[156:159], v[180:183], v[140:143]
ds_read_b64_tr_b16 a[188:189], v193 offset:8192
v_add_u32 v2, s86, v16
v_mfma_f32_16x16x32_bf16 v[140:143], a[152:155], v[176:179], v[140:143]
s_waitcnt lgkmcnt(5)
ds_read_b64_tr_b16 a[190:191], v193 offset:12288
v_xor_b32 v3, 0x2000, v2
v_mfma_f32_16x16x32_bf16 v[144:147], a[160:163], v[176:179], v[144:147]
v_mov_b32 v232, 0
v_mov_b32 v233, 0
v_mfma_f32_16x16x32_bf16 v[144:147], a[164:167], v[180:183], v[144:147]
buffer_load_dwordx4 a[40:43], v14, s[44:47], s65 offen offset:1024 sc1
v_mfma_f32_16x16x32_bf16 v[112:115], a[164:167], v[172:175], v[112:115]
ds_read_b64_tr_b16 a[192:193], v194 offset:0
v_mov_b32 v236, 0
v_mfma_f32_16x16x32_bf16 v[112:115], a[160:163], v[168:171], v[112:115]
ds_read_b64_tr_b16 a[194:195], v194 offset:4096
v_mov_b32 v237, 0
v_mfma_f32_16x16x32_bf16 v[80:83], a[160:163], v[160:163], v[80:83]
ds_read_b64_tr_b16 a[196:197], v194 offset:8192
v_and_b32 v9, 1, v0
v_mfma_f32_16x16x32_bf16 v[80:83], a[164:167], v[164:167], v[80:83]
buffer_load_dwordx4 a[48:51], v15, s[44:47], s65 offen offset:0 sc1
v_mfma_f32_16x16x32_bf16 v[48:51], a[164:167], v[156:159], v[48:51]
ds_read_b64_tr_b16 a[198:199], v194 offset:12288
v_lshlrev_b32 v9, 4, v9
v_mfma_f32_16x16x32_bf16 v[48:51], a[160:163], v[152:155], v[48:51]
v_mov_b32 v10, 0x3f80
v_lshlrev_b32 v9, v9, v10
v_mfma_f32_16x16x32_bf16 v[52:55], a[168:171], v[152:155], v[52:55]
v_lshrrev_b32 v10, 4, v0
v_lshlrev_b32 v10, 1, v10
v_mfma_f32_16x16x32_bf16 v[52:55], a[172:175], v[156:159], v[52:55]
buffer_load_dwordx4 a[56:59], v15, s[44:47], s65 offen offset:1024 sc1
v_mfma_f32_16x16x32_bf16 v[84:87], a[172:175], v[164:167], v[84:87]
ds_read_b64_tr_b16 a[200:201], v195 offset:0
v_bfe_u32 v11, v0, 1, 3
v_mfma_f32_16x16x32_bf16 v[84:87], a[168:171], v[160:163], v[84:87]
ds_read_b64_tr_b16 a[202:203], v195 offset:4096
v_xor_b32 v10, v10, v11
v_mfma_f32_16x16x32_bf16 v[116:119], a[168:171], v[168:171], v[116:119]
s_xor_b32 s65, s84, 106496
ds_read_b64_tr_b16 a[204:205], v195 offset:8192
v_subrev_u32 v11, 1, v10
v_mfma_f32_16x16x32_bf16 v[116:119], a[172:175], v[172:175], v[116:119]
buffer_load_dwordx4 a[36:39], v14, s[44:47], s65 offen offset:0 sc1
v_mfma_f32_16x16x32_bf16 v[148:151], a[172:175], v[180:183], v[148:151]
ds_read_b64_tr_b16 a[206:207], v195 offset:12288
v_ashrrev_i32 v11, 31, v11
v_mfma_f32_16x16x32_bf16 v[148:151], a[168:171], v[176:179], v[148:151]
v_and_b32 v234, v11, v9
v_xor_b32 v10, 1, v10
v_mfma_f32_16x16x32_bf16 v[120:123], a[176:179], v[176:179], v[120:123]
s_waitcnt lgkmcnt(4)
v_subrev_u32 v11, 1, v10
v_ashrrev_i32 v11, 31, v11
v_mfma_f32_16x16x32_bf16 v[120:123], a[180:183], v[180:183], v[120:123]
buffer_load_dwordx4 a[44:47], v14, s[44:47], s65 offen offset:1024 sc1
v_mfma_f32_16x16x32_bf16 v[88:91], a[180:183], v[172:175], v[88:91]
v_and_b32 v235, v11, v9
v_mfma_f32_16x16x32_bf16 v[88:91], a[176:179], v[168:171], v[88:91]
s_mov_b32 s48, s24
s_mov_b32 s49, s25
s_mov_b32 s50, 4194304
v_mfma_f32_16x16x32_bf16 v[56:59], a[176:179], v[160:163], v[56:59]
s_mov_b32 s51, 0x20000
v_mfma_f32_16x16x32_bf16 v[56:59], a[180:183], v[164:167], v[56:59]
buffer_load_dwordx4 a[52:55], v15, s[44:47], s65 offen offset:0 sc1
v_mfma_f32_16x16x32_bf16 v[24:27], a[180:183], v[156:159], v[24:27]
v_mfma_f32_16x16x32_bf16 v[24:27], a[176:179], v[152:155], v[24:27]
v_mfma_f32_16x16x32_bf16 v[28:31], a[184:187], v[152:155], v[28:31]
v_mfma_f32_16x16x32_bf16 v[28:31], a[188:191], v[156:159], v[28:31]
buffer_load_dwordx4 a[60:63], v15, s[44:47], s65 offen offset:1024 sc1
v_mfma_f32_16x16x32_bf16 v[60:63], a[188:191], v[164:167], v[60:63]
v_mfma_f32_16x16x32_bf16 v[60:63], a[184:187], v[160:163], v[60:63]
s_waitcnt vmcnt(24)
s_barrier
v_mfma_f32_16x16x32_bf16 v[92:95], a[184:187], v[168:171], v[92:95]
ds_read_b64_tr_b16 a[144:145], v196 offset:32768
v_mfma_f32_16x16x32_bf16 v[92:95], a[188:191], v[172:175], v[92:95]
ds_read_b64_tr_b16 a[146:147], v196 offset:36864
v_mfma_f32_16x16x32_bf16 v[124:127], a[188:191], v[180:183], v[124:127]
ds_read_b64_tr_b16 a[148:149], v196 offset:40960
v_mfma_f32_16x16x32_bf16 v[124:127], a[184:187], v[176:179], v[124:127]
ds_read_b64_tr_b16 a[150:151], v196 offset:45056
v_mfma_f32_16x16x32_bf16 v[128:131], a[192:195], v[176:179], v[128:131]
ds_read_b64_tr_b16 a[152:153], v197 offset:32768
v_mfma_f32_16x16x32_bf16 v[128:131], a[196:199], v[180:183], v[128:131]
ds_read_b64_tr_b16 a[154:155], v197 offset:36864
v_mfma_f32_16x16x32_bf16 v[96:99], a[196:199], v[172:175], v[96:99]
ds_read_b64_tr_b16 a[156:157], v197 offset:40960
v_mfma_f32_16x16x32_bf16 v[96:99], a[192:195], v[168:171], v[96:99]
ds_read_b64_tr_b16 a[158:159], v197 offset:45056
v_mfma_f32_16x16x32_bf16 v[64:67], a[192:195], v[160:163], v[64:67]
ds_read_b64_tr_b16 a[160:161], v198 offset:32768
v_mfma_f32_16x16x32_bf16 v[64:67], a[196:199], v[164:167], v[64:67]
ds_read_b64_tr_b16 a[162:163], v198 offset:36864
v_mfma_f32_16x16x32_bf16 v[32:35], a[196:199], v[156:159], v[32:35]
ds_read_b64_tr_b16 a[164:165], v198 offset:40960
v_mfma_f32_16x16x32_bf16 v[32:35], a[192:195], v[152:155], v[32:35]
s_waitcnt lgkmcnt(7)
ds_read_b64_tr_b16 a[166:167], v198 offset:45056
v_mfma_f32_16x16x32_bf16 v[36:39], a[200:203], v[152:155], v[36:39]
v_mfma_f32_16x16x32_bf16 v[36:39], a[204:207], v[156:159], v[36:39]
v_mfma_f32_16x16x32_bf16 v[68:71], a[204:207], v[164:167], v[68:71]
v_mfma_f32_16x16x32_bf16 v[68:71], a[200:203], v[160:163], v[68:71]
v_mfma_f32_16x16x32_bf16 v[100:103], a[200:203], v[168:171], v[100:103]
v_mfma_f32_16x16x32_bf16 v[100:103], a[204:207], v[172:175], v[100:103]
v_mfma_f32_16x16x32_bf16 v[132:135], a[204:207], v[180:183], v[132:135]
v_mfma_f32_16x16x32_bf16 v[132:135], a[200:203], v[176:179], v[132:135]
s_waitcnt vmcnt(20)
v_mfma_f32_16x16x32_bf16 v[136:139], a[144:147], a[24:27], v[136:139]
s_waitcnt vmcnt(16)
ds_read_b64_tr_b16 a[168:169], v199 offset:32768
v_mfma_f32_16x16x32_bf16 v[136:139], a[148:151], a[28:31], v[136:139]
ds_read_b64_tr_b16 a[170:171], v199 offset:36864
v_mfma_f32_16x16x32_bf16 v[104:107], a[148:151], a[20:23], v[104:107]
ds_read_b64_tr_b16 a[172:173], v199 offset:40960
v_mfma_f32_16x16x32_bf16 v[104:107], a[144:147], a[16:19], v[104:107]
ds_read_b64_tr_b16 a[174:175], v199 offset:45056
v_mfma_f32_16x16x32_bf16 v[72:75], a[144:147], a[8:11], v[72:75]
v_mfma_f32_16x16x32_bf16 v[72:75], a[148:151], a[12:15], v[72:75]
v_mfma_f32_16x16x32_bf16 v[40:43], a[148:151], a[4:7], v[40:43]
s_waitcnt vmcnt(8)
s_barrier
v_mfma_f32_16x16x32_bf16 v[40:43], a[144:147], a[0:3], v[40:43]
s_waitcnt lgkmcnt(4)
ds_read_b64_tr_b16 a[176:177], v188 offset:0
v_mfma_f32_16x16x32_bf16 v[44:47], a[152:155], a[0:3], v[44:47]
ds_read_b64_tr_b16 a[178:179], v188 offset:4096
v_mfma_f32_16x16x32_bf16 v[44:47], a[156:159], a[4:7], v[44:47]
ds_read_b64_tr_b16 a[180:181], v188 offset:8192
v_mfma_f32_16x16x32_bf16 v[76:79], a[156:159], a[12:15], v[76:79]
ds_read_b64_tr_b16 a[182:183], v188 offset:12288
v_mfma_f32_16x16x32_bf16 v[76:79], a[152:155], a[8:11], v[76:79]
ds_read_b64_tr_b16 a[184:185], v189 offset:0
v_mfma_f32_16x16x32_bf16 v[108:111], a[152:155], a[16:19], v[108:111]
ds_read_b64_tr_b16 a[186:187], v189 offset:4096
v_mfma_f32_16x16x32_bf16 v[108:111], a[156:159], a[20:23], v[108:111]
ds_read_b64_tr_b16 a[188:189], v189 offset:8192
v_mfma_f32_16x16x32_bf16 v[140:143], a[156:159], a[28:31], v[140:143]
ds_read_b64_tr_b16 a[190:191], v189 offset:12288
v_mfma_f32_16x16x32_bf16 v[140:143], a[152:155], a[24:27], v[140:143]
v_mfma_f32_16x16x32_bf16 v[144:147], a[160:163], a[24:27], v[144:147]
v_mfma_f32_16x16x32_bf16 v[144:147], a[164:167], a[28:31], v[144:147]
v_mfma_f32_16x16x32_bf16 v[112:115], a[164:167], a[20:23], v[112:115]
ds_read_b64_tr_b16 a[192:193], v190 offset:0
v_mfma_f32_16x16x32_bf16 v[112:115], a[160:163], a[16:19], v[112:115]
ds_read_b64_tr_b16 a[194:195], v190 offset:4096
v_mfma_f32_16x16x32_bf16 v[80:83], a[160:163], a[8:11], v[80:83]
ds_read_b64_tr_b16 a[196:197], v190 offset:8192
v_mfma_f32_16x16x32_bf16 v[80:83], a[164:167], a[12:15], v[80:83]
ds_read_b64_tr_b16 a[198:199], v190 offset:12288
v_mfma_f32_16x16x32_bf16 v[48:51], a[164:167], a[4:7], v[48:51]
v_mfma_f32_16x16x32_bf16 v[48:51], a[160:163], a[0:3], v[48:51]
s_waitcnt lgkmcnt(4)
v_mfma_f32_16x16x32_bf16 v[52:55], a[168:171], a[0:3], v[52:55]
v_mfma_f32_16x16x32_bf16 v[52:55], a[172:175], a[4:7], v[52:55]
v_mfma_f32_16x16x32_bf16 v[84:87], a[172:175], a[12:15], v[84:87]
ds_read_b64_tr_b16 a[200:201], v191 offset:0
v_mfma_f32_16x16x32_bf16 v[84:87], a[168:171], a[8:11], v[84:87]
ds_read_b64_tr_b16 a[202:203], v191 offset:4096
v_mfma_f32_16x16x32_bf16 v[116:119], a[168:171], a[16:19], v[116:119]
ds_read_b64_tr_b16 a[204:205], v191 offset:8192
v_mfma_f32_16x16x32_bf16 v[116:119], a[172:175], a[20:23], v[116:119]
ds_read_b64_tr_b16 a[206:207], v191 offset:12288
v_mfma_f32_16x16x32_bf16 v[148:151], a[172:175], a[28:31], v[148:151]
v_mfma_f32_16x16x32_bf16 v[148:151], a[168:171], a[24:27], v[148:151]
s_waitcnt vmcnt(4)
v_mfma_f32_16x16x32_bf16 v[136:139], a[176:179], a[56:59], v[136:139]
s_waitcnt vmcnt(0)
v_mfma_f32_16x16x32_bf16 v[136:139], a[180:183], a[60:63], v[136:139]
v_mfma_f32_16x16x32_bf16 v[104:107], a[180:183], a[52:55], v[104:107]
ds_read_b64_tr_b16 a[144:145], v192 offset:32768
v_mfma_f32_16x16x32_bf16 v[104:107], a[176:179], a[48:51], v[104:107]
ds_read_b64_tr_b16 a[146:147], v192 offset:36864
v_mfma_f32_16x16x32_bf16 v[72:75], a[176:179], a[40:43], v[72:75]
ds_read_b64_tr_b16 a[148:149], v192 offset:40960
v_mfma_f32_16x16x32_bf16 v[72:75], a[180:183], a[44:47], v[72:75]
ds_read_b64_tr_b16 a[150:151], v192 offset:45056
v_mfma_f32_16x16x32_bf16 v[40:43], a[180:183], a[36:39], v[40:43]
v_mfma_f32_16x16x32_bf16 v[40:43], a[176:179], a[32:35], v[40:43]
v_mfma_f32_16x16x32_bf16 v[44:47], a[184:187], a[32:35], v[44:47]
v_mfma_f32_16x16x32_bf16 v[44:47], a[188:191], a[36:39], v[44:47]
ds_write_b128 v3, v[136:139] offset:4096
v_mfma_f32_16x16x32_bf16 v[76:79], a[188:191], a[44:47], v[76:79]
ds_read_b64_tr_b16 a[152:153], v193 offset:32768
v_mfma_f32_16x16x32_bf16 v[76:79], a[184:187], a[40:43], v[76:79]
ds_write_b128 v3, v[104:107] offset:0
v_mfma_f32_16x16x32_bf16 v[108:111], a[184:187], a[48:51], v[108:111]
ds_read_b64_tr_b16 a[154:155], v193 offset:36864
v_mfma_f32_16x16x32_bf16 v[108:111], a[188:191], a[52:55], v[108:111]
ds_read_b64_tr_b16 a[156:157], v193 offset:40960
v_mfma_f32_16x16x32_bf16 v[140:143], a[188:191], a[60:63], v[140:143]
ds_read_b64_tr_b16 a[158:159], v193 offset:45056
v_mfma_f32_16x16x32_bf16 v[140:143], a[184:187], a[56:59], v[140:143]
s_waitcnt lgkmcnt(6)
v_mfma_f32_16x16x32_bf16 v[144:147], a[192:195], a[56:59], v[144:147]
v_mfma_f32_16x16x32_bf16 v[144:147], a[196:199], a[60:63], v[144:147]
v_mfma_f32_16x16x32_bf16 v[112:115], a[196:199], a[52:55], v[112:115]
ds_read_b64_tr_b16 a[160:161], v194 offset:32768
v_mfma_f32_16x16x32_bf16 v[112:115], a[192:195], a[48:51], v[112:115]
ds_read_b64_tr_b16 a[162:163], v194 offset:36864
v_mfma_f32_16x16x32_bf16 v[80:83], a[192:195], a[40:43], v[80:83]
ds_read_b64_tr_b16 a[164:165], v194 offset:40960
v_mfma_f32_16x16x32_bf16 v[80:83], a[196:199], a[44:47], v[80:83]
ds_write_b128 v3, v[108:111] offset:1024
v_mfma_f32_16x16x32_bf16 v[48:51], a[196:199], a[36:39], v[48:51]
ds_read_b64_tr_b16 a[166:167], v194 offset:45056
v_mfma_f32_16x16x32_bf16 v[48:51], a[192:195], a[32:35], v[48:51]
ds_write_b128 v3, v[140:143] offset:5120
v_mfma_f32_16x16x32_bf16 v[52:55], a[200:203], a[32:35], v[52:55]
v_mfma_f32_16x16x32_bf16 v[52:55], a[204:207], a[36:39], v[52:55]
ds_write_b128 v3, v[144:147] offset:6144
v_mfma_f32_16x16x32_bf16 v[84:87], a[204:207], a[44:47], v[84:87]
ds_read_b64_tr_b16 a[168:169], v195 offset:32768
v_mfma_f32_16x16x32_bf16 v[84:87], a[200:203], a[40:43], v[84:87]
ds_write_b128 v3, v[112:115] offset:2048
v_mfma_f32_16x16x32_bf16 v[116:119], a[200:203], a[48:51], v[116:119]
ds_read_b64_tr_b16 a[170:171], v195 offset:36864
v_mfma_f32_16x16x32_bf16 v[116:119], a[204:207], a[52:55], v[116:119]
ds_read_b64_tr_b16 a[172:173], v195 offset:40960
v_mfma_f32_16x16x32_bf16 v[148:151], a[204:207], a[60:63], v[148:151]
ds_read_b64_tr_b16 a[174:175], v195 offset:45056
v_mfma_f32_16x16x32_bf16 v[148:151], a[200:203], a[56:59], v[148:151]
v_mfma_f32_16x16x32_bf16 v[120:123], a[144:147], a[24:27], v[120:123]
v_mfma_f32_16x16x32_bf16 v[120:123], a[148:151], a[28:31], v[120:123]
v_mfma_f32_16x16x32_bf16 v[88:91], a[148:151], a[20:23], v[88:91]
ds_read_b64_tr_b16 a[176:177], v184 offset:0
v_mfma_f32_16x16x32_bf16 v[88:91], a[144:147], a[16:19], v[88:91]
ds_read_b64_tr_b16 a[178:179], v184 offset:4096
v_mfma_f32_16x16x32_bf16 v[56:59], a[144:147], a[8:11], v[56:59]
ds_read_b64_tr_b16 a[180:181], v184 offset:8192
v_mfma_f32_16x16x32_bf16 v[56:59], a[148:151], a[12:15], v[56:59]
ds_write_b128 v3, v[116:119] offset:3072
v_mfma_f32_16x16x32_bf16 v[24:27], a[148:151], a[4:7], v[24:27]
ds_read_b64_tr_b16 a[182:183], v184 offset:12288
v_mfma_f32_16x16x32_bf16 v[24:27], a[144:147], a[0:3], v[24:27]
s_waitcnt lgkmcnt(5)
ds_write_b128 v3, v[148:151] offset:7168
v_mfma_f32_16x16x32_bf16 v[28:31], a[152:155], a[0:3], v[28:31]
v_mfma_f32_16x16x32_bf16 v[28:31], a[156:159], a[4:7], v[28:31]
v_mfma_f32_16x16x32_bf16 v[60:63], a[156:159], a[12:15], v[60:63]
s_waitcnt lgkmcnt(0)
s_barrier
v_mfma_f32_16x16x32_bf16 v[60:63], a[152:155], a[8:11], v[60:63]
ds_read_b128 v[200:203], v2 offset:0
ds_read_b128 v[204:207], v2 offset:1024
v_mfma_f32_16x16x32_bf16 v[92:95], a[152:155], a[16:19], v[92:95]
ds_read_b128 v[208:211], v2 offset:2048
ds_read_b128 v[212:215], v2 offset:3072
v_mfma_f32_16x16x32_bf16 v[92:95], a[156:159], a[20:23], v[92:95]
ds_read_b128 v[216:219], v2 offset:4096
ds_read_b128 v[220:223], v2 offset:5120
v_mfma_f32_16x16x32_bf16 v[124:127], a[156:159], a[28:31], v[124:127]
ds_read_b128 v[224:227], v2 offset:6144
ds_read_b128 v[228:231], v2 offset:7168
v_mfma_f32_16x16x32_bf16 v[124:127], a[152:155], a[24:27], v[124:127]
ds_read_b64_tr_b16 a[184:185], v185 offset:0
v_mfma_f32_16x16x32_bf16 v[128:131], a[160:163], a[24:27], v[128:131]
ds_read_b64_tr_b16 a[186:187], v185 offset:4096
v_mfma_f32_16x16x32_bf16 v[128:131], a[164:167], a[28:31], v[128:131]
ds_read_b64_tr_b16 a[188:189], v185 offset:8192
v_mfma_f32_16x16x32_bf16 v[96:99], a[164:167], a[20:23], v[96:99]
s_waitcnt lgkmcnt(10)
ds_read_b64_tr_b16 a[190:191], v185 offset:12288
v_add_f32 v200, v200, v40
v_mfma_f32_16x16x32_bf16 v[96:99], a[160:163], a[16:19], v[96:99]
ds_read_b64_tr_b16 a[192:193], v186 offset:0
v_add_f32 v201, v201, v41
v_mfma_f32_16x16x32_bf16 v[64:67], a[160:163], a[8:11], v[64:67]
ds_read_b64_tr_b16 a[194:195], v186 offset:4096
v_add_f32 v202, v202, v42
v_mfma_f32_16x16x32_bf16 v[64:67], a[164:167], a[12:15], v[64:67]
ds_read_b64_tr_b16 a[196:197], v186 offset:8192
v_add_f32 v203, v203, v43
v_mfma_f32_16x16x32_bf16 v[32:35], a[164:167], a[4:7], v[32:35]
s_waitcnt lgkmcnt(7)
ds_read_b64_tr_b16 a[198:199], v186 offset:12288
v_add_f32 v204, v204, v44
v_mfma_f32_16x16x32_bf16 v[32:35], a[160:163], a[0:3], v[32:35]
v_add_f32 v205, v205, v45
v_add_f32 v206, v206, v46
v_mfma_f32_16x16x32_bf16 v[36:39], a[168:171], a[0:3], v[36:39]
v_add_f32 v207, v207, v47
v_cvt_pk_bf16_f32 v200, v200, v201
v_mfma_f32_16x16x32_bf16 v[36:39], a[172:175], a[4:7], v[36:39]
v_cvt_pk_bf16_f32 v201, v202, v203
v_cvt_pk_bf16_f32 v202, v204, v205
v_cvt_pk_bf16_f32 v203, v206, v207
v_mfma_f32_16x16x32_bf16 v[68:71], a[172:175], a[12:15], v[68:71]
buffer_store_dwordx4 v[200:203], v16, s[44:47], s73 offen offset:0 sc1
v_mfma_f32_16x16x32_bf16 v[68:71], a[168:171], a[8:11], v[68:71]
ds_read_b64_tr_b16 a[200:201], v187 offset:0
v_add_f32 v208, v208, v48
v_mfma_f32_16x16x32_bf16 v[100:103], a[168:171], a[16:19], v[100:103]
ds_read_b64_tr_b16 a[202:203], v187 offset:4096
v_add_f32 v209, v209, v49
v_mfma_f32_16x16x32_bf16 v[100:103], a[172:175], a[20:23], v[100:103]
ds_read_b64_tr_b16 a[204:205], v187 offset:8192
v_add_f32 v210, v210, v50
v_mfma_f32_16x16x32_bf16 v[132:135], a[172:175], a[28:31], v[132:135]
ds_read_b64_tr_b16 a[206:207], v187 offset:12288
v_add_f32 v211, v211, v51
v_mfma_f32_16x16x32_bf16 v[132:135], a[168:171], a[24:27], v[132:135]
v_add_f32 v212, v212, v52
v_add_f32 v213, v213, v53
v_mfma_f32_16x16x32_bf16 v[120:123], a[176:179], a[56:59], v[120:123]
v_add_f32 v214, v214, v54
v_add_f32 v215, v215, v55
v_mfma_f32_16x16x32_bf16 v[120:123], a[180:183], a[60:63], v[120:123]
v_cvt_pk_bf16_f32 v208, v208, v209
v_cvt_pk_bf16_f32 v209, v210, v211
v_cvt_pk_bf16_f32 v210, v212, v213
v_cvt_pk_bf16_f32 v211, v214, v215
v_mfma_f32_16x16x32_bf16 v[88:91], a[180:183], a[52:55], v[88:91]
buffer_store_dwordx4 v[208:211], v16, s[44:47], s73 offen offset:1024 sc1
v_mfma_f32_16x16x32_bf16 v[88:91], a[176:179], a[48:51], v[88:91]
v_add_f32 v216, v216, v72
v_add_f32 v217, v217, v73
v_mfma_f32_16x16x32_bf16 v[56:59], a[176:179], a[40:43], v[56:59]
v_add_f32 v218, v218, v74
v_add_f32 v219, v219, v75
v_mfma_f32_16x16x32_bf16 v[56:59], a[180:183], a[44:47], v[56:59]
s_branch L_po23
L_pg23:
s_branch L_tr2
L_po23:
v_add_f32 v220, v220, v76
v_add_f32 v221, v221, v77
v_mfma_f32_16x16x32_bf16 v[24:27], a[180:183], a[36:39], v[24:27]
v_add_f32 v222, v222, v78
v_add_f32 v223, v223, v79
v_mfma_f32_16x16x32_bf16 v[24:27], a[176:179], a[32:35], v[24:27]
s_waitcnt lgkmcnt(0)
v_cvt_pk_bf16_f32 v216, v216, v217
v_cvt_pk_bf16_f32 v217, v218, v219
v_mfma_f32_16x16x32_bf16 v[28:31], a[184:187], a[32:35], v[28:31]
v_cvt_pk_bf16_f32 v218, v220, v221
v_cvt_pk_bf16_f32 v219, v222, v223
v_mfma_f32_16x16x32_bf16 v[28:31], a[188:191], a[36:39], v[28:31]
buffer_store_dwordx4 v[216:219], v16, s[44:47], s73 offen offset:2048 sc1
v_mfma_f32_16x16x32_bf16 v[60:63], a[188:191], a[44:47], v[60:63]
v_add_f32 v224, v224, v80
v_add_f32 v225, v225, v81
v_mfma_f32_16x16x32_bf16 v[60:63], a[184:187], a[40:43], v[60:63]
v_add_f32 v226, v226, v82
v_add_f32 v227, v227, v83
v_mfma_f32_16x16x32_bf16 v[92:95], a[184:187], a[48:51], v[92:95]
v_add_f32 v228, v228, v84
v_add_f32 v229, v229, v85
v_mfma_f32_16x16x32_bf16 v[92:95], a[188:191], a[52:55], v[92:95]
v_add_f32 v230, v230, v86
v_add_f32 v231, v231, v87
v_mfma_f32_16x16x32_bf16 v[124:127], a[188:191], a[60:63], v[124:127]
v_cvt_pk_bf16_f32 v224, v224, v225
v_cvt_pk_bf16_f32 v225, v226, v227
v_mfma_f32_16x16x32_bf16 v[124:127], a[184:187], a[56:59], v[124:127]
v_cvt_pk_bf16_f32 v226, v228, v229
v_cvt_pk_bf16_f32 v227, v230, v231
v_mfma_f32_16x16x32_bf16 v[128:131], a[192:195], a[56:59], v[128:131]
buffer_store_dwordx4 v[224:227], v16, s[44:47], s73 offen offset:3072 sc1
v_mfma_f32_16x16x32_bf16 v[128:131], a[196:199], a[60:63], v[128:131]
ds_write_b128 v3, v[120:123] offset:36864
v_mfma_f32_16x16x32_bf16 v[96:99], a[196:199], a[52:55], v[96:99]
ds_write_b128 v3, v[88:91] offset:32768
v_mfma_f32_16x16x32_bf16 v[96:99], a[192:195], a[48:51], v[96:99]
v_mfma_f32_16x16x32_bf16 v[64:67], a[192:195], a[40:43], v[64:67]
v_mfma_f32_16x16x32_bf16 v[64:67], a[196:199], a[44:47], v[64:67]
ds_write_b128 v3, v[92:95] offset:33792
v_mfma_f32_16x16x32_bf16 v[32:35], a[196:199], a[36:39], v[32:35]
v_mfma_f32_16x16x32_bf16 v[32:35], a[192:195], a[32:35], v[32:35]
ds_write_b128 v3, v[124:127] offset:37888
v_mfma_f32_16x16x32_bf16 v[36:39], a[200:203], a[32:35], v[36:39]
v_mfma_f32_16x16x32_bf16 v[36:39], a[204:207], a[36:39], v[36:39]
ds_write_b128 v3, v[128:131] offset:38912
v_mfma_f32_16x16x32_bf16 v[68:71], a[204:207], a[44:47], v[68:71]
v_mfma_f32_16x16x32_bf16 v[68:71], a[200:203], a[40:43], v[68:71]
ds_write_b128 v3, v[96:99] offset:34816
v_mfma_f32_16x16x32_bf16 v[100:103], a[200:203], a[48:51], v[100:103]
v_mfma_f32_16x16x32_bf16 v[100:103], a[204:207], a[52:55], v[100:103]
v_mfma_f32_16x16x32_bf16 v[132:135], a[204:207], a[60:63], v[132:135]
v_mfma_f32_16x16x32_bf16 v[132:135], a[200:203], a[56:59], v[132:135]
buffer_load_dwordx4 v[152:155], v16, s[44:47], s75 offen offset:0 sc1
buffer_load_dwordx4 v[156:159], v16, s[44:47], s75 offen offset:1024 sc1
buffer_load_dwordx4 v[160:163], v16, s[44:47], s75 offen offset:2048 sc1
buffer_load_dwordx4 v[164:167], v16, s[44:47], s75 offen offset:3072 sc1
s_nop 3
ds_write_b128 v3, v[100:103] offset:35840
ds_write_b128 v3, v[132:135] offset:39936
s_mov_b32 s72, 0x20000
s_waitcnt lgkmcnt(0)
s_barrier
ds_read_b128 v[88:91], v2 offset:32768
ds_read_b128 v[92:95], v2 offset:33792
ds_read_b128 v[96:99], v2 offset:34816
ds_read_b128 v[100:103], v2 offset:35840
ds_read_b128 v[120:123], v2 offset:36864
ds_read_b128 v[124:127], v2 offset:37888
ds_read_b128 v[128:131], v2 offset:38912
ds_read_b128 v[132:135], v2 offset:39936
s_waitcnt lgkmcnt(7)
v_add_f32 v24, v24, v88
v_add_f32 v25, v25, v89
v_add_f32 v26, v26, v90
v_add_f32 v27, v27, v91
s_waitcnt lgkmcnt(6)
v_add_f32 v28, v28, v92
v_add_f32 v29, v29, v93
v_add_f32 v30, v30, v94
v_add_f32 v31, v31, v95
s_waitcnt lgkmcnt(5)
v_add_f32 v32, v32, v96
v_add_f32 v33, v33, v97
v_add_f32 v34, v34, v98
v_add_f32 v35, v35, v99
s_waitcnt lgkmcnt(4)
v_add_f32 v36, v36, v100
v_add_f32 v37, v37, v101
v_add_f32 v38, v38, v102
v_add_f32 v39, v39, v103
s_waitcnt lgkmcnt(3)
v_add_f32 v56, v56, v120
v_add_f32 v57, v57, v121
v_add_f32 v58, v58, v122
v_add_f32 v59, v59, v123
s_waitcnt lgkmcnt(2)
v_add_f32 v60, v60, v124
v_add_f32 v61, v61, v125
v_add_f32 v62, v62, v126
v_add_f32 v63, v63, v127
s_waitcnt lgkmcnt(1)
v_add_f32 v64, v64, v128
v_add_f32 v65, v65, v129
v_add_f32 v66, v66, v130
v_add_f32 v67, v67, v131
s_waitcnt lgkmcnt(0)
v_add_f32 v68, v68, v132
v_add_f32 v69, v69, v133
v_add_f32 v70, v70, v134
v_add_f32 v71, v71, v135
L_xchk:
s_waitcnt vmcnt(0)
v_max3_u32 v9, v152, v153, v154
v_max3_u32 v9, v9, v155, v156
v_max3_u32 v9, v9, v157, v158
v_max3_u32 v9, v9, v159, v160
v_max3_u32 v9, v9, v161, v162
v_max3_u32 v9, v9, v163, v164
v_max3_u32 v9, v9, v165, v166
v_max_u32 v9, v9, v167
v_cmp_eq_u32 vcc, -1, v9
s_cbranch_vccnz L_xretry
L_xgo:
v_mfma_f32_16x16x32_bf16 v[24:27], v[234:237], v[152:155], v[24:27]
v_mfma_f32_16x16x32_bf16 v[28:31], v[232:235], v[152:155], v[28:31]
v_mfma_f32_16x16x32_bf16 v[32:35], v[234:237], v[156:159], v[32:35]
v_mfma_f32_16x16x32_bf16 v[36:39], v[232:235], v[156:159], v[36:39]
v_mfma_f32_16x16x32_bf16 v[56:59], v[234:237], v[160:163], v[56:59]
v_mfma_f32_16x16x32_bf16 v[60:63], v[232:235], v[160:163], v[60:63]
v_mfma_f32_16x16x32_bf16 v[64:67], v[234:237], v[164:167], v[64:67]
v_mfma_f32_16x16x32_bf16 v[68:71], v[232:235], v[164:167], v[68:71]
s_nop 1
v_cvt_pk_bf16_f32 v24, v24, v25
v_cvt_pk_bf16_f32 v25, v26, v27
v_cvt_pk_bf16_f32 v26, v28, v29
v_cvt_pk_bf16_f32 v27, v30, v31
v_cvt_pk_bf16_f32 v32, v32, v33
v_cvt_pk_bf16_f32 v33, v34, v35
v_cvt_pk_bf16_f32 v34, v36, v37
v_cvt_pk_bf16_f32 v35, v38, v39
v_permlane16_swap_b32 v24, v26
v_permlane16_swap_b32 v25, v27
v_permlane16_swap_b32 v32, v34
v_permlane16_swap_b32 v33, v35
v_mov_b32 v28, v24
v_mov_b32 v29, v25
v_mov_b32 v30, v26
v_mov_b32 v31, v27
v_mov_b32_dpp v24, v32 row_ror:8 row_mask:0xf bank_mask:0xc
v_mov_b32_dpp v25, v33 row_ror:8 row_mask:0xf bank_mask:0xc
v_mov_b32_dpp v26, v34 row_ror:8 row_mask:0xf bank_mask:0xc
v_mov_b32_dpp v27, v35 row_ror:8 row_mask:0xf bank_mask:0xc
v_mov_b32_dpp v32, v28 row_ror:8 row_mask:0xf bank_mask:0x3
v_mov_b32_dpp v33, v29 row_ror:8 row_mask:0xf bank_mask:0x3
v_mov_b32_dpp v34, v30 row_ror:8 row_mask:0xf bank_mask:0x3
v_mov_b32_dpp v35, v31 row_ror:8 row_mask:0xf bank_mask:0x3
buffer_store_dwordx4 v[24:27], v8, s[48:51], s77 offen sc1
s_add_u32 s77, s77, 16384
buffer_store_dwordx4 v[32:35], v8, s[48:51], s77 offen sc1
s_add_u32 s77, s77, 16384
v_cvt_pk_bf16_f32 v56, v56, v57
v_cvt_pk_bf16_f32 v57, v58, v59
v_cvt_pk_bf16_f32 v58, v60, v61
v_cvt_pk_bf16_f32 v59, v62, v63
v_cvt_pk_bf16_f32 v64, v64, v65
v_cvt_pk_bf16_f32 v65, v66, v67
v_cvt_pk_bf16_f32 v66, v68, v69
v_cvt_pk_bf16_f32 v67, v70, v71
v_permlane16_swap_b32 v56, v58
v_permlane16_swap_b32 v57, v59
v_permlane16_swap_b32 v64, v66
v_permlane16_swap_b32 v65, v67
v_mov_b32 v60, v56
v_mov_b32 v61, v57
v_mov_b32 v62, v58
v_mov_b32 v63, v59
v_mov_b32_dpp v56, v64 row_ror:8 row_mask:0xf bank_mask:0xc
v_mov_b32_dpp v57, v65 row_ror:8 row_mask:0xf bank_mask:0xc
v_mov_b32_dpp v58, v66 row_ror:8 row_mask:0xf bank_mask:0xc
v_mov_b32_dpp v59, v67 row_ror:8 row_mask:0xf bank_mask:0xc
v_mov_b32_dpp v64, v60 row_ror:8 row_mask:0xf bank_mask:0x3
v_mov_b32_dpp v65, v61 row_ror:8 row_mask:0xf bank_mask:0x3
v_mov_b32_dpp v66, v62 row_ror:8 row_mask:0xf bank_mask:0x3
v_mov_b32_dpp v67, v63 row_ror:8 row_mask:0xf bank_mask:0x3
buffer_store_dwordx4 v[56:59], v8, s[48:51], s77 offen sc1
s_add_u32 s77, s77, 16384
buffer_store_dwordx4 v[64:67], v8, s[48:51], s77 offen sc1
s_add_u32 s77, s77, 16384
L_end:
s_endpgm
L_xretry:
s_sub_u32 s72, s72, 1
s_cbranch_scc1 L_xgo
buffer_load_dwordx4 v[152:155], v16, s[44:47], s75 offen offset:0 sc1
buffer_load_dwordx4 v[156:159], v16, s[44:47], s75 offen offset:1024 sc1
buffer_load_dwordx4 v[160:163], v16, s[44:47], s75 offen offset:2048 sc1
buffer_load_dwordx4 v[164:167], v16, s[44:47], s75 offen offset:3072 sc1
s_branch L_xchk
L_spin_1:
s_mov_b32 vcc_hi, 0x80000
L_spinlp_3:
s_sleep 1
buffer_load_dword v1, off, s[52:55], s78 offset:0 sc1
s_waitcnt vmcnt(0)
v_readfirstlane_b32 vcc_lo, v1
s_sub_u32 vcc_hi, vcc_hi, 1
s_cbranch_scc1 L_spinbk_2
s_cmp_lt_u32 vcc_lo, s81
s_cbranch_scc1 L_spinlp_3
s_branch L_spinbk_2
L_spin_4:
s_mov_b32 vcc_hi, 0x80000
L_spinlp_6:
s_sleep 1
buffer_load_dword v1, off, s[52:55], s70 offset:0 sc1
s_waitcnt vmcnt(0)
v_readfirstlane_b32 vcc_lo, v1
s_sub_u32 vcc_hi, vcc_hi, 1
s_cbranch_scc1 L_spinbk_5
s_cmp_lt_u32 vcc_lo, s81
s_cbranch_scc1 L_spinlp_6
s_branch L_spinbk_5
L_hretry:
s_sub_u32 s72, s72, 1
s_cbranch_scc1 L_hgo
buffer_load_dwordx4 v[136:139], v16, s[44:47], s77 offen sc1
s_waitcnt vmcnt(0)
v_max3_u32 v1, v136, v137, v138
v_max_u32 v1, v1, v139
v_cmp_eq_u32 vcc, -1, v1
s_cbranch_vccnz L_hretry
s_branch L_hgo
L_spin_8:
s_mov_b32 vcc_hi, 0x80000
L_spinlp_10:
s_sleep 1
buffer_load_dword v19, off, s[52:55], s80 offset:0 sc1
s_waitcnt vmcnt(0)
v_readfirstlane_b32 vcc_lo, v19
s_sub_u32 vcc_hi, vcc_hi, 1
s_cbranch_scc1 L_spinbk_9
s_cmp_lt_u32 vcc_lo, s69
s_cbranch_scc1 L_spinlp_10
s_branch L_spinbk_9
L_spin_1012:
s_mov_b32 vcc_hi, 0x80000
L_spinlp_1014:
s_sleep 1
buffer_load_dword v19, off, s[52:55], s80 offset:0 sc1
s_waitcnt vmcnt(0)
v_readfirstlane_b32 vcc_lo, v19
s_sub_u32 vcc_hi, vcc_hi, 1
s_cbranch_scc1 L_spinbk_1013
s_cmp_lt_u32 vcc_lo, s69
s_cbranch_scc1 L_spinlp_1014
s_branch L_spinbk_1013
L_F1:
s_waitcnt lgkmcnt(7)
v_mfma_f32_16x16x32_bf16 v[104:107], a[144:147], v[40:43], 0
s_waitcnt lgkmcnt(6)
ds_read_b128 a[176:179], v2 offset:8192
v_cndmask_b32 v88, 0, v17, s[0:1]
v_mfma_f32_16x16x32_bf16 v[104:107], a[148:151], v[44:47], v[104:107]
s_waitcnt lgkmcnt(6)
ds_read_b128 a[180:183], v2 offset:9216
v_cndmask_b32 v89, 0, v17, s[4:5]
v_mfma_f32_16x16x32_bf16 v[104:107], a[152:155], v[48:51], v[104:107]
s_waitcnt lgkmcnt(6)
buffer_load_dwordx4 v16, s[32:35], s70 offen offset:2048 sc1 lds
v_mfma_f32_16x16x32_bf16 v[104:107], a[156:159], v[52:55], v[104:107]
ds_read_b128 a[184:187], v2 offset:10240
v_cndmask_b32 v90, 0, v17, s[6:7]
v_mfma_f32_16x16x32_bf16 v[120:123], a[156:159], v[68:71], 0
ds_read_b128 a[188:191], v2 offset:11264
v_cndmask_b32 v91, 0, v17, s[8:9]
v_mfma_f32_16x16x32_bf16 v[120:123], a[152:155], v[64:67], v[120:123]
ds_read_b128 a[192:195], v2 offset:12288
v_accvgpr_write_b32 a128, 0
v_mfma_f32_16x16x32_bf16 v[120:123], a[148:151], v[60:63], v[120:123]
ds_read_b128 a[196:199], v2 offset:13312
v_accvgpr_write_b32 a129, 0
v_mfma_f32_16x16x32_bf16 v[120:123], a[144:147], v[56:59], v[120:123]
ds_read_b128 a[200:203], v2 offset:14336
v_accvgpr_write_b32 a130, 0
v_mfma_f32_16x16x32_bf16 v[136:139], a[144:147], v[72:75], 0
ds_read_b128 a[204:207], v2 offset:15360
v_accvgpr_write_b32 a131, 0
v_mfma_f32_16x16x32_bf16 v[136:139], a[148:151], v[76:79], v[136:139]
buffer_load_dwordx4 v16, s[32:35], s70 offen offset:3072 sc1 lds
v_mfma_f32_16x16x32_bf16 v[136:139], a[152:155], v[80:83], v[136:139]
v_accvgpr_write_b32 a132, 0
v_accvgpr_write_b32 a133, 0
v_mfma_f32_16x16x32_bf16 v[136:139], a[156:159], v[84:87], v[136:139]
v_accvgpr_write_b32 a134, 0
v_accvgpr_write_b32 a135, 0
v_mfma_f32_16x16x32_bf16 v[88:91], a[156:159], v[36:39], v[88:91]
v_accvgpr_write_b32 a136, 0
v_accvgpr_write_b32 a137, 0
v_mfma_f32_16x16x32_bf16 v[88:91], a[152:155], v[32:35], v[88:91]
v_accvgpr_write_b32 a138, 0
v_accvgpr_write_b32 a139, 0
v_mfma_f32_16x16x32_bf16 v[88:91], a[148:151], v[28:31], v[88:91]
v_accvgpr_write_b32 a140, 0
v_accvgpr_write_b32 a141, 0
v_mfma_f32_16x16x32_bf16 v[88:91], a[144:147], v[24:27], v[88:91]
s_waitcnt lgkmcnt(0)
s_nop 1
v_max3_f32 v21, v104, v105, v106
v_max_f32 v21, v21, v107
v_max3_f32 v22, v120, v121, v122
v_max_f32 v22, v22, v123
v_max3_f32 v23, v136, v137, v138
v_max_f32 v23, v23, v139
v_max3_f32 v20, v88, v89, v90
v_max_f32 v20, v20, v91
v_mov_b32 v248, v20
v_mov_b32 v249, v21
v_mov_b32 v250, v22
v_mov_b32 v251, v23
v_permlane16_swap_b32 v248, v20
v_permlane16_swap_b32 v249, v21
v_permlane16_swap_b32 v250, v22
v_permlane16_swap_b32 v251, v23
v_max_f32 v20, v20, v248
v_max_f32 v21, v21, v249
v_max_f32 v22, v22, v250
v_max_f32 v23, v23, v251
v_mov_b32 v248, v20
v_mov_b32 v249, v21
v_mov_b32 v250, v22
v_mov_b32 v251, v23
v_permlane32_swap_b32 v248, v20
v_permlane32_swap_b32 v249, v21
v_permlane32_swap_b32 v250, v22
v_permlane32_swap_b32 v251, v23
v_max_f32 v20, v20, v248
v_max_f32 v21, v21, v249
v_max_f32 v22, v22, v250
v_max_f32 v23, v23, v251
s_cmp_eq_u32 s73, 0
s_cselect_b64 vcc, 0, -1
v_cndmask_b32 v20, v20, v252, vcc
v_cndmask_b32 v21, v21, v253, vcc
v_cndmask_b32 v22, v22, v254, vcc
v_cndmask_b32 v23, v23, v255, vcc
v_sub_f32 v228, 0, v23
v_sub_f32 v229, 0, v23
v_sub_f32 v230, 0, v23
v_sub_f32 v231, 0, v23
v_sub_f32 v224, 0, v22
v_sub_f32 v225, 0, v22
v_sub_f32 v226, 0, v22
v_sub_f32 v227, 0, v22
v_sub_f32 v220, 0, v21
v_sub_f32 v221, 0, v21
v_sub_f32 v222, 0, v21
v_sub_f32 v223, 0, v21
v_sub_f32 v216, 0, v20
v_sub_f32 v217, 0, v20
v_sub_f32 v218, 0, v20
v_sub_f32 v219, 0, v20
v_mfma_f32_16x16x32_bf16 v[140:143], a[160:163], v[72:75], v[228:231]
s_add_u32 m0, s71, 4096
v_add_f32 v104, v104, v220
v_add_f32 v105, v105, v220
v_mfma_f32_16x16x32_bf16 v[140:143], a[164:167], v[76:79], v[140:143]
v_add_f32 v106, v106, v220
v_add_f32 v107, v107, v220
v_exp_f32 v104, v104
v_mfma_f32_16x16x32_bf16 v[140:143], a[168:171], v[80:83], v[140:143]
s_add_u32 s64, s70, 4096
v_exp_f32 v105, v105
v_mfma_f32_16x16x32_bf16 v[140:143], a[172:175], v[84:87], v[140:143]
buffer_load_dwordx4 v16, s[32:35], s64 offen offset:0 sc1 lds
v_mfma_f32_16x16x32_bf16 v[124:127], a[172:175], v[68:71], v[224:227]
v_exp_f32 v106, v106
v_mfma_f32_16x16x32_bf16 v[124:127], a[168:171], v[64:67], v[124:127]
v_exp_f32 v107, v107
v_mfma_f32_16x16x32_bf16 v[124:127], a[164:167], v[60:63], v[124:127]
v_add_f32 v120, v120, v224
v_add_f32 v121, v121, v224
v_add_f32 v122, v122, v224
v_add_f32 v123, v123, v224
v_exp_f32 v120, v120
v_mfma_f32_16x16x32_bf16 v[124:127], a[160:163], v[56:59], v[124:127]
v_exp_f32 v121, v121
v_mfma_f32_16x16x32_bf16 v[108:111], a[160:163], v[40:43], v[220:223]
v_exp_f32 v122, v122
v_mfma_f32_16x16x32_bf16 v[108:111], a[164:167], v[44:47], v[108:111]
v_cndmask_b32 v92, v216, v17, s[10:11]
v_cndmask_b32 v93, v216, v17, s[12:13]
v_cndmask_b32 v94, v216, v17, s[18:19]
v_cndmask_b32 v95, v216, v17, s[22:23]
v_mfma_f32_16x16x32_bf16 v[108:111], a[168:171], v[48:51], v[108:111]
buffer_load_dwordx4 v16, s[32:35], s64 offen offset:1024 sc1 lds
v_cvt_pk_bf16_f32 v160, v104, v105
v_mfma_f32_16x16x32_bf16 v[108:111], a[172:175], v[52:55], v[108:111]
v_exp_f32 v123, v123
v_mfma_f32_16x16x32_bf16 v[92:95], a[172:175], v[36:39], v[92:95]
v_add_f32 v136, v136, v228
v_add_f32 v137, v137, v228
v_add_f32 v138, v138, v228
v_add_f32 v139, v139, v228
v_exp_f32 v136, v136
v_mfma_f32_16x16x32_bf16 v[92:95], a[168:171], v[32:35], v[92:95]
v_cvt_pk_bf16_f32 v161, v106, v107
v_exp_f32 v137, v137
v_cndmask_b32 v96, v216, v17, s[26:27]
v_cndmask_b32 v97, v216, v17, s[56:57]
v_cndmask_b32 v98, v216, v17, s[58:59]
v_cndmask_b32 v99, v216, v17, s[60:61]
v_mfma_f32_16x16x32_bf16 v[92:95], a[164:167], v[28:31], v[92:95]
v_exp_f32 v138, v138
v_mfma_f32_16x16x32_bf16 v[92:95], a[160:163], v[24:27], v[92:95]
v_exp_f32 v139, v139
v_mfma_f32_16x16x32_bf16 v[96:99], a[176:179], v[24:27], v[96:99]
v_cvt_pk_bf16_f32 v184, v120, v121
v_add_f32 v88, v88, v216
v_mfma_f32_16x16x32_bf16 v[96:99], a[180:183], v[28:31], v[96:99]
buffer_load_dwordx4 v16, s[32:35], s64 offen offset:2048 sc1 lds
v_add_f32 v89, v89, v216
v_add_f32 v90, v90, v216
v_add_f32 v91, v91, v216
v_exp_f32 v88, v88
v_mfma_f32_16x16x32_bf16 v[96:99], a[184:187], v[32:35], v[96:99]
v_exp_f32 v89, v89
v_mfma_f32_16x16x32_bf16 v[96:99], a[188:191], v[36:39], v[96:99]
v_cvt_pk_bf16_f32 v185, v122, v123
v_cvt_pk_bf16_f32 v192, v136, v137
v_mfma_f32_16x16x32_bf16 v[112:115], a[188:191], v[52:55], v[220:223]
v_exp_f32 v90, v90
v_mfma_f32_16x16x32_bf16 v[112:115], a[184:187], v[48:51], v[112:115]
v_exp_f32 v91, v91
v_mfma_f32_16x16x32_bf16 v[112:115], a[180:183], v[44:47], v[112:115]
v_exp_f32 v140, v140
v_mfma_f32_16x16x32_bf16 v[112:115], a[176:179], v[40:43], v[112:115]
v_exp_f32 v141, v141
v_mfma_f32_16x16x32_bf16 v[128:131], a[176:179], v[56:59], v[224:227]
buffer_load_dwordx4 v16, s[32:35], s64 offen offset:3072 sc1 lds
v_cvt_pk_bf16_f32 v193, v138, v139
v_mfma_f32_16x16x32_bf16 v[128:131], a[180:183], v[60:63], v[128:131]
v_exp_f32 v142, v142
v_mfma_f32_16x16x32_bf16 v[128:131], a[184:187], v[64:67], v[128:131]
v_exp_f32 v143, v143
v_mfma_f32_16x16x32_bf16 v[128:131], a[188:191], v[68:71], v[128:131]
v_cvt_pk_bf16_f32 v152, v88, v89
v_cvt_pk_bf16_f32 v153, v90, v91
v_mfma_f32_16x16x32_bf16 v[144:147], a[188:191], v[84:87], v[228:231]
v_exp_f32 v124, v124
v_mfma_f32_16x16x32_bf16 v[144:147], a[184:187], v[80:83], v[144:147]
v_exp_f32 v125, v125
v_mfma_f32_16x16x32_bf16 v[144:147], a[180:183], v[76:79], v[144:147]
s_waitcnt vmcnt(6)
s_barrier
v_mfma_f32_16x16x32_bf16 v[144:147], a[176:179], v[72:75], v[144:147]
v_exp_f32 v126, v126
v_mfma_f32_16x16x32_bf16 v[148:151], a[192:195], v[72:75], v[228:231]
v_cvt_pk_bf16_f32 v194, v140, v141
v_cvt_pk_bf16_f32 v195, v142, v143
v_mfma_f32_16x16x32_bf16 v[148:151], a[196:199], v[76:79], v[148:151]
v_exp_f32 v127, v127
v_mfma_f32_16x16x32_bf16 v[148:151], a[200:203], v[80:83], v[148:151]
s_xor_b32 s71, s71, 16384
v_exp_f32 v108, v108
v_mfma_f32_16x16x32_bf16 v[148:151], a[204:207], v[84:87], v[148:151]
s_add_u32 s70, s70, 32768
v_exp_f32 v109, v109
v_mfma_f32_16x16x32_bf16 v[132:135], a[204:207], v[68:71], v[224:227]
s_mov_b32 m0, s71
v_exp_f32 v110, v110
v_mfma_f32_16x16x32_bf16 v[132:135], a[200:203], v[64:67], v[132:135]
buffer_load_dwordx4 v16, s[32:35], s70 offen offset:0 sc1 lds
v_mfma_f32_16x16x32_bf16 v[132:135], a[196:199], v[60:63], v[132:135]
v_cvt_pk_bf16_f32 v186, v124, v125
v_exp_f32 v111, v111
v_mfma_f32_16x16x32_bf16 v[132:135], a[192:195], v[56:59], v[132:135]
v_exp_f32 v92, v92
v_mfma_f32_16x16x32_bf16 v[116:119], a[192:195], v[40:43], v[220:223]
ds_read_b128 a[144:147], v2 offset:16384
v_cndmask_b32 v100, v216, v17, s[62:63]
v_mfma_f32_16x16x32_bf16 v[116:119], a[196:199], v[44:47], v[116:119]
ds_read_b128 a[148:151], v2 offset:17408
v_cndmask_b32 v101, v216, v17, s[48:49]
v_cndmask_b32 v102, v216, v17, s[50:51]
v_cndmask_b32 v103, v216, v17, s[100:101]
v_cvt_pk_bf16_f32 v187, v126, v127
v_exp_f32 v93, v93
v_mfma_f32_16x16x32_bf16 v[116:119], a[200:203], v[48:51], v[116:119]
v_exp_f32 v94, v94
v_mfma_f32_16x16x32_bf16 v[116:119], a[204:207], v[52:55], v[116:119]
ds_read_b128 a[152:155], v2 offset:18432
v_cvt_pk_bf16_f32 v162, v108, v109
v_mfma_f32_16x16x32_bf16 v[100:103], a[204:207], v[36:39], v[100:103]
buffer_load_dwordx4 v16, s[32:35], s70 offen offset:1024 sc1 lds
v_exp_f32 v95, v95
v_mfma_f32_16x16x32_bf16 v[100:103], a[200:203], v[32:35], v[100:103]
ds_read_b128 a[156:159], v2 offset:19456
v_exp_f32 v96, v96
v_mfma_f32_16x16x32_bf16 v[100:103], a[196:199], v[28:31], v[100:103]
v_cvt_pk_bf16_f32 v163, v110, v111
v_exp_f32 v97, v97
v_mfma_f32_16x16x32_bf16 v[100:103], a[192:195], v[24:27], v[100:103]
s_waitcnt lgkmcnt(2)
ds_read_b128 a[160:163], v2 offset:20480
ds_read_b128 a[164:167], v2 offset:21504
ds_read_b128 a[168:171], v2 offset:22528
ds_read_b128 a[172:175], v2 offset:23552
v_mfma_f32_16x16x32_bf16 v[120:123], a[144:147], v[56:59], v[224:227]
v_exp_f32 v98, v98
v_mfma_f32_16x16x32_bf16 v[120:123], a[148:151], v[60:63], v[120:123]
s_waitcnt lgkmcnt(5)
v_cvt_pk_bf16_f32 v154, v92, v93
v_exp_f32 v99, v99
v_mfma_f32_16x16x32_bf16 v[120:123], a[152:155], v[64:67], v[120:123]
s_waitcnt lgkmcnt(4)
v_exp_f32 v112, v112
v_mfma_f32_16x16x32_bf16 v[120:123], a[156:159], v[68:71], v[120:123]
v_exp_f32 v113, v113
v_mfma_f32_16x16x32_bf16 v[136:139], a[156:159], v[84:87], v[228:231]
v_cvt_pk_bf16_f32 v155, v94, v95
v_cndmask_b32 v104, v220, v17, s[0:1]
v_mfma_f32_16x16x32_bf16 v[136:139], a[152:155], v[80:83], v[136:139]
ds_read_b128 a[176:179], v2 offset:24576
buffer_load_dwordx4 v16, s[32:35], s70 offen offset:2048 sc1 lds
v_cndmask_b32 v105, v220, v17, s[4:5]
v_cndmask_b32 v106, v220, v17, s[6:7]
v_cndmask_b32 v107, v220, v17, s[8:9]
v_exp_f32 v114, v114
v_mfma_f32_16x16x32_bf16 v[136:139], a[148:151], v[76:79], v[136:139]
v_cvt_pk_bf16_f32 v156, v96, v97
v_cvt_pk_bf16_f32 v157, v98, v99
v_mfma_f32_16x16x32_bf16 v[136:139], a[144:147], v[72:75], v[136:139]
v_exp_f32 v115, v115
v_mfma_f32_16x16x32_bf16 v[104:107], a[144:147], v[40:43], v[104:107]
v_exp_f32 v128, v128
v_mfma_f32_16x16x32_bf16 v[104:107], a[148:151], v[44:47], v[104:107]
v_exp_f32 v129, v129
v_mfma_f32_16x16x32_bf16 v[104:107], a[152:155], v[48:51], v[104:107]
v_exp_f32 v130, v130
v_mfma_f32_16x16x32_bf16 v[104:107], a[156:159], v[52:55], v[104:107]
s_waitcnt lgkmcnt(0)
v_exp_f32 v131, v131
v_mfma_f32_16x16x32_bf16 v[140:143], a[172:175], v[84:87], v[228:231]
v_cvt_pk_bf16_f32 v164, v112, v113
v_cvt_pk_bf16_f32 v165, v114, v115
v_mfma_f32_16x16x32_bf16 v[140:143], a[168:171], v[80:83], v[140:143]
v_exp_f32 v144, v144
v_mfma_f32_16x16x32_bf16 v[140:143], a[164:167], v[76:79], v[140:143]
v_exp_f32 v145, v145
v_mfma_f32_16x16x32_bf16 v[140:143], a[160:163], v[72:75], v[140:143]
v_exp_f32 v146, v146
v_mfma_f32_16x16x32_bf16 v[124:127], a[160:163], v[56:59], v[224:227]
ds_read_b128 a[180:183], v2 offset:25600
v_cndmask_b32 v108, v220, v17, s[10:11]
v_mfma_f32_16x16x32_bf16 v[124:127], a[164:167], v[60:63], v[124:127]
ds_read_b128 a[184:187], v2 offset:26624
buffer_load_dwordx4 v16, s[32:35], s70 offen offset:3072 sc1 lds
v_cndmask_b32 v109, v220, v17, s[12:13]
v_cndmask_b32 v110, v220, v17, s[18:19]
v_cndmask_b32 v111, v220, v17, s[22:23]
v_cvt_pk_bf16_f32 v188, v128, v129
v_mfma_f32_16x16x32_bf16 v[124:127], a[168:171], v[64:67], v[124:127]
s_add_u32 m0, s86, 131072
v_exp_f32 v147, v147
v_mfma_f32_16x16x32_bf16 v[124:127], a[172:175], v[68:71], v[124:127]
s_add_u32 s64, s85, 0
ds_read_b128 a[188:191], v2 offset:27648
v_exp_f32 v148, v148
v_mfma_f32_16x16x32_bf16 v[108:111], a[172:175], v[52:55], v[108:111]
buffer_load_dwordx4 v12, s[36:39], s64 offen lds
v_cvt_pk_bf16_f32 v189, v130, v131
v_exp_f32 v149, v149
v_mfma_f32_16x16x32_bf16 v[108:111], a[168:171], v[48:51], v[108:111]
s_add_u32 m0, s86, 132096
ds_read_b128 a[192:195], v2 offset:28672
v_cndmask_b32 v112, v220, v17, s[26:27]
v_cndmask_b32 v113, v220, v17, s[56:57]
v_cndmask_b32 v114, v220, v17, s[58:59]
v_cndmask_b32 v115, v220, v17, s[60:61]
v_mfma_f32_16x16x32_bf16 v[108:111], a[164:167], v[44:47], v[108:111]
s_add_u32 s64, s85, 8192
v_exp_f32 v150, v150
v_mfma_f32_16x16x32_bf16 v[108:111], a[160:163], v[40:43], v[108:111]
buffer_load_dwordx4 v13, s[36:39], s64 offen lds
v_cvt_pk_bf16_f32 v196, v144, v145
v_exp_f32 v151, v151
v_mfma_f32_16x16x32_bf16 v[112:115], a[176:179], v[40:43], v[112:115]
s_waitcnt lgkmcnt(2)
s_add_u32 m0, s86, 133120
v_exp_f32 v132, v132
v_mfma_f32_16x16x32_bf16 v[112:115], a[180:183], v[44:47], v[112:115]
s_add_u32 s64, s85, 16384
v_exp_f32 v133, v133
v_mfma_f32_16x16x32_bf16 v[112:115], a[184:187], v[48:51], v[112:115]
s_waitcnt lgkmcnt(1)
buffer_load_dwordx4 v12, s[36:39], s64 offen lds
v_cvt_pk_bf16_f32 v197, v146, v147
v_mfma_f32_16x16x32_bf16 v[112:115], a[188:191], v[52:55], v[112:115]
s_add_u32 m0, s86, 134144
v_exp_f32 v134, v134
v_mfma_f32_16x16x32_bf16 v[128:131], a[188:191], v[68:71], v[224:227]
s_add_u32 s64, s85, 24576
ds_read_b128 a[196:199], v2 offset:29696
ds_read_b128 a[200:203], v2 offset:30720
ds_read_b128 a[204:207], v2 offset:31744
v_cvt_pk_bf16_f32 v198, v148, v149
v_mfma_f32_16x16x32_bf16 v[128:131], a[184:187], v[64:67], v[128:131]
buffer_load_dwordx4 v13, s[36:39], s64 offen lds
v_exp_f32 v135, v135
v_mfma_f32_16x16x32_bf16 v[128:131], a[180:183], v[60:63], v[128:131]
s_add_u32 m0, s71, 4096
v_exp_f32 v116, v116
v_mfma_f32_16x16x32_bf16 v[128:131], a[176:179], v[56:59], v[128:131]
s_add_u32 s64, s70, 4096
v_cvt_pk_bf16_f32 v199, v150, v151
v_exp_f32 v117, v117
v_mfma_f32_16x16x32_bf16 v[144:147], a[176:179], v[72:75], v[228:231]
buffer_load_dwordx4 v16, s[32:35], s64 offen offset:0 sc1 lds
v_mfma_f32_16x16x32_bf16 v[144:147], a[180:183], v[76:79], v[144:147]
v_exp_f32 v118, v118
v_mfma_f32_16x16x32_bf16 v[144:147], a[184:187], v[80:83], v[144:147]
v_cvt_pk_bf16_f32 v190, v132, v133
v_exp_f32 v119, v119
v_mfma_f32_16x16x32_bf16 v[144:147], a[188:191], v[84:87], v[144:147]
s_waitcnt lgkmcnt(0)
v_exp_f32 v100, v100
v_mfma_f32_16x16x32_bf16 v[148:151], a[204:207], v[84:87], v[228:231]
v_exp_f32 v101, v101
v_mfma_f32_16x16x32_bf16 v[148:151], a[200:203], v[80:83], v[148:151]
v_cvt_pk_bf16_f32 v191, v134, v135
v_cvt_pk_bf16_f32 v166, v116, v117
v_cvt_pk_bf16_f32 v167, v118, v119
v_mfma_f32_16x16x32_bf16 v[148:151], a[196:199], v[76:79], v[148:151]
v_exp_f32 v102, v102
v_mfma_f32_16x16x32_bf16 v[148:151], a[192:195], v[72:75], v[148:151]
v_exp_f32 v103, v103
v_mfma_f32_16x16x32_bf16 v[132:135], a[192:195], v[56:59], v[224:227]
s_lshl_b32 s66, s30, 30
ds_read_b128 a[144:147], v3 offset:16384
v_cndmask_b32 v116, v220, v17, s[62:63]
v_mfma_f32_16x16x32_bf16 v[132:135], a[196:199], v[60:63], v[132:135]
ds_read_b128 a[148:151], v3 offset:24576
v_cndmask_b32 v117, v220, v17, s[48:49]
v_cndmask_b32 v118, v220, v17, s[50:51]
v_cndmask_b32 v119, v220, v17, s[100:101]
v_exp_f32 v120, v120
v_mfma_f32_16x16x32_bf16 v[132:135], a[200:203], v[64:67], v[132:135]
v_exp_f32 v121, v121
v_mfma_f32_16x16x32_bf16 v[132:135], a[204:207], v[68:71], v[132:135]
v_exp_f32 v122, v122
v_mfma_f32_16x16x32_bf16 v[116:119], a[204:207], v[52:55], v[116:119]
ds_read_b128 a[152:155], v3 offset:17408
v_accvgpr_write_b32 a142, 0
v_mfma_f32_16x16x32_bf16 v[116:119], a[200:203], v[48:51], v[116:119]
ds_read_b128 a[156:159], v3 offset:25600
buffer_load_dwordx4 v16, s[32:35], s64 offen offset:1024 sc1 lds
v_accvgpr_write_b32 a143, 0
v_cvt_pk_bf16_f32 v158, v100, v101
v_cvt_pk_bf16_f32 v159, v102, v103
v_mfma_f32_16x16x32_bf16 v[116:119], a[196:199], v[44:47], v[116:119]
v_exp_f32 v123, v123
v_mfma_f32_16x16x32_bf16 v[116:119], a[192:195], v[40:43], v[116:119]
v_exp_f32 v136, v136
v_smfmac_f32_16x16x64_bf16 a[128:131], a[240:243], v[152:159], v5
ds_read_b128 a[160:163], v3 offset:18432
v_smfmac_f32_16x16x64_bf16 a[132:135], a[240:243], v[160:167], v5
v_exp_f32 v137, v137
v_smfmac_f32_16x16x64_bf16 a[136:139], a[240:243], v[184:191], v5
v_exp_f32 v138, v138
v_smfmac_f32_16x16x64_bf16 a[140:143], a[240:243], v[192:199], v5
s_waitcnt lgkmcnt(1)
v_cvt_pk_bf16_f32 v200, v120, v121
v_mfma_f32_16x16x32_bf16 a[0:3], a[144:147], v[152:155], 0
v_exp_f32 v139, v139
v_mfma_f32_16x16x32_bf16 a[0:3], a[148:151], v[156:159], a[0:3]
v_exp_f32 v104, v104
v_mfma_f32_16x16x32_bf16 a[32:35], a[148:151], v[164:167], 0
v_cvt_pk_bf16_f32 v201, v122, v123
v_cvt_pk_bf16_f32 v208, v136, v137
v_mfma_f32_16x16x32_bf16 a[32:35], a[144:147], v[160:163], a[32:35]
v_exp_f32 v105, v105
v_mfma_f32_16x16x32_bf16 a[64:67], a[144:147], v[184:187], 0
v_exp_f32 v106, v106
v_mfma_f32_16x16x32_bf16 a[64:67], a[148:151], v[188:191], a[64:67]
v_exp_f32 v107, v107
v_mfma_f32_16x16x32_bf16 a[96:99], a[148:151], v[196:199], 0
buffer_load_dwordx4 v16, s[32:35], s64 offen offset:2048 sc1 lds
v_mfma_f32_16x16x32_bf16 a[96:99], a[144:147], v[192:195], a[96:99]
v_exp_f32 v140, v140
v_mfma_f32_16x16x32_bf16 a[100:103], a[152:155], v[192:195], 0
ds_read_b128 a[164:167], v3 offset:26624
v_cvt_pk_bf16_f32 v209, v138, v139
v_mfma_f32_16x16x32_bf16 a[100:103], a[156:159], v[196:199], a[100:103]
v_exp_f32 v141, v141
v_mfma_f32_16x16x32_bf16 a[68:71], a[156:159], v[188:191], 0
v_exp_f32 v142, v142
v_mfma_f32_16x16x32_bf16 a[68:71], a[152:155], v[184:187], a[68:71]
v_cvt_pk_bf16_f32 v176, v104, v105
v_cvt_pk_bf16_f32 v177, v106, v107
v_mfma_f32_16x16x32_bf16 a[36:39], a[152:155], v[160:163], 0
v_exp_f32 v143, v143
v_mfma_f32_16x16x32_bf16 a[36:39], a[156:159], v[164:167], a[36:39]
v_exp_f32 v124, v124
v_mfma_f32_16x16x32_bf16 a[4:7], a[156:159], v[156:159], 0
v_exp_f32 v125, v125
v_mfma_f32_16x16x32_bf16 a[4:7], a[152:155], v[152:155], a[4:7]
s_waitcnt lgkmcnt(0)
ds_read_b128 a[168:171], v3 offset:19456
v_cvt_pk_bf16_f32 v210, v140, v141
v_mfma_f32_16x16x32_bf16 a[8:11], a[160:163], v[152:155], 0
v_exp_f32 v126, v126
v_mfma_f32_16x16x32_bf16 a[8:11], a[164:167], v[156:159], a[8:11]
ds_read_b128 a[172:175], v3 offset:27648
v_cvt_pk_bf16_f32 v211, v142, v143
v_mfma_f32_16x16x32_bf16 a[40:43], a[164:167], v[164:167], 0
v_exp_f32 v127, v127
v_mfma_f32_16x16x32_bf16 a[40:43], a[160:163], v[160:163], a[40:43]
v_exp_f32 v108, v108
v_mfma_f32_16x16x32_bf16 a[72:75], a[160:163], v[184:187], 0
buffer_load_dwordx4 v16, s[32:35], s64 offen offset:3072 sc1 lds
v_mfma_f32_16x16x32_bf16 a[72:75], a[164:167], v[188:191], a[72:75]
v_exp_f32 v109, v109
v_mfma_f32_16x16x32_bf16 a[104:107], a[164:167], v[196:199], 0
v_exp_f32 v110, v110
v_mfma_f32_16x16x32_bf16 a[104:107], a[160:163], v[192:195], a[104:107]
s_waitcnt lgkmcnt(0)
ds_read_b128 a[176:179], v3 offset:20480
v_cvt_pk_bf16_f32 v202, v124, v125
v_mfma_f32_16x16x32_bf16 a[108:111], a[168:171], v[192:195], 0
v_exp_f32 v111, v111
v_mfma_f32_16x16x32_bf16 a[108:111], a[172:175], v[196:199], a[108:111]
ds_read_b128 a[180:183], v3 offset:28672
v_cvt_pk_bf16_f32 v203, v126, v127
v_mfma_f32_16x16x32_bf16 a[76:79], a[172:175], v[188:191], 0
s_add_u32 m0, s86, 135168
v_exp_f32 v112, v112
v_mfma_f32_16x16x32_bf16 a[76:79], a[168:171], v[184:187], a[76:79]
s_add_u32 s64, s85, 32768
v_exp_f32 v113, v113
v_mfma_f32_16x16x32_bf16 a[44:47], a[168:171], v[160:163], 0
buffer_load_dwordx4 v12, s[36:39], s64 offen lds
v_mfma_f32_16x16x32_bf16 a[44:47], a[172:175], v[164:167], a[44:47]
s_add_u32 m0, s86, 136192
v_cvt_pk_bf16_f32 v178, v108, v109
v_exp_f32 v114, v114
v_mfma_f32_16x16x32_bf16 a[12:15], a[172:175], v[156:159], 0
s_add_u32 s64, s85, 40960
v_exp_f32 v115, v115
v_mfma_f32_16x16x32_bf16 a[12:15], a[168:171], v[152:155], a[12:15]
s_waitcnt lgkmcnt(0)
buffer_load_dwordx4 v13, s[36:39], s64 offen lds
v_mfma_f32_16x16x32_bf16 a[16:19], a[176:179], v[152:155], 0
s_add_u32 m0, s86, 137216
ds_read_b128 a[184:187], v3 offset:21504
ds_read_b128 a[188:191], v3 offset:29696
ds_read_b128 a[192:195], v3 offset:22528
ds_read_b128 a[196:199], v3 offset:30720
ds_read_b128 a[200:203], v3 offset:23552
ds_read_b128 a[204:207], v3 offset:31744
v_xor_b32 v2, 0x8000, v2
v_exp_f32 v128, v128
v_mfma_f32_16x16x32_bf16 a[16:19], a[180:183], v[156:159], a[16:19]
s_waitcnt vmcnt(14)
s_barrier
s_add_u32 s64, s85, 49152
v_cvt_pk_bf16_f32 v179, v110, v111
v_mfma_f32_16x16x32_bf16 a[48:51], a[180:183], v[164:167], 0
buffer_load_dwordx4 v12, s[36:39], s64 offen lds
v_exp_f32 v129, v129
v_mfma_f32_16x16x32_bf16 a[48:51], a[176:179], v[160:163], a[48:51]
s_add_u32 m0, s86, 138240
v_exp_f32 v130, v130
v_mfma_f32_16x16x32_bf16 a[80:83], a[176:179], v[184:187], 0
s_add_u32 s64, s85, 57344
v_cvt_pk_bf16_f32 v180, v112, v113
v_cvt_pk_bf16_f32 v181, v114, v115
v_mfma_f32_16x16x32_bf16 a[80:83], a[180:183], v[188:191], a[80:83]
buffer_load_dwordx4 v13, s[36:39], s64 offen lds
v_exp_f32 v131, v131
v_mfma_f32_16x16x32_bf16 a[112:115], a[180:183], v[196:199], 0
v_exp_f32 v144, v144
v_mfma_f32_16x16x32_bf16 a[112:115], a[176:179], v[192:195], a[112:115]
s_waitcnt lgkmcnt(0)
s_xor_b32 s71, s71, 49152
s_add_u32 s70, s70, 32768
s_mov_b32 m0, s71
v_exp_f32 v145, v145
v_mfma_f32_16x16x32_bf16 a[116:119], a[184:187], v[192:195], 0
buffer_load_dwordx4 v16, s[32:35], s70 offen offset:0 sc1 lds
v_mfma_f32_16x16x32_bf16 a[116:119], a[188:191], v[196:199], a[116:119]
v_exp_f32 v146, v146
v_mfma_f32_16x16x32_bf16 a[84:87], a[188:191], v[188:191], 0
v_cvt_pk_bf16_f32 v204, v128, v129
v_cvt_pk_bf16_f32 v205, v130, v131
v_mfma_f32_16x16x32_bf16 a[84:87], a[184:187], v[184:187], a[84:87]
v_exp_f32 v147, v147
v_mfma_f32_16x16x32_bf16 a[52:55], a[184:187], v[160:163], 0
v_exp_f32 v148, v148
v_mfma_f32_16x16x32_bf16 a[52:55], a[188:191], v[164:167], a[52:55]
v_exp_f32 v149, v149
v_mfma_f32_16x16x32_bf16 a[20:23], a[188:191], v[156:159], 0
ds_read_b128 a[144:147], v2 offset:0
v_lshl_add_u32 v19, v0, 24, s66
v_mfma_f32_16x16x32_bf16 a[20:23], a[184:187], v[152:155], a[20:23]
s_lshr_b32 s67, s31, 4
v_exp_f32 v150, v150
v_mfma_f32_16x16x32_bf16 a[24:27], a[192:195], v[152:155], 0
s_lshl1_add_u32 s67, s3, s67
v_cvt_pk_bf16_f32 v212, v144, v145
v_cvt_pk_bf16_f32 v213, v146, v147
v_mfma_f32_16x16x32_bf16 a[24:27], a[196:199], v[156:159], a[24:27]
s_lshl_b32 s79, s67, 8
v_exp_f32 v151, v151
v_mfma_f32_16x16x32_bf16 a[56:59], a[196:199], v[164:167], 0
s_add_u32 s79, s79, 8192
v_exp_f32 v132, v132
v_mfma_f32_16x16x32_bf16 a[56:59], a[192:195], v[160:163], a[56:59]
s_add_u32 s69, s31, 12
v_exp_f32 v133, v133
v_mfma_f32_16x16x32_bf16 a[88:91], a[192:195], v[184:187], 0
s_lshr_b32 s69, s69, 5
buffer_load_dwordx4 v16, s[32:35], s70 offen offset:1024 sc1 lds
v_mfma_f32_16x16x32_bf16 a[88:91], a[196:199], v[188:191], a[88:91]
s_lshl1_add_u32 s69, s3, s69
v_exp_f32 v134, v134
v_mfma_f32_16x16x32_bf16 a[120:123], a[196:199], v[196:199], 0
s_lshl_b32 s69, s69, 8
v_cvt_pk_bf16_f32 v214, v148, v149
v_cvt_pk_bf16_f32 v215, v150, v151
v_mfma_f32_16x16x32_bf16 a[120:123], a[192:195], v[192:195], a[120:123]
s_add_u32 s69, s69, 8192
v_exp_f32 v135, v135
v_mfma_f32_16x16x32_bf16 a[124:127], a[200:203], v[192:195], 0
s_lshl_b32 s67, s73, 16
v_exp_f32 v116, v116
v_mfma_f32_16x16x32_bf16 a[124:127], a[204:207], v[196:199], a[124:127]
s_xor_b32 s68, s80, 256
v_exp_f32 v117, v117
v_mfma_f32_16x16x32_bf16 a[92:95], a[204:207], v[188:191], 0
s_add_u32 s68, s68, s67
ds_read_b128 a[148:151], v2 offset:1024
v_cvt_pk_bf16_f32 v206, v132, v133
v_mfma_f32_16x16x32_bf16 a[92:95], a[200:203], v[184:187], a[92:95]
s_add_u32 s67, s67, s69
v_exp_f32 v118, v118
v_mfma_f32_16x16x32_bf16 a[60:63], a[200:203], v[160:163], 0
ds_read_b128 a[152:155], v2 offset:2048
v_cvt_pk_bf16_f32 v207, v134, v135
v_mfma_f32_16x16x32_bf16 a[60:63], a[204:207], v[164:167], a[60:63]
ds_read_b128 a[156:159], v2 offset:3072
v_cvt_pk_bf16_f32 v182, v116, v117
v_mfma_f32_16x16x32_bf16 a[28:31], a[204:207], v[156:159], 0
s_mov_b64 exec, 1
buffer_atomic_add a251, v19, s[52:55], s67 offen offset:0 sc1
buffer_atomic_add a251, v19, s[52:55], s68 offen offset:0 sc1
s_mov_b64 exec, -1
v_exp_f32 v119, v119
v_mfma_f32_16x16x32_bf16 a[28:31], a[200:203], v[152:155], a[28:31]
ds_read_b128 a[160:163], v2 offset:4096
ds_read_b128 a[164:167], v2 offset:5120
ds_read_b128 a[168:171], v2 offset:6144
ds_read_b128 a[172:175], v2 offset:7168
v_mul_u32_u24 v19, 52, v0
v_cvt_pk_bf16_f32 v183, v118, v119
v_xor_b32 v3, 0x8000, v3
v_accvgpr_read_b32 v20, a128
v_accvgpr_read_b32 v248, a129
v_add_f32 v20, v20, v248
v_max_f32 v1, v1, v20
v_rcp_f32 v20, v20
v_accvgpr_read_b32 v232, a0
v_accvgpr_read_b32 v233, a1
v_accvgpr_read_b32 v234, a2
v_accvgpr_read_b32 v235, a3
v_accvgpr_read_b32 v236, a4
v_accvgpr_read_b32 v237, a5
v_accvgpr_read_b32 v238, a6
v_accvgpr_read_b32 v239, a7
v_mul_f32 v20, v20, v4
v_mul_f32 v232, v232, v20
v_mul_f32 v233, v233, v20
v_mul_f32 v234, v234, v20
v_mul_f32 v235, v235, v20
v_mul_f32 v236, v236, v20
v_mul_f32 v237, v237, v20
v_mul_f32 v238, v238, v20
v_mul_f32 v239, v239, v20
v_cvt_pk_bf16_f32 v232, v232, v233
v_cvt_pk_bf16_f32 v233, v234, v235
v_cvt_pk_bf16_f32 v234, v236, v237
v_cvt_pk_bf16_f32 v235, v238, v239
s_add_u32 s77, s74, 0
buffer_store_dwordx4 v[232:235], v16, s[44:47], s77 offen sc1
v_accvgpr_read_b32 v240, a8
v_accvgpr_read_b32 v241, a9
v_accvgpr_read_b32 v242, a10
v_accvgpr_read_b32 v243, a11
v_accvgpr_read_b32 v244, a12
v_accvgpr_read_b32 v245, a13
v_accvgpr_read_b32 v246, a14
v_accvgpr_read_b32 v247, a15
v_mul_f32 v240, v240, v20
v_mul_f32 v241, v241, v20
v_mul_f32 v242, v242, v20
v_mul_f32 v243, v243, v20
v_mul_f32 v244, v244, v20
v_mul_f32 v245, v245, v20
v_mul_f32 v246, v246, v20
v_mul_f32 v247, v247, v20
v_cvt_pk_bf16_f32 v240, v240, v241
v_cvt_pk_bf16_f32 v241, v242, v243
v_cvt_pk_bf16_f32 v242, v244, v245
v_cvt_pk_bf16_f32 v243, v246, v247
s_add_u32 s77, s74, 8192
buffer_store_dwordx4 v[240:243], v16, s[44:47], s77 offen sc1
v_accvgpr_read_b32 v232, a16
v_accvgpr_read_b32 v233, a17
v_accvgpr_read_b32 v234, a18
v_accvgpr_read_b32 v235, a19
v_accvgpr_read_b32 v236, a20
v_accvgpr_read_b32 v237, a21
v_accvgpr_read_b32 v238, a22
v_accvgpr_read_b32 v239, a23
v_mul_f32 v232, v232, v20
v_mul_f32 v233, v233, v20
v_mul_f32 v234, v234, v20
v_mul_f32 v235, v235, v20
v_mul_f32 v236, v236, v20
v_mul_f32 v237, v237, v20
v_mul_f32 v238, v238, v20
v_mul_f32 v239, v239, v20
v_cvt_pk_bf16_f32 v232, v232, v233
v_cvt_pk_bf16_f32 v233, v234, v235
v_cvt_pk_bf16_f32 v234, v236, v237
v_cvt_pk_bf16_f32 v235, v238, v239
s_add_u32 s77, s74, 16384
buffer_store_dwordx4 v[232:235], v16, s[44:47], s77 offen sc1
s_branch L_T
L_T1:
buffer_load_dword v19, off, s[52:55], s80 sc1
s_waitcnt lgkmcnt(7)
v_mfma_f32_16x16x32_bf16 v[136:139], a[144:147], v[72:75], v[228:231]
s_waitcnt lgkmcnt(6)
ds_read_b128 a[176:179], v2 offset:8192
v_cndmask_b32 v120, v224, v17, s[0:1]
v_mfma_f32_16x16x32_bf16 v[136:139], a[148:151], v[76:79], v[136:139]
s_waitcnt lgkmcnt(6)
ds_read_b128 a[180:183], v2 offset:9216
v_cndmask_b32 v121, v224, v17, s[4:5]
v_cndmask_b32 v122, v224, v17, s[6:7]
v_cndmask_b32 v123, v224, v17, s[8:9]
v_mfma_f32_16x16x32_bf16 v[136:139], a[152:155], v[80:83], v[136:139]
s_waitcnt lgkmcnt(6)
buffer_load_dwordx4 v16, s[32:35], s70 offen offset:2048 sc1 lds
v_mfma_f32_16x16x32_bf16 v[136:139], a[156:159], v[84:87], v[136:139]
ds_read_b128 a[184:187], v2 offset:10240
v_cndmask_b32 v124, v224, v17, s[10:11]
v_mfma_f32_16x16x32_bf16 v[120:123], a[156:159], v[68:71], v[120:123]
ds_read_b128 a[188:191], v2 offset:11264
v_cndmask_b32 v125, v224, v17, s[12:13]
v_mfma_f32_16x16x32_bf16 v[120:123], a[152:155], v[64:67], v[120:123]
ds_read_b128 a[192:195], v2 offset:12288
v_cndmask_b32 v126, v224, v17, s[18:19]
v_mfma_f32_16x16x32_bf16 v[120:123], a[148:151], v[60:63], v[120:123]
ds_read_b128 a[196:199], v2 offset:13312
v_cndmask_b32 v127, v224, v17, s[22:23]
v_mfma_f32_16x16x32_bf16 v[120:123], a[144:147], v[56:59], v[120:123]
s_waitcnt lgkmcnt(4)
ds_read_b128 a[200:203], v2 offset:14336
v_cndmask_b32 v128, v224, v17, s[26:27]
v_mfma_f32_16x16x32_bf16 v[140:143], a[160:163], v[72:75], v[228:231]
ds_read_b128 a[204:207], v2 offset:15360
v_cndmask_b32 v129, v224, v17, s[56:57]
v_mfma_f32_16x16x32_bf16 v[140:143], a[164:167], v[76:79], v[140:143]
ds_read_b128 a[144:147], v3 offset:0
v_cndmask_b32 v130, v224, v17, s[58:59]
v_mfma_f32_16x16x32_bf16 v[140:143], a[168:171], v[80:83], v[140:143]
v_exp_f32 v136, v136
v_mfma_f32_16x16x32_bf16 v[140:143], a[172:175], v[84:87], v[140:143]
v_exp_f32 v137, v137
v_mfma_f32_16x16x32_bf16 v[124:127], a[172:175], v[68:71], v[124:127]
ds_read_b128 a[148:151], v3 offset:8192
v_cndmask_b32 v131, v224, v17, s[60:61]
v_mfma_f32_16x16x32_bf16 v[124:127], a[168:171], v[64:67], v[124:127]
v_exp_f32 v138, v138
v_mfma_f32_16x16x32_bf16 v[124:127], a[164:167], v[60:63], v[124:127]
s_mul_i32 s69, s83, 8
buffer_load_dwordx4 v16, s[32:35], s70 offen offset:3072 sc1 lds
v_mfma_f32_16x16x32_bf16 v[124:127], a[160:163], v[56:59], v[124:127]
s_sub_u32 s69, 36, s69
v_exp_f32 v139, v139
v_mfma_f32_16x16x32_bf16 v[128:131], a[176:179], v[56:59], v[128:131]
v_exp_f32 v120, v120
v_mfma_f32_16x16x32_bf16 v[128:131], a[180:183], v[60:63], v[128:131]
s_waitcnt lgkmcnt(1)
v_exp_f32 v121, v121
v_mfma_f32_16x16x32_bf16 v[128:131], a[184:187], v[64:67], v[128:131]
v_exp_f32 v122, v122
v_mfma_f32_16x16x32_bf16 v[128:131], a[188:191], v[68:71], v[128:131]
s_add_u32 m0, s71, 4096
ds_read_b128 a[152:155], v3 offset:1024
v_cndmask_b32 v132, v224, v17, s[62:63]
v_mfma_f32_16x16x32_bf16 v[144:147], a[188:191], v[84:87], v[228:231]
s_add_u32 s64, s70, 4096
v_cvt_pk_bf16_f32 v192, v136, v137
v_cndmask_b32 v133, v224, v17, s[48:49]
v_mfma_f32_16x16x32_bf16 v[144:147], a[184:187], v[80:83], v[144:147]
buffer_load_dwordx4 v16, s[32:35], s64 offen offset:0 sc1 lds
v_mfma_f32_16x16x32_bf16 v[144:147], a[180:183], v[76:79], v[144:147]
ds_read_b128 a[156:159], v3 offset:9216
v_cndmask_b32 v134, v224, v17, s[50:51]
v_mfma_f32_16x16x32_bf16 v[144:147], a[176:179], v[72:75], v[144:147]
ds_read_b128 a[160:163], v3 offset:2048
v_cndmask_b32 v135, v224, v17, s[100:101]
v_mfma_f32_16x16x32_bf16 v[148:151], a[192:195], v[72:75], v[228:231]
v_exp_f32 v123, v123
v_mfma_f32_16x16x32_bf16 v[148:151], a[196:199], v[76:79], v[148:151]
v_cvt_pk_bf16_f32 v193, v138, v139
v_cvt_pk_bf16_f32 v184, v120, v121
v_mfma_f32_16x16x32_bf16 v[148:151], a[200:203], v[80:83], v[148:151]
v_exp_f32 v140, v140
v_mfma_f32_16x16x32_bf16 v[148:151], a[204:207], v[84:87], v[148:151]
v_exp_f32 v141, v141
v_mfma_f32_16x16x32_bf16 v[132:135], a[204:207], v[68:71], v[132:135]
v_exp_f32 v142, v142
v_mfma_f32_16x16x32_bf16 v[132:135], a[200:203], v[64:67], v[132:135]
v_exp_f32 v143, v143
v_mfma_f32_16x16x32_bf16 v[132:135], a[196:199], v[60:63], v[132:135]
buffer_load_dwordx4 v16, s[32:35], s64 offen offset:1024 sc1 lds
v_mfma_f32_16x16x32_bf16 v[132:135], a[192:195], v[56:59], v[132:135]
v_exp_f32 v124, v124
v_smfmac_f32_16x16x64_bf16 a[132:135], a[240:243], v[176:183], v5
ds_read_b128 a[164:167], v3 offset:10240
v_smfmac_f32_16x16x64_bf16 a[136:139], a[240:243], v[200:207], v5
ds_read_b128 a[168:171], v3 offset:3072
v_accvgpr_read_b32 v240, a24
v_smfmac_f32_16x16x64_bf16 a[140:143], a[240:243], v[208:215], v5
v_cvt_pk_bf16_f32 v185, v122, v123
v_mfma_f32_16x16x32_bf16 a[32:35], a[144:147], v[176:179], a[32:35]
s_waitcnt lgkmcnt(2)
v_exp_f32 v125, v125
v_mfma_f32_16x16x32_bf16 a[32:35], a[148:151], v[180:183], a[32:35]
ds_read_b128 a[172:175], v3 offset:11264
v_accvgpr_read_b32 v241, a25
v_mfma_f32_16x16x32_bf16 a[64:67], a[148:151], v[204:207], a[64:67]
ds_read_b128 a[176:179], v3 offset:4096
v_accvgpr_read_b32 v242, a26
v_mfma_f32_16x16x32_bf16 a[64:67], a[144:147], v[200:203], a[64:67]
v_cvt_pk_bf16_f32 v194, v140, v141
v_accvgpr_read_b32 v243, a27
v_mfma_f32_16x16x32_bf16 a[96:99], a[144:147], v[208:211], a[96:99]
ds_read_b128 a[180:183], v3 offset:12288
v_accvgpr_read_b32 v244, a28
v_mfma_f32_16x16x32_bf16 a[96:99], a[148:151], v[212:215], a[96:99]
ds_read_b128 a[184:187], v3 offset:5120
v_accvgpr_read_b32 v245, a29
v_mfma_f32_16x16x32_bf16 a[100:103], a[156:159], v[212:215], a[100:103]
ds_read_b128 a[188:191], v3 offset:13312
v_accvgpr_read_b32 v246, a30
v_mfma_f32_16x16x32_bf16 a[100:103], a[152:155], v[208:211], a[100:103]
ds_read_b128 a[192:195], v3 offset:6144
v_accvgpr_read_b32 v247, a31
v_mul_f32 v240, v240, v20
v_mul_f32 v241, v241, v20
v_mul_f32 v242, v242, v20
v_mul_f32 v243, v243, v20
v_mul_f32 v244, v244, v20
v_mul_f32 v245, v245, v20
v_mul_f32 v246, v246, v20
v_mul_f32 v247, v247, v20
v_cvt_pk_bf16_f32 v240, v240, v241
v_cvt_pk_bf16_f32 v241, v242, v243
v_cvt_pk_bf16_f32 v242, v244, v245
v_cvt_pk_bf16_f32 v243, v246, v247
s_add_u32 s77, s74, 24576
buffer_store_dwordx4 v[240:243], v16, s[44:47], s77 offen sc1
v_exp_f32 v126, v126
v_mfma_f32_16x16x32_bf16 a[68:71], a[152:155], v[200:203], a[68:71]
buffer_load_dwordx4 v16, s[32:35], s64 offen offset:2048 sc1 lds
v_cvt_pk_bf16_f32 v195, v142, v143
v_mfma_f32_16x16x32_bf16 a[68:71], a[156:159], v[204:207], a[68:71]
v_exp_f32 v127, v127
v_mfma_f32_16x16x32_bf16 a[36:39], a[156:159], v[180:183], a[36:39]
v_exp_f32 v128, v128
v_mfma_f32_16x16x32_bf16 a[36:39], a[152:155], v[176:179], a[36:39]
v_exp_f32 v129, v129
v_mfma_f32_16x16x32_bf16 a[40:43], a[160:163], v[176:179], a[40:43]
s_waitcnt lgkmcnt(1)
v_cvt_pk_bf16_f32 v186, v124, v125
v_cvt_pk_bf16_f32 v187, v126, v127
v_mfma_f32_16x16x32_bf16 a[40:43], a[164:167], v[180:183], a[40:43]
v_exp_f32 v130, v130
v_mfma_f32_16x16x32_bf16 a[72:75], a[164:167], v[204:207], a[72:75]
buffer_load_dwordx4 v16, s[32:35], s64 offen offset:3072 sc1 lds
v_mfma_f32_16x16x32_bf16 a[72:75], a[160:163], v[200:203], a[72:75]
v_exp_f32 v131, v131
v_mfma_f32_16x16x32_bf16 a[104:107], a[160:163], v[208:211], a[104:107]
v_exp_f32 v144, v144
v_mfma_f32_16x16x32_bf16 a[104:107], a[164:167], v[212:215], a[104:107]
v_exp_f32 v145, v145
v_mfma_f32_16x16x32_bf16 a[108:111], a[172:175], v[212:215], a[108:111]
v_exp_f32 v146, v146
v_mfma_f32_16x16x32_bf16 a[108:111], a[168:171], v[208:211], a[108:111]
ds_read_b128 a[196:199], v3 offset:14336
v_cvt_pk_bf16_f32 v188, v128, v129
v_mfma_f32_16x16x32_bf16 a[76:79], a[168:171], v[200:203], a[76:79]
ds_read_b128 a[200:203], v3 offset:7168
v_cvt_pk_bf16_f32 v189, v130, v131
v_mfma_f32_16x16x32_bf16 a[76:79], a[172:175], v[204:207], a[76:79]
ds_read_b128 a[204:207], v3 offset:15360
v_cvt_pk_bf16_f32 v196, v144, v145
v_mfma_f32_16x16x32_bf16 a[44:47], a[172:175], v[180:183], a[44:47]
v_exp_f32 v147, v147
v_mfma_f32_16x16x32_bf16 a[44:47], a[168:171], v[176:179], a[44:47]
v_exp_f32 v148, v148
v_mfma_f32_16x16x32_bf16 a[48:51], a[176:179], v[176:179], a[48:51]
v_exp_f32 v149, v149
v_mfma_f32_16x16x32_bf16 a[48:51], a[180:183], v[180:183], a[48:51]
v_exp_f32 v150, v150
v_mfma_f32_16x16x32_bf16 a[80:83], a[180:183], v[204:207], a[80:83]
s_waitcnt vmcnt(10)
s_barrier
v_mfma_f32_16x16x32_bf16 a[80:83], a[176:179], v[200:203], a[80:83]
v_exp_f32 v151, v151
v_mfma_f32_16x16x32_bf16 a[112:115], a[176:179], v[208:211], a[112:115]
v_exp_f32 v132, v132
v_mfma_f32_16x16x32_bf16 a[112:115], a[180:183], v[212:215], a[112:115]
v_exp_f32 v133, v133
v_mfma_f32_16x16x32_bf16 a[116:119], a[188:191], v[212:215], a[116:119]
ds_read_b128 a[144:147], v2 offset:16384
v_cvt_pk_bf16_f32 v197, v146, v147
v_mfma_f32_16x16x32_bf16 a[116:119], a[184:187], v[208:211], a[116:119]
v_exp_f32 v134, v134
v_mfma_f32_16x16x32_bf16 a[84:87], a[184:187], v[200:203], a[84:87]
s_waitcnt vmcnt(7)
v_readfirstlane_b32 vcc_lo, v19
s_nop 0
s_cmp_lt_u32 vcc_lo, s69
s_cbranch_scc1 L_spin_1012
L_spinbk_1013:
v_mfma_f32_16x16x32_bf16 a[84:87], a[188:191], v[204:207], a[84:87]
ds_read_b128 a[148:151], v2 offset:17408
v_cvt_pk_bf16_f32 v198, v148, v149
v_mfma_f32_16x16x32_bf16 a[52:55], a[188:191], v[180:183], a[52:55]
ds_read_b128 a[152:155], v2 offset:18432
v_cvt_pk_bf16_f32 v199, v150, v151
v_mfma_f32_16x16x32_bf16 a[52:55], a[184:187], v[176:179], a[52:55]
s_waitcnt lgkmcnt(3)
ds_read_b128 a[156:159], v2 offset:19456
v_cndmask_b32 v136, v228, v17, s[0:1]
v_mfma_f32_16x16x32_bf16 a[56:59], a[192:195], v[176:179], a[56:59]
ds_read_b128 a[160:163], v2 offset:20480
v_cndmask_b32 v137, v228, v17, s[4:5]
v_mfma_f32_16x16x32_bf16 a[56:59], a[196:199], v[180:183], a[56:59]
ds_read_b128 a[164:167], v2 offset:21504
v_cndmask_b32 v138, v228, v17, s[6:7]
v_mfma_f32_16x16x32_bf16 a[88:91], a[196:199], v[204:207], a[88:91]
ds_read_b128 a[168:171], v2 offset:22528
v_cndmask_b32 v139, v228, v17, s[8:9]
v_mfma_f32_16x16x32_bf16 a[88:91], a[192:195], v[200:203], a[88:91]
v_exp_f32 v135, v135
v_mfma_f32_16x16x32_bf16 a[120:123], a[192:195], v[208:211], a[120:123]
ds_read_b128 a[172:175], v2 offset:23552
v_cvt_pk_bf16_f32 v190, v132, v133
v_mfma_f32_16x16x32_bf16 a[120:123], a[196:199], v[212:215], a[120:123]
v_cndmask_b32 v140, v228, v17, s[10:11]
v_cvt_pk_bf16_f32 v191, v134, v135
v_mfma_f32_16x16x32_bf16 a[124:127], a[204:207], v[212:215], a[124:127]
v_cndmask_b32 v141, v228, v17, s[12:13]
v_cndmask_b32 v142, v228, v17, s[18:19]
v_mfma_f32_16x16x32_bf16 a[124:127], a[200:203], v[208:211], a[124:127]
v_cndmask_b32 v143, v228, v17, s[22:23]
v_cndmask_b32 v144, v228, v17, s[26:27]
v_mfma_f32_16x16x32_bf16 a[92:95], a[200:203], v[200:203], a[92:95]
v_cndmask_b32 v145, v228, v17, s[56:57]
v_cndmask_b32 v146, v228, v17, s[58:59]
v_mfma_f32_16x16x32_bf16 a[92:95], a[204:207], v[204:207], a[92:95]
v_cndmask_b32 v147, v228, v17, s[60:61]
v_cndmask_b32 v148, v228, v17, s[62:63]
v_mfma_f32_16x16x32_bf16 a[60:63], a[204:207], v[180:183], a[60:63]
v_cndmask_b32 v149, v228, v17, s[48:49]
v_cndmask_b32 v150, v228, v17, s[50:51]
v_mfma_f32_16x16x32_bf16 a[60:63], a[200:203], v[176:179], a[60:63]
s_waitcnt lgkmcnt(0)
v_cndmask_b32 v151, v228, v17, s[100:101]
v_accvgpr_read_b32 v21, a132
v_mfma_f32_16x16x32_bf16 v[136:139], a[144:147], v[72:75], v[136:139]
ds_read_b128 a[176:179], v2 offset:24576
v_accvgpr_read_b32 v248, a133
v_mfma_f32_16x16x32_bf16 v[136:139], a[148:151], v[76:79], v[136:139]
ds_read_b128 a[180:183], v2 offset:25600
v_add_f32 v21, v21, v248
v_mfma_f32_16x16x32_bf16 v[136:139], a[152:155], v[80:83], v[136:139]
ds_read_b128 a[184:187], v2 offset:26624
v_max_f32 v1, v1, v21
v_mfma_f32_16x16x32_bf16 v[136:139], a[156:159], v[84:87], v[136:139]
ds_read_b128 a[188:191], v2 offset:27648
ds_read_b128 a[192:195], v2 offset:28672
v_mfma_f32_16x16x32_bf16 v[140:143], a[172:175], v[84:87], v[140:143]
ds_read_b128 a[196:199], v2 offset:29696
ds_read_b128 a[200:203], v2 offset:30720
ds_read_b128 a[204:207], v2 offset:31744
v_mfma_f32_16x16x32_bf16 v[140:143], a[168:171], v[80:83], v[140:143]
v_rcp_f32 v21, v21
v_mfma_f32_16x16x32_bf16 v[140:143], a[164:167], v[76:79], v[140:143]
ds_read_b128 a[144:147], v3 offset:16384
v_accvgpr_read_b32 v232, a32
v_mfma_f32_16x16x32_bf16 v[140:143], a[160:163], v[72:75], v[140:143]
s_waitcnt lgkmcnt(7)
ds_read_b128 a[148:151], v3 offset:24576
v_accvgpr_read_b32 v233, a33
v_mfma_f32_16x16x32_bf16 v[144:147], a[176:179], v[72:75], v[144:147]
ds_read_b128 a[152:155], v3 offset:17408
v_accvgpr_read_b32 v234, a34
v_mfma_f32_16x16x32_bf16 v[144:147], a[180:183], v[76:79], v[144:147]
s_waitcnt lgkmcnt(6)
ds_read_b128 a[156:159], v3 offset:25600
v_accvgpr_read_b32 v235, a35
v_mfma_f32_16x16x32_bf16 v[144:147], a[184:187], v[80:83], v[144:147]
ds_read_b128 a[160:163], v3 offset:18432
v_accvgpr_read_b32 v236, a36
v_accvgpr_read_b32 v237, a37
v_accvgpr_read_b32 v238, a38
v_accvgpr_read_b32 v239, a39
v_mul_f32 v21, v21, v6
v_mul_f32 v232, v232, v21
v_mul_f32 v233, v233, v21
v_mul_f32 v234, v234, v21
v_mul_f32 v235, v235, v21
v_mul_f32 v236, v236, v21
v_mul_f32 v237, v237, v21
v_mul_f32 v238, v238, v21
v_mul_f32 v239, v239, v21
v_cvt_pk_bf16_f32 v232, v232, v233
v_cvt_pk_bf16_f32 v233, v234, v235
v_cvt_pk_bf16_f32 v234, v236, v237
v_cvt_pk_bf16_f32 v235, v238, v239
s_add_u32 s77, s74, 4096
buffer_store_dwordx4 v[232:235], v16, s[44:47], s77 offen sc1
v_accvgpr_read_b32 v240, a40
v_accvgpr_read_b32 v241, a41
v_accvgpr_read_b32 v242, a42
v_accvgpr_read_b32 v243, a43
v_accvgpr_read_b32 v244, a44
v_accvgpr_read_b32 v245, a45
v_accvgpr_read_b32 v246, a46
v_accvgpr_read_b32 v247, a47
v_mul_f32 v240, v240, v21
v_mul_f32 v241, v241, v21
v_mul_f32 v242, v242, v21
v_mul_f32 v243, v243, v21
v_mul_f32 v244, v244, v21
v_mul_f32 v245, v245, v21
v_mul_f32 v246, v246, v21
v_mul_f32 v247, v247, v21
v_cvt_pk_bf16_f32 v240, v240, v241
v_cvt_pk_bf16_f32 v241, v242, v243
v_cvt_pk_bf16_f32 v242, v244, v245
v_cvt_pk_bf16_f32 v243, v246, v247
s_add_u32 s77, s74, 12288
buffer_store_dwordx4 v[240:243], v16, s[44:47], s77 offen sc1
v_accvgpr_read_b32 v232, a48
v_accvgpr_read_b32 v233, a49
v_accvgpr_read_b32 v234, a50
v_accvgpr_read_b32 v235, a51
v_accvgpr_read_b32 v236, a52
v_accvgpr_read_b32 v237, a53
v_accvgpr_read_b32 v238, a54
v_accvgpr_read_b32 v239, a55
v_mul_f32 v232, v232, v21
v_mul_f32 v233, v233, v21
v_mul_f32 v234, v234, v21
v_mul_f32 v235, v235, v21
v_mul_f32 v236, v236, v21
v_mul_f32 v237, v237, v21
v_mul_f32 v238, v238, v21
v_mul_f32 v239, v239, v21
v_cvt_pk_bf16_f32 v232, v232, v233
v_cvt_pk_bf16_f32 v233, v234, v235
v_cvt_pk_bf16_f32 v234, v236, v237
v_cvt_pk_bf16_f32 v235, v238, v239
s_add_u32 s77, s74, 20480
buffer_store_dwordx4 v[232:235], v16, s[44:47], s77 offen sc1
v_accvgpr_read_b32 v240, a56
v_accvgpr_read_b32 v241, a57
v_accvgpr_read_b32 v242, a58
v_accvgpr_read_b32 v243, a59
v_accvgpr_read_b32 v244, a60
v_accvgpr_read_b32 v245, a61
v_accvgpr_read_b32 v246, a62
v_accvgpr_read_b32 v247, a63
v_mul_f32 v240, v240, v21
v_mul_f32 v241, v241, v21
v_mul_f32 v242, v242, v21
v_mul_f32 v243, v243, v21
v_mul_f32 v244, v244, v21
v_mul_f32 v245, v245, v21
v_mul_f32 v246, v246, v21
v_mul_f32 v247, v247, v21
v_cvt_pk_bf16_f32 v240, v240, v241
v_cvt_pk_bf16_f32 v241, v242, v243
v_cvt_pk_bf16_f32 v242, v244, v245
v_cvt_pk_bf16_f32 v243, v246, v247
s_add_u32 s77, s74, 28672
buffer_store_dwordx4 v[240:243], v16, s[44:47], s77 offen sc1
v_exp_f32 v136, v136
v_mfma_f32_16x16x32_bf16 v[144:147], a[188:191], v[84:87], v[144:147]
s_waitcnt lgkmcnt(5)
v_exp_f32 v137, v137
v_mfma_f32_16x16x32_bf16 v[148:151], a[204:207], v[84:87], v[148:151]
v_exp_f32 v138, v138
v_mfma_f32_16x16x32_bf16 v[148:151], a[200:203], v[80:83], v[148:151]
s_add_u32 s65, s84, 0
v_exp_f32 v139, v139
v_mfma_f32_16x16x32_bf16 v[148:151], a[196:199], v[76:79], v[148:151]
buffer_load_dwordx4 a[208:211], v14, s[44:47], s65 offen offset:0 sc1
v_mfma_f32_16x16x32_bf16 v[148:151], a[192:195], v[72:75], v[148:151]
ds_read_b128 a[164:167], v3 offset:26624
v_cvt_pk_bf16_f32 v208, v136, v137
v_smfmac_f32_16x16x64_bf16 a[136:139], a[240:243], v[184:191], v5
ds_read_b128 a[168:171], v3 offset:19456
v_smfmac_f32_16x16x64_bf16 a[140:143], a[240:243], v[192:199], v5
s_waitcnt lgkmcnt(2)
ds_read_b128 a[172:175], v3 offset:27648
v_mfma_f32_16x16x32_bf16 a[64:67], a[144:147], v[184:187], a[64:67]
v_exp_f32 v140, v140
v_mfma_f32_16x16x32_bf16 a[64:67], a[148:151], v[188:191], a[64:67]
buffer_load_dwordx4 a[216:219], v14, s[44:47], s65 offen offset:1024 sc1
v_mfma_f32_16x16x32_bf16 a[96:99], a[148:151], v[196:199], a[96:99]
v_exp_f32 v141, v141
v_mfma_f32_16x16x32_bf16 a[96:99], a[144:147], v[192:195], a[96:99]
buffer_load_dwordx4 a[224:227], v15, s[44:47], s65 offen offset:0 sc1
v_mfma_f32_16x16x32_bf16 a[100:103], a[152:155], v[192:195], a[100:103]
v_exp_f32 v142, v142
v_mfma_f32_16x16x32_bf16 a[100:103], a[156:159], v[196:199], a[100:103]
buffer_load_dwordx4 a[232:235], v15, s[44:47], s65 offen offset:1024 sc1
v_mfma_f32_16x16x32_bf16 a[68:71], a[156:159], v[188:191], a[68:71]
s_add_u32 s65, s84, 8192
ds_read_b128 a[176:179], v3 offset:20480
v_cvt_pk_bf16_f32 v209, v138, v139
v_mfma_f32_16x16x32_bf16 a[68:71], a[152:155], v[184:187], a[68:71]
buffer_load_dwordx4 a[212:215], v14, s[44:47], s65 offen offset:0 sc1
v_mfma_f32_16x16x32_bf16 a[72:75], a[160:163], v[184:187], a[72:75]
s_waitcnt lgkmcnt(1)
ds_read_b128 a[180:183], v3 offset:28672
v_cvt_pk_bf16_f32 v210, v140, v141
v_mfma_f32_16x16x32_bf16 a[72:75], a[164:167], v[188:191], a[72:75]
v_exp_f32 v143, v143
v_mfma_f32_16x16x32_bf16 a[104:107], a[164:167], v[196:199], a[104:107]
buffer_load_dwordx4 a[220:223], v14, s[44:47], s65 offen offset:1024 sc1
v_mfma_f32_16x16x32_bf16 a[104:107], a[160:163], v[192:195], a[104:107]
v_exp_f32 v144, v144
v_mfma_f32_16x16x32_bf16 a[108:111], a[168:171], v[192:195], a[108:111]
ds_read_b128 a[184:187], v3 offset:21504
v_xor_b32 v2, 0x8000, v2
v_mfma_f32_16x16x32_bf16 a[108:111], a[172:175], v[196:199], a[108:111]
buffer_load_dwordx4 a[228:231], v15, s[44:47], s65 offen offset:0 sc1
ds_read_b128 a[188:191], v3 offset:29696
v_mfma_f32_16x16x32_bf16 a[76:79], a[172:175], v[188:191], a[76:79]
v_exp_f32 v145, v145
v_mfma_f32_16x16x32_bf16 a[76:79], a[168:171], v[184:187], a[76:79]
s_waitcnt lgkmcnt(2)
buffer_load_dwordx4 a[236:239], v15, s[44:47], s65 offen offset:1024 sc1
v_mfma_f32_16x16x32_bf16 a[80:83], a[176:179], v[184:187], a[80:83]
s_add_u32 s65, s84, 32768
ds_read_b128 a[192:195], v3 offset:22528
v_cvt_pk_bf16_f32 v211, v142, v143
v_mfma_f32_16x16x32_bf16 a[80:83], a[180:183], v[188:191], a[80:83]
buffer_load_dwordx4 v[152:155], v14, s[44:47], s65 offen offset:0 sc1
ds_read_b128 a[196:199], v3 offset:30720
v_exp_f32 v146, v146
v_mfma_f32_16x16x32_bf16 a[112:115], a[180:183], v[196:199], a[112:115]
ds_read_b128 a[200:203], v3 offset:23552
ds_read_b128 a[204:207], v3 offset:31744
v_mfma_f32_16x16x32_bf16 a[112:115], a[176:179], v[192:195], a[112:115]
s_waitcnt vmcnt(13)
s_barrier
v_xor_b32 v3, 0x8000, v3
buffer_load_dwordx4 v[160:163], v14, s[44:47], s65 offen offset:1024 sc1
s_waitcnt lgkmcnt(4)
v_mfma_f32_16x16x32_bf16 a[116:119], a[184:187], v[192:195], a[116:119]
v_exp_f32 v147, v147
v_mfma_f32_16x16x32_bf16 a[116:119], a[188:191], v[196:199], a[116:119]
buffer_load_dwordx4 v[168:171], v15, s[44:47], s65 offen offset:0 sc1
v_mfma_f32_16x16x32_bf16 a[84:87], a[188:191], v[188:191], a[84:87]
v_exp_f32 v148, v148
v_mfma_f32_16x16x32_bf16 a[84:87], a[184:187], v[184:187], a[84:87]
s_waitcnt lgkmcnt(2)
buffer_load_dwordx4 v[176:179], v15, s[44:47], s65 offen offset:1024 sc1
v_cvt_pk_bf16_f32 v212, v144, v145
v_mfma_f32_16x16x32_bf16 a[88:91], a[192:195], v[184:187], a[88:91]
s_add_u32 s65, s84, 40960
v_exp_f32 v149, v149
v_mfma_f32_16x16x32_bf16 a[88:91], a[196:199], v[188:191], a[88:91]
buffer_load_dwordx4 v[156:159], v14, s[44:47], s65 offen offset:0 sc1
v_mfma_f32_16x16x32_bf16 a[120:123], a[196:199], v[196:199], a[120:123]
ds_read_b128 a[144:147], v3 offset:0
v_cvt_pk_bf16_f32 v213, v146, v147
v_mfma_f32_16x16x32_bf16 a[120:123], a[192:195], v[192:195], a[120:123]
s_waitcnt lgkmcnt(1)
buffer_load_dwordx4 v[164:167], v14, s[44:47], s65 offen offset:1024 sc1
ds_read_b128 a[148:151], v3 offset:8192
v_exp_f32 v150, v150
v_mfma_f32_16x16x32_bf16 a[124:127], a[200:203], v[192:195], a[124:127]
ds_read_b128 a[152:155], v3 offset:1024
v_cvt_pk_bf16_f32 v214, v148, v149
v_mfma_f32_16x16x32_bf16 a[124:127], a[204:207], v[196:199], a[124:127]
buffer_load_dwordx4 v[172:175], v15, s[44:47], s65 offen offset:0 sc1
ds_read_b128 a[156:159], v3 offset:9216
v_mfma_f32_16x16x32_bf16 a[92:95], a[204:207], v[188:191], a[92:95]
v_exp_f32 v151, v151
v_mfma_f32_16x16x32_bf16 a[92:95], a[200:203], v[184:187], a[92:95]
buffer_load_dwordx4 v[180:183], v15, s[44:47], s65 offen offset:1024 sc1
ds_read_b128 a[160:163], v3 offset:2048
ds_read_b128 a[164:167], v3 offset:10240
ds_read_b128 a[168:171], v3 offset:3072
ds_read_b128 a[172:175], v3 offset:11264
v_cvt_pk_bf16_f32 v215, v150, v151
v_accvgpr_read_b32 v22, a136
v_accvgpr_read_b32 v248, a137
v_add_f32 v22, v22, v248
v_max_f32 v1, v1, v22
v_rcp_f32 v22, v22
v_accvgpr_read_b32 v232, a64
v_accvgpr_read_b32 v233, a65
v_accvgpr_read_b32 v234, a66
v_accvgpr_read_b32 v235, a67
v_accvgpr_read_b32 v236, a68
v_accvgpr_read_b32 v237, a69
v_accvgpr_read_b32 v238, a70
v_accvgpr_read_b32 v239, a71
v_mul_f32 v22, v22, v8
v_mul_f32 v232, v232, v22
v_mul_f32 v233, v233, v22
v_mul_f32 v234, v234, v22
v_mul_f32 v235, v235, v22
v_mul_f32 v236, v236, v22
v_mul_f32 v237, v237, v22
v_mul_f32 v238, v238, v22
v_mul_f32 v239, v239, v22
v_cvt_pk_bf16_f32 v232, v232, v233
v_cvt_pk_bf16_f32 v233, v234, v235
v_cvt_pk_bf16_f32 v234, v236, v237
v_cvt_pk_bf16_f32 v235, v238, v239
s_add_u32 s77, s75, 0
buffer_store_dwordx4 v[232:235], v16, s[44:47], s77 offen sc1
s_branch L_TAIL
L_fallback_11:
s_waitcnt vmcnt(0) lgkmcnt(0)
s_barrier
s_mov_b32 s73, 1
s_mov_b32 s81, 0
v_and_b32 v232, 15, v0
v_lshrrev_b32 v233, 4, v0
v_lshlrev_b32 v233, 2, v233
v_sub_u32 v232, v232, v233
s_lshl_b32 s66, s30, 4
v_add_u32 v232, s66, v232
s_lshl_b32 s66, s16, 7
v_add_u32 v234, s66, v232
s_lshl_b32 s66, s3, 7
v_add_u32 v232, s66, v232
v_add_u32 v233, 64, v232
v_add_u32 v235, 64, v234
s_mov_b32 m0, s76
s_lshl_b32 s64, s30, 14
s_nop 0
buffer_load_dwordx4 v16, s[32:35], s64 offen offset:0 sc1 lds
s_nop 0
buffer_load_dwordx4 v16, s[32:35], s64 offen offset:1024 sc1 lds
s_nop 0
buffer_load_dwordx4 v16, s[32:35], s64 offen offset:2048 sc1 lds
s_nop 0
buffer_load_dwordx4 v16, s[32:35], s64 offen offset:3072 sc1 lds
s_add_u32 m0, s76, 4096
s_add_u32 s64, s64, 4096
s_nop 0
buffer_load_dwordx4 v16, s[32:35], s64 offen offset:0 sc1 lds
s_nop 0
buffer_load_dwordx4 v16, s[32:35], s64 offen offset:1024 sc1 lds
s_nop 0
buffer_load_dwordx4 v16, s[32:35], s64 offen offset:2048 sc1 lds
s_nop 0
buffer_load_dwordx4 v16, s[32:35], s64 offen offset:3072 sc1 lds
s_lshr_b32 s64, s76, 1
s_add_u32 m0, s64, 81920
s_and_b32 s71, s64, 8192
s_add_u32 s64, s64, s71
s_add_u32 s64, s64, 8192
s_nop 0
buffer_load_dwordx4 v16, s[32:35], s64 offen offset:0 sc1 lds
s_nop 0
buffer_load_dwordx4 v16, s[32:35], s64 offen offset:1024 sc1 lds
s_nop 0
buffer_load_dwordx4 v16, s[32:35], s64 offen offset:2048 sc1 lds
s_nop 0
buffer_load_dwordx4 v16, s[32:35], s64 offen offset:3072 sc1 lds
v_mov_b32 v20, 0xff800000
v_mov_b32 v21, 0xff800000
v_mov_b32 v22, 0xff800000
v_mov_b32 v23, 0xff800000
L_fbl_1015:
buffer_load_dwordx4 a[144:147], v16, s[32:35], s81 offen offset:0 sc1
buffer_load_dwordx4 a[148:151], v16, s[32:35], s81 offen offset:1024 sc1
buffer_load_dwordx4 a[152:155], v16, s[32:35], s81 offen offset:2048 sc1
buffer_load_dwordx4 a[156:159], v16, s[32:35], s81 offen offset:3072 sc1
s_add_u32 s64, s81, 4096
buffer_load_dwordx4 a[160:163], v16, s[32:35], s64 offen offset:0 sc1
buffer_load_dwordx4 a[164:167], v16, s[32:35], s64 offen offset:1024 sc1
buffer_load_dwordx4 a[168:171], v16, s[32:35], s64 offen offset:2048 sc1
buffer_load_dwordx4 a[172:175], v16, s[32:35], s64 offen offset:3072 sc1
v_subrev_u32 v88, 0, v232
v_ashrrev_i32 v88, 31, v88
v_and_b32 v88, 0xff800000, v88
v_subrev_u32 v89, 1, v232
v_ashrrev_i32 v89, 31, v89
v_and_b32 v89, 0xff800000, v89
v_subrev_u32 v90, 2, v232
v_ashrrev_i32 v90, 31, v90
v_and_b32 v90, 0xff800000, v90
v_subrev_u32 v91, 3, v232
v_ashrrev_i32 v91, 31, v91
v_and_b32 v91, 0xff800000, v91
v_subrev_u32 v92, 16, v232
v_ashrrev_i32 v92, 31, v92
v_and_b32 v92, 0xff800000, v92
v_subrev_u32 v93, 17, v232
v_ashrrev_i32 v93, 31, v93
v_and_b32 v93, 0xff800000, v93
v_subrev_u32 v94, 18, v232
v_ashrrev_i32 v94, 31, v94
v_and_b32 v94, 0xff800000, v94
v_subrev_u32 v95, 19, v232
v_ashrrev_i32 v95, 31, v95
v_and_b32 v95, 0xff800000, v95
v_subrev_u32 v232, 32, v232
v_subrev_u32 v104, 0, v233
v_ashrrev_i32 v104, 31, v104
v_and_b32 v104, 0xff800000, v104
v_subrev_u32 v105, 1, v233
v_ashrrev_i32 v105, 31, v105
v_and_b32 v105, 0xff800000, v105
v_subrev_u32 v106, 2, v233
v_ashrrev_i32 v106, 31, v106
v_and_b32 v106, 0xff800000, v106
v_subrev_u32 v107, 3, v233
v_ashrrev_i32 v107, 31, v107
v_and_b32 v107, 0xff800000, v107
v_subrev_u32 v108, 16, v233
v_ashrrev_i32 v108, 31, v108
v_and_b32 v108, 0xff800000, v108
v_subrev_u32 v109, 17, v233
v_ashrrev_i32 v109, 31, v109
v_and_b32 v109, 0xff800000, v109
v_subrev_u32 v110, 18, v233
v_ashrrev_i32 v110, 31, v110
v_and_b32 v110, 0xff800000, v110
v_subrev_u32 v111, 19, v233
v_ashrrev_i32 v111, 31, v111
v_and_b32 v111, 0xff800000, v111
v_subrev_u32 v233, 32, v233
v_subrev_u32 v120, 0, v234
v_ashrrev_i32 v120, 31, v120
v_and_b32 v120, 0xff800000, v120
v_subrev_u32 v121, 1, v234
v_ashrrev_i32 v121, 31, v121
v_and_b32 v121, 0xff800000, v121
v_subrev_u32 v122, 2, v234
v_ashrrev_i32 v122, 31, v122
v_and_b32 v122, 0xff800000, v122
v_subrev_u32 v123, 3, v234
v_ashrrev_i32 v123, 31, v123
v_and_b32 v123, 0xff800000, v123
v_subrev_u32 v124, 16, v234
v_ashrrev_i32 v124, 31, v124
v_and_b32 v124, 0xff800000, v124
v_subrev_u32 v125, 17, v234
v_ashrrev_i32 v125, 31, v125
v_and_b32 v125, 0xff800000, v125
v_subrev_u32 v126, 18, v234
v_ashrrev_i32 v126, 31, v126
v_and_b32 v126, 0xff800000, v126
v_subrev_u32 v127, 19, v234
v_ashrrev_i32 v127, 31, v127
v_and_b32 v127, 0xff800000, v127
v_subrev_u32 v234, 32, v234
v_subrev_u32 v136, 0, v235
v_ashrrev_i32 v136, 31, v136
v_and_b32 v136, 0xff800000, v136
v_subrev_u32 v137, 1, v235
v_ashrrev_i32 v137, 31, v137
v_and_b32 v137, 0xff800000, v137
v_subrev_u32 v138, 2, v235
v_ashrrev_i32 v138, 31, v138
v_and_b32 v138, 0xff800000, v138
v_subrev_u32 v139, 3, v235
v_ashrrev_i32 v139, 31, v139
v_and_b32 v139, 0xff800000, v139
v_subrev_u32 v140, 16, v235
v_ashrrev_i32 v140, 31, v140
v_and_b32 v140, 0xff800000, v140
v_subrev_u32 v141, 17, v235
v_ashrrev_i32 v141, 31, v141
v_and_b32 v141, 0xff800000, v141
v_subrev_u32 v142, 18, v235
v_ashrrev_i32 v142, 31, v142
v_and_b32 v142, 0xff800000, v142
v_subrev_u32 v143, 19, v235
v_ashrrev_i32 v143, 31, v143
v_and_b32 v143, 0xff800000, v143
v_subrev_u32 v235, 32, v235
s_waitcnt vmcnt(0)
v_mfma_f32_16x16x32_bf16 v[88:91], a[144:147], v[24:27], v[88:91]
v_mfma_f32_16x16x32_bf16 v[104:107], a[144:147], v[40:43], v[104:107]
v_mfma_f32_16x16x32_bf16 v[120:123], a[144:147], v[56:59], v[120:123]
v_mfma_f32_16x16x32_bf16 v[136:139], a[144:147], v[72:75], v[136:139]
v_mfma_f32_16x16x32_bf16 v[88:91], a[148:151], v[28:31], v[88:91]
v_mfma_f32_16x16x32_bf16 v[104:107], a[148:151], v[44:47], v[104:107]
v_mfma_f32_16x16x32_bf16 v[120:123], a[148:151], v[60:63], v[120:123]
v_mfma_f32_16x16x32_bf16 v[136:139], a[148:151], v[76:79], v[136:139]
v_mfma_f32_16x16x32_bf16 v[88:91], a[152:155], v[32:35], v[88:91]
v_mfma_f32_16x16x32_bf16 v[104:107], a[152:155], v[48:51], v[104:107]
v_mfma_f32_16x16x32_bf16 v[120:123], a[152:155], v[64:67], v[120:123]
v_mfma_f32_16x16x32_bf16 v[136:139], a[152:155], v[80:83], v[136:139]
v_mfma_f32_16x16x32_bf16 v[88:91], a[156:159], v[36:39], v[88:91]
v_mfma_f32_16x16x32_bf16 v[104:107], a[156:159], v[52:55], v[104:107]
v_mfma_f32_16x16x32_bf16 v[120:123], a[156:159], v[68:71], v[120:123]
v_mfma_f32_16x16x32_bf16 v[136:139], a[156:159], v[84:87], v[136:139]
v_mfma_f32_16x16x32_bf16 v[92:95], a[160:163], v[24:27], v[92:95]
v_mfma_f32_16x16x32_bf16 v[108:111], a[160:163], v[40:43], v[108:111]
v_mfma_f32_16x16x32_bf16 v[124:127], a[160:163], v[56:59], v[124:127]
v_mfma_f32_16x16x32_bf16 v[140:143], a[160:163], v[72:75], v[140:143]
v_mfma_f32_16x16x32_bf16 v[92:95], a[164:167], v[28:31], v[92:95]
v_mfma_f32_16x16x32_bf16 v[108:111], a[164:167], v[44:47], v[108:111]
v_mfma_f32_16x16x32_bf16 v[124:127], a[164:167], v[60:63], v[124:127]
v_mfma_f32_16x16x32_bf16 v[140:143], a[164:167], v[76:79], v[140:143]
v_mfma_f32_16x16x32_bf16 v[92:95], a[168:171], v[32:35], v[92:95]
v_mfma_f32_16x16x32_bf16 v[108:111], a[168:171], v[48:51], v[108:111]
v_mfma_f32_16x16x32_bf16 v[124:127], a[168:171], v[64:67], v[124:127]
v_mfma_f32_16x16x32_bf16 v[140:143], a[168:171], v[80:83], v[140:143]
v_mfma_f32_16x16x32_bf16 v[92:95], a[172:175], v[36:39], v[92:95]
v_mfma_f32_16x16x32_bf16 v[108:111], a[172:175], v[52:55], v[108:111]
v_mfma_f32_16x16x32_bf16 v[124:127], a[172:175], v[68:71], v[124:127]
v_mfma_f32_16x16x32_bf16 v[140:143], a[172:175], v[84:87], v[140:143]
s_nop 7
v_max3_f32 v20, v20, v88, v89
v_max3_f32 v20, v20, v90, v91
v_max3_f32 v20, v20, v92, v93
v_max3_f32 v20, v20, v94, v95
v_max3_f32 v21, v21, v104, v105
v_max3_f32 v21, v21, v106, v107
v_max3_f32 v21, v21, v108, v109
v_max3_f32 v21, v21, v110, v111
v_max3_f32 v22, v22, v120, v121
v_max3_f32 v22, v22, v122, v123
v_max3_f32 v22, v22, v124, v125
v_max3_f32 v22, v22, v126, v127
v_max3_f32 v23, v23, v136, v137
v_max3_f32 v23, v23, v138, v139
v_max3_f32 v23, v23, v140, v141
v_max3_f32 v23, v23, v142, v143
s_add_u32 s81, s81, 16384
s_cmp_lt_u32 s81, s34
s_cbranch_scc1 L_fbl_1015
v_mov_b32 v248, v20
v_mov_b32 v249, v21
v_mov_b32 v250, v22
v_mov_b32 v251, v23
v_permlane16_swap_b32 v248, v20
v_permlane16_swap_b32 v249, v21
v_permlane16_swap_b32 v250, v22
v_permlane16_swap_b32 v251, v23
v_max_f32 v20, v20, v248
v_max_f32 v21, v21, v249
v_max_f32 v22, v22, v250
v_max_f32 v23, v23, v251
v_mov_b32 v248, v20
v_mov_b32 v249, v21
v_mov_b32 v250, v22
v_mov_b32 v251, v23
v_permlane32_swap_b32 v248, v20
v_permlane32_swap_b32 v249, v21
v_permlane32_swap_b32 v250, v22
v_permlane32_swap_b32 v251, v23
v_max_f32 v20, v20, v248
v_max_f32 v21, v21, v249
v_max_f32 v22, v22, v250
v_max_f32 v23, v23, v251
v_mov_b32 v252, v20
v_mov_b32 v253, v21
v_mov_b32 v254, v22
v_mov_b32 v255, v23
s_and_b32 s70, s30, 1
s_lshr_b32 s67, s30, 1
s_lshl3_add_u32 s71, s67, s70
s_add_u32 s71, s71, 4
s_lshl_b32 s71, s71, 13
s_lshl_b32 s70, s70, 14
s_mul_i32 s67, s67, 24576
s_sub_u32 s70, s70, s67
s_add_u32 s70, s70, 65536
v_mov_b32 v2, v16
v_add_u32 v3, 0x10000, v16
v_mov_b32 v1, 0
s_mov_b32 m0, s71
s_waitcnt lgkmcnt(0)
s_barrier
ds_read_b128 a[144:147], v2 offset:0
ds_read_b128 a[148:151], v2 offset:1024
ds_read_b128 a[152:155], v2 offset:2048
ds_read_b128 a[156:159], v2 offset:3072
ds_read_b128 a[160:163], v2 offset:4096
ds_read_b128 a[164:167], v2 offset:5120
ds_read_b128 a[168:171], v2 offset:6144
ds_read_b128 a[172:175], v2 offset:7168
buffer_load_dwordx4 v16, s[32:35], s70 offen offset:0 sc1 lds
buffer_load_dwordx4 v16, s[32:35], s70 offen offset:1024 sc1 lds
s_waitcnt vmcnt(0) lgkmcnt(0)
s_branch L_attstart_7
L_spin_2016:
s_mov_b32 vcc_hi, 0x80000
L_spinlp_2018:
s_sleep 1
buffer_load_dword v19, off, s[52:55], s72 offset:0 sc1
s_waitcnt vmcnt(0)
v_readfirstlane_b32 vcc_lo, v19
s_sub_u32 vcc_hi, vcc_hi, 1
s_cbranch_scc1 L_spinbk_2017
s_cmp_lt_u32 vcc_lo, 8
s_cbranch_scc1 L_spinlp_2018
s_branch L_spinbk_2017
L_spin_3019:
s_mov_b32 vcc_hi, 0x80000
L_spinlp_3021:
s_sleep 1
buffer_load_dword v19, off, s[52:55], s72 offset:0 sc1
s_waitcnt vmcnt(0)
v_readfirstlane_b32 vcc_lo, v19
s_sub_u32 vcc_hi, vcc_hi, 1
s_cbranch_scc1 L_spinbk_3020
s_cmp_lt_u32 vcc_lo, 8
s_cbranch_scc1 L_spinlp_3021
s_branch L_spinbk_3020
.p2align 12
L_pg24:
s_branch L_tr2
L_p5f0:
s_waitcnt lgkmcnt(10)
s_waitcnt vmcnt(28)
v_mfma_f32_16x16x32_bf16 v[136:139], a[144:147], a[232:235], 0
s_waitcnt vmcnt(24)
s_waitcnt lgkmcnt(8)
s_add_u32 m0, s86, 65536
ds_read_b64_tr_b16 a[168:169], v191 offset:32768
v_xor_b32 v192, 0x10000, v184
v_mfma_f32_16x16x32_bf16 v[136:139], a[148:151], a[236:239], v[136:139]
s_add_u32 s64, s85, 524288
ds_read_b64_tr_b16 a[170:171], v191 offset:36864
v_xor_b32 v193, 0x10000, v185
v_mfma_f32_16x16x32_bf16 v[104:107], a[148:151], a[228:231], 0
buffer_load_dwordx4 v12, s[36:39], s64 offen lds
v_mfma_f32_16x16x32_bf16 v[104:107], a[144:147], a[224:227], v[104:107]
s_add_u32 m0, s86, 66560
s_add_u32 s64, s85, 532480
ds_read_b64_tr_b16 a[172:173], v191 offset:40960
v_xor_b32 v194, 0x10000, v186
v_mfma_f32_16x16x32_bf16 v[72:75], a[144:147], a[216:219], 0
buffer_load_dwordx4 v13, s[36:39], s64 offen lds
v_mfma_f32_16x16x32_bf16 v[72:75], a[148:151], a[220:223], v[72:75]
s_add_u32 m0, s86, 67584
ds_read_b64_tr_b16 a[174:175], v191 offset:45056
v_xor_b32 v195, 0x10000, v187
v_mfma_f32_16x16x32_bf16 v[40:43], a[148:151], a[212:215], 0
s_add_u32 s64, s85, 540672
ds_read_b64_tr_b16 a[176:177], v184 offset:32768
v_xor_b32 v196, 0x10000, v188
v_mfma_f32_16x16x32_bf16 v[40:43], a[144:147], a[208:211], v[40:43]
s_waitcnt lgkmcnt(5)
buffer_load_dwordx4 v12, s[36:39], s64 offen lds
v_mfma_f32_16x16x32_bf16 v[44:47], a[152:155], a[208:211], 0
s_add_u32 m0, s86, 68608
s_add_u32 s64, s85, 548864
ds_read_b64_tr_b16 a[178:179], v184 offset:36864
v_xor_b32 v197, 0x10000, v189
v_mfma_f32_16x16x32_bf16 v[44:47], a[156:159], a[212:215], v[44:47]
buffer_load_dwordx4 v13, s[36:39], s64 offen lds
v_mfma_f32_16x16x32_bf16 v[76:79], a[156:159], a[220:223], 0
s_add_u32 m0, s86, 69632
ds_read_b64_tr_b16 a[180:181], v184 offset:40960
v_xor_b32 v198, 0x10000, v190
v_mfma_f32_16x16x32_bf16 v[76:79], a[152:155], a[216:219], v[76:79]
s_add_u32 s64, s85, 557056
ds_read_b64_tr_b16 a[182:183], v184 offset:45056
v_xor_b32 v199, 0x10000, v191
v_mfma_f32_16x16x32_bf16 v[108:111], a[152:155], a[224:227], 0
buffer_load_dwordx4 v12, s[36:39], s64 offen lds
v_mfma_f32_16x16x32_bf16 v[108:111], a[156:159], a[228:231], v[108:111]
s_add_u32 m0, s86, 70656
s_add_u32 s64, s85, 565248
ds_read_b64_tr_b16 a[184:185], v185 offset:32768
v_mfma_f32_16x16x32_bf16 v[140:143], a[156:159], a[236:239], 0
buffer_load_dwordx4 v13, s[36:39], s64 offen lds
v_mfma_f32_16x16x32_bf16 v[140:143], a[152:155], a[232:235], v[140:143]
s_add_u32 m0, s86, 71680
ds_read_b64_tr_b16 a[186:187], v185 offset:36864
v_mfma_f32_16x16x32_bf16 v[144:147], a[160:163], a[232:235], 0
s_add_u32 s64, s85, 573440
ds_read_b64_tr_b16 a[188:189], v185 offset:40960
v_mfma_f32_16x16x32_bf16 v[144:147], a[164:167], a[236:239], v[144:147]
buffer_load_dwordx4 v12, s[36:39], s64 offen lds
v_mfma_f32_16x16x32_bf16 v[112:115], a[164:167], a[228:231], 0
s_and_b32 s71, s31, 4
s_lshl_b32 s71, s71, 5
s_add_u32 m0, s86, 72704
s_add_u32 s64, s85, 581632
ds_read_b64_tr_b16 a[190:191], v185 offset:45056
v_mfma_f32_16x16x32_bf16 v[112:115], a[160:163], a[224:227], v[112:115]
s_add_u32 s71, s71, s79
buffer_load_dwordx4 v13, s[36:39], s64 offen lds
v_mfma_f32_16x16x32_bf16 v[80:83], a[160:163], a[216:219], 0
s_add_u32 s71, s71, 4096
s_add_u32 s72, s80, 4096
ds_read_b64_tr_b16 a[192:193], v186 offset:32768
v_mfma_f32_16x16x32_bf16 v[80:83], a[164:167], a[220:223], v[80:83]
s_add_u32 s65, s84, 65536
ds_read_b64_tr_b16 a[194:195], v186 offset:36864
v_mfma_f32_16x16x32_bf16 v[48:51], a[164:167], a[212:215], 0
buffer_load_dwordx4 a[0:3], v14, s[44:47], s65 offen offset:0 sc1
v_mfma_f32_16x16x32_bf16 v[48:51], a[160:163], a[208:211], v[48:51]
s_waitcnt lgkmcnt(4)
ds_read_b64_tr_b16 a[196:197], v186 offset:40960
v_mfma_f32_16x16x32_bf16 v[52:55], a[168:171], a[208:211], 0
buffer_load_dwordx4 a[8:11], v14, s[44:47], s65 offen offset:1024 sc1
v_mfma_f32_16x16x32_bf16 v[52:55], a[172:175], a[212:215], v[52:55]
ds_read_b64_tr_b16 a[198:199], v186 offset:45056
v_mfma_f32_16x16x32_bf16 v[84:87], a[172:175], a[220:223], 0
ds_read_b64_tr_b16 a[200:201], v187 offset:32768
v_mfma_f32_16x16x32_bf16 v[84:87], a[168:171], a[216:219], v[84:87]
buffer_load_dwordx4 a[16:19], v15, s[44:47], s65 offen offset:0 sc1
v_mfma_f32_16x16x32_bf16 v[116:119], a[168:171], a[224:227], 0
ds_read_b64_tr_b16 a[202:203], v187 offset:36864
v_mfma_f32_16x16x32_bf16 v[116:119], a[172:175], a[228:231], v[116:119]
buffer_load_dwordx4 a[24:27], v15, s[44:47], s65 offen offset:1024 sc1
v_mfma_f32_16x16x32_bf16 v[148:151], a[172:175], a[236:239], 0
ds_read_b64_tr_b16 a[204:205], v187 offset:40960
v_mfma_f32_16x16x32_bf16 v[148:151], a[168:171], a[232:235], v[148:151]
s_add_u32 s65, s84, 73728
ds_read_b64_tr_b16 a[206:207], v187 offset:45056
v_mfma_f32_16x16x32_bf16 v[120:123], a[176:179], a[232:235], 0
buffer_load_dwordx4 a[4:7], v14, s[44:47], s65 offen offset:0 sc1
v_mfma_f32_16x16x32_bf16 v[120:123], a[180:183], a[236:239], v[120:123]
v_mfma_f32_16x16x32_bf16 v[88:91], a[180:183], a[228:231], 0
buffer_load_dwordx4 a[12:15], v14, s[44:47], s65 offen offset:1024 sc1
v_mfma_f32_16x16x32_bf16 v[88:91], a[176:179], a[224:227], v[88:91]
v_mfma_f32_16x16x32_bf16 v[56:59], a[176:179], a[216:219], 0
v_mfma_f32_16x16x32_bf16 v[56:59], a[180:183], a[220:223], v[56:59]
buffer_load_dwordx4 a[20:23], v15, s[44:47], s65 offen offset:0 sc1
v_mfma_f32_16x16x32_bf16 v[24:27], a[180:183], a[212:215], 0
v_mfma_f32_16x16x32_bf16 v[24:27], a[176:179], a[208:211], v[24:27]
buffer_load_dwordx4 a[28:31], v15, s[44:47], s65 offen offset:1024 sc1
v_mfma_f32_16x16x32_bf16 v[28:31], a[184:187], a[208:211], 0
s_waitcnt lgkmcnt(0)
v_mfma_f32_16x16x32_bf16 v[28:31], a[188:191], a[212:215], v[28:31]
v_mfma_f32_16x16x32_bf16 v[60:63], a[188:191], a[220:223], 0
v_mfma_f32_16x16x32_bf16 v[60:63], a[184:187], a[216:219], v[60:63]
s_waitcnt vmcnt(23)
s_barrier
v_mfma_f32_16x16x32_bf16 v[92:95], a[184:187], a[224:227], 0
ds_read_b64_tr_b16 a[144:145], v196 offset:0
v_mfma_f32_16x16x32_bf16 v[92:95], a[188:191], a[228:231], v[92:95]
ds_read_b64_tr_b16 a[146:147], v196 offset:4096
v_mfma_f32_16x16x32_bf16 v[124:127], a[188:191], a[236:239], 0
s_add_u32 m0, s86, 0
ds_read_b64_tr_b16 a[148:149], v196 offset:8192
v_mfma_f32_16x16x32_bf16 v[124:127], a[184:187], a[232:235], v[124:127]
s_add_u32 s64, s85, 786432
ds_read_b64_tr_b16 a[150:151], v196 offset:12288
v_mfma_f32_16x16x32_bf16 v[128:131], a[192:195], a[232:235], 0
buffer_load_dwordx4 v12, s[36:39], s64 offen lds
v_mfma_f32_16x16x32_bf16 v[128:131], a[196:199], a[236:239], v[128:131]
s_add_u32 m0, s86, 1024
ds_read_b64_tr_b16 a[152:153], v197 offset:0
v_mfma_f32_16x16x32_bf16 v[96:99], a[196:199], a[228:231], 0
s_add_u32 s64, s85, 794624
ds_read_b64_tr_b16 a[154:155], v197 offset:4096
v_mfma_f32_16x16x32_bf16 v[96:99], a[192:195], a[224:227], v[96:99]
buffer_load_dwordx4 v13, s[36:39], s64 offen lds
v_mfma_f32_16x16x32_bf16 v[64:67], a[192:195], a[216:219], 0
s_add_u32 m0, s86, 2048
ds_read_b64_tr_b16 a[156:157], v197 offset:8192
v_mfma_f32_16x16x32_bf16 v[64:67], a[196:199], a[220:223], v[64:67]
s_add_u32 s64, s85, 802816
ds_read_b64_tr_b16 a[158:159], v197 offset:12288
v_mfma_f32_16x16x32_bf16 v[32:35], a[196:199], a[212:215], 0
buffer_load_dwordx4 v12, s[36:39], s64 offen lds
v_mfma_f32_16x16x32_bf16 v[32:35], a[192:195], a[208:211], v[32:35]
s_add_u32 m0, s86, 3072
ds_read_b64_tr_b16 a[160:161], v198 offset:0
v_mfma_f32_16x16x32_bf16 v[36:39], a[200:203], a[208:211], 0
s_add_u32 s64, s85, 811008
ds_read_b64_tr_b16 a[162:163], v198 offset:4096
v_mfma_f32_16x16x32_bf16 v[36:39], a[204:207], a[212:215], v[36:39]
buffer_load_dwordx4 v13, s[36:39], s64 offen lds
v_mfma_f32_16x16x32_bf16 v[68:71], a[204:207], a[220:223], 0
s_add_u32 m0, s86, 4096
ds_read_b64_tr_b16 a[164:165], v198 offset:8192
v_mfma_f32_16x16x32_bf16 v[68:71], a[200:203], a[216:219], v[68:71]
s_add_u32 s64, s85, 819200
ds_read_b64_tr_b16 a[166:167], v198 offset:12288
v_mfma_f32_16x16x32_bf16 v[100:103], a[200:203], a[224:227], 0
buffer_load_dwordx4 v12, s[36:39], s64 offen lds
v_mfma_f32_16x16x32_bf16 v[100:103], a[204:207], a[228:231], v[100:103]
v_mfma_f32_16x16x32_bf16 v[132:135], a[204:207], a[236:239], 0
v_mfma_f32_16x16x32_bf16 v[132:135], a[200:203], a[232:235], v[132:135]
s_waitcnt lgkmcnt(3)
v_mfma_f32_16x16x32_bf16 v[136:139], a[144:147], v[176:179], v[136:139]
s_add_u32 m0, s86, 5120
ds_read_b64_tr_b16 a[168:169], v199 offset:0
v_xor_b32 v200, 0x18000, v184
v_mfma_f32_16x16x32_bf16 v[136:139], a[148:151], v[180:183], v[136:139]
s_add_u32 s64, s85, 827392
ds_read_b64_tr_b16 a[170:171], v199 offset:4096
v_xor_b32 v201, 0x18000, v185
v_mfma_f32_16x16x32_bf16 v[104:107], a[148:151], v[172:175], v[104:107]
buffer_load_dwordx4 v13, s[36:39], s64 offen lds
v_mfma_f32_16x16x32_bf16 v[104:107], a[144:147], v[168:171], v[104:107]
s_add_u32 m0, s86, 6144
ds_read_b64_tr_b16 a[172:173], v199 offset:8192
v_xor_b32 v202, 0x18000, v186
v_mfma_f32_16x16x32_bf16 v[72:75], a[144:147], v[160:163], v[72:75]
s_add_u32 s64, s85, 835584
ds_read_b64_tr_b16 a[174:175], v199 offset:12288
v_xor_b32 v203, 0x18000, v187
v_mfma_f32_16x16x32_bf16 v[72:75], a[148:151], v[164:167], v[72:75]
buffer_load_dwordx4 v12, s[36:39], s64 offen lds
v_mfma_f32_16x16x32_bf16 v[40:43], a[148:151], v[156:159], v[40:43]
ds_read_b64_tr_b16 a[176:177], v192 offset:0
v_xor_b32 v204, 0x18000, v188
v_mfma_f32_16x16x32_bf16 v[40:43], a[144:147], v[152:155], v[40:43]
s_add_u32 m0, s86, 7168
ds_read_b64_tr_b16 a[178:179], v192 offset:4096
v_xor_b32 v205, 0x18000, v189
v_mfma_f32_16x16x32_bf16 v[44:47], a[152:155], v[152:155], v[44:47]
s_add_u32 s64, s85, 843776
ds_read_b64_tr_b16 a[180:181], v192 offset:8192
v_xor_b32 v206, 0x18000, v190
v_mfma_f32_16x16x32_bf16 v[44:47], a[156:159], v[156:159], v[44:47]
buffer_load_dwordx4 v13, s[36:39], s64 offen lds
v_mfma_f32_16x16x32_bf16 v[76:79], a[156:159], v[164:167], v[76:79]
ds_read_b64_tr_b16 a[182:183], v192 offset:12288
v_xor_b32 v207, 0x18000, v191
v_mfma_f32_16x16x32_bf16 v[76:79], a[152:155], v[160:163], v[76:79]
s_add_u32 s65, s84, 98304
ds_read_b64_tr_b16 a[184:185], v193 offset:0
v_mfma_f32_16x16x32_bf16 v[108:111], a[152:155], v[168:171], v[108:111]
buffer_load_dwordx4 a[64:67], v14, s[44:47], s65 offen offset:0 sc1
v_mfma_f32_16x16x32_bf16 v[108:111], a[156:159], v[172:175], v[108:111]
ds_read_b64_tr_b16 a[186:187], v193 offset:4096
v_mfma_f32_16x16x32_bf16 v[140:143], a[156:159], v[180:183], v[140:143]
ds_read_b64_tr_b16 a[188:189], v193 offset:8192
v_mfma_f32_16x16x32_bf16 v[140:143], a[152:155], v[176:179], v[140:143]
s_waitcnt lgkmcnt(5)
ds_read_b64_tr_b16 a[190:191], v193 offset:12288
v_mfma_f32_16x16x32_bf16 v[144:147], a[160:163], v[176:179], v[144:147]
buffer_load_dwordx4 a[72:75], v14, s[44:47], s65 offen offset:1024 sc1
v_mfma_f32_16x16x32_bf16 v[144:147], a[164:167], v[180:183], v[144:147]
v_mfma_f32_16x16x32_bf16 v[112:115], a[164:167], v[172:175], v[112:115]
ds_read_b64_tr_b16 a[192:193], v194 offset:0
v_mfma_f32_16x16x32_bf16 v[112:115], a[160:163], v[168:171], v[112:115]
ds_read_b64_tr_b16 a[194:195], v194 offset:4096
v_mfma_f32_16x16x32_bf16 v[80:83], a[160:163], v[160:163], v[80:83]
buffer_load_dwordx4 a[80:83], v15, s[44:47], s65 offen offset:0 sc1
v_mfma_f32_16x16x32_bf16 v[80:83], a[164:167], v[164:167], v[80:83]
ds_read_b64_tr_b16 a[196:197], v194 offset:8192
v_mfma_f32_16x16x32_bf16 v[48:51], a[164:167], v[156:159], v[48:51]
ds_read_b64_tr_b16 a[198:199], v194 offset:12288
v_mfma_f32_16x16x32_bf16 v[48:51], a[160:163], v[152:155], v[48:51]
buffer_load_dwordx4 a[88:91], v15, s[44:47], s65 offen offset:1024 sc1
v_mfma_f32_16x16x32_bf16 v[52:55], a[168:171], v[152:155], v[52:55]
v_mfma_f32_16x16x32_bf16 v[52:55], a[172:175], v[156:159], v[52:55]
v_mfma_f32_16x16x32_bf16 v[84:87], a[172:175], v[164:167], v[84:87]
s_add_u32 s65, s84, 106496
ds_read_b64_tr_b16 a[200:201], v195 offset:0
v_mfma_f32_16x16x32_bf16 v[84:87], a[168:171], v[160:163], v[84:87]
buffer_load_dwordx4 a[68:71], v14, s[44:47], s65 offen offset:0 sc1
v_mfma_f32_16x16x32_bf16 v[116:119], a[168:171], v[168:171], v[116:119]
ds_read_b64_tr_b16 a[202:203], v195 offset:4096
v_mfma_f32_16x16x32_bf16 v[116:119], a[172:175], v[172:175], v[116:119]
ds_read_b64_tr_b16 a[204:205], v195 offset:8192
v_mfma_f32_16x16x32_bf16 v[148:151], a[172:175], v[180:183], v[148:151]
ds_read_b64_tr_b16 a[206:207], v195 offset:12288
v_mfma_f32_16x16x32_bf16 v[148:151], a[168:171], v[176:179], v[148:151]
s_lshl_b32 s66, s30, 30
buffer_load_dwordx4 a[76:79], v14, s[44:47], s65 offen offset:1024 sc1
v_mfma_f32_16x16x32_bf16 v[120:123], a[176:179], v[176:179], v[120:123]
s_waitcnt lgkmcnt(4)
v_lshl_add_u32 v1, v0, 24, s66
v_mfma_f32_16x16x32_bf16 v[120:123], a[180:183], v[180:183], v[120:123]
v_mfma_f32_16x16x32_bf16 v[88:91], a[180:183], v[172:175], v[88:91]
buffer_load_dwordx4 a[84:87], v15, s[44:47], s65 offen offset:0 sc1
v_mfma_f32_16x16x32_bf16 v[88:91], a[176:179], v[168:171], v[88:91]
v_mfma_f32_16x16x32_bf16 v[56:59], a[176:179], v[160:163], v[56:59]
v_mfma_f32_16x16x32_bf16 v[56:59], a[180:183], v[164:167], v[56:59]
v_mfma_f32_16x16x32_bf16 v[24:27], a[180:183], v[156:159], v[24:27]
buffer_load_dwordx4 a[92:95], v15, s[44:47], s65 offen offset:1024 sc1
v_mfma_f32_16x16x32_bf16 v[24:27], a[176:179], v[152:155], v[24:27]
v_mfma_f32_16x16x32_bf16 v[28:31], a[184:187], v[152:155], v[28:31]
v_mfma_f32_16x16x32_bf16 v[28:31], a[188:191], v[156:159], v[28:31]
v_mfma_f32_16x16x32_bf16 v[60:63], a[188:191], v[164:167], v[60:63]
v_mfma_f32_16x16x32_bf16 v[60:63], a[184:187], v[160:163], v[60:63]
s_waitcnt vmcnt(24)
s_barrier
v_mfma_f32_16x16x32_bf16 v[92:95], a[184:187], v[168:171], v[92:95]
s_mov_b64 exec, 1
buffer_atomic_add a251, v1, s[52:55], s71 offen offset:0 sc1
s_mov_b64 exec, -1
v_mfma_f32_16x16x32_bf16 v[92:95], a[188:191], v[172:175], v[92:95]
ds_read_b64_tr_b16 a[144:145], v196 offset:32768
v_mfma_f32_16x16x32_bf16 v[124:127], a[188:191], v[180:183], v[124:127]
s_add_u32 m0, s86, 98304
ds_read_b64_tr_b16 a[146:147], v196 offset:36864
v_mfma_f32_16x16x32_bf16 v[124:127], a[184:187], v[176:179], v[124:127]
s_add_u32 s64, s85, 1048576
ds_read_b64_tr_b16 a[148:149], v196 offset:40960
v_mfma_f32_16x16x32_bf16 v[128:131], a[192:195], v[176:179], v[128:131]
buffer_load_dwordx4 v12, s[36:39], s64 offen lds
v_mfma_f32_16x16x32_bf16 v[128:131], a[196:199], v[180:183], v[128:131]
s_add_u32 m0, s86, 99328
ds_read_b64_tr_b16 a[150:151], v196 offset:45056
v_mfma_f32_16x16x32_bf16 v[96:99], a[196:199], v[172:175], v[96:99]
s_add_u32 s64, s85, 1056768
ds_read_b64_tr_b16 a[152:153], v197 offset:32768
v_mfma_f32_16x16x32_bf16 v[96:99], a[192:195], v[168:171], v[96:99]
buffer_load_dwordx4 v13, s[36:39], s64 offen lds
v_mfma_f32_16x16x32_bf16 v[64:67], a[192:195], v[160:163], v[64:67]
s_add_u32 m0, s86, 100352
ds_read_b64_tr_b16 a[154:155], v197 offset:36864
v_mfma_f32_16x16x32_bf16 v[64:67], a[196:199], v[164:167], v[64:67]
s_add_u32 s64, s85, 1064960
ds_read_b64_tr_b16 a[156:157], v197 offset:40960
v_mfma_f32_16x16x32_bf16 v[32:35], a[196:199], v[156:159], v[32:35]
buffer_load_dwordx4 v12, s[36:39], s64 offen lds
v_mfma_f32_16x16x32_bf16 v[32:35], a[192:195], v[152:155], v[32:35]
s_waitcnt lgkmcnt(4)
s_add_u32 m0, s86, 101376
ds_read_b64_tr_b16 a[158:159], v197 offset:45056
v_mfma_f32_16x16x32_bf16 v[36:39], a[200:203], v[152:155], v[36:39]
s_add_u32 s64, s85, 1073152
ds_read_b64_tr_b16 a[160:161], v198 offset:32768
v_mfma_f32_16x16x32_bf16 v[36:39], a[204:207], v[156:159], v[36:39]
buffer_load_dwordx4 v13, s[36:39], s64 offen lds
v_mfma_f32_16x16x32_bf16 v[68:71], a[204:207], v[164:167], v[68:71]
s_add_u32 m0, s86, 102400
ds_read_b64_tr_b16 a[162:163], v198 offset:36864
v_mfma_f32_16x16x32_bf16 v[68:71], a[200:203], v[160:163], v[68:71]
s_add_u32 s64, s85, 1081344
ds_read_b64_tr_b16 a[164:165], v198 offset:40960
v_mfma_f32_16x16x32_bf16 v[100:103], a[200:203], v[168:171], v[100:103]
buffer_load_dwordx4 v12, s[36:39], s64 offen lds
v_mfma_f32_16x16x32_bf16 v[100:103], a[204:207], v[172:175], v[100:103]
ds_read_b64_tr_b16 a[166:167], v198 offset:45056
v_mfma_f32_16x16x32_bf16 v[132:135], a[204:207], v[180:183], v[132:135]
v_mfma_f32_16x16x32_bf16 v[132:135], a[200:203], v[176:179], v[132:135]
s_waitcnt vmcnt(26)
v_mfma_f32_16x16x32_bf16 v[136:139], a[144:147], a[24:27], v[136:139]
s_waitcnt vmcnt(22)
s_waitcnt lgkmcnt(3)
s_add_u32 m0, s86, 103424
ds_read_b64_tr_b16 a[168:169], v199 offset:32768
v_mfma_f32_16x16x32_bf16 v[136:139], a[148:151], a[28:31], v[136:139]
s_add_u32 s64, s85, 1089536
ds_read_b64_tr_b16 a[170:171], v199 offset:36864
v_mfma_f32_16x16x32_bf16 v[104:107], a[148:151], a[20:23], v[104:107]
buffer_load_dwordx4 v13, s[36:39], s64 offen lds
v_mfma_f32_16x16x32_bf16 v[104:107], a[144:147], a[16:19], v[104:107]
s_add_u32 m0, s86, 104448
ds_read_b64_tr_b16 a[172:173], v199 offset:40960
v_mfma_f32_16x16x32_bf16 v[72:75], a[144:147], a[8:11], v[72:75]
s_add_u32 s64, s85, 1097728
ds_read_b64_tr_b16 a[174:175], v199 offset:45056
v_mfma_f32_16x16x32_bf16 v[72:75], a[148:151], a[12:15], v[72:75]
buffer_load_dwordx4 v12, s[36:39], s64 offen lds
v_mfma_f32_16x16x32_bf16 v[40:43], a[148:151], a[4:7], v[40:43]
ds_read_b64_tr_b16 a[176:177], v192 offset:32768
v_mfma_f32_16x16x32_bf16 v[40:43], a[144:147], a[0:3], v[40:43]
s_add_u32 m0, s86, 105472
ds_read_b64_tr_b16 a[178:179], v192 offset:36864
v_mfma_f32_16x16x32_bf16 v[44:47], a[152:155], a[0:3], v[44:47]
s_add_u32 s64, s85, 1105920
ds_read_b64_tr_b16 a[180:181], v192 offset:40960
v_mfma_f32_16x16x32_bf16 v[44:47], a[156:159], a[4:7], v[44:47]
buffer_load_dwordx4 v13, s[36:39], s64 offen lds
v_mfma_f32_16x16x32_bf16 v[76:79], a[156:159], a[12:15], v[76:79]
ds_read_b64_tr_b16 a[182:183], v192 offset:45056
v_mfma_f32_16x16x32_bf16 v[76:79], a[152:155], a[8:11], v[76:79]
s_add_u32 s65, s84, 131072
ds_read_b64_tr_b16 a[184:185], v193 offset:32768
v_mfma_f32_16x16x32_bf16 v[108:111], a[152:155], a[16:19], v[108:111]
buffer_load_dwordx4 a[32:35], v14, s[44:47], s65 offen offset:0 sc1
v_mfma_f32_16x16x32_bf16 v[108:111], a[156:159], a[20:23], v[108:111]
ds_read_b64_tr_b16 a[186:187], v193 offset:36864
v_mfma_f32_16x16x32_bf16 v[140:143], a[156:159], a[28:31], v[140:143]
ds_read_b64_tr_b16 a[188:189], v193 offset:40960
v_mfma_f32_16x16x32_bf16 v[140:143], a[152:155], a[24:27], v[140:143]
s_waitcnt lgkmcnt(5)
ds_read_b64_tr_b16 a[190:191], v193 offset:45056
v_mfma_f32_16x16x32_bf16 v[144:147], a[160:163], a[24:27], v[144:147]
s_and_b32 s68, s82, 3
buffer_load_dwordx4 a[40:43], v14, s[44:47], s65 offen offset:1024 sc1
v_mfma_f32_16x16x32_bf16 v[144:147], a[164:167], a[28:31], v[144:147]
s_lshl_b32 s68, s68, 11
s_add_u32 s76, s86, s68
s_lshr_b32 s69, s87, 8
v_mfma_f32_16x16x32_bf16 v[112:115], a[164:167], a[20:23], v[112:115]
s_lshr_b32 s67, s82, 1
s_xor_b32 s69, s69, s67
ds_read_b64_tr_b16 a[192:193], v194 offset:32768
v_mfma_f32_16x16x32_bf16 v[112:115], a[160:163], a[16:19], v[112:115]
s_and_b32 s69, s69, 2
s_lshl_b32 s69, s69, 15
ds_read_b64_tr_b16 a[194:195], v194 offset:36864
v_mfma_f32_16x16x32_bf16 v[80:83], a[160:163], a[8:11], v[80:83]
s_add_u32 s68, s68, s69
buffer_load_dwordx4 a[48:51], v15, s[44:47], s65 offen offset:0 sc1
v_mfma_f32_16x16x32_bf16 v[80:83], a[164:167], a[12:15], v[80:83]
ds_read_b64_tr_b16 a[196:197], v194 offset:40960
v_mfma_f32_16x16x32_bf16 v[48:51], a[164:167], a[4:7], v[48:51]
ds_read_b64_tr_b16 a[198:199], v194 offset:45056
v_mfma_f32_16x16x32_bf16 v[48:51], a[160:163], a[0:3], v[48:51]
buffer_load_dwordx4 a[56:59], v15, s[44:47], s65 offen offset:1024 sc1
v_mfma_f32_16x16x32_bf16 v[52:55], a[168:171], a[0:3], v[52:55]
v_mfma_f32_16x16x32_bf16 v[52:55], a[172:175], a[4:7], v[52:55]
v_mfma_f32_16x16x32_bf16 v[84:87], a[172:175], a[12:15], v[84:87]
s_add_u32 s65, s84, 139264
ds_read_b64_tr_b16 a[200:201], v195 offset:32768
v_mfma_f32_16x16x32_bf16 v[84:87], a[168:171], a[8:11], v[84:87]
buffer_load_dwordx4 a[36:39], v14, s[44:47], s65 offen offset:0 sc1
v_mfma_f32_16x16x32_bf16 v[116:119], a[168:171], a[16:19], v[116:119]
ds_read_b64_tr_b16 a[202:203], v195 offset:36864
v_mfma_f32_16x16x32_bf16 v[116:119], a[172:175], a[20:23], v[116:119]
ds_read_b64_tr_b16 a[204:205], v195 offset:40960
v_mfma_f32_16x16x32_bf16 v[148:151], a[172:175], a[28:31], v[148:151]
ds_read_b64_tr_b16 a[206:207], v195 offset:45056
v_mfma_f32_16x16x32_bf16 v[148:151], a[168:171], a[24:27], v[148:151]
buffer_load_dwordx4 a[44:47], v14, s[44:47], s65 offen offset:1024 sc1
v_mfma_f32_16x16x32_bf16 v[120:123], a[176:179], a[24:27], v[120:123]
s_waitcnt lgkmcnt(4)
v_mfma_f32_16x16x32_bf16 v[120:123], a[180:183], a[28:31], v[120:123]
v_mfma_f32_16x16x32_bf16 v[88:91], a[180:183], a[20:23], v[88:91]
buffer_load_dwordx4 a[52:55], v15, s[44:47], s65 offen offset:0 sc1
v_mfma_f32_16x16x32_bf16 v[88:91], a[176:179], a[16:19], v[88:91]
v_mfma_f32_16x16x32_bf16 v[56:59], a[176:179], a[8:11], v[56:59]
v_mfma_f32_16x16x32_bf16 v[56:59], a[180:183], a[12:15], v[56:59]
v_mfma_f32_16x16x32_bf16 v[24:27], a[180:183], a[4:7], v[24:27]
buffer_load_dwordx4 a[60:63], v15, s[44:47], s65 offen offset:1024 sc1
v_mfma_f32_16x16x32_bf16 v[24:27], a[176:179], a[0:3], v[24:27]
v_mfma_f32_16x16x32_bf16 v[28:31], a[184:187], a[0:3], v[28:31]
v_mfma_f32_16x16x32_bf16 v[28:31], a[188:191], a[4:7], v[28:31]
v_mfma_f32_16x16x32_bf16 v[60:63], a[188:191], a[12:15], v[60:63]
s_lshl3_add_u32 s85, s68, s85
v_mfma_f32_16x16x32_bf16 v[60:63], a[184:187], a[8:11], v[60:63]
s_waitcnt vmcnt(25)
s_barrier
v_mfma_f32_16x16x32_bf16 v[92:95], a[184:187], a[16:19], v[92:95]
ds_read_b64_tr_b16 a[144:145], v204 offset:0
v_mfma_f32_16x16x32_bf16 v[92:95], a[188:191], a[20:23], v[92:95]
ds_read_b64_tr_b16 a[146:147], v204 offset:4096
v_mfma_f32_16x16x32_bf16 v[124:127], a[188:191], a[28:31], v[124:127]
s_xor_b32 m0, s76, 131072
ds_read_b64_tr_b16 a[148:149], v204 offset:8192
v_mfma_f32_16x16x32_bf16 v[124:127], a[184:187], a[24:27], v[124:127]
s_xor_b32 s64, s85, 0
ds_read_b64_tr_b16 a[150:151], v204 offset:12288
v_mfma_f32_16x16x32_bf16 v[128:131], a[192:195], a[24:27], v[128:131]
buffer_load_dwordx4 v12, s[40:43], s64 offen lds
v_mfma_f32_16x16x32_bf16 v[128:131], a[196:199], a[28:31], v[128:131]
s_xor_b32 m0, s76, 132096
ds_read_b64_tr_b16 a[152:153], v205 offset:0
v_mfma_f32_16x16x32_bf16 v[96:99], a[196:199], a[20:23], v[96:99]
s_xor_b32 s64, s85, 8192
ds_read_b64_tr_b16 a[154:155], v205 offset:4096
v_mfma_f32_16x16x32_bf16 v[96:99], a[192:195], a[16:19], v[96:99]
buffer_load_dwordx4 v13, s[40:43], s64 offen lds
v_mfma_f32_16x16x32_bf16 v[64:67], a[192:195], a[8:11], v[64:67]
s_xor_b32 m0, s76, 133120
ds_read_b64_tr_b16 a[156:157], v205 offset:8192
v_mfma_f32_16x16x32_bf16 v[64:67], a[196:199], a[12:15], v[64:67]
s_xor_b32 s64, s85, 16384
ds_read_b64_tr_b16 a[158:159], v205 offset:12288
v_mfma_f32_16x16x32_bf16 v[32:35], a[196:199], a[4:7], v[32:35]
buffer_load_dwordx4 v12, s[40:43], s64 offen lds
v_mfma_f32_16x16x32_bf16 v[32:35], a[192:195], a[0:3], v[32:35]
s_waitcnt lgkmcnt(4)
s_xor_b32 m0, s76, 134144
ds_read_b64_tr_b16 a[160:161], v206 offset:0
v_mfma_f32_16x16x32_bf16 v[36:39], a[200:203], a[0:3], v[36:39]
s_xor_b32 s64, s85, 24576
ds_read_b64_tr_b16 a[162:163], v206 offset:4096
v_mfma_f32_16x16x32_bf16 v[36:39], a[204:207], a[4:7], v[36:39]
buffer_load_dwordx4 v13, s[40:43], s64 offen lds
v_mfma_f32_16x16x32_bf16 v[68:71], a[204:207], a[12:15], v[68:71]
s_xor_b32 m0, s76, 135168
ds_read_b64_tr_b16 a[164:165], v206 offset:8192
v_mfma_f32_16x16x32_bf16 v[68:71], a[200:203], a[8:11], v[68:71]
s_xor_b32 s64, s85, 32768
ds_read_b64_tr_b16 a[166:167], v206 offset:12288
v_mfma_f32_16x16x32_bf16 v[100:103], a[200:203], a[16:19], v[100:103]
buffer_load_dwordx4 v12, s[40:43], s64 offen lds
v_mfma_f32_16x16x32_bf16 v[100:103], a[204:207], a[20:23], v[100:103]
v_mfma_f32_16x16x32_bf16 v[132:135], a[204:207], a[28:31], v[132:135]
v_mfma_f32_16x16x32_bf16 v[132:135], a[200:203], a[24:27], v[132:135]
s_waitcnt vmcnt(26)
v_mfma_f32_16x16x32_bf16 v[136:139], a[144:147], a[88:91], v[136:139]
s_waitcnt vmcnt(22)
s_xor_b32 m0, s76, 136192
ds_read_b64_tr_b16 a[168:169], v207 offset:0
v_mfma_f32_16x16x32_bf16 v[136:139], a[148:151], a[92:95], v[136:139]
s_xor_b32 s64, s85, 40960
ds_read_b64_tr_b16 a[170:171], v207 offset:4096
v_mfma_f32_16x16x32_bf16 v[104:107], a[148:151], a[84:87], v[104:107]
buffer_load_dwordx4 v13, s[40:43], s64 offen lds
v_mfma_f32_16x16x32_bf16 v[104:107], a[144:147], a[80:83], v[104:107]
ds_read_b64_tr_b16 a[172:173], v207 offset:8192
v_mfma_f32_16x16x32_bf16 v[72:75], a[144:147], a[72:75], v[72:75]
ds_read_b64_tr_b16 a[174:175], v207 offset:12288
v_mfma_f32_16x16x32_bf16 v[72:75], a[148:151], a[76:79], v[72:75]
ds_read_b64_tr_b16 a[176:177], v200 offset:0
v_mfma_f32_16x16x32_bf16 v[40:43], a[148:151], a[68:71], v[40:43]
ds_read_b64_tr_b16 a[178:179], v200 offset:4096
v_mfma_f32_16x16x32_bf16 v[40:43], a[144:147], a[64:67], v[40:43]
s_waitcnt lgkmcnt(6)
ds_read_b64_tr_b16 a[180:181], v200 offset:8192
v_mfma_f32_16x16x32_bf16 v[44:47], a[152:155], a[64:67], v[44:47]
s_xor_b32 m0, s76, 137216
ds_read_b64_tr_b16 a[182:183], v200 offset:12288
v_mfma_f32_16x16x32_bf16 v[44:47], a[156:159], a[68:71], v[44:47]
s_xor_b32 s64, s85, 49152
v_mfma_f32_16x16x32_bf16 v[76:79], a[156:159], a[76:79], v[76:79]
buffer_load_dwordx4 v12, s[40:43], s64 offen lds
v_mfma_f32_16x16x32_bf16 v[76:79], a[152:155], a[72:75], v[76:79]
ds_read_b64_tr_b16 a[184:185], v201 offset:0
v_mfma_f32_16x16x32_bf16 v[108:111], a[152:155], a[80:83], v[108:111]
ds_read_b64_tr_b16 a[186:187], v201 offset:4096
v_mfma_f32_16x16x32_bf16 v[108:111], a[156:159], a[84:87], v[108:111]
ds_read_b64_tr_b16 a[188:189], v201 offset:8192
v_mfma_f32_16x16x32_bf16 v[140:143], a[156:159], a[92:95], v[140:143]
ds_read_b64_tr_b16 a[190:191], v201 offset:12288
v_mfma_f32_16x16x32_bf16 v[140:143], a[152:155], a[88:91], v[140:143]
v_mfma_f32_16x16x32_bf16 v[144:147], a[160:163], a[88:91], v[144:147]
v_mfma_f32_16x16x32_bf16 v[144:147], a[164:167], a[92:95], v[144:147]
s_xor_b32 m0, s76, 138240
v_mfma_f32_16x16x32_bf16 v[112:115], a[164:167], a[84:87], v[112:115]
s_xor_b32 s64, s85, 57344
ds_read_b64_tr_b16 a[192:193], v202 offset:0
v_mfma_f32_16x16x32_bf16 v[112:115], a[160:163], a[80:83], v[112:115]
buffer_load_dwordx4 v13, s[40:43], s64 offen lds
v_mfma_f32_16x16x32_bf16 v[80:83], a[160:163], a[72:75], v[80:83]
ds_read_b64_tr_b16 a[194:195], v202 offset:4096
v_mfma_f32_16x16x32_bf16 v[80:83], a[164:167], a[76:79], v[80:83]
ds_read_b64_tr_b16 a[196:197], v202 offset:8192
v_mfma_f32_16x16x32_bf16 v[48:51], a[164:167], a[68:71], v[48:51]
ds_read_b64_tr_b16 a[198:199], v202 offset:12288
v_mfma_f32_16x16x32_bf16 v[48:51], a[160:163], a[64:67], v[48:51]
s_waitcnt lgkmcnt(4)
v_mfma_f32_16x16x32_bf16 v[52:55], a[168:171], a[64:67], v[52:55]
v_mfma_f32_16x16x32_bf16 v[52:55], a[172:175], a[68:71], v[52:55]
v_mfma_f32_16x16x32_bf16 v[84:87], a[172:175], a[76:79], v[84:87]
ds_read_b64_tr_b16 a[200:201], v203 offset:0
v_mfma_f32_16x16x32_bf16 v[84:87], a[168:171], a[72:75], v[84:87]
ds_read_b64_tr_b16 a[202:203], v203 offset:4096
v_mfma_f32_16x16x32_bf16 v[116:119], a[168:171], a[80:83], v[116:119]
ds_read_b64_tr_b16 a[204:205], v203 offset:8192
v_mfma_f32_16x16x32_bf16 v[116:119], a[172:175], a[84:87], v[116:119]
ds_read_b64_tr_b16 a[206:207], v203 offset:12288
v_mfma_f32_16x16x32_bf16 v[148:151], a[172:175], a[92:95], v[148:151]
buffer_load_dword v19, off, s[52:55], s72 sc1
v_mfma_f32_16x16x32_bf16 v[148:151], a[168:171], a[88:91], v[148:151]
v_mfma_f32_16x16x32_bf16 v[120:123], a[176:179], a[88:91], v[120:123]
v_mfma_f32_16x16x32_bf16 v[120:123], a[180:183], a[92:95], v[120:123]
v_mfma_f32_16x16x32_bf16 v[88:91], a[180:183], a[84:87], v[88:91]
v_mfma_f32_16x16x32_bf16 v[88:91], a[176:179], a[80:83], v[88:91]
s_branch L_po25
L_pg25:
s_branch L_tr2
L_po25:
v_mfma_f32_16x16x32_bf16 v[56:59], a[176:179], a[72:75], v[56:59]
v_mfma_f32_16x16x32_bf16 v[56:59], a[180:183], a[76:79], v[56:59]
v_mfma_f32_16x16x32_bf16 v[24:27], a[180:183], a[68:71], v[24:27]
v_mfma_f32_16x16x32_bf16 v[24:27], a[176:179], a[64:67], v[24:27]
v_mfma_f32_16x16x32_bf16 v[28:31], a[184:187], a[64:67], v[28:31]
v_mfma_f32_16x16x32_bf16 v[28:31], a[188:191], a[68:71], v[28:31]
v_mfma_f32_16x16x32_bf16 v[60:63], a[188:191], a[76:79], v[60:63]
v_mfma_f32_16x16x32_bf16 v[60:63], a[184:187], a[72:75], v[60:63]
s_waitcnt vmcnt(17)
s_barrier
v_mfma_f32_16x16x32_bf16 v[92:95], a[184:187], a[80:83], v[92:95]
ds_read_b64_tr_b16 a[144:145], v188 offset:0
v_mfma_f32_16x16x32_bf16 v[92:95], a[188:191], a[84:87], v[92:95]
ds_read_b64_tr_b16 a[146:147], v188 offset:4096
v_mfma_f32_16x16x32_bf16 v[124:127], a[188:191], a[92:95], v[124:127]
s_xor_b32 m0, s76, 32768
ds_read_b64_tr_b16 a[148:149], v188 offset:8192
v_mfma_f32_16x16x32_bf16 v[124:127], a[184:187], a[88:91], v[124:127]
s_waitcnt lgkmcnt(3)
s_xor_b32 s64, s85, 262144
ds_read_b64_tr_b16 a[150:151], v188 offset:12288
v_mfma_f32_16x16x32_bf16 v[128:131], a[192:195], a[88:91], v[128:131]
buffer_load_dwordx4 v12, s[40:43], s64 offen lds
v_mfma_f32_16x16x32_bf16 v[128:131], a[196:199], a[92:95], v[128:131]
s_xor_b32 m0, s76, 33792
s_xor_b32 s64, s85, 270336
ds_read_b64_tr_b16 a[152:153], v189 offset:0
v_mfma_f32_16x16x32_bf16 v[96:99], a[196:199], a[84:87], v[96:99]
buffer_load_dwordx4 v13, s[40:43], s64 offen lds
v_mfma_f32_16x16x32_bf16 v[96:99], a[192:195], a[80:83], v[96:99]
s_xor_b32 m0, s76, 34816
ds_read_b64_tr_b16 a[154:155], v189 offset:4096
v_mfma_f32_16x16x32_bf16 v[64:67], a[192:195], a[72:75], v[64:67]
s_xor_b32 s64, s85, 278528
ds_read_b64_tr_b16 a[156:157], v189 offset:8192
v_mfma_f32_16x16x32_bf16 v[64:67], a[196:199], a[76:79], v[64:67]
buffer_load_dwordx4 v12, s[40:43], s64 offen lds
v_mfma_f32_16x16x32_bf16 v[32:35], a[196:199], a[68:71], v[32:35]
s_xor_b32 m0, s76, 35840
ds_read_b64_tr_b16 a[158:159], v189 offset:12288
v_mfma_f32_16x16x32_bf16 v[32:35], a[192:195], a[64:67], v[32:35]
s_xor_b32 s64, s85, 286720
ds_read_b64_tr_b16 a[160:161], v190 offset:0
v_mfma_f32_16x16x32_bf16 v[36:39], a[200:203], a[64:67], v[36:39]
buffer_load_dwordx4 v13, s[40:43], s64 offen lds
v_mfma_f32_16x16x32_bf16 v[36:39], a[204:207], a[68:71], v[36:39]
s_xor_b32 m0, s76, 36864
s_xor_b32 s64, s85, 294912
ds_read_b64_tr_b16 a[162:163], v190 offset:4096
v_mfma_f32_16x16x32_bf16 v[68:71], a[204:207], a[76:79], v[68:71]
buffer_load_dwordx4 v12, s[40:43], s64 offen lds
v_mfma_f32_16x16x32_bf16 v[68:71], a[200:203], a[72:75], v[68:71]
s_xor_b32 m0, s76, 37888
ds_read_b64_tr_b16 a[164:165], v190 offset:8192
v_mfma_f32_16x16x32_bf16 v[100:103], a[200:203], a[80:83], v[100:103]
s_xor_b32 s64, s85, 303104
ds_read_b64_tr_b16 a[166:167], v190 offset:12288
v_mfma_f32_16x16x32_bf16 v[100:103], a[204:207], a[84:87], v[100:103]
buffer_load_dwordx4 v13, s[40:43], s64 offen lds
v_mfma_f32_16x16x32_bf16 v[132:135], a[204:207], a[92:95], v[132:135]
v_mfma_f32_16x16x32_bf16 v[132:135], a[200:203], a[88:91], v[132:135]
s_waitcnt vmcnt(19)
s_waitcnt lgkmcnt(3)
v_mfma_f32_16x16x32_bf16 v[136:139], a[144:147], a[56:59], v[136:139]
s_waitcnt vmcnt(6)
v_readfirstlane_b32 vcc_lo, v19
s_nop 0
s_cmp_lt_u32 vcc_lo, 8
s_cbranch_scc1 L_spin_3019
L_spinbk_3020:
s_sub_u32 s84, s84, 1048576
s_add_u32 s84, s84, s69
v_mfma_f32_16x16x32_bf16 v[136:139], a[148:151], a[60:63], v[136:139]
s_xor_b32 s65, s84, 0
ds_read_b64_tr_b16 a[168:169], v191 offset:0
v_mfma_f32_16x16x32_bf16 v[104:107], a[148:151], a[52:55], v[104:107]
buffer_load_dwordx4 a[208:211], v14, s[44:47], s65 offen offset:0 sc1
v_mfma_f32_16x16x32_bf16 v[104:107], a[144:147], a[48:51], v[104:107]
ds_read_b64_tr_b16 a[170:171], v191 offset:4096
v_mfma_f32_16x16x32_bf16 v[72:75], a[144:147], a[40:43], v[72:75]
buffer_load_dwordx4 a[216:219], v14, s[44:47], s65 offen offset:1024 sc1
v_mfma_f32_16x16x32_bf16 v[72:75], a[148:151], a[44:47], v[72:75]
ds_read_b64_tr_b16 a[172:173], v191 offset:8192
v_mfma_f32_16x16x32_bf16 v[40:43], a[148:151], a[36:39], v[40:43]
buffer_load_dwordx4 a[224:227], v15, s[44:47], s65 offen offset:0 sc1
v_mfma_f32_16x16x32_bf16 v[40:43], a[144:147], a[32:35], v[40:43]
ds_read_b64_tr_b16 a[174:175], v191 offset:12288
v_mfma_f32_16x16x32_bf16 v[44:47], a[152:155], a[32:35], v[44:47]
buffer_load_dwordx4 a[232:235], v15, s[44:47], s65 offen offset:1024 sc1
v_mfma_f32_16x16x32_bf16 v[44:47], a[156:159], a[36:39], v[44:47]
s_xor_b32 s65, s84, 8192
ds_read_b64_tr_b16 a[176:177], v184 offset:0
v_mfma_f32_16x16x32_bf16 v[76:79], a[156:159], a[44:47], v[76:79]
buffer_load_dwordx4 a[212:215], v14, s[44:47], s65 offen offset:0 sc1
v_mfma_f32_16x16x32_bf16 v[76:79], a[152:155], a[40:43], v[76:79]
ds_read_b64_tr_b16 a[178:179], v184 offset:4096
v_mfma_f32_16x16x32_bf16 v[108:111], a[152:155], a[48:51], v[108:111]
ds_read_b64_tr_b16 a[180:181], v184 offset:8192
v_mfma_f32_16x16x32_bf16 v[108:111], a[156:159], a[52:55], v[108:111]
buffer_load_dwordx4 a[220:223], v14, s[44:47], s65 offen offset:1024 sc1
v_mfma_f32_16x16x32_bf16 v[140:143], a[156:159], a[60:63], v[140:143]
ds_read_b64_tr_b16 a[182:183], v184 offset:12288
v_mfma_f32_16x16x32_bf16 v[140:143], a[152:155], a[56:59], v[140:143]
s_waitcnt lgkmcnt(4)
buffer_load_dwordx4 a[228:231], v15, s[44:47], s65 offen offset:0 sc1
v_mfma_f32_16x16x32_bf16 v[144:147], a[160:163], a[56:59], v[144:147]
ds_read_b64_tr_b16 a[184:185], v185 offset:0
v_mfma_f32_16x16x32_bf16 v[144:147], a[164:167], a[60:63], v[144:147]
buffer_load_dwordx4 a[236:239], v15, s[44:47], s65 offen offset:1024 sc1
v_mfma_f32_16x16x32_bf16 v[112:115], a[164:167], a[52:55], v[112:115]
s_xor_b32 m0, s76, 38912
s_xor_b32 s64, s85, 311296
ds_read_b64_tr_b16 a[186:187], v185 offset:4096
v_mfma_f32_16x16x32_bf16 v[112:115], a[160:163], a[48:51], v[112:115]
buffer_load_dwordx4 v12, s[40:43], s64 offen lds
v_mfma_f32_16x16x32_bf16 v[80:83], a[160:163], a[40:43], v[80:83]
s_xor_b32 m0, s76, 39936
ds_read_b64_tr_b16 a[188:189], v185 offset:8192
v_mfma_f32_16x16x32_bf16 v[80:83], a[164:167], a[44:47], v[80:83]
s_xor_b32 s64, s85, 319488
ds_read_b64_tr_b16 a[190:191], v185 offset:12288
v_mfma_f32_16x16x32_bf16 v[48:51], a[164:167], a[36:39], v[48:51]
buffer_load_dwordx4 v13, s[40:43], s64 offen lds
v_mfma_f32_16x16x32_bf16 v[48:51], a[160:163], a[32:35], v[48:51]
s_xor_b32 s65, s84, 32768
ds_read_b64_tr_b16 a[192:193], v186 offset:0
v_mfma_f32_16x16x32_bf16 v[52:55], a[168:171], a[32:35], v[52:55]
buffer_load_dwordx4 v[152:155], v14, s[44:47], s65 offen offset:0 sc1
v_mfma_f32_16x16x32_bf16 v[52:55], a[172:175], a[36:39], v[52:55]
ds_read_b64_tr_b16 a[194:195], v186 offset:4096
v_mfma_f32_16x16x32_bf16 v[84:87], a[172:175], a[44:47], v[84:87]
buffer_load_dwordx4 v[160:163], v14, s[44:47], s65 offen offset:1024 sc1
v_mfma_f32_16x16x32_bf16 v[84:87], a[168:171], a[40:43], v[84:87]
ds_read_b64_tr_b16 a[196:197], v186 offset:8192
v_mfma_f32_16x16x32_bf16 v[116:119], a[168:171], a[48:51], v[116:119]
buffer_load_dwordx4 v[168:171], v15, s[44:47], s65 offen offset:0 sc1
v_mfma_f32_16x16x32_bf16 v[116:119], a[172:175], a[52:55], v[116:119]
ds_read_b64_tr_b16 a[198:199], v186 offset:12288
v_mfma_f32_16x16x32_bf16 v[148:151], a[172:175], a[60:63], v[148:151]
buffer_load_dwordx4 v[176:179], v15, s[44:47], s65 offen offset:1024 sc1
v_mfma_f32_16x16x32_bf16 v[148:151], a[168:171], a[56:59], v[148:151]
s_waitcnt lgkmcnt(3)
ds_read_b64_tr_b16 a[200:201], v187 offset:0
v_mfma_f32_16x16x32_bf16 v[120:123], a[176:179], a[56:59], v[120:123]
s_xor_b32 s65, s84, 40960
ds_read_b64_tr_b16 a[202:203], v187 offset:4096
v_mfma_f32_16x16x32_bf16 v[120:123], a[180:183], a[60:63], v[120:123]
buffer_load_dwordx4 v[156:159], v14, s[44:47], s65 offen offset:0 sc1
v_mfma_f32_16x16x32_bf16 v[88:91], a[180:183], a[52:55], v[88:91]
ds_read_b64_tr_b16 a[204:205], v187 offset:8192
v_mfma_f32_16x16x32_bf16 v[88:91], a[176:179], a[48:51], v[88:91]
buffer_load_dwordx4 v[164:167], v14, s[44:47], s65 offen offset:1024 sc1
v_mfma_f32_16x16x32_bf16 v[56:59], a[176:179], a[40:43], v[56:59]
ds_read_b64_tr_b16 a[206:207], v187 offset:12288
v_mfma_f32_16x16x32_bf16 v[56:59], a[180:183], a[44:47], v[56:59]
buffer_load_dwordx4 v[172:175], v15, s[44:47], s65 offen offset:0 sc1
v_mfma_f32_16x16x32_bf16 v[24:27], a[180:183], a[36:39], v[24:27]
v_mfma_f32_16x16x32_bf16 v[24:27], a[176:179], a[32:35], v[24:27]
buffer_load_dwordx4 v[180:183], v15, s[44:47], s65 offen offset:1024 sc1
v_mfma_f32_16x16x32_bf16 v[28:31], a[184:187], a[32:35], v[28:31]
v_mfma_f32_16x16x32_bf16 v[28:31], a[188:191], a[36:39], v[28:31]
v_mfma_f32_16x16x32_bf16 v[60:63], a[188:191], a[44:47], v[60:63]
v_mfma_f32_16x16x32_bf16 v[60:63], a[184:187], a[40:43], v[60:63]
s_barrier
v_mfma_f32_16x16x32_bf16 v[92:95], a[184:187], a[48:51], v[92:95]
ds_read_b64_tr_b16 a[144:145], v188 offset:32768
v_mfma_f32_16x16x32_bf16 v[92:95], a[188:191], a[52:55], v[92:95]
ds_read_b64_tr_b16 a[146:147], v188 offset:36864
v_mfma_f32_16x16x32_bf16 v[124:127], a[188:191], a[60:63], v[124:127]
s_xor_b32 m0, s76, 65536
ds_read_b64_tr_b16 a[148:149], v188 offset:40960
v_mfma_f32_16x16x32_bf16 v[124:127], a[184:187], a[56:59], v[124:127]
s_waitcnt lgkmcnt(3)
s_xor_b32 s64, s85, 524288
ds_read_b64_tr_b16 a[150:151], v188 offset:45056
v_mfma_f32_16x16x32_bf16 v[128:131], a[192:195], a[56:59], v[128:131]
buffer_load_dwordx4 v12, s[40:43], s64 offen lds
v_mfma_f32_16x16x32_bf16 v[128:131], a[196:199], a[60:63], v[128:131]
s_xor_b32 m0, s76, 66560
ds_read_b64_tr_b16 a[152:153], v189 offset:32768
v_mfma_f32_16x16x32_bf16 v[96:99], a[196:199], a[52:55], v[96:99]
s_xor_b32 s64, s85, 532480
ds_read_b64_tr_b16 a[154:155], v189 offset:36864
v_mfma_f32_16x16x32_bf16 v[96:99], a[192:195], a[48:51], v[96:99]
buffer_load_dwordx4 v13, s[40:43], s64 offen lds
v_mfma_f32_16x16x32_bf16 v[64:67], a[192:195], a[40:43], v[64:67]
s_xor_b32 m0, s76, 67584
ds_read_b64_tr_b16 a[156:157], v189 offset:40960
v_mfma_f32_16x16x32_bf16 v[64:67], a[196:199], a[44:47], v[64:67]
s_xor_b32 s64, s85, 540672
ds_read_b64_tr_b16 a[158:159], v189 offset:45056
v_mfma_f32_16x16x32_bf16 v[32:35], a[196:199], a[36:39], v[32:35]
buffer_load_dwordx4 v12, s[40:43], s64 offen lds
v_mfma_f32_16x16x32_bf16 v[32:35], a[192:195], a[32:35], v[32:35]
s_xor_b32 m0, s76, 68608
ds_read_b64_tr_b16 a[160:161], v190 offset:32768
v_mfma_f32_16x16x32_bf16 v[36:39], a[200:203], a[32:35], v[36:39]
s_xor_b32 s64, s85, 548864
ds_read_b64_tr_b16 a[162:163], v190 offset:36864
v_mfma_f32_16x16x32_bf16 v[36:39], a[204:207], a[36:39], v[36:39]
buffer_load_dwordx4 v13, s[40:43], s64 offen lds
v_mfma_f32_16x16x32_bf16 v[68:71], a[204:207], a[44:47], v[68:71]
s_xor_b32 m0, s76, 69632
ds_read_b64_tr_b16 a[164:165], v190 offset:40960
v_mfma_f32_16x16x32_bf16 v[68:71], a[200:203], a[40:43], v[68:71]
s_xor_b32 s64, s85, 557056
ds_read_b64_tr_b16 a[166:167], v190 offset:45056
v_mfma_f32_16x16x32_bf16 v[100:103], a[200:203], a[48:51], v[100:103]
buffer_load_dwordx4 v12, s[40:43], s64 offen lds
v_mfma_f32_16x16x32_bf16 v[100:103], a[204:207], a[52:55], v[100:103]
s_mov_b32 s70, 3
s_mov_b32 s73, 2
v_mfma_f32_16x16x32_bf16 v[132:135], a[204:207], a[60:63], v[132:135]
v_mfma_f32_16x16x32_bf16 v[132:135], a[200:203], a[56:59], v[132:135]
s_branch L_p5join
L_spin_4022:
s_mov_b32 vcc_hi, 0x80000
L_spinlp_4024:
s_sleep 1
buffer_load_dword v19, off, s[52:55], s72 offset:128 sc1
s_waitcnt vmcnt(0)
v_readfirstlane_b32 vcc_lo, v19
s_sub_u32 vcc_hi, vcc_hi, 1
s_cbranch_scc1 L_spinbk_4023
s_cmp_lt_u32 vcc_lo, s74
s_cbranch_scc1 L_spinlp_4024
s_branch L_spinbk_4023
L_codeend:
.section .rodata,"a"
.p2align 6
.amdhsa_kernel gated_mix__compressed_kv_cla__sliding_local_dilated__prompt_kernel
  .amdhsa_next_free_vgpr 512
  .amdhsa_next_free_sgpr 102
  .amdhsa_accum_offset 256
  .amdhsa_group_segment_fixed_size 0
  .amdhsa_kernarg_size 104
  .amdhsa_user_sgpr_count 2
  .amdhsa_user_sgpr_kernarg_segment_ptr 1
  .amdhsa_system_sgpr_workgroup_id_x 1
.end_amdhsa_kernel
```

```asm
; @launch grid=(256,1,1) block=(256,1,1) lds=163840
.amdgcn_target "amdgcn-amd-amdhsa--gfx950"
.text
.globl gated_mix__compressed_kv_cla__sliding_local_dilated__prompt_kernel
.p2align 8
.type gated_mix__compressed_kv_cla__sliding_local_dilated__prompt_kernel,@function
gated_mix__compressed_kv_cla__sliding_local_dilated__prompt_kernel:
s_cmp_ge_u32 s2, 256
s_cbranch_scc1 L_end
s_load_dwordx16 s[4:19], s[0:1], 0
s_load_dwordx8 s[20:27], s[0:1], 64
s_load_dwordx2 s[28:29], s[0:1], 96
s_getpc_b64 s[88:89]
L_pc:
v_lshrrev_b32 v1, 6, v0
s_lshr_b32 s67, s2, 3
v_lshl_add_u32 v24, s67, 2, v1
s_mov_b32 s90, L_codeend-L_pc
s_mov_b32 s91, 0x20000
v_and_b32 v25, 7, v0
v_lshlrev_b32 v25, 7, v25
v_lshl_add_u32 v24, v24, 10, v25
buffer_load_dword a252, v24, s[88:91], 0 offen
v_and_b32 v0, 63, v0
v_readfirstlane_b32 s30, v1
v_lshrrev_b32 v24, 3, v0
v_lshrrev_b32 v25, 4, v0
v_and_b32 v26, 7, v0
v_xor_b32 v26, v26, v25
v_lshlrev_b32 v26, 4, v26
v_lshl_add_u32 v12, v24, 10, v26
v_xor_b32 v13, 64, v12
v_bfe_u32 v26, v0, 1, 3
v_xor_b32 v26, v26, v25
v_lshlrev_b32 v26, 5, v26
v_and_b32 v24, 1, v0
v_lshl_add_u32 v26, v24, 4, v26
v_lshl_add_u32 v14, v25, 13, v26
v_xor_b32 v15, 128, v14
s_and_b32 s66, s2, 7
s_and_b32 s68, s67, 3
s_lshl2_add_u32 s31, s66, s68
s_cmp_eq_u32 s68, 0
s_cselect_b32 s90, s90, 0
s_lshr_b32 s3, s67, 2
s_lshl2_add_u32 s80, s67, s30
s_lshl_b32 s70, s3, 18
s_lshl_b32 s66, s30, 16
s_add_u32 s70, s70, s66
s_lshl_b32 s71, s30, 17
s_lshl_b32 s66, s31, 8
s_add_u32 s71, s71, s66
s_lshl_b32 s76, s30, 13
s_lshl_b32 s77, s30, 12
s_lshl_b32 s78, s30, 10
s_cmp_eq_u32 s30, 0
s_cbranch_scc1 L_pg1
s_cmp_eq_u32 s30, 1
s_cbranch_scc1 L_tr9
s_cmp_eq_u32 s30, 2
s_cbranch_scc1 L_tr9
s_branch L_tr9
L_tr9:
s_waitcnt lgkmcnt(0)
s_mov_b32 s32, s6
s_mov_b32 s33, s7
s_mov_b32 s34, 2097152
s_mov_b32 s35, 0x20000
s_mov_b32 s36, s10
s_mov_b32 s37, s11
s_mov_b32 s38, 4194304
s_mov_b32 s39, 0x20000
s_mov_b32 s40, s12
s_mov_b32 s41, s13
s_mov_b32 s42, 4194304
s_mov_b32 s43, 0x20000
s_xor_b32 m0, s76, 0
s_xor_b32 s64, s70, 0
buffer_load_dwordx4 v12, s[32:35], s64 offen lds
s_xor_b32 m0, s76, 1024
s_xor_b32 s64, s70, 8192
buffer_load_dwordx4 v13, s[32:35], s64 offen lds
s_xor_b32 m0, s76, 2048
s_xor_b32 s64, s70, 16384
buffer_load_dwordx4 v12, s[32:35], s64 offen lds
s_xor_b32 m0, s76, 3072
s_xor_b32 s64, s70, 24576
buffer_load_dwordx4 v13, s[32:35], s64 offen lds
s_xor_b32 m0, s77, 65536
s_xor_b32 s64, s71, 0
buffer_load_dwordx4 v14, s[36:39], s64 offen lds
s_xor_b32 m0, s77, 66560
s_xor_b32 s64, s71, 32768
buffer_load_dwordx4 v14, s[36:39], s64 offen lds
s_xor_b32 m0, s77, 67584
s_xor_b32 s64, s71, 65536
buffer_load_dwordx4 v15, s[36:39], s64 offen lds
s_xor_b32 m0, s77, 68608
s_xor_b32 s64, s71, 98304
buffer_load_dwordx4 v15, s[36:39], s64 offen lds
s_mov_b32 s44, s28
s_mov_b32 s45, s29
s_mov_b32 s46, 134217728
s_mov_b32 s47, 0x20000
s_mov_b32 s48, s4
s_mov_b32 s49, s5
s_mov_b32 s50, 4194304
s_mov_b32 s51, 0x20000
s_mov_b32 s52, s26
s_mov_b32 s53, s27
s_mov_b32 s54, 256
s_mov_b32 s55, 0x20000
s_mov_b32 s56, s8
s_mov_b32 s57, s9
s_mov_b32 s58, 8388608
s_mov_b32 s59, 0x20000
s_mov_b32 s60, s18
s_mov_b32 s61, s19
s_mov_b32 s62, 6291456
s_mov_b32 s63, 0x20000
v_accvgpr_write_b32 a251, 1
v_and_b32 v24, 15, v0
v_lshrrev_b32 v26, 1, v24
v_xor_b32 v26, v26, v25
v_lshlrev_b32 v26, 4, v26
v_lshl_add_u32 v26, v24, 7, v26
v_add_u32 v2, s76, v26
v_xor_b32 v3, 64, v2
v_bfe_u32 v24, v0, 2, 2
v_lshl_add_u32 v27, v25, 3, v24
v_and_b32 v1, 3, v0
v_cmp_eq_u32 vcc, 0, v1
v_lshlrev_b32 v1, 3, v1
v_lshl_add_u32 v26, v27, 8, v1
v_add_u32 v26, 65536, v26
v_and_b32 v1, 1, v25
v_lshl_add_u32 v24, v1, 2, v24
v_lshlrev_b32 v16, 4, v0
v_mov_b32 v28, 0x3f803f80
v_cndmask_b32 v28, 0, v28, vcc
v_accvgpr_write_b32 a244, v28
v_accvgpr_write_b32 a245, v28
v_accvgpr_write_b32 a246, v28
v_accvgpr_write_b32 a247, v28
v_xor_b32 v1, 0, v24
v_lshl_add_u32 v4, v1, 5, v26
v_xor_b32 v1, 1, v24
v_lshl_add_u32 v5, v1, 5, v26
v_xor_b32 v1, 2, v24
v_lshl_add_u32 v6, v1, 5, v26
v_xor_b32 v1, 3, v24
v_lshl_add_u32 v7, v1, 5, v26
v_xor_b32 v1, 4, v24
v_lshl_add_u32 v8, v1, 5, v26
v_xor_b32 v1, 5, v24
v_lshl_add_u32 v9, v1, 5, v26
v_xor_b32 v1, 6, v24
v_lshl_add_u32 v10, v1, 5, v26
v_xor_b32 v1, 7, v24
v_lshl_add_u32 v11, v1, 5, v26
s_sub_u32 s16, 15, s3
s_lshl_b32 s72, s3, 18
s_lshl_b32 s73, s16, 18
s_cmp_lt_u32 s30, 2
s_cselect_b32 s67, s3, s16
s_lshl4_add_u32 s74, s31, s67
s_and_b32 s66, s30, 1
s_lshl1_add_u32 s74, s74, s66
s_lshl_b32 s74, s74, 10
s_add_u32 s74, s74, 60817408
s_lshl_b32 s66, s30, 15
s_add_u32 s72, s72, s66
s_add_u32 s73, s73, s66
s_mul_i32 s75, s30, 98304
s_lshl_b32 s66, s31, 6
s_add_u32 s75, s75, s66
s_lshl_b32 s79, s31, 20
s_lshl_b32 s66, s3, 17
s_add_u32 s79, s79, s66
s_lshl_b32 s66, s30, 15
s_add_u32 s79, s79, s66
v_bfe_u32 v23, v0, 1, 1
v_lshrrev_b32 v1, 5, v0
v_xor_b32 v23, v23, v1
v_lshlrev_b32 v23, 5, v23
v_and_b32 v1, 1, v0
v_lshl_add_u32 v23, v1, 4, v23
v_lshrrev_b32 v1, 2, v0
v_mul_u32_u24 v1, 6144, v1
v_add_u32 v23, v1, v23
s_lshl_b32 s81, s80, 13
s_and_b32 s67, s2, 7
s_lshl_b32 s82, s67, 8
s_add_u32 s82, s82, s81
s_lshl_b32 s67, s67, 10
s_add_u32 s81, s81, s67
s_add_u32 s83, s81, 1048576
v_mul_u32_u24 v1, 1792, v25
v_add_u32 v1, v1, v16
s_lshl_b32 s68, s2, 3
s_lshl1_add_u32 s68, s30, s68
v_lshrrev_b32 v18, 5, v0
v_add_u32 v18, s68, v18
v_and_b32 v19, 31, v0
v_lshlrev_b32 v19, 4, v19
v_lshl_add_u32 v18, v18, 11, v19
v_mov_b32 v21, 0
v_min_u32 v20, 1, v0
v_lshlrev_b32 v20, 30, v20
v_accvgpr_write_b32 a240, -1
v_accvgpr_write_b32 a241, -1
v_accvgpr_write_b32 a242, -1
v_accvgpr_write_b32 a243, -1
s_lshr_b32 s69, s2, 7
s_or_b32 s69, s69, s30
s_lshl_b32 s69, s69, 21
s_add_u32 s69, s69, s2
s_lshl_b32 s69, s69, 7
s_add_u32 s69, s69, 59768832
s_cmp_eq_u32 s30, 0
s_cbranch_scc1 L_pg2
s_cmp_eq_u32 s30, 1
s_cbranch_scc1 L_pg3
s_cmp_eq_u32 s30, 2
s_cbranch_scc1 L_pg4
s_branch L_pg5
L_tr0:
s_branch L_base
.p2align 12
L_pg1:
s_branch L_tr9
L_base:
s_xor_b32 m0, s76, 4096
s_xor_b32 s64, s70, 32768
buffer_load_dwordx4 v12, s[32:35], s64 offen lds
s_xor_b32 m0, s76, 5120
s_xor_b32 s64, s70, 40960
buffer_load_dwordx4 v13, s[32:35], s64 offen lds
s_xor_b32 m0, s76, 6144
s_xor_b32 s64, s70, 49152
buffer_load_dwordx4 v12, s[32:35], s64 offen lds
s_xor_b32 m0, s76, 7168
s_xor_b32 s64, s70, 57344
buffer_load_dwordx4 v13, s[32:35], s64 offen lds
s_xor_b32 m0, s77, 81920
s_xor_b32 s64, s71, 0
buffer_load_dwordx4 v14, s[40:43], s64 offen lds
s_xor_b32 m0, s77, 82944
s_xor_b32 s64, s71, 32768
buffer_load_dwordx4 v14, s[40:43], s64 offen lds
s_xor_b32 m0, s77, 83968
s_xor_b32 s64, s71, 65536
buffer_load_dwordx4 v15, s[40:43], s64 offen lds
s_xor_b32 m0, s77, 84992
s_xor_b32 s64, s71, 98304
buffer_load_dwordx4 v15, s[40:43], s64 offen lds
s_and_b32 s66, s31, 3
s_lshl_b32 s67, s66, 11
s_add_u32 s84, s76, s67
s_lshl3_add_u32 s70, s67, s70
s_and_b32 s67, s66, 1
s_lshl_b32 s67, s67, 17
s_add_u32 s72, s72, s67
s_add_u32 s67, s73, s67
s_bitcmp1_b32 s66, 1
s_cselect_b32 s73, s72, s67
s_cselect_b32 s72, s67, s72
s_and_b32 s66, s3, 3
s_lshl_b32 s67, s66, 10
s_add_u32 s77, s77, s67
s_lshl_b32 s67, s66, 15
s_add_u32 s71, s71, s67
s_and_b32 s67, s66, 2
s_lshl_b32 s67, s67, 6
v_xor_b32 v14, s67, v14
v_xor_b32 v15, s67, v15
s_and_b32 s66, s3, 4
s_cselect_b64 s[36:37], s[12:13], s[10:11]
s_cselect_b64 s[40:41], s[10:11], s[12:13]
s_lshl_b32 s66, s66, 12
s_add_u32 s77, s77, s66
s_waitcnt vmcnt(8)
s_barrier
ds_read_b128 a[0:3], v2 offset:0
ds_read_b128 a[4:7], v3 offset:0
ds_read_b64_tr_b16 a[176:177], v4 offset:0
ds_read_b64_tr_b16 a[178:179], v4 offset:1024
ds_read_b64_tr_b16 a[180:181], v4 offset:8192
ds_read_b64_tr_b16 a[182:183], v4 offset:9216
ds_read_b128 a[8:11], v2 offset:2048
ds_read_b128 a[12:15], v3 offset:2048
ds_read_b64_tr_b16 a[184:185], v5 offset:0
ds_read_b64_tr_b16 a[186:187], v5 offset:1024
ds_read_b64_tr_b16 a[188:189], v5 offset:8192
ds_read_b64_tr_b16 a[190:191], v5 offset:9216
ds_read_b64_tr_b16 a[88:89], v6 offset:0
ds_read_b64_tr_b16 a[90:91], v6 offset:1024
ds_read_b64_tr_b16 a[92:93], v6 offset:8192
ds_read_b64_tr_b16 a[94:95], v6 offset:9216
s_waitcnt lgkmcnt(12)
v_mfma_f32_16x16x32_bf16 v[184:187], a[176:179], a[0:3], 0
s_waitcnt lgkmcnt(10)
s_xor_b32 m0, s77, 98304
ds_read_b64_tr_b16 a[96:97], v7 offset:0
v_mfma_f32_16x16x32_bf16 v[184:187], a[180:183], a[4:7], v[184:187]
s_waitcnt lgkmcnt(9)
s_xor_b32 s64, s71, 524288
ds_read_b64_tr_b16 a[98:99], v7 offset:1024
v_mfma_f32_16x16x32_bf16 v[192:195], a[180:183], a[12:15], 0
buffer_load_dwordx4 v14, s[36:39], s64 offen lds
v_mfma_f32_16x16x32_bf16 v[192:195], a[176:179], a[8:11], v[192:195]
s_waitcnt lgkmcnt(8)
ds_read_b64_tr_b16 a[100:101], v7 offset:8192
v_mfma_f32_16x16x32_bf16 v[196:199], a[184:187], a[8:11], 0
s_waitcnt lgkmcnt(7)
s_xor_b32 m0, s77, 99328
ds_read_b64_tr_b16 a[102:103], v7 offset:9216
v_mfma_f32_16x16x32_bf16 v[196:199], a[188:191], a[12:15], v[196:199]
s_xor_b32 s64, s71, 557056
ds_read_b64_tr_b16 a[104:105], v8 offset:0
v_mfma_f32_16x16x32_bf16 v[188:191], a[188:191], a[4:7], 0
buffer_load_dwordx4 v14, s[36:39], s64 offen lds
v_mfma_f32_16x16x32_bf16 v[188:191], a[184:187], a[0:3], v[188:191]
s_waitcnt lgkmcnt(7)
ds_read_b64_tr_b16 a[106:107], v8 offset:1024
v_mfma_f32_16x16x32_bf16 v[216:219], a[88:91], a[0:3], 0
s_waitcnt lgkmcnt(6)
s_xor_b32 m0, s77, 100352
ds_read_b64_tr_b16 a[108:109], v8 offset:8192
v_mfma_f32_16x16x32_bf16 v[216:219], a[92:95], a[4:7], v[216:219]
s_xor_b32 s64, s71, 589824
ds_read_b64_tr_b16 a[110:111], v8 offset:9216
v_mfma_f32_16x16x32_bf16 v[224:227], a[92:95], a[12:15], 0
buffer_load_dwordx4 v15, s[36:39], s64 offen lds
v_mfma_f32_16x16x32_bf16 v[224:227], a[88:91], a[8:11], v[224:227]
s_waitcnt lgkmcnt(6)
ds_read_b64_tr_b16 a[112:113], v9 offset:0
v_mfma_f32_16x16x32_bf16 v[228:231], a[96:99], a[8:11], 0
s_waitcnt lgkmcnt(5)
ds_read_b64_tr_b16 a[114:115], v9 offset:1024
v_mfma_f32_16x16x32_bf16 v[228:231], a[100:103], a[12:15], v[228:231]
s_xor_b32 m0, s77, 101376
ds_read_b64_tr_b16 a[116:117], v9 offset:8192
v_mfma_f32_16x16x32_bf16 v[220:223], a[100:103], a[4:7], 0
s_xor_b32 s64, s71, 622592
ds_read_b64_tr_b16 a[118:119], v9 offset:9216
v_mfma_f32_16x16x32_bf16 v[220:223], a[96:99], a[0:3], v[220:223]
s_waitcnt lgkmcnt(6)
buffer_load_dwordx4 v15, s[36:39], s64 offen lds
v_mfma_f32_16x16x32_bf16 v[152:155], a[104:107], a[0:3], 0
s_waitcnt lgkmcnt(4)
ds_read_b64_tr_b16 a[72:73], v10 offset:0
v_mfma_f32_16x16x32_bf16 v[152:155], a[108:111], a[4:7], v[152:155]
s_xor_b32 m0, s77, 114688
ds_read_b64_tr_b16 a[74:75], v10 offset:1024
v_mfma_f32_16x16x32_bf16 v[160:163], a[108:111], a[12:15], 0
s_xor_b32 s64, s71, 524288
ds_read_b64_tr_b16 a[76:77], v10 offset:8192
ds_read_b64_tr_b16 a[78:79], v10 offset:9216
v_mfma_f32_16x16x32_bf16 v[160:163], a[104:107], a[8:11], v[160:163]
s_waitcnt lgkmcnt(6)
buffer_load_dwordx4 v14, s[40:43], s64 offen lds
v_mfma_f32_16x16x32_bf16 v[164:167], a[112:115], a[8:11], 0
s_waitcnt lgkmcnt(4)
s_xor_b32 m0, s77, 115712
ds_read_b64_tr_b16 a[80:81], v11 offset:0
v_mfma_f32_16x16x32_bf16 v[164:167], a[116:119], a[12:15], v[164:167]
s_xor_b32 s64, s71, 557056
ds_read_b64_tr_b16 a[82:83], v11 offset:1024
v_mfma_f32_16x16x32_bf16 v[156:159], a[116:119], a[4:7], 0
ds_read_b64_tr_b16 a[84:85], v11 offset:8192
ds_read_b64_tr_b16 a[86:87], v11 offset:9216
s_waitcnt vmcnt(9)
v_mfma_f32_16x16x32_bf16 v[156:159], a[112:115], a[0:3], v[156:159]
s_waitcnt lgkmcnt(6)
buffer_load_dwordx4 v14, s[40:43], s64 offen lds
v_mfma_f32_16x16x32_bf16 v[24:27], a[72:75], a[0:3], 0
s_waitcnt lgkmcnt(4)
s_xor_b32 m0, s77, 116736
ds_read_b128 a[16:19], v2 offset:4096
ds_read_b128 a[20:23], v3 offset:4096
v_mfma_f32_16x16x32_bf16 v[24:27], a[76:79], a[4:7], v[24:27]
s_xor_b32 s64, s71, 589824
ds_read_b128 a[24:27], v2 offset:6144
ds_read_b128 a[28:31], v3 offset:6144
v_mfma_f32_16x16x32_bf16 v[40:43], a[76:79], a[12:15], 0
buffer_load_dwordx4 v15, s[40:43], s64 offen lds
v_mfma_f32_16x16x32_bf16 v[40:43], a[72:75], a[8:11], v[40:43]
s_waitcnt lgkmcnt(6)
v_mfma_f32_16x16x32_bf16 v[104:107], a[80:83], a[8:11], 0
s_waitcnt lgkmcnt(4)
s_xor_b32 m0, s77, 117760
v_mfma_f32_16x16x32_bf16 v[104:107], a[84:87], a[12:15], v[104:107]
s_xor_b32 s64, s71, 622592
v_mfma_f32_16x16x32_bf16 v[88:91], a[84:87], a[4:7], 0
buffer_load_dwordx4 v15, s[40:43], s64 offen lds
v_mfma_f32_16x16x32_bf16 v[88:91], a[80:83], a[0:3], v[88:91]
s_waitcnt lgkmcnt(3)
v_mfma_f32_16x16x32_bf16 v[232:235], a[88:91], a[16:19], 0
s_waitcnt lgkmcnt(2)
v_mfma_f32_16x16x32_bf16 v[232:235], a[92:95], a[20:23], v[232:235]
s_waitcnt lgkmcnt(0)
s_xor_b32 m0, s84, 32768
v_mfma_f32_16x16x32_bf16 v[240:243], a[92:95], a[28:31], 0
s_xor_b32 s64, s70, 128
v_mfma_f32_16x16x32_bf16 v[240:243], a[88:91], a[24:27], v[240:243]
buffer_load_dwordx4 v12, s[32:35], s64 offen lds
v_mfma_f32_16x16x32_bf16 v[244:247], a[96:99], a[24:27], 0
s_xor_b32 m0, s84, 33792
v_mfma_f32_16x16x32_bf16 v[244:247], a[100:103], a[28:31], v[244:247]
s_xor_b32 s64, s70, 8320
v_mfma_f32_16x16x32_bf16 v[236:239], a[100:103], a[20:23], 0
s_waitcnt vmcnt(9)
s_barrier
v_mfma_f32_16x16x32_bf16 v[236:239], a[96:99], a[16:19], v[236:239]
buffer_load_dwordx4 v13, s[32:35], s64 offen lds
v_mfma_f32_16x16x32_bf16 v[168:171], a[104:107], a[16:19], 0
ds_read_b64_tr_b16 a[88:89], v4 offset:16384
v_mfma_f32_16x16x32_bf16 v[168:171], a[108:111], a[20:23], v[168:171]
s_xor_b32 m0, s84, 34816
ds_read_b64_tr_b16 a[90:91], v4 offset:17408
v_mfma_f32_16x16x32_bf16 v[176:179], a[108:111], a[28:31], 0
s_xor_b32 s64, s70, 16512
ds_read_b64_tr_b16 a[92:93], v4 offset:24576
v_mfma_f32_16x16x32_bf16 v[176:179], a[104:107], a[24:27], v[176:179]
buffer_load_dwordx4 v12, s[32:35], s64 offen lds
v_mfma_f32_16x16x32_bf16 v[180:183], a[112:115], a[24:27], 0
ds_read_b64_tr_b16 a[94:95], v4 offset:25600
v_mfma_f32_16x16x32_bf16 v[180:183], a[116:119], a[28:31], v[180:183]
s_xor_b32 m0, s84, 35840
ds_read_b64_tr_b16 a[96:97], v5 offset:16384
v_mfma_f32_16x16x32_bf16 v[172:175], a[116:119], a[20:23], 0
s_xor_b32 s64, s70, 24704
ds_read_b64_tr_b16 a[98:99], v5 offset:17408
v_mfma_f32_16x16x32_bf16 v[172:175], a[112:115], a[16:19], v[172:175]
buffer_load_dwordx4 v13, s[32:35], s64 offen lds
v_mfma_f32_16x16x32_bf16 v[56:59], a[72:75], a[16:19], 0
ds_read_b64_tr_b16 a[100:101], v5 offset:24576
v_mfma_f32_16x16x32_bf16 v[56:59], a[76:79], a[20:23], v[56:59]
s_xor_b32 m0, s84, 36864
ds_read_b64_tr_b16 a[102:103], v5 offset:25600
v_mfma_f32_16x16x32_bf16 v[72:75], a[76:79], a[28:31], 0
s_xor_b32 s64, s70, 32896
ds_read_b64_tr_b16 a[104:105], v6 offset:16384
v_mfma_f32_16x16x32_bf16 v[72:75], a[72:75], a[24:27], v[72:75]
buffer_load_dwordx4 v12, s[32:35], s64 offen lds
v_mfma_f32_16x16x32_bf16 v[136:139], a[80:83], a[24:27], 0
ds_read_b64_tr_b16 a[106:107], v6 offset:17408
v_mfma_f32_16x16x32_bf16 v[136:139], a[84:87], a[28:31], v[136:139]
s_xor_b32 m0, s84, 37888
ds_read_b64_tr_b16 a[108:109], v6 offset:24576
v_mfma_f32_16x16x32_bf16 v[120:123], a[84:87], a[20:23], 0
s_xor_b32 s64, s70, 41088
ds_read_b64_tr_b16 a[110:111], v6 offset:25600
v_mfma_f32_16x16x32_bf16 v[120:123], a[80:83], a[16:19], v[120:123]
buffer_load_dwordx4 v13, s[32:35], s64 offen lds
v_mfma_f32_16x16x32_bf16 v[200:203], a[176:179], a[16:19], 0
ds_read_b64_tr_b16 a[112:113], v7 offset:16384
v_mfma_f32_16x16x32_bf16 v[200:203], a[180:183], a[20:23], v[200:203]
s_xor_b32 m0, s84, 38912
ds_read_b64_tr_b16 a[114:115], v7 offset:17408
v_mfma_f32_16x16x32_bf16 v[208:211], a[180:183], a[28:31], 0
s_xor_b32 s64, s70, 49280
ds_read_b64_tr_b16 a[116:117], v7 offset:24576
v_mfma_f32_16x16x32_bf16 v[208:211], a[176:179], a[24:27], v[208:211]
buffer_load_dwordx4 v12, s[32:35], s64 offen lds
v_mfma_f32_16x16x32_bf16 v[212:215], a[184:187], a[24:27], 0
ds_read_b64_tr_b16 a[118:119], v7 offset:25600
v_mfma_f32_16x16x32_bf16 v[212:215], a[188:191], a[28:31], v[212:215]
s_xor_b32 m0, s84, 39936
ds_read_b64_tr_b16 a[72:73], v8 offset:16384
v_mfma_f32_16x16x32_bf16 v[204:207], a[188:191], a[20:23], 0
s_xor_b32 s64, s70, 57472
ds_read_b64_tr_b16 a[74:75], v8 offset:17408
v_mfma_f32_16x16x32_bf16 v[204:207], a[184:187], a[16:19], v[204:207]
s_waitcnt lgkmcnt(7)
buffer_load_dwordx4 v13, s[32:35], s64 offen lds
v_mfma_f32_16x16x32_bf16 v[28:31], a[0:3], a[88:91], 0
ds_read_b64_tr_b16 a[76:77], v8 offset:24576
v_mfma_f32_16x16x32_bf16 v[28:31], a[4:7], a[92:95], v[28:31]
ds_read_b64_tr_b16 a[78:79], v8 offset:25600
v_mfma_f32_16x16x32_bf16 v[44:47], a[12:15], a[92:95], 0
ds_read_b64_tr_b16 a[80:81], v9 offset:16384
v_mfma_f32_16x16x32_bf16 v[44:47], a[8:11], a[88:91], v[44:47]
ds_read_b64_tr_b16 a[82:83], v9 offset:17408
v_mfma_f32_16x16x32_bf16 v[60:63], a[16:19], a[88:91], 0
s_xor_b32 m0, s77, 131072
ds_read_b64_tr_b16 a[84:85], v9 offset:24576
v_mfma_f32_16x16x32_bf16 v[60:63], a[20:23], a[92:95], v[60:63]
s_xor_b32 s64, s71, 1048576
ds_read_b64_tr_b16 a[86:87], v9 offset:25600
v_mfma_f32_16x16x32_bf16 v[76:79], a[28:31], a[92:95], 0
buffer_load_dwordx4 v14, s[36:39], s64 offen lds
v_mfma_f32_16x16x32_bf16 v[76:79], a[24:27], a[88:91], v[76:79]
s_xor_b32 m0, s77, 132096
ds_read_b64_tr_b16 a[88:89], v10 offset:16384
v_mfma_f32_16x16x32_bf16 v[140:143], a[24:27], a[96:99], 0
s_xor_b32 s64, s71, 1081344
ds_read_b64_tr_b16 a[90:91], v10 offset:17408
v_mfma_f32_16x16x32_bf16 v[140:143], a[28:31], a[100:103], v[140:143]
buffer_load_dwordx4 v14, s[36:39], s64 offen lds
v_mfma_f32_16x16x32_bf16 v[124:127], a[20:23], a[100:103], 0
ds_read_b64_tr_b16 a[92:93], v10 offset:24576
v_mfma_f32_16x16x32_bf16 v[124:127], a[16:19], a[96:99], v[124:127]
s_xor_b32 m0, s77, 133120
ds_read_b64_tr_b16 a[94:95], v10 offset:25600
v_mfma_f32_16x16x32_bf16 v[108:111], a[8:11], a[96:99], 0
s_xor_b32 s64, s71, 1114112
v_mfma_f32_16x16x32_bf16 v[108:111], a[12:15], a[100:103], v[108:111]
buffer_load_dwordx4 v15, s[36:39], s64 offen lds
v_mfma_f32_16x16x32_bf16 v[92:95], a[4:7], a[100:103], 0
v_mfma_f32_16x16x32_bf16 v[92:95], a[0:3], a[96:99], v[92:95]
s_xor_b32 m0, s77, 134144
ds_read_b64_tr_b16 a[96:97], v11 offset:16384
v_mfma_f32_16x16x32_bf16 v[32:35], a[0:3], a[104:107], 0
s_waitcnt lgkmcnt(5)
s_xor_b32 s64, s71, 1146880
ds_read_b64_tr_b16 a[98:99], v11 offset:17408
v_mfma_f32_16x16x32_bf16 v[32:35], a[4:7], a[108:111], v[32:35]
buffer_load_dwordx4 v15, s[36:39], s64 offen lds
v_mfma_f32_16x16x32_bf16 v[48:51], a[12:15], a[108:111], 0
ds_read_b64_tr_b16 a[100:101], v11 offset:24576
v_mfma_f32_16x16x32_bf16 v[48:51], a[8:11], a[104:107], v[48:51]
s_xor_b32 m0, s77, 147456
ds_read_b64_tr_b16 a[102:103], v11 offset:25600
v_mfma_f32_16x16x32_bf16 v[64:67], a[16:19], a[104:107], 0
s_xor_b32 s64, s71, 1048576
v_mfma_f32_16x16x32_bf16 v[64:67], a[20:23], a[108:111], v[64:67]
buffer_load_dwordx4 v14, s[40:43], s64 offen lds
v_mfma_f32_16x16x32_bf16 v[80:83], a[28:31], a[108:111], 0
s_xor_b32 m0, s77, 148480
v_mfma_f32_16x16x32_bf16 v[80:83], a[24:27], a[104:107], v[80:83]
s_xor_b32 s64, s71, 1081344
v_mfma_f32_16x16x32_bf16 v[144:147], a[24:27], a[112:115], 0
buffer_load_dwordx4 v14, s[40:43], s64 offen lds
v_mfma_f32_16x16x32_bf16 v[144:147], a[28:31], a[116:119], v[144:147]
v_mfma_f32_16x16x32_bf16 v[128:131], a[20:23], a[116:119], 0
s_xor_b32 m0, s77, 149504
v_mfma_f32_16x16x32_bf16 v[128:131], a[16:19], a[112:115], v[128:131]
s_xor_b32 s64, s71, 1114112
v_mfma_f32_16x16x32_bf16 v[112:115], a[8:11], a[112:115], 0
buffer_load_dwordx4 v15, s[40:43], s64 offen lds
v_mfma_f32_16x16x32_bf16 v[112:115], a[12:15], a[116:119], v[112:115]
v_mfma_f32_16x16x32_bf16 v[96:99], a[4:7], a[116:119], 0
s_xor_b32 m0, s77, 150528
v_mfma_f32_16x16x32_bf16 v[96:99], a[0:3], a[112:115], v[96:99]
s_xor_b32 s64, s71, 1146880
v_mfma_f32_16x16x32_bf16 v[36:39], a[0:3], a[72:75], 0
buffer_load_dwordx4 v15, s[40:43], s64 offen lds
v_mfma_f32_16x16x32_bf16 v[36:39], a[4:7], a[76:79], v[36:39]
s_xor_b32 m0, s84, 0
v_mfma_f32_16x16x32_bf16 v[52:55], a[12:15], a[76:79], 0
s_waitcnt vmcnt(16) lgkmcnt(0)
s_barrier
v_mfma_f32_16x16x32_bf16 v[52:55], a[8:11], a[72:75], v[52:55]
s_xor_b32 s64, s70, 256
ds_read_b64_tr_b16 a[104:105], v4 offset:32768
v_mfma_f32_16x16x32_bf16 v[68:71], a[16:19], a[72:75], 0
buffer_load_dwordx4 v12, s[32:35], s64 offen lds
v_mfma_f32_16x16x32_bf16 v[68:71], a[20:23], a[76:79], v[68:71]
s_xor_b32 m0, s84, 1024
global_load_dwordx4 a[144:147], v18, s[4:5] offset:0
v_mfma_f32_16x16x32_bf16 v[84:87], a[28:31], a[76:79], 0
s_xor_b32 s64, s70, 8448
ds_read_b64_tr_b16 a[106:107], v4 offset:33792
v_mfma_f32_16x16x32_bf16 v[84:87], a[24:27], a[72:75], v[84:87]
buffer_load_dwordx4 v13, s[32:35], s64 offen lds
v_mfma_f32_16x16x32_bf16 v[148:151], a[24:27], a[80:83], 0
ds_read_b64_tr_b16 a[108:109], v4 offset:40960
v_mfma_f32_16x16x32_bf16 v[148:151], a[28:31], a[84:87], v[148:151]
s_xor_b32 m0, s84, 2048
ds_read_b64_tr_b16 a[110:111], v4 offset:41984
v_mfma_f32_16x16x32_bf16 v[132:135], a[20:23], a[84:87], 0
s_waitcnt vmcnt(11)
s_xor_b32 s64, s70, 16640
ds_read_b128 a[32:35], v2 offset:32768
v_mfma_f32_16x16x32_bf16 v[132:135], a[16:19], a[80:83], v[132:135]
buffer_load_dwordx4 v12, s[32:35], s64 offen lds
v_mfma_f32_16x16x32_bf16 v[116:119], a[8:11], a[80:83], 0
ds_read_b128 a[36:39], v3 offset:32768
v_mfma_f32_16x16x32_bf16 v[116:119], a[12:15], a[84:87], v[116:119]
s_xor_b32 m0, s84, 3072
ds_read_b128 a[40:43], v2 offset:34816
v_mfma_f32_16x16x32_bf16 v[100:103], a[4:7], a[84:87], 0
s_xor_b32 s64, s70, 24832
ds_read_b128 a[44:47], v3 offset:34816
v_mfma_f32_16x16x32_bf16 v[100:103], a[0:3], a[80:83], v[100:103]
buffer_load_dwordx4 v13, s[32:35], s64 offen lds
v_mfma_f32_16x16x32_bf16 v[248:251], a[0:3], a[88:91], 0
ds_read_b128 a[48:51], v2 offset:36864
v_mfma_f32_16x16x32_bf16 v[248:251], a[4:7], a[92:95], v[248:251]
s_xor_b32 m0, s84, 4096
ds_read_b128 a[52:55], v3 offset:36864
v_mfma_f32_16x16x32_bf16 v[252:255], a[12:15], a[92:95], 0
s_xor_b32 s64, s70, 33024
ds_read_b128 a[56:59], v2 offset:38912
v_mfma_f32_16x16x32_bf16 v[252:255], a[8:11], a[88:91], v[252:255]
buffer_load_dwordx4 v12, s[32:35], s64 offen lds
v_mfma_f32_16x16x32_bf16 a[120:123], a[16:19], a[88:91], 0
s_xor_b32 m0, s84, 5120
ds_read_b128 a[60:63], v3 offset:38912
v_mfma_f32_16x16x32_bf16 a[120:123], a[20:23], a[92:95], a[120:123]
s_xor_b32 s64, s70, 41216
ds_read_b64_tr_b16 a[112:113], v5 offset:32768
v_mfma_f32_16x16x32_bf16 a[124:127], a[28:31], a[92:95], 0
buffer_load_dwordx4 v13, s[32:35], s64 offen lds
v_mfma_f32_16x16x32_bf16 a[124:127], a[24:27], a[88:91], a[124:127]
ds_read_b64_tr_b16 a[114:115], v5 offset:33792
v_mfma_f32_16x16x32_bf16 a[128:131], a[24:27], a[96:99], 0
s_xor_b32 m0, s84, 6144
ds_read_b64_tr_b16 a[116:117], v5 offset:40960
v_mfma_f32_16x16x32_bf16 a[128:131], a[28:31], a[100:103], a[128:131]
s_xor_b32 s64, s70, 49408
ds_read_b64_tr_b16 a[118:119], v5 offset:41984
v_mfma_f32_16x16x32_bf16 a[132:135], a[20:23], a[100:103], 0
buffer_load_dwordx4 v12, s[32:35], s64 offen lds
v_mfma_f32_16x16x32_bf16 a[132:135], a[16:19], a[96:99], a[132:135]
global_load_dwordx4 a[160:163], v19, s[22:23] offset:0
v_mfma_f32_16x16x32_bf16 a[136:139], a[8:11], a[96:99], 0
s_xor_b32 m0, s84, 7168
ds_read_b64_tr_b16 a[72:73], v6 offset:32768
v_mfma_f32_16x16x32_bf16 a[136:139], a[12:15], a[100:103], a[136:139]
s_xor_b32 s64, s70, 57600
ds_read_b64_tr_b16 a[74:75], v6 offset:33792
v_mfma_f32_16x16x32_bf16 a[140:143], a[4:7], a[100:103], 0
buffer_load_dwordx4 v13, s[32:35], s64 offen lds
v_mfma_f32_16x16x32_bf16 a[140:143], a[0:3], a[96:99], a[140:143]
s_waitcnt lgkmcnt(5)
ds_read_b64_tr_b16 a[76:77], v6 offset:40960
v_mfma_f32_16x16x32_bf16 v[184:187], a[104:107], a[32:35], v[184:187]
ds_read_b64_tr_b16 a[78:79], v6 offset:41984
v_mfma_f32_16x16x32_bf16 v[184:187], a[108:111], a[36:39], v[184:187]
ds_read_b64_tr_b16 a[80:81], v7 offset:32768
v_mfma_f32_16x16x32_bf16 v[192:195], a[108:111], a[44:47], v[192:195]
s_xor_b32 m0, s77, 65536
ds_read_b64_tr_b16 a[82:83], v7 offset:33792
v_mfma_f32_16x16x32_bf16 v[192:195], a[104:107], a[40:43], v[192:195]
s_xor_b32 s64, s71, 1572864
ds_read_b64_tr_b16 a[84:85], v7 offset:40960
v_mfma_f32_16x16x32_bf16 v[200:203], a[104:107], a[48:51], v[200:203]
buffer_load_dwordx4 v14, s[36:39], s64 offen lds
v_mfma_f32_16x16x32_bf16 v[200:203], a[108:111], a[52:55], v[200:203]
ds_read_b64_tr_b16 a[86:87], v7 offset:41984
v_mfma_f32_16x16x32_bf16 v[208:211], a[108:111], a[60:63], v[208:211]
s_xor_b32 m0, s77, 66560
ds_read_b64_tr_b16 a[88:89], v8 offset:32768
v_mfma_f32_16x16x32_bf16 v[208:211], a[104:107], a[56:59], v[208:211]
s_waitcnt lgkmcnt(7)
s_xor_b32 s64, s71, 1605632
ds_read_b64_tr_b16 a[90:91], v8 offset:33792
v_mfma_f32_16x16x32_bf16 v[212:215], a[112:115], a[56:59], v[212:215]
buffer_load_dwordx4 v14, s[36:39], s64 offen lds
v_mfma_f32_16x16x32_bf16 v[212:215], a[116:119], a[60:63], v[212:215]
ds_read_b64_tr_b16 a[92:93], v8 offset:40960
v_mfma_f32_16x16x32_bf16 v[204:207], a[116:119], a[52:55], v[204:207]
s_xor_b32 m0, s77, 67584
ds_read_b64_tr_b16 a[94:95], v8 offset:41984
v_mfma_f32_16x16x32_bf16 v[204:207], a[112:115], a[48:51], v[204:207]
s_xor_b32 s64, s71, 1638400
ds_read_b64_tr_b16 a[96:97], v9 offset:32768
v_mfma_f32_16x16x32_bf16 v[196:199], a[112:115], a[40:43], v[196:199]
buffer_load_dwordx4 v15, s[36:39], s64 offen lds
v_mfma_f32_16x16x32_bf16 v[196:199], a[116:119], a[44:47], v[196:199]
ds_read_b64_tr_b16 a[98:99], v9 offset:33792
v_mfma_f32_16x16x32_bf16 v[188:191], a[116:119], a[36:39], v[188:191]
s_xor_b32 m0, s77, 68608
ds_read_b64_tr_b16 a[100:101], v9 offset:40960
v_mfma_f32_16x16x32_bf16 v[188:191], a[112:115], a[32:35], v[188:191]
s_xor_b32 s64, s71, 1671168
ds_read_b64_tr_b16 a[102:103], v9 offset:41984
v_mfma_f32_16x16x32_bf16 v[216:219], a[72:75], a[32:35], v[216:219]
s_waitcnt lgkmcnt(7)
buffer_load_dwordx4 v15, s[36:39], s64 offen lds
v_mfma_f32_16x16x32_bf16 v[216:219], a[76:79], a[36:39], v[216:219]
global_load_dwordx4 a[148:151], v18, s[4:5] offset:512
v_mfma_f32_16x16x32_bf16 v[224:227], a[76:79], a[44:47], v[224:227]
ds_read_b64_tr_b16 a[104:105], v10 offset:32768
v_mfma_f32_16x16x32_bf16 v[224:227], a[72:75], a[40:43], v[224:227]
s_xor_b32 m0, s77, 81920
ds_read_b64_tr_b16 a[106:107], v10 offset:33792
v_mfma_f32_16x16x32_bf16 v[232:235], a[72:75], a[48:51], v[232:235]
s_xor_b32 s64, s71, 1572864
ds_read_b64_tr_b16 a[108:109], v10 offset:40960
v_mfma_f32_16x16x32_bf16 v[232:235], a[76:79], a[52:55], v[232:235]
buffer_load_dwordx4 v14, s[40:43], s64 offen lds
v_mfma_f32_16x16x32_bf16 v[240:243], a[76:79], a[60:63], v[240:243]
ds_read_b64_tr_b16 a[110:111], v10 offset:41984
v_mfma_f32_16x16x32_bf16 v[240:243], a[72:75], a[56:59], v[240:243]
s_xor_b32 m0, s77, 82944
ds_read_b64_tr_b16 a[112:113], v11 offset:32768
v_mfma_f32_16x16x32_bf16 v[244:247], a[80:83], a[56:59], v[244:247]
s_xor_b32 s64, s71, 1605632
ds_read_b64_tr_b16 a[114:115], v11 offset:33792
v_mfma_f32_16x16x32_bf16 v[244:247], a[84:87], a[60:63], v[244:247]
buffer_load_dwordx4 v14, s[40:43], s64 offen lds
v_mfma_f32_16x16x32_bf16 v[236:239], a[84:87], a[52:55], v[236:239]
ds_read_b64_tr_b16 a[116:117], v11 offset:40960
v_mfma_f32_16x16x32_bf16 v[236:239], a[80:83], a[48:51], v[236:239]
s_xor_b32 m0, s77, 83968
ds_read_b64_tr_b16 a[118:119], v11 offset:41984
v_mfma_f32_16x16x32_bf16 v[228:231], a[80:83], a[40:43], v[228:231]
s_xor_b32 s64, s71, 1638400
ds_read_b64_tr_b16 a[72:73], v4 offset:49152
v_mfma_f32_16x16x32_bf16 v[228:231], a[84:87], a[44:47], v[228:231]
buffer_load_dwordx4 v15, s[40:43], s64 offen lds
v_mfma_f32_16x16x32_bf16 v[220:223], a[84:87], a[36:39], v[220:223]
ds_read_b64_tr_b16 a[74:75], v4 offset:50176
v_mfma_f32_16x16x32_bf16 v[220:223], a[80:83], a[32:35], v[220:223]
s_waitcnt lgkmcnt(7)
s_xor_b32 m0, s77, 84992
ds_read_b64_tr_b16 a[76:77], v4 offset:57344
v_mfma_f32_16x16x32_bf16 v[152:155], a[88:91], a[32:35], v[152:155]
s_xor_b32 s64, s71, 1671168
ds_read_b64_tr_b16 a[78:79], v4 offset:58368
v_mfma_f32_16x16x32_bf16 v[152:155], a[92:95], a[36:39], v[152:155]
buffer_load_dwordx4 v15, s[40:43], s64 offen lds
v_mfma_f32_16x16x32_bf16 v[160:163], a[92:95], a[44:47], v[160:163]
ds_read_b64_tr_b16 a[80:81], v5 offset:49152
v_mfma_f32_16x16x32_bf16 v[160:163], a[88:91], a[40:43], v[160:163]
ds_read_b64_tr_b16 a[82:83], v5 offset:50176
v_mfma_f32_16x16x32_bf16 v[168:171], a[88:91], a[48:51], v[168:171]
ds_read_b64_tr_b16 a[84:85], v5 offset:57344
v_mfma_f32_16x16x32_bf16 v[168:171], a[92:95], a[52:55], v[168:171]
ds_read_b64_tr_b16 a[86:87], v5 offset:58368
v_mfma_f32_16x16x32_bf16 v[176:179], a[92:95], a[60:63], v[176:179]
s_xor_b32 m0, s84, 32768
global_load_dwordx4 a[164:167], v19, s[22:23] offset:512
v_mfma_f32_16x16x32_bf16 v[176:179], a[88:91], a[56:59], v[176:179]
s_xor_b32 s64, s70, 384
ds_read_b64_tr_b16 a[88:89], v6 offset:49152
v_mfma_f32_16x16x32_bf16 v[180:183], a[96:99], a[56:59], v[180:183]
buffer_load_dwordx4 v12, s[32:35], s64 offen lds
v_mfma_f32_16x16x32_bf16 v[180:183], a[100:103], a[60:63], v[180:183]
ds_read_b64_tr_b16 a[90:91], v6 offset:50176
v_mfma_f32_16x16x32_bf16 v[172:175], a[100:103], a[52:55], v[172:175]
ds_read_b64_tr_b16 a[92:93], v6 offset:57344
v_mfma_f32_16x16x32_bf16 v[172:175], a[96:99], a[48:51], v[172:175]
ds_read_b64_tr_b16 a[94:95], v6 offset:58368
v_mfma_f32_16x16x32_bf16 v[164:167], a[96:99], a[40:43], v[164:167]
v_mfma_f32_16x16x32_bf16 v[164:167], a[100:103], a[44:47], v[164:167]
s_xor_b32 m0, s84, 33792
v_mfma_f32_16x16x32_bf16 v[156:159], a[100:103], a[36:39], v[156:159]
s_xor_b32 s64, s70, 8576
v_mfma_f32_16x16x32_bf16 v[156:159], a[96:99], a[32:35], v[156:159]
buffer_load_dwordx4 v13, s[32:35], s64 offen lds
v_mfma_f32_16x16x32_bf16 v[24:27], a[104:107], a[32:35], v[24:27]
s_waitcnt lgkmcnt(4)
ds_read_b64_tr_b16 a[96:97], v7 offset:49152
v_mfma_f32_16x16x32_bf16 v[24:27], a[108:111], a[36:39], v[24:27]
ds_read_b64_tr_b16 a[98:99], v7 offset:50176
v_mfma_f32_16x16x32_bf16 v[40:43], a[108:111], a[44:47], v[40:43]
ds_read_b64_tr_b16 a[100:101], v7 offset:57344
v_mfma_f32_16x16x32_bf16 v[40:43], a[104:107], a[40:43], v[40:43]
ds_read_b64_tr_b16 a[102:103], v7 offset:58368
v_mfma_f32_16x16x32_bf16 v[56:59], a[104:107], a[48:51], v[56:59]
s_xor_b32 m0, s84, 34816
v_mfma_f32_16x16x32_bf16 v[56:59], a[108:111], a[52:55], v[56:59]
s_xor_b32 s64, s70, 16768
v_mfma_f32_16x16x32_bf16 v[72:75], a[108:111], a[60:63], v[72:75]
s_waitcnt vmcnt(12)
buffer_load_dwordx4 v12, s[32:35], s64 offen lds
v_mfma_f32_16x16x32_bf16 v[72:75], a[104:107], a[56:59], v[72:75]
ds_read_b64_tr_b16 a[104:105], v8 offset:49152
v_mfma_f32_16x16x32_bf16 v[136:139], a[112:115], a[56:59], v[136:139]
ds_read_b64_tr_b16 a[106:107], v8 offset:50176
v_mfma_f32_16x16x32_bf16 v[136:139], a[116:119], a[60:63], v[136:139]
ds_read_b64_tr_b16 a[108:109], v8 offset:57344
v_add_u32 v4, 0x8000, v4
v_mfma_f32_16x16x32_bf16 v[120:123], a[116:119], a[52:55], v[120:123]
ds_read_b64_tr_b16 a[110:111], v8 offset:58368
v_mfma_f32_16x16x32_bf16 v[120:123], a[112:115], a[48:51], v[120:123]
s_xor_b32 m0, s84, 35840
ds_read_b128 a[0:3], v2 offset:0
v_mfma_f32_16x16x32_bf16 v[104:107], a[112:115], a[40:43], v[104:107]
s_xor_b32 s64, s70, 24960
global_load_dwordx4 a[152:155], v18, s[4:5] offset:1024
v_mfma_f32_16x16x32_bf16 v[104:107], a[116:119], a[44:47], v[104:107]
s_branch L_po2
L_pg2:
s_branch L_tr0
L_po2:
buffer_load_dwordx4 v13, s[32:35], s64 offen lds
v_mfma_f32_16x16x32_bf16 v[88:91], a[116:119], a[36:39], v[88:91]
ds_read_b128 a[4:7], v3 offset:0
v_mfma_f32_16x16x32_bf16 v[88:91], a[112:115], a[32:35], v[88:91]
ds_read_b128 a[8:11], v2 offset:2048
v_mfma_f32_16x16x32_bf16 v[28:31], a[32:35], a[72:75], v[28:31]
ds_read_b128 a[12:15], v3 offset:2048
v_mfma_f32_16x16x32_bf16 v[28:31], a[36:39], a[76:79], v[28:31]
ds_read_b128 a[16:19], v2 offset:4096
v_add_u32 v5, 0x8000, v5
v_mfma_f32_16x16x32_bf16 v[44:47], a[44:47], a[76:79], v[44:47]
s_xor_b32 m0, s84, 36864
ds_read_b128 a[20:23], v3 offset:4096
v_mfma_f32_16x16x32_bf16 v[44:47], a[40:43], a[72:75], v[44:47]
s_xor_b32 s64, s70, 33152
ds_read_b128 a[24:27], v2 offset:6144
v_mfma_f32_16x16x32_bf16 v[60:63], a[48:51], a[72:75], v[60:63]
buffer_load_dwordx4 v12, s[32:35], s64 offen lds
v_mfma_f32_16x16x32_bf16 v[60:63], a[52:55], a[76:79], v[60:63]
ds_read_b128 a[28:31], v3 offset:6144
v_mfma_f32_16x16x32_bf16 v[76:79], a[60:63], a[76:79], v[76:79]
ds_read_b64_tr_b16 a[112:113], v9 offset:49152
v_mfma_f32_16x16x32_bf16 v[76:79], a[56:59], a[72:75], v[76:79]
ds_read_b64_tr_b16 a[114:115], v9 offset:50176
v_mfma_f32_16x16x32_bf16 v[140:143], a[56:59], a[80:83], v[140:143]
ds_read_b64_tr_b16 a[116:117], v9 offset:57344
v_mfma_f32_16x16x32_bf16 v[140:143], a[60:63], a[84:87], v[140:143]
s_xor_b32 m0, s84, 37888
ds_read_b64_tr_b16 a[118:119], v9 offset:58368
v_add_u32 v6, 0x8000, v6
v_mfma_f32_16x16x32_bf16 v[124:127], a[52:55], a[84:87], v[124:127]
s_xor_b32 s64, s70, 41344
ds_read_b64_tr_b16 a[72:73], v10 offset:49152
v_mfma_f32_16x16x32_bf16 v[124:127], a[48:51], a[80:83], v[124:127]
buffer_load_dwordx4 v13, s[32:35], s64 offen lds
v_mfma_f32_16x16x32_bf16 v[108:111], a[40:43], a[80:83], v[108:111]
ds_read_b64_tr_b16 a[74:75], v10 offset:50176
v_mfma_f32_16x16x32_bf16 v[108:111], a[44:47], a[84:87], v[108:111]
ds_read_b64_tr_b16 a[76:77], v10 offset:57344
v_mfma_f32_16x16x32_bf16 v[92:95], a[36:39], a[84:87], v[92:95]
ds_read_b64_tr_b16 a[78:79], v10 offset:58368
v_mfma_f32_16x16x32_bf16 v[92:95], a[32:35], a[80:83], v[92:95]
s_waitcnt lgkmcnt(8)
ds_read_b64_tr_b16 a[80:81], v11 offset:49152
v_mfma_f32_16x16x32_bf16 v[32:35], a[32:35], a[88:91], v[32:35]
s_xor_b32 m0, s84, 38912
ds_read_b64_tr_b16 a[82:83], v11 offset:50176
v_mfma_f32_16x16x32_bf16 v[32:35], a[36:39], a[92:95], v[32:35]
s_xor_b32 s64, s70, 49536
ds_read_b64_tr_b16 a[84:85], v11 offset:57344
v_add_u32 v7, 0x8000, v7
v_mfma_f32_16x16x32_bf16 v[48:51], a[44:47], a[92:95], v[48:51]
buffer_load_dwordx4 v12, s[32:35], s64 offen lds
v_mfma_f32_16x16x32_bf16 v[48:51], a[40:43], a[88:91], v[48:51]
global_load_dwordx4 a[168:171], v19, s[22:23] offset:1024
v_mfma_f32_16x16x32_bf16 v[64:67], a[48:51], a[88:91], v[64:67]
ds_read_b64_tr_b16 a[86:87], v11 offset:58368
v_mfma_f32_16x16x32_bf16 v[64:67], a[52:55], a[92:95], v[64:67]
v_mfma_f32_16x16x32_bf16 v[80:83], a[60:63], a[92:95], v[80:83]
v_mfma_f32_16x16x32_bf16 v[80:83], a[56:59], a[88:91], v[80:83]
s_xor_b32 m0, s84, 39936
v_mfma_f32_16x16x32_bf16 v[144:147], a[56:59], a[96:99], v[144:147]
s_xor_b32 s64, s70, 57728
v_mfma_f32_16x16x32_bf16 v[144:147], a[60:63], a[100:103], v[144:147]
buffer_load_dwordx4 v13, s[32:35], s64 offen lds
v_mfma_f32_16x16x32_bf16 v[128:131], a[52:55], a[100:103], v[128:131]
v_add_u32 v8, 0x8000, v8
v_mfma_f32_16x16x32_bf16 v[128:131], a[48:51], a[96:99], v[128:131]
v_mfma_f32_16x16x32_bf16 v[112:115], a[40:43], a[96:99], v[112:115]
v_mfma_f32_16x16x32_bf16 v[112:115], a[44:47], a[100:103], v[112:115]
v_mfma_f32_16x16x32_bf16 v[96:99], a[36:39], a[100:103], v[96:99]
v_add_u32 v9, 0x8000, v9
v_add_u32 v10, 0x8000, v10
v_mfma_f32_16x16x32_bf16 v[96:99], a[32:35], a[96:99], v[96:99]
v_add_u32 v11, 0x8000, v11
v_mfma_f32_16x16x32_bf16 v[36:39], a[32:35], a[104:107], v[36:39]
v_mfma_f32_16x16x32_bf16 v[36:39], a[36:39], a[108:111], v[36:39]
v_mfma_f32_16x16x32_bf16 v[52:55], a[44:47], a[108:111], v[52:55]
s_cmp_eq_u32 s30, 0
s_cbranch_scc1 L_pg6
s_cmp_eq_u32 s30, 1
s_cbranch_scc1 L_pg7
s_cmp_eq_u32 s30, 2
s_cbranch_scc1 L_pg8
s_branch L_pg9
L_tr1:
s_waitcnt lgkmcnt(0)
s_barrier
v_mfma_f32_16x16x32_bf16 v[52:55], a[40:43], a[104:107], v[52:55]
s_xor_b32 m0, s77, 98304
ds_read_b64_tr_b16 a[88:89], v4 offset:32768
v_mfma_f32_16x16x32_bf16 v[68:71], a[48:51], a[104:107], v[68:71]
s_xor_b32 s64, s71, 2097152
ds_read_b64_tr_b16 a[90:91], v4 offset:33792
v_mfma_f32_16x16x32_bf16 v[68:71], a[52:55], a[108:111], v[68:71]
buffer_load_dwordx4 v14, s[36:39], s64 offen lds
v_mfma_f32_16x16x32_bf16 v[84:87], a[60:63], a[108:111], v[84:87]
ds_read_b64_tr_b16 a[92:93], v4 offset:40960
v_mfma_f32_16x16x32_bf16 v[84:87], a[56:59], a[104:107], v[84:87]
ds_read_b64_tr_b16 a[94:95], v4 offset:41984
v_mfma_f32_16x16x32_bf16 v[148:151], a[56:59], a[112:115], v[148:151]
global_load_dwordx4 a[156:159], v18, s[4:5] offset:1536
v_mfma_f32_16x16x32_bf16 v[148:151], a[60:63], a[116:119], v[148:151]
ds_read_b64_tr_b16 a[96:97], v5 offset:32768
v_mfma_f32_16x16x32_bf16 v[132:135], a[52:55], a[116:119], v[132:135]
ds_read_b64_tr_b16 a[98:99], v5 offset:33792
v_mfma_f32_16x16x32_bf16 v[132:135], a[48:51], a[112:115], v[132:135]
s_xor_b32 m0, s77, 99328
ds_read_b64_tr_b16 a[100:101], v5 offset:40960
v_mfma_f32_16x16x32_bf16 v[116:119], a[40:43], a[112:115], v[116:119]
s_xor_b32 s64, s71, 2129920
ds_read_b64_tr_b16 a[102:103], v5 offset:41984
v_mfma_f32_16x16x32_bf16 v[116:119], a[44:47], a[116:119], v[116:119]
buffer_load_dwordx4 v14, s[36:39], s64 offen lds
v_mfma_f32_16x16x32_bf16 v[100:103], a[36:39], a[116:119], v[100:103]
ds_read_b64_tr_b16 a[104:105], v6 offset:32768
v_mfma_f32_16x16x32_bf16 v[100:103], a[32:35], a[112:115], v[100:103]
ds_read_b64_tr_b16 a[106:107], v6 offset:33792
v_mfma_f32_16x16x32_bf16 v[248:251], a[32:35], a[72:75], v[248:251]
ds_read_b64_tr_b16 a[108:109], v6 offset:40960
v_mfma_f32_16x16x32_bf16 v[248:251], a[36:39], a[76:79], v[248:251]
ds_read_b64_tr_b16 a[110:111], v6 offset:41984
v_mfma_f32_16x16x32_bf16 v[252:255], a[44:47], a[76:79], v[252:255]
ds_read_b64_tr_b16 a[112:113], v7 offset:32768
v_mfma_f32_16x16x32_bf16 v[252:255], a[40:43], a[72:75], v[252:255]
s_xor_b32 m0, s77, 100352
ds_read_b64_tr_b16 a[114:115], v7 offset:33792
v_mfma_f32_16x16x32_bf16 a[120:123], a[48:51], a[72:75], a[120:123]
s_xor_b32 s64, s71, 2162688
ds_read_b64_tr_b16 a[116:117], v7 offset:40960
v_mfma_f32_16x16x32_bf16 a[120:123], a[52:55], a[76:79], a[120:123]
buffer_load_dwordx4 v15, s[36:39], s64 offen lds
v_mfma_f32_16x16x32_bf16 a[124:127], a[60:63], a[76:79], a[124:127]
ds_read_b64_tr_b16 a[118:119], v7 offset:41984
v_mfma_f32_16x16x32_bf16 a[124:127], a[56:59], a[72:75], a[124:127]
ds_read_b64_tr_b16 a[72:73], v8 offset:32768
v_mfma_f32_16x16x32_bf16 a[128:131], a[56:59], a[80:83], a[128:131]
ds_read_b64_tr_b16 a[74:75], v8 offset:33792
v_mfma_f32_16x16x32_bf16 a[128:131], a[60:63], a[84:87], a[128:131]
ds_read_b64_tr_b16 a[76:77], v8 offset:40960
v_mfma_f32_16x16x32_bf16 a[132:135], a[52:55], a[84:87], a[132:135]
ds_read_b64_tr_b16 a[78:79], v8 offset:41984
v_mfma_f32_16x16x32_bf16 a[132:135], a[48:51], a[80:83], a[132:135]
s_xor_b32 m0, s77, 101376
v_mfma_f32_16x16x32_bf16 a[136:139], a[40:43], a[80:83], a[136:139]
s_xor_b32 s64, s71, 2195456
v_mfma_f32_16x16x32_bf16 a[136:139], a[44:47], a[84:87], a[136:139]
buffer_load_dwordx4 v15, s[36:39], s64 offen lds
v_mfma_f32_16x16x32_bf16 a[140:143], a[36:39], a[84:87], a[140:143]
global_load_dwordx4 a[172:175], v19, s[22:23] offset:1536
v_mfma_f32_16x16x32_bf16 a[140:143], a[32:35], a[80:83], a[140:143]
s_waitcnt lgkmcnt(5)
ds_read_b64_tr_b16 a[80:81], v9 offset:32768
v_mfma_f32_16x16x32_bf16 v[184:187], a[88:91], a[0:3], v[184:187]
ds_read_b64_tr_b16 a[82:83], v9 offset:33792
v_mfma_f32_16x16x32_bf16 v[184:187], a[92:95], a[4:7], v[184:187]
ds_read_b64_tr_b16 a[84:85], v9 offset:40960
v_mfma_f32_16x16x32_bf16 v[192:195], a[92:95], a[12:15], v[192:195]
ds_read_b64_tr_b16 a[86:87], v9 offset:41984
v_mfma_f32_16x16x32_bf16 v[192:195], a[88:91], a[8:11], v[192:195]
s_xor_b32 m0, s77, 114688
v_mfma_f32_16x16x32_bf16 v[200:203], a[88:91], a[16:19], v[200:203]
s_xor_b32 s64, s71, 2097152
v_mfma_f32_16x16x32_bf16 v[200:203], a[92:95], a[20:23], v[200:203]
buffer_load_dwordx4 v14, s[40:43], s64 offen lds
v_mfma_f32_16x16x32_bf16 v[208:211], a[92:95], a[28:31], v[208:211]
v_mfma_f32_16x16x32_bf16 v[208:211], a[88:91], a[24:27], v[208:211]
ds_read_b64_tr_b16 a[88:89], v10 offset:32768
v_mfma_f32_16x16x32_bf16 v[212:215], a[96:99], a[24:27], v[212:215]
ds_read_b64_tr_b16 a[90:91], v10 offset:33792
v_mfma_f32_16x16x32_bf16 v[212:215], a[100:103], a[28:31], v[212:215]
ds_read_b64_tr_b16 a[92:93], v10 offset:40960
v_mfma_f32_16x16x32_bf16 v[204:207], a[100:103], a[20:23], v[204:207]
ds_read_b64_tr_b16 a[94:95], v10 offset:41984
v_mfma_f32_16x16x32_bf16 v[204:207], a[96:99], a[16:19], v[204:207]
s_xor_b32 m0, s77, 115712
v_mfma_f32_16x16x32_bf16 v[196:199], a[96:99], a[8:11], v[196:199]
s_xor_b32 s64, s71, 2129920
v_mfma_f32_16x16x32_bf16 v[196:199], a[100:103], a[12:15], v[196:199]
buffer_load_dwordx4 v14, s[40:43], s64 offen lds
v_mfma_f32_16x16x32_bf16 v[188:191], a[100:103], a[4:7], v[188:191]
v_mfma_f32_16x16x32_bf16 v[188:191], a[96:99], a[0:3], v[188:191]
ds_read_b64_tr_b16 a[96:97], v11 offset:32768
v_mfma_f32_16x16x32_bf16 v[216:219], a[104:107], a[0:3], v[216:219]
ds_read_b64_tr_b16 a[98:99], v11 offset:33792
v_mfma_f32_16x16x32_bf16 v[216:219], a[108:111], a[4:7], v[216:219]
ds_read_b64_tr_b16 a[100:101], v11 offset:40960
v_mfma_f32_16x16x32_bf16 v[224:227], a[108:111], a[12:15], v[224:227]
ds_read_b64_tr_b16 a[102:103], v11 offset:41984
v_mfma_f32_16x16x32_bf16 v[224:227], a[104:107], a[8:11], v[224:227]
s_xor_b32 m0, s77, 116736
v_mfma_f32_16x16x32_bf16 v[232:235], a[104:107], a[16:19], v[232:235]
s_xor_b32 s64, s71, 2162688
buffer_store_dword v21, v20, s[44:47], s69 offen sc1
v_mfma_f32_16x16x32_bf16 v[232:235], a[108:111], a[20:23], v[232:235]
buffer_load_dwordx4 v15, s[40:43], s64 offen lds
v_mfma_f32_16x16x32_bf16 v[240:243], a[108:111], a[28:31], v[240:243]
v_mfma_f32_16x16x32_bf16 v[240:243], a[104:107], a[24:27], v[240:243]
ds_read_b64_tr_b16 a[104:105], v4 offset:49152
v_mfma_f32_16x16x32_bf16 v[244:247], a[112:115], a[24:27], v[244:247]
s_waitcnt lgkmcnt(5)
ds_read_b64_tr_b16 a[106:107], v4 offset:50176
v_mfma_f32_16x16x32_bf16 v[244:247], a[116:119], a[28:31], v[244:247]
ds_read_b64_tr_b16 a[108:109], v4 offset:57344
v_mfma_f32_16x16x32_bf16 v[236:239], a[116:119], a[20:23], v[236:239]
ds_read_b64_tr_b16 a[110:111], v4 offset:58368
v_mfma_f32_16x16x32_bf16 v[236:239], a[112:115], a[16:19], v[236:239]
s_xor_b32 m0, s77, 117760
v_mfma_f32_16x16x32_bf16 v[228:231], a[112:115], a[8:11], v[228:231]
s_xor_b32 s64, s71, 2195456
v_mfma_f32_16x16x32_bf16 v[228:231], a[116:119], a[12:15], v[228:231]
buffer_load_dwordx4 v15, s[40:43], s64 offen lds
v_mfma_f32_16x16x32_bf16 v[220:223], a[116:119], a[4:7], v[220:223]
v_mfma_f32_16x16x32_bf16 v[220:223], a[112:115], a[0:3], v[220:223]
ds_read_b64_tr_b16 a[112:113], v5 offset:49152
v_mfma_f32_16x16x32_bf16 v[152:155], a[72:75], a[0:3], v[152:155]
ds_read_b64_tr_b16 a[114:115], v5 offset:50176
v_mfma_f32_16x16x32_bf16 v[152:155], a[76:79], a[4:7], v[152:155]
ds_read_b64_tr_b16 a[116:117], v5 offset:57344
v_mfma_f32_16x16x32_bf16 v[160:163], a[76:79], a[12:15], v[160:163]
ds_read_b64_tr_b16 a[118:119], v5 offset:58368
v_mfma_f32_16x16x32_bf16 v[160:163], a[72:75], a[8:11], v[160:163]
v_mfma_f32_16x16x32_bf16 v[168:171], a[72:75], a[16:19], v[168:171]
v_mfma_f32_16x16x32_bf16 v[168:171], a[76:79], a[20:23], v[168:171]
v_mfma_f32_16x16x32_bf16 v[176:179], a[76:79], a[28:31], v[176:179]
s_xor_b32 m0, s84, 0
v_mfma_f32_16x16x32_bf16 v[176:179], a[72:75], a[24:27], v[176:179]
s_xor_b32 s64, s70, 512
ds_read_b64_tr_b16 a[72:73], v6 offset:49152
v_mfma_f32_16x16x32_bf16 v[180:183], a[80:83], a[24:27], v[180:183]
buffer_load_dwordx4 v12, s[32:35], s64 offen lds
v_mfma_f32_16x16x32_bf16 v[180:183], a[84:87], a[28:31], v[180:183]
ds_read_b64_tr_b16 a[74:75], v6 offset:50176
v_mfma_f32_16x16x32_bf16 v[172:175], a[84:87], a[20:23], v[172:175]
ds_read_b64_tr_b16 a[76:77], v6 offset:57344
v_mfma_f32_16x16x32_bf16 v[172:175], a[80:83], a[16:19], v[172:175]
ds_read_b64_tr_b16 a[78:79], v6 offset:58368
v_mfma_f32_16x16x32_bf16 v[164:167], a[80:83], a[8:11], v[164:167]
buffer_load_dword a252, v16, s[56:59], s81 offen
v_mfma_f32_16x16x32_bf16 v[164:167], a[84:87], a[12:15], v[164:167]
s_xor_b32 m0, s84, 1024
v_mfma_f32_16x16x32_bf16 v[156:159], a[84:87], a[4:7], v[156:159]
s_xor_b32 s64, s70, 8704
v_mfma_f32_16x16x32_bf16 v[156:159], a[80:83], a[0:3], v[156:159]
buffer_load_dwordx4 v13, s[32:35], s64 offen lds
v_mfma_f32_16x16x32_bf16 v[24:27], a[88:91], a[0:3], v[24:27]
ds_read_b64_tr_b16 a[80:81], v7 offset:49152
v_mfma_f32_16x16x32_bf16 v[24:27], a[92:95], a[4:7], v[24:27]
ds_read_b64_tr_b16 a[82:83], v7 offset:50176
v_mfma_f32_16x16x32_bf16 v[40:43], a[92:95], a[12:15], v[40:43]
ds_read_b64_tr_b16 a[84:85], v7 offset:57344
v_mfma_f32_16x16x32_bf16 v[40:43], a[88:91], a[8:11], v[40:43]
ds_read_b64_tr_b16 a[86:87], v7 offset:58368
v_mfma_f32_16x16x32_bf16 v[56:59], a[88:91], a[16:19], v[56:59]
s_xor_b32 m0, s84, 2048
v_mfma_f32_16x16x32_bf16 v[56:59], a[92:95], a[20:23], v[56:59]
s_xor_b32 s64, s70, 16896
v_mfma_f32_16x16x32_bf16 v[72:75], a[92:95], a[28:31], v[72:75]
s_waitcnt vmcnt(14)
buffer_load_dwordx4 v12, s[32:35], s64 offen lds
v_mfma_f32_16x16x32_bf16 v[72:75], a[88:91], a[24:27], v[72:75]
s_waitcnt lgkmcnt(4)
ds_read_b64_tr_b16 a[88:89], v8 offset:49152
v_mfma_f32_16x16x32_bf16 v[136:139], a[96:99], a[24:27], v[136:139]
ds_read_b64_tr_b16 a[90:91], v8 offset:50176
v_mfma_f32_16x16x32_bf16 v[136:139], a[100:103], a[28:31], v[136:139]
ds_read_b64_tr_b16 a[92:93], v8 offset:57344
v_subrev_u32 v4, 0x8000, v4
v_mfma_f32_16x16x32_bf16 v[120:123], a[100:103], a[20:23], v[120:123]
ds_read_b64_tr_b16 a[94:95], v8 offset:58368
v_mfma_f32_16x16x32_bf16 v[120:123], a[96:99], a[16:19], v[120:123]
s_xor_b32 m0, s84, 3072
ds_read_b128 a[32:35], v2 offset:32768
v_mfma_f32_16x16x32_bf16 v[104:107], a[96:99], a[8:11], v[104:107]
s_xor_b32 s64, s70, 25088
ds_read_b128 a[36:39], v3 offset:32768
v_mfma_f32_16x16x32_bf16 v[104:107], a[100:103], a[12:15], v[104:107]
buffer_load_dwordx4 v13, s[32:35], s64 offen lds
v_mfma_f32_16x16x32_bf16 v[88:91], a[100:103], a[4:7], v[88:91]
ds_read_b128 a[40:43], v2 offset:34816
v_mfma_f32_16x16x32_bf16 v[88:91], a[96:99], a[0:3], v[88:91]
ds_read_b128 a[44:47], v3 offset:34816
v_mfma_f32_16x16x32_bf16 v[28:31], a[0:3], a[104:107], v[28:31]
ds_read_b128 a[48:51], v2 offset:36864
v_mfma_f32_16x16x32_bf16 v[28:31], a[4:7], a[108:111], v[28:31]
ds_read_b128 a[52:55], v3 offset:36864
v_subrev_u32 v5, 0x8000, v5
v_mfma_f32_16x16x32_bf16 v[44:47], a[12:15], a[108:111], v[44:47]
s_xor_b32 m0, s84, 4096
ds_read_b128 a[56:59], v2 offset:38912
v_mfma_f32_16x16x32_bf16 v[44:47], a[8:11], a[104:107], v[44:47]
s_xor_b32 s64, s70, 33280
ds_read_b128 a[60:63], v3 offset:38912
v_mfma_f32_16x16x32_bf16 v[60:63], a[16:19], a[104:107], v[60:63]
buffer_load_dwordx4 v12, s[32:35], s64 offen lds
v_mfma_f32_16x16x32_bf16 v[60:63], a[20:23], a[108:111], v[60:63]
ds_read_b64_tr_b16 a[96:97], v9 offset:49152
v_mfma_f32_16x16x32_bf16 v[76:79], a[28:31], a[108:111], v[76:79]
ds_read_b64_tr_b16 a[98:99], v9 offset:50176
v_mfma_f32_16x16x32_bf16 v[76:79], a[24:27], a[104:107], v[76:79]
ds_read_b64_tr_b16 a[100:101], v9 offset:57344
v_mfma_f32_16x16x32_bf16 v[140:143], a[24:27], a[112:115], v[140:143]
ds_read_b64_tr_b16 a[102:103], v9 offset:58368
v_mfma_f32_16x16x32_bf16 v[140:143], a[28:31], a[116:119], v[140:143]
s_xor_b32 m0, s84, 5120
ds_read_b64_tr_b16 a[104:105], v10 offset:49152
v_subrev_u32 v6, 0x8000, v6
v_mfma_f32_16x16x32_bf16 v[124:127], a[20:23], a[116:119], v[124:127]
s_xor_b32 s64, s70, 41472
ds_read_b64_tr_b16 a[106:107], v10 offset:50176
v_mfma_f32_16x16x32_bf16 v[124:127], a[16:19], a[112:115], v[124:127]
buffer_load_dwordx4 v13, s[32:35], s64 offen lds
v_mfma_f32_16x16x32_bf16 v[108:111], a[8:11], a[112:115], v[108:111]
ds_read_b64_tr_b16 a[108:109], v10 offset:57344
v_mfma_f32_16x16x32_bf16 v[108:111], a[12:15], a[116:119], v[108:111]
ds_read_b64_tr_b16 a[110:111], v10 offset:58368
v_mfma_f32_16x16x32_bf16 v[92:95], a[4:7], a[116:119], v[92:95]
v_mfma_f32_16x16x32_bf16 v[92:95], a[0:3], a[112:115], v[92:95]
ds_read_b64_tr_b16 a[112:113], v11 offset:49152
v_mfma_f32_16x16x32_bf16 v[32:35], a[0:3], a[72:75], v[32:35]
s_xor_b32 m0, s84, 6144
ds_read_b64_tr_b16 a[114:115], v11 offset:50176
v_mfma_f32_16x16x32_bf16 v[32:35], a[4:7], a[76:79], v[32:35]
s_xor_b32 s64, s70, 49664
ds_read_b64_tr_b16 a[116:117], v11 offset:57344
v_subrev_u32 v7, 0x8000, v7
v_mfma_f32_16x16x32_bf16 v[48:51], a[12:15], a[76:79], v[48:51]
buffer_load_dwordx4 v12, s[32:35], s64 offen lds
v_mfma_f32_16x16x32_bf16 v[48:51], a[8:11], a[72:75], v[48:51]
ds_read_b64_tr_b16 a[118:119], v11 offset:58368
v_mfma_f32_16x16x32_bf16 v[64:67], a[16:19], a[72:75], v[64:67]
buffer_load_dword a252, v1, s[60:63], s82 offen
v_mfma_f32_16x16x32_bf16 v[64:67], a[20:23], a[76:79], v[64:67]
v_mfma_f32_16x16x32_bf16 v[80:83], a[28:31], a[76:79], v[80:83]
v_mfma_f32_16x16x32_bf16 v[80:83], a[24:27], a[72:75], v[80:83]
s_waitcnt lgkmcnt(4)
s_xor_b32 m0, s84, 7168
v_mfma_f32_16x16x32_bf16 v[144:147], a[24:27], a[80:83], v[144:147]
s_xor_b32 s64, s70, 57856
v_mfma_f32_16x16x32_bf16 v[144:147], a[28:31], a[84:87], v[144:147]
buffer_load_dwordx4 v13, s[32:35], s64 offen lds
v_mfma_f32_16x16x32_bf16 v[128:131], a[20:23], a[84:87], v[128:131]
v_subrev_u32 v8, 0x8000, v8
v_mfma_f32_16x16x32_bf16 v[128:131], a[16:19], a[80:83], v[128:131]
v_mfma_f32_16x16x32_bf16 v[112:115], a[8:11], a[80:83], v[112:115]
v_mfma_f32_16x16x32_bf16 v[112:115], a[12:15], a[84:87], v[112:115]
v_mfma_f32_16x16x32_bf16 v[96:99], a[4:7], a[84:87], v[96:99]
v_subrev_u32 v9, 0x8000, v9
v_subrev_u32 v10, 0x8000, v10
v_mfma_f32_16x16x32_bf16 v[96:99], a[0:3], a[80:83], v[96:99]
v_subrev_u32 v11, 0x8000, v11
v_mfma_f32_16x16x32_bf16 v[36:39], a[0:3], a[88:91], v[36:39]
v_mfma_f32_16x16x32_bf16 v[36:39], a[4:7], a[92:95], v[36:39]
v_mfma_f32_16x16x32_bf16 v[52:55], a[12:15], a[92:95], v[52:55]
s_waitcnt lgkmcnt(0)
s_barrier
v_mfma_f32_16x16x32_bf16 v[52:55], a[8:11], a[88:91], v[52:55]
s_xor_b32 m0, s77, 131072
ds_read_b64_tr_b16 a[72:73], v4 offset:0
v_mfma_f32_16x16x32_bf16 v[68:71], a[16:19], a[88:91], v[68:71]
s_xor_b32 s64, s71, 2621440
ds_read_b64_tr_b16 a[74:75], v4 offset:1024
v_mfma_f32_16x16x32_bf16 v[68:71], a[20:23], a[92:95], v[68:71]
buffer_load_dwordx4 v14, s[36:39], s64 offen lds
v_mfma_f32_16x16x32_bf16 v[84:87], a[28:31], a[92:95], v[84:87]
ds_read_b64_tr_b16 a[76:77], v4 offset:8192
v_mfma_f32_16x16x32_bf16 v[84:87], a[24:27], a[88:91], v[84:87]
ds_read_b64_tr_b16 a[78:79], v4 offset:9216
v_mfma_f32_16x16x32_bf16 v[148:151], a[24:27], a[96:99], v[148:151]
ds_read_b64_tr_b16 a[80:81], v5 offset:0
v_mfma_f32_16x16x32_bf16 v[148:151], a[28:31], a[100:103], v[148:151]
ds_read_b64_tr_b16 a[82:83], v5 offset:1024
v_mfma_f32_16x16x32_bf16 v[132:135], a[20:23], a[100:103], v[132:135]
ds_read_b64_tr_b16 a[84:85], v5 offset:8192
v_mfma_f32_16x16x32_bf16 v[132:135], a[16:19], a[96:99], v[132:135]
s_xor_b32 m0, s77, 132096
ds_read_b64_tr_b16 a[86:87], v5 offset:9216
v_mfma_f32_16x16x32_bf16 v[116:119], a[8:11], a[96:99], v[116:119]
s_xor_b32 s64, s71, 2654208
ds_read_b64_tr_b16 a[88:89], v6 offset:0
v_mfma_f32_16x16x32_bf16 v[116:119], a[12:15], a[100:103], v[116:119]
buffer_load_dwordx4 v14, s[36:39], s64 offen lds
v_mfma_f32_16x16x32_bf16 v[100:103], a[4:7], a[100:103], v[100:103]
ds_read_b64_tr_b16 a[90:91], v6 offset:1024
v_mfma_f32_16x16x32_bf16 v[100:103], a[0:3], a[96:99], v[100:103]
ds_read_b64_tr_b16 a[92:93], v6 offset:8192
v_mfma_f32_16x16x32_bf16 v[248:251], a[0:3], a[104:107], v[248:251]
ds_read_b64_tr_b16 a[94:95], v6 offset:9216
v_mfma_f32_16x16x32_bf16 v[248:251], a[4:7], a[108:111], v[248:251]
ds_read_b64_tr_b16 a[96:97], v7 offset:0
v_mfma_f32_16x16x32_bf16 v[252:255], a[12:15], a[108:111], v[252:255]
ds_read_b64_tr_b16 a[98:99], v7 offset:1024
v_mfma_f32_16x16x32_bf16 v[252:255], a[8:11], a[104:107], v[252:255]
s_xor_b32 m0, s77, 133120
ds_read_b64_tr_b16 a[100:101], v7 offset:8192
v_mfma_f32_16x16x32_bf16 a[120:123], a[16:19], a[104:107], a[120:123]
s_xor_b32 s64, s71, 2686976
ds_read_b64_tr_b16 a[102:103], v7 offset:9216
v_mfma_f32_16x16x32_bf16 a[120:123], a[20:23], a[108:111], a[120:123]
buffer_load_dwordx4 v15, s[36:39], s64 offen lds
v_mfma_f32_16x16x32_bf16 a[124:127], a[28:31], a[108:111], a[124:127]
v_mfma_f32_16x16x32_bf16 a[124:127], a[24:27], a[104:107], a[124:127]
ds_read_b64_tr_b16 a[104:105], v8 offset:0
v_mfma_f32_16x16x32_bf16 a[128:131], a[24:27], a[112:115], a[128:131]
ds_read_b64_tr_b16 a[106:107], v8 offset:1024
v_mfma_f32_16x16x32_bf16 a[128:131], a[28:31], a[116:119], a[128:131]
ds_read_b64_tr_b16 a[108:109], v8 offset:8192
v_mfma_f32_16x16x32_bf16 a[132:135], a[20:23], a[116:119], a[132:135]
ds_read_b64_tr_b16 a[110:111], v8 offset:9216
v_mfma_f32_16x16x32_bf16 a[132:135], a[16:19], a[112:115], a[132:135]
s_xor_b32 m0, s77, 134144
s_add_u32 s81, s81, 1048576
v_mfma_f32_16x16x32_bf16 a[136:139], a[8:11], a[112:115], a[136:139]
s_xor_b32 s64, s71, 2719744
buffer_load_dword a252, v16, s[56:59], s81 offen
v_mfma_f32_16x16x32_bf16 a[136:139], a[12:15], a[116:119], a[136:139]
buffer_load_dwordx4 v15, s[36:39], s64 offen lds
v_mfma_f32_16x16x32_bf16 a[140:143], a[4:7], a[116:119], a[140:143]
v_mfma_f32_16x16x32_bf16 a[140:143], a[0:3], a[112:115], a[140:143]
s_waitcnt lgkmcnt(4)
ds_read_b64_tr_b16 a[112:113], v9 offset:0
v_mfma_f32_16x16x32_bf16 v[184:187], a[72:75], a[32:35], v[184:187]
ds_read_b64_tr_b16 a[114:115], v9 offset:1024
v_mov_b32 v17, 0
v_mfma_f32_16x16x32_bf16 v[184:187], a[76:79], a[36:39], v[184:187]
ds_read_b64_tr_b16 a[116:117], v9 offset:8192
v_accvgpr_read_b32 v19, a144
v_mfma_f32_16x16x32_bf16 v[192:195], a[76:79], a[44:47], v[192:195]
ds_read_b64_tr_b16 a[118:119], v9 offset:9216
v_accvgpr_read_b32 v21, a160
v_mfma_f32_16x16x32_bf16 v[192:195], a[72:75], a[40:43], v[192:195]
s_xor_b32 m0, s77, 147456
v_lshlrev_b32 v18, 16, v19
v_and_b32 v19, 0xffff0000, v19
v_mfma_f32_16x16x32_bf16 v[200:203], a[72:75], a[48:51], v[200:203]
s_xor_b32 s64, s71, 2621440
v_lshlrev_b32 v20, 16, v21
v_and_b32 v21, 0xffff0000, v21
v_mfma_f32_16x16x32_bf16 v[200:203], a[76:79], a[52:55], v[200:203]
buffer_load_dwordx4 v14, s[40:43], s64 offen lds
v_mfma_f32_16x16x32_bf16 v[208:211], a[76:79], a[60:63], v[208:211]
v_mul_f32 v18, v18, v20
v_mul_f32 v19, v19, v21
v_mfma_f32_16x16x32_bf16 v[208:211], a[72:75], a[56:59], v[208:211]
ds_read_b64_tr_b16 a[72:73], v10 offset:0
v_cvt_pk_bf16_f32 v18, v18, v19
v_mfma_f32_16x16x32_bf16 v[212:215], a[80:83], a[56:59], v[212:215]
ds_read_b64_tr_b16 a[74:75], v10 offset:1024
v_lshlrev_b32 v19, 16, v18
v_mfma_f32_16x16x32_bf16 v[212:215], a[84:87], a[60:63], v[212:215]
ds_read_b64_tr_b16 a[76:77], v10 offset:8192
v_and_b32 v18, 0xffff0000, v18
v_mfma_f32_16x16x32_bf16 v[204:207], a[84:87], a[52:55], v[204:207]
ds_read_b64_tr_b16 a[78:79], v10 offset:9216
v_add_f32 v17, v17, v19
v_mfma_f32_16x16x32_bf16 v[204:207], a[80:83], a[48:51], v[204:207]
s_xor_b32 m0, s77, 148480
v_add_f32 v17, v17, v18
v_accvgpr_read_b32 v19, a145
v_mfma_f32_16x16x32_bf16 v[196:199], a[80:83], a[40:43], v[196:199]
s_xor_b32 s64, s71, 2654208
v_accvgpr_read_b32 v21, a161
v_lshlrev_b32 v18, 16, v19
v_mfma_f32_16x16x32_bf16 v[196:199], a[84:87], a[44:47], v[196:199]
buffer_load_dwordx4 v14, s[40:43], s64 offen lds
v_mfma_f32_16x16x32_bf16 v[188:191], a[84:87], a[36:39], v[188:191]
v_and_b32 v19, 0xffff0000, v19
v_lshlrev_b32 v20, 16, v21
v_mfma_f32_16x16x32_bf16 v[188:191], a[80:83], a[32:35], v[188:191]
ds_read_b64_tr_b16 a[80:81], v11 offset:0
v_and_b32 v21, 0xffff0000, v21
v_mfma_f32_16x16x32_bf16 v[216:219], a[88:91], a[32:35], v[216:219]
ds_read_b64_tr_b16 a[82:83], v11 offset:1024
v_mul_f32 v18, v18, v20
v_mfma_f32_16x16x32_bf16 v[216:219], a[92:95], a[36:39], v[216:219]
ds_read_b64_tr_b16 a[84:85], v11 offset:8192
v_mul_f32 v19, v19, v21
v_mfma_f32_16x16x32_bf16 v[224:227], a[92:95], a[44:47], v[224:227]
ds_read_b64_tr_b16 a[86:87], v11 offset:9216
v_cvt_pk_bf16_f32 v18, v18, v19
v_mfma_f32_16x16x32_bf16 v[224:227], a[88:91], a[40:43], v[224:227]
s_xor_b32 m0, s77, 149504
v_lshlrev_b32 v19, 16, v18
v_and_b32 v18, 0xffff0000, v18
v_mfma_f32_16x16x32_bf16 v[232:235], a[88:91], a[48:51], v[232:235]
s_xor_b32 s64, s71, 2686976
v_add_f32 v17, v17, v19
v_add_f32 v17, v17, v18
v_mfma_f32_16x16x32_bf16 v[232:235], a[92:95], a[52:55], v[232:235]
buffer_load_dwordx4 v15, s[40:43], s64 offen lds
v_mfma_f32_16x16x32_bf16 v[240:243], a[92:95], a[60:63], v[240:243]
v_accvgpr_read_b32 v19, a146
v_accvgpr_read_b32 v21, a162
v_mfma_f32_16x16x32_bf16 v[240:243], a[88:91], a[56:59], v[240:243]
ds_read_b64_tr_b16 a[88:89], v4 offset:16384
v_lshlrev_b32 v18, 16, v19
v_mfma_f32_16x16x32_bf16 v[244:247], a[96:99], a[56:59], v[244:247]
ds_read_b64_tr_b16 a[90:91], v4 offset:17408
v_and_b32 v19, 0xffff0000, v19
v_mfma_f32_16x16x32_bf16 v[244:247], a[100:103], a[60:63], v[244:247]
ds_read_b64_tr_b16 a[92:93], v4 offset:24576
v_lshlrev_b32 v20, 16, v21
v_mfma_f32_16x16x32_bf16 v[236:239], a[100:103], a[52:55], v[236:239]
ds_read_b64_tr_b16 a[94:95], v4 offset:25600
v_and_b32 v21, 0xffff0000, v21
v_mfma_f32_16x16x32_bf16 v[236:239], a[96:99], a[48:51], v[236:239]
s_xor_b32 m0, s77, 150528
v_mul_f32 v18, v18, v20
v_mul_f32 v19, v19, v21
v_mfma_f32_16x16x32_bf16 v[228:231], a[96:99], a[40:43], v[228:231]
s_xor_b32 s64, s71, 2719744
v_cvt_pk_bf16_f32 v18, v18, v19
v_lshlrev_b32 v19, 16, v18
v_mfma_f32_16x16x32_bf16 v[228:231], a[100:103], a[44:47], v[228:231]
buffer_load_dwordx4 v15, s[40:43], s64 offen lds
v_mfma_f32_16x16x32_bf16 v[220:223], a[100:103], a[36:39], v[220:223]
v_and_b32 v18, 0xffff0000, v18
v_add_f32 v17, v17, v19
v_mfma_f32_16x16x32_bf16 v[220:223], a[96:99], a[32:35], v[220:223]
s_waitcnt lgkmcnt(4)
ds_read_b64_tr_b16 a[96:97], v5 offset:16384
v_add_f32 v17, v17, v18
v_mfma_f32_16x16x32_bf16 v[152:155], a[104:107], a[32:35], v[152:155]
ds_read_b64_tr_b16 a[98:99], v5 offset:17408
v_accvgpr_read_b32 v19, a147
v_mfma_f32_16x16x32_bf16 v[152:155], a[108:111], a[36:39], v[152:155]
ds_read_b64_tr_b16 a[100:101], v5 offset:24576
v_accvgpr_read_b32 v21, a163
v_mfma_f32_16x16x32_bf16 v[160:163], a[108:111], a[44:47], v[160:163]
ds_read_b64_tr_b16 a[102:103], v5 offset:25600
v_lshlrev_b32 v18, 16, v19
v_mfma_f32_16x16x32_bf16 v[160:163], a[104:107], a[40:43], v[160:163]
s_branch L_po3
L_pg3:
s_branch L_tr0
L_po3:
s_add_u32 s82, s82, 1048576
v_and_b32 v19, 0xffff0000, v19
v_lshlrev_b32 v20, 16, v21
v_mfma_f32_16x16x32_bf16 v[168:171], a[104:107], a[48:51], v[168:171]
buffer_load_dword a252, v1, s[60:63], s82 offen
v_mfma_f32_16x16x32_bf16 v[168:171], a[108:111], a[52:55], v[168:171]
v_and_b32 v21, 0xffff0000, v21
v_mul_f32 v18, v18, v20
v_mfma_f32_16x16x32_bf16 v[176:179], a[108:111], a[60:63], v[176:179]
s_xor_b32 m0, s84, 32768
v_mul_f32 v19, v19, v21
v_cvt_pk_bf16_f32 v18, v18, v19
v_mfma_f32_16x16x32_bf16 v[176:179], a[104:107], a[56:59], v[176:179]
s_xor_b32 s64, s70, 640
ds_read_b64_tr_b16 a[104:105], v6 offset:16384
v_lshlrev_b32 v19, 16, v18
v_mfma_f32_16x16x32_bf16 v[180:183], a[112:115], a[56:59], v[180:183]
buffer_load_dwordx4 v12, s[32:35], s64 offen lds
v_mfma_f32_16x16x32_bf16 v[180:183], a[116:119], a[60:63], v[180:183]
ds_read_b64_tr_b16 a[106:107], v6 offset:17408
v_and_b32 v18, 0xffff0000, v18
v_mfma_f32_16x16x32_bf16 v[172:175], a[116:119], a[52:55], v[172:175]
ds_read_b64_tr_b16 a[108:109], v6 offset:24576
v_add_f32 v17, v17, v19
v_mfma_f32_16x16x32_bf16 v[172:175], a[112:115], a[48:51], v[172:175]
ds_read_b64_tr_b16 a[110:111], v6 offset:25600
v_add_f32 v17, v17, v18
v_mfma_f32_16x16x32_bf16 v[164:167], a[112:115], a[40:43], v[164:167]
v_accvgpr_read_b32 v19, a148
v_accvgpr_read_b32 v21, a164
v_mfma_f32_16x16x32_bf16 v[164:167], a[116:119], a[44:47], v[164:167]
s_xor_b32 m0, s84, 33792
v_lshlrev_b32 v18, 16, v19
v_and_b32 v19, 0xffff0000, v19
v_mfma_f32_16x16x32_bf16 v[156:159], a[116:119], a[36:39], v[156:159]
s_xor_b32 s64, s70, 8832
v_lshlrev_b32 v20, 16, v21
v_and_b32 v21, 0xffff0000, v21
v_mfma_f32_16x16x32_bf16 v[156:159], a[112:115], a[32:35], v[156:159]
buffer_load_dwordx4 v13, s[32:35], s64 offen lds
v_mfma_f32_16x16x32_bf16 v[24:27], a[72:75], a[32:35], v[24:27]
ds_read_b64_tr_b16 a[112:113], v7 offset:16384
v_mul_f32 v18, v18, v20
v_mfma_f32_16x16x32_bf16 v[24:27], a[76:79], a[36:39], v[24:27]
ds_read_b64_tr_b16 a[114:115], v7 offset:17408
v_mul_f32 v19, v19, v21
v_mfma_f32_16x16x32_bf16 v[40:43], a[76:79], a[44:47], v[40:43]
ds_read_b64_tr_b16 a[116:117], v7 offset:24576
v_cvt_pk_bf16_f32 v18, v18, v19
v_mfma_f32_16x16x32_bf16 v[40:43], a[72:75], a[40:43], v[40:43]
ds_read_b64_tr_b16 a[118:119], v7 offset:25600
v_lshlrev_b32 v19, 16, v18
v_mfma_f32_16x16x32_bf16 v[56:59], a[72:75], a[48:51], v[56:59]
s_xor_b32 m0, s84, 34816
v_and_b32 v18, 0xffff0000, v18
v_add_f32 v17, v17, v19
v_mfma_f32_16x16x32_bf16 v[56:59], a[76:79], a[52:55], v[56:59]
s_xor_b32 s64, s70, 17024
v_add_f32 v17, v17, v18
v_accvgpr_read_b32 v19, a149
v_mfma_f32_16x16x32_bf16 v[72:75], a[76:79], a[60:63], v[72:75]
s_waitcnt vmcnt(12)
buffer_load_dwordx4 v12, s[32:35], s64 offen lds
v_mfma_f32_16x16x32_bf16 v[72:75], a[72:75], a[56:59], v[72:75]
ds_read_b64_tr_b16 a[72:73], v8 offset:16384
v_accvgpr_read_b32 v21, a165
v_mfma_f32_16x16x32_bf16 v[136:139], a[80:83], a[56:59], v[136:139]
ds_read_b64_tr_b16 a[74:75], v8 offset:17408
v_lshlrev_b32 v18, 16, v19
v_mfma_f32_16x16x32_bf16 v[136:139], a[84:87], a[60:63], v[136:139]
ds_read_b64_tr_b16 a[76:77], v8 offset:24576
v_and_b32 v19, 0xffff0000, v19
v_mfma_f32_16x16x32_bf16 v[120:123], a[84:87], a[52:55], v[120:123]
ds_read_b64_tr_b16 a[78:79], v8 offset:25600
v_lshlrev_b32 v20, 16, v21
v_mfma_f32_16x16x32_bf16 v[120:123], a[80:83], a[48:51], v[120:123]
s_xor_b32 m0, s84, 35840
ds_read_b128 a[0:3], v2 offset:0
v_and_b32 v21, 0xffff0000, v21
v_mfma_f32_16x16x32_bf16 v[104:107], a[80:83], a[40:43], v[104:107]
s_xor_b32 s64, s70, 25216
ds_read_b128 a[4:7], v3 offset:0
v_mul_f32 v18, v18, v20
v_mfma_f32_16x16x32_bf16 v[104:107], a[84:87], a[44:47], v[104:107]
buffer_load_dwordx4 v13, s[32:35], s64 offen lds
v_mfma_f32_16x16x32_bf16 v[88:91], a[84:87], a[36:39], v[88:91]
ds_read_b128 a[8:11], v2 offset:2048
v_mul_f32 v19, v19, v21
v_mfma_f32_16x16x32_bf16 v[88:91], a[80:83], a[32:35], v[88:91]
s_waitcnt lgkmcnt(7)
ds_read_b128 a[12:15], v3 offset:2048
v_cvt_pk_bf16_f32 v18, v18, v19
v_mfma_f32_16x16x32_bf16 v[28:31], a[32:35], a[88:91], v[28:31]
ds_read_b128 a[16:19], v2 offset:4096
v_lshlrev_b32 v19, 16, v18
v_mfma_f32_16x16x32_bf16 v[28:31], a[36:39], a[92:95], v[28:31]
ds_read_b128 a[20:23], v3 offset:4096
v_and_b32 v18, 0xffff0000, v18
v_mfma_f32_16x16x32_bf16 v[44:47], a[44:47], a[92:95], v[44:47]
s_xor_b32 m0, s84, 36864
ds_read_b128 a[24:27], v2 offset:6144
v_add_f32 v17, v17, v19
v_mfma_f32_16x16x32_bf16 v[44:47], a[40:43], a[88:91], v[44:47]
s_xor_b32 s64, s70, 33408
ds_read_b128 a[28:31], v3 offset:6144
v_add_f32 v17, v17, v18
v_mfma_f32_16x16x32_bf16 v[60:63], a[48:51], a[88:91], v[60:63]
buffer_load_dwordx4 v12, s[32:35], s64 offen lds
v_mfma_f32_16x16x32_bf16 v[60:63], a[52:55], a[92:95], v[60:63]
ds_read_b64_tr_b16 a[80:81], v9 offset:16384
v_accvgpr_read_b32 v19, a150
v_mfma_f32_16x16x32_bf16 v[76:79], a[60:63], a[92:95], v[76:79]
ds_read_b64_tr_b16 a[82:83], v9 offset:17408
v_accvgpr_read_b32 v21, a166
v_mfma_f32_16x16x32_bf16 v[76:79], a[56:59], a[88:91], v[76:79]
ds_read_b64_tr_b16 a[84:85], v9 offset:24576
v_lshlrev_b32 v18, 16, v19
v_mfma_f32_16x16x32_bf16 v[140:143], a[56:59], a[96:99], v[140:143]
ds_read_b64_tr_b16 a[86:87], v9 offset:25600
v_and_b32 v19, 0xffff0000, v19
v_mfma_f32_16x16x32_bf16 v[140:143], a[60:63], a[100:103], v[140:143]
s_xor_b32 m0, s84, 37888
ds_read_b64_tr_b16 a[88:89], v10 offset:16384
v_lshlrev_b32 v20, 16, v21
v_mfma_f32_16x16x32_bf16 v[124:127], a[52:55], a[100:103], v[124:127]
s_xor_b32 s64, s70, 41600
ds_read_b64_tr_b16 a[90:91], v10 offset:17408
v_and_b32 v21, 0xffff0000, v21
v_mfma_f32_16x16x32_bf16 v[124:127], a[48:51], a[96:99], v[124:127]
s_add_u32 s81, s81, 1048576
buffer_load_dwordx4 v13, s[32:35], s64 offen lds
v_mfma_f32_16x16x32_bf16 v[108:111], a[40:43], a[96:99], v[108:111]
buffer_load_dword a252, v16, s[56:59], s81 offen
v_mfma_f32_16x16x32_bf16 v[108:111], a[44:47], a[100:103], v[108:111]
ds_read_b64_tr_b16 a[92:93], v10 offset:24576
v_mul_f32 v18, v18, v20
v_mfma_f32_16x16x32_bf16 v[92:95], a[36:39], a[100:103], v[92:95]
ds_read_b64_tr_b16 a[94:95], v10 offset:25600
v_mul_f32 v19, v19, v21
v_mfma_f32_16x16x32_bf16 v[92:95], a[32:35], a[96:99], v[92:95]
ds_read_b64_tr_b16 a[96:97], v11 offset:16384
v_cvt_pk_bf16_f32 v18, v18, v19
v_mfma_f32_16x16x32_bf16 v[32:35], a[32:35], a[104:107], v[32:35]
s_xor_b32 m0, s84, 38912
ds_read_b64_tr_b16 a[98:99], v11 offset:17408
v_lshlrev_b32 v19, 16, v18
v_mfma_f32_16x16x32_bf16 v[32:35], a[36:39], a[108:111], v[32:35]
s_xor_b32 s64, s70, 49792
ds_read_b64_tr_b16 a[100:101], v11 offset:24576
v_and_b32 v18, 0xffff0000, v18
v_mfma_f32_16x16x32_bf16 v[48:51], a[44:47], a[108:111], v[48:51]
buffer_load_dwordx4 v12, s[32:35], s64 offen lds
v_mfma_f32_16x16x32_bf16 v[48:51], a[40:43], a[104:107], v[48:51]
ds_read_b64_tr_b16 a[102:103], v11 offset:25600
v_add_f32 v17, v17, v19
v_mfma_f32_16x16x32_bf16 v[64:67], a[48:51], a[104:107], v[64:67]
v_add_f32 v17, v17, v18
v_accvgpr_read_b32 v19, a151
v_mfma_f32_16x16x32_bf16 v[64:67], a[52:55], a[108:111], v[64:67]
v_accvgpr_read_b32 v21, a167
v_lshlrev_b32 v18, 16, v19
v_mfma_f32_16x16x32_bf16 v[80:83], a[60:63], a[108:111], v[80:83]
v_and_b32 v19, 0xffff0000, v19
v_lshlrev_b32 v20, 16, v21
v_mfma_f32_16x16x32_bf16 v[80:83], a[56:59], a[104:107], v[80:83]
s_xor_b32 m0, s84, 39936
v_and_b32 v21, 0xffff0000, v21
v_mul_f32 v18, v18, v20
v_mfma_f32_16x16x32_bf16 v[144:147], a[56:59], a[112:115], v[144:147]
s_xor_b32 s64, s70, 57984
v_mul_f32 v19, v19, v21
v_cvt_pk_bf16_f32 v18, v18, v19
v_mfma_f32_16x16x32_bf16 v[144:147], a[60:63], a[116:119], v[144:147]
buffer_load_dwordx4 v13, s[32:35], s64 offen lds
v_mfma_f32_16x16x32_bf16 v[128:131], a[52:55], a[116:119], v[128:131]
v_lshlrev_b32 v19, 16, v18
v_and_b32 v18, 0xffff0000, v18
v_mfma_f32_16x16x32_bf16 v[128:131], a[48:51], a[112:115], v[128:131]
v_add_f32 v17, v17, v19
v_add_f32 v17, v17, v18
v_mfma_f32_16x16x32_bf16 v[112:115], a[40:43], a[112:115], v[112:115]
v_accvgpr_read_b32 v19, a152
v_accvgpr_read_b32 v21, a168
v_mfma_f32_16x16x32_bf16 v[112:115], a[44:47], a[116:119], v[112:115]
v_lshlrev_b32 v18, 16, v19
v_and_b32 v19, 0xffff0000, v19
v_mfma_f32_16x16x32_bf16 v[96:99], a[36:39], a[116:119], v[96:99]
v_lshlrev_b32 v20, 16, v21
v_and_b32 v21, 0xffff0000, v21
v_mfma_f32_16x16x32_bf16 v[96:99], a[32:35], a[112:115], v[96:99]
s_waitcnt lgkmcnt(0)
v_mul_f32 v18, v18, v20
v_mul_f32 v19, v19, v21
v_mfma_f32_16x16x32_bf16 v[36:39], a[32:35], a[72:75], v[36:39]
v_cvt_pk_bf16_f32 v18, v18, v19
v_lshlrev_b32 v19, 16, v18
v_mfma_f32_16x16x32_bf16 v[36:39], a[36:39], a[76:79], v[36:39]
v_and_b32 v18, 0xffff0000, v18
v_add_f32 v17, v17, v19
v_mfma_f32_16x16x32_bf16 v[52:55], a[44:47], a[76:79], v[52:55]
s_waitcnt lgkmcnt(0)
s_barrier
v_mfma_f32_16x16x32_bf16 v[52:55], a[40:43], a[72:75], v[52:55]
s_xor_b32 m0, s77, 65536
ds_read_b64_tr_b16 a[104:105], v4 offset:32768
v_add_f32 v17, v17, v18
v_mfma_f32_16x16x32_bf16 v[68:71], a[48:51], a[72:75], v[68:71]
s_xor_b32 s64, s71, 3145728
ds_read_b64_tr_b16 a[106:107], v4 offset:33792
v_accvgpr_read_b32 v19, a153
v_mfma_f32_16x16x32_bf16 v[68:71], a[52:55], a[76:79], v[68:71]
buffer_load_dwordx4 v14, s[36:39], s64 offen lds
v_mfma_f32_16x16x32_bf16 v[84:87], a[60:63], a[76:79], v[84:87]
ds_read_b64_tr_b16 a[108:109], v4 offset:40960
v_accvgpr_read_b32 v21, a169
v_mfma_f32_16x16x32_bf16 v[84:87], a[56:59], a[72:75], v[84:87]
ds_read_b64_tr_b16 a[110:111], v4 offset:41984
v_lshlrev_b32 v18, 16, v19
v_mfma_f32_16x16x32_bf16 v[148:151], a[56:59], a[80:83], v[148:151]
ds_read_b64_tr_b16 a[112:113], v5 offset:32768
v_and_b32 v19, 0xffff0000, v19
v_mfma_f32_16x16x32_bf16 v[148:151], a[60:63], a[84:87], v[148:151]
ds_read_b64_tr_b16 a[114:115], v5 offset:33792
v_lshlrev_b32 v20, 16, v21
v_mfma_f32_16x16x32_bf16 v[132:135], a[52:55], a[84:87], v[132:135]
ds_read_b64_tr_b16 a[116:117], v5 offset:40960
v_and_b32 v21, 0xffff0000, v21
v_mfma_f32_16x16x32_bf16 v[132:135], a[48:51], a[80:83], v[132:135]
s_xor_b32 m0, s77, 66560
ds_read_b64_tr_b16 a[118:119], v5 offset:41984
v_mul_f32 v18, v18, v20
v_mfma_f32_16x16x32_bf16 v[116:119], a[40:43], a[80:83], v[116:119]
s_xor_b32 s64, s71, 3178496
ds_read_b64_tr_b16 a[72:73], v6 offset:32768
v_mul_f32 v19, v19, v21
v_mfma_f32_16x16x32_bf16 v[116:119], a[44:47], a[84:87], v[116:119]
buffer_load_dwordx4 v14, s[36:39], s64 offen lds
v_mfma_f32_16x16x32_bf16 v[100:103], a[36:39], a[84:87], v[100:103]
ds_read_b64_tr_b16 a[74:75], v6 offset:33792
v_cvt_pk_bf16_f32 v18, v18, v19
v_mfma_f32_16x16x32_bf16 v[100:103], a[32:35], a[80:83], v[100:103]
ds_read_b64_tr_b16 a[76:77], v6 offset:40960
v_lshlrev_b32 v19, 16, v18
v_mfma_f32_16x16x32_bf16 v[248:251], a[32:35], a[88:91], v[248:251]
ds_read_b64_tr_b16 a[78:79], v6 offset:41984
v_and_b32 v18, 0xffff0000, v18
v_mfma_f32_16x16x32_bf16 v[248:251], a[36:39], a[92:95], v[248:251]
ds_read_b64_tr_b16 a[80:81], v7 offset:32768
v_add_f32 v17, v17, v19
v_mfma_f32_16x16x32_bf16 v[252:255], a[44:47], a[92:95], v[252:255]
s_add_u32 s81, s81, 1048576
ds_read_b64_tr_b16 a[82:83], v7 offset:33792
v_add_f32 v17, v17, v18
v_mfma_f32_16x16x32_bf16 v[252:255], a[40:43], a[88:91], v[252:255]
s_xor_b32 m0, s77, 67584
ds_read_b64_tr_b16 a[84:85], v7 offset:40960
v_accvgpr_read_b32 v19, a154
v_mfma_f32_16x16x32_bf16 a[120:123], a[48:51], a[88:91], a[120:123]
s_xor_b32 s64, s71, 3211264
buffer_load_dword a252, v16, s[56:59], s81 offen
v_mfma_f32_16x16x32_bf16 a[120:123], a[52:55], a[92:95], a[120:123]
buffer_load_dwordx4 v15, s[36:39], s64 offen lds
v_mfma_f32_16x16x32_bf16 a[124:127], a[60:63], a[92:95], a[124:127]
ds_read_b64_tr_b16 a[86:87], v7 offset:41984
v_accvgpr_read_b32 v21, a170
v_mfma_f32_16x16x32_bf16 a[124:127], a[56:59], a[88:91], a[124:127]
ds_read_b64_tr_b16 a[88:89], v8 offset:32768
v_lshlrev_b32 v18, 16, v19
v_mfma_f32_16x16x32_bf16 a[128:131], a[56:59], a[96:99], a[128:131]
ds_read_b64_tr_b16 a[90:91], v8 offset:33792
v_and_b32 v19, 0xffff0000, v19
v_mfma_f32_16x16x32_bf16 a[128:131], a[60:63], a[100:103], a[128:131]
ds_read_b64_tr_b16 a[92:93], v8 offset:40960
v_lshlrev_b32 v20, 16, v21
v_mfma_f32_16x16x32_bf16 a[132:135], a[52:55], a[100:103], a[132:135]
ds_read_b64_tr_b16 a[94:95], v8 offset:41984
v_and_b32 v21, 0xffff0000, v21
v_mfma_f32_16x16x32_bf16 a[132:135], a[48:51], a[96:99], a[132:135]
s_xor_b32 m0, s77, 68608
v_mul_f32 v18, v18, v20
v_mul_f32 v19, v19, v21
v_mfma_f32_16x16x32_bf16 a[136:139], a[40:43], a[96:99], a[136:139]
s_xor_b32 s64, s71, 3244032
v_cvt_pk_bf16_f32 v18, v18, v19
v_lshlrev_b32 v19, 16, v18
v_mfma_f32_16x16x32_bf16 a[136:139], a[44:47], a[100:103], a[136:139]
buffer_load_dwordx4 v15, s[36:39], s64 offen lds
v_mfma_f32_16x16x32_bf16 a[140:143], a[36:39], a[100:103], a[140:143]
v_and_b32 v18, 0xffff0000, v18
v_add_f32 v17, v17, v19
v_mfma_f32_16x16x32_bf16 a[140:143], a[32:35], a[96:99], a[140:143]
s_waitcnt lgkmcnt(5)
ds_read_b64_tr_b16 a[96:97], v9 offset:32768
v_add_f32 v17, v17, v18
v_mfma_f32_16x16x32_bf16 v[184:187], a[104:107], a[0:3], v[184:187]
ds_read_b64_tr_b16 a[98:99], v9 offset:33792
v_accvgpr_read_b32 v19, a155
v_mfma_f32_16x16x32_bf16 v[184:187], a[108:111], a[4:7], v[184:187]
ds_read_b64_tr_b16 a[100:101], v9 offset:40960
v_accvgpr_read_b32 v21, a171
v_mfma_f32_16x16x32_bf16 v[192:195], a[108:111], a[12:15], v[192:195]
ds_read_b64_tr_b16 a[102:103], v9 offset:41984
v_lshlrev_b32 v18, 16, v19
v_mfma_f32_16x16x32_bf16 v[192:195], a[104:107], a[8:11], v[192:195]
s_xor_b32 m0, s77, 81920
v_and_b32 v19, 0xffff0000, v19
v_lshlrev_b32 v20, 16, v21
v_mfma_f32_16x16x32_bf16 v[200:203], a[104:107], a[16:19], v[200:203]
s_xor_b32 s64, s71, 3145728
v_and_b32 v21, 0xffff0000, v21
v_mul_f32 v18, v18, v20
v_mfma_f32_16x16x32_bf16 v[200:203], a[108:111], a[20:23], v[200:203]
buffer_load_dwordx4 v14, s[40:43], s64 offen lds
v_mfma_f32_16x16x32_bf16 v[208:211], a[108:111], a[28:31], v[208:211]
v_mul_f32 v19, v19, v21
v_cvt_pk_bf16_f32 v18, v18, v19
v_mfma_f32_16x16x32_bf16 v[208:211], a[104:107], a[24:27], v[208:211]
ds_read_b64_tr_b16 a[104:105], v10 offset:32768
v_lshlrev_b32 v19, 16, v18
v_mfma_f32_16x16x32_bf16 v[212:215], a[112:115], a[24:27], v[212:215]
ds_read_b64_tr_b16 a[106:107], v10 offset:33792
v_and_b32 v18, 0xffff0000, v18
v_mfma_f32_16x16x32_bf16 v[212:215], a[116:119], a[28:31], v[212:215]
ds_read_b64_tr_b16 a[108:109], v10 offset:40960
v_add_f32 v17, v17, v19
v_mfma_f32_16x16x32_bf16 v[204:207], a[116:119], a[20:23], v[204:207]
ds_read_b64_tr_b16 a[110:111], v10 offset:41984
v_add_f32 v17, v17, v18
v_mfma_f32_16x16x32_bf16 v[204:207], a[112:115], a[16:19], v[204:207]
s_xor_b32 m0, s77, 82944
v_accvgpr_read_b32 v19, a156
v_accvgpr_read_b32 v21, a172
v_mfma_f32_16x16x32_bf16 v[196:199], a[112:115], a[8:11], v[196:199]
s_xor_b32 s64, s71, 3178496
v_lshlrev_b32 v18, 16, v19
v_and_b32 v19, 0xffff0000, v19
v_mfma_f32_16x16x32_bf16 v[196:199], a[116:119], a[12:15], v[196:199]
buffer_load_dwordx4 v14, s[40:43], s64 offen lds
v_mfma_f32_16x16x32_bf16 v[188:191], a[116:119], a[4:7], v[188:191]
v_lshlrev_b32 v20, 16, v21
v_and_b32 v21, 0xffff0000, v21
v_mfma_f32_16x16x32_bf16 v[188:191], a[112:115], a[0:3], v[188:191]
ds_read_b64_tr_b16 a[112:113], v11 offset:32768
v_mul_f32 v18, v18, v20
v_mfma_f32_16x16x32_bf16 v[216:219], a[72:75], a[0:3], v[216:219]
ds_read_b64_tr_b16 a[114:115], v11 offset:33792
v_mul_f32 v19, v19, v21
v_mfma_f32_16x16x32_bf16 v[216:219], a[76:79], a[4:7], v[216:219]
ds_read_b64_tr_b16 a[116:117], v11 offset:40960
v_cvt_pk_bf16_f32 v18, v18, v19
v_mfma_f32_16x16x32_bf16 v[224:227], a[76:79], a[12:15], v[224:227]
ds_read_b64_tr_b16 a[118:119], v11 offset:41984
v_lshlrev_b32 v19, 16, v18
v_mfma_f32_16x16x32_bf16 v[224:227], a[72:75], a[8:11], v[224:227]
s_xor_b32 m0, s77, 83968
v_and_b32 v18, 0xffff0000, v18
v_add_f32 v17, v17, v19
v_mfma_f32_16x16x32_bf16 v[232:235], a[72:75], a[16:19], v[232:235]
s_xor_b32 s64, s71, 3211264
v_add_f32 v17, v17, v18
v_accvgpr_read_b32 v19, a157
v_mfma_f32_16x16x32_bf16 v[232:235], a[76:79], a[20:23], v[232:235]
buffer_load_dwordx4 v15, s[40:43], s64 offen lds
v_mfma_f32_16x16x32_bf16 v[240:243], a[76:79], a[28:31], v[240:243]
v_accvgpr_read_b32 v21, a173
v_lshlrev_b32 v18, 16, v19
v_mfma_f32_16x16x32_bf16 v[240:243], a[72:75], a[24:27], v[240:243]
ds_read_b64_tr_b16 a[72:73], v4 offset:49152
v_and_b32 v19, 0xffff0000, v19
v_mfma_f32_16x16x32_bf16 v[244:247], a[80:83], a[24:27], v[244:247]
s_waitcnt lgkmcnt(5)
ds_read_b64_tr_b16 a[74:75], v4 offset:50176
v_lshlrev_b32 v20, 16, v21
v_mfma_f32_16x16x32_bf16 v[244:247], a[84:87], a[28:31], v[244:247]
ds_read_b64_tr_b16 a[76:77], v4 offset:57344
v_and_b32 v21, 0xffff0000, v21
v_mfma_f32_16x16x32_bf16 v[236:239], a[84:87], a[20:23], v[236:239]
s_add_u32 s82, s82, 1048576
ds_read_b64_tr_b16 a[78:79], v4 offset:58368
v_mul_f32 v18, v18, v20
v_mfma_f32_16x16x32_bf16 v[236:239], a[80:83], a[16:19], v[236:239]
s_xor_b32 m0, s77, 84992
v_mul_f32 v19, v19, v21
v_cvt_pk_bf16_f32 v18, v18, v19
v_mfma_f32_16x16x32_bf16 v[228:231], a[80:83], a[8:11], v[228:231]
s_xor_b32 s64, s71, 3244032
buffer_load_dword a252, v1, s[60:63], s82 offen
v_mfma_f32_16x16x32_bf16 v[228:231], a[84:87], a[12:15], v[228:231]
buffer_load_dwordx4 v15, s[40:43], s64 offen lds
v_mfma_f32_16x16x32_bf16 v[220:223], a[84:87], a[4:7], v[220:223]
v_lshlrev_b32 v19, 16, v18
v_and_b32 v18, 0xffff0000, v18
v_mfma_f32_16x16x32_bf16 v[220:223], a[80:83], a[0:3], v[220:223]
ds_read_b64_tr_b16 a[80:81], v5 offset:49152
v_add_f32 v17, v17, v19
v_mfma_f32_16x16x32_bf16 v[152:155], a[88:91], a[0:3], v[152:155]
ds_read_b64_tr_b16 a[82:83], v5 offset:50176
v_add_f32 v17, v17, v18
v_mfma_f32_16x16x32_bf16 v[152:155], a[92:95], a[4:7], v[152:155]
ds_read_b64_tr_b16 a[84:85], v5 offset:57344
v_accvgpr_read_b32 v19, a158
v_mfma_f32_16x16x32_bf16 v[160:163], a[92:95], a[12:15], v[160:163]
ds_read_b64_tr_b16 a[86:87], v5 offset:58368
v_accvgpr_read_b32 v21, a174
v_mfma_f32_16x16x32_bf16 v[160:163], a[88:91], a[8:11], v[160:163]
v_lshlrev_b32 v18, 16, v19
v_and_b32 v19, 0xffff0000, v19
v_mfma_f32_16x16x32_bf16 v[168:171], a[88:91], a[16:19], v[168:171]
v_lshlrev_b32 v20, 16, v21
v_and_b32 v21, 0xffff0000, v21
v_mfma_f32_16x16x32_bf16 v[168:171], a[92:95], a[20:23], v[168:171]
v_mul_f32 v18, v18, v20
v_mul_f32 v19, v19, v21
v_mfma_f32_16x16x32_bf16 v[176:179], a[92:95], a[28:31], v[176:179]
s_xor_b32 m0, s84, 0
v_cvt_pk_bf16_f32 v18, v18, v19
v_lshlrev_b32 v19, 16, v18
v_mfma_f32_16x16x32_bf16 v[176:179], a[88:91], a[24:27], v[176:179]
s_xor_b32 s64, s70, 768
ds_read_b64_tr_b16 a[88:89], v6 offset:49152
v_and_b32 v18, 0xffff0000, v18
v_mfma_f32_16x16x32_bf16 v[180:183], a[96:99], a[24:27], v[180:183]
buffer_load_dwordx4 v12, s[32:35], s64 offen lds
v_mfma_f32_16x16x32_bf16 v[180:183], a[100:103], a[28:31], v[180:183]
ds_read_b64_tr_b16 a[90:91], v6 offset:50176
v_add_f32 v17, v17, v19
v_mfma_f32_16x16x32_bf16 v[172:175], a[100:103], a[20:23], v[172:175]
ds_read_b64_tr_b16 a[92:93], v6 offset:57344
v_add_f32 v17, v17, v18
v_mfma_f32_16x16x32_bf16 v[172:175], a[96:99], a[16:19], v[172:175]
ds_read_b64_tr_b16 a[94:95], v6 offset:58368
v_accvgpr_read_b32 v19, a159
v_mfma_f32_16x16x32_bf16 v[164:167], a[96:99], a[8:11], v[164:167]
v_accvgpr_read_b32 v21, a175
v_lshlrev_b32 v18, 16, v19
v_mfma_f32_16x16x32_bf16 v[164:167], a[100:103], a[12:15], v[164:167]
s_xor_b32 m0, s84, 1024
v_and_b32 v19, 0xffff0000, v19
v_lshlrev_b32 v20, 16, v21
v_mfma_f32_16x16x32_bf16 v[156:159], a[100:103], a[4:7], v[156:159]
s_xor_b32 s64, s70, 8960
v_and_b32 v21, 0xffff0000, v21
v_mul_f32 v18, v18, v20
v_mfma_f32_16x16x32_bf16 v[156:159], a[96:99], a[0:3], v[156:159]
buffer_load_dwordx4 v13, s[32:35], s64 offen lds
v_mfma_f32_16x16x32_bf16 v[24:27], a[104:107], a[0:3], v[24:27]
ds_read_b64_tr_b16 a[96:97], v7 offset:49152
v_mul_f32 v19, v19, v21
v_mfma_f32_16x16x32_bf16 v[24:27], a[108:111], a[4:7], v[24:27]
ds_read_b64_tr_b16 a[98:99], v7 offset:50176
v_cvt_pk_bf16_f32 v18, v18, v19
v_mfma_f32_16x16x32_bf16 v[40:43], a[108:111], a[12:15], v[40:43]
ds_read_b64_tr_b16 a[100:101], v7 offset:57344
v_lshlrev_b32 v19, 16, v18
v_mfma_f32_16x16x32_bf16 v[40:43], a[104:107], a[8:11], v[40:43]
ds_read_b64_tr_b16 a[102:103], v7 offset:58368
v_and_b32 v18, 0xffff0000, v18
v_mfma_f32_16x16x32_bf16 v[56:59], a[104:107], a[16:19], v[56:59]
s_xor_b32 m0, s84, 2048
v_add_f32 v17, v17, v19
v_add_f32 v17, v17, v18
v_mfma_f32_16x16x32_bf16 v[56:59], a[108:111], a[20:23], v[56:59]
s_xor_b32 s64, s70, 17152
v_mfma_f32_16x16x32_bf16 v[72:75], a[108:111], a[28:31], v[72:75]
s_waitcnt vmcnt(12)
buffer_load_dwordx4 v12, s[32:35], s64 offen lds
v_mfma_f32_16x16x32_bf16 v[72:75], a[104:107], a[24:27], v[72:75]
s_waitcnt lgkmcnt(4)
ds_read_b64_tr_b16 a[104:105], v8 offset:49152
v_add_f32_dpp v17, v17, v17 row_ror:8 row_mask:0xf bank_mask:0xf
v_mfma_f32_16x16x32_bf16 v[136:139], a[112:115], a[24:27], v[136:139]
ds_read_b64_tr_b16 a[106:107], v8 offset:50176
v_mfma_f32_16x16x32_bf16 v[136:139], a[116:119], a[28:31], v[136:139]
ds_read_b64_tr_b16 a[108:109], v8 offset:57344
v_add_u32 v4, 0x8000, v4
v_mfma_f32_16x16x32_bf16 v[120:123], a[116:119], a[20:23], v[120:123]
ds_read_b64_tr_b16 a[110:111], v8 offset:58368
v_add_f32_dpp v17, v17, v17 row_ror:4 row_mask:0xf bank_mask:0xf
v_mfma_f32_16x16x32_bf16 v[120:123], a[112:115], a[16:19], v[120:123]
s_xor_b32 m0, s84, 3072
ds_read_b128 a[32:35], v2 offset:32768
v_mfma_f32_16x16x32_bf16 v[104:107], a[112:115], a[8:11], v[104:107]
s_xor_b32 s64, s70, 25344
ds_read_b128 a[36:39], v3 offset:32768
v_add_f32_dpp v17, v17, v17 row_ror:2 row_mask:0xf bank_mask:0xf
v_mfma_f32_16x16x32_bf16 v[104:107], a[116:119], a[12:15], v[104:107]
buffer_load_dwordx4 v13, s[32:35], s64 offen lds
v_mfma_f32_16x16x32_bf16 v[88:91], a[116:119], a[4:7], v[88:91]
ds_read_b128 a[40:43], v2 offset:34816
v_add_f32_dpp v17, v17, v17 row_ror:1 row_mask:0xf bank_mask:0xf
v_mfma_f32_16x16x32_bf16 v[88:91], a[112:115], a[0:3], v[88:91]
ds_read_b128 a[44:47], v3 offset:34816
v_mov_b32 v18, v17
v_mfma_f32_16x16x32_bf16 v[28:31], a[0:3], a[72:75], v[28:31]
ds_read_b128 a[48:51], v2 offset:36864
v_mfma_f32_16x16x32_bf16 v[28:31], a[4:7], a[76:79], v[28:31]
ds_read_b128 a[52:55], v3 offset:36864
v_add_u32 v5, 0x8000, v5
v_mfma_f32_16x16x32_bf16 v[44:47], a[12:15], a[76:79], v[44:47]
s_xor_b32 m0, s84, 4096
ds_read_b128 a[56:59], v2 offset:38912
v_permlane16_swap_b32 v18, v17
v_mfma_f32_16x16x32_bf16 v[44:47], a[8:11], a[72:75], v[44:47]
s_xor_b32 s64, s70, 33536
ds_read_b128 a[60:63], v3 offset:38912
v_add_f32 v17, v17, v18
v_mfma_f32_16x16x32_bf16 v[60:63], a[16:19], a[72:75], v[60:63]
s_add_u32 s81, s81, 1048576
buffer_load_dwordx4 v12, s[32:35], s64 offen lds
v_mfma_f32_16x16x32_bf16 v[60:63], a[20:23], a[76:79], v[60:63]
buffer_load_dword a252, v16, s[56:59], s81 offen
v_mfma_f32_16x16x32_bf16 v[76:79], a[28:31], a[76:79], v[76:79]
ds_read_b64_tr_b16 a[112:113], v9 offset:49152
v_cvt_pk_bf16_f32 v17, v17, v17
v_mfma_f32_16x16x32_bf16 v[76:79], a[24:27], a[72:75], v[76:79]
ds_read_b64_tr_b16 a[114:115], v9 offset:50176
v_and_b32 v17, 0xffff0000, v17
v_mfma_f32_16x16x32_bf16 v[140:143], a[24:27], a[80:83], v[140:143]
ds_read_b64_tr_b16 a[116:117], v9 offset:57344
v_mul_f32 v17, 0xbfb8aa3b, v17
v_mfma_f32_16x16x32_bf16 v[140:143], a[28:31], a[84:87], v[140:143]
s_xor_b32 m0, s84, 5120
ds_read_b64_tr_b16 a[118:119], v9 offset:58368
v_add_u32 v6, 0x8000, v6
v_mfma_f32_16x16x32_bf16 v[124:127], a[20:23], a[84:87], v[124:127]
s_xor_b32 s64, s70, 41728
ds_read_b64_tr_b16 a[72:73], v10 offset:49152
v_mfma_f32_16x16x32_bf16 v[124:127], a[16:19], a[80:83], v[124:127]
buffer_load_dwordx4 v13, s[32:35], s64 offen lds
v_mfma_f32_16x16x32_bf16 v[108:111], a[8:11], a[80:83], v[108:111]
ds_read_b64_tr_b16 a[74:75], v10 offset:50176
v_mfma_f32_16x16x32_bf16 v[108:111], a[12:15], a[84:87], v[108:111]
ds_read_b64_tr_b16 a[76:77], v10 offset:57344
v_mfma_f32_16x16x32_bf16 v[92:95], a[4:7], a[84:87], v[92:95]
ds_read_b64_tr_b16 a[78:79], v10 offset:58368
v_mfma_f32_16x16x32_bf16 v[92:95], a[0:3], a[80:83], v[92:95]
ds_read_b64_tr_b16 a[80:81], v11 offset:49152
v_mfma_f32_16x16x32_bf16 v[32:35], a[0:3], a[88:91], v[32:35]
s_xor_b32 m0, s84, 6144
ds_read_b64_tr_b16 a[82:83], v11 offset:50176
v_mfma_f32_16x16x32_bf16 v[32:35], a[4:7], a[92:95], v[32:35]
s_xor_b32 s64, s70, 49920
ds_read_b64_tr_b16 a[84:85], v11 offset:57344
v_add_u32 v7, 0x8000, v7
v_mfma_f32_16x16x32_bf16 v[48:51], a[12:15], a[92:95], v[48:51]
buffer_load_dwordx4 v12, s[32:35], s64 offen lds
v_mfma_f32_16x16x32_bf16 v[48:51], a[8:11], a[88:91], v[48:51]
ds_read_b64_tr_b16 a[86:87], v11 offset:58368
v_mfma_f32_16x16x32_bf16 v[64:67], a[16:19], a[88:91], v[64:67]
v_exp_f32 v17, v17
v_mfma_f32_16x16x32_bf16 v[64:67], a[20:23], a[92:95], v[64:67]
v_add_f32 v17, 1.0, v17
v_mfma_f32_16x16x32_bf16 v[80:83], a[28:31], a[92:95], v[80:83]
v_rcp_f32 v17, v17
v_mfma_f32_16x16x32_bf16 v[80:83], a[24:27], a[88:91], v[80:83]
s_waitcnt lgkmcnt(5)
s_xor_b32 m0, s84, 7168
v_cvt_pk_bf16_f32 v18, v17, v17
v_mfma_f32_16x16x32_bf16 v[144:147], a[24:27], a[96:99], v[144:147]
s_xor_b32 s64, s70, 58112
v_and_b32 v18, 0xffff0000, v18
v_mfma_f32_16x16x32_bf16 v[144:147], a[28:31], a[100:103], v[144:147]
buffer_load_dwordx4 v13, s[32:35], s64 offen lds
v_mfma_f32_16x16x32_bf16 v[128:131], a[20:23], a[100:103], v[128:131]
s_branch L_po4
L_pg4:
s_branch L_tr0
L_po4:
v_add_u32 v8, 0x8000, v8
v_sub_f32 v19, 1.0, v18
v_mfma_f32_16x16x32_bf16 v[128:131], a[16:19], a[96:99], v[128:131]
v_cvt_pk_bf16_f32 v19, v19, v19
v_mfma_f32_16x16x32_bf16 v[112:115], a[8:11], a[96:99], v[112:115]
v_and_b32 v19, 0xffff0000, v19
v_mfma_f32_16x16x32_bf16 v[112:115], a[12:15], a[100:103], v[112:115]
v_and_b32 v20, 31, v0
v_mfma_f32_16x16x32_bf16 v[96:99], a[4:7], a[100:103], v[96:99]
v_add_u32 v9, 0x8000, v9
v_add_u32 v10, 0x8000, v10
v_mfma_f32_16x16x32_bf16 v[96:99], a[0:3], a[96:99], v[96:99]
v_add_u32 v11, 0x8000, v11
v_lshlrev_b32 v20, 27, v20
v_mfma_f32_16x16x32_bf16 v[36:39], a[0:3], a[104:107], v[36:39]
v_lshrrev_b32 v21, 2, v0
v_mfma_f32_16x16x32_bf16 v[36:39], a[4:7], a[108:111], v[36:39]
v_add_u32 v20, v20, v21
v_mfma_f32_16x16x32_bf16 v[52:55], a[12:15], a[108:111], v[52:55]
s_waitcnt lgkmcnt(0)
s_barrier
v_mfma_f32_16x16x32_bf16 v[52:55], a[8:11], a[104:107], v[52:55]
s_xor_b32 m0, s77, 98304
ds_read_b64_tr_b16 a[88:89], v4 offset:32768
v_mfma_f32_16x16x32_bf16 v[68:71], a[16:19], a[104:107], v[68:71]
s_xor_b32 s64, s71, 3670016
ds_read_b64_tr_b16 a[90:91], v4 offset:33792
v_mfma_f32_16x16x32_bf16 v[68:71], a[20:23], a[108:111], v[68:71]
buffer_load_dwordx4 v14, s[36:39], s64 offen lds
v_mfma_f32_16x16x32_bf16 v[84:87], a[28:31], a[108:111], v[84:87]
ds_read_b64_tr_b16 a[92:93], v4 offset:40960
v_mfma_f32_16x16x32_bf16 v[84:87], a[24:27], a[104:107], v[84:87]
ds_read_b64_tr_b16 a[94:95], v4 offset:41984
v_mfma_f32_16x16x32_bf16 v[148:151], a[24:27], a[112:115], v[148:151]
ds_read_b64_tr_b16 a[96:97], v5 offset:32768
v_mfma_f32_16x16x32_bf16 v[148:151], a[28:31], a[116:119], v[148:151]
ds_read_b64_tr_b16 a[98:99], v5 offset:33792
v_mfma_f32_16x16x32_bf16 v[132:135], a[20:23], a[116:119], v[132:135]
ds_read_b64_tr_b16 a[100:101], v5 offset:40960
v_mfma_f32_16x16x32_bf16 v[132:135], a[16:19], a[112:115], v[132:135]
s_xor_b32 m0, s77, 99328
s_add_u32 s82, s82, 1048576
ds_read_b64_tr_b16 a[102:103], v5 offset:41984
v_mfma_f32_16x16x32_bf16 v[116:119], a[8:11], a[112:115], v[116:119]
s_xor_b32 s64, s71, 3702784
buffer_load_dword a252, v1, s[60:63], s82 offen
v_mfma_f32_16x16x32_bf16 v[116:119], a[12:15], a[116:119], v[116:119]
buffer_load_dwordx4 v14, s[36:39], s64 offen lds
v_mfma_f32_16x16x32_bf16 v[100:103], a[4:7], a[116:119], v[100:103]
ds_read_b64_tr_b16 a[104:105], v6 offset:32768
v_mfma_f32_16x16x32_bf16 v[100:103], a[0:3], a[112:115], v[100:103]
ds_read_b64_tr_b16 a[106:107], v6 offset:33792
v_mfma_f32_16x16x32_bf16 v[248:251], a[0:3], a[72:75], v[248:251]
ds_read_b64_tr_b16 a[108:109], v6 offset:40960
v_mfma_f32_16x16x32_bf16 v[248:251], a[4:7], a[76:79], v[248:251]
ds_read_b64_tr_b16 a[110:111], v6 offset:41984
v_mfma_f32_16x16x32_bf16 v[252:255], a[12:15], a[76:79], v[252:255]
ds_read_b64_tr_b16 a[112:113], v7 offset:32768
v_mfma_f32_16x16x32_bf16 v[252:255], a[8:11], a[72:75], v[252:255]
s_xor_b32 m0, s77, 100352
ds_read_b64_tr_b16 a[114:115], v7 offset:33792
v_mfma_f32_16x16x32_bf16 a[120:123], a[16:19], a[72:75], a[120:123]
s_xor_b32 s64, s71, 3735552
ds_read_b64_tr_b16 a[116:117], v7 offset:40960
v_mfma_f32_16x16x32_bf16 a[120:123], a[20:23], a[76:79], a[120:123]
buffer_load_dwordx4 v15, s[36:39], s64 offen lds
v_mfma_f32_16x16x32_bf16 a[124:127], a[28:31], a[76:79], a[124:127]
ds_read_b64_tr_b16 a[118:119], v7 offset:41984
v_mfma_f32_16x16x32_bf16 a[124:127], a[24:27], a[72:75], a[124:127]
ds_read_b64_tr_b16 a[72:73], v8 offset:32768
v_mfma_f32_16x16x32_bf16 a[128:131], a[24:27], a[80:83], a[128:131]
ds_read_b64_tr_b16 a[74:75], v8 offset:33792
v_mfma_f32_16x16x32_bf16 a[128:131], a[28:31], a[84:87], a[128:131]
s_lshl2_add_u32 s65, s2, s30
ds_read_b64_tr_b16 a[76:77], v8 offset:40960
v_mfma_f32_16x16x32_bf16 a[132:135], a[20:23], a[84:87], a[132:135]
s_lshl4_add_u32 s65, s65, 58720256
ds_read_b64_tr_b16 a[78:79], v8 offset:41984
v_mfma_f32_16x16x32_bf16 a[132:135], a[16:19], a[80:83], a[132:135]
s_xor_b32 m0, s77, 101376
buffer_store_dwordx2 v[18:19], v20, s[44:47], s65 offen sc1
v_mfma_f32_16x16x32_bf16 a[136:139], a[8:11], a[80:83], a[136:139]
s_xor_b32 s64, s71, 3768320
v_lshrrev_b32 v21, 4, v0
v_mfma_f32_16x16x32_bf16 a[136:139], a[12:15], a[84:87], a[136:139]
buffer_load_dwordx4 v15, s[36:39], s64 offen lds
v_mfma_f32_16x16x32_bf16 a[140:143], a[4:7], a[84:87], a[140:143]
v_bfe_u32 v19, v0, 2, 2
v_mfma_f32_16x16x32_bf16 a[140:143], a[0:3], a[80:83], a[140:143]
s_waitcnt lgkmcnt(5)
ds_read_b64_tr_b16 a[80:81], v9 offset:32768
v_lshl_add_u32 v19, v21, 3, v19
v_mfma_f32_16x16x32_bf16 v[184:187], a[88:91], a[32:35], v[184:187]
ds_read_b64_tr_b16 a[82:83], v9 offset:33792
v_lshlrev_b32 v19, 6, v19
v_mfma_f32_16x16x32_bf16 v[184:187], a[92:95], a[36:39], v[184:187]
ds_read_b64_tr_b16 a[84:85], v9 offset:40960
v_and_b32 v21, 1, v21
v_mfma_f32_16x16x32_bf16 v[192:195], a[92:95], a[44:47], v[192:195]
ds_read_b64_tr_b16 a[86:87], v9 offset:41984
v_lshl_add_u32 v19, v21, 5, v19
v_mfma_f32_16x16x32_bf16 v[192:195], a[88:91], a[40:43], v[192:195]
s_xor_b32 m0, s77, 114688
v_and_b32 v21, 3, v0
v_mfma_f32_16x16x32_bf16 v[200:203], a[88:91], a[48:51], v[200:203]
s_xor_b32 s64, s71, 3670016
v_lshl_add_u32 v19, v21, 3, v19
v_mfma_f32_16x16x32_bf16 v[200:203], a[92:95], a[52:55], v[200:203]
buffer_load_dwordx4 v14, s[40:43], s64 offen lds
v_mfma_f32_16x16x32_bf16 v[208:211], a[92:95], a[60:63], v[208:211]
v_add_u32 v19, 114688, v19
v_mfma_f32_16x16x32_bf16 v[208:211], a[88:91], a[56:59], v[208:211]
ds_read_b64_tr_b16 a[88:89], v10 offset:32768
v_xor_b32 v20, 32, v19
v_mfma_f32_16x16x32_bf16 v[212:215], a[96:99], a[56:59], v[212:215]
ds_read_b64_tr_b16 a[90:91], v10 offset:33792
v_mfma_f32_16x16x32_bf16 v[212:215], a[100:103], a[60:63], v[212:215]
ds_read_b64_tr_b16 a[92:93], v10 offset:40960
v_mfma_f32_16x16x32_bf16 v[204:207], a[100:103], a[52:55], v[204:207]
ds_read_b64_tr_b16 a[94:95], v10 offset:41984
v_mfma_f32_16x16x32_bf16 v[204:207], a[96:99], a[48:51], v[204:207]
s_xor_b32 m0, s77, 115712
v_mfma_f32_16x16x32_bf16 v[196:199], a[96:99], a[40:43], v[196:199]
s_xor_b32 s64, s71, 3702784
v_mfma_f32_16x16x32_bf16 v[196:199], a[100:103], a[44:47], v[196:199]
buffer_load_dwordx4 v14, s[40:43], s64 offen lds
v_mfma_f32_16x16x32_bf16 v[188:191], a[100:103], a[36:39], v[188:191]
v_mfma_f32_16x16x32_bf16 v[188:191], a[96:99], a[32:35], v[188:191]
ds_read_b64_tr_b16 a[96:97], v11 offset:32768
v_mfma_f32_16x16x32_bf16 v[216:219], a[104:107], a[32:35], v[216:219]
ds_read_b64_tr_b16 a[98:99], v11 offset:33792
v_mfma_f32_16x16x32_bf16 v[216:219], a[108:111], a[36:39], v[216:219]
ds_read_b64_tr_b16 a[100:101], v11 offset:40960
v_mfma_f32_16x16x32_bf16 v[224:227], a[108:111], a[44:47], v[224:227]
ds_read_b64_tr_b16 a[102:103], v11 offset:41984
v_mfma_f32_16x16x32_bf16 v[224:227], a[104:107], a[40:43], v[224:227]
s_xor_b32 m0, s77, 116736
s_add_u32 s81, s81, 1048576
v_mfma_f32_16x16x32_bf16 v[232:235], a[104:107], a[48:51], v[232:235]
s_xor_b32 s64, s71, 3735552
buffer_load_dword a252, v16, s[56:59], s81 offen
v_mfma_f32_16x16x32_bf16 v[232:235], a[108:111], a[52:55], v[232:235]
buffer_load_dwordx4 v15, s[40:43], s64 offen lds
v_mfma_f32_16x16x32_bf16 v[240:243], a[108:111], a[60:63], v[240:243]
v_mfma_f32_16x16x32_bf16 v[240:243], a[104:107], a[56:59], v[240:243]
ds_read_b64_tr_b16 a[104:105], v4 offset:49152
v_mfma_f32_16x16x32_bf16 v[244:247], a[112:115], a[56:59], v[244:247]
s_waitcnt lgkmcnt(5)
ds_read_b64_tr_b16 a[106:107], v4 offset:50176
v_mfma_f32_16x16x32_bf16 v[244:247], a[116:119], a[60:63], v[244:247]
ds_read_b64_tr_b16 a[108:109], v4 offset:57344
v_mfma_f32_16x16x32_bf16 v[236:239], a[116:119], a[52:55], v[236:239]
ds_read_b64_tr_b16 a[110:111], v4 offset:58368
v_mfma_f32_16x16x32_bf16 v[236:239], a[112:115], a[48:51], v[236:239]
s_xor_b32 m0, s77, 117760
v_mfma_f32_16x16x32_bf16 v[228:231], a[112:115], a[40:43], v[228:231]
s_xor_b32 s64, s71, 3768320
v_mfma_f32_16x16x32_bf16 v[228:231], a[116:119], a[44:47], v[228:231]
buffer_load_dwordx4 v15, s[40:43], s64 offen lds
v_mfma_f32_16x16x32_bf16 v[220:223], a[116:119], a[36:39], v[220:223]
v_mfma_f32_16x16x32_bf16 v[220:223], a[112:115], a[32:35], v[220:223]
ds_read_b64_tr_b16 a[112:113], v5 offset:49152
v_mfma_f32_16x16x32_bf16 v[152:155], a[72:75], a[32:35], v[152:155]
ds_read_b64_tr_b16 a[114:115], v5 offset:50176
v_mfma_f32_16x16x32_bf16 v[152:155], a[76:79], a[36:39], v[152:155]
ds_read_b64_tr_b16 a[116:117], v5 offset:57344
v_mfma_f32_16x16x32_bf16 v[160:163], a[76:79], a[44:47], v[160:163]
ds_read_b64_tr_b16 a[118:119], v5 offset:58368
v_mfma_f32_16x16x32_bf16 v[160:163], a[72:75], a[40:43], v[160:163]
v_mfma_f32_16x16x32_bf16 v[168:171], a[72:75], a[48:51], v[168:171]
v_mfma_f32_16x16x32_bf16 v[168:171], a[76:79], a[52:55], v[168:171]
v_mfma_f32_16x16x32_bf16 v[176:179], a[76:79], a[60:63], v[176:179]
s_xor_b32 m0, s84, 32768
v_mfma_f32_16x16x32_bf16 v[176:179], a[72:75], a[56:59], v[176:179]
s_xor_b32 s64, s70, 896
ds_read_b64_tr_b16 a[72:73], v6 offset:49152
v_mfma_f32_16x16x32_bf16 v[180:183], a[80:83], a[56:59], v[180:183]
buffer_load_dwordx4 v12, s[32:35], s64 offen lds
v_mfma_f32_16x16x32_bf16 v[180:183], a[84:87], a[60:63], v[180:183]
ds_read_b64_tr_b16 a[74:75], v6 offset:50176
v_mfma_f32_16x16x32_bf16 v[172:175], a[84:87], a[52:55], v[172:175]
ds_read_b64_tr_b16 a[76:77], v6 offset:57344
v_mfma_f32_16x16x32_bf16 v[172:175], a[80:83], a[48:51], v[172:175]
ds_read_b64_tr_b16 a[78:79], v6 offset:58368
v_mfma_f32_16x16x32_bf16 v[164:167], a[80:83], a[40:43], v[164:167]
v_mfma_f32_16x16x32_bf16 v[164:167], a[84:87], a[44:47], v[164:167]
s_xor_b32 m0, s84, 33792
v_mfma_f32_16x16x32_bf16 v[156:159], a[84:87], a[36:39], v[156:159]
s_xor_b32 s64, s70, 9088
v_mfma_f32_16x16x32_bf16 v[156:159], a[80:83], a[32:35], v[156:159]
buffer_load_dwordx4 v13, s[32:35], s64 offen lds
v_mfma_f32_16x16x32_bf16 v[24:27], a[88:91], a[32:35], v[24:27]
ds_read_b64_tr_b16 a[80:81], v7 offset:49152
v_mfma_f32_16x16x32_bf16 v[24:27], a[92:95], a[36:39], v[24:27]
ds_read_b64_tr_b16 a[82:83], v7 offset:50176
v_mfma_f32_16x16x32_bf16 v[40:43], a[92:95], a[44:47], v[40:43]
ds_read_b64_tr_b16 a[84:85], v7 offset:57344
v_mfma_f32_16x16x32_bf16 v[40:43], a[88:91], a[40:43], v[40:43]
ds_read_b64_tr_b16 a[86:87], v7 offset:58368
v_mfma_f32_16x16x32_bf16 v[56:59], a[88:91], a[48:51], v[56:59]
s_xor_b32 m0, s84, 34816
v_mfma_f32_16x16x32_bf16 v[56:59], a[92:95], a[52:55], v[56:59]
s_xor_b32 s64, s70, 17280
v_mfma_f32_16x16x32_bf16 v[72:75], a[92:95], a[60:63], v[72:75]
s_waitcnt vmcnt(13)
buffer_load_dwordx4 v12, s[32:35], s64 offen lds
v_mfma_f32_16x16x32_bf16 v[72:75], a[88:91], a[56:59], v[72:75]
s_waitcnt lgkmcnt(4)
ds_read_b64_tr_b16 a[88:89], v8 offset:49152
v_mfma_f32_16x16x32_bf16 v[136:139], a[96:99], a[56:59], v[136:139]
ds_read_b64_tr_b16 a[90:91], v8 offset:50176
v_mfma_f32_16x16x32_bf16 v[136:139], a[100:103], a[60:63], v[136:139]
ds_read_b64_tr_b16 a[92:93], v8 offset:57344
v_subrev_u32 v4, 0x8000, v4
v_mfma_f32_16x16x32_bf16 v[120:123], a[100:103], a[52:55], v[120:123]
ds_read_b64_tr_b16 a[94:95], v8 offset:58368
v_mfma_f32_16x16x32_bf16 v[120:123], a[96:99], a[48:51], v[120:123]
s_xor_b32 m0, s84, 35840
s_add_u32 s81, s81, 1048576
ds_read_b128 a[0:3], v2 offset:0
v_mfma_f32_16x16x32_bf16 v[104:107], a[96:99], a[40:43], v[104:107]
s_xor_b32 s64, s70, 25472
buffer_load_dword a252, v16, s[56:59], s81 offen
v_mfma_f32_16x16x32_bf16 v[104:107], a[100:103], a[44:47], v[104:107]
buffer_load_dwordx4 v13, s[32:35], s64 offen lds
v_mfma_f32_16x16x32_bf16 v[88:91], a[100:103], a[36:39], v[88:91]
ds_read_b128 a[4:7], v3 offset:0
v_mfma_f32_16x16x32_bf16 v[88:91], a[96:99], a[32:35], v[88:91]
ds_read_b128 a[8:11], v2 offset:2048
v_mfma_f32_16x16x32_bf16 v[28:31], a[32:35], a[104:107], v[28:31]
ds_read_b128 a[12:15], v3 offset:2048
v_mfma_f32_16x16x32_bf16 v[28:31], a[36:39], a[108:111], v[28:31]
ds_read_b128 a[16:19], v2 offset:4096
v_subrev_u32 v5, 0x8000, v5
v_mfma_f32_16x16x32_bf16 v[44:47], a[44:47], a[108:111], v[44:47]
s_xor_b32 m0, s84, 36864
ds_read_b128 a[20:23], v3 offset:4096
v_mfma_f32_16x16x32_bf16 v[44:47], a[40:43], a[104:107], v[44:47]
s_xor_b32 s64, s70, 33664
ds_read_b128 a[24:27], v2 offset:6144
v_mfma_f32_16x16x32_bf16 v[60:63], a[48:51], a[104:107], v[60:63]
buffer_load_dwordx4 v12, s[32:35], s64 offen lds
v_mfma_f32_16x16x32_bf16 v[60:63], a[52:55], a[108:111], v[60:63]
ds_read_b128 a[28:31], v3 offset:6144
v_mfma_f32_16x16x32_bf16 v[76:79], a[60:63], a[108:111], v[76:79]
ds_read_b64_tr_b16 a[96:97], v9 offset:49152
v_mfma_f32_16x16x32_bf16 v[76:79], a[56:59], a[104:107], v[76:79]
ds_read_b64_tr_b16 a[98:99], v9 offset:50176
v_mfma_f32_16x16x32_bf16 v[140:143], a[56:59], a[112:115], v[140:143]
ds_read_b64_tr_b16 a[100:101], v9 offset:57344
v_mfma_f32_16x16x32_bf16 v[140:143], a[60:63], a[116:119], v[140:143]
s_xor_b32 m0, s84, 37888
ds_read_b64_tr_b16 a[102:103], v9 offset:58368
v_subrev_u32 v6, 0x8000, v6
v_mfma_f32_16x16x32_bf16 v[124:127], a[52:55], a[116:119], v[124:127]
s_xor_b32 s64, s70, 41856
ds_read_b64_tr_b16 a[104:105], v10 offset:49152
v_mfma_f32_16x16x32_bf16 v[124:127], a[48:51], a[112:115], v[124:127]
buffer_load_dwordx4 v13, s[32:35], s64 offen lds
v_mfma_f32_16x16x32_bf16 v[108:111], a[40:43], a[112:115], v[108:111]
ds_read_b64_tr_b16 a[106:107], v10 offset:50176
v_mfma_f32_16x16x32_bf16 v[108:111], a[44:47], a[116:119], v[108:111]
ds_read_b64_tr_b16 a[108:109], v10 offset:57344
v_mfma_f32_16x16x32_bf16 v[92:95], a[36:39], a[116:119], v[92:95]
ds_read_b64_tr_b16 a[110:111], v10 offset:58368
v_mfma_f32_16x16x32_bf16 v[92:95], a[32:35], a[112:115], v[92:95]
ds_read_b64_tr_b16 a[112:113], v11 offset:49152
v_mfma_f32_16x16x32_bf16 v[32:35], a[32:35], a[72:75], v[32:35]
s_xor_b32 m0, s84, 38912
ds_read_b64_tr_b16 a[114:115], v11 offset:50176
v_mfma_f32_16x16x32_bf16 v[32:35], a[36:39], a[76:79], v[32:35]
s_xor_b32 s64, s70, 50048
ds_read_b64_tr_b16 a[116:117], v11 offset:57344
v_subrev_u32 v7, 0x8000, v7
v_mfma_f32_16x16x32_bf16 v[48:51], a[44:47], a[76:79], v[48:51]
buffer_load_dwordx4 v12, s[32:35], s64 offen lds
v_mfma_f32_16x16x32_bf16 v[48:51], a[40:43], a[72:75], v[48:51]
ds_read_b64_tr_b16 a[118:119], v11 offset:58368
v_mfma_f32_16x16x32_bf16 v[64:67], a[48:51], a[72:75], v[64:67]
v_mfma_f32_16x16x32_bf16 v[64:67], a[52:55], a[76:79], v[64:67]
v_mfma_f32_16x16x32_bf16 v[80:83], a[60:63], a[76:79], v[80:83]
v_mfma_f32_16x16x32_bf16 v[80:83], a[56:59], a[72:75], v[80:83]
s_waitcnt lgkmcnt(5)
s_xor_b32 m0, s84, 39936
v_mfma_f32_16x16x32_bf16 v[144:147], a[56:59], a[80:83], v[144:147]
s_xor_b32 s64, s70, 58240
v_mfma_f32_16x16x32_bf16 v[144:147], a[60:63], a[84:87], v[144:147]
buffer_load_dwordx4 v13, s[32:35], s64 offen lds
v_mfma_f32_16x16x32_bf16 v[128:131], a[52:55], a[84:87], v[128:131]
v_subrev_u32 v8, 0x8000, v8
v_mfma_f32_16x16x32_bf16 v[128:131], a[48:51], a[80:83], v[128:131]
v_mfma_f32_16x16x32_bf16 v[112:115], a[40:43], a[80:83], v[112:115]
v_mfma_f32_16x16x32_bf16 v[112:115], a[44:47], a[84:87], v[112:115]
v_mfma_f32_16x16x32_bf16 v[96:99], a[36:39], a[84:87], v[96:99]
s_and_b32 s77, s77, 0x3fff
v_subrev_u32 v9, 0x8000, v9
v_subrev_u32 v10, 0x8000, v10
v_mfma_f32_16x16x32_bf16 v[96:99], a[32:35], a[80:83], v[96:99]
v_subrev_u32 v11, 0x8000, v11
v_mfma_f32_16x16x32_bf16 v[36:39], a[32:35], a[88:91], v[36:39]
v_mfma_f32_16x16x32_bf16 v[36:39], a[36:39], a[92:95], v[36:39]
v_mfma_f32_16x16x32_bf16 v[52:55], a[44:47], a[92:95], v[52:55]
s_waitcnt lgkmcnt(0)
s_barrier
v_mfma_f32_16x16x32_bf16 v[52:55], a[40:43], a[88:91], v[52:55]
s_xor_b32 m0, s77, 131072
s_add_u32 s82, s82, 1048576
ds_read_b64_tr_b16 a[72:73], v4 offset:0
v_mfma_f32_16x16x32_bf16 v[68:71], a[48:51], a[88:91], v[68:71]
s_xor_b32 s64, s71, 0
buffer_load_dword a252, v1, s[60:63], s82 offen
v_mfma_f32_16x16x32_bf16 v[68:71], a[52:55], a[92:95], v[68:71]
buffer_load_dwordx4 v14, s[56:59], s64 offen lds
v_mfma_f32_16x16x32_bf16 v[84:87], a[60:63], a[92:95], v[84:87]
ds_read_b64_tr_b16 a[74:75], v4 offset:1024
v_mfma_f32_16x16x32_bf16 v[84:87], a[56:59], a[88:91], v[84:87]
ds_read_b64_tr_b16 a[76:77], v4 offset:8192
v_mfma_f32_16x16x32_bf16 v[148:151], a[56:59], a[96:99], v[148:151]
ds_read_b64_tr_b16 a[78:79], v4 offset:9216
v_lshrrev_b32 v13, 3, v0
v_mfma_f32_16x16x32_bf16 v[148:151], a[60:63], a[100:103], v[148:151]
ds_read_b64_tr_b16 a[80:81], v5 offset:0
v_lshl_add_u32 v12, v13, 10, v12
v_mfma_f32_16x16x32_bf16 v[132:135], a[52:55], a[100:103], v[132:135]
ds_read_b64_tr_b16 a[82:83], v5 offset:1024
v_xor_b32 v13, 64, v12
v_mfma_f32_16x16x32_bf16 v[132:135], a[48:51], a[96:99], v[132:135]
ds_read_b64_tr_b16 a[84:85], v5 offset:8192
v_mfma_f32_16x16x32_bf16 v[116:119], a[40:43], a[96:99], v[116:119]
s_add_u32 m0, s78, 147456
ds_read_b64_tr_b16 a[86:87], v5 offset:9216
v_mfma_f32_16x16x32_bf16 v[116:119], a[44:47], a[100:103], v[116:119]
s_add_u32 s64, s75, 0
ds_read_b64_tr_b16 a[88:89], v6 offset:0
v_mfma_f32_16x16x32_bf16 v[100:103], a[36:39], a[100:103], v[100:103]
buffer_load_dwordx4 v23, s[60:63], s64 offen lds
v_mfma_f32_16x16x32_bf16 v[100:103], a[32:35], a[96:99], v[100:103]
ds_read_b64_tr_b16 a[90:91], v6 offset:1024
v_mfma_f32_16x16x32_bf16 v[248:251], a[32:35], a[104:107], v[248:251]
ds_read_b64_tr_b16 a[92:93], v6 offset:8192
v_mfma_f32_16x16x32_bf16 v[248:251], a[36:39], a[108:111], v[248:251]
ds_read_b64_tr_b16 a[94:95], v6 offset:9216
v_mfma_f32_16x16x32_bf16 v[252:255], a[44:47], a[108:111], v[252:255]
ds_read_b64_tr_b16 a[96:97], v7 offset:0
v_mfma_f32_16x16x32_bf16 v[252:255], a[40:43], a[104:107], v[252:255]
ds_read_b64_tr_b16 a[98:99], v7 offset:1024
v_mfma_f32_16x16x32_bf16 a[120:123], a[48:51], a[104:107], a[120:123]
ds_read_b64_tr_b16 a[100:101], v7 offset:8192
v_mfma_f32_16x16x32_bf16 a[120:123], a[52:55], a[108:111], a[120:123]
s_xor_b32 m0, s77, 132096
ds_read_b64_tr_b16 a[102:103], v7 offset:9216
v_mfma_f32_16x16x32_bf16 a[124:127], a[60:63], a[108:111], a[124:127]
s_xor_b32 s64, s71, 32768
v_mfma_f32_16x16x32_bf16 a[124:127], a[56:59], a[104:107], a[124:127]
buffer_load_dwordx4 v14, s[56:59], s64 offen lds
v_mfma_f32_16x16x32_bf16 a[128:131], a[56:59], a[112:115], a[128:131]
ds_read_b64_tr_b16 a[104:105], v8 offset:0
v_mfma_f32_16x16x32_bf16 a[128:131], a[60:63], a[116:119], a[128:131]
ds_read_b64_tr_b16 a[106:107], v8 offset:1024
v_mfma_f32_16x16x32_bf16 a[132:135], a[52:55], a[116:119], a[132:135]
ds_read_b64_tr_b16 a[108:109], v8 offset:8192
v_mfma_f32_16x16x32_bf16 a[132:135], a[48:51], a[112:115], a[132:135]
ds_read_b64_tr_b16 a[110:111], v8 offset:9216
v_mfma_f32_16x16x32_bf16 a[136:139], a[40:43], a[112:115], a[136:139]
v_mfma_f32_16x16x32_bf16 a[136:139], a[44:47], a[116:119], a[136:139]
v_mfma_f32_16x16x32_bf16 a[140:143], a[36:39], a[116:119], a[140:143]
s_add_u32 m0, s78, 151552
v_mfma_f32_16x16x32_bf16 a[140:143], a[32:35], a[112:115], a[140:143]
s_waitcnt lgkmcnt(4)
s_add_u32 s64, s75, 2048
ds_read_b64_tr_b16 a[112:113], v9 offset:0
v_mfma_f32_16x16x32_bf16 v[184:187], a[72:75], a[0:3], v[184:187]
buffer_load_dwordx4 v23, s[60:63], s64 offen lds
v_mfma_f32_16x16x32_bf16 v[184:187], a[76:79], a[4:7], v[184:187]
ds_read_b64_tr_b16 a[114:115], v9 offset:1024
v_mfma_f32_16x16x32_bf16 v[192:195], a[76:79], a[12:15], v[192:195]
ds_read_b64_tr_b16 a[116:117], v9 offset:8192
v_mfma_f32_16x16x32_bf16 v[192:195], a[72:75], a[8:11], v[192:195]
ds_read_b64_tr_b16 a[118:119], v9 offset:9216
v_mfma_f32_16x16x32_bf16 v[200:203], a[72:75], a[16:19], v[200:203]
v_mfma_f32_16x16x32_bf16 v[200:203], a[76:79], a[20:23], v[200:203]
v_mfma_f32_16x16x32_bf16 v[208:211], a[76:79], a[28:31], v[208:211]
v_mfma_f32_16x16x32_bf16 v[208:211], a[72:75], a[24:27], v[208:211]
ds_read_b64_tr_b16 a[72:73], v10 offset:0
v_mfma_f32_16x16x32_bf16 v[212:215], a[80:83], a[24:27], v[212:215]
s_xor_b32 m0, s77, 133120
ds_read_b64_tr_b16 a[74:75], v10 offset:1024
v_mfma_f32_16x16x32_bf16 v[212:215], a[84:87], a[28:31], v[212:215]
s_xor_b32 s64, s71, 65536
ds_read_b64_tr_b16 a[76:77], v10 offset:8192
v_mfma_f32_16x16x32_bf16 v[204:207], a[84:87], a[20:23], v[204:207]
buffer_load_dwordx4 v15, s[56:59], s64 offen lds
v_mfma_f32_16x16x32_bf16 v[204:207], a[80:83], a[16:19], v[204:207]
s_add_u32 s81, s81, 1048576
ds_read_b64_tr_b16 a[78:79], v10 offset:9216
v_mfma_f32_16x16x32_bf16 v[196:199], a[80:83], a[8:11], v[196:199]
buffer_load_dword a252, v16, s[56:59], s81 offen
v_mfma_f32_16x16x32_bf16 v[196:199], a[84:87], a[12:15], v[196:199]
v_mfma_f32_16x16x32_bf16 v[188:191], a[84:87], a[4:7], v[188:191]
v_mfma_f32_16x16x32_bf16 v[188:191], a[80:83], a[0:3], v[188:191]
ds_read_b64_tr_b16 a[80:81], v11 offset:0
v_mfma_f32_16x16x32_bf16 v[216:219], a[88:91], a[0:3], v[216:219]
ds_read_b64_tr_b16 a[82:83], v11 offset:1024
v_mfma_f32_16x16x32_bf16 v[216:219], a[92:95], a[4:7], v[216:219]
s_add_u32 m0, s78, 155648
ds_read_b64_tr_b16 a[84:85], v11 offset:8192
v_mfma_f32_16x16x32_bf16 v[224:227], a[92:95], a[12:15], v[224:227]
s_add_u32 s64, s75, 4096
ds_read_b64_tr_b16 a[86:87], v11 offset:9216
v_mfma_f32_16x16x32_bf16 v[224:227], a[88:91], a[8:11], v[224:227]
buffer_load_dwordx4 v23, s[60:63], s64 offen lds
v_mfma_f32_16x16x32_bf16 v[232:235], a[88:91], a[16:19], v[232:235]
v_mfma_f32_16x16x32_bf16 v[232:235], a[92:95], a[20:23], v[232:235]
v_mfma_f32_16x16x32_bf16 v[240:243], a[92:95], a[28:31], v[240:243]
v_mfma_f32_16x16x32_bf16 v[240:243], a[88:91], a[24:27], v[240:243]
ds_read_b64_tr_b16 a[88:89], v4 offset:16384
v_mfma_f32_16x16x32_bf16 v[244:247], a[96:99], a[24:27], v[244:247]
ds_read_b64_tr_b16 a[90:91], v4 offset:17408
v_mfma_f32_16x16x32_bf16 v[244:247], a[100:103], a[28:31], v[244:247]
ds_read_b64_tr_b16 a[92:93], v4 offset:24576
v_mfma_f32_16x16x32_bf16 v[236:239], a[100:103], a[20:23], v[236:239]
s_xor_b32 m0, s77, 134144
ds_read_b64_tr_b16 a[94:95], v4 offset:25600
v_mfma_f32_16x16x32_bf16 v[236:239], a[96:99], a[16:19], v[236:239]
s_xor_b32 s64, s71, 98304
v_mfma_f32_16x16x32_bf16 v[228:231], a[96:99], a[8:11], v[228:231]
buffer_load_dwordx4 v15, s[56:59], s64 offen lds
v_mfma_f32_16x16x32_bf16 v[228:231], a[100:103], a[12:15], v[228:231]
v_mfma_f32_16x16x32_bf16 v[220:223], a[100:103], a[4:7], v[220:223]
v_mfma_f32_16x16x32_bf16 v[220:223], a[96:99], a[0:3], v[220:223]
s_waitcnt lgkmcnt(4)
ds_read_b64_tr_b16 a[96:97], v5 offset:16384
v_mfma_f32_16x16x32_bf16 v[152:155], a[104:107], a[0:3], v[152:155]
ds_read_b64_tr_b16 a[98:99], v5 offset:17408
v_mfma_f32_16x16x32_bf16 v[152:155], a[108:111], a[4:7], v[152:155]
ds_read_b64_tr_b16 a[100:101], v5 offset:24576
v_mfma_f32_16x16x32_bf16 v[160:163], a[108:111], a[12:15], v[160:163]
ds_read_b64_tr_b16 a[102:103], v5 offset:25600
v_mfma_f32_16x16x32_bf16 v[160:163], a[104:107], a[8:11], v[160:163]
v_mfma_f32_16x16x32_bf16 v[168:171], a[104:107], a[16:19], v[168:171]
v_mfma_f32_16x16x32_bf16 v[168:171], a[108:111], a[20:23], v[168:171]
v_mfma_f32_16x16x32_bf16 v[176:179], a[108:111], a[28:31], v[176:179]
s_xor_b32 m0, s84, 0
v_mfma_f32_16x16x32_bf16 v[176:179], a[104:107], a[24:27], v[176:179]
s_xor_b32 s64, s72, 0
ds_read_b64_tr_b16 a[104:105], v6 offset:16384
v_mfma_f32_16x16x32_bf16 v[180:183], a[112:115], a[24:27], v[180:183]
buffer_load_dwordx4 v12, s[48:51], s64 offen lds
v_mfma_f32_16x16x32_bf16 v[180:183], a[116:119], a[28:31], v[180:183]
ds_read_b64_tr_b16 a[106:107], v6 offset:17408
v_mfma_f32_16x16x32_bf16 v[172:175], a[116:119], a[20:23], v[172:175]
ds_read_b64_tr_b16 a[108:109], v6 offset:24576
v_mfma_f32_16x16x32_bf16 v[172:175], a[112:115], a[16:19], v[172:175]
ds_read_b64_tr_b16 a[110:111], v6 offset:25600
v_mfma_f32_16x16x32_bf16 v[164:167], a[112:115], a[8:11], v[164:167]
v_mfma_f32_16x16x32_bf16 v[164:167], a[116:119], a[12:15], v[164:167]
s_xor_b32 m0, s84, 1024
v_mfma_f32_16x16x32_bf16 v[156:159], a[116:119], a[4:7], v[156:159]
s_xor_b32 s64, s72, 16384
v_mfma_f32_16x16x32_bf16 v[156:159], a[112:115], a[0:3], v[156:159]
buffer_load_dwordx4 v13, s[48:51], s64 offen lds
v_mfma_f32_16x16x32_bf16 v[24:27], a[72:75], a[0:3], v[24:27]
ds_read_b64_tr_b16 a[112:113], v7 offset:16384
v_mfma_f32_16x16x32_bf16 v[24:27], a[76:79], a[4:7], v[24:27]
ds_read_b64_tr_b16 a[114:115], v7 offset:17408
v_mfma_f32_16x16x32_bf16 v[40:43], a[76:79], a[12:15], v[40:43]
ds_read_b64_tr_b16 a[116:117], v7 offset:24576
v_mfma_f32_16x16x32_bf16 v[40:43], a[72:75], a[8:11], v[40:43]
s_add_u32 s82, s82, 1048576
ds_read_b64_tr_b16 a[118:119], v7 offset:25600
v_mfma_f32_16x16x32_bf16 v[56:59], a[72:75], a[16:19], v[56:59]
s_xor_b32 m0, s84, 2048
buffer_load_dword a252, v1, s[60:63], s82 offen
v_mfma_f32_16x16x32_bf16 v[56:59], a[76:79], a[20:23], v[56:59]
s_xor_b32 s64, s72, 131072
v_mfma_f32_16x16x32_bf16 v[72:75], a[76:79], a[28:31], v[72:75]
s_waitcnt vmcnt(12)
buffer_load_dwordx4 v12, s[48:51], s64 offen lds
v_mfma_f32_16x16x32_bf16 v[72:75], a[72:75], a[24:27], v[72:75]
ds_read_b64_tr_b16 a[72:73], v8 offset:16384
v_mfma_f32_16x16x32_bf16 v[136:139], a[80:83], a[24:27], v[136:139]
ds_read_b64_tr_b16 a[74:75], v8 offset:17408
v_mfma_f32_16x16x32_bf16 v[136:139], a[84:87], a[28:31], v[136:139]
ds_read_b64_tr_b16 a[76:77], v8 offset:24576
v_mfma_f32_16x16x32_bf16 v[120:123], a[84:87], a[20:23], v[120:123]
ds_read_b64_tr_b16 a[78:79], v8 offset:25600
v_mfma_f32_16x16x32_bf16 v[120:123], a[80:83], a[16:19], v[120:123]
s_xor_b32 m0, s84, 3072
ds_read_b128 a[32:35], v2 offset:32768
v_mfma_f32_16x16x32_bf16 v[104:107], a[80:83], a[8:11], v[104:107]
s_xor_b32 s64, s72, 147456
ds_read_b128 a[36:39], v3 offset:32768
v_mfma_f32_16x16x32_bf16 v[104:107], a[84:87], a[12:15], v[104:107]
buffer_load_dwordx4 v13, s[48:51], s64 offen lds
v_mfma_f32_16x16x32_bf16 v[88:91], a[84:87], a[4:7], v[88:91]
ds_read_b128 a[40:43], v2 offset:34816
v_mfma_f32_16x16x32_bf16 v[88:91], a[80:83], a[0:3], v[88:91]
s_waitcnt lgkmcnt(7)
ds_read_b128 a[44:47], v3 offset:34816
v_mfma_f32_16x16x32_bf16 v[28:31], a[0:3], a[88:91], v[28:31]
ds_read_b128 a[48:51], v2 offset:36864
v_mfma_f32_16x16x32_bf16 v[28:31], a[4:7], a[92:95], v[28:31]
ds_read_b128 a[52:55], v3 offset:36864
v_mfma_f32_16x16x32_bf16 v[44:47], a[12:15], a[92:95], v[44:47]
s_xor_b32 m0, s84, 4096
ds_read_b128 a[56:59], v2 offset:38912
v_mfma_f32_16x16x32_bf16 v[44:47], a[8:11], a[88:91], v[44:47]
s_xor_b32 s64, s73, 0
ds_read_b128 a[60:63], v3 offset:38912
v_mfma_f32_16x16x32_bf16 v[60:63], a[16:19], a[88:91], v[60:63]
buffer_load_dwordx4 v12, s[48:51], s64 offen lds
v_mfma_f32_16x16x32_bf16 v[60:63], a[20:23], a[92:95], v[60:63]
ds_read_b64_tr_b16 a[80:81], v9 offset:16384
v_mfma_f32_16x16x32_bf16 v[76:79], a[28:31], a[92:95], v[76:79]
ds_read_b64_tr_b16 a[82:83], v9 offset:17408
v_mfma_f32_16x16x32_bf16 v[76:79], a[24:27], a[88:91], v[76:79]
ds_read_b64_tr_b16 a[84:85], v9 offset:24576
v_mfma_f32_16x16x32_bf16 v[140:143], a[24:27], a[96:99], v[140:143]
ds_read_b64_tr_b16 a[86:87], v9 offset:25600
v_mfma_f32_16x16x32_bf16 v[140:143], a[28:31], a[100:103], v[140:143]
s_xor_b32 m0, s84, 5120
ds_read_b64_tr_b16 a[88:89], v10 offset:16384
v_mfma_f32_16x16x32_bf16 v[124:127], a[20:23], a[100:103], v[124:127]
s_xor_b32 s64, s73, 16384
ds_read_b64_tr_b16 a[90:91], v10 offset:17408
v_mfma_f32_16x16x32_bf16 v[124:127], a[16:19], a[96:99], v[124:127]
buffer_load_dwordx4 v13, s[48:51], s64 offen lds
v_mfma_f32_16x16x32_bf16 v[108:111], a[8:11], a[96:99], v[108:111]
s_branch L_po5
L_pg5:
s_branch L_tr0
L_po5:
ds_read_b64_tr_b16 a[92:93], v10 offset:24576
v_mfma_f32_16x16x32_bf16 v[108:111], a[12:15], a[100:103], v[108:111]
ds_read_b64_tr_b16 a[94:95], v10 offset:25600
v_mfma_f32_16x16x32_bf16 v[92:95], a[4:7], a[100:103], v[92:95]
v_mfma_f32_16x16x32_bf16 v[92:95], a[0:3], a[96:99], v[92:95]
ds_read_b64_tr_b16 a[96:97], v11 offset:16384
v_mfma_f32_16x16x32_bf16 v[32:35], a[0:3], a[104:107], v[32:35]
s_xor_b32 m0, s84, 6144
ds_read_b64_tr_b16 a[98:99], v11 offset:17408
v_mfma_f32_16x16x32_bf16 v[32:35], a[4:7], a[108:111], v[32:35]
s_xor_b32 s64, s73, 131072
ds_read_b64_tr_b16 a[100:101], v11 offset:24576
v_mfma_f32_16x16x32_bf16 v[48:51], a[12:15], a[108:111], v[48:51]
buffer_load_dwordx4 v12, s[48:51], s64 offen lds
v_mfma_f32_16x16x32_bf16 v[48:51], a[8:11], a[104:107], v[48:51]
ds_read_b64_tr_b16 a[102:103], v11 offset:25600
v_mfma_f32_16x16x32_bf16 v[64:67], a[16:19], a[104:107], v[64:67]
v_mfma_f32_16x16x32_bf16 v[64:67], a[20:23], a[108:111], v[64:67]
v_mfma_f32_16x16x32_bf16 v[80:83], a[28:31], a[108:111], v[80:83]
v_mfma_f32_16x16x32_bf16 v[80:83], a[24:27], a[104:107], v[80:83]
s_xor_b32 m0, s84, 7168
v_mfma_f32_16x16x32_bf16 v[144:147], a[24:27], a[112:115], v[144:147]
s_xor_b32 s64, s73, 147456
v_mfma_f32_16x16x32_bf16 v[144:147], a[28:31], a[116:119], v[144:147]
buffer_load_dwordx4 v13, s[48:51], s64 offen lds
v_mfma_f32_16x16x32_bf16 v[128:131], a[20:23], a[116:119], v[128:131]
v_mfma_f32_16x16x32_bf16 v[128:131], a[16:19], a[112:115], v[128:131]
v_mfma_f32_16x16x32_bf16 v[112:115], a[8:11], a[112:115], v[112:115]
v_mfma_f32_16x16x32_bf16 v[112:115], a[12:15], a[116:119], v[112:115]
v_mfma_f32_16x16x32_bf16 v[96:99], a[4:7], a[116:119], v[96:99]
v_mfma_f32_16x16x32_bf16 v[96:99], a[0:3], a[112:115], v[96:99]
s_waitcnt lgkmcnt(0)
v_mfma_f32_16x16x32_bf16 v[36:39], a[0:3], a[72:75], v[36:39]
v_mfma_f32_16x16x32_bf16 v[36:39], a[4:7], a[76:79], v[36:39]
v_mfma_f32_16x16x32_bf16 v[52:55], a[12:15], a[76:79], v[52:55]
s_waitcnt lgkmcnt(0)
s_barrier
v_mfma_f32_16x16x32_bf16 v[52:55], a[8:11], a[72:75], v[52:55]
s_xor_b32 m0, s77, 65536
ds_read_b64_tr_b16 a[104:105], v4 offset:32768
v_mfma_f32_16x16x32_bf16 v[68:71], a[16:19], a[72:75], v[68:71]
s_xor_b32 s64, s71, 524288
ds_read_b64_tr_b16 a[106:107], v4 offset:33792
v_mfma_f32_16x16x32_bf16 v[68:71], a[20:23], a[76:79], v[68:71]
buffer_load_dwordx4 v14, s[56:59], s64 offen lds
v_mfma_f32_16x16x32_bf16 v[84:87], a[28:31], a[76:79], v[84:87]
ds_read_b64_tr_b16 a[108:109], v4 offset:40960
v_mfma_f32_16x16x32_bf16 v[84:87], a[24:27], a[72:75], v[84:87]
ds_read_b64_tr_b16 a[110:111], v4 offset:41984
v_mfma_f32_16x16x32_bf16 v[148:151], a[24:27], a[80:83], v[148:151]
ds_read_b64_tr_b16 a[112:113], v5 offset:32768
v_mfma_f32_16x16x32_bf16 v[148:151], a[28:31], a[84:87], v[148:151]
ds_read_b64_tr_b16 a[114:115], v5 offset:33792
v_mfma_f32_16x16x32_bf16 v[132:135], a[20:23], a[84:87], v[132:135]
ds_read_b64_tr_b16 a[116:117], v5 offset:40960
v_mfma_f32_16x16x32_bf16 v[132:135], a[16:19], a[80:83], v[132:135]
ds_read_b64_tr_b16 a[118:119], v5 offset:41984
v_mfma_f32_16x16x32_bf16 v[116:119], a[8:11], a[80:83], v[116:119]
s_add_u32 m0, s78, 81920
ds_read_b64_tr_b16 a[72:73], v6 offset:32768
v_mfma_f32_16x16x32_bf16 v[116:119], a[12:15], a[84:87], v[116:119]
s_add_u32 s64, s75, 393216
ds_read_b64_tr_b16 a[74:75], v6 offset:33792
v_mfma_f32_16x16x32_bf16 v[100:103], a[4:7], a[84:87], v[100:103]
buffer_load_dwordx4 v23, s[60:63], s64 offen lds
v_mfma_f32_16x16x32_bf16 v[100:103], a[0:3], a[80:83], v[100:103]
ds_read_b64_tr_b16 a[76:77], v6 offset:40960
v_mfma_f32_16x16x32_bf16 v[248:251], a[0:3], a[88:91], v[248:251]
ds_read_b64_tr_b16 a[78:79], v6 offset:41984
v_mfma_f32_16x16x32_bf16 v[248:251], a[4:7], a[92:95], v[248:251]
ds_read_b64_tr_b16 a[80:81], v7 offset:32768
v_mfma_f32_16x16x32_bf16 v[252:255], a[12:15], a[92:95], v[252:255]
ds_read_b64_tr_b16 a[82:83], v7 offset:33792
v_mfma_f32_16x16x32_bf16 v[252:255], a[8:11], a[88:91], v[252:255]
ds_read_b64_tr_b16 a[84:85], v7 offset:40960
v_mfma_f32_16x16x32_bf16 a[120:123], a[16:19], a[88:91], a[120:123]
ds_read_b64_tr_b16 a[86:87], v7 offset:41984
v_mfma_f32_16x16x32_bf16 a[120:123], a[20:23], a[92:95], a[120:123]
s_xor_b32 m0, s77, 66560
v_mfma_f32_16x16x32_bf16 a[124:127], a[28:31], a[92:95], a[124:127]
s_xor_b32 s64, s71, 557056
v_mfma_f32_16x16x32_bf16 a[124:127], a[24:27], a[88:91], a[124:127]
buffer_load_dwordx4 v14, s[56:59], s64 offen lds
v_mfma_f32_16x16x32_bf16 a[128:131], a[24:27], a[96:99], a[128:131]
ds_read_b64_tr_b16 a[88:89], v8 offset:32768
v_mfma_f32_16x16x32_bf16 a[128:131], a[28:31], a[100:103], a[128:131]
ds_read_b64_tr_b16 a[90:91], v8 offset:33792
v_mfma_f32_16x16x32_bf16 a[132:135], a[20:23], a[100:103], a[132:135]
ds_read_b64_tr_b16 a[92:93], v8 offset:40960
v_mfma_f32_16x16x32_bf16 a[132:135], a[16:19], a[96:99], a[132:135]
ds_read_b64_tr_b16 a[94:95], v8 offset:41984
v_mfma_f32_16x16x32_bf16 a[136:139], a[8:11], a[96:99], a[136:139]
v_mfma_f32_16x16x32_bf16 a[136:139], a[12:15], a[100:103], a[136:139]
v_mfma_f32_16x16x32_bf16 a[140:143], a[4:7], a[100:103], a[140:143]
s_add_u32 m0, s78, 86016
v_mfma_f32_16x16x32_bf16 a[140:143], a[0:3], a[96:99], a[140:143]
s_waitcnt lgkmcnt(4)
s_add_u32 s64, s75, 395264
ds_read_b64_tr_b16 a[96:97], v9 offset:32768
v_mfma_f32_16x16x32_bf16 v[184:187], a[104:107], a[32:35], v[184:187]
s_lshl_b32 s66, s30, 30
buffer_load_dwordx4 v23, s[60:63], s64 offen lds
v_mfma_f32_16x16x32_bf16 v[184:187], a[108:111], a[36:39], v[184:187]
ds_read_b64_tr_b16 a[98:99], v9 offset:33792
v_lshl_add_u32 v1, v0, 24, s66
v_mfma_f32_16x16x32_bf16 v[192:195], a[108:111], a[44:47], v[192:195]
s_lshr_b32 s66, s3, 1
ds_read_b64_tr_b16 a[100:101], v9 offset:40960
v_mfma_f32_16x16x32_bf16 v[192:195], a[104:107], a[40:43], v[192:195]
s_lshl_b32 s66, s66, 12
ds_read_b64_tr_b16 a[102:103], v9 offset:41984
v_mfma_f32_16x16x32_bf16 v[200:203], a[104:107], a[48:51], v[200:203]
v_mfma_f32_16x16x32_bf16 v[200:203], a[108:111], a[52:55], v[200:203]
v_mfma_f32_16x16x32_bf16 v[208:211], a[108:111], a[60:63], v[208:211]
v_mfma_f32_16x16x32_bf16 v[208:211], a[104:107], a[56:59], v[208:211]
ds_read_b64_tr_b16 a[104:105], v10 offset:32768
v_mfma_f32_16x16x32_bf16 v[212:215], a[112:115], a[56:59], v[212:215]
s_xor_b32 m0, s77, 67584
ds_read_b64_tr_b16 a[106:107], v10 offset:33792
v_mfma_f32_16x16x32_bf16 v[212:215], a[116:119], a[60:63], v[212:215]
s_xor_b32 s64, s71, 589824
ds_read_b64_tr_b16 a[108:109], v10 offset:40960
v_mfma_f32_16x16x32_bf16 v[204:207], a[116:119], a[52:55], v[204:207]
buffer_load_dwordx4 v15, s[56:59], s64 offen lds
v_mfma_f32_16x16x32_bf16 v[204:207], a[112:115], a[48:51], v[204:207]
ds_read_b64_tr_b16 a[110:111], v10 offset:41984
v_mfma_f32_16x16x32_bf16 v[196:199], a[112:115], a[40:43], v[196:199]
v_mfma_f32_16x16x32_bf16 v[196:199], a[116:119], a[44:47], v[196:199]
v_mfma_f32_16x16x32_bf16 v[188:191], a[116:119], a[36:39], v[188:191]
v_mfma_f32_16x16x32_bf16 v[188:191], a[112:115], a[32:35], v[188:191]
s_add_u32 s67, s79, 20480
ds_read_b64_tr_b16 a[112:113], v11 offset:32768
v_mfma_f32_16x16x32_bf16 v[216:219], a[72:75], a[32:35], v[216:219]
ds_read_b64_tr_b16 a[114:115], v11 offset:33792
v_mfma_f32_16x16x32_bf16 v[216:219], a[76:79], a[36:39], v[216:219]
s_add_u32 m0, s78, 90112
ds_read_b64_tr_b16 a[116:117], v11 offset:40960
v_cvt_pk_bf16_f32 v215, v214, v215
v_mfma_f32_16x16x32_bf16 v[224:227], a[76:79], a[44:47], v[224:227]
s_add_u32 s64, s75, 397312
ds_read_b64_tr_b16 a[118:119], v11 offset:41984
v_cvt_pk_bf16_f32 v214, v212, v213
v_mfma_f32_16x16x32_bf16 v[224:227], a[72:75], a[40:43], v[224:227]
buffer_load_dwordx4 v23, s[60:63], s64 offen lds
v_mfma_f32_16x16x32_bf16 v[232:235], a[72:75], a[48:51], v[232:235]
v_cvt_pk_bf16_f32 v212, v208, v209
v_cvt_pk_bf16_f32 v213, v210, v211
v_mfma_f32_16x16x32_bf16 v[232:235], a[76:79], a[52:55], v[232:235]
buffer_store_dwordx4 v[212:215], v16, s[44:47], s67 offen sc1
v_mfma_f32_16x16x32_bf16 v[240:243], a[76:79], a[60:63], v[240:243]
v_cvt_pk_bf16_f32 v207, v206, v207
v_cvt_pk_bf16_f32 v206, v204, v205
v_mfma_f32_16x16x32_bf16 v[240:243], a[72:75], a[56:59], v[240:243]
ds_read_b64_tr_b16 a[72:73], v4 offset:49152
v_cvt_pk_bf16_f32 v204, v200, v201
v_mfma_f32_16x16x32_bf16 v[244:247], a[80:83], a[56:59], v[244:247]
ds_read_b64_tr_b16 a[74:75], v4 offset:50176
v_cvt_pk_bf16_f32 v205, v202, v203
v_mfma_f32_16x16x32_bf16 v[244:247], a[84:87], a[60:63], v[244:247]
ds_read_b64_tr_b16 a[76:77], v4 offset:57344
v_accvgpr_write_b32 a144, v204
v_mfma_f32_16x16x32_bf16 v[236:239], a[84:87], a[52:55], v[236:239]
s_xor_b32 m0, s77, 68608
ds_read_b64_tr_b16 a[78:79], v4 offset:58368
v_accvgpr_write_b32 a145, v205
v_mfma_f32_16x16x32_bf16 v[236:239], a[80:83], a[48:51], v[236:239]
s_xor_b32 s64, s71, 622592
v_accvgpr_write_b32 a146, v206
v_accvgpr_write_b32 a147, v207
v_mfma_f32_16x16x32_bf16 v[228:231], a[80:83], a[40:43], v[228:231]
buffer_load_dwordx4 v15, s[56:59], s64 offen lds
v_mfma_f32_16x16x32_bf16 v[228:231], a[84:87], a[44:47], v[228:231]
v_cvt_pk_bf16_f32 v199, v198, v199
v_cvt_pk_bf16_f32 v198, v196, v197
v_mfma_f32_16x16x32_bf16 v[220:223], a[84:87], a[36:39], v[220:223]
v_cvt_pk_bf16_f32 v196, v192, v193
v_cvt_pk_bf16_f32 v197, v194, v195
v_mfma_f32_16x16x32_bf16 v[220:223], a[80:83], a[32:35], v[220:223]
s_waitcnt lgkmcnt(4)
ds_read_b64_tr_b16 a[80:81], v5 offset:49152
v_accvgpr_write_b32 a148, v196
v_mfma_f32_16x16x32_bf16 v[152:155], a[88:91], a[32:35], v[152:155]
ds_read_b64_tr_b16 a[82:83], v5 offset:50176
v_accvgpr_write_b32 a149, v197
v_mfma_f32_16x16x32_bf16 v[152:155], a[92:95], a[36:39], v[152:155]
ds_read_b64_tr_b16 a[84:85], v5 offset:57344
v_accvgpr_write_b32 a150, v198
v_mfma_f32_16x16x32_bf16 v[160:163], a[92:95], a[44:47], v[160:163]
ds_read_b64_tr_b16 a[86:87], v5 offset:58368
v_accvgpr_write_b32 a151, v199
v_mfma_f32_16x16x32_bf16 v[160:163], a[88:91], a[40:43], v[160:163]
v_cvt_pk_bf16_f32 v191, v190, v191
v_cvt_pk_bf16_f32 v190, v188, v189
v_mfma_f32_16x16x32_bf16 v[168:171], a[88:91], a[48:51], v[168:171]
v_cvt_pk_bf16_f32 v188, v184, v185
v_cvt_pk_bf16_f32 v189, v186, v187
v_mfma_f32_16x16x32_bf16 v[168:171], a[92:95], a[52:55], v[168:171]
v_accvgpr_write_b32 a152, v188
v_accvgpr_write_b32 a153, v189
v_mfma_f32_16x16x32_bf16 v[176:179], a[92:95], a[60:63], v[176:179]
s_xor_b32 m0, s84, 32768
v_accvgpr_write_b32 a154, v190
v_accvgpr_write_b32 a155, v191
v_mfma_f32_16x16x32_bf16 v[176:179], a[88:91], a[56:59], v[176:179]
s_add_u32 s67, s79, 21504
s_xor_b32 s64, s72, 128
ds_read_b64_tr_b16 a[88:89], v6 offset:49152
v_cvt_pk_bf16_f32 v247, v246, v247
v_mfma_f32_16x16x32_bf16 v[180:183], a[96:99], a[56:59], v[180:183]
buffer_load_dwordx4 v12, s[48:51], s64 offen lds
v_mfma_f32_16x16x32_bf16 v[180:183], a[100:103], a[60:63], v[180:183]
ds_read_b64_tr_b16 a[90:91], v6 offset:50176
v_cvt_pk_bf16_f32 v246, v244, v245
v_mfma_f32_16x16x32_bf16 v[172:175], a[100:103], a[52:55], v[172:175]
ds_read_b64_tr_b16 a[92:93], v6 offset:57344
v_cvt_pk_bf16_f32 v244, v240, v241
v_mfma_f32_16x16x32_bf16 v[172:175], a[96:99], a[48:51], v[172:175]
ds_read_b64_tr_b16 a[94:95], v6 offset:58368
v_cvt_pk_bf16_f32 v245, v242, v243
v_mfma_f32_16x16x32_bf16 v[164:167], a[96:99], a[40:43], v[164:167]
buffer_store_dwordx4 v[244:247], v16, s[44:47], s67 offen sc1
v_mfma_f32_16x16x32_bf16 v[164:167], a[100:103], a[44:47], v[164:167]
s_xor_b32 m0, s84, 33792
v_cvt_pk_bf16_f32 v239, v238, v239
v_cvt_pk_bf16_f32 v238, v236, v237
v_mfma_f32_16x16x32_bf16 v[156:159], a[100:103], a[36:39], v[156:159]
s_xor_b32 s64, s72, 16512
v_cvt_pk_bf16_f32 v236, v232, v233
v_cvt_pk_bf16_f32 v237, v234, v235
v_mfma_f32_16x16x32_bf16 v[156:159], a[96:99], a[32:35], v[156:159]
buffer_load_dwordx4 v13, s[48:51], s64 offen lds
v_mfma_f32_16x16x32_bf16 v[24:27], a[104:107], a[32:35], v[24:27]
ds_read_b64_tr_b16 a[96:97], v7 offset:49152
v_accvgpr_write_b32 a156, v236
v_mfma_f32_16x16x32_bf16 v[24:27], a[108:111], a[36:39], v[24:27]
ds_read_b64_tr_b16 a[98:99], v7 offset:50176
v_accvgpr_write_b32 a157, v237
v_mfma_f32_16x16x32_bf16 v[40:43], a[108:111], a[44:47], v[40:43]
ds_read_b64_tr_b16 a[100:101], v7 offset:57344
v_accvgpr_write_b32 a158, v238
v_mfma_f32_16x16x32_bf16 v[40:43], a[104:107], a[40:43], v[40:43]
ds_read_b64_tr_b16 a[102:103], v7 offset:58368
v_accvgpr_write_b32 a159, v239
v_mfma_f32_16x16x32_bf16 v[56:59], a[104:107], a[48:51], v[56:59]
s_xor_b32 m0, s84, 34816
v_cvt_pk_bf16_f32 v231, v230, v231
v_cvt_pk_bf16_f32 v230, v228, v229
v_mfma_f32_16x16x32_bf16 v[56:59], a[108:111], a[52:55], v[56:59]
s_xor_b32 s64, s72, 131200
v_cvt_pk_bf16_f32 v228, v224, v225
v_cvt_pk_bf16_f32 v229, v226, v227
v_mfma_f32_16x16x32_bf16 v[72:75], a[108:111], a[60:63], v[72:75]
s_waitcnt vmcnt(11)
buffer_load_dwordx4 v12, s[48:51], s64 offen lds
v_mfma_f32_16x16x32_bf16 v[72:75], a[104:107], a[56:59], v[72:75]
ds_read_b64_tr_b16 a[104:105], v8 offset:49152
v_accvgpr_write_b32 a160, v228
v_mfma_f32_16x16x32_bf16 v[136:139], a[112:115], a[56:59], v[136:139]
ds_read_b64_tr_b16 a[106:107], v8 offset:50176
v_accvgpr_write_b32 a161, v229
v_mfma_f32_16x16x32_bf16 v[136:139], a[116:119], a[60:63], v[136:139]
ds_read_b64_tr_b16 a[108:109], v8 offset:57344
v_add_u32 v4, 0x8000, v4
v_mfma_f32_16x16x32_bf16 v[120:123], a[116:119], a[52:55], v[120:123]
ds_read_b64_tr_b16 a[110:111], v8 offset:58368
v_accvgpr_write_b32 a162, v230
v_mfma_f32_16x16x32_bf16 v[120:123], a[112:115], a[48:51], v[120:123]
s_xor_b32 m0, s84, 35840
ds_read_b128 a[0:3], v2 offset:0
v_accvgpr_write_b32 a163, v231
v_mfma_f32_16x16x32_bf16 v[104:107], a[112:115], a[40:43], v[104:107]
s_xor_b32 s64, s72, 147584
ds_read_b128 a[4:7], v3 offset:0
v_cvt_pk_bf16_f32 v223, v222, v223
v_mfma_f32_16x16x32_bf16 v[104:107], a[116:119], a[44:47], v[104:107]
buffer_load_dwordx4 v13, s[48:51], s64 offen lds
v_mfma_f32_16x16x32_bf16 v[88:91], a[116:119], a[36:39], v[88:91]
ds_read_b128 a[8:11], v2 offset:2048
v_cvt_pk_bf16_f32 v222, v220, v221
v_mfma_f32_16x16x32_bf16 v[88:91], a[112:115], a[32:35], v[88:91]
s_waitcnt lgkmcnt(7)
ds_read_b128 a[12:15], v3 offset:2048
v_cvt_pk_bf16_f32 v220, v216, v217
v_mfma_f32_16x16x32_bf16 v[28:31], a[32:35], a[72:75], v[28:31]
ds_read_b128 a[16:19], v2 offset:4096
v_cvt_pk_bf16_f32 v221, v218, v219
v_mfma_f32_16x16x32_bf16 v[28:31], a[36:39], a[76:79], v[28:31]
ds_read_b128 a[20:23], v3 offset:4096
v_add_u32 v5, 0x8000, v5
v_mfma_f32_16x16x32_bf16 v[44:47], a[44:47], a[76:79], v[44:47]
s_xor_b32 m0, s84, 36864
ds_read_b128 a[24:27], v2 offset:6144
v_accvgpr_write_b32 a164, v220
v_mfma_f32_16x16x32_bf16 v[44:47], a[40:43], a[72:75], v[44:47]
s_xor_b32 s64, s73, 128
ds_read_b128 a[28:31], v3 offset:6144
v_accvgpr_write_b32 a165, v221
v_mfma_f32_16x16x32_bf16 v[60:63], a[48:51], a[72:75], v[60:63]
buffer_load_dwordx4 v12, s[48:51], s64 offen lds
v_mfma_f32_16x16x32_bf16 v[60:63], a[52:55], a[76:79], v[60:63]
ds_read_b64_tr_b16 a[112:113], v9 offset:49152
v_accvgpr_write_b32 a166, v222
v_mfma_f32_16x16x32_bf16 v[76:79], a[60:63], a[76:79], v[76:79]
ds_read_b64_tr_b16 a[114:115], v9 offset:50176
v_accvgpr_write_b32 a167, v223
v_mfma_f32_16x16x32_bf16 v[76:79], a[56:59], a[72:75], v[76:79]
s_add_u32 s67, s79, 22528
ds_read_b64_tr_b16 a[116:117], v9 offset:57344
v_cvt_pk_bf16_f32 v183, v182, v183
v_mfma_f32_16x16x32_bf16 v[140:143], a[56:59], a[80:83], v[140:143]
ds_read_b64_tr_b16 a[118:119], v9 offset:58368
v_cvt_pk_bf16_f32 v182, v180, v181
v_mfma_f32_16x16x32_bf16 v[140:143], a[60:63], a[84:87], v[140:143]
s_xor_b32 m0, s84, 37888
ds_read_b64_tr_b16 a[72:73], v10 offset:49152
v_add_u32 v6, 0x8000, v6
v_mfma_f32_16x16x32_bf16 v[124:127], a[52:55], a[84:87], v[124:127]
s_xor_b32 s64, s73, 16512
ds_read_b64_tr_b16 a[74:75], v10 offset:50176
v_cvt_pk_bf16_f32 v180, v176, v177
v_mfma_f32_16x16x32_bf16 v[124:127], a[48:51], a[80:83], v[124:127]
buffer_load_dwordx4 v13, s[48:51], s64 offen lds
v_mfma_f32_16x16x32_bf16 v[108:111], a[40:43], a[80:83], v[108:111]
ds_read_b64_tr_b16 a[76:77], v10 offset:57344
v_cvt_pk_bf16_f32 v181, v178, v179
v_mfma_f32_16x16x32_bf16 v[108:111], a[44:47], a[84:87], v[108:111]
ds_read_b64_tr_b16 a[78:79], v10 offset:58368
v_mfma_f32_16x16x32_bf16 v[92:95], a[36:39], a[84:87], v[92:95]
buffer_store_dwordx4 v[180:183], v16, s[44:47], s67 offen sc1
v_mfma_f32_16x16x32_bf16 v[92:95], a[32:35], a[80:83], v[92:95]
ds_read_b64_tr_b16 a[80:81], v11 offset:49152
v_cvt_pk_bf16_f32 v175, v174, v175
v_mfma_f32_16x16x32_bf16 v[32:35], a[32:35], a[88:91], v[32:35]
s_xor_b32 m0, s84, 38912
ds_read_b64_tr_b16 a[82:83], v11 offset:50176
v_cvt_pk_bf16_f32 v174, v172, v173
v_mfma_f32_16x16x32_bf16 v[32:35], a[36:39], a[92:95], v[32:35]
s_xor_b32 s64, s73, 131200
ds_read_b64_tr_b16 a[84:85], v11 offset:57344
v_add_u32 v7, 0x8000, v7
v_mfma_f32_16x16x32_bf16 v[48:51], a[44:47], a[92:95], v[48:51]
buffer_load_dwordx4 v12, s[48:51], s64 offen lds
v_mfma_f32_16x16x32_bf16 v[48:51], a[40:43], a[88:91], v[48:51]
ds_read_b64_tr_b16 a[86:87], v11 offset:58368
v_cvt_pk_bf16_f32 v172, v168, v169
v_mfma_f32_16x16x32_bf16 v[64:67], a[48:51], a[88:91], v[64:67]
v_cvt_pk_bf16_f32 v173, v170, v171
v_accvgpr_write_b32 a168, v172
v_mfma_f32_16x16x32_bf16 v[64:67], a[52:55], a[92:95], v[64:67]
v_accvgpr_write_b32 a169, v173
v_accvgpr_write_b32 a170, v174
v_mfma_f32_16x16x32_bf16 v[80:83], a[60:63], a[92:95], v[80:83]
v_accvgpr_write_b32 a171, v175
v_cvt_pk_bf16_f32 v167, v166, v167
v_mfma_f32_16x16x32_bf16 v[80:83], a[56:59], a[88:91], v[80:83]
s_xor_b32 m0, s84, 39936
v_cvt_pk_bf16_f32 v166, v164, v165
v_cvt_pk_bf16_f32 v164, v160, v161
v_mfma_f32_16x16x32_bf16 v[144:147], a[56:59], a[96:99], v[144:147]
s_xor_b32 s64, s73, 147584
v_cvt_pk_bf16_f32 v165, v162, v163
v_accvgpr_write_b32 a172, v164
v_mfma_f32_16x16x32_bf16 v[144:147], a[60:63], a[100:103], v[144:147]
buffer_load_dwordx4 v13, s[48:51], s64 offen lds
v_mfma_f32_16x16x32_bf16 v[128:131], a[52:55], a[100:103], v[128:131]
v_add_u32 v8, 0x8000, v8
v_accvgpr_write_b32 a173, v165
v_mfma_f32_16x16x32_bf16 v[128:131], a[48:51], a[96:99], v[128:131]
v_accvgpr_write_b32 a174, v166
v_accvgpr_write_b32 a175, v167
v_mfma_f32_16x16x32_bf16 v[112:115], a[40:43], a[96:99], v[112:115]
v_cvt_pk_bf16_f32 v159, v158, v159
v_cvt_pk_bf16_f32 v158, v156, v157
v_mfma_f32_16x16x32_bf16 v[112:115], a[44:47], a[100:103], v[112:115]
v_cvt_pk_bf16_f32 v156, v152, v153
v_cvt_pk_bf16_f32 v157, v154, v155
v_mfma_f32_16x16x32_bf16 v[96:99], a[36:39], a[100:103], v[96:99]
v_add_u32 v9, 0x8000, v9
v_add_u32 v10, 0x8000, v10
v_mfma_f32_16x16x32_bf16 v[96:99], a[32:35], a[96:99], v[96:99]
s_waitcnt lgkmcnt(0)
v_add_u32 v11, 0x8000, v11
v_accvgpr_write_b32 a176, v156
v_mfma_f32_16x16x32_bf16 v[36:39], a[32:35], a[104:107], v[36:39]
v_accvgpr_write_b32 a177, v157
v_accvgpr_write_b32 a178, v158
v_mfma_f32_16x16x32_bf16 v[36:39], a[36:39], a[108:111], v[36:39]
v_accvgpr_write_b32 a179, v159
v_mfma_f32_16x16x32_bf16 v[52:55], a[44:47], a[108:111], v[52:55]
s_add_u32 s67, s79, 23552
s_waitcnt lgkmcnt(0)
s_barrier
v_mfma_f32_16x16x32_bf16 v[52:55], a[40:43], a[104:107], v[52:55]
s_xor_b32 m0, s77, 98304
ds_read_b64_tr_b16 a[88:89], v19 offset:36864
v_cvt_pk_bf16_f32 v139, v138, v139
v_mfma_f32_16x16x32_bf16 v[68:71], a[48:51], a[104:107], v[68:71]
s_xor_b32 s64, s71, 1048576
ds_read_b64_tr_b16 a[90:91], v19 offset:37120
v_cvt_pk_bf16_f32 v138, v136, v137
v_mfma_f32_16x16x32_bf16 v[68:71], a[52:55], a[108:111], v[68:71]
buffer_load_dwordx4 v14, s[56:59], s64 offen lds
v_mfma_f32_16x16x32_bf16 v[84:87], a[60:63], a[108:111], v[84:87]
ds_read_b64_tr_b16 a[92:93], v19 offset:38912
v_cvt_pk_bf16_f32 v136, v72, v73
v_mfma_f32_16x16x32_bf16 v[84:87], a[56:59], a[104:107], v[84:87]
ds_read_b64_tr_b16 a[94:95], v19 offset:39168
v_cvt_pk_bf16_f32 v137, v74, v75
v_mfma_f32_16x16x32_bf16 v[148:151], a[56:59], a[112:115], v[148:151]
ds_read_b64_tr_b16 a[96:97], v20 offset:36864
v_mfma_f32_16x16x32_bf16 v[148:151], a[60:63], a[116:119], v[148:151]
ds_read_b64_tr_b16 a[98:99], v20 offset:37120
v_mfma_f32_16x16x32_bf16 v[132:135], a[52:55], a[116:119], v[132:135]
ds_read_b64_tr_b16 a[100:101], v20 offset:38912
v_mfma_f32_16x16x32_bf16 v[132:135], a[48:51], a[112:115], v[132:135]
ds_read_b64_tr_b16 a[102:103], v20 offset:39168
v_mfma_f32_16x16x32_bf16 v[116:119], a[40:43], a[112:115], v[116:119]
s_add_u32 m0, s78, 114688
ds_read_b64_tr_b16 a[104:105], v19 offset:40960
v_mfma_f32_16x16x32_bf16 v[116:119], a[44:47], a[116:119], v[116:119]
s_add_u32 s64, s75, 786432
ds_read_b64_tr_b16 a[106:107], v19 offset:41216
v_mfma_f32_16x16x32_bf16 v[100:103], a[36:39], a[116:119], v[100:103]
buffer_load_dwordx4 v23, s[60:63], s64 offen lds
v_mfma_f32_16x16x32_bf16 v[100:103], a[32:35], a[112:115], v[100:103]
ds_read_b64_tr_b16 a[108:109], v19 offset:43008
v_mfma_f32_16x16x32_bf16 v[248:251], a[32:35], a[72:75], v[248:251]
ds_read_b64_tr_b16 a[110:111], v19 offset:43264
v_mfma_f32_16x16x32_bf16 v[248:251], a[36:39], a[76:79], v[248:251]
ds_read_b64_tr_b16 a[112:113], v20 offset:40960
v_mfma_f32_16x16x32_bf16 v[252:255], a[44:47], a[76:79], v[252:255]
ds_read_b64_tr_b16 a[114:115], v20 offset:41216
v_mfma_f32_16x16x32_bf16 v[252:255], a[40:43], a[72:75], v[252:255]
ds_read_b64_tr_b16 a[116:117], v20 offset:43008
v_mfma_f32_16x16x32_bf16 a[120:123], a[48:51], a[72:75], a[120:123]
ds_read_b64_tr_b16 a[118:119], v20 offset:43264
v_mfma_f32_16x16x32_bf16 a[120:123], a[52:55], a[76:79], a[120:123]
s_xor_b32 m0, s77, 99328
buffer_store_dwordx4 v[136:139], v16, s[44:47], s67 offen sc1
v_mfma_f32_16x16x32_bf16 a[124:127], a[60:63], a[76:79], a[124:127]
s_xor_b32 s64, s71, 1081344
v_cvt_pk_bf16_f32 v123, v122, v123
v_cvt_pk_bf16_f32 v122, v120, v121
v_mfma_f32_16x16x32_bf16 a[124:127], a[56:59], a[72:75], a[124:127]
buffer_load_dwordx4 v14, s[56:59], s64 offen lds
v_mfma_f32_16x16x32_bf16 a[128:131], a[56:59], a[80:83], a[128:131]
ds_read_b64_tr_b16 a[72:73], v19 offset:32768
v_cvt_pk_bf16_f32 v120, v56, v57
v_mfma_f32_16x16x32_bf16 a[128:131], a[60:63], a[84:87], a[128:131]
ds_read_b64_tr_b16 a[74:75], v19 offset:33024
v_cvt_pk_bf16_f32 v121, v58, v59
v_mfma_f32_16x16x32_bf16 a[132:135], a[52:55], a[84:87], a[132:135]
ds_read_b64_tr_b16 a[76:77], v19 offset:34816
v_accvgpr_write_b32 a180, v120
v_mfma_f32_16x16x32_bf16 a[132:135], a[48:51], a[80:83], a[132:135]
ds_read_b64_tr_b16 a[78:79], v19 offset:35072
v_accvgpr_write_b32 a181, v121
v_mfma_f32_16x16x32_bf16 a[136:139], a[40:43], a[80:83], a[136:139]
v_accvgpr_write_b32 a182, v122
v_accvgpr_write_b32 a183, v123
v_mfma_f32_16x16x32_bf16 a[136:139], a[44:47], a[84:87], a[136:139]
v_cvt_pk_bf16_f32 v107, v106, v107
v_cvt_pk_bf16_f32 v106, v104, v105
v_mfma_f32_16x16x32_bf16 a[140:143], a[36:39], a[84:87], a[140:143]
s_add_u32 m0, s78, 118784
v_cvt_pk_bf16_f32 v104, v40, v41
v_cvt_pk_bf16_f32 v105, v42, v43
v_mfma_f32_16x16x32_bf16 a[140:143], a[32:35], a[80:83], a[140:143]
s_waitcnt lgkmcnt(4)
s_add_u32 s64, s75, 788480
ds_read_b64_tr_b16 a[80:81], v20 offset:32768
v_accvgpr_write_b32 a184, v104
v_mfma_f32_16x16x32_bf16 v[184:187], a[88:91], a[0:3], 0
buffer_load_dwordx4 v23, s[60:63], s64 offen lds
v_mfma_f32_16x16x32_bf16 v[184:187], a[92:95], a[4:7], v[184:187]
ds_read_b64_tr_b16 a[82:83], v20 offset:33024
v_accvgpr_write_b32 a185, v105
v_mfma_f32_16x16x32_bf16 v[192:195], a[92:95], a[12:15], 0
ds_read_b64_tr_b16 a[84:85], v20 offset:34816
v_accvgpr_write_b32 a186, v106
v_mfma_f32_16x16x32_bf16 v[192:195], a[88:91], a[8:11], v[192:195]
ds_read_b64_tr_b16 a[86:87], v20 offset:35072
v_accvgpr_write_b32 a187, v107
v_mfma_f32_16x16x32_bf16 v[200:203], a[88:91], a[16:19], 0
v_cvt_pk_bf16_f32 v91, v90, v91
v_cvt_pk_bf16_f32 v90, v88, v89
v_mfma_f32_16x16x32_bf16 v[200:203], a[92:95], a[20:23], v[200:203]
v_cvt_pk_bf16_f32 v88, v24, v25
v_cvt_pk_bf16_f32 v89, v26, v27
v_mfma_f32_16x16x32_bf16 v[208:211], a[92:95], a[28:31], 0
v_accvgpr_write_b32 a188, v88
v_accvgpr_write_b32 a189, v89
v_mfma_f32_16x16x32_bf16 v[208:211], a[88:91], a[24:27], v[208:211]
s_xor_b32 m0, s77, 100352
ds_read_b64_tr_b16 a[88:89], v4 offset:32768
v_accvgpr_write_b32 a190, v90
v_mfma_f32_16x16x32_bf16 v[212:215], a[96:99], a[24:27], 0
s_xor_b32 s64, s71, 1114112
ds_read_b64_tr_b16 a[90:91], v4 offset:33792
v_accvgpr_write_b32 a191, v91
v_mfma_f32_16x16x32_bf16 v[212:215], a[100:103], a[28:31], v[212:215]
s_add_u32 s67, s79, 8192
ds_read_b64_tr_b16 a[92:93], v4 offset:40960
v_cvt_pk_bf16_f32 v47, v46, v47
v_mfma_f32_16x16x32_bf16 v[204:207], a[100:103], a[20:23], 0
buffer_load_dwordx4 v15, s[56:59], s64 offen lds
v_mfma_f32_16x16x32_bf16 v[204:207], a[96:99], a[16:19], v[204:207]
ds_read_b64_tr_b16 a[94:95], v4 offset:41984
v_cvt_pk_bf16_f32 v46, v44, v45
v_mfma_f32_16x16x32_bf16 v[196:199], a[96:99], a[8:11], 0
v_cvt_pk_bf16_f32 v44, v28, v29
v_cvt_pk_bf16_f32 v45, v30, v31
v_mfma_f32_16x16x32_bf16 v[196:199], a[100:103], a[12:15], v[196:199]
buffer_store_dwordx4 v[44:47], v16, s[44:47], s67 offen sc1
v_mfma_f32_16x16x32_bf16 v[188:191], a[100:103], a[4:7], 0
v_cvt_pk_bf16_f32 v79, v78, v79
v_cvt_pk_bf16_f32 v78, v76, v77
v_mfma_f32_16x16x32_bf16 v[188:191], a[96:99], a[0:3], v[188:191]
s_branch L_po6
L_pg6:
s_branch L_pg10
L_po6:
ds_read_b64_tr_b16 a[96:97], v5 offset:32768
v_cvt_pk_bf16_f32 v76, v60, v61
v_mfma_f32_16x16x32_bf16 v[216:219], a[0:3], a[104:107], 0
ds_read_b64_tr_b16 a[98:99], v5 offset:33792
v_cvt_pk_bf16_f32 v77, v62, v63
v_mfma_f32_16x16x32_bf16 v[216:219], a[4:7], a[108:111], v[216:219]
s_add_u32 m0, s78, 122880
ds_read_b64_tr_b16 a[100:101], v5 offset:40960
v_accvgpr_write_b32 a192, v76
v_mfma_f32_16x16x32_bf16 v[224:227], a[12:15], a[108:111], 0
s_add_u32 s64, s75, 790528
ds_read_b64_tr_b16 a[102:103], v5 offset:41984
v_accvgpr_write_b32 a193, v77
v_mfma_f32_16x16x32_bf16 v[224:227], a[8:11], a[104:107], v[224:227]
buffer_load_dwordx4 v23, s[60:63], s64 offen lds
v_mfma_f32_16x16x32_bf16 v[232:235], a[16:19], a[104:107], 0
v_accvgpr_write_b32 a194, v78
v_accvgpr_write_b32 a195, v79
v_mfma_f32_16x16x32_bf16 v[232:235], a[20:23], a[108:111], v[232:235]
v_cvt_pk_bf16_f32 v124, v124, v125
v_cvt_pk_bf16_f32 v125, v126, v127
v_mfma_f32_16x16x32_bf16 v[240:243], a[28:31], a[108:111], 0
v_cvt_pk_bf16_f32 v126, v140, v141
v_cvt_pk_bf16_f32 v127, v142, v143
v_mfma_f32_16x16x32_bf16 v[240:243], a[24:27], a[104:107], v[240:243]
ds_read_b64_tr_b16 a[104:105], v6 offset:32768
v_accvgpr_write_b32 a196, v124
v_mfma_f32_16x16x32_bf16 v[244:247], a[24:27], a[112:115], 0
ds_read_b64_tr_b16 a[106:107], v6 offset:33792
v_accvgpr_write_b32 a197, v125
v_mfma_f32_16x16x32_bf16 v[244:247], a[28:31], a[116:119], v[244:247]
ds_read_b64_tr_b16 a[108:109], v6 offset:40960
v_accvgpr_write_b32 a198, v126
v_mfma_f32_16x16x32_bf16 v[236:239], a[20:23], a[116:119], 0
s_xor_b32 m0, s77, 101376
ds_read_b64_tr_b16 a[110:111], v6 offset:41984
v_accvgpr_write_b32 a199, v127
v_mfma_f32_16x16x32_bf16 v[236:239], a[16:19], a[112:115], v[236:239]
s_xor_b32 s64, s71, 1146880
v_cvt_pk_bf16_f32 v92, v92, v93
v_cvt_pk_bf16_f32 v93, v94, v95
v_mfma_f32_16x16x32_bf16 v[228:231], a[8:11], a[112:115], 0
buffer_load_dwordx4 v15, s[56:59], s64 offen lds
v_mfma_f32_16x16x32_bf16 v[228:231], a[12:15], a[116:119], v[228:231]
v_cvt_pk_bf16_f32 v94, v108, v109
v_cvt_pk_bf16_f32 v95, v110, v111
v_mfma_f32_16x16x32_bf16 v[220:223], a[4:7], a[116:119], 0
v_accvgpr_write_b32 a200, v92
v_accvgpr_write_b32 a201, v93
v_mfma_f32_16x16x32_bf16 v[220:223], a[0:3], a[112:115], v[220:223]
s_waitcnt lgkmcnt(4)
ds_read_b64_tr_b16 a[112:113], v7 offset:32768
v_accvgpr_write_b32 a202, v94
v_mfma_f32_16x16x32_bf16 v[152:155], a[72:75], a[0:3], 0
ds_read_b64_tr_b16 a[114:115], v7 offset:33792
v_accvgpr_write_b32 a203, v95
v_mfma_f32_16x16x32_bf16 v[152:155], a[76:79], a[4:7], v[152:155]
s_add_u32 s67, s79, 10240
ds_read_b64_tr_b16 a[116:117], v7 offset:40960
v_cvt_pk_bf16_f32 v51, v50, v51
v_mfma_f32_16x16x32_bf16 v[160:163], a[76:79], a[12:15], 0
ds_read_b64_tr_b16 a[118:119], v7 offset:41984
v_cvt_pk_bf16_f32 v50, v48, v49
v_mfma_f32_16x16x32_bf16 v[160:163], a[72:75], a[8:11], v[160:163]
v_cvt_pk_bf16_f32 v48, v32, v33
v_cvt_pk_bf16_f32 v49, v34, v35
v_mfma_f32_16x16x32_bf16 v[168:171], a[72:75], a[16:19], 0
buffer_store_dwordx4 v[48:51], v16, s[44:47], s67 offen sc1
v_mfma_f32_16x16x32_bf16 v[168:171], a[76:79], a[20:23], v[168:171]
v_subrev_u32 v19, 0x8000, v19
v_subrev_u32 v20, 0x8000, v20
v_mfma_f32_16x16x32_bf16 v[176:179], a[76:79], a[28:31], 0
s_xor_b32 m0, s84, 0
v_cvt_pk_bf16_f32 v83, v82, v83
v_cvt_pk_bf16_f32 v82, v80, v81
v_mfma_f32_16x16x32_bf16 v[176:179], a[72:75], a[24:27], v[176:179]
s_xor_b32 s64, s72, 256
ds_read_b64_tr_b16 a[72:73], v8 offset:32768
v_cvt_pk_bf16_f32 v80, v64, v65
v_mfma_f32_16x16x32_bf16 v[180:183], a[80:83], a[24:27], 0
buffer_load_dwordx4 v12, s[48:51], s64 offen lds
v_mfma_f32_16x16x32_bf16 v[180:183], a[84:87], a[28:31], v[180:183]
ds_read_b64_tr_b16 a[74:75], v8 offset:33792
v_subrev_u32 v4, 0x8000, v4
v_mfma_f32_16x16x32_bf16 v[172:175], a[84:87], a[20:23], 0
ds_read_b64_tr_b16 a[76:77], v8 offset:40960
v_cvt_pk_bf16_f32 v81, v66, v67
v_mfma_f32_16x16x32_bf16 v[172:175], a[80:83], a[16:19], v[172:175]
s_xor_b32 m0, s84, 1024
ds_read_b64_tr_b16 a[78:79], v8 offset:41984
v_accvgpr_write_b32 a204, v80
v_mfma_f32_16x16x32_bf16 v[164:167], a[80:83], a[8:11], 0
s_xor_b32 s64, s72, 16640
v_accvgpr_write_b32 a205, v81
v_accvgpr_write_b32 a206, v82
v_mfma_f32_16x16x32_bf16 v[164:167], a[84:87], a[12:15], v[164:167]
buffer_load_dwordx4 v13, s[48:51], s64 offen lds
v_mfma_f32_16x16x32_bf16 v[156:159], a[84:87], a[4:7], 0
v_accvgpr_write_b32 a207, v83
v_cvt_pk_bf16_f32 v128, v128, v129
v_mfma_f32_16x16x32_bf16 v[156:159], a[80:83], a[0:3], v[156:159]
ds_read_b64_tr_b16 a[80:81], v9 offset:32768
v_cvt_pk_bf16_f32 v129, v130, v131
v_mfma_f32_16x16x32_bf16 v[24:27], a[88:91], a[0:3], 0
s_xor_b32 m0, s84, 2048
ds_read_b64_tr_b16 a[82:83], v9 offset:33792
v_cvt_pk_bf16_f32 v130, v144, v145
v_mfma_f32_16x16x32_bf16 v[24:27], a[92:95], a[4:7], v[24:27]
s_xor_b32 s64, s72, 131328
ds_read_b64_tr_b16 a[84:85], v9 offset:40960
v_subrev_u32 v5, 0x8000, v5
v_mfma_f32_16x16x32_bf16 v[40:43], a[92:95], a[12:15], 0
buffer_load_dwordx4 v12, s[48:51], s64 offen lds
v_mfma_f32_16x16x32_bf16 v[40:43], a[88:91], a[8:11], v[40:43]
ds_read_b64_tr_b16 a[86:87], v9 offset:41984
v_cvt_pk_bf16_f32 v131, v146, v147
v_mfma_f32_16x16x32_bf16 v[56:59], a[88:91], a[16:19], 0
s_xor_b32 m0, s84, 3072
v_accvgpr_write_b32 a208, v128
v_accvgpr_write_b32 a209, v129
v_mfma_f32_16x16x32_bf16 v[56:59], a[92:95], a[20:23], v[56:59]
s_xor_b32 s64, s72, 147712
v_accvgpr_write_b32 a210, v130
v_accvgpr_write_b32 a211, v131
v_mfma_f32_16x16x32_bf16 v[72:75], a[92:95], a[28:31], 0
s_waitcnt vmcnt(13)
ds_read_b128 a[32:35], v2 offset:32768
v_cvt_pk_bf16_f32 v96, v96, v97
v_mfma_f32_16x16x32_bf16 v[72:75], a[88:91], a[24:27], v[72:75]
buffer_load_dwordx4 v13, s[48:51], s64 offen lds
v_mfma_f32_16x16x32_bf16 v[136:139], a[96:99], a[24:27], 0
ds_read_b128 a[36:39], v3 offset:32768
v_cvt_pk_bf16_f32 v97, v98, v99
v_mfma_f32_16x16x32_bf16 v[136:139], a[100:103], a[28:31], v[136:139]
ds_read_b128 a[40:43], v2 offset:34816
v_subrev_u32 v6, 0x8000, v6
v_mfma_f32_16x16x32_bf16 v[120:123], a[100:103], a[20:23], 0
s_xor_b32 m0, s84, 4096
ds_read_b128 a[44:47], v3 offset:34816
v_cvt_pk_bf16_f32 v98, v112, v113
v_mfma_f32_16x16x32_bf16 v[120:123], a[96:99], a[16:19], v[120:123]
s_xor_b32 s64, s73, 256
ds_read_b128 a[48:51], v2 offset:36864
v_cvt_pk_bf16_f32 v99, v114, v115
v_mfma_f32_16x16x32_bf16 v[104:107], a[96:99], a[8:11], 0
buffer_load_dwordx4 v12, s[48:51], s64 offen lds
v_mfma_f32_16x16x32_bf16 v[104:107], a[100:103], a[12:15], v[104:107]
ds_read_b128 a[52:55], v3 offset:36864
v_accvgpr_write_b32 a212, v96
v_mfma_f32_16x16x32_bf16 v[88:91], a[100:103], a[4:7], 0
ds_read_b128 a[56:59], v2 offset:38912
v_accvgpr_write_b32 a213, v97
v_mfma_f32_16x16x32_bf16 v[88:91], a[96:99], a[0:3], v[88:91]
s_waitcnt lgkmcnt(7)
s_xor_b32 m0, s84, 5120
ds_read_b128 a[60:63], v3 offset:38912
v_accvgpr_write_b32 a214, v98
v_mfma_f32_16x16x32_bf16 v[28:31], a[104:107], a[0:3], 0
s_xor_b32 s64, s73, 16640
ds_read_b64_tr_b16 a[88:89], v10 offset:32768
v_accvgpr_write_b32 a215, v99
v_mfma_f32_16x16x32_bf16 v[28:31], a[108:111], a[4:7], v[28:31]
s_add_u32 s67, s79, 12288
buffer_load_dwordx4 v13, s[48:51], s64 offen lds
v_mfma_f32_16x16x32_bf16 v[44:47], a[108:111], a[12:15], 0
ds_read_b64_tr_b16 a[90:91], v10 offset:33792
v_subrev_u32 v7, 0x8000, v7
v_mfma_f32_16x16x32_bf16 v[44:47], a[104:107], a[8:11], v[44:47]
ds_read_b64_tr_b16 a[92:93], v10 offset:40960
v_cvt_pk_bf16_f32 v55, v54, v55
v_mfma_f32_16x16x32_bf16 v[60:63], a[104:107], a[16:19], 0
s_xor_b32 m0, s84, 6144
ds_read_b64_tr_b16 a[94:95], v10 offset:41984
v_cvt_pk_bf16_f32 v54, v52, v53
v_mfma_f32_16x16x32_bf16 v[60:63], a[108:111], a[20:23], v[60:63]
s_xor_b32 s64, s73, 131328
ds_read_b64_tr_b16 a[96:97], v11 offset:32768
v_cvt_pk_bf16_f32 v52, v36, v37
v_mfma_f32_16x16x32_bf16 v[76:79], a[108:111], a[28:31], 0
buffer_load_dwordx4 v12, s[48:51], s64 offen lds
v_mfma_f32_16x16x32_bf16 v[76:79], a[104:107], a[24:27], v[76:79]
ds_read_b64_tr_b16 a[98:99], v11 offset:33792
v_cvt_pk_bf16_f32 v53, v38, v39
v_mfma_f32_16x16x32_bf16 v[140:143], a[112:115], a[24:27], 0
ds_read_b64_tr_b16 a[100:101], v11 offset:40960
v_mfma_f32_16x16x32_bf16 v[140:143], a[116:119], a[28:31], v[140:143]
s_xor_b32 m0, s84, 7168
ds_read_b64_tr_b16 a[102:103], v11 offset:41984
v_subrev_u32 v8, 0x8000, v8
v_mfma_f32_16x16x32_bf16 v[124:127], a[116:119], a[20:23], 0
s_xor_b32 s64, s73, 147712
buffer_store_dwordx4 v[52:55], v16, s[44:47], s67 offen sc1
v_mfma_f32_16x16x32_bf16 v[124:127], a[112:115], a[16:19], v[124:127]
buffer_load_dwordx4 v13, s[48:51], s64 offen lds
v_mfma_f32_16x16x32_bf16 v[108:111], a[112:115], a[8:11], 0
v_cvt_pk_bf16_f32 v87, v86, v87
v_cvt_pk_bf16_f32 v86, v84, v85
v_mfma_f32_16x16x32_bf16 v[108:111], a[116:119], a[12:15], v[108:111]
v_cvt_pk_bf16_f32 v84, v68, v69
v_cvt_pk_bf16_f32 v85, v70, v71
v_mfma_f32_16x16x32_bf16 v[92:95], a[116:119], a[4:7], 0
v_subrev_u32 v9, 0x8000, v9
v_subrev_u32 v10, 0x8000, v10
v_mfma_f32_16x16x32_bf16 v[92:95], a[112:115], a[0:3], v[92:95]
v_subrev_u32 v11, 0x8000, v11
v_accvgpr_write_b32 a216, v84
v_mfma_f32_16x16x32_bf16 v[32:35], a[72:75], a[0:3], 0
v_accvgpr_write_b32 a217, v85
v_accvgpr_write_b32 a218, v86
v_mfma_f32_16x16x32_bf16 v[32:35], a[76:79], a[4:7], v[32:35]
v_accvgpr_write_b32 a219, v87
v_cvt_pk_bf16_f32 v132, v132, v133
v_mfma_f32_16x16x32_bf16 v[48:51], a[76:79], a[12:15], 0
s_waitcnt lgkmcnt(0)
s_barrier
v_mfma_f32_16x16x32_bf16 v[48:51], a[72:75], a[8:11], v[48:51]
s_xor_b32 m0, s77, 131072
ds_read_b64_tr_b16 a[104:105], v19 offset:4096
v_cvt_pk_bf16_f32 v133, v134, v135
v_mfma_f32_16x16x32_bf16 v[64:67], a[72:75], a[16:19], 0
s_xor_b32 s64, s71, 1572864
ds_read_b64_tr_b16 a[106:107], v19 offset:4352
v_cvt_pk_bf16_f32 v134, v148, v149
v_mfma_f32_16x16x32_bf16 v[64:67], a[76:79], a[20:23], v[64:67]
buffer_load_dwordx4 v14, s[56:59], s64 offen lds
v_mfma_f32_16x16x32_bf16 v[80:83], a[76:79], a[28:31], 0
ds_read_b64_tr_b16 a[108:109], v19 offset:6144
v_cvt_pk_bf16_f32 v135, v150, v151
v_mfma_f32_16x16x32_bf16 v[80:83], a[72:75], a[24:27], v[80:83]
ds_read_b64_tr_b16 a[110:111], v19 offset:6400
v_accvgpr_write_b32 a220, v132
v_mfma_f32_16x16x32_bf16 v[144:147], a[80:83], a[24:27], 0
ds_read_b64_tr_b16 a[112:113], v20 offset:4096
v_accvgpr_write_b32 a221, v133
v_mfma_f32_16x16x32_bf16 v[144:147], a[84:87], a[28:31], v[144:147]
ds_read_b64_tr_b16 a[114:115], v20 offset:4352
v_accvgpr_write_b32 a222, v134
v_mfma_f32_16x16x32_bf16 v[128:131], a[84:87], a[20:23], 0
ds_read_b64_tr_b16 a[116:117], v20 offset:6144
v_accvgpr_write_b32 a223, v135
v_mfma_f32_16x16x32_bf16 v[128:131], a[80:83], a[16:19], v[128:131]
ds_read_b64_tr_b16 a[118:119], v20 offset:6400
v_cvt_pk_bf16_f32 v100, v100, v101
v_mfma_f32_16x16x32_bf16 v[112:115], a[80:83], a[8:11], 0
s_add_u32 m0, s78, 147456
ds_read_b64_tr_b16 a[72:73], v19 offset:8192
v_cvt_pk_bf16_f32 v101, v102, v103
v_mfma_f32_16x16x32_bf16 v[112:115], a[84:87], a[12:15], v[112:115]
s_add_u32 s64, s75, 1179648
ds_read_b64_tr_b16 a[74:75], v19 offset:8448
v_cvt_pk_bf16_f32 v102, v116, v117
v_mfma_f32_16x16x32_bf16 v[96:99], a[84:87], a[4:7], 0
buffer_load_dwordx4 v23, s[60:63], s64 offen lds
v_mfma_f32_16x16x32_bf16 v[96:99], a[80:83], a[0:3], v[96:99]
ds_read_b64_tr_b16 a[76:77], v19 offset:10240
v_cvt_pk_bf16_f32 v103, v118, v119
v_mfma_f32_16x16x32_bf16 v[36:39], a[88:91], a[0:3], 0
ds_read_b64_tr_b16 a[78:79], v19 offset:10496
v_accvgpr_write_b32 a224, v100
v_mfma_f32_16x16x32_bf16 v[36:39], a[92:95], a[4:7], v[36:39]
ds_read_b64_tr_b16 a[80:81], v20 offset:8192
v_accvgpr_write_b32 a225, v101
v_mfma_f32_16x16x32_bf16 v[52:55], a[92:95], a[12:15], 0
s_xor_b32 s68, s66, 0
ds_read_b64_tr_b16 a[82:83], v20 offset:8448
v_accvgpr_write_b32 a226, v102
v_mfma_f32_16x16x32_bf16 v[52:55], a[88:91], a[8:11], v[52:55]
s_xor_b32 m0, s77, 132096
ds_read_b64_tr_b16 a[84:85], v20 offset:10240
v_accvgpr_write_b32 a227, v103
v_mfma_f32_16x16x32_bf16 v[68:71], a[88:91], a[16:19], 0
s_add_u32 s67, s79, 14336
ds_read_b64_tr_b16 a[86:87], v20 offset:10496
v_cvt_pk_bf16_f32 v255, v254, v255
v_mfma_f32_16x16x32_bf16 v[68:71], a[92:95], a[20:23], v[68:71]
s_xor_b32 s64, s71, 1605632
v_cvt_pk_bf16_f32 v254, v252, v253
v_cvt_pk_bf16_f32 v252, v248, v249
v_mfma_f32_16x16x32_bf16 v[84:87], a[92:95], a[28:31], 0
s_mov_b64 exec, 1
buffer_atomic_add a251, v1, s[52:55], s68 offen offset:0 sc1
s_mov_b64 exec, -1
v_mfma_f32_16x16x32_bf16 v[84:87], a[88:91], a[24:27], v[84:87]
buffer_load_dwordx4 v14, s[56:59], s64 offen lds
v_mfma_f32_16x16x32_bf16 v[148:151], a[96:99], a[24:27], 0
ds_read_b64_tr_b16 a[88:89], v19 offset:0
v_cvt_pk_bf16_f32 v253, v250, v251
v_mfma_f32_16x16x32_bf16 v[148:151], a[100:103], a[28:31], v[148:151]
ds_read_b64_tr_b16 a[90:91], v19 offset:256
v_mfma_f32_16x16x32_bf16 v[132:135], a[100:103], a[20:23], 0
ds_read_b64_tr_b16 a[92:93], v19 offset:2048
v_mfma_f32_16x16x32_bf16 v[132:135], a[96:99], a[16:19], v[132:135]
s_add_u32 s65, s79, 16384
ds_read_b64_tr_b16 a[94:95], v19 offset:2304
v_mfma_f32_16x16x32_bf16 v[116:119], a[96:99], a[8:11], 0
buffer_store_dwordx4 a[144:147], v16, s[44:47], s65 offen sc1
v_mfma_f32_16x16x32_bf16 v[116:119], a[100:103], a[12:15], v[116:119]
buffer_store_dwordx4 v[252:255], v16, s[44:47], s67 offen sc1
v_mfma_f32_16x16x32_bf16 v[100:103], a[100:103], a[4:7], 0
s_add_u32 m0, s78, 151552
v_mfma_f32_16x16x32_bf16 v[100:103], a[96:99], a[0:3], v[100:103]
s_waitcnt lgkmcnt(4)
s_add_u32 s64, s75, 1181696
ds_read_b64_tr_b16 a[96:97], v20 offset:0
v_accvgpr_read_b32 v248, a120
v_mfma_f32_16x16x32_bf16 v[184:187], a[104:107], a[32:35], v[184:187]
buffer_load_dwordx4 v23, s[60:63], s64 offen lds
v_mfma_f32_16x16x32_bf16 v[184:187], a[108:111], a[36:39], v[184:187]
ds_read_b64_tr_b16 a[98:99], v20 offset:256
v_accvgpr_read_b32 v249, a121
v_mfma_f32_16x16x32_bf16 v[192:195], a[108:111], a[44:47], v[192:195]
ds_read_b64_tr_b16 a[100:101], v20 offset:2048
v_accvgpr_read_b32 v250, a122
v_mfma_f32_16x16x32_bf16 v[192:195], a[104:107], a[40:43], v[192:195]
ds_read_b64_tr_b16 a[102:103], v20 offset:2304
v_accvgpr_read_b32 v251, a123
v_mfma_f32_16x16x32_bf16 v[200:203], a[104:107], a[48:51], v[200:203]
v_accvgpr_read_b32 v252, a124
v_accvgpr_read_b32 v253, a125
v_mfma_f32_16x16x32_bf16 v[200:203], a[108:111], a[52:55], v[200:203]
v_accvgpr_read_b32 v254, a126
v_accvgpr_read_b32 v255, a127
v_mfma_f32_16x16x32_bf16 v[208:211], a[108:111], a[60:63], v[208:211]
v_cvt_pk_bf16_f32 v255, v254, v255
v_cvt_pk_bf16_f32 v254, v252, v253
v_mfma_f32_16x16x32_bf16 v[208:211], a[104:107], a[56:59], v[208:211]
ds_read_b64_tr_b16 a[104:105], v4 offset:0
v_cvt_pk_bf16_f32 v252, v248, v249
v_mfma_f32_16x16x32_bf16 v[212:215], a[112:115], a[56:59], v[212:215]
s_xor_b32 m0, s77, 133120
ds_read_b64_tr_b16 a[106:107], v4 offset:1024
v_cvt_pk_bf16_f32 v253, v250, v251
v_mfma_f32_16x16x32_bf16 v[212:215], a[116:119], a[60:63], v[212:215]
s_xor_b32 s64, s71, 1638400
ds_read_b64_tr_b16 a[108:109], v4 offset:8192
v_accvgpr_write_b32 a228, v252
v_mfma_f32_16x16x32_bf16 v[204:207], a[116:119], a[52:55], v[204:207]
buffer_load_dwordx4 v15, s[56:59], s64 offen lds
v_mfma_f32_16x16x32_bf16 v[204:207], a[112:115], a[48:51], v[204:207]
ds_read_b64_tr_b16 a[110:111], v4 offset:9216
v_accvgpr_write_b32 a229, v253
v_mfma_f32_16x16x32_bf16 v[196:199], a[112:115], a[40:43], v[196:199]
v_accvgpr_write_b32 a230, v254
v_accvgpr_write_b32 a231, v255
v_mfma_f32_16x16x32_bf16 v[196:199], a[116:119], a[44:47], v[196:199]
v_mfma_f32_16x16x32_bf16 v[188:191], a[116:119], a[36:39], v[188:191]
v_accvgpr_read_b32 v248, a132
v_accvgpr_read_b32 v249, a133
v_mfma_f32_16x16x32_bf16 v[188:191], a[112:115], a[32:35], v[188:191]
ds_read_b64_tr_b16 a[112:113], v5 offset:0
v_accvgpr_read_b32 v250, a134
v_mfma_f32_16x16x32_bf16 v[216:219], a[32:35], a[72:75], v[216:219]
ds_read_b64_tr_b16 a[114:115], v5 offset:1024
v_accvgpr_read_b32 v251, a135
v_mfma_f32_16x16x32_bf16 v[216:219], a[36:39], a[76:79], v[216:219]
s_add_u32 m0, s78, 155648
ds_read_b64_tr_b16 a[116:117], v5 offset:8192
v_accvgpr_read_b32 v252, a128
v_mfma_f32_16x16x32_bf16 v[224:227], a[44:47], a[76:79], v[224:227]
s_add_u32 s64, s75, 1183744
ds_read_b64_tr_b16 a[118:119], v5 offset:9216
v_accvgpr_read_b32 v253, a129
v_mfma_f32_16x16x32_bf16 v[224:227], a[40:43], a[72:75], v[224:227]
buffer_load_dwordx4 v23, s[60:63], s64 offen lds
v_mfma_f32_16x16x32_bf16 v[232:235], a[48:51], a[72:75], v[232:235]
v_accvgpr_read_b32 v254, a130
v_accvgpr_read_b32 v255, a131
v_mfma_f32_16x16x32_bf16 v[232:235], a[52:55], a[76:79], v[232:235]
v_cvt_pk_bf16_f32 v255, v254, v255
v_cvt_pk_bf16_f32 v254, v252, v253
v_mfma_f32_16x16x32_bf16 v[240:243], a[60:63], a[76:79], v[240:243]
v_cvt_pk_bf16_f32 v252, v248, v249
v_cvt_pk_bf16_f32 v253, v250, v251
v_mfma_f32_16x16x32_bf16 v[240:243], a[56:59], a[72:75], v[240:243]
ds_read_b64_tr_b16 a[72:73], v6 offset:0
v_accvgpr_write_b32 a232, v252
v_mfma_f32_16x16x32_bf16 v[244:247], a[56:59], a[80:83], v[244:247]
ds_read_b64_tr_b16 a[74:75], v6 offset:1024
v_accvgpr_write_b32 a233, v253
v_mfma_f32_16x16x32_bf16 v[244:247], a[60:63], a[84:87], v[244:247]
ds_read_b64_tr_b16 a[76:77], v6 offset:8192
v_accvgpr_write_b32 a234, v254
v_mfma_f32_16x16x32_bf16 v[236:239], a[52:55], a[84:87], v[236:239]
s_xor_b32 m0, s77, 134144
ds_read_b64_tr_b16 a[78:79], v6 offset:9216
v_accvgpr_write_b32 a235, v255
v_mfma_f32_16x16x32_bf16 v[236:239], a[48:51], a[80:83], v[236:239]
s_xor_b32 s64, s71, 1671168
v_mfma_f32_16x16x32_bf16 v[228:231], a[40:43], a[80:83], v[228:231]
buffer_load_dwordx4 v15, s[56:59], s64 offen lds
v_mfma_f32_16x16x32_bf16 v[228:231], a[44:47], a[84:87], v[228:231]
v_accvgpr_read_b32 v248, a140
v_accvgpr_read_b32 v249, a141
v_mfma_f32_16x16x32_bf16 v[220:223], a[36:39], a[84:87], v[220:223]
v_accvgpr_read_b32 v250, a142
v_accvgpr_read_b32 v251, a143
v_mfma_f32_16x16x32_bf16 v[220:223], a[32:35], a[80:83], v[220:223]
s_waitcnt lgkmcnt(4)
ds_read_b64_tr_b16 a[80:81], v7 offset:0
v_accvgpr_read_b32 v252, a136
v_mfma_f32_16x16x32_bf16 v[152:155], a[88:91], a[32:35], v[152:155]
ds_read_b64_tr_b16 a[82:83], v7 offset:1024
v_accvgpr_read_b32 v253, a137
v_mfma_f32_16x16x32_bf16 v[152:155], a[92:95], a[36:39], v[152:155]
ds_read_b64_tr_b16 a[84:85], v7 offset:8192
v_accvgpr_read_b32 v254, a138
v_mfma_f32_16x16x32_bf16 v[160:163], a[92:95], a[44:47], v[160:163]
ds_read_b64_tr_b16 a[86:87], v7 offset:9216
v_accvgpr_read_b32 v255, a139
v_mfma_f32_16x16x32_bf16 v[160:163], a[88:91], a[40:43], v[160:163]
v_cvt_pk_bf16_f32 v255, v254, v255
v_cvt_pk_bf16_f32 v254, v252, v253
v_mfma_f32_16x16x32_bf16 v[168:171], a[88:91], a[48:51], v[168:171]
v_cvt_pk_bf16_f32 v252, v248, v249
v_cvt_pk_bf16_f32 v253, v250, v251
v_mfma_f32_16x16x32_bf16 v[168:171], a[92:95], a[52:55], v[168:171]
v_accvgpr_write_b32 a236, v252
v_accvgpr_write_b32 a237, v253
v_mfma_f32_16x16x32_bf16 v[176:179], a[92:95], a[60:63], v[176:179]
s_xor_b32 m0, s84, 32768
v_accvgpr_write_b32 a238, v254
v_accvgpr_write_b32 a239, v255
v_mfma_f32_16x16x32_bf16 v[176:179], a[88:91], a[56:59], v[176:179]
s_xor_b32 s64, s72, 384
ds_read_b64_tr_b16 a[88:89], v8 offset:0
v_mfma_f32_16x16x32_bf16 v[180:183], a[96:99], a[56:59], v[180:183]
s_add_u32 s65, s79, 4096
buffer_load_dwordx4 v12, s[48:51], s64 offen lds
v_mfma_f32_16x16x32_bf16 v[180:183], a[100:103], a[60:63], v[180:183]
buffer_store_dwordx4 a[148:151], v16, s[44:47], s65 offen sc1
v_mfma_f32_16x16x32_bf16 v[172:175], a[100:103], a[52:55], v[172:175]
ds_read_b64_tr_b16 a[90:91], v8 offset:1024
v_mfma_f32_16x16x32_bf16 v[172:175], a[96:99], a[48:51], v[172:175]
s_xor_b32 m0, s84, 33792
ds_read_b64_tr_b16 a[92:93], v8 offset:8192
v_mfma_f32_16x16x32_bf16 v[164:167], a[96:99], a[40:43], v[164:167]
s_xor_b32 s64, s72, 16768
ds_read_b64_tr_b16 a[94:95], v8 offset:9216
v_mfma_f32_16x16x32_bf16 v[164:167], a[100:103], a[44:47], v[164:167]
buffer_load_dwordx4 v13, s[48:51], s64 offen lds
v_mfma_f32_16x16x32_bf16 v[156:159], a[100:103], a[36:39], v[156:159]
v_mfma_f32_16x16x32_bf16 v[156:159], a[96:99], a[32:35], v[156:159]
ds_read_b64_tr_b16 a[96:97], v9 offset:0
v_mfma_f32_16x16x32_bf16 v[24:27], a[104:107], a[32:35], v[24:27]
s_xor_b32 m0, s84, 34816
ds_read_b64_tr_b16 a[98:99], v9 offset:1024
v_mfma_f32_16x16x32_bf16 v[24:27], a[108:111], a[36:39], v[24:27]
s_xor_b32 s64, s72, 131456
ds_read_b64_tr_b16 a[100:101], v9 offset:8192
v_mfma_f32_16x16x32_bf16 v[40:43], a[108:111], a[44:47], v[40:43]
buffer_load_dwordx4 v12, s[48:51], s64 offen lds
v_mfma_f32_16x16x32_bf16 v[40:43], a[104:107], a[40:43], v[40:43]
ds_read_b64_tr_b16 a[102:103], v9 offset:9216
v_mfma_f32_16x16x32_bf16 v[56:59], a[104:107], a[48:51], v[56:59]
v_mfma_f32_16x16x32_bf16 v[56:59], a[108:111], a[52:55], v[56:59]
s_xor_b32 m0, s84, 35840
v_mfma_f32_16x16x32_bf16 v[72:75], a[108:111], a[60:63], v[72:75]
s_waitcnt vmcnt(14)
s_xor_b32 s64, s72, 147840
ds_read_b128 a[0:3], v2 offset:0
v_mfma_f32_16x16x32_bf16 v[72:75], a[104:107], a[56:59], v[72:75]
buffer_load_dwordx4 v13, s[48:51], s64 offen lds
v_mfma_f32_16x16x32_bf16 v[136:139], a[112:115], a[56:59], v[136:139]
ds_read_b128 a[4:7], v3 offset:0
v_mfma_f32_16x16x32_bf16 v[136:139], a[116:119], a[60:63], v[136:139]
ds_read_b128 a[8:11], v2 offset:2048
v_mfma_f32_16x16x32_bf16 v[120:123], a[116:119], a[52:55], v[120:123]
s_xor_b32 m0, s84, 36864
ds_read_b128 a[12:15], v3 offset:2048
v_mfma_f32_16x16x32_bf16 v[120:123], a[112:115], a[48:51], v[120:123]
s_xor_b32 s64, s73, 384
ds_read_b128 a[16:19], v2 offset:4096
v_mfma_f32_16x16x32_bf16 v[104:107], a[112:115], a[40:43], v[104:107]
buffer_load_dwordx4 v12, s[48:51], s64 offen lds
v_mfma_f32_16x16x32_bf16 v[104:107], a[116:119], a[44:47], v[104:107]
ds_read_b128 a[20:23], v3 offset:4096
v_mfma_f32_16x16x32_bf16 v[88:91], a[116:119], a[36:39], v[88:91]
ds_read_b128 a[24:27], v2 offset:6144
v_mfma_f32_16x16x32_bf16 v[88:91], a[112:115], a[32:35], v[88:91]
s_waitcnt lgkmcnt(7)
s_xor_b32 m0, s84, 37888
ds_read_b128 a[28:31], v3 offset:6144
v_mfma_f32_16x16x32_bf16 v[28:31], a[72:75], a[32:35], v[28:31]
s_xor_b32 s64, s73, 16768
ds_read_b64_tr_b16 a[104:105], v10 offset:0
v_mfma_f32_16x16x32_bf16 v[28:31], a[76:79], a[36:39], v[28:31]
buffer_load_dwordx4 v13, s[48:51], s64 offen lds
v_mfma_f32_16x16x32_bf16 v[44:47], a[76:79], a[44:47], v[44:47]
ds_read_b64_tr_b16 a[106:107], v10 offset:1024
v_mfma_f32_16x16x32_bf16 v[44:47], a[72:75], a[40:43], v[44:47]
ds_read_b64_tr_b16 a[108:109], v10 offset:8192
v_mfma_f32_16x16x32_bf16 v[60:63], a[72:75], a[48:51], v[60:63]
s_xor_b32 m0, s84, 38912
ds_read_b64_tr_b16 a[110:111], v10 offset:9216
v_mfma_f32_16x16x32_bf16 v[60:63], a[76:79], a[52:55], v[60:63]
s_xor_b32 s64, s73, 131456
ds_read_b64_tr_b16 a[112:113], v11 offset:0
v_mfma_f32_16x16x32_bf16 v[76:79], a[76:79], a[60:63], v[76:79]
buffer_load_dwordx4 v12, s[48:51], s64 offen lds
v_mfma_f32_16x16x32_bf16 v[76:79], a[72:75], a[56:59], v[76:79]
ds_read_b64_tr_b16 a[114:115], v11 offset:1024
v_mfma_f32_16x16x32_bf16 v[140:143], a[80:83], a[56:59], v[140:143]
ds_read_b64_tr_b16 a[116:117], v11 offset:8192
v_mfma_f32_16x16x32_bf16 v[140:143], a[84:87], a[60:63], v[140:143]
s_xor_b32 m0, s84, 39936
ds_read_b64_tr_b16 a[118:119], v11 offset:9216
v_mfma_f32_16x16x32_bf16 v[124:127], a[84:87], a[52:55], v[124:127]
s_xor_b32 s64, s73, 147840
v_mfma_f32_16x16x32_bf16 v[124:127], a[80:83], a[48:51], v[124:127]
buffer_load_dwordx4 v13, s[48:51], s64 offen lds
v_mfma_f32_16x16x32_bf16 v[108:111], a[80:83], a[40:43], v[108:111]
v_mfma_f32_16x16x32_bf16 v[108:111], a[84:87], a[44:47], v[108:111]
v_mfma_f32_16x16x32_bf16 v[92:95], a[84:87], a[36:39], v[92:95]
v_mfma_f32_16x16x32_bf16 v[92:95], a[80:83], a[32:35], v[92:95]
v_mfma_f32_16x16x32_bf16 v[32:35], a[88:91], a[32:35], v[32:35]
v_mfma_f32_16x16x32_bf16 v[32:35], a[92:95], a[36:39], v[32:35]
s_branch L_po7
L_pg7:
s_branch L_pg11
L_po7:
v_mfma_f32_16x16x32_bf16 v[48:51], a[92:95], a[44:47], v[48:51]
s_waitcnt lgkmcnt(0)
s_barrier
v_mfma_f32_16x16x32_bf16 v[48:51], a[88:91], a[40:43], v[48:51]
s_xor_b32 m0, s77, 65536
ds_read_b64_tr_b16 a[72:73], v19 offset:36864
v_mfma_f32_16x16x32_bf16 v[64:67], a[88:91], a[48:51], v[64:67]
s_xor_b32 s64, s71, 2097152
ds_read_b64_tr_b16 a[74:75], v19 offset:37120
v_mfma_f32_16x16x32_bf16 v[64:67], a[92:95], a[52:55], v[64:67]
s_add_u32 s65, s79, 0
buffer_load_dwordx4 v14, s[56:59], s64 offen lds
v_mfma_f32_16x16x32_bf16 v[80:83], a[92:95], a[60:63], v[80:83]
buffer_store_dwordx4 a[152:155], v16, s[44:47], s65 offen sc1
v_mfma_f32_16x16x32_bf16 v[80:83], a[88:91], a[56:59], v[80:83]
ds_read_b64_tr_b16 a[76:77], v19 offset:38912
v_mfma_f32_16x16x32_bf16 v[144:147], a[96:99], a[56:59], v[144:147]
ds_read_b64_tr_b16 a[78:79], v19 offset:39168
v_mfma_f32_16x16x32_bf16 v[144:147], a[100:103], a[60:63], v[144:147]
ds_read_b64_tr_b16 a[80:81], v20 offset:36864
v_mfma_f32_16x16x32_bf16 v[128:131], a[100:103], a[52:55], v[128:131]
ds_read_b64_tr_b16 a[82:83], v20 offset:37120
v_mfma_f32_16x16x32_bf16 v[128:131], a[96:99], a[48:51], v[128:131]
ds_read_b64_tr_b16 a[84:85], v20 offset:38912
v_mfma_f32_16x16x32_bf16 v[112:115], a[96:99], a[40:43], v[112:115]
s_add_u32 m0, s78, 81920
ds_read_b64_tr_b16 a[86:87], v20 offset:39168
v_mfma_f32_16x16x32_bf16 v[112:115], a[100:103], a[44:47], v[112:115]
s_add_u32 s64, s75, 1572864
ds_read_b64_tr_b16 a[88:89], v19 offset:40960
v_mfma_f32_16x16x32_bf16 v[96:99], a[100:103], a[36:39], v[96:99]
buffer_load_dwordx4 v23, s[60:63], s64 offen lds
v_mfma_f32_16x16x32_bf16 v[96:99], a[96:99], a[32:35], v[96:99]
ds_read_b64_tr_b16 a[90:91], v19 offset:41216
v_mfma_f32_16x16x32_bf16 v[36:39], a[104:107], a[32:35], v[36:39]
ds_read_b64_tr_b16 a[92:93], v19 offset:43008
v_mfma_f32_16x16x32_bf16 v[36:39], a[108:111], a[36:39], v[36:39]
ds_read_b64_tr_b16 a[94:95], v19 offset:43264
v_mfma_f32_16x16x32_bf16 v[52:55], a[108:111], a[44:47], v[52:55]
ds_read_b64_tr_b16 a[96:97], v20 offset:40960
v_mfma_f32_16x16x32_bf16 v[52:55], a[104:107], a[40:43], v[52:55]
ds_read_b64_tr_b16 a[98:99], v20 offset:41216
v_mfma_f32_16x16x32_bf16 v[68:71], a[104:107], a[48:51], v[68:71]
s_xor_b32 m0, s77, 66560
ds_read_b64_tr_b16 a[100:101], v20 offset:43008
v_mfma_f32_16x16x32_bf16 v[68:71], a[108:111], a[52:55], v[68:71]
s_xor_b32 s64, s71, 2129920
s_xor_b32 s68, s66, 4096
ds_read_b64_tr_b16 a[102:103], v20 offset:43264
v_mfma_f32_16x16x32_bf16 v[84:87], a[108:111], a[60:63], v[84:87]
s_mov_b64 exec, 1
buffer_atomic_add a251, v1, s[52:55], s68 offen offset:0 sc1
s_mov_b64 exec, -1
v_mfma_f32_16x16x32_bf16 v[84:87], a[104:107], a[56:59], v[84:87]
buffer_load_dwordx4 v14, s[56:59], s64 offen lds
v_mfma_f32_16x16x32_bf16 v[148:151], a[112:115], a[56:59], v[148:151]
ds_read_b64_tr_b16 a[104:105], v19 offset:32768
v_mfma_f32_16x16x32_bf16 v[148:151], a[116:119], a[60:63], v[148:151]
ds_read_b64_tr_b16 a[106:107], v19 offset:33024
v_mfma_f32_16x16x32_bf16 v[132:135], a[116:119], a[52:55], v[132:135]
ds_read_b64_tr_b16 a[108:109], v19 offset:34816
v_mfma_f32_16x16x32_bf16 v[132:135], a[112:115], a[48:51], v[132:135]
ds_read_b64_tr_b16 a[110:111], v19 offset:35072
v_mfma_f32_16x16x32_bf16 v[116:119], a[112:115], a[40:43], v[116:119]
v_mfma_f32_16x16x32_bf16 v[116:119], a[116:119], a[44:47], v[116:119]
v_mfma_f32_16x16x32_bf16 v[100:103], a[116:119], a[36:39], v[100:103]
s_add_u32 m0, s78, 86016
v_mfma_f32_16x16x32_bf16 v[100:103], a[112:115], a[32:35], v[100:103]
s_waitcnt lgkmcnt(4)
s_add_u32 s64, s75, 1574912
ds_read_b64_tr_b16 a[112:113], v20 offset:32768
v_mfma_f32_16x16x32_bf16 v[184:187], a[72:75], a[0:3], v[184:187]
buffer_load_dwordx4 v23, s[60:63], s64 offen lds
v_mfma_f32_16x16x32_bf16 v[184:187], a[76:79], a[4:7], v[184:187]
ds_read_b64_tr_b16 a[114:115], v20 offset:33024
v_mfma_f32_16x16x32_bf16 v[192:195], a[76:79], a[12:15], v[192:195]
ds_read_b64_tr_b16 a[116:117], v20 offset:34816
v_mfma_f32_16x16x32_bf16 v[192:195], a[72:75], a[8:11], v[192:195]
ds_read_b64_tr_b16 a[118:119], v20 offset:35072
v_mfma_f32_16x16x32_bf16 v[200:203], a[72:75], a[16:19], v[200:203]
v_mfma_f32_16x16x32_bf16 v[200:203], a[76:79], a[20:23], v[200:203]
v_mfma_f32_16x16x32_bf16 v[208:211], a[76:79], a[28:31], v[208:211]
v_mfma_f32_16x16x32_bf16 v[208:211], a[72:75], a[24:27], v[208:211]
ds_read_b64_tr_b16 a[72:73], v4 offset:32768
v_mfma_f32_16x16x32_bf16 v[212:215], a[80:83], a[24:27], v[212:215]
s_xor_b32 m0, s77, 67584
ds_read_b64_tr_b16 a[74:75], v4 offset:33792
v_mfma_f32_16x16x32_bf16 v[212:215], a[84:87], a[28:31], v[212:215]
s_xor_b32 s64, s71, 2162688
ds_read_b64_tr_b16 a[76:77], v4 offset:40960
v_mfma_f32_16x16x32_bf16 v[204:207], a[84:87], a[20:23], v[204:207]
buffer_load_dwordx4 v15, s[56:59], s64 offen lds
v_mfma_f32_16x16x32_bf16 v[204:207], a[80:83], a[16:19], v[204:207]
ds_read_b64_tr_b16 a[78:79], v4 offset:41984
v_mfma_f32_16x16x32_bf16 v[196:199], a[80:83], a[8:11], v[196:199]
v_mfma_f32_16x16x32_bf16 v[196:199], a[84:87], a[12:15], v[196:199]
v_mfma_f32_16x16x32_bf16 v[188:191], a[84:87], a[4:7], v[188:191]
v_mfma_f32_16x16x32_bf16 v[188:191], a[80:83], a[0:3], v[188:191]
ds_read_b64_tr_b16 a[80:81], v5 offset:32768
v_mfma_f32_16x16x32_bf16 v[216:219], a[0:3], a[88:91], v[216:219]
ds_read_b64_tr_b16 a[82:83], v5 offset:33792
v_mfma_f32_16x16x32_bf16 v[216:219], a[4:7], a[92:95], v[216:219]
s_add_u32 m0, s78, 90112
s_add_u32 s65, s79, 17408
ds_read_b64_tr_b16 a[84:85], v5 offset:40960
v_mfma_f32_16x16x32_bf16 v[224:227], a[12:15], a[92:95], v[224:227]
s_add_u32 s64, s75, 1576960
buffer_store_dwordx4 a[156:159], v16, s[44:47], s65 offen sc1
v_mfma_f32_16x16x32_bf16 v[224:227], a[8:11], a[88:91], v[224:227]
buffer_load_dwordx4 v23, s[60:63], s64 offen lds
v_mfma_f32_16x16x32_bf16 v[232:235], a[16:19], a[88:91], v[232:235]
ds_read_b64_tr_b16 a[86:87], v5 offset:41984
v_mfma_f32_16x16x32_bf16 v[232:235], a[20:23], a[92:95], v[232:235]
v_mfma_f32_16x16x32_bf16 v[240:243], a[28:31], a[92:95], v[240:243]
v_mfma_f32_16x16x32_bf16 v[240:243], a[24:27], a[88:91], v[240:243]
ds_read_b64_tr_b16 a[88:89], v6 offset:32768
v_mfma_f32_16x16x32_bf16 v[244:247], a[24:27], a[96:99], v[244:247]
ds_read_b64_tr_b16 a[90:91], v6 offset:33792
v_mfma_f32_16x16x32_bf16 v[244:247], a[28:31], a[100:103], v[244:247]
ds_read_b64_tr_b16 a[92:93], v6 offset:40960
v_add_u32 v19, 0x8000, v19
v_mfma_f32_16x16x32_bf16 v[236:239], a[20:23], a[100:103], v[236:239]
s_xor_b32 m0, s77, 68608
ds_read_b64_tr_b16 a[94:95], v6 offset:41984
v_mfma_f32_16x16x32_bf16 v[236:239], a[16:19], a[96:99], v[236:239]
s_xor_b32 s64, s71, 2195456
v_mfma_f32_16x16x32_bf16 v[228:231], a[8:11], a[96:99], v[228:231]
buffer_load_dwordx4 v15, s[56:59], s64 offen lds
v_mfma_f32_16x16x32_bf16 v[228:231], a[12:15], a[100:103], v[228:231]
v_mfma_f32_16x16x32_bf16 v[220:223], a[4:7], a[100:103], v[220:223]
v_mfma_f32_16x16x32_bf16 v[220:223], a[0:3], a[96:99], v[220:223]
s_waitcnt lgkmcnt(4)
ds_read_b64_tr_b16 a[96:97], v7 offset:32768
v_mfma_f32_16x16x32_bf16 v[152:155], a[104:107], a[0:3], v[152:155]
ds_read_b64_tr_b16 a[98:99], v7 offset:33792
v_mfma_f32_16x16x32_bf16 v[152:155], a[108:111], a[4:7], v[152:155]
ds_read_b64_tr_b16 a[100:101], v7 offset:40960
v_add_u32 v20, 0x8000, v20
v_mfma_f32_16x16x32_bf16 v[160:163], a[108:111], a[12:15], v[160:163]
ds_read_b64_tr_b16 a[102:103], v7 offset:41984
v_mfma_f32_16x16x32_bf16 v[160:163], a[104:107], a[8:11], v[160:163]
v_mfma_f32_16x16x32_bf16 v[168:171], a[104:107], a[16:19], v[168:171]
v_mfma_f32_16x16x32_bf16 v[168:171], a[108:111], a[20:23], v[168:171]
v_mfma_f32_16x16x32_bf16 v[176:179], a[108:111], a[28:31], v[176:179]
s_xor_b32 m0, s84, 0
v_mfma_f32_16x16x32_bf16 v[176:179], a[104:107], a[24:27], v[176:179]
s_xor_b32 s64, s72, 512
ds_read_b64_tr_b16 a[104:105], v8 offset:32768
v_mfma_f32_16x16x32_bf16 v[180:183], a[112:115], a[24:27], v[180:183]
buffer_load_dwordx4 v12, s[48:51], s64 offen lds
v_mfma_f32_16x16x32_bf16 v[180:183], a[116:119], a[28:31], v[180:183]
ds_read_b64_tr_b16 a[106:107], v8 offset:33792
v_add_u32 v4, 0x8000, v4
v_mfma_f32_16x16x32_bf16 v[172:175], a[116:119], a[20:23], v[172:175]
ds_read_b64_tr_b16 a[108:109], v8 offset:40960
v_mfma_f32_16x16x32_bf16 v[172:175], a[112:115], a[16:19], v[172:175]
s_xor_b32 m0, s84, 1024
ds_read_b64_tr_b16 a[110:111], v8 offset:41984
v_mfma_f32_16x16x32_bf16 v[164:167], a[112:115], a[8:11], v[164:167]
s_xor_b32 s64, s72, 16896
v_mfma_f32_16x16x32_bf16 v[164:167], a[116:119], a[12:15], v[164:167]
buffer_load_dwordx4 v13, s[48:51], s64 offen lds
v_mfma_f32_16x16x32_bf16 v[156:159], a[116:119], a[4:7], v[156:159]
v_mfma_f32_16x16x32_bf16 v[156:159], a[112:115], a[0:3], v[156:159]
ds_read_b64_tr_b16 a[112:113], v9 offset:32768
v_mfma_f32_16x16x32_bf16 v[24:27], a[72:75], a[0:3], v[24:27]
s_xor_b32 m0, s84, 2048
ds_read_b64_tr_b16 a[114:115], v9 offset:33792
v_mfma_f32_16x16x32_bf16 v[24:27], a[76:79], a[4:7], v[24:27]
s_xor_b32 s64, s72, 131584
ds_read_b64_tr_b16 a[116:117], v9 offset:40960
v_add_u32 v5, 0x8000, v5
v_mfma_f32_16x16x32_bf16 v[40:43], a[76:79], a[12:15], v[40:43]
buffer_load_dwordx4 v12, s[48:51], s64 offen lds
v_mfma_f32_16x16x32_bf16 v[40:43], a[72:75], a[8:11], v[40:43]
ds_read_b64_tr_b16 a[118:119], v9 offset:41984
v_mfma_f32_16x16x32_bf16 v[56:59], a[72:75], a[16:19], v[56:59]
v_mfma_f32_16x16x32_bf16 v[56:59], a[76:79], a[20:23], v[56:59]
s_xor_b32 m0, s84, 3072
v_mfma_f32_16x16x32_bf16 v[72:75], a[76:79], a[28:31], v[72:75]
s_waitcnt vmcnt(13)
s_xor_b32 s64, s72, 147968
ds_read_b128 a[32:35], v2 offset:32768
v_mfma_f32_16x16x32_bf16 v[72:75], a[72:75], a[24:27], v[72:75]
buffer_load_dwordx4 v13, s[48:51], s64 offen lds
v_mfma_f32_16x16x32_bf16 v[136:139], a[80:83], a[24:27], v[136:139]
ds_read_b128 a[36:39], v3 offset:32768
v_mfma_f32_16x16x32_bf16 v[136:139], a[84:87], a[28:31], v[136:139]
ds_read_b128 a[40:43], v2 offset:34816
v_add_u32 v6, 0x8000, v6
v_mfma_f32_16x16x32_bf16 v[120:123], a[84:87], a[20:23], v[120:123]
s_xor_b32 m0, s84, 4096
ds_read_b128 a[44:47], v3 offset:34816
v_mfma_f32_16x16x32_bf16 v[120:123], a[80:83], a[16:19], v[120:123]
s_xor_b32 s64, s73, 512
ds_read_b128 a[48:51], v2 offset:36864
v_mfma_f32_16x16x32_bf16 v[104:107], a[80:83], a[8:11], v[104:107]
buffer_load_dwordx4 v12, s[48:51], s64 offen lds
v_mfma_f32_16x16x32_bf16 v[104:107], a[84:87], a[12:15], v[104:107]
ds_read_b128 a[52:55], v3 offset:36864
v_mfma_f32_16x16x32_bf16 v[88:91], a[84:87], a[4:7], v[88:91]
s_add_u32 s65, s79, 5120
ds_read_b128 a[56:59], v2 offset:38912
v_mfma_f32_16x16x32_bf16 v[88:91], a[80:83], a[0:3], v[88:91]
s_waitcnt lgkmcnt(7)
s_xor_b32 m0, s84, 5120
buffer_store_dwordx4 a[160:163], v16, s[44:47], s65 offen sc1
v_mfma_f32_16x16x32_bf16 v[28:31], a[88:91], a[0:3], v[28:31]
s_xor_b32 s64, s73, 16896
ds_read_b128 a[60:63], v3 offset:38912
v_mfma_f32_16x16x32_bf16 v[28:31], a[92:95], a[4:7], v[28:31]
buffer_load_dwordx4 v13, s[48:51], s64 offen lds
v_mfma_f32_16x16x32_bf16 v[44:47], a[92:95], a[12:15], v[44:47]
ds_read_b64_tr_b16 a[72:73], v10 offset:32768
v_add_u32 v7, 0x8000, v7
v_mfma_f32_16x16x32_bf16 v[44:47], a[88:91], a[8:11], v[44:47]
ds_read_b64_tr_b16 a[74:75], v10 offset:33792
v_mfma_f32_16x16x32_bf16 v[60:63], a[88:91], a[16:19], v[60:63]
s_xor_b32 m0, s84, 6144
ds_read_b64_tr_b16 a[76:77], v10 offset:40960
v_mfma_f32_16x16x32_bf16 v[60:63], a[92:95], a[20:23], v[60:63]
s_xor_b32 s64, s73, 131584
ds_read_b64_tr_b16 a[78:79], v10 offset:41984
v_mfma_f32_16x16x32_bf16 v[76:79], a[92:95], a[28:31], v[76:79]
buffer_load_dwordx4 v12, s[48:51], s64 offen lds
v_mfma_f32_16x16x32_bf16 v[76:79], a[88:91], a[24:27], v[76:79]
ds_read_b64_tr_b16 a[80:81], v11 offset:32768
v_mfma_f32_16x16x32_bf16 v[140:143], a[96:99], a[24:27], v[140:143]
ds_read_b64_tr_b16 a[82:83], v11 offset:33792
v_mfma_f32_16x16x32_bf16 v[140:143], a[100:103], a[28:31], v[140:143]
s_xor_b32 m0, s84, 7168
ds_read_b64_tr_b16 a[84:85], v11 offset:40960
v_add_u32 v8, 0x8000, v8
v_mfma_f32_16x16x32_bf16 v[124:127], a[100:103], a[20:23], v[124:127]
s_xor_b32 s64, s73, 147968
ds_read_b64_tr_b16 a[86:87], v11 offset:41984
v_mfma_f32_16x16x32_bf16 v[124:127], a[96:99], a[16:19], v[124:127]
buffer_load_dwordx4 v13, s[48:51], s64 offen lds
v_mfma_f32_16x16x32_bf16 v[108:111], a[96:99], a[8:11], v[108:111]
v_mfma_f32_16x16x32_bf16 v[108:111], a[100:103], a[12:15], v[108:111]
v_mfma_f32_16x16x32_bf16 v[92:95], a[100:103], a[4:7], v[92:95]
v_add_u32 v9, 0x8000, v9
v_add_u32 v10, 0x8000, v10
v_mfma_f32_16x16x32_bf16 v[92:95], a[96:99], a[0:3], v[92:95]
v_add_u32 v11, 0x8000, v11
v_mfma_f32_16x16x32_bf16 v[32:35], a[104:107], a[0:3], v[32:35]
v_mfma_f32_16x16x32_bf16 v[32:35], a[108:111], a[4:7], v[32:35]
v_mfma_f32_16x16x32_bf16 v[48:51], a[108:111], a[12:15], v[48:51]
s_waitcnt lgkmcnt(0)
s_barrier
v_mfma_f32_16x16x32_bf16 v[48:51], a[104:107], a[8:11], v[48:51]
s_xor_b32 m0, s77, 98304
ds_read_b64_tr_b16 a[88:89], v19 offset:36864
v_mfma_f32_16x16x32_bf16 v[64:67], a[104:107], a[16:19], v[64:67]
s_xor_b32 s64, s71, 2621440
ds_read_b64_tr_b16 a[90:91], v19 offset:37120
v_mfma_f32_16x16x32_bf16 v[64:67], a[108:111], a[20:23], v[64:67]
buffer_load_dwordx4 v14, s[56:59], s64 offen lds
v_mfma_f32_16x16x32_bf16 v[80:83], a[108:111], a[28:31], v[80:83]
ds_read_b64_tr_b16 a[92:93], v19 offset:38912
v_mfma_f32_16x16x32_bf16 v[80:83], a[104:107], a[24:27], v[80:83]
ds_read_b64_tr_b16 a[94:95], v19 offset:39168
v_mfma_f32_16x16x32_bf16 v[144:147], a[112:115], a[24:27], v[144:147]
ds_read_b64_tr_b16 a[96:97], v20 offset:36864
v_mfma_f32_16x16x32_bf16 v[144:147], a[116:119], a[28:31], v[144:147]
ds_read_b64_tr_b16 a[98:99], v20 offset:37120
v_mfma_f32_16x16x32_bf16 v[128:131], a[116:119], a[20:23], v[128:131]
ds_read_b64_tr_b16 a[100:101], v20 offset:38912
v_mfma_f32_16x16x32_bf16 v[128:131], a[112:115], a[16:19], v[128:131]
ds_read_b64_tr_b16 a[102:103], v20 offset:39168
v_mfma_f32_16x16x32_bf16 v[112:115], a[112:115], a[8:11], v[112:115]
s_add_u32 m0, s78, 114688
ds_read_b64_tr_b16 a[104:105], v19 offset:40960
v_mfma_f32_16x16x32_bf16 v[112:115], a[116:119], a[12:15], v[112:115]
s_add_u32 s64, s75, 1966080
ds_read_b64_tr_b16 a[106:107], v19 offset:41216
v_mfma_f32_16x16x32_bf16 v[96:99], a[116:119], a[4:7], v[96:99]
buffer_load_dwordx4 v23, s[60:63], s64 offen lds
v_mfma_f32_16x16x32_bf16 v[96:99], a[112:115], a[0:3], v[96:99]
ds_read_b64_tr_b16 a[108:109], v19 offset:43008
v_mfma_f32_16x16x32_bf16 v[36:39], a[72:75], a[0:3], v[36:39]
ds_read_b64_tr_b16 a[110:111], v19 offset:43264
v_mfma_f32_16x16x32_bf16 v[36:39], a[76:79], a[4:7], v[36:39]
ds_read_b64_tr_b16 a[112:113], v20 offset:40960
v_mfma_f32_16x16x32_bf16 v[52:55], a[76:79], a[12:15], v[52:55]
ds_read_b64_tr_b16 a[114:115], v20 offset:41216
v_mfma_f32_16x16x32_bf16 v[52:55], a[72:75], a[8:11], v[52:55]
ds_read_b64_tr_b16 a[116:117], v20 offset:43008
v_mfma_f32_16x16x32_bf16 v[68:71], a[72:75], a[16:19], v[68:71]
s_xor_b32 m0, s77, 99328
ds_read_b64_tr_b16 a[118:119], v20 offset:43264
v_mfma_f32_16x16x32_bf16 v[68:71], a[76:79], a[20:23], v[68:71]
s_xor_b32 s64, s71, 2654208
s_xor_b32 s68, s66, 8192
v_mfma_f32_16x16x32_bf16 v[84:87], a[76:79], a[28:31], v[84:87]
s_mov_b64 exec, 1
buffer_atomic_add a251, v1, s[52:55], s68 offen offset:0 sc1
s_mov_b64 exec, -1
v_mfma_f32_16x16x32_bf16 v[84:87], a[72:75], a[24:27], v[84:87]
buffer_load_dwordx4 v14, s[56:59], s64 offen lds
v_mfma_f32_16x16x32_bf16 v[148:151], a[80:83], a[24:27], v[148:151]
ds_read_b64_tr_b16 a[72:73], v19 offset:32768
v_mfma_f32_16x16x32_bf16 v[148:151], a[84:87], a[28:31], v[148:151]
ds_read_b64_tr_b16 a[74:75], v19 offset:33024
v_mfma_f32_16x16x32_bf16 v[132:135], a[84:87], a[20:23], v[132:135]
s_add_u32 s65, s79, 1024
ds_read_b64_tr_b16 a[76:77], v19 offset:34816
v_mfma_f32_16x16x32_bf16 v[132:135], a[80:83], a[16:19], v[132:135]
buffer_store_dwordx4 a[164:167], v16, s[44:47], s65 offen sc1
v_mfma_f32_16x16x32_bf16 v[116:119], a[80:83], a[8:11], v[116:119]
ds_read_b64_tr_b16 a[78:79], v19 offset:35072
v_mfma_f32_16x16x32_bf16 v[116:119], a[84:87], a[12:15], v[116:119]
v_mfma_f32_16x16x32_bf16 v[100:103], a[84:87], a[4:7], v[100:103]
s_add_u32 m0, s78, 118784
v_mfma_f32_16x16x32_bf16 v[100:103], a[80:83], a[0:3], v[100:103]
s_waitcnt lgkmcnt(4)
s_add_u32 s64, s75, 1968128
ds_read_b64_tr_b16 a[80:81], v20 offset:32768
v_mfma_f32_16x16x32_bf16 v[184:187], a[88:91], a[32:35], v[184:187]
buffer_load_dwordx4 v23, s[60:63], s64 offen lds
v_mfma_f32_16x16x32_bf16 v[184:187], a[92:95], a[36:39], v[184:187]
ds_read_b64_tr_b16 a[82:83], v20 offset:33024
v_mfma_f32_16x16x32_bf16 v[192:195], a[92:95], a[44:47], v[192:195]
ds_read_b64_tr_b16 a[84:85], v20 offset:34816
v_mfma_f32_16x16x32_bf16 v[192:195], a[88:91], a[40:43], v[192:195]
ds_read_b64_tr_b16 a[86:87], v20 offset:35072
v_mfma_f32_16x16x32_bf16 v[200:203], a[88:91], a[48:51], v[200:203]
v_mfma_f32_16x16x32_bf16 v[200:203], a[92:95], a[52:55], v[200:203]
v_mfma_f32_16x16x32_bf16 v[208:211], a[92:95], a[60:63], v[208:211]
v_mfma_f32_16x16x32_bf16 v[208:211], a[88:91], a[56:59], v[208:211]
ds_read_b64_tr_b16 a[88:89], v4 offset:32768
v_mfma_f32_16x16x32_bf16 v[212:215], a[96:99], a[56:59], v[212:215]
s_xor_b32 m0, s77, 100352
ds_read_b64_tr_b16 a[90:91], v4 offset:33792
v_mfma_f32_16x16x32_bf16 v[212:215], a[100:103], a[60:63], v[212:215]
s_xor_b32 s64, s71, 2686976
ds_read_b64_tr_b16 a[92:93], v4 offset:40960
v_mfma_f32_16x16x32_bf16 v[204:207], a[100:103], a[52:55], v[204:207]
buffer_load_dwordx4 v15, s[56:59], s64 offen lds
v_mfma_f32_16x16x32_bf16 v[204:207], a[96:99], a[48:51], v[204:207]
ds_read_b64_tr_b16 a[94:95], v4 offset:41984
v_mfma_f32_16x16x32_bf16 v[196:199], a[96:99], a[40:43], v[196:199]
v_mfma_f32_16x16x32_bf16 v[196:199], a[100:103], a[44:47], v[196:199]
v_mfma_f32_16x16x32_bf16 v[188:191], a[100:103], a[36:39], v[188:191]
v_mfma_f32_16x16x32_bf16 v[188:191], a[96:99], a[32:35], v[188:191]
ds_read_b64_tr_b16 a[96:97], v5 offset:32768
v_mfma_f32_16x16x32_bf16 v[216:219], a[32:35], a[104:107], v[216:219]
ds_read_b64_tr_b16 a[98:99], v5 offset:33792
v_mfma_f32_16x16x32_bf16 v[216:219], a[36:39], a[108:111], v[216:219]
s_add_u32 m0, s78, 122880
ds_read_b64_tr_b16 a[100:101], v5 offset:40960
v_mfma_f32_16x16x32_bf16 v[224:227], a[44:47], a[108:111], v[224:227]
s_add_u32 s64, s75, 1970176
ds_read_b64_tr_b16 a[102:103], v5 offset:41984
v_mfma_f32_16x16x32_bf16 v[224:227], a[40:43], a[104:107], v[224:227]
buffer_load_dwordx4 v23, s[60:63], s64 offen lds
v_mfma_f32_16x16x32_bf16 v[232:235], a[48:51], a[104:107], v[232:235]
v_mfma_f32_16x16x32_bf16 v[232:235], a[52:55], a[108:111], v[232:235]
v_mfma_f32_16x16x32_bf16 v[240:243], a[60:63], a[108:111], v[240:243]
v_mfma_f32_16x16x32_bf16 v[240:243], a[56:59], a[104:107], v[240:243]
ds_read_b64_tr_b16 a[104:105], v6 offset:32768
v_mfma_f32_16x16x32_bf16 v[244:247], a[56:59], a[112:115], v[244:247]
ds_read_b64_tr_b16 a[106:107], v6 offset:33792
v_mfma_f32_16x16x32_bf16 v[244:247], a[60:63], a[116:119], v[244:247]
ds_read_b64_tr_b16 a[108:109], v6 offset:40960
v_subrev_u32 v19, 0x8000, v19
v_mfma_f32_16x16x32_bf16 v[236:239], a[52:55], a[116:119], v[236:239]
s_xor_b32 m0, s77, 101376
ds_read_b64_tr_b16 a[110:111], v6 offset:41984
v_mfma_f32_16x16x32_bf16 v[236:239], a[48:51], a[112:115], v[236:239]
s_xor_b32 s64, s71, 2719744
v_mfma_f32_16x16x32_bf16 v[228:231], a[40:43], a[112:115], v[228:231]
buffer_load_dwordx4 v15, s[56:59], s64 offen lds
v_mfma_f32_16x16x32_bf16 v[228:231], a[44:47], a[116:119], v[228:231]
v_mfma_f32_16x16x32_bf16 v[220:223], a[36:39], a[116:119], v[220:223]
v_mfma_f32_16x16x32_bf16 v[220:223], a[32:35], a[112:115], v[220:223]
s_waitcnt lgkmcnt(4)
ds_read_b64_tr_b16 a[112:113], v7 offset:32768
v_mfma_f32_16x16x32_bf16 v[152:155], a[72:75], a[32:35], v[152:155]
ds_read_b64_tr_b16 a[114:115], v7 offset:33792
v_mfma_f32_16x16x32_bf16 v[152:155], a[76:79], a[36:39], v[152:155]
ds_read_b64_tr_b16 a[116:117], v7 offset:40960
v_subrev_u32 v20, 0x8000, v20
v_mfma_f32_16x16x32_bf16 v[160:163], a[76:79], a[44:47], v[160:163]
ds_read_b64_tr_b16 a[118:119], v7 offset:41984
v_mfma_f32_16x16x32_bf16 v[160:163], a[72:75], a[40:43], v[160:163]
v_mfma_f32_16x16x32_bf16 v[168:171], a[72:75], a[48:51], v[168:171]
v_mfma_f32_16x16x32_bf16 v[168:171], a[76:79], a[52:55], v[168:171]
v_mfma_f32_16x16x32_bf16 v[176:179], a[76:79], a[60:63], v[176:179]
s_xor_b32 m0, s84, 32768
v_mfma_f32_16x16x32_bf16 v[176:179], a[72:75], a[56:59], v[176:179]
s_xor_b32 s64, s72, 640
ds_read_b64_tr_b16 a[72:73], v8 offset:32768
v_mfma_f32_16x16x32_bf16 v[180:183], a[80:83], a[56:59], v[180:183]
s_add_u32 s65, s79, 18432
buffer_load_dwordx4 v12, s[48:51], s64 offen lds
v_mfma_f32_16x16x32_bf16 v[180:183], a[84:87], a[60:63], v[180:183]
buffer_store_dwordx4 a[168:171], v16, s[44:47], s65 offen sc1
v_mfma_f32_16x16x32_bf16 v[172:175], a[84:87], a[52:55], v[172:175]
ds_read_b64_tr_b16 a[74:75], v8 offset:33792
v_subrev_u32 v4, 0x8000, v4
v_mfma_f32_16x16x32_bf16 v[172:175], a[80:83], a[48:51], v[172:175]
s_xor_b32 m0, s84, 33792
ds_read_b64_tr_b16 a[76:77], v8 offset:40960
v_mfma_f32_16x16x32_bf16 v[164:167], a[80:83], a[40:43], v[164:167]
s_xor_b32 s64, s72, 17024
ds_read_b64_tr_b16 a[78:79], v8 offset:41984
v_mfma_f32_16x16x32_bf16 v[164:167], a[84:87], a[44:47], v[164:167]
buffer_load_dwordx4 v13, s[48:51], s64 offen lds
v_mfma_f32_16x16x32_bf16 v[156:159], a[84:87], a[36:39], v[156:159]
v_mfma_f32_16x16x32_bf16 v[156:159], a[80:83], a[32:35], v[156:159]
ds_read_b64_tr_b16 a[80:81], v9 offset:32768
v_mfma_f32_16x16x32_bf16 v[24:27], a[88:91], a[32:35], v[24:27]
s_xor_b32 m0, s84, 34816
ds_read_b64_tr_b16 a[82:83], v9 offset:33792
v_mfma_f32_16x16x32_bf16 v[24:27], a[92:95], a[36:39], v[24:27]
s_xor_b32 s64, s72, 131712
ds_read_b64_tr_b16 a[84:85], v9 offset:40960
v_subrev_u32 v5, 0x8000, v5
v_mfma_f32_16x16x32_bf16 v[40:43], a[92:95], a[44:47], v[40:43]
buffer_load_dwordx4 v12, s[48:51], s64 offen lds
v_mfma_f32_16x16x32_bf16 v[40:43], a[88:91], a[40:43], v[40:43]
ds_read_b64_tr_b16 a[86:87], v9 offset:41984
v_mfma_f32_16x16x32_bf16 v[56:59], a[88:91], a[48:51], v[56:59]
v_mfma_f32_16x16x32_bf16 v[56:59], a[92:95], a[52:55], v[56:59]
s_xor_b32 m0, s84, 35840
v_mfma_f32_16x16x32_bf16 v[72:75], a[92:95], a[60:63], v[72:75]
s_waitcnt vmcnt(13)
s_xor_b32 s64, s72, 148096
ds_read_b128 a[0:3], v2 offset:0
v_mfma_f32_16x16x32_bf16 v[72:75], a[88:91], a[56:59], v[72:75]
buffer_load_dwordx4 v13, s[48:51], s64 offen lds
v_mfma_f32_16x16x32_bf16 v[136:139], a[96:99], a[56:59], v[136:139]
ds_read_b128 a[4:7], v3 offset:0
v_mfma_f32_16x16x32_bf16 v[136:139], a[100:103], a[60:63], v[136:139]
ds_read_b128 a[8:11], v2 offset:2048
v_subrev_u32 v6, 0x8000, v6
v_mfma_f32_16x16x32_bf16 v[120:123], a[100:103], a[52:55], v[120:123]
s_xor_b32 m0, s84, 36864
ds_read_b128 a[12:15], v3 offset:2048
v_mfma_f32_16x16x32_bf16 v[120:123], a[96:99], a[48:51], v[120:123]
s_xor_b32 s64, s73, 640
ds_read_b128 a[16:19], v2 offset:4096
v_mfma_f32_16x16x32_bf16 v[104:107], a[96:99], a[40:43], v[104:107]
buffer_load_dwordx4 v12, s[48:51], s64 offen lds
v_mfma_f32_16x16x32_bf16 v[104:107], a[100:103], a[44:47], v[104:107]
ds_read_b128 a[20:23], v3 offset:4096
v_mfma_f32_16x16x32_bf16 v[88:91], a[100:103], a[36:39], v[88:91]
ds_read_b128 a[24:27], v2 offset:6144
v_mfma_f32_16x16x32_bf16 v[88:91], a[96:99], a[32:35], v[88:91]
s_waitcnt lgkmcnt(7)
s_xor_b32 m0, s84, 37888
ds_read_b128 a[28:31], v3 offset:6144
v_mfma_f32_16x16x32_bf16 v[28:31], a[104:107], a[32:35], v[28:31]
s_xor_b32 s64, s73, 17024
ds_read_b64_tr_b16 a[88:89], v10 offset:32768
v_mfma_f32_16x16x32_bf16 v[28:31], a[108:111], a[36:39], v[28:31]
buffer_load_dwordx4 v13, s[48:51], s64 offen lds
v_mfma_f32_16x16x32_bf16 v[44:47], a[108:111], a[44:47], v[44:47]
ds_read_b64_tr_b16 a[90:91], v10 offset:33792
v_subrev_u32 v7, 0x8000, v7
v_mfma_f32_16x16x32_bf16 v[44:47], a[104:107], a[40:43], v[44:47]
ds_read_b64_tr_b16 a[92:93], v10 offset:40960
v_mfma_f32_16x16x32_bf16 v[60:63], a[104:107], a[48:51], v[60:63]
s_xor_b32 m0, s84, 38912
ds_read_b64_tr_b16 a[94:95], v10 offset:41984
v_mfma_f32_16x16x32_bf16 v[60:63], a[108:111], a[52:55], v[60:63]
s_xor_b32 s64, s73, 131712
ds_read_b64_tr_b16 a[96:97], v11 offset:32768
v_mfma_f32_16x16x32_bf16 v[76:79], a[108:111], a[60:63], v[76:79]
buffer_load_dwordx4 v12, s[48:51], s64 offen lds
v_mfma_f32_16x16x32_bf16 v[76:79], a[104:107], a[56:59], v[76:79]
ds_read_b64_tr_b16 a[98:99], v11 offset:33792
v_mfma_f32_16x16x32_bf16 v[140:143], a[112:115], a[56:59], v[140:143]
ds_read_b64_tr_b16 a[100:101], v11 offset:40960
v_mfma_f32_16x16x32_bf16 v[140:143], a[116:119], a[60:63], v[140:143]
s_xor_b32 m0, s84, 39936
ds_read_b64_tr_b16 a[102:103], v11 offset:41984
v_subrev_u32 v8, 0x8000, v8
v_mfma_f32_16x16x32_bf16 v[124:127], a[116:119], a[52:55], v[124:127]
s_xor_b32 s64, s73, 148096
v_mfma_f32_16x16x32_bf16 v[124:127], a[112:115], a[48:51], v[124:127]
buffer_load_dwordx4 v13, s[48:51], s64 offen lds
v_mfma_f32_16x16x32_bf16 v[108:111], a[112:115], a[40:43], v[108:111]
v_mfma_f32_16x16x32_bf16 v[108:111], a[116:119], a[44:47], v[108:111]
v_mfma_f32_16x16x32_bf16 v[92:95], a[116:119], a[36:39], v[92:95]
v_subrev_u32 v9, 0x8000, v9
v_subrev_u32 v10, 0x8000, v10
v_mfma_f32_16x16x32_bf16 v[92:95], a[112:115], a[32:35], v[92:95]
v_subrev_u32 v11, 0x8000, v11
v_mfma_f32_16x16x32_bf16 v[32:35], a[72:75], a[32:35], v[32:35]
v_mfma_f32_16x16x32_bf16 v[32:35], a[76:79], a[36:39], v[32:35]
v_mfma_f32_16x16x32_bf16 v[48:51], a[76:79], a[44:47], v[48:51]
s_waitcnt lgkmcnt(0)
s_barrier
v_mfma_f32_16x16x32_bf16 v[48:51], a[72:75], a[40:43], v[48:51]
s_xor_b32 m0, s77, 131072
ds_read_b64_tr_b16 a[104:105], v19 offset:4096
v_mfma_f32_16x16x32_bf16 v[64:67], a[72:75], a[48:51], v[64:67]
s_xor_b32 s64, s71, 3145728
ds_read_b64_tr_b16 a[106:107], v19 offset:4352
v_mfma_f32_16x16x32_bf16 v[64:67], a[76:79], a[52:55], v[64:67]
s_add_u32 s65, s79, 6144
buffer_load_dwordx4 v14, s[56:59], s64 offen lds
v_mfma_f32_16x16x32_bf16 v[80:83], a[76:79], a[60:63], v[80:83]
buffer_store_dwordx4 a[172:175], v16, s[44:47], s65 offen sc1
v_mfma_f32_16x16x32_bf16 v[80:83], a[72:75], a[56:59], v[80:83]
ds_read_b64_tr_b16 a[108:109], v19 offset:6144
v_mfma_f32_16x16x32_bf16 v[144:147], a[80:83], a[56:59], v[144:147]
ds_read_b64_tr_b16 a[110:111], v19 offset:6400
v_mfma_f32_16x16x32_bf16 v[144:147], a[84:87], a[60:63], v[144:147]
ds_read_b64_tr_b16 a[112:113], v20 offset:4096
v_mfma_f32_16x16x32_bf16 v[128:131], a[84:87], a[52:55], v[128:131]
ds_read_b64_tr_b16 a[114:115], v20 offset:4352
v_mfma_f32_16x16x32_bf16 v[128:131], a[80:83], a[48:51], v[128:131]
ds_read_b64_tr_b16 a[116:117], v20 offset:6144
v_mfma_f32_16x16x32_bf16 v[112:115], a[80:83], a[40:43], v[112:115]
s_add_u32 m0, s78, 147456
ds_read_b64_tr_b16 a[118:119], v20 offset:6400
v_mfma_f32_16x16x32_bf16 v[112:115], a[84:87], a[44:47], v[112:115]
s_add_u32 s64, s75, 2359296
ds_read_b64_tr_b16 a[72:73], v19 offset:8192
v_mfma_f32_16x16x32_bf16 v[96:99], a[84:87], a[36:39], v[96:99]
s_branch L_po8
L_pg8:
s_branch L_pg12
L_po8:
buffer_load_dwordx4 v23, s[60:63], s64 offen lds
v_mfma_f32_16x16x32_bf16 v[96:99], a[80:83], a[32:35], v[96:99]
ds_read_b64_tr_b16 a[74:75], v19 offset:8448
v_mfma_f32_16x16x32_bf16 v[36:39], a[88:91], a[32:35], v[36:39]
ds_read_b64_tr_b16 a[76:77], v19 offset:10240
v_mfma_f32_16x16x32_bf16 v[36:39], a[92:95], a[36:39], v[36:39]
ds_read_b64_tr_b16 a[78:79], v19 offset:10496
v_mfma_f32_16x16x32_bf16 v[52:55], a[92:95], a[44:47], v[52:55]
ds_read_b64_tr_b16 a[80:81], v20 offset:8192
v_mfma_f32_16x16x32_bf16 v[52:55], a[88:91], a[40:43], v[52:55]
ds_read_b64_tr_b16 a[82:83], v20 offset:8448
v_mfma_f32_16x16x32_bf16 v[68:71], a[88:91], a[48:51], v[68:71]
s_xor_b32 m0, s77, 132096
ds_read_b64_tr_b16 a[84:85], v20 offset:10240
v_mfma_f32_16x16x32_bf16 v[68:71], a[92:95], a[52:55], v[68:71]
s_xor_b32 s64, s71, 3178496
s_xor_b32 s68, s66, 12288
ds_read_b64_tr_b16 a[86:87], v20 offset:10496
v_mfma_f32_16x16x32_bf16 v[84:87], a[92:95], a[60:63], v[84:87]
s_mov_b64 exec, 1
buffer_atomic_add a251, v1, s[52:55], s68 offen offset:0 sc1
s_mov_b64 exec, -1
v_mfma_f32_16x16x32_bf16 v[84:87], a[88:91], a[56:59], v[84:87]
buffer_load_dwordx4 v14, s[56:59], s64 offen lds
v_mfma_f32_16x16x32_bf16 v[148:151], a[96:99], a[56:59], v[148:151]
ds_read_b64_tr_b16 a[88:89], v19 offset:0
v_mfma_f32_16x16x32_bf16 v[148:151], a[100:103], a[60:63], v[148:151]
ds_read_b64_tr_b16 a[90:91], v19 offset:256
v_mfma_f32_16x16x32_bf16 v[132:135], a[100:103], a[52:55], v[132:135]
ds_read_b64_tr_b16 a[92:93], v19 offset:2048
v_mfma_f32_16x16x32_bf16 v[132:135], a[96:99], a[48:51], v[132:135]
ds_read_b64_tr_b16 a[94:95], v19 offset:2304
v_mfma_f32_16x16x32_bf16 v[116:119], a[96:99], a[40:43], v[116:119]
v_mfma_f32_16x16x32_bf16 v[116:119], a[100:103], a[44:47], v[116:119]
v_mfma_f32_16x16x32_bf16 v[100:103], a[100:103], a[36:39], v[100:103]
s_add_u32 m0, s78, 151552
v_mfma_f32_16x16x32_bf16 v[100:103], a[96:99], a[32:35], v[100:103]
s_waitcnt lgkmcnt(4)
s_add_u32 s64, s75, 2361344
ds_read_b64_tr_b16 a[96:97], v20 offset:0
v_mfma_f32_16x16x32_bf16 v[184:187], a[104:107], a[0:3], v[184:187]
s_mov_b32 s36, s20
buffer_load_dwordx4 v23, s[60:63], s64 offen lds
v_mfma_f32_16x16x32_bf16 v[184:187], a[108:111], a[4:7], v[184:187]
s_mov_b32 s37, s21
ds_read_b64_tr_b16 a[98:99], v20 offset:256
v_mfma_f32_16x16x32_bf16 v[192:195], a[108:111], a[12:15], v[192:195]
s_mov_b32 s38, 2097152
ds_read_b64_tr_b16 a[100:101], v20 offset:2048
v_mfma_f32_16x16x32_bf16 v[192:195], a[104:107], a[8:11], v[192:195]
s_mov_b32 s40, s14
ds_read_b64_tr_b16 a[102:103], v20 offset:2304
v_mfma_f32_16x16x32_bf16 v[200:203], a[104:107], a[16:19], v[200:203]
s_mov_b32 s41, s15
v_mfma_f32_16x16x32_bf16 v[200:203], a[108:111], a[20:23], v[200:203]
s_mov_b32 s42, 8388608
v_mfma_f32_16x16x32_bf16 v[208:211], a[108:111], a[28:31], v[208:211]
v_mfma_f32_16x16x32_bf16 v[208:211], a[104:107], a[24:27], v[208:211]
ds_read_b64_tr_b16 a[104:105], v4 offset:0
v_mfma_f32_16x16x32_bf16 v[212:215], a[112:115], a[24:27], v[212:215]
s_xor_b32 m0, s77, 133120
ds_read_b64_tr_b16 a[106:107], v4 offset:1024
v_mfma_f32_16x16x32_bf16 v[212:215], a[116:119], a[28:31], v[212:215]
s_xor_b32 s64, s71, 3211264
ds_read_b64_tr_b16 a[108:109], v4 offset:8192
v_mfma_f32_16x16x32_bf16 v[204:207], a[116:119], a[20:23], v[204:207]
buffer_load_dwordx4 v15, s[56:59], s64 offen lds
v_mfma_f32_16x16x32_bf16 v[204:207], a[112:115], a[16:19], v[204:207]
ds_read_b64_tr_b16 a[110:111], v4 offset:9216
v_mfma_f32_16x16x32_bf16 v[196:199], a[112:115], a[8:11], v[196:199]
v_mfma_f32_16x16x32_bf16 v[196:199], a[116:119], a[12:15], v[196:199]
v_mfma_f32_16x16x32_bf16 v[188:191], a[116:119], a[4:7], v[188:191]
v_mfma_f32_16x16x32_bf16 v[188:191], a[112:115], a[0:3], v[188:191]
ds_read_b64_tr_b16 a[112:113], v5 offset:0
v_mfma_f32_16x16x32_bf16 v[216:219], a[0:3], a[72:75], v[216:219]
ds_read_b64_tr_b16 a[114:115], v5 offset:1024
v_mfma_f32_16x16x32_bf16 v[216:219], a[4:7], a[76:79], v[216:219]
s_add_u32 m0, s78, 155648
s_add_u32 s65, s79, 2048
ds_read_b64_tr_b16 a[116:117], v5 offset:8192
v_mfma_f32_16x16x32_bf16 v[224:227], a[12:15], a[76:79], v[224:227]
s_add_u32 s64, s75, 2363392
buffer_store_dwordx4 a[176:179], v16, s[44:47], s65 offen sc1
v_mfma_f32_16x16x32_bf16 v[224:227], a[8:11], a[72:75], v[224:227]
buffer_load_dwordx4 v23, s[60:63], s64 offen lds
v_mfma_f32_16x16x32_bf16 v[232:235], a[16:19], a[72:75], v[232:235]
ds_read_b64_tr_b16 a[118:119], v5 offset:9216
v_mfma_f32_16x16x32_bf16 v[232:235], a[20:23], a[76:79], v[232:235]
v_mfma_f32_16x16x32_bf16 v[240:243], a[28:31], a[76:79], v[240:243]
v_mfma_f32_16x16x32_bf16 v[240:243], a[24:27], a[72:75], v[240:243]
ds_read_b64_tr_b16 a[72:73], v6 offset:0
v_mfma_f32_16x16x32_bf16 v[244:247], a[24:27], a[80:83], v[244:247]
ds_read_b64_tr_b16 a[74:75], v6 offset:1024
v_mfma_f32_16x16x32_bf16 v[244:247], a[28:31], a[84:87], v[244:247]
ds_read_b64_tr_b16 a[76:77], v6 offset:8192
v_mfma_f32_16x16x32_bf16 v[236:239], a[20:23], a[84:87], v[236:239]
s_xor_b32 m0, s77, 134144
ds_read_b64_tr_b16 a[78:79], v6 offset:9216
v_mfma_f32_16x16x32_bf16 v[236:239], a[16:19], a[80:83], v[236:239]
s_xor_b32 s64, s71, 3244032
v_mfma_f32_16x16x32_bf16 v[228:231], a[8:11], a[80:83], v[228:231]
buffer_load_dwordx4 v15, s[56:59], s64 offen lds
v_mfma_f32_16x16x32_bf16 v[228:231], a[12:15], a[84:87], v[228:231]
v_mfma_f32_16x16x32_bf16 v[220:223], a[4:7], a[84:87], v[220:223]
v_mfma_f32_16x16x32_bf16 v[220:223], a[0:3], a[80:83], v[220:223]
s_waitcnt lgkmcnt(4)
ds_read_b64_tr_b16 a[80:81], v7 offset:0
v_mfma_f32_16x16x32_bf16 v[152:155], a[88:91], a[0:3], v[152:155]
ds_read_b64_tr_b16 a[82:83], v7 offset:1024
v_mfma_f32_16x16x32_bf16 v[152:155], a[92:95], a[4:7], v[152:155]
ds_read_b64_tr_b16 a[84:85], v7 offset:8192
v_mfma_f32_16x16x32_bf16 v[160:163], a[92:95], a[12:15], v[160:163]
ds_read_b64_tr_b16 a[86:87], v7 offset:9216
v_mfma_f32_16x16x32_bf16 v[160:163], a[88:91], a[8:11], v[160:163]
v_mfma_f32_16x16x32_bf16 v[168:171], a[88:91], a[16:19], v[168:171]
v_mfma_f32_16x16x32_bf16 v[168:171], a[92:95], a[20:23], v[168:171]
v_mfma_f32_16x16x32_bf16 v[176:179], a[92:95], a[28:31], v[176:179]
s_xor_b32 m0, s84, 0
v_mfma_f32_16x16x32_bf16 v[176:179], a[88:91], a[24:27], v[176:179]
s_xor_b32 s64, s72, 768
ds_read_b64_tr_b16 a[88:89], v8 offset:0
v_mfma_f32_16x16x32_bf16 v[180:183], a[96:99], a[24:27], v[180:183]
buffer_load_dwordx4 v12, s[48:51], s64 offen lds
v_mfma_f32_16x16x32_bf16 v[180:183], a[100:103], a[28:31], v[180:183]
ds_read_b64_tr_b16 a[90:91], v8 offset:1024
v_mfma_f32_16x16x32_bf16 v[172:175], a[100:103], a[20:23], v[172:175]
ds_read_b64_tr_b16 a[92:93], v8 offset:8192
v_mfma_f32_16x16x32_bf16 v[172:175], a[96:99], a[16:19], v[172:175]
s_xor_b32 m0, s84, 1024
ds_read_b64_tr_b16 a[94:95], v8 offset:9216
v_mfma_f32_16x16x32_bf16 v[164:167], a[96:99], a[8:11], v[164:167]
s_xor_b32 s64, s72, 17152
v_mfma_f32_16x16x32_bf16 v[164:167], a[100:103], a[12:15], v[164:167]
buffer_load_dwordx4 v13, s[48:51], s64 offen lds
v_mfma_f32_16x16x32_bf16 v[156:159], a[100:103], a[4:7], v[156:159]
v_mfma_f32_16x16x32_bf16 v[156:159], a[96:99], a[0:3], v[156:159]
ds_read_b64_tr_b16 a[96:97], v9 offset:0
v_mfma_f32_16x16x32_bf16 v[24:27], a[104:107], a[0:3], v[24:27]
s_xor_b32 m0, s84, 2048
ds_read_b64_tr_b16 a[98:99], v9 offset:1024
v_mfma_f32_16x16x32_bf16 v[24:27], a[108:111], a[4:7], v[24:27]
s_xor_b32 s64, s72, 131840
ds_read_b64_tr_b16 a[100:101], v9 offset:8192
v_mfma_f32_16x16x32_bf16 v[40:43], a[108:111], a[12:15], v[40:43]
buffer_load_dwordx4 v12, s[48:51], s64 offen lds
v_mfma_f32_16x16x32_bf16 v[40:43], a[104:107], a[8:11], v[40:43]
ds_read_b64_tr_b16 a[102:103], v9 offset:9216
v_mfma_f32_16x16x32_bf16 v[56:59], a[104:107], a[16:19], v[56:59]
v_mfma_f32_16x16x32_bf16 v[56:59], a[108:111], a[20:23], v[56:59]
s_xor_b32 m0, s84, 3072
v_mfma_f32_16x16x32_bf16 v[72:75], a[108:111], a[28:31], v[72:75]
s_waitcnt vmcnt(13)
s_xor_b32 s64, s72, 148224
ds_read_b128 a[32:35], v2 offset:32768
v_mfma_f32_16x16x32_bf16 v[72:75], a[104:107], a[24:27], v[72:75]
buffer_load_dwordx4 v13, s[48:51], s64 offen lds
v_mfma_f32_16x16x32_bf16 v[136:139], a[112:115], a[24:27], v[136:139]
ds_read_b128 a[36:39], v3 offset:32768
v_mfma_f32_16x16x32_bf16 v[136:139], a[116:119], a[28:31], v[136:139]
ds_read_b128 a[40:43], v2 offset:34816
v_mfma_f32_16x16x32_bf16 v[120:123], a[116:119], a[20:23], v[120:123]
s_xor_b32 m0, s84, 4096
ds_read_b128 a[44:47], v3 offset:34816
v_mfma_f32_16x16x32_bf16 v[120:123], a[112:115], a[16:19], v[120:123]
s_xor_b32 s64, s73, 768
ds_read_b128 a[48:51], v2 offset:36864
v_mfma_f32_16x16x32_bf16 v[104:107], a[112:115], a[8:11], v[104:107]
buffer_load_dwordx4 v12, s[48:51], s64 offen lds
v_mfma_f32_16x16x32_bf16 v[104:107], a[116:119], a[12:15], v[104:107]
s_add_u32 s65, s79, 19456
ds_read_b128 a[52:55], v3 offset:36864
v_mfma_f32_16x16x32_bf16 v[88:91], a[116:119], a[4:7], v[88:91]
buffer_store_dwordx4 a[180:183], v16, s[44:47], s65 offen sc1
v_mfma_f32_16x16x32_bf16 v[88:91], a[112:115], a[0:3], v[88:91]
s_waitcnt lgkmcnt(6)
s_xor_b32 m0, s84, 5120
ds_read_b128 a[56:59], v2 offset:38912
v_mfma_f32_16x16x32_bf16 v[28:31], a[72:75], a[0:3], v[28:31]
s_xor_b32 s64, s73, 17152
ds_read_b128 a[60:63], v3 offset:38912
v_mfma_f32_16x16x32_bf16 v[28:31], a[76:79], a[4:7], v[28:31]
buffer_load_dwordx4 v13, s[48:51], s64 offen lds
v_mfma_f32_16x16x32_bf16 v[44:47], a[76:79], a[12:15], v[44:47]
ds_read_b64_tr_b16 a[104:105], v10 offset:0
v_mfma_f32_16x16x32_bf16 v[44:47], a[72:75], a[8:11], v[44:47]
ds_read_b64_tr_b16 a[106:107], v10 offset:1024
v_mfma_f32_16x16x32_bf16 v[60:63], a[72:75], a[16:19], v[60:63]
s_xor_b32 m0, s84, 6144
ds_read_b64_tr_b16 a[108:109], v10 offset:8192
v_mfma_f32_16x16x32_bf16 v[60:63], a[76:79], a[20:23], v[60:63]
s_xor_b32 s64, s73, 131840
ds_read_b64_tr_b16 a[110:111], v10 offset:9216
v_mfma_f32_16x16x32_bf16 v[76:79], a[76:79], a[28:31], v[76:79]
buffer_load_dwordx4 v12, s[48:51], s64 offen lds
v_mfma_f32_16x16x32_bf16 v[76:79], a[72:75], a[24:27], v[76:79]
ds_read_b64_tr_b16 a[112:113], v11 offset:0
v_mfma_f32_16x16x32_bf16 v[140:143], a[80:83], a[24:27], v[140:143]
ds_read_b64_tr_b16 a[114:115], v11 offset:1024
v_mfma_f32_16x16x32_bf16 v[140:143], a[84:87], a[28:31], v[140:143]
s_xor_b32 m0, s84, 7168
ds_read_b64_tr_b16 a[116:117], v11 offset:8192
v_mfma_f32_16x16x32_bf16 v[124:127], a[84:87], a[20:23], v[124:127]
s_xor_b32 s64, s73, 148224
ds_read_b64_tr_b16 a[118:119], v11 offset:9216
v_mfma_f32_16x16x32_bf16 v[124:127], a[80:83], a[16:19], v[124:127]
buffer_load_dwordx4 v13, s[48:51], s64 offen lds
v_mfma_f32_16x16x32_bf16 v[108:111], a[80:83], a[8:11], v[108:111]
v_mfma_f32_16x16x32_bf16 v[108:111], a[84:87], a[12:15], v[108:111]
v_mfma_f32_16x16x32_bf16 v[92:95], a[84:87], a[4:7], v[92:95]
v_mfma_f32_16x16x32_bf16 v[92:95], a[80:83], a[0:3], v[92:95]
v_mfma_f32_16x16x32_bf16 v[32:35], a[88:91], a[0:3], v[32:35]
v_mfma_f32_16x16x32_bf16 v[32:35], a[92:95], a[4:7], v[32:35]
v_mfma_f32_16x16x32_bf16 v[48:51], a[92:95], a[12:15], v[48:51]
s_waitcnt lgkmcnt(0)
s_barrier
v_mfma_f32_16x16x32_bf16 v[48:51], a[88:91], a[8:11], v[48:51]
s_xor_b32 m0, s77, 65536
ds_read_b64_tr_b16 a[72:73], v19 offset:36864
v_mfma_f32_16x16x32_bf16 v[64:67], a[88:91], a[16:19], v[64:67]
s_xor_b32 s64, s71, 3670016
ds_read_b64_tr_b16 a[74:75], v19 offset:37120
v_mfma_f32_16x16x32_bf16 v[64:67], a[92:95], a[20:23], v[64:67]
buffer_load_dwordx4 v14, s[56:59], s64 offen lds
v_mfma_f32_16x16x32_bf16 v[80:83], a[92:95], a[28:31], v[80:83]
ds_read_b64_tr_b16 a[76:77], v19 offset:38912
v_mfma_f32_16x16x32_bf16 v[80:83], a[88:91], a[24:27], v[80:83]
ds_read_b64_tr_b16 a[78:79], v19 offset:39168
v_mfma_f32_16x16x32_bf16 v[144:147], a[96:99], a[24:27], v[144:147]
ds_read_b64_tr_b16 a[80:81], v20 offset:36864
v_mfma_f32_16x16x32_bf16 v[144:147], a[100:103], a[28:31], v[144:147]
ds_read_b64_tr_b16 a[82:83], v20 offset:37120
v_mfma_f32_16x16x32_bf16 v[128:131], a[100:103], a[20:23], v[128:131]
ds_read_b64_tr_b16 a[84:85], v20 offset:38912
v_mfma_f32_16x16x32_bf16 v[128:131], a[96:99], a[16:19], v[128:131]
ds_read_b64_tr_b16 a[86:87], v20 offset:39168
v_mfma_f32_16x16x32_bf16 v[112:115], a[96:99], a[8:11], v[112:115]
s_add_u32 m0, s78, 81920
ds_read_b64_tr_b16 a[88:89], v19 offset:40960
v_mfma_f32_16x16x32_bf16 v[112:115], a[100:103], a[12:15], v[112:115]
s_add_u32 s64, s75, 2752512
ds_read_b64_tr_b16 a[90:91], v19 offset:41216
v_mfma_f32_16x16x32_bf16 v[96:99], a[100:103], a[4:7], v[96:99]
buffer_load_dwordx4 v23, s[60:63], s64 offen lds
v_mfma_f32_16x16x32_bf16 v[96:99], a[96:99], a[0:3], v[96:99]
ds_read_b64_tr_b16 a[92:93], v19 offset:43008
v_mfma_f32_16x16x32_bf16 v[36:39], a[104:107], a[0:3], v[36:39]
ds_read_b64_tr_b16 a[94:95], v19 offset:43264
v_mfma_f32_16x16x32_bf16 v[36:39], a[108:111], a[4:7], v[36:39]
ds_read_b64_tr_b16 a[96:97], v20 offset:40960
v_mfma_f32_16x16x32_bf16 v[52:55], a[108:111], a[12:15], v[52:55]
ds_read_b64_tr_b16 a[98:99], v20 offset:41216
v_mfma_f32_16x16x32_bf16 v[52:55], a[104:107], a[8:11], v[52:55]
ds_read_b64_tr_b16 a[100:101], v20 offset:43008
v_mfma_f32_16x16x32_bf16 v[68:71], a[104:107], a[16:19], v[68:71]
ds_read_b64_tr_b16 a[102:103], v20 offset:43264
v_mfma_f32_16x16x32_bf16 v[68:71], a[108:111], a[20:23], v[68:71]
s_xor_b32 m0, s77, 66560
v_mfma_f32_16x16x32_bf16 v[84:87], a[108:111], a[28:31], v[84:87]
s_xor_b32 s64, s71, 3702784
v_mfma_f32_16x16x32_bf16 v[84:87], a[104:107], a[24:27], v[84:87]
buffer_load_dwordx4 v14, s[56:59], s64 offen lds
v_mfma_f32_16x16x32_bf16 v[148:151], a[112:115], a[24:27], v[148:151]
ds_read_b64_tr_b16 a[104:105], v19 offset:32768
v_mfma_f32_16x16x32_bf16 v[148:151], a[116:119], a[28:31], v[148:151]
ds_read_b64_tr_b16 a[106:107], v19 offset:33024
v_mfma_f32_16x16x32_bf16 v[132:135], a[116:119], a[20:23], v[132:135]
s_add_u32 s65, s79, 7168
ds_read_b64_tr_b16 a[108:109], v19 offset:34816
v_mfma_f32_16x16x32_bf16 v[132:135], a[112:115], a[16:19], v[132:135]
buffer_store_dwordx4 a[184:187], v16, s[44:47], s65 offen sc1
v_mfma_f32_16x16x32_bf16 v[116:119], a[112:115], a[8:11], v[116:119]
ds_read_b64_tr_b16 a[110:111], v19 offset:35072
v_mfma_f32_16x16x32_bf16 v[116:119], a[116:119], a[12:15], v[116:119]
v_mfma_f32_16x16x32_bf16 v[100:103], a[116:119], a[4:7], v[100:103]
s_add_u32 m0, s78, 86016
v_mfma_f32_16x16x32_bf16 v[100:103], a[112:115], a[0:3], v[100:103]
s_waitcnt lgkmcnt(4)
s_add_u32 s64, s75, 2754560
ds_read_b64_tr_b16 a[112:113], v20 offset:32768
v_mfma_f32_16x16x32_bf16 v[184:187], a[72:75], a[32:35], v[184:187]
buffer_load_dwordx4 v23, s[60:63], s64 offen lds
v_mfma_f32_16x16x32_bf16 v[184:187], a[76:79], a[36:39], v[184:187]
ds_read_b64_tr_b16 a[114:115], v20 offset:33024
v_and_b32 v22, 15, v0
v_mfma_f32_16x16x32_bf16 v[192:195], a[76:79], a[44:47], v[192:195]
ds_read_b64_tr_b16 a[116:117], v20 offset:34816
v_lshrrev_b32 v17, 4, v0
v_mfma_f32_16x16x32_bf16 v[192:195], a[72:75], a[40:43], v[192:195]
ds_read_b64_tr_b16 a[118:119], v20 offset:35072
v_lshlrev_b32 v17, 2, v17
v_mfma_f32_16x16x32_bf16 v[200:203], a[72:75], a[48:51], v[200:203]
v_sub_u32 v22, v22, v17
v_subrev_u32 v17, 0, v22
v_mfma_f32_16x16x32_bf16 v[200:203], a[76:79], a[52:55], v[200:203]
v_lshlrev_b32 v18, 31, v17
v_or_b32 v21, v17, v18
v_mfma_f32_16x16x32_bf16 v[208:211], a[76:79], a[60:63], v[208:211]
v_ashrrev_i32 v21, 31, v21
v_and_b32 v248, 0xff800000, v21
v_mfma_f32_16x16x32_bf16 v[208:211], a[72:75], a[56:59], v[208:211]
ds_read_b64_tr_b16 a[72:73], v4 offset:32768
v_not_b32 v17, v17
v_mfma_f32_16x16x32_bf16 v[212:215], a[80:83], a[56:59], v[212:215]
s_xor_b32 m0, s77, 67584
ds_read_b64_tr_b16 a[74:75], v4 offset:33792
v_or_b32 v21, v17, v18
v_mfma_f32_16x16x32_bf16 v[212:215], a[84:87], a[60:63], v[212:215]
s_xor_b32 s64, s71, 3735552
ds_read_b64_tr_b16 a[76:77], v4 offset:40960
v_ashrrev_i32 v21, 31, v21
v_mfma_f32_16x16x32_bf16 v[204:207], a[84:87], a[52:55], v[204:207]
buffer_load_dwordx4 v15, s[56:59], s64 offen lds
v_mfma_f32_16x16x32_bf16 v[204:207], a[80:83], a[48:51], v[204:207]
ds_read_b64_tr_b16 a[78:79], v4 offset:41984
v_and_b32 v252, 0xff800000, v21
v_mfma_f32_16x16x32_bf16 v[196:199], a[80:83], a[40:43], v[196:199]
v_subrev_u32 v17, 1, v22
v_lshlrev_b32 v18, 31, v17
v_mfma_f32_16x16x32_bf16 v[196:199], a[84:87], a[44:47], v[196:199]
v_or_b32 v21, v17, v18
v_ashrrev_i32 v21, 31, v21
v_mfma_f32_16x16x32_bf16 v[188:191], a[84:87], a[36:39], v[188:191]
v_and_b32 v249, 0xff800000, v21
v_not_b32 v17, v17
v_mfma_f32_16x16x32_bf16 v[188:191], a[80:83], a[32:35], v[188:191]
ds_read_b64_tr_b16 a[80:81], v5 offset:32768
v_or_b32 v21, v17, v18
v_mfma_f32_16x16x32_bf16 v[216:219], a[32:35], a[88:91], v[216:219]
ds_read_b64_tr_b16 a[82:83], v5 offset:33792
v_ashrrev_i32 v21, 31, v21
v_mfma_f32_16x16x32_bf16 v[216:219], a[36:39], a[92:95], v[216:219]
s_add_u32 m0, s78, 90112
ds_read_b64_tr_b16 a[84:85], v5 offset:40960
v_and_b32 v253, 0xff800000, v21
v_mfma_f32_16x16x32_bf16 v[224:227], a[44:47], a[92:95], v[224:227]
s_add_u32 s64, s75, 2756608
ds_read_b64_tr_b16 a[86:87], v5 offset:41984
v_subrev_u32 v17, 2, v22
v_mfma_f32_16x16x32_bf16 v[224:227], a[40:43], a[88:91], v[224:227]
buffer_load_dwordx4 v23, s[60:63], s64 offen lds
v_mfma_f32_16x16x32_bf16 v[232:235], a[48:51], a[88:91], v[232:235]
v_lshlrev_b32 v18, 31, v17
v_or_b32 v21, v17, v18
v_mfma_f32_16x16x32_bf16 v[232:235], a[52:55], a[92:95], v[232:235]
v_ashrrev_i32 v21, 31, v21
v_and_b32 v250, 0xff800000, v21
v_mfma_f32_16x16x32_bf16 v[240:243], a[60:63], a[92:95], v[240:243]
v_not_b32 v17, v17
v_or_b32 v21, v17, v18
v_mfma_f32_16x16x32_bf16 v[240:243], a[56:59], a[88:91], v[240:243]
ds_read_b64_tr_b16 a[88:89], v6 offset:32768
v_ashrrev_i32 v21, 31, v21
v_mfma_f32_16x16x32_bf16 v[244:247], a[56:59], a[96:99], v[244:247]
ds_read_b64_tr_b16 a[90:91], v6 offset:33792
v_and_b32 v254, 0xff800000, v21
v_mfma_f32_16x16x32_bf16 v[244:247], a[60:63], a[100:103], v[244:247]
ds_read_b64_tr_b16 a[92:93], v6 offset:40960
v_add_u32 v19, 0x8000, v19
v_mfma_f32_16x16x32_bf16 v[236:239], a[52:55], a[100:103], v[236:239]
s_xor_b32 m0, s77, 68608
ds_read_b64_tr_b16 a[94:95], v6 offset:41984
v_subrev_u32 v17, 3, v22
v_mfma_f32_16x16x32_bf16 v[236:239], a[48:51], a[96:99], v[236:239]
s_xor_b32 s64, s71, 3768320
v_lshlrev_b32 v18, 31, v17
v_or_b32 v21, v17, v18
v_mfma_f32_16x16x32_bf16 v[228:231], a[40:43], a[96:99], v[228:231]
buffer_load_dwordx4 v15, s[56:59], s64 offen lds
v_mfma_f32_16x16x32_bf16 v[228:231], a[44:47], a[100:103], v[228:231]
v_ashrrev_i32 v21, 31, v21
v_and_b32 v251, 0xff800000, v21
v_mfma_f32_16x16x32_bf16 v[220:223], a[36:39], a[100:103], v[220:223]
v_not_b32 v17, v17
v_or_b32 v21, v17, v18
v_mfma_f32_16x16x32_bf16 v[220:223], a[32:35], a[96:99], v[220:223]
s_waitcnt lgkmcnt(4)
ds_read_b64_tr_b16 a[96:97], v7 offset:32768
v_ashrrev_i32 v21, 31, v21
v_mfma_f32_16x16x32_bf16 v[152:155], a[104:107], a[32:35], v[152:155]
ds_read_b64_tr_b16 a[98:99], v7 offset:33792
v_and_b32 v255, 0xff800000, v21
v_mfma_f32_16x16x32_bf16 v[152:155], a[108:111], a[36:39], v[152:155]
s_lshl_b32 s69, s30, 4
ds_read_b64_tr_b16 a[100:101], v7 offset:40960
v_add_u32 v20, 0x8000, v20
v_mfma_f32_16x16x32_bf16 v[160:163], a[108:111], a[44:47], v[160:163]
ds_read_b64_tr_b16 a[102:103], v7 offset:41984
v_add_u32 v18, s69, v22
v_mfma_f32_16x16x32_bf16 v[160:163], a[104:107], a[40:43], v[160:163]
s_lshr_b32 s69, s30, 1
v_mfma_f32_16x16x32_bf16 v[168:171], a[104:107], a[48:51], v[168:171]
s_mul_i32 s69, s69, 18432
v_mfma_f32_16x16x32_bf16 v[168:171], a[108:111], a[52:55], v[168:171]
s_add_u32 s69, s69, s78
v_mfma_f32_16x16x32_bf16 v[176:179], a[108:111], a[60:63], v[176:179]
s_add_u32 s69, s69, 32768
s_xor_b32 m0, s84, 32768
v_mfma_f32_16x16x32_bf16 v[176:179], a[104:107], a[56:59], v[176:179]
s_xor_b32 s64, s72, 896
ds_read_b64_tr_b16 a[104:105], v8 offset:32768
v_add_u32 v17, s69, v16
v_mfma_f32_16x16x32_bf16 v[180:183], a[112:115], a[56:59], v[180:183]
s_add_u32 s65, s79, 3072
buffer_load_dwordx4 v12, s[48:51], s64 offen lds
v_mfma_f32_16x16x32_bf16 v[180:183], a[116:119], a[60:63], v[180:183]
buffer_store_dwordx4 a[188:191], v16, s[44:47], s65 offen sc1
v_mfma_f32_16x16x32_bf16 v[172:175], a[116:119], a[52:55], v[172:175]
ds_read_b64_tr_b16 a[106:107], v8 offset:33792
v_add_u32 v4, 0x8000, v4
v_mfma_f32_16x16x32_bf16 v[172:175], a[112:115], a[48:51], v[172:175]
s_xor_b32 m0, s84, 33792
ds_read_b64_tr_b16 a[108:109], v8 offset:40960
v_lshlrev_b32 v21, 5, v0
v_mfma_f32_16x16x32_bf16 v[164:167], a[112:115], a[40:43], v[164:167]
s_xor_b32 s64, s72, 17280
ds_read_b64_tr_b16 a[110:111], v8 offset:41984
v_mfma_f32_16x16x32_bf16 v[164:167], a[116:119], a[44:47], v[164:167]
buffer_load_dwordx4 v13, s[48:51], s64 offen lds
v_mfma_f32_16x16x32_bf16 v[156:159], a[116:119], a[36:39], v[156:159]
v_mfma_f32_16x16x32_bf16 v[156:159], a[112:115], a[32:35], v[156:159]
ds_read_b64_tr_b16 a[112:113], v9 offset:32768
v_mfma_f32_16x16x32_bf16 v[24:27], a[72:75], a[32:35], v[24:27]
s_xor_b32 m0, s84, 34816
ds_read_b64_tr_b16 a[114:115], v9 offset:33792
v_mfma_f32_16x16x32_bf16 v[24:27], a[76:79], a[36:39], v[24:27]
s_xor_b32 s64, s72, 131968
ds_read_b64_tr_b16 a[116:117], v9 offset:40960
v_add_u32 v5, 0x8000, v5
v_mfma_f32_16x16x32_bf16 v[40:43], a[76:79], a[44:47], v[40:43]
buffer_load_dwordx4 v12, s[48:51], s64 offen lds
v_mfma_f32_16x16x32_bf16 v[40:43], a[72:75], a[40:43], v[40:43]
ds_read_b64_tr_b16 a[118:119], v9 offset:41984
v_mfma_f32_16x16x32_bf16 v[56:59], a[72:75], a[48:51], v[56:59]
v_mfma_f32_16x16x32_bf16 v[56:59], a[76:79], a[52:55], v[56:59]
s_xor_b32 m0, s84, 35840
v_mfma_f32_16x16x32_bf16 v[72:75], a[76:79], a[60:63], v[72:75]
s_waitcnt vmcnt(12)
s_xor_b32 s64, s72, 148352
ds_read_b128 a[0:3], v2 offset:0
v_mfma_f32_16x16x32_bf16 v[72:75], a[72:75], a[56:59], v[72:75]
buffer_load_dwordx4 v13, s[48:51], s64 offen lds
v_mfma_f32_16x16x32_bf16 v[136:139], a[80:83], a[56:59], v[136:139]
ds_read_b128 a[4:7], v3 offset:0
v_mfma_f32_16x16x32_bf16 v[136:139], a[84:87], a[60:63], v[136:139]
ds_read_b128 a[8:11], v2 offset:2048
v_add_u32 v6, 0x8000, v6
v_mfma_f32_16x16x32_bf16 v[120:123], a[84:87], a[52:55], v[120:123]
s_xor_b32 m0, s84, 36864
ds_read_b128 a[12:15], v3 offset:2048
v_mfma_f32_16x16x32_bf16 v[120:123], a[80:83], a[48:51], v[120:123]
s_xor_b32 s64, s73, 896
ds_read_b128 a[16:19], v2 offset:4096
v_mfma_f32_16x16x32_bf16 v[104:107], a[80:83], a[40:43], v[104:107]
buffer_load_dwordx4 v12, s[48:51], s64 offen lds
v_mfma_f32_16x16x32_bf16 v[104:107], a[84:87], a[44:47], v[104:107]
ds_read_b128 a[20:23], v3 offset:4096
v_mfma_f32_16x16x32_bf16 v[88:91], a[84:87], a[36:39], v[88:91]
ds_read_b128 a[24:27], v2 offset:6144
v_mfma_f32_16x16x32_bf16 v[88:91], a[80:83], a[32:35], v[88:91]
s_waitcnt lgkmcnt(7)
s_xor_b32 m0, s84, 37888
ds_read_b128 a[28:31], v3 offset:6144
v_mfma_f32_16x16x32_bf16 v[28:31], a[88:91], a[32:35], v[28:31]
s_xor_b32 s64, s73, 17280
ds_read_b64_tr_b16 a[72:73], v10 offset:32768
v_mfma_f32_16x16x32_bf16 v[28:31], a[92:95], a[36:39], v[28:31]
buffer_load_dwordx4 v13, s[48:51], s64 offen lds
v_mfma_f32_16x16x32_bf16 v[44:47], a[92:95], a[44:47], v[44:47]
ds_read_b64_tr_b16 a[74:75], v10 offset:33792
v_add_u32 v7, 0x8000, v7
v_mfma_f32_16x16x32_bf16 v[44:47], a[88:91], a[40:43], v[44:47]
ds_read_b64_tr_b16 a[76:77], v10 offset:40960
v_mfma_f32_16x16x32_bf16 v[60:63], a[88:91], a[48:51], v[60:63]
s_xor_b32 m0, s84, 38912
ds_read_b64_tr_b16 a[78:79], v10 offset:41984
v_mfma_f32_16x16x32_bf16 v[60:63], a[92:95], a[52:55], v[60:63]
s_xor_b32 s64, s73, 131968
ds_read_b64_tr_b16 a[80:81], v11 offset:32768
v_mfma_f32_16x16x32_bf16 v[76:79], a[92:95], a[60:63], v[76:79]
buffer_load_dwordx4 v12, s[48:51], s64 offen lds
v_mfma_f32_16x16x32_bf16 v[76:79], a[88:91], a[56:59], v[76:79]
ds_read_b64_tr_b16 a[82:83], v11 offset:33792
v_mfma_f32_16x16x32_bf16 v[140:143], a[96:99], a[56:59], v[140:143]
ds_read_b64_tr_b16 a[84:85], v11 offset:40960
v_mfma_f32_16x16x32_bf16 v[140:143], a[100:103], a[60:63], v[140:143]
s_xor_b32 m0, s84, 39936
ds_read_b64_tr_b16 a[86:87], v11 offset:41984
v_add_u32 v8, 0x8000, v8
v_mfma_f32_16x16x32_bf16 v[124:127], a[100:103], a[52:55], v[124:127]
s_xor_b32 s64, s73, 148352
v_mfma_f32_16x16x32_bf16 v[124:127], a[96:99], a[48:51], v[124:127]
buffer_load_dwordx4 v13, s[48:51], s64 offen lds
v_mfma_f32_16x16x32_bf16 v[108:111], a[96:99], a[40:43], v[108:111]
v_mfma_f32_16x16x32_bf16 v[108:111], a[100:103], a[44:47], v[108:111]
v_mfma_f32_16x16x32_bf16 v[92:95], a[100:103], a[36:39], v[92:95]
v_add_u32 v9, 0x8000, v9
v_add_u32 v10, 0x8000, v10
v_mfma_f32_16x16x32_bf16 v[92:95], a[96:99], a[32:35], v[92:95]
v_add_u32 v11, 0x8000, v11
v_mfma_f32_16x16x32_bf16 v[32:35], a[104:107], a[32:35], v[32:35]
v_mfma_f32_16x16x32_bf16 v[32:35], a[108:111], a[36:39], v[32:35]
v_mfma_f32_16x16x32_bf16 v[48:51], a[108:111], a[44:47], v[48:51]
s_waitcnt lgkmcnt(0)
s_barrier
v_mfma_f32_16x16x32_bf16 v[48:51], a[104:107], a[40:43], v[48:51]
s_xor_b32 m0, s77, 98304
ds_read_b64_tr_b16 a[88:89], v19 offset:36864
v_mfma_f32_16x16x32_bf16 v[64:67], a[104:107], a[48:51], v[64:67]
s_xor_b32 s64, s71, 4194304
ds_read_b64_tr_b16 a[90:91], v19 offset:37120
v_mfma_f32_16x16x32_bf16 v[64:67], a[108:111], a[52:55], v[64:67]
s_add_u32 s65, s79, 24576
buffer_load_dwordx4 v14, s[56:59], s64 offen lds
v_mfma_f32_16x16x32_bf16 v[80:83], a[108:111], a[60:63], v[80:83]
buffer_store_dwordx4 a[192:195], v16, s[44:47], s65 offen sc1
v_mfma_f32_16x16x32_bf16 v[80:83], a[104:107], a[56:59], v[80:83]
ds_read_b64_tr_b16 a[92:93], v19 offset:38912
v_mfma_f32_16x16x32_bf16 v[144:147], a[112:115], a[56:59], v[144:147]
ds_read_b64_tr_b16 a[94:95], v19 offset:39168
v_mfma_f32_16x16x32_bf16 v[144:147], a[116:119], a[60:63], v[144:147]
ds_read_b64_tr_b16 a[96:97], v20 offset:36864
v_mfma_f32_16x16x32_bf16 v[128:131], a[116:119], a[52:55], v[128:131]
ds_read_b64_tr_b16 a[98:99], v20 offset:37120
v_mfma_f32_16x16x32_bf16 v[128:131], a[112:115], a[48:51], v[128:131]
ds_read_b64_tr_b16 a[100:101], v20 offset:38912
v_mfma_f32_16x16x32_bf16 v[112:115], a[112:115], a[40:43], v[112:115]
s_add_u32 m0, s78, 114688
ds_read_b64_tr_b16 a[102:103], v20 offset:39168
v_mfma_f32_16x16x32_bf16 v[112:115], a[116:119], a[44:47], v[112:115]
s_add_u32 s64, s75, 3145728
ds_read_b64_tr_b16 a[104:105], v19 offset:40960
v_mfma_f32_16x16x32_bf16 v[96:99], a[116:119], a[36:39], v[96:99]
buffer_load_dwordx4 v23, s[60:63], s64 offen lds
v_mfma_f32_16x16x32_bf16 v[96:99], a[112:115], a[32:35], v[96:99]
ds_read_b64_tr_b16 a[106:107], v19 offset:41216
v_mfma_f32_16x16x32_bf16 v[36:39], a[72:75], a[32:35], v[36:39]
ds_read_b64_tr_b16 a[108:109], v19 offset:43008
v_mfma_f32_16x16x32_bf16 v[36:39], a[76:79], a[36:39], v[36:39]
s_branch L_po9
L_pg9:
s_branch L_pg13
L_po9:
ds_read_b64_tr_b16 a[110:111], v19 offset:43264
v_mfma_f32_16x16x32_bf16 v[52:55], a[76:79], a[44:47], v[52:55]
ds_read_b64_tr_b16 a[112:113], v20 offset:40960
v_mfma_f32_16x16x32_bf16 v[52:55], a[72:75], a[40:43], v[52:55]
ds_read_b64_tr_b16 a[114:115], v20 offset:41216
v_mfma_f32_16x16x32_bf16 v[68:71], a[72:75], a[48:51], v[68:71]
ds_read_b64_tr_b16 a[116:117], v20 offset:43008
v_mfma_f32_16x16x32_bf16 v[68:71], a[76:79], a[52:55], v[68:71]
s_xor_b32 m0, s77, 99328
ds_read_b64_tr_b16 a[118:119], v20 offset:43264
v_mfma_f32_16x16x32_bf16 v[84:87], a[76:79], a[60:63], v[84:87]
s_xor_b32 s64, s71, 4227072
v_mfma_f32_16x16x32_bf16 v[84:87], a[72:75], a[56:59], v[84:87]
buffer_load_dwordx4 v14, s[56:59], s64 offen lds
v_mfma_f32_16x16x32_bf16 v[148:151], a[80:83], a[56:59], v[148:151]
ds_read_b64_tr_b16 a[72:73], v19 offset:32768
v_mfma_f32_16x16x32_bf16 v[148:151], a[84:87], a[60:63], v[148:151]
ds_read_b64_tr_b16 a[74:75], v19 offset:33024
v_mfma_f32_16x16x32_bf16 v[132:135], a[84:87], a[52:55], v[132:135]
ds_read_b64_tr_b16 a[76:77], v19 offset:34816
v_mfma_f32_16x16x32_bf16 v[132:135], a[80:83], a[48:51], v[132:135]
ds_read_b64_tr_b16 a[78:79], v19 offset:35072
v_mfma_f32_16x16x32_bf16 v[116:119], a[80:83], a[40:43], v[116:119]
v_mfma_f32_16x16x32_bf16 v[116:119], a[84:87], a[44:47], v[116:119]
v_mfma_f32_16x16x32_bf16 v[100:103], a[84:87], a[36:39], v[100:103]
s_add_u32 m0, s78, 118784
v_mfma_f32_16x16x32_bf16 v[100:103], a[80:83], a[32:35], v[100:103]
s_waitcnt lgkmcnt(4)
s_add_u32 s64, s75, 3147776
ds_read_b64_tr_b16 a[80:81], v20 offset:32768
v_mfma_f32_16x16x32_bf16 v[184:187], a[88:91], a[0:3], v[184:187]
buffer_load_dwordx4 v23, s[60:63], s64 offen lds
v_mfma_f32_16x16x32_bf16 v[184:187], a[92:95], a[4:7], v[184:187]
ds_read_b64_tr_b16 a[82:83], v20 offset:33024
v_mfma_f32_16x16x32_bf16 v[192:195], a[92:95], a[12:15], v[192:195]
ds_read_b64_tr_b16 a[84:85], v20 offset:34816
v_mfma_f32_16x16x32_bf16 v[192:195], a[88:91], a[8:11], v[192:195]
ds_read_b64_tr_b16 a[86:87], v20 offset:35072
v_mfma_f32_16x16x32_bf16 v[200:203], a[88:91], a[16:19], v[200:203]
v_mfma_f32_16x16x32_bf16 v[200:203], a[92:95], a[20:23], v[200:203]
v_mfma_f32_16x16x32_bf16 v[208:211], a[92:95], a[28:31], v[208:211]
v_mfma_f32_16x16x32_bf16 v[208:211], a[88:91], a[24:27], v[208:211]
ds_read_b64_tr_b16 a[88:89], v4 offset:32768
v_mfma_f32_16x16x32_bf16 v[212:215], a[96:99], a[24:27], v[212:215]
s_xor_b32 m0, s77, 100352
ds_read_b64_tr_b16 a[90:91], v4 offset:33792
v_mfma_f32_16x16x32_bf16 v[212:215], a[100:103], a[28:31], v[212:215]
s_xor_b32 s64, s71, 4259840
ds_read_b64_tr_b16 a[92:93], v4 offset:40960
v_mfma_f32_16x16x32_bf16 v[204:207], a[100:103], a[20:23], v[204:207]
buffer_load_dwordx4 v15, s[56:59], s64 offen lds
v_mfma_f32_16x16x32_bf16 v[204:207], a[96:99], a[16:19], v[204:207]
ds_read_b64_tr_b16 a[94:95], v4 offset:41984
v_mfma_f32_16x16x32_bf16 v[196:199], a[96:99], a[8:11], v[196:199]
v_mfma_f32_16x16x32_bf16 v[196:199], a[100:103], a[12:15], v[196:199]
v_mfma_f32_16x16x32_bf16 v[188:191], a[100:103], a[4:7], v[188:191]
v_mfma_f32_16x16x32_bf16 v[188:191], a[96:99], a[0:3], v[188:191]
ds_read_b64_tr_b16 a[96:97], v5 offset:32768
v_mfma_f32_16x16x32_bf16 v[216:219], a[0:3], a[104:107], v[216:219]
s_add_u32 s65, s79, 25600
ds_read_b64_tr_b16 a[98:99], v5 offset:33792
v_mfma_f32_16x16x32_bf16 v[216:219], a[4:7], a[108:111], v[216:219]
s_add_u32 m0, s78, 122880
buffer_store_dwordx4 a[196:199], v16, s[44:47], s65 offen sc1
v_mfma_f32_16x16x32_bf16 v[224:227], a[12:15], a[108:111], v[224:227]
s_add_u32 s64, s75, 3149824
ds_read_b64_tr_b16 a[100:101], v5 offset:40960
v_mfma_f32_16x16x32_bf16 v[224:227], a[8:11], a[104:107], v[224:227]
buffer_load_dwordx4 v23, s[60:63], s64 offen lds
v_mfma_f32_16x16x32_bf16 v[232:235], a[16:19], a[104:107], v[232:235]
ds_read_b64_tr_b16 a[102:103], v5 offset:41984
v_mfma_f32_16x16x32_bf16 v[232:235], a[20:23], a[108:111], v[232:235]
v_mfma_f32_16x16x32_bf16 v[240:243], a[28:31], a[108:111], v[240:243]
v_mfma_f32_16x16x32_bf16 v[240:243], a[24:27], a[104:107], v[240:243]
ds_read_b64_tr_b16 a[104:105], v6 offset:32768
v_mfma_f32_16x16x32_bf16 v[244:247], a[24:27], a[112:115], v[244:247]
ds_read_b64_tr_b16 a[106:107], v6 offset:33792
v_mfma_f32_16x16x32_bf16 v[244:247], a[28:31], a[116:119], v[244:247]
ds_read_b64_tr_b16 a[108:109], v6 offset:40960
v_subrev_u32 v19, 0x8000, v19
v_mfma_f32_16x16x32_bf16 v[236:239], a[20:23], a[116:119], v[236:239]
s_xor_b32 m0, s77, 101376
ds_read_b64_tr_b16 a[110:111], v6 offset:41984
v_mfma_f32_16x16x32_bf16 v[236:239], a[16:19], a[112:115], v[236:239]
s_xor_b32 s64, s71, 4292608
v_mfma_f32_16x16x32_bf16 v[228:231], a[8:11], a[112:115], v[228:231]
buffer_load_dwordx4 v15, s[56:59], s64 offen lds
v_mfma_f32_16x16x32_bf16 v[228:231], a[12:15], a[116:119], v[228:231]
v_mfma_f32_16x16x32_bf16 v[220:223], a[4:7], a[116:119], v[220:223]
v_mfma_f32_16x16x32_bf16 v[220:223], a[0:3], a[112:115], v[220:223]
s_waitcnt lgkmcnt(4)
ds_read_b64_tr_b16 a[112:113], v7 offset:32768
v_mfma_f32_16x16x32_bf16 v[152:155], a[72:75], a[0:3], v[152:155]
ds_read_b64_tr_b16 a[114:115], v7 offset:33792
v_mfma_f32_16x16x32_bf16 v[152:155], a[76:79], a[4:7], v[152:155]
ds_read_b64_tr_b16 a[116:117], v7 offset:40960
v_subrev_u32 v20, 0x8000, v20
v_mfma_f32_16x16x32_bf16 v[160:163], a[76:79], a[12:15], v[160:163]
ds_read_b64_tr_b16 a[118:119], v7 offset:41984
v_mfma_f32_16x16x32_bf16 v[160:163], a[72:75], a[8:11], v[160:163]
v_mfma_f32_16x16x32_bf16 v[168:171], a[72:75], a[16:19], v[168:171]
v_mfma_f32_16x16x32_bf16 v[168:171], a[76:79], a[20:23], v[168:171]
v_mfma_f32_16x16x32_bf16 v[176:179], a[76:79], a[28:31], v[176:179]
s_xor_b32 m0, s84, 0
v_mfma_f32_16x16x32_bf16 v[176:179], a[72:75], a[24:27], v[176:179]
s_xor_b32 s64, s72, 1024
ds_read_b64_tr_b16 a[72:73], v8 offset:32768
v_mfma_f32_16x16x32_bf16 v[180:183], a[80:83], a[24:27], v[180:183]
buffer_load_dwordx4 v12, s[48:51], s64 offen lds
v_mfma_f32_16x16x32_bf16 v[180:183], a[84:87], a[28:31], v[180:183]
ds_read_b64_tr_b16 a[74:75], v8 offset:33792
v_subrev_u32 v4, 0x8000, v4
v_mfma_f32_16x16x32_bf16 v[172:175], a[84:87], a[20:23], v[172:175]
ds_read_b64_tr_b16 a[76:77], v8 offset:40960
v_mfma_f32_16x16x32_bf16 v[172:175], a[80:83], a[16:19], v[172:175]
s_xor_b32 m0, s84, 1024
ds_read_b64_tr_b16 a[78:79], v8 offset:41984
v_mfma_f32_16x16x32_bf16 v[164:167], a[80:83], a[8:11], v[164:167]
s_xor_b32 s64, s72, 17408
v_mfma_f32_16x16x32_bf16 v[164:167], a[84:87], a[12:15], v[164:167]
buffer_load_dwordx4 v13, s[48:51], s64 offen lds
v_mfma_f32_16x16x32_bf16 v[156:159], a[84:87], a[4:7], v[156:159]
v_mfma_f32_16x16x32_bf16 v[156:159], a[80:83], a[0:3], v[156:159]
ds_read_b64_tr_b16 a[80:81], v9 offset:32768
v_mfma_f32_16x16x32_bf16 v[24:27], a[88:91], a[0:3], v[24:27]
s_xor_b32 m0, s84, 2048
ds_read_b64_tr_b16 a[82:83], v9 offset:33792
v_mfma_f32_16x16x32_bf16 v[24:27], a[92:95], a[4:7], v[24:27]
s_xor_b32 s64, s72, 132096
ds_read_b64_tr_b16 a[84:85], v9 offset:40960
v_subrev_u32 v5, 0x8000, v5
v_mfma_f32_16x16x32_bf16 v[40:43], a[92:95], a[12:15], v[40:43]
buffer_load_dwordx4 v12, s[48:51], s64 offen lds
v_mfma_f32_16x16x32_bf16 v[40:43], a[88:91], a[8:11], v[40:43]
ds_read_b64_tr_b16 a[86:87], v9 offset:41984
v_mfma_f32_16x16x32_bf16 v[56:59], a[88:91], a[16:19], v[56:59]
v_mfma_f32_16x16x32_bf16 v[56:59], a[92:95], a[20:23], v[56:59]
s_xor_b32 m0, s84, 3072
v_mfma_f32_16x16x32_bf16 v[72:75], a[92:95], a[28:31], v[72:75]
s_waitcnt vmcnt(12)
s_xor_b32 s64, s72, 148480
ds_read_b128 a[32:35], v2 offset:32768
v_mfma_f32_16x16x32_bf16 v[72:75], a[88:91], a[24:27], v[72:75]
buffer_load_dwordx4 v13, s[48:51], s64 offen lds
v_mfma_f32_16x16x32_bf16 v[136:139], a[96:99], a[24:27], v[136:139]
ds_read_b128 a[36:39], v3 offset:32768
v_mfma_f32_16x16x32_bf16 v[136:139], a[100:103], a[28:31], v[136:139]
ds_read_b128 a[40:43], v2 offset:34816
v_subrev_u32 v6, 0x8000, v6
v_mfma_f32_16x16x32_bf16 v[120:123], a[100:103], a[20:23], v[120:123]
s_xor_b32 m0, s84, 4096
ds_read_b128 a[44:47], v3 offset:34816
v_mfma_f32_16x16x32_bf16 v[120:123], a[96:99], a[16:19], v[120:123]
s_xor_b32 s64, s73, 1024
ds_read_b128 a[48:51], v2 offset:36864
v_mfma_f32_16x16x32_bf16 v[104:107], a[96:99], a[8:11], v[104:107]
buffer_load_dwordx4 v12, s[48:51], s64 offen lds
v_mfma_f32_16x16x32_bf16 v[104:107], a[100:103], a[12:15], v[104:107]
s_add_u32 s65, s79, 9216
ds_read_b128 a[52:55], v3 offset:36864
v_mfma_f32_16x16x32_bf16 v[88:91], a[100:103], a[4:7], v[88:91]
buffer_store_dwordx4 a[200:203], v16, s[44:47], s65 offen sc1
v_mfma_f32_16x16x32_bf16 v[88:91], a[96:99], a[0:3], v[88:91]
s_waitcnt lgkmcnt(6)
s_xor_b32 m0, s84, 5120
ds_read_b128 a[56:59], v2 offset:38912
v_mfma_f32_16x16x32_bf16 v[28:31], a[104:107], a[0:3], v[28:31]
s_xor_b32 s64, s73, 17408
ds_read_b128 a[60:63], v3 offset:38912
v_mfma_f32_16x16x32_bf16 v[28:31], a[108:111], a[4:7], v[28:31]
buffer_load_dwordx4 v13, s[48:51], s64 offen lds
v_mfma_f32_16x16x32_bf16 v[44:47], a[108:111], a[12:15], v[44:47]
ds_read_b64_tr_b16 a[88:89], v10 offset:32768
v_subrev_u32 v7, 0x8000, v7
v_mfma_f32_16x16x32_bf16 v[44:47], a[104:107], a[8:11], v[44:47]
ds_read_b64_tr_b16 a[90:91], v10 offset:33792
v_mfma_f32_16x16x32_bf16 v[60:63], a[104:107], a[16:19], v[60:63]
s_xor_b32 m0, s84, 6144
ds_read_b64_tr_b16 a[92:93], v10 offset:40960
v_mfma_f32_16x16x32_bf16 v[60:63], a[108:111], a[20:23], v[60:63]
s_xor_b32 s64, s73, 132096
ds_read_b64_tr_b16 a[94:95], v10 offset:41984
v_mfma_f32_16x16x32_bf16 v[76:79], a[108:111], a[28:31], v[76:79]
buffer_load_dwordx4 v12, s[48:51], s64 offen lds
v_mfma_f32_16x16x32_bf16 v[76:79], a[104:107], a[24:27], v[76:79]
ds_read_b64_tr_b16 a[96:97], v11 offset:32768
v_mfma_f32_16x16x32_bf16 v[140:143], a[112:115], a[24:27], v[140:143]
ds_read_b64_tr_b16 a[98:99], v11 offset:33792
v_mfma_f32_16x16x32_bf16 v[140:143], a[116:119], a[28:31], v[140:143]
s_xor_b32 m0, s84, 7168
ds_read_b64_tr_b16 a[100:101], v11 offset:40960
v_subrev_u32 v8, 0x8000, v8
v_mfma_f32_16x16x32_bf16 v[124:127], a[116:119], a[20:23], v[124:127]
s_xor_b32 s64, s73, 148480
ds_read_b64_tr_b16 a[102:103], v11 offset:41984
v_mfma_f32_16x16x32_bf16 v[124:127], a[112:115], a[16:19], v[124:127]
buffer_load_dwordx4 v13, s[48:51], s64 offen lds
v_mfma_f32_16x16x32_bf16 v[108:111], a[112:115], a[8:11], v[108:111]
v_mfma_f32_16x16x32_bf16 v[108:111], a[116:119], a[12:15], v[108:111]
v_mfma_f32_16x16x32_bf16 v[92:95], a[116:119], a[4:7], v[92:95]
v_subrev_u32 v9, 0x8000, v9
v_subrev_u32 v10, 0x8000, v10
v_mfma_f32_16x16x32_bf16 v[92:95], a[112:115], a[0:3], v[92:95]
v_subrev_u32 v11, 0x8000, v11
v_mfma_f32_16x16x32_bf16 v[32:35], a[72:75], a[0:3], v[32:35]
v_mfma_f32_16x16x32_bf16 v[32:35], a[76:79], a[4:7], v[32:35]
v_mfma_f32_16x16x32_bf16 v[48:51], a[76:79], a[12:15], v[48:51]
s_waitcnt lgkmcnt(0)
s_barrier
v_mfma_f32_16x16x32_bf16 v[48:51], a[72:75], a[8:11], v[48:51]
s_xor_b32 m0, s77, 131072
ds_read_b64_tr_b16 a[104:105], v19 offset:4096
v_mfma_f32_16x16x32_bf16 v[64:67], a[72:75], a[16:19], v[64:67]
s_xor_b32 s64, s71, 4718592
ds_read_b64_tr_b16 a[106:107], v19 offset:4352
v_mfma_f32_16x16x32_bf16 v[64:67], a[76:79], a[20:23], v[64:67]
buffer_load_dwordx4 v14, s[56:59], s64 offen lds
v_mfma_f32_16x16x32_bf16 v[80:83], a[76:79], a[28:31], v[80:83]
ds_read_b64_tr_b16 a[108:109], v19 offset:6144
v_mfma_f32_16x16x32_bf16 v[80:83], a[72:75], a[24:27], v[80:83]
ds_read_b64_tr_b16 a[110:111], v19 offset:6400
v_mfma_f32_16x16x32_bf16 v[144:147], a[80:83], a[24:27], v[144:147]
ds_read_b64_tr_b16 a[112:113], v20 offset:4096
v_mfma_f32_16x16x32_bf16 v[144:147], a[84:87], a[28:31], v[144:147]
ds_read_b64_tr_b16 a[114:115], v20 offset:4352
v_mfma_f32_16x16x32_bf16 v[128:131], a[84:87], a[20:23], v[128:131]
ds_read_b64_tr_b16 a[116:117], v20 offset:6144
v_mfma_f32_16x16x32_bf16 v[128:131], a[80:83], a[16:19], v[128:131]
ds_read_b64_tr_b16 a[118:119], v20 offset:6400
v_mfma_f32_16x16x32_bf16 v[112:115], a[80:83], a[8:11], v[112:115]
s_add_u32 m0, s78, 147456
ds_read_b64_tr_b16 a[72:73], v19 offset:8192
v_mfma_f32_16x16x32_bf16 v[112:115], a[84:87], a[12:15], v[112:115]
s_add_u32 s64, s75, 3538944
ds_read_b64_tr_b16 a[74:75], v19 offset:8448
v_mfma_f32_16x16x32_bf16 v[96:99], a[84:87], a[4:7], v[96:99]
buffer_load_dwordx4 v23, s[60:63], s64 offen lds
v_mfma_f32_16x16x32_bf16 v[96:99], a[80:83], a[0:3], v[96:99]
ds_read_b64_tr_b16 a[76:77], v19 offset:10240
v_mfma_f32_16x16x32_bf16 v[36:39], a[88:91], a[0:3], v[36:39]
ds_read_b64_tr_b16 a[78:79], v19 offset:10496
v_mfma_f32_16x16x32_bf16 v[36:39], a[92:95], a[4:7], v[36:39]
ds_read_b64_tr_b16 a[80:81], v20 offset:8192
v_mfma_f32_16x16x32_bf16 v[52:55], a[92:95], a[12:15], v[52:55]
ds_read_b64_tr_b16 a[82:83], v20 offset:8448
v_mfma_f32_16x16x32_bf16 v[52:55], a[88:91], a[8:11], v[52:55]
ds_read_b64_tr_b16 a[84:85], v20 offset:10240
v_mfma_f32_16x16x32_bf16 v[68:71], a[88:91], a[16:19], v[68:71]
ds_read_b64_tr_b16 a[86:87], v20 offset:10496
v_mfma_f32_16x16x32_bf16 v[68:71], a[92:95], a[20:23], v[68:71]
s_xor_b32 m0, s77, 132096
v_mfma_f32_16x16x32_bf16 v[84:87], a[92:95], a[28:31], v[84:87]
s_xor_b32 s64, s71, 4751360
v_mfma_f32_16x16x32_bf16 v[84:87], a[88:91], a[24:27], v[84:87]
buffer_load_dwordx4 v14, s[56:59], s64 offen lds
v_mfma_f32_16x16x32_bf16 v[148:151], a[96:99], a[24:27], v[148:151]
ds_read_b64_tr_b16 a[88:89], v19 offset:0
v_mfma_f32_16x16x32_bf16 v[148:151], a[100:103], a[28:31], v[148:151]
ds_read_b64_tr_b16 a[90:91], v19 offset:256
v_mfma_f32_16x16x32_bf16 v[132:135], a[100:103], a[20:23], v[132:135]
s_add_u32 s65, s79, 26624
ds_read_b64_tr_b16 a[92:93], v19 offset:2048
v_mfma_f32_16x16x32_bf16 v[132:135], a[96:99], a[16:19], v[132:135]
buffer_store_dwordx4 a[204:207], v16, s[44:47], s65 offen sc1
v_mfma_f32_16x16x32_bf16 v[116:119], a[96:99], a[8:11], v[116:119]
ds_read_b64_tr_b16 a[94:95], v19 offset:2304
v_mfma_f32_16x16x32_bf16 v[116:119], a[100:103], a[12:15], v[116:119]
v_mfma_f32_16x16x32_bf16 v[100:103], a[100:103], a[4:7], v[100:103]
s_add_u32 m0, s78, 151552
v_mfma_f32_16x16x32_bf16 v[100:103], a[96:99], a[0:3], v[100:103]
s_waitcnt lgkmcnt(4)
s_add_u32 s64, s75, 3540992
ds_read_b64_tr_b16 a[96:97], v20 offset:0
v_mfma_f32_16x16x32_bf16 v[184:187], a[104:107], a[32:35], v[184:187]
buffer_load_dwordx4 v23, s[60:63], s64 offen lds
v_mfma_f32_16x16x32_bf16 v[184:187], a[108:111], a[36:39], v[184:187]
ds_read_b64_tr_b16 a[98:99], v20 offset:256
v_mfma_f32_16x16x32_bf16 v[192:195], a[108:111], a[44:47], v[192:195]
ds_read_b64_tr_b16 a[100:101], v20 offset:2048
v_mfma_f32_16x16x32_bf16 v[192:195], a[104:107], a[40:43], v[192:195]
ds_read_b64_tr_b16 a[102:103], v20 offset:2304
v_mfma_f32_16x16x32_bf16 v[200:203], a[104:107], a[48:51], v[200:203]
s_cmp_eq_u32 s30, 0
s_cselect_b32 s81, 256, 0
v_mfma_f32_16x16x32_bf16 v[200:203], a[108:111], a[52:55], v[200:203]
v_mfma_f32_16x16x32_bf16 v[208:211], a[108:111], a[60:63], v[208:211]
v_mfma_f32_16x16x32_bf16 v[208:211], a[104:107], a[56:59], v[208:211]
ds_read_b64_tr_b16 a[104:105], v4 offset:0
v_mfma_f32_16x16x32_bf16 v[212:215], a[112:115], a[56:59], v[212:215]
s_xor_b32 m0, s77, 133120
ds_read_b64_tr_b16 a[106:107], v4 offset:1024
v_mfma_f32_16x16x32_bf16 v[212:215], a[116:119], a[60:63], v[212:215]
s_xor_b32 s64, s71, 4784128
ds_read_b64_tr_b16 a[108:109], v4 offset:8192
v_mfma_f32_16x16x32_bf16 v[204:207], a[116:119], a[52:55], v[204:207]
buffer_load_dwordx4 v15, s[56:59], s64 offen lds
v_mfma_f32_16x16x32_bf16 v[204:207], a[112:115], a[48:51], v[204:207]
ds_read_b64_tr_b16 a[110:111], v4 offset:9216
v_mfma_f32_16x16x32_bf16 v[196:199], a[112:115], a[40:43], v[196:199]
v_mfma_f32_16x16x32_bf16 v[196:199], a[116:119], a[44:47], v[196:199]
v_mfma_f32_16x16x32_bf16 v[188:191], a[116:119], a[36:39], v[188:191]
v_mfma_f32_16x16x32_bf16 v[188:191], a[112:115], a[32:35], v[188:191]
ds_read_b64_tr_b16 a[112:113], v5 offset:0
v_mfma_f32_16x16x32_bf16 v[216:219], a[32:35], a[72:75], v[216:219]
ds_read_b64_tr_b16 a[114:115], v5 offset:1024
v_mfma_f32_16x16x32_bf16 v[216:219], a[36:39], a[76:79], v[216:219]
s_add_u32 m0, s78, 155648
ds_read_b64_tr_b16 a[116:117], v5 offset:8192
v_mfma_f32_16x16x32_bf16 v[224:227], a[44:47], a[76:79], v[224:227]
s_add_u32 s64, s75, 3543040
ds_read_b64_tr_b16 a[118:119], v5 offset:9216
v_mfma_f32_16x16x32_bf16 v[224:227], a[40:43], a[72:75], v[224:227]
buffer_load_dwordx4 v23, s[60:63], s64 offen lds
v_mfma_f32_16x16x32_bf16 v[232:235], a[48:51], a[72:75], v[232:235]
v_mfma_f32_16x16x32_bf16 v[232:235], a[52:55], a[76:79], v[232:235]
v_mfma_f32_16x16x32_bf16 v[240:243], a[60:63], a[76:79], v[240:243]
v_mfma_f32_16x16x32_bf16 v[240:243], a[56:59], a[72:75], v[240:243]
ds_read_b64_tr_b16 a[72:73], v6 offset:0
v_mfma_f32_16x16x32_bf16 v[244:247], a[56:59], a[80:83], v[244:247]
ds_read_b64_tr_b16 a[74:75], v6 offset:1024
v_mfma_f32_16x16x32_bf16 v[244:247], a[60:63], a[84:87], v[244:247]
ds_read_b64_tr_b16 a[76:77], v6 offset:8192
v_mfma_f32_16x16x32_bf16 v[236:239], a[52:55], a[84:87], v[236:239]
s_xor_b32 m0, s77, 134144
ds_read_b64_tr_b16 a[78:79], v6 offset:9216
v_mfma_f32_16x16x32_bf16 v[236:239], a[48:51], a[80:83], v[236:239]
s_xor_b32 s64, s71, 4816896
v_mfma_f32_16x16x32_bf16 v[228:231], a[40:43], a[80:83], v[228:231]
buffer_load_dwordx4 v15, s[56:59], s64 offen lds
v_mfma_f32_16x16x32_bf16 v[228:231], a[44:47], a[84:87], v[228:231]
v_mfma_f32_16x16x32_bf16 v[220:223], a[36:39], a[84:87], v[220:223]
v_mfma_f32_16x16x32_bf16 v[220:223], a[32:35], a[80:83], v[220:223]
s_waitcnt lgkmcnt(4)
ds_read_b64_tr_b16 a[80:81], v7 offset:0
v_mfma_f32_16x16x32_bf16 v[152:155], a[88:91], a[32:35], v[152:155]
ds_read_b64_tr_b16 a[82:83], v7 offset:1024
v_mfma_f32_16x16x32_bf16 v[152:155], a[92:95], a[36:39], v[152:155]
ds_read_b64_tr_b16 a[84:85], v7 offset:8192
v_mfma_f32_16x16x32_bf16 v[160:163], a[92:95], a[44:47], v[160:163]
ds_read_b64_tr_b16 a[86:87], v7 offset:9216
v_mfma_f32_16x16x32_bf16 v[160:163], a[88:91], a[40:43], v[160:163]
v_mfma_f32_16x16x32_bf16 v[168:171], a[88:91], a[48:51], v[168:171]
v_mfma_f32_16x16x32_bf16 v[168:171], a[92:95], a[52:55], v[168:171]
v_mfma_f32_16x16x32_bf16 v[176:179], a[92:95], a[60:63], v[176:179]
s_xor_b32 m0, s84, 32768
v_mfma_f32_16x16x32_bf16 v[176:179], a[88:91], a[56:59], v[176:179]
s_xor_b32 s64, s72, 1152
ds_read_b64_tr_b16 a[88:89], v8 offset:0
v_mfma_f32_16x16x32_bf16 v[180:183], a[96:99], a[56:59], v[180:183]
s_add_u32 s65, s79, 27648
buffer_load_dwordx4 v12, s[48:51], s64 offen lds
v_mfma_f32_16x16x32_bf16 v[180:183], a[100:103], a[60:63], v[180:183]
buffer_store_dwordx4 a[208:211], v16, s[44:47], s65 offen sc1
v_mfma_f32_16x16x32_bf16 v[172:175], a[100:103], a[52:55], v[172:175]
ds_read_b64_tr_b16 a[90:91], v8 offset:1024
v_mfma_f32_16x16x32_bf16 v[172:175], a[96:99], a[48:51], v[172:175]
s_xor_b32 m0, s84, 33792
ds_read_b64_tr_b16 a[92:93], v8 offset:8192
v_mfma_f32_16x16x32_bf16 v[164:167], a[96:99], a[40:43], v[164:167]
s_xor_b32 s64, s72, 17536
ds_read_b64_tr_b16 a[94:95], v8 offset:9216
v_mfma_f32_16x16x32_bf16 v[164:167], a[100:103], a[44:47], v[164:167]
buffer_load_dwordx4 v13, s[48:51], s64 offen lds
v_mfma_f32_16x16x32_bf16 v[156:159], a[100:103], a[36:39], v[156:159]
v_mfma_f32_16x16x32_bf16 v[156:159], a[96:99], a[32:35], v[156:159]
ds_read_b64_tr_b16 a[96:97], v9 offset:0
v_mfma_f32_16x16x32_bf16 v[24:27], a[104:107], a[32:35], v[24:27]
s_xor_b32 m0, s84, 34816
ds_read_b64_tr_b16 a[98:99], v9 offset:1024
v_mfma_f32_16x16x32_bf16 v[24:27], a[108:111], a[36:39], v[24:27]
s_xor_b32 s64, s72, 132224
ds_read_b64_tr_b16 a[100:101], v9 offset:8192
v_mfma_f32_16x16x32_bf16 v[40:43], a[108:111], a[44:47], v[40:43]
buffer_load_dwordx4 v12, s[48:51], s64 offen lds
v_mfma_f32_16x16x32_bf16 v[40:43], a[104:107], a[40:43], v[40:43]
ds_read_b64_tr_b16 a[102:103], v9 offset:9216
v_mfma_f32_16x16x32_bf16 v[56:59], a[104:107], a[48:51], v[56:59]
v_mfma_f32_16x16x32_bf16 v[56:59], a[108:111], a[52:55], v[56:59]
s_xor_b32 m0, s84, 35840
v_mfma_f32_16x16x32_bf16 v[72:75], a[108:111], a[60:63], v[72:75]
s_waitcnt vmcnt(12)
s_xor_b32 s64, s72, 148608
ds_read_b128 a[0:3], v2 offset:0
v_mfma_f32_16x16x32_bf16 v[72:75], a[104:107], a[56:59], v[72:75]
buffer_load_dwordx4 v13, s[48:51], s64 offen lds
v_mfma_f32_16x16x32_bf16 v[136:139], a[112:115], a[56:59], v[136:139]
ds_read_b128 a[4:7], v3 offset:0
v_mfma_f32_16x16x32_bf16 v[136:139], a[116:119], a[60:63], v[136:139]
ds_read_b128 a[8:11], v2 offset:2048
v_mfma_f32_16x16x32_bf16 v[120:123], a[116:119], a[52:55], v[120:123]
s_xor_b32 m0, s84, 36864
ds_read_b128 a[12:15], v3 offset:2048
v_mfma_f32_16x16x32_bf16 v[120:123], a[112:115], a[48:51], v[120:123]
s_xor_b32 s64, s73, 1152
ds_read_b128 a[16:19], v2 offset:4096
v_mfma_f32_16x16x32_bf16 v[104:107], a[112:115], a[40:43], v[104:107]
buffer_load_dwordx4 v12, s[48:51], s64 offen lds
v_mfma_f32_16x16x32_bf16 v[104:107], a[116:119], a[44:47], v[104:107]
ds_read_b128 a[20:23], v3 offset:4096
v_mfma_f32_16x16x32_bf16 v[88:91], a[116:119], a[36:39], v[88:91]
ds_read_b128 a[24:27], v2 offset:6144
v_mfma_f32_16x16x32_bf16 v[88:91], a[112:115], a[32:35], v[88:91]
s_waitcnt lgkmcnt(7)
s_xor_b32 m0, s84, 37888
ds_read_b128 a[28:31], v3 offset:6144
v_mfma_f32_16x16x32_bf16 v[28:31], a[72:75], a[32:35], v[28:31]
s_xor_b32 s64, s73, 17536
ds_read_b64_tr_b16 a[104:105], v10 offset:0
v_mfma_f32_16x16x32_bf16 v[28:31], a[76:79], a[36:39], v[28:31]
buffer_load_dwordx4 v13, s[48:51], s64 offen lds
v_mfma_f32_16x16x32_bf16 v[44:47], a[76:79], a[44:47], v[44:47]
ds_read_b64_tr_b16 a[106:107], v10 offset:1024
v_mfma_f32_16x16x32_bf16 v[44:47], a[72:75], a[40:43], v[44:47]
ds_read_b64_tr_b16 a[108:109], v10 offset:8192
v_mfma_f32_16x16x32_bf16 v[60:63], a[72:75], a[48:51], v[60:63]
s_xor_b32 m0, s84, 38912
ds_read_b64_tr_b16 a[110:111], v10 offset:9216
v_mfma_f32_16x16x32_bf16 v[60:63], a[76:79], a[52:55], v[60:63]
s_xor_b32 s64, s73, 132224
ds_read_b64_tr_b16 a[112:113], v11 offset:0
v_mfma_f32_16x16x32_bf16 v[76:79], a[76:79], a[60:63], v[76:79]
buffer_load_dwordx4 v12, s[48:51], s64 offen lds
v_mfma_f32_16x16x32_bf16 v[76:79], a[72:75], a[56:59], v[76:79]
ds_read_b64_tr_b16 a[114:115], v11 offset:1024
v_mfma_f32_16x16x32_bf16 v[140:143], a[80:83], a[56:59], v[140:143]
ds_read_b64_tr_b16 a[116:117], v11 offset:8192
v_mfma_f32_16x16x32_bf16 v[140:143], a[84:87], a[60:63], v[140:143]
s_xor_b32 m0, s84, 39936
ds_read_b64_tr_b16 a[118:119], v11 offset:9216
v_mfma_f32_16x16x32_bf16 v[124:127], a[84:87], a[52:55], v[124:127]
s_xor_b32 s64, s73, 148608
v_mfma_f32_16x16x32_bf16 v[124:127], a[80:83], a[48:51], v[124:127]
buffer_load_dwordx4 v13, s[48:51], s64 offen lds
v_mfma_f32_16x16x32_bf16 v[108:111], a[80:83], a[40:43], v[108:111]
v_mfma_f32_16x16x32_bf16 v[108:111], a[84:87], a[44:47], v[108:111]
v_mfma_f32_16x16x32_bf16 v[92:95], a[84:87], a[36:39], v[92:95]
v_mfma_f32_16x16x32_bf16 v[92:95], a[80:83], a[32:35], v[92:95]
v_mfma_f32_16x16x32_bf16 v[32:35], a[88:91], a[32:35], v[32:35]
v_mfma_f32_16x16x32_bf16 v[32:35], a[92:95], a[36:39], v[32:35]
v_mfma_f32_16x16x32_bf16 v[48:51], a[92:95], a[44:47], v[48:51]
s_waitcnt lgkmcnt(0)
s_barrier
v_mfma_f32_16x16x32_bf16 v[48:51], a[88:91], a[40:43], v[48:51]
s_xor_b32 m0, s77, 65536
s_add_u32 s65, s79, 11264
ds_read_b64_tr_b16 a[72:73], v19 offset:36864
v_mfma_f32_16x16x32_bf16 v[64:67], a[88:91], a[48:51], v[64:67]
s_xor_b32 s64, s71, 5242880
buffer_store_dwordx4 a[212:215], v16, s[44:47], s65 offen sc1
v_mfma_f32_16x16x32_bf16 v[64:67], a[92:95], a[52:55], v[64:67]
buffer_load_dwordx4 v14, s[56:59], s64 offen lds
v_mfma_f32_16x16x32_bf16 v[80:83], a[92:95], a[60:63], v[80:83]
ds_read_b64_tr_b16 a[74:75], v19 offset:37120
v_mfma_f32_16x16x32_bf16 v[80:83], a[88:91], a[56:59], v[80:83]
buffer_load_dword v1, off, s[52:55], s78 sc1
v_mfma_f32_16x16x32_bf16 v[144:147], a[96:99], a[56:59], v[144:147]
ds_read_b64_tr_b16 a[76:77], v19 offset:38912
v_mfma_f32_16x16x32_bf16 v[144:147], a[100:103], a[60:63], v[144:147]
ds_read_b64_tr_b16 a[78:79], v19 offset:39168
v_mfma_f32_16x16x32_bf16 v[128:131], a[100:103], a[52:55], v[128:131]
ds_read_b64_tr_b16 a[80:81], v20 offset:36864
v_mfma_f32_16x16x32_bf16 v[128:131], a[96:99], a[48:51], v[128:131]
ds_read_b64_tr_b16 a[82:83], v20 offset:37120
v_mfma_f32_16x16x32_bf16 v[112:115], a[96:99], a[40:43], v[112:115]
s_add_u32 m0, s78, 81920
ds_read_b64_tr_b16 a[84:85], v20 offset:38912
v_mfma_f32_16x16x32_bf16 v[112:115], a[100:103], a[44:47], v[112:115]
s_add_u32 s64, s75, 3932160
ds_read_b64_tr_b16 a[86:87], v20 offset:39168
v_mfma_f32_16x16x32_bf16 v[96:99], a[100:103], a[36:39], v[96:99]
buffer_load_dwordx4 v23, s[60:63], s64 offen lds
v_mfma_f32_16x16x32_bf16 v[96:99], a[96:99], a[32:35], v[96:99]
ds_read_b64_tr_b16 a[88:89], v19 offset:40960
v_mfma_f32_16x16x32_bf16 v[36:39], a[104:107], a[32:35], v[36:39]
ds_read_b64_tr_b16 a[90:91], v19 offset:41216
v_mfma_f32_16x16x32_bf16 v[36:39], a[108:111], a[36:39], v[36:39]
ds_read_b64_tr_b16 a[92:93], v19 offset:43008
v_mfma_f32_16x16x32_bf16 v[52:55], a[108:111], a[44:47], v[52:55]
ds_read_b64_tr_b16 a[94:95], v19 offset:43264
v_mfma_f32_16x16x32_bf16 v[52:55], a[104:107], a[40:43], v[52:55]
ds_read_b64_tr_b16 a[96:97], v20 offset:40960
v_mfma_f32_16x16x32_bf16 v[68:71], a[104:107], a[48:51], v[68:71]
ds_read_b64_tr_b16 a[98:99], v20 offset:41216
v_mfma_f32_16x16x32_bf16 v[68:71], a[108:111], a[52:55], v[68:71]
s_xor_b32 m0, s77, 66560
ds_read_b64_tr_b16 a[100:101], v20 offset:43008
v_mfma_f32_16x16x32_bf16 v[84:87], a[108:111], a[60:63], v[84:87]
s_xor_b32 s64, s71, 5275648
ds_read_b64_tr_b16 a[102:103], v20 offset:43264
v_mfma_f32_16x16x32_bf16 v[84:87], a[104:107], a[56:59], v[84:87]
buffer_load_dwordx4 v14, s[56:59], s64 offen lds
v_mfma_f32_16x16x32_bf16 v[148:151], a[112:115], a[56:59], v[148:151]
ds_read_b64_tr_b16 a[104:105], v19 offset:32768
v_mfma_f32_16x16x32_bf16 v[148:151], a[116:119], a[60:63], v[148:151]
ds_read_b64_tr_b16 a[106:107], v19 offset:33024
v_mfma_f32_16x16x32_bf16 v[132:135], a[116:119], a[52:55], v[132:135]
ds_read_b64_tr_b16 a[108:109], v19 offset:34816
v_mfma_f32_16x16x32_bf16 v[132:135], a[112:115], a[48:51], v[132:135]
ds_read_b64_tr_b16 a[110:111], v19 offset:35072
v_mfma_f32_16x16x32_bf16 v[116:119], a[112:115], a[40:43], v[116:119]
v_mfma_f32_16x16x32_bf16 v[116:119], a[116:119], a[44:47], v[116:119]
v_mfma_f32_16x16x32_bf16 v[100:103], a[116:119], a[36:39], v[100:103]
s_add_u32 m0, s78, 86016
v_mfma_f32_16x16x32_bf16 v[100:103], a[112:115], a[32:35], v[100:103]
s_waitcnt lgkmcnt(5)
s_add_u32 s64, s75, 3934208
ds_read_b64_tr_b16 a[112:113], v20 offset:32768
v_mfma_f32_16x16x32_bf16 v[184:187], a[72:75], a[0:3], v[184:187]
buffer_load_dwordx4 v23, s[60:63], s64 offen lds
v_mfma_f32_16x16x32_bf16 v[184:187], a[76:79], a[4:7], v[184:187]
ds_read_b64_tr_b16 a[114:115], v20 offset:33024
v_mfma_f32_16x16x32_bf16 v[192:195], a[76:79], a[12:15], v[192:195]
ds_read_b64_tr_b16 a[116:117], v20 offset:34816
v_mfma_f32_16x16x32_bf16 v[192:195], a[72:75], a[8:11], v[192:195]
ds_read_b64_tr_b16 a[118:119], v20 offset:35072
v_mfma_f32_16x16x32_bf16 v[200:203], a[72:75], a[16:19], v[200:203]
v_mfma_f32_16x16x32_bf16 v[200:203], a[76:79], a[20:23], v[200:203]
v_mfma_f32_16x16x32_bf16 v[208:211], a[76:79], a[28:31], v[208:211]
s_branch L_po10
L_pg10:
s_branch L_tr1
L_po10:
v_mfma_f32_16x16x32_bf16 v[208:211], a[72:75], a[24:27], v[208:211]
ds_read_b64_tr_b16 a[72:73], v4 offset:32768
v_mfma_f32_16x16x32_bf16 v[212:215], a[80:83], a[24:27], v[212:215]
s_xor_b32 m0, s77, 67584
ds_read_b64_tr_b16 a[74:75], v4 offset:33792
v_mfma_f32_16x16x32_bf16 v[212:215], a[84:87], a[28:31], v[212:215]
s_xor_b32 s64, s71, 5308416
ds_read_b64_tr_b16 a[76:77], v4 offset:40960
v_mfma_f32_16x16x32_bf16 v[204:207], a[84:87], a[20:23], v[204:207]
buffer_load_dwordx4 v15, s[56:59], s64 offen lds
v_mfma_f32_16x16x32_bf16 v[204:207], a[80:83], a[16:19], v[204:207]
ds_read_b64_tr_b16 a[78:79], v4 offset:41984
v_mfma_f32_16x16x32_bf16 v[196:199], a[80:83], a[8:11], v[196:199]
v_mfma_f32_16x16x32_bf16 v[196:199], a[84:87], a[12:15], v[196:199]
v_mfma_f32_16x16x32_bf16 v[188:191], a[84:87], a[4:7], v[188:191]
v_mfma_f32_16x16x32_bf16 v[188:191], a[80:83], a[0:3], v[188:191]
ds_read_b64_tr_b16 a[80:81], v5 offset:32768
v_mfma_f32_16x16x32_bf16 v[216:219], a[0:3], a[88:91], v[216:219]
s_add_u32 s65, s79, 28672
ds_read_b64_tr_b16 a[82:83], v5 offset:33792
v_mfma_f32_16x16x32_bf16 v[216:219], a[4:7], a[92:95], v[216:219]
s_add_u32 m0, s78, 90112
buffer_store_dwordx4 a[216:219], v16, s[44:47], s65 offen sc1
v_mfma_f32_16x16x32_bf16 v[224:227], a[12:15], a[92:95], v[224:227]
s_add_u32 s64, s75, 3936256
ds_read_b64_tr_b16 a[84:85], v5 offset:40960
v_mfma_f32_16x16x32_bf16 v[224:227], a[8:11], a[88:91], v[224:227]
buffer_load_dwordx4 v23, s[60:63], s64 offen lds
v_mfma_f32_16x16x32_bf16 v[232:235], a[16:19], a[88:91], v[232:235]
ds_read_b64_tr_b16 a[86:87], v5 offset:41984
v_mfma_f32_16x16x32_bf16 v[232:235], a[20:23], a[92:95], v[232:235]
v_mfma_f32_16x16x32_bf16 v[240:243], a[28:31], a[92:95], v[240:243]
v_mfma_f32_16x16x32_bf16 v[240:243], a[24:27], a[88:91], v[240:243]
ds_read_b64_tr_b16 a[88:89], v6 offset:32768
v_mfma_f32_16x16x32_bf16 v[244:247], a[24:27], a[96:99], v[244:247]
s_waitcnt lgkmcnt(5)
ds_read_b64_tr_b16 a[90:91], v6 offset:33792
v_mfma_f32_16x16x32_bf16 v[244:247], a[28:31], a[100:103], v[244:247]
ds_read_b64_tr_b16 a[92:93], v6 offset:40960
v_add_u32 v19, 0x8000, v19
v_mfma_f32_16x16x32_bf16 v[236:239], a[20:23], a[100:103], v[236:239]
s_xor_b32 m0, s77, 68608
ds_read_b64_tr_b16 a[94:95], v6 offset:41984
v_mfma_f32_16x16x32_bf16 v[236:239], a[16:19], a[96:99], v[236:239]
s_xor_b32 s64, s71, 5341184
v_mfma_f32_16x16x32_bf16 v[228:231], a[8:11], a[96:99], v[228:231]
buffer_load_dwordx4 v15, s[56:59], s64 offen lds
v_mfma_f32_16x16x32_bf16 v[228:231], a[12:15], a[100:103], v[228:231]
v_mfma_f32_16x16x32_bf16 v[220:223], a[4:7], a[100:103], v[220:223]
v_mfma_f32_16x16x32_bf16 v[220:223], a[0:3], a[96:99], v[220:223]
ds_read_b64_tr_b16 a[96:97], v7 offset:32768
v_mfma_f32_16x16x32_bf16 v[152:155], a[104:107], a[0:3], v[152:155]
ds_read_b64_tr_b16 a[98:99], v7 offset:33792
v_mfma_f32_16x16x32_bf16 v[152:155], a[108:111], a[4:7], v[152:155]
ds_read_b64_tr_b16 a[100:101], v7 offset:40960
v_add_u32 v20, 0x8000, v20
v_mfma_f32_16x16x32_bf16 v[160:163], a[108:111], a[12:15], v[160:163]
ds_read_b64_tr_b16 a[102:103], v7 offset:41984
v_mfma_f32_16x16x32_bf16 v[160:163], a[104:107], a[8:11], v[160:163]
v_mfma_f32_16x16x32_bf16 v[168:171], a[104:107], a[16:19], v[168:171]
v_mfma_f32_16x16x32_bf16 v[168:171], a[108:111], a[20:23], v[168:171]
v_mfma_f32_16x16x32_bf16 v[176:179], a[108:111], a[28:31], v[176:179]
s_xor_b32 m0, s84, 0
v_mfma_f32_16x16x32_bf16 v[176:179], a[104:107], a[24:27], v[176:179]
s_xor_b32 s64, s72, 1280
ds_read_b64_tr_b16 a[104:105], v8 offset:32768
v_mfma_f32_16x16x32_bf16 v[180:183], a[112:115], a[24:27], v[180:183]
buffer_load_dwordx4 v12, s[48:51], s64 offen lds
v_mfma_f32_16x16x32_bf16 v[180:183], a[116:119], a[28:31], v[180:183]
ds_read_b64_tr_b16 a[106:107], v8 offset:33792
v_add_u32 v4, 0x8000, v4
v_mfma_f32_16x16x32_bf16 v[172:175], a[116:119], a[20:23], v[172:175]
ds_read_b64_tr_b16 a[108:109], v8 offset:40960
v_mfma_f32_16x16x32_bf16 v[172:175], a[112:115], a[16:19], v[172:175]
s_xor_b32 m0, s84, 1024
ds_read_b64_tr_b16 a[110:111], v8 offset:41984
v_mfma_f32_16x16x32_bf16 v[164:167], a[112:115], a[8:11], v[164:167]
s_xor_b32 s64, s72, 17664
v_mfma_f32_16x16x32_bf16 v[164:167], a[116:119], a[12:15], v[164:167]
buffer_load_dwordx4 v13, s[48:51], s64 offen lds
v_mfma_f32_16x16x32_bf16 v[156:159], a[116:119], a[4:7], v[156:159]
v_mfma_f32_16x16x32_bf16 v[156:159], a[112:115], a[0:3], v[156:159]
ds_read_b64_tr_b16 a[112:113], v9 offset:32768
v_mfma_f32_16x16x32_bf16 v[24:27], a[72:75], a[0:3], v[24:27]
s_xor_b32 m0, s84, 2048
ds_read_b64_tr_b16 a[114:115], v9 offset:33792
v_mfma_f32_16x16x32_bf16 v[24:27], a[76:79], a[4:7], v[24:27]
s_xor_b32 s64, s72, 132352
ds_read_b64_tr_b16 a[116:117], v9 offset:40960
v_add_u32 v5, 0x8000, v5
v_mfma_f32_16x16x32_bf16 v[40:43], a[76:79], a[12:15], v[40:43]
buffer_load_dwordx4 v12, s[48:51], s64 offen lds
v_mfma_f32_16x16x32_bf16 v[40:43], a[72:75], a[8:11], v[40:43]
ds_read_b64_tr_b16 a[118:119], v9 offset:41984
v_mfma_f32_16x16x32_bf16 v[56:59], a[72:75], a[16:19], v[56:59]
v_mfma_f32_16x16x32_bf16 v[56:59], a[76:79], a[20:23], v[56:59]
s_xor_b32 m0, s84, 3072
v_mfma_f32_16x16x32_bf16 v[72:75], a[76:79], a[28:31], v[72:75]
s_waitcnt vmcnt(13)
s_xor_b32 s64, s72, 148736
ds_read_b128 a[32:35], v2 offset:32768
v_mfma_f32_16x16x32_bf16 v[72:75], a[72:75], a[24:27], v[72:75]
s_waitcnt lgkmcnt(5)
buffer_load_dwordx4 v13, s[48:51], s64 offen lds
v_mfma_f32_16x16x32_bf16 v[136:139], a[80:83], a[24:27], v[136:139]
ds_read_b128 a[36:39], v3 offset:32768
v_mfma_f32_16x16x32_bf16 v[136:139], a[84:87], a[28:31], v[136:139]
ds_read_b128 a[40:43], v2 offset:34816
v_add_u32 v6, 0x8000, v6
v_mfma_f32_16x16x32_bf16 v[120:123], a[84:87], a[20:23], v[120:123]
s_xor_b32 m0, s84, 4096
ds_read_b128 a[44:47], v3 offset:34816
v_mfma_f32_16x16x32_bf16 v[120:123], a[80:83], a[16:19], v[120:123]
s_xor_b32 s64, s73, 1280
ds_read_b128 a[48:51], v2 offset:36864
v_mfma_f32_16x16x32_bf16 v[104:107], a[80:83], a[8:11], v[104:107]
buffer_load_dwordx4 v12, s[48:51], s64 offen lds
v_mfma_f32_16x16x32_bf16 v[104:107], a[84:87], a[12:15], v[104:107]
s_add_u32 s65, s79, 29696
ds_read_b128 a[52:55], v3 offset:36864
v_mfma_f32_16x16x32_bf16 v[88:91], a[84:87], a[4:7], v[88:91]
buffer_store_dwordx4 a[220:223], v16, s[44:47], s65 offen sc1
v_mfma_f32_16x16x32_bf16 v[88:91], a[80:83], a[0:3], v[88:91]
s_xor_b32 m0, s84, 5120
ds_read_b128 a[56:59], v2 offset:38912
v_mfma_f32_16x16x32_bf16 v[28:31], a[88:91], a[0:3], v[28:31]
s_xor_b32 s64, s73, 17664
ds_read_b128 a[60:63], v3 offset:38912
v_mfma_f32_16x16x32_bf16 v[28:31], a[92:95], a[4:7], v[28:31]
buffer_load_dwordx4 v13, s[48:51], s64 offen lds
v_mfma_f32_16x16x32_bf16 v[44:47], a[92:95], a[12:15], v[44:47]
ds_read_b64_tr_b16 a[72:73], v10 offset:32768
v_add_u32 v7, 0x8000, v7
v_mfma_f32_16x16x32_bf16 v[44:47], a[88:91], a[8:11], v[44:47]
ds_read_b64_tr_b16 a[74:75], v10 offset:33792
v_mfma_f32_16x16x32_bf16 v[60:63], a[88:91], a[16:19], v[60:63]
s_xor_b32 m0, s84, 6144
ds_read_b64_tr_b16 a[76:77], v10 offset:40960
v_mfma_f32_16x16x32_bf16 v[60:63], a[92:95], a[20:23], v[60:63]
s_xor_b32 s64, s73, 132352
ds_read_b64_tr_b16 a[78:79], v10 offset:41984
v_mfma_f32_16x16x32_bf16 v[76:79], a[92:95], a[28:31], v[76:79]
buffer_load_dwordx4 v12, s[48:51], s64 offen lds
v_mfma_f32_16x16x32_bf16 v[76:79], a[88:91], a[24:27], v[76:79]
ds_read_b64_tr_b16 a[80:81], v11 offset:32768
v_mfma_f32_16x16x32_bf16 v[140:143], a[96:99], a[24:27], v[140:143]
ds_read_b64_tr_b16 a[82:83], v11 offset:33792
v_mfma_f32_16x16x32_bf16 v[140:143], a[100:103], a[28:31], v[140:143]
s_xor_b32 m0, s84, 7168
ds_read_b64_tr_b16 a[84:85], v11 offset:40960
v_add_u32 v8, 0x8000, v8
v_mfma_f32_16x16x32_bf16 v[124:127], a[100:103], a[20:23], v[124:127]
s_xor_b32 s64, s73, 148736
ds_read_b64_tr_b16 a[86:87], v11 offset:41984
v_mfma_f32_16x16x32_bf16 v[124:127], a[96:99], a[16:19], v[124:127]
buffer_load_dwordx4 v13, s[48:51], s64 offen lds
v_mfma_f32_16x16x32_bf16 v[108:111], a[96:99], a[8:11], v[108:111]
v_mfma_f32_16x16x32_bf16 v[108:111], a[100:103], a[12:15], v[108:111]
v_mfma_f32_16x16x32_bf16 v[92:95], a[100:103], a[4:7], v[92:95]
v_add_u32 v9, 0x8000, v9
v_add_u32 v10, 0x8000, v10
v_mfma_f32_16x16x32_bf16 v[92:95], a[96:99], a[0:3], v[92:95]
v_add_u32 v11, 0x8000, v11
v_mfma_f32_16x16x32_bf16 v[32:35], a[104:107], a[0:3], v[32:35]
v_mfma_f32_16x16x32_bf16 v[32:35], a[108:111], a[4:7], v[32:35]
v_mfma_f32_16x16x32_bf16 v[48:51], a[108:111], a[12:15], v[48:51]
s_waitcnt lgkmcnt(0)
s_barrier
v_mfma_f32_16x16x32_bf16 v[48:51], a[104:107], a[8:11], v[48:51]
s_xor_b32 m0, s77, 98304
ds_read_b64_tr_b16 a[88:89], v19 offset:36864
v_mfma_f32_16x16x32_bf16 v[64:67], a[104:107], a[16:19], v[64:67]
s_xor_b32 s64, s71, 5767168
ds_read_b64_tr_b16 a[90:91], v19 offset:37120
v_mfma_f32_16x16x32_bf16 v[64:67], a[108:111], a[20:23], v[64:67]
buffer_load_dwordx4 v14, s[56:59], s64 offen lds
v_mfma_f32_16x16x32_bf16 v[80:83], a[108:111], a[28:31], v[80:83]
ds_read_b64_tr_b16 a[92:93], v19 offset:38912
v_mfma_f32_16x16x32_bf16 v[80:83], a[104:107], a[24:27], v[80:83]
ds_read_b64_tr_b16 a[94:95], v19 offset:39168
v_mfma_f32_16x16x32_bf16 v[144:147], a[112:115], a[24:27], v[144:147]
ds_read_b64_tr_b16 a[96:97], v20 offset:36864
v_mfma_f32_16x16x32_bf16 v[144:147], a[116:119], a[28:31], v[144:147]
ds_read_b64_tr_b16 a[98:99], v20 offset:37120
v_mfma_f32_16x16x32_bf16 v[128:131], a[116:119], a[20:23], v[128:131]
ds_read_b64_tr_b16 a[100:101], v20 offset:38912
v_mfma_f32_16x16x32_bf16 v[128:131], a[112:115], a[16:19], v[128:131]
ds_read_b64_tr_b16 a[102:103], v20 offset:39168
v_mfma_f32_16x16x32_bf16 v[112:115], a[112:115], a[8:11], v[112:115]
s_add_u32 m0, s78, 114688
ds_read_b64_tr_b16 a[104:105], v19 offset:40960
v_mfma_f32_16x16x32_bf16 v[112:115], a[116:119], a[12:15], v[112:115]
s_add_u32 s64, s75, 4325376
ds_read_b64_tr_b16 a[106:107], v19 offset:41216
v_mfma_f32_16x16x32_bf16 v[96:99], a[116:119], a[4:7], v[96:99]
buffer_load_dwordx4 v23, s[60:63], s64 offen lds
v_mfma_f32_16x16x32_bf16 v[96:99], a[112:115], a[0:3], v[96:99]
ds_read_b64_tr_b16 a[108:109], v19 offset:43008
v_mfma_f32_16x16x32_bf16 v[36:39], a[72:75], a[0:3], v[36:39]
ds_read_b64_tr_b16 a[110:111], v19 offset:43264
v_mfma_f32_16x16x32_bf16 v[36:39], a[76:79], a[4:7], v[36:39]
ds_read_b64_tr_b16 a[112:113], v20 offset:40960
v_mfma_f32_16x16x32_bf16 v[52:55], a[76:79], a[12:15], v[52:55]
ds_read_b64_tr_b16 a[114:115], v20 offset:41216
v_mfma_f32_16x16x32_bf16 v[52:55], a[72:75], a[8:11], v[52:55]
ds_read_b64_tr_b16 a[116:117], v20 offset:43008
v_mfma_f32_16x16x32_bf16 v[68:71], a[72:75], a[16:19], v[68:71]
ds_read_b64_tr_b16 a[118:119], v20 offset:43264
v_mfma_f32_16x16x32_bf16 v[68:71], a[76:79], a[20:23], v[68:71]
s_xor_b32 m0, s77, 99328
v_mfma_f32_16x16x32_bf16 v[84:87], a[76:79], a[28:31], v[84:87]
s_xor_b32 s64, s71, 5799936
v_mfma_f32_16x16x32_bf16 v[84:87], a[72:75], a[24:27], v[84:87]
buffer_load_dwordx4 v14, s[56:59], s64 offen lds
v_mfma_f32_16x16x32_bf16 v[148:151], a[80:83], a[24:27], v[148:151]
ds_read_b64_tr_b16 a[72:73], v19 offset:32768
v_mfma_f32_16x16x32_bf16 v[148:151], a[84:87], a[28:31], v[148:151]
ds_read_b64_tr_b16 a[74:75], v19 offset:33024
v_mfma_f32_16x16x32_bf16 v[132:135], a[84:87], a[20:23], v[132:135]
s_add_u32 s65, s79, 13312
ds_read_b64_tr_b16 a[76:77], v19 offset:34816
v_mfma_f32_16x16x32_bf16 v[132:135], a[80:83], a[16:19], v[132:135]
buffer_store_dwordx4 a[224:227], v16, s[44:47], s65 offen sc1
v_mfma_f32_16x16x32_bf16 v[116:119], a[80:83], a[8:11], v[116:119]
ds_read_b64_tr_b16 a[78:79], v19 offset:35072
v_mfma_f32_16x16x32_bf16 v[116:119], a[84:87], a[12:15], v[116:119]
v_mfma_f32_16x16x32_bf16 v[100:103], a[84:87], a[4:7], v[100:103]
s_add_u32 m0, s78, 118784
v_mfma_f32_16x16x32_bf16 v[100:103], a[80:83], a[0:3], v[100:103]
s_waitcnt lgkmcnt(4)
s_add_u32 s64, s75, 4327424
ds_read_b64_tr_b16 a[80:81], v20 offset:32768
v_mfma_f32_16x16x32_bf16 v[184:187], a[88:91], a[32:35], v[184:187]
buffer_load_dwordx4 v23, s[60:63], s64 offen lds
v_mfma_f32_16x16x32_bf16 v[184:187], a[92:95], a[36:39], v[184:187]
ds_read_b64_tr_b16 a[82:83], v20 offset:33024
v_mfma_f32_16x16x32_bf16 v[192:195], a[92:95], a[44:47], v[192:195]
ds_read_b64_tr_b16 a[84:85], v20 offset:34816
v_mfma_f32_16x16x32_bf16 v[192:195], a[88:91], a[40:43], v[192:195]
ds_read_b64_tr_b16 a[86:87], v20 offset:35072
v_mfma_f32_16x16x32_bf16 v[200:203], a[88:91], a[48:51], v[200:203]
v_mfma_f32_16x16x32_bf16 v[200:203], a[92:95], a[52:55], v[200:203]
v_mfma_f32_16x16x32_bf16 v[208:211], a[92:95], a[60:63], v[208:211]
v_mfma_f32_16x16x32_bf16 v[208:211], a[88:91], a[56:59], v[208:211]
ds_read_b64_tr_b16 a[88:89], v4 offset:32768
v_mfma_f32_16x16x32_bf16 v[212:215], a[96:99], a[56:59], v[212:215]
s_xor_b32 m0, s77, 100352
ds_read_b64_tr_b16 a[90:91], v4 offset:33792
v_mfma_f32_16x16x32_bf16 v[212:215], a[100:103], a[60:63], v[212:215]
s_xor_b32 s64, s71, 5832704
ds_read_b64_tr_b16 a[92:93], v4 offset:40960
v_mfma_f32_16x16x32_bf16 v[204:207], a[100:103], a[52:55], v[204:207]
buffer_load_dwordx4 v15, s[56:59], s64 offen lds
v_mfma_f32_16x16x32_bf16 v[204:207], a[96:99], a[48:51], v[204:207]
ds_read_b64_tr_b16 a[94:95], v4 offset:41984
v_mfma_f32_16x16x32_bf16 v[196:199], a[96:99], a[40:43], v[196:199]
v_mfma_f32_16x16x32_bf16 v[196:199], a[100:103], a[44:47], v[196:199]
v_mfma_f32_16x16x32_bf16 v[188:191], a[100:103], a[36:39], v[188:191]
v_mfma_f32_16x16x32_bf16 v[188:191], a[96:99], a[32:35], v[188:191]
ds_read_b64_tr_b16 a[96:97], v5 offset:32768
v_mfma_f32_16x16x32_bf16 v[216:219], a[32:35], a[104:107], v[216:219]
ds_read_b64_tr_b16 a[98:99], v5 offset:33792
v_mfma_f32_16x16x32_bf16 v[216:219], a[36:39], a[108:111], v[216:219]
s_add_u32 m0, s78, 122880
ds_read_b64_tr_b16 a[100:101], v5 offset:40960
v_mfma_f32_16x16x32_bf16 v[224:227], a[44:47], a[108:111], v[224:227]
s_add_u32 s64, s75, 4329472
ds_read_b64_tr_b16 a[102:103], v5 offset:41984
v_mfma_f32_16x16x32_bf16 v[224:227], a[40:43], a[104:107], v[224:227]
buffer_load_dwordx4 v23, s[60:63], s64 offen lds
v_mfma_f32_16x16x32_bf16 v[232:235], a[48:51], a[104:107], v[232:235]
v_mfma_f32_16x16x32_bf16 v[232:235], a[52:55], a[108:111], v[232:235]
v_mfma_f32_16x16x32_bf16 v[240:243], a[60:63], a[108:111], v[240:243]
v_mfma_f32_16x16x32_bf16 v[240:243], a[56:59], a[104:107], v[240:243]
ds_read_b64_tr_b16 a[104:105], v6 offset:32768
v_mfma_f32_16x16x32_bf16 v[244:247], a[56:59], a[112:115], v[244:247]
ds_read_b64_tr_b16 a[106:107], v6 offset:33792
v_mfma_f32_16x16x32_bf16 v[244:247], a[60:63], a[116:119], v[244:247]
ds_read_b64_tr_b16 a[108:109], v6 offset:40960
v_subrev_u32 v19, 0x8000, v19
v_mfma_f32_16x16x32_bf16 v[236:239], a[52:55], a[116:119], v[236:239]
s_xor_b32 m0, s77, 101376
ds_read_b64_tr_b16 a[110:111], v6 offset:41984
v_mfma_f32_16x16x32_bf16 v[236:239], a[48:51], a[112:115], v[236:239]
s_xor_b32 s64, s71, 5865472
v_mfma_f32_16x16x32_bf16 v[228:231], a[40:43], a[112:115], v[228:231]
buffer_load_dwordx4 v15, s[56:59], s64 offen lds
v_mfma_f32_16x16x32_bf16 v[228:231], a[44:47], a[116:119], v[228:231]
v_mfma_f32_16x16x32_bf16 v[220:223], a[36:39], a[116:119], v[220:223]
v_mfma_f32_16x16x32_bf16 v[220:223], a[32:35], a[112:115], v[220:223]
s_waitcnt lgkmcnt(4)
ds_read_b64_tr_b16 a[112:113], v7 offset:32768
v_mfma_f32_16x16x32_bf16 v[152:155], a[72:75], a[32:35], v[152:155]
ds_read_b64_tr_b16 a[114:115], v7 offset:33792
v_mfma_f32_16x16x32_bf16 v[152:155], a[76:79], a[36:39], v[152:155]
ds_read_b64_tr_b16 a[116:117], v7 offset:40960
v_subrev_u32 v20, 0x8000, v20
v_mfma_f32_16x16x32_bf16 v[160:163], a[76:79], a[44:47], v[160:163]
ds_read_b64_tr_b16 a[118:119], v7 offset:41984
v_mfma_f32_16x16x32_bf16 v[160:163], a[72:75], a[40:43], v[160:163]
v_mfma_f32_16x16x32_bf16 v[168:171], a[72:75], a[48:51], v[168:171]
v_mfma_f32_16x16x32_bf16 v[168:171], a[76:79], a[52:55], v[168:171]
v_mfma_f32_16x16x32_bf16 v[176:179], a[76:79], a[60:63], v[176:179]
s_xor_b32 m0, s84, 32768
s_add_u32 s65, s79, 30720
v_mfma_f32_16x16x32_bf16 v[176:179], a[72:75], a[56:59], v[176:179]
s_xor_b32 s64, s72, 1408
buffer_store_dwordx4 a[228:231], v16, s[44:47], s65 offen sc1
v_mfma_f32_16x16x32_bf16 v[180:183], a[80:83], a[56:59], v[180:183]
buffer_load_dwordx4 v12, s[48:51], s64 offen lds
v_mfma_f32_16x16x32_bf16 v[180:183], a[84:87], a[60:63], v[180:183]
ds_read_b64_tr_b16 a[72:73], v8 offset:32768
v_subrev_u32 v4, 0x8000, v4
v_mfma_f32_16x16x32_bf16 v[172:175], a[84:87], a[52:55], v[172:175]
ds_read_b64_tr_b16 a[74:75], v8 offset:33792
v_mfma_f32_16x16x32_bf16 v[172:175], a[80:83], a[48:51], v[172:175]
s_xor_b32 m0, s84, 33792
ds_read_b64_tr_b16 a[76:77], v8 offset:40960
v_mfma_f32_16x16x32_bf16 v[164:167], a[80:83], a[40:43], v[164:167]
s_xor_b32 s64, s72, 17792
ds_read_b64_tr_b16 a[78:79], v8 offset:41984
v_mfma_f32_16x16x32_bf16 v[164:167], a[84:87], a[44:47], v[164:167]
buffer_load_dwordx4 v13, s[48:51], s64 offen lds
v_mfma_f32_16x16x32_bf16 v[156:159], a[84:87], a[36:39], v[156:159]
v_mfma_f32_16x16x32_bf16 v[156:159], a[80:83], a[32:35], v[156:159]
ds_read_b64_tr_b16 a[80:81], v9 offset:32768
v_mfma_f32_16x16x32_bf16 v[24:27], a[88:91], a[32:35], v[24:27]
s_xor_b32 m0, s84, 34816
ds_read_b64_tr_b16 a[82:83], v9 offset:33792
v_mfma_f32_16x16x32_bf16 v[24:27], a[92:95], a[36:39], v[24:27]
s_xor_b32 s64, s72, 132480
ds_read_b64_tr_b16 a[84:85], v9 offset:40960
v_subrev_u32 v5, 0x8000, v5
v_mfma_f32_16x16x32_bf16 v[40:43], a[92:95], a[44:47], v[40:43]
buffer_load_dwordx4 v12, s[48:51], s64 offen lds
v_mfma_f32_16x16x32_bf16 v[40:43], a[88:91], a[40:43], v[40:43]
ds_read_b64_tr_b16 a[86:87], v9 offset:41984
v_mfma_f32_16x16x32_bf16 v[56:59], a[88:91], a[48:51], v[56:59]
v_mfma_f32_16x16x32_bf16 v[56:59], a[92:95], a[52:55], v[56:59]
s_xor_b32 m0, s84, 35840
v_mfma_f32_16x16x32_bf16 v[72:75], a[92:95], a[60:63], v[72:75]
s_waitcnt vmcnt(12)
s_xor_b32 s64, s72, 148864
ds_read_b128 a[0:3], v2 offset:0
v_mfma_f32_16x16x32_bf16 v[72:75], a[88:91], a[56:59], v[72:75]
buffer_load_dwordx4 v13, s[48:51], s64 offen lds
v_mfma_f32_16x16x32_bf16 v[136:139], a[96:99], a[56:59], v[136:139]
ds_read_b128 a[4:7], v3 offset:0
v_mfma_f32_16x16x32_bf16 v[136:139], a[100:103], a[60:63], v[136:139]
ds_read_b128 a[8:11], v2 offset:2048
v_subrev_u32 v6, 0x8000, v6
v_mfma_f32_16x16x32_bf16 v[120:123], a[100:103], a[52:55], v[120:123]
s_xor_b32 m0, s84, 36864
ds_read_b128 a[12:15], v3 offset:2048
v_mfma_f32_16x16x32_bf16 v[120:123], a[96:99], a[48:51], v[120:123]
s_xor_b32 s64, s73, 1408
ds_read_b128 a[16:19], v2 offset:4096
v_mfma_f32_16x16x32_bf16 v[104:107], a[96:99], a[40:43], v[104:107]
buffer_load_dwordx4 v12, s[48:51], s64 offen lds
v_mfma_f32_16x16x32_bf16 v[104:107], a[100:103], a[44:47], v[104:107]
ds_read_b128 a[20:23], v3 offset:4096
v_mfma_f32_16x16x32_bf16 v[88:91], a[100:103], a[36:39], v[88:91]
ds_read_b128 a[24:27], v2 offset:6144
v_mfma_f32_16x16x32_bf16 v[88:91], a[96:99], a[32:35], v[88:91]
s_waitcnt lgkmcnt(7)
s_xor_b32 m0, s84, 37888
ds_read_b128 a[28:31], v3 offset:6144
v_mfma_f32_16x16x32_bf16 v[28:31], a[104:107], a[32:35], v[28:31]
s_xor_b32 s64, s73, 17792
ds_read_b64_tr_b16 a[88:89], v10 offset:32768
v_mfma_f32_16x16x32_bf16 v[28:31], a[108:111], a[36:39], v[28:31]
buffer_load_dwordx4 v13, s[48:51], s64 offen lds
v_mfma_f32_16x16x32_bf16 v[44:47], a[108:111], a[44:47], v[44:47]
ds_read_b64_tr_b16 a[90:91], v10 offset:33792
v_subrev_u32 v7, 0x8000, v7
v_mfma_f32_16x16x32_bf16 v[44:47], a[104:107], a[40:43], v[44:47]
ds_read_b64_tr_b16 a[92:93], v10 offset:40960
v_mfma_f32_16x16x32_bf16 v[60:63], a[104:107], a[48:51], v[60:63]
s_xor_b32 m0, s84, 38912
ds_read_b64_tr_b16 a[94:95], v10 offset:41984
v_mfma_f32_16x16x32_bf16 v[60:63], a[108:111], a[52:55], v[60:63]
s_xor_b32 s64, s73, 132480
ds_read_b64_tr_b16 a[96:97], v11 offset:32768
v_mfma_f32_16x16x32_bf16 v[76:79], a[108:111], a[60:63], v[76:79]
buffer_load_dwordx4 v12, s[48:51], s64 offen lds
v_mfma_f32_16x16x32_bf16 v[76:79], a[104:107], a[56:59], v[76:79]
ds_read_b64_tr_b16 a[98:99], v11 offset:33792
v_mfma_f32_16x16x32_bf16 v[140:143], a[112:115], a[56:59], v[140:143]
s_xor_b32 m0, s84, 39936
ds_read_b64_tr_b16 a[100:101], v11 offset:40960
v_mfma_f32_16x16x32_bf16 v[140:143], a[116:119], a[60:63], v[140:143]
s_xor_b32 s64, s73, 148864
ds_read_b64_tr_b16 a[102:103], v11 offset:41984
v_subrev_u32 v8, 0x8000, v8
v_mfma_f32_16x16x32_bf16 v[124:127], a[116:119], a[52:55], v[124:127]
v_readfirstlane_b32 vcc_lo, v1
s_nop 0
s_cmp_lt_u32 vcc_lo, s81
s_cbranch_scc1 L_spin_1
L_spinbk_2:
v_mfma_f32_16x16x32_bf16 v[124:127], a[112:115], a[48:51], v[124:127]
buffer_load_dwordx4 v13, s[48:51], s64 offen lds
v_mfma_f32_16x16x32_bf16 v[108:111], a[112:115], a[40:43], v[108:111]
v_mfma_f32_16x16x32_bf16 v[108:111], a[116:119], a[44:47], v[108:111]
v_mfma_f32_16x16x32_bf16 v[92:95], a[116:119], a[36:39], v[92:95]
v_subrev_u32 v9, 0x8000, v9
v_subrev_u32 v10, 0x8000, v10
v_mfma_f32_16x16x32_bf16 v[92:95], a[112:115], a[32:35], v[92:95]
v_subrev_u32 v11, 0x8000, v11
v_mfma_f32_16x16x32_bf16 v[32:35], a[72:75], a[32:35], v[32:35]
s_add_u32 s52, s28, 59768832
s_addc_u32 s53, s29, 0
s_mov_b32 s54, 16384
v_mfma_f32_16x16x32_bf16 v[32:35], a[76:79], a[36:39], v[32:35]
v_mfma_f32_16x16x32_bf16 v[48:51], a[76:79], a[44:47], v[48:51]
s_waitcnt lgkmcnt(0)
s_barrier
v_mfma_f32_16x16x32_bf16 v[48:51], a[72:75], a[40:43], v[48:51]
s_xor_b32 m0, s77, 131072
s_add_u32 s65, s79, 31744
ds_read_b64_tr_b16 a[104:105], v19 offset:4096
v_mfma_f32_16x16x32_bf16 v[64:67], a[72:75], a[48:51], v[64:67]
s_xor_b32 s64, s71, 6291456
buffer_store_dwordx4 a[232:235], v16, s[44:47], s65 offen sc1
v_mfma_f32_16x16x32_bf16 v[64:67], a[76:79], a[52:55], v[64:67]
buffer_load_dwordx4 v14, s[56:59], s64 offen lds
v_mfma_f32_16x16x32_bf16 v[80:83], a[76:79], a[60:63], v[80:83]
ds_read_b64_tr_b16 a[106:107], v19 offset:4352
v_mfma_f32_16x16x32_bf16 v[80:83], a[72:75], a[56:59], v[80:83]
ds_read_b64_tr_b16 a[108:109], v19 offset:6144
v_mfma_f32_16x16x32_bf16 v[144:147], a[80:83], a[56:59], v[144:147]
ds_read_b64_tr_b16 a[110:111], v19 offset:6400
v_mfma_f32_16x16x32_bf16 v[144:147], a[84:87], a[60:63], v[144:147]
ds_read_b64_tr_b16 a[112:113], v20 offset:4096
v_mfma_f32_16x16x32_bf16 v[128:131], a[84:87], a[52:55], v[128:131]
ds_read_b64_tr_b16 a[114:115], v20 offset:4352
v_mfma_f32_16x16x32_bf16 v[128:131], a[80:83], a[48:51], v[128:131]
ds_read_b64_tr_b16 a[116:117], v20 offset:6144
v_mfma_f32_16x16x32_bf16 v[112:115], a[80:83], a[40:43], v[112:115]
s_add_u32 m0, s78, 147456
ds_read_b64_tr_b16 a[118:119], v20 offset:6400
v_mfma_f32_16x16x32_bf16 v[112:115], a[84:87], a[44:47], v[112:115]
s_add_u32 s64, s75, 4718592
ds_read_b64_tr_b16 a[72:73], v19 offset:8192
v_mfma_f32_16x16x32_bf16 v[96:99], a[84:87], a[36:39], v[96:99]
buffer_load_dwordx4 v23, s[60:63], s64 offen lds
v_mfma_f32_16x16x32_bf16 v[96:99], a[80:83], a[32:35], v[96:99]
ds_read_b64_tr_b16 a[74:75], v19 offset:8448
v_mfma_f32_16x16x32_bf16 v[36:39], a[88:91], a[32:35], v[36:39]
ds_read_b64_tr_b16 a[76:77], v19 offset:10240
v_mfma_f32_16x16x32_bf16 v[36:39], a[92:95], a[36:39], v[36:39]
ds_read_b64_tr_b16 a[78:79], v19 offset:10496
v_mfma_f32_16x16x32_bf16 v[52:55], a[92:95], a[44:47], v[52:55]
ds_read_b64_tr_b16 a[80:81], v20 offset:8192
v_mfma_f32_16x16x32_bf16 v[52:55], a[88:91], a[40:43], v[52:55]
ds_read_b64_tr_b16 a[82:83], v20 offset:8448
v_mfma_f32_16x16x32_bf16 v[68:71], a[88:91], a[48:51], v[68:71]
ds_read_b64_tr_b16 a[84:85], v20 offset:10240
v_mfma_f32_16x16x32_bf16 v[68:71], a[92:95], a[52:55], v[68:71]
s_xor_b32 m0, s77, 132096
ds_read_b64_tr_b16 a[86:87], v20 offset:10496
v_mfma_f32_16x16x32_bf16 v[84:87], a[92:95], a[60:63], v[84:87]
s_xor_b32 s64, s71, 6324224
v_mfma_f32_16x16x32_bf16 v[84:87], a[88:91], a[56:59], v[84:87]
buffer_load_dwordx4 v14, s[56:59], s64 offen lds
v_mfma_f32_16x16x32_bf16 v[148:151], a[96:99], a[56:59], v[148:151]
ds_read_b64_tr_b16 a[88:89], v19 offset:0
v_mfma_f32_16x16x32_bf16 v[148:151], a[100:103], a[60:63], v[148:151]
ds_read_b64_tr_b16 a[90:91], v19 offset:256
v_mfma_f32_16x16x32_bf16 v[132:135], a[100:103], a[52:55], v[132:135]
ds_read_b64_tr_b16 a[92:93], v19 offset:2048
v_mfma_f32_16x16x32_bf16 v[132:135], a[96:99], a[48:51], v[132:135]
ds_read_b64_tr_b16 a[94:95], v19 offset:2304
v_mfma_f32_16x16x32_bf16 v[116:119], a[96:99], a[40:43], v[116:119]
v_mfma_f32_16x16x32_bf16 v[116:119], a[100:103], a[44:47], v[116:119]
v_mfma_f32_16x16x32_bf16 v[100:103], a[100:103], a[36:39], v[100:103]
s_add_u32 m0, s78, 151552
v_mfma_f32_16x16x32_bf16 v[100:103], a[96:99], a[32:35], v[100:103]
s_waitcnt lgkmcnt(4)
s_add_u32 s64, s75, 4720640
ds_read_b64_tr_b16 a[96:97], v20 offset:0
v_mfma_f32_16x16x32_bf16 v[184:187], a[104:107], a[0:3], v[184:187]
buffer_load_dwordx4 v23, s[60:63], s64 offen lds
v_mfma_f32_16x16x32_bf16 v[184:187], a[108:111], a[4:7], v[184:187]
ds_read_b64_tr_b16 a[98:99], v20 offset:256
v_mfma_f32_16x16x32_bf16 v[192:195], a[108:111], a[12:15], v[192:195]
ds_read_b64_tr_b16 a[100:101], v20 offset:2048
v_mfma_f32_16x16x32_bf16 v[192:195], a[104:107], a[8:11], v[192:195]
ds_read_b64_tr_b16 a[102:103], v20 offset:2304
v_mfma_f32_16x16x32_bf16 v[200:203], a[104:107], a[16:19], v[200:203]
v_mfma_f32_16x16x32_bf16 v[200:203], a[108:111], a[20:23], v[200:203]
v_mfma_f32_16x16x32_bf16 v[208:211], a[108:111], a[28:31], v[208:211]
v_mfma_f32_16x16x32_bf16 v[208:211], a[104:107], a[24:27], v[208:211]
ds_read_b64_tr_b16 a[104:105], v4 offset:0
v_mfma_f32_16x16x32_bf16 v[212:215], a[112:115], a[24:27], v[212:215]
s_xor_b32 m0, s77, 133120
ds_read_b64_tr_b16 a[106:107], v4 offset:1024
v_mfma_f32_16x16x32_bf16 v[212:215], a[116:119], a[28:31], v[212:215]
s_xor_b32 s64, s71, 6356992
ds_read_b64_tr_b16 a[108:109], v4 offset:8192
v_mfma_f32_16x16x32_bf16 v[204:207], a[116:119], a[20:23], v[204:207]
buffer_load_dwordx4 v15, s[56:59], s64 offen lds
v_mfma_f32_16x16x32_bf16 v[204:207], a[112:115], a[16:19], v[204:207]
ds_read_b64_tr_b16 a[110:111], v4 offset:9216
v_mfma_f32_16x16x32_bf16 v[196:199], a[112:115], a[8:11], v[196:199]
v_mfma_f32_16x16x32_bf16 v[196:199], a[116:119], a[12:15], v[196:199]
v_mfma_f32_16x16x32_bf16 v[188:191], a[116:119], a[4:7], v[188:191]
v_mfma_f32_16x16x32_bf16 v[188:191], a[112:115], a[0:3], v[188:191]
ds_read_b64_tr_b16 a[112:113], v5 offset:0
v_mfma_f32_16x16x32_bf16 v[216:219], a[0:3], a[72:75], v[216:219]
s_add_u32 s65, s79, 15360
ds_read_b64_tr_b16 a[114:115], v5 offset:1024
v_mfma_f32_16x16x32_bf16 v[216:219], a[4:7], a[76:79], v[216:219]
s_add_u32 m0, s78, 155648
buffer_store_dwordx4 a[236:239], v16, s[44:47], s65 offen sc1
v_mfma_f32_16x16x32_bf16 v[224:227], a[12:15], a[76:79], v[224:227]
s_add_u32 s64, s75, 4722688
ds_read_b64_tr_b16 a[116:117], v5 offset:8192
v_mfma_f32_16x16x32_bf16 v[224:227], a[8:11], a[72:75], v[224:227]
buffer_load_dwordx4 v23, s[60:63], s64 offen lds
v_mfma_f32_16x16x32_bf16 v[232:235], a[16:19], a[72:75], v[232:235]
s_branch L_po11
L_pg11:
s_branch L_tr1
L_po11:
ds_read_b64_tr_b16 a[118:119], v5 offset:9216
v_mfma_f32_16x16x32_bf16 v[232:235], a[20:23], a[76:79], v[232:235]
v_mfma_f32_16x16x32_bf16 v[240:243], a[28:31], a[76:79], v[240:243]
v_mfma_f32_16x16x32_bf16 v[240:243], a[24:27], a[72:75], v[240:243]
ds_read_b64_tr_b16 a[72:73], v6 offset:0
v_mfma_f32_16x16x32_bf16 v[244:247], a[24:27], a[80:83], v[244:247]
ds_read_b64_tr_b16 a[74:75], v6 offset:1024
v_mfma_f32_16x16x32_bf16 v[244:247], a[28:31], a[84:87], v[244:247]
ds_read_b64_tr_b16 a[76:77], v6 offset:8192
v_mfma_f32_16x16x32_bf16 v[236:239], a[20:23], a[84:87], v[236:239]
s_xor_b32 m0, s77, 134144
ds_read_b64_tr_b16 a[78:79], v6 offset:9216
v_mfma_f32_16x16x32_bf16 v[236:239], a[16:19], a[80:83], v[236:239]
s_xor_b32 s64, s71, 6389760
v_mfma_f32_16x16x32_bf16 v[228:231], a[8:11], a[80:83], v[228:231]
buffer_load_dwordx4 v15, s[56:59], s64 offen lds
v_mfma_f32_16x16x32_bf16 v[228:231], a[12:15], a[84:87], v[228:231]
v_mfma_f32_16x16x32_bf16 v[220:223], a[4:7], a[84:87], v[220:223]
v_mfma_f32_16x16x32_bf16 v[220:223], a[0:3], a[80:83], v[220:223]
s_waitcnt lgkmcnt(4)
ds_read_b64_tr_b16 a[80:81], v7 offset:0
v_mfma_f32_16x16x32_bf16 v[152:155], a[88:91], a[0:3], v[152:155]
ds_read_b64_tr_b16 a[82:83], v7 offset:1024
v_mfma_f32_16x16x32_bf16 v[152:155], a[92:95], a[4:7], v[152:155]
ds_read_b64_tr_b16 a[84:85], v7 offset:8192
v_mfma_f32_16x16x32_bf16 v[160:163], a[92:95], a[12:15], v[160:163]
ds_read_b64_tr_b16 a[86:87], v7 offset:9216
v_mfma_f32_16x16x32_bf16 v[160:163], a[88:91], a[8:11], v[160:163]
v_mfma_f32_16x16x32_bf16 v[168:171], a[88:91], a[16:19], v[168:171]
v_mfma_f32_16x16x32_bf16 v[168:171], a[92:95], a[20:23], v[168:171]
v_mfma_f32_16x16x32_bf16 v[176:179], a[92:95], a[28:31], v[176:179]
s_xor_b32 m0, s84, 0
v_mfma_f32_16x16x32_bf16 v[176:179], a[88:91], a[24:27], v[176:179]
s_xor_b32 s64, s72, 1536
ds_read_b64_tr_b16 a[88:89], v8 offset:0
v_mfma_f32_16x16x32_bf16 v[180:183], a[96:99], a[24:27], v[180:183]
buffer_load_dwordx4 v12, s[48:51], s64 offen lds
v_mfma_f32_16x16x32_bf16 v[180:183], a[100:103], a[28:31], v[180:183]
ds_read_b64_tr_b16 a[90:91], v8 offset:1024
v_mfma_f32_16x16x32_bf16 v[172:175], a[100:103], a[20:23], v[172:175]
ds_read_b64_tr_b16 a[92:93], v8 offset:8192
v_mfma_f32_16x16x32_bf16 v[172:175], a[96:99], a[16:19], v[172:175]
s_xor_b32 m0, s84, 1024
ds_read_b64_tr_b16 a[94:95], v8 offset:9216
v_mfma_f32_16x16x32_bf16 v[164:167], a[96:99], a[8:11], v[164:167]
s_xor_b32 s64, s72, 17920
v_mfma_f32_16x16x32_bf16 v[164:167], a[100:103], a[12:15], v[164:167]
buffer_load_dwordx4 v13, s[48:51], s64 offen lds
v_mfma_f32_16x16x32_bf16 v[156:159], a[100:103], a[4:7], v[156:159]
v_mfma_f32_16x16x32_bf16 v[156:159], a[96:99], a[0:3], v[156:159]
ds_read_b64_tr_b16 a[96:97], v9 offset:0
v_mfma_f32_16x16x32_bf16 v[24:27], a[104:107], a[0:3], v[24:27]
s_xor_b32 m0, s84, 2048
ds_read_b64_tr_b16 a[98:99], v9 offset:1024
v_mfma_f32_16x16x32_bf16 v[24:27], a[108:111], a[4:7], v[24:27]
s_xor_b32 s64, s72, 132608
ds_read_b64_tr_b16 a[100:101], v9 offset:8192
v_mfma_f32_16x16x32_bf16 v[40:43], a[108:111], a[12:15], v[40:43]
buffer_load_dwordx4 v12, s[48:51], s64 offen lds
v_mfma_f32_16x16x32_bf16 v[40:43], a[104:107], a[8:11], v[40:43]
ds_read_b64_tr_b16 a[102:103], v9 offset:9216
v_mfma_f32_16x16x32_bf16 v[56:59], a[104:107], a[16:19], v[56:59]
v_mfma_f32_16x16x32_bf16 v[56:59], a[108:111], a[20:23], v[56:59]
s_xor_b32 m0, s84, 3072
v_mfma_f32_16x16x32_bf16 v[72:75], a[108:111], a[28:31], v[72:75]
s_waitcnt vmcnt(12)
s_xor_b32 s64, s72, 148992
ds_read_b128 a[32:35], v2 offset:32768
v_mfma_f32_16x16x32_bf16 v[72:75], a[104:107], a[24:27], v[72:75]
buffer_load_dwordx4 v13, s[48:51], s64 offen lds
v_mfma_f32_16x16x32_bf16 v[136:139], a[112:115], a[24:27], v[136:139]
ds_read_b128 a[36:39], v3 offset:32768
v_mfma_f32_16x16x32_bf16 v[136:139], a[116:119], a[28:31], v[136:139]
ds_read_b128 a[40:43], v2 offset:34816
v_mfma_f32_16x16x32_bf16 v[120:123], a[116:119], a[20:23], v[120:123]
s_xor_b32 m0, s84, 4096
ds_read_b128 a[44:47], v3 offset:34816
v_mfma_f32_16x16x32_bf16 v[120:123], a[112:115], a[16:19], v[120:123]
s_xor_b32 s64, s73, 1536
ds_read_b128 a[48:51], v2 offset:36864
v_mfma_f32_16x16x32_bf16 v[104:107], a[112:115], a[8:11], v[104:107]
buffer_load_dwordx4 v12, s[48:51], s64 offen lds
v_mfma_f32_16x16x32_bf16 v[104:107], a[116:119], a[12:15], v[104:107]
ds_read_b128 a[52:55], v3 offset:36864
v_mfma_f32_16x16x32_bf16 v[88:91], a[116:119], a[4:7], v[88:91]
buffer_store_dwordx4 a[240:243], v16, s[44:47], s74 offen sc1
v_mfma_f32_16x16x32_bf16 v[88:91], a[112:115], a[0:3], v[88:91]
s_waitcnt lgkmcnt(6)
s_xor_b32 m0, s84, 5120
ds_read_b128 a[56:59], v2 offset:38912
v_mfma_f32_16x16x32_bf16 v[28:31], a[72:75], a[0:3], v[28:31]
s_xor_b32 s64, s73, 17920
ds_read_b128 a[60:63], v3 offset:38912
v_mfma_f32_16x16x32_bf16 v[28:31], a[76:79], a[4:7], v[28:31]
buffer_load_dwordx4 v13, s[48:51], s64 offen lds
v_mfma_f32_16x16x32_bf16 v[44:47], a[76:79], a[12:15], v[44:47]
ds_read_b64_tr_b16 a[104:105], v10 offset:0
v_mfma_f32_16x16x32_bf16 v[44:47], a[72:75], a[8:11], v[44:47]
ds_read_b64_tr_b16 a[106:107], v10 offset:1024
v_mfma_f32_16x16x32_bf16 v[60:63], a[72:75], a[16:19], v[60:63]
s_xor_b32 m0, s84, 6144
ds_read_b64_tr_b16 a[108:109], v10 offset:8192
v_mfma_f32_16x16x32_bf16 v[60:63], a[76:79], a[20:23], v[60:63]
s_xor_b32 s64, s73, 132608
ds_read_b64_tr_b16 a[110:111], v10 offset:9216
v_mfma_f32_16x16x32_bf16 v[76:79], a[76:79], a[28:31], v[76:79]
buffer_load_dwordx4 v12, s[48:51], s64 offen lds
v_mfma_f32_16x16x32_bf16 v[76:79], a[72:75], a[24:27], v[76:79]
ds_read_b64_tr_b16 a[112:113], v11 offset:0
v_mfma_f32_16x16x32_bf16 v[140:143], a[80:83], a[24:27], v[140:143]
ds_read_b64_tr_b16 a[114:115], v11 offset:1024
v_mfma_f32_16x16x32_bf16 v[140:143], a[84:87], a[28:31], v[140:143]
s_xor_b32 m0, s84, 7168
ds_read_b64_tr_b16 a[116:117], v11 offset:8192
v_mfma_f32_16x16x32_bf16 v[124:127], a[84:87], a[20:23], v[124:127]
s_xor_b32 s64, s73, 148992
ds_read_b64_tr_b16 a[118:119], v11 offset:9216
v_mfma_f32_16x16x32_bf16 v[124:127], a[80:83], a[16:19], v[124:127]
buffer_load_dwordx4 v13, s[48:51], s64 offen lds
v_mfma_f32_16x16x32_bf16 v[108:111], a[80:83], a[8:11], v[108:111]
v_mfma_f32_16x16x32_bf16 v[108:111], a[84:87], a[12:15], v[108:111]
v_mfma_f32_16x16x32_bf16 v[92:95], a[84:87], a[4:7], v[92:95]
v_mfma_f32_16x16x32_bf16 v[92:95], a[80:83], a[0:3], v[92:95]
v_mfma_f32_16x16x32_bf16 v[32:35], a[88:91], a[0:3], v[32:35]
v_mfma_f32_16x16x32_bf16 v[32:35], a[92:95], a[4:7], v[32:35]
v_mfma_f32_16x16x32_bf16 v[48:51], a[92:95], a[12:15], v[48:51]
s_waitcnt lgkmcnt(0)
s_barrier
v_mfma_f32_16x16x32_bf16 v[48:51], a[88:91], a[8:11], v[48:51]
s_xor_b32 m0, s77, 65536
ds_read_b64_tr_b16 a[72:73], v19 offset:36864
v_mfma_f32_16x16x32_bf16 v[64:67], a[88:91], a[16:19], v[64:67]
s_xor_b32 s64, s71, 6815744
ds_read_b64_tr_b16 a[74:75], v19 offset:37120
v_mfma_f32_16x16x32_bf16 v[64:67], a[92:95], a[20:23], v[64:67]
buffer_load_dwordx4 v14, s[56:59], s64 offen lds
v_mfma_f32_16x16x32_bf16 v[80:83], a[92:95], a[28:31], v[80:83]
ds_read_b64_tr_b16 a[76:77], v19 offset:38912
v_mfma_f32_16x16x32_bf16 v[80:83], a[88:91], a[24:27], v[80:83]
ds_read_b64_tr_b16 a[78:79], v19 offset:39168
v_mfma_f32_16x16x32_bf16 v[144:147], a[96:99], a[24:27], v[144:147]
ds_read_b64_tr_b16 a[80:81], v20 offset:36864
v_mfma_f32_16x16x32_bf16 v[144:147], a[100:103], a[28:31], v[144:147]
ds_read_b64_tr_b16 a[82:83], v20 offset:37120
v_mfma_f32_16x16x32_bf16 v[128:131], a[100:103], a[20:23], v[128:131]
ds_read_b64_tr_b16 a[84:85], v20 offset:38912
v_mfma_f32_16x16x32_bf16 v[128:131], a[96:99], a[16:19], v[128:131]
ds_read_b64_tr_b16 a[86:87], v20 offset:39168
v_mfma_f32_16x16x32_bf16 v[112:115], a[96:99], a[8:11], v[112:115]
s_add_u32 m0, s78, 81920
ds_read_b64_tr_b16 a[88:89], v19 offset:40960
v_mfma_f32_16x16x32_bf16 v[112:115], a[100:103], a[12:15], v[112:115]
s_add_u32 s64, s75, 5111808
ds_read_b64_tr_b16 a[90:91], v19 offset:41216
v_mfma_f32_16x16x32_bf16 v[96:99], a[100:103], a[4:7], v[96:99]
buffer_load_dwordx4 v23, s[60:63], s64 offen lds
v_mfma_f32_16x16x32_bf16 v[96:99], a[96:99], a[0:3], v[96:99]
ds_read_b64_tr_b16 a[92:93], v19 offset:43008
v_mfma_f32_16x16x32_bf16 v[36:39], a[104:107], a[0:3], v[36:39]
ds_read_b64_tr_b16 a[94:95], v19 offset:43264
v_mfma_f32_16x16x32_bf16 v[36:39], a[108:111], a[4:7], v[36:39]
ds_read_b64_tr_b16 a[96:97], v20 offset:40960
v_mfma_f32_16x16x32_bf16 v[52:55], a[108:111], a[12:15], v[52:55]
ds_read_b64_tr_b16 a[98:99], v20 offset:41216
v_mfma_f32_16x16x32_bf16 v[52:55], a[104:107], a[8:11], v[52:55]
ds_read_b64_tr_b16 a[100:101], v20 offset:43008
v_mfma_f32_16x16x32_bf16 v[68:71], a[104:107], a[16:19], v[68:71]
ds_read_b64_tr_b16 a[102:103], v20 offset:43264
v_mfma_f32_16x16x32_bf16 v[68:71], a[108:111], a[20:23], v[68:71]
s_xor_b32 m0, s77, 66560
v_mfma_f32_16x16x32_bf16 v[84:87], a[108:111], a[28:31], v[84:87]
s_xor_b32 s64, s71, 6848512
v_mfma_f32_16x16x32_bf16 v[84:87], a[104:107], a[24:27], v[84:87]
buffer_load_dwordx4 v14, s[56:59], s64 offen lds
v_mfma_f32_16x16x32_bf16 v[148:151], a[112:115], a[24:27], v[148:151]
ds_read_b64_tr_b16 a[104:105], v19 offset:32768
v_mfma_f32_16x16x32_bf16 v[148:151], a[116:119], a[28:31], v[148:151]
ds_read_b64_tr_b16 a[106:107], v19 offset:33024
v_mfma_f32_16x16x32_bf16 v[132:135], a[116:119], a[20:23], v[132:135]
ds_read_b64_tr_b16 a[108:109], v19 offset:34816
v_mfma_f32_16x16x32_bf16 v[132:135], a[112:115], a[16:19], v[132:135]
ds_read_b64_tr_b16 a[110:111], v19 offset:35072
v_mfma_f32_16x16x32_bf16 v[116:119], a[112:115], a[8:11], v[116:119]
v_mfma_f32_16x16x32_bf16 v[116:119], a[116:119], a[12:15], v[116:119]
v_mfma_f32_16x16x32_bf16 v[100:103], a[116:119], a[4:7], v[100:103]
s_add_u32 m0, s78, 86016
v_mfma_f32_16x16x32_bf16 v[100:103], a[112:115], a[0:3], v[100:103]
s_waitcnt lgkmcnt(4)
s_add_u32 s64, s75, 5113856
ds_read_b64_tr_b16 a[112:113], v20 offset:32768
v_mfma_f32_16x16x32_bf16 v[184:187], a[72:75], a[32:35], v[184:187]
s_lshl_b32 s66, s30, 30
buffer_load_dwordx4 v23, s[60:63], s64 offen lds
v_mfma_f32_16x16x32_bf16 v[184:187], a[76:79], a[36:39], v[184:187]
ds_read_b64_tr_b16 a[114:115], v20 offset:33024
v_lshl_add_u32 v1, v0, 24, s66
v_mfma_f32_16x16x32_bf16 v[192:195], a[76:79], a[44:47], v[192:195]
s_lshl_b32 s70, s31, 8
ds_read_b64_tr_b16 a[116:117], v20 offset:34816
v_mfma_f32_16x16x32_bf16 v[192:195], a[72:75], a[40:43], v[192:195]
ds_read_b64_tr_b16 a[118:119], v20 offset:35072
v_mfma_f32_16x16x32_bf16 v[200:203], a[72:75], a[48:51], v[200:203]
v_mfma_f32_16x16x32_bf16 v[200:203], a[76:79], a[52:55], v[200:203]
v_mfma_f32_16x16x32_bf16 v[208:211], a[76:79], a[60:63], v[208:211]
v_mfma_f32_16x16x32_bf16 v[208:211], a[72:75], a[56:59], v[208:211]
ds_read_b64_tr_b16 a[72:73], v4 offset:32768
v_mfma_f32_16x16x32_bf16 v[212:215], a[80:83], a[56:59], v[212:215]
s_xor_b32 m0, s77, 67584
ds_read_b64_tr_b16 a[74:75], v4 offset:33792
v_mfma_f32_16x16x32_bf16 v[212:215], a[84:87], a[60:63], v[212:215]
s_xor_b32 s64, s71, 6881280
ds_read_b64_tr_b16 a[76:77], v4 offset:40960
v_mfma_f32_16x16x32_bf16 v[204:207], a[84:87], a[52:55], v[204:207]
buffer_load_dwordx4 v15, s[56:59], s64 offen lds
v_mfma_f32_16x16x32_bf16 v[204:207], a[80:83], a[48:51], v[204:207]
ds_read_b64_tr_b16 a[78:79], v4 offset:41984
v_mfma_f32_16x16x32_bf16 v[196:199], a[80:83], a[40:43], v[196:199]
v_mfma_f32_16x16x32_bf16 v[196:199], a[84:87], a[44:47], v[196:199]
v_mfma_f32_16x16x32_bf16 v[188:191], a[84:87], a[36:39], v[188:191]
v_mfma_f32_16x16x32_bf16 v[188:191], a[80:83], a[32:35], v[188:191]
ds_read_b64_tr_b16 a[80:81], v5 offset:32768
v_mfma_f32_16x16x32_bf16 v[216:219], a[32:35], a[88:91], v[216:219]
ds_read_b64_tr_b16 a[82:83], v5 offset:33792
v_mfma_f32_16x16x32_bf16 v[216:219], a[36:39], a[92:95], v[216:219]
s_add_u32 m0, s78, 90112
ds_read_b64_tr_b16 a[84:85], v5 offset:40960
v_mfma_f32_16x16x32_bf16 v[224:227], a[44:47], a[92:95], v[224:227]
s_add_u32 s64, s75, 5115904
ds_read_b64_tr_b16 a[86:87], v5 offset:41984
v_mfma_f32_16x16x32_bf16 v[224:227], a[40:43], a[88:91], v[224:227]
buffer_load_dwordx4 v23, s[60:63], s64 offen lds
v_mfma_f32_16x16x32_bf16 v[232:235], a[48:51], a[88:91], v[232:235]
v_mfma_f32_16x16x32_bf16 v[232:235], a[52:55], a[92:95], v[232:235]
v_mfma_f32_16x16x32_bf16 v[240:243], a[60:63], a[92:95], v[240:243]
v_mfma_f32_16x16x32_bf16 v[240:243], a[56:59], a[88:91], v[240:243]
ds_read_b64_tr_b16 a[88:89], v6 offset:32768
v_mfma_f32_16x16x32_bf16 v[244:247], a[56:59], a[96:99], v[244:247]
ds_read_b64_tr_b16 a[90:91], v6 offset:33792
v_mfma_f32_16x16x32_bf16 v[244:247], a[60:63], a[100:103], v[244:247]
ds_read_b64_tr_b16 a[92:93], v6 offset:40960
v_add_u32 v19, 0x8000, v19
v_mfma_f32_16x16x32_bf16 v[236:239], a[52:55], a[100:103], v[236:239]
s_xor_b32 m0, s77, 68608
ds_read_b64_tr_b16 a[94:95], v6 offset:41984
v_mfma_f32_16x16x32_bf16 v[236:239], a[48:51], a[96:99], v[236:239]
s_xor_b32 s64, s71, 6914048
v_mfma_f32_16x16x32_bf16 v[228:231], a[40:43], a[96:99], v[228:231]
buffer_load_dwordx4 v15, s[56:59], s64 offen lds
v_mfma_f32_16x16x32_bf16 v[228:231], a[44:47], a[100:103], v[228:231]
v_mfma_f32_16x16x32_bf16 v[220:223], a[36:39], a[100:103], v[220:223]
v_mfma_f32_16x16x32_bf16 v[220:223], a[32:35], a[96:99], v[220:223]
s_waitcnt lgkmcnt(4)
ds_read_b64_tr_b16 a[96:97], v7 offset:32768
v_mfma_f32_16x16x32_bf16 v[152:155], a[104:107], a[32:35], v[152:155]
ds_read_b64_tr_b16 a[98:99], v7 offset:33792
v_mfma_f32_16x16x32_bf16 v[152:155], a[108:111], a[36:39], v[152:155]
ds_read_b64_tr_b16 a[100:101], v7 offset:40960
v_add_u32 v20, 0x8000, v20
v_mfma_f32_16x16x32_bf16 v[160:163], a[108:111], a[44:47], v[160:163]
ds_read_b64_tr_b16 a[102:103], v7 offset:41984
v_mfma_f32_16x16x32_bf16 v[160:163], a[104:107], a[40:43], v[160:163]
v_mfma_f32_16x16x32_bf16 v[168:171], a[104:107], a[48:51], v[168:171]
v_mfma_f32_16x16x32_bf16 v[168:171], a[108:111], a[52:55], v[168:171]
v_mfma_f32_16x16x32_bf16 v[176:179], a[108:111], a[60:63], v[176:179]
s_xor_b32 m0, s84, 32768
v_mfma_f32_16x16x32_bf16 v[176:179], a[104:107], a[56:59], v[176:179]
s_xor_b32 s64, s72, 1664
ds_read_b64_tr_b16 a[104:105], v8 offset:32768
v_mfma_f32_16x16x32_bf16 v[180:183], a[112:115], a[56:59], v[180:183]
buffer_load_dwordx4 v12, s[48:51], s64 offen lds
v_mfma_f32_16x16x32_bf16 v[180:183], a[116:119], a[60:63], v[180:183]
ds_read_b64_tr_b16 a[106:107], v8 offset:33792
v_add_u32 v4, 0x8000, v4
v_mfma_f32_16x16x32_bf16 v[172:175], a[116:119], a[52:55], v[172:175]
ds_read_b64_tr_b16 a[108:109], v8 offset:40960
v_mfma_f32_16x16x32_bf16 v[172:175], a[112:115], a[48:51], v[172:175]
s_xor_b32 m0, s84, 33792
ds_read_b64_tr_b16 a[110:111], v8 offset:41984
v_mfma_f32_16x16x32_bf16 v[164:167], a[112:115], a[40:43], v[164:167]
s_xor_b32 s64, s72, 18048
v_mfma_f32_16x16x32_bf16 v[164:167], a[116:119], a[44:47], v[164:167]
buffer_load_dwordx4 v13, s[48:51], s64 offen lds
v_mfma_f32_16x16x32_bf16 v[156:159], a[116:119], a[36:39], v[156:159]
v_mfma_f32_16x16x32_bf16 v[156:159], a[112:115], a[32:35], v[156:159]
ds_read_b64_tr_b16 a[112:113], v9 offset:32768
v_mfma_f32_16x16x32_bf16 v[24:27], a[72:75], a[32:35], v[24:27]
s_xor_b32 m0, s84, 34816
ds_read_b64_tr_b16 a[114:115], v9 offset:33792
v_mfma_f32_16x16x32_bf16 v[24:27], a[76:79], a[36:39], v[24:27]
s_xor_b32 s64, s72, 132736
ds_read_b64_tr_b16 a[116:117], v9 offset:40960
v_add_u32 v5, 0x8000, v5
v_mfma_f32_16x16x32_bf16 v[40:43], a[76:79], a[44:47], v[40:43]
buffer_load_dwordx4 v12, s[48:51], s64 offen lds
v_mfma_f32_16x16x32_bf16 v[40:43], a[72:75], a[40:43], v[40:43]
ds_read_b64_tr_b16 a[118:119], v9 offset:41984
v_mfma_f32_16x16x32_bf16 v[56:59], a[72:75], a[48:51], v[56:59]
v_mfma_f32_16x16x32_bf16 v[56:59], a[76:79], a[52:55], v[56:59]
s_xor_b32 m0, s84, 35840
v_mfma_f32_16x16x32_bf16 v[72:75], a[76:79], a[60:63], v[72:75]
s_waitcnt vmcnt(10)
s_xor_b32 s64, s72, 149120
ds_read_b128 a[0:3], v2 offset:0
v_mfma_f32_16x16x32_bf16 v[72:75], a[72:75], a[56:59], v[72:75]
buffer_load_dwordx4 v13, s[48:51], s64 offen lds
v_mfma_f32_16x16x32_bf16 v[136:139], a[80:83], a[56:59], v[136:139]
ds_read_b128 a[4:7], v3 offset:0
v_mfma_f32_16x16x32_bf16 v[136:139], a[84:87], a[60:63], v[136:139]
ds_read_b128 a[8:11], v2 offset:2048
v_add_u32 v6, 0x8000, v6
v_mfma_f32_16x16x32_bf16 v[120:123], a[84:87], a[52:55], v[120:123]
s_xor_b32 m0, s84, 36864
ds_read_b128 a[12:15], v3 offset:2048
v_mfma_f32_16x16x32_bf16 v[120:123], a[80:83], a[48:51], v[120:123]
s_xor_b32 s64, s73, 1664
ds_read_b128 a[16:19], v2 offset:4096
v_mfma_f32_16x16x32_bf16 v[104:107], a[80:83], a[40:43], v[104:107]
buffer_load_dwordx4 v12, s[48:51], s64 offen lds
v_mfma_f32_16x16x32_bf16 v[104:107], a[84:87], a[44:47], v[104:107]
ds_read_b128 a[20:23], v3 offset:4096
v_mfma_f32_16x16x32_bf16 v[88:91], a[84:87], a[36:39], v[88:91]
ds_read_b128 a[24:27], v2 offset:6144
v_mfma_f32_16x16x32_bf16 v[88:91], a[80:83], a[32:35], v[88:91]
s_waitcnt lgkmcnt(7)
s_xor_b32 m0, s84, 37888
ds_read_b128 a[28:31], v3 offset:6144
v_mfma_f32_16x16x32_bf16 v[28:31], a[88:91], a[32:35], v[28:31]
s_xor_b32 s64, s73, 18048
ds_read_b64_tr_b16 a[72:73], v10 offset:32768
v_mfma_f32_16x16x32_bf16 v[28:31], a[92:95], a[36:39], v[28:31]
buffer_load_dwordx4 v13, s[48:51], s64 offen lds
v_mfma_f32_16x16x32_bf16 v[44:47], a[92:95], a[44:47], v[44:47]
ds_read_b64_tr_b16 a[74:75], v10 offset:33792
v_add_u32 v7, 0x8000, v7
v_mfma_f32_16x16x32_bf16 v[44:47], a[88:91], a[40:43], v[44:47]
ds_read_b64_tr_b16 a[76:77], v10 offset:40960
v_mfma_f32_16x16x32_bf16 v[60:63], a[88:91], a[48:51], v[60:63]
s_xor_b32 m0, s84, 38912
ds_read_b64_tr_b16 a[78:79], v10 offset:41984
v_mfma_f32_16x16x32_bf16 v[60:63], a[92:95], a[52:55], v[60:63]
s_xor_b32 s64, s73, 132736
ds_read_b64_tr_b16 a[80:81], v11 offset:32768
v_mfma_f32_16x16x32_bf16 v[76:79], a[92:95], a[60:63], v[76:79]
buffer_load_dwordx4 v12, s[48:51], s64 offen lds
v_mfma_f32_16x16x32_bf16 v[76:79], a[88:91], a[56:59], v[76:79]
ds_read_b64_tr_b16 a[82:83], v11 offset:33792
v_mfma_f32_16x16x32_bf16 v[140:143], a[96:99], a[56:59], v[140:143]
ds_read_b64_tr_b16 a[84:85], v11 offset:40960
v_mfma_f32_16x16x32_bf16 v[140:143], a[100:103], a[60:63], v[140:143]
s_xor_b32 m0, s84, 39936
ds_read_b64_tr_b16 a[86:87], v11 offset:41984
v_add_u32 v8, 0x8000, v8
v_mfma_f32_16x16x32_bf16 v[124:127], a[100:103], a[52:55], v[124:127]
s_xor_b32 s64, s73, 149120
v_mfma_f32_16x16x32_bf16 v[124:127], a[96:99], a[48:51], v[124:127]
buffer_load_dwordx4 v13, s[48:51], s64 offen lds
v_mfma_f32_16x16x32_bf16 v[108:111], a[96:99], a[40:43], v[108:111]
v_mfma_f32_16x16x32_bf16 v[108:111], a[100:103], a[44:47], v[108:111]
v_mfma_f32_16x16x32_bf16 v[92:95], a[100:103], a[36:39], v[92:95]
v_add_u32 v9, 0x8000, v9
v_add_u32 v10, 0x8000, v10
v_mfma_f32_16x16x32_bf16 v[92:95], a[96:99], a[32:35], v[92:95]
v_add_u32 v11, 0x8000, v11
v_mfma_f32_16x16x32_bf16 v[32:35], a[104:107], a[32:35], v[32:35]
v_mfma_f32_16x16x32_bf16 v[32:35], a[108:111], a[36:39], v[32:35]
v_mfma_f32_16x16x32_bf16 v[48:51], a[108:111], a[44:47], v[48:51]
s_waitcnt lgkmcnt(0)
s_barrier
v_mfma_f32_16x16x32_bf16 v[48:51], a[104:107], a[40:43], v[48:51]
s_mov_b64 exec, 1
buffer_atomic_add a251, v1, s[52:55], s70 offen offset:0 sc1
s_mov_b64 exec, -1
s_xor_b32 m0, s77, 98304
v_mfma_f32_16x16x32_bf16 v[64:67], a[104:107], a[48:51], v[64:67]
s_lshl4_add_u32 s70, s78, s70
s_xor_b32 s64, s71, 7340032
ds_read_b64_tr_b16 a[88:89], v19 offset:36864
v_mfma_f32_16x16x32_bf16 v[64:67], a[108:111], a[52:55], v[64:67]
s_lshr_b32 s81, s81, 5
buffer_load_dwordx4 v14, s[56:59], s64 offen lds
v_mfma_f32_16x16x32_bf16 v[80:83], a[108:111], a[60:63], v[80:83]
ds_read_b64_tr_b16 a[90:91], v19 offset:37120
v_mfma_f32_16x16x32_bf16 v[80:83], a[104:107], a[56:59], v[80:83]
ds_read_b64_tr_b16 a[92:93], v19 offset:38912
v_mfma_f32_16x16x32_bf16 v[144:147], a[112:115], a[56:59], v[144:147]
ds_read_b64_tr_b16 a[94:95], v19 offset:39168
v_mfma_f32_16x16x32_bf16 v[144:147], a[116:119], a[60:63], v[144:147]
ds_read_b64_tr_b16 a[96:97], v20 offset:36864
v_mfma_f32_16x16x32_bf16 v[128:131], a[116:119], a[52:55], v[128:131]
ds_read_b64_tr_b16 a[98:99], v20 offset:37120
v_mfma_f32_16x16x32_bf16 v[128:131], a[112:115], a[48:51], v[128:131]
ds_read_b64_tr_b16 a[100:101], v20 offset:38912
v_mfma_f32_16x16x32_bf16 v[112:115], a[112:115], a[40:43], v[112:115]
s_add_u32 m0, s78, 114688
ds_read_b64_tr_b16 a[102:103], v20 offset:39168
v_mfma_f32_16x16x32_bf16 v[112:115], a[116:119], a[44:47], v[112:115]
s_add_u32 s64, s75, 5505024
ds_read_b64_tr_b16 a[104:105], v19 offset:40960
v_mfma_f32_16x16x32_bf16 v[96:99], a[116:119], a[36:39], v[96:99]
buffer_load_dwordx4 v23, s[60:63], s64 offen lds
v_mfma_f32_16x16x32_bf16 v[96:99], a[112:115], a[32:35], v[96:99]
ds_read_b64_tr_b16 a[106:107], v19 offset:41216
v_mfma_f32_16x16x32_bf16 v[36:39], a[72:75], a[32:35], v[36:39]
ds_read_b64_tr_b16 a[108:109], v19 offset:43008
v_mfma_f32_16x16x32_bf16 v[36:39], a[76:79], a[36:39], v[36:39]
ds_read_b64_tr_b16 a[110:111], v19 offset:43264
v_mfma_f32_16x16x32_bf16 v[52:55], a[76:79], a[44:47], v[52:55]
ds_read_b64_tr_b16 a[112:113], v20 offset:40960
v_mfma_f32_16x16x32_bf16 v[52:55], a[72:75], a[40:43], v[52:55]
ds_read_b64_tr_b16 a[114:115], v20 offset:41216
v_mfma_f32_16x16x32_bf16 v[68:71], a[72:75], a[48:51], v[68:71]
ds_read_b64_tr_b16 a[116:117], v20 offset:43008
v_mfma_f32_16x16x32_bf16 v[68:71], a[76:79], a[52:55], v[68:71]
s_xor_b32 m0, s77, 99328
ds_read_b64_tr_b16 a[118:119], v20 offset:43264
v_mfma_f32_16x16x32_bf16 v[84:87], a[76:79], a[60:63], v[84:87]
s_xor_b32 s64, s71, 7372800
v_mfma_f32_16x16x32_bf16 v[84:87], a[72:75], a[56:59], v[84:87]
buffer_load_dwordx4 v14, s[56:59], s64 offen lds
v_mfma_f32_16x16x32_bf16 v[148:151], a[80:83], a[56:59], v[148:151]
ds_read_b64_tr_b16 a[72:73], v19 offset:32768
v_mfma_f32_16x16x32_bf16 v[148:151], a[84:87], a[60:63], v[148:151]
ds_read_b64_tr_b16 a[74:75], v19 offset:33024
v_mfma_f32_16x16x32_bf16 v[132:135], a[84:87], a[52:55], v[132:135]
ds_read_b64_tr_b16 a[76:77], v19 offset:34816
v_mfma_f32_16x16x32_bf16 v[132:135], a[80:83], a[48:51], v[132:135]
ds_read_b64_tr_b16 a[78:79], v19 offset:35072
v_mfma_f32_16x16x32_bf16 v[116:119], a[80:83], a[40:43], v[116:119]
v_mfma_f32_16x16x32_bf16 v[116:119], a[84:87], a[44:47], v[116:119]
v_mfma_f32_16x16x32_bf16 v[100:103], a[84:87], a[36:39], v[100:103]
s_add_u32 m0, s78, 118784
v_mfma_f32_16x16x32_bf16 v[100:103], a[80:83], a[32:35], v[100:103]
s_waitcnt lgkmcnt(4)
s_add_u32 s64, s75, 5507072
ds_read_b64_tr_b16 a[80:81], v20 offset:32768
v_mfma_f32_16x16x32_bf16 v[184:187], a[88:91], a[0:3], v[184:187]
buffer_load_dwordx4 v23, s[60:63], s64 offen lds
v_mfma_f32_16x16x32_bf16 v[184:187], a[92:95], a[4:7], v[184:187]
ds_read_b64_tr_b16 a[82:83], v20 offset:33024
v_mfma_f32_16x16x32_bf16 v[192:195], a[92:95], a[12:15], v[192:195]
ds_read_b64_tr_b16 a[84:85], v20 offset:34816
v_mfma_f32_16x16x32_bf16 v[192:195], a[88:91], a[8:11], v[192:195]
ds_read_b64_tr_b16 a[86:87], v20 offset:35072
v_mfma_f32_16x16x32_bf16 v[200:203], a[88:91], a[16:19], v[200:203]
v_mfma_f32_16x16x32_bf16 v[200:203], a[92:95], a[20:23], v[200:203]
v_mfma_f32_16x16x32_bf16 v[208:211], a[92:95], a[28:31], v[208:211]
v_mfma_f32_16x16x32_bf16 v[208:211], a[88:91], a[24:27], v[208:211]
ds_read_b64_tr_b16 a[88:89], v4 offset:32768
v_mfma_f32_16x16x32_bf16 v[212:215], a[96:99], a[24:27], v[212:215]
s_xor_b32 m0, s77, 100352
ds_read_b64_tr_b16 a[90:91], v4 offset:33792
v_mfma_f32_16x16x32_bf16 v[212:215], a[100:103], a[28:31], v[212:215]
s_xor_b32 s64, s71, 7405568
ds_read_b64_tr_b16 a[92:93], v4 offset:40960
v_mfma_f32_16x16x32_bf16 v[204:207], a[100:103], a[20:23], v[204:207]
buffer_load_dwordx4 v15, s[56:59], s64 offen lds
v_mfma_f32_16x16x32_bf16 v[204:207], a[96:99], a[16:19], v[204:207]
ds_read_b64_tr_b16 a[94:95], v4 offset:41984
v_mfma_f32_16x16x32_bf16 v[196:199], a[96:99], a[8:11], v[196:199]
v_mfma_f32_16x16x32_bf16 v[196:199], a[100:103], a[12:15], v[196:199]
v_mfma_f32_16x16x32_bf16 v[188:191], a[100:103], a[4:7], v[188:191]
v_mfma_f32_16x16x32_bf16 v[188:191], a[96:99], a[0:3], v[188:191]
ds_read_b64_tr_b16 a[96:97], v5 offset:32768
v_mfma_f32_16x16x32_bf16 v[216:219], a[0:3], a[104:107], v[216:219]
ds_read_b64_tr_b16 a[98:99], v5 offset:33792
v_mfma_f32_16x16x32_bf16 v[216:219], a[4:7], a[108:111], v[216:219]
s_add_u32 m0, s78, 122880
ds_read_b64_tr_b16 a[100:101], v5 offset:40960
v_mfma_f32_16x16x32_bf16 v[224:227], a[12:15], a[108:111], v[224:227]
s_add_u32 s64, s75, 5509120
ds_read_b64_tr_b16 a[102:103], v5 offset:41984
v_mfma_f32_16x16x32_bf16 v[224:227], a[8:11], a[104:107], v[224:227]
buffer_load_dwordx4 v23, s[60:63], s64 offen lds
v_mfma_f32_16x16x32_bf16 v[232:235], a[16:19], a[104:107], v[232:235]
v_mfma_f32_16x16x32_bf16 v[232:235], a[20:23], a[108:111], v[232:235]
v_mfma_f32_16x16x32_bf16 v[240:243], a[28:31], a[108:111], v[240:243]
v_mfma_f32_16x16x32_bf16 v[240:243], a[24:27], a[104:107], v[240:243]
ds_read_b64_tr_b16 a[104:105], v6 offset:32768
v_mfma_f32_16x16x32_bf16 v[244:247], a[24:27], a[112:115], v[244:247]
ds_read_b64_tr_b16 a[106:107], v6 offset:33792
v_mfma_f32_16x16x32_bf16 v[244:247], a[28:31], a[116:119], v[244:247]
ds_read_b64_tr_b16 a[108:109], v6 offset:40960
v_subrev_u32 v19, 0x8000, v19
v_mfma_f32_16x16x32_bf16 v[236:239], a[20:23], a[116:119], v[236:239]
s_xor_b32 m0, s77, 101376
ds_read_b64_tr_b16 a[110:111], v6 offset:41984
v_mfma_f32_16x16x32_bf16 v[236:239], a[16:19], a[112:115], v[236:239]
s_xor_b32 s64, s71, 7438336
v_mfma_f32_16x16x32_bf16 v[228:231], a[8:11], a[112:115], v[228:231]
buffer_load_dwordx4 v15, s[56:59], s64 offen lds
v_mfma_f32_16x16x32_bf16 v[228:231], a[12:15], a[116:119], v[228:231]
v_mfma_f32_16x16x32_bf16 v[220:223], a[4:7], a[116:119], v[220:223]
v_mfma_f32_16x16x32_bf16 v[220:223], a[0:3], a[112:115], v[220:223]
s_waitcnt lgkmcnt(4)
ds_read_b64_tr_b16 a[112:113], v7 offset:32768
v_mfma_f32_16x16x32_bf16 v[152:155], a[72:75], a[0:3], v[152:155]
ds_read_b64_tr_b16 a[114:115], v7 offset:33792
v_mfma_f32_16x16x32_bf16 v[152:155], a[76:79], a[4:7], v[152:155]
ds_read_b64_tr_b16 a[116:117], v7 offset:40960
v_subrev_u32 v20, 0x8000, v20
v_mfma_f32_16x16x32_bf16 v[160:163], a[76:79], a[12:15], v[160:163]
ds_read_b64_tr_b16 a[118:119], v7 offset:41984
v_mfma_f32_16x16x32_bf16 v[160:163], a[72:75], a[8:11], v[160:163]
v_mfma_f32_16x16x32_bf16 v[168:171], a[72:75], a[16:19], v[168:171]
v_mfma_f32_16x16x32_bf16 v[168:171], a[76:79], a[20:23], v[168:171]
v_mfma_f32_16x16x32_bf16 v[176:179], a[76:79], a[28:31], v[176:179]
s_xor_b32 m0, s84, 0
v_mfma_f32_16x16x32_bf16 v[176:179], a[72:75], a[24:27], v[176:179]
s_xor_b32 s64, s72, 1792
ds_read_b64_tr_b16 a[72:73], v8 offset:32768
v_mfma_f32_16x16x32_bf16 v[180:183], a[80:83], a[24:27], v[180:183]
buffer_load_dwordx4 v12, s[48:51], s64 offen lds
v_mfma_f32_16x16x32_bf16 v[180:183], a[84:87], a[28:31], v[180:183]
ds_read_b64_tr_b16 a[74:75], v8 offset:33792
v_subrev_u32 v4, 0x8000, v4
v_mfma_f32_16x16x32_bf16 v[172:175], a[84:87], a[20:23], v[172:175]
ds_read_b64_tr_b16 a[76:77], v8 offset:40960
v_mfma_f32_16x16x32_bf16 v[172:175], a[80:83], a[16:19], v[172:175]
s_xor_b32 m0, s84, 1024
ds_read_b64_tr_b16 a[78:79], v8 offset:41984
v_mfma_f32_16x16x32_bf16 v[164:167], a[80:83], a[8:11], v[164:167]
s_xor_b32 s64, s72, 18176
v_mfma_f32_16x16x32_bf16 v[164:167], a[84:87], a[12:15], v[164:167]
s_branch L_po12
L_pg12:
s_branch L_tr1
L_po12:
buffer_load_dwordx4 v13, s[48:51], s64 offen lds
v_mfma_f32_16x16x32_bf16 v[156:159], a[84:87], a[4:7], v[156:159]
v_mfma_f32_16x16x32_bf16 v[156:159], a[80:83], a[0:3], v[156:159]
ds_read_b64_tr_b16 a[80:81], v9 offset:32768
v_mfma_f32_16x16x32_bf16 v[24:27], a[88:91], a[0:3], v[24:27]
s_xor_b32 m0, s84, 2048
ds_read_b64_tr_b16 a[82:83], v9 offset:33792
v_mfma_f32_16x16x32_bf16 v[24:27], a[92:95], a[4:7], v[24:27]
s_xor_b32 s64, s72, 132864
ds_read_b64_tr_b16 a[84:85], v9 offset:40960
v_subrev_u32 v5, 0x8000, v5
v_mfma_f32_16x16x32_bf16 v[40:43], a[92:95], a[12:15], v[40:43]
buffer_load_dwordx4 v12, s[48:51], s64 offen lds
v_mfma_f32_16x16x32_bf16 v[40:43], a[88:91], a[8:11], v[40:43]
ds_read_b64_tr_b16 a[86:87], v9 offset:41984
v_mfma_f32_16x16x32_bf16 v[56:59], a[88:91], a[16:19], v[56:59]
v_mfma_f32_16x16x32_bf16 v[56:59], a[92:95], a[20:23], v[56:59]
s_xor_b32 m0, s84, 3072
v_mfma_f32_16x16x32_bf16 v[72:75], a[92:95], a[28:31], v[72:75]
s_waitcnt vmcnt(11)
s_xor_b32 s64, s72, 149248
ds_read_b128 a[32:35], v2 offset:32768
v_mfma_f32_16x16x32_bf16 v[72:75], a[88:91], a[24:27], v[72:75]
buffer_load_dwordx4 v13, s[48:51], s64 offen lds
v_mfma_f32_16x16x32_bf16 v[136:139], a[96:99], a[24:27], v[136:139]
ds_read_b128 a[36:39], v3 offset:32768
v_mfma_f32_16x16x32_bf16 v[136:139], a[100:103], a[28:31], v[136:139]
ds_read_b128 a[40:43], v2 offset:34816
v_subrev_u32 v6, 0x8000, v6
v_mfma_f32_16x16x32_bf16 v[120:123], a[100:103], a[20:23], v[120:123]
s_xor_b32 m0, s84, 4096
ds_read_b128 a[44:47], v3 offset:34816
v_mfma_f32_16x16x32_bf16 v[120:123], a[96:99], a[16:19], v[120:123]
s_xor_b32 s64, s73, 1792
ds_read_b128 a[48:51], v2 offset:36864
v_mfma_f32_16x16x32_bf16 v[104:107], a[96:99], a[8:11], v[104:107]
buffer_load_dwordx4 v12, s[48:51], s64 offen lds
v_mfma_f32_16x16x32_bf16 v[104:107], a[100:103], a[12:15], v[104:107]
ds_read_b128 a[52:55], v3 offset:36864
v_mfma_f32_16x16x32_bf16 v[88:91], a[100:103], a[4:7], v[88:91]
ds_read_b128 a[56:59], v2 offset:38912
v_mfma_f32_16x16x32_bf16 v[88:91], a[96:99], a[0:3], v[88:91]
s_waitcnt lgkmcnt(7)
s_xor_b32 m0, s84, 5120
ds_read_b128 a[60:63], v3 offset:38912
v_mfma_f32_16x16x32_bf16 v[28:31], a[104:107], a[0:3], v[28:31]
s_xor_b32 s64, s73, 18176
ds_read_b64_tr_b16 a[88:89], v10 offset:32768
v_mfma_f32_16x16x32_bf16 v[28:31], a[108:111], a[4:7], v[28:31]
buffer_load_dwordx4 v13, s[48:51], s64 offen lds
v_mfma_f32_16x16x32_bf16 v[44:47], a[108:111], a[12:15], v[44:47]
ds_read_b64_tr_b16 a[90:91], v10 offset:33792
v_subrev_u32 v7, 0x8000, v7
v_mfma_f32_16x16x32_bf16 v[44:47], a[104:107], a[8:11], v[44:47]
ds_read_b64_tr_b16 a[92:93], v10 offset:40960
v_mfma_f32_16x16x32_bf16 v[60:63], a[104:107], a[16:19], v[60:63]
s_xor_b32 m0, s84, 6144
ds_read_b64_tr_b16 a[94:95], v10 offset:41984
v_mfma_f32_16x16x32_bf16 v[60:63], a[108:111], a[20:23], v[60:63]
s_xor_b32 s64, s73, 132864
ds_read_b64_tr_b16 a[96:97], v11 offset:32768
v_mfma_f32_16x16x32_bf16 v[76:79], a[108:111], a[28:31], v[76:79]
buffer_load_dwordx4 v12, s[48:51], s64 offen lds
v_mfma_f32_16x16x32_bf16 v[76:79], a[104:107], a[24:27], v[76:79]
ds_read_b64_tr_b16 a[98:99], v11 offset:33792
v_mfma_f32_16x16x32_bf16 v[140:143], a[112:115], a[24:27], v[140:143]
ds_read_b64_tr_b16 a[100:101], v11 offset:40960
v_mfma_f32_16x16x32_bf16 v[140:143], a[116:119], a[28:31], v[140:143]
s_xor_b32 m0, s84, 7168
ds_read_b64_tr_b16 a[102:103], v11 offset:41984
v_subrev_u32 v8, 0x8000, v8
v_mfma_f32_16x16x32_bf16 v[124:127], a[116:119], a[20:23], v[124:127]
s_xor_b32 s64, s73, 149248
v_mfma_f32_16x16x32_bf16 v[124:127], a[112:115], a[16:19], v[124:127]
buffer_load_dwordx4 v13, s[48:51], s64 offen lds
v_mfma_f32_16x16x32_bf16 v[108:111], a[112:115], a[8:11], v[108:111]
v_mfma_f32_16x16x32_bf16 v[108:111], a[116:119], a[12:15], v[108:111]
v_mfma_f32_16x16x32_bf16 v[92:95], a[116:119], a[4:7], v[92:95]
v_subrev_u32 v9, 0x8000, v9
v_subrev_u32 v10, 0x8000, v10
v_mfma_f32_16x16x32_bf16 v[92:95], a[112:115], a[0:3], v[92:95]
v_subrev_u32 v11, 0x8000, v11
v_mfma_f32_16x16x32_bf16 v[32:35], a[72:75], a[0:3], v[32:35]
v_mfma_f32_16x16x32_bf16 v[32:35], a[76:79], a[4:7], v[32:35]
v_mfma_f32_16x16x32_bf16 v[48:51], a[76:79], a[12:15], v[48:51]
s_waitcnt lgkmcnt(0)
s_barrier
v_mfma_f32_16x16x32_bf16 v[48:51], a[72:75], a[8:11], v[48:51]
s_xor_b32 m0, s84, 32768
buffer_load_dword v1, off, s[52:55], s70 sc1
v_mfma_f32_16x16x32_bf16 v[64:67], a[72:75], a[16:19], v[64:67]
s_xor_b32 s64, s72, 1920
ds_read_b64_tr_b16 a[104:105], v19 offset:4096
v_mfma_f32_16x16x32_bf16 v[64:67], a[76:79], a[20:23], v[64:67]
buffer_load_dwordx4 v12, s[48:51], s64 offen lds
v_mfma_f32_16x16x32_bf16 v[80:83], a[76:79], a[28:31], v[80:83]
ds_read_b64_tr_b16 a[106:107], v19 offset:4352
v_mfma_f32_16x16x32_bf16 v[80:83], a[72:75], a[24:27], v[80:83]
ds_read_b64_tr_b16 a[108:109], v19 offset:6144
v_mfma_f32_16x16x32_bf16 v[144:147], a[80:83], a[24:27], v[144:147]
ds_read_b64_tr_b16 a[110:111], v19 offset:6400
v_mfma_f32_16x16x32_bf16 v[144:147], a[84:87], a[28:31], v[144:147]
s_xor_b32 m0, s84, 33792
ds_read_b64_tr_b16 a[112:113], v20 offset:4096
v_mfma_f32_16x16x32_bf16 v[128:131], a[84:87], a[20:23], v[128:131]
s_xor_b32 s64, s72, 18304
ds_read_b64_tr_b16 a[114:115], v20 offset:4352
v_mfma_f32_16x16x32_bf16 v[128:131], a[80:83], a[16:19], v[128:131]
buffer_load_dwordx4 v13, s[48:51], s64 offen lds
v_mfma_f32_16x16x32_bf16 v[112:115], a[80:83], a[8:11], v[112:115]
ds_read_b64_tr_b16 a[116:117], v20 offset:6144
v_mfma_f32_16x16x32_bf16 v[112:115], a[84:87], a[12:15], v[112:115]
ds_read_b64_tr_b16 a[118:119], v20 offset:6400
v_mfma_f32_16x16x32_bf16 v[96:99], a[84:87], a[4:7], v[96:99]
ds_read_b64_tr_b16 a[72:73], v19 offset:8192
v_mfma_f32_16x16x32_bf16 v[96:99], a[80:83], a[0:3], v[96:99]
s_xor_b32 m0, s84, 34816
ds_read_b64_tr_b16 a[74:75], v19 offset:8448
v_mfma_f32_16x16x32_bf16 v[36:39], a[88:91], a[0:3], v[36:39]
s_xor_b32 s64, s72, 132992
ds_read_b64_tr_b16 a[76:77], v19 offset:10240
v_mfma_f32_16x16x32_bf16 v[36:39], a[92:95], a[4:7], v[36:39]
buffer_load_dwordx4 v12, s[48:51], s64 offen lds
v_mfma_f32_16x16x32_bf16 v[52:55], a[92:95], a[12:15], v[52:55]
ds_read_b64_tr_b16 a[78:79], v19 offset:10496
v_mfma_f32_16x16x32_bf16 v[52:55], a[88:91], a[8:11], v[52:55]
ds_read_b64_tr_b16 a[80:81], v20 offset:8192
v_mfma_f32_16x16x32_bf16 v[68:71], a[88:91], a[16:19], v[68:71]
ds_read_b64_tr_b16 a[82:83], v20 offset:8448
v_mfma_f32_16x16x32_bf16 v[68:71], a[92:95], a[20:23], v[68:71]
s_xor_b32 m0, s84, 35840
ds_read_b64_tr_b16 a[84:85], v20 offset:10240
v_mfma_f32_16x16x32_bf16 v[84:87], a[92:95], a[28:31], v[84:87]
s_xor_b32 s64, s72, 149376
ds_read_b64_tr_b16 a[86:87], v20 offset:10496
v_mfma_f32_16x16x32_bf16 v[84:87], a[88:91], a[24:27], v[84:87]
buffer_load_dwordx4 v13, s[48:51], s64 offen lds
v_mfma_f32_16x16x32_bf16 v[148:151], a[96:99], a[24:27], v[148:151]
ds_read_b64_tr_b16 a[88:89], v19 offset:0
v_mfma_f32_16x16x32_bf16 v[148:151], a[100:103], a[28:31], v[148:151]
ds_read_b64_tr_b16 a[90:91], v19 offset:256
v_mfma_f32_16x16x32_bf16 v[132:135], a[100:103], a[20:23], v[132:135]
ds_read_b64_tr_b16 a[92:93], v19 offset:2048
v_mfma_f32_16x16x32_bf16 v[132:135], a[96:99], a[16:19], v[132:135]
s_xor_b32 m0, s84, 36864
ds_read_b64_tr_b16 a[94:95], v19 offset:2304
v_mfma_f32_16x16x32_bf16 v[116:119], a[96:99], a[8:11], v[116:119]
s_xor_b32 s64, s73, 1920
v_mfma_f32_16x16x32_bf16 v[116:119], a[100:103], a[12:15], v[116:119]
buffer_load_dwordx4 v12, s[48:51], s64 offen lds
v_mfma_f32_16x16x32_bf16 v[100:103], a[100:103], a[4:7], v[100:103]
v_mfma_f32_16x16x32_bf16 v[100:103], a[96:99], a[0:3], v[100:103]
s_waitcnt lgkmcnt(5)
ds_read_b64_tr_b16 a[96:97], v20 offset:0
v_mfma_f32_16x16x32_bf16 v[184:187], a[104:107], a[32:35], v[184:187]
s_xor_b32 m0, s84, 37888
ds_read_b64_tr_b16 a[98:99], v20 offset:256
v_and_b32 v22, 15, v0
v_mfma_f32_16x16x32_bf16 v[184:187], a[108:111], a[36:39], v[184:187]
s_xor_b32 s64, s73, 18304
ds_read_b64_tr_b16 a[100:101], v20 offset:2048
v_lshlrev_b32 v22, 3, v22
v_mfma_f32_16x16x32_bf16 v[192:195], a[108:111], a[44:47], v[192:195]
s_lshl_b32 s85, s30, 7
s_add_u32 s85, s85, 58720256
ds_read_b64_tr_b16 a[102:103], v20 offset:2304
v_mfma_f32_16x16x32_bf16 v[192:195], a[104:107], a[40:43], v[192:195]
s_lshl_b32 s86, s3, 10
s_add_u32 s86, s86, s85
s_lshl_b32 s87, s16, 10
s_lshl_b32 s68, s31, 20
s_add_u32 s32, s28, s68
s_addc_u32 s33, s29, 0
v_mfma_f32_16x16x32_bf16 v[200:203], a[104:107], a[48:51], v[200:203]
s_add_u32 s87, s87, s85
buffer_load_dwordx4 v13, s[48:51], s64 offen lds
v_mfma_f32_16x16x32_bf16 v[200:203], a[108:111], a[52:55], v[200:203]
s_add_u32 s68, s16, 1
s_lshl_b32 s34, s68, 16
v_mfma_f32_16x16x32_bf16 v[208:211], a[108:111], a[60:63], v[208:211]
v_mfma_f32_16x16x32_bf16 v[208:211], a[104:107], a[56:59], v[208:211]
ds_read_b64_tr_b16 a[104:105], v4 offset:0
v_mfma_f32_16x16x32_bf16 v[212:215], a[112:115], a[56:59], v[212:215]
s_xor_b32 m0, s84, 38912
ds_read_b64_tr_b16 a[106:107], v4 offset:1024
v_mfma_f32_16x16x32_bf16 v[212:215], a[116:119], a[60:63], v[212:215]
s_xor_b32 s64, s73, 132992
ds_read_b64_tr_b16 a[108:109], v4 offset:8192
v_mfma_f32_16x16x32_bf16 v[204:207], a[116:119], a[52:55], v[204:207]
buffer_load_dwordx4 v12, s[48:51], s64 offen lds
v_mfma_f32_16x16x32_bf16 v[204:207], a[112:115], a[48:51], v[204:207]
ds_read_b64_tr_b16 a[110:111], v4 offset:9216
v_mfma_f32_16x16x32_bf16 v[196:199], a[112:115], a[40:43], v[196:199]
v_mfma_f32_16x16x32_bf16 v[196:199], a[116:119], a[44:47], v[196:199]
v_mfma_f32_16x16x32_bf16 v[188:191], a[116:119], a[36:39], v[188:191]
s_xor_b32 m0, s84, 39936
v_mfma_f32_16x16x32_bf16 v[188:191], a[112:115], a[32:35], v[188:191]
s_xor_b32 s64, s73, 149376
ds_read_b64_tr_b16 a[112:113], v5 offset:0
v_mfma_f32_16x16x32_bf16 v[216:219], a[32:35], a[72:75], v[216:219]
buffer_load_dwordx4 v13, s[48:51], s64 offen lds
v_mfma_f32_16x16x32_bf16 v[216:219], a[36:39], a[76:79], v[216:219]
ds_read_b64_tr_b16 a[114:115], v5 offset:1024
v_mfma_f32_16x16x32_bf16 v[224:227], a[44:47], a[76:79], v[224:227]
ds_read_b64_tr_b16 a[116:117], v5 offset:8192
v_mfma_f32_16x16x32_bf16 v[224:227], a[40:43], a[72:75], v[224:227]
ds_read_b64_tr_b16 a[118:119], v5 offset:9216
v_mfma_f32_16x16x32_bf16 v[232:235], a[48:51], a[72:75], v[232:235]
s_xor_b32 m0, s77, 131072
v_mfma_f32_16x16x32_bf16 v[232:235], a[52:55], a[76:79], v[232:235]
s_xor_b32 s64, s71, 7864320
v_mfma_f32_16x16x32_bf16 v[240:243], a[60:63], a[76:79], v[240:243]
buffer_load_dwordx4 v14, s[56:59], s64 offen lds
v_mfma_f32_16x16x32_bf16 v[240:243], a[56:59], a[72:75], v[240:243]
ds_read_b64_tr_b16 a[72:73], v6 offset:0
v_mfma_f32_16x16x32_bf16 v[244:247], a[56:59], a[80:83], v[244:247]
s_waitcnt lgkmcnt(5)
ds_read_b64_tr_b16 a[74:75], v6 offset:1024
v_mfma_f32_16x16x32_bf16 v[244:247], a[60:63], a[84:87], v[244:247]
ds_read_b64_tr_b16 a[76:77], v6 offset:8192
v_add_u32 v19, 0x8000, v19
v_mfma_f32_16x16x32_bf16 v[236:239], a[52:55], a[84:87], v[236:239]
s_add_u32 m0, s78, 147456
ds_read_b64_tr_b16 a[78:79], v6 offset:9216
v_mfma_f32_16x16x32_bf16 v[236:239], a[48:51], a[80:83], v[236:239]
s_add_u32 s64, s75, 5898240
v_mfma_f32_16x16x32_bf16 v[228:231], a[40:43], a[80:83], v[228:231]
buffer_load_dwordx4 v23, s[60:63], s64 offen lds
v_mfma_f32_16x16x32_bf16 v[228:231], a[44:47], a[84:87], v[228:231]
v_mfma_f32_16x16x32_bf16 v[220:223], a[36:39], a[84:87], v[220:223]
v_mfma_f32_16x16x32_bf16 v[220:223], a[32:35], a[80:83], v[220:223]
ds_read_b64_tr_b16 a[80:81], v7 offset:0
v_mfma_f32_16x16x32_bf16 v[152:155], a[88:91], a[32:35], v[152:155]
ds_read_b64_tr_b16 a[82:83], v7 offset:1024
v_mfma_f32_16x16x32_bf16 v[152:155], a[92:95], a[36:39], v[152:155]
s_xor_b32 m0, s77, 132096
ds_read_b64_tr_b16 a[84:85], v7 offset:8192
v_add_u32 v20, 0x8000, v20
v_mfma_f32_16x16x32_bf16 v[160:163], a[92:95], a[44:47], v[160:163]
s_xor_b32 s64, s71, 7897088
ds_read_b64_tr_b16 a[86:87], v7 offset:9216
v_mfma_f32_16x16x32_bf16 v[160:163], a[88:91], a[40:43], v[160:163]
buffer_load_dwordx4 v14, s[56:59], s64 offen lds
v_mfma_f32_16x16x32_bf16 v[168:171], a[88:91], a[48:51], v[168:171]
v_mfma_f32_16x16x32_bf16 v[168:171], a[92:95], a[52:55], v[168:171]
v_mfma_f32_16x16x32_bf16 v[176:179], a[92:95], a[60:63], v[176:179]
v_mfma_f32_16x16x32_bf16 v[176:179], a[88:91], a[56:59], v[176:179]
s_add_u32 m0, s78, 151552
ds_read_b64_tr_b16 a[88:89], v8 offset:0
v_mfma_f32_16x16x32_bf16 v[180:183], a[96:99], a[56:59], v[180:183]
s_add_u32 s64, s75, 5900288
ds_read_b64_tr_b16 a[90:91], v8 offset:1024
v_mfma_f32_16x16x32_bf16 v[180:183], a[100:103], a[60:63], v[180:183]
buffer_load_dwordx4 v23, s[60:63], s64 offen lds
v_mfma_f32_16x16x32_bf16 v[172:175], a[100:103], a[52:55], v[172:175]
ds_read_b64_tr_b16 a[92:93], v8 offset:8192
v_add_u32 v4, 0x8000, v4
v_mfma_f32_16x16x32_bf16 v[172:175], a[96:99], a[48:51], v[172:175]
ds_read_b64_tr_b16 a[94:95], v8 offset:9216
v_mfma_f32_16x16x32_bf16 v[164:167], a[96:99], a[40:43], v[164:167]
v_mfma_f32_16x16x32_bf16 v[164:167], a[100:103], a[44:47], v[164:167]
s_xor_b32 m0, s77, 133120
v_mfma_f32_16x16x32_bf16 v[156:159], a[100:103], a[36:39], v[156:159]
s_xor_b32 s64, s71, 7929856
v_mfma_f32_16x16x32_bf16 v[156:159], a[96:99], a[32:35], v[156:159]
buffer_load_dwordx4 v15, s[56:59], s64 offen lds
v_mfma_f32_16x16x32_bf16 v[24:27], a[104:107], a[32:35], v[24:27]
ds_read_b64_tr_b16 a[96:97], v9 offset:0
v_mfma_f32_16x16x32_bf16 v[24:27], a[108:111], a[36:39], v[24:27]
ds_read_b64_tr_b16 a[98:99], v9 offset:1024
v_add_u32 v5, 0x8000, v5
v_mfma_f32_16x16x32_bf16 v[40:43], a[108:111], a[44:47], v[40:43]
ds_read_b64_tr_b16 a[100:101], v9 offset:8192
v_mfma_f32_16x16x32_bf16 v[40:43], a[104:107], a[40:43], v[40:43]
s_add_u32 m0, s78, 155648
ds_read_b64_tr_b16 a[102:103], v9 offset:9216
v_mfma_f32_16x16x32_bf16 v[56:59], a[104:107], a[48:51], v[56:59]
s_add_u32 s64, s75, 5902336
v_mfma_f32_16x16x32_bf16 v[56:59], a[108:111], a[52:55], v[56:59]
buffer_load_dwordx4 v23, s[60:63], s64 offen lds
v_mfma_f32_16x16x32_bf16 v[72:75], a[108:111], a[60:63], v[72:75]
s_waitcnt vmcnt(15)
ds_read_b128 a[0:3], v2 offset:0
v_mfma_f32_16x16x32_bf16 v[72:75], a[104:107], a[56:59], v[72:75]
s_waitcnt lgkmcnt(5)
ds_read_b128 a[4:7], v3 offset:0
v_mfma_f32_16x16x32_bf16 v[136:139], a[112:115], a[56:59], v[136:139]
ds_read_b128 a[8:11], v2 offset:2048
v_mfma_f32_16x16x32_bf16 v[136:139], a[116:119], a[60:63], v[136:139]
s_xor_b32 m0, s77, 134144
ds_read_b128 a[12:15], v3 offset:2048
v_add_u32 v6, 0x8000, v6
v_mfma_f32_16x16x32_bf16 v[120:123], a[116:119], a[52:55], v[120:123]
s_xor_b32 s64, s71, 7962624
ds_read_b128 a[16:19], v2 offset:4096
v_mfma_f32_16x16x32_bf16 v[120:123], a[112:115], a[48:51], v[120:123]
buffer_load_dwordx4 v15, s[56:59], s64 offen lds
v_mfma_f32_16x16x32_bf16 v[104:107], a[112:115], a[40:43], v[104:107]
ds_read_b128 a[20:23], v3 offset:4096
v_mfma_f32_16x16x32_bf16 v[104:107], a[116:119], a[44:47], v[104:107]
ds_read_b128 a[24:27], v2 offset:6144
v_mfma_f32_16x16x32_bf16 v[88:91], a[116:119], a[36:39], v[88:91]
ds_read_b128 a[28:31], v3 offset:6144
v_mfma_f32_16x16x32_bf16 v[88:91], a[112:115], a[32:35], v[88:91]
ds_read_b64_tr_b16 a[104:105], v10 offset:0
v_mfma_f32_16x16x32_bf16 v[28:31], a[72:75], a[32:35], v[28:31]
ds_read_b64_tr_b16 a[106:107], v10 offset:1024
v_mfma_f32_16x16x32_bf16 v[28:31], a[76:79], a[36:39], v[28:31]
ds_read_b64_tr_b16 a[108:109], v10 offset:8192
v_add_u32 v7, 0x8000, v7
v_mfma_f32_16x16x32_bf16 v[44:47], a[76:79], a[44:47], v[44:47]
ds_read_b64_tr_b16 a[110:111], v10 offset:9216
v_mfma_f32_16x16x32_bf16 v[44:47], a[72:75], a[40:43], v[44:47]
ds_read_b64_tr_b16 a[112:113], v11 offset:0
v_mfma_f32_16x16x32_bf16 v[60:63], a[72:75], a[48:51], v[60:63]
ds_read_b64_tr_b16 a[114:115], v11 offset:1024
v_mfma_f32_16x16x32_bf16 v[60:63], a[76:79], a[52:55], v[60:63]
ds_read_b64_tr_b16 a[116:117], v11 offset:8192
v_mfma_f32_16x16x32_bf16 v[76:79], a[76:79], a[60:63], v[76:79]
ds_read_b64_tr_b16 a[118:119], v11 offset:9216
v_mfma_f32_16x16x32_bf16 v[76:79], a[72:75], a[56:59], v[76:79]
v_mfma_f32_16x16x32_bf16 v[140:143], a[80:83], a[56:59], v[140:143]
v_mfma_f32_16x16x32_bf16 v[140:143], a[84:87], a[60:63], v[140:143]
v_add_u32 v8, 0x8000, v8
v_mfma_f32_16x16x32_bf16 v[124:127], a[84:87], a[52:55], v[124:127]
v_lshrrev_b32 v23, 2, v0
v_mul_u32_u24 v23, 3584, v23
v_mfma_f32_16x16x32_bf16 v[124:127], a[80:83], a[48:51], v[124:127]
v_lshl_add_u32 v23, v0, 7, v23
v_mfma_f32_16x16x32_bf16 v[108:111], a[80:83], a[40:43], v[108:111]
v_mfma_f32_16x16x32_bf16 v[108:111], a[84:87], a[44:47], v[108:111]
v_mfma_f32_16x16x32_bf16 v[92:95], a[84:87], a[36:39], v[92:95]
v_add_u32 v9, 0x8000, v9
v_add_u32 v10, 0x8000, v10
v_mfma_f32_16x16x32_bf16 v[92:95], a[80:83], a[32:35], v[92:95]
v_add_u32 v11, 0x8000, v11
v_mfma_f32_16x16x32_bf16 v[32:35], a[88:91], a[32:35], v[32:35]
s_waitcnt vmcnt(15)
v_readfirstlane_b32 vcc_lo, v1
s_nop 0
s_cmp_lt_u32 vcc_lo, s81
s_cbranch_scc1 L_spin_4
L_spinbk_5:
v_mfma_f32_16x16x32_bf16 v[32:35], a[92:95], a[36:39], v[32:35]
buffer_load_dwordx2 a[64:65], v22, s[44:47], s86 offen offset:0 sc1
v_mfma_f32_16x16x32_bf16 v[48:51], a[92:95], a[44:47], v[48:51]
s_waitcnt lgkmcnt(0)
s_barrier
v_mfma_f32_16x16x32_bf16 v[48:51], a[88:91], a[40:43], v[48:51]
ds_read_b64_tr_b16 a[72:73], v19 offset:4096
v_cmp_gt_i32 s[0:1], 0, v18
v_mfma_f32_16x16x32_bf16 v[64:67], a[88:91], a[48:51], v[64:67]
s_lshl2_add_u32 s72, s2, s30
ds_read_b64_tr_b16 a[74:75], v19 offset:4352
v_cmp_gt_i32 s[4:5], 1, v18
v_mfma_f32_16x16x32_bf16 v[64:67], a[92:95], a[52:55], v[64:67]
s_lshl_b32 s72, s72, 12
s_mov_b32 m0, s76
ds_read_b64_tr_b16 a[76:77], v19 offset:6144
v_cmp_gt_i32 s[6:7], 2, v18
v_mfma_f32_16x16x32_bf16 v[80:83], a[92:95], a[60:63], v[80:83]
s_add_u32 s72, s72, 67108864
s_lshl_b32 s64, s30, 14
ds_read_b64_tr_b16 a[78:79], v19 offset:6400
v_cmp_gt_i32 s[8:9], 3, v18
v_mfma_f32_16x16x32_bf16 v[80:83], a[88:91], a[56:59], v[80:83]
s_lshr_b32 s17, s78, 1
buffer_load_dwordx4 v16, s[32:35], s64 offen offset:0 sc1 lds
v_mfma_f32_16x16x32_bf16 v[144:147], a[96:99], a[56:59], v[144:147]
s_add_u32 s17, s17, L_base-L_pc-4+53248
buffer_load_dwordx2 a[66:67], v22, s[44:47], s86 offen offset:512 sc1
v_mfma_f32_16x16x32_bf16 v[144:147], a[100:103], a[60:63], v[144:147]
buffer_load_dword a252, v23, s[88:91], s17 offen
v_mfma_f32_16x16x32_bf16 v[128:131], a[100:103], a[52:55], v[128:131]
buffer_load_dwordx2 a[68:69], v22, s[44:47], s87 offen offset:0 sc1
v_mfma_f32_16x16x32_bf16 v[128:131], a[96:99], a[48:51], v[128:131]
buffer_load_dwordx2 a[70:71], v22, s[44:47], s87 offen offset:512 sc1
v_mfma_f32_16x16x32_bf16 v[112:115], a[96:99], a[40:43], v[112:115]
ds_read_b64_tr_b16 a[80:81], v20 offset:4096
v_cmp_gt_i32 s[10:11], 16, v18
v_mfma_f32_16x16x32_bf16 v[112:115], a[100:103], a[44:47], v[112:115]
ds_read_b64_tr_b16 a[82:83], v20 offset:4352
v_cmp_gt_i32 s[12:13], 17, v18
v_mfma_f32_16x16x32_bf16 v[96:99], a[100:103], a[36:39], v[96:99]
ds_read_b64_tr_b16 a[84:85], v20 offset:6144
v_cmp_gt_i32 s[18:19], 18, v18
v_mfma_f32_16x16x32_bf16 v[96:99], a[96:99], a[32:35], v[96:99]
buffer_load_dwordx4 v16, s[32:35], s64 offen offset:1024 sc1 lds
v_mfma_f32_16x16x32_bf16 v[36:39], a[104:107], a[32:35], v[36:39]
buffer_store_dwordx4 a[240:243], v16, s[44:47], s72 offen offset:0 sc1
v_mfma_f32_16x16x32_bf16 v[36:39], a[108:111], a[36:39], v[36:39]
ds_read_b64_tr_b16 a[86:87], v20 offset:6400
v_cmp_gt_i32 s[22:23], 19, v18
v_mfma_f32_16x16x32_bf16 v[52:55], a[108:111], a[44:47], v[52:55]
ds_read_b64_tr_b16 a[88:89], v19 offset:8192
v_cmp_gt_i32 s[26:27], 32, v18
v_mfma_f32_16x16x32_bf16 v[52:55], a[104:107], a[40:43], v[52:55]
ds_read_b64_tr_b16 a[90:91], v19 offset:8448
v_cmp_gt_i32 s[56:57], 33, v18
v_mfma_f32_16x16x32_bf16 v[68:71], a[104:107], a[48:51], v[68:71]
ds_read_b64_tr_b16 a[92:93], v19 offset:10240
v_cmp_gt_i32 s[58:59], 34, v18
v_mfma_f32_16x16x32_bf16 v[68:71], a[108:111], a[52:55], v[68:71]
ds_read_b64_tr_b16 a[94:95], v19 offset:10496
v_cmp_gt_i32 s[60:61], 35, v18
v_mfma_f32_16x16x32_bf16 v[84:87], a[108:111], a[60:63], v[84:87]
ds_read_b64_tr_b16 a[96:97], v20 offset:8192
v_cmp_gt_i32 s[62:63], 48, v18
v_mfma_f32_16x16x32_bf16 v[84:87], a[104:107], a[56:59], v[84:87]
buffer_load_dwordx4 v16, s[32:35], s64 offen offset:2048 sc1 lds
v_mfma_f32_16x16x32_bf16 v[148:151], a[112:115], a[56:59], v[148:151]
ds_read_b64_tr_b16 a[98:99], v20 offset:8448
v_cmp_gt_i32 s[48:49], 49, v18
v_mfma_f32_16x16x32_bf16 v[148:151], a[116:119], a[60:63], v[148:151]
ds_read_b64_tr_b16 a[100:101], v20 offset:10240
v_cmp_gt_i32 s[50:51], 50, v18
v_mfma_f32_16x16x32_bf16 v[132:135], a[116:119], a[52:55], v[132:135]
ds_read_b64_tr_b16 a[102:103], v20 offset:10496
v_cmp_gt_i32 s[100:101], 51, v18
v_mfma_f32_16x16x32_bf16 v[132:135], a[112:115], a[48:51], v[132:135]
ds_read_b64_tr_b16 a[104:105], v19 offset:0
v_mfma_f32_16x16x32_bf16 v[116:119], a[112:115], a[40:43], v[116:119]
ds_read_b64_tr_b16 a[106:107], v19 offset:256
v_mfma_f32_16x16x32_bf16 v[116:119], a[116:119], a[44:47], v[116:119]
ds_read_b64_tr_b16 a[108:109], v19 offset:2048
v_mfma_f32_16x16x32_bf16 v[100:103], a[116:119], a[36:39], v[100:103]
buffer_store_dwordx4 a[240:243], v16, s[44:47], s72 offen offset:1024 sc1
v_mfma_f32_16x16x32_bf16 v[100:103], a[112:115], a[32:35], v[100:103]
s_waitcnt lgkmcnt(7)
buffer_load_dwordx4 v16, s[32:35], s64 offen offset:3072 sc1 lds
v_mfma_f32_16x16x32_bf16 v[184:187], a[72:75], a[0:3], v[184:187]
s_waitcnt vmcnt(18)
s_and_b32 s66, s2, 7
ds_read_b128 a[32:35], v2 offset:32768
v_mfma_f32_16x16x32_bf16 v[184:187], a[76:79], a[4:7], v[184:187]
s_lshr_b32 s67, s2, 3
s_and_b32 s83, s66, 1
ds_read_b128 a[36:39], v3 offset:32768
v_mfma_f32_16x16x32_bf16 v[192:195], a[76:79], a[12:15], v[192:195]
s_and_b32 s68, s66, 2
s_and_b32 s69, s67, 7
ds_read_b128 a[40:43], v2 offset:34816
v_mfma_f32_16x16x32_bf16 v[192:195], a[72:75], a[8:11], v[192:195]
s_lshl2_add_u32 s82, s68, s69
s_and_b32 s68, s66, 4
ds_read_b128 a[44:47], v3 offset:34816
v_mfma_f32_16x16x32_bf16 v[200:203], a[72:75], a[16:19], v[200:203]
s_lshr_b32 s69, s67, 3
s_xor_b32 s69, s69, 0
ds_read_b128 a[48:51], v2 offset:36864
v_mfma_f32_16x16x32_bf16 v[200:203], a[76:79], a[20:23], v[200:203]
s_add_u32 s87, s68, s69
s_lshl_b32 s87, s87, 8
s_add_u32 m0, s76, 4096
ds_read_b128 a[52:55], v3 offset:36864
v_mfma_f32_16x16x32_bf16 v[208:211], a[76:79], a[28:31], v[208:211]
s_lshl_b32 s86, s30, 13
s_lshl_b32 s85, s30, 16
s_add_u32 s64, s64, 4096
ds_read_b128 a[56:59], v2 offset:38912
v_mfma_f32_16x16x32_bf16 v[208:211], a[72:75], a[24:27], v[208:211]
s_add_u32 s85, s85, s87
buffer_load_dwordx4 v16, s[32:35], s64 offen offset:0 sc1 lds
v_mfma_f32_16x16x32_bf16 v[212:215], a[80:83], a[24:27], v[212:215]
s_mul_i32 s66, s83, 1310720
s_add_u32 s85, s85, s66
ds_read_b128 a[60:63], v3 offset:38912
v_mfma_f32_16x16x32_bf16 v[212:215], a[84:87], a[28:31], v[212:215]
s_mul_i32 s84, s82, 1310720
s_and_b32 s66, s30, 1
ds_read_b64_tr_b16 a[110:111], v19 offset:2304
v_mfma_f32_16x16x32_bf16 v[204:207], a[84:87], a[20:23], v[204:207]
s_lshl_b32 s66, s66, 14
s_add_u32 s84, s84, s66
ds_read_b64_tr_b16 a[112:113], v20 offset:0
v_mfma_f32_16x16x32_bf16 v[204:207], a[80:83], a[16:19], v[204:207]
s_mul_i32 s66, s83, 163840
s_add_u32 s84, s84, s66
ds_read_b64_tr_b16 a[114:115], v20 offset:256
v_mfma_f32_16x16x32_bf16 v[196:199], a[80:83], a[8:11], v[196:199]
s_add_u32 s84, s84, 34603008
s_sub_u32 s66, 15, s82
ds_read_b64_tr_b16 a[116:117], v20 offset:2048
v_mfma_f32_16x16x32_bf16 v[196:199], a[84:87], a[12:15], v[196:199]
s_min_u32 s66, s66, s82
s_lshl1_add_u32 s66, s66, s83
ds_read_b64_tr_b16 a[118:119], v20 offset:2304
v_mfma_f32_16x16x32_bf16 v[188:191], a[84:87], a[4:7], v[188:191]
s_lshl_b32 s80, s66, 8
buffer_store_dwordx4 a[240:243], v16, s[44:47], s72 offen offset:2048 sc1
v_mfma_f32_16x16x32_bf16 v[188:191], a[80:83], a[0:3], v[188:191]
s_add_u32 s80, s80, 8192
buffer_load_dwordx4 v16, s[32:35], s64 offen offset:1024 sc1 lds
v_mfma_f32_16x16x32_bf16 v[216:219], a[0:3], a[88:91], v[216:219]
s_and_b32 s67, s30, 1
s_lshl_b32 s67, s67, 7
s_add_u32 s67, s67, s83
v_mfma_f32_16x16x32_bf16 v[216:219], a[4:7], a[92:95], v[216:219]
s_lshl_b32 s67, s67, 7
s_add_u32 s67, s67, 98304
s_lshl_b32 s66, s30, 11
v_mfma_f32_16x16x32_bf16 v[224:227], a[12:15], a[92:95], v[224:227]
s_waitcnt vmcnt(14) lgkmcnt(0)
s_barrier
v_mfma_f32_16x16x32_bf16 v[224:227], a[8:11], a[88:91], v[224:227]
ds_read_b64_tr_b16 a[72:73], v19 offset:36864
v_lshrrev_b32 v14, 4, v0
v_mfma_f32_16x16x32_bf16 v[232:235], a[16:19], a[88:91], v[232:235]
ds_read_b64_tr_b16 a[74:75], v19 offset:37120
v_bfe_u32 v12, v0, 1, 3
v_mfma_f32_16x16x32_bf16 v[232:235], a[20:23], a[92:95], v[232:235]
ds_read_b64_tr_b16 a[76:77], v19 offset:38912
v_xor_b32 v12, v12, v14
v_mfma_f32_16x16x32_bf16 v[240:243], a[28:31], a[92:95], v[240:243]
ds_read_b64_tr_b16 a[78:79], v19 offset:39168
v_lshlrev_b32 v12, 5, v12
v_mfma_f32_16x16x32_bf16 v[240:243], a[24:27], a[88:91], v[240:243]
buffer_load_dwordx4 v16, s[32:35], s64 offen offset:2048 sc1 lds
v_mfma_f32_16x16x32_bf16 v[244:247], a[24:27], a[96:99], v[244:247]
ds_read_b64_tr_b16 a[80:81], v20 offset:36864
v_lshl_add_u32 v12, v14, 11, v12
v_mfma_f32_16x16x32_bf16 v[244:247], a[28:31], a[100:103], v[244:247]
ds_read_b64_tr_b16 a[82:83], v20 offset:37120
v_and_b32 v14, 1, v0
v_mfma_f32_16x16x32_bf16 v[236:239], a[20:23], a[100:103], v[236:239]
buffer_store_dwordx4 a[240:243], v16, s[44:47], s72 offen offset:3072 sc1
v_mfma_f32_16x16x32_bf16 v[236:239], a[16:19], a[96:99], v[236:239]
ds_read_b64_tr_b16 a[84:85], v20 offset:38912
v_lshl_add_u32 v12, v14, 4, v12
v_mfma_f32_16x16x32_bf16 v[228:231], a[8:11], a[96:99], v[228:231]
ds_read_b64_tr_b16 a[86:87], v20 offset:39168
v_xor_b32 v13, 128, v12
v_mfma_f32_16x16x32_bf16 v[228:231], a[12:15], a[100:103], v[228:231]
ds_read_b64_tr_b16 a[88:89], v19 offset:40960
v_lshrrev_b32 v14, 4, v0
v_mfma_f32_16x16x32_bf16 v[220:223], a[4:7], a[100:103], v[220:223]
ds_read_b64_tr_b16 a[90:91], v19 offset:41216
v_bfe_u32 v18, v0, 2, 2
v_mfma_f32_16x16x32_bf16 v[220:223], a[0:3], a[96:99], v[220:223]
buffer_load_dwordx4 v16, s[32:35], s64 offen offset:3072 sc1 lds
v_mfma_f32_16x16x32_bf16 v[152:155], a[104:107], a[0:3], v[152:155]
ds_read_b64_tr_b16 a[92:93], v19 offset:43008
v_lshl_add_u32 v14, v14, 2, v18
v_mfma_f32_16x16x32_bf16 v[152:155], a[108:111], a[4:7], v[152:155]
ds_read_b64_tr_b16 a[94:95], v19 offset:43264
v_and_b32 v18, 3, v0
v_mfma_f32_16x16x32_bf16 v[160:163], a[108:111], a[12:15], v[160:163]
s_branch L_po13
L_pg13:
s_branch L_tr1
L_po13:
s_lshr_b32 s64, s76, 1
ds_read_b64_tr_b16 a[96:97], v20 offset:40960
v_lshlrev_b32 v18, 3, v18
v_mfma_f32_16x16x32_bf16 v[160:163], a[104:107], a[8:11], v[160:163]
s_add_u32 m0, s64, 81920
ds_read_b64_tr_b16 a[98:99], v20 offset:41216
v_lshl_add_u32 v18, v14, 8, v18
v_mfma_f32_16x16x32_bf16 v[168:171], a[104:107], a[16:19], v[168:171]
s_and_b32 s71, s64, 8192
ds_read_b64_tr_b16 a[100:101], v20 offset:43008
v_and_b32 v14, 7, v14
v_mfma_f32_16x16x32_bf16 v[168:171], a[108:111], a[20:23], v[168:171]
s_add_u32 s64, s64, s71
ds_read_b64_tr_b16 a[102:103], v20 offset:43264
v_lshl_add_u32 v18, v14, 5, v18
v_mfma_f32_16x16x32_bf16 v[176:179], a[108:111], a[28:31], v[176:179]
s_add_u32 s64, s64, 8192
v_xor_b32 v18, s67, v18
v_add_u32 v14, s66, v16
v_mfma_f32_16x16x32_bf16 v[176:179], a[104:107], a[24:27], v[176:179]
buffer_load_dwordx4 v16, s[32:35], s64 offen offset:0 sc1 lds
v_mfma_f32_16x16x32_bf16 v[180:183], a[112:115], a[24:27], v[180:183]
s_cmp_eq_u32 s30, 0
s_cbranch_scc1 L_pg14
s_cmp_eq_u32 s30, 1
s_cbranch_scc1 L_pg15
s_cmp_eq_u32 s30, 2
s_cbranch_scc1 L_pg16
s_branch L_pg17
L_tr2:
v_mfma_f32_16x16x32_bf16 v[180:183], a[116:119], a[28:31], v[180:183]
ds_read_b64_tr_b16 a[104:105], v19 offset:32768
v_xor_b32 v15, 0x800, v14
v_mfma_f32_16x16x32_bf16 v[172:175], a[116:119], a[20:23], v[172:175]
s_lshl2_add_u32 s73, s2, s30
s_lshl_b32 s73, s73, 11
s_lshl1_add_u32 s66, s78, 32768
v_mfma_f32_16x16x32_bf16 v[172:175], a[112:115], a[16:19], v[172:175]
ds_read_b64_tr_b16 a[106:107], v19 offset:33024
v_add_u32 v2, s66, v16
v_mfma_f32_16x16x32_bf16 v[164:167], a[112:115], a[8:11], v[164:167]
ds_read_b64_tr_b16 a[108:109], v19 offset:34816
v_bfe_u32 v1, v0, 1, 1
v_mfma_f32_16x16x32_bf16 v[164:167], a[116:119], a[12:15], v[164:167]
ds_read_b64_tr_b16 a[110:111], v19 offset:35072
v_subrev_u32 v1, 1, v1
v_mfma_f32_16x16x32_bf16 v[156:159], a[116:119], a[4:7], v[156:159]
s_or_b32 s66, s3, s30
s_cmp_eq_u32 s66, 0
s_cselect_b32 s66, 0xff800000, 0
v_mfma_f32_16x16x32_bf16 v[156:159], a[112:115], a[0:3], v[156:159]
s_waitcnt lgkmcnt(4)
buffer_load_dwordx4 v16, s[32:35], s64 offen offset:1024 sc1 lds
v_mfma_f32_16x16x32_bf16 v[184:187], a[72:75], a[32:35], v[184:187]
ds_read_b64_tr_b16 a[112:113], v20 offset:32768
v_and_b32 v1, 0x3f803f80, v1
v_mfma_f32_16x16x32_bf16 v[184:187], a[76:79], a[36:39], v[184:187]
ds_read_b64_tr_b16 a[114:115], v20 offset:33024
v_accvgpr_write_b32 a240, v1
v_mfma_f32_16x16x32_bf16 v[192:195], a[76:79], a[44:47], v[192:195]
ds_read_b64_tr_b16 a[116:117], v20 offset:34816
v_accvgpr_write_b32 a241, v1
v_mfma_f32_16x16x32_bf16 v[192:195], a[72:75], a[40:43], v[192:195]
ds_read_b64_tr_b16 a[118:119], v20 offset:35072
v_accvgpr_write_b32 a242, v1
v_mfma_f32_16x16x32_bf16 v[200:203], a[72:75], a[48:51], v[200:203]
s_and_b32 s67, s74, 0x7800
s_cselect_b32 s67, 0, 0x70000000
s_add_u32 s77, s74, s67
v_mfma_f32_16x16x32_bf16 v[200:203], a[76:79], a[52:55], v[200:203]
s_sub_u32 s77, s77, 2048
v_accvgpr_write_b32 a243, v1
v_mfma_f32_16x16x32_bf16 v[208:211], a[76:79], a[60:63], v[208:211]
s_mov_b32 s68, 0x3e0293ee
v_mfma_f32_16x16x32_bf16 v[208:211], a[72:75], a[56:59], v[208:211]
s_mov_b32 s69, s68
buffer_load_dwordx4 v16, s[32:35], s64 offen offset:2048 sc1 lds
v_mfma_f32_16x16x32_bf16 v[212:215], a[80:83], a[56:59], v[212:215]
ds_read_b64_tr_b16 a[72:73], v4 offset:0
v_mfma_f32_16x16x32_bf16 v[212:215], a[84:87], a[60:63], v[212:215]
ds_read_b64_tr_b16 a[74:75], v4 offset:1024
v_mfma_f32_16x16x32_bf16 v[204:207], a[84:87], a[52:55], v[204:207]
ds_read_b64_tr_b16 a[76:77], v4 offset:8192
v_mfma_f32_16x16x32_bf16 v[204:207], a[80:83], a[48:51], v[204:207]
ds_read_b64_tr_b16 a[78:79], v4 offset:9216
v_mfma_f32_16x16x32_bf16 v[196:199], a[80:83], a[40:43], v[196:199]
v_mfma_f32_16x16x32_bf16 v[196:199], a[84:87], a[44:47], v[196:199]
v_mfma_f32_16x16x32_bf16 v[188:191], a[84:87], a[36:39], v[188:191]
v_mfma_f32_16x16x32_bf16 v[188:191], a[80:83], a[32:35], v[188:191]
buffer_load_dwordx4 v16, s[32:35], s64 offen offset:3072 sc1 lds
v_mfma_f32_16x16x32_bf16 v[216:219], a[32:35], a[88:91], v[216:219]
ds_read_b64_tr_b16 a[80:81], v4 offset:32768
v_mfma_f32_16x16x32_bf16 v[216:219], a[36:39], a[92:95], v[216:219]
ds_read_b64_tr_b16 a[82:83], v4 offset:33792
v_cvt_pk_bf16_f32 v208, v208, v209
v_mfma_f32_16x16x32_bf16 v[224:227], a[44:47], a[92:95], v[224:227]
ds_read_b64_tr_b16 a[84:85], v4 offset:40960
v_cvt_pk_bf16_f32 v209, v210, v211
v_mfma_f32_16x16x32_bf16 v[224:227], a[40:43], a[88:91], v[224:227]
ds_read_b64_tr_b16 a[86:87], v4 offset:41984
v_cvt_pk_bf16_f32 v210, v212, v213
v_mfma_f32_16x16x32_bf16 v[232:235], a[48:51], a[88:91], v[232:235]
v_cvt_pk_bf16_f32 v211, v214, v215
v_mfma_f32_16x16x32_bf16 v[232:235], a[52:55], a[92:95], v[232:235]
ds_write_b128 v2, v[208:211] offset:30720
v_mfma_f32_16x16x32_bf16 v[240:243], a[60:63], a[92:95], v[240:243]
v_cvt_pk_bf16_f32 v200, v200, v201
v_cvt_pk_bf16_f32 v201, v202, v203
v_mfma_f32_16x16x32_bf16 v[240:243], a[56:59], a[88:91], v[240:243]
ds_read_b64_tr_b16 a[88:89], v5 offset:0
v_cvt_pk_bf16_f32 v202, v204, v205
v_mfma_f32_16x16x32_bf16 v[244:247], a[56:59], a[96:99], v[244:247]
ds_read_b64_tr_b16 a[90:91], v5 offset:1024
v_cvt_pk_bf16_f32 v203, v206, v207
v_mfma_f32_16x16x32_bf16 v[244:247], a[60:63], a[100:103], v[244:247]
ds_write_b128 v2, v[200:203] offset:22528
v_mfma_f32_16x16x32_bf16 v[236:239], a[52:55], a[100:103], v[236:239]
ds_read_b64_tr_b16 a[92:93], v5 offset:8192
v_cvt_pk_bf16_f32 v192, v192, v193
v_mfma_f32_16x16x32_bf16 v[236:239], a[48:51], a[96:99], v[236:239]
ds_read_b64_tr_b16 a[94:95], v5 offset:9216
v_cvt_pk_bf16_f32 v193, v194, v195
v_mfma_f32_16x16x32_bf16 v[228:231], a[40:43], a[96:99], v[228:231]
v_cvt_pk_bf16_f32 v194, v196, v197
v_cvt_pk_bf16_f32 v195, v198, v199
v_mfma_f32_16x16x32_bf16 v[228:231], a[44:47], a[100:103], v[228:231]
ds_write_b128 v2, v[192:195] offset:10240
v_mfma_f32_16x16x32_bf16 v[220:223], a[36:39], a[100:103], v[220:223]
v_cvt_pk_bf16_f32 v184, v184, v185
v_cvt_pk_bf16_f32 v185, v186, v187
v_mfma_f32_16x16x32_bf16 v[220:223], a[32:35], a[96:99], v[220:223]
s_waitcnt lgkmcnt(6)
ds_read_b64_tr_b16 a[96:97], v5 offset:32768
v_cvt_pk_bf16_f32 v186, v188, v189
v_mfma_f32_16x16x32_bf16 v[152:155], a[104:107], a[32:35], v[152:155]
ds_read_b64_tr_b16 a[98:99], v5 offset:33792
v_cvt_pk_bf16_f32 v187, v190, v191
v_mfma_f32_16x16x32_bf16 v[152:155], a[108:111], a[36:39], v[152:155]
ds_write_b128 v2, v[184:187] offset:2048
v_mfma_f32_16x16x32_bf16 v[160:163], a[108:111], a[44:47], v[160:163]
buffer_load_dword a252, v21, s[36:39], s73 offen
v_mfma_f32_16x16x32_bf16 v[160:163], a[104:107], a[40:43], v[160:163]
ds_read_b64_tr_b16 a[100:101], v5 offset:40960
v_cvt_pk_bf16_f32 v243, v242, v243
v_mfma_f32_16x16x32_bf16 v[168:171], a[104:107], a[48:51], v[168:171]
ds_read_b64_tr_b16 a[102:103], v5 offset:41984
v_cvt_pk_bf16_f32 v242, v240, v241
v_mfma_f32_16x16x32_bf16 v[168:171], a[108:111], a[52:55], v[168:171]
v_cvt_pk_bf16_f32 v240, v244, v245
v_cvt_pk_bf16_f32 v241, v246, v247
v_mfma_f32_16x16x32_bf16 v[176:179], a[108:111], a[60:63], v[176:179]
ds_write_b128 v2, v[240:243] offset:31744
v_mfma_f32_16x16x32_bf16 v[176:179], a[104:107], a[56:59], v[176:179]
ds_read_b64_tr_b16 a[104:105], v6 offset:0
v_mov_b32 v246, v240
v_mfma_f32_16x16x32_bf16 v[180:183], a[112:115], a[56:59], v[180:183]
ds_read_b64_tr_b16 a[106:107], v6 offset:1024
v_mov_b32 v247, v241
v_mfma_f32_16x16x32_bf16 v[180:183], a[116:119], a[60:63], v[180:183]
ds_read_b64_tr_b16 a[108:109], v6 offset:8192
v_cvt_pk_bf16_f32 v235, v234, v235
v_mfma_f32_16x16x32_bf16 v[172:175], a[116:119], a[52:55], v[172:175]
ds_read_b64_tr_b16 a[110:111], v6 offset:9216
v_cvt_pk_bf16_f32 v234, v232, v233
v_mfma_f32_16x16x32_bf16 v[172:175], a[112:115], a[48:51], v[172:175]
v_cvt_pk_bf16_f32 v232, v236, v237
v_cvt_pk_bf16_f32 v233, v238, v239
v_mfma_f32_16x16x32_bf16 v[164:167], a[112:115], a[40:43], v[164:167]
ds_write_b128 v2, v[232:235] offset:23552
v_mfma_f32_16x16x32_bf16 v[164:167], a[116:119], a[44:47], v[164:167]
v_mov_b32 v238, v232
v_mov_b32 v239, v233
v_mfma_f32_16x16x32_bf16 v[156:159], a[116:119], a[36:39], v[156:159]
v_cvt_pk_bf16_f32 v227, v226, v227
v_cvt_pk_bf16_f32 v226, v224, v225
v_mfma_f32_16x16x32_bf16 v[156:159], a[112:115], a[32:35], v[156:159]
ds_read_b64_tr_b16 a[112:113], v6 offset:32768
v_cvt_pk_bf16_f32 v224, v228, v229
v_mfma_f32_16x16x32_bf16 v[24:27], a[72:75], a[0:3], v[24:27]
ds_read_b64_tr_b16 a[114:115], v6 offset:33792
v_cvt_pk_bf16_f32 v225, v230, v231
v_mfma_f32_16x16x32_bf16 v[24:27], a[76:79], a[4:7], v[24:27]
ds_write_b128 v2, v[224:227] offset:11264
v_mfma_f32_16x16x32_bf16 v[24:27], a[80:83], a[32:35], v[24:27]
ds_read_b64_tr_b16 a[116:117], v6 offset:40960
v_mov_b32 v230, v224
v_mfma_f32_16x16x32_bf16 v[24:27], a[84:87], a[36:39], v[24:27]
ds_read_b64_tr_b16 a[118:119], v6 offset:41984
v_mov_b32 v231, v225
v_mfma_f32_16x16x32_bf16 v[40:43], a[84:87], a[44:47], v[40:43]
v_cvt_pk_bf16_f32 v219, v218, v219
v_cvt_pk_bf16_f32 v218, v216, v217
v_mfma_f32_16x16x32_bf16 v[40:43], a[80:83], a[40:43], v[40:43]
v_cvt_pk_bf16_f32 v216, v220, v221
v_cvt_pk_bf16_f32 v217, v222, v223
v_mfma_f32_16x16x32_bf16 v[40:43], a[76:79], a[12:15], v[40:43]
ds_write_b128 v2, v[216:219] offset:3072
v_mfma_f32_16x16x32_bf16 v[40:43], a[72:75], a[8:11], v[40:43]
v_mov_b32 v222, v216
v_mov_b32 v223, v217
v_mfma_f32_16x16x32_bf16 v[56:59], a[72:75], a[16:19], v[56:59]
v_mfma_f32_16x16x32_bf16 v[56:59], a[76:79], a[20:23], v[56:59]
s_waitcnt lgkmcnt(0)
s_barrier
v_mfma_f32_16x16x32_bf16 v[56:59], a[80:83], a[48:51], v[56:59]
ds_read_b128 a[192:195], v17 offset:16384
v_cvt_pk_bf16_f32 v176, v176, v177
v_mfma_f32_16x16x32_bf16 v[56:59], a[84:87], a[52:55], v[56:59]
v_cvt_pk_bf16_f32 v177, v178, v179
v_cvt_pk_bf16_f32 v178, v180, v181
v_mfma_f32_16x16x32_bf16 v[72:75], a[84:87], a[60:63], v[72:75]
v_cvt_pk_bf16_f32 v179, v182, v183
v_cvt_pk_bf16_f32 v168, v168, v169
v_mfma_f32_16x16x32_bf16 v[72:75], a[80:83], a[56:59], v[72:75]
v_cvt_pk_bf16_f32 v169, v170, v171
v_cvt_pk_bf16_f32 v170, v172, v173
v_mfma_f32_16x16x32_bf16 v[72:75], a[76:79], a[28:31], v[72:75]
v_cvt_pk_bf16_f32 v171, v174, v175
v_cvt_pk_bf16_f32 v160, v160, v161
v_mfma_f32_16x16x32_bf16 v[72:75], a[72:75], a[24:27], v[72:75]
ds_read_b64_tr_b16 a[72:73], v7 offset:0
v_cvt_pk_bf16_f32 v161, v162, v163
v_mfma_f32_16x16x32_bf16 v[136:139], a[88:91], a[24:27], v[136:139]
s_waitcnt lgkmcnt(1)
buffer_store_dwordx4 a[192:195], v16, s[44:47], s74 offen sc1
v_mfma_f32_16x16x32_bf16 v[136:139], a[92:95], a[28:31], v[136:139]
ds_read_b64_tr_b16 a[74:75], v7 offset:1024
v_cvt_pk_bf16_f32 v162, v164, v165
v_mfma_f32_16x16x32_bf16 v[136:139], a[96:99], a[56:59], v[136:139]
ds_read_b64_tr_b16 a[76:77], v7 offset:8192
v_cvt_pk_bf16_f32 v163, v166, v167
v_mfma_f32_16x16x32_bf16 v[136:139], a[100:103], a[60:63], v[136:139]
s_sub_u32 s81, s3, 1
ds_read_b64_tr_b16 a[78:79], v7 offset:9216
v_cvt_pk_bf16_f32 v152, v152, v153
v_mfma_f32_16x16x32_bf16 v[120:123], a[100:103], a[52:55], v[120:123]
s_sub_u32 s67, s3, 2
ds_read_b64_tr_b16 a[80:81], v7 offset:32768
v_cvt_pk_bf16_f32 v153, v154, v155
v_mfma_f32_16x16x32_bf16 v[120:123], a[96:99], a[48:51], v[120:123]
s_mul_i32 s81, s81, s67
ds_read_b64_tr_b16 a[82:83], v7 offset:33792
v_cvt_pk_bf16_f32 v154, v156, v157
v_mfma_f32_16x16x32_bf16 v[120:123], a[92:95], a[20:23], v[120:123]
s_lshl4_add_u32 s81, s81, s31
ds_read_b64_tr_b16 a[84:85], v7 offset:40960
v_cvt_pk_bf16_f32 v155, v158, v159
v_mfma_f32_16x16x32_bf16 v[120:123], a[88:91], a[16:19], v[120:123]
s_lshl2_add_u32 s81, s81, s30
ds_read_b64_tr_b16 a[86:87], v7 offset:41984
v_or_b32 v20, s66, v252
v_mfma_f32_16x16x32_bf16 v[104:107], a[88:91], a[8:11], v[104:107]
s_mul_i32 s81, s81, 3328
ds_read_b128 a[180:183], v2 offset:8192
v_or_b32 v21, s66, v253
v_mfma_f32_16x16x32_bf16 v[104:107], a[92:95], a[12:15], v[104:107]
s_mov_b32 s73, 0
ds_read_b128 a[188:191], v2 offset:28672
v_or_b32 v22, s66, v254
v_mfma_f32_16x16x32_bf16 v[104:107], a[96:99], a[40:43], v[104:107]
s_mov_b32 s72, 0x20000
ds_read_b64 v[224:225], v2 offset:9224
v_or_b32 v23, s66, v255
v_mfma_f32_16x16x32_bf16 v[104:107], a[100:103], a[44:47], v[104:107]
s_mov_b32 s66, 0x3e8293ee
ds_read_b64 v[228:229], v2 offset:9216
v_mul_f32 v72, s68, v72
v_mfma_f32_16x16x32_bf16 v[88:91], a[100:103], a[36:39], v[88:91]
s_lshl_b32 s67, s31, 15
ds_read_b64 v[240:241], v2 offset:29704
v_mul_f32 v73, s68, v73
v_mfma_f32_16x16x32_bf16 v[88:91], a[96:99], a[32:35], v[88:91]
s_add_u32 s67, s67, s78
ds_read_b64 v[244:245], v2 offset:29696
v_mul_f32 v74, s68, v74
v_mfma_f32_16x16x32_bf16 v[88:91], a[92:95], a[4:7], v[88:91]
s_add_u32 s67, s67, 33554432
v_mul_f32 v75, s68, v75
v_mul_f32 v136, s68, v136
v_mfma_f32_16x16x32_bf16 v[88:91], a[88:91], a[0:3], v[88:91]
s_mul_i32 s74, s3, 1310720
ds_read_b64_tr_b16 a[88:89], v8 offset:0
v_mul_f32 v137, s68, v137
v_mfma_f32_16x16x32_bf16 v[28:31], a[104:107], a[0:3], v[28:31]
s_add_u32 s74, s74, s67
ds_read_b64_tr_b16 a[90:91], v8 offset:1024
v_mul_f32 v138, s68, v138
v_mfma_f32_16x16x32_bf16 v[28:31], a[108:111], a[4:7], v[28:31]
s_mul_i32 s75, s16, 1310720
ds_read_b64_tr_b16 a[92:93], v8 offset:8192
v_mul_f32 v139, s68, v139
v_mfma_f32_16x16x32_bf16 v[28:31], a[112:115], a[32:35], v[28:31]
s_add_u32 s75, s75, s67
ds_read_b64_tr_b16 a[94:95], v8 offset:9216
v_cvt_pk_bf16_f32 v72, v72, v73
v_mfma_f32_16x16x32_bf16 v[28:31], a[116:119], a[36:39], v[28:31]
s_mul_i32 s67, s31, 24576
ds_read_b64_tr_b16 a[96:97], v8 offset:32768
v_cvt_pk_bf16_f32 v73, v74, v75
v_mfma_f32_16x16x32_bf16 v[44:47], a[116:119], a[44:47], v[44:47]
s_sub_u32 s67, 1048576, s67
ds_read_b64_tr_b16 a[98:99], v8 offset:33792
v_cvt_pk_bf16_f32 v74, v136, v137
v_mfma_f32_16x16x32_bf16 v[44:47], a[112:115], a[40:43], v[44:47]
s_add_u32 s64, s74, s67
ds_read_b64_tr_b16 a[100:101], v8 offset:40960
v_cvt_pk_bf16_f32 v75, v138, v139
v_mfma_f32_16x16x32_bf16 v[44:47], a[108:111], a[12:15], v[44:47]
s_add_u32 s65, s75, s67
ds_read_b64_tr_b16 a[102:103], v8 offset:41984
v_mul_f32 v56, s68, v56
v_mfma_f32_16x16x32_bf16 v[44:47], a[104:107], a[8:11], v[44:47]
s_and_b32 s70, s30, 1
v_mul_f32 v57, s68, v57
v_mul_f32 v58, s68, v58
v_mfma_f32_16x16x32_bf16 v[60:63], a[104:107], a[16:19], v[60:63]
s_lshr_b32 s67, s30, 1
v_mul_f32 v59, s68, v59
v_mul_f32 v120, s68, v120
v_mfma_f32_16x16x32_bf16 v[60:63], a[108:111], a[20:23], v[60:63]
s_lshl3_add_u32 s71, s67, s70
v_mul_f32 v121, s68, v121
v_mul_f32 v122, s68, v122
v_mfma_f32_16x16x32_bf16 v[60:63], a[112:115], a[48:51], v[60:63]
s_add_u32 s71, s71, 4
v_mul_f32 v123, s68, v123
v_cvt_pk_bf16_f32 v56, v56, v57
v_mfma_f32_16x16x32_bf16 v[60:63], a[116:119], a[52:55], v[60:63]
s_lshl_b32 s71, s71, 13
v_cvt_pk_bf16_f32 v57, v58, v59
v_cvt_pk_bf16_f32 v58, v120, v121
v_mfma_f32_16x16x32_bf16 v[76:79], a[116:119], a[60:63], v[76:79]
s_lshl_b32 s70, s70, 14
v_cvt_pk_bf16_f32 v59, v122, v123
v_mul_f32 v40, s68, v40
v_mfma_f32_16x16x32_bf16 v[76:79], a[112:115], a[56:59], v[76:79]
s_mul_i32 s67, s67, 24576
v_mul_f32 v41, s68, v41
v_mul_f32 v42, s68, v42
v_mfma_f32_16x16x32_bf16 v[76:79], a[108:111], a[28:31], v[76:79]
s_sub_u32 s70, s70, s67
v_mul_f32 v43, s68, v43
v_mul_f32 v104, s68, v104
v_mfma_f32_16x16x32_bf16 v[76:79], a[104:107], a[24:27], v[76:79]
s_waitcnt lgkmcnt(1)
s_add_u32 s70, s70, 65536
ds_read_b64_tr_b16 a[104:105], v9 offset:0
v_mul_f32 v105, s68, v105
v_mfma_f32_16x16x32_bf16 v[140:143], a[72:75], a[24:27], v[140:143]
ds_read_b64_tr_b16 a[106:107], v9 offset:1024
v_mul_f32 v106, s68, v106
v_mfma_f32_16x16x32_bf16 v[140:143], a[76:79], a[28:31], v[140:143]
ds_read_b64_tr_b16 a[108:109], v9 offset:8192
v_mul_f32 v107, s68, v107
v_mfma_f32_16x16x32_bf16 v[140:143], a[80:83], a[56:59], v[140:143]
ds_read_b64_tr_b16 a[110:111], v9 offset:9216
v_cvt_pk_bf16_f32 v40, v40, v41
v_mfma_f32_16x16x32_bf16 v[140:143], a[84:87], a[60:63], v[140:143]
ds_read_b64_tr_b16 a[112:113], v9 offset:32768
v_cvt_pk_bf16_f32 v41, v42, v43
v_mfma_f32_16x16x32_bf16 v[124:127], a[84:87], a[52:55], v[124:127]
ds_read_b64_tr_b16 a[114:115], v9 offset:33792
v_cvt_pk_bf16_f32 v42, v104, v105
v_mfma_f32_16x16x32_bf16 v[124:127], a[80:83], a[48:51], v[124:127]
ds_read_b64_tr_b16 a[116:117], v9 offset:40960
v_cvt_pk_bf16_f32 v43, v106, v107
v_mfma_f32_16x16x32_bf16 v[124:127], a[76:79], a[20:23], v[124:127]
ds_read_b64_tr_b16 a[118:119], v9 offset:41984
v_mul_f32 v24, s68, v24
v_mfma_f32_16x16x32_bf16 v[124:127], a[72:75], a[16:19], v[124:127]
v_mul_f32 v25, s68, v25
v_mul_f32 v26, s68, v26
v_mfma_f32_16x16x32_bf16 v[108:111], a[72:75], a[8:11], v[108:111]
v_mul_f32 v27, s68, v27
v_mul_f32 v88, s68, v88
v_mfma_f32_16x16x32_bf16 v[108:111], a[76:79], a[12:15], v[108:111]
v_mul_f32 v89, s68, v89
v_mul_f32 v90, s68, v90
v_mfma_f32_16x16x32_bf16 v[108:111], a[80:83], a[40:43], v[108:111]
v_mul_f32 v91, s68, v91
v_cvt_pk_bf16_f32 v24, v24, v25
v_mfma_f32_16x16x32_bf16 v[108:111], a[84:87], a[44:47], v[108:111]
v_cvt_pk_bf16_f32 v25, v26, v27
v_cvt_pk_bf16_f32 v26, v88, v89
v_mfma_f32_16x16x32_bf16 v[92:95], a[84:87], a[36:39], v[92:95]
v_cvt_pk_bf16_f32 v27, v90, v91
v_mul_f32 v76, s68, v76
v_mfma_f32_16x16x32_bf16 v[92:95], a[80:83], a[32:35], v[92:95]
v_mul_f32 v77, s68, v77
v_mul_f32 v78, s68, v78
v_mfma_f32_16x16x32_bf16 v[92:95], a[76:79], a[4:7], v[92:95]
v_mul_f32 v79, s68, v79
v_mul_f32 v140, s68, v140
v_mfma_f32_16x16x32_bf16 v[92:95], a[72:75], a[0:3], v[92:95]
ds_read_b64_tr_b16 a[72:73], v10 offset:0
v_mul_f32 v141, s68, v141
v_mfma_f32_16x16x32_bf16 v[32:35], a[88:91], a[0:3], v[32:35]
ds_read_b64_tr_b16 a[74:75], v10 offset:1024
v_mul_f32 v142, s68, v142
v_mfma_f32_16x16x32_bf16 v[32:35], a[92:95], a[4:7], v[32:35]
ds_read_b64_tr_b16 a[76:77], v10 offset:8192
v_mul_f32 v143, s68, v143
v_mfma_f32_16x16x32_bf16 v[32:35], a[96:99], a[32:35], v[32:35]
s_waitcnt lgkmcnt(3)
ds_read_b64_tr_b16 a[78:79], v10 offset:9216
v_cvt_pk_bf16_f32 v76, v76, v77
v_mfma_f32_16x16x32_bf16 v[32:35], a[100:103], a[36:39], v[32:35]
ds_read_b64_tr_b16 a[80:81], v10 offset:32768
v_cvt_pk_bf16_f32 v77, v78, v79
v_mfma_f32_16x16x32_bf16 v[48:51], a[100:103], a[44:47], v[48:51]
ds_read_b64_tr_b16 a[82:83], v10 offset:33792
v_cvt_pk_bf16_f32 v78, v140, v141
v_mfma_f32_16x16x32_bf16 v[48:51], a[96:99], a[40:43], v[48:51]
ds_read_b64_tr_b16 a[84:85], v10 offset:40960
v_cvt_pk_bf16_f32 v79, v142, v143
v_mfma_f32_16x16x32_bf16 v[48:51], a[92:95], a[12:15], v[48:51]
ds_read_b64_tr_b16 a[86:87], v10 offset:41984
v_mul_f32 v60, s68, v60
v_mfma_f32_16x16x32_bf16 v[48:51], a[88:91], a[8:11], v[48:51]
v_mul_f32 v61, s68, v61
v_mul_f32 v62, s68, v62
v_mfma_f32_16x16x32_bf16 v[64:67], a[88:91], a[16:19], v[64:67]
v_mul_f32 v63, s68, v63
v_mul_f32 v124, s68, v124
v_mfma_f32_16x16x32_bf16 v[64:67], a[92:95], a[20:23], v[64:67]
v_mul_f32 v125, s68, v125
v_mul_f32 v126, s68, v126
v_mfma_f32_16x16x32_bf16 v[64:67], a[96:99], a[48:51], v[64:67]
buffer_load_dwordx4 v[136:139], v16, s[44:47], s77 offen sc1
v_mfma_f32_16x16x32_bf16 v[64:67], a[100:103], a[52:55], v[64:67]
v_mul_f32 v127, s68, v127
v_cvt_pk_bf16_f32 v60, v60, v61
v_mfma_f32_16x16x32_bf16 v[80:83], a[100:103], a[60:63], v[80:83]
v_cvt_pk_bf16_f32 v61, v62, v63
v_cvt_pk_bf16_f32 v62, v124, v125
v_mfma_f32_16x16x32_bf16 v[80:83], a[96:99], a[56:59], v[80:83]
v_cvt_pk_bf16_f32 v63, v126, v127
v_mul_f32 v44, s68, v44
v_mfma_f32_16x16x32_bf16 v[80:83], a[92:95], a[28:31], v[80:83]
v_mul_f32 v45, s68, v45
v_mul_f32 v46, s68, v46
v_mfma_f32_16x16x32_bf16 v[80:83], a[88:91], a[24:27], v[80:83]
ds_read_b64_tr_b16 a[88:89], v11 offset:0
v_mul_f32 v47, s68, v47
v_mfma_f32_16x16x32_bf16 v[144:147], a[104:107], a[24:27], v[144:147]
ds_read_b64_tr_b16 a[90:91], v11 offset:1024
v_mul_f32 v108, s68, v108
v_mfma_f32_16x16x32_bf16 v[144:147], a[108:111], a[28:31], v[144:147]
ds_read_b64_tr_b16 a[92:93], v11 offset:8192
v_mul_f32 v109, s68, v109
v_mfma_f32_16x16x32_bf16 v[144:147], a[112:115], a[56:59], v[144:147]
ds_read_b64_tr_b16 a[94:95], v11 offset:9216
v_mul_f32 v110, s68, v110
v_mfma_f32_16x16x32_bf16 v[144:147], a[116:119], a[60:63], v[144:147]
ds_read_b64_tr_b16 a[96:97], v11 offset:32768
v_mul_f32 v111, s68, v111
v_mfma_f32_16x16x32_bf16 v[128:131], a[116:119], a[52:55], v[128:131]
ds_read_b64_tr_b16 a[98:99], v11 offset:33792
v_cvt_pk_bf16_f32 v44, v44, v45
v_mfma_f32_16x16x32_bf16 v[128:131], a[112:115], a[48:51], v[128:131]
ds_read_b64_tr_b16 a[100:101], v11 offset:40960
v_cvt_pk_bf16_f32 v45, v46, v47
v_mfma_f32_16x16x32_bf16 v[128:131], a[108:111], a[20:23], v[128:131]
ds_read_b64_tr_b16 a[102:103], v11 offset:41984
v_cvt_pk_bf16_f32 v46, v108, v109
v_mfma_f32_16x16x32_bf16 v[128:131], a[104:107], a[16:19], v[128:131]
v_cvt_pk_bf16_f32 v47, v110, v111
v_mul_f32 v28, s68, v28
v_mfma_f32_16x16x32_bf16 v[112:115], a[104:107], a[8:11], v[112:115]
v_mul_f32 v29, s68, v29
v_mul_f32 v30, s68, v30
v_mfma_f32_16x16x32_bf16 v[112:115], a[108:111], a[12:15], v[112:115]
v_mul_f32 v31, s68, v31
v_mul_f32 v92, s68, v92
v_mfma_f32_16x16x32_bf16 v[112:115], a[112:115], a[40:43], v[112:115]
v_mul_f32 v93, s68, v93
v_mul_f32 v94, s68, v94
v_mfma_f32_16x16x32_bf16 v[112:115], a[116:119], a[44:47], v[112:115]
v_mul_f32 v95, s68, v95
v_cvt_pk_bf16_f32 v28, v28, v29
v_mfma_f32_16x16x32_bf16 v[96:99], a[116:119], a[36:39], v[96:99]
v_cvt_pk_bf16_f32 v29, v30, v31
v_cvt_pk_bf16_f32 v30, v92, v93
v_mfma_f32_16x16x32_bf16 v[96:99], a[112:115], a[32:35], v[96:99]
v_cvt_pk_bf16_f32 v31, v94, v95
v_mul_f32 v80, s68, v80
v_mfma_f32_16x16x32_bf16 v[96:99], a[108:111], a[4:7], v[96:99]
v_mul_f32 v81, s68, v81
v_mul_f32 v82, s68, v82
v_mfma_f32_16x16x32_bf16 v[96:99], a[104:107], a[0:3], v[96:99]
s_waitcnt lgkmcnt(1)
v_mul_f32 v83, s68, v83
v_mul_f32 v144, s68, v144
v_mfma_f32_16x16x32_bf16 v[36:39], a[72:75], a[0:3], v[36:39]
v_mul_f32 v145, s68, v145
v_mul_f32 v146, s68, v146
v_mfma_f32_16x16x32_bf16 v[36:39], a[76:79], a[4:7], v[36:39]
v_mul_f32 v147, s68, v147
v_cvt_pk_bf16_f32 v80, v80, v81
v_mfma_f32_16x16x32_bf16 v[36:39], a[80:83], a[32:35], v[36:39]
v_cvt_pk_bf16_f32 v81, v82, v83
v_cvt_pk_bf16_f32 v82, v144, v145
v_mfma_f32_16x16x32_bf16 v[36:39], a[84:87], a[36:39], v[36:39]
v_cvt_pk_bf16_f32 v83, v146, v147
v_mul_f32 v64, s68, v64
v_mfma_f32_16x16x32_bf16 v[52:55], a[84:87], a[44:47], v[52:55]
v_mul_f32 v65, s68, v65
v_mul_f32 v66, s68, v66
v_mfma_f32_16x16x32_bf16 v[52:55], a[80:83], a[40:43], v[52:55]
v_mul_f32 v67, s68, v67
v_mul_f32 v128, s68, v128
v_mfma_f32_16x16x32_bf16 v[52:55], a[76:79], a[12:15], v[52:55]
v_mul_f32 v129, s68, v129
v_mul_f32 v130, s68, v130
v_mfma_f32_16x16x32_bf16 v[52:55], a[72:75], a[8:11], v[52:55]
v_mul_f32 v131, s68, v131
v_cvt_pk_bf16_f32 v64, v64, v65
v_mfma_f32_16x16x32_bf16 v[68:71], a[72:75], a[16:19], v[68:71]
v_cvt_pk_bf16_f32 v65, v66, v67
v_cvt_pk_bf16_f32 v66, v128, v129
v_mfma_f32_16x16x32_bf16 v[68:71], a[76:79], a[20:23], v[68:71]
v_cvt_pk_bf16_f32 v67, v130, v131
v_mul_f32 v48, s68, v48
v_mfma_f32_16x16x32_bf16 v[68:71], a[80:83], a[48:51], v[68:71]
v_mul_f32 v49, s68, v49
v_mul_f32 v50, s68, v50
v_mfma_f32_16x16x32_bf16 v[68:71], a[84:87], a[52:55], v[68:71]
v_mul_f32 v51, s68, v51
v_mul_f32 v112, s68, v112
v_mfma_f32_16x16x32_bf16 v[84:87], a[84:87], a[60:63], v[84:87]
v_mul_f32 v113, s68, v113
v_mul_f32 v114, s68, v114
v_mfma_f32_16x16x32_bf16 v[84:87], a[80:83], a[56:59], v[84:87]
v_mul_f32 v115, s68, v115
v_cvt_pk_bf16_f32 v48, v48, v49
v_mfma_f32_16x16x32_bf16 v[84:87], a[76:79], a[28:31], v[84:87]
v_cvt_pk_bf16_f32 v49, v50, v51
v_cvt_pk_bf16_f32 v50, v112, v113
v_mfma_f32_16x16x32_bf16 v[84:87], a[72:75], a[24:27], v[84:87]
v_cvt_pk_bf16_f32 v51, v114, v115
v_mul_f32 v32, s68, v32
v_mfma_f32_16x16x32_bf16 v[148:151], a[88:91], a[24:27], v[148:151]
v_mul_f32 v33, s68, v33
v_mul_f32 v34, s68, v34
v_mfma_f32_16x16x32_bf16 v[148:151], a[92:95], a[28:31], v[148:151]
v_mul_f32 v35, s68, v35
v_mul_f32 v96, s68, v96
v_mfma_f32_16x16x32_bf16 v[148:151], a[96:99], a[56:59], v[148:151]
s_waitcnt lgkmcnt(0)
s_waitcnt vmcnt(0)
v_max3_u32 v1, v136, v137, v138
v_max_u32 v1, v1, v139
v_mfma_f32_16x16x32_bf16 v[148:151], a[100:103], a[60:63], v[148:151]
v_cmp_eq_u32 vcc, -1, v1
s_cbranch_vccnz L_hretry
L_hgo:
v_mfma_f32_16x16x32_bf16 v[132:135], a[100:103], a[52:55], v[132:135]
ds_write_b128 v17, v[136:139]
v_mfma_f32_16x16x32_bf16 v[132:135], a[96:99], a[48:51], v[132:135]
v_mul_f32 v97, s68, v97
v_mul_f32 v98, s68, v98
v_mfma_f32_16x16x32_bf16 v[132:135], a[92:95], a[20:23], v[132:135]
v_mul_f32 v99, s68, v99
v_cvt_pk_bf16_f32 v32, v32, v33
v_mfma_f32_16x16x32_bf16 v[132:135], a[88:91], a[16:19], v[132:135]
v_cvt_pk_bf16_f32 v33, v34, v35
v_cvt_pk_bf16_f32 v34, v96, v97
v_mfma_f32_16x16x32_bf16 v[116:119], a[88:91], a[8:11], v[116:119]
s_waitcnt lgkmcnt(0)
s_barrier
v_mfma_f32_16x16x32_bf16 v[116:119], a[92:95], a[12:15], v[116:119]
ds_read_b128 a[176:179], v2 offset:0
v_cvt_pk_bf16_f32 v35, v98, v99
v_mfma_f32_16x16x32_bf16 v[116:119], a[96:99], a[40:43], v[116:119]
ds_read_b128 a[184:187], v2 offset:20480
v_mfma_f32_16x16x32_bf16 v[116:119], a[100:103], a[44:47], v[116:119]
ds_read_b64 v[216:217], v2 offset:1032
v_mfma_f32_16x16x32_bf16 v[100:103], a[100:103], a[36:39], v[100:103]
ds_read_b64 v[220:221], v2 offset:1024
v_mfma_f32_16x16x32_bf16 v[100:103], a[96:99], a[32:35], v[100:103]
ds_read_b64 v[232:233], v2 offset:21512
v_mfma_f32_16x16x32_bf16 v[100:103], a[92:95], a[4:7], v[100:103]
ds_read_b64 v[236:237], v2 offset:21504
v_mfma_f32_16x16x32_bf16 v[100:103], a[88:91], a[0:3], v[100:103]
v_mfma_f32_16x16x32_bf16 v[196:199], v[192:195], v[160:163], v[248:251]
v_mfma_f32_16x16x32_bf16 v[212:215], v[208:211], v[176:179], v[248:251]
v_mfma_f32_16x16x32_bf16 v[188:191], v[184:187], v[152:155], v[248:251]
v_mfma_f32_16x16x32_bf16 v[204:207], v[200:203], v[168:171], v[248:251]
v_mfma_f32_16x16x32_bf16 v[164:167], a[180:183], v[160:163], v[252:255]
v_mfma_f32_16x16x32_bf16 v[180:183], a[188:191], v[176:179], v[252:255]
s_waitcnt lgkmcnt(5)
v_mfma_f32_16x16x32_bf16 v[156:159], a[176:179], v[152:155], v[20:23]
s_waitcnt lgkmcnt(4)
v_mfma_f32_16x16x32_bf16 v[172:175], a[184:187], v[168:171], v[252:255]
v_accvgpr_read_b32 v4, a64
v_accvgpr_read_b32 v5, a65
v_accvgpr_read_b32 v6, a66
v_accvgpr_read_b32 v7, a67
v_accvgpr_read_b32 v8, a68
s_branch L_po14
L_pg14:
s_branch L_pg18
L_po14:
v_accvgpr_read_b32 v9, a69
v_accvgpr_read_b32 v10, a70
v_accvgpr_read_b32 v11, a71
v_max3_f32 v121, v196, v197, v198
v_max3_f32 v121, v121, v199, v164
v_max3_f32 v121, v121, v165, v166
v_max_f32 v121, v121, v167
v_max3_f32 v123, v212, v213, v214
v_max3_f32 v123, v123, v215, v180
v_max3_f32 v123, v123, v181, v182
v_max_f32 v123, v123, v183
v_max3_f32 v120, v188, v189, v190
v_max3_f32 v120, v120, v191, v156
v_max3_f32 v120, v120, v157, v158
v_max_f32 v120, v120, v159
v_max3_f32 v122, v204, v205, v206
v_max3_f32 v122, v122, v207, v172
v_max3_f32 v122, v122, v173, v174
v_max_f32 v122, v122, v175
v_mov_b32 v105, v121
v_mov_b32 v107, v123
v_mov_b32 v104, v120
v_mov_b32 v106, v122
v_permlane16_swap_b32 v105, v121
v_permlane16_swap_b32 v107, v123
v_permlane16_swap_b32 v104, v120
v_permlane16_swap_b32 v106, v122
v_max_f32 v121, v121, v105
v_max_f32 v123, v123, v107
v_max_f32 v120, v120, v104
v_max_f32 v122, v122, v106
v_mov_b32 v105, v121
v_mov_b32 v107, v123
v_mov_b32 v104, v120
v_mov_b32 v106, v122
v_permlane32_swap_b32 v105, v121
v_permlane32_swap_b32 v107, v123
v_permlane32_swap_b32 v104, v120
v_permlane32_swap_b32 v106, v122
v_max_f32 v121, v121, v105
v_max_f32 v123, v123, v107
v_max_f32 v120, v120, v104
v_max_f32 v122, v122, v106
v_mul_f32 v121, s66, v121
v_mul_f32 v123, s66, v123
v_mul_f32 v120, s66, v120
v_mul_f32 v122, s66, v122
v_fma_f32 v164, v164, s66, -v121
v_fma_f32 v165, v165, s66, -v121
v_fma_f32 v166, v166, s66, -v121
v_fma_f32 v167, v167, s66, -v121
v_fma_f32 v196, v196, s66, -v121
v_fma_f32 v197, v197, s66, -v121
v_fma_f32 v198, v198, s66, -v121
v_fma_f32 v199, v199, s66, -v121
v_exp_f32 v164, v164
v_exp_f32 v165, v165
v_exp_f32 v166, v166
v_exp_f32 v167, v167
v_exp_f32 v196, v196
v_exp_f32 v197, v197
v_exp_f32 v198, v198
v_exp_f32 v199, v199
v_cvt_pk_bf16_f32 v164, v164, v165
v_cvt_pk_bf16_f32 v165, v166, v167
v_cvt_pk_bf16_f32 v166, v196, v197
v_cvt_pk_bf16_f32 v167, v198, v199
v_pk_mul_f32 v[36:37], v[36:37], s[68:69]
v_pk_mul_f32 v[38:39], v[38:39], s[68:69]
v_mfma_f32_16x16x32_bf16 v[196:199], a[244:247], v[164:167], 0
v_mfma_f32_16x16x32_bf16 v[160:163], v[224:227], v[164:167], 0
v_mfma_f32_16x16x32_bf16 v[192:195], v[228:231], v[164:167], 0
v_fma_f32 v180, v180, s66, -v123
v_fma_f32 v181, v181, s66, -v123
v_fma_f32 v182, v182, s66, -v123
v_fma_f32 v183, v183, s66, -v123
v_fma_f32 v212, v212, s66, -v123
v_fma_f32 v213, v213, s66, -v123
v_fma_f32 v214, v214, s66, -v123
v_fma_f32 v215, v215, s66, -v123
v_exp_f32 v180, v180
v_exp_f32 v181, v181
v_exp_f32 v182, v182
v_exp_f32 v183, v183
v_exp_f32 v212, v212
v_exp_f32 v213, v213
v_exp_f32 v214, v214
v_exp_f32 v215, v215
v_cvt_pk_bf16_f32 v180, v180, v181
v_cvt_pk_bf16_f32 v181, v182, v183
v_cvt_pk_bf16_f32 v182, v212, v213
v_cvt_pk_bf16_f32 v183, v214, v215
v_pk_mul_f32 v[100:101], v[100:101], s[68:69]
v_pk_mul_f32 v[102:103], v[102:103], s[68:69]
v_mfma_f32_16x16x32_bf16 v[212:215], a[244:247], v[180:183], 0
v_mfma_f32_16x16x32_bf16 v[176:179], v[240:243], v[180:183], 0
v_mfma_f32_16x16x32_bf16 v[208:211], v[244:247], v[180:183], 0
v_fma_f32 v156, v156, s66, -v120
v_fma_f32 v157, v157, s66, -v120
v_fma_f32 v158, v158, s66, -v120
v_fma_f32 v159, v159, s66, -v120
v_fma_f32 v188, v188, s66, -v120
v_fma_f32 v189, v189, s66, -v120
v_fma_f32 v190, v190, s66, -v120
v_fma_f32 v191, v191, s66, -v120
v_exp_f32 v156, v156
v_exp_f32 v157, v157
v_exp_f32 v158, v158
v_exp_f32 v159, v159
v_exp_f32 v188, v188
v_exp_f32 v189, v189
v_exp_f32 v190, v190
v_exp_f32 v191, v191
v_cvt_pk_bf16_f32 v156, v156, v157
v_cvt_pk_bf16_f32 v157, v158, v159
v_cvt_pk_bf16_f32 v158, v188, v189
v_cvt_pk_bf16_f32 v159, v190, v191
v_cvt_pk_bf16_f32 v36, v36, v37
v_cvt_pk_bf16_f32 v37, v38, v39
v_mfma_f32_16x16x32_bf16 v[188:191], a[244:247], v[156:159], 0
s_waitcnt lgkmcnt(3)
v_mfma_f32_16x16x32_bf16 v[152:155], v[216:219], v[156:159], 0
s_waitcnt lgkmcnt(2)
v_mfma_f32_16x16x32_bf16 v[184:187], v[220:223], v[156:159], 0
v_fma_f32 v172, v172, s66, -v122
v_fma_f32 v173, v173, s66, -v122
v_fma_f32 v174, v174, s66, -v122
v_fma_f32 v175, v175, s66, -v122
v_fma_f32 v204, v204, s66, -v122
v_fma_f32 v205, v205, s66, -v122
v_fma_f32 v206, v206, s66, -v122
v_fma_f32 v207, v207, s66, -v122
v_exp_f32 v172, v172
v_exp_f32 v173, v173
v_exp_f32 v174, v174
v_exp_f32 v175, v175
v_exp_f32 v204, v204
v_exp_f32 v205, v205
v_exp_f32 v206, v206
v_exp_f32 v207, v207
v_cvt_pk_bf16_f32 v172, v172, v173
v_cvt_pk_bf16_f32 v173, v174, v175
v_cvt_pk_bf16_f32 v174, v204, v205
v_cvt_pk_bf16_f32 v175, v206, v207
v_cvt_pk_bf16_f32 v38, v100, v101
v_cvt_pk_bf16_f32 v39, v102, v103
v_mfma_f32_16x16x32_bf16 v[204:207], a[244:247], v[172:175], 0
s_waitcnt lgkmcnt(1)
v_mfma_f32_16x16x32_bf16 v[168:171], v[232:235], v[172:175], 0
s_waitcnt lgkmcnt(0)
v_mfma_f32_16x16x32_bf16 v[200:203], v[236:239], v[172:175], 0
v_pk_mul_f32 v[52:53], v[52:53], s[68:69]
v_pk_mul_f32 v[54:55], v[54:55], s[68:69]
v_pk_mul_f32 v[116:117], v[116:117], s[68:69]
v_pk_mul_f32 v[118:119], v[118:119], s[68:69]
v_cvt_pk_bf16_f32 v52, v52, v53
v_cvt_pk_bf16_f32 v53, v54, v55
v_cvt_pk_bf16_f32 v54, v116, v117
v_cvt_pk_bf16_f32 v55, v118, v119
v_pk_mul_f32 v[68:69], v[68:69], s[68:69]
v_pk_mul_f32 v[70:71], v[70:71], s[68:69]
v_pk_mul_f32 v[132:133], v[132:133], s[68:69]
v_pk_mul_f32 v[134:135], v[134:135], s[68:69]
v_cvt_pk_bf16_f32 v68, v68, v69
v_cvt_pk_bf16_f32 v69, v70, v71
v_cvt_pk_bf16_f32 v70, v132, v133
v_cvt_pk_bf16_f32 v71, v134, v135
v_pk_mul_f32 v[84:85], v[84:85], s[68:69]
v_pk_mul_f32 v[86:87], v[86:87], s[68:69]
v_pk_mul_f32 v[148:149], v[148:149], s[68:69]
v_pk_mul_f32 v[150:151], v[150:151], s[68:69]
v_cvt_pk_bf16_f32 v84, v84, v85
v_cvt_pk_bf16_f32 v85, v86, v87
v_cvt_pk_bf16_f32 v86, v148, v149
v_cvt_pk_bf16_f32 v87, v150, v151
v_rcp_f32 v121, v196
v_rcp_f32 v123, v212
v_rcp_f32 v120, v188
v_rcp_f32 v122, v204
v_mul_f32 v121, v121, v7
v_mul_f32 v123, v123, v11
v_mul_f32 v120, v120, v5
v_mul_f32 v122, v122, v9
v_pk_mul_f32 v[152:153], v[152:153], v[120:121] op_sel_hi:[1,0]
v_pk_mul_f32 v[154:155], v[154:155], v[120:121] op_sel_hi:[1,0]
v_pk_mul_f32 v[184:185], v[184:185], v[120:121] op_sel_hi:[1,0]
v_pk_mul_f32 v[186:187], v[186:187], v[120:121] op_sel_hi:[1,0]
v_cvt_pk_bf16_f32 v152, v152, v153
v_cvt_pk_bf16_f32 v153, v154, v155
v_cvt_pk_bf16_f32 v154, v184, v185
v_cvt_pk_bf16_f32 v155, v186, v187
buffer_store_dwordx4 v[152:155], v16, s[44:47], s64 offen sc1
v_mov_b32 v2, v16
v_add_u32 v3, 0x10000, v16
v_mov_b32 v1, 0
s_mov_b32 m0, s71
s_waitcnt lgkmcnt(0)
s_barrier
ds_read_b128 a[144:147], v2 offset:0
ds_read_b128 a[148:151], v2 offset:1024
ds_read_b128 a[152:155], v2 offset:2048
ds_read_b128 a[156:159], v2 offset:3072
ds_read_b128 a[160:163], v2 offset:4096
ds_read_b128 a[164:167], v2 offset:5120
ds_read_b128 a[168:171], v2 offset:6144
ds_read_b128 a[172:175], v2 offset:7168
buffer_load_dwordx4 v16, s[32:35], s70 offen offset:0 sc1 lds
buffer_load_dwordx4 v16, s[32:35], s70 offen offset:1024 sc1 lds
v_pk_mul_f32 v[168:169], v[168:169], v[122:123] op_sel_hi:[1,0]
v_pk_mul_f32 v[170:171], v[170:171], v[122:123] op_sel_hi:[1,0]
v_pk_mul_f32 v[200:201], v[200:201], v[122:123] op_sel_hi:[1,0]
v_pk_mul_f32 v[202:203], v[202:203], v[122:123] op_sel_hi:[1,0]
v_cvt_pk_bf16_f32 v168, v168, v169
v_cvt_pk_bf16_f32 v169, v170, v171
v_cvt_pk_bf16_f32 v170, v200, v201
v_cvt_pk_bf16_f32 v171, v202, v203
buffer_store_dwordx4 v[168:171], v16, s[44:47], s65 offen sc1
v_pk_mul_f32 v[160:161], v[160:161], v[120:121] op_sel:[0,1]
v_pk_mul_f32 v[162:163], v[162:163], v[120:121] op_sel:[0,1]
v_pk_mul_f32 v[192:193], v[192:193], v[120:121] op_sel:[0,1]
v_pk_mul_f32 v[194:195], v[194:195], v[120:121] op_sel:[0,1]
v_cvt_pk_bf16_f32 v160, v160, v161
v_cvt_pk_bf16_f32 v161, v162, v163
v_cvt_pk_bf16_f32 v162, v192, v193
v_cvt_pk_bf16_f32 v163, v194, v195
s_add_u32 s64, s64, 4096
buffer_store_dwordx4 v[160:163], v16, s[44:47], s64 offen sc1
v_pk_mul_f32 v[176:177], v[176:177], v[122:123] op_sel:[0,1]
v_pk_mul_f32 v[178:179], v[178:179], v[122:123] op_sel:[0,1]
v_pk_mul_f32 v[208:209], v[208:209], v[122:123] op_sel:[0,1]
v_pk_mul_f32 v[210:211], v[210:211], v[122:123] op_sel:[0,1]
v_cvt_pk_bf16_f32 v176, v176, v177
v_cvt_pk_bf16_f32 v177, v178, v179
v_cvt_pk_bf16_f32 v178, v208, v209
v_cvt_pk_bf16_f32 v179, v210, v211
s_add_u32 s65, s65, 4096
buffer_store_dwordx4 v[176:179], v16, s[44:47], s65 offen sc1
v_mov_b32 v17, 0xff800000
v_and_b32 v5, 1, v0
v_mul_u32_u24 v5, 0xaaaa, v5
v_add_u32 v5, 0x4444, v5
v_lshl_or_b32 v5, v5, 16, v5
L_attstart_7:
s_cmp_eq_u32 s3, 0
s_cbranch_scc1 L_F1
s_waitcnt lgkmcnt(7)
v_mfma_f32_16x16x32_bf16 v[88:91], a[144:147], v[24:27], 0
s_waitcnt lgkmcnt(6)
ds_read_b128 a[176:179], v2 offset:8192
v_accvgpr_write_b32 a128, 0
v_mfma_f32_16x16x32_bf16 v[88:91], a[148:151], v[28:31], v[88:91]
s_waitcnt lgkmcnt(6)
ds_read_b128 a[180:183], v2 offset:9216
v_accvgpr_write_b32 a129, 0
v_mfma_f32_16x16x32_bf16 v[88:91], a[152:155], v[32:35], v[88:91]
s_waitcnt lgkmcnt(6)
buffer_load_dwordx4 v16, s[32:35], s70 offen offset:2048 sc1 lds
v_mfma_f32_16x16x32_bf16 v[88:91], a[156:159], v[36:39], v[88:91]
ds_read_b128 a[184:187], v2 offset:10240
v_accvgpr_write_b32 a130, 0
v_mfma_f32_16x16x32_bf16 v[104:107], a[156:159], v[52:55], 0
ds_read_b128 a[188:191], v2 offset:11264
v_accvgpr_write_b32 a131, 0
v_mfma_f32_16x16x32_bf16 v[104:107], a[152:155], v[48:51], v[104:107]
ds_read_b128 a[192:195], v2 offset:12288
v_accvgpr_write_b32 a132, 0
v_mfma_f32_16x16x32_bf16 v[104:107], a[148:151], v[44:47], v[104:107]
ds_read_b128 a[196:199], v2 offset:13312
v_accvgpr_write_b32 a133, 0
v_mfma_f32_16x16x32_bf16 v[104:107], a[144:147], v[40:43], v[104:107]
ds_read_b128 a[200:203], v2 offset:14336
v_accvgpr_write_b32 a134, 0
v_mfma_f32_16x16x32_bf16 v[120:123], a[144:147], v[56:59], 0
ds_read_b128 a[204:207], v2 offset:15360
v_accvgpr_write_b32 a135, 0
v_mfma_f32_16x16x32_bf16 v[120:123], a[148:151], v[60:63], v[120:123]
buffer_load_dwordx4 v16, s[32:35], s70 offen offset:3072 sc1 lds
v_mfma_f32_16x16x32_bf16 v[120:123], a[152:155], v[64:67], v[120:123]
v_accvgpr_write_b32 a136, 0
v_accvgpr_write_b32 a137, 0
v_mfma_f32_16x16x32_bf16 v[120:123], a[156:159], v[68:71], v[120:123]
v_accvgpr_write_b32 a138, 0
v_accvgpr_write_b32 a139, 0
v_mfma_f32_16x16x32_bf16 v[136:139], a[156:159], v[84:87], 0
v_accvgpr_write_b32 a140, 0
v_accvgpr_write_b32 a141, 0
v_mfma_f32_16x16x32_bf16 v[136:139], a[152:155], v[80:83], v[136:139]
v_accvgpr_write_b32 a142, 0
v_accvgpr_write_b32 a143, 0
v_mfma_f32_16x16x32_bf16 v[136:139], a[148:151], v[76:79], v[136:139]
v_mfma_f32_16x16x32_bf16 v[136:139], a[144:147], v[72:75], v[136:139]
s_waitcnt lgkmcnt(0)
s_nop 1
v_max3_f32 v20, v88, v89, v90
v_max_f32 v20, v20, v91
v_max3_f32 v21, v104, v105, v106
v_max_f32 v21, v21, v107
v_max3_f32 v22, v120, v121, v122
v_max_f32 v22, v22, v123
v_max3_f32 v23, v136, v137, v138
v_max_f32 v23, v23, v139
v_mov_b32 v248, v20
v_mov_b32 v249, v21
v_mov_b32 v250, v22
v_mov_b32 v251, v23
v_permlane16_swap_b32 v248, v20
v_permlane16_swap_b32 v249, v21
v_permlane16_swap_b32 v250, v22
v_permlane16_swap_b32 v251, v23
v_max_f32 v20, v20, v248
v_max_f32 v21, v21, v249
v_max_f32 v22, v22, v250
v_max_f32 v23, v23, v251
v_mov_b32 v248, v20
v_mov_b32 v249, v21
v_mov_b32 v250, v22
v_mov_b32 v251, v23
v_permlane32_swap_b32 v248, v20
v_permlane32_swap_b32 v249, v21
v_permlane32_swap_b32 v250, v22
v_permlane32_swap_b32 v251, v23
v_max_f32 v20, v20, v248
v_max_f32 v21, v21, v249
v_max_f32 v22, v22, v250
v_max_f32 v23, v23, v251
s_cmp_eq_u32 s73, 0
s_cselect_b64 vcc, 0, -1
v_cndmask_b32 v20, v20, v252, vcc
v_cndmask_b32 v21, v21, v253, vcc
v_cndmask_b32 v22, v22, v254, vcc
v_cndmask_b32 v23, v23, v255, vcc
v_sub_f32 v228, 0, v23
v_sub_f32 v229, 0, v23
v_sub_f32 v230, 0, v23
v_sub_f32 v231, 0, v23
v_sub_f32 v224, 0, v22
v_sub_f32 v225, 0, v22
v_sub_f32 v226, 0, v22
v_sub_f32 v227, 0, v22
v_sub_f32 v220, 0, v21
v_sub_f32 v221, 0, v21
v_sub_f32 v222, 0, v21
v_sub_f32 v223, 0, v21
v_sub_f32 v216, 0, v20
v_sub_f32 v217, 0, v20
v_sub_f32 v218, 0, v20
v_sub_f32 v219, 0, v20
v_mfma_f32_16x16x32_bf16 v[140:143], a[160:163], v[72:75], v[228:231]
s_add_u32 m0, s71, 4096
v_add_f32 v88, v88, v216
v_add_f32 v89, v89, v216
v_mfma_f32_16x16x32_bf16 v[140:143], a[164:167], v[76:79], v[140:143]
v_add_f32 v90, v90, v216
v_add_f32 v91, v91, v216
v_exp_f32 v88, v88
v_mfma_f32_16x16x32_bf16 v[140:143], a[168:171], v[80:83], v[140:143]
s_add_u32 s64, s70, 4096
v_exp_f32 v89, v89
v_mfma_f32_16x16x32_bf16 v[140:143], a[172:175], v[84:87], v[140:143]
buffer_load_dwordx4 v16, s[32:35], s64 offen offset:0 sc1 lds
v_mfma_f32_16x16x32_bf16 v[124:127], a[172:175], v[68:71], v[224:227]
v_exp_f32 v90, v90
v_mfma_f32_16x16x32_bf16 v[124:127], a[168:171], v[64:67], v[124:127]
v_exp_f32 v91, v91
v_mfma_f32_16x16x32_bf16 v[124:127], a[164:167], v[60:63], v[124:127]
v_add_f32 v104, v104, v220
v_add_f32 v105, v105, v220
v_add_f32 v106, v106, v220
v_add_f32 v107, v107, v220
v_exp_f32 v104, v104
v_mfma_f32_16x16x32_bf16 v[124:127], a[160:163], v[56:59], v[124:127]
v_exp_f32 v105, v105
v_mfma_f32_16x16x32_bf16 v[108:111], a[160:163], v[40:43], v[220:223]
v_exp_f32 v106, v106
v_mfma_f32_16x16x32_bf16 v[108:111], a[164:167], v[44:47], v[108:111]
buffer_load_dwordx4 v16, s[32:35], s64 offen offset:1024 sc1 lds
v_mfma_f32_16x16x32_bf16 v[108:111], a[168:171], v[48:51], v[108:111]
v_cvt_pk_bf16_f32 v152, v88, v89
v_add_f32 v120, v120, v224
v_mfma_f32_16x16x32_bf16 v[108:111], a[172:175], v[52:55], v[108:111]
v_exp_f32 v107, v107
v_mfma_f32_16x16x32_bf16 v[92:95], a[172:175], v[36:39], v[216:219]
v_add_f32 v121, v121, v224
v_add_f32 v122, v122, v224
v_add_f32 v123, v123, v224
v_exp_f32 v120, v120
v_mfma_f32_16x16x32_bf16 v[92:95], a[168:171], v[32:35], v[92:95]
v_cvt_pk_bf16_f32 v153, v90, v91
v_exp_f32 v121, v121
v_mfma_f32_16x16x32_bf16 v[92:95], a[164:167], v[28:31], v[92:95]
v_exp_f32 v122, v122
v_mfma_f32_16x16x32_bf16 v[92:95], a[160:163], v[24:27], v[92:95]
v_exp_f32 v123, v123
v_mfma_f32_16x16x32_bf16 v[96:99], a[176:179], v[24:27], v[216:219]
v_cvt_pk_bf16_f32 v160, v104, v105
v_add_f32 v136, v136, v228
v_mfma_f32_16x16x32_bf16 v[96:99], a[180:183], v[28:31], v[96:99]
buffer_load_dwordx4 v16, s[32:35], s64 offen offset:2048 sc1 lds
v_add_f32 v137, v137, v228
v_add_f32 v138, v138, v228
v_add_f32 v139, v139, v228
v_exp_f32 v136, v136
v_mfma_f32_16x16x32_bf16 v[96:99], a[184:187], v[32:35], v[96:99]
v_exp_f32 v137, v137
v_mfma_f32_16x16x32_bf16 v[96:99], a[188:191], v[36:39], v[96:99]
v_cvt_pk_bf16_f32 v161, v106, v107
v_cvt_pk_bf16_f32 v184, v120, v121
v_mfma_f32_16x16x32_bf16 v[112:115], a[188:191], v[52:55], v[220:223]
v_exp_f32 v138, v138
v_mfma_f32_16x16x32_bf16 v[112:115], a[184:187], v[48:51], v[112:115]
v_exp_f32 v139, v139
v_mfma_f32_16x16x32_bf16 v[112:115], a[180:183], v[44:47], v[112:115]
v_exp_f32 v140, v140
v_mfma_f32_16x16x32_bf16 v[112:115], a[176:179], v[40:43], v[112:115]
v_exp_f32 v141, v141
v_mfma_f32_16x16x32_bf16 v[128:131], a[176:179], v[56:59], v[224:227]
buffer_load_dwordx4 v16, s[32:35], s64 offen offset:3072 sc1 lds
v_cvt_pk_bf16_f32 v185, v122, v123
v_mfma_f32_16x16x32_bf16 v[128:131], a[180:183], v[60:63], v[128:131]
v_exp_f32 v142, v142
v_mfma_f32_16x16x32_bf16 v[128:131], a[184:187], v[64:67], v[128:131]
v_exp_f32 v143, v143
v_mfma_f32_16x16x32_bf16 v[128:131], a[188:191], v[68:71], v[128:131]
v_cvt_pk_bf16_f32 v192, v136, v137
v_cvt_pk_bf16_f32 v193, v138, v139
v_mfma_f32_16x16x32_bf16 v[144:147], a[188:191], v[84:87], v[228:231]
v_exp_f32 v124, v124
v_mfma_f32_16x16x32_bf16 v[144:147], a[184:187], v[80:83], v[144:147]
v_exp_f32 v125, v125
v_mfma_f32_16x16x32_bf16 v[144:147], a[180:183], v[76:79], v[144:147]
s_waitcnt vmcnt(6)
s_barrier
v_mfma_f32_16x16x32_bf16 v[144:147], a[176:179], v[72:75], v[144:147]
v_exp_f32 v126, v126
v_mfma_f32_16x16x32_bf16 v[148:151], a[192:195], v[72:75], v[228:231]
v_cvt_pk_bf16_f32 v194, v140, v141
v_cvt_pk_bf16_f32 v195, v142, v143
v_mfma_f32_16x16x32_bf16 v[148:151], a[196:199], v[76:79], v[148:151]
v_exp_f32 v127, v127
v_mfma_f32_16x16x32_bf16 v[148:151], a[200:203], v[80:83], v[148:151]
s_xor_b32 s71, s71, 16384
v_exp_f32 v108, v108
v_mfma_f32_16x16x32_bf16 v[148:151], a[204:207], v[84:87], v[148:151]
s_add_u32 s70, s70, 32768
v_exp_f32 v109, v109
v_mfma_f32_16x16x32_bf16 v[132:135], a[204:207], v[68:71], v[224:227]
s_mov_b32 m0, s71
v_exp_f32 v110, v110
v_mfma_f32_16x16x32_bf16 v[132:135], a[200:203], v[64:67], v[132:135]
buffer_load_dwordx4 v16, s[32:35], s70 offen offset:0 sc1 lds
v_mfma_f32_16x16x32_bf16 v[132:135], a[196:199], v[60:63], v[132:135]
v_cvt_pk_bf16_f32 v186, v124, v125
v_exp_f32 v111, v111
v_mfma_f32_16x16x32_bf16 v[132:135], a[192:195], v[56:59], v[132:135]
v_exp_f32 v92, v92
v_mfma_f32_16x16x32_bf16 v[116:119], a[192:195], v[40:43], v[220:223]
v_exp_f32 v93, v93
v_mfma_f32_16x16x32_bf16 v[116:119], a[196:199], v[44:47], v[116:119]
ds_read_b128 a[144:147], v2 offset:16384
v_cvt_pk_bf16_f32 v187, v126, v127
v_mfma_f32_16x16x32_bf16 v[116:119], a[200:203], v[48:51], v[116:119]
v_exp_f32 v94, v94
v_mfma_f32_16x16x32_bf16 v[116:119], a[204:207], v[52:55], v[116:119]
ds_read_b128 a[148:151], v2 offset:17408
v_cvt_pk_bf16_f32 v162, v108, v109
v_mfma_f32_16x16x32_bf16 v[100:103], a[204:207], v[36:39], v[216:219]
ds_read_b128 a[152:155], v2 offset:18432
buffer_load_dwordx4 v16, s[32:35], s70 offen offset:1024 sc1 lds
v_exp_f32 v95, v95
v_mfma_f32_16x16x32_bf16 v[100:103], a[200:203], v[32:35], v[100:103]
ds_read_b128 a[156:159], v2 offset:19456
v_exp_f32 v96, v96
v_mfma_f32_16x16x32_bf16 v[100:103], a[196:199], v[28:31], v[100:103]
v_cvt_pk_bf16_f32 v163, v110, v111
v_exp_f32 v97, v97
v_mfma_f32_16x16x32_bf16 v[100:103], a[192:195], v[24:27], v[100:103]
s_waitcnt lgkmcnt(3)
ds_read_b128 a[160:163], v2 offset:20480
ds_read_b128 a[164:167], v2 offset:21504
ds_read_b128 a[168:171], v2 offset:22528
ds_read_b128 a[172:175], v2 offset:23552
v_mfma_f32_16x16x32_bf16 v[88:91], a[144:147], v[24:27], v[216:219]
s_waitcnt lgkmcnt(6)
v_exp_f32 v98, v98
v_mfma_f32_16x16x32_bf16 v[88:91], a[148:151], v[28:31], v[88:91]
s_waitcnt lgkmcnt(5)
v_cvt_pk_bf16_f32 v154, v92, v93
v_exp_f32 v99, v99
v_mfma_f32_16x16x32_bf16 v[88:91], a[152:155], v[32:35], v[88:91]
s_waitcnt lgkmcnt(4)
v_exp_f32 v112, v112
v_mfma_f32_16x16x32_bf16 v[88:91], a[156:159], v[36:39], v[88:91]
v_exp_f32 v113, v113
v_mfma_f32_16x16x32_bf16 v[104:107], a[156:159], v[52:55], v[220:223]
v_cvt_pk_bf16_f32 v155, v94, v95
v_cvt_pk_bf16_f32 v156, v96, v97
v_mfma_f32_16x16x32_bf16 v[104:107], a[152:155], v[48:51], v[104:107]
buffer_load_dwordx4 v16, s[32:35], s70 offen offset:2048 sc1 lds
v_exp_f32 v114, v114
v_mfma_f32_16x16x32_bf16 v[104:107], a[148:151], v[44:47], v[104:107]
v_exp_f32 v115, v115
v_mfma_f32_16x16x32_bf16 v[104:107], a[144:147], v[40:43], v[104:107]
v_exp_f32 v128, v128
v_mfma_f32_16x16x32_bf16 v[120:123], a[144:147], v[56:59], v[224:227]
v_exp_f32 v129, v129
v_mfma_f32_16x16x32_bf16 v[120:123], a[148:151], v[60:63], v[120:123]
v_cvt_pk_bf16_f32 v157, v98, v99
v_cvt_pk_bf16_f32 v164, v112, v113
v_mfma_f32_16x16x32_bf16 v[120:123], a[152:155], v[64:67], v[120:123]
v_exp_f32 v130, v130
v_mfma_f32_16x16x32_bf16 v[120:123], a[156:159], v[68:71], v[120:123]
v_exp_f32 v131, v131
v_mfma_f32_16x16x32_bf16 v[136:139], a[156:159], v[84:87], v[228:231]
v_exp_f32 v144, v144
v_mfma_f32_16x16x32_bf16 v[136:139], a[152:155], v[80:83], v[136:139]
v_exp_f32 v145, v145
v_mfma_f32_16x16x32_bf16 v[136:139], a[148:151], v[76:79], v[136:139]
v_exp_f32 v146, v146
v_mfma_f32_16x16x32_bf16 v[136:139], a[144:147], v[72:75], v[136:139]
s_waitcnt lgkmcnt(0)
v_cvt_pk_bf16_f32 v165, v114, v115
v_cvt_pk_bf16_f32 v188, v128, v129
v_mfma_f32_16x16x32_bf16 v[140:143], a[160:163], v[72:75], v[228:231]
v_exp_f32 v147, v147
v_mfma_f32_16x16x32_bf16 v[140:143], a[164:167], v[76:79], v[140:143]
v_exp_f32 v148, v148
v_mfma_f32_16x16x32_bf16 v[140:143], a[168:171], v[80:83], v[140:143]
v_exp_f32 v149, v149
v_mfma_f32_16x16x32_bf16 v[140:143], a[172:175], v[84:87], v[140:143]
buffer_load_dwordx4 v16, s[32:35], s70 offen offset:3072 sc1 lds
v_mfma_f32_16x16x32_bf16 v[124:127], a[172:175], v[68:71], v[224:227]
v_cvt_pk_bf16_f32 v189, v130, v131
v_cvt_pk_bf16_f32 v196, v144, v145
v_mfma_f32_16x16x32_bf16 v[124:127], a[168:171], v[64:67], v[124:127]
v_exp_f32 v150, v150
v_mfma_f32_16x16x32_bf16 v[124:127], a[164:167], v[60:63], v[124:127]
v_exp_f32 v151, v151
v_mfma_f32_16x16x32_bf16 v[124:127], a[160:163], v[56:59], v[124:127]
v_exp_f32 v132, v132
v_mfma_f32_16x16x32_bf16 v[108:111], a[160:163], v[40:43], v[220:223]
ds_read_b128 a[176:179], v2 offset:24576
v_cvt_pk_bf16_f32 v197, v146, v147
v_mfma_f32_16x16x32_bf16 v[108:111], a[164:167], v[44:47], v[108:111]
ds_read_b128 a[180:183], v2 offset:25600
v_cvt_pk_bf16_f32 v198, v148, v149
v_mfma_f32_16x16x32_bf16 v[108:111], a[168:171], v[48:51], v[108:111]
ds_read_b128 a[184:187], v2 offset:26624
v_exp_f32 v133, v133
v_mfma_f32_16x16x32_bf16 v[108:111], a[172:175], v[52:55], v[108:111]
ds_read_b128 a[188:191], v2 offset:27648
v_exp_f32 v134, v134
v_mfma_f32_16x16x32_bf16 v[92:95], a[172:175], v[36:39], v[216:219]
v_exp_f32 v135, v135
v_mfma_f32_16x16x32_bf16 v[92:95], a[168:171], v[32:35], v[92:95]
v_exp_f32 v116, v116
v_mfma_f32_16x16x32_bf16 v[92:95], a[164:167], v[28:31], v[92:95]
v_exp_f32 v117, v117
v_mfma_f32_16x16x32_bf16 v[92:95], a[160:163], v[24:27], v[92:95]
s_waitcnt lgkmcnt(2)
v_cvt_pk_bf16_f32 v199, v150, v151
v_cvt_pk_bf16_f32 v190, v132, v133
v_mfma_f32_16x16x32_bf16 v[96:99], a[176:179], v[24:27], v[216:219]
v_exp_f32 v118, v118
v_mfma_f32_16x16x32_bf16 v[96:99], a[180:183], v[28:31], v[96:99]
s_waitcnt lgkmcnt(0)
s_add_u32 m0, s71, 4096
v_exp_f32 v119, v119
v_mfma_f32_16x16x32_bf16 v[96:99], a[184:187], v[32:35], v[96:99]
s_add_u32 s64, s70, 4096
v_exp_f32 v100, v100
v_mfma_f32_16x16x32_bf16 v[96:99], a[188:191], v[36:39], v[96:99]
buffer_load_dwordx4 v16, s[32:35], s64 offen offset:0 sc1 lds
v_mfma_f32_16x16x32_bf16 v[112:115], a[188:191], v[52:55], v[220:223]
v_exp_f32 v101, v101
v_mfma_f32_16x16x32_bf16 v[112:115], a[184:187], v[48:51], v[112:115]
v_cvt_pk_bf16_f32 v191, v134, v135
v_cvt_pk_bf16_f32 v166, v116, v117
v_mfma_f32_16x16x32_bf16 v[112:115], a[180:183], v[44:47], v[112:115]
v_exp_f32 v102, v102
v_mfma_f32_16x16x32_bf16 v[112:115], a[176:179], v[40:43], v[112:115]
v_exp_f32 v103, v103
v_mfma_f32_16x16x32_bf16 v[128:131], a[176:179], v[56:59], v[224:227]
s_lshl_b32 s66, s30, 30
ds_read_b128 a[192:195], v2 offset:28672
v_cvt_pk_bf16_f32 v167, v118, v119
v_mfma_f32_16x16x32_bf16 v[128:131], a[180:183], v[60:63], v[128:131]
ds_read_b128 a[196:199], v2 offset:29696
v_exp_f32 v88, v88
v_mfma_f32_16x16x32_bf16 v[128:131], a[184:187], v[64:67], v[128:131]
ds_read_b128 a[200:203], v2 offset:30720
v_exp_f32 v89, v89
v_mfma_f32_16x16x32_bf16 v[128:131], a[188:191], v[68:71], v[128:131]
ds_read_b128 a[204:207], v2 offset:31744
v_cvt_pk_bf16_f32 v158, v100, v101
v_mfma_f32_16x16x32_bf16 v[144:147], a[188:191], v[84:87], v[228:231]
v_exp_f32 v90, v90
v_mfma_f32_16x16x32_bf16 v[144:147], a[184:187], v[80:83], v[144:147]
v_exp_f32 v91, v91
v_mfma_f32_16x16x32_bf16 v[144:147], a[180:183], v[76:79], v[144:147]
v_exp_f32 v104, v104
v_mfma_f32_16x16x32_bf16 v[144:147], a[176:179], v[72:75], v[144:147]
s_waitcnt lgkmcnt(2)
v_exp_f32 v105, v105
v_mfma_f32_16x16x32_bf16 v[148:151], a[192:195], v[72:75], v[228:231]
v_cvt_pk_bf16_f32 v159, v102, v103
v_cvt_pk_bf16_f32 v168, v88, v89
v_mfma_f32_16x16x32_bf16 v[148:151], a[196:199], v[76:79], v[148:151]
s_waitcnt lgkmcnt(0)
v_exp_f32 v106, v106
v_mfma_f32_16x16x32_bf16 v[148:151], a[200:203], v[80:83], v[148:151]
v_exp_f32 v107, v107
v_mfma_f32_16x16x32_bf16 v[148:151], a[204:207], v[84:87], v[148:151]
buffer_load_dwordx4 v16, s[32:35], s64 offen offset:1024 sc1 lds
v_mfma_f32_16x16x32_bf16 v[132:135], a[204:207], v[68:71], v[224:227]
v_exp_f32 v120, v120
v_mfma_f32_16x16x32_bf16 v[132:135], a[200:203], v[64:67], v[132:135]
v_cvt_pk_bf16_f32 v169, v90, v91
v_cvt_pk_bf16_f32 v176, v104, v105
v_mfma_f32_16x16x32_bf16 v[132:135], a[196:199], v[60:63], v[132:135]
v_exp_f32 v121, v121
v_mfma_f32_16x16x32_bf16 v[132:135], a[192:195], v[56:59], v[132:135]
v_exp_f32 v122, v122
v_mfma_f32_16x16x32_bf16 v[116:119], a[192:195], v[40:43], v[220:223]
v_exp_f32 v123, v123
v_mfma_f32_16x16x32_bf16 v[116:119], a[196:199], v[44:47], v[116:119]
v_exp_f32 v136, v136
v_mfma_f32_16x16x32_bf16 v[116:119], a[200:203], v[48:51], v[116:119]
v_exp_f32 v137, v137
v_mfma_f32_16x16x32_bf16 v[116:119], a[204:207], v[52:55], v[116:119]
ds_read_b128 a[144:147], v3 offset:16384
v_cvt_pk_bf16_f32 v177, v106, v107
v_mfma_f32_16x16x32_bf16 v[100:103], a[204:207], v[36:39], v[216:219]
s_branch L_po15
L_pg15:
s_branch L_pg19
L_po15:
v_exp_f32 v138, v138
v_mfma_f32_16x16x32_bf16 v[100:103], a[200:203], v[32:35], v[100:103]
ds_read_b128 a[148:151], v3 offset:24576
v_cvt_pk_bf16_f32 v200, v120, v121
v_mfma_f32_16x16x32_bf16 v[100:103], a[196:199], v[28:31], v[100:103]
v_exp_f32 v139, v139
v_mfma_f32_16x16x32_bf16 v[100:103], a[192:195], v[24:27], v[100:103]
v_exp_f32 v140, v140
v_smfmac_f32_16x16x64_bf16 a[128:131], a[240:243], v[152:159], v5
v_cvt_pk_bf16_f32 v201, v122, v123
v_smfmac_f32_16x16x64_bf16 a[132:135], a[240:243], v[160:167], v5
v_exp_f32 v141, v141
v_smfmac_f32_16x16x64_bf16 a[136:139], a[240:243], v[184:191], v5
v_exp_f32 v142, v142
v_smfmac_f32_16x16x64_bf16 a[140:143], a[240:243], v[192:199], v5
s_waitcnt lgkmcnt(0)
buffer_load_dwordx4 v16, s[32:35], s64 offen offset:2048 sc1 lds
v_cvt_pk_bf16_f32 v208, v136, v137
v_mfma_f32_16x16x32_bf16 a[0:3], a[144:147], v[152:155], 0
ds_read_b128 a[152:155], v3 offset:17408
v_exp_f32 v143, v143
v_mfma_f32_16x16x32_bf16 a[0:3], a[148:151], v[156:159], a[0:3]
ds_read_b128 a[156:159], v3 offset:25600
v_exp_f32 v124, v124
v_mfma_f32_16x16x32_bf16 a[32:35], a[148:151], v[164:167], 0
v_cvt_pk_bf16_f32 v209, v138, v139
v_exp_f32 v125, v125
v_mfma_f32_16x16x32_bf16 a[32:35], a[144:147], v[160:163], a[32:35]
v_exp_f32 v126, v126
v_mfma_f32_16x16x32_bf16 a[64:67], a[144:147], v[184:187], 0
v_exp_f32 v127, v127
v_mfma_f32_16x16x32_bf16 a[64:67], a[148:151], v[188:191], a[64:67]
v_cvt_pk_bf16_f32 v210, v140, v141
v_cvt_pk_bf16_f32 v211, v142, v143
v_mfma_f32_16x16x32_bf16 a[96:99], a[148:151], v[196:199], 0
v_exp_f32 v108, v108
v_mfma_f32_16x16x32_bf16 a[96:99], a[144:147], v[192:195], a[96:99]
s_waitcnt lgkmcnt(0)
v_exp_f32 v109, v109
v_mfma_f32_16x16x32_bf16 a[100:103], a[152:155], v[192:195], 0
ds_read_b128 a[160:163], v3 offset:18432
v_cvt_pk_bf16_f32 v202, v124, v125
v_mfma_f32_16x16x32_bf16 a[100:103], a[156:159], v[196:199], a[100:103]
ds_read_b128 a[164:167], v3 offset:26624
v_exp_f32 v110, v110
v_mfma_f32_16x16x32_bf16 a[68:71], a[156:159], v[188:191], 0
v_exp_f32 v111, v111
v_mfma_f32_16x16x32_bf16 a[68:71], a[152:155], v[184:187], a[68:71]
v_exp_f32 v92, v92
v_mfma_f32_16x16x32_bf16 a[36:39], a[152:155], v[160:163], 0
v_exp_f32 v93, v93
v_mfma_f32_16x16x32_bf16 a[36:39], a[156:159], v[164:167], a[36:39]
v_cvt_pk_bf16_f32 v203, v126, v127
v_cvt_pk_bf16_f32 v178, v108, v109
v_mfma_f32_16x16x32_bf16 a[4:7], a[156:159], v[156:159], 0
buffer_load_dwordx4 v16, s[32:35], s64 offen offset:3072 sc1 lds
v_mfma_f32_16x16x32_bf16 a[4:7], a[152:155], v[152:155], a[4:7]
s_waitcnt lgkmcnt(0)
v_exp_f32 v94, v94
v_mfma_f32_16x16x32_bf16 a[8:11], a[160:163], v[152:155], 0
ds_read_b128 a[168:171], v3 offset:19456
v_cvt_pk_bf16_f32 v179, v110, v111
v_mfma_f32_16x16x32_bf16 a[8:11], a[164:167], v[156:159], a[8:11]
ds_read_b128 a[172:175], v3 offset:27648
v_exp_f32 v95, v95
v_mfma_f32_16x16x32_bf16 a[40:43], a[164:167], v[164:167], 0
v_exp_f32 v96, v96
v_mfma_f32_16x16x32_bf16 a[40:43], a[160:163], v[160:163], a[40:43]
v_exp_f32 v97, v97
v_mfma_f32_16x16x32_bf16 a[72:75], a[160:163], v[184:187], 0
v_exp_f32 v98, v98
v_mfma_f32_16x16x32_bf16 a[72:75], a[164:167], v[188:191], a[72:75]
v_exp_f32 v99, v99
v_mfma_f32_16x16x32_bf16 a[104:107], a[164:167], v[196:199], 0
ds_read_b128 a[176:179], v3 offset:20480
v_cvt_pk_bf16_f32 v170, v92, v93
v_mfma_f32_16x16x32_bf16 a[104:107], a[160:163], v[192:195], a[104:107]
s_waitcnt lgkmcnt(1)
v_exp_f32 v112, v112
v_mfma_f32_16x16x32_bf16 a[108:111], a[168:171], v[192:195], 0
v_exp_f32 v113, v113
v_mfma_f32_16x16x32_bf16 a[108:111], a[172:175], v[196:199], a[108:111]
ds_read_b128 a[180:183], v3 offset:28672
v_cvt_pk_bf16_f32 v171, v94, v95
v_mfma_f32_16x16x32_bf16 a[76:79], a[172:175], v[188:191], 0
v_exp_f32 v114, v114
v_mfma_f32_16x16x32_bf16 a[76:79], a[168:171], v[184:187], a[76:79]
v_cvt_pk_bf16_f32 v172, v96, v97
v_xor_b32 v2, 0x8000, v2
v_mfma_f32_16x16x32_bf16 a[44:47], a[168:171], v[160:163], 0
ds_read_b128 a[184:187], v3 offset:21504
ds_read_b128 a[188:191], v3 offset:29696
ds_read_b128 a[192:195], v3 offset:22528
ds_read_b128 a[196:199], v3 offset:30720
ds_read_b128 a[200:203], v3 offset:23552
ds_read_b128 a[204:207], v3 offset:31744
v_exp_f32 v115, v115
v_mfma_f32_16x16x32_bf16 a[44:47], a[172:175], v[164:167], a[44:47]
s_waitcnt vmcnt(8)
s_barrier
v_exp_f32 v128, v128
v_mfma_f32_16x16x32_bf16 a[12:15], a[172:175], v[156:159], 0
v_cvt_pk_bf16_f32 v173, v98, v99
v_cvt_pk_bf16_f32 v180, v112, v113
v_mfma_f32_16x16x32_bf16 a[12:15], a[168:171], v[152:155], a[12:15]
s_waitcnt lgkmcnt(6)
v_exp_f32 v129, v129
v_mfma_f32_16x16x32_bf16 a[16:19], a[176:179], v[152:155], 0
v_exp_f32 v130, v130
v_mfma_f32_16x16x32_bf16 a[16:19], a[180:183], v[156:159], a[16:19]
s_xor_b32 s71, s71, 49152
v_exp_f32 v131, v131
v_mfma_f32_16x16x32_bf16 a[48:51], a[180:183], v[164:167], 0
s_add_u32 s70, s70, 32768
v_exp_f32 v144, v144
v_mfma_f32_16x16x32_bf16 a[48:51], a[176:179], v[160:163], a[48:51]
s_mov_b32 m0, s71
v_exp_f32 v145, v145
v_mfma_f32_16x16x32_bf16 a[80:83], a[176:179], v[184:187], 0
buffer_load_dwordx4 v16, s[32:35], s70 offen offset:0 sc1 lds
v_cvt_pk_bf16_f32 v181, v114, v115
v_mfma_f32_16x16x32_bf16 a[80:83], a[180:183], v[188:191], a[80:83]
v_exp_f32 v146, v146
v_mfma_f32_16x16x32_bf16 a[112:115], a[180:183], v[196:199], 0
v_exp_f32 v147, v147
v_mfma_f32_16x16x32_bf16 a[112:115], a[176:179], v[192:195], a[112:115]
s_waitcnt lgkmcnt(0)
v_cvt_pk_bf16_f32 v204, v128, v129
v_cvt_pk_bf16_f32 v205, v130, v131
v_mfma_f32_16x16x32_bf16 a[116:119], a[184:187], v[192:195], 0
v_exp_f32 v148, v148
v_mfma_f32_16x16x32_bf16 a[116:119], a[188:191], v[196:199], a[116:119]
v_exp_f32 v149, v149
v_mfma_f32_16x16x32_bf16 a[84:87], a[188:191], v[188:191], 0
v_exp_f32 v150, v150
v_mfma_f32_16x16x32_bf16 a[84:87], a[184:187], v[184:187], a[84:87]
v_exp_f32 v151, v151
v_mfma_f32_16x16x32_bf16 a[52:55], a[184:187], v[160:163], 0
v_cvt_pk_bf16_f32 v212, v144, v145
v_cvt_pk_bf16_f32 v213, v146, v147
v_mfma_f32_16x16x32_bf16 a[52:55], a[188:191], v[164:167], a[52:55]
v_exp_f32 v132, v132
v_mfma_f32_16x16x32_bf16 a[20:23], a[188:191], v[156:159], 0
v_exp_f32 v133, v133
v_mfma_f32_16x16x32_bf16 a[20:23], a[184:187], v[152:155], a[20:23]
ds_read_b128 a[144:147], v2 offset:0
v_lshl_add_u32 v19, v0, 24, s66
v_mfma_f32_16x16x32_bf16 a[24:27], a[192:195], v[152:155], 0
s_lshr_b32 s67, s31, 4
v_exp_f32 v134, v134
v_mfma_f32_16x16x32_bf16 a[24:27], a[196:199], v[156:159], a[24:27]
s_lshl1_add_u32 s67, s3, s67
v_exp_f32 v135, v135
v_mfma_f32_16x16x32_bf16 a[56:59], a[196:199], v[164:167], 0
s_lshl_b32 s79, s67, 8
v_cvt_pk_bf16_f32 v214, v148, v149
v_cvt_pk_bf16_f32 v215, v150, v151
v_mfma_f32_16x16x32_bf16 a[56:59], a[192:195], v[160:163], a[56:59]
s_add_u32 s79, s79, 8192
buffer_load_dwordx4 v16, s[32:35], s70 offen offset:1024 sc1 lds
v_mfma_f32_16x16x32_bf16 a[88:91], a[192:195], v[184:187], 0
s_add_u32 s69, s31, 12
v_exp_f32 v116, v116
v_mfma_f32_16x16x32_bf16 a[88:91], a[196:199], v[188:191], a[88:91]
s_lshr_b32 s69, s69, 5
v_exp_f32 v117, v117
v_mfma_f32_16x16x32_bf16 a[120:123], a[196:199], v[196:199], 0
s_lshl1_add_u32 s69, s3, s69
v_exp_f32 v118, v118
v_mfma_f32_16x16x32_bf16 a[120:123], a[192:195], v[192:195], a[120:123]
s_lshl_b32 s69, s69, 8
v_cvt_pk_bf16_f32 v206, v132, v133
v_cvt_pk_bf16_f32 v207, v134, v135
v_mfma_f32_16x16x32_bf16 a[124:127], a[200:203], v[192:195], 0
s_add_u32 s69, s69, 8192
v_exp_f32 v119, v119
v_mfma_f32_16x16x32_bf16 a[124:127], a[204:207], v[196:199], a[124:127]
s_lshl_b32 s67, s73, 16
v_exp_f32 v100, v100
v_mfma_f32_16x16x32_bf16 a[92:95], a[204:207], v[188:191], 0
s_xor_b32 s68, s80, 256
v_exp_f32 v101, v101
v_mfma_f32_16x16x32_bf16 a[92:95], a[200:203], v[184:187], a[92:95]
s_add_u32 s68, s68, s67
ds_read_b128 a[148:151], v2 offset:1024
v_cvt_pk_bf16_f32 v182, v116, v117
v_mfma_f32_16x16x32_bf16 a[60:63], a[200:203], v[160:163], 0
ds_read_b128 a[152:155], v2 offset:2048
v_exp_f32 v102, v102
v_mfma_f32_16x16x32_bf16 a[60:63], a[204:207], v[164:167], a[60:63]
s_add_u32 s67, s67, s69
ds_read_b128 a[156:159], v2 offset:3072
v_cvt_pk_bf16_f32 v183, v118, v119
v_mfma_f32_16x16x32_bf16 a[28:31], a[204:207], v[156:159], 0
s_mov_b64 exec, 1
buffer_atomic_add a251, v19, s[52:55], s67 offen offset:0 sc1
buffer_atomic_add a251, v19, s[52:55], s68 offen offset:0 sc1
s_mov_b64 exec, -1
v_exp_f32 v103, v103
v_mfma_f32_16x16x32_bf16 a[28:31], a[200:203], v[152:155], a[28:31]
ds_read_b128 a[160:163], v2 offset:4096
ds_read_b128 a[164:167], v2 offset:5120
ds_read_b128 a[168:171], v2 offset:6144
ds_read_b128 a[172:175], v2 offset:7168
v_mul_u32_u24 v19, 52, v0
v_cvt_pk_bf16_f32 v174, v100, v101
v_cvt_pk_bf16_f32 v175, v102, v103
v_xor_b32 v3, 0x8000, v3
s_sub_u32 s72, s3, 1
s_cmp_eq_u32 s72, 0
s_cbranch_scc1 L_DD
L_D:
s_waitcnt lgkmcnt(7)
v_mfma_f32_16x16x32_bf16 v[88:91], a[144:147], v[24:27], v[216:219]
s_waitcnt lgkmcnt(6)
ds_read_b128 a[176:179], v2 offset:8192
v_mfma_f32_16x16x32_bf16 v[88:91], a[148:151], v[28:31], v[88:91]
s_waitcnt lgkmcnt(6)
ds_read_b128 a[180:183], v2 offset:9216
v_mfma_f32_16x16x32_bf16 v[88:91], a[152:155], v[32:35], v[88:91]
s_waitcnt lgkmcnt(6)
buffer_load_dwordx4 v16, s[32:35], s70 offen offset:2048 sc1 lds
v_mfma_f32_16x16x32_bf16 v[88:91], a[156:159], v[36:39], v[88:91]
ds_read_b128 a[184:187], v2 offset:10240
v_mfma_f32_16x16x32_bf16 v[104:107], a[156:159], v[52:55], v[220:223]
v_mfma_f32_16x16x32_bf16 v[104:107], a[152:155], v[48:51], v[104:107]
buffer_load_dword a252, v19, s[40:43], s81 offen
v_mfma_f32_16x16x32_bf16 v[104:107], a[148:151], v[44:47], v[104:107]
ds_read_b128 a[188:191], v2 offset:11264
v_mfma_f32_16x16x32_bf16 v[104:107], a[144:147], v[40:43], v[104:107]
v_mfma_f32_16x16x32_bf16 v[120:123], a[144:147], v[56:59], v[224:227]
v_mfma_f32_16x16x32_bf16 v[120:123], a[148:151], v[60:63], v[120:123]
v_mfma_f32_16x16x32_bf16 v[120:123], a[152:155], v[64:67], v[120:123]
v_exp_f32 v88, v88
v_mfma_f32_16x16x32_bf16 v[120:123], a[156:159], v[68:71], v[120:123]
v_exp_f32 v89, v89
v_mfma_f32_16x16x32_bf16 v[136:139], a[156:159], v[84:87], v[228:231]
v_exp_f32 v90, v90
v_mfma_f32_16x16x32_bf16 v[136:139], a[152:155], v[80:83], v[136:139]
v_exp_f32 v91, v91
v_mfma_f32_16x16x32_bf16 v[136:139], a[148:151], v[76:79], v[136:139]
v_exp_f32 v104, v104
v_mfma_f32_16x16x32_bf16 v[136:139], a[144:147], v[72:75], v[136:139]
s_waitcnt lgkmcnt(0)
s_add_u32 s81, s81, 425984
v_exp_f32 v105, v105
v_mfma_f32_16x16x32_bf16 v[140:143], a[160:163], v[72:75], v[228:231]
v_exp_f32 v106, v106
v_mfma_f32_16x16x32_bf16 v[140:143], a[164:167], v[76:79], v[140:143]
buffer_load_dwordx4 v16, s[32:35], s70 offen offset:3072 sc1 lds
v_mfma_f32_16x16x32_bf16 v[140:143], a[168:171], v[80:83], v[140:143]
v_exp_f32 v107, v107
v_mfma_f32_16x16x32_bf16 v[140:143], a[172:175], v[84:87], v[140:143]
v_cvt_pk_bf16_f32 v152, v88, v89
v_cvt_pk_bf16_f32 v153, v90, v91
v_mfma_f32_16x16x32_bf16 v[124:127], a[172:175], v[68:71], v[224:227]
v_exp_f32 v120, v120
v_mfma_f32_16x16x32_bf16 v[124:127], a[168:171], v[64:67], v[124:127]
v_exp_f32 v121, v121
v_mfma_f32_16x16x32_bf16 v[124:127], a[164:167], v[60:63], v[124:127]
v_exp_f32 v122, v122
v_mfma_f32_16x16x32_bf16 v[124:127], a[160:163], v[56:59], v[124:127]
v_exp_f32 v123, v123
v_mfma_f32_16x16x32_bf16 v[108:111], a[160:163], v[40:43], v[220:223]
v_exp_f32 v136, v136
v_mfma_f32_16x16x32_bf16 v[108:111], a[164:167], v[44:47], v[108:111]
v_exp_f32 v137, v137
v_mfma_f32_16x16x32_bf16 v[108:111], a[168:171], v[48:51], v[108:111]
v_exp_f32 v138, v138
v_mfma_f32_16x16x32_bf16 v[108:111], a[172:175], v[52:55], v[108:111]
v_cvt_pk_bf16_f32 v160, v104, v105
v_cvt_pk_bf16_f32 v161, v106, v107
v_mfma_f32_16x16x32_bf16 v[92:95], a[172:175], v[36:39], v[216:219]
v_exp_f32 v139, v139
v_mfma_f32_16x16x32_bf16 v[92:95], a[168:171], v[32:35], v[92:95]
ds_read_b128 a[192:195], v2 offset:12288
v_cvt_pk_bf16_f32 v184, v120, v121
v_mfma_f32_16x16x32_bf16 v[92:95], a[164:167], v[28:31], v[92:95]
v_exp_f32 v140, v140
v_mfma_f32_16x16x32_bf16 v[92:95], a[160:163], v[24:27], v[92:95]
s_add_u32 m0, s71, 4096
ds_read_b128 a[196:199], v2 offset:13312
v_cvt_pk_bf16_f32 v185, v122, v123
v_mfma_f32_16x16x32_bf16 v[96:99], a[176:179], v[24:27], v[216:219]
s_add_u32 s64, s70, 4096
ds_read_b128 a[200:203], v2 offset:14336
v_cvt_pk_bf16_f32 v192, v136, v137
v_mfma_f32_16x16x32_bf16 v[96:99], a[180:183], v[28:31], v[96:99]
buffer_load_dwordx4 v16, s[32:35], s64 offen offset:0 sc1 lds
v_mfma_f32_16x16x32_bf16 v[96:99], a[184:187], v[32:35], v[96:99]
v_exp_f32 v141, v141
v_mfma_f32_16x16x32_bf16 v[96:99], a[188:191], v[36:39], v[96:99]
ds_read_b128 a[204:207], v2 offset:15360
v_cvt_pk_bf16_f32 v193, v138, v139
v_mfma_f32_16x16x32_bf16 v[112:115], a[188:191], v[52:55], v[220:223]
v_exp_f32 v142, v142
v_mfma_f32_16x16x32_bf16 v[112:115], a[184:187], v[48:51], v[112:115]
v_exp_f32 v143, v143
v_mfma_f32_16x16x32_bf16 v[112:115], a[180:183], v[44:47], v[112:115]
v_exp_f32 v124, v124
v_mfma_f32_16x16x32_bf16 v[112:115], a[176:179], v[40:43], v[112:115]
v_exp_f32 v125, v125
v_mfma_f32_16x16x32_bf16 v[128:131], a[176:179], v[56:59], v[224:227]
v_exp_f32 v126, v126
v_mfma_f32_16x16x32_bf16 v[128:131], a[180:183], v[60:63], v[128:131]
v_exp_f32 v127, v127
v_mfma_f32_16x16x32_bf16 v[128:131], a[184:187], v[64:67], v[128:131]
v_exp_f32 v108, v108
v_mfma_f32_16x16x32_bf16 v[128:131], a[188:191], v[68:71], v[128:131]
v_exp_f32 v109, v109
v_mfma_f32_16x16x32_bf16 v[144:147], a[188:191], v[84:87], v[228:231]
v_exp_f32 v110, v110
v_mfma_f32_16x16x32_bf16 v[144:147], a[184:187], v[80:83], v[144:147]
ds_read_b128 a[144:147], v3 offset:0
v_cvt_pk_bf16_f32 v194, v140, v141
v_mfma_f32_16x16x32_bf16 v[144:147], a[180:183], v[76:79], v[144:147]
ds_read_b128 a[148:151], v3 offset:8192
v_cvt_pk_bf16_f32 v195, v142, v143
v_mfma_f32_16x16x32_bf16 v[144:147], a[176:179], v[72:75], v[144:147]
s_waitcnt lgkmcnt(2)
v_exp_f32 v111, v111
v_mfma_f32_16x16x32_bf16 v[148:151], a[192:195], v[72:75], v[228:231]
buffer_load_dwordx4 v16, s[32:35], s64 offen offset:1024 sc1 lds
v_mfma_f32_16x16x32_bf16 v[148:151], a[196:199], v[76:79], v[148:151]
v_exp_f32 v92, v92
v_mfma_f32_16x16x32_bf16 v[148:151], a[200:203], v[80:83], v[148:151]
v_exp_f32 v93, v93
v_mfma_f32_16x16x32_bf16 v[148:151], a[204:207], v[84:87], v[148:151]
v_exp_f32 v94, v94
v_mfma_f32_16x16x32_bf16 v[132:135], a[204:207], v[68:71], v[224:227]
ds_read_b128 a[152:155], v3 offset:1024
v_cvt_pk_bf16_f32 v186, v124, v125
v_mfma_f32_16x16x32_bf16 v[132:135], a[200:203], v[64:67], v[132:135]
ds_read_b128 a[156:159], v3 offset:9216
v_cvt_pk_bf16_f32 v187, v126, v127
v_mfma_f32_16x16x32_bf16 v[132:135], a[196:199], v[60:63], v[132:135]
v_exp_f32 v95, v95
v_mfma_f32_16x16x32_bf16 v[132:135], a[192:195], v[56:59], v[132:135]
v_exp_f32 v96, v96
v_mfma_f32_16x16x32_bf16 v[116:119], a[192:195], v[40:43], v[220:223]
v_exp_f32 v97, v97
v_mfma_f32_16x16x32_bf16 v[116:119], a[196:199], v[44:47], v[116:119]
v_exp_f32 v98, v98
v_mfma_f32_16x16x32_bf16 v[116:119], a[200:203], v[48:51], v[116:119]
ds_read_b128 a[160:163], v3 offset:2048
v_cvt_pk_bf16_f32 v162, v108, v109
v_mfma_f32_16x16x32_bf16 v[116:119], a[204:207], v[52:55], v[116:119]
v_exp_f32 v99, v99
v_mfma_f32_16x16x32_bf16 v[100:103], a[204:207], v[36:39], v[216:219]
ds_read_b128 a[164:167], v3 offset:10240
v_cvt_pk_bf16_f32 v163, v110, v111
v_mfma_f32_16x16x32_bf16 v[100:103], a[200:203], v[32:35], v[100:103]
v_exp_f32 v112, v112
v_mfma_f32_16x16x32_bf16 v[100:103], a[196:199], v[28:31], v[100:103]
v_exp_f32 v113, v113
v_mfma_f32_16x16x32_bf16 v[100:103], a[192:195], v[24:27], v[100:103]
v_exp_f32 v114, v114
v_smfmac_f32_16x16x64_bf16 a[128:131], a[240:243], v[168:175], v5
ds_read_b128 a[168:171], v3 offset:3072
v_smfmac_f32_16x16x64_bf16 a[132:135], a[240:243], v[176:183], v5
ds_read_b128 a[172:175], v3 offset:11264
v_smfmac_f32_16x16x64_bf16 a[136:139], a[240:243], v[200:207], v5
ds_read_b128 a[176:179], v3 offset:4096
v_smfmac_f32_16x16x64_bf16 a[140:143], a[240:243], v[208:215], v5
s_waitcnt lgkmcnt(3)
buffer_load_dwordx4 v16, s[32:35], s64 offen offset:2048 sc1 lds
v_mfma_f32_16x16x32_bf16 a[0:3], a[144:147], v[168:171], a[0:3]
v_exp_f32 v115, v115
v_mfma_f32_16x16x32_bf16 a[0:3], a[148:151], v[172:175], a[0:3]
v_exp_f32 v128, v128
v_mfma_f32_16x16x32_bf16 a[32:35], a[148:151], v[180:183], a[32:35]
v_exp_f32 v129, v129
v_mfma_f32_16x16x32_bf16 a[32:35], a[144:147], v[176:179], a[32:35]
v_exp_f32 v130, v130
v_mfma_f32_16x16x32_bf16 a[64:67], a[144:147], v[200:203], a[64:67]
v_exp_f32 v131, v131
v_mfma_f32_16x16x32_bf16 a[64:67], a[148:151], v[204:207], a[64:67]
v_cvt_pk_bf16_f32 v154, v92, v93
v_cvt_pk_bf16_f32 v155, v94, v95
v_mfma_f32_16x16x32_bf16 a[96:99], a[148:151], v[212:215], a[96:99]
v_exp_f32 v144, v144
v_mfma_f32_16x16x32_bf16 a[96:99], a[144:147], v[208:211], a[96:99]
ds_read_b128 a[180:183], v3 offset:12288
v_cvt_pk_bf16_f32 v156, v96, v97
v_mfma_f32_16x16x32_bf16 a[100:103], a[152:155], v[208:211], a[100:103]
v_exp_f32 v145, v145
v_mfma_f32_16x16x32_bf16 a[100:103], a[156:159], v[212:215], a[100:103]
ds_read_b128 a[184:187], v3 offset:5120
v_cvt_pk_bf16_f32 v157, v98, v99
v_mfma_f32_16x16x32_bf16 a[68:71], a[156:159], v[204:207], a[68:71]
ds_read_b128 a[188:191], v3 offset:13312
v_cvt_pk_bf16_f32 v164, v112, v113
v_mfma_f32_16x16x32_bf16 a[68:71], a[152:155], v[200:203], a[68:71]
buffer_load_dwordx4 v16, s[32:35], s64 offen offset:3072 sc1 lds
v_mfma_f32_16x16x32_bf16 a[36:39], a[152:155], v[176:179], a[36:39]
ds_read_b128 a[192:195], v3 offset:6144
v_cvt_pk_bf16_f32 v165, v114, v115
v_mfma_f32_16x16x32_bf16 a[36:39], a[156:159], v[180:183], a[36:39]
ds_read_b128 a[196:199], v3 offset:14336
v_cvt_pk_bf16_f32 v188, v128, v129
v_mfma_f32_16x16x32_bf16 a[4:7], a[156:159], v[172:175], a[4:7]
ds_read_b128 a[200:203], v3 offset:7168
v_cvt_pk_bf16_f32 v189, v130, v131
v_mfma_f32_16x16x32_bf16 a[4:7], a[152:155], v[168:171], a[4:7]
v_exp_f32 v146, v146
v_mfma_f32_16x16x32_bf16 a[8:11], a[160:163], v[168:171], a[8:11]
v_exp_f32 v147, v147
v_mfma_f32_16x16x32_bf16 a[8:11], a[164:167], v[172:175], a[8:11]
v_exp_f32 v148, v148
v_mfma_f32_16x16x32_bf16 a[40:43], a[164:167], v[180:183], a[40:43]
ds_read_b128 a[204:207], v3 offset:15360
v_cvt_pk_bf16_f32 v196, v144, v145
v_mfma_f32_16x16x32_bf16 a[40:43], a[160:163], v[176:179], a[40:43]
v_exp_f32 v149, v149
v_mfma_f32_16x16x32_bf16 a[72:75], a[160:163], v[200:203], a[72:75]
v_exp_f32 v150, v150
v_mfma_f32_16x16x32_bf16 a[72:75], a[164:167], v[204:207], a[72:75]
v_exp_f32 v151, v151
v_mfma_f32_16x16x32_bf16 a[104:107], a[164:167], v[212:215], a[104:107]
v_exp_f32 v132, v132
v_mfma_f32_16x16x32_bf16 a[104:107], a[160:163], v[208:211], a[104:107]
s_waitcnt lgkmcnt(1)
v_exp_f32 v133, v133
v_mfma_f32_16x16x32_bf16 a[108:111], a[168:171], v[208:211], a[108:111]
v_exp_f32 v134, v134
v_mfma_f32_16x16x32_bf16 a[108:111], a[172:175], v[212:215], a[108:111]
v_exp_f32 v135, v135
v_mfma_f32_16x16x32_bf16 a[76:79], a[172:175], v[204:207], a[76:79]
v_exp_f32 v116, v116
v_mfma_f32_16x16x32_bf16 a[76:79], a[168:171], v[200:203], a[76:79]
v_exp_f32 v117, v117
v_mfma_f32_16x16x32_bf16 a[44:47], a[168:171], v[176:179], a[44:47]
v_exp_f32 v118, v118
v_mfma_f32_16x16x32_bf16 a[44:47], a[172:175], v[180:183], a[44:47]
s_waitcnt vmcnt(9)
s_barrier
v_mfma_f32_16x16x32_bf16 a[12:15], a[172:175], v[172:175], a[12:15]
s_xor_b32 s71, s71, 16384
v_exp_f32 v119, v119
v_mfma_f32_16x16x32_bf16 a[12:15], a[168:171], v[168:171], a[12:15]
s_add_u32 s70, s70, 32768
v_exp_f32 v100, v100
v_mfma_f32_16x16x32_bf16 a[16:19], a[176:179], v[168:171], a[16:19]
s_mov_b32 m0, s71
v_exp_f32 v101, v101
v_mfma_f32_16x16x32_bf16 a[16:19], a[180:183], v[172:175], a[16:19]
buffer_load_dwordx4 v16, s[32:35], s70 offen offset:0 sc1 lds
v_mfma_f32_16x16x32_bf16 a[48:51], a[180:183], v[180:183], a[48:51]
ds_read_b128 a[144:147], v2 offset:16384
v_cvt_pk_bf16_f32 v197, v146, v147
v_mfma_f32_16x16x32_bf16 a[48:51], a[176:179], v[176:179], a[48:51]
ds_read_b128 a[148:151], v2 offset:17408
v_cvt_pk_bf16_f32 v198, v148, v149
v_mfma_f32_16x16x32_bf16 a[80:83], a[176:179], v[200:203], a[80:83]
v_exp_f32 v102, v102
v_mfma_f32_16x16x32_bf16 a[80:83], a[180:183], v[204:207], a[80:83]
ds_read_b128 a[152:155], v2 offset:18432
v_cvt_pk_bf16_f32 v199, v150, v151
v_mfma_f32_16x16x32_bf16 a[112:115], a[180:183], v[212:215], a[112:115]
ds_read_b128 a[156:159], v2 offset:19456
v_cvt_pk_bf16_f32 v190, v132, v133
v_mfma_f32_16x16x32_bf16 a[112:115], a[176:179], v[208:211], a[112:115]
v_exp_f32 v103, v103
v_mfma_f32_16x16x32_bf16 a[116:119], a[184:187], v[208:211], a[116:119]
ds_read_b128 a[160:163], v2 offset:20480
v_cvt_pk_bf16_f32 v191, v134, v135
v_mfma_f32_16x16x32_bf16 a[116:119], a[188:191], v[212:215], a[116:119]
ds_read_b128 a[164:167], v2 offset:21504
v_cvt_pk_bf16_f32 v166, v116, v117
v_mfma_f32_16x16x32_bf16 a[84:87], a[188:191], v[204:207], a[84:87]
ds_read_b128 a[168:171], v2 offset:22528
v_cvt_pk_bf16_f32 v167, v118, v119
v_mfma_f32_16x16x32_bf16 a[84:87], a[184:187], v[200:203], a[84:87]
ds_read_b128 a[172:175], v2 offset:23552
v_cvt_pk_bf16_f32 v158, v100, v101
v_mfma_f32_16x16x32_bf16 a[52:55], a[184:187], v[176:179], a[52:55]
v_cvt_pk_bf16_f32 v159, v102, v103
v_mfma_f32_16x16x32_bf16 a[52:55], a[188:191], v[180:183], a[52:55]
v_mfma_f32_16x16x32_bf16 a[20:23], a[188:191], v[172:175], a[20:23]
v_mfma_f32_16x16x32_bf16 a[20:23], a[184:187], v[168:171], a[20:23]
v_mfma_f32_16x16x32_bf16 a[24:27], a[192:195], v[168:171], a[24:27]
buffer_load_dwordx4 v16, s[32:35], s70 offen offset:1024 sc1 lds
v_mfma_f32_16x16x32_bf16 a[24:27], a[196:199], v[172:175], a[24:27]
v_mfma_f32_16x16x32_bf16 a[56:59], a[196:199], v[180:183], a[56:59]
v_mfma_f32_16x16x32_bf16 a[56:59], a[192:195], v[176:179], a[56:59]
v_mfma_f32_16x16x32_bf16 a[88:91], a[192:195], v[200:203], a[88:91]
v_mfma_f32_16x16x32_bf16 a[88:91], a[196:199], v[204:207], a[88:91]
v_mfma_f32_16x16x32_bf16 a[120:123], a[196:199], v[212:215], a[120:123]
v_mfma_f32_16x16x32_bf16 a[120:123], a[192:195], v[208:211], a[120:123]
v_mfma_f32_16x16x32_bf16 a[124:127], a[200:203], v[208:211], a[124:127]
s_waitcnt lgkmcnt(0)
v_mfma_f32_16x16x32_bf16 a[124:127], a[204:207], v[212:215], a[124:127]
v_mfma_f32_16x16x32_bf16 a[92:95], a[204:207], v[204:207], a[92:95]
v_mfma_f32_16x16x32_bf16 a[92:95], a[200:203], v[200:203], a[92:95]
v_mfma_f32_16x16x32_bf16 a[60:63], a[200:203], v[176:179], a[60:63]
v_mfma_f32_16x16x32_bf16 a[60:63], a[204:207], v[180:183], a[60:63]
v_mfma_f32_16x16x32_bf16 a[28:31], a[204:207], v[172:175], a[28:31]
v_mfma_f32_16x16x32_bf16 a[28:31], a[200:203], v[168:171], a[28:31]
v_mfma_f32_16x16x32_bf16 v[88:91], a[144:147], v[24:27], v[216:219]
ds_read_b128 a[176:179], v2 offset:24576
v_mfma_f32_16x16x32_bf16 v[88:91], a[148:151], v[28:31], v[88:91]
ds_read_b128 a[180:183], v2 offset:25600
v_mfma_f32_16x16x32_bf16 v[88:91], a[152:155], v[32:35], v[88:91]
buffer_load_dwordx4 v16, s[32:35], s70 offen offset:2048 sc1 lds
v_mfma_f32_16x16x32_bf16 v[88:91], a[156:159], v[36:39], v[88:91]
ds_read_b128 a[184:187], v2 offset:26624
v_mfma_f32_16x16x32_bf16 v[104:107], a[156:159], v[52:55], v[220:223]
v_mfma_f32_16x16x32_bf16 v[104:107], a[152:155], v[48:51], v[104:107]
v_mfma_f32_16x16x32_bf16 v[104:107], a[148:151], v[44:47], v[104:107]
ds_read_b128 a[188:191], v2 offset:27648
v_mfma_f32_16x16x32_bf16 v[104:107], a[144:147], v[40:43], v[104:107]
v_mfma_f32_16x16x32_bf16 v[120:123], a[144:147], v[56:59], v[224:227]
v_mfma_f32_16x16x32_bf16 v[120:123], a[148:151], v[60:63], v[120:123]
v_mfma_f32_16x16x32_bf16 v[120:123], a[152:155], v[64:67], v[120:123]
v_exp_f32 v88, v88
v_mfma_f32_16x16x32_bf16 v[120:123], a[156:159], v[68:71], v[120:123]
v_exp_f32 v89, v89
v_mfma_f32_16x16x32_bf16 v[136:139], a[156:159], v[84:87], v[228:231]
v_exp_f32 v90, v90
v_mfma_f32_16x16x32_bf16 v[136:139], a[152:155], v[80:83], v[136:139]
v_exp_f32 v91, v91
v_mfma_f32_16x16x32_bf16 v[136:139], a[148:151], v[76:79], v[136:139]
v_exp_f32 v104, v104
v_mfma_f32_16x16x32_bf16 v[136:139], a[144:147], v[72:75], v[136:139]
v_exp_f32 v105, v105
v_mfma_f32_16x16x32_bf16 v[140:143], a[160:163], v[72:75], v[228:231]
v_exp_f32 v106, v106
v_mfma_f32_16x16x32_bf16 v[140:143], a[164:167], v[76:79], v[140:143]
buffer_load_dwordx4 v16, s[32:35], s70 offen offset:3072 sc1 lds
v_mfma_f32_16x16x32_bf16 v[140:143], a[168:171], v[80:83], v[140:143]
v_exp_f32 v107, v107
v_mfma_f32_16x16x32_bf16 v[140:143], a[172:175], v[84:87], v[140:143]
v_cvt_pk_bf16_f32 v168, v88, v89
v_cvt_pk_bf16_f32 v169, v90, v91
v_mfma_f32_16x16x32_bf16 v[124:127], a[172:175], v[68:71], v[224:227]
v_exp_f32 v120, v120
v_mfma_f32_16x16x32_bf16 v[124:127], a[168:171], v[64:67], v[124:127]
v_exp_f32 v121, v121
v_mfma_f32_16x16x32_bf16 v[124:127], a[164:167], v[60:63], v[124:127]
v_exp_f32 v122, v122
v_mfma_f32_16x16x32_bf16 v[124:127], a[160:163], v[56:59], v[124:127]
v_exp_f32 v123, v123
v_mfma_f32_16x16x32_bf16 v[108:111], a[160:163], v[40:43], v[220:223]
v_exp_f32 v136, v136
v_mfma_f32_16x16x32_bf16 v[108:111], a[164:167], v[44:47], v[108:111]
v_exp_f32 v137, v137
v_mfma_f32_16x16x32_bf16 v[108:111], a[168:171], v[48:51], v[108:111]
v_exp_f32 v138, v138
v_mfma_f32_16x16x32_bf16 v[108:111], a[172:175], v[52:55], v[108:111]
v_cvt_pk_bf16_f32 v176, v104, v105
v_cvt_pk_bf16_f32 v177, v106, v107
v_mfma_f32_16x16x32_bf16 v[92:95], a[172:175], v[36:39], v[216:219]
v_exp_f32 v139, v139
v_mfma_f32_16x16x32_bf16 v[92:95], a[168:171], v[32:35], v[92:95]
ds_read_b128 a[192:195], v2 offset:28672
v_cvt_pk_bf16_f32 v200, v120, v121
v_mfma_f32_16x16x32_bf16 v[92:95], a[164:167], v[28:31], v[92:95]
v_exp_f32 v140, v140
v_mfma_f32_16x16x32_bf16 v[92:95], a[160:163], v[24:27], v[92:95]
s_waitcnt lgkmcnt(1)
s_add_u32 m0, s71, 4096
ds_read_b128 a[196:199], v2 offset:29696
v_cvt_pk_bf16_f32 v201, v122, v123
v_mfma_f32_16x16x32_bf16 v[96:99], a[176:179], v[24:27], v[216:219]
s_add_u32 s64, s70, 4096
ds_read_b128 a[200:203], v2 offset:30720
v_cvt_pk_bf16_f32 v208, v136, v137
v_mfma_f32_16x16x32_bf16 v[96:99], a[180:183], v[28:31], v[96:99]
buffer_load_dwordx4 v16, s[32:35], s64 offen offset:0 sc1 lds
v_mfma_f32_16x16x32_bf16 v[96:99], a[184:187], v[32:35], v[96:99]
v_exp_f32 v141, v141
v_mfma_f32_16x16x32_bf16 v[96:99], a[188:191], v[36:39], v[96:99]
ds_read_b128 a[204:207], v2 offset:31744
v_cvt_pk_bf16_f32 v209, v138, v139
v_mfma_f32_16x16x32_bf16 v[112:115], a[188:191], v[52:55], v[220:223]
v_exp_f32 v142, v142
v_mfma_f32_16x16x32_bf16 v[112:115], a[184:187], v[48:51], v[112:115]
v_exp_f32 v143, v143
v_mfma_f32_16x16x32_bf16 v[112:115], a[180:183], v[44:47], v[112:115]
v_exp_f32 v124, v124
v_mfma_f32_16x16x32_bf16 v[112:115], a[176:179], v[40:43], v[112:115]
v_exp_f32 v125, v125
v_mfma_f32_16x16x32_bf16 v[128:131], a[176:179], v[56:59], v[224:227]
v_exp_f32 v126, v126
v_mfma_f32_16x16x32_bf16 v[128:131], a[180:183], v[60:63], v[128:131]
v_exp_f32 v127, v127
v_mfma_f32_16x16x32_bf16 v[128:131], a[184:187], v[64:67], v[128:131]
v_exp_f32 v108, v108
v_mfma_f32_16x16x32_bf16 v[128:131], a[188:191], v[68:71], v[128:131]
v_exp_f32 v109, v109
v_mfma_f32_16x16x32_bf16 v[144:147], a[188:191], v[84:87], v[228:231]
v_exp_f32 v110, v110
v_mfma_f32_16x16x32_bf16 v[144:147], a[184:187], v[80:83], v[144:147]
ds_read_b128 a[144:147], v3 offset:16384
v_cvt_pk_bf16_f32 v210, v140, v141
v_mfma_f32_16x16x32_bf16 v[144:147], a[180:183], v[76:79], v[144:147]
ds_read_b128 a[148:151], v3 offset:24576
v_cvt_pk_bf16_f32 v211, v142, v143
v_mfma_f32_16x16x32_bf16 v[144:147], a[176:179], v[72:75], v[144:147]
s_waitcnt lgkmcnt(2)
v_exp_f32 v111, v111
v_mfma_f32_16x16x32_bf16 v[148:151], a[192:195], v[72:75], v[228:231]
s_branch L_po16
L_pg16:
s_branch L_pg20
L_po16:
buffer_load_dwordx4 v16, s[32:35], s64 offen offset:1024 sc1 lds
v_mfma_f32_16x16x32_bf16 v[148:151], a[196:199], v[76:79], v[148:151]
v_exp_f32 v92, v92
v_mfma_f32_16x16x32_bf16 v[148:151], a[200:203], v[80:83], v[148:151]
v_exp_f32 v93, v93
v_mfma_f32_16x16x32_bf16 v[148:151], a[204:207], v[84:87], v[148:151]
v_exp_f32 v94, v94
v_mfma_f32_16x16x32_bf16 v[132:135], a[204:207], v[68:71], v[224:227]
ds_read_b128 a[152:155], v3 offset:17408
v_cvt_pk_bf16_f32 v202, v124, v125
v_mfma_f32_16x16x32_bf16 v[132:135], a[200:203], v[64:67], v[132:135]
ds_read_b128 a[156:159], v3 offset:25600
v_cvt_pk_bf16_f32 v203, v126, v127
v_mfma_f32_16x16x32_bf16 v[132:135], a[196:199], v[60:63], v[132:135]
v_exp_f32 v95, v95
v_mfma_f32_16x16x32_bf16 v[132:135], a[192:195], v[56:59], v[132:135]
v_exp_f32 v96, v96
v_mfma_f32_16x16x32_bf16 v[116:119], a[192:195], v[40:43], v[220:223]
v_exp_f32 v97, v97
v_mfma_f32_16x16x32_bf16 v[116:119], a[196:199], v[44:47], v[116:119]
v_exp_f32 v98, v98
v_mfma_f32_16x16x32_bf16 v[116:119], a[200:203], v[48:51], v[116:119]
ds_read_b128 a[160:163], v3 offset:18432
v_cvt_pk_bf16_f32 v178, v108, v109
v_mfma_f32_16x16x32_bf16 v[116:119], a[204:207], v[52:55], v[116:119]
v_exp_f32 v99, v99
v_mfma_f32_16x16x32_bf16 v[100:103], a[204:207], v[36:39], v[216:219]
ds_read_b128 a[164:167], v3 offset:26624
v_cvt_pk_bf16_f32 v179, v110, v111
v_mfma_f32_16x16x32_bf16 v[100:103], a[200:203], v[32:35], v[100:103]
v_exp_f32 v112, v112
v_mfma_f32_16x16x32_bf16 v[100:103], a[196:199], v[28:31], v[100:103]
v_exp_f32 v113, v113
v_mfma_f32_16x16x32_bf16 v[100:103], a[192:195], v[24:27], v[100:103]
v_exp_f32 v114, v114
v_smfmac_f32_16x16x64_bf16 a[128:131], a[240:243], v[152:159], v5
ds_read_b128 a[168:171], v3 offset:19456
v_smfmac_f32_16x16x64_bf16 a[132:135], a[240:243], v[160:167], v5
ds_read_b128 a[172:175], v3 offset:27648
v_smfmac_f32_16x16x64_bf16 a[136:139], a[240:243], v[184:191], v5
ds_read_b128 a[176:179], v3 offset:20480
v_smfmac_f32_16x16x64_bf16 a[140:143], a[240:243], v[192:199], v5
s_waitcnt lgkmcnt(3)
buffer_load_dwordx4 v16, s[32:35], s64 offen offset:2048 sc1 lds
v_mfma_f32_16x16x32_bf16 a[0:3], a[144:147], v[152:155], a[0:3]
v_exp_f32 v115, v115
v_mfma_f32_16x16x32_bf16 a[0:3], a[148:151], v[156:159], a[0:3]
v_exp_f32 v128, v128
v_mfma_f32_16x16x32_bf16 a[32:35], a[148:151], v[164:167], a[32:35]
v_exp_f32 v129, v129
v_mfma_f32_16x16x32_bf16 a[32:35], a[144:147], v[160:163], a[32:35]
v_exp_f32 v130, v130
v_mfma_f32_16x16x32_bf16 a[64:67], a[144:147], v[184:187], a[64:67]
v_exp_f32 v131, v131
v_mfma_f32_16x16x32_bf16 a[64:67], a[148:151], v[188:191], a[64:67]
v_cvt_pk_bf16_f32 v170, v92, v93
v_cvt_pk_bf16_f32 v171, v94, v95
v_mfma_f32_16x16x32_bf16 a[96:99], a[148:151], v[196:199], a[96:99]
v_exp_f32 v144, v144
v_mfma_f32_16x16x32_bf16 a[96:99], a[144:147], v[192:195], a[96:99]
ds_read_b128 a[180:183], v3 offset:28672
v_cvt_pk_bf16_f32 v172, v96, v97
v_mfma_f32_16x16x32_bf16 a[100:103], a[152:155], v[192:195], a[100:103]
v_exp_f32 v145, v145
v_mfma_f32_16x16x32_bf16 a[100:103], a[156:159], v[196:199], a[100:103]
ds_read_b128 a[184:187], v3 offset:21504
v_xor_b32 v2, 0x8000, v2
v_mfma_f32_16x16x32_bf16 a[68:71], a[156:159], v[188:191], a[68:71]
ds_read_b128 a[188:191], v3 offset:29696
v_cvt_pk_bf16_f32 v173, v98, v99
v_mfma_f32_16x16x32_bf16 a[68:71], a[152:155], v[184:187], a[68:71]
buffer_load_dwordx4 v16, s[32:35], s64 offen offset:3072 sc1 lds
v_mfma_f32_16x16x32_bf16 a[36:39], a[152:155], v[160:163], a[36:39]
ds_read_b128 a[192:195], v3 offset:22528
v_cvt_pk_bf16_f32 v180, v112, v113
v_mfma_f32_16x16x32_bf16 a[36:39], a[156:159], v[164:167], a[36:39]
ds_read_b128 a[196:199], v3 offset:30720
v_cvt_pk_bf16_f32 v181, v114, v115
v_mfma_f32_16x16x32_bf16 a[4:7], a[156:159], v[156:159], a[4:7]
ds_read_b128 a[200:203], v3 offset:23552
v_cvt_pk_bf16_f32 v204, v128, v129
v_mfma_f32_16x16x32_bf16 a[4:7], a[152:155], v[152:155], a[4:7]
v_exp_f32 v146, v146
v_mfma_f32_16x16x32_bf16 a[8:11], a[160:163], v[152:155], a[8:11]
v_exp_f32 v147, v147
v_mfma_f32_16x16x32_bf16 a[8:11], a[164:167], v[156:159], a[8:11]
v_exp_f32 v148, v148
v_mfma_f32_16x16x32_bf16 a[40:43], a[164:167], v[164:167], a[40:43]
ds_read_b128 a[204:207], v3 offset:31744
v_cvt_pk_bf16_f32 v205, v130, v131
v_mfma_f32_16x16x32_bf16 a[40:43], a[160:163], v[160:163], a[40:43]
v_exp_f32 v149, v149
v_mfma_f32_16x16x32_bf16 a[72:75], a[160:163], v[184:187], a[72:75]
v_exp_f32 v150, v150
v_mfma_f32_16x16x32_bf16 a[72:75], a[164:167], v[188:191], a[72:75]
v_exp_f32 v151, v151
v_mfma_f32_16x16x32_bf16 a[104:107], a[164:167], v[196:199], a[104:107]
v_exp_f32 v132, v132
v_mfma_f32_16x16x32_bf16 a[104:107], a[160:163], v[192:195], a[104:107]
s_waitcnt lgkmcnt(1)
v_exp_f32 v133, v133
v_mfma_f32_16x16x32_bf16 a[108:111], a[168:171], v[192:195], a[108:111]
v_exp_f32 v134, v134
v_mfma_f32_16x16x32_bf16 a[108:111], a[172:175], v[196:199], a[108:111]
v_exp_f32 v135, v135
v_mfma_f32_16x16x32_bf16 a[76:79], a[172:175], v[188:191], a[76:79]
v_exp_f32 v116, v116
v_mfma_f32_16x16x32_bf16 a[76:79], a[168:171], v[184:187], a[76:79]
v_exp_f32 v117, v117
v_mfma_f32_16x16x32_bf16 a[44:47], a[168:171], v[160:163], a[44:47]
v_exp_f32 v118, v118
v_mfma_f32_16x16x32_bf16 a[44:47], a[172:175], v[164:167], a[44:47]
s_waitcnt vmcnt(8)
s_barrier
v_mfma_f32_16x16x32_bf16 a[12:15], a[172:175], v[156:159], a[12:15]
s_xor_b32 s71, s71, 49152
v_exp_f32 v119, v119
v_mfma_f32_16x16x32_bf16 a[12:15], a[168:171], v[152:155], a[12:15]
s_add_u32 s70, s70, 32768
v_exp_f32 v100, v100
v_mfma_f32_16x16x32_bf16 a[16:19], a[176:179], v[152:155], a[16:19]
s_mov_b32 m0, s71
v_exp_f32 v101, v101
v_mfma_f32_16x16x32_bf16 a[16:19], a[180:183], v[156:159], a[16:19]
buffer_load_dwordx4 v16, s[32:35], s70 offen offset:0 sc1 lds
v_mfma_f32_16x16x32_bf16 a[48:51], a[180:183], v[164:167], a[48:51]
ds_read_b128 a[144:147], v2 offset:0
v_cvt_pk_bf16_f32 v212, v144, v145
v_mfma_f32_16x16x32_bf16 a[48:51], a[176:179], v[160:163], a[48:51]
ds_read_b128 a[148:151], v2 offset:1024
v_cvt_pk_bf16_f32 v213, v146, v147
v_mfma_f32_16x16x32_bf16 a[80:83], a[176:179], v[184:187], a[80:83]
v_exp_f32 v102, v102
v_mfma_f32_16x16x32_bf16 a[80:83], a[180:183], v[188:191], a[80:83]
ds_read_b128 a[152:155], v2 offset:2048
v_cvt_pk_bf16_f32 v214, v148, v149
v_mfma_f32_16x16x32_bf16 a[112:115], a[180:183], v[196:199], a[112:115]
ds_read_b128 a[156:159], v2 offset:3072
v_cvt_pk_bf16_f32 v215, v150, v151
v_mfma_f32_16x16x32_bf16 a[112:115], a[176:179], v[192:195], a[112:115]
v_exp_f32 v103, v103
v_mfma_f32_16x16x32_bf16 a[116:119], a[184:187], v[192:195], a[116:119]
ds_read_b128 a[160:163], v2 offset:4096
v_cvt_pk_bf16_f32 v206, v132, v133
v_mfma_f32_16x16x32_bf16 a[116:119], a[188:191], v[196:199], a[116:119]
ds_read_b128 a[164:167], v2 offset:5120
v_cvt_pk_bf16_f32 v207, v134, v135
v_mfma_f32_16x16x32_bf16 a[84:87], a[188:191], v[188:191], a[84:87]
ds_read_b128 a[168:171], v2 offset:6144
v_xor_b32 v3, 0x8000, v3
v_mfma_f32_16x16x32_bf16 a[84:87], a[184:187], v[184:187], a[84:87]
ds_read_b128 a[172:175], v2 offset:7168
v_cvt_pk_bf16_f32 v182, v116, v117
v_mfma_f32_16x16x32_bf16 a[52:55], a[184:187], v[160:163], a[52:55]
v_cvt_pk_bf16_f32 v183, v118, v119
v_cvt_pk_bf16_f32 v174, v100, v101
v_mfma_f32_16x16x32_bf16 a[52:55], a[188:191], v[164:167], a[52:55]
v_cvt_pk_bf16_f32 v175, v102, v103
v_mfma_f32_16x16x32_bf16 a[20:23], a[188:191], v[156:159], a[20:23]
v_mfma_f32_16x16x32_bf16 a[20:23], a[184:187], v[152:155], a[20:23]
v_mfma_f32_16x16x32_bf16 a[24:27], a[192:195], v[152:155], a[24:27]
buffer_load_dwordx4 v16, s[32:35], s70 offen offset:1024 sc1 lds
v_mfma_f32_16x16x32_bf16 a[24:27], a[196:199], v[156:159], a[24:27]
v_mfma_f32_16x16x32_bf16 a[56:59], a[196:199], v[164:167], a[56:59]
v_mfma_f32_16x16x32_bf16 a[56:59], a[192:195], v[160:163], a[56:59]
v_mfma_f32_16x16x32_bf16 a[88:91], a[192:195], v[184:187], a[88:91]
v_mfma_f32_16x16x32_bf16 a[88:91], a[196:199], v[188:191], a[88:91]
v_mfma_f32_16x16x32_bf16 a[120:123], a[196:199], v[196:199], a[120:123]
s_sub_u32 s72, s72, 1
v_mfma_f32_16x16x32_bf16 a[120:123], a[192:195], v[192:195], a[120:123]
v_mfma_f32_16x16x32_bf16 a[124:127], a[200:203], v[192:195], a[124:127]
s_waitcnt lgkmcnt(0)
v_mfma_f32_16x16x32_bf16 a[124:127], a[204:207], v[196:199], a[124:127]
v_mfma_f32_16x16x32_bf16 a[92:95], a[204:207], v[188:191], a[92:95]
s_cmp_lg_u32 s72, 0
v_mfma_f32_16x16x32_bf16 a[92:95], a[200:203], v[184:187], a[92:95]
v_mfma_f32_16x16x32_bf16 a[60:63], a[200:203], v[160:163], a[60:63]
v_mfma_f32_16x16x32_bf16 a[60:63], a[204:207], v[164:167], a[60:63]
v_mfma_f32_16x16x32_bf16 a[28:31], a[204:207], v[156:159], a[28:31]
v_mfma_f32_16x16x32_bf16 a[28:31], a[200:203], v[152:155], a[28:31]
s_cbranch_scc1 L_D
L_DD:
s_waitcnt lgkmcnt(7)
v_mfma_f32_16x16x32_bf16 v[104:107], a[144:147], v[40:43], v[220:223]
s_waitcnt lgkmcnt(6)
ds_read_b128 a[176:179], v2 offset:8192
v_cndmask_b32 v88, v216, v17, s[0:1]
v_mfma_f32_16x16x32_bf16 v[104:107], a[148:151], v[44:47], v[104:107]
s_waitcnt lgkmcnt(6)
ds_read_b128 a[180:183], v2 offset:9216
v_cndmask_b32 v89, v216, v17, s[4:5]
v_mfma_f32_16x16x32_bf16 v[104:107], a[152:155], v[48:51], v[104:107]
s_waitcnt lgkmcnt(6)
buffer_load_dwordx4 v16, s[32:35], s70 offen offset:2048 sc1 lds
v_mfma_f32_16x16x32_bf16 v[104:107], a[156:159], v[52:55], v[104:107]
ds_read_b128 a[184:187], v2 offset:10240
v_cndmask_b32 v90, v216, v17, s[6:7]
v_mfma_f32_16x16x32_bf16 v[120:123], a[156:159], v[68:71], v[224:227]
ds_read_b128 a[188:191], v2 offset:11264
v_cndmask_b32 v91, v216, v17, s[8:9]
v_mfma_f32_16x16x32_bf16 v[120:123], a[152:155], v[64:67], v[120:123]
ds_read_b128 a[192:195], v2 offset:12288
v_cndmask_b32 v92, v216, v17, s[10:11]
v_mfma_f32_16x16x32_bf16 v[120:123], a[148:151], v[60:63], v[120:123]
ds_read_b128 a[196:199], v2 offset:13312
v_cndmask_b32 v93, v216, v17, s[12:13]
v_mfma_f32_16x16x32_bf16 v[120:123], a[144:147], v[56:59], v[120:123]
ds_read_b128 a[200:203], v2 offset:14336
v_cndmask_b32 v94, v216, v17, s[18:19]
v_mfma_f32_16x16x32_bf16 v[136:139], a[144:147], v[72:75], v[228:231]
ds_read_b128 a[204:207], v2 offset:15360
v_cndmask_b32 v95, v216, v17, s[22:23]
v_mfma_f32_16x16x32_bf16 v[136:139], a[148:151], v[76:79], v[136:139]
v_cndmask_b32 v96, v216, v17, s[26:27]
v_cndmask_b32 v97, v216, v17, s[56:57]
v_mfma_f32_16x16x32_bf16 v[136:139], a[152:155], v[80:83], v[136:139]
v_exp_f32 v104, v104
v_mfma_f32_16x16x32_bf16 v[136:139], a[156:159], v[84:87], v[136:139]
v_exp_f32 v105, v105
v_mfma_f32_16x16x32_bf16 v[88:91], a[156:159], v[36:39], v[88:91]
v_exp_f32 v106, v106
v_mfma_f32_16x16x32_bf16 v[88:91], a[152:155], v[32:35], v[88:91]
v_exp_f32 v107, v107
v_mfma_f32_16x16x32_bf16 v[88:91], a[148:151], v[28:31], v[88:91]
v_exp_f32 v120, v120
v_mfma_f32_16x16x32_bf16 v[88:91], a[144:147], v[24:27], v[88:91]
s_waitcnt lgkmcnt(0)
v_exp_f32 v121, v121
v_mfma_f32_16x16x32_bf16 v[140:143], a[160:163], v[72:75], v[228:231]
v_exp_f32 v122, v122
v_mfma_f32_16x16x32_bf16 v[140:143], a[164:167], v[76:79], v[140:143]
buffer_load_dwordx4 v16, s[32:35], s70 offen offset:3072 sc1 lds
v_mfma_f32_16x16x32_bf16 v[140:143], a[168:171], v[80:83], v[140:143]
s_add_u32 m0, s86, 131072
v_exp_f32 v123, v123
v_mfma_f32_16x16x32_bf16 v[140:143], a[172:175], v[84:87], v[140:143]
s_add_u32 s64, s85, 0
v_cvt_pk_bf16_f32 v160, v104, v105
v_cvt_pk_bf16_f32 v161, v106, v107
v_mfma_f32_16x16x32_bf16 v[124:127], a[172:175], v[68:71], v[224:227]
buffer_load_dwordx4 v12, s[36:39], s64 offen lds
v_mfma_f32_16x16x32_bf16 v[124:127], a[168:171], v[64:67], v[124:127]
s_add_u32 m0, s86, 132096
v_exp_f32 v136, v136
v_mfma_f32_16x16x32_bf16 v[124:127], a[164:167], v[60:63], v[124:127]
s_add_u32 s64, s85, 8192
v_exp_f32 v137, v137
v_mfma_f32_16x16x32_bf16 v[124:127], a[160:163], v[56:59], v[124:127]
buffer_load_dwordx4 v13, s[36:39], s64 offen lds
v_mfma_f32_16x16x32_bf16 v[108:111], a[160:163], v[40:43], v[220:223]
v_exp_f32 v138, v138
v_mfma_f32_16x16x32_bf16 v[108:111], a[164:167], v[44:47], v[108:111]
ds_read_b128 a[144:147], v3 offset:0
v_cndmask_b32 v98, v216, v17, s[58:59]
v_mfma_f32_16x16x32_bf16 v[108:111], a[168:171], v[48:51], v[108:111]
s_add_u32 m0, s86, 133120
ds_read_b128 a[148:151], v3 offset:8192
v_cndmask_b32 v99, v216, v17, s[60:61]
v_mfma_f32_16x16x32_bf16 v[108:111], a[172:175], v[52:55], v[108:111]
s_add_u32 s64, s85, 16384
v_cvt_pk_bf16_f32 v184, v120, v121
v_cvt_pk_bf16_f32 v185, v122, v123
v_mfma_f32_16x16x32_bf16 v[92:95], a[172:175], v[36:39], v[92:95]
buffer_load_dwordx4 v12, s[36:39], s64 offen lds
v_mfma_f32_16x16x32_bf16 v[92:95], a[168:171], v[32:35], v[92:95]
s_add_u32 m0, s86, 134144
v_exp_f32 v139, v139
v_mfma_f32_16x16x32_bf16 v[92:95], a[164:167], v[28:31], v[92:95]
s_add_u32 s64, s85, 24576
v_exp_f32 v88, v88
v_mfma_f32_16x16x32_bf16 v[92:95], a[160:163], v[24:27], v[92:95]
buffer_load_dwordx4 v13, s[36:39], s64 offen lds
v_mfma_f32_16x16x32_bf16 v[96:99], a[176:179], v[24:27], v[96:99]
s_add_u32 m0, s71, 4096
v_exp_f32 v89, v89
v_mfma_f32_16x16x32_bf16 v[96:99], a[180:183], v[28:31], v[96:99]
s_add_u32 s64, s70, 4096
v_exp_f32 v90, v90
v_mfma_f32_16x16x32_bf16 v[96:99], a[184:187], v[32:35], v[96:99]
buffer_load_dwordx4 v16, s[32:35], s64 offen offset:0 sc1 lds
v_mfma_f32_16x16x32_bf16 v[96:99], a[188:191], v[36:39], v[96:99]
v_cvt_pk_bf16_f32 v192, v136, v137
v_cvt_pk_bf16_f32 v193, v138, v139
v_mfma_f32_16x16x32_bf16 v[112:115], a[188:191], v[52:55], v[220:223]
v_exp_f32 v91, v91
v_mfma_f32_16x16x32_bf16 v[112:115], a[184:187], v[48:51], v[112:115]
v_exp_f32 v140, v140
v_mfma_f32_16x16x32_bf16 v[112:115], a[180:183], v[44:47], v[112:115]
v_exp_f32 v141, v141
v_mfma_f32_16x16x32_bf16 v[112:115], a[176:179], v[40:43], v[112:115]
v_exp_f32 v142, v142
v_mfma_f32_16x16x32_bf16 v[128:131], a[176:179], v[56:59], v[224:227]
v_exp_f32 v143, v143
v_mfma_f32_16x16x32_bf16 v[128:131], a[180:183], v[60:63], v[128:131]
v_exp_f32 v124, v124
v_mfma_f32_16x16x32_bf16 v[128:131], a[184:187], v[64:67], v[128:131]
v_cvt_pk_bf16_f32 v152, v88, v89
v_cvt_pk_bf16_f32 v153, v90, v91
v_mfma_f32_16x16x32_bf16 v[128:131], a[188:191], v[68:71], v[128:131]
v_exp_f32 v125, v125
v_mfma_f32_16x16x32_bf16 v[144:147], a[188:191], v[84:87], v[228:231]
v_exp_f32 v126, v126
v_mfma_f32_16x16x32_bf16 v[144:147], a[184:187], v[80:83], v[144:147]
v_exp_f32 v127, v127
v_mfma_f32_16x16x32_bf16 v[144:147], a[180:183], v[76:79], v[144:147]
v_exp_f32 v108, v108
v_mfma_f32_16x16x32_bf16 v[144:147], a[176:179], v[72:75], v[144:147]
ds_read_b128 a[152:155], v3 offset:1024
v_cndmask_b32 v100, v216, v17, s[62:63]
v_mfma_f32_16x16x32_bf16 v[148:151], a[192:195], v[72:75], v[228:231]
buffer_load_dwordx4 v16, s[32:35], s64 offen offset:1024 sc1 lds
v_mfma_f32_16x16x32_bf16 v[148:151], a[196:199], v[76:79], v[148:151]
ds_read_b128 a[156:159], v3 offset:9216
v_cndmask_b32 v101, v216, v17, s[48:49]
v_mfma_f32_16x16x32_bf16 v[148:151], a[200:203], v[80:83], v[148:151]
v_cvt_pk_bf16_f32 v194, v140, v141
v_cvt_pk_bf16_f32 v195, v142, v143
v_mfma_f32_16x16x32_bf16 v[148:151], a[204:207], v[84:87], v[148:151]
ds_read_b128 a[160:163], v3 offset:2048
v_cndmask_b32 v102, v216, v17, s[50:51]
v_mfma_f32_16x16x32_bf16 v[132:135], a[204:207], v[68:71], v[224:227]
ds_read_b128 a[164:167], v3 offset:10240
v_cndmask_b32 v103, v216, v17, s[100:101]
v_mfma_f32_16x16x32_bf16 v[132:135], a[200:203], v[64:67], v[132:135]
v_exp_f32 v109, v109
v_mfma_f32_16x16x32_bf16 v[132:135], a[196:199], v[60:63], v[132:135]
v_exp_f32 v110, v110
v_mfma_f32_16x16x32_bf16 v[132:135], a[192:195], v[56:59], v[132:135]
v_exp_f32 v111, v111
v_mfma_f32_16x16x32_bf16 v[116:119], a[192:195], v[40:43], v[220:223]
v_exp_f32 v92, v92
v_mfma_f32_16x16x32_bf16 v[116:119], a[196:199], v[44:47], v[116:119]
v_cvt_pk_bf16_f32 v186, v124, v125
v_cvt_pk_bf16_f32 v187, v126, v127
v_mfma_f32_16x16x32_bf16 v[116:119], a[200:203], v[48:51], v[116:119]
v_exp_f32 v93, v93
v_mfma_f32_16x16x32_bf16 v[116:119], a[204:207], v[52:55], v[116:119]
v_exp_f32 v94, v94
v_mfma_f32_16x16x32_bf16 v[100:103], a[204:207], v[36:39], v[100:103]
v_exp_f32 v95, v95
v_mfma_f32_16x16x32_bf16 v[100:103], a[200:203], v[32:35], v[100:103]
v_exp_f32 v96, v96
v_mfma_f32_16x16x32_bf16 v[100:103], a[196:199], v[28:31], v[100:103]
v_exp_f32 v97, v97
v_mfma_f32_16x16x32_bf16 v[100:103], a[192:195], v[24:27], v[100:103]
v_exp_f32 v98, v98
v_smfmac_f32_16x16x64_bf16 a[128:131], a[240:243], v[168:175], v5
ds_read_b128 a[168:171], v3 offset:3072
v_smfmac_f32_16x16x64_bf16 a[132:135], a[240:243], v[176:183], v5
v_cvt_pk_bf16_f32 v162, v108, v109
v_smfmac_f32_16x16x64_bf16 a[136:139], a[240:243], v[200:207], v5
ds_read_b128 a[172:175], v3 offset:11264
v_smfmac_f32_16x16x64_bf16 a[140:143], a[240:243], v[208:215], v5
s_waitcnt lgkmcnt(2)
buffer_load_dwordx4 v16, s[32:35], s64 offen offset:2048 sc1 lds
v_mfma_f32_16x16x32_bf16 a[0:3], a[144:147], v[168:171], a[0:3]
v_exp_f32 v99, v99
v_mfma_f32_16x16x32_bf16 a[0:3], a[148:151], v[172:175], a[0:3]
v_cvt_pk_bf16_f32 v163, v110, v111
v_cvt_pk_bf16_f32 v154, v92, v93
v_mfma_f32_16x16x32_bf16 a[32:35], a[148:151], v[180:183], a[32:35]
v_exp_f32 v112, v112
v_mfma_f32_16x16x32_bf16 a[32:35], a[144:147], v[176:179], a[32:35]
v_exp_f32 v113, v113
v_mfma_f32_16x16x32_bf16 a[64:67], a[144:147], v[200:203], a[64:67]
v_exp_f32 v114, v114
v_mfma_f32_16x16x32_bf16 a[64:67], a[148:151], v[204:207], a[64:67]
v_exp_f32 v115, v115
v_mfma_f32_16x16x32_bf16 a[96:99], a[148:151], v[212:215], a[96:99]
v_exp_f32 v128, v128
v_mfma_f32_16x16x32_bf16 a[96:99], a[144:147], v[208:211], a[96:99]
v_exp_f32 v129, v129
v_mfma_f32_16x16x32_bf16 a[100:103], a[152:155], v[208:211], a[100:103]
v_exp_f32 v130, v130
v_mfma_f32_16x16x32_bf16 a[100:103], a[156:159], v[212:215], a[100:103]
v_cvt_pk_bf16_f32 v155, v94, v95
v_cvt_pk_bf16_f32 v156, v96, v97
v_mfma_f32_16x16x32_bf16 a[68:71], a[156:159], v[204:207], a[68:71]
v_exp_f32 v131, v131
v_mfma_f32_16x16x32_bf16 a[68:71], a[152:155], v[200:203], a[68:71]
buffer_load_dwordx4 v16, s[32:35], s64 offen offset:3072 sc1 lds
v_mfma_f32_16x16x32_bf16 a[36:39], a[152:155], v[176:179], a[36:39]
s_add_u32 m0, s86, 135168
ds_read_b128 a[176:179], v3 offset:4096
v_cvt_pk_bf16_f32 v157, v98, v99
v_mfma_f32_16x16x32_bf16 a[36:39], a[156:159], v[180:183], a[36:39]
s_add_u32 s64, s85, 32768
v_exp_f32 v144, v144
v_mfma_f32_16x16x32_bf16 a[4:7], a[156:159], v[172:175], a[4:7]
buffer_load_dwordx4 v12, s[36:39], s64 offen lds
v_mfma_f32_16x16x32_bf16 a[4:7], a[152:155], v[168:171], a[4:7]
s_add_u32 m0, s86, 136192
ds_read_b128 a[180:183], v3 offset:12288
v_cvt_pk_bf16_f32 v164, v112, v113
v_mfma_f32_16x16x32_bf16 a[8:11], a[160:163], v[168:171], a[8:11]
s_add_u32 s64, s85, 40960
v_exp_f32 v145, v145
v_mfma_f32_16x16x32_bf16 a[8:11], a[164:167], v[172:175], a[8:11]
buffer_load_dwordx4 v13, s[36:39], s64 offen lds
v_mfma_f32_16x16x32_bf16 a[40:43], a[164:167], v[180:183], a[40:43]
ds_read_b128 a[184:187], v3 offset:5120
v_cvt_pk_bf16_f32 v165, v114, v115
v_mfma_f32_16x16x32_bf16 a[40:43], a[160:163], v[176:179], a[40:43]
ds_read_b128 a[188:191], v3 offset:13312
v_cvt_pk_bf16_f32 v188, v128, v129
v_mfma_f32_16x16x32_bf16 a[72:75], a[160:163], v[200:203], a[72:75]
ds_read_b128 a[192:195], v3 offset:6144
v_cvt_pk_bf16_f32 v189, v130, v131
v_mfma_f32_16x16x32_bf16 a[72:75], a[164:167], v[204:207], a[72:75]
ds_read_b128 a[196:199], v3 offset:14336
v_cvt_pk_bf16_f32 v196, v144, v145
v_mfma_f32_16x16x32_bf16 a[104:107], a[164:167], v[212:215], a[104:107]
ds_read_b128 a[200:203], v3 offset:7168
v_mfma_f32_16x16x32_bf16 a[104:107], a[160:163], v[208:211], a[104:107]
s_waitcnt lgkmcnt(5)
s_add_u32 m0, s86, 137216
ds_read_b128 a[204:207], v3 offset:15360
v_mfma_f32_16x16x32_bf16 a[108:111], a[168:171], v[208:211], a[108:111]
s_add_u32 s64, s85, 49152
v_exp_f32 v146, v146
v_mfma_f32_16x16x32_bf16 a[108:111], a[172:175], v[212:215], a[108:111]
buffer_load_dwordx4 v12, s[36:39], s64 offen lds
v_mfma_f32_16x16x32_bf16 a[76:79], a[172:175], v[204:207], a[76:79]
s_add_u32 m0, s86, 138240
v_exp_f32 v147, v147
v_mfma_f32_16x16x32_bf16 a[76:79], a[168:171], v[200:203], a[76:79]
s_add_u32 s64, s85, 57344
v_exp_f32 v148, v148
v_mfma_f32_16x16x32_bf16 a[44:47], a[168:171], v[176:179], a[44:47]
buffer_load_dwordx4 v13, s[36:39], s64 offen lds
v_mfma_f32_16x16x32_bf16 a[44:47], a[172:175], v[180:183], a[44:47]
s_waitcnt vmcnt(16)
s_barrier
v_mfma_f32_16x16x32_bf16 a[12:15], a[172:175], v[172:175], a[12:15]
s_xor_b32 s71, s71, 16384
v_exp_f32 v149, v149
v_mfma_f32_16x16x32_bf16 a[12:15], a[168:171], v[168:171], a[12:15]
s_add_u32 s70, s70, 32768
v_exp_f32 v150, v150
v_mfma_f32_16x16x32_bf16 a[16:19], a[176:179], v[168:171], a[16:19]
s_mov_b32 m0, s71
v_exp_f32 v151, v151
v_mfma_f32_16x16x32_bf16 a[16:19], a[180:183], v[172:175], a[16:19]
buffer_load_dwordx4 v16, s[32:35], s70 offen offset:0 sc1 lds
v_mfma_f32_16x16x32_bf16 a[48:51], a[180:183], v[180:183], a[48:51]
v_exp_f32 v132, v132
v_mfma_f32_16x16x32_bf16 a[48:51], a[176:179], v[176:179], a[48:51]
v_exp_f32 v133, v133
v_mfma_f32_16x16x32_bf16 a[80:83], a[176:179], v[200:203], a[80:83]
v_exp_f32 v134, v134
v_mfma_f32_16x16x32_bf16 a[80:83], a[180:183], v[204:207], a[80:83]
v_exp_f32 v135, v135
v_mfma_f32_16x16x32_bf16 a[112:115], a[180:183], v[212:215], a[112:115]
v_exp_f32 v116, v116
v_mfma_f32_16x16x32_bf16 a[112:115], a[176:179], v[208:211], a[112:115]
s_waitcnt lgkmcnt(0)
v_cvt_pk_bf16_f32 v197, v146, v147
v_cvt_pk_bf16_f32 v198, v148, v149
v_mfma_f32_16x16x32_bf16 a[116:119], a[184:187], v[208:211], a[116:119]
v_exp_f32 v117, v117
v_mfma_f32_16x16x32_bf16 a[116:119], a[188:191], v[212:215], a[116:119]
v_exp_f32 v118, v118
v_mfma_f32_16x16x32_bf16 a[84:87], a[188:191], v[204:207], a[84:87]
v_exp_f32 v119, v119
v_mfma_f32_16x16x32_bf16 a[84:87], a[184:187], v[200:203], a[84:87]
v_exp_f32 v100, v100
v_mfma_f32_16x16x32_bf16 a[52:55], a[184:187], v[176:179], a[52:55]
v_exp_f32 v101, v101
v_mfma_f32_16x16x32_bf16 a[52:55], a[188:191], v[180:183], a[52:55]
ds_read_b128 a[144:147], v2 offset:16384
v_cvt_pk_bf16_f32 v199, v150, v151
v_mfma_f32_16x16x32_bf16 a[20:23], a[188:191], v[172:175], a[20:23]
ds_read_b128 a[148:151], v2 offset:17408
v_cvt_pk_bf16_f32 v190, v132, v133
v_mfma_f32_16x16x32_bf16 a[20:23], a[184:187], v[168:171], a[20:23]
v_exp_f32 v102, v102
v_mfma_f32_16x16x32_bf16 a[24:27], a[192:195], v[168:171], a[24:27]
buffer_load_dwordx4 v16, s[32:35], s70 offen offset:1024 sc1 lds
v_mfma_f32_16x16x32_bf16 a[24:27], a[196:199], v[172:175], a[24:27]
ds_read_b128 a[152:155], v2 offset:18432
v_cvt_pk_bf16_f32 v191, v134, v135
v_mfma_f32_16x16x32_bf16 a[56:59], a[196:199], v[180:183], a[56:59]
ds_read_b128 a[156:159], v2 offset:19456
v_cvt_pk_bf16_f32 v166, v116, v117
v_mfma_f32_16x16x32_bf16 a[56:59], a[192:195], v[176:179], a[56:59]
v_exp_f32 v103, v103
v_mfma_f32_16x16x32_bf16 a[88:91], a[192:195], v[200:203], a[88:91]
ds_read_b128 a[160:163], v2 offset:20480
v_cvt_pk_bf16_f32 v167, v118, v119
v_mfma_f32_16x16x32_bf16 a[88:91], a[196:199], v[204:207], a[88:91]
ds_read_b128 a[164:167], v2 offset:21504
v_cvt_pk_bf16_f32 v158, v100, v101
v_mfma_f32_16x16x32_bf16 a[120:123], a[196:199], v[212:215], a[120:123]
ds_read_b128 a[168:171], v2 offset:22528
v_cvt_pk_bf16_f32 v159, v102, v103
v_mfma_f32_16x16x32_bf16 a[120:123], a[192:195], v[208:211], a[120:123]
ds_read_b128 a[172:175], v2 offset:23552
v_cndmask_b32 v104, v220, v17, s[0:1]
v_mfma_f32_16x16x32_bf16 a[124:127], a[200:203], v[208:211], a[124:127]
v_cndmask_b32 v105, v220, v17, s[4:5]
v_cndmask_b32 v106, v220, v17, s[6:7]
v_mfma_f32_16x16x32_bf16 a[124:127], a[204:207], v[212:215], a[124:127]
v_cndmask_b32 v107, v220, v17, s[8:9]
v_cndmask_b32 v108, v220, v17, s[10:11]
v_mfma_f32_16x16x32_bf16 a[92:95], a[204:207], v[204:207], a[92:95]
v_cndmask_b32 v109, v220, v17, s[12:13]
v_cndmask_b32 v110, v220, v17, s[18:19]
v_mfma_f32_16x16x32_bf16 a[92:95], a[200:203], v[200:203], a[92:95]
v_cndmask_b32 v111, v220, v17, s[22:23]
v_cndmask_b32 v112, v220, v17, s[26:27]
v_mfma_f32_16x16x32_bf16 a[60:63], a[200:203], v[176:179], a[60:63]
v_cndmask_b32 v113, v220, v17, s[56:57]
v_cndmask_b32 v114, v220, v17, s[58:59]
v_mfma_f32_16x16x32_bf16 a[60:63], a[204:207], v[180:183], a[60:63]
v_cndmask_b32 v115, v220, v17, s[60:61]
v_cndmask_b32 v116, v220, v17, s[62:63]
v_mfma_f32_16x16x32_bf16 a[28:31], a[204:207], v[172:175], a[28:31]
v_cndmask_b32 v117, v220, v17, s[48:49]
v_cndmask_b32 v118, v220, v17, s[50:51]
v_mfma_f32_16x16x32_bf16 a[28:31], a[200:203], v[168:171], a[28:31]
s_waitcnt lgkmcnt(0)
v_cndmask_b32 v119, v220, v17, s[100:101]
v_mfma_f32_16x16x32_bf16 v[120:123], a[144:147], v[56:59], v[224:227]
ds_read_b128 a[176:179], v2 offset:24576
v_mfma_f32_16x16x32_bf16 v[120:123], a[148:151], v[60:63], v[120:123]
ds_read_b128 a[180:183], v2 offset:25600
v_mfma_f32_16x16x32_bf16 v[120:123], a[152:155], v[64:67], v[120:123]
buffer_load_dwordx4 v16, s[32:35], s70 offen offset:2048 sc1 lds
v_mfma_f32_16x16x32_bf16 v[120:123], a[156:159], v[68:71], v[120:123]
ds_read_b128 a[184:187], v2 offset:26624
v_mfma_f32_16x16x32_bf16 v[136:139], a[156:159], v[84:87], v[228:231]
ds_read_b128 a[188:191], v2 offset:27648
v_mfma_f32_16x16x32_bf16 v[136:139], a[152:155], v[80:83], v[136:139]
v_mfma_f32_16x16x32_bf16 v[136:139], a[148:151], v[76:79], v[136:139]
v_mfma_f32_16x16x32_bf16 v[136:139], a[144:147], v[72:75], v[136:139]
v_mfma_f32_16x16x32_bf16 v[104:107], a[144:147], v[40:43], v[104:107]
ds_read_b128 a[192:195], v2 offset:28672
v_mfma_f32_16x16x32_bf16 v[104:107], a[148:151], v[44:47], v[104:107]
v_mfma_f32_16x16x32_bf16 v[104:107], a[152:155], v[48:51], v[104:107]
v_exp_f32 v120, v120
v_mfma_f32_16x16x32_bf16 v[104:107], a[156:159], v[52:55], v[104:107]
v_exp_f32 v121, v121
v_mfma_f32_16x16x32_bf16 v[140:143], a[172:175], v[84:87], v[228:231]
v_exp_f32 v122, v122
v_mfma_f32_16x16x32_bf16 v[140:143], a[168:171], v[80:83], v[140:143]
v_exp_f32 v123, v123
v_mfma_f32_16x16x32_bf16 v[140:143], a[164:167], v[76:79], v[140:143]
v_exp_f32 v136, v136
v_mfma_f32_16x16x32_bf16 v[140:143], a[160:163], v[72:75], v[140:143]
buffer_load_dwordx4 v16, s[32:35], s70 offen offset:3072 sc1 lds
v_mfma_f32_16x16x32_bf16 v[124:127], a[160:163], v[56:59], v[224:227]
v_exp_f32 v137, v137
v_mfma_f32_16x16x32_bf16 v[124:127], a[164:167], v[60:63], v[124:127]
v_exp_f32 v138, v138
v_mfma_f32_16x16x32_bf16 v[124:127], a[168:171], v[64:67], v[124:127]
v_exp_f32 v139, v139
v_mfma_f32_16x16x32_bf16 v[124:127], a[172:175], v[68:71], v[124:127]
v_exp_f32 v104, v104
v_mfma_f32_16x16x32_bf16 v[108:111], a[172:175], v[52:55], v[108:111]
v_cvt_pk_bf16_f32 v200, v120, v121
v_cvt_pk_bf16_f32 v201, v122, v123
v_mfma_f32_16x16x32_bf16 v[108:111], a[168:171], v[48:51], v[108:111]
ds_read_b128 a[196:199], v2 offset:29696
v_cvt_pk_bf16_f32 v208, v136, v137
v_mfma_f32_16x16x32_bf16 v[108:111], a[164:167], v[44:47], v[108:111]
ds_read_b128 a[200:203], v2 offset:30720
v_cvt_pk_bf16_f32 v209, v138, v139
v_mfma_f32_16x16x32_bf16 v[108:111], a[160:163], v[40:43], v[108:111]
s_waitcnt lgkmcnt(2)
ds_read_b128 a[204:207], v2 offset:31744
v_mfma_f32_16x16x32_bf16 v[112:115], a[176:179], v[40:43], v[112:115]
v_exp_f32 v105, v105
v_mfma_f32_16x16x32_bf16 v[112:115], a[180:183], v[44:47], v[112:115]
v_exp_f32 v106, v106
v_mfma_f32_16x16x32_bf16 v[112:115], a[184:187], v[48:51], v[112:115]
v_exp_f32 v107, v107
v_mfma_f32_16x16x32_bf16 v[112:115], a[188:191], v[52:55], v[112:115]
s_add_u32 m0, s71, 4096
v_exp_f32 v140, v140
v_mfma_f32_16x16x32_bf16 v[128:131], a[188:191], v[68:71], v[224:227]
s_branch L_po17
L_pg17:
s_branch L_pg21
L_po17:
s_add_u32 s64, s70, 4096
v_exp_f32 v141, v141
v_mfma_f32_16x16x32_bf16 v[128:131], a[184:187], v[64:67], v[128:131]
buffer_load_dwordx4 v16, s[32:35], s64 offen offset:0 sc1 lds
v_mfma_f32_16x16x32_bf16 v[128:131], a[180:183], v[60:63], v[128:131]
v_exp_f32 v142, v142
v_mfma_f32_16x16x32_bf16 v[128:131], a[176:179], v[56:59], v[128:131]
v_exp_f32 v143, v143
v_mfma_f32_16x16x32_bf16 v[144:147], a[176:179], v[72:75], v[228:231]
ds_read_b128 a[144:147], v3 offset:16384
v_cvt_pk_bf16_f32 v176, v104, v105
v_mfma_f32_16x16x32_bf16 v[144:147], a[180:183], v[76:79], v[144:147]
ds_read_b128 a[148:151], v3 offset:24576
v_cvt_pk_bf16_f32 v177, v106, v107
v_mfma_f32_16x16x32_bf16 v[144:147], a[184:187], v[80:83], v[144:147]
v_exp_f32 v124, v124
v_mfma_f32_16x16x32_bf16 v[144:147], a[188:191], v[84:87], v[144:147]
s_waitcnt lgkmcnt(2)
v_exp_f32 v125, v125
v_mfma_f32_16x16x32_bf16 v[148:151], a[204:207], v[84:87], v[228:231]
v_exp_f32 v126, v126
v_mfma_f32_16x16x32_bf16 v[148:151], a[200:203], v[80:83], v[148:151]
v_exp_f32 v127, v127
v_mfma_f32_16x16x32_bf16 v[148:151], a[196:199], v[76:79], v[148:151]
ds_read_b128 a[152:155], v3 offset:17408
v_cvt_pk_bf16_f32 v210, v140, v141
v_mfma_f32_16x16x32_bf16 v[148:151], a[192:195], v[72:75], v[148:151]
ds_read_b128 a[156:159], v3 offset:25600
v_cvt_pk_bf16_f32 v211, v142, v143
v_mfma_f32_16x16x32_bf16 v[132:135], a[192:195], v[56:59], v[224:227]
v_exp_f32 v108, v108
v_mfma_f32_16x16x32_bf16 v[132:135], a[196:199], v[60:63], v[132:135]
v_exp_f32 v109, v109
v_mfma_f32_16x16x32_bf16 v[132:135], a[200:203], v[64:67], v[132:135]
buffer_load_dwordx4 v16, s[32:35], s64 offen offset:1024 sc1 lds
v_mfma_f32_16x16x32_bf16 v[132:135], a[204:207], v[68:71], v[132:135]
v_exp_f32 v110, v110
v_mfma_f32_16x16x32_bf16 v[116:119], a[204:207], v[52:55], v[116:119]
ds_read_b128 a[160:163], v3 offset:18432
v_cvt_pk_bf16_f32 v202, v124, v125
v_mfma_f32_16x16x32_bf16 v[116:119], a[200:203], v[48:51], v[116:119]
v_exp_f32 v111, v111
v_mfma_f32_16x16x32_bf16 v[116:119], a[196:199], v[44:47], v[116:119]
ds_read_b128 a[164:167], v3 offset:26624
v_cvt_pk_bf16_f32 v203, v126, v127
v_mfma_f32_16x16x32_bf16 v[116:119], a[192:195], v[40:43], v[116:119]
v_exp_f32 v112, v112
v_smfmac_f32_16x16x64_bf16 a[128:131], a[240:243], v[152:159], v5
ds_read_b128 a[168:171], v3 offset:19456
v_smfmac_f32_16x16x64_bf16 a[132:135], a[240:243], v[160:167], v5
ds_read_b128 a[172:175], v3 offset:27648
v_smfmac_f32_16x16x64_bf16 a[136:139], a[240:243], v[184:191], v5
ds_read_b128 a[176:179], v3 offset:20480
v_smfmac_f32_16x16x64_bf16 a[140:143], a[240:243], v[192:199], v5
s_waitcnt lgkmcnt(4)
ds_read_b128 a[180:183], v3 offset:28672
v_xor_b32 v2, 0x8000, v2
v_mfma_f32_16x16x32_bf16 a[0:3], a[144:147], v[152:155], a[0:3]
v_exp_f32 v113, v113
v_mfma_f32_16x16x32_bf16 a[0:3], a[148:151], v[156:159], a[0:3]
v_exp_f32 v114, v114
v_mfma_f32_16x16x32_bf16 a[32:35], a[148:151], v[164:167], a[32:35]
v_exp_f32 v115, v115
v_mfma_f32_16x16x32_bf16 a[32:35], a[144:147], v[160:163], a[32:35]
v_exp_f32 v128, v128
v_mfma_f32_16x16x32_bf16 a[64:67], a[144:147], v[184:187], a[64:67]
buffer_load_dwordx4 v16, s[32:35], s64 offen offset:2048 sc1 lds
v_mfma_f32_16x16x32_bf16 a[64:67], a[148:151], v[188:191], a[64:67]
v_exp_f32 v129, v129
v_mfma_f32_16x16x32_bf16 a[96:99], a[148:151], v[196:199], a[96:99]
v_exp_f32 v130, v130
v_mfma_f32_16x16x32_bf16 a[96:99], a[144:147], v[192:195], a[96:99]
v_exp_f32 v131, v131
v_mfma_f32_16x16x32_bf16 a[100:103], a[152:155], v[192:195], a[100:103]
v_exp_f32 v144, v144
v_mfma_f32_16x16x32_bf16 a[100:103], a[156:159], v[196:199], a[100:103]
v_exp_f32 v145, v145
v_mfma_f32_16x16x32_bf16 a[68:71], a[156:159], v[188:191], a[68:71]
ds_read_b128 a[184:187], v3 offset:21504
v_cvt_pk_bf16_f32 v178, v108, v109
v_mfma_f32_16x16x32_bf16 a[68:71], a[152:155], v[184:187], a[68:71]
ds_read_b128 a[188:191], v3 offset:29696
v_cvt_pk_bf16_f32 v179, v110, v111
v_mfma_f32_16x16x32_bf16 a[36:39], a[152:155], v[160:163], a[36:39]
ds_read_b128 a[192:195], v3 offset:22528
v_cvt_pk_bf16_f32 v180, v112, v113
v_mfma_f32_16x16x32_bf16 a[36:39], a[156:159], v[164:167], a[36:39]
v_exp_f32 v146, v146
v_mfma_f32_16x16x32_bf16 a[4:7], a[156:159], v[156:159], a[4:7]
v_exp_f32 v147, v147
v_mfma_f32_16x16x32_bf16 a[4:7], a[152:155], v[152:155], a[4:7]
v_exp_f32 v148, v148
v_mfma_f32_16x16x32_bf16 a[8:11], a[160:163], v[152:155], a[8:11]
s_waitcnt lgkmcnt(2)
ds_read_b128 a[196:199], v3 offset:30720
v_cvt_pk_bf16_f32 v181, v114, v115
v_mfma_f32_16x16x32_bf16 a[8:11], a[164:167], v[156:159], a[8:11]
buffer_load_dwordx4 v16, s[32:35], s64 offen offset:3072 sc1 lds
v_mfma_f32_16x16x32_bf16 a[40:43], a[164:167], v[164:167], a[40:43]
v_exp_f32 v149, v149
v_mfma_f32_16x16x32_bf16 a[40:43], a[160:163], v[160:163], a[40:43]
ds_read_b128 a[200:203], v3 offset:23552
v_cvt_pk_bf16_f32 v204, v128, v129
v_mfma_f32_16x16x32_bf16 a[72:75], a[160:163], v[184:187], a[72:75]
v_exp_f32 v150, v150
v_mfma_f32_16x16x32_bf16 a[72:75], a[164:167], v[188:191], a[72:75]
v_exp_f32 v151, v151
v_mfma_f32_16x16x32_bf16 a[104:107], a[164:167], v[196:199], a[104:107]
v_exp_f32 v132, v132
v_mfma_f32_16x16x32_bf16 a[104:107], a[160:163], v[192:195], a[104:107]
ds_read_b128 a[204:207], v3 offset:31744
v_cvt_pk_bf16_f32 v205, v130, v131
v_mfma_f32_16x16x32_bf16 a[108:111], a[168:171], v[192:195], a[108:111]
v_exp_f32 v133, v133
v_mfma_f32_16x16x32_bf16 a[108:111], a[172:175], v[196:199], a[108:111]
v_exp_f32 v134, v134
v_mfma_f32_16x16x32_bf16 a[76:79], a[172:175], v[188:191], a[76:79]
v_exp_f32 v135, v135
v_mfma_f32_16x16x32_bf16 a[76:79], a[168:171], v[184:187], a[76:79]
v_exp_f32 v116, v116
v_mfma_f32_16x16x32_bf16 a[44:47], a[168:171], v[160:163], a[44:47]
v_exp_f32 v117, v117
v_mfma_f32_16x16x32_bf16 a[44:47], a[172:175], v[164:167], a[44:47]
v_exp_f32 v118, v118
v_mfma_f32_16x16x32_bf16 a[12:15], a[172:175], v[156:159], a[12:15]
v_exp_f32 v119, v119
v_mfma_f32_16x16x32_bf16 a[12:15], a[168:171], v[152:155], a[12:15]
v_cvt_pk_bf16_f32 v212, v144, v145
v_cvt_pk_bf16_f32 v213, v146, v147
v_mfma_f32_16x16x32_bf16 a[16:19], a[176:179], v[152:155], a[16:19]
v_cvt_pk_bf16_f32 v214, v148, v149
v_cvt_pk_bf16_f32 v215, v150, v151
v_mfma_f32_16x16x32_bf16 a[16:19], a[180:183], v[156:159], a[16:19]
s_waitcnt vmcnt(12)
s_barrier
v_mfma_f32_16x16x32_bf16 a[48:51], a[180:183], v[164:167], a[48:51]
s_xor_b32 s71, s71, 49152
ds_read_b128 a[144:147], v2 offset:0
v_cvt_pk_bf16_f32 v206, v132, v133
v_mfma_f32_16x16x32_bf16 a[48:51], a[176:179], v[160:163], a[48:51]
s_add_u32 s70, s70, 32768
ds_read_b128 a[148:151], v2 offset:1024
v_cvt_pk_bf16_f32 v207, v134, v135
v_mfma_f32_16x16x32_bf16 a[80:83], a[176:179], v[184:187], a[80:83]
s_mov_b32 m0, s71
ds_read_b128 a[152:155], v2 offset:2048
v_cvt_pk_bf16_f32 v182, v116, v117
v_mfma_f32_16x16x32_bf16 a[80:83], a[180:183], v[188:191], a[80:83]
buffer_load_dwordx4 v16, s[32:35], s70 offen offset:0 sc1 lds
v_mfma_f32_16x16x32_bf16 a[112:115], a[180:183], v[196:199], a[112:115]
ds_read_b128 a[156:159], v2 offset:3072
v_cvt_pk_bf16_f32 v183, v118, v119
v_mfma_f32_16x16x32_bf16 a[112:115], a[176:179], v[192:195], a[112:115]
ds_read_b128 a[160:163], v2 offset:4096
v_xor_b32 v3, 0x8000, v3
v_mfma_f32_16x16x32_bf16 a[116:119], a[184:187], v[192:195], a[116:119]
s_waitcnt lgkmcnt(4)
ds_read_b128 a[164:167], v2 offset:5120
v_accvgpr_read_b32 v20, a128
v_mfma_f32_16x16x32_bf16 a[116:119], a[188:191], v[196:199], a[116:119]
ds_read_b128 a[168:171], v2 offset:6144
v_accvgpr_read_b32 v248, a129
v_mfma_f32_16x16x32_bf16 a[84:87], a[188:191], v[188:191], a[84:87]
ds_read_b128 a[172:175], v2 offset:7168
v_add_f32 v20, v20, v248
v_mfma_f32_16x16x32_bf16 a[84:87], a[184:187], v[184:187], a[84:87]
v_max_f32 v1, v1, v20
v_mfma_f32_16x16x32_bf16 a[52:55], a[184:187], v[160:163], a[52:55]
v_rcp_f32 v20, v20
v_mfma_f32_16x16x32_bf16 a[52:55], a[188:191], v[164:167], a[52:55]
v_accvgpr_read_b32 v232, a0
v_accvgpr_read_b32 v233, a1
v_mfma_f32_16x16x32_bf16 a[20:23], a[188:191], v[156:159], a[20:23]
v_accvgpr_read_b32 v234, a2
v_accvgpr_read_b32 v235, a3
v_mfma_f32_16x16x32_bf16 a[20:23], a[184:187], v[152:155], a[20:23]
v_accvgpr_read_b32 v236, a4
v_accvgpr_read_b32 v237, a5
v_mfma_f32_16x16x32_bf16 a[24:27], a[192:195], v[152:155], a[24:27]
v_accvgpr_read_b32 v238, a6
v_accvgpr_read_b32 v239, a7
v_mfma_f32_16x16x32_bf16 a[24:27], a[196:199], v[156:159], a[24:27]
v_mul_f32 v20, v20, v4
v_mul_f32 v232, v232, v20
v_mfma_f32_16x16x32_bf16 a[56:59], a[196:199], v[164:167], a[56:59]
buffer_load_dwordx4 v16, s[32:35], s70 offen offset:1024 sc1 lds
v_mfma_f32_16x16x32_bf16 a[56:59], a[192:195], v[160:163], a[56:59]
v_mul_f32 v233, v233, v20
v_mul_f32 v234, v234, v20
v_mfma_f32_16x16x32_bf16 a[88:91], a[192:195], v[184:187], a[88:91]
v_mul_f32 v235, v235, v20
v_mul_f32 v236, v236, v20
v_mfma_f32_16x16x32_bf16 a[88:91], a[196:199], v[188:191], a[88:91]
v_mul_f32 v237, v237, v20
v_mul_f32 v238, v238, v20
v_mfma_f32_16x16x32_bf16 a[120:123], a[196:199], v[196:199], a[120:123]
v_mul_f32 v239, v239, v20
v_cvt_pk_bf16_f32 v232, v232, v233
v_mfma_f32_16x16x32_bf16 a[120:123], a[192:195], v[192:195], a[120:123]
v_cvt_pk_bf16_f32 v233, v234, v235
v_cvt_pk_bf16_f32 v234, v236, v237
v_mfma_f32_16x16x32_bf16 a[124:127], a[200:203], v[192:195], a[124:127]
v_cvt_pk_bf16_f32 v235, v238, v239
v_mfma_f32_16x16x32_bf16 a[124:127], a[204:207], v[196:199], a[124:127]
s_add_u32 s77, s74, 0
buffer_store_dwordx4 v[232:235], v16, s[44:47], s77 offen sc1
v_mfma_f32_16x16x32_bf16 a[92:95], a[204:207], v[188:191], a[92:95]
v_accvgpr_read_b32 v240, a8
v_accvgpr_read_b32 v241, a9
v_mfma_f32_16x16x32_bf16 a[92:95], a[200:203], v[184:187], a[92:95]
v_accvgpr_read_b32 v242, a10
v_accvgpr_read_b32 v243, a11
v_mfma_f32_16x16x32_bf16 a[60:63], a[200:203], v[160:163], a[60:63]
v_accvgpr_read_b32 v244, a12
v_accvgpr_read_b32 v245, a13
v_mfma_f32_16x16x32_bf16 a[60:63], a[204:207], v[164:167], a[60:63]
v_accvgpr_read_b32 v246, a14
v_accvgpr_read_b32 v247, a15
v_mfma_f32_16x16x32_bf16 a[28:31], a[204:207], v[156:159], a[28:31]
v_mul_f32 v240, v240, v20
v_mul_f32 v241, v241, v20
v_mfma_f32_16x16x32_bf16 a[28:31], a[200:203], v[152:155], a[28:31]
v_mul_f32 v242, v242, v20
v_mul_f32 v243, v243, v20
v_mul_f32 v244, v244, v20
v_mul_f32 v245, v245, v20
v_mul_f32 v246, v246, v20
v_mul_f32 v247, v247, v20
v_cvt_pk_bf16_f32 v240, v240, v241
v_cvt_pk_bf16_f32 v241, v242, v243
v_cvt_pk_bf16_f32 v242, v244, v245
v_cvt_pk_bf16_f32 v243, v246, v247
s_add_u32 s77, s74, 8192
buffer_store_dwordx4 v[240:243], v16, s[44:47], s77 offen sc1
v_accvgpr_read_b32 v232, a16
v_accvgpr_read_b32 v233, a17
v_accvgpr_read_b32 v234, a18
v_accvgpr_read_b32 v235, a19
v_accvgpr_read_b32 v236, a20
v_accvgpr_read_b32 v237, a21
v_accvgpr_read_b32 v238, a22
v_accvgpr_read_b32 v239, a23
v_mul_f32 v232, v232, v20
v_mul_f32 v233, v233, v20
v_mul_f32 v234, v234, v20
v_mul_f32 v235, v235, v20
v_mul_f32 v236, v236, v20
v_mul_f32 v237, v237, v20
v_mul_f32 v238, v238, v20
v_mul_f32 v239, v239, v20
v_cvt_pk_bf16_f32 v232, v232, v233
v_cvt_pk_bf16_f32 v233, v234, v235
v_cvt_pk_bf16_f32 v234, v236, v237
v_cvt_pk_bf16_f32 v235, v238, v239
s_add_u32 s77, s74, 16384
buffer_store_dwordx4 v[232:235], v16, s[44:47], s77 offen sc1
s_cmp_eq_u32 s3, 7
s_cbranch_scc1 L_T1
L_T:
s_waitcnt lgkmcnt(7)
v_mfma_f32_16x16x32_bf16 v[120:123], a[144:147], v[56:59], v[224:227]
s_waitcnt lgkmcnt(6)
ds_read_b128 a[176:179], v2 offset:8192
v_mfma_f32_16x16x32_bf16 v[120:123], a[148:151], v[60:63], v[120:123]
s_waitcnt lgkmcnt(6)
ds_read_b128 a[180:183], v2 offset:9216
v_mfma_f32_16x16x32_bf16 v[120:123], a[152:155], v[64:67], v[120:123]
s_waitcnt lgkmcnt(6)
buffer_load_dwordx4 v16, s[32:35], s70 offen offset:2048 sc1 lds
v_mfma_f32_16x16x32_bf16 v[120:123], a[156:159], v[68:71], v[120:123]
ds_read_b128 a[184:187], v2 offset:10240
v_mfma_f32_16x16x32_bf16 v[136:139], a[156:159], v[84:87], v[228:231]
ds_read_b128 a[188:191], v2 offset:11264
v_mfma_f32_16x16x32_bf16 v[136:139], a[152:155], v[80:83], v[136:139]
ds_read_b128 a[192:195], v2 offset:12288
v_mfma_f32_16x16x32_bf16 v[136:139], a[148:151], v[76:79], v[136:139]
ds_read_b128 a[196:199], v2 offset:13312
v_mfma_f32_16x16x32_bf16 v[136:139], a[144:147], v[72:75], v[136:139]
s_waitcnt lgkmcnt(4)
v_mfma_f32_16x16x32_bf16 v[140:143], a[160:163], v[72:75], v[228:231]
ds_read_b128 a[200:203], v2 offset:14336
v_accvgpr_read_b32 v240, a24
v_mfma_f32_16x16x32_bf16 v[140:143], a[164:167], v[76:79], v[140:143]
ds_read_b128 a[204:207], v2 offset:15360
v_accvgpr_read_b32 v241, a25
v_mfma_f32_16x16x32_bf16 v[140:143], a[168:171], v[80:83], v[140:143]
v_exp_f32 v120, v120
v_mfma_f32_16x16x32_bf16 v[140:143], a[172:175], v[84:87], v[140:143]
v_exp_f32 v121, v121
v_mfma_f32_16x16x32_bf16 v[124:127], a[172:175], v[68:71], v[224:227]
v_exp_f32 v122, v122
v_mfma_f32_16x16x32_bf16 v[124:127], a[168:171], v[64:67], v[124:127]
buffer_load_dwordx4 v16, s[32:35], s70 offen offset:3072 sc1 lds
v_mfma_f32_16x16x32_bf16 v[124:127], a[164:167], v[60:63], v[124:127]
v_exp_f32 v123, v123
v_mfma_f32_16x16x32_bf16 v[124:127], a[160:163], v[56:59], v[124:127]
v_exp_f32 v136, v136
v_mfma_f32_16x16x32_bf16 v[128:131], a[176:179], v[56:59], v[224:227]
v_exp_f32 v137, v137
v_mfma_f32_16x16x32_bf16 v[128:131], a[180:183], v[60:63], v[128:131]
s_waitcnt lgkmcnt(0)
v_exp_f32 v138, v138
v_mfma_f32_16x16x32_bf16 v[128:131], a[184:187], v[64:67], v[128:131]
v_exp_f32 v139, v139
v_mfma_f32_16x16x32_bf16 v[128:131], a[188:191], v[68:71], v[128:131]
s_add_u32 m0, s71, 4096
ds_read_b128 a[144:147], v3 offset:0
v_cvt_pk_bf16_f32 v184, v120, v121
v_mfma_f32_16x16x32_bf16 v[144:147], a[188:191], v[84:87], v[228:231]
s_add_u32 s64, s70, 4096
ds_read_b128 a[148:151], v3 offset:8192
v_cvt_pk_bf16_f32 v185, v122, v123
v_mfma_f32_16x16x32_bf16 v[144:147], a[184:187], v[80:83], v[144:147]
buffer_load_dwordx4 v16, s[32:35], s64 offen offset:0 sc1 lds
v_mfma_f32_16x16x32_bf16 v[144:147], a[180:183], v[76:79], v[144:147]
v_exp_f32 v140, v140
v_mfma_f32_16x16x32_bf16 v[144:147], a[176:179], v[72:75], v[144:147]
v_exp_f32 v141, v141
v_mfma_f32_16x16x32_bf16 v[148:151], a[192:195], v[72:75], v[228:231]
v_exp_f32 v142, v142
v_mfma_f32_16x16x32_bf16 v[148:151], a[196:199], v[76:79], v[148:151]
ds_read_b128 a[152:155], v3 offset:1024
v_cvt_pk_bf16_f32 v192, v136, v137
v_mfma_f32_16x16x32_bf16 v[148:151], a[200:203], v[80:83], v[148:151]
ds_read_b128 a[156:159], v3 offset:9216
v_cvt_pk_bf16_f32 v193, v138, v139
v_mfma_f32_16x16x32_bf16 v[148:151], a[204:207], v[84:87], v[148:151]
v_exp_f32 v143, v143
v_mfma_f32_16x16x32_bf16 v[132:135], a[204:207], v[68:71], v[224:227]
v_exp_f32 v124, v124
v_mfma_f32_16x16x32_bf16 v[132:135], a[200:203], v[64:67], v[132:135]
v_exp_f32 v125, v125
v_mfma_f32_16x16x32_bf16 v[132:135], a[196:199], v[60:63], v[132:135]
buffer_load_dwordx4 v16, s[32:35], s64 offen offset:1024 sc1 lds
v_mfma_f32_16x16x32_bf16 v[132:135], a[192:195], v[56:59], v[132:135]
ds_read_b128 a[160:163], v3 offset:2048
v_cvt_pk_bf16_f32 v194, v140, v141
v_smfmac_f32_16x16x64_bf16 a[132:135], a[240:243], v[176:183], v5
ds_read_b128 a[164:167], v3 offset:10240
v_smfmac_f32_16x16x64_bf16 a[136:139], a[240:243], v[200:207], v5
ds_read_b128 a[168:171], v3 offset:3072
v_accvgpr_read_b32 v242, a26
v_smfmac_f32_16x16x64_bf16 a[140:143], a[240:243], v[208:215], v5
s_waitcnt lgkmcnt(3)
ds_read_b128 a[172:175], v3 offset:11264
v_accvgpr_read_b32 v243, a27
v_mfma_f32_16x16x32_bf16 a[32:35], a[144:147], v[176:179], a[32:35]
ds_read_b128 a[176:179], v3 offset:4096
v_accvgpr_read_b32 v244, a28
v_mfma_f32_16x16x32_bf16 a[32:35], a[148:151], v[180:183], a[32:35]
ds_read_b128 a[180:183], v3 offset:12288
v_accvgpr_read_b32 v245, a29
v_mfma_f32_16x16x32_bf16 a[64:67], a[148:151], v[204:207], a[64:67]
ds_read_b128 a[184:187], v3 offset:5120
v_accvgpr_read_b32 v246, a30
v_mfma_f32_16x16x32_bf16 a[64:67], a[144:147], v[200:203], a[64:67]
ds_read_b128 a[188:191], v3 offset:13312
v_accvgpr_read_b32 v247, a31
v_mfma_f32_16x16x32_bf16 a[96:99], a[144:147], v[208:211], a[96:99]
ds_read_b128 a[192:195], v3 offset:6144
v_mul_f32 v240, v240, v20
v_mfma_f32_16x16x32_bf16 a[96:99], a[148:151], v[212:215], a[96:99]
ds_read_b128 a[196:199], v3 offset:14336
v_mul_f32 v241, v241, v20
v_mfma_f32_16x16x32_bf16 a[100:103], a[156:159], v[212:215], a[100:103]
ds_read_b128 a[200:203], v3 offset:7168
v_mul_f32 v242, v242, v20
v_mfma_f32_16x16x32_bf16 a[100:103], a[152:155], v[208:211], a[100:103]
ds_read_b128 a[204:207], v3 offset:15360
v_mul_f32 v243, v243, v20
v_mul_f32 v244, v244, v20
v_mul_f32 v245, v245, v20
v_mul_f32 v246, v246, v20
v_mul_f32 v247, v247, v20
v_cvt_pk_bf16_f32 v240, v240, v241
v_cvt_pk_bf16_f32 v241, v242, v243
v_cvt_pk_bf16_f32 v242, v244, v245
v_cvt_pk_bf16_f32 v243, v246, v247
s_add_u32 s77, s74, 24576
buffer_store_dwordx4 v[240:243], v16, s[44:47], s77 offen sc1
v_exp_f32 v126, v126
v_mfma_f32_16x16x32_bf16 a[68:71], a[152:155], v[200:203], a[68:71]
buffer_load_dwordx4 v16, s[32:35], s64 offen offset:2048 sc1 lds
v_cvt_pk_bf16_f32 v195, v142, v143
v_mfma_f32_16x16x32_bf16 a[68:71], a[156:159], v[204:207], a[68:71]
v_exp_f32 v127, v127
v_mfma_f32_16x16x32_bf16 a[36:39], a[156:159], v[180:183], a[36:39]
v_exp_f32 v128, v128
v_mfma_f32_16x16x32_bf16 a[36:39], a[152:155], v[176:179], a[36:39]
s_waitcnt lgkmcnt(2)
v_exp_f32 v129, v129
v_mfma_f32_16x16x32_bf16 a[40:43], a[160:163], v[176:179], a[40:43]
v_cvt_pk_bf16_f32 v186, v124, v125
v_cvt_pk_bf16_f32 v187, v126, v127
v_mfma_f32_16x16x32_bf16 a[40:43], a[164:167], v[180:183], a[40:43]
v_exp_f32 v130, v130
v_mfma_f32_16x16x32_bf16 a[72:75], a[164:167], v[204:207], a[72:75]
buffer_load_dwordx4 v16, s[32:35], s64 offen offset:3072 sc1 lds
v_mfma_f32_16x16x32_bf16 a[72:75], a[160:163], v[200:203], a[72:75]
v_exp_f32 v131, v131
v_mfma_f32_16x16x32_bf16 a[104:107], a[160:163], v[208:211], a[104:107]
v_exp_f32 v144, v144
v_mfma_f32_16x16x32_bf16 a[104:107], a[164:167], v[212:215], a[104:107]
v_exp_f32 v145, v145
v_mfma_f32_16x16x32_bf16 a[108:111], a[172:175], v[212:215], a[108:111]
v_exp_f32 v146, v146
v_mfma_f32_16x16x32_bf16 a[108:111], a[168:171], v[208:211], a[108:111]
v_exp_f32 v147, v147
v_mfma_f32_16x16x32_bf16 a[76:79], a[168:171], v[200:203], a[76:79]
v_exp_f32 v148, v148
v_mfma_f32_16x16x32_bf16 a[76:79], a[172:175], v[204:207], a[76:79]
v_exp_f32 v149, v149
v_mfma_f32_16x16x32_bf16 a[44:47], a[172:175], v[180:183], a[44:47]
v_cvt_pk_bf16_f32 v188, v128, v129
v_cvt_pk_bf16_f32 v189, v130, v131
v_mfma_f32_16x16x32_bf16 a[44:47], a[168:171], v[176:179], a[44:47]
v_exp_f32 v150, v150
v_mfma_f32_16x16x32_bf16 a[48:51], a[176:179], v[176:179], a[48:51]
v_exp_f32 v151, v151
v_mfma_f32_16x16x32_bf16 a[48:51], a[180:183], v[180:183], a[48:51]
v_exp_f32 v132, v132
v_mfma_f32_16x16x32_bf16 a[80:83], a[180:183], v[204:207], a[80:83]
s_waitcnt vmcnt(9)
s_barrier
v_mfma_f32_16x16x32_bf16 a[80:83], a[176:179], v[200:203], a[80:83]
s_xor_b32 s71, s71, 16384
v_exp_f32 v133, v133
v_mfma_f32_16x16x32_bf16 a[112:115], a[176:179], v[208:211], a[112:115]
s_add_u32 s70, s70, 32768
ds_read_b128 a[144:147], v2 offset:16384
v_cvt_pk_bf16_f32 v196, v144, v145
v_mfma_f32_16x16x32_bf16 a[112:115], a[180:183], v[212:215], a[112:115]
s_mov_b32 m0, s71
v_exp_f32 v134, v134
v_mfma_f32_16x16x32_bf16 a[116:119], a[188:191], v[212:215], a[116:119]
buffer_load_dwordx4 v16, s[32:35], s70 offen offset:0 sc1 lds
v_mfma_f32_16x16x32_bf16 a[116:119], a[184:187], v[208:211], a[116:119]
ds_read_b128 a[148:151], v2 offset:17408
v_cvt_pk_bf16_f32 v197, v146, v147
v_mfma_f32_16x16x32_bf16 a[84:87], a[184:187], v[200:203], a[84:87]
ds_read_b128 a[152:155], v2 offset:18432
v_cvt_pk_bf16_f32 v198, v148, v149
v_mfma_f32_16x16x32_bf16 a[84:87], a[188:191], v[204:207], a[84:87]
ds_read_b128 a[156:159], v2 offset:19456
v_cvt_pk_bf16_f32 v199, v150, v151
v_mfma_f32_16x16x32_bf16 a[52:55], a[188:191], v[180:183], a[52:55]
v_exp_f32 v135, v135
v_mfma_f32_16x16x32_bf16 a[52:55], a[184:187], v[176:179], a[52:55]
ds_read_b128 a[160:163], v2 offset:20480
v_cvt_pk_bf16_f32 v190, v132, v133
v_mfma_f32_16x16x32_bf16 a[56:59], a[192:195], v[176:179], a[56:59]
ds_read_b128 a[164:167], v2 offset:21504
v_cvt_pk_bf16_f32 v191, v134, v135
v_mfma_f32_16x16x32_bf16 a[56:59], a[196:199], v[180:183], a[56:59]
ds_read_b128 a[168:171], v2 offset:22528
v_accvgpr_read_b32 v21, a132
v_mfma_f32_16x16x32_bf16 a[88:91], a[196:199], v[204:207], a[88:91]
ds_read_b128 a[172:175], v2 offset:23552
v_accvgpr_read_b32 v248, a133
v_mfma_f32_16x16x32_bf16 a[88:91], a[192:195], v[200:203], a[88:91]
buffer_load_dwordx4 v16, s[32:35], s70 offen offset:1024 sc1 lds
v_mfma_f32_16x16x32_bf16 a[120:123], a[192:195], v[208:211], a[120:123]
v_add_f32 v21, v21, v248
v_max_f32 v1, v1, v21
v_mfma_f32_16x16x32_bf16 a[120:123], a[196:199], v[212:215], a[120:123]
s_waitcnt lgkmcnt(3)
v_rcp_f32 v21, v21
v_mfma_f32_16x16x32_bf16 a[124:127], a[204:207], v[212:215], a[124:127]
v_accvgpr_read_b32 v232, a32
v_accvgpr_read_b32 v233, a33
v_mfma_f32_16x16x32_bf16 a[124:127], a[200:203], v[208:211], a[124:127]
v_accvgpr_read_b32 v234, a34
v_accvgpr_read_b32 v235, a35
v_mfma_f32_16x16x32_bf16 a[92:95], a[200:203], v[200:203], a[92:95]
v_accvgpr_read_b32 v236, a36
v_accvgpr_read_b32 v237, a37
v_mfma_f32_16x16x32_bf16 a[92:95], a[204:207], v[204:207], a[92:95]
v_accvgpr_read_b32 v238, a38
v_accvgpr_read_b32 v239, a39
v_mfma_f32_16x16x32_bf16 a[60:63], a[204:207], v[180:183], a[60:63]
v_mul_f32 v21, v21, v6
v_mul_f32 v232, v232, v21
v_mfma_f32_16x16x32_bf16 a[60:63], a[200:203], v[176:179], a[60:63]
v_mul_f32 v233, v233, v21
v_mul_f32 v234, v234, v21
v_mfma_f32_16x16x32_bf16 v[120:123], a[144:147], v[56:59], v[224:227]
ds_read_b128 a[176:179], v2 offset:24576
ds_read_b128 a[180:183], v2 offset:25600
v_mfma_f32_16x16x32_bf16 v[120:123], a[148:151], v[60:63], v[120:123]
buffer_load_dwordx4 v16, s[32:35], s70 offen offset:2048 sc1 lds
v_mfma_f32_16x16x32_bf16 v[120:123], a[152:155], v[64:67], v[120:123]
s_add_u32 s64, s70, 4096
ds_read_b128 a[184:187], v2 offset:26624
ds_read_b128 a[188:191], v2 offset:27648
v_mfma_f32_16x16x32_bf16 v[120:123], a[156:159], v[68:71], v[120:123]
buffer_load_dwordx4 v16, s[32:35], s70 offen offset:3072 sc1 lds
v_mfma_f32_16x16x32_bf16 v[136:139], a[156:159], v[84:87], v[228:231]
s_add_u32 m0, s71, 4096
ds_read_b128 a[192:195], v2 offset:28672
ds_read_b128 a[196:199], v2 offset:29696
v_mfma_f32_16x16x32_bf16 v[136:139], a[152:155], v[80:83], v[136:139]
buffer_load_dwordx4 v16, s[32:35], s64 offen offset:0 sc1 lds
v_mfma_f32_16x16x32_bf16 v[136:139], a[148:151], v[76:79], v[136:139]
ds_read_b128 a[200:203], v2 offset:30720
ds_read_b128 a[204:207], v2 offset:31744
v_mfma_f32_16x16x32_bf16 v[136:139], a[144:147], v[72:75], v[136:139]
v_exp_f32 v120, v120
v_mfma_f32_16x16x32_bf16 v[140:143], a[160:163], v[72:75], v[228:231]
s_waitcnt lgkmcnt(4)
v_exp_f32 v121, v121
v_mfma_f32_16x16x32_bf16 v[140:143], a[164:167], v[76:79], v[140:143]
v_exp_f32 v122, v122
v_mfma_f32_16x16x32_bf16 v[140:143], a[168:171], v[80:83], v[140:143]
v_mul_f32 v235, v235, v21
v_mul_f32 v236, v236, v21
v_mul_f32 v237, v237, v21
v_mul_f32 v238, v238, v21
v_mul_f32 v239, v239, v21
v_cvt_pk_bf16_f32 v232, v232, v233
v_cvt_pk_bf16_f32 v233, v234, v235
v_cvt_pk_bf16_f32 v234, v236, v237
v_cvt_pk_bf16_f32 v235, v238, v239
s_add_u32 s77, s74, 4096
buffer_store_dwordx4 v[232:235], v16, s[44:47], s77 offen sc1
v_accvgpr_read_b32 v240, a40
v_accvgpr_read_b32 v241, a41
v_accvgpr_read_b32 v242, a42
v_accvgpr_read_b32 v243, a43
v_accvgpr_read_b32 v244, a44
v_accvgpr_read_b32 v245, a45
v_accvgpr_read_b32 v246, a46
v_accvgpr_read_b32 v247, a47
v_mul_f32 v240, v240, v21
v_mul_f32 v241, v241, v21
v_mul_f32 v242, v242, v21
v_mul_f32 v243, v243, v21
v_mul_f32 v244, v244, v21
v_mul_f32 v245, v245, v21
v_mul_f32 v246, v246, v21
v_mul_f32 v247, v247, v21
v_cvt_pk_bf16_f32 v240, v240, v241
v_cvt_pk_bf16_f32 v241, v242, v243
v_cvt_pk_bf16_f32 v242, v244, v245
v_cvt_pk_bf16_f32 v243, v246, v247
s_add_u32 s77, s74, 12288
buffer_store_dwordx4 v[240:243], v16, s[44:47], s77 offen sc1
v_accvgpr_read_b32 v232, a48
v_accvgpr_read_b32 v233, a49
v_accvgpr_read_b32 v234, a50
v_accvgpr_read_b32 v235, a51
v_accvgpr_read_b32 v236, a52
v_accvgpr_read_b32 v237, a53
v_accvgpr_read_b32 v238, a54
v_accvgpr_read_b32 v239, a55
v_mul_f32 v232, v232, v21
v_mul_f32 v233, v233, v21
v_mul_f32 v234, v234, v21
v_mul_f32 v235, v235, v21
v_mul_f32 v236, v236, v21
v_mul_f32 v237, v237, v21
v_mul_f32 v238, v238, v21
v_mul_f32 v239, v239, v21
v_cvt_pk_bf16_f32 v232, v232, v233
v_cvt_pk_bf16_f32 v233, v234, v235
v_cvt_pk_bf16_f32 v234, v236, v237
v_cvt_pk_bf16_f32 v235, v238, v239
s_add_u32 s77, s74, 20480
buffer_store_dwordx4 v[232:235], v16, s[44:47], s77 offen sc1
v_accvgpr_read_b32 v240, a56
v_accvgpr_read_b32 v241, a57
v_accvgpr_read_b32 v242, a58
v_accvgpr_read_b32 v243, a59
v_accvgpr_read_b32 v244, a60
v_accvgpr_read_b32 v245, a61
v_accvgpr_read_b32 v246, a62
v_accvgpr_read_b32 v247, a63
v_mul_f32 v240, v240, v21
v_mul_f32 v241, v241, v21
v_mul_f32 v242, v242, v21
v_mul_f32 v243, v243, v21
v_mul_f32 v244, v244, v21
v_mul_f32 v245, v245, v21
v_mul_f32 v246, v246, v21
v_mul_f32 v247, v247, v21
v_cvt_pk_bf16_f32 v240, v240, v241
v_cvt_pk_bf16_f32 v241, v242, v243
v_cvt_pk_bf16_f32 v242, v244, v245
v_cvt_pk_bf16_f32 v243, v246, v247
s_add_u32 s77, s74, 28672
buffer_store_dwordx4 v[240:243], v16, s[44:47], s77 offen sc1
v_exp_f32 v123, v123
v_mfma_f32_16x16x32_bf16 v[140:143], a[172:175], v[84:87], v[140:143]
v_exp_f32 v136, v136
v_mfma_f32_16x16x32_bf16 v[124:127], a[172:175], v[68:71], v[224:227]
ds_read_b128 a[144:147], v3 offset:16384
v_cvt_pk_bf16_f32 v200, v120, v121
v_mfma_f32_16x16x32_bf16 v[124:127], a[168:171], v[64:67], v[124:127]
s_branch L_po18
L_pg18:
s_branch L_pg22
L_po18:
v_exp_f32 v137, v137
v_mfma_f32_16x16x32_bf16 v[124:127], a[164:167], v[60:63], v[124:127]
ds_read_b128 a[148:151], v3 offset:24576
v_cvt_pk_bf16_f32 v201, v122, v123
v_mfma_f32_16x16x32_bf16 v[124:127], a[160:163], v[56:59], v[124:127]
v_exp_f32 v138, v138
v_mfma_f32_16x16x32_bf16 v[128:131], a[176:179], v[56:59], v[224:227]
ds_read_b128 a[152:155], v3 offset:17408
v_cvt_pk_bf16_f32 v208, v136, v137
v_mfma_f32_16x16x32_bf16 v[128:131], a[180:183], v[60:63], v[128:131]
v_exp_f32 v139, v139
v_mfma_f32_16x16x32_bf16 v[128:131], a[184:187], v[64:67], v[128:131]
ds_read_b128 a[156:159], v3 offset:25600
v_cvt_pk_bf16_f32 v209, v138, v139
v_mfma_f32_16x16x32_bf16 v[128:131], a[188:191], v[68:71], v[128:131]
v_exp_f32 v140, v140
v_mfma_f32_16x16x32_bf16 v[144:147], a[188:191], v[84:87], v[228:231]
buffer_load_dwordx4 v16, s[32:35], s64 offen offset:1024 sc1 lds
v_mfma_f32_16x16x32_bf16 v[144:147], a[184:187], v[80:83], v[144:147]
v_exp_f32 v141, v141
v_mfma_f32_16x16x32_bf16 v[144:147], a[180:183], v[76:79], v[144:147]
ds_read_b128 a[160:163], v3 offset:18432
v_cvt_pk_bf16_f32 v210, v140, v141
v_mfma_f32_16x16x32_bf16 v[144:147], a[176:179], v[72:75], v[144:147]
s_waitcnt lgkmcnt(2)
v_exp_f32 v142, v142
v_mfma_f32_16x16x32_bf16 v[148:151], a[192:195], v[72:75], v[228:231]
ds_read_b128 a[164:167], v3 offset:26624
ds_read_b128 a[168:171], v3 offset:19456
v_mfma_f32_16x16x32_bf16 v[148:151], a[196:199], v[76:79], v[148:151]
v_exp_f32 v143, v143
v_mfma_f32_16x16x32_bf16 v[148:151], a[200:203], v[80:83], v[148:151]
ds_read_b128 a[172:175], v3 offset:27648
v_cvt_pk_bf16_f32 v211, v142, v143
v_mfma_f32_16x16x32_bf16 v[148:151], a[204:207], v[84:87], v[148:151]
v_exp_f32 v124, v124
v_mfma_f32_16x16x32_bf16 v[132:135], a[204:207], v[68:71], v[224:227]
ds_read_b128 a[176:179], v3 offset:20480
buffer_load_dwordx4 v16, s[32:35], s64 offen offset:2048 sc1 lds
v_mfma_f32_16x16x32_bf16 v[132:135], a[200:203], v[64:67], v[132:135]
v_exp_f32 v125, v125
v_mfma_f32_16x16x32_bf16 v[132:135], a[196:199], v[60:63], v[132:135]
ds_read_b128 a[180:183], v3 offset:28672
v_cvt_pk_bf16_f32 v202, v124, v125
v_mfma_f32_16x16x32_bf16 v[132:135], a[192:195], v[56:59], v[132:135]
v_exp_f32 v126, v126
v_smfmac_f32_16x16x64_bf16 a[136:139], a[240:243], v[184:191], v5
ds_read_b128 a[184:187], v3 offset:21504
v_smfmac_f32_16x16x64_bf16 a[140:143], a[240:243], v[192:199], v5
ds_read_b128 a[188:191], v3 offset:29696
v_mfma_f32_16x16x32_bf16 a[64:67], a[144:147], v[184:187], a[64:67]
v_exp_f32 v127, v127
v_mfma_f32_16x16x32_bf16 a[64:67], a[148:151], v[188:191], a[64:67]
v_exp_f32 v128, v128
v_mfma_f32_16x16x32_bf16 a[96:99], a[148:151], v[196:199], a[96:99]
v_exp_f32 v129, v129
v_mfma_f32_16x16x32_bf16 a[96:99], a[144:147], v[192:195], a[96:99]
ds_read_b128 a[192:195], v3 offset:22528
v_cvt_pk_bf16_f32 v203, v126, v127
v_mfma_f32_16x16x32_bf16 a[100:103], a[152:155], v[192:195], a[100:103]
s_waitcnt lgkmcnt(2)
v_exp_f32 v130, v130
v_mfma_f32_16x16x32_bf16 a[100:103], a[156:159], v[196:199], a[100:103]
ds_read_b128 a[196:199], v3 offset:30720
v_cvt_pk_bf16_f32 v204, v128, v129
v_mfma_f32_16x16x32_bf16 a[68:71], a[156:159], v[188:191], a[68:71]
v_exp_f32 v131, v131
v_mfma_f32_16x16x32_bf16 a[68:71], a[152:155], v[184:187], a[68:71]
ds_read_b128 a[200:203], v3 offset:23552
v_cvt_pk_bf16_f32 v205, v130, v131
v_mfma_f32_16x16x32_bf16 a[72:75], a[160:163], v[184:187], a[72:75]
v_exp_f32 v144, v144
v_mfma_f32_16x16x32_bf16 a[72:75], a[164:167], v[188:191], a[72:75]
buffer_load_dwordx4 v16, s[32:35], s64 offen offset:3072 sc1 lds
v_mfma_f32_16x16x32_bf16 a[104:107], a[164:167], v[196:199], a[104:107]
s_xor_b32 s71, s71, 49152
v_exp_f32 v145, v145
v_mfma_f32_16x16x32_bf16 a[104:107], a[160:163], v[192:195], a[104:107]
ds_read_b128 a[204:207], v3 offset:31744
v_cvt_pk_bf16_f32 v212, v144, v145
v_mfma_f32_16x16x32_bf16 a[108:111], a[168:171], v[192:195], a[108:111]
s_add_u32 s70, s70, 32768
v_xor_b32 v2, 0x8000, v2
v_exp_f32 v146, v146
v_mfma_f32_16x16x32_bf16 a[108:111], a[172:175], v[196:199], a[108:111]
s_waitcnt vmcnt(12)
s_barrier
v_mfma_f32_16x16x32_bf16 a[76:79], a[172:175], v[188:191], a[76:79]
s_mov_b32 m0, s71
v_exp_f32 v147, v147
v_mfma_f32_16x16x32_bf16 a[76:79], a[168:171], v[184:187], a[76:79]
ds_read_b128 a[144:147], v2 offset:0
v_cvt_pk_bf16_f32 v213, v146, v147
v_mfma_f32_16x16x32_bf16 a[80:83], a[176:179], v[184:187], a[80:83]
v_exp_f32 v148, v148
v_mfma_f32_16x16x32_bf16 a[80:83], a[180:183], v[188:191], a[80:83]
ds_read_b128 a[148:151], v2 offset:1024
ds_read_b128 a[152:155], v2 offset:2048
v_mfma_f32_16x16x32_bf16 a[112:115], a[180:183], v[196:199], a[112:115]
v_exp_f32 v149, v149
v_mfma_f32_16x16x32_bf16 a[112:115], a[176:179], v[192:195], a[112:115]
ds_read_b128 a[156:159], v2 offset:3072
v_cvt_pk_bf16_f32 v214, v148, v149
v_mfma_f32_16x16x32_bf16 a[116:119], a[184:187], v[192:195], a[116:119]
s_waitcnt lgkmcnt(4)
v_exp_f32 v150, v150
v_mfma_f32_16x16x32_bf16 a[116:119], a[188:191], v[196:199], a[116:119]
buffer_load_dwordx4 v16, s[32:35], s70 offen offset:0 sc1 lds
v_mfma_f32_16x16x32_bf16 a[84:87], a[188:191], v[188:191], a[84:87]
v_exp_f32 v151, v151
v_mfma_f32_16x16x32_bf16 a[84:87], a[184:187], v[184:187], a[84:87]
ds_read_b128 a[160:163], v2 offset:4096
v_cvt_pk_bf16_f32 v215, v150, v151
v_mfma_f32_16x16x32_bf16 a[88:91], a[192:195], v[184:187], a[88:91]
v_exp_f32 v132, v132
v_mfma_f32_16x16x32_bf16 a[88:91], a[196:199], v[188:191], a[88:91]
ds_read_b128 a[164:167], v2 offset:5120
v_xor_b32 v3, 0x8000, v3
v_mfma_f32_16x16x32_bf16 a[120:123], a[196:199], v[196:199], a[120:123]
v_exp_f32 v133, v133
v_mfma_f32_16x16x32_bf16 a[120:123], a[192:195], v[192:195], a[120:123]
ds_read_b128 a[168:171], v2 offset:6144
v_cvt_pk_bf16_f32 v206, v132, v133
v_mfma_f32_16x16x32_bf16 a[124:127], a[200:203], v[192:195], a[124:127]
v_exp_f32 v134, v134
v_mfma_f32_16x16x32_bf16 a[124:127], a[204:207], v[196:199], a[124:127]
buffer_load_dwordx4 v16, s[32:35], s70 offen offset:1024 sc1 lds
v_mfma_f32_16x16x32_bf16 a[92:95], a[204:207], v[188:191], a[92:95]
v_exp_f32 v135, v135
v_mfma_f32_16x16x32_bf16 a[92:95], a[200:203], v[184:187], a[92:95]
ds_read_b128 a[172:175], v2 offset:7168
v_cvt_pk_bf16_f32 v207, v134, v135
s_lshl_b32 s72, s3, 1
s_sub_u32 s72, 13, s72
L_S:
s_waitcnt lgkmcnt(7)
v_mfma_f32_16x16x32_bf16 v[120:123], a[144:147], v[56:59], v[224:227]
s_waitcnt lgkmcnt(6)
ds_read_b128 a[176:179], v2 offset:8192
ds_read_b128 a[180:183], v2 offset:9216
v_mfma_f32_16x16x32_bf16 v[120:123], a[148:151], v[60:63], v[120:123]
s_waitcnt lgkmcnt(7)
buffer_load_dwordx4 v16, s[32:35], s70 offen offset:2048 sc1 lds
v_mfma_f32_16x16x32_bf16 v[120:123], a[152:155], v[64:67], v[120:123]
s_waitcnt lgkmcnt(6)
s_add_u32 s64, s70, 4096
ds_read_b128 a[184:187], v2 offset:10240
ds_read_b128 a[188:191], v2 offset:11264
v_mfma_f32_16x16x32_bf16 v[120:123], a[156:159], v[68:71], v[120:123]
buffer_load_dwordx4 v16, s[32:35], s70 offen offset:3072 sc1 lds
v_mfma_f32_16x16x32_bf16 v[136:139], a[156:159], v[84:87], v[228:231]
s_add_u32 m0, s71, 4096
ds_read_b128 a[192:195], v2 offset:12288
ds_read_b128 a[196:199], v2 offset:13312
v_mfma_f32_16x16x32_bf16 v[136:139], a[152:155], v[80:83], v[136:139]
buffer_load_dwordx4 v16, s[32:35], s64 offen offset:0 sc1 lds
v_mfma_f32_16x16x32_bf16 v[136:139], a[148:151], v[76:79], v[136:139]
ds_read_b128 a[200:203], v2 offset:14336
ds_read_b128 a[204:207], v2 offset:15360
v_mfma_f32_16x16x32_bf16 v[136:139], a[144:147], v[72:75], v[136:139]
s_waitcnt lgkmcnt(6)
v_exp_f32 v120, v120
v_mfma_f32_16x16x32_bf16 v[140:143], a[160:163], v[72:75], v[228:231]
v_exp_f32 v121, v121
v_mfma_f32_16x16x32_bf16 v[140:143], a[164:167], v[76:79], v[140:143]
v_exp_f32 v122, v122
v_mfma_f32_16x16x32_bf16 v[140:143], a[168:171], v[80:83], v[140:143]
v_exp_f32 v123, v123
v_mfma_f32_16x16x32_bf16 v[140:143], a[172:175], v[84:87], v[140:143]
v_exp_f32 v136, v136
v_mfma_f32_16x16x32_bf16 v[124:127], a[172:175], v[68:71], v[224:227]
ds_read_b128 a[144:147], v3 offset:0
v_cvt_pk_bf16_f32 v184, v120, v121
v_mfma_f32_16x16x32_bf16 v[124:127], a[168:171], v[64:67], v[124:127]
v_exp_f32 v137, v137
v_mfma_f32_16x16x32_bf16 v[124:127], a[164:167], v[60:63], v[124:127]
ds_read_b128 a[148:151], v3 offset:8192
v_cvt_pk_bf16_f32 v185, v122, v123
v_mfma_f32_16x16x32_bf16 v[124:127], a[160:163], v[56:59], v[124:127]
v_exp_f32 v138, v138
v_mfma_f32_16x16x32_bf16 v[128:131], a[176:179], v[56:59], v[224:227]
ds_read_b128 a[152:155], v3 offset:1024
v_cvt_pk_bf16_f32 v192, v136, v137
v_mfma_f32_16x16x32_bf16 v[128:131], a[180:183], v[60:63], v[128:131]
s_waitcnt lgkmcnt(3)
v_exp_f32 v139, v139
v_mfma_f32_16x16x32_bf16 v[128:131], a[184:187], v[64:67], v[128:131]
ds_read_b128 a[156:159], v3 offset:9216
v_cvt_pk_bf16_f32 v193, v138, v139
v_mfma_f32_16x16x32_bf16 v[128:131], a[188:191], v[68:71], v[128:131]
v_exp_f32 v140, v140
v_mfma_f32_16x16x32_bf16 v[144:147], a[188:191], v[84:87], v[228:231]
buffer_load_dwordx4 v16, s[32:35], s64 offen offset:1024 sc1 lds
v_mfma_f32_16x16x32_bf16 v[144:147], a[184:187], v[80:83], v[144:147]
v_exp_f32 v141, v141
v_mfma_f32_16x16x32_bf16 v[144:147], a[180:183], v[76:79], v[144:147]
ds_read_b128 a[160:163], v3 offset:2048
v_cvt_pk_bf16_f32 v194, v140, v141
v_mfma_f32_16x16x32_bf16 v[144:147], a[176:179], v[72:75], v[144:147]
v_exp_f32 v142, v142
v_mfma_f32_16x16x32_bf16 v[148:151], a[192:195], v[72:75], v[228:231]
ds_read_b128 a[164:167], v3 offset:10240
ds_read_b128 a[168:171], v3 offset:3072
v_mfma_f32_16x16x32_bf16 v[148:151], a[196:199], v[76:79], v[148:151]
v_exp_f32 v143, v143
v_mfma_f32_16x16x32_bf16 v[148:151], a[200:203], v[80:83], v[148:151]
ds_read_b128 a[172:175], v3 offset:11264
v_cvt_pk_bf16_f32 v195, v142, v143
v_mfma_f32_16x16x32_bf16 v[148:151], a[204:207], v[84:87], v[148:151]
v_exp_f32 v124, v124
v_mfma_f32_16x16x32_bf16 v[132:135], a[204:207], v[68:71], v[224:227]
ds_read_b128 a[176:179], v3 offset:4096
buffer_load_dwordx4 v16, s[32:35], s64 offen offset:2048 sc1 lds
v_mfma_f32_16x16x32_bf16 v[132:135], a[200:203], v[64:67], v[132:135]
v_exp_f32 v125, v125
v_mfma_f32_16x16x32_bf16 v[132:135], a[196:199], v[60:63], v[132:135]
ds_read_b128 a[180:183], v3 offset:12288
v_cvt_pk_bf16_f32 v186, v124, v125
v_mfma_f32_16x16x32_bf16 v[132:135], a[192:195], v[56:59], v[132:135]
v_exp_f32 v126, v126
v_smfmac_f32_16x16x64_bf16 a[136:139], a[240:243], v[200:207], v5
ds_read_b128 a[184:187], v3 offset:5120
v_smfmac_f32_16x16x64_bf16 a[140:143], a[240:243], v[208:215], v5
s_waitcnt lgkmcnt(3)
ds_read_b128 a[188:191], v3 offset:13312
v_mfma_f32_16x16x32_bf16 a[64:67], a[144:147], v[200:203], a[64:67]
v_exp_f32 v127, v127
v_mfma_f32_16x16x32_bf16 a[64:67], a[148:151], v[204:207], a[64:67]
v_exp_f32 v128, v128
v_mfma_f32_16x16x32_bf16 a[96:99], a[148:151], v[212:215], a[96:99]
v_exp_f32 v129, v129
v_mfma_f32_16x16x32_bf16 a[96:99], a[144:147], v[208:211], a[96:99]
ds_read_b128 a[192:195], v3 offset:6144
v_cvt_pk_bf16_f32 v187, v126, v127
v_mfma_f32_16x16x32_bf16 a[100:103], a[152:155], v[208:211], a[100:103]
v_exp_f32 v130, v130
v_mfma_f32_16x16x32_bf16 a[100:103], a[156:159], v[212:215], a[100:103]
ds_read_b128 a[196:199], v3 offset:14336
v_cvt_pk_bf16_f32 v188, v128, v129
v_mfma_f32_16x16x32_bf16 a[68:71], a[156:159], v[204:207], a[68:71]
v_exp_f32 v131, v131
v_mfma_f32_16x16x32_bf16 a[68:71], a[152:155], v[200:203], a[68:71]
ds_read_b128 a[200:203], v3 offset:7168
v_cvt_pk_bf16_f32 v189, v130, v131
v_mfma_f32_16x16x32_bf16 a[72:75], a[160:163], v[200:203], a[72:75]
v_exp_f32 v144, v144
v_mfma_f32_16x16x32_bf16 a[72:75], a[164:167], v[204:207], a[72:75]
buffer_load_dwordx4 v16, s[32:35], s64 offen offset:3072 sc1 lds
v_mfma_f32_16x16x32_bf16 a[104:107], a[164:167], v[212:215], a[104:107]
s_xor_b32 s71, s71, 16384
v_exp_f32 v145, v145
v_mfma_f32_16x16x32_bf16 a[104:107], a[160:163], v[208:211], a[104:107]
ds_read_b128 a[204:207], v3 offset:15360
v_cvt_pk_bf16_f32 v196, v144, v145
v_mfma_f32_16x16x32_bf16 a[108:111], a[168:171], v[208:211], a[108:111]
s_add_u32 s70, s70, 32768
v_exp_f32 v146, v146
v_mfma_f32_16x16x32_bf16 a[108:111], a[172:175], v[212:215], a[108:111]
s_waitcnt vmcnt(8)
s_barrier
v_mfma_f32_16x16x32_bf16 a[76:79], a[172:175], v[204:207], a[76:79]
s_mov_b32 m0, s71
v_exp_f32 v147, v147
v_mfma_f32_16x16x32_bf16 a[76:79], a[168:171], v[200:203], a[76:79]
s_waitcnt lgkmcnt(1)
ds_read_b128 a[144:147], v2 offset:16384
v_cvt_pk_bf16_f32 v197, v146, v147
v_mfma_f32_16x16x32_bf16 a[80:83], a[176:179], v[200:203], a[80:83]
v_exp_f32 v148, v148
v_mfma_f32_16x16x32_bf16 a[80:83], a[180:183], v[204:207], a[80:83]
ds_read_b128 a[148:151], v2 offset:17408
ds_read_b128 a[152:155], v2 offset:18432
v_mfma_f32_16x16x32_bf16 a[112:115], a[180:183], v[212:215], a[112:115]
v_exp_f32 v149, v149
v_mfma_f32_16x16x32_bf16 a[112:115], a[176:179], v[208:211], a[112:115]
ds_read_b128 a[156:159], v2 offset:19456
v_cvt_pk_bf16_f32 v198, v148, v149
v_mfma_f32_16x16x32_bf16 a[116:119], a[184:187], v[208:211], a[116:119]
v_exp_f32 v150, v150
v_mfma_f32_16x16x32_bf16 a[116:119], a[188:191], v[212:215], a[116:119]
buffer_load_dwordx4 v16, s[32:35], s70 offen offset:0 sc1 lds
v_mfma_f32_16x16x32_bf16 a[84:87], a[188:191], v[204:207], a[84:87]
v_exp_f32 v151, v151
v_mfma_f32_16x16x32_bf16 a[84:87], a[184:187], v[200:203], a[84:87]
ds_read_b128 a[160:163], v2 offset:20480
v_cvt_pk_bf16_f32 v199, v150, v151
v_mfma_f32_16x16x32_bf16 a[88:91], a[192:195], v[200:203], a[88:91]
v_exp_f32 v132, v132
v_mfma_f32_16x16x32_bf16 a[88:91], a[196:199], v[204:207], a[88:91]
ds_read_b128 a[164:167], v2 offset:21504
v_mfma_f32_16x16x32_bf16 a[120:123], a[196:199], v[212:215], a[120:123]
v_exp_f32 v133, v133
v_mfma_f32_16x16x32_bf16 a[120:123], a[192:195], v[208:211], a[120:123]
ds_read_b128 a[168:171], v2 offset:22528
v_cvt_pk_bf16_f32 v190, v132, v133
v_mfma_f32_16x16x32_bf16 a[124:127], a[200:203], v[208:211], a[124:127]
s_waitcnt lgkmcnt(3)
v_exp_f32 v134, v134
v_mfma_f32_16x16x32_bf16 a[124:127], a[204:207], v[212:215], a[124:127]
buffer_load_dwordx4 v16, s[32:35], s70 offen offset:1024 sc1 lds
v_mfma_f32_16x16x32_bf16 a[92:95], a[204:207], v[204:207], a[92:95]
v_exp_f32 v135, v135
v_mfma_f32_16x16x32_bf16 a[92:95], a[200:203], v[200:203], a[92:95]
ds_read_b128 a[172:175], v2 offset:23552
v_cvt_pk_bf16_f32 v191, v134, v135
v_mfma_f32_16x16x32_bf16 v[120:123], a[144:147], v[56:59], v[224:227]
ds_read_b128 a[176:179], v2 offset:24576
ds_read_b128 a[180:183], v2 offset:25600
v_mfma_f32_16x16x32_bf16 v[120:123], a[148:151], v[60:63], v[120:123]
buffer_load_dwordx4 v16, s[32:35], s70 offen offset:2048 sc1 lds
v_mfma_f32_16x16x32_bf16 v[120:123], a[152:155], v[64:67], v[120:123]
s_add_u32 s64, s70, 4096
ds_read_b128 a[184:187], v2 offset:26624
ds_read_b128 a[188:191], v2 offset:27648
v_mfma_f32_16x16x32_bf16 v[120:123], a[156:159], v[68:71], v[120:123]
buffer_load_dwordx4 v16, s[32:35], s70 offen offset:3072 sc1 lds
v_mfma_f32_16x16x32_bf16 v[136:139], a[156:159], v[84:87], v[228:231]
s_add_u32 m0, s71, 4096
ds_read_b128 a[192:195], v2 offset:28672
ds_read_b128 a[196:199], v2 offset:29696
v_mfma_f32_16x16x32_bf16 v[136:139], a[152:155], v[80:83], v[136:139]
buffer_load_dwordx4 v16, s[32:35], s64 offen offset:0 sc1 lds
v_mfma_f32_16x16x32_bf16 v[136:139], a[148:151], v[76:79], v[136:139]
ds_read_b128 a[200:203], v2 offset:30720
ds_read_b128 a[204:207], v2 offset:31744
v_mfma_f32_16x16x32_bf16 v[136:139], a[144:147], v[72:75], v[136:139]
s_waitcnt lgkmcnt(6)
v_exp_f32 v120, v120
v_mfma_f32_16x16x32_bf16 v[140:143], a[160:163], v[72:75], v[228:231]
v_exp_f32 v121, v121
v_mfma_f32_16x16x32_bf16 v[140:143], a[164:167], v[76:79], v[140:143]
v_exp_f32 v122, v122
v_mfma_f32_16x16x32_bf16 v[140:143], a[168:171], v[80:83], v[140:143]
v_exp_f32 v123, v123
v_mfma_f32_16x16x32_bf16 v[140:143], a[172:175], v[84:87], v[140:143]
v_exp_f32 v136, v136
v_mfma_f32_16x16x32_bf16 v[124:127], a[172:175], v[68:71], v[224:227]
ds_read_b128 a[144:147], v3 offset:16384
v_cvt_pk_bf16_f32 v200, v120, v121
v_mfma_f32_16x16x32_bf16 v[124:127], a[168:171], v[64:67], v[124:127]
v_exp_f32 v137, v137
v_mfma_f32_16x16x32_bf16 v[124:127], a[164:167], v[60:63], v[124:127]
ds_read_b128 a[148:151], v3 offset:24576
v_cvt_pk_bf16_f32 v201, v122, v123
v_mfma_f32_16x16x32_bf16 v[124:127], a[160:163], v[56:59], v[124:127]
v_exp_f32 v138, v138
v_mfma_f32_16x16x32_bf16 v[128:131], a[176:179], v[56:59], v[224:227]
ds_read_b128 a[152:155], v3 offset:17408
v_cvt_pk_bf16_f32 v208, v136, v137
v_mfma_f32_16x16x32_bf16 v[128:131], a[180:183], v[60:63], v[128:131]
s_waitcnt lgkmcnt(3)
v_exp_f32 v139, v139
v_mfma_f32_16x16x32_bf16 v[128:131], a[184:187], v[64:67], v[128:131]
ds_read_b128 a[156:159], v3 offset:25600
v_cvt_pk_bf16_f32 v209, v138, v139
v_mfma_f32_16x16x32_bf16 v[128:131], a[188:191], v[68:71], v[128:131]
v_exp_f32 v140, v140
v_mfma_f32_16x16x32_bf16 v[144:147], a[188:191], v[84:87], v[228:231]
buffer_load_dwordx4 v16, s[32:35], s64 offen offset:1024 sc1 lds
v_mfma_f32_16x16x32_bf16 v[144:147], a[184:187], v[80:83], v[144:147]
v_exp_f32 v141, v141
v_mfma_f32_16x16x32_bf16 v[144:147], a[180:183], v[76:79], v[144:147]
ds_read_b128 a[160:163], v3 offset:18432
v_cvt_pk_bf16_f32 v210, v140, v141
v_mfma_f32_16x16x32_bf16 v[144:147], a[176:179], v[72:75], v[144:147]
v_exp_f32 v142, v142
v_mfma_f32_16x16x32_bf16 v[148:151], a[192:195], v[72:75], v[228:231]
ds_read_b128 a[164:167], v3 offset:26624
ds_read_b128 a[168:171], v3 offset:19456
v_mfma_f32_16x16x32_bf16 v[148:151], a[196:199], v[76:79], v[148:151]
v_exp_f32 v143, v143
v_mfma_f32_16x16x32_bf16 v[148:151], a[200:203], v[80:83], v[148:151]
ds_read_b128 a[172:175], v3 offset:27648
v_cvt_pk_bf16_f32 v211, v142, v143
v_mfma_f32_16x16x32_bf16 v[148:151], a[204:207], v[84:87], v[148:151]
v_exp_f32 v124, v124
v_mfma_f32_16x16x32_bf16 v[132:135], a[204:207], v[68:71], v[224:227]
ds_read_b128 a[176:179], v3 offset:20480
buffer_load_dwordx4 v16, s[32:35], s64 offen offset:2048 sc1 lds
v_mfma_f32_16x16x32_bf16 v[132:135], a[200:203], v[64:67], v[132:135]
v_exp_f32 v125, v125
v_mfma_f32_16x16x32_bf16 v[132:135], a[196:199], v[60:63], v[132:135]
ds_read_b128 a[180:183], v3 offset:28672
v_cvt_pk_bf16_f32 v202, v124, v125
v_mfma_f32_16x16x32_bf16 v[132:135], a[192:195], v[56:59], v[132:135]
v_exp_f32 v126, v126
v_smfmac_f32_16x16x64_bf16 a[136:139], a[240:243], v[184:191], v5
ds_read_b128 a[184:187], v3 offset:21504
v_smfmac_f32_16x16x64_bf16 a[140:143], a[240:243], v[192:199], v5
s_waitcnt lgkmcnt(3)
ds_read_b128 a[188:191], v3 offset:29696
v_mfma_f32_16x16x32_bf16 a[64:67], a[144:147], v[184:187], a[64:67]
v_exp_f32 v127, v127
v_mfma_f32_16x16x32_bf16 a[64:67], a[148:151], v[188:191], a[64:67]
v_exp_f32 v128, v128
v_mfma_f32_16x16x32_bf16 a[96:99], a[148:151], v[196:199], a[96:99]
v_exp_f32 v129, v129
v_mfma_f32_16x16x32_bf16 a[96:99], a[144:147], v[192:195], a[96:99]
ds_read_b128 a[192:195], v3 offset:22528
v_cvt_pk_bf16_f32 v203, v126, v127
v_mfma_f32_16x16x32_bf16 a[100:103], a[152:155], v[192:195], a[100:103]
v_exp_f32 v130, v130
v_mfma_f32_16x16x32_bf16 a[100:103], a[156:159], v[196:199], a[100:103]
ds_read_b128 a[196:199], v3 offset:30720
v_cvt_pk_bf16_f32 v204, v128, v129
v_mfma_f32_16x16x32_bf16 a[68:71], a[156:159], v[188:191], a[68:71]
v_exp_f32 v131, v131
v_mfma_f32_16x16x32_bf16 a[68:71], a[152:155], v[184:187], a[68:71]
ds_read_b128 a[200:203], v3 offset:23552
v_cvt_pk_bf16_f32 v205, v130, v131
v_mfma_f32_16x16x32_bf16 a[72:75], a[160:163], v[184:187], a[72:75]
v_exp_f32 v144, v144
v_mfma_f32_16x16x32_bf16 a[72:75], a[164:167], v[188:191], a[72:75]
buffer_load_dwordx4 v16, s[32:35], s64 offen offset:3072 sc1 lds
v_mfma_f32_16x16x32_bf16 a[104:107], a[164:167], v[196:199], a[104:107]
s_xor_b32 s71, s71, 49152
v_exp_f32 v145, v145
v_mfma_f32_16x16x32_bf16 a[104:107], a[160:163], v[192:195], a[104:107]
ds_read_b128 a[204:207], v3 offset:31744
v_cvt_pk_bf16_f32 v212, v144, v145
v_mfma_f32_16x16x32_bf16 a[108:111], a[168:171], v[192:195], a[108:111]
s_add_u32 s70, s70, 32768
v_xor_b32 v2, 0x8000, v2
v_exp_f32 v146, v146
v_mfma_f32_16x16x32_bf16 a[108:111], a[172:175], v[196:199], a[108:111]
s_waitcnt vmcnt(8)
s_barrier
v_mfma_f32_16x16x32_bf16 a[76:79], a[172:175], v[188:191], a[76:79]
s_mov_b32 m0, s71
v_exp_f32 v147, v147
v_mfma_f32_16x16x32_bf16 a[76:79], a[168:171], v[184:187], a[76:79]
s_waitcnt lgkmcnt(1)
ds_read_b128 a[144:147], v2 offset:0
v_cvt_pk_bf16_f32 v213, v146, v147
v_mfma_f32_16x16x32_bf16 a[80:83], a[176:179], v[184:187], a[80:83]
v_exp_f32 v148, v148
v_mfma_f32_16x16x32_bf16 a[80:83], a[180:183], v[188:191], a[80:83]
ds_read_b128 a[148:151], v2 offset:1024
ds_read_b128 a[152:155], v2 offset:2048
v_mfma_f32_16x16x32_bf16 a[112:115], a[180:183], v[196:199], a[112:115]
v_exp_f32 v149, v149
v_mfma_f32_16x16x32_bf16 a[112:115], a[176:179], v[192:195], a[112:115]
ds_read_b128 a[156:159], v2 offset:3072
v_cvt_pk_bf16_f32 v214, v148, v149
v_mfma_f32_16x16x32_bf16 a[116:119], a[184:187], v[192:195], a[116:119]
v_exp_f32 v150, v150
v_mfma_f32_16x16x32_bf16 a[116:119], a[188:191], v[196:199], a[116:119]
buffer_load_dwordx4 v16, s[32:35], s70 offen offset:0 sc1 lds
v_mfma_f32_16x16x32_bf16 a[84:87], a[188:191], v[188:191], a[84:87]
s_sub_u32 s72, s72, 1
v_exp_f32 v151, v151
v_mfma_f32_16x16x32_bf16 a[84:87], a[184:187], v[184:187], a[84:87]
ds_read_b128 a[160:163], v2 offset:4096
v_cvt_pk_bf16_f32 v215, v150, v151
v_mfma_f32_16x16x32_bf16 a[88:91], a[192:195], v[184:187], a[88:91]
v_exp_f32 v132, v132
v_mfma_f32_16x16x32_bf16 a[88:91], a[196:199], v[188:191], a[88:91]
ds_read_b128 a[164:167], v2 offset:5120
v_xor_b32 v3, 0x8000, v3
v_mfma_f32_16x16x32_bf16 a[120:123], a[196:199], v[196:199], a[120:123]
s_cmp_lg_u32 s72, 0
v_exp_f32 v133, v133
v_mfma_f32_16x16x32_bf16 a[120:123], a[192:195], v[192:195], a[120:123]
ds_read_b128 a[168:171], v2 offset:6144
v_cvt_pk_bf16_f32 v206, v132, v133
v_mfma_f32_16x16x32_bf16 a[124:127], a[200:203], v[192:195], a[124:127]
s_waitcnt lgkmcnt(3)
v_exp_f32 v134, v134
v_mfma_f32_16x16x32_bf16 a[124:127], a[204:207], v[196:199], a[124:127]
buffer_load_dwordx4 v16, s[32:35], s70 offen offset:1024 sc1 lds
v_mfma_f32_16x16x32_bf16 a[92:95], a[204:207], v[188:191], a[92:95]
v_exp_f32 v135, v135
v_mfma_f32_16x16x32_bf16 a[92:95], a[200:203], v[184:187], a[92:95]
ds_read_b128 a[172:175], v2 offset:7168
v_cvt_pk_bf16_f32 v207, v134, v135
s_cbranch_scc1 L_S
L_SD:
buffer_load_dword v19, off, s[52:55], s80 sc1
s_waitcnt lgkmcnt(7)
v_mfma_f32_16x16x32_bf16 v[136:139], a[144:147], v[72:75], v[228:231]
s_waitcnt lgkmcnt(6)
ds_read_b128 a[176:179], v2 offset:8192
ds_read_b128 a[180:183], v2 offset:9216
v_mfma_f32_16x16x32_bf16 v[136:139], a[148:151], v[76:79], v[136:139]
s_waitcnt lgkmcnt(7)
buffer_load_dwordx4 v16, s[32:35], s70 offen offset:2048 sc1 lds
v_cndmask_b32 v120, v224, v17, s[0:1]
v_cndmask_b32 v121, v224, v17, s[4:5]
v_cndmask_b32 v122, v224, v17, s[6:7]
v_cndmask_b32 v123, v224, v17, s[8:9]
v_mfma_f32_16x16x32_bf16 v[136:139], a[152:155], v[80:83], v[136:139]
s_waitcnt lgkmcnt(6)
s_add_u32 s64, s70, 4096
ds_read_b128 a[184:187], v2 offset:10240
ds_read_b128 a[188:191], v2 offset:11264
v_mfma_f32_16x16x32_bf16 v[136:139], a[156:159], v[84:87], v[136:139]
buffer_load_dwordx4 v16, s[32:35], s70 offen offset:3072 sc1 lds
v_mfma_f32_16x16x32_bf16 v[120:123], a[156:159], v[68:71], v[120:123]
s_add_u32 m0, s71, 4096
ds_read_b128 a[192:195], v2 offset:12288
ds_read_b128 a[196:199], v2 offset:13312
v_mfma_f32_16x16x32_bf16 v[120:123], a[152:155], v[64:67], v[120:123]
buffer_load_dwordx4 v16, s[32:35], s64 offen offset:0 sc1 lds
v_mfma_f32_16x16x32_bf16 v[120:123], a[148:151], v[60:63], v[120:123]
ds_read_b128 a[200:203], v2 offset:14336
ds_read_b128 a[204:207], v2 offset:15360
v_mfma_f32_16x16x32_bf16 v[120:123], a[144:147], v[56:59], v[120:123]
s_waitcnt lgkmcnt(6)
v_exp_f32 v136, v136
v_mfma_f32_16x16x32_bf16 v[140:143], a[160:163], v[72:75], v[228:231]
v_exp_f32 v137, v137
v_mfma_f32_16x16x32_bf16 v[140:143], a[164:167], v[76:79], v[140:143]
v_cndmask_b32 v124, v224, v17, s[10:11]
v_cndmask_b32 v125, v224, v17, s[12:13]
v_cndmask_b32 v126, v224, v17, s[18:19]
v_cndmask_b32 v127, v224, v17, s[22:23]
v_exp_f32 v138, v138
v_mfma_f32_16x16x32_bf16 v[140:143], a[168:171], v[80:83], v[140:143]
v_exp_f32 v139, v139
v_mfma_f32_16x16x32_bf16 v[140:143], a[172:175], v[84:87], v[140:143]
v_exp_f32 v120, v120
v_mfma_f32_16x16x32_bf16 v[124:127], a[172:175], v[68:71], v[124:127]
ds_read_b128 a[144:147], v3 offset:0
v_cvt_pk_bf16_f32 v192, v136, v137
v_mfma_f32_16x16x32_bf16 v[124:127], a[168:171], v[64:67], v[124:127]
v_cndmask_b32 v128, v224, v17, s[26:27]
v_cndmask_b32 v129, v224, v17, s[56:57]
v_cndmask_b32 v130, v224, v17, s[58:59]
v_cndmask_b32 v131, v224, v17, s[60:61]
v_exp_f32 v121, v121
v_mfma_f32_16x16x32_bf16 v[124:127], a[164:167], v[60:63], v[124:127]
s_mul_i32 s69, s83, 8
ds_read_b128 a[148:151], v3 offset:8192
v_cvt_pk_bf16_f32 v193, v138, v139
v_mfma_f32_16x16x32_bf16 v[124:127], a[160:163], v[56:59], v[124:127]
s_sub_u32 s69, 36, s69
v_exp_f32 v122, v122
v_mfma_f32_16x16x32_bf16 v[128:131], a[176:179], v[56:59], v[128:131]
ds_read_b128 a[152:155], v3 offset:1024
v_cvt_pk_bf16_f32 v184, v120, v121
v_mfma_f32_16x16x32_bf16 v[128:131], a[180:183], v[60:63], v[128:131]
s_waitcnt lgkmcnt(3)
v_exp_f32 v123, v123
v_mfma_f32_16x16x32_bf16 v[128:131], a[184:187], v[64:67], v[128:131]
ds_read_b128 a[156:159], v3 offset:9216
v_cvt_pk_bf16_f32 v185, v122, v123
v_mfma_f32_16x16x32_bf16 v[128:131], a[188:191], v[68:71], v[128:131]
v_exp_f32 v140, v140
v_mfma_f32_16x16x32_bf16 v[144:147], a[188:191], v[84:87], v[228:231]
buffer_load_dwordx4 v16, s[32:35], s64 offen offset:1024 sc1 lds
v_mfma_f32_16x16x32_bf16 v[144:147], a[184:187], v[80:83], v[144:147]
v_exp_f32 v141, v141
v_mfma_f32_16x16x32_bf16 v[144:147], a[180:183], v[76:79], v[144:147]
ds_read_b128 a[160:163], v3 offset:2048
v_cvt_pk_bf16_f32 v194, v140, v141
v_mfma_f32_16x16x32_bf16 v[144:147], a[176:179], v[72:75], v[144:147]
v_exp_f32 v142, v142
v_mfma_f32_16x16x32_bf16 v[148:151], a[192:195], v[72:75], v[228:231]
ds_read_b128 a[164:167], v3 offset:10240
ds_read_b128 a[168:171], v3 offset:3072
v_mfma_f32_16x16x32_bf16 v[148:151], a[196:199], v[76:79], v[148:151]
v_cndmask_b32 v132, v224, v17, s[62:63]
v_cndmask_b32 v133, v224, v17, s[48:49]
v_cndmask_b32 v134, v224, v17, s[50:51]
v_cndmask_b32 v135, v224, v17, s[100:101]
v_exp_f32 v143, v143
v_mfma_f32_16x16x32_bf16 v[148:151], a[200:203], v[80:83], v[148:151]
ds_read_b128 a[172:175], v3 offset:11264
v_cvt_pk_bf16_f32 v195, v142, v143
v_mfma_f32_16x16x32_bf16 v[148:151], a[204:207], v[84:87], v[148:151]
v_exp_f32 v124, v124
v_mfma_f32_16x16x32_bf16 v[132:135], a[204:207], v[68:71], v[132:135]
ds_read_b128 a[176:179], v3 offset:4096
buffer_load_dwordx4 v16, s[32:35], s64 offen offset:2048 sc1 lds
v_mfma_f32_16x16x32_bf16 v[132:135], a[200:203], v[64:67], v[132:135]
v_exp_f32 v125, v125
v_mfma_f32_16x16x32_bf16 v[132:135], a[196:199], v[60:63], v[132:135]
ds_read_b128 a[180:183], v3 offset:12288
v_cvt_pk_bf16_f32 v186, v124, v125
v_mfma_f32_16x16x32_bf16 v[132:135], a[192:195], v[56:59], v[132:135]
v_exp_f32 v126, v126
v_smfmac_f32_16x16x64_bf16 a[136:139], a[240:243], v[200:207], v5
ds_read_b128 a[184:187], v3 offset:5120
v_smfmac_f32_16x16x64_bf16 a[140:143], a[240:243], v[208:215], v5
s_branch L_po19
L_pg19:
s_branch L_pg23
L_po19:
s_waitcnt lgkmcnt(3)
ds_read_b128 a[188:191], v3 offset:13312
v_mfma_f32_16x16x32_bf16 a[64:67], a[144:147], v[200:203], a[64:67]
v_exp_f32 v127, v127
v_mfma_f32_16x16x32_bf16 a[64:67], a[148:151], v[204:207], a[64:67]
v_exp_f32 v128, v128
v_mfma_f32_16x16x32_bf16 a[96:99], a[148:151], v[212:215], a[96:99]
v_exp_f32 v129, v129
v_mfma_f32_16x16x32_bf16 a[96:99], a[144:147], v[208:211], a[96:99]
ds_read_b128 a[192:195], v3 offset:6144
v_cvt_pk_bf16_f32 v187, v126, v127
v_mfma_f32_16x16x32_bf16 a[100:103], a[152:155], v[208:211], a[100:103]
v_exp_f32 v130, v130
v_mfma_f32_16x16x32_bf16 a[100:103], a[156:159], v[212:215], a[100:103]
ds_read_b128 a[196:199], v3 offset:14336
v_cvt_pk_bf16_f32 v188, v128, v129
v_mfma_f32_16x16x32_bf16 a[68:71], a[156:159], v[204:207], a[68:71]
v_exp_f32 v131, v131
v_mfma_f32_16x16x32_bf16 a[68:71], a[152:155], v[200:203], a[68:71]
ds_read_b128 a[200:203], v3 offset:7168
v_cvt_pk_bf16_f32 v189, v130, v131
v_mfma_f32_16x16x32_bf16 a[72:75], a[160:163], v[200:203], a[72:75]
v_exp_f32 v144, v144
v_mfma_f32_16x16x32_bf16 a[72:75], a[164:167], v[204:207], a[72:75]
buffer_load_dwordx4 v16, s[32:35], s64 offen offset:3072 sc1 lds
v_mfma_f32_16x16x32_bf16 a[104:107], a[164:167], v[212:215], a[104:107]
v_exp_f32 v145, v145
v_mfma_f32_16x16x32_bf16 a[104:107], a[160:163], v[208:211], a[104:107]
ds_read_b128 a[204:207], v3 offset:15360
v_cvt_pk_bf16_f32 v196, v144, v145
v_mfma_f32_16x16x32_bf16 a[108:111], a[168:171], v[208:211], a[108:111]
v_exp_f32 v146, v146
v_mfma_f32_16x16x32_bf16 a[108:111], a[172:175], v[212:215], a[108:111]
s_waitcnt vmcnt(9)
s_barrier
v_mfma_f32_16x16x32_bf16 a[76:79], a[172:175], v[204:207], a[76:79]
v_exp_f32 v147, v147
v_mfma_f32_16x16x32_bf16 a[76:79], a[168:171], v[200:203], a[76:79]
s_waitcnt lgkmcnt(1)
ds_read_b128 a[144:147], v2 offset:16384
v_cvt_pk_bf16_f32 v197, v146, v147
v_mfma_f32_16x16x32_bf16 a[80:83], a[176:179], v[200:203], a[80:83]
s_waitcnt vmcnt(6)
v_readfirstlane_b32 vcc_lo, v19
s_nop 0
s_cmp_lt_u32 vcc_lo, s69
s_cbranch_scc1 L_spin_8
L_spinbk_9:
v_exp_f32 v148, v148
v_mfma_f32_16x16x32_bf16 a[80:83], a[180:183], v[204:207], a[80:83]
ds_read_b128 a[148:151], v2 offset:17408
ds_read_b128 a[152:155], v2 offset:18432
v_mfma_f32_16x16x32_bf16 a[112:115], a[180:183], v[212:215], a[112:115]
v_exp_f32 v149, v149
v_mfma_f32_16x16x32_bf16 a[112:115], a[176:179], v[208:211], a[112:115]
ds_read_b128 a[156:159], v2 offset:19456
v_cvt_pk_bf16_f32 v198, v148, v149
v_mfma_f32_16x16x32_bf16 a[116:119], a[184:187], v[208:211], a[116:119]
v_exp_f32 v150, v150
v_mfma_f32_16x16x32_bf16 a[116:119], a[188:191], v[212:215], a[116:119]
v_cndmask_b32 v136, v228, v17, s[0:1]
v_cndmask_b32 v137, v228, v17, s[4:5]
v_mfma_f32_16x16x32_bf16 a[84:87], a[188:191], v[204:207], a[84:87]
v_exp_f32 v151, v151
v_mfma_f32_16x16x32_bf16 a[84:87], a[184:187], v[200:203], a[84:87]
ds_read_b128 a[160:163], v2 offset:20480
v_cvt_pk_bf16_f32 v199, v150, v151
v_mfma_f32_16x16x32_bf16 a[88:91], a[192:195], v[200:203], a[88:91]
v_exp_f32 v132, v132
v_mfma_f32_16x16x32_bf16 a[88:91], a[196:199], v[204:207], a[88:91]
ds_read_b128 a[164:167], v2 offset:21504
v_cndmask_b32 v138, v228, v17, s[6:7]
v_mfma_f32_16x16x32_bf16 a[120:123], a[196:199], v[212:215], a[120:123]
v_exp_f32 v133, v133
v_mfma_f32_16x16x32_bf16 a[120:123], a[192:195], v[208:211], a[120:123]
ds_read_b128 a[168:171], v2 offset:22528
v_cvt_pk_bf16_f32 v190, v132, v133
v_mfma_f32_16x16x32_bf16 a[124:127], a[200:203], v[208:211], a[124:127]
s_waitcnt lgkmcnt(3)
v_exp_f32 v134, v134
v_mfma_f32_16x16x32_bf16 a[124:127], a[204:207], v[212:215], a[124:127]
v_cndmask_b32 v139, v228, v17, s[8:9]
v_cndmask_b32 v140, v228, v17, s[10:11]
v_mfma_f32_16x16x32_bf16 a[92:95], a[204:207], v[204:207], a[92:95]
v_exp_f32 v135, v135
v_mfma_f32_16x16x32_bf16 a[92:95], a[200:203], v[200:203], a[92:95]
ds_read_b128 a[172:175], v2 offset:23552
v_cvt_pk_bf16_f32 v191, v134, v135
v_mfma_f32_16x16x32_bf16 v[136:139], a[144:147], v[72:75], v[136:139]
ds_read_b128 a[176:179], v2 offset:24576
v_cndmask_b32 v141, v228, v17, s[12:13]
v_mfma_f32_16x16x32_bf16 v[136:139], a[148:151], v[76:79], v[136:139]
ds_read_b128 a[180:183], v2 offset:25600
v_cndmask_b32 v142, v228, v17, s[18:19]
v_cndmask_b32 v143, v228, v17, s[22:23]
v_mfma_f32_16x16x32_bf16 v[136:139], a[152:155], v[80:83], v[136:139]
ds_read_b128 a[184:187], v2 offset:26624
v_cndmask_b32 v144, v228, v17, s[26:27]
v_mfma_f32_16x16x32_bf16 v[136:139], a[156:159], v[84:87], v[136:139]
s_waitcnt lgkmcnt(3)
ds_read_b128 a[188:191], v2 offset:27648
v_cndmask_b32 v145, v228, v17, s[56:57]
v_mfma_f32_16x16x32_bf16 v[140:143], a[172:175], v[84:87], v[140:143]
ds_read_b128 a[192:195], v2 offset:28672
ds_read_b128 a[196:199], v2 offset:29696
ds_read_b128 a[200:203], v2 offset:30720
ds_read_b128 a[204:207], v2 offset:31744
v_mfma_f32_16x16x32_bf16 v[140:143], a[168:171], v[80:83], v[140:143]
ds_read_b128 a[144:147], v3 offset:16384
v_cndmask_b32 v146, v228, v17, s[58:59]
v_cndmask_b32 v147, v228, v17, s[60:61]
v_mfma_f32_16x16x32_bf16 v[140:143], a[164:167], v[76:79], v[140:143]
ds_read_b128 a[148:151], v3 offset:24576
v_cndmask_b32 v148, v228, v17, s[62:63]
v_mfma_f32_16x16x32_bf16 v[140:143], a[160:163], v[72:75], v[140:143]
s_waitcnt lgkmcnt(8)
ds_read_b128 a[152:155], v3 offset:17408
v_cndmask_b32 v149, v228, v17, s[48:49]
v_mfma_f32_16x16x32_bf16 v[144:147], a[176:179], v[72:75], v[144:147]
ds_read_b128 a[156:159], v3 offset:25600
v_cndmask_b32 v150, v228, v17, s[50:51]
v_mfma_f32_16x16x32_bf16 v[144:147], a[180:183], v[76:79], v[144:147]
s_waitcnt lgkmcnt(8)
ds_read_b128 a[160:163], v3 offset:18432
v_cndmask_b32 v151, v228, v17, s[100:101]
v_mfma_f32_16x16x32_bf16 v[144:147], a[184:187], v[80:83], v[144:147]
v_exp_f32 v136, v136
v_mfma_f32_16x16x32_bf16 v[144:147], a[188:191], v[84:87], v[144:147]
s_waitcnt lgkmcnt(4)
v_exp_f32 v137, v137
v_mfma_f32_16x16x32_bf16 v[148:151], a[204:207], v[84:87], v[148:151]
v_exp_f32 v138, v138
v_mfma_f32_16x16x32_bf16 v[148:151], a[200:203], v[80:83], v[148:151]
s_add_u32 s65, s84, 0
v_exp_f32 v139, v139
v_mfma_f32_16x16x32_bf16 v[148:151], a[196:199], v[76:79], v[148:151]
buffer_load_dwordx4 a[208:211], v14, s[44:47], s65 offen offset:0 sc1
v_mfma_f32_16x16x32_bf16 v[148:151], a[192:195], v[72:75], v[148:151]
ds_read_b128 a[164:167], v3 offset:26624
v_cvt_pk_bf16_f32 v208, v136, v137
v_smfmac_f32_16x16x64_bf16 a[136:139], a[240:243], v[184:191], v5
ds_read_b128 a[168:171], v3 offset:19456
v_smfmac_f32_16x16x64_bf16 a[140:143], a[240:243], v[192:199], v5
ds_read_b128 a[172:175], v3 offset:27648
v_mfma_f32_16x16x32_bf16 a[64:67], a[144:147], v[184:187], a[64:67]
s_waitcnt lgkmcnt(3)
v_exp_f32 v140, v140
v_mfma_f32_16x16x32_bf16 a[64:67], a[148:151], v[188:191], a[64:67]
buffer_load_dwordx4 a[216:219], v14, s[44:47], s65 offen offset:1024 sc1
v_mfma_f32_16x16x32_bf16 a[96:99], a[148:151], v[196:199], a[96:99]
v_exp_f32 v141, v141
v_mfma_f32_16x16x32_bf16 a[96:99], a[144:147], v[192:195], a[96:99]
buffer_load_dwordx4 a[224:227], v15, s[44:47], s65 offen offset:0 sc1
v_mfma_f32_16x16x32_bf16 a[100:103], a[152:155], v[192:195], a[100:103]
v_exp_f32 v142, v142
v_mfma_f32_16x16x32_bf16 a[100:103], a[156:159], v[196:199], a[100:103]
buffer_load_dwordx4 a[232:235], v15, s[44:47], s65 offen offset:1024 sc1
v_mfma_f32_16x16x32_bf16 a[68:71], a[156:159], v[188:191], a[68:71]
s_add_u32 s65, s84, 8192
ds_read_b128 a[176:179], v3 offset:20480
v_cvt_pk_bf16_f32 v209, v138, v139
v_mfma_f32_16x16x32_bf16 a[68:71], a[152:155], v[184:187], a[68:71]
buffer_load_dwordx4 a[212:215], v14, s[44:47], s65 offen offset:0 sc1
v_mfma_f32_16x16x32_bf16 a[72:75], a[160:163], v[184:187], a[72:75]
s_waitcnt lgkmcnt(1)
ds_read_b128 a[180:183], v3 offset:28672
v_cvt_pk_bf16_f32 v210, v140, v141
v_mfma_f32_16x16x32_bf16 a[72:75], a[164:167], v[188:191], a[72:75]
v_exp_f32 v143, v143
v_mfma_f32_16x16x32_bf16 a[104:107], a[164:167], v[196:199], a[104:107]
buffer_load_dwordx4 a[220:223], v14, s[44:47], s65 offen offset:1024 sc1
v_mfma_f32_16x16x32_bf16 a[104:107], a[160:163], v[192:195], a[104:107]
v_exp_f32 v144, v144
v_mfma_f32_16x16x32_bf16 a[108:111], a[168:171], v[192:195], a[108:111]
ds_read_b128 a[184:187], v3 offset:21504
v_xor_b32 v2, 0x8000, v2
v_mfma_f32_16x16x32_bf16 a[108:111], a[172:175], v[196:199], a[108:111]
buffer_load_dwordx4 a[228:231], v15, s[44:47], s65 offen offset:0 sc1
ds_read_b128 a[188:191], v3 offset:29696
v_mfma_f32_16x16x32_bf16 a[76:79], a[172:175], v[188:191], a[76:79]
v_exp_f32 v145, v145
v_mfma_f32_16x16x32_bf16 a[76:79], a[168:171], v[184:187], a[76:79]
s_waitcnt lgkmcnt(2)
buffer_load_dwordx4 a[236:239], v15, s[44:47], s65 offen offset:1024 sc1
v_mfma_f32_16x16x32_bf16 a[80:83], a[176:179], v[184:187], a[80:83]
s_add_u32 s65, s84, 32768
ds_read_b128 a[192:195], v3 offset:22528
v_cvt_pk_bf16_f32 v211, v142, v143
v_mfma_f32_16x16x32_bf16 a[80:83], a[180:183], v[188:191], a[80:83]
buffer_load_dwordx4 v[152:155], v14, s[44:47], s65 offen offset:0 sc1
ds_read_b128 a[196:199], v3 offset:30720
v_exp_f32 v146, v146
v_mfma_f32_16x16x32_bf16 a[112:115], a[180:183], v[196:199], a[112:115]
ds_read_b128 a[200:203], v3 offset:23552
ds_read_b128 a[204:207], v3 offset:31744
v_mfma_f32_16x16x32_bf16 a[112:115], a[176:179], v[192:195], a[112:115]
s_waitcnt vmcnt(9)
s_barrier
v_xor_b32 v3, 0x8000, v3
buffer_load_dwordx4 v[160:163], v14, s[44:47], s65 offen offset:1024 sc1
s_waitcnt lgkmcnt(4)
v_mfma_f32_16x16x32_bf16 a[116:119], a[184:187], v[192:195], a[116:119]
v_exp_f32 v147, v147
v_mfma_f32_16x16x32_bf16 a[116:119], a[188:191], v[196:199], a[116:119]
buffer_load_dwordx4 v[168:171], v15, s[44:47], s65 offen offset:0 sc1
v_mfma_f32_16x16x32_bf16 a[84:87], a[188:191], v[188:191], a[84:87]
v_exp_f32 v148, v148
v_mfma_f32_16x16x32_bf16 a[84:87], a[184:187], v[184:187], a[84:87]
s_waitcnt lgkmcnt(2)
buffer_load_dwordx4 v[176:179], v15, s[44:47], s65 offen offset:1024 sc1
v_cvt_pk_bf16_f32 v212, v144, v145
v_mfma_f32_16x16x32_bf16 a[88:91], a[192:195], v[184:187], a[88:91]
s_add_u32 s65, s84, 40960
v_exp_f32 v149, v149
v_mfma_f32_16x16x32_bf16 a[88:91], a[196:199], v[188:191], a[88:91]
buffer_load_dwordx4 v[156:159], v14, s[44:47], s65 offen offset:0 sc1
v_mfma_f32_16x16x32_bf16 a[120:123], a[196:199], v[196:199], a[120:123]
ds_read_b128 a[144:147], v3 offset:0
v_cvt_pk_bf16_f32 v213, v146, v147
v_mfma_f32_16x16x32_bf16 a[120:123], a[192:195], v[192:195], a[120:123]
s_waitcnt lgkmcnt(1)
buffer_load_dwordx4 v[164:167], v14, s[44:47], s65 offen offset:1024 sc1
ds_read_b128 a[148:151], v3 offset:8192
v_exp_f32 v150, v150
v_mfma_f32_16x16x32_bf16 a[124:127], a[200:203], v[192:195], a[124:127]
ds_read_b128 a[152:155], v3 offset:1024
v_cvt_pk_bf16_f32 v214, v148, v149
v_mfma_f32_16x16x32_bf16 a[124:127], a[204:207], v[196:199], a[124:127]
buffer_load_dwordx4 v[172:175], v15, s[44:47], s65 offen offset:0 sc1
ds_read_b128 a[156:159], v3 offset:9216
v_mfma_f32_16x16x32_bf16 a[92:95], a[204:207], v[188:191], a[92:95]
v_exp_f32 v151, v151
v_mfma_f32_16x16x32_bf16 a[92:95], a[200:203], v[184:187], a[92:95]
buffer_load_dwordx4 v[180:183], v15, s[44:47], s65 offen offset:1024 sc1
ds_read_b128 a[160:163], v3 offset:2048
ds_read_b128 a[164:167], v3 offset:10240
ds_read_b128 a[168:171], v3 offset:3072
ds_read_b128 a[172:175], v3 offset:11264
v_cvt_pk_bf16_f32 v215, v150, v151
v_accvgpr_read_b32 v22, a136
v_accvgpr_read_b32 v248, a137
v_add_f32 v22, v22, v248
v_max_f32 v1, v1, v22
v_rcp_f32 v22, v22
v_accvgpr_read_b32 v232, a64
v_accvgpr_read_b32 v233, a65
v_accvgpr_read_b32 v234, a66
v_accvgpr_read_b32 v235, a67
v_accvgpr_read_b32 v236, a68
v_accvgpr_read_b32 v237, a69
v_accvgpr_read_b32 v238, a70
v_accvgpr_read_b32 v239, a71
v_mul_f32 v22, v22, v8
v_mul_f32 v232, v232, v22
v_mul_f32 v233, v233, v22
v_mul_f32 v234, v234, v22
v_mul_f32 v235, v235, v22
v_mul_f32 v236, v236, v22
v_mul_f32 v237, v237, v22
v_mul_f32 v238, v238, v22
v_mul_f32 v239, v239, v22
v_cvt_pk_bf16_f32 v232, v232, v233
v_cvt_pk_bf16_f32 v233, v234, v235
v_cvt_pk_bf16_f32 v234, v236, v237
v_cvt_pk_bf16_f32 v235, v238, v239
s_add_u32 s77, s75, 0
buffer_store_dwordx4 v[232:235], v16, s[44:47], s77 offen sc1
L_TAIL:
ds_read_b128 a[176:179], v3 offset:4096
ds_read_b128 a[180:183], v3 offset:12288
ds_read_b128 a[184:187], v3 offset:5120
ds_read_b128 a[188:191], v3 offset:13312
v_smfmac_f32_16x16x64_bf16 a[140:143], a[240:243], v[208:215], v5
s_waitcnt lgkmcnt(11)
s_add_u32 m0, s86, 32768
s_add_u32 s64, s85, 262144
ds_read_b128 a[192:195], v3 offset:6144
v_mfma_f32_16x16x32_bf16 a[96:99], a[144:147], v[208:211], a[96:99]
s_waitcnt lgkmcnt(11)
ds_read_b128 a[196:199], v3 offset:14336
ds_read_b128 a[200:203], v3 offset:7168
ds_read_b128 a[204:207], v3 offset:15360
v_mfma_f32_16x16x32_bf16 a[96:99], a[148:151], v[212:215], a[96:99]
s_waitcnt lgkmcnt(12)
buffer_load_dwordx4 v12, s[36:39], s64 offen lds
v_mfma_f32_16x16x32_bf16 a[100:103], a[156:159], v[212:215], a[100:103]
s_add_u32 m0, s86, 33792
s_add_u32 s64, s85, 270336
v_accvgpr_read_b32 v240, a72
v_accvgpr_read_b32 v241, a73
v_mfma_f32_16x16x32_bf16 a[100:103], a[152:155], v[208:211], a[100:103]
s_waitcnt lgkmcnt(11)
buffer_load_dwordx4 v13, s[36:39], s64 offen lds
v_mfma_f32_16x16x32_bf16 a[104:107], a[160:163], v[208:211], a[104:107]
s_waitcnt lgkmcnt(10)
s_add_u32 m0, s86, 34816
s_add_u32 s64, s85, 278528
v_accvgpr_read_b32 v242, a74
v_accvgpr_read_b32 v243, a75
v_mfma_f32_16x16x32_bf16 a[104:107], a[164:167], v[212:215], a[104:107]
s_waitcnt lgkmcnt(8)
buffer_load_dwordx4 v12, s[36:39], s64 offen lds
v_mfma_f32_16x16x32_bf16 a[108:111], a[172:175], v[212:215], a[108:111]
s_add_u32 m0, s86, 35840
s_add_u32 s64, s85, 286720
v_accvgpr_read_b32 v244, a76
v_accvgpr_read_b32 v245, a77
v_mfma_f32_16x16x32_bf16 a[108:111], a[168:171], v[208:211], a[108:111]
s_waitcnt lgkmcnt(7)
buffer_load_dwordx4 v13, s[36:39], s64 offen lds
v_mfma_f32_16x16x32_bf16 a[112:115], a[176:179], v[208:211], a[112:115]
s_waitcnt lgkmcnt(6)
s_add_u32 m0, s86, 36864
s_add_u32 s64, s85, 294912
v_accvgpr_read_b32 v246, a78
v_accvgpr_read_b32 v247, a79
v_mfma_f32_16x16x32_bf16 a[112:115], a[180:183], v[212:215], a[112:115]
s_waitcnt lgkmcnt(4)
buffer_load_dwordx4 v12, s[36:39], s64 offen lds
v_mfma_f32_16x16x32_bf16 a[116:119], a[188:191], v[212:215], a[116:119]
s_add_u32 m0, s86, 37888
s_add_u32 s64, s85, 303104
v_mul_f32 v240, v240, v22
v_mul_f32 v241, v241, v22
v_mfma_f32_16x16x32_bf16 a[116:119], a[184:187], v[208:211], a[116:119]
s_waitcnt lgkmcnt(3)
buffer_load_dwordx4 v13, s[36:39], s64 offen lds
v_mfma_f32_16x16x32_bf16 a[120:123], a[192:195], v[208:211], a[120:123]
s_waitcnt lgkmcnt(2)
s_add_u32 m0, s86, 38912
s_add_u32 s64, s85, 311296
v_mul_f32 v242, v242, v22
v_mul_f32 v243, v243, v22
v_mfma_f32_16x16x32_bf16 a[120:123], a[196:199], v[212:215], a[120:123]
s_waitcnt lgkmcnt(0)
buffer_load_dwordx4 v12, s[36:39], s64 offen lds
v_mfma_f32_16x16x32_bf16 a[124:127], a[204:207], v[212:215], a[124:127]
s_add_u32 m0, s86, 39936
s_add_u32 s64, s85, 319488
v_mul_f32 v244, v244, v22
v_mul_f32 v245, v245, v22
v_mfma_f32_16x16x32_bf16 a[124:127], a[200:203], v[208:211], a[124:127]
buffer_load_dwordx4 v13, s[36:39], s64 offen lds
v_mul_f32 v246, v246, v22
v_mul_f32 v247, v247, v22
v_cvt_pk_bf16_f32 v240, v240, v241
v_cvt_pk_bf16_f32 v241, v242, v243
v_cvt_pk_bf16_f32 v242, v244, v245
v_cvt_pk_bf16_f32 v243, v246, v247
s_add_u32 s77, s75, 8192
buffer_store_dwordx4 v[240:243], v16, s[44:47], s77 offen sc1
v_accvgpr_read_b32 v23, a140
v_accvgpr_read_b32 v248, a141
v_add_f32 v23, v23, v248
v_max_f32 v1, v1, v23
v_rcp_f32 v23, v23
s_mov_b32 s66, 0x5d800000
v_cmp_le_f32 vcc, s66, v1
s_lshl_b32 s67, s30, 2
s_cmp_lg_u64 vcc, 0
s_cselect_b32 s66, 1, 0
v_mov_b32 v248, s67
v_mov_b32 v249, s66
ds_write_b32 v248, v249
v_accvgpr_read_b32 v232, a80
v_accvgpr_read_b32 v233, a81
v_accvgpr_read_b32 v234, a82
v_accvgpr_read_b32 v235, a83
v_accvgpr_read_b32 v236, a84
v_accvgpr_read_b32 v237, a85
v_accvgpr_read_b32 v238, a86
v_accvgpr_read_b32 v239, a87
v_pk_mul_f32 v[232:233], v[232:233], v[22:23] op_sel_hi:[1,0]
v_pk_mul_f32 v[234:235], v[234:235], v[22:23] op_sel_hi:[1,0]
v_pk_mul_f32 v[236:237], v[236:237], v[22:23] op_sel_hi:[1,0]
v_pk_mul_f32 v[238:239], v[238:239], v[22:23] op_sel_hi:[1,0]
v_cvt_pk_bf16_f32 v232, v232, v233
v_cvt_pk_bf16_f32 v233, v234, v235
v_cvt_pk_bf16_f32 v234, v236, v237
v_cvt_pk_bf16_f32 v235, v238, v239
s_add_u32 s77, s75, 16384
buffer_store_dwordx4 v[232:235], v16, s[44:47], s77 offen sc1
v_accvgpr_read_b32 v240, a88
v_accvgpr_read_b32 v241, a89
v_accvgpr_read_b32 v242, a90
v_accvgpr_read_b32 v243, a91
v_accvgpr_read_b32 v244, a92
v_accvgpr_read_b32 v245, a93
v_accvgpr_read_b32 v246, a94
v_accvgpr_read_b32 v247, a95
v_pk_mul_f32 v[240:241], v[240:241], v[22:23] op_sel_hi:[1,0]
v_pk_mul_f32 v[242:243], v[242:243], v[22:23] op_sel_hi:[1,0]
v_pk_mul_f32 v[244:245], v[244:245], v[22:23] op_sel_hi:[1,0]
v_pk_mul_f32 v[246:247], v[246:247], v[22:23] op_sel_hi:[1,0]
v_cvt_pk_bf16_f32 v240, v240, v241
v_cvt_pk_bf16_f32 v241, v242, v243
v_cvt_pk_bf16_f32 v242, v244, v245
v_cvt_pk_bf16_f32 v243, v246, v247
s_add_u32 s77, s75, 24576
buffer_store_dwordx4 v[240:243], v16, s[44:47], s77 offen sc1
v_accvgpr_read_b32 v232, a96
v_accvgpr_read_b32 v233, a97
v_accvgpr_read_b32 v234, a98
v_accvgpr_read_b32 v235, a99
v_accvgpr_read_b32 v236, a100
v_accvgpr_read_b32 v237, a101
v_accvgpr_read_b32 v238, a102
v_accvgpr_read_b32 v239, a103
v_mul_f32 v23, v23, v10
v_pk_mul_f32 v[232:233], v[232:233], v[22:23] op_sel:[0,1]
v_pk_mul_f32 v[234:235], v[234:235], v[22:23] op_sel:[0,1]
v_pk_mul_f32 v[236:237], v[236:237], v[22:23] op_sel:[0,1]
v_pk_mul_f32 v[238:239], v[238:239], v[22:23] op_sel:[0,1]
v_cvt_pk_bf16_f32 v232, v232, v233
v_cvt_pk_bf16_f32 v233, v234, v235
v_cvt_pk_bf16_f32 v234, v236, v237
v_cvt_pk_bf16_f32 v235, v238, v239
s_add_u32 s77, s75, 4096
buffer_store_dwordx4 v[232:235], v16, s[44:47], s77 offen sc1
v_accvgpr_read_b32 v240, a104
v_accvgpr_read_b32 v241, a105
v_accvgpr_read_b32 v242, a106
v_accvgpr_read_b32 v243, a107
v_accvgpr_read_b32 v244, a108
v_accvgpr_read_b32 v245, a109
v_accvgpr_read_b32 v246, a110
v_accvgpr_read_b32 v247, a111
v_pk_mul_f32 v[240:241], v[240:241], v[22:23] op_sel:[0,1]
v_pk_mul_f32 v[242:243], v[242:243], v[22:23] op_sel:[0,1]
v_pk_mul_f32 v[244:245], v[244:245], v[22:23] op_sel:[0,1]
v_pk_mul_f32 v[246:247], v[246:247], v[22:23] op_sel:[0,1]
v_cvt_pk_bf16_f32 v240, v240, v241
v_cvt_pk_bf16_f32 v241, v242, v243
v_cvt_pk_bf16_f32 v242, v244, v245
v_cvt_pk_bf16_f32 v243, v246, v247
s_add_u32 s77, s75, 12288
buffer_store_dwordx4 v[240:243], v16, s[44:47], s77 offen sc1
v_mov_b32 v248, 0
s_waitcnt lgkmcnt(0)
s_barrier
ds_read_b128 v[248:251], v248
v_xor_b32 v188, 128, v18
v_xor_b32 v189, 160, v18
v_xor_b32 v190, 192, v18
ds_read_b64_tr_b16 a[144:145], v188 offset:32768
ds_read_b64_tr_b16 a[146:147], v188 offset:36864
ds_read_b64_tr_b16 a[148:149], v188 offset:40960
ds_read_b64_tr_b16 a[150:151], v188 offset:45056
ds_read_b64_tr_b16 a[152:153], v189 offset:32768
ds_read_b64_tr_b16 a[154:155], v189 offset:36864
ds_read_b64_tr_b16 a[156:157], v189 offset:40960
ds_read_b64_tr_b16 a[158:159], v189 offset:45056
ds_read_b64_tr_b16 a[160:161], v190 offset:32768
ds_read_b64_tr_b16 a[162:163], v190 offset:36864
ds_read_b64_tr_b16 a[164:165], v190 offset:40960
ds_read_b64_tr_b16 a[166:167], v190 offset:45056
v_xor_b32 v191, 224, v18
v_xor_b32 v184, 0, v18
v_xor_b32 v185, 32, v18
v_xor_b32 v186, 64, v18
v_xor_b32 v187, 96, v18
v_accvgpr_read_b32 v232, a112
v_accvgpr_read_b32 v233, a113
v_accvgpr_read_b32 v234, a114
v_accvgpr_read_b32 v235, a115
v_accvgpr_read_b32 v236, a116
v_accvgpr_read_b32 v237, a117
v_accvgpr_read_b32 v238, a118
v_accvgpr_read_b32 v239, a119
v_pk_mul_f32 v[232:233], v[232:233], v[22:23] op_sel:[0,1]
v_pk_mul_f32 v[234:235], v[234:235], v[22:23] op_sel:[0,1]
v_pk_mul_f32 v[236:237], v[236:237], v[22:23] op_sel:[0,1]
v_pk_mul_f32 v[238:239], v[238:239], v[22:23] op_sel:[0,1]
v_cvt_pk_bf16_f32 v232, v232, v233
v_cvt_pk_bf16_f32 v233, v234, v235
v_cvt_pk_bf16_f32 v234, v236, v237
v_cvt_pk_bf16_f32 v235, v238, v239
s_add_u32 s77, s75, 20480
buffer_store_dwordx4 v[232:235], v16, s[44:47], s77 offen sc1
v_accvgpr_read_b32 v240, a120
v_accvgpr_read_b32 v241, a121
v_accvgpr_read_b32 v242, a122
v_accvgpr_read_b32 v243, a123
v_accvgpr_read_b32 v244, a124
v_accvgpr_read_b32 v245, a125
v_accvgpr_read_b32 v246, a126
v_accvgpr_read_b32 v247, a127
v_pk_mul_f32 v[240:241], v[240:241], v[22:23] op_sel:[0,1]
v_pk_mul_f32 v[242:243], v[242:243], v[22:23] op_sel:[0,1]
v_pk_mul_f32 v[244:245], v[244:245], v[22:23] op_sel:[0,1]
v_pk_mul_f32 v[246:247], v[246:247], v[22:23] op_sel:[0,1]
v_cvt_pk_bf16_f32 v240, v240, v241
v_cvt_pk_bf16_f32 v241, v242, v243
v_cvt_pk_bf16_f32 v242, v244, v245
v_cvt_pk_bf16_f32 v243, v246, v247
s_add_u32 s77, s75, 28672
buffer_store_dwordx4 v[240:243], v16, s[44:47], s77 offen sc1
s_waitcnt lgkmcnt(12)
v_or3_b32 v248, v248, v249, v250
v_or_b32 v248, v248, v251
s_nop 0
v_readfirstlane_b32 s66, v248
s_nop 0
s_cmp_gt_u32 s66, s73
s_cbranch_scc1 L_fallback_11
s_cmp_eq_u32 s83, 0
s_cbranch_scc1 L_p5f0
s_waitcnt lgkmcnt(10)
s_waitcnt vmcnt(28)
v_mfma_f32_16x16x32_bf16 v[136:139], a[144:147], a[232:235], 0
s_waitcnt vmcnt(24)
s_waitcnt lgkmcnt(8)
s_add_u32 m0, s86, 98304
ds_read_b64_tr_b16 a[168:169], v191 offset:32768
v_xor_b32 v192, 0x10000, v184
v_mfma_f32_16x16x32_bf16 v[136:139], a[148:151], a[236:239], v[136:139]
s_add_u32 s64, s85, 524288
ds_read_b64_tr_b16 a[170:171], v191 offset:36864
v_xor_b32 v193, 0x10000, v185
v_mfma_f32_16x16x32_bf16 v[104:107], a[148:151], a[228:231], 0
buffer_load_dwordx4 v12, s[36:39], s64 offen lds
v_mfma_f32_16x16x32_bf16 v[104:107], a[144:147], a[224:227], v[104:107]
s_add_u32 m0, s86, 99328
s_add_u32 s64, s85, 532480
ds_read_b64_tr_b16 a[172:173], v191 offset:40960
v_xor_b32 v194, 0x10000, v186
v_mfma_f32_16x16x32_bf16 v[72:75], a[144:147], a[216:219], 0
buffer_load_dwordx4 v13, s[36:39], s64 offen lds
v_mfma_f32_16x16x32_bf16 v[72:75], a[148:151], a[220:223], v[72:75]
s_add_u32 m0, s86, 100352
ds_read_b64_tr_b16 a[174:175], v191 offset:45056
v_xor_b32 v195, 0x10000, v187
v_mfma_f32_16x16x32_bf16 v[40:43], a[148:151], a[212:215], 0
s_add_u32 s64, s85, 540672
ds_read_b64_tr_b16 a[176:177], v184 offset:32768
v_xor_b32 v196, 0x10000, v188
v_mfma_f32_16x16x32_bf16 v[40:43], a[144:147], a[208:211], v[40:43]
s_waitcnt lgkmcnt(5)
buffer_load_dwordx4 v12, s[36:39], s64 offen lds
v_mfma_f32_16x16x32_bf16 v[44:47], a[152:155], a[208:211], 0
s_add_u32 m0, s86, 101376
s_add_u32 s64, s85, 548864
ds_read_b64_tr_b16 a[178:179], v184 offset:36864
v_xor_b32 v197, 0x10000, v189
v_mfma_f32_16x16x32_bf16 v[44:47], a[156:159], a[212:215], v[44:47]
buffer_load_dwordx4 v13, s[36:39], s64 offen lds
v_mfma_f32_16x16x32_bf16 v[76:79], a[156:159], a[220:223], 0
s_add_u32 m0, s86, 102400
ds_read_b64_tr_b16 a[180:181], v184 offset:40960
v_xor_b32 v198, 0x10000, v190
v_mfma_f32_16x16x32_bf16 v[76:79], a[152:155], a[216:219], v[76:79]
s_add_u32 s64, s85, 557056
ds_read_b64_tr_b16 a[182:183], v184 offset:45056
v_xor_b32 v199, 0x10000, v191
v_mfma_f32_16x16x32_bf16 v[108:111], a[152:155], a[224:227], 0
buffer_load_dwordx4 v12, s[36:39], s64 offen lds
v_mfma_f32_16x16x32_bf16 v[108:111], a[156:159], a[228:231], v[108:111]
s_add_u32 m0, s86, 103424
s_add_u32 s64, s85, 565248
ds_read_b64_tr_b16 a[184:185], v185 offset:32768
v_mfma_f32_16x16x32_bf16 v[140:143], a[156:159], a[236:239], 0
buffer_load_dwordx4 v13, s[36:39], s64 offen lds
v_mfma_f32_16x16x32_bf16 v[140:143], a[152:155], a[232:235], v[140:143]
s_add_u32 m0, s86, 104448
s_add_u32 s64, s85, 573440
ds_read_b64_tr_b16 a[186:187], v185 offset:36864
v_mfma_f32_16x16x32_bf16 v[144:147], a[160:163], a[232:235], 0
s_and_b32 s68, s82, 3
s_lshl_b32 s68, s68, 11
ds_read_b64_tr_b16 a[188:189], v185 offset:40960
v_mfma_f32_16x16x32_bf16 v[144:147], a[164:167], a[236:239], v[144:147]
s_add_u32 s76, s86, s68
buffer_load_dwordx4 v12, s[36:39], s64 offen lds
v_mfma_f32_16x16x32_bf16 v[112:115], a[164:167], a[228:231], 0
s_branch L_po20
L_pg20:
s_branch L_pg24
L_po20:
s_and_b32 s71, s31, 4
s_lshl_b32 s71, s71, 5
s_add_u32 m0, s86, 105472
s_add_u32 s64, s85, 581632
ds_read_b64_tr_b16 a[190:191], v185 offset:45056
v_mfma_f32_16x16x32_bf16 v[112:115], a[160:163], a[224:227], v[112:115]
s_add_u32 s71, s71, s79
buffer_load_dwordx4 v13, s[36:39], s64 offen lds
v_mfma_f32_16x16x32_bf16 v[80:83], a[160:163], a[216:219], 0
s_add_u32 s71, s71, 4096
s_add_u32 s72, s80, 4096
ds_read_b64_tr_b16 a[192:193], v186 offset:32768
v_mfma_f32_16x16x32_bf16 v[80:83], a[164:167], a[220:223], v[80:83]
s_lshr_b32 s69, s87, 8
s_lshr_b32 s67, s82, 1
s_add_u32 s65, s84, 65536
ds_read_b64_tr_b16 a[194:195], v186 offset:36864
v_mfma_f32_16x16x32_bf16 v[48:51], a[164:167], a[212:215], 0
s_xor_b32 s69, s69, s67
buffer_load_dwordx4 a[32:35], v14, s[44:47], s65 offen offset:0 sc1
v_mfma_f32_16x16x32_bf16 v[48:51], a[160:163], a[208:211], v[48:51]
s_waitcnt lgkmcnt(4)
s_and_b32 s69, s69, 2
s_lshl_b32 s69, s69, 15
ds_read_b64_tr_b16 a[196:197], v186 offset:40960
v_mfma_f32_16x16x32_bf16 v[52:55], a[168:171], a[208:211], 0
s_add_u32 s68, s68, s69
buffer_load_dwordx4 a[40:43], v14, s[44:47], s65 offen offset:1024 sc1
v_mfma_f32_16x16x32_bf16 v[52:55], a[172:175], a[212:215], v[52:55]
ds_read_b64_tr_b16 a[198:199], v186 offset:45056
v_mfma_f32_16x16x32_bf16 v[84:87], a[172:175], a[220:223], 0
ds_read_b64_tr_b16 a[200:201], v187 offset:32768
v_mfma_f32_16x16x32_bf16 v[84:87], a[168:171], a[216:219], v[84:87]
buffer_load_dwordx4 a[48:51], v15, s[44:47], s65 offen offset:0 sc1
v_mfma_f32_16x16x32_bf16 v[116:119], a[168:171], a[224:227], 0
ds_read_b64_tr_b16 a[202:203], v187 offset:36864
v_mfma_f32_16x16x32_bf16 v[116:119], a[172:175], a[228:231], v[116:119]
buffer_load_dwordx4 a[56:59], v15, s[44:47], s65 offen offset:1024 sc1
v_mfma_f32_16x16x32_bf16 v[148:151], a[172:175], a[236:239], 0
ds_read_b64_tr_b16 a[204:205], v187 offset:40960
v_mfma_f32_16x16x32_bf16 v[148:151], a[168:171], a[232:235], v[148:151]
s_add_u32 s65, s84, 73728
ds_read_b64_tr_b16 a[206:207], v187 offset:45056
v_mfma_f32_16x16x32_bf16 v[120:123], a[176:179], a[232:235], 0
buffer_load_dwordx4 a[36:39], v14, s[44:47], s65 offen offset:0 sc1
v_mfma_f32_16x16x32_bf16 v[120:123], a[180:183], a[236:239], v[120:123]
v_mfma_f32_16x16x32_bf16 v[88:91], a[180:183], a[228:231], 0
buffer_load_dwordx4 a[44:47], v14, s[44:47], s65 offen offset:1024 sc1
v_mfma_f32_16x16x32_bf16 v[88:91], a[176:179], a[224:227], v[88:91]
v_mfma_f32_16x16x32_bf16 v[56:59], a[176:179], a[216:219], 0
v_mfma_f32_16x16x32_bf16 v[56:59], a[180:183], a[220:223], v[56:59]
buffer_load_dwordx4 a[52:55], v15, s[44:47], s65 offen offset:0 sc1
v_mfma_f32_16x16x32_bf16 v[24:27], a[180:183], a[212:215], 0
v_mfma_f32_16x16x32_bf16 v[24:27], a[176:179], a[208:211], v[24:27]
buffer_load_dwordx4 a[60:63], v15, s[44:47], s65 offen offset:1024 sc1
v_mfma_f32_16x16x32_bf16 v[28:31], a[184:187], a[208:211], 0
s_waitcnt lgkmcnt(0)
v_mfma_f32_16x16x32_bf16 v[28:31], a[188:191], a[212:215], v[28:31]
v_mfma_f32_16x16x32_bf16 v[60:63], a[188:191], a[220:223], 0
buffer_load_dword v19, off, s[52:55], s72 sc1
v_mfma_f32_16x16x32_bf16 v[60:63], a[184:187], a[216:219], v[60:63]
s_add_u32 s85, s85, 2883584
s_lshl3_add_u32 s85, s68, s85
s_waitcnt vmcnt(24) lgkmcnt(0)
s_barrier
v_mfma_f32_16x16x32_bf16 v[92:95], a[184:187], a[224:227], 0
ds_read_b64_tr_b16 a[144:145], v196 offset:0
v_mfma_f32_16x16x32_bf16 v[92:95], a[188:191], a[228:231], v[92:95]
ds_read_b64_tr_b16 a[146:147], v196 offset:4096
v_mfma_f32_16x16x32_bf16 v[124:127], a[188:191], a[236:239], 0
s_xor_b32 m0, s76, 131072
ds_read_b64_tr_b16 a[148:149], v196 offset:8192
v_mfma_f32_16x16x32_bf16 v[124:127], a[184:187], a[232:235], v[124:127]
s_xor_b32 s64, s85, 0
ds_read_b64_tr_b16 a[150:151], v196 offset:12288
v_mfma_f32_16x16x32_bf16 v[128:131], a[192:195], a[232:235], 0
buffer_load_dwordx4 v12, s[40:43], s64 offen lds
v_mfma_f32_16x16x32_bf16 v[128:131], a[196:199], a[236:239], v[128:131]
s_xor_b32 m0, s76, 132096
ds_read_b64_tr_b16 a[152:153], v197 offset:0
v_mfma_f32_16x16x32_bf16 v[96:99], a[196:199], a[228:231], 0
s_xor_b32 s64, s85, 8192
ds_read_b64_tr_b16 a[154:155], v197 offset:4096
v_mfma_f32_16x16x32_bf16 v[96:99], a[192:195], a[224:227], v[96:99]
buffer_load_dwordx4 v13, s[40:43], s64 offen lds
v_mfma_f32_16x16x32_bf16 v[64:67], a[192:195], a[216:219], 0
s_xor_b32 m0, s76, 133120
ds_read_b64_tr_b16 a[156:157], v197 offset:8192
v_mfma_f32_16x16x32_bf16 v[64:67], a[196:199], a[220:223], v[64:67]
s_xor_b32 s64, s85, 16384
ds_read_b64_tr_b16 a[158:159], v197 offset:12288
v_mfma_f32_16x16x32_bf16 v[32:35], a[196:199], a[212:215], 0
buffer_load_dwordx4 v12, s[40:43], s64 offen lds
v_mfma_f32_16x16x32_bf16 v[32:35], a[192:195], a[208:211], v[32:35]
s_xor_b32 m0, s76, 134144
ds_read_b64_tr_b16 a[160:161], v198 offset:0
v_mfma_f32_16x16x32_bf16 v[36:39], a[200:203], a[208:211], 0
s_xor_b32 s64, s85, 24576
ds_read_b64_tr_b16 a[162:163], v198 offset:4096
v_mfma_f32_16x16x32_bf16 v[36:39], a[204:207], a[212:215], v[36:39]
buffer_load_dwordx4 v13, s[40:43], s64 offen lds
v_mfma_f32_16x16x32_bf16 v[68:71], a[204:207], a[220:223], 0
s_xor_b32 m0, s76, 135168
ds_read_b64_tr_b16 a[164:165], v198 offset:8192
v_mfma_f32_16x16x32_bf16 v[68:71], a[200:203], a[216:219], v[68:71]
s_xor_b32 s64, s85, 32768
ds_read_b64_tr_b16 a[166:167], v198 offset:12288
v_mfma_f32_16x16x32_bf16 v[100:103], a[200:203], a[224:227], 0
buffer_load_dwordx4 v12, s[40:43], s64 offen lds
v_mfma_f32_16x16x32_bf16 v[100:103], a[204:207], a[228:231], v[100:103]
v_mfma_f32_16x16x32_bf16 v[132:135], a[204:207], a[236:239], 0
v_mfma_f32_16x16x32_bf16 v[132:135], a[200:203], a[232:235], v[132:135]
s_waitcnt lgkmcnt(3)
v_mfma_f32_16x16x32_bf16 v[136:139], a[144:147], v[176:179], v[136:139]
s_waitcnt vmcnt(5)
v_readfirstlane_b32 vcc_lo, v19
s_nop 0
s_cmp_lt_u32 vcc_lo, 8
s_cbranch_scc1 L_spin_2016
L_spinbk_2017:
s_sub_u32 s84, s84, 688128
s_add_u32 s84, s84, s69
v_mfma_f32_16x16x32_bf16 v[136:139], a[148:151], v[180:183], v[136:139]
s_xor_b32 m0, s76, 136192
s_xor_b32 s64, s85, 40960
ds_read_b64_tr_b16 a[168:169], v199 offset:0
v_mfma_f32_16x16x32_bf16 v[104:107], a[148:151], v[172:175], v[104:107]
buffer_load_dwordx4 v13, s[40:43], s64 offen lds
v_mfma_f32_16x16x32_bf16 v[104:107], a[144:147], v[168:171], v[104:107]
s_xor_b32 m0, s76, 137216
ds_read_b64_tr_b16 a[170:171], v199 offset:4096
v_mfma_f32_16x16x32_bf16 v[72:75], a[144:147], v[160:163], v[72:75]
s_xor_b32 s64, s85, 49152
ds_read_b64_tr_b16 a[172:173], v199 offset:8192
v_mfma_f32_16x16x32_bf16 v[72:75], a[148:151], v[164:167], v[72:75]
buffer_load_dwordx4 v12, s[40:43], s64 offen lds
v_mfma_f32_16x16x32_bf16 v[40:43], a[148:151], v[156:159], v[40:43]
ds_read_b64_tr_b16 a[174:175], v199 offset:12288
v_mfma_f32_16x16x32_bf16 v[40:43], a[144:147], v[152:155], v[40:43]
s_xor_b32 m0, s76, 138240
ds_read_b64_tr_b16 a[176:177], v192 offset:0
v_mfma_f32_16x16x32_bf16 v[44:47], a[152:155], v[152:155], v[44:47]
s_xor_b32 s64, s85, 57344
ds_read_b64_tr_b16 a[178:179], v192 offset:4096
v_mfma_f32_16x16x32_bf16 v[44:47], a[156:159], v[156:159], v[44:47]
buffer_load_dwordx4 v13, s[40:43], s64 offen lds
v_mfma_f32_16x16x32_bf16 v[76:79], a[156:159], v[164:167], v[76:79]
ds_read_b64_tr_b16 a[180:181], v192 offset:8192
v_mfma_f32_16x16x32_bf16 v[76:79], a[152:155], v[160:163], v[76:79]
s_xor_b32 s65, s84, 0
ds_read_b64_tr_b16 a[182:183], v192 offset:12288
v_mfma_f32_16x16x32_bf16 v[108:111], a[152:155], v[168:171], v[108:111]
buffer_load_dwordx4 a[208:211], v14, s[44:47], s65 offen offset:0 sc1
v_mfma_f32_16x16x32_bf16 v[108:111], a[156:159], v[172:175], v[108:111]
ds_read_b64_tr_b16 a[184:185], v193 offset:0
v_mfma_f32_16x16x32_bf16 v[140:143], a[156:159], v[180:183], v[140:143]
ds_read_b64_tr_b16 a[186:187], v193 offset:4096
v_mfma_f32_16x16x32_bf16 v[140:143], a[152:155], v[176:179], v[140:143]
s_waitcnt lgkmcnt(5)
ds_read_b64_tr_b16 a[188:189], v193 offset:8192
v_mfma_f32_16x16x32_bf16 v[144:147], a[160:163], v[176:179], v[144:147]
buffer_load_dwordx4 a[216:219], v14, s[44:47], s65 offen offset:1024 sc1
v_mfma_f32_16x16x32_bf16 v[144:147], a[164:167], v[180:183], v[144:147]
ds_read_b64_tr_b16 a[190:191], v193 offset:12288
v_mfma_f32_16x16x32_bf16 v[112:115], a[164:167], v[172:175], v[112:115]
ds_read_b64_tr_b16 a[192:193], v194 offset:0
v_mfma_f32_16x16x32_bf16 v[112:115], a[160:163], v[168:171], v[112:115]
ds_read_b64_tr_b16 a[194:195], v194 offset:4096
v_mfma_f32_16x16x32_bf16 v[80:83], a[160:163], v[160:163], v[80:83]
buffer_load_dwordx4 a[224:227], v15, s[44:47], s65 offen offset:0 sc1
v_mfma_f32_16x16x32_bf16 v[80:83], a[164:167], v[164:167], v[80:83]
ds_read_b64_tr_b16 a[196:197], v194 offset:8192
v_mfma_f32_16x16x32_bf16 v[48:51], a[164:167], v[156:159], v[48:51]
ds_read_b64_tr_b16 a[198:199], v194 offset:12288
v_mfma_f32_16x16x32_bf16 v[48:51], a[160:163], v[152:155], v[48:51]
buffer_load_dwordx4 a[232:235], v15, s[44:47], s65 offen offset:1024 sc1
v_mfma_f32_16x16x32_bf16 v[52:55], a[168:171], v[152:155], v[52:55]
v_mfma_f32_16x16x32_bf16 v[52:55], a[172:175], v[156:159], v[52:55]
v_mfma_f32_16x16x32_bf16 v[84:87], a[172:175], v[164:167], v[84:87]
s_xor_b32 s65, s84, 8192
ds_read_b64_tr_b16 a[200:201], v195 offset:0
v_mfma_f32_16x16x32_bf16 v[84:87], a[168:171], v[160:163], v[84:87]
buffer_load_dwordx4 a[212:215], v14, s[44:47], s65 offen offset:0 sc1
v_mfma_f32_16x16x32_bf16 v[116:119], a[168:171], v[168:171], v[116:119]
ds_read_b64_tr_b16 a[202:203], v195 offset:4096
v_mfma_f32_16x16x32_bf16 v[116:119], a[172:175], v[172:175], v[116:119]
ds_read_b64_tr_b16 a[204:205], v195 offset:8192
v_mfma_f32_16x16x32_bf16 v[148:151], a[172:175], v[180:183], v[148:151]
ds_read_b64_tr_b16 a[206:207], v195 offset:12288
v_mfma_f32_16x16x32_bf16 v[148:151], a[168:171], v[176:179], v[148:151]
s_waitcnt lgkmcnt(4)
s_lshl_b32 s66, s30, 30
buffer_load_dwordx4 a[220:223], v14, s[44:47], s65 offen offset:1024 sc1
v_mfma_f32_16x16x32_bf16 v[120:123], a[176:179], v[176:179], v[120:123]
v_lshl_add_u32 v1, v0, 24, s66
v_mfma_f32_16x16x32_bf16 v[120:123], a[180:183], v[180:183], v[120:123]
v_mfma_f32_16x16x32_bf16 v[88:91], a[180:183], v[172:175], v[88:91]
buffer_load_dwordx4 a[228:231], v15, s[44:47], s65 offen offset:0 sc1
v_mfma_f32_16x16x32_bf16 v[88:91], a[176:179], v[168:171], v[88:91]
v_mfma_f32_16x16x32_bf16 v[56:59], a[176:179], v[160:163], v[56:59]
v_mfma_f32_16x16x32_bf16 v[56:59], a[180:183], v[164:167], v[56:59]
v_mfma_f32_16x16x32_bf16 v[24:27], a[180:183], v[156:159], v[24:27]
buffer_load_dwordx4 a[236:239], v15, s[44:47], s65 offen offset:1024 sc1
v_mfma_f32_16x16x32_bf16 v[24:27], a[176:179], v[152:155], v[24:27]
v_mfma_f32_16x16x32_bf16 v[28:31], a[184:187], v[152:155], v[28:31]
v_mfma_f32_16x16x32_bf16 v[28:31], a[188:191], v[156:159], v[28:31]
v_mfma_f32_16x16x32_bf16 v[60:63], a[188:191], v[164:167], v[60:63]
v_mfma_f32_16x16x32_bf16 v[60:63], a[184:187], v[160:163], v[60:63]
s_waitcnt lgkmcnt(0)
s_barrier
v_mfma_f32_16x16x32_bf16 v[92:95], a[184:187], v[168:171], v[92:95]
s_mov_b64 exec, 1
buffer_atomic_add a251, v1, s[52:55], s71 offen offset:0 sc1
s_mov_b64 exec, -1
v_mfma_f32_16x16x32_bf16 v[92:95], a[188:191], v[172:175], v[92:95]
ds_read_b64_tr_b16 a[144:145], v188 offset:0
v_mfma_f32_16x16x32_bf16 v[124:127], a[188:191], v[180:183], v[124:127]
s_xor_b32 m0, s76, 32768
ds_read_b64_tr_b16 a[146:147], v188 offset:4096
v_mfma_f32_16x16x32_bf16 v[124:127], a[184:187], v[176:179], v[124:127]
s_xor_b32 s64, s85, 262144
ds_read_b64_tr_b16 a[148:149], v188 offset:8192
v_mfma_f32_16x16x32_bf16 v[128:131], a[192:195], v[176:179], v[128:131]
buffer_load_dwordx4 v12, s[40:43], s64 offen lds
v_mfma_f32_16x16x32_bf16 v[128:131], a[196:199], v[180:183], v[128:131]
s_xor_b32 m0, s76, 33792
ds_read_b64_tr_b16 a[150:151], v188 offset:12288
v_mfma_f32_16x16x32_bf16 v[96:99], a[196:199], v[172:175], v[96:99]
s_xor_b32 s64, s85, 270336
ds_read_b64_tr_b16 a[152:153], v189 offset:0
v_mfma_f32_16x16x32_bf16 v[96:99], a[192:195], v[168:171], v[96:99]
buffer_load_dwordx4 v13, s[40:43], s64 offen lds
v_mfma_f32_16x16x32_bf16 v[64:67], a[192:195], v[160:163], v[64:67]
s_xor_b32 m0, s76, 34816
ds_read_b64_tr_b16 a[154:155], v189 offset:4096
v_mfma_f32_16x16x32_bf16 v[64:67], a[196:199], v[164:167], v[64:67]
s_xor_b32 s64, s85, 278528
ds_read_b64_tr_b16 a[156:157], v189 offset:8192
v_mfma_f32_16x16x32_bf16 v[32:35], a[196:199], v[156:159], v[32:35]
buffer_load_dwordx4 v12, s[40:43], s64 offen lds
v_mfma_f32_16x16x32_bf16 v[32:35], a[192:195], v[152:155], v[32:35]
s_xor_b32 m0, s76, 35840
ds_read_b64_tr_b16 a[158:159], v189 offset:12288
v_mfma_f32_16x16x32_bf16 v[36:39], a[200:203], v[152:155], v[36:39]
s_xor_b32 s64, s85, 286720
ds_read_b64_tr_b16 a[160:161], v190 offset:0
v_mfma_f32_16x16x32_bf16 v[36:39], a[204:207], v[156:159], v[36:39]
buffer_load_dwordx4 v13, s[40:43], s64 offen lds
v_mfma_f32_16x16x32_bf16 v[68:71], a[204:207], v[164:167], v[68:71]
s_xor_b32 m0, s76, 36864
ds_read_b64_tr_b16 a[162:163], v190 offset:4096
v_mfma_f32_16x16x32_bf16 v[68:71], a[200:203], v[160:163], v[68:71]
s_xor_b32 s64, s85, 294912
ds_read_b64_tr_b16 a[164:165], v190 offset:8192
v_mfma_f32_16x16x32_bf16 v[100:103], a[200:203], v[168:171], v[100:103]
buffer_load_dwordx4 v12, s[40:43], s64 offen lds
v_mfma_f32_16x16x32_bf16 v[100:103], a[204:207], v[172:175], v[100:103]
ds_read_b64_tr_b16 a[166:167], v190 offset:12288
v_mfma_f32_16x16x32_bf16 v[132:135], a[204:207], v[180:183], v[132:135]
v_mfma_f32_16x16x32_bf16 v[132:135], a[200:203], v[176:179], v[132:135]
s_waitcnt lgkmcnt(4)
v_mfma_f32_16x16x32_bf16 v[136:139], a[144:147], a[56:59], v[136:139]
s_xor_b32 m0, s76, 37888
ds_read_b64_tr_b16 a[168:169], v191 offset:0
v_mfma_f32_16x16x32_bf16 v[136:139], a[148:151], a[60:63], v[136:139]
s_xor_b32 s64, s85, 303104
ds_read_b64_tr_b16 a[170:171], v191 offset:4096
v_mfma_f32_16x16x32_bf16 v[104:107], a[148:151], a[52:55], v[104:107]
buffer_load_dwordx4 v13, s[40:43], s64 offen lds
v_mfma_f32_16x16x32_bf16 v[104:107], a[144:147], a[48:51], v[104:107]
s_xor_b32 m0, s76, 38912
ds_read_b64_tr_b16 a[172:173], v191 offset:8192
v_mfma_f32_16x16x32_bf16 v[72:75], a[144:147], a[40:43], v[72:75]
s_xor_b32 s64, s85, 311296
ds_read_b64_tr_b16 a[174:175], v191 offset:12288
v_mfma_f32_16x16x32_bf16 v[72:75], a[148:151], a[44:47], v[72:75]
buffer_load_dwordx4 v12, s[40:43], s64 offen lds
v_mfma_f32_16x16x32_bf16 v[40:43], a[148:151], a[36:39], v[40:43]
ds_read_b64_tr_b16 a[176:177], v184 offset:0
v_mfma_f32_16x16x32_bf16 v[40:43], a[144:147], a[32:35], v[40:43]
s_xor_b32 m0, s76, 39936
ds_read_b64_tr_b16 a[178:179], v184 offset:4096
v_mfma_f32_16x16x32_bf16 v[44:47], a[152:155], a[32:35], v[44:47]
s_xor_b32 s64, s85, 319488
ds_read_b64_tr_b16 a[180:181], v184 offset:8192
v_mfma_f32_16x16x32_bf16 v[44:47], a[156:159], a[36:39], v[44:47]
buffer_load_dwordx4 v13, s[40:43], s64 offen lds
v_mfma_f32_16x16x32_bf16 v[76:79], a[156:159], a[44:47], v[76:79]
ds_read_b64_tr_b16 a[182:183], v184 offset:12288
v_mfma_f32_16x16x32_bf16 v[76:79], a[152:155], a[40:43], v[76:79]
s_xor_b32 s65, s84, 32768
ds_read_b64_tr_b16 a[184:185], v185 offset:0
v_mfma_f32_16x16x32_bf16 v[108:111], a[152:155], a[48:51], v[108:111]
buffer_load_dwordx4 v[152:155], v14, s[44:47], s65 offen offset:0 sc1
v_mfma_f32_16x16x32_bf16 v[108:111], a[156:159], a[52:55], v[108:111]
ds_read_b64_tr_b16 a[186:187], v185 offset:4096
v_mfma_f32_16x16x32_bf16 v[140:143], a[156:159], a[60:63], v[140:143]
ds_read_b64_tr_b16 a[188:189], v185 offset:8192
v_mfma_f32_16x16x32_bf16 v[140:143], a[152:155], a[56:59], v[140:143]
s_waitcnt lgkmcnt(5)
ds_read_b64_tr_b16 a[190:191], v185 offset:12288
v_mfma_f32_16x16x32_bf16 v[144:147], a[160:163], a[56:59], v[144:147]
buffer_load_dwordx4 v[160:163], v14, s[44:47], s65 offen offset:1024 sc1
v_mfma_f32_16x16x32_bf16 v[144:147], a[164:167], a[60:63], v[144:147]
v_mfma_f32_16x16x32_bf16 v[112:115], a[164:167], a[52:55], v[112:115]
ds_read_b64_tr_b16 a[192:193], v186 offset:0
v_mfma_f32_16x16x32_bf16 v[112:115], a[160:163], a[48:51], v[112:115]
ds_read_b64_tr_b16 a[194:195], v186 offset:4096
v_mfma_f32_16x16x32_bf16 v[80:83], a[160:163], a[40:43], v[80:83]
buffer_load_dwordx4 v[168:171], v15, s[44:47], s65 offen offset:0 sc1
v_mfma_f32_16x16x32_bf16 v[80:83], a[164:167], a[44:47], v[80:83]
ds_read_b64_tr_b16 a[196:197], v186 offset:8192
v_mfma_f32_16x16x32_bf16 v[48:51], a[164:167], a[36:39], v[48:51]
ds_read_b64_tr_b16 a[198:199], v186 offset:12288
v_mfma_f32_16x16x32_bf16 v[48:51], a[160:163], a[32:35], v[48:51]
buffer_load_dwordx4 v[176:179], v15, s[44:47], s65 offen offset:1024 sc1
v_mfma_f32_16x16x32_bf16 v[52:55], a[168:171], a[32:35], v[52:55]
v_mfma_f32_16x16x32_bf16 v[52:55], a[172:175], a[36:39], v[52:55]
v_mfma_f32_16x16x32_bf16 v[84:87], a[172:175], a[44:47], v[84:87]
s_xor_b32 s65, s84, 40960
ds_read_b64_tr_b16 a[200:201], v187 offset:0
v_mfma_f32_16x16x32_bf16 v[84:87], a[168:171], a[40:43], v[84:87]
buffer_load_dwordx4 v[156:159], v14, s[44:47], s65 offen offset:0 sc1
v_mfma_f32_16x16x32_bf16 v[116:119], a[168:171], a[48:51], v[116:119]
ds_read_b64_tr_b16 a[202:203], v187 offset:4096
v_mfma_f32_16x16x32_bf16 v[116:119], a[172:175], a[52:55], v[116:119]
ds_read_b64_tr_b16 a[204:205], v187 offset:8192
v_mfma_f32_16x16x32_bf16 v[148:151], a[172:175], a[60:63], v[148:151]
ds_read_b64_tr_b16 a[206:207], v187 offset:12288
v_mfma_f32_16x16x32_bf16 v[148:151], a[168:171], a[56:59], v[148:151]
buffer_load_dwordx4 v[164:167], v14, s[44:47], s65 offen offset:1024 sc1
v_mfma_f32_16x16x32_bf16 v[120:123], a[176:179], a[56:59], v[120:123]
s_waitcnt lgkmcnt(4)
v_mfma_f32_16x16x32_bf16 v[120:123], a[180:183], a[60:63], v[120:123]
v_mfma_f32_16x16x32_bf16 v[88:91], a[180:183], a[52:55], v[88:91]
buffer_load_dwordx4 v[172:175], v15, s[44:47], s65 offen offset:0 sc1
v_mfma_f32_16x16x32_bf16 v[88:91], a[176:179], a[48:51], v[88:91]
v_mfma_f32_16x16x32_bf16 v[56:59], a[176:179], a[40:43], v[56:59]
v_mfma_f32_16x16x32_bf16 v[56:59], a[180:183], a[44:47], v[56:59]
v_mfma_f32_16x16x32_bf16 v[24:27], a[180:183], a[36:39], v[24:27]
buffer_load_dwordx4 v[180:183], v15, s[44:47], s65 offen offset:1024 sc1
v_mfma_f32_16x16x32_bf16 v[24:27], a[176:179], a[32:35], v[24:27]
v_mfma_f32_16x16x32_bf16 v[28:31], a[184:187], a[32:35], v[28:31]
v_mfma_f32_16x16x32_bf16 v[28:31], a[188:191], a[36:39], v[28:31]
v_mfma_f32_16x16x32_bf16 v[60:63], a[188:191], a[44:47], v[60:63]
v_mfma_f32_16x16x32_bf16 v[60:63], a[184:187], a[40:43], v[60:63]
s_waitcnt vmcnt(25)
s_barrier
v_mfma_f32_16x16x32_bf16 v[92:95], a[184:187], a[48:51], v[92:95]
ds_read_b64_tr_b16 a[144:145], v188 offset:32768
v_mfma_f32_16x16x32_bf16 v[92:95], a[188:191], a[52:55], v[92:95]
ds_read_b64_tr_b16 a[146:147], v188 offset:36864
v_mfma_f32_16x16x32_bf16 v[124:127], a[188:191], a[60:63], v[124:127]
s_xor_b32 m0, s76, 65536
ds_read_b64_tr_b16 a[148:149], v188 offset:40960
v_mfma_f32_16x16x32_bf16 v[124:127], a[184:187], a[56:59], v[124:127]
s_xor_b32 s64, s85, 524288
ds_read_b64_tr_b16 a[150:151], v188 offset:45056
v_mfma_f32_16x16x32_bf16 v[128:131], a[192:195], a[56:59], v[128:131]
buffer_load_dwordx4 v12, s[40:43], s64 offen lds
v_mfma_f32_16x16x32_bf16 v[128:131], a[196:199], a[60:63], v[128:131]
s_xor_b32 m0, s76, 66560
ds_read_b64_tr_b16 a[152:153], v189 offset:32768
v_mfma_f32_16x16x32_bf16 v[96:99], a[196:199], a[52:55], v[96:99]
s_xor_b32 s64, s85, 532480
ds_read_b64_tr_b16 a[154:155], v189 offset:36864
v_mfma_f32_16x16x32_bf16 v[96:99], a[192:195], a[48:51], v[96:99]
buffer_load_dwordx4 v13, s[40:43], s64 offen lds
v_mfma_f32_16x16x32_bf16 v[64:67], a[192:195], a[40:43], v[64:67]
s_xor_b32 m0, s76, 67584
ds_read_b64_tr_b16 a[156:157], v189 offset:40960
v_mfma_f32_16x16x32_bf16 v[64:67], a[196:199], a[44:47], v[64:67]
s_xor_b32 s64, s85, 540672
ds_read_b64_tr_b16 a[158:159], v189 offset:45056
v_mfma_f32_16x16x32_bf16 v[32:35], a[196:199], a[36:39], v[32:35]
buffer_load_dwordx4 v12, s[40:43], s64 offen lds
v_mfma_f32_16x16x32_bf16 v[32:35], a[192:195], a[32:35], v[32:35]
s_waitcnt lgkmcnt(4)
s_xor_b32 m0, s76, 68608
ds_read_b64_tr_b16 a[160:161], v190 offset:32768
v_mfma_f32_16x16x32_bf16 v[36:39], a[200:203], a[32:35], v[36:39]
s_xor_b32 s64, s85, 548864
ds_read_b64_tr_b16 a[162:163], v190 offset:36864
v_mfma_f32_16x16x32_bf16 v[36:39], a[204:207], a[36:39], v[36:39]
buffer_load_dwordx4 v13, s[40:43], s64 offen lds
v_mfma_f32_16x16x32_bf16 v[68:71], a[204:207], a[44:47], v[68:71]
s_xor_b32 m0, s76, 69632
ds_read_b64_tr_b16 a[164:165], v190 offset:40960
v_mfma_f32_16x16x32_bf16 v[68:71], a[200:203], a[40:43], v[68:71]
s_xor_b32 s64, s85, 557056
ds_read_b64_tr_b16 a[166:167], v190 offset:45056
v_mfma_f32_16x16x32_bf16 v[100:103], a[200:203], a[48:51], v[100:103]
buffer_load_dwordx4 v12, s[40:43], s64 offen lds
v_mfma_f32_16x16x32_bf16 v[100:103], a[204:207], a[52:55], v[100:103]
s_mov_b32 s70, 3
s_mov_b32 s73, 2
v_mfma_f32_16x16x32_bf16 v[132:135], a[204:207], a[60:63], v[132:135]
v_mfma_f32_16x16x32_bf16 v[132:135], a[200:203], a[56:59], v[132:135]
s_branch L_p5join
.p2align 12
L_pg21:
s_branch L_pg25
L_p5join:
L_p5loop:
s_waitcnt lgkmcnt(10)
s_waitcnt vmcnt(19)
v_mfma_f32_16x16x32_bf16 v[136:139], a[144:147], a[232:235], v[136:139]
s_waitcnt vmcnt(15)
s_waitcnt lgkmcnt(8)
s_xor_b32 m0, s76, 70656
s_xor_b32 s64, s85, 565248
ds_read_b64_tr_b16 a[168:169], v191 offset:32768
v_mfma_f32_16x16x32_bf16 v[136:139], a[148:151], a[236:239], v[136:139]
buffer_load_dwordx4 v13, s[40:43], s64 offen lds
v_mfma_f32_16x16x32_bf16 v[104:107], a[148:151], a[228:231], v[104:107]
ds_read_b64_tr_b16 a[170:171], v191 offset:36864
v_mfma_f32_16x16x32_bf16 v[104:107], a[144:147], a[224:227], v[104:107]
s_xor_b32 m0, s76, 71680
ds_read_b64_tr_b16 a[172:173], v191 offset:40960
v_mfma_f32_16x16x32_bf16 v[72:75], a[144:147], a[216:219], v[72:75]
s_xor_b32 s64, s85, 573440
ds_read_b64_tr_b16 a[174:175], v191 offset:45056
v_mfma_f32_16x16x32_bf16 v[72:75], a[148:151], a[220:223], v[72:75]
buffer_load_dwordx4 v12, s[40:43], s64 offen lds
v_mfma_f32_16x16x32_bf16 v[40:43], a[148:151], a[212:215], v[40:43]
ds_read_b64_tr_b16 a[176:177], v184 offset:32768
v_mfma_f32_16x16x32_bf16 v[40:43], a[144:147], a[208:211], v[40:43]
s_waitcnt lgkmcnt(5)
s_xor_b32 m0, s76, 72704
ds_read_b64_tr_b16 a[178:179], v184 offset:36864
v_mfma_f32_16x16x32_bf16 v[44:47], a[152:155], a[208:211], v[44:47]
s_xor_b32 s64, s85, 581632
ds_read_b64_tr_b16 a[180:181], v184 offset:40960
v_mfma_f32_16x16x32_bf16 v[44:47], a[156:159], a[212:215], v[44:47]
buffer_load_dwordx4 v13, s[40:43], s64 offen lds
v_mfma_f32_16x16x32_bf16 v[76:79], a[156:159], a[220:223], v[76:79]
ds_read_b64_tr_b16 a[182:183], v184 offset:45056
v_mfma_f32_16x16x32_bf16 v[76:79], a[152:155], a[216:219], v[76:79]
ds_read_b64_tr_b16 a[184:185], v185 offset:32768
v_mfma_f32_16x16x32_bf16 v[108:111], a[152:155], a[224:227], v[108:111]
s_xor_b32 s65, s84, 65536
ds_read_b64_tr_b16 a[186:187], v185 offset:36864
v_mfma_f32_16x16x32_bf16 v[108:111], a[156:159], a[228:231], v[108:111]
buffer_load_dwordx4 a[0:3], v14, s[44:47], s65 offen offset:0 sc1
v_mfma_f32_16x16x32_bf16 v[140:143], a[156:159], a[236:239], v[140:143]
ds_read_b64_tr_b16 a[188:189], v185 offset:40960
v_mfma_f32_16x16x32_bf16 v[140:143], a[152:155], a[232:235], v[140:143]
ds_read_b64_tr_b16 a[190:191], v185 offset:45056
v_mfma_f32_16x16x32_bf16 v[144:147], a[160:163], a[232:235], v[144:147]
v_mfma_f32_16x16x32_bf16 v[144:147], a[164:167], a[236:239], v[144:147]
buffer_load_dwordx4 a[8:11], v14, s[44:47], s65 offen offset:1024 sc1
v_mfma_f32_16x16x32_bf16 v[112:115], a[164:167], a[228:231], v[112:115]
ds_read_b64_tr_b16 a[192:193], v186 offset:32768
v_mfma_f32_16x16x32_bf16 v[112:115], a[160:163], a[224:227], v[112:115]
ds_read_b64_tr_b16 a[194:195], v186 offset:36864
v_mfma_f32_16x16x32_bf16 v[80:83], a[160:163], a[216:219], v[80:83]
ds_read_b64_tr_b16 a[196:197], v186 offset:40960
v_mfma_f32_16x16x32_bf16 v[80:83], a[164:167], a[220:223], v[80:83]
buffer_load_dwordx4 a[16:19], v15, s[44:47], s65 offen offset:0 sc1
v_mfma_f32_16x16x32_bf16 v[48:51], a[164:167], a[212:215], v[48:51]
ds_read_b64_tr_b16 a[198:199], v186 offset:45056
v_mfma_f32_16x16x32_bf16 v[48:51], a[160:163], a[208:211], v[48:51]
s_waitcnt lgkmcnt(4)
v_mfma_f32_16x16x32_bf16 v[52:55], a[168:171], a[208:211], v[52:55]
v_mfma_f32_16x16x32_bf16 v[52:55], a[172:175], a[212:215], v[52:55]
buffer_load_dwordx4 a[24:27], v15, s[44:47], s65 offen offset:1024 sc1
v_mfma_f32_16x16x32_bf16 v[84:87], a[172:175], a[220:223], v[84:87]
ds_read_b64_tr_b16 a[200:201], v187 offset:32768
v_mfma_f32_16x16x32_bf16 v[84:87], a[168:171], a[216:219], v[84:87]
ds_read_b64_tr_b16 a[202:203], v187 offset:36864
v_mfma_f32_16x16x32_bf16 v[116:119], a[168:171], a[224:227], v[116:119]
s_xor_b32 s65, s84, 73728
ds_read_b64_tr_b16 a[204:205], v187 offset:40960
v_mfma_f32_16x16x32_bf16 v[116:119], a[172:175], a[228:231], v[116:119]
buffer_load_dwordx4 a[4:7], v14, s[44:47], s65 offen offset:0 sc1
v_mfma_f32_16x16x32_bf16 v[148:151], a[172:175], a[236:239], v[148:151]
ds_read_b64_tr_b16 a[206:207], v187 offset:45056
v_mfma_f32_16x16x32_bf16 v[148:151], a[168:171], a[232:235], v[148:151]
v_mfma_f32_16x16x32_bf16 v[120:123], a[176:179], a[232:235], v[120:123]
v_mfma_f32_16x16x32_bf16 v[120:123], a[180:183], a[236:239], v[120:123]
buffer_load_dwordx4 a[12:15], v14, s[44:47], s65 offen offset:1024 sc1
v_mfma_f32_16x16x32_bf16 v[88:91], a[180:183], a[228:231], v[88:91]
v_mfma_f32_16x16x32_bf16 v[88:91], a[176:179], a[224:227], v[88:91]
v_mfma_f32_16x16x32_bf16 v[56:59], a[176:179], a[216:219], v[56:59]
v_mfma_f32_16x16x32_bf16 v[56:59], a[180:183], a[220:223], v[56:59]
buffer_load_dwordx4 a[20:23], v15, s[44:47], s65 offen offset:0 sc1
v_mfma_f32_16x16x32_bf16 v[24:27], a[180:183], a[212:215], v[24:27]
v_mfma_f32_16x16x32_bf16 v[24:27], a[176:179], a[208:211], v[24:27]
v_mfma_f32_16x16x32_bf16 v[28:31], a[184:187], a[208:211], v[28:31]
v_mfma_f32_16x16x32_bf16 v[28:31], a[188:191], a[212:215], v[28:31]
buffer_load_dwordx4 a[28:31], v15, s[44:47], s65 offen offset:1024 sc1
v_mfma_f32_16x16x32_bf16 v[60:63], a[188:191], a[220:223], v[60:63]
v_mfma_f32_16x16x32_bf16 v[60:63], a[184:187], a[216:219], v[60:63]
s_waitcnt vmcnt(24)
s_barrier
v_mfma_f32_16x16x32_bf16 v[92:95], a[184:187], a[224:227], v[92:95]
s_xor_b32 m0, s76, 98304
ds_read_b64_tr_b16 a[144:145], v196 offset:0
v_mfma_f32_16x16x32_bf16 v[92:95], a[188:191], a[228:231], v[92:95]
s_xor_b32 s64, s85, 786432
ds_read_b64_tr_b16 a[146:147], v196 offset:4096
v_mfma_f32_16x16x32_bf16 v[124:127], a[188:191], a[236:239], v[124:127]
buffer_load_dwordx4 v12, s[40:43], s64 offen lds
v_mfma_f32_16x16x32_bf16 v[124:127], a[184:187], a[232:235], v[124:127]
s_waitcnt lgkmcnt(2)
s_xor_b32 m0, s76, 99328
ds_read_b64_tr_b16 a[148:149], v196 offset:8192
v_mfma_f32_16x16x32_bf16 v[128:131], a[192:195], a[232:235], v[128:131]
s_xor_b32 s64, s85, 794624
ds_read_b64_tr_b16 a[150:151], v196 offset:12288
v_mfma_f32_16x16x32_bf16 v[128:131], a[196:199], a[236:239], v[128:131]
buffer_load_dwordx4 v13, s[40:43], s64 offen lds
v_mfma_f32_16x16x32_bf16 v[96:99], a[196:199], a[228:231], v[96:99]
ds_read_b64_tr_b16 a[152:153], v197 offset:0
v_mfma_f32_16x16x32_bf16 v[96:99], a[192:195], a[224:227], v[96:99]
s_xor_b32 m0, s76, 100352
ds_read_b64_tr_b16 a[154:155], v197 offset:4096
v_mfma_f32_16x16x32_bf16 v[64:67], a[192:195], a[216:219], v[64:67]
s_xor_b32 s64, s85, 802816
ds_read_b64_tr_b16 a[156:157], v197 offset:8192
v_mfma_f32_16x16x32_bf16 v[64:67], a[196:199], a[220:223], v[64:67]
buffer_load_dwordx4 v12, s[40:43], s64 offen lds
v_mfma_f32_16x16x32_bf16 v[32:35], a[196:199], a[212:215], v[32:35]
ds_read_b64_tr_b16 a[158:159], v197 offset:12288
v_mfma_f32_16x16x32_bf16 v[32:35], a[192:195], a[208:211], v[32:35]
s_xor_b32 m0, s76, 101376
ds_read_b64_tr_b16 a[160:161], v198 offset:0
v_mfma_f32_16x16x32_bf16 v[36:39], a[200:203], a[208:211], v[36:39]
s_xor_b32 s64, s85, 811008
ds_read_b64_tr_b16 a[162:163], v198 offset:4096
v_mfma_f32_16x16x32_bf16 v[36:39], a[204:207], a[212:215], v[36:39]
buffer_load_dwordx4 v13, s[40:43], s64 offen lds
v_mfma_f32_16x16x32_bf16 v[68:71], a[204:207], a[220:223], v[68:71]
ds_read_b64_tr_b16 a[164:165], v198 offset:8192
v_mfma_f32_16x16x32_bf16 v[68:71], a[200:203], a[216:219], v[68:71]
s_xor_b32 m0, s76, 102400
ds_read_b64_tr_b16 a[166:167], v198 offset:12288
v_mfma_f32_16x16x32_bf16 v[100:103], a[200:203], a[224:227], v[100:103]
s_xor_b32 s64, s85, 819200
v_mfma_f32_16x16x32_bf16 v[100:103], a[204:207], a[228:231], v[100:103]
buffer_load_dwordx4 v12, s[40:43], s64 offen lds
v_mfma_f32_16x16x32_bf16 v[132:135], a[204:207], a[236:239], v[132:135]
v_mfma_f32_16x16x32_bf16 v[132:135], a[200:203], a[232:235], v[132:135]
s_waitcnt vmcnt(25)
s_waitcnt lgkmcnt(3)
s_xor_b32 m0, s76, 103424
buffer_load_dword v19, off, s[52:55], s72 offset:128 sc1
v_mfma_f32_16x16x32_bf16 v[136:139], a[144:147], v[176:179], v[136:139]
s_waitcnt vmcnt(22)
s_xor_b32 s64, s85, 827392
ds_read_b64_tr_b16 a[168:169], v199 offset:0
v_mfma_f32_16x16x32_bf16 v[136:139], a[148:151], v[180:183], v[136:139]
buffer_load_dwordx4 v13, s[40:43], s64 offen lds
v_mfma_f32_16x16x32_bf16 v[104:107], a[148:151], v[172:175], v[104:107]
ds_read_b64_tr_b16 a[170:171], v199 offset:4096
v_mfma_f32_16x16x32_bf16 v[104:107], a[144:147], v[168:171], v[104:107]
s_xor_b32 m0, s76, 104448
ds_read_b64_tr_b16 a[172:173], v199 offset:8192
v_mfma_f32_16x16x32_bf16 v[72:75], a[144:147], v[160:163], v[72:75]
s_xor_b32 s64, s85, 835584
ds_read_b64_tr_b16 a[174:175], v199 offset:12288
v_mfma_f32_16x16x32_bf16 v[72:75], a[148:151], v[164:167], v[72:75]
buffer_load_dwordx4 v12, s[40:43], s64 offen lds
v_mfma_f32_16x16x32_bf16 v[40:43], a[148:151], v[156:159], v[40:43]
ds_read_b64_tr_b16 a[176:177], v192 offset:0
v_mfma_f32_16x16x32_bf16 v[40:43], a[144:147], v[152:155], v[40:43]
s_xor_b32 m0, s76, 105472
ds_read_b64_tr_b16 a[178:179], v192 offset:4096
v_mfma_f32_16x16x32_bf16 v[44:47], a[152:155], v[152:155], v[44:47]
s_xor_b32 s64, s85, 843776
ds_read_b64_tr_b16 a[180:181], v192 offset:8192
v_mfma_f32_16x16x32_bf16 v[44:47], a[156:159], v[156:159], v[44:47]
buffer_load_dwordx4 v13, s[40:43], s64 offen lds
v_mfma_f32_16x16x32_bf16 v[76:79], a[156:159], v[164:167], v[76:79]
ds_read_b64_tr_b16 a[182:183], v192 offset:12288
v_mfma_f32_16x16x32_bf16 v[76:79], a[152:155], v[160:163], v[76:79]
ds_read_b64_tr_b16 a[184:185], v193 offset:0
v_mfma_f32_16x16x32_bf16 v[108:111], a[152:155], v[168:171], v[108:111]
s_xor_b32 s65, s84, 98304
ds_read_b64_tr_b16 a[186:187], v193 offset:4096
v_mfma_f32_16x16x32_bf16 v[108:111], a[156:159], v[172:175], v[108:111]
buffer_load_dwordx4 a[32:35], v14, s[44:47], s65 offen offset:0 sc1
v_mfma_f32_16x16x32_bf16 v[140:143], a[156:159], v[180:183], v[140:143]
ds_read_b64_tr_b16 a[188:189], v193 offset:8192
v_mfma_f32_16x16x32_bf16 v[140:143], a[152:155], v[176:179], v[140:143]
s_waitcnt lgkmcnt(5)
ds_read_b64_tr_b16 a[190:191], v193 offset:12288
v_mfma_f32_16x16x32_bf16 v[144:147], a[160:163], v[176:179], v[144:147]
s_lshl_b32 s75, s73, 20
s_add_u32 s85, s85, s75
s_lshr_b32 s74, s73, 28
v_mfma_f32_16x16x32_bf16 v[144:147], a[164:167], v[180:183], v[144:147]
s_and_b32 s74, s74, 8
buffer_load_dwordx4 a[40:43], v14, s[44:47], s65 offen offset:1024 sc1
v_mfma_f32_16x16x32_bf16 v[112:115], a[164:167], v[172:175], v[112:115]
ds_read_b64_tr_b16 a[192:193], v194 offset:0
v_mfma_f32_16x16x32_bf16 v[112:115], a[160:163], v[168:171], v[112:115]
ds_read_b64_tr_b16 a[194:195], v194 offset:4096
v_mfma_f32_16x16x32_bf16 v[80:83], a[160:163], v[160:163], v[80:83]
ds_read_b64_tr_b16 a[196:197], v194 offset:8192
v_mfma_f32_16x16x32_bf16 v[80:83], a[164:167], v[164:167], v[80:83]
buffer_load_dwordx4 a[48:51], v15, s[44:47], s65 offen offset:0 sc1
v_mfma_f32_16x16x32_bf16 v[48:51], a[164:167], v[156:159], v[48:51]
ds_read_b64_tr_b16 a[198:199], v194 offset:12288
v_mfma_f32_16x16x32_bf16 v[48:51], a[160:163], v[152:155], v[48:51]
v_mfma_f32_16x16x32_bf16 v[52:55], a[168:171], v[152:155], v[52:55]
v_mfma_f32_16x16x32_bf16 v[52:55], a[172:175], v[156:159], v[52:55]
buffer_load_dwordx4 a[56:59], v15, s[44:47], s65 offen offset:1024 sc1
v_mfma_f32_16x16x32_bf16 v[84:87], a[172:175], v[164:167], v[84:87]
ds_read_b64_tr_b16 a[200:201], v195 offset:0
v_mfma_f32_16x16x32_bf16 v[84:87], a[168:171], v[160:163], v[84:87]
ds_read_b64_tr_b16 a[202:203], v195 offset:4096
v_mfma_f32_16x16x32_bf16 v[116:119], a[168:171], v[168:171], v[116:119]
s_xor_b32 s65, s84, 106496
ds_read_b64_tr_b16 a[204:205], v195 offset:8192
v_mfma_f32_16x16x32_bf16 v[116:119], a[172:175], v[172:175], v[116:119]
buffer_load_dwordx4 a[36:39], v14, s[44:47], s65 offen offset:0 sc1
v_mfma_f32_16x16x32_bf16 v[148:151], a[172:175], v[180:183], v[148:151]
ds_read_b64_tr_b16 a[206:207], v195 offset:12288
v_mfma_f32_16x16x32_bf16 v[148:151], a[168:171], v[176:179], v[148:151]
v_mfma_f32_16x16x32_bf16 v[120:123], a[176:179], v[176:179], v[120:123]
s_waitcnt lgkmcnt(4)
v_mfma_f32_16x16x32_bf16 v[120:123], a[180:183], v[180:183], v[120:123]
buffer_load_dwordx4 a[44:47], v14, s[44:47], s65 offen offset:1024 sc1
v_mfma_f32_16x16x32_bf16 v[88:91], a[180:183], v[172:175], v[88:91]
v_mfma_f32_16x16x32_bf16 v[88:91], a[176:179], v[168:171], v[88:91]
v_mfma_f32_16x16x32_bf16 v[56:59], a[176:179], v[160:163], v[56:59]
v_mfma_f32_16x16x32_bf16 v[56:59], a[180:183], v[164:167], v[56:59]
buffer_load_dwordx4 a[52:55], v15, s[44:47], s65 offen offset:0 sc1
v_mfma_f32_16x16x32_bf16 v[24:27], a[180:183], v[156:159], v[24:27]
v_mfma_f32_16x16x32_bf16 v[24:27], a[176:179], v[152:155], v[24:27]
v_mfma_f32_16x16x32_bf16 v[28:31], a[184:187], v[152:155], v[28:31]
v_mfma_f32_16x16x32_bf16 v[28:31], a[188:191], v[156:159], v[28:31]
buffer_load_dwordx4 a[60:63], v15, s[44:47], s65 offen offset:1024 sc1
v_mfma_f32_16x16x32_bf16 v[60:63], a[188:191], v[164:167], v[60:63]
v_mfma_f32_16x16x32_bf16 v[60:63], a[184:187], v[160:163], v[60:63]
s_waitcnt vmcnt(25)
s_barrier
v_mfma_f32_16x16x32_bf16 v[92:95], a[184:187], v[168:171], v[92:95]
s_lshl_b32 s75, s73, 17
s_add_u32 s84, s84, s75
s_xor_b32 m0, s76, 131072
ds_read_b64_tr_b16 a[144:145], v196 offset:32768
v_mfma_f32_16x16x32_bf16 v[92:95], a[188:191], v[172:175], v[92:95]
s_xor_b32 s64, s85, 0
ds_read_b64_tr_b16 a[146:147], v196 offset:36864
v_mfma_f32_16x16x32_bf16 v[124:127], a[188:191], v[180:183], v[124:127]
buffer_load_dwordx4 v12, s[40:43], s64 offen lds
v_mfma_f32_16x16x32_bf16 v[124:127], a[184:187], v[176:179], v[124:127]
s_xor_b32 m0, s76, 132096
ds_read_b64_tr_b16 a[148:149], v196 offset:40960
v_mfma_f32_16x16x32_bf16 v[128:131], a[192:195], v[176:179], v[128:131]
s_xor_b32 s64, s85, 8192
ds_read_b64_tr_b16 a[150:151], v196 offset:45056
v_mfma_f32_16x16x32_bf16 v[128:131], a[196:199], v[180:183], v[128:131]
buffer_load_dwordx4 v13, s[40:43], s64 offen lds
v_mfma_f32_16x16x32_bf16 v[96:99], a[196:199], v[172:175], v[96:99]
ds_read_b64_tr_b16 a[152:153], v197 offset:32768
v_mfma_f32_16x16x32_bf16 v[96:99], a[192:195], v[168:171], v[96:99]
s_xor_b32 m0, s76, 133120
ds_read_b64_tr_b16 a[154:155], v197 offset:36864
v_mfma_f32_16x16x32_bf16 v[64:67], a[192:195], v[160:163], v[64:67]
s_xor_b32 s64, s85, 16384
ds_read_b64_tr_b16 a[156:157], v197 offset:40960
v_mfma_f32_16x16x32_bf16 v[64:67], a[196:199], v[164:167], v[64:67]
buffer_load_dwordx4 v12, s[40:43], s64 offen lds
v_mfma_f32_16x16x32_bf16 v[32:35], a[196:199], v[156:159], v[32:35]
ds_read_b64_tr_b16 a[158:159], v197 offset:45056
v_mfma_f32_16x16x32_bf16 v[32:35], a[192:195], v[152:155], v[32:35]
s_waitcnt lgkmcnt(5)
s_xor_b32 m0, s76, 134144
ds_read_b64_tr_b16 a[160:161], v198 offset:32768
v_mfma_f32_16x16x32_bf16 v[36:39], a[200:203], v[152:155], v[36:39]
s_xor_b32 s64, s85, 24576
ds_read_b64_tr_b16 a[162:163], v198 offset:36864
v_mfma_f32_16x16x32_bf16 v[36:39], a[204:207], v[156:159], v[36:39]
buffer_load_dwordx4 v13, s[40:43], s64 offen lds
v_mfma_f32_16x16x32_bf16 v[68:71], a[204:207], v[164:167], v[68:71]
ds_read_b64_tr_b16 a[164:165], v198 offset:40960
v_mfma_f32_16x16x32_bf16 v[68:71], a[200:203], v[160:163], v[68:71]
s_xor_b32 m0, s76, 135168
ds_read_b64_tr_b16 a[166:167], v198 offset:45056
v_mfma_f32_16x16x32_bf16 v[100:103], a[200:203], v[168:171], v[100:103]
s_xor_b32 s64, s85, 32768
v_mfma_f32_16x16x32_bf16 v[100:103], a[204:207], v[172:175], v[100:103]
buffer_load_dwordx4 v12, s[40:43], s64 offen lds
v_mfma_f32_16x16x32_bf16 v[132:135], a[204:207], v[180:183], v[132:135]
v_mfma_f32_16x16x32_bf16 v[132:135], a[200:203], v[176:179], v[132:135]
s_waitcnt vmcnt(26)
v_mfma_f32_16x16x32_bf16 v[136:139], a[144:147], a[24:27], v[136:139]
s_waitcnt vmcnt(16)
v_readfirstlane_b32 vcc_lo, v19
s_nop 0
s_cmp_lt_u32 vcc_lo, s74
s_cbranch_scc1 L_spin_4022
L_spinbk_4023:
s_waitcnt lgkmcnt(2)
v_mfma_f32_16x16x32_bf16 v[136:139], a[148:151], a[28:31], v[136:139]
s_xor_b32 m0, s76, 136192
ds_read_b64_tr_b16 a[168:169], v199 offset:32768
v_mfma_f32_16x16x32_bf16 v[104:107], a[148:151], a[20:23], v[104:107]
s_xor_b32 s64, s85, 40960
ds_read_b64_tr_b16 a[170:171], v199 offset:36864
v_mfma_f32_16x16x32_bf16 v[104:107], a[144:147], a[16:19], v[104:107]
buffer_load_dwordx4 v13, s[40:43], s64 offen lds
v_mfma_f32_16x16x32_bf16 v[72:75], a[144:147], a[8:11], v[72:75]
s_xor_b32 m0, s76, 137216
ds_read_b64_tr_b16 a[172:173], v199 offset:40960
v_mfma_f32_16x16x32_bf16 v[72:75], a[148:151], a[12:15], v[72:75]
s_xor_b32 s64, s85, 49152
ds_read_b64_tr_b16 a[174:175], v199 offset:45056
v_mfma_f32_16x16x32_bf16 v[40:43], a[148:151], a[4:7], v[40:43]
buffer_load_dwordx4 v12, s[40:43], s64 offen lds
v_mfma_f32_16x16x32_bf16 v[40:43], a[144:147], a[0:3], v[40:43]
ds_read_b64_tr_b16 a[176:177], v192 offset:32768
v_mfma_f32_16x16x32_bf16 v[44:47], a[152:155], a[0:3], v[44:47]
s_xor_b32 m0, s76, 138240
ds_read_b64_tr_b16 a[178:179], v192 offset:36864
v_mfma_f32_16x16x32_bf16 v[44:47], a[156:159], a[4:7], v[44:47]
s_xor_b32 s64, s85, 57344
ds_read_b64_tr_b16 a[180:181], v192 offset:40960
v_mfma_f32_16x16x32_bf16 v[76:79], a[156:159], a[12:15], v[76:79]
buffer_load_dwordx4 v13, s[40:43], s64 offen lds
v_mfma_f32_16x16x32_bf16 v[76:79], a[152:155], a[8:11], v[76:79]
ds_read_b64_tr_b16 a[182:183], v192 offset:45056
v_mfma_f32_16x16x32_bf16 v[108:111], a[152:155], a[16:19], v[108:111]
ds_read_b64_tr_b16 a[184:185], v193 offset:32768
v_mfma_f32_16x16x32_bf16 v[108:111], a[156:159], a[20:23], v[108:111]
s_xor_b32 s65, s84, 0
ds_read_b64_tr_b16 a[186:187], v193 offset:36864
v_mfma_f32_16x16x32_bf16 v[140:143], a[156:159], a[28:31], v[140:143]
buffer_load_dwordx4 a[208:211], v14, s[44:47], s65 offen offset:0 sc1
v_mfma_f32_16x16x32_bf16 v[140:143], a[152:155], a[24:27], v[140:143]
ds_read_b64_tr_b16 a[188:189], v193 offset:40960
v_mfma_f32_16x16x32_bf16 v[144:147], a[160:163], a[24:27], v[144:147]
s_waitcnt lgkmcnt(5)
ds_read_b64_tr_b16 a[190:191], v193 offset:45056
v_mfma_f32_16x16x32_bf16 v[144:147], a[164:167], a[28:31], v[144:147]
v_mfma_f32_16x16x32_bf16 v[112:115], a[164:167], a[20:23], v[112:115]
buffer_load_dwordx4 a[216:219], v14, s[44:47], s65 offen offset:1024 sc1
v_mfma_f32_16x16x32_bf16 v[112:115], a[160:163], a[16:19], v[112:115]
ds_read_b64_tr_b16 a[192:193], v194 offset:32768
v_mfma_f32_16x16x32_bf16 v[80:83], a[160:163], a[8:11], v[80:83]
ds_read_b64_tr_b16 a[194:195], v194 offset:36864
v_mfma_f32_16x16x32_bf16 v[80:83], a[164:167], a[12:15], v[80:83]
ds_read_b64_tr_b16 a[196:197], v194 offset:40960
v_mfma_f32_16x16x32_bf16 v[48:51], a[164:167], a[4:7], v[48:51]
buffer_load_dwordx4 a[224:227], v15, s[44:47], s65 offen offset:0 sc1
v_mfma_f32_16x16x32_bf16 v[48:51], a[160:163], a[0:3], v[48:51]
ds_read_b64_tr_b16 a[198:199], v194 offset:45056
v_mfma_f32_16x16x32_bf16 v[52:55], a[168:171], a[0:3], v[52:55]
v_mfma_f32_16x16x32_bf16 v[52:55], a[172:175], a[4:7], v[52:55]
buffer_load_dwordx4 a[232:235], v15, s[44:47], s65 offen offset:1024 sc1
v_mfma_f32_16x16x32_bf16 v[84:87], a[172:175], a[12:15], v[84:87]
ds_read_b64_tr_b16 a[200:201], v195 offset:32768
v_mfma_f32_16x16x32_bf16 v[84:87], a[168:171], a[8:11], v[84:87]
ds_read_b64_tr_b16 a[202:203], v195 offset:36864
v_mfma_f32_16x16x32_bf16 v[116:119], a[168:171], a[16:19], v[116:119]
s_xor_b32 s65, s84, 8192
ds_read_b64_tr_b16 a[204:205], v195 offset:40960
v_mfma_f32_16x16x32_bf16 v[116:119], a[172:175], a[20:23], v[116:119]
buffer_load_dwordx4 a[212:215], v14, s[44:47], s65 offen offset:0 sc1
v_mfma_f32_16x16x32_bf16 v[148:151], a[172:175], a[28:31], v[148:151]
ds_read_b64_tr_b16 a[206:207], v195 offset:45056
v_mfma_f32_16x16x32_bf16 v[148:151], a[168:171], a[24:27], v[148:151]
v_mfma_f32_16x16x32_bf16 v[120:123], a[176:179], a[24:27], v[120:123]
s_waitcnt lgkmcnt(4)
v_mfma_f32_16x16x32_bf16 v[120:123], a[180:183], a[28:31], v[120:123]
buffer_load_dwordx4 a[220:223], v14, s[44:47], s65 offen offset:1024 sc1
v_mfma_f32_16x16x32_bf16 v[88:91], a[180:183], a[20:23], v[88:91]
v_mfma_f32_16x16x32_bf16 v[88:91], a[176:179], a[16:19], v[88:91]
v_mfma_f32_16x16x32_bf16 v[56:59], a[176:179], a[8:11], v[56:59]
v_mfma_f32_16x16x32_bf16 v[56:59], a[180:183], a[12:15], v[56:59]
buffer_load_dwordx4 a[228:231], v15, s[44:47], s65 offen offset:0 sc1
v_mfma_f32_16x16x32_bf16 v[24:27], a[180:183], a[4:7], v[24:27]
v_mfma_f32_16x16x32_bf16 v[24:27], a[176:179], a[0:3], v[24:27]
v_mfma_f32_16x16x32_bf16 v[28:31], a[184:187], a[0:3], v[28:31]
v_mfma_f32_16x16x32_bf16 v[28:31], a[188:191], a[4:7], v[28:31]
buffer_load_dwordx4 a[236:239], v15, s[44:47], s65 offen offset:1024 sc1
v_mfma_f32_16x16x32_bf16 v[60:63], a[188:191], a[12:15], v[60:63]
v_mfma_f32_16x16x32_bf16 v[60:63], a[184:187], a[8:11], v[60:63]
s_waitcnt vmcnt(24)
s_barrier
v_mfma_f32_16x16x32_bf16 v[92:95], a[184:187], a[16:19], v[92:95]
s_xor_b32 m0, s76, 32768
ds_read_b64_tr_b16 a[144:145], v188 offset:0
v_mfma_f32_16x16x32_bf16 v[92:95], a[188:191], a[20:23], v[92:95]
s_xor_b32 s64, s85, 262144
ds_read_b64_tr_b16 a[146:147], v188 offset:4096
v_mfma_f32_16x16x32_bf16 v[124:127], a[188:191], a[28:31], v[124:127]
buffer_load_dwordx4 v12, s[40:43], s64 offen lds
v_mfma_f32_16x16x32_bf16 v[124:127], a[184:187], a[24:27], v[124:127]
s_xor_b32 m0, s76, 33792
ds_read_b64_tr_b16 a[148:149], v188 offset:8192
v_mfma_f32_16x16x32_bf16 v[128:131], a[192:195], a[24:27], v[128:131]
s_xor_b32 s64, s85, 270336
ds_read_b64_tr_b16 a[150:151], v188 offset:12288
v_mfma_f32_16x16x32_bf16 v[128:131], a[196:199], a[28:31], v[128:131]
buffer_load_dwordx4 v13, s[40:43], s64 offen lds
v_mfma_f32_16x16x32_bf16 v[96:99], a[196:199], a[20:23], v[96:99]
ds_read_b64_tr_b16 a[152:153], v189 offset:0
v_mfma_f32_16x16x32_bf16 v[96:99], a[192:195], a[16:19], v[96:99]
s_xor_b32 m0, s76, 34816
ds_read_b64_tr_b16 a[154:155], v189 offset:4096
v_mfma_f32_16x16x32_bf16 v[64:67], a[192:195], a[8:11], v[64:67]
s_xor_b32 s64, s85, 278528
ds_read_b64_tr_b16 a[156:157], v189 offset:8192
v_mfma_f32_16x16x32_bf16 v[64:67], a[196:199], a[12:15], v[64:67]
buffer_load_dwordx4 v12, s[40:43], s64 offen lds
v_mfma_f32_16x16x32_bf16 v[32:35], a[196:199], a[4:7], v[32:35]
ds_read_b64_tr_b16 a[158:159], v189 offset:12288
v_mfma_f32_16x16x32_bf16 v[32:35], a[192:195], a[0:3], v[32:35]
s_waitcnt lgkmcnt(5)
s_xor_b32 m0, s76, 35840
ds_read_b64_tr_b16 a[160:161], v190 offset:0
v_mfma_f32_16x16x32_bf16 v[36:39], a[200:203], a[0:3], v[36:39]
s_xor_b32 s64, s85, 286720
ds_read_b64_tr_b16 a[162:163], v190 offset:4096
v_mfma_f32_16x16x32_bf16 v[36:39], a[204:207], a[4:7], v[36:39]
buffer_load_dwordx4 v13, s[40:43], s64 offen lds
v_mfma_f32_16x16x32_bf16 v[68:71], a[204:207], a[12:15], v[68:71]
ds_read_b64_tr_b16 a[164:165], v190 offset:8192
v_mfma_f32_16x16x32_bf16 v[68:71], a[200:203], a[8:11], v[68:71]
s_xor_b32 m0, s76, 36864
ds_read_b64_tr_b16 a[166:167], v190 offset:12288
v_mfma_f32_16x16x32_bf16 v[100:103], a[200:203], a[16:19], v[100:103]
s_xor_b32 s64, s85, 294912
v_mfma_f32_16x16x32_bf16 v[100:103], a[204:207], a[20:23], v[100:103]
buffer_load_dwordx4 v12, s[40:43], s64 offen lds
v_mfma_f32_16x16x32_bf16 v[132:135], a[204:207], a[28:31], v[132:135]
v_mfma_f32_16x16x32_bf16 v[132:135], a[200:203], a[24:27], v[132:135]
s_waitcnt vmcnt(25)
s_xor_b32 m0, s76, 37888
v_mfma_f32_16x16x32_bf16 v[136:139], a[144:147], a[56:59], v[136:139]
s_waitcnt vmcnt(21)
s_waitcnt lgkmcnt(2)
s_xor_b32 s64, s85, 303104
ds_read_b64_tr_b16 a[168:169], v191 offset:0
v_mfma_f32_16x16x32_bf16 v[136:139], a[148:151], a[60:63], v[136:139]
buffer_load_dwordx4 v13, s[40:43], s64 offen lds
v_mfma_f32_16x16x32_bf16 v[104:107], a[148:151], a[52:55], v[104:107]
ds_read_b64_tr_b16 a[170:171], v191 offset:4096
v_mfma_f32_16x16x32_bf16 v[104:107], a[144:147], a[48:51], v[104:107]
s_xor_b32 m0, s76, 38912
ds_read_b64_tr_b16 a[172:173], v191 offset:8192
v_mfma_f32_16x16x32_bf16 v[72:75], a[144:147], a[40:43], v[72:75]
s_xor_b32 s64, s85, 311296
ds_read_b64_tr_b16 a[174:175], v191 offset:12288
v_mfma_f32_16x16x32_bf16 v[72:75], a[148:151], a[44:47], v[72:75]
buffer_load_dwordx4 v12, s[40:43], s64 offen lds
v_mfma_f32_16x16x32_bf16 v[40:43], a[148:151], a[36:39], v[40:43]
ds_read_b64_tr_b16 a[176:177], v184 offset:0
v_mfma_f32_16x16x32_bf16 v[40:43], a[144:147], a[32:35], v[40:43]
s_xor_b32 m0, s76, 39936
ds_read_b64_tr_b16 a[178:179], v184 offset:4096
v_mfma_f32_16x16x32_bf16 v[44:47], a[152:155], a[32:35], v[44:47]
s_xor_b32 s64, s85, 319488
ds_read_b64_tr_b16 a[180:181], v184 offset:8192
v_mfma_f32_16x16x32_bf16 v[44:47], a[156:159], a[36:39], v[44:47]
buffer_load_dwordx4 v13, s[40:43], s64 offen lds
v_mfma_f32_16x16x32_bf16 v[76:79], a[156:159], a[44:47], v[76:79]
ds_read_b64_tr_b16 a[182:183], v184 offset:12288
v_mfma_f32_16x16x32_bf16 v[76:79], a[152:155], a[40:43], v[76:79]
ds_read_b64_tr_b16 a[184:185], v185 offset:0
v_mfma_f32_16x16x32_bf16 v[108:111], a[152:155], a[48:51], v[108:111]
s_xor_b32 s65, s84, 32768
ds_read_b64_tr_b16 a[186:187], v185 offset:4096
v_mfma_f32_16x16x32_bf16 v[108:111], a[156:159], a[52:55], v[108:111]
buffer_load_dwordx4 v[152:155], v14, s[44:47], s65 offen offset:0 sc1
v_mfma_f32_16x16x32_bf16 v[140:143], a[156:159], a[60:63], v[140:143]
ds_read_b64_tr_b16 a[188:189], v185 offset:8192
v_mfma_f32_16x16x32_bf16 v[140:143], a[152:155], a[56:59], v[140:143]
ds_read_b64_tr_b16 a[190:191], v185 offset:12288
v_mfma_f32_16x16x32_bf16 v[144:147], a[160:163], a[56:59], v[144:147]
s_waitcnt lgkmcnt(5)
v_mfma_f32_16x16x32_bf16 v[144:147], a[164:167], a[60:63], v[144:147]
buffer_load_dwordx4 v[160:163], v14, s[44:47], s65 offen offset:1024 sc1
v_mfma_f32_16x16x32_bf16 v[112:115], a[164:167], a[52:55], v[112:115]
ds_read_b64_tr_b16 a[192:193], v186 offset:0
v_mfma_f32_16x16x32_bf16 v[112:115], a[160:163], a[48:51], v[112:115]
ds_read_b64_tr_b16 a[194:195], v186 offset:4096
v_mfma_f32_16x16x32_bf16 v[80:83], a[160:163], a[40:43], v[80:83]
ds_read_b64_tr_b16 a[196:197], v186 offset:8192
v_mfma_f32_16x16x32_bf16 v[80:83], a[164:167], a[44:47], v[80:83]
buffer_load_dwordx4 v[168:171], v15, s[44:47], s65 offen offset:0 sc1
v_mfma_f32_16x16x32_bf16 v[48:51], a[164:167], a[36:39], v[48:51]
ds_read_b64_tr_b16 a[198:199], v186 offset:12288
v_mfma_f32_16x16x32_bf16 v[48:51], a[160:163], a[32:35], v[48:51]
v_mfma_f32_16x16x32_bf16 v[52:55], a[168:171], a[32:35], v[52:55]
v_mfma_f32_16x16x32_bf16 v[52:55], a[172:175], a[36:39], v[52:55]
buffer_load_dwordx4 v[176:179], v15, s[44:47], s65 offen offset:1024 sc1
v_mfma_f32_16x16x32_bf16 v[84:87], a[172:175], a[44:47], v[84:87]
ds_read_b64_tr_b16 a[200:201], v187 offset:0
v_mfma_f32_16x16x32_bf16 v[84:87], a[168:171], a[40:43], v[84:87]
ds_read_b64_tr_b16 a[202:203], v187 offset:4096
v_mfma_f32_16x16x32_bf16 v[116:119], a[168:171], a[48:51], v[116:119]
s_xor_b32 s65, s84, 40960
ds_read_b64_tr_b16 a[204:205], v187 offset:8192
v_mfma_f32_16x16x32_bf16 v[116:119], a[172:175], a[52:55], v[116:119]
buffer_load_dwordx4 v[156:159], v14, s[44:47], s65 offen offset:0 sc1
v_mfma_f32_16x16x32_bf16 v[148:151], a[172:175], a[60:63], v[148:151]
ds_read_b64_tr_b16 a[206:207], v187 offset:12288
v_mfma_f32_16x16x32_bf16 v[148:151], a[168:171], a[56:59], v[148:151]
v_mfma_f32_16x16x32_bf16 v[120:123], a[176:179], a[56:59], v[120:123]
s_waitcnt lgkmcnt(4)
v_mfma_f32_16x16x32_bf16 v[120:123], a[180:183], a[60:63], v[120:123]
buffer_load_dwordx4 v[164:167], v14, s[44:47], s65 offen offset:1024 sc1
v_mfma_f32_16x16x32_bf16 v[88:91], a[180:183], a[52:55], v[88:91]
v_mfma_f32_16x16x32_bf16 v[88:91], a[176:179], a[48:51], v[88:91]
v_mfma_f32_16x16x32_bf16 v[56:59], a[176:179], a[40:43], v[56:59]
v_mfma_f32_16x16x32_bf16 v[56:59], a[180:183], a[44:47], v[56:59]
buffer_load_dwordx4 v[172:175], v15, s[44:47], s65 offen offset:0 sc1
v_mfma_f32_16x16x32_bf16 v[24:27], a[180:183], a[36:39], v[24:27]
v_mfma_f32_16x16x32_bf16 v[24:27], a[176:179], a[32:35], v[24:27]
v_mfma_f32_16x16x32_bf16 v[28:31], a[184:187], a[32:35], v[28:31]
v_mfma_f32_16x16x32_bf16 v[28:31], a[188:191], a[36:39], v[28:31]
buffer_load_dwordx4 v[180:183], v15, s[44:47], s65 offen offset:1024 sc1
v_mfma_f32_16x16x32_bf16 v[60:63], a[188:191], a[44:47], v[60:63]
v_mfma_f32_16x16x32_bf16 v[60:63], a[184:187], a[40:43], v[60:63]
s_waitcnt vmcnt(24)
s_barrier
v_mfma_f32_16x16x32_bf16 v[92:95], a[184:187], a[48:51], v[92:95]
s_xor_b32 m0, s76, 65536
ds_read_b64_tr_b16 a[144:145], v188 offset:32768
v_mfma_f32_16x16x32_bf16 v[92:95], a[188:191], a[52:55], v[92:95]
s_xor_b32 s64, s85, 524288
ds_read_b64_tr_b16 a[146:147], v188 offset:36864
v_mfma_f32_16x16x32_bf16 v[124:127], a[188:191], a[60:63], v[124:127]
buffer_load_dwordx4 v12, s[40:43], s64 offen lds
v_mfma_f32_16x16x32_bf16 v[124:127], a[184:187], a[56:59], v[124:127]
s_xor_b32 m0, s76, 66560
ds_read_b64_tr_b16 a[148:149], v188 offset:40960
v_mfma_f32_16x16x32_bf16 v[128:131], a[192:195], a[56:59], v[128:131]
s_xor_b32 s64, s85, 532480
ds_read_b64_tr_b16 a[150:151], v188 offset:45056
v_mfma_f32_16x16x32_bf16 v[128:131], a[196:199], a[60:63], v[128:131]
buffer_load_dwordx4 v13, s[40:43], s64 offen lds
v_mfma_f32_16x16x32_bf16 v[96:99], a[196:199], a[52:55], v[96:99]
ds_read_b64_tr_b16 a[152:153], v189 offset:32768
v_mfma_f32_16x16x32_bf16 v[96:99], a[192:195], a[48:51], v[96:99]
s_branch L_po22
L_pg22:
s_branch L_tr2
L_po22:
s_xor_b32 m0, s76, 67584
ds_read_b64_tr_b16 a[154:155], v189 offset:36864
v_mfma_f32_16x16x32_bf16 v[64:67], a[192:195], a[40:43], v[64:67]
s_xor_b32 s64, s85, 540672
ds_read_b64_tr_b16 a[156:157], v189 offset:40960
v_mfma_f32_16x16x32_bf16 v[64:67], a[196:199], a[44:47], v[64:67]
buffer_load_dwordx4 v12, s[40:43], s64 offen lds
v_mfma_f32_16x16x32_bf16 v[32:35], a[196:199], a[36:39], v[32:35]
ds_read_b64_tr_b16 a[158:159], v189 offset:45056
v_mfma_f32_16x16x32_bf16 v[32:35], a[192:195], a[32:35], v[32:35]
s_waitcnt lgkmcnt(5)
s_xor_b32 m0, s76, 68608
ds_read_b64_tr_b16 a[160:161], v190 offset:32768
v_mfma_f32_16x16x32_bf16 v[36:39], a[200:203], a[32:35], v[36:39]
s_xor_b32 s64, s85, 548864
ds_read_b64_tr_b16 a[162:163], v190 offset:36864
v_mfma_f32_16x16x32_bf16 v[36:39], a[204:207], a[36:39], v[36:39]
buffer_load_dwordx4 v13, s[40:43], s64 offen lds
v_mfma_f32_16x16x32_bf16 v[68:71], a[204:207], a[44:47], v[68:71]
ds_read_b64_tr_b16 a[164:165], v190 offset:40960
v_mfma_f32_16x16x32_bf16 v[68:71], a[200:203], a[40:43], v[68:71]
s_xor_b32 m0, s76, 69632
ds_read_b64_tr_b16 a[166:167], v190 offset:45056
v_mfma_f32_16x16x32_bf16 v[100:103], a[200:203], a[48:51], v[100:103]
s_xor_b32 s64, s85, 557056
v_mfma_f32_16x16x32_bf16 v[100:103], a[204:207], a[52:55], v[100:103]
buffer_load_dwordx4 v12, s[40:43], s64 offen lds
v_mfma_f32_16x16x32_bf16 v[132:135], a[204:207], a[60:63], v[132:135]
s_sub_u32 s73, 1, s73
s_sub_u32 s70, s70, 1
s_cmp_lg_u32 s70, 0
v_mfma_f32_16x16x32_bf16 v[132:135], a[200:203], a[56:59], v[132:135]
s_cbranch_scc1 L_p5loop
L_p5last:
s_waitcnt lgkmcnt(10)
s_waitcnt vmcnt(25)
v_mfma_f32_16x16x32_bf16 v[136:139], a[144:147], a[232:235], v[136:139]
s_waitcnt vmcnt(21)
s_waitcnt lgkmcnt(8)
s_xor_b32 m0, s76, 70656
s_xor_b32 s64, s85, 565248
ds_read_b64_tr_b16 a[168:169], v191 offset:32768
v_mfma_f32_16x16x32_bf16 v[136:139], a[148:151], a[236:239], v[136:139]
buffer_load_dwordx4 v13, s[40:43], s64 offen lds
v_mfma_f32_16x16x32_bf16 v[104:107], a[148:151], a[228:231], v[104:107]
ds_read_b64_tr_b16 a[170:171], v191 offset:36864
v_mfma_f32_16x16x32_bf16 v[104:107], a[144:147], a[224:227], v[104:107]
s_xor_b32 m0, s76, 71680
ds_read_b64_tr_b16 a[172:173], v191 offset:40960
v_mfma_f32_16x16x32_bf16 v[72:75], a[144:147], a[216:219], v[72:75]
s_xor_b32 s64, s85, 573440
ds_read_b64_tr_b16 a[174:175], v191 offset:45056
v_mfma_f32_16x16x32_bf16 v[72:75], a[148:151], a[220:223], v[72:75]
buffer_load_dwordx4 v12, s[40:43], s64 offen lds
v_mfma_f32_16x16x32_bf16 v[40:43], a[148:151], a[212:215], v[40:43]
ds_read_b64_tr_b16 a[176:177], v184 offset:32768
v_mfma_f32_16x16x32_bf16 v[40:43], a[144:147], a[208:211], v[40:43]
s_waitcnt lgkmcnt(5)
s_xor_b32 m0, s76, 72704
ds_read_b64_tr_b16 a[178:179], v184 offset:36864
v_mfma_f32_16x16x32_bf16 v[44:47], a[152:155], a[208:211], v[44:47]
s_xor_b32 s64, s85, 581632
ds_read_b64_tr_b16 a[180:181], v184 offset:40960
v_mfma_f32_16x16x32_bf16 v[44:47], a[156:159], a[212:215], v[44:47]
buffer_load_dwordx4 v13, s[40:43], s64 offen lds
v_mfma_f32_16x16x32_bf16 v[76:79], a[156:159], a[220:223], v[76:79]
ds_read_b64_tr_b16 a[182:183], v184 offset:45056
v_mfma_f32_16x16x32_bf16 v[76:79], a[152:155], a[216:219], v[76:79]
ds_read_b64_tr_b16 a[184:185], v185 offset:32768
v_mfma_f32_16x16x32_bf16 v[108:111], a[152:155], a[224:227], v[108:111]
s_xor_b32 s65, s84, 65536
ds_read_b64_tr_b16 a[186:187], v185 offset:36864
v_mfma_f32_16x16x32_bf16 v[108:111], a[156:159], a[228:231], v[108:111]
buffer_load_dwordx4 a[0:3], v14, s[44:47], s65 offen offset:0 sc1
v_mfma_f32_16x16x32_bf16 v[140:143], a[156:159], a[236:239], v[140:143]
ds_read_b64_tr_b16 a[188:189], v185 offset:40960
v_mfma_f32_16x16x32_bf16 v[140:143], a[152:155], a[232:235], v[140:143]
ds_read_b64_tr_b16 a[190:191], v185 offset:45056
v_mfma_f32_16x16x32_bf16 v[144:147], a[160:163], a[232:235], v[144:147]
v_mfma_f32_16x16x32_bf16 v[144:147], a[164:167], a[236:239], v[144:147]
buffer_load_dwordx4 a[8:11], v14, s[44:47], s65 offen offset:1024 sc1
v_mfma_f32_16x16x32_bf16 v[112:115], a[164:167], a[228:231], v[112:115]
ds_read_b64_tr_b16 a[192:193], v186 offset:32768
v_mfma_f32_16x16x32_bf16 v[112:115], a[160:163], a[224:227], v[112:115]
ds_read_b64_tr_b16 a[194:195], v186 offset:36864
v_mfma_f32_16x16x32_bf16 v[80:83], a[160:163], a[216:219], v[80:83]
ds_read_b64_tr_b16 a[196:197], v186 offset:40960
v_mfma_f32_16x16x32_bf16 v[80:83], a[164:167], a[220:223], v[80:83]
buffer_load_dwordx4 a[16:19], v15, s[44:47], s65 offen offset:0 sc1
v_mfma_f32_16x16x32_bf16 v[48:51], a[164:167], a[212:215], v[48:51]
ds_read_b64_tr_b16 a[198:199], v186 offset:45056
v_mfma_f32_16x16x32_bf16 v[48:51], a[160:163], a[208:211], v[48:51]
s_waitcnt lgkmcnt(4)
v_mfma_f32_16x16x32_bf16 v[52:55], a[168:171], a[208:211], v[52:55]
v_mfma_f32_16x16x32_bf16 v[52:55], a[172:175], a[212:215], v[52:55]
buffer_load_dwordx4 a[24:27], v15, s[44:47], s65 offen offset:1024 sc1
v_mfma_f32_16x16x32_bf16 v[84:87], a[172:175], a[220:223], v[84:87]
ds_read_b64_tr_b16 a[200:201], v187 offset:32768
v_mfma_f32_16x16x32_bf16 v[84:87], a[168:171], a[216:219], v[84:87]
ds_read_b64_tr_b16 a[202:203], v187 offset:36864
v_mfma_f32_16x16x32_bf16 v[116:119], a[168:171], a[224:227], v[116:119]
s_xor_b32 s65, s84, 73728
ds_read_b64_tr_b16 a[204:205], v187 offset:40960
v_mfma_f32_16x16x32_bf16 v[116:119], a[172:175], a[228:231], v[116:119]
buffer_load_dwordx4 a[4:7], v14, s[44:47], s65 offen offset:0 sc1
v_mfma_f32_16x16x32_bf16 v[148:151], a[172:175], a[236:239], v[148:151]
s_xor_b32 s66, s2, 1
s_lshl2_add_u32 s66, s66, s30
ds_read_b64_tr_b16 a[206:207], v187 offset:45056
v_mfma_f32_16x16x32_bf16 v[148:151], a[168:171], a[232:235], v[148:151]
s_lshl_b32 s73, s66, 12
s_add_u32 s73, s73, 67108864
s_lshl2_add_u32 s66, s2, s30
v_mfma_f32_16x16x32_bf16 v[120:123], a[176:179], a[232:235], v[120:123]
s_lshl_b32 s75, s66, 12
s_add_u32 s75, s75, 67108864
s_lshl_b32 s77, s82, 18
v_mfma_f32_16x16x32_bf16 v[120:123], a[180:183], a[236:239], v[120:123]
s_lshl_b32 s66, s30, 16
buffer_load_dwordx4 a[12:15], v14, s[44:47], s65 offen offset:1024 sc1
v_mfma_f32_16x16x32_bf16 v[88:91], a[180:183], a[228:231], v[88:91]
s_add_u32 s77, s77, s66
s_add_u32 s77, s77, s87
s_lshl_b32 s66, s83, 7
v_mfma_f32_16x16x32_bf16 v[88:91], a[176:179], a[224:227], v[88:91]
s_add_u32 s77, s77, s66
v_lshlrev_b32 v1, 24, v0
v_and_b32 v8, 7, v0
v_mfma_f32_16x16x32_bf16 v[56:59], a[176:179], a[216:219], v[56:59]
v_lshlrev_b32 v8, 11, v8
v_bfe_u32 v10, v0, 3, 1
v_mfma_f32_16x16x32_bf16 v[56:59], a[180:183], a[220:223], v[56:59]
buffer_load_dwordx4 a[20:23], v15, s[44:47], s65 offen offset:0 sc1
v_mfma_f32_16x16x32_bf16 v[24:27], a[180:183], a[212:215], v[24:27]
v_lshl_add_u32 v8, v10, 6, v8
v_bfe_u32 v10, v0, 4, 1
v_mfma_f32_16x16x32_bf16 v[24:27], a[176:179], a[208:211], v[24:27]
v_lshl_add_u32 v8, v10, 5, v8
v_lshrrev_b32 v10, 5, v0
v_mfma_f32_16x16x32_bf16 v[28:31], a[184:187], a[208:211], v[28:31]
v_lshl_add_u32 v8, v10, 4, v8
v_add_u32 v2, s86, v16
v_mfma_f32_16x16x32_bf16 v[28:31], a[188:191], a[212:215], v[28:31]
buffer_load_dwordx4 a[28:31], v15, s[44:47], s65 offen offset:1024 sc1
v_mfma_f32_16x16x32_bf16 v[60:63], a[188:191], a[220:223], v[60:63]
v_xor_b32 v3, 0x2000, v2
v_add_u32 v4, 0x20000, v2
v_mfma_f32_16x16x32_bf16 v[60:63], a[184:187], a[216:219], v[60:63]
s_waitcnt vmcnt(24)
s_barrier
v_mfma_f32_16x16x32_bf16 v[92:95], a[184:187], a[224:227], v[92:95]
s_xor_b32 m0, s76, 98304
ds_read_b64_tr_b16 a[144:145], v196 offset:0
v_add_u32 v5, 0x20000, v3
v_mfma_f32_16x16x32_bf16 v[92:95], a[188:191], a[228:231], v[92:95]
s_xor_b32 s64, s85, 786432
ds_read_b64_tr_b16 a[146:147], v196 offset:4096
v_mov_b32 v232, 0
v_mfma_f32_16x16x32_bf16 v[124:127], a[188:191], a[236:239], v[124:127]
buffer_load_dwordx4 v12, s[40:43], s64 offen lds
v_mfma_f32_16x16x32_bf16 v[124:127], a[184:187], a[232:235], v[124:127]
s_waitcnt lgkmcnt(2)
s_xor_b32 m0, s76, 99328
ds_read_b64_tr_b16 a[148:149], v196 offset:8192
v_mov_b32 v233, 0
v_mfma_f32_16x16x32_bf16 v[128:131], a[192:195], a[232:235], v[128:131]
s_xor_b32 s64, s85, 794624
ds_read_b64_tr_b16 a[150:151], v196 offset:12288
v_mov_b32 v236, 0
v_mfma_f32_16x16x32_bf16 v[128:131], a[196:199], a[236:239], v[128:131]
buffer_load_dwordx4 v13, s[40:43], s64 offen lds
v_mfma_f32_16x16x32_bf16 v[96:99], a[196:199], a[228:231], v[96:99]
ds_read_b64_tr_b16 a[152:153], v197 offset:0
v_mov_b32 v237, 0
v_mfma_f32_16x16x32_bf16 v[96:99], a[192:195], a[224:227], v[96:99]
s_xor_b32 m0, s76, 100352
ds_read_b64_tr_b16 a[154:155], v197 offset:4096
v_and_b32 v9, 1, v0
v_mfma_f32_16x16x32_bf16 v[64:67], a[192:195], a[216:219], v[64:67]
s_xor_b32 s64, s85, 802816
ds_read_b64_tr_b16 a[156:157], v197 offset:8192
v_lshlrev_b32 v9, 4, v9
v_mfma_f32_16x16x32_bf16 v[64:67], a[196:199], a[220:223], v[64:67]
buffer_load_dwordx4 v12, s[40:43], s64 offen lds
v_mfma_f32_16x16x32_bf16 v[32:35], a[196:199], a[212:215], v[32:35]
ds_read_b64_tr_b16 a[158:159], v197 offset:12288
v_mov_b32 v10, 0x3f80
v_mfma_f32_16x16x32_bf16 v[32:35], a[192:195], a[208:211], v[32:35]
s_xor_b32 m0, s76, 101376
ds_read_b64_tr_b16 a[160:161], v198 offset:0
v_lshlrev_b32 v9, v9, v10
v_mfma_f32_16x16x32_bf16 v[36:39], a[200:203], a[208:211], v[36:39]
s_xor_b32 s64, s85, 811008
ds_read_b64_tr_b16 a[162:163], v198 offset:4096
v_lshrrev_b32 v10, 4, v0
v_mfma_f32_16x16x32_bf16 v[36:39], a[204:207], a[212:215], v[36:39]
buffer_load_dwordx4 v13, s[40:43], s64 offen lds
v_mfma_f32_16x16x32_bf16 v[68:71], a[204:207], a[220:223], v[68:71]
ds_read_b64_tr_b16 a[164:165], v198 offset:8192
v_lshlrev_b32 v10, 1, v10
v_mfma_f32_16x16x32_bf16 v[68:71], a[200:203], a[216:219], v[68:71]
s_xor_b32 m0, s76, 102400
ds_read_b64_tr_b16 a[166:167], v198 offset:12288
v_bfe_u32 v11, v0, 1, 3
v_mfma_f32_16x16x32_bf16 v[100:103], a[200:203], a[224:227], v[100:103]
s_xor_b32 s64, s85, 819200
v_xor_b32 v10, v10, v11
v_subrev_u32 v11, 1, v10
v_mfma_f32_16x16x32_bf16 v[100:103], a[204:207], a[228:231], v[100:103]
buffer_load_dwordx4 v12, s[40:43], s64 offen lds
v_mfma_f32_16x16x32_bf16 v[132:135], a[204:207], a[236:239], v[132:135]
v_ashrrev_i32 v11, 31, v11
v_and_b32 v234, v11, v9
v_mfma_f32_16x16x32_bf16 v[132:135], a[200:203], a[232:235], v[132:135]
s_waitcnt vmcnt(25)
s_waitcnt lgkmcnt(3)
s_xor_b32 m0, s76, 103424
v_xor_b32 v10, 1, v10
v_subrev_u32 v11, 1, v10
v_mfma_f32_16x16x32_bf16 v[136:139], a[144:147], v[176:179], v[136:139]
s_waitcnt vmcnt(21)
s_xor_b32 s64, s85, 827392
ds_read_b64_tr_b16 a[168:169], v199 offset:0
v_ashrrev_i32 v11, 31, v11
v_mfma_f32_16x16x32_bf16 v[136:139], a[148:151], v[180:183], v[136:139]
buffer_load_dwordx4 v13, s[40:43], s64 offen lds
v_mfma_f32_16x16x32_bf16 v[104:107], a[148:151], v[172:175], v[104:107]
ds_read_b64_tr_b16 a[170:171], v199 offset:4096
v_and_b32 v235, v11, v9
v_mfma_f32_16x16x32_bf16 v[104:107], a[144:147], v[168:171], v[104:107]
s_mov_b32 s48, s24
s_mov_b32 s49, s25
s_xor_b32 m0, s76, 104448
ds_read_b64_tr_b16 a[172:173], v199 offset:8192
v_mfma_f32_16x16x32_bf16 v[72:75], a[144:147], v[160:163], v[72:75]
s_mov_b32 s50, 4194304
s_mov_b32 s51, 0x20000
s_xor_b32 s64, s85, 835584
ds_read_b64_tr_b16 a[174:175], v199 offset:12288
v_mfma_f32_16x16x32_bf16 v[72:75], a[148:151], v[164:167], v[72:75]
buffer_load_dwordx4 v12, s[40:43], s64 offen lds
v_mfma_f32_16x16x32_bf16 v[40:43], a[148:151], v[156:159], v[40:43]
s_waitcnt vmcnt(15)
s_barrier
s_xor_b32 m0, s76, 105472
s_xor_b32 s64, s85, 843776
v_mfma_f32_16x16x32_bf16 v[40:43], a[144:147], v[152:155], v[40:43]
buffer_load_dwordx4 v13, s[40:43], s64 offen lds
v_mfma_f32_16x16x32_bf16 v[44:47], a[152:155], v[152:155], v[44:47]
ds_read_b64_tr_b16 a[176:177], v196 offset:32768
v_mfma_f32_16x16x32_bf16 v[44:47], a[156:159], v[156:159], v[44:47]
s_xor_b32 s65, s84, 98304
ds_read_b64_tr_b16 a[178:179], v196 offset:36864
v_mfma_f32_16x16x32_bf16 v[76:79], a[156:159], v[164:167], v[76:79]
buffer_load_dwordx4 a[32:35], v14, s[44:47], s65 offen offset:0 sc1
v_mfma_f32_16x16x32_bf16 v[76:79], a[152:155], v[160:163], v[76:79]
ds_read_b64_tr_b16 a[180:181], v196 offset:40960
v_mfma_f32_16x16x32_bf16 v[108:111], a[152:155], v[168:171], v[108:111]
ds_read_b64_tr_b16 a[182:183], v196 offset:45056
v_mfma_f32_16x16x32_bf16 v[108:111], a[156:159], v[172:175], v[108:111]
buffer_load_dwordx4 a[40:43], v14, s[44:47], s65 offen offset:1024 sc1
v_mfma_f32_16x16x32_bf16 v[140:143], a[156:159], v[180:183], v[140:143]
ds_read_b64_tr_b16 a[184:185], v197 offset:32768
v_mfma_f32_16x16x32_bf16 v[140:143], a[152:155], v[176:179], v[140:143]
s_waitcnt lgkmcnt(5)
ds_read_b64_tr_b16 a[186:187], v197 offset:36864
v_mfma_f32_16x16x32_bf16 v[144:147], a[160:163], v[176:179], v[144:147]
buffer_load_dwordx4 a[48:51], v15, s[44:47], s65 offen offset:0 sc1
v_mfma_f32_16x16x32_bf16 v[144:147], a[164:167], v[180:183], v[144:147]
ds_read_b64_tr_b16 a[188:189], v197 offset:40960
v_mfma_f32_16x16x32_bf16 v[112:115], a[164:167], v[172:175], v[112:115]
ds_read_b64_tr_b16 a[190:191], v197 offset:45056
v_mfma_f32_16x16x32_bf16 v[112:115], a[160:163], v[168:171], v[112:115]
ds_read_b64_tr_b16 a[192:193], v198 offset:32768
v_mfma_f32_16x16x32_bf16 v[80:83], a[160:163], v[160:163], v[80:83]
buffer_load_dwordx4 a[56:59], v15, s[44:47], s65 offen offset:1024 sc1
v_mfma_f32_16x16x32_bf16 v[80:83], a[164:167], v[164:167], v[80:83]
ds_read_b64_tr_b16 a[194:195], v198 offset:36864
v_mfma_f32_16x16x32_bf16 v[48:51], a[164:167], v[156:159], v[48:51]
s_xor_b32 s65, s84, 106496
ds_read_b64_tr_b16 a[196:197], v198 offset:40960
v_mfma_f32_16x16x32_bf16 v[48:51], a[160:163], v[152:155], v[48:51]
buffer_load_dwordx4 a[36:39], v14, s[44:47], s65 offen offset:0 sc1
v_mfma_f32_16x16x32_bf16 v[52:55], a[168:171], v[152:155], v[52:55]
ds_read_b64_tr_b16 a[198:199], v198 offset:45056
v_mfma_f32_16x16x32_bf16 v[52:55], a[172:175], v[156:159], v[52:55]
v_mfma_f32_16x16x32_bf16 v[84:87], a[172:175], v[164:167], v[84:87]
buffer_load_dwordx4 a[44:47], v14, s[44:47], s65 offen offset:1024 sc1
v_mfma_f32_16x16x32_bf16 v[84:87], a[168:171], v[160:163], v[84:87]
ds_read_b64_tr_b16 a[200:201], v199 offset:32768
v_mfma_f32_16x16x32_bf16 v[116:119], a[168:171], v[168:171], v[116:119]
ds_read_b64_tr_b16 a[202:203], v199 offset:36864
v_mfma_f32_16x16x32_bf16 v[116:119], a[172:175], v[172:175], v[116:119]
buffer_load_dwordx4 a[52:55], v15, s[44:47], s65 offen offset:0 sc1
v_mfma_f32_16x16x32_bf16 v[148:151], a[172:175], v[180:183], v[148:151]
ds_read_b64_tr_b16 a[204:205], v199 offset:40960
v_mfma_f32_16x16x32_bf16 v[148:151], a[168:171], v[176:179], v[148:151]
s_waitcnt vmcnt(19)
s_waitcnt lgkmcnt(4)
ds_read_b64_tr_b16 a[206:207], v199 offset:45056
v_mfma_f32_16x16x32_bf16 v[136:139], a[176:179], a[24:27], v[136:139]
s_waitcnt vmcnt(15)
buffer_load_dwordx4 a[60:63], v15, s[44:47], s65 offen offset:1024 sc1
v_mfma_f32_16x16x32_bf16 v[136:139], a[180:183], a[28:31], v[136:139]
v_mfma_f32_16x16x32_bf16 v[104:107], a[180:183], a[20:23], v[104:107]
v_mfma_f32_16x16x32_bf16 v[104:107], a[176:179], a[16:19], v[104:107]
v_mfma_f32_16x16x32_bf16 v[72:75], a[176:179], a[8:11], v[72:75]
v_mfma_f32_16x16x32_bf16 v[72:75], a[180:183], a[12:15], v[72:75]
v_mfma_f32_16x16x32_bf16 v[40:43], a[180:183], a[4:7], v[40:43]
s_waitcnt vmcnt(8)
s_barrier
v_mfma_f32_16x16x32_bf16 v[40:43], a[176:179], a[0:3], v[40:43]
ds_read_b64_tr_b16 a[144:145], v188 offset:0
v_mfma_f32_16x16x32_bf16 v[44:47], a[184:187], a[0:3], v[44:47]
ds_read_b64_tr_b16 a[146:147], v188 offset:4096
v_mfma_f32_16x16x32_bf16 v[44:47], a[188:191], a[4:7], v[44:47]
ds_read_b64_tr_b16 a[148:149], v188 offset:8192
v_mfma_f32_16x16x32_bf16 v[76:79], a[188:191], a[12:15], v[76:79]
ds_read_b64_tr_b16 a[150:151], v188 offset:12288
v_mfma_f32_16x16x32_bf16 v[76:79], a[184:187], a[8:11], v[76:79]
ds_read_b64_tr_b16 a[152:153], v189 offset:0
v_mfma_f32_16x16x32_bf16 v[108:111], a[184:187], a[16:19], v[108:111]
ds_read_b64_tr_b16 a[154:155], v189 offset:4096
v_mfma_f32_16x16x32_bf16 v[108:111], a[188:191], a[20:23], v[108:111]
ds_read_b64_tr_b16 a[156:157], v189 offset:8192
v_mfma_f32_16x16x32_bf16 v[140:143], a[188:191], a[28:31], v[140:143]
ds_read_b64_tr_b16 a[158:159], v189 offset:12288
v_mfma_f32_16x16x32_bf16 v[140:143], a[184:187], a[24:27], v[140:143]
v_mfma_f32_16x16x32_bf16 v[144:147], a[192:195], a[24:27], v[144:147]
s_waitcnt lgkmcnt(6)
v_mfma_f32_16x16x32_bf16 v[144:147], a[196:199], a[28:31], v[144:147]
v_mfma_f32_16x16x32_bf16 v[112:115], a[196:199], a[20:23], v[112:115]
ds_read_b64_tr_b16 a[160:161], v190 offset:0
v_mfma_f32_16x16x32_bf16 v[112:115], a[192:195], a[16:19], v[112:115]
ds_read_b64_tr_b16 a[162:163], v190 offset:4096
v_mfma_f32_16x16x32_bf16 v[80:83], a[192:195], a[8:11], v[80:83]
ds_read_b64_tr_b16 a[164:165], v190 offset:8192
v_mfma_f32_16x16x32_bf16 v[80:83], a[196:199], a[12:15], v[80:83]
ds_read_b64_tr_b16 a[166:167], v190 offset:12288
v_mfma_f32_16x16x32_bf16 v[48:51], a[196:199], a[4:7], v[48:51]
v_mfma_f32_16x16x32_bf16 v[48:51], a[192:195], a[0:3], v[48:51]
v_mfma_f32_16x16x32_bf16 v[52:55], a[200:203], a[0:3], v[52:55]
v_mfma_f32_16x16x32_bf16 v[52:55], a[204:207], a[4:7], v[52:55]
v_mfma_f32_16x16x32_bf16 v[84:87], a[204:207], a[12:15], v[84:87]
ds_read_b64_tr_b16 a[168:169], v191 offset:0
v_mfma_f32_16x16x32_bf16 v[84:87], a[200:203], a[8:11], v[84:87]
ds_read_b64_tr_b16 a[170:171], v191 offset:4096
v_mfma_f32_16x16x32_bf16 v[116:119], a[200:203], a[16:19], v[116:119]
ds_read_b64_tr_b16 a[172:173], v191 offset:8192
v_mfma_f32_16x16x32_bf16 v[116:119], a[204:207], a[20:23], v[116:119]
ds_read_b64_tr_b16 a[174:175], v191 offset:12288
v_mfma_f32_16x16x32_bf16 v[148:151], a[204:207], a[28:31], v[148:151]
v_mfma_f32_16x16x32_bf16 v[148:151], a[200:203], a[24:27], v[148:151]
s_waitcnt vmcnt(4)
v_mfma_f32_16x16x32_bf16 v[136:139], a[144:147], a[56:59], v[136:139]
s_waitcnt vmcnt(0)
s_waitcnt lgkmcnt(4)
v_mfma_f32_16x16x32_bf16 v[136:139], a[148:151], a[60:63], v[136:139]
v_mfma_f32_16x16x32_bf16 v[104:107], a[148:151], a[52:55], v[104:107]
ds_read_b64_tr_b16 a[176:177], v192 offset:0
v_mfma_f32_16x16x32_bf16 v[104:107], a[144:147], a[48:51], v[104:107]
ds_read_b64_tr_b16 a[178:179], v192 offset:4096
v_mfma_f32_16x16x32_bf16 v[72:75], a[144:147], a[40:43], v[72:75]
ds_read_b64_tr_b16 a[180:181], v192 offset:8192
v_mfma_f32_16x16x32_bf16 v[72:75], a[148:151], a[44:47], v[72:75]
ds_read_b64_tr_b16 a[182:183], v192 offset:12288
v_mfma_f32_16x16x32_bf16 v[40:43], a[148:151], a[36:39], v[40:43]
v_mfma_f32_16x16x32_bf16 v[40:43], a[144:147], a[32:35], v[40:43]
v_mfma_f32_16x16x32_bf16 v[44:47], a[152:155], a[32:35], v[44:47]
v_mfma_f32_16x16x32_bf16 v[44:47], a[156:159], a[36:39], v[44:47]
ds_write_b128 v3, v[136:139] offset:4096
v_mfma_f32_16x16x32_bf16 v[76:79], a[156:159], a[44:47], v[76:79]
ds_read_b64_tr_b16 a[184:185], v193 offset:0
v_mfma_f32_16x16x32_bf16 v[76:79], a[152:155], a[40:43], v[76:79]
ds_write_b128 v3, v[104:107] offset:0
v_mfma_f32_16x16x32_bf16 v[108:111], a[152:155], a[48:51], v[108:111]
ds_read_b64_tr_b16 a[186:187], v193 offset:4096
v_mfma_f32_16x16x32_bf16 v[108:111], a[156:159], a[52:55], v[108:111]
ds_read_b64_tr_b16 a[188:189], v193 offset:8192
v_mfma_f32_16x16x32_bf16 v[140:143], a[156:159], a[60:63], v[140:143]
ds_read_b64_tr_b16 a[190:191], v193 offset:12288
v_mfma_f32_16x16x32_bf16 v[140:143], a[152:155], a[56:59], v[140:143]
v_mfma_f32_16x16x32_bf16 v[144:147], a[160:163], a[56:59], v[144:147]
v_mfma_f32_16x16x32_bf16 v[144:147], a[164:167], a[60:63], v[144:147]
v_mfma_f32_16x16x32_bf16 v[112:115], a[164:167], a[52:55], v[112:115]
ds_read_b64_tr_b16 a[192:193], v194 offset:0
v_mfma_f32_16x16x32_bf16 v[112:115], a[160:163], a[48:51], v[112:115]
ds_read_b64_tr_b16 a[194:195], v194 offset:4096
v_mfma_f32_16x16x32_bf16 v[80:83], a[160:163], a[40:43], v[80:83]
ds_read_b64_tr_b16 a[196:197], v194 offset:8192
v_mfma_f32_16x16x32_bf16 v[80:83], a[164:167], a[44:47], v[80:83]
ds_write_b128 v3, v[108:111] offset:1024
v_mfma_f32_16x16x32_bf16 v[48:51], a[164:167], a[36:39], v[48:51]
ds_read_b64_tr_b16 a[198:199], v194 offset:12288
v_mfma_f32_16x16x32_bf16 v[48:51], a[160:163], a[32:35], v[48:51]
s_waitcnt lgkmcnt(5)
ds_write_b128 v3, v[140:143] offset:5120
v_mfma_f32_16x16x32_bf16 v[52:55], a[168:171], a[32:35], v[52:55]
v_mfma_f32_16x16x32_bf16 v[52:55], a[172:175], a[36:39], v[52:55]
ds_write_b128 v3, v[144:147] offset:6144
v_mfma_f32_16x16x32_bf16 v[84:87], a[172:175], a[44:47], v[84:87]
ds_read_b64_tr_b16 a[200:201], v195 offset:0
v_mfma_f32_16x16x32_bf16 v[84:87], a[168:171], a[40:43], v[84:87]
ds_write_b128 v3, v[112:115] offset:2048
v_mfma_f32_16x16x32_bf16 v[116:119], a[168:171], a[48:51], v[116:119]
ds_read_b64_tr_b16 a[202:203], v195 offset:4096
v_mfma_f32_16x16x32_bf16 v[116:119], a[172:175], a[52:55], v[116:119]
ds_read_b64_tr_b16 a[204:205], v195 offset:8192
v_mfma_f32_16x16x32_bf16 v[148:151], a[172:175], a[60:63], v[148:151]
ds_read_b64_tr_b16 a[206:207], v195 offset:12288
v_mfma_f32_16x16x32_bf16 v[148:151], a[168:171], a[56:59], v[148:151]
v_mfma_f32_16x16x32_bf16 v[120:123], a[176:179], v[176:179], v[120:123]
v_mfma_f32_16x16x32_bf16 v[120:123], a[180:183], v[180:183], v[120:123]
v_mfma_f32_16x16x32_bf16 v[88:91], a[180:183], v[172:175], v[88:91]
ds_read_b64_tr_b16 a[144:145], v192 offset:32768
v_mfma_f32_16x16x32_bf16 v[88:91], a[176:179], v[168:171], v[88:91]
ds_read_b64_tr_b16 a[146:147], v192 offset:36864
v_mfma_f32_16x16x32_bf16 v[56:59], a[176:179], v[160:163], v[56:59]
ds_read_b64_tr_b16 a[148:149], v192 offset:40960
v_mfma_f32_16x16x32_bf16 v[56:59], a[180:183], v[164:167], v[56:59]
ds_write_b128 v3, v[116:119] offset:3072
v_mfma_f32_16x16x32_bf16 v[24:27], a[180:183], v[156:159], v[24:27]
ds_read_b64_tr_b16 a[150:151], v192 offset:45056
v_mfma_f32_16x16x32_bf16 v[24:27], a[176:179], v[152:155], v[24:27]
ds_write_b128 v3, v[148:151] offset:7168
v_mfma_f32_16x16x32_bf16 v[28:31], a[184:187], v[152:155], v[28:31]
v_mfma_f32_16x16x32_bf16 v[28:31], a[188:191], v[156:159], v[28:31]
v_mfma_f32_16x16x32_bf16 v[60:63], a[188:191], v[164:167], v[60:63]
s_waitcnt lgkmcnt(0)
s_barrier
v_mfma_f32_16x16x32_bf16 v[60:63], a[184:187], v[160:163], v[60:63]
ds_read_b128 v[200:203], v2 offset:0
ds_read_b128 v[204:207], v2 offset:1024
v_mfma_f32_16x16x32_bf16 v[92:95], a[184:187], v[168:171], v[92:95]
ds_read_b128 v[208:211], v2 offset:2048
ds_read_b128 v[212:215], v2 offset:3072
v_mfma_f32_16x16x32_bf16 v[92:95], a[188:191], v[172:175], v[92:95]
ds_read_b128 v[216:219], v2 offset:4096
ds_read_b128 v[220:223], v2 offset:5120
v_mfma_f32_16x16x32_bf16 v[124:127], a[188:191], v[180:183], v[124:127]
ds_read_b128 v[224:227], v2 offset:6144
ds_read_b128 v[228:231], v2 offset:7168
v_mfma_f32_16x16x32_bf16 v[124:127], a[184:187], v[176:179], v[124:127]
ds_read_b64_tr_b16 a[152:153], v193 offset:32768
v_mfma_f32_16x16x32_bf16 v[128:131], a[192:195], v[176:179], v[128:131]
ds_read_b64_tr_b16 a[154:155], v193 offset:36864
v_mfma_f32_16x16x32_bf16 v[128:131], a[196:199], v[180:183], v[128:131]
ds_read_b64_tr_b16 a[156:157], v193 offset:40960
v_mfma_f32_16x16x32_bf16 v[96:99], a[196:199], v[172:175], v[96:99]
s_waitcnt lgkmcnt(10)
ds_read_b64_tr_b16 a[158:159], v193 offset:45056
v_add_f32 v200, v200, v40
v_mfma_f32_16x16x32_bf16 v[96:99], a[192:195], v[168:171], v[96:99]
s_waitcnt lgkmcnt(10)
ds_read_b64_tr_b16 a[160:161], v194 offset:32768
v_add_f32 v201, v201, v41
v_add_f32 v202, v202, v42
v_add_f32 v203, v203, v43
v_add_f32 v204, v204, v44
v_add_f32 v205, v205, v45
v_add_f32 v206, v206, v46
v_add_f32 v207, v207, v47
v_cvt_pk_bf16_f32 v200, v200, v201
v_cvt_pk_bf16_f32 v201, v202, v203
v_cvt_pk_bf16_f32 v202, v204, v205
v_cvt_pk_bf16_f32 v203, v206, v207
v_mfma_f32_16x16x32_bf16 v[64:67], a[192:195], v[160:163], v[64:67]
buffer_store_dwordx4 v[200:203], v16, s[44:47], s73 offen offset:0 sc1
v_mfma_f32_16x16x32_bf16 v[64:67], a[196:199], v[164:167], v[64:67]
s_waitcnt lgkmcnt(7)
ds_read_b64_tr_b16 a[162:163], v194 offset:36864
v_add_f32 v208, v208, v48
v_add_f32 v209, v209, v49
v_add_f32 v210, v210, v50
v_add_f32 v211, v211, v51
v_add_f32 v212, v212, v52
v_add_f32 v213, v213, v53
v_add_f32 v214, v214, v54
v_add_f32 v215, v215, v55
v_cvt_pk_bf16_f32 v208, v208, v209
v_cvt_pk_bf16_f32 v209, v210, v211
v_cvt_pk_bf16_f32 v210, v212, v213
v_cvt_pk_bf16_f32 v211, v214, v215
v_mfma_f32_16x16x32_bf16 v[32:35], a[196:199], v[156:159], v[32:35]
buffer_store_dwordx4 v[208:211], v16, s[44:47], s73 offen offset:1024 sc1
v_mfma_f32_16x16x32_bf16 v[32:35], a[192:195], v[152:155], v[32:35]
ds_read_b64_tr_b16 a[164:165], v194 offset:40960
v_add_f32 v216, v216, v72
v_add_f32 v217, v217, v73
v_add_f32 v218, v218, v74
v_add_f32 v219, v219, v75
v_add_f32 v220, v220, v76
v_add_f32 v221, v221, v77
v_add_f32 v222, v222, v78
v_add_f32 v223, v223, v79
v_cvt_pk_bf16_f32 v216, v216, v217
v_cvt_pk_bf16_f32 v217, v218, v219
v_cvt_pk_bf16_f32 v218, v220, v221
v_cvt_pk_bf16_f32 v219, v222, v223
v_mfma_f32_16x16x32_bf16 v[36:39], a[200:203], v[152:155], v[36:39]
buffer_store_dwordx4 v[216:219], v16, s[44:47], s73 offen offset:2048 sc1
v_mfma_f32_16x16x32_bf16 v[36:39], a[204:207], v[156:159], v[36:39]
s_waitcnt lgkmcnt(4)
ds_read_b64_tr_b16 a[166:167], v194 offset:45056
v_add_f32 v224, v224, v80
v_add_f32 v225, v225, v81
v_add_f32 v226, v226, v82
v_add_f32 v227, v227, v83
v_add_f32 v228, v228, v84
v_add_f32 v229, v229, v85
v_add_f32 v230, v230, v86
v_add_f32 v231, v231, v87
v_cvt_pk_bf16_f32 v224, v224, v225
v_cvt_pk_bf16_f32 v225, v226, v227
v_cvt_pk_bf16_f32 v226, v228, v229
v_cvt_pk_bf16_f32 v227, v230, v231
v_mfma_f32_16x16x32_bf16 v[68:71], a[204:207], v[164:167], v[68:71]
buffer_store_dwordx4 v[224:227], v16, s[44:47], s73 offen offset:3072 sc1
v_mfma_f32_16x16x32_bf16 v[68:71], a[200:203], v[160:163], v[68:71]
ds_read_b64_tr_b16 a[168:169], v195 offset:32768
v_mfma_f32_16x16x32_bf16 v[100:103], a[200:203], v[168:171], v[100:103]
ds_read_b64_tr_b16 a[170:171], v195 offset:36864
v_mfma_f32_16x16x32_bf16 v[100:103], a[204:207], v[172:175], v[100:103]
ds_read_b64_tr_b16 a[172:173], v195 offset:40960
v_mfma_f32_16x16x32_bf16 v[132:135], a[204:207], v[180:183], v[132:135]
ds_read_b64_tr_b16 a[174:175], v195 offset:45056
v_mfma_f32_16x16x32_bf16 v[132:135], a[200:203], v[176:179], v[132:135]
v_mfma_f32_16x16x32_bf16 v[120:123], a[144:147], a[24:27], v[120:123]
v_mfma_f32_16x16x32_bf16 v[120:123], a[148:151], a[28:31], v[120:123]
v_mfma_f32_16x16x32_bf16 v[88:91], a[148:151], a[20:23], v[88:91]
ds_read_b64_tr_b16 a[176:177], v184 offset:0
v_mfma_f32_16x16x32_bf16 v[88:91], a[144:147], a[16:19], v[88:91]
ds_read_b64_tr_b16 a[178:179], v184 offset:4096
v_mfma_f32_16x16x32_bf16 v[56:59], a[144:147], a[8:11], v[56:59]
ds_read_b64_tr_b16 a[180:181], v184 offset:8192
v_mfma_f32_16x16x32_bf16 v[56:59], a[148:151], a[12:15], v[56:59]
ds_read_b64_tr_b16 a[182:183], v184 offset:12288
v_mfma_f32_16x16x32_bf16 v[24:27], a[148:151], a[4:7], v[24:27]
v_mfma_f32_16x16x32_bf16 v[24:27], a[144:147], a[0:3], v[24:27]
v_mfma_f32_16x16x32_bf16 v[28:31], a[152:155], a[0:3], v[28:31]
s_waitcnt lgkmcnt(4)
v_mfma_f32_16x16x32_bf16 v[28:31], a[156:159], a[4:7], v[28:31]
v_mfma_f32_16x16x32_bf16 v[60:63], a[156:159], a[12:15], v[60:63]
ds_read_b64_tr_b16 a[184:185], v185 offset:0
v_mfma_f32_16x16x32_bf16 v[60:63], a[152:155], a[8:11], v[60:63]
ds_read_b64_tr_b16 a[186:187], v185 offset:4096
v_mfma_f32_16x16x32_bf16 v[92:95], a[152:155], a[16:19], v[92:95]
ds_read_b64_tr_b16 a[188:189], v185 offset:8192
v_mfma_f32_16x16x32_bf16 v[92:95], a[156:159], a[20:23], v[92:95]
ds_read_b64_tr_b16 a[190:191], v185 offset:12288
v_mfma_f32_16x16x32_bf16 v[124:127], a[156:159], a[28:31], v[124:127]
v_mfma_f32_16x16x32_bf16 v[124:127], a[152:155], a[24:27], v[124:127]
v_mfma_f32_16x16x32_bf16 v[128:131], a[160:163], a[24:27], v[128:131]
v_mfma_f32_16x16x32_bf16 v[128:131], a[164:167], a[28:31], v[128:131]
v_mfma_f32_16x16x32_bf16 v[96:99], a[164:167], a[20:23], v[96:99]
ds_read_b64_tr_b16 a[192:193], v186 offset:0
v_mfma_f32_16x16x32_bf16 v[96:99], a[160:163], a[16:19], v[96:99]
ds_read_b64_tr_b16 a[194:195], v186 offset:4096
v_mfma_f32_16x16x32_bf16 v[64:67], a[160:163], a[8:11], v[64:67]
ds_read_b64_tr_b16 a[196:197], v186 offset:8192
v_mfma_f32_16x16x32_bf16 v[64:67], a[164:167], a[12:15], v[64:67]
ds_read_b64_tr_b16 a[198:199], v186 offset:12288
v_mfma_f32_16x16x32_bf16 v[32:35], a[164:167], a[4:7], v[32:35]
s_branch L_po23
L_pg23:
s_branch L_tr2
L_po23:
v_mfma_f32_16x16x32_bf16 v[32:35], a[160:163], a[0:3], v[32:35]
v_mfma_f32_16x16x32_bf16 v[36:39], a[168:171], a[0:3], v[36:39]
v_mfma_f32_16x16x32_bf16 v[36:39], a[172:175], a[4:7], v[36:39]
v_mfma_f32_16x16x32_bf16 v[68:71], a[172:175], a[12:15], v[68:71]
ds_read_b64_tr_b16 a[200:201], v187 offset:0
v_mfma_f32_16x16x32_bf16 v[68:71], a[168:171], a[8:11], v[68:71]
ds_read_b64_tr_b16 a[202:203], v187 offset:4096
v_mfma_f32_16x16x32_bf16 v[100:103], a[168:171], a[16:19], v[100:103]
ds_read_b64_tr_b16 a[204:205], v187 offset:8192
v_mfma_f32_16x16x32_bf16 v[100:103], a[172:175], a[20:23], v[100:103]
ds_read_b64_tr_b16 a[206:207], v187 offset:12288
v_mfma_f32_16x16x32_bf16 v[132:135], a[172:175], a[28:31], v[132:135]
v_mfma_f32_16x16x32_bf16 v[132:135], a[168:171], a[24:27], v[132:135]
s_waitcnt lgkmcnt(4)
v_mfma_f32_16x16x32_bf16 v[120:123], a[176:179], a[56:59], v[120:123]
v_mfma_f32_16x16x32_bf16 v[120:123], a[180:183], a[60:63], v[120:123]
v_mfma_f32_16x16x32_bf16 v[88:91], a[180:183], a[52:55], v[88:91]
buffer_load_dwordx4 v[152:155], v16, s[44:47], s75 offen offset:0 sc1
v_mfma_f32_16x16x32_bf16 v[88:91], a[176:179], a[48:51], v[88:91]
v_mfma_f32_16x16x32_bf16 v[56:59], a[176:179], a[40:43], v[56:59]
buffer_load_dwordx4 v[156:159], v16, s[44:47], s75 offen offset:1024 sc1
v_mfma_f32_16x16x32_bf16 v[56:59], a[180:183], a[44:47], v[56:59]
v_mfma_f32_16x16x32_bf16 v[24:27], a[180:183], a[36:39], v[24:27]
buffer_load_dwordx4 v[160:163], v16, s[44:47], s75 offen offset:2048 sc1
v_mfma_f32_16x16x32_bf16 v[24:27], a[176:179], a[32:35], v[24:27]
v_mfma_f32_16x16x32_bf16 v[28:31], a[184:187], a[32:35], v[28:31]
buffer_load_dwordx4 v[164:167], v16, s[44:47], s75 offen offset:3072 sc1
v_mfma_f32_16x16x32_bf16 v[28:31], a[188:191], a[36:39], v[28:31]
ds_write_b128 v5, v[120:123] offset:4096
v_mfma_f32_16x16x32_bf16 v[60:63], a[188:191], a[44:47], v[60:63]
v_mfma_f32_16x16x32_bf16 v[60:63], a[184:187], a[40:43], v[60:63]
ds_write_b128 v5, v[88:91] offset:0
v_mfma_f32_16x16x32_bf16 v[92:95], a[184:187], a[48:51], v[92:95]
v_mfma_f32_16x16x32_bf16 v[92:95], a[188:191], a[52:55], v[92:95]
v_mfma_f32_16x16x32_bf16 v[124:127], a[188:191], a[60:63], v[124:127]
v_mfma_f32_16x16x32_bf16 v[124:127], a[184:187], a[56:59], v[124:127]
v_mfma_f32_16x16x32_bf16 v[128:131], a[192:195], a[56:59], v[128:131]
v_mfma_f32_16x16x32_bf16 v[128:131], a[196:199], a[60:63], v[128:131]
v_mfma_f32_16x16x32_bf16 v[96:99], a[196:199], a[52:55], v[96:99]
v_mfma_f32_16x16x32_bf16 v[96:99], a[192:195], a[48:51], v[96:99]
v_mfma_f32_16x16x32_bf16 v[64:67], a[192:195], a[40:43], v[64:67]
v_mfma_f32_16x16x32_bf16 v[64:67], a[196:199], a[44:47], v[64:67]
ds_write_b128 v5, v[92:95] offset:1024
v_mfma_f32_16x16x32_bf16 v[32:35], a[196:199], a[36:39], v[32:35]
v_mfma_f32_16x16x32_bf16 v[32:35], a[192:195], a[32:35], v[32:35]
s_waitcnt lgkmcnt(1)
ds_write_b128 v5, v[124:127] offset:5120
v_mfma_f32_16x16x32_bf16 v[36:39], a[200:203], a[32:35], v[36:39]
v_mfma_f32_16x16x32_bf16 v[36:39], a[204:207], a[36:39], v[36:39]
ds_write_b128 v5, v[128:131] offset:6144
v_mfma_f32_16x16x32_bf16 v[68:71], a[204:207], a[44:47], v[68:71]
v_mfma_f32_16x16x32_bf16 v[68:71], a[200:203], a[40:43], v[68:71]
ds_write_b128 v5, v[96:99] offset:2048
v_mfma_f32_16x16x32_bf16 v[100:103], a[200:203], a[48:51], v[100:103]
v_mfma_f32_16x16x32_bf16 v[100:103], a[204:207], a[52:55], v[100:103]
v_mfma_f32_16x16x32_bf16 v[132:135], a[204:207], a[60:63], v[132:135]
v_mfma_f32_16x16x32_bf16 v[132:135], a[200:203], a[56:59], v[132:135]
s_mov_b32 s72, 0x20000
s_nop 6
ds_write_b128 v5, v[100:103] offset:3072
ds_write_b128 v5, v[132:135] offset:7168
s_waitcnt lgkmcnt(0)
s_barrier
ds_read_b128 v[88:91], v4 offset:0
ds_read_b128 v[92:95], v4 offset:1024
ds_read_b128 v[96:99], v4 offset:2048
ds_read_b128 v[100:103], v4 offset:3072
ds_read_b128 v[120:123], v4 offset:4096
ds_read_b128 v[124:127], v4 offset:5120
ds_read_b128 v[128:131], v4 offset:6144
ds_read_b128 v[132:135], v4 offset:7168
s_waitcnt lgkmcnt(7)
v_add_f32 v24, v24, v88
v_add_f32 v25, v25, v89
v_add_f32 v26, v26, v90
v_add_f32 v27, v27, v91
s_waitcnt lgkmcnt(6)
v_add_f32 v28, v28, v92
v_add_f32 v29, v29, v93
v_add_f32 v30, v30, v94
v_add_f32 v31, v31, v95
s_waitcnt lgkmcnt(5)
v_add_f32 v32, v32, v96
v_add_f32 v33, v33, v97
v_add_f32 v34, v34, v98
v_add_f32 v35, v35, v99
s_waitcnt lgkmcnt(4)
v_add_f32 v36, v36, v100
v_add_f32 v37, v37, v101
v_add_f32 v38, v38, v102
v_add_f32 v39, v39, v103
s_waitcnt lgkmcnt(3)
v_add_f32 v56, v56, v120
v_add_f32 v57, v57, v121
v_add_f32 v58, v58, v122
v_add_f32 v59, v59, v123
s_waitcnt lgkmcnt(2)
v_add_f32 v60, v60, v124
v_add_f32 v61, v61, v125
v_add_f32 v62, v62, v126
v_add_f32 v63, v63, v127
s_waitcnt lgkmcnt(1)
v_add_f32 v64, v64, v128
v_add_f32 v65, v65, v129
v_add_f32 v66, v66, v130
v_add_f32 v67, v67, v131
s_waitcnt lgkmcnt(0)
v_add_f32 v68, v68, v132
v_add_f32 v69, v69, v133
v_add_f32 v70, v70, v134
v_add_f32 v71, v71, v135
s_waitcnt vmcnt(0)
L_xchk:
v_max3_u32 v9, v152, v153, v154
v_max3_u32 v9, v9, v155, v156
v_max3_u32 v9, v9, v157, v158
v_max3_u32 v9, v9, v159, v160
v_max3_u32 v9, v9, v161, v162
v_max3_u32 v9, v9, v163, v164
v_max3_u32 v9, v9, v165, v166
v_max_u32 v9, v9, v167
v_cmp_eq_u32 vcc, -1, v9
s_cbranch_vccnz L_xretry
L_xgo:
v_mfma_f32_16x16x32_bf16 v[24:27], v[234:237], v[152:155], v[24:27]
v_mfma_f32_16x16x32_bf16 v[28:31], v[232:235], v[152:155], v[28:31]
v_mfma_f32_16x16x32_bf16 v[32:35], v[234:237], v[156:159], v[32:35]
v_mfma_f32_16x16x32_bf16 v[36:39], v[232:235], v[156:159], v[36:39]
v_mfma_f32_16x16x32_bf16 v[56:59], v[234:237], v[160:163], v[56:59]
v_mfma_f32_16x16x32_bf16 v[60:63], v[232:235], v[160:163], v[60:63]
v_mfma_f32_16x16x32_bf16 v[64:67], v[234:237], v[164:167], v[64:67]
v_mfma_f32_16x16x32_bf16 v[68:71], v[232:235], v[164:167], v[68:71]
s_nop 1
v_cvt_pk_bf16_f32 v24, v24, v25
v_cvt_pk_bf16_f32 v25, v26, v27
v_cvt_pk_bf16_f32 v26, v28, v29
v_cvt_pk_bf16_f32 v27, v30, v31
v_cvt_pk_bf16_f32 v32, v32, v33
v_cvt_pk_bf16_f32 v33, v34, v35
v_cvt_pk_bf16_f32 v34, v36, v37
v_cvt_pk_bf16_f32 v35, v38, v39
v_permlane16_swap_b32 v24, v26
v_permlane16_swap_b32 v25, v27
v_permlane16_swap_b32 v32, v34
v_permlane16_swap_b32 v33, v35
v_mov_b32 v28, v24
v_mov_b32 v29, v25
v_mov_b32 v30, v26
v_mov_b32 v31, v27
v_mov_b32_dpp v24, v32 row_ror:8 row_mask:0xf bank_mask:0xc
v_mov_b32_dpp v25, v33 row_ror:8 row_mask:0xf bank_mask:0xc
v_mov_b32_dpp v26, v34 row_ror:8 row_mask:0xf bank_mask:0xc
v_mov_b32_dpp v27, v35 row_ror:8 row_mask:0xf bank_mask:0xc
v_mov_b32_dpp v32, v28 row_ror:8 row_mask:0xf bank_mask:0x3
v_mov_b32_dpp v33, v29 row_ror:8 row_mask:0xf bank_mask:0x3
v_mov_b32_dpp v34, v30 row_ror:8 row_mask:0xf bank_mask:0x3
v_mov_b32_dpp v35, v31 row_ror:8 row_mask:0xf bank_mask:0x3
buffer_store_dwordx4 v[24:27], v8, s[48:51], s77 offen sc1
s_add_u32 s77, s77, 16384
buffer_store_dwordx4 v[32:35], v8, s[48:51], s77 offen sc1
s_add_u32 s77, s77, 16384
v_cvt_pk_bf16_f32 v56, v56, v57
v_cvt_pk_bf16_f32 v57, v58, v59
v_cvt_pk_bf16_f32 v58, v60, v61
v_cvt_pk_bf16_f32 v59, v62, v63
v_cvt_pk_bf16_f32 v64, v64, v65
v_cvt_pk_bf16_f32 v65, v66, v67
v_cvt_pk_bf16_f32 v66, v68, v69
v_cvt_pk_bf16_f32 v67, v70, v71
v_permlane16_swap_b32 v56, v58
v_permlane16_swap_b32 v57, v59
v_permlane16_swap_b32 v64, v66
v_permlane16_swap_b32 v65, v67
v_mov_b32 v60, v56
v_mov_b32 v61, v57
v_mov_b32 v62, v58
v_mov_b32 v63, v59
v_mov_b32_dpp v56, v64 row_ror:8 row_mask:0xf bank_mask:0xc
v_mov_b32_dpp v57, v65 row_ror:8 row_mask:0xf bank_mask:0xc
v_mov_b32_dpp v58, v66 row_ror:8 row_mask:0xf bank_mask:0xc
v_mov_b32_dpp v59, v67 row_ror:8 row_mask:0xf bank_mask:0xc
v_mov_b32_dpp v64, v60 row_ror:8 row_mask:0xf bank_mask:0x3
v_mov_b32_dpp v65, v61 row_ror:8 row_mask:0xf bank_mask:0x3
v_mov_b32_dpp v66, v62 row_ror:8 row_mask:0xf bank_mask:0x3
v_mov_b32_dpp v67, v63 row_ror:8 row_mask:0xf bank_mask:0x3
buffer_store_dwordx4 v[56:59], v8, s[48:51], s77 offen sc1
s_add_u32 s77, s77, 16384
buffer_store_dwordx4 v[64:67], v8, s[48:51], s77 offen sc1
s_add_u32 s77, s77, 16384
L_end:
s_endpgm
L_xretry:
s_sub_u32 s72, s72, 1
s_cbranch_scc1 L_xgo
buffer_load_dwordx4 v[152:155], v16, s[44:47], s75 offen offset:0 sc1
buffer_load_dwordx4 v[156:159], v16, s[44:47], s75 offen offset:1024 sc1
buffer_load_dwordx4 v[160:163], v16, s[44:47], s75 offen offset:2048 sc1
buffer_load_dwordx4 v[164:167], v16, s[44:47], s75 offen offset:3072 sc1
s_waitcnt vmcnt(0)
s_branch L_xchk
L_spin_1:
s_mov_b32 vcc_hi, 0x80000
L_spinlp_3:
s_sleep 1
buffer_load_dword v1, off, s[52:55], s78 offset:0 sc1
s_waitcnt vmcnt(0)
v_readfirstlane_b32 vcc_lo, v1
s_sub_u32 vcc_hi, vcc_hi, 1
s_cbranch_scc1 L_spinbk_2
s_cmp_lt_u32 vcc_lo, s81
s_cbranch_scc1 L_spinlp_3
s_branch L_spinbk_2
L_spin_4:
s_mov_b32 vcc_hi, 0x80000
L_spinlp_6:
s_sleep 1
buffer_load_dword v1, off, s[52:55], s70 offset:0 sc1
s_waitcnt vmcnt(0)
v_readfirstlane_b32 vcc_lo, v1
s_sub_u32 vcc_hi, vcc_hi, 1
s_cbranch_scc1 L_spinbk_5
s_cmp_lt_u32 vcc_lo, s81
s_cbranch_scc1 L_spinlp_6
s_branch L_spinbk_5
L_hretry:
s_sub_u32 s72, s72, 1
s_cbranch_scc1 L_hgo
buffer_load_dwordx4 v[136:139], v16, s[44:47], s77 offen sc1
s_waitcnt vmcnt(0)
v_max3_u32 v1, v136, v137, v138
v_max_u32 v1, v1, v139
v_cmp_eq_u32 vcc, -1, v1
s_cbranch_vccnz L_hretry
s_branch L_hgo
L_spin_8:
s_mov_b32 vcc_hi, 0x80000
L_spinlp_10:
s_sleep 1
buffer_load_dword v19, off, s[52:55], s80 offset:0 sc1
s_waitcnt vmcnt(0)
v_readfirstlane_b32 vcc_lo, v19
s_sub_u32 vcc_hi, vcc_hi, 1
s_cbranch_scc1 L_spinbk_9
s_cmp_lt_u32 vcc_lo, s69
s_cbranch_scc1 L_spinlp_10
s_branch L_spinbk_9
L_spin_1012:
s_mov_b32 vcc_hi, 0x80000
L_spinlp_1014:
s_sleep 1
buffer_load_dword v19, off, s[52:55], s80 offset:0 sc1
s_waitcnt vmcnt(0)
v_readfirstlane_b32 vcc_lo, v19
s_sub_u32 vcc_hi, vcc_hi, 1
s_cbranch_scc1 L_spinbk_1013
s_cmp_lt_u32 vcc_lo, s69
s_cbranch_scc1 L_spinlp_1014
s_branch L_spinbk_1013
L_F1:
s_waitcnt lgkmcnt(7)
v_mfma_f32_16x16x32_bf16 v[104:107], a[144:147], v[40:43], 0
s_waitcnt lgkmcnt(6)
ds_read_b128 a[176:179], v2 offset:8192
v_cndmask_b32 v88, 0, v17, s[0:1]
v_mfma_f32_16x16x32_bf16 v[104:107], a[148:151], v[44:47], v[104:107]
s_waitcnt lgkmcnt(6)
ds_read_b128 a[180:183], v2 offset:9216
v_cndmask_b32 v89, 0, v17, s[4:5]
v_mfma_f32_16x16x32_bf16 v[104:107], a[152:155], v[48:51], v[104:107]
s_waitcnt lgkmcnt(6)
buffer_load_dwordx4 v16, s[32:35], s70 offen offset:2048 sc1 lds
v_mfma_f32_16x16x32_bf16 v[104:107], a[156:159], v[52:55], v[104:107]
ds_read_b128 a[184:187], v2 offset:10240
v_cndmask_b32 v90, 0, v17, s[6:7]
v_mfma_f32_16x16x32_bf16 v[120:123], a[156:159], v[68:71], 0
ds_read_b128 a[188:191], v2 offset:11264
v_cndmask_b32 v91, 0, v17, s[8:9]
v_mfma_f32_16x16x32_bf16 v[120:123], a[152:155], v[64:67], v[120:123]
ds_read_b128 a[192:195], v2 offset:12288
v_accvgpr_write_b32 a128, 0
v_mfma_f32_16x16x32_bf16 v[120:123], a[148:151], v[60:63], v[120:123]
ds_read_b128 a[196:199], v2 offset:13312
v_accvgpr_write_b32 a129, 0
v_mfma_f32_16x16x32_bf16 v[120:123], a[144:147], v[56:59], v[120:123]
ds_read_b128 a[200:203], v2 offset:14336
v_accvgpr_write_b32 a130, 0
v_mfma_f32_16x16x32_bf16 v[136:139], a[144:147], v[72:75], 0
ds_read_b128 a[204:207], v2 offset:15360
v_accvgpr_write_b32 a131, 0
v_mfma_f32_16x16x32_bf16 v[136:139], a[148:151], v[76:79], v[136:139]
buffer_load_dwordx4 v16, s[32:35], s70 offen offset:3072 sc1 lds
v_mfma_f32_16x16x32_bf16 v[136:139], a[152:155], v[80:83], v[136:139]
v_accvgpr_write_b32 a132, 0
v_accvgpr_write_b32 a133, 0
v_mfma_f32_16x16x32_bf16 v[136:139], a[156:159], v[84:87], v[136:139]
v_accvgpr_write_b32 a134, 0
v_accvgpr_write_b32 a135, 0
v_mfma_f32_16x16x32_bf16 v[88:91], a[156:159], v[36:39], v[88:91]
v_accvgpr_write_b32 a136, 0
v_accvgpr_write_b32 a137, 0
v_mfma_f32_16x16x32_bf16 v[88:91], a[152:155], v[32:35], v[88:91]
v_accvgpr_write_b32 a138, 0
v_accvgpr_write_b32 a139, 0
v_mfma_f32_16x16x32_bf16 v[88:91], a[148:151], v[28:31], v[88:91]
v_accvgpr_write_b32 a140, 0
v_accvgpr_write_b32 a141, 0
v_mfma_f32_16x16x32_bf16 v[88:91], a[144:147], v[24:27], v[88:91]
s_waitcnt lgkmcnt(0)
s_nop 1
v_max3_f32 v21, v104, v105, v106
v_max_f32 v21, v21, v107
v_max3_f32 v22, v120, v121, v122
v_max_f32 v22, v22, v123
v_max3_f32 v23, v136, v137, v138
v_max_f32 v23, v23, v139
v_max3_f32 v20, v88, v89, v90
v_max_f32 v20, v20, v91
v_mov_b32 v248, v20
v_mov_b32 v249, v21
v_mov_b32 v250, v22
v_mov_b32 v251, v23
v_permlane16_swap_b32 v248, v20
v_permlane16_swap_b32 v249, v21
v_permlane16_swap_b32 v250, v22
v_permlane16_swap_b32 v251, v23
v_max_f32 v20, v20, v248
v_max_f32 v21, v21, v249
v_max_f32 v22, v22, v250
v_max_f32 v23, v23, v251
v_mov_b32 v248, v20
v_mov_b32 v249, v21
v_mov_b32 v250, v22
v_mov_b32 v251, v23
v_permlane32_swap_b32 v248, v20
v_permlane32_swap_b32 v249, v21
v_permlane32_swap_b32 v250, v22
v_permlane32_swap_b32 v251, v23
v_max_f32 v20, v20, v248
v_max_f32 v21, v21, v249
v_max_f32 v22, v22, v250
v_max_f32 v23, v23, v251
s_cmp_eq_u32 s73, 0
s_cselect_b64 vcc, 0, -1
v_cndmask_b32 v20, v20, v252, vcc
v_cndmask_b32 v21, v21, v253, vcc
v_cndmask_b32 v22, v22, v254, vcc
v_cndmask_b32 v23, v23, v255, vcc
v_sub_f32 v228, 0, v23
v_sub_f32 v229, 0, v23
v_sub_f32 v230, 0, v23
v_sub_f32 v231, 0, v23
v_sub_f32 v224, 0, v22
v_sub_f32 v225, 0, v22
v_sub_f32 v226, 0, v22
v_sub_f32 v227, 0, v22
v_sub_f32 v220, 0, v21
v_sub_f32 v221, 0, v21
v_sub_f32 v222, 0, v21
v_sub_f32 v223, 0, v21
v_sub_f32 v216, 0, v20
v_sub_f32 v217, 0, v20
v_sub_f32 v218, 0, v20
v_sub_f32 v219, 0, v20
v_mfma_f32_16x16x32_bf16 v[140:143], a[160:163], v[72:75], v[228:231]
s_add_u32 m0, s71, 4096
v_add_f32 v104, v104, v220
v_add_f32 v105, v105, v220
v_mfma_f32_16x16x32_bf16 v[140:143], a[164:167], v[76:79], v[140:143]
v_add_f32 v106, v106, v220
v_add_f32 v107, v107, v220
v_exp_f32 v104, v104
v_mfma_f32_16x16x32_bf16 v[140:143], a[168:171], v[80:83], v[140:143]
s_add_u32 s64, s70, 4096
v_exp_f32 v105, v105
v_mfma_f32_16x16x32_bf16 v[140:143], a[172:175], v[84:87], v[140:143]
buffer_load_dwordx4 v16, s[32:35], s64 offen offset:0 sc1 lds
v_mfma_f32_16x16x32_bf16 v[124:127], a[172:175], v[68:71], v[224:227]
v_exp_f32 v106, v106
v_mfma_f32_16x16x32_bf16 v[124:127], a[168:171], v[64:67], v[124:127]
v_exp_f32 v107, v107
v_mfma_f32_16x16x32_bf16 v[124:127], a[164:167], v[60:63], v[124:127]
v_add_f32 v120, v120, v224
v_add_f32 v121, v121, v224
v_add_f32 v122, v122, v224
v_add_f32 v123, v123, v224
v_exp_f32 v120, v120
v_mfma_f32_16x16x32_bf16 v[124:127], a[160:163], v[56:59], v[124:127]
v_exp_f32 v121, v121
v_mfma_f32_16x16x32_bf16 v[108:111], a[160:163], v[40:43], v[220:223]
v_exp_f32 v122, v122
v_mfma_f32_16x16x32_bf16 v[108:111], a[164:167], v[44:47], v[108:111]
v_cndmask_b32 v92, v216, v17, s[10:11]
v_cndmask_b32 v93, v216, v17, s[12:13]
v_cndmask_b32 v94, v216, v17, s[18:19]
v_cndmask_b32 v95, v216, v17, s[22:23]
v_mfma_f32_16x16x32_bf16 v[108:111], a[168:171], v[48:51], v[108:111]
buffer_load_dwordx4 v16, s[32:35], s64 offen offset:1024 sc1 lds
v_cvt_pk_bf16_f32 v160, v104, v105
v_mfma_f32_16x16x32_bf16 v[108:111], a[172:175], v[52:55], v[108:111]
v_exp_f32 v123, v123
v_mfma_f32_16x16x32_bf16 v[92:95], a[172:175], v[36:39], v[92:95]
v_add_f32 v136, v136, v228
v_add_f32 v137, v137, v228
v_add_f32 v138, v138, v228
v_add_f32 v139, v139, v228
v_exp_f32 v136, v136
v_mfma_f32_16x16x32_bf16 v[92:95], a[168:171], v[32:35], v[92:95]
v_cvt_pk_bf16_f32 v161, v106, v107
v_exp_f32 v137, v137
v_cndmask_b32 v96, v216, v17, s[26:27]
v_cndmask_b32 v97, v216, v17, s[56:57]
v_cndmask_b32 v98, v216, v17, s[58:59]
v_cndmask_b32 v99, v216, v17, s[60:61]
v_mfma_f32_16x16x32_bf16 v[92:95], a[164:167], v[28:31], v[92:95]
v_exp_f32 v138, v138
v_mfma_f32_16x16x32_bf16 v[92:95], a[160:163], v[24:27], v[92:95]
v_exp_f32 v139, v139
v_mfma_f32_16x16x32_bf16 v[96:99], a[176:179], v[24:27], v[96:99]
v_cvt_pk_bf16_f32 v184, v120, v121
v_add_f32 v88, v88, v216
v_mfma_f32_16x16x32_bf16 v[96:99], a[180:183], v[28:31], v[96:99]
buffer_load_dwordx4 v16, s[32:35], s64 offen offset:2048 sc1 lds
v_add_f32 v89, v89, v216
v_add_f32 v90, v90, v216
v_add_f32 v91, v91, v216
v_exp_f32 v88, v88
v_mfma_f32_16x16x32_bf16 v[96:99], a[184:187], v[32:35], v[96:99]
v_exp_f32 v89, v89
v_mfma_f32_16x16x32_bf16 v[96:99], a[188:191], v[36:39], v[96:99]
v_cvt_pk_bf16_f32 v185, v122, v123
v_cvt_pk_bf16_f32 v192, v136, v137
v_mfma_f32_16x16x32_bf16 v[112:115], a[188:191], v[52:55], v[220:223]
v_exp_f32 v90, v90
v_mfma_f32_16x16x32_bf16 v[112:115], a[184:187], v[48:51], v[112:115]
v_exp_f32 v91, v91
v_mfma_f32_16x16x32_bf16 v[112:115], a[180:183], v[44:47], v[112:115]
v_exp_f32 v140, v140
v_mfma_f32_16x16x32_bf16 v[112:115], a[176:179], v[40:43], v[112:115]
v_exp_f32 v141, v141
v_mfma_f32_16x16x32_bf16 v[128:131], a[176:179], v[56:59], v[224:227]
buffer_load_dwordx4 v16, s[32:35], s64 offen offset:3072 sc1 lds
v_cvt_pk_bf16_f32 v193, v138, v139
v_mfma_f32_16x16x32_bf16 v[128:131], a[180:183], v[60:63], v[128:131]
v_exp_f32 v142, v142
v_mfma_f32_16x16x32_bf16 v[128:131], a[184:187], v[64:67], v[128:131]
v_exp_f32 v143, v143
v_mfma_f32_16x16x32_bf16 v[128:131], a[188:191], v[68:71], v[128:131]
v_cvt_pk_bf16_f32 v152, v88, v89
v_cvt_pk_bf16_f32 v153, v90, v91
v_mfma_f32_16x16x32_bf16 v[144:147], a[188:191], v[84:87], v[228:231]
v_exp_f32 v124, v124
v_mfma_f32_16x16x32_bf16 v[144:147], a[184:187], v[80:83], v[144:147]
v_exp_f32 v125, v125
v_mfma_f32_16x16x32_bf16 v[144:147], a[180:183], v[76:79], v[144:147]
s_waitcnt vmcnt(6)
s_barrier
v_mfma_f32_16x16x32_bf16 v[144:147], a[176:179], v[72:75], v[144:147]
v_exp_f32 v126, v126
v_mfma_f32_16x16x32_bf16 v[148:151], a[192:195], v[72:75], v[228:231]
v_cvt_pk_bf16_f32 v194, v140, v141
v_cvt_pk_bf16_f32 v195, v142, v143
v_mfma_f32_16x16x32_bf16 v[148:151], a[196:199], v[76:79], v[148:151]
v_exp_f32 v127, v127
v_mfma_f32_16x16x32_bf16 v[148:151], a[200:203], v[80:83], v[148:151]
s_xor_b32 s71, s71, 16384
v_exp_f32 v108, v108
v_mfma_f32_16x16x32_bf16 v[148:151], a[204:207], v[84:87], v[148:151]
s_add_u32 s70, s70, 32768
v_exp_f32 v109, v109
v_mfma_f32_16x16x32_bf16 v[132:135], a[204:207], v[68:71], v[224:227]
s_mov_b32 m0, s71
v_exp_f32 v110, v110
v_mfma_f32_16x16x32_bf16 v[132:135], a[200:203], v[64:67], v[132:135]
buffer_load_dwordx4 v16, s[32:35], s70 offen offset:0 sc1 lds
v_mfma_f32_16x16x32_bf16 v[132:135], a[196:199], v[60:63], v[132:135]
v_cvt_pk_bf16_f32 v186, v124, v125
v_exp_f32 v111, v111
v_mfma_f32_16x16x32_bf16 v[132:135], a[192:195], v[56:59], v[132:135]
v_exp_f32 v92, v92
v_mfma_f32_16x16x32_bf16 v[116:119], a[192:195], v[40:43], v[220:223]
ds_read_b128 a[144:147], v2 offset:16384
v_cndmask_b32 v100, v216, v17, s[62:63]
v_mfma_f32_16x16x32_bf16 v[116:119], a[196:199], v[44:47], v[116:119]
ds_read_b128 a[148:151], v2 offset:17408
v_cndmask_b32 v101, v216, v17, s[48:49]
v_cndmask_b32 v102, v216, v17, s[50:51]
v_cndmask_b32 v103, v216, v17, s[100:101]
v_cvt_pk_bf16_f32 v187, v126, v127
v_exp_f32 v93, v93
v_mfma_f32_16x16x32_bf16 v[116:119], a[200:203], v[48:51], v[116:119]
v_exp_f32 v94, v94
v_mfma_f32_16x16x32_bf16 v[116:119], a[204:207], v[52:55], v[116:119]
ds_read_b128 a[152:155], v2 offset:18432
v_cvt_pk_bf16_f32 v162, v108, v109
v_mfma_f32_16x16x32_bf16 v[100:103], a[204:207], v[36:39], v[100:103]
buffer_load_dwordx4 v16, s[32:35], s70 offen offset:1024 sc1 lds
v_exp_f32 v95, v95
v_mfma_f32_16x16x32_bf16 v[100:103], a[200:203], v[32:35], v[100:103]
ds_read_b128 a[156:159], v2 offset:19456
v_exp_f32 v96, v96
v_mfma_f32_16x16x32_bf16 v[100:103], a[196:199], v[28:31], v[100:103]
v_cvt_pk_bf16_f32 v163, v110, v111
v_exp_f32 v97, v97
v_mfma_f32_16x16x32_bf16 v[100:103], a[192:195], v[24:27], v[100:103]
s_waitcnt lgkmcnt(2)
ds_read_b128 a[160:163], v2 offset:20480
ds_read_b128 a[164:167], v2 offset:21504
ds_read_b128 a[168:171], v2 offset:22528
ds_read_b128 a[172:175], v2 offset:23552
v_mfma_f32_16x16x32_bf16 v[120:123], a[144:147], v[56:59], v[224:227]
v_exp_f32 v98, v98
v_mfma_f32_16x16x32_bf16 v[120:123], a[148:151], v[60:63], v[120:123]
s_waitcnt lgkmcnt(5)
v_cvt_pk_bf16_f32 v154, v92, v93
v_exp_f32 v99, v99
v_mfma_f32_16x16x32_bf16 v[120:123], a[152:155], v[64:67], v[120:123]
s_waitcnt lgkmcnt(4)
v_exp_f32 v112, v112
v_mfma_f32_16x16x32_bf16 v[120:123], a[156:159], v[68:71], v[120:123]
v_exp_f32 v113, v113
v_mfma_f32_16x16x32_bf16 v[136:139], a[156:159], v[84:87], v[228:231]
v_cvt_pk_bf16_f32 v155, v94, v95
v_cndmask_b32 v104, v220, v17, s[0:1]
v_mfma_f32_16x16x32_bf16 v[136:139], a[152:155], v[80:83], v[136:139]
ds_read_b128 a[176:179], v2 offset:24576
buffer_load_dwordx4 v16, s[32:35], s70 offen offset:2048 sc1 lds
v_cndmask_b32 v105, v220, v17, s[4:5]
v_cndmask_b32 v106, v220, v17, s[6:7]
v_cndmask_b32 v107, v220, v17, s[8:9]
v_exp_f32 v114, v114
v_mfma_f32_16x16x32_bf16 v[136:139], a[148:151], v[76:79], v[136:139]
v_cvt_pk_bf16_f32 v156, v96, v97
v_cvt_pk_bf16_f32 v157, v98, v99
v_mfma_f32_16x16x32_bf16 v[136:139], a[144:147], v[72:75], v[136:139]
v_exp_f32 v115, v115
v_mfma_f32_16x16x32_bf16 v[104:107], a[144:147], v[40:43], v[104:107]
v_exp_f32 v128, v128
v_mfma_f32_16x16x32_bf16 v[104:107], a[148:151], v[44:47], v[104:107]
v_exp_f32 v129, v129
v_mfma_f32_16x16x32_bf16 v[104:107], a[152:155], v[48:51], v[104:107]
v_exp_f32 v130, v130
v_mfma_f32_16x16x32_bf16 v[104:107], a[156:159], v[52:55], v[104:107]
s_waitcnt lgkmcnt(0)
v_exp_f32 v131, v131
v_mfma_f32_16x16x32_bf16 v[140:143], a[172:175], v[84:87], v[228:231]
v_cvt_pk_bf16_f32 v164, v112, v113
v_cvt_pk_bf16_f32 v165, v114, v115
v_mfma_f32_16x16x32_bf16 v[140:143], a[168:171], v[80:83], v[140:143]
v_exp_f32 v144, v144
v_mfma_f32_16x16x32_bf16 v[140:143], a[164:167], v[76:79], v[140:143]
v_exp_f32 v145, v145
v_mfma_f32_16x16x32_bf16 v[140:143], a[160:163], v[72:75], v[140:143]
v_exp_f32 v146, v146
v_mfma_f32_16x16x32_bf16 v[124:127], a[160:163], v[56:59], v[224:227]
ds_read_b128 a[180:183], v2 offset:25600
v_cndmask_b32 v108, v220, v17, s[10:11]
v_mfma_f32_16x16x32_bf16 v[124:127], a[164:167], v[60:63], v[124:127]
ds_read_b128 a[184:187], v2 offset:26624
buffer_load_dwordx4 v16, s[32:35], s70 offen offset:3072 sc1 lds
v_cndmask_b32 v109, v220, v17, s[12:13]
v_cndmask_b32 v110, v220, v17, s[18:19]
v_cndmask_b32 v111, v220, v17, s[22:23]
v_cvt_pk_bf16_f32 v188, v128, v129
v_mfma_f32_16x16x32_bf16 v[124:127], a[168:171], v[64:67], v[124:127]
s_add_u32 m0, s86, 131072
v_exp_f32 v147, v147
v_mfma_f32_16x16x32_bf16 v[124:127], a[172:175], v[68:71], v[124:127]
s_add_u32 s64, s85, 0
ds_read_b128 a[188:191], v2 offset:27648
v_exp_f32 v148, v148
v_mfma_f32_16x16x32_bf16 v[108:111], a[172:175], v[52:55], v[108:111]
buffer_load_dwordx4 v12, s[36:39], s64 offen lds
v_cvt_pk_bf16_f32 v189, v130, v131
v_exp_f32 v149, v149
v_mfma_f32_16x16x32_bf16 v[108:111], a[168:171], v[48:51], v[108:111]
s_add_u32 m0, s86, 132096
ds_read_b128 a[192:195], v2 offset:28672
v_cndmask_b32 v112, v220, v17, s[26:27]
v_cndmask_b32 v113, v220, v17, s[56:57]
v_cndmask_b32 v114, v220, v17, s[58:59]
v_cndmask_b32 v115, v220, v17, s[60:61]
v_mfma_f32_16x16x32_bf16 v[108:111], a[164:167], v[44:47], v[108:111]
s_add_u32 s64, s85, 8192
v_exp_f32 v150, v150
v_mfma_f32_16x16x32_bf16 v[108:111], a[160:163], v[40:43], v[108:111]
buffer_load_dwordx4 v13, s[36:39], s64 offen lds
v_cvt_pk_bf16_f32 v196, v144, v145
v_exp_f32 v151, v151
v_mfma_f32_16x16x32_bf16 v[112:115], a[176:179], v[40:43], v[112:115]
s_waitcnt lgkmcnt(2)
s_add_u32 m0, s86, 133120
v_exp_f32 v132, v132
v_mfma_f32_16x16x32_bf16 v[112:115], a[180:183], v[44:47], v[112:115]
s_add_u32 s64, s85, 16384
v_exp_f32 v133, v133
v_mfma_f32_16x16x32_bf16 v[112:115], a[184:187], v[48:51], v[112:115]
s_waitcnt lgkmcnt(1)
buffer_load_dwordx4 v12, s[36:39], s64 offen lds
v_cvt_pk_bf16_f32 v197, v146, v147
v_mfma_f32_16x16x32_bf16 v[112:115], a[188:191], v[52:55], v[112:115]
s_add_u32 m0, s86, 134144
v_exp_f32 v134, v134
v_mfma_f32_16x16x32_bf16 v[128:131], a[188:191], v[68:71], v[224:227]
s_add_u32 s64, s85, 24576
ds_read_b128 a[196:199], v2 offset:29696
ds_read_b128 a[200:203], v2 offset:30720
ds_read_b128 a[204:207], v2 offset:31744
v_cvt_pk_bf16_f32 v198, v148, v149
v_mfma_f32_16x16x32_bf16 v[128:131], a[184:187], v[64:67], v[128:131]
buffer_load_dwordx4 v13, s[36:39], s64 offen lds
v_exp_f32 v135, v135
v_mfma_f32_16x16x32_bf16 v[128:131], a[180:183], v[60:63], v[128:131]
s_add_u32 m0, s71, 4096
v_exp_f32 v116, v116
v_mfma_f32_16x16x32_bf16 v[128:131], a[176:179], v[56:59], v[128:131]
s_add_u32 s64, s70, 4096
v_cvt_pk_bf16_f32 v199, v150, v151
v_exp_f32 v117, v117
v_mfma_f32_16x16x32_bf16 v[144:147], a[176:179], v[72:75], v[228:231]
buffer_load_dwordx4 v16, s[32:35], s64 offen offset:0 sc1 lds
v_mfma_f32_16x16x32_bf16 v[144:147], a[180:183], v[76:79], v[144:147]
v_exp_f32 v118, v118
v_mfma_f32_16x16x32_bf16 v[144:147], a[184:187], v[80:83], v[144:147]
v_cvt_pk_bf16_f32 v190, v132, v133
v_exp_f32 v119, v119
v_mfma_f32_16x16x32_bf16 v[144:147], a[188:191], v[84:87], v[144:147]
s_waitcnt lgkmcnt(0)
v_exp_f32 v100, v100
v_mfma_f32_16x16x32_bf16 v[148:151], a[204:207], v[84:87], v[228:231]
v_exp_f32 v101, v101
v_mfma_f32_16x16x32_bf16 v[148:151], a[200:203], v[80:83], v[148:151]
v_cvt_pk_bf16_f32 v191, v134, v135
v_cvt_pk_bf16_f32 v166, v116, v117
v_cvt_pk_bf16_f32 v167, v118, v119
v_mfma_f32_16x16x32_bf16 v[148:151], a[196:199], v[76:79], v[148:151]
v_exp_f32 v102, v102
v_mfma_f32_16x16x32_bf16 v[148:151], a[192:195], v[72:75], v[148:151]
v_exp_f32 v103, v103
v_mfma_f32_16x16x32_bf16 v[132:135], a[192:195], v[56:59], v[224:227]
s_lshl_b32 s66, s30, 30
ds_read_b128 a[144:147], v3 offset:16384
v_cndmask_b32 v116, v220, v17, s[62:63]
v_mfma_f32_16x16x32_bf16 v[132:135], a[196:199], v[60:63], v[132:135]
ds_read_b128 a[148:151], v3 offset:24576
v_cndmask_b32 v117, v220, v17, s[48:49]
v_cndmask_b32 v118, v220, v17, s[50:51]
v_cndmask_b32 v119, v220, v17, s[100:101]
v_exp_f32 v120, v120
v_mfma_f32_16x16x32_bf16 v[132:135], a[200:203], v[64:67], v[132:135]
v_exp_f32 v121, v121
v_mfma_f32_16x16x32_bf16 v[132:135], a[204:207], v[68:71], v[132:135]
v_exp_f32 v122, v122
v_mfma_f32_16x16x32_bf16 v[116:119], a[204:207], v[52:55], v[116:119]
ds_read_b128 a[152:155], v3 offset:17408
v_accvgpr_write_b32 a142, 0
v_mfma_f32_16x16x32_bf16 v[116:119], a[200:203], v[48:51], v[116:119]
ds_read_b128 a[156:159], v3 offset:25600
buffer_load_dwordx4 v16, s[32:35], s64 offen offset:1024 sc1 lds
v_accvgpr_write_b32 a143, 0
v_cvt_pk_bf16_f32 v158, v100, v101
v_cvt_pk_bf16_f32 v159, v102, v103
v_mfma_f32_16x16x32_bf16 v[116:119], a[196:199], v[44:47], v[116:119]
v_exp_f32 v123, v123
v_mfma_f32_16x16x32_bf16 v[116:119], a[192:195], v[40:43], v[116:119]
v_exp_f32 v136, v136
v_smfmac_f32_16x16x64_bf16 a[128:131], a[240:243], v[152:159], v5
ds_read_b128 a[160:163], v3 offset:18432
v_smfmac_f32_16x16x64_bf16 a[132:135], a[240:243], v[160:167], v5
v_exp_f32 v137, v137
v_smfmac_f32_16x16x64_bf16 a[136:139], a[240:243], v[184:191], v5
v_exp_f32 v138, v138
v_smfmac_f32_16x16x64_bf16 a[140:143], a[240:243], v[192:199], v5
s_waitcnt lgkmcnt(1)
v_cvt_pk_bf16_f32 v200, v120, v121
v_mfma_f32_16x16x32_bf16 a[0:3], a[144:147], v[152:155], 0
v_exp_f32 v139, v139
v_mfma_f32_16x16x32_bf16 a[0:3], a[148:151], v[156:159], a[0:3]
v_exp_f32 v104, v104
v_mfma_f32_16x16x32_bf16 a[32:35], a[148:151], v[164:167], 0
v_cvt_pk_bf16_f32 v201, v122, v123
v_cvt_pk_bf16_f32 v208, v136, v137
v_mfma_f32_16x16x32_bf16 a[32:35], a[144:147], v[160:163], a[32:35]
v_exp_f32 v105, v105
v_mfma_f32_16x16x32_bf16 a[64:67], a[144:147], v[184:187], 0
v_exp_f32 v106, v106
v_mfma_f32_16x16x32_bf16 a[64:67], a[148:151], v[188:191], a[64:67]
v_exp_f32 v107, v107
v_mfma_f32_16x16x32_bf16 a[96:99], a[148:151], v[196:199], 0
buffer_load_dwordx4 v16, s[32:35], s64 offen offset:2048 sc1 lds
v_mfma_f32_16x16x32_bf16 a[96:99], a[144:147], v[192:195], a[96:99]
v_exp_f32 v140, v140
v_mfma_f32_16x16x32_bf16 a[100:103], a[152:155], v[192:195], 0
ds_read_b128 a[164:167], v3 offset:26624
v_cvt_pk_bf16_f32 v209, v138, v139
v_mfma_f32_16x16x32_bf16 a[100:103], a[156:159], v[196:199], a[100:103]
v_exp_f32 v141, v141
v_mfma_f32_16x16x32_bf16 a[68:71], a[156:159], v[188:191], 0
v_exp_f32 v142, v142
v_mfma_f32_16x16x32_bf16 a[68:71], a[152:155], v[184:187], a[68:71]
v_cvt_pk_bf16_f32 v176, v104, v105
v_cvt_pk_bf16_f32 v177, v106, v107
v_mfma_f32_16x16x32_bf16 a[36:39], a[152:155], v[160:163], 0
v_exp_f32 v143, v143
v_mfma_f32_16x16x32_bf16 a[36:39], a[156:159], v[164:167], a[36:39]
v_exp_f32 v124, v124
v_mfma_f32_16x16x32_bf16 a[4:7], a[156:159], v[156:159], 0
v_exp_f32 v125, v125
v_mfma_f32_16x16x32_bf16 a[4:7], a[152:155], v[152:155], a[4:7]
s_waitcnt lgkmcnt(0)
ds_read_b128 a[168:171], v3 offset:19456
v_cvt_pk_bf16_f32 v210, v140, v141
v_mfma_f32_16x16x32_bf16 a[8:11], a[160:163], v[152:155], 0
v_exp_f32 v126, v126
v_mfma_f32_16x16x32_bf16 a[8:11], a[164:167], v[156:159], a[8:11]
ds_read_b128 a[172:175], v3 offset:27648
v_cvt_pk_bf16_f32 v211, v142, v143
v_mfma_f32_16x16x32_bf16 a[40:43], a[164:167], v[164:167], 0
v_exp_f32 v127, v127
v_mfma_f32_16x16x32_bf16 a[40:43], a[160:163], v[160:163], a[40:43]
v_exp_f32 v108, v108
v_mfma_f32_16x16x32_bf16 a[72:75], a[160:163], v[184:187], 0
buffer_load_dwordx4 v16, s[32:35], s64 offen offset:3072 sc1 lds
v_mfma_f32_16x16x32_bf16 a[72:75], a[164:167], v[188:191], a[72:75]
v_exp_f32 v109, v109
v_mfma_f32_16x16x32_bf16 a[104:107], a[164:167], v[196:199], 0
v_exp_f32 v110, v110
v_mfma_f32_16x16x32_bf16 a[104:107], a[160:163], v[192:195], a[104:107]
s_waitcnt lgkmcnt(0)
ds_read_b128 a[176:179], v3 offset:20480
v_cvt_pk_bf16_f32 v202, v124, v125
v_mfma_f32_16x16x32_bf16 a[108:111], a[168:171], v[192:195], 0
v_exp_f32 v111, v111
v_mfma_f32_16x16x32_bf16 a[108:111], a[172:175], v[196:199], a[108:111]
ds_read_b128 a[180:183], v3 offset:28672
v_cvt_pk_bf16_f32 v203, v126, v127
v_mfma_f32_16x16x32_bf16 a[76:79], a[172:175], v[188:191], 0
s_add_u32 m0, s86, 135168
v_exp_f32 v112, v112
v_mfma_f32_16x16x32_bf16 a[76:79], a[168:171], v[184:187], a[76:79]
s_add_u32 s64, s85, 32768
v_exp_f32 v113, v113
v_mfma_f32_16x16x32_bf16 a[44:47], a[168:171], v[160:163], 0
buffer_load_dwordx4 v12, s[36:39], s64 offen lds
v_mfma_f32_16x16x32_bf16 a[44:47], a[172:175], v[164:167], a[44:47]
s_add_u32 m0, s86, 136192
v_cvt_pk_bf16_f32 v178, v108, v109
v_exp_f32 v114, v114
v_mfma_f32_16x16x32_bf16 a[12:15], a[172:175], v[156:159], 0
s_add_u32 s64, s85, 40960
v_exp_f32 v115, v115
v_mfma_f32_16x16x32_bf16 a[12:15], a[168:171], v[152:155], a[12:15]
s_waitcnt lgkmcnt(0)
buffer_load_dwordx4 v13, s[36:39], s64 offen lds
v_mfma_f32_16x16x32_bf16 a[16:19], a[176:179], v[152:155], 0
s_add_u32 m0, s86, 137216
ds_read_b128 a[184:187], v3 offset:21504
ds_read_b128 a[188:191], v3 offset:29696
ds_read_b128 a[192:195], v3 offset:22528
ds_read_b128 a[196:199], v3 offset:30720
ds_read_b128 a[200:203], v3 offset:23552
ds_read_b128 a[204:207], v3 offset:31744
v_xor_b32 v2, 0x8000, v2
v_exp_f32 v128, v128
v_mfma_f32_16x16x32_bf16 a[16:19], a[180:183], v[156:159], a[16:19]
s_waitcnt vmcnt(14)
s_barrier
s_add_u32 s64, s85, 49152
v_cvt_pk_bf16_f32 v179, v110, v111
v_mfma_f32_16x16x32_bf16 a[48:51], a[180:183], v[164:167], 0
buffer_load_dwordx4 v12, s[36:39], s64 offen lds
v_exp_f32 v129, v129
v_mfma_f32_16x16x32_bf16 a[48:51], a[176:179], v[160:163], a[48:51]
s_add_u32 m0, s86, 138240
v_exp_f32 v130, v130
v_mfma_f32_16x16x32_bf16 a[80:83], a[176:179], v[184:187], 0
s_add_u32 s64, s85, 57344
v_cvt_pk_bf16_f32 v180, v112, v113
v_cvt_pk_bf16_f32 v181, v114, v115
v_mfma_f32_16x16x32_bf16 a[80:83], a[180:183], v[188:191], a[80:83]
buffer_load_dwordx4 v13, s[36:39], s64 offen lds
v_exp_f32 v131, v131
v_mfma_f32_16x16x32_bf16 a[112:115], a[180:183], v[196:199], 0
v_exp_f32 v144, v144
v_mfma_f32_16x16x32_bf16 a[112:115], a[176:179], v[192:195], a[112:115]
s_waitcnt lgkmcnt(0)
s_xor_b32 s71, s71, 49152
s_add_u32 s70, s70, 32768
s_mov_b32 m0, s71
v_exp_f32 v145, v145
v_mfma_f32_16x16x32_bf16 a[116:119], a[184:187], v[192:195], 0
buffer_load_dwordx4 v16, s[32:35], s70 offen offset:0 sc1 lds
v_mfma_f32_16x16x32_bf16 a[116:119], a[188:191], v[196:199], a[116:119]
v_exp_f32 v146, v146
v_mfma_f32_16x16x32_bf16 a[84:87], a[188:191], v[188:191], 0
v_cvt_pk_bf16_f32 v204, v128, v129
v_cvt_pk_bf16_f32 v205, v130, v131
v_mfma_f32_16x16x32_bf16 a[84:87], a[184:187], v[184:187], a[84:87]
v_exp_f32 v147, v147
v_mfma_f32_16x16x32_bf16 a[52:55], a[184:187], v[160:163], 0
v_exp_f32 v148, v148
v_mfma_f32_16x16x32_bf16 a[52:55], a[188:191], v[164:167], a[52:55]
v_exp_f32 v149, v149
v_mfma_f32_16x16x32_bf16 a[20:23], a[188:191], v[156:159], 0
ds_read_b128 a[144:147], v2 offset:0
v_lshl_add_u32 v19, v0, 24, s66
v_mfma_f32_16x16x32_bf16 a[20:23], a[184:187], v[152:155], a[20:23]
s_lshr_b32 s67, s31, 4
v_exp_f32 v150, v150
v_mfma_f32_16x16x32_bf16 a[24:27], a[192:195], v[152:155], 0
s_lshl1_add_u32 s67, s3, s67
v_cvt_pk_bf16_f32 v212, v144, v145
v_cvt_pk_bf16_f32 v213, v146, v147
v_mfma_f32_16x16x32_bf16 a[24:27], a[196:199], v[156:159], a[24:27]
s_lshl_b32 s79, s67, 8
v_exp_f32 v151, v151
v_mfma_f32_16x16x32_bf16 a[56:59], a[196:199], v[164:167], 0
s_add_u32 s79, s79, 8192
v_exp_f32 v132, v132
v_mfma_f32_16x16x32_bf16 a[56:59], a[192:195], v[160:163], a[56:59]
s_add_u32 s69, s31, 12
v_exp_f32 v133, v133
v_mfma_f32_16x16x32_bf16 a[88:91], a[192:195], v[184:187], 0
s_lshr_b32 s69, s69, 5
buffer_load_dwordx4 v16, s[32:35], s70 offen offset:1024 sc1 lds
v_mfma_f32_16x16x32_bf16 a[88:91], a[196:199], v[188:191], a[88:91]
s_lshl1_add_u32 s69, s3, s69
v_exp_f32 v134, v134
v_mfma_f32_16x16x32_bf16 a[120:123], a[196:199], v[196:199], 0
s_lshl_b32 s69, s69, 8
v_cvt_pk_bf16_f32 v214, v148, v149
v_cvt_pk_bf16_f32 v215, v150, v151
v_mfma_f32_16x16x32_bf16 a[120:123], a[192:195], v[192:195], a[120:123]
s_add_u32 s69, s69, 8192
v_exp_f32 v135, v135
v_mfma_f32_16x16x32_bf16 a[124:127], a[200:203], v[192:195], 0
s_lshl_b32 s67, s73, 16
v_exp_f32 v116, v116
v_mfma_f32_16x16x32_bf16 a[124:127], a[204:207], v[196:199], a[124:127]
s_xor_b32 s68, s80, 256
v_exp_f32 v117, v117
v_mfma_f32_16x16x32_bf16 a[92:95], a[204:207], v[188:191], 0
s_add_u32 s68, s68, s67
ds_read_b128 a[148:151], v2 offset:1024
v_cvt_pk_bf16_f32 v206, v132, v133
v_mfma_f32_16x16x32_bf16 a[92:95], a[200:203], v[184:187], a[92:95]
s_add_u32 s67, s67, s69
v_exp_f32 v118, v118
v_mfma_f32_16x16x32_bf16 a[60:63], a[200:203], v[160:163], 0
ds_read_b128 a[152:155], v2 offset:2048
v_cvt_pk_bf16_f32 v207, v134, v135
v_mfma_f32_16x16x32_bf16 a[60:63], a[204:207], v[164:167], a[60:63]
ds_read_b128 a[156:159], v2 offset:3072
v_cvt_pk_bf16_f32 v182, v116, v117
v_mfma_f32_16x16x32_bf16 a[28:31], a[204:207], v[156:159], 0
s_mov_b64 exec, 1
buffer_atomic_add a251, v19, s[52:55], s67 offen offset:0 sc1
buffer_atomic_add a251, v19, s[52:55], s68 offen offset:0 sc1
s_mov_b64 exec, -1
v_exp_f32 v119, v119
v_mfma_f32_16x16x32_bf16 a[28:31], a[200:203], v[152:155], a[28:31]
ds_read_b128 a[160:163], v2 offset:4096
ds_read_b128 a[164:167], v2 offset:5120
ds_read_b128 a[168:171], v2 offset:6144
ds_read_b128 a[172:175], v2 offset:7168
v_mul_u32_u24 v19, 52, v0
v_cvt_pk_bf16_f32 v183, v118, v119
v_xor_b32 v3, 0x8000, v3
v_accvgpr_read_b32 v20, a128
v_accvgpr_read_b32 v248, a129
v_add_f32 v20, v20, v248
v_max_f32 v1, v1, v20
v_rcp_f32 v20, v20
v_accvgpr_read_b32 v232, a0
v_accvgpr_read_b32 v233, a1
v_accvgpr_read_b32 v234, a2
v_accvgpr_read_b32 v235, a3
v_accvgpr_read_b32 v236, a4
v_accvgpr_read_b32 v237, a5
v_accvgpr_read_b32 v238, a6
v_accvgpr_read_b32 v239, a7
v_mul_f32 v20, v20, v4
v_mul_f32 v232, v232, v20
v_mul_f32 v233, v233, v20
v_mul_f32 v234, v234, v20
v_mul_f32 v235, v235, v20
v_mul_f32 v236, v236, v20
v_mul_f32 v237, v237, v20
v_mul_f32 v238, v238, v20
v_mul_f32 v239, v239, v20
v_cvt_pk_bf16_f32 v232, v232, v233
v_cvt_pk_bf16_f32 v233, v234, v235
v_cvt_pk_bf16_f32 v234, v236, v237
v_cvt_pk_bf16_f32 v235, v238, v239
s_add_u32 s77, s74, 0
buffer_store_dwordx4 v[232:235], v16, s[44:47], s77 offen sc1
v_accvgpr_read_b32 v240, a8
v_accvgpr_read_b32 v241, a9
v_accvgpr_read_b32 v242, a10
v_accvgpr_read_b32 v243, a11
v_accvgpr_read_b32 v244, a12
v_accvgpr_read_b32 v245, a13
v_accvgpr_read_b32 v246, a14
v_accvgpr_read_b32 v247, a15
v_mul_f32 v240, v240, v20
v_mul_f32 v241, v241, v20
v_mul_f32 v242, v242, v20
v_mul_f32 v243, v243, v20
v_mul_f32 v244, v244, v20
v_mul_f32 v245, v245, v20
v_mul_f32 v246, v246, v20
v_mul_f32 v247, v247, v20
v_cvt_pk_bf16_f32 v240, v240, v241
v_cvt_pk_bf16_f32 v241, v242, v243
v_cvt_pk_bf16_f32 v242, v244, v245
v_cvt_pk_bf16_f32 v243, v246, v247
s_add_u32 s77, s74, 8192
buffer_store_dwordx4 v[240:243], v16, s[44:47], s77 offen sc1
v_accvgpr_read_b32 v232, a16
v_accvgpr_read_b32 v233, a17
v_accvgpr_read_b32 v234, a18
v_accvgpr_read_b32 v235, a19
v_accvgpr_read_b32 v236, a20
v_accvgpr_read_b32 v237, a21
v_accvgpr_read_b32 v238, a22
v_accvgpr_read_b32 v239, a23
v_mul_f32 v232, v232, v20
v_mul_f32 v233, v233, v20
v_mul_f32 v234, v234, v20
v_mul_f32 v235, v235, v20
v_mul_f32 v236, v236, v20
v_mul_f32 v237, v237, v20
v_mul_f32 v238, v238, v20
v_mul_f32 v239, v239, v20
v_cvt_pk_bf16_f32 v232, v232, v233
v_cvt_pk_bf16_f32 v233, v234, v235
v_cvt_pk_bf16_f32 v234, v236, v237
v_cvt_pk_bf16_f32 v235, v238, v239
s_add_u32 s77, s74, 16384
buffer_store_dwordx4 v[232:235], v16, s[44:47], s77 offen sc1
s_branch L_T
L_T1:
buffer_load_dword v19, off, s[52:55], s80 sc1
s_waitcnt lgkmcnt(7)
v_mfma_f32_16x16x32_bf16 v[136:139], a[144:147], v[72:75], v[228:231]
s_waitcnt lgkmcnt(6)
ds_read_b128 a[176:179], v2 offset:8192
v_cndmask_b32 v120, v224, v17, s[0:1]
v_mfma_f32_16x16x32_bf16 v[136:139], a[148:151], v[76:79], v[136:139]
s_waitcnt lgkmcnt(6)
ds_read_b128 a[180:183], v2 offset:9216
v_cndmask_b32 v121, v224, v17, s[4:5]
v_cndmask_b32 v122, v224, v17, s[6:7]
v_cndmask_b32 v123, v224, v17, s[8:9]
v_mfma_f32_16x16x32_bf16 v[136:139], a[152:155], v[80:83], v[136:139]
s_waitcnt lgkmcnt(6)
buffer_load_dwordx4 v16, s[32:35], s70 offen offset:2048 sc1 lds
v_mfma_f32_16x16x32_bf16 v[136:139], a[156:159], v[84:87], v[136:139]
ds_read_b128 a[184:187], v2 offset:10240
v_cndmask_b32 v124, v224, v17, s[10:11]
v_mfma_f32_16x16x32_bf16 v[120:123], a[156:159], v[68:71], v[120:123]
ds_read_b128 a[188:191], v2 offset:11264
v_cndmask_b32 v125, v224, v17, s[12:13]
v_mfma_f32_16x16x32_bf16 v[120:123], a[152:155], v[64:67], v[120:123]
ds_read_b128 a[192:195], v2 offset:12288
v_cndmask_b32 v126, v224, v17, s[18:19]
v_mfma_f32_16x16x32_bf16 v[120:123], a[148:151], v[60:63], v[120:123]
ds_read_b128 a[196:199], v2 offset:13312
v_cndmask_b32 v127, v224, v17, s[22:23]
v_mfma_f32_16x16x32_bf16 v[120:123], a[144:147], v[56:59], v[120:123]
s_waitcnt lgkmcnt(4)
ds_read_b128 a[200:203], v2 offset:14336
v_cndmask_b32 v128, v224, v17, s[26:27]
v_mfma_f32_16x16x32_bf16 v[140:143], a[160:163], v[72:75], v[228:231]
ds_read_b128 a[204:207], v2 offset:15360
v_cndmask_b32 v129, v224, v17, s[56:57]
v_mfma_f32_16x16x32_bf16 v[140:143], a[164:167], v[76:79], v[140:143]
ds_read_b128 a[144:147], v3 offset:0
v_cndmask_b32 v130, v224, v17, s[58:59]
v_mfma_f32_16x16x32_bf16 v[140:143], a[168:171], v[80:83], v[140:143]
v_exp_f32 v136, v136
v_mfma_f32_16x16x32_bf16 v[140:143], a[172:175], v[84:87], v[140:143]
v_exp_f32 v137, v137
v_mfma_f32_16x16x32_bf16 v[124:127], a[172:175], v[68:71], v[124:127]
ds_read_b128 a[148:151], v3 offset:8192
v_cndmask_b32 v131, v224, v17, s[60:61]
v_mfma_f32_16x16x32_bf16 v[124:127], a[168:171], v[64:67], v[124:127]
v_exp_f32 v138, v138
v_mfma_f32_16x16x32_bf16 v[124:127], a[164:167], v[60:63], v[124:127]
s_mul_i32 s69, s83, 8
buffer_load_dwordx4 v16, s[32:35], s70 offen offset:3072 sc1 lds
v_mfma_f32_16x16x32_bf16 v[124:127], a[160:163], v[56:59], v[124:127]
s_sub_u32 s69, 36, s69
v_exp_f32 v139, v139
v_mfma_f32_16x16x32_bf16 v[128:131], a[176:179], v[56:59], v[128:131]
v_exp_f32 v120, v120
v_mfma_f32_16x16x32_bf16 v[128:131], a[180:183], v[60:63], v[128:131]
s_waitcnt lgkmcnt(1)
v_exp_f32 v121, v121
v_mfma_f32_16x16x32_bf16 v[128:131], a[184:187], v[64:67], v[128:131]
v_exp_f32 v122, v122
v_mfma_f32_16x16x32_bf16 v[128:131], a[188:191], v[68:71], v[128:131]
s_add_u32 m0, s71, 4096
ds_read_b128 a[152:155], v3 offset:1024
v_cndmask_b32 v132, v224, v17, s[62:63]
v_mfma_f32_16x16x32_bf16 v[144:147], a[188:191], v[84:87], v[228:231]
s_add_u32 s64, s70, 4096
v_cvt_pk_bf16_f32 v192, v136, v137
v_cndmask_b32 v133, v224, v17, s[48:49]
v_mfma_f32_16x16x32_bf16 v[144:147], a[184:187], v[80:83], v[144:147]
buffer_load_dwordx4 v16, s[32:35], s64 offen offset:0 sc1 lds
v_mfma_f32_16x16x32_bf16 v[144:147], a[180:183], v[76:79], v[144:147]
ds_read_b128 a[156:159], v3 offset:9216
v_cndmask_b32 v134, v224, v17, s[50:51]
v_mfma_f32_16x16x32_bf16 v[144:147], a[176:179], v[72:75], v[144:147]
ds_read_b128 a[160:163], v3 offset:2048
v_cndmask_b32 v135, v224, v17, s[100:101]
v_mfma_f32_16x16x32_bf16 v[148:151], a[192:195], v[72:75], v[228:231]
v_exp_f32 v123, v123
v_mfma_f32_16x16x32_bf16 v[148:151], a[196:199], v[76:79], v[148:151]
v_cvt_pk_bf16_f32 v193, v138, v139
v_cvt_pk_bf16_f32 v184, v120, v121
v_mfma_f32_16x16x32_bf16 v[148:151], a[200:203], v[80:83], v[148:151]
v_exp_f32 v140, v140
v_mfma_f32_16x16x32_bf16 v[148:151], a[204:207], v[84:87], v[148:151]
v_exp_f32 v141, v141
v_mfma_f32_16x16x32_bf16 v[132:135], a[204:207], v[68:71], v[132:135]
v_exp_f32 v142, v142
v_mfma_f32_16x16x32_bf16 v[132:135], a[200:203], v[64:67], v[132:135]
v_exp_f32 v143, v143
v_mfma_f32_16x16x32_bf16 v[132:135], a[196:199], v[60:63], v[132:135]
buffer_load_dwordx4 v16, s[32:35], s64 offen offset:1024 sc1 lds
v_mfma_f32_16x16x32_bf16 v[132:135], a[192:195], v[56:59], v[132:135]
v_exp_f32 v124, v124
v_smfmac_f32_16x16x64_bf16 a[132:135], a[240:243], v[176:183], v5
ds_read_b128 a[164:167], v3 offset:10240
v_smfmac_f32_16x16x64_bf16 a[136:139], a[240:243], v[200:207], v5
ds_read_b128 a[168:171], v3 offset:3072
v_accvgpr_read_b32 v240, a24
v_smfmac_f32_16x16x64_bf16 a[140:143], a[240:243], v[208:215], v5
v_cvt_pk_bf16_f32 v185, v122, v123
v_mfma_f32_16x16x32_bf16 a[32:35], a[144:147], v[176:179], a[32:35]
s_waitcnt lgkmcnt(2)
v_exp_f32 v125, v125
v_mfma_f32_16x16x32_bf16 a[32:35], a[148:151], v[180:183], a[32:35]
ds_read_b128 a[172:175], v3 offset:11264
v_accvgpr_read_b32 v241, a25
v_mfma_f32_16x16x32_bf16 a[64:67], a[148:151], v[204:207], a[64:67]
ds_read_b128 a[176:179], v3 offset:4096
v_accvgpr_read_b32 v242, a26
v_mfma_f32_16x16x32_bf16 a[64:67], a[144:147], v[200:203], a[64:67]
v_cvt_pk_bf16_f32 v194, v140, v141
v_accvgpr_read_b32 v243, a27
v_mfma_f32_16x16x32_bf16 a[96:99], a[144:147], v[208:211], a[96:99]
ds_read_b128 a[180:183], v3 offset:12288
v_accvgpr_read_b32 v244, a28
v_mfma_f32_16x16x32_bf16 a[96:99], a[148:151], v[212:215], a[96:99]
ds_read_b128 a[184:187], v3 offset:5120
v_accvgpr_read_b32 v245, a29
v_mfma_f32_16x16x32_bf16 a[100:103], a[156:159], v[212:215], a[100:103]
ds_read_b128 a[188:191], v3 offset:13312
v_accvgpr_read_b32 v246, a30
v_mfma_f32_16x16x32_bf16 a[100:103], a[152:155], v[208:211], a[100:103]
ds_read_b128 a[192:195], v3 offset:6144
v_accvgpr_read_b32 v247, a31
v_mul_f32 v240, v240, v20
v_mul_f32 v241, v241, v20
v_mul_f32 v242, v242, v20
v_mul_f32 v243, v243, v20
v_mul_f32 v244, v244, v20
v_mul_f32 v245, v245, v20
v_mul_f32 v246, v246, v20
v_mul_f32 v247, v247, v20
v_cvt_pk_bf16_f32 v240, v240, v241
v_cvt_pk_bf16_f32 v241, v242, v243
v_cvt_pk_bf16_f32 v242, v244, v245
v_cvt_pk_bf16_f32 v243, v246, v247
s_add_u32 s77, s74, 24576
buffer_store_dwordx4 v[240:243], v16, s[44:47], s77 offen sc1
v_exp_f32 v126, v126
v_mfma_f32_16x16x32_bf16 a[68:71], a[152:155], v[200:203], a[68:71]
buffer_load_dwordx4 v16, s[32:35], s64 offen offset:2048 sc1 lds
v_cvt_pk_bf16_f32 v195, v142, v143
v_mfma_f32_16x16x32_bf16 a[68:71], a[156:159], v[204:207], a[68:71]
v_exp_f32 v127, v127
v_mfma_f32_16x16x32_bf16 a[36:39], a[156:159], v[180:183], a[36:39]
v_exp_f32 v128, v128
v_mfma_f32_16x16x32_bf16 a[36:39], a[152:155], v[176:179], a[36:39]
v_exp_f32 v129, v129
v_mfma_f32_16x16x32_bf16 a[40:43], a[160:163], v[176:179], a[40:43]
s_waitcnt lgkmcnt(1)
v_cvt_pk_bf16_f32 v186, v124, v125
v_cvt_pk_bf16_f32 v187, v126, v127
v_mfma_f32_16x16x32_bf16 a[40:43], a[164:167], v[180:183], a[40:43]
v_exp_f32 v130, v130
v_mfma_f32_16x16x32_bf16 a[72:75], a[164:167], v[204:207], a[72:75]
buffer_load_dwordx4 v16, s[32:35], s64 offen offset:3072 sc1 lds
v_mfma_f32_16x16x32_bf16 a[72:75], a[160:163], v[200:203], a[72:75]
v_exp_f32 v131, v131
v_mfma_f32_16x16x32_bf16 a[104:107], a[160:163], v[208:211], a[104:107]
v_exp_f32 v144, v144
v_mfma_f32_16x16x32_bf16 a[104:107], a[164:167], v[212:215], a[104:107]
v_exp_f32 v145, v145
v_mfma_f32_16x16x32_bf16 a[108:111], a[172:175], v[212:215], a[108:111]
v_exp_f32 v146, v146
v_mfma_f32_16x16x32_bf16 a[108:111], a[168:171], v[208:211], a[108:111]
ds_read_b128 a[196:199], v3 offset:14336
v_cvt_pk_bf16_f32 v188, v128, v129
v_mfma_f32_16x16x32_bf16 a[76:79], a[168:171], v[200:203], a[76:79]
ds_read_b128 a[200:203], v3 offset:7168
v_cvt_pk_bf16_f32 v189, v130, v131
v_mfma_f32_16x16x32_bf16 a[76:79], a[172:175], v[204:207], a[76:79]
ds_read_b128 a[204:207], v3 offset:15360
v_cvt_pk_bf16_f32 v196, v144, v145
v_mfma_f32_16x16x32_bf16 a[44:47], a[172:175], v[180:183], a[44:47]
v_exp_f32 v147, v147
v_mfma_f32_16x16x32_bf16 a[44:47], a[168:171], v[176:179], a[44:47]
v_exp_f32 v148, v148
v_mfma_f32_16x16x32_bf16 a[48:51], a[176:179], v[176:179], a[48:51]
v_exp_f32 v149, v149
v_mfma_f32_16x16x32_bf16 a[48:51], a[180:183], v[180:183], a[48:51]
v_exp_f32 v150, v150
v_mfma_f32_16x16x32_bf16 a[80:83], a[180:183], v[204:207], a[80:83]
s_waitcnt vmcnt(10)
s_barrier
v_mfma_f32_16x16x32_bf16 a[80:83], a[176:179], v[200:203], a[80:83]
v_exp_f32 v151, v151
v_mfma_f32_16x16x32_bf16 a[112:115], a[176:179], v[208:211], a[112:115]
v_exp_f32 v132, v132
v_mfma_f32_16x16x32_bf16 a[112:115], a[180:183], v[212:215], a[112:115]
v_exp_f32 v133, v133
v_mfma_f32_16x16x32_bf16 a[116:119], a[188:191], v[212:215], a[116:119]
ds_read_b128 a[144:147], v2 offset:16384
v_cvt_pk_bf16_f32 v197, v146, v147
v_mfma_f32_16x16x32_bf16 a[116:119], a[184:187], v[208:211], a[116:119]
v_exp_f32 v134, v134
v_mfma_f32_16x16x32_bf16 a[84:87], a[184:187], v[200:203], a[84:87]
s_waitcnt vmcnt(7)
v_readfirstlane_b32 vcc_lo, v19
s_nop 0
s_cmp_lt_u32 vcc_lo, s69
s_cbranch_scc1 L_spin_1012
L_spinbk_1013:
v_mfma_f32_16x16x32_bf16 a[84:87], a[188:191], v[204:207], a[84:87]
ds_read_b128 a[148:151], v2 offset:17408
v_cvt_pk_bf16_f32 v198, v148, v149
v_mfma_f32_16x16x32_bf16 a[52:55], a[188:191], v[180:183], a[52:55]
ds_read_b128 a[152:155], v2 offset:18432
v_cvt_pk_bf16_f32 v199, v150, v151
v_mfma_f32_16x16x32_bf16 a[52:55], a[184:187], v[176:179], a[52:55]
s_waitcnt lgkmcnt(3)
ds_read_b128 a[156:159], v2 offset:19456
v_cndmask_b32 v136, v228, v17, s[0:1]
v_mfma_f32_16x16x32_bf16 a[56:59], a[192:195], v[176:179], a[56:59]
ds_read_b128 a[160:163], v2 offset:20480
v_cndmask_b32 v137, v228, v17, s[4:5]
v_mfma_f32_16x16x32_bf16 a[56:59], a[196:199], v[180:183], a[56:59]
ds_read_b128 a[164:167], v2 offset:21504
v_cndmask_b32 v138, v228, v17, s[6:7]
v_mfma_f32_16x16x32_bf16 a[88:91], a[196:199], v[204:207], a[88:91]
ds_read_b128 a[168:171], v2 offset:22528
v_cndmask_b32 v139, v228, v17, s[8:9]
v_mfma_f32_16x16x32_bf16 a[88:91], a[192:195], v[200:203], a[88:91]
v_exp_f32 v135, v135
v_mfma_f32_16x16x32_bf16 a[120:123], a[192:195], v[208:211], a[120:123]
ds_read_b128 a[172:175], v2 offset:23552
v_cvt_pk_bf16_f32 v190, v132, v133
v_mfma_f32_16x16x32_bf16 a[120:123], a[196:199], v[212:215], a[120:123]
v_cndmask_b32 v140, v228, v17, s[10:11]
v_cvt_pk_bf16_f32 v191, v134, v135
v_mfma_f32_16x16x32_bf16 a[124:127], a[204:207], v[212:215], a[124:127]
v_cndmask_b32 v141, v228, v17, s[12:13]
v_cndmask_b32 v142, v228, v17, s[18:19]
v_mfma_f32_16x16x32_bf16 a[124:127], a[200:203], v[208:211], a[124:127]
v_cndmask_b32 v143, v228, v17, s[22:23]
v_cndmask_b32 v144, v228, v17, s[26:27]
v_mfma_f32_16x16x32_bf16 a[92:95], a[200:203], v[200:203], a[92:95]
v_cndmask_b32 v145, v228, v17, s[56:57]
v_cndmask_b32 v146, v228, v17, s[58:59]
v_mfma_f32_16x16x32_bf16 a[92:95], a[204:207], v[204:207], a[92:95]
v_cndmask_b32 v147, v228, v17, s[60:61]
v_cndmask_b32 v148, v228, v17, s[62:63]
v_mfma_f32_16x16x32_bf16 a[60:63], a[204:207], v[180:183], a[60:63]
v_cndmask_b32 v149, v228, v17, s[48:49]
v_cndmask_b32 v150, v228, v17, s[50:51]
v_mfma_f32_16x16x32_bf16 a[60:63], a[200:203], v[176:179], a[60:63]
s_waitcnt lgkmcnt(0)
v_cndmask_b32 v151, v228, v17, s[100:101]
v_accvgpr_read_b32 v21, a132
v_mfma_f32_16x16x32_bf16 v[136:139], a[144:147], v[72:75], v[136:139]
ds_read_b128 a[176:179], v2 offset:24576
v_accvgpr_read_b32 v248, a133
v_mfma_f32_16x16x32_bf16 v[136:139], a[148:151], v[76:79], v[136:139]
ds_read_b128 a[180:183], v2 offset:25600
v_add_f32 v21, v21, v248
v_mfma_f32_16x16x32_bf16 v[136:139], a[152:155], v[80:83], v[136:139]
ds_read_b128 a[184:187], v2 offset:26624
v_max_f32 v1, v1, v21
v_mfma_f32_16x16x32_bf16 v[136:139], a[156:159], v[84:87], v[136:139]
ds_read_b128 a[188:191], v2 offset:27648
ds_read_b128 a[192:195], v2 offset:28672
v_mfma_f32_16x16x32_bf16 v[140:143], a[172:175], v[84:87], v[140:143]
ds_read_b128 a[196:199], v2 offset:29696
ds_read_b128 a[200:203], v2 offset:30720
ds_read_b128 a[204:207], v2 offset:31744
v_mfma_f32_16x16x32_bf16 v[140:143], a[168:171], v[80:83], v[140:143]
v_rcp_f32 v21, v21
v_mfma_f32_16x16x32_bf16 v[140:143], a[164:167], v[76:79], v[140:143]
ds_read_b128 a[144:147], v3 offset:16384
v_accvgpr_read_b32 v232, a32
v_mfma_f32_16x16x32_bf16 v[140:143], a[160:163], v[72:75], v[140:143]
s_waitcnt lgkmcnt(7)
ds_read_b128 a[148:151], v3 offset:24576
v_accvgpr_read_b32 v233, a33
v_mfma_f32_16x16x32_bf16 v[144:147], a[176:179], v[72:75], v[144:147]
ds_read_b128 a[152:155], v3 offset:17408
v_accvgpr_read_b32 v234, a34
v_mfma_f32_16x16x32_bf16 v[144:147], a[180:183], v[76:79], v[144:147]
s_waitcnt lgkmcnt(6)
ds_read_b128 a[156:159], v3 offset:25600
v_accvgpr_read_b32 v235, a35
v_mfma_f32_16x16x32_bf16 v[144:147], a[184:187], v[80:83], v[144:147]
ds_read_b128 a[160:163], v3 offset:18432
v_accvgpr_read_b32 v236, a36
v_accvgpr_read_b32 v237, a37
v_accvgpr_read_b32 v238, a38
v_accvgpr_read_b32 v239, a39
v_mul_f32 v21, v21, v6
v_mul_f32 v232, v232, v21
v_mul_f32 v233, v233, v21
v_mul_f32 v234, v234, v21
v_mul_f32 v235, v235, v21
v_mul_f32 v236, v236, v21
v_mul_f32 v237, v237, v21
v_mul_f32 v238, v238, v21
v_mul_f32 v239, v239, v21
v_cvt_pk_bf16_f32 v232, v232, v233
v_cvt_pk_bf16_f32 v233, v234, v235
v_cvt_pk_bf16_f32 v234, v236, v237
v_cvt_pk_bf16_f32 v235, v238, v239
s_add_u32 s77, s74, 4096
buffer_store_dwordx4 v[232:235], v16, s[44:47], s77 offen sc1
v_accvgpr_read_b32 v240, a40
v_accvgpr_read_b32 v241, a41
v_accvgpr_read_b32 v242, a42
v_accvgpr_read_b32 v243, a43
v_accvgpr_read_b32 v244, a44
v_accvgpr_read_b32 v245, a45
v_accvgpr_read_b32 v246, a46
v_accvgpr_read_b32 v247, a47
v_mul_f32 v240, v240, v21
v_mul_f32 v241, v241, v21
v_mul_f32 v242, v242, v21
v_mul_f32 v243, v243, v21
v_mul_f32 v244, v244, v21
v_mul_f32 v245, v245, v21
v_mul_f32 v246, v246, v21
v_mul_f32 v247, v247, v21
v_cvt_pk_bf16_f32 v240, v240, v241
v_cvt_pk_bf16_f32 v241, v242, v243
v_cvt_pk_bf16_f32 v242, v244, v245
v_cvt_pk_bf16_f32 v243, v246, v247
s_add_u32 s77, s74, 12288
buffer_store_dwordx4 v[240:243], v16, s[44:47], s77 offen sc1
v_accvgpr_read_b32 v232, a48
v_accvgpr_read_b32 v233, a49
v_accvgpr_read_b32 v234, a50
v_accvgpr_read_b32 v235, a51
v_accvgpr_read_b32 v236, a52
v_accvgpr_read_b32 v237, a53
v_accvgpr_read_b32 v238, a54
v_accvgpr_read_b32 v239, a55
v_mul_f32 v232, v232, v21
v_mul_f32 v233, v233, v21
v_mul_f32 v234, v234, v21
v_mul_f32 v235, v235, v21
v_mul_f32 v236, v236, v21
v_mul_f32 v237, v237, v21
v_mul_f32 v238, v238, v21
v_mul_f32 v239, v239, v21
v_cvt_pk_bf16_f32 v232, v232, v233
v_cvt_pk_bf16_f32 v233, v234, v235
v_cvt_pk_bf16_f32 v234, v236, v237
v_cvt_pk_bf16_f32 v235, v238, v239
s_add_u32 s77, s74, 20480
buffer_store_dwordx4 v[232:235], v16, s[44:47], s77 offen sc1
v_accvgpr_read_b32 v240, a56
v_accvgpr_read_b32 v241, a57
v_accvgpr_read_b32 v242, a58
v_accvgpr_read_b32 v243, a59
v_accvgpr_read_b32 v244, a60
v_accvgpr_read_b32 v245, a61
v_accvgpr_read_b32 v246, a62
v_accvgpr_read_b32 v247, a63
v_mul_f32 v240, v240, v21
v_mul_f32 v241, v241, v21
v_mul_f32 v242, v242, v21
v_mul_f32 v243, v243, v21
v_mul_f32 v244, v244, v21
v_mul_f32 v245, v245, v21
v_mul_f32 v246, v246, v21
v_mul_f32 v247, v247, v21
v_cvt_pk_bf16_f32 v240, v240, v241
v_cvt_pk_bf16_f32 v241, v242, v243
v_cvt_pk_bf16_f32 v242, v244, v245
v_cvt_pk_bf16_f32 v243, v246, v247
s_add_u32 s77, s74, 28672
buffer_store_dwordx4 v[240:243], v16, s[44:47], s77 offen sc1
v_exp_f32 v136, v136
v_mfma_f32_16x16x32_bf16 v[144:147], a[188:191], v[84:87], v[144:147]
s_waitcnt lgkmcnt(5)
v_exp_f32 v137, v137
v_mfma_f32_16x16x32_bf16 v[148:151], a[204:207], v[84:87], v[148:151]
v_exp_f32 v138, v138
v_mfma_f32_16x16x32_bf16 v[148:151], a[200:203], v[80:83], v[148:151]
s_add_u32 s65, s84, 0
v_exp_f32 v139, v139
v_mfma_f32_16x16x32_bf16 v[148:151], a[196:199], v[76:79], v[148:151]
buffer_load_dwordx4 a[208:211], v14, s[44:47], s65 offen offset:0 sc1
v_mfma_f32_16x16x32_bf16 v[148:151], a[192:195], v[72:75], v[148:151]
ds_read_b128 a[164:167], v3 offset:26624
v_cvt_pk_bf16_f32 v208, v136, v137
v_smfmac_f32_16x16x64_bf16 a[136:139], a[240:243], v[184:191], v5
ds_read_b128 a[168:171], v3 offset:19456
v_smfmac_f32_16x16x64_bf16 a[140:143], a[240:243], v[192:199], v5
s_waitcnt lgkmcnt(2)
ds_read_b128 a[172:175], v3 offset:27648
v_mfma_f32_16x16x32_bf16 a[64:67], a[144:147], v[184:187], a[64:67]
v_exp_f32 v140, v140
v_mfma_f32_16x16x32_bf16 a[64:67], a[148:151], v[188:191], a[64:67]
buffer_load_dwordx4 a[216:219], v14, s[44:47], s65 offen offset:1024 sc1
v_mfma_f32_16x16x32_bf16 a[96:99], a[148:151], v[196:199], a[96:99]
v_exp_f32 v141, v141
v_mfma_f32_16x16x32_bf16 a[96:99], a[144:147], v[192:195], a[96:99]
buffer_load_dwordx4 a[224:227], v15, s[44:47], s65 offen offset:0 sc1
v_mfma_f32_16x16x32_bf16 a[100:103], a[152:155], v[192:195], a[100:103]
v_exp_f32 v142, v142
v_mfma_f32_16x16x32_bf16 a[100:103], a[156:159], v[196:199], a[100:103]
buffer_load_dwordx4 a[232:235], v15, s[44:47], s65 offen offset:1024 sc1
v_mfma_f32_16x16x32_bf16 a[68:71], a[156:159], v[188:191], a[68:71]
s_add_u32 s65, s84, 8192
ds_read_b128 a[176:179], v3 offset:20480
v_cvt_pk_bf16_f32 v209, v138, v139
v_mfma_f32_16x16x32_bf16 a[68:71], a[152:155], v[184:187], a[68:71]
buffer_load_dwordx4 a[212:215], v14, s[44:47], s65 offen offset:0 sc1
v_mfma_f32_16x16x32_bf16 a[72:75], a[160:163], v[184:187], a[72:75]
s_waitcnt lgkmcnt(1)
ds_read_b128 a[180:183], v3 offset:28672
v_cvt_pk_bf16_f32 v210, v140, v141
v_mfma_f32_16x16x32_bf16 a[72:75], a[164:167], v[188:191], a[72:75]
v_exp_f32 v143, v143
v_mfma_f32_16x16x32_bf16 a[104:107], a[164:167], v[196:199], a[104:107]
buffer_load_dwordx4 a[220:223], v14, s[44:47], s65 offen offset:1024 sc1
v_mfma_f32_16x16x32_bf16 a[104:107], a[160:163], v[192:195], a[104:107]
v_exp_f32 v144, v144
v_mfma_f32_16x16x32_bf16 a[108:111], a[168:171], v[192:195], a[108:111]
ds_read_b128 a[184:187], v3 offset:21504
v_xor_b32 v2, 0x8000, v2
v_mfma_f32_16x16x32_bf16 a[108:111], a[172:175], v[196:199], a[108:111]
buffer_load_dwordx4 a[228:231], v15, s[44:47], s65 offen offset:0 sc1
ds_read_b128 a[188:191], v3 offset:29696
v_mfma_f32_16x16x32_bf16 a[76:79], a[172:175], v[188:191], a[76:79]
v_exp_f32 v145, v145
v_mfma_f32_16x16x32_bf16 a[76:79], a[168:171], v[184:187], a[76:79]
s_waitcnt lgkmcnt(2)
buffer_load_dwordx4 a[236:239], v15, s[44:47], s65 offen offset:1024 sc1
v_mfma_f32_16x16x32_bf16 a[80:83], a[176:179], v[184:187], a[80:83]
s_add_u32 s65, s84, 32768
ds_read_b128 a[192:195], v3 offset:22528
v_cvt_pk_bf16_f32 v211, v142, v143
v_mfma_f32_16x16x32_bf16 a[80:83], a[180:183], v[188:191], a[80:83]
buffer_load_dwordx4 v[152:155], v14, s[44:47], s65 offen offset:0 sc1
ds_read_b128 a[196:199], v3 offset:30720
v_exp_f32 v146, v146
v_mfma_f32_16x16x32_bf16 a[112:115], a[180:183], v[196:199], a[112:115]
ds_read_b128 a[200:203], v3 offset:23552
ds_read_b128 a[204:207], v3 offset:31744
v_mfma_f32_16x16x32_bf16 a[112:115], a[176:179], v[192:195], a[112:115]
s_waitcnt vmcnt(13)
s_barrier
v_xor_b32 v3, 0x8000, v3
buffer_load_dwordx4 v[160:163], v14, s[44:47], s65 offen offset:1024 sc1
s_waitcnt lgkmcnt(4)
v_mfma_f32_16x16x32_bf16 a[116:119], a[184:187], v[192:195], a[116:119]
v_exp_f32 v147, v147
v_mfma_f32_16x16x32_bf16 a[116:119], a[188:191], v[196:199], a[116:119]
buffer_load_dwordx4 v[168:171], v15, s[44:47], s65 offen offset:0 sc1
v_mfma_f32_16x16x32_bf16 a[84:87], a[188:191], v[188:191], a[84:87]
v_exp_f32 v148, v148
v_mfma_f32_16x16x32_bf16 a[84:87], a[184:187], v[184:187], a[84:87]
s_waitcnt lgkmcnt(2)
buffer_load_dwordx4 v[176:179], v15, s[44:47], s65 offen offset:1024 sc1
v_cvt_pk_bf16_f32 v212, v144, v145
v_mfma_f32_16x16x32_bf16 a[88:91], a[192:195], v[184:187], a[88:91]
s_add_u32 s65, s84, 40960
v_exp_f32 v149, v149
v_mfma_f32_16x16x32_bf16 a[88:91], a[196:199], v[188:191], a[88:91]
buffer_load_dwordx4 v[156:159], v14, s[44:47], s65 offen offset:0 sc1
v_mfma_f32_16x16x32_bf16 a[120:123], a[196:199], v[196:199], a[120:123]
ds_read_b128 a[144:147], v3 offset:0
v_cvt_pk_bf16_f32 v213, v146, v147
v_mfma_f32_16x16x32_bf16 a[120:123], a[192:195], v[192:195], a[120:123]
s_waitcnt lgkmcnt(1)
buffer_load_dwordx4 v[164:167], v14, s[44:47], s65 offen offset:1024 sc1
ds_read_b128 a[148:151], v3 offset:8192
v_exp_f32 v150, v150
v_mfma_f32_16x16x32_bf16 a[124:127], a[200:203], v[192:195], a[124:127]
ds_read_b128 a[152:155], v3 offset:1024
v_cvt_pk_bf16_f32 v214, v148, v149
v_mfma_f32_16x16x32_bf16 a[124:127], a[204:207], v[196:199], a[124:127]
buffer_load_dwordx4 v[172:175], v15, s[44:47], s65 offen offset:0 sc1
ds_read_b128 a[156:159], v3 offset:9216
v_mfma_f32_16x16x32_bf16 a[92:95], a[204:207], v[188:191], a[92:95]
v_exp_f32 v151, v151
v_mfma_f32_16x16x32_bf16 a[92:95], a[200:203], v[184:187], a[92:95]
buffer_load_dwordx4 v[180:183], v15, s[44:47], s65 offen offset:1024 sc1
ds_read_b128 a[160:163], v3 offset:2048
ds_read_b128 a[164:167], v3 offset:10240
ds_read_b128 a[168:171], v3 offset:3072
ds_read_b128 a[172:175], v3 offset:11264
v_cvt_pk_bf16_f32 v215, v150, v151
v_accvgpr_read_b32 v22, a136
v_accvgpr_read_b32 v248, a137
v_add_f32 v22, v22, v248
v_max_f32 v1, v1, v22
v_rcp_f32 v22, v22
v_accvgpr_read_b32 v232, a64
v_accvgpr_read_b32 v233, a65
v_accvgpr_read_b32 v234, a66
v_accvgpr_read_b32 v235, a67
v_accvgpr_read_b32 v236, a68
v_accvgpr_read_b32 v237, a69
v_accvgpr_read_b32 v238, a70
v_accvgpr_read_b32 v239, a71
v_mul_f32 v22, v22, v8
v_mul_f32 v232, v232, v22
v_mul_f32 v233, v233, v22
v_mul_f32 v234, v234, v22
v_mul_f32 v235, v235, v22
v_mul_f32 v236, v236, v22
v_mul_f32 v237, v237, v22
v_mul_f32 v238, v238, v22
v_mul_f32 v239, v239, v22
v_cvt_pk_bf16_f32 v232, v232, v233
v_cvt_pk_bf16_f32 v233, v234, v235
v_cvt_pk_bf16_f32 v234, v236, v237
v_cvt_pk_bf16_f32 v235, v238, v239
s_add_u32 s77, s75, 0
buffer_store_dwordx4 v[232:235], v16, s[44:47], s77 offen sc1
s_branch L_TAIL
L_fallback_11:
s_waitcnt vmcnt(0) lgkmcnt(0)
s_barrier
s_mov_b32 s73, 1
s_mov_b32 s81, 0
v_and_b32 v232, 15, v0
v_lshrrev_b32 v233, 4, v0
v_lshlrev_b32 v233, 2, v233
v_sub_u32 v232, v232, v233
s_lshl_b32 s66, s30, 4
v_add_u32 v232, s66, v232
s_lshl_b32 s66, s16, 7
v_add_u32 v234, s66, v232
s_lshl_b32 s66, s3, 7
v_add_u32 v232, s66, v232
v_add_u32 v233, 64, v232
v_add_u32 v235, 64, v234
s_mov_b32 m0, s76
s_lshl_b32 s64, s30, 14
s_nop 0
buffer_load_dwordx4 v16, s[32:35], s64 offen offset:0 sc1 lds
s_nop 0
buffer_load_dwordx4 v16, s[32:35], s64 offen offset:1024 sc1 lds
s_nop 0
buffer_load_dwordx4 v16, s[32:35], s64 offen offset:2048 sc1 lds
s_nop 0
buffer_load_dwordx4 v16, s[32:35], s64 offen offset:3072 sc1 lds
s_add_u32 m0, s76, 4096
s_add_u32 s64, s64, 4096
s_nop 0
buffer_load_dwordx4 v16, s[32:35], s64 offen offset:0 sc1 lds
s_nop 0
buffer_load_dwordx4 v16, s[32:35], s64 offen offset:1024 sc1 lds
s_nop 0
buffer_load_dwordx4 v16, s[32:35], s64 offen offset:2048 sc1 lds
s_nop 0
buffer_load_dwordx4 v16, s[32:35], s64 offen offset:3072 sc1 lds
s_lshr_b32 s64, s76, 1
s_add_u32 m0, s64, 81920
s_and_b32 s71, s64, 8192
s_add_u32 s64, s64, s71
s_add_u32 s64, s64, 8192
s_nop 0
buffer_load_dwordx4 v16, s[32:35], s64 offen offset:0 sc1 lds
s_nop 0
buffer_load_dwordx4 v16, s[32:35], s64 offen offset:1024 sc1 lds
s_nop 0
buffer_load_dwordx4 v16, s[32:35], s64 offen offset:2048 sc1 lds
s_nop 0
buffer_load_dwordx4 v16, s[32:35], s64 offen offset:3072 sc1 lds
v_mov_b32 v20, 0xff800000
v_mov_b32 v21, 0xff800000
v_mov_b32 v22, 0xff800000
v_mov_b32 v23, 0xff800000
L_fbl_1015:
buffer_load_dwordx4 a[144:147], v16, s[32:35], s81 offen offset:0 sc1
buffer_load_dwordx4 a[148:151], v16, s[32:35], s81 offen offset:1024 sc1
buffer_load_dwordx4 a[152:155], v16, s[32:35], s81 offen offset:2048 sc1
buffer_load_dwordx4 a[156:159], v16, s[32:35], s81 offen offset:3072 sc1
s_add_u32 s64, s81, 4096
buffer_load_dwordx4 a[160:163], v16, s[32:35], s64 offen offset:0 sc1
buffer_load_dwordx4 a[164:167], v16, s[32:35], s64 offen offset:1024 sc1
buffer_load_dwordx4 a[168:171], v16, s[32:35], s64 offen offset:2048 sc1
buffer_load_dwordx4 a[172:175], v16, s[32:35], s64 offen offset:3072 sc1
v_subrev_u32 v88, 0, v232
v_ashrrev_i32 v88, 31, v88
v_and_b32 v88, 0xff800000, v88
v_subrev_u32 v89, 1, v232
v_ashrrev_i32 v89, 31, v89
v_and_b32 v89, 0xff800000, v89
v_subrev_u32 v90, 2, v232
v_ashrrev_i32 v90, 31, v90
v_and_b32 v90, 0xff800000, v90
v_subrev_u32 v91, 3, v232
v_ashrrev_i32 v91, 31, v91
v_and_b32 v91, 0xff800000, v91
v_subrev_u32 v92, 16, v232
v_ashrrev_i32 v92, 31, v92
v_and_b32 v92, 0xff800000, v92
v_subrev_u32 v93, 17, v232
v_ashrrev_i32 v93, 31, v93
v_and_b32 v93, 0xff800000, v93
v_subrev_u32 v94, 18, v232
v_ashrrev_i32 v94, 31, v94
v_and_b32 v94, 0xff800000, v94
v_subrev_u32 v95, 19, v232
v_ashrrev_i32 v95, 31, v95
v_and_b32 v95, 0xff800000, v95
v_subrev_u32 v232, 32, v232
v_subrev_u32 v104, 0, v233
v_ashrrev_i32 v104, 31, v104
v_and_b32 v104, 0xff800000, v104
v_subrev_u32 v105, 1, v233
v_ashrrev_i32 v105, 31, v105
v_and_b32 v105, 0xff800000, v105
v_subrev_u32 v106, 2, v233
v_ashrrev_i32 v106, 31, v106
v_and_b32 v106, 0xff800000, v106
v_subrev_u32 v107, 3, v233
v_ashrrev_i32 v107, 31, v107
v_and_b32 v107, 0xff800000, v107
v_subrev_u32 v108, 16, v233
v_ashrrev_i32 v108, 31, v108
v_and_b32 v108, 0xff800000, v108
v_subrev_u32 v109, 17, v233
v_ashrrev_i32 v109, 31, v109
v_and_b32 v109, 0xff800000, v109
v_subrev_u32 v110, 18, v233
v_ashrrev_i32 v110, 31, v110
v_and_b32 v110, 0xff800000, v110
v_subrev_u32 v111, 19, v233
v_ashrrev_i32 v111, 31, v111
v_and_b32 v111, 0xff800000, v111
v_subrev_u32 v233, 32, v233
v_subrev_u32 v120, 0, v234
v_ashrrev_i32 v120, 31, v120
v_and_b32 v120, 0xff800000, v120
v_subrev_u32 v121, 1, v234
v_ashrrev_i32 v121, 31, v121
v_and_b32 v121, 0xff800000, v121
v_subrev_u32 v122, 2, v234
v_ashrrev_i32 v122, 31, v122
v_and_b32 v122, 0xff800000, v122
v_subrev_u32 v123, 3, v234
v_ashrrev_i32 v123, 31, v123
v_and_b32 v123, 0xff800000, v123
v_subrev_u32 v124, 16, v234
v_ashrrev_i32 v124, 31, v124
v_and_b32 v124, 0xff800000, v124
v_subrev_u32 v125, 17, v234
v_ashrrev_i32 v125, 31, v125
v_and_b32 v125, 0xff800000, v125
v_subrev_u32 v126, 18, v234
v_ashrrev_i32 v126, 31, v126
v_and_b32 v126, 0xff800000, v126
v_subrev_u32 v127, 19, v234
v_ashrrev_i32 v127, 31, v127
v_and_b32 v127, 0xff800000, v127
v_subrev_u32 v234, 32, v234
v_subrev_u32 v136, 0, v235
v_ashrrev_i32 v136, 31, v136
v_and_b32 v136, 0xff800000, v136
v_subrev_u32 v137, 1, v235
v_ashrrev_i32 v137, 31, v137
v_and_b32 v137, 0xff800000, v137
v_subrev_u32 v138, 2, v235
v_ashrrev_i32 v138, 31, v138
v_and_b32 v138, 0xff800000, v138
v_subrev_u32 v139, 3, v235
v_ashrrev_i32 v139, 31, v139
v_and_b32 v139, 0xff800000, v139
v_subrev_u32 v140, 16, v235
v_ashrrev_i32 v140, 31, v140
v_and_b32 v140, 0xff800000, v140
v_subrev_u32 v141, 17, v235
v_ashrrev_i32 v141, 31, v141
v_and_b32 v141, 0xff800000, v141
v_subrev_u32 v142, 18, v235
v_ashrrev_i32 v142, 31, v142
v_and_b32 v142, 0xff800000, v142
v_subrev_u32 v143, 19, v235
v_ashrrev_i32 v143, 31, v143
v_and_b32 v143, 0xff800000, v143
v_subrev_u32 v235, 32, v235
s_waitcnt vmcnt(0)
v_mfma_f32_16x16x32_bf16 v[88:91], a[144:147], v[24:27], v[88:91]
v_mfma_f32_16x16x32_bf16 v[104:107], a[144:147], v[40:43], v[104:107]
v_mfma_f32_16x16x32_bf16 v[120:123], a[144:147], v[56:59], v[120:123]
v_mfma_f32_16x16x32_bf16 v[136:139], a[144:147], v[72:75], v[136:139]
v_mfma_f32_16x16x32_bf16 v[88:91], a[148:151], v[28:31], v[88:91]
v_mfma_f32_16x16x32_bf16 v[104:107], a[148:151], v[44:47], v[104:107]
v_mfma_f32_16x16x32_bf16 v[120:123], a[148:151], v[60:63], v[120:123]
v_mfma_f32_16x16x32_bf16 v[136:139], a[148:151], v[76:79], v[136:139]
v_mfma_f32_16x16x32_bf16 v[88:91], a[152:155], v[32:35], v[88:91]
v_mfma_f32_16x16x32_bf16 v[104:107], a[152:155], v[48:51], v[104:107]
v_mfma_f32_16x16x32_bf16 v[120:123], a[152:155], v[64:67], v[120:123]
v_mfma_f32_16x16x32_bf16 v[136:139], a[152:155], v[80:83], v[136:139]
v_mfma_f32_16x16x32_bf16 v[88:91], a[156:159], v[36:39], v[88:91]
v_mfma_f32_16x16x32_bf16 v[104:107], a[156:159], v[52:55], v[104:107]
v_mfma_f32_16x16x32_bf16 v[120:123], a[156:159], v[68:71], v[120:123]
v_mfma_f32_16x16x32_bf16 v[136:139], a[156:159], v[84:87], v[136:139]
v_mfma_f32_16x16x32_bf16 v[92:95], a[160:163], v[24:27], v[92:95]
v_mfma_f32_16x16x32_bf16 v[108:111], a[160:163], v[40:43], v[108:111]
v_mfma_f32_16x16x32_bf16 v[124:127], a[160:163], v[56:59], v[124:127]
v_mfma_f32_16x16x32_bf16 v[140:143], a[160:163], v[72:75], v[140:143]
v_mfma_f32_16x16x32_bf16 v[92:95], a[164:167], v[28:31], v[92:95]
v_mfma_f32_16x16x32_bf16 v[108:111], a[164:167], v[44:47], v[108:111]
v_mfma_f32_16x16x32_bf16 v[124:127], a[164:167], v[60:63], v[124:127]
v_mfma_f32_16x16x32_bf16 v[140:143], a[164:167], v[76:79], v[140:143]
v_mfma_f32_16x16x32_bf16 v[92:95], a[168:171], v[32:35], v[92:95]
v_mfma_f32_16x16x32_bf16 v[108:111], a[168:171], v[48:51], v[108:111]
v_mfma_f32_16x16x32_bf16 v[124:127], a[168:171], v[64:67], v[124:127]
v_mfma_f32_16x16x32_bf16 v[140:143], a[168:171], v[80:83], v[140:143]
v_mfma_f32_16x16x32_bf16 v[92:95], a[172:175], v[36:39], v[92:95]
v_mfma_f32_16x16x32_bf16 v[108:111], a[172:175], v[52:55], v[108:111]
v_mfma_f32_16x16x32_bf16 v[124:127], a[172:175], v[68:71], v[124:127]
v_mfma_f32_16x16x32_bf16 v[140:143], a[172:175], v[84:87], v[140:143]
s_nop 7
v_max3_f32 v20, v20, v88, v89
v_max3_f32 v20, v20, v90, v91
v_max3_f32 v20, v20, v92, v93
v_max3_f32 v20, v20, v94, v95
v_max3_f32 v21, v21, v104, v105
v_max3_f32 v21, v21, v106, v107
v_max3_f32 v21, v21, v108, v109
v_max3_f32 v21, v21, v110, v111
v_max3_f32 v22, v22, v120, v121
v_max3_f32 v22, v22, v122, v123
v_max3_f32 v22, v22, v124, v125
v_max3_f32 v22, v22, v126, v127
v_max3_f32 v23, v23, v136, v137
v_max3_f32 v23, v23, v138, v139
v_max3_f32 v23, v23, v140, v141
v_max3_f32 v23, v23, v142, v143
s_add_u32 s81, s81, 16384
s_cmp_lt_u32 s81, s34
s_cbranch_scc1 L_fbl_1015
v_mov_b32 v248, v20
v_mov_b32 v249, v21
v_mov_b32 v250, v22
v_mov_b32 v251, v23
v_permlane16_swap_b32 v248, v20
v_permlane16_swap_b32 v249, v21
v_permlane16_swap_b32 v250, v22
v_permlane16_swap_b32 v251, v23
v_max_f32 v20, v20, v248
v_max_f32 v21, v21, v249
v_max_f32 v22, v22, v250
v_max_f32 v23, v23, v251
v_mov_b32 v248, v20
v_mov_b32 v249, v21
v_mov_b32 v250, v22
v_mov_b32 v251, v23
v_permlane32_swap_b32 v248, v20
v_permlane32_swap_b32 v249, v21
v_permlane32_swap_b32 v250, v22
v_permlane32_swap_b32 v251, v23
v_max_f32 v20, v20, v248
v_max_f32 v21, v21, v249
v_max_f32 v22, v22, v250
v_max_f32 v23, v23, v251
v_mov_b32 v252, v20
v_mov_b32 v253, v21
v_mov_b32 v254, v22
v_mov_b32 v255, v23
s_and_b32 s70, s30, 1
s_lshr_b32 s67, s30, 1
s_lshl3_add_u32 s71, s67, s70
s_add_u32 s71, s71, 4
s_lshl_b32 s71, s71, 13
s_lshl_b32 s70, s70, 14
s_mul_i32 s67, s67, 24576
s_sub_u32 s70, s70, s67
s_add_u32 s70, s70, 65536
v_mov_b32 v2, v16
v_add_u32 v3, 0x10000, v16
v_mov_b32 v1, 0
s_mov_b32 m0, s71
s_waitcnt lgkmcnt(0)
s_barrier
ds_read_b128 a[144:147], v2 offset:0
ds_read_b128 a[148:151], v2 offset:1024
ds_read_b128 a[152:155], v2 offset:2048
ds_read_b128 a[156:159], v2 offset:3072
ds_read_b128 a[160:163], v2 offset:4096
ds_read_b128 a[164:167], v2 offset:5120
ds_read_b128 a[168:171], v2 offset:6144
ds_read_b128 a[172:175], v2 offset:7168
buffer_load_dwordx4 v16, s[32:35], s70 offen offset:0 sc1 lds
buffer_load_dwordx4 v16, s[32:35], s70 offen offset:1024 sc1 lds
s_waitcnt vmcnt(0) lgkmcnt(0)
s_branch L_attstart_7
L_spin_2016:
s_mov_b32 vcc_hi, 0x80000
L_spinlp_2018:
s_sleep 1
buffer_load_dword v19, off, s[52:55], s72 offset:0 sc1
s_waitcnt vmcnt(0)
v_readfirstlane_b32 vcc_lo, v19
s_sub_u32 vcc_hi, vcc_hi, 1
s_cbranch_scc1 L_spinbk_2017
s_cmp_lt_u32 vcc_lo, 8
s_cbranch_scc1 L_spinlp_2018
s_branch L_spinbk_2017
L_spin_3019:
s_mov_b32 vcc_hi, 0x80000
L_spinlp_3021:
s_sleep 1
buffer_load_dword v19, off, s[52:55], s72 offset:0 sc1
s_waitcnt vmcnt(0)
v_readfirstlane_b32 vcc_lo, v19
s_sub_u32 vcc_hi, vcc_hi, 1
s_cbranch_scc1 L_spinbk_3020
s_cmp_lt_u32 vcc_lo, 8
s_cbranch_scc1 L_spinlp_3021
s_branch L_spinbk_3020
.p2align 12
L_pg24:
s_branch L_tr2
L_p5f0:
s_waitcnt lgkmcnt(10)
s_waitcnt vmcnt(28)
v_mfma_f32_16x16x32_bf16 v[136:139], a[144:147], a[232:235], 0
s_waitcnt vmcnt(24)
s_waitcnt lgkmcnt(8)
s_add_u32 m0, s86, 65536
ds_read_b64_tr_b16 a[168:169], v191 offset:32768
v_xor_b32 v192, 0x10000, v184
v_mfma_f32_16x16x32_bf16 v[136:139], a[148:151], a[236:239], v[136:139]
s_add_u32 s64, s85, 524288
ds_read_b64_tr_b16 a[170:171], v191 offset:36864
v_xor_b32 v193, 0x10000, v185
v_mfma_f32_16x16x32_bf16 v[104:107], a[148:151], a[228:231], 0
buffer_load_dwordx4 v12, s[36:39], s64 offen lds
v_mfma_f32_16x16x32_bf16 v[104:107], a[144:147], a[224:227], v[104:107]
s_add_u32 m0, s86, 66560
s_add_u32 s64, s85, 532480
ds_read_b64_tr_b16 a[172:173], v191 offset:40960
v_xor_b32 v194, 0x10000, v186
v_mfma_f32_16x16x32_bf16 v[72:75], a[144:147], a[216:219], 0
buffer_load_dwordx4 v13, s[36:39], s64 offen lds
v_mfma_f32_16x16x32_bf16 v[72:75], a[148:151], a[220:223], v[72:75]
s_add_u32 m0, s86, 67584
ds_read_b64_tr_b16 a[174:175], v191 offset:45056
v_xor_b32 v195, 0x10000, v187
v_mfma_f32_16x16x32_bf16 v[40:43], a[148:151], a[212:215], 0
s_add_u32 s64, s85, 540672
ds_read_b64_tr_b16 a[176:177], v184 offset:32768
v_xor_b32 v196, 0x10000, v188
v_mfma_f32_16x16x32_bf16 v[40:43], a[144:147], a[208:211], v[40:43]
s_waitcnt lgkmcnt(5)
buffer_load_dwordx4 v12, s[36:39], s64 offen lds
v_mfma_f32_16x16x32_bf16 v[44:47], a[152:155], a[208:211], 0
s_add_u32 m0, s86, 68608
s_add_u32 s64, s85, 548864
ds_read_b64_tr_b16 a[178:179], v184 offset:36864
v_xor_b32 v197, 0x10000, v189
v_mfma_f32_16x16x32_bf16 v[44:47], a[156:159], a[212:215], v[44:47]
buffer_load_dwordx4 v13, s[36:39], s64 offen lds
v_mfma_f32_16x16x32_bf16 v[76:79], a[156:159], a[220:223], 0
s_add_u32 m0, s86, 69632
ds_read_b64_tr_b16 a[180:181], v184 offset:40960
v_xor_b32 v198, 0x10000, v190
v_mfma_f32_16x16x32_bf16 v[76:79], a[152:155], a[216:219], v[76:79]
s_add_u32 s64, s85, 557056
ds_read_b64_tr_b16 a[182:183], v184 offset:45056
v_xor_b32 v199, 0x10000, v191
v_mfma_f32_16x16x32_bf16 v[108:111], a[152:155], a[224:227], 0
buffer_load_dwordx4 v12, s[36:39], s64 offen lds
v_mfma_f32_16x16x32_bf16 v[108:111], a[156:159], a[228:231], v[108:111]
s_add_u32 m0, s86, 70656
s_add_u32 s64, s85, 565248
ds_read_b64_tr_b16 a[184:185], v185 offset:32768
v_mfma_f32_16x16x32_bf16 v[140:143], a[156:159], a[236:239], 0
buffer_load_dwordx4 v13, s[36:39], s64 offen lds
v_mfma_f32_16x16x32_bf16 v[140:143], a[152:155], a[232:235], v[140:143]
s_add_u32 m0, s86, 71680
ds_read_b64_tr_b16 a[186:187], v185 offset:36864
v_mfma_f32_16x16x32_bf16 v[144:147], a[160:163], a[232:235], 0
s_add_u32 s64, s85, 573440
ds_read_b64_tr_b16 a[188:189], v185 offset:40960
v_mfma_f32_16x16x32_bf16 v[144:147], a[164:167], a[236:239], v[144:147]
buffer_load_dwordx4 v12, s[36:39], s64 offen lds
v_mfma_f32_16x16x32_bf16 v[112:115], a[164:167], a[228:231], 0
s_and_b32 s71, s31, 4
s_lshl_b32 s71, s71, 5
s_add_u32 m0, s86, 72704
s_add_u32 s64, s85, 581632
ds_read_b64_tr_b16 a[190:191], v185 offset:45056
v_mfma_f32_16x16x32_bf16 v[112:115], a[160:163], a[224:227], v[112:115]
s_add_u32 s71, s71, s79
buffer_load_dwordx4 v13, s[36:39], s64 offen lds
v_mfma_f32_16x16x32_bf16 v[80:83], a[160:163], a[216:219], 0
s_add_u32 s71, s71, 4096
s_add_u32 s72, s80, 4096
ds_read_b64_tr_b16 a[192:193], v186 offset:32768
v_mfma_f32_16x16x32_bf16 v[80:83], a[164:167], a[220:223], v[80:83]
s_add_u32 s65, s84, 65536
ds_read_b64_tr_b16 a[194:195], v186 offset:36864
v_mfma_f32_16x16x32_bf16 v[48:51], a[164:167], a[212:215], 0
buffer_load_dwordx4 a[0:3], v14, s[44:47], s65 offen offset:0 sc1
v_mfma_f32_16x16x32_bf16 v[48:51], a[160:163], a[208:211], v[48:51]
s_waitcnt lgkmcnt(4)
ds_read_b64_tr_b16 a[196:197], v186 offset:40960
v_mfma_f32_16x16x32_bf16 v[52:55], a[168:171], a[208:211], 0
buffer_load_dwordx4 a[8:11], v14, s[44:47], s65 offen offset:1024 sc1
v_mfma_f32_16x16x32_bf16 v[52:55], a[172:175], a[212:215], v[52:55]
ds_read_b64_tr_b16 a[198:199], v186 offset:45056
v_mfma_f32_16x16x32_bf16 v[84:87], a[172:175], a[220:223], 0
ds_read_b64_tr_b16 a[200:201], v187 offset:32768
v_mfma_f32_16x16x32_bf16 v[84:87], a[168:171], a[216:219], v[84:87]
buffer_load_dwordx4 a[16:19], v15, s[44:47], s65 offen offset:0 sc1
v_mfma_f32_16x16x32_bf16 v[116:119], a[168:171], a[224:227], 0
ds_read_b64_tr_b16 a[202:203], v187 offset:36864
v_mfma_f32_16x16x32_bf16 v[116:119], a[172:175], a[228:231], v[116:119]
buffer_load_dwordx4 a[24:27], v15, s[44:47], s65 offen offset:1024 sc1
v_mfma_f32_16x16x32_bf16 v[148:151], a[172:175], a[236:239], 0
ds_read_b64_tr_b16 a[204:205], v187 offset:40960
v_mfma_f32_16x16x32_bf16 v[148:151], a[168:171], a[232:235], v[148:151]
s_add_u32 s65, s84, 73728
ds_read_b64_tr_b16 a[206:207], v187 offset:45056
v_mfma_f32_16x16x32_bf16 v[120:123], a[176:179], a[232:235], 0
buffer_load_dwordx4 a[4:7], v14, s[44:47], s65 offen offset:0 sc1
v_mfma_f32_16x16x32_bf16 v[120:123], a[180:183], a[236:239], v[120:123]
v_mfma_f32_16x16x32_bf16 v[88:91], a[180:183], a[228:231], 0
buffer_load_dwordx4 a[12:15], v14, s[44:47], s65 offen offset:1024 sc1
v_mfma_f32_16x16x32_bf16 v[88:91], a[176:179], a[224:227], v[88:91]
v_mfma_f32_16x16x32_bf16 v[56:59], a[176:179], a[216:219], 0
v_mfma_f32_16x16x32_bf16 v[56:59], a[180:183], a[220:223], v[56:59]
buffer_load_dwordx4 a[20:23], v15, s[44:47], s65 offen offset:0 sc1
v_mfma_f32_16x16x32_bf16 v[24:27], a[180:183], a[212:215], 0
v_mfma_f32_16x16x32_bf16 v[24:27], a[176:179], a[208:211], v[24:27]
buffer_load_dwordx4 a[28:31], v15, s[44:47], s65 offen offset:1024 sc1
v_mfma_f32_16x16x32_bf16 v[28:31], a[184:187], a[208:211], 0
s_waitcnt lgkmcnt(0)
v_mfma_f32_16x16x32_bf16 v[28:31], a[188:191], a[212:215], v[28:31]
v_mfma_f32_16x16x32_bf16 v[60:63], a[188:191], a[220:223], 0
v_mfma_f32_16x16x32_bf16 v[60:63], a[184:187], a[216:219], v[60:63]
s_waitcnt vmcnt(23)
s_barrier
v_mfma_f32_16x16x32_bf16 v[92:95], a[184:187], a[224:227], 0
ds_read_b64_tr_b16 a[144:145], v196 offset:0
v_mfma_f32_16x16x32_bf16 v[92:95], a[188:191], a[228:231], v[92:95]
ds_read_b64_tr_b16 a[146:147], v196 offset:4096
v_mfma_f32_16x16x32_bf16 v[124:127], a[188:191], a[236:239], 0
s_add_u32 m0, s86, 0
ds_read_b64_tr_b16 a[148:149], v196 offset:8192
v_mfma_f32_16x16x32_bf16 v[124:127], a[184:187], a[232:235], v[124:127]
s_add_u32 s64, s85, 786432
ds_read_b64_tr_b16 a[150:151], v196 offset:12288
v_mfma_f32_16x16x32_bf16 v[128:131], a[192:195], a[232:235], 0
buffer_load_dwordx4 v12, s[36:39], s64 offen lds
v_mfma_f32_16x16x32_bf16 v[128:131], a[196:199], a[236:239], v[128:131]
s_add_u32 m0, s86, 1024
ds_read_b64_tr_b16 a[152:153], v197 offset:0
v_mfma_f32_16x16x32_bf16 v[96:99], a[196:199], a[228:231], 0
s_add_u32 s64, s85, 794624
ds_read_b64_tr_b16 a[154:155], v197 offset:4096
v_mfma_f32_16x16x32_bf16 v[96:99], a[192:195], a[224:227], v[96:99]
buffer_load_dwordx4 v13, s[36:39], s64 offen lds
v_mfma_f32_16x16x32_bf16 v[64:67], a[192:195], a[216:219], 0
s_add_u32 m0, s86, 2048
ds_read_b64_tr_b16 a[156:157], v197 offset:8192
v_mfma_f32_16x16x32_bf16 v[64:67], a[196:199], a[220:223], v[64:67]
s_add_u32 s64, s85, 802816
ds_read_b64_tr_b16 a[158:159], v197 offset:12288
v_mfma_f32_16x16x32_bf16 v[32:35], a[196:199], a[212:215], 0
buffer_load_dwordx4 v12, s[36:39], s64 offen lds
v_mfma_f32_16x16x32_bf16 v[32:35], a[192:195], a[208:211], v[32:35]
s_add_u32 m0, s86, 3072
ds_read_b64_tr_b16 a[160:161], v198 offset:0
v_mfma_f32_16x16x32_bf16 v[36:39], a[200:203], a[208:211], 0
s_add_u32 s64, s85, 811008
ds_read_b64_tr_b16 a[162:163], v198 offset:4096
v_mfma_f32_16x16x32_bf16 v[36:39], a[204:207], a[212:215], v[36:39]
buffer_load_dwordx4 v13, s[36:39], s64 offen lds
v_mfma_f32_16x16x32_bf16 v[68:71], a[204:207], a[220:223], 0
s_add_u32 m0, s86, 4096
ds_read_b64_tr_b16 a[164:165], v198 offset:8192
v_mfma_f32_16x16x32_bf16 v[68:71], a[200:203], a[216:219], v[68:71]
s_add_u32 s64, s85, 819200
ds_read_b64_tr_b16 a[166:167], v198 offset:12288
v_mfma_f32_16x16x32_bf16 v[100:103], a[200:203], a[224:227], 0
buffer_load_dwordx4 v12, s[36:39], s64 offen lds
v_mfma_f32_16x16x32_bf16 v[100:103], a[204:207], a[228:231], v[100:103]
v_mfma_f32_16x16x32_bf16 v[132:135], a[204:207], a[236:239], 0
v_mfma_f32_16x16x32_bf16 v[132:135], a[200:203], a[232:235], v[132:135]
s_waitcnt lgkmcnt(3)
v_mfma_f32_16x16x32_bf16 v[136:139], a[144:147], v[176:179], v[136:139]
s_add_u32 m0, s86, 5120
ds_read_b64_tr_b16 a[168:169], v199 offset:0
v_xor_b32 v200, 0x18000, v184
v_mfma_f32_16x16x32_bf16 v[136:139], a[148:151], v[180:183], v[136:139]
s_add_u32 s64, s85, 827392
ds_read_b64_tr_b16 a[170:171], v199 offset:4096
v_xor_b32 v201, 0x18000, v185
v_mfma_f32_16x16x32_bf16 v[104:107], a[148:151], v[172:175], v[104:107]
buffer_load_dwordx4 v13, s[36:39], s64 offen lds
v_mfma_f32_16x16x32_bf16 v[104:107], a[144:147], v[168:171], v[104:107]
s_add_u32 m0, s86, 6144
ds_read_b64_tr_b16 a[172:173], v199 offset:8192
v_xor_b32 v202, 0x18000, v186
v_mfma_f32_16x16x32_bf16 v[72:75], a[144:147], v[160:163], v[72:75]
s_add_u32 s64, s85, 835584
ds_read_b64_tr_b16 a[174:175], v199 offset:12288
v_xor_b32 v203, 0x18000, v187
v_mfma_f32_16x16x32_bf16 v[72:75], a[148:151], v[164:167], v[72:75]
buffer_load_dwordx4 v12, s[36:39], s64 offen lds
v_mfma_f32_16x16x32_bf16 v[40:43], a[148:151], v[156:159], v[40:43]
ds_read_b64_tr_b16 a[176:177], v192 offset:0
v_xor_b32 v204, 0x18000, v188
v_mfma_f32_16x16x32_bf16 v[40:43], a[144:147], v[152:155], v[40:43]
s_add_u32 m0, s86, 7168
ds_read_b64_tr_b16 a[178:179], v192 offset:4096
v_xor_b32 v205, 0x18000, v189
v_mfma_f32_16x16x32_bf16 v[44:47], a[152:155], v[152:155], v[44:47]
s_add_u32 s64, s85, 843776
ds_read_b64_tr_b16 a[180:181], v192 offset:8192
v_xor_b32 v206, 0x18000, v190
v_mfma_f32_16x16x32_bf16 v[44:47], a[156:159], v[156:159], v[44:47]
buffer_load_dwordx4 v13, s[36:39], s64 offen lds
v_mfma_f32_16x16x32_bf16 v[76:79], a[156:159], v[164:167], v[76:79]
ds_read_b64_tr_b16 a[182:183], v192 offset:12288
v_xor_b32 v207, 0x18000, v191
v_mfma_f32_16x16x32_bf16 v[76:79], a[152:155], v[160:163], v[76:79]
s_add_u32 s65, s84, 98304
ds_read_b64_tr_b16 a[184:185], v193 offset:0
v_mfma_f32_16x16x32_bf16 v[108:111], a[152:155], v[168:171], v[108:111]
buffer_load_dwordx4 a[64:67], v14, s[44:47], s65 offen offset:0 sc1
v_mfma_f32_16x16x32_bf16 v[108:111], a[156:159], v[172:175], v[108:111]
ds_read_b64_tr_b16 a[186:187], v193 offset:4096
v_mfma_f32_16x16x32_bf16 v[140:143], a[156:159], v[180:183], v[140:143]
ds_read_b64_tr_b16 a[188:189], v193 offset:8192
v_mfma_f32_16x16x32_bf16 v[140:143], a[152:155], v[176:179], v[140:143]
s_waitcnt lgkmcnt(5)
ds_read_b64_tr_b16 a[190:191], v193 offset:12288
v_mfma_f32_16x16x32_bf16 v[144:147], a[160:163], v[176:179], v[144:147]
buffer_load_dwordx4 a[72:75], v14, s[44:47], s65 offen offset:1024 sc1
v_mfma_f32_16x16x32_bf16 v[144:147], a[164:167], v[180:183], v[144:147]
v_mfma_f32_16x16x32_bf16 v[112:115], a[164:167], v[172:175], v[112:115]
ds_read_b64_tr_b16 a[192:193], v194 offset:0
v_mfma_f32_16x16x32_bf16 v[112:115], a[160:163], v[168:171], v[112:115]
ds_read_b64_tr_b16 a[194:195], v194 offset:4096
v_mfma_f32_16x16x32_bf16 v[80:83], a[160:163], v[160:163], v[80:83]
buffer_load_dwordx4 a[80:83], v15, s[44:47], s65 offen offset:0 sc1
v_mfma_f32_16x16x32_bf16 v[80:83], a[164:167], v[164:167], v[80:83]
ds_read_b64_tr_b16 a[196:197], v194 offset:8192
v_mfma_f32_16x16x32_bf16 v[48:51], a[164:167], v[156:159], v[48:51]
ds_read_b64_tr_b16 a[198:199], v194 offset:12288
v_mfma_f32_16x16x32_bf16 v[48:51], a[160:163], v[152:155], v[48:51]
buffer_load_dwordx4 a[88:91], v15, s[44:47], s65 offen offset:1024 sc1
v_mfma_f32_16x16x32_bf16 v[52:55], a[168:171], v[152:155], v[52:55]
v_mfma_f32_16x16x32_bf16 v[52:55], a[172:175], v[156:159], v[52:55]
v_mfma_f32_16x16x32_bf16 v[84:87], a[172:175], v[164:167], v[84:87]
s_add_u32 s65, s84, 106496
ds_read_b64_tr_b16 a[200:201], v195 offset:0
v_mfma_f32_16x16x32_bf16 v[84:87], a[168:171], v[160:163], v[84:87]
buffer_load_dwordx4 a[68:71], v14, s[44:47], s65 offen offset:0 sc1
v_mfma_f32_16x16x32_bf16 v[116:119], a[168:171], v[168:171], v[116:119]
ds_read_b64_tr_b16 a[202:203], v195 offset:4096
v_mfma_f32_16x16x32_bf16 v[116:119], a[172:175], v[172:175], v[116:119]
ds_read_b64_tr_b16 a[204:205], v195 offset:8192
v_mfma_f32_16x16x32_bf16 v[148:151], a[172:175], v[180:183], v[148:151]
ds_read_b64_tr_b16 a[206:207], v195 offset:12288
v_mfma_f32_16x16x32_bf16 v[148:151], a[168:171], v[176:179], v[148:151]
s_lshl_b32 s66, s30, 30
buffer_load_dwordx4 a[76:79], v14, s[44:47], s65 offen offset:1024 sc1
v_mfma_f32_16x16x32_bf16 v[120:123], a[176:179], v[176:179], v[120:123]
s_waitcnt lgkmcnt(4)
v_lshl_add_u32 v1, v0, 24, s66
v_mfma_f32_16x16x32_bf16 v[120:123], a[180:183], v[180:183], v[120:123]
v_mfma_f32_16x16x32_bf16 v[88:91], a[180:183], v[172:175], v[88:91]
buffer_load_dwordx4 a[84:87], v15, s[44:47], s65 offen offset:0 sc1
v_mfma_f32_16x16x32_bf16 v[88:91], a[176:179], v[168:171], v[88:91]
v_mfma_f32_16x16x32_bf16 v[56:59], a[176:179], v[160:163], v[56:59]
v_mfma_f32_16x16x32_bf16 v[56:59], a[180:183], v[164:167], v[56:59]
v_mfma_f32_16x16x32_bf16 v[24:27], a[180:183], v[156:159], v[24:27]
buffer_load_dwordx4 a[92:95], v15, s[44:47], s65 offen offset:1024 sc1
v_mfma_f32_16x16x32_bf16 v[24:27], a[176:179], v[152:155], v[24:27]
v_mfma_f32_16x16x32_bf16 v[28:31], a[184:187], v[152:155], v[28:31]
v_mfma_f32_16x16x32_bf16 v[28:31], a[188:191], v[156:159], v[28:31]
v_mfma_f32_16x16x32_bf16 v[60:63], a[188:191], v[164:167], v[60:63]
v_mfma_f32_16x16x32_bf16 v[60:63], a[184:187], v[160:163], v[60:63]
s_waitcnt vmcnt(24)
s_barrier
v_mfma_f32_16x16x32_bf16 v[92:95], a[184:187], v[168:171], v[92:95]
s_mov_b64 exec, 1
buffer_atomic_add a251, v1, s[52:55], s71 offen offset:0 sc1
s_mov_b64 exec, -1
v_mfma_f32_16x16x32_bf16 v[92:95], a[188:191], v[172:175], v[92:95]
ds_read_b64_tr_b16 a[144:145], v196 offset:32768
v_mfma_f32_16x16x32_bf16 v[124:127], a[188:191], v[180:183], v[124:127]
s_add_u32 m0, s86, 98304
ds_read_b64_tr_b16 a[146:147], v196 offset:36864
v_mfma_f32_16x16x32_bf16 v[124:127], a[184:187], v[176:179], v[124:127]
s_add_u32 s64, s85, 1048576
ds_read_b64_tr_b16 a[148:149], v196 offset:40960
v_mfma_f32_16x16x32_bf16 v[128:131], a[192:195], v[176:179], v[128:131]
buffer_load_dwordx4 v12, s[36:39], s64 offen lds
v_mfma_f32_16x16x32_bf16 v[128:131], a[196:199], v[180:183], v[128:131]
s_add_u32 m0, s86, 99328
ds_read_b64_tr_b16 a[150:151], v196 offset:45056
v_mfma_f32_16x16x32_bf16 v[96:99], a[196:199], v[172:175], v[96:99]
s_add_u32 s64, s85, 1056768
ds_read_b64_tr_b16 a[152:153], v197 offset:32768
v_mfma_f32_16x16x32_bf16 v[96:99], a[192:195], v[168:171], v[96:99]
buffer_load_dwordx4 v13, s[36:39], s64 offen lds
v_mfma_f32_16x16x32_bf16 v[64:67], a[192:195], v[160:163], v[64:67]
s_add_u32 m0, s86, 100352
ds_read_b64_tr_b16 a[154:155], v197 offset:36864
v_mfma_f32_16x16x32_bf16 v[64:67], a[196:199], v[164:167], v[64:67]
s_add_u32 s64, s85, 1064960
ds_read_b64_tr_b16 a[156:157], v197 offset:40960
v_mfma_f32_16x16x32_bf16 v[32:35], a[196:199], v[156:159], v[32:35]
buffer_load_dwordx4 v12, s[36:39], s64 offen lds
v_mfma_f32_16x16x32_bf16 v[32:35], a[192:195], v[152:155], v[32:35]
s_waitcnt lgkmcnt(4)
s_add_u32 m0, s86, 101376
ds_read_b64_tr_b16 a[158:159], v197 offset:45056
v_mfma_f32_16x16x32_bf16 v[36:39], a[200:203], v[152:155], v[36:39]
s_add_u32 s64, s85, 1073152
ds_read_b64_tr_b16 a[160:161], v198 offset:32768
v_mfma_f32_16x16x32_bf16 v[36:39], a[204:207], v[156:159], v[36:39]
buffer_load_dwordx4 v13, s[36:39], s64 offen lds
v_mfma_f32_16x16x32_bf16 v[68:71], a[204:207], v[164:167], v[68:71]
s_add_u32 m0, s86, 102400
ds_read_b64_tr_b16 a[162:163], v198 offset:36864
v_mfma_f32_16x16x32_bf16 v[68:71], a[200:203], v[160:163], v[68:71]
s_add_u32 s64, s85, 1081344
ds_read_b64_tr_b16 a[164:165], v198 offset:40960
v_mfma_f32_16x16x32_bf16 v[100:103], a[200:203], v[168:171], v[100:103]
buffer_load_dwordx4 v12, s[36:39], s64 offen lds
v_mfma_f32_16x16x32_bf16 v[100:103], a[204:207], v[172:175], v[100:103]
ds_read_b64_tr_b16 a[166:167], v198 offset:45056
v_mfma_f32_16x16x32_bf16 v[132:135], a[204:207], v[180:183], v[132:135]
v_mfma_f32_16x16x32_bf16 v[132:135], a[200:203], v[176:179], v[132:135]
s_waitcnt vmcnt(26)
v_mfma_f32_16x16x32_bf16 v[136:139], a[144:147], a[24:27], v[136:139]
s_waitcnt vmcnt(22)
s_waitcnt lgkmcnt(3)
s_add_u32 m0, s86, 103424
ds_read_b64_tr_b16 a[168:169], v199 offset:32768
v_mfma_f32_16x16x32_bf16 v[136:139], a[148:151], a[28:31], v[136:139]
s_add_u32 s64, s85, 1089536
ds_read_b64_tr_b16 a[170:171], v199 offset:36864
v_mfma_f32_16x16x32_bf16 v[104:107], a[148:151], a[20:23], v[104:107]
buffer_load_dwordx4 v13, s[36:39], s64 offen lds
v_mfma_f32_16x16x32_bf16 v[104:107], a[144:147], a[16:19], v[104:107]
s_add_u32 m0, s86, 104448
ds_read_b64_tr_b16 a[172:173], v199 offset:40960
v_mfma_f32_16x16x32_bf16 v[72:75], a[144:147], a[8:11], v[72:75]
s_add_u32 s64, s85, 1097728
ds_read_b64_tr_b16 a[174:175], v199 offset:45056
v_mfma_f32_16x16x32_bf16 v[72:75], a[148:151], a[12:15], v[72:75]
buffer_load_dwordx4 v12, s[36:39], s64 offen lds
v_mfma_f32_16x16x32_bf16 v[40:43], a[148:151], a[4:7], v[40:43]
ds_read_b64_tr_b16 a[176:177], v192 offset:32768
v_mfma_f32_16x16x32_bf16 v[40:43], a[144:147], a[0:3], v[40:43]
s_add_u32 m0, s86, 105472
ds_read_b64_tr_b16 a[178:179], v192 offset:36864
v_mfma_f32_16x16x32_bf16 v[44:47], a[152:155], a[0:3], v[44:47]
s_add_u32 s64, s85, 1105920
ds_read_b64_tr_b16 a[180:181], v192 offset:40960
v_mfma_f32_16x16x32_bf16 v[44:47], a[156:159], a[4:7], v[44:47]
buffer_load_dwordx4 v13, s[36:39], s64 offen lds
v_mfma_f32_16x16x32_bf16 v[76:79], a[156:159], a[12:15], v[76:79]
ds_read_b64_tr_b16 a[182:183], v192 offset:45056
v_mfma_f32_16x16x32_bf16 v[76:79], a[152:155], a[8:11], v[76:79]
s_add_u32 s65, s84, 131072
ds_read_b64_tr_b16 a[184:185], v193 offset:32768
v_mfma_f32_16x16x32_bf16 v[108:111], a[152:155], a[16:19], v[108:111]
buffer_load_dwordx4 a[32:35], v14, s[44:47], s65 offen offset:0 sc1
v_mfma_f32_16x16x32_bf16 v[108:111], a[156:159], a[20:23], v[108:111]
ds_read_b64_tr_b16 a[186:187], v193 offset:36864
v_mfma_f32_16x16x32_bf16 v[140:143], a[156:159], a[28:31], v[140:143]
ds_read_b64_tr_b16 a[188:189], v193 offset:40960
v_mfma_f32_16x16x32_bf16 v[140:143], a[152:155], a[24:27], v[140:143]
s_waitcnt lgkmcnt(5)
ds_read_b64_tr_b16 a[190:191], v193 offset:45056
v_mfma_f32_16x16x32_bf16 v[144:147], a[160:163], a[24:27], v[144:147]
s_and_b32 s68, s82, 3
buffer_load_dwordx4 a[40:43], v14, s[44:47], s65 offen offset:1024 sc1
v_mfma_f32_16x16x32_bf16 v[144:147], a[164:167], a[28:31], v[144:147]
s_lshl_b32 s68, s68, 11
s_add_u32 s76, s86, s68
s_lshr_b32 s69, s87, 8
v_mfma_f32_16x16x32_bf16 v[112:115], a[164:167], a[20:23], v[112:115]
s_lshr_b32 s67, s82, 1
s_xor_b32 s69, s69, s67
ds_read_b64_tr_b16 a[192:193], v194 offset:32768
v_mfma_f32_16x16x32_bf16 v[112:115], a[160:163], a[16:19], v[112:115]
s_and_b32 s69, s69, 2
s_lshl_b32 s69, s69, 15
ds_read_b64_tr_b16 a[194:195], v194 offset:36864
v_mfma_f32_16x16x32_bf16 v[80:83], a[160:163], a[8:11], v[80:83]
s_add_u32 s68, s68, s69
buffer_load_dwordx4 a[48:51], v15, s[44:47], s65 offen offset:0 sc1
v_mfma_f32_16x16x32_bf16 v[80:83], a[164:167], a[12:15], v[80:83]
ds_read_b64_tr_b16 a[196:197], v194 offset:40960
v_mfma_f32_16x16x32_bf16 v[48:51], a[164:167], a[4:7], v[48:51]
ds_read_b64_tr_b16 a[198:199], v194 offset:45056
v_mfma_f32_16x16x32_bf16 v[48:51], a[160:163], a[0:3], v[48:51]
buffer_load_dwordx4 a[56:59], v15, s[44:47], s65 offen offset:1024 sc1
v_mfma_f32_16x16x32_bf16 v[52:55], a[168:171], a[0:3], v[52:55]
v_mfma_f32_16x16x32_bf16 v[52:55], a[172:175], a[4:7], v[52:55]
v_mfma_f32_16x16x32_bf16 v[84:87], a[172:175], a[12:15], v[84:87]
s_add_u32 s65, s84, 139264
ds_read_b64_tr_b16 a[200:201], v195 offset:32768
v_mfma_f32_16x16x32_bf16 v[84:87], a[168:171], a[8:11], v[84:87]
buffer_load_dwordx4 a[36:39], v14, s[44:47], s65 offen offset:0 sc1
v_mfma_f32_16x16x32_bf16 v[116:119], a[168:171], a[16:19], v[116:119]
ds_read_b64_tr_b16 a[202:203], v195 offset:36864
v_mfma_f32_16x16x32_bf16 v[116:119], a[172:175], a[20:23], v[116:119]
ds_read_b64_tr_b16 a[204:205], v195 offset:40960
v_mfma_f32_16x16x32_bf16 v[148:151], a[172:175], a[28:31], v[148:151]
ds_read_b64_tr_b16 a[206:207], v195 offset:45056
v_mfma_f32_16x16x32_bf16 v[148:151], a[168:171], a[24:27], v[148:151]
buffer_load_dwordx4 a[44:47], v14, s[44:47], s65 offen offset:1024 sc1
v_mfma_f32_16x16x32_bf16 v[120:123], a[176:179], a[24:27], v[120:123]
s_waitcnt lgkmcnt(4)
v_mfma_f32_16x16x32_bf16 v[120:123], a[180:183], a[28:31], v[120:123]
v_mfma_f32_16x16x32_bf16 v[88:91], a[180:183], a[20:23], v[88:91]
buffer_load_dwordx4 a[52:55], v15, s[44:47], s65 offen offset:0 sc1
v_mfma_f32_16x16x32_bf16 v[88:91], a[176:179], a[16:19], v[88:91]
v_mfma_f32_16x16x32_bf16 v[56:59], a[176:179], a[8:11], v[56:59]
v_mfma_f32_16x16x32_bf16 v[56:59], a[180:183], a[12:15], v[56:59]
v_mfma_f32_16x16x32_bf16 v[24:27], a[180:183], a[4:7], v[24:27]
buffer_load_dwordx4 a[60:63], v15, s[44:47], s65 offen offset:1024 sc1
v_mfma_f32_16x16x32_bf16 v[24:27], a[176:179], a[0:3], v[24:27]
v_mfma_f32_16x16x32_bf16 v[28:31], a[184:187], a[0:3], v[28:31]
v_mfma_f32_16x16x32_bf16 v[28:31], a[188:191], a[4:7], v[28:31]
v_mfma_f32_16x16x32_bf16 v[60:63], a[188:191], a[12:15], v[60:63]
s_lshl3_add_u32 s85, s68, s85
v_mfma_f32_16x16x32_bf16 v[60:63], a[184:187], a[8:11], v[60:63]
s_waitcnt vmcnt(25)
s_barrier
v_mfma_f32_16x16x32_bf16 v[92:95], a[184:187], a[16:19], v[92:95]
ds_read_b64_tr_b16 a[144:145], v204 offset:0
v_mfma_f32_16x16x32_bf16 v[92:95], a[188:191], a[20:23], v[92:95]
ds_read_b64_tr_b16 a[146:147], v204 offset:4096
v_mfma_f32_16x16x32_bf16 v[124:127], a[188:191], a[28:31], v[124:127]
s_xor_b32 m0, s76, 131072
ds_read_b64_tr_b16 a[148:149], v204 offset:8192
v_mfma_f32_16x16x32_bf16 v[124:127], a[184:187], a[24:27], v[124:127]
s_xor_b32 s64, s85, 0
ds_read_b64_tr_b16 a[150:151], v204 offset:12288
v_mfma_f32_16x16x32_bf16 v[128:131], a[192:195], a[24:27], v[128:131]
buffer_load_dwordx4 v12, s[40:43], s64 offen lds
v_mfma_f32_16x16x32_bf16 v[128:131], a[196:199], a[28:31], v[128:131]
s_xor_b32 m0, s76, 132096
ds_read_b64_tr_b16 a[152:153], v205 offset:0
v_mfma_f32_16x16x32_bf16 v[96:99], a[196:199], a[20:23], v[96:99]
s_xor_b32 s64, s85, 8192
ds_read_b64_tr_b16 a[154:155], v205 offset:4096
v_mfma_f32_16x16x32_bf16 v[96:99], a[192:195], a[16:19], v[96:99]
buffer_load_dwordx4 v13, s[40:43], s64 offen lds
v_mfma_f32_16x16x32_bf16 v[64:67], a[192:195], a[8:11], v[64:67]
s_xor_b32 m0, s76, 133120
ds_read_b64_tr_b16 a[156:157], v205 offset:8192
v_mfma_f32_16x16x32_bf16 v[64:67], a[196:199], a[12:15], v[64:67]
s_xor_b32 s64, s85, 16384
ds_read_b64_tr_b16 a[158:159], v205 offset:12288
v_mfma_f32_16x16x32_bf16 v[32:35], a[196:199], a[4:7], v[32:35]
buffer_load_dwordx4 v12, s[40:43], s64 offen lds
v_mfma_f32_16x16x32_bf16 v[32:35], a[192:195], a[0:3], v[32:35]
s_waitcnt lgkmcnt(4)
s_xor_b32 m0, s76, 134144
ds_read_b64_tr_b16 a[160:161], v206 offset:0
v_mfma_f32_16x16x32_bf16 v[36:39], a[200:203], a[0:3], v[36:39]
s_xor_b32 s64, s85, 24576
ds_read_b64_tr_b16 a[162:163], v206 offset:4096
v_mfma_f32_16x16x32_bf16 v[36:39], a[204:207], a[4:7], v[36:39]
buffer_load_dwordx4 v13, s[40:43], s64 offen lds
v_mfma_f32_16x16x32_bf16 v[68:71], a[204:207], a[12:15], v[68:71]
s_xor_b32 m0, s76, 135168
ds_read_b64_tr_b16 a[164:165], v206 offset:8192
v_mfma_f32_16x16x32_bf16 v[68:71], a[200:203], a[8:11], v[68:71]
s_xor_b32 s64, s85, 32768
ds_read_b64_tr_b16 a[166:167], v206 offset:12288
v_mfma_f32_16x16x32_bf16 v[100:103], a[200:203], a[16:19], v[100:103]
buffer_load_dwordx4 v12, s[40:43], s64 offen lds
v_mfma_f32_16x16x32_bf16 v[100:103], a[204:207], a[20:23], v[100:103]
v_mfma_f32_16x16x32_bf16 v[132:135], a[204:207], a[28:31], v[132:135]
v_mfma_f32_16x16x32_bf16 v[132:135], a[200:203], a[24:27], v[132:135]
s_waitcnt vmcnt(26)
v_mfma_f32_16x16x32_bf16 v[136:139], a[144:147], a[88:91], v[136:139]
s_waitcnt vmcnt(22)
s_xor_b32 m0, s76, 136192
ds_read_b64_tr_b16 a[168:169], v207 offset:0
v_mfma_f32_16x16x32_bf16 v[136:139], a[148:151], a[92:95], v[136:139]
s_xor_b32 s64, s85, 40960
ds_read_b64_tr_b16 a[170:171], v207 offset:4096
v_mfma_f32_16x16x32_bf16 v[104:107], a[148:151], a[84:87], v[104:107]
buffer_load_dwordx4 v13, s[40:43], s64 offen lds
v_mfma_f32_16x16x32_bf16 v[104:107], a[144:147], a[80:83], v[104:107]
ds_read_b64_tr_b16 a[172:173], v207 offset:8192
v_mfma_f32_16x16x32_bf16 v[72:75], a[144:147], a[72:75], v[72:75]
ds_read_b64_tr_b16 a[174:175], v207 offset:12288
v_mfma_f32_16x16x32_bf16 v[72:75], a[148:151], a[76:79], v[72:75]
ds_read_b64_tr_b16 a[176:177], v200 offset:0
v_mfma_f32_16x16x32_bf16 v[40:43], a[148:151], a[68:71], v[40:43]
ds_read_b64_tr_b16 a[178:179], v200 offset:4096
v_mfma_f32_16x16x32_bf16 v[40:43], a[144:147], a[64:67], v[40:43]
s_waitcnt lgkmcnt(6)
ds_read_b64_tr_b16 a[180:181], v200 offset:8192
v_mfma_f32_16x16x32_bf16 v[44:47], a[152:155], a[64:67], v[44:47]
s_xor_b32 m0, s76, 137216
ds_read_b64_tr_b16 a[182:183], v200 offset:12288
v_mfma_f32_16x16x32_bf16 v[44:47], a[156:159], a[68:71], v[44:47]
s_xor_b32 s64, s85, 49152
v_mfma_f32_16x16x32_bf16 v[76:79], a[156:159], a[76:79], v[76:79]
buffer_load_dwordx4 v12, s[40:43], s64 offen lds
v_mfma_f32_16x16x32_bf16 v[76:79], a[152:155], a[72:75], v[76:79]
ds_read_b64_tr_b16 a[184:185], v201 offset:0
v_mfma_f32_16x16x32_bf16 v[108:111], a[152:155], a[80:83], v[108:111]
ds_read_b64_tr_b16 a[186:187], v201 offset:4096
v_mfma_f32_16x16x32_bf16 v[108:111], a[156:159], a[84:87], v[108:111]
ds_read_b64_tr_b16 a[188:189], v201 offset:8192
v_mfma_f32_16x16x32_bf16 v[140:143], a[156:159], a[92:95], v[140:143]
ds_read_b64_tr_b16 a[190:191], v201 offset:12288
v_mfma_f32_16x16x32_bf16 v[140:143], a[152:155], a[88:91], v[140:143]
v_mfma_f32_16x16x32_bf16 v[144:147], a[160:163], a[88:91], v[144:147]
v_mfma_f32_16x16x32_bf16 v[144:147], a[164:167], a[92:95], v[144:147]
s_xor_b32 m0, s76, 138240
v_mfma_f32_16x16x32_bf16 v[112:115], a[164:167], a[84:87], v[112:115]
s_xor_b32 s64, s85, 57344
ds_read_b64_tr_b16 a[192:193], v202 offset:0
v_mfma_f32_16x16x32_bf16 v[112:115], a[160:163], a[80:83], v[112:115]
buffer_load_dwordx4 v13, s[40:43], s64 offen lds
v_mfma_f32_16x16x32_bf16 v[80:83], a[160:163], a[72:75], v[80:83]
ds_read_b64_tr_b16 a[194:195], v202 offset:4096
v_mfma_f32_16x16x32_bf16 v[80:83], a[164:167], a[76:79], v[80:83]
ds_read_b64_tr_b16 a[196:197], v202 offset:8192
v_mfma_f32_16x16x32_bf16 v[48:51], a[164:167], a[68:71], v[48:51]
ds_read_b64_tr_b16 a[198:199], v202 offset:12288
v_mfma_f32_16x16x32_bf16 v[48:51], a[160:163], a[64:67], v[48:51]
s_waitcnt lgkmcnt(4)
v_mfma_f32_16x16x32_bf16 v[52:55], a[168:171], a[64:67], v[52:55]
v_mfma_f32_16x16x32_bf16 v[52:55], a[172:175], a[68:71], v[52:55]
v_mfma_f32_16x16x32_bf16 v[84:87], a[172:175], a[76:79], v[84:87]
ds_read_b64_tr_b16 a[200:201], v203 offset:0
v_mfma_f32_16x16x32_bf16 v[84:87], a[168:171], a[72:75], v[84:87]
ds_read_b64_tr_b16 a[202:203], v203 offset:4096
v_mfma_f32_16x16x32_bf16 v[116:119], a[168:171], a[80:83], v[116:119]
ds_read_b64_tr_b16 a[204:205], v203 offset:8192
v_mfma_f32_16x16x32_bf16 v[116:119], a[172:175], a[84:87], v[116:119]
ds_read_b64_tr_b16 a[206:207], v203 offset:12288
v_mfma_f32_16x16x32_bf16 v[148:151], a[172:175], a[92:95], v[148:151]
buffer_load_dword v19, off, s[52:55], s72 sc1
v_mfma_f32_16x16x32_bf16 v[148:151], a[168:171], a[88:91], v[148:151]
v_mfma_f32_16x16x32_bf16 v[120:123], a[176:179], a[88:91], v[120:123]
v_mfma_f32_16x16x32_bf16 v[120:123], a[180:183], a[92:95], v[120:123]
v_mfma_f32_16x16x32_bf16 v[88:91], a[180:183], a[84:87], v[88:91]
v_mfma_f32_16x16x32_bf16 v[88:91], a[176:179], a[80:83], v[88:91]
s_branch L_po25
L_pg25:
s_branch L_tr2
L_po25:
v_mfma_f32_16x16x32_bf16 v[56:59], a[176:179], a[72:75], v[56:59]
v_mfma_f32_16x16x32_bf16 v[56:59], a[180:183], a[76:79], v[56:59]
v_mfma_f32_16x16x32_bf16 v[24:27], a[180:183], a[68:71], v[24:27]
v_mfma_f32_16x16x32_bf16 v[24:27], a[176:179], a[64:67], v[24:27]
v_mfma_f32_16x16x32_bf16 v[28:31], a[184:187], a[64:67], v[28:31]
v_mfma_f32_16x16x32_bf16 v[28:31], a[188:191], a[68:71], v[28:31]
v_mfma_f32_16x16x32_bf16 v[60:63], a[188:191], a[76:79], v[60:63]
v_mfma_f32_16x16x32_bf16 v[60:63], a[184:187], a[72:75], v[60:63]
s_waitcnt vmcnt(17)
s_barrier
v_mfma_f32_16x16x32_bf16 v[92:95], a[184:187], a[80:83], v[92:95]
ds_read_b64_tr_b16 a[144:145], v188 offset:0
v_mfma_f32_16x16x32_bf16 v[92:95], a[188:191], a[84:87], v[92:95]
ds_read_b64_tr_b16 a[146:147], v188 offset:4096
v_mfma_f32_16x16x32_bf16 v[124:127], a[188:191], a[92:95], v[124:127]
s_xor_b32 m0, s76, 32768
ds_read_b64_tr_b16 a[148:149], v188 offset:8192
v_mfma_f32_16x16x32_bf16 v[124:127], a[184:187], a[88:91], v[124:127]
s_waitcnt lgkmcnt(3)
s_xor_b32 s64, s85, 262144
ds_read_b64_tr_b16 a[150:151], v188 offset:12288
v_mfma_f32_16x16x32_bf16 v[128:131], a[192:195], a[88:91], v[128:131]
buffer_load_dwordx4 v12, s[40:43], s64 offen lds
v_mfma_f32_16x16x32_bf16 v[128:131], a[196:199], a[92:95], v[128:131]
s_xor_b32 m0, s76, 33792
s_xor_b32 s64, s85, 270336
ds_read_b64_tr_b16 a[152:153], v189 offset:0
v_mfma_f32_16x16x32_bf16 v[96:99], a[196:199], a[84:87], v[96:99]
buffer_load_dwordx4 v13, s[40:43], s64 offen lds
v_mfma_f32_16x16x32_bf16 v[96:99], a[192:195], a[80:83], v[96:99]
s_xor_b32 m0, s76, 34816
ds_read_b64_tr_b16 a[154:155], v189 offset:4096
v_mfma_f32_16x16x32_bf16 v[64:67], a[192:195], a[72:75], v[64:67]
s_xor_b32 s64, s85, 278528
ds_read_b64_tr_b16 a[156:157], v189 offset:8192
v_mfma_f32_16x16x32_bf16 v[64:67], a[196:199], a[76:79], v[64:67]
buffer_load_dwordx4 v12, s[40:43], s64 offen lds
v_mfma_f32_16x16x32_bf16 v[32:35], a[196:199], a[68:71], v[32:35]
s_xor_b32 m0, s76, 35840
ds_read_b64_tr_b16 a[158:159], v189 offset:12288
v_mfma_f32_16x16x32_bf16 v[32:35], a[192:195], a[64:67], v[32:35]
s_xor_b32 s64, s85, 286720
ds_read_b64_tr_b16 a[160:161], v190 offset:0
v_mfma_f32_16x16x32_bf16 v[36:39], a[200:203], a[64:67], v[36:39]
buffer_load_dwordx4 v13, s[40:43], s64 offen lds
v_mfma_f32_16x16x32_bf16 v[36:39], a[204:207], a[68:71], v[36:39]
s_xor_b32 m0, s76, 36864
s_xor_b32 s64, s85, 294912
ds_read_b64_tr_b16 a[162:163], v190 offset:4096
v_mfma_f32_16x16x32_bf16 v[68:71], a[204:207], a[76:79], v[68:71]
buffer_load_dwordx4 v12, s[40:43], s64 offen lds
v_mfma_f32_16x16x32_bf16 v[68:71], a[200:203], a[72:75], v[68:71]
s_xor_b32 m0, s76, 37888
ds_read_b64_tr_b16 a[164:165], v190 offset:8192
v_mfma_f32_16x16x32_bf16 v[100:103], a[200:203], a[80:83], v[100:103]
s_xor_b32 s64, s85, 303104
ds_read_b64_tr_b16 a[166:167], v190 offset:12288
v_mfma_f32_16x16x32_bf16 v[100:103], a[204:207], a[84:87], v[100:103]
buffer_load_dwordx4 v13, s[40:43], s64 offen lds
v_mfma_f32_16x16x32_bf16 v[132:135], a[204:207], a[92:95], v[132:135]
v_mfma_f32_16x16x32_bf16 v[132:135], a[200:203], a[88:91], v[132:135]
s_waitcnt vmcnt(19)
s_waitcnt lgkmcnt(3)
v_mfma_f32_16x16x32_bf16 v[136:139], a[144:147], a[56:59], v[136:139]
s_waitcnt vmcnt(6)
v_readfirstlane_b32 vcc_lo, v19
s_nop 0
s_cmp_lt_u32 vcc_lo, 8
s_cbranch_scc1 L_spin_3019
L_spinbk_3020:
s_sub_u32 s84, s84, 1048576
s_add_u32 s84, s84, s69
v_mfma_f32_16x16x32_bf16 v[136:139], a[148:151], a[60:63], v[136:139]
s_xor_b32 s65, s84, 0
ds_read_b64_tr_b16 a[168:169], v191 offset:0
v_mfma_f32_16x16x32_bf16 v[104:107], a[148:151], a[52:55], v[104:107]
buffer_load_dwordx4 a[208:211], v14, s[44:47], s65 offen offset:0 sc1
v_mfma_f32_16x16x32_bf16 v[104:107], a[144:147], a[48:51], v[104:107]
ds_read_b64_tr_b16 a[170:171], v191 offset:4096
v_mfma_f32_16x16x32_bf16 v[72:75], a[144:147], a[40:43], v[72:75]
buffer_load_dwordx4 a[216:219], v14, s[44:47], s65 offen offset:1024 sc1
v_mfma_f32_16x16x32_bf16 v[72:75], a[148:151], a[44:47], v[72:75]
ds_read_b64_tr_b16 a[172:173], v191 offset:8192
v_mfma_f32_16x16x32_bf16 v[40:43], a[148:151], a[36:39], v[40:43]
buffer_load_dwordx4 a[224:227], v15, s[44:47], s65 offen offset:0 sc1
v_mfma_f32_16x16x32_bf16 v[40:43], a[144:147], a[32:35], v[40:43]
ds_read_b64_tr_b16 a[174:175], v191 offset:12288
v_mfma_f32_16x16x32_bf16 v[44:47], a[152:155], a[32:35], v[44:47]
buffer_load_dwordx4 a[232:235], v15, s[44:47], s65 offen offset:1024 sc1
v_mfma_f32_16x16x32_bf16 v[44:47], a[156:159], a[36:39], v[44:47]
s_xor_b32 s65, s84, 8192
ds_read_b64_tr_b16 a[176:177], v184 offset:0
v_mfma_f32_16x16x32_bf16 v[76:79], a[156:159], a[44:47], v[76:79]
buffer_load_dwordx4 a[212:215], v14, s[44:47], s65 offen offset:0 sc1
v_mfma_f32_16x16x32_bf16 v[76:79], a[152:155], a[40:43], v[76:79]
ds_read_b64_tr_b16 a[178:179], v184 offset:4096
v_mfma_f32_16x16x32_bf16 v[108:111], a[152:155], a[48:51], v[108:111]
ds_read_b64_tr_b16 a[180:181], v184 offset:8192
v_mfma_f32_16x16x32_bf16 v[108:111], a[156:159], a[52:55], v[108:111]
buffer_load_dwordx4 a[220:223], v14, s[44:47], s65 offen offset:1024 sc1
v_mfma_f32_16x16x32_bf16 v[140:143], a[156:159], a[60:63], v[140:143]
ds_read_b64_tr_b16 a[182:183], v184 offset:12288
v_mfma_f32_16x16x32_bf16 v[140:143], a[152:155], a[56:59], v[140:143]
s_waitcnt lgkmcnt(4)
buffer_load_dwordx4 a[228:231], v15, s[44:47], s65 offen offset:0 sc1
v_mfma_f32_16x16x32_bf16 v[144:147], a[160:163], a[56:59], v[144:147]
ds_read_b64_tr_b16 a[184:185], v185 offset:0
v_mfma_f32_16x16x32_bf16 v[144:147], a[164:167], a[60:63], v[144:147]
buffer_load_dwordx4 a[236:239], v15, s[44:47], s65 offen offset:1024 sc1
v_mfma_f32_16x16x32_bf16 v[112:115], a[164:167], a[52:55], v[112:115]
s_xor_b32 m0, s76, 38912
s_xor_b32 s64, s85, 311296
ds_read_b64_tr_b16 a[186:187], v185 offset:4096
v_mfma_f32_16x16x32_bf16 v[112:115], a[160:163], a[48:51], v[112:115]
buffer_load_dwordx4 v12, s[40:43], s64 offen lds
v_mfma_f32_16x16x32_bf16 v[80:83], a[160:163], a[40:43], v[80:83]
s_xor_b32 m0, s76, 39936
ds_read_b64_tr_b16 a[188:189], v185 offset:8192
v_mfma_f32_16x16x32_bf16 v[80:83], a[164:167], a[44:47], v[80:83]
s_xor_b32 s64, s85, 319488
ds_read_b64_tr_b16 a[190:191], v185 offset:12288
v_mfma_f32_16x16x32_bf16 v[48:51], a[164:167], a[36:39], v[48:51]
buffer_load_dwordx4 v13, s[40:43], s64 offen lds
v_mfma_f32_16x16x32_bf16 v[48:51], a[160:163], a[32:35], v[48:51]
s_xor_b32 s65, s84, 32768
ds_read_b64_tr_b16 a[192:193], v186 offset:0
v_mfma_f32_16x16x32_bf16 v[52:55], a[168:171], a[32:35], v[52:55]
buffer_load_dwordx4 v[152:155], v14, s[44:47], s65 offen offset:0 sc1
v_mfma_f32_16x16x32_bf16 v[52:55], a[172:175], a[36:39], v[52:55]
ds_read_b64_tr_b16 a[194:195], v186 offset:4096
v_mfma_f32_16x16x32_bf16 v[84:87], a[172:175], a[44:47], v[84:87]
buffer_load_dwordx4 v[160:163], v14, s[44:47], s65 offen offset:1024 sc1
v_mfma_f32_16x16x32_bf16 v[84:87], a[168:171], a[40:43], v[84:87]
ds_read_b64_tr_b16 a[196:197], v186 offset:8192
v_mfma_f32_16x16x32_bf16 v[116:119], a[168:171], a[48:51], v[116:119]
buffer_load_dwordx4 v[168:171], v15, s[44:47], s65 offen offset:0 sc1
v_mfma_f32_16x16x32_bf16 v[116:119], a[172:175], a[52:55], v[116:119]
ds_read_b64_tr_b16 a[198:199], v186 offset:12288
v_mfma_f32_16x16x32_bf16 v[148:151], a[172:175], a[60:63], v[148:151]
buffer_load_dwordx4 v[176:179], v15, s[44:47], s65 offen offset:1024 sc1
v_mfma_f32_16x16x32_bf16 v[148:151], a[168:171], a[56:59], v[148:151]
s_waitcnt lgkmcnt(3)
ds_read_b64_tr_b16 a[200:201], v187 offset:0
v_mfma_f32_16x16x32_bf16 v[120:123], a[176:179], a[56:59], v[120:123]
s_xor_b32 s65, s84, 40960
ds_read_b64_tr_b16 a[202:203], v187 offset:4096
v_mfma_f32_16x16x32_bf16 v[120:123], a[180:183], a[60:63], v[120:123]
buffer_load_dwordx4 v[156:159], v14, s[44:47], s65 offen offset:0 sc1
v_mfma_f32_16x16x32_bf16 v[88:91], a[180:183], a[52:55], v[88:91]
ds_read_b64_tr_b16 a[204:205], v187 offset:8192
v_mfma_f32_16x16x32_bf16 v[88:91], a[176:179], a[48:51], v[88:91]
buffer_load_dwordx4 v[164:167], v14, s[44:47], s65 offen offset:1024 sc1
v_mfma_f32_16x16x32_bf16 v[56:59], a[176:179], a[40:43], v[56:59]
ds_read_b64_tr_b16 a[206:207], v187 offset:12288
v_mfma_f32_16x16x32_bf16 v[56:59], a[180:183], a[44:47], v[56:59]
buffer_load_dwordx4 v[172:175], v15, s[44:47], s65 offen offset:0 sc1
v_mfma_f32_16x16x32_bf16 v[24:27], a[180:183], a[36:39], v[24:27]
v_mfma_f32_16x16x32_bf16 v[24:27], a[176:179], a[32:35], v[24:27]
buffer_load_dwordx4 v[180:183], v15, s[44:47], s65 offen offset:1024 sc1
v_mfma_f32_16x16x32_bf16 v[28:31], a[184:187], a[32:35], v[28:31]
v_mfma_f32_16x16x32_bf16 v[28:31], a[188:191], a[36:39], v[28:31]
v_mfma_f32_16x16x32_bf16 v[60:63], a[188:191], a[44:47], v[60:63]
v_mfma_f32_16x16x32_bf16 v[60:63], a[184:187], a[40:43], v[60:63]
s_barrier
v_mfma_f32_16x16x32_bf16 v[92:95], a[184:187], a[48:51], v[92:95]
ds_read_b64_tr_b16 a[144:145], v188 offset:32768
v_mfma_f32_16x16x32_bf16 v[92:95], a[188:191], a[52:55], v[92:95]
ds_read_b64_tr_b16 a[146:147], v188 offset:36864
v_mfma_f32_16x16x32_bf16 v[124:127], a[188:191], a[60:63], v[124:127]
s_xor_b32 m0, s76, 65536
ds_read_b64_tr_b16 a[148:149], v188 offset:40960
v_mfma_f32_16x16x32_bf16 v[124:127], a[184:187], a[56:59], v[124:127]
s_waitcnt lgkmcnt(3)
s_xor_b32 s64, s85, 524288
ds_read_b64_tr_b16 a[150:151], v188 offset:45056
v_mfma_f32_16x16x32_bf16 v[128:131], a[192:195], a[56:59], v[128:131]
buffer_load_dwordx4 v12, s[40:43], s64 offen lds
v_mfma_f32_16x16x32_bf16 v[128:131], a[196:199], a[60:63], v[128:131]
s_xor_b32 m0, s76, 66560
ds_read_b64_tr_b16 a[152:153], v189 offset:32768
v_mfma_f32_16x16x32_bf16 v[96:99], a[196:199], a[52:55], v[96:99]
s_xor_b32 s64, s85, 532480
ds_read_b64_tr_b16 a[154:155], v189 offset:36864
v_mfma_f32_16x16x32_bf16 v[96:99], a[192:195], a[48:51], v[96:99]
buffer_load_dwordx4 v13, s[40:43], s64 offen lds
v_mfma_f32_16x16x32_bf16 v[64:67], a[192:195], a[40:43], v[64:67]
s_xor_b32 m0, s76, 67584
ds_read_b64_tr_b16 a[156:157], v189 offset:40960
v_mfma_f32_16x16x32_bf16 v[64:67], a[196:199], a[44:47], v[64:67]
s_xor_b32 s64, s85, 540672
ds_read_b64_tr_b16 a[158:159], v189 offset:45056
v_mfma_f32_16x16x32_bf16 v[32:35], a[196:199], a[36:39], v[32:35]
buffer_load_dwordx4 v12, s[40:43], s64 offen lds
v_mfma_f32_16x16x32_bf16 v[32:35], a[192:195], a[32:35], v[32:35]
s_xor_b32 m0, s76, 68608
ds_read_b64_tr_b16 a[160:161], v190 offset:32768
v_mfma_f32_16x16x32_bf16 v[36:39], a[200:203], a[32:35], v[36:39]
s_xor_b32 s64, s85, 548864
ds_read_b64_tr_b16 a[162:163], v190 offset:36864
v_mfma_f32_16x16x32_bf16 v[36:39], a[204:207], a[36:39], v[36:39]
buffer_load_dwordx4 v13, s[40:43], s64 offen lds
v_mfma_f32_16x16x32_bf16 v[68:71], a[204:207], a[44:47], v[68:71]
s_xor_b32 m0, s76, 69632
ds_read_b64_tr_b16 a[164:165], v190 offset:40960
v_mfma_f32_16x16x32_bf16 v[68:71], a[200:203], a[40:43], v[68:71]
s_xor_b32 s64, s85, 557056
ds_read_b64_tr_b16 a[166:167], v190 offset:45056
v_mfma_f32_16x16x32_bf16 v[100:103], a[200:203], a[48:51], v[100:103]
buffer_load_dwordx4 v12, s[40:43], s64 offen lds
v_mfma_f32_16x16x32_bf16 v[100:103], a[204:207], a[52:55], v[100:103]
s_mov_b32 s70, 3
s_mov_b32 s73, 2
v_mfma_f32_16x16x32_bf16 v[132:135], a[204:207], a[60:63], v[132:135]
v_mfma_f32_16x16x32_bf16 v[132:135], a[200:203], a[56:59], v[132:135]
s_branch L_p5join
L_spin_4022:
s_mov_b32 vcc_hi, 0x80000
L_spinlp_4024:
s_sleep 1
buffer_load_dword v19, off, s[52:55], s72 offset:128 sc1
s_waitcnt vmcnt(0)
v_readfirstlane_b32 vcc_lo, v19
s_sub_u32 vcc_hi, vcc_hi, 1
s_cbranch_scc1 L_spinbk_4023
s_cmp_lt_u32 vcc_lo, s74
s_cbranch_scc1 L_spinlp_4024
s_branch L_spinbk_4023
L_codeend:
.section .rodata,"a"
.p2align 6
.amdhsa_kernel gated_mix__compressed_kv_cla__sliding_local_dilated__prompt_kernel
  .amdhsa_next_free_vgpr 512
  .amdhsa_next_free_sgpr 102
  .amdhsa_accum_offset 256
  .amdhsa_group_segment_fixed_size 0
  .amdhsa_kernarg_size 104
  .amdhsa_user_sgpr_count 2
  .amdhsa_user_sgpr_kernarg_segment_ptr 1
  .amdhsa_system_sgpr_workgroup_id_x 1
.end_amdhsa_kernel
```

```asm
; @launch grid=(256,1,1) block=(256,1,1) lds=163840
.amdgcn_target "amdgcn-amd-amdhsa--gfx950"
.text
.globl gated_mix__compressed_kv_cla__sliding_local_dilated__prompt_kernel
.p2align 8
.type gated_mix__compressed_kv_cla__sliding_local_dilated__prompt_kernel,@function
gated_mix__compressed_kv_cla__sliding_local_dilated__prompt_kernel:
s_cmp_ge_u32 s2, 256
s_cbranch_scc1 L_end
s_load_dwordx16 s[4:19], s[0:1], 0
s_load_dwordx8 s[20:27], s[0:1], 64
s_load_dwordx2 s[28:29], s[0:1], 96
s_getpc_b64 s[88:89]
L_pc:
v_lshrrev_b32 v1, 6, v0
s_lshr_b32 s67, s2, 3
v_lshl_add_u32 v24, s67, 2, v1
s_mov_b32 s90, L_codeend-L_pc
s_mov_b32 s91, 0x20000
v_and_b32 v25, 7, v0
v_lshlrev_b32 v25, 7, v25
v_lshl_add_u32 v24, v24, 10, v25
buffer_load_dword a252, v24, s[88:91], 0 offen
v_and_b32 v0, 63, v0
v_readfirstlane_b32 s30, v1
v_lshrrev_b32 v24, 3, v0
v_lshrrev_b32 v25, 4, v0
v_and_b32 v26, 7, v0
v_xor_b32 v26, v26, v25
v_lshlrev_b32 v26, 4, v26
v_lshl_add_u32 v12, v24, 10, v26
v_xor_b32 v13, 64, v12
v_bfe_u32 v26, v0, 1, 3
v_xor_b32 v26, v26, v25
v_lshlrev_b32 v26, 5, v26
v_and_b32 v24, 1, v0
v_lshl_add_u32 v26, v24, 4, v26
v_lshl_add_u32 v14, v25, 13, v26
v_xor_b32 v15, 128, v14
s_and_b32 s66, s2, 7
s_and_b32 s68, s67, 3
s_lshl2_add_u32 s31, s66, s68
s_cmp_eq_u32 s68, 0
s_cselect_b32 s90, s90, 0
s_lshr_b32 s3, s67, 2
s_lshl2_add_u32 s80, s67, s30
s_lshl_b32 s70, s3, 18
s_lshl_b32 s66, s30, 16
s_add_u32 s70, s70, s66
s_lshl_b32 s71, s30, 17
s_lshl_b32 s66, s31, 8
s_add_u32 s71, s71, s66
s_lshl_b32 s76, s30, 13
s_lshl_b32 s77, s30, 12
s_lshl_b32 s78, s30, 10
s_cmp_eq_u32 s30, 0
s_cbranch_scc1 L_pg1
s_cmp_eq_u32 s30, 1
s_cbranch_scc1 L_tr9
s_cmp_eq_u32 s30, 2
s_cbranch_scc1 L_tr9
s_branch L_tr9
L_tr9:
s_waitcnt lgkmcnt(0)
s_mov_b32 s32, s6
s_mov_b32 s33, s7
s_mov_b32 s34, 2097152
s_mov_b32 s35, 0x20000
s_mov_b32 s36, s10
s_mov_b32 s37, s11
s_mov_b32 s38, 4194304
s_mov_b32 s39, 0x20000
s_mov_b32 s40, s12
s_mov_b32 s41, s13
s_mov_b32 s42, 4194304
s_mov_b32 s43, 0x20000
s_xor_b32 m0, s76, 0
s_xor_b32 s64, s70, 0
buffer_load_dwordx4 v12, s[32:35], s64 offen lds
s_xor_b32 m0, s76, 1024
s_xor_b32 s64, s70, 8192
buffer_load_dwordx4 v13, s[32:35], s64 offen lds
s_xor_b32 m0, s76, 2048
s_xor_b32 s64, s70, 16384
buffer_load_dwordx4 v12, s[32:35], s64 offen lds
s_xor_b32 m0, s76, 3072
s_xor_b32 s64, s70, 24576
buffer_load_dwordx4 v13, s[32:35], s64 offen lds
s_xor_b32 m0, s77, 65536
s_xor_b32 s64, s71, 0
buffer_load_dwordx4 v14, s[36:39], s64 offen lds
s_xor_b32 m0, s77, 66560
s_xor_b32 s64, s71, 32768
buffer_load_dwordx4 v14, s[36:39], s64 offen lds
s_xor_b32 m0, s77, 67584
s_xor_b32 s64, s71, 65536
buffer_load_dwordx4 v15, s[36:39], s64 offen lds
s_xor_b32 m0, s77, 68608
s_xor_b32 s64, s71, 98304
buffer_load_dwordx4 v15, s[36:39], s64 offen lds
s_mov_b32 s44, s28
s_mov_b32 s45, s29
s_mov_b32 s46, 134217728
s_mov_b32 s47, 0x20000
s_mov_b32 s48, s4
s_mov_b32 s49, s5
s_mov_b32 s50, 4194304
s_mov_b32 s51, 0x20000
s_mov_b32 s52, s26
s_mov_b32 s53, s27
s_mov_b32 s54, 256
s_mov_b32 s55, 0x20000
s_mov_b32 s56, s8
s_mov_b32 s57, s9
s_mov_b32 s58, 8388608
s_mov_b32 s59, 0x20000
s_mov_b32 s60, s18
s_mov_b32 s61, s19
s_mov_b32 s62, 6291456
s_mov_b32 s63, 0x20000
v_accvgpr_write_b32 a251, 1
v_and_b32 v24, 15, v0
v_lshrrev_b32 v26, 1, v24
v_xor_b32 v26, v26, v25
v_lshlrev_b32 v26, 4, v26
v_lshl_add_u32 v26, v24, 7, v26
v_add_u32 v2, s76, v26
v_xor_b32 v3, 64, v2
v_bfe_u32 v24, v0, 2, 2
v_lshl_add_u32 v27, v25, 3, v24
v_and_b32 v1, 3, v0
v_cmp_eq_u32 vcc, 0, v1
v_lshlrev_b32 v1, 3, v1
v_lshl_add_u32 v26, v27, 8, v1
v_add_u32 v26, 65536, v26
v_and_b32 v1, 1, v25
v_lshl_add_u32 v24, v1, 2, v24
v_lshlrev_b32 v16, 4, v0
v_mov_b32 v28, 0x3f803f80
v_cndmask_b32 v28, 0, v28, vcc
v_accvgpr_write_b32 a244, v28
v_accvgpr_write_b32 a245, v28
v_accvgpr_write_b32 a246, v28
v_accvgpr_write_b32 a247, v28
v_xor_b32 v1, 0, v24
v_lshl_add_u32 v4, v1, 5, v26
v_xor_b32 v1, 1, v24
v_lshl_add_u32 v5, v1, 5, v26
v_xor_b32 v1, 2, v24
v_lshl_add_u32 v6, v1, 5, v26
v_xor_b32 v1, 3, v24
v_lshl_add_u32 v7, v1, 5, v26
v_xor_b32 v1, 4, v24
v_lshl_add_u32 v8, v1, 5, v26
v_xor_b32 v1, 5, v24
v_lshl_add_u32 v9, v1, 5, v26
v_xor_b32 v1, 6, v24
v_lshl_add_u32 v10, v1, 5, v26
v_xor_b32 v1, 7, v24
v_lshl_add_u32 v11, v1, 5, v26
s_sub_u32 s16, 15, s3
s_lshl_b32 s72, s3, 18
s_lshl_b32 s73, s16, 18
s_cmp_lt_u32 s30, 2
s_cselect_b32 s67, s3, s16
s_lshl4_add_u32 s74, s31, s67
s_and_b32 s66, s30, 1
s_lshl1_add_u32 s74, s74, s66
s_lshl_b32 s74, s74, 10
s_add_u32 s74, s74, 60817408
s_lshl_b32 s66, s30, 15
s_add_u32 s72, s72, s66
s_add_u32 s73, s73, s66
s_mul_i32 s75, s30, 98304
s_lshl_b32 s66, s31, 6
s_add_u32 s75, s75, s66
s_lshl_b32 s79, s31, 20
s_lshl_b32 s66, s3, 17
s_add_u32 s79, s79, s66
s_lshl_b32 s66, s30, 15
s_add_u32 s79, s79, s66
v_bfe_u32 v23, v0, 1, 1
v_lshrrev_b32 v1, 5, v0
v_xor_b32 v23, v23, v1
v_lshlrev_b32 v23, 5, v23
v_and_b32 v1, 1, v0
v_lshl_add_u32 v23, v1, 4, v23
v_lshrrev_b32 v1, 2, v0
v_mul_u32_u24 v1, 6144, v1
v_add_u32 v23, v1, v23
s_lshl_b32 s81, s80, 13
s_and_b32 s67, s2, 7
s_lshl_b32 s82, s67, 8
s_add_u32 s82, s82, s81
s_lshl_b32 s67, s67, 10
s_add_u32 s81, s81, s67
s_add_u32 s83, s81, 1048576
v_mul_u32_u24 v1, 1792, v25
v_add_u32 v1, v1, v16
s_lshl_b32 s68, s2, 3
s_lshl1_add_u32 s68, s30, s68
v_lshrrev_b32 v18, 5, v0
v_add_u32 v18, s68, v18
v_and_b32 v19, 31, v0
v_lshlrev_b32 v19, 4, v19
v_lshl_add_u32 v18, v18, 11, v19
v_mov_b32 v21, 0
v_min_u32 v20, 1, v0
v_lshlrev_b32 v20, 30, v20
v_accvgpr_write_b32 a240, -1
v_accvgpr_write_b32 a241, -1
v_accvgpr_write_b32 a242, -1
v_accvgpr_write_b32 a243, -1
s_lshr_b32 s69, s2, 7
s_or_b32 s69, s69, s30
s_lshl_b32 s69, s69, 21
s_add_u32 s69, s69, s2
s_lshl_b32 s69, s69, 7
s_add_u32 s69, s69, 59768832
s_cmp_eq_u32 s30, 0
s_cbranch_scc1 L_pg2
s_cmp_eq_u32 s30, 1
s_cbranch_scc1 L_pg3
s_cmp_eq_u32 s30, 2
s_cbranch_scc1 L_pg4
s_branch L_pg5
L_tr0:
s_branch L_base
.p2align 12
L_pg1:
s_branch L_tr9
L_base:
s_xor_b32 m0, s76, 4096
s_xor_b32 s64, s70, 32768
buffer_load_dwordx4 v12, s[32:35], s64 offen lds
s_xor_b32 m0, s76, 5120
s_xor_b32 s64, s70, 40960
buffer_load_dwordx4 v13, s[32:35], s64 offen lds
s_xor_b32 m0, s76, 6144
s_xor_b32 s64, s70, 49152
buffer_load_dwordx4 v12, s[32:35], s64 offen lds
s_xor_b32 m0, s76, 7168
s_xor_b32 s64, s70, 57344
buffer_load_dwordx4 v13, s[32:35], s64 offen lds
s_xor_b32 m0, s77, 81920
s_xor_b32 s64, s71, 0
buffer_load_dwordx4 v14, s[40:43], s64 offen lds
s_xor_b32 m0, s77, 82944
s_xor_b32 s64, s71, 32768
buffer_load_dwordx4 v14, s[40:43], s64 offen lds
s_xor_b32 m0, s77, 83968
s_xor_b32 s64, s71, 65536
buffer_load_dwordx4 v15, s[40:43], s64 offen lds
s_xor_b32 m0, s77, 84992
s_xor_b32 s64, s71, 98304
buffer_load_dwordx4 v15, s[40:43], s64 offen lds
s_and_b32 s66, s31, 3
s_lshl_b32 s67, s66, 11
s_add_u32 s84, s76, s67
s_lshl3_add_u32 s70, s67, s70
s_and_b32 s67, s66, 1
s_lshl_b32 s67, s67, 17
s_add_u32 s72, s72, s67
s_add_u32 s67, s73, s67
s_bitcmp1_b32 s66, 1
s_cselect_b32 s73, s72, s67
s_cselect_b32 s72, s67, s72
s_and_b32 s66, s3, 3
s_lshl_b32 s67, s66, 10
s_add_u32 s77, s77, s67
s_lshl_b32 s67, s66, 15
s_add_u32 s71, s71, s67
s_and_b32 s67, s66, 2
s_lshl_b32 s67, s67, 6
v_xor_b32 v14, s67, v14
v_xor_b32 v15, s67, v15
s_and_b32 s66, s3, 4
s_cselect_b64 s[36:37], s[12:13], s[10:11]
s_cselect_b64 s[40:41], s[10:11], s[12:13]
s_lshl_b32 s66, s66, 12
s_add_u32 s77, s77, s66
s_waitcnt vmcnt(8)
s_barrier
ds_read_b128 a[0:3], v2 offset:0
ds_read_b128 a[4:7], v3 offset:0
ds_read_b64_tr_b16 a[176:177], v4 offset:0
ds_read_b64_tr_b16 a[178:179], v4 offset:1024
ds_read_b64_tr_b16 a[180:181], v4 offset:8192
ds_read_b64_tr_b16 a[182:183], v4 offset:9216
ds_read_b128 a[8:11], v2 offset:2048
ds_read_b128 a[12:15], v3 offset:2048
ds_read_b64_tr_b16 a[184:185], v5 offset:0
ds_read_b64_tr_b16 a[186:187], v5 offset:1024
ds_read_b64_tr_b16 a[188:189], v5 offset:8192
ds_read_b64_tr_b16 a[190:191], v5 offset:9216
ds_read_b64_tr_b16 a[88:89], v6 offset:0
ds_read_b64_tr_b16 a[90:91], v6 offset:1024
ds_read_b64_tr_b16 a[92:93], v6 offset:8192
ds_read_b64_tr_b16 a[94:95], v6 offset:9216
s_waitcnt lgkmcnt(12)
v_mfma_f32_16x16x32_bf16 v[184:187], a[176:179], a[0:3], 0
s_waitcnt lgkmcnt(10)
s_xor_b32 m0, s77, 98304
ds_read_b64_tr_b16 a[96:97], v7 offset:0
v_mfma_f32_16x16x32_bf16 v[184:187], a[180:183], a[4:7], v[184:187]
s_waitcnt lgkmcnt(9)
s_xor_b32 s64, s71, 524288
ds_read_b64_tr_b16 a[98:99], v7 offset:1024
v_mfma_f32_16x16x32_bf16 v[192:195], a[180:183], a[12:15], 0
buffer_load_dwordx4 v14, s[36:39], s64 offen lds
v_mfma_f32_16x16x32_bf16 v[192:195], a[176:179], a[8:11], v[192:195]
s_waitcnt lgkmcnt(8)
ds_read_b64_tr_b16 a[100:101], v7 offset:8192
v_mfma_f32_16x16x32_bf16 v[196:199], a[184:187], a[8:11], 0
s_waitcnt lgkmcnt(7)
s_xor_b32 m0, s77, 99328
ds_read_b64_tr_b16 a[102:103], v7 offset:9216
v_mfma_f32_16x16x32_bf16 v[196:199], a[188:191], a[12:15], v[196:199]
s_xor_b32 s64, s71, 557056
ds_read_b64_tr_b16 a[104:105], v8 offset:0
v_mfma_f32_16x16x32_bf16 v[188:191], a[188:191], a[4:7], 0
buffer_load_dwordx4 v14, s[36:39], s64 offen lds
v_mfma_f32_16x16x32_bf16 v[188:191], a[184:187], a[0:3], v[188:191]
s_waitcnt lgkmcnt(7)
ds_read_b64_tr_b16 a[106:107], v8 offset:1024
v_mfma_f32_16x16x32_bf16 v[216:219], a[88:91], a[0:3], 0
s_waitcnt lgkmcnt(6)
s_xor_b32 m0, s77, 100352
ds_read_b64_tr_b16 a[108:109], v8 offset:8192
v_mfma_f32_16x16x32_bf16 v[216:219], a[92:95], a[4:7], v[216:219]
s_xor_b32 s64, s71, 589824
ds_read_b64_tr_b16 a[110:111], v8 offset:9216
v_mfma_f32_16x16x32_bf16 v[224:227], a[92:95], a[12:15], 0
buffer_load_dwordx4 v15, s[36:39], s64 offen lds
v_mfma_f32_16x16x32_bf16 v[224:227], a[88:91], a[8:11], v[224:227]
s_waitcnt lgkmcnt(6)
ds_read_b64_tr_b16 a[112:113], v9 offset:0
v_mfma_f32_16x16x32_bf16 v[228:231], a[96:99], a[8:11], 0
s_waitcnt lgkmcnt(5)
ds_read_b64_tr_b16 a[114:115], v9 offset:1024
v_mfma_f32_16x16x32_bf16 v[228:231], a[100:103], a[12:15], v[228:231]
s_xor_b32 m0, s77, 101376
ds_read_b64_tr_b16 a[116:117], v9 offset:8192
v_mfma_f32_16x16x32_bf16 v[220:223], a[100:103], a[4:7], 0
s_xor_b32 s64, s71, 622592
ds_read_b64_tr_b16 a[118:119], v9 offset:9216
v_mfma_f32_16x16x32_bf16 v[220:223], a[96:99], a[0:3], v[220:223]
s_waitcnt lgkmcnt(6)
buffer_load_dwordx4 v15, s[36:39], s64 offen lds
v_mfma_f32_16x16x32_bf16 v[152:155], a[104:107], a[0:3], 0
s_waitcnt lgkmcnt(4)
ds_read_b64_tr_b16 a[72:73], v10 offset:0
v_mfma_f32_16x16x32_bf16 v[152:155], a[108:111], a[4:7], v[152:155]
s_xor_b32 m0, s77, 114688
ds_read_b64_tr_b16 a[74:75], v10 offset:1024
v_mfma_f32_16x16x32_bf16 v[160:163], a[108:111], a[12:15], 0
s_xor_b32 s64, s71, 524288
ds_read_b64_tr_b16 a[76:77], v10 offset:8192
ds_read_b64_tr_b16 a[78:79], v10 offset:9216
v_mfma_f32_16x16x32_bf16 v[160:163], a[104:107], a[8:11], v[160:163]
s_waitcnt lgkmcnt(6)
buffer_load_dwordx4 v14, s[40:43], s64 offen lds
v_mfma_f32_16x16x32_bf16 v[164:167], a[112:115], a[8:11], 0
s_waitcnt lgkmcnt(4)
s_xor_b32 m0, s77, 115712
ds_read_b64_tr_b16 a[80:81], v11 offset:0
v_mfma_f32_16x16x32_bf16 v[164:167], a[116:119], a[12:15], v[164:167]
s_xor_b32 s64, s71, 557056
ds_read_b64_tr_b16 a[82:83], v11 offset:1024
v_mfma_f32_16x16x32_bf16 v[156:159], a[116:119], a[4:7], 0
ds_read_b64_tr_b16 a[84:85], v11 offset:8192
ds_read_b64_tr_b16 a[86:87], v11 offset:9216
s_waitcnt vmcnt(9)
v_mfma_f32_16x16x32_bf16 v[156:159], a[112:115], a[0:3], v[156:159]
s_waitcnt lgkmcnt(6)
buffer_load_dwordx4 v14, s[40:43], s64 offen lds
v_mfma_f32_16x16x32_bf16 v[24:27], a[72:75], a[0:3], 0
s_waitcnt lgkmcnt(4)
s_xor_b32 m0, s77, 116736
ds_read_b128 a[16:19], v2 offset:4096
ds_read_b128 a[20:23], v3 offset:4096
v_mfma_f32_16x16x32_bf16 v[24:27], a[76:79], a[4:7], v[24:27]
s_xor_b32 s64, s71, 589824
ds_read_b128 a[24:27], v2 offset:6144
ds_read_b128 a[28:31], v3 offset:6144
v_mfma_f32_16x16x32_bf16 v[40:43], a[76:79], a[12:15], 0
buffer_load_dwordx4 v15, s[40:43], s64 offen lds
v_mfma_f32_16x16x32_bf16 v[40:43], a[72:75], a[8:11], v[40:43]
s_waitcnt lgkmcnt(6)
v_mfma_f32_16x16x32_bf16 v[104:107], a[80:83], a[8:11], 0
s_waitcnt lgkmcnt(4)
s_xor_b32 m0, s77, 117760
v_mfma_f32_16x16x32_bf16 v[104:107], a[84:87], a[12:15], v[104:107]
s_xor_b32 s64, s71, 622592
v_mfma_f32_16x16x32_bf16 v[88:91], a[84:87], a[4:7], 0
buffer_load_dwordx4 v15, s[40:43], s64 offen lds
v_mfma_f32_16x16x32_bf16 v[88:91], a[80:83], a[0:3], v[88:91]
s_waitcnt lgkmcnt(3)
v_mfma_f32_16x16x32_bf16 v[232:235], a[88:91], a[16:19], 0
s_waitcnt lgkmcnt(2)
v_mfma_f32_16x16x32_bf16 v[232:235], a[92:95], a[20:23], v[232:235]
s_waitcnt lgkmcnt(0)
s_xor_b32 m0, s84, 32768
v_mfma_f32_16x16x32_bf16 v[240:243], a[92:95], a[28:31], 0
s_xor_b32 s64, s70, 128
v_mfma_f32_16x16x32_bf16 v[240:243], a[88:91], a[24:27], v[240:243]
buffer_load_dwordx4 v12, s[32:35], s64 offen lds
v_mfma_f32_16x16x32_bf16 v[244:247], a[96:99], a[24:27], 0
s_xor_b32 m0, s84, 33792
v_mfma_f32_16x16x32_bf16 v[244:247], a[100:103], a[28:31], v[244:247]
s_xor_b32 s64, s70, 8320
v_mfma_f32_16x16x32_bf16 v[236:239], a[100:103], a[20:23], 0
s_waitcnt vmcnt(9)
s_barrier
v_mfma_f32_16x16x32_bf16 v[236:239], a[96:99], a[16:19], v[236:239]
buffer_load_dwordx4 v13, s[32:35], s64 offen lds
v_mfma_f32_16x16x32_bf16 v[168:171], a[104:107], a[16:19], 0
ds_read_b64_tr_b16 a[88:89], v4 offset:16384
v_mfma_f32_16x16x32_bf16 v[168:171], a[108:111], a[20:23], v[168:171]
s_xor_b32 m0, s84, 34816
ds_read_b64_tr_b16 a[90:91], v4 offset:17408
v_mfma_f32_16x16x32_bf16 v[176:179], a[108:111], a[28:31], 0
s_xor_b32 s64, s70, 16512
ds_read_b64_tr_b16 a[92:93], v4 offset:24576
v_mfma_f32_16x16x32_bf16 v[176:179], a[104:107], a[24:27], v[176:179]
buffer_load_dwordx4 v12, s[32:35], s64 offen lds
v_mfma_f32_16x16x32_bf16 v[180:183], a[112:115], a[24:27], 0
ds_read_b64_tr_b16 a[94:95], v4 offset:25600
v_mfma_f32_16x16x32_bf16 v[180:183], a[116:119], a[28:31], v[180:183]
s_xor_b32 m0, s84, 35840
ds_read_b64_tr_b16 a[96:97], v5 offset:16384
v_mfma_f32_16x16x32_bf16 v[172:175], a[116:119], a[20:23], 0
s_xor_b32 s64, s70, 24704
ds_read_b64_tr_b16 a[98:99], v5 offset:17408
v_mfma_f32_16x16x32_bf16 v[172:175], a[112:115], a[16:19], v[172:175]
buffer_load_dwordx4 v13, s[32:35], s64 offen lds
v_mfma_f32_16x16x32_bf16 v[56:59], a[72:75], a[16:19], 0
ds_read_b64_tr_b16 a[100:101], v5 offset:24576
v_mfma_f32_16x16x32_bf16 v[56:59], a[76:79], a[20:23], v[56:59]
s_xor_b32 m0, s84, 36864
ds_read_b64_tr_b16 a[102:103], v5 offset:25600
v_mfma_f32_16x16x32_bf16 v[72:75], a[76:79], a[28:31], 0
s_xor_b32 s64, s70, 32896
ds_read_b64_tr_b16 a[104:105], v6 offset:16384
v_mfma_f32_16x16x32_bf16 v[72:75], a[72:75], a[24:27], v[72:75]
buffer_load_dwordx4 v12, s[32:35], s64 offen lds
v_mfma_f32_16x16x32_bf16 v[136:139], a[80:83], a[24:27], 0
ds_read_b64_tr_b16 a[106:107], v6 offset:17408
v_mfma_f32_16x16x32_bf16 v[136:139], a[84:87], a[28:31], v[136:139]
s_xor_b32 m0, s84, 37888
ds_read_b64_tr_b16 a[108:109], v6 offset:24576
v_mfma_f32_16x16x32_bf16 v[120:123], a[84:87], a[20:23], 0
s_xor_b32 s64, s70, 41088
ds_read_b64_tr_b16 a[110:111], v6 offset:25600
v_mfma_f32_16x16x32_bf16 v[120:123], a[80:83], a[16:19], v[120:123]
buffer_load_dwordx4 v13, s[32:35], s64 offen lds
v_mfma_f32_16x16x32_bf16 v[200:203], a[176:179], a[16:19], 0
ds_read_b64_tr_b16 a[112:113], v7 offset:16384
v_mfma_f32_16x16x32_bf16 v[200:203], a[180:183], a[20:23], v[200:203]
s_xor_b32 m0, s84, 38912
ds_read_b64_tr_b16 a[114:115], v7 offset:17408
v_mfma_f32_16x16x32_bf16 v[208:211], a[180:183], a[28:31], 0
s_xor_b32 s64, s70, 49280
ds_read_b64_tr_b16 a[116:117], v7 offset:24576
v_mfma_f32_16x16x32_bf16 v[208:211], a[176:179], a[24:27], v[208:211]
buffer_load_dwordx4 v12, s[32:35], s64 offen lds
v_mfma_f32_16x16x32_bf16 v[212:215], a[184:187], a[24:27], 0
ds_read_b64_tr_b16 a[118:119], v7 offset:25600
v_mfma_f32_16x16x32_bf16 v[212:215], a[188:191], a[28:31], v[212:215]
s_xor_b32 m0, s84, 39936
ds_read_b64_tr_b16 a[72:73], v8 offset:16384
v_mfma_f32_16x16x32_bf16 v[204:207], a[188:191], a[20:23], 0
s_xor_b32 s64, s70, 57472
ds_read_b64_tr_b16 a[74:75], v8 offset:17408
v_mfma_f32_16x16x32_bf16 v[204:207], a[184:187], a[16:19], v[204:207]
s_waitcnt lgkmcnt(7)
buffer_load_dwordx4 v13, s[32:35], s64 offen lds
v_mfma_f32_16x16x32_bf16 v[28:31], a[0:3], a[88:91], 0
ds_read_b64_tr_b16 a[76:77], v8 offset:24576
v_mfma_f32_16x16x32_bf16 v[28:31], a[4:7], a[92:95], v[28:31]
ds_read_b64_tr_b16 a[78:79], v8 offset:25600
v_mfma_f32_16x16x32_bf16 v[44:47], a[12:15], a[92:95], 0
ds_read_b64_tr_b16 a[80:81], v9 offset:16384
v_mfma_f32_16x16x32_bf16 v[44:47], a[8:11], a[88:91], v[44:47]
ds_read_b64_tr_b16 a[82:83], v9 offset:17408
v_mfma_f32_16x16x32_bf16 v[60:63], a[16:19], a[88:91], 0
s_xor_b32 m0, s77, 131072
ds_read_b64_tr_b16 a[84:85], v9 offset:24576
v_mfma_f32_16x16x32_bf16 v[60:63], a[20:23], a[92:95], v[60:63]
s_xor_b32 s64, s71, 1048576
ds_read_b64_tr_b16 a[86:87], v9 offset:25600
v_mfma_f32_16x16x32_bf16 v[76:79], a[28:31], a[92:95], 0
buffer_load_dwordx4 v14, s[36:39], s64 offen lds
v_mfma_f32_16x16x32_bf16 v[76:79], a[24:27], a[88:91], v[76:79]
s_xor_b32 m0, s77, 132096
ds_read_b64_tr_b16 a[88:89], v10 offset:16384
v_mfma_f32_16x16x32_bf16 v[140:143], a[24:27], a[96:99], 0
s_xor_b32 s64, s71, 1081344
ds_read_b64_tr_b16 a[90:91], v10 offset:17408
v_mfma_f32_16x16x32_bf16 v[140:143], a[28:31], a[100:103], v[140:143]
buffer_load_dwordx4 v14, s[36:39], s64 offen lds
v_mfma_f32_16x16x32_bf16 v[124:127], a[20:23], a[100:103], 0
ds_read_b64_tr_b16 a[92:93], v10 offset:24576
v_mfma_f32_16x16x32_bf16 v[124:127], a[16:19], a[96:99], v[124:127]
s_xor_b32 m0, s77, 133120
ds_read_b64_tr_b16 a[94:95], v10 offset:25600
v_mfma_f32_16x16x32_bf16 v[108:111], a[8:11], a[96:99], 0
s_xor_b32 s64, s71, 1114112
v_mfma_f32_16x16x32_bf16 v[108:111], a[12:15], a[100:103], v[108:111]
buffer_load_dwordx4 v15, s[36:39], s64 offen lds
v_mfma_f32_16x16x32_bf16 v[92:95], a[4:7], a[100:103], 0
v_mfma_f32_16x16x32_bf16 v[92:95], a[0:3], a[96:99], v[92:95]
s_xor_b32 m0, s77, 134144
ds_read_b64_tr_b16 a[96:97], v11 offset:16384
v_mfma_f32_16x16x32_bf16 v[32:35], a[0:3], a[104:107], 0
s_waitcnt lgkmcnt(5)
s_xor_b32 s64, s71, 1146880
ds_read_b64_tr_b16 a[98:99], v11 offset:17408
v_mfma_f32_16x16x32_bf16 v[32:35], a[4:7], a[108:111], v[32:35]
buffer_load_dwordx4 v15, s[36:39], s64 offen lds
v_mfma_f32_16x16x32_bf16 v[48:51], a[12:15], a[108:111], 0
ds_read_b64_tr_b16 a[100:101], v11 offset:24576
v_mfma_f32_16x16x32_bf16 v[48:51], a[8:11], a[104:107], v[48:51]
s_xor_b32 m0, s77, 147456
ds_read_b64_tr_b16 a[102:103], v11 offset:25600
v_mfma_f32_16x16x32_bf16 v[64:67], a[16:19], a[104:107], 0
s_xor_b32 s64, s71, 1048576
v_mfma_f32_16x16x32_bf16 v[64:67], a[20:23], a[108:111], v[64:67]
buffer_load_dwordx4 v14, s[40:43], s64 offen lds
v_mfma_f32_16x16x32_bf16 v[80:83], a[28:31], a[108:111], 0
s_xor_b32 m0, s77, 148480
v_mfma_f32_16x16x32_bf16 v[80:83], a[24:27], a[104:107], v[80:83]
s_xor_b32 s64, s71, 1081344
v_mfma_f32_16x16x32_bf16 v[144:147], a[24:27], a[112:115], 0
buffer_load_dwordx4 v14, s[40:43], s64 offen lds
v_mfma_f32_16x16x32_bf16 v[144:147], a[28:31], a[116:119], v[144:147]
v_mfma_f32_16x16x32_bf16 v[128:131], a[20:23], a[116:119], 0
s_xor_b32 m0, s77, 149504
v_mfma_f32_16x16x32_bf16 v[128:131], a[16:19], a[112:115], v[128:131]
s_xor_b32 s64, s71, 1114112
v_mfma_f32_16x16x32_bf16 v[112:115], a[8:11], a[112:115], 0
buffer_load_dwordx4 v15, s[40:43], s64 offen lds
v_mfma_f32_16x16x32_bf16 v[112:115], a[12:15], a[116:119], v[112:115]
v_mfma_f32_16x16x32_bf16 v[96:99], a[4:7], a[116:119], 0
s_xor_b32 m0, s77, 150528
v_mfma_f32_16x16x32_bf16 v[96:99], a[0:3], a[112:115], v[96:99]
s_xor_b32 s64, s71, 1146880
v_mfma_f32_16x16x32_bf16 v[36:39], a[0:3], a[72:75], 0
buffer_load_dwordx4 v15, s[40:43], s64 offen lds
v_mfma_f32_16x16x32_bf16 v[36:39], a[4:7], a[76:79], v[36:39]
s_xor_b32 m0, s84, 0
v_mfma_f32_16x16x32_bf16 v[52:55], a[12:15], a[76:79], 0
s_waitcnt vmcnt(16) lgkmcnt(0)
s_barrier
v_mfma_f32_16x16x32_bf16 v[52:55], a[8:11], a[72:75], v[52:55]
s_xor_b32 s64, s70, 256
ds_read_b64_tr_b16 a[104:105], v4 offset:32768
v_mfma_f32_16x16x32_bf16 v[68:71], a[16:19], a[72:75], 0
buffer_load_dwordx4 v12, s[32:35], s64 offen lds
v_mfma_f32_16x16x32_bf16 v[68:71], a[20:23], a[76:79], v[68:71]
s_xor_b32 m0, s84, 1024
global_load_dwordx4 a[144:147], v18, s[4:5] offset:0
v_mfma_f32_16x16x32_bf16 v[84:87], a[28:31], a[76:79], 0
s_xor_b32 s64, s70, 8448
ds_read_b64_tr_b16 a[106:107], v4 offset:33792
v_mfma_f32_16x16x32_bf16 v[84:87], a[24:27], a[72:75], v[84:87]
buffer_load_dwordx4 v13, s[32:35], s64 offen lds
v_mfma_f32_16x16x32_bf16 v[148:151], a[24:27], a[80:83], 0
ds_read_b64_tr_b16 a[108:109], v4 offset:40960
v_mfma_f32_16x16x32_bf16 v[148:151], a[28:31], a[84:87], v[148:151]
s_xor_b32 m0, s84, 2048
ds_read_b64_tr_b16 a[110:111], v4 offset:41984
v_mfma_f32_16x16x32_bf16 v[132:135], a[20:23], a[84:87], 0
s_waitcnt vmcnt(11)
s_xor_b32 s64, s70, 16640
ds_read_b128 a[32:35], v2 offset:32768
v_mfma_f32_16x16x32_bf16 v[132:135], a[16:19], a[80:83], v[132:135]
buffer_load_dwordx4 v12, s[32:35], s64 offen lds
v_mfma_f32_16x16x32_bf16 v[116:119], a[8:11], a[80:83], 0
ds_read_b128 a[36:39], v3 offset:32768
v_mfma_f32_16x16x32_bf16 v[116:119], a[12:15], a[84:87], v[116:119]
s_xor_b32 m0, s84, 3072
ds_read_b128 a[40:43], v2 offset:34816
v_mfma_f32_16x16x32_bf16 v[100:103], a[4:7], a[84:87], 0
s_xor_b32 s64, s70, 24832
ds_read_b128 a[44:47], v3 offset:34816
v_mfma_f32_16x16x32_bf16 v[100:103], a[0:3], a[80:83], v[100:103]
buffer_load_dwordx4 v13, s[32:35], s64 offen lds
v_mfma_f32_16x16x32_bf16 v[248:251], a[0:3], a[88:91], 0
ds_read_b128 a[48:51], v2 offset:36864
v_mfma_f32_16x16x32_bf16 v[248:251], a[4:7], a[92:95], v[248:251]
s_xor_b32 m0, s84, 4096
ds_read_b128 a[52:55], v3 offset:36864
v_mfma_f32_16x16x32_bf16 v[252:255], a[12:15], a[92:95], 0
s_xor_b32 s64, s70, 33024
ds_read_b128 a[56:59], v2 offset:38912
v_mfma_f32_16x16x32_bf16 v[252:255], a[8:11], a[88:91], v[252:255]
buffer_load_dwordx4 v12, s[32:35], s64 offen lds
v_mfma_f32_16x16x32_bf16 a[120:123], a[16:19], a[88:91], 0
s_xor_b32 m0, s84, 5120
ds_read_b128 a[60:63], v3 offset:38912
v_mfma_f32_16x16x32_bf16 a[120:123], a[20:23], a[92:95], a[120:123]
s_xor_b32 s64, s70, 41216
ds_read_b64_tr_b16 a[112:113], v5 offset:32768
v_mfma_f32_16x16x32_bf16 a[124:127], a[28:31], a[92:95], 0
buffer_load_dwordx4 v13, s[32:35], s64 offen lds
v_mfma_f32_16x16x32_bf16 a[124:127], a[24:27], a[88:91], a[124:127]
ds_read_b64_tr_b16 a[114:115], v5 offset:33792
v_mfma_f32_16x16x32_bf16 a[128:131], a[24:27], a[96:99], 0
s_xor_b32 m0, s84, 6144
ds_read_b64_tr_b16 a[116:117], v5 offset:40960
v_mfma_f32_16x16x32_bf16 a[128:131], a[28:31], a[100:103], a[128:131]
s_xor_b32 s64, s70, 49408
ds_read_b64_tr_b16 a[118:119], v5 offset:41984
v_mfma_f32_16x16x32_bf16 a[132:135], a[20:23], a[100:103], 0
buffer_load_dwordx4 v12, s[32:35], s64 offen lds
v_mfma_f32_16x16x32_bf16 a[132:135], a[16:19], a[96:99], a[132:135]
global_load_dwordx4 a[160:163], v19, s[22:23] offset:0
v_mfma_f32_16x16x32_bf16 a[136:139], a[8:11], a[96:99], 0
s_xor_b32 m0, s84, 7168
ds_read_b64_tr_b16 a[72:73], v6 offset:32768
v_mfma_f32_16x16x32_bf16 a[136:139], a[12:15], a[100:103], a[136:139]
s_xor_b32 s64, s70, 57600
ds_read_b64_tr_b16 a[74:75], v6 offset:33792
v_mfma_f32_16x16x32_bf16 a[140:143], a[4:7], a[100:103], 0
buffer_load_dwordx4 v13, s[32:35], s64 offen lds
v_mfma_f32_16x16x32_bf16 a[140:143], a[0:3], a[96:99], a[140:143]
s_waitcnt lgkmcnt(5)
ds_read_b64_tr_b16 a[76:77], v6 offset:40960
v_mfma_f32_16x16x32_bf16 v[184:187], a[104:107], a[32:35], v[184:187]
ds_read_b64_tr_b16 a[78:79], v6 offset:41984
v_mfma_f32_16x16x32_bf16 v[184:187], a[108:111], a[36:39], v[184:187]
ds_read_b64_tr_b16 a[80:81], v7 offset:32768
v_mfma_f32_16x16x32_bf16 v[192:195], a[108:111], a[44:47], v[192:195]
s_xor_b32 m0, s77, 65536
ds_read_b64_tr_b16 a[82:83], v7 offset:33792
v_mfma_f32_16x16x32_bf16 v[192:195], a[104:107], a[40:43], v[192:195]
s_xor_b32 s64, s71, 1572864
ds_read_b64_tr_b16 a[84:85], v7 offset:40960
v_mfma_f32_16x16x32_bf16 v[200:203], a[104:107], a[48:51], v[200:203]
buffer_load_dwordx4 v14, s[36:39], s64 offen lds
v_mfma_f32_16x16x32_bf16 v[200:203], a[108:111], a[52:55], v[200:203]
ds_read_b64_tr_b16 a[86:87], v7 offset:41984
v_mfma_f32_16x16x32_bf16 v[208:211], a[108:111], a[60:63], v[208:211]
s_xor_b32 m0, s77, 66560
ds_read_b64_tr_b16 a[88:89], v8 offset:32768
v_mfma_f32_16x16x32_bf16 v[208:211], a[104:107], a[56:59], v[208:211]
s_waitcnt lgkmcnt(7)
s_xor_b32 s64, s71, 1605632
ds_read_b64_tr_b16 a[90:91], v8 offset:33792
v_mfma_f32_16x16x32_bf16 v[212:215], a[112:115], a[56:59], v[212:215]
buffer_load_dwordx4 v14, s[36:39], s64 offen lds
v_mfma_f32_16x16x32_bf16 v[212:215], a[116:119], a[60:63], v[212:215]
ds_read_b64_tr_b16 a[92:93], v8 offset:40960
v_mfma_f32_16x16x32_bf16 v[204:207], a[116:119], a[52:55], v[204:207]
s_xor_b32 m0, s77, 67584
ds_read_b64_tr_b16 a[94:95], v8 offset:41984
v_mfma_f32_16x16x32_bf16 v[204:207], a[112:115], a[48:51], v[204:207]
s_xor_b32 s64, s71, 1638400
ds_read_b64_tr_b16 a[96:97], v9 offset:32768
v_mfma_f32_16x16x32_bf16 v[196:199], a[112:115], a[40:43], v[196:199]
buffer_load_dwordx4 v15, s[36:39], s64 offen lds
v_mfma_f32_16x16x32_bf16 v[196:199], a[116:119], a[44:47], v[196:199]
ds_read_b64_tr_b16 a[98:99], v9 offset:33792
v_mfma_f32_16x16x32_bf16 v[188:191], a[116:119], a[36:39], v[188:191]
s_xor_b32 m0, s77, 68608
ds_read_b64_tr_b16 a[100:101], v9 offset:40960
v_mfma_f32_16x16x32_bf16 v[188:191], a[112:115], a[32:35], v[188:191]
s_xor_b32 s64, s71, 1671168
ds_read_b64_tr_b16 a[102:103], v9 offset:41984
v_mfma_f32_16x16x32_bf16 v[216:219], a[72:75], a[32:35], v[216:219]
s_waitcnt lgkmcnt(7)
buffer_load_dwordx4 v15, s[36:39], s64 offen lds
v_mfma_f32_16x16x32_bf16 v[216:219], a[76:79], a[36:39], v[216:219]
global_load_dwordx4 a[148:151], v18, s[4:5] offset:512
v_mfma_f32_16x16x32_bf16 v[224:227], a[76:79], a[44:47], v[224:227]
ds_read_b64_tr_b16 a[104:105], v10 offset:32768
v_mfma_f32_16x16x32_bf16 v[224:227], a[72:75], a[40:43], v[224:227]
s_xor_b32 m0, s77, 81920
ds_read_b64_tr_b16 a[106:107], v10 offset:33792
v_mfma_f32_16x16x32_bf16 v[232:235], a[72:75], a[48:51], v[232:235]
s_xor_b32 s64, s71, 1572864
ds_read_b64_tr_b16 a[108:109], v10 offset:40960
v_mfma_f32_16x16x32_bf16 v[232:235], a[76:79], a[52:55], v[232:235]
buffer_load_dwordx4 v14, s[40:43], s64 offen lds
v_mfma_f32_16x16x32_bf16 v[240:243], a[76:79], a[60:63], v[240:243]
ds_read_b64_tr_b16 a[110:111], v10 offset:41984
v_mfma_f32_16x16x32_bf16 v[240:243], a[72:75], a[56:59], v[240:243]
s_xor_b32 m0, s77, 82944
ds_read_b64_tr_b16 a[112:113], v11 offset:32768
v_mfma_f32_16x16x32_bf16 v[244:247], a[80:83], a[56:59], v[244:247]
s_xor_b32 s64, s71, 1605632
ds_read_b64_tr_b16 a[114:115], v11 offset:33792
v_mfma_f32_16x16x32_bf16 v[244:247], a[84:87], a[60:63], v[244:247]
buffer_load_dwordx4 v14, s[40:43], s64 offen lds
v_mfma_f32_16x16x32_bf16 v[236:239], a[84:87], a[52:55], v[236:239]
ds_read_b64_tr_b16 a[116:117], v11 offset:40960
v_mfma_f32_16x16x32_bf16 v[236:239], a[80:83], a[48:51], v[236:239]
s_xor_b32 m0, s77, 83968
ds_read_b64_tr_b16 a[118:119], v11 offset:41984
v_mfma_f32_16x16x32_bf16 v[228:231], a[80:83], a[40:43], v[228:231]
s_xor_b32 s64, s71, 1638400
ds_read_b64_tr_b16 a[72:73], v4 offset:49152
v_mfma_f32_16x16x32_bf16 v[228:231], a[84:87], a[44:47], v[228:231]
buffer_load_dwordx4 v15, s[40:43], s64 offen lds
v_mfma_f32_16x16x32_bf16 v[220:223], a[84:87], a[36:39], v[220:223]
ds_read_b64_tr_b16 a[74:75], v4 offset:50176
v_mfma_f32_16x16x32_bf16 v[220:223], a[80:83], a[32:35], v[220:223]
s_waitcnt lgkmcnt(7)
s_xor_b32 m0, s77, 84992
ds_read_b64_tr_b16 a[76:77], v4 offset:57344
v_mfma_f32_16x16x32_bf16 v[152:155], a[88:91], a[32:35], v[152:155]
s_xor_b32 s64, s71, 1671168
ds_read_b64_tr_b16 a[78:79], v4 offset:58368
v_mfma_f32_16x16x32_bf16 v[152:155], a[92:95], a[36:39], v[152:155]
buffer_load_dwordx4 v15, s[40:43], s64 offen lds
v_mfma_f32_16x16x32_bf16 v[160:163], a[92:95], a[44:47], v[160:163]
ds_read_b64_tr_b16 a[80:81], v5 offset:49152
v_mfma_f32_16x16x32_bf16 v[160:163], a[88:91], a[40:43], v[160:163]
ds_read_b64_tr_b16 a[82:83], v5 offset:50176
v_mfma_f32_16x16x32_bf16 v[168:171], a[88:91], a[48:51], v[168:171]
ds_read_b64_tr_b16 a[84:85], v5 offset:57344
v_mfma_f32_16x16x32_bf16 v[168:171], a[92:95], a[52:55], v[168:171]
ds_read_b64_tr_b16 a[86:87], v5 offset:58368
v_mfma_f32_16x16x32_bf16 v[176:179], a[92:95], a[60:63], v[176:179]
s_xor_b32 m0, s84, 32768
global_load_dwordx4 a[164:167], v19, s[22:23] offset:512
v_mfma_f32_16x16x32_bf16 v[176:179], a[88:91], a[56:59], v[176:179]
s_xor_b32 s64, s70, 384
ds_read_b64_tr_b16 a[88:89], v6 offset:49152
v_mfma_f32_16x16x32_bf16 v[180:183], a[96:99], a[56:59], v[180:183]
buffer_load_dwordx4 v12, s[32:35], s64 offen lds
v_mfma_f32_16x16x32_bf16 v[180:183], a[100:103], a[60:63], v[180:183]
ds_read_b64_tr_b16 a[90:91], v6 offset:50176
v_mfma_f32_16x16x32_bf16 v[172:175], a[100:103], a[52:55], v[172:175]
ds_read_b64_tr_b16 a[92:93], v6 offset:57344
v_mfma_f32_16x16x32_bf16 v[172:175], a[96:99], a[48:51], v[172:175]
ds_read_b64_tr_b16 a[94:95], v6 offset:58368
v_mfma_f32_16x16x32_bf16 v[164:167], a[96:99], a[40:43], v[164:167]
v_mfma_f32_16x16x32_bf16 v[164:167], a[100:103], a[44:47], v[164:167]
s_xor_b32 m0, s84, 33792
v_mfma_f32_16x16x32_bf16 v[156:159], a[100:103], a[36:39], v[156:159]
s_xor_b32 s64, s70, 8576
v_mfma_f32_16x16x32_bf16 v[156:159], a[96:99], a[32:35], v[156:159]
buffer_load_dwordx4 v13, s[32:35], s64 offen lds
v_mfma_f32_16x16x32_bf16 v[24:27], a[104:107], a[32:35], v[24:27]
s_waitcnt lgkmcnt(4)
ds_read_b64_tr_b16 a[96:97], v7 offset:49152
v_mfma_f32_16x16x32_bf16 v[24:27], a[108:111], a[36:39], v[24:27]
ds_read_b64_tr_b16 a[98:99], v7 offset:50176
v_mfma_f32_16x16x32_bf16 v[40:43], a[108:111], a[44:47], v[40:43]
ds_read_b64_tr_b16 a[100:101], v7 offset:57344
v_mfma_f32_16x16x32_bf16 v[40:43], a[104:107], a[40:43], v[40:43]
ds_read_b64_tr_b16 a[102:103], v7 offset:58368
v_mfma_f32_16x16x32_bf16 v[56:59], a[104:107], a[48:51], v[56:59]
s_xor_b32 m0, s84, 34816
v_mfma_f32_16x16x32_bf16 v[56:59], a[108:111], a[52:55], v[56:59]
s_xor_b32 s64, s70, 16768
v_mfma_f32_16x16x32_bf16 v[72:75], a[108:111], a[60:63], v[72:75]
s_waitcnt vmcnt(12)
buffer_load_dwordx4 v12, s[32:35], s64 offen lds
v_mfma_f32_16x16x32_bf16 v[72:75], a[104:107], a[56:59], v[72:75]
ds_read_b64_tr_b16 a[104:105], v8 offset:49152
v_mfma_f32_16x16x32_bf16 v[136:139], a[112:115], a[56:59], v[136:139]
ds_read_b64_tr_b16 a[106:107], v8 offset:50176
v_mfma_f32_16x16x32_bf16 v[136:139], a[116:119], a[60:63], v[136:139]
ds_read_b64_tr_b16 a[108:109], v8 offset:57344
v_add_u32 v4, 0x8000, v4
v_mfma_f32_16x16x32_bf16 v[120:123], a[116:119], a[52:55], v[120:123]
ds_read_b64_tr_b16 a[110:111], v8 offset:58368
v_mfma_f32_16x16x32_bf16 v[120:123], a[112:115], a[48:51], v[120:123]
s_xor_b32 m0, s84, 35840
ds_read_b128 a[0:3], v2 offset:0
v_mfma_f32_16x16x32_bf16 v[104:107], a[112:115], a[40:43], v[104:107]
s_xor_b32 s64, s70, 24960
global_load_dwordx4 a[152:155], v18, s[4:5] offset:1024
v_mfma_f32_16x16x32_bf16 v[104:107], a[116:119], a[44:47], v[104:107]
s_branch L_po2
L_pg2:
s_branch L_tr0
L_po2:
buffer_load_dwordx4 v13, s[32:35], s64 offen lds
v_mfma_f32_16x16x32_bf16 v[88:91], a[116:119], a[36:39], v[88:91]
ds_read_b128 a[4:7], v3 offset:0
v_mfma_f32_16x16x32_bf16 v[88:91], a[112:115], a[32:35], v[88:91]
ds_read_b128 a[8:11], v2 offset:2048
v_mfma_f32_16x16x32_bf16 v[28:31], a[32:35], a[72:75], v[28:31]
ds_read_b128 a[12:15], v3 offset:2048
v_mfma_f32_16x16x32_bf16 v[28:31], a[36:39], a[76:79], v[28:31]
ds_read_b128 a[16:19], v2 offset:4096
v_add_u32 v5, 0x8000, v5
v_mfma_f32_16x16x32_bf16 v[44:47], a[44:47], a[76:79], v[44:47]
s_xor_b32 m0, s84, 36864
ds_read_b128 a[20:23], v3 offset:4096
v_mfma_f32_16x16x32_bf16 v[44:47], a[40:43], a[72:75], v[44:47]
s_xor_b32 s64, s70, 33152
ds_read_b128 a[24:27], v2 offset:6144
v_mfma_f32_16x16x32_bf16 v[60:63], a[48:51], a[72:75], v[60:63]
buffer_load_dwordx4 v12, s[32:35], s64 offen lds
v_mfma_f32_16x16x32_bf16 v[60:63], a[52:55], a[76:79], v[60:63]
ds_read_b128 a[28:31], v3 offset:6144
v_mfma_f32_16x16x32_bf16 v[76:79], a[60:63], a[76:79], v[76:79]
ds_read_b64_tr_b16 a[112:113], v9 offset:49152
v_mfma_f32_16x16x32_bf16 v[76:79], a[56:59], a[72:75], v[76:79]
ds_read_b64_tr_b16 a[114:115], v9 offset:50176
v_mfma_f32_16x16x32_bf16 v[140:143], a[56:59], a[80:83], v[140:143]
ds_read_b64_tr_b16 a[116:117], v9 offset:57344
v_mfma_f32_16x16x32_bf16 v[140:143], a[60:63], a[84:87], v[140:143]
s_xor_b32 m0, s84, 37888
ds_read_b64_tr_b16 a[118:119], v9 offset:58368
v_add_u32 v6, 0x8000, v6
v_mfma_f32_16x16x32_bf16 v[124:127], a[52:55], a[84:87], v[124:127]
s_xor_b32 s64, s70, 41344
ds_read_b64_tr_b16 a[72:73], v10 offset:49152
v_mfma_f32_16x16x32_bf16 v[124:127], a[48:51], a[80:83], v[124:127]
buffer_load_dwordx4 v13, s[32:35], s64 offen lds
v_mfma_f32_16x16x32_bf16 v[108:111], a[40:43], a[80:83], v[108:111]
ds_read_b64_tr_b16 a[74:75], v10 offset:50176
v_mfma_f32_16x16x32_bf16 v[108:111], a[44:47], a[84:87], v[108:111]
ds_read_b64_tr_b16 a[76:77], v10 offset:57344
v_mfma_f32_16x16x32_bf16 v[92:95], a[36:39], a[84:87], v[92:95]
ds_read_b64_tr_b16 a[78:79], v10 offset:58368
v_mfma_f32_16x16x32_bf16 v[92:95], a[32:35], a[80:83], v[92:95]
s_waitcnt lgkmcnt(8)
ds_read_b64_tr_b16 a[80:81], v11 offset:49152
v_mfma_f32_16x16x32_bf16 v[32:35], a[32:35], a[88:91], v[32:35]
s_xor_b32 m0, s84, 38912
ds_read_b64_tr_b16 a[82:83], v11 offset:50176
v_mfma_f32_16x16x32_bf16 v[32:35], a[36:39], a[92:95], v[32:35]
s_xor_b32 s64, s70, 49536
ds_read_b64_tr_b16 a[84:85], v11 offset:57344
v_add_u32 v7, 0x8000, v7
v_mfma_f32_16x16x32_bf16 v[48:51], a[44:47], a[92:95], v[48:51]
buffer_load_dwordx4 v12, s[32:35], s64 offen lds
v_mfma_f32_16x16x32_bf16 v[48:51], a[40:43], a[88:91], v[48:51]
global_load_dwordx4 a[168:171], v19, s[22:23] offset:1024
v_mfma_f32_16x16x32_bf16 v[64:67], a[48:51], a[88:91], v[64:67]
ds_read_b64_tr_b16 a[86:87], v11 offset:58368
v_mfma_f32_16x16x32_bf16 v[64:67], a[52:55], a[92:95], v[64:67]
v_mfma_f32_16x16x32_bf16 v[80:83], a[60:63], a[92:95], v[80:83]
v_mfma_f32_16x16x32_bf16 v[80:83], a[56:59], a[88:91], v[80:83]
s_xor_b32 m0, s84, 39936
v_mfma_f32_16x16x32_bf16 v[144:147], a[56:59], a[96:99], v[144:147]
s_xor_b32 s64, s70, 57728
v_mfma_f32_16x16x32_bf16 v[144:147], a[60:63], a[100:103], v[144:147]
buffer_load_dwordx4 v13, s[32:35], s64 offen lds
v_mfma_f32_16x16x32_bf16 v[128:131], a[52:55], a[100:103], v[128:131]
v_add_u32 v8, 0x8000, v8
v_mfma_f32_16x16x32_bf16 v[128:131], a[48:51], a[96:99], v[128:131]
v_mfma_f32_16x16x32_bf16 v[112:115], a[40:43], a[96:99], v[112:115]
v_mfma_f32_16x16x32_bf16 v[112:115], a[44:47], a[100:103], v[112:115]
v_mfma_f32_16x16x32_bf16 v[96:99], a[36:39], a[100:103], v[96:99]
v_add_u32 v9, 0x8000, v9
v_add_u32 v10, 0x8000, v10
v_mfma_f32_16x16x32_bf16 v[96:99], a[32:35], a[96:99], v[96:99]
v_add_u32 v11, 0x8000, v11
v_mfma_f32_16x16x32_bf16 v[36:39], a[32:35], a[104:107], v[36:39]
v_mfma_f32_16x16x32_bf16 v[36:39], a[36:39], a[108:111], v[36:39]
v_mfma_f32_16x16x32_bf16 v[52:55], a[44:47], a[108:111], v[52:55]
s_cmp_eq_u32 s30, 0
s_cbranch_scc1 L_pg6
s_cmp_eq_u32 s30, 1
s_cbranch_scc1 L_pg7
s_cmp_eq_u32 s30, 2
s_cbranch_scc1 L_pg8
s_branch L_pg9
L_tr1:
s_waitcnt lgkmcnt(0)
s_barrier
v_mfma_f32_16x16x32_bf16 v[52:55], a[40:43], a[104:107], v[52:55]
s_xor_b32 m0, s77, 98304
ds_read_b64_tr_b16 a[88:89], v4 offset:32768
v_mfma_f32_16x16x32_bf16 v[68:71], a[48:51], a[104:107], v[68:71]
s_xor_b32 s64, s71, 2097152
ds_read_b64_tr_b16 a[90:91], v4 offset:33792
v_mfma_f32_16x16x32_bf16 v[68:71], a[52:55], a[108:111], v[68:71]
buffer_load_dwordx4 v14, s[36:39], s64 offen lds
v_mfma_f32_16x16x32_bf16 v[84:87], a[60:63], a[108:111], v[84:87]
ds_read_b64_tr_b16 a[92:93], v4 offset:40960
v_mfma_f32_16x16x32_bf16 v[84:87], a[56:59], a[104:107], v[84:87]
ds_read_b64_tr_b16 a[94:95], v4 offset:41984
v_mfma_f32_16x16x32_bf16 v[148:151], a[56:59], a[112:115], v[148:151]
global_load_dwordx4 a[156:159], v18, s[4:5] offset:1536
v_mfma_f32_16x16x32_bf16 v[148:151], a[60:63], a[116:119], v[148:151]
ds_read_b64_tr_b16 a[96:97], v5 offset:32768
v_mfma_f32_16x16x32_bf16 v[132:135], a[52:55], a[116:119], v[132:135]
ds_read_b64_tr_b16 a[98:99], v5 offset:33792
v_mfma_f32_16x16x32_bf16 v[132:135], a[48:51], a[112:115], v[132:135]
s_xor_b32 m0, s77, 99328
ds_read_b64_tr_b16 a[100:101], v5 offset:40960
v_mfma_f32_16x16x32_bf16 v[116:119], a[40:43], a[112:115], v[116:119]
s_xor_b32 s64, s71, 2129920
ds_read_b64_tr_b16 a[102:103], v5 offset:41984
v_mfma_f32_16x16x32_bf16 v[116:119], a[44:47], a[116:119], v[116:119]
buffer_load_dwordx4 v14, s[36:39], s64 offen lds
v_mfma_f32_16x16x32_bf16 v[100:103], a[36:39], a[116:119], v[100:103]
ds_read_b64_tr_b16 a[104:105], v6 offset:32768
v_mfma_f32_16x16x32_bf16 v[100:103], a[32:35], a[112:115], v[100:103]
ds_read_b64_tr_b16 a[106:107], v6 offset:33792
v_mfma_f32_16x16x32_bf16 v[248:251], a[32:35], a[72:75], v[248:251]
ds_read_b64_tr_b16 a[108:109], v6 offset:40960
v_mfma_f32_16x16x32_bf16 v[248:251], a[36:39], a[76:79], v[248:251]
ds_read_b64_tr_b16 a[110:111], v6 offset:41984
v_mfma_f32_16x16x32_bf16 v[252:255], a[44:47], a[76:79], v[252:255]
ds_read_b64_tr_b16 a[112:113], v7 offset:32768
v_mfma_f32_16x16x32_bf16 v[252:255], a[40:43], a[72:75], v[252:255]
s_xor_b32 m0, s77, 100352
ds_read_b64_tr_b16 a[114:115], v7 offset:33792
v_mfma_f32_16x16x32_bf16 a[120:123], a[48:51], a[72:75], a[120:123]
s_xor_b32 s64, s71, 2162688
ds_read_b64_tr_b16 a[116:117], v7 offset:40960
v_mfma_f32_16x16x32_bf16 a[120:123], a[52:55], a[76:79], a[120:123]
buffer_load_dwordx4 v15, s[36:39], s64 offen lds
v_mfma_f32_16x16x32_bf16 a[124:127], a[60:63], a[76:79], a[124:127]
ds_read_b64_tr_b16 a[118:119], v7 offset:41984
v_mfma_f32_16x16x32_bf16 a[124:127], a[56:59], a[72:75], a[124:127]
ds_read_b64_tr_b16 a[72:73], v8 offset:32768
v_mfma_f32_16x16x32_bf16 a[128:131], a[56:59], a[80:83], a[128:131]
ds_read_b64_tr_b16 a[74:75], v8 offset:33792
v_mfma_f32_16x16x32_bf16 a[128:131], a[60:63], a[84:87], a[128:131]
ds_read_b64_tr_b16 a[76:77], v8 offset:40960
v_mfma_f32_16x16x32_bf16 a[132:135], a[52:55], a[84:87], a[132:135]
ds_read_b64_tr_b16 a[78:79], v8 offset:41984
v_mfma_f32_16x16x32_bf16 a[132:135], a[48:51], a[80:83], a[132:135]
s_xor_b32 m0, s77, 101376
v_mfma_f32_16x16x32_bf16 a[136:139], a[40:43], a[80:83], a[136:139]
s_xor_b32 s64, s71, 2195456
v_mfma_f32_16x16x32_bf16 a[136:139], a[44:47], a[84:87], a[136:139]
buffer_load_dwordx4 v15, s[36:39], s64 offen lds
v_mfma_f32_16x16x32_bf16 a[140:143], a[36:39], a[84:87], a[140:143]
global_load_dwordx4 a[172:175], v19, s[22:23] offset:1536
v_mfma_f32_16x16x32_bf16 a[140:143], a[32:35], a[80:83], a[140:143]
s_waitcnt lgkmcnt(5)
ds_read_b64_tr_b16 a[80:81], v9 offset:32768
v_mfma_f32_16x16x32_bf16 v[184:187], a[88:91], a[0:3], v[184:187]
ds_read_b64_tr_b16 a[82:83], v9 offset:33792
v_mfma_f32_16x16x32_bf16 v[184:187], a[92:95], a[4:7], v[184:187]
ds_read_b64_tr_b16 a[84:85], v9 offset:40960
v_mfma_f32_16x16x32_bf16 v[192:195], a[92:95], a[12:15], v[192:195]
ds_read_b64_tr_b16 a[86:87], v9 offset:41984
v_mfma_f32_16x16x32_bf16 v[192:195], a[88:91], a[8:11], v[192:195]
s_xor_b32 m0, s77, 114688
v_mfma_f32_16x16x32_bf16 v[200:203], a[88:91], a[16:19], v[200:203]
s_xor_b32 s64, s71, 2097152
v_mfma_f32_16x16x32_bf16 v[200:203], a[92:95], a[20:23], v[200:203]
buffer_load_dwordx4 v14, s[40:43], s64 offen lds
v_mfma_f32_16x16x32_bf16 v[208:211], a[92:95], a[28:31], v[208:211]
v_mfma_f32_16x16x32_bf16 v[208:211], a[88:91], a[24:27], v[208:211]
ds_read_b64_tr_b16 a[88:89], v10 offset:32768
v_mfma_f32_16x16x32_bf16 v[212:215], a[96:99], a[24:27], v[212:215]
ds_read_b64_tr_b16 a[90:91], v10 offset:33792
v_mfma_f32_16x16x32_bf16 v[212:215], a[100:103], a[28:31], v[212:215]
ds_read_b64_tr_b16 a[92:93], v10 offset:40960
v_mfma_f32_16x16x32_bf16 v[204:207], a[100:103], a[20:23], v[204:207]
ds_read_b64_tr_b16 a[94:95], v10 offset:41984
v_mfma_f32_16x16x32_bf16 v[204:207], a[96:99], a[16:19], v[204:207]
s_xor_b32 m0, s77, 115712
v_mfma_f32_16x16x32_bf16 v[196:199], a[96:99], a[8:11], v[196:199]
s_xor_b32 s64, s71, 2129920
v_mfma_f32_16x16x32_bf16 v[196:199], a[100:103], a[12:15], v[196:199]
buffer_load_dwordx4 v14, s[40:43], s64 offen lds
v_mfma_f32_16x16x32_bf16 v[188:191], a[100:103], a[4:7], v[188:191]
v_mfma_f32_16x16x32_bf16 v[188:191], a[96:99], a[0:3], v[188:191]
ds_read_b64_tr_b16 a[96:97], v11 offset:32768
v_mfma_f32_16x16x32_bf16 v[216:219], a[104:107], a[0:3], v[216:219]
ds_read_b64_tr_b16 a[98:99], v11 offset:33792
v_mfma_f32_16x16x32_bf16 v[216:219], a[108:111], a[4:7], v[216:219]
ds_read_b64_tr_b16 a[100:101], v11 offset:40960
v_mfma_f32_16x16x32_bf16 v[224:227], a[108:111], a[12:15], v[224:227]
ds_read_b64_tr_b16 a[102:103], v11 offset:41984
v_mfma_f32_16x16x32_bf16 v[224:227], a[104:107], a[8:11], v[224:227]
s_xor_b32 m0, s77, 116736
v_mfma_f32_16x16x32_bf16 v[232:235], a[104:107], a[16:19], v[232:235]
s_xor_b32 s64, s71, 2162688
buffer_store_dword v21, v20, s[44:47], s69 offen sc1
v_mfma_f32_16x16x32_bf16 v[232:235], a[108:111], a[20:23], v[232:235]
buffer_load_dwordx4 v15, s[40:43], s64 offen lds
v_mfma_f32_16x16x32_bf16 v[240:243], a[108:111], a[28:31], v[240:243]
v_mfma_f32_16x16x32_bf16 v[240:243], a[104:107], a[24:27], v[240:243]
ds_read_b64_tr_b16 a[104:105], v4 offset:49152
v_mfma_f32_16x16x32_bf16 v[244:247], a[112:115], a[24:27], v[244:247]
s_waitcnt lgkmcnt(5)
ds_read_b64_tr_b16 a[106:107], v4 offset:50176
v_mfma_f32_16x16x32_bf16 v[244:247], a[116:119], a[28:31], v[244:247]
ds_read_b64_tr_b16 a[108:109], v4 offset:57344
v_mfma_f32_16x16x32_bf16 v[236:239], a[116:119], a[20:23], v[236:239]
ds_read_b64_tr_b16 a[110:111], v4 offset:58368
v_mfma_f32_16x16x32_bf16 v[236:239], a[112:115], a[16:19], v[236:239]
s_xor_b32 m0, s77, 117760
v_mfma_f32_16x16x32_bf16 v[228:231], a[112:115], a[8:11], v[228:231]
s_xor_b32 s64, s71, 2195456
v_mfma_f32_16x16x32_bf16 v[228:231], a[116:119], a[12:15], v[228:231]
buffer_load_dwordx4 v15, s[40:43], s64 offen lds
v_mfma_f32_16x16x32_bf16 v[220:223], a[116:119], a[4:7], v[220:223]
v_mfma_f32_16x16x32_bf16 v[220:223], a[112:115], a[0:3], v[220:223]
ds_read_b64_tr_b16 a[112:113], v5 offset:49152
v_mfma_f32_16x16x32_bf16 v[152:155], a[72:75], a[0:3], v[152:155]
ds_read_b64_tr_b16 a[114:115], v5 offset:50176
v_mfma_f32_16x16x32_bf16 v[152:155], a[76:79], a[4:7], v[152:155]
ds_read_b64_tr_b16 a[116:117], v5 offset:57344
v_mfma_f32_16x16x32_bf16 v[160:163], a[76:79], a[12:15], v[160:163]
ds_read_b64_tr_b16 a[118:119], v5 offset:58368
v_mfma_f32_16x16x32_bf16 v[160:163], a[72:75], a[8:11], v[160:163]
v_mfma_f32_16x16x32_bf16 v[168:171], a[72:75], a[16:19], v[168:171]
v_mfma_f32_16x16x32_bf16 v[168:171], a[76:79], a[20:23], v[168:171]
v_mfma_f32_16x16x32_bf16 v[176:179], a[76:79], a[28:31], v[176:179]
s_xor_b32 m0, s84, 0
v_mfma_f32_16x16x32_bf16 v[176:179], a[72:75], a[24:27], v[176:179]
s_xor_b32 s64, s70, 512
ds_read_b64_tr_b16 a[72:73], v6 offset:49152
v_mfma_f32_16x16x32_bf16 v[180:183], a[80:83], a[24:27], v[180:183]
buffer_load_dwordx4 v12, s[32:35], s64 offen lds
v_mfma_f32_16x16x32_bf16 v[180:183], a[84:87], a[28:31], v[180:183]
ds_read_b64_tr_b16 a[74:75], v6 offset:50176
v_mfma_f32_16x16x32_bf16 v[172:175], a[84:87], a[20:23], v[172:175]
ds_read_b64_tr_b16 a[76:77], v6 offset:57344
v_mfma_f32_16x16x32_bf16 v[172:175], a[80:83], a[16:19], v[172:175]
ds_read_b64_tr_b16 a[78:79], v6 offset:58368
v_mfma_f32_16x16x32_bf16 v[164:167], a[80:83], a[8:11], v[164:167]
buffer_load_dword a252, v16, s[56:59], s81 offen
v_mfma_f32_16x16x32_bf16 v[164:167], a[84:87], a[12:15], v[164:167]
s_xor_b32 m0, s84, 1024
v_mfma_f32_16x16x32_bf16 v[156:159], a[84:87], a[4:7], v[156:159]
s_xor_b32 s64, s70, 8704
v_mfma_f32_16x16x32_bf16 v[156:159], a[80:83], a[0:3], v[156:159]
buffer_load_dwordx4 v13, s[32:35], s64 offen lds
v_mfma_f32_16x16x32_bf16 v[24:27], a[88:91], a[0:3], v[24:27]
ds_read_b64_tr_b16 a[80:81], v7 offset:49152
v_mfma_f32_16x16x32_bf16 v[24:27], a[92:95], a[4:7], v[24:27]
ds_read_b64_tr_b16 a[82:83], v7 offset:50176
v_mfma_f32_16x16x32_bf16 v[40:43], a[92:95], a[12:15], v[40:43]
ds_read_b64_tr_b16 a[84:85], v7 offset:57344
v_mfma_f32_16x16x32_bf16 v[40:43], a[88:91], a[8:11], v[40:43]
ds_read_b64_tr_b16 a[86:87], v7 offset:58368
v_mfma_f32_16x16x32_bf16 v[56:59], a[88:91], a[16:19], v[56:59]
s_xor_b32 m0, s84, 2048
v_mfma_f32_16x16x32_bf16 v[56:59], a[92:95], a[20:23], v[56:59]
s_xor_b32 s64, s70, 16896
v_mfma_f32_16x16x32_bf16 v[72:75], a[92:95], a[28:31], v[72:75]
s_waitcnt vmcnt(14)
buffer_load_dwordx4 v12, s[32:35], s64 offen lds
v_mfma_f32_16x16x32_bf16 v[72:75], a[88:91], a[24:27], v[72:75]
s_waitcnt lgkmcnt(4)
ds_read_b64_tr_b16 a[88:89], v8 offset:49152
v_mfma_f32_16x16x32_bf16 v[136:139], a[96:99], a[24:27], v[136:139]
ds_read_b64_tr_b16 a[90:91], v8 offset:50176
v_mfma_f32_16x16x32_bf16 v[136:139], a[100:103], a[28:31], v[136:139]
ds_read_b64_tr_b16 a[92:93], v8 offset:57344
v_subrev_u32 v4, 0x8000, v4
v_mfma_f32_16x16x32_bf16 v[120:123], a[100:103], a[20:23], v[120:123]
ds_read_b64_tr_b16 a[94:95], v8 offset:58368
v_mfma_f32_16x16x32_bf16 v[120:123], a[96:99], a[16:19], v[120:123]
s_xor_b32 m0, s84, 3072
ds_read_b128 a[32:35], v2 offset:32768
v_mfma_f32_16x16x32_bf16 v[104:107], a[96:99], a[8:11], v[104:107]
s_xor_b32 s64, s70, 25088
ds_read_b128 a[36:39], v3 offset:32768
v_mfma_f32_16x16x32_bf16 v[104:107], a[100:103], a[12:15], v[104:107]
buffer_load_dwordx4 v13, s[32:35], s64 offen lds
v_mfma_f32_16x16x32_bf16 v[88:91], a[100:103], a[4:7], v[88:91]
ds_read_b128 a[40:43], v2 offset:34816
v_mfma_f32_16x16x32_bf16 v[88:91], a[96:99], a[0:3], v[88:91]
ds_read_b128 a[44:47], v3 offset:34816
v_mfma_f32_16x16x32_bf16 v[28:31], a[0:3], a[104:107], v[28:31]
ds_read_b128 a[48:51], v2 offset:36864
v_mfma_f32_16x16x32_bf16 v[28:31], a[4:7], a[108:111], v[28:31]
ds_read_b128 a[52:55], v3 offset:36864
v_subrev_u32 v5, 0x8000, v5
v_mfma_f32_16x16x32_bf16 v[44:47], a[12:15], a[108:111], v[44:47]
s_xor_b32 m0, s84, 4096
ds_read_b128 a[56:59], v2 offset:38912
v_mfma_f32_16x16x32_bf16 v[44:47], a[8:11], a[104:107], v[44:47]
s_xor_b32 s64, s70, 33280
ds_read_b128 a[60:63], v3 offset:38912
v_mfma_f32_16x16x32_bf16 v[60:63], a[16:19], a[104:107], v[60:63]
buffer_load_dwordx4 v12, s[32:35], s64 offen lds
v_mfma_f32_16x16x32_bf16 v[60:63], a[20:23], a[108:111], v[60:63]
ds_read_b64_tr_b16 a[96:97], v9 offset:49152
v_mfma_f32_16x16x32_bf16 v[76:79], a[28:31], a[108:111], v[76:79]
ds_read_b64_tr_b16 a[98:99], v9 offset:50176
v_mfma_f32_16x16x32_bf16 v[76:79], a[24:27], a[104:107], v[76:79]
ds_read_b64_tr_b16 a[100:101], v9 offset:57344
v_mfma_f32_16x16x32_bf16 v[140:143], a[24:27], a[112:115], v[140:143]
ds_read_b64_tr_b16 a[102:103], v9 offset:58368
v_mfma_f32_16x16x32_bf16 v[140:143], a[28:31], a[116:119], v[140:143]
s_xor_b32 m0, s84, 5120
ds_read_b64_tr_b16 a[104:105], v10 offset:49152
v_subrev_u32 v6, 0x8000, v6
v_mfma_f32_16x16x32_bf16 v[124:127], a[20:23], a[116:119], v[124:127]
s_xor_b32 s64, s70, 41472
ds_read_b64_tr_b16 a[106:107], v10 offset:50176
v_mfma_f32_16x16x32_bf16 v[124:127], a[16:19], a[112:115], v[124:127]
buffer_load_dwordx4 v13, s[32:35], s64 offen lds
v_mfma_f32_16x16x32_bf16 v[108:111], a[8:11], a[112:115], v[108:111]
ds_read_b64_tr_b16 a[108:109], v10 offset:57344
v_mfma_f32_16x16x32_bf16 v[108:111], a[12:15], a[116:119], v[108:111]
ds_read_b64_tr_b16 a[110:111], v10 offset:58368
v_mfma_f32_16x16x32_bf16 v[92:95], a[4:7], a[116:119], v[92:95]
v_mfma_f32_16x16x32_bf16 v[92:95], a[0:3], a[112:115], v[92:95]
ds_read_b64_tr_b16 a[112:113], v11 offset:49152
v_mfma_f32_16x16x32_bf16 v[32:35], a[0:3], a[72:75], v[32:35]
s_xor_b32 m0, s84, 6144
ds_read_b64_tr_b16 a[114:115], v11 offset:50176
v_mfma_f32_16x16x32_bf16 v[32:35], a[4:7], a[76:79], v[32:35]
s_xor_b32 s64, s70, 49664
ds_read_b64_tr_b16 a[116:117], v11 offset:57344
v_subrev_u32 v7, 0x8000, v7
v_mfma_f32_16x16x32_bf16 v[48:51], a[12:15], a[76:79], v[48:51]
buffer_load_dwordx4 v12, s[32:35], s64 offen lds
v_mfma_f32_16x16x32_bf16 v[48:51], a[8:11], a[72:75], v[48:51]
ds_read_b64_tr_b16 a[118:119], v11 offset:58368
v_mfma_f32_16x16x32_bf16 v[64:67], a[16:19], a[72:75], v[64:67]
buffer_load_dword a252, v1, s[60:63], s82 offen
v_mfma_f32_16x16x32_bf16 v[64:67], a[20:23], a[76:79], v[64:67]
v_mfma_f32_16x16x32_bf16 v[80:83], a[28:31], a[76:79], v[80:83]
v_mfma_f32_16x16x32_bf16 v[80:83], a[24:27], a[72:75], v[80:83]
s_waitcnt lgkmcnt(4)
s_xor_b32 m0, s84, 7168
v_mfma_f32_16x16x32_bf16 v[144:147], a[24:27], a[80:83], v[144:147]
s_xor_b32 s64, s70, 57856
v_mfma_f32_16x16x32_bf16 v[144:147], a[28:31], a[84:87], v[144:147]
buffer_load_dwordx4 v13, s[32:35], s64 offen lds
v_mfma_f32_16x16x32_bf16 v[128:131], a[20:23], a[84:87], v[128:131]
v_subrev_u32 v8, 0x8000, v8
v_mfma_f32_16x16x32_bf16 v[128:131], a[16:19], a[80:83], v[128:131]
v_mfma_f32_16x16x32_bf16 v[112:115], a[8:11], a[80:83], v[112:115]
v_mfma_f32_16x16x32_bf16 v[112:115], a[12:15], a[84:87], v[112:115]
v_mfma_f32_16x16x32_bf16 v[96:99], a[4:7], a[84:87], v[96:99]
v_subrev_u32 v9, 0x8000, v9
v_subrev_u32 v10, 0x8000, v10
v_mfma_f32_16x16x32_bf16 v[96:99], a[0:3], a[80:83], v[96:99]
v_subrev_u32 v11, 0x8000, v11
v_mfma_f32_16x16x32_bf16 v[36:39], a[0:3], a[88:91], v[36:39]
v_mfma_f32_16x16x32_bf16 v[36:39], a[4:7], a[92:95], v[36:39]
v_mfma_f32_16x16x32_bf16 v[52:55], a[12:15], a[92:95], v[52:55]
s_waitcnt lgkmcnt(0)
s_barrier
v_mfma_f32_16x16x32_bf16 v[52:55], a[8:11], a[88:91], v[52:55]
s_xor_b32 m0, s77, 131072
ds_read_b64_tr_b16 a[72:73], v4 offset:0
v_mfma_f32_16x16x32_bf16 v[68:71], a[16:19], a[88:91], v[68:71]
s_xor_b32 s64, s71, 2621440
ds_read_b64_tr_b16 a[74:75], v4 offset:1024
v_mfma_f32_16x16x32_bf16 v[68:71], a[20:23], a[92:95], v[68:71]
buffer_load_dwordx4 v14, s[36:39], s64 offen lds
v_mfma_f32_16x16x32_bf16 v[84:87], a[28:31], a[92:95], v[84:87]
ds_read_b64_tr_b16 a[76:77], v4 offset:8192
v_mfma_f32_16x16x32_bf16 v[84:87], a[24:27], a[88:91], v[84:87]
ds_read_b64_tr_b16 a[78:79], v4 offset:9216
v_mfma_f32_16x16x32_bf16 v[148:151], a[24:27], a[96:99], v[148:151]
ds_read_b64_tr_b16 a[80:81], v5 offset:0
v_mfma_f32_16x16x32_bf16 v[148:151], a[28:31], a[100:103], v[148:151]
ds_read_b64_tr_b16 a[82:83], v5 offset:1024
v_mfma_f32_16x16x32_bf16 v[132:135], a[20:23], a[100:103], v[132:135]
ds_read_b64_tr_b16 a[84:85], v5 offset:8192
v_mfma_f32_16x16x32_bf16 v[132:135], a[16:19], a[96:99], v[132:135]
s_xor_b32 m0, s77, 132096
ds_read_b64_tr_b16 a[86:87], v5 offset:9216
v_mfma_f32_16x16x32_bf16 v[116:119], a[8:11], a[96:99], v[116:119]
s_xor_b32 s64, s71, 2654208
ds_read_b64_tr_b16 a[88:89], v6 offset:0
v_mfma_f32_16x16x32_bf16 v[116:119], a[12:15], a[100:103], v[116:119]
buffer_load_dwordx4 v14, s[36:39], s64 offen lds
v_mfma_f32_16x16x32_bf16 v[100:103], a[4:7], a[100:103], v[100:103]
ds_read_b64_tr_b16 a[90:91], v6 offset:1024
v_mfma_f32_16x16x32_bf16 v[100:103], a[0:3], a[96:99], v[100:103]
ds_read_b64_tr_b16 a[92:93], v6 offset:8192
v_mfma_f32_16x16x32_bf16 v[248:251], a[0:3], a[104:107], v[248:251]
ds_read_b64_tr_b16 a[94:95], v6 offset:9216
v_mfma_f32_16x16x32_bf16 v[248:251], a[4:7], a[108:111], v[248:251]
ds_read_b64_tr_b16 a[96:97], v7 offset:0
v_mfma_f32_16x16x32_bf16 v[252:255], a[12:15], a[108:111], v[252:255]
ds_read_b64_tr_b16 a[98:99], v7 offset:1024
v_mfma_f32_16x16x32_bf16 v[252:255], a[8:11], a[104:107], v[252:255]
s_xor_b32 m0, s77, 133120
ds_read_b64_tr_b16 a[100:101], v7 offset:8192
v_mfma_f32_16x16x32_bf16 a[120:123], a[16:19], a[104:107], a[120:123]
s_xor_b32 s64, s71, 2686976
ds_read_b64_tr_b16 a[102:103], v7 offset:9216
v_mfma_f32_16x16x32_bf16 a[120:123], a[20:23], a[108:111], a[120:123]
buffer_load_dwordx4 v15, s[36:39], s64 offen lds
v_mfma_f32_16x16x32_bf16 a[124:127], a[28:31], a[108:111], a[124:127]
v_mfma_f32_16x16x32_bf16 a[124:127], a[24:27], a[104:107], a[124:127]
ds_read_b64_tr_b16 a[104:105], v8 offset:0
v_mfma_f32_16x16x32_bf16 a[128:131], a[24:27], a[112:115], a[128:131]
ds_read_b64_tr_b16 a[106:107], v8 offset:1024
v_mfma_f32_16x16x32_bf16 a[128:131], a[28:31], a[116:119], a[128:131]
ds_read_b64_tr_b16 a[108:109], v8 offset:8192
v_mfma_f32_16x16x32_bf16 a[132:135], a[20:23], a[116:119], a[132:135]
ds_read_b64_tr_b16 a[110:111], v8 offset:9216
v_mfma_f32_16x16x32_bf16 a[132:135], a[16:19], a[112:115], a[132:135]
s_xor_b32 m0, s77, 134144
s_add_u32 s81, s81, 1048576
v_mfma_f32_16x16x32_bf16 a[136:139], a[8:11], a[112:115], a[136:139]
s_xor_b32 s64, s71, 2719744
buffer_load_dword a252, v16, s[56:59], s81 offen
v_mfma_f32_16x16x32_bf16 a[136:139], a[12:15], a[116:119], a[136:139]
buffer_load_dwordx4 v15, s[36:39], s64 offen lds
v_mfma_f32_16x16x32_bf16 a[140:143], a[4:7], a[116:119], a[140:143]
v_mfma_f32_16x16x32_bf16 a[140:143], a[0:3], a[112:115], a[140:143]
s_waitcnt lgkmcnt(4)
ds_read_b64_tr_b16 a[112:113], v9 offset:0
v_mfma_f32_16x16x32_bf16 v[184:187], a[72:75], a[32:35], v[184:187]
ds_read_b64_tr_b16 a[114:115], v9 offset:1024
v_mov_b32 v17, 0
v_mfma_f32_16x16x32_bf16 v[184:187], a[76:79], a[36:39], v[184:187]
ds_read_b64_tr_b16 a[116:117], v9 offset:8192
v_accvgpr_read_b32 v19, a144
v_mfma_f32_16x16x32_bf16 v[192:195], a[76:79], a[44:47], v[192:195]
ds_read_b64_tr_b16 a[118:119], v9 offset:9216
v_accvgpr_read_b32 v21, a160
v_mfma_f32_16x16x32_bf16 v[192:195], a[72:75], a[40:43], v[192:195]
s_xor_b32 m0, s77, 147456
v_lshlrev_b32 v18, 16, v19
v_and_b32 v19, 0xffff0000, v19
v_mfma_f32_16x16x32_bf16 v[200:203], a[72:75], a[48:51], v[200:203]
s_xor_b32 s64, s71, 2621440
v_lshlrev_b32 v20, 16, v21
v_and_b32 v21, 0xffff0000, v21
v_mfma_f32_16x16x32_bf16 v[200:203], a[76:79], a[52:55], v[200:203]
buffer_load_dwordx4 v14, s[40:43], s64 offen lds
v_mfma_f32_16x16x32_bf16 v[208:211], a[76:79], a[60:63], v[208:211]
v_mul_f32 v18, v18, v20
v_mul_f32 v19, v19, v21
v_mfma_f32_16x16x32_bf16 v[208:211], a[72:75], a[56:59], v[208:211]
ds_read_b64_tr_b16 a[72:73], v10 offset:0
v_cvt_pk_bf16_f32 v18, v18, v19
v_mfma_f32_16x16x32_bf16 v[212:215], a[80:83], a[56:59], v[212:215]
ds_read_b64_tr_b16 a[74:75], v10 offset:1024
v_lshlrev_b32 v19, 16, v18
v_mfma_f32_16x16x32_bf16 v[212:215], a[84:87], a[60:63], v[212:215]
ds_read_b64_tr_b16 a[76:77], v10 offset:8192
v_and_b32 v18, 0xffff0000, v18
v_mfma_f32_16x16x32_bf16 v[204:207], a[84:87], a[52:55], v[204:207]
ds_read_b64_tr_b16 a[78:79], v10 offset:9216
v_add_f32 v17, v17, v19
v_mfma_f32_16x16x32_bf16 v[204:207], a[80:83], a[48:51], v[204:207]
s_xor_b32 m0, s77, 148480
v_add_f32 v17, v17, v18
v_accvgpr_read_b32 v19, a145
v_mfma_f32_16x16x32_bf16 v[196:199], a[80:83], a[40:43], v[196:199]
s_xor_b32 s64, s71, 2654208
v_accvgpr_read_b32 v21, a161
v_lshlrev_b32 v18, 16, v19
v_mfma_f32_16x16x32_bf16 v[196:199], a[84:87], a[44:47], v[196:199]
buffer_load_dwordx4 v14, s[40:43], s64 offen lds
v_mfma_f32_16x16x32_bf16 v[188:191], a[84:87], a[36:39], v[188:191]
v_and_b32 v19, 0xffff0000, v19
v_lshlrev_b32 v20, 16, v21
v_mfma_f32_16x16x32_bf16 v[188:191], a[80:83], a[32:35], v[188:191]
ds_read_b64_tr_b16 a[80:81], v11 offset:0
v_and_b32 v21, 0xffff0000, v21
v_mfma_f32_16x16x32_bf16 v[216:219], a[88:91], a[32:35], v[216:219]
ds_read_b64_tr_b16 a[82:83], v11 offset:1024
v_mul_f32 v18, v18, v20
v_mfma_f32_16x16x32_bf16 v[216:219], a[92:95], a[36:39], v[216:219]
ds_read_b64_tr_b16 a[84:85], v11 offset:8192
v_mul_f32 v19, v19, v21
v_mfma_f32_16x16x32_bf16 v[224:227], a[92:95], a[44:47], v[224:227]
ds_read_b64_tr_b16 a[86:87], v11 offset:9216
v_cvt_pk_bf16_f32 v18, v18, v19
v_mfma_f32_16x16x32_bf16 v[224:227], a[88:91], a[40:43], v[224:227]
s_xor_b32 m0, s77, 149504
v_lshlrev_b32 v19, 16, v18
v_and_b32 v18, 0xffff0000, v18
v_mfma_f32_16x16x32_bf16 v[232:235], a[88:91], a[48:51], v[232:235]
s_xor_b32 s64, s71, 2686976
v_add_f32 v17, v17, v19
v_add_f32 v17, v17, v18
v_mfma_f32_16x16x32_bf16 v[232:235], a[92:95], a[52:55], v[232:235]
buffer_load_dwordx4 v15, s[40:43], s64 offen lds
v_mfma_f32_16x16x32_bf16 v[240:243], a[92:95], a[60:63], v[240:243]
v_accvgpr_read_b32 v19, a146
v_accvgpr_read_b32 v21, a162
v_mfma_f32_16x16x32_bf16 v[240:243], a[88:91], a[56:59], v[240:243]
ds_read_b64_tr_b16 a[88:89], v4 offset:16384
v_lshlrev_b32 v18, 16, v19
v_mfma_f32_16x16x32_bf16 v[244:247], a[96:99], a[56:59], v[244:247]
ds_read_b64_tr_b16 a[90:91], v4 offset:17408
v_and_b32 v19, 0xffff0000, v19
v_mfma_f32_16x16x32_bf16 v[244:247], a[100:103], a[60:63], v[244:247]
ds_read_b64_tr_b16 a[92:93], v4 offset:24576
v_lshlrev_b32 v20, 16, v21
v_mfma_f32_16x16x32_bf16 v[236:239], a[100:103], a[52:55], v[236:239]
ds_read_b64_tr_b16 a[94:95], v4 offset:25600
v_and_b32 v21, 0xffff0000, v21
v_mfma_f32_16x16x32_bf16 v[236:239], a[96:99], a[48:51], v[236:239]
s_xor_b32 m0, s77, 150528
v_mul_f32 v18, v18, v20
v_mul_f32 v19, v19, v21
v_mfma_f32_16x16x32_bf16 v[228:231], a[96:99], a[40:43], v[228:231]
s_xor_b32 s64, s71, 2719744
v_cvt_pk_bf16_f32 v18, v18, v19
v_lshlrev_b32 v19, 16, v18
v_mfma_f32_16x16x32_bf16 v[228:231], a[100:103], a[44:47], v[228:231]
buffer_load_dwordx4 v15, s[40:43], s64 offen lds
v_mfma_f32_16x16x32_bf16 v[220:223], a[100:103], a[36:39], v[220:223]
v_and_b32 v18, 0xffff0000, v18
v_add_f32 v17, v17, v19
v_mfma_f32_16x16x32_bf16 v[220:223], a[96:99], a[32:35], v[220:223]
s_waitcnt lgkmcnt(4)
ds_read_b64_tr_b16 a[96:97], v5 offset:16384
v_add_f32 v17, v17, v18
v_mfma_f32_16x16x32_bf16 v[152:155], a[104:107], a[32:35], v[152:155]
ds_read_b64_tr_b16 a[98:99], v5 offset:17408
v_accvgpr_read_b32 v19, a147
v_mfma_f32_16x16x32_bf16 v[152:155], a[108:111], a[36:39], v[152:155]
ds_read_b64_tr_b16 a[100:101], v5 offset:24576
v_accvgpr_read_b32 v21, a163
v_mfma_f32_16x16x32_bf16 v[160:163], a[108:111], a[44:47], v[160:163]
ds_read_b64_tr_b16 a[102:103], v5 offset:25600
v_lshlrev_b32 v18, 16, v19
v_mfma_f32_16x16x32_bf16 v[160:163], a[104:107], a[40:43], v[160:163]
s_branch L_po3
L_pg3:
s_branch L_tr0
L_po3:
s_add_u32 s82, s82, 1048576
v_and_b32 v19, 0xffff0000, v19
v_lshlrev_b32 v20, 16, v21
v_mfma_f32_16x16x32_bf16 v[168:171], a[104:107], a[48:51], v[168:171]
buffer_load_dword a252, v1, s[60:63], s82 offen
v_mfma_f32_16x16x32_bf16 v[168:171], a[108:111], a[52:55], v[168:171]
v_and_b32 v21, 0xffff0000, v21
v_mul_f32 v18, v18, v20
v_mfma_f32_16x16x32_bf16 v[176:179], a[108:111], a[60:63], v[176:179]
s_xor_b32 m0, s84, 32768
v_mul_f32 v19, v19, v21
v_cvt_pk_bf16_f32 v18, v18, v19
v_mfma_f32_16x16x32_bf16 v[176:179], a[104:107], a[56:59], v[176:179]
s_xor_b32 s64, s70, 640
ds_read_b64_tr_b16 a[104:105], v6 offset:16384
v_lshlrev_b32 v19, 16, v18
v_mfma_f32_16x16x32_bf16 v[180:183], a[112:115], a[56:59], v[180:183]
buffer_load_dwordx4 v12, s[32:35], s64 offen lds
v_mfma_f32_16x16x32_bf16 v[180:183], a[116:119], a[60:63], v[180:183]
ds_read_b64_tr_b16 a[106:107], v6 offset:17408
v_and_b32 v18, 0xffff0000, v18
v_mfma_f32_16x16x32_bf16 v[172:175], a[116:119], a[52:55], v[172:175]
ds_read_b64_tr_b16 a[108:109], v6 offset:24576
v_add_f32 v17, v17, v19
v_mfma_f32_16x16x32_bf16 v[172:175], a[112:115], a[48:51], v[172:175]
ds_read_b64_tr_b16 a[110:111], v6 offset:25600
v_add_f32 v17, v17, v18
v_mfma_f32_16x16x32_bf16 v[164:167], a[112:115], a[40:43], v[164:167]
v_accvgpr_read_b32 v19, a148
v_accvgpr_read_b32 v21, a164
v_mfma_f32_16x16x32_bf16 v[164:167], a[116:119], a[44:47], v[164:167]
s_xor_b32 m0, s84, 33792
v_lshlrev_b32 v18, 16, v19
v_and_b32 v19, 0xffff0000, v19
v_mfma_f32_16x16x32_bf16 v[156:159], a[116:119], a[36:39], v[156:159]
s_xor_b32 s64, s70, 8832
v_lshlrev_b32 v20, 16, v21
v_and_b32 v21, 0xffff0000, v21
v_mfma_f32_16x16x32_bf16 v[156:159], a[112:115], a[32:35], v[156:159]
buffer_load_dwordx4 v13, s[32:35], s64 offen lds
v_mfma_f32_16x16x32_bf16 v[24:27], a[72:75], a[32:35], v[24:27]
ds_read_b64_tr_b16 a[112:113], v7 offset:16384
v_mul_f32 v18, v18, v20
v_mfma_f32_16x16x32_bf16 v[24:27], a[76:79], a[36:39], v[24:27]
ds_read_b64_tr_b16 a[114:115], v7 offset:17408
v_mul_f32 v19, v19, v21
v_mfma_f32_16x16x32_bf16 v[40:43], a[76:79], a[44:47], v[40:43]
ds_read_b64_tr_b16 a[116:117], v7 offset:24576
v_cvt_pk_bf16_f32 v18, v18, v19
v_mfma_f32_16x16x32_bf16 v[40:43], a[72:75], a[40:43], v[40:43]
ds_read_b64_tr_b16 a[118:119], v7 offset:25600
v_lshlrev_b32 v19, 16, v18
v_mfma_f32_16x16x32_bf16 v[56:59], a[72:75], a[48:51], v[56:59]
s_xor_b32 m0, s84, 34816
v_and_b32 v18, 0xffff0000, v18
v_add_f32 v17, v17, v19
v_mfma_f32_16x16x32_bf16 v[56:59], a[76:79], a[52:55], v[56:59]
s_xor_b32 s64, s70, 17024
v_add_f32 v17, v17, v18
v_accvgpr_read_b32 v19, a149
v_mfma_f32_16x16x32_bf16 v[72:75], a[76:79], a[60:63], v[72:75]
s_waitcnt vmcnt(12)
buffer_load_dwordx4 v12, s[32:35], s64 offen lds
v_mfma_f32_16x16x32_bf16 v[72:75], a[72:75], a[56:59], v[72:75]
ds_read_b64_tr_b16 a[72:73], v8 offset:16384
v_accvgpr_read_b32 v21, a165
v_mfma_f32_16x16x32_bf16 v[136:139], a[80:83], a[56:59], v[136:139]
ds_read_b64_tr_b16 a[74:75], v8 offset:17408
v_lshlrev_b32 v18, 16, v19
v_mfma_f32_16x16x32_bf16 v[136:139], a[84:87], a[60:63], v[136:139]
ds_read_b64_tr_b16 a[76:77], v8 offset:24576
v_and_b32 v19, 0xffff0000, v19
v_mfma_f32_16x16x32_bf16 v[120:123], a[84:87], a[52:55], v[120:123]
ds_read_b64_tr_b16 a[78:79], v8 offset:25600
v_lshlrev_b32 v20, 16, v21
v_mfma_f32_16x16x32_bf16 v[120:123], a[80:83], a[48:51], v[120:123]
s_xor_b32 m0, s84, 35840
ds_read_b128 a[0:3], v2 offset:0
v_and_b32 v21, 0xffff0000, v21
v_mfma_f32_16x16x32_bf16 v[104:107], a[80:83], a[40:43], v[104:107]
s_xor_b32 s64, s70, 25216
ds_read_b128 a[4:7], v3 offset:0
v_mul_f32 v18, v18, v20
v_mfma_f32_16x16x32_bf16 v[104:107], a[84:87], a[44:47], v[104:107]
buffer_load_dwordx4 v13, s[32:35], s64 offen lds
v_mfma_f32_16x16x32_bf16 v[88:91], a[84:87], a[36:39], v[88:91]
ds_read_b128 a[8:11], v2 offset:2048
v_mul_f32 v19, v19, v21
v_mfma_f32_16x16x32_bf16 v[88:91], a[80:83], a[32:35], v[88:91]
s_waitcnt lgkmcnt(7)
ds_read_b128 a[12:15], v3 offset:2048
v_cvt_pk_bf16_f32 v18, v18, v19
v_mfma_f32_16x16x32_bf16 v[28:31], a[32:35], a[88:91], v[28:31]
ds_read_b128 a[16:19], v2 offset:4096
v_lshlrev_b32 v19, 16, v18
v_mfma_f32_16x16x32_bf16 v[28:31], a[36:39], a[92:95], v[28:31]
ds_read_b128 a[20:23], v3 offset:4096
v_and_b32 v18, 0xffff0000, v18
v_mfma_f32_16x16x32_bf16 v[44:47], a[44:47], a[92:95], v[44:47]
s_xor_b32 m0, s84, 36864
ds_read_b128 a[24:27], v2 offset:6144
v_add_f32 v17, v17, v19
v_mfma_f32_16x16x32_bf16 v[44:47], a[40:43], a[88:91], v[44:47]
s_xor_b32 s64, s70, 33408
ds_read_b128 a[28:31], v3 offset:6144
v_add_f32 v17, v17, v18
v_mfma_f32_16x16x32_bf16 v[60:63], a[48:51], a[88:91], v[60:63]
buffer_load_dwordx4 v12, s[32:35], s64 offen lds
v_mfma_f32_16x16x32_bf16 v[60:63], a[52:55], a[92:95], v[60:63]
ds_read_b64_tr_b16 a[80:81], v9 offset:16384
v_accvgpr_read_b32 v19, a150
v_mfma_f32_16x16x32_bf16 v[76:79], a[60:63], a[92:95], v[76:79]
ds_read_b64_tr_b16 a[82:83], v9 offset:17408
v_accvgpr_read_b32 v21, a166
v_mfma_f32_16x16x32_bf16 v[76:79], a[56:59], a[88:91], v[76:79]
ds_read_b64_tr_b16 a[84:85], v9 offset:24576
v_lshlrev_b32 v18, 16, v19
v_mfma_f32_16x16x32_bf16 v[140:143], a[56:59], a[96:99], v[140:143]
ds_read_b64_tr_b16 a[86:87], v9 offset:25600
v_and_b32 v19, 0xffff0000, v19
v_mfma_f32_16x16x32_bf16 v[140:143], a[60:63], a[100:103], v[140:143]
s_xor_b32 m0, s84, 37888
ds_read_b64_tr_b16 a[88:89], v10 offset:16384
v_lshlrev_b32 v20, 16, v21
v_mfma_f32_16x16x32_bf16 v[124:127], a[52:55], a[100:103], v[124:127]
s_xor_b32 s64, s70, 41600
ds_read_b64_tr_b16 a[90:91], v10 offset:17408
v_and_b32 v21, 0xffff0000, v21
v_mfma_f32_16x16x32_bf16 v[124:127], a[48:51], a[96:99], v[124:127]
s_add_u32 s81, s81, 1048576
buffer_load_dwordx4 v13, s[32:35], s64 offen lds
v_mfma_f32_16x16x32_bf16 v[108:111], a[40:43], a[96:99], v[108:111]
buffer_load_dword a252, v16, s[56:59], s81 offen
v_mfma_f32_16x16x32_bf16 v[108:111], a[44:47], a[100:103], v[108:111]
ds_read_b64_tr_b16 a[92:93], v10 offset:24576
v_mul_f32 v18, v18, v20
v_mfma_f32_16x16x32_bf16 v[92:95], a[36:39], a[100:103], v[92:95]
ds_read_b64_tr_b16 a[94:95], v10 offset:25600
v_mul_f32 v19, v19, v21
v_mfma_f32_16x16x32_bf16 v[92:95], a[32:35], a[96:99], v[92:95]
ds_read_b64_tr_b16 a[96:97], v11 offset:16384
v_cvt_pk_bf16_f32 v18, v18, v19
v_mfma_f32_16x16x32_bf16 v[32:35], a[32:35], a[104:107], v[32:35]
s_xor_b32 m0, s84, 38912
ds_read_b64_tr_b16 a[98:99], v11 offset:17408
v_lshlrev_b32 v19, 16, v18
v_mfma_f32_16x16x32_bf16 v[32:35], a[36:39], a[108:111], v[32:35]
s_xor_b32 s64, s70, 49792
ds_read_b64_tr_b16 a[100:101], v11 offset:24576
v_and_b32 v18, 0xffff0000, v18
v_mfma_f32_16x16x32_bf16 v[48:51], a[44:47], a[108:111], v[48:51]
buffer_load_dwordx4 v12, s[32:35], s64 offen lds
v_mfma_f32_16x16x32_bf16 v[48:51], a[40:43], a[104:107], v[48:51]
ds_read_b64_tr_b16 a[102:103], v11 offset:25600
v_add_f32 v17, v17, v19
v_mfma_f32_16x16x32_bf16 v[64:67], a[48:51], a[104:107], v[64:67]
v_add_f32 v17, v17, v18
v_accvgpr_read_b32 v19, a151
v_mfma_f32_16x16x32_bf16 v[64:67], a[52:55], a[108:111], v[64:67]
v_accvgpr_read_b32 v21, a167
v_lshlrev_b32 v18, 16, v19
v_mfma_f32_16x16x32_bf16 v[80:83], a[60:63], a[108:111], v[80:83]
v_and_b32 v19, 0xffff0000, v19
v_lshlrev_b32 v20, 16, v21
v_mfma_f32_16x16x32_bf16 v[80:83], a[56:59], a[104:107], v[80:83]
s_xor_b32 m0, s84, 39936
v_and_b32 v21, 0xffff0000, v21
v_mul_f32 v18, v18, v20
v_mfma_f32_16x16x32_bf16 v[144:147], a[56:59], a[112:115], v[144:147]
s_xor_b32 s64, s70, 57984
v_mul_f32 v19, v19, v21
v_cvt_pk_bf16_f32 v18, v18, v19
v_mfma_f32_16x16x32_bf16 v[144:147], a[60:63], a[116:119], v[144:147]
buffer_load_dwordx4 v13, s[32:35], s64 offen lds
v_mfma_f32_16x16x32_bf16 v[128:131], a[52:55], a[116:119], v[128:131]
v_lshlrev_b32 v19, 16, v18
v_and_b32 v18, 0xffff0000, v18
v_mfma_f32_16x16x32_bf16 v[128:131], a[48:51], a[112:115], v[128:131]
v_add_f32 v17, v17, v19
v_add_f32 v17, v17, v18
v_mfma_f32_16x16x32_bf16 v[112:115], a[40:43], a[112:115], v[112:115]
v_accvgpr_read_b32 v19, a152
v_accvgpr_read_b32 v21, a168
v_mfma_f32_16x16x32_bf16 v[112:115], a[44:47], a[116:119], v[112:115]
v_lshlrev_b32 v18, 16, v19
v_and_b32 v19, 0xffff0000, v19
v_mfma_f32_16x16x32_bf16 v[96:99], a[36:39], a[116:119], v[96:99]
v_lshlrev_b32 v20, 16, v21
v_and_b32 v21, 0xffff0000, v21
v_mfma_f32_16x16x32_bf16 v[96:99], a[32:35], a[112:115], v[96:99]
s_waitcnt lgkmcnt(0)
v_mul_f32 v18, v18, v20
v_mul_f32 v19, v19, v21
v_mfma_f32_16x16x32_bf16 v[36:39], a[32:35], a[72:75], v[36:39]
v_cvt_pk_bf16_f32 v18, v18, v19
v_lshlrev_b32 v19, 16, v18
v_mfma_f32_16x16x32_bf16 v[36:39], a[36:39], a[76:79], v[36:39]
v_and_b32 v18, 0xffff0000, v18
v_add_f32 v17, v17, v19
v_mfma_f32_16x16x32_bf16 v[52:55], a[44:47], a[76:79], v[52:55]
s_waitcnt lgkmcnt(0)
s_barrier
v_mfma_f32_16x16x32_bf16 v[52:55], a[40:43], a[72:75], v[52:55]
s_xor_b32 m0, s77, 65536
ds_read_b64_tr_b16 a[104:105], v4 offset:32768
v_add_f32 v17, v17, v18
v_mfma_f32_16x16x32_bf16 v[68:71], a[48:51], a[72:75], v[68:71]
s_xor_b32 s64, s71, 3145728
ds_read_b64_tr_b16 a[106:107], v4 offset:33792
v_accvgpr_read_b32 v19, a153
v_mfma_f32_16x16x32_bf16 v[68:71], a[52:55], a[76:79], v[68:71]
buffer_load_dwordx4 v14, s[36:39], s64 offen lds
v_mfma_f32_16x16x32_bf16 v[84:87], a[60:63], a[76:79], v[84:87]
ds_read_b64_tr_b16 a[108:109], v4 offset:40960
v_accvgpr_read_b32 v21, a169
v_mfma_f32_16x16x32_bf16 v[84:87], a[56:59], a[72:75], v[84:87]
ds_read_b64_tr_b16 a[110:111], v4 offset:41984
v_lshlrev_b32 v18, 16, v19
v_mfma_f32_16x16x32_bf16 v[148:151], a[56:59], a[80:83], v[148:151]
ds_read_b64_tr_b16 a[112:113], v5 offset:32768
v_and_b32 v19, 0xffff0000, v19
v_mfma_f32_16x16x32_bf16 v[148:151], a[60:63], a[84:87], v[148:151]
ds_read_b64_tr_b16 a[114:115], v5 offset:33792
v_lshlrev_b32 v20, 16, v21
v_mfma_f32_16x16x32_bf16 v[132:135], a[52:55], a[84:87], v[132:135]
ds_read_b64_tr_b16 a[116:117], v5 offset:40960
v_and_b32 v21, 0xffff0000, v21
v_mfma_f32_16x16x32_bf16 v[132:135], a[48:51], a[80:83], v[132:135]
s_xor_b32 m0, s77, 66560
ds_read_b64_tr_b16 a[118:119], v5 offset:41984
v_mul_f32 v18, v18, v20
v_mfma_f32_16x16x32_bf16 v[116:119], a[40:43], a[80:83], v[116:119]
s_xor_b32 s64, s71, 3178496
ds_read_b64_tr_b16 a[72:73], v6 offset:32768
v_mul_f32 v19, v19, v21
v_mfma_f32_16x16x32_bf16 v[116:119], a[44:47], a[84:87], v[116:119]
buffer_load_dwordx4 v14, s[36:39], s64 offen lds
v_mfma_f32_16x16x32_bf16 v[100:103], a[36:39], a[84:87], v[100:103]
ds_read_b64_tr_b16 a[74:75], v6 offset:33792
v_cvt_pk_bf16_f32 v18, v18, v19
v_mfma_f32_16x16x32_bf16 v[100:103], a[32:35], a[80:83], v[100:103]
ds_read_b64_tr_b16 a[76:77], v6 offset:40960
v_lshlrev_b32 v19, 16, v18
v_mfma_f32_16x16x32_bf16 v[248:251], a[32:35], a[88:91], v[248:251]
ds_read_b64_tr_b16 a[78:79], v6 offset:41984
v_and_b32 v18, 0xffff0000, v18
v_mfma_f32_16x16x32_bf16 v[248:251], a[36:39], a[92:95], v[248:251]
ds_read_b64_tr_b16 a[80:81], v7 offset:32768
v_add_f32 v17, v17, v19
v_mfma_f32_16x16x32_bf16 v[252:255], a[44:47], a[92:95], v[252:255]
s_add_u32 s81, s81, 1048576
ds_read_b64_tr_b16 a[82:83], v7 offset:33792
v_add_f32 v17, v17, v18
v_mfma_f32_16x16x32_bf16 v[252:255], a[40:43], a[88:91], v[252:255]
s_xor_b32 m0, s77, 67584
ds_read_b64_tr_b16 a[84:85], v7 offset:40960
v_accvgpr_read_b32 v19, a154
v_mfma_f32_16x16x32_bf16 a[120:123], a[48:51], a[88:91], a[120:123]
s_xor_b32 s64, s71, 3211264
buffer_load_dword a252, v16, s[56:59], s81 offen
v_mfma_f32_16x16x32_bf16 a[120:123], a[52:55], a[92:95], a[120:123]
buffer_load_dwordx4 v15, s[36:39], s64 offen lds
v_mfma_f32_16x16x32_bf16 a[124:127], a[60:63], a[92:95], a[124:127]
ds_read_b64_tr_b16 a[86:87], v7 offset:41984
v_accvgpr_read_b32 v21, a170
v_mfma_f32_16x16x32_bf16 a[124:127], a[56:59], a[88:91], a[124:127]
ds_read_b64_tr_b16 a[88:89], v8 offset:32768
v_lshlrev_b32 v18, 16, v19
v_mfma_f32_16x16x32_bf16 a[128:131], a[56:59], a[96:99], a[128:131]
ds_read_b64_tr_b16 a[90:91], v8 offset:33792
v_and_b32 v19, 0xffff0000, v19
v_mfma_f32_16x16x32_bf16 a[128:131], a[60:63], a[100:103], a[128:131]
ds_read_b64_tr_b16 a[92:93], v8 offset:40960
v_lshlrev_b32 v20, 16, v21
v_mfma_f32_16x16x32_bf16 a[132:135], a[52:55], a[100:103], a[132:135]
ds_read_b64_tr_b16 a[94:95], v8 offset:41984
v_and_b32 v21, 0xffff0000, v21
v_mfma_f32_16x16x32_bf16 a[132:135], a[48:51], a[96:99], a[132:135]
s_xor_b32 m0, s77, 68608
v_mul_f32 v18, v18, v20
v_mul_f32 v19, v19, v21
v_mfma_f32_16x16x32_bf16 a[136:139], a[40:43], a[96:99], a[136:139]
s_xor_b32 s64, s71, 3244032
v_cvt_pk_bf16_f32 v18, v18, v19
v_lshlrev_b32 v19, 16, v18
v_mfma_f32_16x16x32_bf16 a[136:139], a[44:47], a[100:103], a[136:139]
buffer_load_dwordx4 v15, s[36:39], s64 offen lds
v_mfma_f32_16x16x32_bf16 a[140:143], a[36:39], a[100:103], a[140:143]
v_and_b32 v18, 0xffff0000, v18
v_add_f32 v17, v17, v19
v_mfma_f32_16x16x32_bf16 a[140:143], a[32:35], a[96:99], a[140:143]
s_waitcnt lgkmcnt(5)
ds_read_b64_tr_b16 a[96:97], v9 offset:32768
v_add_f32 v17, v17, v18
v_mfma_f32_16x16x32_bf16 v[184:187], a[104:107], a[0:3], v[184:187]
ds_read_b64_tr_b16 a[98:99], v9 offset:33792
v_accvgpr_read_b32 v19, a155
v_mfma_f32_16x16x32_bf16 v[184:187], a[108:111], a[4:7], v[184:187]
ds_read_b64_tr_b16 a[100:101], v9 offset:40960
v_accvgpr_read_b32 v21, a171
v_mfma_f32_16x16x32_bf16 v[192:195], a[108:111], a[12:15], v[192:195]
ds_read_b64_tr_b16 a[102:103], v9 offset:41984
v_lshlrev_b32 v18, 16, v19
v_mfma_f32_16x16x32_bf16 v[192:195], a[104:107], a[8:11], v[192:195]
s_xor_b32 m0, s77, 81920
v_and_b32 v19, 0xffff0000, v19
v_lshlrev_b32 v20, 16, v21
v_mfma_f32_16x16x32_bf16 v[200:203], a[104:107], a[16:19], v[200:203]
s_xor_b32 s64, s71, 3145728
v_and_b32 v21, 0xffff0000, v21
v_mul_f32 v18, v18, v20
v_mfma_f32_16x16x32_bf16 v[200:203], a[108:111], a[20:23], v[200:203]
buffer_load_dwordx4 v14, s[40:43], s64 offen lds
v_mfma_f32_16x16x32_bf16 v[208:211], a[108:111], a[28:31], v[208:211]
v_mul_f32 v19, v19, v21
v_cvt_pk_bf16_f32 v18, v18, v19
v_mfma_f32_16x16x32_bf16 v[208:211], a[104:107], a[24:27], v[208:211]
ds_read_b64_tr_b16 a[104:105], v10 offset:32768
v_lshlrev_b32 v19, 16, v18
v_mfma_f32_16x16x32_bf16 v[212:215], a[112:115], a[24:27], v[212:215]
ds_read_b64_tr_b16 a[106:107], v10 offset:33792
v_and_b32 v18, 0xffff0000, v18
v_mfma_f32_16x16x32_bf16 v[212:215], a[116:119], a[28:31], v[212:215]
ds_read_b64_tr_b16 a[108:109], v10 offset:40960
v_add_f32 v17, v17, v19
v_mfma_f32_16x16x32_bf16 v[204:207], a[116:119], a[20:23], v[204:207]
ds_read_b64_tr_b16 a[110:111], v10 offset:41984
v_add_f32 v17, v17, v18
v_mfma_f32_16x16x32_bf16 v[204:207], a[112:115], a[16:19], v[204:207]
s_xor_b32 m0, s77, 82944
v_accvgpr_read_b32 v19, a156
v_accvgpr_read_b32 v21, a172
v_mfma_f32_16x16x32_bf16 v[196:199], a[112:115], a[8:11], v[196:199]
s_xor_b32 s64, s71, 3178496
v_lshlrev_b32 v18, 16, v19
v_and_b32 v19, 0xffff0000, v19
v_mfma_f32_16x16x32_bf16 v[196:199], a[116:119], a[12:15], v[196:199]
buffer_load_dwordx4 v14, s[40:43], s64 offen lds
v_mfma_f32_16x16x32_bf16 v[188:191], a[116:119], a[4:7], v[188:191]
v_lshlrev_b32 v20, 16, v21
v_and_b32 v21, 0xffff0000, v21
v_mfma_f32_16x16x32_bf16 v[188:191], a[112:115], a[0:3], v[188:191]
ds_read_b64_tr_b16 a[112:113], v11 offset:32768
v_mul_f32 v18, v18, v20
v_mfma_f32_16x16x32_bf16 v[216:219], a[72:75], a[0:3], v[216:219]
ds_read_b64_tr_b16 a[114:115], v11 offset:33792
v_mul_f32 v19, v19, v21
v_mfma_f32_16x16x32_bf16 v[216:219], a[76:79], a[4:7], v[216:219]
ds_read_b64_tr_b16 a[116:117], v11 offset:40960
v_cvt_pk_bf16_f32 v18, v18, v19
v_mfma_f32_16x16x32_bf16 v[224:227], a[76:79], a[12:15], v[224:227]
ds_read_b64_tr_b16 a[118:119], v11 offset:41984
v_lshlrev_b32 v19, 16, v18
v_mfma_f32_16x16x32_bf16 v[224:227], a[72:75], a[8:11], v[224:227]
s_xor_b32 m0, s77, 83968
v_and_b32 v18, 0xffff0000, v18
v_add_f32 v17, v17, v19
v_mfma_f32_16x16x32_bf16 v[232:235], a[72:75], a[16:19], v[232:235]
s_xor_b32 s64, s71, 3211264
v_add_f32 v17, v17, v18
v_accvgpr_read_b32 v19, a157
v_mfma_f32_16x16x32_bf16 v[232:235], a[76:79], a[20:23], v[232:235]
buffer_load_dwordx4 v15, s[40:43], s64 offen lds
v_mfma_f32_16x16x32_bf16 v[240:243], a[76:79], a[28:31], v[240:243]
v_accvgpr_read_b32 v21, a173
v_lshlrev_b32 v18, 16, v19
v_mfma_f32_16x16x32_bf16 v[240:243], a[72:75], a[24:27], v[240:243]
ds_read_b64_tr_b16 a[72:73], v4 offset:49152
v_and_b32 v19, 0xffff0000, v19
v_mfma_f32_16x16x32_bf16 v[244:247], a[80:83], a[24:27], v[244:247]
s_waitcnt lgkmcnt(5)
ds_read_b64_tr_b16 a[74:75], v4 offset:50176
v_lshlrev_b32 v20, 16, v21
v_mfma_f32_16x16x32_bf16 v[244:247], a[84:87], a[28:31], v[244:247]
ds_read_b64_tr_b16 a[76:77], v4 offset:57344
v_and_b32 v21, 0xffff0000, v21
v_mfma_f32_16x16x32_bf16 v[236:239], a[84:87], a[20:23], v[236:239]
s_add_u32 s82, s82, 1048576
ds_read_b64_tr_b16 a[78:79], v4 offset:58368
v_mul_f32 v18, v18, v20
v_mfma_f32_16x16x32_bf16 v[236:239], a[80:83], a[16:19], v[236:239]
s_xor_b32 m0, s77, 84992
v_mul_f32 v19, v19, v21
v_cvt_pk_bf16_f32 v18, v18, v19
v_mfma_f32_16x16x32_bf16 v[228:231], a[80:83], a[8:11], v[228:231]
s_xor_b32 s64, s71, 3244032
buffer_load_dword a252, v1, s[60:63], s82 offen
v_mfma_f32_16x16x32_bf16 v[228:231], a[84:87], a[12:15], v[228:231]
buffer_load_dwordx4 v15, s[40:43], s64 offen lds
v_mfma_f32_16x16x32_bf16 v[220:223], a[84:87], a[4:7], v[220:223]
v_lshlrev_b32 v19, 16, v18
v_and_b32 v18, 0xffff0000, v18
v_mfma_f32_16x16x32_bf16 v[220:223], a[80:83], a[0:3], v[220:223]
ds_read_b64_tr_b16 a[80:81], v5 offset:49152
v_add_f32 v17, v17, v19
v_mfma_f32_16x16x32_bf16 v[152:155], a[88:91], a[0:3], v[152:155]
ds_read_b64_tr_b16 a[82:83], v5 offset:50176
v_add_f32 v17, v17, v18
v_mfma_f32_16x16x32_bf16 v[152:155], a[92:95], a[4:7], v[152:155]
ds_read_b64_tr_b16 a[84:85], v5 offset:57344
v_accvgpr_read_b32 v19, a158
v_mfma_f32_16x16x32_bf16 v[160:163], a[92:95], a[12:15], v[160:163]
ds_read_b64_tr_b16 a[86:87], v5 offset:58368
v_accvgpr_read_b32 v21, a174
v_mfma_f32_16x16x32_bf16 v[160:163], a[88:91], a[8:11], v[160:163]
v_lshlrev_b32 v18, 16, v19
v_and_b32 v19, 0xffff0000, v19
v_mfma_f32_16x16x32_bf16 v[168:171], a[88:91], a[16:19], v[168:171]
v_lshlrev_b32 v20, 16, v21
v_and_b32 v21, 0xffff0000, v21
v_mfma_f32_16x16x32_bf16 v[168:171], a[92:95], a[20:23], v[168:171]
v_mul_f32 v18, v18, v20
v_mul_f32 v19, v19, v21
v_mfma_f32_16x16x32_bf16 v[176:179], a[92:95], a[28:31], v[176:179]
s_xor_b32 m0, s84, 0
v_cvt_pk_bf16_f32 v18, v18, v19
v_lshlrev_b32 v19, 16, v18
v_mfma_f32_16x16x32_bf16 v[176:179], a[88:91], a[24:27], v[176:179]
s_xor_b32 s64, s70, 768
ds_read_b64_tr_b16 a[88:89], v6 offset:49152
v_and_b32 v18, 0xffff0000, v18
v_mfma_f32_16x16x32_bf16 v[180:183], a[96:99], a[24:27], v[180:183]
buffer_load_dwordx4 v12, s[32:35], s64 offen lds
v_mfma_f32_16x16x32_bf16 v[180:183], a[100:103], a[28:31], v[180:183]
ds_read_b64_tr_b16 a[90:91], v6 offset:50176
v_add_f32 v17, v17, v19
v_mfma_f32_16x16x32_bf16 v[172:175], a[100:103], a[20:23], v[172:175]
ds_read_b64_tr_b16 a[92:93], v6 offset:57344
v_add_f32 v17, v17, v18
v_mfma_f32_16x16x32_bf16 v[172:175], a[96:99], a[16:19], v[172:175]
ds_read_b64_tr_b16 a[94:95], v6 offset:58368
v_accvgpr_read_b32 v19, a159
v_mfma_f32_16x16x32_bf16 v[164:167], a[96:99], a[8:11], v[164:167]
v_accvgpr_read_b32 v21, a175
v_lshlrev_b32 v18, 16, v19
v_mfma_f32_16x16x32_bf16 v[164:167], a[100:103], a[12:15], v[164:167]
s_xor_b32 m0, s84, 1024
v_and_b32 v19, 0xffff0000, v19
v_lshlrev_b32 v20, 16, v21
v_mfma_f32_16x16x32_bf16 v[156:159], a[100:103], a[4:7], v[156:159]
s_xor_b32 s64, s70, 8960
v_and_b32 v21, 0xffff0000, v21
v_mul_f32 v18, v18, v20
v_mfma_f32_16x16x32_bf16 v[156:159], a[96:99], a[0:3], v[156:159]
buffer_load_dwordx4 v13, s[32:35], s64 offen lds
v_mfma_f32_16x16x32_bf16 v[24:27], a[104:107], a[0:3], v[24:27]
ds_read_b64_tr_b16 a[96:97], v7 offset:49152
v_mul_f32 v19, v19, v21
v_mfma_f32_16x16x32_bf16 v[24:27], a[108:111], a[4:7], v[24:27]
ds_read_b64_tr_b16 a[98:99], v7 offset:50176
v_cvt_pk_bf16_f32 v18, v18, v19
v_mfma_f32_16x16x32_bf16 v[40:43], a[108:111], a[12:15], v[40:43]
ds_read_b64_tr_b16 a[100:101], v7 offset:57344
v_lshlrev_b32 v19, 16, v18
v_mfma_f32_16x16x32_bf16 v[40:43], a[104:107], a[8:11], v[40:43]
ds_read_b64_tr_b16 a[102:103], v7 offset:58368
v_and_b32 v18, 0xffff0000, v18
v_mfma_f32_16x16x32_bf16 v[56:59], a[104:107], a[16:19], v[56:59]
s_xor_b32 m0, s84, 2048
v_add_f32 v17, v17, v19
v_add_f32 v17, v17, v18
v_mfma_f32_16x16x32_bf16 v[56:59], a[108:111], a[20:23], v[56:59]
s_xor_b32 s64, s70, 17152
v_mfma_f32_16x16x32_bf16 v[72:75], a[108:111], a[28:31], v[72:75]
s_waitcnt vmcnt(12)
buffer_load_dwordx4 v12, s[32:35], s64 offen lds
v_mfma_f32_16x16x32_bf16 v[72:75], a[104:107], a[24:27], v[72:75]
s_waitcnt lgkmcnt(4)
ds_read_b64_tr_b16 a[104:105], v8 offset:49152
v_add_f32_dpp v17, v17, v17 row_ror:8 row_mask:0xf bank_mask:0xf
v_mfma_f32_16x16x32_bf16 v[136:139], a[112:115], a[24:27], v[136:139]
ds_read_b64_tr_b16 a[106:107], v8 offset:50176
v_mfma_f32_16x16x32_bf16 v[136:139], a[116:119], a[28:31], v[136:139]
ds_read_b64_tr_b16 a[108:109], v8 offset:57344
v_add_u32 v4, 0x8000, v4
v_mfma_f32_16x16x32_bf16 v[120:123], a[116:119], a[20:23], v[120:123]
ds_read_b64_tr_b16 a[110:111], v8 offset:58368
v_add_f32_dpp v17, v17, v17 row_ror:4 row_mask:0xf bank_mask:0xf
v_mfma_f32_16x16x32_bf16 v[120:123], a[112:115], a[16:19], v[120:123]
s_xor_b32 m0, s84, 3072
ds_read_b128 a[32:35], v2 offset:32768
v_mfma_f32_16x16x32_bf16 v[104:107], a[112:115], a[8:11], v[104:107]
s_xor_b32 s64, s70, 25344
ds_read_b128 a[36:39], v3 offset:32768
v_add_f32_dpp v17, v17, v17 row_ror:2 row_mask:0xf bank_mask:0xf
v_mfma_f32_16x16x32_bf16 v[104:107], a[116:119], a[12:15], v[104:107]
buffer_load_dwordx4 v13, s[32:35], s64 offen lds
v_mfma_f32_16x16x32_bf16 v[88:91], a[116:119], a[4:7], v[88:91]
ds_read_b128 a[40:43], v2 offset:34816
v_add_f32_dpp v17, v17, v17 row_ror:1 row_mask:0xf bank_mask:0xf
v_mfma_f32_16x16x32_bf16 v[88:91], a[112:115], a[0:3], v[88:91]
ds_read_b128 a[44:47], v3 offset:34816
v_mov_b32 v18, v17
v_mfma_f32_16x16x32_bf16 v[28:31], a[0:3], a[72:75], v[28:31]
ds_read_b128 a[48:51], v2 offset:36864
v_mfma_f32_16x16x32_bf16 v[28:31], a[4:7], a[76:79], v[28:31]
ds_read_b128 a[52:55], v3 offset:36864
v_add_u32 v5, 0x8000, v5
v_mfma_f32_16x16x32_bf16 v[44:47], a[12:15], a[76:79], v[44:47]
s_xor_b32 m0, s84, 4096
ds_read_b128 a[56:59], v2 offset:38912
v_permlane16_swap_b32 v18, v17
v_mfma_f32_16x16x32_bf16 v[44:47], a[8:11], a[72:75], v[44:47]
s_xor_b32 s64, s70, 33536
ds_read_b128 a[60:63], v3 offset:38912
v_add_f32 v17, v17, v18
v_mfma_f32_16x16x32_bf16 v[60:63], a[16:19], a[72:75], v[60:63]
s_add_u32 s81, s81, 1048576
buffer_load_dwordx4 v12, s[32:35], s64 offen lds
v_mfma_f32_16x16x32_bf16 v[60:63], a[20:23], a[76:79], v[60:63]
buffer_load_dword a252, v16, s[56:59], s81 offen
v_mfma_f32_16x16x32_bf16 v[76:79], a[28:31], a[76:79], v[76:79]
ds_read_b64_tr_b16 a[112:113], v9 offset:49152
v_cvt_pk_bf16_f32 v17, v17, v17
v_mfma_f32_16x16x32_bf16 v[76:79], a[24:27], a[72:75], v[76:79]
ds_read_b64_tr_b16 a[114:115], v9 offset:50176
v_and_b32 v17, 0xffff0000, v17
v_mfma_f32_16x16x32_bf16 v[140:143], a[24:27], a[80:83], v[140:143]
ds_read_b64_tr_b16 a[116:117], v9 offset:57344
v_mul_f32 v17, 0xbfb8aa3b, v17
v_mfma_f32_16x16x32_bf16 v[140:143], a[28:31], a[84:87], v[140:143]
s_xor_b32 m0, s84, 5120
ds_read_b64_tr_b16 a[118:119], v9 offset:58368
v_add_u32 v6, 0x8000, v6
v_mfma_f32_16x16x32_bf16 v[124:127], a[20:23], a[84:87], v[124:127]
s_xor_b32 s64, s70, 41728
ds_read_b64_tr_b16 a[72:73], v10 offset:49152
v_mfma_f32_16x16x32_bf16 v[124:127], a[16:19], a[80:83], v[124:127]
buffer_load_dwordx4 v13, s[32:35], s64 offen lds
v_mfma_f32_16x16x32_bf16 v[108:111], a[8:11], a[80:83], v[108:111]
ds_read_b64_tr_b16 a[74:75], v10 offset:50176
v_mfma_f32_16x16x32_bf16 v[108:111], a[12:15], a[84:87], v[108:111]
ds_read_b64_tr_b16 a[76:77], v10 offset:57344
v_mfma_f32_16x16x32_bf16 v[92:95], a[4:7], a[84:87], v[92:95]
ds_read_b64_tr_b16 a[78:79], v10 offset:58368
v_mfma_f32_16x16x32_bf16 v[92:95], a[0:3], a[80:83], v[92:95]
ds_read_b64_tr_b16 a[80:81], v11 offset:49152
v_mfma_f32_16x16x32_bf16 v[32:35], a[0:3], a[88:91], v[32:35]
s_xor_b32 m0, s84, 6144
ds_read_b64_tr_b16 a[82:83], v11 offset:50176
v_mfma_f32_16x16x32_bf16 v[32:35], a[4:7], a[92:95], v[32:35]
s_xor_b32 s64, s70, 49920
ds_read_b64_tr_b16 a[84:85], v11 offset:57344
v_add_u32 v7, 0x8000, v7
v_mfma_f32_16x16x32_bf16 v[48:51], a[12:15], a[92:95], v[48:51]
buffer_load_dwordx4 v12, s[32:35], s64 offen lds
v_mfma_f32_16x16x32_bf16 v[48:51], a[8:11], a[88:91], v[48:51]
ds_read_b64_tr_b16 a[86:87], v11 offset:58368
v_mfma_f32_16x16x32_bf16 v[64:67], a[16:19], a[88:91], v[64:67]
v_exp_f32 v17, v17
v_mfma_f32_16x16x32_bf16 v[64:67], a[20:23], a[92:95], v[64:67]
v_add_f32 v17, 1.0, v17
v_mfma_f32_16x16x32_bf16 v[80:83], a[28:31], a[92:95], v[80:83]
v_rcp_f32 v17, v17
v_mfma_f32_16x16x32_bf16 v[80:83], a[24:27], a[88:91], v[80:83]
s_waitcnt lgkmcnt(5)
s_xor_b32 m0, s84, 7168
v_cvt_pk_bf16_f32 v18, v17, v17
v_mfma_f32_16x16x32_bf16 v[144:147], a[24:27], a[96:99], v[144:147]
s_xor_b32 s64, s70, 58112
v_and_b32 v18, 0xffff0000, v18
v_mfma_f32_16x16x32_bf16 v[144:147], a[28:31], a[100:103], v[144:147]
buffer_load_dwordx4 v13, s[32:35], s64 offen lds
v_mfma_f32_16x16x32_bf16 v[128:131], a[20:23], a[100:103], v[128:131]
s_branch L_po4
L_pg4:
s_branch L_tr0
L_po4:
v_add_u32 v8, 0x8000, v8
v_sub_f32 v19, 1.0, v18
v_mfma_f32_16x16x32_bf16 v[128:131], a[16:19], a[96:99], v[128:131]
v_cvt_pk_bf16_f32 v19, v19, v19
v_mfma_f32_16x16x32_bf16 v[112:115], a[8:11], a[96:99], v[112:115]
v_and_b32 v19, 0xffff0000, v19
v_mfma_f32_16x16x32_bf16 v[112:115], a[12:15], a[100:103], v[112:115]
v_and_b32 v20, 31, v0
v_mfma_f32_16x16x32_bf16 v[96:99], a[4:7], a[100:103], v[96:99]
v_add_u32 v9, 0x8000, v9
v_add_u32 v10, 0x8000, v10
v_mfma_f32_16x16x32_bf16 v[96:99], a[0:3], a[96:99], v[96:99]
v_add_u32 v11, 0x8000, v11
v_lshlrev_b32 v20, 27, v20
v_mfma_f32_16x16x32_bf16 v[36:39], a[0:3], a[104:107], v[36:39]
v_lshrrev_b32 v21, 2, v0
v_mfma_f32_16x16x32_bf16 v[36:39], a[4:7], a[108:111], v[36:39]
v_add_u32 v20, v20, v21
v_mfma_f32_16x16x32_bf16 v[52:55], a[12:15], a[108:111], v[52:55]
s_waitcnt lgkmcnt(0)
s_barrier
v_mfma_f32_16x16x32_bf16 v[52:55], a[8:11], a[104:107], v[52:55]
s_xor_b32 m0, s77, 98304
ds_read_b64_tr_b16 a[88:89], v4 offset:32768
v_mfma_f32_16x16x32_bf16 v[68:71], a[16:19], a[104:107], v[68:71]
s_xor_b32 s64, s71, 3670016
ds_read_b64_tr_b16 a[90:91], v4 offset:33792
v_mfma_f32_16x16x32_bf16 v[68:71], a[20:23], a[108:111], v[68:71]
buffer_load_dwordx4 v14, s[36:39], s64 offen lds
v_mfma_f32_16x16x32_bf16 v[84:87], a[28:31], a[108:111], v[84:87]
ds_read_b64_tr_b16 a[92:93], v4 offset:40960
v_mfma_f32_16x16x32_bf16 v[84:87], a[24:27], a[104:107], v[84:87]
ds_read_b64_tr_b16 a[94:95], v4 offset:41984
v_mfma_f32_16x16x32_bf16 v[148:151], a[24:27], a[112:115], v[148:151]
ds_read_b64_tr_b16 a[96:97], v5 offset:32768
v_mfma_f32_16x16x32_bf16 v[148:151], a[28:31], a[116:119], v[148:151]
ds_read_b64_tr_b16 a[98:99], v5 offset:33792
v_mfma_f32_16x16x32_bf16 v[132:135], a[20:23], a[116:119], v[132:135]
ds_read_b64_tr_b16 a[100:101], v5 offset:40960
v_mfma_f32_16x16x32_bf16 v[132:135], a[16:19], a[112:115], v[132:135]
s_xor_b32 m0, s77, 99328
s_add_u32 s82, s82, 1048576
ds_read_b64_tr_b16 a[102:103], v5 offset:41984
v_mfma_f32_16x16x32_bf16 v[116:119], a[8:11], a[112:115], v[116:119]
s_xor_b32 s64, s71, 3702784
buffer_load_dword a252, v1, s[60:63], s82 offen
v_mfma_f32_16x16x32_bf16 v[116:119], a[12:15], a[116:119], v[116:119]
buffer_load_dwordx4 v14, s[36:39], s64 offen lds
v_mfma_f32_16x16x32_bf16 v[100:103], a[4:7], a[116:119], v[100:103]
ds_read_b64_tr_b16 a[104:105], v6 offset:32768
v_mfma_f32_16x16x32_bf16 v[100:103], a[0:3], a[112:115], v[100:103]
ds_read_b64_tr_b16 a[106:107], v6 offset:33792
v_mfma_f32_16x16x32_bf16 v[248:251], a[0:3], a[72:75], v[248:251]
ds_read_b64_tr_b16 a[108:109], v6 offset:40960
v_mfma_f32_16x16x32_bf16 v[248:251], a[4:7], a[76:79], v[248:251]
ds_read_b64_tr_b16 a[110:111], v6 offset:41984
v_mfma_f32_16x16x32_bf16 v[252:255], a[12:15], a[76:79], v[252:255]
ds_read_b64_tr_b16 a[112:113], v7 offset:32768
v_mfma_f32_16x16x32_bf16 v[252:255], a[8:11], a[72:75], v[252:255]
s_xor_b32 m0, s77, 100352
ds_read_b64_tr_b16 a[114:115], v7 offset:33792
v_mfma_f32_16x16x32_bf16 a[120:123], a[16:19], a[72:75], a[120:123]
s_xor_b32 s64, s71, 3735552
ds_read_b64_tr_b16 a[116:117], v7 offset:40960
v_mfma_f32_16x16x32_bf16 a[120:123], a[20:23], a[76:79], a[120:123]
buffer_load_dwordx4 v15, s[36:39], s64 offen lds
v_mfma_f32_16x16x32_bf16 a[124:127], a[28:31], a[76:79], a[124:127]
ds_read_b64_tr_b16 a[118:119], v7 offset:41984
v_mfma_f32_16x16x32_bf16 a[124:127], a[24:27], a[72:75], a[124:127]
ds_read_b64_tr_b16 a[72:73], v8 offset:32768
v_mfma_f32_16x16x32_bf16 a[128:131], a[24:27], a[80:83], a[128:131]
ds_read_b64_tr_b16 a[74:75], v8 offset:33792
v_mfma_f32_16x16x32_bf16 a[128:131], a[28:31], a[84:87], a[128:131]
s_lshl2_add_u32 s65, s2, s30
ds_read_b64_tr_b16 a[76:77], v8 offset:40960
v_mfma_f32_16x16x32_bf16 a[132:135], a[20:23], a[84:87], a[132:135]
s_lshl4_add_u32 s65, s65, 58720256
ds_read_b64_tr_b16 a[78:79], v8 offset:41984
v_mfma_f32_16x16x32_bf16 a[132:135], a[16:19], a[80:83], a[132:135]
s_xor_b32 m0, s77, 101376
buffer_store_dwordx2 v[18:19], v20, s[44:47], s65 offen sc1
v_mfma_f32_16x16x32_bf16 a[136:139], a[8:11], a[80:83], a[136:139]
s_xor_b32 s64, s71, 3768320
v_lshrrev_b32 v21, 4, v0
v_mfma_f32_16x16x32_bf16 a[136:139], a[12:15], a[84:87], a[136:139]
buffer_load_dwordx4 v15, s[36:39], s64 offen lds
v_mfma_f32_16x16x32_bf16 a[140:143], a[4:7], a[84:87], a[140:143]
v_bfe_u32 v19, v0, 2, 2
v_mfma_f32_16x16x32_bf16 a[140:143], a[0:3], a[80:83], a[140:143]
s_waitcnt lgkmcnt(5)
ds_read_b64_tr_b16 a[80:81], v9 offset:32768
v_lshl_add_u32 v19, v21, 3, v19
v_mfma_f32_16x16x32_bf16 v[184:187], a[88:91], a[32:35], v[184:187]
ds_read_b64_tr_b16 a[82:83], v9 offset:33792
v_lshlrev_b32 v19, 6, v19
v_mfma_f32_16x16x32_bf16 v[184:187], a[92:95], a[36:39], v[184:187]
ds_read_b64_tr_b16 a[84:85], v9 offset:40960
v_and_b32 v21, 1, v21
v_mfma_f32_16x16x32_bf16 v[192:195], a[92:95], a[44:47], v[192:195]
ds_read_b64_tr_b16 a[86:87], v9 offset:41984
v_lshl_add_u32 v19, v21, 5, v19
v_mfma_f32_16x16x32_bf16 v[192:195], a[88:91], a[40:43], v[192:195]
s_xor_b32 m0, s77, 114688
v_and_b32 v21, 3, v0
v_mfma_f32_16x16x32_bf16 v[200:203], a[88:91], a[48:51], v[200:203]
s_xor_b32 s64, s71, 3670016
v_lshl_add_u32 v19, v21, 3, v19
v_mfma_f32_16x16x32_bf16 v[200:203], a[92:95], a[52:55], v[200:203]
buffer_load_dwordx4 v14, s[40:43], s64 offen lds
v_mfma_f32_16x16x32_bf16 v[208:211], a[92:95], a[60:63], v[208:211]
v_add_u32 v19, 114688, v19
v_mfma_f32_16x16x32_bf16 v[208:211], a[88:91], a[56:59], v[208:211]
ds_read_b64_tr_b16 a[88:89], v10 offset:32768
v_xor_b32 v20, 32, v19
v_mfma_f32_16x16x32_bf16 v[212:215], a[96:99], a[56:59], v[212:215]
ds_read_b64_tr_b16 a[90:91], v10 offset:33792
v_mfma_f32_16x16x32_bf16 v[212:215], a[100:103], a[60:63], v[212:215]
ds_read_b64_tr_b16 a[92:93], v10 offset:40960
v_mfma_f32_16x16x32_bf16 v[204:207], a[100:103], a[52:55], v[204:207]
ds_read_b64_tr_b16 a[94:95], v10 offset:41984
v_mfma_f32_16x16x32_bf16 v[204:207], a[96:99], a[48:51], v[204:207]
s_xor_b32 m0, s77, 115712
v_mfma_f32_16x16x32_bf16 v[196:199], a[96:99], a[40:43], v[196:199]
s_xor_b32 s64, s71, 3702784
v_mfma_f32_16x16x32_bf16 v[196:199], a[100:103], a[44:47], v[196:199]
buffer_load_dwordx4 v14, s[40:43], s64 offen lds
v_mfma_f32_16x16x32_bf16 v[188:191], a[100:103], a[36:39], v[188:191]
v_mfma_f32_16x16x32_bf16 v[188:191], a[96:99], a[32:35], v[188:191]
ds_read_b64_tr_b16 a[96:97], v11 offset:32768
v_mfma_f32_16x16x32_bf16 v[216:219], a[104:107], a[32:35], v[216:219]
ds_read_b64_tr_b16 a[98:99], v11 offset:33792
v_mfma_f32_16x16x32_bf16 v[216:219], a[108:111], a[36:39], v[216:219]
ds_read_b64_tr_b16 a[100:101], v11 offset:40960
v_mfma_f32_16x16x32_bf16 v[224:227], a[108:111], a[44:47], v[224:227]
ds_read_b64_tr_b16 a[102:103], v11 offset:41984
v_mfma_f32_16x16x32_bf16 v[224:227], a[104:107], a[40:43], v[224:227]
s_xor_b32 m0, s77, 116736
s_add_u32 s81, s81, 1048576
v_mfma_f32_16x16x32_bf16 v[232:235], a[104:107], a[48:51], v[232:235]
s_xor_b32 s64, s71, 3735552
buffer_load_dword a252, v16, s[56:59], s81 offen
v_mfma_f32_16x16x32_bf16 v[232:235], a[108:111], a[52:55], v[232:235]
buffer_load_dwordx4 v15, s[40:43], s64 offen lds
v_mfma_f32_16x16x32_bf16 v[240:243], a[108:111], a[60:63], v[240:243]
v_mfma_f32_16x16x32_bf16 v[240:243], a[104:107], a[56:59], v[240:243]
ds_read_b64_tr_b16 a[104:105], v4 offset:49152
v_mfma_f32_16x16x32_bf16 v[244:247], a[112:115], a[56:59], v[244:247]
s_waitcnt lgkmcnt(5)
ds_read_b64_tr_b16 a[106:107], v4 offset:50176
v_mfma_f32_16x16x32_bf16 v[244:247], a[116:119], a[60:63], v[244:247]
ds_read_b64_tr_b16 a[108:109], v4 offset:57344
v_mfma_f32_16x16x32_bf16 v[236:239], a[116:119], a[52:55], v[236:239]
ds_read_b64_tr_b16 a[110:111], v4 offset:58368
v_mfma_f32_16x16x32_bf16 v[236:239], a[112:115], a[48:51], v[236:239]
s_xor_b32 m0, s77, 117760
v_mfma_f32_16x16x32_bf16 v[228:231], a[112:115], a[40:43], v[228:231]
s_xor_b32 s64, s71, 3768320
v_mfma_f32_16x16x32_bf16 v[228:231], a[116:119], a[44:47], v[228:231]
buffer_load_dwordx4 v15, s[40:43], s64 offen lds
v_mfma_f32_16x16x32_bf16 v[220:223], a[116:119], a[36:39], v[220:223]
v_mfma_f32_16x16x32_bf16 v[220:223], a[112:115], a[32:35], v[220:223]
ds_read_b64_tr_b16 a[112:113], v5 offset:49152
v_mfma_f32_16x16x32_bf16 v[152:155], a[72:75], a[32:35], v[152:155]
ds_read_b64_tr_b16 a[114:115], v5 offset:50176
v_mfma_f32_16x16x32_bf16 v[152:155], a[76:79], a[36:39], v[152:155]
ds_read_b64_tr_b16 a[116:117], v5 offset:57344
v_mfma_f32_16x16x32_bf16 v[160:163], a[76:79], a[44:47], v[160:163]
ds_read_b64_tr_b16 a[118:119], v5 offset:58368
v_mfma_f32_16x16x32_bf16 v[160:163], a[72:75], a[40:43], v[160:163]
v_mfma_f32_16x16x32_bf16 v[168:171], a[72:75], a[48:51], v[168:171]
v_mfma_f32_16x16x32_bf16 v[168:171], a[76:79], a[52:55], v[168:171]
v_mfma_f32_16x16x32_bf16 v[176:179], a[76:79], a[60:63], v[176:179]
s_xor_b32 m0, s84, 32768
v_mfma_f32_16x16x32_bf16 v[176:179], a[72:75], a[56:59], v[176:179]
s_xor_b32 s64, s70, 896
ds_read_b64_tr_b16 a[72:73], v6 offset:49152
v_mfma_f32_16x16x32_bf16 v[180:183], a[80:83], a[56:59], v[180:183]
buffer_load_dwordx4 v12, s[32:35], s64 offen lds
v_mfma_f32_16x16x32_bf16 v[180:183], a[84:87], a[60:63], v[180:183]
ds_read_b64_tr_b16 a[74:75], v6 offset:50176
v_mfma_f32_16x16x32_bf16 v[172:175], a[84:87], a[52:55], v[172:175]
ds_read_b64_tr_b16 a[76:77], v6 offset:57344
v_mfma_f32_16x16x32_bf16 v[172:175], a[80:83], a[48:51], v[172:175]
ds_read_b64_tr_b16 a[78:79], v6 offset:58368
v_mfma_f32_16x16x32_bf16 v[164:167], a[80:83], a[40:43], v[164:167]
v_mfma_f32_16x16x32_bf16 v[164:167], a[84:87], a[44:47], v[164:167]
s_xor_b32 m0, s84, 33792
v_mfma_f32_16x16x32_bf16 v[156:159], a[84:87], a[36:39], v[156:159]
s_xor_b32 s64, s70, 9088
v_mfma_f32_16x16x32_bf16 v[156:159], a[80:83], a[32:35], v[156:159]
buffer_load_dwordx4 v13, s[32:35], s64 offen lds
v_mfma_f32_16x16x32_bf16 v[24:27], a[88:91], a[32:35], v[24:27]
ds_read_b64_tr_b16 a[80:81], v7 offset:49152
v_mfma_f32_16x16x32_bf16 v[24:27], a[92:95], a[36:39], v[24:27]
ds_read_b64_tr_b16 a[82:83], v7 offset:50176
v_mfma_f32_16x16x32_bf16 v[40:43], a[92:95], a[44:47], v[40:43]
ds_read_b64_tr_b16 a[84:85], v7 offset:57344
v_mfma_f32_16x16x32_bf16 v[40:43], a[88:91], a[40:43], v[40:43]
ds_read_b64_tr_b16 a[86:87], v7 offset:58368
v_mfma_f32_16x16x32_bf16 v[56:59], a[88:91], a[48:51], v[56:59]
s_xor_b32 m0, s84, 34816
v_mfma_f32_16x16x32_bf16 v[56:59], a[92:95], a[52:55], v[56:59]
s_xor_b32 s64, s70, 17280
v_mfma_f32_16x16x32_bf16 v[72:75], a[92:95], a[60:63], v[72:75]
s_waitcnt vmcnt(13)
buffer_load_dwordx4 v12, s[32:35], s64 offen lds
v_mfma_f32_16x16x32_bf16 v[72:75], a[88:91], a[56:59], v[72:75]
s_waitcnt lgkmcnt(4)
ds_read_b64_tr_b16 a[88:89], v8 offset:49152
v_mfma_f32_16x16x32_bf16 v[136:139], a[96:99], a[56:59], v[136:139]
ds_read_b64_tr_b16 a[90:91], v8 offset:50176
v_mfma_f32_16x16x32_bf16 v[136:139], a[100:103], a[60:63], v[136:139]
ds_read_b64_tr_b16 a[92:93], v8 offset:57344
v_subrev_u32 v4, 0x8000, v4
v_mfma_f32_16x16x32_bf16 v[120:123], a[100:103], a[52:55], v[120:123]
ds_read_b64_tr_b16 a[94:95], v8 offset:58368
v_mfma_f32_16x16x32_bf16 v[120:123], a[96:99], a[48:51], v[120:123]
s_xor_b32 m0, s84, 35840
s_add_u32 s81, s81, 1048576
ds_read_b128 a[0:3], v2 offset:0
v_mfma_f32_16x16x32_bf16 v[104:107], a[96:99], a[40:43], v[104:107]
s_xor_b32 s64, s70, 25472
buffer_load_dword a252, v16, s[56:59], s81 offen
v_mfma_f32_16x16x32_bf16 v[104:107], a[100:103], a[44:47], v[104:107]
buffer_load_dwordx4 v13, s[32:35], s64 offen lds
v_mfma_f32_16x16x32_bf16 v[88:91], a[100:103], a[36:39], v[88:91]
ds_read_b128 a[4:7], v3 offset:0
v_mfma_f32_16x16x32_bf16 v[88:91], a[96:99], a[32:35], v[88:91]
ds_read_b128 a[8:11], v2 offset:2048
v_mfma_f32_16x16x32_bf16 v[28:31], a[32:35], a[104:107], v[28:31]
ds_read_b128 a[12:15], v3 offset:2048
v_mfma_f32_16x16x32_bf16 v[28:31], a[36:39], a[108:111], v[28:31]
ds_read_b128 a[16:19], v2 offset:4096
v_subrev_u32 v5, 0x8000, v5
v_mfma_f32_16x16x32_bf16 v[44:47], a[44:47], a[108:111], v[44:47]
s_xor_b32 m0, s84, 36864
ds_read_b128 a[20:23], v3 offset:4096
v_mfma_f32_16x16x32_bf16 v[44:47], a[40:43], a[104:107], v[44:47]
s_xor_b32 s64, s70, 33664
ds_read_b128 a[24:27], v2 offset:6144
v_mfma_f32_16x16x32_bf16 v[60:63], a[48:51], a[104:107], v[60:63]
buffer_load_dwordx4 v12, s[32:35], s64 offen lds
v_mfma_f32_16x16x32_bf16 v[60:63], a[52:55], a[108:111], v[60:63]
ds_read_b128 a[28:31], v3 offset:6144
v_mfma_f32_16x16x32_bf16 v[76:79], a[60:63], a[108:111], v[76:79]
ds_read_b64_tr_b16 a[96:97], v9 offset:49152
v_mfma_f32_16x16x32_bf16 v[76:79], a[56:59], a[104:107], v[76:79]
ds_read_b64_tr_b16 a[98:99], v9 offset:50176
v_mfma_f32_16x16x32_bf16 v[140:143], a[56:59], a[112:115], v[140:143]
ds_read_b64_tr_b16 a[100:101], v9 offset:57344
v_mfma_f32_16x16x32_bf16 v[140:143], a[60:63], a[116:119], v[140:143]
s_xor_b32 m0, s84, 37888
ds_read_b64_tr_b16 a[102:103], v9 offset:58368
v_subrev_u32 v6, 0x8000, v6
v_mfma_f32_16x16x32_bf16 v[124:127], a[52:55], a[116:119], v[124:127]
s_xor_b32 s64, s70, 41856
ds_read_b64_tr_b16 a[104:105], v10 offset:49152
v_mfma_f32_16x16x32_bf16 v[124:127], a[48:51], a[112:115], v[124:127]
buffer_load_dwordx4 v13, s[32:35], s64 offen lds
v_mfma_f32_16x16x32_bf16 v[108:111], a[40:43], a[112:115], v[108:111]
ds_read_b64_tr_b16 a[106:107], v10 offset:50176
v_mfma_f32_16x16x32_bf16 v[108:111], a[44:47], a[116:119], v[108:111]
ds_read_b64_tr_b16 a[108:109], v10 offset:57344
v_mfma_f32_16x16x32_bf16 v[92:95], a[36:39], a[116:119], v[92:95]
ds_read_b64_tr_b16 a[110:111], v10 offset:58368
v_mfma_f32_16x16x32_bf16 v[92:95], a[32:35], a[112:115], v[92:95]
ds_read_b64_tr_b16 a[112:113], v11 offset:49152
v_mfma_f32_16x16x32_bf16 v[32:35], a[32:35], a[72:75], v[32:35]
s_xor_b32 m0, s84, 38912
ds_read_b64_tr_b16 a[114:115], v11 offset:50176
v_mfma_f32_16x16x32_bf16 v[32:35], a[36:39], a[76:79], v[32:35]
s_xor_b32 s64, s70, 50048
ds_read_b64_tr_b16 a[116:117], v11 offset:57344
v_subrev_u32 v7, 0x8000, v7
v_mfma_f32_16x16x32_bf16 v[48:51], a[44:47], a[76:79], v[48:51]
buffer_load_dwordx4 v12, s[32:35], s64 offen lds
v_mfma_f32_16x16x32_bf16 v[48:51], a[40:43], a[72:75], v[48:51]
ds_read_b64_tr_b16 a[118:119], v11 offset:58368
v_mfma_f32_16x16x32_bf16 v[64:67], a[48:51], a[72:75], v[64:67]
v_mfma_f32_16x16x32_bf16 v[64:67], a[52:55], a[76:79], v[64:67]
v_mfma_f32_16x16x32_bf16 v[80:83], a[60:63], a[76:79], v[80:83]
v_mfma_f32_16x16x32_bf16 v[80:83], a[56:59], a[72:75], v[80:83]
s_waitcnt lgkmcnt(5)
s_xor_b32 m0, s84, 39936
v_mfma_f32_16x16x32_bf16 v[144:147], a[56:59], a[80:83], v[144:147]
s_xor_b32 s64, s70, 58240
v_mfma_f32_16x16x32_bf16 v[144:147], a[60:63], a[84:87], v[144:147]
buffer_load_dwordx4 v13, s[32:35], s64 offen lds
v_mfma_f32_16x16x32_bf16 v[128:131], a[52:55], a[84:87], v[128:131]
v_subrev_u32 v8, 0x8000, v8
v_mfma_f32_16x16x32_bf16 v[128:131], a[48:51], a[80:83], v[128:131]
v_mfma_f32_16x16x32_bf16 v[112:115], a[40:43], a[80:83], v[112:115]
v_mfma_f32_16x16x32_bf16 v[112:115], a[44:47], a[84:87], v[112:115]
v_mfma_f32_16x16x32_bf16 v[96:99], a[36:39], a[84:87], v[96:99]
s_and_b32 s77, s77, 0x3fff
v_subrev_u32 v9, 0x8000, v9
v_subrev_u32 v10, 0x8000, v10
v_mfma_f32_16x16x32_bf16 v[96:99], a[32:35], a[80:83], v[96:99]
v_subrev_u32 v11, 0x8000, v11
v_mfma_f32_16x16x32_bf16 v[36:39], a[32:35], a[88:91], v[36:39]
v_mfma_f32_16x16x32_bf16 v[36:39], a[36:39], a[92:95], v[36:39]
v_mfma_f32_16x16x32_bf16 v[52:55], a[44:47], a[92:95], v[52:55]
s_waitcnt lgkmcnt(0)
s_barrier
v_mfma_f32_16x16x32_bf16 v[52:55], a[40:43], a[88:91], v[52:55]
s_xor_b32 m0, s77, 131072
s_add_u32 s82, s82, 1048576
ds_read_b64_tr_b16 a[72:73], v4 offset:0
v_mfma_f32_16x16x32_bf16 v[68:71], a[48:51], a[88:91], v[68:71]
s_xor_b32 s64, s71, 0
buffer_load_dword a252, v1, s[60:63], s82 offen
v_mfma_f32_16x16x32_bf16 v[68:71], a[52:55], a[92:95], v[68:71]
buffer_load_dwordx4 v14, s[56:59], s64 offen lds
v_mfma_f32_16x16x32_bf16 v[84:87], a[60:63], a[92:95], v[84:87]
ds_read_b64_tr_b16 a[74:75], v4 offset:1024
v_mfma_f32_16x16x32_bf16 v[84:87], a[56:59], a[88:91], v[84:87]
ds_read_b64_tr_b16 a[76:77], v4 offset:8192
v_mfma_f32_16x16x32_bf16 v[148:151], a[56:59], a[96:99], v[148:151]
ds_read_b64_tr_b16 a[78:79], v4 offset:9216
v_lshrrev_b32 v13, 3, v0
v_mfma_f32_16x16x32_bf16 v[148:151], a[60:63], a[100:103], v[148:151]
ds_read_b64_tr_b16 a[80:81], v5 offset:0
v_lshl_add_u32 v12, v13, 10, v12
v_mfma_f32_16x16x32_bf16 v[132:135], a[52:55], a[100:103], v[132:135]
ds_read_b64_tr_b16 a[82:83], v5 offset:1024
v_xor_b32 v13, 64, v12
v_mfma_f32_16x16x32_bf16 v[132:135], a[48:51], a[96:99], v[132:135]
ds_read_b64_tr_b16 a[84:85], v5 offset:8192
v_mfma_f32_16x16x32_bf16 v[116:119], a[40:43], a[96:99], v[116:119]
s_add_u32 m0, s78, 147456
ds_read_b64_tr_b16 a[86:87], v5 offset:9216
v_mfma_f32_16x16x32_bf16 v[116:119], a[44:47], a[100:103], v[116:119]
s_add_u32 s64, s75, 0
ds_read_b64_tr_b16 a[88:89], v6 offset:0
v_mfma_f32_16x16x32_bf16 v[100:103], a[36:39], a[100:103], v[100:103]
buffer_load_dwordx4 v23, s[60:63], s64 offen lds
v_mfma_f32_16x16x32_bf16 v[100:103], a[32:35], a[96:99], v[100:103]
ds_read_b64_tr_b16 a[90:91], v6 offset:1024
v_mfma_f32_16x16x32_bf16 v[248:251], a[32:35], a[104:107], v[248:251]
ds_read_b64_tr_b16 a[92:93], v6 offset:8192
v_mfma_f32_16x16x32_bf16 v[248:251], a[36:39], a[108:111], v[248:251]
ds_read_b64_tr_b16 a[94:95], v6 offset:9216
v_mfma_f32_16x16x32_bf16 v[252:255], a[44:47], a[108:111], v[252:255]
ds_read_b64_tr_b16 a[96:97], v7 offset:0
v_mfma_f32_16x16x32_bf16 v[252:255], a[40:43], a[104:107], v[252:255]
ds_read_b64_tr_b16 a[98:99], v7 offset:1024
v_mfma_f32_16x16x32_bf16 a[120:123], a[48:51], a[104:107], a[120:123]
ds_read_b64_tr_b16 a[100:101], v7 offset:8192
v_mfma_f32_16x16x32_bf16 a[120:123], a[52:55], a[108:111], a[120:123]
s_xor_b32 m0, s77, 132096
ds_read_b64_tr_b16 a[102:103], v7 offset:9216
v_mfma_f32_16x16x32_bf16 a[124:127], a[60:63], a[108:111], a[124:127]
s_xor_b32 s64, s71, 32768
v_mfma_f32_16x16x32_bf16 a[124:127], a[56:59], a[104:107], a[124:127]
buffer_load_dwordx4 v14, s[56:59], s64 offen lds
v_mfma_f32_16x16x32_bf16 a[128:131], a[56:59], a[112:115], a[128:131]
ds_read_b64_tr_b16 a[104:105], v8 offset:0
v_mfma_f32_16x16x32_bf16 a[128:131], a[60:63], a[116:119], a[128:131]
ds_read_b64_tr_b16 a[106:107], v8 offset:1024
v_mfma_f32_16x16x32_bf16 a[132:135], a[52:55], a[116:119], a[132:135]
ds_read_b64_tr_b16 a[108:109], v8 offset:8192
v_mfma_f32_16x16x32_bf16 a[132:135], a[48:51], a[112:115], a[132:135]
ds_read_b64_tr_b16 a[110:111], v8 offset:9216
v_mfma_f32_16x16x32_bf16 a[136:139], a[40:43], a[112:115], a[136:139]
v_mfma_f32_16x16x32_bf16 a[136:139], a[44:47], a[116:119], a[136:139]
v_mfma_f32_16x16x32_bf16 a[140:143], a[36:39], a[116:119], a[140:143]
s_add_u32 m0, s78, 151552
v_mfma_f32_16x16x32_bf16 a[140:143], a[32:35], a[112:115], a[140:143]
s_waitcnt lgkmcnt(4)
s_add_u32 s64, s75, 2048
ds_read_b64_tr_b16 a[112:113], v9 offset:0
v_mfma_f32_16x16x32_bf16 v[184:187], a[72:75], a[0:3], v[184:187]
buffer_load_dwordx4 v23, s[60:63], s64 offen lds
v_mfma_f32_16x16x32_bf16 v[184:187], a[76:79], a[4:7], v[184:187]
ds_read_b64_tr_b16 a[114:115], v9 offset:1024
v_mfma_f32_16x16x32_bf16 v[192:195], a[76:79], a[12:15], v[192:195]
ds_read_b64_tr_b16 a[116:117], v9 offset:8192
v_mfma_f32_16x16x32_bf16 v[192:195], a[72:75], a[8:11], v[192:195]
ds_read_b64_tr_b16 a[118:119], v9 offset:9216
v_mfma_f32_16x16x32_bf16 v[200:203], a[72:75], a[16:19], v[200:203]
v_mfma_f32_16x16x32_bf16 v[200:203], a[76:79], a[20:23], v[200:203]
v_mfma_f32_16x16x32_bf16 v[208:211], a[76:79], a[28:31], v[208:211]
v_mfma_f32_16x16x32_bf16 v[208:211], a[72:75], a[24:27], v[208:211]
ds_read_b64_tr_b16 a[72:73], v10 offset:0
v_mfma_f32_16x16x32_bf16 v[212:215], a[80:83], a[24:27], v[212:215]
s_xor_b32 m0, s77, 133120
ds_read_b64_tr_b16 a[74:75], v10 offset:1024
v_mfma_f32_16x16x32_bf16 v[212:215], a[84:87], a[28:31], v[212:215]
s_xor_b32 s64, s71, 65536
ds_read_b64_tr_b16 a[76:77], v10 offset:8192
v_mfma_f32_16x16x32_bf16 v[204:207], a[84:87], a[20:23], v[204:207]
buffer_load_dwordx4 v15, s[56:59], s64 offen lds
v_mfma_f32_16x16x32_bf16 v[204:207], a[80:83], a[16:19], v[204:207]
s_add_u32 s81, s81, 1048576
ds_read_b64_tr_b16 a[78:79], v10 offset:9216
v_mfma_f32_16x16x32_bf16 v[196:199], a[80:83], a[8:11], v[196:199]
buffer_load_dword a252, v16, s[56:59], s81 offen
v_mfma_f32_16x16x32_bf16 v[196:199], a[84:87], a[12:15], v[196:199]
v_mfma_f32_16x16x32_bf16 v[188:191], a[84:87], a[4:7], v[188:191]
v_mfma_f32_16x16x32_bf16 v[188:191], a[80:83], a[0:3], v[188:191]
ds_read_b64_tr_b16 a[80:81], v11 offset:0
v_mfma_f32_16x16x32_bf16 v[216:219], a[88:91], a[0:3], v[216:219]
ds_read_b64_tr_b16 a[82:83], v11 offset:1024
v_mfma_f32_16x16x32_bf16 v[216:219], a[92:95], a[4:7], v[216:219]
s_add_u32 m0, s78, 155648
ds_read_b64_tr_b16 a[84:85], v11 offset:8192
v_mfma_f32_16x16x32_bf16 v[224:227], a[92:95], a[12:15], v[224:227]
s_add_u32 s64, s75, 4096
ds_read_b64_tr_b16 a[86:87], v11 offset:9216
v_mfma_f32_16x16x32_bf16 v[224:227], a[88:91], a[8:11], v[224:227]
buffer_load_dwordx4 v23, s[60:63], s64 offen lds
v_mfma_f32_16x16x32_bf16 v[232:235], a[88:91], a[16:19], v[232:235]
v_mfma_f32_16x16x32_bf16 v[232:235], a[92:95], a[20:23], v[232:235]
v_mfma_f32_16x16x32_bf16 v[240:243], a[92:95], a[28:31], v[240:243]
v_mfma_f32_16x16x32_bf16 v[240:243], a[88:91], a[24:27], v[240:243]
ds_read_b64_tr_b16 a[88:89], v4 offset:16384
v_mfma_f32_16x16x32_bf16 v[244:247], a[96:99], a[24:27], v[244:247]
ds_read_b64_tr_b16 a[90:91], v4 offset:17408
v_mfma_f32_16x16x32_bf16 v[244:247], a[100:103], a[28:31], v[244:247]
ds_read_b64_tr_b16 a[92:93], v4 offset:24576
v_mfma_f32_16x16x32_bf16 v[236:239], a[100:103], a[20:23], v[236:239]
s_xor_b32 m0, s77, 134144
ds_read_b64_tr_b16 a[94:95], v4 offset:25600
v_mfma_f32_16x16x32_bf16 v[236:239], a[96:99], a[16:19], v[236:239]
s_xor_b32 s64, s71, 98304
v_mfma_f32_16x16x32_bf16 v[228:231], a[96:99], a[8:11], v[228:231]
buffer_load_dwordx4 v15, s[56:59], s64 offen lds
v_mfma_f32_16x16x32_bf16 v[228:231], a[100:103], a[12:15], v[228:231]
v_mfma_f32_16x16x32_bf16 v[220:223], a[100:103], a[4:7], v[220:223]
v_mfma_f32_16x16x32_bf16 v[220:223], a[96:99], a[0:3], v[220:223]
s_waitcnt lgkmcnt(4)
ds_read_b64_tr_b16 a[96:97], v5 offset:16384
v_mfma_f32_16x16x32_bf16 v[152:155], a[104:107], a[0:3], v[152:155]
ds_read_b64_tr_b16 a[98:99], v5 offset:17408
v_mfma_f32_16x16x32_bf16 v[152:155], a[108:111], a[4:7], v[152:155]
ds_read_b64_tr_b16 a[100:101], v5 offset:24576
v_mfma_f32_16x16x32_bf16 v[160:163], a[108:111], a[12:15], v[160:163]
ds_read_b64_tr_b16 a[102:103], v5 offset:25600
v_mfma_f32_16x16x32_bf16 v[160:163], a[104:107], a[8:11], v[160:163]
v_mfma_f32_16x16x32_bf16 v[168:171], a[104:107], a[16:19], v[168:171]
v_mfma_f32_16x16x32_bf16 v[168:171], a[108:111], a[20:23], v[168:171]
v_mfma_f32_16x16x32_bf16 v[176:179], a[108:111], a[28:31], v[176:179]
s_xor_b32 m0, s84, 0
v_mfma_f32_16x16x32_bf16 v[176:179], a[104:107], a[24:27], v[176:179]
s_xor_b32 s64, s72, 0
ds_read_b64_tr_b16 a[104:105], v6 offset:16384
v_mfma_f32_16x16x32_bf16 v[180:183], a[112:115], a[24:27], v[180:183]
buffer_load_dwordx4 v12, s[48:51], s64 offen lds
v_mfma_f32_16x16x32_bf16 v[180:183], a[116:119], a[28:31], v[180:183]
ds_read_b64_tr_b16 a[106:107], v6 offset:17408
v_mfma_f32_16x16x32_bf16 v[172:175], a[116:119], a[20:23], v[172:175]
ds_read_b64_tr_b16 a[108:109], v6 offset:24576
v_mfma_f32_16x16x32_bf16 v[172:175], a[112:115], a[16:19], v[172:175]
ds_read_b64_tr_b16 a[110:111], v6 offset:25600
v_mfma_f32_16x16x32_bf16 v[164:167], a[112:115], a[8:11], v[164:167]
v_mfma_f32_16x16x32_bf16 v[164:167], a[116:119], a[12:15], v[164:167]
s_xor_b32 m0, s84, 1024
v_mfma_f32_16x16x32_bf16 v[156:159], a[116:119], a[4:7], v[156:159]
s_xor_b32 s64, s72, 16384
v_mfma_f32_16x16x32_bf16 v[156:159], a[112:115], a[0:3], v[156:159]
buffer_load_dwordx4 v13, s[48:51], s64 offen lds
v_mfma_f32_16x16x32_bf16 v[24:27], a[72:75], a[0:3], v[24:27]
ds_read_b64_tr_b16 a[112:113], v7 offset:16384
v_mfma_f32_16x16x32_bf16 v[24:27], a[76:79], a[4:7], v[24:27]
ds_read_b64_tr_b16 a[114:115], v7 offset:17408
v_mfma_f32_16x16x32_bf16 v[40:43], a[76:79], a[12:15], v[40:43]
ds_read_b64_tr_b16 a[116:117], v7 offset:24576
v_mfma_f32_16x16x32_bf16 v[40:43], a[72:75], a[8:11], v[40:43]
s_add_u32 s82, s82, 1048576
ds_read_b64_tr_b16 a[118:119], v7 offset:25600
v_mfma_f32_16x16x32_bf16 v[56:59], a[72:75], a[16:19], v[56:59]
s_xor_b32 m0, s84, 2048
buffer_load_dword a252, v1, s[60:63], s82 offen
v_mfma_f32_16x16x32_bf16 v[56:59], a[76:79], a[20:23], v[56:59]
s_xor_b32 s64, s72, 131072
v_mfma_f32_16x16x32_bf16 v[72:75], a[76:79], a[28:31], v[72:75]
s_waitcnt vmcnt(12)
buffer_load_dwordx4 v12, s[48:51], s64 offen lds
v_mfma_f32_16x16x32_bf16 v[72:75], a[72:75], a[24:27], v[72:75]
ds_read_b64_tr_b16 a[72:73], v8 offset:16384
v_mfma_f32_16x16x32_bf16 v[136:139], a[80:83], a[24:27], v[136:139]
ds_read_b64_tr_b16 a[74:75], v8 offset:17408
v_mfma_f32_16x16x32_bf16 v[136:139], a[84:87], a[28:31], v[136:139]
ds_read_b64_tr_b16 a[76:77], v8 offset:24576
v_mfma_f32_16x16x32_bf16 v[120:123], a[84:87], a[20:23], v[120:123]
ds_read_b64_tr_b16 a[78:79], v8 offset:25600
v_mfma_f32_16x16x32_bf16 v[120:123], a[80:83], a[16:19], v[120:123]
s_xor_b32 m0, s84, 3072
ds_read_b128 a[32:35], v2 offset:32768
v_mfma_f32_16x16x32_bf16 v[104:107], a[80:83], a[8:11], v[104:107]
s_xor_b32 s64, s72, 147456
ds_read_b128 a[36:39], v3 offset:32768
v_mfma_f32_16x16x32_bf16 v[104:107], a[84:87], a[12:15], v[104:107]
buffer_load_dwordx4 v13, s[48:51], s64 offen lds
v_mfma_f32_16x16x32_bf16 v[88:91], a[84:87], a[4:7], v[88:91]
ds_read_b128 a[40:43], v2 offset:34816
v_mfma_f32_16x16x32_bf16 v[88:91], a[80:83], a[0:3], v[88:91]
s_waitcnt lgkmcnt(7)
ds_read_b128 a[44:47], v3 offset:34816
v_mfma_f32_16x16x32_bf16 v[28:31], a[0:3], a[88:91], v[28:31]
ds_read_b128 a[48:51], v2 offset:36864
v_mfma_f32_16x16x32_bf16 v[28:31], a[4:7], a[92:95], v[28:31]
ds_read_b128 a[52:55], v3 offset:36864
v_mfma_f32_16x16x32_bf16 v[44:47], a[12:15], a[92:95], v[44:47]
s_xor_b32 m0, s84, 4096
ds_read_b128 a[56:59], v2 offset:38912
v_mfma_f32_16x16x32_bf16 v[44:47], a[8:11], a[88:91], v[44:47]
s_xor_b32 s64, s73, 0
ds_read_b128 a[60:63], v3 offset:38912
v_mfma_f32_16x16x32_bf16 v[60:63], a[16:19], a[88:91], v[60:63]
buffer_load_dwordx4 v12, s[48:51], s64 offen lds
v_mfma_f32_16x16x32_bf16 v[60:63], a[20:23], a[92:95], v[60:63]
ds_read_b64_tr_b16 a[80:81], v9 offset:16384
v_mfma_f32_16x16x32_bf16 v[76:79], a[28:31], a[92:95], v[76:79]
ds_read_b64_tr_b16 a[82:83], v9 offset:17408
v_mfma_f32_16x16x32_bf16 v[76:79], a[24:27], a[88:91], v[76:79]
ds_read_b64_tr_b16 a[84:85], v9 offset:24576
v_mfma_f32_16x16x32_bf16 v[140:143], a[24:27], a[96:99], v[140:143]
ds_read_b64_tr_b16 a[86:87], v9 offset:25600
v_mfma_f32_16x16x32_bf16 v[140:143], a[28:31], a[100:103], v[140:143]
s_xor_b32 m0, s84, 5120
ds_read_b64_tr_b16 a[88:89], v10 offset:16384
v_mfma_f32_16x16x32_bf16 v[124:127], a[20:23], a[100:103], v[124:127]
s_xor_b32 s64, s73, 16384
ds_read_b64_tr_b16 a[90:91], v10 offset:17408
v_mfma_f32_16x16x32_bf16 v[124:127], a[16:19], a[96:99], v[124:127]
buffer_load_dwordx4 v13, s[48:51], s64 offen lds
v_mfma_f32_16x16x32_bf16 v[108:111], a[8:11], a[96:99], v[108:111]
s_branch L_po5
L_pg5:
s_branch L_tr0
L_po5:
ds_read_b64_tr_b16 a[92:93], v10 offset:24576
v_mfma_f32_16x16x32_bf16 v[108:111], a[12:15], a[100:103], v[108:111]
ds_read_b64_tr_b16 a[94:95], v10 offset:25600
v_mfma_f32_16x16x32_bf16 v[92:95], a[4:7], a[100:103], v[92:95]
v_mfma_f32_16x16x32_bf16 v[92:95], a[0:3], a[96:99], v[92:95]
ds_read_b64_tr_b16 a[96:97], v11 offset:16384
v_mfma_f32_16x16x32_bf16 v[32:35], a[0:3], a[104:107], v[32:35]
s_xor_b32 m0, s84, 6144
ds_read_b64_tr_b16 a[98:99], v11 offset:17408
v_mfma_f32_16x16x32_bf16 v[32:35], a[4:7], a[108:111], v[32:35]
s_xor_b32 s64, s73, 131072
ds_read_b64_tr_b16 a[100:101], v11 offset:24576
v_mfma_f32_16x16x32_bf16 v[48:51], a[12:15], a[108:111], v[48:51]
buffer_load_dwordx4 v12, s[48:51], s64 offen lds
v_mfma_f32_16x16x32_bf16 v[48:51], a[8:11], a[104:107], v[48:51]
ds_read_b64_tr_b16 a[102:103], v11 offset:25600
v_mfma_f32_16x16x32_bf16 v[64:67], a[16:19], a[104:107], v[64:67]
v_mfma_f32_16x16x32_bf16 v[64:67], a[20:23], a[108:111], v[64:67]
v_mfma_f32_16x16x32_bf16 v[80:83], a[28:31], a[108:111], v[80:83]
v_mfma_f32_16x16x32_bf16 v[80:83], a[24:27], a[104:107], v[80:83]
s_xor_b32 m0, s84, 7168
v_mfma_f32_16x16x32_bf16 v[144:147], a[24:27], a[112:115], v[144:147]
s_xor_b32 s64, s73, 147456
v_mfma_f32_16x16x32_bf16 v[144:147], a[28:31], a[116:119], v[144:147]
buffer_load_dwordx4 v13, s[48:51], s64 offen lds
v_mfma_f32_16x16x32_bf16 v[128:131], a[20:23], a[116:119], v[128:131]
v_mfma_f32_16x16x32_bf16 v[128:131], a[16:19], a[112:115], v[128:131]
v_mfma_f32_16x16x32_bf16 v[112:115], a[8:11], a[112:115], v[112:115]
v_mfma_f32_16x16x32_bf16 v[112:115], a[12:15], a[116:119], v[112:115]
v_mfma_f32_16x16x32_bf16 v[96:99], a[4:7], a[116:119], v[96:99]
v_mfma_f32_16x16x32_bf16 v[96:99], a[0:3], a[112:115], v[96:99]
s_waitcnt lgkmcnt(0)
v_mfma_f32_16x16x32_bf16 v[36:39], a[0:3], a[72:75], v[36:39]
v_mfma_f32_16x16x32_bf16 v[36:39], a[4:7], a[76:79], v[36:39]
v_mfma_f32_16x16x32_bf16 v[52:55], a[12:15], a[76:79], v[52:55]
s_waitcnt lgkmcnt(0)
s_barrier
v_mfma_f32_16x16x32_bf16 v[52:55], a[8:11], a[72:75], v[52:55]
s_xor_b32 m0, s77, 65536
ds_read_b64_tr_b16 a[104:105], v4 offset:32768
v_mfma_f32_16x16x32_bf16 v[68:71], a[16:19], a[72:75], v[68:71]
s_xor_b32 s64, s71, 524288
ds_read_b64_tr_b16 a[106:107], v4 offset:33792
v_mfma_f32_16x16x32_bf16 v[68:71], a[20:23], a[76:79], v[68:71]
buffer_load_dwordx4 v14, s[56:59], s64 offen lds
v_mfma_f32_16x16x32_bf16 v[84:87], a[28:31], a[76:79], v[84:87]
ds_read_b64_tr_b16 a[108:109], v4 offset:40960
v_mfma_f32_16x16x32_bf16 v[84:87], a[24:27], a[72:75], v[84:87]
ds_read_b64_tr_b16 a[110:111], v4 offset:41984
v_mfma_f32_16x16x32_bf16 v[148:151], a[24:27], a[80:83], v[148:151]
ds_read_b64_tr_b16 a[112:113], v5 offset:32768
v_mfma_f32_16x16x32_bf16 v[148:151], a[28:31], a[84:87], v[148:151]
ds_read_b64_tr_b16 a[114:115], v5 offset:33792
v_mfma_f32_16x16x32_bf16 v[132:135], a[20:23], a[84:87], v[132:135]
ds_read_b64_tr_b16 a[116:117], v5 offset:40960
v_mfma_f32_16x16x32_bf16 v[132:135], a[16:19], a[80:83], v[132:135]
ds_read_b64_tr_b16 a[118:119], v5 offset:41984
v_mfma_f32_16x16x32_bf16 v[116:119], a[8:11], a[80:83], v[116:119]
s_add_u32 m0, s78, 81920
ds_read_b64_tr_b16 a[72:73], v6 offset:32768
v_mfma_f32_16x16x32_bf16 v[116:119], a[12:15], a[84:87], v[116:119]
s_add_u32 s64, s75, 393216
ds_read_b64_tr_b16 a[74:75], v6 offset:33792
v_mfma_f32_16x16x32_bf16 v[100:103], a[4:7], a[84:87], v[100:103]
buffer_load_dwordx4 v23, s[60:63], s64 offen lds
v_mfma_f32_16x16x32_bf16 v[100:103], a[0:3], a[80:83], v[100:103]
ds_read_b64_tr_b16 a[76:77], v6 offset:40960
v_mfma_f32_16x16x32_bf16 v[248:251], a[0:3], a[88:91], v[248:251]
ds_read_b64_tr_b16 a[78:79], v6 offset:41984
v_mfma_f32_16x16x32_bf16 v[248:251], a[4:7], a[92:95], v[248:251]
ds_read_b64_tr_b16 a[80:81], v7 offset:32768
v_mfma_f32_16x16x32_bf16 v[252:255], a[12:15], a[92:95], v[252:255]
ds_read_b64_tr_b16 a[82:83], v7 offset:33792
v_mfma_f32_16x16x32_bf16 v[252:255], a[8:11], a[88:91], v[252:255]
ds_read_b64_tr_b16 a[84:85], v7 offset:40960
v_mfma_f32_16x16x32_bf16 a[120:123], a[16:19], a[88:91], a[120:123]
ds_read_b64_tr_b16 a[86:87], v7 offset:41984
v_mfma_f32_16x16x32_bf16 a[120:123], a[20:23], a[92:95], a[120:123]
s_xor_b32 m0, s77, 66560
v_mfma_f32_16x16x32_bf16 a[124:127], a[28:31], a[92:95], a[124:127]
s_xor_b32 s64, s71, 557056
v_mfma_f32_16x16x32_bf16 a[124:127], a[24:27], a[88:91], a[124:127]
buffer_load_dwordx4 v14, s[56:59], s64 offen lds
v_mfma_f32_16x16x32_bf16 a[128:131], a[24:27], a[96:99], a[128:131]
ds_read_b64_tr_b16 a[88:89], v8 offset:32768
v_mfma_f32_16x16x32_bf16 a[128:131], a[28:31], a[100:103], a[128:131]
ds_read_b64_tr_b16 a[90:91], v8 offset:33792
v_mfma_f32_16x16x32_bf16 a[132:135], a[20:23], a[100:103], a[132:135]
ds_read_b64_tr_b16 a[92:93], v8 offset:40960
v_mfma_f32_16x16x32_bf16 a[132:135], a[16:19], a[96:99], a[132:135]
ds_read_b64_tr_b16 a[94:95], v8 offset:41984
v_mfma_f32_16x16x32_bf16 a[136:139], a[8:11], a[96:99], a[136:139]
v_mfma_f32_16x16x32_bf16 a[136:139], a[12:15], a[100:103], a[136:139]
v_mfma_f32_16x16x32_bf16 a[140:143], a[4:7], a[100:103], a[140:143]
s_add_u32 m0, s78, 86016
v_mfma_f32_16x16x32_bf16 a[140:143], a[0:3], a[96:99], a[140:143]
s_waitcnt lgkmcnt(4)
s_add_u32 s64, s75, 395264
ds_read_b64_tr_b16 a[96:97], v9 offset:32768
v_mfma_f32_16x16x32_bf16 v[184:187], a[104:107], a[32:35], v[184:187]
s_lshl_b32 s66, s30, 30
buffer_load_dwordx4 v23, s[60:63], s64 offen lds
v_mfma_f32_16x16x32_bf16 v[184:187], a[108:111], a[36:39], v[184:187]
ds_read_b64_tr_b16 a[98:99], v9 offset:33792
v_lshl_add_u32 v1, v0, 24, s66
v_mfma_f32_16x16x32_bf16 v[192:195], a[108:111], a[44:47], v[192:195]
s_lshr_b32 s66, s3, 1
ds_read_b64_tr_b16 a[100:101], v9 offset:40960
v_mfma_f32_16x16x32_bf16 v[192:195], a[104:107], a[40:43], v[192:195]
s_lshl_b32 s66, s66, 12
ds_read_b64_tr_b16 a[102:103], v9 offset:41984
v_mfma_f32_16x16x32_bf16 v[200:203], a[104:107], a[48:51], v[200:203]
v_mfma_f32_16x16x32_bf16 v[200:203], a[108:111], a[52:55], v[200:203]
v_mfma_f32_16x16x32_bf16 v[208:211], a[108:111], a[60:63], v[208:211]
v_mfma_f32_16x16x32_bf16 v[208:211], a[104:107], a[56:59], v[208:211]
ds_read_b64_tr_b16 a[104:105], v10 offset:32768
v_mfma_f32_16x16x32_bf16 v[212:215], a[112:115], a[56:59], v[212:215]
s_xor_b32 m0, s77, 67584
ds_read_b64_tr_b16 a[106:107], v10 offset:33792
v_mfma_f32_16x16x32_bf16 v[212:215], a[116:119], a[60:63], v[212:215]
s_xor_b32 s64, s71, 589824
ds_read_b64_tr_b16 a[108:109], v10 offset:40960
v_mfma_f32_16x16x32_bf16 v[204:207], a[116:119], a[52:55], v[204:207]
buffer_load_dwordx4 v15, s[56:59], s64 offen lds
v_mfma_f32_16x16x32_bf16 v[204:207], a[112:115], a[48:51], v[204:207]
ds_read_b64_tr_b16 a[110:111], v10 offset:41984
v_mfma_f32_16x16x32_bf16 v[196:199], a[112:115], a[40:43], v[196:199]
v_mfma_f32_16x16x32_bf16 v[196:199], a[116:119], a[44:47], v[196:199]
v_mfma_f32_16x16x32_bf16 v[188:191], a[116:119], a[36:39], v[188:191]
v_mfma_f32_16x16x32_bf16 v[188:191], a[112:115], a[32:35], v[188:191]
s_add_u32 s67, s79, 20480
ds_read_b64_tr_b16 a[112:113], v11 offset:32768
v_mfma_f32_16x16x32_bf16 v[216:219], a[72:75], a[32:35], v[216:219]
ds_read_b64_tr_b16 a[114:115], v11 offset:33792
v_mfma_f32_16x16x32_bf16 v[216:219], a[76:79], a[36:39], v[216:219]
s_add_u32 m0, s78, 90112
ds_read_b64_tr_b16 a[116:117], v11 offset:40960
v_cvt_pk_bf16_f32 v215, v214, v215
v_mfma_f32_16x16x32_bf16 v[224:227], a[76:79], a[44:47], v[224:227]
s_add_u32 s64, s75, 397312
ds_read_b64_tr_b16 a[118:119], v11 offset:41984
v_cvt_pk_bf16_f32 v214, v212, v213
v_mfma_f32_16x16x32_bf16 v[224:227], a[72:75], a[40:43], v[224:227]
buffer_load_dwordx4 v23, s[60:63], s64 offen lds
v_mfma_f32_16x16x32_bf16 v[232:235], a[72:75], a[48:51], v[232:235]
v_cvt_pk_bf16_f32 v212, v208, v209
v_cvt_pk_bf16_f32 v213, v210, v211
v_mfma_f32_16x16x32_bf16 v[232:235], a[76:79], a[52:55], v[232:235]
buffer_store_dwordx4 v[212:215], v16, s[44:47], s67 offen sc1
v_mfma_f32_16x16x32_bf16 v[240:243], a[76:79], a[60:63], v[240:243]
v_cvt_pk_bf16_f32 v207, v206, v207
v_cvt_pk_bf16_f32 v206, v204, v205
v_mfma_f32_16x16x32_bf16 v[240:243], a[72:75], a[56:59], v[240:243]
ds_read_b64_tr_b16 a[72:73], v4 offset:49152
v_cvt_pk_bf16_f32 v204, v200, v201
v_mfma_f32_16x16x32_bf16 v[244:247], a[80:83], a[56:59], v[244:247]
ds_read_b64_tr_b16 a[74:75], v4 offset:50176
v_cvt_pk_bf16_f32 v205, v202, v203
v_mfma_f32_16x16x32_bf16 v[244:247], a[84:87], a[60:63], v[244:247]
ds_read_b64_tr_b16 a[76:77], v4 offset:57344
v_accvgpr_write_b32 a144, v204
v_mfma_f32_16x16x32_bf16 v[236:239], a[84:87], a[52:55], v[236:239]
s_xor_b32 m0, s77, 68608
ds_read_b64_tr_b16 a[78:79], v4 offset:58368
v_accvgpr_write_b32 a145, v205
v_mfma_f32_16x16x32_bf16 v[236:239], a[80:83], a[48:51], v[236:239]
s_xor_b32 s64, s71, 622592
v_accvgpr_write_b32 a146, v206
v_accvgpr_write_b32 a147, v207
v_mfma_f32_16x16x32_bf16 v[228:231], a[80:83], a[40:43], v[228:231]
buffer_load_dwordx4 v15, s[56:59], s64 offen lds
v_mfma_f32_16x16x32_bf16 v[228:231], a[84:87], a[44:47], v[228:231]
v_cvt_pk_bf16_f32 v199, v198, v199
v_cvt_pk_bf16_f32 v198, v196, v197
v_mfma_f32_16x16x32_bf16 v[220:223], a[84:87], a[36:39], v[220:223]
v_cvt_pk_bf16_f32 v196, v192, v193
v_cvt_pk_bf16_f32 v197, v194, v195
v_mfma_f32_16x16x32_bf16 v[220:223], a[80:83], a[32:35], v[220:223]
s_waitcnt lgkmcnt(4)
ds_read_b64_tr_b16 a[80:81], v5 offset:49152
v_accvgpr_write_b32 a148, v196
v_mfma_f32_16x16x32_bf16 v[152:155], a[88:91], a[32:35], v[152:155]
ds_read_b64_tr_b16 a[82:83], v5 offset:50176
v_accvgpr_write_b32 a149, v197
v_mfma_f32_16x16x32_bf16 v[152:155], a[92:95], a[36:39], v[152:155]
ds_read_b64_tr_b16 a[84:85], v5 offset:57344
v_accvgpr_write_b32 a150, v198
v_mfma_f32_16x16x32_bf16 v[160:163], a[92:95], a[44:47], v[160:163]
ds_read_b64_tr_b16 a[86:87], v5 offset:58368
v_accvgpr_write_b32 a151, v199
v_mfma_f32_16x16x32_bf16 v[160:163], a[88:91], a[40:43], v[160:163]
v_cvt_pk_bf16_f32 v191, v190, v191
v_cvt_pk_bf16_f32 v190, v188, v189
v_mfma_f32_16x16x32_bf16 v[168:171], a[88:91], a[48:51], v[168:171]
v_cvt_pk_bf16_f32 v188, v184, v185
v_cvt_pk_bf16_f32 v189, v186, v187
v_mfma_f32_16x16x32_bf16 v[168:171], a[92:95], a[52:55], v[168:171]
v_accvgpr_write_b32 a152, v188
v_accvgpr_write_b32 a153, v189
v_mfma_f32_16x16x32_bf16 v[176:179], a[92:95], a[60:63], v[176:179]
s_xor_b32 m0, s84, 32768
v_accvgpr_write_b32 a154, v190
v_accvgpr_write_b32 a155, v191
v_mfma_f32_16x16x32_bf16 v[176:179], a[88:91], a[56:59], v[176:179]
s_add_u32 s67, s79, 21504
s_xor_b32 s64, s72, 128
ds_read_b64_tr_b16 a[88:89], v6 offset:49152
v_cvt_pk_bf16_f32 v247, v246, v247
v_mfma_f32_16x16x32_bf16 v[180:183], a[96:99], a[56:59], v[180:183]
buffer_load_dwordx4 v12, s[48:51], s64 offen lds
v_mfma_f32_16x16x32_bf16 v[180:183], a[100:103], a[60:63], v[180:183]
ds_read_b64_tr_b16 a[90:91], v6 offset:50176
v_cvt_pk_bf16_f32 v246, v244, v245
v_mfma_f32_16x16x32_bf16 v[172:175], a[100:103], a[52:55], v[172:175]
ds_read_b64_tr_b16 a[92:93], v6 offset:57344
v_cvt_pk_bf16_f32 v244, v240, v241
v_mfma_f32_16x16x32_bf16 v[172:175], a[96:99], a[48:51], v[172:175]
ds_read_b64_tr_b16 a[94:95], v6 offset:58368
v_cvt_pk_bf16_f32 v245, v242, v243
v_mfma_f32_16x16x32_bf16 v[164:167], a[96:99], a[40:43], v[164:167]
buffer_store_dwordx4 v[244:247], v16, s[44:47], s67 offen sc1
v_mfma_f32_16x16x32_bf16 v[164:167], a[100:103], a[44:47], v[164:167]
s_xor_b32 m0, s84, 33792
v_cvt_pk_bf16_f32 v239, v238, v239
v_cvt_pk_bf16_f32 v238, v236, v237
v_mfma_f32_16x16x32_bf16 v[156:159], a[100:103], a[36:39], v[156:159]
s_xor_b32 s64, s72, 16512
v_cvt_pk_bf16_f32 v236, v232, v233
v_cvt_pk_bf16_f32 v237, v234, v235
v_mfma_f32_16x16x32_bf16 v[156:159], a[96:99], a[32:35], v[156:159]
buffer_load_dwordx4 v13, s[48:51], s64 offen lds
v_mfma_f32_16x16x32_bf16 v[24:27], a[104:107], a[32:35], v[24:27]
ds_read_b64_tr_b16 a[96:97], v7 offset:49152
v_accvgpr_write_b32 a156, v236
v_mfma_f32_16x16x32_bf16 v[24:27], a[108:111], a[36:39], v[24:27]
ds_read_b64_tr_b16 a[98:99], v7 offset:50176
v_accvgpr_write_b32 a157, v237
v_mfma_f32_16x16x32_bf16 v[40:43], a[108:111], a[44:47], v[40:43]
ds_read_b64_tr_b16 a[100:101], v7 offset:57344
v_accvgpr_write_b32 a158, v238
v_mfma_f32_16x16x32_bf16 v[40:43], a[104:107], a[40:43], v[40:43]
ds_read_b64_tr_b16 a[102:103], v7 offset:58368
v_accvgpr_write_b32 a159, v239
v_mfma_f32_16x16x32_bf16 v[56:59], a[104:107], a[48:51], v[56:59]
s_xor_b32 m0, s84, 34816
v_cvt_pk_bf16_f32 v231, v230, v231
v_cvt_pk_bf16_f32 v230, v228, v229
v_mfma_f32_16x16x32_bf16 v[56:59], a[108:111], a[52:55], v[56:59]
s_xor_b32 s64, s72, 131200
v_cvt_pk_bf16_f32 v228, v224, v225
v_cvt_pk_bf16_f32 v229, v226, v227
v_mfma_f32_16x16x32_bf16 v[72:75], a[108:111], a[60:63], v[72:75]
s_waitcnt vmcnt(11)
buffer_load_dwordx4 v12, s[48:51], s64 offen lds
v_mfma_f32_16x16x32_bf16 v[72:75], a[104:107], a[56:59], v[72:75]
ds_read_b64_tr_b16 a[104:105], v8 offset:49152
v_accvgpr_write_b32 a160, v228
v_mfma_f32_16x16x32_bf16 v[136:139], a[112:115], a[56:59], v[136:139]
ds_read_b64_tr_b16 a[106:107], v8 offset:50176
v_accvgpr_write_b32 a161, v229
v_mfma_f32_16x16x32_bf16 v[136:139], a[116:119], a[60:63], v[136:139]
ds_read_b64_tr_b16 a[108:109], v8 offset:57344
v_add_u32 v4, 0x8000, v4
v_mfma_f32_16x16x32_bf16 v[120:123], a[116:119], a[52:55], v[120:123]
ds_read_b64_tr_b16 a[110:111], v8 offset:58368
v_accvgpr_write_b32 a162, v230
v_mfma_f32_16x16x32_bf16 v[120:123], a[112:115], a[48:51], v[120:123]
s_xor_b32 m0, s84, 35840
ds_read_b128 a[0:3], v2 offset:0
v_accvgpr_write_b32 a163, v231
v_mfma_f32_16x16x32_bf16 v[104:107], a[112:115], a[40:43], v[104:107]
s_xor_b32 s64, s72, 147584
ds_read_b128 a[4:7], v3 offset:0
v_cvt_pk_bf16_f32 v223, v222, v223
v_mfma_f32_16x16x32_bf16 v[104:107], a[116:119], a[44:47], v[104:107]
buffer_load_dwordx4 v13, s[48:51], s64 offen lds
v_mfma_f32_16x16x32_bf16 v[88:91], a[116:119], a[36:39], v[88:91]
ds_read_b128 a[8:11], v2 offset:2048
v_cvt_pk_bf16_f32 v222, v220, v221
v_mfma_f32_16x16x32_bf16 v[88:91], a[112:115], a[32:35], v[88:91]
s_waitcnt lgkmcnt(7)
ds_read_b128 a[12:15], v3 offset:2048
v_cvt_pk_bf16_f32 v220, v216, v217
v_mfma_f32_16x16x32_bf16 v[28:31], a[32:35], a[72:75], v[28:31]
ds_read_b128 a[16:19], v2 offset:4096
v_cvt_pk_bf16_f32 v221, v218, v219
v_mfma_f32_16x16x32_bf16 v[28:31], a[36:39], a[76:79], v[28:31]
ds_read_b128 a[20:23], v3 offset:4096
v_add_u32 v5, 0x8000, v5
v_mfma_f32_16x16x32_bf16 v[44:47], a[44:47], a[76:79], v[44:47]
s_xor_b32 m0, s84, 36864
ds_read_b128 a[24:27], v2 offset:6144
v_accvgpr_write_b32 a164, v220
v_mfma_f32_16x16x32_bf16 v[44:47], a[40:43], a[72:75], v[44:47]
s_xor_b32 s64, s73, 128
ds_read_b128 a[28:31], v3 offset:6144
v_accvgpr_write_b32 a165, v221
v_mfma_f32_16x16x32_bf16 v[60:63], a[48:51], a[72:75], v[60:63]
buffer_load_dwordx4 v12, s[48:51], s64 offen lds
v_mfma_f32_16x16x32_bf16 v[60:63], a[52:55], a[76:79], v[60:63]
ds_read_b64_tr_b16 a[112:113], v9 offset:49152
v_accvgpr_write_b32 a166, v222
v_mfma_f32_16x16x32_bf16 v[76:79], a[60:63], a[76:79], v[76:79]
ds_read_b64_tr_b16 a[114:115], v9 offset:50176
v_accvgpr_write_b32 a167, v223
v_mfma_f32_16x16x32_bf16 v[76:79], a[56:59], a[72:75], v[76:79]
s_add_u32 s67, s79, 22528
ds_read_b64_tr_b16 a[116:117], v9 offset:57344
v_cvt_pk_bf16_f32 v183, v182, v183
v_mfma_f32_16x16x32_bf16 v[140:143], a[56:59], a[80:83], v[140:143]
ds_read_b64_tr_b16 a[118:119], v9 offset:58368
v_cvt_pk_bf16_f32 v182, v180, v181
v_mfma_f32_16x16x32_bf16 v[140:143], a[60:63], a[84:87], v[140:143]
s_xor_b32 m0, s84, 37888
ds_read_b64_tr_b16 a[72:73], v10 offset:49152
v_add_u32 v6, 0x8000, v6
v_mfma_f32_16x16x32_bf16 v[124:127], a[52:55], a[84:87], v[124:127]
s_xor_b32 s64, s73, 16512
ds_read_b64_tr_b16 a[74:75], v10 offset:50176
v_cvt_pk_bf16_f32 v180, v176, v177
v_mfma_f32_16x16x32_bf16 v[124:127], a[48:51], a[80:83], v[124:127]
buffer_load_dwordx4 v13, s[48:51], s64 offen lds
v_mfma_f32_16x16x32_bf16 v[108:111], a[40:43], a[80:83], v[108:111]
ds_read_b64_tr_b16 a[76:77], v10 offset:57344
v_cvt_pk_bf16_f32 v181, v178, v179
v_mfma_f32_16x16x32_bf16 v[108:111], a[44:47], a[84:87], v[108:111]
ds_read_b64_tr_b16 a[78:79], v10 offset:58368
v_mfma_f32_16x16x32_bf16 v[92:95], a[36:39], a[84:87], v[92:95]
buffer_store_dwordx4 v[180:183], v16, s[44:47], s67 offen sc1
v_mfma_f32_16x16x32_bf16 v[92:95], a[32:35], a[80:83], v[92:95]
ds_read_b64_tr_b16 a[80:81], v11 offset:49152
v_cvt_pk_bf16_f32 v175, v174, v175
v_mfma_f32_16x16x32_bf16 v[32:35], a[32:35], a[88:91], v[32:35]
s_xor_b32 m0, s84, 38912
ds_read_b64_tr_b16 a[82:83], v11 offset:50176
v_cvt_pk_bf16_f32 v174, v172, v173
v_mfma_f32_16x16x32_bf16 v[32:35], a[36:39], a[92:95], v[32:35]
s_xor_b32 s64, s73, 131200
ds_read_b64_tr_b16 a[84:85], v11 offset:57344
v_add_u32 v7, 0x8000, v7
v_mfma_f32_16x16x32_bf16 v[48:51], a[44:47], a[92:95], v[48:51]
buffer_load_dwordx4 v12, s[48:51], s64 offen lds
v_mfma_f32_16x16x32_bf16 v[48:51], a[40:43], a[88:91], v[48:51]
ds_read_b64_tr_b16 a[86:87], v11 offset:58368
v_cvt_pk_bf16_f32 v172, v168, v169
v_mfma_f32_16x16x32_bf16 v[64:67], a[48:51], a[88:91], v[64:67]
v_cvt_pk_bf16_f32 v173, v170, v171
v_accvgpr_write_b32 a168, v172
v_mfma_f32_16x16x32_bf16 v[64:67], a[52:55], a[92:95], v[64:67]
v_accvgpr_write_b32 a169, v173
v_accvgpr_write_b32 a170, v174
v_mfma_f32_16x16x32_bf16 v[80:83], a[60:63], a[92:95], v[80:83]
v_accvgpr_write_b32 a171, v175
v_cvt_pk_bf16_f32 v167, v166, v167
v_mfma_f32_16x16x32_bf16 v[80:83], a[56:59], a[88:91], v[80:83]
s_xor_b32 m0, s84, 39936
v_cvt_pk_bf16_f32 v166, v164, v165
v_cvt_pk_bf16_f32 v164, v160, v161
v_mfma_f32_16x16x32_bf16 v[144:147], a[56:59], a[96:99], v[144:147]
s_xor_b32 s64, s73, 147584
v_cvt_pk_bf16_f32 v165, v162, v163
v_accvgpr_write_b32 a172, v164
v_mfma_f32_16x16x32_bf16 v[144:147], a[60:63], a[100:103], v[144:147]
buffer_load_dwordx4 v13, s[48:51], s64 offen lds
v_mfma_f32_16x16x32_bf16 v[128:131], a[52:55], a[100:103], v[128:131]
v_add_u32 v8, 0x8000, v8
v_accvgpr_write_b32 a173, v165
v_mfma_f32_16x16x32_bf16 v[128:131], a[48:51], a[96:99], v[128:131]
v_accvgpr_write_b32 a174, v166
v_accvgpr_write_b32 a175, v167
v_mfma_f32_16x16x32_bf16 v[112:115], a[40:43], a[96:99], v[112:115]
v_cvt_pk_bf16_f32 v159, v158, v159
v_cvt_pk_bf16_f32 v158, v156, v157
v_mfma_f32_16x16x32_bf16 v[112:115], a[44:47], a[100:103], v[112:115]
v_cvt_pk_bf16_f32 v156, v152, v153
v_cvt_pk_bf16_f32 v157, v154, v155
v_mfma_f32_16x16x32_bf16 v[96:99], a[36:39], a[100:103], v[96:99]
v_add_u32 v9, 0x8000, v9
v_add_u32 v10, 0x8000, v10
v_mfma_f32_16x16x32_bf16 v[96:99], a[32:35], a[96:99], v[96:99]
s_waitcnt lgkmcnt(0)
v_add_u32 v11, 0x8000, v11
v_accvgpr_write_b32 a176, v156
v_mfma_f32_16x16x32_bf16 v[36:39], a[32:35], a[104:107], v[36:39]
v_accvgpr_write_b32 a177, v157
v_accvgpr_write_b32 a178, v158
v_mfma_f32_16x16x32_bf16 v[36:39], a[36:39], a[108:111], v[36:39]
v_accvgpr_write_b32 a179, v159
v_mfma_f32_16x16x32_bf16 v[52:55], a[44:47], a[108:111], v[52:55]
s_add_u32 s67, s79, 23552
s_waitcnt lgkmcnt(0)
s_barrier
v_mfma_f32_16x16x32_bf16 v[52:55], a[40:43], a[104:107], v[52:55]
s_xor_b32 m0, s77, 98304
ds_read_b64_tr_b16 a[88:89], v19 offset:36864
v_cvt_pk_bf16_f32 v139, v138, v139
v_mfma_f32_16x16x32_bf16 v[68:71], a[48:51], a[104:107], v[68:71]
s_xor_b32 s64, s71, 1048576
ds_read_b64_tr_b16 a[90:91], v19 offset:37120
v_cvt_pk_bf16_f32 v138, v136, v137
v_mfma_f32_16x16x32_bf16 v[68:71], a[52:55], a[108:111], v[68:71]
buffer_load_dwordx4 v14, s[56:59], s64 offen lds
v_mfma_f32_16x16x32_bf16 v[84:87], a[60:63], a[108:111], v[84:87]
ds_read_b64_tr_b16 a[92:93], v19 offset:38912
v_cvt_pk_bf16_f32 v136, v72, v73
v_mfma_f32_16x16x32_bf16 v[84:87], a[56:59], a[104:107], v[84:87]
ds_read_b64_tr_b16 a[94:95], v19 offset:39168
v_cvt_pk_bf16_f32 v137, v74, v75
v_mfma_f32_16x16x32_bf16 v[148:151], a[56:59], a[112:115], v[148:151]
ds_read_b64_tr_b16 a[96:97], v20 offset:36864
v_mfma_f32_16x16x32_bf16 v[148:151], a[60:63], a[116:119], v[148:151]
ds_read_b64_tr_b16 a[98:99], v20 offset:37120
v_mfma_f32_16x16x32_bf16 v[132:135], a[52:55], a[116:119], v[132:135]
ds_read_b64_tr_b16 a[100:101], v20 offset:38912
v_mfma_f32_16x16x32_bf16 v[132:135], a[48:51], a[112:115], v[132:135]
ds_read_b64_tr_b16 a[102:103], v20 offset:39168
v_mfma_f32_16x16x32_bf16 v[116:119], a[40:43], a[112:115], v[116:119]
s_add_u32 m0, s78, 114688
ds_read_b64_tr_b16 a[104:105], v19 offset:40960
v_mfma_f32_16x16x32_bf16 v[116:119], a[44:47], a[116:119], v[116:119]
s_add_u32 s64, s75, 786432
ds_read_b64_tr_b16 a[106:107], v19 offset:41216
v_mfma_f32_16x16x32_bf16 v[100:103], a[36:39], a[116:119], v[100:103]
buffer_load_dwordx4 v23, s[60:63], s64 offen lds
v_mfma_f32_16x16x32_bf16 v[100:103], a[32:35], a[112:115], v[100:103]
ds_read_b64_tr_b16 a[108:109], v19 offset:43008
v_mfma_f32_16x16x32_bf16 v[248:251], a[32:35], a[72:75], v[248:251]
ds_read_b64_tr_b16 a[110:111], v19 offset:43264
v_mfma_f32_16x16x32_bf16 v[248:251], a[36:39], a[76:79], v[248:251]
ds_read_b64_tr_b16 a[112:113], v20 offset:40960
v_mfma_f32_16x16x32_bf16 v[252:255], a[44:47], a[76:79], v[252:255]
ds_read_b64_tr_b16 a[114:115], v20 offset:41216
v_mfma_f32_16x16x32_bf16 v[252:255], a[40:43], a[72:75], v[252:255]
ds_read_b64_tr_b16 a[116:117], v20 offset:43008
v_mfma_f32_16x16x32_bf16 a[120:123], a[48:51], a[72:75], a[120:123]
ds_read_b64_tr_b16 a[118:119], v20 offset:43264
v_mfma_f32_16x16x32_bf16 a[120:123], a[52:55], a[76:79], a[120:123]
s_xor_b32 m0, s77, 99328
buffer_store_dwordx4 v[136:139], v16, s[44:47], s67 offen sc1
v_mfma_f32_16x16x32_bf16 a[124:127], a[60:63], a[76:79], a[124:127]
s_xor_b32 s64, s71, 1081344
v_cvt_pk_bf16_f32 v123, v122, v123
v_cvt_pk_bf16_f32 v122, v120, v121
v_mfma_f32_16x16x32_bf16 a[124:127], a[56:59], a[72:75], a[124:127]
buffer_load_dwordx4 v14, s[56:59], s64 offen lds
v_mfma_f32_16x16x32_bf16 a[128:131], a[56:59], a[80:83], a[128:131]
ds_read_b64_tr_b16 a[72:73], v19 offset:32768
v_cvt_pk_bf16_f32 v120, v56, v57
v_mfma_f32_16x16x32_bf16 a[128:131], a[60:63], a[84:87], a[128:131]
ds_read_b64_tr_b16 a[74:75], v19 offset:33024
v_cvt_pk_bf16_f32 v121, v58, v59
v_mfma_f32_16x16x32_bf16 a[132:135], a[52:55], a[84:87], a[132:135]
ds_read_b64_tr_b16 a[76:77], v19 offset:34816
v_accvgpr_write_b32 a180, v120
v_mfma_f32_16x16x32_bf16 a[132:135], a[48:51], a[80:83], a[132:135]
ds_read_b64_tr_b16 a[78:79], v19 offset:35072
v_accvgpr_write_b32 a181, v121
v_mfma_f32_16x16x32_bf16 a[136:139], a[40:43], a[80:83], a[136:139]
v_accvgpr_write_b32 a182, v122
v_accvgpr_write_b32 a183, v123
v_mfma_f32_16x16x32_bf16 a[136:139], a[44:47], a[84:87], a[136:139]
v_cvt_pk_bf16_f32 v107, v106, v107
v_cvt_pk_bf16_f32 v106, v104, v105
v_mfma_f32_16x16x32_bf16 a[140:143], a[36:39], a[84:87], a[140:143]
s_add_u32 m0, s78, 118784
v_cvt_pk_bf16_f32 v104, v40, v41
v_cvt_pk_bf16_f32 v105, v42, v43
v_mfma_f32_16x16x32_bf16 a[140:143], a[32:35], a[80:83], a[140:143]
s_waitcnt lgkmcnt(4)
s_add_u32 s64, s75, 788480
ds_read_b64_tr_b16 a[80:81], v20 offset:32768
v_accvgpr_write_b32 a184, v104
v_mfma_f32_16x16x32_bf16 v[184:187], a[88:91], a[0:3], 0
buffer_load_dwordx4 v23, s[60:63], s64 offen lds
v_mfma_f32_16x16x32_bf16 v[184:187], a[92:95], a[4:7], v[184:187]
ds_read_b64_tr_b16 a[82:83], v20 offset:33024
v_accvgpr_write_b32 a185, v105
v_mfma_f32_16x16x32_bf16 v[192:195], a[92:95], a[12:15], 0
ds_read_b64_tr_b16 a[84:85], v20 offset:34816
v_accvgpr_write_b32 a186, v106
v_mfma_f32_16x16x32_bf16 v[192:195], a[88:91], a[8:11], v[192:195]
ds_read_b64_tr_b16 a[86:87], v20 offset:35072
v_accvgpr_write_b32 a187, v107
v_mfma_f32_16x16x32_bf16 v[200:203], a[88:91], a[16:19], 0
v_cvt_pk_bf16_f32 v91, v90, v91
v_cvt_pk_bf16_f32 v90, v88, v89
v_mfma_f32_16x16x32_bf16 v[200:203], a[92:95], a[20:23], v[200:203]
v_cvt_pk_bf16_f32 v88, v24, v25
v_cvt_pk_bf16_f32 v89, v26, v27
v_mfma_f32_16x16x32_bf16 v[208:211], a[92:95], a[28:31], 0
v_accvgpr_write_b32 a188, v88
v_accvgpr_write_b32 a189, v89
v_mfma_f32_16x16x32_bf16 v[208:211], a[88:91], a[24:27], v[208:211]
s_xor_b32 m0, s77, 100352
ds_read_b64_tr_b16 a[88:89], v4 offset:32768
v_accvgpr_write_b32 a190, v90
v_mfma_f32_16x16x32_bf16 v[212:215], a[96:99], a[24:27], 0
s_xor_b32 s64, s71, 1114112
ds_read_b64_tr_b16 a[90:91], v4 offset:33792
v_accvgpr_write_b32 a191, v91
v_mfma_f32_16x16x32_bf16 v[212:215], a[100:103], a[28:31], v[212:215]
s_add_u32 s67, s79, 8192
ds_read_b64_tr_b16 a[92:93], v4 offset:40960
v_cvt_pk_bf16_f32 v47, v46, v47
v_mfma_f32_16x16x32_bf16 v[204:207], a[100:103], a[20:23], 0
buffer_load_dwordx4 v15, s[56:59], s64 offen lds
v_mfma_f32_16x16x32_bf16 v[204:207], a[96:99], a[16:19], v[204:207]
ds_read_b64_tr_b16 a[94:95], v4 offset:41984
v_cvt_pk_bf16_f32 v46, v44, v45
v_mfma_f32_16x16x32_bf16 v[196:199], a[96:99], a[8:11], 0
v_cvt_pk_bf16_f32 v44, v28, v29
v_cvt_pk_bf16_f32 v45, v30, v31
v_mfma_f32_16x16x32_bf16 v[196:199], a[100:103], a[12:15], v[196:199]
buffer_store_dwordx4 v[44:47], v16, s[44:47], s67 offen sc1
v_mfma_f32_16x16x32_bf16 v[188:191], a[100:103], a[4:7], 0
v_cvt_pk_bf16_f32 v79, v78, v79
v_cvt_pk_bf16_f32 v78, v76, v77
v_mfma_f32_16x16x32_bf16 v[188:191], a[96:99], a[0:3], v[188:191]
s_branch L_po6
L_pg6:
s_branch L_pg10
L_po6:
ds_read_b64_tr_b16 a[96:97], v5 offset:32768
v_cvt_pk_bf16_f32 v76, v60, v61
v_mfma_f32_16x16x32_bf16 v[216:219], a[0:3], a[104:107], 0
ds_read_b64_tr_b16 a[98:99], v5 offset:33792
v_cvt_pk_bf16_f32 v77, v62, v63
v_mfma_f32_16x16x32_bf16 v[216:219], a[4:7], a[108:111], v[216:219]
s_add_u32 m0, s78, 122880
ds_read_b64_tr_b16 a[100:101], v5 offset:40960
v_accvgpr_write_b32 a192, v76
v_mfma_f32_16x16x32_bf16 v[224:227], a[12:15], a[108:111], 0
s_add_u32 s64, s75, 790528
ds_read_b64_tr_b16 a[102:103], v5 offset:41984
v_accvgpr_write_b32 a193, v77
v_mfma_f32_16x16x32_bf16 v[224:227], a[8:11], a[104:107], v[224:227]
buffer_load_dwordx4 v23, s[60:63], s64 offen lds
v_mfma_f32_16x16x32_bf16 v[232:235], a[16:19], a[104:107], 0
v_accvgpr_write_b32 a194, v78
v_accvgpr_write_b32 a195, v79
v_mfma_f32_16x16x32_bf16 v[232:235], a[20:23], a[108:111], v[232:235]
v_cvt_pk_bf16_f32 v124, v124, v125
v_cvt_pk_bf16_f32 v125, v126, v127
v_mfma_f32_16x16x32_bf16 v[240:243], a[28:31], a[108:111], 0
v_cvt_pk_bf16_f32 v126, v140, v141
v_cvt_pk_bf16_f32 v127, v142, v143
v_mfma_f32_16x16x32_bf16 v[240:243], a[24:27], a[104:107], v[240:243]
ds_read_b64_tr_b16 a[104:105], v6 offset:32768
v_accvgpr_write_b32 a196, v124
v_mfma_f32_16x16x32_bf16 v[244:247], a[24:27], a[112:115], 0
ds_read_b64_tr_b16 a[106:107], v6 offset:33792
v_accvgpr_write_b32 a197, v125
v_mfma_f32_16x16x32_bf16 v[244:247], a[28:31], a[116:119], v[244:247]
ds_read_b64_tr_b16 a[108:109], v6 offset:40960
v_accvgpr_write_b32 a198, v126
v_mfma_f32_16x16x32_bf16 v[236:239], a[20:23], a[116:119], 0
s_xor_b32 m0, s77, 101376
ds_read_b64_tr_b16 a[110:111], v6 offset:41984
v_accvgpr_write_b32 a199, v127
v_mfma_f32_16x16x32_bf16 v[236:239], a[16:19], a[112:115], v[236:239]
s_xor_b32 s64, s71, 1146880
v_cvt_pk_bf16_f32 v92, v92, v93
v_cvt_pk_bf16_f32 v93, v94, v95
v_mfma_f32_16x16x32_bf16 v[228:231], a[8:11], a[112:115], 0
buffer_load_dwordx4 v15, s[56:59], s64 offen lds
v_mfma_f32_16x16x32_bf16 v[228:231], a[12:15], a[116:119], v[228:231]
v_cvt_pk_bf16_f32 v94, v108, v109
v_cvt_pk_bf16_f32 v95, v110, v111
v_mfma_f32_16x16x32_bf16 v[220:223], a[4:7], a[116:119], 0
v_accvgpr_write_b32 a200, v92
v_accvgpr_write_b32 a201, v93
v_mfma_f32_16x16x32_bf16 v[220:223], a[0:3], a[112:115], v[220:223]
s_waitcnt lgkmcnt(4)
ds_read_b64_tr_b16 a[112:113], v7 offset:32768
v_accvgpr_write_b32 a202, v94
v_mfma_f32_16x16x32_bf16 v[152:155], a[72:75], a[0:3], 0
ds_read_b64_tr_b16 a[114:115], v7 offset:33792
v_accvgpr_write_b32 a203, v95
v_mfma_f32_16x16x32_bf16 v[152:155], a[76:79], a[4:7], v[152:155]
s_add_u32 s67, s79, 10240
ds_read_b64_tr_b16 a[116:117], v7 offset:40960
v_cvt_pk_bf16_f32 v51, v50, v51
v_mfma_f32_16x16x32_bf16 v[160:163], a[76:79], a[12:15], 0
ds_read_b64_tr_b16 a[118:119], v7 offset:41984
v_cvt_pk_bf16_f32 v50, v48, v49
v_mfma_f32_16x16x32_bf16 v[160:163], a[72:75], a[8:11], v[160:163]
v_cvt_pk_bf16_f32 v48, v32, v33
v_cvt_pk_bf16_f32 v49, v34, v35
v_mfma_f32_16x16x32_bf16 v[168:171], a[72:75], a[16:19], 0
buffer_store_dwordx4 v[48:51], v16, s[44:47], s67 offen sc1
v_mfma_f32_16x16x32_bf16 v[168:171], a[76:79], a[20:23], v[168:171]
v_subrev_u32 v19, 0x8000, v19
v_subrev_u32 v20, 0x8000, v20
v_mfma_f32_16x16x32_bf16 v[176:179], a[76:79], a[28:31], 0
s_xor_b32 m0, s84, 0
v_cvt_pk_bf16_f32 v83, v82, v83
v_cvt_pk_bf16_f32 v82, v80, v81
v_mfma_f32_16x16x32_bf16 v[176:179], a[72:75], a[24:27], v[176:179]
s_xor_b32 s64, s72, 256
ds_read_b64_tr_b16 a[72:73], v8 offset:32768
v_cvt_pk_bf16_f32 v80, v64, v65
v_mfma_f32_16x16x32_bf16 v[180:183], a[80:83], a[24:27], 0
buffer_load_dwordx4 v12, s[48:51], s64 offen lds
v_mfma_f32_16x16x32_bf16 v[180:183], a[84:87], a[28:31], v[180:183]
ds_read_b64_tr_b16 a[74:75], v8 offset:33792
v_subrev_u32 v4, 0x8000, v4
v_mfma_f32_16x16x32_bf16 v[172:175], a[84:87], a[20:23], 0
ds_read_b64_tr_b16 a[76:77], v8 offset:40960
v_cvt_pk_bf16_f32 v81, v66, v67
v_mfma_f32_16x16x32_bf16 v[172:175], a[80:83], a[16:19], v[172:175]
s_xor_b32 m0, s84, 1024
ds_read_b64_tr_b16 a[78:79], v8 offset:41984
v_accvgpr_write_b32 a204, v80
v_mfma_f32_16x16x32_bf16 v[164:167], a[80:83], a[8:11], 0
s_xor_b32 s64, s72, 16640
v_accvgpr_write_b32 a205, v81
v_accvgpr_write_b32 a206, v82
v_mfma_f32_16x16x32_bf16 v[164:167], a[84:87], a[12:15], v[164:167]
buffer_load_dwordx4 v13, s[48:51], s64 offen lds
v_mfma_f32_16x16x32_bf16 v[156:159], a[84:87], a[4:7], 0
v_accvgpr_write_b32 a207, v83
v_cvt_pk_bf16_f32 v128, v128, v129
v_mfma_f32_16x16x32_bf16 v[156:159], a[80:83], a[0:3], v[156:159]
ds_read_b64_tr_b16 a[80:81], v9 offset:32768
v_cvt_pk_bf16_f32 v129, v130, v131
v_mfma_f32_16x16x32_bf16 v[24:27], a[88:91], a[0:3], 0
s_xor_b32 m0, s84, 2048
ds_read_b64_tr_b16 a[82:83], v9 offset:33792
v_cvt_pk_bf16_f32 v130, v144, v145
v_mfma_f32_16x16x32_bf16 v[24:27], a[92:95], a[4:7], v[24:27]
s_xor_b32 s64, s72, 131328
ds_read_b64_tr_b16 a[84:85], v9 offset:40960
v_subrev_u32 v5, 0x8000, v5
v_mfma_f32_16x16x32_bf16 v[40:43], a[92:95], a[12:15], 0
buffer_load_dwordx4 v12, s[48:51], s64 offen lds
v_mfma_f32_16x16x32_bf16 v[40:43], a[88:91], a[8:11], v[40:43]
ds_read_b64_tr_b16 a[86:87], v9 offset:41984
v_cvt_pk_bf16_f32 v131, v146, v147
v_mfma_f32_16x16x32_bf16 v[56:59], a[88:91], a[16:19], 0
s_xor_b32 m0, s84, 3072
v_accvgpr_write_b32 a208, v128
v_accvgpr_write_b32 a209, v129
v_mfma_f32_16x16x32_bf16 v[56:59], a[92:95], a[20:23], v[56:59]
s_xor_b32 s64, s72, 147712
v_accvgpr_write_b32 a210, v130
v_accvgpr_write_b32 a211, v131
v_mfma_f32_16x16x32_bf16 v[72:75], a[92:95], a[28:31], 0
s_waitcnt vmcnt(13)
ds_read_b128 a[32:35], v2 offset:32768
v_cvt_pk_bf16_f32 v96, v96, v97
v_mfma_f32_16x16x32_bf16 v[72:75], a[88:91], a[24:27], v[72:75]
buffer_load_dwordx4 v13, s[48:51], s64 offen lds
v_mfma_f32_16x16x32_bf16 v[136:139], a[96:99], a[24:27], 0
ds_read_b128 a[36:39], v3 offset:32768
v_cvt_pk_bf16_f32 v97, v98, v99
v_mfma_f32_16x16x32_bf16 v[136:139], a[100:103], a[28:31], v[136:139]
ds_read_b128 a[40:43], v2 offset:34816
v_subrev_u32 v6, 0x8000, v6
v_mfma_f32_16x16x32_bf16 v[120:123], a[100:103], a[20:23], 0
s_xor_b32 m0, s84, 4096
ds_read_b128 a[44:47], v3 offset:34816
v_cvt_pk_bf16_f32 v98, v112, v113
v_mfma_f32_16x16x32_bf16 v[120:123], a[96:99], a[16:19], v[120:123]
s_xor_b32 s64, s73, 256
ds_read_b128 a[48:51], v2 offset:36864
v_cvt_pk_bf16_f32 v99, v114, v115
v_mfma_f32_16x16x32_bf16 v[104:107], a[96:99], a[8:11], 0
buffer_load_dwordx4 v12, s[48:51], s64 offen lds
v_mfma_f32_16x16x32_bf16 v[104:107], a[100:103], a[12:15], v[104:107]
ds_read_b128 a[52:55], v3 offset:36864
v_accvgpr_write_b32 a212, v96
v_mfma_f32_16x16x32_bf16 v[88:91], a[100:103], a[4:7], 0
ds_read_b128 a[56:59], v2 offset:38912
v_accvgpr_write_b32 a213, v97
v_mfma_f32_16x16x32_bf16 v[88:91], a[96:99], a[0:3], v[88:91]
s_waitcnt lgkmcnt(7)
s_xor_b32 m0, s84, 5120
ds_read_b128 a[60:63], v3 offset:38912
v_accvgpr_write_b32 a214, v98
v_mfma_f32_16x16x32_bf16 v[28:31], a[104:107], a[0:3], 0
s_xor_b32 s64, s73, 16640
ds_read_b64_tr_b16 a[88:89], v10 offset:32768
v_accvgpr_write_b32 a215, v99
v_mfma_f32_16x16x32_bf16 v[28:31], a[108:111], a[4:7], v[28:31]
s_add_u32 s67, s79, 12288
buffer_load_dwordx4 v13, s[48:51], s64 offen lds
v_mfma_f32_16x16x32_bf16 v[44:47], a[108:111], a[12:15], 0
ds_read_b64_tr_b16 a[90:91], v10 offset:33792
v_subrev_u32 v7, 0x8000, v7
v_mfma_f32_16x16x32_bf16 v[44:47], a[104:107], a[8:11], v[44:47]
ds_read_b64_tr_b16 a[92:93], v10 offset:40960
v_cvt_pk_bf16_f32 v55, v54, v55
v_mfma_f32_16x16x32_bf16 v[60:63], a[104:107], a[16:19], 0
s_xor_b32 m0, s84, 6144
ds_read_b64_tr_b16 a[94:95], v10 offset:41984
v_cvt_pk_bf16_f32 v54, v52, v53
v_mfma_f32_16x16x32_bf16 v[60:63], a[108:111], a[20:23], v[60:63]
s_xor_b32 s64, s73, 131328
ds_read_b64_tr_b16 a[96:97], v11 offset:32768
v_cvt_pk_bf16_f32 v52, v36, v37
v_mfma_f32_16x16x32_bf16 v[76:79], a[108:111], a[28:31], 0
buffer_load_dwordx4 v12, s[48:51], s64 offen lds
v_mfma_f32_16x16x32_bf16 v[76:79], a[104:107], a[24:27], v[76:79]
ds_read_b64_tr_b16 a[98:99], v11 offset:33792
v_cvt_pk_bf16_f32 v53, v38, v39
v_mfma_f32_16x16x32_bf16 v[140:143], a[112:115], a[24:27], 0
ds_read_b64_tr_b16 a[100:101], v11 offset:40960
v_mfma_f32_16x16x32_bf16 v[140:143], a[116:119], a[28:31], v[140:143]
s_xor_b32 m0, s84, 7168
ds_read_b64_tr_b16 a[102:103], v11 offset:41984
v_subrev_u32 v8, 0x8000, v8
v_mfma_f32_16x16x32_bf16 v[124:127], a[116:119], a[20:23], 0
s_xor_b32 s64, s73, 147712
buffer_store_dwordx4 v[52:55], v16, s[44:47], s67 offen sc1
v_mfma_f32_16x16x32_bf16 v[124:127], a[112:115], a[16:19], v[124:127]
buffer_load_dwordx4 v13, s[48:51], s64 offen lds
v_mfma_f32_16x16x32_bf16 v[108:111], a[112:115], a[8:11], 0
v_cvt_pk_bf16_f32 v87, v86, v87
v_cvt_pk_bf16_f32 v86, v84, v85
v_mfma_f32_16x16x32_bf16 v[108:111], a[116:119], a[12:15], v[108:111]
v_cvt_pk_bf16_f32 v84, v68, v69
v_cvt_pk_bf16_f32 v85, v70, v71
v_mfma_f32_16x16x32_bf16 v[92:95], a[116:119], a[4:7], 0
v_subrev_u32 v9, 0x8000, v9
v_subrev_u32 v10, 0x8000, v10
v_mfma_f32_16x16x32_bf16 v[92:95], a[112:115], a[0:3], v[92:95]
v_subrev_u32 v11, 0x8000, v11
v_accvgpr_write_b32 a216, v84
v_mfma_f32_16x16x32_bf16 v[32:35], a[72:75], a[0:3], 0
v_accvgpr_write_b32 a217, v85
v_accvgpr_write_b32 a218, v86
v_mfma_f32_16x16x32_bf16 v[32:35], a[76:79], a[4:7], v[32:35]
v_accvgpr_write_b32 a219, v87
v_cvt_pk_bf16_f32 v132, v132, v133
v_mfma_f32_16x16x32_bf16 v[48:51], a[76:79], a[12:15], 0
s_waitcnt lgkmcnt(0)
s_barrier
v_mfma_f32_16x16x32_bf16 v[48:51], a[72:75], a[8:11], v[48:51]
s_xor_b32 m0, s77, 131072
ds_read_b64_tr_b16 a[104:105], v19 offset:4096
v_cvt_pk_bf16_f32 v133, v134, v135
v_mfma_f32_16x16x32_bf16 v[64:67], a[72:75], a[16:19], 0
s_xor_b32 s64, s71, 1572864
ds_read_b64_tr_b16 a[106:107], v19 offset:4352
v_cvt_pk_bf16_f32 v134, v148, v149
v_mfma_f32_16x16x32_bf16 v[64:67], a[76:79], a[20:23], v[64:67]
buffer_load_dwordx4 v14, s[56:59], s64 offen lds
v_mfma_f32_16x16x32_bf16 v[80:83], a[76:79], a[28:31], 0
ds_read_b64_tr_b16 a[108:109], v19 offset:6144
v_cvt_pk_bf16_f32 v135, v150, v151
v_mfma_f32_16x16x32_bf16 v[80:83], a[72:75], a[24:27], v[80:83]
ds_read_b64_tr_b16 a[110:111], v19 offset:6400
v_accvgpr_write_b32 a220, v132
v_mfma_f32_16x16x32_bf16 v[144:147], a[80:83], a[24:27], 0
ds_read_b64_tr_b16 a[112:113], v20 offset:4096
v_accvgpr_write_b32 a221, v133
v_mfma_f32_16x16x32_bf16 v[144:147], a[84:87], a[28:31], v[144:147]
ds_read_b64_tr_b16 a[114:115], v20 offset:4352
v_accvgpr_write_b32 a222, v134
v_mfma_f32_16x16x32_bf16 v[128:131], a[84:87], a[20:23], 0
ds_read_b64_tr_b16 a[116:117], v20 offset:6144
v_accvgpr_write_b32 a223, v135
v_mfma_f32_16x16x32_bf16 v[128:131], a[80:83], a[16:19], v[128:131]
ds_read_b64_tr_b16 a[118:119], v20 offset:6400
v_cvt_pk_bf16_f32 v100, v100, v101
v_mfma_f32_16x16x32_bf16 v[112:115], a[80:83], a[8:11], 0
s_add_u32 m0, s78, 147456
ds_read_b64_tr_b16 a[72:73], v19 offset:8192
v_cvt_pk_bf16_f32 v101, v102, v103
v_mfma_f32_16x16x32_bf16 v[112:115], a[84:87], a[12:15], v[112:115]
s_add_u32 s64, s75, 1179648
ds_read_b64_tr_b16 a[74:75], v19 offset:8448
v_cvt_pk_bf16_f32 v102, v116, v117
v_mfma_f32_16x16x32_bf16 v[96:99], a[84:87], a[4:7], 0
buffer_load_dwordx4 v23, s[60:63], s64 offen lds
v_mfma_f32_16x16x32_bf16 v[96:99], a[80:83], a[0:3], v[96:99]
ds_read_b64_tr_b16 a[76:77], v19 offset:10240
v_cvt_pk_bf16_f32 v103, v118, v119
v_mfma_f32_16x16x32_bf16 v[36:39], a[88:91], a[0:3], 0
ds_read_b64_tr_b16 a[78:79], v19 offset:10496
v_accvgpr_write_b32 a224, v100
v_mfma_f32_16x16x32_bf16 v[36:39], a[92:95], a[4:7], v[36:39]
ds_read_b64_tr_b16 a[80:81], v20 offset:8192
v_accvgpr_write_b32 a225, v101
v_mfma_f32_16x16x32_bf16 v[52:55], a[92:95], a[12:15], 0
s_xor_b32 s68, s66, 0
ds_read_b64_tr_b16 a[82:83], v20 offset:8448
v_accvgpr_write_b32 a226, v102
v_mfma_f32_16x16x32_bf16 v[52:55], a[88:91], a[8:11], v[52:55]
s_xor_b32 m0, s77, 132096
ds_read_b64_tr_b16 a[84:85], v20 offset:10240
v_accvgpr_write_b32 a227, v103
v_mfma_f32_16x16x32_bf16 v[68:71], a[88:91], a[16:19], 0
s_add_u32 s67, s79, 14336
ds_read_b64_tr_b16 a[86:87], v20 offset:10496
v_cvt_pk_bf16_f32 v255, v254, v255
v_mfma_f32_16x16x32_bf16 v[68:71], a[92:95], a[20:23], v[68:71]
s_xor_b32 s64, s71, 1605632
v_cvt_pk_bf16_f32 v254, v252, v253
v_cvt_pk_bf16_f32 v252, v248, v249
v_mfma_f32_16x16x32_bf16 v[84:87], a[92:95], a[28:31], 0
s_mov_b64 exec, 1
buffer_atomic_add a251, v1, s[52:55], s68 offen offset:0 sc1
s_mov_b64 exec, -1
v_mfma_f32_16x16x32_bf16 v[84:87], a[88:91], a[24:27], v[84:87]
buffer_load_dwordx4 v14, s[56:59], s64 offen lds
v_mfma_f32_16x16x32_bf16 v[148:151], a[96:99], a[24:27], 0
ds_read_b64_tr_b16 a[88:89], v19 offset:0
v_cvt_pk_bf16_f32 v253, v250, v251
v_mfma_f32_16x16x32_bf16 v[148:151], a[100:103], a[28:31], v[148:151]
ds_read_b64_tr_b16 a[90:91], v19 offset:256
v_mfma_f32_16x16x32_bf16 v[132:135], a[100:103], a[20:23], 0
ds_read_b64_tr_b16 a[92:93], v19 offset:2048
v_mfma_f32_16x16x32_bf16 v[132:135], a[96:99], a[16:19], v[132:135]
s_add_u32 s65, s79, 16384
ds_read_b64_tr_b16 a[94:95], v19 offset:2304
v_mfma_f32_16x16x32_bf16 v[116:119], a[96:99], a[8:11], 0
buffer_store_dwordx4 a[144:147], v16, s[44:47], s65 offen sc1
v_mfma_f32_16x16x32_bf16 v[116:119], a[100:103], a[12:15], v[116:119]
buffer_store_dwordx4 v[252:255], v16, s[44:47], s67 offen sc1
v_mfma_f32_16x16x32_bf16 v[100:103], a[100:103], a[4:7], 0
s_add_u32 m0, s78, 151552
v_mfma_f32_16x16x32_bf16 v[100:103], a[96:99], a[0:3], v[100:103]
s_waitcnt lgkmcnt(4)
s_add_u32 s64, s75, 1181696
ds_read_b64_tr_b16 a[96:97], v20 offset:0
v_accvgpr_read_b32 v248, a120
v_mfma_f32_16x16x32_bf16 v[184:187], a[104:107], a[32:35], v[184:187]
buffer_load_dwordx4 v23, s[60:63], s64 offen lds
v_mfma_f32_16x16x32_bf16 v[184:187], a[108:111], a[36:39], v[184:187]
ds_read_b64_tr_b16 a[98:99], v20 offset:256
v_accvgpr_read_b32 v249, a121
v_mfma_f32_16x16x32_bf16 v[192:195], a[108:111], a[44:47], v[192:195]
ds_read_b64_tr_b16 a[100:101], v20 offset:2048
v_accvgpr_read_b32 v250, a122
v_mfma_f32_16x16x32_bf16 v[192:195], a[104:107], a[40:43], v[192:195]
ds_read_b64_tr_b16 a[102:103], v20 offset:2304
v_accvgpr_read_b32 v251, a123
v_mfma_f32_16x16x32_bf16 v[200:203], a[104:107], a[48:51], v[200:203]
v_accvgpr_read_b32 v252, a124
v_accvgpr_read_b32 v253, a125
v_mfma_f32_16x16x32_bf16 v[200:203], a[108:111], a[52:55], v[200:203]
v_accvgpr_read_b32 v254, a126
v_accvgpr_read_b32 v255, a127
v_mfma_f32_16x16x32_bf16 v[208:211], a[108:111], a[60:63], v[208:211]
v_cvt_pk_bf16_f32 v255, v254, v255
v_cvt_pk_bf16_f32 v254, v252, v253
v_mfma_f32_16x16x32_bf16 v[208:211], a[104:107], a[56:59], v[208:211]
ds_read_b64_tr_b16 a[104:105], v4 offset:0
v_cvt_pk_bf16_f32 v252, v248, v249
v_mfma_f32_16x16x32_bf16 v[212:215], a[112:115], a[56:59], v[212:215]
s_xor_b32 m0, s77, 133120
ds_read_b64_tr_b16 a[106:107], v4 offset:1024
v_cvt_pk_bf16_f32 v253, v250, v251
v_mfma_f32_16x16x32_bf16 v[212:215], a[116:119], a[60:63], v[212:215]
s_xor_b32 s64, s71, 1638400
ds_read_b64_tr_b16 a[108:109], v4 offset:8192
v_accvgpr_write_b32 a228, v252
v_mfma_f32_16x16x32_bf16 v[204:207], a[116:119], a[52:55], v[204:207]
buffer_load_dwordx4 v15, s[56:59], s64 offen lds
v_mfma_f32_16x16x32_bf16 v[204:207], a[112:115], a[48:51], v[204:207]
ds_read_b64_tr_b16 a[110:111], v4 offset:9216
v_accvgpr_write_b32 a229, v253
v_mfma_f32_16x16x32_bf16 v[196:199], a[112:115], a[40:43], v[196:199]
v_accvgpr_write_b32 a230, v254
v_accvgpr_write_b32 a231, v255
v_mfma_f32_16x16x32_bf16 v[196:199], a[116:119], a[44:47], v[196:199]
v_mfma_f32_16x16x32_bf16 v[188:191], a[116:119], a[36:39], v[188:191]
v_accvgpr_read_b32 v248, a132
v_accvgpr_read_b32 v249, a133
v_mfma_f32_16x16x32_bf16 v[188:191], a[112:115], a[32:35], v[188:191]
ds_read_b64_tr_b16 a[112:113], v5 offset:0
v_accvgpr_read_b32 v250, a134
v_mfma_f32_16x16x32_bf16 v[216:219], a[32:35], a[72:75], v[216:219]
ds_read_b64_tr_b16 a[114:115], v5 offset:1024
v_accvgpr_read_b32 v251, a135
v_mfma_f32_16x16x32_bf16 v[216:219], a[36:39], a[76:79], v[216:219]
s_add_u32 m0, s78, 155648
ds_read_b64_tr_b16 a[116:117], v5 offset:8192
v_accvgpr_read_b32 v252, a128
v_mfma_f32_16x16x32_bf16 v[224:227], a[44:47], a[76:79], v[224:227]
s_add_u32 s64, s75, 1183744
ds_read_b64_tr_b16 a[118:119], v5 offset:9216
v_accvgpr_read_b32 v253, a129
v_mfma_f32_16x16x32_bf16 v[224:227], a[40:43], a[72:75], v[224:227]
buffer_load_dwordx4 v23, s[60:63], s64 offen lds
v_mfma_f32_16x16x32_bf16 v[232:235], a[48:51], a[72:75], v[232:235]
v_accvgpr_read_b32 v254, a130
v_accvgpr_read_b32 v255, a131
v_mfma_f32_16x16x32_bf16 v[232:235], a[52:55], a[76:79], v[232:235]
v_cvt_pk_bf16_f32 v255, v254, v255
v_cvt_pk_bf16_f32 v254, v252, v253
v_mfma_f32_16x16x32_bf16 v[240:243], a[60:63], a[76:79], v[240:243]
v_cvt_pk_bf16_f32 v252, v248, v249
v_cvt_pk_bf16_f32 v253, v250, v251
v_mfma_f32_16x16x32_bf16 v[240:243], a[56:59], a[72:75], v[240:243]
ds_read_b64_tr_b16 a[72:73], v6 offset:0
v_accvgpr_write_b32 a232, v252
v_mfma_f32_16x16x32_bf16 v[244:247], a[56:59], a[80:83], v[244:247]
ds_read_b64_tr_b16 a[74:75], v6 offset:1024
v_accvgpr_write_b32 a233, v253
v_mfma_f32_16x16x32_bf16 v[244:247], a[60:63], a[84:87], v[244:247]
ds_read_b64_tr_b16 a[76:77], v6 offset:8192
v_accvgpr_write_b32 a234, v254
v_mfma_f32_16x16x32_bf16 v[236:239], a[52:55], a[84:87], v[236:239]
s_xor_b32 m0, s77, 134144
ds_read_b64_tr_b16 a[78:79], v6 offset:9216
v_accvgpr_write_b32 a235, v255
v_mfma_f32_16x16x32_bf16 v[236:239], a[48:51], a[80:83], v[236:239]
s_xor_b32 s64, s71, 1671168
v_mfma_f32_16x16x32_bf16 v[228:231], a[40:43], a[80:83], v[228:231]
buffer_load_dwordx4 v15, s[56:59], s64 offen lds
v_mfma_f32_16x16x32_bf16 v[228:231], a[44:47], a[84:87], v[228:231]
v_accvgpr_read_b32 v248, a140
v_accvgpr_read_b32 v249, a141
v_mfma_f32_16x16x32_bf16 v[220:223], a[36:39], a[84:87], v[220:223]
v_accvgpr_read_b32 v250, a142
v_accvgpr_read_b32 v251, a143
v_mfma_f32_16x16x32_bf16 v[220:223], a[32:35], a[80:83], v[220:223]
s_waitcnt lgkmcnt(4)
ds_read_b64_tr_b16 a[80:81], v7 offset:0
v_accvgpr_read_b32 v252, a136
v_mfma_f32_16x16x32_bf16 v[152:155], a[88:91], a[32:35], v[152:155]
ds_read_b64_tr_b16 a[82:83], v7 offset:1024
v_accvgpr_read_b32 v253, a137
v_mfma_f32_16x16x32_bf16 v[152:155], a[92:95], a[36:39], v[152:155]
ds_read_b64_tr_b16 a[84:85], v7 offset:8192
v_accvgpr_read_b32 v254, a138
v_mfma_f32_16x16x32_bf16 v[160:163], a[92:95], a[44:47], v[160:163]
ds_read_b64_tr_b16 a[86:87], v7 offset:9216
v_accvgpr_read_b32 v255, a139
v_mfma_f32_16x16x32_bf16 v[160:163], a[88:91], a[40:43], v[160:163]
v_cvt_pk_bf16_f32 v255, v254, v255
v_cvt_pk_bf16_f32 v254, v252, v253
v_mfma_f32_16x16x32_bf16 v[168:171], a[88:91], a[48:51], v[168:171]
v_cvt_pk_bf16_f32 v252, v248, v249
v_cvt_pk_bf16_f32 v253, v250, v251
v_mfma_f32_16x16x32_bf16 v[168:171], a[92:95], a[52:55], v[168:171]
v_accvgpr_write_b32 a236, v252
v_accvgpr_write_b32 a237, v253
v_mfma_f32_16x16x32_bf16 v[176:179], a[92:95], a[60:63], v[176:179]
s_xor_b32 m0, s84, 32768
v_accvgpr_write_b32 a238, v254
v_accvgpr_write_b32 a239, v255
v_mfma_f32_16x16x32_bf16 v[176:179], a[88:91], a[56:59], v[176:179]
s_xor_b32 s64, s72, 384
ds_read_b64_tr_b16 a[88:89], v8 offset:0
v_mfma_f32_16x16x32_bf16 v[180:183], a[96:99], a[56:59], v[180:183]
s_add_u32 s65, s79, 4096
buffer_load_dwordx4 v12, s[48:51], s64 offen lds
v_mfma_f32_16x16x32_bf16 v[180:183], a[100:103], a[60:63], v[180:183]
buffer_store_dwordx4 a[148:151], v16, s[44:47], s65 offen sc1
v_mfma_f32_16x16x32_bf16 v[172:175], a[100:103], a[52:55], v[172:175]
ds_read_b64_tr_b16 a[90:91], v8 offset:1024
v_mfma_f32_16x16x32_bf16 v[172:175], a[96:99], a[48:51], v[172:175]
s_xor_b32 m0, s84, 33792
ds_read_b64_tr_b16 a[92:93], v8 offset:8192
v_mfma_f32_16x16x32_bf16 v[164:167], a[96:99], a[40:43], v[164:167]
s_xor_b32 s64, s72, 16768
ds_read_b64_tr_b16 a[94:95], v8 offset:9216
v_mfma_f32_16x16x32_bf16 v[164:167], a[100:103], a[44:47], v[164:167]
buffer_load_dwordx4 v13, s[48:51], s64 offen lds
v_mfma_f32_16x16x32_bf16 v[156:159], a[100:103], a[36:39], v[156:159]
v_mfma_f32_16x16x32_bf16 v[156:159], a[96:99], a[32:35], v[156:159]
ds_read_b64_tr_b16 a[96:97], v9 offset:0
v_mfma_f32_16x16x32_bf16 v[24:27], a[104:107], a[32:35], v[24:27]
s_xor_b32 m0, s84, 34816
ds_read_b64_tr_b16 a[98:99], v9 offset:1024
v_mfma_f32_16x16x32_bf16 v[24:27], a[108:111], a[36:39], v[24:27]
s_xor_b32 s64, s72, 131456
ds_read_b64_tr_b16 a[100:101], v9 offset:8192
v_mfma_f32_16x16x32_bf16 v[40:43], a[108:111], a[44:47], v[40:43]
buffer_load_dwordx4 v12, s[48:51], s64 offen lds
v_mfma_f32_16x16x32_bf16 v[40:43], a[104:107], a[40:43], v[40:43]
ds_read_b64_tr_b16 a[102:103], v9 offset:9216
v_mfma_f32_16x16x32_bf16 v[56:59], a[104:107], a[48:51], v[56:59]
v_mfma_f32_16x16x32_bf16 v[56:59], a[108:111], a[52:55], v[56:59]
s_xor_b32 m0, s84, 35840
v_mfma_f32_16x16x32_bf16 v[72:75], a[108:111], a[60:63], v[72:75]
s_waitcnt vmcnt(14)
s_xor_b32 s64, s72, 147840
ds_read_b128 a[0:3], v2 offset:0
v_mfma_f32_16x16x32_bf16 v[72:75], a[104:107], a[56:59], v[72:75]
buffer_load_dwordx4 v13, s[48:51], s64 offen lds
v_mfma_f32_16x16x32_bf16 v[136:139], a[112:115], a[56:59], v[136:139]
ds_read_b128 a[4:7], v3 offset:0
v_mfma_f32_16x16x32_bf16 v[136:139], a[116:119], a[60:63], v[136:139]
ds_read_b128 a[8:11], v2 offset:2048
v_mfma_f32_16x16x32_bf16 v[120:123], a[116:119], a[52:55], v[120:123]
s_xor_b32 m0, s84, 36864
ds_read_b128 a[12:15], v3 offset:2048
v_mfma_f32_16x16x32_bf16 v[120:123], a[112:115], a[48:51], v[120:123]
s_xor_b32 s64, s73, 384
ds_read_b128 a[16:19], v2 offset:4096
v_mfma_f32_16x16x32_bf16 v[104:107], a[112:115], a[40:43], v[104:107]
buffer_load_dwordx4 v12, s[48:51], s64 offen lds
v_mfma_f32_16x16x32_bf16 v[104:107], a[116:119], a[44:47], v[104:107]
ds_read_b128 a[20:23], v3 offset:4096
v_mfma_f32_16x16x32_bf16 v[88:91], a[116:119], a[36:39], v[88:91]
ds_read_b128 a[24:27], v2 offset:6144
v_mfma_f32_16x16x32_bf16 v[88:91], a[112:115], a[32:35], v[88:91]
s_waitcnt lgkmcnt(7)
s_xor_b32 m0, s84, 37888
ds_read_b128 a[28:31], v3 offset:6144
v_mfma_f32_16x16x32_bf16 v[28:31], a[72:75], a[32:35], v[28:31]
s_xor_b32 s64, s73, 16768
ds_read_b64_tr_b16 a[104:105], v10 offset:0
v_mfma_f32_16x16x32_bf16 v[28:31], a[76:79], a[36:39], v[28:31]
buffer_load_dwordx4 v13, s[48:51], s64 offen lds
v_mfma_f32_16x16x32_bf16 v[44:47], a[76:79], a[44:47], v[44:47]
ds_read_b64_tr_b16 a[106:107], v10 offset:1024
v_mfma_f32_16x16x32_bf16 v[44:47], a[72:75], a[40:43], v[44:47]
ds_read_b64_tr_b16 a[108:109], v10 offset:8192
v_mfma_f32_16x16x32_bf16 v[60:63], a[72:75], a[48:51], v[60:63]
s_xor_b32 m0, s84, 38912
ds_read_b64_tr_b16 a[110:111], v10 offset:9216
v_mfma_f32_16x16x32_bf16 v[60:63], a[76:79], a[52:55], v[60:63]
s_xor_b32 s64, s73, 131456
ds_read_b64_tr_b16 a[112:113], v11 offset:0
v_mfma_f32_16x16x32_bf16 v[76:79], a[76:79], a[60:63], v[76:79]
buffer_load_dwordx4 v12, s[48:51], s64 offen lds
v_mfma_f32_16x16x32_bf16 v[76:79], a[72:75], a[56:59], v[76:79]
ds_read_b64_tr_b16 a[114:115], v11 offset:1024
v_mfma_f32_16x16x32_bf16 v[140:143], a[80:83], a[56:59], v[140:143]
ds_read_b64_tr_b16 a[116:117], v11 offset:8192
v_mfma_f32_16x16x32_bf16 v[140:143], a[84:87], a[60:63], v[140:143]
s_xor_b32 m0, s84, 39936
ds_read_b64_tr_b16 a[118:119], v11 offset:9216
v_mfma_f32_16x16x32_bf16 v[124:127], a[84:87], a[52:55], v[124:127]
s_xor_b32 s64, s73, 147840
v_mfma_f32_16x16x32_bf16 v[124:127], a[80:83], a[48:51], v[124:127]
buffer_load_dwordx4 v13, s[48:51], s64 offen lds
v_mfma_f32_16x16x32_bf16 v[108:111], a[80:83], a[40:43], v[108:111]
v_mfma_f32_16x16x32_bf16 v[108:111], a[84:87], a[44:47], v[108:111]
v_mfma_f32_16x16x32_bf16 v[92:95], a[84:87], a[36:39], v[92:95]
v_mfma_f32_16x16x32_bf16 v[92:95], a[80:83], a[32:35], v[92:95]
v_mfma_f32_16x16x32_bf16 v[32:35], a[88:91], a[32:35], v[32:35]
v_mfma_f32_16x16x32_bf16 v[32:35], a[92:95], a[36:39], v[32:35]
s_branch L_po7
L_pg7:
s_branch L_pg11
L_po7:
v_mfma_f32_16x16x32_bf16 v[48:51], a[92:95], a[44:47], v[48:51]
s_waitcnt lgkmcnt(0)
s_barrier
v_mfma_f32_16x16x32_bf16 v[48:51], a[88:91], a[40:43], v[48:51]
s_xor_b32 m0, s77, 65536
ds_read_b64_tr_b16 a[72:73], v19 offset:36864
v_mfma_f32_16x16x32_bf16 v[64:67], a[88:91], a[48:51], v[64:67]
s_xor_b32 s64, s71, 2097152
ds_read_b64_tr_b16 a[74:75], v19 offset:37120
v_mfma_f32_16x16x32_bf16 v[64:67], a[92:95], a[52:55], v[64:67]
s_add_u32 s65, s79, 0
buffer_load_dwordx4 v14, s[56:59], s64 offen lds
v_mfma_f32_16x16x32_bf16 v[80:83], a[92:95], a[60:63], v[80:83]
buffer_store_dwordx4 a[152:155], v16, s[44:47], s65 offen sc1
v_mfma_f32_16x16x32_bf16 v[80:83], a[88:91], a[56:59], v[80:83]
ds_read_b64_tr_b16 a[76:77], v19 offset:38912
v_mfma_f32_16x16x32_bf16 v[144:147], a[96:99], a[56:59], v[144:147]
ds_read_b64_tr_b16 a[78:79], v19 offset:39168
v_mfma_f32_16x16x32_bf16 v[144:147], a[100:103], a[60:63], v[144:147]
ds_read_b64_tr_b16 a[80:81], v20 offset:36864
v_mfma_f32_16x16x32_bf16 v[128:131], a[100:103], a[52:55], v[128:131]
ds_read_b64_tr_b16 a[82:83], v20 offset:37120
v_mfma_f32_16x16x32_bf16 v[128:131], a[96:99], a[48:51], v[128:131]
ds_read_b64_tr_b16 a[84:85], v20 offset:38912
v_mfma_f32_16x16x32_bf16 v[112:115], a[96:99], a[40:43], v[112:115]
s_add_u32 m0, s78, 81920
ds_read_b64_tr_b16 a[86:87], v20 offset:39168
v_mfma_f32_16x16x32_bf16 v[112:115], a[100:103], a[44:47], v[112:115]
s_add_u32 s64, s75, 1572864
ds_read_b64_tr_b16 a[88:89], v19 offset:40960
v_mfma_f32_16x16x32_bf16 v[96:99], a[100:103], a[36:39], v[96:99]
buffer_load_dwordx4 v23, s[60:63], s64 offen lds
v_mfma_f32_16x16x32_bf16 v[96:99], a[96:99], a[32:35], v[96:99]
ds_read_b64_tr_b16 a[90:91], v19 offset:41216
v_mfma_f32_16x16x32_bf16 v[36:39], a[104:107], a[32:35], v[36:39]
ds_read_b64_tr_b16 a[92:93], v19 offset:43008
v_mfma_f32_16x16x32_bf16 v[36:39], a[108:111], a[36:39], v[36:39]
ds_read_b64_tr_b16 a[94:95], v19 offset:43264
v_mfma_f32_16x16x32_bf16 v[52:55], a[108:111], a[44:47], v[52:55]
ds_read_b64_tr_b16 a[96:97], v20 offset:40960
v_mfma_f32_16x16x32_bf16 v[52:55], a[104:107], a[40:43], v[52:55]
ds_read_b64_tr_b16 a[98:99], v20 offset:41216
v_mfma_f32_16x16x32_bf16 v[68:71], a[104:107], a[48:51], v[68:71]
s_xor_b32 m0, s77, 66560
ds_read_b64_tr_b16 a[100:101], v20 offset:43008
v_mfma_f32_16x16x32_bf16 v[68:71], a[108:111], a[52:55], v[68:71]
s_xor_b32 s64, s71, 2129920
s_xor_b32 s68, s66, 4096
ds_read_b64_tr_b16 a[102:103], v20 offset:43264
v_mfma_f32_16x16x32_bf16 v[84:87], a[108:111], a[60:63], v[84:87]
s_mov_b64 exec, 1
buffer_atomic_add a251, v1, s[52:55], s68 offen offset:0 sc1
s_mov_b64 exec, -1
v_mfma_f32_16x16x32_bf16 v[84:87], a[104:107], a[56:59], v[84:87]
buffer_load_dwordx4 v14, s[56:59], s64 offen lds
v_mfma_f32_16x16x32_bf16 v[148:151], a[112:115], a[56:59], v[148:151]
ds_read_b64_tr_b16 a[104:105], v19 offset:32768
v_mfma_f32_16x16x32_bf16 v[148:151], a[116:119], a[60:63], v[148:151]
ds_read_b64_tr_b16 a[106:107], v19 offset:33024
v_mfma_f32_16x16x32_bf16 v[132:135], a[116:119], a[52:55], v[132:135]
ds_read_b64_tr_b16 a[108:109], v19 offset:34816
v_mfma_f32_16x16x32_bf16 v[132:135], a[112:115], a[48:51], v[132:135]
ds_read_b64_tr_b16 a[110:111], v19 offset:35072
v_mfma_f32_16x16x32_bf16 v[116:119], a[112:115], a[40:43], v[116:119]
v_mfma_f32_16x16x32_bf16 v[116:119], a[116:119], a[44:47], v[116:119]
v_mfma_f32_16x16x32_bf16 v[100:103], a[116:119], a[36:39], v[100:103]
s_add_u32 m0, s78, 86016
v_mfma_f32_16x16x32_bf16 v[100:103], a[112:115], a[32:35], v[100:103]
s_waitcnt lgkmcnt(4)
s_add_u32 s64, s75, 1574912
ds_read_b64_tr_b16 a[112:113], v20 offset:32768
v_mfma_f32_16x16x32_bf16 v[184:187], a[72:75], a[0:3], v[184:187]
buffer_load_dwordx4 v23, s[60:63], s64 offen lds
v_mfma_f32_16x16x32_bf16 v[184:187], a[76:79], a[4:7], v[184:187]
ds_read_b64_tr_b16 a[114:115], v20 offset:33024
v_mfma_f32_16x16x32_bf16 v[192:195], a[76:79], a[12:15], v[192:195]
ds_read_b64_tr_b16 a[116:117], v20 offset:34816
v_mfma_f32_16x16x32_bf16 v[192:195], a[72:75], a[8:11], v[192:195]
ds_read_b64_tr_b16 a[118:119], v20 offset:35072
v_mfma_f32_16x16x32_bf16 v[200:203], a[72:75], a[16:19], v[200:203]
v_mfma_f32_16x16x32_bf16 v[200:203], a[76:79], a[20:23], v[200:203]
v_mfma_f32_16x16x32_bf16 v[208:211], a[76:79], a[28:31], v[208:211]
v_mfma_f32_16x16x32_bf16 v[208:211], a[72:75], a[24:27], v[208:211]
ds_read_b64_tr_b16 a[72:73], v4 offset:32768
v_mfma_f32_16x16x32_bf16 v[212:215], a[80:83], a[24:27], v[212:215]
s_xor_b32 m0, s77, 67584
ds_read_b64_tr_b16 a[74:75], v4 offset:33792
v_mfma_f32_16x16x32_bf16 v[212:215], a[84:87], a[28:31], v[212:215]
s_xor_b32 s64, s71, 2162688
ds_read_b64_tr_b16 a[76:77], v4 offset:40960
v_mfma_f32_16x16x32_bf16 v[204:207], a[84:87], a[20:23], v[204:207]
buffer_load_dwordx4 v15, s[56:59], s64 offen lds
v_mfma_f32_16x16x32_bf16 v[204:207], a[80:83], a[16:19], v[204:207]
ds_read_b64_tr_b16 a[78:79], v4 offset:41984
v_mfma_f32_16x16x32_bf16 v[196:199], a[80:83], a[8:11], v[196:199]
v_mfma_f32_16x16x32_bf16 v[196:199], a[84:87], a[12:15], v[196:199]
v_mfma_f32_16x16x32_bf16 v[188:191], a[84:87], a[4:7], v[188:191]
v_mfma_f32_16x16x32_bf16 v[188:191], a[80:83], a[0:3], v[188:191]
ds_read_b64_tr_b16 a[80:81], v5 offset:32768
v_mfma_f32_16x16x32_bf16 v[216:219], a[0:3], a[88:91], v[216:219]
ds_read_b64_tr_b16 a[82:83], v5 offset:33792
v_mfma_f32_16x16x32_bf16 v[216:219], a[4:7], a[92:95], v[216:219]
s_add_u32 m0, s78, 90112
s_add_u32 s65, s79, 17408
ds_read_b64_tr_b16 a[84:85], v5 offset:40960
v_mfma_f32_16x16x32_bf16 v[224:227], a[12:15], a[92:95], v[224:227]
s_add_u32 s64, s75, 1576960
buffer_store_dwordx4 a[156:159], v16, s[44:47], s65 offen sc1
v_mfma_f32_16x16x32_bf16 v[224:227], a[8:11], a[88:91], v[224:227]
buffer_load_dwordx4 v23, s[60:63], s64 offen lds
v_mfma_f32_16x16x32_bf16 v[232:235], a[16:19], a[88:91], v[232:235]
ds_read_b64_tr_b16 a[86:87], v5 offset:41984
v_mfma_f32_16x16x32_bf16 v[232:235], a[20:23], a[92:95], v[232:235]
v_mfma_f32_16x16x32_bf16 v[240:243], a[28:31], a[92:95], v[240:243]
v_mfma_f32_16x16x32_bf16 v[240:243], a[24:27], a[88:91], v[240:243]
ds_read_b64_tr_b16 a[88:89], v6 offset:32768
v_mfma_f32_16x16x32_bf16 v[244:247], a[24:27], a[96:99], v[244:247]
ds_read_b64_tr_b16 a[90:91], v6 offset:33792
v_mfma_f32_16x16x32_bf16 v[244:247], a[28:31], a[100:103], v[244:247]
ds_read_b64_tr_b16 a[92:93], v6 offset:40960
v_add_u32 v19, 0x8000, v19
v_mfma_f32_16x16x32_bf16 v[236:239], a[20:23], a[100:103], v[236:239]
s_xor_b32 m0, s77, 68608
ds_read_b64_tr_b16 a[94:95], v6 offset:41984
v_mfma_f32_16x16x32_bf16 v[236:239], a[16:19], a[96:99], v[236:239]
s_xor_b32 s64, s71, 2195456
v_mfma_f32_16x16x32_bf16 v[228:231], a[8:11], a[96:99], v[228:231]
buffer_load_dwordx4 v15, s[56:59], s64 offen lds
v_mfma_f32_16x16x32_bf16 v[228:231], a[12:15], a[100:103], v[228:231]
v_mfma_f32_16x16x32_bf16 v[220:223], a[4:7], a[100:103], v[220:223]
v_mfma_f32_16x16x32_bf16 v[220:223], a[0:3], a[96:99], v[220:223]
s_waitcnt lgkmcnt(4)
ds_read_b64_tr_b16 a[96:97], v7 offset:32768
v_mfma_f32_16x16x32_bf16 v[152:155], a[104:107], a[0:3], v[152:155]
ds_read_b64_tr_b16 a[98:99], v7 offset:33792
v_mfma_f32_16x16x32_bf16 v[152:155], a[108:111], a[4:7], v[152:155]
ds_read_b64_tr_b16 a[100:101], v7 offset:40960
v_add_u32 v20, 0x8000, v20
v_mfma_f32_16x16x32_bf16 v[160:163], a[108:111], a[12:15], v[160:163]
ds_read_b64_tr_b16 a[102:103], v7 offset:41984
v_mfma_f32_16x16x32_bf16 v[160:163], a[104:107], a[8:11], v[160:163]
v_mfma_f32_16x16x32_bf16 v[168:171], a[104:107], a[16:19], v[168:171]
v_mfma_f32_16x16x32_bf16 v[168:171], a[108:111], a[20:23], v[168:171]
v_mfma_f32_16x16x32_bf16 v[176:179], a[108:111], a[28:31], v[176:179]
s_xor_b32 m0, s84, 0
v_mfma_f32_16x16x32_bf16 v[176:179], a[104:107], a[24:27], v[176:179]
s_xor_b32 s64, s72, 512
ds_read_b64_tr_b16 a[104:105], v8 offset:32768
v_mfma_f32_16x16x32_bf16 v[180:183], a[112:115], a[24:27], v[180:183]
buffer_load_dwordx4 v12, s[48:51], s64 offen lds
v_mfma_f32_16x16x32_bf16 v[180:183], a[116:119], a[28:31], v[180:183]
ds_read_b64_tr_b16 a[106:107], v8 offset:33792
v_add_u32 v4, 0x8000, v4
v_mfma_f32_16x16x32_bf16 v[172:175], a[116:119], a[20:23], v[172:175]
ds_read_b64_tr_b16 a[108:109], v8 offset:40960
v_mfma_f32_16x16x32_bf16 v[172:175], a[112:115], a[16:19], v[172:175]
s_xor_b32 m0, s84, 1024
ds_read_b64_tr_b16 a[110:111], v8 offset:41984
v_mfma_f32_16x16x32_bf16 v[164:167], a[112:115], a[8:11], v[164:167]
s_xor_b32 s64, s72, 16896
v_mfma_f32_16x16x32_bf16 v[164:167], a[116:119], a[12:15], v[164:167]
buffer_load_dwordx4 v13, s[48:51], s64 offen lds
v_mfma_f32_16x16x32_bf16 v[156:159], a[116:119], a[4:7], v[156:159]
v_mfma_f32_16x16x32_bf16 v[156:159], a[112:115], a[0:3], v[156:159]
ds_read_b64_tr_b16 a[112:113], v9 offset:32768
v_mfma_f32_16x16x32_bf16 v[24:27], a[72:75], a[0:3], v[24:27]
s_xor_b32 m0, s84, 2048
ds_read_b64_tr_b16 a[114:115], v9 offset:33792
v_mfma_f32_16x16x32_bf16 v[24:27], a[76:79], a[4:7], v[24:27]
s_xor_b32 s64, s72, 131584
ds_read_b64_tr_b16 a[116:117], v9 offset:40960
v_add_u32 v5, 0x8000, v5
v_mfma_f32_16x16x32_bf16 v[40:43], a[76:79], a[12:15], v[40:43]
buffer_load_dwordx4 v12, s[48:51], s64 offen lds
v_mfma_f32_16x16x32_bf16 v[40:43], a[72:75], a[8:11], v[40:43]
ds_read_b64_tr_b16 a[118:119], v9 offset:41984
v_mfma_f32_16x16x32_bf16 v[56:59], a[72:75], a[16:19], v[56:59]
v_mfma_f32_16x16x32_bf16 v[56:59], a[76:79], a[20:23], v[56:59]
s_xor_b32 m0, s84, 3072
v_mfma_f32_16x16x32_bf16 v[72:75], a[76:79], a[28:31], v[72:75]
s_waitcnt vmcnt(13)
s_xor_b32 s64, s72, 147968
ds_read_b128 a[32:35], v2 offset:32768
v_mfma_f32_16x16x32_bf16 v[72:75], a[72:75], a[24:27], v[72:75]
buffer_load_dwordx4 v13, s[48:51], s64 offen lds
v_mfma_f32_16x16x32_bf16 v[136:139], a[80:83], a[24:27], v[136:139]
ds_read_b128 a[36:39], v3 offset:32768
v_mfma_f32_16x16x32_bf16 v[136:139], a[84:87], a[28:31], v[136:139]
ds_read_b128 a[40:43], v2 offset:34816
v_add_u32 v6, 0x8000, v6
v_mfma_f32_16x16x32_bf16 v[120:123], a[84:87], a[20:23], v[120:123]
s_xor_b32 m0, s84, 4096
ds_read_b128 a[44:47], v3 offset:34816
v_mfma_f32_16x16x32_bf16 v[120:123], a[80:83], a[16:19], v[120:123]
s_xor_b32 s64, s73, 512
ds_read_b128 a[48:51], v2 offset:36864
v_mfma_f32_16x16x32_bf16 v[104:107], a[80:83], a[8:11], v[104:107]
buffer_load_dwordx4 v12, s[48:51], s64 offen lds
v_mfma_f32_16x16x32_bf16 v[104:107], a[84:87], a[12:15], v[104:107]
ds_read_b128 a[52:55], v3 offset:36864
v_mfma_f32_16x16x32_bf16 v[88:91], a[84:87], a[4:7], v[88:91]
s_add_u32 s65, s79, 5120
ds_read_b128 a[56:59], v2 offset:38912
v_mfma_f32_16x16x32_bf16 v[88:91], a[80:83], a[0:3], v[88:91]
s_waitcnt lgkmcnt(7)
s_xor_b32 m0, s84, 5120
buffer_store_dwordx4 a[160:163], v16, s[44:47], s65 offen sc1
v_mfma_f32_16x16x32_bf16 v[28:31], a[88:91], a[0:3], v[28:31]
s_xor_b32 s64, s73, 16896
ds_read_b128 a[60:63], v3 offset:38912
v_mfma_f32_16x16x32_bf16 v[28:31], a[92:95], a[4:7], v[28:31]
buffer_load_dwordx4 v13, s[48:51], s64 offen lds
v_mfma_f32_16x16x32_bf16 v[44:47], a[92:95], a[12:15], v[44:47]
ds_read_b64_tr_b16 a[72:73], v10 offset:32768
v_add_u32 v7, 0x8000, v7
v_mfma_f32_16x16x32_bf16 v[44:47], a[88:91], a[8:11], v[44:47]
ds_read_b64_tr_b16 a[74:75], v10 offset:33792
v_mfma_f32_16x16x32_bf16 v[60:63], a[88:91], a[16:19], v[60:63]
s_xor_b32 m0, s84, 6144
ds_read_b64_tr_b16 a[76:77], v10 offset:40960
v_mfma_f32_16x16x32_bf16 v[60:63], a[92:95], a[20:23], v[60:63]
s_xor_b32 s64, s73, 131584
ds_read_b64_tr_b16 a[78:79], v10 offset:41984
v_mfma_f32_16x16x32_bf16 v[76:79], a[92:95], a[28:31], v[76:79]
buffer_load_dwordx4 v12, s[48:51], s64 offen lds
v_mfma_f32_16x16x32_bf16 v[76:79], a[88:91], a[24:27], v[76:79]
ds_read_b64_tr_b16 a[80:81], v11 offset:32768
v_mfma_f32_16x16x32_bf16 v[140:143], a[96:99], a[24:27], v[140:143]
ds_read_b64_tr_b16 a[82:83], v11 offset:33792
v_mfma_f32_16x16x32_bf16 v[140:143], a[100:103], a[28:31], v[140:143]
s_xor_b32 m0, s84, 7168
ds_read_b64_tr_b16 a[84:85], v11 offset:40960
v_add_u32 v8, 0x8000, v8
v_mfma_f32_16x16x32_bf16 v[124:127], a[100:103], a[20:23], v[124:127]
s_xor_b32 s64, s73, 147968
ds_read_b64_tr_b16 a[86:87], v11 offset:41984
v_mfma_f32_16x16x32_bf16 v[124:127], a[96:99], a[16:19], v[124:127]
buffer_load_dwordx4 v13, s[48:51], s64 offen lds
v_mfma_f32_16x16x32_bf16 v[108:111], a[96:99], a[8:11], v[108:111]
v_mfma_f32_16x16x32_bf16 v[108:111], a[100:103], a[12:15], v[108:111]
v_mfma_f32_16x16x32_bf16 v[92:95], a[100:103], a[4:7], v[92:95]
v_add_u32 v9, 0x8000, v9
v_add_u32 v10, 0x8000, v10
v_mfma_f32_16x16x32_bf16 v[92:95], a[96:99], a[0:3], v[92:95]
v_add_u32 v11, 0x8000, v11
v_mfma_f32_16x16x32_bf16 v[32:35], a[104:107], a[0:3], v[32:35]
v_mfma_f32_16x16x32_bf16 v[32:35], a[108:111], a[4:7], v[32:35]
v_mfma_f32_16x16x32_bf16 v[48:51], a[108:111], a[12:15], v[48:51]
s_waitcnt lgkmcnt(0)
s_barrier
v_mfma_f32_16x16x32_bf16 v[48:51], a[104:107], a[8:11], v[48:51]
s_xor_b32 m0, s77, 98304
ds_read_b64_tr_b16 a[88:89], v19 offset:36864
v_mfma_f32_16x16x32_bf16 v[64:67], a[104:107], a[16:19], v[64:67]
s_xor_b32 s64, s71, 2621440
ds_read_b64_tr_b16 a[90:91], v19 offset:37120
v_mfma_f32_16x16x32_bf16 v[64:67], a[108:111], a[20:23], v[64:67]
buffer_load_dwordx4 v14, s[56:59], s64 offen lds
v_mfma_f32_16x16x32_bf16 v[80:83], a[108:111], a[28:31], v[80:83]
ds_read_b64_tr_b16 a[92:93], v19 offset:38912
v_mfma_f32_16x16x32_bf16 v[80:83], a[104:107], a[24:27], v[80:83]
ds_read_b64_tr_b16 a[94:95], v19 offset:39168
v_mfma_f32_16x16x32_bf16 v[144:147], a[112:115], a[24:27], v[144:147]
ds_read_b64_tr_b16 a[96:97], v20 offset:36864
v_mfma_f32_16x16x32_bf16 v[144:147], a[116:119], a[28:31], v[144:147]
ds_read_b64_tr_b16 a[98:99], v20 offset:37120
v_mfma_f32_16x16x32_bf16 v[128:131], a[116:119], a[20:23], v[128:131]
ds_read_b64_tr_b16 a[100:101], v20 offset:38912
v_mfma_f32_16x16x32_bf16 v[128:131], a[112:115], a[16:19], v[128:131]
ds_read_b64_tr_b16 a[102:103], v20 offset:39168
v_mfma_f32_16x16x32_bf16 v[112:115], a[112:115], a[8:11], v[112:115]
s_add_u32 m0, s78, 114688
ds_read_b64_tr_b16 a[104:105], v19 offset:40960
v_mfma_f32_16x16x32_bf16 v[112:115], a[116:119], a[12:15], v[112:115]
s_add_u32 s64, s75, 1966080
ds_read_b64_tr_b16 a[106:107], v19 offset:41216
v_mfma_f32_16x16x32_bf16 v[96:99], a[116:119], a[4:7], v[96:99]
buffer_load_dwordx4 v23, s[60:63], s64 offen lds
v_mfma_f32_16x16x32_bf16 v[96:99], a[112:115], a[0:3], v[96:99]
ds_read_b64_tr_b16 a[108:109], v19 offset:43008
v_mfma_f32_16x16x32_bf16 v[36:39], a[72:75], a[0:3], v[36:39]
ds_read_b64_tr_b16 a[110:111], v19 offset:43264
v_mfma_f32_16x16x32_bf16 v[36:39], a[76:79], a[4:7], v[36:39]
ds_read_b64_tr_b16 a[112:113], v20 offset:40960
v_mfma_f32_16x16x32_bf16 v[52:55], a[76:79], a[12:15], v[52:55]
ds_read_b64_tr_b16 a[114:115], v20 offset:41216
v_mfma_f32_16x16x32_bf16 v[52:55], a[72:75], a[8:11], v[52:55]
ds_read_b64_tr_b16 a[116:117], v20 offset:43008
v_mfma_f32_16x16x32_bf16 v[68:71], a[72:75], a[16:19], v[68:71]
s_xor_b32 m0, s77, 99328
ds_read_b64_tr_b16 a[118:119], v20 offset:43264
v_mfma_f32_16x16x32_bf16 v[68:71], a[76:79], a[20:23], v[68:71]
s_xor_b32 s64, s71, 2654208
s_xor_b32 s68, s66, 8192
v_mfma_f32_16x16x32_bf16 v[84:87], a[76:79], a[28:31], v[84:87]
s_mov_b64 exec, 1
buffer_atomic_add a251, v1, s[52:55], s68 offen offset:0 sc1
s_mov_b64 exec, -1
v_mfma_f32_16x16x32_bf16 v[84:87], a[72:75], a[24:27], v[84:87]
buffer_load_dwordx4 v14, s[56:59], s64 offen lds
v_mfma_f32_16x16x32_bf16 v[148:151], a[80:83], a[24:27], v[148:151]
ds_read_b64_tr_b16 a[72:73], v19 offset:32768
v_mfma_f32_16x16x32_bf16 v[148:151], a[84:87], a[28:31], v[148:151]
ds_read_b64_tr_b16 a[74:75], v19 offset:33024
v_mfma_f32_16x16x32_bf16 v[132:135], a[84:87], a[20:23], v[132:135]
s_add_u32 s65, s79, 1024
ds_read_b64_tr_b16 a[76:77], v19 offset:34816
v_mfma_f32_16x16x32_bf16 v[132:135], a[80:83], a[16:19], v[132:135]
buffer_store_dwordx4 a[164:167], v16, s[44:47], s65 offen sc1
v_mfma_f32_16x16x32_bf16 v[116:119], a[80:83], a[8:11], v[116:119]
ds_read_b64_tr_b16 a[78:79], v19 offset:35072
v_mfma_f32_16x16x32_bf16 v[116:119], a[84:87], a[12:15], v[116:119]
v_mfma_f32_16x16x32_bf16 v[100:103], a[84:87], a[4:7], v[100:103]
s_add_u32 m0, s78, 118784
v_mfma_f32_16x16x32_bf16 v[100:103], a[80:83], a[0:3], v[100:103]
s_waitcnt lgkmcnt(4)
s_add_u32 s64, s75, 1968128
ds_read_b64_tr_b16 a[80:81], v20 offset:32768
v_mfma_f32_16x16x32_bf16 v[184:187], a[88:91], a[32:35], v[184:187]
buffer_load_dwordx4 v23, s[60:63], s64 offen lds
v_mfma_f32_16x16x32_bf16 v[184:187], a[92:95], a[36:39], v[184:187]
ds_read_b64_tr_b16 a[82:83], v20 offset:33024
v_mfma_f32_16x16x32_bf16 v[192:195], a[92:95], a[44:47], v[192:195]
ds_read_b64_tr_b16 a[84:85], v20 offset:34816
v_mfma_f32_16x16x32_bf16 v[192:195], a[88:91], a[40:43], v[192:195]
ds_read_b64_tr_b16 a[86:87], v20 offset:35072
v_mfma_f32_16x16x32_bf16 v[200:203], a[88:91], a[48:51], v[200:203]
v_mfma_f32_16x16x32_bf16 v[200:203], a[92:95], a[52:55], v[200:203]
v_mfma_f32_16x16x32_bf16 v[208:211], a[92:95], a[60:63], v[208:211]
v_mfma_f32_16x16x32_bf16 v[208:211], a[88:91], a[56:59], v[208:211]
ds_read_b64_tr_b16 a[88:89], v4 offset:32768
v_mfma_f32_16x16x32_bf16 v[212:215], a[96:99], a[56:59], v[212:215]
s_xor_b32 m0, s77, 100352
ds_read_b64_tr_b16 a[90:91], v4 offset:33792
v_mfma_f32_16x16x32_bf16 v[212:215], a[100:103], a[60:63], v[212:215]
s_xor_b32 s64, s71, 2686976
ds_read_b64_tr_b16 a[92:93], v4 offset:40960
v_mfma_f32_16x16x32_bf16 v[204:207], a[100:103], a[52:55], v[204:207]
buffer_load_dwordx4 v15, s[56:59], s64 offen lds
v_mfma_f32_16x16x32_bf16 v[204:207], a[96:99], a[48:51], v[204:207]
ds_read_b64_tr_b16 a[94:95], v4 offset:41984
v_mfma_f32_16x16x32_bf16 v[196:199], a[96:99], a[40:43], v[196:199]
v_mfma_f32_16x16x32_bf16 v[196:199], a[100:103], a[44:47], v[196:199]
v_mfma_f32_16x16x32_bf16 v[188:191], a[100:103], a[36:39], v[188:191]
v_mfma_f32_16x16x32_bf16 v[188:191], a[96:99], a[32:35], v[188:191]
ds_read_b64_tr_b16 a[96:97], v5 offset:32768
v_mfma_f32_16x16x32_bf16 v[216:219], a[32:35], a[104:107], v[216:219]
ds_read_b64_tr_b16 a[98:99], v5 offset:33792
v_mfma_f32_16x16x32_bf16 v[216:219], a[36:39], a[108:111], v[216:219]
s_add_u32 m0, s78, 122880
ds_read_b64_tr_b16 a[100:101], v5 offset:40960
v_mfma_f32_16x16x32_bf16 v[224:227], a[44:47], a[108:111], v[224:227]
s_add_u32 s64, s75, 1970176
ds_read_b64_tr_b16 a[102:103], v5 offset:41984
v_mfma_f32_16x16x32_bf16 v[224:227], a[40:43], a[104:107], v[224:227]
buffer_load_dwordx4 v23, s[60:63], s64 offen lds
v_mfma_f32_16x16x32_bf16 v[232:235], a[48:51], a[104:107], v[232:235]
v_mfma_f32_16x16x32_bf16 v[232:235], a[52:55], a[108:111], v[232:235]
v_mfma_f32_16x16x32_bf16 v[240:243], a[60:63], a[108:111], v[240:243]
v_mfma_f32_16x16x32_bf16 v[240:243], a[56:59], a[104:107], v[240:243]
ds_read_b64_tr_b16 a[104:105], v6 offset:32768
v_mfma_f32_16x16x32_bf16 v[244:247], a[56:59], a[112:115], v[244:247]
ds_read_b64_tr_b16 a[106:107], v6 offset:33792
v_mfma_f32_16x16x32_bf16 v[244:247], a[60:63], a[116:119], v[244:247]
ds_read_b64_tr_b16 a[108:109], v6 offset:40960
v_subrev_u32 v19, 0x8000, v19
v_mfma_f32_16x16x32_bf16 v[236:239], a[52:55], a[116:119], v[236:239]
s_xor_b32 m0, s77, 101376
ds_read_b64_tr_b16 a[110:111], v6 offset:41984
v_mfma_f32_16x16x32_bf16 v[236:239], a[48:51], a[112:115], v[236:239]
s_xor_b32 s64, s71, 2719744
v_mfma_f32_16x16x32_bf16 v[228:231], a[40:43], a[112:115], v[228:231]
buffer_load_dwordx4 v15, s[56:59], s64 offen lds
v_mfma_f32_16x16x32_bf16 v[228:231], a[44:47], a[116:119], v[228:231]
v_mfma_f32_16x16x32_bf16 v[220:223], a[36:39], a[116:119], v[220:223]
v_mfma_f32_16x16x32_bf16 v[220:223], a[32:35], a[112:115], v[220:223]
s_waitcnt lgkmcnt(4)
ds_read_b64_tr_b16 a[112:113], v7 offset:32768
v_mfma_f32_16x16x32_bf16 v[152:155], a[72:75], a[32:35], v[152:155]
ds_read_b64_tr_b16 a[114:115], v7 offset:33792
v_mfma_f32_16x16x32_bf16 v[152:155], a[76:79], a[36:39], v[152:155]
ds_read_b64_tr_b16 a[116:117], v7 offset:40960
v_subrev_u32 v20, 0x8000, v20
v_mfma_f32_16x16x32_bf16 v[160:163], a[76:79], a[44:47], v[160:163]
ds_read_b64_tr_b16 a[118:119], v7 offset:41984
v_mfma_f32_16x16x32_bf16 v[160:163], a[72:75], a[40:43], v[160:163]
v_mfma_f32_16x16x32_bf16 v[168:171], a[72:75], a[48:51], v[168:171]
v_mfma_f32_16x16x32_bf16 v[168:171], a[76:79], a[52:55], v[168:171]
v_mfma_f32_16x16x32_bf16 v[176:179], a[76:79], a[60:63], v[176:179]
s_xor_b32 m0, s84, 32768
v_mfma_f32_16x16x32_bf16 v[176:179], a[72:75], a[56:59], v[176:179]
s_xor_b32 s64, s72, 640
ds_read_b64_tr_b16 a[72:73], v8 offset:32768
v_mfma_f32_16x16x32_bf16 v[180:183], a[80:83], a[56:59], v[180:183]
s_add_u32 s65, s79, 18432
buffer_load_dwordx4 v12, s[48:51], s64 offen lds
v_mfma_f32_16x16x32_bf16 v[180:183], a[84:87], a[60:63], v[180:183]
buffer_store_dwordx4 a[168:171], v16, s[44:47], s65 offen sc1
v_mfma_f32_16x16x32_bf16 v[172:175], a[84:87], a[52:55], v[172:175]
ds_read_b64_tr_b16 a[74:75], v8 offset:33792
v_subrev_u32 v4, 0x8000, v4
v_mfma_f32_16x16x32_bf16 v[172:175], a[80:83], a[48:51], v[172:175]
s_xor_b32 m0, s84, 33792
ds_read_b64_tr_b16 a[76:77], v8 offset:40960
v_mfma_f32_16x16x32_bf16 v[164:167], a[80:83], a[40:43], v[164:167]
s_xor_b32 s64, s72, 17024
ds_read_b64_tr_b16 a[78:79], v8 offset:41984
v_mfma_f32_16x16x32_bf16 v[164:167], a[84:87], a[44:47], v[164:167]
buffer_load_dwordx4 v13, s[48:51], s64 offen lds
v_mfma_f32_16x16x32_bf16 v[156:159], a[84:87], a[36:39], v[156:159]
v_mfma_f32_16x16x32_bf16 v[156:159], a[80:83], a[32:35], v[156:159]
ds_read_b64_tr_b16 a[80:81], v9 offset:32768
v_mfma_f32_16x16x32_bf16 v[24:27], a[88:91], a[32:35], v[24:27]
s_xor_b32 m0, s84, 34816
ds_read_b64_tr_b16 a[82:83], v9 offset:33792
v_mfma_f32_16x16x32_bf16 v[24:27], a[92:95], a[36:39], v[24:27]
s_xor_b32 s64, s72, 131712
ds_read_b64_tr_b16 a[84:85], v9 offset:40960
v_subrev_u32 v5, 0x8000, v5
v_mfma_f32_16x16x32_bf16 v[40:43], a[92:95], a[44:47], v[40:43]
buffer_load_dwordx4 v12, s[48:51], s64 offen lds
v_mfma_f32_16x16x32_bf16 v[40:43], a[88:91], a[40:43], v[40:43]
ds_read_b64_tr_b16 a[86:87], v9 offset:41984
v_mfma_f32_16x16x32_bf16 v[56:59], a[88:91], a[48:51], v[56:59]
v_mfma_f32_16x16x32_bf16 v[56:59], a[92:95], a[52:55], v[56:59]
s_xor_b32 m0, s84, 35840
v_mfma_f32_16x16x32_bf16 v[72:75], a[92:95], a[60:63], v[72:75]
s_waitcnt vmcnt(13)
s_xor_b32 s64, s72, 148096
ds_read_b128 a[0:3], v2 offset:0
v_mfma_f32_16x16x32_bf16 v[72:75], a[88:91], a[56:59], v[72:75]
buffer_load_dwordx4 v13, s[48:51], s64 offen lds
v_mfma_f32_16x16x32_bf16 v[136:139], a[96:99], a[56:59], v[136:139]
ds_read_b128 a[4:7], v3 offset:0
v_mfma_f32_16x16x32_bf16 v[136:139], a[100:103], a[60:63], v[136:139]
ds_read_b128 a[8:11], v2 offset:2048
v_subrev_u32 v6, 0x8000, v6
v_mfma_f32_16x16x32_bf16 v[120:123], a[100:103], a[52:55], v[120:123]
s_xor_b32 m0, s84, 36864
ds_read_b128 a[12:15], v3 offset:2048
v_mfma_f32_16x16x32_bf16 v[120:123], a[96:99], a[48:51], v[120:123]
s_xor_b32 s64, s73, 640
ds_read_b128 a[16:19], v2 offset:4096
v_mfma_f32_16x16x32_bf16 v[104:107], a[96:99], a[40:43], v[104:107]
buffer_load_dwordx4 v12, s[48:51], s64 offen lds
v_mfma_f32_16x16x32_bf16 v[104:107], a[100:103], a[44:47], v[104:107]
ds_read_b128 a[20:23], v3 offset:4096
v_mfma_f32_16x16x32_bf16 v[88:91], a[100:103], a[36:39], v[88:91]
ds_read_b128 a[24:27], v2 offset:6144
v_mfma_f32_16x16x32_bf16 v[88:91], a[96:99], a[32:35], v[88:91]
s_waitcnt lgkmcnt(7)
s_xor_b32 m0, s84, 37888
ds_read_b128 a[28:31], v3 offset:6144
v_mfma_f32_16x16x32_bf16 v[28:31], a[104:107], a[32:35], v[28:31]
s_xor_b32 s64, s73, 17024
ds_read_b64_tr_b16 a[88:89], v10 offset:32768
v_mfma_f32_16x16x32_bf16 v[28:31], a[108:111], a[36:39], v[28:31]
buffer_load_dwordx4 v13, s[48:51], s64 offen lds
v_mfma_f32_16x16x32_bf16 v[44:47], a[108:111], a[44:47], v[44:47]
ds_read_b64_tr_b16 a[90:91], v10 offset:33792
v_subrev_u32 v7, 0x8000, v7
v_mfma_f32_16x16x32_bf16 v[44:47], a[104:107], a[40:43], v[44:47]
ds_read_b64_tr_b16 a[92:93], v10 offset:40960
v_mfma_f32_16x16x32_bf16 v[60:63], a[104:107], a[48:51], v[60:63]
s_xor_b32 m0, s84, 38912
ds_read_b64_tr_b16 a[94:95], v10 offset:41984
v_mfma_f32_16x16x32_bf16 v[60:63], a[108:111], a[52:55], v[60:63]
s_xor_b32 s64, s73, 131712
ds_read_b64_tr_b16 a[96:97], v11 offset:32768
v_mfma_f32_16x16x32_bf16 v[76:79], a[108:111], a[60:63], v[76:79]
buffer_load_dwordx4 v12, s[48:51], s64 offen lds
v_mfma_f32_16x16x32_bf16 v[76:79], a[104:107], a[56:59], v[76:79]
ds_read_b64_tr_b16 a[98:99], v11 offset:33792
v_mfma_f32_16x16x32_bf16 v[140:143], a[112:115], a[56:59], v[140:143]
ds_read_b64_tr_b16 a[100:101], v11 offset:40960
v_mfma_f32_16x16x32_bf16 v[140:143], a[116:119], a[60:63], v[140:143]
s_xor_b32 m0, s84, 39936
ds_read_b64_tr_b16 a[102:103], v11 offset:41984
v_subrev_u32 v8, 0x8000, v8
v_mfma_f32_16x16x32_bf16 v[124:127], a[116:119], a[52:55], v[124:127]
s_xor_b32 s64, s73, 148096
v_mfma_f32_16x16x32_bf16 v[124:127], a[112:115], a[48:51], v[124:127]
buffer_load_dwordx4 v13, s[48:51], s64 offen lds
v_mfma_f32_16x16x32_bf16 v[108:111], a[112:115], a[40:43], v[108:111]
v_mfma_f32_16x16x32_bf16 v[108:111], a[116:119], a[44:47], v[108:111]
v_mfma_f32_16x16x32_bf16 v[92:95], a[116:119], a[36:39], v[92:95]
v_subrev_u32 v9, 0x8000, v9
v_subrev_u32 v10, 0x8000, v10
v_mfma_f32_16x16x32_bf16 v[92:95], a[112:115], a[32:35], v[92:95]
v_subrev_u32 v11, 0x8000, v11
v_mfma_f32_16x16x32_bf16 v[32:35], a[72:75], a[32:35], v[32:35]
v_mfma_f32_16x16x32_bf16 v[32:35], a[76:79], a[36:39], v[32:35]
v_mfma_f32_16x16x32_bf16 v[48:51], a[76:79], a[44:47], v[48:51]
s_waitcnt lgkmcnt(0)
s_barrier
v_mfma_f32_16x16x32_bf16 v[48:51], a[72:75], a[40:43], v[48:51]
s_xor_b32 m0, s77, 131072
ds_read_b64_tr_b16 a[104:105], v19 offset:4096
v_mfma_f32_16x16x32_bf16 v[64:67], a[72:75], a[48:51], v[64:67]
s_xor_b32 s64, s71, 3145728
ds_read_b64_tr_b16 a[106:107], v19 offset:4352
v_mfma_f32_16x16x32_bf16 v[64:67], a[76:79], a[52:55], v[64:67]
s_add_u32 s65, s79, 6144
buffer_load_dwordx4 v14, s[56:59], s64 offen lds
v_mfma_f32_16x16x32_bf16 v[80:83], a[76:79], a[60:63], v[80:83]
buffer_store_dwordx4 a[172:175], v16, s[44:47], s65 offen sc1
v_mfma_f32_16x16x32_bf16 v[80:83], a[72:75], a[56:59], v[80:83]
ds_read_b64_tr_b16 a[108:109], v19 offset:6144
v_mfma_f32_16x16x32_bf16 v[144:147], a[80:83], a[56:59], v[144:147]
ds_read_b64_tr_b16 a[110:111], v19 offset:6400
v_mfma_f32_16x16x32_bf16 v[144:147], a[84:87], a[60:63], v[144:147]
ds_read_b64_tr_b16 a[112:113], v20 offset:4096
v_mfma_f32_16x16x32_bf16 v[128:131], a[84:87], a[52:55], v[128:131]
ds_read_b64_tr_b16 a[114:115], v20 offset:4352
v_mfma_f32_16x16x32_bf16 v[128:131], a[80:83], a[48:51], v[128:131]
ds_read_b64_tr_b16 a[116:117], v20 offset:6144
v_mfma_f32_16x16x32_bf16 v[112:115], a[80:83], a[40:43], v[112:115]
s_add_u32 m0, s78, 147456
ds_read_b64_tr_b16 a[118:119], v20 offset:6400
v_mfma_f32_16x16x32_bf16 v[112:115], a[84:87], a[44:47], v[112:115]
s_add_u32 s64, s75, 2359296
ds_read_b64_tr_b16 a[72:73], v19 offset:8192
v_mfma_f32_16x16x32_bf16 v[96:99], a[84:87], a[36:39], v[96:99]
s_branch L_po8
L_pg8:
s_branch L_pg12
L_po8:
buffer_load_dwordx4 v23, s[60:63], s64 offen lds
v_mfma_f32_16x16x32_bf16 v[96:99], a[80:83], a[32:35], v[96:99]
ds_read_b64_tr_b16 a[74:75], v19 offset:8448
v_mfma_f32_16x16x32_bf16 v[36:39], a[88:91], a[32:35], v[36:39]
ds_read_b64_tr_b16 a[76:77], v19 offset:10240
v_mfma_f32_16x16x32_bf16 v[36:39], a[92:95], a[36:39], v[36:39]
ds_read_b64_tr_b16 a[78:79], v19 offset:10496
v_mfma_f32_16x16x32_bf16 v[52:55], a[92:95], a[44:47], v[52:55]
ds_read_b64_tr_b16 a[80:81], v20 offset:8192
v_mfma_f32_16x16x32_bf16 v[52:55], a[88:91], a[40:43], v[52:55]
ds_read_b64_tr_b16 a[82:83], v20 offset:8448
v_mfma_f32_16x16x32_bf16 v[68:71], a[88:91], a[48:51], v[68:71]
s_xor_b32 m0, s77, 132096
ds_read_b64_tr_b16 a[84:85], v20 offset:10240
v_mfma_f32_16x16x32_bf16 v[68:71], a[92:95], a[52:55], v[68:71]
s_xor_b32 s64, s71, 3178496
s_xor_b32 s68, s66, 12288
ds_read_b64_tr_b16 a[86:87], v20 offset:10496
v_mfma_f32_16x16x32_bf16 v[84:87], a[92:95], a[60:63], v[84:87]
s_mov_b64 exec, 1
buffer_atomic_add a251, v1, s[52:55], s68 offen offset:0 sc1
s_mov_b64 exec, -1
v_mfma_f32_16x16x32_bf16 v[84:87], a[88:91], a[56:59], v[84:87]
buffer_load_dwordx4 v14, s[56:59], s64 offen lds
v_mfma_f32_16x16x32_bf16 v[148:151], a[96:99], a[56:59], v[148:151]
ds_read_b64_tr_b16 a[88:89], v19 offset:0
v_mfma_f32_16x16x32_bf16 v[148:151], a[100:103], a[60:63], v[148:151]
ds_read_b64_tr_b16 a[90:91], v19 offset:256
v_mfma_f32_16x16x32_bf16 v[132:135], a[100:103], a[52:55], v[132:135]
ds_read_b64_tr_b16 a[92:93], v19 offset:2048
v_mfma_f32_16x16x32_bf16 v[132:135], a[96:99], a[48:51], v[132:135]
ds_read_b64_tr_b16 a[94:95], v19 offset:2304
v_mfma_f32_16x16x32_bf16 v[116:119], a[96:99], a[40:43], v[116:119]
v_mfma_f32_16x16x32_bf16 v[116:119], a[100:103], a[44:47], v[116:119]
v_mfma_f32_16x16x32_bf16 v[100:103], a[100:103], a[36:39], v[100:103]
s_add_u32 m0, s78, 151552
v_mfma_f32_16x16x32_bf16 v[100:103], a[96:99], a[32:35], v[100:103]
s_waitcnt lgkmcnt(4)
s_add_u32 s64, s75, 2361344
ds_read_b64_tr_b16 a[96:97], v20 offset:0
v_mfma_f32_16x16x32_bf16 v[184:187], a[104:107], a[0:3], v[184:187]
s_mov_b32 s36, s20
buffer_load_dwordx4 v23, s[60:63], s64 offen lds
v_mfma_f32_16x16x32_bf16 v[184:187], a[108:111], a[4:7], v[184:187]
s_mov_b32 s37, s21
ds_read_b64_tr_b16 a[98:99], v20 offset:256
v_mfma_f32_16x16x32_bf16 v[192:195], a[108:111], a[12:15], v[192:195]
s_mov_b32 s38, 2097152
ds_read_b64_tr_b16 a[100:101], v20 offset:2048
v_mfma_f32_16x16x32_bf16 v[192:195], a[104:107], a[8:11], v[192:195]
s_mov_b32 s40, s14
ds_read_b64_tr_b16 a[102:103], v20 offset:2304
v_mfma_f32_16x16x32_bf16 v[200:203], a[104:107], a[16:19], v[200:203]
s_mov_b32 s41, s15
v_mfma_f32_16x16x32_bf16 v[200:203], a[108:111], a[20:23], v[200:203]
s_mov_b32 s42, 8388608
v_mfma_f32_16x16x32_bf16 v[208:211], a[108:111], a[28:31], v[208:211]
v_mfma_f32_16x16x32_bf16 v[208:211], a[104:107], a[24:27], v[208:211]
ds_read_b64_tr_b16 a[104:105], v4 offset:0
v_mfma_f32_16x16x32_bf16 v[212:215], a[112:115], a[24:27], v[212:215]
s_xor_b32 m0, s77, 133120
ds_read_b64_tr_b16 a[106:107], v4 offset:1024
v_mfma_f32_16x16x32_bf16 v[212:215], a[116:119], a[28:31], v[212:215]
s_xor_b32 s64, s71, 3211264
ds_read_b64_tr_b16 a[108:109], v4 offset:8192
v_mfma_f32_16x16x32_bf16 v[204:207], a[116:119], a[20:23], v[204:207]
buffer_load_dwordx4 v15, s[56:59], s64 offen lds
v_mfma_f32_16x16x32_bf16 v[204:207], a[112:115], a[16:19], v[204:207]
ds_read_b64_tr_b16 a[110:111], v4 offset:9216
v_mfma_f32_16x16x32_bf16 v[196:199], a[112:115], a[8:11], v[196:199]
v_mfma_f32_16x16x32_bf16 v[196:199], a[116:119], a[12:15], v[196:199]
v_mfma_f32_16x16x32_bf16 v[188:191], a[116:119], a[4:7], v[188:191]
v_mfma_f32_16x16x32_bf16 v[188:191], a[112:115], a[0:3], v[188:191]
ds_read_b64_tr_b16 a[112:113], v5 offset:0
v_mfma_f32_16x16x32_bf16 v[216:219], a[0:3], a[72:75], v[216:219]
ds_read_b64_tr_b16 a[114:115], v5 offset:1024
v_mfma_f32_16x16x32_bf16 v[216:219], a[4:7], a[76:79], v[216:219]
s_add_u32 m0, s78, 155648
s_add_u32 s65, s79, 2048
ds_read_b64_tr_b16 a[116:117], v5 offset:8192
v_mfma_f32_16x16x32_bf16 v[224:227], a[12:15], a[76:79], v[224:227]
s_add_u32 s64, s75, 2363392
buffer_store_dwordx4 a[176:179], v16, s[44:47], s65 offen sc1
v_mfma_f32_16x16x32_bf16 v[224:227], a[8:11], a[72:75], v[224:227]
buffer_load_dwordx4 v23, s[60:63], s64 offen lds
v_mfma_f32_16x16x32_bf16 v[232:235], a[16:19], a[72:75], v[232:235]
ds_read_b64_tr_b16 a[118:119], v5 offset:9216
v_mfma_f32_16x16x32_bf16 v[232:235], a[20:23], a[76:79], v[232:235]
v_mfma_f32_16x16x32_bf16 v[240:243], a[28:31], a[76:79], v[240:243]
v_mfma_f32_16x16x32_bf16 v[240:243], a[24:27], a[72:75], v[240:243]
ds_read_b64_tr_b16 a[72:73], v6 offset:0
v_mfma_f32_16x16x32_bf16 v[244:247], a[24:27], a[80:83], v[244:247]
ds_read_b64_tr_b16 a[74:75], v6 offset:1024
v_mfma_f32_16x16x32_bf16 v[244:247], a[28:31], a[84:87], v[244:247]
ds_read_b64_tr_b16 a[76:77], v6 offset:8192
v_mfma_f32_16x16x32_bf16 v[236:239], a[20:23], a[84:87], v[236:239]
s_xor_b32 m0, s77, 134144
ds_read_b64_tr_b16 a[78:79], v6 offset:9216
v_mfma_f32_16x16x32_bf16 v[236:239], a[16:19], a[80:83], v[236:239]
s_xor_b32 s64, s71, 3244032
v_mfma_f32_16x16x32_bf16 v[228:231], a[8:11], a[80:83], v[228:231]
buffer_load_dwordx4 v15, s[56:59], s64 offen lds
v_mfma_f32_16x16x32_bf16 v[228:231], a[12:15], a[84:87], v[228:231]
v_mfma_f32_16x16x32_bf16 v[220:223], a[4:7], a[84:87], v[220:223]
v_mfma_f32_16x16x32_bf16 v[220:223], a[0:3], a[80:83], v[220:223]
s_waitcnt lgkmcnt(4)
ds_read_b64_tr_b16 a[80:81], v7 offset:0
v_mfma_f32_16x16x32_bf16 v[152:155], a[88:91], a[0:3], v[152:155]
ds_read_b64_tr_b16 a[82:83], v7 offset:1024
v_mfma_f32_16x16x32_bf16 v[152:155], a[92:95], a[4:7], v[152:155]
ds_read_b64_tr_b16 a[84:85], v7 offset:8192
v_mfma_f32_16x16x32_bf16 v[160:163], a[92:95], a[12:15], v[160:163]
ds_read_b64_tr_b16 a[86:87], v7 offset:9216
v_mfma_f32_16x16x32_bf16 v[160:163], a[88:91], a[8:11], v[160:163]
v_mfma_f32_16x16x32_bf16 v[168:171], a[88:91], a[16:19], v[168:171]
v_mfma_f32_16x16x32_bf16 v[168:171], a[92:95], a[20:23], v[168:171]
v_mfma_f32_16x16x32_bf16 v[176:179], a[92:95], a[28:31], v[176:179]
s_xor_b32 m0, s84, 0
v_mfma_f32_16x16x32_bf16 v[176:179], a[88:91], a[24:27], v[176:179]
s_xor_b32 s64, s72, 768
ds_read_b64_tr_b16 a[88:89], v8 offset:0
v_mfma_f32_16x16x32_bf16 v[180:183], a[96:99], a[24:27], v[180:183]
buffer_load_dwordx4 v12, s[48:51], s64 offen lds
v_mfma_f32_16x16x32_bf16 v[180:183], a[100:103], a[28:31], v[180:183]
ds_read_b64_tr_b16 a[90:91], v8 offset:1024
v_mfma_f32_16x16x32_bf16 v[172:175], a[100:103], a[20:23], v[172:175]
ds_read_b64_tr_b16 a[92:93], v8 offset:8192
v_mfma_f32_16x16x32_bf16 v[172:175], a[96:99], a[16:19], v[172:175]
s_xor_b32 m0, s84, 1024
ds_read_b64_tr_b16 a[94:95], v8 offset:9216
v_mfma_f32_16x16x32_bf16 v[164:167], a[96:99], a[8:11], v[164:167]
s_xor_b32 s64, s72, 17152
v_mfma_f32_16x16x32_bf16 v[164:167], a[100:103], a[12:15], v[164:167]
buffer_load_dwordx4 v13, s[48:51], s64 offen lds
v_mfma_f32_16x16x32_bf16 v[156:159], a[100:103], a[4:7], v[156:159]
v_mfma_f32_16x16x32_bf16 v[156:159], a[96:99], a[0:3], v[156:159]
ds_read_b64_tr_b16 a[96:97], v9 offset:0
v_mfma_f32_16x16x32_bf16 v[24:27], a[104:107], a[0:3], v[24:27]
s_xor_b32 m0, s84, 2048
ds_read_b64_tr_b16 a[98:99], v9 offset:1024
v_mfma_f32_16x16x32_bf16 v[24:27], a[108:111], a[4:7], v[24:27]
s_xor_b32 s64, s72, 131840
ds_read_b64_tr_b16 a[100:101], v9 offset:8192
v_mfma_f32_16x16x32_bf16 v[40:43], a[108:111], a[12:15], v[40:43]
buffer_load_dwordx4 v12, s[48:51], s64 offen lds
v_mfma_f32_16x16x32_bf16 v[40:43], a[104:107], a[8:11], v[40:43]
ds_read_b64_tr_b16 a[102:103], v9 offset:9216
v_mfma_f32_16x16x32_bf16 v[56:59], a[104:107], a[16:19], v[56:59]
v_mfma_f32_16x16x32_bf16 v[56:59], a[108:111], a[20:23], v[56:59]
s_xor_b32 m0, s84, 3072
v_mfma_f32_16x16x32_bf16 v[72:75], a[108:111], a[28:31], v[72:75]
s_waitcnt vmcnt(13)
s_xor_b32 s64, s72, 148224
ds_read_b128 a[32:35], v2 offset:32768
v_mfma_f32_16x16x32_bf16 v[72:75], a[104:107], a[24:27], v[72:75]
buffer_load_dwordx4 v13, s[48:51], s64 offen lds
v_mfma_f32_16x16x32_bf16 v[136:139], a[112:115], a[24:27], v[136:139]
ds_read_b128 a[36:39], v3 offset:32768
v_mfma_f32_16x16x32_bf16 v[136:139], a[116:119], a[28:31], v[136:139]
ds_read_b128 a[40:43], v2 offset:34816
v_mfma_f32_16x16x32_bf16 v[120:123], a[116:119], a[20:23], v[120:123]
s_xor_b32 m0, s84, 4096
ds_read_b128 a[44:47], v3 offset:34816
v_mfma_f32_16x16x32_bf16 v[120:123], a[112:115], a[16:19], v[120:123]
s_xor_b32 s64, s73, 768
ds_read_b128 a[48:51], v2 offset:36864
v_mfma_f32_16x16x32_bf16 v[104:107], a[112:115], a[8:11], v[104:107]
buffer_load_dwordx4 v12, s[48:51], s64 offen lds
v_mfma_f32_16x16x32_bf16 v[104:107], a[116:119], a[12:15], v[104:107]
s_add_u32 s65, s79, 19456
ds_read_b128 a[52:55], v3 offset:36864
v_mfma_f32_16x16x32_bf16 v[88:91], a[116:119], a[4:7], v[88:91]
buffer_store_dwordx4 a[180:183], v16, s[44:47], s65 offen sc1
v_mfma_f32_16x16x32_bf16 v[88:91], a[112:115], a[0:3], v[88:91]
s_waitcnt lgkmcnt(6)
s_xor_b32 m0, s84, 5120
ds_read_b128 a[56:59], v2 offset:38912
v_mfma_f32_16x16x32_bf16 v[28:31], a[72:75], a[0:3], v[28:31]
s_xor_b32 s64, s73, 17152
ds_read_b128 a[60:63], v3 offset:38912
v_mfma_f32_16x16x32_bf16 v[28:31], a[76:79], a[4:7], v[28:31]
buffer_load_dwordx4 v13, s[48:51], s64 offen lds
v_mfma_f32_16x16x32_bf16 v[44:47], a[76:79], a[12:15], v[44:47]
ds_read_b64_tr_b16 a[104:105], v10 offset:0
v_mfma_f32_16x16x32_bf16 v[44:47], a[72:75], a[8:11], v[44:47]
ds_read_b64_tr_b16 a[106:107], v10 offset:1024
v_mfma_f32_16x16x32_bf16 v[60:63], a[72:75], a[16:19], v[60:63]
s_xor_b32 m0, s84, 6144
ds_read_b64_tr_b16 a[108:109], v10 offset:8192
v_mfma_f32_16x16x32_bf16 v[60:63], a[76:79], a[20:23], v[60:63]
s_xor_b32 s64, s73, 131840
ds_read_b64_tr_b16 a[110:111], v10 offset:9216
v_mfma_f32_16x16x32_bf16 v[76:79], a[76:79], a[28:31], v[76:79]
buffer_load_dwordx4 v12, s[48:51], s64 offen lds
v_mfma_f32_16x16x32_bf16 v[76:79], a[72:75], a[24:27], v[76:79]
ds_read_b64_tr_b16 a[112:113], v11 offset:0
v_mfma_f32_16x16x32_bf16 v[140:143], a[80:83], a[24:27], v[140:143]
ds_read_b64_tr_b16 a[114:115], v11 offset:1024
v_mfma_f32_16x16x32_bf16 v[140:143], a[84:87], a[28:31], v[140:143]
s_xor_b32 m0, s84, 7168
ds_read_b64_tr_b16 a[116:117], v11 offset:8192
v_mfma_f32_16x16x32_bf16 v[124:127], a[84:87], a[20:23], v[124:127]
s_xor_b32 s64, s73, 148224
ds_read_b64_tr_b16 a[118:119], v11 offset:9216
v_mfma_f32_16x16x32_bf16 v[124:127], a[80:83], a[16:19], v[124:127]
buffer_load_dwordx4 v13, s[48:51], s64 offen lds
v_mfma_f32_16x16x32_bf16 v[108:111], a[80:83], a[8:11], v[108:111]
v_mfma_f32_16x16x32_bf16 v[108:111], a[84:87], a[12:15], v[108:111]
v_mfma_f32_16x16x32_bf16 v[92:95], a[84:87], a[4:7], v[92:95]
v_mfma_f32_16x16x32_bf16 v[92:95], a[80:83], a[0:3], v[92:95]
v_mfma_f32_16x16x32_bf16 v[32:35], a[88:91], a[0:3], v[32:35]
v_mfma_f32_16x16x32_bf16 v[32:35], a[92:95], a[4:7], v[32:35]
v_mfma_f32_16x16x32_bf16 v[48:51], a[92:95], a[12:15], v[48:51]
s_waitcnt lgkmcnt(0)
s_barrier
v_mfma_f32_16x16x32_bf16 v[48:51], a[88:91], a[8:11], v[48:51]
s_xor_b32 m0, s77, 65536
ds_read_b64_tr_b16 a[72:73], v19 offset:36864
v_mfma_f32_16x16x32_bf16 v[64:67], a[88:91], a[16:19], v[64:67]
s_xor_b32 s64, s71, 3670016
ds_read_b64_tr_b16 a[74:75], v19 offset:37120
v_mfma_f32_16x16x32_bf16 v[64:67], a[92:95], a[20:23], v[64:67]
buffer_load_dwordx4 v14, s[56:59], s64 offen lds
v_mfma_f32_16x16x32_bf16 v[80:83], a[92:95], a[28:31], v[80:83]
ds_read_b64_tr_b16 a[76:77], v19 offset:38912
v_mfma_f32_16x16x32_bf16 v[80:83], a[88:91], a[24:27], v[80:83]
ds_read_b64_tr_b16 a[78:79], v19 offset:39168
v_mfma_f32_16x16x32_bf16 v[144:147], a[96:99], a[24:27], v[144:147]
ds_read_b64_tr_b16 a[80:81], v20 offset:36864
v_mfma_f32_16x16x32_bf16 v[144:147], a[100:103], a[28:31], v[144:147]
ds_read_b64_tr_b16 a[82:83], v20 offset:37120
v_mfma_f32_16x16x32_bf16 v[128:131], a[100:103], a[20:23], v[128:131]
ds_read_b64_tr_b16 a[84:85], v20 offset:38912
v_mfma_f32_16x16x32_bf16 v[128:131], a[96:99], a[16:19], v[128:131]
ds_read_b64_tr_b16 a[86:87], v20 offset:39168
v_mfma_f32_16x16x32_bf16 v[112:115], a[96:99], a[8:11], v[112:115]
s_add_u32 m0, s78, 81920
ds_read_b64_tr_b16 a[88:89], v19 offset:40960
v_mfma_f32_16x16x32_bf16 v[112:115], a[100:103], a[12:15], v[112:115]
s_add_u32 s64, s75, 2752512
ds_read_b64_tr_b16 a[90:91], v19 offset:41216
v_mfma_f32_16x16x32_bf16 v[96:99], a[100:103], a[4:7], v[96:99]
buffer_load_dwordx4 v23, s[60:63], s64 offen lds
v_mfma_f32_16x16x32_bf16 v[96:99], a[96:99], a[0:3], v[96:99]
ds_read_b64_tr_b16 a[92:93], v19 offset:43008
v_mfma_f32_16x16x32_bf16 v[36:39], a[104:107], a[0:3], v[36:39]
ds_read_b64_tr_b16 a[94:95], v19 offset:43264
v_mfma_f32_16x16x32_bf16 v[36:39], a[108:111], a[4:7], v[36:39]
ds_read_b64_tr_b16 a[96:97], v20 offset:40960
v_mfma_f32_16x16x32_bf16 v[52:55], a[108:111], a[12:15], v[52:55]
ds_read_b64_tr_b16 a[98:99], v20 offset:41216
v_mfma_f32_16x16x32_bf16 v[52:55], a[104:107], a[8:11], v[52:55]
ds_read_b64_tr_b16 a[100:101], v20 offset:43008
v_mfma_f32_16x16x32_bf16 v[68:71], a[104:107], a[16:19], v[68:71]
ds_read_b64_tr_b16 a[102:103], v20 offset:43264
v_mfma_f32_16x16x32_bf16 v[68:71], a[108:111], a[20:23], v[68:71]
s_xor_b32 m0, s77, 66560
v_mfma_f32_16x16x32_bf16 v[84:87], a[108:111], a[28:31], v[84:87]
s_xor_b32 s64, s71, 3702784
v_mfma_f32_16x16x32_bf16 v[84:87], a[104:107], a[24:27], v[84:87]
buffer_load_dwordx4 v14, s[56:59], s64 offen lds
v_mfma_f32_16x16x32_bf16 v[148:151], a[112:115], a[24:27], v[148:151]
ds_read_b64_tr_b16 a[104:105], v19 offset:32768
v_mfma_f32_16x16x32_bf16 v[148:151], a[116:119], a[28:31], v[148:151]
ds_read_b64_tr_b16 a[106:107], v19 offset:33024
v_mfma_f32_16x16x32_bf16 v[132:135], a[116:119], a[20:23], v[132:135]
s_add_u32 s65, s79, 7168
ds_read_b64_tr_b16 a[108:109], v19 offset:34816
v_mfma_f32_16x16x32_bf16 v[132:135], a[112:115], a[16:19], v[132:135]
buffer_store_dwordx4 a[184:187], v16, s[44:47], s65 offen sc1
v_mfma_f32_16x16x32_bf16 v[116:119], a[112:115], a[8:11], v[116:119]
ds_read_b64_tr_b16 a[110:111], v19 offset:35072
v_mfma_f32_16x16x32_bf16 v[116:119], a[116:119], a[12:15], v[116:119]
v_mfma_f32_16x16x32_bf16 v[100:103], a[116:119], a[4:7], v[100:103]
s_add_u32 m0, s78, 86016
v_mfma_f32_16x16x32_bf16 v[100:103], a[112:115], a[0:3], v[100:103]
s_waitcnt lgkmcnt(4)
s_add_u32 s64, s75, 2754560
ds_read_b64_tr_b16 a[112:113], v20 offset:32768
v_mfma_f32_16x16x32_bf16 v[184:187], a[72:75], a[32:35], v[184:187]
buffer_load_dwordx4 v23, s[60:63], s64 offen lds
v_mfma_f32_16x16x32_bf16 v[184:187], a[76:79], a[36:39], v[184:187]
ds_read_b64_tr_b16 a[114:115], v20 offset:33024
v_and_b32 v22, 15, v0
v_mfma_f32_16x16x32_bf16 v[192:195], a[76:79], a[44:47], v[192:195]
ds_read_b64_tr_b16 a[116:117], v20 offset:34816
v_lshrrev_b32 v17, 4, v0
v_mfma_f32_16x16x32_bf16 v[192:195], a[72:75], a[40:43], v[192:195]
ds_read_b64_tr_b16 a[118:119], v20 offset:35072
v_lshlrev_b32 v17, 2, v17
v_mfma_f32_16x16x32_bf16 v[200:203], a[72:75], a[48:51], v[200:203]
v_sub_u32 v22, v22, v17
v_subrev_u32 v17, 0, v22
v_mfma_f32_16x16x32_bf16 v[200:203], a[76:79], a[52:55], v[200:203]
v_lshlrev_b32 v18, 31, v17
v_or_b32 v21, v17, v18
v_mfma_f32_16x16x32_bf16 v[208:211], a[76:79], a[60:63], v[208:211]
v_ashrrev_i32 v21, 31, v21
v_and_b32 v248, 0xff800000, v21
v_mfma_f32_16x16x32_bf16 v[208:211], a[72:75], a[56:59], v[208:211]
ds_read_b64_tr_b16 a[72:73], v4 offset:32768
v_not_b32 v17, v17
v_mfma_f32_16x16x32_bf16 v[212:215], a[80:83], a[56:59], v[212:215]
s_xor_b32 m0, s77, 67584
ds_read_b64_tr_b16 a[74:75], v4 offset:33792
v_or_b32 v21, v17, v18
v_mfma_f32_16x16x32_bf16 v[212:215], a[84:87], a[60:63], v[212:215]
s_xor_b32 s64, s71, 3735552
ds_read_b64_tr_b16 a[76:77], v4 offset:40960
v_ashrrev_i32 v21, 31, v21
v_mfma_f32_16x16x32_bf16 v[204:207], a[84:87], a[52:55], v[204:207]
buffer_load_dwordx4 v15, s[56:59], s64 offen lds
v_mfma_f32_16x16x32_bf16 v[204:207], a[80:83], a[48:51], v[204:207]
ds_read_b64_tr_b16 a[78:79], v4 offset:41984
v_and_b32 v252, 0xff800000, v21
v_mfma_f32_16x16x32_bf16 v[196:199], a[80:83], a[40:43], v[196:199]
v_subrev_u32 v17, 1, v22
v_lshlrev_b32 v18, 31, v17
v_mfma_f32_16x16x32_bf16 v[196:199], a[84:87], a[44:47], v[196:199]
v_or_b32 v21, v17, v18
v_ashrrev_i32 v21, 31, v21
v_mfma_f32_16x16x32_bf16 v[188:191], a[84:87], a[36:39], v[188:191]
v_and_b32 v249, 0xff800000, v21
v_not_b32 v17, v17
v_mfma_f32_16x16x32_bf16 v[188:191], a[80:83], a[32:35], v[188:191]
ds_read_b64_tr_b16 a[80:81], v5 offset:32768
v_or_b32 v21, v17, v18
v_mfma_f32_16x16x32_bf16 v[216:219], a[32:35], a[88:91], v[216:219]
ds_read_b64_tr_b16 a[82:83], v5 offset:33792
v_ashrrev_i32 v21, 31, v21
v_mfma_f32_16x16x32_bf16 v[216:219], a[36:39], a[92:95], v[216:219]
s_add_u32 m0, s78, 90112
ds_read_b64_tr_b16 a[84:85], v5 offset:40960
v_and_b32 v253, 0xff800000, v21
v_mfma_f32_16x16x32_bf16 v[224:227], a[44:47], a[92:95], v[224:227]
s_add_u32 s64, s75, 2756608
ds_read_b64_tr_b16 a[86:87], v5 offset:41984
v_subrev_u32 v17, 2, v22
v_mfma_f32_16x16x32_bf16 v[224:227], a[40:43], a[88:91], v[224:227]
buffer_load_dwordx4 v23, s[60:63], s64 offen lds
v_mfma_f32_16x16x32_bf16 v[232:235], a[48:51], a[88:91], v[232:235]
v_lshlrev_b32 v18, 31, v17
v_or_b32 v21, v17, v18
v_mfma_f32_16x16x32_bf16 v[232:235], a[52:55], a[92:95], v[232:235]
v_ashrrev_i32 v21, 31, v21
v_and_b32 v250, 0xff800000, v21
v_mfma_f32_16x16x32_bf16 v[240:243], a[60:63], a[92:95], v[240:243]
v_not_b32 v17, v17
v_or_b32 v21, v17, v18
v_mfma_f32_16x16x32_bf16 v[240:243], a[56:59], a[88:91], v[240:243]
ds_read_b64_tr_b16 a[88:89], v6 offset:32768
v_ashrrev_i32 v21, 31, v21
v_mfma_f32_16x16x32_bf16 v[244:247], a[56:59], a[96:99], v[244:247]
ds_read_b64_tr_b16 a[90:91], v6 offset:33792
v_and_b32 v254, 0xff800000, v21
v_mfma_f32_16x16x32_bf16 v[244:247], a[60:63], a[100:103], v[244:247]
ds_read_b64_tr_b16 a[92:93], v6 offset:40960
v_add_u32 v19, 0x8000, v19
v_mfma_f32_16x16x32_bf16 v[236:239], a[52:55], a[100:103], v[236:239]
s_xor_b32 m0, s77, 68608
ds_read_b64_tr_b16 a[94:95], v6 offset:41984
v_subrev_u32 v17, 3, v22
v_mfma_f32_16x16x32_bf16 v[236:239], a[48:51], a[96:99], v[236:239]
s_xor_b32 s64, s71, 3768320
v_lshlrev_b32 v18, 31, v17
v_or_b32 v21, v17, v18
v_mfma_f32_16x16x32_bf16 v[228:231], a[40:43], a[96:99], v[228:231]
buffer_load_dwordx4 v15, s[56:59], s64 offen lds
v_mfma_f32_16x16x32_bf16 v[228:231], a[44:47], a[100:103], v[228:231]
v_ashrrev_i32 v21, 31, v21
v_and_b32 v251, 0xff800000, v21
v_mfma_f32_16x16x32_bf16 v[220:223], a[36:39], a[100:103], v[220:223]
v_not_b32 v17, v17
v_or_b32 v21, v17, v18
v_mfma_f32_16x16x32_bf16 v[220:223], a[32:35], a[96:99], v[220:223]
s_waitcnt lgkmcnt(4)
ds_read_b64_tr_b16 a[96:97], v7 offset:32768
v_ashrrev_i32 v21, 31, v21
v_mfma_f32_16x16x32_bf16 v[152:155], a[104:107], a[32:35], v[152:155]
ds_read_b64_tr_b16 a[98:99], v7 offset:33792
v_and_b32 v255, 0xff800000, v21
v_mfma_f32_16x16x32_bf16 v[152:155], a[108:111], a[36:39], v[152:155]
s_lshl_b32 s69, s30, 4
ds_read_b64_tr_b16 a[100:101], v7 offset:40960
v_add_u32 v20, 0x8000, v20
v_mfma_f32_16x16x32_bf16 v[160:163], a[108:111], a[44:47], v[160:163]
ds_read_b64_tr_b16 a[102:103], v7 offset:41984
v_add_u32 v18, s69, v22
v_mfma_f32_16x16x32_bf16 v[160:163], a[104:107], a[40:43], v[160:163]
s_lshr_b32 s69, s30, 1
v_mfma_f32_16x16x32_bf16 v[168:171], a[104:107], a[48:51], v[168:171]
s_mul_i32 s69, s69, 18432
v_mfma_f32_16x16x32_bf16 v[168:171], a[108:111], a[52:55], v[168:171]
s_add_u32 s69, s69, s78
v_mfma_f32_16x16x32_bf16 v[176:179], a[108:111], a[60:63], v[176:179]
s_add_u32 s69, s69, 32768
s_xor_b32 m0, s84, 32768
v_mfma_f32_16x16x32_bf16 v[176:179], a[104:107], a[56:59], v[176:179]
s_xor_b32 s64, s72, 896
ds_read_b64_tr_b16 a[104:105], v8 offset:32768
v_add_u32 v17, s69, v16
v_mfma_f32_16x16x32_bf16 v[180:183], a[112:115], a[56:59], v[180:183]
s_add_u32 s65, s79, 3072
buffer_load_dwordx4 v12, s[48:51], s64 offen lds
v_mfma_f32_16x16x32_bf16 v[180:183], a[116:119], a[60:63], v[180:183]
buffer_store_dwordx4 a[188:191], v16, s[44:47], s65 offen sc1
v_mfma_f32_16x16x32_bf16 v[172:175], a[116:119], a[52:55], v[172:175]
ds_read_b64_tr_b16 a[106:107], v8 offset:33792
v_add_u32 v4, 0x8000, v4
v_mfma_f32_16x16x32_bf16 v[172:175], a[112:115], a[48:51], v[172:175]
s_xor_b32 m0, s84, 33792
ds_read_b64_tr_b16 a[108:109], v8 offset:40960
v_lshlrev_b32 v21, 5, v0
v_mfma_f32_16x16x32_bf16 v[164:167], a[112:115], a[40:43], v[164:167]
s_xor_b32 s64, s72, 17280
ds_read_b64_tr_b16 a[110:111], v8 offset:41984
v_mfma_f32_16x16x32_bf16 v[164:167], a[116:119], a[44:47], v[164:167]
buffer_load_dwordx4 v13, s[48:51], s64 offen lds
v_mfma_f32_16x16x32_bf16 v[156:159], a[116:119], a[36:39], v[156:159]
v_mfma_f32_16x16x32_bf16 v[156:159], a[112:115], a[32:35], v[156:159]
ds_read_b64_tr_b16 a[112:113], v9 offset:32768
v_mfma_f32_16x16x32_bf16 v[24:27], a[72:75], a[32:35], v[24:27]
s_xor_b32 m0, s84, 34816
ds_read_b64_tr_b16 a[114:115], v9 offset:33792
v_mfma_f32_16x16x32_bf16 v[24:27], a[76:79], a[36:39], v[24:27]
s_xor_b32 s64, s72, 131968
ds_read_b64_tr_b16 a[116:117], v9 offset:40960
v_add_u32 v5, 0x8000, v5
v_mfma_f32_16x16x32_bf16 v[40:43], a[76:79], a[44:47], v[40:43]
buffer_load_dwordx4 v12, s[48:51], s64 offen lds
v_mfma_f32_16x16x32_bf16 v[40:43], a[72:75], a[40:43], v[40:43]
ds_read_b64_tr_b16 a[118:119], v9 offset:41984
v_mfma_f32_16x16x32_bf16 v[56:59], a[72:75], a[48:51], v[56:59]
v_mfma_f32_16x16x32_bf16 v[56:59], a[76:79], a[52:55], v[56:59]
s_xor_b32 m0, s84, 35840
v_mfma_f32_16x16x32_bf16 v[72:75], a[76:79], a[60:63], v[72:75]
s_waitcnt vmcnt(12)
s_xor_b32 s64, s72, 148352
ds_read_b128 a[0:3], v2 offset:0
v_mfma_f32_16x16x32_bf16 v[72:75], a[72:75], a[56:59], v[72:75]
buffer_load_dwordx4 v13, s[48:51], s64 offen lds
v_mfma_f32_16x16x32_bf16 v[136:139], a[80:83], a[56:59], v[136:139]
ds_read_b128 a[4:7], v3 offset:0
v_mfma_f32_16x16x32_bf16 v[136:139], a[84:87], a[60:63], v[136:139]
ds_read_b128 a[8:11], v2 offset:2048
v_add_u32 v6, 0x8000, v6
v_mfma_f32_16x16x32_bf16 v[120:123], a[84:87], a[52:55], v[120:123]
s_xor_b32 m0, s84, 36864
ds_read_b128 a[12:15], v3 offset:2048
v_mfma_f32_16x16x32_bf16 v[120:123], a[80:83], a[48:51], v[120:123]
s_xor_b32 s64, s73, 896
ds_read_b128 a[16:19], v2 offset:4096
v_mfma_f32_16x16x32_bf16 v[104:107], a[80:83], a[40:43], v[104:107]
buffer_load_dwordx4 v12, s[48:51], s64 offen lds
v_mfma_f32_16x16x32_bf16 v[104:107], a[84:87], a[44:47], v[104:107]
ds_read_b128 a[20:23], v3 offset:4096
v_mfma_f32_16x16x32_bf16 v[88:91], a[84:87], a[36:39], v[88:91]
ds_read_b128 a[24:27], v2 offset:6144
v_mfma_f32_16x16x32_bf16 v[88:91], a[80:83], a[32:35], v[88:91]
s_waitcnt lgkmcnt(7)
s_xor_b32 m0, s84, 37888
ds_read_b128 a[28:31], v3 offset:6144
v_mfma_f32_16x16x32_bf16 v[28:31], a[88:91], a[32:35], v[28:31]
s_xor_b32 s64, s73, 17280
ds_read_b64_tr_b16 a[72:73], v10 offset:32768
v_mfma_f32_16x16x32_bf16 v[28:31], a[92:95], a[36:39], v[28:31]
buffer_load_dwordx4 v13, s[48:51], s64 offen lds
v_mfma_f32_16x16x32_bf16 v[44:47], a[92:95], a[44:47], v[44:47]
ds_read_b64_tr_b16 a[74:75], v10 offset:33792
v_add_u32 v7, 0x8000, v7
v_mfma_f32_16x16x32_bf16 v[44:47], a[88:91], a[40:43], v[44:47]
ds_read_b64_tr_b16 a[76:77], v10 offset:40960
v_mfma_f32_16x16x32_bf16 v[60:63], a[88:91], a[48:51], v[60:63]
s_xor_b32 m0, s84, 38912
ds_read_b64_tr_b16 a[78:79], v10 offset:41984
v_mfma_f32_16x16x32_bf16 v[60:63], a[92:95], a[52:55], v[60:63]
s_xor_b32 s64, s73, 131968
ds_read_b64_tr_b16 a[80:81], v11 offset:32768
v_mfma_f32_16x16x32_bf16 v[76:79], a[92:95], a[60:63], v[76:79]
buffer_load_dwordx4 v12, s[48:51], s64 offen lds
v_mfma_f32_16x16x32_bf16 v[76:79], a[88:91], a[56:59], v[76:79]
ds_read_b64_tr_b16 a[82:83], v11 offset:33792
v_mfma_f32_16x16x32_bf16 v[140:143], a[96:99], a[56:59], v[140:143]
ds_read_b64_tr_b16 a[84:85], v11 offset:40960
v_mfma_f32_16x16x32_bf16 v[140:143], a[100:103], a[60:63], v[140:143]
s_xor_b32 m0, s84, 39936
ds_read_b64_tr_b16 a[86:87], v11 offset:41984
v_add_u32 v8, 0x8000, v8
v_mfma_f32_16x16x32_bf16 v[124:127], a[100:103], a[52:55], v[124:127]
s_xor_b32 s64, s73, 148352
v_mfma_f32_16x16x32_bf16 v[124:127], a[96:99], a[48:51], v[124:127]
buffer_load_dwordx4 v13, s[48:51], s64 offen lds
v_mfma_f32_16x16x32_bf16 v[108:111], a[96:99], a[40:43], v[108:111]
v_mfma_f32_16x16x32_bf16 v[108:111], a[100:103], a[44:47], v[108:111]
v_mfma_f32_16x16x32_bf16 v[92:95], a[100:103], a[36:39], v[92:95]
v_add_u32 v9, 0x8000, v9
v_add_u32 v10, 0x8000, v10
v_mfma_f32_16x16x32_bf16 v[92:95], a[96:99], a[32:35], v[92:95]
v_add_u32 v11, 0x8000, v11
v_mfma_f32_16x16x32_bf16 v[32:35], a[104:107], a[32:35], v[32:35]
v_mfma_f32_16x16x32_bf16 v[32:35], a[108:111], a[36:39], v[32:35]
v_mfma_f32_16x16x32_bf16 v[48:51], a[108:111], a[44:47], v[48:51]
s_waitcnt lgkmcnt(0)
s_barrier
v_mfma_f32_16x16x32_bf16 v[48:51], a[104:107], a[40:43], v[48:51]
s_xor_b32 m0, s77, 98304
ds_read_b64_tr_b16 a[88:89], v19 offset:36864
v_mfma_f32_16x16x32_bf16 v[64:67], a[104:107], a[48:51], v[64:67]
s_xor_b32 s64, s71, 4194304
ds_read_b64_tr_b16 a[90:91], v19 offset:37120
v_mfma_f32_16x16x32_bf16 v[64:67], a[108:111], a[52:55], v[64:67]
s_add_u32 s65, s79, 24576
buffer_load_dwordx4 v14, s[56:59], s64 offen lds
v_mfma_f32_16x16x32_bf16 v[80:83], a[108:111], a[60:63], v[80:83]
buffer_store_dwordx4 a[192:195], v16, s[44:47], s65 offen sc1
v_mfma_f32_16x16x32_bf16 v[80:83], a[104:107], a[56:59], v[80:83]
ds_read_b64_tr_b16 a[92:93], v19 offset:38912
v_mfma_f32_16x16x32_bf16 v[144:147], a[112:115], a[56:59], v[144:147]
ds_read_b64_tr_b16 a[94:95], v19 offset:39168
v_mfma_f32_16x16x32_bf16 v[144:147], a[116:119], a[60:63], v[144:147]
ds_read_b64_tr_b16 a[96:97], v20 offset:36864
v_mfma_f32_16x16x32_bf16 v[128:131], a[116:119], a[52:55], v[128:131]
ds_read_b64_tr_b16 a[98:99], v20 offset:37120
v_mfma_f32_16x16x32_bf16 v[128:131], a[112:115], a[48:51], v[128:131]
ds_read_b64_tr_b16 a[100:101], v20 offset:38912
v_mfma_f32_16x16x32_bf16 v[112:115], a[112:115], a[40:43], v[112:115]
s_add_u32 m0, s78, 114688
ds_read_b64_tr_b16 a[102:103], v20 offset:39168
v_mfma_f32_16x16x32_bf16 v[112:115], a[116:119], a[44:47], v[112:115]
s_add_u32 s64, s75, 3145728
ds_read_b64_tr_b16 a[104:105], v19 offset:40960
v_mfma_f32_16x16x32_bf16 v[96:99], a[116:119], a[36:39], v[96:99]
buffer_load_dwordx4 v23, s[60:63], s64 offen lds
v_mfma_f32_16x16x32_bf16 v[96:99], a[112:115], a[32:35], v[96:99]
ds_read_b64_tr_b16 a[106:107], v19 offset:41216
v_mfma_f32_16x16x32_bf16 v[36:39], a[72:75], a[32:35], v[36:39]
ds_read_b64_tr_b16 a[108:109], v19 offset:43008
v_mfma_f32_16x16x32_bf16 v[36:39], a[76:79], a[36:39], v[36:39]
s_branch L_po9
L_pg9:
s_branch L_pg13
L_po9:
ds_read_b64_tr_b16 a[110:111], v19 offset:43264
v_mfma_f32_16x16x32_bf16 v[52:55], a[76:79], a[44:47], v[52:55]
ds_read_b64_tr_b16 a[112:113], v20 offset:40960
v_mfma_f32_16x16x32_bf16 v[52:55], a[72:75], a[40:43], v[52:55]
ds_read_b64_tr_b16 a[114:115], v20 offset:41216
v_mfma_f32_16x16x32_bf16 v[68:71], a[72:75], a[48:51], v[68:71]
ds_read_b64_tr_b16 a[116:117], v20 offset:43008
v_mfma_f32_16x16x32_bf16 v[68:71], a[76:79], a[52:55], v[68:71]
s_xor_b32 m0, s77, 99328
ds_read_b64_tr_b16 a[118:119], v20 offset:43264
v_mfma_f32_16x16x32_bf16 v[84:87], a[76:79], a[60:63], v[84:87]
s_xor_b32 s64, s71, 4227072
v_mfma_f32_16x16x32_bf16 v[84:87], a[72:75], a[56:59], v[84:87]
buffer_load_dwordx4 v14, s[56:59], s64 offen lds
v_mfma_f32_16x16x32_bf16 v[148:151], a[80:83], a[56:59], v[148:151]
ds_read_b64_tr_b16 a[72:73], v19 offset:32768
v_mfma_f32_16x16x32_bf16 v[148:151], a[84:87], a[60:63], v[148:151]
ds_read_b64_tr_b16 a[74:75], v19 offset:33024
v_mfma_f32_16x16x32_bf16 v[132:135], a[84:87], a[52:55], v[132:135]
ds_read_b64_tr_b16 a[76:77], v19 offset:34816
v_mfma_f32_16x16x32_bf16 v[132:135], a[80:83], a[48:51], v[132:135]
ds_read_b64_tr_b16 a[78:79], v19 offset:35072
v_mfma_f32_16x16x32_bf16 v[116:119], a[80:83], a[40:43], v[116:119]
v_mfma_f32_16x16x32_bf16 v[116:119], a[84:87], a[44:47], v[116:119]
v_mfma_f32_16x16x32_bf16 v[100:103], a[84:87], a[36:39], v[100:103]
s_add_u32 m0, s78, 118784
v_mfma_f32_16x16x32_bf16 v[100:103], a[80:83], a[32:35], v[100:103]
s_waitcnt lgkmcnt(4)
s_add_u32 s64, s75, 3147776
ds_read_b64_tr_b16 a[80:81], v20 offset:32768
v_mfma_f32_16x16x32_bf16 v[184:187], a[88:91], a[0:3], v[184:187]
buffer_load_dwordx4 v23, s[60:63], s64 offen lds
v_mfma_f32_16x16x32_bf16 v[184:187], a[92:95], a[4:7], v[184:187]
ds_read_b64_tr_b16 a[82:83], v20 offset:33024
v_mfma_f32_16x16x32_bf16 v[192:195], a[92:95], a[12:15], v[192:195]
ds_read_b64_tr_b16 a[84:85], v20 offset:34816
v_mfma_f32_16x16x32_bf16 v[192:195], a[88:91], a[8:11], v[192:195]
ds_read_b64_tr_b16 a[86:87], v20 offset:35072
v_mfma_f32_16x16x32_bf16 v[200:203], a[88:91], a[16:19], v[200:203]
v_mfma_f32_16x16x32_bf16 v[200:203], a[92:95], a[20:23], v[200:203]
v_mfma_f32_16x16x32_bf16 v[208:211], a[92:95], a[28:31], v[208:211]
v_mfma_f32_16x16x32_bf16 v[208:211], a[88:91], a[24:27], v[208:211]
ds_read_b64_tr_b16 a[88:89], v4 offset:32768
v_mfma_f32_16x16x32_bf16 v[212:215], a[96:99], a[24:27], v[212:215]
s_xor_b32 m0, s77, 100352
ds_read_b64_tr_b16 a[90:91], v4 offset:33792
v_mfma_f32_16x16x32_bf16 v[212:215], a[100:103], a[28:31], v[212:215]
s_xor_b32 s64, s71, 4259840
ds_read_b64_tr_b16 a[92:93], v4 offset:40960
v_mfma_f32_16x16x32_bf16 v[204:207], a[100:103], a[20:23], v[204:207]
buffer_load_dwordx4 v15, s[56:59], s64 offen lds
v_mfma_f32_16x16x32_bf16 v[204:207], a[96:99], a[16:19], v[204:207]
ds_read_b64_tr_b16 a[94:95], v4 offset:41984
v_mfma_f32_16x16x32_bf16 v[196:199], a[96:99], a[8:11], v[196:199]
v_mfma_f32_16x16x32_bf16 v[196:199], a[100:103], a[12:15], v[196:199]
v_mfma_f32_16x16x32_bf16 v[188:191], a[100:103], a[4:7], v[188:191]
v_mfma_f32_16x16x32_bf16 v[188:191], a[96:99], a[0:3], v[188:191]
ds_read_b64_tr_b16 a[96:97], v5 offset:32768
v_mfma_f32_16x16x32_bf16 v[216:219], a[0:3], a[104:107], v[216:219]
s_add_u32 s65, s79, 25600
ds_read_b64_tr_b16 a[98:99], v5 offset:33792
v_mfma_f32_16x16x32_bf16 v[216:219], a[4:7], a[108:111], v[216:219]
s_add_u32 m0, s78, 122880
buffer_store_dwordx4 a[196:199], v16, s[44:47], s65 offen sc1
v_mfma_f32_16x16x32_bf16 v[224:227], a[12:15], a[108:111], v[224:227]
s_add_u32 s64, s75, 3149824
ds_read_b64_tr_b16 a[100:101], v5 offset:40960
v_mfma_f32_16x16x32_bf16 v[224:227], a[8:11], a[104:107], v[224:227]
buffer_load_dwordx4 v23, s[60:63], s64 offen lds
v_mfma_f32_16x16x32_bf16 v[232:235], a[16:19], a[104:107], v[232:235]
ds_read_b64_tr_b16 a[102:103], v5 offset:41984
v_mfma_f32_16x16x32_bf16 v[232:235], a[20:23], a[108:111], v[232:235]
v_mfma_f32_16x16x32_bf16 v[240:243], a[28:31], a[108:111], v[240:243]
v_mfma_f32_16x16x32_bf16 v[240:243], a[24:27], a[104:107], v[240:243]
ds_read_b64_tr_b16 a[104:105], v6 offset:32768
v_mfma_f32_16x16x32_bf16 v[244:247], a[24:27], a[112:115], v[244:247]
ds_read_b64_tr_b16 a[106:107], v6 offset:33792
v_mfma_f32_16x16x32_bf16 v[244:247], a[28:31], a[116:119], v[244:247]
ds_read_b64_tr_b16 a[108:109], v6 offset:40960
v_subrev_u32 v19, 0x8000, v19
v_mfma_f32_16x16x32_bf16 v[236:239], a[20:23], a[116:119], v[236:239]
s_xor_b32 m0, s77, 101376
ds_read_b64_tr_b16 a[110:111], v6 offset:41984
v_mfma_f32_16x16x32_bf16 v[236:239], a[16:19], a[112:115], v[236:239]
s_xor_b32 s64, s71, 4292608
v_mfma_f32_16x16x32_bf16 v[228:231], a[8:11], a[112:115], v[228:231]
buffer_load_dwordx4 v15, s[56:59], s64 offen lds
v_mfma_f32_16x16x32_bf16 v[228:231], a[12:15], a[116:119], v[228:231]
v_mfma_f32_16x16x32_bf16 v[220:223], a[4:7], a[116:119], v[220:223]
v_mfma_f32_16x16x32_bf16 v[220:223], a[0:3], a[112:115], v[220:223]
s_waitcnt lgkmcnt(4)
ds_read_b64_tr_b16 a[112:113], v7 offset:32768
v_mfma_f32_16x16x32_bf16 v[152:155], a[72:75], a[0:3], v[152:155]
ds_read_b64_tr_b16 a[114:115], v7 offset:33792
v_mfma_f32_16x16x32_bf16 v[152:155], a[76:79], a[4:7], v[152:155]
ds_read_b64_tr_b16 a[116:117], v7 offset:40960
v_subrev_u32 v20, 0x8000, v20
v_mfma_f32_16x16x32_bf16 v[160:163], a[76:79], a[12:15], v[160:163]
ds_read_b64_tr_b16 a[118:119], v7 offset:41984
v_mfma_f32_16x16x32_bf16 v[160:163], a[72:75], a[8:11], v[160:163]
v_mfma_f32_16x16x32_bf16 v[168:171], a[72:75], a[16:19], v[168:171]
v_mfma_f32_16x16x32_bf16 v[168:171], a[76:79], a[20:23], v[168:171]
v_mfma_f32_16x16x32_bf16 v[176:179], a[76:79], a[28:31], v[176:179]
s_xor_b32 m0, s84, 0
v_mfma_f32_16x16x32_bf16 v[176:179], a[72:75], a[24:27], v[176:179]
s_xor_b32 s64, s72, 1024
ds_read_b64_tr_b16 a[72:73], v8 offset:32768
v_mfma_f32_16x16x32_bf16 v[180:183], a[80:83], a[24:27], v[180:183]
buffer_load_dwordx4 v12, s[48:51], s64 offen lds
v_mfma_f32_16x16x32_bf16 v[180:183], a[84:87], a[28:31], v[180:183]
ds_read_b64_tr_b16 a[74:75], v8 offset:33792
v_subrev_u32 v4, 0x8000, v4
v_mfma_f32_16x16x32_bf16 v[172:175], a[84:87], a[20:23], v[172:175]
ds_read_b64_tr_b16 a[76:77], v8 offset:40960
v_mfma_f32_16x16x32_bf16 v[172:175], a[80:83], a[16:19], v[172:175]
s_xor_b32 m0, s84, 1024
ds_read_b64_tr_b16 a[78:79], v8 offset:41984
v_mfma_f32_16x16x32_bf16 v[164:167], a[80:83], a[8:11], v[164:167]
s_xor_b32 s64, s72, 17408
v_mfma_f32_16x16x32_bf16 v[164:167], a[84:87], a[12:15], v[164:167]
buffer_load_dwordx4 v13, s[48:51], s64 offen lds
v_mfma_f32_16x16x32_bf16 v[156:159], a[84:87], a[4:7], v[156:159]
v_mfma_f32_16x16x32_bf16 v[156:159], a[80:83], a[0:3], v[156:159]
ds_read_b64_tr_b16 a[80:81], v9 offset:32768
v_mfma_f32_16x16x32_bf16 v[24:27], a[88:91], a[0:3], v[24:27]
s_xor_b32 m0, s84, 2048
ds_read_b64_tr_b16 a[82:83], v9 offset:33792
v_mfma_f32_16x16x32_bf16 v[24:27], a[92:95], a[4:7], v[24:27]
s_xor_b32 s64, s72, 132096
ds_read_b64_tr_b16 a[84:85], v9 offset:40960
v_subrev_u32 v5, 0x8000, v5
v_mfma_f32_16x16x32_bf16 v[40:43], a[92:95], a[12:15], v[40:43]
buffer_load_dwordx4 v12, s[48:51], s64 offen lds
v_mfma_f32_16x16x32_bf16 v[40:43], a[88:91], a[8:11], v[40:43]
ds_read_b64_tr_b16 a[86:87], v9 offset:41984
v_mfma_f32_16x16x32_bf16 v[56:59], a[88:91], a[16:19], v[56:59]
v_mfma_f32_16x16x32_bf16 v[56:59], a[92:95], a[20:23], v[56:59]
s_xor_b32 m0, s84, 3072
v_mfma_f32_16x16x32_bf16 v[72:75], a[92:95], a[28:31], v[72:75]
s_waitcnt vmcnt(12)
s_xor_b32 s64, s72, 148480
ds_read_b128 a[32:35], v2 offset:32768
v_mfma_f32_16x16x32_bf16 v[72:75], a[88:91], a[24:27], v[72:75]
buffer_load_dwordx4 v13, s[48:51], s64 offen lds
v_mfma_f32_16x16x32_bf16 v[136:139], a[96:99], a[24:27], v[136:139]
ds_read_b128 a[36:39], v3 offset:32768
v_mfma_f32_16x16x32_bf16 v[136:139], a[100:103], a[28:31], v[136:139]
ds_read_b128 a[40:43], v2 offset:34816
v_subrev_u32 v6, 0x8000, v6
v_mfma_f32_16x16x32_bf16 v[120:123], a[100:103], a[20:23], v[120:123]
s_xor_b32 m0, s84, 4096
ds_read_b128 a[44:47], v3 offset:34816
v_mfma_f32_16x16x32_bf16 v[120:123], a[96:99], a[16:19], v[120:123]
s_xor_b32 s64, s73, 1024
ds_read_b128 a[48:51], v2 offset:36864
v_mfma_f32_16x16x32_bf16 v[104:107], a[96:99], a[8:11], v[104:107]
buffer_load_dwordx4 v12, s[48:51], s64 offen lds
v_mfma_f32_16x16x32_bf16 v[104:107], a[100:103], a[12:15], v[104:107]
s_add_u32 s65, s79, 9216
ds_read_b128 a[52:55], v3 offset:36864
v_mfma_f32_16x16x32_bf16 v[88:91], a[100:103], a[4:7], v[88:91]
buffer_store_dwordx4 a[200:203], v16, s[44:47], s65 offen sc1
v_mfma_f32_16x16x32_bf16 v[88:91], a[96:99], a[0:3], v[88:91]
s_waitcnt lgkmcnt(6)
s_xor_b32 m0, s84, 5120
ds_read_b128 a[56:59], v2 offset:38912
v_mfma_f32_16x16x32_bf16 v[28:31], a[104:107], a[0:3], v[28:31]
s_xor_b32 s64, s73, 17408
ds_read_b128 a[60:63], v3 offset:38912
v_mfma_f32_16x16x32_bf16 v[28:31], a[108:111], a[4:7], v[28:31]
buffer_load_dwordx4 v13, s[48:51], s64 offen lds
v_mfma_f32_16x16x32_bf16 v[44:47], a[108:111], a[12:15], v[44:47]
ds_read_b64_tr_b16 a[88:89], v10 offset:32768
v_subrev_u32 v7, 0x8000, v7
v_mfma_f32_16x16x32_bf16 v[44:47], a[104:107], a[8:11], v[44:47]
ds_read_b64_tr_b16 a[90:91], v10 offset:33792
v_mfma_f32_16x16x32_bf16 v[60:63], a[104:107], a[16:19], v[60:63]
s_xor_b32 m0, s84, 6144
ds_read_b64_tr_b16 a[92:93], v10 offset:40960
v_mfma_f32_16x16x32_bf16 v[60:63], a[108:111], a[20:23], v[60:63]
s_xor_b32 s64, s73, 132096
ds_read_b64_tr_b16 a[94:95], v10 offset:41984
v_mfma_f32_16x16x32_bf16 v[76:79], a[108:111], a[28:31], v[76:79]
buffer_load_dwordx4 v12, s[48:51], s64 offen lds
v_mfma_f32_16x16x32_bf16 v[76:79], a[104:107], a[24:27], v[76:79]
ds_read_b64_tr_b16 a[96:97], v11 offset:32768
v_mfma_f32_16x16x32_bf16 v[140:143], a[112:115], a[24:27], v[140:143]
ds_read_b64_tr_b16 a[98:99], v11 offset:33792
v_mfma_f32_16x16x32_bf16 v[140:143], a[116:119], a[28:31], v[140:143]
s_xor_b32 m0, s84, 7168
ds_read_b64_tr_b16 a[100:101], v11 offset:40960
v_subrev_u32 v8, 0x8000, v8
v_mfma_f32_16x16x32_bf16 v[124:127], a[116:119], a[20:23], v[124:127]
s_xor_b32 s64, s73, 148480
ds_read_b64_tr_b16 a[102:103], v11 offset:41984
v_mfma_f32_16x16x32_bf16 v[124:127], a[112:115], a[16:19], v[124:127]
buffer_load_dwordx4 v13, s[48:51], s64 offen lds
v_mfma_f32_16x16x32_bf16 v[108:111], a[112:115], a[8:11], v[108:111]
v_mfma_f32_16x16x32_bf16 v[108:111], a[116:119], a[12:15], v[108:111]
v_mfma_f32_16x16x32_bf16 v[92:95], a[116:119], a[4:7], v[92:95]
v_subrev_u32 v9, 0x8000, v9
v_subrev_u32 v10, 0x8000, v10
v_mfma_f32_16x16x32_bf16 v[92:95], a[112:115], a[0:3], v[92:95]
v_subrev_u32 v11, 0x8000, v11
v_mfma_f32_16x16x32_bf16 v[32:35], a[72:75], a[0:3], v[32:35]
v_mfma_f32_16x16x32_bf16 v[32:35], a[76:79], a[4:7], v[32:35]
v_mfma_f32_16x16x32_bf16 v[48:51], a[76:79], a[12:15], v[48:51]
s_waitcnt lgkmcnt(0)
s_barrier
v_mfma_f32_16x16x32_bf16 v[48:51], a[72:75], a[8:11], v[48:51]
s_xor_b32 m0, s77, 131072
ds_read_b64_tr_b16 a[104:105], v19 offset:4096
v_mfma_f32_16x16x32_bf16 v[64:67], a[72:75], a[16:19], v[64:67]
s_xor_b32 s64, s71, 4718592
ds_read_b64_tr_b16 a[106:107], v19 offset:4352
v_mfma_f32_16x16x32_bf16 v[64:67], a[76:79], a[20:23], v[64:67]
buffer_load_dwordx4 v14, s[56:59], s64 offen lds
v_mfma_f32_16x16x32_bf16 v[80:83], a[76:79], a[28:31], v[80:83]
ds_read_b64_tr_b16 a[108:109], v19 offset:6144
v_mfma_f32_16x16x32_bf16 v[80:83], a[72:75], a[24:27], v[80:83]
ds_read_b64_tr_b16 a[110:111], v19 offset:6400
v_mfma_f32_16x16x32_bf16 v[144:147], a[80:83], a[24:27], v[144:147]
ds_read_b64_tr_b16 a[112:113], v20 offset:4096
v_mfma_f32_16x16x32_bf16 v[144:147], a[84:87], a[28:31], v[144:147]
ds_read_b64_tr_b16 a[114:115], v20 offset:4352
v_mfma_f32_16x16x32_bf16 v[128:131], a[84:87], a[20:23], v[128:131]
ds_read_b64_tr_b16 a[116:117], v20 offset:6144
v_mfma_f32_16x16x32_bf16 v[128:131], a[80:83], a[16:19], v[128:131]
ds_read_b64_tr_b16 a[118:119], v20 offset:6400
v_mfma_f32_16x16x32_bf16 v[112:115], a[80:83], a[8:11], v[112:115]
s_add_u32 m0, s78, 147456
ds_read_b64_tr_b16 a[72:73], v19 offset:8192
v_mfma_f32_16x16x32_bf16 v[112:115], a[84:87], a[12:15], v[112:115]
s_add_u32 s64, s75, 3538944
ds_read_b64_tr_b16 a[74:75], v19 offset:8448
v_mfma_f32_16x16x32_bf16 v[96:99], a[84:87], a[4:7], v[96:99]
buffer_load_dwordx4 v23, s[60:63], s64 offen lds
v_mfma_f32_16x16x32_bf16 v[96:99], a[80:83], a[0:3], v[96:99]
ds_read_b64_tr_b16 a[76:77], v19 offset:10240
v_mfma_f32_16x16x32_bf16 v[36:39], a[88:91], a[0:3], v[36:39]
ds_read_b64_tr_b16 a[78:79], v19 offset:10496
v_mfma_f32_16x16x32_bf16 v[36:39], a[92:95], a[4:7], v[36:39]
ds_read_b64_tr_b16 a[80:81], v20 offset:8192
v_mfma_f32_16x16x32_bf16 v[52:55], a[92:95], a[12:15], v[52:55]
ds_read_b64_tr_b16 a[82:83], v20 offset:8448
v_mfma_f32_16x16x32_bf16 v[52:55], a[88:91], a[8:11], v[52:55]
ds_read_b64_tr_b16 a[84:85], v20 offset:10240
v_mfma_f32_16x16x32_bf16 v[68:71], a[88:91], a[16:19], v[68:71]
ds_read_b64_tr_b16 a[86:87], v20 offset:10496
v_mfma_f32_16x16x32_bf16 v[68:71], a[92:95], a[20:23], v[68:71]
s_xor_b32 m0, s77, 132096
v_mfma_f32_16x16x32_bf16 v[84:87], a[92:95], a[28:31], v[84:87]
s_xor_b32 s64, s71, 4751360
v_mfma_f32_16x16x32_bf16 v[84:87], a[88:91], a[24:27], v[84:87]
buffer_load_dwordx4 v14, s[56:59], s64 offen lds
v_mfma_f32_16x16x32_bf16 v[148:151], a[96:99], a[24:27], v[148:151]
ds_read_b64_tr_b16 a[88:89], v19 offset:0
v_mfma_f32_16x16x32_bf16 v[148:151], a[100:103], a[28:31], v[148:151]
ds_read_b64_tr_b16 a[90:91], v19 offset:256
v_mfma_f32_16x16x32_bf16 v[132:135], a[100:103], a[20:23], v[132:135]
s_add_u32 s65, s79, 26624
ds_read_b64_tr_b16 a[92:93], v19 offset:2048
v_mfma_f32_16x16x32_bf16 v[132:135], a[96:99], a[16:19], v[132:135]
buffer_store_dwordx4 a[204:207], v16, s[44:47], s65 offen sc1
v_mfma_f32_16x16x32_bf16 v[116:119], a[96:99], a[8:11], v[116:119]
ds_read_b64_tr_b16 a[94:95], v19 offset:2304
v_mfma_f32_16x16x32_bf16 v[116:119], a[100:103], a[12:15], v[116:119]
v_mfma_f32_16x16x32_bf16 v[100:103], a[100:103], a[4:7], v[100:103]
s_add_u32 m0, s78, 151552
v_mfma_f32_16x16x32_bf16 v[100:103], a[96:99], a[0:3], v[100:103]
s_waitcnt lgkmcnt(4)
s_add_u32 s64, s75, 3540992
ds_read_b64_tr_b16 a[96:97], v20 offset:0
v_mfma_f32_16x16x32_bf16 v[184:187], a[104:107], a[32:35], v[184:187]
buffer_load_dwordx4 v23, s[60:63], s64 offen lds
v_mfma_f32_16x16x32_bf16 v[184:187], a[108:111], a[36:39], v[184:187]
ds_read_b64_tr_b16 a[98:99], v20 offset:256
v_mfma_f32_16x16x32_bf16 v[192:195], a[108:111], a[44:47], v[192:195]
ds_read_b64_tr_b16 a[100:101], v20 offset:2048
v_mfma_f32_16x16x32_bf16 v[192:195], a[104:107], a[40:43], v[192:195]
ds_read_b64_tr_b16 a[102:103], v20 offset:2304
v_mfma_f32_16x16x32_bf16 v[200:203], a[104:107], a[48:51], v[200:203]
s_cmp_eq_u32 s30, 0
s_cselect_b32 s81, 256, 0
v_mfma_f32_16x16x32_bf16 v[200:203], a[108:111], a[52:55], v[200:203]
v_mfma_f32_16x16x32_bf16 v[208:211], a[108:111], a[60:63], v[208:211]
v_mfma_f32_16x16x32_bf16 v[208:211], a[104:107], a[56:59], v[208:211]
ds_read_b64_tr_b16 a[104:105], v4 offset:0
v_mfma_f32_16x16x32_bf16 v[212:215], a[112:115], a[56:59], v[212:215]
s_xor_b32 m0, s77, 133120
ds_read_b64_tr_b16 a[106:107], v4 offset:1024
v_mfma_f32_16x16x32_bf16 v[212:215], a[116:119], a[60:63], v[212:215]
s_xor_b32 s64, s71, 4784128
ds_read_b64_tr_b16 a[108:109], v4 offset:8192
v_mfma_f32_16x16x32_bf16 v[204:207], a[116:119], a[52:55], v[204:207]
buffer_load_dwordx4 v15, s[56:59], s64 offen lds
v_mfma_f32_16x16x32_bf16 v[204:207], a[112:115], a[48:51], v[204:207]
ds_read_b64_tr_b16 a[110:111], v4 offset:9216
v_mfma_f32_16x16x32_bf16 v[196:199], a[112:115], a[40:43], v[196:199]
v_mfma_f32_16x16x32_bf16 v[196:199], a[116:119], a[44:47], v[196:199]
v_mfma_f32_16x16x32_bf16 v[188:191], a[116:119], a[36:39], v[188:191]
v_mfma_f32_16x16x32_bf16 v[188:191], a[112:115], a[32:35], v[188:191]
ds_read_b64_tr_b16 a[112:113], v5 offset:0
v_mfma_f32_16x16x32_bf16 v[216:219], a[32:35], a[72:75], v[216:219]
ds_read_b64_tr_b16 a[114:115], v5 offset:1024
v_mfma_f32_16x16x32_bf16 v[216:219], a[36:39], a[76:79], v[216:219]
s_add_u32 m0, s78, 155648
ds_read_b64_tr_b16 a[116:117], v5 offset:8192
v_mfma_f32_16x16x32_bf16 v[224:227], a[44:47], a[76:79], v[224:227]
s_add_u32 s64, s75, 3543040
ds_read_b64_tr_b16 a[118:119], v5 offset:9216
v_mfma_f32_16x16x32_bf16 v[224:227], a[40:43], a[72:75], v[224:227]
buffer_load_dwordx4 v23, s[60:63], s64 offen lds
v_mfma_f32_16x16x32_bf16 v[232:235], a[48:51], a[72:75], v[232:235]
v_mfma_f32_16x16x32_bf16 v[232:235], a[52:55], a[76:79], v[232:235]
v_mfma_f32_16x16x32_bf16 v[240:243], a[60:63], a[76:79], v[240:243]
v_mfma_f32_16x16x32_bf16 v[240:243], a[56:59], a[72:75], v[240:243]
ds_read_b64_tr_b16 a[72:73], v6 offset:0
v_mfma_f32_16x16x32_bf16 v[244:247], a[56:59], a[80:83], v[244:247]
ds_read_b64_tr_b16 a[74:75], v6 offset:1024
v_mfma_f32_16x16x32_bf16 v[244:247], a[60:63], a[84:87], v[244:247]
ds_read_b64_tr_b16 a[76:77], v6 offset:8192
v_mfma_f32_16x16x32_bf16 v[236:239], a[52:55], a[84:87], v[236:239]
s_xor_b32 m0, s77, 134144
ds_read_b64_tr_b16 a[78:79], v6 offset:9216
v_mfma_f32_16x16x32_bf16 v[236:239], a[48:51], a[80:83], v[236:239]
s_xor_b32 s64, s71, 4816896
v_mfma_f32_16x16x32_bf16 v[228:231], a[40:43], a[80:83], v[228:231]
buffer_load_dwordx4 v15, s[56:59], s64 offen lds
v_mfma_f32_16x16x32_bf16 v[228:231], a[44:47], a[84:87], v[228:231]
v_mfma_f32_16x16x32_bf16 v[220:223], a[36:39], a[84:87], v[220:223]
v_mfma_f32_16x16x32_bf16 v[220:223], a[32:35], a[80:83], v[220:223]
s_waitcnt lgkmcnt(4)
ds_read_b64_tr_b16 a[80:81], v7 offset:0
v_mfma_f32_16x16x32_bf16 v[152:155], a[88:91], a[32:35], v[152:155]
ds_read_b64_tr_b16 a[82:83], v7 offset:1024
v_mfma_f32_16x16x32_bf16 v[152:155], a[92:95], a[36:39], v[152:155]
ds_read_b64_tr_b16 a[84:85], v7 offset:8192
v_mfma_f32_16x16x32_bf16 v[160:163], a[92:95], a[44:47], v[160:163]
ds_read_b64_tr_b16 a[86:87], v7 offset:9216
v_mfma_f32_16x16x32_bf16 v[160:163], a[88:91], a[40:43], v[160:163]
v_mfma_f32_16x16x32_bf16 v[168:171], a[88:91], a[48:51], v[168:171]
v_mfma_f32_16x16x32_bf16 v[168:171], a[92:95], a[52:55], v[168:171]
v_mfma_f32_16x16x32_bf16 v[176:179], a[92:95], a[60:63], v[176:179]
s_xor_b32 m0, s84, 32768
v_mfma_f32_16x16x32_bf16 v[176:179], a[88:91], a[56:59], v[176:179]
s_xor_b32 s64, s72, 1152
ds_read_b64_tr_b16 a[88:89], v8 offset:0
v_mfma_f32_16x16x32_bf16 v[180:183], a[96:99], a[56:59], v[180:183]
s_add_u32 s65, s79, 27648
buffer_load_dwordx4 v12, s[48:51], s64 offen lds
v_mfma_f32_16x16x32_bf16 v[180:183], a[100:103], a[60:63], v[180:183]
buffer_store_dwordx4 a[208:211], v16, s[44:47], s65 offen sc1
v_mfma_f32_16x16x32_bf16 v[172:175], a[100:103], a[52:55], v[172:175]
ds_read_b64_tr_b16 a[90:91], v8 offset:1024
v_mfma_f32_16x16x32_bf16 v[172:175], a[96:99], a[48:51], v[172:175]
s_xor_b32 m0, s84, 33792
ds_read_b64_tr_b16 a[92:93], v8 offset:8192
v_mfma_f32_16x16x32_bf16 v[164:167], a[96:99], a[40:43], v[164:167]
s_xor_b32 s64, s72, 17536
ds_read_b64_tr_b16 a[94:95], v8 offset:9216
v_mfma_f32_16x16x32_bf16 v[164:167], a[100:103], a[44:47], v[164:167]
buffer_load_dwordx4 v13, s[48:51], s64 offen lds
v_mfma_f32_16x16x32_bf16 v[156:159], a[100:103], a[36:39], v[156:159]
v_mfma_f32_16x16x32_bf16 v[156:159], a[96:99], a[32:35], v[156:159]
ds_read_b64_tr_b16 a[96:97], v9 offset:0
v_mfma_f32_16x16x32_bf16 v[24:27], a[104:107], a[32:35], v[24:27]
s_xor_b32 m0, s84, 34816
ds_read_b64_tr_b16 a[98:99], v9 offset:1024
v_mfma_f32_16x16x32_bf16 v[24:27], a[108:111], a[36:39], v[24:27]
s_xor_b32 s64, s72, 132224
ds_read_b64_tr_b16 a[100:101], v9 offset:8192
v_mfma_f32_16x16x32_bf16 v[40:43], a[108:111], a[44:47], v[40:43]
buffer_load_dwordx4 v12, s[48:51], s64 offen lds
v_mfma_f32_16x16x32_bf16 v[40:43], a[104:107], a[40:43], v[40:43]
ds_read_b64_tr_b16 a[102:103], v9 offset:9216
v_mfma_f32_16x16x32_bf16 v[56:59], a[104:107], a[48:51], v[56:59]
v_mfma_f32_16x16x32_bf16 v[56:59], a[108:111], a[52:55], v[56:59]
s_xor_b32 m0, s84, 35840
v_mfma_f32_16x16x32_bf16 v[72:75], a[108:111], a[60:63], v[72:75]
s_waitcnt vmcnt(12)
s_xor_b32 s64, s72, 148608
ds_read_b128 a[0:3], v2 offset:0
v_mfma_f32_16x16x32_bf16 v[72:75], a[104:107], a[56:59], v[72:75]
buffer_load_dwordx4 v13, s[48:51], s64 offen lds
v_mfma_f32_16x16x32_bf16 v[136:139], a[112:115], a[56:59], v[136:139]
ds_read_b128 a[4:7], v3 offset:0
v_mfma_f32_16x16x32_bf16 v[136:139], a[116:119], a[60:63], v[136:139]
ds_read_b128 a[8:11], v2 offset:2048
v_mfma_f32_16x16x32_bf16 v[120:123], a[116:119], a[52:55], v[120:123]
s_xor_b32 m0, s84, 36864
ds_read_b128 a[12:15], v3 offset:2048
v_mfma_f32_16x16x32_bf16 v[120:123], a[112:115], a[48:51], v[120:123]
s_xor_b32 s64, s73, 1152
ds_read_b128 a[16:19], v2 offset:4096
v_mfma_f32_16x16x32_bf16 v[104:107], a[112:115], a[40:43], v[104:107]
buffer_load_dwordx4 v12, s[48:51], s64 offen lds
v_mfma_f32_16x16x32_bf16 v[104:107], a[116:119], a[44:47], v[104:107]
ds_read_b128 a[20:23], v3 offset:4096
v_mfma_f32_16x16x32_bf16 v[88:91], a[116:119], a[36:39], v[88:91]
ds_read_b128 a[24:27], v2 offset:6144
v_mfma_f32_16x16x32_bf16 v[88:91], a[112:115], a[32:35], v[88:91]
s_waitcnt lgkmcnt(7)
s_xor_b32 m0, s84, 37888
ds_read_b128 a[28:31], v3 offset:6144
v_mfma_f32_16x16x32_bf16 v[28:31], a[72:75], a[32:35], v[28:31]
s_xor_b32 s64, s73, 17536
ds_read_b64_tr_b16 a[104:105], v10 offset:0
v_mfma_f32_16x16x32_bf16 v[28:31], a[76:79], a[36:39], v[28:31]
buffer_load_dwordx4 v13, s[48:51], s64 offen lds
v_mfma_f32_16x16x32_bf16 v[44:47], a[76:79], a[44:47], v[44:47]
ds_read_b64_tr_b16 a[106:107], v10 offset:1024
v_mfma_f32_16x16x32_bf16 v[44:47], a[72:75], a[40:43], v[44:47]
ds_read_b64_tr_b16 a[108:109], v10 offset:8192
v_mfma_f32_16x16x32_bf16 v[60:63], a[72:75], a[48:51], v[60:63]
s_xor_b32 m0, s84, 38912
ds_read_b64_tr_b16 a[110:111], v10 offset:9216
v_mfma_f32_16x16x32_bf16 v[60:63], a[76:79], a[52:55], v[60:63]
s_xor_b32 s64, s73, 132224
ds_read_b64_tr_b16 a[112:113], v11 offset:0
v_mfma_f32_16x16x32_bf16 v[76:79], a[76:79], a[60:63], v[76:79]
buffer_load_dwordx4 v12, s[48:51], s64 offen lds
v_mfma_f32_16x16x32_bf16 v[76:79], a[72:75], a[56:59], v[76:79]
ds_read_b64_tr_b16 a[114:115], v11 offset:1024
v_mfma_f32_16x16x32_bf16 v[140:143], a[80:83], a[56:59], v[140:143]
ds_read_b64_tr_b16 a[116:117], v11 offset:8192
v_mfma_f32_16x16x32_bf16 v[140:143], a[84:87], a[60:63], v[140:143]
s_xor_b32 m0, s84, 39936
ds_read_b64_tr_b16 a[118:119], v11 offset:9216
v_mfma_f32_16x16x32_bf16 v[124:127], a[84:87], a[52:55], v[124:127]
s_xor_b32 s64, s73, 148608
v_mfma_f32_16x16x32_bf16 v[124:127], a[80:83], a[48:51], v[124:127]
buffer_load_dwordx4 v13, s[48:51], s64 offen lds
v_mfma_f32_16x16x32_bf16 v[108:111], a[80:83], a[40:43], v[108:111]
v_mfma_f32_16x16x32_bf16 v[108:111], a[84:87], a[44:47], v[108:111]
v_mfma_f32_16x16x32_bf16 v[92:95], a[84:87], a[36:39], v[92:95]
v_mfma_f32_16x16x32_bf16 v[92:95], a[80:83], a[32:35], v[92:95]
v_mfma_f32_16x16x32_bf16 v[32:35], a[88:91], a[32:35], v[32:35]
v_mfma_f32_16x16x32_bf16 v[32:35], a[92:95], a[36:39], v[32:35]
v_mfma_f32_16x16x32_bf16 v[48:51], a[92:95], a[44:47], v[48:51]
s_waitcnt lgkmcnt(0)
s_barrier
v_mfma_f32_16x16x32_bf16 v[48:51], a[88:91], a[40:43], v[48:51]
s_xor_b32 m0, s77, 65536
s_add_u32 s65, s79, 11264
ds_read_b64_tr_b16 a[72:73], v19 offset:36864
v_mfma_f32_16x16x32_bf16 v[64:67], a[88:91], a[48:51], v[64:67]
s_xor_b32 s64, s71, 5242880
buffer_store_dwordx4 a[212:215], v16, s[44:47], s65 offen sc1
v_mfma_f32_16x16x32_bf16 v[64:67], a[92:95], a[52:55], v[64:67]
buffer_load_dwordx4 v14, s[56:59], s64 offen lds
v_mfma_f32_16x16x32_bf16 v[80:83], a[92:95], a[60:63], v[80:83]
ds_read_b64_tr_b16 a[74:75], v19 offset:37120
v_mfma_f32_16x16x32_bf16 v[80:83], a[88:91], a[56:59], v[80:83]
buffer_load_dword v1, off, s[52:55], s78 sc1
v_mfma_f32_16x16x32_bf16 v[144:147], a[96:99], a[56:59], v[144:147]
ds_read_b64_tr_b16 a[76:77], v19 offset:38912
v_mfma_f32_16x16x32_bf16 v[144:147], a[100:103], a[60:63], v[144:147]
ds_read_b64_tr_b16 a[78:79], v19 offset:39168
v_mfma_f32_16x16x32_bf16 v[128:131], a[100:103], a[52:55], v[128:131]
ds_read_b64_tr_b16 a[80:81], v20 offset:36864
v_mfma_f32_16x16x32_bf16 v[128:131], a[96:99], a[48:51], v[128:131]
ds_read_b64_tr_b16 a[82:83], v20 offset:37120
v_mfma_f32_16x16x32_bf16 v[112:115], a[96:99], a[40:43], v[112:115]
s_add_u32 m0, s78, 81920
ds_read_b64_tr_b16 a[84:85], v20 offset:38912
v_mfma_f32_16x16x32_bf16 v[112:115], a[100:103], a[44:47], v[112:115]
s_add_u32 s64, s75, 3932160
ds_read_b64_tr_b16 a[86:87], v20 offset:39168
v_mfma_f32_16x16x32_bf16 v[96:99], a[100:103], a[36:39], v[96:99]
buffer_load_dwordx4 v23, s[60:63], s64 offen lds
v_mfma_f32_16x16x32_bf16 v[96:99], a[96:99], a[32:35], v[96:99]
ds_read_b64_tr_b16 a[88:89], v19 offset:40960
v_mfma_f32_16x16x32_bf16 v[36:39], a[104:107], a[32:35], v[36:39]
ds_read_b64_tr_b16 a[90:91], v19 offset:41216
v_mfma_f32_16x16x32_bf16 v[36:39], a[108:111], a[36:39], v[36:39]
ds_read_b64_tr_b16 a[92:93], v19 offset:43008
v_mfma_f32_16x16x32_bf16 v[52:55], a[108:111], a[44:47], v[52:55]
ds_read_b64_tr_b16 a[94:95], v19 offset:43264
v_mfma_f32_16x16x32_bf16 v[52:55], a[104:107], a[40:43], v[52:55]
ds_read_b64_tr_b16 a[96:97], v20 offset:40960
v_mfma_f32_16x16x32_bf16 v[68:71], a[104:107], a[48:51], v[68:71]
ds_read_b64_tr_b16 a[98:99], v20 offset:41216
v_mfma_f32_16x16x32_bf16 v[68:71], a[108:111], a[52:55], v[68:71]
s_xor_b32 m0, s77, 66560
ds_read_b64_tr_b16 a[100:101], v20 offset:43008
v_mfma_f32_16x16x32_bf16 v[84:87], a[108:111], a[60:63], v[84:87]
s_xor_b32 s64, s71, 5275648
ds_read_b64_tr_b16 a[102:103], v20 offset:43264
v_mfma_f32_16x16x32_bf16 v[84:87], a[104:107], a[56:59], v[84:87]
buffer_load_dwordx4 v14, s[56:59], s64 offen lds
v_mfma_f32_16x16x32_bf16 v[148:151], a[112:115], a[56:59], v[148:151]
ds_read_b64_tr_b16 a[104:105], v19 offset:32768
v_mfma_f32_16x16x32_bf16 v[148:151], a[116:119], a[60:63], v[148:151]
ds_read_b64_tr_b16 a[106:107], v19 offset:33024
v_mfma_f32_16x16x32_bf16 v[132:135], a[116:119], a[52:55], v[132:135]
ds_read_b64_tr_b16 a[108:109], v19 offset:34816
v_mfma_f32_16x16x32_bf16 v[132:135], a[112:115], a[48:51], v[132:135]
ds_read_b64_tr_b16 a[110:111], v19 offset:35072
v_mfma_f32_16x16x32_bf16 v[116:119], a[112:115], a[40:43], v[116:119]
v_mfma_f32_16x16x32_bf16 v[116:119], a[116:119], a[44:47], v[116:119]
v_mfma_f32_16x16x32_bf16 v[100:103], a[116:119], a[36:39], v[100:103]
s_add_u32 m0, s78, 86016
v_mfma_f32_16x16x32_bf16 v[100:103], a[112:115], a[32:35], v[100:103]
s_waitcnt lgkmcnt(5)
s_add_u32 s64, s75, 3934208
ds_read_b64_tr_b16 a[112:113], v20 offset:32768
v_mfma_f32_16x16x32_bf16 v[184:187], a[72:75], a[0:3], v[184:187]
buffer_load_dwordx4 v23, s[60:63], s64 offen lds
v_mfma_f32_16x16x32_bf16 v[184:187], a[76:79], a[4:7], v[184:187]
ds_read_b64_tr_b16 a[114:115], v20 offset:33024
v_mfma_f32_16x16x32_bf16 v[192:195], a[76:79], a[12:15], v[192:195]
ds_read_b64_tr_b16 a[116:117], v20 offset:34816
v_mfma_f32_16x16x32_bf16 v[192:195], a[72:75], a[8:11], v[192:195]
ds_read_b64_tr_b16 a[118:119], v20 offset:35072
v_mfma_f32_16x16x32_bf16 v[200:203], a[72:75], a[16:19], v[200:203]
v_mfma_f32_16x16x32_bf16 v[200:203], a[76:79], a[20:23], v[200:203]
v_mfma_f32_16x16x32_bf16 v[208:211], a[76:79], a[28:31], v[208:211]
s_branch L_po10
L_pg10:
s_branch L_tr1
L_po10:
v_mfma_f32_16x16x32_bf16 v[208:211], a[72:75], a[24:27], v[208:211]
ds_read_b64_tr_b16 a[72:73], v4 offset:32768
v_mfma_f32_16x16x32_bf16 v[212:215], a[80:83], a[24:27], v[212:215]
s_xor_b32 m0, s77, 67584
ds_read_b64_tr_b16 a[74:75], v4 offset:33792
v_mfma_f32_16x16x32_bf16 v[212:215], a[84:87], a[28:31], v[212:215]
s_xor_b32 s64, s71, 5308416
ds_read_b64_tr_b16 a[76:77], v4 offset:40960
v_mfma_f32_16x16x32_bf16 v[204:207], a[84:87], a[20:23], v[204:207]
buffer_load_dwordx4 v15, s[56:59], s64 offen lds
v_mfma_f32_16x16x32_bf16 v[204:207], a[80:83], a[16:19], v[204:207]
ds_read_b64_tr_b16 a[78:79], v4 offset:41984
v_mfma_f32_16x16x32_bf16 v[196:199], a[80:83], a[8:11], v[196:199]
v_mfma_f32_16x16x32_bf16 v[196:199], a[84:87], a[12:15], v[196:199]
v_mfma_f32_16x16x32_bf16 v[188:191], a[84:87], a[4:7], v[188:191]
v_mfma_f32_16x16x32_bf16 v[188:191], a[80:83], a[0:3], v[188:191]
ds_read_b64_tr_b16 a[80:81], v5 offset:32768
v_mfma_f32_16x16x32_bf16 v[216:219], a[0:3], a[88:91], v[216:219]
s_add_u32 s65, s79, 28672
ds_read_b64_tr_b16 a[82:83], v5 offset:33792
v_mfma_f32_16x16x32_bf16 v[216:219], a[4:7], a[92:95], v[216:219]
s_add_u32 m0, s78, 90112
buffer_store_dwordx4 a[216:219], v16, s[44:47], s65 offen sc1
v_mfma_f32_16x16x32_bf16 v[224:227], a[12:15], a[92:95], v[224:227]
s_add_u32 s64, s75, 3936256
ds_read_b64_tr_b16 a[84:85], v5 offset:40960
v_mfma_f32_16x16x32_bf16 v[224:227], a[8:11], a[88:91], v[224:227]
buffer_load_dwordx4 v23, s[60:63], s64 offen lds
v_mfma_f32_16x16x32_bf16 v[232:235], a[16:19], a[88:91], v[232:235]
ds_read_b64_tr_b16 a[86:87], v5 offset:41984
v_mfma_f32_16x16x32_bf16 v[232:235], a[20:23], a[92:95], v[232:235]
v_mfma_f32_16x16x32_bf16 v[240:243], a[28:31], a[92:95], v[240:243]
v_mfma_f32_16x16x32_bf16 v[240:243], a[24:27], a[88:91], v[240:243]
ds_read_b64_tr_b16 a[88:89], v6 offset:32768
v_mfma_f32_16x16x32_bf16 v[244:247], a[24:27], a[96:99], v[244:247]
s_waitcnt lgkmcnt(5)
ds_read_b64_tr_b16 a[90:91], v6 offset:33792
v_mfma_f32_16x16x32_bf16 v[244:247], a[28:31], a[100:103], v[244:247]
ds_read_b64_tr_b16 a[92:93], v6 offset:40960
v_add_u32 v19, 0x8000, v19
v_mfma_f32_16x16x32_bf16 v[236:239], a[20:23], a[100:103], v[236:239]
s_xor_b32 m0, s77, 68608
ds_read_b64_tr_b16 a[94:95], v6 offset:41984
v_mfma_f32_16x16x32_bf16 v[236:239], a[16:19], a[96:99], v[236:239]
s_xor_b32 s64, s71, 5341184
v_mfma_f32_16x16x32_bf16 v[228:231], a[8:11], a[96:99], v[228:231]
buffer_load_dwordx4 v15, s[56:59], s64 offen lds
v_mfma_f32_16x16x32_bf16 v[228:231], a[12:15], a[100:103], v[228:231]
v_mfma_f32_16x16x32_bf16 v[220:223], a[4:7], a[100:103], v[220:223]
v_mfma_f32_16x16x32_bf16 v[220:223], a[0:3], a[96:99], v[220:223]
ds_read_b64_tr_b16 a[96:97], v7 offset:32768
v_mfma_f32_16x16x32_bf16 v[152:155], a[104:107], a[0:3], v[152:155]
ds_read_b64_tr_b16 a[98:99], v7 offset:33792
v_mfma_f32_16x16x32_bf16 v[152:155], a[108:111], a[4:7], v[152:155]
ds_read_b64_tr_b16 a[100:101], v7 offset:40960
v_add_u32 v20, 0x8000, v20
v_mfma_f32_16x16x32_bf16 v[160:163], a[108:111], a[12:15], v[160:163]
ds_read_b64_tr_b16 a[102:103], v7 offset:41984
v_mfma_f32_16x16x32_bf16 v[160:163], a[104:107], a[8:11], v[160:163]
v_mfma_f32_16x16x32_bf16 v[168:171], a[104:107], a[16:19], v[168:171]
v_mfma_f32_16x16x32_bf16 v[168:171], a[108:111], a[20:23], v[168:171]
v_mfma_f32_16x16x32_bf16 v[176:179], a[108:111], a[28:31], v[176:179]
s_xor_b32 m0, s84, 0
v_mfma_f32_16x16x32_bf16 v[176:179], a[104:107], a[24:27], v[176:179]
s_xor_b32 s64, s72, 1280
ds_read_b64_tr_b16 a[104:105], v8 offset:32768
v_mfma_f32_16x16x32_bf16 v[180:183], a[112:115], a[24:27], v[180:183]
buffer_load_dwordx4 v12, s[48:51], s64 offen lds
v_mfma_f32_16x16x32_bf16 v[180:183], a[116:119], a[28:31], v[180:183]
ds_read_b64_tr_b16 a[106:107], v8 offset:33792
v_add_u32 v4, 0x8000, v4
v_mfma_f32_16x16x32_bf16 v[172:175], a[116:119], a[20:23], v[172:175]
ds_read_b64_tr_b16 a[108:109], v8 offset:40960
v_mfma_f32_16x16x32_bf16 v[172:175], a[112:115], a[16:19], v[172:175]
s_xor_b32 m0, s84, 1024
ds_read_b64_tr_b16 a[110:111], v8 offset:41984
v_mfma_f32_16x16x32_bf16 v[164:167], a[112:115], a[8:11], v[164:167]
s_xor_b32 s64, s72, 17664
v_mfma_f32_16x16x32_bf16 v[164:167], a[116:119], a[12:15], v[164:167]
buffer_load_dwordx4 v13, s[48:51], s64 offen lds
v_mfma_f32_16x16x32_bf16 v[156:159], a[116:119], a[4:7], v[156:159]
v_mfma_f32_16x16x32_bf16 v[156:159], a[112:115], a[0:3], v[156:159]
ds_read_b64_tr_b16 a[112:113], v9 offset:32768
v_mfma_f32_16x16x32_bf16 v[24:27], a[72:75], a[0:3], v[24:27]
s_xor_b32 m0, s84, 2048
ds_read_b64_tr_b16 a[114:115], v9 offset:33792
v_mfma_f32_16x16x32_bf16 v[24:27], a[76:79], a[4:7], v[24:27]
s_xor_b32 s64, s72, 132352
ds_read_b64_tr_b16 a[116:117], v9 offset:40960
v_add_u32 v5, 0x8000, v5
v_mfma_f32_16x16x32_bf16 v[40:43], a[76:79], a[12:15], v[40:43]
buffer_load_dwordx4 v12, s[48:51], s64 offen lds
v_mfma_f32_16x16x32_bf16 v[40:43], a[72:75], a[8:11], v[40:43]
ds_read_b64_tr_b16 a[118:119], v9 offset:41984
v_mfma_f32_16x16x32_bf16 v[56:59], a[72:75], a[16:19], v[56:59]
v_mfma_f32_16x16x32_bf16 v[56:59], a[76:79], a[20:23], v[56:59]
s_xor_b32 m0, s84, 3072
v_mfma_f32_16x16x32_bf16 v[72:75], a[76:79], a[28:31], v[72:75]
s_waitcnt vmcnt(13)
s_xor_b32 s64, s72, 148736
ds_read_b128 a[32:35], v2 offset:32768
v_mfma_f32_16x16x32_bf16 v[72:75], a[72:75], a[24:27], v[72:75]
s_waitcnt lgkmcnt(5)
buffer_load_dwordx4 v13, s[48:51], s64 offen lds
v_mfma_f32_16x16x32_bf16 v[136:139], a[80:83], a[24:27], v[136:139]
ds_read_b128 a[36:39], v3 offset:32768
v_mfma_f32_16x16x32_bf16 v[136:139], a[84:87], a[28:31], v[136:139]
ds_read_b128 a[40:43], v2 offset:34816
v_add_u32 v6, 0x8000, v6
v_mfma_f32_16x16x32_bf16 v[120:123], a[84:87], a[20:23], v[120:123]
s_xor_b32 m0, s84, 4096
ds_read_b128 a[44:47], v3 offset:34816
v_mfma_f32_16x16x32_bf16 v[120:123], a[80:83], a[16:19], v[120:123]
s_xor_b32 s64, s73, 1280
ds_read_b128 a[48:51], v2 offset:36864
v_mfma_f32_16x16x32_bf16 v[104:107], a[80:83], a[8:11], v[104:107]
buffer_load_dwordx4 v12, s[48:51], s64 offen lds
v_mfma_f32_16x16x32_bf16 v[104:107], a[84:87], a[12:15], v[104:107]
s_add_u32 s65, s79, 29696
ds_read_b128 a[52:55], v3 offset:36864
v_mfma_f32_16x16x32_bf16 v[88:91], a[84:87], a[4:7], v[88:91]
buffer_store_dwordx4 a[220:223], v16, s[44:47], s65 offen sc1
v_mfma_f32_16x16x32_bf16 v[88:91], a[80:83], a[0:3], v[88:91]
s_xor_b32 m0, s84, 5120
ds_read_b128 a[56:59], v2 offset:38912
v_mfma_f32_16x16x32_bf16 v[28:31], a[88:91], a[0:3], v[28:31]
s_xor_b32 s64, s73, 17664
ds_read_b128 a[60:63], v3 offset:38912
v_mfma_f32_16x16x32_bf16 v[28:31], a[92:95], a[4:7], v[28:31]
buffer_load_dwordx4 v13, s[48:51], s64 offen lds
v_mfma_f32_16x16x32_bf16 v[44:47], a[92:95], a[12:15], v[44:47]
ds_read_b64_tr_b16 a[72:73], v10 offset:32768
v_add_u32 v7, 0x8000, v7
v_mfma_f32_16x16x32_bf16 v[44:47], a[88:91], a[8:11], v[44:47]
ds_read_b64_tr_b16 a[74:75], v10 offset:33792
v_mfma_f32_16x16x32_bf16 v[60:63], a[88:91], a[16:19], v[60:63]
s_xor_b32 m0, s84, 6144
ds_read_b64_tr_b16 a[76:77], v10 offset:40960
v_mfma_f32_16x16x32_bf16 v[60:63], a[92:95], a[20:23], v[60:63]
s_xor_b32 s64, s73, 132352
ds_read_b64_tr_b16 a[78:79], v10 offset:41984
v_mfma_f32_16x16x32_bf16 v[76:79], a[92:95], a[28:31], v[76:79]
buffer_load_dwordx4 v12, s[48:51], s64 offen lds
v_mfma_f32_16x16x32_bf16 v[76:79], a[88:91], a[24:27], v[76:79]
ds_read_b64_tr_b16 a[80:81], v11 offset:32768
v_mfma_f32_16x16x32_bf16 v[140:143], a[96:99], a[24:27], v[140:143]
ds_read_b64_tr_b16 a[82:83], v11 offset:33792
v_mfma_f32_16x16x32_bf16 v[140:143], a[100:103], a[28:31], v[140:143]
s_xor_b32 m0, s84, 7168
ds_read_b64_tr_b16 a[84:85], v11 offset:40960
v_add_u32 v8, 0x8000, v8
v_mfma_f32_16x16x32_bf16 v[124:127], a[100:103], a[20:23], v[124:127]
s_xor_b32 s64, s73, 148736
ds_read_b64_tr_b16 a[86:87], v11 offset:41984
v_mfma_f32_16x16x32_bf16 v[124:127], a[96:99], a[16:19], v[124:127]
buffer_load_dwordx4 v13, s[48:51], s64 offen lds
v_mfma_f32_16x16x32_bf16 v[108:111], a[96:99], a[8:11], v[108:111]
v_mfma_f32_16x16x32_bf16 v[108:111], a[100:103], a[12:15], v[108:111]
v_mfma_f32_16x16x32_bf16 v[92:95], a[100:103], a[4:7], v[92:95]
v_add_u32 v9, 0x8000, v9
v_add_u32 v10, 0x8000, v10
v_mfma_f32_16x16x32_bf16 v[92:95], a[96:99], a[0:3], v[92:95]
v_add_u32 v11, 0x8000, v11
v_mfma_f32_16x16x32_bf16 v[32:35], a[104:107], a[0:3], v[32:35]
v_mfma_f32_16x16x32_bf16 v[32:35], a[108:111], a[4:7], v[32:35]
v_mfma_f32_16x16x32_bf16 v[48:51], a[108:111], a[12:15], v[48:51]
s_waitcnt lgkmcnt(0)
s_barrier
v_mfma_f32_16x16x32_bf16 v[48:51], a[104:107], a[8:11], v[48:51]
s_xor_b32 m0, s77, 98304
ds_read_b64_tr_b16 a[88:89], v19 offset:36864
v_mfma_f32_16x16x32_bf16 v[64:67], a[104:107], a[16:19], v[64:67]
s_xor_b32 s64, s71, 5767168
ds_read_b64_tr_b16 a[90:91], v19 offset:37120
v_mfma_f32_16x16x32_bf16 v[64:67], a[108:111], a[20:23], v[64:67]
buffer_load_dwordx4 v14, s[56:59], s64 offen lds
v_mfma_f32_16x16x32_bf16 v[80:83], a[108:111], a[28:31], v[80:83]
ds_read_b64_tr_b16 a[92:93], v19 offset:38912
v_mfma_f32_16x16x32_bf16 v[80:83], a[104:107], a[24:27], v[80:83]
ds_read_b64_tr_b16 a[94:95], v19 offset:39168
v_mfma_f32_16x16x32_bf16 v[144:147], a[112:115], a[24:27], v[144:147]
ds_read_b64_tr_b16 a[96:97], v20 offset:36864
v_mfma_f32_16x16x32_bf16 v[144:147], a[116:119], a[28:31], v[144:147]
ds_read_b64_tr_b16 a[98:99], v20 offset:37120
v_mfma_f32_16x16x32_bf16 v[128:131], a[116:119], a[20:23], v[128:131]
ds_read_b64_tr_b16 a[100:101], v20 offset:38912
v_mfma_f32_16x16x32_bf16 v[128:131], a[112:115], a[16:19], v[128:131]
ds_read_b64_tr_b16 a[102:103], v20 offset:39168
v_mfma_f32_16x16x32_bf16 v[112:115], a[112:115], a[8:11], v[112:115]
s_add_u32 m0, s78, 114688
ds_read_b64_tr_b16 a[104:105], v19 offset:40960
v_mfma_f32_16x16x32_bf16 v[112:115], a[116:119], a[12:15], v[112:115]
s_add_u32 s64, s75, 4325376
ds_read_b64_tr_b16 a[106:107], v19 offset:41216
v_mfma_f32_16x16x32_bf16 v[96:99], a[116:119], a[4:7], v[96:99]
buffer_load_dwordx4 v23, s[60:63], s64 offen lds
v_mfma_f32_16x16x32_bf16 v[96:99], a[112:115], a[0:3], v[96:99]
ds_read_b64_tr_b16 a[108:109], v19 offset:43008
v_mfma_f32_16x16x32_bf16 v[36:39], a[72:75], a[0:3], v[36:39]
ds_read_b64_tr_b16 a[110:111], v19 offset:43264
v_mfma_f32_16x16x32_bf16 v[36:39], a[76:79], a[4:7], v[36:39]
ds_read_b64_tr_b16 a[112:113], v20 offset:40960
v_mfma_f32_16x16x32_bf16 v[52:55], a[76:79], a[12:15], v[52:55]
ds_read_b64_tr_b16 a[114:115], v20 offset:41216
v_mfma_f32_16x16x32_bf16 v[52:55], a[72:75], a[8:11], v[52:55]
ds_read_b64_tr_b16 a[116:117], v20 offset:43008
v_mfma_f32_16x16x32_bf16 v[68:71], a[72:75], a[16:19], v[68:71]
ds_read_b64_tr_b16 a[118:119], v20 offset:43264
v_mfma_f32_16x16x32_bf16 v[68:71], a[76:79], a[20:23], v[68:71]
s_xor_b32 m0, s77, 99328
v_mfma_f32_16x16x32_bf16 v[84:87], a[76:79], a[28:31], v[84:87]
s_xor_b32 s64, s71, 5799936
v_mfma_f32_16x16x32_bf16 v[84:87], a[72:75], a[24:27], v[84:87]
buffer_load_dwordx4 v14, s[56:59], s64 offen lds
v_mfma_f32_16x16x32_bf16 v[148:151], a[80:83], a[24:27], v[148:151]
ds_read_b64_tr_b16 a[72:73], v19 offset:32768
v_mfma_f32_16x16x32_bf16 v[148:151], a[84:87], a[28:31], v[148:151]
ds_read_b64_tr_b16 a[74:75], v19 offset:33024
v_mfma_f32_16x16x32_bf16 v[132:135], a[84:87], a[20:23], v[132:135]
s_add_u32 s65, s79, 13312
ds_read_b64_tr_b16 a[76:77], v19 offset:34816
v_mfma_f32_16x16x32_bf16 v[132:135], a[80:83], a[16:19], v[132:135]
buffer_store_dwordx4 a[224:227], v16, s[44:47], s65 offen sc1
v_mfma_f32_16x16x32_bf16 v[116:119], a[80:83], a[8:11], v[116:119]
ds_read_b64_tr_b16 a[78:79], v19 offset:35072
v_mfma_f32_16x16x32_bf16 v[116:119], a[84:87], a[12:15], v[116:119]
v_mfma_f32_16x16x32_bf16 v[100:103], a[84:87], a[4:7], v[100:103]
s_add_u32 m0, s78, 118784
v_mfma_f32_16x16x32_bf16 v[100:103], a[80:83], a[0:3], v[100:103]
s_waitcnt lgkmcnt(4)
s_add_u32 s64, s75, 4327424
ds_read_b64_tr_b16 a[80:81], v20 offset:32768
v_mfma_f32_16x16x32_bf16 v[184:187], a[88:91], a[32:35], v[184:187]
buffer_load_dwordx4 v23, s[60:63], s64 offen lds
v_mfma_f32_16x16x32_bf16 v[184:187], a[92:95], a[36:39], v[184:187]
ds_read_b64_tr_b16 a[82:83], v20 offset:33024
v_mfma_f32_16x16x32_bf16 v[192:195], a[92:95], a[44:47], v[192:195]
ds_read_b64_tr_b16 a[84:85], v20 offset:34816
v_mfma_f32_16x16x32_bf16 v[192:195], a[88:91], a[40:43], v[192:195]
ds_read_b64_tr_b16 a[86:87], v20 offset:35072
v_mfma_f32_16x16x32_bf16 v[200:203], a[88:91], a[48:51], v[200:203]
v_mfma_f32_16x16x32_bf16 v[200:203], a[92:95], a[52:55], v[200:203]
v_mfma_f32_16x16x32_bf16 v[208:211], a[92:95], a[60:63], v[208:211]
v_mfma_f32_16x16x32_bf16 v[208:211], a[88:91], a[56:59], v[208:211]
ds_read_b64_tr_b16 a[88:89], v4 offset:32768
v_mfma_f32_16x16x32_bf16 v[212:215], a[96:99], a[56:59], v[212:215]
s_xor_b32 m0, s77, 100352
ds_read_b64_tr_b16 a[90:91], v4 offset:33792
v_mfma_f32_16x16x32_bf16 v[212:215], a[100:103], a[60:63], v[212:215]
s_xor_b32 s64, s71, 5832704
ds_read_b64_tr_b16 a[92:93], v4 offset:40960
v_mfma_f32_16x16x32_bf16 v[204:207], a[100:103], a[52:55], v[204:207]
buffer_load_dwordx4 v15, s[56:59], s64 offen lds
v_mfma_f32_16x16x32_bf16 v[204:207], a[96:99], a[48:51], v[204:207]
ds_read_b64_tr_b16 a[94:95], v4 offset:41984
v_mfma_f32_16x16x32_bf16 v[196:199], a[96:99], a[40:43], v[196:199]
v_mfma_f32_16x16x32_bf16 v[196:199], a[100:103], a[44:47], v[196:199]
v_mfma_f32_16x16x32_bf16 v[188:191], a[100:103], a[36:39], v[188:191]
v_mfma_f32_16x16x32_bf16 v[188:191], a[96:99], a[32:35], v[188:191]
ds_read_b64_tr_b16 a[96:97], v5 offset:32768
v_mfma_f32_16x16x32_bf16 v[216:219], a[32:35], a[104:107], v[216:219]
ds_read_b64_tr_b16 a[98:99], v5 offset:33792
v_mfma_f32_16x16x32_bf16 v[216:219], a[36:39], a[108:111], v[216:219]
s_add_u32 m0, s78, 122880
ds_read_b64_tr_b16 a[100:101], v5 offset:40960
v_mfma_f32_16x16x32_bf16 v[224:227], a[44:47], a[108:111], v[224:227]
s_add_u32 s64, s75, 4329472
ds_read_b64_tr_b16 a[102:103], v5 offset:41984
v_mfma_f32_16x16x32_bf16 v[224:227], a[40:43], a[104:107], v[224:227]
buffer_load_dwordx4 v23, s[60:63], s64 offen lds
v_mfma_f32_16x16x32_bf16 v[232:235], a[48:51], a[104:107], v[232:235]
v_mfma_f32_16x16x32_bf16 v[232:235], a[52:55], a[108:111], v[232:235]
v_mfma_f32_16x16x32_bf16 v[240:243], a[60:63], a[108:111], v[240:243]
v_mfma_f32_16x16x32_bf16 v[240:243], a[56:59], a[104:107], v[240:243]
ds_read_b64_tr_b16 a[104:105], v6 offset:32768
v_mfma_f32_16x16x32_bf16 v[244:247], a[56:59], a[112:115], v[244:247]
ds_read_b64_tr_b16 a[106:107], v6 offset:33792
v_mfma_f32_16x16x32_bf16 v[244:247], a[60:63], a[116:119], v[244:247]
ds_read_b64_tr_b16 a[108:109], v6 offset:40960
v_subrev_u32 v19, 0x8000, v19
v_mfma_f32_16x16x32_bf16 v[236:239], a[52:55], a[116:119], v[236:239]
s_xor_b32 m0, s77, 101376
ds_read_b64_tr_b16 a[110:111], v6 offset:41984
v_mfma_f32_16x16x32_bf16 v[236:239], a[48:51], a[112:115], v[236:239]
s_xor_b32 s64, s71, 5865472
v_mfma_f32_16x16x32_bf16 v[228:231], a[40:43], a[112:115], v[228:231]
buffer_load_dwordx4 v15, s[56:59], s64 offen lds
v_mfma_f32_16x16x32_bf16 v[228:231], a[44:47], a[116:119], v[228:231]
v_mfma_f32_16x16x32_bf16 v[220:223], a[36:39], a[116:119], v[220:223]
v_mfma_f32_16x16x32_bf16 v[220:223], a[32:35], a[112:115], v[220:223]
s_waitcnt lgkmcnt(4)
ds_read_b64_tr_b16 a[112:113], v7 offset:32768
v_mfma_f32_16x16x32_bf16 v[152:155], a[72:75], a[32:35], v[152:155]
ds_read_b64_tr_b16 a[114:115], v7 offset:33792
v_mfma_f32_16x16x32_bf16 v[152:155], a[76:79], a[36:39], v[152:155]
ds_read_b64_tr_b16 a[116:117], v7 offset:40960
v_subrev_u32 v20, 0x8000, v20
v_mfma_f32_16x16x32_bf16 v[160:163], a[76:79], a[44:47], v[160:163]
ds_read_b64_tr_b16 a[118:119], v7 offset:41984
v_mfma_f32_16x16x32_bf16 v[160:163], a[72:75], a[40:43], v[160:163]
v_mfma_f32_16x16x32_bf16 v[168:171], a[72:75], a[48:51], v[168:171]
v_mfma_f32_16x16x32_bf16 v[168:171], a[76:79], a[52:55], v[168:171]
v_mfma_f32_16x16x32_bf16 v[176:179], a[76:79], a[60:63], v[176:179]
s_xor_b32 m0, s84, 32768
s_add_u32 s65, s79, 30720
v_mfma_f32_16x16x32_bf16 v[176:179], a[72:75], a[56:59], v[176:179]
s_xor_b32 s64, s72, 1408
buffer_store_dwordx4 a[228:231], v16, s[44:47], s65 offen sc1
v_mfma_f32_16x16x32_bf16 v[180:183], a[80:83], a[56:59], v[180:183]
buffer_load_dwordx4 v12, s[48:51], s64 offen lds
v_mfma_f32_16x16x32_bf16 v[180:183], a[84:87], a[60:63], v[180:183]
ds_read_b64_tr_b16 a[72:73], v8 offset:32768
v_subrev_u32 v4, 0x8000, v4
v_mfma_f32_16x16x32_bf16 v[172:175], a[84:87], a[52:55], v[172:175]
ds_read_b64_tr_b16 a[74:75], v8 offset:33792
v_mfma_f32_16x16x32_bf16 v[172:175], a[80:83], a[48:51], v[172:175]
s_xor_b32 m0, s84, 33792
ds_read_b64_tr_b16 a[76:77], v8 offset:40960
v_mfma_f32_16x16x32_bf16 v[164:167], a[80:83], a[40:43], v[164:167]
s_xor_b32 s64, s72, 17792
ds_read_b64_tr_b16 a[78:79], v8 offset:41984
v_mfma_f32_16x16x32_bf16 v[164:167], a[84:87], a[44:47], v[164:167]
buffer_load_dwordx4 v13, s[48:51], s64 offen lds
v_mfma_f32_16x16x32_bf16 v[156:159], a[84:87], a[36:39], v[156:159]
v_mfma_f32_16x16x32_bf16 v[156:159], a[80:83], a[32:35], v[156:159]
ds_read_b64_tr_b16 a[80:81], v9 offset:32768
v_mfma_f32_16x16x32_bf16 v[24:27], a[88:91], a[32:35], v[24:27]
s_xor_b32 m0, s84, 34816
ds_read_b64_tr_b16 a[82:83], v9 offset:33792
v_mfma_f32_16x16x32_bf16 v[24:27], a[92:95], a[36:39], v[24:27]
s_xor_b32 s64, s72, 132480
ds_read_b64_tr_b16 a[84:85], v9 offset:40960
v_subrev_u32 v5, 0x8000, v5
v_mfma_f32_16x16x32_bf16 v[40:43], a[92:95], a[44:47], v[40:43]
buffer_load_dwordx4 v12, s[48:51], s64 offen lds
v_mfma_f32_16x16x32_bf16 v[40:43], a[88:91], a[40:43], v[40:43]
ds_read_b64_tr_b16 a[86:87], v9 offset:41984
v_mfma_f32_16x16x32_bf16 v[56:59], a[88:91], a[48:51], v[56:59]
v_mfma_f32_16x16x32_bf16 v[56:59], a[92:95], a[52:55], v[56:59]
s_xor_b32 m0, s84, 35840
v_mfma_f32_16x16x32_bf16 v[72:75], a[92:95], a[60:63], v[72:75]
s_waitcnt vmcnt(12)
s_xor_b32 s64, s72, 148864
ds_read_b128 a[0:3], v2 offset:0
v_mfma_f32_16x16x32_bf16 v[72:75], a[88:91], a[56:59], v[72:75]
buffer_load_dwordx4 v13, s[48:51], s64 offen lds
v_mfma_f32_16x16x32_bf16 v[136:139], a[96:99], a[56:59], v[136:139]
ds_read_b128 a[4:7], v3 offset:0
v_mfma_f32_16x16x32_bf16 v[136:139], a[100:103], a[60:63], v[136:139]
ds_read_b128 a[8:11], v2 offset:2048
v_subrev_u32 v6, 0x8000, v6
v_mfma_f32_16x16x32_bf16 v[120:123], a[100:103], a[52:55], v[120:123]
s_xor_b32 m0, s84, 36864
ds_read_b128 a[12:15], v3 offset:2048
v_mfma_f32_16x16x32_bf16 v[120:123], a[96:99], a[48:51], v[120:123]
s_xor_b32 s64, s73, 1408
ds_read_b128 a[16:19], v2 offset:4096
v_mfma_f32_16x16x32_bf16 v[104:107], a[96:99], a[40:43], v[104:107]
buffer_load_dwordx4 v12, s[48:51], s64 offen lds
v_mfma_f32_16x16x32_bf16 v[104:107], a[100:103], a[44:47], v[104:107]
ds_read_b128 a[20:23], v3 offset:4096
v_mfma_f32_16x16x32_bf16 v[88:91], a[100:103], a[36:39], v[88:91]
ds_read_b128 a[24:27], v2 offset:6144
v_mfma_f32_16x16x32_bf16 v[88:91], a[96:99], a[32:35], v[88:91]
s_waitcnt lgkmcnt(7)
s_xor_b32 m0, s84, 37888
ds_read_b128 a[28:31], v3 offset:6144
v_mfma_f32_16x16x32_bf16 v[28:31], a[104:107], a[32:35], v[28:31]
s_xor_b32 s64, s73, 17792
ds_read_b64_tr_b16 a[88:89], v10 offset:32768
v_mfma_f32_16x16x32_bf16 v[28:31], a[108:111], a[36:39], v[28:31]
buffer_load_dwordx4 v13, s[48:51], s64 offen lds
v_mfma_f32_16x16x32_bf16 v[44:47], a[108:111], a[44:47], v[44:47]
ds_read_b64_tr_b16 a[90:91], v10 offset:33792
v_subrev_u32 v7, 0x8000, v7
v_mfma_f32_16x16x32_bf16 v[44:47], a[104:107], a[40:43], v[44:47]
ds_read_b64_tr_b16 a[92:93], v10 offset:40960
v_mfma_f32_16x16x32_bf16 v[60:63], a[104:107], a[48:51], v[60:63]
s_xor_b32 m0, s84, 38912
ds_read_b64_tr_b16 a[94:95], v10 offset:41984
v_mfma_f32_16x16x32_bf16 v[60:63], a[108:111], a[52:55], v[60:63]
s_xor_b32 s64, s73, 132480
ds_read_b64_tr_b16 a[96:97], v11 offset:32768
v_mfma_f32_16x16x32_bf16 v[76:79], a[108:111], a[60:63], v[76:79]
buffer_load_dwordx4 v12, s[48:51], s64 offen lds
v_mfma_f32_16x16x32_bf16 v[76:79], a[104:107], a[56:59], v[76:79]
ds_read_b64_tr_b16 a[98:99], v11 offset:33792
v_mfma_f32_16x16x32_bf16 v[140:143], a[112:115], a[56:59], v[140:143]
s_xor_b32 m0, s84, 39936
ds_read_b64_tr_b16 a[100:101], v11 offset:40960
v_mfma_f32_16x16x32_bf16 v[140:143], a[116:119], a[60:63], v[140:143]
s_xor_b32 s64, s73, 148864
ds_read_b64_tr_b16 a[102:103], v11 offset:41984
v_subrev_u32 v8, 0x8000, v8
v_mfma_f32_16x16x32_bf16 v[124:127], a[116:119], a[52:55], v[124:127]
v_readfirstlane_b32 vcc_lo, v1
s_nop 0
s_cmp_lt_u32 vcc_lo, s81
s_cbranch_scc1 L_spin_1
L_spinbk_2:
v_mfma_f32_16x16x32_bf16 v[124:127], a[112:115], a[48:51], v[124:127]
buffer_load_dwordx4 v13, s[48:51], s64 offen lds
v_mfma_f32_16x16x32_bf16 v[108:111], a[112:115], a[40:43], v[108:111]
v_mfma_f32_16x16x32_bf16 v[108:111], a[116:119], a[44:47], v[108:111]
v_mfma_f32_16x16x32_bf16 v[92:95], a[116:119], a[36:39], v[92:95]
v_subrev_u32 v9, 0x8000, v9
v_subrev_u32 v10, 0x8000, v10
v_mfma_f32_16x16x32_bf16 v[92:95], a[112:115], a[32:35], v[92:95]
v_subrev_u32 v11, 0x8000, v11
v_mfma_f32_16x16x32_bf16 v[32:35], a[72:75], a[32:35], v[32:35]
s_add_u32 s52, s28, 59768832
s_addc_u32 s53, s29, 0
s_mov_b32 s54, 16384
v_mfma_f32_16x16x32_bf16 v[32:35], a[76:79], a[36:39], v[32:35]
v_mfma_f32_16x16x32_bf16 v[48:51], a[76:79], a[44:47], v[48:51]
s_waitcnt lgkmcnt(0)
s_barrier
v_mfma_f32_16x16x32_bf16 v[48:51], a[72:75], a[40:43], v[48:51]
s_xor_b32 m0, s77, 131072
s_add_u32 s65, s79, 31744
ds_read_b64_tr_b16 a[104:105], v19 offset:4096
v_mfma_f32_16x16x32_bf16 v[64:67], a[72:75], a[48:51], v[64:67]
s_xor_b32 s64, s71, 6291456
buffer_store_dwordx4 a[232:235], v16, s[44:47], s65 offen sc1
v_mfma_f32_16x16x32_bf16 v[64:67], a[76:79], a[52:55], v[64:67]
buffer_load_dwordx4 v14, s[56:59], s64 offen lds
v_mfma_f32_16x16x32_bf16 v[80:83], a[76:79], a[60:63], v[80:83]
ds_read_b64_tr_b16 a[106:107], v19 offset:4352
v_mfma_f32_16x16x32_bf16 v[80:83], a[72:75], a[56:59], v[80:83]
ds_read_b64_tr_b16 a[108:109], v19 offset:6144
v_mfma_f32_16x16x32_bf16 v[144:147], a[80:83], a[56:59], v[144:147]
ds_read_b64_tr_b16 a[110:111], v19 offset:6400
v_mfma_f32_16x16x32_bf16 v[144:147], a[84:87], a[60:63], v[144:147]
ds_read_b64_tr_b16 a[112:113], v20 offset:4096
v_mfma_f32_16x16x32_bf16 v[128:131], a[84:87], a[52:55], v[128:131]
ds_read_b64_tr_b16 a[114:115], v20 offset:4352
v_mfma_f32_16x16x32_bf16 v[128:131], a[80:83], a[48:51], v[128:131]
ds_read_b64_tr_b16 a[116:117], v20 offset:6144
v_mfma_f32_16x16x32_bf16 v[112:115], a[80:83], a[40:43], v[112:115]
s_add_u32 m0, s78, 147456
ds_read_b64_tr_b16 a[118:119], v20 offset:6400
v_mfma_f32_16x16x32_bf16 v[112:115], a[84:87], a[44:47], v[112:115]
s_add_u32 s64, s75, 4718592
ds_read_b64_tr_b16 a[72:73], v19 offset:8192
v_mfma_f32_16x16x32_bf16 v[96:99], a[84:87], a[36:39], v[96:99]
buffer_load_dwordx4 v23, s[60:63], s64 offen lds
v_mfma_f32_16x16x32_bf16 v[96:99], a[80:83], a[32:35], v[96:99]
ds_read_b64_tr_b16 a[74:75], v19 offset:8448
v_mfma_f32_16x16x32_bf16 v[36:39], a[88:91], a[32:35], v[36:39]
ds_read_b64_tr_b16 a[76:77], v19 offset:10240
v_mfma_f32_16x16x32_bf16 v[36:39], a[92:95], a[36:39], v[36:39]
ds_read_b64_tr_b16 a[78:79], v19 offset:10496
v_mfma_f32_16x16x32_bf16 v[52:55], a[92:95], a[44:47], v[52:55]
ds_read_b64_tr_b16 a[80:81], v20 offset:8192
v_mfma_f32_16x16x32_bf16 v[52:55], a[88:91], a[40:43], v[52:55]
ds_read_b64_tr_b16 a[82:83], v20 offset:8448
v_mfma_f32_16x16x32_bf16 v[68:71], a[88:91], a[48:51], v[68:71]
ds_read_b64_tr_b16 a[84:85], v20 offset:10240
v_mfma_f32_16x16x32_bf16 v[68:71], a[92:95], a[52:55], v[68:71]
s_xor_b32 m0, s77, 132096
ds_read_b64_tr_b16 a[86:87], v20 offset:10496
v_mfma_f32_16x16x32_bf16 v[84:87], a[92:95], a[60:63], v[84:87]
s_xor_b32 s64, s71, 6324224
v_mfma_f32_16x16x32_bf16 v[84:87], a[88:91], a[56:59], v[84:87]
buffer_load_dwordx4 v14, s[56:59], s64 offen lds
v_mfma_f32_16x16x32_bf16 v[148:151], a[96:99], a[56:59], v[148:151]
ds_read_b64_tr_b16 a[88:89], v19 offset:0
v_mfma_f32_16x16x32_bf16 v[148:151], a[100:103], a[60:63], v[148:151]
ds_read_b64_tr_b16 a[90:91], v19 offset:256
v_mfma_f32_16x16x32_bf16 v[132:135], a[100:103], a[52:55], v[132:135]
ds_read_b64_tr_b16 a[92:93], v19 offset:2048
v_mfma_f32_16x16x32_bf16 v[132:135], a[96:99], a[48:51], v[132:135]
ds_read_b64_tr_b16 a[94:95], v19 offset:2304
v_mfma_f32_16x16x32_bf16 v[116:119], a[96:99], a[40:43], v[116:119]
v_mfma_f32_16x16x32_bf16 v[116:119], a[100:103], a[44:47], v[116:119]
v_mfma_f32_16x16x32_bf16 v[100:103], a[100:103], a[36:39], v[100:103]
s_add_u32 m0, s78, 151552
v_mfma_f32_16x16x32_bf16 v[100:103], a[96:99], a[32:35], v[100:103]
s_waitcnt lgkmcnt(4)
s_add_u32 s64, s75, 4720640
ds_read_b64_tr_b16 a[96:97], v20 offset:0
v_mfma_f32_16x16x32_bf16 v[184:187], a[104:107], a[0:3], v[184:187]
buffer_load_dwordx4 v23, s[60:63], s64 offen lds
v_mfma_f32_16x16x32_bf16 v[184:187], a[108:111], a[4:7], v[184:187]
ds_read_b64_tr_b16 a[98:99], v20 offset:256
v_mfma_f32_16x16x32_bf16 v[192:195], a[108:111], a[12:15], v[192:195]
ds_read_b64_tr_b16 a[100:101], v20 offset:2048
v_mfma_f32_16x16x32_bf16 v[192:195], a[104:107], a[8:11], v[192:195]
ds_read_b64_tr_b16 a[102:103], v20 offset:2304
v_mfma_f32_16x16x32_bf16 v[200:203], a[104:107], a[16:19], v[200:203]
v_mfma_f32_16x16x32_bf16 v[200:203], a[108:111], a[20:23], v[200:203]
v_mfma_f32_16x16x32_bf16 v[208:211], a[108:111], a[28:31], v[208:211]
v_mfma_f32_16x16x32_bf16 v[208:211], a[104:107], a[24:27], v[208:211]
ds_read_b64_tr_b16 a[104:105], v4 offset:0
v_mfma_f32_16x16x32_bf16 v[212:215], a[112:115], a[24:27], v[212:215]
s_xor_b32 m0, s77, 133120
ds_read_b64_tr_b16 a[106:107], v4 offset:1024
v_mfma_f32_16x16x32_bf16 v[212:215], a[116:119], a[28:31], v[212:215]
s_xor_b32 s64, s71, 6356992
ds_read_b64_tr_b16 a[108:109], v4 offset:8192
v_mfma_f32_16x16x32_bf16 v[204:207], a[116:119], a[20:23], v[204:207]
buffer_load_dwordx4 v15, s[56:59], s64 offen lds
v_mfma_f32_16x16x32_bf16 v[204:207], a[112:115], a[16:19], v[204:207]
ds_read_b64_tr_b16 a[110:111], v4 offset:9216
v_mfma_f32_16x16x32_bf16 v[196:199], a[112:115], a[8:11], v[196:199]
v_mfma_f32_16x16x32_bf16 v[196:199], a[116:119], a[12:15], v[196:199]
v_mfma_f32_16x16x32_bf16 v[188:191], a[116:119], a[4:7], v[188:191]
v_mfma_f32_16x16x32_bf16 v[188:191], a[112:115], a[0:3], v[188:191]
ds_read_b64_tr_b16 a[112:113], v5 offset:0
v_mfma_f32_16x16x32_bf16 v[216:219], a[0:3], a[72:75], v[216:219]
s_add_u32 s65, s79, 15360
ds_read_b64_tr_b16 a[114:115], v5 offset:1024
v_mfma_f32_16x16x32_bf16 v[216:219], a[4:7], a[76:79], v[216:219]
s_add_u32 m0, s78, 155648
buffer_store_dwordx4 a[236:239], v16, s[44:47], s65 offen sc1
v_mfma_f32_16x16x32_bf16 v[224:227], a[12:15], a[76:79], v[224:227]
s_add_u32 s64, s75, 4722688
ds_read_b64_tr_b16 a[116:117], v5 offset:8192
v_mfma_f32_16x16x32_bf16 v[224:227], a[8:11], a[72:75], v[224:227]
buffer_load_dwordx4 v23, s[60:63], s64 offen lds
v_mfma_f32_16x16x32_bf16 v[232:235], a[16:19], a[72:75], v[232:235]
s_branch L_po11
L_pg11:
s_branch L_tr1
L_po11:
ds_read_b64_tr_b16 a[118:119], v5 offset:9216
v_mfma_f32_16x16x32_bf16 v[232:235], a[20:23], a[76:79], v[232:235]
v_mfma_f32_16x16x32_bf16 v[240:243], a[28:31], a[76:79], v[240:243]
v_mfma_f32_16x16x32_bf16 v[240:243], a[24:27], a[72:75], v[240:243]
ds_read_b64_tr_b16 a[72:73], v6 offset:0
v_mfma_f32_16x16x32_bf16 v[244:247], a[24:27], a[80:83], v[244:247]
ds_read_b64_tr_b16 a[74:75], v6 offset:1024
v_mfma_f32_16x16x32_bf16 v[244:247], a[28:31], a[84:87], v[244:247]
ds_read_b64_tr_b16 a[76:77], v6 offset:8192
v_mfma_f32_16x16x32_bf16 v[236:239], a[20:23], a[84:87], v[236:239]
s_xor_b32 m0, s77, 134144
ds_read_b64_tr_b16 a[78:79], v6 offset:9216
v_mfma_f32_16x16x32_bf16 v[236:239], a[16:19], a[80:83], v[236:239]
s_xor_b32 s64, s71, 6389760
v_mfma_f32_16x16x32_bf16 v[228:231], a[8:11], a[80:83], v[228:231]
buffer_load_dwordx4 v15, s[56:59], s64 offen lds
v_mfma_f32_16x16x32_bf16 v[228:231], a[12:15], a[84:87], v[228:231]
v_mfma_f32_16x16x32_bf16 v[220:223], a[4:7], a[84:87], v[220:223]
v_mfma_f32_16x16x32_bf16 v[220:223], a[0:3], a[80:83], v[220:223]
s_waitcnt lgkmcnt(4)
ds_read_b64_tr_b16 a[80:81], v7 offset:0
v_mfma_f32_16x16x32_bf16 v[152:155], a[88:91], a[0:3], v[152:155]
ds_read_b64_tr_b16 a[82:83], v7 offset:1024
v_mfma_f32_16x16x32_bf16 v[152:155], a[92:95], a[4:7], v[152:155]
ds_read_b64_tr_b16 a[84:85], v7 offset:8192
v_mfma_f32_16x16x32_bf16 v[160:163], a[92:95], a[12:15], v[160:163]
ds_read_b64_tr_b16 a[86:87], v7 offset:9216
v_mfma_f32_16x16x32_bf16 v[160:163], a[88:91], a[8:11], v[160:163]
v_mfma_f32_16x16x32_bf16 v[168:171], a[88:91], a[16:19], v[168:171]
v_mfma_f32_16x16x32_bf16 v[168:171], a[92:95], a[20:23], v[168:171]
v_mfma_f32_16x16x32_bf16 v[176:179], a[92:95], a[28:31], v[176:179]
s_xor_b32 m0, s84, 0
v_mfma_f32_16x16x32_bf16 v[176:179], a[88:91], a[24:27], v[176:179]
s_xor_b32 s64, s72, 1536
ds_read_b64_tr_b16 a[88:89], v8 offset:0
v_mfma_f32_16x16x32_bf16 v[180:183], a[96:99], a[24:27], v[180:183]
buffer_load_dwordx4 v12, s[48:51], s64 offen lds
v_mfma_f32_16x16x32_bf16 v[180:183], a[100:103], a[28:31], v[180:183]
ds_read_b64_tr_b16 a[90:91], v8 offset:1024
v_mfma_f32_16x16x32_bf16 v[172:175], a[100:103], a[20:23], v[172:175]
ds_read_b64_tr_b16 a[92:93], v8 offset:8192
v_mfma_f32_16x16x32_bf16 v[172:175], a[96:99], a[16:19], v[172:175]
s_xor_b32 m0, s84, 1024
ds_read_b64_tr_b16 a[94:95], v8 offset:9216
v_mfma_f32_16x16x32_bf16 v[164:167], a[96:99], a[8:11], v[164:167]
s_xor_b32 s64, s72, 17920
v_mfma_f32_16x16x32_bf16 v[164:167], a[100:103], a[12:15], v[164:167]
buffer_load_dwordx4 v13, s[48:51], s64 offen lds
v_mfma_f32_16x16x32_bf16 v[156:159], a[100:103], a[4:7], v[156:159]
v_mfma_f32_16x16x32_bf16 v[156:159], a[96:99], a[0:3], v[156:159]
ds_read_b64_tr_b16 a[96:97], v9 offset:0
v_mfma_f32_16x16x32_bf16 v[24:27], a[104:107], a[0:3], v[24:27]
s_xor_b32 m0, s84, 2048
ds_read_b64_tr_b16 a[98:99], v9 offset:1024
v_mfma_f32_16x16x32_bf16 v[24:27], a[108:111], a[4:7], v[24:27]
s_xor_b32 s64, s72, 132608
ds_read_b64_tr_b16 a[100:101], v9 offset:8192
v_mfma_f32_16x16x32_bf16 v[40:43], a[108:111], a[12:15], v[40:43]
buffer_load_dwordx4 v12, s[48:51], s64 offen lds
v_mfma_f32_16x16x32_bf16 v[40:43], a[104:107], a[8:11], v[40:43]
ds_read_b64_tr_b16 a[102:103], v9 offset:9216
v_mfma_f32_16x16x32_bf16 v[56:59], a[104:107], a[16:19], v[56:59]
v_mfma_f32_16x16x32_bf16 v[56:59], a[108:111], a[20:23], v[56:59]
s_xor_b32 m0, s84, 3072
v_mfma_f32_16x16x32_bf16 v[72:75], a[108:111], a[28:31], v[72:75]
s_waitcnt vmcnt(12)
s_xor_b32 s64, s72, 148992
ds_read_b128 a[32:35], v2 offset:32768
v_mfma_f32_16x16x32_bf16 v[72:75], a[104:107], a[24:27], v[72:75]
buffer_load_dwordx4 v13, s[48:51], s64 offen lds
v_mfma_f32_16x16x32_bf16 v[136:139], a[112:115], a[24:27], v[136:139]
ds_read_b128 a[36:39], v3 offset:32768
v_mfma_f32_16x16x32_bf16 v[136:139], a[116:119], a[28:31], v[136:139]
ds_read_b128 a[40:43], v2 offset:34816
v_mfma_f32_16x16x32_bf16 v[120:123], a[116:119], a[20:23], v[120:123]
s_xor_b32 m0, s84, 4096
ds_read_b128 a[44:47], v3 offset:34816
v_mfma_f32_16x16x32_bf16 v[120:123], a[112:115], a[16:19], v[120:123]
s_xor_b32 s64, s73, 1536
ds_read_b128 a[48:51], v2 offset:36864
v_mfma_f32_16x16x32_bf16 v[104:107], a[112:115], a[8:11], v[104:107]
buffer_load_dwordx4 v12, s[48:51], s64 offen lds
v_mfma_f32_16x16x32_bf16 v[104:107], a[116:119], a[12:15], v[104:107]
ds_read_b128 a[52:55], v3 offset:36864
v_mfma_f32_16x16x32_bf16 v[88:91], a[116:119], a[4:7], v[88:91]
buffer_store_dwordx4 a[240:243], v16, s[44:47], s74 offen sc1
v_mfma_f32_16x16x32_bf16 v[88:91], a[112:115], a[0:3], v[88:91]
s_waitcnt lgkmcnt(6)
s_xor_b32 m0, s84, 5120
ds_read_b128 a[56:59], v2 offset:38912
v_mfma_f32_16x16x32_bf16 v[28:31], a[72:75], a[0:3], v[28:31]
s_xor_b32 s64, s73, 17920
ds_read_b128 a[60:63], v3 offset:38912
v_mfma_f32_16x16x32_bf16 v[28:31], a[76:79], a[4:7], v[28:31]
buffer_load_dwordx4 v13, s[48:51], s64 offen lds
v_mfma_f32_16x16x32_bf16 v[44:47], a[76:79], a[12:15], v[44:47]
ds_read_b64_tr_b16 a[104:105], v10 offset:0
v_mfma_f32_16x16x32_bf16 v[44:47], a[72:75], a[8:11], v[44:47]
ds_read_b64_tr_b16 a[106:107], v10 offset:1024
v_mfma_f32_16x16x32_bf16 v[60:63], a[72:75], a[16:19], v[60:63]
s_xor_b32 m0, s84, 6144
ds_read_b64_tr_b16 a[108:109], v10 offset:8192
v_mfma_f32_16x16x32_bf16 v[60:63], a[76:79], a[20:23], v[60:63]
s_xor_b32 s64, s73, 132608
ds_read_b64_tr_b16 a[110:111], v10 offset:9216
v_mfma_f32_16x16x32_bf16 v[76:79], a[76:79], a[28:31], v[76:79]
buffer_load_dwordx4 v12, s[48:51], s64 offen lds
v_mfma_f32_16x16x32_bf16 v[76:79], a[72:75], a[24:27], v[76:79]
ds_read_b64_tr_b16 a[112:113], v11 offset:0
v_mfma_f32_16x16x32_bf16 v[140:143], a[80:83], a[24:27], v[140:143]
ds_read_b64_tr_b16 a[114:115], v11 offset:1024
v_mfma_f32_16x16x32_bf16 v[140:143], a[84:87], a[28:31], v[140:143]
s_xor_b32 m0, s84, 7168
ds_read_b64_tr_b16 a[116:117], v11 offset:8192
v_mfma_f32_16x16x32_bf16 v[124:127], a[84:87], a[20:23], v[124:127]
s_xor_b32 s64, s73, 148992
ds_read_b64_tr_b16 a[118:119], v11 offset:9216
v_mfma_f32_16x16x32_bf16 v[124:127], a[80:83], a[16:19], v[124:127]
buffer_load_dwordx4 v13, s[48:51], s64 offen lds
v_mfma_f32_16x16x32_bf16 v[108:111], a[80:83], a[8:11], v[108:111]
v_mfma_f32_16x16x32_bf16 v[108:111], a[84:87], a[12:15], v[108:111]
v_mfma_f32_16x16x32_bf16 v[92:95], a[84:87], a[4:7], v[92:95]
v_mfma_f32_16x16x32_bf16 v[92:95], a[80:83], a[0:3], v[92:95]
v_mfma_f32_16x16x32_bf16 v[32:35], a[88:91], a[0:3], v[32:35]
v_mfma_f32_16x16x32_bf16 v[32:35], a[92:95], a[4:7], v[32:35]
v_mfma_f32_16x16x32_bf16 v[48:51], a[92:95], a[12:15], v[48:51]
s_waitcnt lgkmcnt(0)
s_barrier
v_mfma_f32_16x16x32_bf16 v[48:51], a[88:91], a[8:11], v[48:51]
s_xor_b32 m0, s77, 65536
ds_read_b64_tr_b16 a[72:73], v19 offset:36864
v_mfma_f32_16x16x32_bf16 v[64:67], a[88:91], a[16:19], v[64:67]
s_xor_b32 s64, s71, 6815744
ds_read_b64_tr_b16 a[74:75], v19 offset:37120
v_mfma_f32_16x16x32_bf16 v[64:67], a[92:95], a[20:23], v[64:67]
buffer_load_dwordx4 v14, s[56:59], s64 offen lds
v_mfma_f32_16x16x32_bf16 v[80:83], a[92:95], a[28:31], v[80:83]
ds_read_b64_tr_b16 a[76:77], v19 offset:38912
v_mfma_f32_16x16x32_bf16 v[80:83], a[88:91], a[24:27], v[80:83]
ds_read_b64_tr_b16 a[78:79], v19 offset:39168
v_mfma_f32_16x16x32_bf16 v[144:147], a[96:99], a[24:27], v[144:147]
ds_read_b64_tr_b16 a[80:81], v20 offset:36864
v_mfma_f32_16x16x32_bf16 v[144:147], a[100:103], a[28:31], v[144:147]
ds_read_b64_tr_b16 a[82:83], v20 offset:37120
v_mfma_f32_16x16x32_bf16 v[128:131], a[100:103], a[20:23], v[128:131]
ds_read_b64_tr_b16 a[84:85], v20 offset:38912
v_mfma_f32_16x16x32_bf16 v[128:131], a[96:99], a[16:19], v[128:131]
ds_read_b64_tr_b16 a[86:87], v20 offset:39168
v_mfma_f32_16x16x32_bf16 v[112:115], a[96:99], a[8:11], v[112:115]
s_add_u32 m0, s78, 81920
ds_read_b64_tr_b16 a[88:89], v19 offset:40960
v_mfma_f32_16x16x32_bf16 v[112:115], a[100:103], a[12:15], v[112:115]
s_add_u32 s64, s75, 5111808
ds_read_b64_tr_b16 a[90:91], v19 offset:41216
v_mfma_f32_16x16x32_bf16 v[96:99], a[100:103], a[4:7], v[96:99]
buffer_load_dwordx4 v23, s[60:63], s64 offen lds
v_mfma_f32_16x16x32_bf16 v[96:99], a[96:99], a[0:3], v[96:99]
ds_read_b64_tr_b16 a[92:93], v19 offset:43008
v_mfma_f32_16x16x32_bf16 v[36:39], a[104:107], a[0:3], v[36:39]
ds_read_b64_tr_b16 a[94:95], v19 offset:43264
v_mfma_f32_16x16x32_bf16 v[36:39], a[108:111], a[4:7], v[36:39]
ds_read_b64_tr_b16 a[96:97], v20 offset:40960
v_mfma_f32_16x16x32_bf16 v[52:55], a[108:111], a[12:15], v[52:55]
ds_read_b64_tr_b16 a[98:99], v20 offset:41216
v_mfma_f32_16x16x32_bf16 v[52:55], a[104:107], a[8:11], v[52:55]
ds_read_b64_tr_b16 a[100:101], v20 offset:43008
v_mfma_f32_16x16x32_bf16 v[68:71], a[104:107], a[16:19], v[68:71]
ds_read_b64_tr_b16 a[102:103], v20 offset:43264
v_mfma_f32_16x16x32_bf16 v[68:71], a[108:111], a[20:23], v[68:71]
s_xor_b32 m0, s77, 66560
v_mfma_f32_16x16x32_bf16 v[84:87], a[108:111], a[28:31], v[84:87]
s_xor_b32 s64, s71, 6848512
v_mfma_f32_16x16x32_bf16 v[84:87], a[104:107], a[24:27], v[84:87]
buffer_load_dwordx4 v14, s[56:59], s64 offen lds
v_mfma_f32_16x16x32_bf16 v[148:151], a[112:115], a[24:27], v[148:151]
ds_read_b64_tr_b16 a[104:105], v19 offset:32768
v_mfma_f32_16x16x32_bf16 v[148:151], a[116:119], a[28:31], v[148:151]
ds_read_b64_tr_b16 a[106:107], v19 offset:33024
v_mfma_f32_16x16x32_bf16 v[132:135], a[116:119], a[20:23], v[132:135]
ds_read_b64_tr_b16 a[108:109], v19 offset:34816
v_mfma_f32_16x16x32_bf16 v[132:135], a[112:115], a[16:19], v[132:135]
ds_read_b64_tr_b16 a[110:111], v19 offset:35072
v_mfma_f32_16x16x32_bf16 v[116:119], a[112:115], a[8:11], v[116:119]
v_mfma_f32_16x16x32_bf16 v[116:119], a[116:119], a[12:15], v[116:119]
v_mfma_f32_16x16x32_bf16 v[100:103], a[116:119], a[4:7], v[100:103]
s_add_u32 m0, s78, 86016
v_mfma_f32_16x16x32_bf16 v[100:103], a[112:115], a[0:3], v[100:103]
s_waitcnt lgkmcnt(4)
s_add_u32 s64, s75, 5113856
ds_read_b64_tr_b16 a[112:113], v20 offset:32768
v_mfma_f32_16x16x32_bf16 v[184:187], a[72:75], a[32:35], v[184:187]
s_lshl_b32 s66, s30, 30
buffer_load_dwordx4 v23, s[60:63], s64 offen lds
v_mfma_f32_16x16x32_bf16 v[184:187], a[76:79], a[36:39], v[184:187]
ds_read_b64_tr_b16 a[114:115], v20 offset:33024
v_lshl_add_u32 v1, v0, 24, s66
v_mfma_f32_16x16x32_bf16 v[192:195], a[76:79], a[44:47], v[192:195]
s_lshl_b32 s70, s31, 8
ds_read_b64_tr_b16 a[116:117], v20 offset:34816
v_mfma_f32_16x16x32_bf16 v[192:195], a[72:75], a[40:43], v[192:195]
ds_read_b64_tr_b16 a[118:119], v20 offset:35072
v_mfma_f32_16x16x32_bf16 v[200:203], a[72:75], a[48:51], v[200:203]
v_mfma_f32_16x16x32_bf16 v[200:203], a[76:79], a[52:55], v[200:203]
v_mfma_f32_16x16x32_bf16 v[208:211], a[76:79], a[60:63], v[208:211]
v_mfma_f32_16x16x32_bf16 v[208:211], a[72:75], a[56:59], v[208:211]
ds_read_b64_tr_b16 a[72:73], v4 offset:32768
v_mfma_f32_16x16x32_bf16 v[212:215], a[80:83], a[56:59], v[212:215]
s_xor_b32 m0, s77, 67584
ds_read_b64_tr_b16 a[74:75], v4 offset:33792
v_mfma_f32_16x16x32_bf16 v[212:215], a[84:87], a[60:63], v[212:215]
s_xor_b32 s64, s71, 6881280
ds_read_b64_tr_b16 a[76:77], v4 offset:40960
v_mfma_f32_16x16x32_bf16 v[204:207], a[84:87], a[52:55], v[204:207]
buffer_load_dwordx4 v15, s[56:59], s64 offen lds
v_mfma_f32_16x16x32_bf16 v[204:207], a[80:83], a[48:51], v[204:207]
ds_read_b64_tr_b16 a[78:79], v4 offset:41984
v_mfma_f32_16x16x32_bf16 v[196:199], a[80:83], a[40:43], v[196:199]
v_mfma_f32_16x16x32_bf16 v[196:199], a[84:87], a[44:47], v[196:199]
v_mfma_f32_16x16x32_bf16 v[188:191], a[84:87], a[36:39], v[188:191]
v_mfma_f32_16x16x32_bf16 v[188:191], a[80:83], a[32:35], v[188:191]
ds_read_b64_tr_b16 a[80:81], v5 offset:32768
v_mfma_f32_16x16x32_bf16 v[216:219], a[32:35], a[88:91], v[216:219]
ds_read_b64_tr_b16 a[82:83], v5 offset:33792
v_mfma_f32_16x16x32_bf16 v[216:219], a[36:39], a[92:95], v[216:219]
s_add_u32 m0, s78, 90112
ds_read_b64_tr_b16 a[84:85], v5 offset:40960
v_mfma_f32_16x16x32_bf16 v[224:227], a[44:47], a[92:95], v[224:227]
s_add_u32 s64, s75, 5115904
ds_read_b64_tr_b16 a[86:87], v5 offset:41984
v_mfma_f32_16x16x32_bf16 v[224:227], a[40:43], a[88:91], v[224:227]
buffer_load_dwordx4 v23, s[60:63], s64 offen lds
v_mfma_f32_16x16x32_bf16 v[232:235], a[48:51], a[88:91], v[232:235]
v_mfma_f32_16x16x32_bf16 v[232:235], a[52:55], a[92:95], v[232:235]
v_mfma_f32_16x16x32_bf16 v[240:243], a[60:63], a[92:95], v[240:243]
v_mfma_f32_16x16x32_bf16 v[240:243], a[56:59], a[88:91], v[240:243]
ds_read_b64_tr_b16 a[88:89], v6 offset:32768
v_mfma_f32_16x16x32_bf16 v[244:247], a[56:59], a[96:99], v[244:247]
ds_read_b64_tr_b16 a[90:91], v6 offset:33792
v_mfma_f32_16x16x32_bf16 v[244:247], a[60:63], a[100:103], v[244:247]
ds_read_b64_tr_b16 a[92:93], v6 offset:40960
v_add_u32 v19, 0x8000, v19
v_mfma_f32_16x16x32_bf16 v[236:239], a[52:55], a[100:103], v[236:239]
s_xor_b32 m0, s77, 68608
ds_read_b64_tr_b16 a[94:95], v6 offset:41984
v_mfma_f32_16x16x32_bf16 v[236:239], a[48:51], a[96:99], v[236:239]
s_xor_b32 s64, s71, 6914048
v_mfma_f32_16x16x32_bf16 v[228:231], a[40:43], a[96:99], v[228:231]
buffer_load_dwordx4 v15, s[56:59], s64 offen lds
v_mfma_f32_16x16x32_bf16 v[228:231], a[44:47], a[100:103], v[228:231]
v_mfma_f32_16x16x32_bf16 v[220:223], a[36:39], a[100:103], v[220:223]
v_mfma_f32_16x16x32_bf16 v[220:223], a[32:35], a[96:99], v[220:223]
s_waitcnt lgkmcnt(4)
ds_read_b64_tr_b16 a[96:97], v7 offset:32768
v_mfma_f32_16x16x32_bf16 v[152:155], a[104:107], a[32:35], v[152:155]
ds_read_b64_tr_b16 a[98:99], v7 offset:33792
v_mfma_f32_16x16x32_bf16 v[152:155], a[108:111], a[36:39], v[152:155]
ds_read_b64_tr_b16 a[100:101], v7 offset:40960
v_add_u32 v20, 0x8000, v20
v_mfma_f32_16x16x32_bf16 v[160:163], a[108:111], a[44:47], v[160:163]
ds_read_b64_tr_b16 a[102:103], v7 offset:41984
v_mfma_f32_16x16x32_bf16 v[160:163], a[104:107], a[40:43], v[160:163]
v_mfma_f32_16x16x32_bf16 v[168:171], a[104:107], a[48:51], v[168:171]
v_mfma_f32_16x16x32_bf16 v[168:171], a[108:111], a[52:55], v[168:171]
v_mfma_f32_16x16x32_bf16 v[176:179], a[108:111], a[60:63], v[176:179]
s_xor_b32 m0, s84, 32768
v_mfma_f32_16x16x32_bf16 v[176:179], a[104:107], a[56:59], v[176:179]
s_xor_b32 s64, s72, 1664
ds_read_b64_tr_b16 a[104:105], v8 offset:32768
v_mfma_f32_16x16x32_bf16 v[180:183], a[112:115], a[56:59], v[180:183]
buffer_load_dwordx4 v12, s[48:51], s64 offen lds
v_mfma_f32_16x16x32_bf16 v[180:183], a[116:119], a[60:63], v[180:183]
ds_read_b64_tr_b16 a[106:107], v8 offset:33792
v_add_u32 v4, 0x8000, v4
v_mfma_f32_16x16x32_bf16 v[172:175], a[116:119], a[52:55], v[172:175]
ds_read_b64_tr_b16 a[108:109], v8 offset:40960
v_mfma_f32_16x16x32_bf16 v[172:175], a[112:115], a[48:51], v[172:175]
s_xor_b32 m0, s84, 33792
ds_read_b64_tr_b16 a[110:111], v8 offset:41984
v_mfma_f32_16x16x32_bf16 v[164:167], a[112:115], a[40:43], v[164:167]
s_xor_b32 s64, s72, 18048
v_mfma_f32_16x16x32_bf16 v[164:167], a[116:119], a[44:47], v[164:167]
buffer_load_dwordx4 v13, s[48:51], s64 offen lds
v_mfma_f32_16x16x32_bf16 v[156:159], a[116:119], a[36:39], v[156:159]
v_mfma_f32_16x16x32_bf16 v[156:159], a[112:115], a[32:35], v[156:159]
ds_read_b64_tr_b16 a[112:113], v9 offset:32768
v_mfma_f32_16x16x32_bf16 v[24:27], a[72:75], a[32:35], v[24:27]
s_xor_b32 m0, s84, 34816
ds_read_b64_tr_b16 a[114:115], v9 offset:33792
v_mfma_f32_16x16x32_bf16 v[24:27], a[76:79], a[36:39], v[24:27]
s_xor_b32 s64, s72, 132736
ds_read_b64_tr_b16 a[116:117], v9 offset:40960
v_add_u32 v5, 0x8000, v5
v_mfma_f32_16x16x32_bf16 v[40:43], a[76:79], a[44:47], v[40:43]
buffer_load_dwordx4 v12, s[48:51], s64 offen lds
v_mfma_f32_16x16x32_bf16 v[40:43], a[72:75], a[40:43], v[40:43]
ds_read_b64_tr_b16 a[118:119], v9 offset:41984
v_mfma_f32_16x16x32_bf16 v[56:59], a[72:75], a[48:51], v[56:59]
v_mfma_f32_16x16x32_bf16 v[56:59], a[76:79], a[52:55], v[56:59]
s_xor_b32 m0, s84, 35840
v_mfma_f32_16x16x32_bf16 v[72:75], a[76:79], a[60:63], v[72:75]
s_waitcnt vmcnt(10)
s_xor_b32 s64, s72, 149120
ds_read_b128 a[0:3], v2 offset:0
v_mfma_f32_16x16x32_bf16 v[72:75], a[72:75], a[56:59], v[72:75]
buffer_load_dwordx4 v13, s[48:51], s64 offen lds
v_mfma_f32_16x16x32_bf16 v[136:139], a[80:83], a[56:59], v[136:139]
ds_read_b128 a[4:7], v3 offset:0
v_mfma_f32_16x16x32_bf16 v[136:139], a[84:87], a[60:63], v[136:139]
ds_read_b128 a[8:11], v2 offset:2048
v_add_u32 v6, 0x8000, v6
v_mfma_f32_16x16x32_bf16 v[120:123], a[84:87], a[52:55], v[120:123]
s_xor_b32 m0, s84, 36864
ds_read_b128 a[12:15], v3 offset:2048
v_mfma_f32_16x16x32_bf16 v[120:123], a[80:83], a[48:51], v[120:123]
s_xor_b32 s64, s73, 1664
ds_read_b128 a[16:19], v2 offset:4096
v_mfma_f32_16x16x32_bf16 v[104:107], a[80:83], a[40:43], v[104:107]
buffer_load_dwordx4 v12, s[48:51], s64 offen lds
v_mfma_f32_16x16x32_bf16 v[104:107], a[84:87], a[44:47], v[104:107]
ds_read_b128 a[20:23], v3 offset:4096
v_mfma_f32_16x16x32_bf16 v[88:91], a[84:87], a[36:39], v[88:91]
ds_read_b128 a[24:27], v2 offset:6144
v_mfma_f32_16x16x32_bf16 v[88:91], a[80:83], a[32:35], v[88:91]
s_waitcnt lgkmcnt(7)
s_xor_b32 m0, s84, 37888
ds_read_b128 a[28:31], v3 offset:6144
v_mfma_f32_16x16x32_bf16 v[28:31], a[88:91], a[32:35], v[28:31]
s_xor_b32 s64, s73, 18048
ds_read_b64_tr_b16 a[72:73], v10 offset:32768
v_mfma_f32_16x16x32_bf16 v[28:31], a[92:95], a[36:39], v[28:31]
buffer_load_dwordx4 v13, s[48:51], s64 offen lds
v_mfma_f32_16x16x32_bf16 v[44:47], a[92:95], a[44:47], v[44:47]
ds_read_b64_tr_b16 a[74:75], v10 offset:33792
v_add_u32 v7, 0x8000, v7
v_mfma_f32_16x16x32_bf16 v[44:47], a[88:91], a[40:43], v[44:47]
ds_read_b64_tr_b16 a[76:77], v10 offset:40960
v_mfma_f32_16x16x32_bf16 v[60:63], a[88:91], a[48:51], v[60:63]
s_xor_b32 m0, s84, 38912
ds_read_b64_tr_b16 a[78:79], v10 offset:41984
v_mfma_f32_16x16x32_bf16 v[60:63], a[92:95], a[52:55], v[60:63]
s_xor_b32 s64, s73, 132736
ds_read_b64_tr_b16 a[80:81], v11 offset:32768
v_mfma_f32_16x16x32_bf16 v[76:79], a[92:95], a[60:63], v[76:79]
buffer_load_dwordx4 v12, s[48:51], s64 offen lds
v_mfma_f32_16x16x32_bf16 v[76:79], a[88:91], a[56:59], v[76:79]
ds_read_b64_tr_b16 a[82:83], v11 offset:33792
v_mfma_f32_16x16x32_bf16 v[140:143], a[96:99], a[56:59], v[140:143]
ds_read_b64_tr_b16 a[84:85], v11 offset:40960
v_mfma_f32_16x16x32_bf16 v[140:143], a[100:103], a[60:63], v[140:143]
s_xor_b32 m0, s84, 39936
ds_read_b64_tr_b16 a[86:87], v11 offset:41984
v_add_u32 v8, 0x8000, v8
v_mfma_f32_16x16x32_bf16 v[124:127], a[100:103], a[52:55], v[124:127]
s_xor_b32 s64, s73, 149120
v_mfma_f32_16x16x32_bf16 v[124:127], a[96:99], a[48:51], v[124:127]
buffer_load_dwordx4 v13, s[48:51], s64 offen lds
v_mfma_f32_16x16x32_bf16 v[108:111], a[96:99], a[40:43], v[108:111]
v_mfma_f32_16x16x32_bf16 v[108:111], a[100:103], a[44:47], v[108:111]
v_mfma_f32_16x16x32_bf16 v[92:95], a[100:103], a[36:39], v[92:95]
v_add_u32 v9, 0x8000, v9
v_add_u32 v10, 0x8000, v10
v_mfma_f32_16x16x32_bf16 v[92:95], a[96:99], a[32:35], v[92:95]
v_add_u32 v11, 0x8000, v11
v_mfma_f32_16x16x32_bf16 v[32:35], a[104:107], a[32:35], v[32:35]
v_mfma_f32_16x16x32_bf16 v[32:35], a[108:111], a[36:39], v[32:35]
v_mfma_f32_16x16x32_bf16 v[48:51], a[108:111], a[44:47], v[48:51]
s_waitcnt lgkmcnt(0)
s_barrier
v_mfma_f32_16x16x32_bf16 v[48:51], a[104:107], a[40:43], v[48:51]
s_mov_b64 exec, 1
buffer_atomic_add a251, v1, s[52:55], s70 offen offset:0 sc1
s_mov_b64 exec, -1
s_xor_b32 m0, s77, 98304
v_mfma_f32_16x16x32_bf16 v[64:67], a[104:107], a[48:51], v[64:67]
s_lshl4_add_u32 s70, s78, s70
s_xor_b32 s64, s71, 7340032
ds_read_b64_tr_b16 a[88:89], v19 offset:36864
v_mfma_f32_16x16x32_bf16 v[64:67], a[108:111], a[52:55], v[64:67]
s_lshr_b32 s81, s81, 5
buffer_load_dwordx4 v14, s[56:59], s64 offen lds
v_mfma_f32_16x16x32_bf16 v[80:83], a[108:111], a[60:63], v[80:83]
ds_read_b64_tr_b16 a[90:91], v19 offset:37120
v_mfma_f32_16x16x32_bf16 v[80:83], a[104:107], a[56:59], v[80:83]
ds_read_b64_tr_b16 a[92:93], v19 offset:38912
v_mfma_f32_16x16x32_bf16 v[144:147], a[112:115], a[56:59], v[144:147]
ds_read_b64_tr_b16 a[94:95], v19 offset:39168
v_mfma_f32_16x16x32_bf16 v[144:147], a[116:119], a[60:63], v[144:147]
ds_read_b64_tr_b16 a[96:97], v20 offset:36864
v_mfma_f32_16x16x32_bf16 v[128:131], a[116:119], a[52:55], v[128:131]
ds_read_b64_tr_b16 a[98:99], v20 offset:37120
v_mfma_f32_16x16x32_bf16 v[128:131], a[112:115], a[48:51], v[128:131]
ds_read_b64_tr_b16 a[100:101], v20 offset:38912
v_mfma_f32_16x16x32_bf16 v[112:115], a[112:115], a[40:43], v[112:115]
s_add_u32 m0, s78, 114688
ds_read_b64_tr_b16 a[102:103], v20 offset:39168
v_mfma_f32_16x16x32_bf16 v[112:115], a[116:119], a[44:47], v[112:115]
s_add_u32 s64, s75, 5505024
ds_read_b64_tr_b16 a[104:105], v19 offset:40960
v_mfma_f32_16x16x32_bf16 v[96:99], a[116:119], a[36:39], v[96:99]
buffer_load_dwordx4 v23, s[60:63], s64 offen lds
v_mfma_f32_16x16x32_bf16 v[96:99], a[112:115], a[32:35], v[96:99]
ds_read_b64_tr_b16 a[106:107], v19 offset:41216
v_mfma_f32_16x16x32_bf16 v[36:39], a[72:75], a[32:35], v[36:39]
ds_read_b64_tr_b16 a[108:109], v19 offset:43008
v_mfma_f32_16x16x32_bf16 v[36:39], a[76:79], a[36:39], v[36:39]
ds_read_b64_tr_b16 a[110:111], v19 offset:43264
v_mfma_f32_16x16x32_bf16 v[52:55], a[76:79], a[44:47], v[52:55]
ds_read_b64_tr_b16 a[112:113], v20 offset:40960
v_mfma_f32_16x16x32_bf16 v[52:55], a[72:75], a[40:43], v[52:55]
ds_read_b64_tr_b16 a[114:115], v20 offset:41216
v_mfma_f32_16x16x32_bf16 v[68:71], a[72:75], a[48:51], v[68:71]
ds_read_b64_tr_b16 a[116:117], v20 offset:43008
v_mfma_f32_16x16x32_bf16 v[68:71], a[76:79], a[52:55], v[68:71]
s_xor_b32 m0, s77, 99328
ds_read_b64_tr_b16 a[118:119], v20 offset:43264
v_mfma_f32_16x16x32_bf16 v[84:87], a[76:79], a[60:63], v[84:87]
s_xor_b32 s64, s71, 7372800
v_mfma_f32_16x16x32_bf16 v[84:87], a[72:75], a[56:59], v[84:87]
buffer_load_dwordx4 v14, s[56:59], s64 offen lds
v_mfma_f32_16x16x32_bf16 v[148:151], a[80:83], a[56:59], v[148:151]
ds_read_b64_tr_b16 a[72:73], v19 offset:32768
v_mfma_f32_16x16x32_bf16 v[148:151], a[84:87], a[60:63], v[148:151]
ds_read_b64_tr_b16 a[74:75], v19 offset:33024
v_mfma_f32_16x16x32_bf16 v[132:135], a[84:87], a[52:55], v[132:135]
ds_read_b64_tr_b16 a[76:77], v19 offset:34816
v_mfma_f32_16x16x32_bf16 v[132:135], a[80:83], a[48:51], v[132:135]
ds_read_b64_tr_b16 a[78:79], v19 offset:35072
v_mfma_f32_16x16x32_bf16 v[116:119], a[80:83], a[40:43], v[116:119]
v_mfma_f32_16x16x32_bf16 v[116:119], a[84:87], a[44:47], v[116:119]
v_mfma_f32_16x16x32_bf16 v[100:103], a[84:87], a[36:39], v[100:103]
s_add_u32 m0, s78, 118784
v_mfma_f32_16x16x32_bf16 v[100:103], a[80:83], a[32:35], v[100:103]
s_waitcnt lgkmcnt(4)
s_add_u32 s64, s75, 5507072
ds_read_b64_tr_b16 a[80:81], v20 offset:32768
v_mfma_f32_16x16x32_bf16 v[184:187], a[88:91], a[0:3], v[184:187]
buffer_load_dwordx4 v23, s[60:63], s64 offen lds
v_mfma_f32_16x16x32_bf16 v[184:187], a[92:95], a[4:7], v[184:187]
ds_read_b64_tr_b16 a[82:83], v20 offset:33024
v_mfma_f32_16x16x32_bf16 v[192:195], a[92:95], a[12:15], v[192:195]
ds_read_b64_tr_b16 a[84:85], v20 offset:34816
v_mfma_f32_16x16x32_bf16 v[192:195], a[88:91], a[8:11], v[192:195]
ds_read_b64_tr_b16 a[86:87], v20 offset:35072
v_mfma_f32_16x16x32_bf16 v[200:203], a[88:91], a[16:19], v[200:203]
v_mfma_f32_16x16x32_bf16 v[200:203], a[92:95], a[20:23], v[200:203]
v_mfma_f32_16x16x32_bf16 v[208:211], a[92:95], a[28:31], v[208:211]
v_mfma_f32_16x16x32_bf16 v[208:211], a[88:91], a[24:27], v[208:211]
ds_read_b64_tr_b16 a[88:89], v4 offset:32768
v_mfma_f32_16x16x32_bf16 v[212:215], a[96:99], a[24:27], v[212:215]
s_xor_b32 m0, s77, 100352
ds_read_b64_tr_b16 a[90:91], v4 offset:33792
v_mfma_f32_16x16x32_bf16 v[212:215], a[100:103], a[28:31], v[212:215]
s_xor_b32 s64, s71, 7405568
ds_read_b64_tr_b16 a[92:93], v4 offset:40960
v_mfma_f32_16x16x32_bf16 v[204:207], a[100:103], a[20:23], v[204:207]
buffer_load_dwordx4 v15, s[56:59], s64 offen lds
v_mfma_f32_16x16x32_bf16 v[204:207], a[96:99], a[16:19], v[204:207]
ds_read_b64_tr_b16 a[94:95], v4 offset:41984
v_mfma_f32_16x16x32_bf16 v[196:199], a[96:99], a[8:11], v[196:199]
v_mfma_f32_16x16x32_bf16 v[196:199], a[100:103], a[12:15], v[196:199]
v_mfma_f32_16x16x32_bf16 v[188:191], a[100:103], a[4:7], v[188:191]
v_mfma_f32_16x16x32_bf16 v[188:191], a[96:99], a[0:3], v[188:191]
ds_read_b64_tr_b16 a[96:97], v5 offset:32768
v_mfma_f32_16x16x32_bf16 v[216:219], a[0:3], a[104:107], v[216:219]
ds_read_b64_tr_b16 a[98:99], v5 offset:33792
v_mfma_f32_16x16x32_bf16 v[216:219], a[4:7], a[108:111], v[216:219]
s_add_u32 m0, s78, 122880
ds_read_b64_tr_b16 a[100:101], v5 offset:40960
v_mfma_f32_16x16x32_bf16 v[224:227], a[12:15], a[108:111], v[224:227]
s_add_u32 s64, s75, 5509120
ds_read_b64_tr_b16 a[102:103], v5 offset:41984
v_mfma_f32_16x16x32_bf16 v[224:227], a[8:11], a[104:107], v[224:227]
buffer_load_dwordx4 v23, s[60:63], s64 offen lds
v_mfma_f32_16x16x32_bf16 v[232:235], a[16:19], a[104:107], v[232:235]
v_mfma_f32_16x16x32_bf16 v[232:235], a[20:23], a[108:111], v[232:235]
v_mfma_f32_16x16x32_bf16 v[240:243], a[28:31], a[108:111], v[240:243]
v_mfma_f32_16x16x32_bf16 v[240:243], a[24:27], a[104:107], v[240:243]
ds_read_b64_tr_b16 a[104:105], v6 offset:32768
v_mfma_f32_16x16x32_bf16 v[244:247], a[24:27], a[112:115], v[244:247]
ds_read_b64_tr_b16 a[106:107], v6 offset:33792
v_mfma_f32_16x16x32_bf16 v[244:247], a[28:31], a[116:119], v[244:247]
ds_read_b64_tr_b16 a[108:109], v6 offset:40960
v_subrev_u32 v19, 0x8000, v19
v_mfma_f32_16x16x32_bf16 v[236:239], a[20:23], a[116:119], v[236:239]
s_xor_b32 m0, s77, 101376
ds_read_b64_tr_b16 a[110:111], v6 offset:41984
v_mfma_f32_16x16x32_bf16 v[236:239], a[16:19], a[112:115], v[236:239]
s_xor_b32 s64, s71, 7438336
v_mfma_f32_16x16x32_bf16 v[228:231], a[8:11], a[112:115], v[228:231]
buffer_load_dwordx4 v15, s[56:59], s64 offen lds
v_mfma_f32_16x16x32_bf16 v[228:231], a[12:15], a[116:119], v[228:231]
v_mfma_f32_16x16x32_bf16 v[220:223], a[4:7], a[116:119], v[220:223]
v_mfma_f32_16x16x32_bf16 v[220:223], a[0:3], a[112:115], v[220:223]
s_waitcnt lgkmcnt(4)
ds_read_b64_tr_b16 a[112:113], v7 offset:32768
v_mfma_f32_16x16x32_bf16 v[152:155], a[72:75], a[0:3], v[152:155]
ds_read_b64_tr_b16 a[114:115], v7 offset:33792
v_mfma_f32_16x16x32_bf16 v[152:155], a[76:79], a[4:7], v[152:155]
ds_read_b64_tr_b16 a[116:117], v7 offset:40960
v_subrev_u32 v20, 0x8000, v20
v_mfma_f32_16x16x32_bf16 v[160:163], a[76:79], a[12:15], v[160:163]
ds_read_b64_tr_b16 a[118:119], v7 offset:41984
v_mfma_f32_16x16x32_bf16 v[160:163], a[72:75], a[8:11], v[160:163]
v_mfma_f32_16x16x32_bf16 v[168:171], a[72:75], a[16:19], v[168:171]
v_mfma_f32_16x16x32_bf16 v[168:171], a[76:79], a[20:23], v[168:171]
v_mfma_f32_16x16x32_bf16 v[176:179], a[76:79], a[28:31], v[176:179]
s_xor_b32 m0, s84, 0
v_mfma_f32_16x16x32_bf16 v[176:179], a[72:75], a[24:27], v[176:179]
s_xor_b32 s64, s72, 1792
ds_read_b64_tr_b16 a[72:73], v8 offset:32768
v_mfma_f32_16x16x32_bf16 v[180:183], a[80:83], a[24:27], v[180:183]
buffer_load_dwordx4 v12, s[48:51], s64 offen lds
v_mfma_f32_16x16x32_bf16 v[180:183], a[84:87], a[28:31], v[180:183]
ds_read_b64_tr_b16 a[74:75], v8 offset:33792
v_subrev_u32 v4, 0x8000, v4
v_mfma_f32_16x16x32_bf16 v[172:175], a[84:87], a[20:23], v[172:175]
ds_read_b64_tr_b16 a[76:77], v8 offset:40960
v_mfma_f32_16x16x32_bf16 v[172:175], a[80:83], a[16:19], v[172:175]
s_xor_b32 m0, s84, 1024
ds_read_b64_tr_b16 a[78:79], v8 offset:41984
v_mfma_f32_16x16x32_bf16 v[164:167], a[80:83], a[8:11], v[164:167]
s_xor_b32 s64, s72, 18176
v_mfma_f32_16x16x32_bf16 v[164:167], a[84:87], a[12:15], v[164:167]
s_branch L_po12
L_pg12:
s_branch L_tr1
L_po12:
buffer_load_dwordx4 v13, s[48:51], s64 offen lds
v_mfma_f32_16x16x32_bf16 v[156:159], a[84:87], a[4:7], v[156:159]
v_mfma_f32_16x16x32_bf16 v[156:159], a[80:83], a[0:3], v[156:159]
ds_read_b64_tr_b16 a[80:81], v9 offset:32768
v_mfma_f32_16x16x32_bf16 v[24:27], a[88:91], a[0:3], v[24:27]
s_xor_b32 m0, s84, 2048
ds_read_b64_tr_b16 a[82:83], v9 offset:33792
v_mfma_f32_16x16x32_bf16 v[24:27], a[92:95], a[4:7], v[24:27]
s_xor_b32 s64, s72, 132864
ds_read_b64_tr_b16 a[84:85], v9 offset:40960
v_subrev_u32 v5, 0x8000, v5
v_mfma_f32_16x16x32_bf16 v[40:43], a[92:95], a[12:15], v[40:43]
buffer_load_dwordx4 v12, s[48:51], s64 offen lds
v_mfma_f32_16x16x32_bf16 v[40:43], a[88:91], a[8:11], v[40:43]
ds_read_b64_tr_b16 a[86:87], v9 offset:41984
v_mfma_f32_16x16x32_bf16 v[56:59], a[88:91], a[16:19], v[56:59]
v_mfma_f32_16x16x32_bf16 v[56:59], a[92:95], a[20:23], v[56:59]
s_xor_b32 m0, s84, 3072
v_mfma_f32_16x16x32_bf16 v[72:75], a[92:95], a[28:31], v[72:75]
s_waitcnt vmcnt(11)
s_xor_b32 s64, s72, 149248
ds_read_b128 a[32:35], v2 offset:32768
v_mfma_f32_16x16x32_bf16 v[72:75], a[88:91], a[24:27], v[72:75]
buffer_load_dwordx4 v13, s[48:51], s64 offen lds
v_mfma_f32_16x16x32_bf16 v[136:139], a[96:99], a[24:27], v[136:139]
ds_read_b128 a[36:39], v3 offset:32768
v_mfma_f32_16x16x32_bf16 v[136:139], a[100:103], a[28:31], v[136:139]
ds_read_b128 a[40:43], v2 offset:34816
v_subrev_u32 v6, 0x8000, v6
v_mfma_f32_16x16x32_bf16 v[120:123], a[100:103], a[20:23], v[120:123]
s_xor_b32 m0, s84, 4096
ds_read_b128 a[44:47], v3 offset:34816
v_mfma_f32_16x16x32_bf16 v[120:123], a[96:99], a[16:19], v[120:123]
s_xor_b32 s64, s73, 1792
ds_read_b128 a[48:51], v2 offset:36864
v_mfma_f32_16x16x32_bf16 v[104:107], a[96:99], a[8:11], v[104:107]
buffer_load_dwordx4 v12, s[48:51], s64 offen lds
v_mfma_f32_16x16x32_bf16 v[104:107], a[100:103], a[12:15], v[104:107]
ds_read_b128 a[52:55], v3 offset:36864
v_mfma_f32_16x16x32_bf16 v[88:91], a[100:103], a[4:7], v[88:91]
ds_read_b128 a[56:59], v2 offset:38912
v_mfma_f32_16x16x32_bf16 v[88:91], a[96:99], a[0:3], v[88:91]
s_waitcnt lgkmcnt(7)
s_xor_b32 m0, s84, 5120
ds_read_b128 a[60:63], v3 offset:38912
v_mfma_f32_16x16x32_bf16 v[28:31], a[104:107], a[0:3], v[28:31]
s_xor_b32 s64, s73, 18176
ds_read_b64_tr_b16 a[88:89], v10 offset:32768
v_mfma_f32_16x16x32_bf16 v[28:31], a[108:111], a[4:7], v[28:31]
buffer_load_dwordx4 v13, s[48:51], s64 offen lds
v_mfma_f32_16x16x32_bf16 v[44:47], a[108:111], a[12:15], v[44:47]
ds_read_b64_tr_b16 a[90:91], v10 offset:33792
v_subrev_u32 v7, 0x8000, v7
v_mfma_f32_16x16x32_bf16 v[44:47], a[104:107], a[8:11], v[44:47]
ds_read_b64_tr_b16 a[92:93], v10 offset:40960
v_mfma_f32_16x16x32_bf16 v[60:63], a[104:107], a[16:19], v[60:63]
s_xor_b32 m0, s84, 6144
ds_read_b64_tr_b16 a[94:95], v10 offset:41984
v_mfma_f32_16x16x32_bf16 v[60:63], a[108:111], a[20:23], v[60:63]
s_xor_b32 s64, s73, 132864
ds_read_b64_tr_b16 a[96:97], v11 offset:32768
v_mfma_f32_16x16x32_bf16 v[76:79], a[108:111], a[28:31], v[76:79]
buffer_load_dwordx4 v12, s[48:51], s64 offen lds
v_mfma_f32_16x16x32_bf16 v[76:79], a[104:107], a[24:27], v[76:79]
ds_read_b64_tr_b16 a[98:99], v11 offset:33792
v_mfma_f32_16x16x32_bf16 v[140:143], a[112:115], a[24:27], v[140:143]
ds_read_b64_tr_b16 a[100:101], v11 offset:40960
v_mfma_f32_16x16x32_bf16 v[140:143], a[116:119], a[28:31], v[140:143]
s_xor_b32 m0, s84, 7168
ds_read_b64_tr_b16 a[102:103], v11 offset:41984
v_subrev_u32 v8, 0x8000, v8
v_mfma_f32_16x16x32_bf16 v[124:127], a[116:119], a[20:23], v[124:127]
s_xor_b32 s64, s73, 149248
v_mfma_f32_16x16x32_bf16 v[124:127], a[112:115], a[16:19], v[124:127]
buffer_load_dwordx4 v13, s[48:51], s64 offen lds
v_mfma_f32_16x16x32_bf16 v[108:111], a[112:115], a[8:11], v[108:111]
v_mfma_f32_16x16x32_bf16 v[108:111], a[116:119], a[12:15], v[108:111]
v_mfma_f32_16x16x32_bf16 v[92:95], a[116:119], a[4:7], v[92:95]
v_subrev_u32 v9, 0x8000, v9
v_subrev_u32 v10, 0x8000, v10
v_mfma_f32_16x16x32_bf16 v[92:95], a[112:115], a[0:3], v[92:95]
v_subrev_u32 v11, 0x8000, v11
v_mfma_f32_16x16x32_bf16 v[32:35], a[72:75], a[0:3], v[32:35]
v_mfma_f32_16x16x32_bf16 v[32:35], a[76:79], a[4:7], v[32:35]
v_mfma_f32_16x16x32_bf16 v[48:51], a[76:79], a[12:15], v[48:51]
s_waitcnt lgkmcnt(0)
s_barrier
v_mfma_f32_16x16x32_bf16 v[48:51], a[72:75], a[8:11], v[48:51]
s_xor_b32 m0, s84, 32768
buffer_load_dword v1, off, s[52:55], s70 sc1
v_mfma_f32_16x16x32_bf16 v[64:67], a[72:75], a[16:19], v[64:67]
s_xor_b32 s64, s72, 1920
ds_read_b64_tr_b16 a[104:105], v19 offset:4096
v_mfma_f32_16x16x32_bf16 v[64:67], a[76:79], a[20:23], v[64:67]
buffer_load_dwordx4 v12, s[48:51], s64 offen lds
v_mfma_f32_16x16x32_bf16 v[80:83], a[76:79], a[28:31], v[80:83]
ds_read_b64_tr_b16 a[106:107], v19 offset:4352
v_mfma_f32_16x16x32_bf16 v[80:83], a[72:75], a[24:27], v[80:83]
ds_read_b64_tr_b16 a[108:109], v19 offset:6144
v_mfma_f32_16x16x32_bf16 v[144:147], a[80:83], a[24:27], v[144:147]
ds_read_b64_tr_b16 a[110:111], v19 offset:6400
v_mfma_f32_16x16x32_bf16 v[144:147], a[84:87], a[28:31], v[144:147]
s_xor_b32 m0, s84, 33792
ds_read_b64_tr_b16 a[112:113], v20 offset:4096
v_mfma_f32_16x16x32_bf16 v[128:131], a[84:87], a[20:23], v[128:131]
s_xor_b32 s64, s72, 18304
ds_read_b64_tr_b16 a[114:115], v20 offset:4352
v_mfma_f32_16x16x32_bf16 v[128:131], a[80:83], a[16:19], v[128:131]
buffer_load_dwordx4 v13, s[48:51], s64 offen lds
v_mfma_f32_16x16x32_bf16 v[112:115], a[80:83], a[8:11], v[112:115]
ds_read_b64_tr_b16 a[116:117], v20 offset:6144
v_mfma_f32_16x16x32_bf16 v[112:115], a[84:87], a[12:15], v[112:115]
ds_read_b64_tr_b16 a[118:119], v20 offset:6400
v_mfma_f32_16x16x32_bf16 v[96:99], a[84:87], a[4:7], v[96:99]
ds_read_b64_tr_b16 a[72:73], v19 offset:8192
v_mfma_f32_16x16x32_bf16 v[96:99], a[80:83], a[0:3], v[96:99]
s_xor_b32 m0, s84, 34816
ds_read_b64_tr_b16 a[74:75], v19 offset:8448
v_mfma_f32_16x16x32_bf16 v[36:39], a[88:91], a[0:3], v[36:39]
s_xor_b32 s64, s72, 132992
ds_read_b64_tr_b16 a[76:77], v19 offset:10240
v_mfma_f32_16x16x32_bf16 v[36:39], a[92:95], a[4:7], v[36:39]
buffer_load_dwordx4 v12, s[48:51], s64 offen lds
v_mfma_f32_16x16x32_bf16 v[52:55], a[92:95], a[12:15], v[52:55]
ds_read_b64_tr_b16 a[78:79], v19 offset:10496
v_mfma_f32_16x16x32_bf16 v[52:55], a[88:91], a[8:11], v[52:55]
ds_read_b64_tr_b16 a[80:81], v20 offset:8192
v_mfma_f32_16x16x32_bf16 v[68:71], a[88:91], a[16:19], v[68:71]
ds_read_b64_tr_b16 a[82:83], v20 offset:8448
v_mfma_f32_16x16x32_bf16 v[68:71], a[92:95], a[20:23], v[68:71]
s_xor_b32 m0, s84, 35840
ds_read_b64_tr_b16 a[84:85], v20 offset:10240
v_mfma_f32_16x16x32_bf16 v[84:87], a[92:95], a[28:31], v[84:87]
s_xor_b32 s64, s72, 149376
ds_read_b64_tr_b16 a[86:87], v20 offset:10496
v_mfma_f32_16x16x32_bf16 v[84:87], a[88:91], a[24:27], v[84:87]
buffer_load_dwordx4 v13, s[48:51], s64 offen lds
v_mfma_f32_16x16x32_bf16 v[148:151], a[96:99], a[24:27], v[148:151]
ds_read_b64_tr_b16 a[88:89], v19 offset:0
v_mfma_f32_16x16x32_bf16 v[148:151], a[100:103], a[28:31], v[148:151]
ds_read_b64_tr_b16 a[90:91], v19 offset:256
v_mfma_f32_16x16x32_bf16 v[132:135], a[100:103], a[20:23], v[132:135]
ds_read_b64_tr_b16 a[92:93], v19 offset:2048
v_mfma_f32_16x16x32_bf16 v[132:135], a[96:99], a[16:19], v[132:135]
s_xor_b32 m0, s84, 36864
ds_read_b64_tr_b16 a[94:95], v19 offset:2304
v_mfma_f32_16x16x32_bf16 v[116:119], a[96:99], a[8:11], v[116:119]
s_xor_b32 s64, s73, 1920
v_mfma_f32_16x16x32_bf16 v[116:119], a[100:103], a[12:15], v[116:119]
buffer_load_dwordx4 v12, s[48:51], s64 offen lds
v_mfma_f32_16x16x32_bf16 v[100:103], a[100:103], a[4:7], v[100:103]
v_mfma_f32_16x16x32_bf16 v[100:103], a[96:99], a[0:3], v[100:103]
s_waitcnt lgkmcnt(5)
ds_read_b64_tr_b16 a[96:97], v20 offset:0
v_mfma_f32_16x16x32_bf16 v[184:187], a[104:107], a[32:35], v[184:187]
s_xor_b32 m0, s84, 37888
ds_read_b64_tr_b16 a[98:99], v20 offset:256
v_and_b32 v22, 15, v0
v_mfma_f32_16x16x32_bf16 v[184:187], a[108:111], a[36:39], v[184:187]
s_xor_b32 s64, s73, 18304
ds_read_b64_tr_b16 a[100:101], v20 offset:2048
v_lshlrev_b32 v22, 3, v22
v_mfma_f32_16x16x32_bf16 v[192:195], a[108:111], a[44:47], v[192:195]
s_lshl_b32 s85, s30, 7
s_add_u32 s85, s85, 58720256
ds_read_b64_tr_b16 a[102:103], v20 offset:2304
v_mfma_f32_16x16x32_bf16 v[192:195], a[104:107], a[40:43], v[192:195]
s_lshl_b32 s86, s3, 10
s_add_u32 s86, s86, s85
s_lshl_b32 s87, s16, 10
s_lshl_b32 s68, s31, 20
s_add_u32 s32, s28, s68
s_addc_u32 s33, s29, 0
v_mfma_f32_16x16x32_bf16 v[200:203], a[104:107], a[48:51], v[200:203]
s_add_u32 s87, s87, s85
buffer_load_dwordx4 v13, s[48:51], s64 offen lds
v_mfma_f32_16x16x32_bf16 v[200:203], a[108:111], a[52:55], v[200:203]
s_add_u32 s68, s16, 1
s_lshl_b32 s34, s68, 16
v_mfma_f32_16x16x32_bf16 v[208:211], a[108:111], a[60:63], v[208:211]
v_mfma_f32_16x16x32_bf16 v[208:211], a[104:107], a[56:59], v[208:211]
ds_read_b64_tr_b16 a[104:105], v4 offset:0
v_mfma_f32_16x16x32_bf16 v[212:215], a[112:115], a[56:59], v[212:215]
s_xor_b32 m0, s84, 38912
ds_read_b64_tr_b16 a[106:107], v4 offset:1024
v_mfma_f32_16x16x32_bf16 v[212:215], a[116:119], a[60:63], v[212:215]
s_xor_b32 s64, s73, 132992
ds_read_b64_tr_b16 a[108:109], v4 offset:8192
v_mfma_f32_16x16x32_bf16 v[204:207], a[116:119], a[52:55], v[204:207]
buffer_load_dwordx4 v12, s[48:51], s64 offen lds
v_mfma_f32_16x16x32_bf16 v[204:207], a[112:115], a[48:51], v[204:207]
ds_read_b64_tr_b16 a[110:111], v4 offset:9216
v_mfma_f32_16x16x32_bf16 v[196:199], a[112:115], a[40:43], v[196:199]
v_mfma_f32_16x16x32_bf16 v[196:199], a[116:119], a[44:47], v[196:199]
v_mfma_f32_16x16x32_bf16 v[188:191], a[116:119], a[36:39], v[188:191]
s_xor_b32 m0, s84, 39936
v_mfma_f32_16x16x32_bf16 v[188:191], a[112:115], a[32:35], v[188:191]
s_xor_b32 s64, s73, 149376
ds_read_b64_tr_b16 a[112:113], v5 offset:0
v_mfma_f32_16x16x32_bf16 v[216:219], a[32:35], a[72:75], v[216:219]
buffer_load_dwordx4 v13, s[48:51], s64 offen lds
v_mfma_f32_16x16x32_bf16 v[216:219], a[36:39], a[76:79], v[216:219]
ds_read_b64_tr_b16 a[114:115], v5 offset:1024
v_mfma_f32_16x16x32_bf16 v[224:227], a[44:47], a[76:79], v[224:227]
ds_read_b64_tr_b16 a[116:117], v5 offset:8192
v_mfma_f32_16x16x32_bf16 v[224:227], a[40:43], a[72:75], v[224:227]
ds_read_b64_tr_b16 a[118:119], v5 offset:9216
v_mfma_f32_16x16x32_bf16 v[232:235], a[48:51], a[72:75], v[232:235]
s_xor_b32 m0, s77, 131072
v_mfma_f32_16x16x32_bf16 v[232:235], a[52:55], a[76:79], v[232:235]
s_xor_b32 s64, s71, 7864320
v_mfma_f32_16x16x32_bf16 v[240:243], a[60:63], a[76:79], v[240:243]
buffer_load_dwordx4 v14, s[56:59], s64 offen lds
v_mfma_f32_16x16x32_bf16 v[240:243], a[56:59], a[72:75], v[240:243]
ds_read_b64_tr_b16 a[72:73], v6 offset:0
v_mfma_f32_16x16x32_bf16 v[244:247], a[56:59], a[80:83], v[244:247]
s_waitcnt lgkmcnt(5)
ds_read_b64_tr_b16 a[74:75], v6 offset:1024
v_mfma_f32_16x16x32_bf16 v[244:247], a[60:63], a[84:87], v[244:247]
ds_read_b64_tr_b16 a[76:77], v6 offset:8192
v_add_u32 v19, 0x8000, v19
v_mfma_f32_16x16x32_bf16 v[236:239], a[52:55], a[84:87], v[236:239]
s_add_u32 m0, s78, 147456
ds_read_b64_tr_b16 a[78:79], v6 offset:9216
v_mfma_f32_16x16x32_bf16 v[236:239], a[48:51], a[80:83], v[236:239]
s_add_u32 s64, s75, 5898240
v_mfma_f32_16x16x32_bf16 v[228:231], a[40:43], a[80:83], v[228:231]
buffer_load_dwordx4 v23, s[60:63], s64 offen lds
v_mfma_f32_16x16x32_bf16 v[228:231], a[44:47], a[84:87], v[228:231]
v_mfma_f32_16x16x32_bf16 v[220:223], a[36:39], a[84:87], v[220:223]
v_mfma_f32_16x16x32_bf16 v[220:223], a[32:35], a[80:83], v[220:223]
ds_read_b64_tr_b16 a[80:81], v7 offset:0
v_mfma_f32_16x16x32_bf16 v[152:155], a[88:91], a[32:35], v[152:155]
ds_read_b64_tr_b16 a[82:83], v7 offset:1024
v_mfma_f32_16x16x32_bf16 v[152:155], a[92:95], a[36:39], v[152:155]
s_xor_b32 m0, s77, 132096
ds_read_b64_tr_b16 a[84:85], v7 offset:8192
v_add_u32 v20, 0x8000, v20
v_mfma_f32_16x16x32_bf16 v[160:163], a[92:95], a[44:47], v[160:163]
s_xor_b32 s64, s71, 7897088
ds_read_b64_tr_b16 a[86:87], v7 offset:9216
v_mfma_f32_16x16x32_bf16 v[160:163], a[88:91], a[40:43], v[160:163]
buffer_load_dwordx4 v14, s[56:59], s64 offen lds
v_mfma_f32_16x16x32_bf16 v[168:171], a[88:91], a[48:51], v[168:171]
v_mfma_f32_16x16x32_bf16 v[168:171], a[92:95], a[52:55], v[168:171]
v_mfma_f32_16x16x32_bf16 v[176:179], a[92:95], a[60:63], v[176:179]
v_mfma_f32_16x16x32_bf16 v[176:179], a[88:91], a[56:59], v[176:179]
s_add_u32 m0, s78, 151552
ds_read_b64_tr_b16 a[88:89], v8 offset:0
v_mfma_f32_16x16x32_bf16 v[180:183], a[96:99], a[56:59], v[180:183]
s_add_u32 s64, s75, 5900288
ds_read_b64_tr_b16 a[90:91], v8 offset:1024
v_mfma_f32_16x16x32_bf16 v[180:183], a[100:103], a[60:63], v[180:183]
buffer_load_dwordx4 v23, s[60:63], s64 offen lds
v_mfma_f32_16x16x32_bf16 v[172:175], a[100:103], a[52:55], v[172:175]
ds_read_b64_tr_b16 a[92:93], v8 offset:8192
v_add_u32 v4, 0x8000, v4
v_mfma_f32_16x16x32_bf16 v[172:175], a[96:99], a[48:51], v[172:175]
ds_read_b64_tr_b16 a[94:95], v8 offset:9216
v_mfma_f32_16x16x32_bf16 v[164:167], a[96:99], a[40:43], v[164:167]
v_mfma_f32_16x16x32_bf16 v[164:167], a[100:103], a[44:47], v[164:167]
s_xor_b32 m0, s77, 133120
v_mfma_f32_16x16x32_bf16 v[156:159], a[100:103], a[36:39], v[156:159]
s_xor_b32 s64, s71, 7929856
v_mfma_f32_16x16x32_bf16 v[156:159], a[96:99], a[32:35], v[156:159]
buffer_load_dwordx4 v15, s[56:59], s64 offen lds
v_mfma_f32_16x16x32_bf16 v[24:27], a[104:107], a[32:35], v[24:27]
ds_read_b64_tr_b16 a[96:97], v9 offset:0
v_mfma_f32_16x16x32_bf16 v[24:27], a[108:111], a[36:39], v[24:27]
ds_read_b64_tr_b16 a[98:99], v9 offset:1024
v_add_u32 v5, 0x8000, v5
v_mfma_f32_16x16x32_bf16 v[40:43], a[108:111], a[44:47], v[40:43]
ds_read_b64_tr_b16 a[100:101], v9 offset:8192
v_mfma_f32_16x16x32_bf16 v[40:43], a[104:107], a[40:43], v[40:43]
s_add_u32 m0, s78, 155648
ds_read_b64_tr_b16 a[102:103], v9 offset:9216
v_mfma_f32_16x16x32_bf16 v[56:59], a[104:107], a[48:51], v[56:59]
s_add_u32 s64, s75, 5902336
v_mfma_f32_16x16x32_bf16 v[56:59], a[108:111], a[52:55], v[56:59]
buffer_load_dwordx4 v23, s[60:63], s64 offen lds
v_mfma_f32_16x16x32_bf16 v[72:75], a[108:111], a[60:63], v[72:75]
s_waitcnt vmcnt(15)
ds_read_b128 a[0:3], v2 offset:0
v_mfma_f32_16x16x32_bf16 v[72:75], a[104:107], a[56:59], v[72:75]
s_waitcnt lgkmcnt(5)
ds_read_b128 a[4:7], v3 offset:0
v_mfma_f32_16x16x32_bf16 v[136:139], a[112:115], a[56:59], v[136:139]
ds_read_b128 a[8:11], v2 offset:2048
v_mfma_f32_16x16x32_bf16 v[136:139], a[116:119], a[60:63], v[136:139]
s_xor_b32 m0, s77, 134144
ds_read_b128 a[12:15], v3 offset:2048
v_add_u32 v6, 0x8000, v6
v_mfma_f32_16x16x32_bf16 v[120:123], a[116:119], a[52:55], v[120:123]
s_xor_b32 s64, s71, 7962624
ds_read_b128 a[16:19], v2 offset:4096
v_mfma_f32_16x16x32_bf16 v[120:123], a[112:115], a[48:51], v[120:123]
buffer_load_dwordx4 v15, s[56:59], s64 offen lds
v_mfma_f32_16x16x32_bf16 v[104:107], a[112:115], a[40:43], v[104:107]
ds_read_b128 a[20:23], v3 offset:4096
v_mfma_f32_16x16x32_bf16 v[104:107], a[116:119], a[44:47], v[104:107]
ds_read_b128 a[24:27], v2 offset:6144
v_mfma_f32_16x16x32_bf16 v[88:91], a[116:119], a[36:39], v[88:91]
ds_read_b128 a[28:31], v3 offset:6144
v_mfma_f32_16x16x32_bf16 v[88:91], a[112:115], a[32:35], v[88:91]
ds_read_b64_tr_b16 a[104:105], v10 offset:0
v_mfma_f32_16x16x32_bf16 v[28:31], a[72:75], a[32:35], v[28:31]
ds_read_b64_tr_b16 a[106:107], v10 offset:1024
v_mfma_f32_16x16x32_bf16 v[28:31], a[76:79], a[36:39], v[28:31]
ds_read_b64_tr_b16 a[108:109], v10 offset:8192
v_add_u32 v7, 0x8000, v7
v_mfma_f32_16x16x32_bf16 v[44:47], a[76:79], a[44:47], v[44:47]
ds_read_b64_tr_b16 a[110:111], v10 offset:9216
v_mfma_f32_16x16x32_bf16 v[44:47], a[72:75], a[40:43], v[44:47]
ds_read_b64_tr_b16 a[112:113], v11 offset:0
v_mfma_f32_16x16x32_bf16 v[60:63], a[72:75], a[48:51], v[60:63]
ds_read_b64_tr_b16 a[114:115], v11 offset:1024
v_mfma_f32_16x16x32_bf16 v[60:63], a[76:79], a[52:55], v[60:63]
ds_read_b64_tr_b16 a[116:117], v11 offset:8192
v_mfma_f32_16x16x32_bf16 v[76:79], a[76:79], a[60:63], v[76:79]
ds_read_b64_tr_b16 a[118:119], v11 offset:9216
v_mfma_f32_16x16x32_bf16 v[76:79], a[72:75], a[56:59], v[76:79]
v_mfma_f32_16x16x32_bf16 v[140:143], a[80:83], a[56:59], v[140:143]
v_mfma_f32_16x16x32_bf16 v[140:143], a[84:87], a[60:63], v[140:143]
v_add_u32 v8, 0x8000, v8
v_mfma_f32_16x16x32_bf16 v[124:127], a[84:87], a[52:55], v[124:127]
v_lshrrev_b32 v23, 2, v0
v_mul_u32_u24 v23, 3584, v23
v_mfma_f32_16x16x32_bf16 v[124:127], a[80:83], a[48:51], v[124:127]
v_lshl_add_u32 v23, v0, 7, v23
v_mfma_f32_16x16x32_bf16 v[108:111], a[80:83], a[40:43], v[108:111]
v_mfma_f32_16x16x32_bf16 v[108:111], a[84:87], a[44:47], v[108:111]
v_mfma_f32_16x16x32_bf16 v[92:95], a[84:87], a[36:39], v[92:95]
v_add_u32 v9, 0x8000, v9
v_add_u32 v10, 0x8000, v10
v_mfma_f32_16x16x32_bf16 v[92:95], a[80:83], a[32:35], v[92:95]
v_add_u32 v11, 0x8000, v11
v_mfma_f32_16x16x32_bf16 v[32:35], a[88:91], a[32:35], v[32:35]
s_waitcnt vmcnt(15)
v_readfirstlane_b32 vcc_lo, v1
s_nop 0
s_cmp_lt_u32 vcc_lo, s81
s_cbranch_scc1 L_spin_4
L_spinbk_5:
v_mfma_f32_16x16x32_bf16 v[32:35], a[92:95], a[36:39], v[32:35]
buffer_load_dwordx2 a[64:65], v22, s[44:47], s86 offen offset:0 sc1
v_mfma_f32_16x16x32_bf16 v[48:51], a[92:95], a[44:47], v[48:51]
s_waitcnt lgkmcnt(0)
s_barrier
v_mfma_f32_16x16x32_bf16 v[48:51], a[88:91], a[40:43], v[48:51]
ds_read_b64_tr_b16 a[72:73], v19 offset:4096
v_cmp_gt_i32 s[0:1], 0, v18
v_mfma_f32_16x16x32_bf16 v[64:67], a[88:91], a[48:51], v[64:67]
s_lshl2_add_u32 s72, s2, s30
ds_read_b64_tr_b16 a[74:75], v19 offset:4352
v_cmp_gt_i32 s[4:5], 1, v18
v_mfma_f32_16x16x32_bf16 v[64:67], a[92:95], a[52:55], v[64:67]
s_lshl_b32 s72, s72, 12
s_mov_b32 m0, s76
ds_read_b64_tr_b16 a[76:77], v19 offset:6144
v_cmp_gt_i32 s[6:7], 2, v18
v_mfma_f32_16x16x32_bf16 v[80:83], a[92:95], a[60:63], v[80:83]
s_add_u32 s72, s72, 67108864
s_lshl_b32 s64, s30, 14
ds_read_b64_tr_b16 a[78:79], v19 offset:6400
v_cmp_gt_i32 s[8:9], 3, v18
v_mfma_f32_16x16x32_bf16 v[80:83], a[88:91], a[56:59], v[80:83]
s_lshr_b32 s17, s78, 1
buffer_load_dwordx4 v16, s[32:35], s64 offen offset:0 sc1 lds
v_mfma_f32_16x16x32_bf16 v[144:147], a[96:99], a[56:59], v[144:147]
s_add_u32 s17, s17, L_base-L_pc-4+53248
buffer_load_dwordx2 a[66:67], v22, s[44:47], s86 offen offset:512 sc1
v_mfma_f32_16x16x32_bf16 v[144:147], a[100:103], a[60:63], v[144:147]
buffer_load_dword a252, v23, s[88:91], s17 offen
v_mfma_f32_16x16x32_bf16 v[128:131], a[100:103], a[52:55], v[128:131]
buffer_load_dwordx2 a[68:69], v22, s[44:47], s87 offen offset:0 sc1
v_mfma_f32_16x16x32_bf16 v[128:131], a[96:99], a[48:51], v[128:131]
buffer_load_dwordx2 a[70:71], v22, s[44:47], s87 offen offset:512 sc1
v_mfma_f32_16x16x32_bf16 v[112:115], a[96:99], a[40:43], v[112:115]
ds_read_b64_tr_b16 a[80:81], v20 offset:4096
v_cmp_gt_i32 s[10:11], 16, v18
v_mfma_f32_16x16x32_bf16 v[112:115], a[100:103], a[44:47], v[112:115]
ds_read_b64_tr_b16 a[82:83], v20 offset:4352
v_cmp_gt_i32 s[12:13], 17, v18
v_mfma_f32_16x16x32_bf16 v[96:99], a[100:103], a[36:39], v[96:99]
ds_read_b64_tr_b16 a[84:85], v20 offset:6144
v_cmp_gt_i32 s[18:19], 18, v18
v_mfma_f32_16x16x32_bf16 v[96:99], a[96:99], a[32:35], v[96:99]
buffer_load_dwordx4 v16, s[32:35], s64 offen offset:1024 sc1 lds
v_mfma_f32_16x16x32_bf16 v[36:39], a[104:107], a[32:35], v[36:39]
buffer_store_dwordx4 a[240:243], v16, s[44:47], s72 offen offset:0 sc1
v_mfma_f32_16x16x32_bf16 v[36:39], a[108:111], a[36:39], v[36:39]
ds_read_b64_tr_b16 a[86:87], v20 offset:6400
v_cmp_gt_i32 s[22:23], 19, v18
v_mfma_f32_16x16x32_bf16 v[52:55], a[108:111], a[44:47], v[52:55]
ds_read_b64_tr_b16 a[88:89], v19 offset:8192
v_cmp_gt_i32 s[26:27], 32, v18
v_mfma_f32_16x16x32_bf16 v[52:55], a[104:107], a[40:43], v[52:55]
ds_read_b64_tr_b16 a[90:91], v19 offset:8448
v_cmp_gt_i32 s[56:57], 33, v18
v_mfma_f32_16x16x32_bf16 v[68:71], a[104:107], a[48:51], v[68:71]
ds_read_b64_tr_b16 a[92:93], v19 offset:10240
v_cmp_gt_i32 s[58:59], 34, v18
v_mfma_f32_16x16x32_bf16 v[68:71], a[108:111], a[52:55], v[68:71]
ds_read_b64_tr_b16 a[94:95], v19 offset:10496
v_cmp_gt_i32 s[60:61], 35, v18
v_mfma_f32_16x16x32_bf16 v[84:87], a[108:111], a[60:63], v[84:87]
ds_read_b64_tr_b16 a[96:97], v20 offset:8192
v_cmp_gt_i32 s[62:63], 48, v18
v_mfma_f32_16x16x32_bf16 v[84:87], a[104:107], a[56:59], v[84:87]
buffer_load_dwordx4 v16, s[32:35], s64 offen offset:2048 sc1 lds
v_mfma_f32_16x16x32_bf16 v[148:151], a[112:115], a[56:59], v[148:151]
ds_read_b64_tr_b16 a[98:99], v20 offset:8448
v_cmp_gt_i32 s[48:49], 49, v18
v_mfma_f32_16x16x32_bf16 v[148:151], a[116:119], a[60:63], v[148:151]
ds_read_b64_tr_b16 a[100:101], v20 offset:10240
v_cmp_gt_i32 s[50:51], 50, v18
v_mfma_f32_16x16x32_bf16 v[132:135], a[116:119], a[52:55], v[132:135]
ds_read_b64_tr_b16 a[102:103], v20 offset:10496
v_cmp_gt_i32 s[100:101], 51, v18
v_mfma_f32_16x16x32_bf16 v[132:135], a[112:115], a[48:51], v[132:135]
ds_read_b64_tr_b16 a[104:105], v19 offset:0
v_mfma_f32_16x16x32_bf16 v[116:119], a[112:115], a[40:43], v[116:119]
ds_read_b64_tr_b16 a[106:107], v19 offset:256
v_mfma_f32_16x16x32_bf16 v[116:119], a[116:119], a[44:47], v[116:119]
ds_read_b64_tr_b16 a[108:109], v19 offset:2048
v_mfma_f32_16x16x32_bf16 v[100:103], a[116:119], a[36:39], v[100:103]
buffer_store_dwordx4 a[240:243], v16, s[44:47], s72 offen offset:1024 sc1
v_mfma_f32_16x16x32_bf16 v[100:103], a[112:115], a[32:35], v[100:103]
s_waitcnt lgkmcnt(7)
buffer_load_dwordx4 v16, s[32:35], s64 offen offset:3072 sc1 lds
v_mfma_f32_16x16x32_bf16 v[184:187], a[72:75], a[0:3], v[184:187]
s_waitcnt vmcnt(18)
s_and_b32 s66, s2, 7
ds_read_b128 a[32:35], v2 offset:32768
v_mfma_f32_16x16x32_bf16 v[184:187], a[76:79], a[4:7], v[184:187]
s_lshr_b32 s67, s2, 3
s_and_b32 s83, s66, 1
ds_read_b128 a[36:39], v3 offset:32768
v_mfma_f32_16x16x32_bf16 v[192:195], a[76:79], a[12:15], v[192:195]
s_and_b32 s68, s66, 2
s_and_b32 s69, s67, 7
ds_read_b128 a[40:43], v2 offset:34816
v_mfma_f32_16x16x32_bf16 v[192:195], a[72:75], a[8:11], v[192:195]
s_lshl2_add_u32 s82, s68, s69
s_and_b32 s68, s66, 4
ds_read_b128 a[44:47], v3 offset:34816
v_mfma_f32_16x16x32_bf16 v[200:203], a[72:75], a[16:19], v[200:203]
s_lshr_b32 s69, s67, 3
s_xor_b32 s69, s69, 0
ds_read_b128 a[48:51], v2 offset:36864
v_mfma_f32_16x16x32_bf16 v[200:203], a[76:79], a[20:23], v[200:203]
s_add_u32 s87, s68, s69
s_lshl_b32 s87, s87, 8
s_add_u32 m0, s76, 4096
ds_read_b128 a[52:55], v3 offset:36864
v_mfma_f32_16x16x32_bf16 v[208:211], a[76:79], a[28:31], v[208:211]
s_lshl_b32 s86, s30, 13
s_lshl_b32 s85, s30, 16
s_add_u32 s64, s64, 4096
ds_read_b128 a[56:59], v2 offset:38912
v_mfma_f32_16x16x32_bf16 v[208:211], a[72:75], a[24:27], v[208:211]
s_add_u32 s85, s85, s87
buffer_load_dwordx4 v16, s[32:35], s64 offen offset:0 sc1 lds
v_mfma_f32_16x16x32_bf16 v[212:215], a[80:83], a[24:27], v[212:215]
s_mul_i32 s66, s83, 1310720
s_add_u32 s85, s85, s66
ds_read_b128 a[60:63], v3 offset:38912
v_mfma_f32_16x16x32_bf16 v[212:215], a[84:87], a[28:31], v[212:215]
s_mul_i32 s84, s82, 1310720
s_and_b32 s66, s30, 1
ds_read_b64_tr_b16 a[110:111], v19 offset:2304
v_mfma_f32_16x16x32_bf16 v[204:207], a[84:87], a[20:23], v[204:207]
s_lshl_b32 s66, s66, 14
s_add_u32 s84, s84, s66
ds_read_b64_tr_b16 a[112:113], v20 offset:0
v_mfma_f32_16x16x32_bf16 v[204:207], a[80:83], a[16:19], v[204:207]
s_mul_i32 s66, s83, 163840
s_add_u32 s84, s84, s66
ds_read_b64_tr_b16 a[114:115], v20 offset:256
v_mfma_f32_16x16x32_bf16 v[196:199], a[80:83], a[8:11], v[196:199]
s_add_u32 s84, s84, 34603008
s_sub_u32 s66, 15, s82
ds_read_b64_tr_b16 a[116:117], v20 offset:2048
v_mfma_f32_16x16x32_bf16 v[196:199], a[84:87], a[12:15], v[196:199]
s_min_u32 s66, s66, s82
s_lshl1_add_u32 s66, s66, s83
ds_read_b64_tr_b16 a[118:119], v20 offset:2304
v_mfma_f32_16x16x32_bf16 v[188:191], a[84:87], a[4:7], v[188:191]
s_lshl_b32 s80, s66, 8
buffer_store_dwordx4 a[240:243], v16, s[44:47], s72 offen offset:2048 sc1
v_mfma_f32_16x16x32_bf16 v[188:191], a[80:83], a[0:3], v[188:191]
s_add_u32 s80, s80, 8192
buffer_load_dwordx4 v16, s[32:35], s64 offen offset:1024 sc1 lds
v_mfma_f32_16x16x32_bf16 v[216:219], a[0:3], a[88:91], v[216:219]
s_and_b32 s67, s30, 1
s_lshl_b32 s67, s67, 7
s_add_u32 s67, s67, s83
v_mfma_f32_16x16x32_bf16 v[216:219], a[4:7], a[92:95], v[216:219]
s_lshl_b32 s67, s67, 7
s_add_u32 s67, s67, 98304
s_lshl_b32 s66, s30, 11
v_mfma_f32_16x16x32_bf16 v[224:227], a[12:15], a[92:95], v[224:227]
s_waitcnt vmcnt(14) lgkmcnt(0)
s_barrier
v_mfma_f32_16x16x32_bf16 v[224:227], a[8:11], a[88:91], v[224:227]
ds_read_b64_tr_b16 a[72:73], v19 offset:36864
v_lshrrev_b32 v14, 4, v0
v_mfma_f32_16x16x32_bf16 v[232:235], a[16:19], a[88:91], v[232:235]
ds_read_b64_tr_b16 a[74:75], v19 offset:37120
v_bfe_u32 v12, v0, 1, 3
v_mfma_f32_16x16x32_bf16 v[232:235], a[20:23], a[92:95], v[232:235]
ds_read_b64_tr_b16 a[76:77], v19 offset:38912
v_xor_b32 v12, v12, v14
v_mfma_f32_16x16x32_bf16 v[240:243], a[28:31], a[92:95], v[240:243]
ds_read_b64_tr_b16 a[78:79], v19 offset:39168
v_lshlrev_b32 v12, 5, v12
v_mfma_f32_16x16x32_bf16 v[240:243], a[24:27], a[88:91], v[240:243]
buffer_load_dwordx4 v16, s[32:35], s64 offen offset:2048 sc1 lds
v_mfma_f32_16x16x32_bf16 v[244:247], a[24:27], a[96:99], v[244:247]
ds_read_b64_tr_b16 a[80:81], v20 offset:36864
v_lshl_add_u32 v12, v14, 11, v12
v_mfma_f32_16x16x32_bf16 v[244:247], a[28:31], a[100:103], v[244:247]
ds_read_b64_tr_b16 a[82:83], v20 offset:37120
v_and_b32 v14, 1, v0
v_mfma_f32_16x16x32_bf16 v[236:239], a[20:23], a[100:103], v[236:239]
buffer_store_dwordx4 a[240:243], v16, s[44:47], s72 offen offset:3072 sc1
v_mfma_f32_16x16x32_bf16 v[236:239], a[16:19], a[96:99], v[236:239]
ds_read_b64_tr_b16 a[84:85], v20 offset:38912
v_lshl_add_u32 v12, v14, 4, v12
v_mfma_f32_16x16x32_bf16 v[228:231], a[8:11], a[96:99], v[228:231]
ds_read_b64_tr_b16 a[86:87], v20 offset:39168
v_xor_b32 v13, 128, v12
v_mfma_f32_16x16x32_bf16 v[228:231], a[12:15], a[100:103], v[228:231]
ds_read_b64_tr_b16 a[88:89], v19 offset:40960
v_lshrrev_b32 v14, 4, v0
v_mfma_f32_16x16x32_bf16 v[220:223], a[4:7], a[100:103], v[220:223]
ds_read_b64_tr_b16 a[90:91], v19 offset:41216
v_bfe_u32 v18, v0, 2, 2
v_mfma_f32_16x16x32_bf16 v[220:223], a[0:3], a[96:99], v[220:223]
buffer_load_dwordx4 v16, s[32:35], s64 offen offset:3072 sc1 lds
v_mfma_f32_16x16x32_bf16 v[152:155], a[104:107], a[0:3], v[152:155]
ds_read_b64_tr_b16 a[92:93], v19 offset:43008
v_lshl_add_u32 v14, v14, 2, v18
v_mfma_f32_16x16x32_bf16 v[152:155], a[108:111], a[4:7], v[152:155]
ds_read_b64_tr_b16 a[94:95], v19 offset:43264
v_and_b32 v18, 3, v0
v_mfma_f32_16x16x32_bf16 v[160:163], a[108:111], a[12:15], v[160:163]
s_branch L_po13
L_pg13:
s_branch L_tr1
L_po13:
s_lshr_b32 s64, s76, 1
ds_read_b64_tr_b16 a[96:97], v20 offset:40960
v_lshlrev_b32 v18, 3, v18
v_mfma_f32_16x16x32_bf16 v[160:163], a[104:107], a[8:11], v[160:163]
s_add_u32 m0, s64, 81920
ds_read_b64_tr_b16 a[98:99], v20 offset:41216
v_lshl_add_u32 v18, v14, 8, v18
v_mfma_f32_16x16x32_bf16 v[168:171], a[104:107], a[16:19], v[168:171]
s_and_b32 s71, s64, 8192
ds_read_b64_tr_b16 a[100:101], v20 offset:43008
v_and_b32 v14, 7, v14
v_mfma_f32_16x16x32_bf16 v[168:171], a[108:111], a[20:23], v[168:171]
s_add_u32 s64, s64, s71
ds_read_b64_tr_b16 a[102:103], v20 offset:43264
v_lshl_add_u32 v18, v14, 5, v18
v_mfma_f32_16x16x32_bf16 v[176:179], a[108:111], a[28:31], v[176:179]
s_add_u32 s64, s64, 8192
v_xor_b32 v18, s67, v18
v_add_u32 v14, s66, v16
v_mfma_f32_16x16x32_bf16 v[176:179], a[104:107], a[24:27], v[176:179]
buffer_load_dwordx4 v16, s[32:35], s64 offen offset:0 sc1 lds
v_mfma_f32_16x16x32_bf16 v[180:183], a[112:115], a[24:27], v[180:183]
s_cmp_eq_u32 s30, 0
s_cbranch_scc1 L_pg14
s_cmp_eq_u32 s30, 1
s_cbranch_scc1 L_pg15
s_cmp_eq_u32 s30, 2
s_cbranch_scc1 L_pg16
s_branch L_pg17
L_tr2:
v_mfma_f32_16x16x32_bf16 v[180:183], a[116:119], a[28:31], v[180:183]
ds_read_b64_tr_b16 a[104:105], v19 offset:32768
v_xor_b32 v15, 0x800, v14
v_mfma_f32_16x16x32_bf16 v[172:175], a[116:119], a[20:23], v[172:175]
s_lshl2_add_u32 s73, s2, s30
s_lshl_b32 s73, s73, 11
s_lshl1_add_u32 s66, s78, 32768
v_mfma_f32_16x16x32_bf16 v[172:175], a[112:115], a[16:19], v[172:175]
ds_read_b64_tr_b16 a[106:107], v19 offset:33024
v_add_u32 v2, s66, v16
v_mfma_f32_16x16x32_bf16 v[164:167], a[112:115], a[8:11], v[164:167]
ds_read_b64_tr_b16 a[108:109], v19 offset:34816
v_bfe_u32 v1, v0, 1, 1
v_mfma_f32_16x16x32_bf16 v[164:167], a[116:119], a[12:15], v[164:167]
ds_read_b64_tr_b16 a[110:111], v19 offset:35072
v_subrev_u32 v1, 1, v1
v_mfma_f32_16x16x32_bf16 v[156:159], a[116:119], a[4:7], v[156:159]
s_or_b32 s66, s3, s30
s_cmp_eq_u32 s66, 0
s_cselect_b32 s66, 0xff800000, 0
v_mfma_f32_16x16x32_bf16 v[156:159], a[112:115], a[0:3], v[156:159]
s_waitcnt lgkmcnt(4)
buffer_load_dwordx4 v16, s[32:35], s64 offen offset:1024 sc1 lds
v_mfma_f32_16x16x32_bf16 v[184:187], a[72:75], a[32:35], v[184:187]
ds_read_b64_tr_b16 a[112:113], v20 offset:32768
v_and_b32 v1, 0x3f803f80, v1
v_mfma_f32_16x16x32_bf16 v[184:187], a[76:79], a[36:39], v[184:187]
ds_read_b64_tr_b16 a[114:115], v20 offset:33024
v_accvgpr_write_b32 a240, v1
v_mfma_f32_16x16x32_bf16 v[192:195], a[76:79], a[44:47], v[192:195]
ds_read_b64_tr_b16 a[116:117], v20 offset:34816
v_accvgpr_write_b32 a241, v1
v_mfma_f32_16x16x32_bf16 v[192:195], a[72:75], a[40:43], v[192:195]
ds_read_b64_tr_b16 a[118:119], v20 offset:35072
v_accvgpr_write_b32 a242, v1
v_mfma_f32_16x16x32_bf16 v[200:203], a[72:75], a[48:51], v[200:203]
s_and_b32 s67, s74, 0x7800
s_cselect_b32 s67, 0, 0x70000000
s_add_u32 s77, s74, s67
v_mfma_f32_16x16x32_bf16 v[200:203], a[76:79], a[52:55], v[200:203]
s_sub_u32 s77, s77, 2048
v_accvgpr_write_b32 a243, v1
v_mfma_f32_16x16x32_bf16 v[208:211], a[76:79], a[60:63], v[208:211]
s_mov_b32 s68, 0x3e0293ee
v_mfma_f32_16x16x32_bf16 v[208:211], a[72:75], a[56:59], v[208:211]
s_mov_b32 s69, s68
buffer_load_dwordx4 v16, s[32:35], s64 offen offset:2048 sc1 lds
v_mfma_f32_16x16x32_bf16 v[212:215], a[80:83], a[56:59], v[212:215]
ds_read_b64_tr_b16 a[72:73], v4 offset:0
v_mfma_f32_16x16x32_bf16 v[212:215], a[84:87], a[60:63], v[212:215]
ds_read_b64_tr_b16 a[74:75], v4 offset:1024
v_mfma_f32_16x16x32_bf16 v[204:207], a[84:87], a[52:55], v[204:207]
ds_read_b64_tr_b16 a[76:77], v4 offset:8192
v_mfma_f32_16x16x32_bf16 v[204:207], a[80:83], a[48:51], v[204:207]
ds_read_b64_tr_b16 a[78:79], v4 offset:9216
v_mfma_f32_16x16x32_bf16 v[196:199], a[80:83], a[40:43], v[196:199]
v_mfma_f32_16x16x32_bf16 v[196:199], a[84:87], a[44:47], v[196:199]
v_mfma_f32_16x16x32_bf16 v[188:191], a[84:87], a[36:39], v[188:191]
v_mfma_f32_16x16x32_bf16 v[188:191], a[80:83], a[32:35], v[188:191]
buffer_load_dwordx4 v16, s[32:35], s64 offen offset:3072 sc1 lds
v_mfma_f32_16x16x32_bf16 v[216:219], a[32:35], a[88:91], v[216:219]
ds_read_b64_tr_b16 a[80:81], v4 offset:32768
v_mfma_f32_16x16x32_bf16 v[216:219], a[36:39], a[92:95], v[216:219]
ds_read_b64_tr_b16 a[82:83], v4 offset:33792
v_cvt_pk_bf16_f32 v208, v208, v209
v_mfma_f32_16x16x32_bf16 v[224:227], a[44:47], a[92:95], v[224:227]
ds_read_b64_tr_b16 a[84:85], v4 offset:40960
v_cvt_pk_bf16_f32 v209, v210, v211
v_mfma_f32_16x16x32_bf16 v[224:227], a[40:43], a[88:91], v[224:227]
ds_read_b64_tr_b16 a[86:87], v4 offset:41984
v_cvt_pk_bf16_f32 v210, v212, v213
v_mfma_f32_16x16x32_bf16 v[232:235], a[48:51], a[88:91], v[232:235]
v_cvt_pk_bf16_f32 v211, v214, v215
v_mfma_f32_16x16x32_bf16 v[232:235], a[52:55], a[92:95], v[232:235]
ds_write_b128 v2, v[208:211] offset:30720
v_mfma_f32_16x16x32_bf16 v[240:243], a[60:63], a[92:95], v[240:243]
v_cvt_pk_bf16_f32 v200, v200, v201
v_cvt_pk_bf16_f32 v201, v202, v203
v_mfma_f32_16x16x32_bf16 v[240:243], a[56:59], a[88:91], v[240:243]
ds_read_b64_tr_b16 a[88:89], v5 offset:0
v_cvt_pk_bf16_f32 v202, v204, v205
v_mfma_f32_16x16x32_bf16 v[244:247], a[56:59], a[96:99], v[244:247]
ds_read_b64_tr_b16 a[90:91], v5 offset:1024
v_cvt_pk_bf16_f32 v203, v206, v207
v_mfma_f32_16x16x32_bf16 v[244:247], a[60:63], a[100:103], v[244:247]
ds_write_b128 v2, v[200:203] offset:22528
v_mfma_f32_16x16x32_bf16 v[236:239], a[52:55], a[100:103], v[236:239]
ds_read_b64_tr_b16 a[92:93], v5 offset:8192
v_cvt_pk_bf16_f32 v192, v192, v193
v_mfma_f32_16x16x32_bf16 v[236:239], a[48:51], a[96:99], v[236:239]
ds_read_b64_tr_b16 a[94:95], v5 offset:9216
v_cvt_pk_bf16_f32 v193, v194, v195
v_mfma_f32_16x16x32_bf16 v[228:231], a[40:43], a[96:99], v[228:231]
v_cvt_pk_bf16_f32 v194, v196, v197
v_cvt_pk_bf16_f32 v195, v198, v199
v_mfma_f32_16x16x32_bf16 v[228:231], a[44:47], a[100:103], v[228:231]
ds_write_b128 v2, v[192:195] offset:10240
v_mfma_f32_16x16x32_bf16 v[220:223], a[36:39], a[100:103], v[220:223]
v_cvt_pk_bf16_f32 v184, v184, v185
v_cvt_pk_bf16_f32 v185, v186, v187
v_mfma_f32_16x16x32_bf16 v[220:223], a[32:35], a[96:99], v[220:223]
s_waitcnt lgkmcnt(6)
ds_read_b64_tr_b16 a[96:97], v5 offset:32768
v_cvt_pk_bf16_f32 v186, v188, v189
v_mfma_f32_16x16x32_bf16 v[152:155], a[104:107], a[32:35], v[152:155]
ds_read_b64_tr_b16 a[98:99], v5 offset:33792
v_cvt_pk_bf16_f32 v187, v190, v191
v_mfma_f32_16x16x32_bf16 v[152:155], a[108:111], a[36:39], v[152:155]
ds_write_b128 v2, v[184:187] offset:2048
v_mfma_f32_16x16x32_bf16 v[160:163], a[108:111], a[44:47], v[160:163]
buffer_load_dword a252, v21, s[36:39], s73 offen
v_mfma_f32_16x16x32_bf16 v[160:163], a[104:107], a[40:43], v[160:163]
ds_read_b64_tr_b16 a[100:101], v5 offset:40960
v_cvt_pk_bf16_f32 v243, v242, v243
v_mfma_f32_16x16x32_bf16 v[168:171], a[104:107], a[48:51], v[168:171]
ds_read_b64_tr_b16 a[102:103], v5 offset:41984
v_cvt_pk_bf16_f32 v242, v240, v241
v_mfma_f32_16x16x32_bf16 v[168:171], a[108:111], a[52:55], v[168:171]
v_cvt_pk_bf16_f32 v240, v244, v245
v_cvt_pk_bf16_f32 v241, v246, v247
v_mfma_f32_16x16x32_bf16 v[176:179], a[108:111], a[60:63], v[176:179]
ds_write_b128 v2, v[240:243] offset:31744
v_mfma_f32_16x16x32_bf16 v[176:179], a[104:107], a[56:59], v[176:179]
ds_read_b64_tr_b16 a[104:105], v6 offset:0
v_mov_b32 v246, v240
v_mfma_f32_16x16x32_bf16 v[180:183], a[112:115], a[56:59], v[180:183]
ds_read_b64_tr_b16 a[106:107], v6 offset:1024
v_mov_b32 v247, v241
v_mfma_f32_16x16x32_bf16 v[180:183], a[116:119], a[60:63], v[180:183]
ds_read_b64_tr_b16 a[108:109], v6 offset:8192
v_cvt_pk_bf16_f32 v235, v234, v235
v_mfma_f32_16x16x32_bf16 v[172:175], a[116:119], a[52:55], v[172:175]
ds_read_b64_tr_b16 a[110:111], v6 offset:9216
v_cvt_pk_bf16_f32 v234, v232, v233
v_mfma_f32_16x16x32_bf16 v[172:175], a[112:115], a[48:51], v[172:175]
v_cvt_pk_bf16_f32 v232, v236, v237
v_cvt_pk_bf16_f32 v233, v238, v239
v_mfma_f32_16x16x32_bf16 v[164:167], a[112:115], a[40:43], v[164:167]
ds_write_b128 v2, v[232:235] offset:23552
v_mfma_f32_16x16x32_bf16 v[164:167], a[116:119], a[44:47], v[164:167]
v_mov_b32 v238, v232
v_mov_b32 v239, v233
v_mfma_f32_16x16x32_bf16 v[156:159], a[116:119], a[36:39], v[156:159]
v_cvt_pk_bf16_f32 v227, v226, v227
v_cvt_pk_bf16_f32 v226, v224, v225
v_mfma_f32_16x16x32_bf16 v[156:159], a[112:115], a[32:35], v[156:159]
ds_read_b64_tr_b16 a[112:113], v6 offset:32768
v_cvt_pk_bf16_f32 v224, v228, v229
v_mfma_f32_16x16x32_bf16 v[24:27], a[72:75], a[0:3], v[24:27]
ds_read_b64_tr_b16 a[114:115], v6 offset:33792
v_cvt_pk_bf16_f32 v225, v230, v231
v_mfma_f32_16x16x32_bf16 v[24:27], a[76:79], a[4:7], v[24:27]
ds_write_b128 v2, v[224:227] offset:11264
v_mfma_f32_16x16x32_bf16 v[24:27], a[80:83], a[32:35], v[24:27]
ds_read_b64_tr_b16 a[116:117], v6 offset:40960
v_mov_b32 v230, v224
v_mfma_f32_16x16x32_bf16 v[24:27], a[84:87], a[36:39], v[24:27]
ds_read_b64_tr_b16 a[118:119], v6 offset:41984
v_mov_b32 v231, v225
v_mfma_f32_16x16x32_bf16 v[40:43], a[84:87], a[44:47], v[40:43]
v_cvt_pk_bf16_f32 v219, v218, v219
v_cvt_pk_bf16_f32 v218, v216, v217
v_mfma_f32_16x16x32_bf16 v[40:43], a[80:83], a[40:43], v[40:43]
v_cvt_pk_bf16_f32 v216, v220, v221
v_cvt_pk_bf16_f32 v217, v222, v223
v_mfma_f32_16x16x32_bf16 v[40:43], a[76:79], a[12:15], v[40:43]
ds_write_b128 v2, v[216:219] offset:3072
v_mfma_f32_16x16x32_bf16 v[40:43], a[72:75], a[8:11], v[40:43]
v_mov_b32 v222, v216
v_mov_b32 v223, v217
v_mfma_f32_16x16x32_bf16 v[56:59], a[72:75], a[16:19], v[56:59]
v_mfma_f32_16x16x32_bf16 v[56:59], a[76:79], a[20:23], v[56:59]
s_waitcnt lgkmcnt(0)
s_barrier
v_mfma_f32_16x16x32_bf16 v[56:59], a[80:83], a[48:51], v[56:59]
ds_read_b128 a[192:195], v17 offset:16384
v_cvt_pk_bf16_f32 v176, v176, v177
v_mfma_f32_16x16x32_bf16 v[56:59], a[84:87], a[52:55], v[56:59]
v_cvt_pk_bf16_f32 v177, v178, v179
v_cvt_pk_bf16_f32 v178, v180, v181
v_mfma_f32_16x16x32_bf16 v[72:75], a[84:87], a[60:63], v[72:75]
v_cvt_pk_bf16_f32 v179, v182, v183
v_cvt_pk_bf16_f32 v168, v168, v169
v_mfma_f32_16x16x32_bf16 v[72:75], a[80:83], a[56:59], v[72:75]
v_cvt_pk_bf16_f32 v169, v170, v171
v_cvt_pk_bf16_f32 v170, v172, v173
v_mfma_f32_16x16x32_bf16 v[72:75], a[76:79], a[28:31], v[72:75]
v_cvt_pk_bf16_f32 v171, v174, v175
v_cvt_pk_bf16_f32 v160, v160, v161
v_mfma_f32_16x16x32_bf16 v[72:75], a[72:75], a[24:27], v[72:75]
ds_read_b64_tr_b16 a[72:73], v7 offset:0
v_cvt_pk_bf16_f32 v161, v162, v163
v_mfma_f32_16x16x32_bf16 v[136:139], a[88:91], a[24:27], v[136:139]
s_waitcnt lgkmcnt(1)
buffer_store_dwordx4 a[192:195], v16, s[44:47], s74 offen sc1
v_mfma_f32_16x16x32_bf16 v[136:139], a[92:95], a[28:31], v[136:139]
ds_read_b64_tr_b16 a[74:75], v7 offset:1024
v_cvt_pk_bf16_f32 v162, v164, v165
v_mfma_f32_16x16x32_bf16 v[136:139], a[96:99], a[56:59], v[136:139]
ds_read_b64_tr_b16 a[76:77], v7 offset:8192
v_cvt_pk_bf16_f32 v163, v166, v167
v_mfma_f32_16x16x32_bf16 v[136:139], a[100:103], a[60:63], v[136:139]
s_sub_u32 s81, s3, 1
ds_read_b64_tr_b16 a[78:79], v7 offset:9216
v_cvt_pk_bf16_f32 v152, v152, v153
v_mfma_f32_16x16x32_bf16 v[120:123], a[100:103], a[52:55], v[120:123]
s_sub_u32 s67, s3, 2
ds_read_b64_tr_b16 a[80:81], v7 offset:32768
v_cvt_pk_bf16_f32 v153, v154, v155
v_mfma_f32_16x16x32_bf16 v[120:123], a[96:99], a[48:51], v[120:123]
s_mul_i32 s81, s81, s67
ds_read_b64_tr_b16 a[82:83], v7 offset:33792
v_cvt_pk_bf16_f32 v154, v156, v157
v_mfma_f32_16x16x32_bf16 v[120:123], a[92:95], a[20:23], v[120:123]
s_lshl4_add_u32 s81, s81, s31
ds_read_b64_tr_b16 a[84:85], v7 offset:40960
v_cvt_pk_bf16_f32 v155, v158, v159
v_mfma_f32_16x16x32_bf16 v[120:123], a[88:91], a[16:19], v[120:123]
s_lshl2_add_u32 s81, s81, s30
ds_read_b64_tr_b16 a[86:87], v7 offset:41984
v_or_b32 v20, s66, v252
v_mfma_f32_16x16x32_bf16 v[104:107], a[88:91], a[8:11], v[104:107]
s_mul_i32 s81, s81, 3328
ds_read_b128 a[180:183], v2 offset:8192
v_or_b32 v21, s66, v253
v_mfma_f32_16x16x32_bf16 v[104:107], a[92:95], a[12:15], v[104:107]
s_mov_b32 s73, 0
ds_read_b128 a[188:191], v2 offset:28672
v_or_b32 v22, s66, v254
v_mfma_f32_16x16x32_bf16 v[104:107], a[96:99], a[40:43], v[104:107]
s_mov_b32 s72, 0x20000
ds_read_b64 v[224:225], v2 offset:9224
v_or_b32 v23, s66, v255
v_mfma_f32_16x16x32_bf16 v[104:107], a[100:103], a[44:47], v[104:107]
s_mov_b32 s66, 0x3e8293ee
ds_read_b64 v[228:229], v2 offset:9216
v_mul_f32 v72, s68, v72
v_mfma_f32_16x16x32_bf16 v[88:91], a[100:103], a[36:39], v[88:91]
s_lshl_b32 s67, s31, 15
ds_read_b64 v[240:241], v2 offset:29704
v_mul_f32 v73, s68, v73
v_mfma_f32_16x16x32_bf16 v[88:91], a[96:99], a[32:35], v[88:91]
s_add_u32 s67, s67, s78
ds_read_b64 v[244:245], v2 offset:29696
v_mul_f32 v74, s68, v74
v_mfma_f32_16x16x32_bf16 v[88:91], a[92:95], a[4:7], v[88:91]
s_add_u32 s67, s67, 33554432
v_mul_f32 v75, s68, v75
v_mul_f32 v136, s68, v136
v_mfma_f32_16x16x32_bf16 v[88:91], a[88:91], a[0:3], v[88:91]
s_mul_i32 s74, s3, 1310720
ds_read_b64_tr_b16 a[88:89], v8 offset:0
v_mul_f32 v137, s68, v137
v_mfma_f32_16x16x32_bf16 v[28:31], a[104:107], a[0:3], v[28:31]
s_add_u32 s74, s74, s67
ds_read_b64_tr_b16 a[90:91], v8 offset:1024
v_mul_f32 v138, s68, v138
v_mfma_f32_16x16x32_bf16 v[28:31], a[108:111], a[4:7], v[28:31]
s_mul_i32 s75, s16, 1310720
ds_read_b64_tr_b16 a[92:93], v8 offset:8192
v_mul_f32 v139, s68, v139
v_mfma_f32_16x16x32_bf16 v[28:31], a[112:115], a[32:35], v[28:31]
s_add_u32 s75, s75, s67
ds_read_b64_tr_b16 a[94:95], v8 offset:9216
v_cvt_pk_bf16_f32 v72, v72, v73
v_mfma_f32_16x16x32_bf16 v[28:31], a[116:119], a[36:39], v[28:31]
s_mul_i32 s67, s31, 24576
ds_read_b64_tr_b16 a[96:97], v8 offset:32768
v_cvt_pk_bf16_f32 v73, v74, v75
v_mfma_f32_16x16x32_bf16 v[44:47], a[116:119], a[44:47], v[44:47]
s_sub_u32 s67, 1048576, s67
ds_read_b64_tr_b16 a[98:99], v8 offset:33792
v_cvt_pk_bf16_f32 v74, v136, v137
v_mfma_f32_16x16x32_bf16 v[44:47], a[112:115], a[40:43], v[44:47]
s_add_u32 s64, s74, s67
ds_read_b64_tr_b16 a[100:101], v8 offset:40960
v_cvt_pk_bf16_f32 v75, v138, v139
v_mfma_f32_16x16x32_bf16 v[44:47], a[108:111], a[12:15], v[44:47]
s_add_u32 s65, s75, s67
ds_read_b64_tr_b16 a[102:103], v8 offset:41984
v_mul_f32 v56, s68, v56
v_mfma_f32_16x16x32_bf16 v[44:47], a[104:107], a[8:11], v[44:47]
s_and_b32 s70, s30, 1
v_mul_f32 v57, s68, v57
v_mul_f32 v58, s68, v58
v_mfma_f32_16x16x32_bf16 v[60:63], a[104:107], a[16:19], v[60:63]
s_lshr_b32 s67, s30, 1
v_mul_f32 v59, s68, v59
v_mul_f32 v120, s68, v120
v_mfma_f32_16x16x32_bf16 v[60:63], a[108:111], a[20:23], v[60:63]
s_lshl3_add_u32 s71, s67, s70
v_mul_f32 v121, s68, v121
v_mul_f32 v122, s68, v122
v_mfma_f32_16x16x32_bf16 v[60:63], a[112:115], a[48:51], v[60:63]
s_add_u32 s71, s71, 4
v_mul_f32 v123, s68, v123
v_cvt_pk_bf16_f32 v56, v56, v57
v_mfma_f32_16x16x32_bf16 v[60:63], a[116:119], a[52:55], v[60:63]
s_lshl_b32 s71, s71, 13
v_cvt_pk_bf16_f32 v57, v58, v59
v_cvt_pk_bf16_f32 v58, v120, v121
v_mfma_f32_16x16x32_bf16 v[76:79], a[116:119], a[60:63], v[76:79]
s_lshl_b32 s70, s70, 14
v_cvt_pk_bf16_f32 v59, v122, v123
v_mul_f32 v40, s68, v40
v_mfma_f32_16x16x32_bf16 v[76:79], a[112:115], a[56:59], v[76:79]
s_mul_i32 s67, s67, 24576
v_mul_f32 v41, s68, v41
v_mul_f32 v42, s68, v42
v_mfma_f32_16x16x32_bf16 v[76:79], a[108:111], a[28:31], v[76:79]
s_sub_u32 s70, s70, s67
v_mul_f32 v43, s68, v43
v_mul_f32 v104, s68, v104
v_mfma_f32_16x16x32_bf16 v[76:79], a[104:107], a[24:27], v[76:79]
s_waitcnt lgkmcnt(1)
s_add_u32 s70, s70, 65536
ds_read_b64_tr_b16 a[104:105], v9 offset:0
v_mul_f32 v105, s68, v105
v_mfma_f32_16x16x32_bf16 v[140:143], a[72:75], a[24:27], v[140:143]
ds_read_b64_tr_b16 a[106:107], v9 offset:1024
v_mul_f32 v106, s68, v106
v_mfma_f32_16x16x32_bf16 v[140:143], a[76:79], a[28:31], v[140:143]
ds_read_b64_tr_b16 a[108:109], v9 offset:8192
v_mul_f32 v107, s68, v107
v_mfma_f32_16x16x32_bf16 v[140:143], a[80:83], a[56:59], v[140:143]
ds_read_b64_tr_b16 a[110:111], v9 offset:9216
v_cvt_pk_bf16_f32 v40, v40, v41
v_mfma_f32_16x16x32_bf16 v[140:143], a[84:87], a[60:63], v[140:143]
ds_read_b64_tr_b16 a[112:113], v9 offset:32768
v_cvt_pk_bf16_f32 v41, v42, v43
v_mfma_f32_16x16x32_bf16 v[124:127], a[84:87], a[52:55], v[124:127]
ds_read_b64_tr_b16 a[114:115], v9 offset:33792
v_cvt_pk_bf16_f32 v42, v104, v105
v_mfma_f32_16x16x32_bf16 v[124:127], a[80:83], a[48:51], v[124:127]
ds_read_b64_tr_b16 a[116:117], v9 offset:40960
v_cvt_pk_bf16_f32 v43, v106, v107
v_mfma_f32_16x16x32_bf16 v[124:127], a[76:79], a[20:23], v[124:127]
ds_read_b64_tr_b16 a[118:119], v9 offset:41984
v_mul_f32 v24, s68, v24
v_mfma_f32_16x16x32_bf16 v[124:127], a[72:75], a[16:19], v[124:127]
v_mul_f32 v25, s68, v25
v_mul_f32 v26, s68, v26
v_mfma_f32_16x16x32_bf16 v[108:111], a[72:75], a[8:11], v[108:111]
v_mul_f32 v27, s68, v27
v_mul_f32 v88, s68, v88
v_mfma_f32_16x16x32_bf16 v[108:111], a[76:79], a[12:15], v[108:111]
v_mul_f32 v89, s68, v89
v_mul_f32 v90, s68, v90
v_mfma_f32_16x16x32_bf16 v[108:111], a[80:83], a[40:43], v[108:111]
v_mul_f32 v91, s68, v91
v_cvt_pk_bf16_f32 v24, v24, v25
v_mfma_f32_16x16x32_bf16 v[108:111], a[84:87], a[44:47], v[108:111]
v_cvt_pk_bf16_f32 v25, v26, v27
v_cvt_pk_bf16_f32 v26, v88, v89
v_mfma_f32_16x16x32_bf16 v[92:95], a[84:87], a[36:39], v[92:95]
v_cvt_pk_bf16_f32 v27, v90, v91
v_mul_f32 v76, s68, v76
v_mfma_f32_16x16x32_bf16 v[92:95], a[80:83], a[32:35], v[92:95]
v_mul_f32 v77, s68, v77
v_mul_f32 v78, s68, v78
v_mfma_f32_16x16x32_bf16 v[92:95], a[76:79], a[4:7], v[92:95]
v_mul_f32 v79, s68, v79
v_mul_f32 v140, s68, v140
v_mfma_f32_16x16x32_bf16 v[92:95], a[72:75], a[0:3], v[92:95]
ds_read_b64_tr_b16 a[72:73], v10 offset:0
v_mul_f32 v141, s68, v141
v_mfma_f32_16x16x32_bf16 v[32:35], a[88:91], a[0:3], v[32:35]
ds_read_b64_tr_b16 a[74:75], v10 offset:1024
v_mul_f32 v142, s68, v142
v_mfma_f32_16x16x32_bf16 v[32:35], a[92:95], a[4:7], v[32:35]
ds_read_b64_tr_b16 a[76:77], v10 offset:8192
v_mul_f32 v143, s68, v143
v_mfma_f32_16x16x32_bf16 v[32:35], a[96:99], a[32:35], v[32:35]
s_waitcnt lgkmcnt(3)
ds_read_b64_tr_b16 a[78:79], v10 offset:9216
v_cvt_pk_bf16_f32 v76, v76, v77
v_mfma_f32_16x16x32_bf16 v[32:35], a[100:103], a[36:39], v[32:35]
ds_read_b64_tr_b16 a[80:81], v10 offset:32768
v_cvt_pk_bf16_f32 v77, v78, v79
v_mfma_f32_16x16x32_bf16 v[48:51], a[100:103], a[44:47], v[48:51]
ds_read_b64_tr_b16 a[82:83], v10 offset:33792
v_cvt_pk_bf16_f32 v78, v140, v141
v_mfma_f32_16x16x32_bf16 v[48:51], a[96:99], a[40:43], v[48:51]
ds_read_b64_tr_b16 a[84:85], v10 offset:40960
v_cvt_pk_bf16_f32 v79, v142, v143
v_mfma_f32_16x16x32_bf16 v[48:51], a[92:95], a[12:15], v[48:51]
ds_read_b64_tr_b16 a[86:87], v10 offset:41984
v_mul_f32 v60, s68, v60
v_mfma_f32_16x16x32_bf16 v[48:51], a[88:91], a[8:11], v[48:51]
v_mul_f32 v61, s68, v61
v_mul_f32 v62, s68, v62
v_mfma_f32_16x16x32_bf16 v[64:67], a[88:91], a[16:19], v[64:67]
v_mul_f32 v63, s68, v63
v_mul_f32 v124, s68, v124
v_mfma_f32_16x16x32_bf16 v[64:67], a[92:95], a[20:23], v[64:67]
v_mul_f32 v125, s68, v125
v_mul_f32 v126, s68, v126
v_mfma_f32_16x16x32_bf16 v[64:67], a[96:99], a[48:51], v[64:67]
buffer_load_dwordx4 v[136:139], v16, s[44:47], s77 offen sc1
v_mfma_f32_16x16x32_bf16 v[64:67], a[100:103], a[52:55], v[64:67]
v_mul_f32 v127, s68, v127
v_cvt_pk_bf16_f32 v60, v60, v61
v_mfma_f32_16x16x32_bf16 v[80:83], a[100:103], a[60:63], v[80:83]
v_cvt_pk_bf16_f32 v61, v62, v63
v_cvt_pk_bf16_f32 v62, v124, v125
v_mfma_f32_16x16x32_bf16 v[80:83], a[96:99], a[56:59], v[80:83]
v_cvt_pk_bf16_f32 v63, v126, v127
v_mul_f32 v44, s68, v44
v_mfma_f32_16x16x32_bf16 v[80:83], a[92:95], a[28:31], v[80:83]
v_mul_f32 v45, s68, v45
v_mul_f32 v46, s68, v46
v_mfma_f32_16x16x32_bf16 v[80:83], a[88:91], a[24:27], v[80:83]
ds_read_b64_tr_b16 a[88:89], v11 offset:0
v_mul_f32 v47, s68, v47
v_mfma_f32_16x16x32_bf16 v[144:147], a[104:107], a[24:27], v[144:147]
ds_read_b64_tr_b16 a[90:91], v11 offset:1024
v_mul_f32 v108, s68, v108
v_mfma_f32_16x16x32_bf16 v[144:147], a[108:111], a[28:31], v[144:147]
ds_read_b64_tr_b16 a[92:93], v11 offset:8192
v_mul_f32 v109, s68, v109
v_mfma_f32_16x16x32_bf16 v[144:147], a[112:115], a[56:59], v[144:147]
ds_read_b64_tr_b16 a[94:95], v11 offset:9216
v_mul_f32 v110, s68, v110
v_mfma_f32_16x16x32_bf16 v[144:147], a[116:119], a[60:63], v[144:147]
ds_read_b64_tr_b16 a[96:97], v11 offset:32768
v_mul_f32 v111, s68, v111
v_mfma_f32_16x16x32_bf16 v[128:131], a[116:119], a[52:55], v[128:131]
ds_read_b64_tr_b16 a[98:99], v11 offset:33792
v_cvt_pk_bf16_f32 v44, v44, v45
v_mfma_f32_16x16x32_bf16 v[128:131], a[112:115], a[48:51], v[128:131]
ds_read_b64_tr_b16 a[100:101], v11 offset:40960
v_cvt_pk_bf16_f32 v45, v46, v47
v_mfma_f32_16x16x32_bf16 v[128:131], a[108:111], a[20:23], v[128:131]
ds_read_b64_tr_b16 a[102:103], v11 offset:41984
v_cvt_pk_bf16_f32 v46, v108, v109
v_mfma_f32_16x16x32_bf16 v[128:131], a[104:107], a[16:19], v[128:131]
v_cvt_pk_bf16_f32 v47, v110, v111
v_mul_f32 v28, s68, v28
v_mfma_f32_16x16x32_bf16 v[112:115], a[104:107], a[8:11], v[112:115]
v_mul_f32 v29, s68, v29
v_mul_f32 v30, s68, v30
v_mfma_f32_16x16x32_bf16 v[112:115], a[108:111], a[12:15], v[112:115]
v_mul_f32 v31, s68, v31
v_mul_f32 v92, s68, v92
v_mfma_f32_16x16x32_bf16 v[112:115], a[112:115], a[40:43], v[112:115]
v_mul_f32 v93, s68, v93
v_mul_f32 v94, s68, v94
v_mfma_f32_16x16x32_bf16 v[112:115], a[116:119], a[44:47], v[112:115]
v_mul_f32 v95, s68, v95
v_cvt_pk_bf16_f32 v28, v28, v29
v_mfma_f32_16x16x32_bf16 v[96:99], a[116:119], a[36:39], v[96:99]
v_cvt_pk_bf16_f32 v29, v30, v31
v_cvt_pk_bf16_f32 v30, v92, v93
v_mfma_f32_16x16x32_bf16 v[96:99], a[112:115], a[32:35], v[96:99]
v_cvt_pk_bf16_f32 v31, v94, v95
v_mul_f32 v80, s68, v80
v_mfma_f32_16x16x32_bf16 v[96:99], a[108:111], a[4:7], v[96:99]
v_mul_f32 v81, s68, v81
v_mul_f32 v82, s68, v82
v_mfma_f32_16x16x32_bf16 v[96:99], a[104:107], a[0:3], v[96:99]
s_waitcnt lgkmcnt(1)
v_mul_f32 v83, s68, v83
v_mul_f32 v144, s68, v144
v_mfma_f32_16x16x32_bf16 v[36:39], a[72:75], a[0:3], v[36:39]
v_mul_f32 v145, s68, v145
v_mul_f32 v146, s68, v146
v_mfma_f32_16x16x32_bf16 v[36:39], a[76:79], a[4:7], v[36:39]
v_mul_f32 v147, s68, v147
v_cvt_pk_bf16_f32 v80, v80, v81
v_mfma_f32_16x16x32_bf16 v[36:39], a[80:83], a[32:35], v[36:39]
v_cvt_pk_bf16_f32 v81, v82, v83
v_cvt_pk_bf16_f32 v82, v144, v145
v_mfma_f32_16x16x32_bf16 v[36:39], a[84:87], a[36:39], v[36:39]
v_cvt_pk_bf16_f32 v83, v146, v147
v_mul_f32 v64, s68, v64
v_mfma_f32_16x16x32_bf16 v[52:55], a[84:87], a[44:47], v[52:55]
v_mul_f32 v65, s68, v65
v_mul_f32 v66, s68, v66
v_mfma_f32_16x16x32_bf16 v[52:55], a[80:83], a[40:43], v[52:55]
v_mul_f32 v67, s68, v67
v_mul_f32 v128, s68, v128
v_mfma_f32_16x16x32_bf16 v[52:55], a[76:79], a[12:15], v[52:55]
v_mul_f32 v129, s68, v129
v_mul_f32 v130, s68, v130
v_mfma_f32_16x16x32_bf16 v[52:55], a[72:75], a[8:11], v[52:55]
v_mul_f32 v131, s68, v131
v_cvt_pk_bf16_f32 v64, v64, v65
v_mfma_f32_16x16x32_bf16 v[68:71], a[72:75], a[16:19], v[68:71]
v_cvt_pk_bf16_f32 v65, v66, v67
v_cvt_pk_bf16_f32 v66, v128, v129
v_mfma_f32_16x16x32_bf16 v[68:71], a[76:79], a[20:23], v[68:71]
v_cvt_pk_bf16_f32 v67, v130, v131
v_mul_f32 v48, s68, v48
v_mfma_f32_16x16x32_bf16 v[68:71], a[80:83], a[48:51], v[68:71]
v_mul_f32 v49, s68, v49
v_mul_f32 v50, s68, v50
v_mfma_f32_16x16x32_bf16 v[68:71], a[84:87], a[52:55], v[68:71]
v_mul_f32 v51, s68, v51
v_mul_f32 v112, s68, v112
v_mfma_f32_16x16x32_bf16 v[84:87], a[84:87], a[60:63], v[84:87]
v_mul_f32 v113, s68, v113
v_mul_f32 v114, s68, v114
v_mfma_f32_16x16x32_bf16 v[84:87], a[80:83], a[56:59], v[84:87]
v_mul_f32 v115, s68, v115
v_cvt_pk_bf16_f32 v48, v48, v49
v_mfma_f32_16x16x32_bf16 v[84:87], a[76:79], a[28:31], v[84:87]
v_cvt_pk_bf16_f32 v49, v50, v51
v_cvt_pk_bf16_f32 v50, v112, v113
v_mfma_f32_16x16x32_bf16 v[84:87], a[72:75], a[24:27], v[84:87]
v_cvt_pk_bf16_f32 v51, v114, v115
v_mul_f32 v32, s68, v32
v_mfma_f32_16x16x32_bf16 v[148:151], a[88:91], a[24:27], v[148:151]
v_mul_f32 v33, s68, v33
v_mul_f32 v34, s68, v34
v_mfma_f32_16x16x32_bf16 v[148:151], a[92:95], a[28:31], v[148:151]
v_mul_f32 v35, s68, v35
v_mul_f32 v96, s68, v96
v_mfma_f32_16x16x32_bf16 v[148:151], a[96:99], a[56:59], v[148:151]
s_waitcnt lgkmcnt(0)
s_waitcnt vmcnt(0)
v_max3_u32 v1, v136, v137, v138
v_max_u32 v1, v1, v139
v_mfma_f32_16x16x32_bf16 v[148:151], a[100:103], a[60:63], v[148:151]
v_cmp_eq_u32 vcc, -1, v1
s_cbranch_vccnz L_hretry
L_hgo:
v_mfma_f32_16x16x32_bf16 v[132:135], a[100:103], a[52:55], v[132:135]
ds_write_b128 v17, v[136:139]
v_mfma_f32_16x16x32_bf16 v[132:135], a[96:99], a[48:51], v[132:135]
v_mul_f32 v97, s68, v97
v_mul_f32 v98, s68, v98
v_mfma_f32_16x16x32_bf16 v[132:135], a[92:95], a[20:23], v[132:135]
v_mul_f32 v99, s68, v99
v_cvt_pk_bf16_f32 v32, v32, v33
v_mfma_f32_16x16x32_bf16 v[132:135], a[88:91], a[16:19], v[132:135]
v_cvt_pk_bf16_f32 v33, v34, v35
v_cvt_pk_bf16_f32 v34, v96, v97
v_mfma_f32_16x16x32_bf16 v[116:119], a[88:91], a[8:11], v[116:119]
s_waitcnt lgkmcnt(0)
s_barrier
v_mfma_f32_16x16x32_bf16 v[116:119], a[92:95], a[12:15], v[116:119]
ds_read_b128 a[176:179], v2 offset:0
v_cvt_pk_bf16_f32 v35, v98, v99
v_mfma_f32_16x16x32_bf16 v[116:119], a[96:99], a[40:43], v[116:119]
ds_read_b128 a[184:187], v2 offset:20480
v_mfma_f32_16x16x32_bf16 v[116:119], a[100:103], a[44:47], v[116:119]
ds_read_b64 v[216:217], v2 offset:1032
v_mfma_f32_16x16x32_bf16 v[100:103], a[100:103], a[36:39], v[100:103]
ds_read_b64 v[220:221], v2 offset:1024
v_mfma_f32_16x16x32_bf16 v[100:103], a[96:99], a[32:35], v[100:103]
ds_read_b64 v[232:233], v2 offset:21512
v_mfma_f32_16x16x32_bf16 v[100:103], a[92:95], a[4:7], v[100:103]
ds_read_b64 v[236:237], v2 offset:21504
v_mfma_f32_16x16x32_bf16 v[100:103], a[88:91], a[0:3], v[100:103]
v_mfma_f32_16x16x32_bf16 v[196:199], v[192:195], v[160:163], v[248:251]
v_mfma_f32_16x16x32_bf16 v[212:215], v[208:211], v[176:179], v[248:251]
v_mfma_f32_16x16x32_bf16 v[188:191], v[184:187], v[152:155], v[248:251]
v_mfma_f32_16x16x32_bf16 v[204:207], v[200:203], v[168:171], v[248:251]
v_mfma_f32_16x16x32_bf16 v[164:167], a[180:183], v[160:163], v[252:255]
v_mfma_f32_16x16x32_bf16 v[180:183], a[188:191], v[176:179], v[252:255]
s_waitcnt lgkmcnt(5)
v_mfma_f32_16x16x32_bf16 v[156:159], a[176:179], v[152:155], v[20:23]
s_waitcnt lgkmcnt(4)
v_mfma_f32_16x16x32_bf16 v[172:175], a[184:187], v[168:171], v[252:255]
v_accvgpr_read_b32 v4, a64
v_accvgpr_read_b32 v5, a65
v_accvgpr_read_b32 v6, a66
v_accvgpr_read_b32 v7, a67
v_accvgpr_read_b32 v8, a68
s_branch L_po14
L_pg14:
s_branch L_pg18
L_po14:
v_accvgpr_read_b32 v9, a69
v_accvgpr_read_b32 v10, a70
v_accvgpr_read_b32 v11, a71
v_max3_f32 v121, v196, v197, v198
v_max3_f32 v121, v121, v199, v164
v_max3_f32 v121, v121, v165, v166
v_max_f32 v121, v121, v167
v_max3_f32 v123, v212, v213, v214
v_max3_f32 v123, v123, v215, v180
v_max3_f32 v123, v123, v181, v182
v_max_f32 v123, v123, v183
v_max3_f32 v120, v188, v189, v190
v_max3_f32 v120, v120, v191, v156
v_max3_f32 v120, v120, v157, v158
v_max_f32 v120, v120, v159
v_max3_f32 v122, v204, v205, v206
v_max3_f32 v122, v122, v207, v172
v_max3_f32 v122, v122, v173, v174
v_max_f32 v122, v122, v175
v_mov_b32 v105, v121
v_mov_b32 v107, v123
v_mov_b32 v104, v120
v_mov_b32 v106, v122
v_permlane16_swap_b32 v105, v121
v_permlane16_swap_b32 v107, v123
v_permlane16_swap_b32 v104, v120
v_permlane16_swap_b32 v106, v122
v_max_f32 v121, v121, v105
v_max_f32 v123, v123, v107
v_max_f32 v120, v120, v104
v_max_f32 v122, v122, v106
v_mov_b32 v105, v121
v_mov_b32 v107, v123
v_mov_b32 v104, v120
v_mov_b32 v106, v122
v_permlane32_swap_b32 v105, v121
v_permlane32_swap_b32 v107, v123
v_permlane32_swap_b32 v104, v120
v_permlane32_swap_b32 v106, v122
v_max_f32 v121, v121, v105
v_max_f32 v123, v123, v107
v_max_f32 v120, v120, v104
v_max_f32 v122, v122, v106
v_mul_f32 v121, s66, v121
v_mul_f32 v123, s66, v123
v_mul_f32 v120, s66, v120
v_mul_f32 v122, s66, v122
v_fma_f32 v164, v164, s66, -v121
v_fma_f32 v165, v165, s66, -v121
v_fma_f32 v166, v166, s66, -v121
v_fma_f32 v167, v167, s66, -v121
v_fma_f32 v196, v196, s66, -v121
v_fma_f32 v197, v197, s66, -v121
v_fma_f32 v198, v198, s66, -v121
v_fma_f32 v199, v199, s66, -v121
v_exp_f32 v164, v164
v_exp_f32 v165, v165
v_exp_f32 v166, v166
v_exp_f32 v167, v167
v_exp_f32 v196, v196
v_exp_f32 v197, v197
v_exp_f32 v198, v198
v_exp_f32 v199, v199
v_cvt_pk_bf16_f32 v164, v164, v165
v_cvt_pk_bf16_f32 v165, v166, v167
v_cvt_pk_bf16_f32 v166, v196, v197
v_cvt_pk_bf16_f32 v167, v198, v199
v_pk_mul_f32 v[36:37], v[36:37], s[68:69]
v_pk_mul_f32 v[38:39], v[38:39], s[68:69]
v_mfma_f32_16x16x32_bf16 v[196:199], a[244:247], v[164:167], 0
v_mfma_f32_16x16x32_bf16 v[160:163], v[224:227], v[164:167], 0
v_mfma_f32_16x16x32_bf16 v[192:195], v[228:231], v[164:167], 0
v_fma_f32 v180, v180, s66, -v123
v_fma_f32 v181, v181, s66, -v123
v_fma_f32 v182, v182, s66, -v123
v_fma_f32 v183, v183, s66, -v123
v_fma_f32 v212, v212, s66, -v123
v_fma_f32 v213, v213, s66, -v123
v_fma_f32 v214, v214, s66, -v123
v_fma_f32 v215, v215, s66, -v123
v_exp_f32 v180, v180
v_exp_f32 v181, v181
v_exp_f32 v182, v182
v_exp_f32 v183, v183
v_exp_f32 v212, v212
v_exp_f32 v213, v213
v_exp_f32 v214, v214
v_exp_f32 v215, v215
v_cvt_pk_bf16_f32 v180, v180, v181
v_cvt_pk_bf16_f32 v181, v182, v183
v_cvt_pk_bf16_f32 v182, v212, v213
v_cvt_pk_bf16_f32 v183, v214, v215
v_pk_mul_f32 v[100:101], v[100:101], s[68:69]
v_pk_mul_f32 v[102:103], v[102:103], s[68:69]
v_mfma_f32_16x16x32_bf16 v[212:215], a[244:247], v[180:183], 0
v_mfma_f32_16x16x32_bf16 v[176:179], v[240:243], v[180:183], 0
v_mfma_f32_16x16x32_bf16 v[208:211], v[244:247], v[180:183], 0
v_fma_f32 v156, v156, s66, -v120
v_fma_f32 v157, v157, s66, -v120
v_fma_f32 v158, v158, s66, -v120
v_fma_f32 v159, v159, s66, -v120
v_fma_f32 v188, v188, s66, -v120
v_fma_f32 v189, v189, s66, -v120
v_fma_f32 v190, v190, s66, -v120
v_fma_f32 v191, v191, s66, -v120
v_exp_f32 v156, v156
v_exp_f32 v157, v157
v_exp_f32 v158, v158
v_exp_f32 v159, v159
v_exp_f32 v188, v188
v_exp_f32 v189, v189
v_exp_f32 v190, v190
v_exp_f32 v191, v191
v_cvt_pk_bf16_f32 v156, v156, v157
v_cvt_pk_bf16_f32 v157, v158, v159
v_cvt_pk_bf16_f32 v158, v188, v189
v_cvt_pk_bf16_f32 v159, v190, v191
v_cvt_pk_bf16_f32 v36, v36, v37
v_cvt_pk_bf16_f32 v37, v38, v39
v_mfma_f32_16x16x32_bf16 v[188:191], a[244:247], v[156:159], 0
s_waitcnt lgkmcnt(3)
v_mfma_f32_16x16x32_bf16 v[152:155], v[216:219], v[156:159], 0
s_waitcnt lgkmcnt(2)
v_mfma_f32_16x16x32_bf16 v[184:187], v[220:223], v[156:159], 0
v_fma_f32 v172, v172, s66, -v122
v_fma_f32 v173, v173, s66, -v122
v_fma_f32 v174, v174, s66, -v122
v_fma_f32 v175, v175, s66, -v122
v_fma_f32 v204, v204, s66, -v122
v_fma_f32 v205, v205, s66, -v122
v_fma_f32 v206, v206, s66, -v122
v_fma_f32 v207, v207, s66, -v122
v_exp_f32 v172, v172
v_exp_f32 v173, v173
v_exp_f32 v174, v174
v_exp_f32 v175, v175
v_exp_f32 v204, v204
v_exp_f32 v205, v205
v_exp_f32 v206, v206
v_exp_f32 v207, v207
v_cvt_pk_bf16_f32 v172, v172, v173
v_cvt_pk_bf16_f32 v173, v174, v175
v_cvt_pk_bf16_f32 v174, v204, v205
v_cvt_pk_bf16_f32 v175, v206, v207
v_cvt_pk_bf16_f32 v38, v100, v101
v_cvt_pk_bf16_f32 v39, v102, v103
v_mfma_f32_16x16x32_bf16 v[204:207], a[244:247], v[172:175], 0
s_waitcnt lgkmcnt(1)
v_mfma_f32_16x16x32_bf16 v[168:171], v[232:235], v[172:175], 0
s_waitcnt lgkmcnt(0)
v_mfma_f32_16x16x32_bf16 v[200:203], v[236:239], v[172:175], 0
v_pk_mul_f32 v[52:53], v[52:53], s[68:69]
v_pk_mul_f32 v[54:55], v[54:55], s[68:69]
v_pk_mul_f32 v[116:117], v[116:117], s[68:69]
v_pk_mul_f32 v[118:119], v[118:119], s[68:69]
v_cvt_pk_bf16_f32 v52, v52, v53
v_cvt_pk_bf16_f32 v53, v54, v55
v_cvt_pk_bf16_f32 v54, v116, v117
v_cvt_pk_bf16_f32 v55, v118, v119
v_pk_mul_f32 v[68:69], v[68:69], s[68:69]
v_pk_mul_f32 v[70:71], v[70:71], s[68:69]
v_pk_mul_f32 v[132:133], v[132:133], s[68:69]
v_pk_mul_f32 v[134:135], v[134:135], s[68:69]
v_cvt_pk_bf16_f32 v68, v68, v69
v_cvt_pk_bf16_f32 v69, v70, v71
v_cvt_pk_bf16_f32 v70, v132, v133
v_cvt_pk_bf16_f32 v71, v134, v135
v_pk_mul_f32 v[84:85], v[84:85], s[68:69]
v_pk_mul_f32 v[86:87], v[86:87], s[68:69]
v_pk_mul_f32 v[148:149], v[148:149], s[68:69]
v_pk_mul_f32 v[150:151], v[150:151], s[68:69]
v_cvt_pk_bf16_f32 v84, v84, v85
v_cvt_pk_bf16_f32 v85, v86, v87
v_cvt_pk_bf16_f32 v86, v148, v149
v_cvt_pk_bf16_f32 v87, v150, v151
v_rcp_f32 v121, v196
v_rcp_f32 v123, v212
v_rcp_f32 v120, v188
v_rcp_f32 v122, v204
v_mul_f32 v121, v121, v7
v_mul_f32 v123, v123, v11
v_mul_f32 v120, v120, v5
v_mul_f32 v122, v122, v9
v_pk_mul_f32 v[152:153], v[152:153], v[120:121] op_sel_hi:[1,0]
v_pk_mul_f32 v[154:155], v[154:155], v[120:121] op_sel_hi:[1,0]
v_pk_mul_f32 v[184:185], v[184:185], v[120:121] op_sel_hi:[1,0]
v_pk_mul_f32 v[186:187], v[186:187], v[120:121] op_sel_hi:[1,0]
v_cvt_pk_bf16_f32 v152, v152, v153
v_cvt_pk_bf16_f32 v153, v154, v155
v_cvt_pk_bf16_f32 v154, v184, v185
v_cvt_pk_bf16_f32 v155, v186, v187
buffer_store_dwordx4 v[152:155], v16, s[44:47], s64 offen sc1
v_mov_b32 v2, v16
v_add_u32 v3, 0x10000, v16
v_mov_b32 v1, 0
s_mov_b32 m0, s71
s_waitcnt lgkmcnt(0)
s_barrier
ds_read_b128 a[144:147], v2 offset:0
ds_read_b128 a[148:151], v2 offset:1024
ds_read_b128 a[152:155], v2 offset:2048
ds_read_b128 a[156:159], v2 offset:3072
ds_read_b128 a[160:163], v2 offset:4096
ds_read_b128 a[164:167], v2 offset:5120
ds_read_b128 a[168:171], v2 offset:6144
ds_read_b128 a[172:175], v2 offset:7168
buffer_load_dwordx4 v16, s[32:35], s70 offen offset:0 sc1 lds
buffer_load_dwordx4 v16, s[32:35], s70 offen offset:1024 sc1 lds
v_pk_mul_f32 v[168:169], v[168:169], v[122:123] op_sel_hi:[1,0]
v_pk_mul_f32 v[170:171], v[170:171], v[122:123] op_sel_hi:[1,0]
v_pk_mul_f32 v[200:201], v[200:201], v[122:123] op_sel_hi:[1,0]
v_pk_mul_f32 v[202:203], v[202:203], v[122:123] op_sel_hi:[1,0]
v_cvt_pk_bf16_f32 v168, v168, v169
v_cvt_pk_bf16_f32 v169, v170, v171
v_cvt_pk_bf16_f32 v170, v200, v201
v_cvt_pk_bf16_f32 v171, v202, v203
buffer_store_dwordx4 v[168:171], v16, s[44:47], s65 offen sc1
v_pk_mul_f32 v[160:161], v[160:161], v[120:121] op_sel:[0,1]
v_pk_mul_f32 v[162:163], v[162:163], v[120:121] op_sel:[0,1]
v_pk_mul_f32 v[192:193], v[192:193], v[120:121] op_sel:[0,1]
v_pk_mul_f32 v[194:195], v[194:195], v[120:121] op_sel:[0,1]
v_cvt_pk_bf16_f32 v160, v160, v161
v_cvt_pk_bf16_f32 v161, v162, v163
v_cvt_pk_bf16_f32 v162, v192, v193
v_cvt_pk_bf16_f32 v163, v194, v195
s_add_u32 s64, s64, 4096
buffer_store_dwordx4 v[160:163], v16, s[44:47], s64 offen sc1
v_pk_mul_f32 v[176:177], v[176:177], v[122:123] op_sel:[0,1]
v_pk_mul_f32 v[178:179], v[178:179], v[122:123] op_sel:[0,1]
v_pk_mul_f32 v[208:209], v[208:209], v[122:123] op_sel:[0,1]
v_pk_mul_f32 v[210:211], v[210:211], v[122:123] op_sel:[0,1]
v_cvt_pk_bf16_f32 v176, v176, v177
v_cvt_pk_bf16_f32 v177, v178, v179
v_cvt_pk_bf16_f32 v178, v208, v209
v_cvt_pk_bf16_f32 v179, v210, v211
s_add_u32 s65, s65, 4096
buffer_store_dwordx4 v[176:179], v16, s[44:47], s65 offen sc1
v_mov_b32 v17, 0xff800000
v_and_b32 v5, 1, v0
v_mul_u32_u24 v5, 0xaaaa, v5
v_add_u32 v5, 0x4444, v5
v_lshl_or_b32 v5, v5, 16, v5
L_attstart_7:
s_cmp_eq_u32 s3, 0
s_cbranch_scc1 L_F1
s_waitcnt lgkmcnt(7)
v_mfma_f32_16x16x32_bf16 v[88:91], a[144:147], v[24:27], 0
s_waitcnt lgkmcnt(6)
ds_read_b128 a[176:179], v2 offset:8192
v_accvgpr_write_b32 a128, 0
v_mfma_f32_16x16x32_bf16 v[88:91], a[148:151], v[28:31], v[88:91]
s_waitcnt lgkmcnt(6)
ds_read_b128 a[180:183], v2 offset:9216
v_accvgpr_write_b32 a129, 0
v_mfma_f32_16x16x32_bf16 v[88:91], a[152:155], v[32:35], v[88:91]
s_waitcnt lgkmcnt(6)
buffer_load_dwordx4 v16, s[32:35], s70 offen offset:2048 sc1 lds
v_mfma_f32_16x16x32_bf16 v[88:91], a[156:159], v[36:39], v[88:91]
ds_read_b128 a[184:187], v2 offset:10240
v_accvgpr_write_b32 a130, 0
v_mfma_f32_16x16x32_bf16 v[104:107], a[156:159], v[52:55], 0
ds_read_b128 a[188:191], v2 offset:11264
v_accvgpr_write_b32 a131, 0
v_mfma_f32_16x16x32_bf16 v[104:107], a[152:155], v[48:51], v[104:107]
ds_read_b128 a[192:195], v2 offset:12288
v_accvgpr_write_b32 a132, 0
v_mfma_f32_16x16x32_bf16 v[104:107], a[148:151], v[44:47], v[104:107]
ds_read_b128 a[196:199], v2 offset:13312
v_accvgpr_write_b32 a133, 0
v_mfma_f32_16x16x32_bf16 v[104:107], a[144:147], v[40:43], v[104:107]
ds_read_b128 a[200:203], v2 offset:14336
v_accvgpr_write_b32 a134, 0
v_mfma_f32_16x16x32_bf16 v[120:123], a[144:147], v[56:59], 0
ds_read_b128 a[204:207], v2 offset:15360
v_accvgpr_write_b32 a135, 0
v_mfma_f32_16x16x32_bf16 v[120:123], a[148:151], v[60:63], v[120:123]
buffer_load_dwordx4 v16, s[32:35], s70 offen offset:3072 sc1 lds
v_mfma_f32_16x16x32_bf16 v[120:123], a[152:155], v[64:67], v[120:123]
v_accvgpr_write_b32 a136, 0
v_accvgpr_write_b32 a137, 0
v_mfma_f32_16x16x32_bf16 v[120:123], a[156:159], v[68:71], v[120:123]
v_accvgpr_write_b32 a138, 0
v_accvgpr_write_b32 a139, 0
v_mfma_f32_16x16x32_bf16 v[136:139], a[156:159], v[84:87], 0
v_accvgpr_write_b32 a140, 0
v_accvgpr_write_b32 a141, 0
v_mfma_f32_16x16x32_bf16 v[136:139], a[152:155], v[80:83], v[136:139]
v_accvgpr_write_b32 a142, 0
v_accvgpr_write_b32 a143, 0
v_mfma_f32_16x16x32_bf16 v[136:139], a[148:151], v[76:79], v[136:139]
v_mfma_f32_16x16x32_bf16 v[136:139], a[144:147], v[72:75], v[136:139]
s_waitcnt lgkmcnt(0)
s_nop 1
v_max3_f32 v20, v88, v89, v90
v_max_f32 v20, v20, v91
v_max3_f32 v21, v104, v105, v106
v_max_f32 v21, v21, v107
v_max3_f32 v22, v120, v121, v122
v_max_f32 v22, v22, v123
v_max3_f32 v23, v136, v137, v138
v_max_f32 v23, v23, v139
v_mov_b32 v248, v20
v_mov_b32 v249, v21
v_mov_b32 v250, v22
v_mov_b32 v251, v23
v_permlane16_swap_b32 v248, v20
v_permlane16_swap_b32 v249, v21
v_permlane16_swap_b32 v250, v22
v_permlane16_swap_b32 v251, v23
v_max_f32 v20, v20, v248
v_max_f32 v21, v21, v249
v_max_f32 v22, v22, v250
v_max_f32 v23, v23, v251
v_mov_b32 v248, v20
v_mov_b32 v249, v21
v_mov_b32 v250, v22
v_mov_b32 v251, v23
v_permlane32_swap_b32 v248, v20
v_permlane32_swap_b32 v249, v21
v_permlane32_swap_b32 v250, v22
v_permlane32_swap_b32 v251, v23
v_max_f32 v20, v20, v248
v_max_f32 v21, v21, v249
v_max_f32 v22, v22, v250
v_max_f32 v23, v23, v251
s_cmp_eq_u32 s73, 0
s_cselect_b64 vcc, 0, -1
v_cndmask_b32 v20, v20, v252, vcc
v_cndmask_b32 v21, v21, v253, vcc
v_cndmask_b32 v22, v22, v254, vcc
v_cndmask_b32 v23, v23, v255, vcc
v_sub_f32 v228, 0, v23
v_sub_f32 v229, 0, v23
v_sub_f32 v230, 0, v23
v_sub_f32 v231, 0, v23
v_sub_f32 v224, 0, v22
v_sub_f32 v225, 0, v22
v_sub_f32 v226, 0, v22
v_sub_f32 v227, 0, v22
v_sub_f32 v220, 0, v21
v_sub_f32 v221, 0, v21
v_sub_f32 v222, 0, v21
v_sub_f32 v223, 0, v21
v_sub_f32 v216, 0, v20
v_sub_f32 v217, 0, v20
v_sub_f32 v218, 0, v20
v_sub_f32 v219, 0, v20
v_mfma_f32_16x16x32_bf16 v[140:143], a[160:163], v[72:75], v[228:231]
s_add_u32 m0, s71, 4096
v_add_f32 v88, v88, v216
v_add_f32 v89, v89, v216
v_mfma_f32_16x16x32_bf16 v[140:143], a[164:167], v[76:79], v[140:143]
v_add_f32 v90, v90, v216
v_add_f32 v91, v91, v216
v_exp_f32 v88, v88
v_mfma_f32_16x16x32_bf16 v[140:143], a[168:171], v[80:83], v[140:143]
s_add_u32 s64, s70, 4096
v_exp_f32 v89, v89
v_mfma_f32_16x16x32_bf16 v[140:143], a[172:175], v[84:87], v[140:143]
buffer_load_dwordx4 v16, s[32:35], s64 offen offset:0 sc1 lds
v_mfma_f32_16x16x32_bf16 v[124:127], a[172:175], v[68:71], v[224:227]
v_exp_f32 v90, v90
v_mfma_f32_16x16x32_bf16 v[124:127], a[168:171], v[64:67], v[124:127]
v_exp_f32 v91, v91
v_mfma_f32_16x16x32_bf16 v[124:127], a[164:167], v[60:63], v[124:127]
v_add_f32 v104, v104, v220
v_add_f32 v105, v105, v220
v_add_f32 v106, v106, v220
v_add_f32 v107, v107, v220
v_exp_f32 v104, v104
v_mfma_f32_16x16x32_bf16 v[124:127], a[160:163], v[56:59], v[124:127]
v_exp_f32 v105, v105
v_mfma_f32_16x16x32_bf16 v[108:111], a[160:163], v[40:43], v[220:223]
v_exp_f32 v106, v106
v_mfma_f32_16x16x32_bf16 v[108:111], a[164:167], v[44:47], v[108:111]
buffer_load_dwordx4 v16, s[32:35], s64 offen offset:1024 sc1 lds
v_mfma_f32_16x16x32_bf16 v[108:111], a[168:171], v[48:51], v[108:111]
v_cvt_pk_bf16_f32 v152, v88, v89
v_add_f32 v120, v120, v224
v_mfma_f32_16x16x32_bf16 v[108:111], a[172:175], v[52:55], v[108:111]
v_exp_f32 v107, v107
v_mfma_f32_16x16x32_bf16 v[92:95], a[172:175], v[36:39], v[216:219]
v_add_f32 v121, v121, v224
v_add_f32 v122, v122, v224
v_add_f32 v123, v123, v224
v_exp_f32 v120, v120
v_mfma_f32_16x16x32_bf16 v[92:95], a[168:171], v[32:35], v[92:95]
v_cvt_pk_bf16_f32 v153, v90, v91
v_exp_f32 v121, v121
v_mfma_f32_16x16x32_bf16 v[92:95], a[164:167], v[28:31], v[92:95]
v_exp_f32 v122, v122
v_mfma_f32_16x16x32_bf16 v[92:95], a[160:163], v[24:27], v[92:95]
v_exp_f32 v123, v123
v_mfma_f32_16x16x32_bf16 v[96:99], a[176:179], v[24:27], v[216:219]
v_cvt_pk_bf16_f32 v160, v104, v105
v_add_f32 v136, v136, v228
v_mfma_f32_16x16x32_bf16 v[96:99], a[180:183], v[28:31], v[96:99]
buffer_load_dwordx4 v16, s[32:35], s64 offen offset:2048 sc1 lds
v_add_f32 v137, v137, v228
v_add_f32 v138, v138, v228
v_add_f32 v139, v139, v228
v_exp_f32 v136, v136
v_mfma_f32_16x16x32_bf16 v[96:99], a[184:187], v[32:35], v[96:99]
v_exp_f32 v137, v137
v_mfma_f32_16x16x32_bf16 v[96:99], a[188:191], v[36:39], v[96:99]
v_cvt_pk_bf16_f32 v161, v106, v107
v_cvt_pk_bf16_f32 v184, v120, v121
v_mfma_f32_16x16x32_bf16 v[112:115], a[188:191], v[52:55], v[220:223]
v_exp_f32 v138, v138
v_mfma_f32_16x16x32_bf16 v[112:115], a[184:187], v[48:51], v[112:115]
v_exp_f32 v139, v139
v_mfma_f32_16x16x32_bf16 v[112:115], a[180:183], v[44:47], v[112:115]
v_exp_f32 v140, v140
v_mfma_f32_16x16x32_bf16 v[112:115], a[176:179], v[40:43], v[112:115]
v_exp_f32 v141, v141
v_mfma_f32_16x16x32_bf16 v[128:131], a[176:179], v[56:59], v[224:227]
buffer_load_dwordx4 v16, s[32:35], s64 offen offset:3072 sc1 lds
v_cvt_pk_bf16_f32 v185, v122, v123
v_mfma_f32_16x16x32_bf16 v[128:131], a[180:183], v[60:63], v[128:131]
v_exp_f32 v142, v142
v_mfma_f32_16x16x32_bf16 v[128:131], a[184:187], v[64:67], v[128:131]
v_exp_f32 v143, v143
v_mfma_f32_16x16x32_bf16 v[128:131], a[188:191], v[68:71], v[128:131]
v_cvt_pk_bf16_f32 v192, v136, v137
v_cvt_pk_bf16_f32 v193, v138, v139
v_mfma_f32_16x16x32_bf16 v[144:147], a[188:191], v[84:87], v[228:231]
v_exp_f32 v124, v124
v_mfma_f32_16x16x32_bf16 v[144:147], a[184:187], v[80:83], v[144:147]
v_exp_f32 v125, v125
v_mfma_f32_16x16x32_bf16 v[144:147], a[180:183], v[76:79], v[144:147]
s_waitcnt vmcnt(6)
s_barrier
v_mfma_f32_16x16x32_bf16 v[144:147], a[176:179], v[72:75], v[144:147]
v_exp_f32 v126, v126
v_mfma_f32_16x16x32_bf16 v[148:151], a[192:195], v[72:75], v[228:231]
v_cvt_pk_bf16_f32 v194, v140, v141
v_cvt_pk_bf16_f32 v195, v142, v143
v_mfma_f32_16x16x32_bf16 v[148:151], a[196:199], v[76:79], v[148:151]
v_exp_f32 v127, v127
v_mfma_f32_16x16x32_bf16 v[148:151], a[200:203], v[80:83], v[148:151]
s_xor_b32 s71, s71, 16384
v_exp_f32 v108, v108
v_mfma_f32_16x16x32_bf16 v[148:151], a[204:207], v[84:87], v[148:151]
s_add_u32 s70, s70, 32768
v_exp_f32 v109, v109
v_mfma_f32_16x16x32_bf16 v[132:135], a[204:207], v[68:71], v[224:227]
s_mov_b32 m0, s71
v_exp_f32 v110, v110
v_mfma_f32_16x16x32_bf16 v[132:135], a[200:203], v[64:67], v[132:135]
buffer_load_dwordx4 v16, s[32:35], s70 offen offset:0 sc1 lds
v_mfma_f32_16x16x32_bf16 v[132:135], a[196:199], v[60:63], v[132:135]
v_cvt_pk_bf16_f32 v186, v124, v125
v_exp_f32 v111, v111
v_mfma_f32_16x16x32_bf16 v[132:135], a[192:195], v[56:59], v[132:135]
v_exp_f32 v92, v92
v_mfma_f32_16x16x32_bf16 v[116:119], a[192:195], v[40:43], v[220:223]
v_exp_f32 v93, v93
v_mfma_f32_16x16x32_bf16 v[116:119], a[196:199], v[44:47], v[116:119]
ds_read_b128 a[144:147], v2 offset:16384
v_cvt_pk_bf16_f32 v187, v126, v127
v_mfma_f32_16x16x32_bf16 v[116:119], a[200:203], v[48:51], v[116:119]
v_exp_f32 v94, v94
v_mfma_f32_16x16x32_bf16 v[116:119], a[204:207], v[52:55], v[116:119]
ds_read_b128 a[148:151], v2 offset:17408
v_cvt_pk_bf16_f32 v162, v108, v109
v_mfma_f32_16x16x32_bf16 v[100:103], a[204:207], v[36:39], v[216:219]
ds_read_b128 a[152:155], v2 offset:18432
buffer_load_dwordx4 v16, s[32:35], s70 offen offset:1024 sc1 lds
v_exp_f32 v95, v95
v_mfma_f32_16x16x32_bf16 v[100:103], a[200:203], v[32:35], v[100:103]
ds_read_b128 a[156:159], v2 offset:19456
v_exp_f32 v96, v96
v_mfma_f32_16x16x32_bf16 v[100:103], a[196:199], v[28:31], v[100:103]
v_cvt_pk_bf16_f32 v163, v110, v111
v_exp_f32 v97, v97
v_mfma_f32_16x16x32_bf16 v[100:103], a[192:195], v[24:27], v[100:103]
s_waitcnt lgkmcnt(3)
ds_read_b128 a[160:163], v2 offset:20480
ds_read_b128 a[164:167], v2 offset:21504
ds_read_b128 a[168:171], v2 offset:22528
ds_read_b128 a[172:175], v2 offset:23552
v_mfma_f32_16x16x32_bf16 v[88:91], a[144:147], v[24:27], v[216:219]
s_waitcnt lgkmcnt(6)
v_exp_f32 v98, v98
v_mfma_f32_16x16x32_bf16 v[88:91], a[148:151], v[28:31], v[88:91]
s_waitcnt lgkmcnt(5)
v_cvt_pk_bf16_f32 v154, v92, v93
v_exp_f32 v99, v99
v_mfma_f32_16x16x32_bf16 v[88:91], a[152:155], v[32:35], v[88:91]
s_waitcnt lgkmcnt(4)
v_exp_f32 v112, v112
v_mfma_f32_16x16x32_bf16 v[88:91], a[156:159], v[36:39], v[88:91]
v_exp_f32 v113, v113
v_mfma_f32_16x16x32_bf16 v[104:107], a[156:159], v[52:55], v[220:223]
v_cvt_pk_bf16_f32 v155, v94, v95
v_cvt_pk_bf16_f32 v156, v96, v97
v_mfma_f32_16x16x32_bf16 v[104:107], a[152:155], v[48:51], v[104:107]
buffer_load_dwordx4 v16, s[32:35], s70 offen offset:2048 sc1 lds
v_exp_f32 v114, v114
v_mfma_f32_16x16x32_bf16 v[104:107], a[148:151], v[44:47], v[104:107]
v_exp_f32 v115, v115
v_mfma_f32_16x16x32_bf16 v[104:107], a[144:147], v[40:43], v[104:107]
v_exp_f32 v128, v128
v_mfma_f32_16x16x32_bf16 v[120:123], a[144:147], v[56:59], v[224:227]
v_exp_f32 v129, v129
v_mfma_f32_16x16x32_bf16 v[120:123], a[148:151], v[60:63], v[120:123]
v_cvt_pk_bf16_f32 v157, v98, v99
v_cvt_pk_bf16_f32 v164, v112, v113
v_mfma_f32_16x16x32_bf16 v[120:123], a[152:155], v[64:67], v[120:123]
v_exp_f32 v130, v130
v_mfma_f32_16x16x32_bf16 v[120:123], a[156:159], v[68:71], v[120:123]
v_exp_f32 v131, v131
v_mfma_f32_16x16x32_bf16 v[136:139], a[156:159], v[84:87], v[228:231]
v_exp_f32 v144, v144
v_mfma_f32_16x16x32_bf16 v[136:139], a[152:155], v[80:83], v[136:139]
v_exp_f32 v145, v145
v_mfma_f32_16x16x32_bf16 v[136:139], a[148:151], v[76:79], v[136:139]
v_exp_f32 v146, v146
v_mfma_f32_16x16x32_bf16 v[136:139], a[144:147], v[72:75], v[136:139]
s_waitcnt lgkmcnt(0)
v_cvt_pk_bf16_f32 v165, v114, v115
v_cvt_pk_bf16_f32 v188, v128, v129
v_mfma_f32_16x16x32_bf16 v[140:143], a[160:163], v[72:75], v[228:231]
v_exp_f32 v147, v147
v_mfma_f32_16x16x32_bf16 v[140:143], a[164:167], v[76:79], v[140:143]
v_exp_f32 v148, v148
v_mfma_f32_16x16x32_bf16 v[140:143], a[168:171], v[80:83], v[140:143]
v_exp_f32 v149, v149
v_mfma_f32_16x16x32_bf16 v[140:143], a[172:175], v[84:87], v[140:143]
buffer_load_dwordx4 v16, s[32:35], s70 offen offset:3072 sc1 lds
v_mfma_f32_16x16x32_bf16 v[124:127], a[172:175], v[68:71], v[224:227]
v_cvt_pk_bf16_f32 v189, v130, v131
v_cvt_pk_bf16_f32 v196, v144, v145
v_mfma_f32_16x16x32_bf16 v[124:127], a[168:171], v[64:67], v[124:127]
v_exp_f32 v150, v150
v_mfma_f32_16x16x32_bf16 v[124:127], a[164:167], v[60:63], v[124:127]
v_exp_f32 v151, v151
v_mfma_f32_16x16x32_bf16 v[124:127], a[160:163], v[56:59], v[124:127]
v_exp_f32 v132, v132
v_mfma_f32_16x16x32_bf16 v[108:111], a[160:163], v[40:43], v[220:223]
ds_read_b128 a[176:179], v2 offset:24576
v_cvt_pk_bf16_f32 v197, v146, v147
v_mfma_f32_16x16x32_bf16 v[108:111], a[164:167], v[44:47], v[108:111]
ds_read_b128 a[180:183], v2 offset:25600
v_cvt_pk_bf16_f32 v198, v148, v149
v_mfma_f32_16x16x32_bf16 v[108:111], a[168:171], v[48:51], v[108:111]
ds_read_b128 a[184:187], v2 offset:26624
v_exp_f32 v133, v133
v_mfma_f32_16x16x32_bf16 v[108:111], a[172:175], v[52:55], v[108:111]
ds_read_b128 a[188:191], v2 offset:27648
v_exp_f32 v134, v134
v_mfma_f32_16x16x32_bf16 v[92:95], a[172:175], v[36:39], v[216:219]
v_exp_f32 v135, v135
v_mfma_f32_16x16x32_bf16 v[92:95], a[168:171], v[32:35], v[92:95]
v_exp_f32 v116, v116
v_mfma_f32_16x16x32_bf16 v[92:95], a[164:167], v[28:31], v[92:95]
v_exp_f32 v117, v117
v_mfma_f32_16x16x32_bf16 v[92:95], a[160:163], v[24:27], v[92:95]
s_waitcnt lgkmcnt(2)
v_cvt_pk_bf16_f32 v199, v150, v151
v_cvt_pk_bf16_f32 v190, v132, v133
v_mfma_f32_16x16x32_bf16 v[96:99], a[176:179], v[24:27], v[216:219]
v_exp_f32 v118, v118
v_mfma_f32_16x16x32_bf16 v[96:99], a[180:183], v[28:31], v[96:99]
s_waitcnt lgkmcnt(0)
s_add_u32 m0, s71, 4096
v_exp_f32 v119, v119
v_mfma_f32_16x16x32_bf16 v[96:99], a[184:187], v[32:35], v[96:99]
s_add_u32 s64, s70, 4096
v_exp_f32 v100, v100
v_mfma_f32_16x16x32_bf16 v[96:99], a[188:191], v[36:39], v[96:99]
buffer_load_dwordx4 v16, s[32:35], s64 offen offset:0 sc1 lds
v_mfma_f32_16x16x32_bf16 v[112:115], a[188:191], v[52:55], v[220:223]
v_exp_f32 v101, v101
v_mfma_f32_16x16x32_bf16 v[112:115], a[184:187], v[48:51], v[112:115]
v_cvt_pk_bf16_f32 v191, v134, v135
v_cvt_pk_bf16_f32 v166, v116, v117
v_mfma_f32_16x16x32_bf16 v[112:115], a[180:183], v[44:47], v[112:115]
v_exp_f32 v102, v102
v_mfma_f32_16x16x32_bf16 v[112:115], a[176:179], v[40:43], v[112:115]
v_exp_f32 v103, v103
v_mfma_f32_16x16x32_bf16 v[128:131], a[176:179], v[56:59], v[224:227]
s_lshl_b32 s66, s30, 30
ds_read_b128 a[192:195], v2 offset:28672
v_cvt_pk_bf16_f32 v167, v118, v119
v_mfma_f32_16x16x32_bf16 v[128:131], a[180:183], v[60:63], v[128:131]
ds_read_b128 a[196:199], v2 offset:29696
v_exp_f32 v88, v88
v_mfma_f32_16x16x32_bf16 v[128:131], a[184:187], v[64:67], v[128:131]
ds_read_b128 a[200:203], v2 offset:30720
v_exp_f32 v89, v89
v_mfma_f32_16x16x32_bf16 v[128:131], a[188:191], v[68:71], v[128:131]
ds_read_b128 a[204:207], v2 offset:31744
v_cvt_pk_bf16_f32 v158, v100, v101
v_mfma_f32_16x16x32_bf16 v[144:147], a[188:191], v[84:87], v[228:231]
v_exp_f32 v90, v90
v_mfma_f32_16x16x32_bf16 v[144:147], a[184:187], v[80:83], v[144:147]
v_exp_f32 v91, v91
v_mfma_f32_16x16x32_bf16 v[144:147], a[180:183], v[76:79], v[144:147]
v_exp_f32 v104, v104
v_mfma_f32_16x16x32_bf16 v[144:147], a[176:179], v[72:75], v[144:147]
s_waitcnt lgkmcnt(2)
v_exp_f32 v105, v105
v_mfma_f32_16x16x32_bf16 v[148:151], a[192:195], v[72:75], v[228:231]
v_cvt_pk_bf16_f32 v159, v102, v103
v_cvt_pk_bf16_f32 v168, v88, v89
v_mfma_f32_16x16x32_bf16 v[148:151], a[196:199], v[76:79], v[148:151]
s_waitcnt lgkmcnt(0)
v_exp_f32 v106, v106
v_mfma_f32_16x16x32_bf16 v[148:151], a[200:203], v[80:83], v[148:151]
v_exp_f32 v107, v107
v_mfma_f32_16x16x32_bf16 v[148:151], a[204:207], v[84:87], v[148:151]
buffer_load_dwordx4 v16, s[32:35], s64 offen offset:1024 sc1 lds
v_mfma_f32_16x16x32_bf16 v[132:135], a[204:207], v[68:71], v[224:227]
v_exp_f32 v120, v120
v_mfma_f32_16x16x32_bf16 v[132:135], a[200:203], v[64:67], v[132:135]
v_cvt_pk_bf16_f32 v169, v90, v91
v_cvt_pk_bf16_f32 v176, v104, v105
v_mfma_f32_16x16x32_bf16 v[132:135], a[196:199], v[60:63], v[132:135]
v_exp_f32 v121, v121
v_mfma_f32_16x16x32_bf16 v[132:135], a[192:195], v[56:59], v[132:135]
v_exp_f32 v122, v122
v_mfma_f32_16x16x32_bf16 v[116:119], a[192:195], v[40:43], v[220:223]
v_exp_f32 v123, v123
v_mfma_f32_16x16x32_bf16 v[116:119], a[196:199], v[44:47], v[116:119]
v_exp_f32 v136, v136
v_mfma_f32_16x16x32_bf16 v[116:119], a[200:203], v[48:51], v[116:119]
v_exp_f32 v137, v137
v_mfma_f32_16x16x32_bf16 v[116:119], a[204:207], v[52:55], v[116:119]
ds_read_b128 a[144:147], v3 offset:16384
v_cvt_pk_bf16_f32 v177, v106, v107
v_mfma_f32_16x16x32_bf16 v[100:103], a[204:207], v[36:39], v[216:219]
s_branch L_po15
L_pg15:
s_branch L_pg19
L_po15:
v_exp_f32 v138, v138
v_mfma_f32_16x16x32_bf16 v[100:103], a[200:203], v[32:35], v[100:103]
ds_read_b128 a[148:151], v3 offset:24576
v_cvt_pk_bf16_f32 v200, v120, v121
v_mfma_f32_16x16x32_bf16 v[100:103], a[196:199], v[28:31], v[100:103]
v_exp_f32 v139, v139
v_mfma_f32_16x16x32_bf16 v[100:103], a[192:195], v[24:27], v[100:103]
v_exp_f32 v140, v140
v_smfmac_f32_16x16x64_bf16 a[128:131], a[240:243], v[152:159], v5
v_cvt_pk_bf16_f32 v201, v122, v123
v_smfmac_f32_16x16x64_bf16 a[132:135], a[240:243], v[160:167], v5
v_exp_f32 v141, v141
v_smfmac_f32_16x16x64_bf16 a[136:139], a[240:243], v[184:191], v5
v_exp_f32 v142, v142
v_smfmac_f32_16x16x64_bf16 a[140:143], a[240:243], v[192:199], v5
s_waitcnt lgkmcnt(0)
buffer_load_dwordx4 v16, s[32:35], s64 offen offset:2048 sc1 lds
v_cvt_pk_bf16_f32 v208, v136, v137
v_mfma_f32_16x16x32_bf16 a[0:3], a[144:147], v[152:155], 0
ds_read_b128 a[152:155], v3 offset:17408
v_exp_f32 v143, v143
v_mfma_f32_16x16x32_bf16 a[0:3], a[148:151], v[156:159], a[0:3]
ds_read_b128 a[156:159], v3 offset:25600
v_exp_f32 v124, v124
v_mfma_f32_16x16x32_bf16 a[32:35], a[148:151], v[164:167], 0
v_cvt_pk_bf16_f32 v209, v138, v139
v_exp_f32 v125, v125
v_mfma_f32_16x16x32_bf16 a[32:35], a[144:147], v[160:163], a[32:35]
v_exp_f32 v126, v126
v_mfma_f32_16x16x32_bf16 a[64:67], a[144:147], v[184:187], 0
v_exp_f32 v127, v127
v_mfma_f32_16x16x32_bf16 a[64:67], a[148:151], v[188:191], a[64:67]
v_cvt_pk_bf16_f32 v210, v140, v141
v_cvt_pk_bf16_f32 v211, v142, v143
v_mfma_f32_16x16x32_bf16 a[96:99], a[148:151], v[196:199], 0
v_exp_f32 v108, v108
v_mfma_f32_16x16x32_bf16 a[96:99], a[144:147], v[192:195], a[96:99]
s_waitcnt lgkmcnt(0)
v_exp_f32 v109, v109
v_mfma_f32_16x16x32_bf16 a[100:103], a[152:155], v[192:195], 0
ds_read_b128 a[160:163], v3 offset:18432
v_cvt_pk_bf16_f32 v202, v124, v125
v_mfma_f32_16x16x32_bf16 a[100:103], a[156:159], v[196:199], a[100:103]
ds_read_b128 a[164:167], v3 offset:26624
v_exp_f32 v110, v110
v_mfma_f32_16x16x32_bf16 a[68:71], a[156:159], v[188:191], 0
v_exp_f32 v111, v111
v_mfma_f32_16x16x32_bf16 a[68:71], a[152:155], v[184:187], a[68:71]
v_exp_f32 v92, v92
v_mfma_f32_16x16x32_bf16 a[36:39], a[152:155], v[160:163], 0
v_exp_f32 v93, v93
v_mfma_f32_16x16x32_bf16 a[36:39], a[156:159], v[164:167], a[36:39]
v_cvt_pk_bf16_f32 v203, v126, v127
v_cvt_pk_bf16_f32 v178, v108, v109
v_mfma_f32_16x16x32_bf16 a[4:7], a[156:159], v[156:159], 0
buffer_load_dwordx4 v16, s[32:35], s64 offen offset:3072 sc1 lds
v_mfma_f32_16x16x32_bf16 a[4:7], a[152:155], v[152:155], a[4:7]
s_waitcnt lgkmcnt(0)
v_exp_f32 v94, v94
v_mfma_f32_16x16x32_bf16 a[8:11], a[160:163], v[152:155], 0
ds_read_b128 a[168:171], v3 offset:19456
v_cvt_pk_bf16_f32 v179, v110, v111
v_mfma_f32_16x16x32_bf16 a[8:11], a[164:167], v[156:159], a[8:11]
ds_read_b128 a[172:175], v3 offset:27648
v_exp_f32 v95, v95
v_mfma_f32_16x16x32_bf16 a[40:43], a[164:167], v[164:167], 0
v_exp_f32 v96, v96
v_mfma_f32_16x16x32_bf16 a[40:43], a[160:163], v[160:163], a[40:43]
v_exp_f32 v97, v97
v_mfma_f32_16x16x32_bf16 a[72:75], a[160:163], v[184:187], 0
v_exp_f32 v98, v98
v_mfma_f32_16x16x32_bf16 a[72:75], a[164:167], v[188:191], a[72:75]
v_exp_f32 v99, v99
v_mfma_f32_16x16x32_bf16 a[104:107], a[164:167], v[196:199], 0
ds_read_b128 a[176:179], v3 offset:20480
v_cvt_pk_bf16_f32 v170, v92, v93
v_mfma_f32_16x16x32_bf16 a[104:107], a[160:163], v[192:195], a[104:107]
s_waitcnt lgkmcnt(1)
v_exp_f32 v112, v112
v_mfma_f32_16x16x32_bf16 a[108:111], a[168:171], v[192:195], 0
v_exp_f32 v113, v113
v_mfma_f32_16x16x32_bf16 a[108:111], a[172:175], v[196:199], a[108:111]
ds_read_b128 a[180:183], v3 offset:28672
v_cvt_pk_bf16_f32 v171, v94, v95
v_mfma_f32_16x16x32_bf16 a[76:79], a[172:175], v[188:191], 0
v_exp_f32 v114, v114
v_mfma_f32_16x16x32_bf16 a[76:79], a[168:171], v[184:187], a[76:79]
v_cvt_pk_bf16_f32 v172, v96, v97
v_xor_b32 v2, 0x8000, v2
v_mfma_f32_16x16x32_bf16 a[44:47], a[168:171], v[160:163], 0
ds_read_b128 a[184:187], v3 offset:21504
ds_read_b128 a[188:191], v3 offset:29696
ds_read_b128 a[192:195], v3 offset:22528
ds_read_b128 a[196:199], v3 offset:30720
ds_read_b128 a[200:203], v3 offset:23552
ds_read_b128 a[204:207], v3 offset:31744
v_exp_f32 v115, v115
v_mfma_f32_16x16x32_bf16 a[44:47], a[172:175], v[164:167], a[44:47]
s_waitcnt vmcnt(8)
s_barrier
v_exp_f32 v128, v128
v_mfma_f32_16x16x32_bf16 a[12:15], a[172:175], v[156:159], 0
v_cvt_pk_bf16_f32 v173, v98, v99
v_cvt_pk_bf16_f32 v180, v112, v113
v_mfma_f32_16x16x32_bf16 a[12:15], a[168:171], v[152:155], a[12:15]
s_waitcnt lgkmcnt(6)
v_exp_f32 v129, v129
v_mfma_f32_16x16x32_bf16 a[16:19], a[176:179], v[152:155], 0
v_exp_f32 v130, v130
v_mfma_f32_16x16x32_bf16 a[16:19], a[180:183], v[156:159], a[16:19]
s_xor_b32 s71, s71, 49152
v_exp_f32 v131, v131
v_mfma_f32_16x16x32_bf16 a[48:51], a[180:183], v[164:167], 0
s_add_u32 s70, s70, 32768
v_exp_f32 v144, v144
v_mfma_f32_16x16x32_bf16 a[48:51], a[176:179], v[160:163], a[48:51]
s_mov_b32 m0, s71
v_exp_f32 v145, v145
v_mfma_f32_16x16x32_bf16 a[80:83], a[176:179], v[184:187], 0
buffer_load_dwordx4 v16, s[32:35], s70 offen offset:0 sc1 lds
v_cvt_pk_bf16_f32 v181, v114, v115
v_mfma_f32_16x16x32_bf16 a[80:83], a[180:183], v[188:191], a[80:83]
v_exp_f32 v146, v146
v_mfma_f32_16x16x32_bf16 a[112:115], a[180:183], v[196:199], 0
v_exp_f32 v147, v147
v_mfma_f32_16x16x32_bf16 a[112:115], a[176:179], v[192:195], a[112:115]
s_waitcnt lgkmcnt(0)
v_cvt_pk_bf16_f32 v204, v128, v129
v_cvt_pk_bf16_f32 v205, v130, v131
v_mfma_f32_16x16x32_bf16 a[116:119], a[184:187], v[192:195], 0
v_exp_f32 v148, v148
v_mfma_f32_16x16x32_bf16 a[116:119], a[188:191], v[196:199], a[116:119]
v_exp_f32 v149, v149
v_mfma_f32_16x16x32_bf16 a[84:87], a[188:191], v[188:191], 0
v_exp_f32 v150, v150
v_mfma_f32_16x16x32_bf16 a[84:87], a[184:187], v[184:187], a[84:87]
v_exp_f32 v151, v151
v_mfma_f32_16x16x32_bf16 a[52:55], a[184:187], v[160:163], 0
v_cvt_pk_bf16_f32 v212, v144, v145
v_cvt_pk_bf16_f32 v213, v146, v147
v_mfma_f32_16x16x32_bf16 a[52:55], a[188:191], v[164:167], a[52:55]
v_exp_f32 v132, v132
v_mfma_f32_16x16x32_bf16 a[20:23], a[188:191], v[156:159], 0
v_exp_f32 v133, v133
v_mfma_f32_16x16x32_bf16 a[20:23], a[184:187], v[152:155], a[20:23]
ds_read_b128 a[144:147], v2 offset:0
v_lshl_add_u32 v19, v0, 24, s66
v_mfma_f32_16x16x32_bf16 a[24:27], a[192:195], v[152:155], 0
s_lshr_b32 s67, s31, 4
v_exp_f32 v134, v134
v_mfma_f32_16x16x32_bf16 a[24:27], a[196:199], v[156:159], a[24:27]
s_lshl1_add_u32 s67, s3, s67
v_exp_f32 v135, v135
v_mfma_f32_16x16x32_bf16 a[56:59], a[196:199], v[164:167], 0
s_lshl_b32 s79, s67, 8
v_cvt_pk_bf16_f32 v214, v148, v149
v_cvt_pk_bf16_f32 v215, v150, v151
v_mfma_f32_16x16x32_bf16 a[56:59], a[192:195], v[160:163], a[56:59]
s_add_u32 s79, s79, 8192
buffer_load_dwordx4 v16, s[32:35], s70 offen offset:1024 sc1 lds
v_mfma_f32_16x16x32_bf16 a[88:91], a[192:195], v[184:187], 0
s_add_u32 s69, s31, 12
v_exp_f32 v116, v116
v_mfma_f32_16x16x32_bf16 a[88:91], a[196:199], v[188:191], a[88:91]
s_lshr_b32 s69, s69, 5
v_exp_f32 v117, v117
v_mfma_f32_16x16x32_bf16 a[120:123], a[196:199], v[196:199], 0
s_lshl1_add_u32 s69, s3, s69
v_exp_f32 v118, v118
v_mfma_f32_16x16x32_bf16 a[120:123], a[192:195], v[192:195], a[120:123]
s_lshl_b32 s69, s69, 8
v_cvt_pk_bf16_f32 v206, v132, v133
v_cvt_pk_bf16_f32 v207, v134, v135
v_mfma_f32_16x16x32_bf16 a[124:127], a[200:203], v[192:195], 0
s_add_u32 s69, s69, 8192
v_exp_f32 v119, v119
v_mfma_f32_16x16x32_bf16 a[124:127], a[204:207], v[196:199], a[124:127]
s_lshl_b32 s67, s73, 16
v_exp_f32 v100, v100
v_mfma_f32_16x16x32_bf16 a[92:95], a[204:207], v[188:191], 0
s_xor_b32 s68, s80, 256
v_exp_f32 v101, v101
v_mfma_f32_16x16x32_bf16 a[92:95], a[200:203], v[184:187], a[92:95]
s_add_u32 s68, s68, s67
ds_read_b128 a[148:151], v2 offset:1024
v_cvt_pk_bf16_f32 v182, v116, v117
v_mfma_f32_16x16x32_bf16 a[60:63], a[200:203], v[160:163], 0
ds_read_b128 a[152:155], v2 offset:2048
v_exp_f32 v102, v102
v_mfma_f32_16x16x32_bf16 a[60:63], a[204:207], v[164:167], a[60:63]
s_add_u32 s67, s67, s69
ds_read_b128 a[156:159], v2 offset:3072
v_cvt_pk_bf16_f32 v183, v118, v119
v_mfma_f32_16x16x32_bf16 a[28:31], a[204:207], v[156:159], 0
s_mov_b64 exec, 1
buffer_atomic_add a251, v19, s[52:55], s67 offen offset:0 sc1
buffer_atomic_add a251, v19, s[52:55], s68 offen offset:0 sc1
s_mov_b64 exec, -1
v_exp_f32 v103, v103
v_mfma_f32_16x16x32_bf16 a[28:31], a[200:203], v[152:155], a[28:31]
ds_read_b128 a[160:163], v2 offset:4096
ds_read_b128 a[164:167], v2 offset:5120
ds_read_b128 a[168:171], v2 offset:6144
ds_read_b128 a[172:175], v2 offset:7168
v_mul_u32_u24 v19, 52, v0
v_cvt_pk_bf16_f32 v174, v100, v101
v_cvt_pk_bf16_f32 v175, v102, v103
v_xor_b32 v3, 0x8000, v3
s_sub_u32 s72, s3, 1
s_cmp_eq_u32 s72, 0
s_cbranch_scc1 L_DD
L_D:
s_waitcnt lgkmcnt(7)
v_mfma_f32_16x16x32_bf16 v[88:91], a[144:147], v[24:27], v[216:219]
s_waitcnt lgkmcnt(6)
ds_read_b128 a[176:179], v2 offset:8192
v_mfma_f32_16x16x32_bf16 v[88:91], a[148:151], v[28:31], v[88:91]
s_waitcnt lgkmcnt(6)
ds_read_b128 a[180:183], v2 offset:9216
v_mfma_f32_16x16x32_bf16 v[88:91], a[152:155], v[32:35], v[88:91]
s_waitcnt lgkmcnt(6)
buffer_load_dwordx4 v16, s[32:35], s70 offen offset:2048 sc1 lds
v_mfma_f32_16x16x32_bf16 v[88:91], a[156:159], v[36:39], v[88:91]
ds_read_b128 a[184:187], v2 offset:10240
v_mfma_f32_16x16x32_bf16 v[104:107], a[156:159], v[52:55], v[220:223]
v_mfma_f32_16x16x32_bf16 v[104:107], a[152:155], v[48:51], v[104:107]
buffer_load_dword a252, v19, s[40:43], s81 offen
v_mfma_f32_16x16x32_bf16 v[104:107], a[148:151], v[44:47], v[104:107]
ds_read_b128 a[188:191], v2 offset:11264
v_mfma_f32_16x16x32_bf16 v[104:107], a[144:147], v[40:43], v[104:107]
v_mfma_f32_16x16x32_bf16 v[120:123], a[144:147], v[56:59], v[224:227]
v_mfma_f32_16x16x32_bf16 v[120:123], a[148:151], v[60:63], v[120:123]
v_mfma_f32_16x16x32_bf16 v[120:123], a[152:155], v[64:67], v[120:123]
v_exp_f32 v88, v88
v_mfma_f32_16x16x32_bf16 v[120:123], a[156:159], v[68:71], v[120:123]
v_exp_f32 v89, v89
v_mfma_f32_16x16x32_bf16 v[136:139], a[156:159], v[84:87], v[228:231]
v_exp_f32 v90, v90
v_mfma_f32_16x16x32_bf16 v[136:139], a[152:155], v[80:83], v[136:139]
v_exp_f32 v91, v91
v_mfma_f32_16x16x32_bf16 v[136:139], a[148:151], v[76:79], v[136:139]
v_exp_f32 v104, v104
v_mfma_f32_16x16x32_bf16 v[136:139], a[144:147], v[72:75], v[136:139]
s_waitcnt lgkmcnt(0)
s_add_u32 s81, s81, 425984
v_exp_f32 v105, v105
v_mfma_f32_16x16x32_bf16 v[140:143], a[160:163], v[72:75], v[228:231]
v_exp_f32 v106, v106
v_mfma_f32_16x16x32_bf16 v[140:143], a[164:167], v[76:79], v[140:143]
buffer_load_dwordx4 v16, s[32:35], s70 offen offset:3072 sc1 lds
v_mfma_f32_16x16x32_bf16 v[140:143], a[168:171], v[80:83], v[140:143]
v_exp_f32 v107, v107
v_mfma_f32_16x16x32_bf16 v[140:143], a[172:175], v[84:87], v[140:143]
v_cvt_pk_bf16_f32 v152, v88, v89
v_cvt_pk_bf16_f32 v153, v90, v91
v_mfma_f32_16x16x32_bf16 v[124:127], a[172:175], v[68:71], v[224:227]
v_exp_f32 v120, v120
v_mfma_f32_16x16x32_bf16 v[124:127], a[168:171], v[64:67], v[124:127]
v_exp_f32 v121, v121
v_mfma_f32_16x16x32_bf16 v[124:127], a[164:167], v[60:63], v[124:127]
v_exp_f32 v122, v122
v_mfma_f32_16x16x32_bf16 v[124:127], a[160:163], v[56:59], v[124:127]
v_exp_f32 v123, v123
v_mfma_f32_16x16x32_bf16 v[108:111], a[160:163], v[40:43], v[220:223]
v_exp_f32 v136, v136
v_mfma_f32_16x16x32_bf16 v[108:111], a[164:167], v[44:47], v[108:111]
v_exp_f32 v137, v137
v_mfma_f32_16x16x32_bf16 v[108:111], a[168:171], v[48:51], v[108:111]
v_exp_f32 v138, v138
v_mfma_f32_16x16x32_bf16 v[108:111], a[172:175], v[52:55], v[108:111]
v_cvt_pk_bf16_f32 v160, v104, v105
v_cvt_pk_bf16_f32 v161, v106, v107
v_mfma_f32_16x16x32_bf16 v[92:95], a[172:175], v[36:39], v[216:219]
v_exp_f32 v139, v139
v_mfma_f32_16x16x32_bf16 v[92:95], a[168:171], v[32:35], v[92:95]
ds_read_b128 a[192:195], v2 offset:12288
v_cvt_pk_bf16_f32 v184, v120, v121
v_mfma_f32_16x16x32_bf16 v[92:95], a[164:167], v[28:31], v[92:95]
v_exp_f32 v140, v140
v_mfma_f32_16x16x32_bf16 v[92:95], a[160:163], v[24:27], v[92:95]
s_add_u32 m0, s71, 4096
ds_read_b128 a[196:199], v2 offset:13312
v_cvt_pk_bf16_f32 v185, v122, v123
v_mfma_f32_16x16x32_bf16 v[96:99], a[176:179], v[24:27], v[216:219]
s_add_u32 s64, s70, 4096
ds_read_b128 a[200:203], v2 offset:14336
v_cvt_pk_bf16_f32 v192, v136, v137
v_mfma_f32_16x16x32_bf16 v[96:99], a[180:183], v[28:31], v[96:99]
buffer_load_dwordx4 v16, s[32:35], s64 offen offset:0 sc1 lds
v_mfma_f32_16x16x32_bf16 v[96:99], a[184:187], v[32:35], v[96:99]
v_exp_f32 v141, v141
v_mfma_f32_16x16x32_bf16 v[96:99], a[188:191], v[36:39], v[96:99]
ds_read_b128 a[204:207], v2 offset:15360
v_cvt_pk_bf16_f32 v193, v138, v139
v_mfma_f32_16x16x32_bf16 v[112:115], a[188:191], v[52:55], v[220:223]
v_exp_f32 v142, v142
v_mfma_f32_16x16x32_bf16 v[112:115], a[184:187], v[48:51], v[112:115]
v_exp_f32 v143, v143
v_mfma_f32_16x16x32_bf16 v[112:115], a[180:183], v[44:47], v[112:115]
v_exp_f32 v124, v124
v_mfma_f32_16x16x32_bf16 v[112:115], a[176:179], v[40:43], v[112:115]
v_exp_f32 v125, v125
v_mfma_f32_16x16x32_bf16 v[128:131], a[176:179], v[56:59], v[224:227]
v_exp_f32 v126, v126
v_mfma_f32_16x16x32_bf16 v[128:131], a[180:183], v[60:63], v[128:131]
v_exp_f32 v127, v127
v_mfma_f32_16x16x32_bf16 v[128:131], a[184:187], v[64:67], v[128:131]
v_exp_f32 v108, v108
v_mfma_f32_16x16x32_bf16 v[128:131], a[188:191], v[68:71], v[128:131]
v_exp_f32 v109, v109
v_mfma_f32_16x16x32_bf16 v[144:147], a[188:191], v[84:87], v[228:231]
v_exp_f32 v110, v110
v_mfma_f32_16x16x32_bf16 v[144:147], a[184:187], v[80:83], v[144:147]
ds_read_b128 a[144:147], v3 offset:0
v_cvt_pk_bf16_f32 v194, v140, v141
v_mfma_f32_16x16x32_bf16 v[144:147], a[180:183], v[76:79], v[144:147]
ds_read_b128 a[148:151], v3 offset:8192
v_cvt_pk_bf16_f32 v195, v142, v143
v_mfma_f32_16x16x32_bf16 v[144:147], a[176:179], v[72:75], v[144:147]
s_waitcnt lgkmcnt(2)
v_exp_f32 v111, v111
v_mfma_f32_16x16x32_bf16 v[148:151], a[192:195], v[72:75], v[228:231]
buffer_load_dwordx4 v16, s[32:35], s64 offen offset:1024 sc1 lds
v_mfma_f32_16x16x32_bf16 v[148:151], a[196:199], v[76:79], v[148:151]
v_exp_f32 v92, v92
v_mfma_f32_16x16x32_bf16 v[148:151], a[200:203], v[80:83], v[148:151]
v_exp_f32 v93, v93
v_mfma_f32_16x16x32_bf16 v[148:151], a[204:207], v[84:87], v[148:151]
v_exp_f32 v94, v94
v_mfma_f32_16x16x32_bf16 v[132:135], a[204:207], v[68:71], v[224:227]
ds_read_b128 a[152:155], v3 offset:1024
v_cvt_pk_bf16_f32 v186, v124, v125
v_mfma_f32_16x16x32_bf16 v[132:135], a[200:203], v[64:67], v[132:135]
ds_read_b128 a[156:159], v3 offset:9216
v_cvt_pk_bf16_f32 v187, v126, v127
v_mfma_f32_16x16x32_bf16 v[132:135], a[196:199], v[60:63], v[132:135]
v_exp_f32 v95, v95
v_mfma_f32_16x16x32_bf16 v[132:135], a[192:195], v[56:59], v[132:135]
v_exp_f32 v96, v96
v_mfma_f32_16x16x32_bf16 v[116:119], a[192:195], v[40:43], v[220:223]
v_exp_f32 v97, v97
v_mfma_f32_16x16x32_bf16 v[116:119], a[196:199], v[44:47], v[116:119]
v_exp_f32 v98, v98
v_mfma_f32_16x16x32_bf16 v[116:119], a[200:203], v[48:51], v[116:119]
ds_read_b128 a[160:163], v3 offset:2048
v_cvt_pk_bf16_f32 v162, v108, v109
v_mfma_f32_16x16x32_bf16 v[116:119], a[204:207], v[52:55], v[116:119]
v_exp_f32 v99, v99
v_mfma_f32_16x16x32_bf16 v[100:103], a[204:207], v[36:39], v[216:219]
ds_read_b128 a[164:167], v3 offset:10240
v_cvt_pk_bf16_f32 v163, v110, v111
v_mfma_f32_16x16x32_bf16 v[100:103], a[200:203], v[32:35], v[100:103]
v_exp_f32 v112, v112
v_mfma_f32_16x16x32_bf16 v[100:103], a[196:199], v[28:31], v[100:103]
v_exp_f32 v113, v113
v_mfma_f32_16x16x32_bf16 v[100:103], a[192:195], v[24:27], v[100:103]
v_exp_f32 v114, v114
v_smfmac_f32_16x16x64_bf16 a[128:131], a[240:243], v[168:175], v5
ds_read_b128 a[168:171], v3 offset:3072
v_smfmac_f32_16x16x64_bf16 a[132:135], a[240:243], v[176:183], v5
ds_read_b128 a[172:175], v3 offset:11264
v_smfmac_f32_16x16x64_bf16 a[136:139], a[240:243], v[200:207], v5
ds_read_b128 a[176:179], v3 offset:4096
v_smfmac_f32_16x16x64_bf16 a[140:143], a[240:243], v[208:215], v5
s_waitcnt lgkmcnt(3)
buffer_load_dwordx4 v16, s[32:35], s64 offen offset:2048 sc1 lds
v_mfma_f32_16x16x32_bf16 a[0:3], a[144:147], v[168:171], a[0:3]
v_exp_f32 v115, v115
v_mfma_f32_16x16x32_bf16 a[0:3], a[148:151], v[172:175], a[0:3]
v_exp_f32 v128, v128
v_mfma_f32_16x16x32_bf16 a[32:35], a[148:151], v[180:183], a[32:35]
v_exp_f32 v129, v129
v_mfma_f32_16x16x32_bf16 a[32:35], a[144:147], v[176:179], a[32:35]
v_exp_f32 v130, v130
v_mfma_f32_16x16x32_bf16 a[64:67], a[144:147], v[200:203], a[64:67]
v_exp_f32 v131, v131
v_mfma_f32_16x16x32_bf16 a[64:67], a[148:151], v[204:207], a[64:67]
v_cvt_pk_bf16_f32 v154, v92, v93
v_cvt_pk_bf16_f32 v155, v94, v95
v_mfma_f32_16x16x32_bf16 a[96:99], a[148:151], v[212:215], a[96:99]
v_exp_f32 v144, v144
v_mfma_f32_16x16x32_bf16 a[96:99], a[144:147], v[208:211], a[96:99]
ds_read_b128 a[180:183], v3 offset:12288
v_cvt_pk_bf16_f32 v156, v96, v97
v_mfma_f32_16x16x32_bf16 a[100:103], a[152:155], v[208:211], a[100:103]
v_exp_f32 v145, v145
v_mfma_f32_16x16x32_bf16 a[100:103], a[156:159], v[212:215], a[100:103]
ds_read_b128 a[184:187], v3 offset:5120
v_cvt_pk_bf16_f32 v157, v98, v99
v_mfma_f32_16x16x32_bf16 a[68:71], a[156:159], v[204:207], a[68:71]
ds_read_b128 a[188:191], v3 offset:13312
v_cvt_pk_bf16_f32 v164, v112, v113
v_mfma_f32_16x16x32_bf16 a[68:71], a[152:155], v[200:203], a[68:71]
buffer_load_dwordx4 v16, s[32:35], s64 offen offset:3072 sc1 lds
v_mfma_f32_16x16x32_bf16 a[36:39], a[152:155], v[176:179], a[36:39]
ds_read_b128 a[192:195], v3 offset:6144
v_cvt_pk_bf16_f32 v165, v114, v115
v_mfma_f32_16x16x32_bf16 a[36:39], a[156:159], v[180:183], a[36:39]
ds_read_b128 a[196:199], v3 offset:14336
v_cvt_pk_bf16_f32 v188, v128, v129
v_mfma_f32_16x16x32_bf16 a[4:7], a[156:159], v[172:175], a[4:7]
ds_read_b128 a[200:203], v3 offset:7168
v_cvt_pk_bf16_f32 v189, v130, v131
v_mfma_f32_16x16x32_bf16 a[4:7], a[152:155], v[168:171], a[4:7]
v_exp_f32 v146, v146
v_mfma_f32_16x16x32_bf16 a[8:11], a[160:163], v[168:171], a[8:11]
v_exp_f32 v147, v147
v_mfma_f32_16x16x32_bf16 a[8:11], a[164:167], v[172:175], a[8:11]
v_exp_f32 v148, v148
v_mfma_f32_16x16x32_bf16 a[40:43], a[164:167], v[180:183], a[40:43]
ds_read_b128 a[204:207], v3 offset:15360
v_cvt_pk_bf16_f32 v196, v144, v145
v_mfma_f32_16x16x32_bf16 a[40:43], a[160:163], v[176:179], a[40:43]
v_exp_f32 v149, v149
v_mfma_f32_16x16x32_bf16 a[72:75], a[160:163], v[200:203], a[72:75]
v_exp_f32 v150, v150
v_mfma_f32_16x16x32_bf16 a[72:75], a[164:167], v[204:207], a[72:75]
v_exp_f32 v151, v151
v_mfma_f32_16x16x32_bf16 a[104:107], a[164:167], v[212:215], a[104:107]
v_exp_f32 v132, v132
v_mfma_f32_16x16x32_bf16 a[104:107], a[160:163], v[208:211], a[104:107]
s_waitcnt lgkmcnt(1)
v_exp_f32 v133, v133
v_mfma_f32_16x16x32_bf16 a[108:111], a[168:171], v[208:211], a[108:111]
v_exp_f32 v134, v134
v_mfma_f32_16x16x32_bf16 a[108:111], a[172:175], v[212:215], a[108:111]
v_exp_f32 v135, v135
v_mfma_f32_16x16x32_bf16 a[76:79], a[172:175], v[204:207], a[76:79]
v_exp_f32 v116, v116
v_mfma_f32_16x16x32_bf16 a[76:79], a[168:171], v[200:203], a[76:79]
v_exp_f32 v117, v117
v_mfma_f32_16x16x32_bf16 a[44:47], a[168:171], v[176:179], a[44:47]
v_exp_f32 v118, v118
v_mfma_f32_16x16x32_bf16 a[44:47], a[172:175], v[180:183], a[44:47]
s_waitcnt vmcnt(9)
s_barrier
v_mfma_f32_16x16x32_bf16 a[12:15], a[172:175], v[172:175], a[12:15]
s_xor_b32 s71, s71, 16384
v_exp_f32 v119, v119
v_mfma_f32_16x16x32_bf16 a[12:15], a[168:171], v[168:171], a[12:15]
s_add_u32 s70, s70, 32768
v_exp_f32 v100, v100
v_mfma_f32_16x16x32_bf16 a[16:19], a[176:179], v[168:171], a[16:19]
s_mov_b32 m0, s71
v_exp_f32 v101, v101
v_mfma_f32_16x16x32_bf16 a[16:19], a[180:183], v[172:175], a[16:19]
buffer_load_dwordx4 v16, s[32:35], s70 offen offset:0 sc1 lds
v_mfma_f32_16x16x32_bf16 a[48:51], a[180:183], v[180:183], a[48:51]
ds_read_b128 a[144:147], v2 offset:16384
v_cvt_pk_bf16_f32 v197, v146, v147
v_mfma_f32_16x16x32_bf16 a[48:51], a[176:179], v[176:179], a[48:51]
ds_read_b128 a[148:151], v2 offset:17408
v_cvt_pk_bf16_f32 v198, v148, v149
v_mfma_f32_16x16x32_bf16 a[80:83], a[176:179], v[200:203], a[80:83]
v_exp_f32 v102, v102
v_mfma_f32_16x16x32_bf16 a[80:83], a[180:183], v[204:207], a[80:83]
ds_read_b128 a[152:155], v2 offset:18432
v_cvt_pk_bf16_f32 v199, v150, v151
v_mfma_f32_16x16x32_bf16 a[112:115], a[180:183], v[212:215], a[112:115]
ds_read_b128 a[156:159], v2 offset:19456
v_cvt_pk_bf16_f32 v190, v132, v133
v_mfma_f32_16x16x32_bf16 a[112:115], a[176:179], v[208:211], a[112:115]
v_exp_f32 v103, v103
v_mfma_f32_16x16x32_bf16 a[116:119], a[184:187], v[208:211], a[116:119]
ds_read_b128 a[160:163], v2 offset:20480
v_cvt_pk_bf16_f32 v191, v134, v135
v_mfma_f32_16x16x32_bf16 a[116:119], a[188:191], v[212:215], a[116:119]
ds_read_b128 a[164:167], v2 offset:21504
v_cvt_pk_bf16_f32 v166, v116, v117
v_mfma_f32_16x16x32_bf16 a[84:87], a[188:191], v[204:207], a[84:87]
ds_read_b128 a[168:171], v2 offset:22528
v_cvt_pk_bf16_f32 v167, v118, v119
v_mfma_f32_16x16x32_bf16 a[84:87], a[184:187], v[200:203], a[84:87]
ds_read_b128 a[172:175], v2 offset:23552
v_cvt_pk_bf16_f32 v158, v100, v101
v_mfma_f32_16x16x32_bf16 a[52:55], a[184:187], v[176:179], a[52:55]
v_cvt_pk_bf16_f32 v159, v102, v103
v_mfma_f32_16x16x32_bf16 a[52:55], a[188:191], v[180:183], a[52:55]
v_mfma_f32_16x16x32_bf16 a[20:23], a[188:191], v[172:175], a[20:23]
v_mfma_f32_16x16x32_bf16 a[20:23], a[184:187], v[168:171], a[20:23]
v_mfma_f32_16x16x32_bf16 a[24:27], a[192:195], v[168:171], a[24:27]
buffer_load_dwordx4 v16, s[32:35], s70 offen offset:1024 sc1 lds
v_mfma_f32_16x16x32_bf16 a[24:27], a[196:199], v[172:175], a[24:27]
v_mfma_f32_16x16x32_bf16 a[56:59], a[196:199], v[180:183], a[56:59]
v_mfma_f32_16x16x32_bf16 a[56:59], a[192:195], v[176:179], a[56:59]
v_mfma_f32_16x16x32_bf16 a[88:91], a[192:195], v[200:203], a[88:91]
v_mfma_f32_16x16x32_bf16 a[88:91], a[196:199], v[204:207], a[88:91]
v_mfma_f32_16x16x32_bf16 a[120:123], a[196:199], v[212:215], a[120:123]
v_mfma_f32_16x16x32_bf16 a[120:123], a[192:195], v[208:211], a[120:123]
v_mfma_f32_16x16x32_bf16 a[124:127], a[200:203], v[208:211], a[124:127]
s_waitcnt lgkmcnt(0)
v_mfma_f32_16x16x32_bf16 a[124:127], a[204:207], v[212:215], a[124:127]
v_mfma_f32_16x16x32_bf16 a[92:95], a[204:207], v[204:207], a[92:95]
v_mfma_f32_16x16x32_bf16 a[92:95], a[200:203], v[200:203], a[92:95]
v_mfma_f32_16x16x32_bf16 a[60:63], a[200:203], v[176:179], a[60:63]
v_mfma_f32_16x16x32_bf16 a[60:63], a[204:207], v[180:183], a[60:63]
v_mfma_f32_16x16x32_bf16 a[28:31], a[204:207], v[172:175], a[28:31]
v_mfma_f32_16x16x32_bf16 a[28:31], a[200:203], v[168:171], a[28:31]
v_mfma_f32_16x16x32_bf16 v[88:91], a[144:147], v[24:27], v[216:219]
ds_read_b128 a[176:179], v2 offset:24576
v_mfma_f32_16x16x32_bf16 v[88:91], a[148:151], v[28:31], v[88:91]
ds_read_b128 a[180:183], v2 offset:25600
v_mfma_f32_16x16x32_bf16 v[88:91], a[152:155], v[32:35], v[88:91]
buffer_load_dwordx4 v16, s[32:35], s70 offen offset:2048 sc1 lds
v_mfma_f32_16x16x32_bf16 v[88:91], a[156:159], v[36:39], v[88:91]
ds_read_b128 a[184:187], v2 offset:26624
v_mfma_f32_16x16x32_bf16 v[104:107], a[156:159], v[52:55], v[220:223]
v_mfma_f32_16x16x32_bf16 v[104:107], a[152:155], v[48:51], v[104:107]
v_mfma_f32_16x16x32_bf16 v[104:107], a[148:151], v[44:47], v[104:107]
ds_read_b128 a[188:191], v2 offset:27648
v_mfma_f32_16x16x32_bf16 v[104:107], a[144:147], v[40:43], v[104:107]
v_mfma_f32_16x16x32_bf16 v[120:123], a[144:147], v[56:59], v[224:227]
v_mfma_f32_16x16x32_bf16 v[120:123], a[148:151], v[60:63], v[120:123]
v_mfma_f32_16x16x32_bf16 v[120:123], a[152:155], v[64:67], v[120:123]
v_exp_f32 v88, v88
v_mfma_f32_16x16x32_bf16 v[120:123], a[156:159], v[68:71], v[120:123]
v_exp_f32 v89, v89
v_mfma_f32_16x16x32_bf16 v[136:139], a[156:159], v[84:87], v[228:231]
v_exp_f32 v90, v90
v_mfma_f32_16x16x32_bf16 v[136:139], a[152:155], v[80:83], v[136:139]
v_exp_f32 v91, v91
v_mfma_f32_16x16x32_bf16 v[136:139], a[148:151], v[76:79], v[136:139]
v_exp_f32 v104, v104
v_mfma_f32_16x16x32_bf16 v[136:139], a[144:147], v[72:75], v[136:139]
v_exp_f32 v105, v105
v_mfma_f32_16x16x32_bf16 v[140:143], a[160:163], v[72:75], v[228:231]
v_exp_f32 v106, v106
v_mfma_f32_16x16x32_bf16 v[140:143], a[164:167], v[76:79], v[140:143]
buffer_load_dwordx4 v16, s[32:35], s70 offen offset:3072 sc1 lds
v_mfma_f32_16x16x32_bf16 v[140:143], a[168:171], v[80:83], v[140:143]
v_exp_f32 v107, v107
v_mfma_f32_16x16x32_bf16 v[140:143], a[172:175], v[84:87], v[140:143]
v_cvt_pk_bf16_f32 v168, v88, v89
v_cvt_pk_bf16_f32 v169, v90, v91
v_mfma_f32_16x16x32_bf16 v[124:127], a[172:175], v[68:71], v[224:227]
v_exp_f32 v120, v120
v_mfma_f32_16x16x32_bf16 v[124:127], a[168:171], v[64:67], v[124:127]
v_exp_f32 v121, v121
v_mfma_f32_16x16x32_bf16 v[124:127], a[164:167], v[60:63], v[124:127]
v_exp_f32 v122, v122
v_mfma_f32_16x16x32_bf16 v[124:127], a[160:163], v[56:59], v[124:127]
v_exp_f32 v123, v123
v_mfma_f32_16x16x32_bf16 v[108:111], a[160:163], v[40:43], v[220:223]
v_exp_f32 v136, v136
v_mfma_f32_16x16x32_bf16 v[108:111], a[164:167], v[44:47], v[108:111]
v_exp_f32 v137, v137
v_mfma_f32_16x16x32_bf16 v[108:111], a[168:171], v[48:51], v[108:111]
v_exp_f32 v138, v138
v_mfma_f32_16x16x32_bf16 v[108:111], a[172:175], v[52:55], v[108:111]
v_cvt_pk_bf16_f32 v176, v104, v105
v_cvt_pk_bf16_f32 v177, v106, v107
v_mfma_f32_16x16x32_bf16 v[92:95], a[172:175], v[36:39], v[216:219]
v_exp_f32 v139, v139
v_mfma_f32_16x16x32_bf16 v[92:95], a[168:171], v[32:35], v[92:95]
ds_read_b128 a[192:195], v2 offset:28672
v_cvt_pk_bf16_f32 v200, v120, v121
v_mfma_f32_16x16x32_bf16 v[92:95], a[164:167], v[28:31], v[92:95]
v_exp_f32 v140, v140
v_mfma_f32_16x16x32_bf16 v[92:95], a[160:163], v[24:27], v[92:95]
s_waitcnt lgkmcnt(1)
s_add_u32 m0, s71, 4096
ds_read_b128 a[196:199], v2 offset:29696
v_cvt_pk_bf16_f32 v201, v122, v123
v_mfma_f32_16x16x32_bf16 v[96:99], a[176:179], v[24:27], v[216:219]
s_add_u32 s64, s70, 4096
ds_read_b128 a[200:203], v2 offset:30720
v_cvt_pk_bf16_f32 v208, v136, v137
v_mfma_f32_16x16x32_bf16 v[96:99], a[180:183], v[28:31], v[96:99]
buffer_load_dwordx4 v16, s[32:35], s64 offen offset:0 sc1 lds
v_mfma_f32_16x16x32_bf16 v[96:99], a[184:187], v[32:35], v[96:99]
v_exp_f32 v141, v141
v_mfma_f32_16x16x32_bf16 v[96:99], a[188:191], v[36:39], v[96:99]
ds_read_b128 a[204:207], v2 offset:31744
v_cvt_pk_bf16_f32 v209, v138, v139
v_mfma_f32_16x16x32_bf16 v[112:115], a[188:191], v[52:55], v[220:223]
v_exp_f32 v142, v142
v_mfma_f32_16x16x32_bf16 v[112:115], a[184:187], v[48:51], v[112:115]
v_exp_f32 v143, v143
v_mfma_f32_16x16x32_bf16 v[112:115], a[180:183], v[44:47], v[112:115]
v_exp_f32 v124, v124
v_mfma_f32_16x16x32_bf16 v[112:115], a[176:179], v[40:43], v[112:115]
v_exp_f32 v125, v125
v_mfma_f32_16x16x32_bf16 v[128:131], a[176:179], v[56:59], v[224:227]
v_exp_f32 v126, v126
v_mfma_f32_16x16x32_bf16 v[128:131], a[180:183], v[60:63], v[128:131]
v_exp_f32 v127, v127
v_mfma_f32_16x16x32_bf16 v[128:131], a[184:187], v[64:67], v[128:131]
v_exp_f32 v108, v108
v_mfma_f32_16x16x32_bf16 v[128:131], a[188:191], v[68:71], v[128:131]
v_exp_f32 v109, v109
v_mfma_f32_16x16x32_bf16 v[144:147], a[188:191], v[84:87], v[228:231]
v_exp_f32 v110, v110
v_mfma_f32_16x16x32_bf16 v[144:147], a[184:187], v[80:83], v[144:147]
ds_read_b128 a[144:147], v3 offset:16384
v_cvt_pk_bf16_f32 v210, v140, v141
v_mfma_f32_16x16x32_bf16 v[144:147], a[180:183], v[76:79], v[144:147]
ds_read_b128 a[148:151], v3 offset:24576
v_cvt_pk_bf16_f32 v211, v142, v143
v_mfma_f32_16x16x32_bf16 v[144:147], a[176:179], v[72:75], v[144:147]
s_waitcnt lgkmcnt(2)
v_exp_f32 v111, v111
v_mfma_f32_16x16x32_bf16 v[148:151], a[192:195], v[72:75], v[228:231]
s_branch L_po16
L_pg16:
s_branch L_pg20
L_po16:
buffer_load_dwordx4 v16, s[32:35], s64 offen offset:1024 sc1 lds
v_mfma_f32_16x16x32_bf16 v[148:151], a[196:199], v[76:79], v[148:151]
v_exp_f32 v92, v92
v_mfma_f32_16x16x32_bf16 v[148:151], a[200:203], v[80:83], v[148:151]
v_exp_f32 v93, v93
v_mfma_f32_16x16x32_bf16 v[148:151], a[204:207], v[84:87], v[148:151]
v_exp_f32 v94, v94
v_mfma_f32_16x16x32_bf16 v[132:135], a[204:207], v[68:71], v[224:227]
ds_read_b128 a[152:155], v3 offset:17408
v_cvt_pk_bf16_f32 v202, v124, v125
v_mfma_f32_16x16x32_bf16 v[132:135], a[200:203], v[64:67], v[132:135]
ds_read_b128 a[156:159], v3 offset:25600
v_cvt_pk_bf16_f32 v203, v126, v127
v_mfma_f32_16x16x32_bf16 v[132:135], a[196:199], v[60:63], v[132:135]
v_exp_f32 v95, v95
v_mfma_f32_16x16x32_bf16 v[132:135], a[192:195], v[56:59], v[132:135]
v_exp_f32 v96, v96
v_mfma_f32_16x16x32_bf16 v[116:119], a[192:195], v[40:43], v[220:223]
v_exp_f32 v97, v97
v_mfma_f32_16x16x32_bf16 v[116:119], a[196:199], v[44:47], v[116:119]
v_exp_f32 v98, v98
v_mfma_f32_16x16x32_bf16 v[116:119], a[200:203], v[48:51], v[116:119]
ds_read_b128 a[160:163], v3 offset:18432
v_cvt_pk_bf16_f32 v178, v108, v109
v_mfma_f32_16x16x32_bf16 v[116:119], a[204:207], v[52:55], v[116:119]
v_exp_f32 v99, v99
v_mfma_f32_16x16x32_bf16 v[100:103], a[204:207], v[36:39], v[216:219]
ds_read_b128 a[164:167], v3 offset:26624
v_cvt_pk_bf16_f32 v179, v110, v111
v_mfma_f32_16x16x32_bf16 v[100:103], a[200:203], v[32:35], v[100:103]
v_exp_f32 v112, v112
v_mfma_f32_16x16x32_bf16 v[100:103], a[196:199], v[28:31], v[100:103]
v_exp_f32 v113, v113
v_mfma_f32_16x16x32_bf16 v[100:103], a[192:195], v[24:27], v[100:103]
v_exp_f32 v114, v114
v_smfmac_f32_16x16x64_bf16 a[128:131], a[240:243], v[152:159], v5
ds_read_b128 a[168:171], v3 offset:19456
v_smfmac_f32_16x16x64_bf16 a[132:135], a[240:243], v[160:167], v5
ds_read_b128 a[172:175], v3 offset:27648
v_smfmac_f32_16x16x64_bf16 a[136:139], a[240:243], v[184:191], v5
ds_read_b128 a[176:179], v3 offset:20480
v_smfmac_f32_16x16x64_bf16 a[140:143], a[240:243], v[192:199], v5
s_waitcnt lgkmcnt(3)
buffer_load_dwordx4 v16, s[32:35], s64 offen offset:2048 sc1 lds
v_mfma_f32_16x16x32_bf16 a[0:3], a[144:147], v[152:155], a[0:3]
v_exp_f32 v115, v115
v_mfma_f32_16x16x32_bf16 a[0:3], a[148:151], v[156:159], a[0:3]
v_exp_f32 v128, v128
v_mfma_f32_16x16x32_bf16 a[32:35], a[148:151], v[164:167], a[32:35]
v_exp_f32 v129, v129
v_mfma_f32_16x16x32_bf16 a[32:35], a[144:147], v[160:163], a[32:35]
v_exp_f32 v130, v130
v_mfma_f32_16x16x32_bf16 a[64:67], a[144:147], v[184:187], a[64:67]
v_exp_f32 v131, v131
v_mfma_f32_16x16x32_bf16 a[64:67], a[148:151], v[188:191], a[64:67]
v_cvt_pk_bf16_f32 v170, v92, v93
v_cvt_pk_bf16_f32 v171, v94, v95
v_mfma_f32_16x16x32_bf16 a[96:99], a[148:151], v[196:199], a[96:99]
v_exp_f32 v144, v144
v_mfma_f32_16x16x32_bf16 a[96:99], a[144:147], v[192:195], a[96:99]
ds_read_b128 a[180:183], v3 offset:28672
v_cvt_pk_bf16_f32 v172, v96, v97
v_mfma_f32_16x16x32_bf16 a[100:103], a[152:155], v[192:195], a[100:103]
v_exp_f32 v145, v145
v_mfma_f32_16x16x32_bf16 a[100:103], a[156:159], v[196:199], a[100:103]
ds_read_b128 a[184:187], v3 offset:21504
v_xor_b32 v2, 0x8000, v2
v_mfma_f32_16x16x32_bf16 a[68:71], a[156:159], v[188:191], a[68:71]
ds_read_b128 a[188:191], v3 offset:29696
v_cvt_pk_bf16_f32 v173, v98, v99
v_mfma_f32_16x16x32_bf16 a[68:71], a[152:155], v[184:187], a[68:71]
buffer_load_dwordx4 v16, s[32:35], s64 offen offset:3072 sc1 lds
v_mfma_f32_16x16x32_bf16 a[36:39], a[152:155], v[160:163], a[36:39]
ds_read_b128 a[192:195], v3 offset:22528
v_cvt_pk_bf16_f32 v180, v112, v113
v_mfma_f32_16x16x32_bf16 a[36:39], a[156:159], v[164:167], a[36:39]
ds_read_b128 a[196:199], v3 offset:30720
v_cvt_pk_bf16_f32 v181, v114, v115
v_mfma_f32_16x16x32_bf16 a[4:7], a[156:159], v[156:159], a[4:7]
ds_read_b128 a[200:203], v3 offset:23552
v_cvt_pk_bf16_f32 v204, v128, v129
v_mfma_f32_16x16x32_bf16 a[4:7], a[152:155], v[152:155], a[4:7]
v_exp_f32 v146, v146
v_mfma_f32_16x16x32_bf16 a[8:11], a[160:163], v[152:155], a[8:11]
v_exp_f32 v147, v147
v_mfma_f32_16x16x32_bf16 a[8:11], a[164:167], v[156:159], a[8:11]
v_exp_f32 v148, v148
v_mfma_f32_16x16x32_bf16 a[40:43], a[164:167], v[164:167], a[40:43]
ds_read_b128 a[204:207], v3 offset:31744
v_cvt_pk_bf16_f32 v205, v130, v131
v_mfma_f32_16x16x32_bf16 a[40:43], a[160:163], v[160:163], a[40:43]
v_exp_f32 v149, v149
v_mfma_f32_16x16x32_bf16 a[72:75], a[160:163], v[184:187], a[72:75]
v_exp_f32 v150, v150
v_mfma_f32_16x16x32_bf16 a[72:75], a[164:167], v[188:191], a[72:75]
v_exp_f32 v151, v151
v_mfma_f32_16x16x32_bf16 a[104:107], a[164:167], v[196:199], a[104:107]
v_exp_f32 v132, v132
v_mfma_f32_16x16x32_bf16 a[104:107], a[160:163], v[192:195], a[104:107]
s_waitcnt lgkmcnt(1)
v_exp_f32 v133, v133
v_mfma_f32_16x16x32_bf16 a[108:111], a[168:171], v[192:195], a[108:111]
v_exp_f32 v134, v134
v_mfma_f32_16x16x32_bf16 a[108:111], a[172:175], v[196:199], a[108:111]
v_exp_f32 v135, v135
v_mfma_f32_16x16x32_bf16 a[76:79], a[172:175], v[188:191], a[76:79]
v_exp_f32 v116, v116
v_mfma_f32_16x16x32_bf16 a[76:79], a[168:171], v[184:187], a[76:79]
v_exp_f32 v117, v117
v_mfma_f32_16x16x32_bf16 a[44:47], a[168:171], v[160:163], a[44:47]
v_exp_f32 v118, v118
v_mfma_f32_16x16x32_bf16 a[44:47], a[172:175], v[164:167], a[44:47]
s_waitcnt vmcnt(8)
s_barrier
v_mfma_f32_16x16x32_bf16 a[12:15], a[172:175], v[156:159], a[12:15]
s_xor_b32 s71, s71, 49152
v_exp_f32 v119, v119
v_mfma_f32_16x16x32_bf16 a[12:15], a[168:171], v[152:155], a[12:15]
s_add_u32 s70, s70, 32768
v_exp_f32 v100, v100
v_mfma_f32_16x16x32_bf16 a[16:19], a[176:179], v[152:155], a[16:19]
s_mov_b32 m0, s71
v_exp_f32 v101, v101
v_mfma_f32_16x16x32_bf16 a[16:19], a[180:183], v[156:159], a[16:19]
buffer_load_dwordx4 v16, s[32:35], s70 offen offset:0 sc1 lds
v_mfma_f32_16x16x32_bf16 a[48:51], a[180:183], v[164:167], a[48:51]
ds_read_b128 a[144:147], v2 offset:0
v_cvt_pk_bf16_f32 v212, v144, v145
v_mfma_f32_16x16x32_bf16 a[48:51], a[176:179], v[160:163], a[48:51]
ds_read_b128 a[148:151], v2 offset:1024
v_cvt_pk_bf16_f32 v213, v146, v147
v_mfma_f32_16x16x32_bf16 a[80:83], a[176:179], v[184:187], a[80:83]
v_exp_f32 v102, v102
v_mfma_f32_16x16x32_bf16 a[80:83], a[180:183], v[188:191], a[80:83]
ds_read_b128 a[152:155], v2 offset:2048
v_cvt_pk_bf16_f32 v214, v148, v149
v_mfma_f32_16x16x32_bf16 a[112:115], a[180:183], v[196:199], a[112:115]
ds_read_b128 a[156:159], v2 offset:3072
v_cvt_pk_bf16_f32 v215, v150, v151
v_mfma_f32_16x16x32_bf16 a[112:115], a[176:179], v[192:195], a[112:115]
v_exp_f32 v103, v103
v_mfma_f32_16x16x32_bf16 a[116:119], a[184:187], v[192:195], a[116:119]
ds_read_b128 a[160:163], v2 offset:4096
v_cvt_pk_bf16_f32 v206, v132, v133
v_mfma_f32_16x16x32_bf16 a[116:119], a[188:191], v[196:199], a[116:119]
ds_read_b128 a[164:167], v2 offset:5120
v_cvt_pk_bf16_f32 v207, v134, v135
v_mfma_f32_16x16x32_bf16 a[84:87], a[188:191], v[188:191], a[84:87]
ds_read_b128 a[168:171], v2 offset:6144
v_xor_b32 v3, 0x8000, v3
v_mfma_f32_16x16x32_bf16 a[84:87], a[184:187], v[184:187], a[84:87]
ds_read_b128 a[172:175], v2 offset:7168
v_cvt_pk_bf16_f32 v182, v116, v117
v_mfma_f32_16x16x32_bf16 a[52:55], a[184:187], v[160:163], a[52:55]
v_cvt_pk_bf16_f32 v183, v118, v119
v_cvt_pk_bf16_f32 v174, v100, v101
v_mfma_f32_16x16x32_bf16 a[52:55], a[188:191], v[164:167], a[52:55]
v_cvt_pk_bf16_f32 v175, v102, v103
v_mfma_f32_16x16x32_bf16 a[20:23], a[188:191], v[156:159], a[20:23]
v_mfma_f32_16x16x32_bf16 a[20:23], a[184:187], v[152:155], a[20:23]
v_mfma_f32_16x16x32_bf16 a[24:27], a[192:195], v[152:155], a[24:27]
buffer_load_dwordx4 v16, s[32:35], s70 offen offset:1024 sc1 lds
v_mfma_f32_16x16x32_bf16 a[24:27], a[196:199], v[156:159], a[24:27]
v_mfma_f32_16x16x32_bf16 a[56:59], a[196:199], v[164:167], a[56:59]
v_mfma_f32_16x16x32_bf16 a[56:59], a[192:195], v[160:163], a[56:59]
v_mfma_f32_16x16x32_bf16 a[88:91], a[192:195], v[184:187], a[88:91]
v_mfma_f32_16x16x32_bf16 a[88:91], a[196:199], v[188:191], a[88:91]
v_mfma_f32_16x16x32_bf16 a[120:123], a[196:199], v[196:199], a[120:123]
s_sub_u32 s72, s72, 1
v_mfma_f32_16x16x32_bf16 a[120:123], a[192:195], v[192:195], a[120:123]
v_mfma_f32_16x16x32_bf16 a[124:127], a[200:203], v[192:195], a[124:127]
s_waitcnt lgkmcnt(0)
v_mfma_f32_16x16x32_bf16 a[124:127], a[204:207], v[196:199], a[124:127]
v_mfma_f32_16x16x32_bf16 a[92:95], a[204:207], v[188:191], a[92:95]
s_cmp_lg_u32 s72, 0
v_mfma_f32_16x16x32_bf16 a[92:95], a[200:203], v[184:187], a[92:95]
v_mfma_f32_16x16x32_bf16 a[60:63], a[200:203], v[160:163], a[60:63]
v_mfma_f32_16x16x32_bf16 a[60:63], a[204:207], v[164:167], a[60:63]
v_mfma_f32_16x16x32_bf16 a[28:31], a[204:207], v[156:159], a[28:31]
v_mfma_f32_16x16x32_bf16 a[28:31], a[200:203], v[152:155], a[28:31]
s_cbranch_scc1 L_D
L_DD:
s_waitcnt lgkmcnt(7)
v_mfma_f32_16x16x32_bf16 v[104:107], a[144:147], v[40:43], v[220:223]
s_waitcnt lgkmcnt(6)
ds_read_b128 a[176:179], v2 offset:8192
v_cndmask_b32 v88, v216, v17, s[0:1]
v_mfma_f32_16x16x32_bf16 v[104:107], a[148:151], v[44:47], v[104:107]
s_waitcnt lgkmcnt(6)
ds_read_b128 a[180:183], v2 offset:9216
v_cndmask_b32 v89, v216, v17, s[4:5]
v_mfma_f32_16x16x32_bf16 v[104:107], a[152:155], v[48:51], v[104:107]
s_waitcnt lgkmcnt(6)
buffer_load_dwordx4 v16, s[32:35], s70 offen offset:2048 sc1 lds
v_mfma_f32_16x16x32_bf16 v[104:107], a[156:159], v[52:55], v[104:107]
ds_read_b128 a[184:187], v2 offset:10240
v_cndmask_b32 v90, v216, v17, s[6:7]
v_mfma_f32_16x16x32_bf16 v[120:123], a[156:159], v[68:71], v[224:227]
ds_read_b128 a[188:191], v2 offset:11264
v_cndmask_b32 v91, v216, v17, s[8:9]
v_mfma_f32_16x16x32_bf16 v[120:123], a[152:155], v[64:67], v[120:123]
ds_read_b128 a[192:195], v2 offset:12288
v_cndmask_b32 v92, v216, v17, s[10:11]
v_mfma_f32_16x16x32_bf16 v[120:123], a[148:151], v[60:63], v[120:123]
ds_read_b128 a[196:199], v2 offset:13312
v_cndmask_b32 v93, v216, v17, s[12:13]
v_mfma_f32_16x16x32_bf16 v[120:123], a[144:147], v[56:59], v[120:123]
ds_read_b128 a[200:203], v2 offset:14336
v_cndmask_b32 v94, v216, v17, s[18:19]
v_mfma_f32_16x16x32_bf16 v[136:139], a[144:147], v[72:75], v[228:231]
ds_read_b128 a[204:207], v2 offset:15360
v_cndmask_b32 v95, v216, v17, s[22:23]
v_mfma_f32_16x16x32_bf16 v[136:139], a[148:151], v[76:79], v[136:139]
v_cndmask_b32 v96, v216, v17, s[26:27]
v_cndmask_b32 v97, v216, v17, s[56:57]
v_mfma_f32_16x16x32_bf16 v[136:139], a[152:155], v[80:83], v[136:139]
v_exp_f32 v104, v104
v_mfma_f32_16x16x32_bf16 v[136:139], a[156:159], v[84:87], v[136:139]
v_exp_f32 v105, v105
v_mfma_f32_16x16x32_bf16 v[88:91], a[156:159], v[36:39], v[88:91]
v_exp_f32 v106, v106
v_mfma_f32_16x16x32_bf16 v[88:91], a[152:155], v[32:35], v[88:91]
v_exp_f32 v107, v107
v_mfma_f32_16x16x32_bf16 v[88:91], a[148:151], v[28:31], v[88:91]
v_exp_f32 v120, v120
v_mfma_f32_16x16x32_bf16 v[88:91], a[144:147], v[24:27], v[88:91]
s_waitcnt lgkmcnt(0)
v_exp_f32 v121, v121
v_mfma_f32_16x16x32_bf16 v[140:143], a[160:163], v[72:75], v[228:231]
v_exp_f32 v122, v122
v_mfma_f32_16x16x32_bf16 v[140:143], a[164:167], v[76:79], v[140:143]
buffer_load_dwordx4 v16, s[32:35], s70 offen offset:3072 sc1 lds
v_mfma_f32_16x16x32_bf16 v[140:143], a[168:171], v[80:83], v[140:143]
s_add_u32 m0, s86, 131072
v_exp_f32 v123, v123
v_mfma_f32_16x16x32_bf16 v[140:143], a[172:175], v[84:87], v[140:143]
s_add_u32 s64, s85, 0
v_cvt_pk_bf16_f32 v160, v104, v105
v_cvt_pk_bf16_f32 v161, v106, v107
v_mfma_f32_16x16x32_bf16 v[124:127], a[172:175], v[68:71], v[224:227]
buffer_load_dwordx4 v12, s[36:39], s64 offen lds
v_mfma_f32_16x16x32_bf16 v[124:127], a[168:171], v[64:67], v[124:127]
s_add_u32 m0, s86, 132096
v_exp_f32 v136, v136
v_mfma_f32_16x16x32_bf16 v[124:127], a[164:167], v[60:63], v[124:127]
s_add_u32 s64, s85, 8192
v_exp_f32 v137, v137
v_mfma_f32_16x16x32_bf16 v[124:127], a[160:163], v[56:59], v[124:127]
buffer_load_dwordx4 v13, s[36:39], s64 offen lds
v_mfma_f32_16x16x32_bf16 v[108:111], a[160:163], v[40:43], v[220:223]
v_exp_f32 v138, v138
v_mfma_f32_16x16x32_bf16 v[108:111], a[164:167], v[44:47], v[108:111]
ds_read_b128 a[144:147], v3 offset:0
v_cndmask_b32 v98, v216, v17, s[58:59]
v_mfma_f32_16x16x32_bf16 v[108:111], a[168:171], v[48:51], v[108:111]
s_add_u32 m0, s86, 133120
ds_read_b128 a[148:151], v3 offset:8192
v_cndmask_b32 v99, v216, v17, s[60:61]
v_mfma_f32_16x16x32_bf16 v[108:111], a[172:175], v[52:55], v[108:111]
s_add_u32 s64, s85, 16384
v_cvt_pk_bf16_f32 v184, v120, v121
v_cvt_pk_bf16_f32 v185, v122, v123
v_mfma_f32_16x16x32_bf16 v[92:95], a[172:175], v[36:39], v[92:95]
buffer_load_dwordx4 v12, s[36:39], s64 offen lds
v_mfma_f32_16x16x32_bf16 v[92:95], a[168:171], v[32:35], v[92:95]
s_add_u32 m0, s86, 134144
v_exp_f32 v139, v139
v_mfma_f32_16x16x32_bf16 v[92:95], a[164:167], v[28:31], v[92:95]
s_add_u32 s64, s85, 24576
v_exp_f32 v88, v88
v_mfma_f32_16x16x32_bf16 v[92:95], a[160:163], v[24:27], v[92:95]
buffer_load_dwordx4 v13, s[36:39], s64 offen lds
v_mfma_f32_16x16x32_bf16 v[96:99], a[176:179], v[24:27], v[96:99]
s_add_u32 m0, s71, 4096
v_exp_f32 v89, v89
v_mfma_f32_16x16x32_bf16 v[96:99], a[180:183], v[28:31], v[96:99]
s_add_u32 s64, s70, 4096
v_exp_f32 v90, v90
v_mfma_f32_16x16x32_bf16 v[96:99], a[184:187], v[32:35], v[96:99]
buffer_load_dwordx4 v16, s[32:35], s64 offen offset:0 sc1 lds
v_mfma_f32_16x16x32_bf16 v[96:99], a[188:191], v[36:39], v[96:99]
v_cvt_pk_bf16_f32 v192, v136, v137
v_cvt_pk_bf16_f32 v193, v138, v139
v_mfma_f32_16x16x32_bf16 v[112:115], a[188:191], v[52:55], v[220:223]
v_exp_f32 v91, v91
v_mfma_f32_16x16x32_bf16 v[112:115], a[184:187], v[48:51], v[112:115]
v_exp_f32 v140, v140
v_mfma_f32_16x16x32_bf16 v[112:115], a[180:183], v[44:47], v[112:115]
v_exp_f32 v141, v141
v_mfma_f32_16x16x32_bf16 v[112:115], a[176:179], v[40:43], v[112:115]
v_exp_f32 v142, v142
v_mfma_f32_16x16x32_bf16 v[128:131], a[176:179], v[56:59], v[224:227]
v_exp_f32 v143, v143
v_mfma_f32_16x16x32_bf16 v[128:131], a[180:183], v[60:63], v[128:131]
v_exp_f32 v124, v124
v_mfma_f32_16x16x32_bf16 v[128:131], a[184:187], v[64:67], v[128:131]
v_cvt_pk_bf16_f32 v152, v88, v89
v_cvt_pk_bf16_f32 v153, v90, v91
v_mfma_f32_16x16x32_bf16 v[128:131], a[188:191], v[68:71], v[128:131]
v_exp_f32 v125, v125
v_mfma_f32_16x16x32_bf16 v[144:147], a[188:191], v[84:87], v[228:231]
v_exp_f32 v126, v126
v_mfma_f32_16x16x32_bf16 v[144:147], a[184:187], v[80:83], v[144:147]
v_exp_f32 v127, v127
v_mfma_f32_16x16x32_bf16 v[144:147], a[180:183], v[76:79], v[144:147]
v_exp_f32 v108, v108
v_mfma_f32_16x16x32_bf16 v[144:147], a[176:179], v[72:75], v[144:147]
ds_read_b128 a[152:155], v3 offset:1024
v_cndmask_b32 v100, v216, v17, s[62:63]
v_mfma_f32_16x16x32_bf16 v[148:151], a[192:195], v[72:75], v[228:231]
buffer_load_dwordx4 v16, s[32:35], s64 offen offset:1024 sc1 lds
v_mfma_f32_16x16x32_bf16 v[148:151], a[196:199], v[76:79], v[148:151]
ds_read_b128 a[156:159], v3 offset:9216
v_cndmask_b32 v101, v216, v17, s[48:49]
v_mfma_f32_16x16x32_bf16 v[148:151], a[200:203], v[80:83], v[148:151]
v_cvt_pk_bf16_f32 v194, v140, v141
v_cvt_pk_bf16_f32 v195, v142, v143
v_mfma_f32_16x16x32_bf16 v[148:151], a[204:207], v[84:87], v[148:151]
ds_read_b128 a[160:163], v3 offset:2048
v_cndmask_b32 v102, v216, v17, s[50:51]
v_mfma_f32_16x16x32_bf16 v[132:135], a[204:207], v[68:71], v[224:227]
ds_read_b128 a[164:167], v3 offset:10240
v_cndmask_b32 v103, v216, v17, s[100:101]
v_mfma_f32_16x16x32_bf16 v[132:135], a[200:203], v[64:67], v[132:135]
v_exp_f32 v109, v109
v_mfma_f32_16x16x32_bf16 v[132:135], a[196:199], v[60:63], v[132:135]
v_exp_f32 v110, v110
v_mfma_f32_16x16x32_bf16 v[132:135], a[192:195], v[56:59], v[132:135]
v_exp_f32 v111, v111
v_mfma_f32_16x16x32_bf16 v[116:119], a[192:195], v[40:43], v[220:223]
v_exp_f32 v92, v92
v_mfma_f32_16x16x32_bf16 v[116:119], a[196:199], v[44:47], v[116:119]
v_cvt_pk_bf16_f32 v186, v124, v125
v_cvt_pk_bf16_f32 v187, v126, v127
v_mfma_f32_16x16x32_bf16 v[116:119], a[200:203], v[48:51], v[116:119]
v_exp_f32 v93, v93
v_mfma_f32_16x16x32_bf16 v[116:119], a[204:207], v[52:55], v[116:119]
v_exp_f32 v94, v94
v_mfma_f32_16x16x32_bf16 v[100:103], a[204:207], v[36:39], v[100:103]
v_exp_f32 v95, v95
v_mfma_f32_16x16x32_bf16 v[100:103], a[200:203], v[32:35], v[100:103]
v_exp_f32 v96, v96
v_mfma_f32_16x16x32_bf16 v[100:103], a[196:199], v[28:31], v[100:103]
v_exp_f32 v97, v97
v_mfma_f32_16x16x32_bf16 v[100:103], a[192:195], v[24:27], v[100:103]
v_exp_f32 v98, v98
v_smfmac_f32_16x16x64_bf16 a[128:131], a[240:243], v[168:175], v5
ds_read_b128 a[168:171], v3 offset:3072
v_smfmac_f32_16x16x64_bf16 a[132:135], a[240:243], v[176:183], v5
v_cvt_pk_bf16_f32 v162, v108, v109
v_smfmac_f32_16x16x64_bf16 a[136:139], a[240:243], v[200:207], v5
ds_read_b128 a[172:175], v3 offset:11264
v_smfmac_f32_16x16x64_bf16 a[140:143], a[240:243], v[208:215], v5
s_waitcnt lgkmcnt(2)
buffer_load_dwordx4 v16, s[32:35], s64 offen offset:2048 sc1 lds
v_mfma_f32_16x16x32_bf16 a[0:3], a[144:147], v[168:171], a[0:3]
v_exp_f32 v99, v99
v_mfma_f32_16x16x32_bf16 a[0:3], a[148:151], v[172:175], a[0:3]
v_cvt_pk_bf16_f32 v163, v110, v111
v_cvt_pk_bf16_f32 v154, v92, v93
v_mfma_f32_16x16x32_bf16 a[32:35], a[148:151], v[180:183], a[32:35]
v_exp_f32 v112, v112
v_mfma_f32_16x16x32_bf16 a[32:35], a[144:147], v[176:179], a[32:35]
v_exp_f32 v113, v113
v_mfma_f32_16x16x32_bf16 a[64:67], a[144:147], v[200:203], a[64:67]
v_exp_f32 v114, v114
v_mfma_f32_16x16x32_bf16 a[64:67], a[148:151], v[204:207], a[64:67]
v_exp_f32 v115, v115
v_mfma_f32_16x16x32_bf16 a[96:99], a[148:151], v[212:215], a[96:99]
v_exp_f32 v128, v128
v_mfma_f32_16x16x32_bf16 a[96:99], a[144:147], v[208:211], a[96:99]
v_exp_f32 v129, v129
v_mfma_f32_16x16x32_bf16 a[100:103], a[152:155], v[208:211], a[100:103]
v_exp_f32 v130, v130
v_mfma_f32_16x16x32_bf16 a[100:103], a[156:159], v[212:215], a[100:103]
v_cvt_pk_bf16_f32 v155, v94, v95
v_cvt_pk_bf16_f32 v156, v96, v97
v_mfma_f32_16x16x32_bf16 a[68:71], a[156:159], v[204:207], a[68:71]
v_exp_f32 v131, v131
v_mfma_f32_16x16x32_bf16 a[68:71], a[152:155], v[200:203], a[68:71]
buffer_load_dwordx4 v16, s[32:35], s64 offen offset:3072 sc1 lds
v_mfma_f32_16x16x32_bf16 a[36:39], a[152:155], v[176:179], a[36:39]
s_add_u32 m0, s86, 135168
ds_read_b128 a[176:179], v3 offset:4096
v_cvt_pk_bf16_f32 v157, v98, v99
v_mfma_f32_16x16x32_bf16 a[36:39], a[156:159], v[180:183], a[36:39]
s_add_u32 s64, s85, 32768
v_exp_f32 v144, v144
v_mfma_f32_16x16x32_bf16 a[4:7], a[156:159], v[172:175], a[4:7]
buffer_load_dwordx4 v12, s[36:39], s64 offen lds
v_mfma_f32_16x16x32_bf16 a[4:7], a[152:155], v[168:171], a[4:7]
s_add_u32 m0, s86, 136192
ds_read_b128 a[180:183], v3 offset:12288
v_cvt_pk_bf16_f32 v164, v112, v113
v_mfma_f32_16x16x32_bf16 a[8:11], a[160:163], v[168:171], a[8:11]
s_add_u32 s64, s85, 40960
v_exp_f32 v145, v145
v_mfma_f32_16x16x32_bf16 a[8:11], a[164:167], v[172:175], a[8:11]
buffer_load_dwordx4 v13, s[36:39], s64 offen lds
v_mfma_f32_16x16x32_bf16 a[40:43], a[164:167], v[180:183], a[40:43]
ds_read_b128 a[184:187], v3 offset:5120
v_cvt_pk_bf16_f32 v165, v114, v115
v_mfma_f32_16x16x32_bf16 a[40:43], a[160:163], v[176:179], a[40:43]
ds_read_b128 a[188:191], v3 offset:13312
v_cvt_pk_bf16_f32 v188, v128, v129
v_mfma_f32_16x16x32_bf16 a[72:75], a[160:163], v[200:203], a[72:75]
ds_read_b128 a[192:195], v3 offset:6144
v_cvt_pk_bf16_f32 v189, v130, v131
v_mfma_f32_16x16x32_bf16 a[72:75], a[164:167], v[204:207], a[72:75]
ds_read_b128 a[196:199], v3 offset:14336
v_cvt_pk_bf16_f32 v196, v144, v145
v_mfma_f32_16x16x32_bf16 a[104:107], a[164:167], v[212:215], a[104:107]
ds_read_b128 a[200:203], v3 offset:7168
v_mfma_f32_16x16x32_bf16 a[104:107], a[160:163], v[208:211], a[104:107]
s_waitcnt lgkmcnt(5)
s_add_u32 m0, s86, 137216
ds_read_b128 a[204:207], v3 offset:15360
v_mfma_f32_16x16x32_bf16 a[108:111], a[168:171], v[208:211], a[108:111]
s_add_u32 s64, s85, 49152
v_exp_f32 v146, v146
v_mfma_f32_16x16x32_bf16 a[108:111], a[172:175], v[212:215], a[108:111]
buffer_load_dwordx4 v12, s[36:39], s64 offen lds
v_mfma_f32_16x16x32_bf16 a[76:79], a[172:175], v[204:207], a[76:79]
s_add_u32 m0, s86, 138240
v_exp_f32 v147, v147
v_mfma_f32_16x16x32_bf16 a[76:79], a[168:171], v[200:203], a[76:79]
s_add_u32 s64, s85, 57344
v_exp_f32 v148, v148
v_mfma_f32_16x16x32_bf16 a[44:47], a[168:171], v[176:179], a[44:47]
buffer_load_dwordx4 v13, s[36:39], s64 offen lds
v_mfma_f32_16x16x32_bf16 a[44:47], a[172:175], v[180:183], a[44:47]
s_waitcnt vmcnt(16)
s_barrier
v_mfma_f32_16x16x32_bf16 a[12:15], a[172:175], v[172:175], a[12:15]
s_xor_b32 s71, s71, 16384
v_exp_f32 v149, v149
v_mfma_f32_16x16x32_bf16 a[12:15], a[168:171], v[168:171], a[12:15]
s_add_u32 s70, s70, 32768
v_exp_f32 v150, v150
v_mfma_f32_16x16x32_bf16 a[16:19], a[176:179], v[168:171], a[16:19]
s_mov_b32 m0, s71
v_exp_f32 v151, v151
v_mfma_f32_16x16x32_bf16 a[16:19], a[180:183], v[172:175], a[16:19]
buffer_load_dwordx4 v16, s[32:35], s70 offen offset:0 sc1 lds
v_mfma_f32_16x16x32_bf16 a[48:51], a[180:183], v[180:183], a[48:51]
v_exp_f32 v132, v132
v_mfma_f32_16x16x32_bf16 a[48:51], a[176:179], v[176:179], a[48:51]
v_exp_f32 v133, v133
v_mfma_f32_16x16x32_bf16 a[80:83], a[176:179], v[200:203], a[80:83]
v_exp_f32 v134, v134
v_mfma_f32_16x16x32_bf16 a[80:83], a[180:183], v[204:207], a[80:83]
v_exp_f32 v135, v135
v_mfma_f32_16x16x32_bf16 a[112:115], a[180:183], v[212:215], a[112:115]
v_exp_f32 v116, v116
v_mfma_f32_16x16x32_bf16 a[112:115], a[176:179], v[208:211], a[112:115]
s_waitcnt lgkmcnt(0)
v_cvt_pk_bf16_f32 v197, v146, v147
v_cvt_pk_bf16_f32 v198, v148, v149
v_mfma_f32_16x16x32_bf16 a[116:119], a[184:187], v[208:211], a[116:119]
v_exp_f32 v117, v117
v_mfma_f32_16x16x32_bf16 a[116:119], a[188:191], v[212:215], a[116:119]
v_exp_f32 v118, v118
v_mfma_f32_16x16x32_bf16 a[84:87], a[188:191], v[204:207], a[84:87]
v_exp_f32 v119, v119
v_mfma_f32_16x16x32_bf16 a[84:87], a[184:187], v[200:203], a[84:87]
v_exp_f32 v100, v100
v_mfma_f32_16x16x32_bf16 a[52:55], a[184:187], v[176:179], a[52:55]
v_exp_f32 v101, v101
v_mfma_f32_16x16x32_bf16 a[52:55], a[188:191], v[180:183], a[52:55]
ds_read_b128 a[144:147], v2 offset:16384
v_cvt_pk_bf16_f32 v199, v150, v151
v_mfma_f32_16x16x32_bf16 a[20:23], a[188:191], v[172:175], a[20:23]
ds_read_b128 a[148:151], v2 offset:17408
v_cvt_pk_bf16_f32 v190, v132, v133
v_mfma_f32_16x16x32_bf16 a[20:23], a[184:187], v[168:171], a[20:23]
v_exp_f32 v102, v102
v_mfma_f32_16x16x32_bf16 a[24:27], a[192:195], v[168:171], a[24:27]
buffer_load_dwordx4 v16, s[32:35], s70 offen offset:1024 sc1 lds
v_mfma_f32_16x16x32_bf16 a[24:27], a[196:199], v[172:175], a[24:27]
ds_read_b128 a[152:155], v2 offset:18432
v_cvt_pk_bf16_f32 v191, v134, v135
v_mfma_f32_16x16x32_bf16 a[56:59], a[196:199], v[180:183], a[56:59]
ds_read_b128 a[156:159], v2 offset:19456
v_cvt_pk_bf16_f32 v166, v116, v117
v_mfma_f32_16x16x32_bf16 a[56:59], a[192:195], v[176:179], a[56:59]
v_exp_f32 v103, v103
v_mfma_f32_16x16x32_bf16 a[88:91], a[192:195], v[200:203], a[88:91]
ds_read_b128 a[160:163], v2 offset:20480
v_cvt_pk_bf16_f32 v167, v118, v119
v_mfma_f32_16x16x32_bf16 a[88:91], a[196:199], v[204:207], a[88:91]
ds_read_b128 a[164:167], v2 offset:21504
v_cvt_pk_bf16_f32 v158, v100, v101
v_mfma_f32_16x16x32_bf16 a[120:123], a[196:199], v[212:215], a[120:123]
ds_read_b128 a[168:171], v2 offset:22528
v_cvt_pk_bf16_f32 v159, v102, v103
v_mfma_f32_16x16x32_bf16 a[120:123], a[192:195], v[208:211], a[120:123]
ds_read_b128 a[172:175], v2 offset:23552
v_cndmask_b32 v104, v220, v17, s[0:1]
v_mfma_f32_16x16x32_bf16 a[124:127], a[200:203], v[208:211], a[124:127]
v_cndmask_b32 v105, v220, v17, s[4:5]
v_cndmask_b32 v106, v220, v17, s[6:7]
v_mfma_f32_16x16x32_bf16 a[124:127], a[204:207], v[212:215], a[124:127]
v_cndmask_b32 v107, v220, v17, s[8:9]
v_cndmask_b32 v108, v220, v17, s[10:11]
v_mfma_f32_16x16x32_bf16 a[92:95], a[204:207], v[204:207], a[92:95]
v_cndmask_b32 v109, v220, v17, s[12:13]
v_cndmask_b32 v110, v220, v17, s[18:19]
v_mfma_f32_16x16x32_bf16 a[92:95], a[200:203], v[200:203], a[92:95]
v_cndmask_b32 v111, v220, v17, s[22:23]
v_cndmask_b32 v112, v220, v17, s[26:27]
v_mfma_f32_16x16x32_bf16 a[60:63], a[200:203], v[176:179], a[60:63]
v_cndmask_b32 v113, v220, v17, s[56:57]
v_cndmask_b32 v114, v220, v17, s[58:59]
v_mfma_f32_16x16x32_bf16 a[60:63], a[204:207], v[180:183], a[60:63]
v_cndmask_b32 v115, v220, v17, s[60:61]
v_cndmask_b32 v116, v220, v17, s[62:63]
v_mfma_f32_16x16x32_bf16 a[28:31], a[204:207], v[172:175], a[28:31]
v_cndmask_b32 v117, v220, v17, s[48:49]
v_cndmask_b32 v118, v220, v17, s[50:51]
v_mfma_f32_16x16x32_bf16 a[28:31], a[200:203], v[168:171], a[28:31]
s_waitcnt lgkmcnt(0)
v_cndmask_b32 v119, v220, v17, s[100:101]
v_mfma_f32_16x16x32_bf16 v[120:123], a[144:147], v[56:59], v[224:227]
ds_read_b128 a[176:179], v2 offset:24576
v_mfma_f32_16x16x32_bf16 v[120:123], a[148:151], v[60:63], v[120:123]
ds_read_b128 a[180:183], v2 offset:25600
v_mfma_f32_16x16x32_bf16 v[120:123], a[152:155], v[64:67], v[120:123]
buffer_load_dwordx4 v16, s[32:35], s70 offen offset:2048 sc1 lds
v_mfma_f32_16x16x32_bf16 v[120:123], a[156:159], v[68:71], v[120:123]
ds_read_b128 a[184:187], v2 offset:26624
v_mfma_f32_16x16x32_bf16 v[136:139], a[156:159], v[84:87], v[228:231]
ds_read_b128 a[188:191], v2 offset:27648
v_mfma_f32_16x16x32_bf16 v[136:139], a[152:155], v[80:83], v[136:139]
v_mfma_f32_16x16x32_bf16 v[136:139], a[148:151], v[76:79], v[136:139]
v_mfma_f32_16x16x32_bf16 v[136:139], a[144:147], v[72:75], v[136:139]
v_mfma_f32_16x16x32_bf16 v[104:107], a[144:147], v[40:43], v[104:107]
ds_read_b128 a[192:195], v2 offset:28672
v_mfma_f32_16x16x32_bf16 v[104:107], a[148:151], v[44:47], v[104:107]
v_mfma_f32_16x16x32_bf16 v[104:107], a[152:155], v[48:51], v[104:107]
v_exp_f32 v120, v120
v_mfma_f32_16x16x32_bf16 v[104:107], a[156:159], v[52:55], v[104:107]
v_exp_f32 v121, v121
v_mfma_f32_16x16x32_bf16 v[140:143], a[172:175], v[84:87], v[228:231]
v_exp_f32 v122, v122
v_mfma_f32_16x16x32_bf16 v[140:143], a[168:171], v[80:83], v[140:143]
v_exp_f32 v123, v123
v_mfma_f32_16x16x32_bf16 v[140:143], a[164:167], v[76:79], v[140:143]
v_exp_f32 v136, v136
v_mfma_f32_16x16x32_bf16 v[140:143], a[160:163], v[72:75], v[140:143]
buffer_load_dwordx4 v16, s[32:35], s70 offen offset:3072 sc1 lds
v_mfma_f32_16x16x32_bf16 v[124:127], a[160:163], v[56:59], v[224:227]
v_exp_f32 v137, v137
v_mfma_f32_16x16x32_bf16 v[124:127], a[164:167], v[60:63], v[124:127]
v_exp_f32 v138, v138
v_mfma_f32_16x16x32_bf16 v[124:127], a[168:171], v[64:67], v[124:127]
v_exp_f32 v139, v139
v_mfma_f32_16x16x32_bf16 v[124:127], a[172:175], v[68:71], v[124:127]
v_exp_f32 v104, v104
v_mfma_f32_16x16x32_bf16 v[108:111], a[172:175], v[52:55], v[108:111]
v_cvt_pk_bf16_f32 v200, v120, v121
v_cvt_pk_bf16_f32 v201, v122, v123
v_mfma_f32_16x16x32_bf16 v[108:111], a[168:171], v[48:51], v[108:111]
ds_read_b128 a[196:199], v2 offset:29696
v_cvt_pk_bf16_f32 v208, v136, v137
v_mfma_f32_16x16x32_bf16 v[108:111], a[164:167], v[44:47], v[108:111]
ds_read_b128 a[200:203], v2 offset:30720
v_cvt_pk_bf16_f32 v209, v138, v139
v_mfma_f32_16x16x32_bf16 v[108:111], a[160:163], v[40:43], v[108:111]
s_waitcnt lgkmcnt(2)
ds_read_b128 a[204:207], v2 offset:31744
v_mfma_f32_16x16x32_bf16 v[112:115], a[176:179], v[40:43], v[112:115]
v_exp_f32 v105, v105
v_mfma_f32_16x16x32_bf16 v[112:115], a[180:183], v[44:47], v[112:115]
v_exp_f32 v106, v106
v_mfma_f32_16x16x32_bf16 v[112:115], a[184:187], v[48:51], v[112:115]
v_exp_f32 v107, v107
v_mfma_f32_16x16x32_bf16 v[112:115], a[188:191], v[52:55], v[112:115]
s_add_u32 m0, s71, 4096
v_exp_f32 v140, v140
v_mfma_f32_16x16x32_bf16 v[128:131], a[188:191], v[68:71], v[224:227]
s_branch L_po17
L_pg17:
s_branch L_pg21
L_po17:
s_add_u32 s64, s70, 4096
v_exp_f32 v141, v141
v_mfma_f32_16x16x32_bf16 v[128:131], a[184:187], v[64:67], v[128:131]
buffer_load_dwordx4 v16, s[32:35], s64 offen offset:0 sc1 lds
v_mfma_f32_16x16x32_bf16 v[128:131], a[180:183], v[60:63], v[128:131]
v_exp_f32 v142, v142
v_mfma_f32_16x16x32_bf16 v[128:131], a[176:179], v[56:59], v[128:131]
v_exp_f32 v143, v143
v_mfma_f32_16x16x32_bf16 v[144:147], a[176:179], v[72:75], v[228:231]
ds_read_b128 a[144:147], v3 offset:16384
v_cvt_pk_bf16_f32 v176, v104, v105
v_mfma_f32_16x16x32_bf16 v[144:147], a[180:183], v[76:79], v[144:147]
ds_read_b128 a[148:151], v3 offset:24576
v_cvt_pk_bf16_f32 v177, v106, v107
v_mfma_f32_16x16x32_bf16 v[144:147], a[184:187], v[80:83], v[144:147]
v_exp_f32 v124, v124
v_mfma_f32_16x16x32_bf16 v[144:147], a[188:191], v[84:87], v[144:147]
s_waitcnt lgkmcnt(2)
v_exp_f32 v125, v125
v_mfma_f32_16x16x32_bf16 v[148:151], a[204:207], v[84:87], v[228:231]
v_exp_f32 v126, v126
v_mfma_f32_16x16x32_bf16 v[148:151], a[200:203], v[80:83], v[148:151]
v_exp_f32 v127, v127
v_mfma_f32_16x16x32_bf16 v[148:151], a[196:199], v[76:79], v[148:151]
ds_read_b128 a[152:155], v3 offset:17408
v_cvt_pk_bf16_f32 v210, v140, v141
v_mfma_f32_16x16x32_bf16 v[148:151], a[192:195], v[72:75], v[148:151]
ds_read_b128 a[156:159], v3 offset:25600
v_cvt_pk_bf16_f32 v211, v142, v143
v_mfma_f32_16x16x32_bf16 v[132:135], a[192:195], v[56:59], v[224:227]
v_exp_f32 v108, v108
v_mfma_f32_16x16x32_bf16 v[132:135], a[196:199], v[60:63], v[132:135]
v_exp_f32 v109, v109
v_mfma_f32_16x16x32_bf16 v[132:135], a[200:203], v[64:67], v[132:135]
buffer_load_dwordx4 v16, s[32:35], s64 offen offset:1024 sc1 lds
v_mfma_f32_16x16x32_bf16 v[132:135], a[204:207], v[68:71], v[132:135]
v_exp_f32 v110, v110
v_mfma_f32_16x16x32_bf16 v[116:119], a[204:207], v[52:55], v[116:119]
ds_read_b128 a[160:163], v3 offset:18432
v_cvt_pk_bf16_f32 v202, v124, v125
v_mfma_f32_16x16x32_bf16 v[116:119], a[200:203], v[48:51], v[116:119]
v_exp_f32 v111, v111
v_mfma_f32_16x16x32_bf16 v[116:119], a[196:199], v[44:47], v[116:119]
ds_read_b128 a[164:167], v3 offset:26624
v_cvt_pk_bf16_f32 v203, v126, v127
v_mfma_f32_16x16x32_bf16 v[116:119], a[192:195], v[40:43], v[116:119]
v_exp_f32 v112, v112
v_smfmac_f32_16x16x64_bf16 a[128:131], a[240:243], v[152:159], v5
ds_read_b128 a[168:171], v3 offset:19456
v_smfmac_f32_16x16x64_bf16 a[132:135], a[240:243], v[160:167], v5
ds_read_b128 a[172:175], v3 offset:27648
v_smfmac_f32_16x16x64_bf16 a[136:139], a[240:243], v[184:191], v5
ds_read_b128 a[176:179], v3 offset:20480
v_smfmac_f32_16x16x64_bf16 a[140:143], a[240:243], v[192:199], v5
s_waitcnt lgkmcnt(4)
ds_read_b128 a[180:183], v3 offset:28672
v_xor_b32 v2, 0x8000, v2
v_mfma_f32_16x16x32_bf16 a[0:3], a[144:147], v[152:155], a[0:3]
v_exp_f32 v113, v113
v_mfma_f32_16x16x32_bf16 a[0:3], a[148:151], v[156:159], a[0:3]
v_exp_f32 v114, v114
v_mfma_f32_16x16x32_bf16 a[32:35], a[148:151], v[164:167], a[32:35]
v_exp_f32 v115, v115
v_mfma_f32_16x16x32_bf16 a[32:35], a[144:147], v[160:163], a[32:35]
v_exp_f32 v128, v128
v_mfma_f32_16x16x32_bf16 a[64:67], a[144:147], v[184:187], a[64:67]
buffer_load_dwordx4 v16, s[32:35], s64 offen offset:2048 sc1 lds
v_mfma_f32_16x16x32_bf16 a[64:67], a[148:151], v[188:191], a[64:67]
v_exp_f32 v129, v129
v_mfma_f32_16x16x32_bf16 a[96:99], a[148:151], v[196:199], a[96:99]
v_exp_f32 v130, v130
v_mfma_f32_16x16x32_bf16 a[96:99], a[144:147], v[192:195], a[96:99]
v_exp_f32 v131, v131
v_mfma_f32_16x16x32_bf16 a[100:103], a[152:155], v[192:195], a[100:103]
v_exp_f32 v144, v144
v_mfma_f32_16x16x32_bf16 a[100:103], a[156:159], v[196:199], a[100:103]
v_exp_f32 v145, v145
v_mfma_f32_16x16x32_bf16 a[68:71], a[156:159], v[188:191], a[68:71]
ds_read_b128 a[184:187], v3 offset:21504
v_cvt_pk_bf16_f32 v178, v108, v109
v_mfma_f32_16x16x32_bf16 a[68:71], a[152:155], v[184:187], a[68:71]
ds_read_b128 a[188:191], v3 offset:29696
v_cvt_pk_bf16_f32 v179, v110, v111
v_mfma_f32_16x16x32_bf16 a[36:39], a[152:155], v[160:163], a[36:39]
ds_read_b128 a[192:195], v3 offset:22528
v_cvt_pk_bf16_f32 v180, v112, v113
v_mfma_f32_16x16x32_bf16 a[36:39], a[156:159], v[164:167], a[36:39]
v_exp_f32 v146, v146
v_mfma_f32_16x16x32_bf16 a[4:7], a[156:159], v[156:159], a[4:7]
v_exp_f32 v147, v147
v_mfma_f32_16x16x32_bf16 a[4:7], a[152:155], v[152:155], a[4:7]
v_exp_f32 v148, v148
v_mfma_f32_16x16x32_bf16 a[8:11], a[160:163], v[152:155], a[8:11]
s_waitcnt lgkmcnt(2)
ds_read_b128 a[196:199], v3 offset:30720
v_cvt_pk_bf16_f32 v181, v114, v115
v_mfma_f32_16x16x32_bf16 a[8:11], a[164:167], v[156:159], a[8:11]
buffer_load_dwordx4 v16, s[32:35], s64 offen offset:3072 sc1 lds
v_mfma_f32_16x16x32_bf16 a[40:43], a[164:167], v[164:167], a[40:43]
v_exp_f32 v149, v149
v_mfma_f32_16x16x32_bf16 a[40:43], a[160:163], v[160:163], a[40:43]
ds_read_b128 a[200:203], v3 offset:23552
v_cvt_pk_bf16_f32 v204, v128, v129
v_mfma_f32_16x16x32_bf16 a[72:75], a[160:163], v[184:187], a[72:75]
v_exp_f32 v150, v150
v_mfma_f32_16x16x32_bf16 a[72:75], a[164:167], v[188:191], a[72:75]
v_exp_f32 v151, v151
v_mfma_f32_16x16x32_bf16 a[104:107], a[164:167], v[196:199], a[104:107]
v_exp_f32 v132, v132
v_mfma_f32_16x16x32_bf16 a[104:107], a[160:163], v[192:195], a[104:107]
ds_read_b128 a[204:207], v3 offset:31744
v_cvt_pk_bf16_f32 v205, v130, v131
v_mfma_f32_16x16x32_bf16 a[108:111], a[168:171], v[192:195], a[108:111]
v_exp_f32 v133, v133
v_mfma_f32_16x16x32_bf16 a[108:111], a[172:175], v[196:199], a[108:111]
v_exp_f32 v134, v134
v_mfma_f32_16x16x32_bf16 a[76:79], a[172:175], v[188:191], a[76:79]
v_exp_f32 v135, v135
v_mfma_f32_16x16x32_bf16 a[76:79], a[168:171], v[184:187], a[76:79]
v_exp_f32 v116, v116
v_mfma_f32_16x16x32_bf16 a[44:47], a[168:171], v[160:163], a[44:47]
v_exp_f32 v117, v117
v_mfma_f32_16x16x32_bf16 a[44:47], a[172:175], v[164:167], a[44:47]
v_exp_f32 v118, v118
v_mfma_f32_16x16x32_bf16 a[12:15], a[172:175], v[156:159], a[12:15]
v_exp_f32 v119, v119
v_mfma_f32_16x16x32_bf16 a[12:15], a[168:171], v[152:155], a[12:15]
v_cvt_pk_bf16_f32 v212, v144, v145
v_cvt_pk_bf16_f32 v213, v146, v147
v_mfma_f32_16x16x32_bf16 a[16:19], a[176:179], v[152:155], a[16:19]
v_cvt_pk_bf16_f32 v214, v148, v149
v_cvt_pk_bf16_f32 v215, v150, v151
v_mfma_f32_16x16x32_bf16 a[16:19], a[180:183], v[156:159], a[16:19]
s_waitcnt vmcnt(12)
s_barrier
v_mfma_f32_16x16x32_bf16 a[48:51], a[180:183], v[164:167], a[48:51]
s_xor_b32 s71, s71, 49152
ds_read_b128 a[144:147], v2 offset:0
v_cvt_pk_bf16_f32 v206, v132, v133
v_mfma_f32_16x16x32_bf16 a[48:51], a[176:179], v[160:163], a[48:51]
s_add_u32 s70, s70, 32768
ds_read_b128 a[148:151], v2 offset:1024
v_cvt_pk_bf16_f32 v207, v134, v135
v_mfma_f32_16x16x32_bf16 a[80:83], a[176:179], v[184:187], a[80:83]
s_mov_b32 m0, s71
ds_read_b128 a[152:155], v2 offset:2048
v_cvt_pk_bf16_f32 v182, v116, v117
v_mfma_f32_16x16x32_bf16 a[80:83], a[180:183], v[188:191], a[80:83]
buffer_load_dwordx4 v16, s[32:35], s70 offen offset:0 sc1 lds
v_mfma_f32_16x16x32_bf16 a[112:115], a[180:183], v[196:199], a[112:115]
ds_read_b128 a[156:159], v2 offset:3072
v_cvt_pk_bf16_f32 v183, v118, v119
v_mfma_f32_16x16x32_bf16 a[112:115], a[176:179], v[192:195], a[112:115]
ds_read_b128 a[160:163], v2 offset:4096
v_xor_b32 v3, 0x8000, v3
v_mfma_f32_16x16x32_bf16 a[116:119], a[184:187], v[192:195], a[116:119]
s_waitcnt lgkmcnt(4)
ds_read_b128 a[164:167], v2 offset:5120
v_accvgpr_read_b32 v20, a128
v_mfma_f32_16x16x32_bf16 a[116:119], a[188:191], v[196:199], a[116:119]
ds_read_b128 a[168:171], v2 offset:6144
v_accvgpr_read_b32 v248, a129
v_mfma_f32_16x16x32_bf16 a[84:87], a[188:191], v[188:191], a[84:87]
ds_read_b128 a[172:175], v2 offset:7168
v_add_f32 v20, v20, v248
v_mfma_f32_16x16x32_bf16 a[84:87], a[184:187], v[184:187], a[84:87]
v_max_f32 v1, v1, v20
v_mfma_f32_16x16x32_bf16 a[52:55], a[184:187], v[160:163], a[52:55]
v_rcp_f32 v20, v20
v_mfma_f32_16x16x32_bf16 a[52:55], a[188:191], v[164:167], a[52:55]
v_accvgpr_read_b32 v232, a0
v_accvgpr_read_b32 v233, a1
v_mfma_f32_16x16x32_bf16 a[20:23], a[188:191], v[156:159], a[20:23]
v_accvgpr_read_b32 v234, a2
v_accvgpr_read_b32 v235, a3
v_mfma_f32_16x16x32_bf16 a[20:23], a[184:187], v[152:155], a[20:23]
v_accvgpr_read_b32 v236, a4
v_accvgpr_read_b32 v237, a5
v_mfma_f32_16x16x32_bf16 a[24:27], a[192:195], v[152:155], a[24:27]
v_accvgpr_read_b32 v238, a6
v_accvgpr_read_b32 v239, a7
v_mfma_f32_16x16x32_bf16 a[24:27], a[196:199], v[156:159], a[24:27]
v_mul_f32 v20, v20, v4
v_mul_f32 v232, v232, v20
v_mfma_f32_16x16x32_bf16 a[56:59], a[196:199], v[164:167], a[56:59]
buffer_load_dwordx4 v16, s[32:35], s70 offen offset:1024 sc1 lds
v_mfma_f32_16x16x32_bf16 a[56:59], a[192:195], v[160:163], a[56:59]
v_mul_f32 v233, v233, v20
v_mul_f32 v234, v234, v20
v_mfma_f32_16x16x32_bf16 a[88:91], a[192:195], v[184:187], a[88:91]
v_mul_f32 v235, v235, v20
v_mul_f32 v236, v236, v20
v_mfma_f32_16x16x32_bf16 a[88:91], a[196:199], v[188:191], a[88:91]
v_mul_f32 v237, v237, v20
v_mul_f32 v238, v238, v20
v_mfma_f32_16x16x32_bf16 a[120:123], a[196:199], v[196:199], a[120:123]
v_mul_f32 v239, v239, v20
v_cvt_pk_bf16_f32 v232, v232, v233
v_mfma_f32_16x16x32_bf16 a[120:123], a[192:195], v[192:195], a[120:123]
v_cvt_pk_bf16_f32 v233, v234, v235
v_cvt_pk_bf16_f32 v234, v236, v237
v_mfma_f32_16x16x32_bf16 a[124:127], a[200:203], v[192:195], a[124:127]
v_cvt_pk_bf16_f32 v235, v238, v239
v_mfma_f32_16x16x32_bf16 a[124:127], a[204:207], v[196:199], a[124:127]
s_add_u32 s77, s74, 0
buffer_store_dwordx4 v[232:235], v16, s[44:47], s77 offen sc1
v_mfma_f32_16x16x32_bf16 a[92:95], a[204:207], v[188:191], a[92:95]
v_accvgpr_read_b32 v240, a8
v_accvgpr_read_b32 v241, a9
v_mfma_f32_16x16x32_bf16 a[92:95], a[200:203], v[184:187], a[92:95]
v_accvgpr_read_b32 v242, a10
v_accvgpr_read_b32 v243, a11
v_mfma_f32_16x16x32_bf16 a[60:63], a[200:203], v[160:163], a[60:63]
v_accvgpr_read_b32 v244, a12
v_accvgpr_read_b32 v245, a13
v_mfma_f32_16x16x32_bf16 a[60:63], a[204:207], v[164:167], a[60:63]
v_accvgpr_read_b32 v246, a14
v_accvgpr_read_b32 v247, a15
v_mfma_f32_16x16x32_bf16 a[28:31], a[204:207], v[156:159], a[28:31]
v_mul_f32 v240, v240, v20
v_mul_f32 v241, v241, v20
v_mfma_f32_16x16x32_bf16 a[28:31], a[200:203], v[152:155], a[28:31]
v_mul_f32 v242, v242, v20
v_mul_f32 v243, v243, v20
v_mul_f32 v244, v244, v20
v_mul_f32 v245, v245, v20
v_mul_f32 v246, v246, v20
v_mul_f32 v247, v247, v20
v_cvt_pk_bf16_f32 v240, v240, v241
v_cvt_pk_bf16_f32 v241, v242, v243
v_cvt_pk_bf16_f32 v242, v244, v245
v_cvt_pk_bf16_f32 v243, v246, v247
s_add_u32 s77, s74, 8192
buffer_store_dwordx4 v[240:243], v16, s[44:47], s77 offen sc1
v_accvgpr_read_b32 v232, a16
v_accvgpr_read_b32 v233, a17
v_accvgpr_read_b32 v234, a18
v_accvgpr_read_b32 v235, a19
v_accvgpr_read_b32 v236, a20
v_accvgpr_read_b32 v237, a21
v_accvgpr_read_b32 v238, a22
v_accvgpr_read_b32 v239, a23
v_mul_f32 v232, v232, v20
v_mul_f32 v233, v233, v20
v_mul_f32 v234, v234, v20
v_mul_f32 v235, v235, v20
v_mul_f32 v236, v236, v20
v_mul_f32 v237, v237, v20
v_mul_f32 v238, v238, v20
v_mul_f32 v239, v239, v20
v_cvt_pk_bf16_f32 v232, v232, v233
v_cvt_pk_bf16_f32 v233, v234, v235
v_cvt_pk_bf16_f32 v234, v236, v237
v_cvt_pk_bf16_f32 v235, v238, v239
s_add_u32 s77, s74, 16384
buffer_store_dwordx4 v[232:235], v16, s[44:47], s77 offen sc1
s_cmp_eq_u32 s3, 7
s_cbranch_scc1 L_T1
L_T:
s_waitcnt lgkmcnt(7)
v_mfma_f32_16x16x32_bf16 v[120:123], a[144:147], v[56:59], v[224:227]
s_waitcnt lgkmcnt(6)
ds_read_b128 a[176:179], v2 offset:8192
v_mfma_f32_16x16x32_bf16 v[120:123], a[148:151], v[60:63], v[120:123]
s_waitcnt lgkmcnt(6)
ds_read_b128 a[180:183], v2 offset:9216
v_mfma_f32_16x16x32_bf16 v[120:123], a[152:155], v[64:67], v[120:123]
s_waitcnt lgkmcnt(6)
buffer_load_dwordx4 v16, s[32:35], s70 offen offset:2048 sc1 lds
v_mfma_f32_16x16x32_bf16 v[120:123], a[156:159], v[68:71], v[120:123]
ds_read_b128 a[184:187], v2 offset:10240
v_mfma_f32_16x16x32_bf16 v[136:139], a[156:159], v[84:87], v[228:231]
ds_read_b128 a[188:191], v2 offset:11264
v_mfma_f32_16x16x32_bf16 v[136:139], a[152:155], v[80:83], v[136:139]
ds_read_b128 a[192:195], v2 offset:12288
v_mfma_f32_16x16x32_bf16 v[136:139], a[148:151], v[76:79], v[136:139]
ds_read_b128 a[196:199], v2 offset:13312
v_mfma_f32_16x16x32_bf16 v[136:139], a[144:147], v[72:75], v[136:139]
s_waitcnt lgkmcnt(4)
v_mfma_f32_16x16x32_bf16 v[140:143], a[160:163], v[72:75], v[228:231]
ds_read_b128 a[200:203], v2 offset:14336
v_accvgpr_read_b32 v240, a24
v_mfma_f32_16x16x32_bf16 v[140:143], a[164:167], v[76:79], v[140:143]
ds_read_b128 a[204:207], v2 offset:15360
v_accvgpr_read_b32 v241, a25
v_mfma_f32_16x16x32_bf16 v[140:143], a[168:171], v[80:83], v[140:143]
v_exp_f32 v120, v120
v_mfma_f32_16x16x32_bf16 v[140:143], a[172:175], v[84:87], v[140:143]
v_exp_f32 v121, v121
v_mfma_f32_16x16x32_bf16 v[124:127], a[172:175], v[68:71], v[224:227]
v_exp_f32 v122, v122
v_mfma_f32_16x16x32_bf16 v[124:127], a[168:171], v[64:67], v[124:127]
buffer_load_dwordx4 v16, s[32:35], s70 offen offset:3072 sc1 lds
v_mfma_f32_16x16x32_bf16 v[124:127], a[164:167], v[60:63], v[124:127]
v_exp_f32 v123, v123
v_mfma_f32_16x16x32_bf16 v[124:127], a[160:163], v[56:59], v[124:127]
v_exp_f32 v136, v136
v_mfma_f32_16x16x32_bf16 v[128:131], a[176:179], v[56:59], v[224:227]
v_exp_f32 v137, v137
v_mfma_f32_16x16x32_bf16 v[128:131], a[180:183], v[60:63], v[128:131]
s_waitcnt lgkmcnt(0)
v_exp_f32 v138, v138
v_mfma_f32_16x16x32_bf16 v[128:131], a[184:187], v[64:67], v[128:131]
v_exp_f32 v139, v139
v_mfma_f32_16x16x32_bf16 v[128:131], a[188:191], v[68:71], v[128:131]
s_add_u32 m0, s71, 4096
ds_read_b128 a[144:147], v3 offset:0
v_cvt_pk_bf16_f32 v184, v120, v121
v_mfma_f32_16x16x32_bf16 v[144:147], a[188:191], v[84:87], v[228:231]
s_add_u32 s64, s70, 4096
ds_read_b128 a[148:151], v3 offset:8192
v_cvt_pk_bf16_f32 v185, v122, v123
v_mfma_f32_16x16x32_bf16 v[144:147], a[184:187], v[80:83], v[144:147]
buffer_load_dwordx4 v16, s[32:35], s64 offen offset:0 sc1 lds
v_mfma_f32_16x16x32_bf16 v[144:147], a[180:183], v[76:79], v[144:147]
v_exp_f32 v140, v140
v_mfma_f32_16x16x32_bf16 v[144:147], a[176:179], v[72:75], v[144:147]
v_exp_f32 v141, v141
v_mfma_f32_16x16x32_bf16 v[148:151], a[192:195], v[72:75], v[228:231]
v_exp_f32 v142, v142
v_mfma_f32_16x16x32_bf16 v[148:151], a[196:199], v[76:79], v[148:151]
ds_read_b128 a[152:155], v3 offset:1024
v_cvt_pk_bf16_f32 v192, v136, v137
v_mfma_f32_16x16x32_bf16 v[148:151], a[200:203], v[80:83], v[148:151]
ds_read_b128 a[156:159], v3 offset:9216
v_cvt_pk_bf16_f32 v193, v138, v139
v_mfma_f32_16x16x32_bf16 v[148:151], a[204:207], v[84:87], v[148:151]
v_exp_f32 v143, v143
v_mfma_f32_16x16x32_bf16 v[132:135], a[204:207], v[68:71], v[224:227]
v_exp_f32 v124, v124
v_mfma_f32_16x16x32_bf16 v[132:135], a[200:203], v[64:67], v[132:135]
v_exp_f32 v125, v125
v_mfma_f32_16x16x32_bf16 v[132:135], a[196:199], v[60:63], v[132:135]
buffer_load_dwordx4 v16, s[32:35], s64 offen offset:1024 sc1 lds
v_mfma_f32_16x16x32_bf16 v[132:135], a[192:195], v[56:59], v[132:135]
ds_read_b128 a[160:163], v3 offset:2048
v_cvt_pk_bf16_f32 v194, v140, v141
v_smfmac_f32_16x16x64_bf16 a[132:135], a[240:243], v[176:183], v5
ds_read_b128 a[164:167], v3 offset:10240
v_smfmac_f32_16x16x64_bf16 a[136:139], a[240:243], v[200:207], v5
ds_read_b128 a[168:171], v3 offset:3072
v_accvgpr_read_b32 v242, a26
v_smfmac_f32_16x16x64_bf16 a[140:143], a[240:243], v[208:215], v5
s_waitcnt lgkmcnt(3)
ds_read_b128 a[172:175], v3 offset:11264
v_accvgpr_read_b32 v243, a27
v_mfma_f32_16x16x32_bf16 a[32:35], a[144:147], v[176:179], a[32:35]
ds_read_b128 a[176:179], v3 offset:4096
v_accvgpr_read_b32 v244, a28
v_mfma_f32_16x16x32_bf16 a[32:35], a[148:151], v[180:183], a[32:35]
ds_read_b128 a[180:183], v3 offset:12288
v_accvgpr_read_b32 v245, a29
v_mfma_f32_16x16x32_bf16 a[64:67], a[148:151], v[204:207], a[64:67]
ds_read_b128 a[184:187], v3 offset:5120
v_accvgpr_read_b32 v246, a30
v_mfma_f32_16x16x32_bf16 a[64:67], a[144:147], v[200:203], a[64:67]
ds_read_b128 a[188:191], v3 offset:13312
v_accvgpr_read_b32 v247, a31
v_mfma_f32_16x16x32_bf16 a[96:99], a[144:147], v[208:211], a[96:99]
ds_read_b128 a[192:195], v3 offset:6144
v_mul_f32 v240, v240, v20
v_mfma_f32_16x16x32_bf16 a[96:99], a[148:151], v[212:215], a[96:99]
ds_read_b128 a[196:199], v3 offset:14336
v_mul_f32 v241, v241, v20
v_mfma_f32_16x16x32_bf16 a[100:103], a[156:159], v[212:215], a[100:103]
ds_read_b128 a[200:203], v3 offset:7168
v_mul_f32 v242, v242, v20
v_mfma_f32_16x16x32_bf16 a[100:103], a[152:155], v[208:211], a[100:103]
ds_read_b128 a[204:207], v3 offset:15360
v_mul_f32 v243, v243, v20
v_mul_f32 v244, v244, v20
v_mul_f32 v245, v245, v20
v_mul_f32 v246, v246, v20
v_mul_f32 v247, v247, v20
v_cvt_pk_bf16_f32 v240, v240, v241
v_cvt_pk_bf16_f32 v241, v242, v243
v_cvt_pk_bf16_f32 v242, v244, v245
v_cvt_pk_bf16_f32 v243, v246, v247
s_add_u32 s77, s74, 24576
buffer_store_dwordx4 v[240:243], v16, s[44:47], s77 offen sc1
v_exp_f32 v126, v126
v_mfma_f32_16x16x32_bf16 a[68:71], a[152:155], v[200:203], a[68:71]
buffer_load_dwordx4 v16, s[32:35], s64 offen offset:2048 sc1 lds
v_cvt_pk_bf16_f32 v195, v142, v143
v_mfma_f32_16x16x32_bf16 a[68:71], a[156:159], v[204:207], a[68:71]
v_exp_f32 v127, v127
v_mfma_f32_16x16x32_bf16 a[36:39], a[156:159], v[180:183], a[36:39]
v_exp_f32 v128, v128
v_mfma_f32_16x16x32_bf16 a[36:39], a[152:155], v[176:179], a[36:39]
s_waitcnt lgkmcnt(2)
v_exp_f32 v129, v129
v_mfma_f32_16x16x32_bf16 a[40:43], a[160:163], v[176:179], a[40:43]
v_cvt_pk_bf16_f32 v186, v124, v125
v_cvt_pk_bf16_f32 v187, v126, v127
v_mfma_f32_16x16x32_bf16 a[40:43], a[164:167], v[180:183], a[40:43]
v_exp_f32 v130, v130
v_mfma_f32_16x16x32_bf16 a[72:75], a[164:167], v[204:207], a[72:75]
buffer_load_dwordx4 v16, s[32:35], s64 offen offset:3072 sc1 lds
v_mfma_f32_16x16x32_bf16 a[72:75], a[160:163], v[200:203], a[72:75]
v_exp_f32 v131, v131
v_mfma_f32_16x16x32_bf16 a[104:107], a[160:163], v[208:211], a[104:107]
v_exp_f32 v144, v144
v_mfma_f32_16x16x32_bf16 a[104:107], a[164:167], v[212:215], a[104:107]
v_exp_f32 v145, v145
v_mfma_f32_16x16x32_bf16 a[108:111], a[172:175], v[212:215], a[108:111]
v_exp_f32 v146, v146
v_mfma_f32_16x16x32_bf16 a[108:111], a[168:171], v[208:211], a[108:111]
v_exp_f32 v147, v147
v_mfma_f32_16x16x32_bf16 a[76:79], a[168:171], v[200:203], a[76:79]
v_exp_f32 v148, v148
v_mfma_f32_16x16x32_bf16 a[76:79], a[172:175], v[204:207], a[76:79]
v_exp_f32 v149, v149
v_mfma_f32_16x16x32_bf16 a[44:47], a[172:175], v[180:183], a[44:47]
v_cvt_pk_bf16_f32 v188, v128, v129
v_cvt_pk_bf16_f32 v189, v130, v131
v_mfma_f32_16x16x32_bf16 a[44:47], a[168:171], v[176:179], a[44:47]
v_exp_f32 v150, v150
v_mfma_f32_16x16x32_bf16 a[48:51], a[176:179], v[176:179], a[48:51]
v_exp_f32 v151, v151
v_mfma_f32_16x16x32_bf16 a[48:51], a[180:183], v[180:183], a[48:51]
v_exp_f32 v132, v132
v_mfma_f32_16x16x32_bf16 a[80:83], a[180:183], v[204:207], a[80:83]
s_waitcnt vmcnt(9)
s_barrier
v_mfma_f32_16x16x32_bf16 a[80:83], a[176:179], v[200:203], a[80:83]
s_xor_b32 s71, s71, 16384
v_exp_f32 v133, v133
v_mfma_f32_16x16x32_bf16 a[112:115], a[176:179], v[208:211], a[112:115]
s_add_u32 s70, s70, 32768
ds_read_b128 a[144:147], v2 offset:16384
v_cvt_pk_bf16_f32 v196, v144, v145
v_mfma_f32_16x16x32_bf16 a[112:115], a[180:183], v[212:215], a[112:115]
s_mov_b32 m0, s71
v_exp_f32 v134, v134
v_mfma_f32_16x16x32_bf16 a[116:119], a[188:191], v[212:215], a[116:119]
buffer_load_dwordx4 v16, s[32:35], s70 offen offset:0 sc1 lds
v_mfma_f32_16x16x32_bf16 a[116:119], a[184:187], v[208:211], a[116:119]
ds_read_b128 a[148:151], v2 offset:17408
v_cvt_pk_bf16_f32 v197, v146, v147
v_mfma_f32_16x16x32_bf16 a[84:87], a[184:187], v[200:203], a[84:87]
ds_read_b128 a[152:155], v2 offset:18432
v_cvt_pk_bf16_f32 v198, v148, v149
v_mfma_f32_16x16x32_bf16 a[84:87], a[188:191], v[204:207], a[84:87]
ds_read_b128 a[156:159], v2 offset:19456
v_cvt_pk_bf16_f32 v199, v150, v151
v_mfma_f32_16x16x32_bf16 a[52:55], a[188:191], v[180:183], a[52:55]
v_exp_f32 v135, v135
v_mfma_f32_16x16x32_bf16 a[52:55], a[184:187], v[176:179], a[52:55]
ds_read_b128 a[160:163], v2 offset:20480
v_cvt_pk_bf16_f32 v190, v132, v133
v_mfma_f32_16x16x32_bf16 a[56:59], a[192:195], v[176:179], a[56:59]
ds_read_b128 a[164:167], v2 offset:21504
v_cvt_pk_bf16_f32 v191, v134, v135
v_mfma_f32_16x16x32_bf16 a[56:59], a[196:199], v[180:183], a[56:59]
ds_read_b128 a[168:171], v2 offset:22528
v_accvgpr_read_b32 v21, a132
v_mfma_f32_16x16x32_bf16 a[88:91], a[196:199], v[204:207], a[88:91]
ds_read_b128 a[172:175], v2 offset:23552
v_accvgpr_read_b32 v248, a133
v_mfma_f32_16x16x32_bf16 a[88:91], a[192:195], v[200:203], a[88:91]
buffer_load_dwordx4 v16, s[32:35], s70 offen offset:1024 sc1 lds
v_mfma_f32_16x16x32_bf16 a[120:123], a[192:195], v[208:211], a[120:123]
v_add_f32 v21, v21, v248
v_max_f32 v1, v1, v21
v_mfma_f32_16x16x32_bf16 a[120:123], a[196:199], v[212:215], a[120:123]
s_waitcnt lgkmcnt(3)
v_rcp_f32 v21, v21
v_mfma_f32_16x16x32_bf16 a[124:127], a[204:207], v[212:215], a[124:127]
v_accvgpr_read_b32 v232, a32
v_accvgpr_read_b32 v233, a33
v_mfma_f32_16x16x32_bf16 a[124:127], a[200:203], v[208:211], a[124:127]
v_accvgpr_read_b32 v234, a34
v_accvgpr_read_b32 v235, a35
v_mfma_f32_16x16x32_bf16 a[92:95], a[200:203], v[200:203], a[92:95]
v_accvgpr_read_b32 v236, a36
v_accvgpr_read_b32 v237, a37
v_mfma_f32_16x16x32_bf16 a[92:95], a[204:207], v[204:207], a[92:95]
v_accvgpr_read_b32 v238, a38
v_accvgpr_read_b32 v239, a39
v_mfma_f32_16x16x32_bf16 a[60:63], a[204:207], v[180:183], a[60:63]
v_mul_f32 v21, v21, v6
v_mul_f32 v232, v232, v21
v_mfma_f32_16x16x32_bf16 a[60:63], a[200:203], v[176:179], a[60:63]
v_mul_f32 v233, v233, v21
v_mul_f32 v234, v234, v21
v_mfma_f32_16x16x32_bf16 v[120:123], a[144:147], v[56:59], v[224:227]
ds_read_b128 a[176:179], v2 offset:24576
ds_read_b128 a[180:183], v2 offset:25600
v_mfma_f32_16x16x32_bf16 v[120:123], a[148:151], v[60:63], v[120:123]
buffer_load_dwordx4 v16, s[32:35], s70 offen offset:2048 sc1 lds
v_mfma_f32_16x16x32_bf16 v[120:123], a[152:155], v[64:67], v[120:123]
s_add_u32 s64, s70, 4096
ds_read_b128 a[184:187], v2 offset:26624
ds_read_b128 a[188:191], v2 offset:27648
v_mfma_f32_16x16x32_bf16 v[120:123], a[156:159], v[68:71], v[120:123]
buffer_load_dwordx4 v16, s[32:35], s70 offen offset:3072 sc1 lds
v_mfma_f32_16x16x32_bf16 v[136:139], a[156:159], v[84:87], v[228:231]
s_add_u32 m0, s71, 4096
ds_read_b128 a[192:195], v2 offset:28672
ds_read_b128 a[196:199], v2 offset:29696
v_mfma_f32_16x16x32_bf16 v[136:139], a[152:155], v[80:83], v[136:139]
buffer_load_dwordx4 v16, s[32:35], s64 offen offset:0 sc1 lds
v_mfma_f32_16x16x32_bf16 v[136:139], a[148:151], v[76:79], v[136:139]
ds_read_b128 a[200:203], v2 offset:30720
ds_read_b128 a[204:207], v2 offset:31744
v_mfma_f32_16x16x32_bf16 v[136:139], a[144:147], v[72:75], v[136:139]
v_exp_f32 v120, v120
v_mfma_f32_16x16x32_bf16 v[140:143], a[160:163], v[72:75], v[228:231]
s_waitcnt lgkmcnt(4)
v_exp_f32 v121, v121
v_mfma_f32_16x16x32_bf16 v[140:143], a[164:167], v[76:79], v[140:143]
v_exp_f32 v122, v122
v_mfma_f32_16x16x32_bf16 v[140:143], a[168:171], v[80:83], v[140:143]
v_mul_f32 v235, v235, v21
v_mul_f32 v236, v236, v21
v_mul_f32 v237, v237, v21
v_mul_f32 v238, v238, v21
v_mul_f32 v239, v239, v21
v_cvt_pk_bf16_f32 v232, v232, v233
v_cvt_pk_bf16_f32 v233, v234, v235
v_cvt_pk_bf16_f32 v234, v236, v237
v_cvt_pk_bf16_f32 v235, v238, v239
s_add_u32 s77, s74, 4096
buffer_store_dwordx4 v[232:235], v16, s[44:47], s77 offen sc1
v_accvgpr_read_b32 v240, a40
v_accvgpr_read_b32 v241, a41
v_accvgpr_read_b32 v242, a42
v_accvgpr_read_b32 v243, a43
v_accvgpr_read_b32 v244, a44
v_accvgpr_read_b32 v245, a45
v_accvgpr_read_b32 v246, a46
v_accvgpr_read_b32 v247, a47
v_mul_f32 v240, v240, v21
v_mul_f32 v241, v241, v21
v_mul_f32 v242, v242, v21
v_mul_f32 v243, v243, v21
v_mul_f32 v244, v244, v21
v_mul_f32 v245, v245, v21
v_mul_f32 v246, v246, v21
v_mul_f32 v247, v247, v21
v_cvt_pk_bf16_f32 v240, v240, v241
v_cvt_pk_bf16_f32 v241, v242, v243
v_cvt_pk_bf16_f32 v242, v244, v245
v_cvt_pk_bf16_f32 v243, v246, v247
s_add_u32 s77, s74, 12288
buffer_store_dwordx4 v[240:243], v16, s[44:47], s77 offen sc1
v_accvgpr_read_b32 v232, a48
v_accvgpr_read_b32 v233, a49
v_accvgpr_read_b32 v234, a50
v_accvgpr_read_b32 v235, a51
v_accvgpr_read_b32 v236, a52
v_accvgpr_read_b32 v237, a53
v_accvgpr_read_b32 v238, a54
v_accvgpr_read_b32 v239, a55
v_mul_f32 v232, v232, v21
v_mul_f32 v233, v233, v21
v_mul_f32 v234, v234, v21
v_mul_f32 v235, v235, v21
v_mul_f32 v236, v236, v21
v_mul_f32 v237, v237, v21
v_mul_f32 v238, v238, v21
v_mul_f32 v239, v239, v21
v_cvt_pk_bf16_f32 v232, v232, v233
v_cvt_pk_bf16_f32 v233, v234, v235
v_cvt_pk_bf16_f32 v234, v236, v237
v_cvt_pk_bf16_f32 v235, v238, v239
s_add_u32 s77, s74, 20480
buffer_store_dwordx4 v[232:235], v16, s[44:47], s77 offen sc1
v_accvgpr_read_b32 v240, a56
v_accvgpr_read_b32 v241, a57
v_accvgpr_read_b32 v242, a58
v_accvgpr_read_b32 v243, a59
v_accvgpr_read_b32 v244, a60
v_accvgpr_read_b32 v245, a61
v_accvgpr_read_b32 v246, a62
v_accvgpr_read_b32 v247, a63
v_mul_f32 v240, v240, v21
v_mul_f32 v241, v241, v21
v_mul_f32 v242, v242, v21
v_mul_f32 v243, v243, v21
v_mul_f32 v244, v244, v21
v_mul_f32 v245, v245, v21
v_mul_f32 v246, v246, v21
v_mul_f32 v247, v247, v21
v_cvt_pk_bf16_f32 v240, v240, v241
v_cvt_pk_bf16_f32 v241, v242, v243
v_cvt_pk_bf16_f32 v242, v244, v245
v_cvt_pk_bf16_f32 v243, v246, v247
s_add_u32 s77, s74, 28672
buffer_store_dwordx4 v[240:243], v16, s[44:47], s77 offen sc1
v_exp_f32 v123, v123
v_mfma_f32_16x16x32_bf16 v[140:143], a[172:175], v[84:87], v[140:143]
v_exp_f32 v136, v136
v_mfma_f32_16x16x32_bf16 v[124:127], a[172:175], v[68:71], v[224:227]
ds_read_b128 a[144:147], v3 offset:16384
v_cvt_pk_bf16_f32 v200, v120, v121
v_mfma_f32_16x16x32_bf16 v[124:127], a[168:171], v[64:67], v[124:127]
s_branch L_po18
L_pg18:
s_branch L_pg22
L_po18:
v_exp_f32 v137, v137
v_mfma_f32_16x16x32_bf16 v[124:127], a[164:167], v[60:63], v[124:127]
ds_read_b128 a[148:151], v3 offset:24576
v_cvt_pk_bf16_f32 v201, v122, v123
v_mfma_f32_16x16x32_bf16 v[124:127], a[160:163], v[56:59], v[124:127]
v_exp_f32 v138, v138
v_mfma_f32_16x16x32_bf16 v[128:131], a[176:179], v[56:59], v[224:227]
ds_read_b128 a[152:155], v3 offset:17408
v_cvt_pk_bf16_f32 v208, v136, v137
v_mfma_f32_16x16x32_bf16 v[128:131], a[180:183], v[60:63], v[128:131]
v_exp_f32 v139, v139
v_mfma_f32_16x16x32_bf16 v[128:131], a[184:187], v[64:67], v[128:131]
ds_read_b128 a[156:159], v3 offset:25600
v_cvt_pk_bf16_f32 v209, v138, v139
v_mfma_f32_16x16x32_bf16 v[128:131], a[188:191], v[68:71], v[128:131]
v_exp_f32 v140, v140
v_mfma_f32_16x16x32_bf16 v[144:147], a[188:191], v[84:87], v[228:231]
buffer_load_dwordx4 v16, s[32:35], s64 offen offset:1024 sc1 lds
v_mfma_f32_16x16x32_bf16 v[144:147], a[184:187], v[80:83], v[144:147]
v_exp_f32 v141, v141
v_mfma_f32_16x16x32_bf16 v[144:147], a[180:183], v[76:79], v[144:147]
ds_read_b128 a[160:163], v3 offset:18432
v_cvt_pk_bf16_f32 v210, v140, v141
v_mfma_f32_16x16x32_bf16 v[144:147], a[176:179], v[72:75], v[144:147]
s_waitcnt lgkmcnt(2)
v_exp_f32 v142, v142
v_mfma_f32_16x16x32_bf16 v[148:151], a[192:195], v[72:75], v[228:231]
ds_read_b128 a[164:167], v3 offset:26624
ds_read_b128 a[168:171], v3 offset:19456
v_mfma_f32_16x16x32_bf16 v[148:151], a[196:199], v[76:79], v[148:151]
v_exp_f32 v143, v143
v_mfma_f32_16x16x32_bf16 v[148:151], a[200:203], v[80:83], v[148:151]
ds_read_b128 a[172:175], v3 offset:27648
v_cvt_pk_bf16_f32 v211, v142, v143
v_mfma_f32_16x16x32_bf16 v[148:151], a[204:207], v[84:87], v[148:151]
v_exp_f32 v124, v124
v_mfma_f32_16x16x32_bf16 v[132:135], a[204:207], v[68:71], v[224:227]
ds_read_b128 a[176:179], v3 offset:20480
buffer_load_dwordx4 v16, s[32:35], s64 offen offset:2048 sc1 lds
v_mfma_f32_16x16x32_bf16 v[132:135], a[200:203], v[64:67], v[132:135]
v_exp_f32 v125, v125
v_mfma_f32_16x16x32_bf16 v[132:135], a[196:199], v[60:63], v[132:135]
ds_read_b128 a[180:183], v3 offset:28672
v_cvt_pk_bf16_f32 v202, v124, v125
v_mfma_f32_16x16x32_bf16 v[132:135], a[192:195], v[56:59], v[132:135]
v_exp_f32 v126, v126
v_smfmac_f32_16x16x64_bf16 a[136:139], a[240:243], v[184:191], v5
ds_read_b128 a[184:187], v3 offset:21504
v_smfmac_f32_16x16x64_bf16 a[140:143], a[240:243], v[192:199], v5
ds_read_b128 a[188:191], v3 offset:29696
v_mfma_f32_16x16x32_bf16 a[64:67], a[144:147], v[184:187], a[64:67]
v_exp_f32 v127, v127
v_mfma_f32_16x16x32_bf16 a[64:67], a[148:151], v[188:191], a[64:67]
v_exp_f32 v128, v128
v_mfma_f32_16x16x32_bf16 a[96:99], a[148:151], v[196:199], a[96:99]
v_exp_f32 v129, v129
v_mfma_f32_16x16x32_bf16 a[96:99], a[144:147], v[192:195], a[96:99]
ds_read_b128 a[192:195], v3 offset:22528
v_cvt_pk_bf16_f32 v203, v126, v127
v_mfma_f32_16x16x32_bf16 a[100:103], a[152:155], v[192:195], a[100:103]
s_waitcnt lgkmcnt(2)
v_exp_f32 v130, v130
v_mfma_f32_16x16x32_bf16 a[100:103], a[156:159], v[196:199], a[100:103]
ds_read_b128 a[196:199], v3 offset:30720
v_cvt_pk_bf16_f32 v204, v128, v129
v_mfma_f32_16x16x32_bf16 a[68:71], a[156:159], v[188:191], a[68:71]
v_exp_f32 v131, v131
v_mfma_f32_16x16x32_bf16 a[68:71], a[152:155], v[184:187], a[68:71]
ds_read_b128 a[200:203], v3 offset:23552
v_cvt_pk_bf16_f32 v205, v130, v131
v_mfma_f32_16x16x32_bf16 a[72:75], a[160:163], v[184:187], a[72:75]
v_exp_f32 v144, v144
v_mfma_f32_16x16x32_bf16 a[72:75], a[164:167], v[188:191], a[72:75]
buffer_load_dwordx4 v16, s[32:35], s64 offen offset:3072 sc1 lds
v_mfma_f32_16x16x32_bf16 a[104:107], a[164:167], v[196:199], a[104:107]
s_xor_b32 s71, s71, 49152
v_exp_f32 v145, v145
v_mfma_f32_16x16x32_bf16 a[104:107], a[160:163], v[192:195], a[104:107]
ds_read_b128 a[204:207], v3 offset:31744
v_cvt_pk_bf16_f32 v212, v144, v145
v_mfma_f32_16x16x32_bf16 a[108:111], a[168:171], v[192:195], a[108:111]
s_add_u32 s70, s70, 32768
v_xor_b32 v2, 0x8000, v2
v_exp_f32 v146, v146
v_mfma_f32_16x16x32_bf16 a[108:111], a[172:175], v[196:199], a[108:111]
s_waitcnt vmcnt(12)
s_barrier
v_mfma_f32_16x16x32_bf16 a[76:79], a[172:175], v[188:191], a[76:79]
s_mov_b32 m0, s71
v_exp_f32 v147, v147
v_mfma_f32_16x16x32_bf16 a[76:79], a[168:171], v[184:187], a[76:79]
ds_read_b128 a[144:147], v2 offset:0
v_cvt_pk_bf16_f32 v213, v146, v147
v_mfma_f32_16x16x32_bf16 a[80:83], a[176:179], v[184:187], a[80:83]
v_exp_f32 v148, v148
v_mfma_f32_16x16x32_bf16 a[80:83], a[180:183], v[188:191], a[80:83]
ds_read_b128 a[148:151], v2 offset:1024
ds_read_b128 a[152:155], v2 offset:2048
v_mfma_f32_16x16x32_bf16 a[112:115], a[180:183], v[196:199], a[112:115]
v_exp_f32 v149, v149
v_mfma_f32_16x16x32_bf16 a[112:115], a[176:179], v[192:195], a[112:115]
ds_read_b128 a[156:159], v2 offset:3072
v_cvt_pk_bf16_f32 v214, v148, v149
v_mfma_f32_16x16x32_bf16 a[116:119], a[184:187], v[192:195], a[116:119]
s_waitcnt lgkmcnt(4)
v_exp_f32 v150, v150
v_mfma_f32_16x16x32_bf16 a[116:119], a[188:191], v[196:199], a[116:119]
buffer_load_dwordx4 v16, s[32:35], s70 offen offset:0 sc1 lds
v_mfma_f32_16x16x32_bf16 a[84:87], a[188:191], v[188:191], a[84:87]
v_exp_f32 v151, v151
v_mfma_f32_16x16x32_bf16 a[84:87], a[184:187], v[184:187], a[84:87]
ds_read_b128 a[160:163], v2 offset:4096
v_cvt_pk_bf16_f32 v215, v150, v151
v_mfma_f32_16x16x32_bf16 a[88:91], a[192:195], v[184:187], a[88:91]
v_exp_f32 v132, v132
v_mfma_f32_16x16x32_bf16 a[88:91], a[196:199], v[188:191], a[88:91]
ds_read_b128 a[164:167], v2 offset:5120
v_xor_b32 v3, 0x8000, v3
v_mfma_f32_16x16x32_bf16 a[120:123], a[196:199], v[196:199], a[120:123]
v_exp_f32 v133, v133
v_mfma_f32_16x16x32_bf16 a[120:123], a[192:195], v[192:195], a[120:123]
ds_read_b128 a[168:171], v2 offset:6144
v_cvt_pk_bf16_f32 v206, v132, v133
v_mfma_f32_16x16x32_bf16 a[124:127], a[200:203], v[192:195], a[124:127]
v_exp_f32 v134, v134
v_mfma_f32_16x16x32_bf16 a[124:127], a[204:207], v[196:199], a[124:127]
buffer_load_dwordx4 v16, s[32:35], s70 offen offset:1024 sc1 lds
v_mfma_f32_16x16x32_bf16 a[92:95], a[204:207], v[188:191], a[92:95]
v_exp_f32 v135, v135
v_mfma_f32_16x16x32_bf16 a[92:95], a[200:203], v[184:187], a[92:95]
ds_read_b128 a[172:175], v2 offset:7168
v_cvt_pk_bf16_f32 v207, v134, v135
s_lshl_b32 s72, s3, 1
s_sub_u32 s72, 13, s72
L_S:
s_waitcnt lgkmcnt(7)
v_mfma_f32_16x16x32_bf16 v[120:123], a[144:147], v[56:59], v[224:227]
s_waitcnt lgkmcnt(6)
ds_read_b128 a[176:179], v2 offset:8192
ds_read_b128 a[180:183], v2 offset:9216
v_mfma_f32_16x16x32_bf16 v[120:123], a[148:151], v[60:63], v[120:123]
s_waitcnt lgkmcnt(7)
buffer_load_dwordx4 v16, s[32:35], s70 offen offset:2048 sc1 lds
v_mfma_f32_16x16x32_bf16 v[120:123], a[152:155], v[64:67], v[120:123]
s_waitcnt lgkmcnt(6)
s_add_u32 s64, s70, 4096
ds_read_b128 a[184:187], v2 offset:10240
ds_read_b128 a[188:191], v2 offset:11264
v_mfma_f32_16x16x32_bf16 v[120:123], a[156:159], v[68:71], v[120:123]
buffer_load_dwordx4 v16, s[32:35], s70 offen offset:3072 sc1 lds
v_mfma_f32_16x16x32_bf16 v[136:139], a[156:159], v[84:87], v[228:231]
s_add_u32 m0, s71, 4096
ds_read_b128 a[192:195], v2 offset:12288
ds_read_b128 a[196:199], v2 offset:13312
v_mfma_f32_16x16x32_bf16 v[136:139], a[152:155], v[80:83], v[136:139]
buffer_load_dwordx4 v16, s[32:35], s64 offen offset:0 sc1 lds
v_mfma_f32_16x16x32_bf16 v[136:139], a[148:151], v[76:79], v[136:139]
ds_read_b128 a[200:203], v2 offset:14336
ds_read_b128 a[204:207], v2 offset:15360
v_mfma_f32_16x16x32_bf16 v[136:139], a[144:147], v[72:75], v[136:139]
s_waitcnt lgkmcnt(6)
v_exp_f32 v120, v120
v_mfma_f32_16x16x32_bf16 v[140:143], a[160:163], v[72:75], v[228:231]
v_exp_f32 v121, v121
v_mfma_f32_16x16x32_bf16 v[140:143], a[164:167], v[76:79], v[140:143]
v_exp_f32 v122, v122
v_mfma_f32_16x16x32_bf16 v[140:143], a[168:171], v[80:83], v[140:143]
v_exp_f32 v123, v123
v_mfma_f32_16x16x32_bf16 v[140:143], a[172:175], v[84:87], v[140:143]
v_exp_f32 v136, v136
v_mfma_f32_16x16x32_bf16 v[124:127], a[172:175], v[68:71], v[224:227]
ds_read_b128 a[144:147], v3 offset:0
v_cvt_pk_bf16_f32 v184, v120, v121
v_mfma_f32_16x16x32_bf16 v[124:127], a[168:171], v[64:67], v[124:127]
v_exp_f32 v137, v137
v_mfma_f32_16x16x32_bf16 v[124:127], a[164:167], v[60:63], v[124:127]
ds_read_b128 a[148:151], v3 offset:8192
v_cvt_pk_bf16_f32 v185, v122, v123
v_mfma_f32_16x16x32_bf16 v[124:127], a[160:163], v[56:59], v[124:127]
v_exp_f32 v138, v138
v_mfma_f32_16x16x32_bf16 v[128:131], a[176:179], v[56:59], v[224:227]
ds_read_b128 a[152:155], v3 offset:1024
v_cvt_pk_bf16_f32 v192, v136, v137
v_mfma_f32_16x16x32_bf16 v[128:131], a[180:183], v[60:63], v[128:131]
s_waitcnt lgkmcnt(3)
v_exp_f32 v139, v139
v_mfma_f32_16x16x32_bf16 v[128:131], a[184:187], v[64:67], v[128:131]
ds_read_b128 a[156:159], v3 offset:9216
v_cvt_pk_bf16_f32 v193, v138, v139
v_mfma_f32_16x16x32_bf16 v[128:131], a[188:191], v[68:71], v[128:131]
v_exp_f32 v140, v140
v_mfma_f32_16x16x32_bf16 v[144:147], a[188:191], v[84:87], v[228:231]
buffer_load_dwordx4 v16, s[32:35], s64 offen offset:1024 sc1 lds
v_mfma_f32_16x16x32_bf16 v[144:147], a[184:187], v[80:83], v[144:147]
v_exp_f32 v141, v141
v_mfma_f32_16x16x32_bf16 v[144:147], a[180:183], v[76:79], v[144:147]
ds_read_b128 a[160:163], v3 offset:2048
v_cvt_pk_bf16_f32 v194, v140, v141
v_mfma_f32_16x16x32_bf16 v[144:147], a[176:179], v[72:75], v[144:147]
v_exp_f32 v142, v142
v_mfma_f32_16x16x32_bf16 v[148:151], a[192:195], v[72:75], v[228:231]
ds_read_b128 a[164:167], v3 offset:10240
ds_read_b128 a[168:171], v3 offset:3072
v_mfma_f32_16x16x32_bf16 v[148:151], a[196:199], v[76:79], v[148:151]
v_exp_f32 v143, v143
v_mfma_f32_16x16x32_bf16 v[148:151], a[200:203], v[80:83], v[148:151]
ds_read_b128 a[172:175], v3 offset:11264
v_cvt_pk_bf16_f32 v195, v142, v143
v_mfma_f32_16x16x32_bf16 v[148:151], a[204:207], v[84:87], v[148:151]
v_exp_f32 v124, v124
v_mfma_f32_16x16x32_bf16 v[132:135], a[204:207], v[68:71], v[224:227]
ds_read_b128 a[176:179], v3 offset:4096
buffer_load_dwordx4 v16, s[32:35], s64 offen offset:2048 sc1 lds
v_mfma_f32_16x16x32_bf16 v[132:135], a[200:203], v[64:67], v[132:135]
v_exp_f32 v125, v125
v_mfma_f32_16x16x32_bf16 v[132:135], a[196:199], v[60:63], v[132:135]
ds_read_b128 a[180:183], v3 offset:12288
v_cvt_pk_bf16_f32 v186, v124, v125
v_mfma_f32_16x16x32_bf16 v[132:135], a[192:195], v[56:59], v[132:135]
v_exp_f32 v126, v126
v_smfmac_f32_16x16x64_bf16 a[136:139], a[240:243], v[200:207], v5
ds_read_b128 a[184:187], v3 offset:5120
v_smfmac_f32_16x16x64_bf16 a[140:143], a[240:243], v[208:215], v5
s_waitcnt lgkmcnt(3)
ds_read_b128 a[188:191], v3 offset:13312
v_mfma_f32_16x16x32_bf16 a[64:67], a[144:147], v[200:203], a[64:67]
v_exp_f32 v127, v127
v_mfma_f32_16x16x32_bf16 a[64:67], a[148:151], v[204:207], a[64:67]
v_exp_f32 v128, v128
v_mfma_f32_16x16x32_bf16 a[96:99], a[148:151], v[212:215], a[96:99]
v_exp_f32 v129, v129
v_mfma_f32_16x16x32_bf16 a[96:99], a[144:147], v[208:211], a[96:99]
ds_read_b128 a[192:195], v3 offset:6144
v_cvt_pk_bf16_f32 v187, v126, v127
v_mfma_f32_16x16x32_bf16 a[100:103], a[152:155], v[208:211], a[100:103]
v_exp_f32 v130, v130
v_mfma_f32_16x16x32_bf16 a[100:103], a[156:159], v[212:215], a[100:103]
ds_read_b128 a[196:199], v3 offset:14336
v_cvt_pk_bf16_f32 v188, v128, v129
v_mfma_f32_16x16x32_bf16 a[68:71], a[156:159], v[204:207], a[68:71]
v_exp_f32 v131, v131
v_mfma_f32_16x16x32_bf16 a[68:71], a[152:155], v[200:203], a[68:71]
ds_read_b128 a[200:203], v3 offset:7168
v_cvt_pk_bf16_f32 v189, v130, v131
v_mfma_f32_16x16x32_bf16 a[72:75], a[160:163], v[200:203], a[72:75]
v_exp_f32 v144, v144
v_mfma_f32_16x16x32_bf16 a[72:75], a[164:167], v[204:207], a[72:75]
buffer_load_dwordx4 v16, s[32:35], s64 offen offset:3072 sc1 lds
v_mfma_f32_16x16x32_bf16 a[104:107], a[164:167], v[212:215], a[104:107]
s_xor_b32 s71, s71, 16384
v_exp_f32 v145, v145
v_mfma_f32_16x16x32_bf16 a[104:107], a[160:163], v[208:211], a[104:107]
ds_read_b128 a[204:207], v3 offset:15360
v_cvt_pk_bf16_f32 v196, v144, v145
v_mfma_f32_16x16x32_bf16 a[108:111], a[168:171], v[208:211], a[108:111]
s_add_u32 s70, s70, 32768
v_exp_f32 v146, v146
v_mfma_f32_16x16x32_bf16 a[108:111], a[172:175], v[212:215], a[108:111]
s_waitcnt vmcnt(8)
s_barrier
v_mfma_f32_16x16x32_bf16 a[76:79], a[172:175], v[204:207], a[76:79]
s_mov_b32 m0, s71
v_exp_f32 v147, v147
v_mfma_f32_16x16x32_bf16 a[76:79], a[168:171], v[200:203], a[76:79]
s_waitcnt lgkmcnt(1)
ds_read_b128 a[144:147], v2 offset:16384
v_cvt_pk_bf16_f32 v197, v146, v147
v_mfma_f32_16x16x32_bf16 a[80:83], a[176:179], v[200:203], a[80:83]
v_exp_f32 v148, v148
v_mfma_f32_16x16x32_bf16 a[80:83], a[180:183], v[204:207], a[80:83]
ds_read_b128 a[148:151], v2 offset:17408
ds_read_b128 a[152:155], v2 offset:18432
v_mfma_f32_16x16x32_bf16 a[112:115], a[180:183], v[212:215], a[112:115]
v_exp_f32 v149, v149
v_mfma_f32_16x16x32_bf16 a[112:115], a[176:179], v[208:211], a[112:115]
ds_read_b128 a[156:159], v2 offset:19456
v_cvt_pk_bf16_f32 v198, v148, v149
v_mfma_f32_16x16x32_bf16 a[116:119], a[184:187], v[208:211], a[116:119]
v_exp_f32 v150, v150
v_mfma_f32_16x16x32_bf16 a[116:119], a[188:191], v[212:215], a[116:119]
buffer_load_dwordx4 v16, s[32:35], s70 offen offset:0 sc1 lds
v_mfma_f32_16x16x32_bf16 a[84:87], a[188:191], v[204:207], a[84:87]
v_exp_f32 v151, v151
v_mfma_f32_16x16x32_bf16 a[84:87], a[184:187], v[200:203], a[84:87]
ds_read_b128 a[160:163], v2 offset:20480
v_cvt_pk_bf16_f32 v199, v150, v151
v_mfma_f32_16x16x32_bf16 a[88:91], a[192:195], v[200:203], a[88:91]
v_exp_f32 v132, v132
v_mfma_f32_16x16x32_bf16 a[88:91], a[196:199], v[204:207], a[88:91]
ds_read_b128 a[164:167], v2 offset:21504
v_mfma_f32_16x16x32_bf16 a[120:123], a[196:199], v[212:215], a[120:123]
v_exp_f32 v133, v133
v_mfma_f32_16x16x32_bf16 a[120:123], a[192:195], v[208:211], a[120:123]
ds_read_b128 a[168:171], v2 offset:22528
v_cvt_pk_bf16_f32 v190, v132, v133
v_mfma_f32_16x16x32_bf16 a[124:127], a[200:203], v[208:211], a[124:127]
s_waitcnt lgkmcnt(3)
v_exp_f32 v134, v134
v_mfma_f32_16x16x32_bf16 a[124:127], a[204:207], v[212:215], a[124:127]
buffer_load_dwordx4 v16, s[32:35], s70 offen offset:1024 sc1 lds
v_mfma_f32_16x16x32_bf16 a[92:95], a[204:207], v[204:207], a[92:95]
v_exp_f32 v135, v135
v_mfma_f32_16x16x32_bf16 a[92:95], a[200:203], v[200:203], a[92:95]
ds_read_b128 a[172:175], v2 offset:23552
v_cvt_pk_bf16_f32 v191, v134, v135
v_mfma_f32_16x16x32_bf16 v[120:123], a[144:147], v[56:59], v[224:227]
ds_read_b128 a[176:179], v2 offset:24576
ds_read_b128 a[180:183], v2 offset:25600
v_mfma_f32_16x16x32_bf16 v[120:123], a[148:151], v[60:63], v[120:123]
buffer_load_dwordx4 v16, s[32:35], s70 offen offset:2048 sc1 lds
v_mfma_f32_16x16x32_bf16 v[120:123], a[152:155], v[64:67], v[120:123]
s_add_u32 s64, s70, 4096
ds_read_b128 a[184:187], v2 offset:26624
ds_read_b128 a[188:191], v2 offset:27648
v_mfma_f32_16x16x32_bf16 v[120:123], a[156:159], v[68:71], v[120:123]
buffer_load_dwordx4 v16, s[32:35], s70 offen offset:3072 sc1 lds
v_mfma_f32_16x16x32_bf16 v[136:139], a[156:159], v[84:87], v[228:231]
s_add_u32 m0, s71, 4096
ds_read_b128 a[192:195], v2 offset:28672
ds_read_b128 a[196:199], v2 offset:29696
v_mfma_f32_16x16x32_bf16 v[136:139], a[152:155], v[80:83], v[136:139]
buffer_load_dwordx4 v16, s[32:35], s64 offen offset:0 sc1 lds
v_mfma_f32_16x16x32_bf16 v[136:139], a[148:151], v[76:79], v[136:139]
ds_read_b128 a[200:203], v2 offset:30720
ds_read_b128 a[204:207], v2 offset:31744
v_mfma_f32_16x16x32_bf16 v[136:139], a[144:147], v[72:75], v[136:139]
s_waitcnt lgkmcnt(6)
v_exp_f32 v120, v120
v_mfma_f32_16x16x32_bf16 v[140:143], a[160:163], v[72:75], v[228:231]
v_exp_f32 v121, v121
v_mfma_f32_16x16x32_bf16 v[140:143], a[164:167], v[76:79], v[140:143]
v_exp_f32 v122, v122
v_mfma_f32_16x16x32_bf16 v[140:143], a[168:171], v[80:83], v[140:143]
v_exp_f32 v123, v123
v_mfma_f32_16x16x32_bf16 v[140:143], a[172:175], v[84:87], v[140:143]
v_exp_f32 v136, v136
v_mfma_f32_16x16x32_bf16 v[124:127], a[172:175], v[68:71], v[224:227]
ds_read_b128 a[144:147], v3 offset:16384
v_cvt_pk_bf16_f32 v200, v120, v121
v_mfma_f32_16x16x32_bf16 v[124:127], a[168:171], v[64:67], v[124:127]
v_exp_f32 v137, v137
v_mfma_f32_16x16x32_bf16 v[124:127], a[164:167], v[60:63], v[124:127]
ds_read_b128 a[148:151], v3 offset:24576
v_cvt_pk_bf16_f32 v201, v122, v123
v_mfma_f32_16x16x32_bf16 v[124:127], a[160:163], v[56:59], v[124:127]
v_exp_f32 v138, v138
v_mfma_f32_16x16x32_bf16 v[128:131], a[176:179], v[56:59], v[224:227]
ds_read_b128 a[152:155], v3 offset:17408
v_cvt_pk_bf16_f32 v208, v136, v137
v_mfma_f32_16x16x32_bf16 v[128:131], a[180:183], v[60:63], v[128:131]
s_waitcnt lgkmcnt(3)
v_exp_f32 v139, v139
v_mfma_f32_16x16x32_bf16 v[128:131], a[184:187], v[64:67], v[128:131]
ds_read_b128 a[156:159], v3 offset:25600
v_cvt_pk_bf16_f32 v209, v138, v139
v_mfma_f32_16x16x32_bf16 v[128:131], a[188:191], v[68:71], v[128:131]
v_exp_f32 v140, v140
v_mfma_f32_16x16x32_bf16 v[144:147], a[188:191], v[84:87], v[228:231]
buffer_load_dwordx4 v16, s[32:35], s64 offen offset:1024 sc1 lds
v_mfma_f32_16x16x32_bf16 v[144:147], a[184:187], v[80:83], v[144:147]
v_exp_f32 v141, v141
v_mfma_f32_16x16x32_bf16 v[144:147], a[180:183], v[76:79], v[144:147]
ds_read_b128 a[160:163], v3 offset:18432
v_cvt_pk_bf16_f32 v210, v140, v141
v_mfma_f32_16x16x32_bf16 v[144:147], a[176:179], v[72:75], v[144:147]
v_exp_f32 v142, v142
v_mfma_f32_16x16x32_bf16 v[148:151], a[192:195], v[72:75], v[228:231]
ds_read_b128 a[164:167], v3 offset:26624
ds_read_b128 a[168:171], v3 offset:19456
v_mfma_f32_16x16x32_bf16 v[148:151], a[196:199], v[76:79], v[148:151]
v_exp_f32 v143, v143
v_mfma_f32_16x16x32_bf16 v[148:151], a[200:203], v[80:83], v[148:151]
ds_read_b128 a[172:175], v3 offset:27648
v_cvt_pk_bf16_f32 v211, v142, v143
v_mfma_f32_16x16x32_bf16 v[148:151], a[204:207], v[84:87], v[148:151]
v_exp_f32 v124, v124
v_mfma_f32_16x16x32_bf16 v[132:135], a[204:207], v[68:71], v[224:227]
ds_read_b128 a[176:179], v3 offset:20480
buffer_load_dwordx4 v16, s[32:35], s64 offen offset:2048 sc1 lds
v_mfma_f32_16x16x32_bf16 v[132:135], a[200:203], v[64:67], v[132:135]
v_exp_f32 v125, v125
v_mfma_f32_16x16x32_bf16 v[132:135], a[196:199], v[60:63], v[132:135]
ds_read_b128 a[180:183], v3 offset:28672
v_cvt_pk_bf16_f32 v202, v124, v125
v_mfma_f32_16x16x32_bf16 v[132:135], a[192:195], v[56:59], v[132:135]
v_exp_f32 v126, v126
v_smfmac_f32_16x16x64_bf16 a[136:139], a[240:243], v[184:191], v5
ds_read_b128 a[184:187], v3 offset:21504
v_smfmac_f32_16x16x64_bf16 a[140:143], a[240:243], v[192:199], v5
s_waitcnt lgkmcnt(3)
ds_read_b128 a[188:191], v3 offset:29696
v_mfma_f32_16x16x32_bf16 a[64:67], a[144:147], v[184:187], a[64:67]
v_exp_f32 v127, v127
v_mfma_f32_16x16x32_bf16 a[64:67], a[148:151], v[188:191], a[64:67]
v_exp_f32 v128, v128
v_mfma_f32_16x16x32_bf16 a[96:99], a[148:151], v[196:199], a[96:99]
v_exp_f32 v129, v129
v_mfma_f32_16x16x32_bf16 a[96:99], a[144:147], v[192:195], a[96:99]
ds_read_b128 a[192:195], v3 offset:22528
v_cvt_pk_bf16_f32 v203, v126, v127
v_mfma_f32_16x16x32_bf16 a[100:103], a[152:155], v[192:195], a[100:103]
v_exp_f32 v130, v130
v_mfma_f32_16x16x32_bf16 a[100:103], a[156:159], v[196:199], a[100:103]
ds_read_b128 a[196:199], v3 offset:30720
v_cvt_pk_bf16_f32 v204, v128, v129
v_mfma_f32_16x16x32_bf16 a[68:71], a[156:159], v[188:191], a[68:71]
v_exp_f32 v131, v131
v_mfma_f32_16x16x32_bf16 a[68:71], a[152:155], v[184:187], a[68:71]
ds_read_b128 a[200:203], v3 offset:23552
v_cvt_pk_bf16_f32 v205, v130, v131
v_mfma_f32_16x16x32_bf16 a[72:75], a[160:163], v[184:187], a[72:75]
v_exp_f32 v144, v144
v_mfma_f32_16x16x32_bf16 a[72:75], a[164:167], v[188:191], a[72:75]
buffer_load_dwordx4 v16, s[32:35], s64 offen offset:3072 sc1 lds
v_mfma_f32_16x16x32_bf16 a[104:107], a[164:167], v[196:199], a[104:107]
s_xor_b32 s71, s71, 49152
v_exp_f32 v145, v145
v_mfma_f32_16x16x32_bf16 a[104:107], a[160:163], v[192:195], a[104:107]
ds_read_b128 a[204:207], v3 offset:31744
v_cvt_pk_bf16_f32 v212, v144, v145
v_mfma_f32_16x16x32_bf16 a[108:111], a[168:171], v[192:195], a[108:111]
s_add_u32 s70, s70, 32768
v_xor_b32 v2, 0x8000, v2
v_exp_f32 v146, v146
v_mfma_f32_16x16x32_bf16 a[108:111], a[172:175], v[196:199], a[108:111]
s_waitcnt vmcnt(8)
s_barrier
v_mfma_f32_16x16x32_bf16 a[76:79], a[172:175], v[188:191], a[76:79]
s_mov_b32 m0, s71
v_exp_f32 v147, v147
v_mfma_f32_16x16x32_bf16 a[76:79], a[168:171], v[184:187], a[76:79]
s_waitcnt lgkmcnt(1)
ds_read_b128 a[144:147], v2 offset:0
v_cvt_pk_bf16_f32 v213, v146, v147
v_mfma_f32_16x16x32_bf16 a[80:83], a[176:179], v[184:187], a[80:83]
v_exp_f32 v148, v148
v_mfma_f32_16x16x32_bf16 a[80:83], a[180:183], v[188:191], a[80:83]
ds_read_b128 a[148:151], v2 offset:1024
ds_read_b128 a[152:155], v2 offset:2048
v_mfma_f32_16x16x32_bf16 a[112:115], a[180:183], v[196:199], a[112:115]
v_exp_f32 v149, v149
v_mfma_f32_16x16x32_bf16 a[112:115], a[176:179], v[192:195], a[112:115]
ds_read_b128 a[156:159], v2 offset:3072
v_cvt_pk_bf16_f32 v214, v148, v149
v_mfma_f32_16x16x32_bf16 a[116:119], a[184:187], v[192:195], a[116:119]
v_exp_f32 v150, v150
v_mfma_f32_16x16x32_bf16 a[116:119], a[188:191], v[196:199], a[116:119]
buffer_load_dwordx4 v16, s[32:35], s70 offen offset:0 sc1 lds
v_mfma_f32_16x16x32_bf16 a[84:87], a[188:191], v[188:191], a[84:87]
s_sub_u32 s72, s72, 1
v_exp_f32 v151, v151
v_mfma_f32_16x16x32_bf16 a[84:87], a[184:187], v[184:187], a[84:87]
ds_read_b128 a[160:163], v2 offset:4096
v_cvt_pk_bf16_f32 v215, v150, v151
v_mfma_f32_16x16x32_bf16 a[88:91], a[192:195], v[184:187], a[88:91]
v_exp_f32 v132, v132
v_mfma_f32_16x16x32_bf16 a[88:91], a[196:199], v[188:191], a[88:91]
ds_read_b128 a[164:167], v2 offset:5120
v_xor_b32 v3, 0x8000, v3
v_mfma_f32_16x16x32_bf16 a[120:123], a[196:199], v[196:199], a[120:123]
s_cmp_lg_u32 s72, 0
v_exp_f32 v133, v133
v_mfma_f32_16x16x32_bf16 a[120:123], a[192:195], v[192:195], a[120:123]
ds_read_b128 a[168:171], v2 offset:6144
v_cvt_pk_bf16_f32 v206, v132, v133
v_mfma_f32_16x16x32_bf16 a[124:127], a[200:203], v[192:195], a[124:127]
s_waitcnt lgkmcnt(3)
v_exp_f32 v134, v134
v_mfma_f32_16x16x32_bf16 a[124:127], a[204:207], v[196:199], a[124:127]
buffer_load_dwordx4 v16, s[32:35], s70 offen offset:1024 sc1 lds
v_mfma_f32_16x16x32_bf16 a[92:95], a[204:207], v[188:191], a[92:95]
v_exp_f32 v135, v135
v_mfma_f32_16x16x32_bf16 a[92:95], a[200:203], v[184:187], a[92:95]
ds_read_b128 a[172:175], v2 offset:7168
v_cvt_pk_bf16_f32 v207, v134, v135
s_cbranch_scc1 L_S
L_SD:
buffer_load_dword v19, off, s[52:55], s80 sc1
s_waitcnt lgkmcnt(7)
v_mfma_f32_16x16x32_bf16 v[136:139], a[144:147], v[72:75], v[228:231]
s_waitcnt lgkmcnt(6)
ds_read_b128 a[176:179], v2 offset:8192
ds_read_b128 a[180:183], v2 offset:9216
v_mfma_f32_16x16x32_bf16 v[136:139], a[148:151], v[76:79], v[136:139]
s_waitcnt lgkmcnt(7)
buffer_load_dwordx4 v16, s[32:35], s70 offen offset:2048 sc1 lds
v_cndmask_b32 v120, v224, v17, s[0:1]
v_cndmask_b32 v121, v224, v17, s[4:5]
v_cndmask_b32 v122, v224, v17, s[6:7]
v_cndmask_b32 v123, v224, v17, s[8:9]
v_mfma_f32_16x16x32_bf16 v[136:139], a[152:155], v[80:83], v[136:139]
s_waitcnt lgkmcnt(6)
s_add_u32 s64, s70, 4096
ds_read_b128 a[184:187], v2 offset:10240
ds_read_b128 a[188:191], v2 offset:11264
v_mfma_f32_16x16x32_bf16 v[136:139], a[156:159], v[84:87], v[136:139]
buffer_load_dwordx4 v16, s[32:35], s70 offen offset:3072 sc1 lds
v_mfma_f32_16x16x32_bf16 v[120:123], a[156:159], v[68:71], v[120:123]
s_add_u32 m0, s71, 4096
ds_read_b128 a[192:195], v2 offset:12288
ds_read_b128 a[196:199], v2 offset:13312
v_mfma_f32_16x16x32_bf16 v[120:123], a[152:155], v[64:67], v[120:123]
buffer_load_dwordx4 v16, s[32:35], s64 offen offset:0 sc1 lds
v_mfma_f32_16x16x32_bf16 v[120:123], a[148:151], v[60:63], v[120:123]
ds_read_b128 a[200:203], v2 offset:14336
ds_read_b128 a[204:207], v2 offset:15360
v_mfma_f32_16x16x32_bf16 v[120:123], a[144:147], v[56:59], v[120:123]
s_waitcnt lgkmcnt(6)
v_exp_f32 v136, v136
v_mfma_f32_16x16x32_bf16 v[140:143], a[160:163], v[72:75], v[228:231]
v_exp_f32 v137, v137
v_mfma_f32_16x16x32_bf16 v[140:143], a[164:167], v[76:79], v[140:143]
v_cndmask_b32 v124, v224, v17, s[10:11]
v_cndmask_b32 v125, v224, v17, s[12:13]
v_cndmask_b32 v126, v224, v17, s[18:19]
v_cndmask_b32 v127, v224, v17, s[22:23]
v_exp_f32 v138, v138
v_mfma_f32_16x16x32_bf16 v[140:143], a[168:171], v[80:83], v[140:143]
v_exp_f32 v139, v139
v_mfma_f32_16x16x32_bf16 v[140:143], a[172:175], v[84:87], v[140:143]
v_exp_f32 v120, v120
v_mfma_f32_16x16x32_bf16 v[124:127], a[172:175], v[68:71], v[124:127]
ds_read_b128 a[144:147], v3 offset:0
v_cvt_pk_bf16_f32 v192, v136, v137
v_mfma_f32_16x16x32_bf16 v[124:127], a[168:171], v[64:67], v[124:127]
v_cndmask_b32 v128, v224, v17, s[26:27]
v_cndmask_b32 v129, v224, v17, s[56:57]
v_cndmask_b32 v130, v224, v17, s[58:59]
v_cndmask_b32 v131, v224, v17, s[60:61]
v_exp_f32 v121, v121
v_mfma_f32_16x16x32_bf16 v[124:127], a[164:167], v[60:63], v[124:127]
s_mul_i32 s69, s83, 8
ds_read_b128 a[148:151], v3 offset:8192
v_cvt_pk_bf16_f32 v193, v138, v139
v_mfma_f32_16x16x32_bf16 v[124:127], a[160:163], v[56:59], v[124:127]
s_sub_u32 s69, 36, s69
v_exp_f32 v122, v122
v_mfma_f32_16x16x32_bf16 v[128:131], a[176:179], v[56:59], v[128:131]
ds_read_b128 a[152:155], v3 offset:1024
v_cvt_pk_bf16_f32 v184, v120, v121
v_mfma_f32_16x16x32_bf16 v[128:131], a[180:183], v[60:63], v[128:131]
s_waitcnt lgkmcnt(3)
v_exp_f32 v123, v123
v_mfma_f32_16x16x32_bf16 v[128:131], a[184:187], v[64:67], v[128:131]
ds_read_b128 a[156:159], v3 offset:9216
v_cvt_pk_bf16_f32 v185, v122, v123
v_mfma_f32_16x16x32_bf16 v[128:131], a[188:191], v[68:71], v[128:131]
v_exp_f32 v140, v140
v_mfma_f32_16x16x32_bf16 v[144:147], a[188:191], v[84:87], v[228:231]
buffer_load_dwordx4 v16, s[32:35], s64 offen offset:1024 sc1 lds
v_mfma_f32_16x16x32_bf16 v[144:147], a[184:187], v[80:83], v[144:147]
v_exp_f32 v141, v141
v_mfma_f32_16x16x32_bf16 v[144:147], a[180:183], v[76:79], v[144:147]
ds_read_b128 a[160:163], v3 offset:2048
v_cvt_pk_bf16_f32 v194, v140, v141
v_mfma_f32_16x16x32_bf16 v[144:147], a[176:179], v[72:75], v[144:147]
v_exp_f32 v142, v142
v_mfma_f32_16x16x32_bf16 v[148:151], a[192:195], v[72:75], v[228:231]
ds_read_b128 a[164:167], v3 offset:10240
ds_read_b128 a[168:171], v3 offset:3072
v_mfma_f32_16x16x32_bf16 v[148:151], a[196:199], v[76:79], v[148:151]
v_cndmask_b32 v132, v224, v17, s[62:63]
v_cndmask_b32 v133, v224, v17, s[48:49]
v_cndmask_b32 v134, v224, v17, s[50:51]
v_cndmask_b32 v135, v224, v17, s[100:101]
v_exp_f32 v143, v143
v_mfma_f32_16x16x32_bf16 v[148:151], a[200:203], v[80:83], v[148:151]
ds_read_b128 a[172:175], v3 offset:11264
v_cvt_pk_bf16_f32 v195, v142, v143
v_mfma_f32_16x16x32_bf16 v[148:151], a[204:207], v[84:87], v[148:151]
v_exp_f32 v124, v124
v_mfma_f32_16x16x32_bf16 v[132:135], a[204:207], v[68:71], v[132:135]
ds_read_b128 a[176:179], v3 offset:4096
buffer_load_dwordx4 v16, s[32:35], s64 offen offset:2048 sc1 lds
v_mfma_f32_16x16x32_bf16 v[132:135], a[200:203], v[64:67], v[132:135]
v_exp_f32 v125, v125
v_mfma_f32_16x16x32_bf16 v[132:135], a[196:199], v[60:63], v[132:135]
ds_read_b128 a[180:183], v3 offset:12288
v_cvt_pk_bf16_f32 v186, v124, v125
v_mfma_f32_16x16x32_bf16 v[132:135], a[192:195], v[56:59], v[132:135]
v_exp_f32 v126, v126
v_smfmac_f32_16x16x64_bf16 a[136:139], a[240:243], v[200:207], v5
ds_read_b128 a[184:187], v3 offset:5120
v_smfmac_f32_16x16x64_bf16 a[140:143], a[240:243], v[208:215], v5
s_branch L_po19
L_pg19:
s_branch L_pg23
L_po19:
s_waitcnt lgkmcnt(3)
ds_read_b128 a[188:191], v3 offset:13312
v_mfma_f32_16x16x32_bf16 a[64:67], a[144:147], v[200:203], a[64:67]
v_exp_f32 v127, v127
v_mfma_f32_16x16x32_bf16 a[64:67], a[148:151], v[204:207], a[64:67]
v_exp_f32 v128, v128
v_mfma_f32_16x16x32_bf16 a[96:99], a[148:151], v[212:215], a[96:99]
v_exp_f32 v129, v129
v_mfma_f32_16x16x32_bf16 a[96:99], a[144:147], v[208:211], a[96:99]
ds_read_b128 a[192:195], v3 offset:6144
v_cvt_pk_bf16_f32 v187, v126, v127
v_mfma_f32_16x16x32_bf16 a[100:103], a[152:155], v[208:211], a[100:103]
v_exp_f32 v130, v130
v_mfma_f32_16x16x32_bf16 a[100:103], a[156:159], v[212:215], a[100:103]
ds_read_b128 a[196:199], v3 offset:14336
v_cvt_pk_bf16_f32 v188, v128, v129
v_mfma_f32_16x16x32_bf16 a[68:71], a[156:159], v[204:207], a[68:71]
v_exp_f32 v131, v131
v_mfma_f32_16x16x32_bf16 a[68:71], a[152:155], v[200:203], a[68:71]
ds_read_b128 a[200:203], v3 offset:7168
v_cvt_pk_bf16_f32 v189, v130, v131
v_mfma_f32_16x16x32_bf16 a[72:75], a[160:163], v[200:203], a[72:75]
v_exp_f32 v144, v144
v_mfma_f32_16x16x32_bf16 a[72:75], a[164:167], v[204:207], a[72:75]
buffer_load_dwordx4 v16, s[32:35], s64 offen offset:3072 sc1 lds
v_mfma_f32_16x16x32_bf16 a[104:107], a[164:167], v[212:215], a[104:107]
v_exp_f32 v145, v145
v_mfma_f32_16x16x32_bf16 a[104:107], a[160:163], v[208:211], a[104:107]
ds_read_b128 a[204:207], v3 offset:15360
v_cvt_pk_bf16_f32 v196, v144, v145
v_mfma_f32_16x16x32_bf16 a[108:111], a[168:171], v[208:211], a[108:111]
v_exp_f32 v146, v146
v_mfma_f32_16x16x32_bf16 a[108:111], a[172:175], v[212:215], a[108:111]
s_waitcnt vmcnt(9)
s_barrier
v_mfma_f32_16x16x32_bf16 a[76:79], a[172:175], v[204:207], a[76:79]
v_exp_f32 v147, v147
v_mfma_f32_16x16x32_bf16 a[76:79], a[168:171], v[200:203], a[76:79]
s_waitcnt lgkmcnt(1)
ds_read_b128 a[144:147], v2 offset:16384
v_cvt_pk_bf16_f32 v197, v146, v147
v_mfma_f32_16x16x32_bf16 a[80:83], a[176:179], v[200:203], a[80:83]
s_waitcnt vmcnt(6)
v_readfirstlane_b32 vcc_lo, v19
s_nop 0
s_cmp_lt_u32 vcc_lo, s69
s_cbranch_scc1 L_spin_8
L_spinbk_9:
v_exp_f32 v148, v148
v_mfma_f32_16x16x32_bf16 a[80:83], a[180:183], v[204:207], a[80:83]
ds_read_b128 a[148:151], v2 offset:17408
ds_read_b128 a[152:155], v2 offset:18432
v_mfma_f32_16x16x32_bf16 a[112:115], a[180:183], v[212:215], a[112:115]
v_exp_f32 v149, v149
v_mfma_f32_16x16x32_bf16 a[112:115], a[176:179], v[208:211], a[112:115]
ds_read_b128 a[156:159], v2 offset:19456
v_cvt_pk_bf16_f32 v198, v148, v149
v_mfma_f32_16x16x32_bf16 a[116:119], a[184:187], v[208:211], a[116:119]
v_exp_f32 v150, v150
v_mfma_f32_16x16x32_bf16 a[116:119], a[188:191], v[212:215], a[116:119]
v_cndmask_b32 v136, v228, v17, s[0:1]
v_cndmask_b32 v137, v228, v17, s[4:5]
v_mfma_f32_16x16x32_bf16 a[84:87], a[188:191], v[204:207], a[84:87]
v_exp_f32 v151, v151
v_mfma_f32_16x16x32_bf16 a[84:87], a[184:187], v[200:203], a[84:87]
ds_read_b128 a[160:163], v2 offset:20480
v_cvt_pk_bf16_f32 v199, v150, v151
v_mfma_f32_16x16x32_bf16 a[88:91], a[192:195], v[200:203], a[88:91]
v_exp_f32 v132, v132
v_mfma_f32_16x16x32_bf16 a[88:91], a[196:199], v[204:207], a[88:91]
ds_read_b128 a[164:167], v2 offset:21504
v_cndmask_b32 v138, v228, v17, s[6:7]
v_mfma_f32_16x16x32_bf16 a[120:123], a[196:199], v[212:215], a[120:123]
v_exp_f32 v133, v133
v_mfma_f32_16x16x32_bf16 a[120:123], a[192:195], v[208:211], a[120:123]
ds_read_b128 a[168:171], v2 offset:22528
v_cvt_pk_bf16_f32 v190, v132, v133
v_mfma_f32_16x16x32_bf16 a[124:127], a[200:203], v[208:211], a[124:127]
s_waitcnt lgkmcnt(3)
v_exp_f32 v134, v134
v_mfma_f32_16x16x32_bf16 a[124:127], a[204:207], v[212:215], a[124:127]
v_cndmask_b32 v139, v228, v17, s[8:9]
v_cndmask_b32 v140, v228, v17, s[10:11]
v_mfma_f32_16x16x32_bf16 a[92:95], a[204:207], v[204:207], a[92:95]
v_exp_f32 v135, v135
v_mfma_f32_16x16x32_bf16 a[92:95], a[200:203], v[200:203], a[92:95]
ds_read_b128 a[172:175], v2 offset:23552
v_cvt_pk_bf16_f32 v191, v134, v135
v_mfma_f32_16x16x32_bf16 v[136:139], a[144:147], v[72:75], v[136:139]
ds_read_b128 a[176:179], v2 offset:24576
v_cndmask_b32 v141, v228, v17, s[12:13]
v_mfma_f32_16x16x32_bf16 v[136:139], a[148:151], v[76:79], v[136:139]
ds_read_b128 a[180:183], v2 offset:25600
v_cndmask_b32 v142, v228, v17, s[18:19]
v_cndmask_b32 v143, v228, v17, s[22:23]
v_mfma_f32_16x16x32_bf16 v[136:139], a[152:155], v[80:83], v[136:139]
ds_read_b128 a[184:187], v2 offset:26624
v_cndmask_b32 v144, v228, v17, s[26:27]
v_mfma_f32_16x16x32_bf16 v[136:139], a[156:159], v[84:87], v[136:139]
s_waitcnt lgkmcnt(3)
ds_read_b128 a[188:191], v2 offset:27648
v_cndmask_b32 v145, v228, v17, s[56:57]
v_mfma_f32_16x16x32_bf16 v[140:143], a[172:175], v[84:87], v[140:143]
ds_read_b128 a[192:195], v2 offset:28672
ds_read_b128 a[196:199], v2 offset:29696
ds_read_b128 a[200:203], v2 offset:30720
ds_read_b128 a[204:207], v2 offset:31744
v_mfma_f32_16x16x32_bf16 v[140:143], a[168:171], v[80:83], v[140:143]
ds_read_b128 a[144:147], v3 offset:16384
v_cndmask_b32 v146, v228, v17, s[58:59]
v_cndmask_b32 v147, v228, v17, s[60:61]
v_mfma_f32_16x16x32_bf16 v[140:143], a[164:167], v[76:79], v[140:143]
ds_read_b128 a[148:151], v3 offset:24576
v_cndmask_b32 v148, v228, v17, s[62:63]
v_mfma_f32_16x16x32_bf16 v[140:143], a[160:163], v[72:75], v[140:143]
s_waitcnt lgkmcnt(8)
ds_read_b128 a[152:155], v3 offset:17408
v_cndmask_b32 v149, v228, v17, s[48:49]
v_mfma_f32_16x16x32_bf16 v[144:147], a[176:179], v[72:75], v[144:147]
ds_read_b128 a[156:159], v3 offset:25600
v_cndmask_b32 v150, v228, v17, s[50:51]
v_mfma_f32_16x16x32_bf16 v[144:147], a[180:183], v[76:79], v[144:147]
s_waitcnt lgkmcnt(8)
ds_read_b128 a[160:163], v3 offset:18432
v_cndmask_b32 v151, v228, v17, s[100:101]
v_mfma_f32_16x16x32_bf16 v[144:147], a[184:187], v[80:83], v[144:147]
v_exp_f32 v136, v136
v_mfma_f32_16x16x32_bf16 v[144:147], a[188:191], v[84:87], v[144:147]
s_waitcnt lgkmcnt(4)
v_exp_f32 v137, v137
v_mfma_f32_16x16x32_bf16 v[148:151], a[204:207], v[84:87], v[148:151]
v_exp_f32 v138, v138
v_mfma_f32_16x16x32_bf16 v[148:151], a[200:203], v[80:83], v[148:151]
s_add_u32 s65, s84, 0
v_exp_f32 v139, v139
v_mfma_f32_16x16x32_bf16 v[148:151], a[196:199], v[76:79], v[148:151]
buffer_load_dwordx4 a[208:211], v14, s[44:47], s65 offen offset:0 sc1
v_mfma_f32_16x16x32_bf16 v[148:151], a[192:195], v[72:75], v[148:151]
ds_read_b128 a[164:167], v3 offset:26624
v_cvt_pk_bf16_f32 v208, v136, v137
v_smfmac_f32_16x16x64_bf16 a[136:139], a[240:243], v[184:191], v5
ds_read_b128 a[168:171], v3 offset:19456
v_smfmac_f32_16x16x64_bf16 a[140:143], a[240:243], v[192:199], v5
ds_read_b128 a[172:175], v3 offset:27648
v_mfma_f32_16x16x32_bf16 a[64:67], a[144:147], v[184:187], a[64:67]
s_waitcnt lgkmcnt(3)
v_exp_f32 v140, v140
v_mfma_f32_16x16x32_bf16 a[64:67], a[148:151], v[188:191], a[64:67]
buffer_load_dwordx4 a[216:219], v14, s[44:47], s65 offen offset:1024 sc1
v_mfma_f32_16x16x32_bf16 a[96:99], a[148:151], v[196:199], a[96:99]
v_exp_f32 v141, v141
v_mfma_f32_16x16x32_bf16 a[96:99], a[144:147], v[192:195], a[96:99]
buffer_load_dwordx4 a[224:227], v15, s[44:47], s65 offen offset:0 sc1
v_mfma_f32_16x16x32_bf16 a[100:103], a[152:155], v[192:195], a[100:103]
v_exp_f32 v142, v142
v_mfma_f32_16x16x32_bf16 a[100:103], a[156:159], v[196:199], a[100:103]
buffer_load_dwordx4 a[232:235], v15, s[44:47], s65 offen offset:1024 sc1
v_mfma_f32_16x16x32_bf16 a[68:71], a[156:159], v[188:191], a[68:71]
s_add_u32 s65, s84, 8192
ds_read_b128 a[176:179], v3 offset:20480
v_cvt_pk_bf16_f32 v209, v138, v139
v_mfma_f32_16x16x32_bf16 a[68:71], a[152:155], v[184:187], a[68:71]
buffer_load_dwordx4 a[212:215], v14, s[44:47], s65 offen offset:0 sc1
v_mfma_f32_16x16x32_bf16 a[72:75], a[160:163], v[184:187], a[72:75]
s_waitcnt lgkmcnt(1)
ds_read_b128 a[180:183], v3 offset:28672
v_cvt_pk_bf16_f32 v210, v140, v141
v_mfma_f32_16x16x32_bf16 a[72:75], a[164:167], v[188:191], a[72:75]
v_exp_f32 v143, v143
v_mfma_f32_16x16x32_bf16 a[104:107], a[164:167], v[196:199], a[104:107]
buffer_load_dwordx4 a[220:223], v14, s[44:47], s65 offen offset:1024 sc1
v_mfma_f32_16x16x32_bf16 a[104:107], a[160:163], v[192:195], a[104:107]
v_exp_f32 v144, v144
v_mfma_f32_16x16x32_bf16 a[108:111], a[168:171], v[192:195], a[108:111]
ds_read_b128 a[184:187], v3 offset:21504
v_xor_b32 v2, 0x8000, v2
v_mfma_f32_16x16x32_bf16 a[108:111], a[172:175], v[196:199], a[108:111]
buffer_load_dwordx4 a[228:231], v15, s[44:47], s65 offen offset:0 sc1
ds_read_b128 a[188:191], v3 offset:29696
v_mfma_f32_16x16x32_bf16 a[76:79], a[172:175], v[188:191], a[76:79]
v_exp_f32 v145, v145
v_mfma_f32_16x16x32_bf16 a[76:79], a[168:171], v[184:187], a[76:79]
s_waitcnt lgkmcnt(2)
buffer_load_dwordx4 a[236:239], v15, s[44:47], s65 offen offset:1024 sc1
v_mfma_f32_16x16x32_bf16 a[80:83], a[176:179], v[184:187], a[80:83]
s_add_u32 s65, s84, 32768
ds_read_b128 a[192:195], v3 offset:22528
v_cvt_pk_bf16_f32 v211, v142, v143
v_mfma_f32_16x16x32_bf16 a[80:83], a[180:183], v[188:191], a[80:83]
buffer_load_dwordx4 v[152:155], v14, s[44:47], s65 offen offset:0 sc1
ds_read_b128 a[196:199], v3 offset:30720
v_exp_f32 v146, v146
v_mfma_f32_16x16x32_bf16 a[112:115], a[180:183], v[196:199], a[112:115]
ds_read_b128 a[200:203], v3 offset:23552
ds_read_b128 a[204:207], v3 offset:31744
v_mfma_f32_16x16x32_bf16 a[112:115], a[176:179], v[192:195], a[112:115]
s_waitcnt vmcnt(9)
s_barrier
v_xor_b32 v3, 0x8000, v3
buffer_load_dwordx4 v[160:163], v14, s[44:47], s65 offen offset:1024 sc1
s_waitcnt lgkmcnt(4)
v_mfma_f32_16x16x32_bf16 a[116:119], a[184:187], v[192:195], a[116:119]
v_exp_f32 v147, v147
v_mfma_f32_16x16x32_bf16 a[116:119], a[188:191], v[196:199], a[116:119]
buffer_load_dwordx4 v[168:171], v15, s[44:47], s65 offen offset:0 sc1
v_mfma_f32_16x16x32_bf16 a[84:87], a[188:191], v[188:191], a[84:87]
v_exp_f32 v148, v148
v_mfma_f32_16x16x32_bf16 a[84:87], a[184:187], v[184:187], a[84:87]
s_waitcnt lgkmcnt(2)
buffer_load_dwordx4 v[176:179], v15, s[44:47], s65 offen offset:1024 sc1
v_cvt_pk_bf16_f32 v212, v144, v145
v_mfma_f32_16x16x32_bf16 a[88:91], a[192:195], v[184:187], a[88:91]
s_add_u32 s65, s84, 40960
v_exp_f32 v149, v149
v_mfma_f32_16x16x32_bf16 a[88:91], a[196:199], v[188:191], a[88:91]
buffer_load_dwordx4 v[156:159], v14, s[44:47], s65 offen offset:0 sc1
v_mfma_f32_16x16x32_bf16 a[120:123], a[196:199], v[196:199], a[120:123]
ds_read_b128 a[144:147], v3 offset:0
v_cvt_pk_bf16_f32 v213, v146, v147
v_mfma_f32_16x16x32_bf16 a[120:123], a[192:195], v[192:195], a[120:123]
s_waitcnt lgkmcnt(1)
buffer_load_dwordx4 v[164:167], v14, s[44:47], s65 offen offset:1024 sc1
ds_read_b128 a[148:151], v3 offset:8192
v_exp_f32 v150, v150
v_mfma_f32_16x16x32_bf16 a[124:127], a[200:203], v[192:195], a[124:127]
ds_read_b128 a[152:155], v3 offset:1024
v_cvt_pk_bf16_f32 v214, v148, v149
v_mfma_f32_16x16x32_bf16 a[124:127], a[204:207], v[196:199], a[124:127]
buffer_load_dwordx4 v[172:175], v15, s[44:47], s65 offen offset:0 sc1
ds_read_b128 a[156:159], v3 offset:9216
v_mfma_f32_16x16x32_bf16 a[92:95], a[204:207], v[188:191], a[92:95]
v_exp_f32 v151, v151
v_mfma_f32_16x16x32_bf16 a[92:95], a[200:203], v[184:187], a[92:95]
buffer_load_dwordx4 v[180:183], v15, s[44:47], s65 offen offset:1024 sc1
ds_read_b128 a[160:163], v3 offset:2048
ds_read_b128 a[164:167], v3 offset:10240
ds_read_b128 a[168:171], v3 offset:3072
ds_read_b128 a[172:175], v3 offset:11264
v_cvt_pk_bf16_f32 v215, v150, v151
v_accvgpr_read_b32 v22, a136
v_accvgpr_read_b32 v248, a137
v_add_f32 v22, v22, v248
v_max_f32 v1, v1, v22
v_rcp_f32 v22, v22
v_accvgpr_read_b32 v232, a64
v_accvgpr_read_b32 v233, a65
v_accvgpr_read_b32 v234, a66
v_accvgpr_read_b32 v235, a67
v_accvgpr_read_b32 v236, a68
v_accvgpr_read_b32 v237, a69
v_accvgpr_read_b32 v238, a70
v_accvgpr_read_b32 v239, a71
v_mul_f32 v22, v22, v8
v_mul_f32 v232, v232, v22
v_mul_f32 v233, v233, v22
v_mul_f32 v234, v234, v22
v_mul_f32 v235, v235, v22
v_mul_f32 v236, v236, v22
v_mul_f32 v237, v237, v22
v_mul_f32 v238, v238, v22
v_mul_f32 v239, v239, v22
v_cvt_pk_bf16_f32 v232, v232, v233
v_cvt_pk_bf16_f32 v233, v234, v235
v_cvt_pk_bf16_f32 v234, v236, v237
v_cvt_pk_bf16_f32 v235, v238, v239
s_add_u32 s77, s75, 0
buffer_store_dwordx4 v[232:235], v16, s[44:47], s77 offen sc1
L_TAIL:
ds_read_b128 a[176:179], v3 offset:4096
ds_read_b128 a[180:183], v3 offset:12288
ds_read_b128 a[184:187], v3 offset:5120
ds_read_b128 a[188:191], v3 offset:13312
v_smfmac_f32_16x16x64_bf16 a[140:143], a[240:243], v[208:215], v5
s_waitcnt lgkmcnt(11)
s_add_u32 m0, s86, 32768
s_add_u32 s64, s85, 262144
ds_read_b128 a[192:195], v3 offset:6144
v_mfma_f32_16x16x32_bf16 a[96:99], a[144:147], v[208:211], a[96:99]
s_waitcnt lgkmcnt(11)
ds_read_b128 a[196:199], v3 offset:14336
ds_read_b128 a[200:203], v3 offset:7168
ds_read_b128 a[204:207], v3 offset:15360
v_mfma_f32_16x16x32_bf16 a[96:99], a[148:151], v[212:215], a[96:99]
s_waitcnt lgkmcnt(12)
buffer_load_dwordx4 v12, s[36:39], s64 offen lds
v_mfma_f32_16x16x32_bf16 a[100:103], a[156:159], v[212:215], a[100:103]
s_add_u32 m0, s86, 33792
s_add_u32 s64, s85, 270336
v_accvgpr_read_b32 v240, a72
v_accvgpr_read_b32 v241, a73
v_mfma_f32_16x16x32_bf16 a[100:103], a[152:155], v[208:211], a[100:103]
s_waitcnt lgkmcnt(11)
buffer_load_dwordx4 v13, s[36:39], s64 offen lds
v_mfma_f32_16x16x32_bf16 a[104:107], a[160:163], v[208:211], a[104:107]
s_waitcnt lgkmcnt(10)
s_add_u32 m0, s86, 34816
s_add_u32 s64, s85, 278528
v_accvgpr_read_b32 v242, a74
v_accvgpr_read_b32 v243, a75
v_mfma_f32_16x16x32_bf16 a[104:107], a[164:167], v[212:215], a[104:107]
s_waitcnt lgkmcnt(8)
buffer_load_dwordx4 v12, s[36:39], s64 offen lds
v_mfma_f32_16x16x32_bf16 a[108:111], a[172:175], v[212:215], a[108:111]
s_add_u32 m0, s86, 35840
s_add_u32 s64, s85, 286720
v_accvgpr_read_b32 v244, a76
v_accvgpr_read_b32 v245, a77
v_mfma_f32_16x16x32_bf16 a[108:111], a[168:171], v[208:211], a[108:111]
s_waitcnt lgkmcnt(7)
buffer_load_dwordx4 v13, s[36:39], s64 offen lds
v_mfma_f32_16x16x32_bf16 a[112:115], a[176:179], v[208:211], a[112:115]
s_waitcnt lgkmcnt(6)
s_add_u32 m0, s86, 36864
s_add_u32 s64, s85, 294912
v_accvgpr_read_b32 v246, a78
v_accvgpr_read_b32 v247, a79
v_mfma_f32_16x16x32_bf16 a[112:115], a[180:183], v[212:215], a[112:115]
s_waitcnt lgkmcnt(4)
buffer_load_dwordx4 v12, s[36:39], s64 offen lds
v_mfma_f32_16x16x32_bf16 a[116:119], a[188:191], v[212:215], a[116:119]
s_add_u32 m0, s86, 37888
s_add_u32 s64, s85, 303104
v_mul_f32 v240, v240, v22
v_mul_f32 v241, v241, v22
v_mfma_f32_16x16x32_bf16 a[116:119], a[184:187], v[208:211], a[116:119]
s_waitcnt lgkmcnt(3)
buffer_load_dwordx4 v13, s[36:39], s64 offen lds
v_mfma_f32_16x16x32_bf16 a[120:123], a[192:195], v[208:211], a[120:123]
s_waitcnt lgkmcnt(2)
s_add_u32 m0, s86, 38912
s_add_u32 s64, s85, 311296
v_mul_f32 v242, v242, v22
v_mul_f32 v243, v243, v22
v_mfma_f32_16x16x32_bf16 a[120:123], a[196:199], v[212:215], a[120:123]
s_waitcnt lgkmcnt(0)
buffer_load_dwordx4 v12, s[36:39], s64 offen lds
v_mfma_f32_16x16x32_bf16 a[124:127], a[204:207], v[212:215], a[124:127]
s_add_u32 m0, s86, 39936
s_add_u32 s64, s85, 319488
v_mul_f32 v244, v244, v22
v_mul_f32 v245, v245, v22
v_mfma_f32_16x16x32_bf16 a[124:127], a[200:203], v[208:211], a[124:127]
buffer_load_dwordx4 v13, s[36:39], s64 offen lds
v_mul_f32 v246, v246, v22
v_mul_f32 v247, v247, v22
v_cvt_pk_bf16_f32 v240, v240, v241
v_cvt_pk_bf16_f32 v241, v242, v243
v_cvt_pk_bf16_f32 v242, v244, v245
v_cvt_pk_bf16_f32 v243, v246, v247
s_add_u32 s77, s75, 8192
buffer_store_dwordx4 v[240:243], v16, s[44:47], s77 offen sc1
v_accvgpr_read_b32 v23, a140
v_accvgpr_read_b32 v248, a141
v_add_f32 v23, v23, v248
v_max_f32 v1, v1, v23
v_rcp_f32 v23, v23
s_mov_b32 s66, 0x5d800000
v_cmp_le_f32 vcc, s66, v1
s_lshl_b32 s67, s30, 2
s_cmp_lg_u64 vcc, 0
s_cselect_b32 s66, 1, 0
v_mov_b32 v248, s67
v_mov_b32 v249, s66
ds_write_b32 v248, v249
v_accvgpr_read_b32 v232, a80
v_accvgpr_read_b32 v233, a81
v_accvgpr_read_b32 v234, a82
v_accvgpr_read_b32 v235, a83
v_accvgpr_read_b32 v236, a84
v_accvgpr_read_b32 v237, a85
v_accvgpr_read_b32 v238, a86
v_accvgpr_read_b32 v239, a87
v_pk_mul_f32 v[232:233], v[232:233], v[22:23] op_sel_hi:[1,0]
v_pk_mul_f32 v[234:235], v[234:235], v[22:23] op_sel_hi:[1,0]
v_pk_mul_f32 v[236:237], v[236:237], v[22:23] op_sel_hi:[1,0]
v_pk_mul_f32 v[238:239], v[238:239], v[22:23] op_sel_hi:[1,0]
v_cvt_pk_bf16_f32 v232, v232, v233
v_cvt_pk_bf16_f32 v233, v234, v235
v_cvt_pk_bf16_f32 v234, v236, v237
v_cvt_pk_bf16_f32 v235, v238, v239
s_add_u32 s77, s75, 16384
buffer_store_dwordx4 v[232:235], v16, s[44:47], s77 offen sc1
v_accvgpr_read_b32 v240, a88
v_accvgpr_read_b32 v241, a89
v_accvgpr_read_b32 v242, a90
v_accvgpr_read_b32 v243, a91
v_accvgpr_read_b32 v244, a92
v_accvgpr_read_b32 v245, a93
v_accvgpr_read_b32 v246, a94
v_accvgpr_read_b32 v247, a95
v_pk_mul_f32 v[240:241], v[240:241], v[22:23] op_sel_hi:[1,0]
v_pk_mul_f32 v[242:243], v[242:243], v[22:23] op_sel_hi:[1,0]
v_pk_mul_f32 v[244:245], v[244:245], v[22:23] op_sel_hi:[1,0]
v_pk_mul_f32 v[246:247], v[246:247], v[22:23] op_sel_hi:[1,0]
v_cvt_pk_bf16_f32 v240, v240, v241
v_cvt_pk_bf16_f32 v241, v242, v243
v_cvt_pk_bf16_f32 v242, v244, v245
v_cvt_pk_bf16_f32 v243, v246, v247
s_add_u32 s77, s75, 24576
buffer_store_dwordx4 v[240:243], v16, s[44:47], s77 offen sc1
v_accvgpr_read_b32 v232, a96
v_accvgpr_read_b32 v233, a97
v_accvgpr_read_b32 v234, a98
v_accvgpr_read_b32 v235, a99
v_accvgpr_read_b32 v236, a100
v_accvgpr_read_b32 v237, a101
v_accvgpr_read_b32 v238, a102
v_accvgpr_read_b32 v239, a103
v_mul_f32 v23, v23, v10
v_pk_mul_f32 v[232:233], v[232:233], v[22:23] op_sel:[0,1]
v_pk_mul_f32 v[234:235], v[234:235], v[22:23] op_sel:[0,1]
v_pk_mul_f32 v[236:237], v[236:237], v[22:23] op_sel:[0,1]
v_pk_mul_f32 v[238:239], v[238:239], v[22:23] op_sel:[0,1]
v_cvt_pk_bf16_f32 v232, v232, v233
v_cvt_pk_bf16_f32 v233, v234, v235
v_cvt_pk_bf16_f32 v234, v236, v237
v_cvt_pk_bf16_f32 v235, v238, v239
s_add_u32 s77, s75, 4096
buffer_store_dwordx4 v[232:235], v16, s[44:47], s77 offen sc1
v_accvgpr_read_b32 v240, a104
v_accvgpr_read_b32 v241, a105
v_accvgpr_read_b32 v242, a106
v_accvgpr_read_b32 v243, a107
v_accvgpr_read_b32 v244, a108
v_accvgpr_read_b32 v245, a109
v_accvgpr_read_b32 v246, a110
v_accvgpr_read_b32 v247, a111
v_pk_mul_f32 v[240:241], v[240:241], v[22:23] op_sel:[0,1]
v_pk_mul_f32 v[242:243], v[242:243], v[22:23] op_sel:[0,1]
v_pk_mul_f32 v[244:245], v[244:245], v[22:23] op_sel:[0,1]
v_pk_mul_f32 v[246:247], v[246:247], v[22:23] op_sel:[0,1]
v_cvt_pk_bf16_f32 v240, v240, v241
v_cvt_pk_bf16_f32 v241, v242, v243
v_cvt_pk_bf16_f32 v242, v244, v245
v_cvt_pk_bf16_f32 v243, v246, v247
s_add_u32 s77, s75, 12288
buffer_store_dwordx4 v[240:243], v16, s[44:47], s77 offen sc1
v_mov_b32 v248, 0
s_waitcnt lgkmcnt(0)
s_barrier
ds_read_b128 v[248:251], v248
v_xor_b32 v188, 128, v18
v_xor_b32 v189, 160, v18
v_xor_b32 v190, 192, v18
ds_read_b64_tr_b16 a[144:145], v188 offset:32768
ds_read_b64_tr_b16 a[146:147], v188 offset:36864
ds_read_b64_tr_b16 a[148:149], v188 offset:40960
ds_read_b64_tr_b16 a[150:151], v188 offset:45056
ds_read_b64_tr_b16 a[152:153], v189 offset:32768
ds_read_b64_tr_b16 a[154:155], v189 offset:36864
ds_read_b64_tr_b16 a[156:157], v189 offset:40960
ds_read_b64_tr_b16 a[158:159], v189 offset:45056
ds_read_b64_tr_b16 a[160:161], v190 offset:32768
ds_read_b64_tr_b16 a[162:163], v190 offset:36864
ds_read_b64_tr_b16 a[164:165], v190 offset:40960
ds_read_b64_tr_b16 a[166:167], v190 offset:45056
v_xor_b32 v191, 224, v18
v_xor_b32 v184, 0, v18
v_xor_b32 v185, 32, v18
v_xor_b32 v186, 64, v18
v_xor_b32 v187, 96, v18
v_accvgpr_read_b32 v232, a112
v_accvgpr_read_b32 v233, a113
v_accvgpr_read_b32 v234, a114
v_accvgpr_read_b32 v235, a115
v_accvgpr_read_b32 v236, a116
v_accvgpr_read_b32 v237, a117
v_accvgpr_read_b32 v238, a118
v_accvgpr_read_b32 v239, a119
v_pk_mul_f32 v[232:233], v[232:233], v[22:23] op_sel:[0,1]
v_pk_mul_f32 v[234:235], v[234:235], v[22:23] op_sel:[0,1]
v_pk_mul_f32 v[236:237], v[236:237], v[22:23] op_sel:[0,1]
v_pk_mul_f32 v[238:239], v[238:239], v[22:23] op_sel:[0,1]
v_cvt_pk_bf16_f32 v232, v232, v233
v_cvt_pk_bf16_f32 v233, v234, v235
v_cvt_pk_bf16_f32 v234, v236, v237
v_cvt_pk_bf16_f32 v235, v238, v239
s_add_u32 s77, s75, 20480
buffer_store_dwordx4 v[232:235], v16, s[44:47], s77 offen sc1
v_accvgpr_read_b32 v240, a120
v_accvgpr_read_b32 v241, a121
v_accvgpr_read_b32 v242, a122
v_accvgpr_read_b32 v243, a123
v_accvgpr_read_b32 v244, a124
v_accvgpr_read_b32 v245, a125
v_accvgpr_read_b32 v246, a126
v_accvgpr_read_b32 v247, a127
v_pk_mul_f32 v[240:241], v[240:241], v[22:23] op_sel:[0,1]
v_pk_mul_f32 v[242:243], v[242:243], v[22:23] op_sel:[0,1]
v_pk_mul_f32 v[244:245], v[244:245], v[22:23] op_sel:[0,1]
v_pk_mul_f32 v[246:247], v[246:247], v[22:23] op_sel:[0,1]
v_cvt_pk_bf16_f32 v240, v240, v241
v_cvt_pk_bf16_f32 v241, v242, v243
v_cvt_pk_bf16_f32 v242, v244, v245
v_cvt_pk_bf16_f32 v243, v246, v247
s_add_u32 s77, s75, 28672
buffer_store_dwordx4 v[240:243], v16, s[44:47], s77 offen sc1
s_waitcnt lgkmcnt(12)
v_or3_b32 v248, v248, v249, v250
v_or_b32 v248, v248, v251
s_nop 0
v_readfirstlane_b32 s66, v248
s_nop 0
s_cmp_gt_u32 s66, s73
s_cbranch_scc1 L_fallback_11
s_cmp_eq_u32 s83, 0
s_cbranch_scc1 L_p5f0
s_waitcnt lgkmcnt(10)
s_waitcnt vmcnt(28)
v_mfma_f32_16x16x32_bf16 v[136:139], a[144:147], a[232:235], 0
s_waitcnt vmcnt(24)
s_waitcnt lgkmcnt(8)
s_add_u32 m0, s86, 98304
ds_read_b64_tr_b16 a[168:169], v191 offset:32768
v_xor_b32 v192, 0x10000, v184
v_mfma_f32_16x16x32_bf16 v[136:139], a[148:151], a[236:239], v[136:139]
s_add_u32 s64, s85, 524288
ds_read_b64_tr_b16 a[170:171], v191 offset:36864
v_xor_b32 v193, 0x10000, v185
v_mfma_f32_16x16x32_bf16 v[104:107], a[148:151], a[228:231], 0
buffer_load_dwordx4 v12, s[36:39], s64 offen lds
v_mfma_f32_16x16x32_bf16 v[104:107], a[144:147], a[224:227], v[104:107]
s_add_u32 m0, s86, 99328
s_add_u32 s64, s85, 532480
ds_read_b64_tr_b16 a[172:173], v191 offset:40960
v_xor_b32 v194, 0x10000, v186
v_mfma_f32_16x16x32_bf16 v[72:75], a[144:147], a[216:219], 0
buffer_load_dwordx4 v13, s[36:39], s64 offen lds
v_mfma_f32_16x16x32_bf16 v[72:75], a[148:151], a[220:223], v[72:75]
s_add_u32 m0, s86, 100352
ds_read_b64_tr_b16 a[174:175], v191 offset:45056
v_xor_b32 v195, 0x10000, v187
v_mfma_f32_16x16x32_bf16 v[40:43], a[148:151], a[212:215], 0
s_add_u32 s64, s85, 540672
ds_read_b64_tr_b16 a[176:177], v184 offset:32768
v_xor_b32 v196, 0x10000, v188
v_mfma_f32_16x16x32_bf16 v[40:43], a[144:147], a[208:211], v[40:43]
s_waitcnt lgkmcnt(5)
buffer_load_dwordx4 v12, s[36:39], s64 offen lds
v_mfma_f32_16x16x32_bf16 v[44:47], a[152:155], a[208:211], 0
s_add_u32 m0, s86, 101376
s_add_u32 s64, s85, 548864
ds_read_b64_tr_b16 a[178:179], v184 offset:36864
v_xor_b32 v197, 0x10000, v189
v_mfma_f32_16x16x32_bf16 v[44:47], a[156:159], a[212:215], v[44:47]
buffer_load_dwordx4 v13, s[36:39], s64 offen lds
v_mfma_f32_16x16x32_bf16 v[76:79], a[156:159], a[220:223], 0
s_add_u32 m0, s86, 102400
ds_read_b64_tr_b16 a[180:181], v184 offset:40960
v_xor_b32 v198, 0x10000, v190
v_mfma_f32_16x16x32_bf16 v[76:79], a[152:155], a[216:219], v[76:79]
s_add_u32 s64, s85, 557056
ds_read_b64_tr_b16 a[182:183], v184 offset:45056
v_xor_b32 v199, 0x10000, v191
v_mfma_f32_16x16x32_bf16 v[108:111], a[152:155], a[224:227], 0
buffer_load_dwordx4 v12, s[36:39], s64 offen lds
v_mfma_f32_16x16x32_bf16 v[108:111], a[156:159], a[228:231], v[108:111]
s_add_u32 m0, s86, 103424
s_add_u32 s64, s85, 565248
ds_read_b64_tr_b16 a[184:185], v185 offset:32768
v_mfma_f32_16x16x32_bf16 v[140:143], a[156:159], a[236:239], 0
buffer_load_dwordx4 v13, s[36:39], s64 offen lds
v_mfma_f32_16x16x32_bf16 v[140:143], a[152:155], a[232:235], v[140:143]
s_add_u32 m0, s86, 104448
s_add_u32 s64, s85, 573440
ds_read_b64_tr_b16 a[186:187], v185 offset:36864
v_mfma_f32_16x16x32_bf16 v[144:147], a[160:163], a[232:235], 0
s_and_b32 s68, s82, 3
s_lshl_b32 s68, s68, 11
ds_read_b64_tr_b16 a[188:189], v185 offset:40960
v_mfma_f32_16x16x32_bf16 v[144:147], a[164:167], a[236:239], v[144:147]
s_add_u32 s76, s86, s68
buffer_load_dwordx4 v12, s[36:39], s64 offen lds
v_mfma_f32_16x16x32_bf16 v[112:115], a[164:167], a[228:231], 0
s_branch L_po20
L_pg20:
s_branch L_pg24
L_po20:
s_and_b32 s71, s31, 4
s_lshl_b32 s71, s71, 5
s_add_u32 m0, s86, 105472
s_add_u32 s64, s85, 581632
ds_read_b64_tr_b16 a[190:191], v185 offset:45056
v_mfma_f32_16x16x32_bf16 v[112:115], a[160:163], a[224:227], v[112:115]
s_add_u32 s71, s71, s79
buffer_load_dwordx4 v13, s[36:39], s64 offen lds
v_mfma_f32_16x16x32_bf16 v[80:83], a[160:163], a[216:219], 0
s_add_u32 s71, s71, 4096
s_add_u32 s72, s80, 4096
ds_read_b64_tr_b16 a[192:193], v186 offset:32768
v_mfma_f32_16x16x32_bf16 v[80:83], a[164:167], a[220:223], v[80:83]
s_lshr_b32 s69, s87, 8
s_lshr_b32 s67, s82, 1
s_add_u32 s65, s84, 65536
ds_read_b64_tr_b16 a[194:195], v186 offset:36864
v_mfma_f32_16x16x32_bf16 v[48:51], a[164:167], a[212:215], 0
s_xor_b32 s69, s69, s67
buffer_load_dwordx4 a[32:35], v14, s[44:47], s65 offen offset:0 sc1
v_mfma_f32_16x16x32_bf16 v[48:51], a[160:163], a[208:211], v[48:51]
s_waitcnt lgkmcnt(4)
s_and_b32 s69, s69, 2
s_lshl_b32 s69, s69, 15
ds_read_b64_tr_b16 a[196:197], v186 offset:40960
v_mfma_f32_16x16x32_bf16 v[52:55], a[168:171], a[208:211], 0
s_add_u32 s68, s68, s69
buffer_load_dwordx4 a[40:43], v14, s[44:47], s65 offen offset:1024 sc1
v_mfma_f32_16x16x32_bf16 v[52:55], a[172:175], a[212:215], v[52:55]
ds_read_b64_tr_b16 a[198:199], v186 offset:45056
v_mfma_f32_16x16x32_bf16 v[84:87], a[172:175], a[220:223], 0
ds_read_b64_tr_b16 a[200:201], v187 offset:32768
v_mfma_f32_16x16x32_bf16 v[84:87], a[168:171], a[216:219], v[84:87]
buffer_load_dwordx4 a[48:51], v15, s[44:47], s65 offen offset:0 sc1
v_mfma_f32_16x16x32_bf16 v[116:119], a[168:171], a[224:227], 0
ds_read_b64_tr_b16 a[202:203], v187 offset:36864
v_mfma_f32_16x16x32_bf16 v[116:119], a[172:175], a[228:231], v[116:119]
buffer_load_dwordx4 a[56:59], v15, s[44:47], s65 offen offset:1024 sc1
v_mfma_f32_16x16x32_bf16 v[148:151], a[172:175], a[236:239], 0
ds_read_b64_tr_b16 a[204:205], v187 offset:40960
v_mfma_f32_16x16x32_bf16 v[148:151], a[168:171], a[232:235], v[148:151]
s_add_u32 s65, s84, 73728
ds_read_b64_tr_b16 a[206:207], v187 offset:45056
v_mfma_f32_16x16x32_bf16 v[120:123], a[176:179], a[232:235], 0
buffer_load_dwordx4 a[36:39], v14, s[44:47], s65 offen offset:0 sc1
v_mfma_f32_16x16x32_bf16 v[120:123], a[180:183], a[236:239], v[120:123]
v_mfma_f32_16x16x32_bf16 v[88:91], a[180:183], a[228:231], 0
buffer_load_dwordx4 a[44:47], v14, s[44:47], s65 offen offset:1024 sc1
v_mfma_f32_16x16x32_bf16 v[88:91], a[176:179], a[224:227], v[88:91]
v_mfma_f32_16x16x32_bf16 v[56:59], a[176:179], a[216:219], 0
v_mfma_f32_16x16x32_bf16 v[56:59], a[180:183], a[220:223], v[56:59]
buffer_load_dwordx4 a[52:55], v15, s[44:47], s65 offen offset:0 sc1
v_mfma_f32_16x16x32_bf16 v[24:27], a[180:183], a[212:215], 0
v_mfma_f32_16x16x32_bf16 v[24:27], a[176:179], a[208:211], v[24:27]
buffer_load_dwordx4 a[60:63], v15, s[44:47], s65 offen offset:1024 sc1
v_mfma_f32_16x16x32_bf16 v[28:31], a[184:187], a[208:211], 0
s_waitcnt lgkmcnt(0)
v_mfma_f32_16x16x32_bf16 v[28:31], a[188:191], a[212:215], v[28:31]
v_mfma_f32_16x16x32_bf16 v[60:63], a[188:191], a[220:223], 0
buffer_load_dword v19, off, s[52:55], s72 sc1
v_mfma_f32_16x16x32_bf16 v[60:63], a[184:187], a[216:219], v[60:63]
s_add_u32 s85, s85, 2883584
s_lshl3_add_u32 s85, s68, s85
s_waitcnt vmcnt(24) lgkmcnt(0)
s_barrier
v_mfma_f32_16x16x32_bf16 v[92:95], a[184:187], a[224:227], 0
ds_read_b64_tr_b16 a[144:145], v196 offset:0
v_mfma_f32_16x16x32_bf16 v[92:95], a[188:191], a[228:231], v[92:95]
ds_read_b64_tr_b16 a[146:147], v196 offset:4096
v_mfma_f32_16x16x32_bf16 v[124:127], a[188:191], a[236:239], 0
s_xor_b32 m0, s76, 131072
ds_read_b64_tr_b16 a[148:149], v196 offset:8192
v_mfma_f32_16x16x32_bf16 v[124:127], a[184:187], a[232:235], v[124:127]
s_xor_b32 s64, s85, 0
ds_read_b64_tr_b16 a[150:151], v196 offset:12288
v_mfma_f32_16x16x32_bf16 v[128:131], a[192:195], a[232:235], 0
buffer_load_dwordx4 v12, s[40:43], s64 offen lds
v_mfma_f32_16x16x32_bf16 v[128:131], a[196:199], a[236:239], v[128:131]
s_xor_b32 m0, s76, 132096
ds_read_b64_tr_b16 a[152:153], v197 offset:0
v_mfma_f32_16x16x32_bf16 v[96:99], a[196:199], a[228:231], 0
s_xor_b32 s64, s85, 8192
ds_read_b64_tr_b16 a[154:155], v197 offset:4096
v_mfma_f32_16x16x32_bf16 v[96:99], a[192:195], a[224:227], v[96:99]
buffer_load_dwordx4 v13, s[40:43], s64 offen lds
v_mfma_f32_16x16x32_bf16 v[64:67], a[192:195], a[216:219], 0
s_xor_b32 m0, s76, 133120
ds_read_b64_tr_b16 a[156:157], v197 offset:8192
v_mfma_f32_16x16x32_bf16 v[64:67], a[196:199], a[220:223], v[64:67]
s_xor_b32 s64, s85, 16384
ds_read_b64_tr_b16 a[158:159], v197 offset:12288
v_mfma_f32_16x16x32_bf16 v[32:35], a[196:199], a[212:215], 0
buffer_load_dwordx4 v12, s[40:43], s64 offen lds
v_mfma_f32_16x16x32_bf16 v[32:35], a[192:195], a[208:211], v[32:35]
s_xor_b32 m0, s76, 134144
ds_read_b64_tr_b16 a[160:161], v198 offset:0
v_mfma_f32_16x16x32_bf16 v[36:39], a[200:203], a[208:211], 0
s_xor_b32 s64, s85, 24576
ds_read_b64_tr_b16 a[162:163], v198 offset:4096
v_mfma_f32_16x16x32_bf16 v[36:39], a[204:207], a[212:215], v[36:39]
buffer_load_dwordx4 v13, s[40:43], s64 offen lds
v_mfma_f32_16x16x32_bf16 v[68:71], a[204:207], a[220:223], 0
s_xor_b32 m0, s76, 135168
ds_read_b64_tr_b16 a[164:165], v198 offset:8192
v_mfma_f32_16x16x32_bf16 v[68:71], a[200:203], a[216:219], v[68:71]
s_xor_b32 s64, s85, 32768
ds_read_b64_tr_b16 a[166:167], v198 offset:12288
v_mfma_f32_16x16x32_bf16 v[100:103], a[200:203], a[224:227], 0
buffer_load_dwordx4 v12, s[40:43], s64 offen lds
v_mfma_f32_16x16x32_bf16 v[100:103], a[204:207], a[228:231], v[100:103]
v_mfma_f32_16x16x32_bf16 v[132:135], a[204:207], a[236:239], 0
v_mfma_f32_16x16x32_bf16 v[132:135], a[200:203], a[232:235], v[132:135]
s_waitcnt lgkmcnt(3)
v_mfma_f32_16x16x32_bf16 v[136:139], a[144:147], v[176:179], v[136:139]
s_waitcnt vmcnt(5)
v_readfirstlane_b32 vcc_lo, v19
s_nop 0
s_cmp_lt_u32 vcc_lo, 8
s_cbranch_scc1 L_spin_2016
L_spinbk_2017:
s_sub_u32 s84, s84, 688128
s_add_u32 s84, s84, s69
v_mfma_f32_16x16x32_bf16 v[136:139], a[148:151], v[180:183], v[136:139]
s_xor_b32 m0, s76, 136192
s_xor_b32 s64, s85, 40960
ds_read_b64_tr_b16 a[168:169], v199 offset:0
v_mfma_f32_16x16x32_bf16 v[104:107], a[148:151], v[172:175], v[104:107]
buffer_load_dwordx4 v13, s[40:43], s64 offen lds
v_mfma_f32_16x16x32_bf16 v[104:107], a[144:147], v[168:171], v[104:107]
s_xor_b32 m0, s76, 137216
ds_read_b64_tr_b16 a[170:171], v199 offset:4096
v_mfma_f32_16x16x32_bf16 v[72:75], a[144:147], v[160:163], v[72:75]
s_xor_b32 s64, s85, 49152
ds_read_b64_tr_b16 a[172:173], v199 offset:8192
v_mfma_f32_16x16x32_bf16 v[72:75], a[148:151], v[164:167], v[72:75]
buffer_load_dwordx4 v12, s[40:43], s64 offen lds
v_mfma_f32_16x16x32_bf16 v[40:43], a[148:151], v[156:159], v[40:43]
ds_read_b64_tr_b16 a[174:175], v199 offset:12288
v_mfma_f32_16x16x32_bf16 v[40:43], a[144:147], v[152:155], v[40:43]
s_xor_b32 m0, s76, 138240
ds_read_b64_tr_b16 a[176:177], v192 offset:0
v_mfma_f32_16x16x32_bf16 v[44:47], a[152:155], v[152:155], v[44:47]
s_xor_b32 s64, s85, 57344
ds_read_b64_tr_b16 a[178:179], v192 offset:4096
v_mfma_f32_16x16x32_bf16 v[44:47], a[156:159], v[156:159], v[44:47]
buffer_load_dwordx4 v13, s[40:43], s64 offen lds
v_mfma_f32_16x16x32_bf16 v[76:79], a[156:159], v[164:167], v[76:79]
ds_read_b64_tr_b16 a[180:181], v192 offset:8192
v_mfma_f32_16x16x32_bf16 v[76:79], a[152:155], v[160:163], v[76:79]
s_xor_b32 s65, s84, 0
ds_read_b64_tr_b16 a[182:183], v192 offset:12288
v_mfma_f32_16x16x32_bf16 v[108:111], a[152:155], v[168:171], v[108:111]
buffer_load_dwordx4 a[208:211], v14, s[44:47], s65 offen offset:0 sc1
v_mfma_f32_16x16x32_bf16 v[108:111], a[156:159], v[172:175], v[108:111]
ds_read_b64_tr_b16 a[184:185], v193 offset:0
v_mfma_f32_16x16x32_bf16 v[140:143], a[156:159], v[180:183], v[140:143]
ds_read_b64_tr_b16 a[186:187], v193 offset:4096
v_mfma_f32_16x16x32_bf16 v[140:143], a[152:155], v[176:179], v[140:143]
s_waitcnt lgkmcnt(5)
ds_read_b64_tr_b16 a[188:189], v193 offset:8192
v_mfma_f32_16x16x32_bf16 v[144:147], a[160:163], v[176:179], v[144:147]
buffer_load_dwordx4 a[216:219], v14, s[44:47], s65 offen offset:1024 sc1
v_mfma_f32_16x16x32_bf16 v[144:147], a[164:167], v[180:183], v[144:147]
ds_read_b64_tr_b16 a[190:191], v193 offset:12288
v_mfma_f32_16x16x32_bf16 v[112:115], a[164:167], v[172:175], v[112:115]
ds_read_b64_tr_b16 a[192:193], v194 offset:0
v_mfma_f32_16x16x32_bf16 v[112:115], a[160:163], v[168:171], v[112:115]
ds_read_b64_tr_b16 a[194:195], v194 offset:4096
v_mfma_f32_16x16x32_bf16 v[80:83], a[160:163], v[160:163], v[80:83]
buffer_load_dwordx4 a[224:227], v15, s[44:47], s65 offen offset:0 sc1
v_mfma_f32_16x16x32_bf16 v[80:83], a[164:167], v[164:167], v[80:83]
ds_read_b64_tr_b16 a[196:197], v194 offset:8192
v_mfma_f32_16x16x32_bf16 v[48:51], a[164:167], v[156:159], v[48:51]
ds_read_b64_tr_b16 a[198:199], v194 offset:12288
v_mfma_f32_16x16x32_bf16 v[48:51], a[160:163], v[152:155], v[48:51]
buffer_load_dwordx4 a[232:235], v15, s[44:47], s65 offen offset:1024 sc1
v_mfma_f32_16x16x32_bf16 v[52:55], a[168:171], v[152:155], v[52:55]
v_mfma_f32_16x16x32_bf16 v[52:55], a[172:175], v[156:159], v[52:55]
v_mfma_f32_16x16x32_bf16 v[84:87], a[172:175], v[164:167], v[84:87]
s_xor_b32 s65, s84, 8192
ds_read_b64_tr_b16 a[200:201], v195 offset:0
v_mfma_f32_16x16x32_bf16 v[84:87], a[168:171], v[160:163], v[84:87]
buffer_load_dwordx4 a[212:215], v14, s[44:47], s65 offen offset:0 sc1
v_mfma_f32_16x16x32_bf16 v[116:119], a[168:171], v[168:171], v[116:119]
ds_read_b64_tr_b16 a[202:203], v195 offset:4096
v_mfma_f32_16x16x32_bf16 v[116:119], a[172:175], v[172:175], v[116:119]
ds_read_b64_tr_b16 a[204:205], v195 offset:8192
v_mfma_f32_16x16x32_bf16 v[148:151], a[172:175], v[180:183], v[148:151]
ds_read_b64_tr_b16 a[206:207], v195 offset:12288
v_mfma_f32_16x16x32_bf16 v[148:151], a[168:171], v[176:179], v[148:151]
s_waitcnt lgkmcnt(4)
s_lshl_b32 s66, s30, 30
buffer_load_dwordx4 a[220:223], v14, s[44:47], s65 offen offset:1024 sc1
v_mfma_f32_16x16x32_bf16 v[120:123], a[176:179], v[176:179], v[120:123]
v_lshl_add_u32 v1, v0, 24, s66
v_mfma_f32_16x16x32_bf16 v[120:123], a[180:183], v[180:183], v[120:123]
v_mfma_f32_16x16x32_bf16 v[88:91], a[180:183], v[172:175], v[88:91]
buffer_load_dwordx4 a[228:231], v15, s[44:47], s65 offen offset:0 sc1
v_mfma_f32_16x16x32_bf16 v[88:91], a[176:179], v[168:171], v[88:91]
v_mfma_f32_16x16x32_bf16 v[56:59], a[176:179], v[160:163], v[56:59]
v_mfma_f32_16x16x32_bf16 v[56:59], a[180:183], v[164:167], v[56:59]
v_mfma_f32_16x16x32_bf16 v[24:27], a[180:183], v[156:159], v[24:27]
buffer_load_dwordx4 a[236:239], v15, s[44:47], s65 offen offset:1024 sc1
v_mfma_f32_16x16x32_bf16 v[24:27], a[176:179], v[152:155], v[24:27]
v_mfma_f32_16x16x32_bf16 v[28:31], a[184:187], v[152:155], v[28:31]
v_mfma_f32_16x16x32_bf16 v[28:31], a[188:191], v[156:159], v[28:31]
v_mfma_f32_16x16x32_bf16 v[60:63], a[188:191], v[164:167], v[60:63]
v_mfma_f32_16x16x32_bf16 v[60:63], a[184:187], v[160:163], v[60:63]
s_waitcnt lgkmcnt(0)
s_barrier
v_mfma_f32_16x16x32_bf16 v[92:95], a[184:187], v[168:171], v[92:95]
s_mov_b64 exec, 1
buffer_atomic_add a251, v1, s[52:55], s71 offen offset:0 sc1
s_mov_b64 exec, -1
v_mfma_f32_16x16x32_bf16 v[92:95], a[188:191], v[172:175], v[92:95]
ds_read_b64_tr_b16 a[144:145], v188 offset:0
v_mfma_f32_16x16x32_bf16 v[124:127], a[188:191], v[180:183], v[124:127]
s_xor_b32 m0, s76, 32768
ds_read_b64_tr_b16 a[146:147], v188 offset:4096
v_mfma_f32_16x16x32_bf16 v[124:127], a[184:187], v[176:179], v[124:127]
s_xor_b32 s64, s85, 262144
ds_read_b64_tr_b16 a[148:149], v188 offset:8192
v_mfma_f32_16x16x32_bf16 v[128:131], a[192:195], v[176:179], v[128:131]
buffer_load_dwordx4 v12, s[40:43], s64 offen lds
v_mfma_f32_16x16x32_bf16 v[128:131], a[196:199], v[180:183], v[128:131]
s_xor_b32 m0, s76, 33792
ds_read_b64_tr_b16 a[150:151], v188 offset:12288
v_mfma_f32_16x16x32_bf16 v[96:99], a[196:199], v[172:175], v[96:99]
s_xor_b32 s64, s85, 270336
ds_read_b64_tr_b16 a[152:153], v189 offset:0
v_mfma_f32_16x16x32_bf16 v[96:99], a[192:195], v[168:171], v[96:99]
buffer_load_dwordx4 v13, s[40:43], s64 offen lds
v_mfma_f32_16x16x32_bf16 v[64:67], a[192:195], v[160:163], v[64:67]
s_xor_b32 m0, s76, 34816
ds_read_b64_tr_b16 a[154:155], v189 offset:4096
v_mfma_f32_16x16x32_bf16 v[64:67], a[196:199], v[164:167], v[64:67]
s_xor_b32 s64, s85, 278528
ds_read_b64_tr_b16 a[156:157], v189 offset:8192
v_mfma_f32_16x16x32_bf16 v[32:35], a[196:199], v[156:159], v[32:35]
buffer_load_dwordx4 v12, s[40:43], s64 offen lds
v_mfma_f32_16x16x32_bf16 v[32:35], a[192:195], v[152:155], v[32:35]
s_xor_b32 m0, s76, 35840
ds_read_b64_tr_b16 a[158:159], v189 offset:12288
v_mfma_f32_16x16x32_bf16 v[36:39], a[200:203], v[152:155], v[36:39]
s_xor_b32 s64, s85, 286720
ds_read_b64_tr_b16 a[160:161], v190 offset:0
v_mfma_f32_16x16x32_bf16 v[36:39], a[204:207], v[156:159], v[36:39]
buffer_load_dwordx4 v13, s[40:43], s64 offen lds
v_mfma_f32_16x16x32_bf16 v[68:71], a[204:207], v[164:167], v[68:71]
s_xor_b32 m0, s76, 36864
ds_read_b64_tr_b16 a[162:163], v190 offset:4096
v_mfma_f32_16x16x32_bf16 v[68:71], a[200:203], v[160:163], v[68:71]
s_xor_b32 s64, s85, 294912
ds_read_b64_tr_b16 a[164:165], v190 offset:8192
v_mfma_f32_16x16x32_bf16 v[100:103], a[200:203], v[168:171], v[100:103]
buffer_load_dwordx4 v12, s[40:43], s64 offen lds
v_mfma_f32_16x16x32_bf16 v[100:103], a[204:207], v[172:175], v[100:103]
ds_read_b64_tr_b16 a[166:167], v190 offset:12288
v_mfma_f32_16x16x32_bf16 v[132:135], a[204:207], v[180:183], v[132:135]
v_mfma_f32_16x16x32_bf16 v[132:135], a[200:203], v[176:179], v[132:135]
s_waitcnt lgkmcnt(4)
v_mfma_f32_16x16x32_bf16 v[136:139], a[144:147], a[56:59], v[136:139]
s_xor_b32 m0, s76, 37888
ds_read_b64_tr_b16 a[168:169], v191 offset:0
v_mfma_f32_16x16x32_bf16 v[136:139], a[148:151], a[60:63], v[136:139]
s_xor_b32 s64, s85, 303104
ds_read_b64_tr_b16 a[170:171], v191 offset:4096
v_mfma_f32_16x16x32_bf16 v[104:107], a[148:151], a[52:55], v[104:107]
buffer_load_dwordx4 v13, s[40:43], s64 offen lds
v_mfma_f32_16x16x32_bf16 v[104:107], a[144:147], a[48:51], v[104:107]
s_xor_b32 m0, s76, 38912
ds_read_b64_tr_b16 a[172:173], v191 offset:8192
v_mfma_f32_16x16x32_bf16 v[72:75], a[144:147], a[40:43], v[72:75]
s_xor_b32 s64, s85, 311296
ds_read_b64_tr_b16 a[174:175], v191 offset:12288
v_mfma_f32_16x16x32_bf16 v[72:75], a[148:151], a[44:47], v[72:75]
buffer_load_dwordx4 v12, s[40:43], s64 offen lds
v_mfma_f32_16x16x32_bf16 v[40:43], a[148:151], a[36:39], v[40:43]
ds_read_b64_tr_b16 a[176:177], v184 offset:0
v_mfma_f32_16x16x32_bf16 v[40:43], a[144:147], a[32:35], v[40:43]
s_xor_b32 m0, s76, 39936
ds_read_b64_tr_b16 a[178:179], v184 offset:4096
v_mfma_f32_16x16x32_bf16 v[44:47], a[152:155], a[32:35], v[44:47]
s_xor_b32 s64, s85, 319488
ds_read_b64_tr_b16 a[180:181], v184 offset:8192
v_mfma_f32_16x16x32_bf16 v[44:47], a[156:159], a[36:39], v[44:47]
buffer_load_dwordx4 v13, s[40:43], s64 offen lds
v_mfma_f32_16x16x32_bf16 v[76:79], a[156:159], a[44:47], v[76:79]
ds_read_b64_tr_b16 a[182:183], v184 offset:12288
v_mfma_f32_16x16x32_bf16 v[76:79], a[152:155], a[40:43], v[76:79]
s_xor_b32 s65, s84, 32768
ds_read_b64_tr_b16 a[184:185], v185 offset:0
v_mfma_f32_16x16x32_bf16 v[108:111], a[152:155], a[48:51], v[108:111]
buffer_load_dwordx4 v[152:155], v14, s[44:47], s65 offen offset:0 sc1
v_mfma_f32_16x16x32_bf16 v[108:111], a[156:159], a[52:55], v[108:111]
ds_read_b64_tr_b16 a[186:187], v185 offset:4096
v_mfma_f32_16x16x32_bf16 v[140:143], a[156:159], a[60:63], v[140:143]
ds_read_b64_tr_b16 a[188:189], v185 offset:8192
v_mfma_f32_16x16x32_bf16 v[140:143], a[152:155], a[56:59], v[140:143]
s_waitcnt lgkmcnt(5)
ds_read_b64_tr_b16 a[190:191], v185 offset:12288
v_mfma_f32_16x16x32_bf16 v[144:147], a[160:163], a[56:59], v[144:147]
buffer_load_dwordx4 v[160:163], v14, s[44:47], s65 offen offset:1024 sc1
v_mfma_f32_16x16x32_bf16 v[144:147], a[164:167], a[60:63], v[144:147]
v_mfma_f32_16x16x32_bf16 v[112:115], a[164:167], a[52:55], v[112:115]
ds_read_b64_tr_b16 a[192:193], v186 offset:0
v_mfma_f32_16x16x32_bf16 v[112:115], a[160:163], a[48:51], v[112:115]
ds_read_b64_tr_b16 a[194:195], v186 offset:4096
v_mfma_f32_16x16x32_bf16 v[80:83], a[160:163], a[40:43], v[80:83]
buffer_load_dwordx4 v[168:171], v15, s[44:47], s65 offen offset:0 sc1
v_mfma_f32_16x16x32_bf16 v[80:83], a[164:167], a[44:47], v[80:83]
ds_read_b64_tr_b16 a[196:197], v186 offset:8192
v_mfma_f32_16x16x32_bf16 v[48:51], a[164:167], a[36:39], v[48:51]
ds_read_b64_tr_b16 a[198:199], v186 offset:12288
v_mfma_f32_16x16x32_bf16 v[48:51], a[160:163], a[32:35], v[48:51]
buffer_load_dwordx4 v[176:179], v15, s[44:47], s65 offen offset:1024 sc1
v_mfma_f32_16x16x32_bf16 v[52:55], a[168:171], a[32:35], v[52:55]
v_mfma_f32_16x16x32_bf16 v[52:55], a[172:175], a[36:39], v[52:55]
v_mfma_f32_16x16x32_bf16 v[84:87], a[172:175], a[44:47], v[84:87]
s_xor_b32 s65, s84, 40960
ds_read_b64_tr_b16 a[200:201], v187 offset:0
v_mfma_f32_16x16x32_bf16 v[84:87], a[168:171], a[40:43], v[84:87]
buffer_load_dwordx4 v[156:159], v14, s[44:47], s65 offen offset:0 sc1
v_mfma_f32_16x16x32_bf16 v[116:119], a[168:171], a[48:51], v[116:119]
ds_read_b64_tr_b16 a[202:203], v187 offset:4096
v_mfma_f32_16x16x32_bf16 v[116:119], a[172:175], a[52:55], v[116:119]
ds_read_b64_tr_b16 a[204:205], v187 offset:8192
v_mfma_f32_16x16x32_bf16 v[148:151], a[172:175], a[60:63], v[148:151]
ds_read_b64_tr_b16 a[206:207], v187 offset:12288
v_mfma_f32_16x16x32_bf16 v[148:151], a[168:171], a[56:59], v[148:151]
buffer_load_dwordx4 v[164:167], v14, s[44:47], s65 offen offset:1024 sc1
v_mfma_f32_16x16x32_bf16 v[120:123], a[176:179], a[56:59], v[120:123]
s_waitcnt lgkmcnt(4)
v_mfma_f32_16x16x32_bf16 v[120:123], a[180:183], a[60:63], v[120:123]
v_mfma_f32_16x16x32_bf16 v[88:91], a[180:183], a[52:55], v[88:91]
buffer_load_dwordx4 v[172:175], v15, s[44:47], s65 offen offset:0 sc1
v_mfma_f32_16x16x32_bf16 v[88:91], a[176:179], a[48:51], v[88:91]
v_mfma_f32_16x16x32_bf16 v[56:59], a[176:179], a[40:43], v[56:59]
v_mfma_f32_16x16x32_bf16 v[56:59], a[180:183], a[44:47], v[56:59]
v_mfma_f32_16x16x32_bf16 v[24:27], a[180:183], a[36:39], v[24:27]
buffer_load_dwordx4 v[180:183], v15, s[44:47], s65 offen offset:1024 sc1
v_mfma_f32_16x16x32_bf16 v[24:27], a[176:179], a[32:35], v[24:27]
v_mfma_f32_16x16x32_bf16 v[28:31], a[184:187], a[32:35], v[28:31]
v_mfma_f32_16x16x32_bf16 v[28:31], a[188:191], a[36:39], v[28:31]
v_mfma_f32_16x16x32_bf16 v[60:63], a[188:191], a[44:47], v[60:63]
v_mfma_f32_16x16x32_bf16 v[60:63], a[184:187], a[40:43], v[60:63]
s_waitcnt vmcnt(25)
s_barrier
v_mfma_f32_16x16x32_bf16 v[92:95], a[184:187], a[48:51], v[92:95]
ds_read_b64_tr_b16 a[144:145], v188 offset:32768
v_mfma_f32_16x16x32_bf16 v[92:95], a[188:191], a[52:55], v[92:95]
ds_read_b64_tr_b16 a[146:147], v188 offset:36864
v_mfma_f32_16x16x32_bf16 v[124:127], a[188:191], a[60:63], v[124:127]
s_xor_b32 m0, s76, 65536
ds_read_b64_tr_b16 a[148:149], v188 offset:40960
v_mfma_f32_16x16x32_bf16 v[124:127], a[184:187], a[56:59], v[124:127]
s_xor_b32 s64, s85, 524288
ds_read_b64_tr_b16 a[150:151], v188 offset:45056
v_mfma_f32_16x16x32_bf16 v[128:131], a[192:195], a[56:59], v[128:131]
buffer_load_dwordx4 v12, s[40:43], s64 offen lds
v_mfma_f32_16x16x32_bf16 v[128:131], a[196:199], a[60:63], v[128:131]
s_xor_b32 m0, s76, 66560
ds_read_b64_tr_b16 a[152:153], v189 offset:32768
v_mfma_f32_16x16x32_bf16 v[96:99], a[196:199], a[52:55], v[96:99]
s_xor_b32 s64, s85, 532480
ds_read_b64_tr_b16 a[154:155], v189 offset:36864
v_mfma_f32_16x16x32_bf16 v[96:99], a[192:195], a[48:51], v[96:99]
buffer_load_dwordx4 v13, s[40:43], s64 offen lds
v_mfma_f32_16x16x32_bf16 v[64:67], a[192:195], a[40:43], v[64:67]
s_xor_b32 m0, s76, 67584
ds_read_b64_tr_b16 a[156:157], v189 offset:40960
v_mfma_f32_16x16x32_bf16 v[64:67], a[196:199], a[44:47], v[64:67]
s_xor_b32 s64, s85, 540672
ds_read_b64_tr_b16 a[158:159], v189 offset:45056
v_mfma_f32_16x16x32_bf16 v[32:35], a[196:199], a[36:39], v[32:35]
buffer_load_dwordx4 v12, s[40:43], s64 offen lds
v_mfma_f32_16x16x32_bf16 v[32:35], a[192:195], a[32:35], v[32:35]
s_waitcnt lgkmcnt(4)
s_xor_b32 m0, s76, 68608
ds_read_b64_tr_b16 a[160:161], v190 offset:32768
v_mfma_f32_16x16x32_bf16 v[36:39], a[200:203], a[32:35], v[36:39]
s_xor_b32 s64, s85, 548864
ds_read_b64_tr_b16 a[162:163], v190 offset:36864
v_mfma_f32_16x16x32_bf16 v[36:39], a[204:207], a[36:39], v[36:39]
buffer_load_dwordx4 v13, s[40:43], s64 offen lds
v_mfma_f32_16x16x32_bf16 v[68:71], a[204:207], a[44:47], v[68:71]
s_xor_b32 m0, s76, 69632
ds_read_b64_tr_b16 a[164:165], v190 offset:40960
v_mfma_f32_16x16x32_bf16 v[68:71], a[200:203], a[40:43], v[68:71]
s_xor_b32 s64, s85, 557056
ds_read_b64_tr_b16 a[166:167], v190 offset:45056
v_mfma_f32_16x16x32_bf16 v[100:103], a[200:203], a[48:51], v[100:103]
buffer_load_dwordx4 v12, s[40:43], s64 offen lds
v_mfma_f32_16x16x32_bf16 v[100:103], a[204:207], a[52:55], v[100:103]
s_mov_b32 s70, 3
s_mov_b32 s73, 2
v_mfma_f32_16x16x32_bf16 v[132:135], a[204:207], a[60:63], v[132:135]
v_mfma_f32_16x16x32_bf16 v[132:135], a[200:203], a[56:59], v[132:135]
s_branch L_p5join
.p2align 12
L_pg21:
s_branch L_pg25
L_p5join:
L_p5loop:
s_waitcnt lgkmcnt(10)
s_waitcnt vmcnt(19)
v_mfma_f32_16x16x32_bf16 v[136:139], a[144:147], a[232:235], v[136:139]
s_waitcnt vmcnt(15)
s_waitcnt lgkmcnt(8)
s_xor_b32 m0, s76, 70656
s_xor_b32 s64, s85, 565248
ds_read_b64_tr_b16 a[168:169], v191 offset:32768
v_mfma_f32_16x16x32_bf16 v[136:139], a[148:151], a[236:239], v[136:139]
buffer_load_dwordx4 v13, s[40:43], s64 offen lds
v_mfma_f32_16x16x32_bf16 v[104:107], a[148:151], a[228:231], v[104:107]
ds_read_b64_tr_b16 a[170:171], v191 offset:36864
v_mfma_f32_16x16x32_bf16 v[104:107], a[144:147], a[224:227], v[104:107]
s_xor_b32 m0, s76, 71680
ds_read_b64_tr_b16 a[172:173], v191 offset:40960
v_mfma_f32_16x16x32_bf16 v[72:75], a[144:147], a[216:219], v[72:75]
s_xor_b32 s64, s85, 573440
ds_read_b64_tr_b16 a[174:175], v191 offset:45056
v_mfma_f32_16x16x32_bf16 v[72:75], a[148:151], a[220:223], v[72:75]
buffer_load_dwordx4 v12, s[40:43], s64 offen lds
v_mfma_f32_16x16x32_bf16 v[40:43], a[148:151], a[212:215], v[40:43]
ds_read_b64_tr_b16 a[176:177], v184 offset:32768
v_mfma_f32_16x16x32_bf16 v[40:43], a[144:147], a[208:211], v[40:43]
s_waitcnt lgkmcnt(5)
s_xor_b32 m0, s76, 72704
ds_read_b64_tr_b16 a[178:179], v184 offset:36864
v_mfma_f32_16x16x32_bf16 v[44:47], a[152:155], a[208:211], v[44:47]
s_xor_b32 s64, s85, 581632
ds_read_b64_tr_b16 a[180:181], v184 offset:40960
v_mfma_f32_16x16x32_bf16 v[44:47], a[156:159], a[212:215], v[44:47]
buffer_load_dwordx4 v13, s[40:43], s64 offen lds
v_mfma_f32_16x16x32_bf16 v[76:79], a[156:159], a[220:223], v[76:79]
ds_read_b64_tr_b16 a[182:183], v184 offset:45056
v_mfma_f32_16x16x32_bf16 v[76:79], a[152:155], a[216:219], v[76:79]
ds_read_b64_tr_b16 a[184:185], v185 offset:32768
v_mfma_f32_16x16x32_bf16 v[108:111], a[152:155], a[224:227], v[108:111]
s_xor_b32 s65, s84, 65536
ds_read_b64_tr_b16 a[186:187], v185 offset:36864
v_mfma_f32_16x16x32_bf16 v[108:111], a[156:159], a[228:231], v[108:111]
buffer_load_dwordx4 a[0:3], v14, s[44:47], s65 offen offset:0 sc1
v_mfma_f32_16x16x32_bf16 v[140:143], a[156:159], a[236:239], v[140:143]
ds_read_b64_tr_b16 a[188:189], v185 offset:40960
v_mfma_f32_16x16x32_bf16 v[140:143], a[152:155], a[232:235], v[140:143]
ds_read_b64_tr_b16 a[190:191], v185 offset:45056
v_mfma_f32_16x16x32_bf16 v[144:147], a[160:163], a[232:235], v[144:147]
v_mfma_f32_16x16x32_bf16 v[144:147], a[164:167], a[236:239], v[144:147]
buffer_load_dwordx4 a[8:11], v14, s[44:47], s65 offen offset:1024 sc1
v_mfma_f32_16x16x32_bf16 v[112:115], a[164:167], a[228:231], v[112:115]
ds_read_b64_tr_b16 a[192:193], v186 offset:32768
v_mfma_f32_16x16x32_bf16 v[112:115], a[160:163], a[224:227], v[112:115]
ds_read_b64_tr_b16 a[194:195], v186 offset:36864
v_mfma_f32_16x16x32_bf16 v[80:83], a[160:163], a[216:219], v[80:83]
ds_read_b64_tr_b16 a[196:197], v186 offset:40960
v_mfma_f32_16x16x32_bf16 v[80:83], a[164:167], a[220:223], v[80:83]
buffer_load_dwordx4 a[16:19], v15, s[44:47], s65 offen offset:0 sc1
v_mfma_f32_16x16x32_bf16 v[48:51], a[164:167], a[212:215], v[48:51]
ds_read_b64_tr_b16 a[198:199], v186 offset:45056
v_mfma_f32_16x16x32_bf16 v[48:51], a[160:163], a[208:211], v[48:51]
s_waitcnt lgkmcnt(4)
v_mfma_f32_16x16x32_bf16 v[52:55], a[168:171], a[208:211], v[52:55]
v_mfma_f32_16x16x32_bf16 v[52:55], a[172:175], a[212:215], v[52:55]
buffer_load_dwordx4 a[24:27], v15, s[44:47], s65 offen offset:1024 sc1
v_mfma_f32_16x16x32_bf16 v[84:87], a[172:175], a[220:223], v[84:87]
ds_read_b64_tr_b16 a[200:201], v187 offset:32768
v_mfma_f32_16x16x32_bf16 v[84:87], a[168:171], a[216:219], v[84:87]
ds_read_b64_tr_b16 a[202:203], v187 offset:36864
v_mfma_f32_16x16x32_bf16 v[116:119], a[168:171], a[224:227], v[116:119]
s_xor_b32 s65, s84, 73728
ds_read_b64_tr_b16 a[204:205], v187 offset:40960
v_mfma_f32_16x16x32_bf16 v[116:119], a[172:175], a[228:231], v[116:119]
buffer_load_dwordx4 a[4:7], v14, s[44:47], s65 offen offset:0 sc1
v_mfma_f32_16x16x32_bf16 v[148:151], a[172:175], a[236:239], v[148:151]
ds_read_b64_tr_b16 a[206:207], v187 offset:45056
v_mfma_f32_16x16x32_bf16 v[148:151], a[168:171], a[232:235], v[148:151]
v_mfma_f32_16x16x32_bf16 v[120:123], a[176:179], a[232:235], v[120:123]
v_mfma_f32_16x16x32_bf16 v[120:123], a[180:183], a[236:239], v[120:123]
buffer_load_dwordx4 a[12:15], v14, s[44:47], s65 offen offset:1024 sc1
v_mfma_f32_16x16x32_bf16 v[88:91], a[180:183], a[228:231], v[88:91]
v_mfma_f32_16x16x32_bf16 v[88:91], a[176:179], a[224:227], v[88:91]
v_mfma_f32_16x16x32_bf16 v[56:59], a[176:179], a[216:219], v[56:59]
v_mfma_f32_16x16x32_bf16 v[56:59], a[180:183], a[220:223], v[56:59]
buffer_load_dwordx4 a[20:23], v15, s[44:47], s65 offen offset:0 sc1
v_mfma_f32_16x16x32_bf16 v[24:27], a[180:183], a[212:215], v[24:27]
v_mfma_f32_16x16x32_bf16 v[24:27], a[176:179], a[208:211], v[24:27]
v_mfma_f32_16x16x32_bf16 v[28:31], a[184:187], a[208:211], v[28:31]
v_mfma_f32_16x16x32_bf16 v[28:31], a[188:191], a[212:215], v[28:31]
buffer_load_dwordx4 a[28:31], v15, s[44:47], s65 offen offset:1024 sc1
v_mfma_f32_16x16x32_bf16 v[60:63], a[188:191], a[220:223], v[60:63]
v_mfma_f32_16x16x32_bf16 v[60:63], a[184:187], a[216:219], v[60:63]
s_waitcnt vmcnt(24)
s_barrier
v_mfma_f32_16x16x32_bf16 v[92:95], a[184:187], a[224:227], v[92:95]
s_xor_b32 m0, s76, 98304
ds_read_b64_tr_b16 a[144:145], v196 offset:0
v_mfma_f32_16x16x32_bf16 v[92:95], a[188:191], a[228:231], v[92:95]
s_xor_b32 s64, s85, 786432
ds_read_b64_tr_b16 a[146:147], v196 offset:4096
v_mfma_f32_16x16x32_bf16 v[124:127], a[188:191], a[236:239], v[124:127]
buffer_load_dwordx4 v12, s[40:43], s64 offen lds
v_mfma_f32_16x16x32_bf16 v[124:127], a[184:187], a[232:235], v[124:127]
s_waitcnt lgkmcnt(2)
s_xor_b32 m0, s76, 99328
ds_read_b64_tr_b16 a[148:149], v196 offset:8192
v_mfma_f32_16x16x32_bf16 v[128:131], a[192:195], a[232:235], v[128:131]
s_xor_b32 s64, s85, 794624
ds_read_b64_tr_b16 a[150:151], v196 offset:12288
v_mfma_f32_16x16x32_bf16 v[128:131], a[196:199], a[236:239], v[128:131]
buffer_load_dwordx4 v13, s[40:43], s64 offen lds
v_mfma_f32_16x16x32_bf16 v[96:99], a[196:199], a[228:231], v[96:99]
ds_read_b64_tr_b16 a[152:153], v197 offset:0
v_mfma_f32_16x16x32_bf16 v[96:99], a[192:195], a[224:227], v[96:99]
s_xor_b32 m0, s76, 100352
ds_read_b64_tr_b16 a[154:155], v197 offset:4096
v_mfma_f32_16x16x32_bf16 v[64:67], a[192:195], a[216:219], v[64:67]
s_xor_b32 s64, s85, 802816
ds_read_b64_tr_b16 a[156:157], v197 offset:8192
v_mfma_f32_16x16x32_bf16 v[64:67], a[196:199], a[220:223], v[64:67]
buffer_load_dwordx4 v12, s[40:43], s64 offen lds
v_mfma_f32_16x16x32_bf16 v[32:35], a[196:199], a[212:215], v[32:35]
ds_read_b64_tr_b16 a[158:159], v197 offset:12288
v_mfma_f32_16x16x32_bf16 v[32:35], a[192:195], a[208:211], v[32:35]
s_xor_b32 m0, s76, 101376
ds_read_b64_tr_b16 a[160:161], v198 offset:0
v_mfma_f32_16x16x32_bf16 v[36:39], a[200:203], a[208:211], v[36:39]
s_xor_b32 s64, s85, 811008
ds_read_b64_tr_b16 a[162:163], v198 offset:4096
v_mfma_f32_16x16x32_bf16 v[36:39], a[204:207], a[212:215], v[36:39]
buffer_load_dwordx4 v13, s[40:43], s64 offen lds
v_mfma_f32_16x16x32_bf16 v[68:71], a[204:207], a[220:223], v[68:71]
ds_read_b64_tr_b16 a[164:165], v198 offset:8192
v_mfma_f32_16x16x32_bf16 v[68:71], a[200:203], a[216:219], v[68:71]
s_xor_b32 m0, s76, 102400
ds_read_b64_tr_b16 a[166:167], v198 offset:12288
v_mfma_f32_16x16x32_bf16 v[100:103], a[200:203], a[224:227], v[100:103]
s_xor_b32 s64, s85, 819200
v_mfma_f32_16x16x32_bf16 v[100:103], a[204:207], a[228:231], v[100:103]
buffer_load_dwordx4 v12, s[40:43], s64 offen lds
v_mfma_f32_16x16x32_bf16 v[132:135], a[204:207], a[236:239], v[132:135]
v_mfma_f32_16x16x32_bf16 v[132:135], a[200:203], a[232:235], v[132:135]
s_waitcnt vmcnt(25)
s_waitcnt lgkmcnt(3)
s_xor_b32 m0, s76, 103424
buffer_load_dword v19, off, s[52:55], s72 offset:128 sc1
v_mfma_f32_16x16x32_bf16 v[136:139], a[144:147], v[176:179], v[136:139]
s_waitcnt vmcnt(22)
s_xor_b32 s64, s85, 827392
ds_read_b64_tr_b16 a[168:169], v199 offset:0
v_mfma_f32_16x16x32_bf16 v[136:139], a[148:151], v[180:183], v[136:139]
buffer_load_dwordx4 v13, s[40:43], s64 offen lds
v_mfma_f32_16x16x32_bf16 v[104:107], a[148:151], v[172:175], v[104:107]
ds_read_b64_tr_b16 a[170:171], v199 offset:4096
v_mfma_f32_16x16x32_bf16 v[104:107], a[144:147], v[168:171], v[104:107]
s_xor_b32 m0, s76, 104448
ds_read_b64_tr_b16 a[172:173], v199 offset:8192
v_mfma_f32_16x16x32_bf16 v[72:75], a[144:147], v[160:163], v[72:75]
s_xor_b32 s64, s85, 835584
ds_read_b64_tr_b16 a[174:175], v199 offset:12288
v_mfma_f32_16x16x32_bf16 v[72:75], a[148:151], v[164:167], v[72:75]
buffer_load_dwordx4 v12, s[40:43], s64 offen lds
v_mfma_f32_16x16x32_bf16 v[40:43], a[148:151], v[156:159], v[40:43]
ds_read_b64_tr_b16 a[176:177], v192 offset:0
v_mfma_f32_16x16x32_bf16 v[40:43], a[144:147], v[152:155], v[40:43]
s_xor_b32 m0, s76, 105472
ds_read_b64_tr_b16 a[178:179], v192 offset:4096
v_mfma_f32_16x16x32_bf16 v[44:47], a[152:155], v[152:155], v[44:47]
s_xor_b32 s64, s85, 843776
ds_read_b64_tr_b16 a[180:181], v192 offset:8192
v_mfma_f32_16x16x32_bf16 v[44:47], a[156:159], v[156:159], v[44:47]
buffer_load_dwordx4 v13, s[40:43], s64 offen lds
v_mfma_f32_16x16x32_bf16 v[76:79], a[156:159], v[164:167], v[76:79]
ds_read_b64_tr_b16 a[182:183], v192 offset:12288
v_mfma_f32_16x16x32_bf16 v[76:79], a[152:155], v[160:163], v[76:79]
ds_read_b64_tr_b16 a[184:185], v193 offset:0
v_mfma_f32_16x16x32_bf16 v[108:111], a[152:155], v[168:171], v[108:111]
s_xor_b32 s65, s84, 98304
ds_read_b64_tr_b16 a[186:187], v193 offset:4096
v_mfma_f32_16x16x32_bf16 v[108:111], a[156:159], v[172:175], v[108:111]
buffer_load_dwordx4 a[32:35], v14, s[44:47], s65 offen offset:0 sc1
v_mfma_f32_16x16x32_bf16 v[140:143], a[156:159], v[180:183], v[140:143]
ds_read_b64_tr_b16 a[188:189], v193 offset:8192
v_mfma_f32_16x16x32_bf16 v[140:143], a[152:155], v[176:179], v[140:143]
s_waitcnt lgkmcnt(5)
ds_read_b64_tr_b16 a[190:191], v193 offset:12288
v_mfma_f32_16x16x32_bf16 v[144:147], a[160:163], v[176:179], v[144:147]
s_lshl_b32 s75, s73, 20
s_add_u32 s85, s85, s75
s_lshr_b32 s74, s73, 28
v_mfma_f32_16x16x32_bf16 v[144:147], a[164:167], v[180:183], v[144:147]
s_and_b32 s74, s74, 8
buffer_load_dwordx4 a[40:43], v14, s[44:47], s65 offen offset:1024 sc1
v_mfma_f32_16x16x32_bf16 v[112:115], a[164:167], v[172:175], v[112:115]
ds_read_b64_tr_b16 a[192:193], v194 offset:0
v_mfma_f32_16x16x32_bf16 v[112:115], a[160:163], v[168:171], v[112:115]
ds_read_b64_tr_b16 a[194:195], v194 offset:4096
v_mfma_f32_16x16x32_bf16 v[80:83], a[160:163], v[160:163], v[80:83]
ds_read_b64_tr_b16 a[196:197], v194 offset:8192
v_mfma_f32_16x16x32_bf16 v[80:83], a[164:167], v[164:167], v[80:83]
buffer_load_dwordx4 a[48:51], v15, s[44:47], s65 offen offset:0 sc1
v_mfma_f32_16x16x32_bf16 v[48:51], a[164:167], v[156:159], v[48:51]
ds_read_b64_tr_b16 a[198:199], v194 offset:12288
v_mfma_f32_16x16x32_bf16 v[48:51], a[160:163], v[152:155], v[48:51]
v_mfma_f32_16x16x32_bf16 v[52:55], a[168:171], v[152:155], v[52:55]
v_mfma_f32_16x16x32_bf16 v[52:55], a[172:175], v[156:159], v[52:55]
buffer_load_dwordx4 a[56:59], v15, s[44:47], s65 offen offset:1024 sc1
v_mfma_f32_16x16x32_bf16 v[84:87], a[172:175], v[164:167], v[84:87]
ds_read_b64_tr_b16 a[200:201], v195 offset:0
v_mfma_f32_16x16x32_bf16 v[84:87], a[168:171], v[160:163], v[84:87]
ds_read_b64_tr_b16 a[202:203], v195 offset:4096
v_mfma_f32_16x16x32_bf16 v[116:119], a[168:171], v[168:171], v[116:119]
s_xor_b32 s65, s84, 106496
ds_read_b64_tr_b16 a[204:205], v195 offset:8192
v_mfma_f32_16x16x32_bf16 v[116:119], a[172:175], v[172:175], v[116:119]
buffer_load_dwordx4 a[36:39], v14, s[44:47], s65 offen offset:0 sc1
v_mfma_f32_16x16x32_bf16 v[148:151], a[172:175], v[180:183], v[148:151]
ds_read_b64_tr_b16 a[206:207], v195 offset:12288
v_mfma_f32_16x16x32_bf16 v[148:151], a[168:171], v[176:179], v[148:151]
v_mfma_f32_16x16x32_bf16 v[120:123], a[176:179], v[176:179], v[120:123]
s_waitcnt lgkmcnt(4)
v_mfma_f32_16x16x32_bf16 v[120:123], a[180:183], v[180:183], v[120:123]
buffer_load_dwordx4 a[44:47], v14, s[44:47], s65 offen offset:1024 sc1
v_mfma_f32_16x16x32_bf16 v[88:91], a[180:183], v[172:175], v[88:91]
v_mfma_f32_16x16x32_bf16 v[88:91], a[176:179], v[168:171], v[88:91]
v_mfma_f32_16x16x32_bf16 v[56:59], a[176:179], v[160:163], v[56:59]
v_mfma_f32_16x16x32_bf16 v[56:59], a[180:183], v[164:167], v[56:59]
buffer_load_dwordx4 a[52:55], v15, s[44:47], s65 offen offset:0 sc1
v_mfma_f32_16x16x32_bf16 v[24:27], a[180:183], v[156:159], v[24:27]
v_mfma_f32_16x16x32_bf16 v[24:27], a[176:179], v[152:155], v[24:27]
v_mfma_f32_16x16x32_bf16 v[28:31], a[184:187], v[152:155], v[28:31]
v_mfma_f32_16x16x32_bf16 v[28:31], a[188:191], v[156:159], v[28:31]
buffer_load_dwordx4 a[60:63], v15, s[44:47], s65 offen offset:1024 sc1
v_mfma_f32_16x16x32_bf16 v[60:63], a[188:191], v[164:167], v[60:63]
v_mfma_f32_16x16x32_bf16 v[60:63], a[184:187], v[160:163], v[60:63]
s_waitcnt vmcnt(25)
s_barrier
v_mfma_f32_16x16x32_bf16 v[92:95], a[184:187], v[168:171], v[92:95]
s_lshl_b32 s75, s73, 17
s_add_u32 s84, s84, s75
s_xor_b32 m0, s76, 131072
ds_read_b64_tr_b16 a[144:145], v196 offset:32768
v_mfma_f32_16x16x32_bf16 v[92:95], a[188:191], v[172:175], v[92:95]
s_xor_b32 s64, s85, 0
ds_read_b64_tr_b16 a[146:147], v196 offset:36864
v_mfma_f32_16x16x32_bf16 v[124:127], a[188:191], v[180:183], v[124:127]
buffer_load_dwordx4 v12, s[40:43], s64 offen lds
v_mfma_f32_16x16x32_bf16 v[124:127], a[184:187], v[176:179], v[124:127]
s_xor_b32 m0, s76, 132096
ds_read_b64_tr_b16 a[148:149], v196 offset:40960
v_mfma_f32_16x16x32_bf16 v[128:131], a[192:195], v[176:179], v[128:131]
s_xor_b32 s64, s85, 8192
ds_read_b64_tr_b16 a[150:151], v196 offset:45056
v_mfma_f32_16x16x32_bf16 v[128:131], a[196:199], v[180:183], v[128:131]
buffer_load_dwordx4 v13, s[40:43], s64 offen lds
v_mfma_f32_16x16x32_bf16 v[96:99], a[196:199], v[172:175], v[96:99]
ds_read_b64_tr_b16 a[152:153], v197 offset:32768
v_mfma_f32_16x16x32_bf16 v[96:99], a[192:195], v[168:171], v[96:99]
s_xor_b32 m0, s76, 133120
ds_read_b64_tr_b16 a[154:155], v197 offset:36864
v_mfma_f32_16x16x32_bf16 v[64:67], a[192:195], v[160:163], v[64:67]
s_xor_b32 s64, s85, 16384
ds_read_b64_tr_b16 a[156:157], v197 offset:40960
v_mfma_f32_16x16x32_bf16 v[64:67], a[196:199], v[164:167], v[64:67]
buffer_load_dwordx4 v12, s[40:43], s64 offen lds
v_mfma_f32_16x16x32_bf16 v[32:35], a[196:199], v[156:159], v[32:35]
ds_read_b64_tr_b16 a[158:159], v197 offset:45056
v_mfma_f32_16x16x32_bf16 v[32:35], a[192:195], v[152:155], v[32:35]
s_waitcnt lgkmcnt(5)
s_xor_b32 m0, s76, 134144
ds_read_b64_tr_b16 a[160:161], v198 offset:32768
v_mfma_f32_16x16x32_bf16 v[36:39], a[200:203], v[152:155], v[36:39]
s_xor_b32 s64, s85, 24576
ds_read_b64_tr_b16 a[162:163], v198 offset:36864
v_mfma_f32_16x16x32_bf16 v[36:39], a[204:207], v[156:159], v[36:39]
buffer_load_dwordx4 v13, s[40:43], s64 offen lds
v_mfma_f32_16x16x32_bf16 v[68:71], a[204:207], v[164:167], v[68:71]
ds_read_b64_tr_b16 a[164:165], v198 offset:40960
v_mfma_f32_16x16x32_bf16 v[68:71], a[200:203], v[160:163], v[68:71]
s_xor_b32 m0, s76, 135168
ds_read_b64_tr_b16 a[166:167], v198 offset:45056
v_mfma_f32_16x16x32_bf16 v[100:103], a[200:203], v[168:171], v[100:103]
s_xor_b32 s64, s85, 32768
v_mfma_f32_16x16x32_bf16 v[100:103], a[204:207], v[172:175], v[100:103]
buffer_load_dwordx4 v12, s[40:43], s64 offen lds
v_mfma_f32_16x16x32_bf16 v[132:135], a[204:207], v[180:183], v[132:135]
v_mfma_f32_16x16x32_bf16 v[132:135], a[200:203], v[176:179], v[132:135]
s_waitcnt vmcnt(26)
v_mfma_f32_16x16x32_bf16 v[136:139], a[144:147], a[24:27], v[136:139]
s_waitcnt vmcnt(16)
v_readfirstlane_b32 vcc_lo, v19
s_nop 0
s_cmp_lt_u32 vcc_lo, s74
s_cbranch_scc1 L_spin_4022
L_spinbk_4023:
s_waitcnt lgkmcnt(2)
v_mfma_f32_16x16x32_bf16 v[136:139], a[148:151], a[28:31], v[136:139]
s_xor_b32 m0, s76, 136192
ds_read_b64_tr_b16 a[168:169], v199 offset:32768
v_mfma_f32_16x16x32_bf16 v[104:107], a[148:151], a[20:23], v[104:107]
s_xor_b32 s64, s85, 40960
ds_read_b64_tr_b16 a[170:171], v199 offset:36864
v_mfma_f32_16x16x32_bf16 v[104:107], a[144:147], a[16:19], v[104:107]
buffer_load_dwordx4 v13, s[40:43], s64 offen lds
v_mfma_f32_16x16x32_bf16 v[72:75], a[144:147], a[8:11], v[72:75]
s_xor_b32 m0, s76, 137216
ds_read_b64_tr_b16 a[172:173], v199 offset:40960
v_mfma_f32_16x16x32_bf16 v[72:75], a[148:151], a[12:15], v[72:75]
s_xor_b32 s64, s85, 49152
ds_read_b64_tr_b16 a[174:175], v199 offset:45056
v_mfma_f32_16x16x32_bf16 v[40:43], a[148:151], a[4:7], v[40:43]
buffer_load_dwordx4 v12, s[40:43], s64 offen lds
v_mfma_f32_16x16x32_bf16 v[40:43], a[144:147], a[0:3], v[40:43]
ds_read_b64_tr_b16 a[176:177], v192 offset:32768
v_mfma_f32_16x16x32_bf16 v[44:47], a[152:155], a[0:3], v[44:47]
s_xor_b32 m0, s76, 138240
ds_read_b64_tr_b16 a[178:179], v192 offset:36864
v_mfma_f32_16x16x32_bf16 v[44:47], a[156:159], a[4:7], v[44:47]
s_xor_b32 s64, s85, 57344
ds_read_b64_tr_b16 a[180:181], v192 offset:40960
v_mfma_f32_16x16x32_bf16 v[76:79], a[156:159], a[12:15], v[76:79]
buffer_load_dwordx4 v13, s[40:43], s64 offen lds
v_mfma_f32_16x16x32_bf16 v[76:79], a[152:155], a[8:11], v[76:79]
ds_read_b64_tr_b16 a[182:183], v192 offset:45056
v_mfma_f32_16x16x32_bf16 v[108:111], a[152:155], a[16:19], v[108:111]
ds_read_b64_tr_b16 a[184:185], v193 offset:32768
v_mfma_f32_16x16x32_bf16 v[108:111], a[156:159], a[20:23], v[108:111]
s_xor_b32 s65, s84, 0
ds_read_b64_tr_b16 a[186:187], v193 offset:36864
v_mfma_f32_16x16x32_bf16 v[140:143], a[156:159], a[28:31], v[140:143]
buffer_load_dwordx4 a[208:211], v14, s[44:47], s65 offen offset:0 sc1
v_mfma_f32_16x16x32_bf16 v[140:143], a[152:155], a[24:27], v[140:143]
ds_read_b64_tr_b16 a[188:189], v193 offset:40960
v_mfma_f32_16x16x32_bf16 v[144:147], a[160:163], a[24:27], v[144:147]
s_waitcnt lgkmcnt(5)
ds_read_b64_tr_b16 a[190:191], v193 offset:45056
v_mfma_f32_16x16x32_bf16 v[144:147], a[164:167], a[28:31], v[144:147]
v_mfma_f32_16x16x32_bf16 v[112:115], a[164:167], a[20:23], v[112:115]
buffer_load_dwordx4 a[216:219], v14, s[44:47], s65 offen offset:1024 sc1
v_mfma_f32_16x16x32_bf16 v[112:115], a[160:163], a[16:19], v[112:115]
ds_read_b64_tr_b16 a[192:193], v194 offset:32768
v_mfma_f32_16x16x32_bf16 v[80:83], a[160:163], a[8:11], v[80:83]
ds_read_b64_tr_b16 a[194:195], v194 offset:36864
v_mfma_f32_16x16x32_bf16 v[80:83], a[164:167], a[12:15], v[80:83]
ds_read_b64_tr_b16 a[196:197], v194 offset:40960
v_mfma_f32_16x16x32_bf16 v[48:51], a[164:167], a[4:7], v[48:51]
buffer_load_dwordx4 a[224:227], v15, s[44:47], s65 offen offset:0 sc1
v_mfma_f32_16x16x32_bf16 v[48:51], a[160:163], a[0:3], v[48:51]
ds_read_b64_tr_b16 a[198:199], v194 offset:45056
v_mfma_f32_16x16x32_bf16 v[52:55], a[168:171], a[0:3], v[52:55]
v_mfma_f32_16x16x32_bf16 v[52:55], a[172:175], a[4:7], v[52:55]
buffer_load_dwordx4 a[232:235], v15, s[44:47], s65 offen offset:1024 sc1
v_mfma_f32_16x16x32_bf16 v[84:87], a[172:175], a[12:15], v[84:87]
ds_read_b64_tr_b16 a[200:201], v195 offset:32768
v_mfma_f32_16x16x32_bf16 v[84:87], a[168:171], a[8:11], v[84:87]
ds_read_b64_tr_b16 a[202:203], v195 offset:36864
v_mfma_f32_16x16x32_bf16 v[116:119], a[168:171], a[16:19], v[116:119]
s_xor_b32 s65, s84, 8192
ds_read_b64_tr_b16 a[204:205], v195 offset:40960
v_mfma_f32_16x16x32_bf16 v[116:119], a[172:175], a[20:23], v[116:119]
buffer_load_dwordx4 a[212:215], v14, s[44:47], s65 offen offset:0 sc1
v_mfma_f32_16x16x32_bf16 v[148:151], a[172:175], a[28:31], v[148:151]
ds_read_b64_tr_b16 a[206:207], v195 offset:45056
v_mfma_f32_16x16x32_bf16 v[148:151], a[168:171], a[24:27], v[148:151]
v_mfma_f32_16x16x32_bf16 v[120:123], a[176:179], a[24:27], v[120:123]
s_waitcnt lgkmcnt(4)
v_mfma_f32_16x16x32_bf16 v[120:123], a[180:183], a[28:31], v[120:123]
buffer_load_dwordx4 a[220:223], v14, s[44:47], s65 offen offset:1024 sc1
v_mfma_f32_16x16x32_bf16 v[88:91], a[180:183], a[20:23], v[88:91]
v_mfma_f32_16x16x32_bf16 v[88:91], a[176:179], a[16:19], v[88:91]
v_mfma_f32_16x16x32_bf16 v[56:59], a[176:179], a[8:11], v[56:59]
v_mfma_f32_16x16x32_bf16 v[56:59], a[180:183], a[12:15], v[56:59]
buffer_load_dwordx4 a[228:231], v15, s[44:47], s65 offen offset:0 sc1
v_mfma_f32_16x16x32_bf16 v[24:27], a[180:183], a[4:7], v[24:27]
v_mfma_f32_16x16x32_bf16 v[24:27], a[176:179], a[0:3], v[24:27]
v_mfma_f32_16x16x32_bf16 v[28:31], a[184:187], a[0:3], v[28:31]
v_mfma_f32_16x16x32_bf16 v[28:31], a[188:191], a[4:7], v[28:31]
buffer_load_dwordx4 a[236:239], v15, s[44:47], s65 offen offset:1024 sc1
v_mfma_f32_16x16x32_bf16 v[60:63], a[188:191], a[12:15], v[60:63]
v_mfma_f32_16x16x32_bf16 v[60:63], a[184:187], a[8:11], v[60:63]
s_waitcnt vmcnt(24)
s_barrier
v_mfma_f32_16x16x32_bf16 v[92:95], a[184:187], a[16:19], v[92:95]
s_xor_b32 m0, s76, 32768
ds_read_b64_tr_b16 a[144:145], v188 offset:0
v_mfma_f32_16x16x32_bf16 v[92:95], a[188:191], a[20:23], v[92:95]
s_xor_b32 s64, s85, 262144
ds_read_b64_tr_b16 a[146:147], v188 offset:4096
v_mfma_f32_16x16x32_bf16 v[124:127], a[188:191], a[28:31], v[124:127]
buffer_load_dwordx4 v12, s[40:43], s64 offen lds
v_mfma_f32_16x16x32_bf16 v[124:127], a[184:187], a[24:27], v[124:127]
s_xor_b32 m0, s76, 33792
ds_read_b64_tr_b16 a[148:149], v188 offset:8192
v_mfma_f32_16x16x32_bf16 v[128:131], a[192:195], a[24:27], v[128:131]
s_xor_b32 s64, s85, 270336
ds_read_b64_tr_b16 a[150:151], v188 offset:12288
v_mfma_f32_16x16x32_bf16 v[128:131], a[196:199], a[28:31], v[128:131]
buffer_load_dwordx4 v13, s[40:43], s64 offen lds
v_mfma_f32_16x16x32_bf16 v[96:99], a[196:199], a[20:23], v[96:99]
ds_read_b64_tr_b16 a[152:153], v189 offset:0
v_mfma_f32_16x16x32_bf16 v[96:99], a[192:195], a[16:19], v[96:99]
s_xor_b32 m0, s76, 34816
ds_read_b64_tr_b16 a[154:155], v189 offset:4096
v_mfma_f32_16x16x32_bf16 v[64:67], a[192:195], a[8:11], v[64:67]
s_xor_b32 s64, s85, 278528
ds_read_b64_tr_b16 a[156:157], v189 offset:8192
v_mfma_f32_16x16x32_bf16 v[64:67], a[196:199], a[12:15], v[64:67]
buffer_load_dwordx4 v12, s[40:43], s64 offen lds
v_mfma_f32_16x16x32_bf16 v[32:35], a[196:199], a[4:7], v[32:35]
ds_read_b64_tr_b16 a[158:159], v189 offset:12288
v_mfma_f32_16x16x32_bf16 v[32:35], a[192:195], a[0:3], v[32:35]
s_waitcnt lgkmcnt(5)
s_xor_b32 m0, s76, 35840
ds_read_b64_tr_b16 a[160:161], v190 offset:0
v_mfma_f32_16x16x32_bf16 v[36:39], a[200:203], a[0:3], v[36:39]
s_xor_b32 s64, s85, 286720
ds_read_b64_tr_b16 a[162:163], v190 offset:4096
v_mfma_f32_16x16x32_bf16 v[36:39], a[204:207], a[4:7], v[36:39]
buffer_load_dwordx4 v13, s[40:43], s64 offen lds
v_mfma_f32_16x16x32_bf16 v[68:71], a[204:207], a[12:15], v[68:71]
ds_read_b64_tr_b16 a[164:165], v190 offset:8192
v_mfma_f32_16x16x32_bf16 v[68:71], a[200:203], a[8:11], v[68:71]
s_xor_b32 m0, s76, 36864
ds_read_b64_tr_b16 a[166:167], v190 offset:12288
v_mfma_f32_16x16x32_bf16 v[100:103], a[200:203], a[16:19], v[100:103]
s_xor_b32 s64, s85, 294912
v_mfma_f32_16x16x32_bf16 v[100:103], a[204:207], a[20:23], v[100:103]
buffer_load_dwordx4 v12, s[40:43], s64 offen lds
v_mfma_f32_16x16x32_bf16 v[132:135], a[204:207], a[28:31], v[132:135]
v_mfma_f32_16x16x32_bf16 v[132:135], a[200:203], a[24:27], v[132:135]
s_waitcnt vmcnt(25)
s_xor_b32 m0, s76, 37888
v_mfma_f32_16x16x32_bf16 v[136:139], a[144:147], a[56:59], v[136:139]
s_waitcnt vmcnt(21)
s_waitcnt lgkmcnt(2)
s_xor_b32 s64, s85, 303104
ds_read_b64_tr_b16 a[168:169], v191 offset:0
v_mfma_f32_16x16x32_bf16 v[136:139], a[148:151], a[60:63], v[136:139]
buffer_load_dwordx4 v13, s[40:43], s64 offen lds
v_mfma_f32_16x16x32_bf16 v[104:107], a[148:151], a[52:55], v[104:107]
ds_read_b64_tr_b16 a[170:171], v191 offset:4096
v_mfma_f32_16x16x32_bf16 v[104:107], a[144:147], a[48:51], v[104:107]
s_xor_b32 m0, s76, 38912
ds_read_b64_tr_b16 a[172:173], v191 offset:8192
v_mfma_f32_16x16x32_bf16 v[72:75], a[144:147], a[40:43], v[72:75]
s_xor_b32 s64, s85, 311296
ds_read_b64_tr_b16 a[174:175], v191 offset:12288
v_mfma_f32_16x16x32_bf16 v[72:75], a[148:151], a[44:47], v[72:75]
buffer_load_dwordx4 v12, s[40:43], s64 offen lds
v_mfma_f32_16x16x32_bf16 v[40:43], a[148:151], a[36:39], v[40:43]
ds_read_b64_tr_b16 a[176:177], v184 offset:0
v_mfma_f32_16x16x32_bf16 v[40:43], a[144:147], a[32:35], v[40:43]
s_xor_b32 m0, s76, 39936
ds_read_b64_tr_b16 a[178:179], v184 offset:4096
v_mfma_f32_16x16x32_bf16 v[44:47], a[152:155], a[32:35], v[44:47]
s_xor_b32 s64, s85, 319488
ds_read_b64_tr_b16 a[180:181], v184 offset:8192
v_mfma_f32_16x16x32_bf16 v[44:47], a[156:159], a[36:39], v[44:47]
buffer_load_dwordx4 v13, s[40:43], s64 offen lds
v_mfma_f32_16x16x32_bf16 v[76:79], a[156:159], a[44:47], v[76:79]
ds_read_b64_tr_b16 a[182:183], v184 offset:12288
v_mfma_f32_16x16x32_bf16 v[76:79], a[152:155], a[40:43], v[76:79]
ds_read_b64_tr_b16 a[184:185], v185 offset:0
v_mfma_f32_16x16x32_bf16 v[108:111], a[152:155], a[48:51], v[108:111]
s_xor_b32 s65, s84, 32768
ds_read_b64_tr_b16 a[186:187], v185 offset:4096
v_mfma_f32_16x16x32_bf16 v[108:111], a[156:159], a[52:55], v[108:111]
buffer_load_dwordx4 v[152:155], v14, s[44:47], s65 offen offset:0 sc1
v_mfma_f32_16x16x32_bf16 v[140:143], a[156:159], a[60:63], v[140:143]
ds_read_b64_tr_b16 a[188:189], v185 offset:8192
v_mfma_f32_16x16x32_bf16 v[140:143], a[152:155], a[56:59], v[140:143]
ds_read_b64_tr_b16 a[190:191], v185 offset:12288
v_mfma_f32_16x16x32_bf16 v[144:147], a[160:163], a[56:59], v[144:147]
s_waitcnt lgkmcnt(5)
v_mfma_f32_16x16x32_bf16 v[144:147], a[164:167], a[60:63], v[144:147]
buffer_load_dwordx4 v[160:163], v14, s[44:47], s65 offen offset:1024 sc1
v_mfma_f32_16x16x32_bf16 v[112:115], a[164:167], a[52:55], v[112:115]
ds_read_b64_tr_b16 a[192:193], v186 offset:0
v_mfma_f32_16x16x32_bf16 v[112:115], a[160:163], a[48:51], v[112:115]
ds_read_b64_tr_b16 a[194:195], v186 offset:4096
v_mfma_f32_16x16x32_bf16 v[80:83], a[160:163], a[40:43], v[80:83]
ds_read_b64_tr_b16 a[196:197], v186 offset:8192
v_mfma_f32_16x16x32_bf16 v[80:83], a[164:167], a[44:47], v[80:83]
buffer_load_dwordx4 v[168:171], v15, s[44:47], s65 offen offset:0 sc1
v_mfma_f32_16x16x32_bf16 v[48:51], a[164:167], a[36:39], v[48:51]
ds_read_b64_tr_b16 a[198:199], v186 offset:12288
v_mfma_f32_16x16x32_bf16 v[48:51], a[160:163], a[32:35], v[48:51]
v_mfma_f32_16x16x32_bf16 v[52:55], a[168:171], a[32:35], v[52:55]
v_mfma_f32_16x16x32_bf16 v[52:55], a[172:175], a[36:39], v[52:55]
buffer_load_dwordx4 v[176:179], v15, s[44:47], s65 offen offset:1024 sc1
v_mfma_f32_16x16x32_bf16 v[84:87], a[172:175], a[44:47], v[84:87]
ds_read_b64_tr_b16 a[200:201], v187 offset:0
v_mfma_f32_16x16x32_bf16 v[84:87], a[168:171], a[40:43], v[84:87]
ds_read_b64_tr_b16 a[202:203], v187 offset:4096
v_mfma_f32_16x16x32_bf16 v[116:119], a[168:171], a[48:51], v[116:119]
s_xor_b32 s65, s84, 40960
ds_read_b64_tr_b16 a[204:205], v187 offset:8192
v_mfma_f32_16x16x32_bf16 v[116:119], a[172:175], a[52:55], v[116:119]
buffer_load_dwordx4 v[156:159], v14, s[44:47], s65 offen offset:0 sc1
v_mfma_f32_16x16x32_bf16 v[148:151], a[172:175], a[60:63], v[148:151]
ds_read_b64_tr_b16 a[206:207], v187 offset:12288
v_mfma_f32_16x16x32_bf16 v[148:151], a[168:171], a[56:59], v[148:151]
v_mfma_f32_16x16x32_bf16 v[120:123], a[176:179], a[56:59], v[120:123]
s_waitcnt lgkmcnt(4)
v_mfma_f32_16x16x32_bf16 v[120:123], a[180:183], a[60:63], v[120:123]
buffer_load_dwordx4 v[164:167], v14, s[44:47], s65 offen offset:1024 sc1
v_mfma_f32_16x16x32_bf16 v[88:91], a[180:183], a[52:55], v[88:91]
v_mfma_f32_16x16x32_bf16 v[88:91], a[176:179], a[48:51], v[88:91]
v_mfma_f32_16x16x32_bf16 v[56:59], a[176:179], a[40:43], v[56:59]
v_mfma_f32_16x16x32_bf16 v[56:59], a[180:183], a[44:47], v[56:59]
buffer_load_dwordx4 v[172:175], v15, s[44:47], s65 offen offset:0 sc1
v_mfma_f32_16x16x32_bf16 v[24:27], a[180:183], a[36:39], v[24:27]
v_mfma_f32_16x16x32_bf16 v[24:27], a[176:179], a[32:35], v[24:27]
v_mfma_f32_16x16x32_bf16 v[28:31], a[184:187], a[32:35], v[28:31]
v_mfma_f32_16x16x32_bf16 v[28:31], a[188:191], a[36:39], v[28:31]
buffer_load_dwordx4 v[180:183], v15, s[44:47], s65 offen offset:1024 sc1
v_mfma_f32_16x16x32_bf16 v[60:63], a[188:191], a[44:47], v[60:63]
v_mfma_f32_16x16x32_bf16 v[60:63], a[184:187], a[40:43], v[60:63]
s_waitcnt vmcnt(24)
s_barrier
v_mfma_f32_16x16x32_bf16 v[92:95], a[184:187], a[48:51], v[92:95]
s_xor_b32 m0, s76, 65536
ds_read_b64_tr_b16 a[144:145], v188 offset:32768
v_mfma_f32_16x16x32_bf16 v[92:95], a[188:191], a[52:55], v[92:95]
s_xor_b32 s64, s85, 524288
ds_read_b64_tr_b16 a[146:147], v188 offset:36864
v_mfma_f32_16x16x32_bf16 v[124:127], a[188:191], a[60:63], v[124:127]
buffer_load_dwordx4 v12, s[40:43], s64 offen lds
v_mfma_f32_16x16x32_bf16 v[124:127], a[184:187], a[56:59], v[124:127]
s_xor_b32 m0, s76, 66560
ds_read_b64_tr_b16 a[148:149], v188 offset:40960
v_mfma_f32_16x16x32_bf16 v[128:131], a[192:195], a[56:59], v[128:131]
s_xor_b32 s64, s85, 532480
ds_read_b64_tr_b16 a[150:151], v188 offset:45056
v_mfma_f32_16x16x32_bf16 v[128:131], a[196:199], a[60:63], v[128:131]
buffer_load_dwordx4 v13, s[40:43], s64 offen lds
v_mfma_f32_16x16x32_bf16 v[96:99], a[196:199], a[52:55], v[96:99]
ds_read_b64_tr_b16 a[152:153], v189 offset:32768
v_mfma_f32_16x16x32_bf16 v[96:99], a[192:195], a[48:51], v[96:99]
s_branch L_po22
L_pg22:
s_branch L_tr2
L_po22:
s_xor_b32 m0, s76, 67584
ds_read_b64_tr_b16 a[154:155], v189 offset:36864
v_mfma_f32_16x16x32_bf16 v[64:67], a[192:195], a[40:43], v[64:67]
s_xor_b32 s64, s85, 540672
ds_read_b64_tr_b16 a[156:157], v189 offset:40960
v_mfma_f32_16x16x32_bf16 v[64:67], a[196:199], a[44:47], v[64:67]
buffer_load_dwordx4 v12, s[40:43], s64 offen lds
v_mfma_f32_16x16x32_bf16 v[32:35], a[196:199], a[36:39], v[32:35]
ds_read_b64_tr_b16 a[158:159], v189 offset:45056
v_mfma_f32_16x16x32_bf16 v[32:35], a[192:195], a[32:35], v[32:35]
s_waitcnt lgkmcnt(5)
s_xor_b32 m0, s76, 68608
ds_read_b64_tr_b16 a[160:161], v190 offset:32768
v_mfma_f32_16x16x32_bf16 v[36:39], a[200:203], a[32:35], v[36:39]
s_xor_b32 s64, s85, 548864
ds_read_b64_tr_b16 a[162:163], v190 offset:36864
v_mfma_f32_16x16x32_bf16 v[36:39], a[204:207], a[36:39], v[36:39]
buffer_load_dwordx4 v13, s[40:43], s64 offen lds
v_mfma_f32_16x16x32_bf16 v[68:71], a[204:207], a[44:47], v[68:71]
ds_read_b64_tr_b16 a[164:165], v190 offset:40960
v_mfma_f32_16x16x32_bf16 v[68:71], a[200:203], a[40:43], v[68:71]
s_xor_b32 m0, s76, 69632
ds_read_b64_tr_b16 a[166:167], v190 offset:45056
v_mfma_f32_16x16x32_bf16 v[100:103], a[200:203], a[48:51], v[100:103]
s_xor_b32 s64, s85, 557056
v_mfma_f32_16x16x32_bf16 v[100:103], a[204:207], a[52:55], v[100:103]
buffer_load_dwordx4 v12, s[40:43], s64 offen lds
v_mfma_f32_16x16x32_bf16 v[132:135], a[204:207], a[60:63], v[132:135]
s_sub_u32 s73, 1, s73
s_sub_u32 s70, s70, 1
s_cmp_lg_u32 s70, 0
v_mfma_f32_16x16x32_bf16 v[132:135], a[200:203], a[56:59], v[132:135]
s_cbranch_scc1 L_p5loop
L_p5last:
s_waitcnt lgkmcnt(10)
s_waitcnt vmcnt(25)
v_mfma_f32_16x16x32_bf16 v[136:139], a[144:147], a[232:235], v[136:139]
s_waitcnt vmcnt(21)
s_waitcnt lgkmcnt(8)
s_xor_b32 m0, s76, 70656
s_xor_b32 s64, s85, 565248
ds_read_b64_tr_b16 a[168:169], v191 offset:32768
v_mfma_f32_16x16x32_bf16 v[136:139], a[148:151], a[236:239], v[136:139]
buffer_load_dwordx4 v13, s[40:43], s64 offen lds
v_mfma_f32_16x16x32_bf16 v[104:107], a[148:151], a[228:231], v[104:107]
ds_read_b64_tr_b16 a[170:171], v191 offset:36864
v_mfma_f32_16x16x32_bf16 v[104:107], a[144:147], a[224:227], v[104:107]
s_xor_b32 m0, s76, 71680
ds_read_b64_tr_b16 a[172:173], v191 offset:40960
v_mfma_f32_16x16x32_bf16 v[72:75], a[144:147], a[216:219], v[72:75]
s_xor_b32 s64, s85, 573440
ds_read_b64_tr_b16 a[174:175], v191 offset:45056
v_mfma_f32_16x16x32_bf16 v[72:75], a[148:151], a[220:223], v[72:75]
buffer_load_dwordx4 v12, s[40:43], s64 offen lds
v_mfma_f32_16x16x32_bf16 v[40:43], a[148:151], a[212:215], v[40:43]
ds_read_b64_tr_b16 a[176:177], v184 offset:32768
v_mfma_f32_16x16x32_bf16 v[40:43], a[144:147], a[208:211], v[40:43]
s_waitcnt lgkmcnt(5)
s_xor_b32 m0, s76, 72704
ds_read_b64_tr_b16 a[178:179], v184 offset:36864
v_mfma_f32_16x16x32_bf16 v[44:47], a[152:155], a[208:211], v[44:47]
s_xor_b32 s64, s85, 581632
ds_read_b64_tr_b16 a[180:181], v184 offset:40960
v_mfma_f32_16x16x32_bf16 v[44:47], a[156:159], a[212:215], v[44:47]
buffer_load_dwordx4 v13, s[40:43], s64 offen lds
v_mfma_f32_16x16x32_bf16 v[76:79], a[156:159], a[220:223], v[76:79]
ds_read_b64_tr_b16 a[182:183], v184 offset:45056
v_mfma_f32_16x16x32_bf16 v[76:79], a[152:155], a[216:219], v[76:79]
ds_read_b64_tr_b16 a[184:185], v185 offset:32768
v_mfma_f32_16x16x32_bf16 v[108:111], a[152:155], a[224:227], v[108:111]
s_xor_b32 s65, s84, 65536
ds_read_b64_tr_b16 a[186:187], v185 offset:36864
v_mfma_f32_16x16x32_bf16 v[108:111], a[156:159], a[228:231], v[108:111]
buffer_load_dwordx4 a[0:3], v14, s[44:47], s65 offen offset:0 sc1
v_mfma_f32_16x16x32_bf16 v[140:143], a[156:159], a[236:239], v[140:143]
ds_read_b64_tr_b16 a[188:189], v185 offset:40960
v_mfma_f32_16x16x32_bf16 v[140:143], a[152:155], a[232:235], v[140:143]
ds_read_b64_tr_b16 a[190:191], v185 offset:45056
v_mfma_f32_16x16x32_bf16 v[144:147], a[160:163], a[232:235], v[144:147]
v_mfma_f32_16x16x32_bf16 v[144:147], a[164:167], a[236:239], v[144:147]
buffer_load_dwordx4 a[8:11], v14, s[44:47], s65 offen offset:1024 sc1
v_mfma_f32_16x16x32_bf16 v[112:115], a[164:167], a[228:231], v[112:115]
ds_read_b64_tr_b16 a[192:193], v186 offset:32768
v_mfma_f32_16x16x32_bf16 v[112:115], a[160:163], a[224:227], v[112:115]
ds_read_b64_tr_b16 a[194:195], v186 offset:36864
v_mfma_f32_16x16x32_bf16 v[80:83], a[160:163], a[216:219], v[80:83]
ds_read_b64_tr_b16 a[196:197], v186 offset:40960
v_mfma_f32_16x16x32_bf16 v[80:83], a[164:167], a[220:223], v[80:83]
buffer_load_dwordx4 a[16:19], v15, s[44:47], s65 offen offset:0 sc1
v_mfma_f32_16x16x32_bf16 v[48:51], a[164:167], a[212:215], v[48:51]
ds_read_b64_tr_b16 a[198:199], v186 offset:45056
v_mfma_f32_16x16x32_bf16 v[48:51], a[160:163], a[208:211], v[48:51]
s_waitcnt lgkmcnt(4)
v_mfma_f32_16x16x32_bf16 v[52:55], a[168:171], a[208:211], v[52:55]
v_mfma_f32_16x16x32_bf16 v[52:55], a[172:175], a[212:215], v[52:55]
buffer_load_dwordx4 a[24:27], v15, s[44:47], s65 offen offset:1024 sc1
v_mfma_f32_16x16x32_bf16 v[84:87], a[172:175], a[220:223], v[84:87]
ds_read_b64_tr_b16 a[200:201], v187 offset:32768
v_mfma_f32_16x16x32_bf16 v[84:87], a[168:171], a[216:219], v[84:87]
ds_read_b64_tr_b16 a[202:203], v187 offset:36864
v_mfma_f32_16x16x32_bf16 v[116:119], a[168:171], a[224:227], v[116:119]
s_xor_b32 s65, s84, 73728
ds_read_b64_tr_b16 a[204:205], v187 offset:40960
v_mfma_f32_16x16x32_bf16 v[116:119], a[172:175], a[228:231], v[116:119]
buffer_load_dwordx4 a[4:7], v14, s[44:47], s65 offen offset:0 sc1
v_mfma_f32_16x16x32_bf16 v[148:151], a[172:175], a[236:239], v[148:151]
s_xor_b32 s66, s2, 1
s_lshl2_add_u32 s66, s66, s30
ds_read_b64_tr_b16 a[206:207], v187 offset:45056
v_mfma_f32_16x16x32_bf16 v[148:151], a[168:171], a[232:235], v[148:151]
s_lshl_b32 s73, s66, 12
s_add_u32 s73, s73, 67108864
s_lshl2_add_u32 s66, s2, s30
v_mfma_f32_16x16x32_bf16 v[120:123], a[176:179], a[232:235], v[120:123]
s_lshl_b32 s75, s66, 12
s_add_u32 s75, s75, 67108864
s_lshl_b32 s77, s82, 18
v_mfma_f32_16x16x32_bf16 v[120:123], a[180:183], a[236:239], v[120:123]
s_lshl_b32 s66, s30, 16
buffer_load_dwordx4 a[12:15], v14, s[44:47], s65 offen offset:1024 sc1
v_mfma_f32_16x16x32_bf16 v[88:91], a[180:183], a[228:231], v[88:91]
s_add_u32 s77, s77, s66
s_add_u32 s77, s77, s87
s_lshl_b32 s66, s83, 7
v_mfma_f32_16x16x32_bf16 v[88:91], a[176:179], a[224:227], v[88:91]
s_add_u32 s77, s77, s66
v_lshlrev_b32 v1, 24, v0
v_and_b32 v8, 7, v0
v_mfma_f32_16x16x32_bf16 v[56:59], a[176:179], a[216:219], v[56:59]
v_lshlrev_b32 v8, 11, v8
v_bfe_u32 v10, v0, 3, 1
v_mfma_f32_16x16x32_bf16 v[56:59], a[180:183], a[220:223], v[56:59]
buffer_load_dwordx4 a[20:23], v15, s[44:47], s65 offen offset:0 sc1
v_mfma_f32_16x16x32_bf16 v[24:27], a[180:183], a[212:215], v[24:27]
v_lshl_add_u32 v8, v10, 6, v8
v_bfe_u32 v10, v0, 4, 1
v_mfma_f32_16x16x32_bf16 v[24:27], a[176:179], a[208:211], v[24:27]
v_lshl_add_u32 v8, v10, 5, v8
v_lshrrev_b32 v10, 5, v0
v_mfma_f32_16x16x32_bf16 v[28:31], a[184:187], a[208:211], v[28:31]
v_lshl_add_u32 v8, v10, 4, v8
v_add_u32 v2, s86, v16
v_mfma_f32_16x16x32_bf16 v[28:31], a[188:191], a[212:215], v[28:31]
buffer_load_dwordx4 a[28:31], v15, s[44:47], s65 offen offset:1024 sc1
v_mfma_f32_16x16x32_bf16 v[60:63], a[188:191], a[220:223], v[60:63]
v_xor_b32 v3, 0x2000, v2
v_add_u32 v4, 0x20000, v2
v_mfma_f32_16x16x32_bf16 v[60:63], a[184:187], a[216:219], v[60:63]
s_waitcnt vmcnt(24)
s_barrier
v_mfma_f32_16x16x32_bf16 v[92:95], a[184:187], a[224:227], v[92:95]
s_xor_b32 m0, s76, 98304
ds_read_b64_tr_b16 a[144:145], v196 offset:0
v_add_u32 v5, 0x20000, v3
v_mfma_f32_16x16x32_bf16 v[92:95], a[188:191], a[228:231], v[92:95]
s_xor_b32 s64, s85, 786432
ds_read_b64_tr_b16 a[146:147], v196 offset:4096
v_mov_b32 v232, 0
v_mfma_f32_16x16x32_bf16 v[124:127], a[188:191], a[236:239], v[124:127]
buffer_load_dwordx4 v12, s[40:43], s64 offen lds
v_mfma_f32_16x16x32_bf16 v[124:127], a[184:187], a[232:235], v[124:127]
s_waitcnt lgkmcnt(2)
s_xor_b32 m0, s76, 99328
ds_read_b64_tr_b16 a[148:149], v196 offset:8192
v_mov_b32 v233, 0
v_mfma_f32_16x16x32_bf16 v[128:131], a[192:195], a[232:235], v[128:131]
s_xor_b32 s64, s85, 794624
ds_read_b64_tr_b16 a[150:151], v196 offset:12288
v_mov_b32 v236, 0
v_mfma_f32_16x16x32_bf16 v[128:131], a[196:199], a[236:239], v[128:131]
buffer_load_dwordx4 v13, s[40:43], s64 offen lds
v_mfma_f32_16x16x32_bf16 v[96:99], a[196:199], a[228:231], v[96:99]
ds_read_b64_tr_b16 a[152:153], v197 offset:0
v_mov_b32 v237, 0
v_mfma_f32_16x16x32_bf16 v[96:99], a[192:195], a[224:227], v[96:99]
s_xor_b32 m0, s76, 100352
ds_read_b64_tr_b16 a[154:155], v197 offset:4096
v_and_b32 v9, 1, v0
v_mfma_f32_16x16x32_bf16 v[64:67], a[192:195], a[216:219], v[64:67]
s_xor_b32 s64, s85, 802816
ds_read_b64_tr_b16 a[156:157], v197 offset:8192
v_lshlrev_b32 v9, 4, v9
v_mfma_f32_16x16x32_bf16 v[64:67], a[196:199], a[220:223], v[64:67]
buffer_load_dwordx4 v12, s[40:43], s64 offen lds
v_mfma_f32_16x16x32_bf16 v[32:35], a[196:199], a[212:215], v[32:35]
ds_read_b64_tr_b16 a[158:159], v197 offset:12288
v_mov_b32 v10, 0x3f80
v_mfma_f32_16x16x32_bf16 v[32:35], a[192:195], a[208:211], v[32:35]
s_xor_b32 m0, s76, 101376
ds_read_b64_tr_b16 a[160:161], v198 offset:0
v_lshlrev_b32 v9, v9, v10
v_mfma_f32_16x16x32_bf16 v[36:39], a[200:203], a[208:211], v[36:39]
s_xor_b32 s64, s85, 811008
ds_read_b64_tr_b16 a[162:163], v198 offset:4096
v_lshrrev_b32 v10, 4, v0
v_mfma_f32_16x16x32_bf16 v[36:39], a[204:207], a[212:215], v[36:39]
buffer_load_dwordx4 v13, s[40:43], s64 offen lds
v_mfma_f32_16x16x32_bf16 v[68:71], a[204:207], a[220:223], v[68:71]
ds_read_b64_tr_b16 a[164:165], v198 offset:8192
v_lshlrev_b32 v10, 1, v10
v_mfma_f32_16x16x32_bf16 v[68:71], a[200:203], a[216:219], v[68:71]
s_xor_b32 m0, s76, 102400
ds_read_b64_tr_b16 a[166:167], v198 offset:12288
v_bfe_u32 v11, v0, 1, 3
v_mfma_f32_16x16x32_bf16 v[100:103], a[200:203], a[224:227], v[100:103]
s_xor_b32 s64, s85, 819200
v_xor_b32 v10, v10, v11
v_subrev_u32 v11, 1, v10
v_mfma_f32_16x16x32_bf16 v[100:103], a[204:207], a[228:231], v[100:103]
buffer_load_dwordx4 v12, s[40:43], s64 offen lds
v_mfma_f32_16x16x32_bf16 v[132:135], a[204:207], a[236:239], v[132:135]
v_ashrrev_i32 v11, 31, v11
v_and_b32 v234, v11, v9
v_mfma_f32_16x16x32_bf16 v[132:135], a[200:203], a[232:235], v[132:135]
s_waitcnt vmcnt(25)
s_waitcnt lgkmcnt(3)
s_xor_b32 m0, s76, 103424
v_xor_b32 v10, 1, v10
v_subrev_u32 v11, 1, v10
v_mfma_f32_16x16x32_bf16 v[136:139], a[144:147], v[176:179], v[136:139]
s_waitcnt vmcnt(21)
s_xor_b32 s64, s85, 827392
ds_read_b64_tr_b16 a[168:169], v199 offset:0
v_ashrrev_i32 v11, 31, v11
v_mfma_f32_16x16x32_bf16 v[136:139], a[148:151], v[180:183], v[136:139]
buffer_load_dwordx4 v13, s[40:43], s64 offen lds
v_mfma_f32_16x16x32_bf16 v[104:107], a[148:151], v[172:175], v[104:107]
ds_read_b64_tr_b16 a[170:171], v199 offset:4096
v_and_b32 v235, v11, v9
v_mfma_f32_16x16x32_bf16 v[104:107], a[144:147], v[168:171], v[104:107]
s_mov_b32 s48, s24
s_mov_b32 s49, s25
s_xor_b32 m0, s76, 104448
ds_read_b64_tr_b16 a[172:173], v199 offset:8192
v_mfma_f32_16x16x32_bf16 v[72:75], a[144:147], v[160:163], v[72:75]
s_mov_b32 s50, 4194304
s_mov_b32 s51, 0x20000
s_xor_b32 s64, s85, 835584
ds_read_b64_tr_b16 a[174:175], v199 offset:12288
v_mfma_f32_16x16x32_bf16 v[72:75], a[148:151], v[164:167], v[72:75]
buffer_load_dwordx4 v12, s[40:43], s64 offen lds
v_mfma_f32_16x16x32_bf16 v[40:43], a[148:151], v[156:159], v[40:43]
s_waitcnt vmcnt(15)
s_barrier
s_xor_b32 m0, s76, 105472
s_xor_b32 s64, s85, 843776
v_mfma_f32_16x16x32_bf16 v[40:43], a[144:147], v[152:155], v[40:43]
buffer_load_dwordx4 v13, s[40:43], s64 offen lds
v_mfma_f32_16x16x32_bf16 v[44:47], a[152:155], v[152:155], v[44:47]
ds_read_b64_tr_b16 a[176:177], v196 offset:32768
v_mfma_f32_16x16x32_bf16 v[44:47], a[156:159], v[156:159], v[44:47]
s_xor_b32 s65, s84, 98304
ds_read_b64_tr_b16 a[178:179], v196 offset:36864
v_mfma_f32_16x16x32_bf16 v[76:79], a[156:159], v[164:167], v[76:79]
buffer_load_dwordx4 a[32:35], v14, s[44:47], s65 offen offset:0 sc1
v_mfma_f32_16x16x32_bf16 v[76:79], a[152:155], v[160:163], v[76:79]
ds_read_b64_tr_b16 a[180:181], v196 offset:40960
v_mfma_f32_16x16x32_bf16 v[108:111], a[152:155], v[168:171], v[108:111]
ds_read_b64_tr_b16 a[182:183], v196 offset:45056
v_mfma_f32_16x16x32_bf16 v[108:111], a[156:159], v[172:175], v[108:111]
buffer_load_dwordx4 a[40:43], v14, s[44:47], s65 offen offset:1024 sc1
v_mfma_f32_16x16x32_bf16 v[140:143], a[156:159], v[180:183], v[140:143]
ds_read_b64_tr_b16 a[184:185], v197 offset:32768
v_mfma_f32_16x16x32_bf16 v[140:143], a[152:155], v[176:179], v[140:143]
s_waitcnt lgkmcnt(5)
ds_read_b64_tr_b16 a[186:187], v197 offset:36864
v_mfma_f32_16x16x32_bf16 v[144:147], a[160:163], v[176:179], v[144:147]
buffer_load_dwordx4 a[48:51], v15, s[44:47], s65 offen offset:0 sc1
v_mfma_f32_16x16x32_bf16 v[144:147], a[164:167], v[180:183], v[144:147]
ds_read_b64_tr_b16 a[188:189], v197 offset:40960
v_mfma_f32_16x16x32_bf16 v[112:115], a[164:167], v[172:175], v[112:115]
ds_read_b64_tr_b16 a[190:191], v197 offset:45056
v_mfma_f32_16x16x32_bf16 v[112:115], a[160:163], v[168:171], v[112:115]
ds_read_b64_tr_b16 a[192:193], v198 offset:32768
v_mfma_f32_16x16x32_bf16 v[80:83], a[160:163], v[160:163], v[80:83]
buffer_load_dwordx4 a[56:59], v15, s[44:47], s65 offen offset:1024 sc1
v_mfma_f32_16x16x32_bf16 v[80:83], a[164:167], v[164:167], v[80:83]
ds_read_b64_tr_b16 a[194:195], v198 offset:36864
v_mfma_f32_16x16x32_bf16 v[48:51], a[164:167], v[156:159], v[48:51]
s_xor_b32 s65, s84, 106496
ds_read_b64_tr_b16 a[196:197], v198 offset:40960
v_mfma_f32_16x16x32_bf16 v[48:51], a[160:163], v[152:155], v[48:51]
buffer_load_dwordx4 a[36:39], v14, s[44:47], s65 offen offset:0 sc1
v_mfma_f32_16x16x32_bf16 v[52:55], a[168:171], v[152:155], v[52:55]
ds_read_b64_tr_b16 a[198:199], v198 offset:45056
v_mfma_f32_16x16x32_bf16 v[52:55], a[172:175], v[156:159], v[52:55]
v_mfma_f32_16x16x32_bf16 v[84:87], a[172:175], v[164:167], v[84:87]
buffer_load_dwordx4 a[44:47], v14, s[44:47], s65 offen offset:1024 sc1
v_mfma_f32_16x16x32_bf16 v[84:87], a[168:171], v[160:163], v[84:87]
ds_read_b64_tr_b16 a[200:201], v199 offset:32768
v_mfma_f32_16x16x32_bf16 v[116:119], a[168:171], v[168:171], v[116:119]
ds_read_b64_tr_b16 a[202:203], v199 offset:36864
v_mfma_f32_16x16x32_bf16 v[116:119], a[172:175], v[172:175], v[116:119]
buffer_load_dwordx4 a[52:55], v15, s[44:47], s65 offen offset:0 sc1
v_mfma_f32_16x16x32_bf16 v[148:151], a[172:175], v[180:183], v[148:151]
ds_read_b64_tr_b16 a[204:205], v199 offset:40960
v_mfma_f32_16x16x32_bf16 v[148:151], a[168:171], v[176:179], v[148:151]
s_waitcnt vmcnt(19)
s_waitcnt lgkmcnt(4)
ds_read_b64_tr_b16 a[206:207], v199 offset:45056
v_mfma_f32_16x16x32_bf16 v[136:139], a[176:179], a[24:27], v[136:139]
s_waitcnt vmcnt(15)
buffer_load_dwordx4 a[60:63], v15, s[44:47], s65 offen offset:1024 sc1
v_mfma_f32_16x16x32_bf16 v[136:139], a[180:183], a[28:31], v[136:139]
v_mfma_f32_16x16x32_bf16 v[104:107], a[180:183], a[20:23], v[104:107]
v_mfma_f32_16x16x32_bf16 v[104:107], a[176:179], a[16:19], v[104:107]
v_mfma_f32_16x16x32_bf16 v[72:75], a[176:179], a[8:11], v[72:75]
v_mfma_f32_16x16x32_bf16 v[72:75], a[180:183], a[12:15], v[72:75]
v_mfma_f32_16x16x32_bf16 v[40:43], a[180:183], a[4:7], v[40:43]
s_waitcnt vmcnt(8)
s_barrier
v_mfma_f32_16x16x32_bf16 v[40:43], a[176:179], a[0:3], v[40:43]
ds_read_b64_tr_b16 a[144:145], v188 offset:0
v_mfma_f32_16x16x32_bf16 v[44:47], a[184:187], a[0:3], v[44:47]
ds_read_b64_tr_b16 a[146:147], v188 offset:4096
v_mfma_f32_16x16x32_bf16 v[44:47], a[188:191], a[4:7], v[44:47]
ds_read_b64_tr_b16 a[148:149], v188 offset:8192
v_mfma_f32_16x16x32_bf16 v[76:79], a[188:191], a[12:15], v[76:79]
ds_read_b64_tr_b16 a[150:151], v188 offset:12288
v_mfma_f32_16x16x32_bf16 v[76:79], a[184:187], a[8:11], v[76:79]
ds_read_b64_tr_b16 a[152:153], v189 offset:0
v_mfma_f32_16x16x32_bf16 v[108:111], a[184:187], a[16:19], v[108:111]
ds_read_b64_tr_b16 a[154:155], v189 offset:4096
v_mfma_f32_16x16x32_bf16 v[108:111], a[188:191], a[20:23], v[108:111]
ds_read_b64_tr_b16 a[156:157], v189 offset:8192
v_mfma_f32_16x16x32_bf16 v[140:143], a[188:191], a[28:31], v[140:143]
ds_read_b64_tr_b16 a[158:159], v189 offset:12288
v_mfma_f32_16x16x32_bf16 v[140:143], a[184:187], a[24:27], v[140:143]
ds_read_b64_tr_b16 a[160:161], v190 offset:0
v_mfma_f32_16x16x32_bf16 v[144:147], a[192:195], a[24:27], v[144:147]
s_waitcnt lgkmcnt(7)
ds_read_b64_tr_b16 a[162:163], v190 offset:4096
v_mfma_f32_16x16x32_bf16 v[144:147], a[196:199], a[28:31], v[144:147]
ds_read_b64_tr_b16 a[164:165], v190 offset:8192
v_mfma_f32_16x16x32_bf16 v[112:115], a[196:199], a[20:23], v[112:115]
ds_read_b64_tr_b16 a[166:167], v190 offset:12288
v_mfma_f32_16x16x32_bf16 v[112:115], a[192:195], a[16:19], v[112:115]
ds_read_b64_tr_b16 a[168:169], v191 offset:0
v_mfma_f32_16x16x32_bf16 v[80:83], a[192:195], a[8:11], v[80:83]
ds_read_b64_tr_b16 a[170:171], v191 offset:4096
v_mfma_f32_16x16x32_bf16 v[80:83], a[196:199], a[12:15], v[80:83]
ds_read_b64_tr_b16 a[172:173], v191 offset:8192
v_mfma_f32_16x16x32_bf16 v[48:51], a[196:199], a[4:7], v[48:51]
ds_read_b64_tr_b16 a[174:175], v191 offset:12288
v_mfma_f32_16x16x32_bf16 v[48:51], a[192:195], a[0:3], v[48:51]
v_mfma_f32_16x16x32_bf16 v[52:55], a[200:203], a[0:3], v[52:55]
v_mfma_f32_16x16x32_bf16 v[52:55], a[204:207], a[4:7], v[52:55]
v_mfma_f32_16x16x32_bf16 v[84:87], a[204:207], a[12:15], v[84:87]
v_mfma_f32_16x16x32_bf16 v[84:87], a[200:203], a[8:11], v[84:87]
v_mfma_f32_16x16x32_bf16 v[116:119], a[200:203], a[16:19], v[116:119]
v_mfma_f32_16x16x32_bf16 v[116:119], a[204:207], a[20:23], v[116:119]
v_mfma_f32_16x16x32_bf16 v[148:151], a[204:207], a[28:31], v[148:151]
v_mfma_f32_16x16x32_bf16 v[148:151], a[200:203], a[24:27], v[148:151]
s_waitcnt vmcnt(5)
v_mfma_f32_16x16x32_bf16 v[104:107], a[144:147], a[48:51], v[104:107]
s_waitcnt vmcnt(1)
s_waitcnt lgkmcnt(0)
v_mfma_f32_16x16x32_bf16 v[104:107], a[148:151], a[52:55], v[104:107]
v_mfma_f32_16x16x32_bf16 v[108:111], a[156:159], a[52:55], v[108:111]
ds_read_b64_tr_b16 a[176:177], v192 offset:0
v_mfma_f32_16x16x32_bf16 v[108:111], a[152:155], a[48:51], v[108:111]
ds_read_b64_tr_b16 a[178:179], v192 offset:4096
v_mfma_f32_16x16x32_bf16 v[112:115], a[160:163], a[48:51], v[112:115]
ds_read_b64_tr_b16 a[180:181], v192 offset:8192
v_mfma_f32_16x16x32_bf16 v[112:115], a[164:167], a[52:55], v[112:115]
ds_read_b64_tr_b16 a[182:183], v192 offset:12288
v_mfma_f32_16x16x32_bf16 v[116:119], a[172:175], a[52:55], v[116:119]
v_mfma_f32_16x16x32_bf16 v[116:119], a[168:171], a[48:51], v[116:119]
v_mfma_f32_16x16x32_bf16 v[148:151], a[168:171], a[56:59], v[148:151]
s_waitcnt vmcnt(0)
v_mfma_f32_16x16x32_bf16 v[148:151], a[172:175], a[60:63], v[148:151]
ds_write_b128 v3, v[104:107] offset:0
v_mfma_f32_16x16x32_bf16 v[144:147], a[164:167], a[60:63], v[144:147]
ds_read_b64_tr_b16 a[184:185], v193 offset:0
v_mfma_f32_16x16x32_bf16 v[144:147], a[160:163], a[56:59], v[144:147]
ds_write_b128 v3, v[108:111] offset:1024
v_mfma_f32_16x16x32_bf16 v[140:143], a[152:155], a[56:59], v[140:143]
ds_read_b64_tr_b16 a[186:187], v193 offset:4096
v_mfma_f32_16x16x32_bf16 v[140:143], a[156:159], a[60:63], v[140:143]
ds_write_b128 v3, v[112:115] offset:2048
v_mfma_f32_16x16x32_bf16 v[136:139], a[148:151], a[60:63], v[136:139]
ds_read_b64_tr_b16 a[188:189], v193 offset:8192
v_mfma_f32_16x16x32_bf16 v[136:139], a[144:147], a[56:59], v[136:139]
ds_write_b128 v3, v[116:119] offset:3072
v_mfma_f32_16x16x32_bf16 v[40:43], a[144:147], a[32:35], v[40:43]
ds_read_b64_tr_b16 a[190:191], v193 offset:12288
v_mfma_f32_16x16x32_bf16 v[40:43], a[148:151], a[36:39], v[40:43]
ds_write_b128 v3, v[148:151] offset:7168
v_mfma_f32_16x16x32_bf16 v[44:47], a[156:159], a[36:39], v[44:47]
ds_read_b64_tr_b16 a[192:193], v194 offset:0
v_mfma_f32_16x16x32_bf16 v[44:47], a[152:155], a[32:35], v[44:47]
ds_write_b128 v3, v[144:147] offset:6144
v_mfma_f32_16x16x32_bf16 v[48:51], a[160:163], a[32:35], v[48:51]
ds_read_b64_tr_b16 a[194:195], v194 offset:4096
v_mfma_f32_16x16x32_bf16 v[48:51], a[164:167], a[36:39], v[48:51]
ds_write_b128 v3, v[140:143] offset:5120
v_mfma_f32_16x16x32_bf16 v[52:55], a[172:175], a[36:39], v[52:55]
ds_read_b64_tr_b16 a[196:197], v194 offset:8192
v_mfma_f32_16x16x32_bf16 v[52:55], a[168:171], a[32:35], v[52:55]
ds_write_b128 v3, v[136:139] offset:4096
v_mfma_f32_16x16x32_bf16 v[84:87], a[168:171], a[40:43], v[84:87]
ds_read_b64_tr_b16 a[198:199], v194 offset:12288
v_mfma_f32_16x16x32_bf16 v[84:87], a[172:175], a[44:47], v[84:87]
v_mfma_f32_16x16x32_bf16 v[80:83], a[164:167], a[44:47], v[80:83]
s_waitcnt lgkmcnt(0)
s_barrier
v_mfma_f32_16x16x32_bf16 v[80:83], a[160:163], a[40:43], v[80:83]
ds_read_b128 v[200:203], v2 offset:0
ds_read_b128 v[204:207], v2 offset:1024
v_mfma_f32_16x16x32_bf16 v[76:79], a[152:155], a[40:43], v[76:79]
ds_read_b128 v[208:211], v2 offset:2048
ds_read_b128 v[212:215], v2 offset:3072
v_mfma_f32_16x16x32_bf16 v[76:79], a[156:159], a[44:47], v[76:79]
ds_read_b128 v[216:219], v2 offset:4096
ds_read_b128 v[220:223], v2 offset:5120
v_mfma_f32_16x16x32_bf16 v[72:75], a[148:151], a[44:47], v[72:75]
ds_read_b128 v[224:227], v2 offset:6144
ds_read_b128 v[228:231], v2 offset:7168
v_mfma_f32_16x16x32_bf16 v[72:75], a[144:147], a[40:43], v[72:75]
ds_read_b64_tr_b16 a[200:201], v195 offset:0
v_mfma_f32_16x16x32_bf16 v[120:123], a[176:179], v[176:179], v[120:123]
ds_read_b64_tr_b16 a[202:203], v195 offset:4096
v_mfma_f32_16x16x32_bf16 v[120:123], a[180:183], v[180:183], v[120:123]
ds_read_b64_tr_b16 a[204:205], v195 offset:8192
v_mfma_f32_16x16x32_bf16 v[88:91], a[180:183], v[172:175], v[88:91]
s_waitcnt lgkmcnt(10)
ds_read_b64_tr_b16 a[206:207], v195 offset:12288
v_add_f32 v200, v200, v40
v_mfma_f32_16x16x32_bf16 v[88:91], a[176:179], v[168:171], v[88:91]
ds_read_b64_tr_b16 a[144:145], v192 offset:32768
v_add_f32 v201, v201, v41
v_mfma_f32_16x16x32_bf16 v[56:59], a[176:179], v[160:163], v[56:59]
ds_read_b64_tr_b16 a[146:147], v192 offset:36864
v_add_f32 v202, v202, v42
v_mfma_f32_16x16x32_bf16 v[56:59], a[180:183], v[164:167], v[56:59]
s_waitcnt lgkmcnt(8)
ds_read_b64_tr_b16 a[148:149], v192 offset:40960
v_add_f32 v203, v203, v43
v_add_f32 v204, v204, v44
v_add_f32 v205, v205, v45
v_add_f32 v206, v206, v46
v_add_f32 v207, v207, v47
v_cvt_pk_bf16_f32 v200, v200, v201
v_cvt_pk_bf16_f32 v201, v202, v203
v_cvt_pk_bf16_f32 v202, v204, v205
v_cvt_pk_bf16_f32 v203, v206, v207
v_mfma_f32_16x16x32_bf16 v[24:27], a[180:183], v[156:159], v[24:27]
buffer_store_dwordx4 v[200:203], v16, s[44:47], s73 offen offset:0 sc1
v_mfma_f32_16x16x32_bf16 v[24:27], a[176:179], v[152:155], v[24:27]
ds_read_b64_tr_b16 a[150:151], v192 offset:45056
v_add_f32 v208, v208, v48
v_mfma_f32_16x16x32_bf16 v[28:31], a[184:187], v[152:155], v[28:31]
v_add_f32 v209, v209, v49
v_add_f32 v210, v210, v50
v_mfma_f32_16x16x32_bf16 v[28:31], a[188:191], v[156:159], v[28:31]
v_add_f32 v211, v211, v51
v_add_f32 v212, v212, v52
v_add_f32 v213, v213, v53
v_add_f32 v214, v214, v54
v_add_f32 v215, v215, v55
v_cvt_pk_bf16_f32 v208, v208, v209
v_cvt_pk_bf16_f32 v209, v210, v211
v_cvt_pk_bf16_f32 v210, v212, v213
v_cvt_pk_bf16_f32 v211, v214, v215
v_mfma_f32_16x16x32_bf16 v[60:63], a[188:191], v[164:167], v[60:63]
buffer_store_dwordx4 v[208:211], v16, s[44:47], s73 offen offset:1024 sc1
v_mfma_f32_16x16x32_bf16 v[60:63], a[184:187], v[160:163], v[60:63]
ds_read_b64_tr_b16 a[152:153], v193 offset:32768
v_add_f32 v216, v216, v72
v_mfma_f32_16x16x32_bf16 v[92:95], a[184:187], v[168:171], v[92:95]
ds_read_b64_tr_b16 a[154:155], v193 offset:36864
v_add_f32 v217, v217, v73
v_mfma_f32_16x16x32_bf16 v[92:95], a[188:191], v[172:175], v[92:95]
ds_read_b64_tr_b16 a[156:157], v193 offset:40960
v_add_f32 v218, v218, v74
v_add_f32 v219, v219, v75
v_add_f32 v220, v220, v76
v_add_f32 v221, v221, v77
v_add_f32 v222, v222, v78
v_add_f32 v223, v223, v79
v_cvt_pk_bf16_f32 v216, v216, v217
v_cvt_pk_bf16_f32 v217, v218, v219
v_cvt_pk_bf16_f32 v218, v220, v221
v_cvt_pk_bf16_f32 v219, v222, v223
v_mfma_f32_16x16x32_bf16 v[124:127], a[188:191], v[180:183], v[124:127]
buffer_store_dwordx4 v[216:219], v16, s[44:47], s73 offen offset:2048 sc1
v_mfma_f32_16x16x32_bf16 v[124:127], a[184:187], v[176:179], v[124:127]
s_waitcnt lgkmcnt(3)
ds_read_b64_tr_b16 a[158:159], v193 offset:45056
v_add_f32 v224, v224, v80
v_mfma_f32_16x16x32_bf16 v[128:131], a[192:195], v[176:179], v[128:131]
v_add_f32 v225, v225, v81
v_add_f32 v226, v226, v82
v_mfma_f32_16x16x32_bf16 v[128:131], a[196:199], v[180:183], v[128:131]
v_add_f32 v227, v227, v83
v_add_f32 v228, v228, v84
v_add_f32 v229, v229, v85
v_add_f32 v230, v230, v86
v_add_f32 v231, v231, v87
v_cvt_pk_bf16_f32 v224, v224, v225
v_cvt_pk_bf16_f32 v225, v226, v227
v_cvt_pk_bf16_f32 v226, v228, v229
v_cvt_pk_bf16_f32 v227, v230, v231
v_mfma_f32_16x16x32_bf16 v[96:99], a[196:199], v[172:175], v[96:99]
buffer_store_dwordx4 v[224:227], v16, s[44:47], s73 offen offset:3072 sc1
v_mfma_f32_16x16x32_bf16 v[96:99], a[192:195], v[168:171], v[96:99]
ds_read_b64_tr_b16 a[160:161], v194 offset:32768
v_mfma_f32_16x16x32_bf16 v[64:67], a[192:195], v[160:163], v[64:67]
ds_read_b64_tr_b16 a[162:163], v194 offset:36864
v_mfma_f32_16x16x32_bf16 v[64:67], a[196:199], v[164:167], v[64:67]
ds_read_b64_tr_b16 a[164:165], v194 offset:40960
v_mfma_f32_16x16x32_bf16 v[32:35], a[196:199], v[156:159], v[32:35]
ds_read_b64_tr_b16 a[166:167], v194 offset:45056
v_mfma_f32_16x16x32_bf16 v[32:35], a[192:195], v[152:155], v[32:35]
v_mfma_f32_16x16x32_bf16 v[36:39], a[200:203], v[152:155], v[36:39]
v_mfma_f32_16x16x32_bf16 v[36:39], a[204:207], v[156:159], v[36:39]
v_mfma_f32_16x16x32_bf16 v[68:71], a[204:207], v[164:167], v[68:71]
ds_read_b64_tr_b16 a[168:169], v195 offset:32768
v_mfma_f32_16x16x32_bf16 v[68:71], a[200:203], v[160:163], v[68:71]
ds_read_b64_tr_b16 a[170:171], v195 offset:36864
v_mfma_f32_16x16x32_bf16 v[100:103], a[200:203], v[168:171], v[100:103]
ds_read_b64_tr_b16 a[172:173], v195 offset:40960
v_mfma_f32_16x16x32_bf16 v[100:103], a[204:207], v[172:175], v[100:103]
ds_read_b64_tr_b16 a[174:175], v195 offset:45056
v_mfma_f32_16x16x32_bf16 v[132:135], a[204:207], v[180:183], v[132:135]
v_mfma_f32_16x16x32_bf16 v[132:135], a[200:203], v[176:179], v[132:135]
v_mfma_f32_16x16x32_bf16 v[120:123], a[144:147], a[24:27], v[120:123]
v_mfma_f32_16x16x32_bf16 v[120:123], a[148:151], a[28:31], v[120:123]
v_mfma_f32_16x16x32_bf16 v[88:91], a[148:151], a[20:23], v[88:91]
ds_read_b64_tr_b16 a[176:177], v184 offset:0
v_mfma_f32_16x16x32_bf16 v[88:91], a[144:147], a[16:19], v[88:91]
ds_read_b64_tr_b16 a[178:179], v184 offset:4096
v_mfma_f32_16x16x32_bf16 v[56:59], a[144:147], a[8:11], v[56:59]
ds_read_b64_tr_b16 a[180:181], v184 offset:8192
v_mfma_f32_16x16x32_bf16 v[56:59], a[148:151], a[12:15], v[56:59]
ds_read_b64_tr_b16 a[182:183], v184 offset:12288
v_mfma_f32_16x16x32_bf16 v[24:27], a[148:151], a[4:7], v[24:27]
ds_read_b64_tr_b16 a[184:185], v185 offset:0
v_mfma_f32_16x16x32_bf16 v[24:27], a[144:147], a[0:3], v[24:27]
s_waitcnt lgkmcnt(5)
ds_read_b64_tr_b16 a[186:187], v185 offset:4096
v_mfma_f32_16x16x32_bf16 v[28:31], a[152:155], a[0:3], v[28:31]
ds_read_b64_tr_b16 a[188:189], v185 offset:8192
v_mfma_f32_16x16x32_bf16 v[28:31], a[156:159], a[4:7], v[28:31]
ds_read_b64_tr_b16 a[190:191], v185 offset:12288
v_mfma_f32_16x16x32_bf16 v[60:63], a[156:159], a[12:15], v[60:63]
ds_read_b64_tr_b16 a[192:193], v186 offset:0
v_mfma_f32_16x16x32_bf16 v[60:63], a[152:155], a[8:11], v[60:63]
ds_read_b64_tr_b16 a[194:195], v186 offset:4096
v_mfma_f32_16x16x32_bf16 v[92:95], a[152:155], a[16:19], v[92:95]
ds_read_b64_tr_b16 a[196:197], v186 offset:8192
v_mfma_f32_16x16x32_bf16 v[92:95], a[156:159], a[20:23], v[92:95]
ds_read_b64_tr_b16 a[198:199], v186 offset:12288
v_mfma_f32_16x16x32_bf16 v[124:127], a[156:159], a[28:31], v[124:127]
ds_read_b64_tr_b16 a[200:201], v187 offset:0
v_mfma_f32_16x16x32_bf16 v[124:127], a[152:155], a[24:27], v[124:127]
ds_read_b64_tr_b16 a[202:203], v187 offset:4096
v_mfma_f32_16x16x32_bf16 v[128:131], a[160:163], a[24:27], v[128:131]
ds_read_b64_tr_b16 a[204:205], v187 offset:8192
v_mfma_f32_16x16x32_bf16 v[128:131], a[164:167], a[28:31], v[128:131]
ds_read_b64_tr_b16 a[206:207], v187 offset:12288
v_mfma_f32_16x16x32_bf16 v[96:99], a[164:167], a[20:23], v[96:99]
s_branch L_po23
L_pg23:
s_branch L_tr2
L_po23:
v_mfma_f32_16x16x32_bf16 v[96:99], a[160:163], a[16:19], v[96:99]
v_mfma_f32_16x16x32_bf16 v[64:67], a[160:163], a[8:11], v[64:67]
v_mfma_f32_16x16x32_bf16 v[64:67], a[164:167], a[12:15], v[64:67]
v_mfma_f32_16x16x32_bf16 v[32:35], a[164:167], a[4:7], v[32:35]
v_mfma_f32_16x16x32_bf16 v[32:35], a[160:163], a[0:3], v[32:35]
v_mfma_f32_16x16x32_bf16 v[36:39], a[168:171], a[0:3], v[36:39]
v_mfma_f32_16x16x32_bf16 v[36:39], a[172:175], a[4:7], v[36:39]
v_mfma_f32_16x16x32_bf16 v[68:71], a[172:175], a[12:15], v[68:71]
v_mfma_f32_16x16x32_bf16 v[68:71], a[168:171], a[8:11], v[68:71]
v_mfma_f32_16x16x32_bf16 v[100:103], a[168:171], a[16:19], v[100:103]
v_mfma_f32_16x16x32_bf16 v[100:103], a[172:175], a[20:23], v[100:103]
v_mfma_f32_16x16x32_bf16 v[132:135], a[172:175], a[28:31], v[132:135]
v_mfma_f32_16x16x32_bf16 v[132:135], a[168:171], a[24:27], v[132:135]
s_waitcnt lgkmcnt(0)
v_mfma_f32_16x16x32_bf16 v[88:91], a[176:179], a[48:51], v[88:91]
v_mfma_f32_16x16x32_bf16 v[88:91], a[180:183], a[52:55], v[88:91]
v_mfma_f32_16x16x32_bf16 v[92:95], a[188:191], a[52:55], v[92:95]
buffer_load_dwordx4 v[152:155], v16, s[44:47], s75 offen offset:0 sc1
v_mfma_f32_16x16x32_bf16 v[92:95], a[184:187], a[48:51], v[92:95]
v_mfma_f32_16x16x32_bf16 v[96:99], a[192:195], a[48:51], v[96:99]
buffer_load_dwordx4 v[156:159], v16, s[44:47], s75 offen offset:1024 sc1
v_mfma_f32_16x16x32_bf16 v[96:99], a[196:199], a[52:55], v[96:99]
v_mfma_f32_16x16x32_bf16 v[100:103], a[204:207], a[52:55], v[100:103]
buffer_load_dwordx4 v[160:163], v16, s[44:47], s75 offen offset:2048 sc1
v_mfma_f32_16x16x32_bf16 v[100:103], a[200:203], a[48:51], v[100:103]
v_mfma_f32_16x16x32_bf16 v[132:135], a[200:203], a[56:59], v[132:135]
buffer_load_dwordx4 v[164:167], v16, s[44:47], s75 offen offset:3072 sc1
v_mfma_f32_16x16x32_bf16 v[132:135], a[204:207], a[60:63], v[132:135]
ds_write_b128 v5, v[88:91] offset:0
v_mfma_f32_16x16x32_bf16 v[128:131], a[196:199], a[60:63], v[128:131]
v_mfma_f32_16x16x32_bf16 v[128:131], a[192:195], a[56:59], v[128:131]
ds_write_b128 v5, v[92:95] offset:1024
v_mfma_f32_16x16x32_bf16 v[124:127], a[184:187], a[56:59], v[124:127]
v_mfma_f32_16x16x32_bf16 v[124:127], a[188:191], a[60:63], v[124:127]
ds_write_b128 v5, v[96:99] offset:2048
v_mfma_f32_16x16x32_bf16 v[120:123], a[180:183], a[60:63], v[120:123]
v_mfma_f32_16x16x32_bf16 v[120:123], a[176:179], a[56:59], v[120:123]
ds_write_b128 v5, v[100:103] offset:3072
v_mfma_f32_16x16x32_bf16 v[24:27], a[176:179], a[32:35], v[24:27]
v_mfma_f32_16x16x32_bf16 v[24:27], a[180:183], a[36:39], v[24:27]
ds_write_b128 v5, v[132:135] offset:7168
v_mfma_f32_16x16x32_bf16 v[28:31], a[188:191], a[36:39], v[28:31]
v_mfma_f32_16x16x32_bf16 v[28:31], a[184:187], a[32:35], v[28:31]
ds_write_b128 v5, v[128:131] offset:6144
v_mfma_f32_16x16x32_bf16 v[32:35], a[192:195], a[32:35], v[32:35]
v_mfma_f32_16x16x32_bf16 v[32:35], a[196:199], a[36:39], v[32:35]
ds_write_b128 v5, v[124:127] offset:5120
v_mfma_f32_16x16x32_bf16 v[36:39], a[204:207], a[36:39], v[36:39]
v_mfma_f32_16x16x32_bf16 v[36:39], a[200:203], a[32:35], v[36:39]
ds_write_b128 v5, v[120:123] offset:4096
v_mfma_f32_16x16x32_bf16 v[68:71], a[200:203], a[40:43], v[68:71]
v_mfma_f32_16x16x32_bf16 v[68:71], a[204:207], a[44:47], v[68:71]
v_mfma_f32_16x16x32_bf16 v[64:67], a[196:199], a[44:47], v[64:67]
v_mfma_f32_16x16x32_bf16 v[64:67], a[192:195], a[40:43], v[64:67]
s_waitcnt lgkmcnt(0)
s_barrier
v_mfma_f32_16x16x32_bf16 v[60:63], a[184:187], a[40:43], v[60:63]
ds_read_b128 v[200:203], v4 offset:0
ds_read_b128 v[204:207], v4 offset:1024
v_mfma_f32_16x16x32_bf16 v[60:63], a[188:191], a[44:47], v[60:63]
ds_read_b128 v[208:211], v4 offset:2048
ds_read_b128 v[212:215], v4 offset:3072
v_mfma_f32_16x16x32_bf16 v[56:59], a[180:183], a[44:47], v[56:59]
ds_read_b128 v[216:219], v4 offset:4096
ds_read_b128 v[220:223], v4 offset:5120
v_mfma_f32_16x16x32_bf16 v[56:59], a[176:179], a[40:43], v[56:59]
ds_read_b128 v[224:227], v4 offset:6144
ds_read_b128 v[228:231], v4 offset:7168
s_mov_b32 s72, 0x20000
s_waitcnt lgkmcnt(7)
v_add_f32 v24, v24, v200
v_add_f32 v25, v25, v201
v_add_f32 v26, v26, v202
v_add_f32 v27, v27, v203
s_waitcnt lgkmcnt(6)
v_add_f32 v28, v28, v204
v_add_f32 v29, v29, v205
v_add_f32 v30, v30, v206
v_add_f32 v31, v31, v207
s_waitcnt lgkmcnt(5)
v_add_f32 v32, v32, v208
v_add_f32 v33, v33, v209
v_add_f32 v34, v34, v210
v_add_f32 v35, v35, v211
s_waitcnt lgkmcnt(4)
v_add_f32 v36, v36, v212
v_add_f32 v37, v37, v213
v_add_f32 v38, v38, v214
v_add_f32 v39, v39, v215
s_waitcnt lgkmcnt(3)
v_add_f32 v56, v56, v216
v_add_f32 v57, v57, v217
v_add_f32 v58, v58, v218
v_add_f32 v59, v59, v219
s_waitcnt lgkmcnt(2)
v_add_f32 v60, v60, v220
v_add_f32 v61, v61, v221
v_add_f32 v62, v62, v222
v_add_f32 v63, v63, v223
s_waitcnt lgkmcnt(1)
v_add_f32 v64, v64, v224
v_add_f32 v65, v65, v225
v_add_f32 v66, v66, v226
v_add_f32 v67, v67, v227
s_waitcnt lgkmcnt(0)
v_add_f32 v68, v68, v228
v_add_f32 v69, v69, v229
v_add_f32 v70, v70, v230
v_add_f32 v71, v71, v231
s_waitcnt vmcnt(0)
L_xchk:
v_max3_u32 v9, v152, v153, v154
v_max3_u32 v9, v9, v155, v156
v_max3_u32 v9, v9, v157, v158
v_max3_u32 v9, v9, v159, v160
v_max3_u32 v9, v9, v161, v162
v_max3_u32 v9, v9, v163, v164
v_max3_u32 v9, v9, v165, v166
v_max_u32 v9, v9, v167
v_cmp_eq_u32 vcc, -1, v9
s_cbranch_vccnz L_xretry
L_xgo:
v_mfma_f32_16x16x32_bf16 v[24:27], v[234:237], v[152:155], v[24:27]
v_mfma_f32_16x16x32_bf16 v[28:31], v[232:235], v[152:155], v[28:31]
v_mfma_f32_16x16x32_bf16 v[32:35], v[234:237], v[156:159], v[32:35]
v_mfma_f32_16x16x32_bf16 v[36:39], v[232:235], v[156:159], v[36:39]
v_mfma_f32_16x16x32_bf16 v[56:59], v[234:237], v[160:163], v[56:59]
v_mfma_f32_16x16x32_bf16 v[60:63], v[232:235], v[160:163], v[60:63]
v_mfma_f32_16x16x32_bf16 v[64:67], v[234:237], v[164:167], v[64:67]
v_mfma_f32_16x16x32_bf16 v[68:71], v[232:235], v[164:167], v[68:71]
s_nop 1
v_cvt_pk_bf16_f32 v24, v24, v25
v_cvt_pk_bf16_f32 v25, v26, v27
v_cvt_pk_bf16_f32 v26, v28, v29
v_cvt_pk_bf16_f32 v27, v30, v31
v_cvt_pk_bf16_f32 v32, v32, v33
v_cvt_pk_bf16_f32 v33, v34, v35
v_cvt_pk_bf16_f32 v34, v36, v37
v_cvt_pk_bf16_f32 v35, v38, v39
v_permlane16_swap_b32 v24, v26
v_permlane16_swap_b32 v25, v27
v_permlane16_swap_b32 v32, v34
v_permlane16_swap_b32 v33, v35
v_mov_b32 v28, v24
v_mov_b32 v29, v25
v_mov_b32 v30, v26
v_mov_b32 v31, v27
v_mov_b32_dpp v24, v32 row_ror:8 row_mask:0xf bank_mask:0xc
v_mov_b32_dpp v25, v33 row_ror:8 row_mask:0xf bank_mask:0xc
v_mov_b32_dpp v26, v34 row_ror:8 row_mask:0xf bank_mask:0xc
v_mov_b32_dpp v27, v35 row_ror:8 row_mask:0xf bank_mask:0xc
v_mov_b32_dpp v32, v28 row_ror:8 row_mask:0xf bank_mask:0x3
v_mov_b32_dpp v33, v29 row_ror:8 row_mask:0xf bank_mask:0x3
v_mov_b32_dpp v34, v30 row_ror:8 row_mask:0xf bank_mask:0x3
v_mov_b32_dpp v35, v31 row_ror:8 row_mask:0xf bank_mask:0x3
buffer_store_dwordx4 v[24:27], v8, s[48:51], s77 offen sc1
s_add_u32 s77, s77, 16384
buffer_store_dwordx4 v[32:35], v8, s[48:51], s77 offen sc1
s_add_u32 s77, s77, 16384
v_cvt_pk_bf16_f32 v56, v56, v57
v_cvt_pk_bf16_f32 v57, v58, v59
v_cvt_pk_bf16_f32 v58, v60, v61
v_cvt_pk_bf16_f32 v59, v62, v63
v_cvt_pk_bf16_f32 v64, v64, v65
v_cvt_pk_bf16_f32 v65, v66, v67
v_cvt_pk_bf16_f32 v66, v68, v69
v_cvt_pk_bf16_f32 v67, v70, v71
v_permlane16_swap_b32 v56, v58
v_permlane16_swap_b32 v57, v59
v_permlane16_swap_b32 v64, v66
v_permlane16_swap_b32 v65, v67
v_mov_b32 v60, v56
v_mov_b32 v61, v57
v_mov_b32 v62, v58
v_mov_b32 v63, v59
v_mov_b32_dpp v56, v64 row_ror:8 row_mask:0xf bank_mask:0xc
v_mov_b32_dpp v57, v65 row_ror:8 row_mask:0xf bank_mask:0xc
v_mov_b32_dpp v58, v66 row_ror:8 row_mask:0xf bank_mask:0xc
v_mov_b32_dpp v59, v67 row_ror:8 row_mask:0xf bank_mask:0xc
v_mov_b32_dpp v64, v60 row_ror:8 row_mask:0xf bank_mask:0x3
v_mov_b32_dpp v65, v61 row_ror:8 row_mask:0xf bank_mask:0x3
v_mov_b32_dpp v66, v62 row_ror:8 row_mask:0xf bank_mask:0x3
v_mov_b32_dpp v67, v63 row_ror:8 row_mask:0xf bank_mask:0x3
buffer_store_dwordx4 v[56:59], v8, s[48:51], s77 offen sc1
s_add_u32 s77, s77, 16384
buffer_store_dwordx4 v[64:67], v8, s[48:51], s77 offen sc1
s_add_u32 s77, s77, 16384
L_end:
s_endpgm
L_xretry:
s_sub_u32 s72, s72, 1
s_cbranch_scc1 L_xgo
buffer_load_dwordx4 v[152:155], v16, s[44:47], s75 offen offset:0 sc1
buffer_load_dwordx4 v[156:159], v16, s[44:47], s75 offen offset:1024 sc1
buffer_load_dwordx4 v[160:163], v16, s[44:47], s75 offen offset:2048 sc1
buffer_load_dwordx4 v[164:167], v16, s[44:47], s75 offen offset:3072 sc1
s_waitcnt vmcnt(0)
s_branch L_xchk
L_spin_1:
s_mov_b32 vcc_hi, 0x80000
L_spinlp_3:
s_sleep 1
buffer_load_dword v1, off, s[52:55], s78 offset:0 sc1
s_waitcnt vmcnt(0)
v_readfirstlane_b32 vcc_lo, v1
s_sub_u32 vcc_hi, vcc_hi, 1
s_cbranch_scc1 L_spinbk_2
s_cmp_lt_u32 vcc_lo, s81
s_cbranch_scc1 L_spinlp_3
s_branch L_spinbk_2
L_spin_4:
s_mov_b32 vcc_hi, 0x80000
L_spinlp_6:
s_sleep 1
buffer_load_dword v1, off, s[52:55], s70 offset:0 sc1
s_waitcnt vmcnt(0)
v_readfirstlane_b32 vcc_lo, v1
s_sub_u32 vcc_hi, vcc_hi, 1
s_cbranch_scc1 L_spinbk_5
s_cmp_lt_u32 vcc_lo, s81
s_cbranch_scc1 L_spinlp_6
s_branch L_spinbk_5
L_hretry:
s_sub_u32 s72, s72, 1
s_cbranch_scc1 L_hgo
buffer_load_dwordx4 v[136:139], v16, s[44:47], s77 offen sc1
s_waitcnt vmcnt(0)
v_max3_u32 v1, v136, v137, v138
v_max_u32 v1, v1, v139
v_cmp_eq_u32 vcc, -1, v1
s_cbranch_vccnz L_hretry
s_branch L_hgo
L_spin_8:
s_mov_b32 vcc_hi, 0x80000
L_spinlp_10:
s_sleep 1
buffer_load_dword v19, off, s[52:55], s80 offset:0 sc1
s_waitcnt vmcnt(0)
v_readfirstlane_b32 vcc_lo, v19
s_sub_u32 vcc_hi, vcc_hi, 1
s_cbranch_scc1 L_spinbk_9
s_cmp_lt_u32 vcc_lo, s69
s_cbranch_scc1 L_spinlp_10
s_branch L_spinbk_9
L_spin_1012:
s_mov_b32 vcc_hi, 0x80000
L_spinlp_1014:
s_sleep 1
buffer_load_dword v19, off, s[52:55], s80 offset:0 sc1
s_waitcnt vmcnt(0)
v_readfirstlane_b32 vcc_lo, v19
s_sub_u32 vcc_hi, vcc_hi, 1
s_cbranch_scc1 L_spinbk_1013
s_cmp_lt_u32 vcc_lo, s69
s_cbranch_scc1 L_spinlp_1014
s_branch L_spinbk_1013
L_F1:
s_waitcnt lgkmcnt(7)
v_mfma_f32_16x16x32_bf16 v[104:107], a[144:147], v[40:43], 0
s_waitcnt lgkmcnt(6)
ds_read_b128 a[176:179], v2 offset:8192
v_cndmask_b32 v88, 0, v17, s[0:1]
v_mfma_f32_16x16x32_bf16 v[104:107], a[148:151], v[44:47], v[104:107]
s_waitcnt lgkmcnt(6)
ds_read_b128 a[180:183], v2 offset:9216
v_cndmask_b32 v89, 0, v17, s[4:5]
v_mfma_f32_16x16x32_bf16 v[104:107], a[152:155], v[48:51], v[104:107]
s_waitcnt lgkmcnt(6)
buffer_load_dwordx4 v16, s[32:35], s70 offen offset:2048 sc1 lds
v_mfma_f32_16x16x32_bf16 v[104:107], a[156:159], v[52:55], v[104:107]
ds_read_b128 a[184:187], v2 offset:10240
v_cndmask_b32 v90, 0, v17, s[6:7]
v_mfma_f32_16x16x32_bf16 v[120:123], a[156:159], v[68:71], 0
ds_read_b128 a[188:191], v2 offset:11264
v_cndmask_b32 v91, 0, v17, s[8:9]
v_mfma_f32_16x16x32_bf16 v[120:123], a[152:155], v[64:67], v[120:123]
ds_read_b128 a[192:195], v2 offset:12288
v_accvgpr_write_b32 a128, 0
v_mfma_f32_16x16x32_bf16 v[120:123], a[148:151], v[60:63], v[120:123]
ds_read_b128 a[196:199], v2 offset:13312
v_accvgpr_write_b32 a129, 0
v_mfma_f32_16x16x32_bf16 v[120:123], a[144:147], v[56:59], v[120:123]
ds_read_b128 a[200:203], v2 offset:14336
v_accvgpr_write_b32 a130, 0
v_mfma_f32_16x16x32_bf16 v[136:139], a[144:147], v[72:75], 0
ds_read_b128 a[204:207], v2 offset:15360
v_accvgpr_write_b32 a131, 0
v_mfma_f32_16x16x32_bf16 v[136:139], a[148:151], v[76:79], v[136:139]
buffer_load_dwordx4 v16, s[32:35], s70 offen offset:3072 sc1 lds
v_mfma_f32_16x16x32_bf16 v[136:139], a[152:155], v[80:83], v[136:139]
v_accvgpr_write_b32 a132, 0
v_accvgpr_write_b32 a133, 0
v_mfma_f32_16x16x32_bf16 v[136:139], a[156:159], v[84:87], v[136:139]
v_accvgpr_write_b32 a134, 0
v_accvgpr_write_b32 a135, 0
v_mfma_f32_16x16x32_bf16 v[88:91], a[156:159], v[36:39], v[88:91]
v_accvgpr_write_b32 a136, 0
v_accvgpr_write_b32 a137, 0
v_mfma_f32_16x16x32_bf16 v[88:91], a[152:155], v[32:35], v[88:91]
v_accvgpr_write_b32 a138, 0
v_accvgpr_write_b32 a139, 0
v_mfma_f32_16x16x32_bf16 v[88:91], a[148:151], v[28:31], v[88:91]
v_accvgpr_write_b32 a140, 0
v_accvgpr_write_b32 a141, 0
v_mfma_f32_16x16x32_bf16 v[88:91], a[144:147], v[24:27], v[88:91]
s_waitcnt lgkmcnt(0)
s_nop 1
v_max3_f32 v21, v104, v105, v106
v_max_f32 v21, v21, v107
v_max3_f32 v22, v120, v121, v122
v_max_f32 v22, v22, v123
v_max3_f32 v23, v136, v137, v138
v_max_f32 v23, v23, v139
v_max3_f32 v20, v88, v89, v90
v_max_f32 v20, v20, v91
v_mov_b32 v248, v20
v_mov_b32 v249, v21
v_mov_b32 v250, v22
v_mov_b32 v251, v23
v_permlane16_swap_b32 v248, v20
v_permlane16_swap_b32 v249, v21
v_permlane16_swap_b32 v250, v22
v_permlane16_swap_b32 v251, v23
v_max_f32 v20, v20, v248
v_max_f32 v21, v21, v249
v_max_f32 v22, v22, v250
v_max_f32 v23, v23, v251
v_mov_b32 v248, v20
v_mov_b32 v249, v21
v_mov_b32 v250, v22
v_mov_b32 v251, v23
v_permlane32_swap_b32 v248, v20
v_permlane32_swap_b32 v249, v21
v_permlane32_swap_b32 v250, v22
v_permlane32_swap_b32 v251, v23
v_max_f32 v20, v20, v248
v_max_f32 v21, v21, v249
v_max_f32 v22, v22, v250
v_max_f32 v23, v23, v251
s_cmp_eq_u32 s73, 0
s_cselect_b64 vcc, 0, -1
v_cndmask_b32 v20, v20, v252, vcc
v_cndmask_b32 v21, v21, v253, vcc
v_cndmask_b32 v22, v22, v254, vcc
v_cndmask_b32 v23, v23, v255, vcc
v_sub_f32 v228, 0, v23
v_sub_f32 v229, 0, v23
v_sub_f32 v230, 0, v23
v_sub_f32 v231, 0, v23
v_sub_f32 v224, 0, v22
v_sub_f32 v225, 0, v22
v_sub_f32 v226, 0, v22
v_sub_f32 v227, 0, v22
v_sub_f32 v220, 0, v21
v_sub_f32 v221, 0, v21
v_sub_f32 v222, 0, v21
v_sub_f32 v223, 0, v21
v_sub_f32 v216, 0, v20
v_sub_f32 v217, 0, v20
v_sub_f32 v218, 0, v20
v_sub_f32 v219, 0, v20
v_mfma_f32_16x16x32_bf16 v[140:143], a[160:163], v[72:75], v[228:231]
s_add_u32 m0, s71, 4096
v_add_f32 v104, v104, v220
v_add_f32 v105, v105, v220
v_mfma_f32_16x16x32_bf16 v[140:143], a[164:167], v[76:79], v[140:143]
v_add_f32 v106, v106, v220
v_add_f32 v107, v107, v220
v_exp_f32 v104, v104
v_mfma_f32_16x16x32_bf16 v[140:143], a[168:171], v[80:83], v[140:143]
s_add_u32 s64, s70, 4096
v_exp_f32 v105, v105
v_mfma_f32_16x16x32_bf16 v[140:143], a[172:175], v[84:87], v[140:143]
buffer_load_dwordx4 v16, s[32:35], s64 offen offset:0 sc1 lds
v_mfma_f32_16x16x32_bf16 v[124:127], a[172:175], v[68:71], v[224:227]
v_exp_f32 v106, v106
v_mfma_f32_16x16x32_bf16 v[124:127], a[168:171], v[64:67], v[124:127]
v_exp_f32 v107, v107
v_mfma_f32_16x16x32_bf16 v[124:127], a[164:167], v[60:63], v[124:127]
v_add_f32 v120, v120, v224
v_add_f32 v121, v121, v224
v_add_f32 v122, v122, v224
v_add_f32 v123, v123, v224
v_exp_f32 v120, v120
v_mfma_f32_16x16x32_bf16 v[124:127], a[160:163], v[56:59], v[124:127]
v_exp_f32 v121, v121
v_mfma_f32_16x16x32_bf16 v[108:111], a[160:163], v[40:43], v[220:223]
v_exp_f32 v122, v122
v_mfma_f32_16x16x32_bf16 v[108:111], a[164:167], v[44:47], v[108:111]
v_cndmask_b32 v92, v216, v17, s[10:11]
v_cndmask_b32 v93, v216, v17, s[12:13]
v_cndmask_b32 v94, v216, v17, s[18:19]
v_cndmask_b32 v95, v216, v17, s[22:23]
v_mfma_f32_16x16x32_bf16 v[108:111], a[168:171], v[48:51], v[108:111]
buffer_load_dwordx4 v16, s[32:35], s64 offen offset:1024 sc1 lds
v_cvt_pk_bf16_f32 v160, v104, v105
v_mfma_f32_16x16x32_bf16 v[108:111], a[172:175], v[52:55], v[108:111]
v_exp_f32 v123, v123
v_mfma_f32_16x16x32_bf16 v[92:95], a[172:175], v[36:39], v[92:95]
v_add_f32 v136, v136, v228
v_add_f32 v137, v137, v228
v_add_f32 v138, v138, v228
v_add_f32 v139, v139, v228
v_exp_f32 v136, v136
v_mfma_f32_16x16x32_bf16 v[92:95], a[168:171], v[32:35], v[92:95]
v_cvt_pk_bf16_f32 v161, v106, v107
v_exp_f32 v137, v137
v_cndmask_b32 v96, v216, v17, s[26:27]
v_cndmask_b32 v97, v216, v17, s[56:57]
v_cndmask_b32 v98, v216, v17, s[58:59]
v_cndmask_b32 v99, v216, v17, s[60:61]
v_mfma_f32_16x16x32_bf16 v[92:95], a[164:167], v[28:31], v[92:95]
v_exp_f32 v138, v138
v_mfma_f32_16x16x32_bf16 v[92:95], a[160:163], v[24:27], v[92:95]
v_exp_f32 v139, v139
v_mfma_f32_16x16x32_bf16 v[96:99], a[176:179], v[24:27], v[96:99]
v_cvt_pk_bf16_f32 v184, v120, v121
v_add_f32 v88, v88, v216
v_mfma_f32_16x16x32_bf16 v[96:99], a[180:183], v[28:31], v[96:99]
buffer_load_dwordx4 v16, s[32:35], s64 offen offset:2048 sc1 lds
v_add_f32 v89, v89, v216
v_add_f32 v90, v90, v216
v_add_f32 v91, v91, v216
v_exp_f32 v88, v88
v_mfma_f32_16x16x32_bf16 v[96:99], a[184:187], v[32:35], v[96:99]
v_exp_f32 v89, v89
v_mfma_f32_16x16x32_bf16 v[96:99], a[188:191], v[36:39], v[96:99]
v_cvt_pk_bf16_f32 v185, v122, v123
v_cvt_pk_bf16_f32 v192, v136, v137
v_mfma_f32_16x16x32_bf16 v[112:115], a[188:191], v[52:55], v[220:223]
v_exp_f32 v90, v90
v_mfma_f32_16x16x32_bf16 v[112:115], a[184:187], v[48:51], v[112:115]
v_exp_f32 v91, v91
v_mfma_f32_16x16x32_bf16 v[112:115], a[180:183], v[44:47], v[112:115]
v_exp_f32 v140, v140
v_mfma_f32_16x16x32_bf16 v[112:115], a[176:179], v[40:43], v[112:115]
v_exp_f32 v141, v141
v_mfma_f32_16x16x32_bf16 v[128:131], a[176:179], v[56:59], v[224:227]
buffer_load_dwordx4 v16, s[32:35], s64 offen offset:3072 sc1 lds
v_cvt_pk_bf16_f32 v193, v138, v139
v_mfma_f32_16x16x32_bf16 v[128:131], a[180:183], v[60:63], v[128:131]
v_exp_f32 v142, v142
v_mfma_f32_16x16x32_bf16 v[128:131], a[184:187], v[64:67], v[128:131]
v_exp_f32 v143, v143
v_mfma_f32_16x16x32_bf16 v[128:131], a[188:191], v[68:71], v[128:131]
v_cvt_pk_bf16_f32 v152, v88, v89
v_cvt_pk_bf16_f32 v153, v90, v91
v_mfma_f32_16x16x32_bf16 v[144:147], a[188:191], v[84:87], v[228:231]
v_exp_f32 v124, v124
v_mfma_f32_16x16x32_bf16 v[144:147], a[184:187], v[80:83], v[144:147]
v_exp_f32 v125, v125
v_mfma_f32_16x16x32_bf16 v[144:147], a[180:183], v[76:79], v[144:147]
s_waitcnt vmcnt(6)
s_barrier
v_mfma_f32_16x16x32_bf16 v[144:147], a[176:179], v[72:75], v[144:147]
v_exp_f32 v126, v126
v_mfma_f32_16x16x32_bf16 v[148:151], a[192:195], v[72:75], v[228:231]
v_cvt_pk_bf16_f32 v194, v140, v141
v_cvt_pk_bf16_f32 v195, v142, v143
v_mfma_f32_16x16x32_bf16 v[148:151], a[196:199], v[76:79], v[148:151]
v_exp_f32 v127, v127
v_mfma_f32_16x16x32_bf16 v[148:151], a[200:203], v[80:83], v[148:151]
s_xor_b32 s71, s71, 16384
v_exp_f32 v108, v108
v_mfma_f32_16x16x32_bf16 v[148:151], a[204:207], v[84:87], v[148:151]
s_add_u32 s70, s70, 32768
v_exp_f32 v109, v109
v_mfma_f32_16x16x32_bf16 v[132:135], a[204:207], v[68:71], v[224:227]
s_mov_b32 m0, s71
v_exp_f32 v110, v110
v_mfma_f32_16x16x32_bf16 v[132:135], a[200:203], v[64:67], v[132:135]
buffer_load_dwordx4 v16, s[32:35], s70 offen offset:0 sc1 lds
v_mfma_f32_16x16x32_bf16 v[132:135], a[196:199], v[60:63], v[132:135]
v_cvt_pk_bf16_f32 v186, v124, v125
v_exp_f32 v111, v111
v_mfma_f32_16x16x32_bf16 v[132:135], a[192:195], v[56:59], v[132:135]
v_exp_f32 v92, v92
v_mfma_f32_16x16x32_bf16 v[116:119], a[192:195], v[40:43], v[220:223]
ds_read_b128 a[144:147], v2 offset:16384
v_cndmask_b32 v100, v216, v17, s[62:63]
v_mfma_f32_16x16x32_bf16 v[116:119], a[196:199], v[44:47], v[116:119]
ds_read_b128 a[148:151], v2 offset:17408
v_cndmask_b32 v101, v216, v17, s[48:49]
v_cndmask_b32 v102, v216, v17, s[50:51]
v_cndmask_b32 v103, v216, v17, s[100:101]
v_cvt_pk_bf16_f32 v187, v126, v127
v_exp_f32 v93, v93
v_mfma_f32_16x16x32_bf16 v[116:119], a[200:203], v[48:51], v[116:119]
v_exp_f32 v94, v94
v_mfma_f32_16x16x32_bf16 v[116:119], a[204:207], v[52:55], v[116:119]
ds_read_b128 a[152:155], v2 offset:18432
v_cvt_pk_bf16_f32 v162, v108, v109
v_mfma_f32_16x16x32_bf16 v[100:103], a[204:207], v[36:39], v[100:103]
buffer_load_dwordx4 v16, s[32:35], s70 offen offset:1024 sc1 lds
v_exp_f32 v95, v95
v_mfma_f32_16x16x32_bf16 v[100:103], a[200:203], v[32:35], v[100:103]
ds_read_b128 a[156:159], v2 offset:19456
v_exp_f32 v96, v96
v_mfma_f32_16x16x32_bf16 v[100:103], a[196:199], v[28:31], v[100:103]
v_cvt_pk_bf16_f32 v163, v110, v111
v_exp_f32 v97, v97
v_mfma_f32_16x16x32_bf16 v[100:103], a[192:195], v[24:27], v[100:103]
s_waitcnt lgkmcnt(2)
ds_read_b128 a[160:163], v2 offset:20480
ds_read_b128 a[164:167], v2 offset:21504
ds_read_b128 a[168:171], v2 offset:22528
ds_read_b128 a[172:175], v2 offset:23552
v_mfma_f32_16x16x32_bf16 v[120:123], a[144:147], v[56:59], v[224:227]
v_exp_f32 v98, v98
v_mfma_f32_16x16x32_bf16 v[120:123], a[148:151], v[60:63], v[120:123]
s_waitcnt lgkmcnt(5)
v_cvt_pk_bf16_f32 v154, v92, v93
v_exp_f32 v99, v99
v_mfma_f32_16x16x32_bf16 v[120:123], a[152:155], v[64:67], v[120:123]
s_waitcnt lgkmcnt(4)
v_exp_f32 v112, v112
v_mfma_f32_16x16x32_bf16 v[120:123], a[156:159], v[68:71], v[120:123]
v_exp_f32 v113, v113
v_mfma_f32_16x16x32_bf16 v[136:139], a[156:159], v[84:87], v[228:231]
v_cvt_pk_bf16_f32 v155, v94, v95
v_cndmask_b32 v104, v220, v17, s[0:1]
v_mfma_f32_16x16x32_bf16 v[136:139], a[152:155], v[80:83], v[136:139]
ds_read_b128 a[176:179], v2 offset:24576
buffer_load_dwordx4 v16, s[32:35], s70 offen offset:2048 sc1 lds
v_cndmask_b32 v105, v220, v17, s[4:5]
v_cndmask_b32 v106, v220, v17, s[6:7]
v_cndmask_b32 v107, v220, v17, s[8:9]
v_exp_f32 v114, v114
v_mfma_f32_16x16x32_bf16 v[136:139], a[148:151], v[76:79], v[136:139]
v_cvt_pk_bf16_f32 v156, v96, v97
v_cvt_pk_bf16_f32 v157, v98, v99
v_mfma_f32_16x16x32_bf16 v[136:139], a[144:147], v[72:75], v[136:139]
v_exp_f32 v115, v115
v_mfma_f32_16x16x32_bf16 v[104:107], a[144:147], v[40:43], v[104:107]
v_exp_f32 v128, v128
v_mfma_f32_16x16x32_bf16 v[104:107], a[148:151], v[44:47], v[104:107]
v_exp_f32 v129, v129
v_mfma_f32_16x16x32_bf16 v[104:107], a[152:155], v[48:51], v[104:107]
v_exp_f32 v130, v130
v_mfma_f32_16x16x32_bf16 v[104:107], a[156:159], v[52:55], v[104:107]
s_waitcnt lgkmcnt(0)
v_exp_f32 v131, v131
v_mfma_f32_16x16x32_bf16 v[140:143], a[172:175], v[84:87], v[228:231]
v_cvt_pk_bf16_f32 v164, v112, v113
v_cvt_pk_bf16_f32 v165, v114, v115
v_mfma_f32_16x16x32_bf16 v[140:143], a[168:171], v[80:83], v[140:143]
v_exp_f32 v144, v144
v_mfma_f32_16x16x32_bf16 v[140:143], a[164:167], v[76:79], v[140:143]
v_exp_f32 v145, v145
v_mfma_f32_16x16x32_bf16 v[140:143], a[160:163], v[72:75], v[140:143]
v_exp_f32 v146, v146
v_mfma_f32_16x16x32_bf16 v[124:127], a[160:163], v[56:59], v[224:227]
ds_read_b128 a[180:183], v2 offset:25600
v_cndmask_b32 v108, v220, v17, s[10:11]
v_mfma_f32_16x16x32_bf16 v[124:127], a[164:167], v[60:63], v[124:127]
ds_read_b128 a[184:187], v2 offset:26624
buffer_load_dwordx4 v16, s[32:35], s70 offen offset:3072 sc1 lds
v_cndmask_b32 v109, v220, v17, s[12:13]
v_cndmask_b32 v110, v220, v17, s[18:19]
v_cndmask_b32 v111, v220, v17, s[22:23]
v_cvt_pk_bf16_f32 v188, v128, v129
v_mfma_f32_16x16x32_bf16 v[124:127], a[168:171], v[64:67], v[124:127]
s_add_u32 m0, s86, 131072
v_exp_f32 v147, v147
v_mfma_f32_16x16x32_bf16 v[124:127], a[172:175], v[68:71], v[124:127]
s_add_u32 s64, s85, 0
ds_read_b128 a[188:191], v2 offset:27648
v_exp_f32 v148, v148
v_mfma_f32_16x16x32_bf16 v[108:111], a[172:175], v[52:55], v[108:111]
buffer_load_dwordx4 v12, s[36:39], s64 offen lds
v_cvt_pk_bf16_f32 v189, v130, v131
v_exp_f32 v149, v149
v_mfma_f32_16x16x32_bf16 v[108:111], a[168:171], v[48:51], v[108:111]
s_add_u32 m0, s86, 132096
ds_read_b128 a[192:195], v2 offset:28672
v_cndmask_b32 v112, v220, v17, s[26:27]
v_cndmask_b32 v113, v220, v17, s[56:57]
v_cndmask_b32 v114, v220, v17, s[58:59]
v_cndmask_b32 v115, v220, v17, s[60:61]
v_mfma_f32_16x16x32_bf16 v[108:111], a[164:167], v[44:47], v[108:111]
s_add_u32 s64, s85, 8192
v_exp_f32 v150, v150
v_mfma_f32_16x16x32_bf16 v[108:111], a[160:163], v[40:43], v[108:111]
buffer_load_dwordx4 v13, s[36:39], s64 offen lds
v_cvt_pk_bf16_f32 v196, v144, v145
v_exp_f32 v151, v151
v_mfma_f32_16x16x32_bf16 v[112:115], a[176:179], v[40:43], v[112:115]
s_waitcnt lgkmcnt(2)
s_add_u32 m0, s86, 133120
v_exp_f32 v132, v132
v_mfma_f32_16x16x32_bf16 v[112:115], a[180:183], v[44:47], v[112:115]
s_add_u32 s64, s85, 16384
v_exp_f32 v133, v133
v_mfma_f32_16x16x32_bf16 v[112:115], a[184:187], v[48:51], v[112:115]
s_waitcnt lgkmcnt(1)
buffer_load_dwordx4 v12, s[36:39], s64 offen lds
v_cvt_pk_bf16_f32 v197, v146, v147
v_mfma_f32_16x16x32_bf16 v[112:115], a[188:191], v[52:55], v[112:115]
s_add_u32 m0, s86, 134144
v_exp_f32 v134, v134
v_mfma_f32_16x16x32_bf16 v[128:131], a[188:191], v[68:71], v[224:227]
s_add_u32 s64, s85, 24576
ds_read_b128 a[196:199], v2 offset:29696
ds_read_b128 a[200:203], v2 offset:30720
ds_read_b128 a[204:207], v2 offset:31744
v_cvt_pk_bf16_f32 v198, v148, v149
v_mfma_f32_16x16x32_bf16 v[128:131], a[184:187], v[64:67], v[128:131]
buffer_load_dwordx4 v13, s[36:39], s64 offen lds
v_exp_f32 v135, v135
v_mfma_f32_16x16x32_bf16 v[128:131], a[180:183], v[60:63], v[128:131]
s_add_u32 m0, s71, 4096
v_exp_f32 v116, v116
v_mfma_f32_16x16x32_bf16 v[128:131], a[176:179], v[56:59], v[128:131]
s_add_u32 s64, s70, 4096
v_cvt_pk_bf16_f32 v199, v150, v151
v_exp_f32 v117, v117
v_mfma_f32_16x16x32_bf16 v[144:147], a[176:179], v[72:75], v[228:231]
buffer_load_dwordx4 v16, s[32:35], s64 offen offset:0 sc1 lds
v_mfma_f32_16x16x32_bf16 v[144:147], a[180:183], v[76:79], v[144:147]
v_exp_f32 v118, v118
v_mfma_f32_16x16x32_bf16 v[144:147], a[184:187], v[80:83], v[144:147]
v_cvt_pk_bf16_f32 v190, v132, v133
v_exp_f32 v119, v119
v_mfma_f32_16x16x32_bf16 v[144:147], a[188:191], v[84:87], v[144:147]
s_waitcnt lgkmcnt(0)
v_exp_f32 v100, v100
v_mfma_f32_16x16x32_bf16 v[148:151], a[204:207], v[84:87], v[228:231]
v_exp_f32 v101, v101
v_mfma_f32_16x16x32_bf16 v[148:151], a[200:203], v[80:83], v[148:151]
v_cvt_pk_bf16_f32 v191, v134, v135
v_cvt_pk_bf16_f32 v166, v116, v117
v_cvt_pk_bf16_f32 v167, v118, v119
v_mfma_f32_16x16x32_bf16 v[148:151], a[196:199], v[76:79], v[148:151]
v_exp_f32 v102, v102
v_mfma_f32_16x16x32_bf16 v[148:151], a[192:195], v[72:75], v[148:151]
v_exp_f32 v103, v103
v_mfma_f32_16x16x32_bf16 v[132:135], a[192:195], v[56:59], v[224:227]
s_lshl_b32 s66, s30, 30
ds_read_b128 a[144:147], v3 offset:16384
v_cndmask_b32 v116, v220, v17, s[62:63]
v_mfma_f32_16x16x32_bf16 v[132:135], a[196:199], v[60:63], v[132:135]
ds_read_b128 a[148:151], v3 offset:24576
v_cndmask_b32 v117, v220, v17, s[48:49]
v_cndmask_b32 v118, v220, v17, s[50:51]
v_cndmask_b32 v119, v220, v17, s[100:101]
v_exp_f32 v120, v120
v_mfma_f32_16x16x32_bf16 v[132:135], a[200:203], v[64:67], v[132:135]
v_exp_f32 v121, v121
v_mfma_f32_16x16x32_bf16 v[132:135], a[204:207], v[68:71], v[132:135]
v_exp_f32 v122, v122
v_mfma_f32_16x16x32_bf16 v[116:119], a[204:207], v[52:55], v[116:119]
ds_read_b128 a[152:155], v3 offset:17408
v_accvgpr_write_b32 a142, 0
v_mfma_f32_16x16x32_bf16 v[116:119], a[200:203], v[48:51], v[116:119]
ds_read_b128 a[156:159], v3 offset:25600
buffer_load_dwordx4 v16, s[32:35], s64 offen offset:1024 sc1 lds
v_accvgpr_write_b32 a143, 0
v_cvt_pk_bf16_f32 v158, v100, v101
v_cvt_pk_bf16_f32 v159, v102, v103
v_mfma_f32_16x16x32_bf16 v[116:119], a[196:199], v[44:47], v[116:119]
v_exp_f32 v123, v123
v_mfma_f32_16x16x32_bf16 v[116:119], a[192:195], v[40:43], v[116:119]
v_exp_f32 v136, v136
v_smfmac_f32_16x16x64_bf16 a[128:131], a[240:243], v[152:159], v5
ds_read_b128 a[160:163], v3 offset:18432
v_smfmac_f32_16x16x64_bf16 a[132:135], a[240:243], v[160:167], v5
v_exp_f32 v137, v137
v_smfmac_f32_16x16x64_bf16 a[136:139], a[240:243], v[184:191], v5
v_exp_f32 v138, v138
v_smfmac_f32_16x16x64_bf16 a[140:143], a[240:243], v[192:199], v5
s_waitcnt lgkmcnt(1)
v_cvt_pk_bf16_f32 v200, v120, v121
v_mfma_f32_16x16x32_bf16 a[0:3], a[144:147], v[152:155], 0
v_exp_f32 v139, v139
v_mfma_f32_16x16x32_bf16 a[0:3], a[148:151], v[156:159], a[0:3]
v_exp_f32 v104, v104
v_mfma_f32_16x16x32_bf16 a[32:35], a[148:151], v[164:167], 0
v_cvt_pk_bf16_f32 v201, v122, v123
v_cvt_pk_bf16_f32 v208, v136, v137
v_mfma_f32_16x16x32_bf16 a[32:35], a[144:147], v[160:163], a[32:35]
v_exp_f32 v105, v105
v_mfma_f32_16x16x32_bf16 a[64:67], a[144:147], v[184:187], 0
v_exp_f32 v106, v106
v_mfma_f32_16x16x32_bf16 a[64:67], a[148:151], v[188:191], a[64:67]
v_exp_f32 v107, v107
v_mfma_f32_16x16x32_bf16 a[96:99], a[148:151], v[196:199], 0
buffer_load_dwordx4 v16, s[32:35], s64 offen offset:2048 sc1 lds
v_mfma_f32_16x16x32_bf16 a[96:99], a[144:147], v[192:195], a[96:99]
v_exp_f32 v140, v140
v_mfma_f32_16x16x32_bf16 a[100:103], a[152:155], v[192:195], 0
ds_read_b128 a[164:167], v3 offset:26624
v_cvt_pk_bf16_f32 v209, v138, v139
v_mfma_f32_16x16x32_bf16 a[100:103], a[156:159], v[196:199], a[100:103]
v_exp_f32 v141, v141
v_mfma_f32_16x16x32_bf16 a[68:71], a[156:159], v[188:191], 0
v_exp_f32 v142, v142
v_mfma_f32_16x16x32_bf16 a[68:71], a[152:155], v[184:187], a[68:71]
v_cvt_pk_bf16_f32 v176, v104, v105
v_cvt_pk_bf16_f32 v177, v106, v107
v_mfma_f32_16x16x32_bf16 a[36:39], a[152:155], v[160:163], 0
v_exp_f32 v143, v143
v_mfma_f32_16x16x32_bf16 a[36:39], a[156:159], v[164:167], a[36:39]
v_exp_f32 v124, v124
v_mfma_f32_16x16x32_bf16 a[4:7], a[156:159], v[156:159], 0
v_exp_f32 v125, v125
v_mfma_f32_16x16x32_bf16 a[4:7], a[152:155], v[152:155], a[4:7]
s_waitcnt lgkmcnt(0)
ds_read_b128 a[168:171], v3 offset:19456
v_cvt_pk_bf16_f32 v210, v140, v141
v_mfma_f32_16x16x32_bf16 a[8:11], a[160:163], v[152:155], 0
v_exp_f32 v126, v126
v_mfma_f32_16x16x32_bf16 a[8:11], a[164:167], v[156:159], a[8:11]
ds_read_b128 a[172:175], v3 offset:27648
v_cvt_pk_bf16_f32 v211, v142, v143
v_mfma_f32_16x16x32_bf16 a[40:43], a[164:167], v[164:167], 0
v_exp_f32 v127, v127
v_mfma_f32_16x16x32_bf16 a[40:43], a[160:163], v[160:163], a[40:43]
v_exp_f32 v108, v108
v_mfma_f32_16x16x32_bf16 a[72:75], a[160:163], v[184:187], 0
buffer_load_dwordx4 v16, s[32:35], s64 offen offset:3072 sc1 lds
v_mfma_f32_16x16x32_bf16 a[72:75], a[164:167], v[188:191], a[72:75]
v_exp_f32 v109, v109
v_mfma_f32_16x16x32_bf16 a[104:107], a[164:167], v[196:199], 0
v_exp_f32 v110, v110
v_mfma_f32_16x16x32_bf16 a[104:107], a[160:163], v[192:195], a[104:107]
s_waitcnt lgkmcnt(0)
ds_read_b128 a[176:179], v3 offset:20480
v_cvt_pk_bf16_f32 v202, v124, v125
v_mfma_f32_16x16x32_bf16 a[108:111], a[168:171], v[192:195], 0
v_exp_f32 v111, v111
v_mfma_f32_16x16x32_bf16 a[108:111], a[172:175], v[196:199], a[108:111]
ds_read_b128 a[180:183], v3 offset:28672
v_cvt_pk_bf16_f32 v203, v126, v127
v_mfma_f32_16x16x32_bf16 a[76:79], a[172:175], v[188:191], 0
s_add_u32 m0, s86, 135168
v_exp_f32 v112, v112
v_mfma_f32_16x16x32_bf16 a[76:79], a[168:171], v[184:187], a[76:79]
s_add_u32 s64, s85, 32768
v_exp_f32 v113, v113
v_mfma_f32_16x16x32_bf16 a[44:47], a[168:171], v[160:163], 0
buffer_load_dwordx4 v12, s[36:39], s64 offen lds
v_mfma_f32_16x16x32_bf16 a[44:47], a[172:175], v[164:167], a[44:47]
s_add_u32 m0, s86, 136192
v_cvt_pk_bf16_f32 v178, v108, v109
v_exp_f32 v114, v114
v_mfma_f32_16x16x32_bf16 a[12:15], a[172:175], v[156:159], 0
s_add_u32 s64, s85, 40960
v_exp_f32 v115, v115
v_mfma_f32_16x16x32_bf16 a[12:15], a[168:171], v[152:155], a[12:15]
s_waitcnt lgkmcnt(0)
buffer_load_dwordx4 v13, s[36:39], s64 offen lds
v_mfma_f32_16x16x32_bf16 a[16:19], a[176:179], v[152:155], 0
s_add_u32 m0, s86, 137216
ds_read_b128 a[184:187], v3 offset:21504
ds_read_b128 a[188:191], v3 offset:29696
ds_read_b128 a[192:195], v3 offset:22528
ds_read_b128 a[196:199], v3 offset:30720
ds_read_b128 a[200:203], v3 offset:23552
ds_read_b128 a[204:207], v3 offset:31744
v_xor_b32 v2, 0x8000, v2
v_exp_f32 v128, v128
v_mfma_f32_16x16x32_bf16 a[16:19], a[180:183], v[156:159], a[16:19]
s_waitcnt vmcnt(14)
s_barrier
s_add_u32 s64, s85, 49152
v_cvt_pk_bf16_f32 v179, v110, v111
v_mfma_f32_16x16x32_bf16 a[48:51], a[180:183], v[164:167], 0
buffer_load_dwordx4 v12, s[36:39], s64 offen lds
v_exp_f32 v129, v129
v_mfma_f32_16x16x32_bf16 a[48:51], a[176:179], v[160:163], a[48:51]
s_add_u32 m0, s86, 138240
v_exp_f32 v130, v130
v_mfma_f32_16x16x32_bf16 a[80:83], a[176:179], v[184:187], 0
s_add_u32 s64, s85, 57344
v_cvt_pk_bf16_f32 v180, v112, v113
v_cvt_pk_bf16_f32 v181, v114, v115
v_mfma_f32_16x16x32_bf16 a[80:83], a[180:183], v[188:191], a[80:83]
buffer_load_dwordx4 v13, s[36:39], s64 offen lds
v_exp_f32 v131, v131
v_mfma_f32_16x16x32_bf16 a[112:115], a[180:183], v[196:199], 0
v_exp_f32 v144, v144
v_mfma_f32_16x16x32_bf16 a[112:115], a[176:179], v[192:195], a[112:115]
s_waitcnt lgkmcnt(0)
s_xor_b32 s71, s71, 49152
s_add_u32 s70, s70, 32768
s_mov_b32 m0, s71
v_exp_f32 v145, v145
v_mfma_f32_16x16x32_bf16 a[116:119], a[184:187], v[192:195], 0
buffer_load_dwordx4 v16, s[32:35], s70 offen offset:0 sc1 lds
v_mfma_f32_16x16x32_bf16 a[116:119], a[188:191], v[196:199], a[116:119]
v_exp_f32 v146, v146
v_mfma_f32_16x16x32_bf16 a[84:87], a[188:191], v[188:191], 0
v_cvt_pk_bf16_f32 v204, v128, v129
v_cvt_pk_bf16_f32 v205, v130, v131
v_mfma_f32_16x16x32_bf16 a[84:87], a[184:187], v[184:187], a[84:87]
v_exp_f32 v147, v147
v_mfma_f32_16x16x32_bf16 a[52:55], a[184:187], v[160:163], 0
v_exp_f32 v148, v148
v_mfma_f32_16x16x32_bf16 a[52:55], a[188:191], v[164:167], a[52:55]
v_exp_f32 v149, v149
v_mfma_f32_16x16x32_bf16 a[20:23], a[188:191], v[156:159], 0
ds_read_b128 a[144:147], v2 offset:0
v_lshl_add_u32 v19, v0, 24, s66
v_mfma_f32_16x16x32_bf16 a[20:23], a[184:187], v[152:155], a[20:23]
s_lshr_b32 s67, s31, 4
v_exp_f32 v150, v150
v_mfma_f32_16x16x32_bf16 a[24:27], a[192:195], v[152:155], 0
s_lshl1_add_u32 s67, s3, s67
v_cvt_pk_bf16_f32 v212, v144, v145
v_cvt_pk_bf16_f32 v213, v146, v147
v_mfma_f32_16x16x32_bf16 a[24:27], a[196:199], v[156:159], a[24:27]
s_lshl_b32 s79, s67, 8
v_exp_f32 v151, v151
v_mfma_f32_16x16x32_bf16 a[56:59], a[196:199], v[164:167], 0
s_add_u32 s79, s79, 8192
v_exp_f32 v132, v132
v_mfma_f32_16x16x32_bf16 a[56:59], a[192:195], v[160:163], a[56:59]
s_add_u32 s69, s31, 12
v_exp_f32 v133, v133
v_mfma_f32_16x16x32_bf16 a[88:91], a[192:195], v[184:187], 0
s_lshr_b32 s69, s69, 5
buffer_load_dwordx4 v16, s[32:35], s70 offen offset:1024 sc1 lds
v_mfma_f32_16x16x32_bf16 a[88:91], a[196:199], v[188:191], a[88:91]
s_lshl1_add_u32 s69, s3, s69
v_exp_f32 v134, v134
v_mfma_f32_16x16x32_bf16 a[120:123], a[196:199], v[196:199], 0
s_lshl_b32 s69, s69, 8
v_cvt_pk_bf16_f32 v214, v148, v149
v_cvt_pk_bf16_f32 v215, v150, v151
v_mfma_f32_16x16x32_bf16 a[120:123], a[192:195], v[192:195], a[120:123]
s_add_u32 s69, s69, 8192
v_exp_f32 v135, v135
v_mfma_f32_16x16x32_bf16 a[124:127], a[200:203], v[192:195], 0
s_lshl_b32 s67, s73, 16
v_exp_f32 v116, v116
v_mfma_f32_16x16x32_bf16 a[124:127], a[204:207], v[196:199], a[124:127]
s_xor_b32 s68, s80, 256
v_exp_f32 v117, v117
v_mfma_f32_16x16x32_bf16 a[92:95], a[204:207], v[188:191], 0
s_add_u32 s68, s68, s67
ds_read_b128 a[148:151], v2 offset:1024
v_cvt_pk_bf16_f32 v206, v132, v133
v_mfma_f32_16x16x32_bf16 a[92:95], a[200:203], v[184:187], a[92:95]
s_add_u32 s67, s67, s69
v_exp_f32 v118, v118
v_mfma_f32_16x16x32_bf16 a[60:63], a[200:203], v[160:163], 0
ds_read_b128 a[152:155], v2 offset:2048
v_cvt_pk_bf16_f32 v207, v134, v135
v_mfma_f32_16x16x32_bf16 a[60:63], a[204:207], v[164:167], a[60:63]
ds_read_b128 a[156:159], v2 offset:3072
v_cvt_pk_bf16_f32 v182, v116, v117
v_mfma_f32_16x16x32_bf16 a[28:31], a[204:207], v[156:159], 0
s_mov_b64 exec, 1
buffer_atomic_add a251, v19, s[52:55], s67 offen offset:0 sc1
buffer_atomic_add a251, v19, s[52:55], s68 offen offset:0 sc1
s_mov_b64 exec, -1
v_exp_f32 v119, v119
v_mfma_f32_16x16x32_bf16 a[28:31], a[200:203], v[152:155], a[28:31]
ds_read_b128 a[160:163], v2 offset:4096
ds_read_b128 a[164:167], v2 offset:5120
ds_read_b128 a[168:171], v2 offset:6144
ds_read_b128 a[172:175], v2 offset:7168
v_mul_u32_u24 v19, 52, v0
v_cvt_pk_bf16_f32 v183, v118, v119
v_xor_b32 v3, 0x8000, v3
v_accvgpr_read_b32 v20, a128
v_accvgpr_read_b32 v248, a129
v_add_f32 v20, v20, v248
v_max_f32 v1, v1, v20
v_rcp_f32 v20, v20
v_accvgpr_read_b32 v232, a0
v_accvgpr_read_b32 v233, a1
v_accvgpr_read_b32 v234, a2
v_accvgpr_read_b32 v235, a3
v_accvgpr_read_b32 v236, a4
v_accvgpr_read_b32 v237, a5
v_accvgpr_read_b32 v238, a6
v_accvgpr_read_b32 v239, a7
v_mul_f32 v20, v20, v4
v_mul_f32 v232, v232, v20
v_mul_f32 v233, v233, v20
v_mul_f32 v234, v234, v20
v_mul_f32 v235, v235, v20
v_mul_f32 v236, v236, v20
v_mul_f32 v237, v237, v20
v_mul_f32 v238, v238, v20
v_mul_f32 v239, v239, v20
v_cvt_pk_bf16_f32 v232, v232, v233
v_cvt_pk_bf16_f32 v233, v234, v235
v_cvt_pk_bf16_f32 v234, v236, v237
v_cvt_pk_bf16_f32 v235, v238, v239
s_add_u32 s77, s74, 0
buffer_store_dwordx4 v[232:235], v16, s[44:47], s77 offen sc1
v_accvgpr_read_b32 v240, a8
v_accvgpr_read_b32 v241, a9
v_accvgpr_read_b32 v242, a10
v_accvgpr_read_b32 v243, a11
v_accvgpr_read_b32 v244, a12
v_accvgpr_read_b32 v245, a13
v_accvgpr_read_b32 v246, a14
v_accvgpr_read_b32 v247, a15
v_mul_f32 v240, v240, v20
v_mul_f32 v241, v241, v20
v_mul_f32 v242, v242, v20
v_mul_f32 v243, v243, v20
v_mul_f32 v244, v244, v20
v_mul_f32 v245, v245, v20
v_mul_f32 v246, v246, v20
v_mul_f32 v247, v247, v20
v_cvt_pk_bf16_f32 v240, v240, v241
v_cvt_pk_bf16_f32 v241, v242, v243
v_cvt_pk_bf16_f32 v242, v244, v245
v_cvt_pk_bf16_f32 v243, v246, v247
s_add_u32 s77, s74, 8192
buffer_store_dwordx4 v[240:243], v16, s[44:47], s77 offen sc1
v_accvgpr_read_b32 v232, a16
v_accvgpr_read_b32 v233, a17
v_accvgpr_read_b32 v234, a18
v_accvgpr_read_b32 v235, a19
v_accvgpr_read_b32 v236, a20
v_accvgpr_read_b32 v237, a21
v_accvgpr_read_b32 v238, a22
v_accvgpr_read_b32 v239, a23
v_mul_f32 v232, v232, v20
v_mul_f32 v233, v233, v20
v_mul_f32 v234, v234, v20
v_mul_f32 v235, v235, v20
v_mul_f32 v236, v236, v20
v_mul_f32 v237, v237, v20
v_mul_f32 v238, v238, v20
v_mul_f32 v239, v239, v20
v_cvt_pk_bf16_f32 v232, v232, v233
v_cvt_pk_bf16_f32 v233, v234, v235
v_cvt_pk_bf16_f32 v234, v236, v237
v_cvt_pk_bf16_f32 v235, v238, v239
s_add_u32 s77, s74, 16384
buffer_store_dwordx4 v[232:235], v16, s[44:47], s77 offen sc1
s_branch L_T
L_T1:
buffer_load_dword v19, off, s[52:55], s80 sc1
s_waitcnt lgkmcnt(7)
v_mfma_f32_16x16x32_bf16 v[136:139], a[144:147], v[72:75], v[228:231]
s_waitcnt lgkmcnt(6)
ds_read_b128 a[176:179], v2 offset:8192
v_cndmask_b32 v120, v224, v17, s[0:1]
v_mfma_f32_16x16x32_bf16 v[136:139], a[148:151], v[76:79], v[136:139]
s_waitcnt lgkmcnt(6)
ds_read_b128 a[180:183], v2 offset:9216
v_cndmask_b32 v121, v224, v17, s[4:5]
v_cndmask_b32 v122, v224, v17, s[6:7]
v_cndmask_b32 v123, v224, v17, s[8:9]
v_mfma_f32_16x16x32_bf16 v[136:139], a[152:155], v[80:83], v[136:139]
s_waitcnt lgkmcnt(6)
buffer_load_dwordx4 v16, s[32:35], s70 offen offset:2048 sc1 lds
v_mfma_f32_16x16x32_bf16 v[136:139], a[156:159], v[84:87], v[136:139]
ds_read_b128 a[184:187], v2 offset:10240
v_cndmask_b32 v124, v224, v17, s[10:11]
v_mfma_f32_16x16x32_bf16 v[120:123], a[156:159], v[68:71], v[120:123]
ds_read_b128 a[188:191], v2 offset:11264
v_cndmask_b32 v125, v224, v17, s[12:13]
v_mfma_f32_16x16x32_bf16 v[120:123], a[152:155], v[64:67], v[120:123]
ds_read_b128 a[192:195], v2 offset:12288
v_cndmask_b32 v126, v224, v17, s[18:19]
v_mfma_f32_16x16x32_bf16 v[120:123], a[148:151], v[60:63], v[120:123]
ds_read_b128 a[196:199], v2 offset:13312
v_cndmask_b32 v127, v224, v17, s[22:23]
v_mfma_f32_16x16x32_bf16 v[120:123], a[144:147], v[56:59], v[120:123]
s_waitcnt lgkmcnt(4)
ds_read_b128 a[200:203], v2 offset:14336
v_cndmask_b32 v128, v224, v17, s[26:27]
v_mfma_f32_16x16x32_bf16 v[140:143], a[160:163], v[72:75], v[228:231]
ds_read_b128 a[204:207], v2 offset:15360
v_cndmask_b32 v129, v224, v17, s[56:57]
v_mfma_f32_16x16x32_bf16 v[140:143], a[164:167], v[76:79], v[140:143]
ds_read_b128 a[144:147], v3 offset:0
v_cndmask_b32 v130, v224, v17, s[58:59]
v_mfma_f32_16x16x32_bf16 v[140:143], a[168:171], v[80:83], v[140:143]
v_exp_f32 v136, v136
v_mfma_f32_16x16x32_bf16 v[140:143], a[172:175], v[84:87], v[140:143]
v_exp_f32 v137, v137
v_mfma_f32_16x16x32_bf16 v[124:127], a[172:175], v[68:71], v[124:127]
ds_read_b128 a[148:151], v3 offset:8192
v_cndmask_b32 v131, v224, v17, s[60:61]
v_mfma_f32_16x16x32_bf16 v[124:127], a[168:171], v[64:67], v[124:127]
v_exp_f32 v138, v138
v_mfma_f32_16x16x32_bf16 v[124:127], a[164:167], v[60:63], v[124:127]
s_mul_i32 s69, s83, 8
buffer_load_dwordx4 v16, s[32:35], s70 offen offset:3072 sc1 lds
v_mfma_f32_16x16x32_bf16 v[124:127], a[160:163], v[56:59], v[124:127]
s_sub_u32 s69, 36, s69
v_exp_f32 v139, v139
v_mfma_f32_16x16x32_bf16 v[128:131], a[176:179], v[56:59], v[128:131]
v_exp_f32 v120, v120
v_mfma_f32_16x16x32_bf16 v[128:131], a[180:183], v[60:63], v[128:131]
s_waitcnt lgkmcnt(1)
v_exp_f32 v121, v121
v_mfma_f32_16x16x32_bf16 v[128:131], a[184:187], v[64:67], v[128:131]
v_exp_f32 v122, v122
v_mfma_f32_16x16x32_bf16 v[128:131], a[188:191], v[68:71], v[128:131]
s_add_u32 m0, s71, 4096
ds_read_b128 a[152:155], v3 offset:1024
v_cndmask_b32 v132, v224, v17, s[62:63]
v_mfma_f32_16x16x32_bf16 v[144:147], a[188:191], v[84:87], v[228:231]
s_add_u32 s64, s70, 4096
v_cvt_pk_bf16_f32 v192, v136, v137
v_cndmask_b32 v133, v224, v17, s[48:49]
v_mfma_f32_16x16x32_bf16 v[144:147], a[184:187], v[80:83], v[144:147]
buffer_load_dwordx4 v16, s[32:35], s64 offen offset:0 sc1 lds
v_mfma_f32_16x16x32_bf16 v[144:147], a[180:183], v[76:79], v[144:147]
ds_read_b128 a[156:159], v3 offset:9216
v_cndmask_b32 v134, v224, v17, s[50:51]
v_mfma_f32_16x16x32_bf16 v[144:147], a[176:179], v[72:75], v[144:147]
ds_read_b128 a[160:163], v3 offset:2048
v_cndmask_b32 v135, v224, v17, s[100:101]
v_mfma_f32_16x16x32_bf16 v[148:151], a[192:195], v[72:75], v[228:231]
v_exp_f32 v123, v123
v_mfma_f32_16x16x32_bf16 v[148:151], a[196:199], v[76:79], v[148:151]
v_cvt_pk_bf16_f32 v193, v138, v139
v_cvt_pk_bf16_f32 v184, v120, v121
v_mfma_f32_16x16x32_bf16 v[148:151], a[200:203], v[80:83], v[148:151]
v_exp_f32 v140, v140
v_mfma_f32_16x16x32_bf16 v[148:151], a[204:207], v[84:87], v[148:151]
v_exp_f32 v141, v141
v_mfma_f32_16x16x32_bf16 v[132:135], a[204:207], v[68:71], v[132:135]
v_exp_f32 v142, v142
v_mfma_f32_16x16x32_bf16 v[132:135], a[200:203], v[64:67], v[132:135]
v_exp_f32 v143, v143
v_mfma_f32_16x16x32_bf16 v[132:135], a[196:199], v[60:63], v[132:135]
buffer_load_dwordx4 v16, s[32:35], s64 offen offset:1024 sc1 lds
v_mfma_f32_16x16x32_bf16 v[132:135], a[192:195], v[56:59], v[132:135]
v_exp_f32 v124, v124
v_smfmac_f32_16x16x64_bf16 a[132:135], a[240:243], v[176:183], v5
ds_read_b128 a[164:167], v3 offset:10240
v_smfmac_f32_16x16x64_bf16 a[136:139], a[240:243], v[200:207], v5
ds_read_b128 a[168:171], v3 offset:3072
v_accvgpr_read_b32 v240, a24
v_smfmac_f32_16x16x64_bf16 a[140:143], a[240:243], v[208:215], v5
v_cvt_pk_bf16_f32 v185, v122, v123
v_mfma_f32_16x16x32_bf16 a[32:35], a[144:147], v[176:179], a[32:35]
s_waitcnt lgkmcnt(2)
v_exp_f32 v125, v125
v_mfma_f32_16x16x32_bf16 a[32:35], a[148:151], v[180:183], a[32:35]
ds_read_b128 a[172:175], v3 offset:11264
v_accvgpr_read_b32 v241, a25
v_mfma_f32_16x16x32_bf16 a[64:67], a[148:151], v[204:207], a[64:67]
ds_read_b128 a[176:179], v3 offset:4096
v_accvgpr_read_b32 v242, a26
v_mfma_f32_16x16x32_bf16 a[64:67], a[144:147], v[200:203], a[64:67]
v_cvt_pk_bf16_f32 v194, v140, v141
v_accvgpr_read_b32 v243, a27
v_mfma_f32_16x16x32_bf16 a[96:99], a[144:147], v[208:211], a[96:99]
ds_read_b128 a[180:183], v3 offset:12288
v_accvgpr_read_b32 v244, a28
v_mfma_f32_16x16x32_bf16 a[96:99], a[148:151], v[212:215], a[96:99]
ds_read_b128 a[184:187], v3 offset:5120
v_accvgpr_read_b32 v245, a29
v_mfma_f32_16x16x32_bf16 a[100:103], a[156:159], v[212:215], a[100:103]
ds_read_b128 a[188:191], v3 offset:13312
v_accvgpr_read_b32 v246, a30
v_mfma_f32_16x16x32_bf16 a[100:103], a[152:155], v[208:211], a[100:103]
ds_read_b128 a[192:195], v3 offset:6144
v_accvgpr_read_b32 v247, a31
v_mul_f32 v240, v240, v20
v_mul_f32 v241, v241, v20
v_mul_f32 v242, v242, v20
v_mul_f32 v243, v243, v20
v_mul_f32 v244, v244, v20
v_mul_f32 v245, v245, v20
v_mul_f32 v246, v246, v20
v_mul_f32 v247, v247, v20
v_cvt_pk_bf16_f32 v240, v240, v241
v_cvt_pk_bf16_f32 v241, v242, v243
v_cvt_pk_bf16_f32 v242, v244, v245
v_cvt_pk_bf16_f32 v243, v246, v247
s_add_u32 s77, s74, 24576
buffer_store_dwordx4 v[240:243], v16, s[44:47], s77 offen sc1
v_exp_f32 v126, v126
v_mfma_f32_16x16x32_bf16 a[68:71], a[152:155], v[200:203], a[68:71]
buffer_load_dwordx4 v16, s[32:35], s64 offen offset:2048 sc1 lds
v_cvt_pk_bf16_f32 v195, v142, v143
v_mfma_f32_16x16x32_bf16 a[68:71], a[156:159], v[204:207], a[68:71]
v_exp_f32 v127, v127
v_mfma_f32_16x16x32_bf16 a[36:39], a[156:159], v[180:183], a[36:39]
v_exp_f32 v128, v128
v_mfma_f32_16x16x32_bf16 a[36:39], a[152:155], v[176:179], a[36:39]
v_exp_f32 v129, v129
v_mfma_f32_16x16x32_bf16 a[40:43], a[160:163], v[176:179], a[40:43]
s_waitcnt lgkmcnt(1)
v_cvt_pk_bf16_f32 v186, v124, v125
v_cvt_pk_bf16_f32 v187, v126, v127
v_mfma_f32_16x16x32_bf16 a[40:43], a[164:167], v[180:183], a[40:43]
v_exp_f32 v130, v130
v_mfma_f32_16x16x32_bf16 a[72:75], a[164:167], v[204:207], a[72:75]
buffer_load_dwordx4 v16, s[32:35], s64 offen offset:3072 sc1 lds
v_mfma_f32_16x16x32_bf16 a[72:75], a[160:163], v[200:203], a[72:75]
v_exp_f32 v131, v131
v_mfma_f32_16x16x32_bf16 a[104:107], a[160:163], v[208:211], a[104:107]
v_exp_f32 v144, v144
v_mfma_f32_16x16x32_bf16 a[104:107], a[164:167], v[212:215], a[104:107]
v_exp_f32 v145, v145
v_mfma_f32_16x16x32_bf16 a[108:111], a[172:175], v[212:215], a[108:111]
v_exp_f32 v146, v146
v_mfma_f32_16x16x32_bf16 a[108:111], a[168:171], v[208:211], a[108:111]
ds_read_b128 a[196:199], v3 offset:14336
v_cvt_pk_bf16_f32 v188, v128, v129
v_mfma_f32_16x16x32_bf16 a[76:79], a[168:171], v[200:203], a[76:79]
ds_read_b128 a[200:203], v3 offset:7168
v_cvt_pk_bf16_f32 v189, v130, v131
v_mfma_f32_16x16x32_bf16 a[76:79], a[172:175], v[204:207], a[76:79]
ds_read_b128 a[204:207], v3 offset:15360
v_cvt_pk_bf16_f32 v196, v144, v145
v_mfma_f32_16x16x32_bf16 a[44:47], a[172:175], v[180:183], a[44:47]
v_exp_f32 v147, v147
v_mfma_f32_16x16x32_bf16 a[44:47], a[168:171], v[176:179], a[44:47]
v_exp_f32 v148, v148
v_mfma_f32_16x16x32_bf16 a[48:51], a[176:179], v[176:179], a[48:51]
v_exp_f32 v149, v149
v_mfma_f32_16x16x32_bf16 a[48:51], a[180:183], v[180:183], a[48:51]
v_exp_f32 v150, v150
v_mfma_f32_16x16x32_bf16 a[80:83], a[180:183], v[204:207], a[80:83]
s_waitcnt vmcnt(10)
s_barrier
v_mfma_f32_16x16x32_bf16 a[80:83], a[176:179], v[200:203], a[80:83]
v_exp_f32 v151, v151
v_mfma_f32_16x16x32_bf16 a[112:115], a[176:179], v[208:211], a[112:115]
v_exp_f32 v132, v132
v_mfma_f32_16x16x32_bf16 a[112:115], a[180:183], v[212:215], a[112:115]
v_exp_f32 v133, v133
v_mfma_f32_16x16x32_bf16 a[116:119], a[188:191], v[212:215], a[116:119]
ds_read_b128 a[144:147], v2 offset:16384
v_cvt_pk_bf16_f32 v197, v146, v147
v_mfma_f32_16x16x32_bf16 a[116:119], a[184:187], v[208:211], a[116:119]
v_exp_f32 v134, v134
v_mfma_f32_16x16x32_bf16 a[84:87], a[184:187], v[200:203], a[84:87]
s_waitcnt vmcnt(7)
v_readfirstlane_b32 vcc_lo, v19
s_nop 0
s_cmp_lt_u32 vcc_lo, s69
s_cbranch_scc1 L_spin_1012
L_spinbk_1013:
v_mfma_f32_16x16x32_bf16 a[84:87], a[188:191], v[204:207], a[84:87]
ds_read_b128 a[148:151], v2 offset:17408
v_cvt_pk_bf16_f32 v198, v148, v149
v_mfma_f32_16x16x32_bf16 a[52:55], a[188:191], v[180:183], a[52:55]
ds_read_b128 a[152:155], v2 offset:18432
v_cvt_pk_bf16_f32 v199, v150, v151
v_mfma_f32_16x16x32_bf16 a[52:55], a[184:187], v[176:179], a[52:55]
s_waitcnt lgkmcnt(3)
ds_read_b128 a[156:159], v2 offset:19456
v_cndmask_b32 v136, v228, v17, s[0:1]
v_mfma_f32_16x16x32_bf16 a[56:59], a[192:195], v[176:179], a[56:59]
ds_read_b128 a[160:163], v2 offset:20480
v_cndmask_b32 v137, v228, v17, s[4:5]
v_mfma_f32_16x16x32_bf16 a[56:59], a[196:199], v[180:183], a[56:59]
ds_read_b128 a[164:167], v2 offset:21504
v_cndmask_b32 v138, v228, v17, s[6:7]
v_mfma_f32_16x16x32_bf16 a[88:91], a[196:199], v[204:207], a[88:91]
ds_read_b128 a[168:171], v2 offset:22528
v_cndmask_b32 v139, v228, v17, s[8:9]
v_mfma_f32_16x16x32_bf16 a[88:91], a[192:195], v[200:203], a[88:91]
v_exp_f32 v135, v135
v_mfma_f32_16x16x32_bf16 a[120:123], a[192:195], v[208:211], a[120:123]
ds_read_b128 a[172:175], v2 offset:23552
v_cvt_pk_bf16_f32 v190, v132, v133
v_mfma_f32_16x16x32_bf16 a[120:123], a[196:199], v[212:215], a[120:123]
v_cndmask_b32 v140, v228, v17, s[10:11]
v_cvt_pk_bf16_f32 v191, v134, v135
v_mfma_f32_16x16x32_bf16 a[124:127], a[204:207], v[212:215], a[124:127]
v_cndmask_b32 v141, v228, v17, s[12:13]
v_cndmask_b32 v142, v228, v17, s[18:19]
v_mfma_f32_16x16x32_bf16 a[124:127], a[200:203], v[208:211], a[124:127]
v_cndmask_b32 v143, v228, v17, s[22:23]
v_cndmask_b32 v144, v228, v17, s[26:27]
v_mfma_f32_16x16x32_bf16 a[92:95], a[200:203], v[200:203], a[92:95]
v_cndmask_b32 v145, v228, v17, s[56:57]
v_cndmask_b32 v146, v228, v17, s[58:59]
v_mfma_f32_16x16x32_bf16 a[92:95], a[204:207], v[204:207], a[92:95]
v_cndmask_b32 v147, v228, v17, s[60:61]
v_cndmask_b32 v148, v228, v17, s[62:63]
v_mfma_f32_16x16x32_bf16 a[60:63], a[204:207], v[180:183], a[60:63]
v_cndmask_b32 v149, v228, v17, s[48:49]
v_cndmask_b32 v150, v228, v17, s[50:51]
v_mfma_f32_16x16x32_bf16 a[60:63], a[200:203], v[176:179], a[60:63]
s_waitcnt lgkmcnt(0)
v_cndmask_b32 v151, v228, v17, s[100:101]
v_accvgpr_read_b32 v21, a132
v_mfma_f32_16x16x32_bf16 v[136:139], a[144:147], v[72:75], v[136:139]
ds_read_b128 a[176:179], v2 offset:24576
v_accvgpr_read_b32 v248, a133
v_mfma_f32_16x16x32_bf16 v[136:139], a[148:151], v[76:79], v[136:139]
ds_read_b128 a[180:183], v2 offset:25600
v_add_f32 v21, v21, v248
v_mfma_f32_16x16x32_bf16 v[136:139], a[152:155], v[80:83], v[136:139]
ds_read_b128 a[184:187], v2 offset:26624
v_max_f32 v1, v1, v21
v_mfma_f32_16x16x32_bf16 v[136:139], a[156:159], v[84:87], v[136:139]
ds_read_b128 a[188:191], v2 offset:27648
ds_read_b128 a[192:195], v2 offset:28672
v_mfma_f32_16x16x32_bf16 v[140:143], a[172:175], v[84:87], v[140:143]
ds_read_b128 a[196:199], v2 offset:29696
ds_read_b128 a[200:203], v2 offset:30720
ds_read_b128 a[204:207], v2 offset:31744
v_mfma_f32_16x16x32_bf16 v[140:143], a[168:171], v[80:83], v[140:143]
v_rcp_f32 v21, v21
v_mfma_f32_16x16x32_bf16 v[140:143], a[164:167], v[76:79], v[140:143]
ds_read_b128 a[144:147], v3 offset:16384
v_accvgpr_read_b32 v232, a32
v_mfma_f32_16x16x32_bf16 v[140:143], a[160:163], v[72:75], v[140:143]
s_waitcnt lgkmcnt(7)
ds_read_b128 a[148:151], v3 offset:24576
v_accvgpr_read_b32 v233, a33
v_mfma_f32_16x16x32_bf16 v[144:147], a[176:179], v[72:75], v[144:147]
ds_read_b128 a[152:155], v3 offset:17408
v_accvgpr_read_b32 v234, a34
v_mfma_f32_16x16x32_bf16 v[144:147], a[180:183], v[76:79], v[144:147]
s_waitcnt lgkmcnt(6)
ds_read_b128 a[156:159], v3 offset:25600
v_accvgpr_read_b32 v235, a35
v_mfma_f32_16x16x32_bf16 v[144:147], a[184:187], v[80:83], v[144:147]
ds_read_b128 a[160:163], v3 offset:18432
v_accvgpr_read_b32 v236, a36
v_accvgpr_read_b32 v237, a37
v_accvgpr_read_b32 v238, a38
v_accvgpr_read_b32 v239, a39
v_mul_f32 v21, v21, v6
v_mul_f32 v232, v232, v21
v_mul_f32 v233, v233, v21
v_mul_f32 v234, v234, v21
v_mul_f32 v235, v235, v21
v_mul_f32 v236, v236, v21
v_mul_f32 v237, v237, v21
v_mul_f32 v238, v238, v21
v_mul_f32 v239, v239, v21
v_cvt_pk_bf16_f32 v232, v232, v233
v_cvt_pk_bf16_f32 v233, v234, v235
v_cvt_pk_bf16_f32 v234, v236, v237
v_cvt_pk_bf16_f32 v235, v238, v239
s_add_u32 s77, s74, 4096
buffer_store_dwordx4 v[232:235], v16, s[44:47], s77 offen sc1
v_accvgpr_read_b32 v240, a40
v_accvgpr_read_b32 v241, a41
v_accvgpr_read_b32 v242, a42
v_accvgpr_read_b32 v243, a43
v_accvgpr_read_b32 v244, a44
v_accvgpr_read_b32 v245, a45
v_accvgpr_read_b32 v246, a46
v_accvgpr_read_b32 v247, a47
v_mul_f32 v240, v240, v21
v_mul_f32 v241, v241, v21
v_mul_f32 v242, v242, v21
v_mul_f32 v243, v243, v21
v_mul_f32 v244, v244, v21
v_mul_f32 v245, v245, v21
v_mul_f32 v246, v246, v21
v_mul_f32 v247, v247, v21
v_cvt_pk_bf16_f32 v240, v240, v241
v_cvt_pk_bf16_f32 v241, v242, v243
v_cvt_pk_bf16_f32 v242, v244, v245
v_cvt_pk_bf16_f32 v243, v246, v247
s_add_u32 s77, s74, 12288
buffer_store_dwordx4 v[240:243], v16, s[44:47], s77 offen sc1
v_accvgpr_read_b32 v232, a48
v_accvgpr_read_b32 v233, a49
v_accvgpr_read_b32 v234, a50
v_accvgpr_read_b32 v235, a51
v_accvgpr_read_b32 v236, a52
v_accvgpr_read_b32 v237, a53
v_accvgpr_read_b32 v238, a54
v_accvgpr_read_b32 v239, a55
v_mul_f32 v232, v232, v21
v_mul_f32 v233, v233, v21
v_mul_f32 v234, v234, v21
v_mul_f32 v235, v235, v21
v_mul_f32 v236, v236, v21
v_mul_f32 v237, v237, v21
v_mul_f32 v238, v238, v21
v_mul_f32 v239, v239, v21
v_cvt_pk_bf16_f32 v232, v232, v233
v_cvt_pk_bf16_f32 v233, v234, v235
v_cvt_pk_bf16_f32 v234, v236, v237
v_cvt_pk_bf16_f32 v235, v238, v239
s_add_u32 s77, s74, 20480
buffer_store_dwordx4 v[232:235], v16, s[44:47], s77 offen sc1
v_accvgpr_read_b32 v240, a56
v_accvgpr_read_b32 v241, a57
v_accvgpr_read_b32 v242, a58
v_accvgpr_read_b32 v243, a59
v_accvgpr_read_b32 v244, a60
v_accvgpr_read_b32 v245, a61
v_accvgpr_read_b32 v246, a62
v_accvgpr_read_b32 v247, a63
v_mul_f32 v240, v240, v21
v_mul_f32 v241, v241, v21
v_mul_f32 v242, v242, v21
v_mul_f32 v243, v243, v21
v_mul_f32 v244, v244, v21
v_mul_f32 v245, v245, v21
v_mul_f32 v246, v246, v21
v_mul_f32 v247, v247, v21
v_cvt_pk_bf16_f32 v240, v240, v241
v_cvt_pk_bf16_f32 v241, v242, v243
v_cvt_pk_bf16_f32 v242, v244, v245
v_cvt_pk_bf16_f32 v243, v246, v247
s_add_u32 s77, s74, 28672
buffer_store_dwordx4 v[240:243], v16, s[44:47], s77 offen sc1
v_exp_f32 v136, v136
v_mfma_f32_16x16x32_bf16 v[144:147], a[188:191], v[84:87], v[144:147]
s_waitcnt lgkmcnt(5)
v_exp_f32 v137, v137
v_mfma_f32_16x16x32_bf16 v[148:151], a[204:207], v[84:87], v[148:151]
v_exp_f32 v138, v138
v_mfma_f32_16x16x32_bf16 v[148:151], a[200:203], v[80:83], v[148:151]
s_add_u32 s65, s84, 0
v_exp_f32 v139, v139
v_mfma_f32_16x16x32_bf16 v[148:151], a[196:199], v[76:79], v[148:151]
buffer_load_dwordx4 a[208:211], v14, s[44:47], s65 offen offset:0 sc1
v_mfma_f32_16x16x32_bf16 v[148:151], a[192:195], v[72:75], v[148:151]
ds_read_b128 a[164:167], v3 offset:26624
v_cvt_pk_bf16_f32 v208, v136, v137
v_smfmac_f32_16x16x64_bf16 a[136:139], a[240:243], v[184:191], v5
ds_read_b128 a[168:171], v3 offset:19456
v_smfmac_f32_16x16x64_bf16 a[140:143], a[240:243], v[192:199], v5
s_waitcnt lgkmcnt(2)
ds_read_b128 a[172:175], v3 offset:27648
v_mfma_f32_16x16x32_bf16 a[64:67], a[144:147], v[184:187], a[64:67]
v_exp_f32 v140, v140
v_mfma_f32_16x16x32_bf16 a[64:67], a[148:151], v[188:191], a[64:67]
buffer_load_dwordx4 a[216:219], v14, s[44:47], s65 offen offset:1024 sc1
v_mfma_f32_16x16x32_bf16 a[96:99], a[148:151], v[196:199], a[96:99]
v_exp_f32 v141, v141
v_mfma_f32_16x16x32_bf16 a[96:99], a[144:147], v[192:195], a[96:99]
buffer_load_dwordx4 a[224:227], v15, s[44:47], s65 offen offset:0 sc1
v_mfma_f32_16x16x32_bf16 a[100:103], a[152:155], v[192:195], a[100:103]
v_exp_f32 v142, v142
v_mfma_f32_16x16x32_bf16 a[100:103], a[156:159], v[196:199], a[100:103]
buffer_load_dwordx4 a[232:235], v15, s[44:47], s65 offen offset:1024 sc1
v_mfma_f32_16x16x32_bf16 a[68:71], a[156:159], v[188:191], a[68:71]
s_add_u32 s65, s84, 8192
ds_read_b128 a[176:179], v3 offset:20480
v_cvt_pk_bf16_f32 v209, v138, v139
v_mfma_f32_16x16x32_bf16 a[68:71], a[152:155], v[184:187], a[68:71]
buffer_load_dwordx4 a[212:215], v14, s[44:47], s65 offen offset:0 sc1
v_mfma_f32_16x16x32_bf16 a[72:75], a[160:163], v[184:187], a[72:75]
s_waitcnt lgkmcnt(1)
ds_read_b128 a[180:183], v3 offset:28672
v_cvt_pk_bf16_f32 v210, v140, v141
v_mfma_f32_16x16x32_bf16 a[72:75], a[164:167], v[188:191], a[72:75]
v_exp_f32 v143, v143
v_mfma_f32_16x16x32_bf16 a[104:107], a[164:167], v[196:199], a[104:107]
buffer_load_dwordx4 a[220:223], v14, s[44:47], s65 offen offset:1024 sc1
v_mfma_f32_16x16x32_bf16 a[104:107], a[160:163], v[192:195], a[104:107]
v_exp_f32 v144, v144
v_mfma_f32_16x16x32_bf16 a[108:111], a[168:171], v[192:195], a[108:111]
ds_read_b128 a[184:187], v3 offset:21504
v_xor_b32 v2, 0x8000, v2
v_mfma_f32_16x16x32_bf16 a[108:111], a[172:175], v[196:199], a[108:111]
buffer_load_dwordx4 a[228:231], v15, s[44:47], s65 offen offset:0 sc1
ds_read_b128 a[188:191], v3 offset:29696
v_mfma_f32_16x16x32_bf16 a[76:79], a[172:175], v[188:191], a[76:79]
v_exp_f32 v145, v145
v_mfma_f32_16x16x32_bf16 a[76:79], a[168:171], v[184:187], a[76:79]
s_waitcnt lgkmcnt(2)
buffer_load_dwordx4 a[236:239], v15, s[44:47], s65 offen offset:1024 sc1
v_mfma_f32_16x16x32_bf16 a[80:83], a[176:179], v[184:187], a[80:83]
s_add_u32 s65, s84, 32768
ds_read_b128 a[192:195], v3 offset:22528
v_cvt_pk_bf16_f32 v211, v142, v143
v_mfma_f32_16x16x32_bf16 a[80:83], a[180:183], v[188:191], a[80:83]
buffer_load_dwordx4 v[152:155], v14, s[44:47], s65 offen offset:0 sc1
ds_read_b128 a[196:199], v3 offset:30720
v_exp_f32 v146, v146
v_mfma_f32_16x16x32_bf16 a[112:115], a[180:183], v[196:199], a[112:115]
ds_read_b128 a[200:203], v3 offset:23552
ds_read_b128 a[204:207], v3 offset:31744
v_mfma_f32_16x16x32_bf16 a[112:115], a[176:179], v[192:195], a[112:115]
s_waitcnt vmcnt(13)
s_barrier
v_xor_b32 v3, 0x8000, v3
buffer_load_dwordx4 v[160:163], v14, s[44:47], s65 offen offset:1024 sc1
s_waitcnt lgkmcnt(4)
v_mfma_f32_16x16x32_bf16 a[116:119], a[184:187], v[192:195], a[116:119]
v_exp_f32 v147, v147
v_mfma_f32_16x16x32_bf16 a[116:119], a[188:191], v[196:199], a[116:119]
buffer_load_dwordx4 v[168:171], v15, s[44:47], s65 offen offset:0 sc1
v_mfma_f32_16x16x32_bf16 a[84:87], a[188:191], v[188:191], a[84:87]
v_exp_f32 v148, v148
v_mfma_f32_16x16x32_bf16 a[84:87], a[184:187], v[184:187], a[84:87]
s_waitcnt lgkmcnt(2)
buffer_load_dwordx4 v[176:179], v15, s[44:47], s65 offen offset:1024 sc1
v_cvt_pk_bf16_f32 v212, v144, v145
v_mfma_f32_16x16x32_bf16 a[88:91], a[192:195], v[184:187], a[88:91]
s_add_u32 s65, s84, 40960
v_exp_f32 v149, v149
v_mfma_f32_16x16x32_bf16 a[88:91], a[196:199], v[188:191], a[88:91]
buffer_load_dwordx4 v[156:159], v14, s[44:47], s65 offen offset:0 sc1
v_mfma_f32_16x16x32_bf16 a[120:123], a[196:199], v[196:199], a[120:123]
ds_read_b128 a[144:147], v3 offset:0
v_cvt_pk_bf16_f32 v213, v146, v147
v_mfma_f32_16x16x32_bf16 a[120:123], a[192:195], v[192:195], a[120:123]
s_waitcnt lgkmcnt(1)
buffer_load_dwordx4 v[164:167], v14, s[44:47], s65 offen offset:1024 sc1
ds_read_b128 a[148:151], v3 offset:8192
v_exp_f32 v150, v150
v_mfma_f32_16x16x32_bf16 a[124:127], a[200:203], v[192:195], a[124:127]
ds_read_b128 a[152:155], v3 offset:1024
v_cvt_pk_bf16_f32 v214, v148, v149
v_mfma_f32_16x16x32_bf16 a[124:127], a[204:207], v[196:199], a[124:127]
buffer_load_dwordx4 v[172:175], v15, s[44:47], s65 offen offset:0 sc1
ds_read_b128 a[156:159], v3 offset:9216
v_mfma_f32_16x16x32_bf16 a[92:95], a[204:207], v[188:191], a[92:95]
v_exp_f32 v151, v151
v_mfma_f32_16x16x32_bf16 a[92:95], a[200:203], v[184:187], a[92:95]
buffer_load_dwordx4 v[180:183], v15, s[44:47], s65 offen offset:1024 sc1
ds_read_b128 a[160:163], v3 offset:2048
ds_read_b128 a[164:167], v3 offset:10240
ds_read_b128 a[168:171], v3 offset:3072
ds_read_b128 a[172:175], v3 offset:11264
v_cvt_pk_bf16_f32 v215, v150, v151
v_accvgpr_read_b32 v22, a136
v_accvgpr_read_b32 v248, a137
v_add_f32 v22, v22, v248
v_max_f32 v1, v1, v22
v_rcp_f32 v22, v22
v_accvgpr_read_b32 v232, a64
v_accvgpr_read_b32 v233, a65
v_accvgpr_read_b32 v234, a66
v_accvgpr_read_b32 v235, a67
v_accvgpr_read_b32 v236, a68
v_accvgpr_read_b32 v237, a69
v_accvgpr_read_b32 v238, a70
v_accvgpr_read_b32 v239, a71
v_mul_f32 v22, v22, v8
v_mul_f32 v232, v232, v22
v_mul_f32 v233, v233, v22
v_mul_f32 v234, v234, v22
v_mul_f32 v235, v235, v22
v_mul_f32 v236, v236, v22
v_mul_f32 v237, v237, v22
v_mul_f32 v238, v238, v22
v_mul_f32 v239, v239, v22
v_cvt_pk_bf16_f32 v232, v232, v233
v_cvt_pk_bf16_f32 v233, v234, v235
v_cvt_pk_bf16_f32 v234, v236, v237
v_cvt_pk_bf16_f32 v235, v238, v239
s_add_u32 s77, s75, 0
buffer_store_dwordx4 v[232:235], v16, s[44:47], s77 offen sc1
s_branch L_TAIL
L_fallback_11:
s_waitcnt vmcnt(0) lgkmcnt(0)
s_barrier
s_mov_b32 s73, 1
s_mov_b32 s81, 0
v_and_b32 v232, 15, v0
v_lshrrev_b32 v233, 4, v0
v_lshlrev_b32 v233, 2, v233
v_sub_u32 v232, v232, v233
s_lshl_b32 s66, s30, 4
v_add_u32 v232, s66, v232
s_lshl_b32 s66, s16, 7
v_add_u32 v234, s66, v232
s_lshl_b32 s66, s3, 7
v_add_u32 v232, s66, v232
v_add_u32 v233, 64, v232
v_add_u32 v235, 64, v234
s_mov_b32 m0, s76
s_lshl_b32 s64, s30, 14
s_nop 0
buffer_load_dwordx4 v16, s[32:35], s64 offen offset:0 sc1 lds
s_nop 0
buffer_load_dwordx4 v16, s[32:35], s64 offen offset:1024 sc1 lds
s_nop 0
buffer_load_dwordx4 v16, s[32:35], s64 offen offset:2048 sc1 lds
s_nop 0
buffer_load_dwordx4 v16, s[32:35], s64 offen offset:3072 sc1 lds
s_add_u32 m0, s76, 4096
s_add_u32 s64, s64, 4096
s_nop 0
buffer_load_dwordx4 v16, s[32:35], s64 offen offset:0 sc1 lds
s_nop 0
buffer_load_dwordx4 v16, s[32:35], s64 offen offset:1024 sc1 lds
s_nop 0
buffer_load_dwordx4 v16, s[32:35], s64 offen offset:2048 sc1 lds
s_nop 0
buffer_load_dwordx4 v16, s[32:35], s64 offen offset:3072 sc1 lds
s_lshr_b32 s64, s76, 1
s_add_u32 m0, s64, 81920
s_and_b32 s71, s64, 8192
s_add_u32 s64, s64, s71
s_add_u32 s64, s64, 8192
s_nop 0
buffer_load_dwordx4 v16, s[32:35], s64 offen offset:0 sc1 lds
s_nop 0
buffer_load_dwordx4 v16, s[32:35], s64 offen offset:1024 sc1 lds
s_nop 0
buffer_load_dwordx4 v16, s[32:35], s64 offen offset:2048 sc1 lds
s_nop 0
buffer_load_dwordx4 v16, s[32:35], s64 offen offset:3072 sc1 lds
v_mov_b32 v20, 0xff800000
v_mov_b32 v21, 0xff800000
v_mov_b32 v22, 0xff800000
v_mov_b32 v23, 0xff800000
L_fbl_1015:
buffer_load_dwordx4 a[144:147], v16, s[32:35], s81 offen offset:0 sc1
buffer_load_dwordx4 a[148:151], v16, s[32:35], s81 offen offset:1024 sc1
buffer_load_dwordx4 a[152:155], v16, s[32:35], s81 offen offset:2048 sc1
buffer_load_dwordx4 a[156:159], v16, s[32:35], s81 offen offset:3072 sc1
s_add_u32 s64, s81, 4096
buffer_load_dwordx4 a[160:163], v16, s[32:35], s64 offen offset:0 sc1
buffer_load_dwordx4 a[164:167], v16, s[32:35], s64 offen offset:1024 sc1
buffer_load_dwordx4 a[168:171], v16, s[32:35], s64 offen offset:2048 sc1
buffer_load_dwordx4 a[172:175], v16, s[32:35], s64 offen offset:3072 sc1
v_subrev_u32 v88, 0, v232
v_ashrrev_i32 v88, 31, v88
v_and_b32 v88, 0xff800000, v88
v_subrev_u32 v89, 1, v232
v_ashrrev_i32 v89, 31, v89
v_and_b32 v89, 0xff800000, v89
v_subrev_u32 v90, 2, v232
v_ashrrev_i32 v90, 31, v90
v_and_b32 v90, 0xff800000, v90
v_subrev_u32 v91, 3, v232
v_ashrrev_i32 v91, 31, v91
v_and_b32 v91, 0xff800000, v91
v_subrev_u32 v92, 16, v232
v_ashrrev_i32 v92, 31, v92
v_and_b32 v92, 0xff800000, v92
v_subrev_u32 v93, 17, v232
v_ashrrev_i32 v93, 31, v93
v_and_b32 v93, 0xff800000, v93
v_subrev_u32 v94, 18, v232
v_ashrrev_i32 v94, 31, v94
v_and_b32 v94, 0xff800000, v94
v_subrev_u32 v95, 19, v232
v_ashrrev_i32 v95, 31, v95
v_and_b32 v95, 0xff800000, v95
v_subrev_u32 v232, 32, v232
v_subrev_u32 v104, 0, v233
v_ashrrev_i32 v104, 31, v104
v_and_b32 v104, 0xff800000, v104
v_subrev_u32 v105, 1, v233
v_ashrrev_i32 v105, 31, v105
v_and_b32 v105, 0xff800000, v105
v_subrev_u32 v106, 2, v233
v_ashrrev_i32 v106, 31, v106
v_and_b32 v106, 0xff800000, v106
v_subrev_u32 v107, 3, v233
v_ashrrev_i32 v107, 31, v107
v_and_b32 v107, 0xff800000, v107
v_subrev_u32 v108, 16, v233
v_ashrrev_i32 v108, 31, v108
v_and_b32 v108, 0xff800000, v108
v_subrev_u32 v109, 17, v233
v_ashrrev_i32 v109, 31, v109
v_and_b32 v109, 0xff800000, v109
v_subrev_u32 v110, 18, v233
v_ashrrev_i32 v110, 31, v110
v_and_b32 v110, 0xff800000, v110
v_subrev_u32 v111, 19, v233
v_ashrrev_i32 v111, 31, v111
v_and_b32 v111, 0xff800000, v111
v_subrev_u32 v233, 32, v233
v_subrev_u32 v120, 0, v234
v_ashrrev_i32 v120, 31, v120
v_and_b32 v120, 0xff800000, v120
v_subrev_u32 v121, 1, v234
v_ashrrev_i32 v121, 31, v121
v_and_b32 v121, 0xff800000, v121
v_subrev_u32 v122, 2, v234
v_ashrrev_i32 v122, 31, v122
v_and_b32 v122, 0xff800000, v122
v_subrev_u32 v123, 3, v234
v_ashrrev_i32 v123, 31, v123
v_and_b32 v123, 0xff800000, v123
v_subrev_u32 v124, 16, v234
v_ashrrev_i32 v124, 31, v124
v_and_b32 v124, 0xff800000, v124
v_subrev_u32 v125, 17, v234
v_ashrrev_i32 v125, 31, v125
v_and_b32 v125, 0xff800000, v125
v_subrev_u32 v126, 18, v234
v_ashrrev_i32 v126, 31, v126
v_and_b32 v126, 0xff800000, v126
v_subrev_u32 v127, 19, v234
v_ashrrev_i32 v127, 31, v127
v_and_b32 v127, 0xff800000, v127
v_subrev_u32 v234, 32, v234
v_subrev_u32 v136, 0, v235
v_ashrrev_i32 v136, 31, v136
v_and_b32 v136, 0xff800000, v136
v_subrev_u32 v137, 1, v235
v_ashrrev_i32 v137, 31, v137
v_and_b32 v137, 0xff800000, v137
v_subrev_u32 v138, 2, v235
v_ashrrev_i32 v138, 31, v138
v_and_b32 v138, 0xff800000, v138
v_subrev_u32 v139, 3, v235
v_ashrrev_i32 v139, 31, v139
v_and_b32 v139, 0xff800000, v139
v_subrev_u32 v140, 16, v235
v_ashrrev_i32 v140, 31, v140
v_and_b32 v140, 0xff800000, v140
v_subrev_u32 v141, 17, v235
v_ashrrev_i32 v141, 31, v141
v_and_b32 v141, 0xff800000, v141
v_subrev_u32 v142, 18, v235
v_ashrrev_i32 v142, 31, v142
v_and_b32 v142, 0xff800000, v142
v_subrev_u32 v143, 19, v235
v_ashrrev_i32 v143, 31, v143
v_and_b32 v143, 0xff800000, v143
v_subrev_u32 v235, 32, v235
s_waitcnt vmcnt(0)
v_mfma_f32_16x16x32_bf16 v[88:91], a[144:147], v[24:27], v[88:91]
v_mfma_f32_16x16x32_bf16 v[104:107], a[144:147], v[40:43], v[104:107]
v_mfma_f32_16x16x32_bf16 v[120:123], a[144:147], v[56:59], v[120:123]
v_mfma_f32_16x16x32_bf16 v[136:139], a[144:147], v[72:75], v[136:139]
v_mfma_f32_16x16x32_bf16 v[88:91], a[148:151], v[28:31], v[88:91]
v_mfma_f32_16x16x32_bf16 v[104:107], a[148:151], v[44:47], v[104:107]
v_mfma_f32_16x16x32_bf16 v[120:123], a[148:151], v[60:63], v[120:123]
v_mfma_f32_16x16x32_bf16 v[136:139], a[148:151], v[76:79], v[136:139]
v_mfma_f32_16x16x32_bf16 v[88:91], a[152:155], v[32:35], v[88:91]
v_mfma_f32_16x16x32_bf16 v[104:107], a[152:155], v[48:51], v[104:107]
v_mfma_f32_16x16x32_bf16 v[120:123], a[152:155], v[64:67], v[120:123]
v_mfma_f32_16x16x32_bf16 v[136:139], a[152:155], v[80:83], v[136:139]
v_mfma_f32_16x16x32_bf16 v[88:91], a[156:159], v[36:39], v[88:91]
v_mfma_f32_16x16x32_bf16 v[104:107], a[156:159], v[52:55], v[104:107]
v_mfma_f32_16x16x32_bf16 v[120:123], a[156:159], v[68:71], v[120:123]
v_mfma_f32_16x16x32_bf16 v[136:139], a[156:159], v[84:87], v[136:139]
v_mfma_f32_16x16x32_bf16 v[92:95], a[160:163], v[24:27], v[92:95]
v_mfma_f32_16x16x32_bf16 v[108:111], a[160:163], v[40:43], v[108:111]
v_mfma_f32_16x16x32_bf16 v[124:127], a[160:163], v[56:59], v[124:127]
v_mfma_f32_16x16x32_bf16 v[140:143], a[160:163], v[72:75], v[140:143]
v_mfma_f32_16x16x32_bf16 v[92:95], a[164:167], v[28:31], v[92:95]
v_mfma_f32_16x16x32_bf16 v[108:111], a[164:167], v[44:47], v[108:111]
v_mfma_f32_16x16x32_bf16 v[124:127], a[164:167], v[60:63], v[124:127]
v_mfma_f32_16x16x32_bf16 v[140:143], a[164:167], v[76:79], v[140:143]
v_mfma_f32_16x16x32_bf16 v[92:95], a[168:171], v[32:35], v[92:95]
v_mfma_f32_16x16x32_bf16 v[108:111], a[168:171], v[48:51], v[108:111]
v_mfma_f32_16x16x32_bf16 v[124:127], a[168:171], v[64:67], v[124:127]
v_mfma_f32_16x16x32_bf16 v[140:143], a[168:171], v[80:83], v[140:143]
v_mfma_f32_16x16x32_bf16 v[92:95], a[172:175], v[36:39], v[92:95]
v_mfma_f32_16x16x32_bf16 v[108:111], a[172:175], v[52:55], v[108:111]
v_mfma_f32_16x16x32_bf16 v[124:127], a[172:175], v[68:71], v[124:127]
v_mfma_f32_16x16x32_bf16 v[140:143], a[172:175], v[84:87], v[140:143]
s_nop 7
v_max3_f32 v20, v20, v88, v89
v_max3_f32 v20, v20, v90, v91
v_max3_f32 v20, v20, v92, v93
v_max3_f32 v20, v20, v94, v95
v_max3_f32 v21, v21, v104, v105
v_max3_f32 v21, v21, v106, v107
v_max3_f32 v21, v21, v108, v109
v_max3_f32 v21, v21, v110, v111
v_max3_f32 v22, v22, v120, v121
v_max3_f32 v22, v22, v122, v123
v_max3_f32 v22, v22, v124, v125
v_max3_f32 v22, v22, v126, v127
v_max3_f32 v23, v23, v136, v137
v_max3_f32 v23, v23, v138, v139
v_max3_f32 v23, v23, v140, v141
v_max3_f32 v23, v23, v142, v143
s_add_u32 s81, s81, 16384
s_cmp_lt_u32 s81, s34
s_cbranch_scc1 L_fbl_1015
v_mov_b32 v248, v20
v_mov_b32 v249, v21
v_mov_b32 v250, v22
v_mov_b32 v251, v23
v_permlane16_swap_b32 v248, v20
v_permlane16_swap_b32 v249, v21
v_permlane16_swap_b32 v250, v22
v_permlane16_swap_b32 v251, v23
v_max_f32 v20, v20, v248
v_max_f32 v21, v21, v249
v_max_f32 v22, v22, v250
v_max_f32 v23, v23, v251
v_mov_b32 v248, v20
v_mov_b32 v249, v21
v_mov_b32 v250, v22
v_mov_b32 v251, v23
v_permlane32_swap_b32 v248, v20
v_permlane32_swap_b32 v249, v21
v_permlane32_swap_b32 v250, v22
v_permlane32_swap_b32 v251, v23
v_max_f32 v20, v20, v248
v_max_f32 v21, v21, v249
v_max_f32 v22, v22, v250
v_max_f32 v23, v23, v251
v_mov_b32 v252, v20
v_mov_b32 v253, v21
v_mov_b32 v254, v22
v_mov_b32 v255, v23
s_and_b32 s70, s30, 1
s_lshr_b32 s67, s30, 1
s_lshl3_add_u32 s71, s67, s70
s_add_u32 s71, s71, 4
s_lshl_b32 s71, s71, 13
s_lshl_b32 s70, s70, 14
s_mul_i32 s67, s67, 24576
s_sub_u32 s70, s70, s67
s_add_u32 s70, s70, 65536
v_mov_b32 v2, v16
v_add_u32 v3, 0x10000, v16
v_mov_b32 v1, 0
s_mov_b32 m0, s71
s_waitcnt lgkmcnt(0)
s_barrier
ds_read_b128 a[144:147], v2 offset:0
ds_read_b128 a[148:151], v2 offset:1024
ds_read_b128 a[152:155], v2 offset:2048
ds_read_b128 a[156:159], v2 offset:3072
ds_read_b128 a[160:163], v2 offset:4096
ds_read_b128 a[164:167], v2 offset:5120
ds_read_b128 a[168:171], v2 offset:6144
ds_read_b128 a[172:175], v2 offset:7168
buffer_load_dwordx4 v16, s[32:35], s70 offen offset:0 sc1 lds
buffer_load_dwordx4 v16, s[32:35], s70 offen offset:1024 sc1 lds
s_waitcnt vmcnt(0) lgkmcnt(0)
s_branch L_attstart_7
L_spin_2016:
s_mov_b32 vcc_hi, 0x80000
L_spinlp_2018:
s_sleep 1
buffer_load_dword v19, off, s[52:55], s72 offset:0 sc1
s_waitcnt vmcnt(0)
v_readfirstlane_b32 vcc_lo, v19
s_sub_u32 vcc_hi, vcc_hi, 1
s_cbranch_scc1 L_spinbk_2017
s_cmp_lt_u32 vcc_lo, 8
s_cbranch_scc1 L_spinlp_2018
s_branch L_spinbk_2017
L_spin_3019:
s_mov_b32 vcc_hi, 0x80000
L_spinlp_3021:
s_sleep 1
buffer_load_dword v19, off, s[52:55], s72 offset:0 sc1
s_waitcnt vmcnt(0)
v_readfirstlane_b32 vcc_lo, v19
s_sub_u32 vcc_hi, vcc_hi, 1
s_cbranch_scc1 L_spinbk_3020
s_cmp_lt_u32 vcc_lo, 8
s_cbranch_scc1 L_spinlp_3021
s_branch L_spinbk_3020
.p2align 12
L_pg24:
s_branch L_tr2
L_p5f0:
s_waitcnt lgkmcnt(10)
s_waitcnt vmcnt(28)
v_mfma_f32_16x16x32_bf16 v[136:139], a[144:147], a[232:235], 0
s_waitcnt vmcnt(24)
s_waitcnt lgkmcnt(8)
s_add_u32 m0, s86, 65536
ds_read_b64_tr_b16 a[168:169], v191 offset:32768
v_xor_b32 v192, 0x10000, v184
v_mfma_f32_16x16x32_bf16 v[136:139], a[148:151], a[236:239], v[136:139]
s_add_u32 s64, s85, 524288
ds_read_b64_tr_b16 a[170:171], v191 offset:36864
v_xor_b32 v193, 0x10000, v185
v_mfma_f32_16x16x32_bf16 v[104:107], a[148:151], a[228:231], 0
buffer_load_dwordx4 v12, s[36:39], s64 offen lds
v_mfma_f32_16x16x32_bf16 v[104:107], a[144:147], a[224:227], v[104:107]
s_add_u32 m0, s86, 66560
s_add_u32 s64, s85, 532480
ds_read_b64_tr_b16 a[172:173], v191 offset:40960
v_xor_b32 v194, 0x10000, v186
v_mfma_f32_16x16x32_bf16 v[72:75], a[144:147], a[216:219], 0
buffer_load_dwordx4 v13, s[36:39], s64 offen lds
v_mfma_f32_16x16x32_bf16 v[72:75], a[148:151], a[220:223], v[72:75]
s_add_u32 m0, s86, 67584
ds_read_b64_tr_b16 a[174:175], v191 offset:45056
v_xor_b32 v195, 0x10000, v187
v_mfma_f32_16x16x32_bf16 v[40:43], a[148:151], a[212:215], 0
s_add_u32 s64, s85, 540672
ds_read_b64_tr_b16 a[176:177], v184 offset:32768
v_xor_b32 v196, 0x10000, v188
v_mfma_f32_16x16x32_bf16 v[40:43], a[144:147], a[208:211], v[40:43]
s_waitcnt lgkmcnt(5)
buffer_load_dwordx4 v12, s[36:39], s64 offen lds
v_mfma_f32_16x16x32_bf16 v[44:47], a[152:155], a[208:211], 0
s_add_u32 m0, s86, 68608
s_add_u32 s64, s85, 548864
ds_read_b64_tr_b16 a[178:179], v184 offset:36864
v_xor_b32 v197, 0x10000, v189
v_mfma_f32_16x16x32_bf16 v[44:47], a[156:159], a[212:215], v[44:47]
buffer_load_dwordx4 v13, s[36:39], s64 offen lds
v_mfma_f32_16x16x32_bf16 v[76:79], a[156:159], a[220:223], 0
s_add_u32 m0, s86, 69632
ds_read_b64_tr_b16 a[180:181], v184 offset:40960
v_xor_b32 v198, 0x10000, v190
v_mfma_f32_16x16x32_bf16 v[76:79], a[152:155], a[216:219], v[76:79]
s_add_u32 s64, s85, 557056
ds_read_b64_tr_b16 a[182:183], v184 offset:45056
v_xor_b32 v199, 0x10000, v191
v_mfma_f32_16x16x32_bf16 v[108:111], a[152:155], a[224:227], 0
buffer_load_dwordx4 v12, s[36:39], s64 offen lds
v_mfma_f32_16x16x32_bf16 v[108:111], a[156:159], a[228:231], v[108:111]
s_add_u32 m0, s86, 70656
s_add_u32 s64, s85, 565248
ds_read_b64_tr_b16 a[184:185], v185 offset:32768
v_mfma_f32_16x16x32_bf16 v[140:143], a[156:159], a[236:239], 0
buffer_load_dwordx4 v13, s[36:39], s64 offen lds
v_mfma_f32_16x16x32_bf16 v[140:143], a[152:155], a[232:235], v[140:143]
s_add_u32 m0, s86, 71680
ds_read_b64_tr_b16 a[186:187], v185 offset:36864
v_mfma_f32_16x16x32_bf16 v[144:147], a[160:163], a[232:235], 0
s_add_u32 s64, s85, 573440
ds_read_b64_tr_b16 a[188:189], v185 offset:40960
v_mfma_f32_16x16x32_bf16 v[144:147], a[164:167], a[236:239], v[144:147]
buffer_load_dwordx4 v12, s[36:39], s64 offen lds
v_mfma_f32_16x16x32_bf16 v[112:115], a[164:167], a[228:231], 0
s_and_b32 s71, s31, 4
s_lshl_b32 s71, s71, 5
s_add_u32 m0, s86, 72704
s_add_u32 s64, s85, 581632
ds_read_b64_tr_b16 a[190:191], v185 offset:45056
v_mfma_f32_16x16x32_bf16 v[112:115], a[160:163], a[224:227], v[112:115]
s_add_u32 s71, s71, s79
buffer_load_dwordx4 v13, s[36:39], s64 offen lds
v_mfma_f32_16x16x32_bf16 v[80:83], a[160:163], a[216:219], 0
s_add_u32 s71, s71, 4096
s_add_u32 s72, s80, 4096
ds_read_b64_tr_b16 a[192:193], v186 offset:32768
v_mfma_f32_16x16x32_bf16 v[80:83], a[164:167], a[220:223], v[80:83]
s_add_u32 s65, s84, 65536
ds_read_b64_tr_b16 a[194:195], v186 offset:36864
v_mfma_f32_16x16x32_bf16 v[48:51], a[164:167], a[212:215], 0
buffer_load_dwordx4 a[0:3], v14, s[44:47], s65 offen offset:0 sc1
v_mfma_f32_16x16x32_bf16 v[48:51], a[160:163], a[208:211], v[48:51]
s_waitcnt lgkmcnt(4)
ds_read_b64_tr_b16 a[196:197], v186 offset:40960
v_mfma_f32_16x16x32_bf16 v[52:55], a[168:171], a[208:211], 0
buffer_load_dwordx4 a[8:11], v14, s[44:47], s65 offen offset:1024 sc1
v_mfma_f32_16x16x32_bf16 v[52:55], a[172:175], a[212:215], v[52:55]
ds_read_b64_tr_b16 a[198:199], v186 offset:45056
v_mfma_f32_16x16x32_bf16 v[84:87], a[172:175], a[220:223], 0
ds_read_b64_tr_b16 a[200:201], v187 offset:32768
v_mfma_f32_16x16x32_bf16 v[84:87], a[168:171], a[216:219], v[84:87]
buffer_load_dwordx4 a[16:19], v15, s[44:47], s65 offen offset:0 sc1
v_mfma_f32_16x16x32_bf16 v[116:119], a[168:171], a[224:227], 0
ds_read_b64_tr_b16 a[202:203], v187 offset:36864
v_mfma_f32_16x16x32_bf16 v[116:119], a[172:175], a[228:231], v[116:119]
buffer_load_dwordx4 a[24:27], v15, s[44:47], s65 offen offset:1024 sc1
v_mfma_f32_16x16x32_bf16 v[148:151], a[172:175], a[236:239], 0
ds_read_b64_tr_b16 a[204:205], v187 offset:40960
v_mfma_f32_16x16x32_bf16 v[148:151], a[168:171], a[232:235], v[148:151]
s_add_u32 s65, s84, 73728
ds_read_b64_tr_b16 a[206:207], v187 offset:45056
v_mfma_f32_16x16x32_bf16 v[120:123], a[176:179], a[232:235], 0
buffer_load_dwordx4 a[4:7], v14, s[44:47], s65 offen offset:0 sc1
v_mfma_f32_16x16x32_bf16 v[120:123], a[180:183], a[236:239], v[120:123]
v_mfma_f32_16x16x32_bf16 v[88:91], a[180:183], a[228:231], 0
buffer_load_dwordx4 a[12:15], v14, s[44:47], s65 offen offset:1024 sc1
v_mfma_f32_16x16x32_bf16 v[88:91], a[176:179], a[224:227], v[88:91]
v_mfma_f32_16x16x32_bf16 v[56:59], a[176:179], a[216:219], 0
v_mfma_f32_16x16x32_bf16 v[56:59], a[180:183], a[220:223], v[56:59]
buffer_load_dwordx4 a[20:23], v15, s[44:47], s65 offen offset:0 sc1
v_mfma_f32_16x16x32_bf16 v[24:27], a[180:183], a[212:215], 0
v_mfma_f32_16x16x32_bf16 v[24:27], a[176:179], a[208:211], v[24:27]
buffer_load_dwordx4 a[28:31], v15, s[44:47], s65 offen offset:1024 sc1
v_mfma_f32_16x16x32_bf16 v[28:31], a[184:187], a[208:211], 0
s_waitcnt lgkmcnt(0)
v_mfma_f32_16x16x32_bf16 v[28:31], a[188:191], a[212:215], v[28:31]
v_mfma_f32_16x16x32_bf16 v[60:63], a[188:191], a[220:223], 0
v_mfma_f32_16x16x32_bf16 v[60:63], a[184:187], a[216:219], v[60:63]
s_waitcnt vmcnt(23)
s_barrier
v_mfma_f32_16x16x32_bf16 v[92:95], a[184:187], a[224:227], 0
ds_read_b64_tr_b16 a[144:145], v196 offset:0
v_mfma_f32_16x16x32_bf16 v[92:95], a[188:191], a[228:231], v[92:95]
ds_read_b64_tr_b16 a[146:147], v196 offset:4096
v_mfma_f32_16x16x32_bf16 v[124:127], a[188:191], a[236:239], 0
s_add_u32 m0, s86, 0
ds_read_b64_tr_b16 a[148:149], v196 offset:8192
v_mfma_f32_16x16x32_bf16 v[124:127], a[184:187], a[232:235], v[124:127]
s_add_u32 s64, s85, 786432
ds_read_b64_tr_b16 a[150:151], v196 offset:12288
v_mfma_f32_16x16x32_bf16 v[128:131], a[192:195], a[232:235], 0
buffer_load_dwordx4 v12, s[36:39], s64 offen lds
v_mfma_f32_16x16x32_bf16 v[128:131], a[196:199], a[236:239], v[128:131]
s_add_u32 m0, s86, 1024
ds_read_b64_tr_b16 a[152:153], v197 offset:0
v_mfma_f32_16x16x32_bf16 v[96:99], a[196:199], a[228:231], 0
s_add_u32 s64, s85, 794624
ds_read_b64_tr_b16 a[154:155], v197 offset:4096
v_mfma_f32_16x16x32_bf16 v[96:99], a[192:195], a[224:227], v[96:99]
buffer_load_dwordx4 v13, s[36:39], s64 offen lds
v_mfma_f32_16x16x32_bf16 v[64:67], a[192:195], a[216:219], 0
s_add_u32 m0, s86, 2048
ds_read_b64_tr_b16 a[156:157], v197 offset:8192
v_mfma_f32_16x16x32_bf16 v[64:67], a[196:199], a[220:223], v[64:67]
s_add_u32 s64, s85, 802816
ds_read_b64_tr_b16 a[158:159], v197 offset:12288
v_mfma_f32_16x16x32_bf16 v[32:35], a[196:199], a[212:215], 0
buffer_load_dwordx4 v12, s[36:39], s64 offen lds
v_mfma_f32_16x16x32_bf16 v[32:35], a[192:195], a[208:211], v[32:35]
s_add_u32 m0, s86, 3072
ds_read_b64_tr_b16 a[160:161], v198 offset:0
v_mfma_f32_16x16x32_bf16 v[36:39], a[200:203], a[208:211], 0
s_add_u32 s64, s85, 811008
ds_read_b64_tr_b16 a[162:163], v198 offset:4096
v_mfma_f32_16x16x32_bf16 v[36:39], a[204:207], a[212:215], v[36:39]
buffer_load_dwordx4 v13, s[36:39], s64 offen lds
v_mfma_f32_16x16x32_bf16 v[68:71], a[204:207], a[220:223], 0
s_add_u32 m0, s86, 4096
ds_read_b64_tr_b16 a[164:165], v198 offset:8192
v_mfma_f32_16x16x32_bf16 v[68:71], a[200:203], a[216:219], v[68:71]
s_add_u32 s64, s85, 819200
ds_read_b64_tr_b16 a[166:167], v198 offset:12288
v_mfma_f32_16x16x32_bf16 v[100:103], a[200:203], a[224:227], 0
buffer_load_dwordx4 v12, s[36:39], s64 offen lds
v_mfma_f32_16x16x32_bf16 v[100:103], a[204:207], a[228:231], v[100:103]
v_mfma_f32_16x16x32_bf16 v[132:135], a[204:207], a[236:239], 0
v_mfma_f32_16x16x32_bf16 v[132:135], a[200:203], a[232:235], v[132:135]
s_waitcnt lgkmcnt(3)
v_mfma_f32_16x16x32_bf16 v[136:139], a[144:147], v[176:179], v[136:139]
s_add_u32 m0, s86, 5120
ds_read_b64_tr_b16 a[168:169], v199 offset:0
v_xor_b32 v200, 0x18000, v184
v_mfma_f32_16x16x32_bf16 v[136:139], a[148:151], v[180:183], v[136:139]
s_add_u32 s64, s85, 827392
ds_read_b64_tr_b16 a[170:171], v199 offset:4096
v_xor_b32 v201, 0x18000, v185
v_mfma_f32_16x16x32_bf16 v[104:107], a[148:151], v[172:175], v[104:107]
buffer_load_dwordx4 v13, s[36:39], s64 offen lds
v_mfma_f32_16x16x32_bf16 v[104:107], a[144:147], v[168:171], v[104:107]
s_add_u32 m0, s86, 6144
ds_read_b64_tr_b16 a[172:173], v199 offset:8192
v_xor_b32 v202, 0x18000, v186
v_mfma_f32_16x16x32_bf16 v[72:75], a[144:147], v[160:163], v[72:75]
s_add_u32 s64, s85, 835584
ds_read_b64_tr_b16 a[174:175], v199 offset:12288
v_xor_b32 v203, 0x18000, v187
v_mfma_f32_16x16x32_bf16 v[72:75], a[148:151], v[164:167], v[72:75]
buffer_load_dwordx4 v12, s[36:39], s64 offen lds
v_mfma_f32_16x16x32_bf16 v[40:43], a[148:151], v[156:159], v[40:43]
ds_read_b64_tr_b16 a[176:177], v192 offset:0
v_xor_b32 v204, 0x18000, v188
v_mfma_f32_16x16x32_bf16 v[40:43], a[144:147], v[152:155], v[40:43]
s_add_u32 m0, s86, 7168
ds_read_b64_tr_b16 a[178:179], v192 offset:4096
v_xor_b32 v205, 0x18000, v189
v_mfma_f32_16x16x32_bf16 v[44:47], a[152:155], v[152:155], v[44:47]
s_add_u32 s64, s85, 843776
ds_read_b64_tr_b16 a[180:181], v192 offset:8192
v_xor_b32 v206, 0x18000, v190
v_mfma_f32_16x16x32_bf16 v[44:47], a[156:159], v[156:159], v[44:47]
buffer_load_dwordx4 v13, s[36:39], s64 offen lds
v_mfma_f32_16x16x32_bf16 v[76:79], a[156:159], v[164:167], v[76:79]
ds_read_b64_tr_b16 a[182:183], v192 offset:12288
v_xor_b32 v207, 0x18000, v191
v_mfma_f32_16x16x32_bf16 v[76:79], a[152:155], v[160:163], v[76:79]
s_add_u32 s65, s84, 98304
ds_read_b64_tr_b16 a[184:185], v193 offset:0
v_mfma_f32_16x16x32_bf16 v[108:111], a[152:155], v[168:171], v[108:111]
buffer_load_dwordx4 a[64:67], v14, s[44:47], s65 offen offset:0 sc1
v_mfma_f32_16x16x32_bf16 v[108:111], a[156:159], v[172:175], v[108:111]
ds_read_b64_tr_b16 a[186:187], v193 offset:4096
v_mfma_f32_16x16x32_bf16 v[140:143], a[156:159], v[180:183], v[140:143]
ds_read_b64_tr_b16 a[188:189], v193 offset:8192
v_mfma_f32_16x16x32_bf16 v[140:143], a[152:155], v[176:179], v[140:143]
s_waitcnt lgkmcnt(5)
ds_read_b64_tr_b16 a[190:191], v193 offset:12288
v_mfma_f32_16x16x32_bf16 v[144:147], a[160:163], v[176:179], v[144:147]
buffer_load_dwordx4 a[72:75], v14, s[44:47], s65 offen offset:1024 sc1
v_mfma_f32_16x16x32_bf16 v[144:147], a[164:167], v[180:183], v[144:147]
v_mfma_f32_16x16x32_bf16 v[112:115], a[164:167], v[172:175], v[112:115]
ds_read_b64_tr_b16 a[192:193], v194 offset:0
v_mfma_f32_16x16x32_bf16 v[112:115], a[160:163], v[168:171], v[112:115]
ds_read_b64_tr_b16 a[194:195], v194 offset:4096
v_mfma_f32_16x16x32_bf16 v[80:83], a[160:163], v[160:163], v[80:83]
buffer_load_dwordx4 a[80:83], v15, s[44:47], s65 offen offset:0 sc1
v_mfma_f32_16x16x32_bf16 v[80:83], a[164:167], v[164:167], v[80:83]
ds_read_b64_tr_b16 a[196:197], v194 offset:8192
v_mfma_f32_16x16x32_bf16 v[48:51], a[164:167], v[156:159], v[48:51]
ds_read_b64_tr_b16 a[198:199], v194 offset:12288
v_mfma_f32_16x16x32_bf16 v[48:51], a[160:163], v[152:155], v[48:51]
buffer_load_dwordx4 a[88:91], v15, s[44:47], s65 offen offset:1024 sc1
v_mfma_f32_16x16x32_bf16 v[52:55], a[168:171], v[152:155], v[52:55]
v_mfma_f32_16x16x32_bf16 v[52:55], a[172:175], v[156:159], v[52:55]
v_mfma_f32_16x16x32_bf16 v[84:87], a[172:175], v[164:167], v[84:87]
s_add_u32 s65, s84, 106496
ds_read_b64_tr_b16 a[200:201], v195 offset:0
v_mfma_f32_16x16x32_bf16 v[84:87], a[168:171], v[160:163], v[84:87]
buffer_load_dwordx4 a[68:71], v14, s[44:47], s65 offen offset:0 sc1
v_mfma_f32_16x16x32_bf16 v[116:119], a[168:171], v[168:171], v[116:119]
ds_read_b64_tr_b16 a[202:203], v195 offset:4096
v_mfma_f32_16x16x32_bf16 v[116:119], a[172:175], v[172:175], v[116:119]
ds_read_b64_tr_b16 a[204:205], v195 offset:8192
v_mfma_f32_16x16x32_bf16 v[148:151], a[172:175], v[180:183], v[148:151]
ds_read_b64_tr_b16 a[206:207], v195 offset:12288
v_mfma_f32_16x16x32_bf16 v[148:151], a[168:171], v[176:179], v[148:151]
s_lshl_b32 s66, s30, 30
buffer_load_dwordx4 a[76:79], v14, s[44:47], s65 offen offset:1024 sc1
v_mfma_f32_16x16x32_bf16 v[120:123], a[176:179], v[176:179], v[120:123]
s_waitcnt lgkmcnt(4)
v_lshl_add_u32 v1, v0, 24, s66
v_mfma_f32_16x16x32_bf16 v[120:123], a[180:183], v[180:183], v[120:123]
v_mfma_f32_16x16x32_bf16 v[88:91], a[180:183], v[172:175], v[88:91]
buffer_load_dwordx4 a[84:87], v15, s[44:47], s65 offen offset:0 sc1
v_mfma_f32_16x16x32_bf16 v[88:91], a[176:179], v[168:171], v[88:91]
v_mfma_f32_16x16x32_bf16 v[56:59], a[176:179], v[160:163], v[56:59]
v_mfma_f32_16x16x32_bf16 v[56:59], a[180:183], v[164:167], v[56:59]
v_mfma_f32_16x16x32_bf16 v[24:27], a[180:183], v[156:159], v[24:27]
buffer_load_dwordx4 a[92:95], v15, s[44:47], s65 offen offset:1024 sc1
v_mfma_f32_16x16x32_bf16 v[24:27], a[176:179], v[152:155], v[24:27]
v_mfma_f32_16x16x32_bf16 v[28:31], a[184:187], v[152:155], v[28:31]
v_mfma_f32_16x16x32_bf16 v[28:31], a[188:191], v[156:159], v[28:31]
v_mfma_f32_16x16x32_bf16 v[60:63], a[188:191], v[164:167], v[60:63]
v_mfma_f32_16x16x32_bf16 v[60:63], a[184:187], v[160:163], v[60:63]
s_waitcnt vmcnt(24)
s_barrier
v_mfma_f32_16x16x32_bf16 v[92:95], a[184:187], v[168:171], v[92:95]
s_mov_b64 exec, 1
buffer_atomic_add a251, v1, s[52:55], s71 offen offset:0 sc1
s_mov_b64 exec, -1
v_mfma_f32_16x16x32_bf16 v[92:95], a[188:191], v[172:175], v[92:95]
ds_read_b64_tr_b16 a[144:145], v196 offset:32768
v_mfma_f32_16x16x32_bf16 v[124:127], a[188:191], v[180:183], v[124:127]
s_add_u32 m0, s86, 98304
ds_read_b64_tr_b16 a[146:147], v196 offset:36864
v_mfma_f32_16x16x32_bf16 v[124:127], a[184:187], v[176:179], v[124:127]
s_add_u32 s64, s85, 1048576
ds_read_b64_tr_b16 a[148:149], v196 offset:40960
v_mfma_f32_16x16x32_bf16 v[128:131], a[192:195], v[176:179], v[128:131]
buffer_load_dwordx4 v12, s[36:39], s64 offen lds
v_mfma_f32_16x16x32_bf16 v[128:131], a[196:199], v[180:183], v[128:131]
s_add_u32 m0, s86, 99328
ds_read_b64_tr_b16 a[150:151], v196 offset:45056
v_mfma_f32_16x16x32_bf16 v[96:99], a[196:199], v[172:175], v[96:99]
s_add_u32 s64, s85, 1056768
ds_read_b64_tr_b16 a[152:153], v197 offset:32768
v_mfma_f32_16x16x32_bf16 v[96:99], a[192:195], v[168:171], v[96:99]
buffer_load_dwordx4 v13, s[36:39], s64 offen lds
v_mfma_f32_16x16x32_bf16 v[64:67], a[192:195], v[160:163], v[64:67]
s_add_u32 m0, s86, 100352
ds_read_b64_tr_b16 a[154:155], v197 offset:36864
v_mfma_f32_16x16x32_bf16 v[64:67], a[196:199], v[164:167], v[64:67]
s_add_u32 s64, s85, 1064960
ds_read_b64_tr_b16 a[156:157], v197 offset:40960
v_mfma_f32_16x16x32_bf16 v[32:35], a[196:199], v[156:159], v[32:35]
buffer_load_dwordx4 v12, s[36:39], s64 offen lds
v_mfma_f32_16x16x32_bf16 v[32:35], a[192:195], v[152:155], v[32:35]
s_waitcnt lgkmcnt(4)
s_add_u32 m0, s86, 101376
ds_read_b64_tr_b16 a[158:159], v197 offset:45056
v_mfma_f32_16x16x32_bf16 v[36:39], a[200:203], v[152:155], v[36:39]
s_add_u32 s64, s85, 1073152
ds_read_b64_tr_b16 a[160:161], v198 offset:32768
v_mfma_f32_16x16x32_bf16 v[36:39], a[204:207], v[156:159], v[36:39]
buffer_load_dwordx4 v13, s[36:39], s64 offen lds
v_mfma_f32_16x16x32_bf16 v[68:71], a[204:207], v[164:167], v[68:71]
s_add_u32 m0, s86, 102400
ds_read_b64_tr_b16 a[162:163], v198 offset:36864
v_mfma_f32_16x16x32_bf16 v[68:71], a[200:203], v[160:163], v[68:71]
s_add_u32 s64, s85, 1081344
ds_read_b64_tr_b16 a[164:165], v198 offset:40960
v_mfma_f32_16x16x32_bf16 v[100:103], a[200:203], v[168:171], v[100:103]
buffer_load_dwordx4 v12, s[36:39], s64 offen lds
v_mfma_f32_16x16x32_bf16 v[100:103], a[204:207], v[172:175], v[100:103]
ds_read_b64_tr_b16 a[166:167], v198 offset:45056
v_mfma_f32_16x16x32_bf16 v[132:135], a[204:207], v[180:183], v[132:135]
v_mfma_f32_16x16x32_bf16 v[132:135], a[200:203], v[176:179], v[132:135]
s_waitcnt vmcnt(26)
v_mfma_f32_16x16x32_bf16 v[136:139], a[144:147], a[24:27], v[136:139]
s_waitcnt vmcnt(22)
s_waitcnt lgkmcnt(3)
s_add_u32 m0, s86, 103424
ds_read_b64_tr_b16 a[168:169], v199 offset:32768
v_mfma_f32_16x16x32_bf16 v[136:139], a[148:151], a[28:31], v[136:139]
s_add_u32 s64, s85, 1089536
ds_read_b64_tr_b16 a[170:171], v199 offset:36864
v_mfma_f32_16x16x32_bf16 v[104:107], a[148:151], a[20:23], v[104:107]
buffer_load_dwordx4 v13, s[36:39], s64 offen lds
v_mfma_f32_16x16x32_bf16 v[104:107], a[144:147], a[16:19], v[104:107]
s_add_u32 m0, s86, 104448
ds_read_b64_tr_b16 a[172:173], v199 offset:40960
v_mfma_f32_16x16x32_bf16 v[72:75], a[144:147], a[8:11], v[72:75]
s_add_u32 s64, s85, 1097728
ds_read_b64_tr_b16 a[174:175], v199 offset:45056
v_mfma_f32_16x16x32_bf16 v[72:75], a[148:151], a[12:15], v[72:75]
buffer_load_dwordx4 v12, s[36:39], s64 offen lds
v_mfma_f32_16x16x32_bf16 v[40:43], a[148:151], a[4:7], v[40:43]
ds_read_b64_tr_b16 a[176:177], v192 offset:32768
v_mfma_f32_16x16x32_bf16 v[40:43], a[144:147], a[0:3], v[40:43]
s_add_u32 m0, s86, 105472
ds_read_b64_tr_b16 a[178:179], v192 offset:36864
v_mfma_f32_16x16x32_bf16 v[44:47], a[152:155], a[0:3], v[44:47]
s_add_u32 s64, s85, 1105920
ds_read_b64_tr_b16 a[180:181], v192 offset:40960
v_mfma_f32_16x16x32_bf16 v[44:47], a[156:159], a[4:7], v[44:47]
buffer_load_dwordx4 v13, s[36:39], s64 offen lds
v_mfma_f32_16x16x32_bf16 v[76:79], a[156:159], a[12:15], v[76:79]
ds_read_b64_tr_b16 a[182:183], v192 offset:45056
v_mfma_f32_16x16x32_bf16 v[76:79], a[152:155], a[8:11], v[76:79]
s_add_u32 s65, s84, 131072
ds_read_b64_tr_b16 a[184:185], v193 offset:32768
v_mfma_f32_16x16x32_bf16 v[108:111], a[152:155], a[16:19], v[108:111]
buffer_load_dwordx4 a[32:35], v14, s[44:47], s65 offen offset:0 sc1
v_mfma_f32_16x16x32_bf16 v[108:111], a[156:159], a[20:23], v[108:111]
ds_read_b64_tr_b16 a[186:187], v193 offset:36864
v_mfma_f32_16x16x32_bf16 v[140:143], a[156:159], a[28:31], v[140:143]
ds_read_b64_tr_b16 a[188:189], v193 offset:40960
v_mfma_f32_16x16x32_bf16 v[140:143], a[152:155], a[24:27], v[140:143]
s_waitcnt lgkmcnt(5)
ds_read_b64_tr_b16 a[190:191], v193 offset:45056
v_mfma_f32_16x16x32_bf16 v[144:147], a[160:163], a[24:27], v[144:147]
s_and_b32 s68, s82, 3
buffer_load_dwordx4 a[40:43], v14, s[44:47], s65 offen offset:1024 sc1
v_mfma_f32_16x16x32_bf16 v[144:147], a[164:167], a[28:31], v[144:147]
s_lshl_b32 s68, s68, 11
s_add_u32 s76, s86, s68
s_lshr_b32 s69, s87, 8
v_mfma_f32_16x16x32_bf16 v[112:115], a[164:167], a[20:23], v[112:115]
s_lshr_b32 s67, s82, 1
s_xor_b32 s69, s69, s67
ds_read_b64_tr_b16 a[192:193], v194 offset:32768
v_mfma_f32_16x16x32_bf16 v[112:115], a[160:163], a[16:19], v[112:115]
s_and_b32 s69, s69, 2
s_lshl_b32 s69, s69, 15
ds_read_b64_tr_b16 a[194:195], v194 offset:36864
v_mfma_f32_16x16x32_bf16 v[80:83], a[160:163], a[8:11], v[80:83]
s_add_u32 s68, s68, s69
buffer_load_dwordx4 a[48:51], v15, s[44:47], s65 offen offset:0 sc1
v_mfma_f32_16x16x32_bf16 v[80:83], a[164:167], a[12:15], v[80:83]
ds_read_b64_tr_b16 a[196:197], v194 offset:40960
v_mfma_f32_16x16x32_bf16 v[48:51], a[164:167], a[4:7], v[48:51]
ds_read_b64_tr_b16 a[198:199], v194 offset:45056
v_mfma_f32_16x16x32_bf16 v[48:51], a[160:163], a[0:3], v[48:51]
buffer_load_dwordx4 a[56:59], v15, s[44:47], s65 offen offset:1024 sc1
v_mfma_f32_16x16x32_bf16 v[52:55], a[168:171], a[0:3], v[52:55]
v_mfma_f32_16x16x32_bf16 v[52:55], a[172:175], a[4:7], v[52:55]
v_mfma_f32_16x16x32_bf16 v[84:87], a[172:175], a[12:15], v[84:87]
s_add_u32 s65, s84, 139264
ds_read_b64_tr_b16 a[200:201], v195 offset:32768
v_mfma_f32_16x16x32_bf16 v[84:87], a[168:171], a[8:11], v[84:87]
buffer_load_dwordx4 a[36:39], v14, s[44:47], s65 offen offset:0 sc1
v_mfma_f32_16x16x32_bf16 v[116:119], a[168:171], a[16:19], v[116:119]
ds_read_b64_tr_b16 a[202:203], v195 offset:36864
v_mfma_f32_16x16x32_bf16 v[116:119], a[172:175], a[20:23], v[116:119]
ds_read_b64_tr_b16 a[204:205], v195 offset:40960
v_mfma_f32_16x16x32_bf16 v[148:151], a[172:175], a[28:31], v[148:151]
ds_read_b64_tr_b16 a[206:207], v195 offset:45056
v_mfma_f32_16x16x32_bf16 v[148:151], a[168:171], a[24:27], v[148:151]
buffer_load_dwordx4 a[44:47], v14, s[44:47], s65 offen offset:1024 sc1
v_mfma_f32_16x16x32_bf16 v[120:123], a[176:179], a[24:27], v[120:123]
s_waitcnt lgkmcnt(4)
v_mfma_f32_16x16x32_bf16 v[120:123], a[180:183], a[28:31], v[120:123]
v_mfma_f32_16x16x32_bf16 v[88:91], a[180:183], a[20:23], v[88:91]
buffer_load_dwordx4 a[52:55], v15, s[44:47], s65 offen offset:0 sc1
v_mfma_f32_16x16x32_bf16 v[88:91], a[176:179], a[16:19], v[88:91]
v_mfma_f32_16x16x32_bf16 v[56:59], a[176:179], a[8:11], v[56:59]
v_mfma_f32_16x16x32_bf16 v[56:59], a[180:183], a[12:15], v[56:59]
v_mfma_f32_16x16x32_bf16 v[24:27], a[180:183], a[4:7], v[24:27]
buffer_load_dwordx4 a[60:63], v15, s[44:47], s65 offen offset:1024 sc1
v_mfma_f32_16x16x32_bf16 v[24:27], a[176:179], a[0:3], v[24:27]
v_mfma_f32_16x16x32_bf16 v[28:31], a[184:187], a[0:3], v[28:31]
v_mfma_f32_16x16x32_bf16 v[28:31], a[188:191], a[4:7], v[28:31]
v_mfma_f32_16x16x32_bf16 v[60:63], a[188:191], a[12:15], v[60:63]
s_lshl3_add_u32 s85, s68, s85
v_mfma_f32_16x16x32_bf16 v[60:63], a[184:187], a[8:11], v[60:63]
s_waitcnt vmcnt(25)
s_barrier
v_mfma_f32_16x16x32_bf16 v[92:95], a[184:187], a[16:19], v[92:95]
ds_read_b64_tr_b16 a[144:145], v204 offset:0
v_mfma_f32_16x16x32_bf16 v[92:95], a[188:191], a[20:23], v[92:95]
ds_read_b64_tr_b16 a[146:147], v204 offset:4096
v_mfma_f32_16x16x32_bf16 v[124:127], a[188:191], a[28:31], v[124:127]
s_xor_b32 m0, s76, 131072
ds_read_b64_tr_b16 a[148:149], v204 offset:8192
v_mfma_f32_16x16x32_bf16 v[124:127], a[184:187], a[24:27], v[124:127]
s_xor_b32 s64, s85, 0
ds_read_b64_tr_b16 a[150:151], v204 offset:12288
v_mfma_f32_16x16x32_bf16 v[128:131], a[192:195], a[24:27], v[128:131]
buffer_load_dwordx4 v12, s[40:43], s64 offen lds
v_mfma_f32_16x16x32_bf16 v[128:131], a[196:199], a[28:31], v[128:131]
s_xor_b32 m0, s76, 132096
ds_read_b64_tr_b16 a[152:153], v205 offset:0
v_mfma_f32_16x16x32_bf16 v[96:99], a[196:199], a[20:23], v[96:99]
s_xor_b32 s64, s85, 8192
ds_read_b64_tr_b16 a[154:155], v205 offset:4096
v_mfma_f32_16x16x32_bf16 v[96:99], a[192:195], a[16:19], v[96:99]
buffer_load_dwordx4 v13, s[40:43], s64 offen lds
v_mfma_f32_16x16x32_bf16 v[64:67], a[192:195], a[8:11], v[64:67]
s_xor_b32 m0, s76, 133120
ds_read_b64_tr_b16 a[156:157], v205 offset:8192
v_mfma_f32_16x16x32_bf16 v[64:67], a[196:199], a[12:15], v[64:67]
s_xor_b32 s64, s85, 16384
ds_read_b64_tr_b16 a[158:159], v205 offset:12288
v_mfma_f32_16x16x32_bf16 v[32:35], a[196:199], a[4:7], v[32:35]
buffer_load_dwordx4 v12, s[40:43], s64 offen lds
v_mfma_f32_16x16x32_bf16 v[32:35], a[192:195], a[0:3], v[32:35]
s_waitcnt lgkmcnt(4)
s_xor_b32 m0, s76, 134144
ds_read_b64_tr_b16 a[160:161], v206 offset:0
v_mfma_f32_16x16x32_bf16 v[36:39], a[200:203], a[0:3], v[36:39]
s_xor_b32 s64, s85, 24576
ds_read_b64_tr_b16 a[162:163], v206 offset:4096
v_mfma_f32_16x16x32_bf16 v[36:39], a[204:207], a[4:7], v[36:39]
buffer_load_dwordx4 v13, s[40:43], s64 offen lds
v_mfma_f32_16x16x32_bf16 v[68:71], a[204:207], a[12:15], v[68:71]
s_xor_b32 m0, s76, 135168
ds_read_b64_tr_b16 a[164:165], v206 offset:8192
v_mfma_f32_16x16x32_bf16 v[68:71], a[200:203], a[8:11], v[68:71]
s_xor_b32 s64, s85, 32768
ds_read_b64_tr_b16 a[166:167], v206 offset:12288
v_mfma_f32_16x16x32_bf16 v[100:103], a[200:203], a[16:19], v[100:103]
buffer_load_dwordx4 v12, s[40:43], s64 offen lds
v_mfma_f32_16x16x32_bf16 v[100:103], a[204:207], a[20:23], v[100:103]
v_mfma_f32_16x16x32_bf16 v[132:135], a[204:207], a[28:31], v[132:135]
v_mfma_f32_16x16x32_bf16 v[132:135], a[200:203], a[24:27], v[132:135]
s_waitcnt vmcnt(26)
v_mfma_f32_16x16x32_bf16 v[136:139], a[144:147], a[88:91], v[136:139]
s_waitcnt vmcnt(22)
s_xor_b32 m0, s76, 136192
ds_read_b64_tr_b16 a[168:169], v207 offset:0
v_mfma_f32_16x16x32_bf16 v[136:139], a[148:151], a[92:95], v[136:139]
s_xor_b32 s64, s85, 40960
ds_read_b64_tr_b16 a[170:171], v207 offset:4096
v_mfma_f32_16x16x32_bf16 v[104:107], a[148:151], a[84:87], v[104:107]
buffer_load_dwordx4 v13, s[40:43], s64 offen lds
v_mfma_f32_16x16x32_bf16 v[104:107], a[144:147], a[80:83], v[104:107]
ds_read_b64_tr_b16 a[172:173], v207 offset:8192
v_mfma_f32_16x16x32_bf16 v[72:75], a[144:147], a[72:75], v[72:75]
ds_read_b64_tr_b16 a[174:175], v207 offset:12288
v_mfma_f32_16x16x32_bf16 v[72:75], a[148:151], a[76:79], v[72:75]
ds_read_b64_tr_b16 a[176:177], v200 offset:0
v_mfma_f32_16x16x32_bf16 v[40:43], a[148:151], a[68:71], v[40:43]
ds_read_b64_tr_b16 a[178:179], v200 offset:4096
v_mfma_f32_16x16x32_bf16 v[40:43], a[144:147], a[64:67], v[40:43]
s_waitcnt lgkmcnt(6)
ds_read_b64_tr_b16 a[180:181], v200 offset:8192
v_mfma_f32_16x16x32_bf16 v[44:47], a[152:155], a[64:67], v[44:47]
s_xor_b32 m0, s76, 137216
ds_read_b64_tr_b16 a[182:183], v200 offset:12288
v_mfma_f32_16x16x32_bf16 v[44:47], a[156:159], a[68:71], v[44:47]
s_xor_b32 s64, s85, 49152
v_mfma_f32_16x16x32_bf16 v[76:79], a[156:159], a[76:79], v[76:79]
buffer_load_dwordx4 v12, s[40:43], s64 offen lds
v_mfma_f32_16x16x32_bf16 v[76:79], a[152:155], a[72:75], v[76:79]
ds_read_b64_tr_b16 a[184:185], v201 offset:0
v_mfma_f32_16x16x32_bf16 v[108:111], a[152:155], a[80:83], v[108:111]
ds_read_b64_tr_b16 a[186:187], v201 offset:4096
v_mfma_f32_16x16x32_bf16 v[108:111], a[156:159], a[84:87], v[108:111]
ds_read_b64_tr_b16 a[188:189], v201 offset:8192
v_mfma_f32_16x16x32_bf16 v[140:143], a[156:159], a[92:95], v[140:143]
ds_read_b64_tr_b16 a[190:191], v201 offset:12288
v_mfma_f32_16x16x32_bf16 v[140:143], a[152:155], a[88:91], v[140:143]
v_mfma_f32_16x16x32_bf16 v[144:147], a[160:163], a[88:91], v[144:147]
v_mfma_f32_16x16x32_bf16 v[144:147], a[164:167], a[92:95], v[144:147]
s_xor_b32 m0, s76, 138240
v_mfma_f32_16x16x32_bf16 v[112:115], a[164:167], a[84:87], v[112:115]
s_xor_b32 s64, s85, 57344
ds_read_b64_tr_b16 a[192:193], v202 offset:0
v_mfma_f32_16x16x32_bf16 v[112:115], a[160:163], a[80:83], v[112:115]
buffer_load_dwordx4 v13, s[40:43], s64 offen lds
v_mfma_f32_16x16x32_bf16 v[80:83], a[160:163], a[72:75], v[80:83]
ds_read_b64_tr_b16 a[194:195], v202 offset:4096
v_mfma_f32_16x16x32_bf16 v[80:83], a[164:167], a[76:79], v[80:83]
ds_read_b64_tr_b16 a[196:197], v202 offset:8192
v_mfma_f32_16x16x32_bf16 v[48:51], a[164:167], a[68:71], v[48:51]
ds_read_b64_tr_b16 a[198:199], v202 offset:12288
v_mfma_f32_16x16x32_bf16 v[48:51], a[160:163], a[64:67], v[48:51]
s_waitcnt lgkmcnt(4)
v_mfma_f32_16x16x32_bf16 v[52:55], a[168:171], a[64:67], v[52:55]
v_mfma_f32_16x16x32_bf16 v[52:55], a[172:175], a[68:71], v[52:55]
v_mfma_f32_16x16x32_bf16 v[84:87], a[172:175], a[76:79], v[84:87]
ds_read_b64_tr_b16 a[200:201], v203 offset:0
v_mfma_f32_16x16x32_bf16 v[84:87], a[168:171], a[72:75], v[84:87]
ds_read_b64_tr_b16 a[202:203], v203 offset:4096
v_mfma_f32_16x16x32_bf16 v[116:119], a[168:171], a[80:83], v[116:119]
ds_read_b64_tr_b16 a[204:205], v203 offset:8192
v_mfma_f32_16x16x32_bf16 v[116:119], a[172:175], a[84:87], v[116:119]
ds_read_b64_tr_b16 a[206:207], v203 offset:12288
v_mfma_f32_16x16x32_bf16 v[148:151], a[172:175], a[92:95], v[148:151]
buffer_load_dword v19, off, s[52:55], s72 sc1
v_mfma_f32_16x16x32_bf16 v[148:151], a[168:171], a[88:91], v[148:151]
v_mfma_f32_16x16x32_bf16 v[120:123], a[176:179], a[88:91], v[120:123]
v_mfma_f32_16x16x32_bf16 v[120:123], a[180:183], a[92:95], v[120:123]
v_mfma_f32_16x16x32_bf16 v[88:91], a[180:183], a[84:87], v[88:91]
v_mfma_f32_16x16x32_bf16 v[88:91], a[176:179], a[80:83], v[88:91]
s_branch L_po25
L_pg25:
s_branch L_tr2
L_po25:
v_mfma_f32_16x16x32_bf16 v[56:59], a[176:179], a[72:75], v[56:59]
v_mfma_f32_16x16x32_bf16 v[56:59], a[180:183], a[76:79], v[56:59]
v_mfma_f32_16x16x32_bf16 v[24:27], a[180:183], a[68:71], v[24:27]
v_mfma_f32_16x16x32_bf16 v[24:27], a[176:179], a[64:67], v[24:27]
v_mfma_f32_16x16x32_bf16 v[28:31], a[184:187], a[64:67], v[28:31]
v_mfma_f32_16x16x32_bf16 v[28:31], a[188:191], a[68:71], v[28:31]
v_mfma_f32_16x16x32_bf16 v[60:63], a[188:191], a[76:79], v[60:63]
v_mfma_f32_16x16x32_bf16 v[60:63], a[184:187], a[72:75], v[60:63]
s_waitcnt vmcnt(17)
s_barrier
v_mfma_f32_16x16x32_bf16 v[92:95], a[184:187], a[80:83], v[92:95]
ds_read_b64_tr_b16 a[144:145], v188 offset:0
v_mfma_f32_16x16x32_bf16 v[92:95], a[188:191], a[84:87], v[92:95]
ds_read_b64_tr_b16 a[146:147], v188 offset:4096
v_mfma_f32_16x16x32_bf16 v[124:127], a[188:191], a[92:95], v[124:127]
s_xor_b32 m0, s76, 32768
ds_read_b64_tr_b16 a[148:149], v188 offset:8192
v_mfma_f32_16x16x32_bf16 v[124:127], a[184:187], a[88:91], v[124:127]
s_waitcnt lgkmcnt(3)
s_xor_b32 s64, s85, 262144
ds_read_b64_tr_b16 a[150:151], v188 offset:12288
v_mfma_f32_16x16x32_bf16 v[128:131], a[192:195], a[88:91], v[128:131]
buffer_load_dwordx4 v12, s[40:43], s64 offen lds
v_mfma_f32_16x16x32_bf16 v[128:131], a[196:199], a[92:95], v[128:131]
s_xor_b32 m0, s76, 33792
s_xor_b32 s64, s85, 270336
ds_read_b64_tr_b16 a[152:153], v189 offset:0
v_mfma_f32_16x16x32_bf16 v[96:99], a[196:199], a[84:87], v[96:99]
buffer_load_dwordx4 v13, s[40:43], s64 offen lds
v_mfma_f32_16x16x32_bf16 v[96:99], a[192:195], a[80:83], v[96:99]
s_xor_b32 m0, s76, 34816
ds_read_b64_tr_b16 a[154:155], v189 offset:4096
v_mfma_f32_16x16x32_bf16 v[64:67], a[192:195], a[72:75], v[64:67]
s_xor_b32 s64, s85, 278528
ds_read_b64_tr_b16 a[156:157], v189 offset:8192
v_mfma_f32_16x16x32_bf16 v[64:67], a[196:199], a[76:79], v[64:67]
buffer_load_dwordx4 v12, s[40:43], s64 offen lds
v_mfma_f32_16x16x32_bf16 v[32:35], a[196:199], a[68:71], v[32:35]
s_xor_b32 m0, s76, 35840
ds_read_b64_tr_b16 a[158:159], v189 offset:12288
v_mfma_f32_16x16x32_bf16 v[32:35], a[192:195], a[64:67], v[32:35]
s_xor_b32 s64, s85, 286720
ds_read_b64_tr_b16 a[160:161], v190 offset:0
v_mfma_f32_16x16x32_bf16 v[36:39], a[200:203], a[64:67], v[36:39]
buffer_load_dwordx4 v13, s[40:43], s64 offen lds
v_mfma_f32_16x16x32_bf16 v[36:39], a[204:207], a[68:71], v[36:39]
s_xor_b32 m0, s76, 36864
s_xor_b32 s64, s85, 294912
ds_read_b64_tr_b16 a[162:163], v190 offset:4096
v_mfma_f32_16x16x32_bf16 v[68:71], a[204:207], a[76:79], v[68:71]
buffer_load_dwordx4 v12, s[40:43], s64 offen lds
v_mfma_f32_16x16x32_bf16 v[68:71], a[200:203], a[72:75], v[68:71]
s_xor_b32 m0, s76, 37888
ds_read_b64_tr_b16 a[164:165], v190 offset:8192
v_mfma_f32_16x16x32_bf16 v[100:103], a[200:203], a[80:83], v[100:103]
s_xor_b32 s64, s85, 303104
ds_read_b64_tr_b16 a[166:167], v190 offset:12288
v_mfma_f32_16x16x32_bf16 v[100:103], a[204:207], a[84:87], v[100:103]
buffer_load_dwordx4 v13, s[40:43], s64 offen lds
v_mfma_f32_16x16x32_bf16 v[132:135], a[204:207], a[92:95], v[132:135]
v_mfma_f32_16x16x32_bf16 v[132:135], a[200:203], a[88:91], v[132:135]
s_waitcnt vmcnt(19)
s_waitcnt lgkmcnt(3)
v_mfma_f32_16x16x32_bf16 v[136:139], a[144:147], a[56:59], v[136:139]
s_waitcnt vmcnt(6)
v_readfirstlane_b32 vcc_lo, v19
s_nop 0
s_cmp_lt_u32 vcc_lo, 8
s_cbranch_scc1 L_spin_3019
L_spinbk_3020:
s_sub_u32 s84, s84, 1048576
s_add_u32 s84, s84, s69
v_mfma_f32_16x16x32_bf16 v[136:139], a[148:151], a[60:63], v[136:139]
s_xor_b32 s65, s84, 0
ds_read_b64_tr_b16 a[168:169], v191 offset:0
v_mfma_f32_16x16x32_bf16 v[104:107], a[148:151], a[52:55], v[104:107]
buffer_load_dwordx4 a[208:211], v14, s[44:47], s65 offen offset:0 sc1
v_mfma_f32_16x16x32_bf16 v[104:107], a[144:147], a[48:51], v[104:107]
ds_read_b64_tr_b16 a[170:171], v191 offset:4096
v_mfma_f32_16x16x32_bf16 v[72:75], a[144:147], a[40:43], v[72:75]
buffer_load_dwordx4 a[216:219], v14, s[44:47], s65 offen offset:1024 sc1
v_mfma_f32_16x16x32_bf16 v[72:75], a[148:151], a[44:47], v[72:75]
ds_read_b64_tr_b16 a[172:173], v191 offset:8192
v_mfma_f32_16x16x32_bf16 v[40:43], a[148:151], a[36:39], v[40:43]
buffer_load_dwordx4 a[224:227], v15, s[44:47], s65 offen offset:0 sc1
v_mfma_f32_16x16x32_bf16 v[40:43], a[144:147], a[32:35], v[40:43]
ds_read_b64_tr_b16 a[174:175], v191 offset:12288
v_mfma_f32_16x16x32_bf16 v[44:47], a[152:155], a[32:35], v[44:47]
buffer_load_dwordx4 a[232:235], v15, s[44:47], s65 offen offset:1024 sc1
v_mfma_f32_16x16x32_bf16 v[44:47], a[156:159], a[36:39], v[44:47]
s_xor_b32 s65, s84, 8192
ds_read_b64_tr_b16 a[176:177], v184 offset:0
v_mfma_f32_16x16x32_bf16 v[76:79], a[156:159], a[44:47], v[76:79]
buffer_load_dwordx4 a[212:215], v14, s[44:47], s65 offen offset:0 sc1
v_mfma_f32_16x16x32_bf16 v[76:79], a[152:155], a[40:43], v[76:79]
ds_read_b64_tr_b16 a[178:179], v184 offset:4096
v_mfma_f32_16x16x32_bf16 v[108:111], a[152:155], a[48:51], v[108:111]
ds_read_b64_tr_b16 a[180:181], v184 offset:8192
v_mfma_f32_16x16x32_bf16 v[108:111], a[156:159], a[52:55], v[108:111]
buffer_load_dwordx4 a[220:223], v14, s[44:47], s65 offen offset:1024 sc1
v_mfma_f32_16x16x32_bf16 v[140:143], a[156:159], a[60:63], v[140:143]
ds_read_b64_tr_b16 a[182:183], v184 offset:12288
v_mfma_f32_16x16x32_bf16 v[140:143], a[152:155], a[56:59], v[140:143]
s_waitcnt lgkmcnt(4)
buffer_load_dwordx4 a[228:231], v15, s[44:47], s65 offen offset:0 sc1
v_mfma_f32_16x16x32_bf16 v[144:147], a[160:163], a[56:59], v[144:147]
ds_read_b64_tr_b16 a[184:185], v185 offset:0
v_mfma_f32_16x16x32_bf16 v[144:147], a[164:167], a[60:63], v[144:147]
buffer_load_dwordx4 a[236:239], v15, s[44:47], s65 offen offset:1024 sc1
v_mfma_f32_16x16x32_bf16 v[112:115], a[164:167], a[52:55], v[112:115]
s_xor_b32 m0, s76, 38912
s_xor_b32 s64, s85, 311296
ds_read_b64_tr_b16 a[186:187], v185 offset:4096
v_mfma_f32_16x16x32_bf16 v[112:115], a[160:163], a[48:51], v[112:115]
buffer_load_dwordx4 v12, s[40:43], s64 offen lds
v_mfma_f32_16x16x32_bf16 v[80:83], a[160:163], a[40:43], v[80:83]
s_xor_b32 m0, s76, 39936
ds_read_b64_tr_b16 a[188:189], v185 offset:8192
v_mfma_f32_16x16x32_bf16 v[80:83], a[164:167], a[44:47], v[80:83]
s_xor_b32 s64, s85, 319488
ds_read_b64_tr_b16 a[190:191], v185 offset:12288
v_mfma_f32_16x16x32_bf16 v[48:51], a[164:167], a[36:39], v[48:51]
buffer_load_dwordx4 v13, s[40:43], s64 offen lds
v_mfma_f32_16x16x32_bf16 v[48:51], a[160:163], a[32:35], v[48:51]
s_xor_b32 s65, s84, 32768
ds_read_b64_tr_b16 a[192:193], v186 offset:0
v_mfma_f32_16x16x32_bf16 v[52:55], a[168:171], a[32:35], v[52:55]
buffer_load_dwordx4 v[152:155], v14, s[44:47], s65 offen offset:0 sc1
v_mfma_f32_16x16x32_bf16 v[52:55], a[172:175], a[36:39], v[52:55]
ds_read_b64_tr_b16 a[194:195], v186 offset:4096
v_mfma_f32_16x16x32_bf16 v[84:87], a[172:175], a[44:47], v[84:87]
buffer_load_dwordx4 v[160:163], v14, s[44:47], s65 offen offset:1024 sc1
v_mfma_f32_16x16x32_bf16 v[84:87], a[168:171], a[40:43], v[84:87]
ds_read_b64_tr_b16 a[196:197], v186 offset:8192
v_mfma_f32_16x16x32_bf16 v[116:119], a[168:171], a[48:51], v[116:119]
buffer_load_dwordx4 v[168:171], v15, s[44:47], s65 offen offset:0 sc1
v_mfma_f32_16x16x32_bf16 v[116:119], a[172:175], a[52:55], v[116:119]
ds_read_b64_tr_b16 a[198:199], v186 offset:12288
v_mfma_f32_16x16x32_bf16 v[148:151], a[172:175], a[60:63], v[148:151]
buffer_load_dwordx4 v[176:179], v15, s[44:47], s65 offen offset:1024 sc1
v_mfma_f32_16x16x32_bf16 v[148:151], a[168:171], a[56:59], v[148:151]
s_waitcnt lgkmcnt(3)
ds_read_b64_tr_b16 a[200:201], v187 offset:0
v_mfma_f32_16x16x32_bf16 v[120:123], a[176:179], a[56:59], v[120:123]
s_xor_b32 s65, s84, 40960
ds_read_b64_tr_b16 a[202:203], v187 offset:4096
v_mfma_f32_16x16x32_bf16 v[120:123], a[180:183], a[60:63], v[120:123]
buffer_load_dwordx4 v[156:159], v14, s[44:47], s65 offen offset:0 sc1
v_mfma_f32_16x16x32_bf16 v[88:91], a[180:183], a[52:55], v[88:91]
ds_read_b64_tr_b16 a[204:205], v187 offset:8192
v_mfma_f32_16x16x32_bf16 v[88:91], a[176:179], a[48:51], v[88:91]
buffer_load_dwordx4 v[164:167], v14, s[44:47], s65 offen offset:1024 sc1
v_mfma_f32_16x16x32_bf16 v[56:59], a[176:179], a[40:43], v[56:59]
ds_read_b64_tr_b16 a[206:207], v187 offset:12288
v_mfma_f32_16x16x32_bf16 v[56:59], a[180:183], a[44:47], v[56:59]
buffer_load_dwordx4 v[172:175], v15, s[44:47], s65 offen offset:0 sc1
v_mfma_f32_16x16x32_bf16 v[24:27], a[180:183], a[36:39], v[24:27]
v_mfma_f32_16x16x32_bf16 v[24:27], a[176:179], a[32:35], v[24:27]
buffer_load_dwordx4 v[180:183], v15, s[44:47], s65 offen offset:1024 sc1
v_mfma_f32_16x16x32_bf16 v[28:31], a[184:187], a[32:35], v[28:31]
v_mfma_f32_16x16x32_bf16 v[28:31], a[188:191], a[36:39], v[28:31]
v_mfma_f32_16x16x32_bf16 v[60:63], a[188:191], a[44:47], v[60:63]
v_mfma_f32_16x16x32_bf16 v[60:63], a[184:187], a[40:43], v[60:63]
s_barrier
v_mfma_f32_16x16x32_bf16 v[92:95], a[184:187], a[48:51], v[92:95]
ds_read_b64_tr_b16 a[144:145], v188 offset:32768
v_mfma_f32_16x16x32_bf16 v[92:95], a[188:191], a[52:55], v[92:95]
ds_read_b64_tr_b16 a[146:147], v188 offset:36864
v_mfma_f32_16x16x32_bf16 v[124:127], a[188:191], a[60:63], v[124:127]
s_xor_b32 m0, s76, 65536
ds_read_b64_tr_b16 a[148:149], v188 offset:40960
v_mfma_f32_16x16x32_bf16 v[124:127], a[184:187], a[56:59], v[124:127]
s_waitcnt lgkmcnt(3)
s_xor_b32 s64, s85, 524288
ds_read_b64_tr_b16 a[150:151], v188 offset:45056
v_mfma_f32_16x16x32_bf16 v[128:131], a[192:195], a[56:59], v[128:131]
buffer_load_dwordx4 v12, s[40:43], s64 offen lds
v_mfma_f32_16x16x32_bf16 v[128:131], a[196:199], a[60:63], v[128:131]
s_xor_b32 m0, s76, 66560
ds_read_b64_tr_b16 a[152:153], v189 offset:32768
v_mfma_f32_16x16x32_bf16 v[96:99], a[196:199], a[52:55], v[96:99]
s_xor_b32 s64, s85, 532480
ds_read_b64_tr_b16 a[154:155], v189 offset:36864
v_mfma_f32_16x16x32_bf16 v[96:99], a[192:195], a[48:51], v[96:99]
buffer_load_dwordx4 v13, s[40:43], s64 offen lds
v_mfma_f32_16x16x32_bf16 v[64:67], a[192:195], a[40:43], v[64:67]
s_xor_b32 m0, s76, 67584
ds_read_b64_tr_b16 a[156:157], v189 offset:40960
v_mfma_f32_16x16x32_bf16 v[64:67], a[196:199], a[44:47], v[64:67]
s_xor_b32 s64, s85, 540672
ds_read_b64_tr_b16 a[158:159], v189 offset:45056
v_mfma_f32_16x16x32_bf16 v[32:35], a[196:199], a[36:39], v[32:35]
buffer_load_dwordx4 v12, s[40:43], s64 offen lds
v_mfma_f32_16x16x32_bf16 v[32:35], a[192:195], a[32:35], v[32:35]
s_xor_b32 m0, s76, 68608
ds_read_b64_tr_b16 a[160:161], v190 offset:32768
v_mfma_f32_16x16x32_bf16 v[36:39], a[200:203], a[32:35], v[36:39]
s_xor_b32 s64, s85, 548864
ds_read_b64_tr_b16 a[162:163], v190 offset:36864
v_mfma_f32_16x16x32_bf16 v[36:39], a[204:207], a[36:39], v[36:39]
buffer_load_dwordx4 v13, s[40:43], s64 offen lds
v_mfma_f32_16x16x32_bf16 v[68:71], a[204:207], a[44:47], v[68:71]
s_xor_b32 m0, s76, 69632
ds_read_b64_tr_b16 a[164:165], v190 offset:40960
v_mfma_f32_16x16x32_bf16 v[68:71], a[200:203], a[40:43], v[68:71]
s_xor_b32 s64, s85, 557056
ds_read_b64_tr_b16 a[166:167], v190 offset:45056
v_mfma_f32_16x16x32_bf16 v[100:103], a[200:203], a[48:51], v[100:103]
buffer_load_dwordx4 v12, s[40:43], s64 offen lds
v_mfma_f32_16x16x32_bf16 v[100:103], a[204:207], a[52:55], v[100:103]
s_mov_b32 s70, 3
s_mov_b32 s73, 2
v_mfma_f32_16x16x32_bf16 v[132:135], a[204:207], a[60:63], v[132:135]
v_mfma_f32_16x16x32_bf16 v[132:135], a[200:203], a[56:59], v[132:135]
s_branch L_p5join
L_spin_4022:
s_mov_b32 vcc_hi, 0x80000
L_spinlp_4024:
s_sleep 1
buffer_load_dword v19, off, s[52:55], s72 offset:128 sc1
s_waitcnt vmcnt(0)
v_readfirstlane_b32 vcc_lo, v19
s_sub_u32 vcc_hi, vcc_hi, 1
s_cbranch_scc1 L_spinbk_4023
s_cmp_lt_u32 vcc_lo, s74
s_cbranch_scc1 L_spinlp_4024
s_branch L_spinbk_4023
L_codeend:
.section .rodata,"a"
.p2align 6
.amdhsa_kernel gated_mix__compressed_kv_cla__sliding_local_dilated__prompt_kernel
  .amdhsa_next_free_vgpr 512
  .amdhsa_next_free_sgpr 102
  .amdhsa_accum_offset 256
  .amdhsa_group_segment_fixed_size 0
  .amdhsa_kernarg_size 104
  .amdhsa_user_sgpr_count 2
  .amdhsa_user_sgpr_kernarg_segment_ptr 1
  .amdhsa_system_sgpr_workgroup_id_x 1
.end_amdhsa_kernel
```

```asm
; @launch grid=(256,1,1) block=(256,1,1) lds=163840
.amdgcn_target "amdgcn-amd-amdhsa--gfx950"
.text
.globl gated_mix__compressed_kv_cla__sliding_local_dilated__prompt_kernel
.p2align 8
.type gated_mix__compressed_kv_cla__sliding_local_dilated__prompt_kernel,@function
gated_mix__compressed_kv_cla__sliding_local_dilated__prompt_kernel:
s_cmp_ge_u32 s2, 256
s_cbranch_scc1 L_end
s_load_dwordx16 s[4:19], s[0:1], 0
s_load_dwordx8 s[20:27], s[0:1], 64
s_load_dwordx2 s[28:29], s[0:1], 96
s_getpc_b64 s[88:89]
L_pc:
v_lshrrev_b32 v1, 6, v0
s_lshr_b32 s67, s2, 3
v_lshl_add_u32 v24, s67, 2, v1
s_mov_b32 s90, L_codeend-L_pc
s_mov_b32 s91, 0x20000
v_and_b32 v25, 7, v0
v_lshlrev_b32 v25, 7, v25
v_lshl_add_u32 v24, v24, 10, v25
buffer_load_dword a252, v24, s[88:91], 0 offen
v_and_b32 v0, 63, v0
v_readfirstlane_b32 s30, v1
v_lshrrev_b32 v24, 3, v0
v_lshrrev_b32 v25, 4, v0
v_and_b32 v26, 7, v0
v_xor_b32 v26, v26, v25
v_lshlrev_b32 v26, 4, v26
v_lshl_add_u32 v12, v24, 10, v26
v_xor_b32 v13, 64, v12
v_bfe_u32 v26, v0, 1, 3
v_xor_b32 v26, v26, v25
v_lshlrev_b32 v26, 5, v26
v_and_b32 v24, 1, v0
v_lshl_add_u32 v26, v24, 4, v26
v_lshl_add_u32 v14, v25, 13, v26
v_xor_b32 v15, 128, v14
s_and_b32 s66, s2, 7
s_and_b32 s68, s67, 3
s_lshl2_add_u32 s31, s66, s68
s_cmp_eq_u32 s68, 0
s_cselect_b32 s90, s90, 0
s_lshr_b32 s3, s67, 2
s_lshl2_add_u32 s80, s67, s30
s_lshl_b32 s70, s3, 18
s_lshl_b32 s66, s30, 16
s_add_u32 s70, s70, s66
s_lshl_b32 s71, s30, 17
s_lshl_b32 s66, s31, 8
s_add_u32 s71, s71, s66
s_lshl_b32 s76, s30, 13
s_lshl_b32 s77, s30, 12
s_lshl_b32 s78, s30, 10
s_cmp_eq_u32 s30, 0
s_cbranch_scc1 L_pg1
s_cmp_eq_u32 s30, 1
s_cbranch_scc1 L_tr9
s_cmp_eq_u32 s30, 2
s_cbranch_scc1 L_tr9
s_branch L_tr9
L_tr9:
s_waitcnt lgkmcnt(0)
s_mov_b32 s32, s6
s_mov_b32 s33, s7
s_mov_b32 s34, 2097152
s_mov_b32 s35, 0x20000
s_mov_b32 s36, s10
s_mov_b32 s37, s11
s_mov_b32 s38, 4194304
s_mov_b32 s39, 0x20000
s_mov_b32 s40, s12
s_mov_b32 s41, s13
s_mov_b32 s42, 4194304
s_mov_b32 s43, 0x20000
s_xor_b32 m0, s76, 0
s_xor_b32 s64, s70, 0
buffer_load_dwordx4 v12, s[32:35], s64 offen lds
s_xor_b32 m0, s76, 1024
s_xor_b32 s64, s70, 8192
buffer_load_dwordx4 v13, s[32:35], s64 offen lds
s_xor_b32 m0, s76, 2048
s_xor_b32 s64, s70, 16384
buffer_load_dwordx4 v12, s[32:35], s64 offen lds
s_xor_b32 m0, s76, 3072
s_xor_b32 s64, s70, 24576
buffer_load_dwordx4 v13, s[32:35], s64 offen lds
s_xor_b32 m0, s77, 65536
s_xor_b32 s64, s71, 0
buffer_load_dwordx4 v14, s[36:39], s64 offen lds
s_xor_b32 m0, s77, 66560
s_xor_b32 s64, s71, 32768
buffer_load_dwordx4 v14, s[36:39], s64 offen lds
s_xor_b32 m0, s77, 67584
s_xor_b32 s64, s71, 65536
buffer_load_dwordx4 v15, s[36:39], s64 offen lds
s_xor_b32 m0, s77, 68608
s_xor_b32 s64, s71, 98304
buffer_load_dwordx4 v15, s[36:39], s64 offen lds
s_mov_b32 s44, s28
s_mov_b32 s45, s29
s_mov_b32 s46, 134217728
s_mov_b32 s47, 0x20000
s_mov_b32 s48, s4
s_mov_b32 s49, s5
s_mov_b32 s50, 4194304
s_mov_b32 s51, 0x20000
s_mov_b32 s52, s26
s_mov_b32 s53, s27
s_mov_b32 s54, 256
s_mov_b32 s55, 0x20000
s_mov_b32 s56, s8
s_mov_b32 s57, s9
s_mov_b32 s58, 8388608
s_mov_b32 s59, 0x20000
s_mov_b32 s60, s18
s_mov_b32 s61, s19
s_mov_b32 s62, 6291456
s_mov_b32 s63, 0x20000
v_accvgpr_write_b32 a251, 1
v_and_b32 v24, 15, v0
v_lshrrev_b32 v26, 1, v24
v_xor_b32 v26, v26, v25
v_lshlrev_b32 v26, 4, v26
v_lshl_add_u32 v26, v24, 7, v26
v_add_u32 v2, s76, v26
v_xor_b32 v3, 64, v2
v_bfe_u32 v24, v0, 2, 2
v_lshl_add_u32 v27, v25, 3, v24
v_and_b32 v1, 3, v0
v_cmp_eq_u32 vcc, 0, v1
v_lshlrev_b32 v1, 3, v1
v_lshl_add_u32 v26, v27, 8, v1
v_add_u32 v26, 65536, v26
v_and_b32 v1, 1, v25
v_lshl_add_u32 v24, v1, 2, v24
v_lshlrev_b32 v16, 4, v0
v_mov_b32 v28, 0x3f803f80
v_cndmask_b32 v28, 0, v28, vcc
v_accvgpr_write_b32 a244, v28
v_accvgpr_write_b32 a245, v28
v_accvgpr_write_b32 a246, v28
v_accvgpr_write_b32 a247, v28
v_xor_b32 v1, 0, v24
v_lshl_add_u32 v4, v1, 5, v26
v_xor_b32 v1, 1, v24
v_lshl_add_u32 v5, v1, 5, v26
v_xor_b32 v1, 2, v24
v_lshl_add_u32 v6, v1, 5, v26
v_xor_b32 v1, 3, v24
v_lshl_add_u32 v7, v1, 5, v26
v_xor_b32 v1, 4, v24
v_lshl_add_u32 v8, v1, 5, v26
v_xor_b32 v1, 5, v24
v_lshl_add_u32 v9, v1, 5, v26
v_xor_b32 v1, 6, v24
v_lshl_add_u32 v10, v1, 5, v26
v_xor_b32 v1, 7, v24
v_lshl_add_u32 v11, v1, 5, v26
s_sub_u32 s16, 15, s3
s_lshl_b32 s72, s3, 18
s_lshl_b32 s73, s16, 18
s_cmp_lt_u32 s30, 2
s_cselect_b32 s67, s3, s16
s_lshl4_add_u32 s74, s31, s67
s_and_b32 s66, s30, 1
s_lshl1_add_u32 s74, s74, s66
s_lshl_b32 s74, s74, 10
s_add_u32 s74, s74, 60817408
s_lshl_b32 s66, s30, 15
s_add_u32 s72, s72, s66
s_add_u32 s73, s73, s66
s_mul_i32 s75, s30, 98304
s_lshl_b32 s66, s31, 6
s_add_u32 s75, s75, s66
s_lshl_b32 s79, s31, 20
s_lshl_b32 s66, s3, 17
s_add_u32 s79, s79, s66
s_lshl_b32 s66, s30, 15
s_add_u32 s79, s79, s66
v_bfe_u32 v23, v0, 1, 1
v_lshrrev_b32 v1, 5, v0
v_xor_b32 v23, v23, v1
v_lshlrev_b32 v23, 5, v23
v_and_b32 v1, 1, v0
v_lshl_add_u32 v23, v1, 4, v23
v_lshrrev_b32 v1, 2, v0
v_mul_u32_u24 v1, 6144, v1
v_add_u32 v23, v1, v23
s_lshl_b32 s81, s80, 13
s_and_b32 s67, s2, 7
s_lshl_b32 s82, s67, 8
s_add_u32 s82, s82, s81
s_lshl_b32 s67, s67, 10
s_add_u32 s81, s81, s67
s_add_u32 s83, s81, 1048576
v_mul_u32_u24 v1, 1792, v25
v_add_u32 v1, v1, v16
s_lshl_b32 s68, s2, 3
s_lshl1_add_u32 s68, s30, s68
v_lshrrev_b32 v18, 5, v0
v_add_u32 v18, s68, v18
v_and_b32 v19, 31, v0
v_lshlrev_b32 v19, 4, v19
v_lshl_add_u32 v18, v18, 11, v19
v_mov_b32 v21, 0
v_min_u32 v20, 1, v0
v_lshlrev_b32 v20, 30, v20
v_accvgpr_write_b32 a240, -1
v_accvgpr_write_b32 a241, -1
v_accvgpr_write_b32 a242, -1
v_accvgpr_write_b32 a243, -1
s_lshr_b32 s69, s2, 7
s_or_b32 s69, s69, s30
s_lshl_b32 s69, s69, 21
s_add_u32 s69, s69, s2
s_lshl_b32 s69, s69, 7
s_add_u32 s69, s69, 59768832
s_cmp_eq_u32 s30, 0
s_cbranch_scc1 L_pg2
s_cmp_eq_u32 s30, 1
s_cbranch_scc1 L_pg3
s_cmp_eq_u32 s30, 2
s_cbranch_scc1 L_pg4
s_branch L_pg5
L_tr0:
s_branch L_base
.p2align 12
L_pg1:
s_branch L_tr9
L_base:
s_xor_b32 m0, s76, 4096
s_xor_b32 s64, s70, 32768
buffer_load_dwordx4 v12, s[32:35], s64 offen lds
s_xor_b32 m0, s76, 5120
s_xor_b32 s64, s70, 40960
buffer_load_dwordx4 v13, s[32:35], s64 offen lds
s_xor_b32 m0, s76, 6144
s_xor_b32 s64, s70, 49152
buffer_load_dwordx4 v12, s[32:35], s64 offen lds
s_xor_b32 m0, s76, 7168
s_xor_b32 s64, s70, 57344
buffer_load_dwordx4 v13, s[32:35], s64 offen lds
s_xor_b32 m0, s77, 81920
s_xor_b32 s64, s71, 0
buffer_load_dwordx4 v14, s[40:43], s64 offen lds
s_xor_b32 m0, s77, 82944
s_xor_b32 s64, s71, 32768
buffer_load_dwordx4 v14, s[40:43], s64 offen lds
s_xor_b32 m0, s77, 83968
s_xor_b32 s64, s71, 65536
buffer_load_dwordx4 v15, s[40:43], s64 offen lds
s_xor_b32 m0, s77, 84992
s_xor_b32 s64, s71, 98304
buffer_load_dwordx4 v15, s[40:43], s64 offen lds
s_and_b32 s66, s31, 3
s_lshl_b32 s67, s66, 11
s_add_u32 s84, s76, s67
s_lshl3_add_u32 s70, s67, s70
s_and_b32 s67, s66, 1
s_lshl_b32 s67, s67, 17
s_add_u32 s72, s72, s67
s_add_u32 s67, s73, s67
s_bitcmp1_b32 s66, 1
s_cselect_b32 s73, s72, s67
s_cselect_b32 s72, s67, s72
s_and_b32 s66, s3, 3
s_lshl_b32 s67, s66, 10
s_add_u32 s77, s77, s67
s_lshl_b32 s67, s66, 15
s_add_u32 s71, s71, s67
s_and_b32 s67, s66, 2
s_lshl_b32 s67, s67, 6
v_xor_b32 v14, s67, v14
v_xor_b32 v15, s67, v15
s_and_b32 s66, s3, 4
s_cselect_b64 s[36:37], s[12:13], s[10:11]
s_cselect_b64 s[40:41], s[10:11], s[12:13]
s_lshl_b32 s66, s66, 12
s_add_u32 s77, s77, s66
s_waitcnt vmcnt(8)
s_barrier
ds_read_b128 a[0:3], v2 offset:0
ds_read_b128 a[4:7], v3 offset:0
ds_read_b64_tr_b16 a[176:177], v4 offset:0
ds_read_b64_tr_b16 a[178:179], v4 offset:1024
ds_read_b64_tr_b16 a[180:181], v4 offset:8192
ds_read_b64_tr_b16 a[182:183], v4 offset:9216
ds_read_b128 a[8:11], v2 offset:2048
ds_read_b128 a[12:15], v3 offset:2048
ds_read_b64_tr_b16 a[184:185], v5 offset:0
ds_read_b64_tr_b16 a[186:187], v5 offset:1024
ds_read_b64_tr_b16 a[188:189], v5 offset:8192
ds_read_b64_tr_b16 a[190:191], v5 offset:9216
ds_read_b64_tr_b16 a[88:89], v6 offset:0
ds_read_b64_tr_b16 a[90:91], v6 offset:1024
ds_read_b64_tr_b16 a[92:93], v6 offset:8192
ds_read_b64_tr_b16 a[94:95], v6 offset:9216
s_waitcnt lgkmcnt(12)
v_mfma_f32_16x16x32_bf16 v[184:187], a[176:179], a[0:3], 0
s_waitcnt lgkmcnt(10)
s_xor_b32 m0, s77, 98304
ds_read_b64_tr_b16 a[96:97], v7 offset:0
v_mfma_f32_16x16x32_bf16 v[184:187], a[180:183], a[4:7], v[184:187]
s_waitcnt lgkmcnt(9)
s_xor_b32 s64, s71, 524288
ds_read_b64_tr_b16 a[98:99], v7 offset:1024
v_mfma_f32_16x16x32_bf16 v[192:195], a[180:183], a[12:15], 0
buffer_load_dwordx4 v14, s[36:39], s64 offen lds
v_mfma_f32_16x16x32_bf16 v[192:195], a[176:179], a[8:11], v[192:195]
s_waitcnt lgkmcnt(8)
ds_read_b64_tr_b16 a[100:101], v7 offset:8192
v_mfma_f32_16x16x32_bf16 v[196:199], a[184:187], a[8:11], 0
s_waitcnt lgkmcnt(7)
s_xor_b32 m0, s77, 99328
ds_read_b64_tr_b16 a[102:103], v7 offset:9216
v_mfma_f32_16x16x32_bf16 v[196:199], a[188:191], a[12:15], v[196:199]
s_xor_b32 s64, s71, 557056
ds_read_b64_tr_b16 a[104:105], v8 offset:0
v_mfma_f32_16x16x32_bf16 v[188:191], a[188:191], a[4:7], 0
buffer_load_dwordx4 v14, s[36:39], s64 offen lds
v_mfma_f32_16x16x32_bf16 v[188:191], a[184:187], a[0:3], v[188:191]
s_waitcnt lgkmcnt(7)
ds_read_b64_tr_b16 a[106:107], v8 offset:1024
v_mfma_f32_16x16x32_bf16 v[216:219], a[88:91], a[0:3], 0
s_waitcnt lgkmcnt(6)
s_xor_b32 m0, s77, 100352
ds_read_b64_tr_b16 a[108:109], v8 offset:8192
v_mfma_f32_16x16x32_bf16 v[216:219], a[92:95], a[4:7], v[216:219]
s_xor_b32 s64, s71, 589824
ds_read_b64_tr_b16 a[110:111], v8 offset:9216
v_mfma_f32_16x16x32_bf16 v[224:227], a[92:95], a[12:15], 0
buffer_load_dwordx4 v15, s[36:39], s64 offen lds
v_mfma_f32_16x16x32_bf16 v[224:227], a[88:91], a[8:11], v[224:227]
s_waitcnt lgkmcnt(6)
ds_read_b64_tr_b16 a[112:113], v9 offset:0
v_mfma_f32_16x16x32_bf16 v[228:231], a[96:99], a[8:11], 0
s_waitcnt lgkmcnt(5)
ds_read_b64_tr_b16 a[114:115], v9 offset:1024
v_mfma_f32_16x16x32_bf16 v[228:231], a[100:103], a[12:15], v[228:231]
s_xor_b32 m0, s77, 101376
ds_read_b64_tr_b16 a[116:117], v9 offset:8192
v_mfma_f32_16x16x32_bf16 v[220:223], a[100:103], a[4:7], 0
s_xor_b32 s64, s71, 622592
ds_read_b64_tr_b16 a[118:119], v9 offset:9216
v_mfma_f32_16x16x32_bf16 v[220:223], a[96:99], a[0:3], v[220:223]
s_waitcnt lgkmcnt(6)
buffer_load_dwordx4 v15, s[36:39], s64 offen lds
v_mfma_f32_16x16x32_bf16 v[152:155], a[104:107], a[0:3], 0
s_waitcnt lgkmcnt(4)
ds_read_b64_tr_b16 a[72:73], v10 offset:0
v_mfma_f32_16x16x32_bf16 v[152:155], a[108:111], a[4:7], v[152:155]
s_xor_b32 m0, s77, 114688
ds_read_b64_tr_b16 a[74:75], v10 offset:1024
v_mfma_f32_16x16x32_bf16 v[160:163], a[108:111], a[12:15], 0
s_xor_b32 s64, s71, 524288
ds_read_b64_tr_b16 a[76:77], v10 offset:8192
ds_read_b64_tr_b16 a[78:79], v10 offset:9216
v_mfma_f32_16x16x32_bf16 v[160:163], a[104:107], a[8:11], v[160:163]
s_waitcnt lgkmcnt(6)
buffer_load_dwordx4 v14, s[40:43], s64 offen lds
v_mfma_f32_16x16x32_bf16 v[164:167], a[112:115], a[8:11], 0
s_waitcnt lgkmcnt(4)
s_xor_b32 m0, s77, 115712
ds_read_b64_tr_b16 a[80:81], v11 offset:0
v_mfma_f32_16x16x32_bf16 v[164:167], a[116:119], a[12:15], v[164:167]
s_xor_b32 s64, s71, 557056
ds_read_b64_tr_b16 a[82:83], v11 offset:1024
v_mfma_f32_16x16x32_bf16 v[156:159], a[116:119], a[4:7], 0
ds_read_b64_tr_b16 a[84:85], v11 offset:8192
ds_read_b64_tr_b16 a[86:87], v11 offset:9216
s_waitcnt vmcnt(9)
v_mfma_f32_16x16x32_bf16 v[156:159], a[112:115], a[0:3], v[156:159]
s_waitcnt lgkmcnt(6)
buffer_load_dwordx4 v14, s[40:43], s64 offen lds
v_mfma_f32_16x16x32_bf16 v[24:27], a[72:75], a[0:3], 0
s_waitcnt lgkmcnt(4)
s_xor_b32 m0, s77, 116736
ds_read_b128 a[16:19], v2 offset:4096
ds_read_b128 a[20:23], v3 offset:4096
v_mfma_f32_16x16x32_bf16 v[24:27], a[76:79], a[4:7], v[24:27]
s_xor_b32 s64, s71, 589824
ds_read_b128 a[24:27], v2 offset:6144
ds_read_b128 a[28:31], v3 offset:6144
v_mfma_f32_16x16x32_bf16 v[40:43], a[76:79], a[12:15], 0
buffer_load_dwordx4 v15, s[40:43], s64 offen lds
v_mfma_f32_16x16x32_bf16 v[40:43], a[72:75], a[8:11], v[40:43]
s_waitcnt lgkmcnt(6)
v_mfma_f32_16x16x32_bf16 v[104:107], a[80:83], a[8:11], 0
s_waitcnt lgkmcnt(4)
s_xor_b32 m0, s77, 117760
v_mfma_f32_16x16x32_bf16 v[104:107], a[84:87], a[12:15], v[104:107]
s_xor_b32 s64, s71, 622592
v_mfma_f32_16x16x32_bf16 v[88:91], a[84:87], a[4:7], 0
buffer_load_dwordx4 v15, s[40:43], s64 offen lds
v_mfma_f32_16x16x32_bf16 v[88:91], a[80:83], a[0:3], v[88:91]
s_waitcnt lgkmcnt(3)
v_mfma_f32_16x16x32_bf16 v[232:235], a[88:91], a[16:19], 0
s_waitcnt lgkmcnt(2)
v_mfma_f32_16x16x32_bf16 v[232:235], a[92:95], a[20:23], v[232:235]
s_waitcnt lgkmcnt(0)
s_xor_b32 m0, s84, 32768
v_mfma_f32_16x16x32_bf16 v[240:243], a[92:95], a[28:31], 0
s_xor_b32 s64, s70, 128
v_mfma_f32_16x16x32_bf16 v[240:243], a[88:91], a[24:27], v[240:243]
buffer_load_dwordx4 v12, s[32:35], s64 offen lds
v_mfma_f32_16x16x32_bf16 v[244:247], a[96:99], a[24:27], 0
s_xor_b32 m0, s84, 33792
v_mfma_f32_16x16x32_bf16 v[244:247], a[100:103], a[28:31], v[244:247]
s_xor_b32 s64, s70, 8320
v_mfma_f32_16x16x32_bf16 v[236:239], a[100:103], a[20:23], 0
s_waitcnt vmcnt(9)
s_barrier
v_mfma_f32_16x16x32_bf16 v[236:239], a[96:99], a[16:19], v[236:239]
buffer_load_dwordx4 v13, s[32:35], s64 offen lds
v_mfma_f32_16x16x32_bf16 v[168:171], a[104:107], a[16:19], 0
ds_read_b64_tr_b16 a[88:89], v4 offset:16384
v_mfma_f32_16x16x32_bf16 v[168:171], a[108:111], a[20:23], v[168:171]
s_xor_b32 m0, s84, 34816
ds_read_b64_tr_b16 a[90:91], v4 offset:17408
v_mfma_f32_16x16x32_bf16 v[176:179], a[108:111], a[28:31], 0
s_xor_b32 s64, s70, 16512
ds_read_b64_tr_b16 a[92:93], v4 offset:24576
v_mfma_f32_16x16x32_bf16 v[176:179], a[104:107], a[24:27], v[176:179]
buffer_load_dwordx4 v12, s[32:35], s64 offen lds
v_mfma_f32_16x16x32_bf16 v[180:183], a[112:115], a[24:27], 0
ds_read_b64_tr_b16 a[94:95], v4 offset:25600
v_mfma_f32_16x16x32_bf16 v[180:183], a[116:119], a[28:31], v[180:183]
s_xor_b32 m0, s84, 35840
ds_read_b64_tr_b16 a[96:97], v5 offset:16384
v_mfma_f32_16x16x32_bf16 v[172:175], a[116:119], a[20:23], 0
s_xor_b32 s64, s70, 24704
ds_read_b64_tr_b16 a[98:99], v5 offset:17408
v_mfma_f32_16x16x32_bf16 v[172:175], a[112:115], a[16:19], v[172:175]
buffer_load_dwordx4 v13, s[32:35], s64 offen lds
v_mfma_f32_16x16x32_bf16 v[56:59], a[72:75], a[16:19], 0
ds_read_b64_tr_b16 a[100:101], v5 offset:24576
v_mfma_f32_16x16x32_bf16 v[56:59], a[76:79], a[20:23], v[56:59]
s_xor_b32 m0, s84, 36864
ds_read_b64_tr_b16 a[102:103], v5 offset:25600
v_mfma_f32_16x16x32_bf16 v[72:75], a[76:79], a[28:31], 0
s_xor_b32 s64, s70, 32896
ds_read_b64_tr_b16 a[104:105], v6 offset:16384
v_mfma_f32_16x16x32_bf16 v[72:75], a[72:75], a[24:27], v[72:75]
buffer_load_dwordx4 v12, s[32:35], s64 offen lds
v_mfma_f32_16x16x32_bf16 v[136:139], a[80:83], a[24:27], 0
ds_read_b64_tr_b16 a[106:107], v6 offset:17408
v_mfma_f32_16x16x32_bf16 v[136:139], a[84:87], a[28:31], v[136:139]
s_xor_b32 m0, s84, 37888
ds_read_b64_tr_b16 a[108:109], v6 offset:24576
v_mfma_f32_16x16x32_bf16 v[120:123], a[84:87], a[20:23], 0
s_xor_b32 s64, s70, 41088
ds_read_b64_tr_b16 a[110:111], v6 offset:25600
v_mfma_f32_16x16x32_bf16 v[120:123], a[80:83], a[16:19], v[120:123]
buffer_load_dwordx4 v13, s[32:35], s64 offen lds
v_mfma_f32_16x16x32_bf16 v[200:203], a[176:179], a[16:19], 0
ds_read_b64_tr_b16 a[112:113], v7 offset:16384
v_mfma_f32_16x16x32_bf16 v[200:203], a[180:183], a[20:23], v[200:203]
s_xor_b32 m0, s84, 38912
ds_read_b64_tr_b16 a[114:115], v7 offset:17408
v_mfma_f32_16x16x32_bf16 v[208:211], a[180:183], a[28:31], 0
s_xor_b32 s64, s70, 49280
ds_read_b64_tr_b16 a[116:117], v7 offset:24576
v_mfma_f32_16x16x32_bf16 v[208:211], a[176:179], a[24:27], v[208:211]
buffer_load_dwordx4 v12, s[32:35], s64 offen lds
v_mfma_f32_16x16x32_bf16 v[212:215], a[184:187], a[24:27], 0
ds_read_b64_tr_b16 a[118:119], v7 offset:25600
v_mfma_f32_16x16x32_bf16 v[212:215], a[188:191], a[28:31], v[212:215]
s_xor_b32 m0, s84, 39936
ds_read_b64_tr_b16 a[72:73], v8 offset:16384
v_mfma_f32_16x16x32_bf16 v[204:207], a[188:191], a[20:23], 0
s_xor_b32 s64, s70, 57472
ds_read_b64_tr_b16 a[74:75], v8 offset:17408
v_mfma_f32_16x16x32_bf16 v[204:207], a[184:187], a[16:19], v[204:207]
s_waitcnt lgkmcnt(7)
buffer_load_dwordx4 v13, s[32:35], s64 offen lds
v_mfma_f32_16x16x32_bf16 v[28:31], a[0:3], a[88:91], 0
ds_read_b64_tr_b16 a[76:77], v8 offset:24576
v_mfma_f32_16x16x32_bf16 v[28:31], a[4:7], a[92:95], v[28:31]
ds_read_b64_tr_b16 a[78:79], v8 offset:25600
v_mfma_f32_16x16x32_bf16 v[44:47], a[12:15], a[92:95], 0
ds_read_b64_tr_b16 a[80:81], v9 offset:16384
v_mfma_f32_16x16x32_bf16 v[44:47], a[8:11], a[88:91], v[44:47]
ds_read_b64_tr_b16 a[82:83], v9 offset:17408
v_mfma_f32_16x16x32_bf16 v[60:63], a[16:19], a[88:91], 0
s_xor_b32 m0, s77, 131072
ds_read_b64_tr_b16 a[84:85], v9 offset:24576
v_mfma_f32_16x16x32_bf16 v[60:63], a[20:23], a[92:95], v[60:63]
s_xor_b32 s64, s71, 1048576
ds_read_b64_tr_b16 a[86:87], v9 offset:25600
v_mfma_f32_16x16x32_bf16 v[76:79], a[28:31], a[92:95], 0
buffer_load_dwordx4 v14, s[36:39], s64 offen lds
v_mfma_f32_16x16x32_bf16 v[76:79], a[24:27], a[88:91], v[76:79]
s_xor_b32 m0, s77, 132096
ds_read_b64_tr_b16 a[88:89], v10 offset:16384
v_mfma_f32_16x16x32_bf16 v[140:143], a[24:27], a[96:99], 0
s_xor_b32 s64, s71, 1081344
ds_read_b64_tr_b16 a[90:91], v10 offset:17408
v_mfma_f32_16x16x32_bf16 v[140:143], a[28:31], a[100:103], v[140:143]
buffer_load_dwordx4 v14, s[36:39], s64 offen lds
v_mfma_f32_16x16x32_bf16 v[124:127], a[20:23], a[100:103], 0
ds_read_b64_tr_b16 a[92:93], v10 offset:24576
v_mfma_f32_16x16x32_bf16 v[124:127], a[16:19], a[96:99], v[124:127]
s_xor_b32 m0, s77, 133120
ds_read_b64_tr_b16 a[94:95], v10 offset:25600
v_mfma_f32_16x16x32_bf16 v[108:111], a[8:11], a[96:99], 0
s_xor_b32 s64, s71, 1114112
v_mfma_f32_16x16x32_bf16 v[108:111], a[12:15], a[100:103], v[108:111]
buffer_load_dwordx4 v15, s[36:39], s64 offen lds
v_mfma_f32_16x16x32_bf16 v[92:95], a[4:7], a[100:103], 0
v_mfma_f32_16x16x32_bf16 v[92:95], a[0:3], a[96:99], v[92:95]
s_xor_b32 m0, s77, 134144
ds_read_b64_tr_b16 a[96:97], v11 offset:16384
v_mfma_f32_16x16x32_bf16 v[32:35], a[0:3], a[104:107], 0
s_waitcnt lgkmcnt(5)
s_xor_b32 s64, s71, 1146880
ds_read_b64_tr_b16 a[98:99], v11 offset:17408
v_mfma_f32_16x16x32_bf16 v[32:35], a[4:7], a[108:111], v[32:35]
buffer_load_dwordx4 v15, s[36:39], s64 offen lds
v_mfma_f32_16x16x32_bf16 v[48:51], a[12:15], a[108:111], 0
ds_read_b64_tr_b16 a[100:101], v11 offset:24576
v_mfma_f32_16x16x32_bf16 v[48:51], a[8:11], a[104:107], v[48:51]
s_xor_b32 m0, s77, 147456
ds_read_b64_tr_b16 a[102:103], v11 offset:25600
v_mfma_f32_16x16x32_bf16 v[64:67], a[16:19], a[104:107], 0
s_xor_b32 s64, s71, 1048576
v_mfma_f32_16x16x32_bf16 v[64:67], a[20:23], a[108:111], v[64:67]
buffer_load_dwordx4 v14, s[40:43], s64 offen lds
v_mfma_f32_16x16x32_bf16 v[80:83], a[28:31], a[108:111], 0
s_xor_b32 m0, s77, 148480
v_mfma_f32_16x16x32_bf16 v[80:83], a[24:27], a[104:107], v[80:83]
s_xor_b32 s64, s71, 1081344
v_mfma_f32_16x16x32_bf16 v[144:147], a[24:27], a[112:115], 0
buffer_load_dwordx4 v14, s[40:43], s64 offen lds
v_mfma_f32_16x16x32_bf16 v[144:147], a[28:31], a[116:119], v[144:147]
v_mfma_f32_16x16x32_bf16 v[128:131], a[20:23], a[116:119], 0
s_xor_b32 m0, s77, 149504
v_mfma_f32_16x16x32_bf16 v[128:131], a[16:19], a[112:115], v[128:131]
s_xor_b32 s64, s71, 1114112
v_mfma_f32_16x16x32_bf16 v[112:115], a[8:11], a[112:115], 0
buffer_load_dwordx4 v15, s[40:43], s64 offen lds
v_mfma_f32_16x16x32_bf16 v[112:115], a[12:15], a[116:119], v[112:115]
v_mfma_f32_16x16x32_bf16 v[96:99], a[4:7], a[116:119], 0
s_xor_b32 m0, s77, 150528
v_mfma_f32_16x16x32_bf16 v[96:99], a[0:3], a[112:115], v[96:99]
s_xor_b32 s64, s71, 1146880
v_mfma_f32_16x16x32_bf16 v[36:39], a[0:3], a[72:75], 0
buffer_load_dwordx4 v15, s[40:43], s64 offen lds
v_mfma_f32_16x16x32_bf16 v[36:39], a[4:7], a[76:79], v[36:39]
s_xor_b32 m0, s84, 0
v_mfma_f32_16x16x32_bf16 v[52:55], a[12:15], a[76:79], 0
s_waitcnt vmcnt(16) lgkmcnt(0)
s_barrier
v_mfma_f32_16x16x32_bf16 v[52:55], a[8:11], a[72:75], v[52:55]
s_xor_b32 s64, s70, 256
ds_read_b64_tr_b16 a[104:105], v4 offset:32768
v_mfma_f32_16x16x32_bf16 v[68:71], a[16:19], a[72:75], 0
buffer_load_dwordx4 v12, s[32:35], s64 offen lds
v_mfma_f32_16x16x32_bf16 v[68:71], a[20:23], a[76:79], v[68:71]
s_xor_b32 m0, s84, 1024
global_load_dwordx4 a[144:147], v18, s[4:5] offset:0
v_mfma_f32_16x16x32_bf16 v[84:87], a[28:31], a[76:79], 0
s_xor_b32 s64, s70, 8448
ds_read_b64_tr_b16 a[106:107], v4 offset:33792
v_mfma_f32_16x16x32_bf16 v[84:87], a[24:27], a[72:75], v[84:87]
buffer_load_dwordx4 v13, s[32:35], s64 offen lds
v_mfma_f32_16x16x32_bf16 v[148:151], a[24:27], a[80:83], 0
ds_read_b64_tr_b16 a[108:109], v4 offset:40960
v_mfma_f32_16x16x32_bf16 v[148:151], a[28:31], a[84:87], v[148:151]
s_xor_b32 m0, s84, 2048
ds_read_b64_tr_b16 a[110:111], v4 offset:41984
v_mfma_f32_16x16x32_bf16 v[132:135], a[20:23], a[84:87], 0
s_waitcnt vmcnt(11)
s_xor_b32 s64, s70, 16640
ds_read_b128 a[32:35], v2 offset:32768
v_mfma_f32_16x16x32_bf16 v[132:135], a[16:19], a[80:83], v[132:135]
buffer_load_dwordx4 v12, s[32:35], s64 offen lds
v_mfma_f32_16x16x32_bf16 v[116:119], a[8:11], a[80:83], 0
ds_read_b128 a[36:39], v3 offset:32768
v_mfma_f32_16x16x32_bf16 v[116:119], a[12:15], a[84:87], v[116:119]
s_xor_b32 m0, s84, 3072
ds_read_b128 a[40:43], v2 offset:34816
v_mfma_f32_16x16x32_bf16 v[100:103], a[4:7], a[84:87], 0
s_xor_b32 s64, s70, 24832
ds_read_b128 a[44:47], v3 offset:34816
v_mfma_f32_16x16x32_bf16 v[100:103], a[0:3], a[80:83], v[100:103]
buffer_load_dwordx4 v13, s[32:35], s64 offen lds
v_mfma_f32_16x16x32_bf16 v[248:251], a[0:3], a[88:91], 0
ds_read_b128 a[48:51], v2 offset:36864
v_mfma_f32_16x16x32_bf16 v[248:251], a[4:7], a[92:95], v[248:251]
s_xor_b32 m0, s84, 4096
ds_read_b128 a[52:55], v3 offset:36864
v_mfma_f32_16x16x32_bf16 v[252:255], a[12:15], a[92:95], 0
s_xor_b32 s64, s70, 33024
ds_read_b128 a[56:59], v2 offset:38912
v_mfma_f32_16x16x32_bf16 v[252:255], a[8:11], a[88:91], v[252:255]
buffer_load_dwordx4 v12, s[32:35], s64 offen lds
v_mfma_f32_16x16x32_bf16 a[120:123], a[16:19], a[88:91], 0
s_xor_b32 m0, s84, 5120
ds_read_b128 a[60:63], v3 offset:38912
v_mfma_f32_16x16x32_bf16 a[120:123], a[20:23], a[92:95], a[120:123]
s_xor_b32 s64, s70, 41216
ds_read_b64_tr_b16 a[112:113], v5 offset:32768
v_mfma_f32_16x16x32_bf16 a[124:127], a[28:31], a[92:95], 0
buffer_load_dwordx4 v13, s[32:35], s64 offen lds
v_mfma_f32_16x16x32_bf16 a[124:127], a[24:27], a[88:91], a[124:127]
ds_read_b64_tr_b16 a[114:115], v5 offset:33792
v_mfma_f32_16x16x32_bf16 a[128:131], a[24:27], a[96:99], 0
s_xor_b32 m0, s84, 6144
ds_read_b64_tr_b16 a[116:117], v5 offset:40960
v_mfma_f32_16x16x32_bf16 a[128:131], a[28:31], a[100:103], a[128:131]
s_xor_b32 s64, s70, 49408
ds_read_b64_tr_b16 a[118:119], v5 offset:41984
v_mfma_f32_16x16x32_bf16 a[132:135], a[20:23], a[100:103], 0
buffer_load_dwordx4 v12, s[32:35], s64 offen lds
v_mfma_f32_16x16x32_bf16 a[132:135], a[16:19], a[96:99], a[132:135]
global_load_dwordx4 a[160:163], v19, s[22:23] offset:0
v_mfma_f32_16x16x32_bf16 a[136:139], a[8:11], a[96:99], 0
s_xor_b32 m0, s84, 7168
ds_read_b64_tr_b16 a[72:73], v6 offset:32768
v_mfma_f32_16x16x32_bf16 a[136:139], a[12:15], a[100:103], a[136:139]
s_xor_b32 s64, s70, 57600
ds_read_b64_tr_b16 a[74:75], v6 offset:33792
v_mfma_f32_16x16x32_bf16 a[140:143], a[4:7], a[100:103], 0
buffer_load_dwordx4 v13, s[32:35], s64 offen lds
v_mfma_f32_16x16x32_bf16 a[140:143], a[0:3], a[96:99], a[140:143]
s_waitcnt lgkmcnt(5)
ds_read_b64_tr_b16 a[76:77], v6 offset:40960
v_mfma_f32_16x16x32_bf16 v[184:187], a[104:107], a[32:35], v[184:187]
ds_read_b64_tr_b16 a[78:79], v6 offset:41984
v_mfma_f32_16x16x32_bf16 v[184:187], a[108:111], a[36:39], v[184:187]
ds_read_b64_tr_b16 a[80:81], v7 offset:32768
v_mfma_f32_16x16x32_bf16 v[192:195], a[108:111], a[44:47], v[192:195]
s_xor_b32 m0, s77, 65536
ds_read_b64_tr_b16 a[82:83], v7 offset:33792
v_mfma_f32_16x16x32_bf16 v[192:195], a[104:107], a[40:43], v[192:195]
s_xor_b32 s64, s71, 1572864
ds_read_b64_tr_b16 a[84:85], v7 offset:40960
v_mfma_f32_16x16x32_bf16 v[200:203], a[104:107], a[48:51], v[200:203]
buffer_load_dwordx4 v14, s[36:39], s64 offen lds
v_mfma_f32_16x16x32_bf16 v[200:203], a[108:111], a[52:55], v[200:203]
ds_read_b64_tr_b16 a[86:87], v7 offset:41984
v_mfma_f32_16x16x32_bf16 v[208:211], a[108:111], a[60:63], v[208:211]
s_xor_b32 m0, s77, 66560
ds_read_b64_tr_b16 a[88:89], v8 offset:32768
v_mfma_f32_16x16x32_bf16 v[208:211], a[104:107], a[56:59], v[208:211]
s_waitcnt lgkmcnt(7)
s_xor_b32 s64, s71, 1605632
ds_read_b64_tr_b16 a[90:91], v8 offset:33792
v_mfma_f32_16x16x32_bf16 v[212:215], a[112:115], a[56:59], v[212:215]
buffer_load_dwordx4 v14, s[36:39], s64 offen lds
v_mfma_f32_16x16x32_bf16 v[212:215], a[116:119], a[60:63], v[212:215]
ds_read_b64_tr_b16 a[92:93], v8 offset:40960
v_mfma_f32_16x16x32_bf16 v[204:207], a[116:119], a[52:55], v[204:207]
s_xor_b32 m0, s77, 67584
ds_read_b64_tr_b16 a[94:95], v8 offset:41984
v_mfma_f32_16x16x32_bf16 v[204:207], a[112:115], a[48:51], v[204:207]
s_xor_b32 s64, s71, 1638400
ds_read_b64_tr_b16 a[96:97], v9 offset:32768
v_mfma_f32_16x16x32_bf16 v[196:199], a[112:115], a[40:43], v[196:199]
buffer_load_dwordx4 v15, s[36:39], s64 offen lds
v_mfma_f32_16x16x32_bf16 v[196:199], a[116:119], a[44:47], v[196:199]
ds_read_b64_tr_b16 a[98:99], v9 offset:33792
v_mfma_f32_16x16x32_bf16 v[188:191], a[116:119], a[36:39], v[188:191]
s_xor_b32 m0, s77, 68608
ds_read_b64_tr_b16 a[100:101], v9 offset:40960
v_mfma_f32_16x16x32_bf16 v[188:191], a[112:115], a[32:35], v[188:191]
s_xor_b32 s64, s71, 1671168
ds_read_b64_tr_b16 a[102:103], v9 offset:41984
v_mfma_f32_16x16x32_bf16 v[216:219], a[72:75], a[32:35], v[216:219]
s_waitcnt lgkmcnt(7)
buffer_load_dwordx4 v15, s[36:39], s64 offen lds
v_mfma_f32_16x16x32_bf16 v[216:219], a[76:79], a[36:39], v[216:219]
global_load_dwordx4 a[148:151], v18, s[4:5] offset:512
v_mfma_f32_16x16x32_bf16 v[224:227], a[76:79], a[44:47], v[224:227]
ds_read_b64_tr_b16 a[104:105], v10 offset:32768
v_mfma_f32_16x16x32_bf16 v[224:227], a[72:75], a[40:43], v[224:227]
s_xor_b32 m0, s77, 81920
ds_read_b64_tr_b16 a[106:107], v10 offset:33792
v_mfma_f32_16x16x32_bf16 v[232:235], a[72:75], a[48:51], v[232:235]
s_xor_b32 s64, s71, 1572864
ds_read_b64_tr_b16 a[108:109], v10 offset:40960
v_mfma_f32_16x16x32_bf16 v[232:235], a[76:79], a[52:55], v[232:235]
buffer_load_dwordx4 v14, s[40:43], s64 offen lds
v_mfma_f32_16x16x32_bf16 v[240:243], a[76:79], a[60:63], v[240:243]
ds_read_b64_tr_b16 a[110:111], v10 offset:41984
v_mfma_f32_16x16x32_bf16 v[240:243], a[72:75], a[56:59], v[240:243]
s_xor_b32 m0, s77, 82944
ds_read_b64_tr_b16 a[112:113], v11 offset:32768
v_mfma_f32_16x16x32_bf16 v[244:247], a[80:83], a[56:59], v[244:247]
s_xor_b32 s64, s71, 1605632
ds_read_b64_tr_b16 a[114:115], v11 offset:33792
v_mfma_f32_16x16x32_bf16 v[244:247], a[84:87], a[60:63], v[244:247]
buffer_load_dwordx4 v14, s[40:43], s64 offen lds
v_mfma_f32_16x16x32_bf16 v[236:239], a[84:87], a[52:55], v[236:239]
ds_read_b64_tr_b16 a[116:117], v11 offset:40960
v_mfma_f32_16x16x32_bf16 v[236:239], a[80:83], a[48:51], v[236:239]
s_xor_b32 m0, s77, 83968
ds_read_b64_tr_b16 a[118:119], v11 offset:41984
v_mfma_f32_16x16x32_bf16 v[228:231], a[80:83], a[40:43], v[228:231]
s_xor_b32 s64, s71, 1638400
ds_read_b64_tr_b16 a[72:73], v4 offset:49152
v_mfma_f32_16x16x32_bf16 v[228:231], a[84:87], a[44:47], v[228:231]
buffer_load_dwordx4 v15, s[40:43], s64 offen lds
v_mfma_f32_16x16x32_bf16 v[220:223], a[84:87], a[36:39], v[220:223]
ds_read_b64_tr_b16 a[74:75], v4 offset:50176
v_mfma_f32_16x16x32_bf16 v[220:223], a[80:83], a[32:35], v[220:223]
s_waitcnt lgkmcnt(7)
s_xor_b32 m0, s77, 84992
ds_read_b64_tr_b16 a[76:77], v4 offset:57344
v_mfma_f32_16x16x32_bf16 v[152:155], a[88:91], a[32:35], v[152:155]
s_xor_b32 s64, s71, 1671168
ds_read_b64_tr_b16 a[78:79], v4 offset:58368
v_mfma_f32_16x16x32_bf16 v[152:155], a[92:95], a[36:39], v[152:155]
buffer_load_dwordx4 v15, s[40:43], s64 offen lds
v_mfma_f32_16x16x32_bf16 v[160:163], a[92:95], a[44:47], v[160:163]
ds_read_b64_tr_b16 a[80:81], v5 offset:49152
v_mfma_f32_16x16x32_bf16 v[160:163], a[88:91], a[40:43], v[160:163]
ds_read_b64_tr_b16 a[82:83], v5 offset:50176
v_mfma_f32_16x16x32_bf16 v[168:171], a[88:91], a[48:51], v[168:171]
ds_read_b64_tr_b16 a[84:85], v5 offset:57344
v_mfma_f32_16x16x32_bf16 v[168:171], a[92:95], a[52:55], v[168:171]
ds_read_b64_tr_b16 a[86:87], v5 offset:58368
v_mfma_f32_16x16x32_bf16 v[176:179], a[92:95], a[60:63], v[176:179]
s_xor_b32 m0, s84, 32768
global_load_dwordx4 a[164:167], v19, s[22:23] offset:512
v_mfma_f32_16x16x32_bf16 v[176:179], a[88:91], a[56:59], v[176:179]
s_xor_b32 s64, s70, 384
ds_read_b64_tr_b16 a[88:89], v6 offset:49152
v_mfma_f32_16x16x32_bf16 v[180:183], a[96:99], a[56:59], v[180:183]
buffer_load_dwordx4 v12, s[32:35], s64 offen lds
v_mfma_f32_16x16x32_bf16 v[180:183], a[100:103], a[60:63], v[180:183]
ds_read_b64_tr_b16 a[90:91], v6 offset:50176
v_mfma_f32_16x16x32_bf16 v[172:175], a[100:103], a[52:55], v[172:175]
ds_read_b64_tr_b16 a[92:93], v6 offset:57344
v_mfma_f32_16x16x32_bf16 v[172:175], a[96:99], a[48:51], v[172:175]
ds_read_b64_tr_b16 a[94:95], v6 offset:58368
v_mfma_f32_16x16x32_bf16 v[164:167], a[96:99], a[40:43], v[164:167]
v_mfma_f32_16x16x32_bf16 v[164:167], a[100:103], a[44:47], v[164:167]
s_xor_b32 m0, s84, 33792
v_mfma_f32_16x16x32_bf16 v[156:159], a[100:103], a[36:39], v[156:159]
s_xor_b32 s64, s70, 8576
v_mfma_f32_16x16x32_bf16 v[156:159], a[96:99], a[32:35], v[156:159]
buffer_load_dwordx4 v13, s[32:35], s64 offen lds
v_mfma_f32_16x16x32_bf16 v[24:27], a[104:107], a[32:35], v[24:27]
s_waitcnt lgkmcnt(4)
ds_read_b64_tr_b16 a[96:97], v7 offset:49152
v_mfma_f32_16x16x32_bf16 v[24:27], a[108:111], a[36:39], v[24:27]
ds_read_b64_tr_b16 a[98:99], v7 offset:50176
v_mfma_f32_16x16x32_bf16 v[40:43], a[108:111], a[44:47], v[40:43]
ds_read_b64_tr_b16 a[100:101], v7 offset:57344
v_mfma_f32_16x16x32_bf16 v[40:43], a[104:107], a[40:43], v[40:43]
ds_read_b64_tr_b16 a[102:103], v7 offset:58368
v_mfma_f32_16x16x32_bf16 v[56:59], a[104:107], a[48:51], v[56:59]
s_xor_b32 m0, s84, 34816
v_mfma_f32_16x16x32_bf16 v[56:59], a[108:111], a[52:55], v[56:59]
s_xor_b32 s64, s70, 16768
v_mfma_f32_16x16x32_bf16 v[72:75], a[108:111], a[60:63], v[72:75]
s_waitcnt vmcnt(12)
buffer_load_dwordx4 v12, s[32:35], s64 offen lds
v_mfma_f32_16x16x32_bf16 v[72:75], a[104:107], a[56:59], v[72:75]
ds_read_b64_tr_b16 a[104:105], v8 offset:49152
v_mfma_f32_16x16x32_bf16 v[136:139], a[112:115], a[56:59], v[136:139]
ds_read_b64_tr_b16 a[106:107], v8 offset:50176
v_mfma_f32_16x16x32_bf16 v[136:139], a[116:119], a[60:63], v[136:139]
ds_read_b64_tr_b16 a[108:109], v8 offset:57344
v_add_u32 v4, 0x8000, v4
v_mfma_f32_16x16x32_bf16 v[120:123], a[116:119], a[52:55], v[120:123]
ds_read_b64_tr_b16 a[110:111], v8 offset:58368
v_mfma_f32_16x16x32_bf16 v[120:123], a[112:115], a[48:51], v[120:123]
s_xor_b32 m0, s84, 35840
ds_read_b128 a[0:3], v2 offset:0
v_mfma_f32_16x16x32_bf16 v[104:107], a[112:115], a[40:43], v[104:107]
s_xor_b32 s64, s70, 24960
global_load_dwordx4 a[152:155], v18, s[4:5] offset:1024
v_mfma_f32_16x16x32_bf16 v[104:107], a[116:119], a[44:47], v[104:107]
s_branch L_po2
L_pg2:
s_branch L_tr0
L_po2:
buffer_load_dwordx4 v13, s[32:35], s64 offen lds
v_mfma_f32_16x16x32_bf16 v[88:91], a[116:119], a[36:39], v[88:91]
ds_read_b128 a[4:7], v3 offset:0
v_mfma_f32_16x16x32_bf16 v[88:91], a[112:115], a[32:35], v[88:91]
ds_read_b128 a[8:11], v2 offset:2048
v_mfma_f32_16x16x32_bf16 v[28:31], a[32:35], a[72:75], v[28:31]
ds_read_b128 a[12:15], v3 offset:2048
v_mfma_f32_16x16x32_bf16 v[28:31], a[36:39], a[76:79], v[28:31]
ds_read_b128 a[16:19], v2 offset:4096
v_add_u32 v5, 0x8000, v5
v_mfma_f32_16x16x32_bf16 v[44:47], a[44:47], a[76:79], v[44:47]
s_xor_b32 m0, s84, 36864
ds_read_b128 a[20:23], v3 offset:4096
v_mfma_f32_16x16x32_bf16 v[44:47], a[40:43], a[72:75], v[44:47]
s_xor_b32 s64, s70, 33152
ds_read_b128 a[24:27], v2 offset:6144
v_mfma_f32_16x16x32_bf16 v[60:63], a[48:51], a[72:75], v[60:63]
buffer_load_dwordx4 v12, s[32:35], s64 offen lds
v_mfma_f32_16x16x32_bf16 v[60:63], a[52:55], a[76:79], v[60:63]
ds_read_b128 a[28:31], v3 offset:6144
v_mfma_f32_16x16x32_bf16 v[76:79], a[60:63], a[76:79], v[76:79]
ds_read_b64_tr_b16 a[112:113], v9 offset:49152
v_mfma_f32_16x16x32_bf16 v[76:79], a[56:59], a[72:75], v[76:79]
ds_read_b64_tr_b16 a[114:115], v9 offset:50176
v_mfma_f32_16x16x32_bf16 v[140:143], a[56:59], a[80:83], v[140:143]
ds_read_b64_tr_b16 a[116:117], v9 offset:57344
v_mfma_f32_16x16x32_bf16 v[140:143], a[60:63], a[84:87], v[140:143]
s_xor_b32 m0, s84, 37888
ds_read_b64_tr_b16 a[118:119], v9 offset:58368
v_add_u32 v6, 0x8000, v6
v_mfma_f32_16x16x32_bf16 v[124:127], a[52:55], a[84:87], v[124:127]
s_xor_b32 s64, s70, 41344
ds_read_b64_tr_b16 a[72:73], v10 offset:49152
v_mfma_f32_16x16x32_bf16 v[124:127], a[48:51], a[80:83], v[124:127]
buffer_load_dwordx4 v13, s[32:35], s64 offen lds
v_mfma_f32_16x16x32_bf16 v[108:111], a[40:43], a[80:83], v[108:111]
ds_read_b64_tr_b16 a[74:75], v10 offset:50176
v_mfma_f32_16x16x32_bf16 v[108:111], a[44:47], a[84:87], v[108:111]
ds_read_b64_tr_b16 a[76:77], v10 offset:57344
v_mfma_f32_16x16x32_bf16 v[92:95], a[36:39], a[84:87], v[92:95]
ds_read_b64_tr_b16 a[78:79], v10 offset:58368
v_mfma_f32_16x16x32_bf16 v[92:95], a[32:35], a[80:83], v[92:95]
s_waitcnt lgkmcnt(8)
ds_read_b64_tr_b16 a[80:81], v11 offset:49152
v_mfma_f32_16x16x32_bf16 v[32:35], a[32:35], a[88:91], v[32:35]
s_xor_b32 m0, s84, 38912
ds_read_b64_tr_b16 a[82:83], v11 offset:50176
v_mfma_f32_16x16x32_bf16 v[32:35], a[36:39], a[92:95], v[32:35]
s_xor_b32 s64, s70, 49536
ds_read_b64_tr_b16 a[84:85], v11 offset:57344
v_add_u32 v7, 0x8000, v7
v_mfma_f32_16x16x32_bf16 v[48:51], a[44:47], a[92:95], v[48:51]
buffer_load_dwordx4 v12, s[32:35], s64 offen lds
v_mfma_f32_16x16x32_bf16 v[48:51], a[40:43], a[88:91], v[48:51]
global_load_dwordx4 a[168:171], v19, s[22:23] offset:1024
v_mfma_f32_16x16x32_bf16 v[64:67], a[48:51], a[88:91], v[64:67]
ds_read_b64_tr_b16 a[86:87], v11 offset:58368
v_mfma_f32_16x16x32_bf16 v[64:67], a[52:55], a[92:95], v[64:67]
v_mfma_f32_16x16x32_bf16 v[80:83], a[60:63], a[92:95], v[80:83]
v_mfma_f32_16x16x32_bf16 v[80:83], a[56:59], a[88:91], v[80:83]
s_xor_b32 m0, s84, 39936
v_mfma_f32_16x16x32_bf16 v[144:147], a[56:59], a[96:99], v[144:147]
s_xor_b32 s64, s70, 57728
v_mfma_f32_16x16x32_bf16 v[144:147], a[60:63], a[100:103], v[144:147]
buffer_load_dwordx4 v13, s[32:35], s64 offen lds
v_mfma_f32_16x16x32_bf16 v[128:131], a[52:55], a[100:103], v[128:131]
v_add_u32 v8, 0x8000, v8
v_mfma_f32_16x16x32_bf16 v[128:131], a[48:51], a[96:99], v[128:131]
v_mfma_f32_16x16x32_bf16 v[112:115], a[40:43], a[96:99], v[112:115]
v_mfma_f32_16x16x32_bf16 v[112:115], a[44:47], a[100:103], v[112:115]
v_mfma_f32_16x16x32_bf16 v[96:99], a[36:39], a[100:103], v[96:99]
v_add_u32 v9, 0x8000, v9
v_add_u32 v10, 0x8000, v10
v_mfma_f32_16x16x32_bf16 v[96:99], a[32:35], a[96:99], v[96:99]
v_add_u32 v11, 0x8000, v11
v_mfma_f32_16x16x32_bf16 v[36:39], a[32:35], a[104:107], v[36:39]
v_mfma_f32_16x16x32_bf16 v[36:39], a[36:39], a[108:111], v[36:39]
v_mfma_f32_16x16x32_bf16 v[52:55], a[44:47], a[108:111], v[52:55]
s_cmp_eq_u32 s30, 0
s_cbranch_scc1 L_pg6
s_cmp_eq_u32 s30, 1
s_cbranch_scc1 L_pg7
s_cmp_eq_u32 s30, 2
s_cbranch_scc1 L_pg8
s_branch L_pg9
L_tr1:
s_waitcnt lgkmcnt(0)
s_barrier
v_mfma_f32_16x16x32_bf16 v[52:55], a[40:43], a[104:107], v[52:55]
s_xor_b32 m0, s77, 98304
ds_read_b64_tr_b16 a[88:89], v4 offset:32768
v_mfma_f32_16x16x32_bf16 v[68:71], a[48:51], a[104:107], v[68:71]
s_xor_b32 s64, s71, 2097152
ds_read_b64_tr_b16 a[90:91], v4 offset:33792
v_mfma_f32_16x16x32_bf16 v[68:71], a[52:55], a[108:111], v[68:71]
buffer_load_dwordx4 v14, s[36:39], s64 offen lds
v_mfma_f32_16x16x32_bf16 v[84:87], a[60:63], a[108:111], v[84:87]
ds_read_b64_tr_b16 a[92:93], v4 offset:40960
v_mfma_f32_16x16x32_bf16 v[84:87], a[56:59], a[104:107], v[84:87]
ds_read_b64_tr_b16 a[94:95], v4 offset:41984
v_mfma_f32_16x16x32_bf16 v[148:151], a[56:59], a[112:115], v[148:151]
global_load_dwordx4 a[156:159], v18, s[4:5] offset:1536
v_mfma_f32_16x16x32_bf16 v[148:151], a[60:63], a[116:119], v[148:151]
ds_read_b64_tr_b16 a[96:97], v5 offset:32768
v_mfma_f32_16x16x32_bf16 v[132:135], a[52:55], a[116:119], v[132:135]
ds_read_b64_tr_b16 a[98:99], v5 offset:33792
v_mfma_f32_16x16x32_bf16 v[132:135], a[48:51], a[112:115], v[132:135]
s_xor_b32 m0, s77, 99328
ds_read_b64_tr_b16 a[100:101], v5 offset:40960
v_mfma_f32_16x16x32_bf16 v[116:119], a[40:43], a[112:115], v[116:119]
s_xor_b32 s64, s71, 2129920
ds_read_b64_tr_b16 a[102:103], v5 offset:41984
v_mfma_f32_16x16x32_bf16 v[116:119], a[44:47], a[116:119], v[116:119]
buffer_load_dwordx4 v14, s[36:39], s64 offen lds
v_mfma_f32_16x16x32_bf16 v[100:103], a[36:39], a[116:119], v[100:103]
ds_read_b64_tr_b16 a[104:105], v6 offset:32768
v_mfma_f32_16x16x32_bf16 v[100:103], a[32:35], a[112:115], v[100:103]
ds_read_b64_tr_b16 a[106:107], v6 offset:33792
v_mfma_f32_16x16x32_bf16 v[248:251], a[32:35], a[72:75], v[248:251]
ds_read_b64_tr_b16 a[108:109], v6 offset:40960
v_mfma_f32_16x16x32_bf16 v[248:251], a[36:39], a[76:79], v[248:251]
ds_read_b64_tr_b16 a[110:111], v6 offset:41984
v_mfma_f32_16x16x32_bf16 v[252:255], a[44:47], a[76:79], v[252:255]
ds_read_b64_tr_b16 a[112:113], v7 offset:32768
v_mfma_f32_16x16x32_bf16 v[252:255], a[40:43], a[72:75], v[252:255]
s_xor_b32 m0, s77, 100352
ds_read_b64_tr_b16 a[114:115], v7 offset:33792
v_mfma_f32_16x16x32_bf16 a[120:123], a[48:51], a[72:75], a[120:123]
s_xor_b32 s64, s71, 2162688
ds_read_b64_tr_b16 a[116:117], v7 offset:40960
v_mfma_f32_16x16x32_bf16 a[120:123], a[52:55], a[76:79], a[120:123]
buffer_load_dwordx4 v15, s[36:39], s64 offen lds
v_mfma_f32_16x16x32_bf16 a[124:127], a[60:63], a[76:79], a[124:127]
ds_read_b64_tr_b16 a[118:119], v7 offset:41984
v_mfma_f32_16x16x32_bf16 a[124:127], a[56:59], a[72:75], a[124:127]
ds_read_b64_tr_b16 a[72:73], v8 offset:32768
v_mfma_f32_16x16x32_bf16 a[128:131], a[56:59], a[80:83], a[128:131]
ds_read_b64_tr_b16 a[74:75], v8 offset:33792
v_mfma_f32_16x16x32_bf16 a[128:131], a[60:63], a[84:87], a[128:131]
ds_read_b64_tr_b16 a[76:77], v8 offset:40960
v_mfma_f32_16x16x32_bf16 a[132:135], a[52:55], a[84:87], a[132:135]
ds_read_b64_tr_b16 a[78:79], v8 offset:41984
v_mfma_f32_16x16x32_bf16 a[132:135], a[48:51], a[80:83], a[132:135]
s_xor_b32 m0, s77, 101376
v_mfma_f32_16x16x32_bf16 a[136:139], a[40:43], a[80:83], a[136:139]
s_xor_b32 s64, s71, 2195456
v_mfma_f32_16x16x32_bf16 a[136:139], a[44:47], a[84:87], a[136:139]
buffer_load_dwordx4 v15, s[36:39], s64 offen lds
v_mfma_f32_16x16x32_bf16 a[140:143], a[36:39], a[84:87], a[140:143]
global_load_dwordx4 a[172:175], v19, s[22:23] offset:1536
v_mfma_f32_16x16x32_bf16 a[140:143], a[32:35], a[80:83], a[140:143]
s_waitcnt lgkmcnt(5)
ds_read_b64_tr_b16 a[80:81], v9 offset:32768
v_mfma_f32_16x16x32_bf16 v[184:187], a[88:91], a[0:3], v[184:187]
ds_read_b64_tr_b16 a[82:83], v9 offset:33792
v_mfma_f32_16x16x32_bf16 v[184:187], a[92:95], a[4:7], v[184:187]
ds_read_b64_tr_b16 a[84:85], v9 offset:40960
v_mfma_f32_16x16x32_bf16 v[192:195], a[92:95], a[12:15], v[192:195]
ds_read_b64_tr_b16 a[86:87], v9 offset:41984
v_mfma_f32_16x16x32_bf16 v[192:195], a[88:91], a[8:11], v[192:195]
s_xor_b32 m0, s77, 114688
v_mfma_f32_16x16x32_bf16 v[200:203], a[88:91], a[16:19], v[200:203]
s_xor_b32 s64, s71, 2097152
v_mfma_f32_16x16x32_bf16 v[200:203], a[92:95], a[20:23], v[200:203]
buffer_load_dwordx4 v14, s[40:43], s64 offen lds
v_mfma_f32_16x16x32_bf16 v[208:211], a[92:95], a[28:31], v[208:211]
v_mfma_f32_16x16x32_bf16 v[208:211], a[88:91], a[24:27], v[208:211]
ds_read_b64_tr_b16 a[88:89], v10 offset:32768
v_mfma_f32_16x16x32_bf16 v[212:215], a[96:99], a[24:27], v[212:215]
ds_read_b64_tr_b16 a[90:91], v10 offset:33792
v_mfma_f32_16x16x32_bf16 v[212:215], a[100:103], a[28:31], v[212:215]
ds_read_b64_tr_b16 a[92:93], v10 offset:40960
v_mfma_f32_16x16x32_bf16 v[204:207], a[100:103], a[20:23], v[204:207]
ds_read_b64_tr_b16 a[94:95], v10 offset:41984
v_mfma_f32_16x16x32_bf16 v[204:207], a[96:99], a[16:19], v[204:207]
s_xor_b32 m0, s77, 115712
v_mfma_f32_16x16x32_bf16 v[196:199], a[96:99], a[8:11], v[196:199]
s_xor_b32 s64, s71, 2129920
v_mfma_f32_16x16x32_bf16 v[196:199], a[100:103], a[12:15], v[196:199]
buffer_load_dwordx4 v14, s[40:43], s64 offen lds
v_mfma_f32_16x16x32_bf16 v[188:191], a[100:103], a[4:7], v[188:191]
v_mfma_f32_16x16x32_bf16 v[188:191], a[96:99], a[0:3], v[188:191]
ds_read_b64_tr_b16 a[96:97], v11 offset:32768
v_mfma_f32_16x16x32_bf16 v[216:219], a[104:107], a[0:3], v[216:219]
ds_read_b64_tr_b16 a[98:99], v11 offset:33792
v_mfma_f32_16x16x32_bf16 v[216:219], a[108:111], a[4:7], v[216:219]
ds_read_b64_tr_b16 a[100:101], v11 offset:40960
v_mfma_f32_16x16x32_bf16 v[224:227], a[108:111], a[12:15], v[224:227]
ds_read_b64_tr_b16 a[102:103], v11 offset:41984
v_mfma_f32_16x16x32_bf16 v[224:227], a[104:107], a[8:11], v[224:227]
s_xor_b32 m0, s77, 116736
v_mfma_f32_16x16x32_bf16 v[232:235], a[104:107], a[16:19], v[232:235]
s_xor_b32 s64, s71, 2162688
buffer_store_dword v21, v20, s[44:47], s69 offen sc1
v_mfma_f32_16x16x32_bf16 v[232:235], a[108:111], a[20:23], v[232:235]
buffer_load_dwordx4 v15, s[40:43], s64 offen lds
v_mfma_f32_16x16x32_bf16 v[240:243], a[108:111], a[28:31], v[240:243]
v_mfma_f32_16x16x32_bf16 v[240:243], a[104:107], a[24:27], v[240:243]
ds_read_b64_tr_b16 a[104:105], v4 offset:49152
v_mfma_f32_16x16x32_bf16 v[244:247], a[112:115], a[24:27], v[244:247]
s_waitcnt lgkmcnt(5)
ds_read_b64_tr_b16 a[106:107], v4 offset:50176
v_mfma_f32_16x16x32_bf16 v[244:247], a[116:119], a[28:31], v[244:247]
ds_read_b64_tr_b16 a[108:109], v4 offset:57344
v_mfma_f32_16x16x32_bf16 v[236:239], a[116:119], a[20:23], v[236:239]
ds_read_b64_tr_b16 a[110:111], v4 offset:58368
v_mfma_f32_16x16x32_bf16 v[236:239], a[112:115], a[16:19], v[236:239]
s_xor_b32 m0, s77, 117760
v_mfma_f32_16x16x32_bf16 v[228:231], a[112:115], a[8:11], v[228:231]
s_xor_b32 s64, s71, 2195456
v_mfma_f32_16x16x32_bf16 v[228:231], a[116:119], a[12:15], v[228:231]
buffer_load_dwordx4 v15, s[40:43], s64 offen lds
v_mfma_f32_16x16x32_bf16 v[220:223], a[116:119], a[4:7], v[220:223]
v_mfma_f32_16x16x32_bf16 v[220:223], a[112:115], a[0:3], v[220:223]
ds_read_b64_tr_b16 a[112:113], v5 offset:49152
v_mfma_f32_16x16x32_bf16 v[152:155], a[72:75], a[0:3], v[152:155]
ds_read_b64_tr_b16 a[114:115], v5 offset:50176
v_mfma_f32_16x16x32_bf16 v[152:155], a[76:79], a[4:7], v[152:155]
ds_read_b64_tr_b16 a[116:117], v5 offset:57344
v_mfma_f32_16x16x32_bf16 v[160:163], a[76:79], a[12:15], v[160:163]
ds_read_b64_tr_b16 a[118:119], v5 offset:58368
v_mfma_f32_16x16x32_bf16 v[160:163], a[72:75], a[8:11], v[160:163]
v_mfma_f32_16x16x32_bf16 v[168:171], a[72:75], a[16:19], v[168:171]
v_mfma_f32_16x16x32_bf16 v[168:171], a[76:79], a[20:23], v[168:171]
v_mfma_f32_16x16x32_bf16 v[176:179], a[76:79], a[28:31], v[176:179]
s_xor_b32 m0, s84, 0
v_mfma_f32_16x16x32_bf16 v[176:179], a[72:75], a[24:27], v[176:179]
s_xor_b32 s64, s70, 512
ds_read_b64_tr_b16 a[72:73], v6 offset:49152
v_mfma_f32_16x16x32_bf16 v[180:183], a[80:83], a[24:27], v[180:183]
buffer_load_dwordx4 v12, s[32:35], s64 offen lds
v_mfma_f32_16x16x32_bf16 v[180:183], a[84:87], a[28:31], v[180:183]
ds_read_b64_tr_b16 a[74:75], v6 offset:50176
v_mfma_f32_16x16x32_bf16 v[172:175], a[84:87], a[20:23], v[172:175]
ds_read_b64_tr_b16 a[76:77], v6 offset:57344
v_mfma_f32_16x16x32_bf16 v[172:175], a[80:83], a[16:19], v[172:175]
ds_read_b64_tr_b16 a[78:79], v6 offset:58368
v_mfma_f32_16x16x32_bf16 v[164:167], a[80:83], a[8:11], v[164:167]
buffer_load_dword a252, v16, s[56:59], s81 offen
v_mfma_f32_16x16x32_bf16 v[164:167], a[84:87], a[12:15], v[164:167]
s_xor_b32 m0, s84, 1024
v_mfma_f32_16x16x32_bf16 v[156:159], a[84:87], a[4:7], v[156:159]
s_xor_b32 s64, s70, 8704
v_mfma_f32_16x16x32_bf16 v[156:159], a[80:83], a[0:3], v[156:159]
buffer_load_dwordx4 v13, s[32:35], s64 offen lds
v_mfma_f32_16x16x32_bf16 v[24:27], a[88:91], a[0:3], v[24:27]
ds_read_b64_tr_b16 a[80:81], v7 offset:49152
v_mfma_f32_16x16x32_bf16 v[24:27], a[92:95], a[4:7], v[24:27]
ds_read_b64_tr_b16 a[82:83], v7 offset:50176
v_mfma_f32_16x16x32_bf16 v[40:43], a[92:95], a[12:15], v[40:43]
ds_read_b64_tr_b16 a[84:85], v7 offset:57344
v_mfma_f32_16x16x32_bf16 v[40:43], a[88:91], a[8:11], v[40:43]
ds_read_b64_tr_b16 a[86:87], v7 offset:58368
v_mfma_f32_16x16x32_bf16 v[56:59], a[88:91], a[16:19], v[56:59]
s_xor_b32 m0, s84, 2048
v_mfma_f32_16x16x32_bf16 v[56:59], a[92:95], a[20:23], v[56:59]
s_xor_b32 s64, s70, 16896
v_mfma_f32_16x16x32_bf16 v[72:75], a[92:95], a[28:31], v[72:75]
s_waitcnt vmcnt(14)
buffer_load_dwordx4 v12, s[32:35], s64 offen lds
v_mfma_f32_16x16x32_bf16 v[72:75], a[88:91], a[24:27], v[72:75]
s_waitcnt lgkmcnt(4)
ds_read_b64_tr_b16 a[88:89], v8 offset:49152
v_mfma_f32_16x16x32_bf16 v[136:139], a[96:99], a[24:27], v[136:139]
ds_read_b64_tr_b16 a[90:91], v8 offset:50176
v_mfma_f32_16x16x32_bf16 v[136:139], a[100:103], a[28:31], v[136:139]
ds_read_b64_tr_b16 a[92:93], v8 offset:57344
v_subrev_u32 v4, 0x8000, v4
v_mfma_f32_16x16x32_bf16 v[120:123], a[100:103], a[20:23], v[120:123]
ds_read_b64_tr_b16 a[94:95], v8 offset:58368
v_mfma_f32_16x16x32_bf16 v[120:123], a[96:99], a[16:19], v[120:123]
s_xor_b32 m0, s84, 3072
ds_read_b128 a[32:35], v2 offset:32768
v_mfma_f32_16x16x32_bf16 v[104:107], a[96:99], a[8:11], v[104:107]
s_xor_b32 s64, s70, 25088
ds_read_b128 a[36:39], v3 offset:32768
v_mfma_f32_16x16x32_bf16 v[104:107], a[100:103], a[12:15], v[104:107]
buffer_load_dwordx4 v13, s[32:35], s64 offen lds
v_mfma_f32_16x16x32_bf16 v[88:91], a[100:103], a[4:7], v[88:91]
ds_read_b128 a[40:43], v2 offset:34816
v_mfma_f32_16x16x32_bf16 v[88:91], a[96:99], a[0:3], v[88:91]
ds_read_b128 a[44:47], v3 offset:34816
v_mfma_f32_16x16x32_bf16 v[28:31], a[0:3], a[104:107], v[28:31]
ds_read_b128 a[48:51], v2 offset:36864
v_mfma_f32_16x16x32_bf16 v[28:31], a[4:7], a[108:111], v[28:31]
ds_read_b128 a[52:55], v3 offset:36864
v_subrev_u32 v5, 0x8000, v5
v_mfma_f32_16x16x32_bf16 v[44:47], a[12:15], a[108:111], v[44:47]
s_xor_b32 m0, s84, 4096
ds_read_b128 a[56:59], v2 offset:38912
v_mfma_f32_16x16x32_bf16 v[44:47], a[8:11], a[104:107], v[44:47]
s_xor_b32 s64, s70, 33280
ds_read_b128 a[60:63], v3 offset:38912
v_mfma_f32_16x16x32_bf16 v[60:63], a[16:19], a[104:107], v[60:63]
buffer_load_dwordx4 v12, s[32:35], s64 offen lds
v_mfma_f32_16x16x32_bf16 v[60:63], a[20:23], a[108:111], v[60:63]
ds_read_b64_tr_b16 a[96:97], v9 offset:49152
v_mfma_f32_16x16x32_bf16 v[76:79], a[28:31], a[108:111], v[76:79]
ds_read_b64_tr_b16 a[98:99], v9 offset:50176
v_mfma_f32_16x16x32_bf16 v[76:79], a[24:27], a[104:107], v[76:79]
ds_read_b64_tr_b16 a[100:101], v9 offset:57344
v_mfma_f32_16x16x32_bf16 v[140:143], a[24:27], a[112:115], v[140:143]
ds_read_b64_tr_b16 a[102:103], v9 offset:58368
v_mfma_f32_16x16x32_bf16 v[140:143], a[28:31], a[116:119], v[140:143]
s_xor_b32 m0, s84, 5120
ds_read_b64_tr_b16 a[104:105], v10 offset:49152
v_subrev_u32 v6, 0x8000, v6
v_mfma_f32_16x16x32_bf16 v[124:127], a[20:23], a[116:119], v[124:127]
s_xor_b32 s64, s70, 41472
ds_read_b64_tr_b16 a[106:107], v10 offset:50176
v_mfma_f32_16x16x32_bf16 v[124:127], a[16:19], a[112:115], v[124:127]
buffer_load_dwordx4 v13, s[32:35], s64 offen lds
v_mfma_f32_16x16x32_bf16 v[108:111], a[8:11], a[112:115], v[108:111]
ds_read_b64_tr_b16 a[108:109], v10 offset:57344
v_mfma_f32_16x16x32_bf16 v[108:111], a[12:15], a[116:119], v[108:111]
ds_read_b64_tr_b16 a[110:111], v10 offset:58368
v_mfma_f32_16x16x32_bf16 v[92:95], a[4:7], a[116:119], v[92:95]
v_mfma_f32_16x16x32_bf16 v[92:95], a[0:3], a[112:115], v[92:95]
ds_read_b64_tr_b16 a[112:113], v11 offset:49152
v_mfma_f32_16x16x32_bf16 v[32:35], a[0:3], a[72:75], v[32:35]
s_xor_b32 m0, s84, 6144
ds_read_b64_tr_b16 a[114:115], v11 offset:50176
v_mfma_f32_16x16x32_bf16 v[32:35], a[4:7], a[76:79], v[32:35]
s_xor_b32 s64, s70, 49664
ds_read_b64_tr_b16 a[116:117], v11 offset:57344
v_subrev_u32 v7, 0x8000, v7
v_mfma_f32_16x16x32_bf16 v[48:51], a[12:15], a[76:79], v[48:51]
buffer_load_dwordx4 v12, s[32:35], s64 offen lds
v_mfma_f32_16x16x32_bf16 v[48:51], a[8:11], a[72:75], v[48:51]
ds_read_b64_tr_b16 a[118:119], v11 offset:58368
v_mfma_f32_16x16x32_bf16 v[64:67], a[16:19], a[72:75], v[64:67]
buffer_load_dword a252, v1, s[60:63], s82 offen
v_mfma_f32_16x16x32_bf16 v[64:67], a[20:23], a[76:79], v[64:67]
v_mfma_f32_16x16x32_bf16 v[80:83], a[28:31], a[76:79], v[80:83]
v_mfma_f32_16x16x32_bf16 v[80:83], a[24:27], a[72:75], v[80:83]
s_waitcnt lgkmcnt(4)
s_xor_b32 m0, s84, 7168
v_mfma_f32_16x16x32_bf16 v[144:147], a[24:27], a[80:83], v[144:147]
s_xor_b32 s64, s70, 57856
v_mfma_f32_16x16x32_bf16 v[144:147], a[28:31], a[84:87], v[144:147]
buffer_load_dwordx4 v13, s[32:35], s64 offen lds
v_mfma_f32_16x16x32_bf16 v[128:131], a[20:23], a[84:87], v[128:131]
v_subrev_u32 v8, 0x8000, v8
v_mfma_f32_16x16x32_bf16 v[128:131], a[16:19], a[80:83], v[128:131]
v_mfma_f32_16x16x32_bf16 v[112:115], a[8:11], a[80:83], v[112:115]
v_mfma_f32_16x16x32_bf16 v[112:115], a[12:15], a[84:87], v[112:115]
v_mfma_f32_16x16x32_bf16 v[96:99], a[4:7], a[84:87], v[96:99]
v_subrev_u32 v9, 0x8000, v9
v_subrev_u32 v10, 0x8000, v10
v_mfma_f32_16x16x32_bf16 v[96:99], a[0:3], a[80:83], v[96:99]
v_subrev_u32 v11, 0x8000, v11
v_mfma_f32_16x16x32_bf16 v[36:39], a[0:3], a[88:91], v[36:39]
v_mfma_f32_16x16x32_bf16 v[36:39], a[4:7], a[92:95], v[36:39]
v_mfma_f32_16x16x32_bf16 v[52:55], a[12:15], a[92:95], v[52:55]
s_waitcnt lgkmcnt(0)
s_barrier
v_mfma_f32_16x16x32_bf16 v[52:55], a[8:11], a[88:91], v[52:55]
s_xor_b32 m0, s77, 131072
ds_read_b64_tr_b16 a[72:73], v4 offset:0
v_mfma_f32_16x16x32_bf16 v[68:71], a[16:19], a[88:91], v[68:71]
s_xor_b32 s64, s71, 2621440
ds_read_b64_tr_b16 a[74:75], v4 offset:1024
v_mfma_f32_16x16x32_bf16 v[68:71], a[20:23], a[92:95], v[68:71]
buffer_load_dwordx4 v14, s[36:39], s64 offen lds
v_mfma_f32_16x16x32_bf16 v[84:87], a[28:31], a[92:95], v[84:87]
ds_read_b64_tr_b16 a[76:77], v4 offset:8192
v_mfma_f32_16x16x32_bf16 v[84:87], a[24:27], a[88:91], v[84:87]
ds_read_b64_tr_b16 a[78:79], v4 offset:9216
v_mfma_f32_16x16x32_bf16 v[148:151], a[24:27], a[96:99], v[148:151]
ds_read_b64_tr_b16 a[80:81], v5 offset:0
v_mfma_f32_16x16x32_bf16 v[148:151], a[28:31], a[100:103], v[148:151]
ds_read_b64_tr_b16 a[82:83], v5 offset:1024
v_mfma_f32_16x16x32_bf16 v[132:135], a[20:23], a[100:103], v[132:135]
ds_read_b64_tr_b16 a[84:85], v5 offset:8192
v_mfma_f32_16x16x32_bf16 v[132:135], a[16:19], a[96:99], v[132:135]
s_xor_b32 m0, s77, 132096
ds_read_b64_tr_b16 a[86:87], v5 offset:9216
v_mfma_f32_16x16x32_bf16 v[116:119], a[8:11], a[96:99], v[116:119]
s_xor_b32 s64, s71, 2654208
ds_read_b64_tr_b16 a[88:89], v6 offset:0
v_mfma_f32_16x16x32_bf16 v[116:119], a[12:15], a[100:103], v[116:119]
buffer_load_dwordx4 v14, s[36:39], s64 offen lds
v_mfma_f32_16x16x32_bf16 v[100:103], a[4:7], a[100:103], v[100:103]
ds_read_b64_tr_b16 a[90:91], v6 offset:1024
v_mfma_f32_16x16x32_bf16 v[100:103], a[0:3], a[96:99], v[100:103]
ds_read_b64_tr_b16 a[92:93], v6 offset:8192
v_mfma_f32_16x16x32_bf16 v[248:251], a[0:3], a[104:107], v[248:251]
ds_read_b64_tr_b16 a[94:95], v6 offset:9216
v_mfma_f32_16x16x32_bf16 v[248:251], a[4:7], a[108:111], v[248:251]
ds_read_b64_tr_b16 a[96:97], v7 offset:0
v_mfma_f32_16x16x32_bf16 v[252:255], a[12:15], a[108:111], v[252:255]
ds_read_b64_tr_b16 a[98:99], v7 offset:1024
v_mfma_f32_16x16x32_bf16 v[252:255], a[8:11], a[104:107], v[252:255]
s_xor_b32 m0, s77, 133120
ds_read_b64_tr_b16 a[100:101], v7 offset:8192
v_mfma_f32_16x16x32_bf16 a[120:123], a[16:19], a[104:107], a[120:123]
s_xor_b32 s64, s71, 2686976
ds_read_b64_tr_b16 a[102:103], v7 offset:9216
v_mfma_f32_16x16x32_bf16 a[120:123], a[20:23], a[108:111], a[120:123]
buffer_load_dwordx4 v15, s[36:39], s64 offen lds
v_mfma_f32_16x16x32_bf16 a[124:127], a[28:31], a[108:111], a[124:127]
v_mfma_f32_16x16x32_bf16 a[124:127], a[24:27], a[104:107], a[124:127]
ds_read_b64_tr_b16 a[104:105], v8 offset:0
v_mfma_f32_16x16x32_bf16 a[128:131], a[24:27], a[112:115], a[128:131]
ds_read_b64_tr_b16 a[106:107], v8 offset:1024
v_mfma_f32_16x16x32_bf16 a[128:131], a[28:31], a[116:119], a[128:131]
ds_read_b64_tr_b16 a[108:109], v8 offset:8192
v_mfma_f32_16x16x32_bf16 a[132:135], a[20:23], a[116:119], a[132:135]
ds_read_b64_tr_b16 a[110:111], v8 offset:9216
v_mfma_f32_16x16x32_bf16 a[132:135], a[16:19], a[112:115], a[132:135]
s_xor_b32 m0, s77, 134144
s_add_u32 s81, s81, 1048576
v_mfma_f32_16x16x32_bf16 a[136:139], a[8:11], a[112:115], a[136:139]
s_xor_b32 s64, s71, 2719744
buffer_load_dword a252, v16, s[56:59], s81 offen
v_mfma_f32_16x16x32_bf16 a[136:139], a[12:15], a[116:119], a[136:139]
buffer_load_dwordx4 v15, s[36:39], s64 offen lds
v_mfma_f32_16x16x32_bf16 a[140:143], a[4:7], a[116:119], a[140:143]
v_mfma_f32_16x16x32_bf16 a[140:143], a[0:3], a[112:115], a[140:143]
s_waitcnt lgkmcnt(4)
ds_read_b64_tr_b16 a[112:113], v9 offset:0
v_mfma_f32_16x16x32_bf16 v[184:187], a[72:75], a[32:35], v[184:187]
ds_read_b64_tr_b16 a[114:115], v9 offset:1024
v_mov_b32 v17, 0
v_mfma_f32_16x16x32_bf16 v[184:187], a[76:79], a[36:39], v[184:187]
ds_read_b64_tr_b16 a[116:117], v9 offset:8192
v_accvgpr_read_b32 v19, a144
v_mfma_f32_16x16x32_bf16 v[192:195], a[76:79], a[44:47], v[192:195]
ds_read_b64_tr_b16 a[118:119], v9 offset:9216
v_accvgpr_read_b32 v21, a160
v_mfma_f32_16x16x32_bf16 v[192:195], a[72:75], a[40:43], v[192:195]
s_xor_b32 m0, s77, 147456
v_lshlrev_b32 v18, 16, v19
v_and_b32 v19, 0xffff0000, v19
v_mfma_f32_16x16x32_bf16 v[200:203], a[72:75], a[48:51], v[200:203]
s_xor_b32 s64, s71, 2621440
v_lshlrev_b32 v20, 16, v21
v_and_b32 v21, 0xffff0000, v21
v_mfma_f32_16x16x32_bf16 v[200:203], a[76:79], a[52:55], v[200:203]
buffer_load_dwordx4 v14, s[40:43], s64 offen lds
v_mfma_f32_16x16x32_bf16 v[208:211], a[76:79], a[60:63], v[208:211]
v_mul_f32 v18, v18, v20
v_mul_f32 v19, v19, v21
v_mfma_f32_16x16x32_bf16 v[208:211], a[72:75], a[56:59], v[208:211]
ds_read_b64_tr_b16 a[72:73], v10 offset:0
v_cvt_pk_bf16_f32 v18, v18, v19
v_mfma_f32_16x16x32_bf16 v[212:215], a[80:83], a[56:59], v[212:215]
ds_read_b64_tr_b16 a[74:75], v10 offset:1024
v_lshlrev_b32 v19, 16, v18
v_mfma_f32_16x16x32_bf16 v[212:215], a[84:87], a[60:63], v[212:215]
ds_read_b64_tr_b16 a[76:77], v10 offset:8192
v_and_b32 v18, 0xffff0000, v18
v_mfma_f32_16x16x32_bf16 v[204:207], a[84:87], a[52:55], v[204:207]
ds_read_b64_tr_b16 a[78:79], v10 offset:9216
v_add_f32 v17, v17, v19
v_mfma_f32_16x16x32_bf16 v[204:207], a[80:83], a[48:51], v[204:207]
s_xor_b32 m0, s77, 148480
v_add_f32 v17, v17, v18
v_accvgpr_read_b32 v19, a145
v_mfma_f32_16x16x32_bf16 v[196:199], a[80:83], a[40:43], v[196:199]
s_xor_b32 s64, s71, 2654208
v_accvgpr_read_b32 v21, a161
v_lshlrev_b32 v18, 16, v19
v_mfma_f32_16x16x32_bf16 v[196:199], a[84:87], a[44:47], v[196:199]
buffer_load_dwordx4 v14, s[40:43], s64 offen lds
v_mfma_f32_16x16x32_bf16 v[188:191], a[84:87], a[36:39], v[188:191]
v_and_b32 v19, 0xffff0000, v19
v_lshlrev_b32 v20, 16, v21
v_mfma_f32_16x16x32_bf16 v[188:191], a[80:83], a[32:35], v[188:191]
ds_read_b64_tr_b16 a[80:81], v11 offset:0
v_and_b32 v21, 0xffff0000, v21
v_mfma_f32_16x16x32_bf16 v[216:219], a[88:91], a[32:35], v[216:219]
ds_read_b64_tr_b16 a[82:83], v11 offset:1024
v_mul_f32 v18, v18, v20
v_mfma_f32_16x16x32_bf16 v[216:219], a[92:95], a[36:39], v[216:219]
ds_read_b64_tr_b16 a[84:85], v11 offset:8192
v_mul_f32 v19, v19, v21
v_mfma_f32_16x16x32_bf16 v[224:227], a[92:95], a[44:47], v[224:227]
ds_read_b64_tr_b16 a[86:87], v11 offset:9216
v_cvt_pk_bf16_f32 v18, v18, v19
v_mfma_f32_16x16x32_bf16 v[224:227], a[88:91], a[40:43], v[224:227]
s_xor_b32 m0, s77, 149504
v_lshlrev_b32 v19, 16, v18
v_and_b32 v18, 0xffff0000, v18
v_mfma_f32_16x16x32_bf16 v[232:235], a[88:91], a[48:51], v[232:235]
s_xor_b32 s64, s71, 2686976
v_add_f32 v17, v17, v19
v_add_f32 v17, v17, v18
v_mfma_f32_16x16x32_bf16 v[232:235], a[92:95], a[52:55], v[232:235]
buffer_load_dwordx4 v15, s[40:43], s64 offen lds
v_mfma_f32_16x16x32_bf16 v[240:243], a[92:95], a[60:63], v[240:243]
v_accvgpr_read_b32 v19, a146
v_accvgpr_read_b32 v21, a162
v_mfma_f32_16x16x32_bf16 v[240:243], a[88:91], a[56:59], v[240:243]
ds_read_b64_tr_b16 a[88:89], v4 offset:16384
v_lshlrev_b32 v18, 16, v19
v_mfma_f32_16x16x32_bf16 v[244:247], a[96:99], a[56:59], v[244:247]
ds_read_b64_tr_b16 a[90:91], v4 offset:17408
v_and_b32 v19, 0xffff0000, v19
v_mfma_f32_16x16x32_bf16 v[244:247], a[100:103], a[60:63], v[244:247]
ds_read_b64_tr_b16 a[92:93], v4 offset:24576
v_lshlrev_b32 v20, 16, v21
v_mfma_f32_16x16x32_bf16 v[236:239], a[100:103], a[52:55], v[236:239]
ds_read_b64_tr_b16 a[94:95], v4 offset:25600
v_and_b32 v21, 0xffff0000, v21
v_mfma_f32_16x16x32_bf16 v[236:239], a[96:99], a[48:51], v[236:239]
s_xor_b32 m0, s77, 150528
v_mul_f32 v18, v18, v20
v_mul_f32 v19, v19, v21
v_mfma_f32_16x16x32_bf16 v[228:231], a[96:99], a[40:43], v[228:231]
s_xor_b32 s64, s71, 2719744
v_cvt_pk_bf16_f32 v18, v18, v19
v_lshlrev_b32 v19, 16, v18
v_mfma_f32_16x16x32_bf16 v[228:231], a[100:103], a[44:47], v[228:231]
buffer_load_dwordx4 v15, s[40:43], s64 offen lds
v_mfma_f32_16x16x32_bf16 v[220:223], a[100:103], a[36:39], v[220:223]
v_and_b32 v18, 0xffff0000, v18
v_add_f32 v17, v17, v19
v_mfma_f32_16x16x32_bf16 v[220:223], a[96:99], a[32:35], v[220:223]
s_waitcnt lgkmcnt(4)
ds_read_b64_tr_b16 a[96:97], v5 offset:16384
v_add_f32 v17, v17, v18
v_mfma_f32_16x16x32_bf16 v[152:155], a[104:107], a[32:35], v[152:155]
ds_read_b64_tr_b16 a[98:99], v5 offset:17408
v_accvgpr_read_b32 v19, a147
v_mfma_f32_16x16x32_bf16 v[152:155], a[108:111], a[36:39], v[152:155]
ds_read_b64_tr_b16 a[100:101], v5 offset:24576
v_accvgpr_read_b32 v21, a163
v_mfma_f32_16x16x32_bf16 v[160:163], a[108:111], a[44:47], v[160:163]
ds_read_b64_tr_b16 a[102:103], v5 offset:25600
v_lshlrev_b32 v18, 16, v19
v_mfma_f32_16x16x32_bf16 v[160:163], a[104:107], a[40:43], v[160:163]
s_branch L_po3
L_pg3:
s_branch L_tr0
L_po3:
s_add_u32 s82, s82, 1048576
v_and_b32 v19, 0xffff0000, v19
v_lshlrev_b32 v20, 16, v21
v_mfma_f32_16x16x32_bf16 v[168:171], a[104:107], a[48:51], v[168:171]
buffer_load_dword a252, v1, s[60:63], s82 offen
v_mfma_f32_16x16x32_bf16 v[168:171], a[108:111], a[52:55], v[168:171]
v_and_b32 v21, 0xffff0000, v21
v_mul_f32 v18, v18, v20
v_mfma_f32_16x16x32_bf16 v[176:179], a[108:111], a[60:63], v[176:179]
s_xor_b32 m0, s84, 32768
v_mul_f32 v19, v19, v21
v_cvt_pk_bf16_f32 v18, v18, v19
v_mfma_f32_16x16x32_bf16 v[176:179], a[104:107], a[56:59], v[176:179]
s_xor_b32 s64, s70, 640
ds_read_b64_tr_b16 a[104:105], v6 offset:16384
v_lshlrev_b32 v19, 16, v18
v_mfma_f32_16x16x32_bf16 v[180:183], a[112:115], a[56:59], v[180:183]
buffer_load_dwordx4 v12, s[32:35], s64 offen lds
v_mfma_f32_16x16x32_bf16 v[180:183], a[116:119], a[60:63], v[180:183]
ds_read_b64_tr_b16 a[106:107], v6 offset:17408
v_and_b32 v18, 0xffff0000, v18
v_mfma_f32_16x16x32_bf16 v[172:175], a[116:119], a[52:55], v[172:175]
ds_read_b64_tr_b16 a[108:109], v6 offset:24576
v_add_f32 v17, v17, v19
v_mfma_f32_16x16x32_bf16 v[172:175], a[112:115], a[48:51], v[172:175]
ds_read_b64_tr_b16 a[110:111], v6 offset:25600
v_add_f32 v17, v17, v18
v_mfma_f32_16x16x32_bf16 v[164:167], a[112:115], a[40:43], v[164:167]
v_accvgpr_read_b32 v19, a148
v_accvgpr_read_b32 v21, a164
v_mfma_f32_16x16x32_bf16 v[164:167], a[116:119], a[44:47], v[164:167]
s_xor_b32 m0, s84, 33792
v_lshlrev_b32 v18, 16, v19
v_and_b32 v19, 0xffff0000, v19
v_mfma_f32_16x16x32_bf16 v[156:159], a[116:119], a[36:39], v[156:159]
s_xor_b32 s64, s70, 8832
v_lshlrev_b32 v20, 16, v21
v_and_b32 v21, 0xffff0000, v21
v_mfma_f32_16x16x32_bf16 v[156:159], a[112:115], a[32:35], v[156:159]
buffer_load_dwordx4 v13, s[32:35], s64 offen lds
v_mfma_f32_16x16x32_bf16 v[24:27], a[72:75], a[32:35], v[24:27]
ds_read_b64_tr_b16 a[112:113], v7 offset:16384
v_mul_f32 v18, v18, v20
v_mfma_f32_16x16x32_bf16 v[24:27], a[76:79], a[36:39], v[24:27]
ds_read_b64_tr_b16 a[114:115], v7 offset:17408
v_mul_f32 v19, v19, v21
v_mfma_f32_16x16x32_bf16 v[40:43], a[76:79], a[44:47], v[40:43]
ds_read_b64_tr_b16 a[116:117], v7 offset:24576
v_cvt_pk_bf16_f32 v18, v18, v19
v_mfma_f32_16x16x32_bf16 v[40:43], a[72:75], a[40:43], v[40:43]
ds_read_b64_tr_b16 a[118:119], v7 offset:25600
v_lshlrev_b32 v19, 16, v18
v_mfma_f32_16x16x32_bf16 v[56:59], a[72:75], a[48:51], v[56:59]
s_xor_b32 m0, s84, 34816
v_and_b32 v18, 0xffff0000, v18
v_add_f32 v17, v17, v19
v_mfma_f32_16x16x32_bf16 v[56:59], a[76:79], a[52:55], v[56:59]
s_xor_b32 s64, s70, 17024
v_add_f32 v17, v17, v18
v_accvgpr_read_b32 v19, a149
v_mfma_f32_16x16x32_bf16 v[72:75], a[76:79], a[60:63], v[72:75]
s_waitcnt vmcnt(12)
buffer_load_dwordx4 v12, s[32:35], s64 offen lds
v_mfma_f32_16x16x32_bf16 v[72:75], a[72:75], a[56:59], v[72:75]
ds_read_b64_tr_b16 a[72:73], v8 offset:16384
v_accvgpr_read_b32 v21, a165
v_mfma_f32_16x16x32_bf16 v[136:139], a[80:83], a[56:59], v[136:139]
ds_read_b64_tr_b16 a[74:75], v8 offset:17408
v_lshlrev_b32 v18, 16, v19
v_mfma_f32_16x16x32_bf16 v[136:139], a[84:87], a[60:63], v[136:139]
ds_read_b64_tr_b16 a[76:77], v8 offset:24576
v_and_b32 v19, 0xffff0000, v19
v_mfma_f32_16x16x32_bf16 v[120:123], a[84:87], a[52:55], v[120:123]
ds_read_b64_tr_b16 a[78:79], v8 offset:25600
v_lshlrev_b32 v20, 16, v21
v_mfma_f32_16x16x32_bf16 v[120:123], a[80:83], a[48:51], v[120:123]
s_xor_b32 m0, s84, 35840
ds_read_b128 a[0:3], v2 offset:0
v_and_b32 v21, 0xffff0000, v21
v_mfma_f32_16x16x32_bf16 v[104:107], a[80:83], a[40:43], v[104:107]
s_xor_b32 s64, s70, 25216
ds_read_b128 a[4:7], v3 offset:0
v_mul_f32 v18, v18, v20
v_mfma_f32_16x16x32_bf16 v[104:107], a[84:87], a[44:47], v[104:107]
buffer_load_dwordx4 v13, s[32:35], s64 offen lds
v_mfma_f32_16x16x32_bf16 v[88:91], a[84:87], a[36:39], v[88:91]
ds_read_b128 a[8:11], v2 offset:2048
v_mul_f32 v19, v19, v21
v_mfma_f32_16x16x32_bf16 v[88:91], a[80:83], a[32:35], v[88:91]
s_waitcnt lgkmcnt(7)
ds_read_b128 a[12:15], v3 offset:2048
v_cvt_pk_bf16_f32 v18, v18, v19
v_mfma_f32_16x16x32_bf16 v[28:31], a[32:35], a[88:91], v[28:31]
ds_read_b128 a[16:19], v2 offset:4096
v_lshlrev_b32 v19, 16, v18
v_mfma_f32_16x16x32_bf16 v[28:31], a[36:39], a[92:95], v[28:31]
ds_read_b128 a[20:23], v3 offset:4096
v_and_b32 v18, 0xffff0000, v18
v_mfma_f32_16x16x32_bf16 v[44:47], a[44:47], a[92:95], v[44:47]
s_xor_b32 m0, s84, 36864
ds_read_b128 a[24:27], v2 offset:6144
v_add_f32 v17, v17, v19
v_mfma_f32_16x16x32_bf16 v[44:47], a[40:43], a[88:91], v[44:47]
s_xor_b32 s64, s70, 33408
ds_read_b128 a[28:31], v3 offset:6144
v_add_f32 v17, v17, v18
v_mfma_f32_16x16x32_bf16 v[60:63], a[48:51], a[88:91], v[60:63]
buffer_load_dwordx4 v12, s[32:35], s64 offen lds
v_mfma_f32_16x16x32_bf16 v[60:63], a[52:55], a[92:95], v[60:63]
ds_read_b64_tr_b16 a[80:81], v9 offset:16384
v_accvgpr_read_b32 v19, a150
v_mfma_f32_16x16x32_bf16 v[76:79], a[60:63], a[92:95], v[76:79]
ds_read_b64_tr_b16 a[82:83], v9 offset:17408
v_accvgpr_read_b32 v21, a166
v_mfma_f32_16x16x32_bf16 v[76:79], a[56:59], a[88:91], v[76:79]
ds_read_b64_tr_b16 a[84:85], v9 offset:24576
v_lshlrev_b32 v18, 16, v19
v_mfma_f32_16x16x32_bf16 v[140:143], a[56:59], a[96:99], v[140:143]
ds_read_b64_tr_b16 a[86:87], v9 offset:25600
v_and_b32 v19, 0xffff0000, v19
v_mfma_f32_16x16x32_bf16 v[140:143], a[60:63], a[100:103], v[140:143]
s_xor_b32 m0, s84, 37888
ds_read_b64_tr_b16 a[88:89], v10 offset:16384
v_lshlrev_b32 v20, 16, v21
v_mfma_f32_16x16x32_bf16 v[124:127], a[52:55], a[100:103], v[124:127]
s_xor_b32 s64, s70, 41600
ds_read_b64_tr_b16 a[90:91], v10 offset:17408
v_and_b32 v21, 0xffff0000, v21
v_mfma_f32_16x16x32_bf16 v[124:127], a[48:51], a[96:99], v[124:127]
s_add_u32 s81, s81, 1048576
buffer_load_dwordx4 v13, s[32:35], s64 offen lds
v_mfma_f32_16x16x32_bf16 v[108:111], a[40:43], a[96:99], v[108:111]
buffer_load_dword a252, v16, s[56:59], s81 offen
v_mfma_f32_16x16x32_bf16 v[108:111], a[44:47], a[100:103], v[108:111]
ds_read_b64_tr_b16 a[92:93], v10 offset:24576
v_mul_f32 v18, v18, v20
v_mfma_f32_16x16x32_bf16 v[92:95], a[36:39], a[100:103], v[92:95]
ds_read_b64_tr_b16 a[94:95], v10 offset:25600
v_mul_f32 v19, v19, v21
v_mfma_f32_16x16x32_bf16 v[92:95], a[32:35], a[96:99], v[92:95]
ds_read_b64_tr_b16 a[96:97], v11 offset:16384
v_cvt_pk_bf16_f32 v18, v18, v19
v_mfma_f32_16x16x32_bf16 v[32:35], a[32:35], a[104:107], v[32:35]
s_xor_b32 m0, s84, 38912
ds_read_b64_tr_b16 a[98:99], v11 offset:17408
v_lshlrev_b32 v19, 16, v18
v_mfma_f32_16x16x32_bf16 v[32:35], a[36:39], a[108:111], v[32:35]
s_xor_b32 s64, s70, 49792
ds_read_b64_tr_b16 a[100:101], v11 offset:24576
v_and_b32 v18, 0xffff0000, v18
v_mfma_f32_16x16x32_bf16 v[48:51], a[44:47], a[108:111], v[48:51]
buffer_load_dwordx4 v12, s[32:35], s64 offen lds
v_mfma_f32_16x16x32_bf16 v[48:51], a[40:43], a[104:107], v[48:51]
ds_read_b64_tr_b16 a[102:103], v11 offset:25600
v_add_f32 v17, v17, v19
v_mfma_f32_16x16x32_bf16 v[64:67], a[48:51], a[104:107], v[64:67]
v_add_f32 v17, v17, v18
v_accvgpr_read_b32 v19, a151
v_mfma_f32_16x16x32_bf16 v[64:67], a[52:55], a[108:111], v[64:67]
v_accvgpr_read_b32 v21, a167
v_lshlrev_b32 v18, 16, v19
v_mfma_f32_16x16x32_bf16 v[80:83], a[60:63], a[108:111], v[80:83]
v_and_b32 v19, 0xffff0000, v19
v_lshlrev_b32 v20, 16, v21
v_mfma_f32_16x16x32_bf16 v[80:83], a[56:59], a[104:107], v[80:83]
s_xor_b32 m0, s84, 39936
v_and_b32 v21, 0xffff0000, v21
v_mul_f32 v18, v18, v20
v_mfma_f32_16x16x32_bf16 v[144:147], a[56:59], a[112:115], v[144:147]
s_xor_b32 s64, s70, 57984
v_mul_f32 v19, v19, v21
v_cvt_pk_bf16_f32 v18, v18, v19
v_mfma_f32_16x16x32_bf16 v[144:147], a[60:63], a[116:119], v[144:147]
buffer_load_dwordx4 v13, s[32:35], s64 offen lds
v_mfma_f32_16x16x32_bf16 v[128:131], a[52:55], a[116:119], v[128:131]
v_lshlrev_b32 v19, 16, v18
v_and_b32 v18, 0xffff0000, v18
v_mfma_f32_16x16x32_bf16 v[128:131], a[48:51], a[112:115], v[128:131]
v_add_f32 v17, v17, v19
v_add_f32 v17, v17, v18
v_mfma_f32_16x16x32_bf16 v[112:115], a[40:43], a[112:115], v[112:115]
v_accvgpr_read_b32 v19, a152
v_accvgpr_read_b32 v21, a168
v_mfma_f32_16x16x32_bf16 v[112:115], a[44:47], a[116:119], v[112:115]
v_lshlrev_b32 v18, 16, v19
v_and_b32 v19, 0xffff0000, v19
v_mfma_f32_16x16x32_bf16 v[96:99], a[36:39], a[116:119], v[96:99]
v_lshlrev_b32 v20, 16, v21
v_and_b32 v21, 0xffff0000, v21
v_mfma_f32_16x16x32_bf16 v[96:99], a[32:35], a[112:115], v[96:99]
s_waitcnt lgkmcnt(0)
v_mul_f32 v18, v18, v20
v_mul_f32 v19, v19, v21
v_mfma_f32_16x16x32_bf16 v[36:39], a[32:35], a[72:75], v[36:39]
v_cvt_pk_bf16_f32 v18, v18, v19
v_lshlrev_b32 v19, 16, v18
v_mfma_f32_16x16x32_bf16 v[36:39], a[36:39], a[76:79], v[36:39]
v_and_b32 v18, 0xffff0000, v18
v_add_f32 v17, v17, v19
v_mfma_f32_16x16x32_bf16 v[52:55], a[44:47], a[76:79], v[52:55]
s_waitcnt lgkmcnt(0)
s_barrier
v_mfma_f32_16x16x32_bf16 v[52:55], a[40:43], a[72:75], v[52:55]
s_xor_b32 m0, s77, 65536
ds_read_b64_tr_b16 a[104:105], v4 offset:32768
v_add_f32 v17, v17, v18
v_mfma_f32_16x16x32_bf16 v[68:71], a[48:51], a[72:75], v[68:71]
s_xor_b32 s64, s71, 3145728
ds_read_b64_tr_b16 a[106:107], v4 offset:33792
v_accvgpr_read_b32 v19, a153
v_mfma_f32_16x16x32_bf16 v[68:71], a[52:55], a[76:79], v[68:71]
buffer_load_dwordx4 v14, s[36:39], s64 offen lds
v_mfma_f32_16x16x32_bf16 v[84:87], a[60:63], a[76:79], v[84:87]
ds_read_b64_tr_b16 a[108:109], v4 offset:40960
v_accvgpr_read_b32 v21, a169
v_mfma_f32_16x16x32_bf16 v[84:87], a[56:59], a[72:75], v[84:87]
ds_read_b64_tr_b16 a[110:111], v4 offset:41984
v_lshlrev_b32 v18, 16, v19
v_mfma_f32_16x16x32_bf16 v[148:151], a[56:59], a[80:83], v[148:151]
ds_read_b64_tr_b16 a[112:113], v5 offset:32768
v_and_b32 v19, 0xffff0000, v19
v_mfma_f32_16x16x32_bf16 v[148:151], a[60:63], a[84:87], v[148:151]
ds_read_b64_tr_b16 a[114:115], v5 offset:33792
v_lshlrev_b32 v20, 16, v21
v_mfma_f32_16x16x32_bf16 v[132:135], a[52:55], a[84:87], v[132:135]
ds_read_b64_tr_b16 a[116:117], v5 offset:40960
v_and_b32 v21, 0xffff0000, v21
v_mfma_f32_16x16x32_bf16 v[132:135], a[48:51], a[80:83], v[132:135]
s_xor_b32 m0, s77, 66560
ds_read_b64_tr_b16 a[118:119], v5 offset:41984
v_mul_f32 v18, v18, v20
v_mfma_f32_16x16x32_bf16 v[116:119], a[40:43], a[80:83], v[116:119]
s_xor_b32 s64, s71, 3178496
ds_read_b64_tr_b16 a[72:73], v6 offset:32768
v_mul_f32 v19, v19, v21
v_mfma_f32_16x16x32_bf16 v[116:119], a[44:47], a[84:87], v[116:119]
buffer_load_dwordx4 v14, s[36:39], s64 offen lds
v_mfma_f32_16x16x32_bf16 v[100:103], a[36:39], a[84:87], v[100:103]
ds_read_b64_tr_b16 a[74:75], v6 offset:33792
v_cvt_pk_bf16_f32 v18, v18, v19
v_mfma_f32_16x16x32_bf16 v[100:103], a[32:35], a[80:83], v[100:103]
ds_read_b64_tr_b16 a[76:77], v6 offset:40960
v_lshlrev_b32 v19, 16, v18
v_mfma_f32_16x16x32_bf16 v[248:251], a[32:35], a[88:91], v[248:251]
ds_read_b64_tr_b16 a[78:79], v6 offset:41984
v_and_b32 v18, 0xffff0000, v18
v_mfma_f32_16x16x32_bf16 v[248:251], a[36:39], a[92:95], v[248:251]
ds_read_b64_tr_b16 a[80:81], v7 offset:32768
v_add_f32 v17, v17, v19
v_mfma_f32_16x16x32_bf16 v[252:255], a[44:47], a[92:95], v[252:255]
s_add_u32 s81, s81, 1048576
ds_read_b64_tr_b16 a[82:83], v7 offset:33792
v_add_f32 v17, v17, v18
v_mfma_f32_16x16x32_bf16 v[252:255], a[40:43], a[88:91], v[252:255]
s_xor_b32 m0, s77, 67584
ds_read_b64_tr_b16 a[84:85], v7 offset:40960
v_accvgpr_read_b32 v19, a154
v_mfma_f32_16x16x32_bf16 a[120:123], a[48:51], a[88:91], a[120:123]
s_xor_b32 s64, s71, 3211264
buffer_load_dword a252, v16, s[56:59], s81 offen
v_mfma_f32_16x16x32_bf16 a[120:123], a[52:55], a[92:95], a[120:123]
buffer_load_dwordx4 v15, s[36:39], s64 offen lds
v_mfma_f32_16x16x32_bf16 a[124:127], a[60:63], a[92:95], a[124:127]
ds_read_b64_tr_b16 a[86:87], v7 offset:41984
v_accvgpr_read_b32 v21, a170
v_mfma_f32_16x16x32_bf16 a[124:127], a[56:59], a[88:91], a[124:127]
ds_read_b64_tr_b16 a[88:89], v8 offset:32768
v_lshlrev_b32 v18, 16, v19
v_mfma_f32_16x16x32_bf16 a[128:131], a[56:59], a[96:99], a[128:131]
ds_read_b64_tr_b16 a[90:91], v8 offset:33792
v_and_b32 v19, 0xffff0000, v19
v_mfma_f32_16x16x32_bf16 a[128:131], a[60:63], a[100:103], a[128:131]
ds_read_b64_tr_b16 a[92:93], v8 offset:40960
v_lshlrev_b32 v20, 16, v21
v_mfma_f32_16x16x32_bf16 a[132:135], a[52:55], a[100:103], a[132:135]
ds_read_b64_tr_b16 a[94:95], v8 offset:41984
v_and_b32 v21, 0xffff0000, v21
v_mfma_f32_16x16x32_bf16 a[132:135], a[48:51], a[96:99], a[132:135]
s_xor_b32 m0, s77, 68608
v_mul_f32 v18, v18, v20
v_mul_f32 v19, v19, v21
v_mfma_f32_16x16x32_bf16 a[136:139], a[40:43], a[96:99], a[136:139]
s_xor_b32 s64, s71, 3244032
v_cvt_pk_bf16_f32 v18, v18, v19
v_lshlrev_b32 v19, 16, v18
v_mfma_f32_16x16x32_bf16 a[136:139], a[44:47], a[100:103], a[136:139]
buffer_load_dwordx4 v15, s[36:39], s64 offen lds
v_mfma_f32_16x16x32_bf16 a[140:143], a[36:39], a[100:103], a[140:143]
v_and_b32 v18, 0xffff0000, v18
v_add_f32 v17, v17, v19
v_mfma_f32_16x16x32_bf16 a[140:143], a[32:35], a[96:99], a[140:143]
s_waitcnt lgkmcnt(5)
ds_read_b64_tr_b16 a[96:97], v9 offset:32768
v_add_f32 v17, v17, v18
v_mfma_f32_16x16x32_bf16 v[184:187], a[104:107], a[0:3], v[184:187]
ds_read_b64_tr_b16 a[98:99], v9 offset:33792
v_accvgpr_read_b32 v19, a155
v_mfma_f32_16x16x32_bf16 v[184:187], a[108:111], a[4:7], v[184:187]
ds_read_b64_tr_b16 a[100:101], v9 offset:40960
v_accvgpr_read_b32 v21, a171
v_mfma_f32_16x16x32_bf16 v[192:195], a[108:111], a[12:15], v[192:195]
ds_read_b64_tr_b16 a[102:103], v9 offset:41984
v_lshlrev_b32 v18, 16, v19
v_mfma_f32_16x16x32_bf16 v[192:195], a[104:107], a[8:11], v[192:195]
s_xor_b32 m0, s77, 81920
v_and_b32 v19, 0xffff0000, v19
v_lshlrev_b32 v20, 16, v21
v_mfma_f32_16x16x32_bf16 v[200:203], a[104:107], a[16:19], v[200:203]
s_xor_b32 s64, s71, 3145728
v_and_b32 v21, 0xffff0000, v21
v_mul_f32 v18, v18, v20
v_mfma_f32_16x16x32_bf16 v[200:203], a[108:111], a[20:23], v[200:203]
buffer_load_dwordx4 v14, s[40:43], s64 offen lds
v_mfma_f32_16x16x32_bf16 v[208:211], a[108:111], a[28:31], v[208:211]
v_mul_f32 v19, v19, v21
v_cvt_pk_bf16_f32 v18, v18, v19
v_mfma_f32_16x16x32_bf16 v[208:211], a[104:107], a[24:27], v[208:211]
ds_read_b64_tr_b16 a[104:105], v10 offset:32768
v_lshlrev_b32 v19, 16, v18
v_mfma_f32_16x16x32_bf16 v[212:215], a[112:115], a[24:27], v[212:215]
ds_read_b64_tr_b16 a[106:107], v10 offset:33792
v_and_b32 v18, 0xffff0000, v18
v_mfma_f32_16x16x32_bf16 v[212:215], a[116:119], a[28:31], v[212:215]
ds_read_b64_tr_b16 a[108:109], v10 offset:40960
v_add_f32 v17, v17, v19
v_mfma_f32_16x16x32_bf16 v[204:207], a[116:119], a[20:23], v[204:207]
ds_read_b64_tr_b16 a[110:111], v10 offset:41984
v_add_f32 v17, v17, v18
v_mfma_f32_16x16x32_bf16 v[204:207], a[112:115], a[16:19], v[204:207]
s_xor_b32 m0, s77, 82944
v_accvgpr_read_b32 v19, a156
v_accvgpr_read_b32 v21, a172
v_mfma_f32_16x16x32_bf16 v[196:199], a[112:115], a[8:11], v[196:199]
s_xor_b32 s64, s71, 3178496
v_lshlrev_b32 v18, 16, v19
v_and_b32 v19, 0xffff0000, v19
v_mfma_f32_16x16x32_bf16 v[196:199], a[116:119], a[12:15], v[196:199]
buffer_load_dwordx4 v14, s[40:43], s64 offen lds
v_mfma_f32_16x16x32_bf16 v[188:191], a[116:119], a[4:7], v[188:191]
v_lshlrev_b32 v20, 16, v21
v_and_b32 v21, 0xffff0000, v21
v_mfma_f32_16x16x32_bf16 v[188:191], a[112:115], a[0:3], v[188:191]
ds_read_b64_tr_b16 a[112:113], v11 offset:32768
v_mul_f32 v18, v18, v20
v_mfma_f32_16x16x32_bf16 v[216:219], a[72:75], a[0:3], v[216:219]
ds_read_b64_tr_b16 a[114:115], v11 offset:33792
v_mul_f32 v19, v19, v21
v_mfma_f32_16x16x32_bf16 v[216:219], a[76:79], a[4:7], v[216:219]
ds_read_b64_tr_b16 a[116:117], v11 offset:40960
v_cvt_pk_bf16_f32 v18, v18, v19
v_mfma_f32_16x16x32_bf16 v[224:227], a[76:79], a[12:15], v[224:227]
ds_read_b64_tr_b16 a[118:119], v11 offset:41984
v_lshlrev_b32 v19, 16, v18
v_mfma_f32_16x16x32_bf16 v[224:227], a[72:75], a[8:11], v[224:227]
s_xor_b32 m0, s77, 83968
v_and_b32 v18, 0xffff0000, v18
v_add_f32 v17, v17, v19
v_mfma_f32_16x16x32_bf16 v[232:235], a[72:75], a[16:19], v[232:235]
s_xor_b32 s64, s71, 3211264
v_add_f32 v17, v17, v18
v_accvgpr_read_b32 v19, a157
v_mfma_f32_16x16x32_bf16 v[232:235], a[76:79], a[20:23], v[232:235]
buffer_load_dwordx4 v15, s[40:43], s64 offen lds
v_mfma_f32_16x16x32_bf16 v[240:243], a[76:79], a[28:31], v[240:243]
v_accvgpr_read_b32 v21, a173
v_lshlrev_b32 v18, 16, v19
v_mfma_f32_16x16x32_bf16 v[240:243], a[72:75], a[24:27], v[240:243]
ds_read_b64_tr_b16 a[72:73], v4 offset:49152
v_and_b32 v19, 0xffff0000, v19
v_mfma_f32_16x16x32_bf16 v[244:247], a[80:83], a[24:27], v[244:247]
s_waitcnt lgkmcnt(5)
ds_read_b64_tr_b16 a[74:75], v4 offset:50176
v_lshlrev_b32 v20, 16, v21
v_mfma_f32_16x16x32_bf16 v[244:247], a[84:87], a[28:31], v[244:247]
ds_read_b64_tr_b16 a[76:77], v4 offset:57344
v_and_b32 v21, 0xffff0000, v21
v_mfma_f32_16x16x32_bf16 v[236:239], a[84:87], a[20:23], v[236:239]
s_add_u32 s82, s82, 1048576
ds_read_b64_tr_b16 a[78:79], v4 offset:58368
v_mul_f32 v18, v18, v20
v_mfma_f32_16x16x32_bf16 v[236:239], a[80:83], a[16:19], v[236:239]
s_xor_b32 m0, s77, 84992
v_mul_f32 v19, v19, v21
v_cvt_pk_bf16_f32 v18, v18, v19
v_mfma_f32_16x16x32_bf16 v[228:231], a[80:83], a[8:11], v[228:231]
s_xor_b32 s64, s71, 3244032
buffer_load_dword a252, v1, s[60:63], s82 offen
v_mfma_f32_16x16x32_bf16 v[228:231], a[84:87], a[12:15], v[228:231]
buffer_load_dwordx4 v15, s[40:43], s64 offen lds
v_mfma_f32_16x16x32_bf16 v[220:223], a[84:87], a[4:7], v[220:223]
v_lshlrev_b32 v19, 16, v18
v_and_b32 v18, 0xffff0000, v18
v_mfma_f32_16x16x32_bf16 v[220:223], a[80:83], a[0:3], v[220:223]
ds_read_b64_tr_b16 a[80:81], v5 offset:49152
v_add_f32 v17, v17, v19
v_mfma_f32_16x16x32_bf16 v[152:155], a[88:91], a[0:3], v[152:155]
ds_read_b64_tr_b16 a[82:83], v5 offset:50176
v_add_f32 v17, v17, v18
v_mfma_f32_16x16x32_bf16 v[152:155], a[92:95], a[4:7], v[152:155]
ds_read_b64_tr_b16 a[84:85], v5 offset:57344
v_accvgpr_read_b32 v19, a158
v_mfma_f32_16x16x32_bf16 v[160:163], a[92:95], a[12:15], v[160:163]
ds_read_b64_tr_b16 a[86:87], v5 offset:58368
v_accvgpr_read_b32 v21, a174
v_mfma_f32_16x16x32_bf16 v[160:163], a[88:91], a[8:11], v[160:163]
v_lshlrev_b32 v18, 16, v19
v_and_b32 v19, 0xffff0000, v19
v_mfma_f32_16x16x32_bf16 v[168:171], a[88:91], a[16:19], v[168:171]
v_lshlrev_b32 v20, 16, v21
v_and_b32 v21, 0xffff0000, v21
v_mfma_f32_16x16x32_bf16 v[168:171], a[92:95], a[20:23], v[168:171]
v_mul_f32 v18, v18, v20
v_mul_f32 v19, v19, v21
v_mfma_f32_16x16x32_bf16 v[176:179], a[92:95], a[28:31], v[176:179]
s_xor_b32 m0, s84, 0
v_cvt_pk_bf16_f32 v18, v18, v19
v_lshlrev_b32 v19, 16, v18
v_mfma_f32_16x16x32_bf16 v[176:179], a[88:91], a[24:27], v[176:179]
s_xor_b32 s64, s70, 768
ds_read_b64_tr_b16 a[88:89], v6 offset:49152
v_and_b32 v18, 0xffff0000, v18
v_mfma_f32_16x16x32_bf16 v[180:183], a[96:99], a[24:27], v[180:183]
buffer_load_dwordx4 v12, s[32:35], s64 offen lds
v_mfma_f32_16x16x32_bf16 v[180:183], a[100:103], a[28:31], v[180:183]
ds_read_b64_tr_b16 a[90:91], v6 offset:50176
v_add_f32 v17, v17, v19
v_mfma_f32_16x16x32_bf16 v[172:175], a[100:103], a[20:23], v[172:175]
ds_read_b64_tr_b16 a[92:93], v6 offset:57344
v_add_f32 v17, v17, v18
v_mfma_f32_16x16x32_bf16 v[172:175], a[96:99], a[16:19], v[172:175]
ds_read_b64_tr_b16 a[94:95], v6 offset:58368
v_accvgpr_read_b32 v19, a159
v_mfma_f32_16x16x32_bf16 v[164:167], a[96:99], a[8:11], v[164:167]
v_accvgpr_read_b32 v21, a175
v_lshlrev_b32 v18, 16, v19
v_mfma_f32_16x16x32_bf16 v[164:167], a[100:103], a[12:15], v[164:167]
s_xor_b32 m0, s84, 1024
v_and_b32 v19, 0xffff0000, v19
v_lshlrev_b32 v20, 16, v21
v_mfma_f32_16x16x32_bf16 v[156:159], a[100:103], a[4:7], v[156:159]
s_xor_b32 s64, s70, 8960
v_and_b32 v21, 0xffff0000, v21
v_mul_f32 v18, v18, v20
v_mfma_f32_16x16x32_bf16 v[156:159], a[96:99], a[0:3], v[156:159]
buffer_load_dwordx4 v13, s[32:35], s64 offen lds
v_mfma_f32_16x16x32_bf16 v[24:27], a[104:107], a[0:3], v[24:27]
ds_read_b64_tr_b16 a[96:97], v7 offset:49152
v_mul_f32 v19, v19, v21
v_mfma_f32_16x16x32_bf16 v[24:27], a[108:111], a[4:7], v[24:27]
ds_read_b64_tr_b16 a[98:99], v7 offset:50176
v_cvt_pk_bf16_f32 v18, v18, v19
v_mfma_f32_16x16x32_bf16 v[40:43], a[108:111], a[12:15], v[40:43]
ds_read_b64_tr_b16 a[100:101], v7 offset:57344
v_lshlrev_b32 v19, 16, v18
v_mfma_f32_16x16x32_bf16 v[40:43], a[104:107], a[8:11], v[40:43]
ds_read_b64_tr_b16 a[102:103], v7 offset:58368
v_and_b32 v18, 0xffff0000, v18
v_mfma_f32_16x16x32_bf16 v[56:59], a[104:107], a[16:19], v[56:59]
s_xor_b32 m0, s84, 2048
v_add_f32 v17, v17, v19
v_add_f32 v17, v17, v18
v_mfma_f32_16x16x32_bf16 v[56:59], a[108:111], a[20:23], v[56:59]
s_xor_b32 s64, s70, 17152
v_mfma_f32_16x16x32_bf16 v[72:75], a[108:111], a[28:31], v[72:75]
s_waitcnt vmcnt(12)
buffer_load_dwordx4 v12, s[32:35], s64 offen lds
v_mfma_f32_16x16x32_bf16 v[72:75], a[104:107], a[24:27], v[72:75]
s_waitcnt lgkmcnt(4)
ds_read_b64_tr_b16 a[104:105], v8 offset:49152
v_add_f32_dpp v17, v17, v17 row_ror:8 row_mask:0xf bank_mask:0xf
v_mfma_f32_16x16x32_bf16 v[136:139], a[112:115], a[24:27], v[136:139]
ds_read_b64_tr_b16 a[106:107], v8 offset:50176
v_mfma_f32_16x16x32_bf16 v[136:139], a[116:119], a[28:31], v[136:139]
ds_read_b64_tr_b16 a[108:109], v8 offset:57344
v_add_u32 v4, 0x8000, v4
v_mfma_f32_16x16x32_bf16 v[120:123], a[116:119], a[20:23], v[120:123]
ds_read_b64_tr_b16 a[110:111], v8 offset:58368
v_add_f32_dpp v17, v17, v17 row_ror:4 row_mask:0xf bank_mask:0xf
v_mfma_f32_16x16x32_bf16 v[120:123], a[112:115], a[16:19], v[120:123]
s_xor_b32 m0, s84, 3072
ds_read_b128 a[32:35], v2 offset:32768
v_mfma_f32_16x16x32_bf16 v[104:107], a[112:115], a[8:11], v[104:107]
s_xor_b32 s64, s70, 25344
ds_read_b128 a[36:39], v3 offset:32768
v_add_f32_dpp v17, v17, v17 row_ror:2 row_mask:0xf bank_mask:0xf
v_mfma_f32_16x16x32_bf16 v[104:107], a[116:119], a[12:15], v[104:107]
buffer_load_dwordx4 v13, s[32:35], s64 offen lds
v_mfma_f32_16x16x32_bf16 v[88:91], a[116:119], a[4:7], v[88:91]
ds_read_b128 a[40:43], v2 offset:34816
v_add_f32_dpp v17, v17, v17 row_ror:1 row_mask:0xf bank_mask:0xf
v_mfma_f32_16x16x32_bf16 v[88:91], a[112:115], a[0:3], v[88:91]
ds_read_b128 a[44:47], v3 offset:34816
v_mov_b32 v18, v17
v_mfma_f32_16x16x32_bf16 v[28:31], a[0:3], a[72:75], v[28:31]
ds_read_b128 a[48:51], v2 offset:36864
v_mfma_f32_16x16x32_bf16 v[28:31], a[4:7], a[76:79], v[28:31]
ds_read_b128 a[52:55], v3 offset:36864
v_add_u32 v5, 0x8000, v5
v_mfma_f32_16x16x32_bf16 v[44:47], a[12:15], a[76:79], v[44:47]
s_xor_b32 m0, s84, 4096
ds_read_b128 a[56:59], v2 offset:38912
v_permlane16_swap_b32 v18, v17
v_mfma_f32_16x16x32_bf16 v[44:47], a[8:11], a[72:75], v[44:47]
s_xor_b32 s64, s70, 33536
ds_read_b128 a[60:63], v3 offset:38912
v_add_f32 v17, v17, v18
v_mfma_f32_16x16x32_bf16 v[60:63], a[16:19], a[72:75], v[60:63]
s_add_u32 s81, s81, 1048576
buffer_load_dwordx4 v12, s[32:35], s64 offen lds
v_mfma_f32_16x16x32_bf16 v[60:63], a[20:23], a[76:79], v[60:63]
buffer_load_dword a252, v16, s[56:59], s81 offen
v_mfma_f32_16x16x32_bf16 v[76:79], a[28:31], a[76:79], v[76:79]
ds_read_b64_tr_b16 a[112:113], v9 offset:49152
v_cvt_pk_bf16_f32 v17, v17, v17
v_mfma_f32_16x16x32_bf16 v[76:79], a[24:27], a[72:75], v[76:79]
ds_read_b64_tr_b16 a[114:115], v9 offset:50176
v_and_b32 v17, 0xffff0000, v17
v_mfma_f32_16x16x32_bf16 v[140:143], a[24:27], a[80:83], v[140:143]
ds_read_b64_tr_b16 a[116:117], v9 offset:57344
v_mul_f32 v17, 0xbfb8aa3b, v17
v_mfma_f32_16x16x32_bf16 v[140:143], a[28:31], a[84:87], v[140:143]
s_xor_b32 m0, s84, 5120
ds_read_b64_tr_b16 a[118:119], v9 offset:58368
v_add_u32 v6, 0x8000, v6
v_mfma_f32_16x16x32_bf16 v[124:127], a[20:23], a[84:87], v[124:127]
s_xor_b32 s64, s70, 41728
ds_read_b64_tr_b16 a[72:73], v10 offset:49152
v_mfma_f32_16x16x32_bf16 v[124:127], a[16:19], a[80:83], v[124:127]
buffer_load_dwordx4 v13, s[32:35], s64 offen lds
v_mfma_f32_16x16x32_bf16 v[108:111], a[8:11], a[80:83], v[108:111]
ds_read_b64_tr_b16 a[74:75], v10 offset:50176
v_mfma_f32_16x16x32_bf16 v[108:111], a[12:15], a[84:87], v[108:111]
ds_read_b64_tr_b16 a[76:77], v10 offset:57344
v_mfma_f32_16x16x32_bf16 v[92:95], a[4:7], a[84:87], v[92:95]
ds_read_b64_tr_b16 a[78:79], v10 offset:58368
v_mfma_f32_16x16x32_bf16 v[92:95], a[0:3], a[80:83], v[92:95]
ds_read_b64_tr_b16 a[80:81], v11 offset:49152
v_mfma_f32_16x16x32_bf16 v[32:35], a[0:3], a[88:91], v[32:35]
s_xor_b32 m0, s84, 6144
ds_read_b64_tr_b16 a[82:83], v11 offset:50176
v_mfma_f32_16x16x32_bf16 v[32:35], a[4:7], a[92:95], v[32:35]
s_xor_b32 s64, s70, 49920
ds_read_b64_tr_b16 a[84:85], v11 offset:57344
v_add_u32 v7, 0x8000, v7
v_mfma_f32_16x16x32_bf16 v[48:51], a[12:15], a[92:95], v[48:51]
buffer_load_dwordx4 v12, s[32:35], s64 offen lds
v_mfma_f32_16x16x32_bf16 v[48:51], a[8:11], a[88:91], v[48:51]
ds_read_b64_tr_b16 a[86:87], v11 offset:58368
v_mfma_f32_16x16x32_bf16 v[64:67], a[16:19], a[88:91], v[64:67]
v_exp_f32 v17, v17
v_mfma_f32_16x16x32_bf16 v[64:67], a[20:23], a[92:95], v[64:67]
v_add_f32 v17, 1.0, v17
v_mfma_f32_16x16x32_bf16 v[80:83], a[28:31], a[92:95], v[80:83]
v_rcp_f32 v17, v17
v_mfma_f32_16x16x32_bf16 v[80:83], a[24:27], a[88:91], v[80:83]
s_waitcnt lgkmcnt(5)
s_xor_b32 m0, s84, 7168
v_cvt_pk_bf16_f32 v18, v17, v17
v_mfma_f32_16x16x32_bf16 v[144:147], a[24:27], a[96:99], v[144:147]
s_xor_b32 s64, s70, 58112
v_and_b32 v18, 0xffff0000, v18
v_mfma_f32_16x16x32_bf16 v[144:147], a[28:31], a[100:103], v[144:147]
buffer_load_dwordx4 v13, s[32:35], s64 offen lds
v_mfma_f32_16x16x32_bf16 v[128:131], a[20:23], a[100:103], v[128:131]
s_branch L_po4
L_pg4:
s_branch L_tr0
L_po4:
v_add_u32 v8, 0x8000, v8
v_sub_f32 v19, 1.0, v18
v_mfma_f32_16x16x32_bf16 v[128:131], a[16:19], a[96:99], v[128:131]
v_cvt_pk_bf16_f32 v19, v19, v19
v_mfma_f32_16x16x32_bf16 v[112:115], a[8:11], a[96:99], v[112:115]
v_and_b32 v19, 0xffff0000, v19
v_mfma_f32_16x16x32_bf16 v[112:115], a[12:15], a[100:103], v[112:115]
v_and_b32 v20, 31, v0
v_mfma_f32_16x16x32_bf16 v[96:99], a[4:7], a[100:103], v[96:99]
v_add_u32 v9, 0x8000, v9
v_add_u32 v10, 0x8000, v10
v_mfma_f32_16x16x32_bf16 v[96:99], a[0:3], a[96:99], v[96:99]
v_add_u32 v11, 0x8000, v11
v_lshlrev_b32 v20, 27, v20
v_mfma_f32_16x16x32_bf16 v[36:39], a[0:3], a[104:107], v[36:39]
v_lshrrev_b32 v21, 2, v0
v_mfma_f32_16x16x32_bf16 v[36:39], a[4:7], a[108:111], v[36:39]
v_add_u32 v20, v20, v21
v_mfma_f32_16x16x32_bf16 v[52:55], a[12:15], a[108:111], v[52:55]
s_waitcnt lgkmcnt(0)
s_barrier
v_mfma_f32_16x16x32_bf16 v[52:55], a[8:11], a[104:107], v[52:55]
s_xor_b32 m0, s77, 98304
ds_read_b64_tr_b16 a[88:89], v4 offset:32768
v_mfma_f32_16x16x32_bf16 v[68:71], a[16:19], a[104:107], v[68:71]
s_xor_b32 s64, s71, 3670016
ds_read_b64_tr_b16 a[90:91], v4 offset:33792
v_mfma_f32_16x16x32_bf16 v[68:71], a[20:23], a[108:111], v[68:71]
buffer_load_dwordx4 v14, s[36:39], s64 offen lds
v_mfma_f32_16x16x32_bf16 v[84:87], a[28:31], a[108:111], v[84:87]
ds_read_b64_tr_b16 a[92:93], v4 offset:40960
v_mfma_f32_16x16x32_bf16 v[84:87], a[24:27], a[104:107], v[84:87]
ds_read_b64_tr_b16 a[94:95], v4 offset:41984
v_mfma_f32_16x16x32_bf16 v[148:151], a[24:27], a[112:115], v[148:151]
ds_read_b64_tr_b16 a[96:97], v5 offset:32768
v_mfma_f32_16x16x32_bf16 v[148:151], a[28:31], a[116:119], v[148:151]
ds_read_b64_tr_b16 a[98:99], v5 offset:33792
v_mfma_f32_16x16x32_bf16 v[132:135], a[20:23], a[116:119], v[132:135]
ds_read_b64_tr_b16 a[100:101], v5 offset:40960
v_mfma_f32_16x16x32_bf16 v[132:135], a[16:19], a[112:115], v[132:135]
s_xor_b32 m0, s77, 99328
s_add_u32 s82, s82, 1048576
ds_read_b64_tr_b16 a[102:103], v5 offset:41984
v_mfma_f32_16x16x32_bf16 v[116:119], a[8:11], a[112:115], v[116:119]
s_xor_b32 s64, s71, 3702784
buffer_load_dword a252, v1, s[60:63], s82 offen
v_mfma_f32_16x16x32_bf16 v[116:119], a[12:15], a[116:119], v[116:119]
buffer_load_dwordx4 v14, s[36:39], s64 offen lds
v_mfma_f32_16x16x32_bf16 v[100:103], a[4:7], a[116:119], v[100:103]
ds_read_b64_tr_b16 a[104:105], v6 offset:32768
v_mfma_f32_16x16x32_bf16 v[100:103], a[0:3], a[112:115], v[100:103]
ds_read_b64_tr_b16 a[106:107], v6 offset:33792
v_mfma_f32_16x16x32_bf16 v[248:251], a[0:3], a[72:75], v[248:251]
ds_read_b64_tr_b16 a[108:109], v6 offset:40960
v_mfma_f32_16x16x32_bf16 v[248:251], a[4:7], a[76:79], v[248:251]
ds_read_b64_tr_b16 a[110:111], v6 offset:41984
v_mfma_f32_16x16x32_bf16 v[252:255], a[12:15], a[76:79], v[252:255]
ds_read_b64_tr_b16 a[112:113], v7 offset:32768
v_mfma_f32_16x16x32_bf16 v[252:255], a[8:11], a[72:75], v[252:255]
s_xor_b32 m0, s77, 100352
ds_read_b64_tr_b16 a[114:115], v7 offset:33792
v_mfma_f32_16x16x32_bf16 a[120:123], a[16:19], a[72:75], a[120:123]
s_xor_b32 s64, s71, 3735552
ds_read_b64_tr_b16 a[116:117], v7 offset:40960
v_mfma_f32_16x16x32_bf16 a[120:123], a[20:23], a[76:79], a[120:123]
buffer_load_dwordx4 v15, s[36:39], s64 offen lds
v_mfma_f32_16x16x32_bf16 a[124:127], a[28:31], a[76:79], a[124:127]
ds_read_b64_tr_b16 a[118:119], v7 offset:41984
v_mfma_f32_16x16x32_bf16 a[124:127], a[24:27], a[72:75], a[124:127]
ds_read_b64_tr_b16 a[72:73], v8 offset:32768
v_mfma_f32_16x16x32_bf16 a[128:131], a[24:27], a[80:83], a[128:131]
ds_read_b64_tr_b16 a[74:75], v8 offset:33792
v_mfma_f32_16x16x32_bf16 a[128:131], a[28:31], a[84:87], a[128:131]
s_lshl2_add_u32 s65, s2, s30
ds_read_b64_tr_b16 a[76:77], v8 offset:40960
v_mfma_f32_16x16x32_bf16 a[132:135], a[20:23], a[84:87], a[132:135]
s_lshl4_add_u32 s65, s65, 58720256
ds_read_b64_tr_b16 a[78:79], v8 offset:41984
v_mfma_f32_16x16x32_bf16 a[132:135], a[16:19], a[80:83], a[132:135]
s_xor_b32 m0, s77, 101376
buffer_store_dwordx2 v[18:19], v20, s[44:47], s65 offen sc1
v_mfma_f32_16x16x32_bf16 a[136:139], a[8:11], a[80:83], a[136:139]
s_xor_b32 s64, s71, 3768320
v_lshrrev_b32 v21, 4, v0
v_mfma_f32_16x16x32_bf16 a[136:139], a[12:15], a[84:87], a[136:139]
buffer_load_dwordx4 v15, s[36:39], s64 offen lds
v_mfma_f32_16x16x32_bf16 a[140:143], a[4:7], a[84:87], a[140:143]
v_bfe_u32 v19, v0, 2, 2
v_mfma_f32_16x16x32_bf16 a[140:143], a[0:3], a[80:83], a[140:143]
s_waitcnt lgkmcnt(5)
ds_read_b64_tr_b16 a[80:81], v9 offset:32768
v_lshl_add_u32 v19, v21, 3, v19
v_mfma_f32_16x16x32_bf16 v[184:187], a[88:91], a[32:35], v[184:187]
ds_read_b64_tr_b16 a[82:83], v9 offset:33792
v_lshlrev_b32 v19, 6, v19
v_mfma_f32_16x16x32_bf16 v[184:187], a[92:95], a[36:39], v[184:187]
ds_read_b64_tr_b16 a[84:85], v9 offset:40960
v_and_b32 v21, 1, v21
v_mfma_f32_16x16x32_bf16 v[192:195], a[92:95], a[44:47], v[192:195]
ds_read_b64_tr_b16 a[86:87], v9 offset:41984
v_lshl_add_u32 v19, v21, 5, v19
v_mfma_f32_16x16x32_bf16 v[192:195], a[88:91], a[40:43], v[192:195]
s_xor_b32 m0, s77, 114688
v_and_b32 v21, 3, v0
v_mfma_f32_16x16x32_bf16 v[200:203], a[88:91], a[48:51], v[200:203]
s_xor_b32 s64, s71, 3670016
v_lshl_add_u32 v19, v21, 3, v19
v_mfma_f32_16x16x32_bf16 v[200:203], a[92:95], a[52:55], v[200:203]
buffer_load_dwordx4 v14, s[40:43], s64 offen lds
v_mfma_f32_16x16x32_bf16 v[208:211], a[92:95], a[60:63], v[208:211]
v_add_u32 v19, 114688, v19
v_mfma_f32_16x16x32_bf16 v[208:211], a[88:91], a[56:59], v[208:211]
ds_read_b64_tr_b16 a[88:89], v10 offset:32768
v_xor_b32 v20, 32, v19
v_mfma_f32_16x16x32_bf16 v[212:215], a[96:99], a[56:59], v[212:215]
ds_read_b64_tr_b16 a[90:91], v10 offset:33792
v_mfma_f32_16x16x32_bf16 v[212:215], a[100:103], a[60:63], v[212:215]
ds_read_b64_tr_b16 a[92:93], v10 offset:40960
v_mfma_f32_16x16x32_bf16 v[204:207], a[100:103], a[52:55], v[204:207]
ds_read_b64_tr_b16 a[94:95], v10 offset:41984
v_mfma_f32_16x16x32_bf16 v[204:207], a[96:99], a[48:51], v[204:207]
s_xor_b32 m0, s77, 115712
v_mfma_f32_16x16x32_bf16 v[196:199], a[96:99], a[40:43], v[196:199]
s_xor_b32 s64, s71, 3702784
v_mfma_f32_16x16x32_bf16 v[196:199], a[100:103], a[44:47], v[196:199]
buffer_load_dwordx4 v14, s[40:43], s64 offen lds
v_mfma_f32_16x16x32_bf16 v[188:191], a[100:103], a[36:39], v[188:191]
v_mfma_f32_16x16x32_bf16 v[188:191], a[96:99], a[32:35], v[188:191]
ds_read_b64_tr_b16 a[96:97], v11 offset:32768
v_mfma_f32_16x16x32_bf16 v[216:219], a[104:107], a[32:35], v[216:219]
ds_read_b64_tr_b16 a[98:99], v11 offset:33792
v_mfma_f32_16x16x32_bf16 v[216:219], a[108:111], a[36:39], v[216:219]
ds_read_b64_tr_b16 a[100:101], v11 offset:40960
v_mfma_f32_16x16x32_bf16 v[224:227], a[108:111], a[44:47], v[224:227]
ds_read_b64_tr_b16 a[102:103], v11 offset:41984
v_mfma_f32_16x16x32_bf16 v[224:227], a[104:107], a[40:43], v[224:227]
s_xor_b32 m0, s77, 116736
s_add_u32 s81, s81, 1048576
v_mfma_f32_16x16x32_bf16 v[232:235], a[104:107], a[48:51], v[232:235]
s_xor_b32 s64, s71, 3735552
buffer_load_dword a252, v16, s[56:59], s81 offen
v_mfma_f32_16x16x32_bf16 v[232:235], a[108:111], a[52:55], v[232:235]
buffer_load_dwordx4 v15, s[40:43], s64 offen lds
v_mfma_f32_16x16x32_bf16 v[240:243], a[108:111], a[60:63], v[240:243]
v_mfma_f32_16x16x32_bf16 v[240:243], a[104:107], a[56:59], v[240:243]
ds_read_b64_tr_b16 a[104:105], v4 offset:49152
v_mfma_f32_16x16x32_bf16 v[244:247], a[112:115], a[56:59], v[244:247]
s_waitcnt lgkmcnt(5)
ds_read_b64_tr_b16 a[106:107], v4 offset:50176
v_mfma_f32_16x16x32_bf16 v[244:247], a[116:119], a[60:63], v[244:247]
ds_read_b64_tr_b16 a[108:109], v4 offset:57344
v_mfma_f32_16x16x32_bf16 v[236:239], a[116:119], a[52:55], v[236:239]
ds_read_b64_tr_b16 a[110:111], v4 offset:58368
v_mfma_f32_16x16x32_bf16 v[236:239], a[112:115], a[48:51], v[236:239]
s_xor_b32 m0, s77, 117760
v_mfma_f32_16x16x32_bf16 v[228:231], a[112:115], a[40:43], v[228:231]
s_xor_b32 s64, s71, 3768320
v_mfma_f32_16x16x32_bf16 v[228:231], a[116:119], a[44:47], v[228:231]
buffer_load_dwordx4 v15, s[40:43], s64 offen lds
v_mfma_f32_16x16x32_bf16 v[220:223], a[116:119], a[36:39], v[220:223]
v_mfma_f32_16x16x32_bf16 v[220:223], a[112:115], a[32:35], v[220:223]
ds_read_b64_tr_b16 a[112:113], v5 offset:49152
v_mfma_f32_16x16x32_bf16 v[152:155], a[72:75], a[32:35], v[152:155]
ds_read_b64_tr_b16 a[114:115], v5 offset:50176
v_mfma_f32_16x16x32_bf16 v[152:155], a[76:79], a[36:39], v[152:155]
ds_read_b64_tr_b16 a[116:117], v5 offset:57344
v_mfma_f32_16x16x32_bf16 v[160:163], a[76:79], a[44:47], v[160:163]
ds_read_b64_tr_b16 a[118:119], v5 offset:58368
v_mfma_f32_16x16x32_bf16 v[160:163], a[72:75], a[40:43], v[160:163]
v_mfma_f32_16x16x32_bf16 v[168:171], a[72:75], a[48:51], v[168:171]
v_mfma_f32_16x16x32_bf16 v[168:171], a[76:79], a[52:55], v[168:171]
v_mfma_f32_16x16x32_bf16 v[176:179], a[76:79], a[60:63], v[176:179]
s_xor_b32 m0, s84, 32768
v_mfma_f32_16x16x32_bf16 v[176:179], a[72:75], a[56:59], v[176:179]
s_xor_b32 s64, s70, 896
ds_read_b64_tr_b16 a[72:73], v6 offset:49152
v_mfma_f32_16x16x32_bf16 v[180:183], a[80:83], a[56:59], v[180:183]
buffer_load_dwordx4 v12, s[32:35], s64 offen lds
v_mfma_f32_16x16x32_bf16 v[180:183], a[84:87], a[60:63], v[180:183]
ds_read_b64_tr_b16 a[74:75], v6 offset:50176
v_mfma_f32_16x16x32_bf16 v[172:175], a[84:87], a[52:55], v[172:175]
ds_read_b64_tr_b16 a[76:77], v6 offset:57344
v_mfma_f32_16x16x32_bf16 v[172:175], a[80:83], a[48:51], v[172:175]
ds_read_b64_tr_b16 a[78:79], v6 offset:58368
v_mfma_f32_16x16x32_bf16 v[164:167], a[80:83], a[40:43], v[164:167]
v_mfma_f32_16x16x32_bf16 v[164:167], a[84:87], a[44:47], v[164:167]
s_xor_b32 m0, s84, 33792
v_mfma_f32_16x16x32_bf16 v[156:159], a[84:87], a[36:39], v[156:159]
s_xor_b32 s64, s70, 9088
v_mfma_f32_16x16x32_bf16 v[156:159], a[80:83], a[32:35], v[156:159]
buffer_load_dwordx4 v13, s[32:35], s64 offen lds
v_mfma_f32_16x16x32_bf16 v[24:27], a[88:91], a[32:35], v[24:27]
ds_read_b64_tr_b16 a[80:81], v7 offset:49152
v_mfma_f32_16x16x32_bf16 v[24:27], a[92:95], a[36:39], v[24:27]
ds_read_b64_tr_b16 a[82:83], v7 offset:50176
v_mfma_f32_16x16x32_bf16 v[40:43], a[92:95], a[44:47], v[40:43]
ds_read_b64_tr_b16 a[84:85], v7 offset:57344
v_mfma_f32_16x16x32_bf16 v[40:43], a[88:91], a[40:43], v[40:43]
ds_read_b64_tr_b16 a[86:87], v7 offset:58368
v_mfma_f32_16x16x32_bf16 v[56:59], a[88:91], a[48:51], v[56:59]
s_xor_b32 m0, s84, 34816
v_mfma_f32_16x16x32_bf16 v[56:59], a[92:95], a[52:55], v[56:59]
s_xor_b32 s64, s70, 17280
v_mfma_f32_16x16x32_bf16 v[72:75], a[92:95], a[60:63], v[72:75]
s_waitcnt vmcnt(13)
buffer_load_dwordx4 v12, s[32:35], s64 offen lds
v_mfma_f32_16x16x32_bf16 v[72:75], a[88:91], a[56:59], v[72:75]
s_waitcnt lgkmcnt(4)
ds_read_b64_tr_b16 a[88:89], v8 offset:49152
v_mfma_f32_16x16x32_bf16 v[136:139], a[96:99], a[56:59], v[136:139]
ds_read_b64_tr_b16 a[90:91], v8 offset:50176
v_mfma_f32_16x16x32_bf16 v[136:139], a[100:103], a[60:63], v[136:139]
ds_read_b64_tr_b16 a[92:93], v8 offset:57344
v_subrev_u32 v4, 0x8000, v4
v_mfma_f32_16x16x32_bf16 v[120:123], a[100:103], a[52:55], v[120:123]
ds_read_b64_tr_b16 a[94:95], v8 offset:58368
v_mfma_f32_16x16x32_bf16 v[120:123], a[96:99], a[48:51], v[120:123]
s_xor_b32 m0, s84, 35840
s_add_u32 s81, s81, 1048576
ds_read_b128 a[0:3], v2 offset:0
v_mfma_f32_16x16x32_bf16 v[104:107], a[96:99], a[40:43], v[104:107]
s_xor_b32 s64, s70, 25472
buffer_load_dword a252, v16, s[56:59], s81 offen
v_mfma_f32_16x16x32_bf16 v[104:107], a[100:103], a[44:47], v[104:107]
buffer_load_dwordx4 v13, s[32:35], s64 offen lds
v_mfma_f32_16x16x32_bf16 v[88:91], a[100:103], a[36:39], v[88:91]
ds_read_b128 a[4:7], v3 offset:0
v_mfma_f32_16x16x32_bf16 v[88:91], a[96:99], a[32:35], v[88:91]
ds_read_b128 a[8:11], v2 offset:2048
v_mfma_f32_16x16x32_bf16 v[28:31], a[32:35], a[104:107], v[28:31]
ds_read_b128 a[12:15], v3 offset:2048
v_mfma_f32_16x16x32_bf16 v[28:31], a[36:39], a[108:111], v[28:31]
ds_read_b128 a[16:19], v2 offset:4096
v_subrev_u32 v5, 0x8000, v5
v_mfma_f32_16x16x32_bf16 v[44:47], a[44:47], a[108:111], v[44:47]
s_xor_b32 m0, s84, 36864
ds_read_b128 a[20:23], v3 offset:4096
v_mfma_f32_16x16x32_bf16 v[44:47], a[40:43], a[104:107], v[44:47]
s_xor_b32 s64, s70, 33664
ds_read_b128 a[24:27], v2 offset:6144
v_mfma_f32_16x16x32_bf16 v[60:63], a[48:51], a[104:107], v[60:63]
buffer_load_dwordx4 v12, s[32:35], s64 offen lds
v_mfma_f32_16x16x32_bf16 v[60:63], a[52:55], a[108:111], v[60:63]
ds_read_b128 a[28:31], v3 offset:6144
v_mfma_f32_16x16x32_bf16 v[76:79], a[60:63], a[108:111], v[76:79]
ds_read_b64_tr_b16 a[96:97], v9 offset:49152
v_mfma_f32_16x16x32_bf16 v[76:79], a[56:59], a[104:107], v[76:79]
ds_read_b64_tr_b16 a[98:99], v9 offset:50176
v_mfma_f32_16x16x32_bf16 v[140:143], a[56:59], a[112:115], v[140:143]
ds_read_b64_tr_b16 a[100:101], v9 offset:57344
v_mfma_f32_16x16x32_bf16 v[140:143], a[60:63], a[116:119], v[140:143]
s_xor_b32 m0, s84, 37888
ds_read_b64_tr_b16 a[102:103], v9 offset:58368
v_subrev_u32 v6, 0x8000, v6
v_mfma_f32_16x16x32_bf16 v[124:127], a[52:55], a[116:119], v[124:127]
s_xor_b32 s64, s70, 41856
ds_read_b64_tr_b16 a[104:105], v10 offset:49152
v_mfma_f32_16x16x32_bf16 v[124:127], a[48:51], a[112:115], v[124:127]
buffer_load_dwordx4 v13, s[32:35], s64 offen lds
v_mfma_f32_16x16x32_bf16 v[108:111], a[40:43], a[112:115], v[108:111]
ds_read_b64_tr_b16 a[106:107], v10 offset:50176
v_mfma_f32_16x16x32_bf16 v[108:111], a[44:47], a[116:119], v[108:111]
ds_read_b64_tr_b16 a[108:109], v10 offset:57344
v_mfma_f32_16x16x32_bf16 v[92:95], a[36:39], a[116:119], v[92:95]
ds_read_b64_tr_b16 a[110:111], v10 offset:58368
v_mfma_f32_16x16x32_bf16 v[92:95], a[32:35], a[112:115], v[92:95]
ds_read_b64_tr_b16 a[112:113], v11 offset:49152
v_mfma_f32_16x16x32_bf16 v[32:35], a[32:35], a[72:75], v[32:35]
s_xor_b32 m0, s84, 38912
ds_read_b64_tr_b16 a[114:115], v11 offset:50176
v_mfma_f32_16x16x32_bf16 v[32:35], a[36:39], a[76:79], v[32:35]
s_xor_b32 s64, s70, 50048
ds_read_b64_tr_b16 a[116:117], v11 offset:57344
v_subrev_u32 v7, 0x8000, v7
v_mfma_f32_16x16x32_bf16 v[48:51], a[44:47], a[76:79], v[48:51]
buffer_load_dwordx4 v12, s[32:35], s64 offen lds
v_mfma_f32_16x16x32_bf16 v[48:51], a[40:43], a[72:75], v[48:51]
ds_read_b64_tr_b16 a[118:119], v11 offset:58368
v_mfma_f32_16x16x32_bf16 v[64:67], a[48:51], a[72:75], v[64:67]
v_mfma_f32_16x16x32_bf16 v[64:67], a[52:55], a[76:79], v[64:67]
v_mfma_f32_16x16x32_bf16 v[80:83], a[60:63], a[76:79], v[80:83]
v_mfma_f32_16x16x32_bf16 v[80:83], a[56:59], a[72:75], v[80:83]
s_waitcnt lgkmcnt(5)
s_xor_b32 m0, s84, 39936
v_mfma_f32_16x16x32_bf16 v[144:147], a[56:59], a[80:83], v[144:147]
s_xor_b32 s64, s70, 58240
v_mfma_f32_16x16x32_bf16 v[144:147], a[60:63], a[84:87], v[144:147]
buffer_load_dwordx4 v13, s[32:35], s64 offen lds
v_mfma_f32_16x16x32_bf16 v[128:131], a[52:55], a[84:87], v[128:131]
v_subrev_u32 v8, 0x8000, v8
v_mfma_f32_16x16x32_bf16 v[128:131], a[48:51], a[80:83], v[128:131]
v_mfma_f32_16x16x32_bf16 v[112:115], a[40:43], a[80:83], v[112:115]
v_mfma_f32_16x16x32_bf16 v[112:115], a[44:47], a[84:87], v[112:115]
v_mfma_f32_16x16x32_bf16 v[96:99], a[36:39], a[84:87], v[96:99]
s_and_b32 s77, s77, 0x3fff
v_subrev_u32 v9, 0x8000, v9
v_subrev_u32 v10, 0x8000, v10
v_mfma_f32_16x16x32_bf16 v[96:99], a[32:35], a[80:83], v[96:99]
v_subrev_u32 v11, 0x8000, v11
v_mfma_f32_16x16x32_bf16 v[36:39], a[32:35], a[88:91], v[36:39]
v_mfma_f32_16x16x32_bf16 v[36:39], a[36:39], a[92:95], v[36:39]
v_mfma_f32_16x16x32_bf16 v[52:55], a[44:47], a[92:95], v[52:55]
s_waitcnt lgkmcnt(0)
s_barrier
v_mfma_f32_16x16x32_bf16 v[52:55], a[40:43], a[88:91], v[52:55]
s_xor_b32 m0, s77, 131072
s_add_u32 s82, s82, 1048576
ds_read_b64_tr_b16 a[72:73], v4 offset:0
v_mfma_f32_16x16x32_bf16 v[68:71], a[48:51], a[88:91], v[68:71]
s_xor_b32 s64, s71, 0
buffer_load_dword a252, v1, s[60:63], s82 offen
v_mfma_f32_16x16x32_bf16 v[68:71], a[52:55], a[92:95], v[68:71]
buffer_load_dwordx4 v14, s[56:59], s64 offen lds
v_mfma_f32_16x16x32_bf16 v[84:87], a[60:63], a[92:95], v[84:87]
ds_read_b64_tr_b16 a[74:75], v4 offset:1024
v_mfma_f32_16x16x32_bf16 v[84:87], a[56:59], a[88:91], v[84:87]
ds_read_b64_tr_b16 a[76:77], v4 offset:8192
v_mfma_f32_16x16x32_bf16 v[148:151], a[56:59], a[96:99], v[148:151]
ds_read_b64_tr_b16 a[78:79], v4 offset:9216
v_lshrrev_b32 v13, 3, v0
v_mfma_f32_16x16x32_bf16 v[148:151], a[60:63], a[100:103], v[148:151]
ds_read_b64_tr_b16 a[80:81], v5 offset:0
v_lshl_add_u32 v12, v13, 10, v12
v_mfma_f32_16x16x32_bf16 v[132:135], a[52:55], a[100:103], v[132:135]
ds_read_b64_tr_b16 a[82:83], v5 offset:1024
v_xor_b32 v13, 64, v12
v_mfma_f32_16x16x32_bf16 v[132:135], a[48:51], a[96:99], v[132:135]
ds_read_b64_tr_b16 a[84:85], v5 offset:8192
v_mfma_f32_16x16x32_bf16 v[116:119], a[40:43], a[96:99], v[116:119]
s_add_u32 m0, s78, 147456
ds_read_b64_tr_b16 a[86:87], v5 offset:9216
v_mfma_f32_16x16x32_bf16 v[116:119], a[44:47], a[100:103], v[116:119]
s_add_u32 s64, s75, 0
ds_read_b64_tr_b16 a[88:89], v6 offset:0
v_mfma_f32_16x16x32_bf16 v[100:103], a[36:39], a[100:103], v[100:103]
buffer_load_dwordx4 v23, s[60:63], s64 offen lds
v_mfma_f32_16x16x32_bf16 v[100:103], a[32:35], a[96:99], v[100:103]
ds_read_b64_tr_b16 a[90:91], v6 offset:1024
v_mfma_f32_16x16x32_bf16 v[248:251], a[32:35], a[104:107], v[248:251]
ds_read_b64_tr_b16 a[92:93], v6 offset:8192
v_mfma_f32_16x16x32_bf16 v[248:251], a[36:39], a[108:111], v[248:251]
ds_read_b64_tr_b16 a[94:95], v6 offset:9216
v_mfma_f32_16x16x32_bf16 v[252:255], a[44:47], a[108:111], v[252:255]
ds_read_b64_tr_b16 a[96:97], v7 offset:0
v_mfma_f32_16x16x32_bf16 v[252:255], a[40:43], a[104:107], v[252:255]
ds_read_b64_tr_b16 a[98:99], v7 offset:1024
v_mfma_f32_16x16x32_bf16 a[120:123], a[48:51], a[104:107], a[120:123]
ds_read_b64_tr_b16 a[100:101], v7 offset:8192
v_mfma_f32_16x16x32_bf16 a[120:123], a[52:55], a[108:111], a[120:123]
s_xor_b32 m0, s77, 132096
ds_read_b64_tr_b16 a[102:103], v7 offset:9216
v_mfma_f32_16x16x32_bf16 a[124:127], a[60:63], a[108:111], a[124:127]
s_xor_b32 s64, s71, 32768
v_mfma_f32_16x16x32_bf16 a[124:127], a[56:59], a[104:107], a[124:127]
buffer_load_dwordx4 v14, s[56:59], s64 offen lds
v_mfma_f32_16x16x32_bf16 a[128:131], a[56:59], a[112:115], a[128:131]
ds_read_b64_tr_b16 a[104:105], v8 offset:0
v_mfma_f32_16x16x32_bf16 a[128:131], a[60:63], a[116:119], a[128:131]
ds_read_b64_tr_b16 a[106:107], v8 offset:1024
v_mfma_f32_16x16x32_bf16 a[132:135], a[52:55], a[116:119], a[132:135]
ds_read_b64_tr_b16 a[108:109], v8 offset:8192
v_mfma_f32_16x16x32_bf16 a[132:135], a[48:51], a[112:115], a[132:135]
ds_read_b64_tr_b16 a[110:111], v8 offset:9216
v_mfma_f32_16x16x32_bf16 a[136:139], a[40:43], a[112:115], a[136:139]
v_mfma_f32_16x16x32_bf16 a[136:139], a[44:47], a[116:119], a[136:139]
v_mfma_f32_16x16x32_bf16 a[140:143], a[36:39], a[116:119], a[140:143]
s_add_u32 m0, s78, 151552
v_mfma_f32_16x16x32_bf16 a[140:143], a[32:35], a[112:115], a[140:143]
s_waitcnt lgkmcnt(4)
s_add_u32 s64, s75, 2048
ds_read_b64_tr_b16 a[112:113], v9 offset:0
v_mfma_f32_16x16x32_bf16 v[184:187], a[72:75], a[0:3], v[184:187]
buffer_load_dwordx4 v23, s[60:63], s64 offen lds
v_mfma_f32_16x16x32_bf16 v[184:187], a[76:79], a[4:7], v[184:187]
ds_read_b64_tr_b16 a[114:115], v9 offset:1024
v_mfma_f32_16x16x32_bf16 v[192:195], a[76:79], a[12:15], v[192:195]
ds_read_b64_tr_b16 a[116:117], v9 offset:8192
v_mfma_f32_16x16x32_bf16 v[192:195], a[72:75], a[8:11], v[192:195]
ds_read_b64_tr_b16 a[118:119], v9 offset:9216
v_mfma_f32_16x16x32_bf16 v[200:203], a[72:75], a[16:19], v[200:203]
v_mfma_f32_16x16x32_bf16 v[200:203], a[76:79], a[20:23], v[200:203]
v_mfma_f32_16x16x32_bf16 v[208:211], a[76:79], a[28:31], v[208:211]
v_mfma_f32_16x16x32_bf16 v[208:211], a[72:75], a[24:27], v[208:211]
ds_read_b64_tr_b16 a[72:73], v10 offset:0
v_mfma_f32_16x16x32_bf16 v[212:215], a[80:83], a[24:27], v[212:215]
s_xor_b32 m0, s77, 133120
ds_read_b64_tr_b16 a[74:75], v10 offset:1024
v_mfma_f32_16x16x32_bf16 v[212:215], a[84:87], a[28:31], v[212:215]
s_xor_b32 s64, s71, 65536
ds_read_b64_tr_b16 a[76:77], v10 offset:8192
v_mfma_f32_16x16x32_bf16 v[204:207], a[84:87], a[20:23], v[204:207]
buffer_load_dwordx4 v15, s[56:59], s64 offen lds
v_mfma_f32_16x16x32_bf16 v[204:207], a[80:83], a[16:19], v[204:207]
s_add_u32 s81, s81, 1048576
ds_read_b64_tr_b16 a[78:79], v10 offset:9216
v_mfma_f32_16x16x32_bf16 v[196:199], a[80:83], a[8:11], v[196:199]
buffer_load_dword a252, v16, s[56:59], s81 offen
v_mfma_f32_16x16x32_bf16 v[196:199], a[84:87], a[12:15], v[196:199]
v_mfma_f32_16x16x32_bf16 v[188:191], a[84:87], a[4:7], v[188:191]
v_mfma_f32_16x16x32_bf16 v[188:191], a[80:83], a[0:3], v[188:191]
ds_read_b64_tr_b16 a[80:81], v11 offset:0
v_mfma_f32_16x16x32_bf16 v[216:219], a[88:91], a[0:3], v[216:219]
ds_read_b64_tr_b16 a[82:83], v11 offset:1024
v_mfma_f32_16x16x32_bf16 v[216:219], a[92:95], a[4:7], v[216:219]
s_add_u32 m0, s78, 155648
ds_read_b64_tr_b16 a[84:85], v11 offset:8192
v_mfma_f32_16x16x32_bf16 v[224:227], a[92:95], a[12:15], v[224:227]
s_add_u32 s64, s75, 4096
ds_read_b64_tr_b16 a[86:87], v11 offset:9216
v_mfma_f32_16x16x32_bf16 v[224:227], a[88:91], a[8:11], v[224:227]
buffer_load_dwordx4 v23, s[60:63], s64 offen lds
v_mfma_f32_16x16x32_bf16 v[232:235], a[88:91], a[16:19], v[232:235]
v_mfma_f32_16x16x32_bf16 v[232:235], a[92:95], a[20:23], v[232:235]
v_mfma_f32_16x16x32_bf16 v[240:243], a[92:95], a[28:31], v[240:243]
v_mfma_f32_16x16x32_bf16 v[240:243], a[88:91], a[24:27], v[240:243]
ds_read_b64_tr_b16 a[88:89], v4 offset:16384
v_mfma_f32_16x16x32_bf16 v[244:247], a[96:99], a[24:27], v[244:247]
ds_read_b64_tr_b16 a[90:91], v4 offset:17408
v_mfma_f32_16x16x32_bf16 v[244:247], a[100:103], a[28:31], v[244:247]
ds_read_b64_tr_b16 a[92:93], v4 offset:24576
v_mfma_f32_16x16x32_bf16 v[236:239], a[100:103], a[20:23], v[236:239]
s_xor_b32 m0, s77, 134144
ds_read_b64_tr_b16 a[94:95], v4 offset:25600
v_mfma_f32_16x16x32_bf16 v[236:239], a[96:99], a[16:19], v[236:239]
s_xor_b32 s64, s71, 98304
v_mfma_f32_16x16x32_bf16 v[228:231], a[96:99], a[8:11], v[228:231]
buffer_load_dwordx4 v15, s[56:59], s64 offen lds
v_mfma_f32_16x16x32_bf16 v[228:231], a[100:103], a[12:15], v[228:231]
v_mfma_f32_16x16x32_bf16 v[220:223], a[100:103], a[4:7], v[220:223]
v_mfma_f32_16x16x32_bf16 v[220:223], a[96:99], a[0:3], v[220:223]
s_waitcnt lgkmcnt(4)
ds_read_b64_tr_b16 a[96:97], v5 offset:16384
v_mfma_f32_16x16x32_bf16 v[152:155], a[104:107], a[0:3], v[152:155]
ds_read_b64_tr_b16 a[98:99], v5 offset:17408
v_mfma_f32_16x16x32_bf16 v[152:155], a[108:111], a[4:7], v[152:155]
ds_read_b64_tr_b16 a[100:101], v5 offset:24576
v_mfma_f32_16x16x32_bf16 v[160:163], a[108:111], a[12:15], v[160:163]
ds_read_b64_tr_b16 a[102:103], v5 offset:25600
v_mfma_f32_16x16x32_bf16 v[160:163], a[104:107], a[8:11], v[160:163]
v_mfma_f32_16x16x32_bf16 v[168:171], a[104:107], a[16:19], v[168:171]
v_mfma_f32_16x16x32_bf16 v[168:171], a[108:111], a[20:23], v[168:171]
v_mfma_f32_16x16x32_bf16 v[176:179], a[108:111], a[28:31], v[176:179]
s_xor_b32 m0, s84, 0
v_mfma_f32_16x16x32_bf16 v[176:179], a[104:107], a[24:27], v[176:179]
s_xor_b32 s64, s72, 0
ds_read_b64_tr_b16 a[104:105], v6 offset:16384
v_mfma_f32_16x16x32_bf16 v[180:183], a[112:115], a[24:27], v[180:183]
buffer_load_dwordx4 v12, s[48:51], s64 offen lds
v_mfma_f32_16x16x32_bf16 v[180:183], a[116:119], a[28:31], v[180:183]
ds_read_b64_tr_b16 a[106:107], v6 offset:17408
v_mfma_f32_16x16x32_bf16 v[172:175], a[116:119], a[20:23], v[172:175]
ds_read_b64_tr_b16 a[108:109], v6 offset:24576
v_mfma_f32_16x16x32_bf16 v[172:175], a[112:115], a[16:19], v[172:175]
ds_read_b64_tr_b16 a[110:111], v6 offset:25600
v_mfma_f32_16x16x32_bf16 v[164:167], a[112:115], a[8:11], v[164:167]
v_mfma_f32_16x16x32_bf16 v[164:167], a[116:119], a[12:15], v[164:167]
s_xor_b32 m0, s84, 1024
v_mfma_f32_16x16x32_bf16 v[156:159], a[116:119], a[4:7], v[156:159]
s_xor_b32 s64, s72, 16384
v_mfma_f32_16x16x32_bf16 v[156:159], a[112:115], a[0:3], v[156:159]
buffer_load_dwordx4 v13, s[48:51], s64 offen lds
v_mfma_f32_16x16x32_bf16 v[24:27], a[72:75], a[0:3], v[24:27]
ds_read_b64_tr_b16 a[112:113], v7 offset:16384
v_mfma_f32_16x16x32_bf16 v[24:27], a[76:79], a[4:7], v[24:27]
ds_read_b64_tr_b16 a[114:115], v7 offset:17408
v_mfma_f32_16x16x32_bf16 v[40:43], a[76:79], a[12:15], v[40:43]
ds_read_b64_tr_b16 a[116:117], v7 offset:24576
v_mfma_f32_16x16x32_bf16 v[40:43], a[72:75], a[8:11], v[40:43]
s_add_u32 s82, s82, 1048576
ds_read_b64_tr_b16 a[118:119], v7 offset:25600
v_mfma_f32_16x16x32_bf16 v[56:59], a[72:75], a[16:19], v[56:59]
s_xor_b32 m0, s84, 2048
buffer_load_dword a252, v1, s[60:63], s82 offen
v_mfma_f32_16x16x32_bf16 v[56:59], a[76:79], a[20:23], v[56:59]
s_xor_b32 s64, s72, 131072
v_mfma_f32_16x16x32_bf16 v[72:75], a[76:79], a[28:31], v[72:75]
s_waitcnt vmcnt(12)
buffer_load_dwordx4 v12, s[48:51], s64 offen lds
v_mfma_f32_16x16x32_bf16 v[72:75], a[72:75], a[24:27], v[72:75]
ds_read_b64_tr_b16 a[72:73], v8 offset:16384
v_mfma_f32_16x16x32_bf16 v[136:139], a[80:83], a[24:27], v[136:139]
ds_read_b64_tr_b16 a[74:75], v8 offset:17408
v_mfma_f32_16x16x32_bf16 v[136:139], a[84:87], a[28:31], v[136:139]
ds_read_b64_tr_b16 a[76:77], v8 offset:24576
v_mfma_f32_16x16x32_bf16 v[120:123], a[84:87], a[20:23], v[120:123]
ds_read_b64_tr_b16 a[78:79], v8 offset:25600
v_mfma_f32_16x16x32_bf16 v[120:123], a[80:83], a[16:19], v[120:123]
s_xor_b32 m0, s84, 3072
ds_read_b128 a[32:35], v2 offset:32768
v_mfma_f32_16x16x32_bf16 v[104:107], a[80:83], a[8:11], v[104:107]
s_xor_b32 s64, s72, 147456
ds_read_b128 a[36:39], v3 offset:32768
v_mfma_f32_16x16x32_bf16 v[104:107], a[84:87], a[12:15], v[104:107]
buffer_load_dwordx4 v13, s[48:51], s64 offen lds
v_mfma_f32_16x16x32_bf16 v[88:91], a[84:87], a[4:7], v[88:91]
ds_read_b128 a[40:43], v2 offset:34816
v_mfma_f32_16x16x32_bf16 v[88:91], a[80:83], a[0:3], v[88:91]
s_waitcnt lgkmcnt(7)
ds_read_b128 a[44:47], v3 offset:34816
v_mfma_f32_16x16x32_bf16 v[28:31], a[0:3], a[88:91], v[28:31]
ds_read_b128 a[48:51], v2 offset:36864
v_mfma_f32_16x16x32_bf16 v[28:31], a[4:7], a[92:95], v[28:31]
ds_read_b128 a[52:55], v3 offset:36864
v_mfma_f32_16x16x32_bf16 v[44:47], a[12:15], a[92:95], v[44:47]
s_xor_b32 m0, s84, 4096
ds_read_b128 a[56:59], v2 offset:38912
v_mfma_f32_16x16x32_bf16 v[44:47], a[8:11], a[88:91], v[44:47]
s_xor_b32 s64, s73, 0
ds_read_b128 a[60:63], v3 offset:38912
v_mfma_f32_16x16x32_bf16 v[60:63], a[16:19], a[88:91], v[60:63]
buffer_load_dwordx4 v12, s[48:51], s64 offen lds
v_mfma_f32_16x16x32_bf16 v[60:63], a[20:23], a[92:95], v[60:63]
ds_read_b64_tr_b16 a[80:81], v9 offset:16384
v_mfma_f32_16x16x32_bf16 v[76:79], a[28:31], a[92:95], v[76:79]
ds_read_b64_tr_b16 a[82:83], v9 offset:17408
v_mfma_f32_16x16x32_bf16 v[76:79], a[24:27], a[88:91], v[76:79]
ds_read_b64_tr_b16 a[84:85], v9 offset:24576
v_mfma_f32_16x16x32_bf16 v[140:143], a[24:27], a[96:99], v[140:143]
ds_read_b64_tr_b16 a[86:87], v9 offset:25600
v_mfma_f32_16x16x32_bf16 v[140:143], a[28:31], a[100:103], v[140:143]
s_xor_b32 m0, s84, 5120
ds_read_b64_tr_b16 a[88:89], v10 offset:16384
v_mfma_f32_16x16x32_bf16 v[124:127], a[20:23], a[100:103], v[124:127]
s_xor_b32 s64, s73, 16384
ds_read_b64_tr_b16 a[90:91], v10 offset:17408
v_mfma_f32_16x16x32_bf16 v[124:127], a[16:19], a[96:99], v[124:127]
buffer_load_dwordx4 v13, s[48:51], s64 offen lds
v_mfma_f32_16x16x32_bf16 v[108:111], a[8:11], a[96:99], v[108:111]
s_branch L_po5
L_pg5:
s_branch L_tr0
L_po5:
ds_read_b64_tr_b16 a[92:93], v10 offset:24576
v_mfma_f32_16x16x32_bf16 v[108:111], a[12:15], a[100:103], v[108:111]
ds_read_b64_tr_b16 a[94:95], v10 offset:25600
v_mfma_f32_16x16x32_bf16 v[92:95], a[4:7], a[100:103], v[92:95]
v_mfma_f32_16x16x32_bf16 v[92:95], a[0:3], a[96:99], v[92:95]
ds_read_b64_tr_b16 a[96:97], v11 offset:16384
v_mfma_f32_16x16x32_bf16 v[32:35], a[0:3], a[104:107], v[32:35]
s_xor_b32 m0, s84, 6144
ds_read_b64_tr_b16 a[98:99], v11 offset:17408
v_mfma_f32_16x16x32_bf16 v[32:35], a[4:7], a[108:111], v[32:35]
s_xor_b32 s64, s73, 131072
ds_read_b64_tr_b16 a[100:101], v11 offset:24576
v_mfma_f32_16x16x32_bf16 v[48:51], a[12:15], a[108:111], v[48:51]
buffer_load_dwordx4 v12, s[48:51], s64 offen lds
v_mfma_f32_16x16x32_bf16 v[48:51], a[8:11], a[104:107], v[48:51]
ds_read_b64_tr_b16 a[102:103], v11 offset:25600
v_mfma_f32_16x16x32_bf16 v[64:67], a[16:19], a[104:107], v[64:67]
v_mfma_f32_16x16x32_bf16 v[64:67], a[20:23], a[108:111], v[64:67]
v_mfma_f32_16x16x32_bf16 v[80:83], a[28:31], a[108:111], v[80:83]
v_mfma_f32_16x16x32_bf16 v[80:83], a[24:27], a[104:107], v[80:83]
s_xor_b32 m0, s84, 7168
v_mfma_f32_16x16x32_bf16 v[144:147], a[24:27], a[112:115], v[144:147]
s_xor_b32 s64, s73, 147456
v_mfma_f32_16x16x32_bf16 v[144:147], a[28:31], a[116:119], v[144:147]
buffer_load_dwordx4 v13, s[48:51], s64 offen lds
v_mfma_f32_16x16x32_bf16 v[128:131], a[20:23], a[116:119], v[128:131]
v_mfma_f32_16x16x32_bf16 v[128:131], a[16:19], a[112:115], v[128:131]
v_mfma_f32_16x16x32_bf16 v[112:115], a[8:11], a[112:115], v[112:115]
v_mfma_f32_16x16x32_bf16 v[112:115], a[12:15], a[116:119], v[112:115]
v_mfma_f32_16x16x32_bf16 v[96:99], a[4:7], a[116:119], v[96:99]
v_mfma_f32_16x16x32_bf16 v[96:99], a[0:3], a[112:115], v[96:99]
s_waitcnt lgkmcnt(0)
v_mfma_f32_16x16x32_bf16 v[36:39], a[0:3], a[72:75], v[36:39]
v_mfma_f32_16x16x32_bf16 v[36:39], a[4:7], a[76:79], v[36:39]
v_mfma_f32_16x16x32_bf16 v[52:55], a[12:15], a[76:79], v[52:55]
s_waitcnt lgkmcnt(0)
s_barrier
v_mfma_f32_16x16x32_bf16 v[52:55], a[8:11], a[72:75], v[52:55]
s_xor_b32 m0, s77, 65536
ds_read_b64_tr_b16 a[104:105], v4 offset:32768
v_mfma_f32_16x16x32_bf16 v[68:71], a[16:19], a[72:75], v[68:71]
s_xor_b32 s64, s71, 524288
ds_read_b64_tr_b16 a[106:107], v4 offset:33792
v_mfma_f32_16x16x32_bf16 v[68:71], a[20:23], a[76:79], v[68:71]
buffer_load_dwordx4 v14, s[56:59], s64 offen lds
v_mfma_f32_16x16x32_bf16 v[84:87], a[28:31], a[76:79], v[84:87]
ds_read_b64_tr_b16 a[108:109], v4 offset:40960
v_mfma_f32_16x16x32_bf16 v[84:87], a[24:27], a[72:75], v[84:87]
ds_read_b64_tr_b16 a[110:111], v4 offset:41984
v_mfma_f32_16x16x32_bf16 v[148:151], a[24:27], a[80:83], v[148:151]
ds_read_b64_tr_b16 a[112:113], v5 offset:32768
v_mfma_f32_16x16x32_bf16 v[148:151], a[28:31], a[84:87], v[148:151]
ds_read_b64_tr_b16 a[114:115], v5 offset:33792
v_mfma_f32_16x16x32_bf16 v[132:135], a[20:23], a[84:87], v[132:135]
ds_read_b64_tr_b16 a[116:117], v5 offset:40960
v_mfma_f32_16x16x32_bf16 v[132:135], a[16:19], a[80:83], v[132:135]
ds_read_b64_tr_b16 a[118:119], v5 offset:41984
v_mfma_f32_16x16x32_bf16 v[116:119], a[8:11], a[80:83], v[116:119]
s_add_u32 m0, s78, 81920
ds_read_b64_tr_b16 a[72:73], v6 offset:32768
v_mfma_f32_16x16x32_bf16 v[116:119], a[12:15], a[84:87], v[116:119]
s_add_u32 s64, s75, 393216
ds_read_b64_tr_b16 a[74:75], v6 offset:33792
v_mfma_f32_16x16x32_bf16 v[100:103], a[4:7], a[84:87], v[100:103]
buffer_load_dwordx4 v23, s[60:63], s64 offen lds
v_mfma_f32_16x16x32_bf16 v[100:103], a[0:3], a[80:83], v[100:103]
ds_read_b64_tr_b16 a[76:77], v6 offset:40960
v_mfma_f32_16x16x32_bf16 v[248:251], a[0:3], a[88:91], v[248:251]
ds_read_b64_tr_b16 a[78:79], v6 offset:41984
v_mfma_f32_16x16x32_bf16 v[248:251], a[4:7], a[92:95], v[248:251]
ds_read_b64_tr_b16 a[80:81], v7 offset:32768
v_mfma_f32_16x16x32_bf16 v[252:255], a[12:15], a[92:95], v[252:255]
ds_read_b64_tr_b16 a[82:83], v7 offset:33792
v_mfma_f32_16x16x32_bf16 v[252:255], a[8:11], a[88:91], v[252:255]
ds_read_b64_tr_b16 a[84:85], v7 offset:40960
v_mfma_f32_16x16x32_bf16 a[120:123], a[16:19], a[88:91], a[120:123]
ds_read_b64_tr_b16 a[86:87], v7 offset:41984
v_mfma_f32_16x16x32_bf16 a[120:123], a[20:23], a[92:95], a[120:123]
s_xor_b32 m0, s77, 66560
v_mfma_f32_16x16x32_bf16 a[124:127], a[28:31], a[92:95], a[124:127]
s_xor_b32 s64, s71, 557056
v_mfma_f32_16x16x32_bf16 a[124:127], a[24:27], a[88:91], a[124:127]
buffer_load_dwordx4 v14, s[56:59], s64 offen lds
v_mfma_f32_16x16x32_bf16 a[128:131], a[24:27], a[96:99], a[128:131]
ds_read_b64_tr_b16 a[88:89], v8 offset:32768
v_mfma_f32_16x16x32_bf16 a[128:131], a[28:31], a[100:103], a[128:131]
ds_read_b64_tr_b16 a[90:91], v8 offset:33792
v_mfma_f32_16x16x32_bf16 a[132:135], a[20:23], a[100:103], a[132:135]
ds_read_b64_tr_b16 a[92:93], v8 offset:40960
v_mfma_f32_16x16x32_bf16 a[132:135], a[16:19], a[96:99], a[132:135]
ds_read_b64_tr_b16 a[94:95], v8 offset:41984
v_mfma_f32_16x16x32_bf16 a[136:139], a[8:11], a[96:99], a[136:139]
v_mfma_f32_16x16x32_bf16 a[136:139], a[12:15], a[100:103], a[136:139]
v_mfma_f32_16x16x32_bf16 a[140:143], a[4:7], a[100:103], a[140:143]
s_add_u32 m0, s78, 86016
v_mfma_f32_16x16x32_bf16 a[140:143], a[0:3], a[96:99], a[140:143]
s_waitcnt lgkmcnt(4)
s_add_u32 s64, s75, 395264
ds_read_b64_tr_b16 a[96:97], v9 offset:32768
v_mfma_f32_16x16x32_bf16 v[184:187], a[104:107], a[32:35], v[184:187]
s_lshl_b32 s66, s30, 30
buffer_load_dwordx4 v23, s[60:63], s64 offen lds
v_mfma_f32_16x16x32_bf16 v[184:187], a[108:111], a[36:39], v[184:187]
ds_read_b64_tr_b16 a[98:99], v9 offset:33792
v_lshl_add_u32 v1, v0, 24, s66
v_mfma_f32_16x16x32_bf16 v[192:195], a[108:111], a[44:47], v[192:195]
s_lshr_b32 s66, s3, 1
ds_read_b64_tr_b16 a[100:101], v9 offset:40960
v_mfma_f32_16x16x32_bf16 v[192:195], a[104:107], a[40:43], v[192:195]
s_lshl_b32 s66, s66, 12
ds_read_b64_tr_b16 a[102:103], v9 offset:41984
v_mfma_f32_16x16x32_bf16 v[200:203], a[104:107], a[48:51], v[200:203]
v_mfma_f32_16x16x32_bf16 v[200:203], a[108:111], a[52:55], v[200:203]
v_mfma_f32_16x16x32_bf16 v[208:211], a[108:111], a[60:63], v[208:211]
v_mfma_f32_16x16x32_bf16 v[208:211], a[104:107], a[56:59], v[208:211]
ds_read_b64_tr_b16 a[104:105], v10 offset:32768
v_mfma_f32_16x16x32_bf16 v[212:215], a[112:115], a[56:59], v[212:215]
s_xor_b32 m0, s77, 67584
ds_read_b64_tr_b16 a[106:107], v10 offset:33792
v_mfma_f32_16x16x32_bf16 v[212:215], a[116:119], a[60:63], v[212:215]
s_xor_b32 s64, s71, 589824
ds_read_b64_tr_b16 a[108:109], v10 offset:40960
v_mfma_f32_16x16x32_bf16 v[204:207], a[116:119], a[52:55], v[204:207]
buffer_load_dwordx4 v15, s[56:59], s64 offen lds
v_mfma_f32_16x16x32_bf16 v[204:207], a[112:115], a[48:51], v[204:207]
ds_read_b64_tr_b16 a[110:111], v10 offset:41984
v_mfma_f32_16x16x32_bf16 v[196:199], a[112:115], a[40:43], v[196:199]
v_mfma_f32_16x16x32_bf16 v[196:199], a[116:119], a[44:47], v[196:199]
v_mfma_f32_16x16x32_bf16 v[188:191], a[116:119], a[36:39], v[188:191]
v_mfma_f32_16x16x32_bf16 v[188:191], a[112:115], a[32:35], v[188:191]
s_add_u32 s67, s79, 20480
ds_read_b64_tr_b16 a[112:113], v11 offset:32768
v_mfma_f32_16x16x32_bf16 v[216:219], a[72:75], a[32:35], v[216:219]
ds_read_b64_tr_b16 a[114:115], v11 offset:33792
v_mfma_f32_16x16x32_bf16 v[216:219], a[76:79], a[36:39], v[216:219]
s_add_u32 m0, s78, 90112
ds_read_b64_tr_b16 a[116:117], v11 offset:40960
v_cvt_pk_bf16_f32 v215, v214, v215
v_mfma_f32_16x16x32_bf16 v[224:227], a[76:79], a[44:47], v[224:227]
s_add_u32 s64, s75, 397312
ds_read_b64_tr_b16 a[118:119], v11 offset:41984
v_cvt_pk_bf16_f32 v214, v212, v213
v_mfma_f32_16x16x32_bf16 v[224:227], a[72:75], a[40:43], v[224:227]
buffer_load_dwordx4 v23, s[60:63], s64 offen lds
v_mfma_f32_16x16x32_bf16 v[232:235], a[72:75], a[48:51], v[232:235]
v_cvt_pk_bf16_f32 v212, v208, v209
v_cvt_pk_bf16_f32 v213, v210, v211
v_mfma_f32_16x16x32_bf16 v[232:235], a[76:79], a[52:55], v[232:235]
buffer_store_dwordx4 v[212:215], v16, s[44:47], s67 offen sc1
v_mfma_f32_16x16x32_bf16 v[240:243], a[76:79], a[60:63], v[240:243]
v_cvt_pk_bf16_f32 v207, v206, v207
v_cvt_pk_bf16_f32 v206, v204, v205
v_mfma_f32_16x16x32_bf16 v[240:243], a[72:75], a[56:59], v[240:243]
ds_read_b64_tr_b16 a[72:73], v4 offset:49152
v_cvt_pk_bf16_f32 v204, v200, v201
v_mfma_f32_16x16x32_bf16 v[244:247], a[80:83], a[56:59], v[244:247]
ds_read_b64_tr_b16 a[74:75], v4 offset:50176
v_cvt_pk_bf16_f32 v205, v202, v203
v_mfma_f32_16x16x32_bf16 v[244:247], a[84:87], a[60:63], v[244:247]
ds_read_b64_tr_b16 a[76:77], v4 offset:57344
v_accvgpr_write_b32 a144, v204
v_mfma_f32_16x16x32_bf16 v[236:239], a[84:87], a[52:55], v[236:239]
s_xor_b32 m0, s77, 68608
ds_read_b64_tr_b16 a[78:79], v4 offset:58368
v_accvgpr_write_b32 a145, v205
v_mfma_f32_16x16x32_bf16 v[236:239], a[80:83], a[48:51], v[236:239]
s_xor_b32 s64, s71, 622592
v_accvgpr_write_b32 a146, v206
v_accvgpr_write_b32 a147, v207
v_mfma_f32_16x16x32_bf16 v[228:231], a[80:83], a[40:43], v[228:231]
buffer_load_dwordx4 v15, s[56:59], s64 offen lds
v_mfma_f32_16x16x32_bf16 v[228:231], a[84:87], a[44:47], v[228:231]
v_cvt_pk_bf16_f32 v199, v198, v199
v_cvt_pk_bf16_f32 v198, v196, v197
v_mfma_f32_16x16x32_bf16 v[220:223], a[84:87], a[36:39], v[220:223]
v_cvt_pk_bf16_f32 v196, v192, v193
v_cvt_pk_bf16_f32 v197, v194, v195
v_mfma_f32_16x16x32_bf16 v[220:223], a[80:83], a[32:35], v[220:223]
s_waitcnt lgkmcnt(4)
ds_read_b64_tr_b16 a[80:81], v5 offset:49152
v_accvgpr_write_b32 a148, v196
v_mfma_f32_16x16x32_bf16 v[152:155], a[88:91], a[32:35], v[152:155]
ds_read_b64_tr_b16 a[82:83], v5 offset:50176
v_accvgpr_write_b32 a149, v197
v_mfma_f32_16x16x32_bf16 v[152:155], a[92:95], a[36:39], v[152:155]
ds_read_b64_tr_b16 a[84:85], v5 offset:57344
v_accvgpr_write_b32 a150, v198
v_mfma_f32_16x16x32_bf16 v[160:163], a[92:95], a[44:47], v[160:163]
ds_read_b64_tr_b16 a[86:87], v5 offset:58368
v_accvgpr_write_b32 a151, v199
v_mfma_f32_16x16x32_bf16 v[160:163], a[88:91], a[40:43], v[160:163]
v_cvt_pk_bf16_f32 v191, v190, v191
v_cvt_pk_bf16_f32 v190, v188, v189
v_mfma_f32_16x16x32_bf16 v[168:171], a[88:91], a[48:51], v[168:171]
v_cvt_pk_bf16_f32 v188, v184, v185
v_cvt_pk_bf16_f32 v189, v186, v187
v_mfma_f32_16x16x32_bf16 v[168:171], a[92:95], a[52:55], v[168:171]
v_accvgpr_write_b32 a152, v188
v_accvgpr_write_b32 a153, v189
v_mfma_f32_16x16x32_bf16 v[176:179], a[92:95], a[60:63], v[176:179]
s_xor_b32 m0, s84, 32768
v_accvgpr_write_b32 a154, v190
v_accvgpr_write_b32 a155, v191
v_mfma_f32_16x16x32_bf16 v[176:179], a[88:91], a[56:59], v[176:179]
s_add_u32 s67, s79, 21504
s_xor_b32 s64, s72, 128
ds_read_b64_tr_b16 a[88:89], v6 offset:49152
v_cvt_pk_bf16_f32 v247, v246, v247
v_mfma_f32_16x16x32_bf16 v[180:183], a[96:99], a[56:59], v[180:183]
buffer_load_dwordx4 v12, s[48:51], s64 offen lds
v_mfma_f32_16x16x32_bf16 v[180:183], a[100:103], a[60:63], v[180:183]
ds_read_b64_tr_b16 a[90:91], v6 offset:50176
v_cvt_pk_bf16_f32 v246, v244, v245
v_mfma_f32_16x16x32_bf16 v[172:175], a[100:103], a[52:55], v[172:175]
ds_read_b64_tr_b16 a[92:93], v6 offset:57344
v_cvt_pk_bf16_f32 v244, v240, v241
v_mfma_f32_16x16x32_bf16 v[172:175], a[96:99], a[48:51], v[172:175]
ds_read_b64_tr_b16 a[94:95], v6 offset:58368
v_cvt_pk_bf16_f32 v245, v242, v243
v_mfma_f32_16x16x32_bf16 v[164:167], a[96:99], a[40:43], v[164:167]
buffer_store_dwordx4 v[244:247], v16, s[44:47], s67 offen sc1
v_mfma_f32_16x16x32_bf16 v[164:167], a[100:103], a[44:47], v[164:167]
s_xor_b32 m0, s84, 33792
v_cvt_pk_bf16_f32 v239, v238, v239
v_cvt_pk_bf16_f32 v238, v236, v237
v_mfma_f32_16x16x32_bf16 v[156:159], a[100:103], a[36:39], v[156:159]
s_xor_b32 s64, s72, 16512
v_cvt_pk_bf16_f32 v236, v232, v233
v_cvt_pk_bf16_f32 v237, v234, v235
v_mfma_f32_16x16x32_bf16 v[156:159], a[96:99], a[32:35], v[156:159]
buffer_load_dwordx4 v13, s[48:51], s64 offen lds
v_mfma_f32_16x16x32_bf16 v[24:27], a[104:107], a[32:35], v[24:27]
ds_read_b64_tr_b16 a[96:97], v7 offset:49152
v_accvgpr_write_b32 a156, v236
v_mfma_f32_16x16x32_bf16 v[24:27], a[108:111], a[36:39], v[24:27]
ds_read_b64_tr_b16 a[98:99], v7 offset:50176
v_accvgpr_write_b32 a157, v237
v_mfma_f32_16x16x32_bf16 v[40:43], a[108:111], a[44:47], v[40:43]
ds_read_b64_tr_b16 a[100:101], v7 offset:57344
v_accvgpr_write_b32 a158, v238
v_mfma_f32_16x16x32_bf16 v[40:43], a[104:107], a[40:43], v[40:43]
ds_read_b64_tr_b16 a[102:103], v7 offset:58368
v_accvgpr_write_b32 a159, v239
v_mfma_f32_16x16x32_bf16 v[56:59], a[104:107], a[48:51], v[56:59]
s_xor_b32 m0, s84, 34816
v_cvt_pk_bf16_f32 v231, v230, v231
v_cvt_pk_bf16_f32 v230, v228, v229
v_mfma_f32_16x16x32_bf16 v[56:59], a[108:111], a[52:55], v[56:59]
s_xor_b32 s64, s72, 131200
v_cvt_pk_bf16_f32 v228, v224, v225
v_cvt_pk_bf16_f32 v229, v226, v227
v_mfma_f32_16x16x32_bf16 v[72:75], a[108:111], a[60:63], v[72:75]
s_waitcnt vmcnt(11)
buffer_load_dwordx4 v12, s[48:51], s64 offen lds
v_mfma_f32_16x16x32_bf16 v[72:75], a[104:107], a[56:59], v[72:75]
ds_read_b64_tr_b16 a[104:105], v8 offset:49152
v_accvgpr_write_b32 a160, v228
v_mfma_f32_16x16x32_bf16 v[136:139], a[112:115], a[56:59], v[136:139]
ds_read_b64_tr_b16 a[106:107], v8 offset:50176
v_accvgpr_write_b32 a161, v229
v_mfma_f32_16x16x32_bf16 v[136:139], a[116:119], a[60:63], v[136:139]
ds_read_b64_tr_b16 a[108:109], v8 offset:57344
v_add_u32 v4, 0x8000, v4
v_mfma_f32_16x16x32_bf16 v[120:123], a[116:119], a[52:55], v[120:123]
ds_read_b64_tr_b16 a[110:111], v8 offset:58368
v_accvgpr_write_b32 a162, v230
v_mfma_f32_16x16x32_bf16 v[120:123], a[112:115], a[48:51], v[120:123]
s_xor_b32 m0, s84, 35840
ds_read_b128 a[0:3], v2 offset:0
v_accvgpr_write_b32 a163, v231
v_mfma_f32_16x16x32_bf16 v[104:107], a[112:115], a[40:43], v[104:107]
s_xor_b32 s64, s72, 147584
ds_read_b128 a[4:7], v3 offset:0
v_cvt_pk_bf16_f32 v223, v222, v223
v_mfma_f32_16x16x32_bf16 v[104:107], a[116:119], a[44:47], v[104:107]
buffer_load_dwordx4 v13, s[48:51], s64 offen lds
v_mfma_f32_16x16x32_bf16 v[88:91], a[116:119], a[36:39], v[88:91]
ds_read_b128 a[8:11], v2 offset:2048
v_cvt_pk_bf16_f32 v222, v220, v221
v_mfma_f32_16x16x32_bf16 v[88:91], a[112:115], a[32:35], v[88:91]
s_waitcnt lgkmcnt(7)
ds_read_b128 a[12:15], v3 offset:2048
v_cvt_pk_bf16_f32 v220, v216, v217
v_mfma_f32_16x16x32_bf16 v[28:31], a[32:35], a[72:75], v[28:31]
ds_read_b128 a[16:19], v2 offset:4096
v_cvt_pk_bf16_f32 v221, v218, v219
v_mfma_f32_16x16x32_bf16 v[28:31], a[36:39], a[76:79], v[28:31]
ds_read_b128 a[20:23], v3 offset:4096
v_add_u32 v5, 0x8000, v5
v_mfma_f32_16x16x32_bf16 v[44:47], a[44:47], a[76:79], v[44:47]
s_xor_b32 m0, s84, 36864
ds_read_b128 a[24:27], v2 offset:6144
v_accvgpr_write_b32 a164, v220
v_mfma_f32_16x16x32_bf16 v[44:47], a[40:43], a[72:75], v[44:47]
s_xor_b32 s64, s73, 128
ds_read_b128 a[28:31], v3 offset:6144
v_accvgpr_write_b32 a165, v221
v_mfma_f32_16x16x32_bf16 v[60:63], a[48:51], a[72:75], v[60:63]
buffer_load_dwordx4 v12, s[48:51], s64 offen lds
v_mfma_f32_16x16x32_bf16 v[60:63], a[52:55], a[76:79], v[60:63]
ds_read_b64_tr_b16 a[112:113], v9 offset:49152
v_accvgpr_write_b32 a166, v222
v_mfma_f32_16x16x32_bf16 v[76:79], a[60:63], a[76:79], v[76:79]
ds_read_b64_tr_b16 a[114:115], v9 offset:50176
v_accvgpr_write_b32 a167, v223
v_mfma_f32_16x16x32_bf16 v[76:79], a[56:59], a[72:75], v[76:79]
s_add_u32 s67, s79, 22528
ds_read_b64_tr_b16 a[116:117], v9 offset:57344
v_cvt_pk_bf16_f32 v183, v182, v183
v_mfma_f32_16x16x32_bf16 v[140:143], a[56:59], a[80:83], v[140:143]
ds_read_b64_tr_b16 a[118:119], v9 offset:58368
v_cvt_pk_bf16_f32 v182, v180, v181
v_mfma_f32_16x16x32_bf16 v[140:143], a[60:63], a[84:87], v[140:143]
s_xor_b32 m0, s84, 37888
ds_read_b64_tr_b16 a[72:73], v10 offset:49152
v_add_u32 v6, 0x8000, v6
v_mfma_f32_16x16x32_bf16 v[124:127], a[52:55], a[84:87], v[124:127]
s_xor_b32 s64, s73, 16512
ds_read_b64_tr_b16 a[74:75], v10 offset:50176
v_cvt_pk_bf16_f32 v180, v176, v177
v_mfma_f32_16x16x32_bf16 v[124:127], a[48:51], a[80:83], v[124:127]
buffer_load_dwordx4 v13, s[48:51], s64 offen lds
v_mfma_f32_16x16x32_bf16 v[108:111], a[40:43], a[80:83], v[108:111]
ds_read_b64_tr_b16 a[76:77], v10 offset:57344
v_cvt_pk_bf16_f32 v181, v178, v179
v_mfma_f32_16x16x32_bf16 v[108:111], a[44:47], a[84:87], v[108:111]
ds_read_b64_tr_b16 a[78:79], v10 offset:58368
v_mfma_f32_16x16x32_bf16 v[92:95], a[36:39], a[84:87], v[92:95]
buffer_store_dwordx4 v[180:183], v16, s[44:47], s67 offen sc1
v_mfma_f32_16x16x32_bf16 v[92:95], a[32:35], a[80:83], v[92:95]
ds_read_b64_tr_b16 a[80:81], v11 offset:49152
v_cvt_pk_bf16_f32 v175, v174, v175
v_mfma_f32_16x16x32_bf16 v[32:35], a[32:35], a[88:91], v[32:35]
s_xor_b32 m0, s84, 38912
ds_read_b64_tr_b16 a[82:83], v11 offset:50176
v_cvt_pk_bf16_f32 v174, v172, v173
v_mfma_f32_16x16x32_bf16 v[32:35], a[36:39], a[92:95], v[32:35]
s_xor_b32 s64, s73, 131200
ds_read_b64_tr_b16 a[84:85], v11 offset:57344
v_add_u32 v7, 0x8000, v7
v_mfma_f32_16x16x32_bf16 v[48:51], a[44:47], a[92:95], v[48:51]
buffer_load_dwordx4 v12, s[48:51], s64 offen lds
v_mfma_f32_16x16x32_bf16 v[48:51], a[40:43], a[88:91], v[48:51]
ds_read_b64_tr_b16 a[86:87], v11 offset:58368
v_cvt_pk_bf16_f32 v172, v168, v169
v_mfma_f32_16x16x32_bf16 v[64:67], a[48:51], a[88:91], v[64:67]
v_cvt_pk_bf16_f32 v173, v170, v171
v_accvgpr_write_b32 a168, v172
v_mfma_f32_16x16x32_bf16 v[64:67], a[52:55], a[92:95], v[64:67]
v_accvgpr_write_b32 a169, v173
v_accvgpr_write_b32 a170, v174
v_mfma_f32_16x16x32_bf16 v[80:83], a[60:63], a[92:95], v[80:83]
v_accvgpr_write_b32 a171, v175
v_cvt_pk_bf16_f32 v167, v166, v167
v_mfma_f32_16x16x32_bf16 v[80:83], a[56:59], a[88:91], v[80:83]
s_xor_b32 m0, s84, 39936
v_cvt_pk_bf16_f32 v166, v164, v165
v_cvt_pk_bf16_f32 v164, v160, v161
v_mfma_f32_16x16x32_bf16 v[144:147], a[56:59], a[96:99], v[144:147]
s_xor_b32 s64, s73, 147584
v_cvt_pk_bf16_f32 v165, v162, v163
v_accvgpr_write_b32 a172, v164
v_mfma_f32_16x16x32_bf16 v[144:147], a[60:63], a[100:103], v[144:147]
buffer_load_dwordx4 v13, s[48:51], s64 offen lds
v_mfma_f32_16x16x32_bf16 v[128:131], a[52:55], a[100:103], v[128:131]
v_add_u32 v8, 0x8000, v8
v_accvgpr_write_b32 a173, v165
v_mfma_f32_16x16x32_bf16 v[128:131], a[48:51], a[96:99], v[128:131]
v_accvgpr_write_b32 a174, v166
v_accvgpr_write_b32 a175, v167
v_mfma_f32_16x16x32_bf16 v[112:115], a[40:43], a[96:99], v[112:115]
v_cvt_pk_bf16_f32 v159, v158, v159
v_cvt_pk_bf16_f32 v158, v156, v157
v_mfma_f32_16x16x32_bf16 v[112:115], a[44:47], a[100:103], v[112:115]
v_cvt_pk_bf16_f32 v156, v152, v153
v_cvt_pk_bf16_f32 v157, v154, v155
v_mfma_f32_16x16x32_bf16 v[96:99], a[36:39], a[100:103], v[96:99]
v_add_u32 v9, 0x8000, v9
v_add_u32 v10, 0x8000, v10
v_mfma_f32_16x16x32_bf16 v[96:99], a[32:35], a[96:99], v[96:99]
s_waitcnt lgkmcnt(0)
v_add_u32 v11, 0x8000, v11
v_accvgpr_write_b32 a176, v156
v_mfma_f32_16x16x32_bf16 v[36:39], a[32:35], a[104:107], v[36:39]
v_accvgpr_write_b32 a177, v157
v_accvgpr_write_b32 a178, v158
v_mfma_f32_16x16x32_bf16 v[36:39], a[36:39], a[108:111], v[36:39]
v_accvgpr_write_b32 a179, v159
v_mfma_f32_16x16x32_bf16 v[52:55], a[44:47], a[108:111], v[52:55]
s_add_u32 s67, s79, 23552
s_waitcnt lgkmcnt(0)
s_barrier
v_mfma_f32_16x16x32_bf16 v[52:55], a[40:43], a[104:107], v[52:55]
s_xor_b32 m0, s77, 98304
ds_read_b64_tr_b16 a[88:89], v19 offset:36864
v_cvt_pk_bf16_f32 v139, v138, v139
v_mfma_f32_16x16x32_bf16 v[68:71], a[48:51], a[104:107], v[68:71]
s_xor_b32 s64, s71, 1048576
ds_read_b64_tr_b16 a[90:91], v19 offset:37120
v_cvt_pk_bf16_f32 v138, v136, v137
v_mfma_f32_16x16x32_bf16 v[68:71], a[52:55], a[108:111], v[68:71]
buffer_load_dwordx4 v14, s[56:59], s64 offen lds
v_mfma_f32_16x16x32_bf16 v[84:87], a[60:63], a[108:111], v[84:87]
ds_read_b64_tr_b16 a[92:93], v19 offset:38912
v_cvt_pk_bf16_f32 v136, v72, v73
v_mfma_f32_16x16x32_bf16 v[84:87], a[56:59], a[104:107], v[84:87]
ds_read_b64_tr_b16 a[94:95], v19 offset:39168
v_cvt_pk_bf16_f32 v137, v74, v75
v_mfma_f32_16x16x32_bf16 v[148:151], a[56:59], a[112:115], v[148:151]
ds_read_b64_tr_b16 a[96:97], v20 offset:36864
v_mfma_f32_16x16x32_bf16 v[148:151], a[60:63], a[116:119], v[148:151]
ds_read_b64_tr_b16 a[98:99], v20 offset:37120
v_mfma_f32_16x16x32_bf16 v[132:135], a[52:55], a[116:119], v[132:135]
ds_read_b64_tr_b16 a[100:101], v20 offset:38912
v_mfma_f32_16x16x32_bf16 v[132:135], a[48:51], a[112:115], v[132:135]
ds_read_b64_tr_b16 a[102:103], v20 offset:39168
v_mfma_f32_16x16x32_bf16 v[116:119], a[40:43], a[112:115], v[116:119]
s_add_u32 m0, s78, 114688
ds_read_b64_tr_b16 a[104:105], v19 offset:40960
v_mfma_f32_16x16x32_bf16 v[116:119], a[44:47], a[116:119], v[116:119]
s_add_u32 s64, s75, 786432
ds_read_b64_tr_b16 a[106:107], v19 offset:41216
v_mfma_f32_16x16x32_bf16 v[100:103], a[36:39], a[116:119], v[100:103]
buffer_load_dwordx4 v23, s[60:63], s64 offen lds
v_mfma_f32_16x16x32_bf16 v[100:103], a[32:35], a[112:115], v[100:103]
ds_read_b64_tr_b16 a[108:109], v19 offset:43008
v_mfma_f32_16x16x32_bf16 v[248:251], a[32:35], a[72:75], v[248:251]
ds_read_b64_tr_b16 a[110:111], v19 offset:43264
v_mfma_f32_16x16x32_bf16 v[248:251], a[36:39], a[76:79], v[248:251]
ds_read_b64_tr_b16 a[112:113], v20 offset:40960
v_mfma_f32_16x16x32_bf16 v[252:255], a[44:47], a[76:79], v[252:255]
ds_read_b64_tr_b16 a[114:115], v20 offset:41216
v_mfma_f32_16x16x32_bf16 v[252:255], a[40:43], a[72:75], v[252:255]
ds_read_b64_tr_b16 a[116:117], v20 offset:43008
v_mfma_f32_16x16x32_bf16 a[120:123], a[48:51], a[72:75], a[120:123]
ds_read_b64_tr_b16 a[118:119], v20 offset:43264
v_mfma_f32_16x16x32_bf16 a[120:123], a[52:55], a[76:79], a[120:123]
s_xor_b32 m0, s77, 99328
buffer_store_dwordx4 v[136:139], v16, s[44:47], s67 offen sc1
v_mfma_f32_16x16x32_bf16 a[124:127], a[60:63], a[76:79], a[124:127]
s_xor_b32 s64, s71, 1081344
v_cvt_pk_bf16_f32 v123, v122, v123
v_cvt_pk_bf16_f32 v122, v120, v121
v_mfma_f32_16x16x32_bf16 a[124:127], a[56:59], a[72:75], a[124:127]
buffer_load_dwordx4 v14, s[56:59], s64 offen lds
v_mfma_f32_16x16x32_bf16 a[128:131], a[56:59], a[80:83], a[128:131]
ds_read_b64_tr_b16 a[72:73], v19 offset:32768
v_cvt_pk_bf16_f32 v120, v56, v57
v_mfma_f32_16x16x32_bf16 a[128:131], a[60:63], a[84:87], a[128:131]
ds_read_b64_tr_b16 a[74:75], v19 offset:33024
v_cvt_pk_bf16_f32 v121, v58, v59
v_mfma_f32_16x16x32_bf16 a[132:135], a[52:55], a[84:87], a[132:135]
ds_read_b64_tr_b16 a[76:77], v19 offset:34816
v_accvgpr_write_b32 a180, v120
v_mfma_f32_16x16x32_bf16 a[132:135], a[48:51], a[80:83], a[132:135]
ds_read_b64_tr_b16 a[78:79], v19 offset:35072
v_accvgpr_write_b32 a181, v121
v_mfma_f32_16x16x32_bf16 a[136:139], a[40:43], a[80:83], a[136:139]
v_accvgpr_write_b32 a182, v122
v_accvgpr_write_b32 a183, v123
v_mfma_f32_16x16x32_bf16 a[136:139], a[44:47], a[84:87], a[136:139]
v_cvt_pk_bf16_f32 v107, v106, v107
v_cvt_pk_bf16_f32 v106, v104, v105
v_mfma_f32_16x16x32_bf16 a[140:143], a[36:39], a[84:87], a[140:143]
s_add_u32 m0, s78, 118784
v_cvt_pk_bf16_f32 v104, v40, v41
v_cvt_pk_bf16_f32 v105, v42, v43
v_mfma_f32_16x16x32_bf16 a[140:143], a[32:35], a[80:83], a[140:143]
s_waitcnt lgkmcnt(4)
s_add_u32 s64, s75, 788480
ds_read_b64_tr_b16 a[80:81], v20 offset:32768
v_accvgpr_write_b32 a184, v104
v_mfma_f32_16x16x32_bf16 v[184:187], a[88:91], a[0:3], 0
buffer_load_dwordx4 v23, s[60:63], s64 offen lds
v_mfma_f32_16x16x32_bf16 v[184:187], a[92:95], a[4:7], v[184:187]
ds_read_b64_tr_b16 a[82:83], v20 offset:33024
v_accvgpr_write_b32 a185, v105
v_mfma_f32_16x16x32_bf16 v[192:195], a[92:95], a[12:15], 0
ds_read_b64_tr_b16 a[84:85], v20 offset:34816
v_accvgpr_write_b32 a186, v106
v_mfma_f32_16x16x32_bf16 v[192:195], a[88:91], a[8:11], v[192:195]
ds_read_b64_tr_b16 a[86:87], v20 offset:35072
v_accvgpr_write_b32 a187, v107
v_mfma_f32_16x16x32_bf16 v[200:203], a[88:91], a[16:19], 0
v_cvt_pk_bf16_f32 v91, v90, v91
v_cvt_pk_bf16_f32 v90, v88, v89
v_mfma_f32_16x16x32_bf16 v[200:203], a[92:95], a[20:23], v[200:203]
v_cvt_pk_bf16_f32 v88, v24, v25
v_cvt_pk_bf16_f32 v89, v26, v27
v_mfma_f32_16x16x32_bf16 v[208:211], a[92:95], a[28:31], 0
v_accvgpr_write_b32 a188, v88
v_accvgpr_write_b32 a189, v89
v_mfma_f32_16x16x32_bf16 v[208:211], a[88:91], a[24:27], v[208:211]
s_xor_b32 m0, s77, 100352
ds_read_b64_tr_b16 a[88:89], v4 offset:32768
v_accvgpr_write_b32 a190, v90
v_mfma_f32_16x16x32_bf16 v[212:215], a[96:99], a[24:27], 0
s_xor_b32 s64, s71, 1114112
ds_read_b64_tr_b16 a[90:91], v4 offset:33792
v_accvgpr_write_b32 a191, v91
v_mfma_f32_16x16x32_bf16 v[212:215], a[100:103], a[28:31], v[212:215]
s_add_u32 s67, s79, 8192
ds_read_b64_tr_b16 a[92:93], v4 offset:40960
v_cvt_pk_bf16_f32 v47, v46, v47
v_mfma_f32_16x16x32_bf16 v[204:207], a[100:103], a[20:23], 0
buffer_load_dwordx4 v15, s[56:59], s64 offen lds
v_mfma_f32_16x16x32_bf16 v[204:207], a[96:99], a[16:19], v[204:207]
ds_read_b64_tr_b16 a[94:95], v4 offset:41984
v_cvt_pk_bf16_f32 v46, v44, v45
v_mfma_f32_16x16x32_bf16 v[196:199], a[96:99], a[8:11], 0
v_cvt_pk_bf16_f32 v44, v28, v29
v_cvt_pk_bf16_f32 v45, v30, v31
v_mfma_f32_16x16x32_bf16 v[196:199], a[100:103], a[12:15], v[196:199]
buffer_store_dwordx4 v[44:47], v16, s[44:47], s67 offen sc1
v_mfma_f32_16x16x32_bf16 v[188:191], a[100:103], a[4:7], 0
v_cvt_pk_bf16_f32 v79, v78, v79
v_cvt_pk_bf16_f32 v78, v76, v77
v_mfma_f32_16x16x32_bf16 v[188:191], a[96:99], a[0:3], v[188:191]
s_branch L_po6
L_pg6:
s_branch L_pg10
L_po6:
ds_read_b64_tr_b16 a[96:97], v5 offset:32768
v_cvt_pk_bf16_f32 v76, v60, v61
v_mfma_f32_16x16x32_bf16 v[216:219], a[0:3], a[104:107], 0
ds_read_b64_tr_b16 a[98:99], v5 offset:33792
v_cvt_pk_bf16_f32 v77, v62, v63
v_mfma_f32_16x16x32_bf16 v[216:219], a[4:7], a[108:111], v[216:219]
s_add_u32 m0, s78, 122880
ds_read_b64_tr_b16 a[100:101], v5 offset:40960
v_accvgpr_write_b32 a192, v76
v_mfma_f32_16x16x32_bf16 v[224:227], a[12:15], a[108:111], 0
s_add_u32 s64, s75, 790528
ds_read_b64_tr_b16 a[102:103], v5 offset:41984
v_accvgpr_write_b32 a193, v77
v_mfma_f32_16x16x32_bf16 v[224:227], a[8:11], a[104:107], v[224:227]
buffer_load_dwordx4 v23, s[60:63], s64 offen lds
v_mfma_f32_16x16x32_bf16 v[232:235], a[16:19], a[104:107], 0
v_accvgpr_write_b32 a194, v78
v_accvgpr_write_b32 a195, v79
v_mfma_f32_16x16x32_bf16 v[232:235], a[20:23], a[108:111], v[232:235]
v_cvt_pk_bf16_f32 v124, v124, v125
v_cvt_pk_bf16_f32 v125, v126, v127
v_mfma_f32_16x16x32_bf16 v[240:243], a[28:31], a[108:111], 0
v_cvt_pk_bf16_f32 v126, v140, v141
v_cvt_pk_bf16_f32 v127, v142, v143
v_mfma_f32_16x16x32_bf16 v[240:243], a[24:27], a[104:107], v[240:243]
ds_read_b64_tr_b16 a[104:105], v6 offset:32768
v_accvgpr_write_b32 a196, v124
v_mfma_f32_16x16x32_bf16 v[244:247], a[24:27], a[112:115], 0
ds_read_b64_tr_b16 a[106:107], v6 offset:33792
v_accvgpr_write_b32 a197, v125
v_mfma_f32_16x16x32_bf16 v[244:247], a[28:31], a[116:119], v[244:247]
ds_read_b64_tr_b16 a[108:109], v6 offset:40960
v_accvgpr_write_b32 a198, v126
v_mfma_f32_16x16x32_bf16 v[236:239], a[20:23], a[116:119], 0
s_xor_b32 m0, s77, 101376
ds_read_b64_tr_b16 a[110:111], v6 offset:41984
v_accvgpr_write_b32 a199, v127
v_mfma_f32_16x16x32_bf16 v[236:239], a[16:19], a[112:115], v[236:239]
s_xor_b32 s64, s71, 1146880
v_cvt_pk_bf16_f32 v92, v92, v93
v_cvt_pk_bf16_f32 v93, v94, v95
v_mfma_f32_16x16x32_bf16 v[228:231], a[8:11], a[112:115], 0
buffer_load_dwordx4 v15, s[56:59], s64 offen lds
v_mfma_f32_16x16x32_bf16 v[228:231], a[12:15], a[116:119], v[228:231]
v_cvt_pk_bf16_f32 v94, v108, v109
v_cvt_pk_bf16_f32 v95, v110, v111
v_mfma_f32_16x16x32_bf16 v[220:223], a[4:7], a[116:119], 0
v_accvgpr_write_b32 a200, v92
v_accvgpr_write_b32 a201, v93
v_mfma_f32_16x16x32_bf16 v[220:223], a[0:3], a[112:115], v[220:223]
s_waitcnt lgkmcnt(4)
ds_read_b64_tr_b16 a[112:113], v7 offset:32768
v_accvgpr_write_b32 a202, v94
v_mfma_f32_16x16x32_bf16 v[152:155], a[72:75], a[0:3], 0
ds_read_b64_tr_b16 a[114:115], v7 offset:33792
v_accvgpr_write_b32 a203, v95
v_mfma_f32_16x16x32_bf16 v[152:155], a[76:79], a[4:7], v[152:155]
s_add_u32 s67, s79, 10240
ds_read_b64_tr_b16 a[116:117], v7 offset:40960
v_cvt_pk_bf16_f32 v51, v50, v51
v_mfma_f32_16x16x32_bf16 v[160:163], a[76:79], a[12:15], 0
ds_read_b64_tr_b16 a[118:119], v7 offset:41984
v_cvt_pk_bf16_f32 v50, v48, v49
v_mfma_f32_16x16x32_bf16 v[160:163], a[72:75], a[8:11], v[160:163]
v_cvt_pk_bf16_f32 v48, v32, v33
v_cvt_pk_bf16_f32 v49, v34, v35
v_mfma_f32_16x16x32_bf16 v[168:171], a[72:75], a[16:19], 0
buffer_store_dwordx4 v[48:51], v16, s[44:47], s67 offen sc1
v_mfma_f32_16x16x32_bf16 v[168:171], a[76:79], a[20:23], v[168:171]
v_subrev_u32 v19, 0x8000, v19
v_subrev_u32 v20, 0x8000, v20
v_mfma_f32_16x16x32_bf16 v[176:179], a[76:79], a[28:31], 0
s_xor_b32 m0, s84, 0
v_cvt_pk_bf16_f32 v83, v82, v83
v_cvt_pk_bf16_f32 v82, v80, v81
v_mfma_f32_16x16x32_bf16 v[176:179], a[72:75], a[24:27], v[176:179]
s_xor_b32 s64, s72, 256
ds_read_b64_tr_b16 a[72:73], v8 offset:32768
v_cvt_pk_bf16_f32 v80, v64, v65
v_mfma_f32_16x16x32_bf16 v[180:183], a[80:83], a[24:27], 0
buffer_load_dwordx4 v12, s[48:51], s64 offen lds
v_mfma_f32_16x16x32_bf16 v[180:183], a[84:87], a[28:31], v[180:183]
ds_read_b64_tr_b16 a[74:75], v8 offset:33792
v_subrev_u32 v4, 0x8000, v4
v_mfma_f32_16x16x32_bf16 v[172:175], a[84:87], a[20:23], 0
ds_read_b64_tr_b16 a[76:77], v8 offset:40960
v_cvt_pk_bf16_f32 v81, v66, v67
v_mfma_f32_16x16x32_bf16 v[172:175], a[80:83], a[16:19], v[172:175]
s_xor_b32 m0, s84, 1024
ds_read_b64_tr_b16 a[78:79], v8 offset:41984
v_accvgpr_write_b32 a204, v80
v_mfma_f32_16x16x32_bf16 v[164:167], a[80:83], a[8:11], 0
s_xor_b32 s64, s72, 16640
v_accvgpr_write_b32 a205, v81
v_accvgpr_write_b32 a206, v82
v_mfma_f32_16x16x32_bf16 v[164:167], a[84:87], a[12:15], v[164:167]
buffer_load_dwordx4 v13, s[48:51], s64 offen lds
v_mfma_f32_16x16x32_bf16 v[156:159], a[84:87], a[4:7], 0
v_accvgpr_write_b32 a207, v83
v_cvt_pk_bf16_f32 v128, v128, v129
v_mfma_f32_16x16x32_bf16 v[156:159], a[80:83], a[0:3], v[156:159]
ds_read_b64_tr_b16 a[80:81], v9 offset:32768
v_cvt_pk_bf16_f32 v129, v130, v131
v_mfma_f32_16x16x32_bf16 v[24:27], a[88:91], a[0:3], 0
s_xor_b32 m0, s84, 2048
ds_read_b64_tr_b16 a[82:83], v9 offset:33792
v_cvt_pk_bf16_f32 v130, v144, v145
v_mfma_f32_16x16x32_bf16 v[24:27], a[92:95], a[4:7], v[24:27]
s_xor_b32 s64, s72, 131328
ds_read_b64_tr_b16 a[84:85], v9 offset:40960
v_subrev_u32 v5, 0x8000, v5
v_mfma_f32_16x16x32_bf16 v[40:43], a[92:95], a[12:15], 0
buffer_load_dwordx4 v12, s[48:51], s64 offen lds
v_mfma_f32_16x16x32_bf16 v[40:43], a[88:91], a[8:11], v[40:43]
ds_read_b64_tr_b16 a[86:87], v9 offset:41984
v_cvt_pk_bf16_f32 v131, v146, v147
v_mfma_f32_16x16x32_bf16 v[56:59], a[88:91], a[16:19], 0
s_xor_b32 m0, s84, 3072
v_accvgpr_write_b32 a208, v128
v_accvgpr_write_b32 a209, v129
v_mfma_f32_16x16x32_bf16 v[56:59], a[92:95], a[20:23], v[56:59]
s_xor_b32 s64, s72, 147712
v_accvgpr_write_b32 a210, v130
v_accvgpr_write_b32 a211, v131
v_mfma_f32_16x16x32_bf16 v[72:75], a[92:95], a[28:31], 0
s_waitcnt vmcnt(13)
ds_read_b128 a[32:35], v2 offset:32768
v_cvt_pk_bf16_f32 v96, v96, v97
v_mfma_f32_16x16x32_bf16 v[72:75], a[88:91], a[24:27], v[72:75]
buffer_load_dwordx4 v13, s[48:51], s64 offen lds
v_mfma_f32_16x16x32_bf16 v[136:139], a[96:99], a[24:27], 0
ds_read_b128 a[36:39], v3 offset:32768
v_cvt_pk_bf16_f32 v97, v98, v99
v_mfma_f32_16x16x32_bf16 v[136:139], a[100:103], a[28:31], v[136:139]
ds_read_b128 a[40:43], v2 offset:34816
v_subrev_u32 v6, 0x8000, v6
v_mfma_f32_16x16x32_bf16 v[120:123], a[100:103], a[20:23], 0
s_xor_b32 m0, s84, 4096
ds_read_b128 a[44:47], v3 offset:34816
v_cvt_pk_bf16_f32 v98, v112, v113
v_mfma_f32_16x16x32_bf16 v[120:123], a[96:99], a[16:19], v[120:123]
s_xor_b32 s64, s73, 256
ds_read_b128 a[48:51], v2 offset:36864
v_cvt_pk_bf16_f32 v99, v114, v115
v_mfma_f32_16x16x32_bf16 v[104:107], a[96:99], a[8:11], 0
buffer_load_dwordx4 v12, s[48:51], s64 offen lds
v_mfma_f32_16x16x32_bf16 v[104:107], a[100:103], a[12:15], v[104:107]
ds_read_b128 a[52:55], v3 offset:36864
v_accvgpr_write_b32 a212, v96
v_mfma_f32_16x16x32_bf16 v[88:91], a[100:103], a[4:7], 0
ds_read_b128 a[56:59], v2 offset:38912
v_accvgpr_write_b32 a213, v97
v_mfma_f32_16x16x32_bf16 v[88:91], a[96:99], a[0:3], v[88:91]
s_waitcnt lgkmcnt(7)
s_xor_b32 m0, s84, 5120
ds_read_b128 a[60:63], v3 offset:38912
v_accvgpr_write_b32 a214, v98
v_mfma_f32_16x16x32_bf16 v[28:31], a[104:107], a[0:3], 0
s_xor_b32 s64, s73, 16640
ds_read_b64_tr_b16 a[88:89], v10 offset:32768
v_accvgpr_write_b32 a215, v99
v_mfma_f32_16x16x32_bf16 v[28:31], a[108:111], a[4:7], v[28:31]
s_add_u32 s67, s79, 12288
buffer_load_dwordx4 v13, s[48:51], s64 offen lds
v_mfma_f32_16x16x32_bf16 v[44:47], a[108:111], a[12:15], 0
ds_read_b64_tr_b16 a[90:91], v10 offset:33792
v_subrev_u32 v7, 0x8000, v7
v_mfma_f32_16x16x32_bf16 v[44:47], a[104:107], a[8:11], v[44:47]
ds_read_b64_tr_b16 a[92:93], v10 offset:40960
v_cvt_pk_bf16_f32 v55, v54, v55
v_mfma_f32_16x16x32_bf16 v[60:63], a[104:107], a[16:19], 0
s_xor_b32 m0, s84, 6144
ds_read_b64_tr_b16 a[94:95], v10 offset:41984
v_cvt_pk_bf16_f32 v54, v52, v53
v_mfma_f32_16x16x32_bf16 v[60:63], a[108:111], a[20:23], v[60:63]
s_xor_b32 s64, s73, 131328
ds_read_b64_tr_b16 a[96:97], v11 offset:32768
v_cvt_pk_bf16_f32 v52, v36, v37
v_mfma_f32_16x16x32_bf16 v[76:79], a[108:111], a[28:31], 0
buffer_load_dwordx4 v12, s[48:51], s64 offen lds
v_mfma_f32_16x16x32_bf16 v[76:79], a[104:107], a[24:27], v[76:79]
ds_read_b64_tr_b16 a[98:99], v11 offset:33792
v_cvt_pk_bf16_f32 v53, v38, v39
v_mfma_f32_16x16x32_bf16 v[140:143], a[112:115], a[24:27], 0
ds_read_b64_tr_b16 a[100:101], v11 offset:40960
v_mfma_f32_16x16x32_bf16 v[140:143], a[116:119], a[28:31], v[140:143]
s_xor_b32 m0, s84, 7168
ds_read_b64_tr_b16 a[102:103], v11 offset:41984
v_subrev_u32 v8, 0x8000, v8
v_mfma_f32_16x16x32_bf16 v[124:127], a[116:119], a[20:23], 0
s_xor_b32 s64, s73, 147712
buffer_store_dwordx4 v[52:55], v16, s[44:47], s67 offen sc1
v_mfma_f32_16x16x32_bf16 v[124:127], a[112:115], a[16:19], v[124:127]
buffer_load_dwordx4 v13, s[48:51], s64 offen lds
v_mfma_f32_16x16x32_bf16 v[108:111], a[112:115], a[8:11], 0
v_cvt_pk_bf16_f32 v87, v86, v87
v_cvt_pk_bf16_f32 v86, v84, v85
v_mfma_f32_16x16x32_bf16 v[108:111], a[116:119], a[12:15], v[108:111]
v_cvt_pk_bf16_f32 v84, v68, v69
v_cvt_pk_bf16_f32 v85, v70, v71
v_mfma_f32_16x16x32_bf16 v[92:95], a[116:119], a[4:7], 0
v_subrev_u32 v9, 0x8000, v9
v_subrev_u32 v10, 0x8000, v10
v_mfma_f32_16x16x32_bf16 v[92:95], a[112:115], a[0:3], v[92:95]
v_subrev_u32 v11, 0x8000, v11
v_accvgpr_write_b32 a216, v84
v_mfma_f32_16x16x32_bf16 v[32:35], a[72:75], a[0:3], 0
v_accvgpr_write_b32 a217, v85
v_accvgpr_write_b32 a218, v86
v_mfma_f32_16x16x32_bf16 v[32:35], a[76:79], a[4:7], v[32:35]
v_accvgpr_write_b32 a219, v87
v_cvt_pk_bf16_f32 v132, v132, v133
v_mfma_f32_16x16x32_bf16 v[48:51], a[76:79], a[12:15], 0
s_waitcnt lgkmcnt(0)
s_barrier
v_mfma_f32_16x16x32_bf16 v[48:51], a[72:75], a[8:11], v[48:51]
s_xor_b32 m0, s77, 131072
ds_read_b64_tr_b16 a[104:105], v19 offset:4096
v_cvt_pk_bf16_f32 v133, v134, v135
v_mfma_f32_16x16x32_bf16 v[64:67], a[72:75], a[16:19], 0
s_xor_b32 s64, s71, 1572864
ds_read_b64_tr_b16 a[106:107], v19 offset:4352
v_cvt_pk_bf16_f32 v134, v148, v149
v_mfma_f32_16x16x32_bf16 v[64:67], a[76:79], a[20:23], v[64:67]
buffer_load_dwordx4 v14, s[56:59], s64 offen lds
v_mfma_f32_16x16x32_bf16 v[80:83], a[76:79], a[28:31], 0
ds_read_b64_tr_b16 a[108:109], v19 offset:6144
v_cvt_pk_bf16_f32 v135, v150, v151
v_mfma_f32_16x16x32_bf16 v[80:83], a[72:75], a[24:27], v[80:83]
ds_read_b64_tr_b16 a[110:111], v19 offset:6400
v_accvgpr_write_b32 a220, v132
v_mfma_f32_16x16x32_bf16 v[144:147], a[80:83], a[24:27], 0
ds_read_b64_tr_b16 a[112:113], v20 offset:4096
v_accvgpr_write_b32 a221, v133
v_mfma_f32_16x16x32_bf16 v[144:147], a[84:87], a[28:31], v[144:147]
ds_read_b64_tr_b16 a[114:115], v20 offset:4352
v_accvgpr_write_b32 a222, v134
v_mfma_f32_16x16x32_bf16 v[128:131], a[84:87], a[20:23], 0
ds_read_b64_tr_b16 a[116:117], v20 offset:6144
v_accvgpr_write_b32 a223, v135
v_mfma_f32_16x16x32_bf16 v[128:131], a[80:83], a[16:19], v[128:131]
ds_read_b64_tr_b16 a[118:119], v20 offset:6400
v_cvt_pk_bf16_f32 v100, v100, v101
v_mfma_f32_16x16x32_bf16 v[112:115], a[80:83], a[8:11], 0
s_add_u32 m0, s78, 147456
ds_read_b64_tr_b16 a[72:73], v19 offset:8192
v_cvt_pk_bf16_f32 v101, v102, v103
v_mfma_f32_16x16x32_bf16 v[112:115], a[84:87], a[12:15], v[112:115]
s_add_u32 s64, s75, 1179648
ds_read_b64_tr_b16 a[74:75], v19 offset:8448
v_cvt_pk_bf16_f32 v102, v116, v117
v_mfma_f32_16x16x32_bf16 v[96:99], a[84:87], a[4:7], 0
buffer_load_dwordx4 v23, s[60:63], s64 offen lds
v_mfma_f32_16x16x32_bf16 v[96:99], a[80:83], a[0:3], v[96:99]
ds_read_b64_tr_b16 a[76:77], v19 offset:10240
v_cvt_pk_bf16_f32 v103, v118, v119
v_mfma_f32_16x16x32_bf16 v[36:39], a[88:91], a[0:3], 0
ds_read_b64_tr_b16 a[78:79], v19 offset:10496
v_accvgpr_write_b32 a224, v100
v_mfma_f32_16x16x32_bf16 v[36:39], a[92:95], a[4:7], v[36:39]
ds_read_b64_tr_b16 a[80:81], v20 offset:8192
v_accvgpr_write_b32 a225, v101
v_mfma_f32_16x16x32_bf16 v[52:55], a[92:95], a[12:15], 0
s_xor_b32 s68, s66, 0
ds_read_b64_tr_b16 a[82:83], v20 offset:8448
v_accvgpr_write_b32 a226, v102
v_mfma_f32_16x16x32_bf16 v[52:55], a[88:91], a[8:11], v[52:55]
s_xor_b32 m0, s77, 132096
ds_read_b64_tr_b16 a[84:85], v20 offset:10240
v_accvgpr_write_b32 a227, v103
v_mfma_f32_16x16x32_bf16 v[68:71], a[88:91], a[16:19], 0
s_add_u32 s67, s79, 14336
ds_read_b64_tr_b16 a[86:87], v20 offset:10496
v_cvt_pk_bf16_f32 v255, v254, v255
v_mfma_f32_16x16x32_bf16 v[68:71], a[92:95], a[20:23], v[68:71]
s_xor_b32 s64, s71, 1605632
v_cvt_pk_bf16_f32 v254, v252, v253
v_cvt_pk_bf16_f32 v252, v248, v249
v_mfma_f32_16x16x32_bf16 v[84:87], a[92:95], a[28:31], 0
s_mov_b64 exec, 1
buffer_atomic_add a251, v1, s[52:55], s68 offen offset:0 sc1
s_mov_b64 exec, -1
v_mfma_f32_16x16x32_bf16 v[84:87], a[88:91], a[24:27], v[84:87]
buffer_load_dwordx4 v14, s[56:59], s64 offen lds
v_mfma_f32_16x16x32_bf16 v[148:151], a[96:99], a[24:27], 0
ds_read_b64_tr_b16 a[88:89], v19 offset:0
v_cvt_pk_bf16_f32 v253, v250, v251
v_mfma_f32_16x16x32_bf16 v[148:151], a[100:103], a[28:31], v[148:151]
ds_read_b64_tr_b16 a[90:91], v19 offset:256
v_mfma_f32_16x16x32_bf16 v[132:135], a[100:103], a[20:23], 0
ds_read_b64_tr_b16 a[92:93], v19 offset:2048
v_mfma_f32_16x16x32_bf16 v[132:135], a[96:99], a[16:19], v[132:135]
s_add_u32 s65, s79, 16384
ds_read_b64_tr_b16 a[94:95], v19 offset:2304
v_mfma_f32_16x16x32_bf16 v[116:119], a[96:99], a[8:11], 0
buffer_store_dwordx4 a[144:147], v16, s[44:47], s65 offen sc1
v_mfma_f32_16x16x32_bf16 v[116:119], a[100:103], a[12:15], v[116:119]
buffer_store_dwordx4 v[252:255], v16, s[44:47], s67 offen sc1
v_mfma_f32_16x16x32_bf16 v[100:103], a[100:103], a[4:7], 0
s_add_u32 m0, s78, 151552
v_mfma_f32_16x16x32_bf16 v[100:103], a[96:99], a[0:3], v[100:103]
s_waitcnt lgkmcnt(4)
s_add_u32 s64, s75, 1181696
ds_read_b64_tr_b16 a[96:97], v20 offset:0
v_accvgpr_read_b32 v248, a120
v_mfma_f32_16x16x32_bf16 v[184:187], a[104:107], a[32:35], v[184:187]
buffer_load_dwordx4 v23, s[60:63], s64 offen lds
v_mfma_f32_16x16x32_bf16 v[184:187], a[108:111], a[36:39], v[184:187]
ds_read_b64_tr_b16 a[98:99], v20 offset:256
v_accvgpr_read_b32 v249, a121
v_mfma_f32_16x16x32_bf16 v[192:195], a[108:111], a[44:47], v[192:195]
ds_read_b64_tr_b16 a[100:101], v20 offset:2048
v_accvgpr_read_b32 v250, a122
v_mfma_f32_16x16x32_bf16 v[192:195], a[104:107], a[40:43], v[192:195]
ds_read_b64_tr_b16 a[102:103], v20 offset:2304
v_accvgpr_read_b32 v251, a123
v_mfma_f32_16x16x32_bf16 v[200:203], a[104:107], a[48:51], v[200:203]
v_accvgpr_read_b32 v252, a124
v_accvgpr_read_b32 v253, a125
v_mfma_f32_16x16x32_bf16 v[200:203], a[108:111], a[52:55], v[200:203]
v_accvgpr_read_b32 v254, a126
v_accvgpr_read_b32 v255, a127
v_mfma_f32_16x16x32_bf16 v[208:211], a[108:111], a[60:63], v[208:211]
v_cvt_pk_bf16_f32 v255, v254, v255
v_cvt_pk_bf16_f32 v254, v252, v253
v_mfma_f32_16x16x32_bf16 v[208:211], a[104:107], a[56:59], v[208:211]
ds_read_b64_tr_b16 a[104:105], v4 offset:0
v_cvt_pk_bf16_f32 v252, v248, v249
v_mfma_f32_16x16x32_bf16 v[212:215], a[112:115], a[56:59], v[212:215]
s_xor_b32 m0, s77, 133120
ds_read_b64_tr_b16 a[106:107], v4 offset:1024
v_cvt_pk_bf16_f32 v253, v250, v251
v_mfma_f32_16x16x32_bf16 v[212:215], a[116:119], a[60:63], v[212:215]
s_xor_b32 s64, s71, 1638400
ds_read_b64_tr_b16 a[108:109], v4 offset:8192
v_accvgpr_write_b32 a228, v252
v_mfma_f32_16x16x32_bf16 v[204:207], a[116:119], a[52:55], v[204:207]
buffer_load_dwordx4 v15, s[56:59], s64 offen lds
v_mfma_f32_16x16x32_bf16 v[204:207], a[112:115], a[48:51], v[204:207]
ds_read_b64_tr_b16 a[110:111], v4 offset:9216
v_accvgpr_write_b32 a229, v253
v_mfma_f32_16x16x32_bf16 v[196:199], a[112:115], a[40:43], v[196:199]
v_accvgpr_write_b32 a230, v254
v_accvgpr_write_b32 a231, v255
v_mfma_f32_16x16x32_bf16 v[196:199], a[116:119], a[44:47], v[196:199]
v_mfma_f32_16x16x32_bf16 v[188:191], a[116:119], a[36:39], v[188:191]
v_accvgpr_read_b32 v248, a132
v_accvgpr_read_b32 v249, a133
v_mfma_f32_16x16x32_bf16 v[188:191], a[112:115], a[32:35], v[188:191]
ds_read_b64_tr_b16 a[112:113], v5 offset:0
v_accvgpr_read_b32 v250, a134
v_mfma_f32_16x16x32_bf16 v[216:219], a[32:35], a[72:75], v[216:219]
ds_read_b64_tr_b16 a[114:115], v5 offset:1024
v_accvgpr_read_b32 v251, a135
v_mfma_f32_16x16x32_bf16 v[216:219], a[36:39], a[76:79], v[216:219]
s_add_u32 m0, s78, 155648
ds_read_b64_tr_b16 a[116:117], v5 offset:8192
v_accvgpr_read_b32 v252, a128
v_mfma_f32_16x16x32_bf16 v[224:227], a[44:47], a[76:79], v[224:227]
s_add_u32 s64, s75, 1183744
ds_read_b64_tr_b16 a[118:119], v5 offset:9216
v_accvgpr_read_b32 v253, a129
v_mfma_f32_16x16x32_bf16 v[224:227], a[40:43], a[72:75], v[224:227]
buffer_load_dwordx4 v23, s[60:63], s64 offen lds
v_mfma_f32_16x16x32_bf16 v[232:235], a[48:51], a[72:75], v[232:235]
v_accvgpr_read_b32 v254, a130
v_accvgpr_read_b32 v255, a131
v_mfma_f32_16x16x32_bf16 v[232:235], a[52:55], a[76:79], v[232:235]
v_cvt_pk_bf16_f32 v255, v254, v255
v_cvt_pk_bf16_f32 v254, v252, v253
v_mfma_f32_16x16x32_bf16 v[240:243], a[60:63], a[76:79], v[240:243]
v_cvt_pk_bf16_f32 v252, v248, v249
v_cvt_pk_bf16_f32 v253, v250, v251
v_mfma_f32_16x16x32_bf16 v[240:243], a[56:59], a[72:75], v[240:243]
ds_read_b64_tr_b16 a[72:73], v6 offset:0
v_accvgpr_write_b32 a232, v252
v_mfma_f32_16x16x32_bf16 v[244:247], a[56:59], a[80:83], v[244:247]
ds_read_b64_tr_b16 a[74:75], v6 offset:1024
v_accvgpr_write_b32 a233, v253
v_mfma_f32_16x16x32_bf16 v[244:247], a[60:63], a[84:87], v[244:247]
ds_read_b64_tr_b16 a[76:77], v6 offset:8192
v_accvgpr_write_b32 a234, v254
v_mfma_f32_16x16x32_bf16 v[236:239], a[52:55], a[84:87], v[236:239]
s_xor_b32 m0, s77, 134144
ds_read_b64_tr_b16 a[78:79], v6 offset:9216
v_accvgpr_write_b32 a235, v255
v_mfma_f32_16x16x32_bf16 v[236:239], a[48:51], a[80:83], v[236:239]
s_xor_b32 s64, s71, 1671168
v_mfma_f32_16x16x32_bf16 v[228:231], a[40:43], a[80:83], v[228:231]
buffer_load_dwordx4 v15, s[56:59], s64 offen lds
v_mfma_f32_16x16x32_bf16 v[228:231], a[44:47], a[84:87], v[228:231]
v_accvgpr_read_b32 v248, a140
v_accvgpr_read_b32 v249, a141
v_mfma_f32_16x16x32_bf16 v[220:223], a[36:39], a[84:87], v[220:223]
v_accvgpr_read_b32 v250, a142
v_accvgpr_read_b32 v251, a143
v_mfma_f32_16x16x32_bf16 v[220:223], a[32:35], a[80:83], v[220:223]
s_waitcnt lgkmcnt(4)
ds_read_b64_tr_b16 a[80:81], v7 offset:0
v_accvgpr_read_b32 v252, a136
v_mfma_f32_16x16x32_bf16 v[152:155], a[88:91], a[32:35], v[152:155]
ds_read_b64_tr_b16 a[82:83], v7 offset:1024
v_accvgpr_read_b32 v253, a137
v_mfma_f32_16x16x32_bf16 v[152:155], a[92:95], a[36:39], v[152:155]
ds_read_b64_tr_b16 a[84:85], v7 offset:8192
v_accvgpr_read_b32 v254, a138
v_mfma_f32_16x16x32_bf16 v[160:163], a[92:95], a[44:47], v[160:163]
ds_read_b64_tr_b16 a[86:87], v7 offset:9216
v_accvgpr_read_b32 v255, a139
v_mfma_f32_16x16x32_bf16 v[160:163], a[88:91], a[40:43], v[160:163]
v_cvt_pk_bf16_f32 v255, v254, v255
v_cvt_pk_bf16_f32 v254, v252, v253
v_mfma_f32_16x16x32_bf16 v[168:171], a[88:91], a[48:51], v[168:171]
v_cvt_pk_bf16_f32 v252, v248, v249
v_cvt_pk_bf16_f32 v253, v250, v251
v_mfma_f32_16x16x32_bf16 v[168:171], a[92:95], a[52:55], v[168:171]
v_accvgpr_write_b32 a236, v252
v_accvgpr_write_b32 a237, v253
v_mfma_f32_16x16x32_bf16 v[176:179], a[92:95], a[60:63], v[176:179]
s_xor_b32 m0, s84, 32768
v_accvgpr_write_b32 a238, v254
v_accvgpr_write_b32 a239, v255
v_mfma_f32_16x16x32_bf16 v[176:179], a[88:91], a[56:59], v[176:179]
s_xor_b32 s64, s72, 384
ds_read_b64_tr_b16 a[88:89], v8 offset:0
v_mfma_f32_16x16x32_bf16 v[180:183], a[96:99], a[56:59], v[180:183]
s_add_u32 s65, s79, 4096
buffer_load_dwordx4 v12, s[48:51], s64 offen lds
v_mfma_f32_16x16x32_bf16 v[180:183], a[100:103], a[60:63], v[180:183]
buffer_store_dwordx4 a[148:151], v16, s[44:47], s65 offen sc1
v_mfma_f32_16x16x32_bf16 v[172:175], a[100:103], a[52:55], v[172:175]
ds_read_b64_tr_b16 a[90:91], v8 offset:1024
v_mfma_f32_16x16x32_bf16 v[172:175], a[96:99], a[48:51], v[172:175]
s_xor_b32 m0, s84, 33792
ds_read_b64_tr_b16 a[92:93], v8 offset:8192
v_mfma_f32_16x16x32_bf16 v[164:167], a[96:99], a[40:43], v[164:167]
s_xor_b32 s64, s72, 16768
ds_read_b64_tr_b16 a[94:95], v8 offset:9216
v_mfma_f32_16x16x32_bf16 v[164:167], a[100:103], a[44:47], v[164:167]
buffer_load_dwordx4 v13, s[48:51], s64 offen lds
v_mfma_f32_16x16x32_bf16 v[156:159], a[100:103], a[36:39], v[156:159]
v_mfma_f32_16x16x32_bf16 v[156:159], a[96:99], a[32:35], v[156:159]
ds_read_b64_tr_b16 a[96:97], v9 offset:0
v_mfma_f32_16x16x32_bf16 v[24:27], a[104:107], a[32:35], v[24:27]
s_xor_b32 m0, s84, 34816
ds_read_b64_tr_b16 a[98:99], v9 offset:1024
v_mfma_f32_16x16x32_bf16 v[24:27], a[108:111], a[36:39], v[24:27]
s_xor_b32 s64, s72, 131456
ds_read_b64_tr_b16 a[100:101], v9 offset:8192
v_mfma_f32_16x16x32_bf16 v[40:43], a[108:111], a[44:47], v[40:43]
buffer_load_dwordx4 v12, s[48:51], s64 offen lds
v_mfma_f32_16x16x32_bf16 v[40:43], a[104:107], a[40:43], v[40:43]
ds_read_b64_tr_b16 a[102:103], v9 offset:9216
v_mfma_f32_16x16x32_bf16 v[56:59], a[104:107], a[48:51], v[56:59]
v_mfma_f32_16x16x32_bf16 v[56:59], a[108:111], a[52:55], v[56:59]
s_xor_b32 m0, s84, 35840
v_mfma_f32_16x16x32_bf16 v[72:75], a[108:111], a[60:63], v[72:75]
s_waitcnt vmcnt(14)
s_xor_b32 s64, s72, 147840
ds_read_b128 a[0:3], v2 offset:0
v_mfma_f32_16x16x32_bf16 v[72:75], a[104:107], a[56:59], v[72:75]
buffer_load_dwordx4 v13, s[48:51], s64 offen lds
v_mfma_f32_16x16x32_bf16 v[136:139], a[112:115], a[56:59], v[136:139]
ds_read_b128 a[4:7], v3 offset:0
v_mfma_f32_16x16x32_bf16 v[136:139], a[116:119], a[60:63], v[136:139]
ds_read_b128 a[8:11], v2 offset:2048
v_mfma_f32_16x16x32_bf16 v[120:123], a[116:119], a[52:55], v[120:123]
s_xor_b32 m0, s84, 36864
ds_read_b128 a[12:15], v3 offset:2048
v_mfma_f32_16x16x32_bf16 v[120:123], a[112:115], a[48:51], v[120:123]
s_xor_b32 s64, s73, 384
ds_read_b128 a[16:19], v2 offset:4096
v_mfma_f32_16x16x32_bf16 v[104:107], a[112:115], a[40:43], v[104:107]
buffer_load_dwordx4 v12, s[48:51], s64 offen lds
v_mfma_f32_16x16x32_bf16 v[104:107], a[116:119], a[44:47], v[104:107]
ds_read_b128 a[20:23], v3 offset:4096
v_mfma_f32_16x16x32_bf16 v[88:91], a[116:119], a[36:39], v[88:91]
ds_read_b128 a[24:27], v2 offset:6144
v_mfma_f32_16x16x32_bf16 v[88:91], a[112:115], a[32:35], v[88:91]
s_waitcnt lgkmcnt(7)
s_xor_b32 m0, s84, 37888
ds_read_b128 a[28:31], v3 offset:6144
v_mfma_f32_16x16x32_bf16 v[28:31], a[72:75], a[32:35], v[28:31]
s_xor_b32 s64, s73, 16768
ds_read_b64_tr_b16 a[104:105], v10 offset:0
v_mfma_f32_16x16x32_bf16 v[28:31], a[76:79], a[36:39], v[28:31]
buffer_load_dwordx4 v13, s[48:51], s64 offen lds
v_mfma_f32_16x16x32_bf16 v[44:47], a[76:79], a[44:47], v[44:47]
ds_read_b64_tr_b16 a[106:107], v10 offset:1024
v_mfma_f32_16x16x32_bf16 v[44:47], a[72:75], a[40:43], v[44:47]
ds_read_b64_tr_b16 a[108:109], v10 offset:8192
v_mfma_f32_16x16x32_bf16 v[60:63], a[72:75], a[48:51], v[60:63]
s_xor_b32 m0, s84, 38912
ds_read_b64_tr_b16 a[110:111], v10 offset:9216
v_mfma_f32_16x16x32_bf16 v[60:63], a[76:79], a[52:55], v[60:63]
s_xor_b32 s64, s73, 131456
ds_read_b64_tr_b16 a[112:113], v11 offset:0
v_mfma_f32_16x16x32_bf16 v[76:79], a[76:79], a[60:63], v[76:79]
buffer_load_dwordx4 v12, s[48:51], s64 offen lds
v_mfma_f32_16x16x32_bf16 v[76:79], a[72:75], a[56:59], v[76:79]
ds_read_b64_tr_b16 a[114:115], v11 offset:1024
v_mfma_f32_16x16x32_bf16 v[140:143], a[80:83], a[56:59], v[140:143]
ds_read_b64_tr_b16 a[116:117], v11 offset:8192
v_mfma_f32_16x16x32_bf16 v[140:143], a[84:87], a[60:63], v[140:143]
s_xor_b32 m0, s84, 39936
ds_read_b64_tr_b16 a[118:119], v11 offset:9216
v_mfma_f32_16x16x32_bf16 v[124:127], a[84:87], a[52:55], v[124:127]
s_xor_b32 s64, s73, 147840
v_mfma_f32_16x16x32_bf16 v[124:127], a[80:83], a[48:51], v[124:127]
buffer_load_dwordx4 v13, s[48:51], s64 offen lds
v_mfma_f32_16x16x32_bf16 v[108:111], a[80:83], a[40:43], v[108:111]
v_mfma_f32_16x16x32_bf16 v[108:111], a[84:87], a[44:47], v[108:111]
v_mfma_f32_16x16x32_bf16 v[92:95], a[84:87], a[36:39], v[92:95]
v_mfma_f32_16x16x32_bf16 v[92:95], a[80:83], a[32:35], v[92:95]
v_mfma_f32_16x16x32_bf16 v[32:35], a[88:91], a[32:35], v[32:35]
v_mfma_f32_16x16x32_bf16 v[32:35], a[92:95], a[36:39], v[32:35]
s_branch L_po7
L_pg7:
s_branch L_pg11
L_po7:
v_mfma_f32_16x16x32_bf16 v[48:51], a[92:95], a[44:47], v[48:51]
s_waitcnt lgkmcnt(0)
s_barrier
v_mfma_f32_16x16x32_bf16 v[48:51], a[88:91], a[40:43], v[48:51]
s_xor_b32 m0, s77, 65536
ds_read_b64_tr_b16 a[72:73], v19 offset:36864
v_mfma_f32_16x16x32_bf16 v[64:67], a[88:91], a[48:51], v[64:67]
s_xor_b32 s64, s71, 2097152
ds_read_b64_tr_b16 a[74:75], v19 offset:37120
v_mfma_f32_16x16x32_bf16 v[64:67], a[92:95], a[52:55], v[64:67]
s_add_u32 s65, s79, 0
buffer_load_dwordx4 v14, s[56:59], s64 offen lds
v_mfma_f32_16x16x32_bf16 v[80:83], a[92:95], a[60:63], v[80:83]
buffer_store_dwordx4 a[152:155], v16, s[44:47], s65 offen sc1
v_mfma_f32_16x16x32_bf16 v[80:83], a[88:91], a[56:59], v[80:83]
ds_read_b64_tr_b16 a[76:77], v19 offset:38912
v_mfma_f32_16x16x32_bf16 v[144:147], a[96:99], a[56:59], v[144:147]
ds_read_b64_tr_b16 a[78:79], v19 offset:39168
v_mfma_f32_16x16x32_bf16 v[144:147], a[100:103], a[60:63], v[144:147]
ds_read_b64_tr_b16 a[80:81], v20 offset:36864
v_mfma_f32_16x16x32_bf16 v[128:131], a[100:103], a[52:55], v[128:131]
ds_read_b64_tr_b16 a[82:83], v20 offset:37120
v_mfma_f32_16x16x32_bf16 v[128:131], a[96:99], a[48:51], v[128:131]
ds_read_b64_tr_b16 a[84:85], v20 offset:38912
v_mfma_f32_16x16x32_bf16 v[112:115], a[96:99], a[40:43], v[112:115]
s_add_u32 m0, s78, 81920
ds_read_b64_tr_b16 a[86:87], v20 offset:39168
v_mfma_f32_16x16x32_bf16 v[112:115], a[100:103], a[44:47], v[112:115]
s_add_u32 s64, s75, 1572864
ds_read_b64_tr_b16 a[88:89], v19 offset:40960
v_mfma_f32_16x16x32_bf16 v[96:99], a[100:103], a[36:39], v[96:99]
buffer_load_dwordx4 v23, s[60:63], s64 offen lds
v_mfma_f32_16x16x32_bf16 v[96:99], a[96:99], a[32:35], v[96:99]
ds_read_b64_tr_b16 a[90:91], v19 offset:41216
v_mfma_f32_16x16x32_bf16 v[36:39], a[104:107], a[32:35], v[36:39]
ds_read_b64_tr_b16 a[92:93], v19 offset:43008
v_mfma_f32_16x16x32_bf16 v[36:39], a[108:111], a[36:39], v[36:39]
ds_read_b64_tr_b16 a[94:95], v19 offset:43264
v_mfma_f32_16x16x32_bf16 v[52:55], a[108:111], a[44:47], v[52:55]
ds_read_b64_tr_b16 a[96:97], v20 offset:40960
v_mfma_f32_16x16x32_bf16 v[52:55], a[104:107], a[40:43], v[52:55]
ds_read_b64_tr_b16 a[98:99], v20 offset:41216
v_mfma_f32_16x16x32_bf16 v[68:71], a[104:107], a[48:51], v[68:71]
s_xor_b32 m0, s77, 66560
ds_read_b64_tr_b16 a[100:101], v20 offset:43008
v_mfma_f32_16x16x32_bf16 v[68:71], a[108:111], a[52:55], v[68:71]
s_xor_b32 s64, s71, 2129920
s_xor_b32 s68, s66, 4096
ds_read_b64_tr_b16 a[102:103], v20 offset:43264
v_mfma_f32_16x16x32_bf16 v[84:87], a[108:111], a[60:63], v[84:87]
s_mov_b64 exec, 1
buffer_atomic_add a251, v1, s[52:55], s68 offen offset:0 sc1
s_mov_b64 exec, -1
v_mfma_f32_16x16x32_bf16 v[84:87], a[104:107], a[56:59], v[84:87]
buffer_load_dwordx4 v14, s[56:59], s64 offen lds
v_mfma_f32_16x16x32_bf16 v[148:151], a[112:115], a[56:59], v[148:151]
ds_read_b64_tr_b16 a[104:105], v19 offset:32768
v_mfma_f32_16x16x32_bf16 v[148:151], a[116:119], a[60:63], v[148:151]
ds_read_b64_tr_b16 a[106:107], v19 offset:33024
v_mfma_f32_16x16x32_bf16 v[132:135], a[116:119], a[52:55], v[132:135]
ds_read_b64_tr_b16 a[108:109], v19 offset:34816
v_mfma_f32_16x16x32_bf16 v[132:135], a[112:115], a[48:51], v[132:135]
ds_read_b64_tr_b16 a[110:111], v19 offset:35072
v_mfma_f32_16x16x32_bf16 v[116:119], a[112:115], a[40:43], v[116:119]
v_mfma_f32_16x16x32_bf16 v[116:119], a[116:119], a[44:47], v[116:119]
v_mfma_f32_16x16x32_bf16 v[100:103], a[116:119], a[36:39], v[100:103]
s_add_u32 m0, s78, 86016
v_mfma_f32_16x16x32_bf16 v[100:103], a[112:115], a[32:35], v[100:103]
s_waitcnt lgkmcnt(4)
s_add_u32 s64, s75, 1574912
ds_read_b64_tr_b16 a[112:113], v20 offset:32768
v_mfma_f32_16x16x32_bf16 v[184:187], a[72:75], a[0:3], v[184:187]
buffer_load_dwordx4 v23, s[60:63], s64 offen lds
v_mfma_f32_16x16x32_bf16 v[184:187], a[76:79], a[4:7], v[184:187]
ds_read_b64_tr_b16 a[114:115], v20 offset:33024
v_mfma_f32_16x16x32_bf16 v[192:195], a[76:79], a[12:15], v[192:195]
ds_read_b64_tr_b16 a[116:117], v20 offset:34816
v_mfma_f32_16x16x32_bf16 v[192:195], a[72:75], a[8:11], v[192:195]
ds_read_b64_tr_b16 a[118:119], v20 offset:35072
v_mfma_f32_16x16x32_bf16 v[200:203], a[72:75], a[16:19], v[200:203]
v_mfma_f32_16x16x32_bf16 v[200:203], a[76:79], a[20:23], v[200:203]
v_mfma_f32_16x16x32_bf16 v[208:211], a[76:79], a[28:31], v[208:211]
v_mfma_f32_16x16x32_bf16 v[208:211], a[72:75], a[24:27], v[208:211]
ds_read_b64_tr_b16 a[72:73], v4 offset:32768
v_mfma_f32_16x16x32_bf16 v[212:215], a[80:83], a[24:27], v[212:215]
s_xor_b32 m0, s77, 67584
ds_read_b64_tr_b16 a[74:75], v4 offset:33792
v_mfma_f32_16x16x32_bf16 v[212:215], a[84:87], a[28:31], v[212:215]
s_xor_b32 s64, s71, 2162688
ds_read_b64_tr_b16 a[76:77], v4 offset:40960
v_mfma_f32_16x16x32_bf16 v[204:207], a[84:87], a[20:23], v[204:207]
buffer_load_dwordx4 v15, s[56:59], s64 offen lds
v_mfma_f32_16x16x32_bf16 v[204:207], a[80:83], a[16:19], v[204:207]
ds_read_b64_tr_b16 a[78:79], v4 offset:41984
v_mfma_f32_16x16x32_bf16 v[196:199], a[80:83], a[8:11], v[196:199]
v_mfma_f32_16x16x32_bf16 v[196:199], a[84:87], a[12:15], v[196:199]
v_mfma_f32_16x16x32_bf16 v[188:191], a[84:87], a[4:7], v[188:191]
v_mfma_f32_16x16x32_bf16 v[188:191], a[80:83], a[0:3], v[188:191]
ds_read_b64_tr_b16 a[80:81], v5 offset:32768
v_mfma_f32_16x16x32_bf16 v[216:219], a[0:3], a[88:91], v[216:219]
ds_read_b64_tr_b16 a[82:83], v5 offset:33792
v_mfma_f32_16x16x32_bf16 v[216:219], a[4:7], a[92:95], v[216:219]
s_add_u32 m0, s78, 90112
s_add_u32 s65, s79, 17408
ds_read_b64_tr_b16 a[84:85], v5 offset:40960
v_mfma_f32_16x16x32_bf16 v[224:227], a[12:15], a[92:95], v[224:227]
s_add_u32 s64, s75, 1576960
buffer_store_dwordx4 a[156:159], v16, s[44:47], s65 offen sc1
v_mfma_f32_16x16x32_bf16 v[224:227], a[8:11], a[88:91], v[224:227]
buffer_load_dwordx4 v23, s[60:63], s64 offen lds
v_mfma_f32_16x16x32_bf16 v[232:235], a[16:19], a[88:91], v[232:235]
ds_read_b64_tr_b16 a[86:87], v5 offset:41984
v_mfma_f32_16x16x32_bf16 v[232:235], a[20:23], a[92:95], v[232:235]
v_mfma_f32_16x16x32_bf16 v[240:243], a[28:31], a[92:95], v[240:243]
v_mfma_f32_16x16x32_bf16 v[240:243], a[24:27], a[88:91], v[240:243]
ds_read_b64_tr_b16 a[88:89], v6 offset:32768
v_mfma_f32_16x16x32_bf16 v[244:247], a[24:27], a[96:99], v[244:247]
ds_read_b64_tr_b16 a[90:91], v6 offset:33792
v_mfma_f32_16x16x32_bf16 v[244:247], a[28:31], a[100:103], v[244:247]
ds_read_b64_tr_b16 a[92:93], v6 offset:40960
v_add_u32 v19, 0x8000, v19
v_mfma_f32_16x16x32_bf16 v[236:239], a[20:23], a[100:103], v[236:239]
s_xor_b32 m0, s77, 68608
ds_read_b64_tr_b16 a[94:95], v6 offset:41984
v_mfma_f32_16x16x32_bf16 v[236:239], a[16:19], a[96:99], v[236:239]
s_xor_b32 s64, s71, 2195456
v_mfma_f32_16x16x32_bf16 v[228:231], a[8:11], a[96:99], v[228:231]
buffer_load_dwordx4 v15, s[56:59], s64 offen lds
v_mfma_f32_16x16x32_bf16 v[228:231], a[12:15], a[100:103], v[228:231]
v_mfma_f32_16x16x32_bf16 v[220:223], a[4:7], a[100:103], v[220:223]
v_mfma_f32_16x16x32_bf16 v[220:223], a[0:3], a[96:99], v[220:223]
s_waitcnt lgkmcnt(4)
ds_read_b64_tr_b16 a[96:97], v7 offset:32768
v_mfma_f32_16x16x32_bf16 v[152:155], a[104:107], a[0:3], v[152:155]
ds_read_b64_tr_b16 a[98:99], v7 offset:33792
v_mfma_f32_16x16x32_bf16 v[152:155], a[108:111], a[4:7], v[152:155]
ds_read_b64_tr_b16 a[100:101], v7 offset:40960
v_add_u32 v20, 0x8000, v20
v_mfma_f32_16x16x32_bf16 v[160:163], a[108:111], a[12:15], v[160:163]
ds_read_b64_tr_b16 a[102:103], v7 offset:41984
v_mfma_f32_16x16x32_bf16 v[160:163], a[104:107], a[8:11], v[160:163]
v_mfma_f32_16x16x32_bf16 v[168:171], a[104:107], a[16:19], v[168:171]
v_mfma_f32_16x16x32_bf16 v[168:171], a[108:111], a[20:23], v[168:171]
v_mfma_f32_16x16x32_bf16 v[176:179], a[108:111], a[28:31], v[176:179]
s_xor_b32 m0, s84, 0
v_mfma_f32_16x16x32_bf16 v[176:179], a[104:107], a[24:27], v[176:179]
s_xor_b32 s64, s72, 512
ds_read_b64_tr_b16 a[104:105], v8 offset:32768
v_mfma_f32_16x16x32_bf16 v[180:183], a[112:115], a[24:27], v[180:183]
buffer_load_dwordx4 v12, s[48:51], s64 offen lds
v_mfma_f32_16x16x32_bf16 v[180:183], a[116:119], a[28:31], v[180:183]
ds_read_b64_tr_b16 a[106:107], v8 offset:33792
v_add_u32 v4, 0x8000, v4
v_mfma_f32_16x16x32_bf16 v[172:175], a[116:119], a[20:23], v[172:175]
ds_read_b64_tr_b16 a[108:109], v8 offset:40960
v_mfma_f32_16x16x32_bf16 v[172:175], a[112:115], a[16:19], v[172:175]
s_xor_b32 m0, s84, 1024
ds_read_b64_tr_b16 a[110:111], v8 offset:41984
v_mfma_f32_16x16x32_bf16 v[164:167], a[112:115], a[8:11], v[164:167]
s_xor_b32 s64, s72, 16896
v_mfma_f32_16x16x32_bf16 v[164:167], a[116:119], a[12:15], v[164:167]
buffer_load_dwordx4 v13, s[48:51], s64 offen lds
v_mfma_f32_16x16x32_bf16 v[156:159], a[116:119], a[4:7], v[156:159]
v_mfma_f32_16x16x32_bf16 v[156:159], a[112:115], a[0:3], v[156:159]
ds_read_b64_tr_b16 a[112:113], v9 offset:32768
v_mfma_f32_16x16x32_bf16 v[24:27], a[72:75], a[0:3], v[24:27]
s_xor_b32 m0, s84, 2048
ds_read_b64_tr_b16 a[114:115], v9 offset:33792
v_mfma_f32_16x16x32_bf16 v[24:27], a[76:79], a[4:7], v[24:27]
s_xor_b32 s64, s72, 131584
ds_read_b64_tr_b16 a[116:117], v9 offset:40960
v_add_u32 v5, 0x8000, v5
v_mfma_f32_16x16x32_bf16 v[40:43], a[76:79], a[12:15], v[40:43]
buffer_load_dwordx4 v12, s[48:51], s64 offen lds
v_mfma_f32_16x16x32_bf16 v[40:43], a[72:75], a[8:11], v[40:43]
ds_read_b64_tr_b16 a[118:119], v9 offset:41984
v_mfma_f32_16x16x32_bf16 v[56:59], a[72:75], a[16:19], v[56:59]
v_mfma_f32_16x16x32_bf16 v[56:59], a[76:79], a[20:23], v[56:59]
s_xor_b32 m0, s84, 3072
v_mfma_f32_16x16x32_bf16 v[72:75], a[76:79], a[28:31], v[72:75]
s_waitcnt vmcnt(13)
s_xor_b32 s64, s72, 147968
ds_read_b128 a[32:35], v2 offset:32768
v_mfma_f32_16x16x32_bf16 v[72:75], a[72:75], a[24:27], v[72:75]
buffer_load_dwordx4 v13, s[48:51], s64 offen lds
v_mfma_f32_16x16x32_bf16 v[136:139], a[80:83], a[24:27], v[136:139]
ds_read_b128 a[36:39], v3 offset:32768
v_mfma_f32_16x16x32_bf16 v[136:139], a[84:87], a[28:31], v[136:139]
ds_read_b128 a[40:43], v2 offset:34816
v_add_u32 v6, 0x8000, v6
v_mfma_f32_16x16x32_bf16 v[120:123], a[84:87], a[20:23], v[120:123]
s_xor_b32 m0, s84, 4096
ds_read_b128 a[44:47], v3 offset:34816
v_mfma_f32_16x16x32_bf16 v[120:123], a[80:83], a[16:19], v[120:123]
s_xor_b32 s64, s73, 512
ds_read_b128 a[48:51], v2 offset:36864
v_mfma_f32_16x16x32_bf16 v[104:107], a[80:83], a[8:11], v[104:107]
buffer_load_dwordx4 v12, s[48:51], s64 offen lds
v_mfma_f32_16x16x32_bf16 v[104:107], a[84:87], a[12:15], v[104:107]
ds_read_b128 a[52:55], v3 offset:36864
v_mfma_f32_16x16x32_bf16 v[88:91], a[84:87], a[4:7], v[88:91]
s_add_u32 s65, s79, 5120
ds_read_b128 a[56:59], v2 offset:38912
v_mfma_f32_16x16x32_bf16 v[88:91], a[80:83], a[0:3], v[88:91]
s_waitcnt lgkmcnt(7)
s_xor_b32 m0, s84, 5120
buffer_store_dwordx4 a[160:163], v16, s[44:47], s65 offen sc1
v_mfma_f32_16x16x32_bf16 v[28:31], a[88:91], a[0:3], v[28:31]
s_xor_b32 s64, s73, 16896
ds_read_b128 a[60:63], v3 offset:38912
v_mfma_f32_16x16x32_bf16 v[28:31], a[92:95], a[4:7], v[28:31]
buffer_load_dwordx4 v13, s[48:51], s64 offen lds
v_mfma_f32_16x16x32_bf16 v[44:47], a[92:95], a[12:15], v[44:47]
ds_read_b64_tr_b16 a[72:73], v10 offset:32768
v_add_u32 v7, 0x8000, v7
v_mfma_f32_16x16x32_bf16 v[44:47], a[88:91], a[8:11], v[44:47]
ds_read_b64_tr_b16 a[74:75], v10 offset:33792
v_mfma_f32_16x16x32_bf16 v[60:63], a[88:91], a[16:19], v[60:63]
s_xor_b32 m0, s84, 6144
ds_read_b64_tr_b16 a[76:77], v10 offset:40960
v_mfma_f32_16x16x32_bf16 v[60:63], a[92:95], a[20:23], v[60:63]
s_xor_b32 s64, s73, 131584
ds_read_b64_tr_b16 a[78:79], v10 offset:41984
v_mfma_f32_16x16x32_bf16 v[76:79], a[92:95], a[28:31], v[76:79]
buffer_load_dwordx4 v12, s[48:51], s64 offen lds
v_mfma_f32_16x16x32_bf16 v[76:79], a[88:91], a[24:27], v[76:79]
ds_read_b64_tr_b16 a[80:81], v11 offset:32768
v_mfma_f32_16x16x32_bf16 v[140:143], a[96:99], a[24:27], v[140:143]
ds_read_b64_tr_b16 a[82:83], v11 offset:33792
v_mfma_f32_16x16x32_bf16 v[140:143], a[100:103], a[28:31], v[140:143]
s_xor_b32 m0, s84, 7168
ds_read_b64_tr_b16 a[84:85], v11 offset:40960
v_add_u32 v8, 0x8000, v8
v_mfma_f32_16x16x32_bf16 v[124:127], a[100:103], a[20:23], v[124:127]
s_xor_b32 s64, s73, 147968
ds_read_b64_tr_b16 a[86:87], v11 offset:41984
v_mfma_f32_16x16x32_bf16 v[124:127], a[96:99], a[16:19], v[124:127]
buffer_load_dwordx4 v13, s[48:51], s64 offen lds
v_mfma_f32_16x16x32_bf16 v[108:111], a[96:99], a[8:11], v[108:111]
v_mfma_f32_16x16x32_bf16 v[108:111], a[100:103], a[12:15], v[108:111]
v_mfma_f32_16x16x32_bf16 v[92:95], a[100:103], a[4:7], v[92:95]
v_add_u32 v9, 0x8000, v9
v_add_u32 v10, 0x8000, v10
v_mfma_f32_16x16x32_bf16 v[92:95], a[96:99], a[0:3], v[92:95]
v_add_u32 v11, 0x8000, v11
v_mfma_f32_16x16x32_bf16 v[32:35], a[104:107], a[0:3], v[32:35]
v_mfma_f32_16x16x32_bf16 v[32:35], a[108:111], a[4:7], v[32:35]
v_mfma_f32_16x16x32_bf16 v[48:51], a[108:111], a[12:15], v[48:51]
s_waitcnt lgkmcnt(0)
s_barrier
v_mfma_f32_16x16x32_bf16 v[48:51], a[104:107], a[8:11], v[48:51]
s_xor_b32 m0, s77, 98304
ds_read_b64_tr_b16 a[88:89], v19 offset:36864
v_mfma_f32_16x16x32_bf16 v[64:67], a[104:107], a[16:19], v[64:67]
s_xor_b32 s64, s71, 2621440
ds_read_b64_tr_b16 a[90:91], v19 offset:37120
v_mfma_f32_16x16x32_bf16 v[64:67], a[108:111], a[20:23], v[64:67]
buffer_load_dwordx4 v14, s[56:59], s64 offen lds
v_mfma_f32_16x16x32_bf16 v[80:83], a[108:111], a[28:31], v[80:83]
ds_read_b64_tr_b16 a[92:93], v19 offset:38912
v_mfma_f32_16x16x32_bf16 v[80:83], a[104:107], a[24:27], v[80:83]
ds_read_b64_tr_b16 a[94:95], v19 offset:39168
v_mfma_f32_16x16x32_bf16 v[144:147], a[112:115], a[24:27], v[144:147]
ds_read_b64_tr_b16 a[96:97], v20 offset:36864
v_mfma_f32_16x16x32_bf16 v[144:147], a[116:119], a[28:31], v[144:147]
ds_read_b64_tr_b16 a[98:99], v20 offset:37120
v_mfma_f32_16x16x32_bf16 v[128:131], a[116:119], a[20:23], v[128:131]
ds_read_b64_tr_b16 a[100:101], v20 offset:38912
v_mfma_f32_16x16x32_bf16 v[128:131], a[112:115], a[16:19], v[128:131]
ds_read_b64_tr_b16 a[102:103], v20 offset:39168
v_mfma_f32_16x16x32_bf16 v[112:115], a[112:115], a[8:11], v[112:115]
s_add_u32 m0, s78, 114688
ds_read_b64_tr_b16 a[104:105], v19 offset:40960
v_mfma_f32_16x16x32_bf16 v[112:115], a[116:119], a[12:15], v[112:115]
s_add_u32 s64, s75, 1966080
ds_read_b64_tr_b16 a[106:107], v19 offset:41216
v_mfma_f32_16x16x32_bf16 v[96:99], a[116:119], a[4:7], v[96:99]
buffer_load_dwordx4 v23, s[60:63], s64 offen lds
v_mfma_f32_16x16x32_bf16 v[96:99], a[112:115], a[0:3], v[96:99]
ds_read_b64_tr_b16 a[108:109], v19 offset:43008
v_mfma_f32_16x16x32_bf16 v[36:39], a[72:75], a[0:3], v[36:39]
ds_read_b64_tr_b16 a[110:111], v19 offset:43264
v_mfma_f32_16x16x32_bf16 v[36:39], a[76:79], a[4:7], v[36:39]
ds_read_b64_tr_b16 a[112:113], v20 offset:40960
v_mfma_f32_16x16x32_bf16 v[52:55], a[76:79], a[12:15], v[52:55]
ds_read_b64_tr_b16 a[114:115], v20 offset:41216
v_mfma_f32_16x16x32_bf16 v[52:55], a[72:75], a[8:11], v[52:55]
ds_read_b64_tr_b16 a[116:117], v20 offset:43008
v_mfma_f32_16x16x32_bf16 v[68:71], a[72:75], a[16:19], v[68:71]
s_xor_b32 m0, s77, 99328
ds_read_b64_tr_b16 a[118:119], v20 offset:43264
v_mfma_f32_16x16x32_bf16 v[68:71], a[76:79], a[20:23], v[68:71]
s_xor_b32 s64, s71, 2654208
s_xor_b32 s68, s66, 8192
v_mfma_f32_16x16x32_bf16 v[84:87], a[76:79], a[28:31], v[84:87]
s_mov_b64 exec, 1
buffer_atomic_add a251, v1, s[52:55], s68 offen offset:0 sc1
s_mov_b64 exec, -1
v_mfma_f32_16x16x32_bf16 v[84:87], a[72:75], a[24:27], v[84:87]
buffer_load_dwordx4 v14, s[56:59], s64 offen lds
v_mfma_f32_16x16x32_bf16 v[148:151], a[80:83], a[24:27], v[148:151]
ds_read_b64_tr_b16 a[72:73], v19 offset:32768
v_mfma_f32_16x16x32_bf16 v[148:151], a[84:87], a[28:31], v[148:151]
ds_read_b64_tr_b16 a[74:75], v19 offset:33024
v_mfma_f32_16x16x32_bf16 v[132:135], a[84:87], a[20:23], v[132:135]
s_add_u32 s65, s79, 1024
ds_read_b64_tr_b16 a[76:77], v19 offset:34816
v_mfma_f32_16x16x32_bf16 v[132:135], a[80:83], a[16:19], v[132:135]
buffer_store_dwordx4 a[164:167], v16, s[44:47], s65 offen sc1
v_mfma_f32_16x16x32_bf16 v[116:119], a[80:83], a[8:11], v[116:119]
ds_read_b64_tr_b16 a[78:79], v19 offset:35072
v_mfma_f32_16x16x32_bf16 v[116:119], a[84:87], a[12:15], v[116:119]
v_mfma_f32_16x16x32_bf16 v[100:103], a[84:87], a[4:7], v[100:103]
s_add_u32 m0, s78, 118784
v_mfma_f32_16x16x32_bf16 v[100:103], a[80:83], a[0:3], v[100:103]
s_waitcnt lgkmcnt(4)
s_add_u32 s64, s75, 1968128
ds_read_b64_tr_b16 a[80:81], v20 offset:32768
v_mfma_f32_16x16x32_bf16 v[184:187], a[88:91], a[32:35], v[184:187]
buffer_load_dwordx4 v23, s[60:63], s64 offen lds
v_mfma_f32_16x16x32_bf16 v[184:187], a[92:95], a[36:39], v[184:187]
ds_read_b64_tr_b16 a[82:83], v20 offset:33024
v_mfma_f32_16x16x32_bf16 v[192:195], a[92:95], a[44:47], v[192:195]
ds_read_b64_tr_b16 a[84:85], v20 offset:34816
v_mfma_f32_16x16x32_bf16 v[192:195], a[88:91], a[40:43], v[192:195]
ds_read_b64_tr_b16 a[86:87], v20 offset:35072
v_mfma_f32_16x16x32_bf16 v[200:203], a[88:91], a[48:51], v[200:203]
v_mfma_f32_16x16x32_bf16 v[200:203], a[92:95], a[52:55], v[200:203]
v_mfma_f32_16x16x32_bf16 v[208:211], a[92:95], a[60:63], v[208:211]
v_mfma_f32_16x16x32_bf16 v[208:211], a[88:91], a[56:59], v[208:211]
ds_read_b64_tr_b16 a[88:89], v4 offset:32768
v_mfma_f32_16x16x32_bf16 v[212:215], a[96:99], a[56:59], v[212:215]
s_xor_b32 m0, s77, 100352
ds_read_b64_tr_b16 a[90:91], v4 offset:33792
v_mfma_f32_16x16x32_bf16 v[212:215], a[100:103], a[60:63], v[212:215]
s_xor_b32 s64, s71, 2686976
ds_read_b64_tr_b16 a[92:93], v4 offset:40960
v_mfma_f32_16x16x32_bf16 v[204:207], a[100:103], a[52:55], v[204:207]
buffer_load_dwordx4 v15, s[56:59], s64 offen lds
v_mfma_f32_16x16x32_bf16 v[204:207], a[96:99], a[48:51], v[204:207]
ds_read_b64_tr_b16 a[94:95], v4 offset:41984
v_mfma_f32_16x16x32_bf16 v[196:199], a[96:99], a[40:43], v[196:199]
v_mfma_f32_16x16x32_bf16 v[196:199], a[100:103], a[44:47], v[196:199]
v_mfma_f32_16x16x32_bf16 v[188:191], a[100:103], a[36:39], v[188:191]
v_mfma_f32_16x16x32_bf16 v[188:191], a[96:99], a[32:35], v[188:191]
ds_read_b64_tr_b16 a[96:97], v5 offset:32768
v_mfma_f32_16x16x32_bf16 v[216:219], a[32:35], a[104:107], v[216:219]
ds_read_b64_tr_b16 a[98:99], v5 offset:33792
v_mfma_f32_16x16x32_bf16 v[216:219], a[36:39], a[108:111], v[216:219]
s_add_u32 m0, s78, 122880
ds_read_b64_tr_b16 a[100:101], v5 offset:40960
v_mfma_f32_16x16x32_bf16 v[224:227], a[44:47], a[108:111], v[224:227]
s_add_u32 s64, s75, 1970176
ds_read_b64_tr_b16 a[102:103], v5 offset:41984
v_mfma_f32_16x16x32_bf16 v[224:227], a[40:43], a[104:107], v[224:227]
buffer_load_dwordx4 v23, s[60:63], s64 offen lds
v_mfma_f32_16x16x32_bf16 v[232:235], a[48:51], a[104:107], v[232:235]
v_mfma_f32_16x16x32_bf16 v[232:235], a[52:55], a[108:111], v[232:235]
v_mfma_f32_16x16x32_bf16 v[240:243], a[60:63], a[108:111], v[240:243]
v_mfma_f32_16x16x32_bf16 v[240:243], a[56:59], a[104:107], v[240:243]
ds_read_b64_tr_b16 a[104:105], v6 offset:32768
v_mfma_f32_16x16x32_bf16 v[244:247], a[56:59], a[112:115], v[244:247]
ds_read_b64_tr_b16 a[106:107], v6 offset:33792
v_mfma_f32_16x16x32_bf16 v[244:247], a[60:63], a[116:119], v[244:247]
ds_read_b64_tr_b16 a[108:109], v6 offset:40960
v_subrev_u32 v19, 0x8000, v19
v_mfma_f32_16x16x32_bf16 v[236:239], a[52:55], a[116:119], v[236:239]
s_xor_b32 m0, s77, 101376
ds_read_b64_tr_b16 a[110:111], v6 offset:41984
v_mfma_f32_16x16x32_bf16 v[236:239], a[48:51], a[112:115], v[236:239]
s_xor_b32 s64, s71, 2719744
v_mfma_f32_16x16x32_bf16 v[228:231], a[40:43], a[112:115], v[228:231]
buffer_load_dwordx4 v15, s[56:59], s64 offen lds
v_mfma_f32_16x16x32_bf16 v[228:231], a[44:47], a[116:119], v[228:231]
v_mfma_f32_16x16x32_bf16 v[220:223], a[36:39], a[116:119], v[220:223]
v_mfma_f32_16x16x32_bf16 v[220:223], a[32:35], a[112:115], v[220:223]
s_waitcnt lgkmcnt(4)
ds_read_b64_tr_b16 a[112:113], v7 offset:32768
v_mfma_f32_16x16x32_bf16 v[152:155], a[72:75], a[32:35], v[152:155]
ds_read_b64_tr_b16 a[114:115], v7 offset:33792
v_mfma_f32_16x16x32_bf16 v[152:155], a[76:79], a[36:39], v[152:155]
ds_read_b64_tr_b16 a[116:117], v7 offset:40960
v_subrev_u32 v20, 0x8000, v20
v_mfma_f32_16x16x32_bf16 v[160:163], a[76:79], a[44:47], v[160:163]
ds_read_b64_tr_b16 a[118:119], v7 offset:41984
v_mfma_f32_16x16x32_bf16 v[160:163], a[72:75], a[40:43], v[160:163]
v_mfma_f32_16x16x32_bf16 v[168:171], a[72:75], a[48:51], v[168:171]
v_mfma_f32_16x16x32_bf16 v[168:171], a[76:79], a[52:55], v[168:171]
v_mfma_f32_16x16x32_bf16 v[176:179], a[76:79], a[60:63], v[176:179]
s_xor_b32 m0, s84, 32768
v_mfma_f32_16x16x32_bf16 v[176:179], a[72:75], a[56:59], v[176:179]
s_xor_b32 s64, s72, 640
ds_read_b64_tr_b16 a[72:73], v8 offset:32768
v_mfma_f32_16x16x32_bf16 v[180:183], a[80:83], a[56:59], v[180:183]
s_add_u32 s65, s79, 18432
buffer_load_dwordx4 v12, s[48:51], s64 offen lds
v_mfma_f32_16x16x32_bf16 v[180:183], a[84:87], a[60:63], v[180:183]
buffer_store_dwordx4 a[168:171], v16, s[44:47], s65 offen sc1
v_mfma_f32_16x16x32_bf16 v[172:175], a[84:87], a[52:55], v[172:175]
ds_read_b64_tr_b16 a[74:75], v8 offset:33792
v_subrev_u32 v4, 0x8000, v4
v_mfma_f32_16x16x32_bf16 v[172:175], a[80:83], a[48:51], v[172:175]
s_xor_b32 m0, s84, 33792
ds_read_b64_tr_b16 a[76:77], v8 offset:40960
v_mfma_f32_16x16x32_bf16 v[164:167], a[80:83], a[40:43], v[164:167]
s_xor_b32 s64, s72, 17024
ds_read_b64_tr_b16 a[78:79], v8 offset:41984
v_mfma_f32_16x16x32_bf16 v[164:167], a[84:87], a[44:47], v[164:167]
buffer_load_dwordx4 v13, s[48:51], s64 offen lds
v_mfma_f32_16x16x32_bf16 v[156:159], a[84:87], a[36:39], v[156:159]
v_mfma_f32_16x16x32_bf16 v[156:159], a[80:83], a[32:35], v[156:159]
ds_read_b64_tr_b16 a[80:81], v9 offset:32768
v_mfma_f32_16x16x32_bf16 v[24:27], a[88:91], a[32:35], v[24:27]
s_xor_b32 m0, s84, 34816
ds_read_b64_tr_b16 a[82:83], v9 offset:33792
v_mfma_f32_16x16x32_bf16 v[24:27], a[92:95], a[36:39], v[24:27]
s_xor_b32 s64, s72, 131712
ds_read_b64_tr_b16 a[84:85], v9 offset:40960
v_subrev_u32 v5, 0x8000, v5
v_mfma_f32_16x16x32_bf16 v[40:43], a[92:95], a[44:47], v[40:43]
buffer_load_dwordx4 v12, s[48:51], s64 offen lds
v_mfma_f32_16x16x32_bf16 v[40:43], a[88:91], a[40:43], v[40:43]
ds_read_b64_tr_b16 a[86:87], v9 offset:41984
v_mfma_f32_16x16x32_bf16 v[56:59], a[88:91], a[48:51], v[56:59]
v_mfma_f32_16x16x32_bf16 v[56:59], a[92:95], a[52:55], v[56:59]
s_xor_b32 m0, s84, 35840
v_mfma_f32_16x16x32_bf16 v[72:75], a[92:95], a[60:63], v[72:75]
s_waitcnt vmcnt(13)
s_xor_b32 s64, s72, 148096
ds_read_b128 a[0:3], v2 offset:0
v_mfma_f32_16x16x32_bf16 v[72:75], a[88:91], a[56:59], v[72:75]
buffer_load_dwordx4 v13, s[48:51], s64 offen lds
v_mfma_f32_16x16x32_bf16 v[136:139], a[96:99], a[56:59], v[136:139]
ds_read_b128 a[4:7], v3 offset:0
v_mfma_f32_16x16x32_bf16 v[136:139], a[100:103], a[60:63], v[136:139]
ds_read_b128 a[8:11], v2 offset:2048
v_subrev_u32 v6, 0x8000, v6
v_mfma_f32_16x16x32_bf16 v[120:123], a[100:103], a[52:55], v[120:123]
s_xor_b32 m0, s84, 36864
ds_read_b128 a[12:15], v3 offset:2048
v_mfma_f32_16x16x32_bf16 v[120:123], a[96:99], a[48:51], v[120:123]
s_xor_b32 s64, s73, 640
ds_read_b128 a[16:19], v2 offset:4096
v_mfma_f32_16x16x32_bf16 v[104:107], a[96:99], a[40:43], v[104:107]
buffer_load_dwordx4 v12, s[48:51], s64 offen lds
v_mfma_f32_16x16x32_bf16 v[104:107], a[100:103], a[44:47], v[104:107]
ds_read_b128 a[20:23], v3 offset:4096
v_mfma_f32_16x16x32_bf16 v[88:91], a[100:103], a[36:39], v[88:91]
ds_read_b128 a[24:27], v2 offset:6144
v_mfma_f32_16x16x32_bf16 v[88:91], a[96:99], a[32:35], v[88:91]
s_waitcnt lgkmcnt(7)
s_xor_b32 m0, s84, 37888
ds_read_b128 a[28:31], v3 offset:6144
v_mfma_f32_16x16x32_bf16 v[28:31], a[104:107], a[32:35], v[28:31]
s_xor_b32 s64, s73, 17024
ds_read_b64_tr_b16 a[88:89], v10 offset:32768
v_mfma_f32_16x16x32_bf16 v[28:31], a[108:111], a[36:39], v[28:31]
buffer_load_dwordx4 v13, s[48:51], s64 offen lds
v_mfma_f32_16x16x32_bf16 v[44:47], a[108:111], a[44:47], v[44:47]
ds_read_b64_tr_b16 a[90:91], v10 offset:33792
v_subrev_u32 v7, 0x8000, v7
v_mfma_f32_16x16x32_bf16 v[44:47], a[104:107], a[40:43], v[44:47]
ds_read_b64_tr_b16 a[92:93], v10 offset:40960
v_mfma_f32_16x16x32_bf16 v[60:63], a[104:107], a[48:51], v[60:63]
s_xor_b32 m0, s84, 38912
ds_read_b64_tr_b16 a[94:95], v10 offset:41984
v_mfma_f32_16x16x32_bf16 v[60:63], a[108:111], a[52:55], v[60:63]
s_xor_b32 s64, s73, 131712
ds_read_b64_tr_b16 a[96:97], v11 offset:32768
v_mfma_f32_16x16x32_bf16 v[76:79], a[108:111], a[60:63], v[76:79]
buffer_load_dwordx4 v12, s[48:51], s64 offen lds
v_mfma_f32_16x16x32_bf16 v[76:79], a[104:107], a[56:59], v[76:79]
ds_read_b64_tr_b16 a[98:99], v11 offset:33792
v_mfma_f32_16x16x32_bf16 v[140:143], a[112:115], a[56:59], v[140:143]
ds_read_b64_tr_b16 a[100:101], v11 offset:40960
v_mfma_f32_16x16x32_bf16 v[140:143], a[116:119], a[60:63], v[140:143]
s_xor_b32 m0, s84, 39936
ds_read_b64_tr_b16 a[102:103], v11 offset:41984
v_subrev_u32 v8, 0x8000, v8
v_mfma_f32_16x16x32_bf16 v[124:127], a[116:119], a[52:55], v[124:127]
s_xor_b32 s64, s73, 148096
v_mfma_f32_16x16x32_bf16 v[124:127], a[112:115], a[48:51], v[124:127]
buffer_load_dwordx4 v13, s[48:51], s64 offen lds
v_mfma_f32_16x16x32_bf16 v[108:111], a[112:115], a[40:43], v[108:111]
v_mfma_f32_16x16x32_bf16 v[108:111], a[116:119], a[44:47], v[108:111]
v_mfma_f32_16x16x32_bf16 v[92:95], a[116:119], a[36:39], v[92:95]
v_subrev_u32 v9, 0x8000, v9
v_subrev_u32 v10, 0x8000, v10
v_mfma_f32_16x16x32_bf16 v[92:95], a[112:115], a[32:35], v[92:95]
v_subrev_u32 v11, 0x8000, v11
v_mfma_f32_16x16x32_bf16 v[32:35], a[72:75], a[32:35], v[32:35]
v_mfma_f32_16x16x32_bf16 v[32:35], a[76:79], a[36:39], v[32:35]
v_mfma_f32_16x16x32_bf16 v[48:51], a[76:79], a[44:47], v[48:51]
s_waitcnt lgkmcnt(0)
s_barrier
v_mfma_f32_16x16x32_bf16 v[48:51], a[72:75], a[40:43], v[48:51]
s_xor_b32 m0, s77, 131072
ds_read_b64_tr_b16 a[104:105], v19 offset:4096
v_mfma_f32_16x16x32_bf16 v[64:67], a[72:75], a[48:51], v[64:67]
s_xor_b32 s64, s71, 3145728
ds_read_b64_tr_b16 a[106:107], v19 offset:4352
v_mfma_f32_16x16x32_bf16 v[64:67], a[76:79], a[52:55], v[64:67]
s_add_u32 s65, s79, 6144
buffer_load_dwordx4 v14, s[56:59], s64 offen lds
v_mfma_f32_16x16x32_bf16 v[80:83], a[76:79], a[60:63], v[80:83]
buffer_store_dwordx4 a[172:175], v16, s[44:47], s65 offen sc1
v_mfma_f32_16x16x32_bf16 v[80:83], a[72:75], a[56:59], v[80:83]
ds_read_b64_tr_b16 a[108:109], v19 offset:6144
v_mfma_f32_16x16x32_bf16 v[144:147], a[80:83], a[56:59], v[144:147]
ds_read_b64_tr_b16 a[110:111], v19 offset:6400
v_mfma_f32_16x16x32_bf16 v[144:147], a[84:87], a[60:63], v[144:147]
ds_read_b64_tr_b16 a[112:113], v20 offset:4096
v_mfma_f32_16x16x32_bf16 v[128:131], a[84:87], a[52:55], v[128:131]
ds_read_b64_tr_b16 a[114:115], v20 offset:4352
v_mfma_f32_16x16x32_bf16 v[128:131], a[80:83], a[48:51], v[128:131]
ds_read_b64_tr_b16 a[116:117], v20 offset:6144
v_mfma_f32_16x16x32_bf16 v[112:115], a[80:83], a[40:43], v[112:115]
s_add_u32 m0, s78, 147456
ds_read_b64_tr_b16 a[118:119], v20 offset:6400
v_mfma_f32_16x16x32_bf16 v[112:115], a[84:87], a[44:47], v[112:115]
s_add_u32 s64, s75, 2359296
ds_read_b64_tr_b16 a[72:73], v19 offset:8192
v_mfma_f32_16x16x32_bf16 v[96:99], a[84:87], a[36:39], v[96:99]
s_branch L_po8
L_pg8:
s_branch L_pg12
L_po8:
buffer_load_dwordx4 v23, s[60:63], s64 offen lds
v_mfma_f32_16x16x32_bf16 v[96:99], a[80:83], a[32:35], v[96:99]
ds_read_b64_tr_b16 a[74:75], v19 offset:8448
v_mfma_f32_16x16x32_bf16 v[36:39], a[88:91], a[32:35], v[36:39]
ds_read_b64_tr_b16 a[76:77], v19 offset:10240
v_mfma_f32_16x16x32_bf16 v[36:39], a[92:95], a[36:39], v[36:39]
ds_read_b64_tr_b16 a[78:79], v19 offset:10496
v_mfma_f32_16x16x32_bf16 v[52:55], a[92:95], a[44:47], v[52:55]
ds_read_b64_tr_b16 a[80:81], v20 offset:8192
v_mfma_f32_16x16x32_bf16 v[52:55], a[88:91], a[40:43], v[52:55]
ds_read_b64_tr_b16 a[82:83], v20 offset:8448
v_mfma_f32_16x16x32_bf16 v[68:71], a[88:91], a[48:51], v[68:71]
s_xor_b32 m0, s77, 132096
ds_read_b64_tr_b16 a[84:85], v20 offset:10240
v_mfma_f32_16x16x32_bf16 v[68:71], a[92:95], a[52:55], v[68:71]
s_xor_b32 s64, s71, 3178496
s_xor_b32 s68, s66, 12288
ds_read_b64_tr_b16 a[86:87], v20 offset:10496
v_mfma_f32_16x16x32_bf16 v[84:87], a[92:95], a[60:63], v[84:87]
s_mov_b64 exec, 1
buffer_atomic_add a251, v1, s[52:55], s68 offen offset:0 sc1
s_mov_b64 exec, -1
v_mfma_f32_16x16x32_bf16 v[84:87], a[88:91], a[56:59], v[84:87]
buffer_load_dwordx4 v14, s[56:59], s64 offen lds
v_mfma_f32_16x16x32_bf16 v[148:151], a[96:99], a[56:59], v[148:151]
ds_read_b64_tr_b16 a[88:89], v19 offset:0
v_mfma_f32_16x16x32_bf16 v[148:151], a[100:103], a[60:63], v[148:151]
ds_read_b64_tr_b16 a[90:91], v19 offset:256
v_mfma_f32_16x16x32_bf16 v[132:135], a[100:103], a[52:55], v[132:135]
ds_read_b64_tr_b16 a[92:93], v19 offset:2048
v_mfma_f32_16x16x32_bf16 v[132:135], a[96:99], a[48:51], v[132:135]
ds_read_b64_tr_b16 a[94:95], v19 offset:2304
v_mfma_f32_16x16x32_bf16 v[116:119], a[96:99], a[40:43], v[116:119]
v_mfma_f32_16x16x32_bf16 v[116:119], a[100:103], a[44:47], v[116:119]
v_mfma_f32_16x16x32_bf16 v[100:103], a[100:103], a[36:39], v[100:103]
s_add_u32 m0, s78, 151552
v_mfma_f32_16x16x32_bf16 v[100:103], a[96:99], a[32:35], v[100:103]
s_waitcnt lgkmcnt(4)
s_add_u32 s64, s75, 2361344
ds_read_b64_tr_b16 a[96:97], v20 offset:0
v_mfma_f32_16x16x32_bf16 v[184:187], a[104:107], a[0:3], v[184:187]
s_mov_b32 s36, s20
buffer_load_dwordx4 v23, s[60:63], s64 offen lds
v_mfma_f32_16x16x32_bf16 v[184:187], a[108:111], a[4:7], v[184:187]
s_mov_b32 s37, s21
ds_read_b64_tr_b16 a[98:99], v20 offset:256
v_mfma_f32_16x16x32_bf16 v[192:195], a[108:111], a[12:15], v[192:195]
s_mov_b32 s38, 2097152
ds_read_b64_tr_b16 a[100:101], v20 offset:2048
v_mfma_f32_16x16x32_bf16 v[192:195], a[104:107], a[8:11], v[192:195]
s_mov_b32 s40, s14
ds_read_b64_tr_b16 a[102:103], v20 offset:2304
v_mfma_f32_16x16x32_bf16 v[200:203], a[104:107], a[16:19], v[200:203]
s_mov_b32 s41, s15
v_mfma_f32_16x16x32_bf16 v[200:203], a[108:111], a[20:23], v[200:203]
s_mov_b32 s42, 8388608
v_mfma_f32_16x16x32_bf16 v[208:211], a[108:111], a[28:31], v[208:211]
v_mfma_f32_16x16x32_bf16 v[208:211], a[104:107], a[24:27], v[208:211]
ds_read_b64_tr_b16 a[104:105], v4 offset:0
v_mfma_f32_16x16x32_bf16 v[212:215], a[112:115], a[24:27], v[212:215]
s_xor_b32 m0, s77, 133120
ds_read_b64_tr_b16 a[106:107], v4 offset:1024
v_mfma_f32_16x16x32_bf16 v[212:215], a[116:119], a[28:31], v[212:215]
s_xor_b32 s64, s71, 3211264
ds_read_b64_tr_b16 a[108:109], v4 offset:8192
v_mfma_f32_16x16x32_bf16 v[204:207], a[116:119], a[20:23], v[204:207]
buffer_load_dwordx4 v15, s[56:59], s64 offen lds
v_mfma_f32_16x16x32_bf16 v[204:207], a[112:115], a[16:19], v[204:207]
ds_read_b64_tr_b16 a[110:111], v4 offset:9216
v_mfma_f32_16x16x32_bf16 v[196:199], a[112:115], a[8:11], v[196:199]
v_mfma_f32_16x16x32_bf16 v[196:199], a[116:119], a[12:15], v[196:199]
v_mfma_f32_16x16x32_bf16 v[188:191], a[116:119], a[4:7], v[188:191]
v_mfma_f32_16x16x32_bf16 v[188:191], a[112:115], a[0:3], v[188:191]
ds_read_b64_tr_b16 a[112:113], v5 offset:0
v_mfma_f32_16x16x32_bf16 v[216:219], a[0:3], a[72:75], v[216:219]
ds_read_b64_tr_b16 a[114:115], v5 offset:1024
v_mfma_f32_16x16x32_bf16 v[216:219], a[4:7], a[76:79], v[216:219]
s_add_u32 m0, s78, 155648
s_add_u32 s65, s79, 2048
ds_read_b64_tr_b16 a[116:117], v5 offset:8192
v_mfma_f32_16x16x32_bf16 v[224:227], a[12:15], a[76:79], v[224:227]
s_add_u32 s64, s75, 2363392
buffer_store_dwordx4 a[176:179], v16, s[44:47], s65 offen sc1
v_mfma_f32_16x16x32_bf16 v[224:227], a[8:11], a[72:75], v[224:227]
buffer_load_dwordx4 v23, s[60:63], s64 offen lds
v_mfma_f32_16x16x32_bf16 v[232:235], a[16:19], a[72:75], v[232:235]
ds_read_b64_tr_b16 a[118:119], v5 offset:9216
v_mfma_f32_16x16x32_bf16 v[232:235], a[20:23], a[76:79], v[232:235]
v_mfma_f32_16x16x32_bf16 v[240:243], a[28:31], a[76:79], v[240:243]
v_mfma_f32_16x16x32_bf16 v[240:243], a[24:27], a[72:75], v[240:243]
ds_read_b64_tr_b16 a[72:73], v6 offset:0
v_mfma_f32_16x16x32_bf16 v[244:247], a[24:27], a[80:83], v[244:247]
ds_read_b64_tr_b16 a[74:75], v6 offset:1024
v_mfma_f32_16x16x32_bf16 v[244:247], a[28:31], a[84:87], v[244:247]
ds_read_b64_tr_b16 a[76:77], v6 offset:8192
v_mfma_f32_16x16x32_bf16 v[236:239], a[20:23], a[84:87], v[236:239]
s_xor_b32 m0, s77, 134144
ds_read_b64_tr_b16 a[78:79], v6 offset:9216
v_mfma_f32_16x16x32_bf16 v[236:239], a[16:19], a[80:83], v[236:239]
s_xor_b32 s64, s71, 3244032
v_mfma_f32_16x16x32_bf16 v[228:231], a[8:11], a[80:83], v[228:231]
buffer_load_dwordx4 v15, s[56:59], s64 offen lds
v_mfma_f32_16x16x32_bf16 v[228:231], a[12:15], a[84:87], v[228:231]
v_mfma_f32_16x16x32_bf16 v[220:223], a[4:7], a[84:87], v[220:223]
v_mfma_f32_16x16x32_bf16 v[220:223], a[0:3], a[80:83], v[220:223]
s_waitcnt lgkmcnt(4)
ds_read_b64_tr_b16 a[80:81], v7 offset:0
v_mfma_f32_16x16x32_bf16 v[152:155], a[88:91], a[0:3], v[152:155]
ds_read_b64_tr_b16 a[82:83], v7 offset:1024
v_mfma_f32_16x16x32_bf16 v[152:155], a[92:95], a[4:7], v[152:155]
ds_read_b64_tr_b16 a[84:85], v7 offset:8192
v_mfma_f32_16x16x32_bf16 v[160:163], a[92:95], a[12:15], v[160:163]
ds_read_b64_tr_b16 a[86:87], v7 offset:9216
v_mfma_f32_16x16x32_bf16 v[160:163], a[88:91], a[8:11], v[160:163]
v_mfma_f32_16x16x32_bf16 v[168:171], a[88:91], a[16:19], v[168:171]
v_mfma_f32_16x16x32_bf16 v[168:171], a[92:95], a[20:23], v[168:171]
v_mfma_f32_16x16x32_bf16 v[176:179], a[92:95], a[28:31], v[176:179]
s_xor_b32 m0, s84, 0
v_mfma_f32_16x16x32_bf16 v[176:179], a[88:91], a[24:27], v[176:179]
s_xor_b32 s64, s72, 768
ds_read_b64_tr_b16 a[88:89], v8 offset:0
v_mfma_f32_16x16x32_bf16 v[180:183], a[96:99], a[24:27], v[180:183]
buffer_load_dwordx4 v12, s[48:51], s64 offen lds
v_mfma_f32_16x16x32_bf16 v[180:183], a[100:103], a[28:31], v[180:183]
ds_read_b64_tr_b16 a[90:91], v8 offset:1024
v_mfma_f32_16x16x32_bf16 v[172:175], a[100:103], a[20:23], v[172:175]
ds_read_b64_tr_b16 a[92:93], v8 offset:8192
v_mfma_f32_16x16x32_bf16 v[172:175], a[96:99], a[16:19], v[172:175]
s_xor_b32 m0, s84, 1024
ds_read_b64_tr_b16 a[94:95], v8 offset:9216
v_mfma_f32_16x16x32_bf16 v[164:167], a[96:99], a[8:11], v[164:167]
s_xor_b32 s64, s72, 17152
v_mfma_f32_16x16x32_bf16 v[164:167], a[100:103], a[12:15], v[164:167]
buffer_load_dwordx4 v13, s[48:51], s64 offen lds
v_mfma_f32_16x16x32_bf16 v[156:159], a[100:103], a[4:7], v[156:159]
v_mfma_f32_16x16x32_bf16 v[156:159], a[96:99], a[0:3], v[156:159]
ds_read_b64_tr_b16 a[96:97], v9 offset:0
v_mfma_f32_16x16x32_bf16 v[24:27], a[104:107], a[0:3], v[24:27]
s_xor_b32 m0, s84, 2048
ds_read_b64_tr_b16 a[98:99], v9 offset:1024
v_mfma_f32_16x16x32_bf16 v[24:27], a[108:111], a[4:7], v[24:27]
s_xor_b32 s64, s72, 131840
ds_read_b64_tr_b16 a[100:101], v9 offset:8192
v_mfma_f32_16x16x32_bf16 v[40:43], a[108:111], a[12:15], v[40:43]
buffer_load_dwordx4 v12, s[48:51], s64 offen lds
v_mfma_f32_16x16x32_bf16 v[40:43], a[104:107], a[8:11], v[40:43]
ds_read_b64_tr_b16 a[102:103], v9 offset:9216
v_mfma_f32_16x16x32_bf16 v[56:59], a[104:107], a[16:19], v[56:59]
v_mfma_f32_16x16x32_bf16 v[56:59], a[108:111], a[20:23], v[56:59]
s_xor_b32 m0, s84, 3072
v_mfma_f32_16x16x32_bf16 v[72:75], a[108:111], a[28:31], v[72:75]
s_waitcnt vmcnt(13)
s_xor_b32 s64, s72, 148224
ds_read_b128 a[32:35], v2 offset:32768
v_mfma_f32_16x16x32_bf16 v[72:75], a[104:107], a[24:27], v[72:75]
buffer_load_dwordx4 v13, s[48:51], s64 offen lds
v_mfma_f32_16x16x32_bf16 v[136:139], a[112:115], a[24:27], v[136:139]
ds_read_b128 a[36:39], v3 offset:32768
v_mfma_f32_16x16x32_bf16 v[136:139], a[116:119], a[28:31], v[136:139]
ds_read_b128 a[40:43], v2 offset:34816
v_mfma_f32_16x16x32_bf16 v[120:123], a[116:119], a[20:23], v[120:123]
s_xor_b32 m0, s84, 4096
ds_read_b128 a[44:47], v3 offset:34816
v_mfma_f32_16x16x32_bf16 v[120:123], a[112:115], a[16:19], v[120:123]
s_xor_b32 s64, s73, 768
ds_read_b128 a[48:51], v2 offset:36864
v_mfma_f32_16x16x32_bf16 v[104:107], a[112:115], a[8:11], v[104:107]
buffer_load_dwordx4 v12, s[48:51], s64 offen lds
v_mfma_f32_16x16x32_bf16 v[104:107], a[116:119], a[12:15], v[104:107]
s_add_u32 s65, s79, 19456
ds_read_b128 a[52:55], v3 offset:36864
v_mfma_f32_16x16x32_bf16 v[88:91], a[116:119], a[4:7], v[88:91]
buffer_store_dwordx4 a[180:183], v16, s[44:47], s65 offen sc1
v_mfma_f32_16x16x32_bf16 v[88:91], a[112:115], a[0:3], v[88:91]
s_waitcnt lgkmcnt(6)
s_xor_b32 m0, s84, 5120
ds_read_b128 a[56:59], v2 offset:38912
v_mfma_f32_16x16x32_bf16 v[28:31], a[72:75], a[0:3], v[28:31]
s_xor_b32 s64, s73, 17152
ds_read_b128 a[60:63], v3 offset:38912
v_mfma_f32_16x16x32_bf16 v[28:31], a[76:79], a[4:7], v[28:31]
buffer_load_dwordx4 v13, s[48:51], s64 offen lds
v_mfma_f32_16x16x32_bf16 v[44:47], a[76:79], a[12:15], v[44:47]
ds_read_b64_tr_b16 a[104:105], v10 offset:0
v_mfma_f32_16x16x32_bf16 v[44:47], a[72:75], a[8:11], v[44:47]
ds_read_b64_tr_b16 a[106:107], v10 offset:1024
v_mfma_f32_16x16x32_bf16 v[60:63], a[72:75], a[16:19], v[60:63]
s_xor_b32 m0, s84, 6144
ds_read_b64_tr_b16 a[108:109], v10 offset:8192
v_mfma_f32_16x16x32_bf16 v[60:63], a[76:79], a[20:23], v[60:63]
s_xor_b32 s64, s73, 131840
ds_read_b64_tr_b16 a[110:111], v10 offset:9216
v_mfma_f32_16x16x32_bf16 v[76:79], a[76:79], a[28:31], v[76:79]
buffer_load_dwordx4 v12, s[48:51], s64 offen lds
v_mfma_f32_16x16x32_bf16 v[76:79], a[72:75], a[24:27], v[76:79]
ds_read_b64_tr_b16 a[112:113], v11 offset:0
v_mfma_f32_16x16x32_bf16 v[140:143], a[80:83], a[24:27], v[140:143]
ds_read_b64_tr_b16 a[114:115], v11 offset:1024
v_mfma_f32_16x16x32_bf16 v[140:143], a[84:87], a[28:31], v[140:143]
s_xor_b32 m0, s84, 7168
ds_read_b64_tr_b16 a[116:117], v11 offset:8192
v_mfma_f32_16x16x32_bf16 v[124:127], a[84:87], a[20:23], v[124:127]
s_xor_b32 s64, s73, 148224
ds_read_b64_tr_b16 a[118:119], v11 offset:9216
v_mfma_f32_16x16x32_bf16 v[124:127], a[80:83], a[16:19], v[124:127]
buffer_load_dwordx4 v13, s[48:51], s64 offen lds
v_mfma_f32_16x16x32_bf16 v[108:111], a[80:83], a[8:11], v[108:111]
v_mfma_f32_16x16x32_bf16 v[108:111], a[84:87], a[12:15], v[108:111]
v_mfma_f32_16x16x32_bf16 v[92:95], a[84:87], a[4:7], v[92:95]
v_mfma_f32_16x16x32_bf16 v[92:95], a[80:83], a[0:3], v[92:95]
v_mfma_f32_16x16x32_bf16 v[32:35], a[88:91], a[0:3], v[32:35]
v_mfma_f32_16x16x32_bf16 v[32:35], a[92:95], a[4:7], v[32:35]
v_mfma_f32_16x16x32_bf16 v[48:51], a[92:95], a[12:15], v[48:51]
s_waitcnt lgkmcnt(0)
s_barrier
v_mfma_f32_16x16x32_bf16 v[48:51], a[88:91], a[8:11], v[48:51]
s_xor_b32 m0, s77, 65536
ds_read_b64_tr_b16 a[72:73], v19 offset:36864
v_mfma_f32_16x16x32_bf16 v[64:67], a[88:91], a[16:19], v[64:67]
s_xor_b32 s64, s71, 3670016
ds_read_b64_tr_b16 a[74:75], v19 offset:37120
v_mfma_f32_16x16x32_bf16 v[64:67], a[92:95], a[20:23], v[64:67]
buffer_load_dwordx4 v14, s[56:59], s64 offen lds
v_mfma_f32_16x16x32_bf16 v[80:83], a[92:95], a[28:31], v[80:83]
ds_read_b64_tr_b16 a[76:77], v19 offset:38912
v_mfma_f32_16x16x32_bf16 v[80:83], a[88:91], a[24:27], v[80:83]
ds_read_b64_tr_b16 a[78:79], v19 offset:39168
v_mfma_f32_16x16x32_bf16 v[144:147], a[96:99], a[24:27], v[144:147]
ds_read_b64_tr_b16 a[80:81], v20 offset:36864
v_mfma_f32_16x16x32_bf16 v[144:147], a[100:103], a[28:31], v[144:147]
ds_read_b64_tr_b16 a[82:83], v20 offset:37120
v_mfma_f32_16x16x32_bf16 v[128:131], a[100:103], a[20:23], v[128:131]
ds_read_b64_tr_b16 a[84:85], v20 offset:38912
v_mfma_f32_16x16x32_bf16 v[128:131], a[96:99], a[16:19], v[128:131]
ds_read_b64_tr_b16 a[86:87], v20 offset:39168
v_mfma_f32_16x16x32_bf16 v[112:115], a[96:99], a[8:11], v[112:115]
s_add_u32 m0, s78, 81920
ds_read_b64_tr_b16 a[88:89], v19 offset:40960
v_mfma_f32_16x16x32_bf16 v[112:115], a[100:103], a[12:15], v[112:115]
s_add_u32 s64, s75, 2752512
ds_read_b64_tr_b16 a[90:91], v19 offset:41216
v_mfma_f32_16x16x32_bf16 v[96:99], a[100:103], a[4:7], v[96:99]
buffer_load_dwordx4 v23, s[60:63], s64 offen lds
v_mfma_f32_16x16x32_bf16 v[96:99], a[96:99], a[0:3], v[96:99]
ds_read_b64_tr_b16 a[92:93], v19 offset:43008
v_mfma_f32_16x16x32_bf16 v[36:39], a[104:107], a[0:3], v[36:39]
ds_read_b64_tr_b16 a[94:95], v19 offset:43264
v_mfma_f32_16x16x32_bf16 v[36:39], a[108:111], a[4:7], v[36:39]
ds_read_b64_tr_b16 a[96:97], v20 offset:40960
v_mfma_f32_16x16x32_bf16 v[52:55], a[108:111], a[12:15], v[52:55]
ds_read_b64_tr_b16 a[98:99], v20 offset:41216
v_mfma_f32_16x16x32_bf16 v[52:55], a[104:107], a[8:11], v[52:55]
ds_read_b64_tr_b16 a[100:101], v20 offset:43008
v_mfma_f32_16x16x32_bf16 v[68:71], a[104:107], a[16:19], v[68:71]
ds_read_b64_tr_b16 a[102:103], v20 offset:43264
v_mfma_f32_16x16x32_bf16 v[68:71], a[108:111], a[20:23], v[68:71]
s_xor_b32 m0, s77, 66560
v_mfma_f32_16x16x32_bf16 v[84:87], a[108:111], a[28:31], v[84:87]
s_xor_b32 s64, s71, 3702784
v_mfma_f32_16x16x32_bf16 v[84:87], a[104:107], a[24:27], v[84:87]
buffer_load_dwordx4 v14, s[56:59], s64 offen lds
v_mfma_f32_16x16x32_bf16 v[148:151], a[112:115], a[24:27], v[148:151]
ds_read_b64_tr_b16 a[104:105], v19 offset:32768
v_mfma_f32_16x16x32_bf16 v[148:151], a[116:119], a[28:31], v[148:151]
ds_read_b64_tr_b16 a[106:107], v19 offset:33024
v_mfma_f32_16x16x32_bf16 v[132:135], a[116:119], a[20:23], v[132:135]
s_add_u32 s65, s79, 7168
ds_read_b64_tr_b16 a[108:109], v19 offset:34816
v_mfma_f32_16x16x32_bf16 v[132:135], a[112:115], a[16:19], v[132:135]
buffer_store_dwordx4 a[184:187], v16, s[44:47], s65 offen sc1
v_mfma_f32_16x16x32_bf16 v[116:119], a[112:115], a[8:11], v[116:119]
ds_read_b64_tr_b16 a[110:111], v19 offset:35072
v_mfma_f32_16x16x32_bf16 v[116:119], a[116:119], a[12:15], v[116:119]
v_mfma_f32_16x16x32_bf16 v[100:103], a[116:119], a[4:7], v[100:103]
s_add_u32 m0, s78, 86016
v_mfma_f32_16x16x32_bf16 v[100:103], a[112:115], a[0:3], v[100:103]
s_waitcnt lgkmcnt(4)
s_add_u32 s64, s75, 2754560
ds_read_b64_tr_b16 a[112:113], v20 offset:32768
v_mfma_f32_16x16x32_bf16 v[184:187], a[72:75], a[32:35], v[184:187]
buffer_load_dwordx4 v23, s[60:63], s64 offen lds
v_mfma_f32_16x16x32_bf16 v[184:187], a[76:79], a[36:39], v[184:187]
ds_read_b64_tr_b16 a[114:115], v20 offset:33024
v_and_b32 v22, 15, v0
v_mfma_f32_16x16x32_bf16 v[192:195], a[76:79], a[44:47], v[192:195]
ds_read_b64_tr_b16 a[116:117], v20 offset:34816
v_lshrrev_b32 v17, 4, v0
v_mfma_f32_16x16x32_bf16 v[192:195], a[72:75], a[40:43], v[192:195]
ds_read_b64_tr_b16 a[118:119], v20 offset:35072
v_lshlrev_b32 v17, 2, v17
v_mfma_f32_16x16x32_bf16 v[200:203], a[72:75], a[48:51], v[200:203]
v_sub_u32 v22, v22, v17
v_subrev_u32 v17, 0, v22
v_mfma_f32_16x16x32_bf16 v[200:203], a[76:79], a[52:55], v[200:203]
v_lshlrev_b32 v18, 31, v17
v_or_b32 v21, v17, v18
v_mfma_f32_16x16x32_bf16 v[208:211], a[76:79], a[60:63], v[208:211]
v_ashrrev_i32 v21, 31, v21
v_and_b32 v248, 0xff800000, v21
v_mfma_f32_16x16x32_bf16 v[208:211], a[72:75], a[56:59], v[208:211]
ds_read_b64_tr_b16 a[72:73], v4 offset:32768
v_not_b32 v17, v17
v_mfma_f32_16x16x32_bf16 v[212:215], a[80:83], a[56:59], v[212:215]
s_xor_b32 m0, s77, 67584
ds_read_b64_tr_b16 a[74:75], v4 offset:33792
v_or_b32 v21, v17, v18
v_mfma_f32_16x16x32_bf16 v[212:215], a[84:87], a[60:63], v[212:215]
s_xor_b32 s64, s71, 3735552
ds_read_b64_tr_b16 a[76:77], v4 offset:40960
v_ashrrev_i32 v21, 31, v21
v_mfma_f32_16x16x32_bf16 v[204:207], a[84:87], a[52:55], v[204:207]
buffer_load_dwordx4 v15, s[56:59], s64 offen lds
v_mfma_f32_16x16x32_bf16 v[204:207], a[80:83], a[48:51], v[204:207]
ds_read_b64_tr_b16 a[78:79], v4 offset:41984
v_and_b32 v252, 0xff800000, v21
v_mfma_f32_16x16x32_bf16 v[196:199], a[80:83], a[40:43], v[196:199]
v_subrev_u32 v17, 1, v22
v_lshlrev_b32 v18, 31, v17
v_mfma_f32_16x16x32_bf16 v[196:199], a[84:87], a[44:47], v[196:199]
v_or_b32 v21, v17, v18
v_ashrrev_i32 v21, 31, v21
v_mfma_f32_16x16x32_bf16 v[188:191], a[84:87], a[36:39], v[188:191]
v_and_b32 v249, 0xff800000, v21
v_not_b32 v17, v17
v_mfma_f32_16x16x32_bf16 v[188:191], a[80:83], a[32:35], v[188:191]
ds_read_b64_tr_b16 a[80:81], v5 offset:32768
v_or_b32 v21, v17, v18
v_mfma_f32_16x16x32_bf16 v[216:219], a[32:35], a[88:91], v[216:219]
ds_read_b64_tr_b16 a[82:83], v5 offset:33792
v_ashrrev_i32 v21, 31, v21
v_mfma_f32_16x16x32_bf16 v[216:219], a[36:39], a[92:95], v[216:219]
s_add_u32 m0, s78, 90112
ds_read_b64_tr_b16 a[84:85], v5 offset:40960
v_and_b32 v253, 0xff800000, v21
v_mfma_f32_16x16x32_bf16 v[224:227], a[44:47], a[92:95], v[224:227]
s_add_u32 s64, s75, 2756608
ds_read_b64_tr_b16 a[86:87], v5 offset:41984
v_subrev_u32 v17, 2, v22
v_mfma_f32_16x16x32_bf16 v[224:227], a[40:43], a[88:91], v[224:227]
buffer_load_dwordx4 v23, s[60:63], s64 offen lds
v_mfma_f32_16x16x32_bf16 v[232:235], a[48:51], a[88:91], v[232:235]
v_lshlrev_b32 v18, 31, v17
v_or_b32 v21, v17, v18
v_mfma_f32_16x16x32_bf16 v[232:235], a[52:55], a[92:95], v[232:235]
v_ashrrev_i32 v21, 31, v21
v_and_b32 v250, 0xff800000, v21
v_mfma_f32_16x16x32_bf16 v[240:243], a[60:63], a[92:95], v[240:243]
v_not_b32 v17, v17
v_or_b32 v21, v17, v18
v_mfma_f32_16x16x32_bf16 v[240:243], a[56:59], a[88:91], v[240:243]
ds_read_b64_tr_b16 a[88:89], v6 offset:32768
v_ashrrev_i32 v21, 31, v21
v_mfma_f32_16x16x32_bf16 v[244:247], a[56:59], a[96:99], v[244:247]
ds_read_b64_tr_b16 a[90:91], v6 offset:33792
v_and_b32 v254, 0xff800000, v21
v_mfma_f32_16x16x32_bf16 v[244:247], a[60:63], a[100:103], v[244:247]
ds_read_b64_tr_b16 a[92:93], v6 offset:40960
v_add_u32 v19, 0x8000, v19
v_mfma_f32_16x16x32_bf16 v[236:239], a[52:55], a[100:103], v[236:239]
s_xor_b32 m0, s77, 68608
ds_read_b64_tr_b16 a[94:95], v6 offset:41984
v_subrev_u32 v17, 3, v22
v_mfma_f32_16x16x32_bf16 v[236:239], a[48:51], a[96:99], v[236:239]
s_xor_b32 s64, s71, 3768320
v_lshlrev_b32 v18, 31, v17
v_or_b32 v21, v17, v18
v_mfma_f32_16x16x32_bf16 v[228:231], a[40:43], a[96:99], v[228:231]
buffer_load_dwordx4 v15, s[56:59], s64 offen lds
v_mfma_f32_16x16x32_bf16 v[228:231], a[44:47], a[100:103], v[228:231]
v_ashrrev_i32 v21, 31, v21
v_and_b32 v251, 0xff800000, v21
v_mfma_f32_16x16x32_bf16 v[220:223], a[36:39], a[100:103], v[220:223]
v_not_b32 v17, v17
v_or_b32 v21, v17, v18
v_mfma_f32_16x16x32_bf16 v[220:223], a[32:35], a[96:99], v[220:223]
s_waitcnt lgkmcnt(4)
ds_read_b64_tr_b16 a[96:97], v7 offset:32768
v_ashrrev_i32 v21, 31, v21
v_mfma_f32_16x16x32_bf16 v[152:155], a[104:107], a[32:35], v[152:155]
ds_read_b64_tr_b16 a[98:99], v7 offset:33792
v_and_b32 v255, 0xff800000, v21
v_mfma_f32_16x16x32_bf16 v[152:155], a[108:111], a[36:39], v[152:155]
s_lshl_b32 s69, s30, 4
ds_read_b64_tr_b16 a[100:101], v7 offset:40960
v_add_u32 v20, 0x8000, v20
v_mfma_f32_16x16x32_bf16 v[160:163], a[108:111], a[44:47], v[160:163]
ds_read_b64_tr_b16 a[102:103], v7 offset:41984
v_add_u32 v18, s69, v22
v_mfma_f32_16x16x32_bf16 v[160:163], a[104:107], a[40:43], v[160:163]
s_lshr_b32 s69, s30, 1
v_mfma_f32_16x16x32_bf16 v[168:171], a[104:107], a[48:51], v[168:171]
s_mul_i32 s69, s69, 18432
v_mfma_f32_16x16x32_bf16 v[168:171], a[108:111], a[52:55], v[168:171]
s_add_u32 s69, s69, s78
v_mfma_f32_16x16x32_bf16 v[176:179], a[108:111], a[60:63], v[176:179]
s_add_u32 s69, s69, 32768
s_xor_b32 m0, s84, 32768
v_mfma_f32_16x16x32_bf16 v[176:179], a[104:107], a[56:59], v[176:179]
s_xor_b32 s64, s72, 896
ds_read_b64_tr_b16 a[104:105], v8 offset:32768
v_add_u32 v17, s69, v16
v_mfma_f32_16x16x32_bf16 v[180:183], a[112:115], a[56:59], v[180:183]
s_add_u32 s65, s79, 3072
buffer_load_dwordx4 v12, s[48:51], s64 offen lds
v_mfma_f32_16x16x32_bf16 v[180:183], a[116:119], a[60:63], v[180:183]
buffer_store_dwordx4 a[188:191], v16, s[44:47], s65 offen sc1
v_mfma_f32_16x16x32_bf16 v[172:175], a[116:119], a[52:55], v[172:175]
ds_read_b64_tr_b16 a[106:107], v8 offset:33792
v_add_u32 v4, 0x8000, v4
v_mfma_f32_16x16x32_bf16 v[172:175], a[112:115], a[48:51], v[172:175]
s_xor_b32 m0, s84, 33792
ds_read_b64_tr_b16 a[108:109], v8 offset:40960
v_lshlrev_b32 v21, 5, v0
v_mfma_f32_16x16x32_bf16 v[164:167], a[112:115], a[40:43], v[164:167]
s_xor_b32 s64, s72, 17280
ds_read_b64_tr_b16 a[110:111], v8 offset:41984
v_mfma_f32_16x16x32_bf16 v[164:167], a[116:119], a[44:47], v[164:167]
buffer_load_dwordx4 v13, s[48:51], s64 offen lds
v_mfma_f32_16x16x32_bf16 v[156:159], a[116:119], a[36:39], v[156:159]
v_mfma_f32_16x16x32_bf16 v[156:159], a[112:115], a[32:35], v[156:159]
ds_read_b64_tr_b16 a[112:113], v9 offset:32768
v_mfma_f32_16x16x32_bf16 v[24:27], a[72:75], a[32:35], v[24:27]
s_xor_b32 m0, s84, 34816
ds_read_b64_tr_b16 a[114:115], v9 offset:33792
v_mfma_f32_16x16x32_bf16 v[24:27], a[76:79], a[36:39], v[24:27]
s_xor_b32 s64, s72, 131968
ds_read_b64_tr_b16 a[116:117], v9 offset:40960
v_add_u32 v5, 0x8000, v5
v_mfma_f32_16x16x32_bf16 v[40:43], a[76:79], a[44:47], v[40:43]
buffer_load_dwordx4 v12, s[48:51], s64 offen lds
v_mfma_f32_16x16x32_bf16 v[40:43], a[72:75], a[40:43], v[40:43]
ds_read_b64_tr_b16 a[118:119], v9 offset:41984
v_mfma_f32_16x16x32_bf16 v[56:59], a[72:75], a[48:51], v[56:59]
v_mfma_f32_16x16x32_bf16 v[56:59], a[76:79], a[52:55], v[56:59]
s_xor_b32 m0, s84, 35840
v_mfma_f32_16x16x32_bf16 v[72:75], a[76:79], a[60:63], v[72:75]
s_waitcnt vmcnt(12)
s_xor_b32 s64, s72, 148352
ds_read_b128 a[0:3], v2 offset:0
v_mfma_f32_16x16x32_bf16 v[72:75], a[72:75], a[56:59], v[72:75]
buffer_load_dwordx4 v13, s[48:51], s64 offen lds
v_mfma_f32_16x16x32_bf16 v[136:139], a[80:83], a[56:59], v[136:139]
ds_read_b128 a[4:7], v3 offset:0
v_mfma_f32_16x16x32_bf16 v[136:139], a[84:87], a[60:63], v[136:139]
ds_read_b128 a[8:11], v2 offset:2048
v_add_u32 v6, 0x8000, v6
v_mfma_f32_16x16x32_bf16 v[120:123], a[84:87], a[52:55], v[120:123]
s_xor_b32 m0, s84, 36864
ds_read_b128 a[12:15], v3 offset:2048
v_mfma_f32_16x16x32_bf16 v[120:123], a[80:83], a[48:51], v[120:123]
s_xor_b32 s64, s73, 896
ds_read_b128 a[16:19], v2 offset:4096
v_mfma_f32_16x16x32_bf16 v[104:107], a[80:83], a[40:43], v[104:107]
buffer_load_dwordx4 v12, s[48:51], s64 offen lds
v_mfma_f32_16x16x32_bf16 v[104:107], a[84:87], a[44:47], v[104:107]
ds_read_b128 a[20:23], v3 offset:4096
v_mfma_f32_16x16x32_bf16 v[88:91], a[84:87], a[36:39], v[88:91]
ds_read_b128 a[24:27], v2 offset:6144
v_mfma_f32_16x16x32_bf16 v[88:91], a[80:83], a[32:35], v[88:91]
s_waitcnt lgkmcnt(7)
s_xor_b32 m0, s84, 37888
ds_read_b128 a[28:31], v3 offset:6144
v_mfma_f32_16x16x32_bf16 v[28:31], a[88:91], a[32:35], v[28:31]
s_xor_b32 s64, s73, 17280
ds_read_b64_tr_b16 a[72:73], v10 offset:32768
v_mfma_f32_16x16x32_bf16 v[28:31], a[92:95], a[36:39], v[28:31]
buffer_load_dwordx4 v13, s[48:51], s64 offen lds
v_mfma_f32_16x16x32_bf16 v[44:47], a[92:95], a[44:47], v[44:47]
ds_read_b64_tr_b16 a[74:75], v10 offset:33792
v_add_u32 v7, 0x8000, v7
v_mfma_f32_16x16x32_bf16 v[44:47], a[88:91], a[40:43], v[44:47]
ds_read_b64_tr_b16 a[76:77], v10 offset:40960
v_mfma_f32_16x16x32_bf16 v[60:63], a[88:91], a[48:51], v[60:63]
s_xor_b32 m0, s84, 38912
ds_read_b64_tr_b16 a[78:79], v10 offset:41984
v_mfma_f32_16x16x32_bf16 v[60:63], a[92:95], a[52:55], v[60:63]
s_xor_b32 s64, s73, 131968
ds_read_b64_tr_b16 a[80:81], v11 offset:32768
v_mfma_f32_16x16x32_bf16 v[76:79], a[92:95], a[60:63], v[76:79]
buffer_load_dwordx4 v12, s[48:51], s64 offen lds
v_mfma_f32_16x16x32_bf16 v[76:79], a[88:91], a[56:59], v[76:79]
ds_read_b64_tr_b16 a[82:83], v11 offset:33792
v_mfma_f32_16x16x32_bf16 v[140:143], a[96:99], a[56:59], v[140:143]
ds_read_b64_tr_b16 a[84:85], v11 offset:40960
v_mfma_f32_16x16x32_bf16 v[140:143], a[100:103], a[60:63], v[140:143]
s_xor_b32 m0, s84, 39936
ds_read_b64_tr_b16 a[86:87], v11 offset:41984
v_add_u32 v8, 0x8000, v8
v_mfma_f32_16x16x32_bf16 v[124:127], a[100:103], a[52:55], v[124:127]
s_xor_b32 s64, s73, 148352
v_mfma_f32_16x16x32_bf16 v[124:127], a[96:99], a[48:51], v[124:127]
buffer_load_dwordx4 v13, s[48:51], s64 offen lds
v_mfma_f32_16x16x32_bf16 v[108:111], a[96:99], a[40:43], v[108:111]
v_mfma_f32_16x16x32_bf16 v[108:111], a[100:103], a[44:47], v[108:111]
v_mfma_f32_16x16x32_bf16 v[92:95], a[100:103], a[36:39], v[92:95]
v_add_u32 v9, 0x8000, v9
v_add_u32 v10, 0x8000, v10
v_mfma_f32_16x16x32_bf16 v[92:95], a[96:99], a[32:35], v[92:95]
v_add_u32 v11, 0x8000, v11
v_mfma_f32_16x16x32_bf16 v[32:35], a[104:107], a[32:35], v[32:35]
v_mfma_f32_16x16x32_bf16 v[32:35], a[108:111], a[36:39], v[32:35]
v_mfma_f32_16x16x32_bf16 v[48:51], a[108:111], a[44:47], v[48:51]
s_waitcnt lgkmcnt(0)
s_barrier
v_mfma_f32_16x16x32_bf16 v[48:51], a[104:107], a[40:43], v[48:51]
s_xor_b32 m0, s77, 98304
ds_read_b64_tr_b16 a[88:89], v19 offset:36864
v_mfma_f32_16x16x32_bf16 v[64:67], a[104:107], a[48:51], v[64:67]
s_xor_b32 s64, s71, 4194304
ds_read_b64_tr_b16 a[90:91], v19 offset:37120
v_mfma_f32_16x16x32_bf16 v[64:67], a[108:111], a[52:55], v[64:67]
s_add_u32 s65, s79, 24576
buffer_load_dwordx4 v14, s[56:59], s64 offen lds
v_mfma_f32_16x16x32_bf16 v[80:83], a[108:111], a[60:63], v[80:83]
buffer_store_dwordx4 a[192:195], v16, s[44:47], s65 offen sc1
v_mfma_f32_16x16x32_bf16 v[80:83], a[104:107], a[56:59], v[80:83]
ds_read_b64_tr_b16 a[92:93], v19 offset:38912
v_mfma_f32_16x16x32_bf16 v[144:147], a[112:115], a[56:59], v[144:147]
ds_read_b64_tr_b16 a[94:95], v19 offset:39168
v_mfma_f32_16x16x32_bf16 v[144:147], a[116:119], a[60:63], v[144:147]
ds_read_b64_tr_b16 a[96:97], v20 offset:36864
v_mfma_f32_16x16x32_bf16 v[128:131], a[116:119], a[52:55], v[128:131]
ds_read_b64_tr_b16 a[98:99], v20 offset:37120
v_mfma_f32_16x16x32_bf16 v[128:131], a[112:115], a[48:51], v[128:131]
ds_read_b64_tr_b16 a[100:101], v20 offset:38912
v_mfma_f32_16x16x32_bf16 v[112:115], a[112:115], a[40:43], v[112:115]
s_add_u32 m0, s78, 114688
ds_read_b64_tr_b16 a[102:103], v20 offset:39168
v_mfma_f32_16x16x32_bf16 v[112:115], a[116:119], a[44:47], v[112:115]
s_add_u32 s64, s75, 3145728
ds_read_b64_tr_b16 a[104:105], v19 offset:40960
v_mfma_f32_16x16x32_bf16 v[96:99], a[116:119], a[36:39], v[96:99]
buffer_load_dwordx4 v23, s[60:63], s64 offen lds
v_mfma_f32_16x16x32_bf16 v[96:99], a[112:115], a[32:35], v[96:99]
ds_read_b64_tr_b16 a[106:107], v19 offset:41216
v_mfma_f32_16x16x32_bf16 v[36:39], a[72:75], a[32:35], v[36:39]
ds_read_b64_tr_b16 a[108:109], v19 offset:43008
v_mfma_f32_16x16x32_bf16 v[36:39], a[76:79], a[36:39], v[36:39]
s_branch L_po9
L_pg9:
s_branch L_pg13
L_po9:
ds_read_b64_tr_b16 a[110:111], v19 offset:43264
v_mfma_f32_16x16x32_bf16 v[52:55], a[76:79], a[44:47], v[52:55]
ds_read_b64_tr_b16 a[112:113], v20 offset:40960
v_mfma_f32_16x16x32_bf16 v[52:55], a[72:75], a[40:43], v[52:55]
ds_read_b64_tr_b16 a[114:115], v20 offset:41216
v_mfma_f32_16x16x32_bf16 v[68:71], a[72:75], a[48:51], v[68:71]
ds_read_b64_tr_b16 a[116:117], v20 offset:43008
v_mfma_f32_16x16x32_bf16 v[68:71], a[76:79], a[52:55], v[68:71]
s_xor_b32 m0, s77, 99328
ds_read_b64_tr_b16 a[118:119], v20 offset:43264
v_mfma_f32_16x16x32_bf16 v[84:87], a[76:79], a[60:63], v[84:87]
s_xor_b32 s64, s71, 4227072
v_mfma_f32_16x16x32_bf16 v[84:87], a[72:75], a[56:59], v[84:87]
buffer_load_dwordx4 v14, s[56:59], s64 offen lds
v_mfma_f32_16x16x32_bf16 v[148:151], a[80:83], a[56:59], v[148:151]
ds_read_b64_tr_b16 a[72:73], v19 offset:32768
v_mfma_f32_16x16x32_bf16 v[148:151], a[84:87], a[60:63], v[148:151]
ds_read_b64_tr_b16 a[74:75], v19 offset:33024
v_mfma_f32_16x16x32_bf16 v[132:135], a[84:87], a[52:55], v[132:135]
ds_read_b64_tr_b16 a[76:77], v19 offset:34816
v_mfma_f32_16x16x32_bf16 v[132:135], a[80:83], a[48:51], v[132:135]
ds_read_b64_tr_b16 a[78:79], v19 offset:35072
v_mfma_f32_16x16x32_bf16 v[116:119], a[80:83], a[40:43], v[116:119]
v_mfma_f32_16x16x32_bf16 v[116:119], a[84:87], a[44:47], v[116:119]
v_mfma_f32_16x16x32_bf16 v[100:103], a[84:87], a[36:39], v[100:103]
s_add_u32 m0, s78, 118784
v_mfma_f32_16x16x32_bf16 v[100:103], a[80:83], a[32:35], v[100:103]
s_waitcnt lgkmcnt(4)
s_add_u32 s64, s75, 3147776
ds_read_b64_tr_b16 a[80:81], v20 offset:32768
v_mfma_f32_16x16x32_bf16 v[184:187], a[88:91], a[0:3], v[184:187]
buffer_load_dwordx4 v23, s[60:63], s64 offen lds
v_mfma_f32_16x16x32_bf16 v[184:187], a[92:95], a[4:7], v[184:187]
ds_read_b64_tr_b16 a[82:83], v20 offset:33024
v_mfma_f32_16x16x32_bf16 v[192:195], a[92:95], a[12:15], v[192:195]
ds_read_b64_tr_b16 a[84:85], v20 offset:34816
v_mfma_f32_16x16x32_bf16 v[192:195], a[88:91], a[8:11], v[192:195]
ds_read_b64_tr_b16 a[86:87], v20 offset:35072
v_mfma_f32_16x16x32_bf16 v[200:203], a[88:91], a[16:19], v[200:203]
v_mfma_f32_16x16x32_bf16 v[200:203], a[92:95], a[20:23], v[200:203]
v_mfma_f32_16x16x32_bf16 v[208:211], a[92:95], a[28:31], v[208:211]
v_mfma_f32_16x16x32_bf16 v[208:211], a[88:91], a[24:27], v[208:211]
ds_read_b64_tr_b16 a[88:89], v4 offset:32768
v_mfma_f32_16x16x32_bf16 v[212:215], a[96:99], a[24:27], v[212:215]
s_xor_b32 m0, s77, 100352
ds_read_b64_tr_b16 a[90:91], v4 offset:33792
v_mfma_f32_16x16x32_bf16 v[212:215], a[100:103], a[28:31], v[212:215]
s_xor_b32 s64, s71, 4259840
ds_read_b64_tr_b16 a[92:93], v4 offset:40960
v_mfma_f32_16x16x32_bf16 v[204:207], a[100:103], a[20:23], v[204:207]
buffer_load_dwordx4 v15, s[56:59], s64 offen lds
v_mfma_f32_16x16x32_bf16 v[204:207], a[96:99], a[16:19], v[204:207]
ds_read_b64_tr_b16 a[94:95], v4 offset:41984
v_mfma_f32_16x16x32_bf16 v[196:199], a[96:99], a[8:11], v[196:199]
v_mfma_f32_16x16x32_bf16 v[196:199], a[100:103], a[12:15], v[196:199]
v_mfma_f32_16x16x32_bf16 v[188:191], a[100:103], a[4:7], v[188:191]
v_mfma_f32_16x16x32_bf16 v[188:191], a[96:99], a[0:3], v[188:191]
ds_read_b64_tr_b16 a[96:97], v5 offset:32768
v_mfma_f32_16x16x32_bf16 v[216:219], a[0:3], a[104:107], v[216:219]
s_add_u32 s65, s79, 25600
ds_read_b64_tr_b16 a[98:99], v5 offset:33792
v_mfma_f32_16x16x32_bf16 v[216:219], a[4:7], a[108:111], v[216:219]
s_add_u32 m0, s78, 122880
buffer_store_dwordx4 a[196:199], v16, s[44:47], s65 offen sc1
v_mfma_f32_16x16x32_bf16 v[224:227], a[12:15], a[108:111], v[224:227]
s_add_u32 s64, s75, 3149824
ds_read_b64_tr_b16 a[100:101], v5 offset:40960
v_mfma_f32_16x16x32_bf16 v[224:227], a[8:11], a[104:107], v[224:227]
buffer_load_dwordx4 v23, s[60:63], s64 offen lds
v_mfma_f32_16x16x32_bf16 v[232:235], a[16:19], a[104:107], v[232:235]
ds_read_b64_tr_b16 a[102:103], v5 offset:41984
v_mfma_f32_16x16x32_bf16 v[232:235], a[20:23], a[108:111], v[232:235]
v_mfma_f32_16x16x32_bf16 v[240:243], a[28:31], a[108:111], v[240:243]
v_mfma_f32_16x16x32_bf16 v[240:243], a[24:27], a[104:107], v[240:243]
ds_read_b64_tr_b16 a[104:105], v6 offset:32768
v_mfma_f32_16x16x32_bf16 v[244:247], a[24:27], a[112:115], v[244:247]
ds_read_b64_tr_b16 a[106:107], v6 offset:33792
v_mfma_f32_16x16x32_bf16 v[244:247], a[28:31], a[116:119], v[244:247]
ds_read_b64_tr_b16 a[108:109], v6 offset:40960
v_subrev_u32 v19, 0x8000, v19
v_mfma_f32_16x16x32_bf16 v[236:239], a[20:23], a[116:119], v[236:239]
s_xor_b32 m0, s77, 101376
ds_read_b64_tr_b16 a[110:111], v6 offset:41984
v_mfma_f32_16x16x32_bf16 v[236:239], a[16:19], a[112:115], v[236:239]
s_xor_b32 s64, s71, 4292608
v_mfma_f32_16x16x32_bf16 v[228:231], a[8:11], a[112:115], v[228:231]
buffer_load_dwordx4 v15, s[56:59], s64 offen lds
v_mfma_f32_16x16x32_bf16 v[228:231], a[12:15], a[116:119], v[228:231]
v_mfma_f32_16x16x32_bf16 v[220:223], a[4:7], a[116:119], v[220:223]
v_mfma_f32_16x16x32_bf16 v[220:223], a[0:3], a[112:115], v[220:223]
s_waitcnt lgkmcnt(4)
ds_read_b64_tr_b16 a[112:113], v7 offset:32768
v_mfma_f32_16x16x32_bf16 v[152:155], a[72:75], a[0:3], v[152:155]
ds_read_b64_tr_b16 a[114:115], v7 offset:33792
v_mfma_f32_16x16x32_bf16 v[152:155], a[76:79], a[4:7], v[152:155]
ds_read_b64_tr_b16 a[116:117], v7 offset:40960
v_subrev_u32 v20, 0x8000, v20
v_mfma_f32_16x16x32_bf16 v[160:163], a[76:79], a[12:15], v[160:163]
ds_read_b64_tr_b16 a[118:119], v7 offset:41984
v_mfma_f32_16x16x32_bf16 v[160:163], a[72:75], a[8:11], v[160:163]
v_mfma_f32_16x16x32_bf16 v[168:171], a[72:75], a[16:19], v[168:171]
v_mfma_f32_16x16x32_bf16 v[168:171], a[76:79], a[20:23], v[168:171]
v_mfma_f32_16x16x32_bf16 v[176:179], a[76:79], a[28:31], v[176:179]
s_xor_b32 m0, s84, 0
v_mfma_f32_16x16x32_bf16 v[176:179], a[72:75], a[24:27], v[176:179]
s_xor_b32 s64, s72, 1024
ds_read_b64_tr_b16 a[72:73], v8 offset:32768
v_mfma_f32_16x16x32_bf16 v[180:183], a[80:83], a[24:27], v[180:183]
buffer_load_dwordx4 v12, s[48:51], s64 offen lds
v_mfma_f32_16x16x32_bf16 v[180:183], a[84:87], a[28:31], v[180:183]
ds_read_b64_tr_b16 a[74:75], v8 offset:33792
v_subrev_u32 v4, 0x8000, v4
v_mfma_f32_16x16x32_bf16 v[172:175], a[84:87], a[20:23], v[172:175]
ds_read_b64_tr_b16 a[76:77], v8 offset:40960
v_mfma_f32_16x16x32_bf16 v[172:175], a[80:83], a[16:19], v[172:175]
s_xor_b32 m0, s84, 1024
ds_read_b64_tr_b16 a[78:79], v8 offset:41984
v_mfma_f32_16x16x32_bf16 v[164:167], a[80:83], a[8:11], v[164:167]
s_xor_b32 s64, s72, 17408
v_mfma_f32_16x16x32_bf16 v[164:167], a[84:87], a[12:15], v[164:167]
buffer_load_dwordx4 v13, s[48:51], s64 offen lds
v_mfma_f32_16x16x32_bf16 v[156:159], a[84:87], a[4:7], v[156:159]
v_mfma_f32_16x16x32_bf16 v[156:159], a[80:83], a[0:3], v[156:159]
ds_read_b64_tr_b16 a[80:81], v9 offset:32768
v_mfma_f32_16x16x32_bf16 v[24:27], a[88:91], a[0:3], v[24:27]
s_xor_b32 m0, s84, 2048
ds_read_b64_tr_b16 a[82:83], v9 offset:33792
v_mfma_f32_16x16x32_bf16 v[24:27], a[92:95], a[4:7], v[24:27]
s_xor_b32 s64, s72, 132096
ds_read_b64_tr_b16 a[84:85], v9 offset:40960
v_subrev_u32 v5, 0x8000, v5
v_mfma_f32_16x16x32_bf16 v[40:43], a[92:95], a[12:15], v[40:43]
buffer_load_dwordx4 v12, s[48:51], s64 offen lds
v_mfma_f32_16x16x32_bf16 v[40:43], a[88:91], a[8:11], v[40:43]
ds_read_b64_tr_b16 a[86:87], v9 offset:41984
v_mfma_f32_16x16x32_bf16 v[56:59], a[88:91], a[16:19], v[56:59]
v_mfma_f32_16x16x32_bf16 v[56:59], a[92:95], a[20:23], v[56:59]
s_xor_b32 m0, s84, 3072
v_mfma_f32_16x16x32_bf16 v[72:75], a[92:95], a[28:31], v[72:75]
s_waitcnt vmcnt(12)
s_xor_b32 s64, s72, 148480
ds_read_b128 a[32:35], v2 offset:32768
v_mfma_f32_16x16x32_bf16 v[72:75], a[88:91], a[24:27], v[72:75]
buffer_load_dwordx4 v13, s[48:51], s64 offen lds
v_mfma_f32_16x16x32_bf16 v[136:139], a[96:99], a[24:27], v[136:139]
ds_read_b128 a[36:39], v3 offset:32768
v_mfma_f32_16x16x32_bf16 v[136:139], a[100:103], a[28:31], v[136:139]
ds_read_b128 a[40:43], v2 offset:34816
v_subrev_u32 v6, 0x8000, v6
v_mfma_f32_16x16x32_bf16 v[120:123], a[100:103], a[20:23], v[120:123]
s_xor_b32 m0, s84, 4096
ds_read_b128 a[44:47], v3 offset:34816
v_mfma_f32_16x16x32_bf16 v[120:123], a[96:99], a[16:19], v[120:123]
s_xor_b32 s64, s73, 1024
ds_read_b128 a[48:51], v2 offset:36864
v_mfma_f32_16x16x32_bf16 v[104:107], a[96:99], a[8:11], v[104:107]
buffer_load_dwordx4 v12, s[48:51], s64 offen lds
v_mfma_f32_16x16x32_bf16 v[104:107], a[100:103], a[12:15], v[104:107]
s_add_u32 s65, s79, 9216
ds_read_b128 a[52:55], v3 offset:36864
v_mfma_f32_16x16x32_bf16 v[88:91], a[100:103], a[4:7], v[88:91]
buffer_store_dwordx4 a[200:203], v16, s[44:47], s65 offen sc1
v_mfma_f32_16x16x32_bf16 v[88:91], a[96:99], a[0:3], v[88:91]
s_waitcnt lgkmcnt(6)
s_xor_b32 m0, s84, 5120
ds_read_b128 a[56:59], v2 offset:38912
v_mfma_f32_16x16x32_bf16 v[28:31], a[104:107], a[0:3], v[28:31]
s_xor_b32 s64, s73, 17408
ds_read_b128 a[60:63], v3 offset:38912
v_mfma_f32_16x16x32_bf16 v[28:31], a[108:111], a[4:7], v[28:31]
buffer_load_dwordx4 v13, s[48:51], s64 offen lds
v_mfma_f32_16x16x32_bf16 v[44:47], a[108:111], a[12:15], v[44:47]
ds_read_b64_tr_b16 a[88:89], v10 offset:32768
v_subrev_u32 v7, 0x8000, v7
v_mfma_f32_16x16x32_bf16 v[44:47], a[104:107], a[8:11], v[44:47]
ds_read_b64_tr_b16 a[90:91], v10 offset:33792
v_mfma_f32_16x16x32_bf16 v[60:63], a[104:107], a[16:19], v[60:63]
s_xor_b32 m0, s84, 6144
ds_read_b64_tr_b16 a[92:93], v10 offset:40960
v_mfma_f32_16x16x32_bf16 v[60:63], a[108:111], a[20:23], v[60:63]
s_xor_b32 s64, s73, 132096
ds_read_b64_tr_b16 a[94:95], v10 offset:41984
v_mfma_f32_16x16x32_bf16 v[76:79], a[108:111], a[28:31], v[76:79]
buffer_load_dwordx4 v12, s[48:51], s64 offen lds
v_mfma_f32_16x16x32_bf16 v[76:79], a[104:107], a[24:27], v[76:79]
ds_read_b64_tr_b16 a[96:97], v11 offset:32768
v_mfma_f32_16x16x32_bf16 v[140:143], a[112:115], a[24:27], v[140:143]
ds_read_b64_tr_b16 a[98:99], v11 offset:33792
v_mfma_f32_16x16x32_bf16 v[140:143], a[116:119], a[28:31], v[140:143]
s_xor_b32 m0, s84, 7168
ds_read_b64_tr_b16 a[100:101], v11 offset:40960
v_subrev_u32 v8, 0x8000, v8
v_mfma_f32_16x16x32_bf16 v[124:127], a[116:119], a[20:23], v[124:127]
s_xor_b32 s64, s73, 148480
ds_read_b64_tr_b16 a[102:103], v11 offset:41984
v_mfma_f32_16x16x32_bf16 v[124:127], a[112:115], a[16:19], v[124:127]
buffer_load_dwordx4 v13, s[48:51], s64 offen lds
v_mfma_f32_16x16x32_bf16 v[108:111], a[112:115], a[8:11], v[108:111]
v_mfma_f32_16x16x32_bf16 v[108:111], a[116:119], a[12:15], v[108:111]
v_mfma_f32_16x16x32_bf16 v[92:95], a[116:119], a[4:7], v[92:95]
v_subrev_u32 v9, 0x8000, v9
v_subrev_u32 v10, 0x8000, v10
v_mfma_f32_16x16x32_bf16 v[92:95], a[112:115], a[0:3], v[92:95]
v_subrev_u32 v11, 0x8000, v11
v_mfma_f32_16x16x32_bf16 v[32:35], a[72:75], a[0:3], v[32:35]
v_mfma_f32_16x16x32_bf16 v[32:35], a[76:79], a[4:7], v[32:35]
v_mfma_f32_16x16x32_bf16 v[48:51], a[76:79], a[12:15], v[48:51]
s_waitcnt lgkmcnt(0)
s_barrier
v_mfma_f32_16x16x32_bf16 v[48:51], a[72:75], a[8:11], v[48:51]
s_xor_b32 m0, s77, 131072
ds_read_b64_tr_b16 a[104:105], v19 offset:4096
v_mfma_f32_16x16x32_bf16 v[64:67], a[72:75], a[16:19], v[64:67]
s_xor_b32 s64, s71, 4718592
ds_read_b64_tr_b16 a[106:107], v19 offset:4352
v_mfma_f32_16x16x32_bf16 v[64:67], a[76:79], a[20:23], v[64:67]
buffer_load_dwordx4 v14, s[56:59], s64 offen lds
v_mfma_f32_16x16x32_bf16 v[80:83], a[76:79], a[28:31], v[80:83]
ds_read_b64_tr_b16 a[108:109], v19 offset:6144
v_mfma_f32_16x16x32_bf16 v[80:83], a[72:75], a[24:27], v[80:83]
ds_read_b64_tr_b16 a[110:111], v19 offset:6400
v_mfma_f32_16x16x32_bf16 v[144:147], a[80:83], a[24:27], v[144:147]
ds_read_b64_tr_b16 a[112:113], v20 offset:4096
v_mfma_f32_16x16x32_bf16 v[144:147], a[84:87], a[28:31], v[144:147]
ds_read_b64_tr_b16 a[114:115], v20 offset:4352
v_mfma_f32_16x16x32_bf16 v[128:131], a[84:87], a[20:23], v[128:131]
ds_read_b64_tr_b16 a[116:117], v20 offset:6144
v_mfma_f32_16x16x32_bf16 v[128:131], a[80:83], a[16:19], v[128:131]
ds_read_b64_tr_b16 a[118:119], v20 offset:6400
v_mfma_f32_16x16x32_bf16 v[112:115], a[80:83], a[8:11], v[112:115]
s_add_u32 m0, s78, 147456
ds_read_b64_tr_b16 a[72:73], v19 offset:8192
v_mfma_f32_16x16x32_bf16 v[112:115], a[84:87], a[12:15], v[112:115]
s_add_u32 s64, s75, 3538944
ds_read_b64_tr_b16 a[74:75], v19 offset:8448
v_mfma_f32_16x16x32_bf16 v[96:99], a[84:87], a[4:7], v[96:99]
buffer_load_dwordx4 v23, s[60:63], s64 offen lds
v_mfma_f32_16x16x32_bf16 v[96:99], a[80:83], a[0:3], v[96:99]
ds_read_b64_tr_b16 a[76:77], v19 offset:10240
v_mfma_f32_16x16x32_bf16 v[36:39], a[88:91], a[0:3], v[36:39]
ds_read_b64_tr_b16 a[78:79], v19 offset:10496
v_mfma_f32_16x16x32_bf16 v[36:39], a[92:95], a[4:7], v[36:39]
ds_read_b64_tr_b16 a[80:81], v20 offset:8192
v_mfma_f32_16x16x32_bf16 v[52:55], a[92:95], a[12:15], v[52:55]
ds_read_b64_tr_b16 a[82:83], v20 offset:8448
v_mfma_f32_16x16x32_bf16 v[52:55], a[88:91], a[8:11], v[52:55]
ds_read_b64_tr_b16 a[84:85], v20 offset:10240
v_mfma_f32_16x16x32_bf16 v[68:71], a[88:91], a[16:19], v[68:71]
ds_read_b64_tr_b16 a[86:87], v20 offset:10496
v_mfma_f32_16x16x32_bf16 v[68:71], a[92:95], a[20:23], v[68:71]
s_xor_b32 m0, s77, 132096
v_mfma_f32_16x16x32_bf16 v[84:87], a[92:95], a[28:31], v[84:87]
s_xor_b32 s64, s71, 4751360
v_mfma_f32_16x16x32_bf16 v[84:87], a[88:91], a[24:27], v[84:87]
buffer_load_dwordx4 v14, s[56:59], s64 offen lds
v_mfma_f32_16x16x32_bf16 v[148:151], a[96:99], a[24:27], v[148:151]
ds_read_b64_tr_b16 a[88:89], v19 offset:0
v_mfma_f32_16x16x32_bf16 v[148:151], a[100:103], a[28:31], v[148:151]
ds_read_b64_tr_b16 a[90:91], v19 offset:256
v_mfma_f32_16x16x32_bf16 v[132:135], a[100:103], a[20:23], v[132:135]
s_add_u32 s65, s79, 26624
ds_read_b64_tr_b16 a[92:93], v19 offset:2048
v_mfma_f32_16x16x32_bf16 v[132:135], a[96:99], a[16:19], v[132:135]
buffer_store_dwordx4 a[204:207], v16, s[44:47], s65 offen sc1
v_mfma_f32_16x16x32_bf16 v[116:119], a[96:99], a[8:11], v[116:119]
ds_read_b64_tr_b16 a[94:95], v19 offset:2304
v_mfma_f32_16x16x32_bf16 v[116:119], a[100:103], a[12:15], v[116:119]
v_mfma_f32_16x16x32_bf16 v[100:103], a[100:103], a[4:7], v[100:103]
s_add_u32 m0, s78, 151552
v_mfma_f32_16x16x32_bf16 v[100:103], a[96:99], a[0:3], v[100:103]
s_waitcnt lgkmcnt(4)
s_add_u32 s64, s75, 3540992
ds_read_b64_tr_b16 a[96:97], v20 offset:0
v_mfma_f32_16x16x32_bf16 v[184:187], a[104:107], a[32:35], v[184:187]
buffer_load_dwordx4 v23, s[60:63], s64 offen lds
v_mfma_f32_16x16x32_bf16 v[184:187], a[108:111], a[36:39], v[184:187]
ds_read_b64_tr_b16 a[98:99], v20 offset:256
v_mfma_f32_16x16x32_bf16 v[192:195], a[108:111], a[44:47], v[192:195]
ds_read_b64_tr_b16 a[100:101], v20 offset:2048
v_mfma_f32_16x16x32_bf16 v[192:195], a[104:107], a[40:43], v[192:195]
ds_read_b64_tr_b16 a[102:103], v20 offset:2304
v_mfma_f32_16x16x32_bf16 v[200:203], a[104:107], a[48:51], v[200:203]
s_cmp_eq_u32 s30, 0
s_cselect_b32 s81, 256, 0
v_mfma_f32_16x16x32_bf16 v[200:203], a[108:111], a[52:55], v[200:203]
v_mfma_f32_16x16x32_bf16 v[208:211], a[108:111], a[60:63], v[208:211]
v_mfma_f32_16x16x32_bf16 v[208:211], a[104:107], a[56:59], v[208:211]
ds_read_b64_tr_b16 a[104:105], v4 offset:0
v_mfma_f32_16x16x32_bf16 v[212:215], a[112:115], a[56:59], v[212:215]
s_xor_b32 m0, s77, 133120
ds_read_b64_tr_b16 a[106:107], v4 offset:1024
v_mfma_f32_16x16x32_bf16 v[212:215], a[116:119], a[60:63], v[212:215]
s_xor_b32 s64, s71, 4784128
ds_read_b64_tr_b16 a[108:109], v4 offset:8192
v_mfma_f32_16x16x32_bf16 v[204:207], a[116:119], a[52:55], v[204:207]
buffer_load_dwordx4 v15, s[56:59], s64 offen lds
v_mfma_f32_16x16x32_bf16 v[204:207], a[112:115], a[48:51], v[204:207]
ds_read_b64_tr_b16 a[110:111], v4 offset:9216
v_mfma_f32_16x16x32_bf16 v[196:199], a[112:115], a[40:43], v[196:199]
v_mfma_f32_16x16x32_bf16 v[196:199], a[116:119], a[44:47], v[196:199]
v_mfma_f32_16x16x32_bf16 v[188:191], a[116:119], a[36:39], v[188:191]
v_mfma_f32_16x16x32_bf16 v[188:191], a[112:115], a[32:35], v[188:191]
ds_read_b64_tr_b16 a[112:113], v5 offset:0
v_mfma_f32_16x16x32_bf16 v[216:219], a[32:35], a[72:75], v[216:219]
ds_read_b64_tr_b16 a[114:115], v5 offset:1024
v_mfma_f32_16x16x32_bf16 v[216:219], a[36:39], a[76:79], v[216:219]
s_add_u32 m0, s78, 155648
ds_read_b64_tr_b16 a[116:117], v5 offset:8192
v_mfma_f32_16x16x32_bf16 v[224:227], a[44:47], a[76:79], v[224:227]
s_add_u32 s64, s75, 3543040
ds_read_b64_tr_b16 a[118:119], v5 offset:9216
v_mfma_f32_16x16x32_bf16 v[224:227], a[40:43], a[72:75], v[224:227]
buffer_load_dwordx4 v23, s[60:63], s64 offen lds
v_mfma_f32_16x16x32_bf16 v[232:235], a[48:51], a[72:75], v[232:235]
v_mfma_f32_16x16x32_bf16 v[232:235], a[52:55], a[76:79], v[232:235]
v_mfma_f32_16x16x32_bf16 v[240:243], a[60:63], a[76:79], v[240:243]
v_mfma_f32_16x16x32_bf16 v[240:243], a[56:59], a[72:75], v[240:243]
ds_read_b64_tr_b16 a[72:73], v6 offset:0
v_mfma_f32_16x16x32_bf16 v[244:247], a[56:59], a[80:83], v[244:247]
ds_read_b64_tr_b16 a[74:75], v6 offset:1024
v_mfma_f32_16x16x32_bf16 v[244:247], a[60:63], a[84:87], v[244:247]
ds_read_b64_tr_b16 a[76:77], v6 offset:8192
v_mfma_f32_16x16x32_bf16 v[236:239], a[52:55], a[84:87], v[236:239]
s_xor_b32 m0, s77, 134144
ds_read_b64_tr_b16 a[78:79], v6 offset:9216
v_mfma_f32_16x16x32_bf16 v[236:239], a[48:51], a[80:83], v[236:239]
s_xor_b32 s64, s71, 4816896
v_mfma_f32_16x16x32_bf16 v[228:231], a[40:43], a[80:83], v[228:231]
buffer_load_dwordx4 v15, s[56:59], s64 offen lds
v_mfma_f32_16x16x32_bf16 v[228:231], a[44:47], a[84:87], v[228:231]
v_mfma_f32_16x16x32_bf16 v[220:223], a[36:39], a[84:87], v[220:223]
v_mfma_f32_16x16x32_bf16 v[220:223], a[32:35], a[80:83], v[220:223]
s_waitcnt lgkmcnt(4)
ds_read_b64_tr_b16 a[80:81], v7 offset:0
v_mfma_f32_16x16x32_bf16 v[152:155], a[88:91], a[32:35], v[152:155]
ds_read_b64_tr_b16 a[82:83], v7 offset:1024
v_mfma_f32_16x16x32_bf16 v[152:155], a[92:95], a[36:39], v[152:155]
ds_read_b64_tr_b16 a[84:85], v7 offset:8192
v_mfma_f32_16x16x32_bf16 v[160:163], a[92:95], a[44:47], v[160:163]
ds_read_b64_tr_b16 a[86:87], v7 offset:9216
v_mfma_f32_16x16x32_bf16 v[160:163], a[88:91], a[40:43], v[160:163]
v_mfma_f32_16x16x32_bf16 v[168:171], a[88:91], a[48:51], v[168:171]
v_mfma_f32_16x16x32_bf16 v[168:171], a[92:95], a[52:55], v[168:171]
v_mfma_f32_16x16x32_bf16 v[176:179], a[92:95], a[60:63], v[176:179]
s_xor_b32 m0, s84, 32768
v_mfma_f32_16x16x32_bf16 v[176:179], a[88:91], a[56:59], v[176:179]
s_xor_b32 s64, s72, 1152
ds_read_b64_tr_b16 a[88:89], v8 offset:0
v_mfma_f32_16x16x32_bf16 v[180:183], a[96:99], a[56:59], v[180:183]
s_add_u32 s65, s79, 27648
buffer_load_dwordx4 v12, s[48:51], s64 offen lds
v_mfma_f32_16x16x32_bf16 v[180:183], a[100:103], a[60:63], v[180:183]
buffer_store_dwordx4 a[208:211], v16, s[44:47], s65 offen sc1
v_mfma_f32_16x16x32_bf16 v[172:175], a[100:103], a[52:55], v[172:175]
ds_read_b64_tr_b16 a[90:91], v8 offset:1024
v_mfma_f32_16x16x32_bf16 v[172:175], a[96:99], a[48:51], v[172:175]
s_xor_b32 m0, s84, 33792
ds_read_b64_tr_b16 a[92:93], v8 offset:8192
v_mfma_f32_16x16x32_bf16 v[164:167], a[96:99], a[40:43], v[164:167]
s_xor_b32 s64, s72, 17536
ds_read_b64_tr_b16 a[94:95], v8 offset:9216
v_mfma_f32_16x16x32_bf16 v[164:167], a[100:103], a[44:47], v[164:167]
buffer_load_dwordx4 v13, s[48:51], s64 offen lds
v_mfma_f32_16x16x32_bf16 v[156:159], a[100:103], a[36:39], v[156:159]
v_mfma_f32_16x16x32_bf16 v[156:159], a[96:99], a[32:35], v[156:159]
ds_read_b64_tr_b16 a[96:97], v9 offset:0
v_mfma_f32_16x16x32_bf16 v[24:27], a[104:107], a[32:35], v[24:27]
s_xor_b32 m0, s84, 34816
ds_read_b64_tr_b16 a[98:99], v9 offset:1024
v_mfma_f32_16x16x32_bf16 v[24:27], a[108:111], a[36:39], v[24:27]
s_xor_b32 s64, s72, 132224
ds_read_b64_tr_b16 a[100:101], v9 offset:8192
v_mfma_f32_16x16x32_bf16 v[40:43], a[108:111], a[44:47], v[40:43]
buffer_load_dwordx4 v12, s[48:51], s64 offen lds
v_mfma_f32_16x16x32_bf16 v[40:43], a[104:107], a[40:43], v[40:43]
ds_read_b64_tr_b16 a[102:103], v9 offset:9216
v_mfma_f32_16x16x32_bf16 v[56:59], a[104:107], a[48:51], v[56:59]
v_mfma_f32_16x16x32_bf16 v[56:59], a[108:111], a[52:55], v[56:59]
s_xor_b32 m0, s84, 35840
v_mfma_f32_16x16x32_bf16 v[72:75], a[108:111], a[60:63], v[72:75]
s_waitcnt vmcnt(12)
s_xor_b32 s64, s72, 148608
ds_read_b128 a[0:3], v2 offset:0
v_mfma_f32_16x16x32_bf16 v[72:75], a[104:107], a[56:59], v[72:75]
buffer_load_dwordx4 v13, s[48:51], s64 offen lds
v_mfma_f32_16x16x32_bf16 v[136:139], a[112:115], a[56:59], v[136:139]
ds_read_b128 a[4:7], v3 offset:0
v_mfma_f32_16x16x32_bf16 v[136:139], a[116:119], a[60:63], v[136:139]
ds_read_b128 a[8:11], v2 offset:2048
v_mfma_f32_16x16x32_bf16 v[120:123], a[116:119], a[52:55], v[120:123]
s_xor_b32 m0, s84, 36864
ds_read_b128 a[12:15], v3 offset:2048
v_mfma_f32_16x16x32_bf16 v[120:123], a[112:115], a[48:51], v[120:123]
s_xor_b32 s64, s73, 1152
ds_read_b128 a[16:19], v2 offset:4096
v_mfma_f32_16x16x32_bf16 v[104:107], a[112:115], a[40:43], v[104:107]
buffer_load_dwordx4 v12, s[48:51], s64 offen lds
v_mfma_f32_16x16x32_bf16 v[104:107], a[116:119], a[44:47], v[104:107]
ds_read_b128 a[20:23], v3 offset:4096
v_mfma_f32_16x16x32_bf16 v[88:91], a[116:119], a[36:39], v[88:91]
ds_read_b128 a[24:27], v2 offset:6144
v_mfma_f32_16x16x32_bf16 v[88:91], a[112:115], a[32:35], v[88:91]
s_waitcnt lgkmcnt(7)
s_xor_b32 m0, s84, 37888
ds_read_b128 a[28:31], v3 offset:6144
v_mfma_f32_16x16x32_bf16 v[28:31], a[72:75], a[32:35], v[28:31]
s_xor_b32 s64, s73, 17536
ds_read_b64_tr_b16 a[104:105], v10 offset:0
v_mfma_f32_16x16x32_bf16 v[28:31], a[76:79], a[36:39], v[28:31]
buffer_load_dwordx4 v13, s[48:51], s64 offen lds
v_mfma_f32_16x16x32_bf16 v[44:47], a[76:79], a[44:47], v[44:47]
ds_read_b64_tr_b16 a[106:107], v10 offset:1024
v_mfma_f32_16x16x32_bf16 v[44:47], a[72:75], a[40:43], v[44:47]
ds_read_b64_tr_b16 a[108:109], v10 offset:8192
v_mfma_f32_16x16x32_bf16 v[60:63], a[72:75], a[48:51], v[60:63]
s_xor_b32 m0, s84, 38912
ds_read_b64_tr_b16 a[110:111], v10 offset:9216
v_mfma_f32_16x16x32_bf16 v[60:63], a[76:79], a[52:55], v[60:63]
s_xor_b32 s64, s73, 132224
ds_read_b64_tr_b16 a[112:113], v11 offset:0
v_mfma_f32_16x16x32_bf16 v[76:79], a[76:79], a[60:63], v[76:79]
buffer_load_dwordx4 v12, s[48:51], s64 offen lds
v_mfma_f32_16x16x32_bf16 v[76:79], a[72:75], a[56:59], v[76:79]
ds_read_b64_tr_b16 a[114:115], v11 offset:1024
v_mfma_f32_16x16x32_bf16 v[140:143], a[80:83], a[56:59], v[140:143]
ds_read_b64_tr_b16 a[116:117], v11 offset:8192
v_mfma_f32_16x16x32_bf16 v[140:143], a[84:87], a[60:63], v[140:143]
s_xor_b32 m0, s84, 39936
ds_read_b64_tr_b16 a[118:119], v11 offset:9216
v_mfma_f32_16x16x32_bf16 v[124:127], a[84:87], a[52:55], v[124:127]
s_xor_b32 s64, s73, 148608
v_mfma_f32_16x16x32_bf16 v[124:127], a[80:83], a[48:51], v[124:127]
buffer_load_dwordx4 v13, s[48:51], s64 offen lds
v_mfma_f32_16x16x32_bf16 v[108:111], a[80:83], a[40:43], v[108:111]
v_mfma_f32_16x16x32_bf16 v[108:111], a[84:87], a[44:47], v[108:111]
v_mfma_f32_16x16x32_bf16 v[92:95], a[84:87], a[36:39], v[92:95]
v_mfma_f32_16x16x32_bf16 v[92:95], a[80:83], a[32:35], v[92:95]
v_mfma_f32_16x16x32_bf16 v[32:35], a[88:91], a[32:35], v[32:35]
v_mfma_f32_16x16x32_bf16 v[32:35], a[92:95], a[36:39], v[32:35]
v_mfma_f32_16x16x32_bf16 v[48:51], a[92:95], a[44:47], v[48:51]
s_waitcnt lgkmcnt(0)
s_barrier
v_mfma_f32_16x16x32_bf16 v[48:51], a[88:91], a[40:43], v[48:51]
s_xor_b32 m0, s77, 65536
s_add_u32 s65, s79, 11264
ds_read_b64_tr_b16 a[72:73], v19 offset:36864
v_mfma_f32_16x16x32_bf16 v[64:67], a[88:91], a[48:51], v[64:67]
s_xor_b32 s64, s71, 5242880
buffer_store_dwordx4 a[212:215], v16, s[44:47], s65 offen sc1
v_mfma_f32_16x16x32_bf16 v[64:67], a[92:95], a[52:55], v[64:67]
buffer_load_dwordx4 v14, s[56:59], s64 offen lds
v_mfma_f32_16x16x32_bf16 v[80:83], a[92:95], a[60:63], v[80:83]
ds_read_b64_tr_b16 a[74:75], v19 offset:37120
v_mfma_f32_16x16x32_bf16 v[80:83], a[88:91], a[56:59], v[80:83]
buffer_load_dword v1, off, s[52:55], s78 sc1
v_mfma_f32_16x16x32_bf16 v[144:147], a[96:99], a[56:59], v[144:147]
ds_read_b64_tr_b16 a[76:77], v19 offset:38912
v_mfma_f32_16x16x32_bf16 v[144:147], a[100:103], a[60:63], v[144:147]
ds_read_b64_tr_b16 a[78:79], v19 offset:39168
v_mfma_f32_16x16x32_bf16 v[128:131], a[100:103], a[52:55], v[128:131]
ds_read_b64_tr_b16 a[80:81], v20 offset:36864
v_mfma_f32_16x16x32_bf16 v[128:131], a[96:99], a[48:51], v[128:131]
ds_read_b64_tr_b16 a[82:83], v20 offset:37120
v_mfma_f32_16x16x32_bf16 v[112:115], a[96:99], a[40:43], v[112:115]
s_add_u32 m0, s78, 81920
ds_read_b64_tr_b16 a[84:85], v20 offset:38912
v_mfma_f32_16x16x32_bf16 v[112:115], a[100:103], a[44:47], v[112:115]
s_add_u32 s64, s75, 3932160
ds_read_b64_tr_b16 a[86:87], v20 offset:39168
v_mfma_f32_16x16x32_bf16 v[96:99], a[100:103], a[36:39], v[96:99]
buffer_load_dwordx4 v23, s[60:63], s64 offen lds
v_mfma_f32_16x16x32_bf16 v[96:99], a[96:99], a[32:35], v[96:99]
ds_read_b64_tr_b16 a[88:89], v19 offset:40960
v_mfma_f32_16x16x32_bf16 v[36:39], a[104:107], a[32:35], v[36:39]
ds_read_b64_tr_b16 a[90:91], v19 offset:41216
v_mfma_f32_16x16x32_bf16 v[36:39], a[108:111], a[36:39], v[36:39]
ds_read_b64_tr_b16 a[92:93], v19 offset:43008
v_mfma_f32_16x16x32_bf16 v[52:55], a[108:111], a[44:47], v[52:55]
ds_read_b64_tr_b16 a[94:95], v19 offset:43264
v_mfma_f32_16x16x32_bf16 v[52:55], a[104:107], a[40:43], v[52:55]
ds_read_b64_tr_b16 a[96:97], v20 offset:40960
v_mfma_f32_16x16x32_bf16 v[68:71], a[104:107], a[48:51], v[68:71]
ds_read_b64_tr_b16 a[98:99], v20 offset:41216
v_mfma_f32_16x16x32_bf16 v[68:71], a[108:111], a[52:55], v[68:71]
s_xor_b32 m0, s77, 66560
ds_read_b64_tr_b16 a[100:101], v20 offset:43008
v_mfma_f32_16x16x32_bf16 v[84:87], a[108:111], a[60:63], v[84:87]
s_xor_b32 s64, s71, 5275648
ds_read_b64_tr_b16 a[102:103], v20 offset:43264
v_mfma_f32_16x16x32_bf16 v[84:87], a[104:107], a[56:59], v[84:87]
buffer_load_dwordx4 v14, s[56:59], s64 offen lds
v_mfma_f32_16x16x32_bf16 v[148:151], a[112:115], a[56:59], v[148:151]
ds_read_b64_tr_b16 a[104:105], v19 offset:32768
v_mfma_f32_16x16x32_bf16 v[148:151], a[116:119], a[60:63], v[148:151]
ds_read_b64_tr_b16 a[106:107], v19 offset:33024
v_mfma_f32_16x16x32_bf16 v[132:135], a[116:119], a[52:55], v[132:135]
ds_read_b64_tr_b16 a[108:109], v19 offset:34816
v_mfma_f32_16x16x32_bf16 v[132:135], a[112:115], a[48:51], v[132:135]
ds_read_b64_tr_b16 a[110:111], v19 offset:35072
v_mfma_f32_16x16x32_bf16 v[116:119], a[112:115], a[40:43], v[116:119]
v_mfma_f32_16x16x32_bf16 v[116:119], a[116:119], a[44:47], v[116:119]
v_mfma_f32_16x16x32_bf16 v[100:103], a[116:119], a[36:39], v[100:103]
s_add_u32 m0, s78, 86016
v_mfma_f32_16x16x32_bf16 v[100:103], a[112:115], a[32:35], v[100:103]
s_waitcnt lgkmcnt(5)
s_add_u32 s64, s75, 3934208
ds_read_b64_tr_b16 a[112:113], v20 offset:32768
v_mfma_f32_16x16x32_bf16 v[184:187], a[72:75], a[0:3], v[184:187]
buffer_load_dwordx4 v23, s[60:63], s64 offen lds
v_mfma_f32_16x16x32_bf16 v[184:187], a[76:79], a[4:7], v[184:187]
ds_read_b64_tr_b16 a[114:115], v20 offset:33024
v_mfma_f32_16x16x32_bf16 v[192:195], a[76:79], a[12:15], v[192:195]
ds_read_b64_tr_b16 a[116:117], v20 offset:34816
v_mfma_f32_16x16x32_bf16 v[192:195], a[72:75], a[8:11], v[192:195]
ds_read_b64_tr_b16 a[118:119], v20 offset:35072
v_mfma_f32_16x16x32_bf16 v[200:203], a[72:75], a[16:19], v[200:203]
v_mfma_f32_16x16x32_bf16 v[200:203], a[76:79], a[20:23], v[200:203]
v_mfma_f32_16x16x32_bf16 v[208:211], a[76:79], a[28:31], v[208:211]
s_branch L_po10
L_pg10:
s_branch L_tr1
L_po10:
v_mfma_f32_16x16x32_bf16 v[208:211], a[72:75], a[24:27], v[208:211]
ds_read_b64_tr_b16 a[72:73], v4 offset:32768
v_mfma_f32_16x16x32_bf16 v[212:215], a[80:83], a[24:27], v[212:215]
s_xor_b32 m0, s77, 67584
ds_read_b64_tr_b16 a[74:75], v4 offset:33792
v_mfma_f32_16x16x32_bf16 v[212:215], a[84:87], a[28:31], v[212:215]
s_xor_b32 s64, s71, 5308416
ds_read_b64_tr_b16 a[76:77], v4 offset:40960
v_mfma_f32_16x16x32_bf16 v[204:207], a[84:87], a[20:23], v[204:207]
buffer_load_dwordx4 v15, s[56:59], s64 offen lds
v_mfma_f32_16x16x32_bf16 v[204:207], a[80:83], a[16:19], v[204:207]
ds_read_b64_tr_b16 a[78:79], v4 offset:41984
v_mfma_f32_16x16x32_bf16 v[196:199], a[80:83], a[8:11], v[196:199]
v_mfma_f32_16x16x32_bf16 v[196:199], a[84:87], a[12:15], v[196:199]
v_mfma_f32_16x16x32_bf16 v[188:191], a[84:87], a[4:7], v[188:191]
v_mfma_f32_16x16x32_bf16 v[188:191], a[80:83], a[0:3], v[188:191]
ds_read_b64_tr_b16 a[80:81], v5 offset:32768
v_mfma_f32_16x16x32_bf16 v[216:219], a[0:3], a[88:91], v[216:219]
s_add_u32 s65, s79, 28672
ds_read_b64_tr_b16 a[82:83], v5 offset:33792
v_mfma_f32_16x16x32_bf16 v[216:219], a[4:7], a[92:95], v[216:219]
s_add_u32 m0, s78, 90112
buffer_store_dwordx4 a[216:219], v16, s[44:47], s65 offen sc1
v_mfma_f32_16x16x32_bf16 v[224:227], a[12:15], a[92:95], v[224:227]
s_add_u32 s64, s75, 3936256
ds_read_b64_tr_b16 a[84:85], v5 offset:40960
v_mfma_f32_16x16x32_bf16 v[224:227], a[8:11], a[88:91], v[224:227]
buffer_load_dwordx4 v23, s[60:63], s64 offen lds
v_mfma_f32_16x16x32_bf16 v[232:235], a[16:19], a[88:91], v[232:235]
ds_read_b64_tr_b16 a[86:87], v5 offset:41984
v_mfma_f32_16x16x32_bf16 v[232:235], a[20:23], a[92:95], v[232:235]
v_mfma_f32_16x16x32_bf16 v[240:243], a[28:31], a[92:95], v[240:243]
v_mfma_f32_16x16x32_bf16 v[240:243], a[24:27], a[88:91], v[240:243]
ds_read_b64_tr_b16 a[88:89], v6 offset:32768
v_mfma_f32_16x16x32_bf16 v[244:247], a[24:27], a[96:99], v[244:247]
s_waitcnt lgkmcnt(5)
ds_read_b64_tr_b16 a[90:91], v6 offset:33792
v_mfma_f32_16x16x32_bf16 v[244:247], a[28:31], a[100:103], v[244:247]
ds_read_b64_tr_b16 a[92:93], v6 offset:40960
v_add_u32 v19, 0x8000, v19
v_mfma_f32_16x16x32_bf16 v[236:239], a[20:23], a[100:103], v[236:239]
s_xor_b32 m0, s77, 68608
ds_read_b64_tr_b16 a[94:95], v6 offset:41984
v_mfma_f32_16x16x32_bf16 v[236:239], a[16:19], a[96:99], v[236:239]
s_xor_b32 s64, s71, 5341184
v_mfma_f32_16x16x32_bf16 v[228:231], a[8:11], a[96:99], v[228:231]
buffer_load_dwordx4 v15, s[56:59], s64 offen lds
v_mfma_f32_16x16x32_bf16 v[228:231], a[12:15], a[100:103], v[228:231]
v_mfma_f32_16x16x32_bf16 v[220:223], a[4:7], a[100:103], v[220:223]
v_mfma_f32_16x16x32_bf16 v[220:223], a[0:3], a[96:99], v[220:223]
ds_read_b64_tr_b16 a[96:97], v7 offset:32768
v_mfma_f32_16x16x32_bf16 v[152:155], a[104:107], a[0:3], v[152:155]
ds_read_b64_tr_b16 a[98:99], v7 offset:33792
v_mfma_f32_16x16x32_bf16 v[152:155], a[108:111], a[4:7], v[152:155]
ds_read_b64_tr_b16 a[100:101], v7 offset:40960
v_add_u32 v20, 0x8000, v20
v_mfma_f32_16x16x32_bf16 v[160:163], a[108:111], a[12:15], v[160:163]
ds_read_b64_tr_b16 a[102:103], v7 offset:41984
v_mfma_f32_16x16x32_bf16 v[160:163], a[104:107], a[8:11], v[160:163]
v_mfma_f32_16x16x32_bf16 v[168:171], a[104:107], a[16:19], v[168:171]
v_mfma_f32_16x16x32_bf16 v[168:171], a[108:111], a[20:23], v[168:171]
v_mfma_f32_16x16x32_bf16 v[176:179], a[108:111], a[28:31], v[176:179]
s_xor_b32 m0, s84, 0
v_mfma_f32_16x16x32_bf16 v[176:179], a[104:107], a[24:27], v[176:179]
s_xor_b32 s64, s72, 1280
ds_read_b64_tr_b16 a[104:105], v8 offset:32768
v_mfma_f32_16x16x32_bf16 v[180:183], a[112:115], a[24:27], v[180:183]
buffer_load_dwordx4 v12, s[48:51], s64 offen lds
v_mfma_f32_16x16x32_bf16 v[180:183], a[116:119], a[28:31], v[180:183]
ds_read_b64_tr_b16 a[106:107], v8 offset:33792
v_add_u32 v4, 0x8000, v4
v_mfma_f32_16x16x32_bf16 v[172:175], a[116:119], a[20:23], v[172:175]
ds_read_b64_tr_b16 a[108:109], v8 offset:40960
v_mfma_f32_16x16x32_bf16 v[172:175], a[112:115], a[16:19], v[172:175]
s_xor_b32 m0, s84, 1024
ds_read_b64_tr_b16 a[110:111], v8 offset:41984
v_mfma_f32_16x16x32_bf16 v[164:167], a[112:115], a[8:11], v[164:167]
s_xor_b32 s64, s72, 17664
v_mfma_f32_16x16x32_bf16 v[164:167], a[116:119], a[12:15], v[164:167]
buffer_load_dwordx4 v13, s[48:51], s64 offen lds
v_mfma_f32_16x16x32_bf16 v[156:159], a[116:119], a[4:7], v[156:159]
v_mfma_f32_16x16x32_bf16 v[156:159], a[112:115], a[0:3], v[156:159]
ds_read_b64_tr_b16 a[112:113], v9 offset:32768
v_mfma_f32_16x16x32_bf16 v[24:27], a[72:75], a[0:3], v[24:27]
s_xor_b32 m0, s84, 2048
ds_read_b64_tr_b16 a[114:115], v9 offset:33792
v_mfma_f32_16x16x32_bf16 v[24:27], a[76:79], a[4:7], v[24:27]
s_xor_b32 s64, s72, 132352
ds_read_b64_tr_b16 a[116:117], v9 offset:40960
v_add_u32 v5, 0x8000, v5
v_mfma_f32_16x16x32_bf16 v[40:43], a[76:79], a[12:15], v[40:43]
buffer_load_dwordx4 v12, s[48:51], s64 offen lds
v_mfma_f32_16x16x32_bf16 v[40:43], a[72:75], a[8:11], v[40:43]
ds_read_b64_tr_b16 a[118:119], v9 offset:41984
v_mfma_f32_16x16x32_bf16 v[56:59], a[72:75], a[16:19], v[56:59]
v_mfma_f32_16x16x32_bf16 v[56:59], a[76:79], a[20:23], v[56:59]
s_xor_b32 m0, s84, 3072
v_mfma_f32_16x16x32_bf16 v[72:75], a[76:79], a[28:31], v[72:75]
s_waitcnt vmcnt(13)
s_xor_b32 s64, s72, 148736
ds_read_b128 a[32:35], v2 offset:32768
v_mfma_f32_16x16x32_bf16 v[72:75], a[72:75], a[24:27], v[72:75]
s_waitcnt lgkmcnt(5)
buffer_load_dwordx4 v13, s[48:51], s64 offen lds
v_mfma_f32_16x16x32_bf16 v[136:139], a[80:83], a[24:27], v[136:139]
ds_read_b128 a[36:39], v3 offset:32768
v_mfma_f32_16x16x32_bf16 v[136:139], a[84:87], a[28:31], v[136:139]
ds_read_b128 a[40:43], v2 offset:34816
v_add_u32 v6, 0x8000, v6
v_mfma_f32_16x16x32_bf16 v[120:123], a[84:87], a[20:23], v[120:123]
s_xor_b32 m0, s84, 4096
ds_read_b128 a[44:47], v3 offset:34816
v_mfma_f32_16x16x32_bf16 v[120:123], a[80:83], a[16:19], v[120:123]
s_xor_b32 s64, s73, 1280
ds_read_b128 a[48:51], v2 offset:36864
v_mfma_f32_16x16x32_bf16 v[104:107], a[80:83], a[8:11], v[104:107]
buffer_load_dwordx4 v12, s[48:51], s64 offen lds
v_mfma_f32_16x16x32_bf16 v[104:107], a[84:87], a[12:15], v[104:107]
s_add_u32 s65, s79, 29696
ds_read_b128 a[52:55], v3 offset:36864
v_mfma_f32_16x16x32_bf16 v[88:91], a[84:87], a[4:7], v[88:91]
buffer_store_dwordx4 a[220:223], v16, s[44:47], s65 offen sc1
v_mfma_f32_16x16x32_bf16 v[88:91], a[80:83], a[0:3], v[88:91]
s_xor_b32 m0, s84, 5120
ds_read_b128 a[56:59], v2 offset:38912
v_mfma_f32_16x16x32_bf16 v[28:31], a[88:91], a[0:3], v[28:31]
s_xor_b32 s64, s73, 17664
ds_read_b128 a[60:63], v3 offset:38912
v_mfma_f32_16x16x32_bf16 v[28:31], a[92:95], a[4:7], v[28:31]
buffer_load_dwordx4 v13, s[48:51], s64 offen lds
v_mfma_f32_16x16x32_bf16 v[44:47], a[92:95], a[12:15], v[44:47]
ds_read_b64_tr_b16 a[72:73], v10 offset:32768
v_add_u32 v7, 0x8000, v7
v_mfma_f32_16x16x32_bf16 v[44:47], a[88:91], a[8:11], v[44:47]
ds_read_b64_tr_b16 a[74:75], v10 offset:33792
v_mfma_f32_16x16x32_bf16 v[60:63], a[88:91], a[16:19], v[60:63]
s_xor_b32 m0, s84, 6144
ds_read_b64_tr_b16 a[76:77], v10 offset:40960
v_mfma_f32_16x16x32_bf16 v[60:63], a[92:95], a[20:23], v[60:63]
s_xor_b32 s64, s73, 132352
ds_read_b64_tr_b16 a[78:79], v10 offset:41984
v_mfma_f32_16x16x32_bf16 v[76:79], a[92:95], a[28:31], v[76:79]
buffer_load_dwordx4 v12, s[48:51], s64 offen lds
v_mfma_f32_16x16x32_bf16 v[76:79], a[88:91], a[24:27], v[76:79]
ds_read_b64_tr_b16 a[80:81], v11 offset:32768
v_mfma_f32_16x16x32_bf16 v[140:143], a[96:99], a[24:27], v[140:143]
ds_read_b64_tr_b16 a[82:83], v11 offset:33792
v_mfma_f32_16x16x32_bf16 v[140:143], a[100:103], a[28:31], v[140:143]
s_xor_b32 m0, s84, 7168
ds_read_b64_tr_b16 a[84:85], v11 offset:40960
v_add_u32 v8, 0x8000, v8
v_mfma_f32_16x16x32_bf16 v[124:127], a[100:103], a[20:23], v[124:127]
s_xor_b32 s64, s73, 148736
ds_read_b64_tr_b16 a[86:87], v11 offset:41984
v_mfma_f32_16x16x32_bf16 v[124:127], a[96:99], a[16:19], v[124:127]
buffer_load_dwordx4 v13, s[48:51], s64 offen lds
v_mfma_f32_16x16x32_bf16 v[108:111], a[96:99], a[8:11], v[108:111]
v_mfma_f32_16x16x32_bf16 v[108:111], a[100:103], a[12:15], v[108:111]
v_mfma_f32_16x16x32_bf16 v[92:95], a[100:103], a[4:7], v[92:95]
v_add_u32 v9, 0x8000, v9
v_add_u32 v10, 0x8000, v10
v_mfma_f32_16x16x32_bf16 v[92:95], a[96:99], a[0:3], v[92:95]
v_add_u32 v11, 0x8000, v11
v_mfma_f32_16x16x32_bf16 v[32:35], a[104:107], a[0:3], v[32:35]
v_mfma_f32_16x16x32_bf16 v[32:35], a[108:111], a[4:7], v[32:35]
v_mfma_f32_16x16x32_bf16 v[48:51], a[108:111], a[12:15], v[48:51]
s_waitcnt lgkmcnt(0)
s_barrier
v_mfma_f32_16x16x32_bf16 v[48:51], a[104:107], a[8:11], v[48:51]
s_xor_b32 m0, s77, 98304
ds_read_b64_tr_b16 a[88:89], v19 offset:36864
v_mfma_f32_16x16x32_bf16 v[64:67], a[104:107], a[16:19], v[64:67]
s_xor_b32 s64, s71, 5767168
ds_read_b64_tr_b16 a[90:91], v19 offset:37120
v_mfma_f32_16x16x32_bf16 v[64:67], a[108:111], a[20:23], v[64:67]
buffer_load_dwordx4 v14, s[56:59], s64 offen lds
v_mfma_f32_16x16x32_bf16 v[80:83], a[108:111], a[28:31], v[80:83]
ds_read_b64_tr_b16 a[92:93], v19 offset:38912
v_mfma_f32_16x16x32_bf16 v[80:83], a[104:107], a[24:27], v[80:83]
ds_read_b64_tr_b16 a[94:95], v19 offset:39168
v_mfma_f32_16x16x32_bf16 v[144:147], a[112:115], a[24:27], v[144:147]
ds_read_b64_tr_b16 a[96:97], v20 offset:36864
v_mfma_f32_16x16x32_bf16 v[144:147], a[116:119], a[28:31], v[144:147]
ds_read_b64_tr_b16 a[98:99], v20 offset:37120
v_mfma_f32_16x16x32_bf16 v[128:131], a[116:119], a[20:23], v[128:131]
ds_read_b64_tr_b16 a[100:101], v20 offset:38912
v_mfma_f32_16x16x32_bf16 v[128:131], a[112:115], a[16:19], v[128:131]
ds_read_b64_tr_b16 a[102:103], v20 offset:39168
v_mfma_f32_16x16x32_bf16 v[112:115], a[112:115], a[8:11], v[112:115]
s_add_u32 m0, s78, 114688
ds_read_b64_tr_b16 a[104:105], v19 offset:40960
v_mfma_f32_16x16x32_bf16 v[112:115], a[116:119], a[12:15], v[112:115]
s_add_u32 s64, s75, 4325376
ds_read_b64_tr_b16 a[106:107], v19 offset:41216
v_mfma_f32_16x16x32_bf16 v[96:99], a[116:119], a[4:7], v[96:99]
buffer_load_dwordx4 v23, s[60:63], s64 offen lds
v_mfma_f32_16x16x32_bf16 v[96:99], a[112:115], a[0:3], v[96:99]
ds_read_b64_tr_b16 a[108:109], v19 offset:43008
v_mfma_f32_16x16x32_bf16 v[36:39], a[72:75], a[0:3], v[36:39]
ds_read_b64_tr_b16 a[110:111], v19 offset:43264
v_mfma_f32_16x16x32_bf16 v[36:39], a[76:79], a[4:7], v[36:39]
ds_read_b64_tr_b16 a[112:113], v20 offset:40960
v_mfma_f32_16x16x32_bf16 v[52:55], a[76:79], a[12:15], v[52:55]
ds_read_b64_tr_b16 a[114:115], v20 offset:41216
v_mfma_f32_16x16x32_bf16 v[52:55], a[72:75], a[8:11], v[52:55]
ds_read_b64_tr_b16 a[116:117], v20 offset:43008
v_mfma_f32_16x16x32_bf16 v[68:71], a[72:75], a[16:19], v[68:71]
ds_read_b64_tr_b16 a[118:119], v20 offset:43264
v_mfma_f32_16x16x32_bf16 v[68:71], a[76:79], a[20:23], v[68:71]
s_xor_b32 m0, s77, 99328
v_mfma_f32_16x16x32_bf16 v[84:87], a[76:79], a[28:31], v[84:87]
s_xor_b32 s64, s71, 5799936
v_mfma_f32_16x16x32_bf16 v[84:87], a[72:75], a[24:27], v[84:87]
buffer_load_dwordx4 v14, s[56:59], s64 offen lds
v_mfma_f32_16x16x32_bf16 v[148:151], a[80:83], a[24:27], v[148:151]
ds_read_b64_tr_b16 a[72:73], v19 offset:32768
v_mfma_f32_16x16x32_bf16 v[148:151], a[84:87], a[28:31], v[148:151]
ds_read_b64_tr_b16 a[74:75], v19 offset:33024
v_mfma_f32_16x16x32_bf16 v[132:135], a[84:87], a[20:23], v[132:135]
s_add_u32 s65, s79, 13312
ds_read_b64_tr_b16 a[76:77], v19 offset:34816
v_mfma_f32_16x16x32_bf16 v[132:135], a[80:83], a[16:19], v[132:135]
buffer_store_dwordx4 a[224:227], v16, s[44:47], s65 offen sc1
v_mfma_f32_16x16x32_bf16 v[116:119], a[80:83], a[8:11], v[116:119]
ds_read_b64_tr_b16 a[78:79], v19 offset:35072
v_mfma_f32_16x16x32_bf16 v[116:119], a[84:87], a[12:15], v[116:119]
v_mfma_f32_16x16x32_bf16 v[100:103], a[84:87], a[4:7], v[100:103]
s_add_u32 m0, s78, 118784
v_mfma_f32_16x16x32_bf16 v[100:103], a[80:83], a[0:3], v[100:103]
s_waitcnt lgkmcnt(4)
s_add_u32 s64, s75, 4327424
ds_read_b64_tr_b16 a[80:81], v20 offset:32768
v_mfma_f32_16x16x32_bf16 v[184:187], a[88:91], a[32:35], v[184:187]
buffer_load_dwordx4 v23, s[60:63], s64 offen lds
v_mfma_f32_16x16x32_bf16 v[184:187], a[92:95], a[36:39], v[184:187]
ds_read_b64_tr_b16 a[82:83], v20 offset:33024
v_mfma_f32_16x16x32_bf16 v[192:195], a[92:95], a[44:47], v[192:195]
ds_read_b64_tr_b16 a[84:85], v20 offset:34816
v_mfma_f32_16x16x32_bf16 v[192:195], a[88:91], a[40:43], v[192:195]
ds_read_b64_tr_b16 a[86:87], v20 offset:35072
v_mfma_f32_16x16x32_bf16 v[200:203], a[88:91], a[48:51], v[200:203]
v_mfma_f32_16x16x32_bf16 v[200:203], a[92:95], a[52:55], v[200:203]
v_mfma_f32_16x16x32_bf16 v[208:211], a[92:95], a[60:63], v[208:211]
v_mfma_f32_16x16x32_bf16 v[208:211], a[88:91], a[56:59], v[208:211]
ds_read_b64_tr_b16 a[88:89], v4 offset:32768
v_mfma_f32_16x16x32_bf16 v[212:215], a[96:99], a[56:59], v[212:215]
s_xor_b32 m0, s77, 100352
ds_read_b64_tr_b16 a[90:91], v4 offset:33792
v_mfma_f32_16x16x32_bf16 v[212:215], a[100:103], a[60:63], v[212:215]
s_xor_b32 s64, s71, 5832704
ds_read_b64_tr_b16 a[92:93], v4 offset:40960
v_mfma_f32_16x16x32_bf16 v[204:207], a[100:103], a[52:55], v[204:207]
buffer_load_dwordx4 v15, s[56:59], s64 offen lds
v_mfma_f32_16x16x32_bf16 v[204:207], a[96:99], a[48:51], v[204:207]
ds_read_b64_tr_b16 a[94:95], v4 offset:41984
v_mfma_f32_16x16x32_bf16 v[196:199], a[96:99], a[40:43], v[196:199]
v_mfma_f32_16x16x32_bf16 v[196:199], a[100:103], a[44:47], v[196:199]
v_mfma_f32_16x16x32_bf16 v[188:191], a[100:103], a[36:39], v[188:191]
v_mfma_f32_16x16x32_bf16 v[188:191], a[96:99], a[32:35], v[188:191]
ds_read_b64_tr_b16 a[96:97], v5 offset:32768
v_mfma_f32_16x16x32_bf16 v[216:219], a[32:35], a[104:107], v[216:219]
ds_read_b64_tr_b16 a[98:99], v5 offset:33792
v_mfma_f32_16x16x32_bf16 v[216:219], a[36:39], a[108:111], v[216:219]
s_add_u32 m0, s78, 122880
ds_read_b64_tr_b16 a[100:101], v5 offset:40960
v_mfma_f32_16x16x32_bf16 v[224:227], a[44:47], a[108:111], v[224:227]
s_add_u32 s64, s75, 4329472
ds_read_b64_tr_b16 a[102:103], v5 offset:41984
v_mfma_f32_16x16x32_bf16 v[224:227], a[40:43], a[104:107], v[224:227]
buffer_load_dwordx4 v23, s[60:63], s64 offen lds
v_mfma_f32_16x16x32_bf16 v[232:235], a[48:51], a[104:107], v[232:235]
v_mfma_f32_16x16x32_bf16 v[232:235], a[52:55], a[108:111], v[232:235]
v_mfma_f32_16x16x32_bf16 v[240:243], a[60:63], a[108:111], v[240:243]
v_mfma_f32_16x16x32_bf16 v[240:243], a[56:59], a[104:107], v[240:243]
ds_read_b64_tr_b16 a[104:105], v6 offset:32768
v_mfma_f32_16x16x32_bf16 v[244:247], a[56:59], a[112:115], v[244:247]
ds_read_b64_tr_b16 a[106:107], v6 offset:33792
v_mfma_f32_16x16x32_bf16 v[244:247], a[60:63], a[116:119], v[244:247]
ds_read_b64_tr_b16 a[108:109], v6 offset:40960
v_subrev_u32 v19, 0x8000, v19
v_mfma_f32_16x16x32_bf16 v[236:239], a[52:55], a[116:119], v[236:239]
s_xor_b32 m0, s77, 101376
ds_read_b64_tr_b16 a[110:111], v6 offset:41984
v_mfma_f32_16x16x32_bf16 v[236:239], a[48:51], a[112:115], v[236:239]
s_xor_b32 s64, s71, 5865472
v_mfma_f32_16x16x32_bf16 v[228:231], a[40:43], a[112:115], v[228:231]
buffer_load_dwordx4 v15, s[56:59], s64 offen lds
v_mfma_f32_16x16x32_bf16 v[228:231], a[44:47], a[116:119], v[228:231]
v_mfma_f32_16x16x32_bf16 v[220:223], a[36:39], a[116:119], v[220:223]
v_mfma_f32_16x16x32_bf16 v[220:223], a[32:35], a[112:115], v[220:223]
s_waitcnt lgkmcnt(4)
ds_read_b64_tr_b16 a[112:113], v7 offset:32768
v_mfma_f32_16x16x32_bf16 v[152:155], a[72:75], a[32:35], v[152:155]
ds_read_b64_tr_b16 a[114:115], v7 offset:33792
v_mfma_f32_16x16x32_bf16 v[152:155], a[76:79], a[36:39], v[152:155]
ds_read_b64_tr_b16 a[116:117], v7 offset:40960
v_subrev_u32 v20, 0x8000, v20
v_mfma_f32_16x16x32_bf16 v[160:163], a[76:79], a[44:47], v[160:163]
ds_read_b64_tr_b16 a[118:119], v7 offset:41984
v_mfma_f32_16x16x32_bf16 v[160:163], a[72:75], a[40:43], v[160:163]
v_mfma_f32_16x16x32_bf16 v[168:171], a[72:75], a[48:51], v[168:171]
v_mfma_f32_16x16x32_bf16 v[168:171], a[76:79], a[52:55], v[168:171]
v_mfma_f32_16x16x32_bf16 v[176:179], a[76:79], a[60:63], v[176:179]
s_xor_b32 m0, s84, 32768
s_add_u32 s65, s79, 30720
v_mfma_f32_16x16x32_bf16 v[176:179], a[72:75], a[56:59], v[176:179]
s_xor_b32 s64, s72, 1408
buffer_store_dwordx4 a[228:231], v16, s[44:47], s65 offen sc1
v_mfma_f32_16x16x32_bf16 v[180:183], a[80:83], a[56:59], v[180:183]
buffer_load_dwordx4 v12, s[48:51], s64 offen lds
v_mfma_f32_16x16x32_bf16 v[180:183], a[84:87], a[60:63], v[180:183]
ds_read_b64_tr_b16 a[72:73], v8 offset:32768
v_subrev_u32 v4, 0x8000, v4
v_mfma_f32_16x16x32_bf16 v[172:175], a[84:87], a[52:55], v[172:175]
ds_read_b64_tr_b16 a[74:75], v8 offset:33792
v_mfma_f32_16x16x32_bf16 v[172:175], a[80:83], a[48:51], v[172:175]
s_xor_b32 m0, s84, 33792
ds_read_b64_tr_b16 a[76:77], v8 offset:40960
v_mfma_f32_16x16x32_bf16 v[164:167], a[80:83], a[40:43], v[164:167]
s_xor_b32 s64, s72, 17792
ds_read_b64_tr_b16 a[78:79], v8 offset:41984
v_mfma_f32_16x16x32_bf16 v[164:167], a[84:87], a[44:47], v[164:167]
buffer_load_dwordx4 v13, s[48:51], s64 offen lds
v_mfma_f32_16x16x32_bf16 v[156:159], a[84:87], a[36:39], v[156:159]
v_mfma_f32_16x16x32_bf16 v[156:159], a[80:83], a[32:35], v[156:159]
ds_read_b64_tr_b16 a[80:81], v9 offset:32768
v_mfma_f32_16x16x32_bf16 v[24:27], a[88:91], a[32:35], v[24:27]
s_xor_b32 m0, s84, 34816
ds_read_b64_tr_b16 a[82:83], v9 offset:33792
v_mfma_f32_16x16x32_bf16 v[24:27], a[92:95], a[36:39], v[24:27]
s_xor_b32 s64, s72, 132480
ds_read_b64_tr_b16 a[84:85], v9 offset:40960
v_subrev_u32 v5, 0x8000, v5
v_mfma_f32_16x16x32_bf16 v[40:43], a[92:95], a[44:47], v[40:43]
buffer_load_dwordx4 v12, s[48:51], s64 offen lds
v_mfma_f32_16x16x32_bf16 v[40:43], a[88:91], a[40:43], v[40:43]
ds_read_b64_tr_b16 a[86:87], v9 offset:41984
v_mfma_f32_16x16x32_bf16 v[56:59], a[88:91], a[48:51], v[56:59]
v_mfma_f32_16x16x32_bf16 v[56:59], a[92:95], a[52:55], v[56:59]
s_xor_b32 m0, s84, 35840
v_mfma_f32_16x16x32_bf16 v[72:75], a[92:95], a[60:63], v[72:75]
s_waitcnt vmcnt(12)
s_xor_b32 s64, s72, 148864
ds_read_b128 a[0:3], v2 offset:0
v_mfma_f32_16x16x32_bf16 v[72:75], a[88:91], a[56:59], v[72:75]
buffer_load_dwordx4 v13, s[48:51], s64 offen lds
v_mfma_f32_16x16x32_bf16 v[136:139], a[96:99], a[56:59], v[136:139]
ds_read_b128 a[4:7], v3 offset:0
v_mfma_f32_16x16x32_bf16 v[136:139], a[100:103], a[60:63], v[136:139]
ds_read_b128 a[8:11], v2 offset:2048
v_subrev_u32 v6, 0x8000, v6
v_mfma_f32_16x16x32_bf16 v[120:123], a[100:103], a[52:55], v[120:123]
s_xor_b32 m0, s84, 36864
ds_read_b128 a[12:15], v3 offset:2048
v_mfma_f32_16x16x32_bf16 v[120:123], a[96:99], a[48:51], v[120:123]
s_xor_b32 s64, s73, 1408
ds_read_b128 a[16:19], v2 offset:4096
v_mfma_f32_16x16x32_bf16 v[104:107], a[96:99], a[40:43], v[104:107]
buffer_load_dwordx4 v12, s[48:51], s64 offen lds
v_mfma_f32_16x16x32_bf16 v[104:107], a[100:103], a[44:47], v[104:107]
ds_read_b128 a[20:23], v3 offset:4096
v_mfma_f32_16x16x32_bf16 v[88:91], a[100:103], a[36:39], v[88:91]
ds_read_b128 a[24:27], v2 offset:6144
v_mfma_f32_16x16x32_bf16 v[88:91], a[96:99], a[32:35], v[88:91]
s_waitcnt lgkmcnt(7)
s_xor_b32 m0, s84, 37888
ds_read_b128 a[28:31], v3 offset:6144
v_mfma_f32_16x16x32_bf16 v[28:31], a[104:107], a[32:35], v[28:31]
s_xor_b32 s64, s73, 17792
ds_read_b64_tr_b16 a[88:89], v10 offset:32768
v_mfma_f32_16x16x32_bf16 v[28:31], a[108:111], a[36:39], v[28:31]
buffer_load_dwordx4 v13, s[48:51], s64 offen lds
v_mfma_f32_16x16x32_bf16 v[44:47], a[108:111], a[44:47], v[44:47]
ds_read_b64_tr_b16 a[90:91], v10 offset:33792
v_subrev_u32 v7, 0x8000, v7
v_mfma_f32_16x16x32_bf16 v[44:47], a[104:107], a[40:43], v[44:47]
ds_read_b64_tr_b16 a[92:93], v10 offset:40960
v_mfma_f32_16x16x32_bf16 v[60:63], a[104:107], a[48:51], v[60:63]
s_xor_b32 m0, s84, 38912
ds_read_b64_tr_b16 a[94:95], v10 offset:41984
v_mfma_f32_16x16x32_bf16 v[60:63], a[108:111], a[52:55], v[60:63]
s_xor_b32 s64, s73, 132480
ds_read_b64_tr_b16 a[96:97], v11 offset:32768
v_mfma_f32_16x16x32_bf16 v[76:79], a[108:111], a[60:63], v[76:79]
buffer_load_dwordx4 v12, s[48:51], s64 offen lds
v_mfma_f32_16x16x32_bf16 v[76:79], a[104:107], a[56:59], v[76:79]
ds_read_b64_tr_b16 a[98:99], v11 offset:33792
v_mfma_f32_16x16x32_bf16 v[140:143], a[112:115], a[56:59], v[140:143]
s_xor_b32 m0, s84, 39936
ds_read_b64_tr_b16 a[100:101], v11 offset:40960
v_mfma_f32_16x16x32_bf16 v[140:143], a[116:119], a[60:63], v[140:143]
s_xor_b32 s64, s73, 148864
ds_read_b64_tr_b16 a[102:103], v11 offset:41984
v_subrev_u32 v8, 0x8000, v8
v_mfma_f32_16x16x32_bf16 v[124:127], a[116:119], a[52:55], v[124:127]
v_readfirstlane_b32 vcc_lo, v1
s_nop 0
s_cmp_lt_u32 vcc_lo, s81
s_cbranch_scc1 L_spin_1
L_spinbk_2:
v_mfma_f32_16x16x32_bf16 v[124:127], a[112:115], a[48:51], v[124:127]
buffer_load_dwordx4 v13, s[48:51], s64 offen lds
v_mfma_f32_16x16x32_bf16 v[108:111], a[112:115], a[40:43], v[108:111]
v_mfma_f32_16x16x32_bf16 v[108:111], a[116:119], a[44:47], v[108:111]
v_mfma_f32_16x16x32_bf16 v[92:95], a[116:119], a[36:39], v[92:95]
v_subrev_u32 v9, 0x8000, v9
v_subrev_u32 v10, 0x8000, v10
v_mfma_f32_16x16x32_bf16 v[92:95], a[112:115], a[32:35], v[92:95]
v_subrev_u32 v11, 0x8000, v11
v_mfma_f32_16x16x32_bf16 v[32:35], a[72:75], a[32:35], v[32:35]
s_add_u32 s52, s28, 59768832
s_addc_u32 s53, s29, 0
s_mov_b32 s54, 16384
v_mfma_f32_16x16x32_bf16 v[32:35], a[76:79], a[36:39], v[32:35]
v_mfma_f32_16x16x32_bf16 v[48:51], a[76:79], a[44:47], v[48:51]
s_waitcnt lgkmcnt(0)
s_barrier
v_mfma_f32_16x16x32_bf16 v[48:51], a[72:75], a[40:43], v[48:51]
s_xor_b32 m0, s77, 131072
s_add_u32 s65, s79, 31744
ds_read_b64_tr_b16 a[104:105], v19 offset:4096
v_mfma_f32_16x16x32_bf16 v[64:67], a[72:75], a[48:51], v[64:67]
s_xor_b32 s64, s71, 6291456
buffer_store_dwordx4 a[232:235], v16, s[44:47], s65 offen sc1
v_mfma_f32_16x16x32_bf16 v[64:67], a[76:79], a[52:55], v[64:67]
buffer_load_dwordx4 v14, s[56:59], s64 offen lds
v_mfma_f32_16x16x32_bf16 v[80:83], a[76:79], a[60:63], v[80:83]
ds_read_b64_tr_b16 a[106:107], v19 offset:4352
v_mfma_f32_16x16x32_bf16 v[80:83], a[72:75], a[56:59], v[80:83]
ds_read_b64_tr_b16 a[108:109], v19 offset:6144
v_mfma_f32_16x16x32_bf16 v[144:147], a[80:83], a[56:59], v[144:147]
ds_read_b64_tr_b16 a[110:111], v19 offset:6400
v_mfma_f32_16x16x32_bf16 v[144:147], a[84:87], a[60:63], v[144:147]
ds_read_b64_tr_b16 a[112:113], v20 offset:4096
v_mfma_f32_16x16x32_bf16 v[128:131], a[84:87], a[52:55], v[128:131]
ds_read_b64_tr_b16 a[114:115], v20 offset:4352
v_mfma_f32_16x16x32_bf16 v[128:131], a[80:83], a[48:51], v[128:131]
ds_read_b64_tr_b16 a[116:117], v20 offset:6144
v_mfma_f32_16x16x32_bf16 v[112:115], a[80:83], a[40:43], v[112:115]
s_add_u32 m0, s78, 147456
ds_read_b64_tr_b16 a[118:119], v20 offset:6400
v_mfma_f32_16x16x32_bf16 v[112:115], a[84:87], a[44:47], v[112:115]
s_add_u32 s64, s75, 4718592
ds_read_b64_tr_b16 a[72:73], v19 offset:8192
v_mfma_f32_16x16x32_bf16 v[96:99], a[84:87], a[36:39], v[96:99]
buffer_load_dwordx4 v23, s[60:63], s64 offen lds
v_mfma_f32_16x16x32_bf16 v[96:99], a[80:83], a[32:35], v[96:99]
ds_read_b64_tr_b16 a[74:75], v19 offset:8448
v_mfma_f32_16x16x32_bf16 v[36:39], a[88:91], a[32:35], v[36:39]
ds_read_b64_tr_b16 a[76:77], v19 offset:10240
v_mfma_f32_16x16x32_bf16 v[36:39], a[92:95], a[36:39], v[36:39]
ds_read_b64_tr_b16 a[78:79], v19 offset:10496
v_mfma_f32_16x16x32_bf16 v[52:55], a[92:95], a[44:47], v[52:55]
ds_read_b64_tr_b16 a[80:81], v20 offset:8192
v_mfma_f32_16x16x32_bf16 v[52:55], a[88:91], a[40:43], v[52:55]
ds_read_b64_tr_b16 a[82:83], v20 offset:8448
v_mfma_f32_16x16x32_bf16 v[68:71], a[88:91], a[48:51], v[68:71]
ds_read_b64_tr_b16 a[84:85], v20 offset:10240
v_mfma_f32_16x16x32_bf16 v[68:71], a[92:95], a[52:55], v[68:71]
s_xor_b32 m0, s77, 132096
ds_read_b64_tr_b16 a[86:87], v20 offset:10496
v_mfma_f32_16x16x32_bf16 v[84:87], a[92:95], a[60:63], v[84:87]
s_xor_b32 s64, s71, 6324224
v_mfma_f32_16x16x32_bf16 v[84:87], a[88:91], a[56:59], v[84:87]
buffer_load_dwordx4 v14, s[56:59], s64 offen lds
v_mfma_f32_16x16x32_bf16 v[148:151], a[96:99], a[56:59], v[148:151]
ds_read_b64_tr_b16 a[88:89], v19 offset:0
v_mfma_f32_16x16x32_bf16 v[148:151], a[100:103], a[60:63], v[148:151]
ds_read_b64_tr_b16 a[90:91], v19 offset:256
v_mfma_f32_16x16x32_bf16 v[132:135], a[100:103], a[52:55], v[132:135]
ds_read_b64_tr_b16 a[92:93], v19 offset:2048
v_mfma_f32_16x16x32_bf16 v[132:135], a[96:99], a[48:51], v[132:135]
ds_read_b64_tr_b16 a[94:95], v19 offset:2304
v_mfma_f32_16x16x32_bf16 v[116:119], a[96:99], a[40:43], v[116:119]
v_mfma_f32_16x16x32_bf16 v[116:119], a[100:103], a[44:47], v[116:119]
v_mfma_f32_16x16x32_bf16 v[100:103], a[100:103], a[36:39], v[100:103]
s_add_u32 m0, s78, 151552
v_mfma_f32_16x16x32_bf16 v[100:103], a[96:99], a[32:35], v[100:103]
s_waitcnt lgkmcnt(4)
s_add_u32 s64, s75, 4720640
ds_read_b64_tr_b16 a[96:97], v20 offset:0
v_mfma_f32_16x16x32_bf16 v[184:187], a[104:107], a[0:3], v[184:187]
buffer_load_dwordx4 v23, s[60:63], s64 offen lds
v_mfma_f32_16x16x32_bf16 v[184:187], a[108:111], a[4:7], v[184:187]
ds_read_b64_tr_b16 a[98:99], v20 offset:256
v_mfma_f32_16x16x32_bf16 v[192:195], a[108:111], a[12:15], v[192:195]
ds_read_b64_tr_b16 a[100:101], v20 offset:2048
v_mfma_f32_16x16x32_bf16 v[192:195], a[104:107], a[8:11], v[192:195]
ds_read_b64_tr_b16 a[102:103], v20 offset:2304
v_mfma_f32_16x16x32_bf16 v[200:203], a[104:107], a[16:19], v[200:203]
v_mfma_f32_16x16x32_bf16 v[200:203], a[108:111], a[20:23], v[200:203]
v_mfma_f32_16x16x32_bf16 v[208:211], a[108:111], a[28:31], v[208:211]
v_mfma_f32_16x16x32_bf16 v[208:211], a[104:107], a[24:27], v[208:211]
ds_read_b64_tr_b16 a[104:105], v4 offset:0
v_mfma_f32_16x16x32_bf16 v[212:215], a[112:115], a[24:27], v[212:215]
s_xor_b32 m0, s77, 133120
ds_read_b64_tr_b16 a[106:107], v4 offset:1024
v_mfma_f32_16x16x32_bf16 v[212:215], a[116:119], a[28:31], v[212:215]
s_xor_b32 s64, s71, 6356992
ds_read_b64_tr_b16 a[108:109], v4 offset:8192
v_mfma_f32_16x16x32_bf16 v[204:207], a[116:119], a[20:23], v[204:207]
buffer_load_dwordx4 v15, s[56:59], s64 offen lds
v_mfma_f32_16x16x32_bf16 v[204:207], a[112:115], a[16:19], v[204:207]
ds_read_b64_tr_b16 a[110:111], v4 offset:9216
v_mfma_f32_16x16x32_bf16 v[196:199], a[112:115], a[8:11], v[196:199]
v_mfma_f32_16x16x32_bf16 v[196:199], a[116:119], a[12:15], v[196:199]
v_mfma_f32_16x16x32_bf16 v[188:191], a[116:119], a[4:7], v[188:191]
v_mfma_f32_16x16x32_bf16 v[188:191], a[112:115], a[0:3], v[188:191]
ds_read_b64_tr_b16 a[112:113], v5 offset:0
v_mfma_f32_16x16x32_bf16 v[216:219], a[0:3], a[72:75], v[216:219]
s_add_u32 s65, s79, 15360
ds_read_b64_tr_b16 a[114:115], v5 offset:1024
v_mfma_f32_16x16x32_bf16 v[216:219], a[4:7], a[76:79], v[216:219]
s_add_u32 m0, s78, 155648
buffer_store_dwordx4 a[236:239], v16, s[44:47], s65 offen sc1
v_mfma_f32_16x16x32_bf16 v[224:227], a[12:15], a[76:79], v[224:227]
s_add_u32 s64, s75, 4722688
ds_read_b64_tr_b16 a[116:117], v5 offset:8192
v_mfma_f32_16x16x32_bf16 v[224:227], a[8:11], a[72:75], v[224:227]
buffer_load_dwordx4 v23, s[60:63], s64 offen lds
v_mfma_f32_16x16x32_bf16 v[232:235], a[16:19], a[72:75], v[232:235]
s_branch L_po11
L_pg11:
s_branch L_tr1
L_po11:
ds_read_b64_tr_b16 a[118:119], v5 offset:9216
v_mfma_f32_16x16x32_bf16 v[232:235], a[20:23], a[76:79], v[232:235]
v_mfma_f32_16x16x32_bf16 v[240:243], a[28:31], a[76:79], v[240:243]
v_mfma_f32_16x16x32_bf16 v[240:243], a[24:27], a[72:75], v[240:243]
ds_read_b64_tr_b16 a[72:73], v6 offset:0
v_mfma_f32_16x16x32_bf16 v[244:247], a[24:27], a[80:83], v[244:247]
ds_read_b64_tr_b16 a[74:75], v6 offset:1024
v_mfma_f32_16x16x32_bf16 v[244:247], a[28:31], a[84:87], v[244:247]
ds_read_b64_tr_b16 a[76:77], v6 offset:8192
v_mfma_f32_16x16x32_bf16 v[236:239], a[20:23], a[84:87], v[236:239]
s_xor_b32 m0, s77, 134144
ds_read_b64_tr_b16 a[78:79], v6 offset:9216
v_mfma_f32_16x16x32_bf16 v[236:239], a[16:19], a[80:83], v[236:239]
s_xor_b32 s64, s71, 6389760
v_mfma_f32_16x16x32_bf16 v[228:231], a[8:11], a[80:83], v[228:231]
buffer_load_dwordx4 v15, s[56:59], s64 offen lds
v_mfma_f32_16x16x32_bf16 v[228:231], a[12:15], a[84:87], v[228:231]
v_mfma_f32_16x16x32_bf16 v[220:223], a[4:7], a[84:87], v[220:223]
v_mfma_f32_16x16x32_bf16 v[220:223], a[0:3], a[80:83], v[220:223]
s_waitcnt lgkmcnt(4)
ds_read_b64_tr_b16 a[80:81], v7 offset:0
v_mfma_f32_16x16x32_bf16 v[152:155], a[88:91], a[0:3], v[152:155]
ds_read_b64_tr_b16 a[82:83], v7 offset:1024
v_mfma_f32_16x16x32_bf16 v[152:155], a[92:95], a[4:7], v[152:155]
ds_read_b64_tr_b16 a[84:85], v7 offset:8192
v_mfma_f32_16x16x32_bf16 v[160:163], a[92:95], a[12:15], v[160:163]
ds_read_b64_tr_b16 a[86:87], v7 offset:9216
v_mfma_f32_16x16x32_bf16 v[160:163], a[88:91], a[8:11], v[160:163]
v_mfma_f32_16x16x32_bf16 v[168:171], a[88:91], a[16:19], v[168:171]
v_mfma_f32_16x16x32_bf16 v[168:171], a[92:95], a[20:23], v[168:171]
v_mfma_f32_16x16x32_bf16 v[176:179], a[92:95], a[28:31], v[176:179]
s_xor_b32 m0, s84, 0
v_mfma_f32_16x16x32_bf16 v[176:179], a[88:91], a[24:27], v[176:179]
s_xor_b32 s64, s72, 1536
ds_read_b64_tr_b16 a[88:89], v8 offset:0
v_mfma_f32_16x16x32_bf16 v[180:183], a[96:99], a[24:27], v[180:183]
buffer_load_dwordx4 v12, s[48:51], s64 offen lds
v_mfma_f32_16x16x32_bf16 v[180:183], a[100:103], a[28:31], v[180:183]
ds_read_b64_tr_b16 a[90:91], v8 offset:1024
v_mfma_f32_16x16x32_bf16 v[172:175], a[100:103], a[20:23], v[172:175]
ds_read_b64_tr_b16 a[92:93], v8 offset:8192
v_mfma_f32_16x16x32_bf16 v[172:175], a[96:99], a[16:19], v[172:175]
s_xor_b32 m0, s84, 1024
ds_read_b64_tr_b16 a[94:95], v8 offset:9216
v_mfma_f32_16x16x32_bf16 v[164:167], a[96:99], a[8:11], v[164:167]
s_xor_b32 s64, s72, 17920
v_mfma_f32_16x16x32_bf16 v[164:167], a[100:103], a[12:15], v[164:167]
buffer_load_dwordx4 v13, s[48:51], s64 offen lds
v_mfma_f32_16x16x32_bf16 v[156:159], a[100:103], a[4:7], v[156:159]
v_mfma_f32_16x16x32_bf16 v[156:159], a[96:99], a[0:3], v[156:159]
ds_read_b64_tr_b16 a[96:97], v9 offset:0
v_mfma_f32_16x16x32_bf16 v[24:27], a[104:107], a[0:3], v[24:27]
s_xor_b32 m0, s84, 2048
ds_read_b64_tr_b16 a[98:99], v9 offset:1024
v_mfma_f32_16x16x32_bf16 v[24:27], a[108:111], a[4:7], v[24:27]
s_xor_b32 s64, s72, 132608
ds_read_b64_tr_b16 a[100:101], v9 offset:8192
v_mfma_f32_16x16x32_bf16 v[40:43], a[108:111], a[12:15], v[40:43]
buffer_load_dwordx4 v12, s[48:51], s64 offen lds
v_mfma_f32_16x16x32_bf16 v[40:43], a[104:107], a[8:11], v[40:43]
ds_read_b64_tr_b16 a[102:103], v9 offset:9216
v_mfma_f32_16x16x32_bf16 v[56:59], a[104:107], a[16:19], v[56:59]
v_mfma_f32_16x16x32_bf16 v[56:59], a[108:111], a[20:23], v[56:59]
s_xor_b32 m0, s84, 3072
v_mfma_f32_16x16x32_bf16 v[72:75], a[108:111], a[28:31], v[72:75]
s_waitcnt vmcnt(12)
s_xor_b32 s64, s72, 148992
ds_read_b128 a[32:35], v2 offset:32768
v_mfma_f32_16x16x32_bf16 v[72:75], a[104:107], a[24:27], v[72:75]
buffer_load_dwordx4 v13, s[48:51], s64 offen lds
v_mfma_f32_16x16x32_bf16 v[136:139], a[112:115], a[24:27], v[136:139]
ds_read_b128 a[36:39], v3 offset:32768
v_mfma_f32_16x16x32_bf16 v[136:139], a[116:119], a[28:31], v[136:139]
ds_read_b128 a[40:43], v2 offset:34816
v_mfma_f32_16x16x32_bf16 v[120:123], a[116:119], a[20:23], v[120:123]
s_xor_b32 m0, s84, 4096
ds_read_b128 a[44:47], v3 offset:34816
v_mfma_f32_16x16x32_bf16 v[120:123], a[112:115], a[16:19], v[120:123]
s_xor_b32 s64, s73, 1536
ds_read_b128 a[48:51], v2 offset:36864
v_mfma_f32_16x16x32_bf16 v[104:107], a[112:115], a[8:11], v[104:107]
buffer_load_dwordx4 v12, s[48:51], s64 offen lds
v_mfma_f32_16x16x32_bf16 v[104:107], a[116:119], a[12:15], v[104:107]
ds_read_b128 a[52:55], v3 offset:36864
v_mfma_f32_16x16x32_bf16 v[88:91], a[116:119], a[4:7], v[88:91]
buffer_store_dwordx4 a[240:243], v16, s[44:47], s74 offen sc1
v_mfma_f32_16x16x32_bf16 v[88:91], a[112:115], a[0:3], v[88:91]
s_waitcnt lgkmcnt(6)
s_xor_b32 m0, s84, 5120
ds_read_b128 a[56:59], v2 offset:38912
v_mfma_f32_16x16x32_bf16 v[28:31], a[72:75], a[0:3], v[28:31]
s_xor_b32 s64, s73, 17920
ds_read_b128 a[60:63], v3 offset:38912
v_mfma_f32_16x16x32_bf16 v[28:31], a[76:79], a[4:7], v[28:31]
buffer_load_dwordx4 v13, s[48:51], s64 offen lds
v_mfma_f32_16x16x32_bf16 v[44:47], a[76:79], a[12:15], v[44:47]
ds_read_b64_tr_b16 a[104:105], v10 offset:0
v_mfma_f32_16x16x32_bf16 v[44:47], a[72:75], a[8:11], v[44:47]
ds_read_b64_tr_b16 a[106:107], v10 offset:1024
v_mfma_f32_16x16x32_bf16 v[60:63], a[72:75], a[16:19], v[60:63]
s_xor_b32 m0, s84, 6144
ds_read_b64_tr_b16 a[108:109], v10 offset:8192
v_mfma_f32_16x16x32_bf16 v[60:63], a[76:79], a[20:23], v[60:63]
s_xor_b32 s64, s73, 132608
ds_read_b64_tr_b16 a[110:111], v10 offset:9216
v_mfma_f32_16x16x32_bf16 v[76:79], a[76:79], a[28:31], v[76:79]
buffer_load_dwordx4 v12, s[48:51], s64 offen lds
v_mfma_f32_16x16x32_bf16 v[76:79], a[72:75], a[24:27], v[76:79]
ds_read_b64_tr_b16 a[112:113], v11 offset:0
v_mfma_f32_16x16x32_bf16 v[140:143], a[80:83], a[24:27], v[140:143]
ds_read_b64_tr_b16 a[114:115], v11 offset:1024
v_mfma_f32_16x16x32_bf16 v[140:143], a[84:87], a[28:31], v[140:143]
s_xor_b32 m0, s84, 7168
ds_read_b64_tr_b16 a[116:117], v11 offset:8192
v_mfma_f32_16x16x32_bf16 v[124:127], a[84:87], a[20:23], v[124:127]
s_xor_b32 s64, s73, 148992
ds_read_b64_tr_b16 a[118:119], v11 offset:9216
v_mfma_f32_16x16x32_bf16 v[124:127], a[80:83], a[16:19], v[124:127]
buffer_load_dwordx4 v13, s[48:51], s64 offen lds
v_mfma_f32_16x16x32_bf16 v[108:111], a[80:83], a[8:11], v[108:111]
v_mfma_f32_16x16x32_bf16 v[108:111], a[84:87], a[12:15], v[108:111]
v_mfma_f32_16x16x32_bf16 v[92:95], a[84:87], a[4:7], v[92:95]
v_mfma_f32_16x16x32_bf16 v[92:95], a[80:83], a[0:3], v[92:95]
v_mfma_f32_16x16x32_bf16 v[32:35], a[88:91], a[0:3], v[32:35]
v_mfma_f32_16x16x32_bf16 v[32:35], a[92:95], a[4:7], v[32:35]
v_mfma_f32_16x16x32_bf16 v[48:51], a[92:95], a[12:15], v[48:51]
s_waitcnt lgkmcnt(0)
s_barrier
v_mfma_f32_16x16x32_bf16 v[48:51], a[88:91], a[8:11], v[48:51]
s_xor_b32 m0, s77, 65536
ds_read_b64_tr_b16 a[72:73], v19 offset:36864
v_mfma_f32_16x16x32_bf16 v[64:67], a[88:91], a[16:19], v[64:67]
s_xor_b32 s64, s71, 6815744
ds_read_b64_tr_b16 a[74:75], v19 offset:37120
v_mfma_f32_16x16x32_bf16 v[64:67], a[92:95], a[20:23], v[64:67]
buffer_load_dwordx4 v14, s[56:59], s64 offen lds
v_mfma_f32_16x16x32_bf16 v[80:83], a[92:95], a[28:31], v[80:83]
ds_read_b64_tr_b16 a[76:77], v19 offset:38912
v_mfma_f32_16x16x32_bf16 v[80:83], a[88:91], a[24:27], v[80:83]
ds_read_b64_tr_b16 a[78:79], v19 offset:39168
v_mfma_f32_16x16x32_bf16 v[144:147], a[96:99], a[24:27], v[144:147]
ds_read_b64_tr_b16 a[80:81], v20 offset:36864
v_mfma_f32_16x16x32_bf16 v[144:147], a[100:103], a[28:31], v[144:147]
ds_read_b64_tr_b16 a[82:83], v20 offset:37120
v_mfma_f32_16x16x32_bf16 v[128:131], a[100:103], a[20:23], v[128:131]
ds_read_b64_tr_b16 a[84:85], v20 offset:38912
v_mfma_f32_16x16x32_bf16 v[128:131], a[96:99], a[16:19], v[128:131]
ds_read_b64_tr_b16 a[86:87], v20 offset:39168
v_mfma_f32_16x16x32_bf16 v[112:115], a[96:99], a[8:11], v[112:115]
s_add_u32 m0, s78, 81920
ds_read_b64_tr_b16 a[88:89], v19 offset:40960
v_mfma_f32_16x16x32_bf16 v[112:115], a[100:103], a[12:15], v[112:115]
s_add_u32 s64, s75, 5111808
ds_read_b64_tr_b16 a[90:91], v19 offset:41216
v_mfma_f32_16x16x32_bf16 v[96:99], a[100:103], a[4:7], v[96:99]
buffer_load_dwordx4 v23, s[60:63], s64 offen lds
v_mfma_f32_16x16x32_bf16 v[96:99], a[96:99], a[0:3], v[96:99]
ds_read_b64_tr_b16 a[92:93], v19 offset:43008
v_mfma_f32_16x16x32_bf16 v[36:39], a[104:107], a[0:3], v[36:39]
ds_read_b64_tr_b16 a[94:95], v19 offset:43264
v_mfma_f32_16x16x32_bf16 v[36:39], a[108:111], a[4:7], v[36:39]
ds_read_b64_tr_b16 a[96:97], v20 offset:40960
v_mfma_f32_16x16x32_bf16 v[52:55], a[108:111], a[12:15], v[52:55]
ds_read_b64_tr_b16 a[98:99], v20 offset:41216
v_mfma_f32_16x16x32_bf16 v[52:55], a[104:107], a[8:11], v[52:55]
ds_read_b64_tr_b16 a[100:101], v20 offset:43008
v_mfma_f32_16x16x32_bf16 v[68:71], a[104:107], a[16:19], v[68:71]
ds_read_b64_tr_b16 a[102:103], v20 offset:43264
v_mfma_f32_16x16x32_bf16 v[68:71], a[108:111], a[20:23], v[68:71]
s_xor_b32 m0, s77, 66560
v_mfma_f32_16x16x32_bf16 v[84:87], a[108:111], a[28:31], v[84:87]
s_xor_b32 s64, s71, 6848512
v_mfma_f32_16x16x32_bf16 v[84:87], a[104:107], a[24:27], v[84:87]
buffer_load_dwordx4 v14, s[56:59], s64 offen lds
v_mfma_f32_16x16x32_bf16 v[148:151], a[112:115], a[24:27], v[148:151]
ds_read_b64_tr_b16 a[104:105], v19 offset:32768
v_mfma_f32_16x16x32_bf16 v[148:151], a[116:119], a[28:31], v[148:151]
ds_read_b64_tr_b16 a[106:107], v19 offset:33024
v_mfma_f32_16x16x32_bf16 v[132:135], a[116:119], a[20:23], v[132:135]
ds_read_b64_tr_b16 a[108:109], v19 offset:34816
v_mfma_f32_16x16x32_bf16 v[132:135], a[112:115], a[16:19], v[132:135]
ds_read_b64_tr_b16 a[110:111], v19 offset:35072
v_mfma_f32_16x16x32_bf16 v[116:119], a[112:115], a[8:11], v[116:119]
v_mfma_f32_16x16x32_bf16 v[116:119], a[116:119], a[12:15], v[116:119]
v_mfma_f32_16x16x32_bf16 v[100:103], a[116:119], a[4:7], v[100:103]
s_add_u32 m0, s78, 86016
v_mfma_f32_16x16x32_bf16 v[100:103], a[112:115], a[0:3], v[100:103]
s_waitcnt lgkmcnt(4)
s_add_u32 s64, s75, 5113856
ds_read_b64_tr_b16 a[112:113], v20 offset:32768
v_mfma_f32_16x16x32_bf16 v[184:187], a[72:75], a[32:35], v[184:187]
s_lshl_b32 s66, s30, 30
buffer_load_dwordx4 v23, s[60:63], s64 offen lds
v_mfma_f32_16x16x32_bf16 v[184:187], a[76:79], a[36:39], v[184:187]
ds_read_b64_tr_b16 a[114:115], v20 offset:33024
v_lshl_add_u32 v1, v0, 24, s66
v_mfma_f32_16x16x32_bf16 v[192:195], a[76:79], a[44:47], v[192:195]
s_lshl_b32 s70, s31, 8
ds_read_b64_tr_b16 a[116:117], v20 offset:34816
v_mfma_f32_16x16x32_bf16 v[192:195], a[72:75], a[40:43], v[192:195]
ds_read_b64_tr_b16 a[118:119], v20 offset:35072
v_mfma_f32_16x16x32_bf16 v[200:203], a[72:75], a[48:51], v[200:203]
v_mfma_f32_16x16x32_bf16 v[200:203], a[76:79], a[52:55], v[200:203]
v_mfma_f32_16x16x32_bf16 v[208:211], a[76:79], a[60:63], v[208:211]
v_mfma_f32_16x16x32_bf16 v[208:211], a[72:75], a[56:59], v[208:211]
ds_read_b64_tr_b16 a[72:73], v4 offset:32768
v_mfma_f32_16x16x32_bf16 v[212:215], a[80:83], a[56:59], v[212:215]
s_xor_b32 m0, s77, 67584
ds_read_b64_tr_b16 a[74:75], v4 offset:33792
v_mfma_f32_16x16x32_bf16 v[212:215], a[84:87], a[60:63], v[212:215]
s_xor_b32 s64, s71, 6881280
ds_read_b64_tr_b16 a[76:77], v4 offset:40960
v_mfma_f32_16x16x32_bf16 v[204:207], a[84:87], a[52:55], v[204:207]
buffer_load_dwordx4 v15, s[56:59], s64 offen lds
v_mfma_f32_16x16x32_bf16 v[204:207], a[80:83], a[48:51], v[204:207]
ds_read_b64_tr_b16 a[78:79], v4 offset:41984
v_mfma_f32_16x16x32_bf16 v[196:199], a[80:83], a[40:43], v[196:199]
v_mfma_f32_16x16x32_bf16 v[196:199], a[84:87], a[44:47], v[196:199]
v_mfma_f32_16x16x32_bf16 v[188:191], a[84:87], a[36:39], v[188:191]
v_mfma_f32_16x16x32_bf16 v[188:191], a[80:83], a[32:35], v[188:191]
ds_read_b64_tr_b16 a[80:81], v5 offset:32768
v_mfma_f32_16x16x32_bf16 v[216:219], a[32:35], a[88:91], v[216:219]
ds_read_b64_tr_b16 a[82:83], v5 offset:33792
v_mfma_f32_16x16x32_bf16 v[216:219], a[36:39], a[92:95], v[216:219]
s_add_u32 m0, s78, 90112
ds_read_b64_tr_b16 a[84:85], v5 offset:40960
v_mfma_f32_16x16x32_bf16 v[224:227], a[44:47], a[92:95], v[224:227]
s_add_u32 s64, s75, 5115904
ds_read_b64_tr_b16 a[86:87], v5 offset:41984
v_mfma_f32_16x16x32_bf16 v[224:227], a[40:43], a[88:91], v[224:227]
buffer_load_dwordx4 v23, s[60:63], s64 offen lds
v_mfma_f32_16x16x32_bf16 v[232:235], a[48:51], a[88:91], v[232:235]
v_mfma_f32_16x16x32_bf16 v[232:235], a[52:55], a[92:95], v[232:235]
v_mfma_f32_16x16x32_bf16 v[240:243], a[60:63], a[92:95], v[240:243]
v_mfma_f32_16x16x32_bf16 v[240:243], a[56:59], a[88:91], v[240:243]
ds_read_b64_tr_b16 a[88:89], v6 offset:32768
v_mfma_f32_16x16x32_bf16 v[244:247], a[56:59], a[96:99], v[244:247]
ds_read_b64_tr_b16 a[90:91], v6 offset:33792
v_mfma_f32_16x16x32_bf16 v[244:247], a[60:63], a[100:103], v[244:247]
ds_read_b64_tr_b16 a[92:93], v6 offset:40960
v_add_u32 v19, 0x8000, v19
v_mfma_f32_16x16x32_bf16 v[236:239], a[52:55], a[100:103], v[236:239]
s_xor_b32 m0, s77, 68608
ds_read_b64_tr_b16 a[94:95], v6 offset:41984
v_mfma_f32_16x16x32_bf16 v[236:239], a[48:51], a[96:99], v[236:239]
s_xor_b32 s64, s71, 6914048
v_mfma_f32_16x16x32_bf16 v[228:231], a[40:43], a[96:99], v[228:231]
buffer_load_dwordx4 v15, s[56:59], s64 offen lds
v_mfma_f32_16x16x32_bf16 v[228:231], a[44:47], a[100:103], v[228:231]
v_mfma_f32_16x16x32_bf16 v[220:223], a[36:39], a[100:103], v[220:223]
v_mfma_f32_16x16x32_bf16 v[220:223], a[32:35], a[96:99], v[220:223]
s_waitcnt lgkmcnt(4)
ds_read_b64_tr_b16 a[96:97], v7 offset:32768
v_mfma_f32_16x16x32_bf16 v[152:155], a[104:107], a[32:35], v[152:155]
ds_read_b64_tr_b16 a[98:99], v7 offset:33792
v_mfma_f32_16x16x32_bf16 v[152:155], a[108:111], a[36:39], v[152:155]
ds_read_b64_tr_b16 a[100:101], v7 offset:40960
v_add_u32 v20, 0x8000, v20
v_mfma_f32_16x16x32_bf16 v[160:163], a[108:111], a[44:47], v[160:163]
ds_read_b64_tr_b16 a[102:103], v7 offset:41984
v_mfma_f32_16x16x32_bf16 v[160:163], a[104:107], a[40:43], v[160:163]
v_mfma_f32_16x16x32_bf16 v[168:171], a[104:107], a[48:51], v[168:171]
v_mfma_f32_16x16x32_bf16 v[168:171], a[108:111], a[52:55], v[168:171]
v_mfma_f32_16x16x32_bf16 v[176:179], a[108:111], a[60:63], v[176:179]
s_xor_b32 m0, s84, 32768
v_mfma_f32_16x16x32_bf16 v[176:179], a[104:107], a[56:59], v[176:179]
s_xor_b32 s64, s72, 1664
ds_read_b64_tr_b16 a[104:105], v8 offset:32768
v_mfma_f32_16x16x32_bf16 v[180:183], a[112:115], a[56:59], v[180:183]
buffer_load_dwordx4 v12, s[48:51], s64 offen lds
v_mfma_f32_16x16x32_bf16 v[180:183], a[116:119], a[60:63], v[180:183]
ds_read_b64_tr_b16 a[106:107], v8 offset:33792
v_add_u32 v4, 0x8000, v4
v_mfma_f32_16x16x32_bf16 v[172:175], a[116:119], a[52:55], v[172:175]
ds_read_b64_tr_b16 a[108:109], v8 offset:40960
v_mfma_f32_16x16x32_bf16 v[172:175], a[112:115], a[48:51], v[172:175]
s_xor_b32 m0, s84, 33792
ds_read_b64_tr_b16 a[110:111], v8 offset:41984
v_mfma_f32_16x16x32_bf16 v[164:167], a[112:115], a[40:43], v[164:167]
s_xor_b32 s64, s72, 18048
v_mfma_f32_16x16x32_bf16 v[164:167], a[116:119], a[44:47], v[164:167]
buffer_load_dwordx4 v13, s[48:51], s64 offen lds
v_mfma_f32_16x16x32_bf16 v[156:159], a[116:119], a[36:39], v[156:159]
v_mfma_f32_16x16x32_bf16 v[156:159], a[112:115], a[32:35], v[156:159]
ds_read_b64_tr_b16 a[112:113], v9 offset:32768
v_mfma_f32_16x16x32_bf16 v[24:27], a[72:75], a[32:35], v[24:27]
s_xor_b32 m0, s84, 34816
ds_read_b64_tr_b16 a[114:115], v9 offset:33792
v_mfma_f32_16x16x32_bf16 v[24:27], a[76:79], a[36:39], v[24:27]
s_xor_b32 s64, s72, 132736
ds_read_b64_tr_b16 a[116:117], v9 offset:40960
v_add_u32 v5, 0x8000, v5
v_mfma_f32_16x16x32_bf16 v[40:43], a[76:79], a[44:47], v[40:43]
buffer_load_dwordx4 v12, s[48:51], s64 offen lds
v_mfma_f32_16x16x32_bf16 v[40:43], a[72:75], a[40:43], v[40:43]
ds_read_b64_tr_b16 a[118:119], v9 offset:41984
v_mfma_f32_16x16x32_bf16 v[56:59], a[72:75], a[48:51], v[56:59]
v_mfma_f32_16x16x32_bf16 v[56:59], a[76:79], a[52:55], v[56:59]
s_xor_b32 m0, s84, 35840
v_mfma_f32_16x16x32_bf16 v[72:75], a[76:79], a[60:63], v[72:75]
s_waitcnt vmcnt(10)
s_xor_b32 s64, s72, 149120
ds_read_b128 a[0:3], v2 offset:0
v_mfma_f32_16x16x32_bf16 v[72:75], a[72:75], a[56:59], v[72:75]
buffer_load_dwordx4 v13, s[48:51], s64 offen lds
v_mfma_f32_16x16x32_bf16 v[136:139], a[80:83], a[56:59], v[136:139]
ds_read_b128 a[4:7], v3 offset:0
v_mfma_f32_16x16x32_bf16 v[136:139], a[84:87], a[60:63], v[136:139]
ds_read_b128 a[8:11], v2 offset:2048
v_add_u32 v6, 0x8000, v6
v_mfma_f32_16x16x32_bf16 v[120:123], a[84:87], a[52:55], v[120:123]
s_xor_b32 m0, s84, 36864
ds_read_b128 a[12:15], v3 offset:2048
v_mfma_f32_16x16x32_bf16 v[120:123], a[80:83], a[48:51], v[120:123]
s_xor_b32 s64, s73, 1664
ds_read_b128 a[16:19], v2 offset:4096
v_mfma_f32_16x16x32_bf16 v[104:107], a[80:83], a[40:43], v[104:107]
buffer_load_dwordx4 v12, s[48:51], s64 offen lds
v_mfma_f32_16x16x32_bf16 v[104:107], a[84:87], a[44:47], v[104:107]
ds_read_b128 a[20:23], v3 offset:4096
v_mfma_f32_16x16x32_bf16 v[88:91], a[84:87], a[36:39], v[88:91]
ds_read_b128 a[24:27], v2 offset:6144
v_mfma_f32_16x16x32_bf16 v[88:91], a[80:83], a[32:35], v[88:91]
s_waitcnt lgkmcnt(7)
s_xor_b32 m0, s84, 37888
ds_read_b128 a[28:31], v3 offset:6144
v_mfma_f32_16x16x32_bf16 v[28:31], a[88:91], a[32:35], v[28:31]
s_xor_b32 s64, s73, 18048
ds_read_b64_tr_b16 a[72:73], v10 offset:32768
v_mfma_f32_16x16x32_bf16 v[28:31], a[92:95], a[36:39], v[28:31]
buffer_load_dwordx4 v13, s[48:51], s64 offen lds
v_mfma_f32_16x16x32_bf16 v[44:47], a[92:95], a[44:47], v[44:47]
ds_read_b64_tr_b16 a[74:75], v10 offset:33792
v_add_u32 v7, 0x8000, v7
v_mfma_f32_16x16x32_bf16 v[44:47], a[88:91], a[40:43], v[44:47]
ds_read_b64_tr_b16 a[76:77], v10 offset:40960
v_mfma_f32_16x16x32_bf16 v[60:63], a[88:91], a[48:51], v[60:63]
s_xor_b32 m0, s84, 38912
ds_read_b64_tr_b16 a[78:79], v10 offset:41984
v_mfma_f32_16x16x32_bf16 v[60:63], a[92:95], a[52:55], v[60:63]
s_xor_b32 s64, s73, 132736
ds_read_b64_tr_b16 a[80:81], v11 offset:32768
v_mfma_f32_16x16x32_bf16 v[76:79], a[92:95], a[60:63], v[76:79]
buffer_load_dwordx4 v12, s[48:51], s64 offen lds
v_mfma_f32_16x16x32_bf16 v[76:79], a[88:91], a[56:59], v[76:79]
ds_read_b64_tr_b16 a[82:83], v11 offset:33792
v_mfma_f32_16x16x32_bf16 v[140:143], a[96:99], a[56:59], v[140:143]
ds_read_b64_tr_b16 a[84:85], v11 offset:40960
v_mfma_f32_16x16x32_bf16 v[140:143], a[100:103], a[60:63], v[140:143]
s_xor_b32 m0, s84, 39936
ds_read_b64_tr_b16 a[86:87], v11 offset:41984
v_add_u32 v8, 0x8000, v8
v_mfma_f32_16x16x32_bf16 v[124:127], a[100:103], a[52:55], v[124:127]
s_xor_b32 s64, s73, 149120
v_mfma_f32_16x16x32_bf16 v[124:127], a[96:99], a[48:51], v[124:127]
buffer_load_dwordx4 v13, s[48:51], s64 offen lds
v_mfma_f32_16x16x32_bf16 v[108:111], a[96:99], a[40:43], v[108:111]
v_mfma_f32_16x16x32_bf16 v[108:111], a[100:103], a[44:47], v[108:111]
v_mfma_f32_16x16x32_bf16 v[92:95], a[100:103], a[36:39], v[92:95]
v_add_u32 v9, 0x8000, v9
v_add_u32 v10, 0x8000, v10
v_mfma_f32_16x16x32_bf16 v[92:95], a[96:99], a[32:35], v[92:95]
v_add_u32 v11, 0x8000, v11
v_mfma_f32_16x16x32_bf16 v[32:35], a[104:107], a[32:35], v[32:35]
v_mfma_f32_16x16x32_bf16 v[32:35], a[108:111], a[36:39], v[32:35]
v_mfma_f32_16x16x32_bf16 v[48:51], a[108:111], a[44:47], v[48:51]
s_waitcnt lgkmcnt(0)
s_barrier
v_mfma_f32_16x16x32_bf16 v[48:51], a[104:107], a[40:43], v[48:51]
s_mov_b64 exec, 1
buffer_atomic_add a251, v1, s[52:55], s70 offen offset:0 sc1
s_mov_b64 exec, -1
s_xor_b32 m0, s77, 98304
v_mfma_f32_16x16x32_bf16 v[64:67], a[104:107], a[48:51], v[64:67]
s_lshl4_add_u32 s70, s78, s70
s_xor_b32 s64, s71, 7340032
ds_read_b64_tr_b16 a[88:89], v19 offset:36864
v_mfma_f32_16x16x32_bf16 v[64:67], a[108:111], a[52:55], v[64:67]
s_lshr_b32 s81, s81, 5
buffer_load_dwordx4 v14, s[56:59], s64 offen lds
v_mfma_f32_16x16x32_bf16 v[80:83], a[108:111], a[60:63], v[80:83]
ds_read_b64_tr_b16 a[90:91], v19 offset:37120
v_mfma_f32_16x16x32_bf16 v[80:83], a[104:107], a[56:59], v[80:83]
ds_read_b64_tr_b16 a[92:93], v19 offset:38912
v_mfma_f32_16x16x32_bf16 v[144:147], a[112:115], a[56:59], v[144:147]
ds_read_b64_tr_b16 a[94:95], v19 offset:39168
v_mfma_f32_16x16x32_bf16 v[144:147], a[116:119], a[60:63], v[144:147]
ds_read_b64_tr_b16 a[96:97], v20 offset:36864
v_mfma_f32_16x16x32_bf16 v[128:131], a[116:119], a[52:55], v[128:131]
ds_read_b64_tr_b16 a[98:99], v20 offset:37120
v_mfma_f32_16x16x32_bf16 v[128:131], a[112:115], a[48:51], v[128:131]
ds_read_b64_tr_b16 a[100:101], v20 offset:38912
v_mfma_f32_16x16x32_bf16 v[112:115], a[112:115], a[40:43], v[112:115]
s_add_u32 m0, s78, 114688
ds_read_b64_tr_b16 a[102:103], v20 offset:39168
v_mfma_f32_16x16x32_bf16 v[112:115], a[116:119], a[44:47], v[112:115]
s_add_u32 s64, s75, 5505024
ds_read_b64_tr_b16 a[104:105], v19 offset:40960
v_mfma_f32_16x16x32_bf16 v[96:99], a[116:119], a[36:39], v[96:99]
buffer_load_dwordx4 v23, s[60:63], s64 offen lds
v_mfma_f32_16x16x32_bf16 v[96:99], a[112:115], a[32:35], v[96:99]
ds_read_b64_tr_b16 a[106:107], v19 offset:41216
v_mfma_f32_16x16x32_bf16 v[36:39], a[72:75], a[32:35], v[36:39]
ds_read_b64_tr_b16 a[108:109], v19 offset:43008
v_mfma_f32_16x16x32_bf16 v[36:39], a[76:79], a[36:39], v[36:39]
ds_read_b64_tr_b16 a[110:111], v19 offset:43264
v_mfma_f32_16x16x32_bf16 v[52:55], a[76:79], a[44:47], v[52:55]
ds_read_b64_tr_b16 a[112:113], v20 offset:40960
v_mfma_f32_16x16x32_bf16 v[52:55], a[72:75], a[40:43], v[52:55]
ds_read_b64_tr_b16 a[114:115], v20 offset:41216
v_mfma_f32_16x16x32_bf16 v[68:71], a[72:75], a[48:51], v[68:71]
ds_read_b64_tr_b16 a[116:117], v20 offset:43008
v_mfma_f32_16x16x32_bf16 v[68:71], a[76:79], a[52:55], v[68:71]
s_xor_b32 m0, s77, 99328
ds_read_b64_tr_b16 a[118:119], v20 offset:43264
v_mfma_f32_16x16x32_bf16 v[84:87], a[76:79], a[60:63], v[84:87]
s_xor_b32 s64, s71, 7372800
v_mfma_f32_16x16x32_bf16 v[84:87], a[72:75], a[56:59], v[84:87]
buffer_load_dwordx4 v14, s[56:59], s64 offen lds
v_mfma_f32_16x16x32_bf16 v[148:151], a[80:83], a[56:59], v[148:151]
ds_read_b64_tr_b16 a[72:73], v19 offset:32768
v_mfma_f32_16x16x32_bf16 v[148:151], a[84:87], a[60:63], v[148:151]
ds_read_b64_tr_b16 a[74:75], v19 offset:33024
v_mfma_f32_16x16x32_bf16 v[132:135], a[84:87], a[52:55], v[132:135]
ds_read_b64_tr_b16 a[76:77], v19 offset:34816
v_mfma_f32_16x16x32_bf16 v[132:135], a[80:83], a[48:51], v[132:135]
ds_read_b64_tr_b16 a[78:79], v19 offset:35072
v_mfma_f32_16x16x32_bf16 v[116:119], a[80:83], a[40:43], v[116:119]
v_mfma_f32_16x16x32_bf16 v[116:119], a[84:87], a[44:47], v[116:119]
v_mfma_f32_16x16x32_bf16 v[100:103], a[84:87], a[36:39], v[100:103]
s_add_u32 m0, s78, 118784
v_mfma_f32_16x16x32_bf16 v[100:103], a[80:83], a[32:35], v[100:103]
s_waitcnt lgkmcnt(4)
s_add_u32 s64, s75, 5507072
ds_read_b64_tr_b16 a[80:81], v20 offset:32768
v_mfma_f32_16x16x32_bf16 v[184:187], a[88:91], a[0:3], v[184:187]
buffer_load_dwordx4 v23, s[60:63], s64 offen lds
v_mfma_f32_16x16x32_bf16 v[184:187], a[92:95], a[4:7], v[184:187]
ds_read_b64_tr_b16 a[82:83], v20 offset:33024
v_mfma_f32_16x16x32_bf16 v[192:195], a[92:95], a[12:15], v[192:195]
ds_read_b64_tr_b16 a[84:85], v20 offset:34816
v_mfma_f32_16x16x32_bf16 v[192:195], a[88:91], a[8:11], v[192:195]
ds_read_b64_tr_b16 a[86:87], v20 offset:35072
v_mfma_f32_16x16x32_bf16 v[200:203], a[88:91], a[16:19], v[200:203]
v_mfma_f32_16x16x32_bf16 v[200:203], a[92:95], a[20:23], v[200:203]
v_mfma_f32_16x16x32_bf16 v[208:211], a[92:95], a[28:31], v[208:211]
v_mfma_f32_16x16x32_bf16 v[208:211], a[88:91], a[24:27], v[208:211]
ds_read_b64_tr_b16 a[88:89], v4 offset:32768
v_mfma_f32_16x16x32_bf16 v[212:215], a[96:99], a[24:27], v[212:215]
s_xor_b32 m0, s77, 100352
ds_read_b64_tr_b16 a[90:91], v4 offset:33792
v_mfma_f32_16x16x32_bf16 v[212:215], a[100:103], a[28:31], v[212:215]
s_xor_b32 s64, s71, 7405568
ds_read_b64_tr_b16 a[92:93], v4 offset:40960
v_mfma_f32_16x16x32_bf16 v[204:207], a[100:103], a[20:23], v[204:207]
buffer_load_dwordx4 v15, s[56:59], s64 offen lds
v_mfma_f32_16x16x32_bf16 v[204:207], a[96:99], a[16:19], v[204:207]
ds_read_b64_tr_b16 a[94:95], v4 offset:41984
v_mfma_f32_16x16x32_bf16 v[196:199], a[96:99], a[8:11], v[196:199]
v_mfma_f32_16x16x32_bf16 v[196:199], a[100:103], a[12:15], v[196:199]
v_mfma_f32_16x16x32_bf16 v[188:191], a[100:103], a[4:7], v[188:191]
v_mfma_f32_16x16x32_bf16 v[188:191], a[96:99], a[0:3], v[188:191]
ds_read_b64_tr_b16 a[96:97], v5 offset:32768
v_mfma_f32_16x16x32_bf16 v[216:219], a[0:3], a[104:107], v[216:219]
ds_read_b64_tr_b16 a[98:99], v5 offset:33792
v_mfma_f32_16x16x32_bf16 v[216:219], a[4:7], a[108:111], v[216:219]
s_add_u32 m0, s78, 122880
ds_read_b64_tr_b16 a[100:101], v5 offset:40960
v_mfma_f32_16x16x32_bf16 v[224:227], a[12:15], a[108:111], v[224:227]
s_add_u32 s64, s75, 5509120
ds_read_b64_tr_b16 a[102:103], v5 offset:41984
v_mfma_f32_16x16x32_bf16 v[224:227], a[8:11], a[104:107], v[224:227]
buffer_load_dwordx4 v23, s[60:63], s64 offen lds
v_mfma_f32_16x16x32_bf16 v[232:235], a[16:19], a[104:107], v[232:235]
v_mfma_f32_16x16x32_bf16 v[232:235], a[20:23], a[108:111], v[232:235]
v_mfma_f32_16x16x32_bf16 v[240:243], a[28:31], a[108:111], v[240:243]
v_mfma_f32_16x16x32_bf16 v[240:243], a[24:27], a[104:107], v[240:243]
ds_read_b64_tr_b16 a[104:105], v6 offset:32768
v_mfma_f32_16x16x32_bf16 v[244:247], a[24:27], a[112:115], v[244:247]
ds_read_b64_tr_b16 a[106:107], v6 offset:33792
v_mfma_f32_16x16x32_bf16 v[244:247], a[28:31], a[116:119], v[244:247]
ds_read_b64_tr_b16 a[108:109], v6 offset:40960
v_subrev_u32 v19, 0x8000, v19
v_mfma_f32_16x16x32_bf16 v[236:239], a[20:23], a[116:119], v[236:239]
s_xor_b32 m0, s77, 101376
ds_read_b64_tr_b16 a[110:111], v6 offset:41984
v_mfma_f32_16x16x32_bf16 v[236:239], a[16:19], a[112:115], v[236:239]
s_xor_b32 s64, s71, 7438336
v_mfma_f32_16x16x32_bf16 v[228:231], a[8:11], a[112:115], v[228:231]
buffer_load_dwordx4 v15, s[56:59], s64 offen lds
v_mfma_f32_16x16x32_bf16 v[228:231], a[12:15], a[116:119], v[228:231]
v_mfma_f32_16x16x32_bf16 v[220:223], a[4:7], a[116:119], v[220:223]
v_mfma_f32_16x16x32_bf16 v[220:223], a[0:3], a[112:115], v[220:223]
s_waitcnt lgkmcnt(4)
ds_read_b64_tr_b16 a[112:113], v7 offset:32768
v_mfma_f32_16x16x32_bf16 v[152:155], a[72:75], a[0:3], v[152:155]
ds_read_b64_tr_b16 a[114:115], v7 offset:33792
v_mfma_f32_16x16x32_bf16 v[152:155], a[76:79], a[4:7], v[152:155]
ds_read_b64_tr_b16 a[116:117], v7 offset:40960
v_subrev_u32 v20, 0x8000, v20
v_mfma_f32_16x16x32_bf16 v[160:163], a[76:79], a[12:15], v[160:163]
ds_read_b64_tr_b16 a[118:119], v7 offset:41984
v_mfma_f32_16x16x32_bf16 v[160:163], a[72:75], a[8:11], v[160:163]
v_mfma_f32_16x16x32_bf16 v[168:171], a[72:75], a[16:19], v[168:171]
v_mfma_f32_16x16x32_bf16 v[168:171], a[76:79], a[20:23], v[168:171]
v_mfma_f32_16x16x32_bf16 v[176:179], a[76:79], a[28:31], v[176:179]
s_xor_b32 m0, s84, 0
v_mfma_f32_16x16x32_bf16 v[176:179], a[72:75], a[24:27], v[176:179]
s_xor_b32 s64, s72, 1792
ds_read_b64_tr_b16 a[72:73], v8 offset:32768
v_mfma_f32_16x16x32_bf16 v[180:183], a[80:83], a[24:27], v[180:183]
buffer_load_dwordx4 v12, s[48:51], s64 offen lds
v_mfma_f32_16x16x32_bf16 v[180:183], a[84:87], a[28:31], v[180:183]
ds_read_b64_tr_b16 a[74:75], v8 offset:33792
v_subrev_u32 v4, 0x8000, v4
v_mfma_f32_16x16x32_bf16 v[172:175], a[84:87], a[20:23], v[172:175]
ds_read_b64_tr_b16 a[76:77], v8 offset:40960
v_mfma_f32_16x16x32_bf16 v[172:175], a[80:83], a[16:19], v[172:175]
s_xor_b32 m0, s84, 1024
ds_read_b64_tr_b16 a[78:79], v8 offset:41984
v_mfma_f32_16x16x32_bf16 v[164:167], a[80:83], a[8:11], v[164:167]
s_xor_b32 s64, s72, 18176
v_mfma_f32_16x16x32_bf16 v[164:167], a[84:87], a[12:15], v[164:167]
s_branch L_po12
L_pg12:
s_branch L_tr1
L_po12:
buffer_load_dwordx4 v13, s[48:51], s64 offen lds
v_mfma_f32_16x16x32_bf16 v[156:159], a[84:87], a[4:7], v[156:159]
v_mfma_f32_16x16x32_bf16 v[156:159], a[80:83], a[0:3], v[156:159]
ds_read_b64_tr_b16 a[80:81], v9 offset:32768
v_mfma_f32_16x16x32_bf16 v[24:27], a[88:91], a[0:3], v[24:27]
s_xor_b32 m0, s84, 2048
ds_read_b64_tr_b16 a[82:83], v9 offset:33792
v_mfma_f32_16x16x32_bf16 v[24:27], a[92:95], a[4:7], v[24:27]
s_xor_b32 s64, s72, 132864
ds_read_b64_tr_b16 a[84:85], v9 offset:40960
v_subrev_u32 v5, 0x8000, v5
v_mfma_f32_16x16x32_bf16 v[40:43], a[92:95], a[12:15], v[40:43]
buffer_load_dwordx4 v12, s[48:51], s64 offen lds
v_mfma_f32_16x16x32_bf16 v[40:43], a[88:91], a[8:11], v[40:43]
ds_read_b64_tr_b16 a[86:87], v9 offset:41984
v_mfma_f32_16x16x32_bf16 v[56:59], a[88:91], a[16:19], v[56:59]
v_mfma_f32_16x16x32_bf16 v[56:59], a[92:95], a[20:23], v[56:59]
s_xor_b32 m0, s84, 3072
v_mfma_f32_16x16x32_bf16 v[72:75], a[92:95], a[28:31], v[72:75]
s_waitcnt vmcnt(11)
s_xor_b32 s64, s72, 149248
ds_read_b128 a[32:35], v2 offset:32768
v_mfma_f32_16x16x32_bf16 v[72:75], a[88:91], a[24:27], v[72:75]
buffer_load_dwordx4 v13, s[48:51], s64 offen lds
v_mfma_f32_16x16x32_bf16 v[136:139], a[96:99], a[24:27], v[136:139]
ds_read_b128 a[36:39], v3 offset:32768
v_mfma_f32_16x16x32_bf16 v[136:139], a[100:103], a[28:31], v[136:139]
ds_read_b128 a[40:43], v2 offset:34816
v_subrev_u32 v6, 0x8000, v6
v_mfma_f32_16x16x32_bf16 v[120:123], a[100:103], a[20:23], v[120:123]
s_xor_b32 m0, s84, 4096
ds_read_b128 a[44:47], v3 offset:34816
v_mfma_f32_16x16x32_bf16 v[120:123], a[96:99], a[16:19], v[120:123]
s_xor_b32 s64, s73, 1792
ds_read_b128 a[48:51], v2 offset:36864
v_mfma_f32_16x16x32_bf16 v[104:107], a[96:99], a[8:11], v[104:107]
buffer_load_dwordx4 v12, s[48:51], s64 offen lds
v_mfma_f32_16x16x32_bf16 v[104:107], a[100:103], a[12:15], v[104:107]
ds_read_b128 a[52:55], v3 offset:36864
v_mfma_f32_16x16x32_bf16 v[88:91], a[100:103], a[4:7], v[88:91]
ds_read_b128 a[56:59], v2 offset:38912
v_mfma_f32_16x16x32_bf16 v[88:91], a[96:99], a[0:3], v[88:91]
s_waitcnt lgkmcnt(7)
s_xor_b32 m0, s84, 5120
ds_read_b128 a[60:63], v3 offset:38912
v_mfma_f32_16x16x32_bf16 v[28:31], a[104:107], a[0:3], v[28:31]
s_xor_b32 s64, s73, 18176
ds_read_b64_tr_b16 a[88:89], v10 offset:32768
v_mfma_f32_16x16x32_bf16 v[28:31], a[108:111], a[4:7], v[28:31]
buffer_load_dwordx4 v13, s[48:51], s64 offen lds
v_mfma_f32_16x16x32_bf16 v[44:47], a[108:111], a[12:15], v[44:47]
ds_read_b64_tr_b16 a[90:91], v10 offset:33792
v_subrev_u32 v7, 0x8000, v7
v_mfma_f32_16x16x32_bf16 v[44:47], a[104:107], a[8:11], v[44:47]
ds_read_b64_tr_b16 a[92:93], v10 offset:40960
v_mfma_f32_16x16x32_bf16 v[60:63], a[104:107], a[16:19], v[60:63]
s_xor_b32 m0, s84, 6144
ds_read_b64_tr_b16 a[94:95], v10 offset:41984
v_mfma_f32_16x16x32_bf16 v[60:63], a[108:111], a[20:23], v[60:63]
s_xor_b32 s64, s73, 132864
ds_read_b64_tr_b16 a[96:97], v11 offset:32768
v_mfma_f32_16x16x32_bf16 v[76:79], a[108:111], a[28:31], v[76:79]
buffer_load_dwordx4 v12, s[48:51], s64 offen lds
v_mfma_f32_16x16x32_bf16 v[76:79], a[104:107], a[24:27], v[76:79]
ds_read_b64_tr_b16 a[98:99], v11 offset:33792
v_mfma_f32_16x16x32_bf16 v[140:143], a[112:115], a[24:27], v[140:143]
ds_read_b64_tr_b16 a[100:101], v11 offset:40960
v_mfma_f32_16x16x32_bf16 v[140:143], a[116:119], a[28:31], v[140:143]
s_xor_b32 m0, s84, 7168
ds_read_b64_tr_b16 a[102:103], v11 offset:41984
v_subrev_u32 v8, 0x8000, v8
v_mfma_f32_16x16x32_bf16 v[124:127], a[116:119], a[20:23], v[124:127]
s_xor_b32 s64, s73, 149248
v_mfma_f32_16x16x32_bf16 v[124:127], a[112:115], a[16:19], v[124:127]
buffer_load_dwordx4 v13, s[48:51], s64 offen lds
v_mfma_f32_16x16x32_bf16 v[108:111], a[112:115], a[8:11], v[108:111]
v_mfma_f32_16x16x32_bf16 v[108:111], a[116:119], a[12:15], v[108:111]
v_mfma_f32_16x16x32_bf16 v[92:95], a[116:119], a[4:7], v[92:95]
v_subrev_u32 v9, 0x8000, v9
v_subrev_u32 v10, 0x8000, v10
v_mfma_f32_16x16x32_bf16 v[92:95], a[112:115], a[0:3], v[92:95]
v_subrev_u32 v11, 0x8000, v11
v_mfma_f32_16x16x32_bf16 v[32:35], a[72:75], a[0:3], v[32:35]
v_mfma_f32_16x16x32_bf16 v[32:35], a[76:79], a[4:7], v[32:35]
v_mfma_f32_16x16x32_bf16 v[48:51], a[76:79], a[12:15], v[48:51]
s_waitcnt lgkmcnt(0)
s_barrier
v_mfma_f32_16x16x32_bf16 v[48:51], a[72:75], a[8:11], v[48:51]
s_xor_b32 m0, s84, 32768
buffer_load_dword v1, off, s[52:55], s70 sc1
v_mfma_f32_16x16x32_bf16 v[64:67], a[72:75], a[16:19], v[64:67]
s_xor_b32 s64, s72, 1920
ds_read_b64_tr_b16 a[104:105], v19 offset:4096
v_mfma_f32_16x16x32_bf16 v[64:67], a[76:79], a[20:23], v[64:67]
buffer_load_dwordx4 v12, s[48:51], s64 offen lds
v_mfma_f32_16x16x32_bf16 v[80:83], a[76:79], a[28:31], v[80:83]
ds_read_b64_tr_b16 a[106:107], v19 offset:4352
v_mfma_f32_16x16x32_bf16 v[80:83], a[72:75], a[24:27], v[80:83]
ds_read_b64_tr_b16 a[108:109], v19 offset:6144
v_mfma_f32_16x16x32_bf16 v[144:147], a[80:83], a[24:27], v[144:147]
ds_read_b64_tr_b16 a[110:111], v19 offset:6400
v_mfma_f32_16x16x32_bf16 v[144:147], a[84:87], a[28:31], v[144:147]
s_xor_b32 m0, s84, 33792
ds_read_b64_tr_b16 a[112:113], v20 offset:4096
v_mfma_f32_16x16x32_bf16 v[128:131], a[84:87], a[20:23], v[128:131]
s_xor_b32 s64, s72, 18304
ds_read_b64_tr_b16 a[114:115], v20 offset:4352
v_mfma_f32_16x16x32_bf16 v[128:131], a[80:83], a[16:19], v[128:131]
buffer_load_dwordx4 v13, s[48:51], s64 offen lds
v_mfma_f32_16x16x32_bf16 v[112:115], a[80:83], a[8:11], v[112:115]
ds_read_b64_tr_b16 a[116:117], v20 offset:6144
v_mfma_f32_16x16x32_bf16 v[112:115], a[84:87], a[12:15], v[112:115]
ds_read_b64_tr_b16 a[118:119], v20 offset:6400
v_mfma_f32_16x16x32_bf16 v[96:99], a[84:87], a[4:7], v[96:99]
ds_read_b64_tr_b16 a[72:73], v19 offset:8192
v_mfma_f32_16x16x32_bf16 v[96:99], a[80:83], a[0:3], v[96:99]
s_xor_b32 m0, s84, 34816
ds_read_b64_tr_b16 a[74:75], v19 offset:8448
v_mfma_f32_16x16x32_bf16 v[36:39], a[88:91], a[0:3], v[36:39]
s_xor_b32 s64, s72, 132992
ds_read_b64_tr_b16 a[76:77], v19 offset:10240
v_mfma_f32_16x16x32_bf16 v[36:39], a[92:95], a[4:7], v[36:39]
buffer_load_dwordx4 v12, s[48:51], s64 offen lds
v_mfma_f32_16x16x32_bf16 v[52:55], a[92:95], a[12:15], v[52:55]
ds_read_b64_tr_b16 a[78:79], v19 offset:10496
v_mfma_f32_16x16x32_bf16 v[52:55], a[88:91], a[8:11], v[52:55]
ds_read_b64_tr_b16 a[80:81], v20 offset:8192
v_mfma_f32_16x16x32_bf16 v[68:71], a[88:91], a[16:19], v[68:71]
ds_read_b64_tr_b16 a[82:83], v20 offset:8448
v_mfma_f32_16x16x32_bf16 v[68:71], a[92:95], a[20:23], v[68:71]
s_xor_b32 m0, s84, 35840
ds_read_b64_tr_b16 a[84:85], v20 offset:10240
v_mfma_f32_16x16x32_bf16 v[84:87], a[92:95], a[28:31], v[84:87]
s_xor_b32 s64, s72, 149376
ds_read_b64_tr_b16 a[86:87], v20 offset:10496
v_mfma_f32_16x16x32_bf16 v[84:87], a[88:91], a[24:27], v[84:87]
buffer_load_dwordx4 v13, s[48:51], s64 offen lds
v_mfma_f32_16x16x32_bf16 v[148:151], a[96:99], a[24:27], v[148:151]
ds_read_b64_tr_b16 a[88:89], v19 offset:0
v_mfma_f32_16x16x32_bf16 v[148:151], a[100:103], a[28:31], v[148:151]
ds_read_b64_tr_b16 a[90:91], v19 offset:256
v_mfma_f32_16x16x32_bf16 v[132:135], a[100:103], a[20:23], v[132:135]
ds_read_b64_tr_b16 a[92:93], v19 offset:2048
v_mfma_f32_16x16x32_bf16 v[132:135], a[96:99], a[16:19], v[132:135]
s_xor_b32 m0, s84, 36864
ds_read_b64_tr_b16 a[94:95], v19 offset:2304
v_mfma_f32_16x16x32_bf16 v[116:119], a[96:99], a[8:11], v[116:119]
s_xor_b32 s64, s73, 1920
v_mfma_f32_16x16x32_bf16 v[116:119], a[100:103], a[12:15], v[116:119]
buffer_load_dwordx4 v12, s[48:51], s64 offen lds
v_mfma_f32_16x16x32_bf16 v[100:103], a[100:103], a[4:7], v[100:103]
v_mfma_f32_16x16x32_bf16 v[100:103], a[96:99], a[0:3], v[100:103]
s_waitcnt lgkmcnt(5)
ds_read_b64_tr_b16 a[96:97], v20 offset:0
v_mfma_f32_16x16x32_bf16 v[184:187], a[104:107], a[32:35], v[184:187]
s_xor_b32 m0, s84, 37888
ds_read_b64_tr_b16 a[98:99], v20 offset:256
v_and_b32 v22, 15, v0
v_mfma_f32_16x16x32_bf16 v[184:187], a[108:111], a[36:39], v[184:187]
s_xor_b32 s64, s73, 18304
ds_read_b64_tr_b16 a[100:101], v20 offset:2048
v_lshlrev_b32 v22, 3, v22
v_mfma_f32_16x16x32_bf16 v[192:195], a[108:111], a[44:47], v[192:195]
s_lshl_b32 s85, s30, 7
s_add_u32 s85, s85, 58720256
ds_read_b64_tr_b16 a[102:103], v20 offset:2304
v_mfma_f32_16x16x32_bf16 v[192:195], a[104:107], a[40:43], v[192:195]
s_lshl_b32 s86, s3, 10
s_add_u32 s86, s86, s85
s_lshl_b32 s87, s16, 10
s_lshl_b32 s68, s31, 20
s_add_u32 s32, s28, s68
s_addc_u32 s33, s29, 0
v_mfma_f32_16x16x32_bf16 v[200:203], a[104:107], a[48:51], v[200:203]
s_add_u32 s87, s87, s85
buffer_load_dwordx4 v13, s[48:51], s64 offen lds
v_mfma_f32_16x16x32_bf16 v[200:203], a[108:111], a[52:55], v[200:203]
s_add_u32 s68, s16, 1
s_lshl_b32 s34, s68, 16
v_mfma_f32_16x16x32_bf16 v[208:211], a[108:111], a[60:63], v[208:211]
v_mfma_f32_16x16x32_bf16 v[208:211], a[104:107], a[56:59], v[208:211]
ds_read_b64_tr_b16 a[104:105], v4 offset:0
v_mfma_f32_16x16x32_bf16 v[212:215], a[112:115], a[56:59], v[212:215]
s_xor_b32 m0, s84, 38912
ds_read_b64_tr_b16 a[106:107], v4 offset:1024
v_mfma_f32_16x16x32_bf16 v[212:215], a[116:119], a[60:63], v[212:215]
s_xor_b32 s64, s73, 132992
ds_read_b64_tr_b16 a[108:109], v4 offset:8192
v_mfma_f32_16x16x32_bf16 v[204:207], a[116:119], a[52:55], v[204:207]
buffer_load_dwordx4 v12, s[48:51], s64 offen lds
v_mfma_f32_16x16x32_bf16 v[204:207], a[112:115], a[48:51], v[204:207]
ds_read_b64_tr_b16 a[110:111], v4 offset:9216
v_mfma_f32_16x16x32_bf16 v[196:199], a[112:115], a[40:43], v[196:199]
v_mfma_f32_16x16x32_bf16 v[196:199], a[116:119], a[44:47], v[196:199]
v_mfma_f32_16x16x32_bf16 v[188:191], a[116:119], a[36:39], v[188:191]
s_xor_b32 m0, s84, 39936
v_mfma_f32_16x16x32_bf16 v[188:191], a[112:115], a[32:35], v[188:191]
s_xor_b32 s64, s73, 149376
ds_read_b64_tr_b16 a[112:113], v5 offset:0
v_mfma_f32_16x16x32_bf16 v[216:219], a[32:35], a[72:75], v[216:219]
buffer_load_dwordx4 v13, s[48:51], s64 offen lds
v_mfma_f32_16x16x32_bf16 v[216:219], a[36:39], a[76:79], v[216:219]
ds_read_b64_tr_b16 a[114:115], v5 offset:1024
v_mfma_f32_16x16x32_bf16 v[224:227], a[44:47], a[76:79], v[224:227]
ds_read_b64_tr_b16 a[116:117], v5 offset:8192
v_mfma_f32_16x16x32_bf16 v[224:227], a[40:43], a[72:75], v[224:227]
ds_read_b64_tr_b16 a[118:119], v5 offset:9216
v_mfma_f32_16x16x32_bf16 v[232:235], a[48:51], a[72:75], v[232:235]
s_xor_b32 m0, s77, 131072
v_mfma_f32_16x16x32_bf16 v[232:235], a[52:55], a[76:79], v[232:235]
s_xor_b32 s64, s71, 7864320
v_mfma_f32_16x16x32_bf16 v[240:243], a[60:63], a[76:79], v[240:243]
buffer_load_dwordx4 v14, s[56:59], s64 offen lds
v_mfma_f32_16x16x32_bf16 v[240:243], a[56:59], a[72:75], v[240:243]
ds_read_b64_tr_b16 a[72:73], v6 offset:0
v_mfma_f32_16x16x32_bf16 v[244:247], a[56:59], a[80:83], v[244:247]
s_waitcnt lgkmcnt(5)
ds_read_b64_tr_b16 a[74:75], v6 offset:1024
v_mfma_f32_16x16x32_bf16 v[244:247], a[60:63], a[84:87], v[244:247]
ds_read_b64_tr_b16 a[76:77], v6 offset:8192
v_add_u32 v19, 0x8000, v19
v_mfma_f32_16x16x32_bf16 v[236:239], a[52:55], a[84:87], v[236:239]
s_add_u32 m0, s78, 147456
ds_read_b64_tr_b16 a[78:79], v6 offset:9216
v_mfma_f32_16x16x32_bf16 v[236:239], a[48:51], a[80:83], v[236:239]
s_add_u32 s64, s75, 5898240
v_mfma_f32_16x16x32_bf16 v[228:231], a[40:43], a[80:83], v[228:231]
buffer_load_dwordx4 v23, s[60:63], s64 offen lds
v_mfma_f32_16x16x32_bf16 v[228:231], a[44:47], a[84:87], v[228:231]
v_mfma_f32_16x16x32_bf16 v[220:223], a[36:39], a[84:87], v[220:223]
v_mfma_f32_16x16x32_bf16 v[220:223], a[32:35], a[80:83], v[220:223]
ds_read_b64_tr_b16 a[80:81], v7 offset:0
v_mfma_f32_16x16x32_bf16 v[152:155], a[88:91], a[32:35], v[152:155]
ds_read_b64_tr_b16 a[82:83], v7 offset:1024
v_mfma_f32_16x16x32_bf16 v[152:155], a[92:95], a[36:39], v[152:155]
s_xor_b32 m0, s77, 132096
ds_read_b64_tr_b16 a[84:85], v7 offset:8192
v_add_u32 v20, 0x8000, v20
v_mfma_f32_16x16x32_bf16 v[160:163], a[92:95], a[44:47], v[160:163]
s_xor_b32 s64, s71, 7897088
ds_read_b64_tr_b16 a[86:87], v7 offset:9216
v_mfma_f32_16x16x32_bf16 v[160:163], a[88:91], a[40:43], v[160:163]
buffer_load_dwordx4 v14, s[56:59], s64 offen lds
v_mfma_f32_16x16x32_bf16 v[168:171], a[88:91], a[48:51], v[168:171]
v_mfma_f32_16x16x32_bf16 v[168:171], a[92:95], a[52:55], v[168:171]
v_mfma_f32_16x16x32_bf16 v[176:179], a[92:95], a[60:63], v[176:179]
v_mfma_f32_16x16x32_bf16 v[176:179], a[88:91], a[56:59], v[176:179]
s_add_u32 m0, s78, 151552
ds_read_b64_tr_b16 a[88:89], v8 offset:0
v_mfma_f32_16x16x32_bf16 v[180:183], a[96:99], a[56:59], v[180:183]
s_add_u32 s64, s75, 5900288
ds_read_b64_tr_b16 a[90:91], v8 offset:1024
v_mfma_f32_16x16x32_bf16 v[180:183], a[100:103], a[60:63], v[180:183]
buffer_load_dwordx4 v23, s[60:63], s64 offen lds
v_mfma_f32_16x16x32_bf16 v[172:175], a[100:103], a[52:55], v[172:175]
ds_read_b64_tr_b16 a[92:93], v8 offset:8192
v_add_u32 v4, 0x8000, v4
v_mfma_f32_16x16x32_bf16 v[172:175], a[96:99], a[48:51], v[172:175]
ds_read_b64_tr_b16 a[94:95], v8 offset:9216
v_mfma_f32_16x16x32_bf16 v[164:167], a[96:99], a[40:43], v[164:167]
v_mfma_f32_16x16x32_bf16 v[164:167], a[100:103], a[44:47], v[164:167]
s_xor_b32 m0, s77, 133120
v_mfma_f32_16x16x32_bf16 v[156:159], a[100:103], a[36:39], v[156:159]
s_xor_b32 s64, s71, 7929856
v_mfma_f32_16x16x32_bf16 v[156:159], a[96:99], a[32:35], v[156:159]
buffer_load_dwordx4 v15, s[56:59], s64 offen lds
v_mfma_f32_16x16x32_bf16 v[24:27], a[104:107], a[32:35], v[24:27]
ds_read_b64_tr_b16 a[96:97], v9 offset:0
v_mfma_f32_16x16x32_bf16 v[24:27], a[108:111], a[36:39], v[24:27]
ds_read_b64_tr_b16 a[98:99], v9 offset:1024
v_add_u32 v5, 0x8000, v5
v_mfma_f32_16x16x32_bf16 v[40:43], a[108:111], a[44:47], v[40:43]
ds_read_b64_tr_b16 a[100:101], v9 offset:8192
v_mfma_f32_16x16x32_bf16 v[40:43], a[104:107], a[40:43], v[40:43]
s_add_u32 m0, s78, 155648
ds_read_b64_tr_b16 a[102:103], v9 offset:9216
v_mfma_f32_16x16x32_bf16 v[56:59], a[104:107], a[48:51], v[56:59]
s_add_u32 s64, s75, 5902336
v_mfma_f32_16x16x32_bf16 v[56:59], a[108:111], a[52:55], v[56:59]
buffer_load_dwordx4 v23, s[60:63], s64 offen lds
v_mfma_f32_16x16x32_bf16 v[72:75], a[108:111], a[60:63], v[72:75]
s_waitcnt vmcnt(15)
ds_read_b128 a[0:3], v2 offset:0
v_mfma_f32_16x16x32_bf16 v[72:75], a[104:107], a[56:59], v[72:75]
s_waitcnt lgkmcnt(5)
ds_read_b128 a[4:7], v3 offset:0
v_mfma_f32_16x16x32_bf16 v[136:139], a[112:115], a[56:59], v[136:139]
ds_read_b128 a[8:11], v2 offset:2048
v_mfma_f32_16x16x32_bf16 v[136:139], a[116:119], a[60:63], v[136:139]
s_xor_b32 m0, s77, 134144
ds_read_b128 a[12:15], v3 offset:2048
v_add_u32 v6, 0x8000, v6
v_mfma_f32_16x16x32_bf16 v[120:123], a[116:119], a[52:55], v[120:123]
s_xor_b32 s64, s71, 7962624
ds_read_b128 a[16:19], v2 offset:4096
v_mfma_f32_16x16x32_bf16 v[120:123], a[112:115], a[48:51], v[120:123]
buffer_load_dwordx4 v15, s[56:59], s64 offen lds
v_mfma_f32_16x16x32_bf16 v[104:107], a[112:115], a[40:43], v[104:107]
ds_read_b128 a[20:23], v3 offset:4096
v_mfma_f32_16x16x32_bf16 v[104:107], a[116:119], a[44:47], v[104:107]
ds_read_b128 a[24:27], v2 offset:6144
v_mfma_f32_16x16x32_bf16 v[88:91], a[116:119], a[36:39], v[88:91]
ds_read_b128 a[28:31], v3 offset:6144
v_mfma_f32_16x16x32_bf16 v[88:91], a[112:115], a[32:35], v[88:91]
ds_read_b64_tr_b16 a[104:105], v10 offset:0
v_mfma_f32_16x16x32_bf16 v[28:31], a[72:75], a[32:35], v[28:31]
ds_read_b64_tr_b16 a[106:107], v10 offset:1024
v_mfma_f32_16x16x32_bf16 v[28:31], a[76:79], a[36:39], v[28:31]
ds_read_b64_tr_b16 a[108:109], v10 offset:8192
v_add_u32 v7, 0x8000, v7
v_mfma_f32_16x16x32_bf16 v[44:47], a[76:79], a[44:47], v[44:47]
ds_read_b64_tr_b16 a[110:111], v10 offset:9216
v_mfma_f32_16x16x32_bf16 v[44:47], a[72:75], a[40:43], v[44:47]
ds_read_b64_tr_b16 a[112:113], v11 offset:0
v_mfma_f32_16x16x32_bf16 v[60:63], a[72:75], a[48:51], v[60:63]
ds_read_b64_tr_b16 a[114:115], v11 offset:1024
v_mfma_f32_16x16x32_bf16 v[60:63], a[76:79], a[52:55], v[60:63]
ds_read_b64_tr_b16 a[116:117], v11 offset:8192
v_mfma_f32_16x16x32_bf16 v[76:79], a[76:79], a[60:63], v[76:79]
ds_read_b64_tr_b16 a[118:119], v11 offset:9216
v_mfma_f32_16x16x32_bf16 v[76:79], a[72:75], a[56:59], v[76:79]
v_mfma_f32_16x16x32_bf16 v[140:143], a[80:83], a[56:59], v[140:143]
v_mfma_f32_16x16x32_bf16 v[140:143], a[84:87], a[60:63], v[140:143]
v_add_u32 v8, 0x8000, v8
v_mfma_f32_16x16x32_bf16 v[124:127], a[84:87], a[52:55], v[124:127]
v_lshrrev_b32 v23, 2, v0
v_mul_u32_u24 v23, 3584, v23
v_mfma_f32_16x16x32_bf16 v[124:127], a[80:83], a[48:51], v[124:127]
v_lshl_add_u32 v23, v0, 7, v23
v_mfma_f32_16x16x32_bf16 v[108:111], a[80:83], a[40:43], v[108:111]
v_mfma_f32_16x16x32_bf16 v[108:111], a[84:87], a[44:47], v[108:111]
v_mfma_f32_16x16x32_bf16 v[92:95], a[84:87], a[36:39], v[92:95]
v_add_u32 v9, 0x8000, v9
v_add_u32 v10, 0x8000, v10
v_mfma_f32_16x16x32_bf16 v[92:95], a[80:83], a[32:35], v[92:95]
v_add_u32 v11, 0x8000, v11
v_mfma_f32_16x16x32_bf16 v[32:35], a[88:91], a[32:35], v[32:35]
s_waitcnt vmcnt(15)
v_readfirstlane_b32 vcc_lo, v1
s_nop 0
s_cmp_lt_u32 vcc_lo, s81
s_cbranch_scc1 L_spin_4
L_spinbk_5:
v_mfma_f32_16x16x32_bf16 v[32:35], a[92:95], a[36:39], v[32:35]
buffer_load_dwordx2 a[64:65], v22, s[44:47], s86 offen offset:0 sc1
v_mfma_f32_16x16x32_bf16 v[48:51], a[92:95], a[44:47], v[48:51]
s_waitcnt lgkmcnt(0)
s_barrier
v_mfma_f32_16x16x32_bf16 v[48:51], a[88:91], a[40:43], v[48:51]
ds_read_b64_tr_b16 a[72:73], v19 offset:4096
v_cmp_gt_i32 s[0:1], 0, v18
v_mfma_f32_16x16x32_bf16 v[64:67], a[88:91], a[48:51], v[64:67]
s_lshl2_add_u32 s72, s2, s30
ds_read_b64_tr_b16 a[74:75], v19 offset:4352
v_cmp_gt_i32 s[4:5], 1, v18
v_mfma_f32_16x16x32_bf16 v[64:67], a[92:95], a[52:55], v[64:67]
s_lshl_b32 s72, s72, 12
s_mov_b32 m0, s76
ds_read_b64_tr_b16 a[76:77], v19 offset:6144
v_cmp_gt_i32 s[6:7], 2, v18
v_mfma_f32_16x16x32_bf16 v[80:83], a[92:95], a[60:63], v[80:83]
s_add_u32 s72, s72, 67108864
s_lshl_b32 s64, s30, 14
ds_read_b64_tr_b16 a[78:79], v19 offset:6400
v_cmp_gt_i32 s[8:9], 3, v18
v_mfma_f32_16x16x32_bf16 v[80:83], a[88:91], a[56:59], v[80:83]
s_lshr_b32 s17, s78, 1
buffer_load_dwordx4 v16, s[32:35], s64 offen offset:0 sc1 lds
v_mfma_f32_16x16x32_bf16 v[144:147], a[96:99], a[56:59], v[144:147]
s_add_u32 s17, s17, L_base-L_pc-4+53248
buffer_load_dwordx2 a[66:67], v22, s[44:47], s86 offen offset:512 sc1
v_mfma_f32_16x16x32_bf16 v[144:147], a[100:103], a[60:63], v[144:147]
buffer_load_dword a252, v23, s[88:91], s17 offen
v_mfma_f32_16x16x32_bf16 v[128:131], a[100:103], a[52:55], v[128:131]
buffer_load_dwordx2 a[68:69], v22, s[44:47], s87 offen offset:0 sc1
v_mfma_f32_16x16x32_bf16 v[128:131], a[96:99], a[48:51], v[128:131]
buffer_load_dwordx2 a[70:71], v22, s[44:47], s87 offen offset:512 sc1
v_mfma_f32_16x16x32_bf16 v[112:115], a[96:99], a[40:43], v[112:115]
ds_read_b64_tr_b16 a[80:81], v20 offset:4096
v_cmp_gt_i32 s[10:11], 16, v18
v_mfma_f32_16x16x32_bf16 v[112:115], a[100:103], a[44:47], v[112:115]
ds_read_b64_tr_b16 a[82:83], v20 offset:4352
v_cmp_gt_i32 s[12:13], 17, v18
v_mfma_f32_16x16x32_bf16 v[96:99], a[100:103], a[36:39], v[96:99]
ds_read_b64_tr_b16 a[84:85], v20 offset:6144
v_cmp_gt_i32 s[18:19], 18, v18
v_mfma_f32_16x16x32_bf16 v[96:99], a[96:99], a[32:35], v[96:99]
buffer_load_dwordx4 v16, s[32:35], s64 offen offset:1024 sc1 lds
v_mfma_f32_16x16x32_bf16 v[36:39], a[104:107], a[32:35], v[36:39]
buffer_store_dwordx4 a[240:243], v16, s[44:47], s72 offen offset:0 sc1
v_mfma_f32_16x16x32_bf16 v[36:39], a[108:111], a[36:39], v[36:39]
ds_read_b64_tr_b16 a[86:87], v20 offset:6400
v_cmp_gt_i32 s[22:23], 19, v18
v_mfma_f32_16x16x32_bf16 v[52:55], a[108:111], a[44:47], v[52:55]
ds_read_b64_tr_b16 a[88:89], v19 offset:8192
v_cmp_gt_i32 s[26:27], 32, v18
v_mfma_f32_16x16x32_bf16 v[52:55], a[104:107], a[40:43], v[52:55]
ds_read_b64_tr_b16 a[90:91], v19 offset:8448
v_cmp_gt_i32 s[56:57], 33, v18
v_mfma_f32_16x16x32_bf16 v[68:71], a[104:107], a[48:51], v[68:71]
ds_read_b64_tr_b16 a[92:93], v19 offset:10240
v_cmp_gt_i32 s[58:59], 34, v18
v_mfma_f32_16x16x32_bf16 v[68:71], a[108:111], a[52:55], v[68:71]
ds_read_b64_tr_b16 a[94:95], v19 offset:10496
v_cmp_gt_i32 s[60:61], 35, v18
v_mfma_f32_16x16x32_bf16 v[84:87], a[108:111], a[60:63], v[84:87]
ds_read_b64_tr_b16 a[96:97], v20 offset:8192
v_cmp_gt_i32 s[62:63], 48, v18
v_mfma_f32_16x16x32_bf16 v[84:87], a[104:107], a[56:59], v[84:87]
buffer_load_dwordx4 v16, s[32:35], s64 offen offset:2048 sc1 lds
v_mfma_f32_16x16x32_bf16 v[148:151], a[112:115], a[56:59], v[148:151]
ds_read_b64_tr_b16 a[98:99], v20 offset:8448
v_cmp_gt_i32 s[48:49], 49, v18
v_mfma_f32_16x16x32_bf16 v[148:151], a[116:119], a[60:63], v[148:151]
ds_read_b64_tr_b16 a[100:101], v20 offset:10240
v_cmp_gt_i32 s[50:51], 50, v18
v_mfma_f32_16x16x32_bf16 v[132:135], a[116:119], a[52:55], v[132:135]
ds_read_b64_tr_b16 a[102:103], v20 offset:10496
v_cmp_gt_i32 s[100:101], 51, v18
v_mfma_f32_16x16x32_bf16 v[132:135], a[112:115], a[48:51], v[132:135]
ds_read_b64_tr_b16 a[104:105], v19 offset:0
v_mfma_f32_16x16x32_bf16 v[116:119], a[112:115], a[40:43], v[116:119]
ds_read_b64_tr_b16 a[106:107], v19 offset:256
v_mfma_f32_16x16x32_bf16 v[116:119], a[116:119], a[44:47], v[116:119]
ds_read_b64_tr_b16 a[108:109], v19 offset:2048
v_mfma_f32_16x16x32_bf16 v[100:103], a[116:119], a[36:39], v[100:103]
buffer_store_dwordx4 a[240:243], v16, s[44:47], s72 offen offset:1024 sc1
v_mfma_f32_16x16x32_bf16 v[100:103], a[112:115], a[32:35], v[100:103]
s_waitcnt lgkmcnt(7)
buffer_load_dwordx4 v16, s[32:35], s64 offen offset:3072 sc1 lds
v_mfma_f32_16x16x32_bf16 v[184:187], a[72:75], a[0:3], v[184:187]
s_waitcnt vmcnt(18)
s_and_b32 s66, s2, 7
ds_read_b128 a[32:35], v2 offset:32768
v_mfma_f32_16x16x32_bf16 v[184:187], a[76:79], a[4:7], v[184:187]
s_lshr_b32 s67, s2, 3
s_and_b32 s83, s66, 1
ds_read_b128 a[36:39], v3 offset:32768
v_mfma_f32_16x16x32_bf16 v[192:195], a[76:79], a[12:15], v[192:195]
s_and_b32 s68, s66, 2
s_and_b32 s69, s67, 7
ds_read_b128 a[40:43], v2 offset:34816
v_mfma_f32_16x16x32_bf16 v[192:195], a[72:75], a[8:11], v[192:195]
s_lshl2_add_u32 s82, s68, s69
s_and_b32 s68, s66, 4
ds_read_b128 a[44:47], v3 offset:34816
v_mfma_f32_16x16x32_bf16 v[200:203], a[72:75], a[16:19], v[200:203]
s_lshr_b32 s69, s67, 3
s_xor_b32 s69, s69, 0
ds_read_b128 a[48:51], v2 offset:36864
v_mfma_f32_16x16x32_bf16 v[200:203], a[76:79], a[20:23], v[200:203]
s_add_u32 s87, s68, s69
s_lshl_b32 s87, s87, 8
s_add_u32 m0, s76, 4096
ds_read_b128 a[52:55], v3 offset:36864
v_mfma_f32_16x16x32_bf16 v[208:211], a[76:79], a[28:31], v[208:211]
s_lshl_b32 s86, s30, 13
s_lshl_b32 s85, s30, 16
s_add_u32 s64, s64, 4096
ds_read_b128 a[56:59], v2 offset:38912
v_mfma_f32_16x16x32_bf16 v[208:211], a[72:75], a[24:27], v[208:211]
s_add_u32 s85, s85, s87
buffer_load_dwordx4 v16, s[32:35], s64 offen offset:0 sc1 lds
v_mfma_f32_16x16x32_bf16 v[212:215], a[80:83], a[24:27], v[212:215]
s_mul_i32 s66, s83, 1310720
s_add_u32 s85, s85, s66
ds_read_b128 a[60:63], v3 offset:38912
v_mfma_f32_16x16x32_bf16 v[212:215], a[84:87], a[28:31], v[212:215]
s_mul_i32 s84, s82, 1310720
s_and_b32 s66, s30, 1
ds_read_b64_tr_b16 a[110:111], v19 offset:2304
v_mfma_f32_16x16x32_bf16 v[204:207], a[84:87], a[20:23], v[204:207]
s_lshl_b32 s66, s66, 14
s_add_u32 s84, s84, s66
ds_read_b64_tr_b16 a[112:113], v20 offset:0
v_mfma_f32_16x16x32_bf16 v[204:207], a[80:83], a[16:19], v[204:207]
s_mul_i32 s66, s83, 163840
s_add_u32 s84, s84, s66
ds_read_b64_tr_b16 a[114:115], v20 offset:256
v_mfma_f32_16x16x32_bf16 v[196:199], a[80:83], a[8:11], v[196:199]
s_add_u32 s84, s84, 34603008
s_sub_u32 s66, 15, s82
ds_read_b64_tr_b16 a[116:117], v20 offset:2048
v_mfma_f32_16x16x32_bf16 v[196:199], a[84:87], a[12:15], v[196:199]
s_min_u32 s66, s66, s82
s_lshl1_add_u32 s66, s66, s83
ds_read_b64_tr_b16 a[118:119], v20 offset:2304
v_mfma_f32_16x16x32_bf16 v[188:191], a[84:87], a[4:7], v[188:191]
s_lshl_b32 s80, s66, 8
buffer_store_dwordx4 a[240:243], v16, s[44:47], s72 offen offset:2048 sc1
v_mfma_f32_16x16x32_bf16 v[188:191], a[80:83], a[0:3], v[188:191]
s_add_u32 s80, s80, 8192
buffer_load_dwordx4 v16, s[32:35], s64 offen offset:1024 sc1 lds
v_mfma_f32_16x16x32_bf16 v[216:219], a[0:3], a[88:91], v[216:219]
s_and_b32 s67, s30, 1
s_lshl_b32 s67, s67, 7
s_add_u32 s67, s67, s83
v_mfma_f32_16x16x32_bf16 v[216:219], a[4:7], a[92:95], v[216:219]
s_lshl_b32 s67, s67, 7
s_add_u32 s67, s67, 98304
s_lshl_b32 s66, s30, 11
v_mfma_f32_16x16x32_bf16 v[224:227], a[12:15], a[92:95], v[224:227]
s_waitcnt vmcnt(14) lgkmcnt(0)
s_barrier
v_mfma_f32_16x16x32_bf16 v[224:227], a[8:11], a[88:91], v[224:227]
ds_read_b64_tr_b16 a[72:73], v19 offset:36864
v_lshrrev_b32 v14, 4, v0
v_mfma_f32_16x16x32_bf16 v[232:235], a[16:19], a[88:91], v[232:235]
ds_read_b64_tr_b16 a[74:75], v19 offset:37120
v_bfe_u32 v12, v0, 1, 3
v_mfma_f32_16x16x32_bf16 v[232:235], a[20:23], a[92:95], v[232:235]
ds_read_b64_tr_b16 a[76:77], v19 offset:38912
v_xor_b32 v12, v12, v14
v_mfma_f32_16x16x32_bf16 v[240:243], a[28:31], a[92:95], v[240:243]
ds_read_b64_tr_b16 a[78:79], v19 offset:39168
v_lshlrev_b32 v12, 5, v12
v_mfma_f32_16x16x32_bf16 v[240:243], a[24:27], a[88:91], v[240:243]
buffer_load_dwordx4 v16, s[32:35], s64 offen offset:2048 sc1 lds
v_mfma_f32_16x16x32_bf16 v[244:247], a[24:27], a[96:99], v[244:247]
ds_read_b64_tr_b16 a[80:81], v20 offset:36864
v_lshl_add_u32 v12, v14, 11, v12
v_mfma_f32_16x16x32_bf16 v[244:247], a[28:31], a[100:103], v[244:247]
ds_read_b64_tr_b16 a[82:83], v20 offset:37120
v_and_b32 v14, 1, v0
v_mfma_f32_16x16x32_bf16 v[236:239], a[20:23], a[100:103], v[236:239]
buffer_store_dwordx4 a[240:243], v16, s[44:47], s72 offen offset:3072 sc1
v_mfma_f32_16x16x32_bf16 v[236:239], a[16:19], a[96:99], v[236:239]
ds_read_b64_tr_b16 a[84:85], v20 offset:38912
v_lshl_add_u32 v12, v14, 4, v12
v_mfma_f32_16x16x32_bf16 v[228:231], a[8:11], a[96:99], v[228:231]
ds_read_b64_tr_b16 a[86:87], v20 offset:39168
v_xor_b32 v13, 128, v12
v_mfma_f32_16x16x32_bf16 v[228:231], a[12:15], a[100:103], v[228:231]
ds_read_b64_tr_b16 a[88:89], v19 offset:40960
v_lshrrev_b32 v14, 4, v0
v_mfma_f32_16x16x32_bf16 v[220:223], a[4:7], a[100:103], v[220:223]
ds_read_b64_tr_b16 a[90:91], v19 offset:41216
v_bfe_u32 v18, v0, 2, 2
v_mfma_f32_16x16x32_bf16 v[220:223], a[0:3], a[96:99], v[220:223]
buffer_load_dwordx4 v16, s[32:35], s64 offen offset:3072 sc1 lds
v_mfma_f32_16x16x32_bf16 v[152:155], a[104:107], a[0:3], v[152:155]
ds_read_b64_tr_b16 a[92:93], v19 offset:43008
v_lshl_add_u32 v14, v14, 2, v18
v_mfma_f32_16x16x32_bf16 v[152:155], a[108:111], a[4:7], v[152:155]
ds_read_b64_tr_b16 a[94:95], v19 offset:43264
v_and_b32 v18, 3, v0
v_mfma_f32_16x16x32_bf16 v[160:163], a[108:111], a[12:15], v[160:163]
s_branch L_po13
L_pg13:
s_branch L_tr1
L_po13:
s_lshr_b32 s64, s76, 1
ds_read_b64_tr_b16 a[96:97], v20 offset:40960
v_lshlrev_b32 v18, 3, v18
v_mfma_f32_16x16x32_bf16 v[160:163], a[104:107], a[8:11], v[160:163]
s_add_u32 m0, s64, 81920
ds_read_b64_tr_b16 a[98:99], v20 offset:41216
v_lshl_add_u32 v18, v14, 8, v18
v_mfma_f32_16x16x32_bf16 v[168:171], a[104:107], a[16:19], v[168:171]
s_and_b32 s71, s64, 8192
ds_read_b64_tr_b16 a[100:101], v20 offset:43008
v_and_b32 v14, 7, v14
v_mfma_f32_16x16x32_bf16 v[168:171], a[108:111], a[20:23], v[168:171]
s_add_u32 s64, s64, s71
ds_read_b64_tr_b16 a[102:103], v20 offset:43264
v_lshl_add_u32 v18, v14, 5, v18
v_mfma_f32_16x16x32_bf16 v[176:179], a[108:111], a[28:31], v[176:179]
s_add_u32 s64, s64, 8192
v_xor_b32 v18, s67, v18
v_add_u32 v14, s66, v16
v_mfma_f32_16x16x32_bf16 v[176:179], a[104:107], a[24:27], v[176:179]
buffer_load_dwordx4 v16, s[32:35], s64 offen offset:0 sc1 lds
v_mfma_f32_16x16x32_bf16 v[180:183], a[112:115], a[24:27], v[180:183]
s_cmp_eq_u32 s30, 0
s_cbranch_scc1 L_pg14
s_cmp_eq_u32 s30, 1
s_cbranch_scc1 L_pg15
s_cmp_eq_u32 s30, 2
s_cbranch_scc1 L_pg16
s_branch L_pg17
L_tr2:
s_cmp_lg_u32 s3, 0
s_cbranch_scc1 L_tr3
s_cmp_eq_u32 s30, 0
s_cbranch_scc1 L_pg18
s_cmp_eq_u32 s30, 1
s_cbranch_scc1 L_pg26
s_cmp_eq_u32 s30, 2
s_cbranch_scc1 L_pg27
s_branch L_tr3
L_tr3:
s_cmp_lg_u32 s3, 7
s_cbranch_scc1 L_tr4
s_cmp_eq_u32 s30, 0
s_cbranch_scc1 L_pg21
s_cmp_eq_u32 s30, 1
s_cbranch_scc1 L_pg28
s_cmp_eq_u32 s30, 2
s_cbranch_scc1 L_pg29
s_branch L_tr4
L_tr4:
v_mfma_f32_16x16x32_bf16 v[180:183], a[116:119], a[28:31], v[180:183]
ds_read_b64_tr_b16 a[104:105], v19 offset:32768
v_xor_b32 v15, 0x800, v14
v_mfma_f32_16x16x32_bf16 v[172:175], a[116:119], a[20:23], v[172:175]
s_lshl2_add_u32 s73, s2, s30
s_lshl_b32 s73, s73, 11
s_lshl1_add_u32 s66, s78, 32768
v_mfma_f32_16x16x32_bf16 v[172:175], a[112:115], a[16:19], v[172:175]
ds_read_b64_tr_b16 a[106:107], v19 offset:33024
v_add_u32 v2, s66, v16
v_mfma_f32_16x16x32_bf16 v[164:167], a[112:115], a[8:11], v[164:167]
ds_read_b64_tr_b16 a[108:109], v19 offset:34816
v_bfe_u32 v1, v0, 1, 1
v_mfma_f32_16x16x32_bf16 v[164:167], a[116:119], a[12:15], v[164:167]
ds_read_b64_tr_b16 a[110:111], v19 offset:35072
v_subrev_u32 v1, 1, v1
v_mfma_f32_16x16x32_bf16 v[156:159], a[116:119], a[4:7], v[156:159]
s_or_b32 s66, s3, s30
s_cmp_eq_u32 s66, 0
s_cselect_b32 s66, 0xff800000, 0
v_mfma_f32_16x16x32_bf16 v[156:159], a[112:115], a[0:3], v[156:159]
s_waitcnt lgkmcnt(4)
buffer_load_dwordx4 v16, s[32:35], s64 offen offset:1024 sc1 lds
v_mfma_f32_16x16x32_bf16 v[184:187], a[72:75], a[32:35], v[184:187]
ds_read_b64_tr_b16 a[112:113], v20 offset:32768
v_and_b32 v1, 0x3f803f80, v1
v_mfma_f32_16x16x32_bf16 v[184:187], a[76:79], a[36:39], v[184:187]
ds_read_b64_tr_b16 a[114:115], v20 offset:33024
v_accvgpr_write_b32 a240, v1
v_mfma_f32_16x16x32_bf16 v[192:195], a[76:79], a[44:47], v[192:195]
ds_read_b64_tr_b16 a[116:117], v20 offset:34816
v_accvgpr_write_b32 a241, v1
v_mfma_f32_16x16x32_bf16 v[192:195], a[72:75], a[40:43], v[192:195]
ds_read_b64_tr_b16 a[118:119], v20 offset:35072
v_accvgpr_write_b32 a242, v1
v_mfma_f32_16x16x32_bf16 v[200:203], a[72:75], a[48:51], v[200:203]
s_and_b32 s67, s74, 0x7800
s_cselect_b32 s67, 0, 0x70000000
s_add_u32 s77, s74, s67
v_mfma_f32_16x16x32_bf16 v[200:203], a[76:79], a[52:55], v[200:203]
s_sub_u32 s77, s77, 2048
v_accvgpr_write_b32 a243, v1
v_mfma_f32_16x16x32_bf16 v[208:211], a[76:79], a[60:63], v[208:211]
s_mov_b32 s68, 0x3e0293ee
v_mfma_f32_16x16x32_bf16 v[208:211], a[72:75], a[56:59], v[208:211]
s_mov_b32 s69, s68
buffer_load_dwordx4 v16, s[32:35], s64 offen offset:2048 sc1 lds
v_mfma_f32_16x16x32_bf16 v[212:215], a[80:83], a[56:59], v[212:215]
ds_read_b64_tr_b16 a[72:73], v4 offset:0
v_mfma_f32_16x16x32_bf16 v[212:215], a[84:87], a[60:63], v[212:215]
ds_read_b64_tr_b16 a[74:75], v4 offset:1024
v_mfma_f32_16x16x32_bf16 v[204:207], a[84:87], a[52:55], v[204:207]
ds_read_b64_tr_b16 a[76:77], v4 offset:8192
v_mfma_f32_16x16x32_bf16 v[204:207], a[80:83], a[48:51], v[204:207]
ds_read_b64_tr_b16 a[78:79], v4 offset:9216
v_mfma_f32_16x16x32_bf16 v[196:199], a[80:83], a[40:43], v[196:199]
v_mfma_f32_16x16x32_bf16 v[196:199], a[84:87], a[44:47], v[196:199]
v_mfma_f32_16x16x32_bf16 v[188:191], a[84:87], a[36:39], v[188:191]
v_mfma_f32_16x16x32_bf16 v[188:191], a[80:83], a[32:35], v[188:191]
buffer_load_dwordx4 v16, s[32:35], s64 offen offset:3072 sc1 lds
v_mfma_f32_16x16x32_bf16 v[216:219], a[32:35], a[88:91], v[216:219]
ds_read_b64_tr_b16 a[80:81], v4 offset:32768
v_mfma_f32_16x16x32_bf16 v[216:219], a[36:39], a[92:95], v[216:219]
ds_read_b64_tr_b16 a[82:83], v4 offset:33792
v_cvt_pk_bf16_f32 v208, v208, v209
v_mfma_f32_16x16x32_bf16 v[224:227], a[44:47], a[92:95], v[224:227]
ds_read_b64_tr_b16 a[84:85], v4 offset:40960
v_cvt_pk_bf16_f32 v209, v210, v211
v_mfma_f32_16x16x32_bf16 v[224:227], a[40:43], a[88:91], v[224:227]
ds_read_b64_tr_b16 a[86:87], v4 offset:41984
v_cvt_pk_bf16_f32 v210, v212, v213
v_mfma_f32_16x16x32_bf16 v[232:235], a[48:51], a[88:91], v[232:235]
v_cvt_pk_bf16_f32 v211, v214, v215
v_mfma_f32_16x16x32_bf16 v[232:235], a[52:55], a[92:95], v[232:235]
ds_write_b128 v2, v[208:211] offset:30720
v_mfma_f32_16x16x32_bf16 v[240:243], a[60:63], a[92:95], v[240:243]
v_cvt_pk_bf16_f32 v200, v200, v201
v_cvt_pk_bf16_f32 v201, v202, v203
v_mfma_f32_16x16x32_bf16 v[240:243], a[56:59], a[88:91], v[240:243]
ds_read_b64_tr_b16 a[88:89], v5 offset:0
v_cvt_pk_bf16_f32 v202, v204, v205
v_mfma_f32_16x16x32_bf16 v[244:247], a[56:59], a[96:99], v[244:247]
ds_read_b64_tr_b16 a[90:91], v5 offset:1024
v_cvt_pk_bf16_f32 v203, v206, v207
v_mfma_f32_16x16x32_bf16 v[244:247], a[60:63], a[100:103], v[244:247]
ds_write_b128 v2, v[200:203] offset:22528
v_mfma_f32_16x16x32_bf16 v[236:239], a[52:55], a[100:103], v[236:239]
ds_read_b64_tr_b16 a[92:93], v5 offset:8192
v_cvt_pk_bf16_f32 v192, v192, v193
v_mfma_f32_16x16x32_bf16 v[236:239], a[48:51], a[96:99], v[236:239]
ds_read_b64_tr_b16 a[94:95], v5 offset:9216
v_cvt_pk_bf16_f32 v193, v194, v195
v_mfma_f32_16x16x32_bf16 v[228:231], a[40:43], a[96:99], v[228:231]
v_cvt_pk_bf16_f32 v194, v196, v197
v_cvt_pk_bf16_f32 v195, v198, v199
v_mfma_f32_16x16x32_bf16 v[228:231], a[44:47], a[100:103], v[228:231]
ds_write_b128 v2, v[192:195] offset:10240
v_mfma_f32_16x16x32_bf16 v[220:223], a[36:39], a[100:103], v[220:223]
v_cvt_pk_bf16_f32 v184, v184, v185
v_cvt_pk_bf16_f32 v185, v186, v187
v_mfma_f32_16x16x32_bf16 v[220:223], a[32:35], a[96:99], v[220:223]
s_waitcnt lgkmcnt(6)
ds_read_b64_tr_b16 a[96:97], v5 offset:32768
v_cvt_pk_bf16_f32 v186, v188, v189
v_mfma_f32_16x16x32_bf16 v[152:155], a[104:107], a[32:35], v[152:155]
ds_read_b64_tr_b16 a[98:99], v5 offset:33792
v_cvt_pk_bf16_f32 v187, v190, v191
v_mfma_f32_16x16x32_bf16 v[152:155], a[108:111], a[36:39], v[152:155]
ds_write_b128 v2, v[184:187] offset:2048
v_mfma_f32_16x16x32_bf16 v[160:163], a[108:111], a[44:47], v[160:163]
buffer_load_dword a252, v21, s[36:39], s73 offen
v_mfma_f32_16x16x32_bf16 v[160:163], a[104:107], a[40:43], v[160:163]
ds_read_b64_tr_b16 a[100:101], v5 offset:40960
v_cvt_pk_bf16_f32 v243, v242, v243
v_mfma_f32_16x16x32_bf16 v[168:171], a[104:107], a[48:51], v[168:171]
ds_read_b64_tr_b16 a[102:103], v5 offset:41984
v_cvt_pk_bf16_f32 v242, v240, v241
v_mfma_f32_16x16x32_bf16 v[168:171], a[108:111], a[52:55], v[168:171]
v_cvt_pk_bf16_f32 v240, v244, v245
v_cvt_pk_bf16_f32 v241, v246, v247
v_mfma_f32_16x16x32_bf16 v[176:179], a[108:111], a[60:63], v[176:179]
ds_write_b128 v2, v[240:243] offset:31744
v_mfma_f32_16x16x32_bf16 v[176:179], a[104:107], a[56:59], v[176:179]
ds_read_b64_tr_b16 a[104:105], v6 offset:0
v_mov_b32 v246, v240
v_mfma_f32_16x16x32_bf16 v[180:183], a[112:115], a[56:59], v[180:183]
ds_read_b64_tr_b16 a[106:107], v6 offset:1024
v_mov_b32 v247, v241
v_mfma_f32_16x16x32_bf16 v[180:183], a[116:119], a[60:63], v[180:183]
ds_read_b64_tr_b16 a[108:109], v6 offset:8192
v_cvt_pk_bf16_f32 v235, v234, v235
v_mfma_f32_16x16x32_bf16 v[172:175], a[116:119], a[52:55], v[172:175]
ds_read_b64_tr_b16 a[110:111], v6 offset:9216
v_cvt_pk_bf16_f32 v234, v232, v233
v_mfma_f32_16x16x32_bf16 v[172:175], a[112:115], a[48:51], v[172:175]
v_cvt_pk_bf16_f32 v232, v236, v237
v_cvt_pk_bf16_f32 v233, v238, v239
v_mfma_f32_16x16x32_bf16 v[164:167], a[112:115], a[40:43], v[164:167]
ds_write_b128 v2, v[232:235] offset:23552
v_mfma_f32_16x16x32_bf16 v[164:167], a[116:119], a[44:47], v[164:167]
v_mov_b32 v238, v232
v_mov_b32 v239, v233
v_mfma_f32_16x16x32_bf16 v[156:159], a[116:119], a[36:39], v[156:159]
v_cvt_pk_bf16_f32 v227, v226, v227
v_cvt_pk_bf16_f32 v226, v224, v225
v_mfma_f32_16x16x32_bf16 v[156:159], a[112:115], a[32:35], v[156:159]
ds_read_b64_tr_b16 a[112:113], v6 offset:32768
v_cvt_pk_bf16_f32 v224, v228, v229
v_mfma_f32_16x16x32_bf16 v[24:27], a[72:75], a[0:3], v[24:27]
ds_read_b64_tr_b16 a[114:115], v6 offset:33792
v_cvt_pk_bf16_f32 v225, v230, v231
v_mfma_f32_16x16x32_bf16 v[24:27], a[76:79], a[4:7], v[24:27]
ds_write_b128 v2, v[224:227] offset:11264
v_mfma_f32_16x16x32_bf16 v[24:27], a[80:83], a[32:35], v[24:27]
ds_read_b64_tr_b16 a[116:117], v6 offset:40960
v_mov_b32 v230, v224
v_mfma_f32_16x16x32_bf16 v[24:27], a[84:87], a[36:39], v[24:27]
ds_read_b64_tr_b16 a[118:119], v6 offset:41984
v_mov_b32 v231, v225
v_mfma_f32_16x16x32_bf16 v[40:43], a[84:87], a[44:47], v[40:43]
v_cvt_pk_bf16_f32 v219, v218, v219
v_cvt_pk_bf16_f32 v218, v216, v217
v_mfma_f32_16x16x32_bf16 v[40:43], a[80:83], a[40:43], v[40:43]
v_cvt_pk_bf16_f32 v216, v220, v221
v_cvt_pk_bf16_f32 v217, v222, v223
v_mfma_f32_16x16x32_bf16 v[40:43], a[76:79], a[12:15], v[40:43]
ds_write_b128 v2, v[216:219] offset:3072
v_mfma_f32_16x16x32_bf16 v[40:43], a[72:75], a[8:11], v[40:43]
v_mov_b32 v222, v216
v_mov_b32 v223, v217
v_mfma_f32_16x16x32_bf16 v[56:59], a[72:75], a[16:19], v[56:59]
v_mfma_f32_16x16x32_bf16 v[56:59], a[76:79], a[20:23], v[56:59]
s_waitcnt lgkmcnt(0)
s_barrier
v_mfma_f32_16x16x32_bf16 v[56:59], a[80:83], a[48:51], v[56:59]
ds_read_b128 a[192:195], v17 offset:16384
v_cvt_pk_bf16_f32 v176, v176, v177
v_mfma_f32_16x16x32_bf16 v[56:59], a[84:87], a[52:55], v[56:59]
v_cvt_pk_bf16_f32 v177, v178, v179
v_cvt_pk_bf16_f32 v178, v180, v181
v_mfma_f32_16x16x32_bf16 v[72:75], a[84:87], a[60:63], v[72:75]
v_cvt_pk_bf16_f32 v179, v182, v183
v_cvt_pk_bf16_f32 v168, v168, v169
v_mfma_f32_16x16x32_bf16 v[72:75], a[80:83], a[56:59], v[72:75]
v_cvt_pk_bf16_f32 v169, v170, v171
v_cvt_pk_bf16_f32 v170, v172, v173
v_mfma_f32_16x16x32_bf16 v[72:75], a[76:79], a[28:31], v[72:75]
v_cvt_pk_bf16_f32 v171, v174, v175
v_cvt_pk_bf16_f32 v160, v160, v161
v_mfma_f32_16x16x32_bf16 v[72:75], a[72:75], a[24:27], v[72:75]
ds_read_b64_tr_b16 a[72:73], v7 offset:0
v_cvt_pk_bf16_f32 v161, v162, v163
v_mfma_f32_16x16x32_bf16 v[136:139], a[88:91], a[24:27], v[136:139]
s_waitcnt lgkmcnt(1)
buffer_store_dwordx4 a[192:195], v16, s[44:47], s74 offen sc1
v_mfma_f32_16x16x32_bf16 v[136:139], a[92:95], a[28:31], v[136:139]
ds_read_b64_tr_b16 a[74:75], v7 offset:1024
v_cvt_pk_bf16_f32 v162, v164, v165
v_mfma_f32_16x16x32_bf16 v[136:139], a[96:99], a[56:59], v[136:139]
ds_read_b64_tr_b16 a[76:77], v7 offset:8192
v_cvt_pk_bf16_f32 v163, v166, v167
v_mfma_f32_16x16x32_bf16 v[136:139], a[100:103], a[60:63], v[136:139]
s_sub_u32 s81, s3, 1
ds_read_b64_tr_b16 a[78:79], v7 offset:9216
v_cvt_pk_bf16_f32 v152, v152, v153
v_mfma_f32_16x16x32_bf16 v[120:123], a[100:103], a[52:55], v[120:123]
s_sub_u32 s67, s3, 2
ds_read_b64_tr_b16 a[80:81], v7 offset:32768
v_cvt_pk_bf16_f32 v153, v154, v155
v_mfma_f32_16x16x32_bf16 v[120:123], a[96:99], a[48:51], v[120:123]
s_mul_i32 s81, s81, s67
ds_read_b64_tr_b16 a[82:83], v7 offset:33792
v_cvt_pk_bf16_f32 v154, v156, v157
v_mfma_f32_16x16x32_bf16 v[120:123], a[92:95], a[20:23], v[120:123]
s_lshl4_add_u32 s81, s81, s31
ds_read_b64_tr_b16 a[84:85], v7 offset:40960
v_cvt_pk_bf16_f32 v155, v158, v159
v_mfma_f32_16x16x32_bf16 v[120:123], a[88:91], a[16:19], v[120:123]
s_lshl2_add_u32 s81, s81, s30
ds_read_b64_tr_b16 a[86:87], v7 offset:41984
v_or_b32 v20, s66, v252
v_mfma_f32_16x16x32_bf16 v[104:107], a[88:91], a[8:11], v[104:107]
s_mul_i32 s81, s81, 3328
ds_read_b128 a[180:183], v2 offset:8192
v_or_b32 v21, s66, v253
v_mfma_f32_16x16x32_bf16 v[104:107], a[92:95], a[12:15], v[104:107]
s_mov_b32 s73, 0
ds_read_b128 a[188:191], v2 offset:28672
v_or_b32 v22, s66, v254
v_mfma_f32_16x16x32_bf16 v[104:107], a[96:99], a[40:43], v[104:107]
s_mov_b32 s72, 0x20000
ds_read_b64 v[224:225], v2 offset:9224
v_or_b32 v23, s66, v255
v_mfma_f32_16x16x32_bf16 v[104:107], a[100:103], a[44:47], v[104:107]
s_mov_b32 s66, 0x3e8293ee
ds_read_b64 v[228:229], v2 offset:9216
v_mul_f32 v72, s68, v72
v_mfma_f32_16x16x32_bf16 v[88:91], a[100:103], a[36:39], v[88:91]
s_lshl_b32 s67, s31, 15
ds_read_b64 v[240:241], v2 offset:29704
v_mul_f32 v73, s68, v73
v_mfma_f32_16x16x32_bf16 v[88:91], a[96:99], a[32:35], v[88:91]
s_add_u32 s67, s67, s78
ds_read_b64 v[244:245], v2 offset:29696
v_mul_f32 v74, s68, v74
v_mfma_f32_16x16x32_bf16 v[88:91], a[92:95], a[4:7], v[88:91]
s_add_u32 s67, s67, 33554432
v_mul_f32 v75, s68, v75
v_mul_f32 v136, s68, v136
v_mfma_f32_16x16x32_bf16 v[88:91], a[88:91], a[0:3], v[88:91]
s_mul_i32 s74, s3, 1310720
ds_read_b64_tr_b16 a[88:89], v8 offset:0
v_mul_f32 v137, s68, v137
v_mfma_f32_16x16x32_bf16 v[28:31], a[104:107], a[0:3], v[28:31]
s_add_u32 s74, s74, s67
ds_read_b64_tr_b16 a[90:91], v8 offset:1024
v_mul_f32 v138, s68, v138
v_mfma_f32_16x16x32_bf16 v[28:31], a[108:111], a[4:7], v[28:31]
s_mul_i32 s75, s16, 1310720
ds_read_b64_tr_b16 a[92:93], v8 offset:8192
v_mul_f32 v139, s68, v139
v_mfma_f32_16x16x32_bf16 v[28:31], a[112:115], a[32:35], v[28:31]
s_add_u32 s75, s75, s67
ds_read_b64_tr_b16 a[94:95], v8 offset:9216
v_cvt_pk_bf16_f32 v72, v72, v73
v_mfma_f32_16x16x32_bf16 v[28:31], a[116:119], a[36:39], v[28:31]
s_mul_i32 s67, s31, 24576
ds_read_b64_tr_b16 a[96:97], v8 offset:32768
v_cvt_pk_bf16_f32 v73, v74, v75
v_mfma_f32_16x16x32_bf16 v[44:47], a[116:119], a[44:47], v[44:47]
s_sub_u32 s67, 1048576, s67
ds_read_b64_tr_b16 a[98:99], v8 offset:33792
v_cvt_pk_bf16_f32 v74, v136, v137
v_mfma_f32_16x16x32_bf16 v[44:47], a[112:115], a[40:43], v[44:47]
s_add_u32 s64, s74, s67
ds_read_b64_tr_b16 a[100:101], v8 offset:40960
v_cvt_pk_bf16_f32 v75, v138, v139
v_mfma_f32_16x16x32_bf16 v[44:47], a[108:111], a[12:15], v[44:47]
s_add_u32 s65, s75, s67
ds_read_b64_tr_b16 a[102:103], v8 offset:41984
v_mul_f32 v56, s68, v56
v_mfma_f32_16x16x32_bf16 v[44:47], a[104:107], a[8:11], v[44:47]
s_and_b32 s70, s30, 1
v_mul_f32 v57, s68, v57
v_mul_f32 v58, s68, v58
v_mfma_f32_16x16x32_bf16 v[60:63], a[104:107], a[16:19], v[60:63]
s_lshr_b32 s67, s30, 1
v_mul_f32 v59, s68, v59
v_mul_f32 v120, s68, v120
v_mfma_f32_16x16x32_bf16 v[60:63], a[108:111], a[20:23], v[60:63]
s_lshl3_add_u32 s71, s67, s70
v_mul_f32 v121, s68, v121
v_mul_f32 v122, s68, v122
v_mfma_f32_16x16x32_bf16 v[60:63], a[112:115], a[48:51], v[60:63]
s_add_u32 s71, s71, 4
v_mul_f32 v123, s68, v123
v_cvt_pk_bf16_f32 v56, v56, v57
v_mfma_f32_16x16x32_bf16 v[60:63], a[116:119], a[52:55], v[60:63]
s_lshl_b32 s71, s71, 13
v_cvt_pk_bf16_f32 v57, v58, v59
v_cvt_pk_bf16_f32 v58, v120, v121
v_mfma_f32_16x16x32_bf16 v[76:79], a[116:119], a[60:63], v[76:79]
s_lshl_b32 s70, s70, 14
v_cvt_pk_bf16_f32 v59, v122, v123
v_mul_f32 v40, s68, v40
v_mfma_f32_16x16x32_bf16 v[76:79], a[112:115], a[56:59], v[76:79]
s_mul_i32 s67, s67, 24576
v_mul_f32 v41, s68, v41
v_mul_f32 v42, s68, v42
v_mfma_f32_16x16x32_bf16 v[76:79], a[108:111], a[28:31], v[76:79]
s_sub_u32 s70, s70, s67
v_mul_f32 v43, s68, v43
v_mul_f32 v104, s68, v104
v_mfma_f32_16x16x32_bf16 v[76:79], a[104:107], a[24:27], v[76:79]
s_waitcnt lgkmcnt(1)
s_add_u32 s70, s70, 65536
ds_read_b64_tr_b16 a[104:105], v9 offset:0
v_mul_f32 v105, s68, v105
v_mfma_f32_16x16x32_bf16 v[140:143], a[72:75], a[24:27], v[140:143]
ds_read_b64_tr_b16 a[106:107], v9 offset:1024
v_mul_f32 v106, s68, v106
v_mfma_f32_16x16x32_bf16 v[140:143], a[76:79], a[28:31], v[140:143]
ds_read_b64_tr_b16 a[108:109], v9 offset:8192
v_mul_f32 v107, s68, v107
v_mfma_f32_16x16x32_bf16 v[140:143], a[80:83], a[56:59], v[140:143]
ds_read_b64_tr_b16 a[110:111], v9 offset:9216
v_cvt_pk_bf16_f32 v40, v40, v41
v_mfma_f32_16x16x32_bf16 v[140:143], a[84:87], a[60:63], v[140:143]
ds_read_b64_tr_b16 a[112:113], v9 offset:32768
v_cvt_pk_bf16_f32 v41, v42, v43
v_mfma_f32_16x16x32_bf16 v[124:127], a[84:87], a[52:55], v[124:127]
ds_read_b64_tr_b16 a[114:115], v9 offset:33792
v_cvt_pk_bf16_f32 v42, v104, v105
v_mfma_f32_16x16x32_bf16 v[124:127], a[80:83], a[48:51], v[124:127]
ds_read_b64_tr_b16 a[116:117], v9 offset:40960
v_cvt_pk_bf16_f32 v43, v106, v107
v_mfma_f32_16x16x32_bf16 v[124:127], a[76:79], a[20:23], v[124:127]
ds_read_b64_tr_b16 a[118:119], v9 offset:41984
v_mul_f32 v24, s68, v24
v_mfma_f32_16x16x32_bf16 v[124:127], a[72:75], a[16:19], v[124:127]
v_mul_f32 v25, s68, v25
v_mul_f32 v26, s68, v26
v_mfma_f32_16x16x32_bf16 v[108:111], a[72:75], a[8:11], v[108:111]
v_mul_f32 v27, s68, v27
v_mul_f32 v88, s68, v88
v_mfma_f32_16x16x32_bf16 v[108:111], a[76:79], a[12:15], v[108:111]
v_mul_f32 v89, s68, v89
v_mul_f32 v90, s68, v90
v_mfma_f32_16x16x32_bf16 v[108:111], a[80:83], a[40:43], v[108:111]
v_mul_f32 v91, s68, v91
v_cvt_pk_bf16_f32 v24, v24, v25
v_mfma_f32_16x16x32_bf16 v[108:111], a[84:87], a[44:47], v[108:111]
v_cvt_pk_bf16_f32 v25, v26, v27
v_cvt_pk_bf16_f32 v26, v88, v89
v_mfma_f32_16x16x32_bf16 v[92:95], a[84:87], a[36:39], v[92:95]
v_cvt_pk_bf16_f32 v27, v90, v91
v_mul_f32 v76, s68, v76
v_mfma_f32_16x16x32_bf16 v[92:95], a[80:83], a[32:35], v[92:95]
v_mul_f32 v77, s68, v77
v_mul_f32 v78, s68, v78
v_mfma_f32_16x16x32_bf16 v[92:95], a[76:79], a[4:7], v[92:95]
v_mul_f32 v79, s68, v79
v_mul_f32 v140, s68, v140
v_mfma_f32_16x16x32_bf16 v[92:95], a[72:75], a[0:3], v[92:95]
ds_read_b64_tr_b16 a[72:73], v10 offset:0
v_mul_f32 v141, s68, v141
v_mfma_f32_16x16x32_bf16 v[32:35], a[88:91], a[0:3], v[32:35]
ds_read_b64_tr_b16 a[74:75], v10 offset:1024
v_mul_f32 v142, s68, v142
v_mfma_f32_16x16x32_bf16 v[32:35], a[92:95], a[4:7], v[32:35]
ds_read_b64_tr_b16 a[76:77], v10 offset:8192
v_mul_f32 v143, s68, v143
v_mfma_f32_16x16x32_bf16 v[32:35], a[96:99], a[32:35], v[32:35]
s_waitcnt lgkmcnt(3)
ds_read_b64_tr_b16 a[78:79], v10 offset:9216
v_cvt_pk_bf16_f32 v76, v76, v77
v_mfma_f32_16x16x32_bf16 v[32:35], a[100:103], a[36:39], v[32:35]
ds_read_b64_tr_b16 a[80:81], v10 offset:32768
v_cvt_pk_bf16_f32 v77, v78, v79
v_mfma_f32_16x16x32_bf16 v[48:51], a[100:103], a[44:47], v[48:51]
ds_read_b64_tr_b16 a[82:83], v10 offset:33792
v_cvt_pk_bf16_f32 v78, v140, v141
v_mfma_f32_16x16x32_bf16 v[48:51], a[96:99], a[40:43], v[48:51]
ds_read_b64_tr_b16 a[84:85], v10 offset:40960
v_cvt_pk_bf16_f32 v79, v142, v143
v_mfma_f32_16x16x32_bf16 v[48:51], a[92:95], a[12:15], v[48:51]
ds_read_b64_tr_b16 a[86:87], v10 offset:41984
v_mul_f32 v60, s68, v60
v_mfma_f32_16x16x32_bf16 v[48:51], a[88:91], a[8:11], v[48:51]
v_mul_f32 v61, s68, v61
v_mul_f32 v62, s68, v62
v_mfma_f32_16x16x32_bf16 v[64:67], a[88:91], a[16:19], v[64:67]
v_mul_f32 v63, s68, v63
v_mul_f32 v124, s68, v124
v_mfma_f32_16x16x32_bf16 v[64:67], a[92:95], a[20:23], v[64:67]
v_mul_f32 v125, s68, v125
v_mul_f32 v126, s68, v126
v_mfma_f32_16x16x32_bf16 v[64:67], a[96:99], a[48:51], v[64:67]
buffer_load_dwordx4 v[136:139], v16, s[44:47], s77 offen sc1
v_mfma_f32_16x16x32_bf16 v[64:67], a[100:103], a[52:55], v[64:67]
v_mul_f32 v127, s68, v127
v_cvt_pk_bf16_f32 v60, v60, v61
v_mfma_f32_16x16x32_bf16 v[80:83], a[100:103], a[60:63], v[80:83]
v_cvt_pk_bf16_f32 v61, v62, v63
v_cvt_pk_bf16_f32 v62, v124, v125
v_mfma_f32_16x16x32_bf16 v[80:83], a[96:99], a[56:59], v[80:83]
v_cvt_pk_bf16_f32 v63, v126, v127
v_mul_f32 v44, s68, v44
v_mfma_f32_16x16x32_bf16 v[80:83], a[92:95], a[28:31], v[80:83]
v_mul_f32 v45, s68, v45
v_mul_f32 v46, s68, v46
v_mfma_f32_16x16x32_bf16 v[80:83], a[88:91], a[24:27], v[80:83]
ds_read_b64_tr_b16 a[88:89], v11 offset:0
v_mul_f32 v47, s68, v47
v_mfma_f32_16x16x32_bf16 v[144:147], a[104:107], a[24:27], v[144:147]
ds_read_b64_tr_b16 a[90:91], v11 offset:1024
v_mul_f32 v108, s68, v108
v_mfma_f32_16x16x32_bf16 v[144:147], a[108:111], a[28:31], v[144:147]
ds_read_b64_tr_b16 a[92:93], v11 offset:8192
v_mul_f32 v109, s68, v109
v_mfma_f32_16x16x32_bf16 v[144:147], a[112:115], a[56:59], v[144:147]
ds_read_b64_tr_b16 a[94:95], v11 offset:9216
v_mul_f32 v110, s68, v110
v_mfma_f32_16x16x32_bf16 v[144:147], a[116:119], a[60:63], v[144:147]
ds_read_b64_tr_b16 a[96:97], v11 offset:32768
v_mul_f32 v111, s68, v111
v_mfma_f32_16x16x32_bf16 v[128:131], a[116:119], a[52:55], v[128:131]
ds_read_b64_tr_b16 a[98:99], v11 offset:33792
v_cvt_pk_bf16_f32 v44, v44, v45
v_mfma_f32_16x16x32_bf16 v[128:131], a[112:115], a[48:51], v[128:131]
ds_read_b64_tr_b16 a[100:101], v11 offset:40960
v_cvt_pk_bf16_f32 v45, v46, v47
v_mfma_f32_16x16x32_bf16 v[128:131], a[108:111], a[20:23], v[128:131]
ds_read_b64_tr_b16 a[102:103], v11 offset:41984
v_cvt_pk_bf16_f32 v46, v108, v109
v_mfma_f32_16x16x32_bf16 v[128:131], a[104:107], a[16:19], v[128:131]
v_cvt_pk_bf16_f32 v47, v110, v111
v_mul_f32 v28, s68, v28
v_mfma_f32_16x16x32_bf16 v[112:115], a[104:107], a[8:11], v[112:115]
v_mul_f32 v29, s68, v29
v_mul_f32 v30, s68, v30
v_mfma_f32_16x16x32_bf16 v[112:115], a[108:111], a[12:15], v[112:115]
v_mul_f32 v31, s68, v31
v_mul_f32 v92, s68, v92
v_mfma_f32_16x16x32_bf16 v[112:115], a[112:115], a[40:43], v[112:115]
v_mul_f32 v93, s68, v93
v_mul_f32 v94, s68, v94
v_mfma_f32_16x16x32_bf16 v[112:115], a[116:119], a[44:47], v[112:115]
v_mul_f32 v95, s68, v95
v_cvt_pk_bf16_f32 v28, v28, v29
v_mfma_f32_16x16x32_bf16 v[96:99], a[116:119], a[36:39], v[96:99]
v_cvt_pk_bf16_f32 v29, v30, v31
v_cvt_pk_bf16_f32 v30, v92, v93
v_mfma_f32_16x16x32_bf16 v[96:99], a[112:115], a[32:35], v[96:99]
v_cvt_pk_bf16_f32 v31, v94, v95
v_mul_f32 v80, s68, v80
v_mfma_f32_16x16x32_bf16 v[96:99], a[108:111], a[4:7], v[96:99]
v_mul_f32 v81, s68, v81
v_mul_f32 v82, s68, v82
v_mfma_f32_16x16x32_bf16 v[96:99], a[104:107], a[0:3], v[96:99]
s_waitcnt lgkmcnt(1)
v_mul_f32 v83, s68, v83
v_mul_f32 v144, s68, v144
v_mfma_f32_16x16x32_bf16 v[36:39], a[72:75], a[0:3], v[36:39]
v_mul_f32 v145, s68, v145
v_mul_f32 v146, s68, v146
v_mfma_f32_16x16x32_bf16 v[36:39], a[76:79], a[4:7], v[36:39]
v_mul_f32 v147, s68, v147
v_cvt_pk_bf16_f32 v80, v80, v81
v_mfma_f32_16x16x32_bf16 v[36:39], a[80:83], a[32:35], v[36:39]
v_cvt_pk_bf16_f32 v81, v82, v83
v_cvt_pk_bf16_f32 v82, v144, v145
v_mfma_f32_16x16x32_bf16 v[36:39], a[84:87], a[36:39], v[36:39]
v_cvt_pk_bf16_f32 v83, v146, v147
v_mul_f32 v64, s68, v64
v_mfma_f32_16x16x32_bf16 v[52:55], a[84:87], a[44:47], v[52:55]
v_mul_f32 v65, s68, v65
v_mul_f32 v66, s68, v66
v_mfma_f32_16x16x32_bf16 v[52:55], a[80:83], a[40:43], v[52:55]
v_mul_f32 v67, s68, v67
v_mul_f32 v128, s68, v128
v_mfma_f32_16x16x32_bf16 v[52:55], a[76:79], a[12:15], v[52:55]
v_mul_f32 v129, s68, v129
v_mul_f32 v130, s68, v130
v_mfma_f32_16x16x32_bf16 v[52:55], a[72:75], a[8:11], v[52:55]
v_mul_f32 v131, s68, v131
v_cvt_pk_bf16_f32 v64, v64, v65
v_mfma_f32_16x16x32_bf16 v[68:71], a[72:75], a[16:19], v[68:71]
v_cvt_pk_bf16_f32 v65, v66, v67
v_cvt_pk_bf16_f32 v66, v128, v129
v_mfma_f32_16x16x32_bf16 v[68:71], a[76:79], a[20:23], v[68:71]
v_cvt_pk_bf16_f32 v67, v130, v131
v_mul_f32 v48, s68, v48
v_mfma_f32_16x16x32_bf16 v[68:71], a[80:83], a[48:51], v[68:71]
v_mul_f32 v49, s68, v49
v_mul_f32 v50, s68, v50
v_mfma_f32_16x16x32_bf16 v[68:71], a[84:87], a[52:55], v[68:71]
v_mul_f32 v51, s68, v51
v_mul_f32 v112, s68, v112
v_mfma_f32_16x16x32_bf16 v[84:87], a[84:87], a[60:63], v[84:87]
v_mul_f32 v113, s68, v113
v_mul_f32 v114, s68, v114
v_mfma_f32_16x16x32_bf16 v[84:87], a[80:83], a[56:59], v[84:87]
v_mul_f32 v115, s68, v115
v_cvt_pk_bf16_f32 v48, v48, v49
v_mfma_f32_16x16x32_bf16 v[84:87], a[76:79], a[28:31], v[84:87]
v_cvt_pk_bf16_f32 v49, v50, v51
v_cvt_pk_bf16_f32 v50, v112, v113
v_mfma_f32_16x16x32_bf16 v[84:87], a[72:75], a[24:27], v[84:87]
v_cvt_pk_bf16_f32 v51, v114, v115
v_mul_f32 v32, s68, v32
v_mfma_f32_16x16x32_bf16 v[148:151], a[88:91], a[24:27], v[148:151]
v_mul_f32 v33, s68, v33
v_mul_f32 v34, s68, v34
v_mfma_f32_16x16x32_bf16 v[148:151], a[92:95], a[28:31], v[148:151]
v_mul_f32 v35, s68, v35
v_mul_f32 v96, s68, v96
v_mfma_f32_16x16x32_bf16 v[148:151], a[96:99], a[56:59], v[148:151]
s_waitcnt lgkmcnt(0)
s_waitcnt vmcnt(0)
v_max3_u32 v1, v136, v137, v138
v_max_u32 v1, v1, v139
v_mfma_f32_16x16x32_bf16 v[148:151], a[100:103], a[60:63], v[148:151]
v_cmp_eq_u32 vcc, -1, v1
s_cbranch_vccnz L_hretry
L_hgo:
v_mfma_f32_16x16x32_bf16 v[132:135], a[100:103], a[52:55], v[132:135]
ds_write_b128 v17, v[136:139]
v_mfma_f32_16x16x32_bf16 v[132:135], a[96:99], a[48:51], v[132:135]
v_mul_f32 v97, s68, v97
v_mul_f32 v98, s68, v98
v_mfma_f32_16x16x32_bf16 v[132:135], a[92:95], a[20:23], v[132:135]
v_mul_f32 v99, s68, v99
v_cvt_pk_bf16_f32 v32, v32, v33
v_mfma_f32_16x16x32_bf16 v[132:135], a[88:91], a[16:19], v[132:135]
v_cvt_pk_bf16_f32 v33, v34, v35
v_cvt_pk_bf16_f32 v34, v96, v97
v_mfma_f32_16x16x32_bf16 v[116:119], a[88:91], a[8:11], v[116:119]
s_waitcnt lgkmcnt(0)
s_barrier
v_mfma_f32_16x16x32_bf16 v[116:119], a[92:95], a[12:15], v[116:119]
ds_read_b128 a[176:179], v2 offset:0
v_cvt_pk_bf16_f32 v35, v98, v99
v_mfma_f32_16x16x32_bf16 v[116:119], a[96:99], a[40:43], v[116:119]
ds_read_b128 a[184:187], v2 offset:20480
v_mfma_f32_16x16x32_bf16 v[116:119], a[100:103], a[44:47], v[116:119]
ds_read_b64 v[216:217], v2 offset:1032
v_mfma_f32_16x16x32_bf16 v[100:103], a[100:103], a[36:39], v[100:103]
ds_read_b64 v[220:221], v2 offset:1024
v_mfma_f32_16x16x32_bf16 v[100:103], a[96:99], a[32:35], v[100:103]
ds_read_b64 v[232:233], v2 offset:21512
v_mfma_f32_16x16x32_bf16 v[100:103], a[92:95], a[4:7], v[100:103]
ds_read_b64 v[236:237], v2 offset:21504
v_mfma_f32_16x16x32_bf16 v[100:103], a[88:91], a[0:3], v[100:103]
v_mfma_f32_16x16x32_bf16 v[196:199], v[192:195], v[160:163], v[248:251]
s_branch L_po14
L_pg14:
s_branch L_pg19
L_po14:
v_mfma_f32_16x16x32_bf16 v[212:215], v[208:211], v[176:179], v[248:251]
v_mfma_f32_16x16x32_bf16 v[188:191], v[184:187], v[152:155], v[248:251]
v_mfma_f32_16x16x32_bf16 v[204:207], v[200:203], v[168:171], v[248:251]
v_mfma_f32_16x16x32_bf16 v[164:167], a[180:183], v[160:163], v[252:255]
v_mfma_f32_16x16x32_bf16 v[180:183], a[188:191], v[176:179], v[252:255]
s_waitcnt lgkmcnt(5)
v_mfma_f32_16x16x32_bf16 v[156:159], a[176:179], v[152:155], v[20:23]
s_waitcnt lgkmcnt(4)
v_mfma_f32_16x16x32_bf16 v[172:175], a[184:187], v[168:171], v[252:255]
v_accvgpr_read_b32 v4, a64
v_accvgpr_read_b32 v5, a65
v_accvgpr_read_b32 v6, a66
v_accvgpr_read_b32 v7, a67
v_accvgpr_read_b32 v8, a68
v_accvgpr_read_b32 v9, a69
v_accvgpr_read_b32 v10, a70
v_accvgpr_read_b32 v11, a71
v_max3_f32 v121, v196, v197, v198
v_max3_f32 v121, v121, v199, v164
v_max3_f32 v121, v121, v165, v166
v_max_f32 v121, v121, v167
v_max3_f32 v123, v212, v213, v214
v_max3_f32 v123, v123, v215, v180
v_max3_f32 v123, v123, v181, v182
v_max_f32 v123, v123, v183
v_max3_f32 v120, v188, v189, v190
v_max3_f32 v120, v120, v191, v156
v_max3_f32 v120, v120, v157, v158
v_max_f32 v120, v120, v159
v_max3_f32 v122, v204, v205, v206
v_max3_f32 v122, v122, v207, v172
v_max3_f32 v122, v122, v173, v174
v_max_f32 v122, v122, v175
v_mov_b32 v105, v121
v_mov_b32 v107, v123
v_mov_b32 v104, v120
v_mov_b32 v106, v122
v_permlane16_swap_b32 v105, v121
v_permlane16_swap_b32 v107, v123
v_permlane16_swap_b32 v104, v120
v_permlane16_swap_b32 v106, v122
v_max_f32 v121, v121, v105
v_max_f32 v123, v123, v107
v_max_f32 v120, v120, v104
v_max_f32 v122, v122, v106
v_mov_b32 v105, v121
v_mov_b32 v107, v123
v_mov_b32 v104, v120
v_mov_b32 v106, v122
v_permlane32_swap_b32 v105, v121
v_permlane32_swap_b32 v107, v123
v_permlane32_swap_b32 v104, v120
v_permlane32_swap_b32 v106, v122
v_max_f32 v121, v121, v105
v_max_f32 v123, v123, v107
v_max_f32 v120, v120, v104
v_max_f32 v122, v122, v106
v_mul_f32 v121, s66, v121
v_mul_f32 v123, s66, v123
v_mul_f32 v120, s66, v120
v_mul_f32 v122, s66, v122
v_fma_f32 v164, v164, s66, -v121
v_fma_f32 v165, v165, s66, -v121
v_fma_f32 v166, v166, s66, -v121
v_fma_f32 v167, v167, s66, -v121
v_fma_f32 v196, v196, s66, -v121
v_fma_f32 v197, v197, s66, -v121
v_fma_f32 v198, v198, s66, -v121
v_fma_f32 v199, v199, s66, -v121
v_exp_f32 v164, v164
v_exp_f32 v165, v165
v_exp_f32 v166, v166
v_exp_f32 v167, v167
v_exp_f32 v196, v196
v_exp_f32 v197, v197
v_exp_f32 v198, v198
v_exp_f32 v199, v199
v_cvt_pk_bf16_f32 v164, v164, v165
v_cvt_pk_bf16_f32 v165, v166, v167
v_cvt_pk_bf16_f32 v166, v196, v197
v_cvt_pk_bf16_f32 v167, v198, v199
v_pk_mul_f32 v[36:37], v[36:37], s[68:69]
v_pk_mul_f32 v[38:39], v[38:39], s[68:69]
v_mfma_f32_16x16x32_bf16 v[196:199], a[244:247], v[164:167], 0
v_mfma_f32_16x16x32_bf16 v[160:163], v[224:227], v[164:167], 0
v_mfma_f32_16x16x32_bf16 v[192:195], v[228:231], v[164:167], 0
v_fma_f32 v180, v180, s66, -v123
v_fma_f32 v181, v181, s66, -v123
v_fma_f32 v182, v182, s66, -v123
v_fma_f32 v183, v183, s66, -v123
v_fma_f32 v212, v212, s66, -v123
v_fma_f32 v213, v213, s66, -v123
v_fma_f32 v214, v214, s66, -v123
v_fma_f32 v215, v215, s66, -v123
v_exp_f32 v180, v180
v_exp_f32 v181, v181
v_exp_f32 v182, v182
v_exp_f32 v183, v183
v_exp_f32 v212, v212
v_exp_f32 v213, v213
v_exp_f32 v214, v214
v_exp_f32 v215, v215
v_cvt_pk_bf16_f32 v180, v180, v181
v_cvt_pk_bf16_f32 v181, v182, v183
v_cvt_pk_bf16_f32 v182, v212, v213
v_cvt_pk_bf16_f32 v183, v214, v215
v_pk_mul_f32 v[100:101], v[100:101], s[68:69]
v_pk_mul_f32 v[102:103], v[102:103], s[68:69]
v_mfma_f32_16x16x32_bf16 v[212:215], a[244:247], v[180:183], 0
v_mfma_f32_16x16x32_bf16 v[176:179], v[240:243], v[180:183], 0
v_mfma_f32_16x16x32_bf16 v[208:211], v[244:247], v[180:183], 0
v_fma_f32 v156, v156, s66, -v120
v_fma_f32 v157, v157, s66, -v120
v_fma_f32 v158, v158, s66, -v120
v_fma_f32 v159, v159, s66, -v120
v_fma_f32 v188, v188, s66, -v120
v_fma_f32 v189, v189, s66, -v120
v_fma_f32 v190, v190, s66, -v120
v_fma_f32 v191, v191, s66, -v120
v_exp_f32 v156, v156
v_exp_f32 v157, v157
v_exp_f32 v158, v158
v_exp_f32 v159, v159
v_exp_f32 v188, v188
v_exp_f32 v189, v189
v_exp_f32 v190, v190
v_exp_f32 v191, v191
v_cvt_pk_bf16_f32 v156, v156, v157
v_cvt_pk_bf16_f32 v157, v158, v159
v_cvt_pk_bf16_f32 v158, v188, v189
v_cvt_pk_bf16_f32 v159, v190, v191
v_cvt_pk_bf16_f32 v36, v36, v37
v_cvt_pk_bf16_f32 v37, v38, v39
v_mfma_f32_16x16x32_bf16 v[188:191], a[244:247], v[156:159], 0
s_waitcnt lgkmcnt(3)
v_mfma_f32_16x16x32_bf16 v[152:155], v[216:219], v[156:159], 0
s_waitcnt lgkmcnt(2)
v_mfma_f32_16x16x32_bf16 v[184:187], v[220:223], v[156:159], 0
v_fma_f32 v172, v172, s66, -v122
v_fma_f32 v173, v173, s66, -v122
v_fma_f32 v174, v174, s66, -v122
v_fma_f32 v175, v175, s66, -v122
v_fma_f32 v204, v204, s66, -v122
v_fma_f32 v205, v205, s66, -v122
v_fma_f32 v206, v206, s66, -v122
v_fma_f32 v207, v207, s66, -v122
v_exp_f32 v172, v172
v_exp_f32 v173, v173
v_exp_f32 v174, v174
v_exp_f32 v175, v175
v_exp_f32 v204, v204
v_exp_f32 v205, v205
v_exp_f32 v206, v206
v_exp_f32 v207, v207
v_cvt_pk_bf16_f32 v172, v172, v173
v_cvt_pk_bf16_f32 v173, v174, v175
v_cvt_pk_bf16_f32 v174, v204, v205
v_cvt_pk_bf16_f32 v175, v206, v207
v_cvt_pk_bf16_f32 v38, v100, v101
v_cvt_pk_bf16_f32 v39, v102, v103
v_mfma_f32_16x16x32_bf16 v[204:207], a[244:247], v[172:175], 0
s_waitcnt lgkmcnt(1)
v_mfma_f32_16x16x32_bf16 v[168:171], v[232:235], v[172:175], 0
s_waitcnt lgkmcnt(0)
v_mfma_f32_16x16x32_bf16 v[200:203], v[236:239], v[172:175], 0
v_pk_mul_f32 v[52:53], v[52:53], s[68:69]
v_pk_mul_f32 v[54:55], v[54:55], s[68:69]
v_pk_mul_f32 v[116:117], v[116:117], s[68:69]
v_pk_mul_f32 v[118:119], v[118:119], s[68:69]
v_cvt_pk_bf16_f32 v52, v52, v53
v_cvt_pk_bf16_f32 v53, v54, v55
v_cvt_pk_bf16_f32 v54, v116, v117
v_cvt_pk_bf16_f32 v55, v118, v119
v_pk_mul_f32 v[68:69], v[68:69], s[68:69]
v_pk_mul_f32 v[70:71], v[70:71], s[68:69]
v_pk_mul_f32 v[132:133], v[132:133], s[68:69]
v_pk_mul_f32 v[134:135], v[134:135], s[68:69]
v_cvt_pk_bf16_f32 v68, v68, v69
v_cvt_pk_bf16_f32 v69, v70, v71
v_cvt_pk_bf16_f32 v70, v132, v133
v_cvt_pk_bf16_f32 v71, v134, v135
v_pk_mul_f32 v[84:85], v[84:85], s[68:69]
v_pk_mul_f32 v[86:87], v[86:87], s[68:69]
v_pk_mul_f32 v[148:149], v[148:149], s[68:69]
v_pk_mul_f32 v[150:151], v[150:151], s[68:69]
v_cvt_pk_bf16_f32 v84, v84, v85
v_cvt_pk_bf16_f32 v85, v86, v87
v_cvt_pk_bf16_f32 v86, v148, v149
v_cvt_pk_bf16_f32 v87, v150, v151
v_rcp_f32 v121, v196
v_rcp_f32 v123, v212
v_rcp_f32 v120, v188
v_rcp_f32 v122, v204
v_mul_f32 v121, v121, v7
v_mul_f32 v123, v123, v11
v_mul_f32 v120, v120, v5
v_mul_f32 v122, v122, v9
v_pk_mul_f32 v[152:153], v[152:153], v[120:121] op_sel_hi:[1,0]
v_pk_mul_f32 v[154:155], v[154:155], v[120:121] op_sel_hi:[1,0]
v_pk_mul_f32 v[184:185], v[184:185], v[120:121] op_sel_hi:[1,0]
v_pk_mul_f32 v[186:187], v[186:187], v[120:121] op_sel_hi:[1,0]
v_cvt_pk_bf16_f32 v152, v152, v153
v_cvt_pk_bf16_f32 v153, v154, v155
v_cvt_pk_bf16_f32 v154, v184, v185
v_cvt_pk_bf16_f32 v155, v186, v187
buffer_store_dwordx4 v[152:155], v16, s[44:47], s64 offen sc1
v_mov_b32 v2, v16
v_add_u32 v3, 0x10000, v16
v_mov_b32 v1, 0
s_mov_b32 m0, s71
s_waitcnt lgkmcnt(0)
s_barrier
ds_read_b128 a[144:147], v2 offset:0
ds_read_b128 a[148:151], v2 offset:1024
ds_read_b128 a[152:155], v2 offset:2048
ds_read_b128 a[156:159], v2 offset:3072
ds_read_b128 a[160:163], v2 offset:4096
ds_read_b128 a[164:167], v2 offset:5120
ds_read_b128 a[168:171], v2 offset:6144
ds_read_b128 a[172:175], v2 offset:7168
buffer_load_dwordx4 v16, s[32:35], s70 offen offset:0 sc1 lds
buffer_load_dwordx4 v16, s[32:35], s70 offen offset:1024 sc1 lds
v_pk_mul_f32 v[168:169], v[168:169], v[122:123] op_sel_hi:[1,0]
v_pk_mul_f32 v[170:171], v[170:171], v[122:123] op_sel_hi:[1,0]
v_pk_mul_f32 v[200:201], v[200:201], v[122:123] op_sel_hi:[1,0]
v_pk_mul_f32 v[202:203], v[202:203], v[122:123] op_sel_hi:[1,0]
v_cvt_pk_bf16_f32 v168, v168, v169
v_cvt_pk_bf16_f32 v169, v170, v171
v_cvt_pk_bf16_f32 v170, v200, v201
v_cvt_pk_bf16_f32 v171, v202, v203
buffer_store_dwordx4 v[168:171], v16, s[44:47], s65 offen sc1
v_pk_mul_f32 v[160:161], v[160:161], v[120:121] op_sel:[0,1]
v_pk_mul_f32 v[162:163], v[162:163], v[120:121] op_sel:[0,1]
v_pk_mul_f32 v[192:193], v[192:193], v[120:121] op_sel:[0,1]
v_pk_mul_f32 v[194:195], v[194:195], v[120:121] op_sel:[0,1]
v_cvt_pk_bf16_f32 v160, v160, v161
v_cvt_pk_bf16_f32 v161, v162, v163
v_cvt_pk_bf16_f32 v162, v192, v193
v_cvt_pk_bf16_f32 v163, v194, v195
s_add_u32 s64, s64, 4096
buffer_store_dwordx4 v[160:163], v16, s[44:47], s64 offen sc1
v_pk_mul_f32 v[176:177], v[176:177], v[122:123] op_sel:[0,1]
v_pk_mul_f32 v[178:179], v[178:179], v[122:123] op_sel:[0,1]
v_pk_mul_f32 v[208:209], v[208:209], v[122:123] op_sel:[0,1]
v_pk_mul_f32 v[210:211], v[210:211], v[122:123] op_sel:[0,1]
v_cvt_pk_bf16_f32 v176, v176, v177
v_cvt_pk_bf16_f32 v177, v178, v179
v_cvt_pk_bf16_f32 v178, v208, v209
v_cvt_pk_bf16_f32 v179, v210, v211
s_add_u32 s65, s65, 4096
buffer_store_dwordx4 v[176:179], v16, s[44:47], s65 offen sc1
v_mov_b32 v17, 0xff800000
v_and_b32 v5, 1, v0
v_mul_u32_u24 v5, 0xaaaa, v5
v_add_u32 v5, 0x4444, v5
v_lshl_or_b32 v5, v5, 16, v5
L_attstart_7:
s_cmp_eq_u32 s3, 0
s_cbranch_scc1 L_F1
s_waitcnt lgkmcnt(7)
v_mfma_f32_16x16x32_bf16 v[88:91], a[144:147], v[24:27], 0
s_waitcnt lgkmcnt(6)
ds_read_b128 a[176:179], v2 offset:8192
v_accvgpr_write_b32 a128, 0
v_mfma_f32_16x16x32_bf16 v[88:91], a[148:151], v[28:31], v[88:91]
s_waitcnt lgkmcnt(6)
ds_read_b128 a[180:183], v2 offset:9216
v_accvgpr_write_b32 a129, 0
v_mfma_f32_16x16x32_bf16 v[88:91], a[152:155], v[32:35], v[88:91]
s_waitcnt lgkmcnt(6)
buffer_load_dwordx4 v16, s[32:35], s70 offen offset:2048 sc1 lds
v_mfma_f32_16x16x32_bf16 v[88:91], a[156:159], v[36:39], v[88:91]
ds_read_b128 a[184:187], v2 offset:10240
v_accvgpr_write_b32 a130, 0
v_mfma_f32_16x16x32_bf16 v[104:107], a[156:159], v[52:55], 0
ds_read_b128 a[188:191], v2 offset:11264
v_accvgpr_write_b32 a131, 0
v_mfma_f32_16x16x32_bf16 v[104:107], a[152:155], v[48:51], v[104:107]
ds_read_b128 a[192:195], v2 offset:12288
v_accvgpr_write_b32 a132, 0
v_mfma_f32_16x16x32_bf16 v[104:107], a[148:151], v[44:47], v[104:107]
ds_read_b128 a[196:199], v2 offset:13312
v_accvgpr_write_b32 a133, 0
v_mfma_f32_16x16x32_bf16 v[104:107], a[144:147], v[40:43], v[104:107]
ds_read_b128 a[200:203], v2 offset:14336
v_accvgpr_write_b32 a134, 0
v_mfma_f32_16x16x32_bf16 v[120:123], a[144:147], v[56:59], 0
ds_read_b128 a[204:207], v2 offset:15360
v_accvgpr_write_b32 a135, 0
v_mfma_f32_16x16x32_bf16 v[120:123], a[148:151], v[60:63], v[120:123]
buffer_load_dwordx4 v16, s[32:35], s70 offen offset:3072 sc1 lds
v_mfma_f32_16x16x32_bf16 v[120:123], a[152:155], v[64:67], v[120:123]
v_accvgpr_write_b32 a136, 0
v_accvgpr_write_b32 a137, 0
v_mfma_f32_16x16x32_bf16 v[120:123], a[156:159], v[68:71], v[120:123]
v_accvgpr_write_b32 a138, 0
v_accvgpr_write_b32 a139, 0
v_mfma_f32_16x16x32_bf16 v[136:139], a[156:159], v[84:87], 0
v_accvgpr_write_b32 a140, 0
v_accvgpr_write_b32 a141, 0
v_mfma_f32_16x16x32_bf16 v[136:139], a[152:155], v[80:83], v[136:139]
v_accvgpr_write_b32 a142, 0
v_accvgpr_write_b32 a143, 0
v_mfma_f32_16x16x32_bf16 v[136:139], a[148:151], v[76:79], v[136:139]
v_mfma_f32_16x16x32_bf16 v[136:139], a[144:147], v[72:75], v[136:139]
s_waitcnt lgkmcnt(0)
s_nop 1
v_max3_f32 v20, v88, v89, v90
v_max_f32 v20, v20, v91
v_max3_f32 v21, v104, v105, v106
v_max_f32 v21, v21, v107
v_max3_f32 v22, v120, v121, v122
v_max_f32 v22, v22, v123
v_max3_f32 v23, v136, v137, v138
v_max_f32 v23, v23, v139
v_mov_b32 v248, v20
v_mov_b32 v249, v21
v_mov_b32 v250, v22
v_mov_b32 v251, v23
v_permlane16_swap_b32 v248, v20
v_permlane16_swap_b32 v249, v21
v_permlane16_swap_b32 v250, v22
v_permlane16_swap_b32 v251, v23
v_max_f32 v20, v20, v248
v_max_f32 v21, v21, v249
v_max_f32 v22, v22, v250
v_max_f32 v23, v23, v251
v_mov_b32 v248, v20
v_mov_b32 v249, v21
v_mov_b32 v250, v22
v_mov_b32 v251, v23
v_permlane32_swap_b32 v248, v20
v_permlane32_swap_b32 v249, v21
v_permlane32_swap_b32 v250, v22
v_permlane32_swap_b32 v251, v23
v_max_f32 v20, v20, v248
v_max_f32 v21, v21, v249
v_max_f32 v22, v22, v250
v_max_f32 v23, v23, v251
s_cmp_eq_u32 s73, 0
s_cselect_b64 vcc, 0, -1
v_cndmask_b32 v20, v20, v252, vcc
v_cndmask_b32 v21, v21, v253, vcc
v_cndmask_b32 v22, v22, v254, vcc
v_cndmask_b32 v23, v23, v255, vcc
v_sub_f32 v228, 0, v23
v_sub_f32 v229, 0, v23
v_sub_f32 v230, 0, v23
v_sub_f32 v231, 0, v23
v_sub_f32 v224, 0, v22
v_sub_f32 v225, 0, v22
v_sub_f32 v226, 0, v22
v_sub_f32 v227, 0, v22
v_sub_f32 v220, 0, v21
v_sub_f32 v221, 0, v21
v_sub_f32 v222, 0, v21
v_sub_f32 v223, 0, v21
v_sub_f32 v216, 0, v20
v_sub_f32 v217, 0, v20
v_sub_f32 v218, 0, v20
v_sub_f32 v219, 0, v20
v_mfma_f32_16x16x32_bf16 v[140:143], a[160:163], v[72:75], v[228:231]
s_add_u32 m0, s71, 4096
v_add_f32 v88, v88, v216
v_add_f32 v89, v89, v216
v_mfma_f32_16x16x32_bf16 v[140:143], a[164:167], v[76:79], v[140:143]
v_add_f32 v90, v90, v216
v_add_f32 v91, v91, v216
v_exp_f32 v88, v88
v_mfma_f32_16x16x32_bf16 v[140:143], a[168:171], v[80:83], v[140:143]
s_add_u32 s64, s70, 4096
v_exp_f32 v89, v89
v_mfma_f32_16x16x32_bf16 v[140:143], a[172:175], v[84:87], v[140:143]
buffer_load_dwordx4 v16, s[32:35], s64 offen offset:0 sc1 lds
v_mfma_f32_16x16x32_bf16 v[124:127], a[172:175], v[68:71], v[224:227]
v_exp_f32 v90, v90
v_mfma_f32_16x16x32_bf16 v[124:127], a[168:171], v[64:67], v[124:127]
v_exp_f32 v91, v91
v_mfma_f32_16x16x32_bf16 v[124:127], a[164:167], v[60:63], v[124:127]
v_add_f32 v104, v104, v220
v_add_f32 v105, v105, v220
v_add_f32 v106, v106, v220
v_add_f32 v107, v107, v220
v_exp_f32 v104, v104
v_mfma_f32_16x16x32_bf16 v[124:127], a[160:163], v[56:59], v[124:127]
v_exp_f32 v105, v105
v_mfma_f32_16x16x32_bf16 v[108:111], a[160:163], v[40:43], v[220:223]
v_exp_f32 v106, v106
v_mfma_f32_16x16x32_bf16 v[108:111], a[164:167], v[44:47], v[108:111]
buffer_load_dwordx4 v16, s[32:35], s64 offen offset:1024 sc1 lds
v_mfma_f32_16x16x32_bf16 v[108:111], a[168:171], v[48:51], v[108:111]
v_cvt_pk_bf16_f32 v152, v88, v89
v_add_f32 v120, v120, v224
v_mfma_f32_16x16x32_bf16 v[108:111], a[172:175], v[52:55], v[108:111]
v_exp_f32 v107, v107
v_mfma_f32_16x16x32_bf16 v[92:95], a[172:175], v[36:39], v[216:219]
v_add_f32 v121, v121, v224
v_add_f32 v122, v122, v224
v_add_f32 v123, v123, v224
v_exp_f32 v120, v120
v_mfma_f32_16x16x32_bf16 v[92:95], a[168:171], v[32:35], v[92:95]
v_cvt_pk_bf16_f32 v153, v90, v91
v_exp_f32 v121, v121
v_mfma_f32_16x16x32_bf16 v[92:95], a[164:167], v[28:31], v[92:95]
v_exp_f32 v122, v122
v_mfma_f32_16x16x32_bf16 v[92:95], a[160:163], v[24:27], v[92:95]
v_exp_f32 v123, v123
v_mfma_f32_16x16x32_bf16 v[96:99], a[176:179], v[24:27], v[216:219]
v_cvt_pk_bf16_f32 v160, v104, v105
v_add_f32 v136, v136, v228
v_mfma_f32_16x16x32_bf16 v[96:99], a[180:183], v[28:31], v[96:99]
buffer_load_dwordx4 v16, s[32:35], s64 offen offset:2048 sc1 lds
v_add_f32 v137, v137, v228
v_add_f32 v138, v138, v228
v_add_f32 v139, v139, v228
v_exp_f32 v136, v136
v_mfma_f32_16x16x32_bf16 v[96:99], a[184:187], v[32:35], v[96:99]
v_exp_f32 v137, v137
v_mfma_f32_16x16x32_bf16 v[96:99], a[188:191], v[36:39], v[96:99]
v_cvt_pk_bf16_f32 v161, v106, v107
v_cvt_pk_bf16_f32 v184, v120, v121
v_mfma_f32_16x16x32_bf16 v[112:115], a[188:191], v[52:55], v[220:223]
v_exp_f32 v138, v138
v_mfma_f32_16x16x32_bf16 v[112:115], a[184:187], v[48:51], v[112:115]
v_exp_f32 v139, v139
v_mfma_f32_16x16x32_bf16 v[112:115], a[180:183], v[44:47], v[112:115]
v_exp_f32 v140, v140
v_mfma_f32_16x16x32_bf16 v[112:115], a[176:179], v[40:43], v[112:115]
v_exp_f32 v141, v141
v_mfma_f32_16x16x32_bf16 v[128:131], a[176:179], v[56:59], v[224:227]
buffer_load_dwordx4 v16, s[32:35], s64 offen offset:3072 sc1 lds
v_cvt_pk_bf16_f32 v185, v122, v123
v_mfma_f32_16x16x32_bf16 v[128:131], a[180:183], v[60:63], v[128:131]
v_exp_f32 v142, v142
v_mfma_f32_16x16x32_bf16 v[128:131], a[184:187], v[64:67], v[128:131]
v_exp_f32 v143, v143
v_mfma_f32_16x16x32_bf16 v[128:131], a[188:191], v[68:71], v[128:131]
v_cvt_pk_bf16_f32 v192, v136, v137
v_cvt_pk_bf16_f32 v193, v138, v139
v_mfma_f32_16x16x32_bf16 v[144:147], a[188:191], v[84:87], v[228:231]
v_exp_f32 v124, v124
v_mfma_f32_16x16x32_bf16 v[144:147], a[184:187], v[80:83], v[144:147]
v_exp_f32 v125, v125
v_mfma_f32_16x16x32_bf16 v[144:147], a[180:183], v[76:79], v[144:147]
s_waitcnt vmcnt(6)
s_barrier
v_mfma_f32_16x16x32_bf16 v[144:147], a[176:179], v[72:75], v[144:147]
v_exp_f32 v126, v126
v_mfma_f32_16x16x32_bf16 v[148:151], a[192:195], v[72:75], v[228:231]
v_cvt_pk_bf16_f32 v194, v140, v141
v_cvt_pk_bf16_f32 v195, v142, v143
v_mfma_f32_16x16x32_bf16 v[148:151], a[196:199], v[76:79], v[148:151]
v_exp_f32 v127, v127
v_mfma_f32_16x16x32_bf16 v[148:151], a[200:203], v[80:83], v[148:151]
s_xor_b32 s71, s71, 16384
v_exp_f32 v108, v108
v_mfma_f32_16x16x32_bf16 v[148:151], a[204:207], v[84:87], v[148:151]
s_add_u32 s70, s70, 32768
v_exp_f32 v109, v109
v_mfma_f32_16x16x32_bf16 v[132:135], a[204:207], v[68:71], v[224:227]
s_mov_b32 m0, s71
v_exp_f32 v110, v110
v_mfma_f32_16x16x32_bf16 v[132:135], a[200:203], v[64:67], v[132:135]
buffer_load_dwordx4 v16, s[32:35], s70 offen offset:0 sc1 lds
v_mfma_f32_16x16x32_bf16 v[132:135], a[196:199], v[60:63], v[132:135]
v_cvt_pk_bf16_f32 v186, v124, v125
v_exp_f32 v111, v111
v_mfma_f32_16x16x32_bf16 v[132:135], a[192:195], v[56:59], v[132:135]
v_exp_f32 v92, v92
v_mfma_f32_16x16x32_bf16 v[116:119], a[192:195], v[40:43], v[220:223]
v_exp_f32 v93, v93
v_mfma_f32_16x16x32_bf16 v[116:119], a[196:199], v[44:47], v[116:119]
ds_read_b128 a[144:147], v2 offset:16384
v_cvt_pk_bf16_f32 v187, v126, v127
v_mfma_f32_16x16x32_bf16 v[116:119], a[200:203], v[48:51], v[116:119]
v_exp_f32 v94, v94
v_mfma_f32_16x16x32_bf16 v[116:119], a[204:207], v[52:55], v[116:119]
ds_read_b128 a[148:151], v2 offset:17408
v_cvt_pk_bf16_f32 v162, v108, v109
v_mfma_f32_16x16x32_bf16 v[100:103], a[204:207], v[36:39], v[216:219]
ds_read_b128 a[152:155], v2 offset:18432
buffer_load_dwordx4 v16, s[32:35], s70 offen offset:1024 sc1 lds
v_exp_f32 v95, v95
v_mfma_f32_16x16x32_bf16 v[100:103], a[200:203], v[32:35], v[100:103]
ds_read_b128 a[156:159], v2 offset:19456
v_exp_f32 v96, v96
v_mfma_f32_16x16x32_bf16 v[100:103], a[196:199], v[28:31], v[100:103]
v_cvt_pk_bf16_f32 v163, v110, v111
v_exp_f32 v97, v97
v_mfma_f32_16x16x32_bf16 v[100:103], a[192:195], v[24:27], v[100:103]
s_waitcnt lgkmcnt(3)
ds_read_b128 a[160:163], v2 offset:20480
ds_read_b128 a[164:167], v2 offset:21504
ds_read_b128 a[168:171], v2 offset:22528
ds_read_b128 a[172:175], v2 offset:23552
v_mfma_f32_16x16x32_bf16 v[88:91], a[144:147], v[24:27], v[216:219]
s_waitcnt lgkmcnt(6)
v_exp_f32 v98, v98
v_mfma_f32_16x16x32_bf16 v[88:91], a[148:151], v[28:31], v[88:91]
s_waitcnt lgkmcnt(5)
v_cvt_pk_bf16_f32 v154, v92, v93
v_exp_f32 v99, v99
v_mfma_f32_16x16x32_bf16 v[88:91], a[152:155], v[32:35], v[88:91]
s_waitcnt lgkmcnt(4)
v_exp_f32 v112, v112
v_mfma_f32_16x16x32_bf16 v[88:91], a[156:159], v[36:39], v[88:91]
v_exp_f32 v113, v113
v_mfma_f32_16x16x32_bf16 v[104:107], a[156:159], v[52:55], v[220:223]
v_cvt_pk_bf16_f32 v155, v94, v95
v_cvt_pk_bf16_f32 v156, v96, v97
v_mfma_f32_16x16x32_bf16 v[104:107], a[152:155], v[48:51], v[104:107]
buffer_load_dwordx4 v16, s[32:35], s70 offen offset:2048 sc1 lds
v_exp_f32 v114, v114
v_mfma_f32_16x16x32_bf16 v[104:107], a[148:151], v[44:47], v[104:107]
v_exp_f32 v115, v115
v_mfma_f32_16x16x32_bf16 v[104:107], a[144:147], v[40:43], v[104:107]
v_exp_f32 v128, v128
v_mfma_f32_16x16x32_bf16 v[120:123], a[144:147], v[56:59], v[224:227]
v_exp_f32 v129, v129
v_mfma_f32_16x16x32_bf16 v[120:123], a[148:151], v[60:63], v[120:123]
v_cvt_pk_bf16_f32 v157, v98, v99
v_cvt_pk_bf16_f32 v164, v112, v113
v_mfma_f32_16x16x32_bf16 v[120:123], a[152:155], v[64:67], v[120:123]
v_exp_f32 v130, v130
v_mfma_f32_16x16x32_bf16 v[120:123], a[156:159], v[68:71], v[120:123]
v_exp_f32 v131, v131
v_mfma_f32_16x16x32_bf16 v[136:139], a[156:159], v[84:87], v[228:231]
v_exp_f32 v144, v144
v_mfma_f32_16x16x32_bf16 v[136:139], a[152:155], v[80:83], v[136:139]
v_exp_f32 v145, v145
v_mfma_f32_16x16x32_bf16 v[136:139], a[148:151], v[76:79], v[136:139]
v_exp_f32 v146, v146
v_mfma_f32_16x16x32_bf16 v[136:139], a[144:147], v[72:75], v[136:139]
s_waitcnt lgkmcnt(0)
v_cvt_pk_bf16_f32 v165, v114, v115
v_cvt_pk_bf16_f32 v188, v128, v129
v_mfma_f32_16x16x32_bf16 v[140:143], a[160:163], v[72:75], v[228:231]
v_exp_f32 v147, v147
v_mfma_f32_16x16x32_bf16 v[140:143], a[164:167], v[76:79], v[140:143]
v_exp_f32 v148, v148
v_mfma_f32_16x16x32_bf16 v[140:143], a[168:171], v[80:83], v[140:143]
v_exp_f32 v149, v149
v_mfma_f32_16x16x32_bf16 v[140:143], a[172:175], v[84:87], v[140:143]
buffer_load_dwordx4 v16, s[32:35], s70 offen offset:3072 sc1 lds
v_mfma_f32_16x16x32_bf16 v[124:127], a[172:175], v[68:71], v[224:227]
v_cvt_pk_bf16_f32 v189, v130, v131
v_cvt_pk_bf16_f32 v196, v144, v145
v_mfma_f32_16x16x32_bf16 v[124:127], a[168:171], v[64:67], v[124:127]
v_exp_f32 v150, v150
v_mfma_f32_16x16x32_bf16 v[124:127], a[164:167], v[60:63], v[124:127]
v_exp_f32 v151, v151
v_mfma_f32_16x16x32_bf16 v[124:127], a[160:163], v[56:59], v[124:127]
v_exp_f32 v132, v132
v_mfma_f32_16x16x32_bf16 v[108:111], a[160:163], v[40:43], v[220:223]
ds_read_b128 a[176:179], v2 offset:24576
v_cvt_pk_bf16_f32 v197, v146, v147
v_mfma_f32_16x16x32_bf16 v[108:111], a[164:167], v[44:47], v[108:111]
ds_read_b128 a[180:183], v2 offset:25600
v_cvt_pk_bf16_f32 v198, v148, v149
v_mfma_f32_16x16x32_bf16 v[108:111], a[168:171], v[48:51], v[108:111]
ds_read_b128 a[184:187], v2 offset:26624
v_exp_f32 v133, v133
v_mfma_f32_16x16x32_bf16 v[108:111], a[172:175], v[52:55], v[108:111]
ds_read_b128 a[188:191], v2 offset:27648
v_exp_f32 v134, v134
v_mfma_f32_16x16x32_bf16 v[92:95], a[172:175], v[36:39], v[216:219]
v_exp_f32 v135, v135
v_mfma_f32_16x16x32_bf16 v[92:95], a[168:171], v[32:35], v[92:95]
v_exp_f32 v116, v116
v_mfma_f32_16x16x32_bf16 v[92:95], a[164:167], v[28:31], v[92:95]
v_exp_f32 v117, v117
v_mfma_f32_16x16x32_bf16 v[92:95], a[160:163], v[24:27], v[92:95]
s_waitcnt lgkmcnt(2)
v_cvt_pk_bf16_f32 v199, v150, v151
v_cvt_pk_bf16_f32 v190, v132, v133
v_mfma_f32_16x16x32_bf16 v[96:99], a[176:179], v[24:27], v[216:219]
v_exp_f32 v118, v118
v_mfma_f32_16x16x32_bf16 v[96:99], a[180:183], v[28:31], v[96:99]
s_waitcnt lgkmcnt(0)
s_add_u32 m0, s71, 4096
v_exp_f32 v119, v119
v_mfma_f32_16x16x32_bf16 v[96:99], a[184:187], v[32:35], v[96:99]
s_add_u32 s64, s70, 4096
v_exp_f32 v100, v100
v_mfma_f32_16x16x32_bf16 v[96:99], a[188:191], v[36:39], v[96:99]
buffer_load_dwordx4 v16, s[32:35], s64 offen offset:0 sc1 lds
v_mfma_f32_16x16x32_bf16 v[112:115], a[188:191], v[52:55], v[220:223]
v_exp_f32 v101, v101
v_mfma_f32_16x16x32_bf16 v[112:115], a[184:187], v[48:51], v[112:115]
v_cvt_pk_bf16_f32 v191, v134, v135
v_cvt_pk_bf16_f32 v166, v116, v117
v_mfma_f32_16x16x32_bf16 v[112:115], a[180:183], v[44:47], v[112:115]
v_exp_f32 v102, v102
v_mfma_f32_16x16x32_bf16 v[112:115], a[176:179], v[40:43], v[112:115]
v_exp_f32 v103, v103
v_mfma_f32_16x16x32_bf16 v[128:131], a[176:179], v[56:59], v[224:227]
s_lshl_b32 s66, s30, 30
ds_read_b128 a[192:195], v2 offset:28672
v_cvt_pk_bf16_f32 v167, v118, v119
v_mfma_f32_16x16x32_bf16 v[128:131], a[180:183], v[60:63], v[128:131]
ds_read_b128 a[196:199], v2 offset:29696
v_exp_f32 v88, v88
v_mfma_f32_16x16x32_bf16 v[128:131], a[184:187], v[64:67], v[128:131]
ds_read_b128 a[200:203], v2 offset:30720
v_exp_f32 v89, v89
v_mfma_f32_16x16x32_bf16 v[128:131], a[188:191], v[68:71], v[128:131]
ds_read_b128 a[204:207], v2 offset:31744
v_cvt_pk_bf16_f32 v158, v100, v101
v_mfma_f32_16x16x32_bf16 v[144:147], a[188:191], v[84:87], v[228:231]
v_exp_f32 v90, v90
v_mfma_f32_16x16x32_bf16 v[144:147], a[184:187], v[80:83], v[144:147]
v_exp_f32 v91, v91
v_mfma_f32_16x16x32_bf16 v[144:147], a[180:183], v[76:79], v[144:147]
v_exp_f32 v104, v104
v_mfma_f32_16x16x32_bf16 v[144:147], a[176:179], v[72:75], v[144:147]
s_waitcnt lgkmcnt(2)
v_exp_f32 v105, v105
v_mfma_f32_16x16x32_bf16 v[148:151], a[192:195], v[72:75], v[228:231]
v_cvt_pk_bf16_f32 v159, v102, v103
v_cvt_pk_bf16_f32 v168, v88, v89
v_mfma_f32_16x16x32_bf16 v[148:151], a[196:199], v[76:79], v[148:151]
s_waitcnt lgkmcnt(0)
v_exp_f32 v106, v106
v_mfma_f32_16x16x32_bf16 v[148:151], a[200:203], v[80:83], v[148:151]
v_exp_f32 v107, v107
v_mfma_f32_16x16x32_bf16 v[148:151], a[204:207], v[84:87], v[148:151]
buffer_load_dwordx4 v16, s[32:35], s64 offen offset:1024 sc1 lds
v_mfma_f32_16x16x32_bf16 v[132:135], a[204:207], v[68:71], v[224:227]
v_exp_f32 v120, v120
v_mfma_f32_16x16x32_bf16 v[132:135], a[200:203], v[64:67], v[132:135]
v_cvt_pk_bf16_f32 v169, v90, v91
v_cvt_pk_bf16_f32 v176, v104, v105
v_mfma_f32_16x16x32_bf16 v[132:135], a[196:199], v[60:63], v[132:135]
v_exp_f32 v121, v121
v_mfma_f32_16x16x32_bf16 v[132:135], a[192:195], v[56:59], v[132:135]
s_branch L_po15
L_pg15:
s_branch L_pg20
L_po15:
v_exp_f32 v122, v122
v_mfma_f32_16x16x32_bf16 v[116:119], a[192:195], v[40:43], v[220:223]
v_exp_f32 v123, v123
v_mfma_f32_16x16x32_bf16 v[116:119], a[196:199], v[44:47], v[116:119]
v_exp_f32 v136, v136
v_mfma_f32_16x16x32_bf16 v[116:119], a[200:203], v[48:51], v[116:119]
v_exp_f32 v137, v137
v_mfma_f32_16x16x32_bf16 v[116:119], a[204:207], v[52:55], v[116:119]
ds_read_b128 a[144:147], v3 offset:16384
v_cvt_pk_bf16_f32 v177, v106, v107
v_mfma_f32_16x16x32_bf16 v[100:103], a[204:207], v[36:39], v[216:219]
v_exp_f32 v138, v138
v_mfma_f32_16x16x32_bf16 v[100:103], a[200:203], v[32:35], v[100:103]
ds_read_b128 a[148:151], v3 offset:24576
v_cvt_pk_bf16_f32 v200, v120, v121
v_mfma_f32_16x16x32_bf16 v[100:103], a[196:199], v[28:31], v[100:103]
v_exp_f32 v139, v139
v_mfma_f32_16x16x32_bf16 v[100:103], a[192:195], v[24:27], v[100:103]
v_exp_f32 v140, v140
v_smfmac_f32_16x16x64_bf16 a[128:131], a[240:243], v[152:159], v5
v_cvt_pk_bf16_f32 v201, v122, v123
v_smfmac_f32_16x16x64_bf16 a[132:135], a[240:243], v[160:167], v5
v_exp_f32 v141, v141
v_smfmac_f32_16x16x64_bf16 a[136:139], a[240:243], v[184:191], v5
v_exp_f32 v142, v142
v_smfmac_f32_16x16x64_bf16 a[140:143], a[240:243], v[192:199], v5
s_waitcnt lgkmcnt(0)
buffer_load_dwordx4 v16, s[32:35], s64 offen offset:2048 sc1 lds
v_cvt_pk_bf16_f32 v208, v136, v137
v_mfma_f32_16x16x32_bf16 a[0:3], a[144:147], v[152:155], 0
ds_read_b128 a[152:155], v3 offset:17408
v_exp_f32 v143, v143
v_mfma_f32_16x16x32_bf16 a[0:3], a[148:151], v[156:159], a[0:3]
ds_read_b128 a[156:159], v3 offset:25600
v_exp_f32 v124, v124
v_mfma_f32_16x16x32_bf16 a[32:35], a[148:151], v[164:167], 0
v_cvt_pk_bf16_f32 v209, v138, v139
v_exp_f32 v125, v125
v_mfma_f32_16x16x32_bf16 a[32:35], a[144:147], v[160:163], a[32:35]
v_exp_f32 v126, v126
v_mfma_f32_16x16x32_bf16 a[64:67], a[144:147], v[184:187], 0
v_exp_f32 v127, v127
v_mfma_f32_16x16x32_bf16 a[64:67], a[148:151], v[188:191], a[64:67]
v_cvt_pk_bf16_f32 v210, v140, v141
v_cvt_pk_bf16_f32 v211, v142, v143
v_mfma_f32_16x16x32_bf16 a[96:99], a[148:151], v[196:199], 0
v_exp_f32 v108, v108
v_mfma_f32_16x16x32_bf16 a[96:99], a[144:147], v[192:195], a[96:99]
s_waitcnt lgkmcnt(0)
v_exp_f32 v109, v109
v_mfma_f32_16x16x32_bf16 a[100:103], a[152:155], v[192:195], 0
ds_read_b128 a[160:163], v3 offset:18432
v_cvt_pk_bf16_f32 v202, v124, v125
v_mfma_f32_16x16x32_bf16 a[100:103], a[156:159], v[196:199], a[100:103]
ds_read_b128 a[164:167], v3 offset:26624
v_exp_f32 v110, v110
v_mfma_f32_16x16x32_bf16 a[68:71], a[156:159], v[188:191], 0
v_exp_f32 v111, v111
v_mfma_f32_16x16x32_bf16 a[68:71], a[152:155], v[184:187], a[68:71]
v_exp_f32 v92, v92
v_mfma_f32_16x16x32_bf16 a[36:39], a[152:155], v[160:163], 0
v_exp_f32 v93, v93
v_mfma_f32_16x16x32_bf16 a[36:39], a[156:159], v[164:167], a[36:39]
v_cvt_pk_bf16_f32 v203, v126, v127
v_cvt_pk_bf16_f32 v178, v108, v109
v_mfma_f32_16x16x32_bf16 a[4:7], a[156:159], v[156:159], 0
buffer_load_dwordx4 v16, s[32:35], s64 offen offset:3072 sc1 lds
v_mfma_f32_16x16x32_bf16 a[4:7], a[152:155], v[152:155], a[4:7]
s_waitcnt lgkmcnt(0)
v_exp_f32 v94, v94
v_mfma_f32_16x16x32_bf16 a[8:11], a[160:163], v[152:155], 0
ds_read_b128 a[168:171], v3 offset:19456
v_cvt_pk_bf16_f32 v179, v110, v111
v_mfma_f32_16x16x32_bf16 a[8:11], a[164:167], v[156:159], a[8:11]
ds_read_b128 a[172:175], v3 offset:27648
v_exp_f32 v95, v95
v_mfma_f32_16x16x32_bf16 a[40:43], a[164:167], v[164:167], 0
v_exp_f32 v96, v96
v_mfma_f32_16x16x32_bf16 a[40:43], a[160:163], v[160:163], a[40:43]
v_exp_f32 v97, v97
v_mfma_f32_16x16x32_bf16 a[72:75], a[160:163], v[184:187], 0
v_exp_f32 v98, v98
v_mfma_f32_16x16x32_bf16 a[72:75], a[164:167], v[188:191], a[72:75]
v_exp_f32 v99, v99
v_mfma_f32_16x16x32_bf16 a[104:107], a[164:167], v[196:199], 0
ds_read_b128 a[176:179], v3 offset:20480
v_cvt_pk_bf16_f32 v170, v92, v93
v_mfma_f32_16x16x32_bf16 a[104:107], a[160:163], v[192:195], a[104:107]
s_waitcnt lgkmcnt(1)
v_exp_f32 v112, v112
v_mfma_f32_16x16x32_bf16 a[108:111], a[168:171], v[192:195], 0
v_exp_f32 v113, v113
v_mfma_f32_16x16x32_bf16 a[108:111], a[172:175], v[196:199], a[108:111]
ds_read_b128 a[180:183], v3 offset:28672
v_cvt_pk_bf16_f32 v171, v94, v95
v_mfma_f32_16x16x32_bf16 a[76:79], a[172:175], v[188:191], 0
v_exp_f32 v114, v114
v_mfma_f32_16x16x32_bf16 a[76:79], a[168:171], v[184:187], a[76:79]
v_cvt_pk_bf16_f32 v172, v96, v97
v_xor_b32 v2, 0x8000, v2
v_mfma_f32_16x16x32_bf16 a[44:47], a[168:171], v[160:163], 0
ds_read_b128 a[184:187], v3 offset:21504
ds_read_b128 a[188:191], v3 offset:29696
ds_read_b128 a[192:195], v3 offset:22528
ds_read_b128 a[196:199], v3 offset:30720
ds_read_b128 a[200:203], v3 offset:23552
ds_read_b128 a[204:207], v3 offset:31744
v_exp_f32 v115, v115
v_mfma_f32_16x16x32_bf16 a[44:47], a[172:175], v[164:167], a[44:47]
s_waitcnt vmcnt(8)
s_barrier
v_exp_f32 v128, v128
v_mfma_f32_16x16x32_bf16 a[12:15], a[172:175], v[156:159], 0
v_cvt_pk_bf16_f32 v173, v98, v99
v_cvt_pk_bf16_f32 v180, v112, v113
v_mfma_f32_16x16x32_bf16 a[12:15], a[168:171], v[152:155], a[12:15]
s_waitcnt lgkmcnt(6)
v_exp_f32 v129, v129
v_mfma_f32_16x16x32_bf16 a[16:19], a[176:179], v[152:155], 0
v_exp_f32 v130, v130
v_mfma_f32_16x16x32_bf16 a[16:19], a[180:183], v[156:159], a[16:19]
s_xor_b32 s71, s71, 49152
v_exp_f32 v131, v131
v_mfma_f32_16x16x32_bf16 a[48:51], a[180:183], v[164:167], 0
s_add_u32 s70, s70, 32768
v_exp_f32 v144, v144
v_mfma_f32_16x16x32_bf16 a[48:51], a[176:179], v[160:163], a[48:51]
s_mov_b32 m0, s71
v_exp_f32 v145, v145
v_mfma_f32_16x16x32_bf16 a[80:83], a[176:179], v[184:187], 0
buffer_load_dwordx4 v16, s[32:35], s70 offen offset:0 sc1 lds
v_cvt_pk_bf16_f32 v181, v114, v115
v_mfma_f32_16x16x32_bf16 a[80:83], a[180:183], v[188:191], a[80:83]
v_exp_f32 v146, v146
v_mfma_f32_16x16x32_bf16 a[112:115], a[180:183], v[196:199], 0
v_exp_f32 v147, v147
v_mfma_f32_16x16x32_bf16 a[112:115], a[176:179], v[192:195], a[112:115]
s_waitcnt lgkmcnt(0)
v_cvt_pk_bf16_f32 v204, v128, v129
v_cvt_pk_bf16_f32 v205, v130, v131
v_mfma_f32_16x16x32_bf16 a[116:119], a[184:187], v[192:195], 0
v_exp_f32 v148, v148
v_mfma_f32_16x16x32_bf16 a[116:119], a[188:191], v[196:199], a[116:119]
v_exp_f32 v149, v149
v_mfma_f32_16x16x32_bf16 a[84:87], a[188:191], v[188:191], 0
v_exp_f32 v150, v150
v_mfma_f32_16x16x32_bf16 a[84:87], a[184:187], v[184:187], a[84:87]
v_exp_f32 v151, v151
v_mfma_f32_16x16x32_bf16 a[52:55], a[184:187], v[160:163], 0
v_cvt_pk_bf16_f32 v212, v144, v145
v_cvt_pk_bf16_f32 v213, v146, v147
v_mfma_f32_16x16x32_bf16 a[52:55], a[188:191], v[164:167], a[52:55]
v_exp_f32 v132, v132
v_mfma_f32_16x16x32_bf16 a[20:23], a[188:191], v[156:159], 0
v_exp_f32 v133, v133
v_mfma_f32_16x16x32_bf16 a[20:23], a[184:187], v[152:155], a[20:23]
ds_read_b128 a[144:147], v2 offset:0
v_lshl_add_u32 v19, v0, 24, s66
v_mfma_f32_16x16x32_bf16 a[24:27], a[192:195], v[152:155], 0
s_lshr_b32 s67, s31, 4
v_exp_f32 v134, v134
v_mfma_f32_16x16x32_bf16 a[24:27], a[196:199], v[156:159], a[24:27]
s_lshl1_add_u32 s67, s3, s67
v_exp_f32 v135, v135
v_mfma_f32_16x16x32_bf16 a[56:59], a[196:199], v[164:167], 0
s_lshl_b32 s79, s67, 8
v_cvt_pk_bf16_f32 v214, v148, v149
v_cvt_pk_bf16_f32 v215, v150, v151
v_mfma_f32_16x16x32_bf16 a[56:59], a[192:195], v[160:163], a[56:59]
s_add_u32 s79, s79, 8192
buffer_load_dwordx4 v16, s[32:35], s70 offen offset:1024 sc1 lds
v_mfma_f32_16x16x32_bf16 a[88:91], a[192:195], v[184:187], 0
s_add_u32 s69, s31, 12
v_exp_f32 v116, v116
v_mfma_f32_16x16x32_bf16 a[88:91], a[196:199], v[188:191], a[88:91]
s_lshr_b32 s69, s69, 5
v_exp_f32 v117, v117
v_mfma_f32_16x16x32_bf16 a[120:123], a[196:199], v[196:199], 0
s_lshl1_add_u32 s69, s3, s69
v_exp_f32 v118, v118
v_mfma_f32_16x16x32_bf16 a[120:123], a[192:195], v[192:195], a[120:123]
s_lshl_b32 s69, s69, 8
v_cvt_pk_bf16_f32 v206, v132, v133
v_cvt_pk_bf16_f32 v207, v134, v135
v_mfma_f32_16x16x32_bf16 a[124:127], a[200:203], v[192:195], 0
s_add_u32 s69, s69, 8192
v_exp_f32 v119, v119
v_mfma_f32_16x16x32_bf16 a[124:127], a[204:207], v[196:199], a[124:127]
s_lshl_b32 s67, s73, 16
v_exp_f32 v100, v100
v_mfma_f32_16x16x32_bf16 a[92:95], a[204:207], v[188:191], 0
s_xor_b32 s68, s80, 256
v_exp_f32 v101, v101
v_mfma_f32_16x16x32_bf16 a[92:95], a[200:203], v[184:187], a[92:95]
s_add_u32 s68, s68, s67
ds_read_b128 a[148:151], v2 offset:1024
v_cvt_pk_bf16_f32 v182, v116, v117
v_mfma_f32_16x16x32_bf16 a[60:63], a[200:203], v[160:163], 0
ds_read_b128 a[152:155], v2 offset:2048
v_exp_f32 v102, v102
v_mfma_f32_16x16x32_bf16 a[60:63], a[204:207], v[164:167], a[60:63]
s_add_u32 s67, s67, s69
ds_read_b128 a[156:159], v2 offset:3072
v_cvt_pk_bf16_f32 v183, v118, v119
v_mfma_f32_16x16x32_bf16 a[28:31], a[204:207], v[156:159], 0
s_mov_b64 exec, 1
buffer_atomic_add a251, v19, s[52:55], s67 offen offset:0 sc1
buffer_atomic_add a251, v19, s[52:55], s68 offen offset:0 sc1
s_mov_b64 exec, -1
v_exp_f32 v103, v103
v_mfma_f32_16x16x32_bf16 a[28:31], a[200:203], v[152:155], a[28:31]
ds_read_b128 a[160:163], v2 offset:4096
ds_read_b128 a[164:167], v2 offset:5120
ds_read_b128 a[168:171], v2 offset:6144
ds_read_b128 a[172:175], v2 offset:7168
v_mul_u32_u24 v19, 52, v0
v_cvt_pk_bf16_f32 v174, v100, v101
v_cvt_pk_bf16_f32 v175, v102, v103
v_xor_b32 v3, 0x8000, v3
s_sub_u32 s72, s3, 1
s_cmp_eq_u32 s72, 0
s_cbranch_scc1 L_DD
L_D:
s_waitcnt lgkmcnt(7)
v_mfma_f32_16x16x32_bf16 v[88:91], a[144:147], v[24:27], v[216:219]
s_waitcnt lgkmcnt(6)
ds_read_b128 a[176:179], v2 offset:8192
v_mfma_f32_16x16x32_bf16 v[88:91], a[148:151], v[28:31], v[88:91]
s_waitcnt lgkmcnt(6)
ds_read_b128 a[180:183], v2 offset:9216
v_mfma_f32_16x16x32_bf16 v[88:91], a[152:155], v[32:35], v[88:91]
s_waitcnt lgkmcnt(6)
buffer_load_dwordx4 v16, s[32:35], s70 offen offset:2048 sc1 lds
v_mfma_f32_16x16x32_bf16 v[88:91], a[156:159], v[36:39], v[88:91]
ds_read_b128 a[184:187], v2 offset:10240
v_mfma_f32_16x16x32_bf16 v[104:107], a[156:159], v[52:55], v[220:223]
v_mfma_f32_16x16x32_bf16 v[104:107], a[152:155], v[48:51], v[104:107]
buffer_load_dword a252, v19, s[40:43], s81 offen
v_mfma_f32_16x16x32_bf16 v[104:107], a[148:151], v[44:47], v[104:107]
ds_read_b128 a[188:191], v2 offset:11264
v_mfma_f32_16x16x32_bf16 v[104:107], a[144:147], v[40:43], v[104:107]
v_mfma_f32_16x16x32_bf16 v[120:123], a[144:147], v[56:59], v[224:227]
v_mfma_f32_16x16x32_bf16 v[120:123], a[148:151], v[60:63], v[120:123]
v_mfma_f32_16x16x32_bf16 v[120:123], a[152:155], v[64:67], v[120:123]
v_exp_f32 v88, v88
v_mfma_f32_16x16x32_bf16 v[120:123], a[156:159], v[68:71], v[120:123]
v_exp_f32 v89, v89
v_mfma_f32_16x16x32_bf16 v[136:139], a[156:159], v[84:87], v[228:231]
v_exp_f32 v90, v90
v_mfma_f32_16x16x32_bf16 v[136:139], a[152:155], v[80:83], v[136:139]
v_exp_f32 v91, v91
v_mfma_f32_16x16x32_bf16 v[136:139], a[148:151], v[76:79], v[136:139]
v_exp_f32 v104, v104
v_mfma_f32_16x16x32_bf16 v[136:139], a[144:147], v[72:75], v[136:139]
s_waitcnt lgkmcnt(0)
s_add_u32 s81, s81, 425984
v_exp_f32 v105, v105
v_mfma_f32_16x16x32_bf16 v[140:143], a[160:163], v[72:75], v[228:231]
v_exp_f32 v106, v106
v_mfma_f32_16x16x32_bf16 v[140:143], a[164:167], v[76:79], v[140:143]
buffer_load_dwordx4 v16, s[32:35], s70 offen offset:3072 sc1 lds
v_mfma_f32_16x16x32_bf16 v[140:143], a[168:171], v[80:83], v[140:143]
v_exp_f32 v107, v107
v_mfma_f32_16x16x32_bf16 v[140:143], a[172:175], v[84:87], v[140:143]
v_cvt_pk_bf16_f32 v152, v88, v89
v_cvt_pk_bf16_f32 v153, v90, v91
v_mfma_f32_16x16x32_bf16 v[124:127], a[172:175], v[68:71], v[224:227]
v_exp_f32 v120, v120
v_mfma_f32_16x16x32_bf16 v[124:127], a[168:171], v[64:67], v[124:127]
v_exp_f32 v121, v121
v_mfma_f32_16x16x32_bf16 v[124:127], a[164:167], v[60:63], v[124:127]
v_exp_f32 v122, v122
v_mfma_f32_16x16x32_bf16 v[124:127], a[160:163], v[56:59], v[124:127]
v_exp_f32 v123, v123
v_mfma_f32_16x16x32_bf16 v[108:111], a[160:163], v[40:43], v[220:223]
v_exp_f32 v136, v136
v_mfma_f32_16x16x32_bf16 v[108:111], a[164:167], v[44:47], v[108:111]
v_exp_f32 v137, v137
v_mfma_f32_16x16x32_bf16 v[108:111], a[168:171], v[48:51], v[108:111]
v_exp_f32 v138, v138
v_mfma_f32_16x16x32_bf16 v[108:111], a[172:175], v[52:55], v[108:111]
v_cvt_pk_bf16_f32 v160, v104, v105
v_cvt_pk_bf16_f32 v161, v106, v107
v_mfma_f32_16x16x32_bf16 v[92:95], a[172:175], v[36:39], v[216:219]
v_exp_f32 v139, v139
v_mfma_f32_16x16x32_bf16 v[92:95], a[168:171], v[32:35], v[92:95]
ds_read_b128 a[192:195], v2 offset:12288
v_cvt_pk_bf16_f32 v184, v120, v121
v_mfma_f32_16x16x32_bf16 v[92:95], a[164:167], v[28:31], v[92:95]
v_exp_f32 v140, v140
v_mfma_f32_16x16x32_bf16 v[92:95], a[160:163], v[24:27], v[92:95]
s_add_u32 m0, s71, 4096
ds_read_b128 a[196:199], v2 offset:13312
v_cvt_pk_bf16_f32 v185, v122, v123
v_mfma_f32_16x16x32_bf16 v[96:99], a[176:179], v[24:27], v[216:219]
s_add_u32 s64, s70, 4096
ds_read_b128 a[200:203], v2 offset:14336
v_cvt_pk_bf16_f32 v192, v136, v137
v_mfma_f32_16x16x32_bf16 v[96:99], a[180:183], v[28:31], v[96:99]
buffer_load_dwordx4 v16, s[32:35], s64 offen offset:0 sc1 lds
v_mfma_f32_16x16x32_bf16 v[96:99], a[184:187], v[32:35], v[96:99]
v_exp_f32 v141, v141
v_mfma_f32_16x16x32_bf16 v[96:99], a[188:191], v[36:39], v[96:99]
ds_read_b128 a[204:207], v2 offset:15360
v_cvt_pk_bf16_f32 v193, v138, v139
v_mfma_f32_16x16x32_bf16 v[112:115], a[188:191], v[52:55], v[220:223]
v_exp_f32 v142, v142
v_mfma_f32_16x16x32_bf16 v[112:115], a[184:187], v[48:51], v[112:115]
v_exp_f32 v143, v143
v_mfma_f32_16x16x32_bf16 v[112:115], a[180:183], v[44:47], v[112:115]
v_exp_f32 v124, v124
v_mfma_f32_16x16x32_bf16 v[112:115], a[176:179], v[40:43], v[112:115]
v_exp_f32 v125, v125
v_mfma_f32_16x16x32_bf16 v[128:131], a[176:179], v[56:59], v[224:227]
v_exp_f32 v126, v126
v_mfma_f32_16x16x32_bf16 v[128:131], a[180:183], v[60:63], v[128:131]
v_exp_f32 v127, v127
v_mfma_f32_16x16x32_bf16 v[128:131], a[184:187], v[64:67], v[128:131]
v_exp_f32 v108, v108
v_mfma_f32_16x16x32_bf16 v[128:131], a[188:191], v[68:71], v[128:131]
v_exp_f32 v109, v109
v_mfma_f32_16x16x32_bf16 v[144:147], a[188:191], v[84:87], v[228:231]
v_exp_f32 v110, v110
v_mfma_f32_16x16x32_bf16 v[144:147], a[184:187], v[80:83], v[144:147]
ds_read_b128 a[144:147], v3 offset:0
v_cvt_pk_bf16_f32 v194, v140, v141
v_mfma_f32_16x16x32_bf16 v[144:147], a[180:183], v[76:79], v[144:147]
ds_read_b128 a[148:151], v3 offset:8192
v_cvt_pk_bf16_f32 v195, v142, v143
v_mfma_f32_16x16x32_bf16 v[144:147], a[176:179], v[72:75], v[144:147]
s_waitcnt lgkmcnt(2)
v_exp_f32 v111, v111
v_mfma_f32_16x16x32_bf16 v[148:151], a[192:195], v[72:75], v[228:231]
buffer_load_dwordx4 v16, s[32:35], s64 offen offset:1024 sc1 lds
v_mfma_f32_16x16x32_bf16 v[148:151], a[196:199], v[76:79], v[148:151]
v_exp_f32 v92, v92
v_mfma_f32_16x16x32_bf16 v[148:151], a[200:203], v[80:83], v[148:151]
v_exp_f32 v93, v93
v_mfma_f32_16x16x32_bf16 v[148:151], a[204:207], v[84:87], v[148:151]
v_exp_f32 v94, v94
v_mfma_f32_16x16x32_bf16 v[132:135], a[204:207], v[68:71], v[224:227]
ds_read_b128 a[152:155], v3 offset:1024
v_cvt_pk_bf16_f32 v186, v124, v125
v_mfma_f32_16x16x32_bf16 v[132:135], a[200:203], v[64:67], v[132:135]
ds_read_b128 a[156:159], v3 offset:9216
v_cvt_pk_bf16_f32 v187, v126, v127
v_mfma_f32_16x16x32_bf16 v[132:135], a[196:199], v[60:63], v[132:135]
v_exp_f32 v95, v95
v_mfma_f32_16x16x32_bf16 v[132:135], a[192:195], v[56:59], v[132:135]
v_exp_f32 v96, v96
v_mfma_f32_16x16x32_bf16 v[116:119], a[192:195], v[40:43], v[220:223]
v_exp_f32 v97, v97
v_mfma_f32_16x16x32_bf16 v[116:119], a[196:199], v[44:47], v[116:119]
v_exp_f32 v98, v98
v_mfma_f32_16x16x32_bf16 v[116:119], a[200:203], v[48:51], v[116:119]
ds_read_b128 a[160:163], v3 offset:2048
v_cvt_pk_bf16_f32 v162, v108, v109
v_mfma_f32_16x16x32_bf16 v[116:119], a[204:207], v[52:55], v[116:119]
v_exp_f32 v99, v99
v_mfma_f32_16x16x32_bf16 v[100:103], a[204:207], v[36:39], v[216:219]
ds_read_b128 a[164:167], v3 offset:10240
v_cvt_pk_bf16_f32 v163, v110, v111
v_mfma_f32_16x16x32_bf16 v[100:103], a[200:203], v[32:35], v[100:103]
v_exp_f32 v112, v112
v_mfma_f32_16x16x32_bf16 v[100:103], a[196:199], v[28:31], v[100:103]
v_exp_f32 v113, v113
v_mfma_f32_16x16x32_bf16 v[100:103], a[192:195], v[24:27], v[100:103]
v_exp_f32 v114, v114
v_smfmac_f32_16x16x64_bf16 a[128:131], a[240:243], v[168:175], v5
ds_read_b128 a[168:171], v3 offset:3072
v_smfmac_f32_16x16x64_bf16 a[132:135], a[240:243], v[176:183], v5
ds_read_b128 a[172:175], v3 offset:11264
v_smfmac_f32_16x16x64_bf16 a[136:139], a[240:243], v[200:207], v5
ds_read_b128 a[176:179], v3 offset:4096
v_smfmac_f32_16x16x64_bf16 a[140:143], a[240:243], v[208:215], v5
s_waitcnt lgkmcnt(3)
buffer_load_dwordx4 v16, s[32:35], s64 offen offset:2048 sc1 lds
v_mfma_f32_16x16x32_bf16 a[0:3], a[144:147], v[168:171], a[0:3]
v_exp_f32 v115, v115
v_mfma_f32_16x16x32_bf16 a[0:3], a[148:151], v[172:175], a[0:3]
v_exp_f32 v128, v128
v_mfma_f32_16x16x32_bf16 a[32:35], a[148:151], v[180:183], a[32:35]
v_exp_f32 v129, v129
v_mfma_f32_16x16x32_bf16 a[32:35], a[144:147], v[176:179], a[32:35]
v_exp_f32 v130, v130
v_mfma_f32_16x16x32_bf16 a[64:67], a[144:147], v[200:203], a[64:67]
v_exp_f32 v131, v131
v_mfma_f32_16x16x32_bf16 a[64:67], a[148:151], v[204:207], a[64:67]
v_cvt_pk_bf16_f32 v154, v92, v93
v_cvt_pk_bf16_f32 v155, v94, v95
v_mfma_f32_16x16x32_bf16 a[96:99], a[148:151], v[212:215], a[96:99]
v_exp_f32 v144, v144
v_mfma_f32_16x16x32_bf16 a[96:99], a[144:147], v[208:211], a[96:99]
ds_read_b128 a[180:183], v3 offset:12288
v_cvt_pk_bf16_f32 v156, v96, v97
v_mfma_f32_16x16x32_bf16 a[100:103], a[152:155], v[208:211], a[100:103]
v_exp_f32 v145, v145
v_mfma_f32_16x16x32_bf16 a[100:103], a[156:159], v[212:215], a[100:103]
ds_read_b128 a[184:187], v3 offset:5120
v_cvt_pk_bf16_f32 v157, v98, v99
v_mfma_f32_16x16x32_bf16 a[68:71], a[156:159], v[204:207], a[68:71]
ds_read_b128 a[188:191], v3 offset:13312
v_cvt_pk_bf16_f32 v164, v112, v113
v_mfma_f32_16x16x32_bf16 a[68:71], a[152:155], v[200:203], a[68:71]
buffer_load_dwordx4 v16, s[32:35], s64 offen offset:3072 sc1 lds
v_mfma_f32_16x16x32_bf16 a[36:39], a[152:155], v[176:179], a[36:39]
ds_read_b128 a[192:195], v3 offset:6144
v_cvt_pk_bf16_f32 v165, v114, v115
v_mfma_f32_16x16x32_bf16 a[36:39], a[156:159], v[180:183], a[36:39]
ds_read_b128 a[196:199], v3 offset:14336
v_cvt_pk_bf16_f32 v188, v128, v129
v_mfma_f32_16x16x32_bf16 a[4:7], a[156:159], v[172:175], a[4:7]
ds_read_b128 a[200:203], v3 offset:7168
v_cvt_pk_bf16_f32 v189, v130, v131
v_mfma_f32_16x16x32_bf16 a[4:7], a[152:155], v[168:171], a[4:7]
v_exp_f32 v146, v146
v_mfma_f32_16x16x32_bf16 a[8:11], a[160:163], v[168:171], a[8:11]
v_exp_f32 v147, v147
v_mfma_f32_16x16x32_bf16 a[8:11], a[164:167], v[172:175], a[8:11]
v_exp_f32 v148, v148
v_mfma_f32_16x16x32_bf16 a[40:43], a[164:167], v[180:183], a[40:43]
ds_read_b128 a[204:207], v3 offset:15360
v_cvt_pk_bf16_f32 v196, v144, v145
v_mfma_f32_16x16x32_bf16 a[40:43], a[160:163], v[176:179], a[40:43]
v_exp_f32 v149, v149
v_mfma_f32_16x16x32_bf16 a[72:75], a[160:163], v[200:203], a[72:75]
v_exp_f32 v150, v150
v_mfma_f32_16x16x32_bf16 a[72:75], a[164:167], v[204:207], a[72:75]
v_exp_f32 v151, v151
v_mfma_f32_16x16x32_bf16 a[104:107], a[164:167], v[212:215], a[104:107]
v_exp_f32 v132, v132
v_mfma_f32_16x16x32_bf16 a[104:107], a[160:163], v[208:211], a[104:107]
s_waitcnt lgkmcnt(1)
v_exp_f32 v133, v133
v_mfma_f32_16x16x32_bf16 a[108:111], a[168:171], v[208:211], a[108:111]
v_exp_f32 v134, v134
v_mfma_f32_16x16x32_bf16 a[108:111], a[172:175], v[212:215], a[108:111]
v_exp_f32 v135, v135
v_mfma_f32_16x16x32_bf16 a[76:79], a[172:175], v[204:207], a[76:79]
v_exp_f32 v116, v116
v_mfma_f32_16x16x32_bf16 a[76:79], a[168:171], v[200:203], a[76:79]
v_exp_f32 v117, v117
v_mfma_f32_16x16x32_bf16 a[44:47], a[168:171], v[176:179], a[44:47]
v_exp_f32 v118, v118
v_mfma_f32_16x16x32_bf16 a[44:47], a[172:175], v[180:183], a[44:47]
s_waitcnt vmcnt(9)
s_barrier
v_mfma_f32_16x16x32_bf16 a[12:15], a[172:175], v[172:175], a[12:15]
s_xor_b32 s71, s71, 16384
v_exp_f32 v119, v119
v_mfma_f32_16x16x32_bf16 a[12:15], a[168:171], v[168:171], a[12:15]
s_add_u32 s70, s70, 32768
v_exp_f32 v100, v100
v_mfma_f32_16x16x32_bf16 a[16:19], a[176:179], v[168:171], a[16:19]
s_mov_b32 m0, s71
v_exp_f32 v101, v101
v_mfma_f32_16x16x32_bf16 a[16:19], a[180:183], v[172:175], a[16:19]
buffer_load_dwordx4 v16, s[32:35], s70 offen offset:0 sc1 lds
v_mfma_f32_16x16x32_bf16 a[48:51], a[180:183], v[180:183], a[48:51]
ds_read_b128 a[144:147], v2 offset:16384
v_cvt_pk_bf16_f32 v197, v146, v147
v_mfma_f32_16x16x32_bf16 a[48:51], a[176:179], v[176:179], a[48:51]
ds_read_b128 a[148:151], v2 offset:17408
v_cvt_pk_bf16_f32 v198, v148, v149
v_mfma_f32_16x16x32_bf16 a[80:83], a[176:179], v[200:203], a[80:83]
v_exp_f32 v102, v102
v_mfma_f32_16x16x32_bf16 a[80:83], a[180:183], v[204:207], a[80:83]
ds_read_b128 a[152:155], v2 offset:18432
v_cvt_pk_bf16_f32 v199, v150, v151
v_mfma_f32_16x16x32_bf16 a[112:115], a[180:183], v[212:215], a[112:115]
ds_read_b128 a[156:159], v2 offset:19456
v_cvt_pk_bf16_f32 v190, v132, v133
v_mfma_f32_16x16x32_bf16 a[112:115], a[176:179], v[208:211], a[112:115]
v_exp_f32 v103, v103
v_mfma_f32_16x16x32_bf16 a[116:119], a[184:187], v[208:211], a[116:119]
ds_read_b128 a[160:163], v2 offset:20480
v_cvt_pk_bf16_f32 v191, v134, v135
v_mfma_f32_16x16x32_bf16 a[116:119], a[188:191], v[212:215], a[116:119]
ds_read_b128 a[164:167], v2 offset:21504
v_cvt_pk_bf16_f32 v166, v116, v117
v_mfma_f32_16x16x32_bf16 a[84:87], a[188:191], v[204:207], a[84:87]
ds_read_b128 a[168:171], v2 offset:22528
v_cvt_pk_bf16_f32 v167, v118, v119
v_mfma_f32_16x16x32_bf16 a[84:87], a[184:187], v[200:203], a[84:87]
ds_read_b128 a[172:175], v2 offset:23552
v_cvt_pk_bf16_f32 v158, v100, v101
v_mfma_f32_16x16x32_bf16 a[52:55], a[184:187], v[176:179], a[52:55]
v_cvt_pk_bf16_f32 v159, v102, v103
v_mfma_f32_16x16x32_bf16 a[52:55], a[188:191], v[180:183], a[52:55]
v_mfma_f32_16x16x32_bf16 a[20:23], a[188:191], v[172:175], a[20:23]
v_mfma_f32_16x16x32_bf16 a[20:23], a[184:187], v[168:171], a[20:23]
v_mfma_f32_16x16x32_bf16 a[24:27], a[192:195], v[168:171], a[24:27]
buffer_load_dwordx4 v16, s[32:35], s70 offen offset:1024 sc1 lds
v_mfma_f32_16x16x32_bf16 a[24:27], a[196:199], v[172:175], a[24:27]
v_mfma_f32_16x16x32_bf16 a[56:59], a[196:199], v[180:183], a[56:59]
v_mfma_f32_16x16x32_bf16 a[56:59], a[192:195], v[176:179], a[56:59]
v_mfma_f32_16x16x32_bf16 a[88:91], a[192:195], v[200:203], a[88:91]
v_mfma_f32_16x16x32_bf16 a[88:91], a[196:199], v[204:207], a[88:91]
v_mfma_f32_16x16x32_bf16 a[120:123], a[196:199], v[212:215], a[120:123]
v_mfma_f32_16x16x32_bf16 a[120:123], a[192:195], v[208:211], a[120:123]
v_mfma_f32_16x16x32_bf16 a[124:127], a[200:203], v[208:211], a[124:127]
s_waitcnt lgkmcnt(0)
v_mfma_f32_16x16x32_bf16 a[124:127], a[204:207], v[212:215], a[124:127]
v_mfma_f32_16x16x32_bf16 a[92:95], a[204:207], v[204:207], a[92:95]
v_mfma_f32_16x16x32_bf16 a[92:95], a[200:203], v[200:203], a[92:95]
v_mfma_f32_16x16x32_bf16 a[60:63], a[200:203], v[176:179], a[60:63]
v_mfma_f32_16x16x32_bf16 a[60:63], a[204:207], v[180:183], a[60:63]
v_mfma_f32_16x16x32_bf16 a[28:31], a[204:207], v[172:175], a[28:31]
v_mfma_f32_16x16x32_bf16 a[28:31], a[200:203], v[168:171], a[28:31]
v_mfma_f32_16x16x32_bf16 v[88:91], a[144:147], v[24:27], v[216:219]
ds_read_b128 a[176:179], v2 offset:24576
v_mfma_f32_16x16x32_bf16 v[88:91], a[148:151], v[28:31], v[88:91]
ds_read_b128 a[180:183], v2 offset:25600
v_mfma_f32_16x16x32_bf16 v[88:91], a[152:155], v[32:35], v[88:91]
buffer_load_dwordx4 v16, s[32:35], s70 offen offset:2048 sc1 lds
v_mfma_f32_16x16x32_bf16 v[88:91], a[156:159], v[36:39], v[88:91]
ds_read_b128 a[184:187], v2 offset:26624
v_mfma_f32_16x16x32_bf16 v[104:107], a[156:159], v[52:55], v[220:223]
v_mfma_f32_16x16x32_bf16 v[104:107], a[152:155], v[48:51], v[104:107]
v_mfma_f32_16x16x32_bf16 v[104:107], a[148:151], v[44:47], v[104:107]
ds_read_b128 a[188:191], v2 offset:27648
v_mfma_f32_16x16x32_bf16 v[104:107], a[144:147], v[40:43], v[104:107]
v_mfma_f32_16x16x32_bf16 v[120:123], a[144:147], v[56:59], v[224:227]
v_mfma_f32_16x16x32_bf16 v[120:123], a[148:151], v[60:63], v[120:123]
v_mfma_f32_16x16x32_bf16 v[120:123], a[152:155], v[64:67], v[120:123]
v_exp_f32 v88, v88
v_mfma_f32_16x16x32_bf16 v[120:123], a[156:159], v[68:71], v[120:123]
v_exp_f32 v89, v89
v_mfma_f32_16x16x32_bf16 v[136:139], a[156:159], v[84:87], v[228:231]
v_exp_f32 v90, v90
v_mfma_f32_16x16x32_bf16 v[136:139], a[152:155], v[80:83], v[136:139]
v_exp_f32 v91, v91
v_mfma_f32_16x16x32_bf16 v[136:139], a[148:151], v[76:79], v[136:139]
v_exp_f32 v104, v104
v_mfma_f32_16x16x32_bf16 v[136:139], a[144:147], v[72:75], v[136:139]
v_exp_f32 v105, v105
v_mfma_f32_16x16x32_bf16 v[140:143], a[160:163], v[72:75], v[228:231]
v_exp_f32 v106, v106
v_mfma_f32_16x16x32_bf16 v[140:143], a[164:167], v[76:79], v[140:143]
buffer_load_dwordx4 v16, s[32:35], s70 offen offset:3072 sc1 lds
v_mfma_f32_16x16x32_bf16 v[140:143], a[168:171], v[80:83], v[140:143]
v_exp_f32 v107, v107
v_mfma_f32_16x16x32_bf16 v[140:143], a[172:175], v[84:87], v[140:143]
v_cvt_pk_bf16_f32 v168, v88, v89
v_cvt_pk_bf16_f32 v169, v90, v91
v_mfma_f32_16x16x32_bf16 v[124:127], a[172:175], v[68:71], v[224:227]
v_exp_f32 v120, v120
v_mfma_f32_16x16x32_bf16 v[124:127], a[168:171], v[64:67], v[124:127]
v_exp_f32 v121, v121
v_mfma_f32_16x16x32_bf16 v[124:127], a[164:167], v[60:63], v[124:127]
v_exp_f32 v122, v122
v_mfma_f32_16x16x32_bf16 v[124:127], a[160:163], v[56:59], v[124:127]
v_exp_f32 v123, v123
v_mfma_f32_16x16x32_bf16 v[108:111], a[160:163], v[40:43], v[220:223]
v_exp_f32 v136, v136
v_mfma_f32_16x16x32_bf16 v[108:111], a[164:167], v[44:47], v[108:111]
v_exp_f32 v137, v137
v_mfma_f32_16x16x32_bf16 v[108:111], a[168:171], v[48:51], v[108:111]
v_exp_f32 v138, v138
v_mfma_f32_16x16x32_bf16 v[108:111], a[172:175], v[52:55], v[108:111]
v_cvt_pk_bf16_f32 v176, v104, v105
v_cvt_pk_bf16_f32 v177, v106, v107
v_mfma_f32_16x16x32_bf16 v[92:95], a[172:175], v[36:39], v[216:219]
v_exp_f32 v139, v139
v_mfma_f32_16x16x32_bf16 v[92:95], a[168:171], v[32:35], v[92:95]
ds_read_b128 a[192:195], v2 offset:28672
v_cvt_pk_bf16_f32 v200, v120, v121
v_mfma_f32_16x16x32_bf16 v[92:95], a[164:167], v[28:31], v[92:95]
v_exp_f32 v140, v140
v_mfma_f32_16x16x32_bf16 v[92:95], a[160:163], v[24:27], v[92:95]
s_waitcnt lgkmcnt(1)
s_add_u32 m0, s71, 4096
ds_read_b128 a[196:199], v2 offset:29696
v_cvt_pk_bf16_f32 v201, v122, v123
v_mfma_f32_16x16x32_bf16 v[96:99], a[176:179], v[24:27], v[216:219]
s_add_u32 s64, s70, 4096
ds_read_b128 a[200:203], v2 offset:30720
v_cvt_pk_bf16_f32 v208, v136, v137
v_mfma_f32_16x16x32_bf16 v[96:99], a[180:183], v[28:31], v[96:99]
buffer_load_dwordx4 v16, s[32:35], s64 offen offset:0 sc1 lds
v_mfma_f32_16x16x32_bf16 v[96:99], a[184:187], v[32:35], v[96:99]
v_exp_f32 v141, v141
v_mfma_f32_16x16x32_bf16 v[96:99], a[188:191], v[36:39], v[96:99]
ds_read_b128 a[204:207], v2 offset:31744
v_cvt_pk_bf16_f32 v209, v138, v139
v_mfma_f32_16x16x32_bf16 v[112:115], a[188:191], v[52:55], v[220:223]
v_exp_f32 v142, v142
v_mfma_f32_16x16x32_bf16 v[112:115], a[184:187], v[48:51], v[112:115]
v_exp_f32 v143, v143
v_mfma_f32_16x16x32_bf16 v[112:115], a[180:183], v[44:47], v[112:115]
v_exp_f32 v124, v124
v_mfma_f32_16x16x32_bf16 v[112:115], a[176:179], v[40:43], v[112:115]
v_exp_f32 v125, v125
v_mfma_f32_16x16x32_bf16 v[128:131], a[176:179], v[56:59], v[224:227]
v_exp_f32 v126, v126
v_mfma_f32_16x16x32_bf16 v[128:131], a[180:183], v[60:63], v[128:131]
v_exp_f32 v127, v127
v_mfma_f32_16x16x32_bf16 v[128:131], a[184:187], v[64:67], v[128:131]
v_exp_f32 v108, v108
v_mfma_f32_16x16x32_bf16 v[128:131], a[188:191], v[68:71], v[128:131]
v_exp_f32 v109, v109
v_mfma_f32_16x16x32_bf16 v[144:147], a[188:191], v[84:87], v[228:231]
s_branch L_po16
L_pg16:
s_branch L_pg22
L_po16:
v_exp_f32 v110, v110
v_mfma_f32_16x16x32_bf16 v[144:147], a[184:187], v[80:83], v[144:147]
ds_read_b128 a[144:147], v3 offset:16384
v_cvt_pk_bf16_f32 v210, v140, v141
v_mfma_f32_16x16x32_bf16 v[144:147], a[180:183], v[76:79], v[144:147]
ds_read_b128 a[148:151], v3 offset:24576
v_cvt_pk_bf16_f32 v211, v142, v143
v_mfma_f32_16x16x32_bf16 v[144:147], a[176:179], v[72:75], v[144:147]
s_waitcnt lgkmcnt(2)
v_exp_f32 v111, v111
v_mfma_f32_16x16x32_bf16 v[148:151], a[192:195], v[72:75], v[228:231]
buffer_load_dwordx4 v16, s[32:35], s64 offen offset:1024 sc1 lds
v_mfma_f32_16x16x32_bf16 v[148:151], a[196:199], v[76:79], v[148:151]
v_exp_f32 v92, v92
v_mfma_f32_16x16x32_bf16 v[148:151], a[200:203], v[80:83], v[148:151]
v_exp_f32 v93, v93
v_mfma_f32_16x16x32_bf16 v[148:151], a[204:207], v[84:87], v[148:151]
v_exp_f32 v94, v94
v_mfma_f32_16x16x32_bf16 v[132:135], a[204:207], v[68:71], v[224:227]
ds_read_b128 a[152:155], v3 offset:17408
v_cvt_pk_bf16_f32 v202, v124, v125
v_mfma_f32_16x16x32_bf16 v[132:135], a[200:203], v[64:67], v[132:135]
ds_read_b128 a[156:159], v3 offset:25600
v_cvt_pk_bf16_f32 v203, v126, v127
v_mfma_f32_16x16x32_bf16 v[132:135], a[196:199], v[60:63], v[132:135]
v_exp_f32 v95, v95
v_mfma_f32_16x16x32_bf16 v[132:135], a[192:195], v[56:59], v[132:135]
v_exp_f32 v96, v96
v_mfma_f32_16x16x32_bf16 v[116:119], a[192:195], v[40:43], v[220:223]
v_exp_f32 v97, v97
v_mfma_f32_16x16x32_bf16 v[116:119], a[196:199], v[44:47], v[116:119]
v_exp_f32 v98, v98
v_mfma_f32_16x16x32_bf16 v[116:119], a[200:203], v[48:51], v[116:119]
ds_read_b128 a[160:163], v3 offset:18432
v_cvt_pk_bf16_f32 v178, v108, v109
v_mfma_f32_16x16x32_bf16 v[116:119], a[204:207], v[52:55], v[116:119]
v_exp_f32 v99, v99
v_mfma_f32_16x16x32_bf16 v[100:103], a[204:207], v[36:39], v[216:219]
ds_read_b128 a[164:167], v3 offset:26624
v_cvt_pk_bf16_f32 v179, v110, v111
v_mfma_f32_16x16x32_bf16 v[100:103], a[200:203], v[32:35], v[100:103]
v_exp_f32 v112, v112
v_mfma_f32_16x16x32_bf16 v[100:103], a[196:199], v[28:31], v[100:103]
v_exp_f32 v113, v113
v_mfma_f32_16x16x32_bf16 v[100:103], a[192:195], v[24:27], v[100:103]
v_exp_f32 v114, v114
v_smfmac_f32_16x16x64_bf16 a[128:131], a[240:243], v[152:159], v5
ds_read_b128 a[168:171], v3 offset:19456
v_smfmac_f32_16x16x64_bf16 a[132:135], a[240:243], v[160:167], v5
ds_read_b128 a[172:175], v3 offset:27648
v_smfmac_f32_16x16x64_bf16 a[136:139], a[240:243], v[184:191], v5
ds_read_b128 a[176:179], v3 offset:20480
v_smfmac_f32_16x16x64_bf16 a[140:143], a[240:243], v[192:199], v5
s_waitcnt lgkmcnt(3)
buffer_load_dwordx4 v16, s[32:35], s64 offen offset:2048 sc1 lds
v_mfma_f32_16x16x32_bf16 a[0:3], a[144:147], v[152:155], a[0:3]
v_exp_f32 v115, v115
v_mfma_f32_16x16x32_bf16 a[0:3], a[148:151], v[156:159], a[0:3]
v_exp_f32 v128, v128
v_mfma_f32_16x16x32_bf16 a[32:35], a[148:151], v[164:167], a[32:35]
v_exp_f32 v129, v129
v_mfma_f32_16x16x32_bf16 a[32:35], a[144:147], v[160:163], a[32:35]
v_exp_f32 v130, v130
v_mfma_f32_16x16x32_bf16 a[64:67], a[144:147], v[184:187], a[64:67]
v_exp_f32 v131, v131
v_mfma_f32_16x16x32_bf16 a[64:67], a[148:151], v[188:191], a[64:67]
v_cvt_pk_bf16_f32 v170, v92, v93
v_cvt_pk_bf16_f32 v171, v94, v95
v_mfma_f32_16x16x32_bf16 a[96:99], a[148:151], v[196:199], a[96:99]
v_exp_f32 v144, v144
v_mfma_f32_16x16x32_bf16 a[96:99], a[144:147], v[192:195], a[96:99]
ds_read_b128 a[180:183], v3 offset:28672
v_cvt_pk_bf16_f32 v172, v96, v97
v_mfma_f32_16x16x32_bf16 a[100:103], a[152:155], v[192:195], a[100:103]
v_exp_f32 v145, v145
v_mfma_f32_16x16x32_bf16 a[100:103], a[156:159], v[196:199], a[100:103]
ds_read_b128 a[184:187], v3 offset:21504
v_xor_b32 v2, 0x8000, v2
v_mfma_f32_16x16x32_bf16 a[68:71], a[156:159], v[188:191], a[68:71]
ds_read_b128 a[188:191], v3 offset:29696
v_cvt_pk_bf16_f32 v173, v98, v99
v_mfma_f32_16x16x32_bf16 a[68:71], a[152:155], v[184:187], a[68:71]
buffer_load_dwordx4 v16, s[32:35], s64 offen offset:3072 sc1 lds
v_mfma_f32_16x16x32_bf16 a[36:39], a[152:155], v[160:163], a[36:39]
ds_read_b128 a[192:195], v3 offset:22528
v_cvt_pk_bf16_f32 v180, v112, v113
v_mfma_f32_16x16x32_bf16 a[36:39], a[156:159], v[164:167], a[36:39]
ds_read_b128 a[196:199], v3 offset:30720
v_cvt_pk_bf16_f32 v181, v114, v115
v_mfma_f32_16x16x32_bf16 a[4:7], a[156:159], v[156:159], a[4:7]
ds_read_b128 a[200:203], v3 offset:23552
v_cvt_pk_bf16_f32 v204, v128, v129
v_mfma_f32_16x16x32_bf16 a[4:7], a[152:155], v[152:155], a[4:7]
v_exp_f32 v146, v146
v_mfma_f32_16x16x32_bf16 a[8:11], a[160:163], v[152:155], a[8:11]
v_exp_f32 v147, v147
v_mfma_f32_16x16x32_bf16 a[8:11], a[164:167], v[156:159], a[8:11]
v_exp_f32 v148, v148
v_mfma_f32_16x16x32_bf16 a[40:43], a[164:167], v[164:167], a[40:43]
ds_read_b128 a[204:207], v3 offset:31744
v_cvt_pk_bf16_f32 v205, v130, v131
v_mfma_f32_16x16x32_bf16 a[40:43], a[160:163], v[160:163], a[40:43]
v_exp_f32 v149, v149
v_mfma_f32_16x16x32_bf16 a[72:75], a[160:163], v[184:187], a[72:75]
v_exp_f32 v150, v150
v_mfma_f32_16x16x32_bf16 a[72:75], a[164:167], v[188:191], a[72:75]
v_exp_f32 v151, v151
v_mfma_f32_16x16x32_bf16 a[104:107], a[164:167], v[196:199], a[104:107]
v_exp_f32 v132, v132
v_mfma_f32_16x16x32_bf16 a[104:107], a[160:163], v[192:195], a[104:107]
s_waitcnt lgkmcnt(1)
v_exp_f32 v133, v133
v_mfma_f32_16x16x32_bf16 a[108:111], a[168:171], v[192:195], a[108:111]
v_exp_f32 v134, v134
v_mfma_f32_16x16x32_bf16 a[108:111], a[172:175], v[196:199], a[108:111]
v_exp_f32 v135, v135
v_mfma_f32_16x16x32_bf16 a[76:79], a[172:175], v[188:191], a[76:79]
v_exp_f32 v116, v116
v_mfma_f32_16x16x32_bf16 a[76:79], a[168:171], v[184:187], a[76:79]
v_exp_f32 v117, v117
v_mfma_f32_16x16x32_bf16 a[44:47], a[168:171], v[160:163], a[44:47]
v_exp_f32 v118, v118
v_mfma_f32_16x16x32_bf16 a[44:47], a[172:175], v[164:167], a[44:47]
s_waitcnt vmcnt(8)
s_barrier
v_mfma_f32_16x16x32_bf16 a[12:15], a[172:175], v[156:159], a[12:15]
s_xor_b32 s71, s71, 49152
v_exp_f32 v119, v119
v_mfma_f32_16x16x32_bf16 a[12:15], a[168:171], v[152:155], a[12:15]
s_add_u32 s70, s70, 32768
v_exp_f32 v100, v100
v_mfma_f32_16x16x32_bf16 a[16:19], a[176:179], v[152:155], a[16:19]
s_mov_b32 m0, s71
v_exp_f32 v101, v101
v_mfma_f32_16x16x32_bf16 a[16:19], a[180:183], v[156:159], a[16:19]
buffer_load_dwordx4 v16, s[32:35], s70 offen offset:0 sc1 lds
v_mfma_f32_16x16x32_bf16 a[48:51], a[180:183], v[164:167], a[48:51]
ds_read_b128 a[144:147], v2 offset:0
v_cvt_pk_bf16_f32 v212, v144, v145
v_mfma_f32_16x16x32_bf16 a[48:51], a[176:179], v[160:163], a[48:51]
ds_read_b128 a[148:151], v2 offset:1024
v_cvt_pk_bf16_f32 v213, v146, v147
v_mfma_f32_16x16x32_bf16 a[80:83], a[176:179], v[184:187], a[80:83]
v_exp_f32 v102, v102
v_mfma_f32_16x16x32_bf16 a[80:83], a[180:183], v[188:191], a[80:83]
ds_read_b128 a[152:155], v2 offset:2048
v_cvt_pk_bf16_f32 v214, v148, v149
v_mfma_f32_16x16x32_bf16 a[112:115], a[180:183], v[196:199], a[112:115]
ds_read_b128 a[156:159], v2 offset:3072
v_cvt_pk_bf16_f32 v215, v150, v151
v_mfma_f32_16x16x32_bf16 a[112:115], a[176:179], v[192:195], a[112:115]
v_exp_f32 v103, v103
v_mfma_f32_16x16x32_bf16 a[116:119], a[184:187], v[192:195], a[116:119]
ds_read_b128 a[160:163], v2 offset:4096
v_cvt_pk_bf16_f32 v206, v132, v133
v_mfma_f32_16x16x32_bf16 a[116:119], a[188:191], v[196:199], a[116:119]
ds_read_b128 a[164:167], v2 offset:5120
v_cvt_pk_bf16_f32 v207, v134, v135
v_mfma_f32_16x16x32_bf16 a[84:87], a[188:191], v[188:191], a[84:87]
ds_read_b128 a[168:171], v2 offset:6144
v_xor_b32 v3, 0x8000, v3
v_mfma_f32_16x16x32_bf16 a[84:87], a[184:187], v[184:187], a[84:87]
ds_read_b128 a[172:175], v2 offset:7168
v_cvt_pk_bf16_f32 v182, v116, v117
v_mfma_f32_16x16x32_bf16 a[52:55], a[184:187], v[160:163], a[52:55]
v_cvt_pk_bf16_f32 v183, v118, v119
v_cvt_pk_bf16_f32 v174, v100, v101
v_mfma_f32_16x16x32_bf16 a[52:55], a[188:191], v[164:167], a[52:55]
v_cvt_pk_bf16_f32 v175, v102, v103
v_mfma_f32_16x16x32_bf16 a[20:23], a[188:191], v[156:159], a[20:23]
v_mfma_f32_16x16x32_bf16 a[20:23], a[184:187], v[152:155], a[20:23]
v_mfma_f32_16x16x32_bf16 a[24:27], a[192:195], v[152:155], a[24:27]
buffer_load_dwordx4 v16, s[32:35], s70 offen offset:1024 sc1 lds
v_mfma_f32_16x16x32_bf16 a[24:27], a[196:199], v[156:159], a[24:27]
v_mfma_f32_16x16x32_bf16 a[56:59], a[196:199], v[164:167], a[56:59]
v_mfma_f32_16x16x32_bf16 a[56:59], a[192:195], v[160:163], a[56:59]
v_mfma_f32_16x16x32_bf16 a[88:91], a[192:195], v[184:187], a[88:91]
v_mfma_f32_16x16x32_bf16 a[88:91], a[196:199], v[188:191], a[88:91]
v_mfma_f32_16x16x32_bf16 a[120:123], a[196:199], v[196:199], a[120:123]
s_sub_u32 s72, s72, 1
v_mfma_f32_16x16x32_bf16 a[120:123], a[192:195], v[192:195], a[120:123]
v_mfma_f32_16x16x32_bf16 a[124:127], a[200:203], v[192:195], a[124:127]
s_waitcnt lgkmcnt(0)
v_mfma_f32_16x16x32_bf16 a[124:127], a[204:207], v[196:199], a[124:127]
v_mfma_f32_16x16x32_bf16 a[92:95], a[204:207], v[188:191], a[92:95]
s_cmp_lg_u32 s72, 0
v_mfma_f32_16x16x32_bf16 a[92:95], a[200:203], v[184:187], a[92:95]
v_mfma_f32_16x16x32_bf16 a[60:63], a[200:203], v[160:163], a[60:63]
v_mfma_f32_16x16x32_bf16 a[60:63], a[204:207], v[164:167], a[60:63]
v_mfma_f32_16x16x32_bf16 a[28:31], a[204:207], v[156:159], a[28:31]
v_mfma_f32_16x16x32_bf16 a[28:31], a[200:203], v[152:155], a[28:31]
s_cbranch_scc1 L_D
L_DD:
s_waitcnt lgkmcnt(7)
v_mfma_f32_16x16x32_bf16 v[104:107], a[144:147], v[40:43], v[220:223]
s_waitcnt lgkmcnt(6)
ds_read_b128 a[176:179], v2 offset:8192
v_cndmask_b32 v88, v216, v17, s[0:1]
v_mfma_f32_16x16x32_bf16 v[104:107], a[148:151], v[44:47], v[104:107]
s_waitcnt lgkmcnt(6)
ds_read_b128 a[180:183], v2 offset:9216
v_cndmask_b32 v89, v216, v17, s[4:5]
v_mfma_f32_16x16x32_bf16 v[104:107], a[152:155], v[48:51], v[104:107]
s_waitcnt lgkmcnt(6)
buffer_load_dwordx4 v16, s[32:35], s70 offen offset:2048 sc1 lds
v_mfma_f32_16x16x32_bf16 v[104:107], a[156:159], v[52:55], v[104:107]
ds_read_b128 a[184:187], v2 offset:10240
v_cndmask_b32 v90, v216, v17, s[6:7]
v_mfma_f32_16x16x32_bf16 v[120:123], a[156:159], v[68:71], v[224:227]
ds_read_b128 a[188:191], v2 offset:11264
v_cndmask_b32 v91, v216, v17, s[8:9]
v_mfma_f32_16x16x32_bf16 v[120:123], a[152:155], v[64:67], v[120:123]
ds_read_b128 a[192:195], v2 offset:12288
v_cndmask_b32 v92, v216, v17, s[10:11]
v_mfma_f32_16x16x32_bf16 v[120:123], a[148:151], v[60:63], v[120:123]
ds_read_b128 a[196:199], v2 offset:13312
v_cndmask_b32 v93, v216, v17, s[12:13]
v_mfma_f32_16x16x32_bf16 v[120:123], a[144:147], v[56:59], v[120:123]
ds_read_b128 a[200:203], v2 offset:14336
v_cndmask_b32 v94, v216, v17, s[18:19]
v_mfma_f32_16x16x32_bf16 v[136:139], a[144:147], v[72:75], v[228:231]
ds_read_b128 a[204:207], v2 offset:15360
v_cndmask_b32 v95, v216, v17, s[22:23]
v_mfma_f32_16x16x32_bf16 v[136:139], a[148:151], v[76:79], v[136:139]
v_cndmask_b32 v96, v216, v17, s[26:27]
v_cndmask_b32 v97, v216, v17, s[56:57]
v_mfma_f32_16x16x32_bf16 v[136:139], a[152:155], v[80:83], v[136:139]
v_exp_f32 v104, v104
v_mfma_f32_16x16x32_bf16 v[136:139], a[156:159], v[84:87], v[136:139]
v_exp_f32 v105, v105
v_mfma_f32_16x16x32_bf16 v[88:91], a[156:159], v[36:39], v[88:91]
v_exp_f32 v106, v106
v_mfma_f32_16x16x32_bf16 v[88:91], a[152:155], v[32:35], v[88:91]
v_exp_f32 v107, v107
v_mfma_f32_16x16x32_bf16 v[88:91], a[148:151], v[28:31], v[88:91]
v_exp_f32 v120, v120
v_mfma_f32_16x16x32_bf16 v[88:91], a[144:147], v[24:27], v[88:91]
s_waitcnt lgkmcnt(0)
v_exp_f32 v121, v121
v_mfma_f32_16x16x32_bf16 v[140:143], a[160:163], v[72:75], v[228:231]
v_exp_f32 v122, v122
v_mfma_f32_16x16x32_bf16 v[140:143], a[164:167], v[76:79], v[140:143]
buffer_load_dwordx4 v16, s[32:35], s70 offen offset:3072 sc1 lds
v_mfma_f32_16x16x32_bf16 v[140:143], a[168:171], v[80:83], v[140:143]
s_add_u32 m0, s86, 131072
v_exp_f32 v123, v123
v_mfma_f32_16x16x32_bf16 v[140:143], a[172:175], v[84:87], v[140:143]
s_add_u32 s64, s85, 0
v_cvt_pk_bf16_f32 v160, v104, v105
v_cvt_pk_bf16_f32 v161, v106, v107
v_mfma_f32_16x16x32_bf16 v[124:127], a[172:175], v[68:71], v[224:227]
buffer_load_dwordx4 v12, s[36:39], s64 offen lds
v_mfma_f32_16x16x32_bf16 v[124:127], a[168:171], v[64:67], v[124:127]
s_add_u32 m0, s86, 132096
v_exp_f32 v136, v136
v_mfma_f32_16x16x32_bf16 v[124:127], a[164:167], v[60:63], v[124:127]
s_add_u32 s64, s85, 8192
v_exp_f32 v137, v137
v_mfma_f32_16x16x32_bf16 v[124:127], a[160:163], v[56:59], v[124:127]
buffer_load_dwordx4 v13, s[36:39], s64 offen lds
v_mfma_f32_16x16x32_bf16 v[108:111], a[160:163], v[40:43], v[220:223]
v_exp_f32 v138, v138
v_mfma_f32_16x16x32_bf16 v[108:111], a[164:167], v[44:47], v[108:111]
ds_read_b128 a[144:147], v3 offset:0
v_cndmask_b32 v98, v216, v17, s[58:59]
v_mfma_f32_16x16x32_bf16 v[108:111], a[168:171], v[48:51], v[108:111]
s_add_u32 m0, s86, 133120
ds_read_b128 a[148:151], v3 offset:8192
v_cndmask_b32 v99, v216, v17, s[60:61]
v_mfma_f32_16x16x32_bf16 v[108:111], a[172:175], v[52:55], v[108:111]
s_add_u32 s64, s85, 16384
v_cvt_pk_bf16_f32 v184, v120, v121
v_cvt_pk_bf16_f32 v185, v122, v123
v_mfma_f32_16x16x32_bf16 v[92:95], a[172:175], v[36:39], v[92:95]
buffer_load_dwordx4 v12, s[36:39], s64 offen lds
v_mfma_f32_16x16x32_bf16 v[92:95], a[168:171], v[32:35], v[92:95]
s_add_u32 m0, s86, 134144
v_exp_f32 v139, v139
v_mfma_f32_16x16x32_bf16 v[92:95], a[164:167], v[28:31], v[92:95]
s_add_u32 s64, s85, 24576
v_exp_f32 v88, v88
v_mfma_f32_16x16x32_bf16 v[92:95], a[160:163], v[24:27], v[92:95]
buffer_load_dwordx4 v13, s[36:39], s64 offen lds
v_mfma_f32_16x16x32_bf16 v[96:99], a[176:179], v[24:27], v[96:99]
s_add_u32 m0, s71, 4096
v_exp_f32 v89, v89
v_mfma_f32_16x16x32_bf16 v[96:99], a[180:183], v[28:31], v[96:99]
s_add_u32 s64, s70, 4096
v_exp_f32 v90, v90
v_mfma_f32_16x16x32_bf16 v[96:99], a[184:187], v[32:35], v[96:99]
buffer_load_dwordx4 v16, s[32:35], s64 offen offset:0 sc1 lds
v_mfma_f32_16x16x32_bf16 v[96:99], a[188:191], v[36:39], v[96:99]
v_cvt_pk_bf16_f32 v192, v136, v137
v_cvt_pk_bf16_f32 v193, v138, v139
v_mfma_f32_16x16x32_bf16 v[112:115], a[188:191], v[52:55], v[220:223]
v_exp_f32 v91, v91
v_mfma_f32_16x16x32_bf16 v[112:115], a[184:187], v[48:51], v[112:115]
v_exp_f32 v140, v140
v_mfma_f32_16x16x32_bf16 v[112:115], a[180:183], v[44:47], v[112:115]
v_exp_f32 v141, v141
v_mfma_f32_16x16x32_bf16 v[112:115], a[176:179], v[40:43], v[112:115]
v_exp_f32 v142, v142
v_mfma_f32_16x16x32_bf16 v[128:131], a[176:179], v[56:59], v[224:227]
v_exp_f32 v143, v143
v_mfma_f32_16x16x32_bf16 v[128:131], a[180:183], v[60:63], v[128:131]
v_exp_f32 v124, v124
v_mfma_f32_16x16x32_bf16 v[128:131], a[184:187], v[64:67], v[128:131]
v_cvt_pk_bf16_f32 v152, v88, v89
v_cvt_pk_bf16_f32 v153, v90, v91
v_mfma_f32_16x16x32_bf16 v[128:131], a[188:191], v[68:71], v[128:131]
v_exp_f32 v125, v125
v_mfma_f32_16x16x32_bf16 v[144:147], a[188:191], v[84:87], v[228:231]
v_exp_f32 v126, v126
v_mfma_f32_16x16x32_bf16 v[144:147], a[184:187], v[80:83], v[144:147]
v_exp_f32 v127, v127
v_mfma_f32_16x16x32_bf16 v[144:147], a[180:183], v[76:79], v[144:147]
v_exp_f32 v108, v108
v_mfma_f32_16x16x32_bf16 v[144:147], a[176:179], v[72:75], v[144:147]
ds_read_b128 a[152:155], v3 offset:1024
v_cndmask_b32 v100, v216, v17, s[62:63]
v_mfma_f32_16x16x32_bf16 v[148:151], a[192:195], v[72:75], v[228:231]
buffer_load_dwordx4 v16, s[32:35], s64 offen offset:1024 sc1 lds
v_mfma_f32_16x16x32_bf16 v[148:151], a[196:199], v[76:79], v[148:151]
ds_read_b128 a[156:159], v3 offset:9216
v_cndmask_b32 v101, v216, v17, s[48:49]
v_mfma_f32_16x16x32_bf16 v[148:151], a[200:203], v[80:83], v[148:151]
v_cvt_pk_bf16_f32 v194, v140, v141
v_cvt_pk_bf16_f32 v195, v142, v143
v_mfma_f32_16x16x32_bf16 v[148:151], a[204:207], v[84:87], v[148:151]
ds_read_b128 a[160:163], v3 offset:2048
v_cndmask_b32 v102, v216, v17, s[50:51]
v_mfma_f32_16x16x32_bf16 v[132:135], a[204:207], v[68:71], v[224:227]
ds_read_b128 a[164:167], v3 offset:10240
v_cndmask_b32 v103, v216, v17, s[100:101]
v_mfma_f32_16x16x32_bf16 v[132:135], a[200:203], v[64:67], v[132:135]
v_exp_f32 v109, v109
v_mfma_f32_16x16x32_bf16 v[132:135], a[196:199], v[60:63], v[132:135]
v_exp_f32 v110, v110
v_mfma_f32_16x16x32_bf16 v[132:135], a[192:195], v[56:59], v[132:135]
v_exp_f32 v111, v111
v_mfma_f32_16x16x32_bf16 v[116:119], a[192:195], v[40:43], v[220:223]
v_exp_f32 v92, v92
v_mfma_f32_16x16x32_bf16 v[116:119], a[196:199], v[44:47], v[116:119]
v_cvt_pk_bf16_f32 v186, v124, v125
v_cvt_pk_bf16_f32 v187, v126, v127
v_mfma_f32_16x16x32_bf16 v[116:119], a[200:203], v[48:51], v[116:119]
v_exp_f32 v93, v93
v_mfma_f32_16x16x32_bf16 v[116:119], a[204:207], v[52:55], v[116:119]
v_exp_f32 v94, v94
v_mfma_f32_16x16x32_bf16 v[100:103], a[204:207], v[36:39], v[100:103]
v_exp_f32 v95, v95
v_mfma_f32_16x16x32_bf16 v[100:103], a[200:203], v[32:35], v[100:103]
v_exp_f32 v96, v96
v_mfma_f32_16x16x32_bf16 v[100:103], a[196:199], v[28:31], v[100:103]
v_exp_f32 v97, v97
v_mfma_f32_16x16x32_bf16 v[100:103], a[192:195], v[24:27], v[100:103]
v_exp_f32 v98, v98
v_smfmac_f32_16x16x64_bf16 a[128:131], a[240:243], v[168:175], v5
ds_read_b128 a[168:171], v3 offset:3072
v_smfmac_f32_16x16x64_bf16 a[132:135], a[240:243], v[176:183], v5
v_cvt_pk_bf16_f32 v162, v108, v109
v_smfmac_f32_16x16x64_bf16 a[136:139], a[240:243], v[200:207], v5
ds_read_b128 a[172:175], v3 offset:11264
v_smfmac_f32_16x16x64_bf16 a[140:143], a[240:243], v[208:215], v5
s_waitcnt lgkmcnt(2)
buffer_load_dwordx4 v16, s[32:35], s64 offen offset:2048 sc1 lds
v_mfma_f32_16x16x32_bf16 a[0:3], a[144:147], v[168:171], a[0:3]
v_exp_f32 v99, v99
v_mfma_f32_16x16x32_bf16 a[0:3], a[148:151], v[172:175], a[0:3]
v_cvt_pk_bf16_f32 v163, v110, v111
v_cvt_pk_bf16_f32 v154, v92, v93
v_mfma_f32_16x16x32_bf16 a[32:35], a[148:151], v[180:183], a[32:35]
v_exp_f32 v112, v112
v_mfma_f32_16x16x32_bf16 a[32:35], a[144:147], v[176:179], a[32:35]
v_exp_f32 v113, v113
v_mfma_f32_16x16x32_bf16 a[64:67], a[144:147], v[200:203], a[64:67]
v_exp_f32 v114, v114
v_mfma_f32_16x16x32_bf16 a[64:67], a[148:151], v[204:207], a[64:67]
v_exp_f32 v115, v115
v_mfma_f32_16x16x32_bf16 a[96:99], a[148:151], v[212:215], a[96:99]
v_exp_f32 v128, v128
v_mfma_f32_16x16x32_bf16 a[96:99], a[144:147], v[208:211], a[96:99]
v_exp_f32 v129, v129
v_mfma_f32_16x16x32_bf16 a[100:103], a[152:155], v[208:211], a[100:103]
v_exp_f32 v130, v130
v_mfma_f32_16x16x32_bf16 a[100:103], a[156:159], v[212:215], a[100:103]
v_cvt_pk_bf16_f32 v155, v94, v95
v_cvt_pk_bf16_f32 v156, v96, v97
v_mfma_f32_16x16x32_bf16 a[68:71], a[156:159], v[204:207], a[68:71]
v_exp_f32 v131, v131
v_mfma_f32_16x16x32_bf16 a[68:71], a[152:155], v[200:203], a[68:71]
buffer_load_dwordx4 v16, s[32:35], s64 offen offset:3072 sc1 lds
v_mfma_f32_16x16x32_bf16 a[36:39], a[152:155], v[176:179], a[36:39]
s_add_u32 m0, s86, 135168
ds_read_b128 a[176:179], v3 offset:4096
v_cvt_pk_bf16_f32 v157, v98, v99
v_mfma_f32_16x16x32_bf16 a[36:39], a[156:159], v[180:183], a[36:39]
s_add_u32 s64, s85, 32768
v_exp_f32 v144, v144
v_mfma_f32_16x16x32_bf16 a[4:7], a[156:159], v[172:175], a[4:7]
buffer_load_dwordx4 v12, s[36:39], s64 offen lds
v_mfma_f32_16x16x32_bf16 a[4:7], a[152:155], v[168:171], a[4:7]
s_add_u32 m0, s86, 136192
ds_read_b128 a[180:183], v3 offset:12288
v_cvt_pk_bf16_f32 v164, v112, v113
v_mfma_f32_16x16x32_bf16 a[8:11], a[160:163], v[168:171], a[8:11]
s_add_u32 s64, s85, 40960
v_exp_f32 v145, v145
v_mfma_f32_16x16x32_bf16 a[8:11], a[164:167], v[172:175], a[8:11]
buffer_load_dwordx4 v13, s[36:39], s64 offen lds
v_mfma_f32_16x16x32_bf16 a[40:43], a[164:167], v[180:183], a[40:43]
ds_read_b128 a[184:187], v3 offset:5120
v_cvt_pk_bf16_f32 v165, v114, v115
v_mfma_f32_16x16x32_bf16 a[40:43], a[160:163], v[176:179], a[40:43]
ds_read_b128 a[188:191], v3 offset:13312
v_cvt_pk_bf16_f32 v188, v128, v129
v_mfma_f32_16x16x32_bf16 a[72:75], a[160:163], v[200:203], a[72:75]
ds_read_b128 a[192:195], v3 offset:6144
v_cvt_pk_bf16_f32 v189, v130, v131
v_mfma_f32_16x16x32_bf16 a[72:75], a[164:167], v[204:207], a[72:75]
ds_read_b128 a[196:199], v3 offset:14336
v_cvt_pk_bf16_f32 v196, v144, v145
v_mfma_f32_16x16x32_bf16 a[104:107], a[164:167], v[212:215], a[104:107]
ds_read_b128 a[200:203], v3 offset:7168
v_mfma_f32_16x16x32_bf16 a[104:107], a[160:163], v[208:211], a[104:107]
s_waitcnt lgkmcnt(5)
s_add_u32 m0, s86, 137216
ds_read_b128 a[204:207], v3 offset:15360
v_mfma_f32_16x16x32_bf16 a[108:111], a[168:171], v[208:211], a[108:111]
s_add_u32 s64, s85, 49152
v_exp_f32 v146, v146
v_mfma_f32_16x16x32_bf16 a[108:111], a[172:175], v[212:215], a[108:111]
buffer_load_dwordx4 v12, s[36:39], s64 offen lds
v_mfma_f32_16x16x32_bf16 a[76:79], a[172:175], v[204:207], a[76:79]
s_add_u32 m0, s86, 138240
v_exp_f32 v147, v147
v_mfma_f32_16x16x32_bf16 a[76:79], a[168:171], v[200:203], a[76:79]
s_add_u32 s64, s85, 57344
v_exp_f32 v148, v148
v_mfma_f32_16x16x32_bf16 a[44:47], a[168:171], v[176:179], a[44:47]
buffer_load_dwordx4 v13, s[36:39], s64 offen lds
v_mfma_f32_16x16x32_bf16 a[44:47], a[172:175], v[180:183], a[44:47]
s_waitcnt vmcnt(16)
s_barrier
v_mfma_f32_16x16x32_bf16 a[12:15], a[172:175], v[172:175], a[12:15]
s_xor_b32 s71, s71, 16384
v_exp_f32 v149, v149
v_mfma_f32_16x16x32_bf16 a[12:15], a[168:171], v[168:171], a[12:15]
s_add_u32 s70, s70, 32768
v_exp_f32 v150, v150
v_mfma_f32_16x16x32_bf16 a[16:19], a[176:179], v[168:171], a[16:19]
s_mov_b32 m0, s71
v_exp_f32 v151, v151
v_mfma_f32_16x16x32_bf16 a[16:19], a[180:183], v[172:175], a[16:19]
buffer_load_dwordx4 v16, s[32:35], s70 offen offset:0 sc1 lds
v_mfma_f32_16x16x32_bf16 a[48:51], a[180:183], v[180:183], a[48:51]
v_exp_f32 v132, v132
v_mfma_f32_16x16x32_bf16 a[48:51], a[176:179], v[176:179], a[48:51]
v_exp_f32 v133, v133
v_mfma_f32_16x16x32_bf16 a[80:83], a[176:179], v[200:203], a[80:83]
v_exp_f32 v134, v134
v_mfma_f32_16x16x32_bf16 a[80:83], a[180:183], v[204:207], a[80:83]
v_exp_f32 v135, v135
v_mfma_f32_16x16x32_bf16 a[112:115], a[180:183], v[212:215], a[112:115]
v_exp_f32 v116, v116
v_mfma_f32_16x16x32_bf16 a[112:115], a[176:179], v[208:211], a[112:115]
s_waitcnt lgkmcnt(0)
v_cvt_pk_bf16_f32 v197, v146, v147
v_cvt_pk_bf16_f32 v198, v148, v149
v_mfma_f32_16x16x32_bf16 a[116:119], a[184:187], v[208:211], a[116:119]
v_exp_f32 v117, v117
v_mfma_f32_16x16x32_bf16 a[116:119], a[188:191], v[212:215], a[116:119]
v_exp_f32 v118, v118
v_mfma_f32_16x16x32_bf16 a[84:87], a[188:191], v[204:207], a[84:87]
v_exp_f32 v119, v119
v_mfma_f32_16x16x32_bf16 a[84:87], a[184:187], v[200:203], a[84:87]
v_exp_f32 v100, v100
v_mfma_f32_16x16x32_bf16 a[52:55], a[184:187], v[176:179], a[52:55]
v_exp_f32 v101, v101
v_mfma_f32_16x16x32_bf16 a[52:55], a[188:191], v[180:183], a[52:55]
ds_read_b128 a[144:147], v2 offset:16384
v_cvt_pk_bf16_f32 v199, v150, v151
v_mfma_f32_16x16x32_bf16 a[20:23], a[188:191], v[172:175], a[20:23]
ds_read_b128 a[148:151], v2 offset:17408
v_cvt_pk_bf16_f32 v190, v132, v133
v_mfma_f32_16x16x32_bf16 a[20:23], a[184:187], v[168:171], a[20:23]
v_exp_f32 v102, v102
v_mfma_f32_16x16x32_bf16 a[24:27], a[192:195], v[168:171], a[24:27]
buffer_load_dwordx4 v16, s[32:35], s70 offen offset:1024 sc1 lds
v_mfma_f32_16x16x32_bf16 a[24:27], a[196:199], v[172:175], a[24:27]
ds_read_b128 a[152:155], v2 offset:18432
v_cvt_pk_bf16_f32 v191, v134, v135
v_mfma_f32_16x16x32_bf16 a[56:59], a[196:199], v[180:183], a[56:59]
ds_read_b128 a[156:159], v2 offset:19456
v_cvt_pk_bf16_f32 v166, v116, v117
v_mfma_f32_16x16x32_bf16 a[56:59], a[192:195], v[176:179], a[56:59]
v_exp_f32 v103, v103
v_mfma_f32_16x16x32_bf16 a[88:91], a[192:195], v[200:203], a[88:91]
ds_read_b128 a[160:163], v2 offset:20480
v_cvt_pk_bf16_f32 v167, v118, v119
v_mfma_f32_16x16x32_bf16 a[88:91], a[196:199], v[204:207], a[88:91]
ds_read_b128 a[164:167], v2 offset:21504
v_cvt_pk_bf16_f32 v158, v100, v101
v_mfma_f32_16x16x32_bf16 a[120:123], a[196:199], v[212:215], a[120:123]
ds_read_b128 a[168:171], v2 offset:22528
v_cvt_pk_bf16_f32 v159, v102, v103
v_mfma_f32_16x16x32_bf16 a[120:123], a[192:195], v[208:211], a[120:123]
ds_read_b128 a[172:175], v2 offset:23552
v_cndmask_b32 v104, v220, v17, s[0:1]
v_mfma_f32_16x16x32_bf16 a[124:127], a[200:203], v[208:211], a[124:127]
v_cndmask_b32 v105, v220, v17, s[4:5]
v_cndmask_b32 v106, v220, v17, s[6:7]
v_mfma_f32_16x16x32_bf16 a[124:127], a[204:207], v[212:215], a[124:127]
v_cndmask_b32 v107, v220, v17, s[8:9]
v_cndmask_b32 v108, v220, v17, s[10:11]
v_mfma_f32_16x16x32_bf16 a[92:95], a[204:207], v[204:207], a[92:95]
v_cndmask_b32 v109, v220, v17, s[12:13]
v_cndmask_b32 v110, v220, v17, s[18:19]
v_mfma_f32_16x16x32_bf16 a[92:95], a[200:203], v[200:203], a[92:95]
v_cndmask_b32 v111, v220, v17, s[22:23]
v_cndmask_b32 v112, v220, v17, s[26:27]
v_mfma_f32_16x16x32_bf16 a[60:63], a[200:203], v[176:179], a[60:63]
v_cndmask_b32 v113, v220, v17, s[56:57]
v_cndmask_b32 v114, v220, v17, s[58:59]
v_mfma_f32_16x16x32_bf16 a[60:63], a[204:207], v[180:183], a[60:63]
v_cndmask_b32 v115, v220, v17, s[60:61]
v_cndmask_b32 v116, v220, v17, s[62:63]
v_mfma_f32_16x16x32_bf16 a[28:31], a[204:207], v[172:175], a[28:31]
v_cndmask_b32 v117, v220, v17, s[48:49]
v_cndmask_b32 v118, v220, v17, s[50:51]
v_mfma_f32_16x16x32_bf16 a[28:31], a[200:203], v[168:171], a[28:31]
s_waitcnt lgkmcnt(0)
v_cndmask_b32 v119, v220, v17, s[100:101]
v_mfma_f32_16x16x32_bf16 v[120:123], a[144:147], v[56:59], v[224:227]
ds_read_b128 a[176:179], v2 offset:24576
v_mfma_f32_16x16x32_bf16 v[120:123], a[148:151], v[60:63], v[120:123]
ds_read_b128 a[180:183], v2 offset:25600
v_mfma_f32_16x16x32_bf16 v[120:123], a[152:155], v[64:67], v[120:123]
buffer_load_dwordx4 v16, s[32:35], s70 offen offset:2048 sc1 lds
v_mfma_f32_16x16x32_bf16 v[120:123], a[156:159], v[68:71], v[120:123]
ds_read_b128 a[184:187], v2 offset:26624
v_mfma_f32_16x16x32_bf16 v[136:139], a[156:159], v[84:87], v[228:231]
ds_read_b128 a[188:191], v2 offset:27648
v_mfma_f32_16x16x32_bf16 v[136:139], a[152:155], v[80:83], v[136:139]
v_mfma_f32_16x16x32_bf16 v[136:139], a[148:151], v[76:79], v[136:139]
v_mfma_f32_16x16x32_bf16 v[136:139], a[144:147], v[72:75], v[136:139]
v_mfma_f32_16x16x32_bf16 v[104:107], a[144:147], v[40:43], v[104:107]
ds_read_b128 a[192:195], v2 offset:28672
v_mfma_f32_16x16x32_bf16 v[104:107], a[148:151], v[44:47], v[104:107]
v_mfma_f32_16x16x32_bf16 v[104:107], a[152:155], v[48:51], v[104:107]
v_exp_f32 v120, v120
v_mfma_f32_16x16x32_bf16 v[104:107], a[156:159], v[52:55], v[104:107]
v_exp_f32 v121, v121
v_mfma_f32_16x16x32_bf16 v[140:143], a[172:175], v[84:87], v[228:231]
v_exp_f32 v122, v122
v_mfma_f32_16x16x32_bf16 v[140:143], a[168:171], v[80:83], v[140:143]
v_exp_f32 v123, v123
v_mfma_f32_16x16x32_bf16 v[140:143], a[164:167], v[76:79], v[140:143]
v_exp_f32 v136, v136
v_mfma_f32_16x16x32_bf16 v[140:143], a[160:163], v[72:75], v[140:143]
buffer_load_dwordx4 v16, s[32:35], s70 offen offset:3072 sc1 lds
v_mfma_f32_16x16x32_bf16 v[124:127], a[160:163], v[56:59], v[224:227]
v_exp_f32 v137, v137
v_mfma_f32_16x16x32_bf16 v[124:127], a[164:167], v[60:63], v[124:127]
v_exp_f32 v138, v138
v_mfma_f32_16x16x32_bf16 v[124:127], a[168:171], v[64:67], v[124:127]
v_exp_f32 v139, v139
v_mfma_f32_16x16x32_bf16 v[124:127], a[172:175], v[68:71], v[124:127]
v_exp_f32 v104, v104
v_mfma_f32_16x16x32_bf16 v[108:111], a[172:175], v[52:55], v[108:111]
v_cvt_pk_bf16_f32 v200, v120, v121
v_cvt_pk_bf16_f32 v201, v122, v123
v_mfma_f32_16x16x32_bf16 v[108:111], a[168:171], v[48:51], v[108:111]
ds_read_b128 a[196:199], v2 offset:29696
v_cvt_pk_bf16_f32 v208, v136, v137
v_mfma_f32_16x16x32_bf16 v[108:111], a[164:167], v[44:47], v[108:111]
ds_read_b128 a[200:203], v2 offset:30720
v_cvt_pk_bf16_f32 v209, v138, v139
v_mfma_f32_16x16x32_bf16 v[108:111], a[160:163], v[40:43], v[108:111]
s_branch L_po17
L_pg17:
s_branch L_pg23
L_po17:
s_waitcnt lgkmcnt(2)
ds_read_b128 a[204:207], v2 offset:31744
v_mfma_f32_16x16x32_bf16 v[112:115], a[176:179], v[40:43], v[112:115]
v_exp_f32 v105, v105
v_mfma_f32_16x16x32_bf16 v[112:115], a[180:183], v[44:47], v[112:115]
v_exp_f32 v106, v106
v_mfma_f32_16x16x32_bf16 v[112:115], a[184:187], v[48:51], v[112:115]
v_exp_f32 v107, v107
v_mfma_f32_16x16x32_bf16 v[112:115], a[188:191], v[52:55], v[112:115]
s_add_u32 m0, s71, 4096
v_exp_f32 v140, v140
v_mfma_f32_16x16x32_bf16 v[128:131], a[188:191], v[68:71], v[224:227]
s_add_u32 s64, s70, 4096
v_exp_f32 v141, v141
v_mfma_f32_16x16x32_bf16 v[128:131], a[184:187], v[64:67], v[128:131]
buffer_load_dwordx4 v16, s[32:35], s64 offen offset:0 sc1 lds
v_mfma_f32_16x16x32_bf16 v[128:131], a[180:183], v[60:63], v[128:131]
v_exp_f32 v142, v142
v_mfma_f32_16x16x32_bf16 v[128:131], a[176:179], v[56:59], v[128:131]
v_exp_f32 v143, v143
v_mfma_f32_16x16x32_bf16 v[144:147], a[176:179], v[72:75], v[228:231]
ds_read_b128 a[144:147], v3 offset:16384
v_cvt_pk_bf16_f32 v176, v104, v105
v_mfma_f32_16x16x32_bf16 v[144:147], a[180:183], v[76:79], v[144:147]
ds_read_b128 a[148:151], v3 offset:24576
v_cvt_pk_bf16_f32 v177, v106, v107
v_mfma_f32_16x16x32_bf16 v[144:147], a[184:187], v[80:83], v[144:147]
v_exp_f32 v124, v124
v_mfma_f32_16x16x32_bf16 v[144:147], a[188:191], v[84:87], v[144:147]
s_waitcnt lgkmcnt(2)
v_exp_f32 v125, v125
v_mfma_f32_16x16x32_bf16 v[148:151], a[204:207], v[84:87], v[228:231]
v_exp_f32 v126, v126
v_mfma_f32_16x16x32_bf16 v[148:151], a[200:203], v[80:83], v[148:151]
v_exp_f32 v127, v127
v_mfma_f32_16x16x32_bf16 v[148:151], a[196:199], v[76:79], v[148:151]
ds_read_b128 a[152:155], v3 offset:17408
v_cvt_pk_bf16_f32 v210, v140, v141
v_mfma_f32_16x16x32_bf16 v[148:151], a[192:195], v[72:75], v[148:151]
ds_read_b128 a[156:159], v3 offset:25600
v_cvt_pk_bf16_f32 v211, v142, v143
v_mfma_f32_16x16x32_bf16 v[132:135], a[192:195], v[56:59], v[224:227]
v_exp_f32 v108, v108
v_mfma_f32_16x16x32_bf16 v[132:135], a[196:199], v[60:63], v[132:135]
v_exp_f32 v109, v109
v_mfma_f32_16x16x32_bf16 v[132:135], a[200:203], v[64:67], v[132:135]
buffer_load_dwordx4 v16, s[32:35], s64 offen offset:1024 sc1 lds
v_mfma_f32_16x16x32_bf16 v[132:135], a[204:207], v[68:71], v[132:135]
v_exp_f32 v110, v110
v_mfma_f32_16x16x32_bf16 v[116:119], a[204:207], v[52:55], v[116:119]
ds_read_b128 a[160:163], v3 offset:18432
v_cvt_pk_bf16_f32 v202, v124, v125
v_mfma_f32_16x16x32_bf16 v[116:119], a[200:203], v[48:51], v[116:119]
v_exp_f32 v111, v111
v_mfma_f32_16x16x32_bf16 v[116:119], a[196:199], v[44:47], v[116:119]
ds_read_b128 a[164:167], v3 offset:26624
v_cvt_pk_bf16_f32 v203, v126, v127
v_mfma_f32_16x16x32_bf16 v[116:119], a[192:195], v[40:43], v[116:119]
v_exp_f32 v112, v112
v_smfmac_f32_16x16x64_bf16 a[128:131], a[240:243], v[152:159], v5
ds_read_b128 a[168:171], v3 offset:19456
v_smfmac_f32_16x16x64_bf16 a[132:135], a[240:243], v[160:167], v5
ds_read_b128 a[172:175], v3 offset:27648
v_smfmac_f32_16x16x64_bf16 a[136:139], a[240:243], v[184:191], v5
ds_read_b128 a[176:179], v3 offset:20480
v_smfmac_f32_16x16x64_bf16 a[140:143], a[240:243], v[192:199], v5
s_waitcnt lgkmcnt(4)
ds_read_b128 a[180:183], v3 offset:28672
v_xor_b32 v2, 0x8000, v2
v_mfma_f32_16x16x32_bf16 a[0:3], a[144:147], v[152:155], a[0:3]
v_exp_f32 v113, v113
v_mfma_f32_16x16x32_bf16 a[0:3], a[148:151], v[156:159], a[0:3]
v_exp_f32 v114, v114
v_mfma_f32_16x16x32_bf16 a[32:35], a[148:151], v[164:167], a[32:35]
v_exp_f32 v115, v115
v_mfma_f32_16x16x32_bf16 a[32:35], a[144:147], v[160:163], a[32:35]
v_exp_f32 v128, v128
v_mfma_f32_16x16x32_bf16 a[64:67], a[144:147], v[184:187], a[64:67]
buffer_load_dwordx4 v16, s[32:35], s64 offen offset:2048 sc1 lds
v_mfma_f32_16x16x32_bf16 a[64:67], a[148:151], v[188:191], a[64:67]
v_exp_f32 v129, v129
v_mfma_f32_16x16x32_bf16 a[96:99], a[148:151], v[196:199], a[96:99]
v_exp_f32 v130, v130
v_mfma_f32_16x16x32_bf16 a[96:99], a[144:147], v[192:195], a[96:99]
v_exp_f32 v131, v131
v_mfma_f32_16x16x32_bf16 a[100:103], a[152:155], v[192:195], a[100:103]
v_exp_f32 v144, v144
v_mfma_f32_16x16x32_bf16 a[100:103], a[156:159], v[196:199], a[100:103]
v_exp_f32 v145, v145
v_mfma_f32_16x16x32_bf16 a[68:71], a[156:159], v[188:191], a[68:71]
ds_read_b128 a[184:187], v3 offset:21504
v_cvt_pk_bf16_f32 v178, v108, v109
v_mfma_f32_16x16x32_bf16 a[68:71], a[152:155], v[184:187], a[68:71]
ds_read_b128 a[188:191], v3 offset:29696
v_cvt_pk_bf16_f32 v179, v110, v111
v_mfma_f32_16x16x32_bf16 a[36:39], a[152:155], v[160:163], a[36:39]
ds_read_b128 a[192:195], v3 offset:22528
v_cvt_pk_bf16_f32 v180, v112, v113
v_mfma_f32_16x16x32_bf16 a[36:39], a[156:159], v[164:167], a[36:39]
v_exp_f32 v146, v146
v_mfma_f32_16x16x32_bf16 a[4:7], a[156:159], v[156:159], a[4:7]
v_exp_f32 v147, v147
v_mfma_f32_16x16x32_bf16 a[4:7], a[152:155], v[152:155], a[4:7]
v_exp_f32 v148, v148
v_mfma_f32_16x16x32_bf16 a[8:11], a[160:163], v[152:155], a[8:11]
s_waitcnt lgkmcnt(2)
ds_read_b128 a[196:199], v3 offset:30720
v_cvt_pk_bf16_f32 v181, v114, v115
v_mfma_f32_16x16x32_bf16 a[8:11], a[164:167], v[156:159], a[8:11]
buffer_load_dwordx4 v16, s[32:35], s64 offen offset:3072 sc1 lds
v_mfma_f32_16x16x32_bf16 a[40:43], a[164:167], v[164:167], a[40:43]
v_exp_f32 v149, v149
v_mfma_f32_16x16x32_bf16 a[40:43], a[160:163], v[160:163], a[40:43]
ds_read_b128 a[200:203], v3 offset:23552
v_cvt_pk_bf16_f32 v204, v128, v129
v_mfma_f32_16x16x32_bf16 a[72:75], a[160:163], v[184:187], a[72:75]
v_exp_f32 v150, v150
v_mfma_f32_16x16x32_bf16 a[72:75], a[164:167], v[188:191], a[72:75]
v_exp_f32 v151, v151
v_mfma_f32_16x16x32_bf16 a[104:107], a[164:167], v[196:199], a[104:107]
v_exp_f32 v132, v132
v_mfma_f32_16x16x32_bf16 a[104:107], a[160:163], v[192:195], a[104:107]
ds_read_b128 a[204:207], v3 offset:31744
v_cvt_pk_bf16_f32 v205, v130, v131
v_mfma_f32_16x16x32_bf16 a[108:111], a[168:171], v[192:195], a[108:111]
v_exp_f32 v133, v133
v_mfma_f32_16x16x32_bf16 a[108:111], a[172:175], v[196:199], a[108:111]
v_exp_f32 v134, v134
v_mfma_f32_16x16x32_bf16 a[76:79], a[172:175], v[188:191], a[76:79]
v_exp_f32 v135, v135
v_mfma_f32_16x16x32_bf16 a[76:79], a[168:171], v[184:187], a[76:79]
v_exp_f32 v116, v116
v_mfma_f32_16x16x32_bf16 a[44:47], a[168:171], v[160:163], a[44:47]
v_exp_f32 v117, v117
v_mfma_f32_16x16x32_bf16 a[44:47], a[172:175], v[164:167], a[44:47]
v_exp_f32 v118, v118
v_mfma_f32_16x16x32_bf16 a[12:15], a[172:175], v[156:159], a[12:15]
v_exp_f32 v119, v119
v_mfma_f32_16x16x32_bf16 a[12:15], a[168:171], v[152:155], a[12:15]
v_cvt_pk_bf16_f32 v212, v144, v145
v_cvt_pk_bf16_f32 v213, v146, v147
v_mfma_f32_16x16x32_bf16 a[16:19], a[176:179], v[152:155], a[16:19]
v_cvt_pk_bf16_f32 v214, v148, v149
v_cvt_pk_bf16_f32 v215, v150, v151
v_mfma_f32_16x16x32_bf16 a[16:19], a[180:183], v[156:159], a[16:19]
s_waitcnt vmcnt(12)
s_barrier
v_mfma_f32_16x16x32_bf16 a[48:51], a[180:183], v[164:167], a[48:51]
s_xor_b32 s71, s71, 49152
ds_read_b128 a[144:147], v2 offset:0
v_cvt_pk_bf16_f32 v206, v132, v133
v_mfma_f32_16x16x32_bf16 a[48:51], a[176:179], v[160:163], a[48:51]
s_add_u32 s70, s70, 32768
ds_read_b128 a[148:151], v2 offset:1024
v_cvt_pk_bf16_f32 v207, v134, v135
v_mfma_f32_16x16x32_bf16 a[80:83], a[176:179], v[184:187], a[80:83]
s_mov_b32 m0, s71
ds_read_b128 a[152:155], v2 offset:2048
v_cvt_pk_bf16_f32 v182, v116, v117
v_mfma_f32_16x16x32_bf16 a[80:83], a[180:183], v[188:191], a[80:83]
buffer_load_dwordx4 v16, s[32:35], s70 offen offset:0 sc1 lds
v_mfma_f32_16x16x32_bf16 a[112:115], a[180:183], v[196:199], a[112:115]
ds_read_b128 a[156:159], v2 offset:3072
v_cvt_pk_bf16_f32 v183, v118, v119
v_mfma_f32_16x16x32_bf16 a[112:115], a[176:179], v[192:195], a[112:115]
ds_read_b128 a[160:163], v2 offset:4096
v_xor_b32 v3, 0x8000, v3
v_mfma_f32_16x16x32_bf16 a[116:119], a[184:187], v[192:195], a[116:119]
s_waitcnt lgkmcnt(4)
ds_read_b128 a[164:167], v2 offset:5120
v_accvgpr_read_b32 v20, a128
v_mfma_f32_16x16x32_bf16 a[116:119], a[188:191], v[196:199], a[116:119]
ds_read_b128 a[168:171], v2 offset:6144
v_accvgpr_read_b32 v248, a129
v_mfma_f32_16x16x32_bf16 a[84:87], a[188:191], v[188:191], a[84:87]
ds_read_b128 a[172:175], v2 offset:7168
v_add_f32 v20, v20, v248
v_mfma_f32_16x16x32_bf16 a[84:87], a[184:187], v[184:187], a[84:87]
v_max_f32 v1, v1, v20
v_mfma_f32_16x16x32_bf16 a[52:55], a[184:187], v[160:163], a[52:55]
v_rcp_f32 v20, v20
v_mfma_f32_16x16x32_bf16 a[52:55], a[188:191], v[164:167], a[52:55]
v_accvgpr_read_b32 v232, a0
v_accvgpr_read_b32 v233, a1
v_mfma_f32_16x16x32_bf16 a[20:23], a[188:191], v[156:159], a[20:23]
v_accvgpr_read_b32 v234, a2
v_accvgpr_read_b32 v235, a3
v_mfma_f32_16x16x32_bf16 a[20:23], a[184:187], v[152:155], a[20:23]
v_accvgpr_read_b32 v236, a4
v_accvgpr_read_b32 v237, a5
v_mfma_f32_16x16x32_bf16 a[24:27], a[192:195], v[152:155], a[24:27]
v_accvgpr_read_b32 v238, a6
v_accvgpr_read_b32 v239, a7
v_mfma_f32_16x16x32_bf16 a[24:27], a[196:199], v[156:159], a[24:27]
v_mul_f32 v20, v20, v4
v_mul_f32 v232, v232, v20
v_mfma_f32_16x16x32_bf16 a[56:59], a[196:199], v[164:167], a[56:59]
buffer_load_dwordx4 v16, s[32:35], s70 offen offset:1024 sc1 lds
v_mfma_f32_16x16x32_bf16 a[56:59], a[192:195], v[160:163], a[56:59]
v_mul_f32 v233, v233, v20
v_mul_f32 v234, v234, v20
v_mfma_f32_16x16x32_bf16 a[88:91], a[192:195], v[184:187], a[88:91]
v_mul_f32 v235, v235, v20
v_mul_f32 v236, v236, v20
v_mfma_f32_16x16x32_bf16 a[88:91], a[196:199], v[188:191], a[88:91]
v_mul_f32 v237, v237, v20
v_mul_f32 v238, v238, v20
v_mfma_f32_16x16x32_bf16 a[120:123], a[196:199], v[196:199], a[120:123]
v_mul_f32 v239, v239, v20
v_cvt_pk_bf16_f32 v232, v232, v233
v_mfma_f32_16x16x32_bf16 a[120:123], a[192:195], v[192:195], a[120:123]
v_cvt_pk_bf16_f32 v233, v234, v235
v_cvt_pk_bf16_f32 v234, v236, v237
v_mfma_f32_16x16x32_bf16 a[124:127], a[200:203], v[192:195], a[124:127]
v_cvt_pk_bf16_f32 v235, v238, v239
v_mfma_f32_16x16x32_bf16 a[124:127], a[204:207], v[196:199], a[124:127]
s_add_u32 s77, s74, 0
buffer_store_dwordx4 v[232:235], v16, s[44:47], s77 offen sc1
v_mfma_f32_16x16x32_bf16 a[92:95], a[204:207], v[188:191], a[92:95]
v_accvgpr_read_b32 v240, a8
v_accvgpr_read_b32 v241, a9
v_mfma_f32_16x16x32_bf16 a[92:95], a[200:203], v[184:187], a[92:95]
v_accvgpr_read_b32 v242, a10
v_accvgpr_read_b32 v243, a11
v_mfma_f32_16x16x32_bf16 a[60:63], a[200:203], v[160:163], a[60:63]
v_accvgpr_read_b32 v244, a12
v_accvgpr_read_b32 v245, a13
v_mfma_f32_16x16x32_bf16 a[60:63], a[204:207], v[164:167], a[60:63]
v_accvgpr_read_b32 v246, a14
v_accvgpr_read_b32 v247, a15
v_mfma_f32_16x16x32_bf16 a[28:31], a[204:207], v[156:159], a[28:31]
v_mul_f32 v240, v240, v20
v_mul_f32 v241, v241, v20
v_mfma_f32_16x16x32_bf16 a[28:31], a[200:203], v[152:155], a[28:31]
v_mul_f32 v242, v242, v20
v_mul_f32 v243, v243, v20
v_mul_f32 v244, v244, v20
v_mul_f32 v245, v245, v20
v_mul_f32 v246, v246, v20
v_mul_f32 v247, v247, v20
v_cvt_pk_bf16_f32 v240, v240, v241
v_cvt_pk_bf16_f32 v241, v242, v243
v_cvt_pk_bf16_f32 v242, v244, v245
v_cvt_pk_bf16_f32 v243, v246, v247
s_add_u32 s77, s74, 8192
buffer_store_dwordx4 v[240:243], v16, s[44:47], s77 offen sc1
v_accvgpr_read_b32 v232, a16
v_accvgpr_read_b32 v233, a17
v_accvgpr_read_b32 v234, a18
v_accvgpr_read_b32 v235, a19
v_accvgpr_read_b32 v236, a20
v_accvgpr_read_b32 v237, a21
v_accvgpr_read_b32 v238, a22
v_accvgpr_read_b32 v239, a23
v_mul_f32 v232, v232, v20
v_mul_f32 v233, v233, v20
v_mul_f32 v234, v234, v20
v_mul_f32 v235, v235, v20
v_mul_f32 v236, v236, v20
v_mul_f32 v237, v237, v20
v_mul_f32 v238, v238, v20
v_mul_f32 v239, v239, v20
v_cvt_pk_bf16_f32 v232, v232, v233
v_cvt_pk_bf16_f32 v233, v234, v235
v_cvt_pk_bf16_f32 v234, v236, v237
v_cvt_pk_bf16_f32 v235, v238, v239
s_add_u32 s77, s74, 16384
buffer_store_dwordx4 v[232:235], v16, s[44:47], s77 offen sc1
s_cmp_eq_u32 s3, 7
s_cbranch_scc1 L_T1
s_branch L_po18
L_pg18:
s_branch L_tr3
L_po18:
L_T:
s_waitcnt lgkmcnt(7)
v_mfma_f32_16x16x32_bf16 v[120:123], a[144:147], v[56:59], v[224:227]
s_waitcnt lgkmcnt(6)
ds_read_b128 a[176:179], v2 offset:8192
v_mfma_f32_16x16x32_bf16 v[120:123], a[148:151], v[60:63], v[120:123]
s_waitcnt lgkmcnt(6)
ds_read_b128 a[180:183], v2 offset:9216
v_mfma_f32_16x16x32_bf16 v[120:123], a[152:155], v[64:67], v[120:123]
s_waitcnt lgkmcnt(6)
buffer_load_dwordx4 v16, s[32:35], s70 offen offset:2048 sc1 lds
v_mfma_f32_16x16x32_bf16 v[120:123], a[156:159], v[68:71], v[120:123]
ds_read_b128 a[184:187], v2 offset:10240
v_mfma_f32_16x16x32_bf16 v[136:139], a[156:159], v[84:87], v[228:231]
ds_read_b128 a[188:191], v2 offset:11264
v_mfma_f32_16x16x32_bf16 v[136:139], a[152:155], v[80:83], v[136:139]
ds_read_b128 a[192:195], v2 offset:12288
v_mfma_f32_16x16x32_bf16 v[136:139], a[148:151], v[76:79], v[136:139]
ds_read_b128 a[196:199], v2 offset:13312
v_mfma_f32_16x16x32_bf16 v[136:139], a[144:147], v[72:75], v[136:139]
s_waitcnt lgkmcnt(4)
v_mfma_f32_16x16x32_bf16 v[140:143], a[160:163], v[72:75], v[228:231]
ds_read_b128 a[200:203], v2 offset:14336
v_accvgpr_read_b32 v240, a24
v_mfma_f32_16x16x32_bf16 v[140:143], a[164:167], v[76:79], v[140:143]
ds_read_b128 a[204:207], v2 offset:15360
v_accvgpr_read_b32 v241, a25
v_mfma_f32_16x16x32_bf16 v[140:143], a[168:171], v[80:83], v[140:143]
v_exp_f32 v120, v120
v_mfma_f32_16x16x32_bf16 v[140:143], a[172:175], v[84:87], v[140:143]
v_exp_f32 v121, v121
v_mfma_f32_16x16x32_bf16 v[124:127], a[172:175], v[68:71], v[224:227]
v_exp_f32 v122, v122
v_mfma_f32_16x16x32_bf16 v[124:127], a[168:171], v[64:67], v[124:127]
buffer_load_dwordx4 v16, s[32:35], s70 offen offset:3072 sc1 lds
v_mfma_f32_16x16x32_bf16 v[124:127], a[164:167], v[60:63], v[124:127]
v_exp_f32 v123, v123
v_mfma_f32_16x16x32_bf16 v[124:127], a[160:163], v[56:59], v[124:127]
v_exp_f32 v136, v136
v_mfma_f32_16x16x32_bf16 v[128:131], a[176:179], v[56:59], v[224:227]
v_exp_f32 v137, v137
v_mfma_f32_16x16x32_bf16 v[128:131], a[180:183], v[60:63], v[128:131]
s_waitcnt lgkmcnt(0)
v_exp_f32 v138, v138
v_mfma_f32_16x16x32_bf16 v[128:131], a[184:187], v[64:67], v[128:131]
v_exp_f32 v139, v139
v_mfma_f32_16x16x32_bf16 v[128:131], a[188:191], v[68:71], v[128:131]
s_add_u32 m0, s71, 4096
ds_read_b128 a[144:147], v3 offset:0
v_cvt_pk_bf16_f32 v184, v120, v121
v_mfma_f32_16x16x32_bf16 v[144:147], a[188:191], v[84:87], v[228:231]
s_add_u32 s64, s70, 4096
ds_read_b128 a[148:151], v3 offset:8192
v_cvt_pk_bf16_f32 v185, v122, v123
v_mfma_f32_16x16x32_bf16 v[144:147], a[184:187], v[80:83], v[144:147]
buffer_load_dwordx4 v16, s[32:35], s64 offen offset:0 sc1 lds
v_mfma_f32_16x16x32_bf16 v[144:147], a[180:183], v[76:79], v[144:147]
v_exp_f32 v140, v140
v_mfma_f32_16x16x32_bf16 v[144:147], a[176:179], v[72:75], v[144:147]
v_exp_f32 v141, v141
v_mfma_f32_16x16x32_bf16 v[148:151], a[192:195], v[72:75], v[228:231]
v_exp_f32 v142, v142
v_mfma_f32_16x16x32_bf16 v[148:151], a[196:199], v[76:79], v[148:151]
ds_read_b128 a[152:155], v3 offset:1024
v_cvt_pk_bf16_f32 v192, v136, v137
v_mfma_f32_16x16x32_bf16 v[148:151], a[200:203], v[80:83], v[148:151]
ds_read_b128 a[156:159], v3 offset:9216
v_cvt_pk_bf16_f32 v193, v138, v139
v_mfma_f32_16x16x32_bf16 v[148:151], a[204:207], v[84:87], v[148:151]
v_exp_f32 v143, v143
v_mfma_f32_16x16x32_bf16 v[132:135], a[204:207], v[68:71], v[224:227]
v_exp_f32 v124, v124
v_mfma_f32_16x16x32_bf16 v[132:135], a[200:203], v[64:67], v[132:135]
v_exp_f32 v125, v125
v_mfma_f32_16x16x32_bf16 v[132:135], a[196:199], v[60:63], v[132:135]
buffer_load_dwordx4 v16, s[32:35], s64 offen offset:1024 sc1 lds
v_mfma_f32_16x16x32_bf16 v[132:135], a[192:195], v[56:59], v[132:135]
ds_read_b128 a[160:163], v3 offset:2048
v_cvt_pk_bf16_f32 v194, v140, v141
v_smfmac_f32_16x16x64_bf16 a[132:135], a[240:243], v[176:183], v5
ds_read_b128 a[164:167], v3 offset:10240
v_smfmac_f32_16x16x64_bf16 a[136:139], a[240:243], v[200:207], v5
ds_read_b128 a[168:171], v3 offset:3072
v_accvgpr_read_b32 v242, a26
v_smfmac_f32_16x16x64_bf16 a[140:143], a[240:243], v[208:215], v5
s_waitcnt lgkmcnt(3)
ds_read_b128 a[172:175], v3 offset:11264
v_accvgpr_read_b32 v243, a27
v_mfma_f32_16x16x32_bf16 a[32:35], a[144:147], v[176:179], a[32:35]
ds_read_b128 a[176:179], v3 offset:4096
v_accvgpr_read_b32 v244, a28
v_mfma_f32_16x16x32_bf16 a[32:35], a[148:151], v[180:183], a[32:35]
ds_read_b128 a[180:183], v3 offset:12288
v_accvgpr_read_b32 v245, a29
v_mfma_f32_16x16x32_bf16 a[64:67], a[148:151], v[204:207], a[64:67]
ds_read_b128 a[184:187], v3 offset:5120
v_accvgpr_read_b32 v246, a30
v_mfma_f32_16x16x32_bf16 a[64:67], a[144:147], v[200:203], a[64:67]
ds_read_b128 a[188:191], v3 offset:13312
v_accvgpr_read_b32 v247, a31
v_mfma_f32_16x16x32_bf16 a[96:99], a[144:147], v[208:211], a[96:99]
ds_read_b128 a[192:195], v3 offset:6144
v_mul_f32 v240, v240, v20
v_mfma_f32_16x16x32_bf16 a[96:99], a[148:151], v[212:215], a[96:99]
ds_read_b128 a[196:199], v3 offset:14336
v_mul_f32 v241, v241, v20
v_mfma_f32_16x16x32_bf16 a[100:103], a[156:159], v[212:215], a[100:103]
ds_read_b128 a[200:203], v3 offset:7168
v_mul_f32 v242, v242, v20
v_mfma_f32_16x16x32_bf16 a[100:103], a[152:155], v[208:211], a[100:103]
ds_read_b128 a[204:207], v3 offset:15360
v_mul_f32 v243, v243, v20
v_mul_f32 v244, v244, v20
v_mul_f32 v245, v245, v20
v_mul_f32 v246, v246, v20
v_mul_f32 v247, v247, v20
v_cvt_pk_bf16_f32 v240, v240, v241
v_cvt_pk_bf16_f32 v241, v242, v243
v_cvt_pk_bf16_f32 v242, v244, v245
v_cvt_pk_bf16_f32 v243, v246, v247
s_add_u32 s77, s74, 24576
buffer_store_dwordx4 v[240:243], v16, s[44:47], s77 offen sc1
v_exp_f32 v126, v126
v_mfma_f32_16x16x32_bf16 a[68:71], a[152:155], v[200:203], a[68:71]
buffer_load_dwordx4 v16, s[32:35], s64 offen offset:2048 sc1 lds
v_cvt_pk_bf16_f32 v195, v142, v143
v_mfma_f32_16x16x32_bf16 a[68:71], a[156:159], v[204:207], a[68:71]
v_exp_f32 v127, v127
v_mfma_f32_16x16x32_bf16 a[36:39], a[156:159], v[180:183], a[36:39]
v_exp_f32 v128, v128
v_mfma_f32_16x16x32_bf16 a[36:39], a[152:155], v[176:179], a[36:39]
s_waitcnt lgkmcnt(2)
v_exp_f32 v129, v129
v_mfma_f32_16x16x32_bf16 a[40:43], a[160:163], v[176:179], a[40:43]
v_cvt_pk_bf16_f32 v186, v124, v125
v_cvt_pk_bf16_f32 v187, v126, v127
v_mfma_f32_16x16x32_bf16 a[40:43], a[164:167], v[180:183], a[40:43]
v_exp_f32 v130, v130
v_mfma_f32_16x16x32_bf16 a[72:75], a[164:167], v[204:207], a[72:75]
buffer_load_dwordx4 v16, s[32:35], s64 offen offset:3072 sc1 lds
v_mfma_f32_16x16x32_bf16 a[72:75], a[160:163], v[200:203], a[72:75]
v_exp_f32 v131, v131
v_mfma_f32_16x16x32_bf16 a[104:107], a[160:163], v[208:211], a[104:107]
v_exp_f32 v144, v144
v_mfma_f32_16x16x32_bf16 a[104:107], a[164:167], v[212:215], a[104:107]
v_exp_f32 v145, v145
v_mfma_f32_16x16x32_bf16 a[108:111], a[172:175], v[212:215], a[108:111]
v_exp_f32 v146, v146
v_mfma_f32_16x16x32_bf16 a[108:111], a[168:171], v[208:211], a[108:111]
v_exp_f32 v147, v147
v_mfma_f32_16x16x32_bf16 a[76:79], a[168:171], v[200:203], a[76:79]
v_exp_f32 v148, v148
v_mfma_f32_16x16x32_bf16 a[76:79], a[172:175], v[204:207], a[76:79]
v_exp_f32 v149, v149
v_mfma_f32_16x16x32_bf16 a[44:47], a[172:175], v[180:183], a[44:47]
v_cvt_pk_bf16_f32 v188, v128, v129
v_cvt_pk_bf16_f32 v189, v130, v131
v_mfma_f32_16x16x32_bf16 a[44:47], a[168:171], v[176:179], a[44:47]
v_exp_f32 v150, v150
v_mfma_f32_16x16x32_bf16 a[48:51], a[176:179], v[176:179], a[48:51]
v_exp_f32 v151, v151
v_mfma_f32_16x16x32_bf16 a[48:51], a[180:183], v[180:183], a[48:51]
v_exp_f32 v132, v132
v_mfma_f32_16x16x32_bf16 a[80:83], a[180:183], v[204:207], a[80:83]
s_waitcnt vmcnt(9)
s_barrier
v_mfma_f32_16x16x32_bf16 a[80:83], a[176:179], v[200:203], a[80:83]
s_xor_b32 s71, s71, 16384
v_exp_f32 v133, v133
v_mfma_f32_16x16x32_bf16 a[112:115], a[176:179], v[208:211], a[112:115]
s_add_u32 s70, s70, 32768
ds_read_b128 a[144:147], v2 offset:16384
v_cvt_pk_bf16_f32 v196, v144, v145
v_mfma_f32_16x16x32_bf16 a[112:115], a[180:183], v[212:215], a[112:115]
s_mov_b32 m0, s71
v_exp_f32 v134, v134
v_mfma_f32_16x16x32_bf16 a[116:119], a[188:191], v[212:215], a[116:119]
buffer_load_dwordx4 v16, s[32:35], s70 offen offset:0 sc1 lds
v_mfma_f32_16x16x32_bf16 a[116:119], a[184:187], v[208:211], a[116:119]
ds_read_b128 a[148:151], v2 offset:17408
v_cvt_pk_bf16_f32 v197, v146, v147
v_mfma_f32_16x16x32_bf16 a[84:87], a[184:187], v[200:203], a[84:87]
ds_read_b128 a[152:155], v2 offset:18432
v_cvt_pk_bf16_f32 v198, v148, v149
v_mfma_f32_16x16x32_bf16 a[84:87], a[188:191], v[204:207], a[84:87]
ds_read_b128 a[156:159], v2 offset:19456
v_cvt_pk_bf16_f32 v199, v150, v151
v_mfma_f32_16x16x32_bf16 a[52:55], a[188:191], v[180:183], a[52:55]
v_exp_f32 v135, v135
v_mfma_f32_16x16x32_bf16 a[52:55], a[184:187], v[176:179], a[52:55]
ds_read_b128 a[160:163], v2 offset:20480
v_cvt_pk_bf16_f32 v190, v132, v133
v_mfma_f32_16x16x32_bf16 a[56:59], a[192:195], v[176:179], a[56:59]
ds_read_b128 a[164:167], v2 offset:21504
v_cvt_pk_bf16_f32 v191, v134, v135
v_mfma_f32_16x16x32_bf16 a[56:59], a[196:199], v[180:183], a[56:59]
ds_read_b128 a[168:171], v2 offset:22528
v_accvgpr_read_b32 v21, a132
v_mfma_f32_16x16x32_bf16 a[88:91], a[196:199], v[204:207], a[88:91]
ds_read_b128 a[172:175], v2 offset:23552
v_accvgpr_read_b32 v248, a133
v_mfma_f32_16x16x32_bf16 a[88:91], a[192:195], v[200:203], a[88:91]
buffer_load_dwordx4 v16, s[32:35], s70 offen offset:1024 sc1 lds
v_mfma_f32_16x16x32_bf16 a[120:123], a[192:195], v[208:211], a[120:123]
v_add_f32 v21, v21, v248
v_max_f32 v1, v1, v21
v_mfma_f32_16x16x32_bf16 a[120:123], a[196:199], v[212:215], a[120:123]
s_waitcnt lgkmcnt(3)
v_rcp_f32 v21, v21
v_mfma_f32_16x16x32_bf16 a[124:127], a[204:207], v[212:215], a[124:127]
v_accvgpr_read_b32 v232, a32
v_accvgpr_read_b32 v233, a33
v_mfma_f32_16x16x32_bf16 a[124:127], a[200:203], v[208:211], a[124:127]
v_accvgpr_read_b32 v234, a34
v_accvgpr_read_b32 v235, a35
v_mfma_f32_16x16x32_bf16 a[92:95], a[200:203], v[200:203], a[92:95]
v_accvgpr_read_b32 v236, a36
v_accvgpr_read_b32 v237, a37
v_mfma_f32_16x16x32_bf16 a[92:95], a[204:207], v[204:207], a[92:95]
v_accvgpr_read_b32 v238, a38
v_accvgpr_read_b32 v239, a39
v_mfma_f32_16x16x32_bf16 a[60:63], a[204:207], v[180:183], a[60:63]
v_mul_f32 v21, v21, v6
v_mul_f32 v232, v232, v21
v_mfma_f32_16x16x32_bf16 a[60:63], a[200:203], v[176:179], a[60:63]
v_mul_f32 v233, v233, v21
v_mul_f32 v234, v234, v21
v_mfma_f32_16x16x32_bf16 v[120:123], a[144:147], v[56:59], v[224:227]
ds_read_b128 a[176:179], v2 offset:24576
ds_read_b128 a[180:183], v2 offset:25600
v_mfma_f32_16x16x32_bf16 v[120:123], a[148:151], v[60:63], v[120:123]
buffer_load_dwordx4 v16, s[32:35], s70 offen offset:2048 sc1 lds
v_mfma_f32_16x16x32_bf16 v[120:123], a[152:155], v[64:67], v[120:123]
s_add_u32 s64, s70, 4096
ds_read_b128 a[184:187], v2 offset:26624
ds_read_b128 a[188:191], v2 offset:27648
v_mfma_f32_16x16x32_bf16 v[120:123], a[156:159], v[68:71], v[120:123]
buffer_load_dwordx4 v16, s[32:35], s70 offen offset:3072 sc1 lds
v_mfma_f32_16x16x32_bf16 v[136:139], a[156:159], v[84:87], v[228:231]
s_add_u32 m0, s71, 4096
ds_read_b128 a[192:195], v2 offset:28672
ds_read_b128 a[196:199], v2 offset:29696
v_mfma_f32_16x16x32_bf16 v[136:139], a[152:155], v[80:83], v[136:139]
buffer_load_dwordx4 v16, s[32:35], s64 offen offset:0 sc1 lds
v_mfma_f32_16x16x32_bf16 v[136:139], a[148:151], v[76:79], v[136:139]
ds_read_b128 a[200:203], v2 offset:30720
ds_read_b128 a[204:207], v2 offset:31744
v_mfma_f32_16x16x32_bf16 v[136:139], a[144:147], v[72:75], v[136:139]
v_exp_f32 v120, v120
v_mfma_f32_16x16x32_bf16 v[140:143], a[160:163], v[72:75], v[228:231]
s_waitcnt lgkmcnt(4)
v_exp_f32 v121, v121
v_mfma_f32_16x16x32_bf16 v[140:143], a[164:167], v[76:79], v[140:143]
v_exp_f32 v122, v122
v_mfma_f32_16x16x32_bf16 v[140:143], a[168:171], v[80:83], v[140:143]
v_mul_f32 v235, v235, v21
v_mul_f32 v236, v236, v21
v_mul_f32 v237, v237, v21
v_mul_f32 v238, v238, v21
v_mul_f32 v239, v239, v21
v_cvt_pk_bf16_f32 v232, v232, v233
v_cvt_pk_bf16_f32 v233, v234, v235
v_cvt_pk_bf16_f32 v234, v236, v237
v_cvt_pk_bf16_f32 v235, v238, v239
s_add_u32 s77, s74, 4096
buffer_store_dwordx4 v[232:235], v16, s[44:47], s77 offen sc1
v_accvgpr_read_b32 v240, a40
v_accvgpr_read_b32 v241, a41
v_accvgpr_read_b32 v242, a42
v_accvgpr_read_b32 v243, a43
v_accvgpr_read_b32 v244, a44
v_accvgpr_read_b32 v245, a45
v_accvgpr_read_b32 v246, a46
v_accvgpr_read_b32 v247, a47
v_mul_f32 v240, v240, v21
v_mul_f32 v241, v241, v21
v_mul_f32 v242, v242, v21
v_mul_f32 v243, v243, v21
v_mul_f32 v244, v244, v21
v_mul_f32 v245, v245, v21
v_mul_f32 v246, v246, v21
v_mul_f32 v247, v247, v21
v_cvt_pk_bf16_f32 v240, v240, v241
v_cvt_pk_bf16_f32 v241, v242, v243
v_cvt_pk_bf16_f32 v242, v244, v245
v_cvt_pk_bf16_f32 v243, v246, v247
s_add_u32 s77, s74, 12288
buffer_store_dwordx4 v[240:243], v16, s[44:47], s77 offen sc1
v_accvgpr_read_b32 v232, a48
v_accvgpr_read_b32 v233, a49
v_accvgpr_read_b32 v234, a50
v_accvgpr_read_b32 v235, a51
v_accvgpr_read_b32 v236, a52
v_accvgpr_read_b32 v237, a53
v_accvgpr_read_b32 v238, a54
v_accvgpr_read_b32 v239, a55
v_mul_f32 v232, v232, v21
v_mul_f32 v233, v233, v21
v_mul_f32 v234, v234, v21
v_mul_f32 v235, v235, v21
v_mul_f32 v236, v236, v21
v_mul_f32 v237, v237, v21
v_mul_f32 v238, v238, v21
v_mul_f32 v239, v239, v21
v_cvt_pk_bf16_f32 v232, v232, v233
v_cvt_pk_bf16_f32 v233, v234, v235
v_cvt_pk_bf16_f32 v234, v236, v237
v_cvt_pk_bf16_f32 v235, v238, v239
s_add_u32 s77, s74, 20480
buffer_store_dwordx4 v[232:235], v16, s[44:47], s77 offen sc1
v_accvgpr_read_b32 v240, a56
v_accvgpr_read_b32 v241, a57
v_accvgpr_read_b32 v242, a58
v_accvgpr_read_b32 v243, a59
v_accvgpr_read_b32 v244, a60
v_accvgpr_read_b32 v245, a61
v_accvgpr_read_b32 v246, a62
v_accvgpr_read_b32 v247, a63
v_mul_f32 v240, v240, v21
v_mul_f32 v241, v241, v21
v_mul_f32 v242, v242, v21
v_mul_f32 v243, v243, v21
v_mul_f32 v244, v244, v21
v_mul_f32 v245, v245, v21
v_mul_f32 v246, v246, v21
v_mul_f32 v247, v247, v21
v_cvt_pk_bf16_f32 v240, v240, v241
v_cvt_pk_bf16_f32 v241, v242, v243
v_cvt_pk_bf16_f32 v242, v244, v245
v_cvt_pk_bf16_f32 v243, v246, v247
s_add_u32 s77, s74, 28672
s_branch L_po19
L_pg19:
s_branch L_pg24
L_po19:
buffer_store_dwordx4 v[240:243], v16, s[44:47], s77 offen sc1
v_exp_f32 v123, v123
v_mfma_f32_16x16x32_bf16 v[140:143], a[172:175], v[84:87], v[140:143]
v_exp_f32 v136, v136
v_mfma_f32_16x16x32_bf16 v[124:127], a[172:175], v[68:71], v[224:227]
ds_read_b128 a[144:147], v3 offset:16384
v_cvt_pk_bf16_f32 v200, v120, v121
v_mfma_f32_16x16x32_bf16 v[124:127], a[168:171], v[64:67], v[124:127]
v_exp_f32 v137, v137
v_mfma_f32_16x16x32_bf16 v[124:127], a[164:167], v[60:63], v[124:127]
ds_read_b128 a[148:151], v3 offset:24576
v_cvt_pk_bf16_f32 v201, v122, v123
v_mfma_f32_16x16x32_bf16 v[124:127], a[160:163], v[56:59], v[124:127]
v_exp_f32 v138, v138
v_mfma_f32_16x16x32_bf16 v[128:131], a[176:179], v[56:59], v[224:227]
ds_read_b128 a[152:155], v3 offset:17408
v_cvt_pk_bf16_f32 v208, v136, v137
v_mfma_f32_16x16x32_bf16 v[128:131], a[180:183], v[60:63], v[128:131]
v_exp_f32 v139, v139
v_mfma_f32_16x16x32_bf16 v[128:131], a[184:187], v[64:67], v[128:131]
ds_read_b128 a[156:159], v3 offset:25600
v_cvt_pk_bf16_f32 v209, v138, v139
v_mfma_f32_16x16x32_bf16 v[128:131], a[188:191], v[68:71], v[128:131]
v_exp_f32 v140, v140
v_mfma_f32_16x16x32_bf16 v[144:147], a[188:191], v[84:87], v[228:231]
buffer_load_dwordx4 v16, s[32:35], s64 offen offset:1024 sc1 lds
v_mfma_f32_16x16x32_bf16 v[144:147], a[184:187], v[80:83], v[144:147]
v_exp_f32 v141, v141
v_mfma_f32_16x16x32_bf16 v[144:147], a[180:183], v[76:79], v[144:147]
ds_read_b128 a[160:163], v3 offset:18432
v_cvt_pk_bf16_f32 v210, v140, v141
v_mfma_f32_16x16x32_bf16 v[144:147], a[176:179], v[72:75], v[144:147]
s_waitcnt lgkmcnt(2)
v_exp_f32 v142, v142
v_mfma_f32_16x16x32_bf16 v[148:151], a[192:195], v[72:75], v[228:231]
ds_read_b128 a[164:167], v3 offset:26624
ds_read_b128 a[168:171], v3 offset:19456
v_mfma_f32_16x16x32_bf16 v[148:151], a[196:199], v[76:79], v[148:151]
v_exp_f32 v143, v143
v_mfma_f32_16x16x32_bf16 v[148:151], a[200:203], v[80:83], v[148:151]
ds_read_b128 a[172:175], v3 offset:27648
v_cvt_pk_bf16_f32 v211, v142, v143
v_mfma_f32_16x16x32_bf16 v[148:151], a[204:207], v[84:87], v[148:151]
v_exp_f32 v124, v124
v_mfma_f32_16x16x32_bf16 v[132:135], a[204:207], v[68:71], v[224:227]
ds_read_b128 a[176:179], v3 offset:20480
buffer_load_dwordx4 v16, s[32:35], s64 offen offset:2048 sc1 lds
v_mfma_f32_16x16x32_bf16 v[132:135], a[200:203], v[64:67], v[132:135]
v_exp_f32 v125, v125
v_mfma_f32_16x16x32_bf16 v[132:135], a[196:199], v[60:63], v[132:135]
ds_read_b128 a[180:183], v3 offset:28672
v_cvt_pk_bf16_f32 v202, v124, v125
v_mfma_f32_16x16x32_bf16 v[132:135], a[192:195], v[56:59], v[132:135]
v_exp_f32 v126, v126
v_smfmac_f32_16x16x64_bf16 a[136:139], a[240:243], v[184:191], v5
ds_read_b128 a[184:187], v3 offset:21504
v_smfmac_f32_16x16x64_bf16 a[140:143], a[240:243], v[192:199], v5
ds_read_b128 a[188:191], v3 offset:29696
v_mfma_f32_16x16x32_bf16 a[64:67], a[144:147], v[184:187], a[64:67]
v_exp_f32 v127, v127
v_mfma_f32_16x16x32_bf16 a[64:67], a[148:151], v[188:191], a[64:67]
v_exp_f32 v128, v128
v_mfma_f32_16x16x32_bf16 a[96:99], a[148:151], v[196:199], a[96:99]
v_exp_f32 v129, v129
v_mfma_f32_16x16x32_bf16 a[96:99], a[144:147], v[192:195], a[96:99]
ds_read_b128 a[192:195], v3 offset:22528
v_cvt_pk_bf16_f32 v203, v126, v127
v_mfma_f32_16x16x32_bf16 a[100:103], a[152:155], v[192:195], a[100:103]
s_waitcnt lgkmcnt(2)
v_exp_f32 v130, v130
v_mfma_f32_16x16x32_bf16 a[100:103], a[156:159], v[196:199], a[100:103]
ds_read_b128 a[196:199], v3 offset:30720
v_cvt_pk_bf16_f32 v204, v128, v129
v_mfma_f32_16x16x32_bf16 a[68:71], a[156:159], v[188:191], a[68:71]
v_exp_f32 v131, v131
v_mfma_f32_16x16x32_bf16 a[68:71], a[152:155], v[184:187], a[68:71]
ds_read_b128 a[200:203], v3 offset:23552
v_cvt_pk_bf16_f32 v205, v130, v131
v_mfma_f32_16x16x32_bf16 a[72:75], a[160:163], v[184:187], a[72:75]
v_exp_f32 v144, v144
v_mfma_f32_16x16x32_bf16 a[72:75], a[164:167], v[188:191], a[72:75]
buffer_load_dwordx4 v16, s[32:35], s64 offen offset:3072 sc1 lds
v_mfma_f32_16x16x32_bf16 a[104:107], a[164:167], v[196:199], a[104:107]
s_xor_b32 s71, s71, 49152
v_exp_f32 v145, v145
v_mfma_f32_16x16x32_bf16 a[104:107], a[160:163], v[192:195], a[104:107]
ds_read_b128 a[204:207], v3 offset:31744
v_cvt_pk_bf16_f32 v212, v144, v145
v_mfma_f32_16x16x32_bf16 a[108:111], a[168:171], v[192:195], a[108:111]
s_add_u32 s70, s70, 32768
v_xor_b32 v2, 0x8000, v2
v_exp_f32 v146, v146
v_mfma_f32_16x16x32_bf16 a[108:111], a[172:175], v[196:199], a[108:111]
s_waitcnt vmcnt(12)
s_barrier
v_mfma_f32_16x16x32_bf16 a[76:79], a[172:175], v[188:191], a[76:79]
s_mov_b32 m0, s71
v_exp_f32 v147, v147
v_mfma_f32_16x16x32_bf16 a[76:79], a[168:171], v[184:187], a[76:79]
ds_read_b128 a[144:147], v2 offset:0
v_cvt_pk_bf16_f32 v213, v146, v147
v_mfma_f32_16x16x32_bf16 a[80:83], a[176:179], v[184:187], a[80:83]
v_exp_f32 v148, v148
v_mfma_f32_16x16x32_bf16 a[80:83], a[180:183], v[188:191], a[80:83]
ds_read_b128 a[148:151], v2 offset:1024
ds_read_b128 a[152:155], v2 offset:2048
v_mfma_f32_16x16x32_bf16 a[112:115], a[180:183], v[196:199], a[112:115]
v_exp_f32 v149, v149
v_mfma_f32_16x16x32_bf16 a[112:115], a[176:179], v[192:195], a[112:115]
ds_read_b128 a[156:159], v2 offset:3072
v_cvt_pk_bf16_f32 v214, v148, v149
v_mfma_f32_16x16x32_bf16 a[116:119], a[184:187], v[192:195], a[116:119]
s_waitcnt lgkmcnt(4)
v_exp_f32 v150, v150
v_mfma_f32_16x16x32_bf16 a[116:119], a[188:191], v[196:199], a[116:119]
buffer_load_dwordx4 v16, s[32:35], s70 offen offset:0 sc1 lds
v_mfma_f32_16x16x32_bf16 a[84:87], a[188:191], v[188:191], a[84:87]
v_exp_f32 v151, v151
v_mfma_f32_16x16x32_bf16 a[84:87], a[184:187], v[184:187], a[84:87]
ds_read_b128 a[160:163], v2 offset:4096
v_cvt_pk_bf16_f32 v215, v150, v151
v_mfma_f32_16x16x32_bf16 a[88:91], a[192:195], v[184:187], a[88:91]
v_exp_f32 v132, v132
v_mfma_f32_16x16x32_bf16 a[88:91], a[196:199], v[188:191], a[88:91]
ds_read_b128 a[164:167], v2 offset:5120
v_xor_b32 v3, 0x8000, v3
v_mfma_f32_16x16x32_bf16 a[120:123], a[196:199], v[196:199], a[120:123]
v_exp_f32 v133, v133
v_mfma_f32_16x16x32_bf16 a[120:123], a[192:195], v[192:195], a[120:123]
ds_read_b128 a[168:171], v2 offset:6144
v_cvt_pk_bf16_f32 v206, v132, v133
v_mfma_f32_16x16x32_bf16 a[124:127], a[200:203], v[192:195], a[124:127]
v_exp_f32 v134, v134
v_mfma_f32_16x16x32_bf16 a[124:127], a[204:207], v[196:199], a[124:127]
buffer_load_dwordx4 v16, s[32:35], s70 offen offset:1024 sc1 lds
v_mfma_f32_16x16x32_bf16 a[92:95], a[204:207], v[188:191], a[92:95]
v_exp_f32 v135, v135
v_mfma_f32_16x16x32_bf16 a[92:95], a[200:203], v[184:187], a[92:95]
ds_read_b128 a[172:175], v2 offset:7168
v_cvt_pk_bf16_f32 v207, v134, v135
s_lshl_b32 s72, s3, 1
s_sub_u32 s72, 13, s72
L_S:
s_waitcnt lgkmcnt(7)
v_mfma_f32_16x16x32_bf16 v[120:123], a[144:147], v[56:59], v[224:227]
s_waitcnt lgkmcnt(6)
ds_read_b128 a[176:179], v2 offset:8192
ds_read_b128 a[180:183], v2 offset:9216
v_mfma_f32_16x16x32_bf16 v[120:123], a[148:151], v[60:63], v[120:123]
s_waitcnt lgkmcnt(7)
buffer_load_dwordx4 v16, s[32:35], s70 offen offset:2048 sc1 lds
v_mfma_f32_16x16x32_bf16 v[120:123], a[152:155], v[64:67], v[120:123]
s_waitcnt lgkmcnt(6)
s_add_u32 s64, s70, 4096
ds_read_b128 a[184:187], v2 offset:10240
ds_read_b128 a[188:191], v2 offset:11264
v_mfma_f32_16x16x32_bf16 v[120:123], a[156:159], v[68:71], v[120:123]
buffer_load_dwordx4 v16, s[32:35], s70 offen offset:3072 sc1 lds
v_mfma_f32_16x16x32_bf16 v[136:139], a[156:159], v[84:87], v[228:231]
s_add_u32 m0, s71, 4096
ds_read_b128 a[192:195], v2 offset:12288
ds_read_b128 a[196:199], v2 offset:13312
v_mfma_f32_16x16x32_bf16 v[136:139], a[152:155], v[80:83], v[136:139]
buffer_load_dwordx4 v16, s[32:35], s64 offen offset:0 sc1 lds
v_mfma_f32_16x16x32_bf16 v[136:139], a[148:151], v[76:79], v[136:139]
ds_read_b128 a[200:203], v2 offset:14336
ds_read_b128 a[204:207], v2 offset:15360
v_mfma_f32_16x16x32_bf16 v[136:139], a[144:147], v[72:75], v[136:139]
s_waitcnt lgkmcnt(6)
v_exp_f32 v120, v120
v_mfma_f32_16x16x32_bf16 v[140:143], a[160:163], v[72:75], v[228:231]
v_exp_f32 v121, v121
v_mfma_f32_16x16x32_bf16 v[140:143], a[164:167], v[76:79], v[140:143]
v_exp_f32 v122, v122
v_mfma_f32_16x16x32_bf16 v[140:143], a[168:171], v[80:83], v[140:143]
v_exp_f32 v123, v123
v_mfma_f32_16x16x32_bf16 v[140:143], a[172:175], v[84:87], v[140:143]
v_exp_f32 v136, v136
v_mfma_f32_16x16x32_bf16 v[124:127], a[172:175], v[68:71], v[224:227]
ds_read_b128 a[144:147], v3 offset:0
v_cvt_pk_bf16_f32 v184, v120, v121
v_mfma_f32_16x16x32_bf16 v[124:127], a[168:171], v[64:67], v[124:127]
v_exp_f32 v137, v137
v_mfma_f32_16x16x32_bf16 v[124:127], a[164:167], v[60:63], v[124:127]
ds_read_b128 a[148:151], v3 offset:8192
v_cvt_pk_bf16_f32 v185, v122, v123
v_mfma_f32_16x16x32_bf16 v[124:127], a[160:163], v[56:59], v[124:127]
v_exp_f32 v138, v138
v_mfma_f32_16x16x32_bf16 v[128:131], a[176:179], v[56:59], v[224:227]
ds_read_b128 a[152:155], v3 offset:1024
v_cvt_pk_bf16_f32 v192, v136, v137
v_mfma_f32_16x16x32_bf16 v[128:131], a[180:183], v[60:63], v[128:131]
s_waitcnt lgkmcnt(3)
v_exp_f32 v139, v139
v_mfma_f32_16x16x32_bf16 v[128:131], a[184:187], v[64:67], v[128:131]
ds_read_b128 a[156:159], v3 offset:9216
v_cvt_pk_bf16_f32 v193, v138, v139
v_mfma_f32_16x16x32_bf16 v[128:131], a[188:191], v[68:71], v[128:131]
v_exp_f32 v140, v140
v_mfma_f32_16x16x32_bf16 v[144:147], a[188:191], v[84:87], v[228:231]
buffer_load_dwordx4 v16, s[32:35], s64 offen offset:1024 sc1 lds
v_mfma_f32_16x16x32_bf16 v[144:147], a[184:187], v[80:83], v[144:147]
v_exp_f32 v141, v141
v_mfma_f32_16x16x32_bf16 v[144:147], a[180:183], v[76:79], v[144:147]
ds_read_b128 a[160:163], v3 offset:2048
v_cvt_pk_bf16_f32 v194, v140, v141
v_mfma_f32_16x16x32_bf16 v[144:147], a[176:179], v[72:75], v[144:147]
v_exp_f32 v142, v142
v_mfma_f32_16x16x32_bf16 v[148:151], a[192:195], v[72:75], v[228:231]
ds_read_b128 a[164:167], v3 offset:10240
ds_read_b128 a[168:171], v3 offset:3072
v_mfma_f32_16x16x32_bf16 v[148:151], a[196:199], v[76:79], v[148:151]
v_exp_f32 v143, v143
v_mfma_f32_16x16x32_bf16 v[148:151], a[200:203], v[80:83], v[148:151]
ds_read_b128 a[172:175], v3 offset:11264
v_cvt_pk_bf16_f32 v195, v142, v143
v_mfma_f32_16x16x32_bf16 v[148:151], a[204:207], v[84:87], v[148:151]
v_exp_f32 v124, v124
v_mfma_f32_16x16x32_bf16 v[132:135], a[204:207], v[68:71], v[224:227]
ds_read_b128 a[176:179], v3 offset:4096
buffer_load_dwordx4 v16, s[32:35], s64 offen offset:2048 sc1 lds
v_mfma_f32_16x16x32_bf16 v[132:135], a[200:203], v[64:67], v[132:135]
v_exp_f32 v125, v125
v_mfma_f32_16x16x32_bf16 v[132:135], a[196:199], v[60:63], v[132:135]
ds_read_b128 a[180:183], v3 offset:12288
v_cvt_pk_bf16_f32 v186, v124, v125
v_mfma_f32_16x16x32_bf16 v[132:135], a[192:195], v[56:59], v[132:135]
v_exp_f32 v126, v126
v_smfmac_f32_16x16x64_bf16 a[136:139], a[240:243], v[200:207], v5
ds_read_b128 a[184:187], v3 offset:5120
v_smfmac_f32_16x16x64_bf16 a[140:143], a[240:243], v[208:215], v5
s_waitcnt lgkmcnt(3)
ds_read_b128 a[188:191], v3 offset:13312
v_mfma_f32_16x16x32_bf16 a[64:67], a[144:147], v[200:203], a[64:67]
v_exp_f32 v127, v127
v_mfma_f32_16x16x32_bf16 a[64:67], a[148:151], v[204:207], a[64:67]
v_exp_f32 v128, v128
v_mfma_f32_16x16x32_bf16 a[96:99], a[148:151], v[212:215], a[96:99]
v_exp_f32 v129, v129
v_mfma_f32_16x16x32_bf16 a[96:99], a[144:147], v[208:211], a[96:99]
ds_read_b128 a[192:195], v3 offset:6144
v_cvt_pk_bf16_f32 v187, v126, v127
v_mfma_f32_16x16x32_bf16 a[100:103], a[152:155], v[208:211], a[100:103]
v_exp_f32 v130, v130
v_mfma_f32_16x16x32_bf16 a[100:103], a[156:159], v[212:215], a[100:103]
ds_read_b128 a[196:199], v3 offset:14336
v_cvt_pk_bf16_f32 v188, v128, v129
v_mfma_f32_16x16x32_bf16 a[68:71], a[156:159], v[204:207], a[68:71]
v_exp_f32 v131, v131
v_mfma_f32_16x16x32_bf16 a[68:71], a[152:155], v[200:203], a[68:71]
ds_read_b128 a[200:203], v3 offset:7168
v_cvt_pk_bf16_f32 v189, v130, v131
v_mfma_f32_16x16x32_bf16 a[72:75], a[160:163], v[200:203], a[72:75]
v_exp_f32 v144, v144
v_mfma_f32_16x16x32_bf16 a[72:75], a[164:167], v[204:207], a[72:75]
buffer_load_dwordx4 v16, s[32:35], s64 offen offset:3072 sc1 lds
v_mfma_f32_16x16x32_bf16 a[104:107], a[164:167], v[212:215], a[104:107]
s_xor_b32 s71, s71, 16384
v_exp_f32 v145, v145
v_mfma_f32_16x16x32_bf16 a[104:107], a[160:163], v[208:211], a[104:107]
ds_read_b128 a[204:207], v3 offset:15360
v_cvt_pk_bf16_f32 v196, v144, v145
v_mfma_f32_16x16x32_bf16 a[108:111], a[168:171], v[208:211], a[108:111]
s_add_u32 s70, s70, 32768
v_exp_f32 v146, v146
v_mfma_f32_16x16x32_bf16 a[108:111], a[172:175], v[212:215], a[108:111]
s_waitcnt vmcnt(8)
s_barrier
v_mfma_f32_16x16x32_bf16 a[76:79], a[172:175], v[204:207], a[76:79]
s_mov_b32 m0, s71
v_exp_f32 v147, v147
v_mfma_f32_16x16x32_bf16 a[76:79], a[168:171], v[200:203], a[76:79]
s_waitcnt lgkmcnt(1)
ds_read_b128 a[144:147], v2 offset:16384
v_cvt_pk_bf16_f32 v197, v146, v147
v_mfma_f32_16x16x32_bf16 a[80:83], a[176:179], v[200:203], a[80:83]
v_exp_f32 v148, v148
v_mfma_f32_16x16x32_bf16 a[80:83], a[180:183], v[204:207], a[80:83]
ds_read_b128 a[148:151], v2 offset:17408
ds_read_b128 a[152:155], v2 offset:18432
v_mfma_f32_16x16x32_bf16 a[112:115], a[180:183], v[212:215], a[112:115]
v_exp_f32 v149, v149
v_mfma_f32_16x16x32_bf16 a[112:115], a[176:179], v[208:211], a[112:115]
ds_read_b128 a[156:159], v2 offset:19456
v_cvt_pk_bf16_f32 v198, v148, v149
v_mfma_f32_16x16x32_bf16 a[116:119], a[184:187], v[208:211], a[116:119]
v_exp_f32 v150, v150
v_mfma_f32_16x16x32_bf16 a[116:119], a[188:191], v[212:215], a[116:119]
buffer_load_dwordx4 v16, s[32:35], s70 offen offset:0 sc1 lds
v_mfma_f32_16x16x32_bf16 a[84:87], a[188:191], v[204:207], a[84:87]
v_exp_f32 v151, v151
v_mfma_f32_16x16x32_bf16 a[84:87], a[184:187], v[200:203], a[84:87]
ds_read_b128 a[160:163], v2 offset:20480
v_cvt_pk_bf16_f32 v199, v150, v151
v_mfma_f32_16x16x32_bf16 a[88:91], a[192:195], v[200:203], a[88:91]
v_exp_f32 v132, v132
v_mfma_f32_16x16x32_bf16 a[88:91], a[196:199], v[204:207], a[88:91]
ds_read_b128 a[164:167], v2 offset:21504
v_mfma_f32_16x16x32_bf16 a[120:123], a[196:199], v[212:215], a[120:123]
v_exp_f32 v133, v133
v_mfma_f32_16x16x32_bf16 a[120:123], a[192:195], v[208:211], a[120:123]
ds_read_b128 a[168:171], v2 offset:22528
v_cvt_pk_bf16_f32 v190, v132, v133
v_mfma_f32_16x16x32_bf16 a[124:127], a[200:203], v[208:211], a[124:127]
s_waitcnt lgkmcnt(3)
v_exp_f32 v134, v134
v_mfma_f32_16x16x32_bf16 a[124:127], a[204:207], v[212:215], a[124:127]
buffer_load_dwordx4 v16, s[32:35], s70 offen offset:1024 sc1 lds
v_mfma_f32_16x16x32_bf16 a[92:95], a[204:207], v[204:207], a[92:95]
v_exp_f32 v135, v135
v_mfma_f32_16x16x32_bf16 a[92:95], a[200:203], v[200:203], a[92:95]
ds_read_b128 a[172:175], v2 offset:23552
v_cvt_pk_bf16_f32 v191, v134, v135
v_mfma_f32_16x16x32_bf16 v[120:123], a[144:147], v[56:59], v[224:227]
ds_read_b128 a[176:179], v2 offset:24576
ds_read_b128 a[180:183], v2 offset:25600
v_mfma_f32_16x16x32_bf16 v[120:123], a[148:151], v[60:63], v[120:123]
buffer_load_dwordx4 v16, s[32:35], s70 offen offset:2048 sc1 lds
v_mfma_f32_16x16x32_bf16 v[120:123], a[152:155], v[64:67], v[120:123]
s_add_u32 s64, s70, 4096
ds_read_b128 a[184:187], v2 offset:26624
ds_read_b128 a[188:191], v2 offset:27648
v_mfma_f32_16x16x32_bf16 v[120:123], a[156:159], v[68:71], v[120:123]
buffer_load_dwordx4 v16, s[32:35], s70 offen offset:3072 sc1 lds
v_mfma_f32_16x16x32_bf16 v[136:139], a[156:159], v[84:87], v[228:231]
s_add_u32 m0, s71, 4096
ds_read_b128 a[192:195], v2 offset:28672
ds_read_b128 a[196:199], v2 offset:29696
v_mfma_f32_16x16x32_bf16 v[136:139], a[152:155], v[80:83], v[136:139]
buffer_load_dwordx4 v16, s[32:35], s64 offen offset:0 sc1 lds
v_mfma_f32_16x16x32_bf16 v[136:139], a[148:151], v[76:79], v[136:139]
ds_read_b128 a[200:203], v2 offset:30720
ds_read_b128 a[204:207], v2 offset:31744
v_mfma_f32_16x16x32_bf16 v[136:139], a[144:147], v[72:75], v[136:139]
s_waitcnt lgkmcnt(6)
v_exp_f32 v120, v120
v_mfma_f32_16x16x32_bf16 v[140:143], a[160:163], v[72:75], v[228:231]
v_exp_f32 v121, v121
v_mfma_f32_16x16x32_bf16 v[140:143], a[164:167], v[76:79], v[140:143]
v_exp_f32 v122, v122
v_mfma_f32_16x16x32_bf16 v[140:143], a[168:171], v[80:83], v[140:143]
v_exp_f32 v123, v123
v_mfma_f32_16x16x32_bf16 v[140:143], a[172:175], v[84:87], v[140:143]
v_exp_f32 v136, v136
v_mfma_f32_16x16x32_bf16 v[124:127], a[172:175], v[68:71], v[224:227]
ds_read_b128 a[144:147], v3 offset:16384
v_cvt_pk_bf16_f32 v200, v120, v121
v_mfma_f32_16x16x32_bf16 v[124:127], a[168:171], v[64:67], v[124:127]
v_exp_f32 v137, v137
v_mfma_f32_16x16x32_bf16 v[124:127], a[164:167], v[60:63], v[124:127]
ds_read_b128 a[148:151], v3 offset:24576
v_cvt_pk_bf16_f32 v201, v122, v123
v_mfma_f32_16x16x32_bf16 v[124:127], a[160:163], v[56:59], v[124:127]
v_exp_f32 v138, v138
v_mfma_f32_16x16x32_bf16 v[128:131], a[176:179], v[56:59], v[224:227]
ds_read_b128 a[152:155], v3 offset:17408
v_cvt_pk_bf16_f32 v208, v136, v137
v_mfma_f32_16x16x32_bf16 v[128:131], a[180:183], v[60:63], v[128:131]
s_waitcnt lgkmcnt(3)
v_exp_f32 v139, v139
v_mfma_f32_16x16x32_bf16 v[128:131], a[184:187], v[64:67], v[128:131]
ds_read_b128 a[156:159], v3 offset:25600
v_cvt_pk_bf16_f32 v209, v138, v139
v_mfma_f32_16x16x32_bf16 v[128:131], a[188:191], v[68:71], v[128:131]
v_exp_f32 v140, v140
v_mfma_f32_16x16x32_bf16 v[144:147], a[188:191], v[84:87], v[228:231]
buffer_load_dwordx4 v16, s[32:35], s64 offen offset:1024 sc1 lds
v_mfma_f32_16x16x32_bf16 v[144:147], a[184:187], v[80:83], v[144:147]
v_exp_f32 v141, v141
v_mfma_f32_16x16x32_bf16 v[144:147], a[180:183], v[76:79], v[144:147]
ds_read_b128 a[160:163], v3 offset:18432
v_cvt_pk_bf16_f32 v210, v140, v141
v_mfma_f32_16x16x32_bf16 v[144:147], a[176:179], v[72:75], v[144:147]
v_exp_f32 v142, v142
v_mfma_f32_16x16x32_bf16 v[148:151], a[192:195], v[72:75], v[228:231]
ds_read_b128 a[164:167], v3 offset:26624
ds_read_b128 a[168:171], v3 offset:19456
v_mfma_f32_16x16x32_bf16 v[148:151], a[196:199], v[76:79], v[148:151]
v_exp_f32 v143, v143
v_mfma_f32_16x16x32_bf16 v[148:151], a[200:203], v[80:83], v[148:151]
ds_read_b128 a[172:175], v3 offset:27648
v_cvt_pk_bf16_f32 v211, v142, v143
v_mfma_f32_16x16x32_bf16 v[148:151], a[204:207], v[84:87], v[148:151]
v_exp_f32 v124, v124
v_mfma_f32_16x16x32_bf16 v[132:135], a[204:207], v[68:71], v[224:227]
ds_read_b128 a[176:179], v3 offset:20480
buffer_load_dwordx4 v16, s[32:35], s64 offen offset:2048 sc1 lds
v_mfma_f32_16x16x32_bf16 v[132:135], a[200:203], v[64:67], v[132:135]
v_exp_f32 v125, v125
v_mfma_f32_16x16x32_bf16 v[132:135], a[196:199], v[60:63], v[132:135]
ds_read_b128 a[180:183], v3 offset:28672
v_cvt_pk_bf16_f32 v202, v124, v125
v_mfma_f32_16x16x32_bf16 v[132:135], a[192:195], v[56:59], v[132:135]
v_exp_f32 v126, v126
v_smfmac_f32_16x16x64_bf16 a[136:139], a[240:243], v[184:191], v5
ds_read_b128 a[184:187], v3 offset:21504
v_smfmac_f32_16x16x64_bf16 a[140:143], a[240:243], v[192:199], v5
s_waitcnt lgkmcnt(3)
ds_read_b128 a[188:191], v3 offset:29696
v_mfma_f32_16x16x32_bf16 a[64:67], a[144:147], v[184:187], a[64:67]
v_exp_f32 v127, v127
v_mfma_f32_16x16x32_bf16 a[64:67], a[148:151], v[188:191], a[64:67]
v_exp_f32 v128, v128
v_mfma_f32_16x16x32_bf16 a[96:99], a[148:151], v[196:199], a[96:99]
v_exp_f32 v129, v129
v_mfma_f32_16x16x32_bf16 a[96:99], a[144:147], v[192:195], a[96:99]
ds_read_b128 a[192:195], v3 offset:22528
v_cvt_pk_bf16_f32 v203, v126, v127
v_mfma_f32_16x16x32_bf16 a[100:103], a[152:155], v[192:195], a[100:103]
v_exp_f32 v130, v130
v_mfma_f32_16x16x32_bf16 a[100:103], a[156:159], v[196:199], a[100:103]
ds_read_b128 a[196:199], v3 offset:30720
v_cvt_pk_bf16_f32 v204, v128, v129
v_mfma_f32_16x16x32_bf16 a[68:71], a[156:159], v[188:191], a[68:71]
v_exp_f32 v131, v131
v_mfma_f32_16x16x32_bf16 a[68:71], a[152:155], v[184:187], a[68:71]
ds_read_b128 a[200:203], v3 offset:23552
v_cvt_pk_bf16_f32 v205, v130, v131
v_mfma_f32_16x16x32_bf16 a[72:75], a[160:163], v[184:187], a[72:75]
v_exp_f32 v144, v144
v_mfma_f32_16x16x32_bf16 a[72:75], a[164:167], v[188:191], a[72:75]
buffer_load_dwordx4 v16, s[32:35], s64 offen offset:3072 sc1 lds
v_mfma_f32_16x16x32_bf16 a[104:107], a[164:167], v[196:199], a[104:107]
s_xor_b32 s71, s71, 49152
v_exp_f32 v145, v145
v_mfma_f32_16x16x32_bf16 a[104:107], a[160:163], v[192:195], a[104:107]
ds_read_b128 a[204:207], v3 offset:31744
v_cvt_pk_bf16_f32 v212, v144, v145
v_mfma_f32_16x16x32_bf16 a[108:111], a[168:171], v[192:195], a[108:111]
s_add_u32 s70, s70, 32768
v_xor_b32 v2, 0x8000, v2
v_exp_f32 v146, v146
v_mfma_f32_16x16x32_bf16 a[108:111], a[172:175], v[196:199], a[108:111]
s_waitcnt vmcnt(8)
s_barrier
v_mfma_f32_16x16x32_bf16 a[76:79], a[172:175], v[188:191], a[76:79]
s_mov_b32 m0, s71
v_exp_f32 v147, v147
v_mfma_f32_16x16x32_bf16 a[76:79], a[168:171], v[184:187], a[76:79]
s_waitcnt lgkmcnt(1)
ds_read_b128 a[144:147], v2 offset:0
v_cvt_pk_bf16_f32 v213, v146, v147
v_mfma_f32_16x16x32_bf16 a[80:83], a[176:179], v[184:187], a[80:83]
v_exp_f32 v148, v148
v_mfma_f32_16x16x32_bf16 a[80:83], a[180:183], v[188:191], a[80:83]
ds_read_b128 a[148:151], v2 offset:1024
ds_read_b128 a[152:155], v2 offset:2048
v_mfma_f32_16x16x32_bf16 a[112:115], a[180:183], v[196:199], a[112:115]
v_exp_f32 v149, v149
v_mfma_f32_16x16x32_bf16 a[112:115], a[176:179], v[192:195], a[112:115]
ds_read_b128 a[156:159], v2 offset:3072
v_cvt_pk_bf16_f32 v214, v148, v149
v_mfma_f32_16x16x32_bf16 a[116:119], a[184:187], v[192:195], a[116:119]
v_exp_f32 v150, v150
v_mfma_f32_16x16x32_bf16 a[116:119], a[188:191], v[196:199], a[116:119]
buffer_load_dwordx4 v16, s[32:35], s70 offen offset:0 sc1 lds
v_mfma_f32_16x16x32_bf16 a[84:87], a[188:191], v[188:191], a[84:87]
s_sub_u32 s72, s72, 1
v_exp_f32 v151, v151
v_mfma_f32_16x16x32_bf16 a[84:87], a[184:187], v[184:187], a[84:87]
ds_read_b128 a[160:163], v2 offset:4096
v_cvt_pk_bf16_f32 v215, v150, v151
v_mfma_f32_16x16x32_bf16 a[88:91], a[192:195], v[184:187], a[88:91]
v_exp_f32 v132, v132
v_mfma_f32_16x16x32_bf16 a[88:91], a[196:199], v[188:191], a[88:91]
ds_read_b128 a[164:167], v2 offset:5120
v_xor_b32 v3, 0x8000, v3
v_mfma_f32_16x16x32_bf16 a[120:123], a[196:199], v[196:199], a[120:123]
s_cmp_lg_u32 s72, 0
v_exp_f32 v133, v133
v_mfma_f32_16x16x32_bf16 a[120:123], a[192:195], v[192:195], a[120:123]
ds_read_b128 a[168:171], v2 offset:6144
v_cvt_pk_bf16_f32 v206, v132, v133
v_mfma_f32_16x16x32_bf16 a[124:127], a[200:203], v[192:195], a[124:127]
s_waitcnt lgkmcnt(3)
v_exp_f32 v134, v134
v_mfma_f32_16x16x32_bf16 a[124:127], a[204:207], v[196:199], a[124:127]
buffer_load_dwordx4 v16, s[32:35], s70 offen offset:1024 sc1 lds
v_mfma_f32_16x16x32_bf16 a[92:95], a[204:207], v[188:191], a[92:95]
v_exp_f32 v135, v135
v_mfma_f32_16x16x32_bf16 a[92:95], a[200:203], v[184:187], a[92:95]
ds_read_b128 a[172:175], v2 offset:7168
v_cvt_pk_bf16_f32 v207, v134, v135
s_cbranch_scc1 L_S
L_SD:
buffer_load_dword v19, off, s[52:55], s80 sc1
s_waitcnt lgkmcnt(7)
v_mfma_f32_16x16x32_bf16 v[136:139], a[144:147], v[72:75], v[228:231]
s_waitcnt lgkmcnt(6)
ds_read_b128 a[176:179], v2 offset:8192
ds_read_b128 a[180:183], v2 offset:9216
v_mfma_f32_16x16x32_bf16 v[136:139], a[148:151], v[76:79], v[136:139]
s_waitcnt lgkmcnt(7)
buffer_load_dwordx4 v16, s[32:35], s70 offen offset:2048 sc1 lds
v_cndmask_b32 v120, v224, v17, s[0:1]
v_cndmask_b32 v121, v224, v17, s[4:5]
v_cndmask_b32 v122, v224, v17, s[6:7]
v_cndmask_b32 v123, v224, v17, s[8:9]
v_mfma_f32_16x16x32_bf16 v[136:139], a[152:155], v[80:83], v[136:139]
s_waitcnt lgkmcnt(6)
s_add_u32 s64, s70, 4096
ds_read_b128 a[184:187], v2 offset:10240
ds_read_b128 a[188:191], v2 offset:11264
v_mfma_f32_16x16x32_bf16 v[136:139], a[156:159], v[84:87], v[136:139]
buffer_load_dwordx4 v16, s[32:35], s70 offen offset:3072 sc1 lds
v_mfma_f32_16x16x32_bf16 v[120:123], a[156:159], v[68:71], v[120:123]
s_add_u32 m0, s71, 4096
ds_read_b128 a[192:195], v2 offset:12288
ds_read_b128 a[196:199], v2 offset:13312
v_mfma_f32_16x16x32_bf16 v[120:123], a[152:155], v[64:67], v[120:123]
buffer_load_dwordx4 v16, s[32:35], s64 offen offset:0 sc1 lds
v_mfma_f32_16x16x32_bf16 v[120:123], a[148:151], v[60:63], v[120:123]
ds_read_b128 a[200:203], v2 offset:14336
ds_read_b128 a[204:207], v2 offset:15360
v_mfma_f32_16x16x32_bf16 v[120:123], a[144:147], v[56:59], v[120:123]
s_waitcnt lgkmcnt(6)
v_exp_f32 v136, v136
v_mfma_f32_16x16x32_bf16 v[140:143], a[160:163], v[72:75], v[228:231]
v_exp_f32 v137, v137
v_mfma_f32_16x16x32_bf16 v[140:143], a[164:167], v[76:79], v[140:143]
v_cndmask_b32 v124, v224, v17, s[10:11]
v_cndmask_b32 v125, v224, v17, s[12:13]
v_cndmask_b32 v126, v224, v17, s[18:19]
v_cndmask_b32 v127, v224, v17, s[22:23]
v_exp_f32 v138, v138
v_mfma_f32_16x16x32_bf16 v[140:143], a[168:171], v[80:83], v[140:143]
v_exp_f32 v139, v139
v_mfma_f32_16x16x32_bf16 v[140:143], a[172:175], v[84:87], v[140:143]
v_exp_f32 v120, v120
v_mfma_f32_16x16x32_bf16 v[124:127], a[172:175], v[68:71], v[124:127]
ds_read_b128 a[144:147], v3 offset:0
v_cvt_pk_bf16_f32 v192, v136, v137
v_mfma_f32_16x16x32_bf16 v[124:127], a[168:171], v[64:67], v[124:127]
v_cndmask_b32 v128, v224, v17, s[26:27]
v_cndmask_b32 v129, v224, v17, s[56:57]
v_cndmask_b32 v130, v224, v17, s[58:59]
v_cndmask_b32 v131, v224, v17, s[60:61]
v_exp_f32 v121, v121
v_mfma_f32_16x16x32_bf16 v[124:127], a[164:167], v[60:63], v[124:127]
s_mul_i32 s69, s83, 8
ds_read_b128 a[148:151], v3 offset:8192
v_cvt_pk_bf16_f32 v193, v138, v139
v_mfma_f32_16x16x32_bf16 v[124:127], a[160:163], v[56:59], v[124:127]
s_sub_u32 s69, 36, s69
v_exp_f32 v122, v122
v_mfma_f32_16x16x32_bf16 v[128:131], a[176:179], v[56:59], v[128:131]
ds_read_b128 a[152:155], v3 offset:1024
v_cvt_pk_bf16_f32 v184, v120, v121
v_mfma_f32_16x16x32_bf16 v[128:131], a[180:183], v[60:63], v[128:131]
s_waitcnt lgkmcnt(3)
v_exp_f32 v123, v123
v_mfma_f32_16x16x32_bf16 v[128:131], a[184:187], v[64:67], v[128:131]
ds_read_b128 a[156:159], v3 offset:9216
v_cvt_pk_bf16_f32 v185, v122, v123
v_mfma_f32_16x16x32_bf16 v[128:131], a[188:191], v[68:71], v[128:131]
v_exp_f32 v140, v140
v_mfma_f32_16x16x32_bf16 v[144:147], a[188:191], v[84:87], v[228:231]
buffer_load_dwordx4 v16, s[32:35], s64 offen offset:1024 sc1 lds
v_mfma_f32_16x16x32_bf16 v[144:147], a[184:187], v[80:83], v[144:147]
v_exp_f32 v141, v141
v_mfma_f32_16x16x32_bf16 v[144:147], a[180:183], v[76:79], v[144:147]
ds_read_b128 a[160:163], v3 offset:2048
v_cvt_pk_bf16_f32 v194, v140, v141
v_mfma_f32_16x16x32_bf16 v[144:147], a[176:179], v[72:75], v[144:147]
v_exp_f32 v142, v142
v_mfma_f32_16x16x32_bf16 v[148:151], a[192:195], v[72:75], v[228:231]
ds_read_b128 a[164:167], v3 offset:10240
ds_read_b128 a[168:171], v3 offset:3072
v_mfma_f32_16x16x32_bf16 v[148:151], a[196:199], v[76:79], v[148:151]
v_cndmask_b32 v132, v224, v17, s[62:63]
v_cndmask_b32 v133, v224, v17, s[48:49]
v_cndmask_b32 v134, v224, v17, s[50:51]
v_cndmask_b32 v135, v224, v17, s[100:101]
v_exp_f32 v143, v143
v_mfma_f32_16x16x32_bf16 v[148:151], a[200:203], v[80:83], v[148:151]
ds_read_b128 a[172:175], v3 offset:11264
v_cvt_pk_bf16_f32 v195, v142, v143
v_mfma_f32_16x16x32_bf16 v[148:151], a[204:207], v[84:87], v[148:151]
v_exp_f32 v124, v124
v_mfma_f32_16x16x32_bf16 v[132:135], a[204:207], v[68:71], v[132:135]
ds_read_b128 a[176:179], v3 offset:4096
buffer_load_dwordx4 v16, s[32:35], s64 offen offset:2048 sc1 lds
v_mfma_f32_16x16x32_bf16 v[132:135], a[200:203], v[64:67], v[132:135]
s_branch L_po20
L_pg20:
s_branch L_pg25
L_po20:
v_exp_f32 v125, v125
v_mfma_f32_16x16x32_bf16 v[132:135], a[196:199], v[60:63], v[132:135]
ds_read_b128 a[180:183], v3 offset:12288
v_cvt_pk_bf16_f32 v186, v124, v125
v_mfma_f32_16x16x32_bf16 v[132:135], a[192:195], v[56:59], v[132:135]
v_exp_f32 v126, v126
v_smfmac_f32_16x16x64_bf16 a[136:139], a[240:243], v[200:207], v5
ds_read_b128 a[184:187], v3 offset:5120
v_smfmac_f32_16x16x64_bf16 a[140:143], a[240:243], v[208:215], v5
s_waitcnt lgkmcnt(3)
ds_read_b128 a[188:191], v3 offset:13312
v_mfma_f32_16x16x32_bf16 a[64:67], a[144:147], v[200:203], a[64:67]
v_exp_f32 v127, v127
v_mfma_f32_16x16x32_bf16 a[64:67], a[148:151], v[204:207], a[64:67]
v_exp_f32 v128, v128
v_mfma_f32_16x16x32_bf16 a[96:99], a[148:151], v[212:215], a[96:99]
v_exp_f32 v129, v129
v_mfma_f32_16x16x32_bf16 a[96:99], a[144:147], v[208:211], a[96:99]
ds_read_b128 a[192:195], v3 offset:6144
v_cvt_pk_bf16_f32 v187, v126, v127
v_mfma_f32_16x16x32_bf16 a[100:103], a[152:155], v[208:211], a[100:103]
v_exp_f32 v130, v130
v_mfma_f32_16x16x32_bf16 a[100:103], a[156:159], v[212:215], a[100:103]
ds_read_b128 a[196:199], v3 offset:14336
v_cvt_pk_bf16_f32 v188, v128, v129
v_mfma_f32_16x16x32_bf16 a[68:71], a[156:159], v[204:207], a[68:71]
v_exp_f32 v131, v131
v_mfma_f32_16x16x32_bf16 a[68:71], a[152:155], v[200:203], a[68:71]
ds_read_b128 a[200:203], v3 offset:7168
v_cvt_pk_bf16_f32 v189, v130, v131
v_mfma_f32_16x16x32_bf16 a[72:75], a[160:163], v[200:203], a[72:75]
v_exp_f32 v144, v144
v_mfma_f32_16x16x32_bf16 a[72:75], a[164:167], v[204:207], a[72:75]
buffer_load_dwordx4 v16, s[32:35], s64 offen offset:3072 sc1 lds
v_mfma_f32_16x16x32_bf16 a[104:107], a[164:167], v[212:215], a[104:107]
v_exp_f32 v145, v145
v_mfma_f32_16x16x32_bf16 a[104:107], a[160:163], v[208:211], a[104:107]
ds_read_b128 a[204:207], v3 offset:15360
v_cvt_pk_bf16_f32 v196, v144, v145
v_mfma_f32_16x16x32_bf16 a[108:111], a[168:171], v[208:211], a[108:111]
v_exp_f32 v146, v146
v_mfma_f32_16x16x32_bf16 a[108:111], a[172:175], v[212:215], a[108:111]
s_waitcnt vmcnt(9)
s_barrier
v_mfma_f32_16x16x32_bf16 a[76:79], a[172:175], v[204:207], a[76:79]
v_exp_f32 v147, v147
v_mfma_f32_16x16x32_bf16 a[76:79], a[168:171], v[200:203], a[76:79]
s_waitcnt lgkmcnt(1)
ds_read_b128 a[144:147], v2 offset:16384
v_cvt_pk_bf16_f32 v197, v146, v147
v_mfma_f32_16x16x32_bf16 a[80:83], a[176:179], v[200:203], a[80:83]
s_waitcnt vmcnt(6)
v_readfirstlane_b32 vcc_lo, v19
s_nop 0
s_cmp_lt_u32 vcc_lo, s69
s_cbranch_scc1 L_spin_8
L_spinbk_9:
v_exp_f32 v148, v148
v_mfma_f32_16x16x32_bf16 a[80:83], a[180:183], v[204:207], a[80:83]
ds_read_b128 a[148:151], v2 offset:17408
ds_read_b128 a[152:155], v2 offset:18432
v_mfma_f32_16x16x32_bf16 a[112:115], a[180:183], v[212:215], a[112:115]
v_exp_f32 v149, v149
v_mfma_f32_16x16x32_bf16 a[112:115], a[176:179], v[208:211], a[112:115]
ds_read_b128 a[156:159], v2 offset:19456
v_cvt_pk_bf16_f32 v198, v148, v149
v_mfma_f32_16x16x32_bf16 a[116:119], a[184:187], v[208:211], a[116:119]
v_exp_f32 v150, v150
v_mfma_f32_16x16x32_bf16 a[116:119], a[188:191], v[212:215], a[116:119]
v_cndmask_b32 v136, v228, v17, s[0:1]
v_cndmask_b32 v137, v228, v17, s[4:5]
v_mfma_f32_16x16x32_bf16 a[84:87], a[188:191], v[204:207], a[84:87]
v_exp_f32 v151, v151
v_mfma_f32_16x16x32_bf16 a[84:87], a[184:187], v[200:203], a[84:87]
ds_read_b128 a[160:163], v2 offset:20480
v_cvt_pk_bf16_f32 v199, v150, v151
v_mfma_f32_16x16x32_bf16 a[88:91], a[192:195], v[200:203], a[88:91]
v_exp_f32 v132, v132
v_mfma_f32_16x16x32_bf16 a[88:91], a[196:199], v[204:207], a[88:91]
ds_read_b128 a[164:167], v2 offset:21504
v_cndmask_b32 v138, v228, v17, s[6:7]
v_mfma_f32_16x16x32_bf16 a[120:123], a[196:199], v[212:215], a[120:123]
v_exp_f32 v133, v133
v_mfma_f32_16x16x32_bf16 a[120:123], a[192:195], v[208:211], a[120:123]
ds_read_b128 a[168:171], v2 offset:22528
v_cvt_pk_bf16_f32 v190, v132, v133
v_mfma_f32_16x16x32_bf16 a[124:127], a[200:203], v[208:211], a[124:127]
s_waitcnt lgkmcnt(3)
v_exp_f32 v134, v134
v_mfma_f32_16x16x32_bf16 a[124:127], a[204:207], v[212:215], a[124:127]
v_cndmask_b32 v139, v228, v17, s[8:9]
v_cndmask_b32 v140, v228, v17, s[10:11]
v_mfma_f32_16x16x32_bf16 a[92:95], a[204:207], v[204:207], a[92:95]
v_exp_f32 v135, v135
v_mfma_f32_16x16x32_bf16 a[92:95], a[200:203], v[200:203], a[92:95]
ds_read_b128 a[172:175], v2 offset:23552
v_cvt_pk_bf16_f32 v191, v134, v135
v_mfma_f32_16x16x32_bf16 v[136:139], a[144:147], v[72:75], v[136:139]
ds_read_b128 a[176:179], v2 offset:24576
v_cndmask_b32 v141, v228, v17, s[12:13]
v_mfma_f32_16x16x32_bf16 v[136:139], a[148:151], v[76:79], v[136:139]
ds_read_b128 a[180:183], v2 offset:25600
v_cndmask_b32 v142, v228, v17, s[18:19]
v_cndmask_b32 v143, v228, v17, s[22:23]
v_mfma_f32_16x16x32_bf16 v[136:139], a[152:155], v[80:83], v[136:139]
ds_read_b128 a[184:187], v2 offset:26624
v_cndmask_b32 v144, v228, v17, s[26:27]
v_mfma_f32_16x16x32_bf16 v[136:139], a[156:159], v[84:87], v[136:139]
s_waitcnt lgkmcnt(3)
ds_read_b128 a[188:191], v2 offset:27648
v_cndmask_b32 v145, v228, v17, s[56:57]
v_mfma_f32_16x16x32_bf16 v[140:143], a[172:175], v[84:87], v[140:143]
ds_read_b128 a[192:195], v2 offset:28672
ds_read_b128 a[196:199], v2 offset:29696
ds_read_b128 a[200:203], v2 offset:30720
ds_read_b128 a[204:207], v2 offset:31744
v_mfma_f32_16x16x32_bf16 v[140:143], a[168:171], v[80:83], v[140:143]
ds_read_b128 a[144:147], v3 offset:16384
v_cndmask_b32 v146, v228, v17, s[58:59]
v_cndmask_b32 v147, v228, v17, s[60:61]
v_mfma_f32_16x16x32_bf16 v[140:143], a[164:167], v[76:79], v[140:143]
ds_read_b128 a[148:151], v3 offset:24576
v_cndmask_b32 v148, v228, v17, s[62:63]
v_mfma_f32_16x16x32_bf16 v[140:143], a[160:163], v[72:75], v[140:143]
s_waitcnt lgkmcnt(8)
ds_read_b128 a[152:155], v3 offset:17408
v_cndmask_b32 v149, v228, v17, s[48:49]
v_mfma_f32_16x16x32_bf16 v[144:147], a[176:179], v[72:75], v[144:147]
ds_read_b128 a[156:159], v3 offset:25600
v_cndmask_b32 v150, v228, v17, s[50:51]
v_mfma_f32_16x16x32_bf16 v[144:147], a[180:183], v[76:79], v[144:147]
s_waitcnt lgkmcnt(8)
ds_read_b128 a[160:163], v3 offset:18432
v_cndmask_b32 v151, v228, v17, s[100:101]
v_mfma_f32_16x16x32_bf16 v[144:147], a[184:187], v[80:83], v[144:147]
v_exp_f32 v136, v136
v_mfma_f32_16x16x32_bf16 v[144:147], a[188:191], v[84:87], v[144:147]
s_waitcnt lgkmcnt(4)
v_exp_f32 v137, v137
v_mfma_f32_16x16x32_bf16 v[148:151], a[204:207], v[84:87], v[148:151]
v_exp_f32 v138, v138
v_mfma_f32_16x16x32_bf16 v[148:151], a[200:203], v[80:83], v[148:151]
s_add_u32 s65, s84, 0
v_exp_f32 v139, v139
v_mfma_f32_16x16x32_bf16 v[148:151], a[196:199], v[76:79], v[148:151]
buffer_load_dwordx4 a[208:211], v14, s[44:47], s65 offen offset:0 sc1
v_mfma_f32_16x16x32_bf16 v[148:151], a[192:195], v[72:75], v[148:151]
ds_read_b128 a[164:167], v3 offset:26624
v_cvt_pk_bf16_f32 v208, v136, v137
v_smfmac_f32_16x16x64_bf16 a[136:139], a[240:243], v[184:191], v5
ds_read_b128 a[168:171], v3 offset:19456
v_smfmac_f32_16x16x64_bf16 a[140:143], a[240:243], v[192:199], v5
ds_read_b128 a[172:175], v3 offset:27648
v_mfma_f32_16x16x32_bf16 a[64:67], a[144:147], v[184:187], a[64:67]
s_waitcnt lgkmcnt(3)
v_exp_f32 v140, v140
v_mfma_f32_16x16x32_bf16 a[64:67], a[148:151], v[188:191], a[64:67]
buffer_load_dwordx4 a[216:219], v14, s[44:47], s65 offen offset:1024 sc1
v_mfma_f32_16x16x32_bf16 a[96:99], a[148:151], v[196:199], a[96:99]
v_exp_f32 v141, v141
v_mfma_f32_16x16x32_bf16 a[96:99], a[144:147], v[192:195], a[96:99]
buffer_load_dwordx4 a[224:227], v15, s[44:47], s65 offen offset:0 sc1
v_mfma_f32_16x16x32_bf16 a[100:103], a[152:155], v[192:195], a[100:103]
v_exp_f32 v142, v142
v_mfma_f32_16x16x32_bf16 a[100:103], a[156:159], v[196:199], a[100:103]
buffer_load_dwordx4 a[232:235], v15, s[44:47], s65 offen offset:1024 sc1
v_mfma_f32_16x16x32_bf16 a[68:71], a[156:159], v[188:191], a[68:71]
s_add_u32 s65, s84, 8192
ds_read_b128 a[176:179], v3 offset:20480
v_cvt_pk_bf16_f32 v209, v138, v139
v_mfma_f32_16x16x32_bf16 a[68:71], a[152:155], v[184:187], a[68:71]
buffer_load_dwordx4 a[212:215], v14, s[44:47], s65 offen offset:0 sc1
v_mfma_f32_16x16x32_bf16 a[72:75], a[160:163], v[184:187], a[72:75]
s_waitcnt lgkmcnt(1)
ds_read_b128 a[180:183], v3 offset:28672
v_cvt_pk_bf16_f32 v210, v140, v141
v_mfma_f32_16x16x32_bf16 a[72:75], a[164:167], v[188:191], a[72:75]
v_exp_f32 v143, v143
v_mfma_f32_16x16x32_bf16 a[104:107], a[164:167], v[196:199], a[104:107]
buffer_load_dwordx4 a[220:223], v14, s[44:47], s65 offen offset:1024 sc1
v_mfma_f32_16x16x32_bf16 a[104:107], a[160:163], v[192:195], a[104:107]
v_exp_f32 v144, v144
v_mfma_f32_16x16x32_bf16 a[108:111], a[168:171], v[192:195], a[108:111]
ds_read_b128 a[184:187], v3 offset:21504
v_xor_b32 v2, 0x8000, v2
v_mfma_f32_16x16x32_bf16 a[108:111], a[172:175], v[196:199], a[108:111]
buffer_load_dwordx4 a[228:231], v15, s[44:47], s65 offen offset:0 sc1
ds_read_b128 a[188:191], v3 offset:29696
v_mfma_f32_16x16x32_bf16 a[76:79], a[172:175], v[188:191], a[76:79]
v_exp_f32 v145, v145
v_mfma_f32_16x16x32_bf16 a[76:79], a[168:171], v[184:187], a[76:79]
s_waitcnt lgkmcnt(2)
buffer_load_dwordx4 a[236:239], v15, s[44:47], s65 offen offset:1024 sc1
v_mfma_f32_16x16x32_bf16 a[80:83], a[176:179], v[184:187], a[80:83]
s_add_u32 s65, s84, 32768
ds_read_b128 a[192:195], v3 offset:22528
v_cvt_pk_bf16_f32 v211, v142, v143
v_mfma_f32_16x16x32_bf16 a[80:83], a[180:183], v[188:191], a[80:83]
buffer_load_dwordx4 v[152:155], v14, s[44:47], s65 offen offset:0 sc1
ds_read_b128 a[196:199], v3 offset:30720
v_exp_f32 v146, v146
v_mfma_f32_16x16x32_bf16 a[112:115], a[180:183], v[196:199], a[112:115]
ds_read_b128 a[200:203], v3 offset:23552
ds_read_b128 a[204:207], v3 offset:31744
v_mfma_f32_16x16x32_bf16 a[112:115], a[176:179], v[192:195], a[112:115]
s_waitcnt vmcnt(9)
s_barrier
v_xor_b32 v3, 0x8000, v3
buffer_load_dwordx4 v[160:163], v14, s[44:47], s65 offen offset:1024 sc1
s_waitcnt lgkmcnt(4)
v_mfma_f32_16x16x32_bf16 a[116:119], a[184:187], v[192:195], a[116:119]
v_exp_f32 v147, v147
v_mfma_f32_16x16x32_bf16 a[116:119], a[188:191], v[196:199], a[116:119]
buffer_load_dwordx4 v[168:171], v15, s[44:47], s65 offen offset:0 sc1
v_mfma_f32_16x16x32_bf16 a[84:87], a[188:191], v[188:191], a[84:87]
v_exp_f32 v148, v148
v_mfma_f32_16x16x32_bf16 a[84:87], a[184:187], v[184:187], a[84:87]
s_waitcnt lgkmcnt(2)
buffer_load_dwordx4 v[176:179], v15, s[44:47], s65 offen offset:1024 sc1
v_cvt_pk_bf16_f32 v212, v144, v145
v_mfma_f32_16x16x32_bf16 a[88:91], a[192:195], v[184:187], a[88:91]
s_add_u32 s65, s84, 40960
v_exp_f32 v149, v149
v_mfma_f32_16x16x32_bf16 a[88:91], a[196:199], v[188:191], a[88:91]
buffer_load_dwordx4 v[156:159], v14, s[44:47], s65 offen offset:0 sc1
v_mfma_f32_16x16x32_bf16 a[120:123], a[196:199], v[196:199], a[120:123]
ds_read_b128 a[144:147], v3 offset:0
v_cvt_pk_bf16_f32 v213, v146, v147
v_mfma_f32_16x16x32_bf16 a[120:123], a[192:195], v[192:195], a[120:123]
s_waitcnt lgkmcnt(1)
buffer_load_dwordx4 v[164:167], v14, s[44:47], s65 offen offset:1024 sc1
ds_read_b128 a[148:151], v3 offset:8192
v_exp_f32 v150, v150
v_mfma_f32_16x16x32_bf16 a[124:127], a[200:203], v[192:195], a[124:127]
ds_read_b128 a[152:155], v3 offset:1024
v_cvt_pk_bf16_f32 v214, v148, v149
v_mfma_f32_16x16x32_bf16 a[124:127], a[204:207], v[196:199], a[124:127]
buffer_load_dwordx4 v[172:175], v15, s[44:47], s65 offen offset:0 sc1
ds_read_b128 a[156:159], v3 offset:9216
v_mfma_f32_16x16x32_bf16 a[92:95], a[204:207], v[188:191], a[92:95]
v_exp_f32 v151, v151
v_mfma_f32_16x16x32_bf16 a[92:95], a[200:203], v[184:187], a[92:95]
buffer_load_dwordx4 v[180:183], v15, s[44:47], s65 offen offset:1024 sc1
ds_read_b128 a[160:163], v3 offset:2048
ds_read_b128 a[164:167], v3 offset:10240
ds_read_b128 a[168:171], v3 offset:3072
ds_read_b128 a[172:175], v3 offset:11264
v_cvt_pk_bf16_f32 v215, v150, v151
v_accvgpr_read_b32 v22, a136
v_accvgpr_read_b32 v248, a137
v_add_f32 v22, v22, v248
v_max_f32 v1, v1, v22
v_rcp_f32 v22, v22
v_accvgpr_read_b32 v232, a64
v_accvgpr_read_b32 v233, a65
v_accvgpr_read_b32 v234, a66
v_accvgpr_read_b32 v235, a67
v_accvgpr_read_b32 v236, a68
v_accvgpr_read_b32 v237, a69
v_accvgpr_read_b32 v238, a70
v_accvgpr_read_b32 v239, a71
v_mul_f32 v22, v22, v8
v_mul_f32 v232, v232, v22
v_mul_f32 v233, v233, v22
v_mul_f32 v234, v234, v22
v_mul_f32 v235, v235, v22
v_mul_f32 v236, v236, v22
v_mul_f32 v237, v237, v22
v_mul_f32 v238, v238, v22
v_mul_f32 v239, v239, v22
v_cvt_pk_bf16_f32 v232, v232, v233
v_cvt_pk_bf16_f32 v233, v234, v235
v_cvt_pk_bf16_f32 v234, v236, v237
v_cvt_pk_bf16_f32 v235, v238, v239
s_add_u32 s77, s75, 0
buffer_store_dwordx4 v[232:235], v16, s[44:47], s77 offen sc1
s_branch L_po21
L_pg21:
s_branch L_tr4
L_po21:
L_TAIL:
ds_read_b128 a[176:179], v3 offset:4096
ds_read_b128 a[180:183], v3 offset:12288
ds_read_b128 a[184:187], v3 offset:5120
ds_read_b128 a[188:191], v3 offset:13312
v_smfmac_f32_16x16x64_bf16 a[140:143], a[240:243], v[208:215], v5
s_waitcnt lgkmcnt(11)
s_add_u32 m0, s86, 32768
s_add_u32 s64, s85, 262144
ds_read_b128 a[192:195], v3 offset:6144
v_mfma_f32_16x16x32_bf16 a[96:99], a[144:147], v[208:211], a[96:99]
s_waitcnt lgkmcnt(11)
ds_read_b128 a[196:199], v3 offset:14336
ds_read_b128 a[200:203], v3 offset:7168
ds_read_b128 a[204:207], v3 offset:15360
v_mfma_f32_16x16x32_bf16 a[96:99], a[148:151], v[212:215], a[96:99]
s_waitcnt lgkmcnt(12)
buffer_load_dwordx4 v12, s[36:39], s64 offen lds
v_mfma_f32_16x16x32_bf16 a[100:103], a[156:159], v[212:215], a[100:103]
s_add_u32 m0, s86, 33792
s_add_u32 s64, s85, 270336
v_accvgpr_read_b32 v240, a72
v_accvgpr_read_b32 v241, a73
v_mfma_f32_16x16x32_bf16 a[100:103], a[152:155], v[208:211], a[100:103]
s_waitcnt lgkmcnt(11)
buffer_load_dwordx4 v13, s[36:39], s64 offen lds
v_mfma_f32_16x16x32_bf16 a[104:107], a[160:163], v[208:211], a[104:107]
s_waitcnt lgkmcnt(10)
s_add_u32 m0, s86, 34816
s_add_u32 s64, s85, 278528
v_accvgpr_read_b32 v242, a74
v_accvgpr_read_b32 v243, a75
v_mfma_f32_16x16x32_bf16 a[104:107], a[164:167], v[212:215], a[104:107]
s_waitcnt lgkmcnt(8)
buffer_load_dwordx4 v12, s[36:39], s64 offen lds
v_mfma_f32_16x16x32_bf16 a[108:111], a[172:175], v[212:215], a[108:111]
s_add_u32 m0, s86, 35840
s_add_u32 s64, s85, 286720
v_accvgpr_read_b32 v244, a76
v_accvgpr_read_b32 v245, a77
v_mfma_f32_16x16x32_bf16 a[108:111], a[168:171], v[208:211], a[108:111]
s_waitcnt lgkmcnt(7)
buffer_load_dwordx4 v13, s[36:39], s64 offen lds
v_mfma_f32_16x16x32_bf16 a[112:115], a[176:179], v[208:211], a[112:115]
s_waitcnt lgkmcnt(6)
s_add_u32 m0, s86, 36864
s_add_u32 s64, s85, 294912
v_accvgpr_read_b32 v246, a78
v_accvgpr_read_b32 v247, a79
v_mfma_f32_16x16x32_bf16 a[112:115], a[180:183], v[212:215], a[112:115]
s_waitcnt lgkmcnt(4)
buffer_load_dwordx4 v12, s[36:39], s64 offen lds
v_mfma_f32_16x16x32_bf16 a[116:119], a[188:191], v[212:215], a[116:119]
s_add_u32 m0, s86, 37888
s_add_u32 s64, s85, 303104
v_mul_f32 v240, v240, v22
v_mul_f32 v241, v241, v22
v_mfma_f32_16x16x32_bf16 a[116:119], a[184:187], v[208:211], a[116:119]
s_waitcnt lgkmcnt(3)
buffer_load_dwordx4 v13, s[36:39], s64 offen lds
v_mfma_f32_16x16x32_bf16 a[120:123], a[192:195], v[208:211], a[120:123]
s_waitcnt lgkmcnt(2)
s_add_u32 m0, s86, 38912
s_add_u32 s64, s85, 311296
v_mul_f32 v242, v242, v22
v_mul_f32 v243, v243, v22
v_mfma_f32_16x16x32_bf16 a[120:123], a[196:199], v[212:215], a[120:123]
s_waitcnt lgkmcnt(0)
buffer_load_dwordx4 v12, s[36:39], s64 offen lds
v_mfma_f32_16x16x32_bf16 a[124:127], a[204:207], v[212:215], a[124:127]
s_add_u32 m0, s86, 39936
s_add_u32 s64, s85, 319488
v_mul_f32 v244, v244, v22
v_mul_f32 v245, v245, v22
v_mfma_f32_16x16x32_bf16 a[124:127], a[200:203], v[208:211], a[124:127]
buffer_load_dwordx4 v13, s[36:39], s64 offen lds
v_mul_f32 v246, v246, v22
v_mul_f32 v247, v247, v22
v_cvt_pk_bf16_f32 v240, v240, v241
v_cvt_pk_bf16_f32 v241, v242, v243
v_cvt_pk_bf16_f32 v242, v244, v245
v_cvt_pk_bf16_f32 v243, v246, v247
s_add_u32 s77, s75, 8192
buffer_store_dwordx4 v[240:243], v16, s[44:47], s77 offen sc1
v_accvgpr_read_b32 v23, a140
v_accvgpr_read_b32 v248, a141
v_add_f32 v23, v23, v248
v_max_f32 v1, v1, v23
v_rcp_f32 v23, v23
s_mov_b32 s66, 0x5d800000
v_cmp_le_f32 vcc, s66, v1
s_lshl_b32 s67, s30, 2
s_cmp_lg_u64 vcc, 0
s_cselect_b32 s66, 1, 0
v_mov_b32 v248, s67
v_mov_b32 v249, s66
ds_write_b32 v248, v249
v_accvgpr_read_b32 v232, a80
v_accvgpr_read_b32 v233, a81
v_accvgpr_read_b32 v234, a82
v_accvgpr_read_b32 v235, a83
v_accvgpr_read_b32 v236, a84
v_accvgpr_read_b32 v237, a85
v_accvgpr_read_b32 v238, a86
v_accvgpr_read_b32 v239, a87
v_pk_mul_f32 v[232:233], v[232:233], v[22:23] op_sel_hi:[1,0]
v_pk_mul_f32 v[234:235], v[234:235], v[22:23] op_sel_hi:[1,0]
v_pk_mul_f32 v[236:237], v[236:237], v[22:23] op_sel_hi:[1,0]
v_pk_mul_f32 v[238:239], v[238:239], v[22:23] op_sel_hi:[1,0]
v_cvt_pk_bf16_f32 v232, v232, v233
v_cvt_pk_bf16_f32 v233, v234, v235
v_cvt_pk_bf16_f32 v234, v236, v237
v_cvt_pk_bf16_f32 v235, v238, v239
s_add_u32 s77, s75, 16384
buffer_store_dwordx4 v[232:235], v16, s[44:47], s77 offen sc1
v_accvgpr_read_b32 v240, a88
v_accvgpr_read_b32 v241, a89
v_accvgpr_read_b32 v242, a90
v_accvgpr_read_b32 v243, a91
v_accvgpr_read_b32 v244, a92
v_accvgpr_read_b32 v245, a93
v_accvgpr_read_b32 v246, a94
v_accvgpr_read_b32 v247, a95
v_pk_mul_f32 v[240:241], v[240:241], v[22:23] op_sel_hi:[1,0]
v_pk_mul_f32 v[242:243], v[242:243], v[22:23] op_sel_hi:[1,0]
v_pk_mul_f32 v[244:245], v[244:245], v[22:23] op_sel_hi:[1,0]
v_pk_mul_f32 v[246:247], v[246:247], v[22:23] op_sel_hi:[1,0]
v_cvt_pk_bf16_f32 v240, v240, v241
v_cvt_pk_bf16_f32 v241, v242, v243
v_cvt_pk_bf16_f32 v242, v244, v245
v_cvt_pk_bf16_f32 v243, v246, v247
s_add_u32 s77, s75, 24576
buffer_store_dwordx4 v[240:243], v16, s[44:47], s77 offen sc1
v_accvgpr_read_b32 v232, a96
v_accvgpr_read_b32 v233, a97
v_accvgpr_read_b32 v234, a98
v_accvgpr_read_b32 v235, a99
v_accvgpr_read_b32 v236, a100
v_accvgpr_read_b32 v237, a101
v_accvgpr_read_b32 v238, a102
v_accvgpr_read_b32 v239, a103
v_mul_f32 v23, v23, v10
v_pk_mul_f32 v[232:233], v[232:233], v[22:23] op_sel:[0,1]
v_pk_mul_f32 v[234:235], v[234:235], v[22:23] op_sel:[0,1]
v_pk_mul_f32 v[236:237], v[236:237], v[22:23] op_sel:[0,1]
v_pk_mul_f32 v[238:239], v[238:239], v[22:23] op_sel:[0,1]
v_cvt_pk_bf16_f32 v232, v232, v233
v_cvt_pk_bf16_f32 v233, v234, v235
v_cvt_pk_bf16_f32 v234, v236, v237
v_cvt_pk_bf16_f32 v235, v238, v239
s_add_u32 s77, s75, 4096
buffer_store_dwordx4 v[232:235], v16, s[44:47], s77 offen sc1
v_accvgpr_read_b32 v240, a104
v_accvgpr_read_b32 v241, a105
v_accvgpr_read_b32 v242, a106
v_accvgpr_read_b32 v243, a107
v_accvgpr_read_b32 v244, a108
v_accvgpr_read_b32 v245, a109
v_accvgpr_read_b32 v246, a110
v_accvgpr_read_b32 v247, a111
v_pk_mul_f32 v[240:241], v[240:241], v[22:23] op_sel:[0,1]
v_pk_mul_f32 v[242:243], v[242:243], v[22:23] op_sel:[0,1]
v_pk_mul_f32 v[244:245], v[244:245], v[22:23] op_sel:[0,1]
v_pk_mul_f32 v[246:247], v[246:247], v[22:23] op_sel:[0,1]
v_cvt_pk_bf16_f32 v240, v240, v241
v_cvt_pk_bf16_f32 v241, v242, v243
v_cvt_pk_bf16_f32 v242, v244, v245
v_cvt_pk_bf16_f32 v243, v246, v247
s_add_u32 s77, s75, 12288
buffer_store_dwordx4 v[240:243], v16, s[44:47], s77 offen sc1
v_mov_b32 v248, 0
s_waitcnt lgkmcnt(0)
s_barrier
ds_read_b128 v[248:251], v248
v_xor_b32 v188, 128, v18
v_xor_b32 v189, 160, v18
v_xor_b32 v190, 192, v18
ds_read_b64_tr_b16 a[144:145], v188 offset:32768
ds_read_b64_tr_b16 a[146:147], v188 offset:36864
ds_read_b64_tr_b16 a[148:149], v188 offset:40960
ds_read_b64_tr_b16 a[150:151], v188 offset:45056
ds_read_b64_tr_b16 a[152:153], v189 offset:32768
ds_read_b64_tr_b16 a[154:155], v189 offset:36864
ds_read_b64_tr_b16 a[156:157], v189 offset:40960
ds_read_b64_tr_b16 a[158:159], v189 offset:45056
ds_read_b64_tr_b16 a[160:161], v190 offset:32768
ds_read_b64_tr_b16 a[162:163], v190 offset:36864
ds_read_b64_tr_b16 a[164:165], v190 offset:40960
ds_read_b64_tr_b16 a[166:167], v190 offset:45056
v_xor_b32 v191, 224, v18
v_xor_b32 v184, 0, v18
v_xor_b32 v185, 32, v18
v_xor_b32 v186, 64, v18
v_xor_b32 v187, 96, v18
v_accvgpr_read_b32 v232, a112
v_accvgpr_read_b32 v233, a113
v_accvgpr_read_b32 v234, a114
v_accvgpr_read_b32 v235, a115
v_accvgpr_read_b32 v236, a116
v_accvgpr_read_b32 v237, a117
v_accvgpr_read_b32 v238, a118
v_accvgpr_read_b32 v239, a119
v_pk_mul_f32 v[232:233], v[232:233], v[22:23] op_sel:[0,1]
v_pk_mul_f32 v[234:235], v[234:235], v[22:23] op_sel:[0,1]
v_pk_mul_f32 v[236:237], v[236:237], v[22:23] op_sel:[0,1]
v_pk_mul_f32 v[238:239], v[238:239], v[22:23] op_sel:[0,1]
v_cvt_pk_bf16_f32 v232, v232, v233
v_cvt_pk_bf16_f32 v233, v234, v235
v_cvt_pk_bf16_f32 v234, v236, v237
v_cvt_pk_bf16_f32 v235, v238, v239
s_add_u32 s77, s75, 20480
buffer_store_dwordx4 v[232:235], v16, s[44:47], s77 offen sc1
v_accvgpr_read_b32 v240, a120
v_accvgpr_read_b32 v241, a121
v_accvgpr_read_b32 v242, a122
v_accvgpr_read_b32 v243, a123
v_accvgpr_read_b32 v244, a124
v_accvgpr_read_b32 v245, a125
v_accvgpr_read_b32 v246, a126
v_accvgpr_read_b32 v247, a127
v_pk_mul_f32 v[240:241], v[240:241], v[22:23] op_sel:[0,1]
v_pk_mul_f32 v[242:243], v[242:243], v[22:23] op_sel:[0,1]
v_pk_mul_f32 v[244:245], v[244:245], v[22:23] op_sel:[0,1]
v_pk_mul_f32 v[246:247], v[246:247], v[22:23] op_sel:[0,1]
v_cvt_pk_bf16_f32 v240, v240, v241
v_cvt_pk_bf16_f32 v241, v242, v243
v_cvt_pk_bf16_f32 v242, v244, v245
v_cvt_pk_bf16_f32 v243, v246, v247
s_add_u32 s77, s75, 28672
buffer_store_dwordx4 v[240:243], v16, s[44:47], s77 offen sc1
s_waitcnt lgkmcnt(12)
v_or3_b32 v248, v248, v249, v250
v_or_b32 v248, v248, v251
s_nop 0
v_readfirstlane_b32 s66, v248
s_nop 0
s_cmp_gt_u32 s66, s73
s_cbranch_scc1 L_fallback_11
s_cmp_eq_u32 s83, 0
s_cbranch_scc1 L_p5f0
s_waitcnt lgkmcnt(10)
s_waitcnt vmcnt(28)
v_mfma_f32_16x16x32_bf16 v[136:139], a[144:147], a[232:235], 0
s_waitcnt vmcnt(24)
s_waitcnt lgkmcnt(8)
s_add_u32 m0, s86, 98304
ds_read_b64_tr_b16 a[168:169], v191 offset:32768
v_xor_b32 v192, 0x10000, v184
v_mfma_f32_16x16x32_bf16 v[136:139], a[148:151], a[236:239], v[136:139]
s_add_u32 s64, s85, 524288
ds_read_b64_tr_b16 a[170:171], v191 offset:36864
v_xor_b32 v193, 0x10000, v185
v_mfma_f32_16x16x32_bf16 v[104:107], a[148:151], a[228:231], 0
buffer_load_dwordx4 v12, s[36:39], s64 offen lds
v_mfma_f32_16x16x32_bf16 v[104:107], a[144:147], a[224:227], v[104:107]
s_add_u32 m0, s86, 99328
s_add_u32 s64, s85, 532480
ds_read_b64_tr_b16 a[172:173], v191 offset:40960
v_xor_b32 v194, 0x10000, v186
v_mfma_f32_16x16x32_bf16 v[72:75], a[144:147], a[216:219], 0
buffer_load_dwordx4 v13, s[36:39], s64 offen lds
v_mfma_f32_16x16x32_bf16 v[72:75], a[148:151], a[220:223], v[72:75]
s_add_u32 m0, s86, 100352
ds_read_b64_tr_b16 a[174:175], v191 offset:45056
v_xor_b32 v195, 0x10000, v187
v_mfma_f32_16x16x32_bf16 v[40:43], a[148:151], a[212:215], 0
s_add_u32 s64, s85, 540672
ds_read_b64_tr_b16 a[176:177], v184 offset:32768
v_xor_b32 v196, 0x10000, v188
v_mfma_f32_16x16x32_bf16 v[40:43], a[144:147], a[208:211], v[40:43]
s_waitcnt lgkmcnt(5)
buffer_load_dwordx4 v12, s[36:39], s64 offen lds
v_mfma_f32_16x16x32_bf16 v[44:47], a[152:155], a[208:211], 0
s_add_u32 m0, s86, 101376
s_add_u32 s64, s85, 548864
ds_read_b64_tr_b16 a[178:179], v184 offset:36864
v_xor_b32 v197, 0x10000, v189
v_mfma_f32_16x16x32_bf16 v[44:47], a[156:159], a[212:215], v[44:47]
buffer_load_dwordx4 v13, s[36:39], s64 offen lds
v_mfma_f32_16x16x32_bf16 v[76:79], a[156:159], a[220:223], 0
s_add_u32 m0, s86, 102400
ds_read_b64_tr_b16 a[180:181], v184 offset:40960
v_xor_b32 v198, 0x10000, v190
v_mfma_f32_16x16x32_bf16 v[76:79], a[152:155], a[216:219], v[76:79]
s_add_u32 s64, s85, 557056
ds_read_b64_tr_b16 a[182:183], v184 offset:45056
v_xor_b32 v199, 0x10000, v191
v_mfma_f32_16x16x32_bf16 v[108:111], a[152:155], a[224:227], 0
buffer_load_dwordx4 v12, s[36:39], s64 offen lds
v_mfma_f32_16x16x32_bf16 v[108:111], a[156:159], a[228:231], v[108:111]
s_add_u32 m0, s86, 103424
s_add_u32 s64, s85, 565248
ds_read_b64_tr_b16 a[184:185], v185 offset:32768
v_mfma_f32_16x16x32_bf16 v[140:143], a[156:159], a[236:239], 0
s_branch L_po22
L_pg22:
s_branch L_pg30
L_po22:
buffer_load_dwordx4 v13, s[36:39], s64 offen lds
v_mfma_f32_16x16x32_bf16 v[140:143], a[152:155], a[232:235], v[140:143]
s_add_u32 m0, s86, 104448
s_add_u32 s64, s85, 573440
ds_read_b64_tr_b16 a[186:187], v185 offset:36864
v_mfma_f32_16x16x32_bf16 v[144:147], a[160:163], a[232:235], 0
s_and_b32 s68, s82, 3
s_lshl_b32 s68, s68, 11
ds_read_b64_tr_b16 a[188:189], v185 offset:40960
v_mfma_f32_16x16x32_bf16 v[144:147], a[164:167], a[236:239], v[144:147]
s_add_u32 s76, s86, s68
buffer_load_dwordx4 v12, s[36:39], s64 offen lds
v_mfma_f32_16x16x32_bf16 v[112:115], a[164:167], a[228:231], 0
s_and_b32 s71, s31, 4
s_lshl_b32 s71, s71, 5
s_add_u32 m0, s86, 105472
s_add_u32 s64, s85, 581632
ds_read_b64_tr_b16 a[190:191], v185 offset:45056
v_mfma_f32_16x16x32_bf16 v[112:115], a[160:163], a[224:227], v[112:115]
s_add_u32 s71, s71, s79
buffer_load_dwordx4 v13, s[36:39], s64 offen lds
v_mfma_f32_16x16x32_bf16 v[80:83], a[160:163], a[216:219], 0
s_add_u32 s71, s71, 4096
s_add_u32 s72, s80, 4096
ds_read_b64_tr_b16 a[192:193], v186 offset:32768
v_mfma_f32_16x16x32_bf16 v[80:83], a[164:167], a[220:223], v[80:83]
s_lshr_b32 s69, s87, 8
s_lshr_b32 s67, s82, 1
s_add_u32 s65, s84, 65536
ds_read_b64_tr_b16 a[194:195], v186 offset:36864
v_mfma_f32_16x16x32_bf16 v[48:51], a[164:167], a[212:215], 0
s_xor_b32 s69, s69, s67
buffer_load_dwordx4 a[32:35], v14, s[44:47], s65 offen offset:0 sc1
v_mfma_f32_16x16x32_bf16 v[48:51], a[160:163], a[208:211], v[48:51]
s_waitcnt lgkmcnt(4)
s_and_b32 s69, s69, 2
s_lshl_b32 s69, s69, 15
ds_read_b64_tr_b16 a[196:197], v186 offset:40960
v_mfma_f32_16x16x32_bf16 v[52:55], a[168:171], a[208:211], 0
s_add_u32 s68, s68, s69
buffer_load_dwordx4 a[40:43], v14, s[44:47], s65 offen offset:1024 sc1
v_mfma_f32_16x16x32_bf16 v[52:55], a[172:175], a[212:215], v[52:55]
ds_read_b64_tr_b16 a[198:199], v186 offset:45056
v_mfma_f32_16x16x32_bf16 v[84:87], a[172:175], a[220:223], 0
ds_read_b64_tr_b16 a[200:201], v187 offset:32768
v_mfma_f32_16x16x32_bf16 v[84:87], a[168:171], a[216:219], v[84:87]
buffer_load_dwordx4 a[48:51], v15, s[44:47], s65 offen offset:0 sc1
v_mfma_f32_16x16x32_bf16 v[116:119], a[168:171], a[224:227], 0
ds_read_b64_tr_b16 a[202:203], v187 offset:36864
v_mfma_f32_16x16x32_bf16 v[116:119], a[172:175], a[228:231], v[116:119]
buffer_load_dwordx4 a[56:59], v15, s[44:47], s65 offen offset:1024 sc1
v_mfma_f32_16x16x32_bf16 v[148:151], a[172:175], a[236:239], 0
ds_read_b64_tr_b16 a[204:205], v187 offset:40960
v_mfma_f32_16x16x32_bf16 v[148:151], a[168:171], a[232:235], v[148:151]
s_add_u32 s65, s84, 73728
ds_read_b64_tr_b16 a[206:207], v187 offset:45056
v_mfma_f32_16x16x32_bf16 v[120:123], a[176:179], a[232:235], 0
buffer_load_dwordx4 a[36:39], v14, s[44:47], s65 offen offset:0 sc1
v_mfma_f32_16x16x32_bf16 v[120:123], a[180:183], a[236:239], v[120:123]
v_mfma_f32_16x16x32_bf16 v[88:91], a[180:183], a[228:231], 0
buffer_load_dwordx4 a[44:47], v14, s[44:47], s65 offen offset:1024 sc1
v_mfma_f32_16x16x32_bf16 v[88:91], a[176:179], a[224:227], v[88:91]
v_mfma_f32_16x16x32_bf16 v[56:59], a[176:179], a[216:219], 0
v_mfma_f32_16x16x32_bf16 v[56:59], a[180:183], a[220:223], v[56:59]
buffer_load_dwordx4 a[52:55], v15, s[44:47], s65 offen offset:0 sc1
v_mfma_f32_16x16x32_bf16 v[24:27], a[180:183], a[212:215], 0
v_mfma_f32_16x16x32_bf16 v[24:27], a[176:179], a[208:211], v[24:27]
buffer_load_dwordx4 a[60:63], v15, s[44:47], s65 offen offset:1024 sc1
v_mfma_f32_16x16x32_bf16 v[28:31], a[184:187], a[208:211], 0
s_waitcnt lgkmcnt(0)
v_mfma_f32_16x16x32_bf16 v[28:31], a[188:191], a[212:215], v[28:31]
v_mfma_f32_16x16x32_bf16 v[60:63], a[188:191], a[220:223], 0
buffer_load_dword v19, off, s[52:55], s72 sc1
v_mfma_f32_16x16x32_bf16 v[60:63], a[184:187], a[216:219], v[60:63]
s_add_u32 s85, s85, 2883584
s_lshl3_add_u32 s85, s68, s85
s_waitcnt vmcnt(24) lgkmcnt(0)
s_barrier
v_mfma_f32_16x16x32_bf16 v[92:95], a[184:187], a[224:227], 0
ds_read_b64_tr_b16 a[144:145], v196 offset:0
v_mfma_f32_16x16x32_bf16 v[92:95], a[188:191], a[228:231], v[92:95]
ds_read_b64_tr_b16 a[146:147], v196 offset:4096
v_mfma_f32_16x16x32_bf16 v[124:127], a[188:191], a[236:239], 0
s_xor_b32 m0, s76, 131072
ds_read_b64_tr_b16 a[148:149], v196 offset:8192
v_mfma_f32_16x16x32_bf16 v[124:127], a[184:187], a[232:235], v[124:127]
s_xor_b32 s64, s85, 0
ds_read_b64_tr_b16 a[150:151], v196 offset:12288
v_mfma_f32_16x16x32_bf16 v[128:131], a[192:195], a[232:235], 0
buffer_load_dwordx4 v12, s[40:43], s64 offen lds
v_mfma_f32_16x16x32_bf16 v[128:131], a[196:199], a[236:239], v[128:131]
s_xor_b32 m0, s76, 132096
ds_read_b64_tr_b16 a[152:153], v197 offset:0
v_mfma_f32_16x16x32_bf16 v[96:99], a[196:199], a[228:231], 0
s_xor_b32 s64, s85, 8192
ds_read_b64_tr_b16 a[154:155], v197 offset:4096
v_mfma_f32_16x16x32_bf16 v[96:99], a[192:195], a[224:227], v[96:99]
buffer_load_dwordx4 v13, s[40:43], s64 offen lds
v_mfma_f32_16x16x32_bf16 v[64:67], a[192:195], a[216:219], 0
s_xor_b32 m0, s76, 133120
ds_read_b64_tr_b16 a[156:157], v197 offset:8192
v_mfma_f32_16x16x32_bf16 v[64:67], a[196:199], a[220:223], v[64:67]
s_xor_b32 s64, s85, 16384
ds_read_b64_tr_b16 a[158:159], v197 offset:12288
v_mfma_f32_16x16x32_bf16 v[32:35], a[196:199], a[212:215], 0
buffer_load_dwordx4 v12, s[40:43], s64 offen lds
v_mfma_f32_16x16x32_bf16 v[32:35], a[192:195], a[208:211], v[32:35]
s_xor_b32 m0, s76, 134144
ds_read_b64_tr_b16 a[160:161], v198 offset:0
v_mfma_f32_16x16x32_bf16 v[36:39], a[200:203], a[208:211], 0
s_xor_b32 s64, s85, 24576
ds_read_b64_tr_b16 a[162:163], v198 offset:4096
v_mfma_f32_16x16x32_bf16 v[36:39], a[204:207], a[212:215], v[36:39]
buffer_load_dwordx4 v13, s[40:43], s64 offen lds
v_mfma_f32_16x16x32_bf16 v[68:71], a[204:207], a[220:223], 0
s_xor_b32 m0, s76, 135168
ds_read_b64_tr_b16 a[164:165], v198 offset:8192
v_mfma_f32_16x16x32_bf16 v[68:71], a[200:203], a[216:219], v[68:71]
s_xor_b32 s64, s85, 32768
ds_read_b64_tr_b16 a[166:167], v198 offset:12288
v_mfma_f32_16x16x32_bf16 v[100:103], a[200:203], a[224:227], 0
buffer_load_dwordx4 v12, s[40:43], s64 offen lds
v_mfma_f32_16x16x32_bf16 v[100:103], a[204:207], a[228:231], v[100:103]
v_mfma_f32_16x16x32_bf16 v[132:135], a[204:207], a[236:239], 0
v_mfma_f32_16x16x32_bf16 v[132:135], a[200:203], a[232:235], v[132:135]
s_waitcnt lgkmcnt(3)
v_mfma_f32_16x16x32_bf16 v[136:139], a[144:147], v[176:179], v[136:139]
s_waitcnt vmcnt(5)
v_readfirstlane_b32 vcc_lo, v19
s_nop 0
s_cmp_lt_u32 vcc_lo, 8
s_cbranch_scc1 L_spin_2016
L_spinbk_2017:
s_sub_u32 s84, s84, 688128
s_add_u32 s84, s84, s69
v_mfma_f32_16x16x32_bf16 v[136:139], a[148:151], v[180:183], v[136:139]
s_xor_b32 m0, s76, 136192
s_xor_b32 s64, s85, 40960
ds_read_b64_tr_b16 a[168:169], v199 offset:0
v_mfma_f32_16x16x32_bf16 v[104:107], a[148:151], v[172:175], v[104:107]
buffer_load_dwordx4 v13, s[40:43], s64 offen lds
v_mfma_f32_16x16x32_bf16 v[104:107], a[144:147], v[168:171], v[104:107]
s_xor_b32 m0, s76, 137216
ds_read_b64_tr_b16 a[170:171], v199 offset:4096
v_mfma_f32_16x16x32_bf16 v[72:75], a[144:147], v[160:163], v[72:75]
s_xor_b32 s64, s85, 49152
ds_read_b64_tr_b16 a[172:173], v199 offset:8192
v_mfma_f32_16x16x32_bf16 v[72:75], a[148:151], v[164:167], v[72:75]
buffer_load_dwordx4 v12, s[40:43], s64 offen lds
v_mfma_f32_16x16x32_bf16 v[40:43], a[148:151], v[156:159], v[40:43]
ds_read_b64_tr_b16 a[174:175], v199 offset:12288
v_mfma_f32_16x16x32_bf16 v[40:43], a[144:147], v[152:155], v[40:43]
s_xor_b32 m0, s76, 138240
ds_read_b64_tr_b16 a[176:177], v192 offset:0
v_mfma_f32_16x16x32_bf16 v[44:47], a[152:155], v[152:155], v[44:47]
s_xor_b32 s64, s85, 57344
ds_read_b64_tr_b16 a[178:179], v192 offset:4096
v_mfma_f32_16x16x32_bf16 v[44:47], a[156:159], v[156:159], v[44:47]
buffer_load_dwordx4 v13, s[40:43], s64 offen lds
v_mfma_f32_16x16x32_bf16 v[76:79], a[156:159], v[164:167], v[76:79]
ds_read_b64_tr_b16 a[180:181], v192 offset:8192
v_mfma_f32_16x16x32_bf16 v[76:79], a[152:155], v[160:163], v[76:79]
s_xor_b32 s65, s84, 0
ds_read_b64_tr_b16 a[182:183], v192 offset:12288
v_mfma_f32_16x16x32_bf16 v[108:111], a[152:155], v[168:171], v[108:111]
buffer_load_dwordx4 a[208:211], v14, s[44:47], s65 offen offset:0 sc1
v_mfma_f32_16x16x32_bf16 v[108:111], a[156:159], v[172:175], v[108:111]
ds_read_b64_tr_b16 a[184:185], v193 offset:0
v_mfma_f32_16x16x32_bf16 v[140:143], a[156:159], v[180:183], v[140:143]
ds_read_b64_tr_b16 a[186:187], v193 offset:4096
v_mfma_f32_16x16x32_bf16 v[140:143], a[152:155], v[176:179], v[140:143]
s_waitcnt lgkmcnt(5)
ds_read_b64_tr_b16 a[188:189], v193 offset:8192
v_mfma_f32_16x16x32_bf16 v[144:147], a[160:163], v[176:179], v[144:147]
buffer_load_dwordx4 a[216:219], v14, s[44:47], s65 offen offset:1024 sc1
v_mfma_f32_16x16x32_bf16 v[144:147], a[164:167], v[180:183], v[144:147]
ds_read_b64_tr_b16 a[190:191], v193 offset:12288
v_mfma_f32_16x16x32_bf16 v[112:115], a[164:167], v[172:175], v[112:115]
ds_read_b64_tr_b16 a[192:193], v194 offset:0
v_mfma_f32_16x16x32_bf16 v[112:115], a[160:163], v[168:171], v[112:115]
ds_read_b64_tr_b16 a[194:195], v194 offset:4096
v_mfma_f32_16x16x32_bf16 v[80:83], a[160:163], v[160:163], v[80:83]
buffer_load_dwordx4 a[224:227], v15, s[44:47], s65 offen offset:0 sc1
v_mfma_f32_16x16x32_bf16 v[80:83], a[164:167], v[164:167], v[80:83]
ds_read_b64_tr_b16 a[196:197], v194 offset:8192
v_mfma_f32_16x16x32_bf16 v[48:51], a[164:167], v[156:159], v[48:51]
ds_read_b64_tr_b16 a[198:199], v194 offset:12288
v_mfma_f32_16x16x32_bf16 v[48:51], a[160:163], v[152:155], v[48:51]
buffer_load_dwordx4 a[232:235], v15, s[44:47], s65 offen offset:1024 sc1
v_mfma_f32_16x16x32_bf16 v[52:55], a[168:171], v[152:155], v[52:55]
v_mfma_f32_16x16x32_bf16 v[52:55], a[172:175], v[156:159], v[52:55]
v_mfma_f32_16x16x32_bf16 v[84:87], a[172:175], v[164:167], v[84:87]
s_xor_b32 s65, s84, 8192
ds_read_b64_tr_b16 a[200:201], v195 offset:0
v_mfma_f32_16x16x32_bf16 v[84:87], a[168:171], v[160:163], v[84:87]
buffer_load_dwordx4 a[212:215], v14, s[44:47], s65 offen offset:0 sc1
v_mfma_f32_16x16x32_bf16 v[116:119], a[168:171], v[168:171], v[116:119]
ds_read_b64_tr_b16 a[202:203], v195 offset:4096
v_mfma_f32_16x16x32_bf16 v[116:119], a[172:175], v[172:175], v[116:119]
ds_read_b64_tr_b16 a[204:205], v195 offset:8192
v_mfma_f32_16x16x32_bf16 v[148:151], a[172:175], v[180:183], v[148:151]
ds_read_b64_tr_b16 a[206:207], v195 offset:12288
v_mfma_f32_16x16x32_bf16 v[148:151], a[168:171], v[176:179], v[148:151]
s_waitcnt lgkmcnt(4)
s_lshl_b32 s66, s30, 30
buffer_load_dwordx4 a[220:223], v14, s[44:47], s65 offen offset:1024 sc1
v_mfma_f32_16x16x32_bf16 v[120:123], a[176:179], v[176:179], v[120:123]
v_lshl_add_u32 v1, v0, 24, s66
v_mfma_f32_16x16x32_bf16 v[120:123], a[180:183], v[180:183], v[120:123]
v_mfma_f32_16x16x32_bf16 v[88:91], a[180:183], v[172:175], v[88:91]
buffer_load_dwordx4 a[228:231], v15, s[44:47], s65 offen offset:0 sc1
v_mfma_f32_16x16x32_bf16 v[88:91], a[176:179], v[168:171], v[88:91]
v_mfma_f32_16x16x32_bf16 v[56:59], a[176:179], v[160:163], v[56:59]
v_mfma_f32_16x16x32_bf16 v[56:59], a[180:183], v[164:167], v[56:59]
v_mfma_f32_16x16x32_bf16 v[24:27], a[180:183], v[156:159], v[24:27]
buffer_load_dwordx4 a[236:239], v15, s[44:47], s65 offen offset:1024 sc1
v_mfma_f32_16x16x32_bf16 v[24:27], a[176:179], v[152:155], v[24:27]
v_mfma_f32_16x16x32_bf16 v[28:31], a[184:187], v[152:155], v[28:31]
v_mfma_f32_16x16x32_bf16 v[28:31], a[188:191], v[156:159], v[28:31]
v_mfma_f32_16x16x32_bf16 v[60:63], a[188:191], v[164:167], v[60:63]
v_mfma_f32_16x16x32_bf16 v[60:63], a[184:187], v[160:163], v[60:63]
s_waitcnt lgkmcnt(0)
s_barrier
v_mfma_f32_16x16x32_bf16 v[92:95], a[184:187], v[168:171], v[92:95]
s_mov_b64 exec, 1
buffer_atomic_add a251, v1, s[52:55], s71 offen offset:0 sc1
s_mov_b64 exec, -1
v_mfma_f32_16x16x32_bf16 v[92:95], a[188:191], v[172:175], v[92:95]
ds_read_b64_tr_b16 a[144:145], v188 offset:0
v_mfma_f32_16x16x32_bf16 v[124:127], a[188:191], v[180:183], v[124:127]
s_xor_b32 m0, s76, 32768
ds_read_b64_tr_b16 a[146:147], v188 offset:4096
v_mfma_f32_16x16x32_bf16 v[124:127], a[184:187], v[176:179], v[124:127]
s_xor_b32 s64, s85, 262144
ds_read_b64_tr_b16 a[148:149], v188 offset:8192
v_mfma_f32_16x16x32_bf16 v[128:131], a[192:195], v[176:179], v[128:131]
buffer_load_dwordx4 v12, s[40:43], s64 offen lds
v_mfma_f32_16x16x32_bf16 v[128:131], a[196:199], v[180:183], v[128:131]
s_xor_b32 m0, s76, 33792
ds_read_b64_tr_b16 a[150:151], v188 offset:12288
v_mfma_f32_16x16x32_bf16 v[96:99], a[196:199], v[172:175], v[96:99]
s_xor_b32 s64, s85, 270336
ds_read_b64_tr_b16 a[152:153], v189 offset:0
v_mfma_f32_16x16x32_bf16 v[96:99], a[192:195], v[168:171], v[96:99]
buffer_load_dwordx4 v13, s[40:43], s64 offen lds
v_mfma_f32_16x16x32_bf16 v[64:67], a[192:195], v[160:163], v[64:67]
s_xor_b32 m0, s76, 34816
ds_read_b64_tr_b16 a[154:155], v189 offset:4096
v_mfma_f32_16x16x32_bf16 v[64:67], a[196:199], v[164:167], v[64:67]
s_xor_b32 s64, s85, 278528
ds_read_b64_tr_b16 a[156:157], v189 offset:8192
v_mfma_f32_16x16x32_bf16 v[32:35], a[196:199], v[156:159], v[32:35]
buffer_load_dwordx4 v12, s[40:43], s64 offen lds
v_mfma_f32_16x16x32_bf16 v[32:35], a[192:195], v[152:155], v[32:35]
s_xor_b32 m0, s76, 35840
ds_read_b64_tr_b16 a[158:159], v189 offset:12288
v_mfma_f32_16x16x32_bf16 v[36:39], a[200:203], v[152:155], v[36:39]
s_xor_b32 s64, s85, 286720
ds_read_b64_tr_b16 a[160:161], v190 offset:0
v_mfma_f32_16x16x32_bf16 v[36:39], a[204:207], v[156:159], v[36:39]
buffer_load_dwordx4 v13, s[40:43], s64 offen lds
v_mfma_f32_16x16x32_bf16 v[68:71], a[204:207], v[164:167], v[68:71]
s_xor_b32 m0, s76, 36864
ds_read_b64_tr_b16 a[162:163], v190 offset:4096
v_mfma_f32_16x16x32_bf16 v[68:71], a[200:203], v[160:163], v[68:71]
s_xor_b32 s64, s85, 294912
ds_read_b64_tr_b16 a[164:165], v190 offset:8192
v_mfma_f32_16x16x32_bf16 v[100:103], a[200:203], v[168:171], v[100:103]
buffer_load_dwordx4 v12, s[40:43], s64 offen lds
v_mfma_f32_16x16x32_bf16 v[100:103], a[204:207], v[172:175], v[100:103]
ds_read_b64_tr_b16 a[166:167], v190 offset:12288
v_mfma_f32_16x16x32_bf16 v[132:135], a[204:207], v[180:183], v[132:135]
v_mfma_f32_16x16x32_bf16 v[132:135], a[200:203], v[176:179], v[132:135]
s_waitcnt lgkmcnt(4)
v_mfma_f32_16x16x32_bf16 v[136:139], a[144:147], a[56:59], v[136:139]
s_xor_b32 m0, s76, 37888
ds_read_b64_tr_b16 a[168:169], v191 offset:0
v_mfma_f32_16x16x32_bf16 v[136:139], a[148:151], a[60:63], v[136:139]
s_xor_b32 s64, s85, 303104
ds_read_b64_tr_b16 a[170:171], v191 offset:4096
v_mfma_f32_16x16x32_bf16 v[104:107], a[148:151], a[52:55], v[104:107]
buffer_load_dwordx4 v13, s[40:43], s64 offen lds
v_mfma_f32_16x16x32_bf16 v[104:107], a[144:147], a[48:51], v[104:107]
s_xor_b32 m0, s76, 38912
ds_read_b64_tr_b16 a[172:173], v191 offset:8192
v_mfma_f32_16x16x32_bf16 v[72:75], a[144:147], a[40:43], v[72:75]
s_xor_b32 s64, s85, 311296
ds_read_b64_tr_b16 a[174:175], v191 offset:12288
v_mfma_f32_16x16x32_bf16 v[72:75], a[148:151], a[44:47], v[72:75]
buffer_load_dwordx4 v12, s[40:43], s64 offen lds
v_mfma_f32_16x16x32_bf16 v[40:43], a[148:151], a[36:39], v[40:43]
ds_read_b64_tr_b16 a[176:177], v184 offset:0
v_mfma_f32_16x16x32_bf16 v[40:43], a[144:147], a[32:35], v[40:43]
s_xor_b32 m0, s76, 39936
ds_read_b64_tr_b16 a[178:179], v184 offset:4096
v_mfma_f32_16x16x32_bf16 v[44:47], a[152:155], a[32:35], v[44:47]
s_xor_b32 s64, s85, 319488
ds_read_b64_tr_b16 a[180:181], v184 offset:8192
v_mfma_f32_16x16x32_bf16 v[44:47], a[156:159], a[36:39], v[44:47]
buffer_load_dwordx4 v13, s[40:43], s64 offen lds
v_mfma_f32_16x16x32_bf16 v[76:79], a[156:159], a[44:47], v[76:79]
ds_read_b64_tr_b16 a[182:183], v184 offset:12288
v_mfma_f32_16x16x32_bf16 v[76:79], a[152:155], a[40:43], v[76:79]
s_xor_b32 s65, s84, 32768
ds_read_b64_tr_b16 a[184:185], v185 offset:0
v_mfma_f32_16x16x32_bf16 v[108:111], a[152:155], a[48:51], v[108:111]
buffer_load_dwordx4 v[152:155], v14, s[44:47], s65 offen offset:0 sc1
v_mfma_f32_16x16x32_bf16 v[108:111], a[156:159], a[52:55], v[108:111]
ds_read_b64_tr_b16 a[186:187], v185 offset:4096
v_mfma_f32_16x16x32_bf16 v[140:143], a[156:159], a[60:63], v[140:143]
ds_read_b64_tr_b16 a[188:189], v185 offset:8192
v_mfma_f32_16x16x32_bf16 v[140:143], a[152:155], a[56:59], v[140:143]
s_waitcnt lgkmcnt(5)
ds_read_b64_tr_b16 a[190:191], v185 offset:12288
v_mfma_f32_16x16x32_bf16 v[144:147], a[160:163], a[56:59], v[144:147]
buffer_load_dwordx4 v[160:163], v14, s[44:47], s65 offen offset:1024 sc1
v_mfma_f32_16x16x32_bf16 v[144:147], a[164:167], a[60:63], v[144:147]
v_mfma_f32_16x16x32_bf16 v[112:115], a[164:167], a[52:55], v[112:115]
ds_read_b64_tr_b16 a[192:193], v186 offset:0
v_mfma_f32_16x16x32_bf16 v[112:115], a[160:163], a[48:51], v[112:115]
ds_read_b64_tr_b16 a[194:195], v186 offset:4096
v_mfma_f32_16x16x32_bf16 v[80:83], a[160:163], a[40:43], v[80:83]
buffer_load_dwordx4 v[168:171], v15, s[44:47], s65 offen offset:0 sc1
v_mfma_f32_16x16x32_bf16 v[80:83], a[164:167], a[44:47], v[80:83]
ds_read_b64_tr_b16 a[196:197], v186 offset:8192
v_mfma_f32_16x16x32_bf16 v[48:51], a[164:167], a[36:39], v[48:51]
ds_read_b64_tr_b16 a[198:199], v186 offset:12288
v_mfma_f32_16x16x32_bf16 v[48:51], a[160:163], a[32:35], v[48:51]
buffer_load_dwordx4 v[176:179], v15, s[44:47], s65 offen offset:1024 sc1
v_mfma_f32_16x16x32_bf16 v[52:55], a[168:171], a[32:35], v[52:55]
v_mfma_f32_16x16x32_bf16 v[52:55], a[172:175], a[36:39], v[52:55]
v_mfma_f32_16x16x32_bf16 v[84:87], a[172:175], a[44:47], v[84:87]
s_xor_b32 s65, s84, 40960
ds_read_b64_tr_b16 a[200:201], v187 offset:0
v_mfma_f32_16x16x32_bf16 v[84:87], a[168:171], a[40:43], v[84:87]
buffer_load_dwordx4 v[156:159], v14, s[44:47], s65 offen offset:0 sc1
v_mfma_f32_16x16x32_bf16 v[116:119], a[168:171], a[48:51], v[116:119]
ds_read_b64_tr_b16 a[202:203], v187 offset:4096
v_mfma_f32_16x16x32_bf16 v[116:119], a[172:175], a[52:55], v[116:119]
ds_read_b64_tr_b16 a[204:205], v187 offset:8192
v_mfma_f32_16x16x32_bf16 v[148:151], a[172:175], a[60:63], v[148:151]
ds_read_b64_tr_b16 a[206:207], v187 offset:12288
v_mfma_f32_16x16x32_bf16 v[148:151], a[168:171], a[56:59], v[148:151]
buffer_load_dwordx4 v[164:167], v14, s[44:47], s65 offen offset:1024 sc1
v_mfma_f32_16x16x32_bf16 v[120:123], a[176:179], a[56:59], v[120:123]
s_waitcnt lgkmcnt(4)
v_mfma_f32_16x16x32_bf16 v[120:123], a[180:183], a[60:63], v[120:123]
v_mfma_f32_16x16x32_bf16 v[88:91], a[180:183], a[52:55], v[88:91]
buffer_load_dwordx4 v[172:175], v15, s[44:47], s65 offen offset:0 sc1
v_mfma_f32_16x16x32_bf16 v[88:91], a[176:179], a[48:51], v[88:91]
v_mfma_f32_16x16x32_bf16 v[56:59], a[176:179], a[40:43], v[56:59]
v_mfma_f32_16x16x32_bf16 v[56:59], a[180:183], a[44:47], v[56:59]
v_mfma_f32_16x16x32_bf16 v[24:27], a[180:183], a[36:39], v[24:27]
buffer_load_dwordx4 v[180:183], v15, s[44:47], s65 offen offset:1024 sc1
v_mfma_f32_16x16x32_bf16 v[24:27], a[176:179], a[32:35], v[24:27]
v_mfma_f32_16x16x32_bf16 v[28:31], a[184:187], a[32:35], v[28:31]
v_mfma_f32_16x16x32_bf16 v[28:31], a[188:191], a[36:39], v[28:31]
v_mfma_f32_16x16x32_bf16 v[60:63], a[188:191], a[44:47], v[60:63]
v_mfma_f32_16x16x32_bf16 v[60:63], a[184:187], a[40:43], v[60:63]
s_waitcnt vmcnt(25)
s_barrier
v_mfma_f32_16x16x32_bf16 v[92:95], a[184:187], a[48:51], v[92:95]
ds_read_b64_tr_b16 a[144:145], v188 offset:32768
v_mfma_f32_16x16x32_bf16 v[92:95], a[188:191], a[52:55], v[92:95]
ds_read_b64_tr_b16 a[146:147], v188 offset:36864
v_mfma_f32_16x16x32_bf16 v[124:127], a[188:191], a[60:63], v[124:127]
s_xor_b32 m0, s76, 65536
ds_read_b64_tr_b16 a[148:149], v188 offset:40960
v_mfma_f32_16x16x32_bf16 v[124:127], a[184:187], a[56:59], v[124:127]
s_xor_b32 s64, s85, 524288
ds_read_b64_tr_b16 a[150:151], v188 offset:45056
v_mfma_f32_16x16x32_bf16 v[128:131], a[192:195], a[56:59], v[128:131]
buffer_load_dwordx4 v12, s[40:43], s64 offen lds
v_mfma_f32_16x16x32_bf16 v[128:131], a[196:199], a[60:63], v[128:131]
s_xor_b32 m0, s76, 66560
ds_read_b64_tr_b16 a[152:153], v189 offset:32768
v_mfma_f32_16x16x32_bf16 v[96:99], a[196:199], a[52:55], v[96:99]
s_xor_b32 s64, s85, 532480
ds_read_b64_tr_b16 a[154:155], v189 offset:36864
v_mfma_f32_16x16x32_bf16 v[96:99], a[192:195], a[48:51], v[96:99]
buffer_load_dwordx4 v13, s[40:43], s64 offen lds
v_mfma_f32_16x16x32_bf16 v[64:67], a[192:195], a[40:43], v[64:67]
s_xor_b32 m0, s76, 67584
ds_read_b64_tr_b16 a[156:157], v189 offset:40960
v_mfma_f32_16x16x32_bf16 v[64:67], a[196:199], a[44:47], v[64:67]
s_xor_b32 s64, s85, 540672
ds_read_b64_tr_b16 a[158:159], v189 offset:45056
v_mfma_f32_16x16x32_bf16 v[32:35], a[196:199], a[36:39], v[32:35]
buffer_load_dwordx4 v12, s[40:43], s64 offen lds
v_mfma_f32_16x16x32_bf16 v[32:35], a[192:195], a[32:35], v[32:35]
s_waitcnt lgkmcnt(4)
s_xor_b32 m0, s76, 68608
ds_read_b64_tr_b16 a[160:161], v190 offset:32768
v_mfma_f32_16x16x32_bf16 v[36:39], a[200:203], a[32:35], v[36:39]
s_xor_b32 s64, s85, 548864
ds_read_b64_tr_b16 a[162:163], v190 offset:36864
v_mfma_f32_16x16x32_bf16 v[36:39], a[204:207], a[36:39], v[36:39]
buffer_load_dwordx4 v13, s[40:43], s64 offen lds
v_mfma_f32_16x16x32_bf16 v[68:71], a[204:207], a[44:47], v[68:71]
s_xor_b32 m0, s76, 69632
ds_read_b64_tr_b16 a[164:165], v190 offset:40960
v_mfma_f32_16x16x32_bf16 v[68:71], a[200:203], a[40:43], v[68:71]
s_xor_b32 s64, s85, 557056
ds_read_b64_tr_b16 a[166:167], v190 offset:45056
v_mfma_f32_16x16x32_bf16 v[100:103], a[200:203], a[48:51], v[100:103]
buffer_load_dwordx4 v12, s[40:43], s64 offen lds
v_mfma_f32_16x16x32_bf16 v[100:103], a[204:207], a[52:55], v[100:103]
s_mov_b32 s70, 3
s_mov_b32 s73, 2
v_mfma_f32_16x16x32_bf16 v[132:135], a[204:207], a[60:63], v[132:135]
v_mfma_f32_16x16x32_bf16 v[132:135], a[200:203], a[56:59], v[132:135]
s_branch L_p5join
.p2align 12
L_pg23:
s_branch L_pg31
L_p5join:
L_p5loop:
s_waitcnt lgkmcnt(10)
s_waitcnt vmcnt(19)
v_mfma_f32_16x16x32_bf16 v[136:139], a[144:147], a[232:235], v[136:139]
s_waitcnt vmcnt(15)
s_waitcnt lgkmcnt(8)
s_xor_b32 m0, s76, 70656
s_xor_b32 s64, s85, 565248
ds_read_b64_tr_b16 a[168:169], v191 offset:32768
v_mfma_f32_16x16x32_bf16 v[136:139], a[148:151], a[236:239], v[136:139]
buffer_load_dwordx4 v13, s[40:43], s64 offen lds
v_mfma_f32_16x16x32_bf16 v[104:107], a[148:151], a[228:231], v[104:107]
ds_read_b64_tr_b16 a[170:171], v191 offset:36864
v_mfma_f32_16x16x32_bf16 v[104:107], a[144:147], a[224:227], v[104:107]
s_xor_b32 m0, s76, 71680
ds_read_b64_tr_b16 a[172:173], v191 offset:40960
v_mfma_f32_16x16x32_bf16 v[72:75], a[144:147], a[216:219], v[72:75]
s_xor_b32 s64, s85, 573440
ds_read_b64_tr_b16 a[174:175], v191 offset:45056
v_mfma_f32_16x16x32_bf16 v[72:75], a[148:151], a[220:223], v[72:75]
buffer_load_dwordx4 v12, s[40:43], s64 offen lds
v_mfma_f32_16x16x32_bf16 v[40:43], a[148:151], a[212:215], v[40:43]
ds_read_b64_tr_b16 a[176:177], v184 offset:32768
v_mfma_f32_16x16x32_bf16 v[40:43], a[144:147], a[208:211], v[40:43]
s_waitcnt lgkmcnt(5)
s_xor_b32 m0, s76, 72704
ds_read_b64_tr_b16 a[178:179], v184 offset:36864
v_mfma_f32_16x16x32_bf16 v[44:47], a[152:155], a[208:211], v[44:47]
s_xor_b32 s64, s85, 581632
ds_read_b64_tr_b16 a[180:181], v184 offset:40960
v_mfma_f32_16x16x32_bf16 v[44:47], a[156:159], a[212:215], v[44:47]
buffer_load_dwordx4 v13, s[40:43], s64 offen lds
v_mfma_f32_16x16x32_bf16 v[76:79], a[156:159], a[220:223], v[76:79]
ds_read_b64_tr_b16 a[182:183], v184 offset:45056
v_mfma_f32_16x16x32_bf16 v[76:79], a[152:155], a[216:219], v[76:79]
ds_read_b64_tr_b16 a[184:185], v185 offset:32768
v_mfma_f32_16x16x32_bf16 v[108:111], a[152:155], a[224:227], v[108:111]
s_xor_b32 s65, s84, 65536
ds_read_b64_tr_b16 a[186:187], v185 offset:36864
v_mfma_f32_16x16x32_bf16 v[108:111], a[156:159], a[228:231], v[108:111]
buffer_load_dwordx4 a[0:3], v14, s[44:47], s65 offen offset:0 sc1
v_mfma_f32_16x16x32_bf16 v[140:143], a[156:159], a[236:239], v[140:143]
ds_read_b64_tr_b16 a[188:189], v185 offset:40960
v_mfma_f32_16x16x32_bf16 v[140:143], a[152:155], a[232:235], v[140:143]
ds_read_b64_tr_b16 a[190:191], v185 offset:45056
v_mfma_f32_16x16x32_bf16 v[144:147], a[160:163], a[232:235], v[144:147]
v_mfma_f32_16x16x32_bf16 v[144:147], a[164:167], a[236:239], v[144:147]
buffer_load_dwordx4 a[8:11], v14, s[44:47], s65 offen offset:1024 sc1
v_mfma_f32_16x16x32_bf16 v[112:115], a[164:167], a[228:231], v[112:115]
ds_read_b64_tr_b16 a[192:193], v186 offset:32768
v_mfma_f32_16x16x32_bf16 v[112:115], a[160:163], a[224:227], v[112:115]
ds_read_b64_tr_b16 a[194:195], v186 offset:36864
v_mfma_f32_16x16x32_bf16 v[80:83], a[160:163], a[216:219], v[80:83]
ds_read_b64_tr_b16 a[196:197], v186 offset:40960
v_mfma_f32_16x16x32_bf16 v[80:83], a[164:167], a[220:223], v[80:83]
buffer_load_dwordx4 a[16:19], v15, s[44:47], s65 offen offset:0 sc1
v_mfma_f32_16x16x32_bf16 v[48:51], a[164:167], a[212:215], v[48:51]
ds_read_b64_tr_b16 a[198:199], v186 offset:45056
v_mfma_f32_16x16x32_bf16 v[48:51], a[160:163], a[208:211], v[48:51]
s_waitcnt lgkmcnt(4)
v_mfma_f32_16x16x32_bf16 v[52:55], a[168:171], a[208:211], v[52:55]
v_mfma_f32_16x16x32_bf16 v[52:55], a[172:175], a[212:215], v[52:55]
buffer_load_dwordx4 a[24:27], v15, s[44:47], s65 offen offset:1024 sc1
v_mfma_f32_16x16x32_bf16 v[84:87], a[172:175], a[220:223], v[84:87]
ds_read_b64_tr_b16 a[200:201], v187 offset:32768
v_mfma_f32_16x16x32_bf16 v[84:87], a[168:171], a[216:219], v[84:87]
ds_read_b64_tr_b16 a[202:203], v187 offset:36864
v_mfma_f32_16x16x32_bf16 v[116:119], a[168:171], a[224:227], v[116:119]
s_xor_b32 s65, s84, 73728
ds_read_b64_tr_b16 a[204:205], v187 offset:40960
v_mfma_f32_16x16x32_bf16 v[116:119], a[172:175], a[228:231], v[116:119]
buffer_load_dwordx4 a[4:7], v14, s[44:47], s65 offen offset:0 sc1
v_mfma_f32_16x16x32_bf16 v[148:151], a[172:175], a[236:239], v[148:151]
ds_read_b64_tr_b16 a[206:207], v187 offset:45056
v_mfma_f32_16x16x32_bf16 v[148:151], a[168:171], a[232:235], v[148:151]
v_mfma_f32_16x16x32_bf16 v[120:123], a[176:179], a[232:235], v[120:123]
v_mfma_f32_16x16x32_bf16 v[120:123], a[180:183], a[236:239], v[120:123]
buffer_load_dwordx4 a[12:15], v14, s[44:47], s65 offen offset:1024 sc1
v_mfma_f32_16x16x32_bf16 v[88:91], a[180:183], a[228:231], v[88:91]
v_mfma_f32_16x16x32_bf16 v[88:91], a[176:179], a[224:227], v[88:91]
v_mfma_f32_16x16x32_bf16 v[56:59], a[176:179], a[216:219], v[56:59]
v_mfma_f32_16x16x32_bf16 v[56:59], a[180:183], a[220:223], v[56:59]
buffer_load_dwordx4 a[20:23], v15, s[44:47], s65 offen offset:0 sc1
v_mfma_f32_16x16x32_bf16 v[24:27], a[180:183], a[212:215], v[24:27]
v_mfma_f32_16x16x32_bf16 v[24:27], a[176:179], a[208:211], v[24:27]
v_mfma_f32_16x16x32_bf16 v[28:31], a[184:187], a[208:211], v[28:31]
v_mfma_f32_16x16x32_bf16 v[28:31], a[188:191], a[212:215], v[28:31]
buffer_load_dwordx4 a[28:31], v15, s[44:47], s65 offen offset:1024 sc1
v_mfma_f32_16x16x32_bf16 v[60:63], a[188:191], a[220:223], v[60:63]
v_mfma_f32_16x16x32_bf16 v[60:63], a[184:187], a[216:219], v[60:63]
s_waitcnt vmcnt(24)
s_barrier
v_mfma_f32_16x16x32_bf16 v[92:95], a[184:187], a[224:227], v[92:95]
s_xor_b32 m0, s76, 98304
ds_read_b64_tr_b16 a[144:145], v196 offset:0
v_mfma_f32_16x16x32_bf16 v[92:95], a[188:191], a[228:231], v[92:95]
s_xor_b32 s64, s85, 786432
ds_read_b64_tr_b16 a[146:147], v196 offset:4096
v_mfma_f32_16x16x32_bf16 v[124:127], a[188:191], a[236:239], v[124:127]
buffer_load_dwordx4 v12, s[40:43], s64 offen lds
v_mfma_f32_16x16x32_bf16 v[124:127], a[184:187], a[232:235], v[124:127]
s_waitcnt lgkmcnt(2)
s_xor_b32 m0, s76, 99328
ds_read_b64_tr_b16 a[148:149], v196 offset:8192
v_mfma_f32_16x16x32_bf16 v[128:131], a[192:195], a[232:235], v[128:131]
s_xor_b32 s64, s85, 794624
ds_read_b64_tr_b16 a[150:151], v196 offset:12288
v_mfma_f32_16x16x32_bf16 v[128:131], a[196:199], a[236:239], v[128:131]
buffer_load_dwordx4 v13, s[40:43], s64 offen lds
v_mfma_f32_16x16x32_bf16 v[96:99], a[196:199], a[228:231], v[96:99]
ds_read_b64_tr_b16 a[152:153], v197 offset:0
v_mfma_f32_16x16x32_bf16 v[96:99], a[192:195], a[224:227], v[96:99]
s_xor_b32 m0, s76, 100352
ds_read_b64_tr_b16 a[154:155], v197 offset:4096
v_mfma_f32_16x16x32_bf16 v[64:67], a[192:195], a[216:219], v[64:67]
s_xor_b32 s64, s85, 802816
ds_read_b64_tr_b16 a[156:157], v197 offset:8192
v_mfma_f32_16x16x32_bf16 v[64:67], a[196:199], a[220:223], v[64:67]
buffer_load_dwordx4 v12, s[40:43], s64 offen lds
v_mfma_f32_16x16x32_bf16 v[32:35], a[196:199], a[212:215], v[32:35]
ds_read_b64_tr_b16 a[158:159], v197 offset:12288
v_mfma_f32_16x16x32_bf16 v[32:35], a[192:195], a[208:211], v[32:35]
s_xor_b32 m0, s76, 101376
ds_read_b64_tr_b16 a[160:161], v198 offset:0
v_mfma_f32_16x16x32_bf16 v[36:39], a[200:203], a[208:211], v[36:39]
s_xor_b32 s64, s85, 811008
ds_read_b64_tr_b16 a[162:163], v198 offset:4096
v_mfma_f32_16x16x32_bf16 v[36:39], a[204:207], a[212:215], v[36:39]
buffer_load_dwordx4 v13, s[40:43], s64 offen lds
v_mfma_f32_16x16x32_bf16 v[68:71], a[204:207], a[220:223], v[68:71]
ds_read_b64_tr_b16 a[164:165], v198 offset:8192
v_mfma_f32_16x16x32_bf16 v[68:71], a[200:203], a[216:219], v[68:71]
s_xor_b32 m0, s76, 102400
ds_read_b64_tr_b16 a[166:167], v198 offset:12288
v_mfma_f32_16x16x32_bf16 v[100:103], a[200:203], a[224:227], v[100:103]
s_xor_b32 s64, s85, 819200
v_mfma_f32_16x16x32_bf16 v[100:103], a[204:207], a[228:231], v[100:103]
buffer_load_dwordx4 v12, s[40:43], s64 offen lds
v_mfma_f32_16x16x32_bf16 v[132:135], a[204:207], a[236:239], v[132:135]
v_mfma_f32_16x16x32_bf16 v[132:135], a[200:203], a[232:235], v[132:135]
s_waitcnt vmcnt(25)
s_waitcnt lgkmcnt(3)
s_xor_b32 m0, s76, 103424
buffer_load_dword v19, off, s[52:55], s72 offset:128 sc1
v_mfma_f32_16x16x32_bf16 v[136:139], a[144:147], v[176:179], v[136:139]
s_waitcnt vmcnt(22)
s_xor_b32 s64, s85, 827392
ds_read_b64_tr_b16 a[168:169], v199 offset:0
v_mfma_f32_16x16x32_bf16 v[136:139], a[148:151], v[180:183], v[136:139]
buffer_load_dwordx4 v13, s[40:43], s64 offen lds
v_mfma_f32_16x16x32_bf16 v[104:107], a[148:151], v[172:175], v[104:107]
ds_read_b64_tr_b16 a[170:171], v199 offset:4096
v_mfma_f32_16x16x32_bf16 v[104:107], a[144:147], v[168:171], v[104:107]
s_xor_b32 m0, s76, 104448
ds_read_b64_tr_b16 a[172:173], v199 offset:8192
v_mfma_f32_16x16x32_bf16 v[72:75], a[144:147], v[160:163], v[72:75]
s_xor_b32 s64, s85, 835584
ds_read_b64_tr_b16 a[174:175], v199 offset:12288
v_mfma_f32_16x16x32_bf16 v[72:75], a[148:151], v[164:167], v[72:75]
buffer_load_dwordx4 v12, s[40:43], s64 offen lds
v_mfma_f32_16x16x32_bf16 v[40:43], a[148:151], v[156:159], v[40:43]
ds_read_b64_tr_b16 a[176:177], v192 offset:0
v_mfma_f32_16x16x32_bf16 v[40:43], a[144:147], v[152:155], v[40:43]
s_xor_b32 m0, s76, 105472
ds_read_b64_tr_b16 a[178:179], v192 offset:4096
v_mfma_f32_16x16x32_bf16 v[44:47], a[152:155], v[152:155], v[44:47]
s_xor_b32 s64, s85, 843776
ds_read_b64_tr_b16 a[180:181], v192 offset:8192
v_mfma_f32_16x16x32_bf16 v[44:47], a[156:159], v[156:159], v[44:47]
buffer_load_dwordx4 v13, s[40:43], s64 offen lds
v_mfma_f32_16x16x32_bf16 v[76:79], a[156:159], v[164:167], v[76:79]
ds_read_b64_tr_b16 a[182:183], v192 offset:12288
v_mfma_f32_16x16x32_bf16 v[76:79], a[152:155], v[160:163], v[76:79]
ds_read_b64_tr_b16 a[184:185], v193 offset:0
v_mfma_f32_16x16x32_bf16 v[108:111], a[152:155], v[168:171], v[108:111]
s_xor_b32 s65, s84, 98304
ds_read_b64_tr_b16 a[186:187], v193 offset:4096
v_mfma_f32_16x16x32_bf16 v[108:111], a[156:159], v[172:175], v[108:111]
buffer_load_dwordx4 a[32:35], v14, s[44:47], s65 offen offset:0 sc1
v_mfma_f32_16x16x32_bf16 v[140:143], a[156:159], v[180:183], v[140:143]
ds_read_b64_tr_b16 a[188:189], v193 offset:8192
v_mfma_f32_16x16x32_bf16 v[140:143], a[152:155], v[176:179], v[140:143]
s_waitcnt lgkmcnt(5)
ds_read_b64_tr_b16 a[190:191], v193 offset:12288
v_mfma_f32_16x16x32_bf16 v[144:147], a[160:163], v[176:179], v[144:147]
s_lshl_b32 s75, s73, 20
s_add_u32 s85, s85, s75
s_lshr_b32 s74, s73, 28
v_mfma_f32_16x16x32_bf16 v[144:147], a[164:167], v[180:183], v[144:147]
s_and_b32 s74, s74, 8
buffer_load_dwordx4 a[40:43], v14, s[44:47], s65 offen offset:1024 sc1
v_mfma_f32_16x16x32_bf16 v[112:115], a[164:167], v[172:175], v[112:115]
ds_read_b64_tr_b16 a[192:193], v194 offset:0
v_mfma_f32_16x16x32_bf16 v[112:115], a[160:163], v[168:171], v[112:115]
ds_read_b64_tr_b16 a[194:195], v194 offset:4096
v_mfma_f32_16x16x32_bf16 v[80:83], a[160:163], v[160:163], v[80:83]
ds_read_b64_tr_b16 a[196:197], v194 offset:8192
v_mfma_f32_16x16x32_bf16 v[80:83], a[164:167], v[164:167], v[80:83]
buffer_load_dwordx4 a[48:51], v15, s[44:47], s65 offen offset:0 sc1
v_mfma_f32_16x16x32_bf16 v[48:51], a[164:167], v[156:159], v[48:51]
ds_read_b64_tr_b16 a[198:199], v194 offset:12288
v_mfma_f32_16x16x32_bf16 v[48:51], a[160:163], v[152:155], v[48:51]
v_mfma_f32_16x16x32_bf16 v[52:55], a[168:171], v[152:155], v[52:55]
v_mfma_f32_16x16x32_bf16 v[52:55], a[172:175], v[156:159], v[52:55]
buffer_load_dwordx4 a[56:59], v15, s[44:47], s65 offen offset:1024 sc1
v_mfma_f32_16x16x32_bf16 v[84:87], a[172:175], v[164:167], v[84:87]
ds_read_b64_tr_b16 a[200:201], v195 offset:0
v_mfma_f32_16x16x32_bf16 v[84:87], a[168:171], v[160:163], v[84:87]
ds_read_b64_tr_b16 a[202:203], v195 offset:4096
v_mfma_f32_16x16x32_bf16 v[116:119], a[168:171], v[168:171], v[116:119]
s_xor_b32 s65, s84, 106496
ds_read_b64_tr_b16 a[204:205], v195 offset:8192
v_mfma_f32_16x16x32_bf16 v[116:119], a[172:175], v[172:175], v[116:119]
buffer_load_dwordx4 a[36:39], v14, s[44:47], s65 offen offset:0 sc1
v_mfma_f32_16x16x32_bf16 v[148:151], a[172:175], v[180:183], v[148:151]
ds_read_b64_tr_b16 a[206:207], v195 offset:12288
v_mfma_f32_16x16x32_bf16 v[148:151], a[168:171], v[176:179], v[148:151]
v_mfma_f32_16x16x32_bf16 v[120:123], a[176:179], v[176:179], v[120:123]
s_waitcnt lgkmcnt(4)
v_mfma_f32_16x16x32_bf16 v[120:123], a[180:183], v[180:183], v[120:123]
buffer_load_dwordx4 a[44:47], v14, s[44:47], s65 offen offset:1024 sc1
v_mfma_f32_16x16x32_bf16 v[88:91], a[180:183], v[172:175], v[88:91]
v_mfma_f32_16x16x32_bf16 v[88:91], a[176:179], v[168:171], v[88:91]
v_mfma_f32_16x16x32_bf16 v[56:59], a[176:179], v[160:163], v[56:59]
v_mfma_f32_16x16x32_bf16 v[56:59], a[180:183], v[164:167], v[56:59]
buffer_load_dwordx4 a[52:55], v15, s[44:47], s65 offen offset:0 sc1
v_mfma_f32_16x16x32_bf16 v[24:27], a[180:183], v[156:159], v[24:27]
v_mfma_f32_16x16x32_bf16 v[24:27], a[176:179], v[152:155], v[24:27]
v_mfma_f32_16x16x32_bf16 v[28:31], a[184:187], v[152:155], v[28:31]
v_mfma_f32_16x16x32_bf16 v[28:31], a[188:191], v[156:159], v[28:31]
buffer_load_dwordx4 a[60:63], v15, s[44:47], s65 offen offset:1024 sc1
v_mfma_f32_16x16x32_bf16 v[60:63], a[188:191], v[164:167], v[60:63]
v_mfma_f32_16x16x32_bf16 v[60:63], a[184:187], v[160:163], v[60:63]
s_waitcnt vmcnt(25)
s_barrier
v_mfma_f32_16x16x32_bf16 v[92:95], a[184:187], v[168:171], v[92:95]
s_lshl_b32 s75, s73, 17
s_add_u32 s84, s84, s75
s_xor_b32 m0, s76, 131072
ds_read_b64_tr_b16 a[144:145], v196 offset:32768
v_mfma_f32_16x16x32_bf16 v[92:95], a[188:191], v[172:175], v[92:95]
s_xor_b32 s64, s85, 0
ds_read_b64_tr_b16 a[146:147], v196 offset:36864
v_mfma_f32_16x16x32_bf16 v[124:127], a[188:191], v[180:183], v[124:127]
buffer_load_dwordx4 v12, s[40:43], s64 offen lds
v_mfma_f32_16x16x32_bf16 v[124:127], a[184:187], v[176:179], v[124:127]
s_xor_b32 m0, s76, 132096
ds_read_b64_tr_b16 a[148:149], v196 offset:40960
v_mfma_f32_16x16x32_bf16 v[128:131], a[192:195], v[176:179], v[128:131]
s_xor_b32 s64, s85, 8192
ds_read_b64_tr_b16 a[150:151], v196 offset:45056
v_mfma_f32_16x16x32_bf16 v[128:131], a[196:199], v[180:183], v[128:131]
buffer_load_dwordx4 v13, s[40:43], s64 offen lds
v_mfma_f32_16x16x32_bf16 v[96:99], a[196:199], v[172:175], v[96:99]
ds_read_b64_tr_b16 a[152:153], v197 offset:32768
v_mfma_f32_16x16x32_bf16 v[96:99], a[192:195], v[168:171], v[96:99]
s_xor_b32 m0, s76, 133120
ds_read_b64_tr_b16 a[154:155], v197 offset:36864
v_mfma_f32_16x16x32_bf16 v[64:67], a[192:195], v[160:163], v[64:67]
s_xor_b32 s64, s85, 16384
ds_read_b64_tr_b16 a[156:157], v197 offset:40960
v_mfma_f32_16x16x32_bf16 v[64:67], a[196:199], v[164:167], v[64:67]
buffer_load_dwordx4 v12, s[40:43], s64 offen lds
v_mfma_f32_16x16x32_bf16 v[32:35], a[196:199], v[156:159], v[32:35]
ds_read_b64_tr_b16 a[158:159], v197 offset:45056
v_mfma_f32_16x16x32_bf16 v[32:35], a[192:195], v[152:155], v[32:35]
s_waitcnt lgkmcnt(5)
s_xor_b32 m0, s76, 134144
ds_read_b64_tr_b16 a[160:161], v198 offset:32768
v_mfma_f32_16x16x32_bf16 v[36:39], a[200:203], v[152:155], v[36:39]
s_xor_b32 s64, s85, 24576
ds_read_b64_tr_b16 a[162:163], v198 offset:36864
v_mfma_f32_16x16x32_bf16 v[36:39], a[204:207], v[156:159], v[36:39]
buffer_load_dwordx4 v13, s[40:43], s64 offen lds
v_mfma_f32_16x16x32_bf16 v[68:71], a[204:207], v[164:167], v[68:71]
ds_read_b64_tr_b16 a[164:165], v198 offset:40960
v_mfma_f32_16x16x32_bf16 v[68:71], a[200:203], v[160:163], v[68:71]
s_xor_b32 m0, s76, 135168
ds_read_b64_tr_b16 a[166:167], v198 offset:45056
v_mfma_f32_16x16x32_bf16 v[100:103], a[200:203], v[168:171], v[100:103]
s_xor_b32 s64, s85, 32768
v_mfma_f32_16x16x32_bf16 v[100:103], a[204:207], v[172:175], v[100:103]
buffer_load_dwordx4 v12, s[40:43], s64 offen lds
v_mfma_f32_16x16x32_bf16 v[132:135], a[204:207], v[180:183], v[132:135]
v_mfma_f32_16x16x32_bf16 v[132:135], a[200:203], v[176:179], v[132:135]
s_waitcnt vmcnt(26)
v_mfma_f32_16x16x32_bf16 v[136:139], a[144:147], a[24:27], v[136:139]
s_waitcnt vmcnt(16)
v_readfirstlane_b32 vcc_lo, v19
s_nop 0
s_cmp_lt_u32 vcc_lo, s74
s_cbranch_scc1 L_spin_4022
L_spinbk_4023:
s_waitcnt lgkmcnt(2)
v_mfma_f32_16x16x32_bf16 v[136:139], a[148:151], a[28:31], v[136:139]
s_xor_b32 m0, s76, 136192
ds_read_b64_tr_b16 a[168:169], v199 offset:32768
v_mfma_f32_16x16x32_bf16 v[104:107], a[148:151], a[20:23], v[104:107]
s_xor_b32 s64, s85, 40960
ds_read_b64_tr_b16 a[170:171], v199 offset:36864
v_mfma_f32_16x16x32_bf16 v[104:107], a[144:147], a[16:19], v[104:107]
buffer_load_dwordx4 v13, s[40:43], s64 offen lds
v_mfma_f32_16x16x32_bf16 v[72:75], a[144:147], a[8:11], v[72:75]
s_xor_b32 m0, s76, 137216
ds_read_b64_tr_b16 a[172:173], v199 offset:40960
v_mfma_f32_16x16x32_bf16 v[72:75], a[148:151], a[12:15], v[72:75]
s_xor_b32 s64, s85, 49152
ds_read_b64_tr_b16 a[174:175], v199 offset:45056
v_mfma_f32_16x16x32_bf16 v[40:43], a[148:151], a[4:7], v[40:43]
buffer_load_dwordx4 v12, s[40:43], s64 offen lds
v_mfma_f32_16x16x32_bf16 v[40:43], a[144:147], a[0:3], v[40:43]
ds_read_b64_tr_b16 a[176:177], v192 offset:32768
v_mfma_f32_16x16x32_bf16 v[44:47], a[152:155], a[0:3], v[44:47]
s_xor_b32 m0, s76, 138240
ds_read_b64_tr_b16 a[178:179], v192 offset:36864
v_mfma_f32_16x16x32_bf16 v[44:47], a[156:159], a[4:7], v[44:47]
s_xor_b32 s64, s85, 57344
ds_read_b64_tr_b16 a[180:181], v192 offset:40960
v_mfma_f32_16x16x32_bf16 v[76:79], a[156:159], a[12:15], v[76:79]
buffer_load_dwordx4 v13, s[40:43], s64 offen lds
v_mfma_f32_16x16x32_bf16 v[76:79], a[152:155], a[8:11], v[76:79]
ds_read_b64_tr_b16 a[182:183], v192 offset:45056
v_mfma_f32_16x16x32_bf16 v[108:111], a[152:155], a[16:19], v[108:111]
ds_read_b64_tr_b16 a[184:185], v193 offset:32768
v_mfma_f32_16x16x32_bf16 v[108:111], a[156:159], a[20:23], v[108:111]
s_xor_b32 s65, s84, 0
ds_read_b64_tr_b16 a[186:187], v193 offset:36864
v_mfma_f32_16x16x32_bf16 v[140:143], a[156:159], a[28:31], v[140:143]
buffer_load_dwordx4 a[208:211], v14, s[44:47], s65 offen offset:0 sc1
v_mfma_f32_16x16x32_bf16 v[140:143], a[152:155], a[24:27], v[140:143]
ds_read_b64_tr_b16 a[188:189], v193 offset:40960
v_mfma_f32_16x16x32_bf16 v[144:147], a[160:163], a[24:27], v[144:147]
s_waitcnt lgkmcnt(5)
ds_read_b64_tr_b16 a[190:191], v193 offset:45056
v_mfma_f32_16x16x32_bf16 v[144:147], a[164:167], a[28:31], v[144:147]
v_mfma_f32_16x16x32_bf16 v[112:115], a[164:167], a[20:23], v[112:115]
buffer_load_dwordx4 a[216:219], v14, s[44:47], s65 offen offset:1024 sc1
v_mfma_f32_16x16x32_bf16 v[112:115], a[160:163], a[16:19], v[112:115]
ds_read_b64_tr_b16 a[192:193], v194 offset:32768
v_mfma_f32_16x16x32_bf16 v[80:83], a[160:163], a[8:11], v[80:83]
ds_read_b64_tr_b16 a[194:195], v194 offset:36864
v_mfma_f32_16x16x32_bf16 v[80:83], a[164:167], a[12:15], v[80:83]
ds_read_b64_tr_b16 a[196:197], v194 offset:40960
v_mfma_f32_16x16x32_bf16 v[48:51], a[164:167], a[4:7], v[48:51]
buffer_load_dwordx4 a[224:227], v15, s[44:47], s65 offen offset:0 sc1
v_mfma_f32_16x16x32_bf16 v[48:51], a[160:163], a[0:3], v[48:51]
ds_read_b64_tr_b16 a[198:199], v194 offset:45056
v_mfma_f32_16x16x32_bf16 v[52:55], a[168:171], a[0:3], v[52:55]
v_mfma_f32_16x16x32_bf16 v[52:55], a[172:175], a[4:7], v[52:55]
buffer_load_dwordx4 a[232:235], v15, s[44:47], s65 offen offset:1024 sc1
v_mfma_f32_16x16x32_bf16 v[84:87], a[172:175], a[12:15], v[84:87]
ds_read_b64_tr_b16 a[200:201], v195 offset:32768
v_mfma_f32_16x16x32_bf16 v[84:87], a[168:171], a[8:11], v[84:87]
ds_read_b64_tr_b16 a[202:203], v195 offset:36864
v_mfma_f32_16x16x32_bf16 v[116:119], a[168:171], a[16:19], v[116:119]
s_xor_b32 s65, s84, 8192
ds_read_b64_tr_b16 a[204:205], v195 offset:40960
v_mfma_f32_16x16x32_bf16 v[116:119], a[172:175], a[20:23], v[116:119]
buffer_load_dwordx4 a[212:215], v14, s[44:47], s65 offen offset:0 sc1
v_mfma_f32_16x16x32_bf16 v[148:151], a[172:175], a[28:31], v[148:151]
ds_read_b64_tr_b16 a[206:207], v195 offset:45056
v_mfma_f32_16x16x32_bf16 v[148:151], a[168:171], a[24:27], v[148:151]
v_mfma_f32_16x16x32_bf16 v[120:123], a[176:179], a[24:27], v[120:123]
s_waitcnt lgkmcnt(4)
v_mfma_f32_16x16x32_bf16 v[120:123], a[180:183], a[28:31], v[120:123]
buffer_load_dwordx4 a[220:223], v14, s[44:47], s65 offen offset:1024 sc1
v_mfma_f32_16x16x32_bf16 v[88:91], a[180:183], a[20:23], v[88:91]
v_mfma_f32_16x16x32_bf16 v[88:91], a[176:179], a[16:19], v[88:91]
v_mfma_f32_16x16x32_bf16 v[56:59], a[176:179], a[8:11], v[56:59]
v_mfma_f32_16x16x32_bf16 v[56:59], a[180:183], a[12:15], v[56:59]
buffer_load_dwordx4 a[228:231], v15, s[44:47], s65 offen offset:0 sc1
v_mfma_f32_16x16x32_bf16 v[24:27], a[180:183], a[4:7], v[24:27]
v_mfma_f32_16x16x32_bf16 v[24:27], a[176:179], a[0:3], v[24:27]
v_mfma_f32_16x16x32_bf16 v[28:31], a[184:187], a[0:3], v[28:31]
v_mfma_f32_16x16x32_bf16 v[28:31], a[188:191], a[4:7], v[28:31]
buffer_load_dwordx4 a[236:239], v15, s[44:47], s65 offen offset:1024 sc1
v_mfma_f32_16x16x32_bf16 v[60:63], a[188:191], a[12:15], v[60:63]
v_mfma_f32_16x16x32_bf16 v[60:63], a[184:187], a[8:11], v[60:63]
s_waitcnt vmcnt(24)
s_barrier
v_mfma_f32_16x16x32_bf16 v[92:95], a[184:187], a[16:19], v[92:95]
s_xor_b32 m0, s76, 32768
ds_read_b64_tr_b16 a[144:145], v188 offset:0
v_mfma_f32_16x16x32_bf16 v[92:95], a[188:191], a[20:23], v[92:95]
s_xor_b32 s64, s85, 262144
ds_read_b64_tr_b16 a[146:147], v188 offset:4096
v_mfma_f32_16x16x32_bf16 v[124:127], a[188:191], a[28:31], v[124:127]
buffer_load_dwordx4 v12, s[40:43], s64 offen lds
v_mfma_f32_16x16x32_bf16 v[124:127], a[184:187], a[24:27], v[124:127]
s_xor_b32 m0, s76, 33792
ds_read_b64_tr_b16 a[148:149], v188 offset:8192
v_mfma_f32_16x16x32_bf16 v[128:131], a[192:195], a[24:27], v[128:131]
s_xor_b32 s64, s85, 270336
ds_read_b64_tr_b16 a[150:151], v188 offset:12288
v_mfma_f32_16x16x32_bf16 v[128:131], a[196:199], a[28:31], v[128:131]
buffer_load_dwordx4 v13, s[40:43], s64 offen lds
v_mfma_f32_16x16x32_bf16 v[96:99], a[196:199], a[20:23], v[96:99]
ds_read_b64_tr_b16 a[152:153], v189 offset:0
v_mfma_f32_16x16x32_bf16 v[96:99], a[192:195], a[16:19], v[96:99]
s_xor_b32 m0, s76, 34816
ds_read_b64_tr_b16 a[154:155], v189 offset:4096
v_mfma_f32_16x16x32_bf16 v[64:67], a[192:195], a[8:11], v[64:67]
s_xor_b32 s64, s85, 278528
ds_read_b64_tr_b16 a[156:157], v189 offset:8192
v_mfma_f32_16x16x32_bf16 v[64:67], a[196:199], a[12:15], v[64:67]
buffer_load_dwordx4 v12, s[40:43], s64 offen lds
v_mfma_f32_16x16x32_bf16 v[32:35], a[196:199], a[4:7], v[32:35]
ds_read_b64_tr_b16 a[158:159], v189 offset:12288
v_mfma_f32_16x16x32_bf16 v[32:35], a[192:195], a[0:3], v[32:35]
s_waitcnt lgkmcnt(5)
s_xor_b32 m0, s76, 35840
ds_read_b64_tr_b16 a[160:161], v190 offset:0
v_mfma_f32_16x16x32_bf16 v[36:39], a[200:203], a[0:3], v[36:39]
s_xor_b32 s64, s85, 286720
ds_read_b64_tr_b16 a[162:163], v190 offset:4096
v_mfma_f32_16x16x32_bf16 v[36:39], a[204:207], a[4:7], v[36:39]
buffer_load_dwordx4 v13, s[40:43], s64 offen lds
v_mfma_f32_16x16x32_bf16 v[68:71], a[204:207], a[12:15], v[68:71]
ds_read_b64_tr_b16 a[164:165], v190 offset:8192
v_mfma_f32_16x16x32_bf16 v[68:71], a[200:203], a[8:11], v[68:71]
s_xor_b32 m0, s76, 36864
ds_read_b64_tr_b16 a[166:167], v190 offset:12288
v_mfma_f32_16x16x32_bf16 v[100:103], a[200:203], a[16:19], v[100:103]
s_xor_b32 s64, s85, 294912
v_mfma_f32_16x16x32_bf16 v[100:103], a[204:207], a[20:23], v[100:103]
buffer_load_dwordx4 v12, s[40:43], s64 offen lds
v_mfma_f32_16x16x32_bf16 v[132:135], a[204:207], a[28:31], v[132:135]
v_mfma_f32_16x16x32_bf16 v[132:135], a[200:203], a[24:27], v[132:135]
s_waitcnt vmcnt(25)
s_xor_b32 m0, s76, 37888
v_mfma_f32_16x16x32_bf16 v[136:139], a[144:147], a[56:59], v[136:139]
s_waitcnt vmcnt(21)
s_waitcnt lgkmcnt(2)
s_xor_b32 s64, s85, 303104
ds_read_b64_tr_b16 a[168:169], v191 offset:0
v_mfma_f32_16x16x32_bf16 v[136:139], a[148:151], a[60:63], v[136:139]
buffer_load_dwordx4 v13, s[40:43], s64 offen lds
v_mfma_f32_16x16x32_bf16 v[104:107], a[148:151], a[52:55], v[104:107]
ds_read_b64_tr_b16 a[170:171], v191 offset:4096
v_mfma_f32_16x16x32_bf16 v[104:107], a[144:147], a[48:51], v[104:107]
s_xor_b32 m0, s76, 38912
ds_read_b64_tr_b16 a[172:173], v191 offset:8192
v_mfma_f32_16x16x32_bf16 v[72:75], a[144:147], a[40:43], v[72:75]
s_xor_b32 s64, s85, 311296
ds_read_b64_tr_b16 a[174:175], v191 offset:12288
v_mfma_f32_16x16x32_bf16 v[72:75], a[148:151], a[44:47], v[72:75]
buffer_load_dwordx4 v12, s[40:43], s64 offen lds
v_mfma_f32_16x16x32_bf16 v[40:43], a[148:151], a[36:39], v[40:43]
ds_read_b64_tr_b16 a[176:177], v184 offset:0
v_mfma_f32_16x16x32_bf16 v[40:43], a[144:147], a[32:35], v[40:43]
s_xor_b32 m0, s76, 39936
ds_read_b64_tr_b16 a[178:179], v184 offset:4096
v_mfma_f32_16x16x32_bf16 v[44:47], a[152:155], a[32:35], v[44:47]
s_xor_b32 s64, s85, 319488
ds_read_b64_tr_b16 a[180:181], v184 offset:8192
v_mfma_f32_16x16x32_bf16 v[44:47], a[156:159], a[36:39], v[44:47]
buffer_load_dwordx4 v13, s[40:43], s64 offen lds
v_mfma_f32_16x16x32_bf16 v[76:79], a[156:159], a[44:47], v[76:79]
ds_read_b64_tr_b16 a[182:183], v184 offset:12288
v_mfma_f32_16x16x32_bf16 v[76:79], a[152:155], a[40:43], v[76:79]
ds_read_b64_tr_b16 a[184:185], v185 offset:0
v_mfma_f32_16x16x32_bf16 v[108:111], a[152:155], a[48:51], v[108:111]
s_xor_b32 s65, s84, 32768
ds_read_b64_tr_b16 a[186:187], v185 offset:4096
v_mfma_f32_16x16x32_bf16 v[108:111], a[156:159], a[52:55], v[108:111]
buffer_load_dwordx4 v[152:155], v14, s[44:47], s65 offen offset:0 sc1
v_mfma_f32_16x16x32_bf16 v[140:143], a[156:159], a[60:63], v[140:143]
ds_read_b64_tr_b16 a[188:189], v185 offset:8192
v_mfma_f32_16x16x32_bf16 v[140:143], a[152:155], a[56:59], v[140:143]
ds_read_b64_tr_b16 a[190:191], v185 offset:12288
v_mfma_f32_16x16x32_bf16 v[144:147], a[160:163], a[56:59], v[144:147]
s_waitcnt lgkmcnt(5)
v_mfma_f32_16x16x32_bf16 v[144:147], a[164:167], a[60:63], v[144:147]
buffer_load_dwordx4 v[160:163], v14, s[44:47], s65 offen offset:1024 sc1
v_mfma_f32_16x16x32_bf16 v[112:115], a[164:167], a[52:55], v[112:115]
ds_read_b64_tr_b16 a[192:193], v186 offset:0
v_mfma_f32_16x16x32_bf16 v[112:115], a[160:163], a[48:51], v[112:115]
ds_read_b64_tr_b16 a[194:195], v186 offset:4096
v_mfma_f32_16x16x32_bf16 v[80:83], a[160:163], a[40:43], v[80:83]
ds_read_b64_tr_b16 a[196:197], v186 offset:8192
v_mfma_f32_16x16x32_bf16 v[80:83], a[164:167], a[44:47], v[80:83]
buffer_load_dwordx4 v[168:171], v15, s[44:47], s65 offen offset:0 sc1
v_mfma_f32_16x16x32_bf16 v[48:51], a[164:167], a[36:39], v[48:51]
ds_read_b64_tr_b16 a[198:199], v186 offset:12288
v_mfma_f32_16x16x32_bf16 v[48:51], a[160:163], a[32:35], v[48:51]
v_mfma_f32_16x16x32_bf16 v[52:55], a[168:171], a[32:35], v[52:55]
v_mfma_f32_16x16x32_bf16 v[52:55], a[172:175], a[36:39], v[52:55]
buffer_load_dwordx4 v[176:179], v15, s[44:47], s65 offen offset:1024 sc1
v_mfma_f32_16x16x32_bf16 v[84:87], a[172:175], a[44:47], v[84:87]
ds_read_b64_tr_b16 a[200:201], v187 offset:0
v_mfma_f32_16x16x32_bf16 v[84:87], a[168:171], a[40:43], v[84:87]
ds_read_b64_tr_b16 a[202:203], v187 offset:4096
v_mfma_f32_16x16x32_bf16 v[116:119], a[168:171], a[48:51], v[116:119]
s_xor_b32 s65, s84, 40960
ds_read_b64_tr_b16 a[204:205], v187 offset:8192
v_mfma_f32_16x16x32_bf16 v[116:119], a[172:175], a[52:55], v[116:119]
buffer_load_dwordx4 v[156:159], v14, s[44:47], s65 offen offset:0 sc1
v_mfma_f32_16x16x32_bf16 v[148:151], a[172:175], a[60:63], v[148:151]
ds_read_b64_tr_b16 a[206:207], v187 offset:12288
v_mfma_f32_16x16x32_bf16 v[148:151], a[168:171], a[56:59], v[148:151]
v_mfma_f32_16x16x32_bf16 v[120:123], a[176:179], a[56:59], v[120:123]
s_waitcnt lgkmcnt(4)
v_mfma_f32_16x16x32_bf16 v[120:123], a[180:183], a[60:63], v[120:123]
buffer_load_dwordx4 v[164:167], v14, s[44:47], s65 offen offset:1024 sc1
v_mfma_f32_16x16x32_bf16 v[88:91], a[180:183], a[52:55], v[88:91]
v_mfma_f32_16x16x32_bf16 v[88:91], a[176:179], a[48:51], v[88:91]
v_mfma_f32_16x16x32_bf16 v[56:59], a[176:179], a[40:43], v[56:59]
v_mfma_f32_16x16x32_bf16 v[56:59], a[180:183], a[44:47], v[56:59]
buffer_load_dwordx4 v[172:175], v15, s[44:47], s65 offen offset:0 sc1
v_mfma_f32_16x16x32_bf16 v[24:27], a[180:183], a[36:39], v[24:27]
v_mfma_f32_16x16x32_bf16 v[24:27], a[176:179], a[32:35], v[24:27]
v_mfma_f32_16x16x32_bf16 v[28:31], a[184:187], a[32:35], v[28:31]
v_mfma_f32_16x16x32_bf16 v[28:31], a[188:191], a[36:39], v[28:31]
buffer_load_dwordx4 v[180:183], v15, s[44:47], s65 offen offset:1024 sc1
v_mfma_f32_16x16x32_bf16 v[60:63], a[188:191], a[44:47], v[60:63]
v_mfma_f32_16x16x32_bf16 v[60:63], a[184:187], a[40:43], v[60:63]
s_waitcnt vmcnt(24)
s_barrier
v_mfma_f32_16x16x32_bf16 v[92:95], a[184:187], a[48:51], v[92:95]
s_xor_b32 m0, s76, 65536
ds_read_b64_tr_b16 a[144:145], v188 offset:32768
v_mfma_f32_16x16x32_bf16 v[92:95], a[188:191], a[52:55], v[92:95]
s_xor_b32 s64, s85, 524288
ds_read_b64_tr_b16 a[146:147], v188 offset:36864
v_mfma_f32_16x16x32_bf16 v[124:127], a[188:191], a[60:63], v[124:127]
buffer_load_dwordx4 v12, s[40:43], s64 offen lds
v_mfma_f32_16x16x32_bf16 v[124:127], a[184:187], a[56:59], v[124:127]
s_xor_b32 m0, s76, 66560
ds_read_b64_tr_b16 a[148:149], v188 offset:40960
v_mfma_f32_16x16x32_bf16 v[128:131], a[192:195], a[56:59], v[128:131]
s_xor_b32 s64, s85, 532480
ds_read_b64_tr_b16 a[150:151], v188 offset:45056
v_mfma_f32_16x16x32_bf16 v[128:131], a[196:199], a[60:63], v[128:131]
buffer_load_dwordx4 v13, s[40:43], s64 offen lds
v_mfma_f32_16x16x32_bf16 v[96:99], a[196:199], a[52:55], v[96:99]
ds_read_b64_tr_b16 a[152:153], v189 offset:32768
v_mfma_f32_16x16x32_bf16 v[96:99], a[192:195], a[48:51], v[96:99]
s_branch L_po24
L_pg24:
s_branch L_tr2
L_po24:
s_xor_b32 m0, s76, 67584
ds_read_b64_tr_b16 a[154:155], v189 offset:36864
v_mfma_f32_16x16x32_bf16 v[64:67], a[192:195], a[40:43], v[64:67]
s_xor_b32 s64, s85, 540672
ds_read_b64_tr_b16 a[156:157], v189 offset:40960
v_mfma_f32_16x16x32_bf16 v[64:67], a[196:199], a[44:47], v[64:67]
buffer_load_dwordx4 v12, s[40:43], s64 offen lds
v_mfma_f32_16x16x32_bf16 v[32:35], a[196:199], a[36:39], v[32:35]
ds_read_b64_tr_b16 a[158:159], v189 offset:45056
v_mfma_f32_16x16x32_bf16 v[32:35], a[192:195], a[32:35], v[32:35]
s_waitcnt lgkmcnt(5)
s_xor_b32 m0, s76, 68608
ds_read_b64_tr_b16 a[160:161], v190 offset:32768
v_mfma_f32_16x16x32_bf16 v[36:39], a[200:203], a[32:35], v[36:39]
s_xor_b32 s64, s85, 548864
ds_read_b64_tr_b16 a[162:163], v190 offset:36864
v_mfma_f32_16x16x32_bf16 v[36:39], a[204:207], a[36:39], v[36:39]
buffer_load_dwordx4 v13, s[40:43], s64 offen lds
v_mfma_f32_16x16x32_bf16 v[68:71], a[204:207], a[44:47], v[68:71]
ds_read_b64_tr_b16 a[164:165], v190 offset:40960
v_mfma_f32_16x16x32_bf16 v[68:71], a[200:203], a[40:43], v[68:71]
s_xor_b32 m0, s76, 69632
ds_read_b64_tr_b16 a[166:167], v190 offset:45056
v_mfma_f32_16x16x32_bf16 v[100:103], a[200:203], a[48:51], v[100:103]
s_xor_b32 s64, s85, 557056
v_mfma_f32_16x16x32_bf16 v[100:103], a[204:207], a[52:55], v[100:103]
buffer_load_dwordx4 v12, s[40:43], s64 offen lds
v_mfma_f32_16x16x32_bf16 v[132:135], a[204:207], a[60:63], v[132:135]
s_sub_u32 s73, 1, s73
s_sub_u32 s70, s70, 1
s_cmp_lg_u32 s70, 0
v_mfma_f32_16x16x32_bf16 v[132:135], a[200:203], a[56:59], v[132:135]
s_cbranch_scc1 L_p5loop
L_p5last:
s_waitcnt lgkmcnt(10)
s_waitcnt vmcnt(25)
v_mfma_f32_16x16x32_bf16 v[136:139], a[144:147], a[232:235], v[136:139]
s_waitcnt vmcnt(21)
s_waitcnt lgkmcnt(8)
s_xor_b32 m0, s76, 70656
s_xor_b32 s64, s85, 565248
ds_read_b64_tr_b16 a[168:169], v191 offset:32768
v_mfma_f32_16x16x32_bf16 v[136:139], a[148:151], a[236:239], v[136:139]
buffer_load_dwordx4 v13, s[40:43], s64 offen lds
v_mfma_f32_16x16x32_bf16 v[104:107], a[148:151], a[228:231], v[104:107]
ds_read_b64_tr_b16 a[170:171], v191 offset:36864
v_mfma_f32_16x16x32_bf16 v[104:107], a[144:147], a[224:227], v[104:107]
s_xor_b32 m0, s76, 71680
ds_read_b64_tr_b16 a[172:173], v191 offset:40960
v_mfma_f32_16x16x32_bf16 v[72:75], a[144:147], a[216:219], v[72:75]
s_xor_b32 s64, s85, 573440
ds_read_b64_tr_b16 a[174:175], v191 offset:45056
v_mfma_f32_16x16x32_bf16 v[72:75], a[148:151], a[220:223], v[72:75]
buffer_load_dwordx4 v12, s[40:43], s64 offen lds
v_mfma_f32_16x16x32_bf16 v[40:43], a[148:151], a[212:215], v[40:43]
ds_read_b64_tr_b16 a[176:177], v184 offset:32768
v_mfma_f32_16x16x32_bf16 v[40:43], a[144:147], a[208:211], v[40:43]
s_waitcnt lgkmcnt(5)
s_xor_b32 m0, s76, 72704
ds_read_b64_tr_b16 a[178:179], v184 offset:36864
v_mfma_f32_16x16x32_bf16 v[44:47], a[152:155], a[208:211], v[44:47]
s_xor_b32 s64, s85, 581632
ds_read_b64_tr_b16 a[180:181], v184 offset:40960
v_mfma_f32_16x16x32_bf16 v[44:47], a[156:159], a[212:215], v[44:47]
buffer_load_dwordx4 v13, s[40:43], s64 offen lds
v_mfma_f32_16x16x32_bf16 v[76:79], a[156:159], a[220:223], v[76:79]
ds_read_b64_tr_b16 a[182:183], v184 offset:45056
v_mfma_f32_16x16x32_bf16 v[76:79], a[152:155], a[216:219], v[76:79]
ds_read_b64_tr_b16 a[184:185], v185 offset:32768
v_mfma_f32_16x16x32_bf16 v[108:111], a[152:155], a[224:227], v[108:111]
s_xor_b32 s65, s84, 65536
ds_read_b64_tr_b16 a[186:187], v185 offset:36864
v_mfma_f32_16x16x32_bf16 v[108:111], a[156:159], a[228:231], v[108:111]
buffer_load_dwordx4 a[0:3], v14, s[44:47], s65 offen offset:0 sc1
v_mfma_f32_16x16x32_bf16 v[140:143], a[156:159], a[236:239], v[140:143]
ds_read_b64_tr_b16 a[188:189], v185 offset:40960
v_mfma_f32_16x16x32_bf16 v[140:143], a[152:155], a[232:235], v[140:143]
ds_read_b64_tr_b16 a[190:191], v185 offset:45056
v_mfma_f32_16x16x32_bf16 v[144:147], a[160:163], a[232:235], v[144:147]
v_mfma_f32_16x16x32_bf16 v[144:147], a[164:167], a[236:239], v[144:147]
buffer_load_dwordx4 a[8:11], v14, s[44:47], s65 offen offset:1024 sc1
v_mfma_f32_16x16x32_bf16 v[112:115], a[164:167], a[228:231], v[112:115]
ds_read_b64_tr_b16 a[192:193], v186 offset:32768
v_mfma_f32_16x16x32_bf16 v[112:115], a[160:163], a[224:227], v[112:115]
ds_read_b64_tr_b16 a[194:195], v186 offset:36864
v_mfma_f32_16x16x32_bf16 v[80:83], a[160:163], a[216:219], v[80:83]
ds_read_b64_tr_b16 a[196:197], v186 offset:40960
v_mfma_f32_16x16x32_bf16 v[80:83], a[164:167], a[220:223], v[80:83]
buffer_load_dwordx4 a[16:19], v15, s[44:47], s65 offen offset:0 sc1
v_mfma_f32_16x16x32_bf16 v[48:51], a[164:167], a[212:215], v[48:51]
ds_read_b64_tr_b16 a[198:199], v186 offset:45056
v_mfma_f32_16x16x32_bf16 v[48:51], a[160:163], a[208:211], v[48:51]
s_waitcnt lgkmcnt(4)
v_mfma_f32_16x16x32_bf16 v[52:55], a[168:171], a[208:211], v[52:55]
v_mfma_f32_16x16x32_bf16 v[52:55], a[172:175], a[212:215], v[52:55]
buffer_load_dwordx4 a[24:27], v15, s[44:47], s65 offen offset:1024 sc1
v_mfma_f32_16x16x32_bf16 v[84:87], a[172:175], a[220:223], v[84:87]
ds_read_b64_tr_b16 a[200:201], v187 offset:32768
v_mfma_f32_16x16x32_bf16 v[84:87], a[168:171], a[216:219], v[84:87]
ds_read_b64_tr_b16 a[202:203], v187 offset:36864
v_mfma_f32_16x16x32_bf16 v[116:119], a[168:171], a[224:227], v[116:119]
s_xor_b32 s65, s84, 73728
ds_read_b64_tr_b16 a[204:205], v187 offset:40960
v_mfma_f32_16x16x32_bf16 v[116:119], a[172:175], a[228:231], v[116:119]
buffer_load_dwordx4 a[4:7], v14, s[44:47], s65 offen offset:0 sc1
v_mfma_f32_16x16x32_bf16 v[148:151], a[172:175], a[236:239], v[148:151]
s_xor_b32 s66, s2, 1
s_lshl2_add_u32 s66, s66, s30
ds_read_b64_tr_b16 a[206:207], v187 offset:45056
v_mfma_f32_16x16x32_bf16 v[148:151], a[168:171], a[232:235], v[148:151]
s_lshl_b32 s73, s66, 12
s_add_u32 s73, s73, 67108864
s_lshl2_add_u32 s66, s2, s30
v_mfma_f32_16x16x32_bf16 v[120:123], a[176:179], a[232:235], v[120:123]
s_lshl_b32 s75, s66, 12
s_add_u32 s75, s75, 67108864
s_lshl_b32 s77, s82, 18
v_mfma_f32_16x16x32_bf16 v[120:123], a[180:183], a[236:239], v[120:123]
s_lshl_b32 s66, s30, 16
buffer_load_dwordx4 a[12:15], v14, s[44:47], s65 offen offset:1024 sc1
v_mfma_f32_16x16x32_bf16 v[88:91], a[180:183], a[228:231], v[88:91]
s_add_u32 s77, s77, s66
s_add_u32 s77, s77, s87
s_lshl_b32 s66, s83, 7
v_mfma_f32_16x16x32_bf16 v[88:91], a[176:179], a[224:227], v[88:91]
s_add_u32 s77, s77, s66
v_lshlrev_b32 v1, 24, v0
v_and_b32 v8, 7, v0
v_mfma_f32_16x16x32_bf16 v[56:59], a[176:179], a[216:219], v[56:59]
v_lshlrev_b32 v8, 11, v8
v_bfe_u32 v10, v0, 3, 1
v_mfma_f32_16x16x32_bf16 v[56:59], a[180:183], a[220:223], v[56:59]
buffer_load_dwordx4 a[20:23], v15, s[44:47], s65 offen offset:0 sc1
v_mfma_f32_16x16x32_bf16 v[24:27], a[180:183], a[212:215], v[24:27]
v_lshl_add_u32 v8, v10, 6, v8
v_bfe_u32 v10, v0, 4, 1
v_mfma_f32_16x16x32_bf16 v[24:27], a[176:179], a[208:211], v[24:27]
v_lshl_add_u32 v8, v10, 5, v8
v_lshrrev_b32 v10, 5, v0
v_mfma_f32_16x16x32_bf16 v[28:31], a[184:187], a[208:211], v[28:31]
v_lshl_add_u32 v8, v10, 4, v8
v_add_u32 v2, s86, v16
v_mfma_f32_16x16x32_bf16 v[28:31], a[188:191], a[212:215], v[28:31]
buffer_load_dwordx4 a[28:31], v15, s[44:47], s65 offen offset:1024 sc1
v_mfma_f32_16x16x32_bf16 v[60:63], a[188:191], a[220:223], v[60:63]
v_xor_b32 v3, 0x2000, v2
v_add_u32 v4, 0x20000, v2
v_mfma_f32_16x16x32_bf16 v[60:63], a[184:187], a[216:219], v[60:63]
s_waitcnt vmcnt(24)
s_barrier
v_mfma_f32_16x16x32_bf16 v[92:95], a[184:187], a[224:227], v[92:95]
s_xor_b32 m0, s76, 98304
ds_read_b64_tr_b16 a[144:145], v196 offset:0
v_add_u32 v5, 0x20000, v3
v_mfma_f32_16x16x32_bf16 v[92:95], a[188:191], a[228:231], v[92:95]
s_xor_b32 s64, s85, 786432
ds_read_b64_tr_b16 a[146:147], v196 offset:4096
v_mov_b32 v232, 0
v_mfma_f32_16x16x32_bf16 v[124:127], a[188:191], a[236:239], v[124:127]
buffer_load_dwordx4 v12, s[40:43], s64 offen lds
v_mfma_f32_16x16x32_bf16 v[124:127], a[184:187], a[232:235], v[124:127]
s_waitcnt lgkmcnt(2)
s_xor_b32 m0, s76, 99328
ds_read_b64_tr_b16 a[148:149], v196 offset:8192
v_mov_b32 v233, 0
v_mfma_f32_16x16x32_bf16 v[128:131], a[192:195], a[232:235], v[128:131]
s_xor_b32 s64, s85, 794624
ds_read_b64_tr_b16 a[150:151], v196 offset:12288
v_mov_b32 v236, 0
v_mfma_f32_16x16x32_bf16 v[128:131], a[196:199], a[236:239], v[128:131]
buffer_load_dwordx4 v13, s[40:43], s64 offen lds
v_mfma_f32_16x16x32_bf16 v[96:99], a[196:199], a[228:231], v[96:99]
ds_read_b64_tr_b16 a[152:153], v197 offset:0
v_mov_b32 v237, 0
v_mfma_f32_16x16x32_bf16 v[96:99], a[192:195], a[224:227], v[96:99]
s_xor_b32 m0, s76, 100352
ds_read_b64_tr_b16 a[154:155], v197 offset:4096
v_and_b32 v9, 1, v0
v_mfma_f32_16x16x32_bf16 v[64:67], a[192:195], a[216:219], v[64:67]
s_xor_b32 s64, s85, 802816
ds_read_b64_tr_b16 a[156:157], v197 offset:8192
v_lshlrev_b32 v9, 4, v9
v_mfma_f32_16x16x32_bf16 v[64:67], a[196:199], a[220:223], v[64:67]
buffer_load_dwordx4 v12, s[40:43], s64 offen lds
v_mfma_f32_16x16x32_bf16 v[32:35], a[196:199], a[212:215], v[32:35]
ds_read_b64_tr_b16 a[158:159], v197 offset:12288
v_mov_b32 v10, 0x3f80
v_mfma_f32_16x16x32_bf16 v[32:35], a[192:195], a[208:211], v[32:35]
s_xor_b32 m0, s76, 101376
ds_read_b64_tr_b16 a[160:161], v198 offset:0
v_lshlrev_b32 v9, v9, v10
v_mfma_f32_16x16x32_bf16 v[36:39], a[200:203], a[208:211], v[36:39]
s_xor_b32 s64, s85, 811008
ds_read_b64_tr_b16 a[162:163], v198 offset:4096
v_lshrrev_b32 v10, 4, v0
v_mfma_f32_16x16x32_bf16 v[36:39], a[204:207], a[212:215], v[36:39]
buffer_load_dwordx4 v13, s[40:43], s64 offen lds
v_mfma_f32_16x16x32_bf16 v[68:71], a[204:207], a[220:223], v[68:71]
ds_read_b64_tr_b16 a[164:165], v198 offset:8192
v_lshlrev_b32 v10, 1, v10
v_mfma_f32_16x16x32_bf16 v[68:71], a[200:203], a[216:219], v[68:71]
s_xor_b32 m0, s76, 102400
ds_read_b64_tr_b16 a[166:167], v198 offset:12288
v_bfe_u32 v11, v0, 1, 3
v_mfma_f32_16x16x32_bf16 v[100:103], a[200:203], a[224:227], v[100:103]
s_xor_b32 s64, s85, 819200
v_xor_b32 v10, v10, v11
v_subrev_u32 v11, 1, v10
v_mfma_f32_16x16x32_bf16 v[100:103], a[204:207], a[228:231], v[100:103]
buffer_load_dwordx4 v12, s[40:43], s64 offen lds
v_mfma_f32_16x16x32_bf16 v[132:135], a[204:207], a[236:239], v[132:135]
v_ashrrev_i32 v11, 31, v11
v_and_b32 v234, v11, v9
v_mfma_f32_16x16x32_bf16 v[132:135], a[200:203], a[232:235], v[132:135]
s_waitcnt vmcnt(25)
s_waitcnt lgkmcnt(3)
s_xor_b32 m0, s76, 103424
v_xor_b32 v10, 1, v10
v_subrev_u32 v11, 1, v10
v_mfma_f32_16x16x32_bf16 v[136:139], a[144:147], v[176:179], v[136:139]
s_waitcnt vmcnt(21)
s_xor_b32 s64, s85, 827392
ds_read_b64_tr_b16 a[168:169], v199 offset:0
v_ashrrev_i32 v11, 31, v11
v_mfma_f32_16x16x32_bf16 v[136:139], a[148:151], v[180:183], v[136:139]
buffer_load_dwordx4 v13, s[40:43], s64 offen lds
v_mfma_f32_16x16x32_bf16 v[104:107], a[148:151], v[172:175], v[104:107]
ds_read_b64_tr_b16 a[170:171], v199 offset:4096
v_and_b32 v235, v11, v9
v_mfma_f32_16x16x32_bf16 v[104:107], a[144:147], v[168:171], v[104:107]
s_mov_b32 s48, s24
s_mov_b32 s49, s25
s_xor_b32 m0, s76, 104448
ds_read_b64_tr_b16 a[172:173], v199 offset:8192
v_mfma_f32_16x16x32_bf16 v[72:75], a[144:147], v[160:163], v[72:75]
s_mov_b32 s50, 4194304
s_mov_b32 s51, 0x20000
s_xor_b32 s64, s85, 835584
ds_read_b64_tr_b16 a[174:175], v199 offset:12288
v_mfma_f32_16x16x32_bf16 v[72:75], a[148:151], v[164:167], v[72:75]
buffer_load_dwordx4 v12, s[40:43], s64 offen lds
v_mfma_f32_16x16x32_bf16 v[40:43], a[148:151], v[156:159], v[40:43]
s_waitcnt vmcnt(15)
s_barrier
s_xor_b32 m0, s76, 105472
s_xor_b32 s64, s85, 843776
v_mfma_f32_16x16x32_bf16 v[40:43], a[144:147], v[152:155], v[40:43]
buffer_load_dwordx4 v13, s[40:43], s64 offen lds
v_mfma_f32_16x16x32_bf16 v[44:47], a[152:155], v[152:155], v[44:47]
ds_read_b64_tr_b16 a[176:177], v196 offset:32768
v_mfma_f32_16x16x32_bf16 v[44:47], a[156:159], v[156:159], v[44:47]
s_xor_b32 s65, s84, 98304
ds_read_b64_tr_b16 a[178:179], v196 offset:36864
v_mfma_f32_16x16x32_bf16 v[76:79], a[156:159], v[164:167], v[76:79]
buffer_load_dwordx4 a[32:35], v14, s[44:47], s65 offen offset:0 sc1
v_mfma_f32_16x16x32_bf16 v[76:79], a[152:155], v[160:163], v[76:79]
ds_read_b64_tr_b16 a[180:181], v196 offset:40960
v_mfma_f32_16x16x32_bf16 v[108:111], a[152:155], v[168:171], v[108:111]
ds_read_b64_tr_b16 a[182:183], v196 offset:45056
v_mfma_f32_16x16x32_bf16 v[108:111], a[156:159], v[172:175], v[108:111]
buffer_load_dwordx4 a[40:43], v14, s[44:47], s65 offen offset:1024 sc1
v_mfma_f32_16x16x32_bf16 v[140:143], a[156:159], v[180:183], v[140:143]
ds_read_b64_tr_b16 a[184:185], v197 offset:32768
v_mfma_f32_16x16x32_bf16 v[140:143], a[152:155], v[176:179], v[140:143]
s_waitcnt lgkmcnt(5)
ds_read_b64_tr_b16 a[186:187], v197 offset:36864
v_mfma_f32_16x16x32_bf16 v[144:147], a[160:163], v[176:179], v[144:147]
buffer_load_dwordx4 a[48:51], v15, s[44:47], s65 offen offset:0 sc1
v_mfma_f32_16x16x32_bf16 v[144:147], a[164:167], v[180:183], v[144:147]
ds_read_b64_tr_b16 a[188:189], v197 offset:40960
v_mfma_f32_16x16x32_bf16 v[112:115], a[164:167], v[172:175], v[112:115]
ds_read_b64_tr_b16 a[190:191], v197 offset:45056
v_mfma_f32_16x16x32_bf16 v[112:115], a[160:163], v[168:171], v[112:115]
ds_read_b64_tr_b16 a[192:193], v198 offset:32768
v_mfma_f32_16x16x32_bf16 v[80:83], a[160:163], v[160:163], v[80:83]
buffer_load_dwordx4 a[56:59], v15, s[44:47], s65 offen offset:1024 sc1
v_mfma_f32_16x16x32_bf16 v[80:83], a[164:167], v[164:167], v[80:83]
ds_read_b64_tr_b16 a[194:195], v198 offset:36864
v_mfma_f32_16x16x32_bf16 v[48:51], a[164:167], v[156:159], v[48:51]
s_xor_b32 s65, s84, 106496
ds_read_b64_tr_b16 a[196:197], v198 offset:40960
v_mfma_f32_16x16x32_bf16 v[48:51], a[160:163], v[152:155], v[48:51]
buffer_load_dwordx4 a[36:39], v14, s[44:47], s65 offen offset:0 sc1
v_mfma_f32_16x16x32_bf16 v[52:55], a[168:171], v[152:155], v[52:55]
ds_read_b64_tr_b16 a[198:199], v198 offset:45056
v_mfma_f32_16x16x32_bf16 v[52:55], a[172:175], v[156:159], v[52:55]
v_mfma_f32_16x16x32_bf16 v[84:87], a[172:175], v[164:167], v[84:87]
buffer_load_dwordx4 a[44:47], v14, s[44:47], s65 offen offset:1024 sc1
v_mfma_f32_16x16x32_bf16 v[84:87], a[168:171], v[160:163], v[84:87]
ds_read_b64_tr_b16 a[200:201], v199 offset:32768
v_mfma_f32_16x16x32_bf16 v[116:119], a[168:171], v[168:171], v[116:119]
ds_read_b64_tr_b16 a[202:203], v199 offset:36864
v_mfma_f32_16x16x32_bf16 v[116:119], a[172:175], v[172:175], v[116:119]
buffer_load_dwordx4 a[52:55], v15, s[44:47], s65 offen offset:0 sc1
v_mfma_f32_16x16x32_bf16 v[148:151], a[172:175], v[180:183], v[148:151]
ds_read_b64_tr_b16 a[204:205], v199 offset:40960
v_mfma_f32_16x16x32_bf16 v[148:151], a[168:171], v[176:179], v[148:151]
s_waitcnt vmcnt(19)
s_waitcnt lgkmcnt(4)
ds_read_b64_tr_b16 a[206:207], v199 offset:45056
v_mfma_f32_16x16x32_bf16 v[136:139], a[176:179], a[24:27], v[136:139]
s_waitcnt vmcnt(15)
buffer_load_dwordx4 a[60:63], v15, s[44:47], s65 offen offset:1024 sc1
v_mfma_f32_16x16x32_bf16 v[136:139], a[180:183], a[28:31], v[136:139]
v_mfma_f32_16x16x32_bf16 v[104:107], a[180:183], a[20:23], v[104:107]
v_mfma_f32_16x16x32_bf16 v[104:107], a[176:179], a[16:19], v[104:107]
v_mfma_f32_16x16x32_bf16 v[72:75], a[176:179], a[8:11], v[72:75]
v_mfma_f32_16x16x32_bf16 v[72:75], a[180:183], a[12:15], v[72:75]
v_mfma_f32_16x16x32_bf16 v[40:43], a[180:183], a[4:7], v[40:43]
s_waitcnt vmcnt(8)
s_barrier
v_mfma_f32_16x16x32_bf16 v[40:43], a[176:179], a[0:3], v[40:43]
ds_read_b64_tr_b16 a[144:145], v188 offset:0
v_mfma_f32_16x16x32_bf16 v[44:47], a[184:187], a[0:3], v[44:47]
ds_read_b64_tr_b16 a[146:147], v188 offset:4096
v_mfma_f32_16x16x32_bf16 v[44:47], a[188:191], a[4:7], v[44:47]
ds_read_b64_tr_b16 a[148:149], v188 offset:8192
v_mfma_f32_16x16x32_bf16 v[76:79], a[188:191], a[12:15], v[76:79]
ds_read_b64_tr_b16 a[150:151], v188 offset:12288
v_mfma_f32_16x16x32_bf16 v[76:79], a[184:187], a[8:11], v[76:79]
ds_read_b64_tr_b16 a[152:153], v189 offset:0
v_mfma_f32_16x16x32_bf16 v[108:111], a[184:187], a[16:19], v[108:111]
ds_read_b64_tr_b16 a[154:155], v189 offset:4096
v_mfma_f32_16x16x32_bf16 v[108:111], a[188:191], a[20:23], v[108:111]
ds_read_b64_tr_b16 a[156:157], v189 offset:8192
v_mfma_f32_16x16x32_bf16 v[140:143], a[188:191], a[28:31], v[140:143]
ds_read_b64_tr_b16 a[158:159], v189 offset:12288
v_mfma_f32_16x16x32_bf16 v[140:143], a[184:187], a[24:27], v[140:143]
ds_read_b64_tr_b16 a[160:161], v190 offset:0
v_mfma_f32_16x16x32_bf16 v[144:147], a[192:195], a[24:27], v[144:147]
s_waitcnt lgkmcnt(7)
ds_read_b64_tr_b16 a[162:163], v190 offset:4096
v_mfma_f32_16x16x32_bf16 v[144:147], a[196:199], a[28:31], v[144:147]
ds_read_b64_tr_b16 a[164:165], v190 offset:8192
v_mfma_f32_16x16x32_bf16 v[112:115], a[196:199], a[20:23], v[112:115]
ds_read_b64_tr_b16 a[166:167], v190 offset:12288
v_mfma_f32_16x16x32_bf16 v[112:115], a[192:195], a[16:19], v[112:115]
ds_read_b64_tr_b16 a[168:169], v191 offset:0
v_mfma_f32_16x16x32_bf16 v[80:83], a[192:195], a[8:11], v[80:83]
ds_read_b64_tr_b16 a[170:171], v191 offset:4096
v_mfma_f32_16x16x32_bf16 v[80:83], a[196:199], a[12:15], v[80:83]
ds_read_b64_tr_b16 a[172:173], v191 offset:8192
v_mfma_f32_16x16x32_bf16 v[48:51], a[196:199], a[4:7], v[48:51]
ds_read_b64_tr_b16 a[174:175], v191 offset:12288
v_mfma_f32_16x16x32_bf16 v[48:51], a[192:195], a[0:3], v[48:51]
v_mfma_f32_16x16x32_bf16 v[52:55], a[200:203], a[0:3], v[52:55]
v_mfma_f32_16x16x32_bf16 v[52:55], a[204:207], a[4:7], v[52:55]
v_mfma_f32_16x16x32_bf16 v[84:87], a[204:207], a[12:15], v[84:87]
v_mfma_f32_16x16x32_bf16 v[84:87], a[200:203], a[8:11], v[84:87]
v_mfma_f32_16x16x32_bf16 v[116:119], a[200:203], a[16:19], v[116:119]
v_mfma_f32_16x16x32_bf16 v[116:119], a[204:207], a[20:23], v[116:119]
v_mfma_f32_16x16x32_bf16 v[148:151], a[204:207], a[28:31], v[148:151]
v_mfma_f32_16x16x32_bf16 v[148:151], a[200:203], a[24:27], v[148:151]
s_waitcnt vmcnt(5)
v_mfma_f32_16x16x32_bf16 v[104:107], a[144:147], a[48:51], v[104:107]
s_waitcnt vmcnt(1)
s_waitcnt lgkmcnt(0)
v_mfma_f32_16x16x32_bf16 v[104:107], a[148:151], a[52:55], v[104:107]
v_mfma_f32_16x16x32_bf16 v[108:111], a[156:159], a[52:55], v[108:111]
ds_read_b64_tr_b16 a[176:177], v192 offset:0
v_mfma_f32_16x16x32_bf16 v[108:111], a[152:155], a[48:51], v[108:111]
ds_read_b64_tr_b16 a[178:179], v192 offset:4096
v_mfma_f32_16x16x32_bf16 v[112:115], a[160:163], a[48:51], v[112:115]
ds_read_b64_tr_b16 a[180:181], v192 offset:8192
v_mfma_f32_16x16x32_bf16 v[112:115], a[164:167], a[52:55], v[112:115]
ds_read_b64_tr_b16 a[182:183], v192 offset:12288
v_mfma_f32_16x16x32_bf16 v[116:119], a[172:175], a[52:55], v[116:119]
v_mfma_f32_16x16x32_bf16 v[116:119], a[168:171], a[48:51], v[116:119]
v_mfma_f32_16x16x32_bf16 v[148:151], a[168:171], a[56:59], v[148:151]
s_waitcnt vmcnt(0)
v_mfma_f32_16x16x32_bf16 v[148:151], a[172:175], a[60:63], v[148:151]
ds_write_b128 v3, v[104:107] offset:0
v_mfma_f32_16x16x32_bf16 v[144:147], a[164:167], a[60:63], v[144:147]
ds_read_b64_tr_b16 a[184:185], v193 offset:0
v_mfma_f32_16x16x32_bf16 v[144:147], a[160:163], a[56:59], v[144:147]
ds_write_b128 v3, v[108:111] offset:1024
v_mfma_f32_16x16x32_bf16 v[140:143], a[152:155], a[56:59], v[140:143]
ds_read_b64_tr_b16 a[186:187], v193 offset:4096
v_mfma_f32_16x16x32_bf16 v[140:143], a[156:159], a[60:63], v[140:143]
ds_write_b128 v3, v[112:115] offset:2048
v_mfma_f32_16x16x32_bf16 v[136:139], a[148:151], a[60:63], v[136:139]
ds_read_b64_tr_b16 a[188:189], v193 offset:8192
v_mfma_f32_16x16x32_bf16 v[136:139], a[144:147], a[56:59], v[136:139]
ds_write_b128 v3, v[116:119] offset:3072
v_mfma_f32_16x16x32_bf16 v[40:43], a[144:147], a[32:35], v[40:43]
ds_read_b64_tr_b16 a[190:191], v193 offset:12288
v_mfma_f32_16x16x32_bf16 v[40:43], a[148:151], a[36:39], v[40:43]
ds_write_b128 v3, v[148:151] offset:7168
v_mfma_f32_16x16x32_bf16 v[44:47], a[156:159], a[36:39], v[44:47]
ds_read_b64_tr_b16 a[192:193], v194 offset:0
v_mfma_f32_16x16x32_bf16 v[44:47], a[152:155], a[32:35], v[44:47]
ds_write_b128 v3, v[144:147] offset:6144
v_mfma_f32_16x16x32_bf16 v[48:51], a[160:163], a[32:35], v[48:51]
ds_read_b64_tr_b16 a[194:195], v194 offset:4096
v_mfma_f32_16x16x32_bf16 v[48:51], a[164:167], a[36:39], v[48:51]
ds_write_b128 v3, v[140:143] offset:5120
v_mfma_f32_16x16x32_bf16 v[52:55], a[172:175], a[36:39], v[52:55]
ds_read_b64_tr_b16 a[196:197], v194 offset:8192
v_mfma_f32_16x16x32_bf16 v[52:55], a[168:171], a[32:35], v[52:55]
ds_write_b128 v3, v[136:139] offset:4096
v_mfma_f32_16x16x32_bf16 v[84:87], a[168:171], a[40:43], v[84:87]
ds_read_b64_tr_b16 a[198:199], v194 offset:12288
v_mfma_f32_16x16x32_bf16 v[84:87], a[172:175], a[44:47], v[84:87]
v_mfma_f32_16x16x32_bf16 v[80:83], a[164:167], a[44:47], v[80:83]
s_waitcnt lgkmcnt(0)
s_barrier
v_mfma_f32_16x16x32_bf16 v[80:83], a[160:163], a[40:43], v[80:83]
ds_read_b128 v[200:203], v2 offset:0
ds_read_b128 v[204:207], v2 offset:1024
v_mfma_f32_16x16x32_bf16 v[76:79], a[152:155], a[40:43], v[76:79]
ds_read_b128 v[208:211], v2 offset:2048
ds_read_b128 v[212:215], v2 offset:3072
v_mfma_f32_16x16x32_bf16 v[76:79], a[156:159], a[44:47], v[76:79]
ds_read_b128 v[216:219], v2 offset:4096
ds_read_b128 v[220:223], v2 offset:5120
v_mfma_f32_16x16x32_bf16 v[72:75], a[148:151], a[44:47], v[72:75]
ds_read_b128 v[224:227], v2 offset:6144
ds_read_b128 v[228:231], v2 offset:7168
v_mfma_f32_16x16x32_bf16 v[72:75], a[144:147], a[40:43], v[72:75]
ds_read_b64_tr_b16 a[200:201], v195 offset:0
v_mfma_f32_16x16x32_bf16 v[120:123], a[176:179], v[176:179], v[120:123]
ds_read_b64_tr_b16 a[202:203], v195 offset:4096
v_mfma_f32_16x16x32_bf16 v[120:123], a[180:183], v[180:183], v[120:123]
ds_read_b64_tr_b16 a[204:205], v195 offset:8192
v_mfma_f32_16x16x32_bf16 v[88:91], a[180:183], v[172:175], v[88:91]
s_waitcnt lgkmcnt(10)
ds_read_b64_tr_b16 a[206:207], v195 offset:12288
v_add_f32 v200, v200, v40
v_mfma_f32_16x16x32_bf16 v[88:91], a[176:179], v[168:171], v[88:91]
ds_read_b64_tr_b16 a[144:145], v192 offset:32768
v_add_f32 v201, v201, v41
v_mfma_f32_16x16x32_bf16 v[56:59], a[176:179], v[160:163], v[56:59]
ds_read_b64_tr_b16 a[146:147], v192 offset:36864
v_add_f32 v202, v202, v42
v_mfma_f32_16x16x32_bf16 v[56:59], a[180:183], v[164:167], v[56:59]
s_waitcnt lgkmcnt(8)
ds_read_b64_tr_b16 a[148:149], v192 offset:40960
v_add_f32 v203, v203, v43
v_add_f32 v204, v204, v44
v_add_f32 v205, v205, v45
v_add_f32 v206, v206, v46
v_add_f32 v207, v207, v47
v_cvt_pk_bf16_f32 v200, v200, v201
v_cvt_pk_bf16_f32 v201, v202, v203
v_cvt_pk_bf16_f32 v202, v204, v205
v_cvt_pk_bf16_f32 v203, v206, v207
v_mfma_f32_16x16x32_bf16 v[24:27], a[180:183], v[156:159], v[24:27]
buffer_store_dwordx4 v[200:203], v16, s[44:47], s73 offen offset:0 sc1
v_mfma_f32_16x16x32_bf16 v[24:27], a[176:179], v[152:155], v[24:27]
ds_read_b64_tr_b16 a[150:151], v192 offset:45056
v_add_f32 v208, v208, v48
v_mfma_f32_16x16x32_bf16 v[28:31], a[184:187], v[152:155], v[28:31]
v_add_f32 v209, v209, v49
v_add_f32 v210, v210, v50
v_mfma_f32_16x16x32_bf16 v[28:31], a[188:191], v[156:159], v[28:31]
v_add_f32 v211, v211, v51
v_add_f32 v212, v212, v52
v_add_f32 v213, v213, v53
v_add_f32 v214, v214, v54
v_add_f32 v215, v215, v55
v_cvt_pk_bf16_f32 v208, v208, v209
v_cvt_pk_bf16_f32 v209, v210, v211
v_cvt_pk_bf16_f32 v210, v212, v213
v_cvt_pk_bf16_f32 v211, v214, v215
v_mfma_f32_16x16x32_bf16 v[60:63], a[188:191], v[164:167], v[60:63]
buffer_store_dwordx4 v[208:211], v16, s[44:47], s73 offen offset:1024 sc1
v_mfma_f32_16x16x32_bf16 v[60:63], a[184:187], v[160:163], v[60:63]
ds_read_b64_tr_b16 a[152:153], v193 offset:32768
v_add_f32 v216, v216, v72
v_mfma_f32_16x16x32_bf16 v[92:95], a[184:187], v[168:171], v[92:95]
ds_read_b64_tr_b16 a[154:155], v193 offset:36864
v_add_f32 v217, v217, v73
v_mfma_f32_16x16x32_bf16 v[92:95], a[188:191], v[172:175], v[92:95]
ds_read_b64_tr_b16 a[156:157], v193 offset:40960
v_add_f32 v218, v218, v74
v_add_f32 v219, v219, v75
v_add_f32 v220, v220, v76
v_add_f32 v221, v221, v77
v_add_f32 v222, v222, v78
v_add_f32 v223, v223, v79
v_cvt_pk_bf16_f32 v216, v216, v217
v_cvt_pk_bf16_f32 v217, v218, v219
v_cvt_pk_bf16_f32 v218, v220, v221
v_cvt_pk_bf16_f32 v219, v222, v223
v_mfma_f32_16x16x32_bf16 v[124:127], a[188:191], v[180:183], v[124:127]
buffer_store_dwordx4 v[216:219], v16, s[44:47], s73 offen offset:2048 sc1
v_mfma_f32_16x16x32_bf16 v[124:127], a[184:187], v[176:179], v[124:127]
s_waitcnt lgkmcnt(3)
ds_read_b64_tr_b16 a[158:159], v193 offset:45056
v_add_f32 v224, v224, v80
v_mfma_f32_16x16x32_bf16 v[128:131], a[192:195], v[176:179], v[128:131]
v_add_f32 v225, v225, v81
v_add_f32 v226, v226, v82
v_mfma_f32_16x16x32_bf16 v[128:131], a[196:199], v[180:183], v[128:131]
v_add_f32 v227, v227, v83
v_add_f32 v228, v228, v84
v_add_f32 v229, v229, v85
v_add_f32 v230, v230, v86
v_add_f32 v231, v231, v87
v_cvt_pk_bf16_f32 v224, v224, v225
v_cvt_pk_bf16_f32 v225, v226, v227
v_cvt_pk_bf16_f32 v226, v228, v229
v_cvt_pk_bf16_f32 v227, v230, v231
v_mfma_f32_16x16x32_bf16 v[96:99], a[196:199], v[172:175], v[96:99]
buffer_store_dwordx4 v[224:227], v16, s[44:47], s73 offen offset:3072 sc1
v_mfma_f32_16x16x32_bf16 v[96:99], a[192:195], v[168:171], v[96:99]
ds_read_b64_tr_b16 a[160:161], v194 offset:32768
v_mfma_f32_16x16x32_bf16 v[64:67], a[192:195], v[160:163], v[64:67]
ds_read_b64_tr_b16 a[162:163], v194 offset:36864
v_mfma_f32_16x16x32_bf16 v[64:67], a[196:199], v[164:167], v[64:67]
ds_read_b64_tr_b16 a[164:165], v194 offset:40960
v_mfma_f32_16x16x32_bf16 v[32:35], a[196:199], v[156:159], v[32:35]
ds_read_b64_tr_b16 a[166:167], v194 offset:45056
v_mfma_f32_16x16x32_bf16 v[32:35], a[192:195], v[152:155], v[32:35]
v_mfma_f32_16x16x32_bf16 v[36:39], a[200:203], v[152:155], v[36:39]
v_mfma_f32_16x16x32_bf16 v[36:39], a[204:207], v[156:159], v[36:39]
v_mfma_f32_16x16x32_bf16 v[68:71], a[204:207], v[164:167], v[68:71]
ds_read_b64_tr_b16 a[168:169], v195 offset:32768
v_mfma_f32_16x16x32_bf16 v[68:71], a[200:203], v[160:163], v[68:71]
ds_read_b64_tr_b16 a[170:171], v195 offset:36864
v_mfma_f32_16x16x32_bf16 v[100:103], a[200:203], v[168:171], v[100:103]
ds_read_b64_tr_b16 a[172:173], v195 offset:40960
v_mfma_f32_16x16x32_bf16 v[100:103], a[204:207], v[172:175], v[100:103]
ds_read_b64_tr_b16 a[174:175], v195 offset:45056
v_mfma_f32_16x16x32_bf16 v[132:135], a[204:207], v[180:183], v[132:135]
v_mfma_f32_16x16x32_bf16 v[132:135], a[200:203], v[176:179], v[132:135]
v_mfma_f32_16x16x32_bf16 v[120:123], a[144:147], a[24:27], v[120:123]
v_mfma_f32_16x16x32_bf16 v[120:123], a[148:151], a[28:31], v[120:123]
v_mfma_f32_16x16x32_bf16 v[88:91], a[148:151], a[20:23], v[88:91]
ds_read_b64_tr_b16 a[176:177], v184 offset:0
v_mfma_f32_16x16x32_bf16 v[88:91], a[144:147], a[16:19], v[88:91]
ds_read_b64_tr_b16 a[178:179], v184 offset:4096
v_mfma_f32_16x16x32_bf16 v[56:59], a[144:147], a[8:11], v[56:59]
ds_read_b64_tr_b16 a[180:181], v184 offset:8192
v_mfma_f32_16x16x32_bf16 v[56:59], a[148:151], a[12:15], v[56:59]
ds_read_b64_tr_b16 a[182:183], v184 offset:12288
v_mfma_f32_16x16x32_bf16 v[24:27], a[148:151], a[4:7], v[24:27]
ds_read_b64_tr_b16 a[184:185], v185 offset:0
v_mfma_f32_16x16x32_bf16 v[24:27], a[144:147], a[0:3], v[24:27]
s_waitcnt lgkmcnt(5)
ds_read_b64_tr_b16 a[186:187], v185 offset:4096
v_mfma_f32_16x16x32_bf16 v[28:31], a[152:155], a[0:3], v[28:31]
ds_read_b64_tr_b16 a[188:189], v185 offset:8192
v_mfma_f32_16x16x32_bf16 v[28:31], a[156:159], a[4:7], v[28:31]
ds_read_b64_tr_b16 a[190:191], v185 offset:12288
v_mfma_f32_16x16x32_bf16 v[60:63], a[156:159], a[12:15], v[60:63]
ds_read_b64_tr_b16 a[192:193], v186 offset:0
v_mfma_f32_16x16x32_bf16 v[60:63], a[152:155], a[8:11], v[60:63]
ds_read_b64_tr_b16 a[194:195], v186 offset:4096
v_mfma_f32_16x16x32_bf16 v[92:95], a[152:155], a[16:19], v[92:95]
ds_read_b64_tr_b16 a[196:197], v186 offset:8192
v_mfma_f32_16x16x32_bf16 v[92:95], a[156:159], a[20:23], v[92:95]
ds_read_b64_tr_b16 a[198:199], v186 offset:12288
v_mfma_f32_16x16x32_bf16 v[124:127], a[156:159], a[28:31], v[124:127]
ds_read_b64_tr_b16 a[200:201], v187 offset:0
v_mfma_f32_16x16x32_bf16 v[124:127], a[152:155], a[24:27], v[124:127]
ds_read_b64_tr_b16 a[202:203], v187 offset:4096
v_mfma_f32_16x16x32_bf16 v[128:131], a[160:163], a[24:27], v[128:131]
ds_read_b64_tr_b16 a[204:205], v187 offset:8192
v_mfma_f32_16x16x32_bf16 v[128:131], a[164:167], a[28:31], v[128:131]
ds_read_b64_tr_b16 a[206:207], v187 offset:12288
v_mfma_f32_16x16x32_bf16 v[96:99], a[164:167], a[20:23], v[96:99]
s_branch L_po25
L_pg25:
s_branch L_tr2
L_po25:
v_mfma_f32_16x16x32_bf16 v[96:99], a[160:163], a[16:19], v[96:99]
v_mfma_f32_16x16x32_bf16 v[64:67], a[160:163], a[8:11], v[64:67]
v_mfma_f32_16x16x32_bf16 v[64:67], a[164:167], a[12:15], v[64:67]
v_mfma_f32_16x16x32_bf16 v[32:35], a[164:167], a[4:7], v[32:35]
v_mfma_f32_16x16x32_bf16 v[32:35], a[160:163], a[0:3], v[32:35]
v_mfma_f32_16x16x32_bf16 v[36:39], a[168:171], a[0:3], v[36:39]
v_mfma_f32_16x16x32_bf16 v[36:39], a[172:175], a[4:7], v[36:39]
v_mfma_f32_16x16x32_bf16 v[68:71], a[172:175], a[12:15], v[68:71]
v_mfma_f32_16x16x32_bf16 v[68:71], a[168:171], a[8:11], v[68:71]
v_mfma_f32_16x16x32_bf16 v[100:103], a[168:171], a[16:19], v[100:103]
v_mfma_f32_16x16x32_bf16 v[100:103], a[172:175], a[20:23], v[100:103]
v_mfma_f32_16x16x32_bf16 v[132:135], a[172:175], a[28:31], v[132:135]
v_mfma_f32_16x16x32_bf16 v[132:135], a[168:171], a[24:27], v[132:135]
s_waitcnt lgkmcnt(0)
v_mfma_f32_16x16x32_bf16 v[88:91], a[176:179], a[48:51], v[88:91]
v_mfma_f32_16x16x32_bf16 v[88:91], a[180:183], a[52:55], v[88:91]
v_mfma_f32_16x16x32_bf16 v[92:95], a[188:191], a[52:55], v[92:95]
buffer_load_dwordx4 v[152:155], v16, s[44:47], s75 offen offset:0 sc1
v_mfma_f32_16x16x32_bf16 v[92:95], a[184:187], a[48:51], v[92:95]
v_mfma_f32_16x16x32_bf16 v[96:99], a[192:195], a[48:51], v[96:99]
buffer_load_dwordx4 v[156:159], v16, s[44:47], s75 offen offset:1024 sc1
v_mfma_f32_16x16x32_bf16 v[96:99], a[196:199], a[52:55], v[96:99]
v_mfma_f32_16x16x32_bf16 v[100:103], a[204:207], a[52:55], v[100:103]
buffer_load_dwordx4 v[160:163], v16, s[44:47], s75 offen offset:2048 sc1
v_mfma_f32_16x16x32_bf16 v[100:103], a[200:203], a[48:51], v[100:103]
v_mfma_f32_16x16x32_bf16 v[132:135], a[200:203], a[56:59], v[132:135]
buffer_load_dwordx4 v[164:167], v16, s[44:47], s75 offen offset:3072 sc1
v_mfma_f32_16x16x32_bf16 v[132:135], a[204:207], a[60:63], v[132:135]
ds_write_b128 v5, v[88:91] offset:0
v_mfma_f32_16x16x32_bf16 v[128:131], a[196:199], a[60:63], v[128:131]
v_mfma_f32_16x16x32_bf16 v[128:131], a[192:195], a[56:59], v[128:131]
ds_write_b128 v5, v[92:95] offset:1024
v_mfma_f32_16x16x32_bf16 v[124:127], a[184:187], a[56:59], v[124:127]
v_mfma_f32_16x16x32_bf16 v[124:127], a[188:191], a[60:63], v[124:127]
ds_write_b128 v5, v[96:99] offset:2048
v_mfma_f32_16x16x32_bf16 v[120:123], a[180:183], a[60:63], v[120:123]
v_mfma_f32_16x16x32_bf16 v[120:123], a[176:179], a[56:59], v[120:123]
ds_write_b128 v5, v[100:103] offset:3072
v_mfma_f32_16x16x32_bf16 v[24:27], a[176:179], a[32:35], v[24:27]
v_mfma_f32_16x16x32_bf16 v[24:27], a[180:183], a[36:39], v[24:27]
ds_write_b128 v5, v[132:135] offset:7168
v_mfma_f32_16x16x32_bf16 v[28:31], a[188:191], a[36:39], v[28:31]
v_mfma_f32_16x16x32_bf16 v[28:31], a[184:187], a[32:35], v[28:31]
ds_write_b128 v5, v[128:131] offset:6144
v_mfma_f32_16x16x32_bf16 v[32:35], a[192:195], a[32:35], v[32:35]
v_mfma_f32_16x16x32_bf16 v[32:35], a[196:199], a[36:39], v[32:35]
ds_write_b128 v5, v[124:127] offset:5120
v_mfma_f32_16x16x32_bf16 v[36:39], a[204:207], a[36:39], v[36:39]
v_mfma_f32_16x16x32_bf16 v[36:39], a[200:203], a[32:35], v[36:39]
ds_write_b128 v5, v[120:123] offset:4096
v_mfma_f32_16x16x32_bf16 v[68:71], a[200:203], a[40:43], v[68:71]
v_mfma_f32_16x16x32_bf16 v[68:71], a[204:207], a[44:47], v[68:71]
v_mfma_f32_16x16x32_bf16 v[64:67], a[196:199], a[44:47], v[64:67]
v_mfma_f32_16x16x32_bf16 v[64:67], a[192:195], a[40:43], v[64:67]
s_waitcnt lgkmcnt(0)
s_barrier
v_mfma_f32_16x16x32_bf16 v[60:63], a[184:187], a[40:43], v[60:63]
ds_read_b128 v[200:203], v4 offset:0
ds_read_b128 v[204:207], v4 offset:1024
v_mfma_f32_16x16x32_bf16 v[60:63], a[188:191], a[44:47], v[60:63]
ds_read_b128 v[208:211], v4 offset:2048
ds_read_b128 v[212:215], v4 offset:3072
v_mfma_f32_16x16x32_bf16 v[56:59], a[180:183], a[44:47], v[56:59]
ds_read_b128 v[216:219], v4 offset:4096
ds_read_b128 v[220:223], v4 offset:5120
v_mfma_f32_16x16x32_bf16 v[56:59], a[176:179], a[40:43], v[56:59]
ds_read_b128 v[224:227], v4 offset:6144
ds_read_b128 v[228:231], v4 offset:7168
s_mov_b32 s72, 0x20000
s_waitcnt lgkmcnt(7)
v_add_f32 v24, v24, v200
v_add_f32 v25, v25, v201
v_add_f32 v26, v26, v202
v_add_f32 v27, v27, v203
s_waitcnt lgkmcnt(6)
v_add_f32 v28, v28, v204
v_add_f32 v29, v29, v205
v_add_f32 v30, v30, v206
v_add_f32 v31, v31, v207
s_waitcnt lgkmcnt(5)
v_add_f32 v32, v32, v208
v_add_f32 v33, v33, v209
v_add_f32 v34, v34, v210
v_add_f32 v35, v35, v211
s_waitcnt lgkmcnt(4)
v_add_f32 v36, v36, v212
v_add_f32 v37, v37, v213
v_add_f32 v38, v38, v214
v_add_f32 v39, v39, v215
s_waitcnt lgkmcnt(3)
v_add_f32 v56, v56, v216
v_add_f32 v57, v57, v217
v_add_f32 v58, v58, v218
v_add_f32 v59, v59, v219
s_waitcnt lgkmcnt(2)
v_add_f32 v60, v60, v220
v_add_f32 v61, v61, v221
v_add_f32 v62, v62, v222
v_add_f32 v63, v63, v223
s_waitcnt lgkmcnt(1)
v_add_f32 v64, v64, v224
v_add_f32 v65, v65, v225
v_add_f32 v66, v66, v226
v_add_f32 v67, v67, v227
s_waitcnt lgkmcnt(0)
v_add_f32 v68, v68, v228
v_add_f32 v69, v69, v229
v_add_f32 v70, v70, v230
v_add_f32 v71, v71, v231
s_waitcnt vmcnt(0)
L_xchk:
v_max3_u32 v9, v152, v153, v154
v_max3_u32 v9, v9, v155, v156
v_max3_u32 v9, v9, v157, v158
v_max3_u32 v9, v9, v159, v160
v_max3_u32 v9, v9, v161, v162
v_max3_u32 v9, v9, v163, v164
v_max3_u32 v9, v9, v165, v166
v_max_u32 v9, v9, v167
v_cmp_eq_u32 vcc, -1, v9
s_cbranch_vccnz L_xretry
L_xgo:
v_mfma_f32_16x16x32_bf16 v[24:27], v[234:237], v[152:155], v[24:27]
v_mfma_f32_16x16x32_bf16 v[28:31], v[232:235], v[152:155], v[28:31]
v_mfma_f32_16x16x32_bf16 v[32:35], v[234:237], v[156:159], v[32:35]
v_mfma_f32_16x16x32_bf16 v[36:39], v[232:235], v[156:159], v[36:39]
v_mfma_f32_16x16x32_bf16 v[56:59], v[234:237], v[160:163], v[56:59]
v_mfma_f32_16x16x32_bf16 v[60:63], v[232:235], v[160:163], v[60:63]
v_mfma_f32_16x16x32_bf16 v[64:67], v[234:237], v[164:167], v[64:67]
v_mfma_f32_16x16x32_bf16 v[68:71], v[232:235], v[164:167], v[68:71]
s_nop 1
v_cvt_pk_bf16_f32 v24, v24, v25
v_cvt_pk_bf16_f32 v25, v26, v27
v_cvt_pk_bf16_f32 v26, v28, v29
v_cvt_pk_bf16_f32 v27, v30, v31
v_cvt_pk_bf16_f32 v32, v32, v33
v_cvt_pk_bf16_f32 v33, v34, v35
v_cvt_pk_bf16_f32 v34, v36, v37
v_cvt_pk_bf16_f32 v35, v38, v39
v_permlane16_swap_b32 v24, v26
v_permlane16_swap_b32 v25, v27
v_permlane16_swap_b32 v32, v34
v_permlane16_swap_b32 v33, v35
v_mov_b32 v28, v24
v_mov_b32 v29, v25
v_mov_b32 v30, v26
v_mov_b32 v31, v27
v_mov_b32_dpp v24, v32 row_ror:8 row_mask:0xf bank_mask:0xc
v_mov_b32_dpp v25, v33 row_ror:8 row_mask:0xf bank_mask:0xc
v_mov_b32_dpp v26, v34 row_ror:8 row_mask:0xf bank_mask:0xc
v_mov_b32_dpp v27, v35 row_ror:8 row_mask:0xf bank_mask:0xc
v_mov_b32_dpp v32, v28 row_ror:8 row_mask:0xf bank_mask:0x3
v_mov_b32_dpp v33, v29 row_ror:8 row_mask:0xf bank_mask:0x3
v_mov_b32_dpp v34, v30 row_ror:8 row_mask:0xf bank_mask:0x3
v_mov_b32_dpp v35, v31 row_ror:8 row_mask:0xf bank_mask:0x3
buffer_store_dwordx4 v[24:27], v8, s[48:51], s77 offen sc1
s_add_u32 s77, s77, 16384
buffer_store_dwordx4 v[32:35], v8, s[48:51], s77 offen sc1
s_add_u32 s77, s77, 16384
v_cvt_pk_bf16_f32 v56, v56, v57
v_cvt_pk_bf16_f32 v57, v58, v59
v_cvt_pk_bf16_f32 v58, v60, v61
v_cvt_pk_bf16_f32 v59, v62, v63
v_cvt_pk_bf16_f32 v64, v64, v65
v_cvt_pk_bf16_f32 v65, v66, v67
v_cvt_pk_bf16_f32 v66, v68, v69
v_cvt_pk_bf16_f32 v67, v70, v71
v_permlane16_swap_b32 v56, v58
v_permlane16_swap_b32 v57, v59
v_permlane16_swap_b32 v64, v66
v_permlane16_swap_b32 v65, v67
v_mov_b32 v60, v56
v_mov_b32 v61, v57
v_mov_b32 v62, v58
v_mov_b32 v63, v59
v_mov_b32_dpp v56, v64 row_ror:8 row_mask:0xf bank_mask:0xc
v_mov_b32_dpp v57, v65 row_ror:8 row_mask:0xf bank_mask:0xc
v_mov_b32_dpp v58, v66 row_ror:8 row_mask:0xf bank_mask:0xc
v_mov_b32_dpp v59, v67 row_ror:8 row_mask:0xf bank_mask:0xc
v_mov_b32_dpp v64, v60 row_ror:8 row_mask:0xf bank_mask:0x3
v_mov_b32_dpp v65, v61 row_ror:8 row_mask:0xf bank_mask:0x3
v_mov_b32_dpp v66, v62 row_ror:8 row_mask:0xf bank_mask:0x3
v_mov_b32_dpp v67, v63 row_ror:8 row_mask:0xf bank_mask:0x3
buffer_store_dwordx4 v[56:59], v8, s[48:51], s77 offen sc1
s_add_u32 s77, s77, 16384
buffer_store_dwordx4 v[64:67], v8, s[48:51], s77 offen sc1
s_add_u32 s77, s77, 16384
L_end:
s_endpgm
L_xretry:
s_sub_u32 s72, s72, 1
s_cbranch_scc1 L_xgo
buffer_load_dwordx4 v[152:155], v16, s[44:47], s75 offen offset:0 sc1
buffer_load_dwordx4 v[156:159], v16, s[44:47], s75 offen offset:1024 sc1
buffer_load_dwordx4 v[160:163], v16, s[44:47], s75 offen offset:2048 sc1
buffer_load_dwordx4 v[164:167], v16, s[44:47], s75 offen offset:3072 sc1
s_waitcnt vmcnt(0)
s_branch L_xchk
L_spin_1:
s_mov_b32 vcc_hi, 0x80000
L_spinlp_3:
s_sleep 1
buffer_load_dword v1, off, s[52:55], s78 offset:0 sc1
s_waitcnt vmcnt(0)
v_readfirstlane_b32 vcc_lo, v1
s_sub_u32 vcc_hi, vcc_hi, 1
s_cbranch_scc1 L_spinbk_2
s_cmp_lt_u32 vcc_lo, s81
s_cbranch_scc1 L_spinlp_3
s_branch L_spinbk_2
L_spin_4:
s_mov_b32 vcc_hi, 0x80000
L_spinlp_6:
s_sleep 1
buffer_load_dword v1, off, s[52:55], s70 offset:0 sc1
s_waitcnt vmcnt(0)
v_readfirstlane_b32 vcc_lo, v1
s_sub_u32 vcc_hi, vcc_hi, 1
s_cbranch_scc1 L_spinbk_5
s_cmp_lt_u32 vcc_lo, s81
s_cbranch_scc1 L_spinlp_6
s_branch L_spinbk_5
L_hretry:
s_sub_u32 s72, s72, 1
s_cbranch_scc1 L_hgo
buffer_load_dwordx4 v[136:139], v16, s[44:47], s77 offen sc1
s_waitcnt vmcnt(0)
v_max3_u32 v1, v136, v137, v138
v_max_u32 v1, v1, v139
v_cmp_eq_u32 vcc, -1, v1
s_cbranch_vccnz L_hretry
s_branch L_hgo
L_spin_8:
s_mov_b32 vcc_hi, 0x80000
L_spinlp_10:
s_sleep 1
buffer_load_dword v19, off, s[52:55], s80 offset:0 sc1
s_waitcnt vmcnt(0)
v_readfirstlane_b32 vcc_lo, v19
s_sub_u32 vcc_hi, vcc_hi, 1
s_cbranch_scc1 L_spinbk_9
s_cmp_lt_u32 vcc_lo, s69
s_cbranch_scc1 L_spinlp_10
s_branch L_spinbk_9
L_spin_1012:
s_mov_b32 vcc_hi, 0x80000
L_spinlp_1014:
s_sleep 1
buffer_load_dword v19, off, s[52:55], s80 offset:0 sc1
s_waitcnt vmcnt(0)
v_readfirstlane_b32 vcc_lo, v19
s_sub_u32 vcc_hi, vcc_hi, 1
s_cbranch_scc1 L_spinbk_1013
s_cmp_lt_u32 vcc_lo, s69
s_cbranch_scc1 L_spinlp_1014
s_branch L_spinbk_1013
L_pg26:
s_branch L_tr3
L_F1:
s_waitcnt lgkmcnt(7)
v_mfma_f32_16x16x32_bf16 v[104:107], a[144:147], v[40:43], 0
s_waitcnt lgkmcnt(6)
ds_read_b128 a[176:179], v2 offset:8192
v_cndmask_b32 v88, 0, v17, s[0:1]
v_mfma_f32_16x16x32_bf16 v[104:107], a[148:151], v[44:47], v[104:107]
s_waitcnt lgkmcnt(6)
ds_read_b128 a[180:183], v2 offset:9216
v_cndmask_b32 v89, 0, v17, s[4:5]
v_mfma_f32_16x16x32_bf16 v[104:107], a[152:155], v[48:51], v[104:107]
s_waitcnt lgkmcnt(6)
buffer_load_dwordx4 v16, s[32:35], s70 offen offset:2048 sc1 lds
v_mfma_f32_16x16x32_bf16 v[104:107], a[156:159], v[52:55], v[104:107]
ds_read_b128 a[184:187], v2 offset:10240
v_cndmask_b32 v90, 0, v17, s[6:7]
v_mfma_f32_16x16x32_bf16 v[120:123], a[156:159], v[68:71], 0
ds_read_b128 a[188:191], v2 offset:11264
v_cndmask_b32 v91, 0, v17, s[8:9]
v_mfma_f32_16x16x32_bf16 v[120:123], a[152:155], v[64:67], v[120:123]
ds_read_b128 a[192:195], v2 offset:12288
v_accvgpr_write_b32 a128, 0
v_mfma_f32_16x16x32_bf16 v[120:123], a[148:151], v[60:63], v[120:123]
ds_read_b128 a[196:199], v2 offset:13312
v_accvgpr_write_b32 a129, 0
v_mfma_f32_16x16x32_bf16 v[120:123], a[144:147], v[56:59], v[120:123]
ds_read_b128 a[200:203], v2 offset:14336
v_accvgpr_write_b32 a130, 0
v_mfma_f32_16x16x32_bf16 v[136:139], a[144:147], v[72:75], 0
ds_read_b128 a[204:207], v2 offset:15360
v_accvgpr_write_b32 a131, 0
v_mfma_f32_16x16x32_bf16 v[136:139], a[148:151], v[76:79], v[136:139]
buffer_load_dwordx4 v16, s[32:35], s70 offen offset:3072 sc1 lds
v_mfma_f32_16x16x32_bf16 v[136:139], a[152:155], v[80:83], v[136:139]
v_accvgpr_write_b32 a132, 0
v_accvgpr_write_b32 a133, 0
v_mfma_f32_16x16x32_bf16 v[136:139], a[156:159], v[84:87], v[136:139]
v_accvgpr_write_b32 a134, 0
v_accvgpr_write_b32 a135, 0
v_mfma_f32_16x16x32_bf16 v[88:91], a[156:159], v[36:39], v[88:91]
v_accvgpr_write_b32 a136, 0
v_accvgpr_write_b32 a137, 0
v_mfma_f32_16x16x32_bf16 v[88:91], a[152:155], v[32:35], v[88:91]
v_accvgpr_write_b32 a138, 0
v_accvgpr_write_b32 a139, 0
v_mfma_f32_16x16x32_bf16 v[88:91], a[148:151], v[28:31], v[88:91]
v_accvgpr_write_b32 a140, 0
v_accvgpr_write_b32 a141, 0
v_mfma_f32_16x16x32_bf16 v[88:91], a[144:147], v[24:27], v[88:91]
s_waitcnt lgkmcnt(0)
s_nop 1
v_max3_f32 v21, v104, v105, v106
v_max_f32 v21, v21, v107
v_max3_f32 v22, v120, v121, v122
v_max_f32 v22, v22, v123
v_max3_f32 v23, v136, v137, v138
v_max_f32 v23, v23, v139
v_max3_f32 v20, v88, v89, v90
v_max_f32 v20, v20, v91
v_mov_b32 v248, v20
v_mov_b32 v249, v21
v_mov_b32 v250, v22
v_mov_b32 v251, v23
v_permlane16_swap_b32 v248, v20
v_permlane16_swap_b32 v249, v21
v_permlane16_swap_b32 v250, v22
v_permlane16_swap_b32 v251, v23
v_max_f32 v20, v20, v248
v_max_f32 v21, v21, v249
v_max_f32 v22, v22, v250
v_max_f32 v23, v23, v251
v_mov_b32 v248, v20
v_mov_b32 v249, v21
v_mov_b32 v250, v22
v_mov_b32 v251, v23
v_permlane32_swap_b32 v248, v20
v_permlane32_swap_b32 v249, v21
v_permlane32_swap_b32 v250, v22
v_permlane32_swap_b32 v251, v23
v_max_f32 v20, v20, v248
v_max_f32 v21, v21, v249
v_max_f32 v22, v22, v250
v_max_f32 v23, v23, v251
s_cmp_eq_u32 s73, 0
s_cselect_b64 vcc, 0, -1
v_cndmask_b32 v20, v20, v252, vcc
v_cndmask_b32 v21, v21, v253, vcc
v_cndmask_b32 v22, v22, v254, vcc
v_cndmask_b32 v23, v23, v255, vcc
v_sub_f32 v228, 0, v23
v_sub_f32 v229, 0, v23
v_sub_f32 v230, 0, v23
v_sub_f32 v231, 0, v23
v_sub_f32 v224, 0, v22
v_sub_f32 v225, 0, v22
v_sub_f32 v226, 0, v22
v_sub_f32 v227, 0, v22
v_sub_f32 v220, 0, v21
v_sub_f32 v221, 0, v21
v_sub_f32 v222, 0, v21
v_sub_f32 v223, 0, v21
v_sub_f32 v216, 0, v20
v_sub_f32 v217, 0, v20
v_sub_f32 v218, 0, v20
v_sub_f32 v219, 0, v20
v_mfma_f32_16x16x32_bf16 v[140:143], a[160:163], v[72:75], v[228:231]
s_add_u32 m0, s71, 4096
v_add_f32 v104, v104, v220
v_add_f32 v105, v105, v220
v_mfma_f32_16x16x32_bf16 v[140:143], a[164:167], v[76:79], v[140:143]
v_add_f32 v106, v106, v220
v_add_f32 v107, v107, v220
v_exp_f32 v104, v104
v_mfma_f32_16x16x32_bf16 v[140:143], a[168:171], v[80:83], v[140:143]
s_add_u32 s64, s70, 4096
v_exp_f32 v105, v105
v_mfma_f32_16x16x32_bf16 v[140:143], a[172:175], v[84:87], v[140:143]
buffer_load_dwordx4 v16, s[32:35], s64 offen offset:0 sc1 lds
v_mfma_f32_16x16x32_bf16 v[124:127], a[172:175], v[68:71], v[224:227]
v_exp_f32 v106, v106
v_mfma_f32_16x16x32_bf16 v[124:127], a[168:171], v[64:67], v[124:127]
v_exp_f32 v107, v107
v_mfma_f32_16x16x32_bf16 v[124:127], a[164:167], v[60:63], v[124:127]
v_add_f32 v120, v120, v224
v_add_f32 v121, v121, v224
v_add_f32 v122, v122, v224
v_add_f32 v123, v123, v224
v_exp_f32 v120, v120
v_mfma_f32_16x16x32_bf16 v[124:127], a[160:163], v[56:59], v[124:127]
v_exp_f32 v121, v121
v_mfma_f32_16x16x32_bf16 v[108:111], a[160:163], v[40:43], v[220:223]
v_exp_f32 v122, v122
v_mfma_f32_16x16x32_bf16 v[108:111], a[164:167], v[44:47], v[108:111]
v_cndmask_b32 v92, v216, v17, s[10:11]
v_cndmask_b32 v93, v216, v17, s[12:13]
v_cndmask_b32 v94, v216, v17, s[18:19]
v_cndmask_b32 v95, v216, v17, s[22:23]
v_mfma_f32_16x16x32_bf16 v[108:111], a[168:171], v[48:51], v[108:111]
buffer_load_dwordx4 v16, s[32:35], s64 offen offset:1024 sc1 lds
v_cvt_pk_bf16_f32 v160, v104, v105
v_mfma_f32_16x16x32_bf16 v[108:111], a[172:175], v[52:55], v[108:111]
v_exp_f32 v123, v123
v_mfma_f32_16x16x32_bf16 v[92:95], a[172:175], v[36:39], v[92:95]
v_add_f32 v136, v136, v228
v_add_f32 v137, v137, v228
v_add_f32 v138, v138, v228
v_add_f32 v139, v139, v228
v_exp_f32 v136, v136
v_mfma_f32_16x16x32_bf16 v[92:95], a[168:171], v[32:35], v[92:95]
v_cvt_pk_bf16_f32 v161, v106, v107
v_exp_f32 v137, v137
v_cndmask_b32 v96, v216, v17, s[26:27]
v_cndmask_b32 v97, v216, v17, s[56:57]
v_cndmask_b32 v98, v216, v17, s[58:59]
v_cndmask_b32 v99, v216, v17, s[60:61]
v_mfma_f32_16x16x32_bf16 v[92:95], a[164:167], v[28:31], v[92:95]
v_exp_f32 v138, v138
v_mfma_f32_16x16x32_bf16 v[92:95], a[160:163], v[24:27], v[92:95]
v_exp_f32 v139, v139
v_mfma_f32_16x16x32_bf16 v[96:99], a[176:179], v[24:27], v[96:99]
v_cvt_pk_bf16_f32 v184, v120, v121
v_add_f32 v88, v88, v216
v_mfma_f32_16x16x32_bf16 v[96:99], a[180:183], v[28:31], v[96:99]
buffer_load_dwordx4 v16, s[32:35], s64 offen offset:2048 sc1 lds
v_add_f32 v89, v89, v216
v_add_f32 v90, v90, v216
v_add_f32 v91, v91, v216
v_exp_f32 v88, v88
v_mfma_f32_16x16x32_bf16 v[96:99], a[184:187], v[32:35], v[96:99]
v_exp_f32 v89, v89
v_mfma_f32_16x16x32_bf16 v[96:99], a[188:191], v[36:39], v[96:99]
v_cvt_pk_bf16_f32 v185, v122, v123
v_cvt_pk_bf16_f32 v192, v136, v137
v_mfma_f32_16x16x32_bf16 v[112:115], a[188:191], v[52:55], v[220:223]
v_exp_f32 v90, v90
v_mfma_f32_16x16x32_bf16 v[112:115], a[184:187], v[48:51], v[112:115]
v_exp_f32 v91, v91
v_mfma_f32_16x16x32_bf16 v[112:115], a[180:183], v[44:47], v[112:115]
v_exp_f32 v140, v140
v_mfma_f32_16x16x32_bf16 v[112:115], a[176:179], v[40:43], v[112:115]
v_exp_f32 v141, v141
v_mfma_f32_16x16x32_bf16 v[128:131], a[176:179], v[56:59], v[224:227]
buffer_load_dwordx4 v16, s[32:35], s64 offen offset:3072 sc1 lds
v_cvt_pk_bf16_f32 v193, v138, v139
v_mfma_f32_16x16x32_bf16 v[128:131], a[180:183], v[60:63], v[128:131]
v_exp_f32 v142, v142
v_mfma_f32_16x16x32_bf16 v[128:131], a[184:187], v[64:67], v[128:131]
v_exp_f32 v143, v143
v_mfma_f32_16x16x32_bf16 v[128:131], a[188:191], v[68:71], v[128:131]
v_cvt_pk_bf16_f32 v152, v88, v89
v_cvt_pk_bf16_f32 v153, v90, v91
v_mfma_f32_16x16x32_bf16 v[144:147], a[188:191], v[84:87], v[228:231]
v_exp_f32 v124, v124
v_mfma_f32_16x16x32_bf16 v[144:147], a[184:187], v[80:83], v[144:147]
v_exp_f32 v125, v125
v_mfma_f32_16x16x32_bf16 v[144:147], a[180:183], v[76:79], v[144:147]
s_waitcnt vmcnt(6)
s_barrier
v_mfma_f32_16x16x32_bf16 v[144:147], a[176:179], v[72:75], v[144:147]
v_exp_f32 v126, v126
v_mfma_f32_16x16x32_bf16 v[148:151], a[192:195], v[72:75], v[228:231]
v_cvt_pk_bf16_f32 v194, v140, v141
v_cvt_pk_bf16_f32 v195, v142, v143
v_mfma_f32_16x16x32_bf16 v[148:151], a[196:199], v[76:79], v[148:151]
v_exp_f32 v127, v127
v_mfma_f32_16x16x32_bf16 v[148:151], a[200:203], v[80:83], v[148:151]
s_xor_b32 s71, s71, 16384
v_exp_f32 v108, v108
v_mfma_f32_16x16x32_bf16 v[148:151], a[204:207], v[84:87], v[148:151]
s_add_u32 s70, s70, 32768
v_exp_f32 v109, v109
v_mfma_f32_16x16x32_bf16 v[132:135], a[204:207], v[68:71], v[224:227]
s_mov_b32 m0, s71
v_exp_f32 v110, v110
v_mfma_f32_16x16x32_bf16 v[132:135], a[200:203], v[64:67], v[132:135]
buffer_load_dwordx4 v16, s[32:35], s70 offen offset:0 sc1 lds
v_mfma_f32_16x16x32_bf16 v[132:135], a[196:199], v[60:63], v[132:135]
v_cvt_pk_bf16_f32 v186, v124, v125
v_exp_f32 v111, v111
v_mfma_f32_16x16x32_bf16 v[132:135], a[192:195], v[56:59], v[132:135]
v_exp_f32 v92, v92
v_mfma_f32_16x16x32_bf16 v[116:119], a[192:195], v[40:43], v[220:223]
ds_read_b128 a[144:147], v2 offset:16384
v_cndmask_b32 v100, v216, v17, s[62:63]
v_mfma_f32_16x16x32_bf16 v[116:119], a[196:199], v[44:47], v[116:119]
ds_read_b128 a[148:151], v2 offset:17408
v_cndmask_b32 v101, v216, v17, s[48:49]
v_cndmask_b32 v102, v216, v17, s[50:51]
v_cndmask_b32 v103, v216, v17, s[100:101]
v_cvt_pk_bf16_f32 v187, v126, v127
v_exp_f32 v93, v93
v_mfma_f32_16x16x32_bf16 v[116:119], a[200:203], v[48:51], v[116:119]
v_exp_f32 v94, v94
v_mfma_f32_16x16x32_bf16 v[116:119], a[204:207], v[52:55], v[116:119]
ds_read_b128 a[152:155], v2 offset:18432
v_cvt_pk_bf16_f32 v162, v108, v109
v_mfma_f32_16x16x32_bf16 v[100:103], a[204:207], v[36:39], v[100:103]
buffer_load_dwordx4 v16, s[32:35], s70 offen offset:1024 sc1 lds
v_exp_f32 v95, v95
v_mfma_f32_16x16x32_bf16 v[100:103], a[200:203], v[32:35], v[100:103]
ds_read_b128 a[156:159], v2 offset:19456
v_exp_f32 v96, v96
v_mfma_f32_16x16x32_bf16 v[100:103], a[196:199], v[28:31], v[100:103]
v_cvt_pk_bf16_f32 v163, v110, v111
v_exp_f32 v97, v97
v_mfma_f32_16x16x32_bf16 v[100:103], a[192:195], v[24:27], v[100:103]
s_waitcnt lgkmcnt(2)
ds_read_b128 a[160:163], v2 offset:20480
ds_read_b128 a[164:167], v2 offset:21504
ds_read_b128 a[168:171], v2 offset:22528
ds_read_b128 a[172:175], v2 offset:23552
v_mfma_f32_16x16x32_bf16 v[120:123], a[144:147], v[56:59], v[224:227]
v_exp_f32 v98, v98
v_mfma_f32_16x16x32_bf16 v[120:123], a[148:151], v[60:63], v[120:123]
s_waitcnt lgkmcnt(5)
v_cvt_pk_bf16_f32 v154, v92, v93
v_exp_f32 v99, v99
v_mfma_f32_16x16x32_bf16 v[120:123], a[152:155], v[64:67], v[120:123]
s_waitcnt lgkmcnt(4)
v_exp_f32 v112, v112
v_mfma_f32_16x16x32_bf16 v[120:123], a[156:159], v[68:71], v[120:123]
v_exp_f32 v113, v113
v_mfma_f32_16x16x32_bf16 v[136:139], a[156:159], v[84:87], v[228:231]
v_cvt_pk_bf16_f32 v155, v94, v95
v_cndmask_b32 v104, v220, v17, s[0:1]
v_mfma_f32_16x16x32_bf16 v[136:139], a[152:155], v[80:83], v[136:139]
ds_read_b128 a[176:179], v2 offset:24576
buffer_load_dwordx4 v16, s[32:35], s70 offen offset:2048 sc1 lds
v_cndmask_b32 v105, v220, v17, s[4:5]
v_cndmask_b32 v106, v220, v17, s[6:7]
v_cndmask_b32 v107, v220, v17, s[8:9]
v_exp_f32 v114, v114
v_mfma_f32_16x16x32_bf16 v[136:139], a[148:151], v[76:79], v[136:139]
v_cvt_pk_bf16_f32 v156, v96, v97
v_cvt_pk_bf16_f32 v157, v98, v99
v_mfma_f32_16x16x32_bf16 v[136:139], a[144:147], v[72:75], v[136:139]
v_exp_f32 v115, v115
v_mfma_f32_16x16x32_bf16 v[104:107], a[144:147], v[40:43], v[104:107]
v_exp_f32 v128, v128
v_mfma_f32_16x16x32_bf16 v[104:107], a[148:151], v[44:47], v[104:107]
v_exp_f32 v129, v129
v_mfma_f32_16x16x32_bf16 v[104:107], a[152:155], v[48:51], v[104:107]
v_exp_f32 v130, v130
v_mfma_f32_16x16x32_bf16 v[104:107], a[156:159], v[52:55], v[104:107]
s_waitcnt lgkmcnt(0)
v_exp_f32 v131, v131
v_mfma_f32_16x16x32_bf16 v[140:143], a[172:175], v[84:87], v[228:231]
v_cvt_pk_bf16_f32 v164, v112, v113
v_cvt_pk_bf16_f32 v165, v114, v115
v_mfma_f32_16x16x32_bf16 v[140:143], a[168:171], v[80:83], v[140:143]
v_exp_f32 v144, v144
v_mfma_f32_16x16x32_bf16 v[140:143], a[164:167], v[76:79], v[140:143]
v_exp_f32 v145, v145
v_mfma_f32_16x16x32_bf16 v[140:143], a[160:163], v[72:75], v[140:143]
v_exp_f32 v146, v146
v_mfma_f32_16x16x32_bf16 v[124:127], a[160:163], v[56:59], v[224:227]
ds_read_b128 a[180:183], v2 offset:25600
v_cndmask_b32 v108, v220, v17, s[10:11]
v_mfma_f32_16x16x32_bf16 v[124:127], a[164:167], v[60:63], v[124:127]
ds_read_b128 a[184:187], v2 offset:26624
buffer_load_dwordx4 v16, s[32:35], s70 offen offset:3072 sc1 lds
v_cndmask_b32 v109, v220, v17, s[12:13]
v_cndmask_b32 v110, v220, v17, s[18:19]
v_cndmask_b32 v111, v220, v17, s[22:23]
v_cvt_pk_bf16_f32 v188, v128, v129
v_mfma_f32_16x16x32_bf16 v[124:127], a[168:171], v[64:67], v[124:127]
s_add_u32 m0, s86, 131072
v_exp_f32 v147, v147
v_mfma_f32_16x16x32_bf16 v[124:127], a[172:175], v[68:71], v[124:127]
s_add_u32 s64, s85, 0
ds_read_b128 a[188:191], v2 offset:27648
v_exp_f32 v148, v148
v_mfma_f32_16x16x32_bf16 v[108:111], a[172:175], v[52:55], v[108:111]
buffer_load_dwordx4 v12, s[36:39], s64 offen lds
v_cvt_pk_bf16_f32 v189, v130, v131
v_exp_f32 v149, v149
v_mfma_f32_16x16x32_bf16 v[108:111], a[168:171], v[48:51], v[108:111]
s_add_u32 m0, s86, 132096
ds_read_b128 a[192:195], v2 offset:28672
v_cndmask_b32 v112, v220, v17, s[26:27]
v_cndmask_b32 v113, v220, v17, s[56:57]
v_cndmask_b32 v114, v220, v17, s[58:59]
v_cndmask_b32 v115, v220, v17, s[60:61]
v_mfma_f32_16x16x32_bf16 v[108:111], a[164:167], v[44:47], v[108:111]
s_add_u32 s64, s85, 8192
v_exp_f32 v150, v150
v_mfma_f32_16x16x32_bf16 v[108:111], a[160:163], v[40:43], v[108:111]
buffer_load_dwordx4 v13, s[36:39], s64 offen lds
v_cvt_pk_bf16_f32 v196, v144, v145
v_exp_f32 v151, v151
v_mfma_f32_16x16x32_bf16 v[112:115], a[176:179], v[40:43], v[112:115]
s_waitcnt lgkmcnt(2)
s_add_u32 m0, s86, 133120
v_exp_f32 v132, v132
v_mfma_f32_16x16x32_bf16 v[112:115], a[180:183], v[44:47], v[112:115]
s_add_u32 s64, s85, 16384
v_exp_f32 v133, v133
v_mfma_f32_16x16x32_bf16 v[112:115], a[184:187], v[48:51], v[112:115]
s_waitcnt lgkmcnt(1)
buffer_load_dwordx4 v12, s[36:39], s64 offen lds
v_cvt_pk_bf16_f32 v197, v146, v147
v_mfma_f32_16x16x32_bf16 v[112:115], a[188:191], v[52:55], v[112:115]
s_add_u32 m0, s86, 134144
v_exp_f32 v134, v134
v_mfma_f32_16x16x32_bf16 v[128:131], a[188:191], v[68:71], v[224:227]
s_add_u32 s64, s85, 24576
ds_read_b128 a[196:199], v2 offset:29696
ds_read_b128 a[200:203], v2 offset:30720
ds_read_b128 a[204:207], v2 offset:31744
v_cvt_pk_bf16_f32 v198, v148, v149
v_mfma_f32_16x16x32_bf16 v[128:131], a[184:187], v[64:67], v[128:131]
buffer_load_dwordx4 v13, s[36:39], s64 offen lds
v_exp_f32 v135, v135
v_mfma_f32_16x16x32_bf16 v[128:131], a[180:183], v[60:63], v[128:131]
s_add_u32 m0, s71, 4096
v_exp_f32 v116, v116
v_mfma_f32_16x16x32_bf16 v[128:131], a[176:179], v[56:59], v[128:131]
s_add_u32 s64, s70, 4096
v_cvt_pk_bf16_f32 v199, v150, v151
v_exp_f32 v117, v117
v_mfma_f32_16x16x32_bf16 v[144:147], a[176:179], v[72:75], v[228:231]
buffer_load_dwordx4 v16, s[32:35], s64 offen offset:0 sc1 lds
v_mfma_f32_16x16x32_bf16 v[144:147], a[180:183], v[76:79], v[144:147]
v_exp_f32 v118, v118
v_mfma_f32_16x16x32_bf16 v[144:147], a[184:187], v[80:83], v[144:147]
v_cvt_pk_bf16_f32 v190, v132, v133
v_exp_f32 v119, v119
v_mfma_f32_16x16x32_bf16 v[144:147], a[188:191], v[84:87], v[144:147]
s_waitcnt lgkmcnt(0)
v_exp_f32 v100, v100
v_mfma_f32_16x16x32_bf16 v[148:151], a[204:207], v[84:87], v[228:231]
v_exp_f32 v101, v101
v_mfma_f32_16x16x32_bf16 v[148:151], a[200:203], v[80:83], v[148:151]
v_cvt_pk_bf16_f32 v191, v134, v135
v_cvt_pk_bf16_f32 v166, v116, v117
v_cvt_pk_bf16_f32 v167, v118, v119
v_mfma_f32_16x16x32_bf16 v[148:151], a[196:199], v[76:79], v[148:151]
v_exp_f32 v102, v102
v_mfma_f32_16x16x32_bf16 v[148:151], a[192:195], v[72:75], v[148:151]
v_exp_f32 v103, v103
v_mfma_f32_16x16x32_bf16 v[132:135], a[192:195], v[56:59], v[224:227]
s_lshl_b32 s66, s30, 30
ds_read_b128 a[144:147], v3 offset:16384
v_cndmask_b32 v116, v220, v17, s[62:63]
v_mfma_f32_16x16x32_bf16 v[132:135], a[196:199], v[60:63], v[132:135]
ds_read_b128 a[148:151], v3 offset:24576
v_cndmask_b32 v117, v220, v17, s[48:49]
v_cndmask_b32 v118, v220, v17, s[50:51]
v_cndmask_b32 v119, v220, v17, s[100:101]
v_exp_f32 v120, v120
v_mfma_f32_16x16x32_bf16 v[132:135], a[200:203], v[64:67], v[132:135]
v_exp_f32 v121, v121
v_mfma_f32_16x16x32_bf16 v[132:135], a[204:207], v[68:71], v[132:135]
v_exp_f32 v122, v122
v_mfma_f32_16x16x32_bf16 v[116:119], a[204:207], v[52:55], v[116:119]
ds_read_b128 a[152:155], v3 offset:17408
v_accvgpr_write_b32 a142, 0
v_mfma_f32_16x16x32_bf16 v[116:119], a[200:203], v[48:51], v[116:119]
s_branch L_po27
L_pg27:
s_branch L_tr3
L_po27:
ds_read_b128 a[156:159], v3 offset:25600
buffer_load_dwordx4 v16, s[32:35], s64 offen offset:1024 sc1 lds
v_accvgpr_write_b32 a143, 0
v_cvt_pk_bf16_f32 v158, v100, v101
v_cvt_pk_bf16_f32 v159, v102, v103
v_mfma_f32_16x16x32_bf16 v[116:119], a[196:199], v[44:47], v[116:119]
v_exp_f32 v123, v123
v_mfma_f32_16x16x32_bf16 v[116:119], a[192:195], v[40:43], v[116:119]
v_exp_f32 v136, v136
v_smfmac_f32_16x16x64_bf16 a[128:131], a[240:243], v[152:159], v5
ds_read_b128 a[160:163], v3 offset:18432
v_smfmac_f32_16x16x64_bf16 a[132:135], a[240:243], v[160:167], v5
v_exp_f32 v137, v137
v_smfmac_f32_16x16x64_bf16 a[136:139], a[240:243], v[184:191], v5
v_exp_f32 v138, v138
v_smfmac_f32_16x16x64_bf16 a[140:143], a[240:243], v[192:199], v5
s_waitcnt lgkmcnt(1)
v_cvt_pk_bf16_f32 v200, v120, v121
v_mfma_f32_16x16x32_bf16 a[0:3], a[144:147], v[152:155], 0
v_exp_f32 v139, v139
v_mfma_f32_16x16x32_bf16 a[0:3], a[148:151], v[156:159], a[0:3]
v_exp_f32 v104, v104
v_mfma_f32_16x16x32_bf16 a[32:35], a[148:151], v[164:167], 0
v_cvt_pk_bf16_f32 v201, v122, v123
v_cvt_pk_bf16_f32 v208, v136, v137
v_mfma_f32_16x16x32_bf16 a[32:35], a[144:147], v[160:163], a[32:35]
v_exp_f32 v105, v105
v_mfma_f32_16x16x32_bf16 a[64:67], a[144:147], v[184:187], 0
v_exp_f32 v106, v106
v_mfma_f32_16x16x32_bf16 a[64:67], a[148:151], v[188:191], a[64:67]
v_exp_f32 v107, v107
v_mfma_f32_16x16x32_bf16 a[96:99], a[148:151], v[196:199], 0
buffer_load_dwordx4 v16, s[32:35], s64 offen offset:2048 sc1 lds
v_mfma_f32_16x16x32_bf16 a[96:99], a[144:147], v[192:195], a[96:99]
v_exp_f32 v140, v140
v_mfma_f32_16x16x32_bf16 a[100:103], a[152:155], v[192:195], 0
ds_read_b128 a[164:167], v3 offset:26624
v_cvt_pk_bf16_f32 v209, v138, v139
v_mfma_f32_16x16x32_bf16 a[100:103], a[156:159], v[196:199], a[100:103]
v_exp_f32 v141, v141
v_mfma_f32_16x16x32_bf16 a[68:71], a[156:159], v[188:191], 0
v_exp_f32 v142, v142
v_mfma_f32_16x16x32_bf16 a[68:71], a[152:155], v[184:187], a[68:71]
v_cvt_pk_bf16_f32 v176, v104, v105
v_cvt_pk_bf16_f32 v177, v106, v107
v_mfma_f32_16x16x32_bf16 a[36:39], a[152:155], v[160:163], 0
v_exp_f32 v143, v143
v_mfma_f32_16x16x32_bf16 a[36:39], a[156:159], v[164:167], a[36:39]
v_exp_f32 v124, v124
v_mfma_f32_16x16x32_bf16 a[4:7], a[156:159], v[156:159], 0
v_exp_f32 v125, v125
v_mfma_f32_16x16x32_bf16 a[4:7], a[152:155], v[152:155], a[4:7]
s_waitcnt lgkmcnt(0)
ds_read_b128 a[168:171], v3 offset:19456
v_cvt_pk_bf16_f32 v210, v140, v141
v_mfma_f32_16x16x32_bf16 a[8:11], a[160:163], v[152:155], 0
v_exp_f32 v126, v126
v_mfma_f32_16x16x32_bf16 a[8:11], a[164:167], v[156:159], a[8:11]
ds_read_b128 a[172:175], v3 offset:27648
v_cvt_pk_bf16_f32 v211, v142, v143
v_mfma_f32_16x16x32_bf16 a[40:43], a[164:167], v[164:167], 0
v_exp_f32 v127, v127
v_mfma_f32_16x16x32_bf16 a[40:43], a[160:163], v[160:163], a[40:43]
v_exp_f32 v108, v108
v_mfma_f32_16x16x32_bf16 a[72:75], a[160:163], v[184:187], 0
buffer_load_dwordx4 v16, s[32:35], s64 offen offset:3072 sc1 lds
v_mfma_f32_16x16x32_bf16 a[72:75], a[164:167], v[188:191], a[72:75]
v_exp_f32 v109, v109
v_mfma_f32_16x16x32_bf16 a[104:107], a[164:167], v[196:199], 0
v_exp_f32 v110, v110
v_mfma_f32_16x16x32_bf16 a[104:107], a[160:163], v[192:195], a[104:107]
s_waitcnt lgkmcnt(0)
ds_read_b128 a[176:179], v3 offset:20480
v_cvt_pk_bf16_f32 v202, v124, v125
v_mfma_f32_16x16x32_bf16 a[108:111], a[168:171], v[192:195], 0
v_exp_f32 v111, v111
v_mfma_f32_16x16x32_bf16 a[108:111], a[172:175], v[196:199], a[108:111]
ds_read_b128 a[180:183], v3 offset:28672
v_cvt_pk_bf16_f32 v203, v126, v127
v_mfma_f32_16x16x32_bf16 a[76:79], a[172:175], v[188:191], 0
s_add_u32 m0, s86, 135168
v_exp_f32 v112, v112
v_mfma_f32_16x16x32_bf16 a[76:79], a[168:171], v[184:187], a[76:79]
s_add_u32 s64, s85, 32768
v_exp_f32 v113, v113
v_mfma_f32_16x16x32_bf16 a[44:47], a[168:171], v[160:163], 0
buffer_load_dwordx4 v12, s[36:39], s64 offen lds
v_mfma_f32_16x16x32_bf16 a[44:47], a[172:175], v[164:167], a[44:47]
s_add_u32 m0, s86, 136192
v_cvt_pk_bf16_f32 v178, v108, v109
v_exp_f32 v114, v114
v_mfma_f32_16x16x32_bf16 a[12:15], a[172:175], v[156:159], 0
s_add_u32 s64, s85, 40960
v_exp_f32 v115, v115
v_mfma_f32_16x16x32_bf16 a[12:15], a[168:171], v[152:155], a[12:15]
s_waitcnt lgkmcnt(0)
buffer_load_dwordx4 v13, s[36:39], s64 offen lds
v_mfma_f32_16x16x32_bf16 a[16:19], a[176:179], v[152:155], 0
s_add_u32 m0, s86, 137216
ds_read_b128 a[184:187], v3 offset:21504
ds_read_b128 a[188:191], v3 offset:29696
ds_read_b128 a[192:195], v3 offset:22528
ds_read_b128 a[196:199], v3 offset:30720
ds_read_b128 a[200:203], v3 offset:23552
ds_read_b128 a[204:207], v3 offset:31744
v_xor_b32 v2, 0x8000, v2
v_exp_f32 v128, v128
v_mfma_f32_16x16x32_bf16 a[16:19], a[180:183], v[156:159], a[16:19]
s_waitcnt vmcnt(14)
s_barrier
s_add_u32 s64, s85, 49152
v_cvt_pk_bf16_f32 v179, v110, v111
v_mfma_f32_16x16x32_bf16 a[48:51], a[180:183], v[164:167], 0
buffer_load_dwordx4 v12, s[36:39], s64 offen lds
v_exp_f32 v129, v129
v_mfma_f32_16x16x32_bf16 a[48:51], a[176:179], v[160:163], a[48:51]
s_add_u32 m0, s86, 138240
v_exp_f32 v130, v130
v_mfma_f32_16x16x32_bf16 a[80:83], a[176:179], v[184:187], 0
s_add_u32 s64, s85, 57344
v_cvt_pk_bf16_f32 v180, v112, v113
v_cvt_pk_bf16_f32 v181, v114, v115
v_mfma_f32_16x16x32_bf16 a[80:83], a[180:183], v[188:191], a[80:83]
buffer_load_dwordx4 v13, s[36:39], s64 offen lds
v_exp_f32 v131, v131
v_mfma_f32_16x16x32_bf16 a[112:115], a[180:183], v[196:199], 0
v_exp_f32 v144, v144
v_mfma_f32_16x16x32_bf16 a[112:115], a[176:179], v[192:195], a[112:115]
s_waitcnt lgkmcnt(0)
s_xor_b32 s71, s71, 49152
s_add_u32 s70, s70, 32768
s_mov_b32 m0, s71
v_exp_f32 v145, v145
v_mfma_f32_16x16x32_bf16 a[116:119], a[184:187], v[192:195], 0
buffer_load_dwordx4 v16, s[32:35], s70 offen offset:0 sc1 lds
v_mfma_f32_16x16x32_bf16 a[116:119], a[188:191], v[196:199], a[116:119]
v_exp_f32 v146, v146
v_mfma_f32_16x16x32_bf16 a[84:87], a[188:191], v[188:191], 0
v_cvt_pk_bf16_f32 v204, v128, v129
v_cvt_pk_bf16_f32 v205, v130, v131
v_mfma_f32_16x16x32_bf16 a[84:87], a[184:187], v[184:187], a[84:87]
v_exp_f32 v147, v147
v_mfma_f32_16x16x32_bf16 a[52:55], a[184:187], v[160:163], 0
v_exp_f32 v148, v148
v_mfma_f32_16x16x32_bf16 a[52:55], a[188:191], v[164:167], a[52:55]
v_exp_f32 v149, v149
v_mfma_f32_16x16x32_bf16 a[20:23], a[188:191], v[156:159], 0
ds_read_b128 a[144:147], v2 offset:0
v_lshl_add_u32 v19, v0, 24, s66
v_mfma_f32_16x16x32_bf16 a[20:23], a[184:187], v[152:155], a[20:23]
s_lshr_b32 s67, s31, 4
v_exp_f32 v150, v150
v_mfma_f32_16x16x32_bf16 a[24:27], a[192:195], v[152:155], 0
s_lshl1_add_u32 s67, s3, s67
v_cvt_pk_bf16_f32 v212, v144, v145
v_cvt_pk_bf16_f32 v213, v146, v147
v_mfma_f32_16x16x32_bf16 a[24:27], a[196:199], v[156:159], a[24:27]
s_lshl_b32 s79, s67, 8
v_exp_f32 v151, v151
v_mfma_f32_16x16x32_bf16 a[56:59], a[196:199], v[164:167], 0
s_add_u32 s79, s79, 8192
v_exp_f32 v132, v132
v_mfma_f32_16x16x32_bf16 a[56:59], a[192:195], v[160:163], a[56:59]
s_add_u32 s69, s31, 12
v_exp_f32 v133, v133
v_mfma_f32_16x16x32_bf16 a[88:91], a[192:195], v[184:187], 0
s_lshr_b32 s69, s69, 5
buffer_load_dwordx4 v16, s[32:35], s70 offen offset:1024 sc1 lds
v_mfma_f32_16x16x32_bf16 a[88:91], a[196:199], v[188:191], a[88:91]
s_lshl1_add_u32 s69, s3, s69
v_exp_f32 v134, v134
v_mfma_f32_16x16x32_bf16 a[120:123], a[196:199], v[196:199], 0
s_lshl_b32 s69, s69, 8
v_cvt_pk_bf16_f32 v214, v148, v149
v_cvt_pk_bf16_f32 v215, v150, v151
v_mfma_f32_16x16x32_bf16 a[120:123], a[192:195], v[192:195], a[120:123]
s_add_u32 s69, s69, 8192
v_exp_f32 v135, v135
v_mfma_f32_16x16x32_bf16 a[124:127], a[200:203], v[192:195], 0
s_lshl_b32 s67, s73, 16
v_exp_f32 v116, v116
v_mfma_f32_16x16x32_bf16 a[124:127], a[204:207], v[196:199], a[124:127]
s_xor_b32 s68, s80, 256
v_exp_f32 v117, v117
v_mfma_f32_16x16x32_bf16 a[92:95], a[204:207], v[188:191], 0
s_add_u32 s68, s68, s67
ds_read_b128 a[148:151], v2 offset:1024
v_cvt_pk_bf16_f32 v206, v132, v133
v_mfma_f32_16x16x32_bf16 a[92:95], a[200:203], v[184:187], a[92:95]
s_add_u32 s67, s67, s69
v_exp_f32 v118, v118
v_mfma_f32_16x16x32_bf16 a[60:63], a[200:203], v[160:163], 0
ds_read_b128 a[152:155], v2 offset:2048
v_cvt_pk_bf16_f32 v207, v134, v135
v_mfma_f32_16x16x32_bf16 a[60:63], a[204:207], v[164:167], a[60:63]
ds_read_b128 a[156:159], v2 offset:3072
v_cvt_pk_bf16_f32 v182, v116, v117
v_mfma_f32_16x16x32_bf16 a[28:31], a[204:207], v[156:159], 0
s_mov_b64 exec, 1
buffer_atomic_add a251, v19, s[52:55], s67 offen offset:0 sc1
buffer_atomic_add a251, v19, s[52:55], s68 offen offset:0 sc1
s_mov_b64 exec, -1
v_exp_f32 v119, v119
v_mfma_f32_16x16x32_bf16 a[28:31], a[200:203], v[152:155], a[28:31]
ds_read_b128 a[160:163], v2 offset:4096
ds_read_b128 a[164:167], v2 offset:5120
ds_read_b128 a[168:171], v2 offset:6144
ds_read_b128 a[172:175], v2 offset:7168
v_mul_u32_u24 v19, 52, v0
v_cvt_pk_bf16_f32 v183, v118, v119
v_xor_b32 v3, 0x8000, v3
v_accvgpr_read_b32 v20, a128
v_accvgpr_read_b32 v248, a129
v_add_f32 v20, v20, v248
v_max_f32 v1, v1, v20
v_rcp_f32 v20, v20
v_accvgpr_read_b32 v232, a0
v_accvgpr_read_b32 v233, a1
v_accvgpr_read_b32 v234, a2
v_accvgpr_read_b32 v235, a3
v_accvgpr_read_b32 v236, a4
v_accvgpr_read_b32 v237, a5
v_accvgpr_read_b32 v238, a6
v_accvgpr_read_b32 v239, a7
v_mul_f32 v20, v20, v4
v_mul_f32 v232, v232, v20
v_mul_f32 v233, v233, v20
v_mul_f32 v234, v234, v20
v_mul_f32 v235, v235, v20
v_mul_f32 v236, v236, v20
v_mul_f32 v237, v237, v20
v_mul_f32 v238, v238, v20
v_mul_f32 v239, v239, v20
v_cvt_pk_bf16_f32 v232, v232, v233
v_cvt_pk_bf16_f32 v233, v234, v235
v_cvt_pk_bf16_f32 v234, v236, v237
v_cvt_pk_bf16_f32 v235, v238, v239
s_add_u32 s77, s74, 0
buffer_store_dwordx4 v[232:235], v16, s[44:47], s77 offen sc1
v_accvgpr_read_b32 v240, a8
v_accvgpr_read_b32 v241, a9
v_accvgpr_read_b32 v242, a10
v_accvgpr_read_b32 v243, a11
v_accvgpr_read_b32 v244, a12
v_accvgpr_read_b32 v245, a13
v_accvgpr_read_b32 v246, a14
v_accvgpr_read_b32 v247, a15
v_mul_f32 v240, v240, v20
v_mul_f32 v241, v241, v20
v_mul_f32 v242, v242, v20
v_mul_f32 v243, v243, v20
v_mul_f32 v244, v244, v20
v_mul_f32 v245, v245, v20
v_mul_f32 v246, v246, v20
v_mul_f32 v247, v247, v20
v_cvt_pk_bf16_f32 v240, v240, v241
v_cvt_pk_bf16_f32 v241, v242, v243
v_cvt_pk_bf16_f32 v242, v244, v245
v_cvt_pk_bf16_f32 v243, v246, v247
s_add_u32 s77, s74, 8192
buffer_store_dwordx4 v[240:243], v16, s[44:47], s77 offen sc1
v_accvgpr_read_b32 v232, a16
v_accvgpr_read_b32 v233, a17
v_accvgpr_read_b32 v234, a18
v_accvgpr_read_b32 v235, a19
v_accvgpr_read_b32 v236, a20
v_accvgpr_read_b32 v237, a21
v_accvgpr_read_b32 v238, a22
v_accvgpr_read_b32 v239, a23
v_mul_f32 v232, v232, v20
v_mul_f32 v233, v233, v20
v_mul_f32 v234, v234, v20
v_mul_f32 v235, v235, v20
v_mul_f32 v236, v236, v20
v_mul_f32 v237, v237, v20
v_mul_f32 v238, v238, v20
v_mul_f32 v239, v239, v20
v_cvt_pk_bf16_f32 v232, v232, v233
v_cvt_pk_bf16_f32 v233, v234, v235
v_cvt_pk_bf16_f32 v234, v236, v237
v_cvt_pk_bf16_f32 v235, v238, v239
s_add_u32 s77, s74, 16384
buffer_store_dwordx4 v[232:235], v16, s[44:47], s77 offen sc1
s_branch L_T
L_pg28:
s_branch L_tr4
L_T1:
buffer_load_dword v19, off, s[52:55], s80 sc1
s_waitcnt lgkmcnt(7)
v_mfma_f32_16x16x32_bf16 v[136:139], a[144:147], v[72:75], v[228:231]
s_waitcnt lgkmcnt(6)
ds_read_b128 a[176:179], v2 offset:8192
v_cndmask_b32 v120, v224, v17, s[0:1]
v_mfma_f32_16x16x32_bf16 v[136:139], a[148:151], v[76:79], v[136:139]
s_waitcnt lgkmcnt(6)
ds_read_b128 a[180:183], v2 offset:9216
v_cndmask_b32 v121, v224, v17, s[4:5]
v_cndmask_b32 v122, v224, v17, s[6:7]
v_cndmask_b32 v123, v224, v17, s[8:9]
v_mfma_f32_16x16x32_bf16 v[136:139], a[152:155], v[80:83], v[136:139]
s_waitcnt lgkmcnt(6)
buffer_load_dwordx4 v16, s[32:35], s70 offen offset:2048 sc1 lds
v_mfma_f32_16x16x32_bf16 v[136:139], a[156:159], v[84:87], v[136:139]
ds_read_b128 a[184:187], v2 offset:10240
v_cndmask_b32 v124, v224, v17, s[10:11]
v_mfma_f32_16x16x32_bf16 v[120:123], a[156:159], v[68:71], v[120:123]
ds_read_b128 a[188:191], v2 offset:11264
v_cndmask_b32 v125, v224, v17, s[12:13]
v_mfma_f32_16x16x32_bf16 v[120:123], a[152:155], v[64:67], v[120:123]
ds_read_b128 a[192:195], v2 offset:12288
v_cndmask_b32 v126, v224, v17, s[18:19]
v_mfma_f32_16x16x32_bf16 v[120:123], a[148:151], v[60:63], v[120:123]
ds_read_b128 a[196:199], v2 offset:13312
v_cndmask_b32 v127, v224, v17, s[22:23]
v_mfma_f32_16x16x32_bf16 v[120:123], a[144:147], v[56:59], v[120:123]
s_waitcnt lgkmcnt(4)
ds_read_b128 a[200:203], v2 offset:14336
v_cndmask_b32 v128, v224, v17, s[26:27]
v_mfma_f32_16x16x32_bf16 v[140:143], a[160:163], v[72:75], v[228:231]
ds_read_b128 a[204:207], v2 offset:15360
v_cndmask_b32 v129, v224, v17, s[56:57]
v_mfma_f32_16x16x32_bf16 v[140:143], a[164:167], v[76:79], v[140:143]
ds_read_b128 a[144:147], v3 offset:0
v_cndmask_b32 v130, v224, v17, s[58:59]
v_mfma_f32_16x16x32_bf16 v[140:143], a[168:171], v[80:83], v[140:143]
v_exp_f32 v136, v136
v_mfma_f32_16x16x32_bf16 v[140:143], a[172:175], v[84:87], v[140:143]
v_exp_f32 v137, v137
v_mfma_f32_16x16x32_bf16 v[124:127], a[172:175], v[68:71], v[124:127]
ds_read_b128 a[148:151], v3 offset:8192
v_cndmask_b32 v131, v224, v17, s[60:61]
v_mfma_f32_16x16x32_bf16 v[124:127], a[168:171], v[64:67], v[124:127]
v_exp_f32 v138, v138
v_mfma_f32_16x16x32_bf16 v[124:127], a[164:167], v[60:63], v[124:127]
s_mul_i32 s69, s83, 8
buffer_load_dwordx4 v16, s[32:35], s70 offen offset:3072 sc1 lds
v_mfma_f32_16x16x32_bf16 v[124:127], a[160:163], v[56:59], v[124:127]
s_sub_u32 s69, 36, s69
v_exp_f32 v139, v139
v_mfma_f32_16x16x32_bf16 v[128:131], a[176:179], v[56:59], v[128:131]
v_exp_f32 v120, v120
v_mfma_f32_16x16x32_bf16 v[128:131], a[180:183], v[60:63], v[128:131]
s_waitcnt lgkmcnt(1)
v_exp_f32 v121, v121
v_mfma_f32_16x16x32_bf16 v[128:131], a[184:187], v[64:67], v[128:131]
v_exp_f32 v122, v122
v_mfma_f32_16x16x32_bf16 v[128:131], a[188:191], v[68:71], v[128:131]
s_add_u32 m0, s71, 4096
ds_read_b128 a[152:155], v3 offset:1024
v_cndmask_b32 v132, v224, v17, s[62:63]
v_mfma_f32_16x16x32_bf16 v[144:147], a[188:191], v[84:87], v[228:231]
s_add_u32 s64, s70, 4096
v_cvt_pk_bf16_f32 v192, v136, v137
v_cndmask_b32 v133, v224, v17, s[48:49]
v_mfma_f32_16x16x32_bf16 v[144:147], a[184:187], v[80:83], v[144:147]
buffer_load_dwordx4 v16, s[32:35], s64 offen offset:0 sc1 lds
v_mfma_f32_16x16x32_bf16 v[144:147], a[180:183], v[76:79], v[144:147]
ds_read_b128 a[156:159], v3 offset:9216
v_cndmask_b32 v134, v224, v17, s[50:51]
v_mfma_f32_16x16x32_bf16 v[144:147], a[176:179], v[72:75], v[144:147]
ds_read_b128 a[160:163], v3 offset:2048
v_cndmask_b32 v135, v224, v17, s[100:101]
v_mfma_f32_16x16x32_bf16 v[148:151], a[192:195], v[72:75], v[228:231]
v_exp_f32 v123, v123
v_mfma_f32_16x16x32_bf16 v[148:151], a[196:199], v[76:79], v[148:151]
v_cvt_pk_bf16_f32 v193, v138, v139
v_cvt_pk_bf16_f32 v184, v120, v121
v_mfma_f32_16x16x32_bf16 v[148:151], a[200:203], v[80:83], v[148:151]
v_exp_f32 v140, v140
v_mfma_f32_16x16x32_bf16 v[148:151], a[204:207], v[84:87], v[148:151]
v_exp_f32 v141, v141
v_mfma_f32_16x16x32_bf16 v[132:135], a[204:207], v[68:71], v[132:135]
v_exp_f32 v142, v142
v_mfma_f32_16x16x32_bf16 v[132:135], a[200:203], v[64:67], v[132:135]
v_exp_f32 v143, v143
v_mfma_f32_16x16x32_bf16 v[132:135], a[196:199], v[60:63], v[132:135]
buffer_load_dwordx4 v16, s[32:35], s64 offen offset:1024 sc1 lds
v_mfma_f32_16x16x32_bf16 v[132:135], a[192:195], v[56:59], v[132:135]
v_exp_f32 v124, v124
v_smfmac_f32_16x16x64_bf16 a[132:135], a[240:243], v[176:183], v5
ds_read_b128 a[164:167], v3 offset:10240
v_smfmac_f32_16x16x64_bf16 a[136:139], a[240:243], v[200:207], v5
ds_read_b128 a[168:171], v3 offset:3072
v_accvgpr_read_b32 v240, a24
v_smfmac_f32_16x16x64_bf16 a[140:143], a[240:243], v[208:215], v5
v_cvt_pk_bf16_f32 v185, v122, v123
v_mfma_f32_16x16x32_bf16 a[32:35], a[144:147], v[176:179], a[32:35]
s_waitcnt lgkmcnt(2)
v_exp_f32 v125, v125
v_mfma_f32_16x16x32_bf16 a[32:35], a[148:151], v[180:183], a[32:35]
ds_read_b128 a[172:175], v3 offset:11264
v_accvgpr_read_b32 v241, a25
v_mfma_f32_16x16x32_bf16 a[64:67], a[148:151], v[204:207], a[64:67]
ds_read_b128 a[176:179], v3 offset:4096
v_accvgpr_read_b32 v242, a26
v_mfma_f32_16x16x32_bf16 a[64:67], a[144:147], v[200:203], a[64:67]
v_cvt_pk_bf16_f32 v194, v140, v141
v_accvgpr_read_b32 v243, a27
v_mfma_f32_16x16x32_bf16 a[96:99], a[144:147], v[208:211], a[96:99]
ds_read_b128 a[180:183], v3 offset:12288
v_accvgpr_read_b32 v244, a28
v_mfma_f32_16x16x32_bf16 a[96:99], a[148:151], v[212:215], a[96:99]
ds_read_b128 a[184:187], v3 offset:5120
v_accvgpr_read_b32 v245, a29
v_mfma_f32_16x16x32_bf16 a[100:103], a[156:159], v[212:215], a[100:103]
ds_read_b128 a[188:191], v3 offset:13312
v_accvgpr_read_b32 v246, a30
v_mfma_f32_16x16x32_bf16 a[100:103], a[152:155], v[208:211], a[100:103]
ds_read_b128 a[192:195], v3 offset:6144
v_accvgpr_read_b32 v247, a31
v_mul_f32 v240, v240, v20
v_mul_f32 v241, v241, v20
v_mul_f32 v242, v242, v20
v_mul_f32 v243, v243, v20
v_mul_f32 v244, v244, v20
v_mul_f32 v245, v245, v20
v_mul_f32 v246, v246, v20
v_mul_f32 v247, v247, v20
v_cvt_pk_bf16_f32 v240, v240, v241
v_cvt_pk_bf16_f32 v241, v242, v243
v_cvt_pk_bf16_f32 v242, v244, v245
v_cvt_pk_bf16_f32 v243, v246, v247
s_add_u32 s77, s74, 24576
buffer_store_dwordx4 v[240:243], v16, s[44:47], s77 offen sc1
v_exp_f32 v126, v126
v_mfma_f32_16x16x32_bf16 a[68:71], a[152:155], v[200:203], a[68:71]
buffer_load_dwordx4 v16, s[32:35], s64 offen offset:2048 sc1 lds
v_cvt_pk_bf16_f32 v195, v142, v143
v_mfma_f32_16x16x32_bf16 a[68:71], a[156:159], v[204:207], a[68:71]
v_exp_f32 v127, v127
v_mfma_f32_16x16x32_bf16 a[36:39], a[156:159], v[180:183], a[36:39]
v_exp_f32 v128, v128
v_mfma_f32_16x16x32_bf16 a[36:39], a[152:155], v[176:179], a[36:39]
v_exp_f32 v129, v129
v_mfma_f32_16x16x32_bf16 a[40:43], a[160:163], v[176:179], a[40:43]
s_waitcnt lgkmcnt(1)
v_cvt_pk_bf16_f32 v186, v124, v125
v_cvt_pk_bf16_f32 v187, v126, v127
v_mfma_f32_16x16x32_bf16 a[40:43], a[164:167], v[180:183], a[40:43]
v_exp_f32 v130, v130
v_mfma_f32_16x16x32_bf16 a[72:75], a[164:167], v[204:207], a[72:75]
buffer_load_dwordx4 v16, s[32:35], s64 offen offset:3072 sc1 lds
v_mfma_f32_16x16x32_bf16 a[72:75], a[160:163], v[200:203], a[72:75]
v_exp_f32 v131, v131
v_mfma_f32_16x16x32_bf16 a[104:107], a[160:163], v[208:211], a[104:107]
v_exp_f32 v144, v144
v_mfma_f32_16x16x32_bf16 a[104:107], a[164:167], v[212:215], a[104:107]
v_exp_f32 v145, v145
v_mfma_f32_16x16x32_bf16 a[108:111], a[172:175], v[212:215], a[108:111]
v_exp_f32 v146, v146
v_mfma_f32_16x16x32_bf16 a[108:111], a[168:171], v[208:211], a[108:111]
ds_read_b128 a[196:199], v3 offset:14336
v_cvt_pk_bf16_f32 v188, v128, v129
v_mfma_f32_16x16x32_bf16 a[76:79], a[168:171], v[200:203], a[76:79]
ds_read_b128 a[200:203], v3 offset:7168
v_cvt_pk_bf16_f32 v189, v130, v131
v_mfma_f32_16x16x32_bf16 a[76:79], a[172:175], v[204:207], a[76:79]
ds_read_b128 a[204:207], v3 offset:15360
v_cvt_pk_bf16_f32 v196, v144, v145
v_mfma_f32_16x16x32_bf16 a[44:47], a[172:175], v[180:183], a[44:47]
v_exp_f32 v147, v147
v_mfma_f32_16x16x32_bf16 a[44:47], a[168:171], v[176:179], a[44:47]
v_exp_f32 v148, v148
v_mfma_f32_16x16x32_bf16 a[48:51], a[176:179], v[176:179], a[48:51]
v_exp_f32 v149, v149
v_mfma_f32_16x16x32_bf16 a[48:51], a[180:183], v[180:183], a[48:51]
v_exp_f32 v150, v150
v_mfma_f32_16x16x32_bf16 a[80:83], a[180:183], v[204:207], a[80:83]
s_waitcnt vmcnt(10)
s_barrier
v_mfma_f32_16x16x32_bf16 a[80:83], a[176:179], v[200:203], a[80:83]
v_exp_f32 v151, v151
v_mfma_f32_16x16x32_bf16 a[112:115], a[176:179], v[208:211], a[112:115]
v_exp_f32 v132, v132
v_mfma_f32_16x16x32_bf16 a[112:115], a[180:183], v[212:215], a[112:115]
v_exp_f32 v133, v133
v_mfma_f32_16x16x32_bf16 a[116:119], a[188:191], v[212:215], a[116:119]
ds_read_b128 a[144:147], v2 offset:16384
v_cvt_pk_bf16_f32 v197, v146, v147
v_mfma_f32_16x16x32_bf16 a[116:119], a[184:187], v[208:211], a[116:119]
v_exp_f32 v134, v134
v_mfma_f32_16x16x32_bf16 a[84:87], a[184:187], v[200:203], a[84:87]
s_waitcnt vmcnt(7)
v_readfirstlane_b32 vcc_lo, v19
s_nop 0
s_cmp_lt_u32 vcc_lo, s69
s_cbranch_scc1 L_spin_1012
L_spinbk_1013:
v_mfma_f32_16x16x32_bf16 a[84:87], a[188:191], v[204:207], a[84:87]
ds_read_b128 a[148:151], v2 offset:17408
v_cvt_pk_bf16_f32 v198, v148, v149
v_mfma_f32_16x16x32_bf16 a[52:55], a[188:191], v[180:183], a[52:55]
ds_read_b128 a[152:155], v2 offset:18432
v_cvt_pk_bf16_f32 v199, v150, v151
v_mfma_f32_16x16x32_bf16 a[52:55], a[184:187], v[176:179], a[52:55]
s_waitcnt lgkmcnt(3)
ds_read_b128 a[156:159], v2 offset:19456
v_cndmask_b32 v136, v228, v17, s[0:1]
v_mfma_f32_16x16x32_bf16 a[56:59], a[192:195], v[176:179], a[56:59]
ds_read_b128 a[160:163], v2 offset:20480
v_cndmask_b32 v137, v228, v17, s[4:5]
v_mfma_f32_16x16x32_bf16 a[56:59], a[196:199], v[180:183], a[56:59]
ds_read_b128 a[164:167], v2 offset:21504
v_cndmask_b32 v138, v228, v17, s[6:7]
v_mfma_f32_16x16x32_bf16 a[88:91], a[196:199], v[204:207], a[88:91]
ds_read_b128 a[168:171], v2 offset:22528
v_cndmask_b32 v139, v228, v17, s[8:9]
v_mfma_f32_16x16x32_bf16 a[88:91], a[192:195], v[200:203], a[88:91]
v_exp_f32 v135, v135
v_mfma_f32_16x16x32_bf16 a[120:123], a[192:195], v[208:211], a[120:123]
ds_read_b128 a[172:175], v2 offset:23552
v_cvt_pk_bf16_f32 v190, v132, v133
v_mfma_f32_16x16x32_bf16 a[120:123], a[196:199], v[212:215], a[120:123]
v_cndmask_b32 v140, v228, v17, s[10:11]
v_cvt_pk_bf16_f32 v191, v134, v135
v_mfma_f32_16x16x32_bf16 a[124:127], a[204:207], v[212:215], a[124:127]
v_cndmask_b32 v141, v228, v17, s[12:13]
v_cndmask_b32 v142, v228, v17, s[18:19]
v_mfma_f32_16x16x32_bf16 a[124:127], a[200:203], v[208:211], a[124:127]
v_cndmask_b32 v143, v228, v17, s[22:23]
v_cndmask_b32 v144, v228, v17, s[26:27]
v_mfma_f32_16x16x32_bf16 a[92:95], a[200:203], v[200:203], a[92:95]
v_cndmask_b32 v145, v228, v17, s[56:57]
v_cndmask_b32 v146, v228, v17, s[58:59]
v_mfma_f32_16x16x32_bf16 a[92:95], a[204:207], v[204:207], a[92:95]
v_cndmask_b32 v147, v228, v17, s[60:61]
v_cndmask_b32 v148, v228, v17, s[62:63]
v_mfma_f32_16x16x32_bf16 a[60:63], a[204:207], v[180:183], a[60:63]
v_cndmask_b32 v149, v228, v17, s[48:49]
v_cndmask_b32 v150, v228, v17, s[50:51]
v_mfma_f32_16x16x32_bf16 a[60:63], a[200:203], v[176:179], a[60:63]
s_waitcnt lgkmcnt(0)
v_cndmask_b32 v151, v228, v17, s[100:101]
v_accvgpr_read_b32 v21, a132
v_mfma_f32_16x16x32_bf16 v[136:139], a[144:147], v[72:75], v[136:139]
ds_read_b128 a[176:179], v2 offset:24576
v_accvgpr_read_b32 v248, a133
v_mfma_f32_16x16x32_bf16 v[136:139], a[148:151], v[76:79], v[136:139]
ds_read_b128 a[180:183], v2 offset:25600
v_add_f32 v21, v21, v248
v_mfma_f32_16x16x32_bf16 v[136:139], a[152:155], v[80:83], v[136:139]
ds_read_b128 a[184:187], v2 offset:26624
v_max_f32 v1, v1, v21
v_mfma_f32_16x16x32_bf16 v[136:139], a[156:159], v[84:87], v[136:139]
ds_read_b128 a[188:191], v2 offset:27648
ds_read_b128 a[192:195], v2 offset:28672
v_mfma_f32_16x16x32_bf16 v[140:143], a[172:175], v[84:87], v[140:143]
ds_read_b128 a[196:199], v2 offset:29696
ds_read_b128 a[200:203], v2 offset:30720
ds_read_b128 a[204:207], v2 offset:31744
v_mfma_f32_16x16x32_bf16 v[140:143], a[168:171], v[80:83], v[140:143]
v_rcp_f32 v21, v21
v_mfma_f32_16x16x32_bf16 v[140:143], a[164:167], v[76:79], v[140:143]
ds_read_b128 a[144:147], v3 offset:16384
v_accvgpr_read_b32 v232, a32
v_mfma_f32_16x16x32_bf16 v[140:143], a[160:163], v[72:75], v[140:143]
s_waitcnt lgkmcnt(7)
ds_read_b128 a[148:151], v3 offset:24576
v_accvgpr_read_b32 v233, a33
v_mfma_f32_16x16x32_bf16 v[144:147], a[176:179], v[72:75], v[144:147]
ds_read_b128 a[152:155], v3 offset:17408
v_accvgpr_read_b32 v234, a34
v_mfma_f32_16x16x32_bf16 v[144:147], a[180:183], v[76:79], v[144:147]
s_waitcnt lgkmcnt(6)
ds_read_b128 a[156:159], v3 offset:25600
v_accvgpr_read_b32 v235, a35
v_mfma_f32_16x16x32_bf16 v[144:147], a[184:187], v[80:83], v[144:147]
ds_read_b128 a[160:163], v3 offset:18432
v_accvgpr_read_b32 v236, a36
v_accvgpr_read_b32 v237, a37
v_accvgpr_read_b32 v238, a38
v_accvgpr_read_b32 v239, a39
v_mul_f32 v21, v21, v6
v_mul_f32 v232, v232, v21
v_mul_f32 v233, v233, v21
v_mul_f32 v234, v234, v21
v_mul_f32 v235, v235, v21
v_mul_f32 v236, v236, v21
v_mul_f32 v237, v237, v21
v_mul_f32 v238, v238, v21
v_mul_f32 v239, v239, v21
v_cvt_pk_bf16_f32 v232, v232, v233
v_cvt_pk_bf16_f32 v233, v234, v235
v_cvt_pk_bf16_f32 v234, v236, v237
v_cvt_pk_bf16_f32 v235, v238, v239
s_add_u32 s77, s74, 4096
buffer_store_dwordx4 v[232:235], v16, s[44:47], s77 offen sc1
v_accvgpr_read_b32 v240, a40
v_accvgpr_read_b32 v241, a41
v_accvgpr_read_b32 v242, a42
v_accvgpr_read_b32 v243, a43
v_accvgpr_read_b32 v244, a44
v_accvgpr_read_b32 v245, a45
v_accvgpr_read_b32 v246, a46
v_accvgpr_read_b32 v247, a47
v_mul_f32 v240, v240, v21
v_mul_f32 v241, v241, v21
v_mul_f32 v242, v242, v21
v_mul_f32 v243, v243, v21
v_mul_f32 v244, v244, v21
v_mul_f32 v245, v245, v21
v_mul_f32 v246, v246, v21
v_mul_f32 v247, v247, v21
v_cvt_pk_bf16_f32 v240, v240, v241
v_cvt_pk_bf16_f32 v241, v242, v243
v_cvt_pk_bf16_f32 v242, v244, v245
v_cvt_pk_bf16_f32 v243, v246, v247
s_add_u32 s77, s74, 12288
s_branch L_po29
L_pg29:
s_branch L_tr4
L_po29:
buffer_store_dwordx4 v[240:243], v16, s[44:47], s77 offen sc1
v_accvgpr_read_b32 v232, a48
v_accvgpr_read_b32 v233, a49
v_accvgpr_read_b32 v234, a50
v_accvgpr_read_b32 v235, a51
v_accvgpr_read_b32 v236, a52
v_accvgpr_read_b32 v237, a53
v_accvgpr_read_b32 v238, a54
v_accvgpr_read_b32 v239, a55
v_mul_f32 v232, v232, v21
v_mul_f32 v233, v233, v21
v_mul_f32 v234, v234, v21
v_mul_f32 v235, v235, v21
v_mul_f32 v236, v236, v21
v_mul_f32 v237, v237, v21
v_mul_f32 v238, v238, v21
v_mul_f32 v239, v239, v21
v_cvt_pk_bf16_f32 v232, v232, v233
v_cvt_pk_bf16_f32 v233, v234, v235
v_cvt_pk_bf16_f32 v234, v236, v237
v_cvt_pk_bf16_f32 v235, v238, v239
s_add_u32 s77, s74, 20480
buffer_store_dwordx4 v[232:235], v16, s[44:47], s77 offen sc1
v_accvgpr_read_b32 v240, a56
v_accvgpr_read_b32 v241, a57
v_accvgpr_read_b32 v242, a58
v_accvgpr_read_b32 v243, a59
v_accvgpr_read_b32 v244, a60
v_accvgpr_read_b32 v245, a61
v_accvgpr_read_b32 v246, a62
v_accvgpr_read_b32 v247, a63
v_mul_f32 v240, v240, v21
v_mul_f32 v241, v241, v21
v_mul_f32 v242, v242, v21
v_mul_f32 v243, v243, v21
v_mul_f32 v244, v244, v21
v_mul_f32 v245, v245, v21
v_mul_f32 v246, v246, v21
v_mul_f32 v247, v247, v21
v_cvt_pk_bf16_f32 v240, v240, v241
v_cvt_pk_bf16_f32 v241, v242, v243
v_cvt_pk_bf16_f32 v242, v244, v245
v_cvt_pk_bf16_f32 v243, v246, v247
s_add_u32 s77, s74, 28672
buffer_store_dwordx4 v[240:243], v16, s[44:47], s77 offen sc1
v_exp_f32 v136, v136
v_mfma_f32_16x16x32_bf16 v[144:147], a[188:191], v[84:87], v[144:147]
s_waitcnt lgkmcnt(5)
v_exp_f32 v137, v137
v_mfma_f32_16x16x32_bf16 v[148:151], a[204:207], v[84:87], v[148:151]
v_exp_f32 v138, v138
v_mfma_f32_16x16x32_bf16 v[148:151], a[200:203], v[80:83], v[148:151]
s_add_u32 s65, s84, 0
v_exp_f32 v139, v139
v_mfma_f32_16x16x32_bf16 v[148:151], a[196:199], v[76:79], v[148:151]
buffer_load_dwordx4 a[208:211], v14, s[44:47], s65 offen offset:0 sc1
v_mfma_f32_16x16x32_bf16 v[148:151], a[192:195], v[72:75], v[148:151]
ds_read_b128 a[164:167], v3 offset:26624
v_cvt_pk_bf16_f32 v208, v136, v137
v_smfmac_f32_16x16x64_bf16 a[136:139], a[240:243], v[184:191], v5
ds_read_b128 a[168:171], v3 offset:19456
v_smfmac_f32_16x16x64_bf16 a[140:143], a[240:243], v[192:199], v5
s_waitcnt lgkmcnt(2)
ds_read_b128 a[172:175], v3 offset:27648
v_mfma_f32_16x16x32_bf16 a[64:67], a[144:147], v[184:187], a[64:67]
v_exp_f32 v140, v140
v_mfma_f32_16x16x32_bf16 a[64:67], a[148:151], v[188:191], a[64:67]
buffer_load_dwordx4 a[216:219], v14, s[44:47], s65 offen offset:1024 sc1
v_mfma_f32_16x16x32_bf16 a[96:99], a[148:151], v[196:199], a[96:99]
v_exp_f32 v141, v141
v_mfma_f32_16x16x32_bf16 a[96:99], a[144:147], v[192:195], a[96:99]
buffer_load_dwordx4 a[224:227], v15, s[44:47], s65 offen offset:0 sc1
v_mfma_f32_16x16x32_bf16 a[100:103], a[152:155], v[192:195], a[100:103]
v_exp_f32 v142, v142
v_mfma_f32_16x16x32_bf16 a[100:103], a[156:159], v[196:199], a[100:103]
buffer_load_dwordx4 a[232:235], v15, s[44:47], s65 offen offset:1024 sc1
v_mfma_f32_16x16x32_bf16 a[68:71], a[156:159], v[188:191], a[68:71]
s_add_u32 s65, s84, 8192
ds_read_b128 a[176:179], v3 offset:20480
v_cvt_pk_bf16_f32 v209, v138, v139
v_mfma_f32_16x16x32_bf16 a[68:71], a[152:155], v[184:187], a[68:71]
buffer_load_dwordx4 a[212:215], v14, s[44:47], s65 offen offset:0 sc1
v_mfma_f32_16x16x32_bf16 a[72:75], a[160:163], v[184:187], a[72:75]
s_waitcnt lgkmcnt(1)
ds_read_b128 a[180:183], v3 offset:28672
v_cvt_pk_bf16_f32 v210, v140, v141
v_mfma_f32_16x16x32_bf16 a[72:75], a[164:167], v[188:191], a[72:75]
v_exp_f32 v143, v143
v_mfma_f32_16x16x32_bf16 a[104:107], a[164:167], v[196:199], a[104:107]
buffer_load_dwordx4 a[220:223], v14, s[44:47], s65 offen offset:1024 sc1
v_mfma_f32_16x16x32_bf16 a[104:107], a[160:163], v[192:195], a[104:107]
v_exp_f32 v144, v144
v_mfma_f32_16x16x32_bf16 a[108:111], a[168:171], v[192:195], a[108:111]
ds_read_b128 a[184:187], v3 offset:21504
v_xor_b32 v2, 0x8000, v2
v_mfma_f32_16x16x32_bf16 a[108:111], a[172:175], v[196:199], a[108:111]
buffer_load_dwordx4 a[228:231], v15, s[44:47], s65 offen offset:0 sc1
ds_read_b128 a[188:191], v3 offset:29696
v_mfma_f32_16x16x32_bf16 a[76:79], a[172:175], v[188:191], a[76:79]
v_exp_f32 v145, v145
v_mfma_f32_16x16x32_bf16 a[76:79], a[168:171], v[184:187], a[76:79]
s_waitcnt lgkmcnt(2)
buffer_load_dwordx4 a[236:239], v15, s[44:47], s65 offen offset:1024 sc1
v_mfma_f32_16x16x32_bf16 a[80:83], a[176:179], v[184:187], a[80:83]
s_add_u32 s65, s84, 32768
ds_read_b128 a[192:195], v3 offset:22528
v_cvt_pk_bf16_f32 v211, v142, v143
v_mfma_f32_16x16x32_bf16 a[80:83], a[180:183], v[188:191], a[80:83]
buffer_load_dwordx4 v[152:155], v14, s[44:47], s65 offen offset:0 sc1
ds_read_b128 a[196:199], v3 offset:30720
v_exp_f32 v146, v146
v_mfma_f32_16x16x32_bf16 a[112:115], a[180:183], v[196:199], a[112:115]
ds_read_b128 a[200:203], v3 offset:23552
ds_read_b128 a[204:207], v3 offset:31744
v_mfma_f32_16x16x32_bf16 a[112:115], a[176:179], v[192:195], a[112:115]
s_waitcnt vmcnt(13)
s_barrier
v_xor_b32 v3, 0x8000, v3
buffer_load_dwordx4 v[160:163], v14, s[44:47], s65 offen offset:1024 sc1
s_waitcnt lgkmcnt(4)
v_mfma_f32_16x16x32_bf16 a[116:119], a[184:187], v[192:195], a[116:119]
v_exp_f32 v147, v147
v_mfma_f32_16x16x32_bf16 a[116:119], a[188:191], v[196:199], a[116:119]
buffer_load_dwordx4 v[168:171], v15, s[44:47], s65 offen offset:0 sc1
v_mfma_f32_16x16x32_bf16 a[84:87], a[188:191], v[188:191], a[84:87]
v_exp_f32 v148, v148
v_mfma_f32_16x16x32_bf16 a[84:87], a[184:187], v[184:187], a[84:87]
s_waitcnt lgkmcnt(2)
buffer_load_dwordx4 v[176:179], v15, s[44:47], s65 offen offset:1024 sc1
v_cvt_pk_bf16_f32 v212, v144, v145
v_mfma_f32_16x16x32_bf16 a[88:91], a[192:195], v[184:187], a[88:91]
s_add_u32 s65, s84, 40960
v_exp_f32 v149, v149
v_mfma_f32_16x16x32_bf16 a[88:91], a[196:199], v[188:191], a[88:91]
buffer_load_dwordx4 v[156:159], v14, s[44:47], s65 offen offset:0 sc1
v_mfma_f32_16x16x32_bf16 a[120:123], a[196:199], v[196:199], a[120:123]
ds_read_b128 a[144:147], v3 offset:0
v_cvt_pk_bf16_f32 v213, v146, v147
v_mfma_f32_16x16x32_bf16 a[120:123], a[192:195], v[192:195], a[120:123]
s_waitcnt lgkmcnt(1)
buffer_load_dwordx4 v[164:167], v14, s[44:47], s65 offen offset:1024 sc1
ds_read_b128 a[148:151], v3 offset:8192
v_exp_f32 v150, v150
v_mfma_f32_16x16x32_bf16 a[124:127], a[200:203], v[192:195], a[124:127]
ds_read_b128 a[152:155], v3 offset:1024
v_cvt_pk_bf16_f32 v214, v148, v149
v_mfma_f32_16x16x32_bf16 a[124:127], a[204:207], v[196:199], a[124:127]
buffer_load_dwordx4 v[172:175], v15, s[44:47], s65 offen offset:0 sc1
ds_read_b128 a[156:159], v3 offset:9216
v_mfma_f32_16x16x32_bf16 a[92:95], a[204:207], v[188:191], a[92:95]
v_exp_f32 v151, v151
v_mfma_f32_16x16x32_bf16 a[92:95], a[200:203], v[184:187], a[92:95]
buffer_load_dwordx4 v[180:183], v15, s[44:47], s65 offen offset:1024 sc1
ds_read_b128 a[160:163], v3 offset:2048
ds_read_b128 a[164:167], v3 offset:10240
ds_read_b128 a[168:171], v3 offset:3072
ds_read_b128 a[172:175], v3 offset:11264
v_cvt_pk_bf16_f32 v215, v150, v151
v_accvgpr_read_b32 v22, a136
v_accvgpr_read_b32 v248, a137
v_add_f32 v22, v22, v248
v_max_f32 v1, v1, v22
v_rcp_f32 v22, v22
v_accvgpr_read_b32 v232, a64
v_accvgpr_read_b32 v233, a65
v_accvgpr_read_b32 v234, a66
v_accvgpr_read_b32 v235, a67
v_accvgpr_read_b32 v236, a68
v_accvgpr_read_b32 v237, a69
v_accvgpr_read_b32 v238, a70
v_accvgpr_read_b32 v239, a71
v_mul_f32 v22, v22, v8
v_mul_f32 v232, v232, v22
v_mul_f32 v233, v233, v22
v_mul_f32 v234, v234, v22
v_mul_f32 v235, v235, v22
v_mul_f32 v236, v236, v22
v_mul_f32 v237, v237, v22
v_mul_f32 v238, v238, v22
v_mul_f32 v239, v239, v22
v_cvt_pk_bf16_f32 v232, v232, v233
v_cvt_pk_bf16_f32 v233, v234, v235
v_cvt_pk_bf16_f32 v234, v236, v237
v_cvt_pk_bf16_f32 v235, v238, v239
s_add_u32 s77, s75, 0
buffer_store_dwordx4 v[232:235], v16, s[44:47], s77 offen sc1
s_branch L_TAIL
L_fallback_11:
s_waitcnt vmcnt(0) lgkmcnt(0)
s_barrier
s_mov_b32 s73, 1
s_mov_b32 s81, 0
v_and_b32 v232, 15, v0
v_lshrrev_b32 v233, 4, v0
v_lshlrev_b32 v233, 2, v233
v_sub_u32 v232, v232, v233
s_lshl_b32 s66, s30, 4
v_add_u32 v232, s66, v232
s_lshl_b32 s66, s16, 7
v_add_u32 v234, s66, v232
s_lshl_b32 s66, s3, 7
v_add_u32 v232, s66, v232
v_add_u32 v233, 64, v232
v_add_u32 v235, 64, v234
s_mov_b32 m0, s76
s_lshl_b32 s64, s30, 14
s_nop 0
buffer_load_dwordx4 v16, s[32:35], s64 offen offset:0 sc1 lds
s_nop 0
buffer_load_dwordx4 v16, s[32:35], s64 offen offset:1024 sc1 lds
s_nop 0
buffer_load_dwordx4 v16, s[32:35], s64 offen offset:2048 sc1 lds
s_nop 0
buffer_load_dwordx4 v16, s[32:35], s64 offen offset:3072 sc1 lds
s_add_u32 m0, s76, 4096
s_add_u32 s64, s64, 4096
s_nop 0
buffer_load_dwordx4 v16, s[32:35], s64 offen offset:0 sc1 lds
s_nop 0
buffer_load_dwordx4 v16, s[32:35], s64 offen offset:1024 sc1 lds
s_nop 0
buffer_load_dwordx4 v16, s[32:35], s64 offen offset:2048 sc1 lds
s_nop 0
buffer_load_dwordx4 v16, s[32:35], s64 offen offset:3072 sc1 lds
s_lshr_b32 s64, s76, 1
s_add_u32 m0, s64, 81920
s_and_b32 s71, s64, 8192
s_add_u32 s64, s64, s71
s_add_u32 s64, s64, 8192
s_nop 0
buffer_load_dwordx4 v16, s[32:35], s64 offen offset:0 sc1 lds
s_nop 0
buffer_load_dwordx4 v16, s[32:35], s64 offen offset:1024 sc1 lds
s_nop 0
buffer_load_dwordx4 v16, s[32:35], s64 offen offset:2048 sc1 lds
s_nop 0
buffer_load_dwordx4 v16, s[32:35], s64 offen offset:3072 sc1 lds
v_mov_b32 v20, 0xff800000
v_mov_b32 v21, 0xff800000
v_mov_b32 v22, 0xff800000
v_mov_b32 v23, 0xff800000
L_fbl_1015:
buffer_load_dwordx4 a[144:147], v16, s[32:35], s81 offen offset:0 sc1
buffer_load_dwordx4 a[148:151], v16, s[32:35], s81 offen offset:1024 sc1
buffer_load_dwordx4 a[152:155], v16, s[32:35], s81 offen offset:2048 sc1
buffer_load_dwordx4 a[156:159], v16, s[32:35], s81 offen offset:3072 sc1
s_add_u32 s64, s81, 4096
buffer_load_dwordx4 a[160:163], v16, s[32:35], s64 offen offset:0 sc1
buffer_load_dwordx4 a[164:167], v16, s[32:35], s64 offen offset:1024 sc1
buffer_load_dwordx4 a[168:171], v16, s[32:35], s64 offen offset:2048 sc1
buffer_load_dwordx4 a[172:175], v16, s[32:35], s64 offen offset:3072 sc1
v_subrev_u32 v88, 0, v232
v_ashrrev_i32 v88, 31, v88
v_and_b32 v88, 0xff800000, v88
v_subrev_u32 v89, 1, v232
v_ashrrev_i32 v89, 31, v89
v_and_b32 v89, 0xff800000, v89
v_subrev_u32 v90, 2, v232
v_ashrrev_i32 v90, 31, v90
v_and_b32 v90, 0xff800000, v90
v_subrev_u32 v91, 3, v232
v_ashrrev_i32 v91, 31, v91
v_and_b32 v91, 0xff800000, v91
v_subrev_u32 v92, 16, v232
v_ashrrev_i32 v92, 31, v92
v_and_b32 v92, 0xff800000, v92
v_subrev_u32 v93, 17, v232
v_ashrrev_i32 v93, 31, v93
v_and_b32 v93, 0xff800000, v93
v_subrev_u32 v94, 18, v232
v_ashrrev_i32 v94, 31, v94
v_and_b32 v94, 0xff800000, v94
v_subrev_u32 v95, 19, v232
v_ashrrev_i32 v95, 31, v95
v_and_b32 v95, 0xff800000, v95
v_subrev_u32 v232, 32, v232
v_subrev_u32 v104, 0, v233
v_ashrrev_i32 v104, 31, v104
v_and_b32 v104, 0xff800000, v104
v_subrev_u32 v105, 1, v233
v_ashrrev_i32 v105, 31, v105
v_and_b32 v105, 0xff800000, v105
v_subrev_u32 v106, 2, v233
v_ashrrev_i32 v106, 31, v106
v_and_b32 v106, 0xff800000, v106
v_subrev_u32 v107, 3, v233
v_ashrrev_i32 v107, 31, v107
v_and_b32 v107, 0xff800000, v107
v_subrev_u32 v108, 16, v233
v_ashrrev_i32 v108, 31, v108
v_and_b32 v108, 0xff800000, v108
v_subrev_u32 v109, 17, v233
v_ashrrev_i32 v109, 31, v109
v_and_b32 v109, 0xff800000, v109
v_subrev_u32 v110, 18, v233
v_ashrrev_i32 v110, 31, v110
v_and_b32 v110, 0xff800000, v110
v_subrev_u32 v111, 19, v233
v_ashrrev_i32 v111, 31, v111
v_and_b32 v111, 0xff800000, v111
v_subrev_u32 v233, 32, v233
v_subrev_u32 v120, 0, v234
v_ashrrev_i32 v120, 31, v120
v_and_b32 v120, 0xff800000, v120
v_subrev_u32 v121, 1, v234
v_ashrrev_i32 v121, 31, v121
v_and_b32 v121, 0xff800000, v121
v_subrev_u32 v122, 2, v234
v_ashrrev_i32 v122, 31, v122
v_and_b32 v122, 0xff800000, v122
v_subrev_u32 v123, 3, v234
v_ashrrev_i32 v123, 31, v123
v_and_b32 v123, 0xff800000, v123
v_subrev_u32 v124, 16, v234
v_ashrrev_i32 v124, 31, v124
v_and_b32 v124, 0xff800000, v124
v_subrev_u32 v125, 17, v234
v_ashrrev_i32 v125, 31, v125
v_and_b32 v125, 0xff800000, v125
v_subrev_u32 v126, 18, v234
v_ashrrev_i32 v126, 31, v126
v_and_b32 v126, 0xff800000, v126
v_subrev_u32 v127, 19, v234
v_ashrrev_i32 v127, 31, v127
v_and_b32 v127, 0xff800000, v127
v_subrev_u32 v234, 32, v234
v_subrev_u32 v136, 0, v235
v_ashrrev_i32 v136, 31, v136
v_and_b32 v136, 0xff800000, v136
v_subrev_u32 v137, 1, v235
v_ashrrev_i32 v137, 31, v137
v_and_b32 v137, 0xff800000, v137
v_subrev_u32 v138, 2, v235
v_ashrrev_i32 v138, 31, v138
v_and_b32 v138, 0xff800000, v138
v_subrev_u32 v139, 3, v235
v_ashrrev_i32 v139, 31, v139
v_and_b32 v139, 0xff800000, v139
v_subrev_u32 v140, 16, v235
v_ashrrev_i32 v140, 31, v140
v_and_b32 v140, 0xff800000, v140
v_subrev_u32 v141, 17, v235
v_ashrrev_i32 v141, 31, v141
v_and_b32 v141, 0xff800000, v141
v_subrev_u32 v142, 18, v235
v_ashrrev_i32 v142, 31, v142
v_and_b32 v142, 0xff800000, v142
v_subrev_u32 v143, 19, v235
v_ashrrev_i32 v143, 31, v143
v_and_b32 v143, 0xff800000, v143
v_subrev_u32 v235, 32, v235
s_waitcnt vmcnt(0)
v_mfma_f32_16x16x32_bf16 v[88:91], a[144:147], v[24:27], v[88:91]
v_mfma_f32_16x16x32_bf16 v[104:107], a[144:147], v[40:43], v[104:107]
v_mfma_f32_16x16x32_bf16 v[120:123], a[144:147], v[56:59], v[120:123]
v_mfma_f32_16x16x32_bf16 v[136:139], a[144:147], v[72:75], v[136:139]
v_mfma_f32_16x16x32_bf16 v[88:91], a[148:151], v[28:31], v[88:91]
v_mfma_f32_16x16x32_bf16 v[104:107], a[148:151], v[44:47], v[104:107]
v_mfma_f32_16x16x32_bf16 v[120:123], a[148:151], v[60:63], v[120:123]
v_mfma_f32_16x16x32_bf16 v[136:139], a[148:151], v[76:79], v[136:139]
v_mfma_f32_16x16x32_bf16 v[88:91], a[152:155], v[32:35], v[88:91]
v_mfma_f32_16x16x32_bf16 v[104:107], a[152:155], v[48:51], v[104:107]
v_mfma_f32_16x16x32_bf16 v[120:123], a[152:155], v[64:67], v[120:123]
v_mfma_f32_16x16x32_bf16 v[136:139], a[152:155], v[80:83], v[136:139]
v_mfma_f32_16x16x32_bf16 v[88:91], a[156:159], v[36:39], v[88:91]
v_mfma_f32_16x16x32_bf16 v[104:107], a[156:159], v[52:55], v[104:107]
v_mfma_f32_16x16x32_bf16 v[120:123], a[156:159], v[68:71], v[120:123]
v_mfma_f32_16x16x32_bf16 v[136:139], a[156:159], v[84:87], v[136:139]
v_mfma_f32_16x16x32_bf16 v[92:95], a[160:163], v[24:27], v[92:95]
v_mfma_f32_16x16x32_bf16 v[108:111], a[160:163], v[40:43], v[108:111]
v_mfma_f32_16x16x32_bf16 v[124:127], a[160:163], v[56:59], v[124:127]
v_mfma_f32_16x16x32_bf16 v[140:143], a[160:163], v[72:75], v[140:143]
v_mfma_f32_16x16x32_bf16 v[92:95], a[164:167], v[28:31], v[92:95]
v_mfma_f32_16x16x32_bf16 v[108:111], a[164:167], v[44:47], v[108:111]
v_mfma_f32_16x16x32_bf16 v[124:127], a[164:167], v[60:63], v[124:127]
v_mfma_f32_16x16x32_bf16 v[140:143], a[164:167], v[76:79], v[140:143]
v_mfma_f32_16x16x32_bf16 v[92:95], a[168:171], v[32:35], v[92:95]
v_mfma_f32_16x16x32_bf16 v[108:111], a[168:171], v[48:51], v[108:111]
v_mfma_f32_16x16x32_bf16 v[124:127], a[168:171], v[64:67], v[124:127]
v_mfma_f32_16x16x32_bf16 v[140:143], a[168:171], v[80:83], v[140:143]
v_mfma_f32_16x16x32_bf16 v[92:95], a[172:175], v[36:39], v[92:95]
v_mfma_f32_16x16x32_bf16 v[108:111], a[172:175], v[52:55], v[108:111]
v_mfma_f32_16x16x32_bf16 v[124:127], a[172:175], v[68:71], v[124:127]
v_mfma_f32_16x16x32_bf16 v[140:143], a[172:175], v[84:87], v[140:143]
s_nop 7
v_max3_f32 v20, v20, v88, v89
v_max3_f32 v20, v20, v90, v91
v_max3_f32 v20, v20, v92, v93
v_max3_f32 v20, v20, v94, v95
v_max3_f32 v21, v21, v104, v105
v_max3_f32 v21, v21, v106, v107
v_max3_f32 v21, v21, v108, v109
v_max3_f32 v21, v21, v110, v111
v_max3_f32 v22, v22, v120, v121
v_max3_f32 v22, v22, v122, v123
v_max3_f32 v22, v22, v124, v125
v_max3_f32 v22, v22, v126, v127
v_max3_f32 v23, v23, v136, v137
v_max3_f32 v23, v23, v138, v139
v_max3_f32 v23, v23, v140, v141
v_max3_f32 v23, v23, v142, v143
s_add_u32 s81, s81, 16384
s_cmp_lt_u32 s81, s34
s_cbranch_scc1 L_fbl_1015
v_mov_b32 v248, v20
v_mov_b32 v249, v21
v_mov_b32 v250, v22
v_mov_b32 v251, v23
v_permlane16_swap_b32 v248, v20
v_permlane16_swap_b32 v249, v21
v_permlane16_swap_b32 v250, v22
v_permlane16_swap_b32 v251, v23
v_max_f32 v20, v20, v248
v_max_f32 v21, v21, v249
v_max_f32 v22, v22, v250
v_max_f32 v23, v23, v251
v_mov_b32 v248, v20
v_mov_b32 v249, v21
v_mov_b32 v250, v22
v_mov_b32 v251, v23
v_permlane32_swap_b32 v248, v20
v_permlane32_swap_b32 v249, v21
v_permlane32_swap_b32 v250, v22
v_permlane32_swap_b32 v251, v23
v_max_f32 v20, v20, v248
v_max_f32 v21, v21, v249
v_max_f32 v22, v22, v250
v_max_f32 v23, v23, v251
v_mov_b32 v252, v20
v_mov_b32 v253, v21
v_mov_b32 v254, v22
v_mov_b32 v255, v23
s_and_b32 s70, s30, 1
s_lshr_b32 s67, s30, 1
s_lshl3_add_u32 s71, s67, s70
s_add_u32 s71, s71, 4
s_lshl_b32 s71, s71, 13
s_lshl_b32 s70, s70, 14
s_mul_i32 s67, s67, 24576
s_sub_u32 s70, s70, s67
s_add_u32 s70, s70, 65536
v_mov_b32 v2, v16
v_add_u32 v3, 0x10000, v16
v_mov_b32 v1, 0
s_mov_b32 m0, s71
s_waitcnt lgkmcnt(0)
s_barrier
ds_read_b128 a[144:147], v2 offset:0
ds_read_b128 a[148:151], v2 offset:1024
ds_read_b128 a[152:155], v2 offset:2048
ds_read_b128 a[156:159], v2 offset:3072
ds_read_b128 a[160:163], v2 offset:4096
ds_read_b128 a[164:167], v2 offset:5120
ds_read_b128 a[168:171], v2 offset:6144
ds_read_b128 a[172:175], v2 offset:7168
buffer_load_dwordx4 v16, s[32:35], s70 offen offset:0 sc1 lds
buffer_load_dwordx4 v16, s[32:35], s70 offen offset:1024 sc1 lds
s_waitcnt vmcnt(0) lgkmcnt(0)
s_branch L_attstart_7
L_spin_2016:
s_mov_b32 vcc_hi, 0x80000
L_spinlp_2018:
s_sleep 1
buffer_load_dword v19, off, s[52:55], s72 offset:0 sc1
s_waitcnt vmcnt(0)
v_readfirstlane_b32 vcc_lo, v19
s_sub_u32 vcc_hi, vcc_hi, 1
s_cbranch_scc1 L_spinbk_2017
s_cmp_lt_u32 vcc_lo, 8
s_cbranch_scc1 L_spinlp_2018
s_branch L_spinbk_2017
L_spin_3019:
s_mov_b32 vcc_hi, 0x80000
L_spinlp_3021:
s_sleep 1
buffer_load_dword v19, off, s[52:55], s72 offset:0 sc1
s_waitcnt vmcnt(0)
v_readfirstlane_b32 vcc_lo, v19
s_sub_u32 vcc_hi, vcc_hi, 1
s_cbranch_scc1 L_spinbk_3020
s_cmp_lt_u32 vcc_lo, 8
s_cbranch_scc1 L_spinlp_3021
s_branch L_spinbk_3020
.p2align 12
L_pg30:
s_branch L_tr2
L_p5f0:
s_waitcnt lgkmcnt(10)
s_waitcnt vmcnt(28)
v_mfma_f32_16x16x32_bf16 v[136:139], a[144:147], a[232:235], 0
s_waitcnt vmcnt(24)
s_waitcnt lgkmcnt(8)
s_add_u32 m0, s86, 65536
ds_read_b64_tr_b16 a[168:169], v191 offset:32768
v_xor_b32 v192, 0x10000, v184
v_mfma_f32_16x16x32_bf16 v[136:139], a[148:151], a[236:239], v[136:139]
s_add_u32 s64, s85, 524288
ds_read_b64_tr_b16 a[170:171], v191 offset:36864
v_xor_b32 v193, 0x10000, v185
v_mfma_f32_16x16x32_bf16 v[104:107], a[148:151], a[228:231], 0
buffer_load_dwordx4 v12, s[36:39], s64 offen lds
v_mfma_f32_16x16x32_bf16 v[104:107], a[144:147], a[224:227], v[104:107]
s_add_u32 m0, s86, 66560
s_add_u32 s64, s85, 532480
ds_read_b64_tr_b16 a[172:173], v191 offset:40960
v_xor_b32 v194, 0x10000, v186
v_mfma_f32_16x16x32_bf16 v[72:75], a[144:147], a[216:219], 0
buffer_load_dwordx4 v13, s[36:39], s64 offen lds
v_mfma_f32_16x16x32_bf16 v[72:75], a[148:151], a[220:223], v[72:75]
s_add_u32 m0, s86, 67584
ds_read_b64_tr_b16 a[174:175], v191 offset:45056
v_xor_b32 v195, 0x10000, v187
v_mfma_f32_16x16x32_bf16 v[40:43], a[148:151], a[212:215], 0
s_add_u32 s64, s85, 540672
ds_read_b64_tr_b16 a[176:177], v184 offset:32768
v_xor_b32 v196, 0x10000, v188
v_mfma_f32_16x16x32_bf16 v[40:43], a[144:147], a[208:211], v[40:43]
s_waitcnt lgkmcnt(5)
buffer_load_dwordx4 v12, s[36:39], s64 offen lds
v_mfma_f32_16x16x32_bf16 v[44:47], a[152:155], a[208:211], 0
s_add_u32 m0, s86, 68608
s_add_u32 s64, s85, 548864
ds_read_b64_tr_b16 a[178:179], v184 offset:36864
v_xor_b32 v197, 0x10000, v189
v_mfma_f32_16x16x32_bf16 v[44:47], a[156:159], a[212:215], v[44:47]
buffer_load_dwordx4 v13, s[36:39], s64 offen lds
v_mfma_f32_16x16x32_bf16 v[76:79], a[156:159], a[220:223], 0
s_add_u32 m0, s86, 69632
ds_read_b64_tr_b16 a[180:181], v184 offset:40960
v_xor_b32 v198, 0x10000, v190
v_mfma_f32_16x16x32_bf16 v[76:79], a[152:155], a[216:219], v[76:79]
s_add_u32 s64, s85, 557056
ds_read_b64_tr_b16 a[182:183], v184 offset:45056
v_xor_b32 v199, 0x10000, v191
v_mfma_f32_16x16x32_bf16 v[108:111], a[152:155], a[224:227], 0
buffer_load_dwordx4 v12, s[36:39], s64 offen lds
v_mfma_f32_16x16x32_bf16 v[108:111], a[156:159], a[228:231], v[108:111]
s_add_u32 m0, s86, 70656
s_add_u32 s64, s85, 565248
ds_read_b64_tr_b16 a[184:185], v185 offset:32768
v_mfma_f32_16x16x32_bf16 v[140:143], a[156:159], a[236:239], 0
buffer_load_dwordx4 v13, s[36:39], s64 offen lds
v_mfma_f32_16x16x32_bf16 v[140:143], a[152:155], a[232:235], v[140:143]
s_add_u32 m0, s86, 71680
ds_read_b64_tr_b16 a[186:187], v185 offset:36864
v_mfma_f32_16x16x32_bf16 v[144:147], a[160:163], a[232:235], 0
s_add_u32 s64, s85, 573440
ds_read_b64_tr_b16 a[188:189], v185 offset:40960
v_mfma_f32_16x16x32_bf16 v[144:147], a[164:167], a[236:239], v[144:147]
buffer_load_dwordx4 v12, s[36:39], s64 offen lds
v_mfma_f32_16x16x32_bf16 v[112:115], a[164:167], a[228:231], 0
s_and_b32 s71, s31, 4
s_lshl_b32 s71, s71, 5
s_add_u32 m0, s86, 72704
s_add_u32 s64, s85, 581632
ds_read_b64_tr_b16 a[190:191], v185 offset:45056
v_mfma_f32_16x16x32_bf16 v[112:115], a[160:163], a[224:227], v[112:115]
s_add_u32 s71, s71, s79
buffer_load_dwordx4 v13, s[36:39], s64 offen lds
v_mfma_f32_16x16x32_bf16 v[80:83], a[160:163], a[216:219], 0
s_add_u32 s71, s71, 4096
s_add_u32 s72, s80, 4096
ds_read_b64_tr_b16 a[192:193], v186 offset:32768
v_mfma_f32_16x16x32_bf16 v[80:83], a[164:167], a[220:223], v[80:83]
s_add_u32 s65, s84, 65536
ds_read_b64_tr_b16 a[194:195], v186 offset:36864
v_mfma_f32_16x16x32_bf16 v[48:51], a[164:167], a[212:215], 0
buffer_load_dwordx4 a[0:3], v14, s[44:47], s65 offen offset:0 sc1
v_mfma_f32_16x16x32_bf16 v[48:51], a[160:163], a[208:211], v[48:51]
s_waitcnt lgkmcnt(4)
ds_read_b64_tr_b16 a[196:197], v186 offset:40960
v_mfma_f32_16x16x32_bf16 v[52:55], a[168:171], a[208:211], 0
buffer_load_dwordx4 a[8:11], v14, s[44:47], s65 offen offset:1024 sc1
v_mfma_f32_16x16x32_bf16 v[52:55], a[172:175], a[212:215], v[52:55]
ds_read_b64_tr_b16 a[198:199], v186 offset:45056
v_mfma_f32_16x16x32_bf16 v[84:87], a[172:175], a[220:223], 0
ds_read_b64_tr_b16 a[200:201], v187 offset:32768
v_mfma_f32_16x16x32_bf16 v[84:87], a[168:171], a[216:219], v[84:87]
buffer_load_dwordx4 a[16:19], v15, s[44:47], s65 offen offset:0 sc1
v_mfma_f32_16x16x32_bf16 v[116:119], a[168:171], a[224:227], 0
ds_read_b64_tr_b16 a[202:203], v187 offset:36864
v_mfma_f32_16x16x32_bf16 v[116:119], a[172:175], a[228:231], v[116:119]
buffer_load_dwordx4 a[24:27], v15, s[44:47], s65 offen offset:1024 sc1
v_mfma_f32_16x16x32_bf16 v[148:151], a[172:175], a[236:239], 0
ds_read_b64_tr_b16 a[204:205], v187 offset:40960
v_mfma_f32_16x16x32_bf16 v[148:151], a[168:171], a[232:235], v[148:151]
s_add_u32 s65, s84, 73728
ds_read_b64_tr_b16 a[206:207], v187 offset:45056
v_mfma_f32_16x16x32_bf16 v[120:123], a[176:179], a[232:235], 0
buffer_load_dwordx4 a[4:7], v14, s[44:47], s65 offen offset:0 sc1
v_mfma_f32_16x16x32_bf16 v[120:123], a[180:183], a[236:239], v[120:123]
v_mfma_f32_16x16x32_bf16 v[88:91], a[180:183], a[228:231], 0
buffer_load_dwordx4 a[12:15], v14, s[44:47], s65 offen offset:1024 sc1
v_mfma_f32_16x16x32_bf16 v[88:91], a[176:179], a[224:227], v[88:91]
v_mfma_f32_16x16x32_bf16 v[56:59], a[176:179], a[216:219], 0
v_mfma_f32_16x16x32_bf16 v[56:59], a[180:183], a[220:223], v[56:59]
buffer_load_dwordx4 a[20:23], v15, s[44:47], s65 offen offset:0 sc1
v_mfma_f32_16x16x32_bf16 v[24:27], a[180:183], a[212:215], 0
v_mfma_f32_16x16x32_bf16 v[24:27], a[176:179], a[208:211], v[24:27]
buffer_load_dwordx4 a[28:31], v15, s[44:47], s65 offen offset:1024 sc1
v_mfma_f32_16x16x32_bf16 v[28:31], a[184:187], a[208:211], 0
s_waitcnt lgkmcnt(0)
v_mfma_f32_16x16x32_bf16 v[28:31], a[188:191], a[212:215], v[28:31]
v_mfma_f32_16x16x32_bf16 v[60:63], a[188:191], a[220:223], 0
v_mfma_f32_16x16x32_bf16 v[60:63], a[184:187], a[216:219], v[60:63]
s_waitcnt vmcnt(23)
s_barrier
v_mfma_f32_16x16x32_bf16 v[92:95], a[184:187], a[224:227], 0
ds_read_b64_tr_b16 a[144:145], v196 offset:0
v_mfma_f32_16x16x32_bf16 v[92:95], a[188:191], a[228:231], v[92:95]
ds_read_b64_tr_b16 a[146:147], v196 offset:4096
v_mfma_f32_16x16x32_bf16 v[124:127], a[188:191], a[236:239], 0
s_add_u32 m0, s86, 0
ds_read_b64_tr_b16 a[148:149], v196 offset:8192
v_mfma_f32_16x16x32_bf16 v[124:127], a[184:187], a[232:235], v[124:127]
s_add_u32 s64, s85, 786432
ds_read_b64_tr_b16 a[150:151], v196 offset:12288
v_mfma_f32_16x16x32_bf16 v[128:131], a[192:195], a[232:235], 0
buffer_load_dwordx4 v12, s[36:39], s64 offen lds
v_mfma_f32_16x16x32_bf16 v[128:131], a[196:199], a[236:239], v[128:131]
s_add_u32 m0, s86, 1024
ds_read_b64_tr_b16 a[152:153], v197 offset:0
v_mfma_f32_16x16x32_bf16 v[96:99], a[196:199], a[228:231], 0
s_add_u32 s64, s85, 794624
ds_read_b64_tr_b16 a[154:155], v197 offset:4096
v_mfma_f32_16x16x32_bf16 v[96:99], a[192:195], a[224:227], v[96:99]
buffer_load_dwordx4 v13, s[36:39], s64 offen lds
v_mfma_f32_16x16x32_bf16 v[64:67], a[192:195], a[216:219], 0
s_add_u32 m0, s86, 2048
ds_read_b64_tr_b16 a[156:157], v197 offset:8192
v_mfma_f32_16x16x32_bf16 v[64:67], a[196:199], a[220:223], v[64:67]
s_add_u32 s64, s85, 802816
ds_read_b64_tr_b16 a[158:159], v197 offset:12288
v_mfma_f32_16x16x32_bf16 v[32:35], a[196:199], a[212:215], 0
buffer_load_dwordx4 v12, s[36:39], s64 offen lds
v_mfma_f32_16x16x32_bf16 v[32:35], a[192:195], a[208:211], v[32:35]
s_add_u32 m0, s86, 3072
ds_read_b64_tr_b16 a[160:161], v198 offset:0
v_mfma_f32_16x16x32_bf16 v[36:39], a[200:203], a[208:211], 0
s_add_u32 s64, s85, 811008
ds_read_b64_tr_b16 a[162:163], v198 offset:4096
v_mfma_f32_16x16x32_bf16 v[36:39], a[204:207], a[212:215], v[36:39]
buffer_load_dwordx4 v13, s[36:39], s64 offen lds
v_mfma_f32_16x16x32_bf16 v[68:71], a[204:207], a[220:223], 0
s_add_u32 m0, s86, 4096
ds_read_b64_tr_b16 a[164:165], v198 offset:8192
v_mfma_f32_16x16x32_bf16 v[68:71], a[200:203], a[216:219], v[68:71]
s_add_u32 s64, s85, 819200
ds_read_b64_tr_b16 a[166:167], v198 offset:12288
v_mfma_f32_16x16x32_bf16 v[100:103], a[200:203], a[224:227], 0
buffer_load_dwordx4 v12, s[36:39], s64 offen lds
v_mfma_f32_16x16x32_bf16 v[100:103], a[204:207], a[228:231], v[100:103]
v_mfma_f32_16x16x32_bf16 v[132:135], a[204:207], a[236:239], 0
v_mfma_f32_16x16x32_bf16 v[132:135], a[200:203], a[232:235], v[132:135]
s_waitcnt lgkmcnt(3)
v_mfma_f32_16x16x32_bf16 v[136:139], a[144:147], v[176:179], v[136:139]
s_add_u32 m0, s86, 5120
ds_read_b64_tr_b16 a[168:169], v199 offset:0
v_xor_b32 v200, 0x18000, v184
v_mfma_f32_16x16x32_bf16 v[136:139], a[148:151], v[180:183], v[136:139]
s_add_u32 s64, s85, 827392
ds_read_b64_tr_b16 a[170:171], v199 offset:4096
v_xor_b32 v201, 0x18000, v185
v_mfma_f32_16x16x32_bf16 v[104:107], a[148:151], v[172:175], v[104:107]
buffer_load_dwordx4 v13, s[36:39], s64 offen lds
v_mfma_f32_16x16x32_bf16 v[104:107], a[144:147], v[168:171], v[104:107]
s_add_u32 m0, s86, 6144
ds_read_b64_tr_b16 a[172:173], v199 offset:8192
v_xor_b32 v202, 0x18000, v186
v_mfma_f32_16x16x32_bf16 v[72:75], a[144:147], v[160:163], v[72:75]
s_add_u32 s64, s85, 835584
ds_read_b64_tr_b16 a[174:175], v199 offset:12288
v_xor_b32 v203, 0x18000, v187
v_mfma_f32_16x16x32_bf16 v[72:75], a[148:151], v[164:167], v[72:75]
buffer_load_dwordx4 v12, s[36:39], s64 offen lds
v_mfma_f32_16x16x32_bf16 v[40:43], a[148:151], v[156:159], v[40:43]
ds_read_b64_tr_b16 a[176:177], v192 offset:0
v_xor_b32 v204, 0x18000, v188
v_mfma_f32_16x16x32_bf16 v[40:43], a[144:147], v[152:155], v[40:43]
s_add_u32 m0, s86, 7168
ds_read_b64_tr_b16 a[178:179], v192 offset:4096
v_xor_b32 v205, 0x18000, v189
v_mfma_f32_16x16x32_bf16 v[44:47], a[152:155], v[152:155], v[44:47]
s_add_u32 s64, s85, 843776
ds_read_b64_tr_b16 a[180:181], v192 offset:8192
v_xor_b32 v206, 0x18000, v190
v_mfma_f32_16x16x32_bf16 v[44:47], a[156:159], v[156:159], v[44:47]
buffer_load_dwordx4 v13, s[36:39], s64 offen lds
v_mfma_f32_16x16x32_bf16 v[76:79], a[156:159], v[164:167], v[76:79]
ds_read_b64_tr_b16 a[182:183], v192 offset:12288
v_xor_b32 v207, 0x18000, v191
v_mfma_f32_16x16x32_bf16 v[76:79], a[152:155], v[160:163], v[76:79]
s_add_u32 s65, s84, 98304
ds_read_b64_tr_b16 a[184:185], v193 offset:0
v_mfma_f32_16x16x32_bf16 v[108:111], a[152:155], v[168:171], v[108:111]
buffer_load_dwordx4 a[64:67], v14, s[44:47], s65 offen offset:0 sc1
v_mfma_f32_16x16x32_bf16 v[108:111], a[156:159], v[172:175], v[108:111]
ds_read_b64_tr_b16 a[186:187], v193 offset:4096
v_mfma_f32_16x16x32_bf16 v[140:143], a[156:159], v[180:183], v[140:143]
ds_read_b64_tr_b16 a[188:189], v193 offset:8192
v_mfma_f32_16x16x32_bf16 v[140:143], a[152:155], v[176:179], v[140:143]
s_waitcnt lgkmcnt(5)
ds_read_b64_tr_b16 a[190:191], v193 offset:12288
v_mfma_f32_16x16x32_bf16 v[144:147], a[160:163], v[176:179], v[144:147]
buffer_load_dwordx4 a[72:75], v14, s[44:47], s65 offen offset:1024 sc1
v_mfma_f32_16x16x32_bf16 v[144:147], a[164:167], v[180:183], v[144:147]
v_mfma_f32_16x16x32_bf16 v[112:115], a[164:167], v[172:175], v[112:115]
ds_read_b64_tr_b16 a[192:193], v194 offset:0
v_mfma_f32_16x16x32_bf16 v[112:115], a[160:163], v[168:171], v[112:115]
ds_read_b64_tr_b16 a[194:195], v194 offset:4096
v_mfma_f32_16x16x32_bf16 v[80:83], a[160:163], v[160:163], v[80:83]
buffer_load_dwordx4 a[80:83], v15, s[44:47], s65 offen offset:0 sc1
v_mfma_f32_16x16x32_bf16 v[80:83], a[164:167], v[164:167], v[80:83]
ds_read_b64_tr_b16 a[196:197], v194 offset:8192
v_mfma_f32_16x16x32_bf16 v[48:51], a[164:167], v[156:159], v[48:51]
ds_read_b64_tr_b16 a[198:199], v194 offset:12288
v_mfma_f32_16x16x32_bf16 v[48:51], a[160:163], v[152:155], v[48:51]
buffer_load_dwordx4 a[88:91], v15, s[44:47], s65 offen offset:1024 sc1
v_mfma_f32_16x16x32_bf16 v[52:55], a[168:171], v[152:155], v[52:55]
v_mfma_f32_16x16x32_bf16 v[52:55], a[172:175], v[156:159], v[52:55]
v_mfma_f32_16x16x32_bf16 v[84:87], a[172:175], v[164:167], v[84:87]
s_add_u32 s65, s84, 106496
ds_read_b64_tr_b16 a[200:201], v195 offset:0
v_mfma_f32_16x16x32_bf16 v[84:87], a[168:171], v[160:163], v[84:87]
buffer_load_dwordx4 a[68:71], v14, s[44:47], s65 offen offset:0 sc1
v_mfma_f32_16x16x32_bf16 v[116:119], a[168:171], v[168:171], v[116:119]
ds_read_b64_tr_b16 a[202:203], v195 offset:4096
v_mfma_f32_16x16x32_bf16 v[116:119], a[172:175], v[172:175], v[116:119]
ds_read_b64_tr_b16 a[204:205], v195 offset:8192
v_mfma_f32_16x16x32_bf16 v[148:151], a[172:175], v[180:183], v[148:151]
ds_read_b64_tr_b16 a[206:207], v195 offset:12288
v_mfma_f32_16x16x32_bf16 v[148:151], a[168:171], v[176:179], v[148:151]
s_lshl_b32 s66, s30, 30
buffer_load_dwordx4 a[76:79], v14, s[44:47], s65 offen offset:1024 sc1
v_mfma_f32_16x16x32_bf16 v[120:123], a[176:179], v[176:179], v[120:123]
s_waitcnt lgkmcnt(4)
v_lshl_add_u32 v1, v0, 24, s66
v_mfma_f32_16x16x32_bf16 v[120:123], a[180:183], v[180:183], v[120:123]
v_mfma_f32_16x16x32_bf16 v[88:91], a[180:183], v[172:175], v[88:91]
buffer_load_dwordx4 a[84:87], v15, s[44:47], s65 offen offset:0 sc1
v_mfma_f32_16x16x32_bf16 v[88:91], a[176:179], v[168:171], v[88:91]
v_mfma_f32_16x16x32_bf16 v[56:59], a[176:179], v[160:163], v[56:59]
v_mfma_f32_16x16x32_bf16 v[56:59], a[180:183], v[164:167], v[56:59]
v_mfma_f32_16x16x32_bf16 v[24:27], a[180:183], v[156:159], v[24:27]
buffer_load_dwordx4 a[92:95], v15, s[44:47], s65 offen offset:1024 sc1
v_mfma_f32_16x16x32_bf16 v[24:27], a[176:179], v[152:155], v[24:27]
v_mfma_f32_16x16x32_bf16 v[28:31], a[184:187], v[152:155], v[28:31]
v_mfma_f32_16x16x32_bf16 v[28:31], a[188:191], v[156:159], v[28:31]
v_mfma_f32_16x16x32_bf16 v[60:63], a[188:191], v[164:167], v[60:63]
v_mfma_f32_16x16x32_bf16 v[60:63], a[184:187], v[160:163], v[60:63]
s_waitcnt vmcnt(24)
s_barrier
v_mfma_f32_16x16x32_bf16 v[92:95], a[184:187], v[168:171], v[92:95]
s_mov_b64 exec, 1
buffer_atomic_add a251, v1, s[52:55], s71 offen offset:0 sc1
s_mov_b64 exec, -1
v_mfma_f32_16x16x32_bf16 v[92:95], a[188:191], v[172:175], v[92:95]
ds_read_b64_tr_b16 a[144:145], v196 offset:32768
v_mfma_f32_16x16x32_bf16 v[124:127], a[188:191], v[180:183], v[124:127]
s_add_u32 m0, s86, 98304
ds_read_b64_tr_b16 a[146:147], v196 offset:36864
v_mfma_f32_16x16x32_bf16 v[124:127], a[184:187], v[176:179], v[124:127]
s_add_u32 s64, s85, 1048576
ds_read_b64_tr_b16 a[148:149], v196 offset:40960
v_mfma_f32_16x16x32_bf16 v[128:131], a[192:195], v[176:179], v[128:131]
buffer_load_dwordx4 v12, s[36:39], s64 offen lds
v_mfma_f32_16x16x32_bf16 v[128:131], a[196:199], v[180:183], v[128:131]
s_add_u32 m0, s86, 99328
ds_read_b64_tr_b16 a[150:151], v196 offset:45056
v_mfma_f32_16x16x32_bf16 v[96:99], a[196:199], v[172:175], v[96:99]
s_add_u32 s64, s85, 1056768
ds_read_b64_tr_b16 a[152:153], v197 offset:32768
v_mfma_f32_16x16x32_bf16 v[96:99], a[192:195], v[168:171], v[96:99]
buffer_load_dwordx4 v13, s[36:39], s64 offen lds
v_mfma_f32_16x16x32_bf16 v[64:67], a[192:195], v[160:163], v[64:67]
s_add_u32 m0, s86, 100352
ds_read_b64_tr_b16 a[154:155], v197 offset:36864
v_mfma_f32_16x16x32_bf16 v[64:67], a[196:199], v[164:167], v[64:67]
s_add_u32 s64, s85, 1064960
ds_read_b64_tr_b16 a[156:157], v197 offset:40960
v_mfma_f32_16x16x32_bf16 v[32:35], a[196:199], v[156:159], v[32:35]
buffer_load_dwordx4 v12, s[36:39], s64 offen lds
v_mfma_f32_16x16x32_bf16 v[32:35], a[192:195], v[152:155], v[32:35]
s_waitcnt lgkmcnt(4)
s_add_u32 m0, s86, 101376
ds_read_b64_tr_b16 a[158:159], v197 offset:45056
v_mfma_f32_16x16x32_bf16 v[36:39], a[200:203], v[152:155], v[36:39]
s_add_u32 s64, s85, 1073152
ds_read_b64_tr_b16 a[160:161], v198 offset:32768
v_mfma_f32_16x16x32_bf16 v[36:39], a[204:207], v[156:159], v[36:39]
buffer_load_dwordx4 v13, s[36:39], s64 offen lds
v_mfma_f32_16x16x32_bf16 v[68:71], a[204:207], v[164:167], v[68:71]
s_add_u32 m0, s86, 102400
ds_read_b64_tr_b16 a[162:163], v198 offset:36864
v_mfma_f32_16x16x32_bf16 v[68:71], a[200:203], v[160:163], v[68:71]
s_add_u32 s64, s85, 1081344
ds_read_b64_tr_b16 a[164:165], v198 offset:40960
v_mfma_f32_16x16x32_bf16 v[100:103], a[200:203], v[168:171], v[100:103]
buffer_load_dwordx4 v12, s[36:39], s64 offen lds
v_mfma_f32_16x16x32_bf16 v[100:103], a[204:207], v[172:175], v[100:103]
ds_read_b64_tr_b16 a[166:167], v198 offset:45056
v_mfma_f32_16x16x32_bf16 v[132:135], a[204:207], v[180:183], v[132:135]
v_mfma_f32_16x16x32_bf16 v[132:135], a[200:203], v[176:179], v[132:135]
s_waitcnt vmcnt(26)
v_mfma_f32_16x16x32_bf16 v[136:139], a[144:147], a[24:27], v[136:139]
s_waitcnt vmcnt(22)
s_waitcnt lgkmcnt(3)
s_add_u32 m0, s86, 103424
ds_read_b64_tr_b16 a[168:169], v199 offset:32768
v_mfma_f32_16x16x32_bf16 v[136:139], a[148:151], a[28:31], v[136:139]
s_add_u32 s64, s85, 1089536
ds_read_b64_tr_b16 a[170:171], v199 offset:36864
v_mfma_f32_16x16x32_bf16 v[104:107], a[148:151], a[20:23], v[104:107]
buffer_load_dwordx4 v13, s[36:39], s64 offen lds
v_mfma_f32_16x16x32_bf16 v[104:107], a[144:147], a[16:19], v[104:107]
s_add_u32 m0, s86, 104448
ds_read_b64_tr_b16 a[172:173], v199 offset:40960
v_mfma_f32_16x16x32_bf16 v[72:75], a[144:147], a[8:11], v[72:75]
s_add_u32 s64, s85, 1097728
ds_read_b64_tr_b16 a[174:175], v199 offset:45056
v_mfma_f32_16x16x32_bf16 v[72:75], a[148:151], a[12:15], v[72:75]
buffer_load_dwordx4 v12, s[36:39], s64 offen lds
v_mfma_f32_16x16x32_bf16 v[40:43], a[148:151], a[4:7], v[40:43]
ds_read_b64_tr_b16 a[176:177], v192 offset:32768
v_mfma_f32_16x16x32_bf16 v[40:43], a[144:147], a[0:3], v[40:43]
s_add_u32 m0, s86, 105472
ds_read_b64_tr_b16 a[178:179], v192 offset:36864
v_mfma_f32_16x16x32_bf16 v[44:47], a[152:155], a[0:3], v[44:47]
s_add_u32 s64, s85, 1105920
ds_read_b64_tr_b16 a[180:181], v192 offset:40960
v_mfma_f32_16x16x32_bf16 v[44:47], a[156:159], a[4:7], v[44:47]
buffer_load_dwordx4 v13, s[36:39], s64 offen lds
v_mfma_f32_16x16x32_bf16 v[76:79], a[156:159], a[12:15], v[76:79]
ds_read_b64_tr_b16 a[182:183], v192 offset:45056
v_mfma_f32_16x16x32_bf16 v[76:79], a[152:155], a[8:11], v[76:79]
s_add_u32 s65, s84, 131072
ds_read_b64_tr_b16 a[184:185], v193 offset:32768
v_mfma_f32_16x16x32_bf16 v[108:111], a[152:155], a[16:19], v[108:111]
buffer_load_dwordx4 a[32:35], v14, s[44:47], s65 offen offset:0 sc1
v_mfma_f32_16x16x32_bf16 v[108:111], a[156:159], a[20:23], v[108:111]
ds_read_b64_tr_b16 a[186:187], v193 offset:36864
v_mfma_f32_16x16x32_bf16 v[140:143], a[156:159], a[28:31], v[140:143]
ds_read_b64_tr_b16 a[188:189], v193 offset:40960
v_mfma_f32_16x16x32_bf16 v[140:143], a[152:155], a[24:27], v[140:143]
s_waitcnt lgkmcnt(5)
ds_read_b64_tr_b16 a[190:191], v193 offset:45056
v_mfma_f32_16x16x32_bf16 v[144:147], a[160:163], a[24:27], v[144:147]
s_and_b32 s68, s82, 3
buffer_load_dwordx4 a[40:43], v14, s[44:47], s65 offen offset:1024 sc1
v_mfma_f32_16x16x32_bf16 v[144:147], a[164:167], a[28:31], v[144:147]
s_lshl_b32 s68, s68, 11
s_add_u32 s76, s86, s68
s_lshr_b32 s69, s87, 8
v_mfma_f32_16x16x32_bf16 v[112:115], a[164:167], a[20:23], v[112:115]
s_lshr_b32 s67, s82, 1
s_xor_b32 s69, s69, s67
ds_read_b64_tr_b16 a[192:193], v194 offset:32768
v_mfma_f32_16x16x32_bf16 v[112:115], a[160:163], a[16:19], v[112:115]
s_and_b32 s69, s69, 2
s_lshl_b32 s69, s69, 15
ds_read_b64_tr_b16 a[194:195], v194 offset:36864
v_mfma_f32_16x16x32_bf16 v[80:83], a[160:163], a[8:11], v[80:83]
s_add_u32 s68, s68, s69
buffer_load_dwordx4 a[48:51], v15, s[44:47], s65 offen offset:0 sc1
v_mfma_f32_16x16x32_bf16 v[80:83], a[164:167], a[12:15], v[80:83]
ds_read_b64_tr_b16 a[196:197], v194 offset:40960
v_mfma_f32_16x16x32_bf16 v[48:51], a[164:167], a[4:7], v[48:51]
ds_read_b64_tr_b16 a[198:199], v194 offset:45056
v_mfma_f32_16x16x32_bf16 v[48:51], a[160:163], a[0:3], v[48:51]
buffer_load_dwordx4 a[56:59], v15, s[44:47], s65 offen offset:1024 sc1
v_mfma_f32_16x16x32_bf16 v[52:55], a[168:171], a[0:3], v[52:55]
v_mfma_f32_16x16x32_bf16 v[52:55], a[172:175], a[4:7], v[52:55]
v_mfma_f32_16x16x32_bf16 v[84:87], a[172:175], a[12:15], v[84:87]
s_add_u32 s65, s84, 139264
ds_read_b64_tr_b16 a[200:201], v195 offset:32768
v_mfma_f32_16x16x32_bf16 v[84:87], a[168:171], a[8:11], v[84:87]
buffer_load_dwordx4 a[36:39], v14, s[44:47], s65 offen offset:0 sc1
v_mfma_f32_16x16x32_bf16 v[116:119], a[168:171], a[16:19], v[116:119]
ds_read_b64_tr_b16 a[202:203], v195 offset:36864
v_mfma_f32_16x16x32_bf16 v[116:119], a[172:175], a[20:23], v[116:119]
ds_read_b64_tr_b16 a[204:205], v195 offset:40960
v_mfma_f32_16x16x32_bf16 v[148:151], a[172:175], a[28:31], v[148:151]
ds_read_b64_tr_b16 a[206:207], v195 offset:45056
v_mfma_f32_16x16x32_bf16 v[148:151], a[168:171], a[24:27], v[148:151]
buffer_load_dwordx4 a[44:47], v14, s[44:47], s65 offen offset:1024 sc1
v_mfma_f32_16x16x32_bf16 v[120:123], a[176:179], a[24:27], v[120:123]
s_waitcnt lgkmcnt(4)
v_mfma_f32_16x16x32_bf16 v[120:123], a[180:183], a[28:31], v[120:123]
v_mfma_f32_16x16x32_bf16 v[88:91], a[180:183], a[20:23], v[88:91]
buffer_load_dwordx4 a[52:55], v15, s[44:47], s65 offen offset:0 sc1
v_mfma_f32_16x16x32_bf16 v[88:91], a[176:179], a[16:19], v[88:91]
v_mfma_f32_16x16x32_bf16 v[56:59], a[176:179], a[8:11], v[56:59]
v_mfma_f32_16x16x32_bf16 v[56:59], a[180:183], a[12:15], v[56:59]
v_mfma_f32_16x16x32_bf16 v[24:27], a[180:183], a[4:7], v[24:27]
buffer_load_dwordx4 a[60:63], v15, s[44:47], s65 offen offset:1024 sc1
v_mfma_f32_16x16x32_bf16 v[24:27], a[176:179], a[0:3], v[24:27]
v_mfma_f32_16x16x32_bf16 v[28:31], a[184:187], a[0:3], v[28:31]
v_mfma_f32_16x16x32_bf16 v[28:31], a[188:191], a[4:7], v[28:31]
v_mfma_f32_16x16x32_bf16 v[60:63], a[188:191], a[12:15], v[60:63]
s_lshl3_add_u32 s85, s68, s85
v_mfma_f32_16x16x32_bf16 v[60:63], a[184:187], a[8:11], v[60:63]
s_waitcnt vmcnt(25)
s_barrier
v_mfma_f32_16x16x32_bf16 v[92:95], a[184:187], a[16:19], v[92:95]
ds_read_b64_tr_b16 a[144:145], v204 offset:0
v_mfma_f32_16x16x32_bf16 v[92:95], a[188:191], a[20:23], v[92:95]
ds_read_b64_tr_b16 a[146:147], v204 offset:4096
v_mfma_f32_16x16x32_bf16 v[124:127], a[188:191], a[28:31], v[124:127]
s_xor_b32 m0, s76, 131072
ds_read_b64_tr_b16 a[148:149], v204 offset:8192
v_mfma_f32_16x16x32_bf16 v[124:127], a[184:187], a[24:27], v[124:127]
s_xor_b32 s64, s85, 0
ds_read_b64_tr_b16 a[150:151], v204 offset:12288
v_mfma_f32_16x16x32_bf16 v[128:131], a[192:195], a[24:27], v[128:131]
buffer_load_dwordx4 v12, s[40:43], s64 offen lds
v_mfma_f32_16x16x32_bf16 v[128:131], a[196:199], a[28:31], v[128:131]
s_xor_b32 m0, s76, 132096
ds_read_b64_tr_b16 a[152:153], v205 offset:0
v_mfma_f32_16x16x32_bf16 v[96:99], a[196:199], a[20:23], v[96:99]
s_xor_b32 s64, s85, 8192
ds_read_b64_tr_b16 a[154:155], v205 offset:4096
v_mfma_f32_16x16x32_bf16 v[96:99], a[192:195], a[16:19], v[96:99]
buffer_load_dwordx4 v13, s[40:43], s64 offen lds
v_mfma_f32_16x16x32_bf16 v[64:67], a[192:195], a[8:11], v[64:67]
s_xor_b32 m0, s76, 133120
ds_read_b64_tr_b16 a[156:157], v205 offset:8192
v_mfma_f32_16x16x32_bf16 v[64:67], a[196:199], a[12:15], v[64:67]
s_xor_b32 s64, s85, 16384
ds_read_b64_tr_b16 a[158:159], v205 offset:12288
v_mfma_f32_16x16x32_bf16 v[32:35], a[196:199], a[4:7], v[32:35]
buffer_load_dwordx4 v12, s[40:43], s64 offen lds
v_mfma_f32_16x16x32_bf16 v[32:35], a[192:195], a[0:3], v[32:35]
s_waitcnt lgkmcnt(4)
s_xor_b32 m0, s76, 134144
ds_read_b64_tr_b16 a[160:161], v206 offset:0
v_mfma_f32_16x16x32_bf16 v[36:39], a[200:203], a[0:3], v[36:39]
s_xor_b32 s64, s85, 24576
ds_read_b64_tr_b16 a[162:163], v206 offset:4096
v_mfma_f32_16x16x32_bf16 v[36:39], a[204:207], a[4:7], v[36:39]
buffer_load_dwordx4 v13, s[40:43], s64 offen lds
v_mfma_f32_16x16x32_bf16 v[68:71], a[204:207], a[12:15], v[68:71]
s_xor_b32 m0, s76, 135168
ds_read_b64_tr_b16 a[164:165], v206 offset:8192
v_mfma_f32_16x16x32_bf16 v[68:71], a[200:203], a[8:11], v[68:71]
s_xor_b32 s64, s85, 32768
ds_read_b64_tr_b16 a[166:167], v206 offset:12288
v_mfma_f32_16x16x32_bf16 v[100:103], a[200:203], a[16:19], v[100:103]
buffer_load_dwordx4 v12, s[40:43], s64 offen lds
v_mfma_f32_16x16x32_bf16 v[100:103], a[204:207], a[20:23], v[100:103]
v_mfma_f32_16x16x32_bf16 v[132:135], a[204:207], a[28:31], v[132:135]
v_mfma_f32_16x16x32_bf16 v[132:135], a[200:203], a[24:27], v[132:135]
s_waitcnt vmcnt(26)
v_mfma_f32_16x16x32_bf16 v[136:139], a[144:147], a[88:91], v[136:139]
s_waitcnt vmcnt(22)
s_xor_b32 m0, s76, 136192
ds_read_b64_tr_b16 a[168:169], v207 offset:0
v_mfma_f32_16x16x32_bf16 v[136:139], a[148:151], a[92:95], v[136:139]
s_xor_b32 s64, s85, 40960
ds_read_b64_tr_b16 a[170:171], v207 offset:4096
v_mfma_f32_16x16x32_bf16 v[104:107], a[148:151], a[84:87], v[104:107]
buffer_load_dwordx4 v13, s[40:43], s64 offen lds
v_mfma_f32_16x16x32_bf16 v[104:107], a[144:147], a[80:83], v[104:107]
ds_read_b64_tr_b16 a[172:173], v207 offset:8192
v_mfma_f32_16x16x32_bf16 v[72:75], a[144:147], a[72:75], v[72:75]
ds_read_b64_tr_b16 a[174:175], v207 offset:12288
v_mfma_f32_16x16x32_bf16 v[72:75], a[148:151], a[76:79], v[72:75]
ds_read_b64_tr_b16 a[176:177], v200 offset:0
v_mfma_f32_16x16x32_bf16 v[40:43], a[148:151], a[68:71], v[40:43]
ds_read_b64_tr_b16 a[178:179], v200 offset:4096
v_mfma_f32_16x16x32_bf16 v[40:43], a[144:147], a[64:67], v[40:43]
s_waitcnt lgkmcnt(6)
ds_read_b64_tr_b16 a[180:181], v200 offset:8192
v_mfma_f32_16x16x32_bf16 v[44:47], a[152:155], a[64:67], v[44:47]
s_xor_b32 m0, s76, 137216
ds_read_b64_tr_b16 a[182:183], v200 offset:12288
v_mfma_f32_16x16x32_bf16 v[44:47], a[156:159], a[68:71], v[44:47]
s_xor_b32 s64, s85, 49152
v_mfma_f32_16x16x32_bf16 v[76:79], a[156:159], a[76:79], v[76:79]
buffer_load_dwordx4 v12, s[40:43], s64 offen lds
v_mfma_f32_16x16x32_bf16 v[76:79], a[152:155], a[72:75], v[76:79]
ds_read_b64_tr_b16 a[184:185], v201 offset:0
v_mfma_f32_16x16x32_bf16 v[108:111], a[152:155], a[80:83], v[108:111]
ds_read_b64_tr_b16 a[186:187], v201 offset:4096
v_mfma_f32_16x16x32_bf16 v[108:111], a[156:159], a[84:87], v[108:111]
ds_read_b64_tr_b16 a[188:189], v201 offset:8192
v_mfma_f32_16x16x32_bf16 v[140:143], a[156:159], a[92:95], v[140:143]
ds_read_b64_tr_b16 a[190:191], v201 offset:12288
v_mfma_f32_16x16x32_bf16 v[140:143], a[152:155], a[88:91], v[140:143]
v_mfma_f32_16x16x32_bf16 v[144:147], a[160:163], a[88:91], v[144:147]
v_mfma_f32_16x16x32_bf16 v[144:147], a[164:167], a[92:95], v[144:147]
s_xor_b32 m0, s76, 138240
v_mfma_f32_16x16x32_bf16 v[112:115], a[164:167], a[84:87], v[112:115]
s_xor_b32 s64, s85, 57344
ds_read_b64_tr_b16 a[192:193], v202 offset:0
v_mfma_f32_16x16x32_bf16 v[112:115], a[160:163], a[80:83], v[112:115]
buffer_load_dwordx4 v13, s[40:43], s64 offen lds
v_mfma_f32_16x16x32_bf16 v[80:83], a[160:163], a[72:75], v[80:83]
ds_read_b64_tr_b16 a[194:195], v202 offset:4096
v_mfma_f32_16x16x32_bf16 v[80:83], a[164:167], a[76:79], v[80:83]
ds_read_b64_tr_b16 a[196:197], v202 offset:8192
v_mfma_f32_16x16x32_bf16 v[48:51], a[164:167], a[68:71], v[48:51]
ds_read_b64_tr_b16 a[198:199], v202 offset:12288
v_mfma_f32_16x16x32_bf16 v[48:51], a[160:163], a[64:67], v[48:51]
s_waitcnt lgkmcnt(4)
v_mfma_f32_16x16x32_bf16 v[52:55], a[168:171], a[64:67], v[52:55]
v_mfma_f32_16x16x32_bf16 v[52:55], a[172:175], a[68:71], v[52:55]
v_mfma_f32_16x16x32_bf16 v[84:87], a[172:175], a[76:79], v[84:87]
ds_read_b64_tr_b16 a[200:201], v203 offset:0
v_mfma_f32_16x16x32_bf16 v[84:87], a[168:171], a[72:75], v[84:87]
ds_read_b64_tr_b16 a[202:203], v203 offset:4096
v_mfma_f32_16x16x32_bf16 v[116:119], a[168:171], a[80:83], v[116:119]
ds_read_b64_tr_b16 a[204:205], v203 offset:8192
v_mfma_f32_16x16x32_bf16 v[116:119], a[172:175], a[84:87], v[116:119]
ds_read_b64_tr_b16 a[206:207], v203 offset:12288
v_mfma_f32_16x16x32_bf16 v[148:151], a[172:175], a[92:95], v[148:151]
buffer_load_dword v19, off, s[52:55], s72 sc1
v_mfma_f32_16x16x32_bf16 v[148:151], a[168:171], a[88:91], v[148:151]
v_mfma_f32_16x16x32_bf16 v[120:123], a[176:179], a[88:91], v[120:123]
v_mfma_f32_16x16x32_bf16 v[120:123], a[180:183], a[92:95], v[120:123]
v_mfma_f32_16x16x32_bf16 v[88:91], a[180:183], a[84:87], v[88:91]
v_mfma_f32_16x16x32_bf16 v[88:91], a[176:179], a[80:83], v[88:91]
s_branch L_po31
L_pg31:
s_branch L_tr2
L_po31:
v_mfma_f32_16x16x32_bf16 v[56:59], a[176:179], a[72:75], v[56:59]
v_mfma_f32_16x16x32_bf16 v[56:59], a[180:183], a[76:79], v[56:59]
v_mfma_f32_16x16x32_bf16 v[24:27], a[180:183], a[68:71], v[24:27]
v_mfma_f32_16x16x32_bf16 v[24:27], a[176:179], a[64:67], v[24:27]
v_mfma_f32_16x16x32_bf16 v[28:31], a[184:187], a[64:67], v[28:31]
v_mfma_f32_16x16x32_bf16 v[28:31], a[188:191], a[68:71], v[28:31]
v_mfma_f32_16x16x32_bf16 v[60:63], a[188:191], a[76:79], v[60:63]
v_mfma_f32_16x16x32_bf16 v[60:63], a[184:187], a[72:75], v[60:63]
s_waitcnt vmcnt(17)
s_barrier
v_mfma_f32_16x16x32_bf16 v[92:95], a[184:187], a[80:83], v[92:95]
ds_read_b64_tr_b16 a[144:145], v188 offset:0
v_mfma_f32_16x16x32_bf16 v[92:95], a[188:191], a[84:87], v[92:95]
ds_read_b64_tr_b16 a[146:147], v188 offset:4096
v_mfma_f32_16x16x32_bf16 v[124:127], a[188:191], a[92:95], v[124:127]
s_xor_b32 m0, s76, 32768
ds_read_b64_tr_b16 a[148:149], v188 offset:8192
v_mfma_f32_16x16x32_bf16 v[124:127], a[184:187], a[88:91], v[124:127]
s_waitcnt lgkmcnt(3)
s_xor_b32 s64, s85, 262144
ds_read_b64_tr_b16 a[150:151], v188 offset:12288
v_mfma_f32_16x16x32_bf16 v[128:131], a[192:195], a[88:91], v[128:131]
buffer_load_dwordx4 v12, s[40:43], s64 offen lds
v_mfma_f32_16x16x32_bf16 v[128:131], a[196:199], a[92:95], v[128:131]
s_xor_b32 m0, s76, 33792
s_xor_b32 s64, s85, 270336
ds_read_b64_tr_b16 a[152:153], v189 offset:0
v_mfma_f32_16x16x32_bf16 v[96:99], a[196:199], a[84:87], v[96:99]
buffer_load_dwordx4 v13, s[40:43], s64 offen lds
v_mfma_f32_16x16x32_bf16 v[96:99], a[192:195], a[80:83], v[96:99]
s_xor_b32 m0, s76, 34816
ds_read_b64_tr_b16 a[154:155], v189 offset:4096
v_mfma_f32_16x16x32_bf16 v[64:67], a[192:195], a[72:75], v[64:67]
s_xor_b32 s64, s85, 278528
ds_read_b64_tr_b16 a[156:157], v189 offset:8192
v_mfma_f32_16x16x32_bf16 v[64:67], a[196:199], a[76:79], v[64:67]
buffer_load_dwordx4 v12, s[40:43], s64 offen lds
v_mfma_f32_16x16x32_bf16 v[32:35], a[196:199], a[68:71], v[32:35]
s_xor_b32 m0, s76, 35840
ds_read_b64_tr_b16 a[158:159], v189 offset:12288
v_mfma_f32_16x16x32_bf16 v[32:35], a[192:195], a[64:67], v[32:35]
s_xor_b32 s64, s85, 286720
ds_read_b64_tr_b16 a[160:161], v190 offset:0
v_mfma_f32_16x16x32_bf16 v[36:39], a[200:203], a[64:67], v[36:39]
buffer_load_dwordx4 v13, s[40:43], s64 offen lds
v_mfma_f32_16x16x32_bf16 v[36:39], a[204:207], a[68:71], v[36:39]
s_xor_b32 m0, s76, 36864
s_xor_b32 s64, s85, 294912
ds_read_b64_tr_b16 a[162:163], v190 offset:4096
v_mfma_f32_16x16x32_bf16 v[68:71], a[204:207], a[76:79], v[68:71]
buffer_load_dwordx4 v12, s[40:43], s64 offen lds
v_mfma_f32_16x16x32_bf16 v[68:71], a[200:203], a[72:75], v[68:71]
s_xor_b32 m0, s76, 37888
ds_read_b64_tr_b16 a[164:165], v190 offset:8192
v_mfma_f32_16x16x32_bf16 v[100:103], a[200:203], a[80:83], v[100:103]
s_xor_b32 s64, s85, 303104
ds_read_b64_tr_b16 a[166:167], v190 offset:12288
v_mfma_f32_16x16x32_bf16 v[100:103], a[204:207], a[84:87], v[100:103]
buffer_load_dwordx4 v13, s[40:43], s64 offen lds
v_mfma_f32_16x16x32_bf16 v[132:135], a[204:207], a[92:95], v[132:135]
v_mfma_f32_16x16x32_bf16 v[132:135], a[200:203], a[88:91], v[132:135]
s_waitcnt vmcnt(19)
s_waitcnt lgkmcnt(3)
v_mfma_f32_16x16x32_bf16 v[136:139], a[144:147], a[56:59], v[136:139]
s_waitcnt vmcnt(6)
v_readfirstlane_b32 vcc_lo, v19
s_nop 0
s_cmp_lt_u32 vcc_lo, 8
s_cbranch_scc1 L_spin_3019
L_spinbk_3020:
s_sub_u32 s84, s84, 1048576
s_add_u32 s84, s84, s69
v_mfma_f32_16x16x32_bf16 v[136:139], a[148:151], a[60:63], v[136:139]
s_xor_b32 s65, s84, 0
ds_read_b64_tr_b16 a[168:169], v191 offset:0
v_mfma_f32_16x16x32_bf16 v[104:107], a[148:151], a[52:55], v[104:107]
buffer_load_dwordx4 a[208:211], v14, s[44:47], s65 offen offset:0 sc1
v_mfma_f32_16x16x32_bf16 v[104:107], a[144:147], a[48:51], v[104:107]
ds_read_b64_tr_b16 a[170:171], v191 offset:4096
v_mfma_f32_16x16x32_bf16 v[72:75], a[144:147], a[40:43], v[72:75]
buffer_load_dwordx4 a[216:219], v14, s[44:47], s65 offen offset:1024 sc1
v_mfma_f32_16x16x32_bf16 v[72:75], a[148:151], a[44:47], v[72:75]
ds_read_b64_tr_b16 a[172:173], v191 offset:8192
v_mfma_f32_16x16x32_bf16 v[40:43], a[148:151], a[36:39], v[40:43]
buffer_load_dwordx4 a[224:227], v15, s[44:47], s65 offen offset:0 sc1
v_mfma_f32_16x16x32_bf16 v[40:43], a[144:147], a[32:35], v[40:43]
ds_read_b64_tr_b16 a[174:175], v191 offset:12288
v_mfma_f32_16x16x32_bf16 v[44:47], a[152:155], a[32:35], v[44:47]
buffer_load_dwordx4 a[232:235], v15, s[44:47], s65 offen offset:1024 sc1
v_mfma_f32_16x16x32_bf16 v[44:47], a[156:159], a[36:39], v[44:47]
s_xor_b32 s65, s84, 8192
ds_read_b64_tr_b16 a[176:177], v184 offset:0
v_mfma_f32_16x16x32_bf16 v[76:79], a[156:159], a[44:47], v[76:79]
buffer_load_dwordx4 a[212:215], v14, s[44:47], s65 offen offset:0 sc1
v_mfma_f32_16x16x32_bf16 v[76:79], a[152:155], a[40:43], v[76:79]
ds_read_b64_tr_b16 a[178:179], v184 offset:4096
v_mfma_f32_16x16x32_bf16 v[108:111], a[152:155], a[48:51], v[108:111]
ds_read_b64_tr_b16 a[180:181], v184 offset:8192
v_mfma_f32_16x16x32_bf16 v[108:111], a[156:159], a[52:55], v[108:111]
buffer_load_dwordx4 a[220:223], v14, s[44:47], s65 offen offset:1024 sc1
v_mfma_f32_16x16x32_bf16 v[140:143], a[156:159], a[60:63], v[140:143]
ds_read_b64_tr_b16 a[182:183], v184 offset:12288
v_mfma_f32_16x16x32_bf16 v[140:143], a[152:155], a[56:59], v[140:143]
s_waitcnt lgkmcnt(4)
buffer_load_dwordx4 a[228:231], v15, s[44:47], s65 offen offset:0 sc1
v_mfma_f32_16x16x32_bf16 v[144:147], a[160:163], a[56:59], v[144:147]
ds_read_b64_tr_b16 a[184:185], v185 offset:0
v_mfma_f32_16x16x32_bf16 v[144:147], a[164:167], a[60:63], v[144:147]
buffer_load_dwordx4 a[236:239], v15, s[44:47], s65 offen offset:1024 sc1
v_mfma_f32_16x16x32_bf16 v[112:115], a[164:167], a[52:55], v[112:115]
s_xor_b32 m0, s76, 38912
s_xor_b32 s64, s85, 311296
ds_read_b64_tr_b16 a[186:187], v185 offset:4096
v_mfma_f32_16x16x32_bf16 v[112:115], a[160:163], a[48:51], v[112:115]
buffer_load_dwordx4 v12, s[40:43], s64 offen lds
v_mfma_f32_16x16x32_bf16 v[80:83], a[160:163], a[40:43], v[80:83]
s_xor_b32 m0, s76, 39936
ds_read_b64_tr_b16 a[188:189], v185 offset:8192
v_mfma_f32_16x16x32_bf16 v[80:83], a[164:167], a[44:47], v[80:83]
s_xor_b32 s64, s85, 319488
ds_read_b64_tr_b16 a[190:191], v185 offset:12288
v_mfma_f32_16x16x32_bf16 v[48:51], a[164:167], a[36:39], v[48:51]
buffer_load_dwordx4 v13, s[40:43], s64 offen lds
v_mfma_f32_16x16x32_bf16 v[48:51], a[160:163], a[32:35], v[48:51]
s_xor_b32 s65, s84, 32768
ds_read_b64_tr_b16 a[192:193], v186 offset:0
v_mfma_f32_16x16x32_bf16 v[52:55], a[168:171], a[32:35], v[52:55]
buffer_load_dwordx4 v[152:155], v14, s[44:47], s65 offen offset:0 sc1
v_mfma_f32_16x16x32_bf16 v[52:55], a[172:175], a[36:39], v[52:55]
ds_read_b64_tr_b16 a[194:195], v186 offset:4096
v_mfma_f32_16x16x32_bf16 v[84:87], a[172:175], a[44:47], v[84:87]
buffer_load_dwordx4 v[160:163], v14, s[44:47], s65 offen offset:1024 sc1
v_mfma_f32_16x16x32_bf16 v[84:87], a[168:171], a[40:43], v[84:87]
ds_read_b64_tr_b16 a[196:197], v186 offset:8192
v_mfma_f32_16x16x32_bf16 v[116:119], a[168:171], a[48:51], v[116:119]
buffer_load_dwordx4 v[168:171], v15, s[44:47], s65 offen offset:0 sc1
v_mfma_f32_16x16x32_bf16 v[116:119], a[172:175], a[52:55], v[116:119]
ds_read_b64_tr_b16 a[198:199], v186 offset:12288
v_mfma_f32_16x16x32_bf16 v[148:151], a[172:175], a[60:63], v[148:151]
buffer_load_dwordx4 v[176:179], v15, s[44:47], s65 offen offset:1024 sc1
v_mfma_f32_16x16x32_bf16 v[148:151], a[168:171], a[56:59], v[148:151]
s_waitcnt lgkmcnt(3)
ds_read_b64_tr_b16 a[200:201], v187 offset:0
v_mfma_f32_16x16x32_bf16 v[120:123], a[176:179], a[56:59], v[120:123]
s_xor_b32 s65, s84, 40960
ds_read_b64_tr_b16 a[202:203], v187 offset:4096
v_mfma_f32_16x16x32_bf16 v[120:123], a[180:183], a[60:63], v[120:123]
buffer_load_dwordx4 v[156:159], v14, s[44:47], s65 offen offset:0 sc1
v_mfma_f32_16x16x32_bf16 v[88:91], a[180:183], a[52:55], v[88:91]
ds_read_b64_tr_b16 a[204:205], v187 offset:8192
v_mfma_f32_16x16x32_bf16 v[88:91], a[176:179], a[48:51], v[88:91]
buffer_load_dwordx4 v[164:167], v14, s[44:47], s65 offen offset:1024 sc1
v_mfma_f32_16x16x32_bf16 v[56:59], a[176:179], a[40:43], v[56:59]
ds_read_b64_tr_b16 a[206:207], v187 offset:12288
v_mfma_f32_16x16x32_bf16 v[56:59], a[180:183], a[44:47], v[56:59]
buffer_load_dwordx4 v[172:175], v15, s[44:47], s65 offen offset:0 sc1
v_mfma_f32_16x16x32_bf16 v[24:27], a[180:183], a[36:39], v[24:27]
v_mfma_f32_16x16x32_bf16 v[24:27], a[176:179], a[32:35], v[24:27]
buffer_load_dwordx4 v[180:183], v15, s[44:47], s65 offen offset:1024 sc1
v_mfma_f32_16x16x32_bf16 v[28:31], a[184:187], a[32:35], v[28:31]
v_mfma_f32_16x16x32_bf16 v[28:31], a[188:191], a[36:39], v[28:31]
v_mfma_f32_16x16x32_bf16 v[60:63], a[188:191], a[44:47], v[60:63]
v_mfma_f32_16x16x32_bf16 v[60:63], a[184:187], a[40:43], v[60:63]
s_barrier
v_mfma_f32_16x16x32_bf16 v[92:95], a[184:187], a[48:51], v[92:95]
ds_read_b64_tr_b16 a[144:145], v188 offset:32768
v_mfma_f32_16x16x32_bf16 v[92:95], a[188:191], a[52:55], v[92:95]
ds_read_b64_tr_b16 a[146:147], v188 offset:36864
v_mfma_f32_16x16x32_bf16 v[124:127], a[188:191], a[60:63], v[124:127]
s_xor_b32 m0, s76, 65536
ds_read_b64_tr_b16 a[148:149], v188 offset:40960
v_mfma_f32_16x16x32_bf16 v[124:127], a[184:187], a[56:59], v[124:127]
s_waitcnt lgkmcnt(3)
s_xor_b32 s64, s85, 524288
ds_read_b64_tr_b16 a[150:151], v188 offset:45056
v_mfma_f32_16x16x32_bf16 v[128:131], a[192:195], a[56:59], v[128:131]
buffer_load_dwordx4 v12, s[40:43], s64 offen lds
v_mfma_f32_16x16x32_bf16 v[128:131], a[196:199], a[60:63], v[128:131]
s_xor_b32 m0, s76, 66560
ds_read_b64_tr_b16 a[152:153], v189 offset:32768
v_mfma_f32_16x16x32_bf16 v[96:99], a[196:199], a[52:55], v[96:99]
s_xor_b32 s64, s85, 532480
ds_read_b64_tr_b16 a[154:155], v189 offset:36864
v_mfma_f32_16x16x32_bf16 v[96:99], a[192:195], a[48:51], v[96:99]
buffer_load_dwordx4 v13, s[40:43], s64 offen lds
v_mfma_f32_16x16x32_bf16 v[64:67], a[192:195], a[40:43], v[64:67]
s_xor_b32 m0, s76, 67584
ds_read_b64_tr_b16 a[156:157], v189 offset:40960
v_mfma_f32_16x16x32_bf16 v[64:67], a[196:199], a[44:47], v[64:67]
s_xor_b32 s64, s85, 540672
ds_read_b64_tr_b16 a[158:159], v189 offset:45056
v_mfma_f32_16x16x32_bf16 v[32:35], a[196:199], a[36:39], v[32:35]
buffer_load_dwordx4 v12, s[40:43], s64 offen lds
v_mfma_f32_16x16x32_bf16 v[32:35], a[192:195], a[32:35], v[32:35]
s_xor_b32 m0, s76, 68608
ds_read_b64_tr_b16 a[160:161], v190 offset:32768
v_mfma_f32_16x16x32_bf16 v[36:39], a[200:203], a[32:35], v[36:39]
s_xor_b32 s64, s85, 548864
ds_read_b64_tr_b16 a[162:163], v190 offset:36864
v_mfma_f32_16x16x32_bf16 v[36:39], a[204:207], a[36:39], v[36:39]
buffer_load_dwordx4 v13, s[40:43], s64 offen lds
v_mfma_f32_16x16x32_bf16 v[68:71], a[204:207], a[44:47], v[68:71]
s_xor_b32 m0, s76, 69632
ds_read_b64_tr_b16 a[164:165], v190 offset:40960
v_mfma_f32_16x16x32_bf16 v[68:71], a[200:203], a[40:43], v[68:71]
s_xor_b32 s64, s85, 557056
ds_read_b64_tr_b16 a[166:167], v190 offset:45056
v_mfma_f32_16x16x32_bf16 v[100:103], a[200:203], a[48:51], v[100:103]
buffer_load_dwordx4 v12, s[40:43], s64 offen lds
v_mfma_f32_16x16x32_bf16 v[100:103], a[204:207], a[52:55], v[100:103]
s_mov_b32 s70, 3
s_mov_b32 s73, 2
v_mfma_f32_16x16x32_bf16 v[132:135], a[204:207], a[60:63], v[132:135]
v_mfma_f32_16x16x32_bf16 v[132:135], a[200:203], a[56:59], v[132:135]
s_branch L_p5join
L_spin_4022:
s_mov_b32 vcc_hi, 0x80000
L_spinlp_4024:
s_sleep 1
buffer_load_dword v19, off, s[52:55], s72 offset:128 sc1
s_waitcnt vmcnt(0)
v_readfirstlane_b32 vcc_lo, v19
s_sub_u32 vcc_hi, vcc_hi, 1
s_cbranch_scc1 L_spinbk_4023
s_cmp_lt_u32 vcc_lo, s74
s_cbranch_scc1 L_spinlp_4024
s_branch L_spinbk_4023
L_codeend:
.section .rodata,"a"
.p2align 6
.amdhsa_kernel gated_mix__compressed_kv_cla__sliding_local_dilated__prompt_kernel
  .amdhsa_next_free_vgpr 512
  .amdhsa_next_free_sgpr 102
  .amdhsa_accum_offset 256
  .amdhsa_group_segment_fixed_size 0
  .amdhsa_kernarg_size 104
  .amdhsa_user_sgpr_count 2
  .amdhsa_user_sgpr_kernarg_segment_ptr 1
  .amdhsa_system_sgpr_workgroup_id_x 1
.end_amdhsa_kernel
```

```asm
; @launch grid=(256,1,1) block=(256,1,1) lds=163840
.amdgcn_target "amdgcn-amd-amdhsa--gfx950"
.text
.globl gated_mix__compressed_kv_cla__sliding_local_dilated__prompt_kernel
.p2align 8
.type gated_mix__compressed_kv_cla__sliding_local_dilated__prompt_kernel,@function
gated_mix__compressed_kv_cla__sliding_local_dilated__prompt_kernel:
s_cmp_ge_u32 s2, 256
s_cbranch_scc1 L_end
s_load_dwordx16 s[4:19], s[0:1], 0
s_load_dwordx8 s[20:27], s[0:1], 64
s_load_dwordx2 s[28:29], s[0:1], 96
s_getpc_b64 s[88:89]
L_pc:
v_lshrrev_b32 v1, 6, v0
s_lshr_b32 s67, s2, 3
v_lshl_add_u32 v24, s67, 2, v1
s_mov_b32 s90, L_codeend-L_pc
s_mov_b32 s91, 0x20000
v_and_b32 v25, 7, v0
v_lshlrev_b32 v25, 7, v25
v_lshl_add_u32 v24, v24, 10, v25
buffer_load_dword a252, v24, s[88:91], 0 offen
v_and_b32 v0, 63, v0
v_readfirstlane_b32 s30, v1
v_lshrrev_b32 v24, 3, v0
v_lshrrev_b32 v25, 4, v0
v_and_b32 v26, 7, v0
v_xor_b32 v26, v26, v25
v_lshlrev_b32 v26, 4, v26
v_lshl_add_u32 v12, v24, 10, v26
v_xor_b32 v13, 64, v12
v_bfe_u32 v26, v0, 1, 3
v_xor_b32 v26, v26, v25
v_lshlrev_b32 v26, 5, v26
v_and_b32 v24, 1, v0
v_lshl_add_u32 v26, v24, 4, v26
v_lshl_add_u32 v14, v25, 13, v26
v_xor_b32 v15, 128, v14
s_and_b32 s66, s2, 7
s_and_b32 s68, s67, 3
s_lshl2_add_u32 s31, s66, s68
s_cmp_eq_u32 s68, 0
s_cselect_b32 s90, s90, 0
s_lshr_b32 s3, s67, 2
s_lshl2_add_u32 s80, s67, s30
s_lshl_b32 s70, s3, 18
s_lshl_b32 s66, s30, 16
s_add_u32 s70, s70, s66
s_lshl_b32 s71, s30, 17
s_lshl_b32 s66, s31, 8
s_add_u32 s71, s71, s66
s_lshl_b32 s76, s30, 13
s_lshl_b32 s77, s30, 12
s_lshl_b32 s78, s30, 10
s_cmp_eq_u32 s30, 0
s_cbranch_scc1 L_pg1
s_cmp_eq_u32 s30, 1
s_cbranch_scc1 L_tr9
s_cmp_eq_u32 s30, 2
s_cbranch_scc1 L_tr9
s_branch L_tr9
L_tr9:
s_waitcnt lgkmcnt(0)
s_mov_b32 s32, s6
s_mov_b32 s33, s7
s_mov_b32 s34, 2097152
s_mov_b32 s35, 0x20000
s_mov_b32 s36, s10
s_mov_b32 s37, s11
s_mov_b32 s38, 4194304
s_mov_b32 s39, 0x20000
s_mov_b32 s40, s12
s_mov_b32 s41, s13
s_mov_b32 s42, 4194304
s_mov_b32 s43, 0x20000
s_xor_b32 m0, s76, 0
s_xor_b32 s64, s70, 0
buffer_load_dwordx4 v12, s[32:35], s64 offen lds
s_xor_b32 m0, s76, 1024
s_xor_b32 s64, s70, 8192
buffer_load_dwordx4 v13, s[32:35], s64 offen lds
s_xor_b32 m0, s76, 2048
s_xor_b32 s64, s70, 16384
buffer_load_dwordx4 v12, s[32:35], s64 offen lds
s_xor_b32 m0, s76, 3072
s_xor_b32 s64, s70, 24576
buffer_load_dwordx4 v13, s[32:35], s64 offen lds
s_xor_b32 m0, s77, 65536
s_xor_b32 s64, s71, 0
buffer_load_dwordx4 v14, s[36:39], s64 offen lds
s_xor_b32 m0, s77, 66560
s_xor_b32 s64, s71, 32768
buffer_load_dwordx4 v14, s[36:39], s64 offen lds
s_xor_b32 m0, s77, 67584
s_xor_b32 s64, s71, 65536
buffer_load_dwordx4 v15, s[36:39], s64 offen lds
s_xor_b32 m0, s77, 68608
s_xor_b32 s64, s71, 98304
buffer_load_dwordx4 v15, s[36:39], s64 offen lds
s_mov_b32 s44, s28
s_mov_b32 s45, s29
s_mov_b32 s46, 134217728
s_mov_b32 s47, 0x20000
s_mov_b32 s48, s4
s_mov_b32 s49, s5
s_mov_b32 s50, 4194304
s_mov_b32 s51, 0x20000
s_mov_b32 s52, s26
s_mov_b32 s53, s27
s_mov_b32 s54, 256
s_mov_b32 s55, 0x20000
s_mov_b32 s56, s8
s_mov_b32 s57, s9
s_mov_b32 s58, 8388608
s_mov_b32 s59, 0x20000
s_mov_b32 s60, s18
s_mov_b32 s61, s19
s_mov_b32 s62, 6291456
s_mov_b32 s63, 0x20000
v_accvgpr_write_b32 a251, 1
v_and_b32 v24, 15, v0
v_lshrrev_b32 v26, 1, v24
v_xor_b32 v26, v26, v25
v_lshlrev_b32 v26, 4, v26
v_lshl_add_u32 v26, v24, 7, v26
v_add_u32 v2, s76, v26
v_xor_b32 v3, 64, v2
v_bfe_u32 v24, v0, 2, 2
v_lshl_add_u32 v27, v25, 3, v24
v_and_b32 v1, 3, v0
v_cmp_eq_u32 vcc, 0, v1
v_lshlrev_b32 v1, 3, v1
v_lshl_add_u32 v26, v27, 8, v1
v_add_u32 v26, 65536, v26
v_and_b32 v1, 1, v25
v_lshl_add_u32 v24, v1, 2, v24
v_lshlrev_b32 v16, 4, v0
v_mov_b32 v28, 0x3f803f80
v_cndmask_b32 v28, 0, v28, vcc
v_accvgpr_write_b32 a244, v28
v_accvgpr_write_b32 a245, v28
v_accvgpr_write_b32 a246, v28
v_accvgpr_write_b32 a247, v28
v_xor_b32 v1, 0, v24
v_lshl_add_u32 v4, v1, 5, v26
v_xor_b32 v1, 1, v24
v_lshl_add_u32 v5, v1, 5, v26
v_xor_b32 v1, 2, v24
v_lshl_add_u32 v6, v1, 5, v26
v_xor_b32 v1, 3, v24
v_lshl_add_u32 v7, v1, 5, v26
v_xor_b32 v1, 4, v24
v_lshl_add_u32 v8, v1, 5, v26
v_xor_b32 v1, 5, v24
v_lshl_add_u32 v9, v1, 5, v26
v_xor_b32 v1, 6, v24
v_lshl_add_u32 v10, v1, 5, v26
v_xor_b32 v1, 7, v24
v_lshl_add_u32 v11, v1, 5, v26
s_sub_u32 s16, 15, s3
s_lshl_b32 s72, s3, 18
s_lshl_b32 s73, s16, 18
s_cmp_lt_u32 s30, 2
s_cselect_b32 s67, s3, s16
s_lshl4_add_u32 s74, s31, s67
s_and_b32 s66, s30, 1
s_lshl1_add_u32 s74, s74, s66
s_lshl_b32 s74, s74, 10
s_add_u32 s74, s74, 60817408
s_lshl_b32 s66, s30, 15
s_add_u32 s72, s72, s66
s_add_u32 s73, s73, s66
s_mul_i32 s75, s30, 98304
s_lshl_b32 s66, s31, 6
s_add_u32 s75, s75, s66
s_lshl_b32 s79, s31, 20
s_lshl_b32 s66, s3, 17
s_add_u32 s79, s79, s66
s_lshl_b32 s66, s30, 15
s_add_u32 s79, s79, s66
v_bfe_u32 v23, v0, 1, 1
v_lshrrev_b32 v1, 5, v0
v_xor_b32 v23, v23, v1
v_lshlrev_b32 v23, 5, v23
v_and_b32 v1, 1, v0
v_lshl_add_u32 v23, v1, 4, v23
v_lshrrev_b32 v1, 2, v0
v_mul_u32_u24 v1, 6144, v1
v_add_u32 v23, v1, v23
s_lshl_b32 s81, s80, 13
s_and_b32 s67, s2, 7
s_lshl_b32 s82, s67, 8
s_add_u32 s82, s82, s81
s_lshl_b32 s67, s67, 10
s_add_u32 s81, s81, s67
s_add_u32 s83, s81, 1048576
v_mul_u32_u24 v1, 1792, v25
v_add_u32 v1, v1, v16
s_lshl_b32 s68, s2, 3
s_lshl1_add_u32 s68, s30, s68
v_lshrrev_b32 v18, 5, v0
v_add_u32 v18, s68, v18
v_and_b32 v19, 31, v0
v_lshlrev_b32 v19, 4, v19
v_lshl_add_u32 v18, v18, 11, v19
v_mov_b32 v21, 0
v_min_u32 v20, 1, v0
v_lshlrev_b32 v20, 30, v20
v_accvgpr_write_b32 a240, -1
v_accvgpr_write_b32 a241, -1
v_accvgpr_write_b32 a242, -1
v_accvgpr_write_b32 a243, -1
s_lshr_b32 s69, s2, 7
s_or_b32 s69, s69, s30
s_lshl_b32 s69, s69, 21
s_add_u32 s69, s69, s2
s_lshl_b32 s69, s69, 7
s_add_u32 s69, s69, 59768832
s_cmp_eq_u32 s30, 0
s_cbranch_scc1 L_pg2
s_cmp_eq_u32 s30, 1
s_cbranch_scc1 L_pg3
s_cmp_eq_u32 s30, 2
s_cbranch_scc1 L_pg4
s_branch L_pg5
L_tr0:
s_branch L_base
.p2align 12
L_pg1:
s_branch L_tr9
L_base:
s_xor_b32 m0, s76, 4096
s_xor_b32 s64, s70, 32768
buffer_load_dwordx4 v12, s[32:35], s64 offen lds
s_xor_b32 m0, s76, 5120
s_xor_b32 s64, s70, 40960
buffer_load_dwordx4 v13, s[32:35], s64 offen lds
s_xor_b32 m0, s76, 6144
s_xor_b32 s64, s70, 49152
buffer_load_dwordx4 v12, s[32:35], s64 offen lds
s_xor_b32 m0, s76, 7168
s_xor_b32 s64, s70, 57344
buffer_load_dwordx4 v13, s[32:35], s64 offen lds
s_xor_b32 m0, s77, 81920
s_xor_b32 s64, s71, 0
buffer_load_dwordx4 v14, s[40:43], s64 offen lds
s_xor_b32 m0, s77, 82944
s_xor_b32 s64, s71, 32768
buffer_load_dwordx4 v14, s[40:43], s64 offen lds
s_xor_b32 m0, s77, 83968
s_xor_b32 s64, s71, 65536
buffer_load_dwordx4 v15, s[40:43], s64 offen lds
s_xor_b32 m0, s77, 84992
s_xor_b32 s64, s71, 98304
buffer_load_dwordx4 v15, s[40:43], s64 offen lds
s_and_b32 s66, s31, 3
s_lshl_b32 s67, s66, 11
s_add_u32 s84, s76, s67
s_lshl3_add_u32 s70, s67, s70
s_and_b32 s67, s66, 1
s_lshl_b32 s67, s67, 17
s_add_u32 s72, s72, s67
s_add_u32 s67, s73, s67
s_bitcmp1_b32 s66, 1
s_cselect_b32 s73, s72, s67
s_cselect_b32 s72, s67, s72
s_and_b32 s66, s3, 3
s_lshl_b32 s67, s66, 10
s_add_u32 s77, s77, s67
s_lshl_b32 s67, s66, 15
s_add_u32 s71, s71, s67
s_and_b32 s67, s66, 2
s_lshl_b32 s67, s67, 6
v_xor_b32 v14, s67, v14
v_xor_b32 v15, s67, v15
s_and_b32 s66, s3, 4
s_cselect_b64 s[36:37], s[12:13], s[10:11]
s_cselect_b64 s[40:41], s[10:11], s[12:13]
s_lshl_b32 s66, s66, 12
s_add_u32 s77, s77, s66
s_waitcnt vmcnt(8)
s_barrier
ds_read_b128 a[0:3], v2 offset:0
ds_read_b128 a[4:7], v3 offset:0
ds_read_b64_tr_b16 a[176:177], v4 offset:0
ds_read_b64_tr_b16 a[178:179], v4 offset:1024
ds_read_b64_tr_b16 a[180:181], v4 offset:8192
ds_read_b64_tr_b16 a[182:183], v4 offset:9216
ds_read_b128 a[8:11], v2 offset:2048
ds_read_b128 a[12:15], v3 offset:2048
ds_read_b64_tr_b16 a[184:185], v5 offset:0
ds_read_b64_tr_b16 a[186:187], v5 offset:1024
ds_read_b64_tr_b16 a[188:189], v5 offset:8192
ds_read_b64_tr_b16 a[190:191], v5 offset:9216
ds_read_b64_tr_b16 a[88:89], v6 offset:0
ds_read_b64_tr_b16 a[90:91], v6 offset:1024
ds_read_b64_tr_b16 a[92:93], v6 offset:8192
ds_read_b64_tr_b16 a[94:95], v6 offset:9216
s_waitcnt lgkmcnt(12)
v_mfma_f32_16x16x32_bf16 v[184:187], a[176:179], a[0:3], 0
s_waitcnt lgkmcnt(10)
s_xor_b32 m0, s77, 98304
ds_read_b64_tr_b16 a[96:97], v7 offset:0
v_mfma_f32_16x16x32_bf16 v[184:187], a[180:183], a[4:7], v[184:187]
s_waitcnt lgkmcnt(9)
s_xor_b32 s64, s71, 524288
ds_read_b64_tr_b16 a[98:99], v7 offset:1024
v_mfma_f32_16x16x32_bf16 v[192:195], a[180:183], a[12:15], 0
buffer_load_dwordx4 v14, s[36:39], s64 offen lds
v_mfma_f32_16x16x32_bf16 v[192:195], a[176:179], a[8:11], v[192:195]
s_waitcnt lgkmcnt(8)
ds_read_b64_tr_b16 a[100:101], v7 offset:8192
v_mfma_f32_16x16x32_bf16 v[196:199], a[184:187], a[8:11], 0
s_waitcnt lgkmcnt(7)
s_xor_b32 m0, s77, 99328
ds_read_b64_tr_b16 a[102:103], v7 offset:9216
v_mfma_f32_16x16x32_bf16 v[196:199], a[188:191], a[12:15], v[196:199]
s_xor_b32 s64, s71, 557056
ds_read_b64_tr_b16 a[104:105], v8 offset:0
v_mfma_f32_16x16x32_bf16 v[188:191], a[188:191], a[4:7], 0
buffer_load_dwordx4 v14, s[36:39], s64 offen lds
v_mfma_f32_16x16x32_bf16 v[188:191], a[184:187], a[0:3], v[188:191]
s_waitcnt lgkmcnt(7)
ds_read_b64_tr_b16 a[106:107], v8 offset:1024
v_mfma_f32_16x16x32_bf16 v[216:219], a[88:91], a[0:3], 0
s_waitcnt lgkmcnt(6)
s_xor_b32 m0, s77, 100352
ds_read_b64_tr_b16 a[108:109], v8 offset:8192
v_mfma_f32_16x16x32_bf16 v[216:219], a[92:95], a[4:7], v[216:219]
s_xor_b32 s64, s71, 589824
ds_read_b64_tr_b16 a[110:111], v8 offset:9216
v_mfma_f32_16x16x32_bf16 v[224:227], a[92:95], a[12:15], 0
buffer_load_dwordx4 v15, s[36:39], s64 offen lds
v_mfma_f32_16x16x32_bf16 v[224:227], a[88:91], a[8:11], v[224:227]
s_waitcnt lgkmcnt(6)
ds_read_b64_tr_b16 a[112:113], v9 offset:0
v_mfma_f32_16x16x32_bf16 v[228:231], a[96:99], a[8:11], 0
s_waitcnt lgkmcnt(5)
ds_read_b64_tr_b16 a[114:115], v9 offset:1024
v_mfma_f32_16x16x32_bf16 v[228:231], a[100:103], a[12:15], v[228:231]
s_xor_b32 m0, s77, 101376
ds_read_b64_tr_b16 a[116:117], v9 offset:8192
v_mfma_f32_16x16x32_bf16 v[220:223], a[100:103], a[4:7], 0
s_xor_b32 s64, s71, 622592
ds_read_b64_tr_b16 a[118:119], v9 offset:9216
v_mfma_f32_16x16x32_bf16 v[220:223], a[96:99], a[0:3], v[220:223]
s_waitcnt lgkmcnt(6)
buffer_load_dwordx4 v15, s[36:39], s64 offen lds
v_mfma_f32_16x16x32_bf16 v[152:155], a[104:107], a[0:3], 0
s_waitcnt lgkmcnt(4)
ds_read_b64_tr_b16 a[72:73], v10 offset:0
v_mfma_f32_16x16x32_bf16 v[152:155], a[108:111], a[4:7], v[152:155]
s_xor_b32 m0, s77, 114688
ds_read_b64_tr_b16 a[74:75], v10 offset:1024
v_mfma_f32_16x16x32_bf16 v[160:163], a[108:111], a[12:15], 0
s_xor_b32 s64, s71, 524288
ds_read_b64_tr_b16 a[76:77], v10 offset:8192
ds_read_b64_tr_b16 a[78:79], v10 offset:9216
v_mfma_f32_16x16x32_bf16 v[160:163], a[104:107], a[8:11], v[160:163]
s_waitcnt lgkmcnt(6)
buffer_load_dwordx4 v14, s[40:43], s64 offen lds
v_mfma_f32_16x16x32_bf16 v[164:167], a[112:115], a[8:11], 0
s_waitcnt lgkmcnt(4)
s_xor_b32 m0, s77, 115712
ds_read_b64_tr_b16 a[80:81], v11 offset:0
v_mfma_f32_16x16x32_bf16 v[164:167], a[116:119], a[12:15], v[164:167]
s_xor_b32 s64, s71, 557056
ds_read_b64_tr_b16 a[82:83], v11 offset:1024
v_mfma_f32_16x16x32_bf16 v[156:159], a[116:119], a[4:7], 0
ds_read_b64_tr_b16 a[84:85], v11 offset:8192
ds_read_b64_tr_b16 a[86:87], v11 offset:9216
s_waitcnt vmcnt(9)
v_mfma_f32_16x16x32_bf16 v[156:159], a[112:115], a[0:3], v[156:159]
s_waitcnt lgkmcnt(6)
buffer_load_dwordx4 v14, s[40:43], s64 offen lds
v_mfma_f32_16x16x32_bf16 v[24:27], a[72:75], a[0:3], 0
s_waitcnt lgkmcnt(4)
s_xor_b32 m0, s77, 116736
ds_read_b128 a[16:19], v2 offset:4096
ds_read_b128 a[20:23], v3 offset:4096
v_mfma_f32_16x16x32_bf16 v[24:27], a[76:79], a[4:7], v[24:27]
s_xor_b32 s64, s71, 589824
ds_read_b128 a[24:27], v2 offset:6144
ds_read_b128 a[28:31], v3 offset:6144
v_mfma_f32_16x16x32_bf16 v[40:43], a[76:79], a[12:15], 0
buffer_load_dwordx4 v15, s[40:43], s64 offen lds
v_mfma_f32_16x16x32_bf16 v[40:43], a[72:75], a[8:11], v[40:43]
s_waitcnt lgkmcnt(6)
v_mfma_f32_16x16x32_bf16 v[104:107], a[80:83], a[8:11], 0
s_waitcnt lgkmcnt(4)
s_xor_b32 m0, s77, 117760
v_mfma_f32_16x16x32_bf16 v[104:107], a[84:87], a[12:15], v[104:107]
s_xor_b32 s64, s71, 622592
v_mfma_f32_16x16x32_bf16 v[88:91], a[84:87], a[4:7], 0
buffer_load_dwordx4 v15, s[40:43], s64 offen lds
v_mfma_f32_16x16x32_bf16 v[88:91], a[80:83], a[0:3], v[88:91]
s_waitcnt lgkmcnt(3)
v_mfma_f32_16x16x32_bf16 v[232:235], a[88:91], a[16:19], 0
s_waitcnt lgkmcnt(2)
v_mfma_f32_16x16x32_bf16 v[232:235], a[92:95], a[20:23], v[232:235]
s_waitcnt lgkmcnt(0)
s_xor_b32 m0, s84, 32768
v_mfma_f32_16x16x32_bf16 v[240:243], a[92:95], a[28:31], 0
s_xor_b32 s64, s70, 128
v_mfma_f32_16x16x32_bf16 v[240:243], a[88:91], a[24:27], v[240:243]
buffer_load_dwordx4 v12, s[32:35], s64 offen lds
v_mfma_f32_16x16x32_bf16 v[244:247], a[96:99], a[24:27], 0
s_xor_b32 m0, s84, 33792
v_mfma_f32_16x16x32_bf16 v[244:247], a[100:103], a[28:31], v[244:247]
s_xor_b32 s64, s70, 8320
v_mfma_f32_16x16x32_bf16 v[236:239], a[100:103], a[20:23], 0
s_waitcnt vmcnt(9)
s_barrier
v_mfma_f32_16x16x32_bf16 v[236:239], a[96:99], a[16:19], v[236:239]
buffer_load_dwordx4 v13, s[32:35], s64 offen lds
v_mfma_f32_16x16x32_bf16 v[168:171], a[104:107], a[16:19], 0
ds_read_b64_tr_b16 a[88:89], v4 offset:16384
v_mfma_f32_16x16x32_bf16 v[168:171], a[108:111], a[20:23], v[168:171]
s_xor_b32 m0, s84, 34816
ds_read_b64_tr_b16 a[90:91], v4 offset:17408
v_mfma_f32_16x16x32_bf16 v[176:179], a[108:111], a[28:31], 0
s_xor_b32 s64, s70, 16512
ds_read_b64_tr_b16 a[92:93], v4 offset:24576
v_mfma_f32_16x16x32_bf16 v[176:179], a[104:107], a[24:27], v[176:179]
buffer_load_dwordx4 v12, s[32:35], s64 offen lds
v_mfma_f32_16x16x32_bf16 v[180:183], a[112:115], a[24:27], 0
ds_read_b64_tr_b16 a[94:95], v4 offset:25600
v_mfma_f32_16x16x32_bf16 v[180:183], a[116:119], a[28:31], v[180:183]
s_xor_b32 m0, s84, 35840
ds_read_b64_tr_b16 a[96:97], v5 offset:16384
v_mfma_f32_16x16x32_bf16 v[172:175], a[116:119], a[20:23], 0
s_xor_b32 s64, s70, 24704
ds_read_b64_tr_b16 a[98:99], v5 offset:17408
v_mfma_f32_16x16x32_bf16 v[172:175], a[112:115], a[16:19], v[172:175]
buffer_load_dwordx4 v13, s[32:35], s64 offen lds
v_mfma_f32_16x16x32_bf16 v[56:59], a[72:75], a[16:19], 0
ds_read_b64_tr_b16 a[100:101], v5 offset:24576
v_mfma_f32_16x16x32_bf16 v[56:59], a[76:79], a[20:23], v[56:59]
s_xor_b32 m0, s84, 36864
ds_read_b64_tr_b16 a[102:103], v5 offset:25600
v_mfma_f32_16x16x32_bf16 v[72:75], a[76:79], a[28:31], 0
s_xor_b32 s64, s70, 32896
ds_read_b64_tr_b16 a[104:105], v6 offset:16384
v_mfma_f32_16x16x32_bf16 v[72:75], a[72:75], a[24:27], v[72:75]
buffer_load_dwordx4 v12, s[32:35], s64 offen lds
v_mfma_f32_16x16x32_bf16 v[136:139], a[80:83], a[24:27], 0
ds_read_b64_tr_b16 a[106:107], v6 offset:17408
v_mfma_f32_16x16x32_bf16 v[136:139], a[84:87], a[28:31], v[136:139]
s_xor_b32 m0, s84, 37888
ds_read_b64_tr_b16 a[108:109], v6 offset:24576
v_mfma_f32_16x16x32_bf16 v[120:123], a[84:87], a[20:23], 0
s_xor_b32 s64, s70, 41088
ds_read_b64_tr_b16 a[110:111], v6 offset:25600
v_mfma_f32_16x16x32_bf16 v[120:123], a[80:83], a[16:19], v[120:123]
buffer_load_dwordx4 v13, s[32:35], s64 offen lds
v_mfma_f32_16x16x32_bf16 v[200:203], a[176:179], a[16:19], 0
ds_read_b64_tr_b16 a[112:113], v7 offset:16384
v_mfma_f32_16x16x32_bf16 v[200:203], a[180:183], a[20:23], v[200:203]
s_xor_b32 m0, s84, 38912
ds_read_b64_tr_b16 a[114:115], v7 offset:17408
v_mfma_f32_16x16x32_bf16 v[208:211], a[180:183], a[28:31], 0
s_xor_b32 s64, s70, 49280
ds_read_b64_tr_b16 a[116:117], v7 offset:24576
v_mfma_f32_16x16x32_bf16 v[208:211], a[176:179], a[24:27], v[208:211]
buffer_load_dwordx4 v12, s[32:35], s64 offen lds
v_mfma_f32_16x16x32_bf16 v[212:215], a[184:187], a[24:27], 0
ds_read_b64_tr_b16 a[118:119], v7 offset:25600
v_mfma_f32_16x16x32_bf16 v[212:215], a[188:191], a[28:31], v[212:215]
s_xor_b32 m0, s84, 39936
ds_read_b64_tr_b16 a[72:73], v8 offset:16384
v_mfma_f32_16x16x32_bf16 v[204:207], a[188:191], a[20:23], 0
s_xor_b32 s64, s70, 57472
ds_read_b64_tr_b16 a[74:75], v8 offset:17408
v_mfma_f32_16x16x32_bf16 v[204:207], a[184:187], a[16:19], v[204:207]
s_waitcnt lgkmcnt(7)
buffer_load_dwordx4 v13, s[32:35], s64 offen lds
v_mfma_f32_16x16x32_bf16 v[28:31], a[0:3], a[88:91], 0
ds_read_b64_tr_b16 a[76:77], v8 offset:24576
v_mfma_f32_16x16x32_bf16 v[28:31], a[4:7], a[92:95], v[28:31]
ds_read_b64_tr_b16 a[78:79], v8 offset:25600
v_mfma_f32_16x16x32_bf16 v[44:47], a[12:15], a[92:95], 0
ds_read_b64_tr_b16 a[80:81], v9 offset:16384
v_mfma_f32_16x16x32_bf16 v[44:47], a[8:11], a[88:91], v[44:47]
ds_read_b64_tr_b16 a[82:83], v9 offset:17408
v_mfma_f32_16x16x32_bf16 v[60:63], a[16:19], a[88:91], 0
s_xor_b32 m0, s77, 131072
ds_read_b64_tr_b16 a[84:85], v9 offset:24576
v_mfma_f32_16x16x32_bf16 v[60:63], a[20:23], a[92:95], v[60:63]
s_xor_b32 s64, s71, 1048576
ds_read_b64_tr_b16 a[86:87], v9 offset:25600
v_mfma_f32_16x16x32_bf16 v[76:79], a[28:31], a[92:95], 0
buffer_load_dwordx4 v14, s[36:39], s64 offen lds
v_mfma_f32_16x16x32_bf16 v[76:79], a[24:27], a[88:91], v[76:79]
ds_read_b64_tr_b16 a[88:89], v10 offset:16384
v_mfma_f32_16x16x32_bf16 v[140:143], a[24:27], a[96:99], 0
ds_read_b64_tr_b16 a[90:91], v10 offset:17408
v_mfma_f32_16x16x32_bf16 v[140:143], a[28:31], a[100:103], v[140:143]
ds_read_b64_tr_b16 a[92:93], v10 offset:24576
v_mfma_f32_16x16x32_bf16 v[124:127], a[20:23], a[100:103], 0
s_xor_b32 m0, s77, 132096
ds_read_b64_tr_b16 a[94:95], v10 offset:25600
v_mfma_f32_16x16x32_bf16 v[124:127], a[16:19], a[96:99], v[124:127]
s_xor_b32 s64, s71, 1081344
v_mfma_f32_16x16x32_bf16 v[108:111], a[8:11], a[96:99], 0
buffer_load_dwordx4 v14, s[36:39], s64 offen lds
v_mfma_f32_16x16x32_bf16 v[108:111], a[12:15], a[100:103], v[108:111]
v_mfma_f32_16x16x32_bf16 v[92:95], a[4:7], a[100:103], 0
v_mfma_f32_16x16x32_bf16 v[92:95], a[0:3], a[96:99], v[92:95]
ds_read_b64_tr_b16 a[96:97], v11 offset:16384
v_mfma_f32_16x16x32_bf16 v[32:35], a[0:3], a[104:107], 0
s_waitcnt lgkmcnt(5)
ds_read_b64_tr_b16 a[98:99], v11 offset:17408
v_mfma_f32_16x16x32_bf16 v[32:35], a[4:7], a[108:111], v[32:35]
s_xor_b32 m0, s77, 133120
ds_read_b64_tr_b16 a[100:101], v11 offset:24576
v_mfma_f32_16x16x32_bf16 v[48:51], a[12:15], a[108:111], 0
s_xor_b32 s64, s71, 1114112
ds_read_b64_tr_b16 a[102:103], v11 offset:25600
v_mfma_f32_16x16x32_bf16 v[48:51], a[8:11], a[104:107], v[48:51]
buffer_load_dwordx4 v15, s[36:39], s64 offen lds
v_mfma_f32_16x16x32_bf16 v[64:67], a[16:19], a[104:107], 0
v_mfma_f32_16x16x32_bf16 v[64:67], a[20:23], a[108:111], v[64:67]
v_mfma_f32_16x16x32_bf16 v[80:83], a[28:31], a[108:111], 0
v_mfma_f32_16x16x32_bf16 v[80:83], a[24:27], a[104:107], v[80:83]
v_mfma_f32_16x16x32_bf16 v[144:147], a[24:27], a[112:115], 0
s_xor_b32 m0, s77, 134144
v_mfma_f32_16x16x32_bf16 v[144:147], a[28:31], a[116:119], v[144:147]
s_xor_b32 s64, s71, 1146880
v_mfma_f32_16x16x32_bf16 v[128:131], a[20:23], a[116:119], 0
buffer_load_dwordx4 v15, s[36:39], s64 offen lds
v_mfma_f32_16x16x32_bf16 v[128:131], a[16:19], a[112:115], v[128:131]
v_mfma_f32_16x16x32_bf16 v[112:115], a[8:11], a[112:115], 0
v_mfma_f32_16x16x32_bf16 v[112:115], a[12:15], a[116:119], v[112:115]
v_mfma_f32_16x16x32_bf16 v[96:99], a[4:7], a[116:119], 0
v_mfma_f32_16x16x32_bf16 v[96:99], a[0:3], a[112:115], v[96:99]
s_xor_b32 m0, s77, 147456
v_mfma_f32_16x16x32_bf16 v[36:39], a[0:3], a[72:75], 0
s_xor_b32 s64, s71, 1048576
v_mfma_f32_16x16x32_bf16 v[36:39], a[4:7], a[76:79], v[36:39]
buffer_load_dwordx4 v14, s[40:43], s64 offen lds
v_mfma_f32_16x16x32_bf16 v[52:55], a[12:15], a[76:79], 0
s_waitcnt vmcnt(13) lgkmcnt(0)
s_barrier
v_mfma_f32_16x16x32_bf16 v[52:55], a[8:11], a[72:75], v[52:55]
ds_read_b64_tr_b16 a[104:105], v4 offset:32768
v_mfma_f32_16x16x32_bf16 v[68:71], a[16:19], a[72:75], 0
global_load_dwordx4 a[144:147], v18, s[4:5] offset:0
v_mfma_f32_16x16x32_bf16 v[68:71], a[20:23], a[76:79], v[68:71]
ds_read_b64_tr_b16 a[106:107], v4 offset:33792
v_mfma_f32_16x16x32_bf16 v[84:87], a[28:31], a[76:79], 0
s_xor_b32 m0, s77, 148480
ds_read_b64_tr_b16 a[108:109], v4 offset:40960
v_mfma_f32_16x16x32_bf16 v[84:87], a[24:27], a[72:75], v[84:87]
s_xor_b32 s64, s71, 1081344
ds_read_b64_tr_b16 a[110:111], v4 offset:41984
v_mfma_f32_16x16x32_bf16 v[148:151], a[24:27], a[80:83], 0
buffer_load_dwordx4 v14, s[40:43], s64 offen lds
v_mfma_f32_16x16x32_bf16 v[148:151], a[28:31], a[84:87], v[148:151]
ds_read_b64_tr_b16 a[112:113], v5 offset:32768
v_mfma_f32_16x16x32_bf16 v[132:135], a[20:23], a[84:87], 0
s_waitcnt vmcnt(7)
ds_read_b128 a[32:35], v2 offset:32768
v_mfma_f32_16x16x32_bf16 v[132:135], a[16:19], a[80:83], v[132:135]
ds_read_b128 a[36:39], v3 offset:32768
v_mfma_f32_16x16x32_bf16 v[116:119], a[8:11], a[80:83], 0
ds_read_b128 a[40:43], v2 offset:34816
v_mfma_f32_16x16x32_bf16 v[116:119], a[12:15], a[84:87], v[116:119]
s_xor_b32 m0, s77, 149504
ds_read_b128 a[44:47], v3 offset:34816
v_mfma_f32_16x16x32_bf16 v[100:103], a[4:7], a[84:87], 0
s_xor_b32 s64, s71, 1114112
ds_read_b128 a[48:51], v2 offset:36864
v_mfma_f32_16x16x32_bf16 v[100:103], a[0:3], a[80:83], v[100:103]
buffer_load_dwordx4 v15, s[40:43], s64 offen lds
v_mfma_f32_16x16x32_bf16 v[248:251], a[0:3], a[88:91], 0
ds_read_b128 a[52:55], v3 offset:36864
v_mfma_f32_16x16x32_bf16 v[248:251], a[4:7], a[92:95], v[248:251]
ds_read_b128 a[56:59], v2 offset:38912
v_mfma_f32_16x16x32_bf16 v[252:255], a[12:15], a[92:95], 0
ds_read_b128 a[60:63], v3 offset:38912
v_mfma_f32_16x16x32_bf16 v[252:255], a[8:11], a[88:91], v[252:255]
ds_read_b64_tr_b16 a[114:115], v5 offset:33792
v_mfma_f32_16x16x32_bf16 a[120:123], a[16:19], a[88:91], 0
s_xor_b32 m0, s77, 150528
ds_read_b64_tr_b16 a[116:117], v5 offset:40960
v_mfma_f32_16x16x32_bf16 a[120:123], a[20:23], a[92:95], a[120:123]
s_xor_b32 s64, s71, 1146880
ds_read_b64_tr_b16 a[118:119], v5 offset:41984
v_mfma_f32_16x16x32_bf16 a[124:127], a[28:31], a[92:95], 0
buffer_load_dwordx4 v15, s[40:43], s64 offen lds
v_mfma_f32_16x16x32_bf16 a[124:127], a[24:27], a[88:91], a[124:127]
ds_read_b64_tr_b16 a[72:73], v6 offset:32768
v_mfma_f32_16x16x32_bf16 a[128:131], a[24:27], a[96:99], 0
ds_read_b64_tr_b16 a[74:75], v6 offset:33792
v_mfma_f32_16x16x32_bf16 a[128:131], a[28:31], a[100:103], a[128:131]
ds_read_b64_tr_b16 a[76:77], v6 offset:40960
v_mfma_f32_16x16x32_bf16 a[132:135], a[20:23], a[100:103], 0
global_load_dwordx4 a[160:163], v19, s[22:23] offset:0
v_mfma_f32_16x16x32_bf16 a[132:135], a[16:19], a[96:99], a[132:135]
s_xor_b32 m0, s84, 0
ds_read_b64_tr_b16 a[78:79], v6 offset:41984
v_mfma_f32_16x16x32_bf16 a[136:139], a[8:11], a[96:99], 0
s_xor_b32 s64, s70, 256
ds_read_b64_tr_b16 a[80:81], v7 offset:32768
v_mfma_f32_16x16x32_bf16 a[136:139], a[12:15], a[100:103], a[136:139]
buffer_load_dwordx4 v12, s[32:35], s64 offen lds
v_mfma_f32_16x16x32_bf16 a[140:143], a[4:7], a[100:103], 0
ds_read_b64_tr_b16 a[82:83], v7 offset:33792
v_mfma_f32_16x16x32_bf16 a[140:143], a[0:3], a[96:99], a[140:143]
s_waitcnt lgkmcnt(6)
ds_read_b64_tr_b16 a[84:85], v7 offset:40960
v_mfma_f32_16x16x32_bf16 v[184:187], a[104:107], a[32:35], v[184:187]
ds_read_b64_tr_b16 a[86:87], v7 offset:41984
v_mfma_f32_16x16x32_bf16 v[184:187], a[108:111], a[36:39], v[184:187]
ds_read_b64_tr_b16 a[88:89], v8 offset:32768
v_mfma_f32_16x16x32_bf16 v[192:195], a[108:111], a[44:47], v[192:195]
s_xor_b32 m0, s84, 1024
ds_read_b64_tr_b16 a[90:91], v8 offset:33792
v_mfma_f32_16x16x32_bf16 v[192:195], a[104:107], a[40:43], v[192:195]
s_xor_b32 s64, s70, 8448
ds_read_b64_tr_b16 a[92:93], v8 offset:40960
v_mfma_f32_16x16x32_bf16 v[200:203], a[104:107], a[48:51], v[200:203]
buffer_load_dwordx4 v13, s[32:35], s64 offen lds
v_mfma_f32_16x16x32_bf16 v[200:203], a[108:111], a[52:55], v[200:203]
ds_read_b64_tr_b16 a[94:95], v8 offset:41984
v_mfma_f32_16x16x32_bf16 v[208:211], a[108:111], a[60:63], v[208:211]
ds_read_b64_tr_b16 a[96:97], v9 offset:32768
v_mfma_f32_16x16x32_bf16 v[208:211], a[104:107], a[56:59], v[208:211]
ds_read_b64_tr_b16 a[98:99], v9 offset:33792
v_mfma_f32_16x16x32_bf16 v[212:215], a[112:115], a[56:59], v[212:215]
ds_read_b64_tr_b16 a[100:101], v9 offset:40960
v_mfma_f32_16x16x32_bf16 v[212:215], a[116:119], a[60:63], v[212:215]
s_xor_b32 m0, s84, 2048
ds_read_b64_tr_b16 a[102:103], v9 offset:41984
v_mfma_f32_16x16x32_bf16 v[204:207], a[116:119], a[52:55], v[204:207]
s_xor_b32 s64, s70, 16640
ds_read_b64_tr_b16 a[104:105], v10 offset:32768
v_mfma_f32_16x16x32_bf16 v[204:207], a[112:115], a[48:51], v[204:207]
buffer_load_dwordx4 v12, s[32:35], s64 offen lds
v_mfma_f32_16x16x32_bf16 v[196:199], a[112:115], a[40:43], v[196:199]
ds_read_b64_tr_b16 a[106:107], v10 offset:33792
v_mfma_f32_16x16x32_bf16 v[196:199], a[116:119], a[44:47], v[196:199]
ds_read_b64_tr_b16 a[108:109], v10 offset:40960
v_mfma_f32_16x16x32_bf16 v[188:191], a[116:119], a[36:39], v[188:191]
ds_read_b64_tr_b16 a[110:111], v10 offset:41984
v_mfma_f32_16x16x32_bf16 v[188:191], a[112:115], a[32:35], v[188:191]
s_waitcnt lgkmcnt(8)
ds_read_b64_tr_b16 a[112:113], v11 offset:32768
v_mfma_f32_16x16x32_bf16 v[216:219], a[72:75], a[32:35], v[216:219]
s_xor_b32 m0, s84, 3072
global_load_dwordx4 a[148:151], v18, s[4:5] offset:512
v_mfma_f32_16x16x32_bf16 v[216:219], a[76:79], a[36:39], v[216:219]
s_xor_b32 s64, s70, 24832
ds_read_b64_tr_b16 a[114:115], v11 offset:33792
v_mfma_f32_16x16x32_bf16 v[224:227], a[76:79], a[44:47], v[224:227]
buffer_load_dwordx4 v13, s[32:35], s64 offen lds
v_mfma_f32_16x16x32_bf16 v[224:227], a[72:75], a[40:43], v[224:227]
ds_read_b64_tr_b16 a[116:117], v11 offset:40960
v_mfma_f32_16x16x32_bf16 v[232:235], a[72:75], a[48:51], v[232:235]
ds_read_b64_tr_b16 a[118:119], v11 offset:41984
v_mfma_f32_16x16x32_bf16 v[232:235], a[76:79], a[52:55], v[232:235]
v_mfma_f32_16x16x32_bf16 v[240:243], a[76:79], a[60:63], v[240:243]
s_xor_b32 m0, s84, 4096
v_mfma_f32_16x16x32_bf16 v[240:243], a[72:75], a[56:59], v[240:243]
s_xor_b32 s64, s70, 33024
ds_read_b64_tr_b16 a[72:73], v4 offset:49152
v_mfma_f32_16x16x32_bf16 v[244:247], a[80:83], a[56:59], v[244:247]
buffer_load_dwordx4 v12, s[32:35], s64 offen lds
v_mfma_f32_16x16x32_bf16 v[244:247], a[84:87], a[60:63], v[244:247]
ds_read_b64_tr_b16 a[74:75], v4 offset:50176
v_mfma_f32_16x16x32_bf16 v[236:239], a[84:87], a[52:55], v[236:239]
ds_read_b64_tr_b16 a[76:77], v4 offset:57344
v_mfma_f32_16x16x32_bf16 v[236:239], a[80:83], a[48:51], v[236:239]
ds_read_b64_tr_b16 a[78:79], v4 offset:58368
v_mfma_f32_16x16x32_bf16 v[228:231], a[80:83], a[40:43], v[228:231]
v_mfma_f32_16x16x32_bf16 v[228:231], a[84:87], a[44:47], v[228:231]
s_xor_b32 m0, s84, 5120
v_mfma_f32_16x16x32_bf16 v[220:223], a[84:87], a[36:39], v[220:223]
s_xor_b32 s64, s70, 41216
v_mfma_f32_16x16x32_bf16 v[220:223], a[80:83], a[32:35], v[220:223]
buffer_load_dwordx4 v13, s[32:35], s64 offen lds
v_mfma_f32_16x16x32_bf16 v[152:155], a[88:91], a[32:35], v[152:155]
ds_read_b64_tr_b16 a[80:81], v5 offset:49152
v_mfma_f32_16x16x32_bf16 v[152:155], a[92:95], a[36:39], v[152:155]
ds_read_b64_tr_b16 a[82:83], v5 offset:50176
v_mfma_f32_16x16x32_bf16 v[160:163], a[92:95], a[44:47], v[160:163]
ds_read_b64_tr_b16 a[84:85], v5 offset:57344
v_mfma_f32_16x16x32_bf16 v[160:163], a[88:91], a[40:43], v[160:163]
ds_read_b64_tr_b16 a[86:87], v5 offset:58368
v_mfma_f32_16x16x32_bf16 v[168:171], a[88:91], a[48:51], v[168:171]
s_xor_b32 m0, s84, 6144
v_mfma_f32_16x16x32_bf16 v[168:171], a[92:95], a[52:55], v[168:171]
s_xor_b32 s64, s70, 49408
v_mfma_f32_16x16x32_bf16 v[176:179], a[92:95], a[60:63], v[176:179]
buffer_load_dwordx4 v12, s[32:35], s64 offen lds
v_mfma_f32_16x16x32_bf16 v[176:179], a[88:91], a[56:59], v[176:179]
s_waitcnt lgkmcnt(4)
global_load_dwordx4 a[164:167], v19, s[22:23] offset:512
v_mfma_f32_16x16x32_bf16 v[180:183], a[96:99], a[56:59], v[180:183]
ds_read_b64_tr_b16 a[88:89], v6 offset:49152
v_mfma_f32_16x16x32_bf16 v[180:183], a[100:103], a[60:63], v[180:183]
ds_read_b64_tr_b16 a[90:91], v6 offset:50176
v_mfma_f32_16x16x32_bf16 v[172:175], a[100:103], a[52:55], v[172:175]
ds_read_b64_tr_b16 a[92:93], v6 offset:57344
v_mfma_f32_16x16x32_bf16 v[172:175], a[96:99], a[48:51], v[172:175]
s_xor_b32 m0, s84, 7168
ds_read_b64_tr_b16 a[94:95], v6 offset:58368
v_mfma_f32_16x16x32_bf16 v[164:167], a[96:99], a[40:43], v[164:167]
s_xor_b32 s64, s70, 57600
v_mfma_f32_16x16x32_bf16 v[164:167], a[100:103], a[44:47], v[164:167]
buffer_load_dwordx4 v13, s[32:35], s64 offen lds
v_mfma_f32_16x16x32_bf16 v[156:159], a[100:103], a[36:39], v[156:159]
v_mfma_f32_16x16x32_bf16 v[156:159], a[96:99], a[32:35], v[156:159]
ds_read_b64_tr_b16 a[96:97], v7 offset:49152
v_mfma_f32_16x16x32_bf16 v[24:27], a[104:107], a[32:35], v[24:27]
ds_read_b64_tr_b16 a[98:99], v7 offset:50176
v_mfma_f32_16x16x32_bf16 v[24:27], a[108:111], a[36:39], v[24:27]
ds_read_b64_tr_b16 a[100:101], v7 offset:57344
v_mfma_f32_16x16x32_bf16 v[40:43], a[108:111], a[44:47], v[40:43]
s_xor_b32 m0, s77, 65536
ds_read_b64_tr_b16 a[102:103], v7 offset:58368
v_mfma_f32_16x16x32_bf16 v[40:43], a[104:107], a[40:43], v[40:43]
s_xor_b32 s64, s71, 1572864
v_mfma_f32_16x16x32_bf16 v[56:59], a[104:107], a[48:51], v[56:59]
buffer_load_dwordx4 v14, s[36:39], s64 offen lds
v_mfma_f32_16x16x32_bf16 v[56:59], a[108:111], a[52:55], v[56:59]
v_mfma_f32_16x16x32_bf16 v[72:75], a[108:111], a[60:63], v[72:75]
v_mfma_f32_16x16x32_bf16 v[72:75], a[104:107], a[56:59], v[72:75]
ds_read_b64_tr_b16 a[104:105], v8 offset:49152
v_mfma_f32_16x16x32_bf16 v[136:139], a[112:115], a[56:59], v[136:139]
ds_read_b64_tr_b16 a[106:107], v8 offset:50176
v_mfma_f32_16x16x32_bf16 v[136:139], a[116:119], a[60:63], v[136:139]
s_xor_b32 m0, s77, 66560
ds_read_b64_tr_b16 a[108:109], v8 offset:57344
v_add_u32 v4, 0x8000, v4
v_mfma_f32_16x16x32_bf16 v[120:123], a[116:119], a[52:55], v[120:123]
s_xor_b32 s64, s71, 1605632
ds_read_b64_tr_b16 a[110:111], v8 offset:58368
v_mfma_f32_16x16x32_bf16 v[120:123], a[112:115], a[48:51], v[120:123]
buffer_load_dwordx4 v14, s[36:39], s64 offen lds
v_mfma_f32_16x16x32_bf16 v[104:107], a[112:115], a[40:43], v[104:107]
global_load_dwordx4 a[152:155], v18, s[4:5] offset:1024
v_mfma_f32_16x16x32_bf16 v[104:107], a[116:119], a[44:47], v[104:107]
v_mfma_f32_16x16x32_bf16 v[88:91], a[116:119], a[36:39], v[88:91]
v_mfma_f32_16x16x32_bf16 v[88:91], a[112:115], a[32:35], v[88:91]
ds_read_b64_tr_b16 a[112:113], v9 offset:49152
v_mfma_f32_16x16x32_bf16 v[28:31], a[32:35], a[72:75], v[28:31]
s_xor_b32 m0, s77, 67584
ds_read_b64_tr_b16 a[114:115], v9 offset:50176
v_mfma_f32_16x16x32_bf16 v[28:31], a[36:39], a[76:79], v[28:31]
s_xor_b32 s64, s71, 1638400
ds_read_b64_tr_b16 a[116:117], v9 offset:57344
v_add_u32 v5, 0x8000, v5
v_mfma_f32_16x16x32_bf16 v[44:47], a[44:47], a[76:79], v[44:47]
buffer_load_dwordx4 v15, s[36:39], s64 offen lds
v_mfma_f32_16x16x32_bf16 v[44:47], a[40:43], a[72:75], v[44:47]
ds_read_b64_tr_b16 a[118:119], v9 offset:58368
v_mfma_f32_16x16x32_bf16 v[60:63], a[48:51], a[72:75], v[60:63]
v_mfma_f32_16x16x32_bf16 v[60:63], a[52:55], a[76:79], v[60:63]
v_mfma_f32_16x16x32_bf16 v[76:79], a[60:63], a[76:79], v[76:79]
v_mfma_f32_16x16x32_bf16 v[76:79], a[56:59], a[72:75], v[76:79]
s_waitcnt lgkmcnt(4)
s_xor_b32 m0, s77, 68608
ds_read_b64_tr_b16 a[72:73], v10 offset:49152
v_mfma_f32_16x16x32_bf16 v[140:143], a[56:59], a[80:83], v[140:143]
s_xor_b32 s64, s71, 1671168
ds_read_b64_tr_b16 a[74:75], v10 offset:50176
v_mfma_f32_16x16x32_bf16 v[140:143], a[60:63], a[84:87], v[140:143]
buffer_load_dwordx4 v15, s[36:39], s64 offen lds
v_mfma_f32_16x16x32_bf16 v[124:127], a[52:55], a[84:87], v[124:127]
ds_read_b64_tr_b16 a[76:77], v10 offset:57344
v_add_u32 v6, 0x8000, v6
v_mfma_f32_16x16x32_bf16 v[124:127], a[48:51], a[80:83], v[124:127]
s_branch L_po2
L_pg2:
s_branch L_tr0
L_po2:
ds_read_b64_tr_b16 a[78:79], v10 offset:58368
v_mfma_f32_16x16x32_bf16 v[108:111], a[40:43], a[80:83], v[108:111]
v_mfma_f32_16x16x32_bf16 v[108:111], a[44:47], a[84:87], v[108:111]
v_mfma_f32_16x16x32_bf16 v[92:95], a[36:39], a[84:87], v[92:95]
s_xor_b32 m0, s77, 81920
v_mfma_f32_16x16x32_bf16 v[92:95], a[32:35], a[80:83], v[92:95]
s_xor_b32 s64, s71, 1572864
ds_read_b64_tr_b16 a[80:81], v11 offset:49152
v_mfma_f32_16x16x32_bf16 v[32:35], a[32:35], a[88:91], v[32:35]
buffer_load_dwordx4 v14, s[40:43], s64 offen lds
v_mfma_f32_16x16x32_bf16 v[32:35], a[36:39], a[92:95], v[32:35]
ds_read_b64_tr_b16 a[82:83], v11 offset:50176
v_add_u32 v7, 0x8000, v7
v_mfma_f32_16x16x32_bf16 v[48:51], a[44:47], a[92:95], v[48:51]
global_load_dwordx4 a[168:171], v19, s[22:23] offset:1024
v_mfma_f32_16x16x32_bf16 v[48:51], a[40:43], a[88:91], v[48:51]
ds_read_b64_tr_b16 a[84:85], v11 offset:57344
v_mfma_f32_16x16x32_bf16 v[64:67], a[48:51], a[88:91], v[64:67]
ds_read_b64_tr_b16 a[86:87], v11 offset:58368
v_mfma_f32_16x16x32_bf16 v[64:67], a[52:55], a[92:95], v[64:67]
s_xor_b32 m0, s77, 82944
v_mfma_f32_16x16x32_bf16 v[80:83], a[60:63], a[92:95], v[80:83]
s_xor_b32 s64, s71, 1605632
v_mfma_f32_16x16x32_bf16 v[80:83], a[56:59], a[88:91], v[80:83]
buffer_load_dwordx4 v14, s[40:43], s64 offen lds
v_mfma_f32_16x16x32_bf16 v[144:147], a[56:59], a[96:99], v[144:147]
v_mfma_f32_16x16x32_bf16 v[144:147], a[60:63], a[100:103], v[144:147]
v_add_u32 v8, 0x8000, v8
v_mfma_f32_16x16x32_bf16 v[128:131], a[52:55], a[100:103], v[128:131]
v_mfma_f32_16x16x32_bf16 v[128:131], a[48:51], a[96:99], v[128:131]
v_mfma_f32_16x16x32_bf16 v[112:115], a[40:43], a[96:99], v[112:115]
s_xor_b32 m0, s77, 83968
v_mfma_f32_16x16x32_bf16 v[112:115], a[44:47], a[100:103], v[112:115]
s_xor_b32 s64, s71, 1638400
v_mfma_f32_16x16x32_bf16 v[96:99], a[36:39], a[100:103], v[96:99]
buffer_load_dwordx4 v15, s[40:43], s64 offen lds
v_mfma_f32_16x16x32_bf16 v[96:99], a[32:35], a[96:99], v[96:99]
v_add_u32 v9, 0x8000, v9
v_add_u32 v10, 0x8000, v10
v_mfma_f32_16x16x32_bf16 v[36:39], a[32:35], a[104:107], v[36:39]
v_add_u32 v11, 0x8000, v11
v_mfma_f32_16x16x32_bf16 v[36:39], a[36:39], a[108:111], v[36:39]
s_xor_b32 m0, s77, 84992
v_mfma_f32_16x16x32_bf16 v[52:55], a[44:47], a[108:111], v[52:55]
s_cmp_eq_u32 s30, 0
s_cbranch_scc1 L_pg6
s_cmp_eq_u32 s30, 1
s_cbranch_scc1 L_pg7
s_cmp_eq_u32 s30, 2
s_cbranch_scc1 L_pg8
s_branch L_pg9
L_tr1:
s_waitcnt vmcnt(20) lgkmcnt(0)
s_barrier
v_mfma_f32_16x16x32_bf16 v[52:55], a[40:43], a[104:107], v[52:55]
s_xor_b32 s64, s71, 1671168
ds_read_b64_tr_b16 a[88:89], v4 offset:32768
v_mfma_f32_16x16x32_bf16 v[68:71], a[48:51], a[104:107], v[68:71]
buffer_load_dwordx4 v15, s[40:43], s64 offen lds
v_mfma_f32_16x16x32_bf16 v[68:71], a[52:55], a[108:111], v[68:71]
ds_read_b64_tr_b16 a[90:91], v4 offset:33792
v_mfma_f32_16x16x32_bf16 v[84:87], a[60:63], a[108:111], v[84:87]
ds_read_b64_tr_b16 a[92:93], v4 offset:40960
v_mfma_f32_16x16x32_bf16 v[84:87], a[56:59], a[104:107], v[84:87]
ds_read_b64_tr_b16 a[94:95], v4 offset:41984
v_mfma_f32_16x16x32_bf16 v[148:151], a[56:59], a[112:115], v[148:151]
global_load_dwordx4 a[156:159], v18, s[4:5] offset:1536
v_mfma_f32_16x16x32_bf16 v[148:151], a[60:63], a[116:119], v[148:151]
s_xor_b32 m0, s84, 32768
ds_read_b64_tr_b16 a[96:97], v5 offset:32768
v_mfma_f32_16x16x32_bf16 v[132:135], a[52:55], a[116:119], v[132:135]
s_waitcnt vmcnt(11)
s_xor_b32 s64, s70, 384
ds_read_b128 a[0:3], v2 offset:0
v_mfma_f32_16x16x32_bf16 v[132:135], a[48:51], a[112:115], v[132:135]
buffer_load_dwordx4 v12, s[32:35], s64 offen lds
v_mfma_f32_16x16x32_bf16 v[116:119], a[40:43], a[112:115], v[116:119]
ds_read_b128 a[4:7], v3 offset:0
v_mfma_f32_16x16x32_bf16 v[116:119], a[44:47], a[116:119], v[116:119]
ds_read_b128 a[8:11], v2 offset:2048
v_mfma_f32_16x16x32_bf16 v[100:103], a[36:39], a[116:119], v[100:103]
ds_read_b128 a[12:15], v3 offset:2048
v_mfma_f32_16x16x32_bf16 v[100:103], a[32:35], a[112:115], v[100:103]
ds_read_b128 a[16:19], v2 offset:4096
v_mfma_f32_16x16x32_bf16 v[248:251], a[32:35], a[72:75], v[248:251]
s_xor_b32 m0, s84, 33792
ds_read_b128 a[20:23], v3 offset:4096
v_mfma_f32_16x16x32_bf16 v[248:251], a[36:39], a[76:79], v[248:251]
s_xor_b32 s64, s70, 8576
ds_read_b128 a[24:27], v2 offset:6144
v_mfma_f32_16x16x32_bf16 v[252:255], a[44:47], a[76:79], v[252:255]
buffer_load_dwordx4 v13, s[32:35], s64 offen lds
v_mfma_f32_16x16x32_bf16 v[252:255], a[40:43], a[72:75], v[252:255]
ds_read_b128 a[28:31], v3 offset:6144
v_mfma_f32_16x16x32_bf16 a[120:123], a[48:51], a[72:75], a[120:123]
ds_read_b64_tr_b16 a[98:99], v5 offset:33792
v_mfma_f32_16x16x32_bf16 a[120:123], a[52:55], a[76:79], a[120:123]
ds_read_b64_tr_b16 a[100:101], v5 offset:40960
v_mfma_f32_16x16x32_bf16 a[124:127], a[60:63], a[76:79], a[124:127]
ds_read_b64_tr_b16 a[102:103], v5 offset:41984
v_mfma_f32_16x16x32_bf16 a[124:127], a[56:59], a[72:75], a[124:127]
s_xor_b32 m0, s84, 34816
ds_read_b64_tr_b16 a[104:105], v6 offset:32768
v_mfma_f32_16x16x32_bf16 a[128:131], a[56:59], a[80:83], a[128:131]
s_xor_b32 s64, s70, 16768
ds_read_b64_tr_b16 a[106:107], v6 offset:33792
v_mfma_f32_16x16x32_bf16 a[128:131], a[60:63], a[84:87], a[128:131]
buffer_load_dwordx4 v12, s[32:35], s64 offen lds
v_mfma_f32_16x16x32_bf16 a[132:135], a[52:55], a[84:87], a[132:135]
ds_read_b64_tr_b16 a[108:109], v6 offset:40960
v_mfma_f32_16x16x32_bf16 a[132:135], a[48:51], a[80:83], a[132:135]
ds_read_b64_tr_b16 a[110:111], v6 offset:41984
v_mfma_f32_16x16x32_bf16 a[136:139], a[40:43], a[80:83], a[136:139]
ds_read_b64_tr_b16 a[112:113], v7 offset:32768
v_mfma_f32_16x16x32_bf16 a[136:139], a[44:47], a[84:87], a[136:139]
ds_read_b64_tr_b16 a[114:115], v7 offset:33792
v_mfma_f32_16x16x32_bf16 a[140:143], a[36:39], a[84:87], a[140:143]
s_xor_b32 m0, s84, 35840
global_load_dwordx4 a[172:175], v19, s[22:23] offset:1536
v_mfma_f32_16x16x32_bf16 a[140:143], a[32:35], a[80:83], a[140:143]
s_waitcnt lgkmcnt(7)
s_xor_b32 s64, s70, 24960
ds_read_b64_tr_b16 a[116:117], v7 offset:40960
v_mfma_f32_16x16x32_bf16 v[184:187], a[88:91], a[0:3], v[184:187]
buffer_load_dwordx4 v13, s[32:35], s64 offen lds
v_mfma_f32_16x16x32_bf16 v[184:187], a[92:95], a[4:7], v[184:187]
ds_read_b64_tr_b16 a[118:119], v7 offset:41984
v_mfma_f32_16x16x32_bf16 v[192:195], a[92:95], a[12:15], v[192:195]
ds_read_b64_tr_b16 a[72:73], v8 offset:32768
v_mfma_f32_16x16x32_bf16 v[192:195], a[88:91], a[8:11], v[192:195]
ds_read_b64_tr_b16 a[74:75], v8 offset:33792
v_mfma_f32_16x16x32_bf16 v[200:203], a[88:91], a[16:19], v[200:203]
ds_read_b64_tr_b16 a[76:77], v8 offset:40960
v_mfma_f32_16x16x32_bf16 v[200:203], a[92:95], a[20:23], v[200:203]
s_xor_b32 m0, s84, 36864
ds_read_b64_tr_b16 a[78:79], v8 offset:41984
v_mfma_f32_16x16x32_bf16 v[208:211], a[92:95], a[28:31], v[208:211]
s_xor_b32 s64, s70, 33152
ds_read_b64_tr_b16 a[80:81], v9 offset:32768
v_mfma_f32_16x16x32_bf16 v[208:211], a[88:91], a[24:27], v[208:211]
buffer_load_dwordx4 v12, s[32:35], s64 offen lds
v_mfma_f32_16x16x32_bf16 v[212:215], a[96:99], a[24:27], v[212:215]
s_waitcnt lgkmcnt(7)
ds_read_b64_tr_b16 a[82:83], v9 offset:33792
v_mfma_f32_16x16x32_bf16 v[212:215], a[100:103], a[28:31], v[212:215]
ds_read_b64_tr_b16 a[84:85], v9 offset:40960
v_mfma_f32_16x16x32_bf16 v[204:207], a[100:103], a[20:23], v[204:207]
ds_read_b64_tr_b16 a[86:87], v9 offset:41984
v_mfma_f32_16x16x32_bf16 v[204:207], a[96:99], a[16:19], v[204:207]
ds_read_b64_tr_b16 a[88:89], v10 offset:32768
v_mfma_f32_16x16x32_bf16 v[196:199], a[96:99], a[8:11], v[196:199]
s_xor_b32 m0, s84, 37888
ds_read_b64_tr_b16 a[90:91], v10 offset:33792
v_mfma_f32_16x16x32_bf16 v[196:199], a[100:103], a[12:15], v[196:199]
s_xor_b32 s64, s70, 41344
ds_read_b64_tr_b16 a[92:93], v10 offset:40960
v_mfma_f32_16x16x32_bf16 v[188:191], a[100:103], a[4:7], v[188:191]
buffer_load_dwordx4 v13, s[32:35], s64 offen lds
v_mfma_f32_16x16x32_bf16 v[188:191], a[96:99], a[0:3], v[188:191]
ds_read_b64_tr_b16 a[94:95], v10 offset:41984
v_mfma_f32_16x16x32_bf16 v[216:219], a[104:107], a[0:3], v[216:219]
ds_read_b64_tr_b16 a[96:97], v11 offset:32768
v_mfma_f32_16x16x32_bf16 v[216:219], a[108:111], a[4:7], v[216:219]
ds_read_b64_tr_b16 a[98:99], v11 offset:33792
v_mfma_f32_16x16x32_bf16 v[224:227], a[108:111], a[12:15], v[224:227]
ds_read_b64_tr_b16 a[100:101], v11 offset:40960
v_mfma_f32_16x16x32_bf16 v[224:227], a[104:107], a[8:11], v[224:227]
s_xor_b32 m0, s84, 38912
ds_read_b64_tr_b16 a[102:103], v11 offset:41984
v_mfma_f32_16x16x32_bf16 v[232:235], a[104:107], a[16:19], v[232:235]
s_xor_b32 s64, s70, 49536
buffer_store_dword v21, v20, s[44:47], s69 offen sc1
v_mfma_f32_16x16x32_bf16 v[232:235], a[108:111], a[20:23], v[232:235]
buffer_load_dwordx4 v12, s[32:35], s64 offen lds
v_mfma_f32_16x16x32_bf16 v[240:243], a[108:111], a[28:31], v[240:243]
v_mfma_f32_16x16x32_bf16 v[240:243], a[104:107], a[24:27], v[240:243]
ds_read_b64_tr_b16 a[104:105], v4 offset:49152
v_mfma_f32_16x16x32_bf16 v[244:247], a[112:115], a[24:27], v[244:247]
s_waitcnt lgkmcnt(6)
ds_read_b64_tr_b16 a[106:107], v4 offset:50176
v_mfma_f32_16x16x32_bf16 v[244:247], a[116:119], a[28:31], v[244:247]
ds_read_b64_tr_b16 a[108:109], v4 offset:57344
v_mfma_f32_16x16x32_bf16 v[236:239], a[116:119], a[20:23], v[236:239]
s_xor_b32 m0, s84, 39936
ds_read_b64_tr_b16 a[110:111], v4 offset:58368
v_mfma_f32_16x16x32_bf16 v[236:239], a[112:115], a[16:19], v[236:239]
s_xor_b32 s64, s70, 57728
v_mfma_f32_16x16x32_bf16 v[228:231], a[112:115], a[8:11], v[228:231]
buffer_load_dwordx4 v13, s[32:35], s64 offen lds
v_mfma_f32_16x16x32_bf16 v[228:231], a[116:119], a[12:15], v[228:231]
v_mfma_f32_16x16x32_bf16 v[220:223], a[116:119], a[4:7], v[220:223]
v_mfma_f32_16x16x32_bf16 v[220:223], a[112:115], a[0:3], v[220:223]
ds_read_b64_tr_b16 a[112:113], v5 offset:49152
v_mfma_f32_16x16x32_bf16 v[152:155], a[72:75], a[0:3], v[152:155]
ds_read_b64_tr_b16 a[114:115], v5 offset:50176
v_mfma_f32_16x16x32_bf16 v[152:155], a[76:79], a[4:7], v[152:155]
s_xor_b32 m0, s77, 98304
ds_read_b64_tr_b16 a[116:117], v5 offset:57344
v_mfma_f32_16x16x32_bf16 v[160:163], a[76:79], a[12:15], v[160:163]
s_xor_b32 s64, s71, 2097152
ds_read_b64_tr_b16 a[118:119], v5 offset:58368
v_mfma_f32_16x16x32_bf16 v[160:163], a[72:75], a[8:11], v[160:163]
buffer_load_dwordx4 v14, s[36:39], s64 offen lds
v_mfma_f32_16x16x32_bf16 v[168:171], a[72:75], a[16:19], v[168:171]
v_mfma_f32_16x16x32_bf16 v[168:171], a[76:79], a[20:23], v[168:171]
v_mfma_f32_16x16x32_bf16 v[176:179], a[76:79], a[28:31], v[176:179]
v_mfma_f32_16x16x32_bf16 v[176:179], a[72:75], a[24:27], v[176:179]
ds_read_b64_tr_b16 a[72:73], v6 offset:49152
v_mfma_f32_16x16x32_bf16 v[180:183], a[80:83], a[24:27], v[180:183]
s_xor_b32 m0, s77, 99328
ds_read_b64_tr_b16 a[74:75], v6 offset:50176
v_mfma_f32_16x16x32_bf16 v[180:183], a[84:87], a[28:31], v[180:183]
s_xor_b32 s64, s71, 2129920
ds_read_b64_tr_b16 a[76:77], v6 offset:57344
v_mfma_f32_16x16x32_bf16 v[172:175], a[84:87], a[20:23], v[172:175]
buffer_load_dwordx4 v14, s[36:39], s64 offen lds
v_mfma_f32_16x16x32_bf16 v[172:175], a[80:83], a[16:19], v[172:175]
ds_read_b64_tr_b16 a[78:79], v6 offset:58368
v_mfma_f32_16x16x32_bf16 v[164:167], a[80:83], a[8:11], v[164:167]
buffer_load_dword a252, v16, s[56:59], s81 offen
v_mfma_f32_16x16x32_bf16 v[164:167], a[84:87], a[12:15], v[164:167]
v_mfma_f32_16x16x32_bf16 v[156:159], a[84:87], a[4:7], v[156:159]
s_xor_b32 m0, s77, 100352
v_mfma_f32_16x16x32_bf16 v[156:159], a[80:83], a[0:3], v[156:159]
s_xor_b32 s64, s71, 2162688
ds_read_b64_tr_b16 a[80:81], v7 offset:49152
v_mfma_f32_16x16x32_bf16 v[24:27], a[88:91], a[0:3], v[24:27]
s_waitcnt lgkmcnt(5)
buffer_load_dwordx4 v15, s[36:39], s64 offen lds
v_mfma_f32_16x16x32_bf16 v[24:27], a[92:95], a[4:7], v[24:27]
ds_read_b64_tr_b16 a[82:83], v7 offset:50176
v_mfma_f32_16x16x32_bf16 v[40:43], a[92:95], a[12:15], v[40:43]
ds_read_b64_tr_b16 a[84:85], v7 offset:57344
v_mfma_f32_16x16x32_bf16 v[40:43], a[88:91], a[8:11], v[40:43]
ds_read_b64_tr_b16 a[86:87], v7 offset:58368
v_mfma_f32_16x16x32_bf16 v[56:59], a[88:91], a[16:19], v[56:59]
v_mfma_f32_16x16x32_bf16 v[56:59], a[92:95], a[20:23], v[56:59]
s_xor_b32 m0, s77, 101376
v_mfma_f32_16x16x32_bf16 v[72:75], a[92:95], a[28:31], v[72:75]
s_xor_b32 s64, s71, 2195456
v_mfma_f32_16x16x32_bf16 v[72:75], a[88:91], a[24:27], v[72:75]
buffer_load_dwordx4 v15, s[36:39], s64 offen lds
v_mfma_f32_16x16x32_bf16 v[136:139], a[96:99], a[24:27], v[136:139]
ds_read_b64_tr_b16 a[88:89], v8 offset:49152
v_mfma_f32_16x16x32_bf16 v[136:139], a[100:103], a[28:31], v[136:139]
ds_read_b64_tr_b16 a[90:91], v8 offset:50176
v_subrev_u32 v4, 0x8000, v4
v_mfma_f32_16x16x32_bf16 v[120:123], a[100:103], a[20:23], v[120:123]
ds_read_b64_tr_b16 a[92:93], v8 offset:57344
v_mfma_f32_16x16x32_bf16 v[120:123], a[96:99], a[16:19], v[120:123]
ds_read_b64_tr_b16 a[94:95], v8 offset:58368
v_mfma_f32_16x16x32_bf16 v[104:107], a[96:99], a[8:11], v[104:107]
s_xor_b32 m0, s77, 114688
v_mfma_f32_16x16x32_bf16 v[104:107], a[100:103], a[12:15], v[104:107]
s_xor_b32 s64, s71, 2097152
v_mfma_f32_16x16x32_bf16 v[88:91], a[100:103], a[4:7], v[88:91]
buffer_load_dwordx4 v14, s[40:43], s64 offen lds
v_mfma_f32_16x16x32_bf16 v[88:91], a[96:99], a[0:3], v[88:91]
ds_read_b64_tr_b16 a[96:97], v9 offset:49152
v_mfma_f32_16x16x32_bf16 v[28:31], a[0:3], a[104:107], v[28:31]
ds_read_b64_tr_b16 a[98:99], v9 offset:50176
v_mfma_f32_16x16x32_bf16 v[28:31], a[4:7], a[108:111], v[28:31]
ds_read_b64_tr_b16 a[100:101], v9 offset:57344
v_subrev_u32 v5, 0x8000, v5
v_mfma_f32_16x16x32_bf16 v[44:47], a[12:15], a[108:111], v[44:47]
ds_read_b64_tr_b16 a[102:103], v9 offset:58368
v_mfma_f32_16x16x32_bf16 v[44:47], a[8:11], a[104:107], v[44:47]
s_xor_b32 m0, s77, 115712
v_mfma_f32_16x16x32_bf16 v[60:63], a[16:19], a[104:107], v[60:63]
s_xor_b32 s64, s71, 2129920
v_mfma_f32_16x16x32_bf16 v[60:63], a[20:23], a[108:111], v[60:63]
buffer_load_dwordx4 v14, s[40:43], s64 offen lds
v_mfma_f32_16x16x32_bf16 v[76:79], a[28:31], a[108:111], v[76:79]
v_mfma_f32_16x16x32_bf16 v[76:79], a[24:27], a[104:107], v[76:79]
ds_read_b64_tr_b16 a[104:105], v10 offset:49152
v_mfma_f32_16x16x32_bf16 v[140:143], a[24:27], a[112:115], v[140:143]
ds_read_b64_tr_b16 a[106:107], v10 offset:50176
v_mfma_f32_16x16x32_bf16 v[140:143], a[28:31], a[116:119], v[140:143]
ds_read_b64_tr_b16 a[108:109], v10 offset:57344
v_subrev_u32 v6, 0x8000, v6
v_mfma_f32_16x16x32_bf16 v[124:127], a[20:23], a[116:119], v[124:127]
s_xor_b32 m0, s77, 116736
ds_read_b64_tr_b16 a[110:111], v10 offset:58368
v_mfma_f32_16x16x32_bf16 v[124:127], a[16:19], a[112:115], v[124:127]
s_xor_b32 s64, s71, 2162688
v_mfma_f32_16x16x32_bf16 v[108:111], a[8:11], a[112:115], v[108:111]
buffer_load_dwordx4 v15, s[40:43], s64 offen lds
v_mfma_f32_16x16x32_bf16 v[108:111], a[12:15], a[116:119], v[108:111]
v_mfma_f32_16x16x32_bf16 v[92:95], a[4:7], a[116:119], v[92:95]
v_mfma_f32_16x16x32_bf16 v[92:95], a[0:3], a[112:115], v[92:95]
s_waitcnt lgkmcnt(4)
ds_read_b64_tr_b16 a[112:113], v11 offset:49152
v_mfma_f32_16x16x32_bf16 v[32:35], a[0:3], a[72:75], v[32:35]
ds_read_b64_tr_b16 a[114:115], v11 offset:50176
v_mfma_f32_16x16x32_bf16 v[32:35], a[4:7], a[76:79], v[32:35]
s_xor_b32 m0, s77, 117760
ds_read_b64_tr_b16 a[116:117], v11 offset:57344
v_subrev_u32 v7, 0x8000, v7
v_mfma_f32_16x16x32_bf16 v[48:51], a[12:15], a[76:79], v[48:51]
s_xor_b32 s64, s71, 2195456
ds_read_b64_tr_b16 a[118:119], v11 offset:58368
v_mfma_f32_16x16x32_bf16 v[48:51], a[8:11], a[72:75], v[48:51]
buffer_load_dwordx4 v15, s[40:43], s64 offen lds
v_mfma_f32_16x16x32_bf16 v[64:67], a[16:19], a[72:75], v[64:67]
buffer_load_dword a252, v1, s[60:63], s82 offen
v_mfma_f32_16x16x32_bf16 v[64:67], a[20:23], a[76:79], v[64:67]
v_mfma_f32_16x16x32_bf16 v[80:83], a[28:31], a[76:79], v[80:83]
v_mfma_f32_16x16x32_bf16 v[80:83], a[24:27], a[72:75], v[80:83]
v_mfma_f32_16x16x32_bf16 v[144:147], a[24:27], a[80:83], v[144:147]
s_xor_b32 m0, s84, 0
v_mfma_f32_16x16x32_bf16 v[144:147], a[28:31], a[84:87], v[144:147]
s_xor_b32 s64, s70, 512
v_subrev_u32 v8, 0x8000, v8
v_mfma_f32_16x16x32_bf16 v[128:131], a[20:23], a[84:87], v[128:131]
buffer_load_dwordx4 v12, s[32:35], s64 offen lds
v_mfma_f32_16x16x32_bf16 v[128:131], a[16:19], a[80:83], v[128:131]
v_mfma_f32_16x16x32_bf16 v[112:115], a[8:11], a[80:83], v[112:115]
v_mfma_f32_16x16x32_bf16 v[112:115], a[12:15], a[84:87], v[112:115]
v_mfma_f32_16x16x32_bf16 v[96:99], a[4:7], a[84:87], v[96:99]
v_subrev_u32 v9, 0x8000, v9
v_subrev_u32 v10, 0x8000, v10
v_mfma_f32_16x16x32_bf16 v[96:99], a[0:3], a[80:83], v[96:99]
s_xor_b32 m0, s84, 1024
v_subrev_u32 v11, 0x8000, v11
v_mfma_f32_16x16x32_bf16 v[36:39], a[0:3], a[88:91], v[36:39]
s_xor_b32 s64, s70, 8704
v_mfma_f32_16x16x32_bf16 v[36:39], a[4:7], a[92:95], v[36:39]
buffer_load_dwordx4 v13, s[32:35], s64 offen lds
v_mfma_f32_16x16x32_bf16 v[52:55], a[12:15], a[92:95], v[52:55]
s_waitcnt vmcnt(23) lgkmcnt(0)
s_barrier
v_mfma_f32_16x16x32_bf16 v[52:55], a[8:11], a[88:91], v[52:55]
ds_read_b64_tr_b16 a[72:73], v4 offset:0
v_mfma_f32_16x16x32_bf16 v[68:71], a[16:19], a[88:91], v[68:71]
ds_read_b64_tr_b16 a[74:75], v4 offset:1024
v_mfma_f32_16x16x32_bf16 v[68:71], a[20:23], a[92:95], v[68:71]
ds_read_b64_tr_b16 a[76:77], v4 offset:8192
v_mfma_f32_16x16x32_bf16 v[84:87], a[28:31], a[92:95], v[84:87]
s_xor_b32 m0, s84, 2048
ds_read_b64_tr_b16 a[78:79], v4 offset:9216
v_mfma_f32_16x16x32_bf16 v[84:87], a[24:27], a[88:91], v[84:87]
s_xor_b32 s64, s70, 16896
ds_read_b64_tr_b16 a[80:81], v5 offset:0
v_mfma_f32_16x16x32_bf16 v[148:151], a[24:27], a[96:99], v[148:151]
buffer_load_dwordx4 v12, s[32:35], s64 offen lds
v_mfma_f32_16x16x32_bf16 v[148:151], a[28:31], a[100:103], v[148:151]
ds_read_b64_tr_b16 a[82:83], v5 offset:1024
v_mfma_f32_16x16x32_bf16 v[132:135], a[20:23], a[100:103], v[132:135]
s_waitcnt vmcnt(13)
ds_read_b128 a[32:35], v2 offset:32768
v_mfma_f32_16x16x32_bf16 v[132:135], a[16:19], a[96:99], v[132:135]
ds_read_b128 a[36:39], v3 offset:32768
v_mfma_f32_16x16x32_bf16 v[116:119], a[8:11], a[96:99], v[116:119]
ds_read_b128 a[40:43], v2 offset:34816
v_mfma_f32_16x16x32_bf16 v[116:119], a[12:15], a[100:103], v[116:119]
s_xor_b32 m0, s84, 3072
ds_read_b128 a[44:47], v3 offset:34816
v_mfma_f32_16x16x32_bf16 v[100:103], a[4:7], a[100:103], v[100:103]
s_xor_b32 s64, s70, 25088
ds_read_b128 a[48:51], v2 offset:36864
v_mfma_f32_16x16x32_bf16 v[100:103], a[0:3], a[96:99], v[100:103]
buffer_load_dwordx4 v13, s[32:35], s64 offen lds
v_mfma_f32_16x16x32_bf16 v[248:251], a[0:3], a[104:107], v[248:251]
ds_read_b128 a[52:55], v3 offset:36864
v_mfma_f32_16x16x32_bf16 v[248:251], a[4:7], a[108:111], v[248:251]
ds_read_b128 a[56:59], v2 offset:38912
v_mfma_f32_16x16x32_bf16 v[252:255], a[12:15], a[108:111], v[252:255]
ds_read_b128 a[60:63], v3 offset:38912
v_mfma_f32_16x16x32_bf16 v[252:255], a[8:11], a[104:107], v[252:255]
ds_read_b64_tr_b16 a[84:85], v5 offset:8192
v_mfma_f32_16x16x32_bf16 a[120:123], a[16:19], a[104:107], a[120:123]
s_xor_b32 m0, s84, 4096
ds_read_b64_tr_b16 a[86:87], v5 offset:9216
v_mfma_f32_16x16x32_bf16 a[120:123], a[20:23], a[108:111], a[120:123]
s_xor_b32 s64, s70, 33280
ds_read_b64_tr_b16 a[88:89], v6 offset:0
v_mfma_f32_16x16x32_bf16 a[124:127], a[28:31], a[108:111], a[124:127]
buffer_load_dwordx4 v12, s[32:35], s64 offen lds
v_mfma_f32_16x16x32_bf16 a[124:127], a[24:27], a[104:107], a[124:127]
ds_read_b64_tr_b16 a[90:91], v6 offset:1024
v_mfma_f32_16x16x32_bf16 a[128:131], a[24:27], a[112:115], a[128:131]
ds_read_b64_tr_b16 a[92:93], v6 offset:8192
v_mfma_f32_16x16x32_bf16 a[128:131], a[28:31], a[116:119], a[128:131]
ds_read_b64_tr_b16 a[94:95], v6 offset:9216
v_mfma_f32_16x16x32_bf16 a[132:135], a[20:23], a[116:119], a[132:135]
s_xor_b32 m0, s84, 5120
ds_read_b64_tr_b16 a[96:97], v7 offset:0
v_mfma_f32_16x16x32_bf16 a[132:135], a[16:19], a[112:115], a[132:135]
s_xor_b32 s64, s70, 41472
ds_read_b64_tr_b16 a[98:99], v7 offset:1024
v_mfma_f32_16x16x32_bf16 a[136:139], a[8:11], a[112:115], a[136:139]
s_add_u32 s81, s81, 1048576
buffer_load_dwordx4 v13, s[32:35], s64 offen lds
v_mfma_f32_16x16x32_bf16 a[136:139], a[12:15], a[116:119], a[136:139]
buffer_load_dword a252, v16, s[56:59], s81 offen
v_mfma_f32_16x16x32_bf16 a[140:143], a[4:7], a[116:119], a[140:143]
ds_read_b64_tr_b16 a[100:101], v7 offset:8192
v_mfma_f32_16x16x32_bf16 a[140:143], a[0:3], a[112:115], a[140:143]
s_waitcnt lgkmcnt(6)
ds_read_b64_tr_b16 a[102:103], v7 offset:9216
v_mfma_f32_16x16x32_bf16 v[184:187], a[72:75], a[32:35], v[184:187]
ds_read_b64_tr_b16 a[104:105], v8 offset:0
v_mov_b32 v17, 0
v_mfma_f32_16x16x32_bf16 v[184:187], a[76:79], a[36:39], v[184:187]
s_xor_b32 m0, s84, 6144
ds_read_b64_tr_b16 a[106:107], v8 offset:1024
v_accvgpr_read_b32 v19, a144
v_mfma_f32_16x16x32_bf16 v[192:195], a[76:79], a[44:47], v[192:195]
s_xor_b32 s64, s70, 49664
ds_read_b64_tr_b16 a[108:109], v8 offset:8192
v_accvgpr_read_b32 v21, a160
v_mfma_f32_16x16x32_bf16 v[192:195], a[72:75], a[40:43], v[192:195]
buffer_load_dwordx4 v12, s[32:35], s64 offen lds
v_mfma_f32_16x16x32_bf16 v[200:203], a[72:75], a[48:51], v[200:203]
ds_read_b64_tr_b16 a[110:111], v8 offset:9216
v_lshlrev_b32 v18, 16, v19
v_mfma_f32_16x16x32_bf16 v[200:203], a[76:79], a[52:55], v[200:203]
ds_read_b64_tr_b16 a[112:113], v9 offset:0
v_and_b32 v19, 0xffff0000, v19
v_mfma_f32_16x16x32_bf16 v[208:211], a[76:79], a[60:63], v[208:211]
ds_read_b64_tr_b16 a[114:115], v9 offset:1024
v_lshlrev_b32 v20, 16, v21
v_mfma_f32_16x16x32_bf16 v[208:211], a[72:75], a[56:59], v[208:211]
ds_read_b64_tr_b16 a[116:117], v9 offset:8192
v_and_b32 v21, 0xffff0000, v21
v_mfma_f32_16x16x32_bf16 v[212:215], a[80:83], a[56:59], v[212:215]
s_xor_b32 m0, s84, 7168
ds_read_b64_tr_b16 a[118:119], v9 offset:9216
v_mul_f32 v18, v18, v20
v_mfma_f32_16x16x32_bf16 v[212:215], a[84:87], a[60:63], v[212:215]
s_xor_b32 s64, s70, 57856
ds_read_b64_tr_b16 a[72:73], v10 offset:0
v_mul_f32 v19, v19, v21
v_mfma_f32_16x16x32_bf16 v[204:207], a[84:87], a[52:55], v[204:207]
buffer_load_dwordx4 v13, s[32:35], s64 offen lds
v_mfma_f32_16x16x32_bf16 v[204:207], a[80:83], a[48:51], v[204:207]
ds_read_b64_tr_b16 a[74:75], v10 offset:1024
v_cvt_pk_bf16_f32 v18, v18, v19
v_mfma_f32_16x16x32_bf16 v[196:199], a[80:83], a[40:43], v[196:199]
ds_read_b64_tr_b16 a[76:77], v10 offset:8192
v_lshlrev_b32 v19, 16, v18
v_mfma_f32_16x16x32_bf16 v[196:199], a[84:87], a[44:47], v[196:199]
ds_read_b64_tr_b16 a[78:79], v10 offset:9216
v_and_b32 v18, 0xffff0000, v18
v_mfma_f32_16x16x32_bf16 v[188:191], a[84:87], a[36:39], v[188:191]
v_add_f32 v17, v17, v19
v_add_f32 v17, v17, v18
v_mfma_f32_16x16x32_bf16 v[188:191], a[80:83], a[32:35], v[188:191]
s_waitcnt lgkmcnt(7)
s_xor_b32 m0, s77, 131072
ds_read_b64_tr_b16 a[80:81], v11 offset:0
v_accvgpr_read_b32 v19, a145
v_mfma_f32_16x16x32_bf16 v[216:219], a[88:91], a[32:35], v[216:219]
s_xor_b32 s64, s71, 2621440
ds_read_b64_tr_b16 a[82:83], v11 offset:1024
v_accvgpr_read_b32 v21, a161
v_mfma_f32_16x16x32_bf16 v[216:219], a[92:95], a[36:39], v[216:219]
buffer_load_dwordx4 v14, s[36:39], s64 offen lds
v_mfma_f32_16x16x32_bf16 v[224:227], a[92:95], a[44:47], v[224:227]
ds_read_b64_tr_b16 a[84:85], v11 offset:8192
v_lshlrev_b32 v18, 16, v19
v_mfma_f32_16x16x32_bf16 v[224:227], a[88:91], a[40:43], v[224:227]
ds_read_b64_tr_b16 a[86:87], v11 offset:9216
v_and_b32 v19, 0xffff0000, v19
v_mfma_f32_16x16x32_bf16 v[232:235], a[88:91], a[48:51], v[232:235]
v_lshlrev_b32 v20, 16, v21
v_and_b32 v21, 0xffff0000, v21
v_mfma_f32_16x16x32_bf16 v[232:235], a[92:95], a[52:55], v[232:235]
v_mul_f32 v18, v18, v20
v_mul_f32 v19, v19, v21
v_mfma_f32_16x16x32_bf16 v[240:243], a[92:95], a[60:63], v[240:243]
s_xor_b32 m0, s77, 132096
v_cvt_pk_bf16_f32 v18, v18, v19
v_lshlrev_b32 v19, 16, v18
v_mfma_f32_16x16x32_bf16 v[240:243], a[88:91], a[56:59], v[240:243]
s_xor_b32 s64, s71, 2654208
ds_read_b64_tr_b16 a[88:89], v4 offset:16384
v_and_b32 v18, 0xffff0000, v18
v_mfma_f32_16x16x32_bf16 v[244:247], a[96:99], a[56:59], v[244:247]
buffer_load_dwordx4 v14, s[36:39], s64 offen lds
v_mfma_f32_16x16x32_bf16 v[244:247], a[100:103], a[60:63], v[244:247]
ds_read_b64_tr_b16 a[90:91], v4 offset:17408
v_add_f32 v17, v17, v19
v_mfma_f32_16x16x32_bf16 v[236:239], a[100:103], a[52:55], v[236:239]
ds_read_b64_tr_b16 a[92:93], v4 offset:24576
v_add_f32 v17, v17, v18
v_mfma_f32_16x16x32_bf16 v[236:239], a[96:99], a[48:51], v[236:239]
ds_read_b64_tr_b16 a[94:95], v4 offset:25600
v_accvgpr_read_b32 v19, a146
v_mfma_f32_16x16x32_bf16 v[228:231], a[96:99], a[40:43], v[228:231]
v_accvgpr_read_b32 v21, a162
v_lshlrev_b32 v18, 16, v19
v_mfma_f32_16x16x32_bf16 v[228:231], a[100:103], a[44:47], v[228:231]
s_xor_b32 m0, s77, 133120
v_and_b32 v19, 0xffff0000, v19
v_lshlrev_b32 v20, 16, v21
v_mfma_f32_16x16x32_bf16 v[220:223], a[100:103], a[36:39], v[220:223]
s_xor_b32 s64, s71, 2686976
v_and_b32 v21, 0xffff0000, v21
v_mul_f32 v18, v18, v20
v_mfma_f32_16x16x32_bf16 v[220:223], a[96:99], a[32:35], v[220:223]
buffer_load_dwordx4 v15, s[36:39], s64 offen lds
v_mfma_f32_16x16x32_bf16 v[152:155], a[104:107], a[32:35], v[152:155]
ds_read_b64_tr_b16 a[96:97], v5 offset:16384
v_mul_f32 v19, v19, v21
v_mfma_f32_16x16x32_bf16 v[152:155], a[108:111], a[36:39], v[152:155]
ds_read_b64_tr_b16 a[98:99], v5 offset:17408
v_cvt_pk_bf16_f32 v18, v18, v19
v_mfma_f32_16x16x32_bf16 v[160:163], a[108:111], a[44:47], v[160:163]
ds_read_b64_tr_b16 a[100:101], v5 offset:24576
v_lshlrev_b32 v19, 16, v18
v_mfma_f32_16x16x32_bf16 v[160:163], a[104:107], a[40:43], v[160:163]
s_add_u32 s82, s82, 1048576
ds_read_b64_tr_b16 a[102:103], v5 offset:25600
v_and_b32 v18, 0xffff0000, v18
v_mfma_f32_16x16x32_bf16 v[168:171], a[104:107], a[48:51], v[168:171]
s_xor_b32 m0, s77, 134144
buffer_load_dword a252, v1, s[60:63], s82 offen
v_mfma_f32_16x16x32_bf16 v[168:171], a[108:111], a[52:55], v[168:171]
s_xor_b32 s64, s71, 2719744
v_add_f32 v17, v17, v19
v_add_f32 v17, v17, v18
v_mfma_f32_16x16x32_bf16 v[176:179], a[108:111], a[60:63], v[176:179]
buffer_load_dwordx4 v15, s[36:39], s64 offen lds
v_mfma_f32_16x16x32_bf16 v[176:179], a[104:107], a[56:59], v[176:179]
s_waitcnt lgkmcnt(4)
ds_read_b64_tr_b16 a[104:105], v6 offset:16384
v_accvgpr_read_b32 v19, a147
v_mfma_f32_16x16x32_bf16 v[180:183], a[112:115], a[56:59], v[180:183]
ds_read_b64_tr_b16 a[106:107], v6 offset:17408
v_accvgpr_read_b32 v21, a163
v_mfma_f32_16x16x32_bf16 v[180:183], a[116:119], a[60:63], v[180:183]
ds_read_b64_tr_b16 a[108:109], v6 offset:24576
v_lshlrev_b32 v18, 16, v19
v_mfma_f32_16x16x32_bf16 v[172:175], a[116:119], a[52:55], v[172:175]
s_branch L_po3
L_pg3:
s_branch L_tr0
L_po3:
ds_read_b64_tr_b16 a[110:111], v6 offset:25600
v_and_b32 v19, 0xffff0000, v19
v_mfma_f32_16x16x32_bf16 v[172:175], a[112:115], a[48:51], v[172:175]
s_xor_b32 m0, s77, 147456
v_lshlrev_b32 v20, 16, v21
v_and_b32 v21, 0xffff0000, v21
v_mfma_f32_16x16x32_bf16 v[164:167], a[112:115], a[40:43], v[164:167]
s_xor_b32 s64, s71, 2621440
v_mul_f32 v18, v18, v20
v_mul_f32 v19, v19, v21
v_mfma_f32_16x16x32_bf16 v[164:167], a[116:119], a[44:47], v[164:167]
buffer_load_dwordx4 v14, s[40:43], s64 offen lds
v_mfma_f32_16x16x32_bf16 v[156:159], a[116:119], a[36:39], v[156:159]
v_cvt_pk_bf16_f32 v18, v18, v19
v_lshlrev_b32 v19, 16, v18
v_mfma_f32_16x16x32_bf16 v[156:159], a[112:115], a[32:35], v[156:159]
ds_read_b64_tr_b16 a[112:113], v7 offset:16384
v_and_b32 v18, 0xffff0000, v18
v_mfma_f32_16x16x32_bf16 v[24:27], a[72:75], a[32:35], v[24:27]
ds_read_b64_tr_b16 a[114:115], v7 offset:17408
v_add_f32 v17, v17, v19
v_mfma_f32_16x16x32_bf16 v[24:27], a[76:79], a[36:39], v[24:27]
ds_read_b64_tr_b16 a[116:117], v7 offset:24576
v_add_f32 v17, v17, v18
v_mfma_f32_16x16x32_bf16 v[40:43], a[76:79], a[44:47], v[40:43]
s_xor_b32 m0, s77, 148480
ds_read_b64_tr_b16 a[118:119], v7 offset:25600
v_accvgpr_read_b32 v19, a148
v_mfma_f32_16x16x32_bf16 v[40:43], a[72:75], a[40:43], v[40:43]
s_xor_b32 s64, s71, 2654208
v_accvgpr_read_b32 v21, a164
v_lshlrev_b32 v18, 16, v19
v_mfma_f32_16x16x32_bf16 v[56:59], a[72:75], a[48:51], v[56:59]
buffer_load_dwordx4 v14, s[40:43], s64 offen lds
v_mfma_f32_16x16x32_bf16 v[56:59], a[76:79], a[52:55], v[56:59]
v_and_b32 v19, 0xffff0000, v19
v_lshlrev_b32 v20, 16, v21
v_mfma_f32_16x16x32_bf16 v[72:75], a[76:79], a[60:63], v[72:75]
v_and_b32 v21, 0xffff0000, v21
v_mul_f32 v18, v18, v20
v_mfma_f32_16x16x32_bf16 v[72:75], a[72:75], a[56:59], v[72:75]
ds_read_b64_tr_b16 a[72:73], v8 offset:16384
v_mul_f32 v19, v19, v21
v_mfma_f32_16x16x32_bf16 v[136:139], a[80:83], a[56:59], v[136:139]
ds_read_b64_tr_b16 a[74:75], v8 offset:17408
v_cvt_pk_bf16_f32 v18, v18, v19
v_mfma_f32_16x16x32_bf16 v[136:139], a[84:87], a[60:63], v[136:139]
s_xor_b32 m0, s77, 149504
ds_read_b64_tr_b16 a[76:77], v8 offset:24576
v_lshlrev_b32 v19, 16, v18
v_mfma_f32_16x16x32_bf16 v[120:123], a[84:87], a[52:55], v[120:123]
s_xor_b32 s64, s71, 2686976
ds_read_b64_tr_b16 a[78:79], v8 offset:25600
v_and_b32 v18, 0xffff0000, v18
v_mfma_f32_16x16x32_bf16 v[120:123], a[80:83], a[48:51], v[120:123]
buffer_load_dwordx4 v15, s[40:43], s64 offen lds
v_mfma_f32_16x16x32_bf16 v[104:107], a[80:83], a[40:43], v[104:107]
v_add_f32 v17, v17, v19
v_add_f32 v17, v17, v18
v_mfma_f32_16x16x32_bf16 v[104:107], a[84:87], a[44:47], v[104:107]
v_accvgpr_read_b32 v19, a149
v_accvgpr_read_b32 v21, a165
v_mfma_f32_16x16x32_bf16 v[88:91], a[84:87], a[36:39], v[88:91]
v_lshlrev_b32 v18, 16, v19
v_and_b32 v19, 0xffff0000, v19
v_mfma_f32_16x16x32_bf16 v[88:91], a[80:83], a[32:35], v[88:91]
ds_read_b64_tr_b16 a[80:81], v9 offset:16384
v_lshlrev_b32 v20, 16, v21
v_mfma_f32_16x16x32_bf16 v[28:31], a[32:35], a[88:91], v[28:31]
s_xor_b32 m0, s77, 150528
ds_read_b64_tr_b16 a[82:83], v9 offset:17408
v_and_b32 v21, 0xffff0000, v21
v_mfma_f32_16x16x32_bf16 v[28:31], a[36:39], a[92:95], v[28:31]
s_xor_b32 s64, s71, 2719744
ds_read_b64_tr_b16 a[84:85], v9 offset:24576
v_mul_f32 v18, v18, v20
v_mfma_f32_16x16x32_bf16 v[44:47], a[44:47], a[92:95], v[44:47]
buffer_load_dwordx4 v15, s[40:43], s64 offen lds
v_mfma_f32_16x16x32_bf16 v[44:47], a[40:43], a[88:91], v[44:47]
ds_read_b64_tr_b16 a[86:87], v9 offset:25600
v_mul_f32 v19, v19, v21
v_mfma_f32_16x16x32_bf16 v[60:63], a[48:51], a[88:91], v[60:63]
v_cvt_pk_bf16_f32 v18, v18, v19
v_lshlrev_b32 v19, 16, v18
v_mfma_f32_16x16x32_bf16 v[60:63], a[52:55], a[92:95], v[60:63]
v_and_b32 v18, 0xffff0000, v18
v_add_f32 v17, v17, v19
v_mfma_f32_16x16x32_bf16 v[76:79], a[60:63], a[92:95], v[76:79]
s_xor_b32 m0, s84, 32768
v_add_f32 v17, v17, v18
v_accvgpr_read_b32 v19, a150
v_mfma_f32_16x16x32_bf16 v[76:79], a[56:59], a[88:91], v[76:79]
s_waitcnt lgkmcnt(4)
s_xor_b32 s64, s70, 640
ds_read_b64_tr_b16 a[88:89], v10 offset:16384
v_accvgpr_read_b32 v21, a166
v_mfma_f32_16x16x32_bf16 v[140:143], a[56:59], a[96:99], v[140:143]
buffer_load_dwordx4 v12, s[32:35], s64 offen lds
v_mfma_f32_16x16x32_bf16 v[140:143], a[60:63], a[100:103], v[140:143]
ds_read_b64_tr_b16 a[90:91], v10 offset:17408
v_lshlrev_b32 v18, 16, v19
v_mfma_f32_16x16x32_bf16 v[124:127], a[52:55], a[100:103], v[124:127]
ds_read_b64_tr_b16 a[92:93], v10 offset:24576
v_and_b32 v19, 0xffff0000, v19
v_mfma_f32_16x16x32_bf16 v[124:127], a[48:51], a[96:99], v[124:127]
s_add_u32 s81, s81, 1048576
ds_read_b64_tr_b16 a[94:95], v10 offset:25600
v_lshlrev_b32 v20, 16, v21
v_mfma_f32_16x16x32_bf16 v[108:111], a[40:43], a[96:99], v[108:111]
buffer_load_dword a252, v16, s[56:59], s81 offen
v_mfma_f32_16x16x32_bf16 v[108:111], a[44:47], a[100:103], v[108:111]
s_xor_b32 m0, s84, 33792
v_and_b32 v21, 0xffff0000, v21
v_mul_f32 v18, v18, v20
v_mfma_f32_16x16x32_bf16 v[92:95], a[36:39], a[100:103], v[92:95]
s_xor_b32 s64, s70, 8832
v_mul_f32 v19, v19, v21
v_cvt_pk_bf16_f32 v18, v18, v19
v_mfma_f32_16x16x32_bf16 v[92:95], a[32:35], a[96:99], v[92:95]
buffer_load_dwordx4 v13, s[32:35], s64 offen lds
v_mfma_f32_16x16x32_bf16 v[32:35], a[32:35], a[104:107], v[32:35]
ds_read_b64_tr_b16 a[96:97], v11 offset:16384
v_lshlrev_b32 v19, 16, v18
v_mfma_f32_16x16x32_bf16 v[32:35], a[36:39], a[108:111], v[32:35]
ds_read_b64_tr_b16 a[98:99], v11 offset:17408
v_and_b32 v18, 0xffff0000, v18
v_mfma_f32_16x16x32_bf16 v[48:51], a[44:47], a[108:111], v[48:51]
ds_read_b64_tr_b16 a[100:101], v11 offset:24576
v_add_f32 v17, v17, v19
v_mfma_f32_16x16x32_bf16 v[48:51], a[40:43], a[104:107], v[48:51]
ds_read_b64_tr_b16 a[102:103], v11 offset:25600
v_add_f32 v17, v17, v18
v_mfma_f32_16x16x32_bf16 v[64:67], a[48:51], a[104:107], v[64:67]
s_xor_b32 m0, s84, 34816
v_accvgpr_read_b32 v19, a151
v_accvgpr_read_b32 v21, a167
v_mfma_f32_16x16x32_bf16 v[64:67], a[52:55], a[108:111], v[64:67]
s_xor_b32 s64, s70, 17024
v_lshlrev_b32 v18, 16, v19
v_and_b32 v19, 0xffff0000, v19
v_mfma_f32_16x16x32_bf16 v[80:83], a[60:63], a[108:111], v[80:83]
buffer_load_dwordx4 v12, s[32:35], s64 offen lds
v_mfma_f32_16x16x32_bf16 v[80:83], a[56:59], a[104:107], v[80:83]
v_lshlrev_b32 v20, 16, v21
v_and_b32 v21, 0xffff0000, v21
v_mfma_f32_16x16x32_bf16 v[144:147], a[56:59], a[112:115], v[144:147]
v_mul_f32 v18, v18, v20
v_mul_f32 v19, v19, v21
v_mfma_f32_16x16x32_bf16 v[144:147], a[60:63], a[116:119], v[144:147]
v_cvt_pk_bf16_f32 v18, v18, v19
v_lshlrev_b32 v19, 16, v18
v_mfma_f32_16x16x32_bf16 v[128:131], a[52:55], a[116:119], v[128:131]
v_and_b32 v18, 0xffff0000, v18
v_add_f32 v17, v17, v19
v_mfma_f32_16x16x32_bf16 v[128:131], a[48:51], a[112:115], v[128:131]
s_xor_b32 m0, s84, 35840
v_add_f32 v17, v17, v18
v_accvgpr_read_b32 v19, a152
v_mfma_f32_16x16x32_bf16 v[112:115], a[40:43], a[112:115], v[112:115]
s_xor_b32 s64, s70, 25216
v_accvgpr_read_b32 v21, a168
v_lshlrev_b32 v18, 16, v19
v_mfma_f32_16x16x32_bf16 v[112:115], a[44:47], a[116:119], v[112:115]
buffer_load_dwordx4 v13, s[32:35], s64 offen lds
v_mfma_f32_16x16x32_bf16 v[96:99], a[36:39], a[116:119], v[96:99]
v_and_b32 v19, 0xffff0000, v19
v_lshlrev_b32 v20, 16, v21
v_mfma_f32_16x16x32_bf16 v[96:99], a[32:35], a[112:115], v[96:99]
v_and_b32 v21, 0xffff0000, v21
v_mul_f32 v18, v18, v20
v_mfma_f32_16x16x32_bf16 v[36:39], a[32:35], a[72:75], v[36:39]
v_mul_f32 v19, v19, v21
v_cvt_pk_bf16_f32 v18, v18, v19
v_mfma_f32_16x16x32_bf16 v[36:39], a[36:39], a[76:79], v[36:39]
s_xor_b32 m0, s84, 36864
v_lshlrev_b32 v19, 16, v18
v_and_b32 v18, 0xffff0000, v18
v_mfma_f32_16x16x32_bf16 v[52:55], a[44:47], a[76:79], v[52:55]
s_waitcnt vmcnt(24) lgkmcnt(0)
s_barrier
v_mfma_f32_16x16x32_bf16 v[52:55], a[40:43], a[72:75], v[52:55]
s_xor_b32 s64, s70, 33408
ds_read_b64_tr_b16 a[104:105], v4 offset:32768
v_add_f32 v17, v17, v19
v_mfma_f32_16x16x32_bf16 v[68:71], a[48:51], a[72:75], v[68:71]
buffer_load_dwordx4 v12, s[32:35], s64 offen lds
v_mfma_f32_16x16x32_bf16 v[68:71], a[52:55], a[76:79], v[68:71]
ds_read_b64_tr_b16 a[106:107], v4 offset:33792
v_add_f32 v17, v17, v18
v_mfma_f32_16x16x32_bf16 v[84:87], a[60:63], a[76:79], v[84:87]
ds_read_b64_tr_b16 a[108:109], v4 offset:40960
v_accvgpr_read_b32 v19, a153
v_mfma_f32_16x16x32_bf16 v[84:87], a[56:59], a[72:75], v[84:87]
ds_read_b64_tr_b16 a[110:111], v4 offset:41984
v_accvgpr_read_b32 v21, a169
v_mfma_f32_16x16x32_bf16 v[148:151], a[56:59], a[80:83], v[148:151]
s_xor_b32 m0, s84, 37888
ds_read_b64_tr_b16 a[112:113], v5 offset:32768
v_lshlrev_b32 v18, 16, v19
v_mfma_f32_16x16x32_bf16 v[148:151], a[60:63], a[84:87], v[148:151]
s_xor_b32 s64, s70, 41600
ds_read_b64_tr_b16 a[114:115], v5 offset:33792
v_and_b32 v19, 0xffff0000, v19
v_mfma_f32_16x16x32_bf16 v[132:135], a[52:55], a[84:87], v[132:135]
s_waitcnt vmcnt(15)
ds_read_b128 a[0:3], v2 offset:0
v_lshlrev_b32 v20, 16, v21
v_mfma_f32_16x16x32_bf16 v[132:135], a[48:51], a[80:83], v[132:135]
buffer_load_dwordx4 v13, s[32:35], s64 offen lds
v_mfma_f32_16x16x32_bf16 v[116:119], a[40:43], a[80:83], v[116:119]
ds_read_b128 a[4:7], v3 offset:0
v_and_b32 v21, 0xffff0000, v21
v_mfma_f32_16x16x32_bf16 v[116:119], a[44:47], a[84:87], v[116:119]
ds_read_b128 a[8:11], v2 offset:2048
v_mul_f32 v18, v18, v20
v_mfma_f32_16x16x32_bf16 v[100:103], a[36:39], a[84:87], v[100:103]
ds_read_b128 a[12:15], v3 offset:2048
v_mul_f32 v19, v19, v21
v_mfma_f32_16x16x32_bf16 v[100:103], a[32:35], a[80:83], v[100:103]
ds_read_b128 a[16:19], v2 offset:4096
v_cvt_pk_bf16_f32 v18, v18, v19
v_mfma_f32_16x16x32_bf16 v[248:251], a[32:35], a[88:91], v[248:251]
s_xor_b32 m0, s84, 38912
ds_read_b128 a[20:23], v3 offset:4096
v_lshlrev_b32 v19, 16, v18
v_mfma_f32_16x16x32_bf16 v[248:251], a[36:39], a[92:95], v[248:251]
s_xor_b32 s64, s70, 49792
ds_read_b128 a[24:27], v2 offset:6144
v_and_b32 v18, 0xffff0000, v18
v_mfma_f32_16x16x32_bf16 v[252:255], a[44:47], a[92:95], v[252:255]
buffer_load_dwordx4 v12, s[32:35], s64 offen lds
v_mfma_f32_16x16x32_bf16 v[252:255], a[40:43], a[88:91], v[252:255]
ds_read_b128 a[28:31], v3 offset:6144
v_add_f32 v17, v17, v19
v_mfma_f32_16x16x32_bf16 a[120:123], a[48:51], a[88:91], a[120:123]
ds_read_b64_tr_b16 a[116:117], v5 offset:40960
v_add_f32 v17, v17, v18
v_mfma_f32_16x16x32_bf16 a[120:123], a[52:55], a[92:95], a[120:123]
s_add_u32 s81, s81, 1048576
ds_read_b64_tr_b16 a[118:119], v5 offset:41984
v_accvgpr_read_b32 v19, a154
v_mfma_f32_16x16x32_bf16 a[124:127], a[60:63], a[92:95], a[124:127]
buffer_load_dword a252, v16, s[56:59], s81 offen
v_mfma_f32_16x16x32_bf16 a[124:127], a[56:59], a[88:91], a[124:127]
s_xor_b32 m0, s84, 39936
ds_read_b64_tr_b16 a[72:73], v6 offset:32768
v_accvgpr_read_b32 v21, a170
v_mfma_f32_16x16x32_bf16 a[128:131], a[56:59], a[96:99], a[128:131]
s_xor_b32 s64, s70, 57984
ds_read_b64_tr_b16 a[74:75], v6 offset:33792
v_lshlrev_b32 v18, 16, v19
v_mfma_f32_16x16x32_bf16 a[128:131], a[60:63], a[100:103], a[128:131]
buffer_load_dwordx4 v13, s[32:35], s64 offen lds
v_mfma_f32_16x16x32_bf16 a[132:135], a[52:55], a[100:103], a[132:135]
ds_read_b64_tr_b16 a[76:77], v6 offset:40960
v_and_b32 v19, 0xffff0000, v19
v_mfma_f32_16x16x32_bf16 a[132:135], a[48:51], a[96:99], a[132:135]
ds_read_b64_tr_b16 a[78:79], v6 offset:41984
v_lshlrev_b32 v20, 16, v21
v_mfma_f32_16x16x32_bf16 a[136:139], a[40:43], a[96:99], a[136:139]
ds_read_b64_tr_b16 a[80:81], v7 offset:32768
v_and_b32 v21, 0xffff0000, v21
v_mfma_f32_16x16x32_bf16 a[136:139], a[44:47], a[100:103], a[136:139]
ds_read_b64_tr_b16 a[82:83], v7 offset:33792
v_mul_f32 v18, v18, v20
v_mfma_f32_16x16x32_bf16 a[140:143], a[36:39], a[100:103], a[140:143]
s_xor_b32 m0, s77, 65536
ds_read_b64_tr_b16 a[84:85], v7 offset:40960
v_mul_f32 v19, v19, v21
v_mfma_f32_16x16x32_bf16 a[140:143], a[32:35], a[96:99], a[140:143]
s_waitcnt lgkmcnt(7)
s_xor_b32 s64, s71, 3145728
ds_read_b64_tr_b16 a[86:87], v7 offset:41984
v_cvt_pk_bf16_f32 v18, v18, v19
v_mfma_f32_16x16x32_bf16 v[184:187], a[104:107], a[0:3], v[184:187]
buffer_load_dwordx4 v14, s[36:39], s64 offen lds
v_mfma_f32_16x16x32_bf16 v[184:187], a[108:111], a[4:7], v[184:187]
ds_read_b64_tr_b16 a[88:89], v8 offset:32768
v_lshlrev_b32 v19, 16, v18
v_mfma_f32_16x16x32_bf16 v[192:195], a[108:111], a[12:15], v[192:195]
ds_read_b64_tr_b16 a[90:91], v8 offset:33792
v_and_b32 v18, 0xffff0000, v18
v_mfma_f32_16x16x32_bf16 v[192:195], a[104:107], a[8:11], v[192:195]
ds_read_b64_tr_b16 a[92:93], v8 offset:40960
v_add_f32 v17, v17, v19
v_mfma_f32_16x16x32_bf16 v[200:203], a[104:107], a[16:19], v[200:203]
ds_read_b64_tr_b16 a[94:95], v8 offset:41984
v_add_f32 v17, v17, v18
v_mfma_f32_16x16x32_bf16 v[200:203], a[108:111], a[20:23], v[200:203]
s_xor_b32 m0, s77, 66560
ds_read_b64_tr_b16 a[96:97], v9 offset:32768
v_accvgpr_read_b32 v19, a155
v_mfma_f32_16x16x32_bf16 v[208:211], a[108:111], a[28:31], v[208:211]
s_xor_b32 s64, s71, 3178496
ds_read_b64_tr_b16 a[98:99], v9 offset:33792
v_accvgpr_read_b32 v21, a171
v_mfma_f32_16x16x32_bf16 v[208:211], a[104:107], a[24:27], v[208:211]
buffer_load_dwordx4 v14, s[36:39], s64 offen lds
v_mfma_f32_16x16x32_bf16 v[212:215], a[112:115], a[24:27], v[212:215]
ds_read_b64_tr_b16 a[100:101], v9 offset:40960
v_lshlrev_b32 v18, 16, v19
v_mfma_f32_16x16x32_bf16 v[212:215], a[116:119], a[28:31], v[212:215]
ds_read_b64_tr_b16 a[102:103], v9 offset:41984
v_and_b32 v19, 0xffff0000, v19
v_mfma_f32_16x16x32_bf16 v[204:207], a[116:119], a[20:23], v[204:207]
ds_read_b64_tr_b16 a[104:105], v10 offset:32768
v_lshlrev_b32 v20, 16, v21
v_mfma_f32_16x16x32_bf16 v[204:207], a[112:115], a[16:19], v[204:207]
ds_read_b64_tr_b16 a[106:107], v10 offset:33792
v_and_b32 v21, 0xffff0000, v21
v_mfma_f32_16x16x32_bf16 v[196:199], a[112:115], a[8:11], v[196:199]
s_xor_b32 m0, s77, 67584
ds_read_b64_tr_b16 a[108:109], v10 offset:40960
v_mul_f32 v18, v18, v20
v_mfma_f32_16x16x32_bf16 v[196:199], a[116:119], a[12:15], v[196:199]
s_xor_b32 s64, s71, 3211264
ds_read_b64_tr_b16 a[110:111], v10 offset:41984
v_mul_f32 v19, v19, v21
v_mfma_f32_16x16x32_bf16 v[188:191], a[116:119], a[4:7], v[188:191]
buffer_load_dwordx4 v15, s[36:39], s64 offen lds
v_mfma_f32_16x16x32_bf16 v[188:191], a[112:115], a[0:3], v[188:191]
s_waitcnt lgkmcnt(7)
ds_read_b64_tr_b16 a[112:113], v11 offset:32768
v_cvt_pk_bf16_f32 v18, v18, v19
v_mfma_f32_16x16x32_bf16 v[216:219], a[72:75], a[0:3], v[216:219]
ds_read_b64_tr_b16 a[114:115], v11 offset:33792
v_lshlrev_b32 v19, 16, v18
v_mfma_f32_16x16x32_bf16 v[216:219], a[76:79], a[4:7], v[216:219]
ds_read_b64_tr_b16 a[116:117], v11 offset:40960
v_and_b32 v18, 0xffff0000, v18
v_mfma_f32_16x16x32_bf16 v[224:227], a[76:79], a[12:15], v[224:227]
s_xor_b32 m0, s77, 68608
ds_read_b64_tr_b16 a[118:119], v11 offset:41984
v_add_f32 v17, v17, v19
v_mfma_f32_16x16x32_bf16 v[224:227], a[72:75], a[8:11], v[224:227]
s_xor_b32 s64, s71, 3244032
v_add_f32 v17, v17, v18
v_accvgpr_read_b32 v19, a156
v_mfma_f32_16x16x32_bf16 v[232:235], a[72:75], a[16:19], v[232:235]
buffer_load_dwordx4 v15, s[36:39], s64 offen lds
v_mfma_f32_16x16x32_bf16 v[232:235], a[76:79], a[20:23], v[232:235]
v_accvgpr_read_b32 v21, a172
v_lshlrev_b32 v18, 16, v19
v_mfma_f32_16x16x32_bf16 v[240:243], a[76:79], a[28:31], v[240:243]
v_and_b32 v19, 0xffff0000, v19
v_lshlrev_b32 v20, 16, v21
v_mfma_f32_16x16x32_bf16 v[240:243], a[72:75], a[24:27], v[240:243]
ds_read_b64_tr_b16 a[72:73], v4 offset:49152
v_and_b32 v21, 0xffff0000, v21
v_mfma_f32_16x16x32_bf16 v[244:247], a[80:83], a[24:27], v[244:247]
ds_read_b64_tr_b16 a[74:75], v4 offset:50176
v_mul_f32 v18, v18, v20
v_mfma_f32_16x16x32_bf16 v[244:247], a[84:87], a[28:31], v[244:247]
s_xor_b32 m0, s77, 81920
ds_read_b64_tr_b16 a[76:77], v4 offset:57344
v_mul_f32 v19, v19, v21
v_mfma_f32_16x16x32_bf16 v[236:239], a[84:87], a[20:23], v[236:239]
s_xor_b32 s64, s71, 3145728
ds_read_b64_tr_b16 a[78:79], v4 offset:58368
v_cvt_pk_bf16_f32 v18, v18, v19
v_mfma_f32_16x16x32_bf16 v[236:239], a[80:83], a[16:19], v[236:239]
s_add_u32 s82, s82, 1048576
buffer_load_dwordx4 v14, s[40:43], s64 offen lds
v_mfma_f32_16x16x32_bf16 v[228:231], a[80:83], a[8:11], v[228:231]
buffer_load_dword a252, v1, s[60:63], s82 offen
v_mfma_f32_16x16x32_bf16 v[228:231], a[84:87], a[12:15], v[228:231]
v_lshlrev_b32 v19, 16, v18
v_and_b32 v18, 0xffff0000, v18
v_mfma_f32_16x16x32_bf16 v[220:223], a[84:87], a[4:7], v[220:223]
v_add_f32 v17, v17, v19
v_add_f32 v17, v17, v18
v_mfma_f32_16x16x32_bf16 v[220:223], a[80:83], a[0:3], v[220:223]
ds_read_b64_tr_b16 a[80:81], v5 offset:49152
v_accvgpr_read_b32 v19, a157
v_mfma_f32_16x16x32_bf16 v[152:155], a[88:91], a[0:3], v[152:155]
s_xor_b32 m0, s77, 82944
ds_read_b64_tr_b16 a[82:83], v5 offset:50176
v_accvgpr_read_b32 v21, a173
v_mfma_f32_16x16x32_bf16 v[152:155], a[92:95], a[4:7], v[152:155]
s_xor_b32 s64, s71, 3178496
ds_read_b64_tr_b16 a[84:85], v5 offset:57344
v_lshlrev_b32 v18, 16, v19
v_mfma_f32_16x16x32_bf16 v[160:163], a[92:95], a[12:15], v[160:163]
buffer_load_dwordx4 v14, s[40:43], s64 offen lds
v_mfma_f32_16x16x32_bf16 v[160:163], a[88:91], a[8:11], v[160:163]
ds_read_b64_tr_b16 a[86:87], v5 offset:58368
v_and_b32 v19, 0xffff0000, v19
v_mfma_f32_16x16x32_bf16 v[168:171], a[88:91], a[16:19], v[168:171]
v_lshlrev_b32 v20, 16, v21
v_and_b32 v21, 0xffff0000, v21
v_mfma_f32_16x16x32_bf16 v[168:171], a[92:95], a[20:23], v[168:171]
v_mul_f32 v18, v18, v20
v_mul_f32 v19, v19, v21
v_mfma_f32_16x16x32_bf16 v[176:179], a[92:95], a[28:31], v[176:179]
v_cvt_pk_bf16_f32 v18, v18, v19
v_lshlrev_b32 v19, 16, v18
v_mfma_f32_16x16x32_bf16 v[176:179], a[88:91], a[24:27], v[176:179]
s_waitcnt lgkmcnt(4)
s_xor_b32 m0, s77, 83968
ds_read_b64_tr_b16 a[88:89], v6 offset:49152
v_and_b32 v18, 0xffff0000, v18
v_mfma_f32_16x16x32_bf16 v[180:183], a[96:99], a[24:27], v[180:183]
s_xor_b32 s64, s71, 3211264
ds_read_b64_tr_b16 a[90:91], v6 offset:50176
v_add_f32 v17, v17, v19
v_mfma_f32_16x16x32_bf16 v[180:183], a[100:103], a[28:31], v[180:183]
buffer_load_dwordx4 v15, s[40:43], s64 offen lds
v_mfma_f32_16x16x32_bf16 v[172:175], a[100:103], a[20:23], v[172:175]
ds_read_b64_tr_b16 a[92:93], v6 offset:57344
v_add_f32 v17, v17, v18
v_mfma_f32_16x16x32_bf16 v[172:175], a[96:99], a[16:19], v[172:175]
ds_read_b64_tr_b16 a[94:95], v6 offset:58368
v_accvgpr_read_b32 v19, a158
v_mfma_f32_16x16x32_bf16 v[164:167], a[96:99], a[8:11], v[164:167]
v_accvgpr_read_b32 v21, a174
v_lshlrev_b32 v18, 16, v19
v_mfma_f32_16x16x32_bf16 v[164:167], a[100:103], a[12:15], v[164:167]
v_and_b32 v19, 0xffff0000, v19
v_lshlrev_b32 v20, 16, v21
v_mfma_f32_16x16x32_bf16 v[156:159], a[100:103], a[4:7], v[156:159]
s_xor_b32 m0, s77, 84992
v_and_b32 v21, 0xffff0000, v21
v_mul_f32 v18, v18, v20
v_mfma_f32_16x16x32_bf16 v[156:159], a[96:99], a[0:3], v[156:159]
s_xor_b32 s64, s71, 3244032
ds_read_b64_tr_b16 a[96:97], v7 offset:49152
v_mul_f32 v19, v19, v21
v_mfma_f32_16x16x32_bf16 v[24:27], a[104:107], a[0:3], v[24:27]
buffer_load_dwordx4 v15, s[40:43], s64 offen lds
v_mfma_f32_16x16x32_bf16 v[24:27], a[108:111], a[4:7], v[24:27]
ds_read_b64_tr_b16 a[98:99], v7 offset:50176
v_cvt_pk_bf16_f32 v18, v18, v19
v_mfma_f32_16x16x32_bf16 v[40:43], a[108:111], a[12:15], v[40:43]
ds_read_b64_tr_b16 a[100:101], v7 offset:57344
v_lshlrev_b32 v19, 16, v18
v_mfma_f32_16x16x32_bf16 v[40:43], a[104:107], a[8:11], v[40:43]
ds_read_b64_tr_b16 a[102:103], v7 offset:58368
v_and_b32 v18, 0xffff0000, v18
v_mfma_f32_16x16x32_bf16 v[56:59], a[104:107], a[16:19], v[56:59]
v_add_f32 v17, v17, v19
v_add_f32 v17, v17, v18
v_mfma_f32_16x16x32_bf16 v[56:59], a[108:111], a[20:23], v[56:59]
s_xor_b32 m0, s84, 0
v_accvgpr_read_b32 v19, a159
v_accvgpr_read_b32 v21, a175
v_mfma_f32_16x16x32_bf16 v[72:75], a[108:111], a[28:31], v[72:75]
s_xor_b32 s64, s70, 768
v_lshlrev_b32 v18, 16, v19
v_and_b32 v19, 0xffff0000, v19
v_mfma_f32_16x16x32_bf16 v[72:75], a[104:107], a[24:27], v[72:75]
buffer_load_dwordx4 v12, s[32:35], s64 offen lds
v_mfma_f32_16x16x32_bf16 v[136:139], a[112:115], a[24:27], v[136:139]
ds_read_b64_tr_b16 a[104:105], v8 offset:49152
v_lshlrev_b32 v20, 16, v21
v_mfma_f32_16x16x32_bf16 v[136:139], a[116:119], a[28:31], v[136:139]
ds_read_b64_tr_b16 a[106:107], v8 offset:50176
v_add_u32 v4, 0x8000, v4
v_mfma_f32_16x16x32_bf16 v[120:123], a[116:119], a[20:23], v[120:123]
ds_read_b64_tr_b16 a[108:109], v8 offset:57344
v_and_b32 v21, 0xffff0000, v21
v_mfma_f32_16x16x32_bf16 v[120:123], a[112:115], a[16:19], v[120:123]
ds_read_b64_tr_b16 a[110:111], v8 offset:58368
v_mul_f32 v18, v18, v20
v_mfma_f32_16x16x32_bf16 v[104:107], a[112:115], a[8:11], v[104:107]
s_xor_b32 m0, s84, 1024
v_mul_f32 v19, v19, v21
v_cvt_pk_bf16_f32 v18, v18, v19
v_mfma_f32_16x16x32_bf16 v[104:107], a[116:119], a[12:15], v[104:107]
s_xor_b32 s64, s70, 8960
v_lshlrev_b32 v19, 16, v18
v_and_b32 v18, 0xffff0000, v18
v_mfma_f32_16x16x32_bf16 v[88:91], a[116:119], a[4:7], v[88:91]
buffer_load_dwordx4 v13, s[32:35], s64 offen lds
v_mfma_f32_16x16x32_bf16 v[88:91], a[112:115], a[0:3], v[88:91]
ds_read_b64_tr_b16 a[112:113], v9 offset:49152
v_add_f32 v17, v17, v19
v_mfma_f32_16x16x32_bf16 v[28:31], a[0:3], a[72:75], v[28:31]
ds_read_b64_tr_b16 a[114:115], v9 offset:50176
v_add_f32 v17, v17, v18
v_mfma_f32_16x16x32_bf16 v[28:31], a[4:7], a[76:79], v[28:31]
ds_read_b64_tr_b16 a[116:117], v9 offset:57344
v_add_u32 v5, 0x8000, v5
v_mfma_f32_16x16x32_bf16 v[44:47], a[12:15], a[76:79], v[44:47]
ds_read_b64_tr_b16 a[118:119], v9 offset:58368
v_add_f32_dpp v17, v17, v17 row_ror:8 row_mask:0xf bank_mask:0xf
v_mfma_f32_16x16x32_bf16 v[44:47], a[8:11], a[72:75], v[44:47]
s_xor_b32 m0, s84, 2048
s_add_u32 s81, s81, 1048576
v_mfma_f32_16x16x32_bf16 v[60:63], a[16:19], a[72:75], v[60:63]
s_xor_b32 s64, s70, 17152
buffer_load_dword a252, v16, s[56:59], s81 offen
v_mfma_f32_16x16x32_bf16 v[60:63], a[20:23], a[76:79], v[60:63]
buffer_load_dwordx4 v12, s[32:35], s64 offen lds
v_mfma_f32_16x16x32_bf16 v[76:79], a[28:31], a[76:79], v[76:79]
v_add_f32_dpp v17, v17, v17 row_ror:4 row_mask:0xf bank_mask:0xf
v_mfma_f32_16x16x32_bf16 v[76:79], a[24:27], a[72:75], v[76:79]
s_waitcnt lgkmcnt(4)
ds_read_b64_tr_b16 a[72:73], v10 offset:49152
v_mfma_f32_16x16x32_bf16 v[140:143], a[24:27], a[80:83], v[140:143]
ds_read_b64_tr_b16 a[74:75], v10 offset:50176
v_add_f32_dpp v17, v17, v17 row_ror:2 row_mask:0xf bank_mask:0xf
v_mfma_f32_16x16x32_bf16 v[140:143], a[28:31], a[84:87], v[140:143]
ds_read_b64_tr_b16 a[76:77], v10 offset:57344
v_add_u32 v6, 0x8000, v6
v_mfma_f32_16x16x32_bf16 v[124:127], a[20:23], a[84:87], v[124:127]
s_xor_b32 m0, s84, 3072
ds_read_b64_tr_b16 a[78:79], v10 offset:58368
v_add_f32_dpp v17, v17, v17 row_ror:1 row_mask:0xf bank_mask:0xf
v_mfma_f32_16x16x32_bf16 v[124:127], a[16:19], a[80:83], v[124:127]
s_xor_b32 s64, s70, 25344
v_mov_b32 v18, v17
v_mfma_f32_16x16x32_bf16 v[108:111], a[8:11], a[80:83], v[108:111]
buffer_load_dwordx4 v13, s[32:35], s64 offen lds
v_mfma_f32_16x16x32_bf16 v[108:111], a[12:15], a[84:87], v[108:111]
v_permlane16_swap_b32 v18, v17
v_mfma_f32_16x16x32_bf16 v[92:95], a[4:7], a[84:87], v[92:95]
v_add_f32 v17, v17, v18
v_mfma_f32_16x16x32_bf16 v[92:95], a[0:3], a[80:83], v[92:95]
ds_read_b64_tr_b16 a[80:81], v11 offset:49152
v_cvt_pk_bf16_f32 v17, v17, v17
v_mfma_f32_16x16x32_bf16 v[32:35], a[0:3], a[88:91], v[32:35]
ds_read_b64_tr_b16 a[82:83], v11 offset:50176
v_and_b32 v17, 0xffff0000, v17
v_mfma_f32_16x16x32_bf16 v[32:35], a[4:7], a[92:95], v[32:35]
s_xor_b32 m0, s84, 4096
ds_read_b64_tr_b16 a[84:85], v11 offset:57344
v_add_u32 v7, 0x8000, v7
v_mfma_f32_16x16x32_bf16 v[48:51], a[12:15], a[92:95], v[48:51]
s_xor_b32 s64, s70, 33536
ds_read_b64_tr_b16 a[86:87], v11 offset:58368
v_mul_f32 v17, 0xbfb8aa3b, v17
v_mfma_f32_16x16x32_bf16 v[48:51], a[8:11], a[88:91], v[48:51]
buffer_load_dwordx4 v12, s[32:35], s64 offen lds
v_mfma_f32_16x16x32_bf16 v[64:67], a[16:19], a[88:91], v[64:67]
v_exp_f32 v17, v17
v_mfma_f32_16x16x32_bf16 v[64:67], a[20:23], a[92:95], v[64:67]
v_add_f32 v17, 1.0, v17
v_mfma_f32_16x16x32_bf16 v[80:83], a[28:31], a[92:95], v[80:83]
v_rcp_f32 v17, v17
v_mfma_f32_16x16x32_bf16 v[80:83], a[24:27], a[88:91], v[80:83]
v_cvt_pk_bf16_f32 v18, v17, v17
v_mfma_f32_16x16x32_bf16 v[144:147], a[24:27], a[96:99], v[144:147]
s_xor_b32 m0, s84, 5120
v_and_b32 v18, 0xffff0000, v18
v_mfma_f32_16x16x32_bf16 v[144:147], a[28:31], a[100:103], v[144:147]
s_xor_b32 s64, s70, 41728
v_add_u32 v8, 0x8000, v8
v_sub_f32 v19, 1.0, v18
v_mfma_f32_16x16x32_bf16 v[128:131], a[20:23], a[100:103], v[128:131]
buffer_load_dwordx4 v13, s[32:35], s64 offen lds
v_mfma_f32_16x16x32_bf16 v[128:131], a[16:19], a[96:99], v[128:131]
v_cvt_pk_bf16_f32 v19, v19, v19
v_mfma_f32_16x16x32_bf16 v[112:115], a[8:11], a[96:99], v[112:115]
v_and_b32 v19, 0xffff0000, v19
v_mfma_f32_16x16x32_bf16 v[112:115], a[12:15], a[100:103], v[112:115]
v_and_b32 v20, 31, v0
v_mfma_f32_16x16x32_bf16 v[96:99], a[4:7], a[100:103], v[96:99]
s_xor_b32 m0, s84, 6144
v_add_u32 v9, 0x8000, v9
v_add_u32 v10, 0x8000, v10
v_mfma_f32_16x16x32_bf16 v[96:99], a[0:3], a[96:99], v[96:99]
s_xor_b32 s64, s70, 49920
v_add_u32 v11, 0x8000, v11
v_lshlrev_b32 v20, 27, v20
v_mfma_f32_16x16x32_bf16 v[36:39], a[0:3], a[104:107], v[36:39]
s_branch L_po4
L_pg4:
s_branch L_tr0
L_po4:
buffer_load_dwordx4 v12, s[32:35], s64 offen lds
v_mfma_f32_16x16x32_bf16 v[36:39], a[4:7], a[108:111], v[36:39]
v_lshrrev_b32 v21, 2, v0
v_mfma_f32_16x16x32_bf16 v[52:55], a[12:15], a[108:111], v[52:55]
s_waitcnt vmcnt(27) lgkmcnt(0)
s_barrier
v_mfma_f32_16x16x32_bf16 v[52:55], a[8:11], a[104:107], v[52:55]
ds_read_b64_tr_b16 a[88:89], v4 offset:32768
v_add_u32 v20, v20, v21
v_mfma_f32_16x16x32_bf16 v[68:71], a[16:19], a[104:107], v[68:71]
ds_read_b64_tr_b16 a[90:91], v4 offset:33792
v_mfma_f32_16x16x32_bf16 v[68:71], a[20:23], a[108:111], v[68:71]
s_xor_b32 m0, s84, 7168
ds_read_b64_tr_b16 a[92:93], v4 offset:40960
v_mfma_f32_16x16x32_bf16 v[84:87], a[28:31], a[108:111], v[84:87]
s_xor_b32 s64, s70, 58112
ds_read_b64_tr_b16 a[94:95], v4 offset:41984
v_mfma_f32_16x16x32_bf16 v[84:87], a[24:27], a[104:107], v[84:87]
buffer_load_dwordx4 v13, s[32:35], s64 offen lds
v_mfma_f32_16x16x32_bf16 v[148:151], a[24:27], a[112:115], v[148:151]
ds_read_b64_tr_b16 a[96:97], v5 offset:32768
v_mfma_f32_16x16x32_bf16 v[148:151], a[28:31], a[116:119], v[148:151]
ds_read_b64_tr_b16 a[98:99], v5 offset:33792
v_mfma_f32_16x16x32_bf16 v[132:135], a[20:23], a[116:119], v[132:135]
s_waitcnt vmcnt(18)
ds_read_b128 a[32:35], v2 offset:32768
v_mfma_f32_16x16x32_bf16 v[132:135], a[16:19], a[112:115], v[132:135]
ds_read_b128 a[36:39], v3 offset:32768
v_mfma_f32_16x16x32_bf16 v[116:119], a[8:11], a[112:115], v[116:119]
s_xor_b32 m0, s77, 98304
ds_read_b128 a[40:43], v2 offset:34816
v_mfma_f32_16x16x32_bf16 v[116:119], a[12:15], a[116:119], v[116:119]
s_xor_b32 s64, s71, 3670016
ds_read_b128 a[44:47], v3 offset:34816
v_mfma_f32_16x16x32_bf16 v[100:103], a[4:7], a[116:119], v[100:103]
buffer_load_dwordx4 v14, s[36:39], s64 offen lds
v_mfma_f32_16x16x32_bf16 v[100:103], a[0:3], a[112:115], v[100:103]
ds_read_b128 a[48:51], v2 offset:36864
v_mfma_f32_16x16x32_bf16 v[248:251], a[0:3], a[72:75], v[248:251]
ds_read_b128 a[52:55], v3 offset:36864
v_mfma_f32_16x16x32_bf16 v[248:251], a[4:7], a[76:79], v[248:251]
ds_read_b128 a[56:59], v2 offset:38912
v_mfma_f32_16x16x32_bf16 v[252:255], a[12:15], a[76:79], v[252:255]
s_add_u32 s82, s82, 1048576
ds_read_b128 a[60:63], v3 offset:38912
v_mfma_f32_16x16x32_bf16 v[252:255], a[8:11], a[72:75], v[252:255]
s_xor_b32 m0, s77, 99328
buffer_load_dword a252, v1, s[60:63], s82 offen
v_mfma_f32_16x16x32_bf16 a[120:123], a[16:19], a[72:75], a[120:123]
s_xor_b32 s64, s71, 3702784
ds_read_b64_tr_b16 a[100:101], v5 offset:40960
v_mfma_f32_16x16x32_bf16 a[120:123], a[20:23], a[76:79], a[120:123]
buffer_load_dwordx4 v14, s[36:39], s64 offen lds
v_mfma_f32_16x16x32_bf16 a[124:127], a[28:31], a[76:79], a[124:127]
ds_read_b64_tr_b16 a[102:103], v5 offset:41984
v_mfma_f32_16x16x32_bf16 a[124:127], a[24:27], a[72:75], a[124:127]
ds_read_b64_tr_b16 a[104:105], v6 offset:32768
v_mfma_f32_16x16x32_bf16 a[128:131], a[24:27], a[80:83], a[128:131]
ds_read_b64_tr_b16 a[106:107], v6 offset:33792
v_mfma_f32_16x16x32_bf16 a[128:131], a[28:31], a[84:87], a[128:131]
ds_read_b64_tr_b16 a[108:109], v6 offset:40960
v_mfma_f32_16x16x32_bf16 a[132:135], a[20:23], a[84:87], a[132:135]
s_xor_b32 m0, s77, 100352
ds_read_b64_tr_b16 a[110:111], v6 offset:41984
v_mfma_f32_16x16x32_bf16 a[132:135], a[16:19], a[80:83], a[132:135]
s_xor_b32 s64, s71, 3735552
ds_read_b64_tr_b16 a[112:113], v7 offset:32768
v_mfma_f32_16x16x32_bf16 a[136:139], a[8:11], a[80:83], a[136:139]
buffer_load_dwordx4 v15, s[36:39], s64 offen lds
v_mfma_f32_16x16x32_bf16 a[136:139], a[12:15], a[84:87], a[136:139]
ds_read_b64_tr_b16 a[114:115], v7 offset:33792
v_mfma_f32_16x16x32_bf16 a[140:143], a[4:7], a[84:87], a[140:143]
ds_read_b64_tr_b16 a[116:117], v7 offset:40960
v_mfma_f32_16x16x32_bf16 a[140:143], a[0:3], a[80:83], a[140:143]
s_waitcnt lgkmcnt(8)
ds_read_b64_tr_b16 a[118:119], v7 offset:41984
v_mfma_f32_16x16x32_bf16 v[184:187], a[88:91], a[32:35], v[184:187]
ds_read_b64_tr_b16 a[72:73], v8 offset:32768
v_mfma_f32_16x16x32_bf16 v[184:187], a[92:95], a[36:39], v[184:187]
s_xor_b32 m0, s77, 101376
ds_read_b64_tr_b16 a[74:75], v8 offset:33792
v_mfma_f32_16x16x32_bf16 v[192:195], a[92:95], a[44:47], v[192:195]
s_xor_b32 s64, s71, 3768320
ds_read_b64_tr_b16 a[76:77], v8 offset:40960
v_mfma_f32_16x16x32_bf16 v[192:195], a[88:91], a[40:43], v[192:195]
buffer_load_dwordx4 v15, s[36:39], s64 offen lds
v_mfma_f32_16x16x32_bf16 v[200:203], a[88:91], a[48:51], v[200:203]
ds_read_b64_tr_b16 a[78:79], v8 offset:41984
v_mfma_f32_16x16x32_bf16 v[200:203], a[92:95], a[52:55], v[200:203]
ds_read_b64_tr_b16 a[80:81], v9 offset:32768
v_mfma_f32_16x16x32_bf16 v[208:211], a[92:95], a[60:63], v[208:211]
ds_read_b64_tr_b16 a[82:83], v9 offset:33792
v_mfma_f32_16x16x32_bf16 v[208:211], a[88:91], a[56:59], v[208:211]
ds_read_b64_tr_b16 a[84:85], v9 offset:40960
v_mfma_f32_16x16x32_bf16 v[212:215], a[96:99], a[56:59], v[212:215]
s_waitcnt lgkmcnt(8)
s_xor_b32 m0, s77, 114688
ds_read_b64_tr_b16 a[86:87], v9 offset:41984
v_mfma_f32_16x16x32_bf16 v[212:215], a[100:103], a[60:63], v[212:215]
s_xor_b32 s64, s71, 3670016
ds_read_b64_tr_b16 a[88:89], v10 offset:32768
v_mfma_f32_16x16x32_bf16 v[204:207], a[100:103], a[52:55], v[204:207]
buffer_load_dwordx4 v14, s[40:43], s64 offen lds
v_mfma_f32_16x16x32_bf16 v[204:207], a[96:99], a[48:51], v[204:207]
ds_read_b64_tr_b16 a[90:91], v10 offset:33792
v_mfma_f32_16x16x32_bf16 v[196:199], a[96:99], a[40:43], v[196:199]
s_lshl2_add_u32 s65, s2, s30
ds_read_b64_tr_b16 a[92:93], v10 offset:40960
v_mfma_f32_16x16x32_bf16 v[196:199], a[100:103], a[44:47], v[196:199]
s_lshl4_add_u32 s65, s65, 58720256
ds_read_b64_tr_b16 a[94:95], v10 offset:41984
v_mfma_f32_16x16x32_bf16 v[188:191], a[100:103], a[36:39], v[188:191]
buffer_store_dwordx2 v[18:19], v20, s[44:47], s65 offen sc1
v_mfma_f32_16x16x32_bf16 v[188:191], a[96:99], a[32:35], v[188:191]
s_xor_b32 m0, s77, 115712
ds_read_b64_tr_b16 a[96:97], v11 offset:32768
v_lshrrev_b32 v21, 4, v0
v_mfma_f32_16x16x32_bf16 v[216:219], a[104:107], a[32:35], v[216:219]
s_xor_b32 s64, s71, 3702784
ds_read_b64_tr_b16 a[98:99], v11 offset:33792
v_bfe_u32 v19, v0, 2, 2
v_mfma_f32_16x16x32_bf16 v[216:219], a[108:111], a[36:39], v[216:219]
buffer_load_dwordx4 v14, s[40:43], s64 offen lds
v_mfma_f32_16x16x32_bf16 v[224:227], a[108:111], a[44:47], v[224:227]
ds_read_b64_tr_b16 a[100:101], v11 offset:40960
v_lshl_add_u32 v19, v21, 3, v19
v_mfma_f32_16x16x32_bf16 v[224:227], a[104:107], a[40:43], v[224:227]
s_add_u32 s81, s81, 1048576
ds_read_b64_tr_b16 a[102:103], v11 offset:41984
v_lshlrev_b32 v19, 6, v19
v_mfma_f32_16x16x32_bf16 v[232:235], a[104:107], a[48:51], v[232:235]
buffer_load_dword a252, v16, s[56:59], s81 offen
v_mfma_f32_16x16x32_bf16 v[232:235], a[108:111], a[52:55], v[232:235]
v_and_b32 v21, 1, v21
v_mfma_f32_16x16x32_bf16 v[240:243], a[108:111], a[60:63], v[240:243]
s_xor_b32 m0, s77, 116736
v_lshl_add_u32 v19, v21, 5, v19
v_mfma_f32_16x16x32_bf16 v[240:243], a[104:107], a[56:59], v[240:243]
s_xor_b32 s64, s71, 3735552
ds_read_b64_tr_b16 a[104:105], v4 offset:49152
v_and_b32 v21, 3, v0
v_mfma_f32_16x16x32_bf16 v[244:247], a[112:115], a[56:59], v[244:247]
s_waitcnt lgkmcnt(5)
buffer_load_dwordx4 v15, s[40:43], s64 offen lds
v_mfma_f32_16x16x32_bf16 v[244:247], a[116:119], a[60:63], v[244:247]
ds_read_b64_tr_b16 a[106:107], v4 offset:50176
v_lshl_add_u32 v19, v21, 3, v19
v_mfma_f32_16x16x32_bf16 v[236:239], a[116:119], a[52:55], v[236:239]
ds_read_b64_tr_b16 a[108:109], v4 offset:57344
v_add_u32 v19, 114688, v19
v_mfma_f32_16x16x32_bf16 v[236:239], a[112:115], a[48:51], v[236:239]
ds_read_b64_tr_b16 a[110:111], v4 offset:58368
v_xor_b32 v20, 32, v19
v_mfma_f32_16x16x32_bf16 v[228:231], a[112:115], a[40:43], v[228:231]
v_mfma_f32_16x16x32_bf16 v[228:231], a[116:119], a[44:47], v[228:231]
s_xor_b32 m0, s77, 117760
v_mfma_f32_16x16x32_bf16 v[220:223], a[116:119], a[36:39], v[220:223]
s_xor_b32 s64, s71, 3768320
v_mfma_f32_16x16x32_bf16 v[220:223], a[112:115], a[32:35], v[220:223]
buffer_load_dwordx4 v15, s[40:43], s64 offen lds
v_mfma_f32_16x16x32_bf16 v[152:155], a[72:75], a[32:35], v[152:155]
ds_read_b64_tr_b16 a[112:113], v5 offset:49152
v_mfma_f32_16x16x32_bf16 v[152:155], a[76:79], a[36:39], v[152:155]
ds_read_b64_tr_b16 a[114:115], v5 offset:50176
v_mfma_f32_16x16x32_bf16 v[160:163], a[76:79], a[44:47], v[160:163]
ds_read_b64_tr_b16 a[116:117], v5 offset:57344
v_mfma_f32_16x16x32_bf16 v[160:163], a[72:75], a[40:43], v[160:163]
ds_read_b64_tr_b16 a[118:119], v5 offset:58368
v_mfma_f32_16x16x32_bf16 v[168:171], a[72:75], a[48:51], v[168:171]
v_mfma_f32_16x16x32_bf16 v[168:171], a[76:79], a[52:55], v[168:171]
v_mfma_f32_16x16x32_bf16 v[176:179], a[76:79], a[60:63], v[176:179]
s_xor_b32 m0, s84, 32768
v_mfma_f32_16x16x32_bf16 v[176:179], a[72:75], a[56:59], v[176:179]
s_xor_b32 s64, s70, 896
ds_read_b64_tr_b16 a[72:73], v6 offset:49152
v_mfma_f32_16x16x32_bf16 v[180:183], a[80:83], a[56:59], v[180:183]
buffer_load_dwordx4 v12, s[32:35], s64 offen lds
v_mfma_f32_16x16x32_bf16 v[180:183], a[84:87], a[60:63], v[180:183]
ds_read_b64_tr_b16 a[74:75], v6 offset:50176
v_mfma_f32_16x16x32_bf16 v[172:175], a[84:87], a[52:55], v[172:175]
ds_read_b64_tr_b16 a[76:77], v6 offset:57344
v_mfma_f32_16x16x32_bf16 v[172:175], a[80:83], a[48:51], v[172:175]
ds_read_b64_tr_b16 a[78:79], v6 offset:58368
v_mfma_f32_16x16x32_bf16 v[164:167], a[80:83], a[40:43], v[164:167]
v_mfma_f32_16x16x32_bf16 v[164:167], a[84:87], a[44:47], v[164:167]
s_xor_b32 m0, s84, 33792
v_mfma_f32_16x16x32_bf16 v[156:159], a[84:87], a[36:39], v[156:159]
s_xor_b32 s64, s70, 9088
v_mfma_f32_16x16x32_bf16 v[156:159], a[80:83], a[32:35], v[156:159]
buffer_load_dwordx4 v13, s[32:35], s64 offen lds
v_mfma_f32_16x16x32_bf16 v[24:27], a[88:91], a[32:35], v[24:27]
ds_read_b64_tr_b16 a[80:81], v7 offset:49152
v_mfma_f32_16x16x32_bf16 v[24:27], a[92:95], a[36:39], v[24:27]
ds_read_b64_tr_b16 a[82:83], v7 offset:50176
v_mfma_f32_16x16x32_bf16 v[40:43], a[92:95], a[44:47], v[40:43]
ds_read_b64_tr_b16 a[84:85], v7 offset:57344
v_mfma_f32_16x16x32_bf16 v[40:43], a[88:91], a[40:43], v[40:43]
ds_read_b64_tr_b16 a[86:87], v7 offset:58368
v_mfma_f32_16x16x32_bf16 v[56:59], a[88:91], a[48:51], v[56:59]
s_xor_b32 m0, s84, 34816
v_mfma_f32_16x16x32_bf16 v[56:59], a[92:95], a[52:55], v[56:59]
s_xor_b32 s64, s70, 17280
v_mfma_f32_16x16x32_bf16 v[72:75], a[92:95], a[60:63], v[72:75]
s_waitcnt vmcnt(13)
buffer_load_dwordx4 v12, s[32:35], s64 offen lds
v_mfma_f32_16x16x32_bf16 v[72:75], a[88:91], a[56:59], v[72:75]
s_waitcnt lgkmcnt(4)
ds_read_b64_tr_b16 a[88:89], v8 offset:49152
v_mfma_f32_16x16x32_bf16 v[136:139], a[96:99], a[56:59], v[136:139]
ds_read_b64_tr_b16 a[90:91], v8 offset:50176
v_mfma_f32_16x16x32_bf16 v[136:139], a[100:103], a[60:63], v[136:139]
ds_read_b64_tr_b16 a[92:93], v8 offset:57344
v_subrev_u32 v4, 0x8000, v4
v_mfma_f32_16x16x32_bf16 v[120:123], a[100:103], a[52:55], v[120:123]
ds_read_b64_tr_b16 a[94:95], v8 offset:58368
v_mfma_f32_16x16x32_bf16 v[120:123], a[96:99], a[48:51], v[120:123]
s_xor_b32 m0, s84, 35840
s_add_u32 s81, s81, 1048576
ds_read_b128 a[0:3], v2 offset:0
v_mfma_f32_16x16x32_bf16 v[104:107], a[96:99], a[40:43], v[104:107]
s_xor_b32 s64, s70, 25472
buffer_load_dword a252, v16, s[56:59], s81 offen
v_mfma_f32_16x16x32_bf16 v[104:107], a[100:103], a[44:47], v[104:107]
buffer_load_dwordx4 v13, s[32:35], s64 offen lds
v_mfma_f32_16x16x32_bf16 v[88:91], a[100:103], a[36:39], v[88:91]
ds_read_b128 a[4:7], v3 offset:0
v_mfma_f32_16x16x32_bf16 v[88:91], a[96:99], a[32:35], v[88:91]
ds_read_b128 a[8:11], v2 offset:2048
v_mfma_f32_16x16x32_bf16 v[28:31], a[32:35], a[104:107], v[28:31]
ds_read_b128 a[12:15], v3 offset:2048
v_mfma_f32_16x16x32_bf16 v[28:31], a[36:39], a[108:111], v[28:31]
ds_read_b128 a[16:19], v2 offset:4096
v_subrev_u32 v5, 0x8000, v5
v_mfma_f32_16x16x32_bf16 v[44:47], a[44:47], a[108:111], v[44:47]
s_xor_b32 m0, s84, 36864
ds_read_b128 a[20:23], v3 offset:4096
v_mfma_f32_16x16x32_bf16 v[44:47], a[40:43], a[104:107], v[44:47]
s_xor_b32 s64, s70, 33664
ds_read_b128 a[24:27], v2 offset:6144
v_mfma_f32_16x16x32_bf16 v[60:63], a[48:51], a[104:107], v[60:63]
buffer_load_dwordx4 v12, s[32:35], s64 offen lds
v_mfma_f32_16x16x32_bf16 v[60:63], a[52:55], a[108:111], v[60:63]
ds_read_b128 a[28:31], v3 offset:6144
v_mfma_f32_16x16x32_bf16 v[76:79], a[60:63], a[108:111], v[76:79]
ds_read_b64_tr_b16 a[96:97], v9 offset:49152
v_mfma_f32_16x16x32_bf16 v[76:79], a[56:59], a[104:107], v[76:79]
ds_read_b64_tr_b16 a[98:99], v9 offset:50176
v_mfma_f32_16x16x32_bf16 v[140:143], a[56:59], a[112:115], v[140:143]
ds_read_b64_tr_b16 a[100:101], v9 offset:57344
v_mfma_f32_16x16x32_bf16 v[140:143], a[60:63], a[116:119], v[140:143]
s_xor_b32 m0, s84, 37888
ds_read_b64_tr_b16 a[102:103], v9 offset:58368
v_subrev_u32 v6, 0x8000, v6
v_mfma_f32_16x16x32_bf16 v[124:127], a[52:55], a[116:119], v[124:127]
s_xor_b32 s64, s70, 41856
ds_read_b64_tr_b16 a[104:105], v10 offset:49152
v_mfma_f32_16x16x32_bf16 v[124:127], a[48:51], a[112:115], v[124:127]
buffer_load_dwordx4 v13, s[32:35], s64 offen lds
v_mfma_f32_16x16x32_bf16 v[108:111], a[40:43], a[112:115], v[108:111]
ds_read_b64_tr_b16 a[106:107], v10 offset:50176
v_mfma_f32_16x16x32_bf16 v[108:111], a[44:47], a[116:119], v[108:111]
ds_read_b64_tr_b16 a[108:109], v10 offset:57344
v_mfma_f32_16x16x32_bf16 v[92:95], a[36:39], a[116:119], v[92:95]
ds_read_b64_tr_b16 a[110:111], v10 offset:58368
v_mfma_f32_16x16x32_bf16 v[92:95], a[32:35], a[112:115], v[92:95]
ds_read_b64_tr_b16 a[112:113], v11 offset:49152
v_mfma_f32_16x16x32_bf16 v[32:35], a[32:35], a[72:75], v[32:35]
s_xor_b32 m0, s84, 38912
ds_read_b64_tr_b16 a[114:115], v11 offset:50176
v_mfma_f32_16x16x32_bf16 v[32:35], a[36:39], a[76:79], v[32:35]
s_xor_b32 s64, s70, 50048
ds_read_b64_tr_b16 a[116:117], v11 offset:57344
v_subrev_u32 v7, 0x8000, v7
v_mfma_f32_16x16x32_bf16 v[48:51], a[44:47], a[76:79], v[48:51]
buffer_load_dwordx4 v12, s[32:35], s64 offen lds
v_mfma_f32_16x16x32_bf16 v[48:51], a[40:43], a[72:75], v[48:51]
ds_read_b64_tr_b16 a[118:119], v11 offset:58368
v_mfma_f32_16x16x32_bf16 v[64:67], a[48:51], a[72:75], v[64:67]
v_mfma_f32_16x16x32_bf16 v[64:67], a[52:55], a[76:79], v[64:67]
v_mfma_f32_16x16x32_bf16 v[80:83], a[60:63], a[76:79], v[80:83]
v_mfma_f32_16x16x32_bf16 v[80:83], a[56:59], a[72:75], v[80:83]
s_waitcnt lgkmcnt(5)
s_xor_b32 m0, s84, 39936
v_mfma_f32_16x16x32_bf16 v[144:147], a[56:59], a[80:83], v[144:147]
s_xor_b32 s64, s70, 58240
v_mfma_f32_16x16x32_bf16 v[144:147], a[60:63], a[84:87], v[144:147]
buffer_load_dwordx4 v13, s[32:35], s64 offen lds
v_mfma_f32_16x16x32_bf16 v[128:131], a[52:55], a[84:87], v[128:131]
v_subrev_u32 v8, 0x8000, v8
v_mfma_f32_16x16x32_bf16 v[128:131], a[48:51], a[80:83], v[128:131]
v_mfma_f32_16x16x32_bf16 v[112:115], a[40:43], a[80:83], v[112:115]
v_mfma_f32_16x16x32_bf16 v[112:115], a[44:47], a[84:87], v[112:115]
v_mfma_f32_16x16x32_bf16 v[96:99], a[36:39], a[84:87], v[96:99]
s_and_b32 s77, s77, 0x3fff
v_subrev_u32 v9, 0x8000, v9
v_subrev_u32 v10, 0x8000, v10
v_mfma_f32_16x16x32_bf16 v[96:99], a[32:35], a[80:83], v[96:99]
v_subrev_u32 v11, 0x8000, v11
v_mfma_f32_16x16x32_bf16 v[36:39], a[32:35], a[88:91], v[36:39]
v_mfma_f32_16x16x32_bf16 v[36:39], a[36:39], a[92:95], v[36:39]
v_mfma_f32_16x16x32_bf16 v[52:55], a[44:47], a[92:95], v[52:55]
s_waitcnt lgkmcnt(0)
s_barrier
v_mfma_f32_16x16x32_bf16 v[52:55], a[40:43], a[88:91], v[52:55]
s_xor_b32 m0, s77, 131072
s_add_u32 s82, s82, 1048576
ds_read_b64_tr_b16 a[72:73], v4 offset:0
v_mfma_f32_16x16x32_bf16 v[68:71], a[48:51], a[88:91], v[68:71]
s_xor_b32 s64, s71, 0
buffer_load_dword a252, v1, s[60:63], s82 offen
v_mfma_f32_16x16x32_bf16 v[68:71], a[52:55], a[92:95], v[68:71]
buffer_load_dwordx4 v14, s[56:59], s64 offen lds
v_mfma_f32_16x16x32_bf16 v[84:87], a[60:63], a[92:95], v[84:87]
ds_read_b64_tr_b16 a[74:75], v4 offset:1024
v_mfma_f32_16x16x32_bf16 v[84:87], a[56:59], a[88:91], v[84:87]
ds_read_b64_tr_b16 a[76:77], v4 offset:8192
v_mfma_f32_16x16x32_bf16 v[148:151], a[56:59], a[96:99], v[148:151]
ds_read_b64_tr_b16 a[78:79], v4 offset:9216
v_lshrrev_b32 v13, 3, v0
v_mfma_f32_16x16x32_bf16 v[148:151], a[60:63], a[100:103], v[148:151]
ds_read_b64_tr_b16 a[80:81], v5 offset:0
v_lshl_add_u32 v12, v13, 10, v12
v_mfma_f32_16x16x32_bf16 v[132:135], a[52:55], a[100:103], v[132:135]
ds_read_b64_tr_b16 a[82:83], v5 offset:1024
v_xor_b32 v13, 64, v12
v_mfma_f32_16x16x32_bf16 v[132:135], a[48:51], a[96:99], v[132:135]
ds_read_b64_tr_b16 a[84:85], v5 offset:8192
v_mfma_f32_16x16x32_bf16 v[116:119], a[40:43], a[96:99], v[116:119]
s_add_u32 m0, s78, 147456
ds_read_b64_tr_b16 a[86:87], v5 offset:9216
v_mfma_f32_16x16x32_bf16 v[116:119], a[44:47], a[100:103], v[116:119]
s_add_u32 s64, s75, 0
ds_read_b64_tr_b16 a[88:89], v6 offset:0
v_mfma_f32_16x16x32_bf16 v[100:103], a[36:39], a[100:103], v[100:103]
buffer_load_dwordx4 v23, s[60:63], s64 offen lds
v_mfma_f32_16x16x32_bf16 v[100:103], a[32:35], a[96:99], v[100:103]
ds_read_b64_tr_b16 a[90:91], v6 offset:1024
v_mfma_f32_16x16x32_bf16 v[248:251], a[32:35], a[104:107], v[248:251]
ds_read_b64_tr_b16 a[92:93], v6 offset:8192
v_mfma_f32_16x16x32_bf16 v[248:251], a[36:39], a[108:111], v[248:251]
ds_read_b64_tr_b16 a[94:95], v6 offset:9216
v_mfma_f32_16x16x32_bf16 v[252:255], a[44:47], a[108:111], v[252:255]
ds_read_b64_tr_b16 a[96:97], v7 offset:0
v_mfma_f32_16x16x32_bf16 v[252:255], a[40:43], a[104:107], v[252:255]
ds_read_b64_tr_b16 a[98:99], v7 offset:1024
v_mfma_f32_16x16x32_bf16 a[120:123], a[48:51], a[104:107], a[120:123]
ds_read_b64_tr_b16 a[100:101], v7 offset:8192
v_mfma_f32_16x16x32_bf16 a[120:123], a[52:55], a[108:111], a[120:123]
s_xor_b32 m0, s77, 132096
ds_read_b64_tr_b16 a[102:103], v7 offset:9216
v_mfma_f32_16x16x32_bf16 a[124:127], a[60:63], a[108:111], a[124:127]
s_xor_b32 s64, s71, 32768
v_mfma_f32_16x16x32_bf16 a[124:127], a[56:59], a[104:107], a[124:127]
buffer_load_dwordx4 v14, s[56:59], s64 offen lds
v_mfma_f32_16x16x32_bf16 a[128:131], a[56:59], a[112:115], a[128:131]
ds_read_b64_tr_b16 a[104:105], v8 offset:0
v_mfma_f32_16x16x32_bf16 a[128:131], a[60:63], a[116:119], a[128:131]
ds_read_b64_tr_b16 a[106:107], v8 offset:1024
v_mfma_f32_16x16x32_bf16 a[132:135], a[52:55], a[116:119], a[132:135]
ds_read_b64_tr_b16 a[108:109], v8 offset:8192
v_mfma_f32_16x16x32_bf16 a[132:135], a[48:51], a[112:115], a[132:135]
ds_read_b64_tr_b16 a[110:111], v8 offset:9216
v_mfma_f32_16x16x32_bf16 a[136:139], a[40:43], a[112:115], a[136:139]
v_mfma_f32_16x16x32_bf16 a[136:139], a[44:47], a[116:119], a[136:139]
v_mfma_f32_16x16x32_bf16 a[140:143], a[36:39], a[116:119], a[140:143]
s_add_u32 m0, s78, 151552
v_mfma_f32_16x16x32_bf16 a[140:143], a[32:35], a[112:115], a[140:143]
s_waitcnt lgkmcnt(4)
s_add_u32 s64, s75, 2048
ds_read_b64_tr_b16 a[112:113], v9 offset:0
v_mfma_f32_16x16x32_bf16 v[184:187], a[72:75], a[0:3], v[184:187]
buffer_load_dwordx4 v23, s[60:63], s64 offen lds
v_mfma_f32_16x16x32_bf16 v[184:187], a[76:79], a[4:7], v[184:187]
ds_read_b64_tr_b16 a[114:115], v9 offset:1024
v_mfma_f32_16x16x32_bf16 v[192:195], a[76:79], a[12:15], v[192:195]
ds_read_b64_tr_b16 a[116:117], v9 offset:8192
v_mfma_f32_16x16x32_bf16 v[192:195], a[72:75], a[8:11], v[192:195]
ds_read_b64_tr_b16 a[118:119], v9 offset:9216
v_mfma_f32_16x16x32_bf16 v[200:203], a[72:75], a[16:19], v[200:203]
v_mfma_f32_16x16x32_bf16 v[200:203], a[76:79], a[20:23], v[200:203]
v_mfma_f32_16x16x32_bf16 v[208:211], a[76:79], a[28:31], v[208:211]
v_mfma_f32_16x16x32_bf16 v[208:211], a[72:75], a[24:27], v[208:211]
ds_read_b64_tr_b16 a[72:73], v10 offset:0
v_mfma_f32_16x16x32_bf16 v[212:215], a[80:83], a[24:27], v[212:215]
s_xor_b32 m0, s77, 133120
ds_read_b64_tr_b16 a[74:75], v10 offset:1024
v_mfma_f32_16x16x32_bf16 v[212:215], a[84:87], a[28:31], v[212:215]
s_xor_b32 s64, s71, 65536
ds_read_b64_tr_b16 a[76:77], v10 offset:8192
v_mfma_f32_16x16x32_bf16 v[204:207], a[84:87], a[20:23], v[204:207]
buffer_load_dwordx4 v15, s[56:59], s64 offen lds
v_mfma_f32_16x16x32_bf16 v[204:207], a[80:83], a[16:19], v[204:207]
s_add_u32 s81, s81, 1048576
ds_read_b64_tr_b16 a[78:79], v10 offset:9216
v_mfma_f32_16x16x32_bf16 v[196:199], a[80:83], a[8:11], v[196:199]
buffer_load_dword a252, v16, s[56:59], s81 offen
v_mfma_f32_16x16x32_bf16 v[196:199], a[84:87], a[12:15], v[196:199]
v_mfma_f32_16x16x32_bf16 v[188:191], a[84:87], a[4:7], v[188:191]
v_mfma_f32_16x16x32_bf16 v[188:191], a[80:83], a[0:3], v[188:191]
ds_read_b64_tr_b16 a[80:81], v11 offset:0
v_mfma_f32_16x16x32_bf16 v[216:219], a[88:91], a[0:3], v[216:219]
ds_read_b64_tr_b16 a[82:83], v11 offset:1024
v_mfma_f32_16x16x32_bf16 v[216:219], a[92:95], a[4:7], v[216:219]
s_add_u32 m0, s78, 155648
ds_read_b64_tr_b16 a[84:85], v11 offset:8192
v_mfma_f32_16x16x32_bf16 v[224:227], a[92:95], a[12:15], v[224:227]
s_add_u32 s64, s75, 4096
ds_read_b64_tr_b16 a[86:87], v11 offset:9216
v_mfma_f32_16x16x32_bf16 v[224:227], a[88:91], a[8:11], v[224:227]
buffer_load_dwordx4 v23, s[60:63], s64 offen lds
v_mfma_f32_16x16x32_bf16 v[232:235], a[88:91], a[16:19], v[232:235]
v_mfma_f32_16x16x32_bf16 v[232:235], a[92:95], a[20:23], v[232:235]
v_mfma_f32_16x16x32_bf16 v[240:243], a[92:95], a[28:31], v[240:243]
v_mfma_f32_16x16x32_bf16 v[240:243], a[88:91], a[24:27], v[240:243]
ds_read_b64_tr_b16 a[88:89], v4 offset:16384
v_mfma_f32_16x16x32_bf16 v[244:247], a[96:99], a[24:27], v[244:247]
ds_read_b64_tr_b16 a[90:91], v4 offset:17408
v_mfma_f32_16x16x32_bf16 v[244:247], a[100:103], a[28:31], v[244:247]
ds_read_b64_tr_b16 a[92:93], v4 offset:24576
v_mfma_f32_16x16x32_bf16 v[236:239], a[100:103], a[20:23], v[236:239]
s_xor_b32 m0, s77, 134144
ds_read_b64_tr_b16 a[94:95], v4 offset:25600
v_mfma_f32_16x16x32_bf16 v[236:239], a[96:99], a[16:19], v[236:239]
s_xor_b32 s64, s71, 98304
v_mfma_f32_16x16x32_bf16 v[228:231], a[96:99], a[8:11], v[228:231]
buffer_load_dwordx4 v15, s[56:59], s64 offen lds
v_mfma_f32_16x16x32_bf16 v[228:231], a[100:103], a[12:15], v[228:231]
v_mfma_f32_16x16x32_bf16 v[220:223], a[100:103], a[4:7], v[220:223]
v_mfma_f32_16x16x32_bf16 v[220:223], a[96:99], a[0:3], v[220:223]
s_waitcnt lgkmcnt(4)
ds_read_b64_tr_b16 a[96:97], v5 offset:16384
v_mfma_f32_16x16x32_bf16 v[152:155], a[104:107], a[0:3], v[152:155]
ds_read_b64_tr_b16 a[98:99], v5 offset:17408
v_mfma_f32_16x16x32_bf16 v[152:155], a[108:111], a[4:7], v[152:155]
ds_read_b64_tr_b16 a[100:101], v5 offset:24576
v_mfma_f32_16x16x32_bf16 v[160:163], a[108:111], a[12:15], v[160:163]
ds_read_b64_tr_b16 a[102:103], v5 offset:25600
v_mfma_f32_16x16x32_bf16 v[160:163], a[104:107], a[8:11], v[160:163]
v_mfma_f32_16x16x32_bf16 v[168:171], a[104:107], a[16:19], v[168:171]
v_mfma_f32_16x16x32_bf16 v[168:171], a[108:111], a[20:23], v[168:171]
v_mfma_f32_16x16x32_bf16 v[176:179], a[108:111], a[28:31], v[176:179]
s_xor_b32 m0, s84, 0
v_mfma_f32_16x16x32_bf16 v[176:179], a[104:107], a[24:27], v[176:179]
s_xor_b32 s64, s72, 0
ds_read_b64_tr_b16 a[104:105], v6 offset:16384
v_mfma_f32_16x16x32_bf16 v[180:183], a[112:115], a[24:27], v[180:183]
buffer_load_dwordx4 v12, s[48:51], s64 offen lds
v_mfma_f32_16x16x32_bf16 v[180:183], a[116:119], a[28:31], v[180:183]
ds_read_b64_tr_b16 a[106:107], v6 offset:17408
v_mfma_f32_16x16x32_bf16 v[172:175], a[116:119], a[20:23], v[172:175]
ds_read_b64_tr_b16 a[108:109], v6 offset:24576
v_mfma_f32_16x16x32_bf16 v[172:175], a[112:115], a[16:19], v[172:175]
ds_read_b64_tr_b16 a[110:111], v6 offset:25600
v_mfma_f32_16x16x32_bf16 v[164:167], a[112:115], a[8:11], v[164:167]
v_mfma_f32_16x16x32_bf16 v[164:167], a[116:119], a[12:15], v[164:167]
s_xor_b32 m0, s84, 1024
v_mfma_f32_16x16x32_bf16 v[156:159], a[116:119], a[4:7], v[156:159]
s_xor_b32 s64, s72, 16384
v_mfma_f32_16x16x32_bf16 v[156:159], a[112:115], a[0:3], v[156:159]
buffer_load_dwordx4 v13, s[48:51], s64 offen lds
v_mfma_f32_16x16x32_bf16 v[24:27], a[72:75], a[0:3], v[24:27]
ds_read_b64_tr_b16 a[112:113], v7 offset:16384
v_mfma_f32_16x16x32_bf16 v[24:27], a[76:79], a[4:7], v[24:27]
ds_read_b64_tr_b16 a[114:115], v7 offset:17408
v_mfma_f32_16x16x32_bf16 v[40:43], a[76:79], a[12:15], v[40:43]
ds_read_b64_tr_b16 a[116:117], v7 offset:24576
v_mfma_f32_16x16x32_bf16 v[40:43], a[72:75], a[8:11], v[40:43]
s_add_u32 s82, s82, 1048576
ds_read_b64_tr_b16 a[118:119], v7 offset:25600
v_mfma_f32_16x16x32_bf16 v[56:59], a[72:75], a[16:19], v[56:59]
s_xor_b32 m0, s84, 2048
buffer_load_dword a252, v1, s[60:63], s82 offen
v_mfma_f32_16x16x32_bf16 v[56:59], a[76:79], a[20:23], v[56:59]
s_xor_b32 s64, s72, 131072
v_mfma_f32_16x16x32_bf16 v[72:75], a[76:79], a[28:31], v[72:75]
s_waitcnt vmcnt(12)
buffer_load_dwordx4 v12, s[48:51], s64 offen lds
v_mfma_f32_16x16x32_bf16 v[72:75], a[72:75], a[24:27], v[72:75]
ds_read_b64_tr_b16 a[72:73], v8 offset:16384
v_mfma_f32_16x16x32_bf16 v[136:139], a[80:83], a[24:27], v[136:139]
ds_read_b64_tr_b16 a[74:75], v8 offset:17408
v_mfma_f32_16x16x32_bf16 v[136:139], a[84:87], a[28:31], v[136:139]
ds_read_b64_tr_b16 a[76:77], v8 offset:24576
v_mfma_f32_16x16x32_bf16 v[120:123], a[84:87], a[20:23], v[120:123]
ds_read_b64_tr_b16 a[78:79], v8 offset:25600
v_mfma_f32_16x16x32_bf16 v[120:123], a[80:83], a[16:19], v[120:123]
s_xor_b32 m0, s84, 3072
ds_read_b128 a[32:35], v2 offset:32768
v_mfma_f32_16x16x32_bf16 v[104:107], a[80:83], a[8:11], v[104:107]
s_xor_b32 s64, s72, 147456
ds_read_b128 a[36:39], v3 offset:32768
v_mfma_f32_16x16x32_bf16 v[104:107], a[84:87], a[12:15], v[104:107]
buffer_load_dwordx4 v13, s[48:51], s64 offen lds
v_mfma_f32_16x16x32_bf16 v[88:91], a[84:87], a[4:7], v[88:91]
ds_read_b128 a[40:43], v2 offset:34816
v_mfma_f32_16x16x32_bf16 v[88:91], a[80:83], a[0:3], v[88:91]
s_waitcnt lgkmcnt(7)
ds_read_b128 a[44:47], v3 offset:34816
v_mfma_f32_16x16x32_bf16 v[28:31], a[0:3], a[88:91], v[28:31]
ds_read_b128 a[48:51], v2 offset:36864
v_mfma_f32_16x16x32_bf16 v[28:31], a[4:7], a[92:95], v[28:31]
ds_read_b128 a[52:55], v3 offset:36864
v_mfma_f32_16x16x32_bf16 v[44:47], a[12:15], a[92:95], v[44:47]
s_xor_b32 m0, s84, 4096
ds_read_b128 a[56:59], v2 offset:38912
v_mfma_f32_16x16x32_bf16 v[44:47], a[8:11], a[88:91], v[44:47]
s_xor_b32 s64, s73, 0
ds_read_b128 a[60:63], v3 offset:38912
v_mfma_f32_16x16x32_bf16 v[60:63], a[16:19], a[88:91], v[60:63]
buffer_load_dwordx4 v12, s[48:51], s64 offen lds
v_mfma_f32_16x16x32_bf16 v[60:63], a[20:23], a[92:95], v[60:63]
ds_read_b64_tr_b16 a[80:81], v9 offset:16384
v_mfma_f32_16x16x32_bf16 v[76:79], a[28:31], a[92:95], v[76:79]
ds_read_b64_tr_b16 a[82:83], v9 offset:17408
v_mfma_f32_16x16x32_bf16 v[76:79], a[24:27], a[88:91], v[76:79]
ds_read_b64_tr_b16 a[84:85], v9 offset:24576
v_mfma_f32_16x16x32_bf16 v[140:143], a[24:27], a[96:99], v[140:143]
ds_read_b64_tr_b16 a[86:87], v9 offset:25600
v_mfma_f32_16x16x32_bf16 v[140:143], a[28:31], a[100:103], v[140:143]
s_xor_b32 m0, s84, 5120
ds_read_b64_tr_b16 a[88:89], v10 offset:16384
v_mfma_f32_16x16x32_bf16 v[124:127], a[20:23], a[100:103], v[124:127]
s_xor_b32 s64, s73, 16384
ds_read_b64_tr_b16 a[90:91], v10 offset:17408
v_mfma_f32_16x16x32_bf16 v[124:127], a[16:19], a[96:99], v[124:127]
buffer_load_dwordx4 v13, s[48:51], s64 offen lds
v_mfma_f32_16x16x32_bf16 v[108:111], a[8:11], a[96:99], v[108:111]
s_branch L_po5
L_pg5:
s_branch L_tr0
L_po5:
ds_read_b64_tr_b16 a[92:93], v10 offset:24576
v_mfma_f32_16x16x32_bf16 v[108:111], a[12:15], a[100:103], v[108:111]
ds_read_b64_tr_b16 a[94:95], v10 offset:25600
v_mfma_f32_16x16x32_bf16 v[92:95], a[4:7], a[100:103], v[92:95]
v_mfma_f32_16x16x32_bf16 v[92:95], a[0:3], a[96:99], v[92:95]
ds_read_b64_tr_b16 a[96:97], v11 offset:16384
v_mfma_f32_16x16x32_bf16 v[32:35], a[0:3], a[104:107], v[32:35]
s_xor_b32 m0, s84, 6144
ds_read_b64_tr_b16 a[98:99], v11 offset:17408
v_mfma_f32_16x16x32_bf16 v[32:35], a[4:7], a[108:111], v[32:35]
s_xor_b32 s64, s73, 131072
ds_read_b64_tr_b16 a[100:101], v11 offset:24576
v_mfma_f32_16x16x32_bf16 v[48:51], a[12:15], a[108:111], v[48:51]
buffer_load_dwordx4 v12, s[48:51], s64 offen lds
v_mfma_f32_16x16x32_bf16 v[48:51], a[8:11], a[104:107], v[48:51]
ds_read_b64_tr_b16 a[102:103], v11 offset:25600
v_mfma_f32_16x16x32_bf16 v[64:67], a[16:19], a[104:107], v[64:67]
v_mfma_f32_16x16x32_bf16 v[64:67], a[20:23], a[108:111], v[64:67]
v_mfma_f32_16x16x32_bf16 v[80:83], a[28:31], a[108:111], v[80:83]
v_mfma_f32_16x16x32_bf16 v[80:83], a[24:27], a[104:107], v[80:83]
s_xor_b32 m0, s84, 7168
v_mfma_f32_16x16x32_bf16 v[144:147], a[24:27], a[112:115], v[144:147]
s_xor_b32 s64, s73, 147456
v_mfma_f32_16x16x32_bf16 v[144:147], a[28:31], a[116:119], v[144:147]
buffer_load_dwordx4 v13, s[48:51], s64 offen lds
v_mfma_f32_16x16x32_bf16 v[128:131], a[20:23], a[116:119], v[128:131]
v_mfma_f32_16x16x32_bf16 v[128:131], a[16:19], a[112:115], v[128:131]
v_mfma_f32_16x16x32_bf16 v[112:115], a[8:11], a[112:115], v[112:115]
v_mfma_f32_16x16x32_bf16 v[112:115], a[12:15], a[116:119], v[112:115]
v_mfma_f32_16x16x32_bf16 v[96:99], a[4:7], a[116:119], v[96:99]
v_mfma_f32_16x16x32_bf16 v[96:99], a[0:3], a[112:115], v[96:99]
s_waitcnt lgkmcnt(0)
v_mfma_f32_16x16x32_bf16 v[36:39], a[0:3], a[72:75], v[36:39]
v_mfma_f32_16x16x32_bf16 v[36:39], a[4:7], a[76:79], v[36:39]
v_mfma_f32_16x16x32_bf16 v[52:55], a[12:15], a[76:79], v[52:55]
s_waitcnt lgkmcnt(0)
s_barrier
v_mfma_f32_16x16x32_bf16 v[52:55], a[8:11], a[72:75], v[52:55]
s_xor_b32 m0, s77, 65536
ds_read_b64_tr_b16 a[104:105], v4 offset:32768
v_mfma_f32_16x16x32_bf16 v[68:71], a[16:19], a[72:75], v[68:71]
s_xor_b32 s64, s71, 524288
ds_read_b64_tr_b16 a[106:107], v4 offset:33792
v_mfma_f32_16x16x32_bf16 v[68:71], a[20:23], a[76:79], v[68:71]
buffer_load_dwordx4 v14, s[56:59], s64 offen lds
v_mfma_f32_16x16x32_bf16 v[84:87], a[28:31], a[76:79], v[84:87]
ds_read_b64_tr_b16 a[108:109], v4 offset:40960
v_mfma_f32_16x16x32_bf16 v[84:87], a[24:27], a[72:75], v[84:87]
ds_read_b64_tr_b16 a[110:111], v4 offset:41984
v_mfma_f32_16x16x32_bf16 v[148:151], a[24:27], a[80:83], v[148:151]
ds_read_b64_tr_b16 a[112:113], v5 offset:32768
v_mfma_f32_16x16x32_bf16 v[148:151], a[28:31], a[84:87], v[148:151]
ds_read_b64_tr_b16 a[114:115], v5 offset:33792
v_mfma_f32_16x16x32_bf16 v[132:135], a[20:23], a[84:87], v[132:135]
ds_read_b64_tr_b16 a[116:117], v5 offset:40960
v_mfma_f32_16x16x32_bf16 v[132:135], a[16:19], a[80:83], v[132:135]
ds_read_b64_tr_b16 a[118:119], v5 offset:41984
v_mfma_f32_16x16x32_bf16 v[116:119], a[8:11], a[80:83], v[116:119]
s_add_u32 m0, s78, 81920
ds_read_b64_tr_b16 a[72:73], v6 offset:32768
v_mfma_f32_16x16x32_bf16 v[116:119], a[12:15], a[84:87], v[116:119]
s_add_u32 s64, s75, 393216
ds_read_b64_tr_b16 a[74:75], v6 offset:33792
v_mfma_f32_16x16x32_bf16 v[100:103], a[4:7], a[84:87], v[100:103]
buffer_load_dwordx4 v23, s[60:63], s64 offen lds
v_mfma_f32_16x16x32_bf16 v[100:103], a[0:3], a[80:83], v[100:103]
ds_read_b64_tr_b16 a[76:77], v6 offset:40960
v_mfma_f32_16x16x32_bf16 v[248:251], a[0:3], a[88:91], v[248:251]
ds_read_b64_tr_b16 a[78:79], v6 offset:41984
v_mfma_f32_16x16x32_bf16 v[248:251], a[4:7], a[92:95], v[248:251]
ds_read_b64_tr_b16 a[80:81], v7 offset:32768
v_mfma_f32_16x16x32_bf16 v[252:255], a[12:15], a[92:95], v[252:255]
ds_read_b64_tr_b16 a[82:83], v7 offset:33792
v_mfma_f32_16x16x32_bf16 v[252:255], a[8:11], a[88:91], v[252:255]
ds_read_b64_tr_b16 a[84:85], v7 offset:40960
v_mfma_f32_16x16x32_bf16 a[120:123], a[16:19], a[88:91], a[120:123]
ds_read_b64_tr_b16 a[86:87], v7 offset:41984
v_mfma_f32_16x16x32_bf16 a[120:123], a[20:23], a[92:95], a[120:123]
s_xor_b32 m0, s77, 66560
v_mfma_f32_16x16x32_bf16 a[124:127], a[28:31], a[92:95], a[124:127]
s_xor_b32 s64, s71, 557056
v_mfma_f32_16x16x32_bf16 a[124:127], a[24:27], a[88:91], a[124:127]
buffer_load_dwordx4 v14, s[56:59], s64 offen lds
v_mfma_f32_16x16x32_bf16 a[128:131], a[24:27], a[96:99], a[128:131]
ds_read_b64_tr_b16 a[88:89], v8 offset:32768
v_mfma_f32_16x16x32_bf16 a[128:131], a[28:31], a[100:103], a[128:131]
ds_read_b64_tr_b16 a[90:91], v8 offset:33792
v_mfma_f32_16x16x32_bf16 a[132:135], a[20:23], a[100:103], a[132:135]
ds_read_b64_tr_b16 a[92:93], v8 offset:40960
v_mfma_f32_16x16x32_bf16 a[132:135], a[16:19], a[96:99], a[132:135]
ds_read_b64_tr_b16 a[94:95], v8 offset:41984
v_mfma_f32_16x16x32_bf16 a[136:139], a[8:11], a[96:99], a[136:139]
v_mfma_f32_16x16x32_bf16 a[136:139], a[12:15], a[100:103], a[136:139]
v_mfma_f32_16x16x32_bf16 a[140:143], a[4:7], a[100:103], a[140:143]
s_add_u32 m0, s78, 86016
v_mfma_f32_16x16x32_bf16 a[140:143], a[0:3], a[96:99], a[140:143]
s_waitcnt lgkmcnt(4)
s_add_u32 s64, s75, 395264
ds_read_b64_tr_b16 a[96:97], v9 offset:32768
v_mfma_f32_16x16x32_bf16 v[184:187], a[104:107], a[32:35], v[184:187]
s_lshl_b32 s66, s30, 30
buffer_load_dwordx4 v23, s[60:63], s64 offen lds
v_mfma_f32_16x16x32_bf16 v[184:187], a[108:111], a[36:39], v[184:187]
ds_read_b64_tr_b16 a[98:99], v9 offset:33792
v_lshl_add_u32 v1, v0, 24, s66
v_mfma_f32_16x16x32_bf16 v[192:195], a[108:111], a[44:47], v[192:195]
s_lshr_b32 s66, s3, 1
ds_read_b64_tr_b16 a[100:101], v9 offset:40960
v_mfma_f32_16x16x32_bf16 v[192:195], a[104:107], a[40:43], v[192:195]
s_lshl_b32 s66, s66, 12
ds_read_b64_tr_b16 a[102:103], v9 offset:41984
v_mfma_f32_16x16x32_bf16 v[200:203], a[104:107], a[48:51], v[200:203]
v_mfma_f32_16x16x32_bf16 v[200:203], a[108:111], a[52:55], v[200:203]
v_mfma_f32_16x16x32_bf16 v[208:211], a[108:111], a[60:63], v[208:211]
v_mfma_f32_16x16x32_bf16 v[208:211], a[104:107], a[56:59], v[208:211]
ds_read_b64_tr_b16 a[104:105], v10 offset:32768
v_mfma_f32_16x16x32_bf16 v[212:215], a[112:115], a[56:59], v[212:215]
s_xor_b32 m0, s77, 67584
ds_read_b64_tr_b16 a[106:107], v10 offset:33792
v_mfma_f32_16x16x32_bf16 v[212:215], a[116:119], a[60:63], v[212:215]
s_xor_b32 s64, s71, 589824
ds_read_b64_tr_b16 a[108:109], v10 offset:40960
v_mfma_f32_16x16x32_bf16 v[204:207], a[116:119], a[52:55], v[204:207]
buffer_load_dwordx4 v15, s[56:59], s64 offen lds
v_mfma_f32_16x16x32_bf16 v[204:207], a[112:115], a[48:51], v[204:207]
ds_read_b64_tr_b16 a[110:111], v10 offset:41984
v_mfma_f32_16x16x32_bf16 v[196:199], a[112:115], a[40:43], v[196:199]
v_mfma_f32_16x16x32_bf16 v[196:199], a[116:119], a[44:47], v[196:199]
v_mfma_f32_16x16x32_bf16 v[188:191], a[116:119], a[36:39], v[188:191]
v_mfma_f32_16x16x32_bf16 v[188:191], a[112:115], a[32:35], v[188:191]
s_add_u32 s67, s79, 20480
ds_read_b64_tr_b16 a[112:113], v11 offset:32768
v_mfma_f32_16x16x32_bf16 v[216:219], a[72:75], a[32:35], v[216:219]
ds_read_b64_tr_b16 a[114:115], v11 offset:33792
v_mfma_f32_16x16x32_bf16 v[216:219], a[76:79], a[36:39], v[216:219]
s_add_u32 m0, s78, 90112
ds_read_b64_tr_b16 a[116:117], v11 offset:40960
v_cvt_pk_bf16_f32 v215, v214, v215
v_mfma_f32_16x16x32_bf16 v[224:227], a[76:79], a[44:47], v[224:227]
s_add_u32 s64, s75, 397312
ds_read_b64_tr_b16 a[118:119], v11 offset:41984
v_cvt_pk_bf16_f32 v214, v212, v213
v_mfma_f32_16x16x32_bf16 v[224:227], a[72:75], a[40:43], v[224:227]
buffer_load_dwordx4 v23, s[60:63], s64 offen lds
v_mfma_f32_16x16x32_bf16 v[232:235], a[72:75], a[48:51], v[232:235]
v_cvt_pk_bf16_f32 v212, v208, v209
v_cvt_pk_bf16_f32 v213, v210, v211
v_mfma_f32_16x16x32_bf16 v[232:235], a[76:79], a[52:55], v[232:235]
buffer_store_dwordx4 v[212:215], v16, s[44:47], s67 offen sc1
v_mfma_f32_16x16x32_bf16 v[240:243], a[76:79], a[60:63], v[240:243]
v_cvt_pk_bf16_f32 v207, v206, v207
v_cvt_pk_bf16_f32 v206, v204, v205
v_mfma_f32_16x16x32_bf16 v[240:243], a[72:75], a[56:59], v[240:243]
ds_read_b64_tr_b16 a[72:73], v4 offset:49152
v_cvt_pk_bf16_f32 v204, v200, v201
v_mfma_f32_16x16x32_bf16 v[244:247], a[80:83], a[56:59], v[244:247]
ds_read_b64_tr_b16 a[74:75], v4 offset:50176
v_cvt_pk_bf16_f32 v205, v202, v203
v_mfma_f32_16x16x32_bf16 v[244:247], a[84:87], a[60:63], v[244:247]
ds_read_b64_tr_b16 a[76:77], v4 offset:57344
v_accvgpr_write_b32 a144, v204
v_mfma_f32_16x16x32_bf16 v[236:239], a[84:87], a[52:55], v[236:239]
s_xor_b32 m0, s77, 68608
ds_read_b64_tr_b16 a[78:79], v4 offset:58368
v_accvgpr_write_b32 a145, v205
v_mfma_f32_16x16x32_bf16 v[236:239], a[80:83], a[48:51], v[236:239]
s_xor_b32 s64, s71, 622592
v_accvgpr_write_b32 a146, v206
v_accvgpr_write_b32 a147, v207
v_mfma_f32_16x16x32_bf16 v[228:231], a[80:83], a[40:43], v[228:231]
buffer_load_dwordx4 v15, s[56:59], s64 offen lds
v_mfma_f32_16x16x32_bf16 v[228:231], a[84:87], a[44:47], v[228:231]
v_cvt_pk_bf16_f32 v199, v198, v199
v_cvt_pk_bf16_f32 v198, v196, v197
v_mfma_f32_16x16x32_bf16 v[220:223], a[84:87], a[36:39], v[220:223]
v_cvt_pk_bf16_f32 v196, v192, v193
v_cvt_pk_bf16_f32 v197, v194, v195
v_mfma_f32_16x16x32_bf16 v[220:223], a[80:83], a[32:35], v[220:223]
s_waitcnt lgkmcnt(4)
ds_read_b64_tr_b16 a[80:81], v5 offset:49152
v_accvgpr_write_b32 a148, v196
v_mfma_f32_16x16x32_bf16 v[152:155], a[88:91], a[32:35], v[152:155]
ds_read_b64_tr_b16 a[82:83], v5 offset:50176
v_accvgpr_write_b32 a149, v197
v_mfma_f32_16x16x32_bf16 v[152:155], a[92:95], a[36:39], v[152:155]
ds_read_b64_tr_b16 a[84:85], v5 offset:57344
v_accvgpr_write_b32 a150, v198
v_mfma_f32_16x16x32_bf16 v[160:163], a[92:95], a[44:47], v[160:163]
ds_read_b64_tr_b16 a[86:87], v5 offset:58368
v_accvgpr_write_b32 a151, v199
v_mfma_f32_16x16x32_bf16 v[160:163], a[88:91], a[40:43], v[160:163]
v_cvt_pk_bf16_f32 v191, v190, v191
v_cvt_pk_bf16_f32 v190, v188, v189
v_mfma_f32_16x16x32_bf16 v[168:171], a[88:91], a[48:51], v[168:171]
v_cvt_pk_bf16_f32 v188, v184, v185
v_cvt_pk_bf16_f32 v189, v186, v187
v_mfma_f32_16x16x32_bf16 v[168:171], a[92:95], a[52:55], v[168:171]
v_accvgpr_write_b32 a152, v188
v_accvgpr_write_b32 a153, v189
v_mfma_f32_16x16x32_bf16 v[176:179], a[92:95], a[60:63], v[176:179]
s_xor_b32 m0, s84, 32768
v_accvgpr_write_b32 a154, v190
v_accvgpr_write_b32 a155, v191
v_mfma_f32_16x16x32_bf16 v[176:179], a[88:91], a[56:59], v[176:179]
s_add_u32 s67, s79, 21504
s_xor_b32 s64, s72, 128
ds_read_b64_tr_b16 a[88:89], v6 offset:49152
v_cvt_pk_bf16_f32 v247, v246, v247
v_mfma_f32_16x16x32_bf16 v[180:183], a[96:99], a[56:59], v[180:183]
buffer_load_dwordx4 v12, s[48:51], s64 offen lds
v_mfma_f32_16x16x32_bf16 v[180:183], a[100:103], a[60:63], v[180:183]
ds_read_b64_tr_b16 a[90:91], v6 offset:50176
v_cvt_pk_bf16_f32 v246, v244, v245
v_mfma_f32_16x16x32_bf16 v[172:175], a[100:103], a[52:55], v[172:175]
ds_read_b64_tr_b16 a[92:93], v6 offset:57344
v_cvt_pk_bf16_f32 v244, v240, v241
v_mfma_f32_16x16x32_bf16 v[172:175], a[96:99], a[48:51], v[172:175]
ds_read_b64_tr_b16 a[94:95], v6 offset:58368
v_cvt_pk_bf16_f32 v245, v242, v243
v_mfma_f32_16x16x32_bf16 v[164:167], a[96:99], a[40:43], v[164:167]
buffer_store_dwordx4 v[244:247], v16, s[44:47], s67 offen sc1
v_mfma_f32_16x16x32_bf16 v[164:167], a[100:103], a[44:47], v[164:167]
s_xor_b32 m0, s84, 33792
v_cvt_pk_bf16_f32 v239, v238, v239
v_cvt_pk_bf16_f32 v238, v236, v237
v_mfma_f32_16x16x32_bf16 v[156:159], a[100:103], a[36:39], v[156:159]
s_xor_b32 s64, s72, 16512
v_cvt_pk_bf16_f32 v236, v232, v233
v_cvt_pk_bf16_f32 v237, v234, v235
v_mfma_f32_16x16x32_bf16 v[156:159], a[96:99], a[32:35], v[156:159]
buffer_load_dwordx4 v13, s[48:51], s64 offen lds
v_mfma_f32_16x16x32_bf16 v[24:27], a[104:107], a[32:35], v[24:27]
ds_read_b64_tr_b16 a[96:97], v7 offset:49152
v_accvgpr_write_b32 a156, v236
v_mfma_f32_16x16x32_bf16 v[24:27], a[108:111], a[36:39], v[24:27]
ds_read_b64_tr_b16 a[98:99], v7 offset:50176
v_accvgpr_write_b32 a157, v237
v_mfma_f32_16x16x32_bf16 v[40:43], a[108:111], a[44:47], v[40:43]
ds_read_b64_tr_b16 a[100:101], v7 offset:57344
v_accvgpr_write_b32 a158, v238
v_mfma_f32_16x16x32_bf16 v[40:43], a[104:107], a[40:43], v[40:43]
ds_read_b64_tr_b16 a[102:103], v7 offset:58368
v_accvgpr_write_b32 a159, v239
v_mfma_f32_16x16x32_bf16 v[56:59], a[104:107], a[48:51], v[56:59]
s_xor_b32 m0, s84, 34816
v_cvt_pk_bf16_f32 v231, v230, v231
v_cvt_pk_bf16_f32 v230, v228, v229
v_mfma_f32_16x16x32_bf16 v[56:59], a[108:111], a[52:55], v[56:59]
s_xor_b32 s64, s72, 131200
v_cvt_pk_bf16_f32 v228, v224, v225
v_cvt_pk_bf16_f32 v229, v226, v227
v_mfma_f32_16x16x32_bf16 v[72:75], a[108:111], a[60:63], v[72:75]
s_waitcnt vmcnt(11)
buffer_load_dwordx4 v12, s[48:51], s64 offen lds
v_mfma_f32_16x16x32_bf16 v[72:75], a[104:107], a[56:59], v[72:75]
ds_read_b64_tr_b16 a[104:105], v8 offset:49152
v_accvgpr_write_b32 a160, v228
v_mfma_f32_16x16x32_bf16 v[136:139], a[112:115], a[56:59], v[136:139]
ds_read_b64_tr_b16 a[106:107], v8 offset:50176
v_accvgpr_write_b32 a161, v229
v_mfma_f32_16x16x32_bf16 v[136:139], a[116:119], a[60:63], v[136:139]
ds_read_b64_tr_b16 a[108:109], v8 offset:57344
v_add_u32 v4, 0x8000, v4
v_mfma_f32_16x16x32_bf16 v[120:123], a[116:119], a[52:55], v[120:123]
ds_read_b64_tr_b16 a[110:111], v8 offset:58368
v_accvgpr_write_b32 a162, v230
v_mfma_f32_16x16x32_bf16 v[120:123], a[112:115], a[48:51], v[120:123]
s_xor_b32 m0, s84, 35840
ds_read_b128 a[0:3], v2 offset:0
v_accvgpr_write_b32 a163, v231
v_mfma_f32_16x16x32_bf16 v[104:107], a[112:115], a[40:43], v[104:107]
s_xor_b32 s64, s72, 147584
ds_read_b128 a[4:7], v3 offset:0
v_cvt_pk_bf16_f32 v223, v222, v223
v_mfma_f32_16x16x32_bf16 v[104:107], a[116:119], a[44:47], v[104:107]
buffer_load_dwordx4 v13, s[48:51], s64 offen lds
v_mfma_f32_16x16x32_bf16 v[88:91], a[116:119], a[36:39], v[88:91]
ds_read_b128 a[8:11], v2 offset:2048
v_cvt_pk_bf16_f32 v222, v220, v221
v_mfma_f32_16x16x32_bf16 v[88:91], a[112:115], a[32:35], v[88:91]
s_waitcnt lgkmcnt(7)
ds_read_b128 a[12:15], v3 offset:2048
v_cvt_pk_bf16_f32 v220, v216, v217
v_mfma_f32_16x16x32_bf16 v[28:31], a[32:35], a[72:75], v[28:31]
ds_read_b128 a[16:19], v2 offset:4096
v_cvt_pk_bf16_f32 v221, v218, v219
v_mfma_f32_16x16x32_bf16 v[28:31], a[36:39], a[76:79], v[28:31]
ds_read_b128 a[20:23], v3 offset:4096
v_add_u32 v5, 0x8000, v5
v_mfma_f32_16x16x32_bf16 v[44:47], a[44:47], a[76:79], v[44:47]
s_xor_b32 m0, s84, 36864
ds_read_b128 a[24:27], v2 offset:6144
v_accvgpr_write_b32 a164, v220
v_mfma_f32_16x16x32_bf16 v[44:47], a[40:43], a[72:75], v[44:47]
s_xor_b32 s64, s73, 128
ds_read_b128 a[28:31], v3 offset:6144
v_accvgpr_write_b32 a165, v221
v_mfma_f32_16x16x32_bf16 v[60:63], a[48:51], a[72:75], v[60:63]
buffer_load_dwordx4 v12, s[48:51], s64 offen lds
v_mfma_f32_16x16x32_bf16 v[60:63], a[52:55], a[76:79], v[60:63]
ds_read_b64_tr_b16 a[112:113], v9 offset:49152
v_accvgpr_write_b32 a166, v222
v_mfma_f32_16x16x32_bf16 v[76:79], a[60:63], a[76:79], v[76:79]
ds_read_b64_tr_b16 a[114:115], v9 offset:50176
v_accvgpr_write_b32 a167, v223
v_mfma_f32_16x16x32_bf16 v[76:79], a[56:59], a[72:75], v[76:79]
s_add_u32 s67, s79, 22528
ds_read_b64_tr_b16 a[116:117], v9 offset:57344
v_cvt_pk_bf16_f32 v183, v182, v183
v_mfma_f32_16x16x32_bf16 v[140:143], a[56:59], a[80:83], v[140:143]
ds_read_b64_tr_b16 a[118:119], v9 offset:58368
v_cvt_pk_bf16_f32 v182, v180, v181
v_mfma_f32_16x16x32_bf16 v[140:143], a[60:63], a[84:87], v[140:143]
s_xor_b32 m0, s84, 37888
ds_read_b64_tr_b16 a[72:73], v10 offset:49152
v_add_u32 v6, 0x8000, v6
v_mfma_f32_16x16x32_bf16 v[124:127], a[52:55], a[84:87], v[124:127]
s_xor_b32 s64, s73, 16512
ds_read_b64_tr_b16 a[74:75], v10 offset:50176
v_cvt_pk_bf16_f32 v180, v176, v177
v_mfma_f32_16x16x32_bf16 v[124:127], a[48:51], a[80:83], v[124:127]
buffer_load_dwordx4 v13, s[48:51], s64 offen lds
v_mfma_f32_16x16x32_bf16 v[108:111], a[40:43], a[80:83], v[108:111]
ds_read_b64_tr_b16 a[76:77], v10 offset:57344
v_cvt_pk_bf16_f32 v181, v178, v179
v_mfma_f32_16x16x32_bf16 v[108:111], a[44:47], a[84:87], v[108:111]
ds_read_b64_tr_b16 a[78:79], v10 offset:58368
v_mfma_f32_16x16x32_bf16 v[92:95], a[36:39], a[84:87], v[92:95]
buffer_store_dwordx4 v[180:183], v16, s[44:47], s67 offen sc1
v_mfma_f32_16x16x32_bf16 v[92:95], a[32:35], a[80:83], v[92:95]
ds_read_b64_tr_b16 a[80:81], v11 offset:49152
v_cvt_pk_bf16_f32 v175, v174, v175
v_mfma_f32_16x16x32_bf16 v[32:35], a[32:35], a[88:91], v[32:35]
s_xor_b32 m0, s84, 38912
ds_read_b64_tr_b16 a[82:83], v11 offset:50176
v_cvt_pk_bf16_f32 v174, v172, v173
v_mfma_f32_16x16x32_bf16 v[32:35], a[36:39], a[92:95], v[32:35]
s_xor_b32 s64, s73, 131200
ds_read_b64_tr_b16 a[84:85], v11 offset:57344
v_add_u32 v7, 0x8000, v7
v_mfma_f32_16x16x32_bf16 v[48:51], a[44:47], a[92:95], v[48:51]
buffer_load_dwordx4 v12, s[48:51], s64 offen lds
v_mfma_f32_16x16x32_bf16 v[48:51], a[40:43], a[88:91], v[48:51]
ds_read_b64_tr_b16 a[86:87], v11 offset:58368
v_cvt_pk_bf16_f32 v172, v168, v169
v_mfma_f32_16x16x32_bf16 v[64:67], a[48:51], a[88:91], v[64:67]
v_cvt_pk_bf16_f32 v173, v170, v171
v_accvgpr_write_b32 a168, v172
v_mfma_f32_16x16x32_bf16 v[64:67], a[52:55], a[92:95], v[64:67]
v_accvgpr_write_b32 a169, v173
v_accvgpr_write_b32 a170, v174
v_mfma_f32_16x16x32_bf16 v[80:83], a[60:63], a[92:95], v[80:83]
v_accvgpr_write_b32 a171, v175
v_cvt_pk_bf16_f32 v167, v166, v167
v_mfma_f32_16x16x32_bf16 v[80:83], a[56:59], a[88:91], v[80:83]
s_xor_b32 m0, s84, 39936
v_cvt_pk_bf16_f32 v166, v164, v165
v_cvt_pk_bf16_f32 v164, v160, v161
v_mfma_f32_16x16x32_bf16 v[144:147], a[56:59], a[96:99], v[144:147]
s_xor_b32 s64, s73, 147584
v_cvt_pk_bf16_f32 v165, v162, v163
v_accvgpr_write_b32 a172, v164
v_mfma_f32_16x16x32_bf16 v[144:147], a[60:63], a[100:103], v[144:147]
buffer_load_dwordx4 v13, s[48:51], s64 offen lds
v_mfma_f32_16x16x32_bf16 v[128:131], a[52:55], a[100:103], v[128:131]
v_add_u32 v8, 0x8000, v8
v_accvgpr_write_b32 a173, v165
v_mfma_f32_16x16x32_bf16 v[128:131], a[48:51], a[96:99], v[128:131]
v_accvgpr_write_b32 a174, v166
v_accvgpr_write_b32 a175, v167
v_mfma_f32_16x16x32_bf16 v[112:115], a[40:43], a[96:99], v[112:115]
v_cvt_pk_bf16_f32 v159, v158, v159
v_cvt_pk_bf16_f32 v158, v156, v157
v_mfma_f32_16x16x32_bf16 v[112:115], a[44:47], a[100:103], v[112:115]
v_cvt_pk_bf16_f32 v156, v152, v153
v_cvt_pk_bf16_f32 v157, v154, v155
v_mfma_f32_16x16x32_bf16 v[96:99], a[36:39], a[100:103], v[96:99]
v_add_u32 v9, 0x8000, v9
v_add_u32 v10, 0x8000, v10
v_mfma_f32_16x16x32_bf16 v[96:99], a[32:35], a[96:99], v[96:99]
s_waitcnt lgkmcnt(0)
v_add_u32 v11, 0x8000, v11
v_accvgpr_write_b32 a176, v156
v_mfma_f32_16x16x32_bf16 v[36:39], a[32:35], a[104:107], v[36:39]
v_accvgpr_write_b32 a177, v157
v_accvgpr_write_b32 a178, v158
v_mfma_f32_16x16x32_bf16 v[36:39], a[36:39], a[108:111], v[36:39]
v_accvgpr_write_b32 a179, v159
v_mfma_f32_16x16x32_bf16 v[52:55], a[44:47], a[108:111], v[52:55]
s_add_u32 s67, s79, 23552
s_waitcnt lgkmcnt(0)
s_barrier
v_mfma_f32_16x16x32_bf16 v[52:55], a[40:43], a[104:107], v[52:55]
s_xor_b32 m0, s77, 98304
ds_read_b64_tr_b16 a[88:89], v19 offset:36864
v_cvt_pk_bf16_f32 v139, v138, v139
v_mfma_f32_16x16x32_bf16 v[68:71], a[48:51], a[104:107], v[68:71]
s_xor_b32 s64, s71, 1048576
ds_read_b64_tr_b16 a[90:91], v19 offset:37120
v_cvt_pk_bf16_f32 v138, v136, v137
v_mfma_f32_16x16x32_bf16 v[68:71], a[52:55], a[108:111], v[68:71]
buffer_load_dwordx4 v14, s[56:59], s64 offen lds
v_mfma_f32_16x16x32_bf16 v[84:87], a[60:63], a[108:111], v[84:87]
ds_read_b64_tr_b16 a[92:93], v19 offset:38912
v_cvt_pk_bf16_f32 v136, v72, v73
v_mfma_f32_16x16x32_bf16 v[84:87], a[56:59], a[104:107], v[84:87]
ds_read_b64_tr_b16 a[94:95], v19 offset:39168
v_cvt_pk_bf16_f32 v137, v74, v75
v_mfma_f32_16x16x32_bf16 v[148:151], a[56:59], a[112:115], v[148:151]
ds_read_b64_tr_b16 a[96:97], v20 offset:36864
v_mfma_f32_16x16x32_bf16 v[148:151], a[60:63], a[116:119], v[148:151]
ds_read_b64_tr_b16 a[98:99], v20 offset:37120
v_mfma_f32_16x16x32_bf16 v[132:135], a[52:55], a[116:119], v[132:135]
ds_read_b64_tr_b16 a[100:101], v20 offset:38912
v_mfma_f32_16x16x32_bf16 v[132:135], a[48:51], a[112:115], v[132:135]
ds_read_b64_tr_b16 a[102:103], v20 offset:39168
v_mfma_f32_16x16x32_bf16 v[116:119], a[40:43], a[112:115], v[116:119]
s_add_u32 m0, s78, 114688
ds_read_b64_tr_b16 a[104:105], v19 offset:40960
v_mfma_f32_16x16x32_bf16 v[116:119], a[44:47], a[116:119], v[116:119]
s_add_u32 s64, s75, 786432
ds_read_b64_tr_b16 a[106:107], v19 offset:41216
v_mfma_f32_16x16x32_bf16 v[100:103], a[36:39], a[116:119], v[100:103]
buffer_load_dwordx4 v23, s[60:63], s64 offen lds
v_mfma_f32_16x16x32_bf16 v[100:103], a[32:35], a[112:115], v[100:103]
ds_read_b64_tr_b16 a[108:109], v19 offset:43008
v_mfma_f32_16x16x32_bf16 v[248:251], a[32:35], a[72:75], v[248:251]
ds_read_b64_tr_b16 a[110:111], v19 offset:43264
v_mfma_f32_16x16x32_bf16 v[248:251], a[36:39], a[76:79], v[248:251]
ds_read_b64_tr_b16 a[112:113], v20 offset:40960
v_mfma_f32_16x16x32_bf16 v[252:255], a[44:47], a[76:79], v[252:255]
ds_read_b64_tr_b16 a[114:115], v20 offset:41216
v_mfma_f32_16x16x32_bf16 v[252:255], a[40:43], a[72:75], v[252:255]
ds_read_b64_tr_b16 a[116:117], v20 offset:43008
v_mfma_f32_16x16x32_bf16 a[120:123], a[48:51], a[72:75], a[120:123]
ds_read_b64_tr_b16 a[118:119], v20 offset:43264
v_mfma_f32_16x16x32_bf16 a[120:123], a[52:55], a[76:79], a[120:123]
s_xor_b32 m0, s77, 99328
buffer_store_dwordx4 v[136:139], v16, s[44:47], s67 offen sc1
v_mfma_f32_16x16x32_bf16 a[124:127], a[60:63], a[76:79], a[124:127]
s_xor_b32 s64, s71, 1081344
v_cvt_pk_bf16_f32 v123, v122, v123
v_cvt_pk_bf16_f32 v122, v120, v121
v_mfma_f32_16x16x32_bf16 a[124:127], a[56:59], a[72:75], a[124:127]
buffer_load_dwordx4 v14, s[56:59], s64 offen lds
v_mfma_f32_16x16x32_bf16 a[128:131], a[56:59], a[80:83], a[128:131]
ds_read_b64_tr_b16 a[72:73], v19 offset:32768
v_cvt_pk_bf16_f32 v120, v56, v57
v_mfma_f32_16x16x32_bf16 a[128:131], a[60:63], a[84:87], a[128:131]
ds_read_b64_tr_b16 a[74:75], v19 offset:33024
v_cvt_pk_bf16_f32 v121, v58, v59
v_mfma_f32_16x16x32_bf16 a[132:135], a[52:55], a[84:87], a[132:135]
ds_read_b64_tr_b16 a[76:77], v19 offset:34816
v_accvgpr_write_b32 a180, v120
v_mfma_f32_16x16x32_bf16 a[132:135], a[48:51], a[80:83], a[132:135]
ds_read_b64_tr_b16 a[78:79], v19 offset:35072
v_accvgpr_write_b32 a181, v121
v_mfma_f32_16x16x32_bf16 a[136:139], a[40:43], a[80:83], a[136:139]
v_accvgpr_write_b32 a182, v122
v_accvgpr_write_b32 a183, v123
v_mfma_f32_16x16x32_bf16 a[136:139], a[44:47], a[84:87], a[136:139]
v_cvt_pk_bf16_f32 v107, v106, v107
v_cvt_pk_bf16_f32 v106, v104, v105
v_mfma_f32_16x16x32_bf16 a[140:143], a[36:39], a[84:87], a[140:143]
s_add_u32 m0, s78, 118784
v_cvt_pk_bf16_f32 v104, v40, v41
v_cvt_pk_bf16_f32 v105, v42, v43
v_mfma_f32_16x16x32_bf16 a[140:143], a[32:35], a[80:83], a[140:143]
s_waitcnt lgkmcnt(4)
s_add_u32 s64, s75, 788480
ds_read_b64_tr_b16 a[80:81], v20 offset:32768
v_accvgpr_write_b32 a184, v104
v_mfma_f32_16x16x32_bf16 v[184:187], a[88:91], a[0:3], 0
buffer_load_dwordx4 v23, s[60:63], s64 offen lds
v_mfma_f32_16x16x32_bf16 v[184:187], a[92:95], a[4:7], v[184:187]
ds_read_b64_tr_b16 a[82:83], v20 offset:33024
v_accvgpr_write_b32 a185, v105
v_mfma_f32_16x16x32_bf16 v[192:195], a[92:95], a[12:15], 0
ds_read_b64_tr_b16 a[84:85], v20 offset:34816
v_accvgpr_write_b32 a186, v106
v_mfma_f32_16x16x32_bf16 v[192:195], a[88:91], a[8:11], v[192:195]
ds_read_b64_tr_b16 a[86:87], v20 offset:35072
v_accvgpr_write_b32 a187, v107
v_mfma_f32_16x16x32_bf16 v[200:203], a[88:91], a[16:19], 0
v_cvt_pk_bf16_f32 v91, v90, v91
v_cvt_pk_bf16_f32 v90, v88, v89
v_mfma_f32_16x16x32_bf16 v[200:203], a[92:95], a[20:23], v[200:203]
v_cvt_pk_bf16_f32 v88, v24, v25
v_cvt_pk_bf16_f32 v89, v26, v27
v_mfma_f32_16x16x32_bf16 v[208:211], a[92:95], a[28:31], 0
v_accvgpr_write_b32 a188, v88
v_accvgpr_write_b32 a189, v89
v_mfma_f32_16x16x32_bf16 v[208:211], a[88:91], a[24:27], v[208:211]
s_xor_b32 m0, s77, 100352
ds_read_b64_tr_b16 a[88:89], v4 offset:32768
v_accvgpr_write_b32 a190, v90
v_mfma_f32_16x16x32_bf16 v[212:215], a[96:99], a[24:27], 0
s_xor_b32 s64, s71, 1114112
ds_read_b64_tr_b16 a[90:91], v4 offset:33792
v_accvgpr_write_b32 a191, v91
v_mfma_f32_16x16x32_bf16 v[212:215], a[100:103], a[28:31], v[212:215]
s_add_u32 s67, s79, 8192
ds_read_b64_tr_b16 a[92:93], v4 offset:40960
v_cvt_pk_bf16_f32 v47, v46, v47
v_mfma_f32_16x16x32_bf16 v[204:207], a[100:103], a[20:23], 0
buffer_load_dwordx4 v15, s[56:59], s64 offen lds
v_mfma_f32_16x16x32_bf16 v[204:207], a[96:99], a[16:19], v[204:207]
ds_read_b64_tr_b16 a[94:95], v4 offset:41984
v_cvt_pk_bf16_f32 v46, v44, v45
v_mfma_f32_16x16x32_bf16 v[196:199], a[96:99], a[8:11], 0
v_cvt_pk_bf16_f32 v44, v28, v29
v_cvt_pk_bf16_f32 v45, v30, v31
v_mfma_f32_16x16x32_bf16 v[196:199], a[100:103], a[12:15], v[196:199]
buffer_store_dwordx4 v[44:47], v16, s[44:47], s67 offen sc1
v_mfma_f32_16x16x32_bf16 v[188:191], a[100:103], a[4:7], 0
v_cvt_pk_bf16_f32 v79, v78, v79
v_cvt_pk_bf16_f32 v78, v76, v77
v_mfma_f32_16x16x32_bf16 v[188:191], a[96:99], a[0:3], v[188:191]
s_branch L_po6
L_pg6:
s_branch L_pg10
L_po6:
ds_read_b64_tr_b16 a[96:97], v5 offset:32768
v_cvt_pk_bf16_f32 v76, v60, v61
v_mfma_f32_16x16x32_bf16 v[216:219], a[0:3], a[104:107], 0
ds_read_b64_tr_b16 a[98:99], v5 offset:33792
v_cvt_pk_bf16_f32 v77, v62, v63
v_mfma_f32_16x16x32_bf16 v[216:219], a[4:7], a[108:111], v[216:219]
s_add_u32 m0, s78, 122880
ds_read_b64_tr_b16 a[100:101], v5 offset:40960
v_accvgpr_write_b32 a192, v76
v_mfma_f32_16x16x32_bf16 v[224:227], a[12:15], a[108:111], 0
s_add_u32 s64, s75, 790528
ds_read_b64_tr_b16 a[102:103], v5 offset:41984
v_accvgpr_write_b32 a193, v77
v_mfma_f32_16x16x32_bf16 v[224:227], a[8:11], a[104:107], v[224:227]
buffer_load_dwordx4 v23, s[60:63], s64 offen lds
v_mfma_f32_16x16x32_bf16 v[232:235], a[16:19], a[104:107], 0
v_accvgpr_write_b32 a194, v78
v_accvgpr_write_b32 a195, v79
v_mfma_f32_16x16x32_bf16 v[232:235], a[20:23], a[108:111], v[232:235]
v_cvt_pk_bf16_f32 v124, v124, v125
v_cvt_pk_bf16_f32 v125, v126, v127
v_mfma_f32_16x16x32_bf16 v[240:243], a[28:31], a[108:111], 0
v_cvt_pk_bf16_f32 v126, v140, v141
v_cvt_pk_bf16_f32 v127, v142, v143
v_mfma_f32_16x16x32_bf16 v[240:243], a[24:27], a[104:107], v[240:243]
ds_read_b64_tr_b16 a[104:105], v6 offset:32768
v_accvgpr_write_b32 a196, v124
v_mfma_f32_16x16x32_bf16 v[244:247], a[24:27], a[112:115], 0
ds_read_b64_tr_b16 a[106:107], v6 offset:33792
v_accvgpr_write_b32 a197, v125
v_mfma_f32_16x16x32_bf16 v[244:247], a[28:31], a[116:119], v[244:247]
ds_read_b64_tr_b16 a[108:109], v6 offset:40960
v_accvgpr_write_b32 a198, v126
v_mfma_f32_16x16x32_bf16 v[236:239], a[20:23], a[116:119], 0
s_xor_b32 m0, s77, 101376
ds_read_b64_tr_b16 a[110:111], v6 offset:41984
v_accvgpr_write_b32 a199, v127
v_mfma_f32_16x16x32_bf16 v[236:239], a[16:19], a[112:115], v[236:239]
s_xor_b32 s64, s71, 1146880
v_cvt_pk_bf16_f32 v92, v92, v93
v_cvt_pk_bf16_f32 v93, v94, v95
v_mfma_f32_16x16x32_bf16 v[228:231], a[8:11], a[112:115], 0
buffer_load_dwordx4 v15, s[56:59], s64 offen lds
v_mfma_f32_16x16x32_bf16 v[228:231], a[12:15], a[116:119], v[228:231]
v_cvt_pk_bf16_f32 v94, v108, v109
v_cvt_pk_bf16_f32 v95, v110, v111
v_mfma_f32_16x16x32_bf16 v[220:223], a[4:7], a[116:119], 0
v_accvgpr_write_b32 a200, v92
v_accvgpr_write_b32 a201, v93
v_mfma_f32_16x16x32_bf16 v[220:223], a[0:3], a[112:115], v[220:223]
s_waitcnt lgkmcnt(4)
ds_read_b64_tr_b16 a[112:113], v7 offset:32768
v_accvgpr_write_b32 a202, v94
v_mfma_f32_16x16x32_bf16 v[152:155], a[72:75], a[0:3], 0
ds_read_b64_tr_b16 a[114:115], v7 offset:33792
v_accvgpr_write_b32 a203, v95
v_mfma_f32_16x16x32_bf16 v[152:155], a[76:79], a[4:7], v[152:155]
s_add_u32 s67, s79, 10240
ds_read_b64_tr_b16 a[116:117], v7 offset:40960
v_cvt_pk_bf16_f32 v51, v50, v51
v_mfma_f32_16x16x32_bf16 v[160:163], a[76:79], a[12:15], 0
ds_read_b64_tr_b16 a[118:119], v7 offset:41984
v_cvt_pk_bf16_f32 v50, v48, v49
v_mfma_f32_16x16x32_bf16 v[160:163], a[72:75], a[8:11], v[160:163]
v_cvt_pk_bf16_f32 v48, v32, v33
v_cvt_pk_bf16_f32 v49, v34, v35
v_mfma_f32_16x16x32_bf16 v[168:171], a[72:75], a[16:19], 0
buffer_store_dwordx4 v[48:51], v16, s[44:47], s67 offen sc1
v_mfma_f32_16x16x32_bf16 v[168:171], a[76:79], a[20:23], v[168:171]
v_subrev_u32 v19, 0x8000, v19
v_subrev_u32 v20, 0x8000, v20
v_mfma_f32_16x16x32_bf16 v[176:179], a[76:79], a[28:31], 0
s_xor_b32 m0, s84, 0
v_cvt_pk_bf16_f32 v83, v82, v83
v_cvt_pk_bf16_f32 v82, v80, v81
v_mfma_f32_16x16x32_bf16 v[176:179], a[72:75], a[24:27], v[176:179]
s_xor_b32 s64, s72, 256
ds_read_b64_tr_b16 a[72:73], v8 offset:32768
v_cvt_pk_bf16_f32 v80, v64, v65
v_mfma_f32_16x16x32_bf16 v[180:183], a[80:83], a[24:27], 0
buffer_load_dwordx4 v12, s[48:51], s64 offen lds
v_mfma_f32_16x16x32_bf16 v[180:183], a[84:87], a[28:31], v[180:183]
ds_read_b64_tr_b16 a[74:75], v8 offset:33792
v_subrev_u32 v4, 0x8000, v4
v_mfma_f32_16x16x32_bf16 v[172:175], a[84:87], a[20:23], 0
ds_read_b64_tr_b16 a[76:77], v8 offset:40960
v_cvt_pk_bf16_f32 v81, v66, v67
v_mfma_f32_16x16x32_bf16 v[172:175], a[80:83], a[16:19], v[172:175]
s_xor_b32 m0, s84, 1024
ds_read_b64_tr_b16 a[78:79], v8 offset:41984
v_accvgpr_write_b32 a204, v80
v_mfma_f32_16x16x32_bf16 v[164:167], a[80:83], a[8:11], 0
s_xor_b32 s64, s72, 16640
v_accvgpr_write_b32 a205, v81
v_accvgpr_write_b32 a206, v82
v_mfma_f32_16x16x32_bf16 v[164:167], a[84:87], a[12:15], v[164:167]
buffer_load_dwordx4 v13, s[48:51], s64 offen lds
v_mfma_f32_16x16x32_bf16 v[156:159], a[84:87], a[4:7], 0
v_accvgpr_write_b32 a207, v83
v_cvt_pk_bf16_f32 v128, v128, v129
v_mfma_f32_16x16x32_bf16 v[156:159], a[80:83], a[0:3], v[156:159]
ds_read_b64_tr_b16 a[80:81], v9 offset:32768
v_cvt_pk_bf16_f32 v129, v130, v131
v_mfma_f32_16x16x32_bf16 v[24:27], a[88:91], a[0:3], 0
s_xor_b32 m0, s84, 2048
ds_read_b64_tr_b16 a[82:83], v9 offset:33792
v_cvt_pk_bf16_f32 v130, v144, v145
v_mfma_f32_16x16x32_bf16 v[24:27], a[92:95], a[4:7], v[24:27]
s_xor_b32 s64, s72, 131328
ds_read_b64_tr_b16 a[84:85], v9 offset:40960
v_subrev_u32 v5, 0x8000, v5
v_mfma_f32_16x16x32_bf16 v[40:43], a[92:95], a[12:15], 0
buffer_load_dwordx4 v12, s[48:51], s64 offen lds
v_mfma_f32_16x16x32_bf16 v[40:43], a[88:91], a[8:11], v[40:43]
ds_read_b64_tr_b16 a[86:87], v9 offset:41984
v_cvt_pk_bf16_f32 v131, v146, v147
v_mfma_f32_16x16x32_bf16 v[56:59], a[88:91], a[16:19], 0
s_xor_b32 m0, s84, 3072
v_accvgpr_write_b32 a208, v128
v_accvgpr_write_b32 a209, v129
v_mfma_f32_16x16x32_bf16 v[56:59], a[92:95], a[20:23], v[56:59]
s_xor_b32 s64, s72, 147712
v_accvgpr_write_b32 a210, v130
v_accvgpr_write_b32 a211, v131
v_mfma_f32_16x16x32_bf16 v[72:75], a[92:95], a[28:31], 0
s_waitcnt vmcnt(13)
ds_read_b128 a[32:35], v2 offset:32768
v_cvt_pk_bf16_f32 v96, v96, v97
v_mfma_f32_16x16x32_bf16 v[72:75], a[88:91], a[24:27], v[72:75]
buffer_load_dwordx4 v13, s[48:51], s64 offen lds
v_mfma_f32_16x16x32_bf16 v[136:139], a[96:99], a[24:27], 0
ds_read_b128 a[36:39], v3 offset:32768
v_cvt_pk_bf16_f32 v97, v98, v99
v_mfma_f32_16x16x32_bf16 v[136:139], a[100:103], a[28:31], v[136:139]
ds_read_b128 a[40:43], v2 offset:34816
v_subrev_u32 v6, 0x8000, v6
v_mfma_f32_16x16x32_bf16 v[120:123], a[100:103], a[20:23], 0
s_xor_b32 m0, s84, 4096
ds_read_b128 a[44:47], v3 offset:34816
v_cvt_pk_bf16_f32 v98, v112, v113
v_mfma_f32_16x16x32_bf16 v[120:123], a[96:99], a[16:19], v[120:123]
s_xor_b32 s64, s73, 256
ds_read_b128 a[48:51], v2 offset:36864
v_cvt_pk_bf16_f32 v99, v114, v115
v_mfma_f32_16x16x32_bf16 v[104:107], a[96:99], a[8:11], 0
buffer_load_dwordx4 v12, s[48:51], s64 offen lds
v_mfma_f32_16x16x32_bf16 v[104:107], a[100:103], a[12:15], v[104:107]
ds_read_b128 a[52:55], v3 offset:36864
v_accvgpr_write_b32 a212, v96
v_mfma_f32_16x16x32_bf16 v[88:91], a[100:103], a[4:7], 0
ds_read_b128 a[56:59], v2 offset:38912
v_accvgpr_write_b32 a213, v97
v_mfma_f32_16x16x32_bf16 v[88:91], a[96:99], a[0:3], v[88:91]
s_waitcnt lgkmcnt(7)
s_xor_b32 m0, s84, 5120
ds_read_b128 a[60:63], v3 offset:38912
v_accvgpr_write_b32 a214, v98
v_mfma_f32_16x16x32_bf16 v[28:31], a[104:107], a[0:3], 0
s_xor_b32 s64, s73, 16640
ds_read_b64_tr_b16 a[88:89], v10 offset:32768
v_accvgpr_write_b32 a215, v99
v_mfma_f32_16x16x32_bf16 v[28:31], a[108:111], a[4:7], v[28:31]
s_add_u32 s67, s79, 12288
buffer_load_dwordx4 v13, s[48:51], s64 offen lds
v_mfma_f32_16x16x32_bf16 v[44:47], a[108:111], a[12:15], 0
ds_read_b64_tr_b16 a[90:91], v10 offset:33792
v_subrev_u32 v7, 0x8000, v7
v_mfma_f32_16x16x32_bf16 v[44:47], a[104:107], a[8:11], v[44:47]
ds_read_b64_tr_b16 a[92:93], v10 offset:40960
v_cvt_pk_bf16_f32 v55, v54, v55
v_mfma_f32_16x16x32_bf16 v[60:63], a[104:107], a[16:19], 0
s_xor_b32 m0, s84, 6144
ds_read_b64_tr_b16 a[94:95], v10 offset:41984
v_cvt_pk_bf16_f32 v54, v52, v53
v_mfma_f32_16x16x32_bf16 v[60:63], a[108:111], a[20:23], v[60:63]
s_xor_b32 s64, s73, 131328
ds_read_b64_tr_b16 a[96:97], v11 offset:32768
v_cvt_pk_bf16_f32 v52, v36, v37
v_mfma_f32_16x16x32_bf16 v[76:79], a[108:111], a[28:31], 0
buffer_load_dwordx4 v12, s[48:51], s64 offen lds
v_mfma_f32_16x16x32_bf16 v[76:79], a[104:107], a[24:27], v[76:79]
ds_read_b64_tr_b16 a[98:99], v11 offset:33792
v_cvt_pk_bf16_f32 v53, v38, v39
v_mfma_f32_16x16x32_bf16 v[140:143], a[112:115], a[24:27], 0
ds_read_b64_tr_b16 a[100:101], v11 offset:40960
v_mfma_f32_16x16x32_bf16 v[140:143], a[116:119], a[28:31], v[140:143]
s_xor_b32 m0, s84, 7168
ds_read_b64_tr_b16 a[102:103], v11 offset:41984
v_subrev_u32 v8, 0x8000, v8
v_mfma_f32_16x16x32_bf16 v[124:127], a[116:119], a[20:23], 0
s_xor_b32 s64, s73, 147712
buffer_store_dwordx4 v[52:55], v16, s[44:47], s67 offen sc1
v_mfma_f32_16x16x32_bf16 v[124:127], a[112:115], a[16:19], v[124:127]
buffer_load_dwordx4 v13, s[48:51], s64 offen lds
v_mfma_f32_16x16x32_bf16 v[108:111], a[112:115], a[8:11], 0
v_cvt_pk_bf16_f32 v87, v86, v87
v_cvt_pk_bf16_f32 v86, v84, v85
v_mfma_f32_16x16x32_bf16 v[108:111], a[116:119], a[12:15], v[108:111]
v_cvt_pk_bf16_f32 v84, v68, v69
v_cvt_pk_bf16_f32 v85, v70, v71
v_mfma_f32_16x16x32_bf16 v[92:95], a[116:119], a[4:7], 0
v_subrev_u32 v9, 0x8000, v9
v_subrev_u32 v10, 0x8000, v10
v_mfma_f32_16x16x32_bf16 v[92:95], a[112:115], a[0:3], v[92:95]
v_subrev_u32 v11, 0x8000, v11
v_accvgpr_write_b32 a216, v84
v_mfma_f32_16x16x32_bf16 v[32:35], a[72:75], a[0:3], 0
v_accvgpr_write_b32 a217, v85
v_accvgpr_write_b32 a218, v86
v_mfma_f32_16x16x32_bf16 v[32:35], a[76:79], a[4:7], v[32:35]
v_accvgpr_write_b32 a219, v87
v_cvt_pk_bf16_f32 v132, v132, v133
v_mfma_f32_16x16x32_bf16 v[48:51], a[76:79], a[12:15], 0
s_waitcnt lgkmcnt(0)
s_barrier
v_mfma_f32_16x16x32_bf16 v[48:51], a[72:75], a[8:11], v[48:51]
s_xor_b32 m0, s77, 131072
ds_read_b64_tr_b16 a[104:105], v19 offset:4096
v_cvt_pk_bf16_f32 v133, v134, v135
v_mfma_f32_16x16x32_bf16 v[64:67], a[72:75], a[16:19], 0
s_xor_b32 s64, s71, 1572864
ds_read_b64_tr_b16 a[106:107], v19 offset:4352
v_cvt_pk_bf16_f32 v134, v148, v149
v_mfma_f32_16x16x32_bf16 v[64:67], a[76:79], a[20:23], v[64:67]
buffer_load_dwordx4 v14, s[56:59], s64 offen lds
v_mfma_f32_16x16x32_bf16 v[80:83], a[76:79], a[28:31], 0
ds_read_b64_tr_b16 a[108:109], v19 offset:6144
v_cvt_pk_bf16_f32 v135, v150, v151
v_mfma_f32_16x16x32_bf16 v[80:83], a[72:75], a[24:27], v[80:83]
ds_read_b64_tr_b16 a[110:111], v19 offset:6400
v_accvgpr_write_b32 a220, v132
v_mfma_f32_16x16x32_bf16 v[144:147], a[80:83], a[24:27], 0
ds_read_b64_tr_b16 a[112:113], v20 offset:4096
v_accvgpr_write_b32 a221, v133
v_mfma_f32_16x16x32_bf16 v[144:147], a[84:87], a[28:31], v[144:147]
ds_read_b64_tr_b16 a[114:115], v20 offset:4352
v_accvgpr_write_b32 a222, v134
v_mfma_f32_16x16x32_bf16 v[128:131], a[84:87], a[20:23], 0
ds_read_b64_tr_b16 a[116:117], v20 offset:6144
v_accvgpr_write_b32 a223, v135
v_mfma_f32_16x16x32_bf16 v[128:131], a[80:83], a[16:19], v[128:131]
ds_read_b64_tr_b16 a[118:119], v20 offset:6400
v_cvt_pk_bf16_f32 v100, v100, v101
v_mfma_f32_16x16x32_bf16 v[112:115], a[80:83], a[8:11], 0
s_add_u32 m0, s78, 147456
ds_read_b64_tr_b16 a[72:73], v19 offset:8192
v_cvt_pk_bf16_f32 v101, v102, v103
v_mfma_f32_16x16x32_bf16 v[112:115], a[84:87], a[12:15], v[112:115]
s_add_u32 s64, s75, 1179648
ds_read_b64_tr_b16 a[74:75], v19 offset:8448
v_cvt_pk_bf16_f32 v102, v116, v117
v_mfma_f32_16x16x32_bf16 v[96:99], a[84:87], a[4:7], 0
buffer_load_dwordx4 v23, s[60:63], s64 offen lds
v_mfma_f32_16x16x32_bf16 v[96:99], a[80:83], a[0:3], v[96:99]
ds_read_b64_tr_b16 a[76:77], v19 offset:10240
v_cvt_pk_bf16_f32 v103, v118, v119
v_mfma_f32_16x16x32_bf16 v[36:39], a[88:91], a[0:3], 0
ds_read_b64_tr_b16 a[78:79], v19 offset:10496
v_accvgpr_write_b32 a224, v100
v_mfma_f32_16x16x32_bf16 v[36:39], a[92:95], a[4:7], v[36:39]
ds_read_b64_tr_b16 a[80:81], v20 offset:8192
v_accvgpr_write_b32 a225, v101
v_mfma_f32_16x16x32_bf16 v[52:55], a[92:95], a[12:15], 0
s_xor_b32 s68, s66, 0
ds_read_b64_tr_b16 a[82:83], v20 offset:8448
v_accvgpr_write_b32 a226, v102
v_mfma_f32_16x16x32_bf16 v[52:55], a[88:91], a[8:11], v[52:55]
s_xor_b32 m0, s77, 132096
ds_read_b64_tr_b16 a[84:85], v20 offset:10240
v_accvgpr_write_b32 a227, v103
v_mfma_f32_16x16x32_bf16 v[68:71], a[88:91], a[16:19], 0
s_add_u32 s67, s79, 14336
ds_read_b64_tr_b16 a[86:87], v20 offset:10496
v_cvt_pk_bf16_f32 v255, v254, v255
v_mfma_f32_16x16x32_bf16 v[68:71], a[92:95], a[20:23], v[68:71]
s_xor_b32 s64, s71, 1605632
v_cvt_pk_bf16_f32 v254, v252, v253
v_cvt_pk_bf16_f32 v252, v248, v249
v_mfma_f32_16x16x32_bf16 v[84:87], a[92:95], a[28:31], 0
s_mov_b64 exec, 1
buffer_atomic_add a251, v1, s[52:55], s68 offen offset:0 sc1
s_mov_b64 exec, -1
v_mfma_f32_16x16x32_bf16 v[84:87], a[88:91], a[24:27], v[84:87]
buffer_load_dwordx4 v14, s[56:59], s64 offen lds
v_mfma_f32_16x16x32_bf16 v[148:151], a[96:99], a[24:27], 0
ds_read_b64_tr_b16 a[88:89], v19 offset:0
v_cvt_pk_bf16_f32 v253, v250, v251
v_mfma_f32_16x16x32_bf16 v[148:151], a[100:103], a[28:31], v[148:151]
ds_read_b64_tr_b16 a[90:91], v19 offset:256
v_mfma_f32_16x16x32_bf16 v[132:135], a[100:103], a[20:23], 0
ds_read_b64_tr_b16 a[92:93], v19 offset:2048
v_mfma_f32_16x16x32_bf16 v[132:135], a[96:99], a[16:19], v[132:135]
s_add_u32 s65, s79, 16384
ds_read_b64_tr_b16 a[94:95], v19 offset:2304
v_mfma_f32_16x16x32_bf16 v[116:119], a[96:99], a[8:11], 0
buffer_store_dwordx4 a[144:147], v16, s[44:47], s65 offen sc1
v_mfma_f32_16x16x32_bf16 v[116:119], a[100:103], a[12:15], v[116:119]
buffer_store_dwordx4 v[252:255], v16, s[44:47], s67 offen sc1
v_mfma_f32_16x16x32_bf16 v[100:103], a[100:103], a[4:7], 0
s_add_u32 m0, s78, 151552
v_mfma_f32_16x16x32_bf16 v[100:103], a[96:99], a[0:3], v[100:103]
s_waitcnt lgkmcnt(4)
s_add_u32 s64, s75, 1181696
ds_read_b64_tr_b16 a[96:97], v20 offset:0
v_accvgpr_read_b32 v248, a120
v_mfma_f32_16x16x32_bf16 v[184:187], a[104:107], a[32:35], v[184:187]
buffer_load_dwordx4 v23, s[60:63], s64 offen lds
v_mfma_f32_16x16x32_bf16 v[184:187], a[108:111], a[36:39], v[184:187]
ds_read_b64_tr_b16 a[98:99], v20 offset:256
v_accvgpr_read_b32 v249, a121
v_mfma_f32_16x16x32_bf16 v[192:195], a[108:111], a[44:47], v[192:195]
ds_read_b64_tr_b16 a[100:101], v20 offset:2048
v_accvgpr_read_b32 v250, a122
v_mfma_f32_16x16x32_bf16 v[192:195], a[104:107], a[40:43], v[192:195]
ds_read_b64_tr_b16 a[102:103], v20 offset:2304
v_accvgpr_read_b32 v251, a123
v_mfma_f32_16x16x32_bf16 v[200:203], a[104:107], a[48:51], v[200:203]
v_accvgpr_read_b32 v252, a124
v_accvgpr_read_b32 v253, a125
v_mfma_f32_16x16x32_bf16 v[200:203], a[108:111], a[52:55], v[200:203]
v_accvgpr_read_b32 v254, a126
v_accvgpr_read_b32 v255, a127
v_mfma_f32_16x16x32_bf16 v[208:211], a[108:111], a[60:63], v[208:211]
v_cvt_pk_bf16_f32 v255, v254, v255
v_cvt_pk_bf16_f32 v254, v252, v253
v_mfma_f32_16x16x32_bf16 v[208:211], a[104:107], a[56:59], v[208:211]
ds_read_b64_tr_b16 a[104:105], v4 offset:0
v_cvt_pk_bf16_f32 v252, v248, v249
v_mfma_f32_16x16x32_bf16 v[212:215], a[112:115], a[56:59], v[212:215]
s_xor_b32 m0, s77, 133120
ds_read_b64_tr_b16 a[106:107], v4 offset:1024
v_cvt_pk_bf16_f32 v253, v250, v251
v_mfma_f32_16x16x32_bf16 v[212:215], a[116:119], a[60:63], v[212:215]
s_xor_b32 s64, s71, 1638400
ds_read_b64_tr_b16 a[108:109], v4 offset:8192
v_accvgpr_write_b32 a228, v252
v_mfma_f32_16x16x32_bf16 v[204:207], a[116:119], a[52:55], v[204:207]
buffer_load_dwordx4 v15, s[56:59], s64 offen lds
v_mfma_f32_16x16x32_bf16 v[204:207], a[112:115], a[48:51], v[204:207]
ds_read_b64_tr_b16 a[110:111], v4 offset:9216
v_accvgpr_write_b32 a229, v253
v_mfma_f32_16x16x32_bf16 v[196:199], a[112:115], a[40:43], v[196:199]
v_accvgpr_write_b32 a230, v254
v_accvgpr_write_b32 a231, v255
v_mfma_f32_16x16x32_bf16 v[196:199], a[116:119], a[44:47], v[196:199]
v_mfma_f32_16x16x32_bf16 v[188:191], a[116:119], a[36:39], v[188:191]
v_accvgpr_read_b32 v248, a132
v_accvgpr_read_b32 v249, a133
v_mfma_f32_16x16x32_bf16 v[188:191], a[112:115], a[32:35], v[188:191]
ds_read_b64_tr_b16 a[112:113], v5 offset:0
v_accvgpr_read_b32 v250, a134
v_mfma_f32_16x16x32_bf16 v[216:219], a[32:35], a[72:75], v[216:219]
ds_read_b64_tr_b16 a[114:115], v5 offset:1024
v_accvgpr_read_b32 v251, a135
v_mfma_f32_16x16x32_bf16 v[216:219], a[36:39], a[76:79], v[216:219]
s_add_u32 m0, s78, 155648
ds_read_b64_tr_b16 a[116:117], v5 offset:8192
v_accvgpr_read_b32 v252, a128
v_mfma_f32_16x16x32_bf16 v[224:227], a[44:47], a[76:79], v[224:227]
s_add_u32 s64, s75, 1183744
ds_read_b64_tr_b16 a[118:119], v5 offset:9216
v_accvgpr_read_b32 v253, a129
v_mfma_f32_16x16x32_bf16 v[224:227], a[40:43], a[72:75], v[224:227]
buffer_load_dwordx4 v23, s[60:63], s64 offen lds
v_mfma_f32_16x16x32_bf16 v[232:235], a[48:51], a[72:75], v[232:235]
v_accvgpr_read_b32 v254, a130
v_accvgpr_read_b32 v255, a131
v_mfma_f32_16x16x32_bf16 v[232:235], a[52:55], a[76:79], v[232:235]
v_cvt_pk_bf16_f32 v255, v254, v255
v_cvt_pk_bf16_f32 v254, v252, v253
v_mfma_f32_16x16x32_bf16 v[240:243], a[60:63], a[76:79], v[240:243]
v_cvt_pk_bf16_f32 v252, v248, v249
v_cvt_pk_bf16_f32 v253, v250, v251
v_mfma_f32_16x16x32_bf16 v[240:243], a[56:59], a[72:75], v[240:243]
ds_read_b64_tr_b16 a[72:73], v6 offset:0
v_accvgpr_write_b32 a232, v252
v_mfma_f32_16x16x32_bf16 v[244:247], a[56:59], a[80:83], v[244:247]
ds_read_b64_tr_b16 a[74:75], v6 offset:1024
v_accvgpr_write_b32 a233, v253
v_mfma_f32_16x16x32_bf16 v[244:247], a[60:63], a[84:87], v[244:247]
ds_read_b64_tr_b16 a[76:77], v6 offset:8192
v_accvgpr_write_b32 a234, v254
v_mfma_f32_16x16x32_bf16 v[236:239], a[52:55], a[84:87], v[236:239]
s_xor_b32 m0, s77, 134144
ds_read_b64_tr_b16 a[78:79], v6 offset:9216
v_accvgpr_write_b32 a235, v255
v_mfma_f32_16x16x32_bf16 v[236:239], a[48:51], a[80:83], v[236:239]
s_xor_b32 s64, s71, 1671168
v_mfma_f32_16x16x32_bf16 v[228:231], a[40:43], a[80:83], v[228:231]
buffer_load_dwordx4 v15, s[56:59], s64 offen lds
v_mfma_f32_16x16x32_bf16 v[228:231], a[44:47], a[84:87], v[228:231]
v_accvgpr_read_b32 v248, a140
v_accvgpr_read_b32 v249, a141
v_mfma_f32_16x16x32_bf16 v[220:223], a[36:39], a[84:87], v[220:223]
v_accvgpr_read_b32 v250, a142
v_accvgpr_read_b32 v251, a143
v_mfma_f32_16x16x32_bf16 v[220:223], a[32:35], a[80:83], v[220:223]
s_waitcnt lgkmcnt(4)
ds_read_b64_tr_b16 a[80:81], v7 offset:0
v_accvgpr_read_b32 v252, a136
v_mfma_f32_16x16x32_bf16 v[152:155], a[88:91], a[32:35], v[152:155]
ds_read_b64_tr_b16 a[82:83], v7 offset:1024
v_accvgpr_read_b32 v253, a137
v_mfma_f32_16x16x32_bf16 v[152:155], a[92:95], a[36:39], v[152:155]
ds_read_b64_tr_b16 a[84:85], v7 offset:8192
v_accvgpr_read_b32 v254, a138
v_mfma_f32_16x16x32_bf16 v[160:163], a[92:95], a[44:47], v[160:163]
ds_read_b64_tr_b16 a[86:87], v7 offset:9216
v_accvgpr_read_b32 v255, a139
v_mfma_f32_16x16x32_bf16 v[160:163], a[88:91], a[40:43], v[160:163]
v_cvt_pk_bf16_f32 v255, v254, v255
v_cvt_pk_bf16_f32 v254, v252, v253
v_mfma_f32_16x16x32_bf16 v[168:171], a[88:91], a[48:51], v[168:171]
v_cvt_pk_bf16_f32 v252, v248, v249
v_cvt_pk_bf16_f32 v253, v250, v251
v_mfma_f32_16x16x32_bf16 v[168:171], a[92:95], a[52:55], v[168:171]
v_accvgpr_write_b32 a236, v252
v_accvgpr_write_b32 a237, v253
v_mfma_f32_16x16x32_bf16 v[176:179], a[92:95], a[60:63], v[176:179]
s_xor_b32 m0, s84, 32768
v_accvgpr_write_b32 a238, v254
v_accvgpr_write_b32 a239, v255
v_mfma_f32_16x16x32_bf16 v[176:179], a[88:91], a[56:59], v[176:179]
s_xor_b32 s64, s72, 384
ds_read_b64_tr_b16 a[88:89], v8 offset:0
v_mfma_f32_16x16x32_bf16 v[180:183], a[96:99], a[56:59], v[180:183]
s_add_u32 s65, s79, 4096
buffer_load_dwordx4 v12, s[48:51], s64 offen lds
v_mfma_f32_16x16x32_bf16 v[180:183], a[100:103], a[60:63], v[180:183]
buffer_store_dwordx4 a[148:151], v16, s[44:47], s65 offen sc1
v_mfma_f32_16x16x32_bf16 v[172:175], a[100:103], a[52:55], v[172:175]
ds_read_b64_tr_b16 a[90:91], v8 offset:1024
v_mfma_f32_16x16x32_bf16 v[172:175], a[96:99], a[48:51], v[172:175]
s_xor_b32 m0, s84, 33792
ds_read_b64_tr_b16 a[92:93], v8 offset:8192
v_mfma_f32_16x16x32_bf16 v[164:167], a[96:99], a[40:43], v[164:167]
s_xor_b32 s64, s72, 16768
ds_read_b64_tr_b16 a[94:95], v8 offset:9216
v_mfma_f32_16x16x32_bf16 v[164:167], a[100:103], a[44:47], v[164:167]
buffer_load_dwordx4 v13, s[48:51], s64 offen lds
v_mfma_f32_16x16x32_bf16 v[156:159], a[100:103], a[36:39], v[156:159]
v_mfma_f32_16x16x32_bf16 v[156:159], a[96:99], a[32:35], v[156:159]
ds_read_b64_tr_b16 a[96:97], v9 offset:0
v_mfma_f32_16x16x32_bf16 v[24:27], a[104:107], a[32:35], v[24:27]
s_xor_b32 m0, s84, 34816
ds_read_b64_tr_b16 a[98:99], v9 offset:1024
v_mfma_f32_16x16x32_bf16 v[24:27], a[108:111], a[36:39], v[24:27]
s_xor_b32 s64, s72, 131456
ds_read_b64_tr_b16 a[100:101], v9 offset:8192
v_mfma_f32_16x16x32_bf16 v[40:43], a[108:111], a[44:47], v[40:43]
buffer_load_dwordx4 v12, s[48:51], s64 offen lds
v_mfma_f32_16x16x32_bf16 v[40:43], a[104:107], a[40:43], v[40:43]
ds_read_b64_tr_b16 a[102:103], v9 offset:9216
v_mfma_f32_16x16x32_bf16 v[56:59], a[104:107], a[48:51], v[56:59]
v_mfma_f32_16x16x32_bf16 v[56:59], a[108:111], a[52:55], v[56:59]
s_xor_b32 m0, s84, 35840
v_mfma_f32_16x16x32_bf16 v[72:75], a[108:111], a[60:63], v[72:75]
s_waitcnt vmcnt(14)
s_xor_b32 s64, s72, 147840
ds_read_b128 a[0:3], v2 offset:0
v_mfma_f32_16x16x32_bf16 v[72:75], a[104:107], a[56:59], v[72:75]
buffer_load_dwordx4 v13, s[48:51], s64 offen lds
v_mfma_f32_16x16x32_bf16 v[136:139], a[112:115], a[56:59], v[136:139]
ds_read_b128 a[4:7], v3 offset:0
v_mfma_f32_16x16x32_bf16 v[136:139], a[116:119], a[60:63], v[136:139]
ds_read_b128 a[8:11], v2 offset:2048
v_mfma_f32_16x16x32_bf16 v[120:123], a[116:119], a[52:55], v[120:123]
s_xor_b32 m0, s84, 36864
ds_read_b128 a[12:15], v3 offset:2048
v_mfma_f32_16x16x32_bf16 v[120:123], a[112:115], a[48:51], v[120:123]
s_xor_b32 s64, s73, 384
ds_read_b128 a[16:19], v2 offset:4096
v_mfma_f32_16x16x32_bf16 v[104:107], a[112:115], a[40:43], v[104:107]
buffer_load_dwordx4 v12, s[48:51], s64 offen lds
v_mfma_f32_16x16x32_bf16 v[104:107], a[116:119], a[44:47], v[104:107]
ds_read_b128 a[20:23], v3 offset:4096
v_mfma_f32_16x16x32_bf16 v[88:91], a[116:119], a[36:39], v[88:91]
ds_read_b128 a[24:27], v2 offset:6144
v_mfma_f32_16x16x32_bf16 v[88:91], a[112:115], a[32:35], v[88:91]
s_waitcnt lgkmcnt(7)
s_xor_b32 m0, s84, 37888
ds_read_b128 a[28:31], v3 offset:6144
v_mfma_f32_16x16x32_bf16 v[28:31], a[72:75], a[32:35], v[28:31]
s_xor_b32 s64, s73, 16768
ds_read_b64_tr_b16 a[104:105], v10 offset:0
v_mfma_f32_16x16x32_bf16 v[28:31], a[76:79], a[36:39], v[28:31]
buffer_load_dwordx4 v13, s[48:51], s64 offen lds
v_mfma_f32_16x16x32_bf16 v[44:47], a[76:79], a[44:47], v[44:47]
ds_read_b64_tr_b16 a[106:107], v10 offset:1024
v_mfma_f32_16x16x32_bf16 v[44:47], a[72:75], a[40:43], v[44:47]
ds_read_b64_tr_b16 a[108:109], v10 offset:8192
v_mfma_f32_16x16x32_bf16 v[60:63], a[72:75], a[48:51], v[60:63]
s_xor_b32 m0, s84, 38912
ds_read_b64_tr_b16 a[110:111], v10 offset:9216
v_mfma_f32_16x16x32_bf16 v[60:63], a[76:79], a[52:55], v[60:63]
s_xor_b32 s64, s73, 131456
ds_read_b64_tr_b16 a[112:113], v11 offset:0
v_mfma_f32_16x16x32_bf16 v[76:79], a[76:79], a[60:63], v[76:79]
buffer_load_dwordx4 v12, s[48:51], s64 offen lds
v_mfma_f32_16x16x32_bf16 v[76:79], a[72:75], a[56:59], v[76:79]
ds_read_b64_tr_b16 a[114:115], v11 offset:1024
v_mfma_f32_16x16x32_bf16 v[140:143], a[80:83], a[56:59], v[140:143]
ds_read_b64_tr_b16 a[116:117], v11 offset:8192
v_mfma_f32_16x16x32_bf16 v[140:143], a[84:87], a[60:63], v[140:143]
s_xor_b32 m0, s84, 39936
ds_read_b64_tr_b16 a[118:119], v11 offset:9216
v_mfma_f32_16x16x32_bf16 v[124:127], a[84:87], a[52:55], v[124:127]
s_xor_b32 s64, s73, 147840
v_mfma_f32_16x16x32_bf16 v[124:127], a[80:83], a[48:51], v[124:127]
buffer_load_dwordx4 v13, s[48:51], s64 offen lds
v_mfma_f32_16x16x32_bf16 v[108:111], a[80:83], a[40:43], v[108:111]
v_mfma_f32_16x16x32_bf16 v[108:111], a[84:87], a[44:47], v[108:111]
v_mfma_f32_16x16x32_bf16 v[92:95], a[84:87], a[36:39], v[92:95]
v_mfma_f32_16x16x32_bf16 v[92:95], a[80:83], a[32:35], v[92:95]
v_mfma_f32_16x16x32_bf16 v[32:35], a[88:91], a[32:35], v[32:35]
v_mfma_f32_16x16x32_bf16 v[32:35], a[92:95], a[36:39], v[32:35]
s_branch L_po7
L_pg7:
s_branch L_pg11
L_po7:
v_mfma_f32_16x16x32_bf16 v[48:51], a[92:95], a[44:47], v[48:51]
s_waitcnt lgkmcnt(0)
s_barrier
v_mfma_f32_16x16x32_bf16 v[48:51], a[88:91], a[40:43], v[48:51]
s_xor_b32 m0, s77, 65536
ds_read_b64_tr_b16 a[72:73], v19 offset:36864
v_mfma_f32_16x16x32_bf16 v[64:67], a[88:91], a[48:51], v[64:67]
s_xor_b32 s64, s71, 2097152
ds_read_b64_tr_b16 a[74:75], v19 offset:37120
v_mfma_f32_16x16x32_bf16 v[64:67], a[92:95], a[52:55], v[64:67]
s_add_u32 s65, s79, 0
buffer_load_dwordx4 v14, s[56:59], s64 offen lds
v_mfma_f32_16x16x32_bf16 v[80:83], a[92:95], a[60:63], v[80:83]
buffer_store_dwordx4 a[152:155], v16, s[44:47], s65 offen sc1
v_mfma_f32_16x16x32_bf16 v[80:83], a[88:91], a[56:59], v[80:83]
ds_read_b64_tr_b16 a[76:77], v19 offset:38912
v_mfma_f32_16x16x32_bf16 v[144:147], a[96:99], a[56:59], v[144:147]
ds_read_b64_tr_b16 a[78:79], v19 offset:39168
v_mfma_f32_16x16x32_bf16 v[144:147], a[100:103], a[60:63], v[144:147]
ds_read_b64_tr_b16 a[80:81], v20 offset:36864
v_mfma_f32_16x16x32_bf16 v[128:131], a[100:103], a[52:55], v[128:131]
ds_read_b64_tr_b16 a[82:83], v20 offset:37120
v_mfma_f32_16x16x32_bf16 v[128:131], a[96:99], a[48:51], v[128:131]
ds_read_b64_tr_b16 a[84:85], v20 offset:38912
v_mfma_f32_16x16x32_bf16 v[112:115], a[96:99], a[40:43], v[112:115]
s_add_u32 m0, s78, 81920
ds_read_b64_tr_b16 a[86:87], v20 offset:39168
v_mfma_f32_16x16x32_bf16 v[112:115], a[100:103], a[44:47], v[112:115]
s_add_u32 s64, s75, 1572864
ds_read_b64_tr_b16 a[88:89], v19 offset:40960
v_mfma_f32_16x16x32_bf16 v[96:99], a[100:103], a[36:39], v[96:99]
buffer_load_dwordx4 v23, s[60:63], s64 offen lds
v_mfma_f32_16x16x32_bf16 v[96:99], a[96:99], a[32:35], v[96:99]
ds_read_b64_tr_b16 a[90:91], v19 offset:41216
v_mfma_f32_16x16x32_bf16 v[36:39], a[104:107], a[32:35], v[36:39]
ds_read_b64_tr_b16 a[92:93], v19 offset:43008
v_mfma_f32_16x16x32_bf16 v[36:39], a[108:111], a[36:39], v[36:39]
ds_read_b64_tr_b16 a[94:95], v19 offset:43264
v_mfma_f32_16x16x32_bf16 v[52:55], a[108:111], a[44:47], v[52:55]
ds_read_b64_tr_b16 a[96:97], v20 offset:40960
v_mfma_f32_16x16x32_bf16 v[52:55], a[104:107], a[40:43], v[52:55]
ds_read_b64_tr_b16 a[98:99], v20 offset:41216
v_mfma_f32_16x16x32_bf16 v[68:71], a[104:107], a[48:51], v[68:71]
s_xor_b32 m0, s77, 66560
ds_read_b64_tr_b16 a[100:101], v20 offset:43008
v_mfma_f32_16x16x32_bf16 v[68:71], a[108:111], a[52:55], v[68:71]
s_xor_b32 s64, s71, 2129920
s_xor_b32 s68, s66, 4096
ds_read_b64_tr_b16 a[102:103], v20 offset:43264
v_mfma_f32_16x16x32_bf16 v[84:87], a[108:111], a[60:63], v[84:87]
s_mov_b64 exec, 1
buffer_atomic_add a251, v1, s[52:55], s68 offen offset:0 sc1
s_mov_b64 exec, -1
v_mfma_f32_16x16x32_bf16 v[84:87], a[104:107], a[56:59], v[84:87]
buffer_load_dwordx4 v14, s[56:59], s64 offen lds
v_mfma_f32_16x16x32_bf16 v[148:151], a[112:115], a[56:59], v[148:151]
ds_read_b64_tr_b16 a[104:105], v19 offset:32768
v_mfma_f32_16x16x32_bf16 v[148:151], a[116:119], a[60:63], v[148:151]
ds_read_b64_tr_b16 a[106:107], v19 offset:33024
v_mfma_f32_16x16x32_bf16 v[132:135], a[116:119], a[52:55], v[132:135]
ds_read_b64_tr_b16 a[108:109], v19 offset:34816
v_mfma_f32_16x16x32_bf16 v[132:135], a[112:115], a[48:51], v[132:135]
ds_read_b64_tr_b16 a[110:111], v19 offset:35072
v_mfma_f32_16x16x32_bf16 v[116:119], a[112:115], a[40:43], v[116:119]
v_mfma_f32_16x16x32_bf16 v[116:119], a[116:119], a[44:47], v[116:119]
v_mfma_f32_16x16x32_bf16 v[100:103], a[116:119], a[36:39], v[100:103]
s_add_u32 m0, s78, 86016
v_mfma_f32_16x16x32_bf16 v[100:103], a[112:115], a[32:35], v[100:103]
s_waitcnt lgkmcnt(4)
s_add_u32 s64, s75, 1574912
ds_read_b64_tr_b16 a[112:113], v20 offset:32768
v_mfma_f32_16x16x32_bf16 v[184:187], a[72:75], a[0:3], v[184:187]
buffer_load_dwordx4 v23, s[60:63], s64 offen lds
v_mfma_f32_16x16x32_bf16 v[184:187], a[76:79], a[4:7], v[184:187]
ds_read_b64_tr_b16 a[114:115], v20 offset:33024
v_mfma_f32_16x16x32_bf16 v[192:195], a[76:79], a[12:15], v[192:195]
ds_read_b64_tr_b16 a[116:117], v20 offset:34816
v_mfma_f32_16x16x32_bf16 v[192:195], a[72:75], a[8:11], v[192:195]
ds_read_b64_tr_b16 a[118:119], v20 offset:35072
v_mfma_f32_16x16x32_bf16 v[200:203], a[72:75], a[16:19], v[200:203]
v_mfma_f32_16x16x32_bf16 v[200:203], a[76:79], a[20:23], v[200:203]
v_mfma_f32_16x16x32_bf16 v[208:211], a[76:79], a[28:31], v[208:211]
v_mfma_f32_16x16x32_bf16 v[208:211], a[72:75], a[24:27], v[208:211]
ds_read_b64_tr_b16 a[72:73], v4 offset:32768
v_mfma_f32_16x16x32_bf16 v[212:215], a[80:83], a[24:27], v[212:215]
s_xor_b32 m0, s77, 67584
ds_read_b64_tr_b16 a[74:75], v4 offset:33792
v_mfma_f32_16x16x32_bf16 v[212:215], a[84:87], a[28:31], v[212:215]
s_xor_b32 s64, s71, 2162688
ds_read_b64_tr_b16 a[76:77], v4 offset:40960
v_mfma_f32_16x16x32_bf16 v[204:207], a[84:87], a[20:23], v[204:207]
buffer_load_dwordx4 v15, s[56:59], s64 offen lds
v_mfma_f32_16x16x32_bf16 v[204:207], a[80:83], a[16:19], v[204:207]
ds_read_b64_tr_b16 a[78:79], v4 offset:41984
v_mfma_f32_16x16x32_bf16 v[196:199], a[80:83], a[8:11], v[196:199]
v_mfma_f32_16x16x32_bf16 v[196:199], a[84:87], a[12:15], v[196:199]
v_mfma_f32_16x16x32_bf16 v[188:191], a[84:87], a[4:7], v[188:191]
v_mfma_f32_16x16x32_bf16 v[188:191], a[80:83], a[0:3], v[188:191]
ds_read_b64_tr_b16 a[80:81], v5 offset:32768
v_mfma_f32_16x16x32_bf16 v[216:219], a[0:3], a[88:91], v[216:219]
ds_read_b64_tr_b16 a[82:83], v5 offset:33792
v_mfma_f32_16x16x32_bf16 v[216:219], a[4:7], a[92:95], v[216:219]
s_add_u32 m0, s78, 90112
s_add_u32 s65, s79, 17408
ds_read_b64_tr_b16 a[84:85], v5 offset:40960
v_mfma_f32_16x16x32_bf16 v[224:227], a[12:15], a[92:95], v[224:227]
s_add_u32 s64, s75, 1576960
buffer_store_dwordx4 a[156:159], v16, s[44:47], s65 offen sc1
v_mfma_f32_16x16x32_bf16 v[224:227], a[8:11], a[88:91], v[224:227]
buffer_load_dwordx4 v23, s[60:63], s64 offen lds
v_mfma_f32_16x16x32_bf16 v[232:235], a[16:19], a[88:91], v[232:235]
ds_read_b64_tr_b16 a[86:87], v5 offset:41984
v_mfma_f32_16x16x32_bf16 v[232:235], a[20:23], a[92:95], v[232:235]
v_mfma_f32_16x16x32_bf16 v[240:243], a[28:31], a[92:95], v[240:243]
v_mfma_f32_16x16x32_bf16 v[240:243], a[24:27], a[88:91], v[240:243]
ds_read_b64_tr_b16 a[88:89], v6 offset:32768
v_mfma_f32_16x16x32_bf16 v[244:247], a[24:27], a[96:99], v[244:247]
ds_read_b64_tr_b16 a[90:91], v6 offset:33792
v_mfma_f32_16x16x32_bf16 v[244:247], a[28:31], a[100:103], v[244:247]
ds_read_b64_tr_b16 a[92:93], v6 offset:40960
v_add_u32 v19, 0x8000, v19
v_mfma_f32_16x16x32_bf16 v[236:239], a[20:23], a[100:103], v[236:239]
s_xor_b32 m0, s77, 68608
ds_read_b64_tr_b16 a[94:95], v6 offset:41984
v_mfma_f32_16x16x32_bf16 v[236:239], a[16:19], a[96:99], v[236:239]
s_xor_b32 s64, s71, 2195456
v_mfma_f32_16x16x32_bf16 v[228:231], a[8:11], a[96:99], v[228:231]
buffer_load_dwordx4 v15, s[56:59], s64 offen lds
v_mfma_f32_16x16x32_bf16 v[228:231], a[12:15], a[100:103], v[228:231]
v_mfma_f32_16x16x32_bf16 v[220:223], a[4:7], a[100:103], v[220:223]
v_mfma_f32_16x16x32_bf16 v[220:223], a[0:3], a[96:99], v[220:223]
s_waitcnt lgkmcnt(4)
ds_read_b64_tr_b16 a[96:97], v7 offset:32768
v_mfma_f32_16x16x32_bf16 v[152:155], a[104:107], a[0:3], v[152:155]
ds_read_b64_tr_b16 a[98:99], v7 offset:33792
v_mfma_f32_16x16x32_bf16 v[152:155], a[108:111], a[4:7], v[152:155]
ds_read_b64_tr_b16 a[100:101], v7 offset:40960
v_add_u32 v20, 0x8000, v20
v_mfma_f32_16x16x32_bf16 v[160:163], a[108:111], a[12:15], v[160:163]
ds_read_b64_tr_b16 a[102:103], v7 offset:41984
v_mfma_f32_16x16x32_bf16 v[160:163], a[104:107], a[8:11], v[160:163]
v_mfma_f32_16x16x32_bf16 v[168:171], a[104:107], a[16:19], v[168:171]
v_mfma_f32_16x16x32_bf16 v[168:171], a[108:111], a[20:23], v[168:171]
v_mfma_f32_16x16x32_bf16 v[176:179], a[108:111], a[28:31], v[176:179]
s_xor_b32 m0, s84, 0
v_mfma_f32_16x16x32_bf16 v[176:179], a[104:107], a[24:27], v[176:179]
s_xor_b32 s64, s72, 512
ds_read_b64_tr_b16 a[104:105], v8 offset:32768
v_mfma_f32_16x16x32_bf16 v[180:183], a[112:115], a[24:27], v[180:183]
buffer_load_dwordx4 v12, s[48:51], s64 offen lds
v_mfma_f32_16x16x32_bf16 v[180:183], a[116:119], a[28:31], v[180:183]
ds_read_b64_tr_b16 a[106:107], v8 offset:33792
v_add_u32 v4, 0x8000, v4
v_mfma_f32_16x16x32_bf16 v[172:175], a[116:119], a[20:23], v[172:175]
ds_read_b64_tr_b16 a[108:109], v8 offset:40960
v_mfma_f32_16x16x32_bf16 v[172:175], a[112:115], a[16:19], v[172:175]
s_xor_b32 m0, s84, 1024
ds_read_b64_tr_b16 a[110:111], v8 offset:41984
v_mfma_f32_16x16x32_bf16 v[164:167], a[112:115], a[8:11], v[164:167]
s_xor_b32 s64, s72, 16896
v_mfma_f32_16x16x32_bf16 v[164:167], a[116:119], a[12:15], v[164:167]
buffer_load_dwordx4 v13, s[48:51], s64 offen lds
v_mfma_f32_16x16x32_bf16 v[156:159], a[116:119], a[4:7], v[156:159]
v_mfma_f32_16x16x32_bf16 v[156:159], a[112:115], a[0:3], v[156:159]
ds_read_b64_tr_b16 a[112:113], v9 offset:32768
v_mfma_f32_16x16x32_bf16 v[24:27], a[72:75], a[0:3], v[24:27]
s_xor_b32 m0, s84, 2048
ds_read_b64_tr_b16 a[114:115], v9 offset:33792
v_mfma_f32_16x16x32_bf16 v[24:27], a[76:79], a[4:7], v[24:27]
s_xor_b32 s64, s72, 131584
ds_read_b64_tr_b16 a[116:117], v9 offset:40960
v_add_u32 v5, 0x8000, v5
v_mfma_f32_16x16x32_bf16 v[40:43], a[76:79], a[12:15], v[40:43]
buffer_load_dwordx4 v12, s[48:51], s64 offen lds
v_mfma_f32_16x16x32_bf16 v[40:43], a[72:75], a[8:11], v[40:43]
ds_read_b64_tr_b16 a[118:119], v9 offset:41984
v_mfma_f32_16x16x32_bf16 v[56:59], a[72:75], a[16:19], v[56:59]
v_mfma_f32_16x16x32_bf16 v[56:59], a[76:79], a[20:23], v[56:59]
s_xor_b32 m0, s84, 3072
v_mfma_f32_16x16x32_bf16 v[72:75], a[76:79], a[28:31], v[72:75]
s_waitcnt vmcnt(13)
s_xor_b32 s64, s72, 147968
ds_read_b128 a[32:35], v2 offset:32768
v_mfma_f32_16x16x32_bf16 v[72:75], a[72:75], a[24:27], v[72:75]
buffer_load_dwordx4 v13, s[48:51], s64 offen lds
v_mfma_f32_16x16x32_bf16 v[136:139], a[80:83], a[24:27], v[136:139]
ds_read_b128 a[36:39], v3 offset:32768
v_mfma_f32_16x16x32_bf16 v[136:139], a[84:87], a[28:31], v[136:139]
ds_read_b128 a[40:43], v2 offset:34816
v_add_u32 v6, 0x8000, v6
v_mfma_f32_16x16x32_bf16 v[120:123], a[84:87], a[20:23], v[120:123]
s_xor_b32 m0, s84, 4096
ds_read_b128 a[44:47], v3 offset:34816
v_mfma_f32_16x16x32_bf16 v[120:123], a[80:83], a[16:19], v[120:123]
s_xor_b32 s64, s73, 512
ds_read_b128 a[48:51], v2 offset:36864
v_mfma_f32_16x16x32_bf16 v[104:107], a[80:83], a[8:11], v[104:107]
buffer_load_dwordx4 v12, s[48:51], s64 offen lds
v_mfma_f32_16x16x32_bf16 v[104:107], a[84:87], a[12:15], v[104:107]
ds_read_b128 a[52:55], v3 offset:36864
v_mfma_f32_16x16x32_bf16 v[88:91], a[84:87], a[4:7], v[88:91]
s_add_u32 s65, s79, 5120
ds_read_b128 a[56:59], v2 offset:38912
v_mfma_f32_16x16x32_bf16 v[88:91], a[80:83], a[0:3], v[88:91]
s_waitcnt lgkmcnt(7)
s_xor_b32 m0, s84, 5120
buffer_store_dwordx4 a[160:163], v16, s[44:47], s65 offen sc1
v_mfma_f32_16x16x32_bf16 v[28:31], a[88:91], a[0:3], v[28:31]
s_xor_b32 s64, s73, 16896
ds_read_b128 a[60:63], v3 offset:38912
v_mfma_f32_16x16x32_bf16 v[28:31], a[92:95], a[4:7], v[28:31]
buffer_load_dwordx4 v13, s[48:51], s64 offen lds
v_mfma_f32_16x16x32_bf16 v[44:47], a[92:95], a[12:15], v[44:47]
ds_read_b64_tr_b16 a[72:73], v10 offset:32768
v_add_u32 v7, 0x8000, v7
v_mfma_f32_16x16x32_bf16 v[44:47], a[88:91], a[8:11], v[44:47]
ds_read_b64_tr_b16 a[74:75], v10 offset:33792
v_mfma_f32_16x16x32_bf16 v[60:63], a[88:91], a[16:19], v[60:63]
s_xor_b32 m0, s84, 6144
ds_read_b64_tr_b16 a[76:77], v10 offset:40960
v_mfma_f32_16x16x32_bf16 v[60:63], a[92:95], a[20:23], v[60:63]
s_xor_b32 s64, s73, 131584
ds_read_b64_tr_b16 a[78:79], v10 offset:41984
v_mfma_f32_16x16x32_bf16 v[76:79], a[92:95], a[28:31], v[76:79]
buffer_load_dwordx4 v12, s[48:51], s64 offen lds
v_mfma_f32_16x16x32_bf16 v[76:79], a[88:91], a[24:27], v[76:79]
ds_read_b64_tr_b16 a[80:81], v11 offset:32768
v_mfma_f32_16x16x32_bf16 v[140:143], a[96:99], a[24:27], v[140:143]
ds_read_b64_tr_b16 a[82:83], v11 offset:33792
v_mfma_f32_16x16x32_bf16 v[140:143], a[100:103], a[28:31], v[140:143]
s_xor_b32 m0, s84, 7168
ds_read_b64_tr_b16 a[84:85], v11 offset:40960
v_add_u32 v8, 0x8000, v8
v_mfma_f32_16x16x32_bf16 v[124:127], a[100:103], a[20:23], v[124:127]
s_xor_b32 s64, s73, 147968
ds_read_b64_tr_b16 a[86:87], v11 offset:41984
v_mfma_f32_16x16x32_bf16 v[124:127], a[96:99], a[16:19], v[124:127]
buffer_load_dwordx4 v13, s[48:51], s64 offen lds
v_mfma_f32_16x16x32_bf16 v[108:111], a[96:99], a[8:11], v[108:111]
v_mfma_f32_16x16x32_bf16 v[108:111], a[100:103], a[12:15], v[108:111]
v_mfma_f32_16x16x32_bf16 v[92:95], a[100:103], a[4:7], v[92:95]
v_add_u32 v9, 0x8000, v9
v_add_u32 v10, 0x8000, v10
v_mfma_f32_16x16x32_bf16 v[92:95], a[96:99], a[0:3], v[92:95]
v_add_u32 v11, 0x8000, v11
v_mfma_f32_16x16x32_bf16 v[32:35], a[104:107], a[0:3], v[32:35]
v_mfma_f32_16x16x32_bf16 v[32:35], a[108:111], a[4:7], v[32:35]
v_mfma_f32_16x16x32_bf16 v[48:51], a[108:111], a[12:15], v[48:51]
s_waitcnt lgkmcnt(0)
s_barrier
v_mfma_f32_16x16x32_bf16 v[48:51], a[104:107], a[8:11], v[48:51]
s_xor_b32 m0, s77, 98304
ds_read_b64_tr_b16 a[88:89], v19 offset:36864
v_mfma_f32_16x16x32_bf16 v[64:67], a[104:107], a[16:19], v[64:67]
s_xor_b32 s64, s71, 2621440
ds_read_b64_tr_b16 a[90:91], v19 offset:37120
v_mfma_f32_16x16x32_bf16 v[64:67], a[108:111], a[20:23], v[64:67]
buffer_load_dwordx4 v14, s[56:59], s64 offen lds
v_mfma_f32_16x16x32_bf16 v[80:83], a[108:111], a[28:31], v[80:83]
ds_read_b64_tr_b16 a[92:93], v19 offset:38912
v_mfma_f32_16x16x32_bf16 v[80:83], a[104:107], a[24:27], v[80:83]
ds_read_b64_tr_b16 a[94:95], v19 offset:39168
v_mfma_f32_16x16x32_bf16 v[144:147], a[112:115], a[24:27], v[144:147]
ds_read_b64_tr_b16 a[96:97], v20 offset:36864
v_mfma_f32_16x16x32_bf16 v[144:147], a[116:119], a[28:31], v[144:147]
ds_read_b64_tr_b16 a[98:99], v20 offset:37120
v_mfma_f32_16x16x32_bf16 v[128:131], a[116:119], a[20:23], v[128:131]
ds_read_b64_tr_b16 a[100:101], v20 offset:38912
v_mfma_f32_16x16x32_bf16 v[128:131], a[112:115], a[16:19], v[128:131]
ds_read_b64_tr_b16 a[102:103], v20 offset:39168
v_mfma_f32_16x16x32_bf16 v[112:115], a[112:115], a[8:11], v[112:115]
s_add_u32 m0, s78, 114688
ds_read_b64_tr_b16 a[104:105], v19 offset:40960
v_mfma_f32_16x16x32_bf16 v[112:115], a[116:119], a[12:15], v[112:115]
s_add_u32 s64, s75, 1966080
ds_read_b64_tr_b16 a[106:107], v19 offset:41216
v_mfma_f32_16x16x32_bf16 v[96:99], a[116:119], a[4:7], v[96:99]
buffer_load_dwordx4 v23, s[60:63], s64 offen lds
v_mfma_f32_16x16x32_bf16 v[96:99], a[112:115], a[0:3], v[96:99]
ds_read_b64_tr_b16 a[108:109], v19 offset:43008
v_mfma_f32_16x16x32_bf16 v[36:39], a[72:75], a[0:3], v[36:39]
ds_read_b64_tr_b16 a[110:111], v19 offset:43264
v_mfma_f32_16x16x32_bf16 v[36:39], a[76:79], a[4:7], v[36:39]
ds_read_b64_tr_b16 a[112:113], v20 offset:40960
v_mfma_f32_16x16x32_bf16 v[52:55], a[76:79], a[12:15], v[52:55]
ds_read_b64_tr_b16 a[114:115], v20 offset:41216
v_mfma_f32_16x16x32_bf16 v[52:55], a[72:75], a[8:11], v[52:55]
ds_read_b64_tr_b16 a[116:117], v20 offset:43008
v_mfma_f32_16x16x32_bf16 v[68:71], a[72:75], a[16:19], v[68:71]
s_xor_b32 m0, s77, 99328
ds_read_b64_tr_b16 a[118:119], v20 offset:43264
v_mfma_f32_16x16x32_bf16 v[68:71], a[76:79], a[20:23], v[68:71]
s_xor_b32 s64, s71, 2654208
s_xor_b32 s68, s66, 8192
v_mfma_f32_16x16x32_bf16 v[84:87], a[76:79], a[28:31], v[84:87]
s_mov_b64 exec, 1
buffer_atomic_add a251, v1, s[52:55], s68 offen offset:0 sc1
s_mov_b64 exec, -1
v_mfma_f32_16x16x32_bf16 v[84:87], a[72:75], a[24:27], v[84:87]
buffer_load_dwordx4 v14, s[56:59], s64 offen lds
v_mfma_f32_16x16x32_bf16 v[148:151], a[80:83], a[24:27], v[148:151]
ds_read_b64_tr_b16 a[72:73], v19 offset:32768
v_mfma_f32_16x16x32_bf16 v[148:151], a[84:87], a[28:31], v[148:151]
ds_read_b64_tr_b16 a[74:75], v19 offset:33024
v_mfma_f32_16x16x32_bf16 v[132:135], a[84:87], a[20:23], v[132:135]
s_add_u32 s65, s79, 1024
ds_read_b64_tr_b16 a[76:77], v19 offset:34816
v_mfma_f32_16x16x32_bf16 v[132:135], a[80:83], a[16:19], v[132:135]
buffer_store_dwordx4 a[164:167], v16, s[44:47], s65 offen sc1
v_mfma_f32_16x16x32_bf16 v[116:119], a[80:83], a[8:11], v[116:119]
ds_read_b64_tr_b16 a[78:79], v19 offset:35072
v_mfma_f32_16x16x32_bf16 v[116:119], a[84:87], a[12:15], v[116:119]
v_mfma_f32_16x16x32_bf16 v[100:103], a[84:87], a[4:7], v[100:103]
s_add_u32 m0, s78, 118784
v_mfma_f32_16x16x32_bf16 v[100:103], a[80:83], a[0:3], v[100:103]
s_waitcnt lgkmcnt(4)
s_add_u32 s64, s75, 1968128
ds_read_b64_tr_b16 a[80:81], v20 offset:32768
v_mfma_f32_16x16x32_bf16 v[184:187], a[88:91], a[32:35], v[184:187]
buffer_load_dwordx4 v23, s[60:63], s64 offen lds
v_mfma_f32_16x16x32_bf16 v[184:187], a[92:95], a[36:39], v[184:187]
ds_read_b64_tr_b16 a[82:83], v20 offset:33024
v_mfma_f32_16x16x32_bf16 v[192:195], a[92:95], a[44:47], v[192:195]
ds_read_b64_tr_b16 a[84:85], v20 offset:34816
v_mfma_f32_16x16x32_bf16 v[192:195], a[88:91], a[40:43], v[192:195]
ds_read_b64_tr_b16 a[86:87], v20 offset:35072
v_mfma_f32_16x16x32_bf16 v[200:203], a[88:91], a[48:51], v[200:203]
v_mfma_f32_16x16x32_bf16 v[200:203], a[92:95], a[52:55], v[200:203]
v_mfma_f32_16x16x32_bf16 v[208:211], a[92:95], a[60:63], v[208:211]
v_mfma_f32_16x16x32_bf16 v[208:211], a[88:91], a[56:59], v[208:211]
ds_read_b64_tr_b16 a[88:89], v4 offset:32768
v_mfma_f32_16x16x32_bf16 v[212:215], a[96:99], a[56:59], v[212:215]
s_xor_b32 m0, s77, 100352
ds_read_b64_tr_b16 a[90:91], v4 offset:33792
v_mfma_f32_16x16x32_bf16 v[212:215], a[100:103], a[60:63], v[212:215]
s_xor_b32 s64, s71, 2686976
ds_read_b64_tr_b16 a[92:93], v4 offset:40960
v_mfma_f32_16x16x32_bf16 v[204:207], a[100:103], a[52:55], v[204:207]
buffer_load_dwordx4 v15, s[56:59], s64 offen lds
v_mfma_f32_16x16x32_bf16 v[204:207], a[96:99], a[48:51], v[204:207]
ds_read_b64_tr_b16 a[94:95], v4 offset:41984
v_mfma_f32_16x16x32_bf16 v[196:199], a[96:99], a[40:43], v[196:199]
v_mfma_f32_16x16x32_bf16 v[196:199], a[100:103], a[44:47], v[196:199]
v_mfma_f32_16x16x32_bf16 v[188:191], a[100:103], a[36:39], v[188:191]
v_mfma_f32_16x16x32_bf16 v[188:191], a[96:99], a[32:35], v[188:191]
ds_read_b64_tr_b16 a[96:97], v5 offset:32768
v_mfma_f32_16x16x32_bf16 v[216:219], a[32:35], a[104:107], v[216:219]
ds_read_b64_tr_b16 a[98:99], v5 offset:33792
v_mfma_f32_16x16x32_bf16 v[216:219], a[36:39], a[108:111], v[216:219]
s_add_u32 m0, s78, 122880
ds_read_b64_tr_b16 a[100:101], v5 offset:40960
v_mfma_f32_16x16x32_bf16 v[224:227], a[44:47], a[108:111], v[224:227]
s_add_u32 s64, s75, 1970176
ds_read_b64_tr_b16 a[102:103], v5 offset:41984
v_mfma_f32_16x16x32_bf16 v[224:227], a[40:43], a[104:107], v[224:227]
buffer_load_dwordx4 v23, s[60:63], s64 offen lds
v_mfma_f32_16x16x32_bf16 v[232:235], a[48:51], a[104:107], v[232:235]
v_mfma_f32_16x16x32_bf16 v[232:235], a[52:55], a[108:111], v[232:235]
v_mfma_f32_16x16x32_bf16 v[240:243], a[60:63], a[108:111], v[240:243]
v_mfma_f32_16x16x32_bf16 v[240:243], a[56:59], a[104:107], v[240:243]
ds_read_b64_tr_b16 a[104:105], v6 offset:32768
v_mfma_f32_16x16x32_bf16 v[244:247], a[56:59], a[112:115], v[244:247]
ds_read_b64_tr_b16 a[106:107], v6 offset:33792
v_mfma_f32_16x16x32_bf16 v[244:247], a[60:63], a[116:119], v[244:247]
ds_read_b64_tr_b16 a[108:109], v6 offset:40960
v_subrev_u32 v19, 0x8000, v19
v_mfma_f32_16x16x32_bf16 v[236:239], a[52:55], a[116:119], v[236:239]
s_xor_b32 m0, s77, 101376
ds_read_b64_tr_b16 a[110:111], v6 offset:41984
v_mfma_f32_16x16x32_bf16 v[236:239], a[48:51], a[112:115], v[236:239]
s_xor_b32 s64, s71, 2719744
v_mfma_f32_16x16x32_bf16 v[228:231], a[40:43], a[112:115], v[228:231]
buffer_load_dwordx4 v15, s[56:59], s64 offen lds
v_mfma_f32_16x16x32_bf16 v[228:231], a[44:47], a[116:119], v[228:231]
v_mfma_f32_16x16x32_bf16 v[220:223], a[36:39], a[116:119], v[220:223]
v_mfma_f32_16x16x32_bf16 v[220:223], a[32:35], a[112:115], v[220:223]
s_waitcnt lgkmcnt(4)
ds_read_b64_tr_b16 a[112:113], v7 offset:32768
v_mfma_f32_16x16x32_bf16 v[152:155], a[72:75], a[32:35], v[152:155]
ds_read_b64_tr_b16 a[114:115], v7 offset:33792
v_mfma_f32_16x16x32_bf16 v[152:155], a[76:79], a[36:39], v[152:155]
ds_read_b64_tr_b16 a[116:117], v7 offset:40960
v_subrev_u32 v20, 0x8000, v20
v_mfma_f32_16x16x32_bf16 v[160:163], a[76:79], a[44:47], v[160:163]
ds_read_b64_tr_b16 a[118:119], v7 offset:41984
v_mfma_f32_16x16x32_bf16 v[160:163], a[72:75], a[40:43], v[160:163]
v_mfma_f32_16x16x32_bf16 v[168:171], a[72:75], a[48:51], v[168:171]
v_mfma_f32_16x16x32_bf16 v[168:171], a[76:79], a[52:55], v[168:171]
v_mfma_f32_16x16x32_bf16 v[176:179], a[76:79], a[60:63], v[176:179]
s_xor_b32 m0, s84, 32768
v_mfma_f32_16x16x32_bf16 v[176:179], a[72:75], a[56:59], v[176:179]
s_xor_b32 s64, s72, 640
ds_read_b64_tr_b16 a[72:73], v8 offset:32768
v_mfma_f32_16x16x32_bf16 v[180:183], a[80:83], a[56:59], v[180:183]
s_add_u32 s65, s79, 18432
buffer_load_dwordx4 v12, s[48:51], s64 offen lds
v_mfma_f32_16x16x32_bf16 v[180:183], a[84:87], a[60:63], v[180:183]
buffer_store_dwordx4 a[168:171], v16, s[44:47], s65 offen sc1
v_mfma_f32_16x16x32_bf16 v[172:175], a[84:87], a[52:55], v[172:175]
ds_read_b64_tr_b16 a[74:75], v8 offset:33792
v_subrev_u32 v4, 0x8000, v4
v_mfma_f32_16x16x32_bf16 v[172:175], a[80:83], a[48:51], v[172:175]
s_xor_b32 m0, s84, 33792
ds_read_b64_tr_b16 a[76:77], v8 offset:40960
v_mfma_f32_16x16x32_bf16 v[164:167], a[80:83], a[40:43], v[164:167]
s_xor_b32 s64, s72, 17024
ds_read_b64_tr_b16 a[78:79], v8 offset:41984
v_mfma_f32_16x16x32_bf16 v[164:167], a[84:87], a[44:47], v[164:167]
buffer_load_dwordx4 v13, s[48:51], s64 offen lds
v_mfma_f32_16x16x32_bf16 v[156:159], a[84:87], a[36:39], v[156:159]
v_mfma_f32_16x16x32_bf16 v[156:159], a[80:83], a[32:35], v[156:159]
ds_read_b64_tr_b16 a[80:81], v9 offset:32768
v_mfma_f32_16x16x32_bf16 v[24:27], a[88:91], a[32:35], v[24:27]
s_xor_b32 m0, s84, 34816
ds_read_b64_tr_b16 a[82:83], v9 offset:33792
v_mfma_f32_16x16x32_bf16 v[24:27], a[92:95], a[36:39], v[24:27]
s_xor_b32 s64, s72, 131712
ds_read_b64_tr_b16 a[84:85], v9 offset:40960
v_subrev_u32 v5, 0x8000, v5
v_mfma_f32_16x16x32_bf16 v[40:43], a[92:95], a[44:47], v[40:43]
buffer_load_dwordx4 v12, s[48:51], s64 offen lds
v_mfma_f32_16x16x32_bf16 v[40:43], a[88:91], a[40:43], v[40:43]
ds_read_b64_tr_b16 a[86:87], v9 offset:41984
v_mfma_f32_16x16x32_bf16 v[56:59], a[88:91], a[48:51], v[56:59]
v_mfma_f32_16x16x32_bf16 v[56:59], a[92:95], a[52:55], v[56:59]
s_xor_b32 m0, s84, 35840
v_mfma_f32_16x16x32_bf16 v[72:75], a[92:95], a[60:63], v[72:75]
s_waitcnt vmcnt(13)
s_xor_b32 s64, s72, 148096
ds_read_b128 a[0:3], v2 offset:0
v_mfma_f32_16x16x32_bf16 v[72:75], a[88:91], a[56:59], v[72:75]
buffer_load_dwordx4 v13, s[48:51], s64 offen lds
v_mfma_f32_16x16x32_bf16 v[136:139], a[96:99], a[56:59], v[136:139]
ds_read_b128 a[4:7], v3 offset:0
v_mfma_f32_16x16x32_bf16 v[136:139], a[100:103], a[60:63], v[136:139]
ds_read_b128 a[8:11], v2 offset:2048
v_subrev_u32 v6, 0x8000, v6
v_mfma_f32_16x16x32_bf16 v[120:123], a[100:103], a[52:55], v[120:123]
s_xor_b32 m0, s84, 36864
ds_read_b128 a[12:15], v3 offset:2048
v_mfma_f32_16x16x32_bf16 v[120:123], a[96:99], a[48:51], v[120:123]
s_xor_b32 s64, s73, 640
ds_read_b128 a[16:19], v2 offset:4096
v_mfma_f32_16x16x32_bf16 v[104:107], a[96:99], a[40:43], v[104:107]
buffer_load_dwordx4 v12, s[48:51], s64 offen lds
v_mfma_f32_16x16x32_bf16 v[104:107], a[100:103], a[44:47], v[104:107]
ds_read_b128 a[20:23], v3 offset:4096
v_mfma_f32_16x16x32_bf16 v[88:91], a[100:103], a[36:39], v[88:91]
ds_read_b128 a[24:27], v2 offset:6144
v_mfma_f32_16x16x32_bf16 v[88:91], a[96:99], a[32:35], v[88:91]
s_waitcnt lgkmcnt(7)
s_xor_b32 m0, s84, 37888
ds_read_b128 a[28:31], v3 offset:6144
v_mfma_f32_16x16x32_bf16 v[28:31], a[104:107], a[32:35], v[28:31]
s_xor_b32 s64, s73, 17024
ds_read_b64_tr_b16 a[88:89], v10 offset:32768
v_mfma_f32_16x16x32_bf16 v[28:31], a[108:111], a[36:39], v[28:31]
buffer_load_dwordx4 v13, s[48:51], s64 offen lds
v_mfma_f32_16x16x32_bf16 v[44:47], a[108:111], a[44:47], v[44:47]
ds_read_b64_tr_b16 a[90:91], v10 offset:33792
v_subrev_u32 v7, 0x8000, v7
v_mfma_f32_16x16x32_bf16 v[44:47], a[104:107], a[40:43], v[44:47]
ds_read_b64_tr_b16 a[92:93], v10 offset:40960
v_mfma_f32_16x16x32_bf16 v[60:63], a[104:107], a[48:51], v[60:63]
s_xor_b32 m0, s84, 38912
ds_read_b64_tr_b16 a[94:95], v10 offset:41984
v_mfma_f32_16x16x32_bf16 v[60:63], a[108:111], a[52:55], v[60:63]
s_xor_b32 s64, s73, 131712
ds_read_b64_tr_b16 a[96:97], v11 offset:32768
v_mfma_f32_16x16x32_bf16 v[76:79], a[108:111], a[60:63], v[76:79]
buffer_load_dwordx4 v12, s[48:51], s64 offen lds
v_mfma_f32_16x16x32_bf16 v[76:79], a[104:107], a[56:59], v[76:79]
ds_read_b64_tr_b16 a[98:99], v11 offset:33792
v_mfma_f32_16x16x32_bf16 v[140:143], a[112:115], a[56:59], v[140:143]
ds_read_b64_tr_b16 a[100:101], v11 offset:40960
v_mfma_f32_16x16x32_bf16 v[140:143], a[116:119], a[60:63], v[140:143]
s_xor_b32 m0, s84, 39936
ds_read_b64_tr_b16 a[102:103], v11 offset:41984
v_subrev_u32 v8, 0x8000, v8
v_mfma_f32_16x16x32_bf16 v[124:127], a[116:119], a[52:55], v[124:127]
s_xor_b32 s64, s73, 148096
v_mfma_f32_16x16x32_bf16 v[124:127], a[112:115], a[48:51], v[124:127]
buffer_load_dwordx4 v13, s[48:51], s64 offen lds
v_mfma_f32_16x16x32_bf16 v[108:111], a[112:115], a[40:43], v[108:111]
v_mfma_f32_16x16x32_bf16 v[108:111], a[116:119], a[44:47], v[108:111]
v_mfma_f32_16x16x32_bf16 v[92:95], a[116:119], a[36:39], v[92:95]
v_subrev_u32 v9, 0x8000, v9
v_subrev_u32 v10, 0x8000, v10
v_mfma_f32_16x16x32_bf16 v[92:95], a[112:115], a[32:35], v[92:95]
v_subrev_u32 v11, 0x8000, v11
v_mfma_f32_16x16x32_bf16 v[32:35], a[72:75], a[32:35], v[32:35]
v_mfma_f32_16x16x32_bf16 v[32:35], a[76:79], a[36:39], v[32:35]
v_mfma_f32_16x16x32_bf16 v[48:51], a[76:79], a[44:47], v[48:51]
s_waitcnt lgkmcnt(0)
s_barrier
v_mfma_f32_16x16x32_bf16 v[48:51], a[72:75], a[40:43], v[48:51]
s_xor_b32 m0, s77, 131072
ds_read_b64_tr_b16 a[104:105], v19 offset:4096
v_mfma_f32_16x16x32_bf16 v[64:67], a[72:75], a[48:51], v[64:67]
s_xor_b32 s64, s71, 3145728
ds_read_b64_tr_b16 a[106:107], v19 offset:4352
v_mfma_f32_16x16x32_bf16 v[64:67], a[76:79], a[52:55], v[64:67]
s_add_u32 s65, s79, 6144
buffer_load_dwordx4 v14, s[56:59], s64 offen lds
v_mfma_f32_16x16x32_bf16 v[80:83], a[76:79], a[60:63], v[80:83]
buffer_store_dwordx4 a[172:175], v16, s[44:47], s65 offen sc1
v_mfma_f32_16x16x32_bf16 v[80:83], a[72:75], a[56:59], v[80:83]
ds_read_b64_tr_b16 a[108:109], v19 offset:6144
v_mfma_f32_16x16x32_bf16 v[144:147], a[80:83], a[56:59], v[144:147]
ds_read_b64_tr_b16 a[110:111], v19 offset:6400
v_mfma_f32_16x16x32_bf16 v[144:147], a[84:87], a[60:63], v[144:147]
ds_read_b64_tr_b16 a[112:113], v20 offset:4096
v_mfma_f32_16x16x32_bf16 v[128:131], a[84:87], a[52:55], v[128:131]
ds_read_b64_tr_b16 a[114:115], v20 offset:4352
v_mfma_f32_16x16x32_bf16 v[128:131], a[80:83], a[48:51], v[128:131]
ds_read_b64_tr_b16 a[116:117], v20 offset:6144
v_mfma_f32_16x16x32_bf16 v[112:115], a[80:83], a[40:43], v[112:115]
s_add_u32 m0, s78, 147456
ds_read_b64_tr_b16 a[118:119], v20 offset:6400
v_mfma_f32_16x16x32_bf16 v[112:115], a[84:87], a[44:47], v[112:115]
s_add_u32 s64, s75, 2359296
ds_read_b64_tr_b16 a[72:73], v19 offset:8192
v_mfma_f32_16x16x32_bf16 v[96:99], a[84:87], a[36:39], v[96:99]
s_branch L_po8
L_pg8:
s_branch L_pg12
L_po8:
buffer_load_dwordx4 v23, s[60:63], s64 offen lds
v_mfma_f32_16x16x32_bf16 v[96:99], a[80:83], a[32:35], v[96:99]
ds_read_b64_tr_b16 a[74:75], v19 offset:8448
v_mfma_f32_16x16x32_bf16 v[36:39], a[88:91], a[32:35], v[36:39]
ds_read_b64_tr_b16 a[76:77], v19 offset:10240
v_mfma_f32_16x16x32_bf16 v[36:39], a[92:95], a[36:39], v[36:39]
ds_read_b64_tr_b16 a[78:79], v19 offset:10496
v_mfma_f32_16x16x32_bf16 v[52:55], a[92:95], a[44:47], v[52:55]
ds_read_b64_tr_b16 a[80:81], v20 offset:8192
v_mfma_f32_16x16x32_bf16 v[52:55], a[88:91], a[40:43], v[52:55]
ds_read_b64_tr_b16 a[82:83], v20 offset:8448
v_mfma_f32_16x16x32_bf16 v[68:71], a[88:91], a[48:51], v[68:71]
s_xor_b32 m0, s77, 132096
ds_read_b64_tr_b16 a[84:85], v20 offset:10240
v_mfma_f32_16x16x32_bf16 v[68:71], a[92:95], a[52:55], v[68:71]
s_xor_b32 s64, s71, 3178496
s_xor_b32 s68, s66, 12288
ds_read_b64_tr_b16 a[86:87], v20 offset:10496
v_mfma_f32_16x16x32_bf16 v[84:87], a[92:95], a[60:63], v[84:87]
s_mov_b64 exec, 1
buffer_atomic_add a251, v1, s[52:55], s68 offen offset:0 sc1
s_mov_b64 exec, -1
v_mfma_f32_16x16x32_bf16 v[84:87], a[88:91], a[56:59], v[84:87]
buffer_load_dwordx4 v14, s[56:59], s64 offen lds
v_mfma_f32_16x16x32_bf16 v[148:151], a[96:99], a[56:59], v[148:151]
ds_read_b64_tr_b16 a[88:89], v19 offset:0
v_mfma_f32_16x16x32_bf16 v[148:151], a[100:103], a[60:63], v[148:151]
ds_read_b64_tr_b16 a[90:91], v19 offset:256
v_mfma_f32_16x16x32_bf16 v[132:135], a[100:103], a[52:55], v[132:135]
ds_read_b64_tr_b16 a[92:93], v19 offset:2048
v_mfma_f32_16x16x32_bf16 v[132:135], a[96:99], a[48:51], v[132:135]
ds_read_b64_tr_b16 a[94:95], v19 offset:2304
v_mfma_f32_16x16x32_bf16 v[116:119], a[96:99], a[40:43], v[116:119]
v_mfma_f32_16x16x32_bf16 v[116:119], a[100:103], a[44:47], v[116:119]
v_mfma_f32_16x16x32_bf16 v[100:103], a[100:103], a[36:39], v[100:103]
s_add_u32 m0, s78, 151552
v_mfma_f32_16x16x32_bf16 v[100:103], a[96:99], a[32:35], v[100:103]
s_waitcnt lgkmcnt(4)
s_add_u32 s64, s75, 2361344
ds_read_b64_tr_b16 a[96:97], v20 offset:0
v_mfma_f32_16x16x32_bf16 v[184:187], a[104:107], a[0:3], v[184:187]
s_mov_b32 s36, s20
buffer_load_dwordx4 v23, s[60:63], s64 offen lds
v_mfma_f32_16x16x32_bf16 v[184:187], a[108:111], a[4:7], v[184:187]
s_mov_b32 s37, s21
ds_read_b64_tr_b16 a[98:99], v20 offset:256
v_mfma_f32_16x16x32_bf16 v[192:195], a[108:111], a[12:15], v[192:195]
s_mov_b32 s38, 2097152
ds_read_b64_tr_b16 a[100:101], v20 offset:2048
v_mfma_f32_16x16x32_bf16 v[192:195], a[104:107], a[8:11], v[192:195]
s_mov_b32 s40, s14
ds_read_b64_tr_b16 a[102:103], v20 offset:2304
v_mfma_f32_16x16x32_bf16 v[200:203], a[104:107], a[16:19], v[200:203]
s_mov_b32 s41, s15
v_mfma_f32_16x16x32_bf16 v[200:203], a[108:111], a[20:23], v[200:203]
s_mov_b32 s42, 8388608
v_mfma_f32_16x16x32_bf16 v[208:211], a[108:111], a[28:31], v[208:211]
v_mfma_f32_16x16x32_bf16 v[208:211], a[104:107], a[24:27], v[208:211]
ds_read_b64_tr_b16 a[104:105], v4 offset:0
v_mfma_f32_16x16x32_bf16 v[212:215], a[112:115], a[24:27], v[212:215]
s_xor_b32 m0, s77, 133120
ds_read_b64_tr_b16 a[106:107], v4 offset:1024
v_mfma_f32_16x16x32_bf16 v[212:215], a[116:119], a[28:31], v[212:215]
s_xor_b32 s64, s71, 3211264
ds_read_b64_tr_b16 a[108:109], v4 offset:8192
v_mfma_f32_16x16x32_bf16 v[204:207], a[116:119], a[20:23], v[204:207]
buffer_load_dwordx4 v15, s[56:59], s64 offen lds
v_mfma_f32_16x16x32_bf16 v[204:207], a[112:115], a[16:19], v[204:207]
ds_read_b64_tr_b16 a[110:111], v4 offset:9216
v_mfma_f32_16x16x32_bf16 v[196:199], a[112:115], a[8:11], v[196:199]
v_mfma_f32_16x16x32_bf16 v[196:199], a[116:119], a[12:15], v[196:199]
v_mfma_f32_16x16x32_bf16 v[188:191], a[116:119], a[4:7], v[188:191]
v_mfma_f32_16x16x32_bf16 v[188:191], a[112:115], a[0:3], v[188:191]
ds_read_b64_tr_b16 a[112:113], v5 offset:0
v_mfma_f32_16x16x32_bf16 v[216:219], a[0:3], a[72:75], v[216:219]
ds_read_b64_tr_b16 a[114:115], v5 offset:1024
v_mfma_f32_16x16x32_bf16 v[216:219], a[4:7], a[76:79], v[216:219]
s_add_u32 m0, s78, 155648
s_add_u32 s65, s79, 2048
ds_read_b64_tr_b16 a[116:117], v5 offset:8192
v_mfma_f32_16x16x32_bf16 v[224:227], a[12:15], a[76:79], v[224:227]
s_add_u32 s64, s75, 2363392
buffer_store_dwordx4 a[176:179], v16, s[44:47], s65 offen sc1
v_mfma_f32_16x16x32_bf16 v[224:227], a[8:11], a[72:75], v[224:227]
buffer_load_dwordx4 v23, s[60:63], s64 offen lds
v_mfma_f32_16x16x32_bf16 v[232:235], a[16:19], a[72:75], v[232:235]
ds_read_b64_tr_b16 a[118:119], v5 offset:9216
v_mfma_f32_16x16x32_bf16 v[232:235], a[20:23], a[76:79], v[232:235]
v_mfma_f32_16x16x32_bf16 v[240:243], a[28:31], a[76:79], v[240:243]
v_mfma_f32_16x16x32_bf16 v[240:243], a[24:27], a[72:75], v[240:243]
ds_read_b64_tr_b16 a[72:73], v6 offset:0
v_mfma_f32_16x16x32_bf16 v[244:247], a[24:27], a[80:83], v[244:247]
ds_read_b64_tr_b16 a[74:75], v6 offset:1024
v_mfma_f32_16x16x32_bf16 v[244:247], a[28:31], a[84:87], v[244:247]
ds_read_b64_tr_b16 a[76:77], v6 offset:8192
v_mfma_f32_16x16x32_bf16 v[236:239], a[20:23], a[84:87], v[236:239]
s_xor_b32 m0, s77, 134144
ds_read_b64_tr_b16 a[78:79], v6 offset:9216
v_mfma_f32_16x16x32_bf16 v[236:239], a[16:19], a[80:83], v[236:239]
s_xor_b32 s64, s71, 3244032
v_mfma_f32_16x16x32_bf16 v[228:231], a[8:11], a[80:83], v[228:231]
buffer_load_dwordx4 v15, s[56:59], s64 offen lds
v_mfma_f32_16x16x32_bf16 v[228:231], a[12:15], a[84:87], v[228:231]
v_mfma_f32_16x16x32_bf16 v[220:223], a[4:7], a[84:87], v[220:223]
v_mfma_f32_16x16x32_bf16 v[220:223], a[0:3], a[80:83], v[220:223]
s_waitcnt lgkmcnt(4)
ds_read_b64_tr_b16 a[80:81], v7 offset:0
v_mfma_f32_16x16x32_bf16 v[152:155], a[88:91], a[0:3], v[152:155]
ds_read_b64_tr_b16 a[82:83], v7 offset:1024
v_mfma_f32_16x16x32_bf16 v[152:155], a[92:95], a[4:7], v[152:155]
ds_read_b64_tr_b16 a[84:85], v7 offset:8192
v_mfma_f32_16x16x32_bf16 v[160:163], a[92:95], a[12:15], v[160:163]
ds_read_b64_tr_b16 a[86:87], v7 offset:9216
v_mfma_f32_16x16x32_bf16 v[160:163], a[88:91], a[8:11], v[160:163]
v_mfma_f32_16x16x32_bf16 v[168:171], a[88:91], a[16:19], v[168:171]
v_mfma_f32_16x16x32_bf16 v[168:171], a[92:95], a[20:23], v[168:171]
v_mfma_f32_16x16x32_bf16 v[176:179], a[92:95], a[28:31], v[176:179]
s_xor_b32 m0, s84, 0
v_mfma_f32_16x16x32_bf16 v[176:179], a[88:91], a[24:27], v[176:179]
s_xor_b32 s64, s72, 768
ds_read_b64_tr_b16 a[88:89], v8 offset:0
v_mfma_f32_16x16x32_bf16 v[180:183], a[96:99], a[24:27], v[180:183]
buffer_load_dwordx4 v12, s[48:51], s64 offen lds
v_mfma_f32_16x16x32_bf16 v[180:183], a[100:103], a[28:31], v[180:183]
ds_read_b64_tr_b16 a[90:91], v8 offset:1024
v_mfma_f32_16x16x32_bf16 v[172:175], a[100:103], a[20:23], v[172:175]
ds_read_b64_tr_b16 a[92:93], v8 offset:8192
v_mfma_f32_16x16x32_bf16 v[172:175], a[96:99], a[16:19], v[172:175]
s_xor_b32 m0, s84, 1024
ds_read_b64_tr_b16 a[94:95], v8 offset:9216
v_mfma_f32_16x16x32_bf16 v[164:167], a[96:99], a[8:11], v[164:167]
s_xor_b32 s64, s72, 17152
v_mfma_f32_16x16x32_bf16 v[164:167], a[100:103], a[12:15], v[164:167]
buffer_load_dwordx4 v13, s[48:51], s64 offen lds
v_mfma_f32_16x16x32_bf16 v[156:159], a[100:103], a[4:7], v[156:159]
v_mfma_f32_16x16x32_bf16 v[156:159], a[96:99], a[0:3], v[156:159]
ds_read_b64_tr_b16 a[96:97], v9 offset:0
v_mfma_f32_16x16x32_bf16 v[24:27], a[104:107], a[0:3], v[24:27]
s_xor_b32 m0, s84, 2048
ds_read_b64_tr_b16 a[98:99], v9 offset:1024
v_mfma_f32_16x16x32_bf16 v[24:27], a[108:111], a[4:7], v[24:27]
s_xor_b32 s64, s72, 131840
ds_read_b64_tr_b16 a[100:101], v9 offset:8192
v_mfma_f32_16x16x32_bf16 v[40:43], a[108:111], a[12:15], v[40:43]
buffer_load_dwordx4 v12, s[48:51], s64 offen lds
v_mfma_f32_16x16x32_bf16 v[40:43], a[104:107], a[8:11], v[40:43]
ds_read_b64_tr_b16 a[102:103], v9 offset:9216
v_mfma_f32_16x16x32_bf16 v[56:59], a[104:107], a[16:19], v[56:59]
v_mfma_f32_16x16x32_bf16 v[56:59], a[108:111], a[20:23], v[56:59]
s_xor_b32 m0, s84, 3072
v_mfma_f32_16x16x32_bf16 v[72:75], a[108:111], a[28:31], v[72:75]
s_waitcnt vmcnt(13)
s_xor_b32 s64, s72, 148224
ds_read_b128 a[32:35], v2 offset:32768
v_mfma_f32_16x16x32_bf16 v[72:75], a[104:107], a[24:27], v[72:75]
buffer_load_dwordx4 v13, s[48:51], s64 offen lds
v_mfma_f32_16x16x32_bf16 v[136:139], a[112:115], a[24:27], v[136:139]
ds_read_b128 a[36:39], v3 offset:32768
v_mfma_f32_16x16x32_bf16 v[136:139], a[116:119], a[28:31], v[136:139]
ds_read_b128 a[40:43], v2 offset:34816
v_mfma_f32_16x16x32_bf16 v[120:123], a[116:119], a[20:23], v[120:123]
s_xor_b32 m0, s84, 4096
ds_read_b128 a[44:47], v3 offset:34816
v_mfma_f32_16x16x32_bf16 v[120:123], a[112:115], a[16:19], v[120:123]
s_xor_b32 s64, s73, 768
ds_read_b128 a[48:51], v2 offset:36864
v_mfma_f32_16x16x32_bf16 v[104:107], a[112:115], a[8:11], v[104:107]
buffer_load_dwordx4 v12, s[48:51], s64 offen lds
v_mfma_f32_16x16x32_bf16 v[104:107], a[116:119], a[12:15], v[104:107]
s_add_u32 s65, s79, 19456
ds_read_b128 a[52:55], v3 offset:36864
v_mfma_f32_16x16x32_bf16 v[88:91], a[116:119], a[4:7], v[88:91]
buffer_store_dwordx4 a[180:183], v16, s[44:47], s65 offen sc1
v_mfma_f32_16x16x32_bf16 v[88:91], a[112:115], a[0:3], v[88:91]
s_waitcnt lgkmcnt(6)
s_xor_b32 m0, s84, 5120
ds_read_b128 a[56:59], v2 offset:38912
v_mfma_f32_16x16x32_bf16 v[28:31], a[72:75], a[0:3], v[28:31]
s_xor_b32 s64, s73, 17152
ds_read_b128 a[60:63], v3 offset:38912
v_mfma_f32_16x16x32_bf16 v[28:31], a[76:79], a[4:7], v[28:31]
buffer_load_dwordx4 v13, s[48:51], s64 offen lds
v_mfma_f32_16x16x32_bf16 v[44:47], a[76:79], a[12:15], v[44:47]
ds_read_b64_tr_b16 a[104:105], v10 offset:0
v_mfma_f32_16x16x32_bf16 v[44:47], a[72:75], a[8:11], v[44:47]
ds_read_b64_tr_b16 a[106:107], v10 offset:1024
v_mfma_f32_16x16x32_bf16 v[60:63], a[72:75], a[16:19], v[60:63]
s_xor_b32 m0, s84, 6144
ds_read_b64_tr_b16 a[108:109], v10 offset:8192
v_mfma_f32_16x16x32_bf16 v[60:63], a[76:79], a[20:23], v[60:63]
s_xor_b32 s64, s73, 131840
ds_read_b64_tr_b16 a[110:111], v10 offset:9216
v_mfma_f32_16x16x32_bf16 v[76:79], a[76:79], a[28:31], v[76:79]
buffer_load_dwordx4 v12, s[48:51], s64 offen lds
v_mfma_f32_16x16x32_bf16 v[76:79], a[72:75], a[24:27], v[76:79]
ds_read_b64_tr_b16 a[112:113], v11 offset:0
v_mfma_f32_16x16x32_bf16 v[140:143], a[80:83], a[24:27], v[140:143]
ds_read_b64_tr_b16 a[114:115], v11 offset:1024
v_mfma_f32_16x16x32_bf16 v[140:143], a[84:87], a[28:31], v[140:143]
s_xor_b32 m0, s84, 7168
ds_read_b64_tr_b16 a[116:117], v11 offset:8192
v_mfma_f32_16x16x32_bf16 v[124:127], a[84:87], a[20:23], v[124:127]
s_xor_b32 s64, s73, 148224
ds_read_b64_tr_b16 a[118:119], v11 offset:9216
v_mfma_f32_16x16x32_bf16 v[124:127], a[80:83], a[16:19], v[124:127]
buffer_load_dwordx4 v13, s[48:51], s64 offen lds
v_mfma_f32_16x16x32_bf16 v[108:111], a[80:83], a[8:11], v[108:111]
v_mfma_f32_16x16x32_bf16 v[108:111], a[84:87], a[12:15], v[108:111]
v_mfma_f32_16x16x32_bf16 v[92:95], a[84:87], a[4:7], v[92:95]
v_mfma_f32_16x16x32_bf16 v[92:95], a[80:83], a[0:3], v[92:95]
v_mfma_f32_16x16x32_bf16 v[32:35], a[88:91], a[0:3], v[32:35]
v_mfma_f32_16x16x32_bf16 v[32:35], a[92:95], a[4:7], v[32:35]
v_mfma_f32_16x16x32_bf16 v[48:51], a[92:95], a[12:15], v[48:51]
s_waitcnt lgkmcnt(0)
s_barrier
v_mfma_f32_16x16x32_bf16 v[48:51], a[88:91], a[8:11], v[48:51]
s_xor_b32 m0, s77, 65536
ds_read_b64_tr_b16 a[72:73], v19 offset:36864
v_mfma_f32_16x16x32_bf16 v[64:67], a[88:91], a[16:19], v[64:67]
s_xor_b32 s64, s71, 3670016
ds_read_b64_tr_b16 a[74:75], v19 offset:37120
v_mfma_f32_16x16x32_bf16 v[64:67], a[92:95], a[20:23], v[64:67]
buffer_load_dwordx4 v14, s[56:59], s64 offen lds
v_mfma_f32_16x16x32_bf16 v[80:83], a[92:95], a[28:31], v[80:83]
ds_read_b64_tr_b16 a[76:77], v19 offset:38912
v_mfma_f32_16x16x32_bf16 v[80:83], a[88:91], a[24:27], v[80:83]
ds_read_b64_tr_b16 a[78:79], v19 offset:39168
v_mfma_f32_16x16x32_bf16 v[144:147], a[96:99], a[24:27], v[144:147]
ds_read_b64_tr_b16 a[80:81], v20 offset:36864
v_mfma_f32_16x16x32_bf16 v[144:147], a[100:103], a[28:31], v[144:147]
ds_read_b64_tr_b16 a[82:83], v20 offset:37120
v_mfma_f32_16x16x32_bf16 v[128:131], a[100:103], a[20:23], v[128:131]
ds_read_b64_tr_b16 a[84:85], v20 offset:38912
v_mfma_f32_16x16x32_bf16 v[128:131], a[96:99], a[16:19], v[128:131]
ds_read_b64_tr_b16 a[86:87], v20 offset:39168
v_mfma_f32_16x16x32_bf16 v[112:115], a[96:99], a[8:11], v[112:115]
s_add_u32 m0, s78, 81920
ds_read_b64_tr_b16 a[88:89], v19 offset:40960
v_mfma_f32_16x16x32_bf16 v[112:115], a[100:103], a[12:15], v[112:115]
s_add_u32 s64, s75, 2752512
ds_read_b64_tr_b16 a[90:91], v19 offset:41216
v_mfma_f32_16x16x32_bf16 v[96:99], a[100:103], a[4:7], v[96:99]
buffer_load_dwordx4 v23, s[60:63], s64 offen lds
v_mfma_f32_16x16x32_bf16 v[96:99], a[96:99], a[0:3], v[96:99]
ds_read_b64_tr_b16 a[92:93], v19 offset:43008
v_mfma_f32_16x16x32_bf16 v[36:39], a[104:107], a[0:3], v[36:39]
ds_read_b64_tr_b16 a[94:95], v19 offset:43264
v_mfma_f32_16x16x32_bf16 v[36:39], a[108:111], a[4:7], v[36:39]
ds_read_b64_tr_b16 a[96:97], v20 offset:40960
v_mfma_f32_16x16x32_bf16 v[52:55], a[108:111], a[12:15], v[52:55]
ds_read_b64_tr_b16 a[98:99], v20 offset:41216
v_mfma_f32_16x16x32_bf16 v[52:55], a[104:107], a[8:11], v[52:55]
ds_read_b64_tr_b16 a[100:101], v20 offset:43008
v_mfma_f32_16x16x32_bf16 v[68:71], a[104:107], a[16:19], v[68:71]
ds_read_b64_tr_b16 a[102:103], v20 offset:43264
v_mfma_f32_16x16x32_bf16 v[68:71], a[108:111], a[20:23], v[68:71]
s_xor_b32 m0, s77, 66560
v_mfma_f32_16x16x32_bf16 v[84:87], a[108:111], a[28:31], v[84:87]
s_xor_b32 s64, s71, 3702784
v_mfma_f32_16x16x32_bf16 v[84:87], a[104:107], a[24:27], v[84:87]
buffer_load_dwordx4 v14, s[56:59], s64 offen lds
v_mfma_f32_16x16x32_bf16 v[148:151], a[112:115], a[24:27], v[148:151]
ds_read_b64_tr_b16 a[104:105], v19 offset:32768
v_mfma_f32_16x16x32_bf16 v[148:151], a[116:119], a[28:31], v[148:151]
ds_read_b64_tr_b16 a[106:107], v19 offset:33024
v_mfma_f32_16x16x32_bf16 v[132:135], a[116:119], a[20:23], v[132:135]
s_add_u32 s65, s79, 7168
ds_read_b64_tr_b16 a[108:109], v19 offset:34816
v_mfma_f32_16x16x32_bf16 v[132:135], a[112:115], a[16:19], v[132:135]
buffer_store_dwordx4 a[184:187], v16, s[44:47], s65 offen sc1
v_mfma_f32_16x16x32_bf16 v[116:119], a[112:115], a[8:11], v[116:119]
ds_read_b64_tr_b16 a[110:111], v19 offset:35072
v_mfma_f32_16x16x32_bf16 v[116:119], a[116:119], a[12:15], v[116:119]
v_mfma_f32_16x16x32_bf16 v[100:103], a[116:119], a[4:7], v[100:103]
s_add_u32 m0, s78, 86016
v_mfma_f32_16x16x32_bf16 v[100:103], a[112:115], a[0:3], v[100:103]
s_waitcnt lgkmcnt(4)
s_add_u32 s64, s75, 2754560
ds_read_b64_tr_b16 a[112:113], v20 offset:32768
v_mfma_f32_16x16x32_bf16 v[184:187], a[72:75], a[32:35], v[184:187]
buffer_load_dwordx4 v23, s[60:63], s64 offen lds
v_mfma_f32_16x16x32_bf16 v[184:187], a[76:79], a[36:39], v[184:187]
ds_read_b64_tr_b16 a[114:115], v20 offset:33024
v_and_b32 v22, 15, v0
v_mfma_f32_16x16x32_bf16 v[192:195], a[76:79], a[44:47], v[192:195]
ds_read_b64_tr_b16 a[116:117], v20 offset:34816
v_lshrrev_b32 v17, 4, v0
v_mfma_f32_16x16x32_bf16 v[192:195], a[72:75], a[40:43], v[192:195]
ds_read_b64_tr_b16 a[118:119], v20 offset:35072
v_lshlrev_b32 v17, 2, v17
v_mfma_f32_16x16x32_bf16 v[200:203], a[72:75], a[48:51], v[200:203]
v_sub_u32 v22, v22, v17
v_subrev_u32 v17, 0, v22
v_mfma_f32_16x16x32_bf16 v[200:203], a[76:79], a[52:55], v[200:203]
v_lshlrev_b32 v18, 31, v17
v_or_b32 v21, v17, v18
v_mfma_f32_16x16x32_bf16 v[208:211], a[76:79], a[60:63], v[208:211]
v_ashrrev_i32 v21, 31, v21
v_and_b32 v248, 0xff800000, v21
v_mfma_f32_16x16x32_bf16 v[208:211], a[72:75], a[56:59], v[208:211]
ds_read_b64_tr_b16 a[72:73], v4 offset:32768
v_not_b32 v17, v17
v_mfma_f32_16x16x32_bf16 v[212:215], a[80:83], a[56:59], v[212:215]
s_xor_b32 m0, s77, 67584
ds_read_b64_tr_b16 a[74:75], v4 offset:33792
v_or_b32 v21, v17, v18
v_mfma_f32_16x16x32_bf16 v[212:215], a[84:87], a[60:63], v[212:215]
s_xor_b32 s64, s71, 3735552
ds_read_b64_tr_b16 a[76:77], v4 offset:40960
v_ashrrev_i32 v21, 31, v21
v_mfma_f32_16x16x32_bf16 v[204:207], a[84:87], a[52:55], v[204:207]
buffer_load_dwordx4 v15, s[56:59], s64 offen lds
v_mfma_f32_16x16x32_bf16 v[204:207], a[80:83], a[48:51], v[204:207]
ds_read_b64_tr_b16 a[78:79], v4 offset:41984
v_and_b32 v252, 0xff800000, v21
v_mfma_f32_16x16x32_bf16 v[196:199], a[80:83], a[40:43], v[196:199]
v_subrev_u32 v17, 1, v22
v_lshlrev_b32 v18, 31, v17
v_mfma_f32_16x16x32_bf16 v[196:199], a[84:87], a[44:47], v[196:199]
v_or_b32 v21, v17, v18
v_ashrrev_i32 v21, 31, v21
v_mfma_f32_16x16x32_bf16 v[188:191], a[84:87], a[36:39], v[188:191]
v_and_b32 v249, 0xff800000, v21
v_not_b32 v17, v17
v_mfma_f32_16x16x32_bf16 v[188:191], a[80:83], a[32:35], v[188:191]
ds_read_b64_tr_b16 a[80:81], v5 offset:32768
v_or_b32 v21, v17, v18
v_mfma_f32_16x16x32_bf16 v[216:219], a[32:35], a[88:91], v[216:219]
ds_read_b64_tr_b16 a[82:83], v5 offset:33792
v_ashrrev_i32 v21, 31, v21
v_mfma_f32_16x16x32_bf16 v[216:219], a[36:39], a[92:95], v[216:219]
s_add_u32 m0, s78, 90112
ds_read_b64_tr_b16 a[84:85], v5 offset:40960
v_and_b32 v253, 0xff800000, v21
v_mfma_f32_16x16x32_bf16 v[224:227], a[44:47], a[92:95], v[224:227]
s_add_u32 s64, s75, 2756608
ds_read_b64_tr_b16 a[86:87], v5 offset:41984
v_subrev_u32 v17, 2, v22
v_mfma_f32_16x16x32_bf16 v[224:227], a[40:43], a[88:91], v[224:227]
buffer_load_dwordx4 v23, s[60:63], s64 offen lds
v_mfma_f32_16x16x32_bf16 v[232:235], a[48:51], a[88:91], v[232:235]
v_lshlrev_b32 v18, 31, v17
v_or_b32 v21, v17, v18
v_mfma_f32_16x16x32_bf16 v[232:235], a[52:55], a[92:95], v[232:235]
v_ashrrev_i32 v21, 31, v21
v_and_b32 v250, 0xff800000, v21
v_mfma_f32_16x16x32_bf16 v[240:243], a[60:63], a[92:95], v[240:243]
v_not_b32 v17, v17
v_or_b32 v21, v17, v18
v_mfma_f32_16x16x32_bf16 v[240:243], a[56:59], a[88:91], v[240:243]
ds_read_b64_tr_b16 a[88:89], v6 offset:32768
v_ashrrev_i32 v21, 31, v21
v_mfma_f32_16x16x32_bf16 v[244:247], a[56:59], a[96:99], v[244:247]
ds_read_b64_tr_b16 a[90:91], v6 offset:33792
v_and_b32 v254, 0xff800000, v21
v_mfma_f32_16x16x32_bf16 v[244:247], a[60:63], a[100:103], v[244:247]
ds_read_b64_tr_b16 a[92:93], v6 offset:40960
v_add_u32 v19, 0x8000, v19
v_mfma_f32_16x16x32_bf16 v[236:239], a[52:55], a[100:103], v[236:239]
s_xor_b32 m0, s77, 68608
ds_read_b64_tr_b16 a[94:95], v6 offset:41984
v_subrev_u32 v17, 3, v22
v_mfma_f32_16x16x32_bf16 v[236:239], a[48:51], a[96:99], v[236:239]
s_xor_b32 s64, s71, 3768320
v_lshlrev_b32 v18, 31, v17
v_or_b32 v21, v17, v18
v_mfma_f32_16x16x32_bf16 v[228:231], a[40:43], a[96:99], v[228:231]
buffer_load_dwordx4 v15, s[56:59], s64 offen lds
v_mfma_f32_16x16x32_bf16 v[228:231], a[44:47], a[100:103], v[228:231]
v_ashrrev_i32 v21, 31, v21
v_and_b32 v251, 0xff800000, v21
v_mfma_f32_16x16x32_bf16 v[220:223], a[36:39], a[100:103], v[220:223]
v_not_b32 v17, v17
v_or_b32 v21, v17, v18
v_mfma_f32_16x16x32_bf16 v[220:223], a[32:35], a[96:99], v[220:223]
s_waitcnt lgkmcnt(4)
ds_read_b64_tr_b16 a[96:97], v7 offset:32768
v_ashrrev_i32 v21, 31, v21
v_mfma_f32_16x16x32_bf16 v[152:155], a[104:107], a[32:35], v[152:155]
ds_read_b64_tr_b16 a[98:99], v7 offset:33792
v_and_b32 v255, 0xff800000, v21
v_mfma_f32_16x16x32_bf16 v[152:155], a[108:111], a[36:39], v[152:155]
s_lshl_b32 s69, s30, 4
ds_read_b64_tr_b16 a[100:101], v7 offset:40960
v_add_u32 v20, 0x8000, v20
v_mfma_f32_16x16x32_bf16 v[160:163], a[108:111], a[44:47], v[160:163]
ds_read_b64_tr_b16 a[102:103], v7 offset:41984
v_add_u32 v18, s69, v22
v_mfma_f32_16x16x32_bf16 v[160:163], a[104:107], a[40:43], v[160:163]
s_lshr_b32 s69, s30, 1
v_mfma_f32_16x16x32_bf16 v[168:171], a[104:107], a[48:51], v[168:171]
s_mul_i32 s69, s69, 18432
v_mfma_f32_16x16x32_bf16 v[168:171], a[108:111], a[52:55], v[168:171]
s_add_u32 s69, s69, s78
v_mfma_f32_16x16x32_bf16 v[176:179], a[108:111], a[60:63], v[176:179]
s_add_u32 s69, s69, 32768
s_xor_b32 m0, s84, 32768
v_mfma_f32_16x16x32_bf16 v[176:179], a[104:107], a[56:59], v[176:179]
s_xor_b32 s64, s72, 896
ds_read_b64_tr_b16 a[104:105], v8 offset:32768
v_add_u32 v17, s69, v16
v_mfma_f32_16x16x32_bf16 v[180:183], a[112:115], a[56:59], v[180:183]
s_add_u32 s65, s79, 3072
buffer_load_dwordx4 v12, s[48:51], s64 offen lds
v_mfma_f32_16x16x32_bf16 v[180:183], a[116:119], a[60:63], v[180:183]
buffer_store_dwordx4 a[188:191], v16, s[44:47], s65 offen sc1
v_mfma_f32_16x16x32_bf16 v[172:175], a[116:119], a[52:55], v[172:175]
ds_read_b64_tr_b16 a[106:107], v8 offset:33792
v_add_u32 v4, 0x8000, v4
v_mfma_f32_16x16x32_bf16 v[172:175], a[112:115], a[48:51], v[172:175]
s_xor_b32 m0, s84, 33792
ds_read_b64_tr_b16 a[108:109], v8 offset:40960
v_lshlrev_b32 v21, 5, v0
v_mfma_f32_16x16x32_bf16 v[164:167], a[112:115], a[40:43], v[164:167]
s_xor_b32 s64, s72, 17280
ds_read_b64_tr_b16 a[110:111], v8 offset:41984
v_mfma_f32_16x16x32_bf16 v[164:167], a[116:119], a[44:47], v[164:167]
buffer_load_dwordx4 v13, s[48:51], s64 offen lds
v_mfma_f32_16x16x32_bf16 v[156:159], a[116:119], a[36:39], v[156:159]
v_mfma_f32_16x16x32_bf16 v[156:159], a[112:115], a[32:35], v[156:159]
ds_read_b64_tr_b16 a[112:113], v9 offset:32768
v_mfma_f32_16x16x32_bf16 v[24:27], a[72:75], a[32:35], v[24:27]
s_xor_b32 m0, s84, 34816
ds_read_b64_tr_b16 a[114:115], v9 offset:33792
v_mfma_f32_16x16x32_bf16 v[24:27], a[76:79], a[36:39], v[24:27]
s_xor_b32 s64, s72, 131968
ds_read_b64_tr_b16 a[116:117], v9 offset:40960
v_add_u32 v5, 0x8000, v5
v_mfma_f32_16x16x32_bf16 v[40:43], a[76:79], a[44:47], v[40:43]
buffer_load_dwordx4 v12, s[48:51], s64 offen lds
v_mfma_f32_16x16x32_bf16 v[40:43], a[72:75], a[40:43], v[40:43]
ds_read_b64_tr_b16 a[118:119], v9 offset:41984
v_mfma_f32_16x16x32_bf16 v[56:59], a[72:75], a[48:51], v[56:59]
v_mfma_f32_16x16x32_bf16 v[56:59], a[76:79], a[52:55], v[56:59]
s_xor_b32 m0, s84, 35840
v_mfma_f32_16x16x32_bf16 v[72:75], a[76:79], a[60:63], v[72:75]
s_waitcnt vmcnt(12)
s_xor_b32 s64, s72, 148352
ds_read_b128 a[0:3], v2 offset:0
v_mfma_f32_16x16x32_bf16 v[72:75], a[72:75], a[56:59], v[72:75]
buffer_load_dwordx4 v13, s[48:51], s64 offen lds
v_mfma_f32_16x16x32_bf16 v[136:139], a[80:83], a[56:59], v[136:139]
ds_read_b128 a[4:7], v3 offset:0
v_mfma_f32_16x16x32_bf16 v[136:139], a[84:87], a[60:63], v[136:139]
ds_read_b128 a[8:11], v2 offset:2048
v_add_u32 v6, 0x8000, v6
v_mfma_f32_16x16x32_bf16 v[120:123], a[84:87], a[52:55], v[120:123]
s_xor_b32 m0, s84, 36864
ds_read_b128 a[12:15], v3 offset:2048
v_mfma_f32_16x16x32_bf16 v[120:123], a[80:83], a[48:51], v[120:123]
s_xor_b32 s64, s73, 896
ds_read_b128 a[16:19], v2 offset:4096
v_mfma_f32_16x16x32_bf16 v[104:107], a[80:83], a[40:43], v[104:107]
buffer_load_dwordx4 v12, s[48:51], s64 offen lds
v_mfma_f32_16x16x32_bf16 v[104:107], a[84:87], a[44:47], v[104:107]
ds_read_b128 a[20:23], v3 offset:4096
v_mfma_f32_16x16x32_bf16 v[88:91], a[84:87], a[36:39], v[88:91]
ds_read_b128 a[24:27], v2 offset:6144
v_mfma_f32_16x16x32_bf16 v[88:91], a[80:83], a[32:35], v[88:91]
s_waitcnt lgkmcnt(7)
s_xor_b32 m0, s84, 37888
ds_read_b128 a[28:31], v3 offset:6144
v_mfma_f32_16x16x32_bf16 v[28:31], a[88:91], a[32:35], v[28:31]
s_xor_b32 s64, s73, 17280
ds_read_b64_tr_b16 a[72:73], v10 offset:32768
v_mfma_f32_16x16x32_bf16 v[28:31], a[92:95], a[36:39], v[28:31]
buffer_load_dwordx4 v13, s[48:51], s64 offen lds
v_mfma_f32_16x16x32_bf16 v[44:47], a[92:95], a[44:47], v[44:47]
ds_read_b64_tr_b16 a[74:75], v10 offset:33792
v_add_u32 v7, 0x8000, v7
v_mfma_f32_16x16x32_bf16 v[44:47], a[88:91], a[40:43], v[44:47]
ds_read_b64_tr_b16 a[76:77], v10 offset:40960
v_mfma_f32_16x16x32_bf16 v[60:63], a[88:91], a[48:51], v[60:63]
s_xor_b32 m0, s84, 38912
ds_read_b64_tr_b16 a[78:79], v10 offset:41984
v_mfma_f32_16x16x32_bf16 v[60:63], a[92:95], a[52:55], v[60:63]
s_xor_b32 s64, s73, 131968
ds_read_b64_tr_b16 a[80:81], v11 offset:32768
v_mfma_f32_16x16x32_bf16 v[76:79], a[92:95], a[60:63], v[76:79]
buffer_load_dwordx4 v12, s[48:51], s64 offen lds
v_mfma_f32_16x16x32_bf16 v[76:79], a[88:91], a[56:59], v[76:79]
ds_read_b64_tr_b16 a[82:83], v11 offset:33792
v_mfma_f32_16x16x32_bf16 v[140:143], a[96:99], a[56:59], v[140:143]
ds_read_b64_tr_b16 a[84:85], v11 offset:40960
v_mfma_f32_16x16x32_bf16 v[140:143], a[100:103], a[60:63], v[140:143]
s_xor_b32 m0, s84, 39936
ds_read_b64_tr_b16 a[86:87], v11 offset:41984
v_add_u32 v8, 0x8000, v8
v_mfma_f32_16x16x32_bf16 v[124:127], a[100:103], a[52:55], v[124:127]
s_xor_b32 s64, s73, 148352
v_mfma_f32_16x16x32_bf16 v[124:127], a[96:99], a[48:51], v[124:127]
buffer_load_dwordx4 v13, s[48:51], s64 offen lds
v_mfma_f32_16x16x32_bf16 v[108:111], a[96:99], a[40:43], v[108:111]
v_mfma_f32_16x16x32_bf16 v[108:111], a[100:103], a[44:47], v[108:111]
v_mfma_f32_16x16x32_bf16 v[92:95], a[100:103], a[36:39], v[92:95]
v_add_u32 v9, 0x8000, v9
v_add_u32 v10, 0x8000, v10
v_mfma_f32_16x16x32_bf16 v[92:95], a[96:99], a[32:35], v[92:95]
v_add_u32 v11, 0x8000, v11
v_mfma_f32_16x16x32_bf16 v[32:35], a[104:107], a[32:35], v[32:35]
v_mfma_f32_16x16x32_bf16 v[32:35], a[108:111], a[36:39], v[32:35]
v_mfma_f32_16x16x32_bf16 v[48:51], a[108:111], a[44:47], v[48:51]
s_waitcnt lgkmcnt(0)
s_barrier
v_mfma_f32_16x16x32_bf16 v[48:51], a[104:107], a[40:43], v[48:51]
s_xor_b32 m0, s77, 98304
ds_read_b64_tr_b16 a[88:89], v19 offset:36864
v_mfma_f32_16x16x32_bf16 v[64:67], a[104:107], a[48:51], v[64:67]
s_xor_b32 s64, s71, 4194304
ds_read_b64_tr_b16 a[90:91], v19 offset:37120
v_mfma_f32_16x16x32_bf16 v[64:67], a[108:111], a[52:55], v[64:67]
s_add_u32 s65, s79, 24576
buffer_load_dwordx4 v14, s[56:59], s64 offen lds
v_mfma_f32_16x16x32_bf16 v[80:83], a[108:111], a[60:63], v[80:83]
buffer_store_dwordx4 a[192:195], v16, s[44:47], s65 offen sc1
v_mfma_f32_16x16x32_bf16 v[80:83], a[104:107], a[56:59], v[80:83]
ds_read_b64_tr_b16 a[92:93], v19 offset:38912
v_mfma_f32_16x16x32_bf16 v[144:147], a[112:115], a[56:59], v[144:147]
ds_read_b64_tr_b16 a[94:95], v19 offset:39168
v_mfma_f32_16x16x32_bf16 v[144:147], a[116:119], a[60:63], v[144:147]
ds_read_b64_tr_b16 a[96:97], v20 offset:36864
v_mfma_f32_16x16x32_bf16 v[128:131], a[116:119], a[52:55], v[128:131]
ds_read_b64_tr_b16 a[98:99], v20 offset:37120
v_mfma_f32_16x16x32_bf16 v[128:131], a[112:115], a[48:51], v[128:131]
ds_read_b64_tr_b16 a[100:101], v20 offset:38912
v_mfma_f32_16x16x32_bf16 v[112:115], a[112:115], a[40:43], v[112:115]
s_add_u32 m0, s78, 114688
ds_read_b64_tr_b16 a[102:103], v20 offset:39168
v_mfma_f32_16x16x32_bf16 v[112:115], a[116:119], a[44:47], v[112:115]
s_add_u32 s64, s75, 3145728
ds_read_b64_tr_b16 a[104:105], v19 offset:40960
v_mfma_f32_16x16x32_bf16 v[96:99], a[116:119], a[36:39], v[96:99]
buffer_load_dwordx4 v23, s[60:63], s64 offen lds
v_mfma_f32_16x16x32_bf16 v[96:99], a[112:115], a[32:35], v[96:99]
ds_read_b64_tr_b16 a[106:107], v19 offset:41216
v_mfma_f32_16x16x32_bf16 v[36:39], a[72:75], a[32:35], v[36:39]
ds_read_b64_tr_b16 a[108:109], v19 offset:43008
v_mfma_f32_16x16x32_bf16 v[36:39], a[76:79], a[36:39], v[36:39]
s_branch L_po9
L_pg9:
s_branch L_pg13
L_po9:
ds_read_b64_tr_b16 a[110:111], v19 offset:43264
v_mfma_f32_16x16x32_bf16 v[52:55], a[76:79], a[44:47], v[52:55]
ds_read_b64_tr_b16 a[112:113], v20 offset:40960
v_mfma_f32_16x16x32_bf16 v[52:55], a[72:75], a[40:43], v[52:55]
ds_read_b64_tr_b16 a[114:115], v20 offset:41216
v_mfma_f32_16x16x32_bf16 v[68:71], a[72:75], a[48:51], v[68:71]
ds_read_b64_tr_b16 a[116:117], v20 offset:43008
v_mfma_f32_16x16x32_bf16 v[68:71], a[76:79], a[52:55], v[68:71]
s_xor_b32 m0, s77, 99328
ds_read_b64_tr_b16 a[118:119], v20 offset:43264
v_mfma_f32_16x16x32_bf16 v[84:87], a[76:79], a[60:63], v[84:87]
s_xor_b32 s64, s71, 4227072
v_mfma_f32_16x16x32_bf16 v[84:87], a[72:75], a[56:59], v[84:87]
buffer_load_dwordx4 v14, s[56:59], s64 offen lds
v_mfma_f32_16x16x32_bf16 v[148:151], a[80:83], a[56:59], v[148:151]
ds_read_b64_tr_b16 a[72:73], v19 offset:32768
v_mfma_f32_16x16x32_bf16 v[148:151], a[84:87], a[60:63], v[148:151]
ds_read_b64_tr_b16 a[74:75], v19 offset:33024
v_mfma_f32_16x16x32_bf16 v[132:135], a[84:87], a[52:55], v[132:135]
ds_read_b64_tr_b16 a[76:77], v19 offset:34816
v_mfma_f32_16x16x32_bf16 v[132:135], a[80:83], a[48:51], v[132:135]
ds_read_b64_tr_b16 a[78:79], v19 offset:35072
v_mfma_f32_16x16x32_bf16 v[116:119], a[80:83], a[40:43], v[116:119]
v_mfma_f32_16x16x32_bf16 v[116:119], a[84:87], a[44:47], v[116:119]
v_mfma_f32_16x16x32_bf16 v[100:103], a[84:87], a[36:39], v[100:103]
s_add_u32 m0, s78, 118784
v_mfma_f32_16x16x32_bf16 v[100:103], a[80:83], a[32:35], v[100:103]
s_waitcnt lgkmcnt(4)
s_add_u32 s64, s75, 3147776
ds_read_b64_tr_b16 a[80:81], v20 offset:32768
v_mfma_f32_16x16x32_bf16 v[184:187], a[88:91], a[0:3], v[184:187]
buffer_load_dwordx4 v23, s[60:63], s64 offen lds
v_mfma_f32_16x16x32_bf16 v[184:187], a[92:95], a[4:7], v[184:187]
ds_read_b64_tr_b16 a[82:83], v20 offset:33024
v_mfma_f32_16x16x32_bf16 v[192:195], a[92:95], a[12:15], v[192:195]
ds_read_b64_tr_b16 a[84:85], v20 offset:34816
v_mfma_f32_16x16x32_bf16 v[192:195], a[88:91], a[8:11], v[192:195]
ds_read_b64_tr_b16 a[86:87], v20 offset:35072
v_mfma_f32_16x16x32_bf16 v[200:203], a[88:91], a[16:19], v[200:203]
v_mfma_f32_16x16x32_bf16 v[200:203], a[92:95], a[20:23], v[200:203]
v_mfma_f32_16x16x32_bf16 v[208:211], a[92:95], a[28:31], v[208:211]
v_mfma_f32_16x16x32_bf16 v[208:211], a[88:91], a[24:27], v[208:211]
ds_read_b64_tr_b16 a[88:89], v4 offset:32768
v_mfma_f32_16x16x32_bf16 v[212:215], a[96:99], a[24:27], v[212:215]
s_xor_b32 m0, s77, 100352
ds_read_b64_tr_b16 a[90:91], v4 offset:33792
v_mfma_f32_16x16x32_bf16 v[212:215], a[100:103], a[28:31], v[212:215]
s_xor_b32 s64, s71, 4259840
ds_read_b64_tr_b16 a[92:93], v4 offset:40960
v_mfma_f32_16x16x32_bf16 v[204:207], a[100:103], a[20:23], v[204:207]
buffer_load_dwordx4 v15, s[56:59], s64 offen lds
v_mfma_f32_16x16x32_bf16 v[204:207], a[96:99], a[16:19], v[204:207]
ds_read_b64_tr_b16 a[94:95], v4 offset:41984
v_mfma_f32_16x16x32_bf16 v[196:199], a[96:99], a[8:11], v[196:199]
v_mfma_f32_16x16x32_bf16 v[196:199], a[100:103], a[12:15], v[196:199]
v_mfma_f32_16x16x32_bf16 v[188:191], a[100:103], a[4:7], v[188:191]
v_mfma_f32_16x16x32_bf16 v[188:191], a[96:99], a[0:3], v[188:191]
ds_read_b64_tr_b16 a[96:97], v5 offset:32768
v_mfma_f32_16x16x32_bf16 v[216:219], a[0:3], a[104:107], v[216:219]
s_add_u32 s65, s79, 25600
ds_read_b64_tr_b16 a[98:99], v5 offset:33792
v_mfma_f32_16x16x32_bf16 v[216:219], a[4:7], a[108:111], v[216:219]
s_add_u32 m0, s78, 122880
buffer_store_dwordx4 a[196:199], v16, s[44:47], s65 offen sc1
v_mfma_f32_16x16x32_bf16 v[224:227], a[12:15], a[108:111], v[224:227]
s_add_u32 s64, s75, 3149824
ds_read_b64_tr_b16 a[100:101], v5 offset:40960
v_mfma_f32_16x16x32_bf16 v[224:227], a[8:11], a[104:107], v[224:227]
buffer_load_dwordx4 v23, s[60:63], s64 offen lds
v_mfma_f32_16x16x32_bf16 v[232:235], a[16:19], a[104:107], v[232:235]
ds_read_b64_tr_b16 a[102:103], v5 offset:41984
v_mfma_f32_16x16x32_bf16 v[232:235], a[20:23], a[108:111], v[232:235]
v_mfma_f32_16x16x32_bf16 v[240:243], a[28:31], a[108:111], v[240:243]
v_mfma_f32_16x16x32_bf16 v[240:243], a[24:27], a[104:107], v[240:243]
ds_read_b64_tr_b16 a[104:105], v6 offset:32768
v_mfma_f32_16x16x32_bf16 v[244:247], a[24:27], a[112:115], v[244:247]
ds_read_b64_tr_b16 a[106:107], v6 offset:33792
v_mfma_f32_16x16x32_bf16 v[244:247], a[28:31], a[116:119], v[244:247]
ds_read_b64_tr_b16 a[108:109], v6 offset:40960
v_subrev_u32 v19, 0x8000, v19
v_mfma_f32_16x16x32_bf16 v[236:239], a[20:23], a[116:119], v[236:239]
s_xor_b32 m0, s77, 101376
ds_read_b64_tr_b16 a[110:111], v6 offset:41984
v_mfma_f32_16x16x32_bf16 v[236:239], a[16:19], a[112:115], v[236:239]
s_xor_b32 s64, s71, 4292608
v_mfma_f32_16x16x32_bf16 v[228:231], a[8:11], a[112:115], v[228:231]
buffer_load_dwordx4 v15, s[56:59], s64 offen lds
v_mfma_f32_16x16x32_bf16 v[228:231], a[12:15], a[116:119], v[228:231]
v_mfma_f32_16x16x32_bf16 v[220:223], a[4:7], a[116:119], v[220:223]
v_mfma_f32_16x16x32_bf16 v[220:223], a[0:3], a[112:115], v[220:223]
s_waitcnt lgkmcnt(4)
ds_read_b64_tr_b16 a[112:113], v7 offset:32768
v_mfma_f32_16x16x32_bf16 v[152:155], a[72:75], a[0:3], v[152:155]
ds_read_b64_tr_b16 a[114:115], v7 offset:33792
v_mfma_f32_16x16x32_bf16 v[152:155], a[76:79], a[4:7], v[152:155]
ds_read_b64_tr_b16 a[116:117], v7 offset:40960
v_subrev_u32 v20, 0x8000, v20
v_mfma_f32_16x16x32_bf16 v[160:163], a[76:79], a[12:15], v[160:163]
ds_read_b64_tr_b16 a[118:119], v7 offset:41984
v_mfma_f32_16x16x32_bf16 v[160:163], a[72:75], a[8:11], v[160:163]
v_mfma_f32_16x16x32_bf16 v[168:171], a[72:75], a[16:19], v[168:171]
v_mfma_f32_16x16x32_bf16 v[168:171], a[76:79], a[20:23], v[168:171]
v_mfma_f32_16x16x32_bf16 v[176:179], a[76:79], a[28:31], v[176:179]
s_xor_b32 m0, s84, 0
v_mfma_f32_16x16x32_bf16 v[176:179], a[72:75], a[24:27], v[176:179]
s_xor_b32 s64, s72, 1024
ds_read_b64_tr_b16 a[72:73], v8 offset:32768
v_mfma_f32_16x16x32_bf16 v[180:183], a[80:83], a[24:27], v[180:183]
buffer_load_dwordx4 v12, s[48:51], s64 offen lds
v_mfma_f32_16x16x32_bf16 v[180:183], a[84:87], a[28:31], v[180:183]
ds_read_b64_tr_b16 a[74:75], v8 offset:33792
v_subrev_u32 v4, 0x8000, v4
v_mfma_f32_16x16x32_bf16 v[172:175], a[84:87], a[20:23], v[172:175]
ds_read_b64_tr_b16 a[76:77], v8 offset:40960
v_mfma_f32_16x16x32_bf16 v[172:175], a[80:83], a[16:19], v[172:175]
s_xor_b32 m0, s84, 1024
ds_read_b64_tr_b16 a[78:79], v8 offset:41984
v_mfma_f32_16x16x32_bf16 v[164:167], a[80:83], a[8:11], v[164:167]
s_xor_b32 s64, s72, 17408
v_mfma_f32_16x16x32_bf16 v[164:167], a[84:87], a[12:15], v[164:167]
buffer_load_dwordx4 v13, s[48:51], s64 offen lds
v_mfma_f32_16x16x32_bf16 v[156:159], a[84:87], a[4:7], v[156:159]
v_mfma_f32_16x16x32_bf16 v[156:159], a[80:83], a[0:3], v[156:159]
ds_read_b64_tr_b16 a[80:81], v9 offset:32768
v_mfma_f32_16x16x32_bf16 v[24:27], a[88:91], a[0:3], v[24:27]
s_xor_b32 m0, s84, 2048
ds_read_b64_tr_b16 a[82:83], v9 offset:33792
v_mfma_f32_16x16x32_bf16 v[24:27], a[92:95], a[4:7], v[24:27]
s_xor_b32 s64, s72, 132096
ds_read_b64_tr_b16 a[84:85], v9 offset:40960
v_subrev_u32 v5, 0x8000, v5
v_mfma_f32_16x16x32_bf16 v[40:43], a[92:95], a[12:15], v[40:43]
buffer_load_dwordx4 v12, s[48:51], s64 offen lds
v_mfma_f32_16x16x32_bf16 v[40:43], a[88:91], a[8:11], v[40:43]
ds_read_b64_tr_b16 a[86:87], v9 offset:41984
v_mfma_f32_16x16x32_bf16 v[56:59], a[88:91], a[16:19], v[56:59]
v_mfma_f32_16x16x32_bf16 v[56:59], a[92:95], a[20:23], v[56:59]
s_xor_b32 m0, s84, 3072
v_mfma_f32_16x16x32_bf16 v[72:75], a[92:95], a[28:31], v[72:75]
s_waitcnt vmcnt(12)
s_xor_b32 s64, s72, 148480
ds_read_b128 a[32:35], v2 offset:32768
v_mfma_f32_16x16x32_bf16 v[72:75], a[88:91], a[24:27], v[72:75]
buffer_load_dwordx4 v13, s[48:51], s64 offen lds
v_mfma_f32_16x16x32_bf16 v[136:139], a[96:99], a[24:27], v[136:139]
ds_read_b128 a[36:39], v3 offset:32768
v_mfma_f32_16x16x32_bf16 v[136:139], a[100:103], a[28:31], v[136:139]
ds_read_b128 a[40:43], v2 offset:34816
v_subrev_u32 v6, 0x8000, v6
v_mfma_f32_16x16x32_bf16 v[120:123], a[100:103], a[20:23], v[120:123]
s_xor_b32 m0, s84, 4096
ds_read_b128 a[44:47], v3 offset:34816
v_mfma_f32_16x16x32_bf16 v[120:123], a[96:99], a[16:19], v[120:123]
s_xor_b32 s64, s73, 1024
ds_read_b128 a[48:51], v2 offset:36864
v_mfma_f32_16x16x32_bf16 v[104:107], a[96:99], a[8:11], v[104:107]
buffer_load_dwordx4 v12, s[48:51], s64 offen lds
v_mfma_f32_16x16x32_bf16 v[104:107], a[100:103], a[12:15], v[104:107]
s_add_u32 s65, s79, 9216
ds_read_b128 a[52:55], v3 offset:36864
v_mfma_f32_16x16x32_bf16 v[88:91], a[100:103], a[4:7], v[88:91]
buffer_store_dwordx4 a[200:203], v16, s[44:47], s65 offen sc1
v_mfma_f32_16x16x32_bf16 v[88:91], a[96:99], a[0:3], v[88:91]
s_waitcnt lgkmcnt(6)
s_xor_b32 m0, s84, 5120
ds_read_b128 a[56:59], v2 offset:38912
v_mfma_f32_16x16x32_bf16 v[28:31], a[104:107], a[0:3], v[28:31]
s_xor_b32 s64, s73, 17408
ds_read_b128 a[60:63], v3 offset:38912
v_mfma_f32_16x16x32_bf16 v[28:31], a[108:111], a[4:7], v[28:31]
buffer_load_dwordx4 v13, s[48:51], s64 offen lds
v_mfma_f32_16x16x32_bf16 v[44:47], a[108:111], a[12:15], v[44:47]
ds_read_b64_tr_b16 a[88:89], v10 offset:32768
v_subrev_u32 v7, 0x8000, v7
v_mfma_f32_16x16x32_bf16 v[44:47], a[104:107], a[8:11], v[44:47]
ds_read_b64_tr_b16 a[90:91], v10 offset:33792
v_mfma_f32_16x16x32_bf16 v[60:63], a[104:107], a[16:19], v[60:63]
s_xor_b32 m0, s84, 6144
ds_read_b64_tr_b16 a[92:93], v10 offset:40960
v_mfma_f32_16x16x32_bf16 v[60:63], a[108:111], a[20:23], v[60:63]
s_xor_b32 s64, s73, 132096
ds_read_b64_tr_b16 a[94:95], v10 offset:41984
v_mfma_f32_16x16x32_bf16 v[76:79], a[108:111], a[28:31], v[76:79]
buffer_load_dwordx4 v12, s[48:51], s64 offen lds
v_mfma_f32_16x16x32_bf16 v[76:79], a[104:107], a[24:27], v[76:79]
ds_read_b64_tr_b16 a[96:97], v11 offset:32768
v_mfma_f32_16x16x32_bf16 v[140:143], a[112:115], a[24:27], v[140:143]
ds_read_b64_tr_b16 a[98:99], v11 offset:33792
v_mfma_f32_16x16x32_bf16 v[140:143], a[116:119], a[28:31], v[140:143]
s_xor_b32 m0, s84, 7168
ds_read_b64_tr_b16 a[100:101], v11 offset:40960
v_subrev_u32 v8, 0x8000, v8
v_mfma_f32_16x16x32_bf16 v[124:127], a[116:119], a[20:23], v[124:127]
s_xor_b32 s64, s73, 148480
ds_read_b64_tr_b16 a[102:103], v11 offset:41984
v_mfma_f32_16x16x32_bf16 v[124:127], a[112:115], a[16:19], v[124:127]
buffer_load_dwordx4 v13, s[48:51], s64 offen lds
v_mfma_f32_16x16x32_bf16 v[108:111], a[112:115], a[8:11], v[108:111]
v_mfma_f32_16x16x32_bf16 v[108:111], a[116:119], a[12:15], v[108:111]
v_mfma_f32_16x16x32_bf16 v[92:95], a[116:119], a[4:7], v[92:95]
v_subrev_u32 v9, 0x8000, v9
v_subrev_u32 v10, 0x8000, v10
v_mfma_f32_16x16x32_bf16 v[92:95], a[112:115], a[0:3], v[92:95]
v_subrev_u32 v11, 0x8000, v11
v_mfma_f32_16x16x32_bf16 v[32:35], a[72:75], a[0:3], v[32:35]
v_mfma_f32_16x16x32_bf16 v[32:35], a[76:79], a[4:7], v[32:35]
v_mfma_f32_16x16x32_bf16 v[48:51], a[76:79], a[12:15], v[48:51]
s_waitcnt lgkmcnt(0)
s_barrier
v_mfma_f32_16x16x32_bf16 v[48:51], a[72:75], a[8:11], v[48:51]
s_xor_b32 m0, s77, 131072
ds_read_b64_tr_b16 a[104:105], v19 offset:4096
v_mfma_f32_16x16x32_bf16 v[64:67], a[72:75], a[16:19], v[64:67]
s_xor_b32 s64, s71, 4718592
ds_read_b64_tr_b16 a[106:107], v19 offset:4352
v_mfma_f32_16x16x32_bf16 v[64:67], a[76:79], a[20:23], v[64:67]
buffer_load_dwordx4 v14, s[56:59], s64 offen lds
v_mfma_f32_16x16x32_bf16 v[80:83], a[76:79], a[28:31], v[80:83]
ds_read_b64_tr_b16 a[108:109], v19 offset:6144
v_mfma_f32_16x16x32_bf16 v[80:83], a[72:75], a[24:27], v[80:83]
ds_read_b64_tr_b16 a[110:111], v19 offset:6400
v_mfma_f32_16x16x32_bf16 v[144:147], a[80:83], a[24:27], v[144:147]
ds_read_b64_tr_b16 a[112:113], v20 offset:4096
v_mfma_f32_16x16x32_bf16 v[144:147], a[84:87], a[28:31], v[144:147]
ds_read_b64_tr_b16 a[114:115], v20 offset:4352
v_mfma_f32_16x16x32_bf16 v[128:131], a[84:87], a[20:23], v[128:131]
ds_read_b64_tr_b16 a[116:117], v20 offset:6144
v_mfma_f32_16x16x32_bf16 v[128:131], a[80:83], a[16:19], v[128:131]
ds_read_b64_tr_b16 a[118:119], v20 offset:6400
v_mfma_f32_16x16x32_bf16 v[112:115], a[80:83], a[8:11], v[112:115]
s_add_u32 m0, s78, 147456
ds_read_b64_tr_b16 a[72:73], v19 offset:8192
v_mfma_f32_16x16x32_bf16 v[112:115], a[84:87], a[12:15], v[112:115]
s_add_u32 s64, s75, 3538944
ds_read_b64_tr_b16 a[74:75], v19 offset:8448
v_mfma_f32_16x16x32_bf16 v[96:99], a[84:87], a[4:7], v[96:99]
buffer_load_dwordx4 v23, s[60:63], s64 offen lds
v_mfma_f32_16x16x32_bf16 v[96:99], a[80:83], a[0:3], v[96:99]
ds_read_b64_tr_b16 a[76:77], v19 offset:10240
v_mfma_f32_16x16x32_bf16 v[36:39], a[88:91], a[0:3], v[36:39]
ds_read_b64_tr_b16 a[78:79], v19 offset:10496
v_mfma_f32_16x16x32_bf16 v[36:39], a[92:95], a[4:7], v[36:39]
ds_read_b64_tr_b16 a[80:81], v20 offset:8192
v_mfma_f32_16x16x32_bf16 v[52:55], a[92:95], a[12:15], v[52:55]
ds_read_b64_tr_b16 a[82:83], v20 offset:8448
v_mfma_f32_16x16x32_bf16 v[52:55], a[88:91], a[8:11], v[52:55]
ds_read_b64_tr_b16 a[84:85], v20 offset:10240
v_mfma_f32_16x16x32_bf16 v[68:71], a[88:91], a[16:19], v[68:71]
ds_read_b64_tr_b16 a[86:87], v20 offset:10496
v_mfma_f32_16x16x32_bf16 v[68:71], a[92:95], a[20:23], v[68:71]
s_xor_b32 m0, s77, 132096
v_mfma_f32_16x16x32_bf16 v[84:87], a[92:95], a[28:31], v[84:87]
s_xor_b32 s64, s71, 4751360
v_mfma_f32_16x16x32_bf16 v[84:87], a[88:91], a[24:27], v[84:87]
buffer_load_dwordx4 v14, s[56:59], s64 offen lds
v_mfma_f32_16x16x32_bf16 v[148:151], a[96:99], a[24:27], v[148:151]
ds_read_b64_tr_b16 a[88:89], v19 offset:0
v_mfma_f32_16x16x32_bf16 v[148:151], a[100:103], a[28:31], v[148:151]
ds_read_b64_tr_b16 a[90:91], v19 offset:256
v_mfma_f32_16x16x32_bf16 v[132:135], a[100:103], a[20:23], v[132:135]
s_add_u32 s65, s79, 26624
ds_read_b64_tr_b16 a[92:93], v19 offset:2048
v_mfma_f32_16x16x32_bf16 v[132:135], a[96:99], a[16:19], v[132:135]
buffer_store_dwordx4 a[204:207], v16, s[44:47], s65 offen sc1
v_mfma_f32_16x16x32_bf16 v[116:119], a[96:99], a[8:11], v[116:119]
ds_read_b64_tr_b16 a[94:95], v19 offset:2304
v_mfma_f32_16x16x32_bf16 v[116:119], a[100:103], a[12:15], v[116:119]
v_mfma_f32_16x16x32_bf16 v[100:103], a[100:103], a[4:7], v[100:103]
s_add_u32 m0, s78, 151552
v_mfma_f32_16x16x32_bf16 v[100:103], a[96:99], a[0:3], v[100:103]
s_waitcnt lgkmcnt(4)
s_add_u32 s64, s75, 3540992
ds_read_b64_tr_b16 a[96:97], v20 offset:0
v_mfma_f32_16x16x32_bf16 v[184:187], a[104:107], a[32:35], v[184:187]
buffer_load_dwordx4 v23, s[60:63], s64 offen lds
v_mfma_f32_16x16x32_bf16 v[184:187], a[108:111], a[36:39], v[184:187]
ds_read_b64_tr_b16 a[98:99], v20 offset:256
v_mfma_f32_16x16x32_bf16 v[192:195], a[108:111], a[44:47], v[192:195]
ds_read_b64_tr_b16 a[100:101], v20 offset:2048
v_mfma_f32_16x16x32_bf16 v[192:195], a[104:107], a[40:43], v[192:195]
ds_read_b64_tr_b16 a[102:103], v20 offset:2304
v_mfma_f32_16x16x32_bf16 v[200:203], a[104:107], a[48:51], v[200:203]
s_cmp_eq_u32 s30, 0
s_cselect_b32 s81, 256, 0
v_mfma_f32_16x16x32_bf16 v[200:203], a[108:111], a[52:55], v[200:203]
v_mfma_f32_16x16x32_bf16 v[208:211], a[108:111], a[60:63], v[208:211]
v_mfma_f32_16x16x32_bf16 v[208:211], a[104:107], a[56:59], v[208:211]
ds_read_b64_tr_b16 a[104:105], v4 offset:0
v_mfma_f32_16x16x32_bf16 v[212:215], a[112:115], a[56:59], v[212:215]
s_xor_b32 m0, s77, 133120
ds_read_b64_tr_b16 a[106:107], v4 offset:1024
v_mfma_f32_16x16x32_bf16 v[212:215], a[116:119], a[60:63], v[212:215]
s_xor_b32 s64, s71, 4784128
ds_read_b64_tr_b16 a[108:109], v4 offset:8192
v_mfma_f32_16x16x32_bf16 v[204:207], a[116:119], a[52:55], v[204:207]
buffer_load_dwordx4 v15, s[56:59], s64 offen lds
v_mfma_f32_16x16x32_bf16 v[204:207], a[112:115], a[48:51], v[204:207]
ds_read_b64_tr_b16 a[110:111], v4 offset:9216
v_mfma_f32_16x16x32_bf16 v[196:199], a[112:115], a[40:43], v[196:199]
v_mfma_f32_16x16x32_bf16 v[196:199], a[116:119], a[44:47], v[196:199]
v_mfma_f32_16x16x32_bf16 v[188:191], a[116:119], a[36:39], v[188:191]
v_mfma_f32_16x16x32_bf16 v[188:191], a[112:115], a[32:35], v[188:191]
ds_read_b64_tr_b16 a[112:113], v5 offset:0
v_mfma_f32_16x16x32_bf16 v[216:219], a[32:35], a[72:75], v[216:219]
ds_read_b64_tr_b16 a[114:115], v5 offset:1024
v_mfma_f32_16x16x32_bf16 v[216:219], a[36:39], a[76:79], v[216:219]
s_add_u32 m0, s78, 155648
ds_read_b64_tr_b16 a[116:117], v5 offset:8192
v_mfma_f32_16x16x32_bf16 v[224:227], a[44:47], a[76:79], v[224:227]
s_add_u32 s64, s75, 3543040
ds_read_b64_tr_b16 a[118:119], v5 offset:9216
v_mfma_f32_16x16x32_bf16 v[224:227], a[40:43], a[72:75], v[224:227]
buffer_load_dwordx4 v23, s[60:63], s64 offen lds
v_mfma_f32_16x16x32_bf16 v[232:235], a[48:51], a[72:75], v[232:235]
v_mfma_f32_16x16x32_bf16 v[232:235], a[52:55], a[76:79], v[232:235]
v_mfma_f32_16x16x32_bf16 v[240:243], a[60:63], a[76:79], v[240:243]
v_mfma_f32_16x16x32_bf16 v[240:243], a[56:59], a[72:75], v[240:243]
ds_read_b64_tr_b16 a[72:73], v6 offset:0
v_mfma_f32_16x16x32_bf16 v[244:247], a[56:59], a[80:83], v[244:247]
ds_read_b64_tr_b16 a[74:75], v6 offset:1024
v_mfma_f32_16x16x32_bf16 v[244:247], a[60:63], a[84:87], v[244:247]
ds_read_b64_tr_b16 a[76:77], v6 offset:8192
v_mfma_f32_16x16x32_bf16 v[236:239], a[52:55], a[84:87], v[236:239]
s_xor_b32 m0, s77, 134144
ds_read_b64_tr_b16 a[78:79], v6 offset:9216
v_mfma_f32_16x16x32_bf16 v[236:239], a[48:51], a[80:83], v[236:239]
s_xor_b32 s64, s71, 4816896
v_mfma_f32_16x16x32_bf16 v[228:231], a[40:43], a[80:83], v[228:231]
buffer_load_dwordx4 v15, s[56:59], s64 offen lds
v_mfma_f32_16x16x32_bf16 v[228:231], a[44:47], a[84:87], v[228:231]
v_mfma_f32_16x16x32_bf16 v[220:223], a[36:39], a[84:87], v[220:223]
v_mfma_f32_16x16x32_bf16 v[220:223], a[32:35], a[80:83], v[220:223]
s_waitcnt lgkmcnt(4)
ds_read_b64_tr_b16 a[80:81], v7 offset:0
v_mfma_f32_16x16x32_bf16 v[152:155], a[88:91], a[32:35], v[152:155]
ds_read_b64_tr_b16 a[82:83], v7 offset:1024
v_mfma_f32_16x16x32_bf16 v[152:155], a[92:95], a[36:39], v[152:155]
ds_read_b64_tr_b16 a[84:85], v7 offset:8192
v_mfma_f32_16x16x32_bf16 v[160:163], a[92:95], a[44:47], v[160:163]
ds_read_b64_tr_b16 a[86:87], v7 offset:9216
v_mfma_f32_16x16x32_bf16 v[160:163], a[88:91], a[40:43], v[160:163]
v_mfma_f32_16x16x32_bf16 v[168:171], a[88:91], a[48:51], v[168:171]
v_mfma_f32_16x16x32_bf16 v[168:171], a[92:95], a[52:55], v[168:171]
v_mfma_f32_16x16x32_bf16 v[176:179], a[92:95], a[60:63], v[176:179]
s_xor_b32 m0, s84, 32768
v_mfma_f32_16x16x32_bf16 v[176:179], a[88:91], a[56:59], v[176:179]
s_xor_b32 s64, s72, 1152
ds_read_b64_tr_b16 a[88:89], v8 offset:0
v_mfma_f32_16x16x32_bf16 v[180:183], a[96:99], a[56:59], v[180:183]
s_add_u32 s65, s79, 27648
buffer_load_dwordx4 v12, s[48:51], s64 offen lds
v_mfma_f32_16x16x32_bf16 v[180:183], a[100:103], a[60:63], v[180:183]
buffer_store_dwordx4 a[208:211], v16, s[44:47], s65 offen sc1
v_mfma_f32_16x16x32_bf16 v[172:175], a[100:103], a[52:55], v[172:175]
ds_read_b64_tr_b16 a[90:91], v8 offset:1024
v_mfma_f32_16x16x32_bf16 v[172:175], a[96:99], a[48:51], v[172:175]
s_xor_b32 m0, s84, 33792
ds_read_b64_tr_b16 a[92:93], v8 offset:8192
v_mfma_f32_16x16x32_bf16 v[164:167], a[96:99], a[40:43], v[164:167]
s_xor_b32 s64, s72, 17536
ds_read_b64_tr_b16 a[94:95], v8 offset:9216
v_mfma_f32_16x16x32_bf16 v[164:167], a[100:103], a[44:47], v[164:167]
buffer_load_dwordx4 v13, s[48:51], s64 offen lds
v_mfma_f32_16x16x32_bf16 v[156:159], a[100:103], a[36:39], v[156:159]
v_mfma_f32_16x16x32_bf16 v[156:159], a[96:99], a[32:35], v[156:159]
ds_read_b64_tr_b16 a[96:97], v9 offset:0
v_mfma_f32_16x16x32_bf16 v[24:27], a[104:107], a[32:35], v[24:27]
s_xor_b32 m0, s84, 34816
ds_read_b64_tr_b16 a[98:99], v9 offset:1024
v_mfma_f32_16x16x32_bf16 v[24:27], a[108:111], a[36:39], v[24:27]
s_xor_b32 s64, s72, 132224
ds_read_b64_tr_b16 a[100:101], v9 offset:8192
v_mfma_f32_16x16x32_bf16 v[40:43], a[108:111], a[44:47], v[40:43]
buffer_load_dwordx4 v12, s[48:51], s64 offen lds
v_mfma_f32_16x16x32_bf16 v[40:43], a[104:107], a[40:43], v[40:43]
ds_read_b64_tr_b16 a[102:103], v9 offset:9216
v_mfma_f32_16x16x32_bf16 v[56:59], a[104:107], a[48:51], v[56:59]
v_mfma_f32_16x16x32_bf16 v[56:59], a[108:111], a[52:55], v[56:59]
s_xor_b32 m0, s84, 35840
v_mfma_f32_16x16x32_bf16 v[72:75], a[108:111], a[60:63], v[72:75]
s_waitcnt vmcnt(12)
s_xor_b32 s64, s72, 148608
ds_read_b128 a[0:3], v2 offset:0
v_mfma_f32_16x16x32_bf16 v[72:75], a[104:107], a[56:59], v[72:75]
buffer_load_dwordx4 v13, s[48:51], s64 offen lds
v_mfma_f32_16x16x32_bf16 v[136:139], a[112:115], a[56:59], v[136:139]
ds_read_b128 a[4:7], v3 offset:0
v_mfma_f32_16x16x32_bf16 v[136:139], a[116:119], a[60:63], v[136:139]
ds_read_b128 a[8:11], v2 offset:2048
v_mfma_f32_16x16x32_bf16 v[120:123], a[116:119], a[52:55], v[120:123]
s_xor_b32 m0, s84, 36864
ds_read_b128 a[12:15], v3 offset:2048
v_mfma_f32_16x16x32_bf16 v[120:123], a[112:115], a[48:51], v[120:123]
s_xor_b32 s64, s73, 1152
ds_read_b128 a[16:19], v2 offset:4096
v_mfma_f32_16x16x32_bf16 v[104:107], a[112:115], a[40:43], v[104:107]
buffer_load_dwordx4 v12, s[48:51], s64 offen lds
v_mfma_f32_16x16x32_bf16 v[104:107], a[116:119], a[44:47], v[104:107]
ds_read_b128 a[20:23], v3 offset:4096
v_mfma_f32_16x16x32_bf16 v[88:91], a[116:119], a[36:39], v[88:91]
ds_read_b128 a[24:27], v2 offset:6144
v_mfma_f32_16x16x32_bf16 v[88:91], a[112:115], a[32:35], v[88:91]
s_waitcnt lgkmcnt(7)
s_xor_b32 m0, s84, 37888
ds_read_b128 a[28:31], v3 offset:6144
v_mfma_f32_16x16x32_bf16 v[28:31], a[72:75], a[32:35], v[28:31]
s_xor_b32 s64, s73, 17536
ds_read_b64_tr_b16 a[104:105], v10 offset:0
v_mfma_f32_16x16x32_bf16 v[28:31], a[76:79], a[36:39], v[28:31]
buffer_load_dwordx4 v13, s[48:51], s64 offen lds
v_mfma_f32_16x16x32_bf16 v[44:47], a[76:79], a[44:47], v[44:47]
ds_read_b64_tr_b16 a[106:107], v10 offset:1024
v_mfma_f32_16x16x32_bf16 v[44:47], a[72:75], a[40:43], v[44:47]
ds_read_b64_tr_b16 a[108:109], v10 offset:8192
v_mfma_f32_16x16x32_bf16 v[60:63], a[72:75], a[48:51], v[60:63]
s_xor_b32 m0, s84, 38912
ds_read_b64_tr_b16 a[110:111], v10 offset:9216
v_mfma_f32_16x16x32_bf16 v[60:63], a[76:79], a[52:55], v[60:63]
s_xor_b32 s64, s73, 132224
ds_read_b64_tr_b16 a[112:113], v11 offset:0
v_mfma_f32_16x16x32_bf16 v[76:79], a[76:79], a[60:63], v[76:79]
buffer_load_dwordx4 v12, s[48:51], s64 offen lds
v_mfma_f32_16x16x32_bf16 v[76:79], a[72:75], a[56:59], v[76:79]
ds_read_b64_tr_b16 a[114:115], v11 offset:1024
v_mfma_f32_16x16x32_bf16 v[140:143], a[80:83], a[56:59], v[140:143]
ds_read_b64_tr_b16 a[116:117], v11 offset:8192
v_mfma_f32_16x16x32_bf16 v[140:143], a[84:87], a[60:63], v[140:143]
s_xor_b32 m0, s84, 39936
ds_read_b64_tr_b16 a[118:119], v11 offset:9216
v_mfma_f32_16x16x32_bf16 v[124:127], a[84:87], a[52:55], v[124:127]
s_xor_b32 s64, s73, 148608
v_mfma_f32_16x16x32_bf16 v[124:127], a[80:83], a[48:51], v[124:127]
buffer_load_dwordx4 v13, s[48:51], s64 offen lds
v_mfma_f32_16x16x32_bf16 v[108:111], a[80:83], a[40:43], v[108:111]
v_mfma_f32_16x16x32_bf16 v[108:111], a[84:87], a[44:47], v[108:111]
v_mfma_f32_16x16x32_bf16 v[92:95], a[84:87], a[36:39], v[92:95]
v_mfma_f32_16x16x32_bf16 v[92:95], a[80:83], a[32:35], v[92:95]
v_mfma_f32_16x16x32_bf16 v[32:35], a[88:91], a[32:35], v[32:35]
v_mfma_f32_16x16x32_bf16 v[32:35], a[92:95], a[36:39], v[32:35]
v_mfma_f32_16x16x32_bf16 v[48:51], a[92:95], a[44:47], v[48:51]
s_waitcnt lgkmcnt(0)
s_barrier
v_mfma_f32_16x16x32_bf16 v[48:51], a[88:91], a[40:43], v[48:51]
s_xor_b32 m0, s77, 65536
s_add_u32 s65, s79, 11264
ds_read_b64_tr_b16 a[72:73], v19 offset:36864
v_mfma_f32_16x16x32_bf16 v[64:67], a[88:91], a[48:51], v[64:67]
s_xor_b32 s64, s71, 5242880
buffer_store_dwordx4 a[212:215], v16, s[44:47], s65 offen sc1
v_mfma_f32_16x16x32_bf16 v[64:67], a[92:95], a[52:55], v[64:67]
buffer_load_dwordx4 v14, s[56:59], s64 offen lds
v_mfma_f32_16x16x32_bf16 v[80:83], a[92:95], a[60:63], v[80:83]
ds_read_b64_tr_b16 a[74:75], v19 offset:37120
v_mfma_f32_16x16x32_bf16 v[80:83], a[88:91], a[56:59], v[80:83]
buffer_load_dword v1, off, s[52:55], s78 sc1
v_mfma_f32_16x16x32_bf16 v[144:147], a[96:99], a[56:59], v[144:147]
ds_read_b64_tr_b16 a[76:77], v19 offset:38912
v_mfma_f32_16x16x32_bf16 v[144:147], a[100:103], a[60:63], v[144:147]
ds_read_b64_tr_b16 a[78:79], v19 offset:39168
v_mfma_f32_16x16x32_bf16 v[128:131], a[100:103], a[52:55], v[128:131]
ds_read_b64_tr_b16 a[80:81], v20 offset:36864
v_mfma_f32_16x16x32_bf16 v[128:131], a[96:99], a[48:51], v[128:131]
ds_read_b64_tr_b16 a[82:83], v20 offset:37120
v_mfma_f32_16x16x32_bf16 v[112:115], a[96:99], a[40:43], v[112:115]
s_add_u32 m0, s78, 81920
ds_read_b64_tr_b16 a[84:85], v20 offset:38912
v_mfma_f32_16x16x32_bf16 v[112:115], a[100:103], a[44:47], v[112:115]
s_add_u32 s64, s75, 3932160
ds_read_b64_tr_b16 a[86:87], v20 offset:39168
v_mfma_f32_16x16x32_bf16 v[96:99], a[100:103], a[36:39], v[96:99]
buffer_load_dwordx4 v23, s[60:63], s64 offen lds
v_mfma_f32_16x16x32_bf16 v[96:99], a[96:99], a[32:35], v[96:99]
ds_read_b64_tr_b16 a[88:89], v19 offset:40960
v_mfma_f32_16x16x32_bf16 v[36:39], a[104:107], a[32:35], v[36:39]
ds_read_b64_tr_b16 a[90:91], v19 offset:41216
v_mfma_f32_16x16x32_bf16 v[36:39], a[108:111], a[36:39], v[36:39]
ds_read_b64_tr_b16 a[92:93], v19 offset:43008
v_mfma_f32_16x16x32_bf16 v[52:55], a[108:111], a[44:47], v[52:55]
ds_read_b64_tr_b16 a[94:95], v19 offset:43264
v_mfma_f32_16x16x32_bf16 v[52:55], a[104:107], a[40:43], v[52:55]
ds_read_b64_tr_b16 a[96:97], v20 offset:40960
v_mfma_f32_16x16x32_bf16 v[68:71], a[104:107], a[48:51], v[68:71]
ds_read_b64_tr_b16 a[98:99], v20 offset:41216
v_mfma_f32_16x16x32_bf16 v[68:71], a[108:111], a[52:55], v[68:71]
s_xor_b32 m0, s77, 66560
ds_read_b64_tr_b16 a[100:101], v20 offset:43008
v_mfma_f32_16x16x32_bf16 v[84:87], a[108:111], a[60:63], v[84:87]
s_xor_b32 s64, s71, 5275648
ds_read_b64_tr_b16 a[102:103], v20 offset:43264
v_mfma_f32_16x16x32_bf16 v[84:87], a[104:107], a[56:59], v[84:87]
buffer_load_dwordx4 v14, s[56:59], s64 offen lds
v_mfma_f32_16x16x32_bf16 v[148:151], a[112:115], a[56:59], v[148:151]
ds_read_b64_tr_b16 a[104:105], v19 offset:32768
v_mfma_f32_16x16x32_bf16 v[148:151], a[116:119], a[60:63], v[148:151]
ds_read_b64_tr_b16 a[106:107], v19 offset:33024
v_mfma_f32_16x16x32_bf16 v[132:135], a[116:119], a[52:55], v[132:135]
ds_read_b64_tr_b16 a[108:109], v19 offset:34816
v_mfma_f32_16x16x32_bf16 v[132:135], a[112:115], a[48:51], v[132:135]
ds_read_b64_tr_b16 a[110:111], v19 offset:35072
v_mfma_f32_16x16x32_bf16 v[116:119], a[112:115], a[40:43], v[116:119]
v_mfma_f32_16x16x32_bf16 v[116:119], a[116:119], a[44:47], v[116:119]
v_mfma_f32_16x16x32_bf16 v[100:103], a[116:119], a[36:39], v[100:103]
s_add_u32 m0, s78, 86016
v_mfma_f32_16x16x32_bf16 v[100:103], a[112:115], a[32:35], v[100:103]
s_waitcnt lgkmcnt(5)
s_add_u32 s64, s75, 3934208
ds_read_b64_tr_b16 a[112:113], v20 offset:32768
v_mfma_f32_16x16x32_bf16 v[184:187], a[72:75], a[0:3], v[184:187]
buffer_load_dwordx4 v23, s[60:63], s64 offen lds
v_mfma_f32_16x16x32_bf16 v[184:187], a[76:79], a[4:7], v[184:187]
ds_read_b64_tr_b16 a[114:115], v20 offset:33024
v_mfma_f32_16x16x32_bf16 v[192:195], a[76:79], a[12:15], v[192:195]
ds_read_b64_tr_b16 a[116:117], v20 offset:34816
v_mfma_f32_16x16x32_bf16 v[192:195], a[72:75], a[8:11], v[192:195]
ds_read_b64_tr_b16 a[118:119], v20 offset:35072
v_mfma_f32_16x16x32_bf16 v[200:203], a[72:75], a[16:19], v[200:203]
v_mfma_f32_16x16x32_bf16 v[200:203], a[76:79], a[20:23], v[200:203]
v_mfma_f32_16x16x32_bf16 v[208:211], a[76:79], a[28:31], v[208:211]
s_branch L_po10
L_pg10:
s_branch L_tr1
L_po10:
v_mfma_f32_16x16x32_bf16 v[208:211], a[72:75], a[24:27], v[208:211]
ds_read_b64_tr_b16 a[72:73], v4 offset:32768
v_mfma_f32_16x16x32_bf16 v[212:215], a[80:83], a[24:27], v[212:215]
s_xor_b32 m0, s77, 67584
ds_read_b64_tr_b16 a[74:75], v4 offset:33792
v_mfma_f32_16x16x32_bf16 v[212:215], a[84:87], a[28:31], v[212:215]
s_xor_b32 s64, s71, 5308416
ds_read_b64_tr_b16 a[76:77], v4 offset:40960
v_mfma_f32_16x16x32_bf16 v[204:207], a[84:87], a[20:23], v[204:207]
buffer_load_dwordx4 v15, s[56:59], s64 offen lds
v_mfma_f32_16x16x32_bf16 v[204:207], a[80:83], a[16:19], v[204:207]
ds_read_b64_tr_b16 a[78:79], v4 offset:41984
v_mfma_f32_16x16x32_bf16 v[196:199], a[80:83], a[8:11], v[196:199]
v_mfma_f32_16x16x32_bf16 v[196:199], a[84:87], a[12:15], v[196:199]
v_mfma_f32_16x16x32_bf16 v[188:191], a[84:87], a[4:7], v[188:191]
v_mfma_f32_16x16x32_bf16 v[188:191], a[80:83], a[0:3], v[188:191]
ds_read_b64_tr_b16 a[80:81], v5 offset:32768
v_mfma_f32_16x16x32_bf16 v[216:219], a[0:3], a[88:91], v[216:219]
s_add_u32 s65, s79, 28672
ds_read_b64_tr_b16 a[82:83], v5 offset:33792
v_mfma_f32_16x16x32_bf16 v[216:219], a[4:7], a[92:95], v[216:219]
s_add_u32 m0, s78, 90112
buffer_store_dwordx4 a[216:219], v16, s[44:47], s65 offen sc1
v_mfma_f32_16x16x32_bf16 v[224:227], a[12:15], a[92:95], v[224:227]
s_add_u32 s64, s75, 3936256
ds_read_b64_tr_b16 a[84:85], v5 offset:40960
v_mfma_f32_16x16x32_bf16 v[224:227], a[8:11], a[88:91], v[224:227]
buffer_load_dwordx4 v23, s[60:63], s64 offen lds
v_mfma_f32_16x16x32_bf16 v[232:235], a[16:19], a[88:91], v[232:235]
ds_read_b64_tr_b16 a[86:87], v5 offset:41984
v_mfma_f32_16x16x32_bf16 v[232:235], a[20:23], a[92:95], v[232:235]
v_mfma_f32_16x16x32_bf16 v[240:243], a[28:31], a[92:95], v[240:243]
v_mfma_f32_16x16x32_bf16 v[240:243], a[24:27], a[88:91], v[240:243]
ds_read_b64_tr_b16 a[88:89], v6 offset:32768
v_mfma_f32_16x16x32_bf16 v[244:247], a[24:27], a[96:99], v[244:247]
s_waitcnt lgkmcnt(5)
ds_read_b64_tr_b16 a[90:91], v6 offset:33792
v_mfma_f32_16x16x32_bf16 v[244:247], a[28:31], a[100:103], v[244:247]
ds_read_b64_tr_b16 a[92:93], v6 offset:40960
v_add_u32 v19, 0x8000, v19
v_mfma_f32_16x16x32_bf16 v[236:239], a[20:23], a[100:103], v[236:239]
s_xor_b32 m0, s77, 68608
ds_read_b64_tr_b16 a[94:95], v6 offset:41984
v_mfma_f32_16x16x32_bf16 v[236:239], a[16:19], a[96:99], v[236:239]
s_xor_b32 s64, s71, 5341184
v_mfma_f32_16x16x32_bf16 v[228:231], a[8:11], a[96:99], v[228:231]
buffer_load_dwordx4 v15, s[56:59], s64 offen lds
v_mfma_f32_16x16x32_bf16 v[228:231], a[12:15], a[100:103], v[228:231]
v_mfma_f32_16x16x32_bf16 v[220:223], a[4:7], a[100:103], v[220:223]
v_mfma_f32_16x16x32_bf16 v[220:223], a[0:3], a[96:99], v[220:223]
ds_read_b64_tr_b16 a[96:97], v7 offset:32768
v_mfma_f32_16x16x32_bf16 v[152:155], a[104:107], a[0:3], v[152:155]
ds_read_b64_tr_b16 a[98:99], v7 offset:33792
v_mfma_f32_16x16x32_bf16 v[152:155], a[108:111], a[4:7], v[152:155]
ds_read_b64_tr_b16 a[100:101], v7 offset:40960
v_add_u32 v20, 0x8000, v20
v_mfma_f32_16x16x32_bf16 v[160:163], a[108:111], a[12:15], v[160:163]
ds_read_b64_tr_b16 a[102:103], v7 offset:41984
v_mfma_f32_16x16x32_bf16 v[160:163], a[104:107], a[8:11], v[160:163]
v_mfma_f32_16x16x32_bf16 v[168:171], a[104:107], a[16:19], v[168:171]
v_mfma_f32_16x16x32_bf16 v[168:171], a[108:111], a[20:23], v[168:171]
v_mfma_f32_16x16x32_bf16 v[176:179], a[108:111], a[28:31], v[176:179]
s_xor_b32 m0, s84, 0
v_mfma_f32_16x16x32_bf16 v[176:179], a[104:107], a[24:27], v[176:179]
s_xor_b32 s64, s72, 1280
ds_read_b64_tr_b16 a[104:105], v8 offset:32768
v_mfma_f32_16x16x32_bf16 v[180:183], a[112:115], a[24:27], v[180:183]
buffer_load_dwordx4 v12, s[48:51], s64 offen lds
v_mfma_f32_16x16x32_bf16 v[180:183], a[116:119], a[28:31], v[180:183]
ds_read_b64_tr_b16 a[106:107], v8 offset:33792
v_add_u32 v4, 0x8000, v4
v_mfma_f32_16x16x32_bf16 v[172:175], a[116:119], a[20:23], v[172:175]
ds_read_b64_tr_b16 a[108:109], v8 offset:40960
v_mfma_f32_16x16x32_bf16 v[172:175], a[112:115], a[16:19], v[172:175]
s_xor_b32 m0, s84, 1024
ds_read_b64_tr_b16 a[110:111], v8 offset:41984
v_mfma_f32_16x16x32_bf16 v[164:167], a[112:115], a[8:11], v[164:167]
s_xor_b32 s64, s72, 17664
v_mfma_f32_16x16x32_bf16 v[164:167], a[116:119], a[12:15], v[164:167]
buffer_load_dwordx4 v13, s[48:51], s64 offen lds
v_mfma_f32_16x16x32_bf16 v[156:159], a[116:119], a[4:7], v[156:159]
v_mfma_f32_16x16x32_bf16 v[156:159], a[112:115], a[0:3], v[156:159]
ds_read_b64_tr_b16 a[112:113], v9 offset:32768
v_mfma_f32_16x16x32_bf16 v[24:27], a[72:75], a[0:3], v[24:27]
s_xor_b32 m0, s84, 2048
ds_read_b64_tr_b16 a[114:115], v9 offset:33792
v_mfma_f32_16x16x32_bf16 v[24:27], a[76:79], a[4:7], v[24:27]
s_xor_b32 s64, s72, 132352
ds_read_b64_tr_b16 a[116:117], v9 offset:40960
v_add_u32 v5, 0x8000, v5
v_mfma_f32_16x16x32_bf16 v[40:43], a[76:79], a[12:15], v[40:43]
buffer_load_dwordx4 v12, s[48:51], s64 offen lds
v_mfma_f32_16x16x32_bf16 v[40:43], a[72:75], a[8:11], v[40:43]
ds_read_b64_tr_b16 a[118:119], v9 offset:41984
v_mfma_f32_16x16x32_bf16 v[56:59], a[72:75], a[16:19], v[56:59]
v_mfma_f32_16x16x32_bf16 v[56:59], a[76:79], a[20:23], v[56:59]
s_xor_b32 m0, s84, 3072
v_mfma_f32_16x16x32_bf16 v[72:75], a[76:79], a[28:31], v[72:75]
s_waitcnt vmcnt(13)
s_xor_b32 s64, s72, 148736
ds_read_b128 a[32:35], v2 offset:32768
v_mfma_f32_16x16x32_bf16 v[72:75], a[72:75], a[24:27], v[72:75]
s_waitcnt lgkmcnt(5)
buffer_load_dwordx4 v13, s[48:51], s64 offen lds
v_mfma_f32_16x16x32_bf16 v[136:139], a[80:83], a[24:27], v[136:139]
ds_read_b128 a[36:39], v3 offset:32768
v_mfma_f32_16x16x32_bf16 v[136:139], a[84:87], a[28:31], v[136:139]
ds_read_b128 a[40:43], v2 offset:34816
v_add_u32 v6, 0x8000, v6
v_mfma_f32_16x16x32_bf16 v[120:123], a[84:87], a[20:23], v[120:123]
s_xor_b32 m0, s84, 4096
ds_read_b128 a[44:47], v3 offset:34816
v_mfma_f32_16x16x32_bf16 v[120:123], a[80:83], a[16:19], v[120:123]
s_xor_b32 s64, s73, 1280
ds_read_b128 a[48:51], v2 offset:36864
v_mfma_f32_16x16x32_bf16 v[104:107], a[80:83], a[8:11], v[104:107]
buffer_load_dwordx4 v12, s[48:51], s64 offen lds
v_mfma_f32_16x16x32_bf16 v[104:107], a[84:87], a[12:15], v[104:107]
s_add_u32 s65, s79, 29696
ds_read_b128 a[52:55], v3 offset:36864
v_mfma_f32_16x16x32_bf16 v[88:91], a[84:87], a[4:7], v[88:91]
buffer_store_dwordx4 a[220:223], v16, s[44:47], s65 offen sc1
v_mfma_f32_16x16x32_bf16 v[88:91], a[80:83], a[0:3], v[88:91]
s_xor_b32 m0, s84, 5120
ds_read_b128 a[56:59], v2 offset:38912
v_mfma_f32_16x16x32_bf16 v[28:31], a[88:91], a[0:3], v[28:31]
s_xor_b32 s64, s73, 17664
ds_read_b128 a[60:63], v3 offset:38912
v_mfma_f32_16x16x32_bf16 v[28:31], a[92:95], a[4:7], v[28:31]
buffer_load_dwordx4 v13, s[48:51], s64 offen lds
v_mfma_f32_16x16x32_bf16 v[44:47], a[92:95], a[12:15], v[44:47]
ds_read_b64_tr_b16 a[72:73], v10 offset:32768
v_add_u32 v7, 0x8000, v7
v_mfma_f32_16x16x32_bf16 v[44:47], a[88:91], a[8:11], v[44:47]
ds_read_b64_tr_b16 a[74:75], v10 offset:33792
v_mfma_f32_16x16x32_bf16 v[60:63], a[88:91], a[16:19], v[60:63]
s_xor_b32 m0, s84, 6144
ds_read_b64_tr_b16 a[76:77], v10 offset:40960
v_mfma_f32_16x16x32_bf16 v[60:63], a[92:95], a[20:23], v[60:63]
s_xor_b32 s64, s73, 132352
ds_read_b64_tr_b16 a[78:79], v10 offset:41984
v_mfma_f32_16x16x32_bf16 v[76:79], a[92:95], a[28:31], v[76:79]
buffer_load_dwordx4 v12, s[48:51], s64 offen lds
v_mfma_f32_16x16x32_bf16 v[76:79], a[88:91], a[24:27], v[76:79]
ds_read_b64_tr_b16 a[80:81], v11 offset:32768
v_mfma_f32_16x16x32_bf16 v[140:143], a[96:99], a[24:27], v[140:143]
ds_read_b64_tr_b16 a[82:83], v11 offset:33792
v_mfma_f32_16x16x32_bf16 v[140:143], a[100:103], a[28:31], v[140:143]
s_xor_b32 m0, s84, 7168
ds_read_b64_tr_b16 a[84:85], v11 offset:40960
v_add_u32 v8, 0x8000, v8
v_mfma_f32_16x16x32_bf16 v[124:127], a[100:103], a[20:23], v[124:127]
s_xor_b32 s64, s73, 148736
ds_read_b64_tr_b16 a[86:87], v11 offset:41984
v_mfma_f32_16x16x32_bf16 v[124:127], a[96:99], a[16:19], v[124:127]
buffer_load_dwordx4 v13, s[48:51], s64 offen lds
v_mfma_f32_16x16x32_bf16 v[108:111], a[96:99], a[8:11], v[108:111]
v_mfma_f32_16x16x32_bf16 v[108:111], a[100:103], a[12:15], v[108:111]
v_mfma_f32_16x16x32_bf16 v[92:95], a[100:103], a[4:7], v[92:95]
v_add_u32 v9, 0x8000, v9
v_add_u32 v10, 0x8000, v10
v_mfma_f32_16x16x32_bf16 v[92:95], a[96:99], a[0:3], v[92:95]
v_add_u32 v11, 0x8000, v11
v_mfma_f32_16x16x32_bf16 v[32:35], a[104:107], a[0:3], v[32:35]
v_mfma_f32_16x16x32_bf16 v[32:35], a[108:111], a[4:7], v[32:35]
v_mfma_f32_16x16x32_bf16 v[48:51], a[108:111], a[12:15], v[48:51]
s_waitcnt lgkmcnt(0)
s_barrier
v_mfma_f32_16x16x32_bf16 v[48:51], a[104:107], a[8:11], v[48:51]
s_xor_b32 m0, s77, 98304
ds_read_b64_tr_b16 a[88:89], v19 offset:36864
v_mfma_f32_16x16x32_bf16 v[64:67], a[104:107], a[16:19], v[64:67]
s_xor_b32 s64, s71, 5767168
ds_read_b64_tr_b16 a[90:91], v19 offset:37120
v_mfma_f32_16x16x32_bf16 v[64:67], a[108:111], a[20:23], v[64:67]
buffer_load_dwordx4 v14, s[56:59], s64 offen lds
v_mfma_f32_16x16x32_bf16 v[80:83], a[108:111], a[28:31], v[80:83]
ds_read_b64_tr_b16 a[92:93], v19 offset:38912
v_mfma_f32_16x16x32_bf16 v[80:83], a[104:107], a[24:27], v[80:83]
ds_read_b64_tr_b16 a[94:95], v19 offset:39168
v_mfma_f32_16x16x32_bf16 v[144:147], a[112:115], a[24:27], v[144:147]
ds_read_b64_tr_b16 a[96:97], v20 offset:36864
v_mfma_f32_16x16x32_bf16 v[144:147], a[116:119], a[28:31], v[144:147]
ds_read_b64_tr_b16 a[98:99], v20 offset:37120
v_mfma_f32_16x16x32_bf16 v[128:131], a[116:119], a[20:23], v[128:131]
ds_read_b64_tr_b16 a[100:101], v20 offset:38912
v_mfma_f32_16x16x32_bf16 v[128:131], a[112:115], a[16:19], v[128:131]
ds_read_b64_tr_b16 a[102:103], v20 offset:39168
v_mfma_f32_16x16x32_bf16 v[112:115], a[112:115], a[8:11], v[112:115]
s_add_u32 m0, s78, 114688
ds_read_b64_tr_b16 a[104:105], v19 offset:40960
v_mfma_f32_16x16x32_bf16 v[112:115], a[116:119], a[12:15], v[112:115]
s_add_u32 s64, s75, 4325376
ds_read_b64_tr_b16 a[106:107], v19 offset:41216
v_mfma_f32_16x16x32_bf16 v[96:99], a[116:119], a[4:7], v[96:99]
buffer_load_dwordx4 v23, s[60:63], s64 offen lds
v_mfma_f32_16x16x32_bf16 v[96:99], a[112:115], a[0:3], v[96:99]
ds_read_b64_tr_b16 a[108:109], v19 offset:43008
v_mfma_f32_16x16x32_bf16 v[36:39], a[72:75], a[0:3], v[36:39]
ds_read_b64_tr_b16 a[110:111], v19 offset:43264
v_mfma_f32_16x16x32_bf16 v[36:39], a[76:79], a[4:7], v[36:39]
ds_read_b64_tr_b16 a[112:113], v20 offset:40960
v_mfma_f32_16x16x32_bf16 v[52:55], a[76:79], a[12:15], v[52:55]
ds_read_b64_tr_b16 a[114:115], v20 offset:41216
v_mfma_f32_16x16x32_bf16 v[52:55], a[72:75], a[8:11], v[52:55]
ds_read_b64_tr_b16 a[116:117], v20 offset:43008
v_mfma_f32_16x16x32_bf16 v[68:71], a[72:75], a[16:19], v[68:71]
ds_read_b64_tr_b16 a[118:119], v20 offset:43264
v_mfma_f32_16x16x32_bf16 v[68:71], a[76:79], a[20:23], v[68:71]
s_xor_b32 m0, s77, 99328
v_mfma_f32_16x16x32_bf16 v[84:87], a[76:79], a[28:31], v[84:87]
s_xor_b32 s64, s71, 5799936
v_mfma_f32_16x16x32_bf16 v[84:87], a[72:75], a[24:27], v[84:87]
buffer_load_dwordx4 v14, s[56:59], s64 offen lds
v_mfma_f32_16x16x32_bf16 v[148:151], a[80:83], a[24:27], v[148:151]
ds_read_b64_tr_b16 a[72:73], v19 offset:32768
v_mfma_f32_16x16x32_bf16 v[148:151], a[84:87], a[28:31], v[148:151]
ds_read_b64_tr_b16 a[74:75], v19 offset:33024
v_mfma_f32_16x16x32_bf16 v[132:135], a[84:87], a[20:23], v[132:135]
s_add_u32 s65, s79, 13312
ds_read_b64_tr_b16 a[76:77], v19 offset:34816
v_mfma_f32_16x16x32_bf16 v[132:135], a[80:83], a[16:19], v[132:135]
buffer_store_dwordx4 a[224:227], v16, s[44:47], s65 offen sc1
v_mfma_f32_16x16x32_bf16 v[116:119], a[80:83], a[8:11], v[116:119]
ds_read_b64_tr_b16 a[78:79], v19 offset:35072
v_mfma_f32_16x16x32_bf16 v[116:119], a[84:87], a[12:15], v[116:119]
v_mfma_f32_16x16x32_bf16 v[100:103], a[84:87], a[4:7], v[100:103]
s_add_u32 m0, s78, 118784
v_mfma_f32_16x16x32_bf16 v[100:103], a[80:83], a[0:3], v[100:103]
s_waitcnt lgkmcnt(4)
s_add_u32 s64, s75, 4327424
ds_read_b64_tr_b16 a[80:81], v20 offset:32768
v_mfma_f32_16x16x32_bf16 v[184:187], a[88:91], a[32:35], v[184:187]
buffer_load_dwordx4 v23, s[60:63], s64 offen lds
v_mfma_f32_16x16x32_bf16 v[184:187], a[92:95], a[36:39], v[184:187]
ds_read_b64_tr_b16 a[82:83], v20 offset:33024
v_mfma_f32_16x16x32_bf16 v[192:195], a[92:95], a[44:47], v[192:195]
ds_read_b64_tr_b16 a[84:85], v20 offset:34816
v_mfma_f32_16x16x32_bf16 v[192:195], a[88:91], a[40:43], v[192:195]
ds_read_b64_tr_b16 a[86:87], v20 offset:35072
v_mfma_f32_16x16x32_bf16 v[200:203], a[88:91], a[48:51], v[200:203]
v_mfma_f32_16x16x32_bf16 v[200:203], a[92:95], a[52:55], v[200:203]
v_mfma_f32_16x16x32_bf16 v[208:211], a[92:95], a[60:63], v[208:211]
v_mfma_f32_16x16x32_bf16 v[208:211], a[88:91], a[56:59], v[208:211]
ds_read_b64_tr_b16 a[88:89], v4 offset:32768
v_mfma_f32_16x16x32_bf16 v[212:215], a[96:99], a[56:59], v[212:215]
s_xor_b32 m0, s77, 100352
ds_read_b64_tr_b16 a[90:91], v4 offset:33792
v_mfma_f32_16x16x32_bf16 v[212:215], a[100:103], a[60:63], v[212:215]
s_xor_b32 s64, s71, 5832704
ds_read_b64_tr_b16 a[92:93], v4 offset:40960
v_mfma_f32_16x16x32_bf16 v[204:207], a[100:103], a[52:55], v[204:207]
buffer_load_dwordx4 v15, s[56:59], s64 offen lds
v_mfma_f32_16x16x32_bf16 v[204:207], a[96:99], a[48:51], v[204:207]
ds_read_b64_tr_b16 a[94:95], v4 offset:41984
v_mfma_f32_16x16x32_bf16 v[196:199], a[96:99], a[40:43], v[196:199]
v_mfma_f32_16x16x32_bf16 v[196:199], a[100:103], a[44:47], v[196:199]
v_mfma_f32_16x16x32_bf16 v[188:191], a[100:103], a[36:39], v[188:191]
v_mfma_f32_16x16x32_bf16 v[188:191], a[96:99], a[32:35], v[188:191]
ds_read_b64_tr_b16 a[96:97], v5 offset:32768
v_mfma_f32_16x16x32_bf16 v[216:219], a[32:35], a[104:107], v[216:219]
ds_read_b64_tr_b16 a[98:99], v5 offset:33792
v_mfma_f32_16x16x32_bf16 v[216:219], a[36:39], a[108:111], v[216:219]
s_add_u32 m0, s78, 122880
ds_read_b64_tr_b16 a[100:101], v5 offset:40960
v_mfma_f32_16x16x32_bf16 v[224:227], a[44:47], a[108:111], v[224:227]
s_add_u32 s64, s75, 4329472
ds_read_b64_tr_b16 a[102:103], v5 offset:41984
v_mfma_f32_16x16x32_bf16 v[224:227], a[40:43], a[104:107], v[224:227]
buffer_load_dwordx4 v23, s[60:63], s64 offen lds
v_mfma_f32_16x16x32_bf16 v[232:235], a[48:51], a[104:107], v[232:235]
v_mfma_f32_16x16x32_bf16 v[232:235], a[52:55], a[108:111], v[232:235]
v_mfma_f32_16x16x32_bf16 v[240:243], a[60:63], a[108:111], v[240:243]
v_mfma_f32_16x16x32_bf16 v[240:243], a[56:59], a[104:107], v[240:243]
ds_read_b64_tr_b16 a[104:105], v6 offset:32768
v_mfma_f32_16x16x32_bf16 v[244:247], a[56:59], a[112:115], v[244:247]
ds_read_b64_tr_b16 a[106:107], v6 offset:33792
v_mfma_f32_16x16x32_bf16 v[244:247], a[60:63], a[116:119], v[244:247]
ds_read_b64_tr_b16 a[108:109], v6 offset:40960
v_subrev_u32 v19, 0x8000, v19
v_mfma_f32_16x16x32_bf16 v[236:239], a[52:55], a[116:119], v[236:239]
s_xor_b32 m0, s77, 101376
ds_read_b64_tr_b16 a[110:111], v6 offset:41984
v_mfma_f32_16x16x32_bf16 v[236:239], a[48:51], a[112:115], v[236:239]
s_xor_b32 s64, s71, 5865472
v_mfma_f32_16x16x32_bf16 v[228:231], a[40:43], a[112:115], v[228:231]
buffer_load_dwordx4 v15, s[56:59], s64 offen lds
v_mfma_f32_16x16x32_bf16 v[228:231], a[44:47], a[116:119], v[228:231]
v_mfma_f32_16x16x32_bf16 v[220:223], a[36:39], a[116:119], v[220:223]
v_mfma_f32_16x16x32_bf16 v[220:223], a[32:35], a[112:115], v[220:223]
s_waitcnt lgkmcnt(4)
ds_read_b64_tr_b16 a[112:113], v7 offset:32768
v_mfma_f32_16x16x32_bf16 v[152:155], a[72:75], a[32:35], v[152:155]
ds_read_b64_tr_b16 a[114:115], v7 offset:33792
v_mfma_f32_16x16x32_bf16 v[152:155], a[76:79], a[36:39], v[152:155]
ds_read_b64_tr_b16 a[116:117], v7 offset:40960
v_subrev_u32 v20, 0x8000, v20
v_mfma_f32_16x16x32_bf16 v[160:163], a[76:79], a[44:47], v[160:163]
ds_read_b64_tr_b16 a[118:119], v7 offset:41984
v_mfma_f32_16x16x32_bf16 v[160:163], a[72:75], a[40:43], v[160:163]
v_mfma_f32_16x16x32_bf16 v[168:171], a[72:75], a[48:51], v[168:171]
v_mfma_f32_16x16x32_bf16 v[168:171], a[76:79], a[52:55], v[168:171]
v_mfma_f32_16x16x32_bf16 v[176:179], a[76:79], a[60:63], v[176:179]
s_xor_b32 m0, s84, 32768
s_add_u32 s65, s79, 30720
v_mfma_f32_16x16x32_bf16 v[176:179], a[72:75], a[56:59], v[176:179]
s_xor_b32 s64, s72, 1408
buffer_store_dwordx4 a[228:231], v16, s[44:47], s65 offen sc1
v_mfma_f32_16x16x32_bf16 v[180:183], a[80:83], a[56:59], v[180:183]
buffer_load_dwordx4 v12, s[48:51], s64 offen lds
v_mfma_f32_16x16x32_bf16 v[180:183], a[84:87], a[60:63], v[180:183]
ds_read_b64_tr_b16 a[72:73], v8 offset:32768
v_subrev_u32 v4, 0x8000, v4
v_mfma_f32_16x16x32_bf16 v[172:175], a[84:87], a[52:55], v[172:175]
ds_read_b64_tr_b16 a[74:75], v8 offset:33792
v_mfma_f32_16x16x32_bf16 v[172:175], a[80:83], a[48:51], v[172:175]
s_xor_b32 m0, s84, 33792
ds_read_b64_tr_b16 a[76:77], v8 offset:40960
v_mfma_f32_16x16x32_bf16 v[164:167], a[80:83], a[40:43], v[164:167]
s_xor_b32 s64, s72, 17792
ds_read_b64_tr_b16 a[78:79], v8 offset:41984
v_mfma_f32_16x16x32_bf16 v[164:167], a[84:87], a[44:47], v[164:167]
buffer_load_dwordx4 v13, s[48:51], s64 offen lds
v_mfma_f32_16x16x32_bf16 v[156:159], a[84:87], a[36:39], v[156:159]
v_mfma_f32_16x16x32_bf16 v[156:159], a[80:83], a[32:35], v[156:159]
ds_read_b64_tr_b16 a[80:81], v9 offset:32768
v_mfma_f32_16x16x32_bf16 v[24:27], a[88:91], a[32:35], v[24:27]
s_xor_b32 m0, s84, 34816
ds_read_b64_tr_b16 a[82:83], v9 offset:33792
v_mfma_f32_16x16x32_bf16 v[24:27], a[92:95], a[36:39], v[24:27]
s_xor_b32 s64, s72, 132480
ds_read_b64_tr_b16 a[84:85], v9 offset:40960
v_subrev_u32 v5, 0x8000, v5
v_mfma_f32_16x16x32_bf16 v[40:43], a[92:95], a[44:47], v[40:43]
buffer_load_dwordx4 v12, s[48:51], s64 offen lds
v_mfma_f32_16x16x32_bf16 v[40:43], a[88:91], a[40:43], v[40:43]
ds_read_b64_tr_b16 a[86:87], v9 offset:41984
v_mfma_f32_16x16x32_bf16 v[56:59], a[88:91], a[48:51], v[56:59]
v_mfma_f32_16x16x32_bf16 v[56:59], a[92:95], a[52:55], v[56:59]
s_xor_b32 m0, s84, 35840
v_mfma_f32_16x16x32_bf16 v[72:75], a[92:95], a[60:63], v[72:75]
s_waitcnt vmcnt(12)
s_xor_b32 s64, s72, 148864
ds_read_b128 a[0:3], v2 offset:0
v_mfma_f32_16x16x32_bf16 v[72:75], a[88:91], a[56:59], v[72:75]
buffer_load_dwordx4 v13, s[48:51], s64 offen lds
v_mfma_f32_16x16x32_bf16 v[136:139], a[96:99], a[56:59], v[136:139]
ds_read_b128 a[4:7], v3 offset:0
v_mfma_f32_16x16x32_bf16 v[136:139], a[100:103], a[60:63], v[136:139]
ds_read_b128 a[8:11], v2 offset:2048
v_subrev_u32 v6, 0x8000, v6
v_mfma_f32_16x16x32_bf16 v[120:123], a[100:103], a[52:55], v[120:123]
s_xor_b32 m0, s84, 36864
ds_read_b128 a[12:15], v3 offset:2048
v_mfma_f32_16x16x32_bf16 v[120:123], a[96:99], a[48:51], v[120:123]
s_xor_b32 s64, s73, 1408
ds_read_b128 a[16:19], v2 offset:4096
v_mfma_f32_16x16x32_bf16 v[104:107], a[96:99], a[40:43], v[104:107]
buffer_load_dwordx4 v12, s[48:51], s64 offen lds
v_mfma_f32_16x16x32_bf16 v[104:107], a[100:103], a[44:47], v[104:107]
ds_read_b128 a[20:23], v3 offset:4096
v_mfma_f32_16x16x32_bf16 v[88:91], a[100:103], a[36:39], v[88:91]
ds_read_b128 a[24:27], v2 offset:6144
v_mfma_f32_16x16x32_bf16 v[88:91], a[96:99], a[32:35], v[88:91]
s_waitcnt lgkmcnt(7)
s_xor_b32 m0, s84, 37888
ds_read_b128 a[28:31], v3 offset:6144
v_mfma_f32_16x16x32_bf16 v[28:31], a[104:107], a[32:35], v[28:31]
s_xor_b32 s64, s73, 17792
ds_read_b64_tr_b16 a[88:89], v10 offset:32768
v_mfma_f32_16x16x32_bf16 v[28:31], a[108:111], a[36:39], v[28:31]
buffer_load_dwordx4 v13, s[48:51], s64 offen lds
v_mfma_f32_16x16x32_bf16 v[44:47], a[108:111], a[44:47], v[44:47]
ds_read_b64_tr_b16 a[90:91], v10 offset:33792
v_subrev_u32 v7, 0x8000, v7
v_mfma_f32_16x16x32_bf16 v[44:47], a[104:107], a[40:43], v[44:47]
ds_read_b64_tr_b16 a[92:93], v10 offset:40960
v_mfma_f32_16x16x32_bf16 v[60:63], a[104:107], a[48:51], v[60:63]
s_xor_b32 m0, s84, 38912
ds_read_b64_tr_b16 a[94:95], v10 offset:41984
v_mfma_f32_16x16x32_bf16 v[60:63], a[108:111], a[52:55], v[60:63]
s_xor_b32 s64, s73, 132480
ds_read_b64_tr_b16 a[96:97], v11 offset:32768
v_mfma_f32_16x16x32_bf16 v[76:79], a[108:111], a[60:63], v[76:79]
buffer_load_dwordx4 v12, s[48:51], s64 offen lds
v_mfma_f32_16x16x32_bf16 v[76:79], a[104:107], a[56:59], v[76:79]
ds_read_b64_tr_b16 a[98:99], v11 offset:33792
v_mfma_f32_16x16x32_bf16 v[140:143], a[112:115], a[56:59], v[140:143]
s_xor_b32 m0, s84, 39936
ds_read_b64_tr_b16 a[100:101], v11 offset:40960
v_mfma_f32_16x16x32_bf16 v[140:143], a[116:119], a[60:63], v[140:143]
s_xor_b32 s64, s73, 148864
ds_read_b64_tr_b16 a[102:103], v11 offset:41984
v_subrev_u32 v8, 0x8000, v8
v_mfma_f32_16x16x32_bf16 v[124:127], a[116:119], a[52:55], v[124:127]
v_readfirstlane_b32 vcc_lo, v1
s_nop 0
s_cmp_lt_u32 vcc_lo, s81
s_cbranch_scc1 L_spin_1
L_spinbk_2:
v_mfma_f32_16x16x32_bf16 v[124:127], a[112:115], a[48:51], v[124:127]
buffer_load_dwordx4 v13, s[48:51], s64 offen lds
v_mfma_f32_16x16x32_bf16 v[108:111], a[112:115], a[40:43], v[108:111]
v_mfma_f32_16x16x32_bf16 v[108:111], a[116:119], a[44:47], v[108:111]
v_mfma_f32_16x16x32_bf16 v[92:95], a[116:119], a[36:39], v[92:95]
v_subrev_u32 v9, 0x8000, v9
v_subrev_u32 v10, 0x8000, v10
v_mfma_f32_16x16x32_bf16 v[92:95], a[112:115], a[32:35], v[92:95]
v_subrev_u32 v11, 0x8000, v11
v_mfma_f32_16x16x32_bf16 v[32:35], a[72:75], a[32:35], v[32:35]
s_add_u32 s52, s28, 59768832
s_addc_u32 s53, s29, 0
s_mov_b32 s54, 16384
v_mfma_f32_16x16x32_bf16 v[32:35], a[76:79], a[36:39], v[32:35]
v_mfma_f32_16x16x32_bf16 v[48:51], a[76:79], a[44:47], v[48:51]
s_waitcnt lgkmcnt(0)
s_barrier
v_mfma_f32_16x16x32_bf16 v[48:51], a[72:75], a[40:43], v[48:51]
s_xor_b32 m0, s77, 131072
s_add_u32 s65, s79, 31744
ds_read_b64_tr_b16 a[104:105], v19 offset:4096
v_mfma_f32_16x16x32_bf16 v[64:67], a[72:75], a[48:51], v[64:67]
s_xor_b32 s64, s71, 6291456
buffer_store_dwordx4 a[232:235], v16, s[44:47], s65 offen sc1
v_mfma_f32_16x16x32_bf16 v[64:67], a[76:79], a[52:55], v[64:67]
buffer_load_dwordx4 v14, s[56:59], s64 offen lds
v_mfma_f32_16x16x32_bf16 v[80:83], a[76:79], a[60:63], v[80:83]
ds_read_b64_tr_b16 a[106:107], v19 offset:4352
v_mfma_f32_16x16x32_bf16 v[80:83], a[72:75], a[56:59], v[80:83]
ds_read_b64_tr_b16 a[108:109], v19 offset:6144
v_mfma_f32_16x16x32_bf16 v[144:147], a[80:83], a[56:59], v[144:147]
ds_read_b64_tr_b16 a[110:111], v19 offset:6400
v_mfma_f32_16x16x32_bf16 v[144:147], a[84:87], a[60:63], v[144:147]
ds_read_b64_tr_b16 a[112:113], v20 offset:4096
v_mfma_f32_16x16x32_bf16 v[128:131], a[84:87], a[52:55], v[128:131]
ds_read_b64_tr_b16 a[114:115], v20 offset:4352
v_mfma_f32_16x16x32_bf16 v[128:131], a[80:83], a[48:51], v[128:131]
ds_read_b64_tr_b16 a[116:117], v20 offset:6144
v_mfma_f32_16x16x32_bf16 v[112:115], a[80:83], a[40:43], v[112:115]
s_add_u32 m0, s78, 147456
ds_read_b64_tr_b16 a[118:119], v20 offset:6400
v_mfma_f32_16x16x32_bf16 v[112:115], a[84:87], a[44:47], v[112:115]
s_add_u32 s64, s75, 4718592
ds_read_b64_tr_b16 a[72:73], v19 offset:8192
v_mfma_f32_16x16x32_bf16 v[96:99], a[84:87], a[36:39], v[96:99]
buffer_load_dwordx4 v23, s[60:63], s64 offen lds
v_mfma_f32_16x16x32_bf16 v[96:99], a[80:83], a[32:35], v[96:99]
ds_read_b64_tr_b16 a[74:75], v19 offset:8448
v_mfma_f32_16x16x32_bf16 v[36:39], a[88:91], a[32:35], v[36:39]
ds_read_b64_tr_b16 a[76:77], v19 offset:10240
v_mfma_f32_16x16x32_bf16 v[36:39], a[92:95], a[36:39], v[36:39]
ds_read_b64_tr_b16 a[78:79], v19 offset:10496
v_mfma_f32_16x16x32_bf16 v[52:55], a[92:95], a[44:47], v[52:55]
ds_read_b64_tr_b16 a[80:81], v20 offset:8192
v_mfma_f32_16x16x32_bf16 v[52:55], a[88:91], a[40:43], v[52:55]
ds_read_b64_tr_b16 a[82:83], v20 offset:8448
v_mfma_f32_16x16x32_bf16 v[68:71], a[88:91], a[48:51], v[68:71]
ds_read_b64_tr_b16 a[84:85], v20 offset:10240
v_mfma_f32_16x16x32_bf16 v[68:71], a[92:95], a[52:55], v[68:71]
s_xor_b32 m0, s77, 132096
ds_read_b64_tr_b16 a[86:87], v20 offset:10496
v_mfma_f32_16x16x32_bf16 v[84:87], a[92:95], a[60:63], v[84:87]
s_xor_b32 s64, s71, 6324224
v_mfma_f32_16x16x32_bf16 v[84:87], a[88:91], a[56:59], v[84:87]
buffer_load_dwordx4 v14, s[56:59], s64 offen lds
v_mfma_f32_16x16x32_bf16 v[148:151], a[96:99], a[56:59], v[148:151]
ds_read_b64_tr_b16 a[88:89], v19 offset:0
v_mfma_f32_16x16x32_bf16 v[148:151], a[100:103], a[60:63], v[148:151]
ds_read_b64_tr_b16 a[90:91], v19 offset:256
v_mfma_f32_16x16x32_bf16 v[132:135], a[100:103], a[52:55], v[132:135]
ds_read_b64_tr_b16 a[92:93], v19 offset:2048
v_mfma_f32_16x16x32_bf16 v[132:135], a[96:99], a[48:51], v[132:135]
ds_read_b64_tr_b16 a[94:95], v19 offset:2304
v_mfma_f32_16x16x32_bf16 v[116:119], a[96:99], a[40:43], v[116:119]
v_mfma_f32_16x16x32_bf16 v[116:119], a[100:103], a[44:47], v[116:119]
v_mfma_f32_16x16x32_bf16 v[100:103], a[100:103], a[36:39], v[100:103]
s_add_u32 m0, s78, 151552
v_mfma_f32_16x16x32_bf16 v[100:103], a[96:99], a[32:35], v[100:103]
s_waitcnt lgkmcnt(4)
s_add_u32 s64, s75, 4720640
ds_read_b64_tr_b16 a[96:97], v20 offset:0
v_mfma_f32_16x16x32_bf16 v[184:187], a[104:107], a[0:3], v[184:187]
buffer_load_dwordx4 v23, s[60:63], s64 offen lds
v_mfma_f32_16x16x32_bf16 v[184:187], a[108:111], a[4:7], v[184:187]
ds_read_b64_tr_b16 a[98:99], v20 offset:256
v_mfma_f32_16x16x32_bf16 v[192:195], a[108:111], a[12:15], v[192:195]
ds_read_b64_tr_b16 a[100:101], v20 offset:2048
v_mfma_f32_16x16x32_bf16 v[192:195], a[104:107], a[8:11], v[192:195]
ds_read_b64_tr_b16 a[102:103], v20 offset:2304
v_mfma_f32_16x16x32_bf16 v[200:203], a[104:107], a[16:19], v[200:203]
v_mfma_f32_16x16x32_bf16 v[200:203], a[108:111], a[20:23], v[200:203]
v_mfma_f32_16x16x32_bf16 v[208:211], a[108:111], a[28:31], v[208:211]
v_mfma_f32_16x16x32_bf16 v[208:211], a[104:107], a[24:27], v[208:211]
ds_read_b64_tr_b16 a[104:105], v4 offset:0
v_mfma_f32_16x16x32_bf16 v[212:215], a[112:115], a[24:27], v[212:215]
s_xor_b32 m0, s77, 133120
ds_read_b64_tr_b16 a[106:107], v4 offset:1024
v_mfma_f32_16x16x32_bf16 v[212:215], a[116:119], a[28:31], v[212:215]
s_xor_b32 s64, s71, 6356992
ds_read_b64_tr_b16 a[108:109], v4 offset:8192
v_mfma_f32_16x16x32_bf16 v[204:207], a[116:119], a[20:23], v[204:207]
buffer_load_dwordx4 v15, s[56:59], s64 offen lds
v_mfma_f32_16x16x32_bf16 v[204:207], a[112:115], a[16:19], v[204:207]
ds_read_b64_tr_b16 a[110:111], v4 offset:9216
v_mfma_f32_16x16x32_bf16 v[196:199], a[112:115], a[8:11], v[196:199]
v_mfma_f32_16x16x32_bf16 v[196:199], a[116:119], a[12:15], v[196:199]
v_mfma_f32_16x16x32_bf16 v[188:191], a[116:119], a[4:7], v[188:191]
v_mfma_f32_16x16x32_bf16 v[188:191], a[112:115], a[0:3], v[188:191]
ds_read_b64_tr_b16 a[112:113], v5 offset:0
v_mfma_f32_16x16x32_bf16 v[216:219], a[0:3], a[72:75], v[216:219]
s_add_u32 s65, s79, 15360
ds_read_b64_tr_b16 a[114:115], v5 offset:1024
v_mfma_f32_16x16x32_bf16 v[216:219], a[4:7], a[76:79], v[216:219]
s_add_u32 m0, s78, 155648
buffer_store_dwordx4 a[236:239], v16, s[44:47], s65 offen sc1
v_mfma_f32_16x16x32_bf16 v[224:227], a[12:15], a[76:79], v[224:227]
s_add_u32 s64, s75, 4722688
ds_read_b64_tr_b16 a[116:117], v5 offset:8192
v_mfma_f32_16x16x32_bf16 v[224:227], a[8:11], a[72:75], v[224:227]
buffer_load_dwordx4 v23, s[60:63], s64 offen lds
v_mfma_f32_16x16x32_bf16 v[232:235], a[16:19], a[72:75], v[232:235]
s_branch L_po11
L_pg11:
s_branch L_tr1
L_po11:
ds_read_b64_tr_b16 a[118:119], v5 offset:9216
v_mfma_f32_16x16x32_bf16 v[232:235], a[20:23], a[76:79], v[232:235]
v_mfma_f32_16x16x32_bf16 v[240:243], a[28:31], a[76:79], v[240:243]
v_mfma_f32_16x16x32_bf16 v[240:243], a[24:27], a[72:75], v[240:243]
ds_read_b64_tr_b16 a[72:73], v6 offset:0
v_mfma_f32_16x16x32_bf16 v[244:247], a[24:27], a[80:83], v[244:247]
ds_read_b64_tr_b16 a[74:75], v6 offset:1024
v_mfma_f32_16x16x32_bf16 v[244:247], a[28:31], a[84:87], v[244:247]
ds_read_b64_tr_b16 a[76:77], v6 offset:8192
v_mfma_f32_16x16x32_bf16 v[236:239], a[20:23], a[84:87], v[236:239]
s_xor_b32 m0, s77, 134144
ds_read_b64_tr_b16 a[78:79], v6 offset:9216
v_mfma_f32_16x16x32_bf16 v[236:239], a[16:19], a[80:83], v[236:239]
s_xor_b32 s64, s71, 6389760
v_mfma_f32_16x16x32_bf16 v[228:231], a[8:11], a[80:83], v[228:231]
buffer_load_dwordx4 v15, s[56:59], s64 offen lds
v_mfma_f32_16x16x32_bf16 v[228:231], a[12:15], a[84:87], v[228:231]
v_mfma_f32_16x16x32_bf16 v[220:223], a[4:7], a[84:87], v[220:223]
v_mfma_f32_16x16x32_bf16 v[220:223], a[0:3], a[80:83], v[220:223]
s_waitcnt lgkmcnt(4)
ds_read_b64_tr_b16 a[80:81], v7 offset:0
v_mfma_f32_16x16x32_bf16 v[152:155], a[88:91], a[0:3], v[152:155]
ds_read_b64_tr_b16 a[82:83], v7 offset:1024
v_mfma_f32_16x16x32_bf16 v[152:155], a[92:95], a[4:7], v[152:155]
ds_read_b64_tr_b16 a[84:85], v7 offset:8192
v_mfma_f32_16x16x32_bf16 v[160:163], a[92:95], a[12:15], v[160:163]
ds_read_b64_tr_b16 a[86:87], v7 offset:9216
v_mfma_f32_16x16x32_bf16 v[160:163], a[88:91], a[8:11], v[160:163]
v_mfma_f32_16x16x32_bf16 v[168:171], a[88:91], a[16:19], v[168:171]
v_mfma_f32_16x16x32_bf16 v[168:171], a[92:95], a[20:23], v[168:171]
v_mfma_f32_16x16x32_bf16 v[176:179], a[92:95], a[28:31], v[176:179]
s_xor_b32 m0, s84, 0
v_mfma_f32_16x16x32_bf16 v[176:179], a[88:91], a[24:27], v[176:179]
s_xor_b32 s64, s72, 1536
ds_read_b64_tr_b16 a[88:89], v8 offset:0
v_mfma_f32_16x16x32_bf16 v[180:183], a[96:99], a[24:27], v[180:183]
buffer_load_dwordx4 v12, s[48:51], s64 offen lds
v_mfma_f32_16x16x32_bf16 v[180:183], a[100:103], a[28:31], v[180:183]
ds_read_b64_tr_b16 a[90:91], v8 offset:1024
v_mfma_f32_16x16x32_bf16 v[172:175], a[100:103], a[20:23], v[172:175]
ds_read_b64_tr_b16 a[92:93], v8 offset:8192
v_mfma_f32_16x16x32_bf16 v[172:175], a[96:99], a[16:19], v[172:175]
s_xor_b32 m0, s84, 1024
ds_read_b64_tr_b16 a[94:95], v8 offset:9216
v_mfma_f32_16x16x32_bf16 v[164:167], a[96:99], a[8:11], v[164:167]
s_xor_b32 s64, s72, 17920
v_mfma_f32_16x16x32_bf16 v[164:167], a[100:103], a[12:15], v[164:167]
buffer_load_dwordx4 v13, s[48:51], s64 offen lds
v_mfma_f32_16x16x32_bf16 v[156:159], a[100:103], a[4:7], v[156:159]
v_mfma_f32_16x16x32_bf16 v[156:159], a[96:99], a[0:3], v[156:159]
ds_read_b64_tr_b16 a[96:97], v9 offset:0
v_mfma_f32_16x16x32_bf16 v[24:27], a[104:107], a[0:3], v[24:27]
s_xor_b32 m0, s84, 2048
ds_read_b64_tr_b16 a[98:99], v9 offset:1024
v_mfma_f32_16x16x32_bf16 v[24:27], a[108:111], a[4:7], v[24:27]
s_xor_b32 s64, s72, 132608
ds_read_b64_tr_b16 a[100:101], v9 offset:8192
v_mfma_f32_16x16x32_bf16 v[40:43], a[108:111], a[12:15], v[40:43]
buffer_load_dwordx4 v12, s[48:51], s64 offen lds
v_mfma_f32_16x16x32_bf16 v[40:43], a[104:107], a[8:11], v[40:43]
ds_read_b64_tr_b16 a[102:103], v9 offset:9216
v_mfma_f32_16x16x32_bf16 v[56:59], a[104:107], a[16:19], v[56:59]
v_mfma_f32_16x16x32_bf16 v[56:59], a[108:111], a[20:23], v[56:59]
s_xor_b32 m0, s84, 3072
v_mfma_f32_16x16x32_bf16 v[72:75], a[108:111], a[28:31], v[72:75]
s_waitcnt vmcnt(12)
s_xor_b32 s64, s72, 148992
ds_read_b128 a[32:35], v2 offset:32768
v_mfma_f32_16x16x32_bf16 v[72:75], a[104:107], a[24:27], v[72:75]
buffer_load_dwordx4 v13, s[48:51], s64 offen lds
v_mfma_f32_16x16x32_bf16 v[136:139], a[112:115], a[24:27], v[136:139]
ds_read_b128 a[36:39], v3 offset:32768
v_mfma_f32_16x16x32_bf16 v[136:139], a[116:119], a[28:31], v[136:139]
ds_read_b128 a[40:43], v2 offset:34816
v_mfma_f32_16x16x32_bf16 v[120:123], a[116:119], a[20:23], v[120:123]
s_xor_b32 m0, s84, 4096
ds_read_b128 a[44:47], v3 offset:34816
v_mfma_f32_16x16x32_bf16 v[120:123], a[112:115], a[16:19], v[120:123]
s_xor_b32 s64, s73, 1536
ds_read_b128 a[48:51], v2 offset:36864
v_mfma_f32_16x16x32_bf16 v[104:107], a[112:115], a[8:11], v[104:107]
buffer_load_dwordx4 v12, s[48:51], s64 offen lds
v_mfma_f32_16x16x32_bf16 v[104:107], a[116:119], a[12:15], v[104:107]
ds_read_b128 a[52:55], v3 offset:36864
v_mfma_f32_16x16x32_bf16 v[88:91], a[116:119], a[4:7], v[88:91]
buffer_store_dwordx4 a[240:243], v16, s[44:47], s74 offen sc1
v_mfma_f32_16x16x32_bf16 v[88:91], a[112:115], a[0:3], v[88:91]
s_waitcnt lgkmcnt(6)
s_xor_b32 m0, s84, 5120
ds_read_b128 a[56:59], v2 offset:38912
v_mfma_f32_16x16x32_bf16 v[28:31], a[72:75], a[0:3], v[28:31]
s_xor_b32 s64, s73, 17920
ds_read_b128 a[60:63], v3 offset:38912
v_mfma_f32_16x16x32_bf16 v[28:31], a[76:79], a[4:7], v[28:31]
buffer_load_dwordx4 v13, s[48:51], s64 offen lds
v_mfma_f32_16x16x32_bf16 v[44:47], a[76:79], a[12:15], v[44:47]
ds_read_b64_tr_b16 a[104:105], v10 offset:0
v_mfma_f32_16x16x32_bf16 v[44:47], a[72:75], a[8:11], v[44:47]
ds_read_b64_tr_b16 a[106:107], v10 offset:1024
v_mfma_f32_16x16x32_bf16 v[60:63], a[72:75], a[16:19], v[60:63]
s_xor_b32 m0, s84, 6144
ds_read_b64_tr_b16 a[108:109], v10 offset:8192
v_mfma_f32_16x16x32_bf16 v[60:63], a[76:79], a[20:23], v[60:63]
s_xor_b32 s64, s73, 132608
ds_read_b64_tr_b16 a[110:111], v10 offset:9216
v_mfma_f32_16x16x32_bf16 v[76:79], a[76:79], a[28:31], v[76:79]
buffer_load_dwordx4 v12, s[48:51], s64 offen lds
v_mfma_f32_16x16x32_bf16 v[76:79], a[72:75], a[24:27], v[76:79]
ds_read_b64_tr_b16 a[112:113], v11 offset:0
v_mfma_f32_16x16x32_bf16 v[140:143], a[80:83], a[24:27], v[140:143]
ds_read_b64_tr_b16 a[114:115], v11 offset:1024
v_mfma_f32_16x16x32_bf16 v[140:143], a[84:87], a[28:31], v[140:143]
s_xor_b32 m0, s84, 7168
ds_read_b64_tr_b16 a[116:117], v11 offset:8192
v_mfma_f32_16x16x32_bf16 v[124:127], a[84:87], a[20:23], v[124:127]
s_xor_b32 s64, s73, 148992
ds_read_b64_tr_b16 a[118:119], v11 offset:9216
v_mfma_f32_16x16x32_bf16 v[124:127], a[80:83], a[16:19], v[124:127]
buffer_load_dwordx4 v13, s[48:51], s64 offen lds
v_mfma_f32_16x16x32_bf16 v[108:111], a[80:83], a[8:11], v[108:111]
v_mfma_f32_16x16x32_bf16 v[108:111], a[84:87], a[12:15], v[108:111]
v_mfma_f32_16x16x32_bf16 v[92:95], a[84:87], a[4:7], v[92:95]
v_mfma_f32_16x16x32_bf16 v[92:95], a[80:83], a[0:3], v[92:95]
v_mfma_f32_16x16x32_bf16 v[32:35], a[88:91], a[0:3], v[32:35]
v_mfma_f32_16x16x32_bf16 v[32:35], a[92:95], a[4:7], v[32:35]
v_mfma_f32_16x16x32_bf16 v[48:51], a[92:95], a[12:15], v[48:51]
s_waitcnt lgkmcnt(0)
s_barrier
v_mfma_f32_16x16x32_bf16 v[48:51], a[88:91], a[8:11], v[48:51]
s_xor_b32 m0, s77, 65536
ds_read_b64_tr_b16 a[72:73], v19 offset:36864
v_mfma_f32_16x16x32_bf16 v[64:67], a[88:91], a[16:19], v[64:67]
s_xor_b32 s64, s71, 6815744
ds_read_b64_tr_b16 a[74:75], v19 offset:37120
v_mfma_f32_16x16x32_bf16 v[64:67], a[92:95], a[20:23], v[64:67]
buffer_load_dwordx4 v14, s[56:59], s64 offen lds
v_mfma_f32_16x16x32_bf16 v[80:83], a[92:95], a[28:31], v[80:83]
ds_read_b64_tr_b16 a[76:77], v19 offset:38912
v_mfma_f32_16x16x32_bf16 v[80:83], a[88:91], a[24:27], v[80:83]
ds_read_b64_tr_b16 a[78:79], v19 offset:39168
v_mfma_f32_16x16x32_bf16 v[144:147], a[96:99], a[24:27], v[144:147]
ds_read_b64_tr_b16 a[80:81], v20 offset:36864
v_mfma_f32_16x16x32_bf16 v[144:147], a[100:103], a[28:31], v[144:147]
ds_read_b64_tr_b16 a[82:83], v20 offset:37120
v_mfma_f32_16x16x32_bf16 v[128:131], a[100:103], a[20:23], v[128:131]
ds_read_b64_tr_b16 a[84:85], v20 offset:38912
v_mfma_f32_16x16x32_bf16 v[128:131], a[96:99], a[16:19], v[128:131]
ds_read_b64_tr_b16 a[86:87], v20 offset:39168
v_mfma_f32_16x16x32_bf16 v[112:115], a[96:99], a[8:11], v[112:115]
s_add_u32 m0, s78, 81920
ds_read_b64_tr_b16 a[88:89], v19 offset:40960
v_mfma_f32_16x16x32_bf16 v[112:115], a[100:103], a[12:15], v[112:115]
s_add_u32 s64, s75, 5111808
ds_read_b64_tr_b16 a[90:91], v19 offset:41216
v_mfma_f32_16x16x32_bf16 v[96:99], a[100:103], a[4:7], v[96:99]
buffer_load_dwordx4 v23, s[60:63], s64 offen lds
v_mfma_f32_16x16x32_bf16 v[96:99], a[96:99], a[0:3], v[96:99]
ds_read_b64_tr_b16 a[92:93], v19 offset:43008
v_mfma_f32_16x16x32_bf16 v[36:39], a[104:107], a[0:3], v[36:39]
ds_read_b64_tr_b16 a[94:95], v19 offset:43264
v_mfma_f32_16x16x32_bf16 v[36:39], a[108:111], a[4:7], v[36:39]
ds_read_b64_tr_b16 a[96:97], v20 offset:40960
v_mfma_f32_16x16x32_bf16 v[52:55], a[108:111], a[12:15], v[52:55]
ds_read_b64_tr_b16 a[98:99], v20 offset:41216
v_mfma_f32_16x16x32_bf16 v[52:55], a[104:107], a[8:11], v[52:55]
ds_read_b64_tr_b16 a[100:101], v20 offset:43008
v_mfma_f32_16x16x32_bf16 v[68:71], a[104:107], a[16:19], v[68:71]
ds_read_b64_tr_b16 a[102:103], v20 offset:43264
v_mfma_f32_16x16x32_bf16 v[68:71], a[108:111], a[20:23], v[68:71]
s_xor_b32 m0, s77, 66560
v_mfma_f32_16x16x32_bf16 v[84:87], a[108:111], a[28:31], v[84:87]
s_xor_b32 s64, s71, 6848512
v_mfma_f32_16x16x32_bf16 v[84:87], a[104:107], a[24:27], v[84:87]
buffer_load_dwordx4 v14, s[56:59], s64 offen lds
v_mfma_f32_16x16x32_bf16 v[148:151], a[112:115], a[24:27], v[148:151]
ds_read_b64_tr_b16 a[104:105], v19 offset:32768
v_mfma_f32_16x16x32_bf16 v[148:151], a[116:119], a[28:31], v[148:151]
ds_read_b64_tr_b16 a[106:107], v19 offset:33024
v_mfma_f32_16x16x32_bf16 v[132:135], a[116:119], a[20:23], v[132:135]
ds_read_b64_tr_b16 a[108:109], v19 offset:34816
v_mfma_f32_16x16x32_bf16 v[132:135], a[112:115], a[16:19], v[132:135]
ds_read_b64_tr_b16 a[110:111], v19 offset:35072
v_mfma_f32_16x16x32_bf16 v[116:119], a[112:115], a[8:11], v[116:119]
v_mfma_f32_16x16x32_bf16 v[116:119], a[116:119], a[12:15], v[116:119]
v_mfma_f32_16x16x32_bf16 v[100:103], a[116:119], a[4:7], v[100:103]
s_add_u32 m0, s78, 86016
v_mfma_f32_16x16x32_bf16 v[100:103], a[112:115], a[0:3], v[100:103]
s_waitcnt lgkmcnt(4)
s_add_u32 s64, s75, 5113856
ds_read_b64_tr_b16 a[112:113], v20 offset:32768
v_mfma_f32_16x16x32_bf16 v[184:187], a[72:75], a[32:35], v[184:187]
s_lshl_b32 s66, s30, 30
buffer_load_dwordx4 v23, s[60:63], s64 offen lds
v_mfma_f32_16x16x32_bf16 v[184:187], a[76:79], a[36:39], v[184:187]
ds_read_b64_tr_b16 a[114:115], v20 offset:33024
v_lshl_add_u32 v1, v0, 24, s66
v_mfma_f32_16x16x32_bf16 v[192:195], a[76:79], a[44:47], v[192:195]
s_lshl_b32 s70, s31, 8
ds_read_b64_tr_b16 a[116:117], v20 offset:34816
v_mfma_f32_16x16x32_bf16 v[192:195], a[72:75], a[40:43], v[192:195]
ds_read_b64_tr_b16 a[118:119], v20 offset:35072
v_mfma_f32_16x16x32_bf16 v[200:203], a[72:75], a[48:51], v[200:203]
v_mfma_f32_16x16x32_bf16 v[200:203], a[76:79], a[52:55], v[200:203]
v_mfma_f32_16x16x32_bf16 v[208:211], a[76:79], a[60:63], v[208:211]
v_mfma_f32_16x16x32_bf16 v[208:211], a[72:75], a[56:59], v[208:211]
ds_read_b64_tr_b16 a[72:73], v4 offset:32768
v_mfma_f32_16x16x32_bf16 v[212:215], a[80:83], a[56:59], v[212:215]
s_xor_b32 m0, s77, 67584
ds_read_b64_tr_b16 a[74:75], v4 offset:33792
v_mfma_f32_16x16x32_bf16 v[212:215], a[84:87], a[60:63], v[212:215]
s_xor_b32 s64, s71, 6881280
ds_read_b64_tr_b16 a[76:77], v4 offset:40960
v_mfma_f32_16x16x32_bf16 v[204:207], a[84:87], a[52:55], v[204:207]
buffer_load_dwordx4 v15, s[56:59], s64 offen lds
v_mfma_f32_16x16x32_bf16 v[204:207], a[80:83], a[48:51], v[204:207]
ds_read_b64_tr_b16 a[78:79], v4 offset:41984
v_mfma_f32_16x16x32_bf16 v[196:199], a[80:83], a[40:43], v[196:199]
v_mfma_f32_16x16x32_bf16 v[196:199], a[84:87], a[44:47], v[196:199]
v_mfma_f32_16x16x32_bf16 v[188:191], a[84:87], a[36:39], v[188:191]
v_mfma_f32_16x16x32_bf16 v[188:191], a[80:83], a[32:35], v[188:191]
ds_read_b64_tr_b16 a[80:81], v5 offset:32768
v_mfma_f32_16x16x32_bf16 v[216:219], a[32:35], a[88:91], v[216:219]
ds_read_b64_tr_b16 a[82:83], v5 offset:33792
v_mfma_f32_16x16x32_bf16 v[216:219], a[36:39], a[92:95], v[216:219]
s_add_u32 m0, s78, 90112
ds_read_b64_tr_b16 a[84:85], v5 offset:40960
v_mfma_f32_16x16x32_bf16 v[224:227], a[44:47], a[92:95], v[224:227]
s_add_u32 s64, s75, 5115904
ds_read_b64_tr_b16 a[86:87], v5 offset:41984
v_mfma_f32_16x16x32_bf16 v[224:227], a[40:43], a[88:91], v[224:227]
buffer_load_dwordx4 v23, s[60:63], s64 offen lds
v_mfma_f32_16x16x32_bf16 v[232:235], a[48:51], a[88:91], v[232:235]
v_mfma_f32_16x16x32_bf16 v[232:235], a[52:55], a[92:95], v[232:235]
v_mfma_f32_16x16x32_bf16 v[240:243], a[60:63], a[92:95], v[240:243]
v_mfma_f32_16x16x32_bf16 v[240:243], a[56:59], a[88:91], v[240:243]
ds_read_b64_tr_b16 a[88:89], v6 offset:32768
v_mfma_f32_16x16x32_bf16 v[244:247], a[56:59], a[96:99], v[244:247]
ds_read_b64_tr_b16 a[90:91], v6 offset:33792
v_mfma_f32_16x16x32_bf16 v[244:247], a[60:63], a[100:103], v[244:247]
ds_read_b64_tr_b16 a[92:93], v6 offset:40960
v_add_u32 v19, 0x8000, v19
v_mfma_f32_16x16x32_bf16 v[236:239], a[52:55], a[100:103], v[236:239]
s_xor_b32 m0, s77, 68608
ds_read_b64_tr_b16 a[94:95], v6 offset:41984
v_mfma_f32_16x16x32_bf16 v[236:239], a[48:51], a[96:99], v[236:239]
s_xor_b32 s64, s71, 6914048
v_mfma_f32_16x16x32_bf16 v[228:231], a[40:43], a[96:99], v[228:231]
buffer_load_dwordx4 v15, s[56:59], s64 offen lds
v_mfma_f32_16x16x32_bf16 v[228:231], a[44:47], a[100:103], v[228:231]
v_mfma_f32_16x16x32_bf16 v[220:223], a[36:39], a[100:103], v[220:223]
v_mfma_f32_16x16x32_bf16 v[220:223], a[32:35], a[96:99], v[220:223]
s_waitcnt lgkmcnt(4)
ds_read_b64_tr_b16 a[96:97], v7 offset:32768
v_mfma_f32_16x16x32_bf16 v[152:155], a[104:107], a[32:35], v[152:155]
ds_read_b64_tr_b16 a[98:99], v7 offset:33792
v_mfma_f32_16x16x32_bf16 v[152:155], a[108:111], a[36:39], v[152:155]
ds_read_b64_tr_b16 a[100:101], v7 offset:40960
v_add_u32 v20, 0x8000, v20
v_mfma_f32_16x16x32_bf16 v[160:163], a[108:111], a[44:47], v[160:163]
ds_read_b64_tr_b16 a[102:103], v7 offset:41984
v_mfma_f32_16x16x32_bf16 v[160:163], a[104:107], a[40:43], v[160:163]
v_mfma_f32_16x16x32_bf16 v[168:171], a[104:107], a[48:51], v[168:171]
v_mfma_f32_16x16x32_bf16 v[168:171], a[108:111], a[52:55], v[168:171]
v_mfma_f32_16x16x32_bf16 v[176:179], a[108:111], a[60:63], v[176:179]
s_xor_b32 m0, s84, 32768
v_mfma_f32_16x16x32_bf16 v[176:179], a[104:107], a[56:59], v[176:179]
s_xor_b32 s64, s72, 1664
ds_read_b64_tr_b16 a[104:105], v8 offset:32768
v_mfma_f32_16x16x32_bf16 v[180:183], a[112:115], a[56:59], v[180:183]
buffer_load_dwordx4 v12, s[48:51], s64 offen lds
v_mfma_f32_16x16x32_bf16 v[180:183], a[116:119], a[60:63], v[180:183]
ds_read_b64_tr_b16 a[106:107], v8 offset:33792
v_add_u32 v4, 0x8000, v4
v_mfma_f32_16x16x32_bf16 v[172:175], a[116:119], a[52:55], v[172:175]
ds_read_b64_tr_b16 a[108:109], v8 offset:40960
v_mfma_f32_16x16x32_bf16 v[172:175], a[112:115], a[48:51], v[172:175]
s_xor_b32 m0, s84, 33792
ds_read_b64_tr_b16 a[110:111], v8 offset:41984
v_mfma_f32_16x16x32_bf16 v[164:167], a[112:115], a[40:43], v[164:167]
s_xor_b32 s64, s72, 18048
v_mfma_f32_16x16x32_bf16 v[164:167], a[116:119], a[44:47], v[164:167]
buffer_load_dwordx4 v13, s[48:51], s64 offen lds
v_mfma_f32_16x16x32_bf16 v[156:159], a[116:119], a[36:39], v[156:159]
v_mfma_f32_16x16x32_bf16 v[156:159], a[112:115], a[32:35], v[156:159]
ds_read_b64_tr_b16 a[112:113], v9 offset:32768
v_mfma_f32_16x16x32_bf16 v[24:27], a[72:75], a[32:35], v[24:27]
s_xor_b32 m0, s84, 34816
ds_read_b64_tr_b16 a[114:115], v9 offset:33792
v_mfma_f32_16x16x32_bf16 v[24:27], a[76:79], a[36:39], v[24:27]
s_xor_b32 s64, s72, 132736
ds_read_b64_tr_b16 a[116:117], v9 offset:40960
v_add_u32 v5, 0x8000, v5
v_mfma_f32_16x16x32_bf16 v[40:43], a[76:79], a[44:47], v[40:43]
buffer_load_dwordx4 v12, s[48:51], s64 offen lds
v_mfma_f32_16x16x32_bf16 v[40:43], a[72:75], a[40:43], v[40:43]
ds_read_b64_tr_b16 a[118:119], v9 offset:41984
v_mfma_f32_16x16x32_bf16 v[56:59], a[72:75], a[48:51], v[56:59]
v_mfma_f32_16x16x32_bf16 v[56:59], a[76:79], a[52:55], v[56:59]
s_xor_b32 m0, s84, 35840
v_mfma_f32_16x16x32_bf16 v[72:75], a[76:79], a[60:63], v[72:75]
s_waitcnt vmcnt(10)
s_xor_b32 s64, s72, 149120
ds_read_b128 a[0:3], v2 offset:0
v_mfma_f32_16x16x32_bf16 v[72:75], a[72:75], a[56:59], v[72:75]
buffer_load_dwordx4 v13, s[48:51], s64 offen lds
v_mfma_f32_16x16x32_bf16 v[136:139], a[80:83], a[56:59], v[136:139]
ds_read_b128 a[4:7], v3 offset:0
v_mfma_f32_16x16x32_bf16 v[136:139], a[84:87], a[60:63], v[136:139]
ds_read_b128 a[8:11], v2 offset:2048
v_add_u32 v6, 0x8000, v6
v_mfma_f32_16x16x32_bf16 v[120:123], a[84:87], a[52:55], v[120:123]
s_xor_b32 m0, s84, 36864
ds_read_b128 a[12:15], v3 offset:2048
v_mfma_f32_16x16x32_bf16 v[120:123], a[80:83], a[48:51], v[120:123]
s_xor_b32 s64, s73, 1664
ds_read_b128 a[16:19], v2 offset:4096
v_mfma_f32_16x16x32_bf16 v[104:107], a[80:83], a[40:43], v[104:107]
buffer_load_dwordx4 v12, s[48:51], s64 offen lds
v_mfma_f32_16x16x32_bf16 v[104:107], a[84:87], a[44:47], v[104:107]
ds_read_b128 a[20:23], v3 offset:4096
v_mfma_f32_16x16x32_bf16 v[88:91], a[84:87], a[36:39], v[88:91]
ds_read_b128 a[24:27], v2 offset:6144
v_mfma_f32_16x16x32_bf16 v[88:91], a[80:83], a[32:35], v[88:91]
s_waitcnt lgkmcnt(7)
s_xor_b32 m0, s84, 37888
ds_read_b128 a[28:31], v3 offset:6144
v_mfma_f32_16x16x32_bf16 v[28:31], a[88:91], a[32:35], v[28:31]
s_xor_b32 s64, s73, 18048
ds_read_b64_tr_b16 a[72:73], v10 offset:32768
v_mfma_f32_16x16x32_bf16 v[28:31], a[92:95], a[36:39], v[28:31]
buffer_load_dwordx4 v13, s[48:51], s64 offen lds
v_mfma_f32_16x16x32_bf16 v[44:47], a[92:95], a[44:47], v[44:47]
ds_read_b64_tr_b16 a[74:75], v10 offset:33792
v_add_u32 v7, 0x8000, v7
v_mfma_f32_16x16x32_bf16 v[44:47], a[88:91], a[40:43], v[44:47]
ds_read_b64_tr_b16 a[76:77], v10 offset:40960
v_mfma_f32_16x16x32_bf16 v[60:63], a[88:91], a[48:51], v[60:63]
s_xor_b32 m0, s84, 38912
ds_read_b64_tr_b16 a[78:79], v10 offset:41984
v_mfma_f32_16x16x32_bf16 v[60:63], a[92:95], a[52:55], v[60:63]
s_xor_b32 s64, s73, 132736
ds_read_b64_tr_b16 a[80:81], v11 offset:32768
v_mfma_f32_16x16x32_bf16 v[76:79], a[92:95], a[60:63], v[76:79]
buffer_load_dwordx4 v12, s[48:51], s64 offen lds
v_mfma_f32_16x16x32_bf16 v[76:79], a[88:91], a[56:59], v[76:79]
ds_read_b64_tr_b16 a[82:83], v11 offset:33792
v_mfma_f32_16x16x32_bf16 v[140:143], a[96:99], a[56:59], v[140:143]
ds_read_b64_tr_b16 a[84:85], v11 offset:40960
v_mfma_f32_16x16x32_bf16 v[140:143], a[100:103], a[60:63], v[140:143]
s_xor_b32 m0, s84, 39936
ds_read_b64_tr_b16 a[86:87], v11 offset:41984
v_add_u32 v8, 0x8000, v8
v_mfma_f32_16x16x32_bf16 v[124:127], a[100:103], a[52:55], v[124:127]
s_xor_b32 s64, s73, 149120
v_mfma_f32_16x16x32_bf16 v[124:127], a[96:99], a[48:51], v[124:127]
buffer_load_dwordx4 v13, s[48:51], s64 offen lds
v_mfma_f32_16x16x32_bf16 v[108:111], a[96:99], a[40:43], v[108:111]
v_mfma_f32_16x16x32_bf16 v[108:111], a[100:103], a[44:47], v[108:111]
v_mfma_f32_16x16x32_bf16 v[92:95], a[100:103], a[36:39], v[92:95]
v_add_u32 v9, 0x8000, v9
v_add_u32 v10, 0x8000, v10
v_mfma_f32_16x16x32_bf16 v[92:95], a[96:99], a[32:35], v[92:95]
v_add_u32 v11, 0x8000, v11
v_mfma_f32_16x16x32_bf16 v[32:35], a[104:107], a[32:35], v[32:35]
v_mfma_f32_16x16x32_bf16 v[32:35], a[108:111], a[36:39], v[32:35]
v_mfma_f32_16x16x32_bf16 v[48:51], a[108:111], a[44:47], v[48:51]
s_waitcnt lgkmcnt(0)
s_barrier
v_mfma_f32_16x16x32_bf16 v[48:51], a[104:107], a[40:43], v[48:51]
s_mov_b64 exec, 1
buffer_atomic_add a251, v1, s[52:55], s70 offen offset:0 sc1
s_mov_b64 exec, -1
s_xor_b32 m0, s77, 98304
v_mfma_f32_16x16x32_bf16 v[64:67], a[104:107], a[48:51], v[64:67]
s_lshl4_add_u32 s70, s78, s70
s_xor_b32 s64, s71, 7340032
ds_read_b64_tr_b16 a[88:89], v19 offset:36864
v_mfma_f32_16x16x32_bf16 v[64:67], a[108:111], a[52:55], v[64:67]
s_lshr_b32 s81, s81, 5
buffer_load_dwordx4 v14, s[56:59], s64 offen lds
v_mfma_f32_16x16x32_bf16 v[80:83], a[108:111], a[60:63], v[80:83]
ds_read_b64_tr_b16 a[90:91], v19 offset:37120
v_mfma_f32_16x16x32_bf16 v[80:83], a[104:107], a[56:59], v[80:83]
ds_read_b64_tr_b16 a[92:93], v19 offset:38912
v_mfma_f32_16x16x32_bf16 v[144:147], a[112:115], a[56:59], v[144:147]
ds_read_b64_tr_b16 a[94:95], v19 offset:39168
v_mfma_f32_16x16x32_bf16 v[144:147], a[116:119], a[60:63], v[144:147]
ds_read_b64_tr_b16 a[96:97], v20 offset:36864
v_mfma_f32_16x16x32_bf16 v[128:131], a[116:119], a[52:55], v[128:131]
ds_read_b64_tr_b16 a[98:99], v20 offset:37120
v_mfma_f32_16x16x32_bf16 v[128:131], a[112:115], a[48:51], v[128:131]
ds_read_b64_tr_b16 a[100:101], v20 offset:38912
v_mfma_f32_16x16x32_bf16 v[112:115], a[112:115], a[40:43], v[112:115]
s_add_u32 m0, s78, 114688
ds_read_b64_tr_b16 a[102:103], v20 offset:39168
v_mfma_f32_16x16x32_bf16 v[112:115], a[116:119], a[44:47], v[112:115]
s_add_u32 s64, s75, 5505024
ds_read_b64_tr_b16 a[104:105], v19 offset:40960
v_mfma_f32_16x16x32_bf16 v[96:99], a[116:119], a[36:39], v[96:99]
buffer_load_dwordx4 v23, s[60:63], s64 offen lds
v_mfma_f32_16x16x32_bf16 v[96:99], a[112:115], a[32:35], v[96:99]
ds_read_b64_tr_b16 a[106:107], v19 offset:41216
v_mfma_f32_16x16x32_bf16 v[36:39], a[72:75], a[32:35], v[36:39]
ds_read_b64_tr_b16 a[108:109], v19 offset:43008
v_mfma_f32_16x16x32_bf16 v[36:39], a[76:79], a[36:39], v[36:39]
ds_read_b64_tr_b16 a[110:111], v19 offset:43264
v_mfma_f32_16x16x32_bf16 v[52:55], a[76:79], a[44:47], v[52:55]
ds_read_b64_tr_b16 a[112:113], v20 offset:40960
v_mfma_f32_16x16x32_bf16 v[52:55], a[72:75], a[40:43], v[52:55]
ds_read_b64_tr_b16 a[114:115], v20 offset:41216
v_mfma_f32_16x16x32_bf16 v[68:71], a[72:75], a[48:51], v[68:71]
ds_read_b64_tr_b16 a[116:117], v20 offset:43008
v_mfma_f32_16x16x32_bf16 v[68:71], a[76:79], a[52:55], v[68:71]
s_xor_b32 m0, s77, 99328
ds_read_b64_tr_b16 a[118:119], v20 offset:43264
v_mfma_f32_16x16x32_bf16 v[84:87], a[76:79], a[60:63], v[84:87]
s_xor_b32 s64, s71, 7372800
v_mfma_f32_16x16x32_bf16 v[84:87], a[72:75], a[56:59], v[84:87]
buffer_load_dwordx4 v14, s[56:59], s64 offen lds
v_mfma_f32_16x16x32_bf16 v[148:151], a[80:83], a[56:59], v[148:151]
ds_read_b64_tr_b16 a[72:73], v19 offset:32768
v_mfma_f32_16x16x32_bf16 v[148:151], a[84:87], a[60:63], v[148:151]
ds_read_b64_tr_b16 a[74:75], v19 offset:33024
v_mfma_f32_16x16x32_bf16 v[132:135], a[84:87], a[52:55], v[132:135]
ds_read_b64_tr_b16 a[76:77], v19 offset:34816
v_mfma_f32_16x16x32_bf16 v[132:135], a[80:83], a[48:51], v[132:135]
ds_read_b64_tr_b16 a[78:79], v19 offset:35072
v_mfma_f32_16x16x32_bf16 v[116:119], a[80:83], a[40:43], v[116:119]
v_mfma_f32_16x16x32_bf16 v[116:119], a[84:87], a[44:47], v[116:119]
v_mfma_f32_16x16x32_bf16 v[100:103], a[84:87], a[36:39], v[100:103]
s_add_u32 m0, s78, 118784
v_mfma_f32_16x16x32_bf16 v[100:103], a[80:83], a[32:35], v[100:103]
s_waitcnt lgkmcnt(4)
s_add_u32 s64, s75, 5507072
ds_read_b64_tr_b16 a[80:81], v20 offset:32768
v_mfma_f32_16x16x32_bf16 v[184:187], a[88:91], a[0:3], v[184:187]
buffer_load_dwordx4 v23, s[60:63], s64 offen lds
v_mfma_f32_16x16x32_bf16 v[184:187], a[92:95], a[4:7], v[184:187]
ds_read_b64_tr_b16 a[82:83], v20 offset:33024
v_mfma_f32_16x16x32_bf16 v[192:195], a[92:95], a[12:15], v[192:195]
ds_read_b64_tr_b16 a[84:85], v20 offset:34816
v_mfma_f32_16x16x32_bf16 v[192:195], a[88:91], a[8:11], v[192:195]
ds_read_b64_tr_b16 a[86:87], v20 offset:35072
v_mfma_f32_16x16x32_bf16 v[200:203], a[88:91], a[16:19], v[200:203]
v_mfma_f32_16x16x32_bf16 v[200:203], a[92:95], a[20:23], v[200:203]
v_mfma_f32_16x16x32_bf16 v[208:211], a[92:95], a[28:31], v[208:211]
v_mfma_f32_16x16x32_bf16 v[208:211], a[88:91], a[24:27], v[208:211]
ds_read_b64_tr_b16 a[88:89], v4 offset:32768
v_mfma_f32_16x16x32_bf16 v[212:215], a[96:99], a[24:27], v[212:215]
s_xor_b32 m0, s77, 100352
ds_read_b64_tr_b16 a[90:91], v4 offset:33792
v_mfma_f32_16x16x32_bf16 v[212:215], a[100:103], a[28:31], v[212:215]
s_xor_b32 s64, s71, 7405568
ds_read_b64_tr_b16 a[92:93], v4 offset:40960
v_mfma_f32_16x16x32_bf16 v[204:207], a[100:103], a[20:23], v[204:207]
buffer_load_dwordx4 v15, s[56:59], s64 offen lds
v_mfma_f32_16x16x32_bf16 v[204:207], a[96:99], a[16:19], v[204:207]
ds_read_b64_tr_b16 a[94:95], v4 offset:41984
v_mfma_f32_16x16x32_bf16 v[196:199], a[96:99], a[8:11], v[196:199]
v_mfma_f32_16x16x32_bf16 v[196:199], a[100:103], a[12:15], v[196:199]
v_mfma_f32_16x16x32_bf16 v[188:191], a[100:103], a[4:7], v[188:191]
v_mfma_f32_16x16x32_bf16 v[188:191], a[96:99], a[0:3], v[188:191]
ds_read_b64_tr_b16 a[96:97], v5 offset:32768
v_mfma_f32_16x16x32_bf16 v[216:219], a[0:3], a[104:107], v[216:219]
ds_read_b64_tr_b16 a[98:99], v5 offset:33792
v_mfma_f32_16x16x32_bf16 v[216:219], a[4:7], a[108:111], v[216:219]
s_add_u32 m0, s78, 122880
ds_read_b64_tr_b16 a[100:101], v5 offset:40960
v_mfma_f32_16x16x32_bf16 v[224:227], a[12:15], a[108:111], v[224:227]
s_add_u32 s64, s75, 5509120
ds_read_b64_tr_b16 a[102:103], v5 offset:41984
v_mfma_f32_16x16x32_bf16 v[224:227], a[8:11], a[104:107], v[224:227]
buffer_load_dwordx4 v23, s[60:63], s64 offen lds
v_mfma_f32_16x16x32_bf16 v[232:235], a[16:19], a[104:107], v[232:235]
v_mfma_f32_16x16x32_bf16 v[232:235], a[20:23], a[108:111], v[232:235]
v_mfma_f32_16x16x32_bf16 v[240:243], a[28:31], a[108:111], v[240:243]
v_mfma_f32_16x16x32_bf16 v[240:243], a[24:27], a[104:107], v[240:243]
ds_read_b64_tr_b16 a[104:105], v6 offset:32768
v_mfma_f32_16x16x32_bf16 v[244:247], a[24:27], a[112:115], v[244:247]
ds_read_b64_tr_b16 a[106:107], v6 offset:33792
v_mfma_f32_16x16x32_bf16 v[244:247], a[28:31], a[116:119], v[244:247]
ds_read_b64_tr_b16 a[108:109], v6 offset:40960
v_subrev_u32 v19, 0x8000, v19
v_mfma_f32_16x16x32_bf16 v[236:239], a[20:23], a[116:119], v[236:239]
s_xor_b32 m0, s77, 101376
ds_read_b64_tr_b16 a[110:111], v6 offset:41984
v_mfma_f32_16x16x32_bf16 v[236:239], a[16:19], a[112:115], v[236:239]
s_xor_b32 s64, s71, 7438336
v_mfma_f32_16x16x32_bf16 v[228:231], a[8:11], a[112:115], v[228:231]
buffer_load_dwordx4 v15, s[56:59], s64 offen lds
v_mfma_f32_16x16x32_bf16 v[228:231], a[12:15], a[116:119], v[228:231]
v_mfma_f32_16x16x32_bf16 v[220:223], a[4:7], a[116:119], v[220:223]
v_mfma_f32_16x16x32_bf16 v[220:223], a[0:3], a[112:115], v[220:223]
s_waitcnt lgkmcnt(4)
ds_read_b64_tr_b16 a[112:113], v7 offset:32768
v_mfma_f32_16x16x32_bf16 v[152:155], a[72:75], a[0:3], v[152:155]
ds_read_b64_tr_b16 a[114:115], v7 offset:33792
v_mfma_f32_16x16x32_bf16 v[152:155], a[76:79], a[4:7], v[152:155]
ds_read_b64_tr_b16 a[116:117], v7 offset:40960
v_subrev_u32 v20, 0x8000, v20
v_mfma_f32_16x16x32_bf16 v[160:163], a[76:79], a[12:15], v[160:163]
ds_read_b64_tr_b16 a[118:119], v7 offset:41984
v_mfma_f32_16x16x32_bf16 v[160:163], a[72:75], a[8:11], v[160:163]
v_mfma_f32_16x16x32_bf16 v[168:171], a[72:75], a[16:19], v[168:171]
v_mfma_f32_16x16x32_bf16 v[168:171], a[76:79], a[20:23], v[168:171]
v_mfma_f32_16x16x32_bf16 v[176:179], a[76:79], a[28:31], v[176:179]
s_xor_b32 m0, s84, 0
v_mfma_f32_16x16x32_bf16 v[176:179], a[72:75], a[24:27], v[176:179]
s_xor_b32 s64, s72, 1792
ds_read_b64_tr_b16 a[72:73], v8 offset:32768
v_mfma_f32_16x16x32_bf16 v[180:183], a[80:83], a[24:27], v[180:183]
buffer_load_dwordx4 v12, s[48:51], s64 offen lds
v_mfma_f32_16x16x32_bf16 v[180:183], a[84:87], a[28:31], v[180:183]
ds_read_b64_tr_b16 a[74:75], v8 offset:33792
v_subrev_u32 v4, 0x8000, v4
v_mfma_f32_16x16x32_bf16 v[172:175], a[84:87], a[20:23], v[172:175]
ds_read_b64_tr_b16 a[76:77], v8 offset:40960
v_mfma_f32_16x16x32_bf16 v[172:175], a[80:83], a[16:19], v[172:175]
s_xor_b32 m0, s84, 1024
ds_read_b64_tr_b16 a[78:79], v8 offset:41984
v_mfma_f32_16x16x32_bf16 v[164:167], a[80:83], a[8:11], v[164:167]
s_xor_b32 s64, s72, 18176
v_mfma_f32_16x16x32_bf16 v[164:167], a[84:87], a[12:15], v[164:167]
s_branch L_po12
L_pg12:
s_branch L_tr1
L_po12:
buffer_load_dwordx4 v13, s[48:51], s64 offen lds
v_mfma_f32_16x16x32_bf16 v[156:159], a[84:87], a[4:7], v[156:159]
v_mfma_f32_16x16x32_bf16 v[156:159], a[80:83], a[0:3], v[156:159]
ds_read_b64_tr_b16 a[80:81], v9 offset:32768
v_mfma_f32_16x16x32_bf16 v[24:27], a[88:91], a[0:3], v[24:27]
s_xor_b32 m0, s84, 2048
ds_read_b64_tr_b16 a[82:83], v9 offset:33792
v_mfma_f32_16x16x32_bf16 v[24:27], a[92:95], a[4:7], v[24:27]
s_xor_b32 s64, s72, 132864
ds_read_b64_tr_b16 a[84:85], v9 offset:40960
v_subrev_u32 v5, 0x8000, v5
v_mfma_f32_16x16x32_bf16 v[40:43], a[92:95], a[12:15], v[40:43]
buffer_load_dwordx4 v12, s[48:51], s64 offen lds
v_mfma_f32_16x16x32_bf16 v[40:43], a[88:91], a[8:11], v[40:43]
ds_read_b64_tr_b16 a[86:87], v9 offset:41984
v_mfma_f32_16x16x32_bf16 v[56:59], a[88:91], a[16:19], v[56:59]
v_mfma_f32_16x16x32_bf16 v[56:59], a[92:95], a[20:23], v[56:59]
s_xor_b32 m0, s84, 3072
v_mfma_f32_16x16x32_bf16 v[72:75], a[92:95], a[28:31], v[72:75]
s_waitcnt vmcnt(11)
s_xor_b32 s64, s72, 149248
ds_read_b128 a[32:35], v2 offset:32768
v_mfma_f32_16x16x32_bf16 v[72:75], a[88:91], a[24:27], v[72:75]
buffer_load_dwordx4 v13, s[48:51], s64 offen lds
v_mfma_f32_16x16x32_bf16 v[136:139], a[96:99], a[24:27], v[136:139]
ds_read_b128 a[36:39], v3 offset:32768
v_mfma_f32_16x16x32_bf16 v[136:139], a[100:103], a[28:31], v[136:139]
ds_read_b128 a[40:43], v2 offset:34816
v_subrev_u32 v6, 0x8000, v6
v_mfma_f32_16x16x32_bf16 v[120:123], a[100:103], a[20:23], v[120:123]
s_xor_b32 m0, s84, 4096
ds_read_b128 a[44:47], v3 offset:34816
v_mfma_f32_16x16x32_bf16 v[120:123], a[96:99], a[16:19], v[120:123]
s_xor_b32 s64, s73, 1792
ds_read_b128 a[48:51], v2 offset:36864
v_mfma_f32_16x16x32_bf16 v[104:107], a[96:99], a[8:11], v[104:107]
buffer_load_dwordx4 v12, s[48:51], s64 offen lds
v_mfma_f32_16x16x32_bf16 v[104:107], a[100:103], a[12:15], v[104:107]
ds_read_b128 a[52:55], v3 offset:36864
v_mfma_f32_16x16x32_bf16 v[88:91], a[100:103], a[4:7], v[88:91]
ds_read_b128 a[56:59], v2 offset:38912
v_mfma_f32_16x16x32_bf16 v[88:91], a[96:99], a[0:3], v[88:91]
s_waitcnt lgkmcnt(7)
s_xor_b32 m0, s84, 5120
ds_read_b128 a[60:63], v3 offset:38912
v_mfma_f32_16x16x32_bf16 v[28:31], a[104:107], a[0:3], v[28:31]
s_xor_b32 s64, s73, 18176
ds_read_b64_tr_b16 a[88:89], v10 offset:32768
v_mfma_f32_16x16x32_bf16 v[28:31], a[108:111], a[4:7], v[28:31]
buffer_load_dwordx4 v13, s[48:51], s64 offen lds
v_mfma_f32_16x16x32_bf16 v[44:47], a[108:111], a[12:15], v[44:47]
ds_read_b64_tr_b16 a[90:91], v10 offset:33792
v_subrev_u32 v7, 0x8000, v7
v_mfma_f32_16x16x32_bf16 v[44:47], a[104:107], a[8:11], v[44:47]
ds_read_b64_tr_b16 a[92:93], v10 offset:40960
v_mfma_f32_16x16x32_bf16 v[60:63], a[104:107], a[16:19], v[60:63]
s_xor_b32 m0, s84, 6144
ds_read_b64_tr_b16 a[94:95], v10 offset:41984
v_mfma_f32_16x16x32_bf16 v[60:63], a[108:111], a[20:23], v[60:63]
s_xor_b32 s64, s73, 132864
ds_read_b64_tr_b16 a[96:97], v11 offset:32768
v_mfma_f32_16x16x32_bf16 v[76:79], a[108:111], a[28:31], v[76:79]
buffer_load_dwordx4 v12, s[48:51], s64 offen lds
v_mfma_f32_16x16x32_bf16 v[76:79], a[104:107], a[24:27], v[76:79]
ds_read_b64_tr_b16 a[98:99], v11 offset:33792
v_mfma_f32_16x16x32_bf16 v[140:143], a[112:115], a[24:27], v[140:143]
ds_read_b64_tr_b16 a[100:101], v11 offset:40960
v_mfma_f32_16x16x32_bf16 v[140:143], a[116:119], a[28:31], v[140:143]
s_xor_b32 m0, s84, 7168
ds_read_b64_tr_b16 a[102:103], v11 offset:41984
v_subrev_u32 v8, 0x8000, v8
v_mfma_f32_16x16x32_bf16 v[124:127], a[116:119], a[20:23], v[124:127]
s_xor_b32 s64, s73, 149248
v_mfma_f32_16x16x32_bf16 v[124:127], a[112:115], a[16:19], v[124:127]
buffer_load_dwordx4 v13, s[48:51], s64 offen lds
v_mfma_f32_16x16x32_bf16 v[108:111], a[112:115], a[8:11], v[108:111]
v_mfma_f32_16x16x32_bf16 v[108:111], a[116:119], a[12:15], v[108:111]
v_mfma_f32_16x16x32_bf16 v[92:95], a[116:119], a[4:7], v[92:95]
v_subrev_u32 v9, 0x8000, v9
v_subrev_u32 v10, 0x8000, v10
v_mfma_f32_16x16x32_bf16 v[92:95], a[112:115], a[0:3], v[92:95]
v_subrev_u32 v11, 0x8000, v11
v_mfma_f32_16x16x32_bf16 v[32:35], a[72:75], a[0:3], v[32:35]
v_mfma_f32_16x16x32_bf16 v[32:35], a[76:79], a[4:7], v[32:35]
v_mfma_f32_16x16x32_bf16 v[48:51], a[76:79], a[12:15], v[48:51]
s_waitcnt lgkmcnt(0)
s_barrier
v_mfma_f32_16x16x32_bf16 v[48:51], a[72:75], a[8:11], v[48:51]
s_xor_b32 m0, s84, 32768
buffer_load_dword v1, off, s[52:55], s70 sc1
v_mfma_f32_16x16x32_bf16 v[64:67], a[72:75], a[16:19], v[64:67]
s_xor_b32 s64, s72, 1920
ds_read_b64_tr_b16 a[104:105], v19 offset:4096
v_mfma_f32_16x16x32_bf16 v[64:67], a[76:79], a[20:23], v[64:67]
buffer_load_dwordx4 v12, s[48:51], s64 offen lds
v_mfma_f32_16x16x32_bf16 v[80:83], a[76:79], a[28:31], v[80:83]
ds_read_b64_tr_b16 a[106:107], v19 offset:4352
v_mfma_f32_16x16x32_bf16 v[80:83], a[72:75], a[24:27], v[80:83]
ds_read_b64_tr_b16 a[108:109], v19 offset:6144
v_mfma_f32_16x16x32_bf16 v[144:147], a[80:83], a[24:27], v[144:147]
ds_read_b64_tr_b16 a[110:111], v19 offset:6400
v_mfma_f32_16x16x32_bf16 v[144:147], a[84:87], a[28:31], v[144:147]
s_xor_b32 m0, s84, 33792
ds_read_b64_tr_b16 a[112:113], v20 offset:4096
v_mfma_f32_16x16x32_bf16 v[128:131], a[84:87], a[20:23], v[128:131]
s_xor_b32 s64, s72, 18304
ds_read_b64_tr_b16 a[114:115], v20 offset:4352
v_mfma_f32_16x16x32_bf16 v[128:131], a[80:83], a[16:19], v[128:131]
buffer_load_dwordx4 v13, s[48:51], s64 offen lds
v_mfma_f32_16x16x32_bf16 v[112:115], a[80:83], a[8:11], v[112:115]
ds_read_b64_tr_b16 a[116:117], v20 offset:6144
v_mfma_f32_16x16x32_bf16 v[112:115], a[84:87], a[12:15], v[112:115]
ds_read_b64_tr_b16 a[118:119], v20 offset:6400
v_mfma_f32_16x16x32_bf16 v[96:99], a[84:87], a[4:7], v[96:99]
ds_read_b64_tr_b16 a[72:73], v19 offset:8192
v_mfma_f32_16x16x32_bf16 v[96:99], a[80:83], a[0:3], v[96:99]
s_xor_b32 m0, s84, 34816
ds_read_b64_tr_b16 a[74:75], v19 offset:8448
v_mfma_f32_16x16x32_bf16 v[36:39], a[88:91], a[0:3], v[36:39]
s_xor_b32 s64, s72, 132992
ds_read_b64_tr_b16 a[76:77], v19 offset:10240
v_mfma_f32_16x16x32_bf16 v[36:39], a[92:95], a[4:7], v[36:39]
buffer_load_dwordx4 v12, s[48:51], s64 offen lds
v_mfma_f32_16x16x32_bf16 v[52:55], a[92:95], a[12:15], v[52:55]
ds_read_b64_tr_b16 a[78:79], v19 offset:10496
v_mfma_f32_16x16x32_bf16 v[52:55], a[88:91], a[8:11], v[52:55]
ds_read_b64_tr_b16 a[80:81], v20 offset:8192
v_mfma_f32_16x16x32_bf16 v[68:71], a[88:91], a[16:19], v[68:71]
ds_read_b64_tr_b16 a[82:83], v20 offset:8448
v_mfma_f32_16x16x32_bf16 v[68:71], a[92:95], a[20:23], v[68:71]
s_xor_b32 m0, s84, 35840
ds_read_b64_tr_b16 a[84:85], v20 offset:10240
v_mfma_f32_16x16x32_bf16 v[84:87], a[92:95], a[28:31], v[84:87]
s_xor_b32 s64, s72, 149376
ds_read_b64_tr_b16 a[86:87], v20 offset:10496
v_mfma_f32_16x16x32_bf16 v[84:87], a[88:91], a[24:27], v[84:87]
buffer_load_dwordx4 v13, s[48:51], s64 offen lds
v_mfma_f32_16x16x32_bf16 v[148:151], a[96:99], a[24:27], v[148:151]
ds_read_b64_tr_b16 a[88:89], v19 offset:0
v_mfma_f32_16x16x32_bf16 v[148:151], a[100:103], a[28:31], v[148:151]
ds_read_b64_tr_b16 a[90:91], v19 offset:256
v_mfma_f32_16x16x32_bf16 v[132:135], a[100:103], a[20:23], v[132:135]
ds_read_b64_tr_b16 a[92:93], v19 offset:2048
v_mfma_f32_16x16x32_bf16 v[132:135], a[96:99], a[16:19], v[132:135]
s_xor_b32 m0, s84, 36864
ds_read_b64_tr_b16 a[94:95], v19 offset:2304
v_mfma_f32_16x16x32_bf16 v[116:119], a[96:99], a[8:11], v[116:119]
s_xor_b32 s64, s73, 1920
v_mfma_f32_16x16x32_bf16 v[116:119], a[100:103], a[12:15], v[116:119]
buffer_load_dwordx4 v12, s[48:51], s64 offen lds
v_mfma_f32_16x16x32_bf16 v[100:103], a[100:103], a[4:7], v[100:103]
v_mfma_f32_16x16x32_bf16 v[100:103], a[96:99], a[0:3], v[100:103]
s_waitcnt lgkmcnt(5)
ds_read_b64_tr_b16 a[96:97], v20 offset:0
v_mfma_f32_16x16x32_bf16 v[184:187], a[104:107], a[32:35], v[184:187]
s_xor_b32 m0, s84, 37888
ds_read_b64_tr_b16 a[98:99], v20 offset:256
v_and_b32 v22, 15, v0
v_mfma_f32_16x16x32_bf16 v[184:187], a[108:111], a[36:39], v[184:187]
s_xor_b32 s64, s73, 18304
ds_read_b64_tr_b16 a[100:101], v20 offset:2048
v_lshlrev_b32 v22, 3, v22
v_mfma_f32_16x16x32_bf16 v[192:195], a[108:111], a[44:47], v[192:195]
s_lshl_b32 s85, s30, 7
s_add_u32 s85, s85, 58720256
ds_read_b64_tr_b16 a[102:103], v20 offset:2304
v_mfma_f32_16x16x32_bf16 v[192:195], a[104:107], a[40:43], v[192:195]
s_lshl_b32 s86, s3, 10
s_add_u32 s86, s86, s85
s_lshl_b32 s87, s16, 10
s_lshl_b32 s68, s31, 20
s_add_u32 s32, s28, s68
s_addc_u32 s33, s29, 0
v_mfma_f32_16x16x32_bf16 v[200:203], a[104:107], a[48:51], v[200:203]
s_add_u32 s87, s87, s85
buffer_load_dwordx4 v13, s[48:51], s64 offen lds
v_mfma_f32_16x16x32_bf16 v[200:203], a[108:111], a[52:55], v[200:203]
s_add_u32 s68, s16, 1
s_lshl_b32 s34, s68, 16
v_mfma_f32_16x16x32_bf16 v[208:211], a[108:111], a[60:63], v[208:211]
v_mfma_f32_16x16x32_bf16 v[208:211], a[104:107], a[56:59], v[208:211]
ds_read_b64_tr_b16 a[104:105], v4 offset:0
v_mfma_f32_16x16x32_bf16 v[212:215], a[112:115], a[56:59], v[212:215]
s_xor_b32 m0, s84, 38912
ds_read_b64_tr_b16 a[106:107], v4 offset:1024
v_mfma_f32_16x16x32_bf16 v[212:215], a[116:119], a[60:63], v[212:215]
s_xor_b32 s64, s73, 132992
ds_read_b64_tr_b16 a[108:109], v4 offset:8192
v_mfma_f32_16x16x32_bf16 v[204:207], a[116:119], a[52:55], v[204:207]
buffer_load_dwordx4 v12, s[48:51], s64 offen lds
v_mfma_f32_16x16x32_bf16 v[204:207], a[112:115], a[48:51], v[204:207]
ds_read_b64_tr_b16 a[110:111], v4 offset:9216
v_mfma_f32_16x16x32_bf16 v[196:199], a[112:115], a[40:43], v[196:199]
v_mfma_f32_16x16x32_bf16 v[196:199], a[116:119], a[44:47], v[196:199]
v_mfma_f32_16x16x32_bf16 v[188:191], a[116:119], a[36:39], v[188:191]
s_xor_b32 m0, s84, 39936
v_mfma_f32_16x16x32_bf16 v[188:191], a[112:115], a[32:35], v[188:191]
s_xor_b32 s64, s73, 149376
ds_read_b64_tr_b16 a[112:113], v5 offset:0
v_mfma_f32_16x16x32_bf16 v[216:219], a[32:35], a[72:75], v[216:219]
buffer_load_dwordx4 v13, s[48:51], s64 offen lds
v_mfma_f32_16x16x32_bf16 v[216:219], a[36:39], a[76:79], v[216:219]
ds_read_b64_tr_b16 a[114:115], v5 offset:1024
v_mfma_f32_16x16x32_bf16 v[224:227], a[44:47], a[76:79], v[224:227]
ds_read_b64_tr_b16 a[116:117], v5 offset:8192
v_mfma_f32_16x16x32_bf16 v[224:227], a[40:43], a[72:75], v[224:227]
ds_read_b64_tr_b16 a[118:119], v5 offset:9216
v_mfma_f32_16x16x32_bf16 v[232:235], a[48:51], a[72:75], v[232:235]
s_xor_b32 m0, s77, 131072
v_mfma_f32_16x16x32_bf16 v[232:235], a[52:55], a[76:79], v[232:235]
s_xor_b32 s64, s71, 7864320
v_mfma_f32_16x16x32_bf16 v[240:243], a[60:63], a[76:79], v[240:243]
buffer_load_dwordx4 v14, s[56:59], s64 offen lds
v_mfma_f32_16x16x32_bf16 v[240:243], a[56:59], a[72:75], v[240:243]
ds_read_b64_tr_b16 a[72:73], v6 offset:0
v_mfma_f32_16x16x32_bf16 v[244:247], a[56:59], a[80:83], v[244:247]
s_waitcnt lgkmcnt(5)
ds_read_b64_tr_b16 a[74:75], v6 offset:1024
v_mfma_f32_16x16x32_bf16 v[244:247], a[60:63], a[84:87], v[244:247]
ds_read_b64_tr_b16 a[76:77], v6 offset:8192
v_add_u32 v19, 0x8000, v19
v_mfma_f32_16x16x32_bf16 v[236:239], a[52:55], a[84:87], v[236:239]
s_add_u32 m0, s78, 147456
ds_read_b64_tr_b16 a[78:79], v6 offset:9216
v_mfma_f32_16x16x32_bf16 v[236:239], a[48:51], a[80:83], v[236:239]
s_add_u32 s64, s75, 5898240
v_mfma_f32_16x16x32_bf16 v[228:231], a[40:43], a[80:83], v[228:231]
buffer_load_dwordx4 v23, s[60:63], s64 offen lds
v_mfma_f32_16x16x32_bf16 v[228:231], a[44:47], a[84:87], v[228:231]
v_mfma_f32_16x16x32_bf16 v[220:223], a[36:39], a[84:87], v[220:223]
v_mfma_f32_16x16x32_bf16 v[220:223], a[32:35], a[80:83], v[220:223]
ds_read_b64_tr_b16 a[80:81], v7 offset:0
v_mfma_f32_16x16x32_bf16 v[152:155], a[88:91], a[32:35], v[152:155]
ds_read_b64_tr_b16 a[82:83], v7 offset:1024
v_mfma_f32_16x16x32_bf16 v[152:155], a[92:95], a[36:39], v[152:155]
s_xor_b32 m0, s77, 132096
ds_read_b64_tr_b16 a[84:85], v7 offset:8192
v_add_u32 v20, 0x8000, v20
v_mfma_f32_16x16x32_bf16 v[160:163], a[92:95], a[44:47], v[160:163]
s_xor_b32 s64, s71, 7897088
ds_read_b64_tr_b16 a[86:87], v7 offset:9216
v_mfma_f32_16x16x32_bf16 v[160:163], a[88:91], a[40:43], v[160:163]
buffer_load_dwordx4 v14, s[56:59], s64 offen lds
v_mfma_f32_16x16x32_bf16 v[168:171], a[88:91], a[48:51], v[168:171]
v_mfma_f32_16x16x32_bf16 v[168:171], a[92:95], a[52:55], v[168:171]
v_mfma_f32_16x16x32_bf16 v[176:179], a[92:95], a[60:63], v[176:179]
v_mfma_f32_16x16x32_bf16 v[176:179], a[88:91], a[56:59], v[176:179]
s_add_u32 m0, s78, 151552
ds_read_b64_tr_b16 a[88:89], v8 offset:0
v_mfma_f32_16x16x32_bf16 v[180:183], a[96:99], a[56:59], v[180:183]
s_add_u32 s64, s75, 5900288
ds_read_b64_tr_b16 a[90:91], v8 offset:1024
v_mfma_f32_16x16x32_bf16 v[180:183], a[100:103], a[60:63], v[180:183]
buffer_load_dwordx4 v23, s[60:63], s64 offen lds
v_mfma_f32_16x16x32_bf16 v[172:175], a[100:103], a[52:55], v[172:175]
ds_read_b64_tr_b16 a[92:93], v8 offset:8192
v_add_u32 v4, 0x8000, v4
v_mfma_f32_16x16x32_bf16 v[172:175], a[96:99], a[48:51], v[172:175]
ds_read_b64_tr_b16 a[94:95], v8 offset:9216
v_mfma_f32_16x16x32_bf16 v[164:167], a[96:99], a[40:43], v[164:167]
v_mfma_f32_16x16x32_bf16 v[164:167], a[100:103], a[44:47], v[164:167]
s_xor_b32 m0, s77, 133120
v_mfma_f32_16x16x32_bf16 v[156:159], a[100:103], a[36:39], v[156:159]
s_xor_b32 s64, s71, 7929856
v_mfma_f32_16x16x32_bf16 v[156:159], a[96:99], a[32:35], v[156:159]
buffer_load_dwordx4 v15, s[56:59], s64 offen lds
v_mfma_f32_16x16x32_bf16 v[24:27], a[104:107], a[32:35], v[24:27]
ds_read_b64_tr_b16 a[96:97], v9 offset:0
v_mfma_f32_16x16x32_bf16 v[24:27], a[108:111], a[36:39], v[24:27]
ds_read_b64_tr_b16 a[98:99], v9 offset:1024
v_add_u32 v5, 0x8000, v5
v_mfma_f32_16x16x32_bf16 v[40:43], a[108:111], a[44:47], v[40:43]
ds_read_b64_tr_b16 a[100:101], v9 offset:8192
v_mfma_f32_16x16x32_bf16 v[40:43], a[104:107], a[40:43], v[40:43]
s_add_u32 m0, s78, 155648
ds_read_b64_tr_b16 a[102:103], v9 offset:9216
v_mfma_f32_16x16x32_bf16 v[56:59], a[104:107], a[48:51], v[56:59]
s_add_u32 s64, s75, 5902336
v_mfma_f32_16x16x32_bf16 v[56:59], a[108:111], a[52:55], v[56:59]
buffer_load_dwordx4 v23, s[60:63], s64 offen lds
v_mfma_f32_16x16x32_bf16 v[72:75], a[108:111], a[60:63], v[72:75]
s_waitcnt vmcnt(15)
ds_read_b128 a[0:3], v2 offset:0
v_mfma_f32_16x16x32_bf16 v[72:75], a[104:107], a[56:59], v[72:75]
s_waitcnt lgkmcnt(5)
ds_read_b128 a[4:7], v3 offset:0
v_mfma_f32_16x16x32_bf16 v[136:139], a[112:115], a[56:59], v[136:139]
ds_read_b128 a[8:11], v2 offset:2048
v_mfma_f32_16x16x32_bf16 v[136:139], a[116:119], a[60:63], v[136:139]
s_xor_b32 m0, s77, 134144
ds_read_b128 a[12:15], v3 offset:2048
v_add_u32 v6, 0x8000, v6
v_mfma_f32_16x16x32_bf16 v[120:123], a[116:119], a[52:55], v[120:123]
s_xor_b32 s64, s71, 7962624
ds_read_b128 a[16:19], v2 offset:4096
v_mfma_f32_16x16x32_bf16 v[120:123], a[112:115], a[48:51], v[120:123]
buffer_load_dwordx4 v15, s[56:59], s64 offen lds
v_mfma_f32_16x16x32_bf16 v[104:107], a[112:115], a[40:43], v[104:107]
ds_read_b128 a[20:23], v3 offset:4096
v_mfma_f32_16x16x32_bf16 v[104:107], a[116:119], a[44:47], v[104:107]
ds_read_b128 a[24:27], v2 offset:6144
v_mfma_f32_16x16x32_bf16 v[88:91], a[116:119], a[36:39], v[88:91]
ds_read_b128 a[28:31], v3 offset:6144
v_mfma_f32_16x16x32_bf16 v[88:91], a[112:115], a[32:35], v[88:91]
ds_read_b64_tr_b16 a[104:105], v10 offset:0
v_mfma_f32_16x16x32_bf16 v[28:31], a[72:75], a[32:35], v[28:31]
ds_read_b64_tr_b16 a[106:107], v10 offset:1024
v_mfma_f32_16x16x32_bf16 v[28:31], a[76:79], a[36:39], v[28:31]
ds_read_b64_tr_b16 a[108:109], v10 offset:8192
v_add_u32 v7, 0x8000, v7
v_mfma_f32_16x16x32_bf16 v[44:47], a[76:79], a[44:47], v[44:47]
ds_read_b64_tr_b16 a[110:111], v10 offset:9216
v_mfma_f32_16x16x32_bf16 v[44:47], a[72:75], a[40:43], v[44:47]
ds_read_b64_tr_b16 a[112:113], v11 offset:0
v_mfma_f32_16x16x32_bf16 v[60:63], a[72:75], a[48:51], v[60:63]
ds_read_b64_tr_b16 a[114:115], v11 offset:1024
v_mfma_f32_16x16x32_bf16 v[60:63], a[76:79], a[52:55], v[60:63]
ds_read_b64_tr_b16 a[116:117], v11 offset:8192
v_mfma_f32_16x16x32_bf16 v[76:79], a[76:79], a[60:63], v[76:79]
ds_read_b64_tr_b16 a[118:119], v11 offset:9216
v_mfma_f32_16x16x32_bf16 v[76:79], a[72:75], a[56:59], v[76:79]
v_mfma_f32_16x16x32_bf16 v[140:143], a[80:83], a[56:59], v[140:143]
v_mfma_f32_16x16x32_bf16 v[140:143], a[84:87], a[60:63], v[140:143]
v_add_u32 v8, 0x8000, v8
v_mfma_f32_16x16x32_bf16 v[124:127], a[84:87], a[52:55], v[124:127]
v_lshrrev_b32 v23, 2, v0
v_mul_u32_u24 v23, 3584, v23
v_mfma_f32_16x16x32_bf16 v[124:127], a[80:83], a[48:51], v[124:127]
v_lshl_add_u32 v23, v0, 7, v23
v_mfma_f32_16x16x32_bf16 v[108:111], a[80:83], a[40:43], v[108:111]
v_mfma_f32_16x16x32_bf16 v[108:111], a[84:87], a[44:47], v[108:111]
v_mfma_f32_16x16x32_bf16 v[92:95], a[84:87], a[36:39], v[92:95]
v_add_u32 v9, 0x8000, v9
v_add_u32 v10, 0x8000, v10
v_mfma_f32_16x16x32_bf16 v[92:95], a[80:83], a[32:35], v[92:95]
v_add_u32 v11, 0x8000, v11
v_mfma_f32_16x16x32_bf16 v[32:35], a[88:91], a[32:35], v[32:35]
s_waitcnt vmcnt(15)
v_readfirstlane_b32 vcc_lo, v1
s_nop 0
s_cmp_lt_u32 vcc_lo, s81
s_cbranch_scc1 L_spin_4
L_spinbk_5:
v_mfma_f32_16x16x32_bf16 v[32:35], a[92:95], a[36:39], v[32:35]
buffer_load_dwordx2 a[64:65], v22, s[44:47], s86 offen offset:0 sc1
v_mfma_f32_16x16x32_bf16 v[48:51], a[92:95], a[44:47], v[48:51]
s_waitcnt lgkmcnt(0)
s_barrier
v_mfma_f32_16x16x32_bf16 v[48:51], a[88:91], a[40:43], v[48:51]
ds_read_b64_tr_b16 a[72:73], v19 offset:4096
v_cmp_gt_i32 s[0:1], 0, v18
v_mfma_f32_16x16x32_bf16 v[64:67], a[88:91], a[48:51], v[64:67]
s_lshl2_add_u32 s72, s2, s30
ds_read_b64_tr_b16 a[74:75], v19 offset:4352
v_cmp_gt_i32 s[4:5], 1, v18
v_mfma_f32_16x16x32_bf16 v[64:67], a[92:95], a[52:55], v[64:67]
s_lshl_b32 s72, s72, 12
s_mov_b32 m0, s76
ds_read_b64_tr_b16 a[76:77], v19 offset:6144
v_cmp_gt_i32 s[6:7], 2, v18
v_mfma_f32_16x16x32_bf16 v[80:83], a[92:95], a[60:63], v[80:83]
s_add_u32 s72, s72, 67108864
s_lshl_b32 s64, s30, 14
ds_read_b64_tr_b16 a[78:79], v19 offset:6400
v_cmp_gt_i32 s[8:9], 3, v18
v_mfma_f32_16x16x32_bf16 v[80:83], a[88:91], a[56:59], v[80:83]
s_lshr_b32 s17, s78, 1
buffer_load_dwordx4 v16, s[32:35], s64 offen offset:0 sc1 lds
v_mfma_f32_16x16x32_bf16 v[144:147], a[96:99], a[56:59], v[144:147]
s_add_u32 s17, s17, L_base-L_pc-4+53248
buffer_load_dwordx2 a[66:67], v22, s[44:47], s86 offen offset:512 sc1
v_mfma_f32_16x16x32_bf16 v[144:147], a[100:103], a[60:63], v[144:147]
buffer_load_dword a252, v23, s[88:91], s17 offen
v_mfma_f32_16x16x32_bf16 v[128:131], a[100:103], a[52:55], v[128:131]
buffer_load_dwordx2 a[68:69], v22, s[44:47], s87 offen offset:0 sc1
v_mfma_f32_16x16x32_bf16 v[128:131], a[96:99], a[48:51], v[128:131]
buffer_load_dwordx2 a[70:71], v22, s[44:47], s87 offen offset:512 sc1
v_mfma_f32_16x16x32_bf16 v[112:115], a[96:99], a[40:43], v[112:115]
ds_read_b64_tr_b16 a[80:81], v20 offset:4096
v_cmp_gt_i32 s[10:11], 16, v18
v_mfma_f32_16x16x32_bf16 v[112:115], a[100:103], a[44:47], v[112:115]
ds_read_b64_tr_b16 a[82:83], v20 offset:4352
v_cmp_gt_i32 s[12:13], 17, v18
v_mfma_f32_16x16x32_bf16 v[96:99], a[100:103], a[36:39], v[96:99]
ds_read_b64_tr_b16 a[84:85], v20 offset:6144
v_cmp_gt_i32 s[18:19], 18, v18
v_mfma_f32_16x16x32_bf16 v[96:99], a[96:99], a[32:35], v[96:99]
buffer_load_dwordx4 v16, s[32:35], s64 offen offset:1024 sc1 lds
v_mfma_f32_16x16x32_bf16 v[36:39], a[104:107], a[32:35], v[36:39]
buffer_store_dwordx4 a[240:243], v16, s[44:47], s72 offen offset:0 sc1
v_mfma_f32_16x16x32_bf16 v[36:39], a[108:111], a[36:39], v[36:39]
ds_read_b64_tr_b16 a[86:87], v20 offset:6400
v_cmp_gt_i32 s[22:23], 19, v18
v_mfma_f32_16x16x32_bf16 v[52:55], a[108:111], a[44:47], v[52:55]
ds_read_b64_tr_b16 a[88:89], v19 offset:8192
v_cmp_gt_i32 s[26:27], 32, v18
v_mfma_f32_16x16x32_bf16 v[52:55], a[104:107], a[40:43], v[52:55]
ds_read_b64_tr_b16 a[90:91], v19 offset:8448
v_cmp_gt_i32 s[56:57], 33, v18
v_mfma_f32_16x16x32_bf16 v[68:71], a[104:107], a[48:51], v[68:71]
ds_read_b64_tr_b16 a[92:93], v19 offset:10240
v_cmp_gt_i32 s[58:59], 34, v18
v_mfma_f32_16x16x32_bf16 v[68:71], a[108:111], a[52:55], v[68:71]
ds_read_b64_tr_b16 a[94:95], v19 offset:10496
v_cmp_gt_i32 s[60:61], 35, v18
v_mfma_f32_16x16x32_bf16 v[84:87], a[108:111], a[60:63], v[84:87]
ds_read_b64_tr_b16 a[96:97], v20 offset:8192
v_cmp_gt_i32 s[62:63], 48, v18
v_mfma_f32_16x16x32_bf16 v[84:87], a[104:107], a[56:59], v[84:87]
buffer_load_dwordx4 v16, s[32:35], s64 offen offset:2048 sc1 lds
v_mfma_f32_16x16x32_bf16 v[148:151], a[112:115], a[56:59], v[148:151]
ds_read_b64_tr_b16 a[98:99], v20 offset:8448
v_cmp_gt_i32 s[48:49], 49, v18
v_mfma_f32_16x16x32_bf16 v[148:151], a[116:119], a[60:63], v[148:151]
ds_read_b64_tr_b16 a[100:101], v20 offset:10240
v_cmp_gt_i32 s[50:51], 50, v18
v_mfma_f32_16x16x32_bf16 v[132:135], a[116:119], a[52:55], v[132:135]
ds_read_b64_tr_b16 a[102:103], v20 offset:10496
v_cmp_gt_i32 s[100:101], 51, v18
v_mfma_f32_16x16x32_bf16 v[132:135], a[112:115], a[48:51], v[132:135]
ds_read_b64_tr_b16 a[104:105], v19 offset:0
v_mfma_f32_16x16x32_bf16 v[116:119], a[112:115], a[40:43], v[116:119]
ds_read_b64_tr_b16 a[106:107], v19 offset:256
v_mfma_f32_16x16x32_bf16 v[116:119], a[116:119], a[44:47], v[116:119]
ds_read_b64_tr_b16 a[108:109], v19 offset:2048
v_mfma_f32_16x16x32_bf16 v[100:103], a[116:119], a[36:39], v[100:103]
buffer_store_dwordx4 a[240:243], v16, s[44:47], s72 offen offset:1024 sc1
v_mfma_f32_16x16x32_bf16 v[100:103], a[112:115], a[32:35], v[100:103]
s_waitcnt lgkmcnt(7)
buffer_load_dwordx4 v16, s[32:35], s64 offen offset:3072 sc1 lds
v_mfma_f32_16x16x32_bf16 v[184:187], a[72:75], a[0:3], v[184:187]
s_waitcnt vmcnt(18)
s_and_b32 s66, s2, 7
ds_read_b128 a[32:35], v2 offset:32768
v_mfma_f32_16x16x32_bf16 v[184:187], a[76:79], a[4:7], v[184:187]
s_lshr_b32 s67, s2, 3
s_and_b32 s83, s66, 1
ds_read_b128 a[36:39], v3 offset:32768
v_mfma_f32_16x16x32_bf16 v[192:195], a[76:79], a[12:15], v[192:195]
s_and_b32 s68, s66, 2
s_and_b32 s69, s67, 7
ds_read_b128 a[40:43], v2 offset:34816
v_mfma_f32_16x16x32_bf16 v[192:195], a[72:75], a[8:11], v[192:195]
s_lshl2_add_u32 s82, s68, s69
s_and_b32 s68, s66, 4
ds_read_b128 a[44:47], v3 offset:34816
v_mfma_f32_16x16x32_bf16 v[200:203], a[72:75], a[16:19], v[200:203]
s_lshr_b32 s69, s67, 3
s_xor_b32 s69, s69, 0
ds_read_b128 a[48:51], v2 offset:36864
v_mfma_f32_16x16x32_bf16 v[200:203], a[76:79], a[20:23], v[200:203]
s_add_u32 s87, s68, s69
s_lshl_b32 s87, s87, 8
s_add_u32 m0, s76, 4096
ds_read_b128 a[52:55], v3 offset:36864
v_mfma_f32_16x16x32_bf16 v[208:211], a[76:79], a[28:31], v[208:211]
s_lshl_b32 s86, s30, 13
s_lshl_b32 s85, s30, 16
s_add_u32 s64, s64, 4096
ds_read_b128 a[56:59], v2 offset:38912
v_mfma_f32_16x16x32_bf16 v[208:211], a[72:75], a[24:27], v[208:211]
s_add_u32 s85, s85, s87
buffer_load_dwordx4 v16, s[32:35], s64 offen offset:0 sc1 lds
v_mfma_f32_16x16x32_bf16 v[212:215], a[80:83], a[24:27], v[212:215]
s_mul_i32 s66, s83, 1310720
s_add_u32 s85, s85, s66
ds_read_b128 a[60:63], v3 offset:38912
v_mfma_f32_16x16x32_bf16 v[212:215], a[84:87], a[28:31], v[212:215]
s_mul_i32 s84, s82, 1310720
s_and_b32 s66, s30, 1
ds_read_b64_tr_b16 a[110:111], v19 offset:2304
v_mfma_f32_16x16x32_bf16 v[204:207], a[84:87], a[20:23], v[204:207]
s_lshl_b32 s66, s66, 14
s_add_u32 s84, s84, s66
ds_read_b64_tr_b16 a[112:113], v20 offset:0
v_mfma_f32_16x16x32_bf16 v[204:207], a[80:83], a[16:19], v[204:207]
s_mul_i32 s66, s83, 163840
s_add_u32 s84, s84, s66
ds_read_b64_tr_b16 a[114:115], v20 offset:256
v_mfma_f32_16x16x32_bf16 v[196:199], a[80:83], a[8:11], v[196:199]
s_add_u32 s84, s84, 34603008
s_sub_u32 s66, 15, s82
ds_read_b64_tr_b16 a[116:117], v20 offset:2048
v_mfma_f32_16x16x32_bf16 v[196:199], a[84:87], a[12:15], v[196:199]
s_min_u32 s66, s66, s82
s_lshl1_add_u32 s66, s66, s83
ds_read_b64_tr_b16 a[118:119], v20 offset:2304
v_mfma_f32_16x16x32_bf16 v[188:191], a[84:87], a[4:7], v[188:191]
s_lshl_b32 s80, s66, 8
buffer_store_dwordx4 a[240:243], v16, s[44:47], s72 offen offset:2048 sc1
v_mfma_f32_16x16x32_bf16 v[188:191], a[80:83], a[0:3], v[188:191]
s_add_u32 s80, s80, 8192
buffer_load_dwordx4 v16, s[32:35], s64 offen offset:1024 sc1 lds
v_mfma_f32_16x16x32_bf16 v[216:219], a[0:3], a[88:91], v[216:219]
s_and_b32 s67, s30, 1
s_lshl_b32 s67, s67, 7
s_add_u32 s67, s67, s83
v_mfma_f32_16x16x32_bf16 v[216:219], a[4:7], a[92:95], v[216:219]
s_lshl_b32 s67, s67, 7
s_add_u32 s67, s67, 98304
s_lshl_b32 s66, s30, 11
v_mfma_f32_16x16x32_bf16 v[224:227], a[12:15], a[92:95], v[224:227]
s_waitcnt vmcnt(14) lgkmcnt(0)
s_barrier
v_mfma_f32_16x16x32_bf16 v[224:227], a[8:11], a[88:91], v[224:227]
ds_read_b64_tr_b16 a[72:73], v19 offset:36864
v_lshrrev_b32 v14, 4, v0
v_mfma_f32_16x16x32_bf16 v[232:235], a[16:19], a[88:91], v[232:235]
ds_read_b64_tr_b16 a[74:75], v19 offset:37120
v_bfe_u32 v12, v0, 1, 3
v_mfma_f32_16x16x32_bf16 v[232:235], a[20:23], a[92:95], v[232:235]
ds_read_b64_tr_b16 a[76:77], v19 offset:38912
v_xor_b32 v12, v12, v14
v_mfma_f32_16x16x32_bf16 v[240:243], a[28:31], a[92:95], v[240:243]
ds_read_b64_tr_b16 a[78:79], v19 offset:39168
v_lshlrev_b32 v12, 5, v12
v_mfma_f32_16x16x32_bf16 v[240:243], a[24:27], a[88:91], v[240:243]
buffer_load_dwordx4 v16, s[32:35], s64 offen offset:2048 sc1 lds
v_mfma_f32_16x16x32_bf16 v[244:247], a[24:27], a[96:99], v[244:247]
ds_read_b64_tr_b16 a[80:81], v20 offset:36864
v_lshl_add_u32 v12, v14, 11, v12
v_mfma_f32_16x16x32_bf16 v[244:247], a[28:31], a[100:103], v[244:247]
ds_read_b64_tr_b16 a[82:83], v20 offset:37120
v_and_b32 v14, 1, v0
v_mfma_f32_16x16x32_bf16 v[236:239], a[20:23], a[100:103], v[236:239]
buffer_store_dwordx4 a[240:243], v16, s[44:47], s72 offen offset:3072 sc1
v_mfma_f32_16x16x32_bf16 v[236:239], a[16:19], a[96:99], v[236:239]
ds_read_b64_tr_b16 a[84:85], v20 offset:38912
v_lshl_add_u32 v12, v14, 4, v12
v_mfma_f32_16x16x32_bf16 v[228:231], a[8:11], a[96:99], v[228:231]
ds_read_b64_tr_b16 a[86:87], v20 offset:39168
v_xor_b32 v13, 128, v12
v_mfma_f32_16x16x32_bf16 v[228:231], a[12:15], a[100:103], v[228:231]
ds_read_b64_tr_b16 a[88:89], v19 offset:40960
v_lshrrev_b32 v14, 4, v0
v_mfma_f32_16x16x32_bf16 v[220:223], a[4:7], a[100:103], v[220:223]
ds_read_b64_tr_b16 a[90:91], v19 offset:41216
v_bfe_u32 v18, v0, 2, 2
v_mfma_f32_16x16x32_bf16 v[220:223], a[0:3], a[96:99], v[220:223]
buffer_load_dwordx4 v16, s[32:35], s64 offen offset:3072 sc1 lds
v_mfma_f32_16x16x32_bf16 v[152:155], a[104:107], a[0:3], v[152:155]
ds_read_b64_tr_b16 a[92:93], v19 offset:43008
v_lshl_add_u32 v14, v14, 2, v18
v_mfma_f32_16x16x32_bf16 v[152:155], a[108:111], a[4:7], v[152:155]
ds_read_b64_tr_b16 a[94:95], v19 offset:43264
v_and_b32 v18, 3, v0
v_mfma_f32_16x16x32_bf16 v[160:163], a[108:111], a[12:15], v[160:163]
s_branch L_po13
L_pg13:
s_branch L_tr1
L_po13:
s_lshr_b32 s64, s76, 1
ds_read_b64_tr_b16 a[96:97], v20 offset:40960
v_lshlrev_b32 v18, 3, v18
v_mfma_f32_16x16x32_bf16 v[160:163], a[104:107], a[8:11], v[160:163]
s_add_u32 m0, s64, 81920
ds_read_b64_tr_b16 a[98:99], v20 offset:41216
v_lshl_add_u32 v18, v14, 8, v18
v_mfma_f32_16x16x32_bf16 v[168:171], a[104:107], a[16:19], v[168:171]
s_and_b32 s71, s64, 8192
ds_read_b64_tr_b16 a[100:101], v20 offset:43008
v_and_b32 v14, 7, v14
v_mfma_f32_16x16x32_bf16 v[168:171], a[108:111], a[20:23], v[168:171]
s_add_u32 s64, s64, s71
ds_read_b64_tr_b16 a[102:103], v20 offset:43264
v_lshl_add_u32 v18, v14, 5, v18
v_mfma_f32_16x16x32_bf16 v[176:179], a[108:111], a[28:31], v[176:179]
s_add_u32 s64, s64, 8192
v_xor_b32 v18, s67, v18
v_add_u32 v14, s66, v16
v_mfma_f32_16x16x32_bf16 v[176:179], a[104:107], a[24:27], v[176:179]
buffer_load_dwordx4 v16, s[32:35], s64 offen offset:0 sc1 lds
v_mfma_f32_16x16x32_bf16 v[180:183], a[112:115], a[24:27], v[180:183]
s_cmp_eq_u32 s30, 0
s_cbranch_scc1 L_pg14
s_cmp_eq_u32 s30, 1
s_cbranch_scc1 L_pg15
s_cmp_eq_u32 s30, 2
s_cbranch_scc1 L_pg16
s_branch L_pg17
L_tr2:
s_cmp_lg_u32 s3, 0
s_cbranch_scc1 L_tr3
s_cmp_eq_u32 s30, 0
s_cbranch_scc1 L_pg18
s_cmp_eq_u32 s30, 1
s_cbranch_scc1 L_pg26
s_cmp_eq_u32 s30, 2
s_cbranch_scc1 L_pg27
s_branch L_tr3
L_tr3:
s_cmp_lg_u32 s3, 7
s_cbranch_scc1 L_tr4
s_cmp_eq_u32 s30, 0
s_cbranch_scc1 L_pg21
s_cmp_eq_u32 s30, 1
s_cbranch_scc1 L_pg28
s_cmp_eq_u32 s30, 2
s_cbranch_scc1 L_pg29
s_branch L_tr4
L_tr4:
v_mfma_f32_16x16x32_bf16 v[180:183], a[116:119], a[28:31], v[180:183]
ds_read_b64_tr_b16 a[104:105], v19 offset:32768
v_xor_b32 v15, 0x800, v14
v_mfma_f32_16x16x32_bf16 v[172:175], a[116:119], a[20:23], v[172:175]
s_lshl2_add_u32 s73, s2, s30
s_lshl_b32 s73, s73, 11
s_lshl1_add_u32 s66, s78, 32768
v_mfma_f32_16x16x32_bf16 v[172:175], a[112:115], a[16:19], v[172:175]
ds_read_b64_tr_b16 a[106:107], v19 offset:33024
v_add_u32 v2, s66, v16
v_mfma_f32_16x16x32_bf16 v[164:167], a[112:115], a[8:11], v[164:167]
ds_read_b64_tr_b16 a[108:109], v19 offset:34816
v_bfe_u32 v1, v0, 1, 1
v_mfma_f32_16x16x32_bf16 v[164:167], a[116:119], a[12:15], v[164:167]
ds_read_b64_tr_b16 a[110:111], v19 offset:35072
v_subrev_u32 v1, 1, v1
v_mfma_f32_16x16x32_bf16 v[156:159], a[116:119], a[4:7], v[156:159]
s_or_b32 s66, s3, s30
s_cmp_eq_u32 s66, 0
s_cselect_b32 s66, 0xff800000, 0
v_mfma_f32_16x16x32_bf16 v[156:159], a[112:115], a[0:3], v[156:159]
s_waitcnt lgkmcnt(4)
buffer_load_dwordx4 v16, s[32:35], s64 offen offset:1024 sc1 lds
v_mfma_f32_16x16x32_bf16 v[184:187], a[72:75], a[32:35], v[184:187]
ds_read_b64_tr_b16 a[112:113], v20 offset:32768
v_and_b32 v1, 0x3f803f80, v1
v_mfma_f32_16x16x32_bf16 v[184:187], a[76:79], a[36:39], v[184:187]
ds_read_b64_tr_b16 a[114:115], v20 offset:33024
v_accvgpr_write_b32 a240, v1
v_mfma_f32_16x16x32_bf16 v[192:195], a[76:79], a[44:47], v[192:195]
ds_read_b64_tr_b16 a[116:117], v20 offset:34816
v_accvgpr_write_b32 a241, v1
v_mfma_f32_16x16x32_bf16 v[192:195], a[72:75], a[40:43], v[192:195]
ds_read_b64_tr_b16 a[118:119], v20 offset:35072
v_accvgpr_write_b32 a242, v1
v_mfma_f32_16x16x32_bf16 v[200:203], a[72:75], a[48:51], v[200:203]
s_and_b32 s67, s74, 0x7800
s_cselect_b32 s67, 0, 0x70000000
s_add_u32 s77, s74, s67
v_mfma_f32_16x16x32_bf16 v[200:203], a[76:79], a[52:55], v[200:203]
s_sub_u32 s77, s77, 2048
v_accvgpr_write_b32 a243, v1
v_mfma_f32_16x16x32_bf16 v[208:211], a[76:79], a[60:63], v[208:211]
s_mov_b32 s68, 0x3e0293ee
v_mfma_f32_16x16x32_bf16 v[208:211], a[72:75], a[56:59], v[208:211]
s_mov_b32 s69, s68
buffer_load_dwordx4 v16, s[32:35], s64 offen offset:2048 sc1 lds
v_mfma_f32_16x16x32_bf16 v[212:215], a[80:83], a[56:59], v[212:215]
ds_read_b64_tr_b16 a[72:73], v4 offset:0
v_mfma_f32_16x16x32_bf16 v[212:215], a[84:87], a[60:63], v[212:215]
ds_read_b64_tr_b16 a[74:75], v4 offset:1024
v_mfma_f32_16x16x32_bf16 v[204:207], a[84:87], a[52:55], v[204:207]
ds_read_b64_tr_b16 a[76:77], v4 offset:8192
v_mfma_f32_16x16x32_bf16 v[204:207], a[80:83], a[48:51], v[204:207]
ds_read_b64_tr_b16 a[78:79], v4 offset:9216
v_mfma_f32_16x16x32_bf16 v[196:199], a[80:83], a[40:43], v[196:199]
v_mfma_f32_16x16x32_bf16 v[196:199], a[84:87], a[44:47], v[196:199]
v_mfma_f32_16x16x32_bf16 v[188:191], a[84:87], a[36:39], v[188:191]
v_mfma_f32_16x16x32_bf16 v[188:191], a[80:83], a[32:35], v[188:191]
buffer_load_dwordx4 v16, s[32:35], s64 offen offset:3072 sc1 lds
v_mfma_f32_16x16x32_bf16 v[216:219], a[32:35], a[88:91], v[216:219]
ds_read_b64_tr_b16 a[80:81], v4 offset:32768
v_mfma_f32_16x16x32_bf16 v[216:219], a[36:39], a[92:95], v[216:219]
ds_read_b64_tr_b16 a[82:83], v4 offset:33792
v_cvt_pk_bf16_f32 v208, v208, v209
v_mfma_f32_16x16x32_bf16 v[224:227], a[44:47], a[92:95], v[224:227]
ds_read_b64_tr_b16 a[84:85], v4 offset:40960
v_cvt_pk_bf16_f32 v209, v210, v211
v_mfma_f32_16x16x32_bf16 v[224:227], a[40:43], a[88:91], v[224:227]
ds_read_b64_tr_b16 a[86:87], v4 offset:41984
v_cvt_pk_bf16_f32 v210, v212, v213
v_mfma_f32_16x16x32_bf16 v[232:235], a[48:51], a[88:91], v[232:235]
v_cvt_pk_bf16_f32 v211, v214, v215
v_mfma_f32_16x16x32_bf16 v[232:235], a[52:55], a[92:95], v[232:235]
ds_write_b128 v2, v[208:211] offset:30720
v_mfma_f32_16x16x32_bf16 v[240:243], a[60:63], a[92:95], v[240:243]
v_cvt_pk_bf16_f32 v200, v200, v201
v_cvt_pk_bf16_f32 v201, v202, v203
v_mfma_f32_16x16x32_bf16 v[240:243], a[56:59], a[88:91], v[240:243]
ds_read_b64_tr_b16 a[88:89], v5 offset:0
v_cvt_pk_bf16_f32 v202, v204, v205
v_mfma_f32_16x16x32_bf16 v[244:247], a[56:59], a[96:99], v[244:247]
ds_read_b64_tr_b16 a[90:91], v5 offset:1024
v_cvt_pk_bf16_f32 v203, v206, v207
v_mfma_f32_16x16x32_bf16 v[244:247], a[60:63], a[100:103], v[244:247]
ds_write_b128 v2, v[200:203] offset:22528
v_mfma_f32_16x16x32_bf16 v[236:239], a[52:55], a[100:103], v[236:239]
ds_read_b64_tr_b16 a[92:93], v5 offset:8192
v_cvt_pk_bf16_f32 v192, v192, v193
v_mfma_f32_16x16x32_bf16 v[236:239], a[48:51], a[96:99], v[236:239]
ds_read_b64_tr_b16 a[94:95], v5 offset:9216
v_cvt_pk_bf16_f32 v193, v194, v195
v_mfma_f32_16x16x32_bf16 v[228:231], a[40:43], a[96:99], v[228:231]
v_cvt_pk_bf16_f32 v194, v196, v197
v_cvt_pk_bf16_f32 v195, v198, v199
v_mfma_f32_16x16x32_bf16 v[228:231], a[44:47], a[100:103], v[228:231]
ds_write_b128 v2, v[192:195] offset:10240
v_mfma_f32_16x16x32_bf16 v[220:223], a[36:39], a[100:103], v[220:223]
v_cvt_pk_bf16_f32 v184, v184, v185
v_cvt_pk_bf16_f32 v185, v186, v187
v_mfma_f32_16x16x32_bf16 v[220:223], a[32:35], a[96:99], v[220:223]
s_waitcnt lgkmcnt(6)
ds_read_b64_tr_b16 a[96:97], v5 offset:32768
v_cvt_pk_bf16_f32 v186, v188, v189
v_mfma_f32_16x16x32_bf16 v[152:155], a[104:107], a[32:35], v[152:155]
ds_read_b64_tr_b16 a[98:99], v5 offset:33792
v_cvt_pk_bf16_f32 v187, v190, v191
v_mfma_f32_16x16x32_bf16 v[152:155], a[108:111], a[36:39], v[152:155]
ds_write_b128 v2, v[184:187] offset:2048
v_mfma_f32_16x16x32_bf16 v[160:163], a[108:111], a[44:47], v[160:163]
buffer_load_dword a252, v21, s[36:39], s73 offen
v_mfma_f32_16x16x32_bf16 v[160:163], a[104:107], a[40:43], v[160:163]
ds_read_b64_tr_b16 a[100:101], v5 offset:40960
v_cvt_pk_bf16_f32 v243, v242, v243
v_mfma_f32_16x16x32_bf16 v[168:171], a[104:107], a[48:51], v[168:171]
ds_read_b64_tr_b16 a[102:103], v5 offset:41984
v_cvt_pk_bf16_f32 v242, v240, v241
v_mfma_f32_16x16x32_bf16 v[168:171], a[108:111], a[52:55], v[168:171]
v_cvt_pk_bf16_f32 v240, v244, v245
v_cvt_pk_bf16_f32 v241, v246, v247
v_mfma_f32_16x16x32_bf16 v[176:179], a[108:111], a[60:63], v[176:179]
ds_write_b128 v2, v[240:243] offset:31744
v_mfma_f32_16x16x32_bf16 v[176:179], a[104:107], a[56:59], v[176:179]
ds_read_b64_tr_b16 a[104:105], v6 offset:0
v_mov_b32 v246, v240
v_mfma_f32_16x16x32_bf16 v[180:183], a[112:115], a[56:59], v[180:183]
ds_read_b64_tr_b16 a[106:107], v6 offset:1024
v_mov_b32 v247, v241
v_mfma_f32_16x16x32_bf16 v[180:183], a[116:119], a[60:63], v[180:183]
ds_read_b64_tr_b16 a[108:109], v6 offset:8192
v_cvt_pk_bf16_f32 v235, v234, v235
v_mfma_f32_16x16x32_bf16 v[172:175], a[116:119], a[52:55], v[172:175]
ds_read_b64_tr_b16 a[110:111], v6 offset:9216
v_cvt_pk_bf16_f32 v234, v232, v233
v_mfma_f32_16x16x32_bf16 v[172:175], a[112:115], a[48:51], v[172:175]
v_cvt_pk_bf16_f32 v232, v236, v237
v_cvt_pk_bf16_f32 v233, v238, v239
v_mfma_f32_16x16x32_bf16 v[164:167], a[112:115], a[40:43], v[164:167]
ds_write_b128 v2, v[232:235] offset:23552
v_mfma_f32_16x16x32_bf16 v[164:167], a[116:119], a[44:47], v[164:167]
v_mov_b32 v238, v232
v_mov_b32 v239, v233
v_mfma_f32_16x16x32_bf16 v[156:159], a[116:119], a[36:39], v[156:159]
v_cvt_pk_bf16_f32 v227, v226, v227
v_cvt_pk_bf16_f32 v226, v224, v225
v_mfma_f32_16x16x32_bf16 v[156:159], a[112:115], a[32:35], v[156:159]
ds_read_b64_tr_b16 a[112:113], v6 offset:32768
v_cvt_pk_bf16_f32 v224, v228, v229
v_mfma_f32_16x16x32_bf16 v[24:27], a[72:75], a[0:3], v[24:27]
ds_read_b64_tr_b16 a[114:115], v6 offset:33792
v_cvt_pk_bf16_f32 v225, v230, v231
v_mfma_f32_16x16x32_bf16 v[24:27], a[76:79], a[4:7], v[24:27]
ds_write_b128 v2, v[224:227] offset:11264
v_mfma_f32_16x16x32_bf16 v[24:27], a[80:83], a[32:35], v[24:27]
ds_read_b64_tr_b16 a[116:117], v6 offset:40960
v_mov_b32 v230, v224
v_mfma_f32_16x16x32_bf16 v[24:27], a[84:87], a[36:39], v[24:27]
ds_read_b64_tr_b16 a[118:119], v6 offset:41984
v_mov_b32 v231, v225
v_mfma_f32_16x16x32_bf16 v[40:43], a[84:87], a[44:47], v[40:43]
v_cvt_pk_bf16_f32 v219, v218, v219
v_cvt_pk_bf16_f32 v218, v216, v217
v_mfma_f32_16x16x32_bf16 v[40:43], a[80:83], a[40:43], v[40:43]
v_cvt_pk_bf16_f32 v216, v220, v221
v_cvt_pk_bf16_f32 v217, v222, v223
v_mfma_f32_16x16x32_bf16 v[40:43], a[76:79], a[12:15], v[40:43]
ds_write_b128 v2, v[216:219] offset:3072
v_mfma_f32_16x16x32_bf16 v[40:43], a[72:75], a[8:11], v[40:43]
v_mov_b32 v222, v216
v_mov_b32 v223, v217
v_mfma_f32_16x16x32_bf16 v[56:59], a[72:75], a[16:19], v[56:59]
v_mfma_f32_16x16x32_bf16 v[56:59], a[76:79], a[20:23], v[56:59]
s_waitcnt lgkmcnt(0)
s_barrier
v_mfma_f32_16x16x32_bf16 v[56:59], a[80:83], a[48:51], v[56:59]
ds_read_b128 a[192:195], v17 offset:16384
v_cvt_pk_bf16_f32 v176, v176, v177
v_mfma_f32_16x16x32_bf16 v[56:59], a[84:87], a[52:55], v[56:59]
v_cvt_pk_bf16_f32 v177, v178, v179
v_cvt_pk_bf16_f32 v178, v180, v181
v_mfma_f32_16x16x32_bf16 v[72:75], a[84:87], a[60:63], v[72:75]
v_cvt_pk_bf16_f32 v179, v182, v183
v_cvt_pk_bf16_f32 v168, v168, v169
v_mfma_f32_16x16x32_bf16 v[72:75], a[80:83], a[56:59], v[72:75]
v_cvt_pk_bf16_f32 v169, v170, v171
v_cvt_pk_bf16_f32 v170, v172, v173
v_mfma_f32_16x16x32_bf16 v[72:75], a[76:79], a[28:31], v[72:75]
v_cvt_pk_bf16_f32 v171, v174, v175
v_cvt_pk_bf16_f32 v160, v160, v161
v_mfma_f32_16x16x32_bf16 v[72:75], a[72:75], a[24:27], v[72:75]
ds_read_b64_tr_b16 a[72:73], v7 offset:0
v_cvt_pk_bf16_f32 v161, v162, v163
v_mfma_f32_16x16x32_bf16 v[136:139], a[88:91], a[24:27], v[136:139]
s_waitcnt lgkmcnt(1)
buffer_store_dwordx4 a[192:195], v16, s[44:47], s74 offen sc1
v_mfma_f32_16x16x32_bf16 v[136:139], a[92:95], a[28:31], v[136:139]
ds_read_b64_tr_b16 a[74:75], v7 offset:1024
v_cvt_pk_bf16_f32 v162, v164, v165
v_mfma_f32_16x16x32_bf16 v[136:139], a[96:99], a[56:59], v[136:139]
ds_read_b64_tr_b16 a[76:77], v7 offset:8192
v_cvt_pk_bf16_f32 v163, v166, v167
v_mfma_f32_16x16x32_bf16 v[136:139], a[100:103], a[60:63], v[136:139]
s_sub_u32 s81, s3, 1
ds_read_b64_tr_b16 a[78:79], v7 offset:9216
v_cvt_pk_bf16_f32 v152, v152, v153
v_mfma_f32_16x16x32_bf16 v[120:123], a[100:103], a[52:55], v[120:123]
s_sub_u32 s67, s3, 2
ds_read_b64_tr_b16 a[80:81], v7 offset:32768
v_cvt_pk_bf16_f32 v153, v154, v155
v_mfma_f32_16x16x32_bf16 v[120:123], a[96:99], a[48:51], v[120:123]
s_mul_i32 s81, s81, s67
ds_read_b64_tr_b16 a[82:83], v7 offset:33792
v_cvt_pk_bf16_f32 v154, v156, v157
v_mfma_f32_16x16x32_bf16 v[120:123], a[92:95], a[20:23], v[120:123]
s_lshl4_add_u32 s81, s81, s31
ds_read_b64_tr_b16 a[84:85], v7 offset:40960
v_cvt_pk_bf16_f32 v155, v158, v159
v_mfma_f32_16x16x32_bf16 v[120:123], a[88:91], a[16:19], v[120:123]
s_lshl2_add_u32 s81, s81, s30
ds_read_b64_tr_b16 a[86:87], v7 offset:41984
v_or_b32 v20, s66, v252
v_mfma_f32_16x16x32_bf16 v[104:107], a[88:91], a[8:11], v[104:107]
s_mul_i32 s81, s81, 3328
ds_read_b128 a[180:183], v2 offset:8192
v_or_b32 v21, s66, v253
v_mfma_f32_16x16x32_bf16 v[104:107], a[92:95], a[12:15], v[104:107]
s_mov_b32 s73, 0
ds_read_b128 a[188:191], v2 offset:28672
v_or_b32 v22, s66, v254
v_mfma_f32_16x16x32_bf16 v[104:107], a[96:99], a[40:43], v[104:107]
s_mov_b32 s72, 0x20000
ds_read_b64 v[224:225], v2 offset:9224
v_or_b32 v23, s66, v255
v_mfma_f32_16x16x32_bf16 v[104:107], a[100:103], a[44:47], v[104:107]
s_mov_b32 s66, 0x3e8293ee
ds_read_b64 v[228:229], v2 offset:9216
v_mul_f32 v72, s68, v72
v_mfma_f32_16x16x32_bf16 v[88:91], a[100:103], a[36:39], v[88:91]
s_lshl_b32 s67, s31, 15
ds_read_b64 v[240:241], v2 offset:29704
v_mul_f32 v73, s68, v73
v_mfma_f32_16x16x32_bf16 v[88:91], a[96:99], a[32:35], v[88:91]
s_add_u32 s67, s67, s78
ds_read_b64 v[244:245], v2 offset:29696
v_mul_f32 v74, s68, v74
v_mfma_f32_16x16x32_bf16 v[88:91], a[92:95], a[4:7], v[88:91]
s_add_u32 s67, s67, 33554432
v_mul_f32 v75, s68, v75
v_mul_f32 v136, s68, v136
v_mfma_f32_16x16x32_bf16 v[88:91], a[88:91], a[0:3], v[88:91]
s_mul_i32 s74, s3, 1310720
ds_read_b64_tr_b16 a[88:89], v8 offset:0
v_mul_f32 v137, s68, v137
v_mfma_f32_16x16x32_bf16 v[28:31], a[104:107], a[0:3], v[28:31]
s_add_u32 s74, s74, s67
ds_read_b64_tr_b16 a[90:91], v8 offset:1024
v_mul_f32 v138, s68, v138
v_mfma_f32_16x16x32_bf16 v[28:31], a[108:111], a[4:7], v[28:31]
s_mul_i32 s75, s16, 1310720
ds_read_b64_tr_b16 a[92:93], v8 offset:8192
v_mul_f32 v139, s68, v139
v_mfma_f32_16x16x32_bf16 v[28:31], a[112:115], a[32:35], v[28:31]
s_add_u32 s75, s75, s67
ds_read_b64_tr_b16 a[94:95], v8 offset:9216
v_cvt_pk_bf16_f32 v72, v72, v73
v_mfma_f32_16x16x32_bf16 v[28:31], a[116:119], a[36:39], v[28:31]
s_mul_i32 s67, s31, 24576
ds_read_b64_tr_b16 a[96:97], v8 offset:32768
v_cvt_pk_bf16_f32 v73, v74, v75
v_mfma_f32_16x16x32_bf16 v[44:47], a[116:119], a[44:47], v[44:47]
s_sub_u32 s67, 1048576, s67
ds_read_b64_tr_b16 a[98:99], v8 offset:33792
v_cvt_pk_bf16_f32 v74, v136, v137
v_mfma_f32_16x16x32_bf16 v[44:47], a[112:115], a[40:43], v[44:47]
s_add_u32 s64, s74, s67
ds_read_b64_tr_b16 a[100:101], v8 offset:40960
v_cvt_pk_bf16_f32 v75, v138, v139
v_mfma_f32_16x16x32_bf16 v[44:47], a[108:111], a[12:15], v[44:47]
s_add_u32 s65, s75, s67
ds_read_b64_tr_b16 a[102:103], v8 offset:41984
v_mul_f32 v56, s68, v56
v_mfma_f32_16x16x32_bf16 v[44:47], a[104:107], a[8:11], v[44:47]
s_and_b32 s70, s30, 1
v_mul_f32 v57, s68, v57
v_mul_f32 v58, s68, v58
v_mfma_f32_16x16x32_bf16 v[60:63], a[104:107], a[16:19], v[60:63]
s_lshr_b32 s67, s30, 1
v_mul_f32 v59, s68, v59
v_mul_f32 v120, s68, v120
v_mfma_f32_16x16x32_bf16 v[60:63], a[108:111], a[20:23], v[60:63]
s_lshl3_add_u32 s71, s67, s70
v_mul_f32 v121, s68, v121
v_mul_f32 v122, s68, v122
v_mfma_f32_16x16x32_bf16 v[60:63], a[112:115], a[48:51], v[60:63]
s_add_u32 s71, s71, 4
v_mul_f32 v123, s68, v123
v_cvt_pk_bf16_f32 v56, v56, v57
v_mfma_f32_16x16x32_bf16 v[60:63], a[116:119], a[52:55], v[60:63]
s_lshl_b32 s71, s71, 13
v_cvt_pk_bf16_f32 v57, v58, v59
v_cvt_pk_bf16_f32 v58, v120, v121
v_mfma_f32_16x16x32_bf16 v[76:79], a[116:119], a[60:63], v[76:79]
s_lshl_b32 s70, s70, 14
v_cvt_pk_bf16_f32 v59, v122, v123
v_mul_f32 v40, s68, v40
v_mfma_f32_16x16x32_bf16 v[76:79], a[112:115], a[56:59], v[76:79]
s_mul_i32 s67, s67, 24576
v_mul_f32 v41, s68, v41
v_mul_f32 v42, s68, v42
v_mfma_f32_16x16x32_bf16 v[76:79], a[108:111], a[28:31], v[76:79]
s_sub_u32 s70, s70, s67
v_mul_f32 v43, s68, v43
v_mul_f32 v104, s68, v104
v_mfma_f32_16x16x32_bf16 v[76:79], a[104:107], a[24:27], v[76:79]
s_waitcnt lgkmcnt(1)
s_add_u32 s70, s70, 65536
ds_read_b64_tr_b16 a[104:105], v9 offset:0
v_mul_f32 v105, s68, v105
v_mfma_f32_16x16x32_bf16 v[140:143], a[72:75], a[24:27], v[140:143]
ds_read_b64_tr_b16 a[106:107], v9 offset:1024
v_mul_f32 v106, s68, v106
v_mfma_f32_16x16x32_bf16 v[140:143], a[76:79], a[28:31], v[140:143]
ds_read_b64_tr_b16 a[108:109], v9 offset:8192
v_mul_f32 v107, s68, v107
v_mfma_f32_16x16x32_bf16 v[140:143], a[80:83], a[56:59], v[140:143]
ds_read_b64_tr_b16 a[110:111], v9 offset:9216
v_cvt_pk_bf16_f32 v40, v40, v41
v_mfma_f32_16x16x32_bf16 v[140:143], a[84:87], a[60:63], v[140:143]
ds_read_b64_tr_b16 a[112:113], v9 offset:32768
v_cvt_pk_bf16_f32 v41, v42, v43
v_mfma_f32_16x16x32_bf16 v[124:127], a[84:87], a[52:55], v[124:127]
ds_read_b64_tr_b16 a[114:115], v9 offset:33792
v_cvt_pk_bf16_f32 v42, v104, v105
v_mfma_f32_16x16x32_bf16 v[124:127], a[80:83], a[48:51], v[124:127]
ds_read_b64_tr_b16 a[116:117], v9 offset:40960
v_cvt_pk_bf16_f32 v43, v106, v107
v_mfma_f32_16x16x32_bf16 v[124:127], a[76:79], a[20:23], v[124:127]
ds_read_b64_tr_b16 a[118:119], v9 offset:41984
v_mul_f32 v24, s68, v24
v_mfma_f32_16x16x32_bf16 v[124:127], a[72:75], a[16:19], v[124:127]
v_mul_f32 v25, s68, v25
v_mul_f32 v26, s68, v26
v_mfma_f32_16x16x32_bf16 v[108:111], a[72:75], a[8:11], v[108:111]
v_mul_f32 v27, s68, v27
v_mul_f32 v88, s68, v88
v_mfma_f32_16x16x32_bf16 v[108:111], a[76:79], a[12:15], v[108:111]
v_mul_f32 v89, s68, v89
v_mul_f32 v90, s68, v90
v_mfma_f32_16x16x32_bf16 v[108:111], a[80:83], a[40:43], v[108:111]
v_mul_f32 v91, s68, v91
v_cvt_pk_bf16_f32 v24, v24, v25
v_mfma_f32_16x16x32_bf16 v[108:111], a[84:87], a[44:47], v[108:111]
v_cvt_pk_bf16_f32 v25, v26, v27
v_cvt_pk_bf16_f32 v26, v88, v89
v_mfma_f32_16x16x32_bf16 v[92:95], a[84:87], a[36:39], v[92:95]
v_cvt_pk_bf16_f32 v27, v90, v91
v_mul_f32 v76, s68, v76
v_mfma_f32_16x16x32_bf16 v[92:95], a[80:83], a[32:35], v[92:95]
v_mul_f32 v77, s68, v77
v_mul_f32 v78, s68, v78
v_mfma_f32_16x16x32_bf16 v[92:95], a[76:79], a[4:7], v[92:95]
v_mul_f32 v79, s68, v79
v_mul_f32 v140, s68, v140
v_mfma_f32_16x16x32_bf16 v[92:95], a[72:75], a[0:3], v[92:95]
ds_read_b64_tr_b16 a[72:73], v10 offset:0
v_mul_f32 v141, s68, v141
v_mfma_f32_16x16x32_bf16 v[32:35], a[88:91], a[0:3], v[32:35]
ds_read_b64_tr_b16 a[74:75], v10 offset:1024
v_mul_f32 v142, s68, v142
v_mfma_f32_16x16x32_bf16 v[32:35], a[92:95], a[4:7], v[32:35]
ds_read_b64_tr_b16 a[76:77], v10 offset:8192
v_mul_f32 v143, s68, v143
v_mfma_f32_16x16x32_bf16 v[32:35], a[96:99], a[32:35], v[32:35]
s_waitcnt lgkmcnt(3)
ds_read_b64_tr_b16 a[78:79], v10 offset:9216
v_cvt_pk_bf16_f32 v76, v76, v77
v_mfma_f32_16x16x32_bf16 v[32:35], a[100:103], a[36:39], v[32:35]
ds_read_b64_tr_b16 a[80:81], v10 offset:32768
v_cvt_pk_bf16_f32 v77, v78, v79
v_mfma_f32_16x16x32_bf16 v[48:51], a[100:103], a[44:47], v[48:51]
ds_read_b64_tr_b16 a[82:83], v10 offset:33792
v_cvt_pk_bf16_f32 v78, v140, v141
v_mfma_f32_16x16x32_bf16 v[48:51], a[96:99], a[40:43], v[48:51]
ds_read_b64_tr_b16 a[84:85], v10 offset:40960
v_cvt_pk_bf16_f32 v79, v142, v143
v_mfma_f32_16x16x32_bf16 v[48:51], a[92:95], a[12:15], v[48:51]
ds_read_b64_tr_b16 a[86:87], v10 offset:41984
v_mul_f32 v60, s68, v60
v_mfma_f32_16x16x32_bf16 v[48:51], a[88:91], a[8:11], v[48:51]
v_mul_f32 v61, s68, v61
v_mul_f32 v62, s68, v62
v_mfma_f32_16x16x32_bf16 v[64:67], a[88:91], a[16:19], v[64:67]
v_mul_f32 v63, s68, v63
v_mul_f32 v124, s68, v124
v_mfma_f32_16x16x32_bf16 v[64:67], a[92:95], a[20:23], v[64:67]
v_mul_f32 v125, s68, v125
v_mul_f32 v126, s68, v126
v_mfma_f32_16x16x32_bf16 v[64:67], a[96:99], a[48:51], v[64:67]
buffer_load_dwordx4 v[136:139], v16, s[44:47], s77 offen sc1
v_mfma_f32_16x16x32_bf16 v[64:67], a[100:103], a[52:55], v[64:67]
v_mul_f32 v127, s68, v127
v_cvt_pk_bf16_f32 v60, v60, v61
v_mfma_f32_16x16x32_bf16 v[80:83], a[100:103], a[60:63], v[80:83]
v_cvt_pk_bf16_f32 v61, v62, v63
v_cvt_pk_bf16_f32 v62, v124, v125
v_mfma_f32_16x16x32_bf16 v[80:83], a[96:99], a[56:59], v[80:83]
v_cvt_pk_bf16_f32 v63, v126, v127
v_mul_f32 v44, s68, v44
v_mfma_f32_16x16x32_bf16 v[80:83], a[92:95], a[28:31], v[80:83]
v_mul_f32 v45, s68, v45
v_mul_f32 v46, s68, v46
v_mfma_f32_16x16x32_bf16 v[80:83], a[88:91], a[24:27], v[80:83]
ds_read_b64_tr_b16 a[88:89], v11 offset:0
v_mul_f32 v47, s68, v47
v_mfma_f32_16x16x32_bf16 v[144:147], a[104:107], a[24:27], v[144:147]
ds_read_b64_tr_b16 a[90:91], v11 offset:1024
v_mul_f32 v108, s68, v108
v_mfma_f32_16x16x32_bf16 v[144:147], a[108:111], a[28:31], v[144:147]
ds_read_b64_tr_b16 a[92:93], v11 offset:8192
v_mul_f32 v109, s68, v109
v_mfma_f32_16x16x32_bf16 v[144:147], a[112:115], a[56:59], v[144:147]
ds_read_b64_tr_b16 a[94:95], v11 offset:9216
v_mul_f32 v110, s68, v110
v_mfma_f32_16x16x32_bf16 v[144:147], a[116:119], a[60:63], v[144:147]
ds_read_b64_tr_b16 a[96:97], v11 offset:32768
v_mul_f32 v111, s68, v111
v_mfma_f32_16x16x32_bf16 v[128:131], a[116:119], a[52:55], v[128:131]
ds_read_b64_tr_b16 a[98:99], v11 offset:33792
v_cvt_pk_bf16_f32 v44, v44, v45
v_mfma_f32_16x16x32_bf16 v[128:131], a[112:115], a[48:51], v[128:131]
ds_read_b64_tr_b16 a[100:101], v11 offset:40960
v_cvt_pk_bf16_f32 v45, v46, v47
v_mfma_f32_16x16x32_bf16 v[128:131], a[108:111], a[20:23], v[128:131]
ds_read_b64_tr_b16 a[102:103], v11 offset:41984
v_cvt_pk_bf16_f32 v46, v108, v109
v_mfma_f32_16x16x32_bf16 v[128:131], a[104:107], a[16:19], v[128:131]
v_cvt_pk_bf16_f32 v47, v110, v111
v_mul_f32 v28, s68, v28
v_mfma_f32_16x16x32_bf16 v[112:115], a[104:107], a[8:11], v[112:115]
v_mul_f32 v29, s68, v29
v_mul_f32 v30, s68, v30
v_mfma_f32_16x16x32_bf16 v[112:115], a[108:111], a[12:15], v[112:115]
v_mul_f32 v31, s68, v31
v_mul_f32 v92, s68, v92
v_mfma_f32_16x16x32_bf16 v[112:115], a[112:115], a[40:43], v[112:115]
v_mul_f32 v93, s68, v93
v_mul_f32 v94, s68, v94
v_mfma_f32_16x16x32_bf16 v[112:115], a[116:119], a[44:47], v[112:115]
v_mul_f32 v95, s68, v95
v_cvt_pk_bf16_f32 v28, v28, v29
v_mfma_f32_16x16x32_bf16 v[96:99], a[116:119], a[36:39], v[96:99]
v_cvt_pk_bf16_f32 v29, v30, v31
v_cvt_pk_bf16_f32 v30, v92, v93
v_mfma_f32_16x16x32_bf16 v[96:99], a[112:115], a[32:35], v[96:99]
v_cvt_pk_bf16_f32 v31, v94, v95
v_mul_f32 v80, s68, v80
v_mfma_f32_16x16x32_bf16 v[96:99], a[108:111], a[4:7], v[96:99]
v_mul_f32 v81, s68, v81
v_mul_f32 v82, s68, v82
v_mfma_f32_16x16x32_bf16 v[96:99], a[104:107], a[0:3], v[96:99]
s_waitcnt lgkmcnt(1)
v_mul_f32 v83, s68, v83
v_mul_f32 v144, s68, v144
v_mfma_f32_16x16x32_bf16 v[36:39], a[72:75], a[0:3], v[36:39]
v_mul_f32 v145, s68, v145
v_mul_f32 v146, s68, v146
v_mfma_f32_16x16x32_bf16 v[36:39], a[76:79], a[4:7], v[36:39]
v_mul_f32 v147, s68, v147
v_cvt_pk_bf16_f32 v80, v80, v81
v_mfma_f32_16x16x32_bf16 v[36:39], a[80:83], a[32:35], v[36:39]
v_cvt_pk_bf16_f32 v81, v82, v83
v_cvt_pk_bf16_f32 v82, v144, v145
v_mfma_f32_16x16x32_bf16 v[36:39], a[84:87], a[36:39], v[36:39]
v_cvt_pk_bf16_f32 v83, v146, v147
v_mul_f32 v64, s68, v64
v_mfma_f32_16x16x32_bf16 v[52:55], a[84:87], a[44:47], v[52:55]
v_mul_f32 v65, s68, v65
v_mul_f32 v66, s68, v66
v_mfma_f32_16x16x32_bf16 v[52:55], a[80:83], a[40:43], v[52:55]
v_mul_f32 v67, s68, v67
v_mul_f32 v128, s68, v128
v_mfma_f32_16x16x32_bf16 v[52:55], a[76:79], a[12:15], v[52:55]
v_mul_f32 v129, s68, v129
v_mul_f32 v130, s68, v130
v_mfma_f32_16x16x32_bf16 v[52:55], a[72:75], a[8:11], v[52:55]
v_mul_f32 v131, s68, v131
v_cvt_pk_bf16_f32 v64, v64, v65
v_mfma_f32_16x16x32_bf16 v[68:71], a[72:75], a[16:19], v[68:71]
v_cvt_pk_bf16_f32 v65, v66, v67
v_cvt_pk_bf16_f32 v66, v128, v129
v_mfma_f32_16x16x32_bf16 v[68:71], a[76:79], a[20:23], v[68:71]
v_cvt_pk_bf16_f32 v67, v130, v131
v_mul_f32 v48, s68, v48
v_mfma_f32_16x16x32_bf16 v[68:71], a[80:83], a[48:51], v[68:71]
v_mul_f32 v49, s68, v49
v_mul_f32 v50, s68, v50
v_mfma_f32_16x16x32_bf16 v[68:71], a[84:87], a[52:55], v[68:71]
v_mul_f32 v51, s68, v51
v_mul_f32 v112, s68, v112
v_mfma_f32_16x16x32_bf16 v[84:87], a[84:87], a[60:63], v[84:87]
v_mul_f32 v113, s68, v113
v_mul_f32 v114, s68, v114
v_mfma_f32_16x16x32_bf16 v[84:87], a[80:83], a[56:59], v[84:87]
v_mul_f32 v115, s68, v115
v_cvt_pk_bf16_f32 v48, v48, v49
v_mfma_f32_16x16x32_bf16 v[84:87], a[76:79], a[28:31], v[84:87]
v_cvt_pk_bf16_f32 v49, v50, v51
v_cvt_pk_bf16_f32 v50, v112, v113
v_mfma_f32_16x16x32_bf16 v[84:87], a[72:75], a[24:27], v[84:87]
v_cvt_pk_bf16_f32 v51, v114, v115
v_mul_f32 v32, s68, v32
v_mfma_f32_16x16x32_bf16 v[148:151], a[88:91], a[24:27], v[148:151]
v_mul_f32 v33, s68, v33
v_mul_f32 v34, s68, v34
v_mfma_f32_16x16x32_bf16 v[148:151], a[92:95], a[28:31], v[148:151]
v_mul_f32 v35, s68, v35
v_mul_f32 v96, s68, v96
v_mfma_f32_16x16x32_bf16 v[148:151], a[96:99], a[56:59], v[148:151]
s_waitcnt lgkmcnt(0)
s_waitcnt vmcnt(0)
v_max3_u32 v1, v136, v137, v138
v_max_u32 v1, v1, v139
v_mfma_f32_16x16x32_bf16 v[148:151], a[100:103], a[60:63], v[148:151]
v_cmp_eq_u32 vcc, -1, v1
s_cbranch_vccnz L_hretry
L_hgo:
v_mfma_f32_16x16x32_bf16 v[132:135], a[100:103], a[52:55], v[132:135]
ds_write_b128 v17, v[136:139]
v_mfma_f32_16x16x32_bf16 v[132:135], a[96:99], a[48:51], v[132:135]
v_mul_f32 v97, s68, v97
v_mul_f32 v98, s68, v98
v_mfma_f32_16x16x32_bf16 v[132:135], a[92:95], a[20:23], v[132:135]
v_mul_f32 v99, s68, v99
v_cvt_pk_bf16_f32 v32, v32, v33
v_mfma_f32_16x16x32_bf16 v[132:135], a[88:91], a[16:19], v[132:135]
v_cvt_pk_bf16_f32 v33, v34, v35
v_cvt_pk_bf16_f32 v34, v96, v97
v_mfma_f32_16x16x32_bf16 v[116:119], a[88:91], a[8:11], v[116:119]
s_waitcnt lgkmcnt(0)
s_barrier
v_mfma_f32_16x16x32_bf16 v[116:119], a[92:95], a[12:15], v[116:119]
ds_read_b128 a[176:179], v2 offset:0
v_cvt_pk_bf16_f32 v35, v98, v99
v_mfma_f32_16x16x32_bf16 v[116:119], a[96:99], a[40:43], v[116:119]
ds_read_b128 a[184:187], v2 offset:20480
v_mfma_f32_16x16x32_bf16 v[116:119], a[100:103], a[44:47], v[116:119]
ds_read_b64 v[216:217], v2 offset:1032
v_mfma_f32_16x16x32_bf16 v[100:103], a[100:103], a[36:39], v[100:103]
ds_read_b64 v[220:221], v2 offset:1024
v_mfma_f32_16x16x32_bf16 v[100:103], a[96:99], a[32:35], v[100:103]
ds_read_b64 v[232:233], v2 offset:21512
v_mfma_f32_16x16x32_bf16 v[100:103], a[92:95], a[4:7], v[100:103]
ds_read_b64 v[236:237], v2 offset:21504
v_mfma_f32_16x16x32_bf16 v[100:103], a[88:91], a[0:3], v[100:103]
v_mfma_f32_16x16x32_bf16 v[196:199], v[192:195], v[160:163], v[248:251]
s_branch L_po14
L_pg14:
s_branch L_pg19
L_po14:
v_mfma_f32_16x16x32_bf16 v[212:215], v[208:211], v[176:179], v[248:251]
v_mfma_f32_16x16x32_bf16 v[188:191], v[184:187], v[152:155], v[248:251]
v_mfma_f32_16x16x32_bf16 v[204:207], v[200:203], v[168:171], v[248:251]
v_mfma_f32_16x16x32_bf16 v[164:167], a[180:183], v[160:163], v[252:255]
v_mfma_f32_16x16x32_bf16 v[180:183], a[188:191], v[176:179], v[252:255]
s_waitcnt lgkmcnt(5)
v_mfma_f32_16x16x32_bf16 v[156:159], a[176:179], v[152:155], v[20:23]
s_waitcnt lgkmcnt(4)
v_mfma_f32_16x16x32_bf16 v[172:175], a[184:187], v[168:171], v[252:255]
v_accvgpr_read_b32 v4, a64
v_accvgpr_read_b32 v5, a65
v_accvgpr_read_b32 v6, a66
v_accvgpr_read_b32 v7, a67
v_accvgpr_read_b32 v8, a68
v_accvgpr_read_b32 v9, a69
v_accvgpr_read_b32 v10, a70
v_accvgpr_read_b32 v11, a71
v_max3_f32 v121, v196, v197, v198
v_max3_f32 v121, v121, v199, v164
v_max3_f32 v121, v121, v165, v166
v_max_f32 v121, v121, v167
v_max3_f32 v123, v212, v213, v214
v_max3_f32 v123, v123, v215, v180
v_max3_f32 v123, v123, v181, v182
v_max_f32 v123, v123, v183
v_max3_f32 v120, v188, v189, v190
v_max3_f32 v120, v120, v191, v156
v_max3_f32 v120, v120, v157, v158
v_max_f32 v120, v120, v159
v_max3_f32 v122, v204, v205, v206
v_max3_f32 v122, v122, v207, v172
v_max3_f32 v122, v122, v173, v174
v_max_f32 v122, v122, v175
v_mov_b32 v105, v121
v_mov_b32 v107, v123
v_mov_b32 v104, v120
v_mov_b32 v106, v122
v_permlane16_swap_b32 v105, v121
v_permlane16_swap_b32 v107, v123
v_permlane16_swap_b32 v104, v120
v_permlane16_swap_b32 v106, v122
v_max_f32 v121, v121, v105
v_max_f32 v123, v123, v107
v_max_f32 v120, v120, v104
v_max_f32 v122, v122, v106
v_mov_b32 v105, v121
v_mov_b32 v107, v123
v_mov_b32 v104, v120
v_mov_b32 v106, v122
v_permlane32_swap_b32 v105, v121
v_permlane32_swap_b32 v107, v123
v_permlane32_swap_b32 v104, v120
v_permlane32_swap_b32 v106, v122
v_max_f32 v121, v121, v105
v_max_f32 v123, v123, v107
v_max_f32 v120, v120, v104
v_max_f32 v122, v122, v106
v_mul_f32 v121, s66, v121
v_mul_f32 v123, s66, v123
v_mul_f32 v120, s66, v120
v_mul_f32 v122, s66, v122
v_fma_f32 v164, v164, s66, -v121
v_fma_f32 v165, v165, s66, -v121
v_fma_f32 v166, v166, s66, -v121
v_fma_f32 v167, v167, s66, -v121
v_fma_f32 v196, v196, s66, -v121
v_fma_f32 v197, v197, s66, -v121
v_fma_f32 v198, v198, s66, -v121
v_fma_f32 v199, v199, s66, -v121
v_exp_f32 v164, v164
v_exp_f32 v165, v165
v_exp_f32 v166, v166
v_exp_f32 v167, v167
v_exp_f32 v196, v196
v_exp_f32 v197, v197
v_exp_f32 v198, v198
v_exp_f32 v199, v199
v_cvt_pk_bf16_f32 v164, v164, v165
v_cvt_pk_bf16_f32 v165, v166, v167
v_cvt_pk_bf16_f32 v166, v196, v197
v_cvt_pk_bf16_f32 v167, v198, v199
v_pk_mul_f32 v[36:37], v[36:37], s[68:69]
v_pk_mul_f32 v[38:39], v[38:39], s[68:69]
v_mfma_f32_16x16x32_bf16 v[196:199], a[244:247], v[164:167], 0
v_mfma_f32_16x16x32_bf16 v[160:163], v[224:227], v[164:167], 0
v_mfma_f32_16x16x32_bf16 v[192:195], v[228:231], v[164:167], 0
v_fma_f32 v180, v180, s66, -v123
v_fma_f32 v181, v181, s66, -v123
v_fma_f32 v182, v182, s66, -v123
v_fma_f32 v183, v183, s66, -v123
v_fma_f32 v212, v212, s66, -v123
v_fma_f32 v213, v213, s66, -v123
v_fma_f32 v214, v214, s66, -v123
v_fma_f32 v215, v215, s66, -v123
v_exp_f32 v180, v180
v_exp_f32 v181, v181
v_exp_f32 v182, v182
v_exp_f32 v183, v183
v_exp_f32 v212, v212
v_exp_f32 v213, v213
v_exp_f32 v214, v214
v_exp_f32 v215, v215
v_cvt_pk_bf16_f32 v180, v180, v181
v_cvt_pk_bf16_f32 v181, v182, v183
v_cvt_pk_bf16_f32 v182, v212, v213
v_cvt_pk_bf16_f32 v183, v214, v215
v_pk_mul_f32 v[100:101], v[100:101], s[68:69]
v_pk_mul_f32 v[102:103], v[102:103], s[68:69]
v_mfma_f32_16x16x32_bf16 v[212:215], a[244:247], v[180:183], 0
v_mfma_f32_16x16x32_bf16 v[176:179], v[240:243], v[180:183], 0
v_mfma_f32_16x16x32_bf16 v[208:211], v[244:247], v[180:183], 0
v_fma_f32 v156, v156, s66, -v120
v_fma_f32 v157, v157, s66, -v120
v_fma_f32 v158, v158, s66, -v120
v_fma_f32 v159, v159, s66, -v120
v_fma_f32 v188, v188, s66, -v120
v_fma_f32 v189, v189, s66, -v120
v_fma_f32 v190, v190, s66, -v120
v_fma_f32 v191, v191, s66, -v120
v_exp_f32 v156, v156
v_exp_f32 v157, v157
v_exp_f32 v158, v158
v_exp_f32 v159, v159
v_exp_f32 v188, v188
v_exp_f32 v189, v189
v_exp_f32 v190, v190
v_exp_f32 v191, v191
v_cvt_pk_bf16_f32 v156, v156, v157
v_cvt_pk_bf16_f32 v157, v158, v159
v_cvt_pk_bf16_f32 v158, v188, v189
v_cvt_pk_bf16_f32 v159, v190, v191
v_cvt_pk_bf16_f32 v36, v36, v37
v_cvt_pk_bf16_f32 v37, v38, v39
v_mfma_f32_16x16x32_bf16 v[188:191], a[244:247], v[156:159], 0
s_waitcnt lgkmcnt(3)
v_mfma_f32_16x16x32_bf16 v[152:155], v[216:219], v[156:159], 0
s_waitcnt lgkmcnt(2)
v_mfma_f32_16x16x32_bf16 v[184:187], v[220:223], v[156:159], 0
v_fma_f32 v172, v172, s66, -v122
v_fma_f32 v173, v173, s66, -v122
v_fma_f32 v174, v174, s66, -v122
v_fma_f32 v175, v175, s66, -v122
v_fma_f32 v204, v204, s66, -v122
v_fma_f32 v205, v205, s66, -v122
v_fma_f32 v206, v206, s66, -v122
v_fma_f32 v207, v207, s66, -v122
v_exp_f32 v172, v172
v_exp_f32 v173, v173
v_exp_f32 v174, v174
v_exp_f32 v175, v175
v_exp_f32 v204, v204
v_exp_f32 v205, v205
v_exp_f32 v206, v206
v_exp_f32 v207, v207
v_cvt_pk_bf16_f32 v172, v172, v173
v_cvt_pk_bf16_f32 v173, v174, v175
v_cvt_pk_bf16_f32 v174, v204, v205
v_cvt_pk_bf16_f32 v175, v206, v207
v_cvt_pk_bf16_f32 v38, v100, v101
v_cvt_pk_bf16_f32 v39, v102, v103
v_mfma_f32_16x16x32_bf16 v[204:207], a[244:247], v[172:175], 0
s_waitcnt lgkmcnt(1)
v_mfma_f32_16x16x32_bf16 v[168:171], v[232:235], v[172:175], 0
s_waitcnt lgkmcnt(0)
v_mfma_f32_16x16x32_bf16 v[200:203], v[236:239], v[172:175], 0
v_pk_mul_f32 v[52:53], v[52:53], s[68:69]
v_pk_mul_f32 v[54:55], v[54:55], s[68:69]
v_pk_mul_f32 v[116:117], v[116:117], s[68:69]
v_pk_mul_f32 v[118:119], v[118:119], s[68:69]
v_cvt_pk_bf16_f32 v52, v52, v53
v_cvt_pk_bf16_f32 v53, v54, v55
v_cvt_pk_bf16_f32 v54, v116, v117
v_cvt_pk_bf16_f32 v55, v118, v119
v_pk_mul_f32 v[68:69], v[68:69], s[68:69]
v_pk_mul_f32 v[70:71], v[70:71], s[68:69]
v_pk_mul_f32 v[132:133], v[132:133], s[68:69]
v_pk_mul_f32 v[134:135], v[134:135], s[68:69]
v_cvt_pk_bf16_f32 v68, v68, v69
v_cvt_pk_bf16_f32 v69, v70, v71
v_cvt_pk_bf16_f32 v70, v132, v133
v_cvt_pk_bf16_f32 v71, v134, v135
v_pk_mul_f32 v[84:85], v[84:85], s[68:69]
v_pk_mul_f32 v[86:87], v[86:87], s[68:69]
v_pk_mul_f32 v[148:149], v[148:149], s[68:69]
v_pk_mul_f32 v[150:151], v[150:151], s[68:69]
v_cvt_pk_bf16_f32 v84, v84, v85
v_cvt_pk_bf16_f32 v85, v86, v87
v_cvt_pk_bf16_f32 v86, v148, v149
v_cvt_pk_bf16_f32 v87, v150, v151
v_rcp_f32 v121, v196
v_rcp_f32 v123, v212
v_rcp_f32 v120, v188
v_rcp_f32 v122, v204
v_mul_f32 v121, v121, v7
v_mul_f32 v123, v123, v11
v_mul_f32 v120, v120, v5
v_mul_f32 v122, v122, v9
v_pk_mul_f32 v[152:153], v[152:153], v[120:121] op_sel_hi:[1,0]
v_pk_mul_f32 v[154:155], v[154:155], v[120:121] op_sel_hi:[1,0]
v_pk_mul_f32 v[184:185], v[184:185], v[120:121] op_sel_hi:[1,0]
v_pk_mul_f32 v[186:187], v[186:187], v[120:121] op_sel_hi:[1,0]
v_cvt_pk_bf16_f32 v152, v152, v153
v_cvt_pk_bf16_f32 v153, v154, v155
v_cvt_pk_bf16_f32 v154, v184, v185
v_cvt_pk_bf16_f32 v155, v186, v187
buffer_store_dwordx4 v[152:155], v16, s[44:47], s64 offen sc1
v_mov_b32 v2, v16
v_add_u32 v3, 0x10000, v16
v_mov_b32 v1, 0
s_mov_b32 m0, s71
s_waitcnt lgkmcnt(0)
s_barrier
ds_read_b128 a[144:147], v2 offset:0
ds_read_b128 a[148:151], v2 offset:1024
ds_read_b128 a[152:155], v2 offset:2048
ds_read_b128 a[156:159], v2 offset:3072
ds_read_b128 a[160:163], v2 offset:4096
ds_read_b128 a[164:167], v2 offset:5120
ds_read_b128 a[168:171], v2 offset:6144
ds_read_b128 a[172:175], v2 offset:7168
buffer_load_dwordx4 v16, s[32:35], s70 offen offset:0 sc1 lds
buffer_load_dwordx4 v16, s[32:35], s70 offen offset:1024 sc1 lds
v_pk_mul_f32 v[168:169], v[168:169], v[122:123] op_sel_hi:[1,0]
v_pk_mul_f32 v[170:171], v[170:171], v[122:123] op_sel_hi:[1,0]
v_pk_mul_f32 v[200:201], v[200:201], v[122:123] op_sel_hi:[1,0]
v_pk_mul_f32 v[202:203], v[202:203], v[122:123] op_sel_hi:[1,0]
v_cvt_pk_bf16_f32 v168, v168, v169
v_cvt_pk_bf16_f32 v169, v170, v171
v_cvt_pk_bf16_f32 v170, v200, v201
v_cvt_pk_bf16_f32 v171, v202, v203
buffer_store_dwordx4 v[168:171], v16, s[44:47], s65 offen sc1
v_pk_mul_f32 v[160:161], v[160:161], v[120:121] op_sel:[0,1]
v_pk_mul_f32 v[162:163], v[162:163], v[120:121] op_sel:[0,1]
v_pk_mul_f32 v[192:193], v[192:193], v[120:121] op_sel:[0,1]
v_pk_mul_f32 v[194:195], v[194:195], v[120:121] op_sel:[0,1]
v_cvt_pk_bf16_f32 v160, v160, v161
v_cvt_pk_bf16_f32 v161, v162, v163
v_cvt_pk_bf16_f32 v162, v192, v193
v_cvt_pk_bf16_f32 v163, v194, v195
s_add_u32 s64, s64, 4096
buffer_store_dwordx4 v[160:163], v16, s[44:47], s64 offen sc1
v_pk_mul_f32 v[176:177], v[176:177], v[122:123] op_sel:[0,1]
v_pk_mul_f32 v[178:179], v[178:179], v[122:123] op_sel:[0,1]
v_pk_mul_f32 v[208:209], v[208:209], v[122:123] op_sel:[0,1]
v_pk_mul_f32 v[210:211], v[210:211], v[122:123] op_sel:[0,1]
v_cvt_pk_bf16_f32 v176, v176, v177
v_cvt_pk_bf16_f32 v177, v178, v179
v_cvt_pk_bf16_f32 v178, v208, v209
v_cvt_pk_bf16_f32 v179, v210, v211
s_add_u32 s65, s65, 4096
buffer_store_dwordx4 v[176:179], v16, s[44:47], s65 offen sc1
v_mov_b32 v17, 0xff800000
v_and_b32 v5, 1, v0
v_mul_u32_u24 v5, 0xaaaa, v5
v_add_u32 v5, 0x4444, v5
v_lshl_or_b32 v5, v5, 16, v5
L_attstart_7:
s_cmp_eq_u32 s3, 0
s_cbranch_scc1 L_F1
s_waitcnt lgkmcnt(7)
v_mfma_f32_16x16x32_bf16 v[88:91], a[144:147], v[24:27], 0
s_waitcnt lgkmcnt(6)
ds_read_b128 a[176:179], v2 offset:8192
v_accvgpr_write_b32 a128, 0
v_mfma_f32_16x16x32_bf16 v[88:91], a[148:151], v[28:31], v[88:91]
s_waitcnt lgkmcnt(6)
ds_read_b128 a[180:183], v2 offset:9216
v_accvgpr_write_b32 a129, 0
v_mfma_f32_16x16x32_bf16 v[88:91], a[152:155], v[32:35], v[88:91]
s_waitcnt lgkmcnt(6)
buffer_load_dwordx4 v16, s[32:35], s70 offen offset:2048 sc1 lds
v_mfma_f32_16x16x32_bf16 v[88:91], a[156:159], v[36:39], v[88:91]
ds_read_b128 a[184:187], v2 offset:10240
v_accvgpr_write_b32 a130, 0
v_mfma_f32_16x16x32_bf16 v[104:107], a[156:159], v[52:55], 0
ds_read_b128 a[188:191], v2 offset:11264
v_accvgpr_write_b32 a131, 0
v_mfma_f32_16x16x32_bf16 v[104:107], a[152:155], v[48:51], v[104:107]
ds_read_b128 a[192:195], v2 offset:12288
v_accvgpr_write_b32 a132, 0
v_mfma_f32_16x16x32_bf16 v[104:107], a[148:151], v[44:47], v[104:107]
ds_read_b128 a[196:199], v2 offset:13312
v_accvgpr_write_b32 a133, 0
v_mfma_f32_16x16x32_bf16 v[104:107], a[144:147], v[40:43], v[104:107]
ds_read_b128 a[200:203], v2 offset:14336
v_accvgpr_write_b32 a134, 0
v_mfma_f32_16x16x32_bf16 v[120:123], a[144:147], v[56:59], 0
ds_read_b128 a[204:207], v2 offset:15360
v_accvgpr_write_b32 a135, 0
v_mfma_f32_16x16x32_bf16 v[120:123], a[148:151], v[60:63], v[120:123]
buffer_load_dwordx4 v16, s[32:35], s70 offen offset:3072 sc1 lds
v_mfma_f32_16x16x32_bf16 v[120:123], a[152:155], v[64:67], v[120:123]
v_accvgpr_write_b32 a136, 0
v_accvgpr_write_b32 a137, 0
v_mfma_f32_16x16x32_bf16 v[120:123], a[156:159], v[68:71], v[120:123]
v_accvgpr_write_b32 a138, 0
v_accvgpr_write_b32 a139, 0
v_mfma_f32_16x16x32_bf16 v[136:139], a[156:159], v[84:87], 0
v_accvgpr_write_b32 a140, 0
v_accvgpr_write_b32 a141, 0
v_mfma_f32_16x16x32_bf16 v[136:139], a[152:155], v[80:83], v[136:139]
v_accvgpr_write_b32 a142, 0
v_accvgpr_write_b32 a143, 0
v_mfma_f32_16x16x32_bf16 v[136:139], a[148:151], v[76:79], v[136:139]
v_mfma_f32_16x16x32_bf16 v[136:139], a[144:147], v[72:75], v[136:139]
s_waitcnt lgkmcnt(0)
s_nop 1
v_max3_f32 v20, v88, v89, v90
v_max_f32 v20, v20, v91
v_max3_f32 v21, v104, v105, v106
v_max_f32 v21, v21, v107
v_max3_f32 v22, v120, v121, v122
v_max_f32 v22, v22, v123
v_max3_f32 v23, v136, v137, v138
v_max_f32 v23, v23, v139
v_mov_b32 v248, v20
v_mov_b32 v249, v21
v_mov_b32 v250, v22
v_mov_b32 v251, v23
v_permlane16_swap_b32 v248, v20
v_permlane16_swap_b32 v249, v21
v_permlane16_swap_b32 v250, v22
v_permlane16_swap_b32 v251, v23
v_max_f32 v20, v20, v248
v_max_f32 v21, v21, v249
v_max_f32 v22, v22, v250
v_max_f32 v23, v23, v251
v_mov_b32 v248, v20
v_mov_b32 v249, v21
v_mov_b32 v250, v22
v_mov_b32 v251, v23
v_permlane32_swap_b32 v248, v20
v_permlane32_swap_b32 v249, v21
v_permlane32_swap_b32 v250, v22
v_permlane32_swap_b32 v251, v23
v_max_f32 v20, v20, v248
v_max_f32 v21, v21, v249
v_max_f32 v22, v22, v250
v_max_f32 v23, v23, v251
s_cmp_eq_u32 s73, 0
s_cselect_b64 vcc, 0, -1
v_cndmask_b32 v20, v20, v252, vcc
v_cndmask_b32 v21, v21, v253, vcc
v_cndmask_b32 v22, v22, v254, vcc
v_cndmask_b32 v23, v23, v255, vcc
v_sub_f32 v228, 0, v23
v_sub_f32 v229, 0, v23
v_sub_f32 v230, 0, v23
v_sub_f32 v231, 0, v23
v_sub_f32 v224, 0, v22
v_sub_f32 v225, 0, v22
v_sub_f32 v226, 0, v22
v_sub_f32 v227, 0, v22
v_sub_f32 v220, 0, v21
v_sub_f32 v221, 0, v21
v_sub_f32 v222, 0, v21
v_sub_f32 v223, 0, v21
v_sub_f32 v216, 0, v20
v_sub_f32 v217, 0, v20
v_sub_f32 v218, 0, v20
v_sub_f32 v219, 0, v20
v_mfma_f32_16x16x32_bf16 v[140:143], a[160:163], v[72:75], v[228:231]
s_add_u32 m0, s71, 4096
v_add_f32 v88, v88, v216
v_add_f32 v89, v89, v216
v_mfma_f32_16x16x32_bf16 v[140:143], a[164:167], v[76:79], v[140:143]
v_add_f32 v90, v90, v216
v_add_f32 v91, v91, v216
v_exp_f32 v88, v88
v_mfma_f32_16x16x32_bf16 v[140:143], a[168:171], v[80:83], v[140:143]
s_add_u32 s64, s70, 4096
v_exp_f32 v89, v89
v_mfma_f32_16x16x32_bf16 v[140:143], a[172:175], v[84:87], v[140:143]
buffer_load_dwordx4 v16, s[32:35], s64 offen offset:0 sc1 lds
v_mfma_f32_16x16x32_bf16 v[124:127], a[172:175], v[68:71], v[224:227]
v_exp_f32 v90, v90
v_mfma_f32_16x16x32_bf16 v[124:127], a[168:171], v[64:67], v[124:127]
v_exp_f32 v91, v91
v_mfma_f32_16x16x32_bf16 v[124:127], a[164:167], v[60:63], v[124:127]
v_add_f32 v104, v104, v220
v_add_f32 v105, v105, v220
v_add_f32 v106, v106, v220
v_add_f32 v107, v107, v220
v_exp_f32 v104, v104
v_mfma_f32_16x16x32_bf16 v[124:127], a[160:163], v[56:59], v[124:127]
v_exp_f32 v105, v105
v_mfma_f32_16x16x32_bf16 v[108:111], a[160:163], v[40:43], v[220:223]
v_exp_f32 v106, v106
v_mfma_f32_16x16x32_bf16 v[108:111], a[164:167], v[44:47], v[108:111]
buffer_load_dwordx4 v16, s[32:35], s64 offen offset:1024 sc1 lds
v_mfma_f32_16x16x32_bf16 v[108:111], a[168:171], v[48:51], v[108:111]
v_cvt_pk_bf16_f32 v152, v88, v89
v_add_f32 v120, v120, v224
v_mfma_f32_16x16x32_bf16 v[108:111], a[172:175], v[52:55], v[108:111]
v_exp_f32 v107, v107
v_mfma_f32_16x16x32_bf16 v[92:95], a[172:175], v[36:39], v[216:219]
v_add_f32 v121, v121, v224
v_add_f32 v122, v122, v224
v_add_f32 v123, v123, v224
v_exp_f32 v120, v120
v_mfma_f32_16x16x32_bf16 v[92:95], a[168:171], v[32:35], v[92:95]
v_cvt_pk_bf16_f32 v153, v90, v91
v_exp_f32 v121, v121
v_mfma_f32_16x16x32_bf16 v[92:95], a[164:167], v[28:31], v[92:95]
v_exp_f32 v122, v122
v_mfma_f32_16x16x32_bf16 v[92:95], a[160:163], v[24:27], v[92:95]
v_exp_f32 v123, v123
v_mfma_f32_16x16x32_bf16 v[96:99], a[176:179], v[24:27], v[216:219]
v_cvt_pk_bf16_f32 v160, v104, v105
v_add_f32 v136, v136, v228
v_mfma_f32_16x16x32_bf16 v[96:99], a[180:183], v[28:31], v[96:99]
buffer_load_dwordx4 v16, s[32:35], s64 offen offset:2048 sc1 lds
v_add_f32 v137, v137, v228
v_add_f32 v138, v138, v228
v_add_f32 v139, v139, v228
v_exp_f32 v136, v136
v_mfma_f32_16x16x32_bf16 v[96:99], a[184:187], v[32:35], v[96:99]
v_exp_f32 v137, v137
v_mfma_f32_16x16x32_bf16 v[96:99], a[188:191], v[36:39], v[96:99]
v_cvt_pk_bf16_f32 v161, v106, v107
v_cvt_pk_bf16_f32 v184, v120, v121
v_mfma_f32_16x16x32_bf16 v[112:115], a[188:191], v[52:55], v[220:223]
v_exp_f32 v138, v138
v_mfma_f32_16x16x32_bf16 v[112:115], a[184:187], v[48:51], v[112:115]
v_exp_f32 v139, v139
v_mfma_f32_16x16x32_bf16 v[112:115], a[180:183], v[44:47], v[112:115]
v_exp_f32 v140, v140
v_mfma_f32_16x16x32_bf16 v[112:115], a[176:179], v[40:43], v[112:115]
v_exp_f32 v141, v141
v_mfma_f32_16x16x32_bf16 v[128:131], a[176:179], v[56:59], v[224:227]
buffer_load_dwordx4 v16, s[32:35], s64 offen offset:3072 sc1 lds
v_cvt_pk_bf16_f32 v185, v122, v123
v_mfma_f32_16x16x32_bf16 v[128:131], a[180:183], v[60:63], v[128:131]
v_exp_f32 v142, v142
v_mfma_f32_16x16x32_bf16 v[128:131], a[184:187], v[64:67], v[128:131]
v_exp_f32 v143, v143
v_mfma_f32_16x16x32_bf16 v[128:131], a[188:191], v[68:71], v[128:131]
v_cvt_pk_bf16_f32 v192, v136, v137
v_cvt_pk_bf16_f32 v193, v138, v139
v_mfma_f32_16x16x32_bf16 v[144:147], a[188:191], v[84:87], v[228:231]
v_exp_f32 v124, v124
v_mfma_f32_16x16x32_bf16 v[144:147], a[184:187], v[80:83], v[144:147]
v_exp_f32 v125, v125
v_mfma_f32_16x16x32_bf16 v[144:147], a[180:183], v[76:79], v[144:147]
s_waitcnt vmcnt(6)
s_barrier
v_mfma_f32_16x16x32_bf16 v[144:147], a[176:179], v[72:75], v[144:147]
v_exp_f32 v126, v126
v_mfma_f32_16x16x32_bf16 v[148:151], a[192:195], v[72:75], v[228:231]
v_cvt_pk_bf16_f32 v194, v140, v141
v_cvt_pk_bf16_f32 v195, v142, v143
v_mfma_f32_16x16x32_bf16 v[148:151], a[196:199], v[76:79], v[148:151]
v_exp_f32 v127, v127
v_mfma_f32_16x16x32_bf16 v[148:151], a[200:203], v[80:83], v[148:151]
s_xor_b32 s71, s71, 16384
v_exp_f32 v108, v108
v_mfma_f32_16x16x32_bf16 v[148:151], a[204:207], v[84:87], v[148:151]
s_add_u32 s70, s70, 32768
v_exp_f32 v109, v109
v_mfma_f32_16x16x32_bf16 v[132:135], a[204:207], v[68:71], v[224:227]
s_mov_b32 m0, s71
v_exp_f32 v110, v110
v_mfma_f32_16x16x32_bf16 v[132:135], a[200:203], v[64:67], v[132:135]
buffer_load_dwordx4 v16, s[32:35], s70 offen offset:0 sc1 lds
v_mfma_f32_16x16x32_bf16 v[132:135], a[196:199], v[60:63], v[132:135]
v_cvt_pk_bf16_f32 v186, v124, v125
v_exp_f32 v111, v111
v_mfma_f32_16x16x32_bf16 v[132:135], a[192:195], v[56:59], v[132:135]
v_exp_f32 v92, v92
v_mfma_f32_16x16x32_bf16 v[116:119], a[192:195], v[40:43], v[220:223]
v_exp_f32 v93, v93
v_mfma_f32_16x16x32_bf16 v[116:119], a[196:199], v[44:47], v[116:119]
ds_read_b128 a[144:147], v2 offset:16384
v_cvt_pk_bf16_f32 v187, v126, v127
v_mfma_f32_16x16x32_bf16 v[116:119], a[200:203], v[48:51], v[116:119]
v_exp_f32 v94, v94
v_mfma_f32_16x16x32_bf16 v[116:119], a[204:207], v[52:55], v[116:119]
ds_read_b128 a[148:151], v2 offset:17408
v_cvt_pk_bf16_f32 v162, v108, v109
v_mfma_f32_16x16x32_bf16 v[100:103], a[204:207], v[36:39], v[216:219]
ds_read_b128 a[152:155], v2 offset:18432
buffer_load_dwordx4 v16, s[32:35], s70 offen offset:1024 sc1 lds
v_exp_f32 v95, v95
v_mfma_f32_16x16x32_bf16 v[100:103], a[200:203], v[32:35], v[100:103]
ds_read_b128 a[156:159], v2 offset:19456
v_exp_f32 v96, v96
v_mfma_f32_16x16x32_bf16 v[100:103], a[196:199], v[28:31], v[100:103]
v_cvt_pk_bf16_f32 v163, v110, v111
v_exp_f32 v97, v97
v_mfma_f32_16x16x32_bf16 v[100:103], a[192:195], v[24:27], v[100:103]
s_waitcnt lgkmcnt(3)
ds_read_b128 a[160:163], v2 offset:20480
ds_read_b128 a[164:167], v2 offset:21504
ds_read_b128 a[168:171], v2 offset:22528
ds_read_b128 a[172:175], v2 offset:23552
v_mfma_f32_16x16x32_bf16 v[88:91], a[144:147], v[24:27], v[216:219]
s_waitcnt lgkmcnt(6)
v_exp_f32 v98, v98
v_mfma_f32_16x16x32_bf16 v[88:91], a[148:151], v[28:31], v[88:91]
s_waitcnt lgkmcnt(5)
v_cvt_pk_bf16_f32 v154, v92, v93
v_exp_f32 v99, v99
v_mfma_f32_16x16x32_bf16 v[88:91], a[152:155], v[32:35], v[88:91]
s_waitcnt lgkmcnt(4)
v_exp_f32 v112, v112
v_mfma_f32_16x16x32_bf16 v[88:91], a[156:159], v[36:39], v[88:91]
v_exp_f32 v113, v113
v_mfma_f32_16x16x32_bf16 v[104:107], a[156:159], v[52:55], v[220:223]
v_cvt_pk_bf16_f32 v155, v94, v95
v_cvt_pk_bf16_f32 v156, v96, v97
v_mfma_f32_16x16x32_bf16 v[104:107], a[152:155], v[48:51], v[104:107]
buffer_load_dwordx4 v16, s[32:35], s70 offen offset:2048 sc1 lds
v_exp_f32 v114, v114
v_mfma_f32_16x16x32_bf16 v[104:107], a[148:151], v[44:47], v[104:107]
v_exp_f32 v115, v115
v_mfma_f32_16x16x32_bf16 v[104:107], a[144:147], v[40:43], v[104:107]
v_exp_f32 v128, v128
v_mfma_f32_16x16x32_bf16 v[120:123], a[144:147], v[56:59], v[224:227]
v_exp_f32 v129, v129
v_mfma_f32_16x16x32_bf16 v[120:123], a[148:151], v[60:63], v[120:123]
v_cvt_pk_bf16_f32 v157, v98, v99
v_cvt_pk_bf16_f32 v164, v112, v113
v_mfma_f32_16x16x32_bf16 v[120:123], a[152:155], v[64:67], v[120:123]
v_exp_f32 v130, v130
v_mfma_f32_16x16x32_bf16 v[120:123], a[156:159], v[68:71], v[120:123]
v_exp_f32 v131, v131
v_mfma_f32_16x16x32_bf16 v[136:139], a[156:159], v[84:87], v[228:231]
v_exp_f32 v144, v144
v_mfma_f32_16x16x32_bf16 v[136:139], a[152:155], v[80:83], v[136:139]
v_exp_f32 v145, v145
v_mfma_f32_16x16x32_bf16 v[136:139], a[148:151], v[76:79], v[136:139]
v_exp_f32 v146, v146
v_mfma_f32_16x16x32_bf16 v[136:139], a[144:147], v[72:75], v[136:139]
s_waitcnt lgkmcnt(0)
v_cvt_pk_bf16_f32 v165, v114, v115
v_cvt_pk_bf16_f32 v188, v128, v129
v_mfma_f32_16x16x32_bf16 v[140:143], a[160:163], v[72:75], v[228:231]
v_exp_f32 v147, v147
v_mfma_f32_16x16x32_bf16 v[140:143], a[164:167], v[76:79], v[140:143]
v_exp_f32 v148, v148
v_mfma_f32_16x16x32_bf16 v[140:143], a[168:171], v[80:83], v[140:143]
v_exp_f32 v149, v149
v_mfma_f32_16x16x32_bf16 v[140:143], a[172:175], v[84:87], v[140:143]
buffer_load_dwordx4 v16, s[32:35], s70 offen offset:3072 sc1 lds
v_mfma_f32_16x16x32_bf16 v[124:127], a[172:175], v[68:71], v[224:227]
v_cvt_pk_bf16_f32 v189, v130, v131
v_cvt_pk_bf16_f32 v196, v144, v145
v_mfma_f32_16x16x32_bf16 v[124:127], a[168:171], v[64:67], v[124:127]
v_exp_f32 v150, v150
v_mfma_f32_16x16x32_bf16 v[124:127], a[164:167], v[60:63], v[124:127]
v_exp_f32 v151, v151
v_mfma_f32_16x16x32_bf16 v[124:127], a[160:163], v[56:59], v[124:127]
v_exp_f32 v132, v132
v_mfma_f32_16x16x32_bf16 v[108:111], a[160:163], v[40:43], v[220:223]
ds_read_b128 a[176:179], v2 offset:24576
v_cvt_pk_bf16_f32 v197, v146, v147
v_mfma_f32_16x16x32_bf16 v[108:111], a[164:167], v[44:47], v[108:111]
ds_read_b128 a[180:183], v2 offset:25600
v_cvt_pk_bf16_f32 v198, v148, v149
v_mfma_f32_16x16x32_bf16 v[108:111], a[168:171], v[48:51], v[108:111]
ds_read_b128 a[184:187], v2 offset:26624
v_exp_f32 v133, v133
v_mfma_f32_16x16x32_bf16 v[108:111], a[172:175], v[52:55], v[108:111]
ds_read_b128 a[188:191], v2 offset:27648
v_exp_f32 v134, v134
v_mfma_f32_16x16x32_bf16 v[92:95], a[172:175], v[36:39], v[216:219]
v_exp_f32 v135, v135
v_mfma_f32_16x16x32_bf16 v[92:95], a[168:171], v[32:35], v[92:95]
v_exp_f32 v116, v116
v_mfma_f32_16x16x32_bf16 v[92:95], a[164:167], v[28:31], v[92:95]
v_exp_f32 v117, v117
v_mfma_f32_16x16x32_bf16 v[92:95], a[160:163], v[24:27], v[92:95]
s_waitcnt lgkmcnt(2)
v_cvt_pk_bf16_f32 v199, v150, v151
v_cvt_pk_bf16_f32 v190, v132, v133
v_mfma_f32_16x16x32_bf16 v[96:99], a[176:179], v[24:27], v[216:219]
v_exp_f32 v118, v118
v_mfma_f32_16x16x32_bf16 v[96:99], a[180:183], v[28:31], v[96:99]
s_waitcnt lgkmcnt(0)
s_add_u32 m0, s71, 4096
v_exp_f32 v119, v119
v_mfma_f32_16x16x32_bf16 v[96:99], a[184:187], v[32:35], v[96:99]
s_add_u32 s64, s70, 4096
v_exp_f32 v100, v100
v_mfma_f32_16x16x32_bf16 v[96:99], a[188:191], v[36:39], v[96:99]
buffer_load_dwordx4 v16, s[32:35], s64 offen offset:0 sc1 lds
v_mfma_f32_16x16x32_bf16 v[112:115], a[188:191], v[52:55], v[220:223]
v_exp_f32 v101, v101
v_mfma_f32_16x16x32_bf16 v[112:115], a[184:187], v[48:51], v[112:115]
v_cvt_pk_bf16_f32 v191, v134, v135
v_cvt_pk_bf16_f32 v166, v116, v117
v_mfma_f32_16x16x32_bf16 v[112:115], a[180:183], v[44:47], v[112:115]
v_exp_f32 v102, v102
v_mfma_f32_16x16x32_bf16 v[112:115], a[176:179], v[40:43], v[112:115]
v_exp_f32 v103, v103
v_mfma_f32_16x16x32_bf16 v[128:131], a[176:179], v[56:59], v[224:227]
s_lshl_b32 s66, s30, 30
ds_read_b128 a[192:195], v2 offset:28672
v_cvt_pk_bf16_f32 v167, v118, v119
v_mfma_f32_16x16x32_bf16 v[128:131], a[180:183], v[60:63], v[128:131]
ds_read_b128 a[196:199], v2 offset:29696
v_exp_f32 v88, v88
v_mfma_f32_16x16x32_bf16 v[128:131], a[184:187], v[64:67], v[128:131]
ds_read_b128 a[200:203], v2 offset:30720
v_exp_f32 v89, v89
v_mfma_f32_16x16x32_bf16 v[128:131], a[188:191], v[68:71], v[128:131]
ds_read_b128 a[204:207], v2 offset:31744
v_cvt_pk_bf16_f32 v158, v100, v101
v_mfma_f32_16x16x32_bf16 v[144:147], a[188:191], v[84:87], v[228:231]
v_exp_f32 v90, v90
v_mfma_f32_16x16x32_bf16 v[144:147], a[184:187], v[80:83], v[144:147]
v_exp_f32 v91, v91
v_mfma_f32_16x16x32_bf16 v[144:147], a[180:183], v[76:79], v[144:147]
v_exp_f32 v104, v104
v_mfma_f32_16x16x32_bf16 v[144:147], a[176:179], v[72:75], v[144:147]
s_waitcnt lgkmcnt(2)
v_exp_f32 v105, v105
v_mfma_f32_16x16x32_bf16 v[148:151], a[192:195], v[72:75], v[228:231]
v_cvt_pk_bf16_f32 v159, v102, v103
v_cvt_pk_bf16_f32 v168, v88, v89
v_mfma_f32_16x16x32_bf16 v[148:151], a[196:199], v[76:79], v[148:151]
s_waitcnt lgkmcnt(0)
v_exp_f32 v106, v106
v_mfma_f32_16x16x32_bf16 v[148:151], a[200:203], v[80:83], v[148:151]
v_exp_f32 v107, v107
v_mfma_f32_16x16x32_bf16 v[148:151], a[204:207], v[84:87], v[148:151]
buffer_load_dwordx4 v16, s[32:35], s64 offen offset:1024 sc1 lds
v_mfma_f32_16x16x32_bf16 v[132:135], a[204:207], v[68:71], v[224:227]
v_exp_f32 v120, v120
v_mfma_f32_16x16x32_bf16 v[132:135], a[200:203], v[64:67], v[132:135]
v_cvt_pk_bf16_f32 v169, v90, v91
v_cvt_pk_bf16_f32 v176, v104, v105
v_mfma_f32_16x16x32_bf16 v[132:135], a[196:199], v[60:63], v[132:135]
v_exp_f32 v121, v121
v_mfma_f32_16x16x32_bf16 v[132:135], a[192:195], v[56:59], v[132:135]
s_branch L_po15
L_pg15:
s_branch L_pg20
L_po15:
v_exp_f32 v122, v122
v_mfma_f32_16x16x32_bf16 v[116:119], a[192:195], v[40:43], v[220:223]
v_exp_f32 v123, v123
v_mfma_f32_16x16x32_bf16 v[116:119], a[196:199], v[44:47], v[116:119]
v_exp_f32 v136, v136
v_mfma_f32_16x16x32_bf16 v[116:119], a[200:203], v[48:51], v[116:119]
v_exp_f32 v137, v137
v_mfma_f32_16x16x32_bf16 v[116:119], a[204:207], v[52:55], v[116:119]
ds_read_b128 a[144:147], v3 offset:16384
v_cvt_pk_bf16_f32 v177, v106, v107
v_mfma_f32_16x16x32_bf16 v[100:103], a[204:207], v[36:39], v[216:219]
v_exp_f32 v138, v138
v_mfma_f32_16x16x32_bf16 v[100:103], a[200:203], v[32:35], v[100:103]
ds_read_b128 a[148:151], v3 offset:24576
v_cvt_pk_bf16_f32 v200, v120, v121
v_mfma_f32_16x16x32_bf16 v[100:103], a[196:199], v[28:31], v[100:103]
v_exp_f32 v139, v139
v_mfma_f32_16x16x32_bf16 v[100:103], a[192:195], v[24:27], v[100:103]
v_exp_f32 v140, v140
v_smfmac_f32_16x16x64_bf16 a[128:131], a[240:243], v[152:159], v5
v_cvt_pk_bf16_f32 v201, v122, v123
v_smfmac_f32_16x16x64_bf16 a[132:135], a[240:243], v[160:167], v5
v_exp_f32 v141, v141
v_smfmac_f32_16x16x64_bf16 a[136:139], a[240:243], v[184:191], v5
v_exp_f32 v142, v142
v_smfmac_f32_16x16x64_bf16 a[140:143], a[240:243], v[192:199], v5
s_waitcnt lgkmcnt(0)
buffer_load_dwordx4 v16, s[32:35], s64 offen offset:2048 sc1 lds
v_cvt_pk_bf16_f32 v208, v136, v137
v_mfma_f32_16x16x32_bf16 a[0:3], a[144:147], v[152:155], 0
ds_read_b128 a[152:155], v3 offset:17408
v_exp_f32 v143, v143
v_mfma_f32_16x16x32_bf16 a[0:3], a[148:151], v[156:159], a[0:3]
ds_read_b128 a[156:159], v3 offset:25600
v_exp_f32 v124, v124
v_mfma_f32_16x16x32_bf16 a[32:35], a[148:151], v[164:167], 0
v_cvt_pk_bf16_f32 v209, v138, v139
v_exp_f32 v125, v125
v_mfma_f32_16x16x32_bf16 a[32:35], a[144:147], v[160:163], a[32:35]
v_exp_f32 v126, v126
v_mfma_f32_16x16x32_bf16 a[64:67], a[144:147], v[184:187], 0
v_exp_f32 v127, v127
v_mfma_f32_16x16x32_bf16 a[64:67], a[148:151], v[188:191], a[64:67]
v_cvt_pk_bf16_f32 v210, v140, v141
v_cvt_pk_bf16_f32 v211, v142, v143
v_mfma_f32_16x16x32_bf16 a[96:99], a[148:151], v[196:199], 0
v_exp_f32 v108, v108
v_mfma_f32_16x16x32_bf16 a[96:99], a[144:147], v[192:195], a[96:99]
s_waitcnt lgkmcnt(0)
v_exp_f32 v109, v109
v_mfma_f32_16x16x32_bf16 a[100:103], a[152:155], v[192:195], 0
ds_read_b128 a[160:163], v3 offset:18432
v_cvt_pk_bf16_f32 v202, v124, v125
v_mfma_f32_16x16x32_bf16 a[100:103], a[156:159], v[196:199], a[100:103]
ds_read_b128 a[164:167], v3 offset:26624
v_exp_f32 v110, v110
v_mfma_f32_16x16x32_bf16 a[68:71], a[156:159], v[188:191], 0
v_exp_f32 v111, v111
v_mfma_f32_16x16x32_bf16 a[68:71], a[152:155], v[184:187], a[68:71]
v_exp_f32 v92, v92
v_mfma_f32_16x16x32_bf16 a[36:39], a[152:155], v[160:163], 0
v_exp_f32 v93, v93
v_mfma_f32_16x16x32_bf16 a[36:39], a[156:159], v[164:167], a[36:39]
v_cvt_pk_bf16_f32 v203, v126, v127
v_cvt_pk_bf16_f32 v178, v108, v109
v_mfma_f32_16x16x32_bf16 a[4:7], a[156:159], v[156:159], 0
buffer_load_dwordx4 v16, s[32:35], s64 offen offset:3072 sc1 lds
v_mfma_f32_16x16x32_bf16 a[4:7], a[152:155], v[152:155], a[4:7]
s_waitcnt lgkmcnt(0)
v_exp_f32 v94, v94
v_mfma_f32_16x16x32_bf16 a[8:11], a[160:163], v[152:155], 0
ds_read_b128 a[168:171], v3 offset:19456
v_cvt_pk_bf16_f32 v179, v110, v111
v_mfma_f32_16x16x32_bf16 a[8:11], a[164:167], v[156:159], a[8:11]
ds_read_b128 a[172:175], v3 offset:27648
v_exp_f32 v95, v95
v_mfma_f32_16x16x32_bf16 a[40:43], a[164:167], v[164:167], 0
v_exp_f32 v96, v96
v_mfma_f32_16x16x32_bf16 a[40:43], a[160:163], v[160:163], a[40:43]
v_exp_f32 v97, v97
v_mfma_f32_16x16x32_bf16 a[72:75], a[160:163], v[184:187], 0
v_exp_f32 v98, v98
v_mfma_f32_16x16x32_bf16 a[72:75], a[164:167], v[188:191], a[72:75]
v_exp_f32 v99, v99
v_mfma_f32_16x16x32_bf16 a[104:107], a[164:167], v[196:199], 0
ds_read_b128 a[176:179], v3 offset:20480
v_cvt_pk_bf16_f32 v170, v92, v93
v_mfma_f32_16x16x32_bf16 a[104:107], a[160:163], v[192:195], a[104:107]
s_waitcnt lgkmcnt(1)
v_exp_f32 v112, v112
v_mfma_f32_16x16x32_bf16 a[108:111], a[168:171], v[192:195], 0
v_exp_f32 v113, v113
v_mfma_f32_16x16x32_bf16 a[108:111], a[172:175], v[196:199], a[108:111]
ds_read_b128 a[180:183], v3 offset:28672
v_cvt_pk_bf16_f32 v171, v94, v95
v_mfma_f32_16x16x32_bf16 a[76:79], a[172:175], v[188:191], 0
v_exp_f32 v114, v114
v_mfma_f32_16x16x32_bf16 a[76:79], a[168:171], v[184:187], a[76:79]
v_cvt_pk_bf16_f32 v172, v96, v97
v_xor_b32 v2, 0x8000, v2
v_mfma_f32_16x16x32_bf16 a[44:47], a[168:171], v[160:163], 0
ds_read_b128 a[184:187], v3 offset:21504
ds_read_b128 a[188:191], v3 offset:29696
ds_read_b128 a[192:195], v3 offset:22528
ds_read_b128 a[196:199], v3 offset:30720
ds_read_b128 a[200:203], v3 offset:23552
ds_read_b128 a[204:207], v3 offset:31744
v_exp_f32 v115, v115
v_mfma_f32_16x16x32_bf16 a[44:47], a[172:175], v[164:167], a[44:47]
s_waitcnt vmcnt(8)
s_barrier
v_exp_f32 v128, v128
v_mfma_f32_16x16x32_bf16 a[12:15], a[172:175], v[156:159], 0
v_cvt_pk_bf16_f32 v173, v98, v99
v_cvt_pk_bf16_f32 v180, v112, v113
v_mfma_f32_16x16x32_bf16 a[12:15], a[168:171], v[152:155], a[12:15]
s_waitcnt lgkmcnt(6)
v_exp_f32 v129, v129
v_mfma_f32_16x16x32_bf16 a[16:19], a[176:179], v[152:155], 0
v_exp_f32 v130, v130
v_mfma_f32_16x16x32_bf16 a[16:19], a[180:183], v[156:159], a[16:19]
s_xor_b32 s71, s71, 49152
v_exp_f32 v131, v131
v_mfma_f32_16x16x32_bf16 a[48:51], a[180:183], v[164:167], 0
s_add_u32 s70, s70, 32768
v_exp_f32 v144, v144
v_mfma_f32_16x16x32_bf16 a[48:51], a[176:179], v[160:163], a[48:51]
s_mov_b32 m0, s71
v_exp_f32 v145, v145
v_mfma_f32_16x16x32_bf16 a[80:83], a[176:179], v[184:187], 0
buffer_load_dwordx4 v16, s[32:35], s70 offen offset:0 sc1 lds
v_cvt_pk_bf16_f32 v181, v114, v115
v_mfma_f32_16x16x32_bf16 a[80:83], a[180:183], v[188:191], a[80:83]
v_exp_f32 v146, v146
v_mfma_f32_16x16x32_bf16 a[112:115], a[180:183], v[196:199], 0
v_exp_f32 v147, v147
v_mfma_f32_16x16x32_bf16 a[112:115], a[176:179], v[192:195], a[112:115]
s_waitcnt lgkmcnt(0)
v_cvt_pk_bf16_f32 v204, v128, v129
v_cvt_pk_bf16_f32 v205, v130, v131
v_mfma_f32_16x16x32_bf16 a[116:119], a[184:187], v[192:195], 0
v_exp_f32 v148, v148
v_mfma_f32_16x16x32_bf16 a[116:119], a[188:191], v[196:199], a[116:119]
v_exp_f32 v149, v149
v_mfma_f32_16x16x32_bf16 a[84:87], a[188:191], v[188:191], 0
v_exp_f32 v150, v150
v_mfma_f32_16x16x32_bf16 a[84:87], a[184:187], v[184:187], a[84:87]
v_exp_f32 v151, v151
v_mfma_f32_16x16x32_bf16 a[52:55], a[184:187], v[160:163], 0
v_cvt_pk_bf16_f32 v212, v144, v145
v_cvt_pk_bf16_f32 v213, v146, v147
v_mfma_f32_16x16x32_bf16 a[52:55], a[188:191], v[164:167], a[52:55]
v_exp_f32 v132, v132
v_mfma_f32_16x16x32_bf16 a[20:23], a[188:191], v[156:159], 0
v_exp_f32 v133, v133
v_mfma_f32_16x16x32_bf16 a[20:23], a[184:187], v[152:155], a[20:23]
ds_read_b128 a[144:147], v2 offset:0
v_lshl_add_u32 v19, v0, 24, s66
v_mfma_f32_16x16x32_bf16 a[24:27], a[192:195], v[152:155], 0
s_lshr_b32 s67, s31, 4
v_exp_f32 v134, v134
v_mfma_f32_16x16x32_bf16 a[24:27], a[196:199], v[156:159], a[24:27]
s_lshl1_add_u32 s67, s3, s67
v_exp_f32 v135, v135
v_mfma_f32_16x16x32_bf16 a[56:59], a[196:199], v[164:167], 0
s_lshl_b32 s79, s67, 8
v_cvt_pk_bf16_f32 v214, v148, v149
v_cvt_pk_bf16_f32 v215, v150, v151
v_mfma_f32_16x16x32_bf16 a[56:59], a[192:195], v[160:163], a[56:59]
s_add_u32 s79, s79, 8192
buffer_load_dwordx4 v16, s[32:35], s70 offen offset:1024 sc1 lds
v_mfma_f32_16x16x32_bf16 a[88:91], a[192:195], v[184:187], 0
s_add_u32 s69, s31, 12
v_exp_f32 v116, v116
v_mfma_f32_16x16x32_bf16 a[88:91], a[196:199], v[188:191], a[88:91]
s_lshr_b32 s69, s69, 5
v_exp_f32 v117, v117
v_mfma_f32_16x16x32_bf16 a[120:123], a[196:199], v[196:199], 0
s_lshl1_add_u32 s69, s3, s69
v_exp_f32 v118, v118
v_mfma_f32_16x16x32_bf16 a[120:123], a[192:195], v[192:195], a[120:123]
s_lshl_b32 s69, s69, 8
v_cvt_pk_bf16_f32 v206, v132, v133
v_cvt_pk_bf16_f32 v207, v134, v135
v_mfma_f32_16x16x32_bf16 a[124:127], a[200:203], v[192:195], 0
s_add_u32 s69, s69, 8192
v_exp_f32 v119, v119
v_mfma_f32_16x16x32_bf16 a[124:127], a[204:207], v[196:199], a[124:127]
s_lshl_b32 s67, s73, 16
v_exp_f32 v100, v100
v_mfma_f32_16x16x32_bf16 a[92:95], a[204:207], v[188:191], 0
s_xor_b32 s68, s80, 256
v_exp_f32 v101, v101
v_mfma_f32_16x16x32_bf16 a[92:95], a[200:203], v[184:187], a[92:95]
s_add_u32 s68, s68, s67
ds_read_b128 a[148:151], v2 offset:1024
v_cvt_pk_bf16_f32 v182, v116, v117
v_mfma_f32_16x16x32_bf16 a[60:63], a[200:203], v[160:163], 0
ds_read_b128 a[152:155], v2 offset:2048
v_exp_f32 v102, v102
v_mfma_f32_16x16x32_bf16 a[60:63], a[204:207], v[164:167], a[60:63]
s_add_u32 s67, s67, s69
ds_read_b128 a[156:159], v2 offset:3072
v_cvt_pk_bf16_f32 v183, v118, v119
v_mfma_f32_16x16x32_bf16 a[28:31], a[204:207], v[156:159], 0
s_mov_b64 exec, 1
buffer_atomic_add a251, v19, s[52:55], s67 offen offset:0 sc1
buffer_atomic_add a251, v19, s[52:55], s68 offen offset:0 sc1
s_mov_b64 exec, -1
v_exp_f32 v103, v103
v_mfma_f32_16x16x32_bf16 a[28:31], a[200:203], v[152:155], a[28:31]
ds_read_b128 a[160:163], v2 offset:4096
ds_read_b128 a[164:167], v2 offset:5120
ds_read_b128 a[168:171], v2 offset:6144
ds_read_b128 a[172:175], v2 offset:7168
v_mul_u32_u24 v19, 52, v0
v_cvt_pk_bf16_f32 v174, v100, v101
v_cvt_pk_bf16_f32 v175, v102, v103
v_xor_b32 v3, 0x8000, v3
s_sub_u32 s72, s3, 1
s_cmp_eq_u32 s72, 0
s_cbranch_scc1 L_DD
L_D:
s_waitcnt lgkmcnt(7)
v_mfma_f32_16x16x32_bf16 v[88:91], a[144:147], v[24:27], v[216:219]
s_waitcnt lgkmcnt(6)
ds_read_b128 a[176:179], v2 offset:8192
v_mfma_f32_16x16x32_bf16 v[88:91], a[148:151], v[28:31], v[88:91]
s_waitcnt lgkmcnt(6)
ds_read_b128 a[180:183], v2 offset:9216
v_mfma_f32_16x16x32_bf16 v[88:91], a[152:155], v[32:35], v[88:91]
s_waitcnt lgkmcnt(6)
buffer_load_dwordx4 v16, s[32:35], s70 offen offset:2048 sc1 lds
v_mfma_f32_16x16x32_bf16 v[88:91], a[156:159], v[36:39], v[88:91]
ds_read_b128 a[184:187], v2 offset:10240
v_mfma_f32_16x16x32_bf16 v[104:107], a[156:159], v[52:55], v[220:223]
v_mfma_f32_16x16x32_bf16 v[104:107], a[152:155], v[48:51], v[104:107]
buffer_load_dword a252, v19, s[40:43], s81 offen
v_mfma_f32_16x16x32_bf16 v[104:107], a[148:151], v[44:47], v[104:107]
ds_read_b128 a[188:191], v2 offset:11264
v_mfma_f32_16x16x32_bf16 v[104:107], a[144:147], v[40:43], v[104:107]
v_mfma_f32_16x16x32_bf16 v[120:123], a[144:147], v[56:59], v[224:227]
v_mfma_f32_16x16x32_bf16 v[120:123], a[148:151], v[60:63], v[120:123]
v_mfma_f32_16x16x32_bf16 v[120:123], a[152:155], v[64:67], v[120:123]
v_exp_f32 v88, v88
v_mfma_f32_16x16x32_bf16 v[120:123], a[156:159], v[68:71], v[120:123]
v_exp_f32 v89, v89
v_mfma_f32_16x16x32_bf16 v[136:139], a[156:159], v[84:87], v[228:231]
v_exp_f32 v90, v90
v_mfma_f32_16x16x32_bf16 v[136:139], a[152:155], v[80:83], v[136:139]
v_exp_f32 v91, v91
v_mfma_f32_16x16x32_bf16 v[136:139], a[148:151], v[76:79], v[136:139]
v_exp_f32 v104, v104
v_mfma_f32_16x16x32_bf16 v[136:139], a[144:147], v[72:75], v[136:139]
s_waitcnt lgkmcnt(0)
s_add_u32 s81, s81, 425984
v_exp_f32 v105, v105
v_mfma_f32_16x16x32_bf16 v[140:143], a[160:163], v[72:75], v[228:231]
v_exp_f32 v106, v106
v_mfma_f32_16x16x32_bf16 v[140:143], a[164:167], v[76:79], v[140:143]
buffer_load_dwordx4 v16, s[32:35], s70 offen offset:3072 sc1 lds
v_mfma_f32_16x16x32_bf16 v[140:143], a[168:171], v[80:83], v[140:143]
v_exp_f32 v107, v107
v_mfma_f32_16x16x32_bf16 v[140:143], a[172:175], v[84:87], v[140:143]
v_cvt_pk_bf16_f32 v152, v88, v89
v_cvt_pk_bf16_f32 v153, v90, v91
v_mfma_f32_16x16x32_bf16 v[124:127], a[172:175], v[68:71], v[224:227]
v_exp_f32 v120, v120
v_mfma_f32_16x16x32_bf16 v[124:127], a[168:171], v[64:67], v[124:127]
v_exp_f32 v121, v121
v_mfma_f32_16x16x32_bf16 v[124:127], a[164:167], v[60:63], v[124:127]
v_exp_f32 v122, v122
v_mfma_f32_16x16x32_bf16 v[124:127], a[160:163], v[56:59], v[124:127]
v_exp_f32 v123, v123
v_mfma_f32_16x16x32_bf16 v[108:111], a[160:163], v[40:43], v[220:223]
v_exp_f32 v136, v136
v_mfma_f32_16x16x32_bf16 v[108:111], a[164:167], v[44:47], v[108:111]
v_exp_f32 v137, v137
v_mfma_f32_16x16x32_bf16 v[108:111], a[168:171], v[48:51], v[108:111]
v_exp_f32 v138, v138
v_mfma_f32_16x16x32_bf16 v[108:111], a[172:175], v[52:55], v[108:111]
v_cvt_pk_bf16_f32 v160, v104, v105
v_cvt_pk_bf16_f32 v161, v106, v107
v_mfma_f32_16x16x32_bf16 v[92:95], a[172:175], v[36:39], v[216:219]
v_exp_f32 v139, v139
v_mfma_f32_16x16x32_bf16 v[92:95], a[168:171], v[32:35], v[92:95]
ds_read_b128 a[192:195], v2 offset:12288
v_cvt_pk_bf16_f32 v184, v120, v121
v_mfma_f32_16x16x32_bf16 v[92:95], a[164:167], v[28:31], v[92:95]
v_exp_f32 v140, v140
v_mfma_f32_16x16x32_bf16 v[92:95], a[160:163], v[24:27], v[92:95]
s_add_u32 m0, s71, 4096
ds_read_b128 a[196:199], v2 offset:13312
v_cvt_pk_bf16_f32 v185, v122, v123
v_mfma_f32_16x16x32_bf16 v[96:99], a[176:179], v[24:27], v[216:219]
s_add_u32 s64, s70, 4096
ds_read_b128 a[200:203], v2 offset:14336
v_cvt_pk_bf16_f32 v192, v136, v137
v_mfma_f32_16x16x32_bf16 v[96:99], a[180:183], v[28:31], v[96:99]
buffer_load_dwordx4 v16, s[32:35], s64 offen offset:0 sc1 lds
v_mfma_f32_16x16x32_bf16 v[96:99], a[184:187], v[32:35], v[96:99]
v_exp_f32 v141, v141
v_mfma_f32_16x16x32_bf16 v[96:99], a[188:191], v[36:39], v[96:99]
ds_read_b128 a[204:207], v2 offset:15360
v_cvt_pk_bf16_f32 v193, v138, v139
v_mfma_f32_16x16x32_bf16 v[112:115], a[188:191], v[52:55], v[220:223]
v_exp_f32 v142, v142
v_mfma_f32_16x16x32_bf16 v[112:115], a[184:187], v[48:51], v[112:115]
v_exp_f32 v143, v143
v_mfma_f32_16x16x32_bf16 v[112:115], a[180:183], v[44:47], v[112:115]
v_exp_f32 v124, v124
v_mfma_f32_16x16x32_bf16 v[112:115], a[176:179], v[40:43], v[112:115]
v_exp_f32 v125, v125
v_mfma_f32_16x16x32_bf16 v[128:131], a[176:179], v[56:59], v[224:227]
v_exp_f32 v126, v126
v_mfma_f32_16x16x32_bf16 v[128:131], a[180:183], v[60:63], v[128:131]
v_exp_f32 v127, v127
v_mfma_f32_16x16x32_bf16 v[128:131], a[184:187], v[64:67], v[128:131]
v_exp_f32 v108, v108
v_mfma_f32_16x16x32_bf16 v[128:131], a[188:191], v[68:71], v[128:131]
v_exp_f32 v109, v109
v_mfma_f32_16x16x32_bf16 v[144:147], a[188:191], v[84:87], v[228:231]
v_exp_f32 v110, v110
v_mfma_f32_16x16x32_bf16 v[144:147], a[184:187], v[80:83], v[144:147]
ds_read_b128 a[144:147], v3 offset:0
v_cvt_pk_bf16_f32 v194, v140, v141
v_mfma_f32_16x16x32_bf16 v[144:147], a[180:183], v[76:79], v[144:147]
ds_read_b128 a[148:151], v3 offset:8192
v_cvt_pk_bf16_f32 v195, v142, v143
v_mfma_f32_16x16x32_bf16 v[144:147], a[176:179], v[72:75], v[144:147]
s_waitcnt lgkmcnt(2)
v_exp_f32 v111, v111
v_mfma_f32_16x16x32_bf16 v[148:151], a[192:195], v[72:75], v[228:231]
buffer_load_dwordx4 v16, s[32:35], s64 offen offset:1024 sc1 lds
v_mfma_f32_16x16x32_bf16 v[148:151], a[196:199], v[76:79], v[148:151]
v_exp_f32 v92, v92
v_mfma_f32_16x16x32_bf16 v[148:151], a[200:203], v[80:83], v[148:151]
v_exp_f32 v93, v93
v_mfma_f32_16x16x32_bf16 v[148:151], a[204:207], v[84:87], v[148:151]
v_exp_f32 v94, v94
v_mfma_f32_16x16x32_bf16 v[132:135], a[204:207], v[68:71], v[224:227]
ds_read_b128 a[152:155], v3 offset:1024
v_cvt_pk_bf16_f32 v186, v124, v125
v_mfma_f32_16x16x32_bf16 v[132:135], a[200:203], v[64:67], v[132:135]
ds_read_b128 a[156:159], v3 offset:9216
v_cvt_pk_bf16_f32 v187, v126, v127
v_mfma_f32_16x16x32_bf16 v[132:135], a[196:199], v[60:63], v[132:135]
v_exp_f32 v95, v95
v_mfma_f32_16x16x32_bf16 v[132:135], a[192:195], v[56:59], v[132:135]
v_exp_f32 v96, v96
v_mfma_f32_16x16x32_bf16 v[116:119], a[192:195], v[40:43], v[220:223]
v_exp_f32 v97, v97
v_mfma_f32_16x16x32_bf16 v[116:119], a[196:199], v[44:47], v[116:119]
v_exp_f32 v98, v98
v_mfma_f32_16x16x32_bf16 v[116:119], a[200:203], v[48:51], v[116:119]
ds_read_b128 a[160:163], v3 offset:2048
v_cvt_pk_bf16_f32 v162, v108, v109
v_mfma_f32_16x16x32_bf16 v[116:119], a[204:207], v[52:55], v[116:119]
v_exp_f32 v99, v99
v_mfma_f32_16x16x32_bf16 v[100:103], a[204:207], v[36:39], v[216:219]
ds_read_b128 a[164:167], v3 offset:10240
v_cvt_pk_bf16_f32 v163, v110, v111
v_mfma_f32_16x16x32_bf16 v[100:103], a[200:203], v[32:35], v[100:103]
v_exp_f32 v112, v112
v_mfma_f32_16x16x32_bf16 v[100:103], a[196:199], v[28:31], v[100:103]
v_exp_f32 v113, v113
v_mfma_f32_16x16x32_bf16 v[100:103], a[192:195], v[24:27], v[100:103]
v_exp_f32 v114, v114
v_smfmac_f32_16x16x64_bf16 a[128:131], a[240:243], v[168:175], v5
ds_read_b128 a[168:171], v3 offset:3072
v_smfmac_f32_16x16x64_bf16 a[132:135], a[240:243], v[176:183], v5
ds_read_b128 a[172:175], v3 offset:11264
v_smfmac_f32_16x16x64_bf16 a[136:139], a[240:243], v[200:207], v5
ds_read_b128 a[176:179], v3 offset:4096
v_smfmac_f32_16x16x64_bf16 a[140:143], a[240:243], v[208:215], v5
s_waitcnt lgkmcnt(3)
buffer_load_dwordx4 v16, s[32:35], s64 offen offset:2048 sc1 lds
v_mfma_f32_16x16x32_bf16 a[0:3], a[144:147], v[168:171], a[0:3]
v_exp_f32 v115, v115
v_mfma_f32_16x16x32_bf16 a[0:3], a[148:151], v[172:175], a[0:3]
v_exp_f32 v128, v128
v_mfma_f32_16x16x32_bf16 a[32:35], a[148:151], v[180:183], a[32:35]
v_exp_f32 v129, v129
v_mfma_f32_16x16x32_bf16 a[32:35], a[144:147], v[176:179], a[32:35]
v_exp_f32 v130, v130
v_mfma_f32_16x16x32_bf16 a[64:67], a[144:147], v[200:203], a[64:67]
v_exp_f32 v131, v131
v_mfma_f32_16x16x32_bf16 a[64:67], a[148:151], v[204:207], a[64:67]
v_cvt_pk_bf16_f32 v154, v92, v93
v_cvt_pk_bf16_f32 v155, v94, v95
v_mfma_f32_16x16x32_bf16 a[96:99], a[148:151], v[212:215], a[96:99]
v_exp_f32 v144, v144
v_mfma_f32_16x16x32_bf16 a[96:99], a[144:147], v[208:211], a[96:99]
ds_read_b128 a[180:183], v3 offset:12288
v_cvt_pk_bf16_f32 v156, v96, v97
v_mfma_f32_16x16x32_bf16 a[100:103], a[152:155], v[208:211], a[100:103]
v_exp_f32 v145, v145
v_mfma_f32_16x16x32_bf16 a[100:103], a[156:159], v[212:215], a[100:103]
ds_read_b128 a[184:187], v3 offset:5120
v_cvt_pk_bf16_f32 v157, v98, v99
v_mfma_f32_16x16x32_bf16 a[68:71], a[156:159], v[204:207], a[68:71]
ds_read_b128 a[188:191], v3 offset:13312
v_cvt_pk_bf16_f32 v164, v112, v113
v_mfma_f32_16x16x32_bf16 a[68:71], a[152:155], v[200:203], a[68:71]
buffer_load_dwordx4 v16, s[32:35], s64 offen offset:3072 sc1 lds
v_mfma_f32_16x16x32_bf16 a[36:39], a[152:155], v[176:179], a[36:39]
ds_read_b128 a[192:195], v3 offset:6144
v_cvt_pk_bf16_f32 v165, v114, v115
v_mfma_f32_16x16x32_bf16 a[36:39], a[156:159], v[180:183], a[36:39]
ds_read_b128 a[196:199], v3 offset:14336
v_cvt_pk_bf16_f32 v188, v128, v129
v_mfma_f32_16x16x32_bf16 a[4:7], a[156:159], v[172:175], a[4:7]
ds_read_b128 a[200:203], v3 offset:7168
v_cvt_pk_bf16_f32 v189, v130, v131
v_mfma_f32_16x16x32_bf16 a[4:7], a[152:155], v[168:171], a[4:7]
v_exp_f32 v146, v146
v_mfma_f32_16x16x32_bf16 a[8:11], a[160:163], v[168:171], a[8:11]
v_exp_f32 v147, v147
v_mfma_f32_16x16x32_bf16 a[8:11], a[164:167], v[172:175], a[8:11]
v_exp_f32 v148, v148
v_mfma_f32_16x16x32_bf16 a[40:43], a[164:167], v[180:183], a[40:43]
ds_read_b128 a[204:207], v3 offset:15360
v_cvt_pk_bf16_f32 v196, v144, v145
v_mfma_f32_16x16x32_bf16 a[40:43], a[160:163], v[176:179], a[40:43]
v_exp_f32 v149, v149
v_mfma_f32_16x16x32_bf16 a[72:75], a[160:163], v[200:203], a[72:75]
v_exp_f32 v150, v150
v_mfma_f32_16x16x32_bf16 a[72:75], a[164:167], v[204:207], a[72:75]
v_exp_f32 v151, v151
v_mfma_f32_16x16x32_bf16 a[104:107], a[164:167], v[212:215], a[104:107]
v_exp_f32 v132, v132
v_mfma_f32_16x16x32_bf16 a[104:107], a[160:163], v[208:211], a[104:107]
s_waitcnt lgkmcnt(1)
v_exp_f32 v133, v133
v_mfma_f32_16x16x32_bf16 a[108:111], a[168:171], v[208:211], a[108:111]
v_exp_f32 v134, v134
v_mfma_f32_16x16x32_bf16 a[108:111], a[172:175], v[212:215], a[108:111]
v_exp_f32 v135, v135
v_mfma_f32_16x16x32_bf16 a[76:79], a[172:175], v[204:207], a[76:79]
v_exp_f32 v116, v116
v_mfma_f32_16x16x32_bf16 a[76:79], a[168:171], v[200:203], a[76:79]
v_exp_f32 v117, v117
v_mfma_f32_16x16x32_bf16 a[44:47], a[168:171], v[176:179], a[44:47]
v_exp_f32 v118, v118
v_mfma_f32_16x16x32_bf16 a[44:47], a[172:175], v[180:183], a[44:47]
s_waitcnt vmcnt(9)
s_barrier
v_mfma_f32_16x16x32_bf16 a[12:15], a[172:175], v[172:175], a[12:15]
s_xor_b32 s71, s71, 16384
v_exp_f32 v119, v119
v_mfma_f32_16x16x32_bf16 a[12:15], a[168:171], v[168:171], a[12:15]
s_add_u32 s70, s70, 32768
v_exp_f32 v100, v100
v_mfma_f32_16x16x32_bf16 a[16:19], a[176:179], v[168:171], a[16:19]
s_mov_b32 m0, s71
v_exp_f32 v101, v101
v_mfma_f32_16x16x32_bf16 a[16:19], a[180:183], v[172:175], a[16:19]
buffer_load_dwordx4 v16, s[32:35], s70 offen offset:0 sc1 lds
v_mfma_f32_16x16x32_bf16 a[48:51], a[180:183], v[180:183], a[48:51]
ds_read_b128 a[144:147], v2 offset:16384
v_cvt_pk_bf16_f32 v197, v146, v147
v_mfma_f32_16x16x32_bf16 a[48:51], a[176:179], v[176:179], a[48:51]
ds_read_b128 a[148:151], v2 offset:17408
v_cvt_pk_bf16_f32 v198, v148, v149
v_mfma_f32_16x16x32_bf16 a[80:83], a[176:179], v[200:203], a[80:83]
v_exp_f32 v102, v102
v_mfma_f32_16x16x32_bf16 a[80:83], a[180:183], v[204:207], a[80:83]
ds_read_b128 a[152:155], v2 offset:18432
v_cvt_pk_bf16_f32 v199, v150, v151
v_mfma_f32_16x16x32_bf16 a[112:115], a[180:183], v[212:215], a[112:115]
ds_read_b128 a[156:159], v2 offset:19456
v_cvt_pk_bf16_f32 v190, v132, v133
v_mfma_f32_16x16x32_bf16 a[112:115], a[176:179], v[208:211], a[112:115]
v_exp_f32 v103, v103
v_mfma_f32_16x16x32_bf16 a[116:119], a[184:187], v[208:211], a[116:119]
ds_read_b128 a[160:163], v2 offset:20480
v_cvt_pk_bf16_f32 v191, v134, v135
v_mfma_f32_16x16x32_bf16 a[116:119], a[188:191], v[212:215], a[116:119]
ds_read_b128 a[164:167], v2 offset:21504
v_cvt_pk_bf16_f32 v166, v116, v117
v_mfma_f32_16x16x32_bf16 a[84:87], a[188:191], v[204:207], a[84:87]
ds_read_b128 a[168:171], v2 offset:22528
v_cvt_pk_bf16_f32 v167, v118, v119
v_mfma_f32_16x16x32_bf16 a[84:87], a[184:187], v[200:203], a[84:87]
ds_read_b128 a[172:175], v2 offset:23552
v_cvt_pk_bf16_f32 v158, v100, v101
v_mfma_f32_16x16x32_bf16 a[52:55], a[184:187], v[176:179], a[52:55]
v_cvt_pk_bf16_f32 v159, v102, v103
v_mfma_f32_16x16x32_bf16 a[52:55], a[188:191], v[180:183], a[52:55]
v_mfma_f32_16x16x32_bf16 a[20:23], a[188:191], v[172:175], a[20:23]
v_mfma_f32_16x16x32_bf16 a[20:23], a[184:187], v[168:171], a[20:23]
v_mfma_f32_16x16x32_bf16 a[24:27], a[192:195], v[168:171], a[24:27]
buffer_load_dwordx4 v16, s[32:35], s70 offen offset:1024 sc1 lds
v_mfma_f32_16x16x32_bf16 a[24:27], a[196:199], v[172:175], a[24:27]
v_mfma_f32_16x16x32_bf16 a[56:59], a[196:199], v[180:183], a[56:59]
v_mfma_f32_16x16x32_bf16 a[56:59], a[192:195], v[176:179], a[56:59]
v_mfma_f32_16x16x32_bf16 a[88:91], a[192:195], v[200:203], a[88:91]
v_mfma_f32_16x16x32_bf16 a[88:91], a[196:199], v[204:207], a[88:91]
v_mfma_f32_16x16x32_bf16 a[120:123], a[196:199], v[212:215], a[120:123]
v_mfma_f32_16x16x32_bf16 a[120:123], a[192:195], v[208:211], a[120:123]
v_mfma_f32_16x16x32_bf16 a[124:127], a[200:203], v[208:211], a[124:127]
s_waitcnt lgkmcnt(0)
v_mfma_f32_16x16x32_bf16 a[124:127], a[204:207], v[212:215], a[124:127]
v_mfma_f32_16x16x32_bf16 a[92:95], a[204:207], v[204:207], a[92:95]
v_mfma_f32_16x16x32_bf16 a[92:95], a[200:203], v[200:203], a[92:95]
v_mfma_f32_16x16x32_bf16 a[60:63], a[200:203], v[176:179], a[60:63]
v_mfma_f32_16x16x32_bf16 a[60:63], a[204:207], v[180:183], a[60:63]
v_mfma_f32_16x16x32_bf16 a[28:31], a[204:207], v[172:175], a[28:31]
v_mfma_f32_16x16x32_bf16 a[28:31], a[200:203], v[168:171], a[28:31]
v_mfma_f32_16x16x32_bf16 v[88:91], a[144:147], v[24:27], v[216:219]
ds_read_b128 a[176:179], v2 offset:24576
v_mfma_f32_16x16x32_bf16 v[88:91], a[148:151], v[28:31], v[88:91]
ds_read_b128 a[180:183], v2 offset:25600
v_mfma_f32_16x16x32_bf16 v[88:91], a[152:155], v[32:35], v[88:91]
buffer_load_dwordx4 v16, s[32:35], s70 offen offset:2048 sc1 lds
v_mfma_f32_16x16x32_bf16 v[88:91], a[156:159], v[36:39], v[88:91]
ds_read_b128 a[184:187], v2 offset:26624
v_mfma_f32_16x16x32_bf16 v[104:107], a[156:159], v[52:55], v[220:223]
v_mfma_f32_16x16x32_bf16 v[104:107], a[152:155], v[48:51], v[104:107]
v_mfma_f32_16x16x32_bf16 v[104:107], a[148:151], v[44:47], v[104:107]
ds_read_b128 a[188:191], v2 offset:27648
v_mfma_f32_16x16x32_bf16 v[104:107], a[144:147], v[40:43], v[104:107]
v_mfma_f32_16x16x32_bf16 v[120:123], a[144:147], v[56:59], v[224:227]
v_mfma_f32_16x16x32_bf16 v[120:123], a[148:151], v[60:63], v[120:123]
v_mfma_f32_16x16x32_bf16 v[120:123], a[152:155], v[64:67], v[120:123]
v_exp_f32 v88, v88
v_mfma_f32_16x16x32_bf16 v[120:123], a[156:159], v[68:71], v[120:123]
v_exp_f32 v89, v89
v_mfma_f32_16x16x32_bf16 v[136:139], a[156:159], v[84:87], v[228:231]
v_exp_f32 v90, v90
v_mfma_f32_16x16x32_bf16 v[136:139], a[152:155], v[80:83], v[136:139]
v_exp_f32 v91, v91
v_mfma_f32_16x16x32_bf16 v[136:139], a[148:151], v[76:79], v[136:139]
v_exp_f32 v104, v104
v_mfma_f32_16x16x32_bf16 v[136:139], a[144:147], v[72:75], v[136:139]
v_exp_f32 v105, v105
v_mfma_f32_16x16x32_bf16 v[140:143], a[160:163], v[72:75], v[228:231]
v_exp_f32 v106, v106
v_mfma_f32_16x16x32_bf16 v[140:143], a[164:167], v[76:79], v[140:143]
buffer_load_dwordx4 v16, s[32:35], s70 offen offset:3072 sc1 lds
v_mfma_f32_16x16x32_bf16 v[140:143], a[168:171], v[80:83], v[140:143]
v_exp_f32 v107, v107
v_mfma_f32_16x16x32_bf16 v[140:143], a[172:175], v[84:87], v[140:143]
v_cvt_pk_bf16_f32 v168, v88, v89
v_cvt_pk_bf16_f32 v169, v90, v91
v_mfma_f32_16x16x32_bf16 v[124:127], a[172:175], v[68:71], v[224:227]
v_exp_f32 v120, v120
v_mfma_f32_16x16x32_bf16 v[124:127], a[168:171], v[64:67], v[124:127]
v_exp_f32 v121, v121
v_mfma_f32_16x16x32_bf16 v[124:127], a[164:167], v[60:63], v[124:127]
v_exp_f32 v122, v122
v_mfma_f32_16x16x32_bf16 v[124:127], a[160:163], v[56:59], v[124:127]
v_exp_f32 v123, v123
v_mfma_f32_16x16x32_bf16 v[108:111], a[160:163], v[40:43], v[220:223]
v_exp_f32 v136, v136
v_mfma_f32_16x16x32_bf16 v[108:111], a[164:167], v[44:47], v[108:111]
v_exp_f32 v137, v137
v_mfma_f32_16x16x32_bf16 v[108:111], a[168:171], v[48:51], v[108:111]
v_exp_f32 v138, v138
v_mfma_f32_16x16x32_bf16 v[108:111], a[172:175], v[52:55], v[108:111]
v_cvt_pk_bf16_f32 v176, v104, v105
v_cvt_pk_bf16_f32 v177, v106, v107
v_mfma_f32_16x16x32_bf16 v[92:95], a[172:175], v[36:39], v[216:219]
v_exp_f32 v139, v139
v_mfma_f32_16x16x32_bf16 v[92:95], a[168:171], v[32:35], v[92:95]
ds_read_b128 a[192:195], v2 offset:28672
v_cvt_pk_bf16_f32 v200, v120, v121
v_mfma_f32_16x16x32_bf16 v[92:95], a[164:167], v[28:31], v[92:95]
v_exp_f32 v140, v140
v_mfma_f32_16x16x32_bf16 v[92:95], a[160:163], v[24:27], v[92:95]
s_waitcnt lgkmcnt(1)
s_add_u32 m0, s71, 4096
ds_read_b128 a[196:199], v2 offset:29696
v_cvt_pk_bf16_f32 v201, v122, v123
v_mfma_f32_16x16x32_bf16 v[96:99], a[176:179], v[24:27], v[216:219]
s_add_u32 s64, s70, 4096
ds_read_b128 a[200:203], v2 offset:30720
v_cvt_pk_bf16_f32 v208, v136, v137
v_mfma_f32_16x16x32_bf16 v[96:99], a[180:183], v[28:31], v[96:99]
buffer_load_dwordx4 v16, s[32:35], s64 offen offset:0 sc1 lds
v_mfma_f32_16x16x32_bf16 v[96:99], a[184:187], v[32:35], v[96:99]
v_exp_f32 v141, v141
v_mfma_f32_16x16x32_bf16 v[96:99], a[188:191], v[36:39], v[96:99]
ds_read_b128 a[204:207], v2 offset:31744
v_cvt_pk_bf16_f32 v209, v138, v139
v_mfma_f32_16x16x32_bf16 v[112:115], a[188:191], v[52:55], v[220:223]
v_exp_f32 v142, v142
v_mfma_f32_16x16x32_bf16 v[112:115], a[184:187], v[48:51], v[112:115]
v_exp_f32 v143, v143
v_mfma_f32_16x16x32_bf16 v[112:115], a[180:183], v[44:47], v[112:115]
v_exp_f32 v124, v124
v_mfma_f32_16x16x32_bf16 v[112:115], a[176:179], v[40:43], v[112:115]
v_exp_f32 v125, v125
v_mfma_f32_16x16x32_bf16 v[128:131], a[176:179], v[56:59], v[224:227]
v_exp_f32 v126, v126
v_mfma_f32_16x16x32_bf16 v[128:131], a[180:183], v[60:63], v[128:131]
v_exp_f32 v127, v127
v_mfma_f32_16x16x32_bf16 v[128:131], a[184:187], v[64:67], v[128:131]
v_exp_f32 v108, v108
v_mfma_f32_16x16x32_bf16 v[128:131], a[188:191], v[68:71], v[128:131]
v_exp_f32 v109, v109
v_mfma_f32_16x16x32_bf16 v[144:147], a[188:191], v[84:87], v[228:231]
s_branch L_po16
L_pg16:
s_branch L_pg22
L_po16:
v_exp_f32 v110, v110
v_mfma_f32_16x16x32_bf16 v[144:147], a[184:187], v[80:83], v[144:147]
ds_read_b128 a[144:147], v3 offset:16384
v_cvt_pk_bf16_f32 v210, v140, v141
v_mfma_f32_16x16x32_bf16 v[144:147], a[180:183], v[76:79], v[144:147]
ds_read_b128 a[148:151], v3 offset:24576
v_cvt_pk_bf16_f32 v211, v142, v143
v_mfma_f32_16x16x32_bf16 v[144:147], a[176:179], v[72:75], v[144:147]
s_waitcnt lgkmcnt(2)
v_exp_f32 v111, v111
v_mfma_f32_16x16x32_bf16 v[148:151], a[192:195], v[72:75], v[228:231]
buffer_load_dwordx4 v16, s[32:35], s64 offen offset:1024 sc1 lds
v_mfma_f32_16x16x32_bf16 v[148:151], a[196:199], v[76:79], v[148:151]
v_exp_f32 v92, v92
v_mfma_f32_16x16x32_bf16 v[148:151], a[200:203], v[80:83], v[148:151]
v_exp_f32 v93, v93
v_mfma_f32_16x16x32_bf16 v[148:151], a[204:207], v[84:87], v[148:151]
v_exp_f32 v94, v94
v_mfma_f32_16x16x32_bf16 v[132:135], a[204:207], v[68:71], v[224:227]
ds_read_b128 a[152:155], v3 offset:17408
v_cvt_pk_bf16_f32 v202, v124, v125
v_mfma_f32_16x16x32_bf16 v[132:135], a[200:203], v[64:67], v[132:135]
ds_read_b128 a[156:159], v3 offset:25600
v_cvt_pk_bf16_f32 v203, v126, v127
v_mfma_f32_16x16x32_bf16 v[132:135], a[196:199], v[60:63], v[132:135]
v_exp_f32 v95, v95
v_mfma_f32_16x16x32_bf16 v[132:135], a[192:195], v[56:59], v[132:135]
v_exp_f32 v96, v96
v_mfma_f32_16x16x32_bf16 v[116:119], a[192:195], v[40:43], v[220:223]
v_exp_f32 v97, v97
v_mfma_f32_16x16x32_bf16 v[116:119], a[196:199], v[44:47], v[116:119]
v_exp_f32 v98, v98
v_mfma_f32_16x16x32_bf16 v[116:119], a[200:203], v[48:51], v[116:119]
ds_read_b128 a[160:163], v3 offset:18432
v_cvt_pk_bf16_f32 v178, v108, v109
v_mfma_f32_16x16x32_bf16 v[116:119], a[204:207], v[52:55], v[116:119]
v_exp_f32 v99, v99
v_mfma_f32_16x16x32_bf16 v[100:103], a[204:207], v[36:39], v[216:219]
ds_read_b128 a[164:167], v3 offset:26624
v_cvt_pk_bf16_f32 v179, v110, v111
v_mfma_f32_16x16x32_bf16 v[100:103], a[200:203], v[32:35], v[100:103]
v_exp_f32 v112, v112
v_mfma_f32_16x16x32_bf16 v[100:103], a[196:199], v[28:31], v[100:103]
v_exp_f32 v113, v113
v_mfma_f32_16x16x32_bf16 v[100:103], a[192:195], v[24:27], v[100:103]
v_exp_f32 v114, v114
v_smfmac_f32_16x16x64_bf16 a[128:131], a[240:243], v[152:159], v5
ds_read_b128 a[168:171], v3 offset:19456
v_smfmac_f32_16x16x64_bf16 a[132:135], a[240:243], v[160:167], v5
ds_read_b128 a[172:175], v3 offset:27648
v_smfmac_f32_16x16x64_bf16 a[136:139], a[240:243], v[184:191], v5
ds_read_b128 a[176:179], v3 offset:20480
v_smfmac_f32_16x16x64_bf16 a[140:143], a[240:243], v[192:199], v5
s_waitcnt lgkmcnt(3)
buffer_load_dwordx4 v16, s[32:35], s64 offen offset:2048 sc1 lds
v_mfma_f32_16x16x32_bf16 a[0:3], a[144:147], v[152:155], a[0:3]
v_exp_f32 v115, v115
v_mfma_f32_16x16x32_bf16 a[0:3], a[148:151], v[156:159], a[0:3]
v_exp_f32 v128, v128
v_mfma_f32_16x16x32_bf16 a[32:35], a[148:151], v[164:167], a[32:35]
v_exp_f32 v129, v129
v_mfma_f32_16x16x32_bf16 a[32:35], a[144:147], v[160:163], a[32:35]
v_exp_f32 v130, v130
v_mfma_f32_16x16x32_bf16 a[64:67], a[144:147], v[184:187], a[64:67]
v_exp_f32 v131, v131
v_mfma_f32_16x16x32_bf16 a[64:67], a[148:151], v[188:191], a[64:67]
v_cvt_pk_bf16_f32 v170, v92, v93
v_cvt_pk_bf16_f32 v171, v94, v95
v_mfma_f32_16x16x32_bf16 a[96:99], a[148:151], v[196:199], a[96:99]
v_exp_f32 v144, v144
v_mfma_f32_16x16x32_bf16 a[96:99], a[144:147], v[192:195], a[96:99]
ds_read_b128 a[180:183], v3 offset:28672
v_cvt_pk_bf16_f32 v172, v96, v97
v_mfma_f32_16x16x32_bf16 a[100:103], a[152:155], v[192:195], a[100:103]
v_exp_f32 v145, v145
v_mfma_f32_16x16x32_bf16 a[100:103], a[156:159], v[196:199], a[100:103]
ds_read_b128 a[184:187], v3 offset:21504
v_xor_b32 v2, 0x8000, v2
v_mfma_f32_16x16x32_bf16 a[68:71], a[156:159], v[188:191], a[68:71]
ds_read_b128 a[188:191], v3 offset:29696
v_cvt_pk_bf16_f32 v173, v98, v99
v_mfma_f32_16x16x32_bf16 a[68:71], a[152:155], v[184:187], a[68:71]
buffer_load_dwordx4 v16, s[32:35], s64 offen offset:3072 sc1 lds
v_mfma_f32_16x16x32_bf16 a[36:39], a[152:155], v[160:163], a[36:39]
ds_read_b128 a[192:195], v3 offset:22528
v_cvt_pk_bf16_f32 v180, v112, v113
v_mfma_f32_16x16x32_bf16 a[36:39], a[156:159], v[164:167], a[36:39]
ds_read_b128 a[196:199], v3 offset:30720
v_cvt_pk_bf16_f32 v181, v114, v115
v_mfma_f32_16x16x32_bf16 a[4:7], a[156:159], v[156:159], a[4:7]
ds_read_b128 a[200:203], v3 offset:23552
v_cvt_pk_bf16_f32 v204, v128, v129
v_mfma_f32_16x16x32_bf16 a[4:7], a[152:155], v[152:155], a[4:7]
v_exp_f32 v146, v146
v_mfma_f32_16x16x32_bf16 a[8:11], a[160:163], v[152:155], a[8:11]
v_exp_f32 v147, v147
v_mfma_f32_16x16x32_bf16 a[8:11], a[164:167], v[156:159], a[8:11]
v_exp_f32 v148, v148
v_mfma_f32_16x16x32_bf16 a[40:43], a[164:167], v[164:167], a[40:43]
ds_read_b128 a[204:207], v3 offset:31744
v_cvt_pk_bf16_f32 v205, v130, v131
v_mfma_f32_16x16x32_bf16 a[40:43], a[160:163], v[160:163], a[40:43]
v_exp_f32 v149, v149
v_mfma_f32_16x16x32_bf16 a[72:75], a[160:163], v[184:187], a[72:75]
v_exp_f32 v150, v150
v_mfma_f32_16x16x32_bf16 a[72:75], a[164:167], v[188:191], a[72:75]
v_exp_f32 v151, v151
v_mfma_f32_16x16x32_bf16 a[104:107], a[164:167], v[196:199], a[104:107]
v_exp_f32 v132, v132
v_mfma_f32_16x16x32_bf16 a[104:107], a[160:163], v[192:195], a[104:107]
s_waitcnt lgkmcnt(1)
v_exp_f32 v133, v133
v_mfma_f32_16x16x32_bf16 a[108:111], a[168:171], v[192:195], a[108:111]
v_exp_f32 v134, v134
v_mfma_f32_16x16x32_bf16 a[108:111], a[172:175], v[196:199], a[108:111]
v_exp_f32 v135, v135
v_mfma_f32_16x16x32_bf16 a[76:79], a[172:175], v[188:191], a[76:79]
v_exp_f32 v116, v116
v_mfma_f32_16x16x32_bf16 a[76:79], a[168:171], v[184:187], a[76:79]
v_exp_f32 v117, v117
v_mfma_f32_16x16x32_bf16 a[44:47], a[168:171], v[160:163], a[44:47]
v_exp_f32 v118, v118
v_mfma_f32_16x16x32_bf16 a[44:47], a[172:175], v[164:167], a[44:47]
s_waitcnt vmcnt(8)
s_barrier
v_mfma_f32_16x16x32_bf16 a[12:15], a[172:175], v[156:159], a[12:15]
s_xor_b32 s71, s71, 49152
v_exp_f32 v119, v119
v_mfma_f32_16x16x32_bf16 a[12:15], a[168:171], v[152:155], a[12:15]
s_add_u32 s70, s70, 32768
v_exp_f32 v100, v100
v_mfma_f32_16x16x32_bf16 a[16:19], a[176:179], v[152:155], a[16:19]
s_mov_b32 m0, s71
v_exp_f32 v101, v101
v_mfma_f32_16x16x32_bf16 a[16:19], a[180:183], v[156:159], a[16:19]
buffer_load_dwordx4 v16, s[32:35], s70 offen offset:0 sc1 lds
v_mfma_f32_16x16x32_bf16 a[48:51], a[180:183], v[164:167], a[48:51]
ds_read_b128 a[144:147], v2 offset:0
v_cvt_pk_bf16_f32 v212, v144, v145
v_mfma_f32_16x16x32_bf16 a[48:51], a[176:179], v[160:163], a[48:51]
ds_read_b128 a[148:151], v2 offset:1024
v_cvt_pk_bf16_f32 v213, v146, v147
v_mfma_f32_16x16x32_bf16 a[80:83], a[176:179], v[184:187], a[80:83]
v_exp_f32 v102, v102
v_mfma_f32_16x16x32_bf16 a[80:83], a[180:183], v[188:191], a[80:83]
ds_read_b128 a[152:155], v2 offset:2048
v_cvt_pk_bf16_f32 v214, v148, v149
v_mfma_f32_16x16x32_bf16 a[112:115], a[180:183], v[196:199], a[112:115]
ds_read_b128 a[156:159], v2 offset:3072
v_cvt_pk_bf16_f32 v215, v150, v151
v_mfma_f32_16x16x32_bf16 a[112:115], a[176:179], v[192:195], a[112:115]
v_exp_f32 v103, v103
v_mfma_f32_16x16x32_bf16 a[116:119], a[184:187], v[192:195], a[116:119]
ds_read_b128 a[160:163], v2 offset:4096
v_cvt_pk_bf16_f32 v206, v132, v133
v_mfma_f32_16x16x32_bf16 a[116:119], a[188:191], v[196:199], a[116:119]
ds_read_b128 a[164:167], v2 offset:5120
v_cvt_pk_bf16_f32 v207, v134, v135
v_mfma_f32_16x16x32_bf16 a[84:87], a[188:191], v[188:191], a[84:87]
ds_read_b128 a[168:171], v2 offset:6144
v_xor_b32 v3, 0x8000, v3
v_mfma_f32_16x16x32_bf16 a[84:87], a[184:187], v[184:187], a[84:87]
ds_read_b128 a[172:175], v2 offset:7168
v_cvt_pk_bf16_f32 v182, v116, v117
v_mfma_f32_16x16x32_bf16 a[52:55], a[184:187], v[160:163], a[52:55]
v_cvt_pk_bf16_f32 v183, v118, v119
v_cvt_pk_bf16_f32 v174, v100, v101
v_mfma_f32_16x16x32_bf16 a[52:55], a[188:191], v[164:167], a[52:55]
v_cvt_pk_bf16_f32 v175, v102, v103
v_mfma_f32_16x16x32_bf16 a[20:23], a[188:191], v[156:159], a[20:23]
v_mfma_f32_16x16x32_bf16 a[20:23], a[184:187], v[152:155], a[20:23]
v_mfma_f32_16x16x32_bf16 a[24:27], a[192:195], v[152:155], a[24:27]
buffer_load_dwordx4 v16, s[32:35], s70 offen offset:1024 sc1 lds
v_mfma_f32_16x16x32_bf16 a[24:27], a[196:199], v[156:159], a[24:27]
v_mfma_f32_16x16x32_bf16 a[56:59], a[196:199], v[164:167], a[56:59]
v_mfma_f32_16x16x32_bf16 a[56:59], a[192:195], v[160:163], a[56:59]
v_mfma_f32_16x16x32_bf16 a[88:91], a[192:195], v[184:187], a[88:91]
v_mfma_f32_16x16x32_bf16 a[88:91], a[196:199], v[188:191], a[88:91]
v_mfma_f32_16x16x32_bf16 a[120:123], a[196:199], v[196:199], a[120:123]
s_sub_u32 s72, s72, 1
v_mfma_f32_16x16x32_bf16 a[120:123], a[192:195], v[192:195], a[120:123]
v_mfma_f32_16x16x32_bf16 a[124:127], a[200:203], v[192:195], a[124:127]
s_waitcnt lgkmcnt(0)
v_mfma_f32_16x16x32_bf16 a[124:127], a[204:207], v[196:199], a[124:127]
v_mfma_f32_16x16x32_bf16 a[92:95], a[204:207], v[188:191], a[92:95]
s_cmp_lg_u32 s72, 0
v_mfma_f32_16x16x32_bf16 a[92:95], a[200:203], v[184:187], a[92:95]
v_mfma_f32_16x16x32_bf16 a[60:63], a[200:203], v[160:163], a[60:63]
v_mfma_f32_16x16x32_bf16 a[60:63], a[204:207], v[164:167], a[60:63]
v_mfma_f32_16x16x32_bf16 a[28:31], a[204:207], v[156:159], a[28:31]
v_mfma_f32_16x16x32_bf16 a[28:31], a[200:203], v[152:155], a[28:31]
s_cbranch_scc1 L_D
L_DD:
s_waitcnt lgkmcnt(7)
v_mfma_f32_16x16x32_bf16 v[104:107], a[144:147], v[40:43], v[220:223]
s_waitcnt lgkmcnt(6)
ds_read_b128 a[176:179], v2 offset:8192
v_cndmask_b32 v88, v216, v17, s[0:1]
v_mfma_f32_16x16x32_bf16 v[104:107], a[148:151], v[44:47], v[104:107]
s_waitcnt lgkmcnt(6)
ds_read_b128 a[180:183], v2 offset:9216
v_cndmask_b32 v89, v216, v17, s[4:5]
v_mfma_f32_16x16x32_bf16 v[104:107], a[152:155], v[48:51], v[104:107]
s_waitcnt lgkmcnt(6)
buffer_load_dwordx4 v16, s[32:35], s70 offen offset:2048 sc1 lds
v_mfma_f32_16x16x32_bf16 v[104:107], a[156:159], v[52:55], v[104:107]
ds_read_b128 a[184:187], v2 offset:10240
v_cndmask_b32 v90, v216, v17, s[6:7]
v_mfma_f32_16x16x32_bf16 v[120:123], a[156:159], v[68:71], v[224:227]
ds_read_b128 a[188:191], v2 offset:11264
v_cndmask_b32 v91, v216, v17, s[8:9]
v_mfma_f32_16x16x32_bf16 v[120:123], a[152:155], v[64:67], v[120:123]
ds_read_b128 a[192:195], v2 offset:12288
v_cndmask_b32 v92, v216, v17, s[10:11]
v_mfma_f32_16x16x32_bf16 v[120:123], a[148:151], v[60:63], v[120:123]
ds_read_b128 a[196:199], v2 offset:13312
v_cndmask_b32 v93, v216, v17, s[12:13]
v_mfma_f32_16x16x32_bf16 v[120:123], a[144:147], v[56:59], v[120:123]
ds_read_b128 a[200:203], v2 offset:14336
v_cndmask_b32 v94, v216, v17, s[18:19]
v_mfma_f32_16x16x32_bf16 v[136:139], a[144:147], v[72:75], v[228:231]
ds_read_b128 a[204:207], v2 offset:15360
v_cndmask_b32 v95, v216, v17, s[22:23]
v_mfma_f32_16x16x32_bf16 v[136:139], a[148:151], v[76:79], v[136:139]
v_cndmask_b32 v96, v216, v17, s[26:27]
v_cndmask_b32 v97, v216, v17, s[56:57]
v_mfma_f32_16x16x32_bf16 v[136:139], a[152:155], v[80:83], v[136:139]
v_exp_f32 v104, v104
v_mfma_f32_16x16x32_bf16 v[136:139], a[156:159], v[84:87], v[136:139]
v_exp_f32 v105, v105
v_mfma_f32_16x16x32_bf16 v[88:91], a[156:159], v[36:39], v[88:91]
v_exp_f32 v106, v106
v_mfma_f32_16x16x32_bf16 v[88:91], a[152:155], v[32:35], v[88:91]
v_exp_f32 v107, v107
v_mfma_f32_16x16x32_bf16 v[88:91], a[148:151], v[28:31], v[88:91]
v_exp_f32 v120, v120
v_mfma_f32_16x16x32_bf16 v[88:91], a[144:147], v[24:27], v[88:91]
s_waitcnt lgkmcnt(0)
v_exp_f32 v121, v121
v_mfma_f32_16x16x32_bf16 v[140:143], a[160:163], v[72:75], v[228:231]
v_exp_f32 v122, v122
v_mfma_f32_16x16x32_bf16 v[140:143], a[164:167], v[76:79], v[140:143]
buffer_load_dwordx4 v16, s[32:35], s70 offen offset:3072 sc1 lds
v_mfma_f32_16x16x32_bf16 v[140:143], a[168:171], v[80:83], v[140:143]
s_add_u32 m0, s86, 131072
v_exp_f32 v123, v123
v_mfma_f32_16x16x32_bf16 v[140:143], a[172:175], v[84:87], v[140:143]
s_add_u32 s64, s85, 0
v_cvt_pk_bf16_f32 v160, v104, v105
v_cvt_pk_bf16_f32 v161, v106, v107
v_mfma_f32_16x16x32_bf16 v[124:127], a[172:175], v[68:71], v[224:227]
buffer_load_dwordx4 v12, s[36:39], s64 offen lds
v_mfma_f32_16x16x32_bf16 v[124:127], a[168:171], v[64:67], v[124:127]
s_add_u32 m0, s86, 132096
v_exp_f32 v136, v136
v_mfma_f32_16x16x32_bf16 v[124:127], a[164:167], v[60:63], v[124:127]
s_add_u32 s64, s85, 8192
v_exp_f32 v137, v137
v_mfma_f32_16x16x32_bf16 v[124:127], a[160:163], v[56:59], v[124:127]
buffer_load_dwordx4 v13, s[36:39], s64 offen lds
v_mfma_f32_16x16x32_bf16 v[108:111], a[160:163], v[40:43], v[220:223]
v_exp_f32 v138, v138
v_mfma_f32_16x16x32_bf16 v[108:111], a[164:167], v[44:47], v[108:111]
ds_read_b128 a[144:147], v3 offset:0
v_cndmask_b32 v98, v216, v17, s[58:59]
v_mfma_f32_16x16x32_bf16 v[108:111], a[168:171], v[48:51], v[108:111]
s_add_u32 m0, s86, 133120
ds_read_b128 a[148:151], v3 offset:8192
v_cndmask_b32 v99, v216, v17, s[60:61]
v_mfma_f32_16x16x32_bf16 v[108:111], a[172:175], v[52:55], v[108:111]
s_add_u32 s64, s85, 16384
v_cvt_pk_bf16_f32 v184, v120, v121
v_cvt_pk_bf16_f32 v185, v122, v123
v_mfma_f32_16x16x32_bf16 v[92:95], a[172:175], v[36:39], v[92:95]
buffer_load_dwordx4 v12, s[36:39], s64 offen lds
v_mfma_f32_16x16x32_bf16 v[92:95], a[168:171], v[32:35], v[92:95]
s_add_u32 m0, s86, 134144
v_exp_f32 v139, v139
v_mfma_f32_16x16x32_bf16 v[92:95], a[164:167], v[28:31], v[92:95]
s_add_u32 s64, s85, 24576
v_exp_f32 v88, v88
v_mfma_f32_16x16x32_bf16 v[92:95], a[160:163], v[24:27], v[92:95]
buffer_load_dwordx4 v13, s[36:39], s64 offen lds
v_mfma_f32_16x16x32_bf16 v[96:99], a[176:179], v[24:27], v[96:99]
s_add_u32 m0, s71, 4096
v_exp_f32 v89, v89
v_mfma_f32_16x16x32_bf16 v[96:99], a[180:183], v[28:31], v[96:99]
s_add_u32 s64, s70, 4096
v_exp_f32 v90, v90
v_mfma_f32_16x16x32_bf16 v[96:99], a[184:187], v[32:35], v[96:99]
buffer_load_dwordx4 v16, s[32:35], s64 offen offset:0 sc1 lds
v_mfma_f32_16x16x32_bf16 v[96:99], a[188:191], v[36:39], v[96:99]
v_cvt_pk_bf16_f32 v192, v136, v137
v_cvt_pk_bf16_f32 v193, v138, v139
v_mfma_f32_16x16x32_bf16 v[112:115], a[188:191], v[52:55], v[220:223]
v_exp_f32 v91, v91
v_mfma_f32_16x16x32_bf16 v[112:115], a[184:187], v[48:51], v[112:115]
v_exp_f32 v140, v140
v_mfma_f32_16x16x32_bf16 v[112:115], a[180:183], v[44:47], v[112:115]
v_exp_f32 v141, v141
v_mfma_f32_16x16x32_bf16 v[112:115], a[176:179], v[40:43], v[112:115]
v_exp_f32 v142, v142
v_mfma_f32_16x16x32_bf16 v[128:131], a[176:179], v[56:59], v[224:227]
v_exp_f32 v143, v143
v_mfma_f32_16x16x32_bf16 v[128:131], a[180:183], v[60:63], v[128:131]
v_exp_f32 v124, v124
v_mfma_f32_16x16x32_bf16 v[128:131], a[184:187], v[64:67], v[128:131]
v_cvt_pk_bf16_f32 v152, v88, v89
v_cvt_pk_bf16_f32 v153, v90, v91
v_mfma_f32_16x16x32_bf16 v[128:131], a[188:191], v[68:71], v[128:131]
v_exp_f32 v125, v125
v_mfma_f32_16x16x32_bf16 v[144:147], a[188:191], v[84:87], v[228:231]
v_exp_f32 v126, v126
v_mfma_f32_16x16x32_bf16 v[144:147], a[184:187], v[80:83], v[144:147]
v_exp_f32 v127, v127
v_mfma_f32_16x16x32_bf16 v[144:147], a[180:183], v[76:79], v[144:147]
v_exp_f32 v108, v108
v_mfma_f32_16x16x32_bf16 v[144:147], a[176:179], v[72:75], v[144:147]
ds_read_b128 a[152:155], v3 offset:1024
v_cndmask_b32 v100, v216, v17, s[62:63]
v_mfma_f32_16x16x32_bf16 v[148:151], a[192:195], v[72:75], v[228:231]
buffer_load_dwordx4 v16, s[32:35], s64 offen offset:1024 sc1 lds
v_mfma_f32_16x16x32_bf16 v[148:151], a[196:199], v[76:79], v[148:151]
ds_read_b128 a[156:159], v3 offset:9216
v_cndmask_b32 v101, v216, v17, s[48:49]
v_mfma_f32_16x16x32_bf16 v[148:151], a[200:203], v[80:83], v[148:151]
v_cvt_pk_bf16_f32 v194, v140, v141
v_cvt_pk_bf16_f32 v195, v142, v143
v_mfma_f32_16x16x32_bf16 v[148:151], a[204:207], v[84:87], v[148:151]
ds_read_b128 a[160:163], v3 offset:2048
v_cndmask_b32 v102, v216, v17, s[50:51]
v_mfma_f32_16x16x32_bf16 v[132:135], a[204:207], v[68:71], v[224:227]
ds_read_b128 a[164:167], v3 offset:10240
v_cndmask_b32 v103, v216, v17, s[100:101]
v_mfma_f32_16x16x32_bf16 v[132:135], a[200:203], v[64:67], v[132:135]
v_exp_f32 v109, v109
v_mfma_f32_16x16x32_bf16 v[132:135], a[196:199], v[60:63], v[132:135]
v_exp_f32 v110, v110
v_mfma_f32_16x16x32_bf16 v[132:135], a[192:195], v[56:59], v[132:135]
v_exp_f32 v111, v111
v_mfma_f32_16x16x32_bf16 v[116:119], a[192:195], v[40:43], v[220:223]
v_exp_f32 v92, v92
v_mfma_f32_16x16x32_bf16 v[116:119], a[196:199], v[44:47], v[116:119]
v_cvt_pk_bf16_f32 v186, v124, v125
v_cvt_pk_bf16_f32 v187, v126, v127
v_mfma_f32_16x16x32_bf16 v[116:119], a[200:203], v[48:51], v[116:119]
v_exp_f32 v93, v93
v_mfma_f32_16x16x32_bf16 v[116:119], a[204:207], v[52:55], v[116:119]
v_exp_f32 v94, v94
v_mfma_f32_16x16x32_bf16 v[100:103], a[204:207], v[36:39], v[100:103]
v_exp_f32 v95, v95
v_mfma_f32_16x16x32_bf16 v[100:103], a[200:203], v[32:35], v[100:103]
v_exp_f32 v96, v96
v_mfma_f32_16x16x32_bf16 v[100:103], a[196:199], v[28:31], v[100:103]
v_exp_f32 v97, v97
v_mfma_f32_16x16x32_bf16 v[100:103], a[192:195], v[24:27], v[100:103]
v_exp_f32 v98, v98
v_smfmac_f32_16x16x64_bf16 a[128:131], a[240:243], v[168:175], v5
ds_read_b128 a[168:171], v3 offset:3072
v_smfmac_f32_16x16x64_bf16 a[132:135], a[240:243], v[176:183], v5
v_cvt_pk_bf16_f32 v162, v108, v109
v_smfmac_f32_16x16x64_bf16 a[136:139], a[240:243], v[200:207], v5
ds_read_b128 a[172:175], v3 offset:11264
v_smfmac_f32_16x16x64_bf16 a[140:143], a[240:243], v[208:215], v5
s_waitcnt lgkmcnt(2)
buffer_load_dwordx4 v16, s[32:35], s64 offen offset:2048 sc1 lds
v_mfma_f32_16x16x32_bf16 a[0:3], a[144:147], v[168:171], a[0:3]
v_exp_f32 v99, v99
v_mfma_f32_16x16x32_bf16 a[0:3], a[148:151], v[172:175], a[0:3]
v_cvt_pk_bf16_f32 v163, v110, v111
v_cvt_pk_bf16_f32 v154, v92, v93
v_mfma_f32_16x16x32_bf16 a[32:35], a[148:151], v[180:183], a[32:35]
v_exp_f32 v112, v112
v_mfma_f32_16x16x32_bf16 a[32:35], a[144:147], v[176:179], a[32:35]
v_exp_f32 v113, v113
v_mfma_f32_16x16x32_bf16 a[64:67], a[144:147], v[200:203], a[64:67]
v_exp_f32 v114, v114
v_mfma_f32_16x16x32_bf16 a[64:67], a[148:151], v[204:207], a[64:67]
v_exp_f32 v115, v115
v_mfma_f32_16x16x32_bf16 a[96:99], a[148:151], v[212:215], a[96:99]
v_exp_f32 v128, v128
v_mfma_f32_16x16x32_bf16 a[96:99], a[144:147], v[208:211], a[96:99]
v_exp_f32 v129, v129
v_mfma_f32_16x16x32_bf16 a[100:103], a[152:155], v[208:211], a[100:103]
v_exp_f32 v130, v130
v_mfma_f32_16x16x32_bf16 a[100:103], a[156:159], v[212:215], a[100:103]
v_cvt_pk_bf16_f32 v155, v94, v95
v_cvt_pk_bf16_f32 v156, v96, v97
v_mfma_f32_16x16x32_bf16 a[68:71], a[156:159], v[204:207], a[68:71]
v_exp_f32 v131, v131
v_mfma_f32_16x16x32_bf16 a[68:71], a[152:155], v[200:203], a[68:71]
buffer_load_dwordx4 v16, s[32:35], s64 offen offset:3072 sc1 lds
v_mfma_f32_16x16x32_bf16 a[36:39], a[152:155], v[176:179], a[36:39]
s_add_u32 m0, s86, 135168
ds_read_b128 a[176:179], v3 offset:4096
v_cvt_pk_bf16_f32 v157, v98, v99
v_mfma_f32_16x16x32_bf16 a[36:39], a[156:159], v[180:183], a[36:39]
s_add_u32 s64, s85, 32768
v_exp_f32 v144, v144
v_mfma_f32_16x16x32_bf16 a[4:7], a[156:159], v[172:175], a[4:7]
buffer_load_dwordx4 v12, s[36:39], s64 offen lds
v_mfma_f32_16x16x32_bf16 a[4:7], a[152:155], v[168:171], a[4:7]
s_add_u32 m0, s86, 136192
ds_read_b128 a[180:183], v3 offset:12288
v_cvt_pk_bf16_f32 v164, v112, v113
v_mfma_f32_16x16x32_bf16 a[8:11], a[160:163], v[168:171], a[8:11]
s_add_u32 s64, s85, 40960
v_exp_f32 v145, v145
v_mfma_f32_16x16x32_bf16 a[8:11], a[164:167], v[172:175], a[8:11]
buffer_load_dwordx4 v13, s[36:39], s64 offen lds
v_mfma_f32_16x16x32_bf16 a[40:43], a[164:167], v[180:183], a[40:43]
ds_read_b128 a[184:187], v3 offset:5120
v_cvt_pk_bf16_f32 v165, v114, v115
v_mfma_f32_16x16x32_bf16 a[40:43], a[160:163], v[176:179], a[40:43]
ds_read_b128 a[188:191], v3 offset:13312
v_cvt_pk_bf16_f32 v188, v128, v129
v_mfma_f32_16x16x32_bf16 a[72:75], a[160:163], v[200:203], a[72:75]
ds_read_b128 a[192:195], v3 offset:6144
v_cvt_pk_bf16_f32 v189, v130, v131
v_mfma_f32_16x16x32_bf16 a[72:75], a[164:167], v[204:207], a[72:75]
ds_read_b128 a[196:199], v3 offset:14336
v_cvt_pk_bf16_f32 v196, v144, v145
v_mfma_f32_16x16x32_bf16 a[104:107], a[164:167], v[212:215], a[104:107]
ds_read_b128 a[200:203], v3 offset:7168
v_mfma_f32_16x16x32_bf16 a[104:107], a[160:163], v[208:211], a[104:107]
s_waitcnt lgkmcnt(5)
s_add_u32 m0, s86, 137216
ds_read_b128 a[204:207], v3 offset:15360
v_mfma_f32_16x16x32_bf16 a[108:111], a[168:171], v[208:211], a[108:111]
s_add_u32 s64, s85, 49152
v_exp_f32 v146, v146
v_mfma_f32_16x16x32_bf16 a[108:111], a[172:175], v[212:215], a[108:111]
buffer_load_dwordx4 v12, s[36:39], s64 offen lds
v_mfma_f32_16x16x32_bf16 a[76:79], a[172:175], v[204:207], a[76:79]
s_add_u32 m0, s86, 138240
v_exp_f32 v147, v147
v_mfma_f32_16x16x32_bf16 a[76:79], a[168:171], v[200:203], a[76:79]
s_add_u32 s64, s85, 57344
v_exp_f32 v148, v148
v_mfma_f32_16x16x32_bf16 a[44:47], a[168:171], v[176:179], a[44:47]
buffer_load_dwordx4 v13, s[36:39], s64 offen lds
v_mfma_f32_16x16x32_bf16 a[44:47], a[172:175], v[180:183], a[44:47]
s_waitcnt vmcnt(16)
s_barrier
v_mfma_f32_16x16x32_bf16 a[12:15], a[172:175], v[172:175], a[12:15]
s_xor_b32 s71, s71, 16384
v_exp_f32 v149, v149
v_mfma_f32_16x16x32_bf16 a[12:15], a[168:171], v[168:171], a[12:15]
s_add_u32 s70, s70, 32768
v_exp_f32 v150, v150
v_mfma_f32_16x16x32_bf16 a[16:19], a[176:179], v[168:171], a[16:19]
s_mov_b32 m0, s71
v_exp_f32 v151, v151
v_mfma_f32_16x16x32_bf16 a[16:19], a[180:183], v[172:175], a[16:19]
buffer_load_dwordx4 v16, s[32:35], s70 offen offset:0 sc1 lds
v_mfma_f32_16x16x32_bf16 a[48:51], a[180:183], v[180:183], a[48:51]
v_exp_f32 v132, v132
v_mfma_f32_16x16x32_bf16 a[48:51], a[176:179], v[176:179], a[48:51]
v_exp_f32 v133, v133
v_mfma_f32_16x16x32_bf16 a[80:83], a[176:179], v[200:203], a[80:83]
v_exp_f32 v134, v134
v_mfma_f32_16x16x32_bf16 a[80:83], a[180:183], v[204:207], a[80:83]
v_exp_f32 v135, v135
v_mfma_f32_16x16x32_bf16 a[112:115], a[180:183], v[212:215], a[112:115]
v_exp_f32 v116, v116
v_mfma_f32_16x16x32_bf16 a[112:115], a[176:179], v[208:211], a[112:115]
s_waitcnt lgkmcnt(0)
v_cvt_pk_bf16_f32 v197, v146, v147
v_cvt_pk_bf16_f32 v198, v148, v149
v_mfma_f32_16x16x32_bf16 a[116:119], a[184:187], v[208:211], a[116:119]
v_exp_f32 v117, v117
v_mfma_f32_16x16x32_bf16 a[116:119], a[188:191], v[212:215], a[116:119]
v_exp_f32 v118, v118
v_mfma_f32_16x16x32_bf16 a[84:87], a[188:191], v[204:207], a[84:87]
v_exp_f32 v119, v119
v_mfma_f32_16x16x32_bf16 a[84:87], a[184:187], v[200:203], a[84:87]
v_exp_f32 v100, v100
v_mfma_f32_16x16x32_bf16 a[52:55], a[184:187], v[176:179], a[52:55]
v_exp_f32 v101, v101
v_mfma_f32_16x16x32_bf16 a[52:55], a[188:191], v[180:183], a[52:55]
ds_read_b128 a[144:147], v2 offset:16384
v_cvt_pk_bf16_f32 v199, v150, v151
v_mfma_f32_16x16x32_bf16 a[20:23], a[188:191], v[172:175], a[20:23]
ds_read_b128 a[148:151], v2 offset:17408
v_cvt_pk_bf16_f32 v190, v132, v133
v_mfma_f32_16x16x32_bf16 a[20:23], a[184:187], v[168:171], a[20:23]
v_exp_f32 v102, v102
v_mfma_f32_16x16x32_bf16 a[24:27], a[192:195], v[168:171], a[24:27]
buffer_load_dwordx4 v16, s[32:35], s70 offen offset:1024 sc1 lds
v_mfma_f32_16x16x32_bf16 a[24:27], a[196:199], v[172:175], a[24:27]
ds_read_b128 a[152:155], v2 offset:18432
v_cvt_pk_bf16_f32 v191, v134, v135
v_mfma_f32_16x16x32_bf16 a[56:59], a[196:199], v[180:183], a[56:59]
ds_read_b128 a[156:159], v2 offset:19456
v_cvt_pk_bf16_f32 v166, v116, v117
v_mfma_f32_16x16x32_bf16 a[56:59], a[192:195], v[176:179], a[56:59]
v_exp_f32 v103, v103
v_mfma_f32_16x16x32_bf16 a[88:91], a[192:195], v[200:203], a[88:91]
ds_read_b128 a[160:163], v2 offset:20480
v_cvt_pk_bf16_f32 v167, v118, v119
v_mfma_f32_16x16x32_bf16 a[88:91], a[196:199], v[204:207], a[88:91]
ds_read_b128 a[164:167], v2 offset:21504
v_cvt_pk_bf16_f32 v158, v100, v101
v_mfma_f32_16x16x32_bf16 a[120:123], a[196:199], v[212:215], a[120:123]
ds_read_b128 a[168:171], v2 offset:22528
v_cvt_pk_bf16_f32 v159, v102, v103
v_mfma_f32_16x16x32_bf16 a[120:123], a[192:195], v[208:211], a[120:123]
ds_read_b128 a[172:175], v2 offset:23552
v_cndmask_b32 v104, v220, v17, s[0:1]
v_mfma_f32_16x16x32_bf16 a[124:127], a[200:203], v[208:211], a[124:127]
v_cndmask_b32 v105, v220, v17, s[4:5]
v_cndmask_b32 v106, v220, v17, s[6:7]
v_mfma_f32_16x16x32_bf16 a[124:127], a[204:207], v[212:215], a[124:127]
v_cndmask_b32 v107, v220, v17, s[8:9]
v_cndmask_b32 v108, v220, v17, s[10:11]
v_mfma_f32_16x16x32_bf16 a[92:95], a[204:207], v[204:207], a[92:95]
v_cndmask_b32 v109, v220, v17, s[12:13]
v_cndmask_b32 v110, v220, v17, s[18:19]
v_mfma_f32_16x16x32_bf16 a[92:95], a[200:203], v[200:203], a[92:95]
v_cndmask_b32 v111, v220, v17, s[22:23]
v_cndmask_b32 v112, v220, v17, s[26:27]
v_mfma_f32_16x16x32_bf16 a[60:63], a[200:203], v[176:179], a[60:63]
v_cndmask_b32 v113, v220, v17, s[56:57]
v_cndmask_b32 v114, v220, v17, s[58:59]
v_mfma_f32_16x16x32_bf16 a[60:63], a[204:207], v[180:183], a[60:63]
v_cndmask_b32 v115, v220, v17, s[60:61]
v_cndmask_b32 v116, v220, v17, s[62:63]
v_mfma_f32_16x16x32_bf16 a[28:31], a[204:207], v[172:175], a[28:31]
v_cndmask_b32 v117, v220, v17, s[48:49]
v_cndmask_b32 v118, v220, v17, s[50:51]
v_mfma_f32_16x16x32_bf16 a[28:31], a[200:203], v[168:171], a[28:31]
s_waitcnt lgkmcnt(0)
v_cndmask_b32 v119, v220, v17, s[100:101]
v_mfma_f32_16x16x32_bf16 v[120:123], a[144:147], v[56:59], v[224:227]
ds_read_b128 a[176:179], v2 offset:24576
v_mfma_f32_16x16x32_bf16 v[120:123], a[148:151], v[60:63], v[120:123]
ds_read_b128 a[180:183], v2 offset:25600
v_mfma_f32_16x16x32_bf16 v[120:123], a[152:155], v[64:67], v[120:123]
buffer_load_dwordx4 v16, s[32:35], s70 offen offset:2048 sc1 lds
v_mfma_f32_16x16x32_bf16 v[120:123], a[156:159], v[68:71], v[120:123]
ds_read_b128 a[184:187], v2 offset:26624
v_mfma_f32_16x16x32_bf16 v[136:139], a[156:159], v[84:87], v[228:231]
ds_read_b128 a[188:191], v2 offset:27648
v_mfma_f32_16x16x32_bf16 v[136:139], a[152:155], v[80:83], v[136:139]
v_mfma_f32_16x16x32_bf16 v[136:139], a[148:151], v[76:79], v[136:139]
v_mfma_f32_16x16x32_bf16 v[136:139], a[144:147], v[72:75], v[136:139]
v_mfma_f32_16x16x32_bf16 v[104:107], a[144:147], v[40:43], v[104:107]
ds_read_b128 a[192:195], v2 offset:28672
v_mfma_f32_16x16x32_bf16 v[104:107], a[148:151], v[44:47], v[104:107]
v_mfma_f32_16x16x32_bf16 v[104:107], a[152:155], v[48:51], v[104:107]
v_exp_f32 v120, v120
v_mfma_f32_16x16x32_bf16 v[104:107], a[156:159], v[52:55], v[104:107]
v_exp_f32 v121, v121
v_mfma_f32_16x16x32_bf16 v[140:143], a[172:175], v[84:87], v[228:231]
v_exp_f32 v122, v122
v_mfma_f32_16x16x32_bf16 v[140:143], a[168:171], v[80:83], v[140:143]
v_exp_f32 v123, v123
v_mfma_f32_16x16x32_bf16 v[140:143], a[164:167], v[76:79], v[140:143]
v_exp_f32 v136, v136
v_mfma_f32_16x16x32_bf16 v[140:143], a[160:163], v[72:75], v[140:143]
buffer_load_dwordx4 v16, s[32:35], s70 offen offset:3072 sc1 lds
v_mfma_f32_16x16x32_bf16 v[124:127], a[160:163], v[56:59], v[224:227]
v_exp_f32 v137, v137
v_mfma_f32_16x16x32_bf16 v[124:127], a[164:167], v[60:63], v[124:127]
v_exp_f32 v138, v138
v_mfma_f32_16x16x32_bf16 v[124:127], a[168:171], v[64:67], v[124:127]
v_exp_f32 v139, v139
v_mfma_f32_16x16x32_bf16 v[124:127], a[172:175], v[68:71], v[124:127]
v_exp_f32 v104, v104
v_mfma_f32_16x16x32_bf16 v[108:111], a[172:175], v[52:55], v[108:111]
v_cvt_pk_bf16_f32 v200, v120, v121
v_cvt_pk_bf16_f32 v201, v122, v123
v_mfma_f32_16x16x32_bf16 v[108:111], a[168:171], v[48:51], v[108:111]
ds_read_b128 a[196:199], v2 offset:29696
v_cvt_pk_bf16_f32 v208, v136, v137
v_mfma_f32_16x16x32_bf16 v[108:111], a[164:167], v[44:47], v[108:111]
ds_read_b128 a[200:203], v2 offset:30720
v_cvt_pk_bf16_f32 v209, v138, v139
v_mfma_f32_16x16x32_bf16 v[108:111], a[160:163], v[40:43], v[108:111]
s_branch L_po17
L_pg17:
s_branch L_pg23
L_po17:
s_waitcnt lgkmcnt(2)
ds_read_b128 a[204:207], v2 offset:31744
v_mfma_f32_16x16x32_bf16 v[112:115], a[176:179], v[40:43], v[112:115]
v_exp_f32 v105, v105
v_mfma_f32_16x16x32_bf16 v[112:115], a[180:183], v[44:47], v[112:115]
v_exp_f32 v106, v106
v_mfma_f32_16x16x32_bf16 v[112:115], a[184:187], v[48:51], v[112:115]
v_exp_f32 v107, v107
v_mfma_f32_16x16x32_bf16 v[112:115], a[188:191], v[52:55], v[112:115]
s_add_u32 m0, s71, 4096
v_exp_f32 v140, v140
v_mfma_f32_16x16x32_bf16 v[128:131], a[188:191], v[68:71], v[224:227]
s_add_u32 s64, s70, 4096
v_exp_f32 v141, v141
v_mfma_f32_16x16x32_bf16 v[128:131], a[184:187], v[64:67], v[128:131]
buffer_load_dwordx4 v16, s[32:35], s64 offen offset:0 sc1 lds
v_mfma_f32_16x16x32_bf16 v[128:131], a[180:183], v[60:63], v[128:131]
v_exp_f32 v142, v142
v_mfma_f32_16x16x32_bf16 v[128:131], a[176:179], v[56:59], v[128:131]
v_exp_f32 v143, v143
v_mfma_f32_16x16x32_bf16 v[144:147], a[176:179], v[72:75], v[228:231]
ds_read_b128 a[144:147], v3 offset:16384
v_cvt_pk_bf16_f32 v176, v104, v105
v_mfma_f32_16x16x32_bf16 v[144:147], a[180:183], v[76:79], v[144:147]
ds_read_b128 a[148:151], v3 offset:24576
v_cvt_pk_bf16_f32 v177, v106, v107
v_mfma_f32_16x16x32_bf16 v[144:147], a[184:187], v[80:83], v[144:147]
v_exp_f32 v124, v124
v_mfma_f32_16x16x32_bf16 v[144:147], a[188:191], v[84:87], v[144:147]
s_waitcnt lgkmcnt(2)
v_exp_f32 v125, v125
v_mfma_f32_16x16x32_bf16 v[148:151], a[204:207], v[84:87], v[228:231]
v_exp_f32 v126, v126
v_mfma_f32_16x16x32_bf16 v[148:151], a[200:203], v[80:83], v[148:151]
v_exp_f32 v127, v127
v_mfma_f32_16x16x32_bf16 v[148:151], a[196:199], v[76:79], v[148:151]
ds_read_b128 a[152:155], v3 offset:17408
v_cvt_pk_bf16_f32 v210, v140, v141
v_mfma_f32_16x16x32_bf16 v[148:151], a[192:195], v[72:75], v[148:151]
ds_read_b128 a[156:159], v3 offset:25600
v_cvt_pk_bf16_f32 v211, v142, v143
v_mfma_f32_16x16x32_bf16 v[132:135], a[192:195], v[56:59], v[224:227]
v_exp_f32 v108, v108
v_mfma_f32_16x16x32_bf16 v[132:135], a[196:199], v[60:63], v[132:135]
v_exp_f32 v109, v109
v_mfma_f32_16x16x32_bf16 v[132:135], a[200:203], v[64:67], v[132:135]
buffer_load_dwordx4 v16, s[32:35], s64 offen offset:1024 sc1 lds
v_mfma_f32_16x16x32_bf16 v[132:135], a[204:207], v[68:71], v[132:135]
v_exp_f32 v110, v110
v_mfma_f32_16x16x32_bf16 v[116:119], a[204:207], v[52:55], v[116:119]
ds_read_b128 a[160:163], v3 offset:18432
v_cvt_pk_bf16_f32 v202, v124, v125
v_mfma_f32_16x16x32_bf16 v[116:119], a[200:203], v[48:51], v[116:119]
v_exp_f32 v111, v111
v_mfma_f32_16x16x32_bf16 v[116:119], a[196:199], v[44:47], v[116:119]
ds_read_b128 a[164:167], v3 offset:26624
v_cvt_pk_bf16_f32 v203, v126, v127
v_mfma_f32_16x16x32_bf16 v[116:119], a[192:195], v[40:43], v[116:119]
v_exp_f32 v112, v112
v_smfmac_f32_16x16x64_bf16 a[128:131], a[240:243], v[152:159], v5
ds_read_b128 a[168:171], v3 offset:19456
v_smfmac_f32_16x16x64_bf16 a[132:135], a[240:243], v[160:167], v5
ds_read_b128 a[172:175], v3 offset:27648
v_smfmac_f32_16x16x64_bf16 a[136:139], a[240:243], v[184:191], v5
ds_read_b128 a[176:179], v3 offset:20480
v_smfmac_f32_16x16x64_bf16 a[140:143], a[240:243], v[192:199], v5
s_waitcnt lgkmcnt(4)
ds_read_b128 a[180:183], v3 offset:28672
v_xor_b32 v2, 0x8000, v2
v_mfma_f32_16x16x32_bf16 a[0:3], a[144:147], v[152:155], a[0:3]
v_exp_f32 v113, v113
v_mfma_f32_16x16x32_bf16 a[0:3], a[148:151], v[156:159], a[0:3]
v_exp_f32 v114, v114
v_mfma_f32_16x16x32_bf16 a[32:35], a[148:151], v[164:167], a[32:35]
v_exp_f32 v115, v115
v_mfma_f32_16x16x32_bf16 a[32:35], a[144:147], v[160:163], a[32:35]
v_exp_f32 v128, v128
v_mfma_f32_16x16x32_bf16 a[64:67], a[144:147], v[184:187], a[64:67]
buffer_load_dwordx4 v16, s[32:35], s64 offen offset:2048 sc1 lds
v_mfma_f32_16x16x32_bf16 a[64:67], a[148:151], v[188:191], a[64:67]
v_exp_f32 v129, v129
v_mfma_f32_16x16x32_bf16 a[96:99], a[148:151], v[196:199], a[96:99]
v_exp_f32 v130, v130
v_mfma_f32_16x16x32_bf16 a[96:99], a[144:147], v[192:195], a[96:99]
v_exp_f32 v131, v131
v_mfma_f32_16x16x32_bf16 a[100:103], a[152:155], v[192:195], a[100:103]
v_exp_f32 v144, v144
v_mfma_f32_16x16x32_bf16 a[100:103], a[156:159], v[196:199], a[100:103]
v_exp_f32 v145, v145
v_mfma_f32_16x16x32_bf16 a[68:71], a[156:159], v[188:191], a[68:71]
ds_read_b128 a[184:187], v3 offset:21504
v_cvt_pk_bf16_f32 v178, v108, v109
v_mfma_f32_16x16x32_bf16 a[68:71], a[152:155], v[184:187], a[68:71]
ds_read_b128 a[188:191], v3 offset:29696
v_cvt_pk_bf16_f32 v179, v110, v111
v_mfma_f32_16x16x32_bf16 a[36:39], a[152:155], v[160:163], a[36:39]
ds_read_b128 a[192:195], v3 offset:22528
v_cvt_pk_bf16_f32 v180, v112, v113
v_mfma_f32_16x16x32_bf16 a[36:39], a[156:159], v[164:167], a[36:39]
v_exp_f32 v146, v146
v_mfma_f32_16x16x32_bf16 a[4:7], a[156:159], v[156:159], a[4:7]
v_exp_f32 v147, v147
v_mfma_f32_16x16x32_bf16 a[4:7], a[152:155], v[152:155], a[4:7]
v_exp_f32 v148, v148
v_mfma_f32_16x16x32_bf16 a[8:11], a[160:163], v[152:155], a[8:11]
s_waitcnt lgkmcnt(2)
ds_read_b128 a[196:199], v3 offset:30720
v_cvt_pk_bf16_f32 v181, v114, v115
v_mfma_f32_16x16x32_bf16 a[8:11], a[164:167], v[156:159], a[8:11]
buffer_load_dwordx4 v16, s[32:35], s64 offen offset:3072 sc1 lds
v_mfma_f32_16x16x32_bf16 a[40:43], a[164:167], v[164:167], a[40:43]
v_exp_f32 v149, v149
v_mfma_f32_16x16x32_bf16 a[40:43], a[160:163], v[160:163], a[40:43]
ds_read_b128 a[200:203], v3 offset:23552
v_cvt_pk_bf16_f32 v204, v128, v129
v_mfma_f32_16x16x32_bf16 a[72:75], a[160:163], v[184:187], a[72:75]
v_exp_f32 v150, v150
v_mfma_f32_16x16x32_bf16 a[72:75], a[164:167], v[188:191], a[72:75]
v_exp_f32 v151, v151
v_mfma_f32_16x16x32_bf16 a[104:107], a[164:167], v[196:199], a[104:107]
v_exp_f32 v132, v132
v_mfma_f32_16x16x32_bf16 a[104:107], a[160:163], v[192:195], a[104:107]
ds_read_b128 a[204:207], v3 offset:31744
v_cvt_pk_bf16_f32 v205, v130, v131
v_mfma_f32_16x16x32_bf16 a[108:111], a[168:171], v[192:195], a[108:111]
v_exp_f32 v133, v133
v_mfma_f32_16x16x32_bf16 a[108:111], a[172:175], v[196:199], a[108:111]
v_exp_f32 v134, v134
v_mfma_f32_16x16x32_bf16 a[76:79], a[172:175], v[188:191], a[76:79]
v_exp_f32 v135, v135
v_mfma_f32_16x16x32_bf16 a[76:79], a[168:171], v[184:187], a[76:79]
v_exp_f32 v116, v116
v_mfma_f32_16x16x32_bf16 a[44:47], a[168:171], v[160:163], a[44:47]
v_exp_f32 v117, v117
v_mfma_f32_16x16x32_bf16 a[44:47], a[172:175], v[164:167], a[44:47]
v_exp_f32 v118, v118
v_mfma_f32_16x16x32_bf16 a[12:15], a[172:175], v[156:159], a[12:15]
v_exp_f32 v119, v119
v_mfma_f32_16x16x32_bf16 a[12:15], a[168:171], v[152:155], a[12:15]
v_cvt_pk_bf16_f32 v212, v144, v145
v_cvt_pk_bf16_f32 v213, v146, v147
v_mfma_f32_16x16x32_bf16 a[16:19], a[176:179], v[152:155], a[16:19]
v_cvt_pk_bf16_f32 v214, v148, v149
v_cvt_pk_bf16_f32 v215, v150, v151
v_mfma_f32_16x16x32_bf16 a[16:19], a[180:183], v[156:159], a[16:19]
s_waitcnt vmcnt(12)
s_barrier
v_mfma_f32_16x16x32_bf16 a[48:51], a[180:183], v[164:167], a[48:51]
s_xor_b32 s71, s71, 49152
ds_read_b128 a[144:147], v2 offset:0
v_cvt_pk_bf16_f32 v206, v132, v133
v_mfma_f32_16x16x32_bf16 a[48:51], a[176:179], v[160:163], a[48:51]
s_add_u32 s70, s70, 32768
ds_read_b128 a[148:151], v2 offset:1024
v_cvt_pk_bf16_f32 v207, v134, v135
v_mfma_f32_16x16x32_bf16 a[80:83], a[176:179], v[184:187], a[80:83]
s_mov_b32 m0, s71
ds_read_b128 a[152:155], v2 offset:2048
v_cvt_pk_bf16_f32 v182, v116, v117
v_mfma_f32_16x16x32_bf16 a[80:83], a[180:183], v[188:191], a[80:83]
buffer_load_dwordx4 v16, s[32:35], s70 offen offset:0 sc1 lds
v_mfma_f32_16x16x32_bf16 a[112:115], a[180:183], v[196:199], a[112:115]
ds_read_b128 a[156:159], v2 offset:3072
v_cvt_pk_bf16_f32 v183, v118, v119
v_mfma_f32_16x16x32_bf16 a[112:115], a[176:179], v[192:195], a[112:115]
ds_read_b128 a[160:163], v2 offset:4096
v_xor_b32 v3, 0x8000, v3
v_mfma_f32_16x16x32_bf16 a[116:119], a[184:187], v[192:195], a[116:119]
s_waitcnt lgkmcnt(4)
ds_read_b128 a[164:167], v2 offset:5120
v_accvgpr_read_b32 v20, a128
v_mfma_f32_16x16x32_bf16 a[116:119], a[188:191], v[196:199], a[116:119]
ds_read_b128 a[168:171], v2 offset:6144
v_accvgpr_read_b32 v248, a129
v_mfma_f32_16x16x32_bf16 a[84:87], a[188:191], v[188:191], a[84:87]
ds_read_b128 a[172:175], v2 offset:7168
v_add_f32 v20, v20, v248
v_mfma_f32_16x16x32_bf16 a[84:87], a[184:187], v[184:187], a[84:87]
v_max_f32 v1, v1, v20
v_mfma_f32_16x16x32_bf16 a[52:55], a[184:187], v[160:163], a[52:55]
v_rcp_f32 v20, v20
v_mfma_f32_16x16x32_bf16 a[52:55], a[188:191], v[164:167], a[52:55]
v_accvgpr_read_b32 v232, a0
v_accvgpr_read_b32 v233, a1
v_mfma_f32_16x16x32_bf16 a[20:23], a[188:191], v[156:159], a[20:23]
v_accvgpr_read_b32 v234, a2
v_accvgpr_read_b32 v235, a3
v_mfma_f32_16x16x32_bf16 a[20:23], a[184:187], v[152:155], a[20:23]
v_accvgpr_read_b32 v236, a4
v_accvgpr_read_b32 v237, a5
v_mfma_f32_16x16x32_bf16 a[24:27], a[192:195], v[152:155], a[24:27]
v_accvgpr_read_b32 v238, a6
v_accvgpr_read_b32 v239, a7
v_mfma_f32_16x16x32_bf16 a[24:27], a[196:199], v[156:159], a[24:27]
v_mul_f32 v20, v20, v4
v_mul_f32 v232, v232, v20
v_mfma_f32_16x16x32_bf16 a[56:59], a[196:199], v[164:167], a[56:59]
buffer_load_dwordx4 v16, s[32:35], s70 offen offset:1024 sc1 lds
v_mfma_f32_16x16x32_bf16 a[56:59], a[192:195], v[160:163], a[56:59]
v_mul_f32 v233, v233, v20
v_mul_f32 v234, v234, v20
v_mfma_f32_16x16x32_bf16 a[88:91], a[192:195], v[184:187], a[88:91]
v_mul_f32 v235, v235, v20
v_mul_f32 v236, v236, v20
v_mfma_f32_16x16x32_bf16 a[88:91], a[196:199], v[188:191], a[88:91]
v_mul_f32 v237, v237, v20
v_mul_f32 v238, v238, v20
v_mfma_f32_16x16x32_bf16 a[120:123], a[196:199], v[196:199], a[120:123]
v_mul_f32 v239, v239, v20
v_cvt_pk_bf16_f32 v232, v232, v233
v_mfma_f32_16x16x32_bf16 a[120:123], a[192:195], v[192:195], a[120:123]
v_cvt_pk_bf16_f32 v233, v234, v235
v_cvt_pk_bf16_f32 v234, v236, v237
v_mfma_f32_16x16x32_bf16 a[124:127], a[200:203], v[192:195], a[124:127]
v_cvt_pk_bf16_f32 v235, v238, v239
v_mfma_f32_16x16x32_bf16 a[124:127], a[204:207], v[196:199], a[124:127]
s_add_u32 s77, s74, 0
buffer_store_dwordx4 v[232:235], v16, s[44:47], s77 offen sc1
v_mfma_f32_16x16x32_bf16 a[92:95], a[204:207], v[188:191], a[92:95]
v_accvgpr_read_b32 v240, a8
v_accvgpr_read_b32 v241, a9
v_mfma_f32_16x16x32_bf16 a[92:95], a[200:203], v[184:187], a[92:95]
v_accvgpr_read_b32 v242, a10
v_accvgpr_read_b32 v243, a11
v_mfma_f32_16x16x32_bf16 a[60:63], a[200:203], v[160:163], a[60:63]
v_accvgpr_read_b32 v244, a12
v_accvgpr_read_b32 v245, a13
v_mfma_f32_16x16x32_bf16 a[60:63], a[204:207], v[164:167], a[60:63]
v_accvgpr_read_b32 v246, a14
v_accvgpr_read_b32 v247, a15
v_mfma_f32_16x16x32_bf16 a[28:31], a[204:207], v[156:159], a[28:31]
v_mul_f32 v240, v240, v20
v_mul_f32 v241, v241, v20
v_mfma_f32_16x16x32_bf16 a[28:31], a[200:203], v[152:155], a[28:31]
v_mul_f32 v242, v242, v20
v_mul_f32 v243, v243, v20
v_mul_f32 v244, v244, v20
v_mul_f32 v245, v245, v20
v_mul_f32 v246, v246, v20
v_mul_f32 v247, v247, v20
v_cvt_pk_bf16_f32 v240, v240, v241
v_cvt_pk_bf16_f32 v241, v242, v243
v_cvt_pk_bf16_f32 v242, v244, v245
v_cvt_pk_bf16_f32 v243, v246, v247
s_add_u32 s77, s74, 8192
buffer_store_dwordx4 v[240:243], v16, s[44:47], s77 offen sc1
v_accvgpr_read_b32 v232, a16
v_accvgpr_read_b32 v233, a17
v_accvgpr_read_b32 v234, a18
v_accvgpr_read_b32 v235, a19
v_accvgpr_read_b32 v236, a20
v_accvgpr_read_b32 v237, a21
v_accvgpr_read_b32 v238, a22
v_accvgpr_read_b32 v239, a23
v_mul_f32 v232, v232, v20
v_mul_f32 v233, v233, v20
v_mul_f32 v234, v234, v20
v_mul_f32 v235, v235, v20
v_mul_f32 v236, v236, v20
v_mul_f32 v237, v237, v20
v_mul_f32 v238, v238, v20
v_mul_f32 v239, v239, v20
v_cvt_pk_bf16_f32 v232, v232, v233
v_cvt_pk_bf16_f32 v233, v234, v235
v_cvt_pk_bf16_f32 v234, v236, v237
v_cvt_pk_bf16_f32 v235, v238, v239
s_add_u32 s77, s74, 16384
buffer_store_dwordx4 v[232:235], v16, s[44:47], s77 offen sc1
s_cmp_eq_u32 s3, 7
s_cbranch_scc1 L_T1
s_branch L_po18
L_pg18:
s_branch L_tr3
L_po18:
L_T:
s_waitcnt lgkmcnt(7)
v_mfma_f32_16x16x32_bf16 v[120:123], a[144:147], v[56:59], v[224:227]
s_waitcnt lgkmcnt(6)
ds_read_b128 a[176:179], v2 offset:8192
v_mfma_f32_16x16x32_bf16 v[120:123], a[148:151], v[60:63], v[120:123]
s_waitcnt lgkmcnt(6)
ds_read_b128 a[180:183], v2 offset:9216
v_mfma_f32_16x16x32_bf16 v[120:123], a[152:155], v[64:67], v[120:123]
s_waitcnt lgkmcnt(6)
buffer_load_dwordx4 v16, s[32:35], s70 offen offset:2048 sc1 lds
v_mfma_f32_16x16x32_bf16 v[120:123], a[156:159], v[68:71], v[120:123]
ds_read_b128 a[184:187], v2 offset:10240
v_mfma_f32_16x16x32_bf16 v[136:139], a[156:159], v[84:87], v[228:231]
ds_read_b128 a[188:191], v2 offset:11264
v_mfma_f32_16x16x32_bf16 v[136:139], a[152:155], v[80:83], v[136:139]
ds_read_b128 a[192:195], v2 offset:12288
v_mfma_f32_16x16x32_bf16 v[136:139], a[148:151], v[76:79], v[136:139]
ds_read_b128 a[196:199], v2 offset:13312
v_mfma_f32_16x16x32_bf16 v[136:139], a[144:147], v[72:75], v[136:139]
s_waitcnt lgkmcnt(4)
v_mfma_f32_16x16x32_bf16 v[140:143], a[160:163], v[72:75], v[228:231]
ds_read_b128 a[200:203], v2 offset:14336
v_accvgpr_read_b32 v240, a24
v_mfma_f32_16x16x32_bf16 v[140:143], a[164:167], v[76:79], v[140:143]
ds_read_b128 a[204:207], v2 offset:15360
v_accvgpr_read_b32 v241, a25
v_mfma_f32_16x16x32_bf16 v[140:143], a[168:171], v[80:83], v[140:143]
v_exp_f32 v120, v120
v_mfma_f32_16x16x32_bf16 v[140:143], a[172:175], v[84:87], v[140:143]
v_exp_f32 v121, v121
v_mfma_f32_16x16x32_bf16 v[124:127], a[172:175], v[68:71], v[224:227]
v_exp_f32 v122, v122
v_mfma_f32_16x16x32_bf16 v[124:127], a[168:171], v[64:67], v[124:127]
buffer_load_dwordx4 v16, s[32:35], s70 offen offset:3072 sc1 lds
v_mfma_f32_16x16x32_bf16 v[124:127], a[164:167], v[60:63], v[124:127]
v_exp_f32 v123, v123
v_mfma_f32_16x16x32_bf16 v[124:127], a[160:163], v[56:59], v[124:127]
v_exp_f32 v136, v136
v_mfma_f32_16x16x32_bf16 v[128:131], a[176:179], v[56:59], v[224:227]
v_exp_f32 v137, v137
v_mfma_f32_16x16x32_bf16 v[128:131], a[180:183], v[60:63], v[128:131]
s_waitcnt lgkmcnt(0)
v_exp_f32 v138, v138
v_mfma_f32_16x16x32_bf16 v[128:131], a[184:187], v[64:67], v[128:131]
v_exp_f32 v139, v139
v_mfma_f32_16x16x32_bf16 v[128:131], a[188:191], v[68:71], v[128:131]
s_add_u32 m0, s71, 4096
ds_read_b128 a[144:147], v3 offset:0
v_cvt_pk_bf16_f32 v184, v120, v121
v_mfma_f32_16x16x32_bf16 v[144:147], a[188:191], v[84:87], v[228:231]
s_add_u32 s64, s70, 4096
ds_read_b128 a[148:151], v3 offset:8192
v_cvt_pk_bf16_f32 v185, v122, v123
v_mfma_f32_16x16x32_bf16 v[144:147], a[184:187], v[80:83], v[144:147]
buffer_load_dwordx4 v16, s[32:35], s64 offen offset:0 sc1 lds
v_mfma_f32_16x16x32_bf16 v[144:147], a[180:183], v[76:79], v[144:147]
v_exp_f32 v140, v140
v_mfma_f32_16x16x32_bf16 v[144:147], a[176:179], v[72:75], v[144:147]
v_exp_f32 v141, v141
v_mfma_f32_16x16x32_bf16 v[148:151], a[192:195], v[72:75], v[228:231]
v_exp_f32 v142, v142
v_mfma_f32_16x16x32_bf16 v[148:151], a[196:199], v[76:79], v[148:151]
ds_read_b128 a[152:155], v3 offset:1024
v_cvt_pk_bf16_f32 v192, v136, v137
v_mfma_f32_16x16x32_bf16 v[148:151], a[200:203], v[80:83], v[148:151]
ds_read_b128 a[156:159], v3 offset:9216
v_cvt_pk_bf16_f32 v193, v138, v139
v_mfma_f32_16x16x32_bf16 v[148:151], a[204:207], v[84:87], v[148:151]
v_exp_f32 v143, v143
v_mfma_f32_16x16x32_bf16 v[132:135], a[204:207], v[68:71], v[224:227]
v_exp_f32 v124, v124
v_mfma_f32_16x16x32_bf16 v[132:135], a[200:203], v[64:67], v[132:135]
v_exp_f32 v125, v125
v_mfma_f32_16x16x32_bf16 v[132:135], a[196:199], v[60:63], v[132:135]
buffer_load_dwordx4 v16, s[32:35], s64 offen offset:1024 sc1 lds
v_mfma_f32_16x16x32_bf16 v[132:135], a[192:195], v[56:59], v[132:135]
ds_read_b128 a[160:163], v3 offset:2048
v_cvt_pk_bf16_f32 v194, v140, v141
v_smfmac_f32_16x16x64_bf16 a[132:135], a[240:243], v[176:183], v5
ds_read_b128 a[164:167], v3 offset:10240
v_smfmac_f32_16x16x64_bf16 a[136:139], a[240:243], v[200:207], v5
ds_read_b128 a[168:171], v3 offset:3072
v_accvgpr_read_b32 v242, a26
v_smfmac_f32_16x16x64_bf16 a[140:143], a[240:243], v[208:215], v5
s_waitcnt lgkmcnt(3)
ds_read_b128 a[172:175], v3 offset:11264
v_accvgpr_read_b32 v243, a27
v_mfma_f32_16x16x32_bf16 a[32:35], a[144:147], v[176:179], a[32:35]
ds_read_b128 a[176:179], v3 offset:4096
v_accvgpr_read_b32 v244, a28
v_mfma_f32_16x16x32_bf16 a[32:35], a[148:151], v[180:183], a[32:35]
ds_read_b128 a[180:183], v3 offset:12288
v_accvgpr_read_b32 v245, a29
v_mfma_f32_16x16x32_bf16 a[64:67], a[148:151], v[204:207], a[64:67]
ds_read_b128 a[184:187], v3 offset:5120
v_accvgpr_read_b32 v246, a30
v_mfma_f32_16x16x32_bf16 a[64:67], a[144:147], v[200:203], a[64:67]
ds_read_b128 a[188:191], v3 offset:13312
v_accvgpr_read_b32 v247, a31
v_mfma_f32_16x16x32_bf16 a[96:99], a[144:147], v[208:211], a[96:99]
ds_read_b128 a[192:195], v3 offset:6144
v_mul_f32 v240, v240, v20
v_mfma_f32_16x16x32_bf16 a[96:99], a[148:151], v[212:215], a[96:99]
ds_read_b128 a[196:199], v3 offset:14336
v_mul_f32 v241, v241, v20
v_mfma_f32_16x16x32_bf16 a[100:103], a[156:159], v[212:215], a[100:103]
ds_read_b128 a[200:203], v3 offset:7168
v_mul_f32 v242, v242, v20
v_mfma_f32_16x16x32_bf16 a[100:103], a[152:155], v[208:211], a[100:103]
ds_read_b128 a[204:207], v3 offset:15360
v_mul_f32 v243, v243, v20
v_mul_f32 v244, v244, v20
v_mul_f32 v245, v245, v20
v_mul_f32 v246, v246, v20
v_mul_f32 v247, v247, v20
v_cvt_pk_bf16_f32 v240, v240, v241
v_cvt_pk_bf16_f32 v241, v242, v243
v_cvt_pk_bf16_f32 v242, v244, v245
v_cvt_pk_bf16_f32 v243, v246, v247
s_add_u32 s77, s74, 24576
buffer_store_dwordx4 v[240:243], v16, s[44:47], s77 offen sc1
v_exp_f32 v126, v126
v_mfma_f32_16x16x32_bf16 a[68:71], a[152:155], v[200:203], a[68:71]
buffer_load_dwordx4 v16, s[32:35], s64 offen offset:2048 sc1 lds
v_cvt_pk_bf16_f32 v195, v142, v143
v_mfma_f32_16x16x32_bf16 a[68:71], a[156:159], v[204:207], a[68:71]
v_exp_f32 v127, v127
v_mfma_f32_16x16x32_bf16 a[36:39], a[156:159], v[180:183], a[36:39]
v_exp_f32 v128, v128
v_mfma_f32_16x16x32_bf16 a[36:39], a[152:155], v[176:179], a[36:39]
s_waitcnt lgkmcnt(2)
v_exp_f32 v129, v129
v_mfma_f32_16x16x32_bf16 a[40:43], a[160:163], v[176:179], a[40:43]
v_cvt_pk_bf16_f32 v186, v124, v125
v_cvt_pk_bf16_f32 v187, v126, v127
v_mfma_f32_16x16x32_bf16 a[40:43], a[164:167], v[180:183], a[40:43]
v_exp_f32 v130, v130
v_mfma_f32_16x16x32_bf16 a[72:75], a[164:167], v[204:207], a[72:75]
buffer_load_dwordx4 v16, s[32:35], s64 offen offset:3072 sc1 lds
v_mfma_f32_16x16x32_bf16 a[72:75], a[160:163], v[200:203], a[72:75]
v_exp_f32 v131, v131
v_mfma_f32_16x16x32_bf16 a[104:107], a[160:163], v[208:211], a[104:107]
v_exp_f32 v144, v144
v_mfma_f32_16x16x32_bf16 a[104:107], a[164:167], v[212:215], a[104:107]
v_exp_f32 v145, v145
v_mfma_f32_16x16x32_bf16 a[108:111], a[172:175], v[212:215], a[108:111]
v_exp_f32 v146, v146
v_mfma_f32_16x16x32_bf16 a[108:111], a[168:171], v[208:211], a[108:111]
v_exp_f32 v147, v147
v_mfma_f32_16x16x32_bf16 a[76:79], a[168:171], v[200:203], a[76:79]
v_exp_f32 v148, v148
v_mfma_f32_16x16x32_bf16 a[76:79], a[172:175], v[204:207], a[76:79]
v_exp_f32 v149, v149
v_mfma_f32_16x16x32_bf16 a[44:47], a[172:175], v[180:183], a[44:47]
v_cvt_pk_bf16_f32 v188, v128, v129
v_cvt_pk_bf16_f32 v189, v130, v131
v_mfma_f32_16x16x32_bf16 a[44:47], a[168:171], v[176:179], a[44:47]
v_exp_f32 v150, v150
v_mfma_f32_16x16x32_bf16 a[48:51], a[176:179], v[176:179], a[48:51]
v_exp_f32 v151, v151
v_mfma_f32_16x16x32_bf16 a[48:51], a[180:183], v[180:183], a[48:51]
v_exp_f32 v132, v132
v_mfma_f32_16x16x32_bf16 a[80:83], a[180:183], v[204:207], a[80:83]
s_waitcnt vmcnt(9)
s_barrier
v_mfma_f32_16x16x32_bf16 a[80:83], a[176:179], v[200:203], a[80:83]
s_xor_b32 s71, s71, 16384
v_exp_f32 v133, v133
v_mfma_f32_16x16x32_bf16 a[112:115], a[176:179], v[208:211], a[112:115]
s_add_u32 s70, s70, 32768
ds_read_b128 a[144:147], v2 offset:16384
v_cvt_pk_bf16_f32 v196, v144, v145
v_mfma_f32_16x16x32_bf16 a[112:115], a[180:183], v[212:215], a[112:115]
s_mov_b32 m0, s71
v_exp_f32 v134, v134
v_mfma_f32_16x16x32_bf16 a[116:119], a[188:191], v[212:215], a[116:119]
buffer_load_dwordx4 v16, s[32:35], s70 offen offset:0 sc1 lds
v_mfma_f32_16x16x32_bf16 a[116:119], a[184:187], v[208:211], a[116:119]
ds_read_b128 a[148:151], v2 offset:17408
v_cvt_pk_bf16_f32 v197, v146, v147
v_mfma_f32_16x16x32_bf16 a[84:87], a[184:187], v[200:203], a[84:87]
ds_read_b128 a[152:155], v2 offset:18432
v_cvt_pk_bf16_f32 v198, v148, v149
v_mfma_f32_16x16x32_bf16 a[84:87], a[188:191], v[204:207], a[84:87]
ds_read_b128 a[156:159], v2 offset:19456
v_cvt_pk_bf16_f32 v199, v150, v151
v_mfma_f32_16x16x32_bf16 a[52:55], a[188:191], v[180:183], a[52:55]
v_exp_f32 v135, v135
v_mfma_f32_16x16x32_bf16 a[52:55], a[184:187], v[176:179], a[52:55]
ds_read_b128 a[160:163], v2 offset:20480
v_cvt_pk_bf16_f32 v190, v132, v133
v_mfma_f32_16x16x32_bf16 a[56:59], a[192:195], v[176:179], a[56:59]
ds_read_b128 a[164:167], v2 offset:21504
v_cvt_pk_bf16_f32 v191, v134, v135
v_mfma_f32_16x16x32_bf16 a[56:59], a[196:199], v[180:183], a[56:59]
ds_read_b128 a[168:171], v2 offset:22528
v_accvgpr_read_b32 v21, a132
v_mfma_f32_16x16x32_bf16 a[88:91], a[196:199], v[204:207], a[88:91]
ds_read_b128 a[172:175], v2 offset:23552
v_accvgpr_read_b32 v248, a133
v_mfma_f32_16x16x32_bf16 a[88:91], a[192:195], v[200:203], a[88:91]
buffer_load_dwordx4 v16, s[32:35], s70 offen offset:1024 sc1 lds
v_mfma_f32_16x16x32_bf16 a[120:123], a[192:195], v[208:211], a[120:123]
v_add_f32 v21, v21, v248
v_max_f32 v1, v1, v21
v_mfma_f32_16x16x32_bf16 a[120:123], a[196:199], v[212:215], a[120:123]
s_waitcnt lgkmcnt(3)
v_rcp_f32 v21, v21
v_mfma_f32_16x16x32_bf16 a[124:127], a[204:207], v[212:215], a[124:127]
v_accvgpr_read_b32 v232, a32
v_accvgpr_read_b32 v233, a33
v_mfma_f32_16x16x32_bf16 a[124:127], a[200:203], v[208:211], a[124:127]
v_accvgpr_read_b32 v234, a34
v_accvgpr_read_b32 v235, a35
v_mfma_f32_16x16x32_bf16 a[92:95], a[200:203], v[200:203], a[92:95]
v_accvgpr_read_b32 v236, a36
v_accvgpr_read_b32 v237, a37
v_mfma_f32_16x16x32_bf16 a[92:95], a[204:207], v[204:207], a[92:95]
v_accvgpr_read_b32 v238, a38
v_accvgpr_read_b32 v239, a39
v_mfma_f32_16x16x32_bf16 a[60:63], a[204:207], v[180:183], a[60:63]
v_mul_f32 v21, v21, v6
v_mul_f32 v232, v232, v21
v_mfma_f32_16x16x32_bf16 a[60:63], a[200:203], v[176:179], a[60:63]
v_mul_f32 v233, v233, v21
v_mul_f32 v234, v234, v21
v_mfma_f32_16x16x32_bf16 v[120:123], a[144:147], v[56:59], v[224:227]
ds_read_b128 a[176:179], v2 offset:24576
ds_read_b128 a[180:183], v2 offset:25600
v_mfma_f32_16x16x32_bf16 v[120:123], a[148:151], v[60:63], v[120:123]
buffer_load_dwordx4 v16, s[32:35], s70 offen offset:2048 sc1 lds
v_mfma_f32_16x16x32_bf16 v[120:123], a[152:155], v[64:67], v[120:123]
s_add_u32 s64, s70, 4096
ds_read_b128 a[184:187], v2 offset:26624
ds_read_b128 a[188:191], v2 offset:27648
v_mfma_f32_16x16x32_bf16 v[120:123], a[156:159], v[68:71], v[120:123]
buffer_load_dwordx4 v16, s[32:35], s70 offen offset:3072 sc1 lds
v_mfma_f32_16x16x32_bf16 v[136:139], a[156:159], v[84:87], v[228:231]
s_add_u32 m0, s71, 4096
ds_read_b128 a[192:195], v2 offset:28672
ds_read_b128 a[196:199], v2 offset:29696
v_mfma_f32_16x16x32_bf16 v[136:139], a[152:155], v[80:83], v[136:139]
buffer_load_dwordx4 v16, s[32:35], s64 offen offset:0 sc1 lds
v_mfma_f32_16x16x32_bf16 v[136:139], a[148:151], v[76:79], v[136:139]
ds_read_b128 a[200:203], v2 offset:30720
ds_read_b128 a[204:207], v2 offset:31744
v_mfma_f32_16x16x32_bf16 v[136:139], a[144:147], v[72:75], v[136:139]
v_exp_f32 v120, v120
v_mfma_f32_16x16x32_bf16 v[140:143], a[160:163], v[72:75], v[228:231]
s_waitcnt lgkmcnt(4)
v_exp_f32 v121, v121
v_mfma_f32_16x16x32_bf16 v[140:143], a[164:167], v[76:79], v[140:143]
v_exp_f32 v122, v122
v_mfma_f32_16x16x32_bf16 v[140:143], a[168:171], v[80:83], v[140:143]
v_mul_f32 v235, v235, v21
v_mul_f32 v236, v236, v21
v_mul_f32 v237, v237, v21
v_mul_f32 v238, v238, v21
v_mul_f32 v239, v239, v21
v_cvt_pk_bf16_f32 v232, v232, v233
v_cvt_pk_bf16_f32 v233, v234, v235
v_cvt_pk_bf16_f32 v234, v236, v237
v_cvt_pk_bf16_f32 v235, v238, v239
s_add_u32 s77, s74, 4096
buffer_store_dwordx4 v[232:235], v16, s[44:47], s77 offen sc1
v_accvgpr_read_b32 v240, a40
v_accvgpr_read_b32 v241, a41
v_accvgpr_read_b32 v242, a42
v_accvgpr_read_b32 v243, a43
v_accvgpr_read_b32 v244, a44
v_accvgpr_read_b32 v245, a45
v_accvgpr_read_b32 v246, a46
v_accvgpr_read_b32 v247, a47
v_mul_f32 v240, v240, v21
v_mul_f32 v241, v241, v21
v_mul_f32 v242, v242, v21
v_mul_f32 v243, v243, v21
v_mul_f32 v244, v244, v21
v_mul_f32 v245, v245, v21
v_mul_f32 v246, v246, v21
v_mul_f32 v247, v247, v21
v_cvt_pk_bf16_f32 v240, v240, v241
v_cvt_pk_bf16_f32 v241, v242, v243
v_cvt_pk_bf16_f32 v242, v244, v245
v_cvt_pk_bf16_f32 v243, v246, v247
s_add_u32 s77, s74, 12288
buffer_store_dwordx4 v[240:243], v16, s[44:47], s77 offen sc1
v_accvgpr_read_b32 v232, a48
v_accvgpr_read_b32 v233, a49
v_accvgpr_read_b32 v234, a50
v_accvgpr_read_b32 v235, a51
v_accvgpr_read_b32 v236, a52
v_accvgpr_read_b32 v237, a53
v_accvgpr_read_b32 v238, a54
v_accvgpr_read_b32 v239, a55
v_mul_f32 v232, v232, v21
v_mul_f32 v233, v233, v21
v_mul_f32 v234, v234, v21
v_mul_f32 v235, v235, v21
v_mul_f32 v236, v236, v21
v_mul_f32 v237, v237, v21
v_mul_f32 v238, v238, v21
v_mul_f32 v239, v239, v21
v_cvt_pk_bf16_f32 v232, v232, v233
v_cvt_pk_bf16_f32 v233, v234, v235
v_cvt_pk_bf16_f32 v234, v236, v237
v_cvt_pk_bf16_f32 v235, v238, v239
s_add_u32 s77, s74, 20480
buffer_store_dwordx4 v[232:235], v16, s[44:47], s77 offen sc1
v_accvgpr_read_b32 v240, a56
v_accvgpr_read_b32 v241, a57
v_accvgpr_read_b32 v242, a58
v_accvgpr_read_b32 v243, a59
v_accvgpr_read_b32 v244, a60
v_accvgpr_read_b32 v245, a61
v_accvgpr_read_b32 v246, a62
v_accvgpr_read_b32 v247, a63
v_mul_f32 v240, v240, v21
v_mul_f32 v241, v241, v21
v_mul_f32 v242, v242, v21
v_mul_f32 v243, v243, v21
v_mul_f32 v244, v244, v21
v_mul_f32 v245, v245, v21
v_mul_f32 v246, v246, v21
v_mul_f32 v247, v247, v21
v_cvt_pk_bf16_f32 v240, v240, v241
v_cvt_pk_bf16_f32 v241, v242, v243
v_cvt_pk_bf16_f32 v242, v244, v245
v_cvt_pk_bf16_f32 v243, v246, v247
s_add_u32 s77, s74, 28672
s_branch L_po19
L_pg19:
s_branch L_pg24
L_po19:
buffer_store_dwordx4 v[240:243], v16, s[44:47], s77 offen sc1
v_exp_f32 v123, v123
v_mfma_f32_16x16x32_bf16 v[140:143], a[172:175], v[84:87], v[140:143]
v_exp_f32 v136, v136
v_mfma_f32_16x16x32_bf16 v[124:127], a[172:175], v[68:71], v[224:227]
ds_read_b128 a[144:147], v3 offset:16384
v_cvt_pk_bf16_f32 v200, v120, v121
v_mfma_f32_16x16x32_bf16 v[124:127], a[168:171], v[64:67], v[124:127]
v_exp_f32 v137, v137
v_mfma_f32_16x16x32_bf16 v[124:127], a[164:167], v[60:63], v[124:127]
ds_read_b128 a[148:151], v3 offset:24576
v_cvt_pk_bf16_f32 v201, v122, v123
v_mfma_f32_16x16x32_bf16 v[124:127], a[160:163], v[56:59], v[124:127]
v_exp_f32 v138, v138
v_mfma_f32_16x16x32_bf16 v[128:131], a[176:179], v[56:59], v[224:227]
ds_read_b128 a[152:155], v3 offset:17408
v_cvt_pk_bf16_f32 v208, v136, v137
v_mfma_f32_16x16x32_bf16 v[128:131], a[180:183], v[60:63], v[128:131]
v_exp_f32 v139, v139
v_mfma_f32_16x16x32_bf16 v[128:131], a[184:187], v[64:67], v[128:131]
ds_read_b128 a[156:159], v3 offset:25600
v_cvt_pk_bf16_f32 v209, v138, v139
v_mfma_f32_16x16x32_bf16 v[128:131], a[188:191], v[68:71], v[128:131]
v_exp_f32 v140, v140
v_mfma_f32_16x16x32_bf16 v[144:147], a[188:191], v[84:87], v[228:231]
buffer_load_dwordx4 v16, s[32:35], s64 offen offset:1024 sc1 lds
v_mfma_f32_16x16x32_bf16 v[144:147], a[184:187], v[80:83], v[144:147]
v_exp_f32 v141, v141
v_mfma_f32_16x16x32_bf16 v[144:147], a[180:183], v[76:79], v[144:147]
ds_read_b128 a[160:163], v3 offset:18432
v_cvt_pk_bf16_f32 v210, v140, v141
v_mfma_f32_16x16x32_bf16 v[144:147], a[176:179], v[72:75], v[144:147]
s_waitcnt lgkmcnt(2)
v_exp_f32 v142, v142
v_mfma_f32_16x16x32_bf16 v[148:151], a[192:195], v[72:75], v[228:231]
ds_read_b128 a[164:167], v3 offset:26624
ds_read_b128 a[168:171], v3 offset:19456
v_mfma_f32_16x16x32_bf16 v[148:151], a[196:199], v[76:79], v[148:151]
v_exp_f32 v143, v143
v_mfma_f32_16x16x32_bf16 v[148:151], a[200:203], v[80:83], v[148:151]
ds_read_b128 a[172:175], v3 offset:27648
v_cvt_pk_bf16_f32 v211, v142, v143
v_mfma_f32_16x16x32_bf16 v[148:151], a[204:207], v[84:87], v[148:151]
v_exp_f32 v124, v124
v_mfma_f32_16x16x32_bf16 v[132:135], a[204:207], v[68:71], v[224:227]
ds_read_b128 a[176:179], v3 offset:20480
buffer_load_dwordx4 v16, s[32:35], s64 offen offset:2048 sc1 lds
v_mfma_f32_16x16x32_bf16 v[132:135], a[200:203], v[64:67], v[132:135]
v_exp_f32 v125, v125
v_mfma_f32_16x16x32_bf16 v[132:135], a[196:199], v[60:63], v[132:135]
ds_read_b128 a[180:183], v3 offset:28672
v_cvt_pk_bf16_f32 v202, v124, v125
v_mfma_f32_16x16x32_bf16 v[132:135], a[192:195], v[56:59], v[132:135]
v_exp_f32 v126, v126
v_smfmac_f32_16x16x64_bf16 a[136:139], a[240:243], v[184:191], v5
ds_read_b128 a[184:187], v3 offset:21504
v_smfmac_f32_16x16x64_bf16 a[140:143], a[240:243], v[192:199], v5
ds_read_b128 a[188:191], v3 offset:29696
v_mfma_f32_16x16x32_bf16 a[64:67], a[144:147], v[184:187], a[64:67]
v_exp_f32 v127, v127
v_mfma_f32_16x16x32_bf16 a[64:67], a[148:151], v[188:191], a[64:67]
v_exp_f32 v128, v128
v_mfma_f32_16x16x32_bf16 a[96:99], a[148:151], v[196:199], a[96:99]
v_exp_f32 v129, v129
v_mfma_f32_16x16x32_bf16 a[96:99], a[144:147], v[192:195], a[96:99]
ds_read_b128 a[192:195], v3 offset:22528
v_cvt_pk_bf16_f32 v203, v126, v127
v_mfma_f32_16x16x32_bf16 a[100:103], a[152:155], v[192:195], a[100:103]
s_waitcnt lgkmcnt(2)
v_exp_f32 v130, v130
v_mfma_f32_16x16x32_bf16 a[100:103], a[156:159], v[196:199], a[100:103]
ds_read_b128 a[196:199], v3 offset:30720
v_cvt_pk_bf16_f32 v204, v128, v129
v_mfma_f32_16x16x32_bf16 a[68:71], a[156:159], v[188:191], a[68:71]
v_exp_f32 v131, v131
v_mfma_f32_16x16x32_bf16 a[68:71], a[152:155], v[184:187], a[68:71]
ds_read_b128 a[200:203], v3 offset:23552
v_cvt_pk_bf16_f32 v205, v130, v131
v_mfma_f32_16x16x32_bf16 a[72:75], a[160:163], v[184:187], a[72:75]
v_exp_f32 v144, v144
v_mfma_f32_16x16x32_bf16 a[72:75], a[164:167], v[188:191], a[72:75]
buffer_load_dwordx4 v16, s[32:35], s64 offen offset:3072 sc1 lds
v_mfma_f32_16x16x32_bf16 a[104:107], a[164:167], v[196:199], a[104:107]
s_xor_b32 s71, s71, 49152
v_exp_f32 v145, v145
v_mfma_f32_16x16x32_bf16 a[104:107], a[160:163], v[192:195], a[104:107]
ds_read_b128 a[204:207], v3 offset:31744
v_cvt_pk_bf16_f32 v212, v144, v145
v_mfma_f32_16x16x32_bf16 a[108:111], a[168:171], v[192:195], a[108:111]
s_add_u32 s70, s70, 32768
v_xor_b32 v2, 0x8000, v2
v_exp_f32 v146, v146
v_mfma_f32_16x16x32_bf16 a[108:111], a[172:175], v[196:199], a[108:111]
s_waitcnt vmcnt(12)
s_barrier
v_mfma_f32_16x16x32_bf16 a[76:79], a[172:175], v[188:191], a[76:79]
s_mov_b32 m0, s71
v_exp_f32 v147, v147
v_mfma_f32_16x16x32_bf16 a[76:79], a[168:171], v[184:187], a[76:79]
ds_read_b128 a[144:147], v2 offset:0
v_cvt_pk_bf16_f32 v213, v146, v147
v_mfma_f32_16x16x32_bf16 a[80:83], a[176:179], v[184:187], a[80:83]
v_exp_f32 v148, v148
v_mfma_f32_16x16x32_bf16 a[80:83], a[180:183], v[188:191], a[80:83]
ds_read_b128 a[148:151], v2 offset:1024
ds_read_b128 a[152:155], v2 offset:2048
v_mfma_f32_16x16x32_bf16 a[112:115], a[180:183], v[196:199], a[112:115]
v_exp_f32 v149, v149
v_mfma_f32_16x16x32_bf16 a[112:115], a[176:179], v[192:195], a[112:115]
ds_read_b128 a[156:159], v2 offset:3072
v_cvt_pk_bf16_f32 v214, v148, v149
v_mfma_f32_16x16x32_bf16 a[116:119], a[184:187], v[192:195], a[116:119]
s_waitcnt lgkmcnt(4)
v_exp_f32 v150, v150
v_mfma_f32_16x16x32_bf16 a[116:119], a[188:191], v[196:199], a[116:119]
buffer_load_dwordx4 v16, s[32:35], s70 offen offset:0 sc1 lds
v_mfma_f32_16x16x32_bf16 a[84:87], a[188:191], v[188:191], a[84:87]
v_exp_f32 v151, v151
v_mfma_f32_16x16x32_bf16 a[84:87], a[184:187], v[184:187], a[84:87]
ds_read_b128 a[160:163], v2 offset:4096
v_cvt_pk_bf16_f32 v215, v150, v151
v_mfma_f32_16x16x32_bf16 a[88:91], a[192:195], v[184:187], a[88:91]
v_exp_f32 v132, v132
v_mfma_f32_16x16x32_bf16 a[88:91], a[196:199], v[188:191], a[88:91]
ds_read_b128 a[164:167], v2 offset:5120
v_xor_b32 v3, 0x8000, v3
v_mfma_f32_16x16x32_bf16 a[120:123], a[196:199], v[196:199], a[120:123]
v_exp_f32 v133, v133
v_mfma_f32_16x16x32_bf16 a[120:123], a[192:195], v[192:195], a[120:123]
ds_read_b128 a[168:171], v2 offset:6144
v_cvt_pk_bf16_f32 v206, v132, v133
v_mfma_f32_16x16x32_bf16 a[124:127], a[200:203], v[192:195], a[124:127]
v_exp_f32 v134, v134
v_mfma_f32_16x16x32_bf16 a[124:127], a[204:207], v[196:199], a[124:127]
buffer_load_dwordx4 v16, s[32:35], s70 offen offset:1024 sc1 lds
v_mfma_f32_16x16x32_bf16 a[92:95], a[204:207], v[188:191], a[92:95]
v_exp_f32 v135, v135
v_mfma_f32_16x16x32_bf16 a[92:95], a[200:203], v[184:187], a[92:95]
ds_read_b128 a[172:175], v2 offset:7168
v_cvt_pk_bf16_f32 v207, v134, v135
s_lshl_b32 s72, s3, 1
s_sub_u32 s72, 13, s72
L_S:
s_waitcnt lgkmcnt(7)
v_mfma_f32_16x16x32_bf16 v[120:123], a[144:147], v[56:59], v[224:227]
s_waitcnt lgkmcnt(6)
ds_read_b128 a[176:179], v2 offset:8192
ds_read_b128 a[180:183], v2 offset:9216
v_mfma_f32_16x16x32_bf16 v[120:123], a[148:151], v[60:63], v[120:123]
s_waitcnt lgkmcnt(7)
buffer_load_dwordx4 v16, s[32:35], s70 offen offset:2048 sc1 lds
v_mfma_f32_16x16x32_bf16 v[120:123], a[152:155], v[64:67], v[120:123]
s_waitcnt lgkmcnt(6)
s_add_u32 s64, s70, 4096
ds_read_b128 a[184:187], v2 offset:10240
ds_read_b128 a[188:191], v2 offset:11264
v_mfma_f32_16x16x32_bf16 v[120:123], a[156:159], v[68:71], v[120:123]
buffer_load_dwordx4 v16, s[32:35], s70 offen offset:3072 sc1 lds
v_mfma_f32_16x16x32_bf16 v[136:139], a[156:159], v[84:87], v[228:231]
s_add_u32 m0, s71, 4096
ds_read_b128 a[192:195], v2 offset:12288
ds_read_b128 a[196:199], v2 offset:13312
v_mfma_f32_16x16x32_bf16 v[136:139], a[152:155], v[80:83], v[136:139]
buffer_load_dwordx4 v16, s[32:35], s64 offen offset:0 sc1 lds
v_mfma_f32_16x16x32_bf16 v[136:139], a[148:151], v[76:79], v[136:139]
ds_read_b128 a[200:203], v2 offset:14336
ds_read_b128 a[204:207], v2 offset:15360
v_mfma_f32_16x16x32_bf16 v[136:139], a[144:147], v[72:75], v[136:139]
s_waitcnt lgkmcnt(6)
v_exp_f32 v120, v120
v_mfma_f32_16x16x32_bf16 v[140:143], a[160:163], v[72:75], v[228:231]
v_exp_f32 v121, v121
v_mfma_f32_16x16x32_bf16 v[140:143], a[164:167], v[76:79], v[140:143]
v_exp_f32 v122, v122
v_mfma_f32_16x16x32_bf16 v[140:143], a[168:171], v[80:83], v[140:143]
v_exp_f32 v123, v123
v_mfma_f32_16x16x32_bf16 v[140:143], a[172:175], v[84:87], v[140:143]
v_exp_f32 v136, v136
v_mfma_f32_16x16x32_bf16 v[124:127], a[172:175], v[68:71], v[224:227]
ds_read_b128 a[144:147], v3 offset:0
v_cvt_pk_bf16_f32 v184, v120, v121
v_mfma_f32_16x16x32_bf16 v[124:127], a[168:171], v[64:67], v[124:127]
v_exp_f32 v137, v137
v_mfma_f32_16x16x32_bf16 v[124:127], a[164:167], v[60:63], v[124:127]
ds_read_b128 a[148:151], v3 offset:8192
v_cvt_pk_bf16_f32 v185, v122, v123
v_mfma_f32_16x16x32_bf16 v[124:127], a[160:163], v[56:59], v[124:127]
v_exp_f32 v138, v138
v_mfma_f32_16x16x32_bf16 v[128:131], a[176:179], v[56:59], v[224:227]
ds_read_b128 a[152:155], v3 offset:1024
v_cvt_pk_bf16_f32 v192, v136, v137
v_mfma_f32_16x16x32_bf16 v[128:131], a[180:183], v[60:63], v[128:131]
s_waitcnt lgkmcnt(3)
v_exp_f32 v139, v139
v_mfma_f32_16x16x32_bf16 v[128:131], a[184:187], v[64:67], v[128:131]
ds_read_b128 a[156:159], v3 offset:9216
v_cvt_pk_bf16_f32 v193, v138, v139
v_mfma_f32_16x16x32_bf16 v[128:131], a[188:191], v[68:71], v[128:131]
v_exp_f32 v140, v140
v_mfma_f32_16x16x32_bf16 v[144:147], a[188:191], v[84:87], v[228:231]
buffer_load_dwordx4 v16, s[32:35], s64 offen offset:1024 sc1 lds
v_mfma_f32_16x16x32_bf16 v[144:147], a[184:187], v[80:83], v[144:147]
v_exp_f32 v141, v141
v_mfma_f32_16x16x32_bf16 v[144:147], a[180:183], v[76:79], v[144:147]
ds_read_b128 a[160:163], v3 offset:2048
v_cvt_pk_bf16_f32 v194, v140, v141
v_mfma_f32_16x16x32_bf16 v[144:147], a[176:179], v[72:75], v[144:147]
v_exp_f32 v142, v142
v_mfma_f32_16x16x32_bf16 v[148:151], a[192:195], v[72:75], v[228:231]
ds_read_b128 a[164:167], v3 offset:10240
ds_read_b128 a[168:171], v3 offset:3072
v_mfma_f32_16x16x32_bf16 v[148:151], a[196:199], v[76:79], v[148:151]
v_exp_f32 v143, v143
v_mfma_f32_16x16x32_bf16 v[148:151], a[200:203], v[80:83], v[148:151]
ds_read_b128 a[172:175], v3 offset:11264
v_cvt_pk_bf16_f32 v195, v142, v143
v_mfma_f32_16x16x32_bf16 v[148:151], a[204:207], v[84:87], v[148:151]
v_exp_f32 v124, v124
v_mfma_f32_16x16x32_bf16 v[132:135], a[204:207], v[68:71], v[224:227]
ds_read_b128 a[176:179], v3 offset:4096
buffer_load_dwordx4 v16, s[32:35], s64 offen offset:2048 sc1 lds
v_mfma_f32_16x16x32_bf16 v[132:135], a[200:203], v[64:67], v[132:135]
v_exp_f32 v125, v125
v_mfma_f32_16x16x32_bf16 v[132:135], a[196:199], v[60:63], v[132:135]
ds_read_b128 a[180:183], v3 offset:12288
v_cvt_pk_bf16_f32 v186, v124, v125
v_mfma_f32_16x16x32_bf16 v[132:135], a[192:195], v[56:59], v[132:135]
v_exp_f32 v126, v126
v_smfmac_f32_16x16x64_bf16 a[136:139], a[240:243], v[200:207], v5
ds_read_b128 a[184:187], v3 offset:5120
v_smfmac_f32_16x16x64_bf16 a[140:143], a[240:243], v[208:215], v5
s_waitcnt lgkmcnt(3)
ds_read_b128 a[188:191], v3 offset:13312
v_mfma_f32_16x16x32_bf16 a[64:67], a[144:147], v[200:203], a[64:67]
v_exp_f32 v127, v127
v_mfma_f32_16x16x32_bf16 a[64:67], a[148:151], v[204:207], a[64:67]
v_exp_f32 v128, v128
v_mfma_f32_16x16x32_bf16 a[96:99], a[148:151], v[212:215], a[96:99]
v_exp_f32 v129, v129
v_mfma_f32_16x16x32_bf16 a[96:99], a[144:147], v[208:211], a[96:99]
ds_read_b128 a[192:195], v3 offset:6144
v_cvt_pk_bf16_f32 v187, v126, v127
v_mfma_f32_16x16x32_bf16 a[100:103], a[152:155], v[208:211], a[100:103]
v_exp_f32 v130, v130
v_mfma_f32_16x16x32_bf16 a[100:103], a[156:159], v[212:215], a[100:103]
ds_read_b128 a[196:199], v3 offset:14336
v_cvt_pk_bf16_f32 v188, v128, v129
v_mfma_f32_16x16x32_bf16 a[68:71], a[156:159], v[204:207], a[68:71]
v_exp_f32 v131, v131
v_mfma_f32_16x16x32_bf16 a[68:71], a[152:155], v[200:203], a[68:71]
ds_read_b128 a[200:203], v3 offset:7168
v_cvt_pk_bf16_f32 v189, v130, v131
v_mfma_f32_16x16x32_bf16 a[72:75], a[160:163], v[200:203], a[72:75]
v_exp_f32 v144, v144
v_mfma_f32_16x16x32_bf16 a[72:75], a[164:167], v[204:207], a[72:75]
buffer_load_dwordx4 v16, s[32:35], s64 offen offset:3072 sc1 lds
v_mfma_f32_16x16x32_bf16 a[104:107], a[164:167], v[212:215], a[104:107]
s_xor_b32 s71, s71, 16384
v_exp_f32 v145, v145
v_mfma_f32_16x16x32_bf16 a[104:107], a[160:163], v[208:211], a[104:107]
ds_read_b128 a[204:207], v3 offset:15360
v_cvt_pk_bf16_f32 v196, v144, v145
v_mfma_f32_16x16x32_bf16 a[108:111], a[168:171], v[208:211], a[108:111]
s_add_u32 s70, s70, 32768
v_exp_f32 v146, v146
v_mfma_f32_16x16x32_bf16 a[108:111], a[172:175], v[212:215], a[108:111]
s_waitcnt vmcnt(8)
s_barrier
v_mfma_f32_16x16x32_bf16 a[76:79], a[172:175], v[204:207], a[76:79]
s_mov_b32 m0, s71
v_exp_f32 v147, v147
v_mfma_f32_16x16x32_bf16 a[76:79], a[168:171], v[200:203], a[76:79]
s_waitcnt lgkmcnt(1)
ds_read_b128 a[144:147], v2 offset:16384
v_cvt_pk_bf16_f32 v197, v146, v147
v_mfma_f32_16x16x32_bf16 a[80:83], a[176:179], v[200:203], a[80:83]
v_exp_f32 v148, v148
v_mfma_f32_16x16x32_bf16 a[80:83], a[180:183], v[204:207], a[80:83]
ds_read_b128 a[148:151], v2 offset:17408
ds_read_b128 a[152:155], v2 offset:18432
v_mfma_f32_16x16x32_bf16 a[112:115], a[180:183], v[212:215], a[112:115]
v_exp_f32 v149, v149
v_mfma_f32_16x16x32_bf16 a[112:115], a[176:179], v[208:211], a[112:115]
ds_read_b128 a[156:159], v2 offset:19456
v_cvt_pk_bf16_f32 v198, v148, v149
v_mfma_f32_16x16x32_bf16 a[116:119], a[184:187], v[208:211], a[116:119]
v_exp_f32 v150, v150
v_mfma_f32_16x16x32_bf16 a[116:119], a[188:191], v[212:215], a[116:119]
buffer_load_dwordx4 v16, s[32:35], s70 offen offset:0 sc1 lds
v_mfma_f32_16x16x32_bf16 a[84:87], a[188:191], v[204:207], a[84:87]
v_exp_f32 v151, v151
v_mfma_f32_16x16x32_bf16 a[84:87], a[184:187], v[200:203], a[84:87]
ds_read_b128 a[160:163], v2 offset:20480
v_cvt_pk_bf16_f32 v199, v150, v151
v_mfma_f32_16x16x32_bf16 a[88:91], a[192:195], v[200:203], a[88:91]
v_exp_f32 v132, v132
v_mfma_f32_16x16x32_bf16 a[88:91], a[196:199], v[204:207], a[88:91]
ds_read_b128 a[164:167], v2 offset:21504
v_mfma_f32_16x16x32_bf16 a[120:123], a[196:199], v[212:215], a[120:123]
v_exp_f32 v133, v133
v_mfma_f32_16x16x32_bf16 a[120:123], a[192:195], v[208:211], a[120:123]
ds_read_b128 a[168:171], v2 offset:22528
v_cvt_pk_bf16_f32 v190, v132, v133
v_mfma_f32_16x16x32_bf16 a[124:127], a[200:203], v[208:211], a[124:127]
s_waitcnt lgkmcnt(3)
v_exp_f32 v134, v134
v_mfma_f32_16x16x32_bf16 a[124:127], a[204:207], v[212:215], a[124:127]
buffer_load_dwordx4 v16, s[32:35], s70 offen offset:1024 sc1 lds
v_mfma_f32_16x16x32_bf16 a[92:95], a[204:207], v[204:207], a[92:95]
v_exp_f32 v135, v135
v_mfma_f32_16x16x32_bf16 a[92:95], a[200:203], v[200:203], a[92:95]
ds_read_b128 a[172:175], v2 offset:23552
v_cvt_pk_bf16_f32 v191, v134, v135
v_mfma_f32_16x16x32_bf16 v[120:123], a[144:147], v[56:59], v[224:227]
ds_read_b128 a[176:179], v2 offset:24576
ds_read_b128 a[180:183], v2 offset:25600
v_mfma_f32_16x16x32_bf16 v[120:123], a[148:151], v[60:63], v[120:123]
buffer_load_dwordx4 v16, s[32:35], s70 offen offset:2048 sc1 lds
v_mfma_f32_16x16x32_bf16 v[120:123], a[152:155], v[64:67], v[120:123]
s_add_u32 s64, s70, 4096
ds_read_b128 a[184:187], v2 offset:26624
ds_read_b128 a[188:191], v2 offset:27648
v_mfma_f32_16x16x32_bf16 v[120:123], a[156:159], v[68:71], v[120:123]
buffer_load_dwordx4 v16, s[32:35], s70 offen offset:3072 sc1 lds
v_mfma_f32_16x16x32_bf16 v[136:139], a[156:159], v[84:87], v[228:231]
s_add_u32 m0, s71, 4096
ds_read_b128 a[192:195], v2 offset:28672
ds_read_b128 a[196:199], v2 offset:29696
v_mfma_f32_16x16x32_bf16 v[136:139], a[152:155], v[80:83], v[136:139]
buffer_load_dwordx4 v16, s[32:35], s64 offen offset:0 sc1 lds
v_mfma_f32_16x16x32_bf16 v[136:139], a[148:151], v[76:79], v[136:139]
ds_read_b128 a[200:203], v2 offset:30720
ds_read_b128 a[204:207], v2 offset:31744
v_mfma_f32_16x16x32_bf16 v[136:139], a[144:147], v[72:75], v[136:139]
s_waitcnt lgkmcnt(6)
v_exp_f32 v120, v120
v_mfma_f32_16x16x32_bf16 v[140:143], a[160:163], v[72:75], v[228:231]
v_exp_f32 v121, v121
v_mfma_f32_16x16x32_bf16 v[140:143], a[164:167], v[76:79], v[140:143]
v_exp_f32 v122, v122
v_mfma_f32_16x16x32_bf16 v[140:143], a[168:171], v[80:83], v[140:143]
v_exp_f32 v123, v123
v_mfma_f32_16x16x32_bf16 v[140:143], a[172:175], v[84:87], v[140:143]
v_exp_f32 v136, v136
v_mfma_f32_16x16x32_bf16 v[124:127], a[172:175], v[68:71], v[224:227]
ds_read_b128 a[144:147], v3 offset:16384
v_cvt_pk_bf16_f32 v200, v120, v121
v_mfma_f32_16x16x32_bf16 v[124:127], a[168:171], v[64:67], v[124:127]
v_exp_f32 v137, v137
v_mfma_f32_16x16x32_bf16 v[124:127], a[164:167], v[60:63], v[124:127]
ds_read_b128 a[148:151], v3 offset:24576
v_cvt_pk_bf16_f32 v201, v122, v123
v_mfma_f32_16x16x32_bf16 v[124:127], a[160:163], v[56:59], v[124:127]
v_exp_f32 v138, v138
v_mfma_f32_16x16x32_bf16 v[128:131], a[176:179], v[56:59], v[224:227]
ds_read_b128 a[152:155], v3 offset:17408
v_cvt_pk_bf16_f32 v208, v136, v137
v_mfma_f32_16x16x32_bf16 v[128:131], a[180:183], v[60:63], v[128:131]
s_waitcnt lgkmcnt(3)
v_exp_f32 v139, v139
v_mfma_f32_16x16x32_bf16 v[128:131], a[184:187], v[64:67], v[128:131]
ds_read_b128 a[156:159], v3 offset:25600
v_cvt_pk_bf16_f32 v209, v138, v139
v_mfma_f32_16x16x32_bf16 v[128:131], a[188:191], v[68:71], v[128:131]
v_exp_f32 v140, v140
v_mfma_f32_16x16x32_bf16 v[144:147], a[188:191], v[84:87], v[228:231]
buffer_load_dwordx4 v16, s[32:35], s64 offen offset:1024 sc1 lds
v_mfma_f32_16x16x32_bf16 v[144:147], a[184:187], v[80:83], v[144:147]
v_exp_f32 v141, v141
v_mfma_f32_16x16x32_bf16 v[144:147], a[180:183], v[76:79], v[144:147]
ds_read_b128 a[160:163], v3 offset:18432
v_cvt_pk_bf16_f32 v210, v140, v141
v_mfma_f32_16x16x32_bf16 v[144:147], a[176:179], v[72:75], v[144:147]
v_exp_f32 v142, v142
v_mfma_f32_16x16x32_bf16 v[148:151], a[192:195], v[72:75], v[228:231]
ds_read_b128 a[164:167], v3 offset:26624
ds_read_b128 a[168:171], v3 offset:19456
v_mfma_f32_16x16x32_bf16 v[148:151], a[196:199], v[76:79], v[148:151]
v_exp_f32 v143, v143
v_mfma_f32_16x16x32_bf16 v[148:151], a[200:203], v[80:83], v[148:151]
ds_read_b128 a[172:175], v3 offset:27648
v_cvt_pk_bf16_f32 v211, v142, v143
v_mfma_f32_16x16x32_bf16 v[148:151], a[204:207], v[84:87], v[148:151]
v_exp_f32 v124, v124
v_mfma_f32_16x16x32_bf16 v[132:135], a[204:207], v[68:71], v[224:227]
ds_read_b128 a[176:179], v3 offset:20480
buffer_load_dwordx4 v16, s[32:35], s64 offen offset:2048 sc1 lds
v_mfma_f32_16x16x32_bf16 v[132:135], a[200:203], v[64:67], v[132:135]
v_exp_f32 v125, v125
v_mfma_f32_16x16x32_bf16 v[132:135], a[196:199], v[60:63], v[132:135]
ds_read_b128 a[180:183], v3 offset:28672
v_cvt_pk_bf16_f32 v202, v124, v125
v_mfma_f32_16x16x32_bf16 v[132:135], a[192:195], v[56:59], v[132:135]
v_exp_f32 v126, v126
v_smfmac_f32_16x16x64_bf16 a[136:139], a[240:243], v[184:191], v5
ds_read_b128 a[184:187], v3 offset:21504
v_smfmac_f32_16x16x64_bf16 a[140:143], a[240:243], v[192:199], v5
s_waitcnt lgkmcnt(3)
ds_read_b128 a[188:191], v3 offset:29696
v_mfma_f32_16x16x32_bf16 a[64:67], a[144:147], v[184:187], a[64:67]
v_exp_f32 v127, v127
v_mfma_f32_16x16x32_bf16 a[64:67], a[148:151], v[188:191], a[64:67]
v_exp_f32 v128, v128
v_mfma_f32_16x16x32_bf16 a[96:99], a[148:151], v[196:199], a[96:99]
v_exp_f32 v129, v129
v_mfma_f32_16x16x32_bf16 a[96:99], a[144:147], v[192:195], a[96:99]
ds_read_b128 a[192:195], v3 offset:22528
v_cvt_pk_bf16_f32 v203, v126, v127
v_mfma_f32_16x16x32_bf16 a[100:103], a[152:155], v[192:195], a[100:103]
v_exp_f32 v130, v130
v_mfma_f32_16x16x32_bf16 a[100:103], a[156:159], v[196:199], a[100:103]
ds_read_b128 a[196:199], v3 offset:30720
v_cvt_pk_bf16_f32 v204, v128, v129
v_mfma_f32_16x16x32_bf16 a[68:71], a[156:159], v[188:191], a[68:71]
v_exp_f32 v131, v131
v_mfma_f32_16x16x32_bf16 a[68:71], a[152:155], v[184:187], a[68:71]
ds_read_b128 a[200:203], v3 offset:23552
v_cvt_pk_bf16_f32 v205, v130, v131
v_mfma_f32_16x16x32_bf16 a[72:75], a[160:163], v[184:187], a[72:75]
v_exp_f32 v144, v144
v_mfma_f32_16x16x32_bf16 a[72:75], a[164:167], v[188:191], a[72:75]
buffer_load_dwordx4 v16, s[32:35], s64 offen offset:3072 sc1 lds
v_mfma_f32_16x16x32_bf16 a[104:107], a[164:167], v[196:199], a[104:107]
s_xor_b32 s71, s71, 49152
v_exp_f32 v145, v145
v_mfma_f32_16x16x32_bf16 a[104:107], a[160:163], v[192:195], a[104:107]
ds_read_b128 a[204:207], v3 offset:31744
v_cvt_pk_bf16_f32 v212, v144, v145
v_mfma_f32_16x16x32_bf16 a[108:111], a[168:171], v[192:195], a[108:111]
s_add_u32 s70, s70, 32768
v_xor_b32 v2, 0x8000, v2
v_exp_f32 v146, v146
v_mfma_f32_16x16x32_bf16 a[108:111], a[172:175], v[196:199], a[108:111]
s_waitcnt vmcnt(8)
s_barrier
v_mfma_f32_16x16x32_bf16 a[76:79], a[172:175], v[188:191], a[76:79]
s_mov_b32 m0, s71
v_exp_f32 v147, v147
v_mfma_f32_16x16x32_bf16 a[76:79], a[168:171], v[184:187], a[76:79]
s_waitcnt lgkmcnt(1)
ds_read_b128 a[144:147], v2 offset:0
v_cvt_pk_bf16_f32 v213, v146, v147
v_mfma_f32_16x16x32_bf16 a[80:83], a[176:179], v[184:187], a[80:83]
v_exp_f32 v148, v148
v_mfma_f32_16x16x32_bf16 a[80:83], a[180:183], v[188:191], a[80:83]
ds_read_b128 a[148:151], v2 offset:1024
ds_read_b128 a[152:155], v2 offset:2048
v_mfma_f32_16x16x32_bf16 a[112:115], a[180:183], v[196:199], a[112:115]
v_exp_f32 v149, v149
v_mfma_f32_16x16x32_bf16 a[112:115], a[176:179], v[192:195], a[112:115]
ds_read_b128 a[156:159], v2 offset:3072
v_cvt_pk_bf16_f32 v214, v148, v149
v_mfma_f32_16x16x32_bf16 a[116:119], a[184:187], v[192:195], a[116:119]
v_exp_f32 v150, v150
v_mfma_f32_16x16x32_bf16 a[116:119], a[188:191], v[196:199], a[116:119]
buffer_load_dwordx4 v16, s[32:35], s70 offen offset:0 sc1 lds
v_mfma_f32_16x16x32_bf16 a[84:87], a[188:191], v[188:191], a[84:87]
s_sub_u32 s72, s72, 1
v_exp_f32 v151, v151
v_mfma_f32_16x16x32_bf16 a[84:87], a[184:187], v[184:187], a[84:87]
ds_read_b128 a[160:163], v2 offset:4096
v_cvt_pk_bf16_f32 v215, v150, v151
v_mfma_f32_16x16x32_bf16 a[88:91], a[192:195], v[184:187], a[88:91]
v_exp_f32 v132, v132
v_mfma_f32_16x16x32_bf16 a[88:91], a[196:199], v[188:191], a[88:91]
ds_read_b128 a[164:167], v2 offset:5120
v_xor_b32 v3, 0x8000, v3
v_mfma_f32_16x16x32_bf16 a[120:123], a[196:199], v[196:199], a[120:123]
s_cmp_lg_u32 s72, 0
v_exp_f32 v133, v133
v_mfma_f32_16x16x32_bf16 a[120:123], a[192:195], v[192:195], a[120:123]
ds_read_b128 a[168:171], v2 offset:6144
v_cvt_pk_bf16_f32 v206, v132, v133
v_mfma_f32_16x16x32_bf16 a[124:127], a[200:203], v[192:195], a[124:127]
s_waitcnt lgkmcnt(3)
v_exp_f32 v134, v134
v_mfma_f32_16x16x32_bf16 a[124:127], a[204:207], v[196:199], a[124:127]
buffer_load_dwordx4 v16, s[32:35], s70 offen offset:1024 sc1 lds
v_mfma_f32_16x16x32_bf16 a[92:95], a[204:207], v[188:191], a[92:95]
v_exp_f32 v135, v135
v_mfma_f32_16x16x32_bf16 a[92:95], a[200:203], v[184:187], a[92:95]
ds_read_b128 a[172:175], v2 offset:7168
v_cvt_pk_bf16_f32 v207, v134, v135
s_cbranch_scc1 L_S
L_SD:
buffer_load_dword v19, off, s[52:55], s80 sc1
s_waitcnt lgkmcnt(7)
v_mfma_f32_16x16x32_bf16 v[136:139], a[144:147], v[72:75], v[228:231]
s_waitcnt lgkmcnt(6)
ds_read_b128 a[176:179], v2 offset:8192
ds_read_b128 a[180:183], v2 offset:9216
v_mfma_f32_16x16x32_bf16 v[136:139], a[148:151], v[76:79], v[136:139]
s_waitcnt lgkmcnt(7)
buffer_load_dwordx4 v16, s[32:35], s70 offen offset:2048 sc1 lds
v_cndmask_b32 v120, v224, v17, s[0:1]
v_cndmask_b32 v121, v224, v17, s[4:5]
v_cndmask_b32 v122, v224, v17, s[6:7]
v_cndmask_b32 v123, v224, v17, s[8:9]
v_mfma_f32_16x16x32_bf16 v[136:139], a[152:155], v[80:83], v[136:139]
s_waitcnt lgkmcnt(6)
s_add_u32 s64, s70, 4096
ds_read_b128 a[184:187], v2 offset:10240
ds_read_b128 a[188:191], v2 offset:11264
v_mfma_f32_16x16x32_bf16 v[136:139], a[156:159], v[84:87], v[136:139]
buffer_load_dwordx4 v16, s[32:35], s70 offen offset:3072 sc1 lds
v_mfma_f32_16x16x32_bf16 v[120:123], a[156:159], v[68:71], v[120:123]
s_add_u32 m0, s71, 4096
ds_read_b128 a[192:195], v2 offset:12288
ds_read_b128 a[196:199], v2 offset:13312
v_mfma_f32_16x16x32_bf16 v[120:123], a[152:155], v[64:67], v[120:123]
buffer_load_dwordx4 v16, s[32:35], s64 offen offset:0 sc1 lds
v_mfma_f32_16x16x32_bf16 v[120:123], a[148:151], v[60:63], v[120:123]
ds_read_b128 a[200:203], v2 offset:14336
ds_read_b128 a[204:207], v2 offset:15360
v_mfma_f32_16x16x32_bf16 v[120:123], a[144:147], v[56:59], v[120:123]
s_waitcnt lgkmcnt(6)
v_exp_f32 v136, v136
v_mfma_f32_16x16x32_bf16 v[140:143], a[160:163], v[72:75], v[228:231]
v_exp_f32 v137, v137
v_mfma_f32_16x16x32_bf16 v[140:143], a[164:167], v[76:79], v[140:143]
v_cndmask_b32 v124, v224, v17, s[10:11]
v_cndmask_b32 v125, v224, v17, s[12:13]
v_cndmask_b32 v126, v224, v17, s[18:19]
v_cndmask_b32 v127, v224, v17, s[22:23]
v_exp_f32 v138, v138
v_mfma_f32_16x16x32_bf16 v[140:143], a[168:171], v[80:83], v[140:143]
v_exp_f32 v139, v139
v_mfma_f32_16x16x32_bf16 v[140:143], a[172:175], v[84:87], v[140:143]
v_exp_f32 v120, v120
v_mfma_f32_16x16x32_bf16 v[124:127], a[172:175], v[68:71], v[124:127]
ds_read_b128 a[144:147], v3 offset:0
v_cvt_pk_bf16_f32 v192, v136, v137
v_mfma_f32_16x16x32_bf16 v[124:127], a[168:171], v[64:67], v[124:127]
v_cndmask_b32 v128, v224, v17, s[26:27]
v_cndmask_b32 v129, v224, v17, s[56:57]
v_cndmask_b32 v130, v224, v17, s[58:59]
v_cndmask_b32 v131, v224, v17, s[60:61]
v_exp_f32 v121, v121
v_mfma_f32_16x16x32_bf16 v[124:127], a[164:167], v[60:63], v[124:127]
s_mul_i32 s69, s83, 8
ds_read_b128 a[148:151], v3 offset:8192
v_cvt_pk_bf16_f32 v193, v138, v139
v_mfma_f32_16x16x32_bf16 v[124:127], a[160:163], v[56:59], v[124:127]
s_sub_u32 s69, 36, s69
v_exp_f32 v122, v122
v_mfma_f32_16x16x32_bf16 v[128:131], a[176:179], v[56:59], v[128:131]
ds_read_b128 a[152:155], v3 offset:1024
v_cvt_pk_bf16_f32 v184, v120, v121
v_mfma_f32_16x16x32_bf16 v[128:131], a[180:183], v[60:63], v[128:131]
s_waitcnt lgkmcnt(3)
v_exp_f32 v123, v123
v_mfma_f32_16x16x32_bf16 v[128:131], a[184:187], v[64:67], v[128:131]
ds_read_b128 a[156:159], v3 offset:9216
v_cvt_pk_bf16_f32 v185, v122, v123
v_mfma_f32_16x16x32_bf16 v[128:131], a[188:191], v[68:71], v[128:131]
v_exp_f32 v140, v140
v_mfma_f32_16x16x32_bf16 v[144:147], a[188:191], v[84:87], v[228:231]
buffer_load_dwordx4 v16, s[32:35], s64 offen offset:1024 sc1 lds
v_mfma_f32_16x16x32_bf16 v[144:147], a[184:187], v[80:83], v[144:147]
v_exp_f32 v141, v141
v_mfma_f32_16x16x32_bf16 v[144:147], a[180:183], v[76:79], v[144:147]
ds_read_b128 a[160:163], v3 offset:2048
v_cvt_pk_bf16_f32 v194, v140, v141
v_mfma_f32_16x16x32_bf16 v[144:147], a[176:179], v[72:75], v[144:147]
v_exp_f32 v142, v142
v_mfma_f32_16x16x32_bf16 v[148:151], a[192:195], v[72:75], v[228:231]
ds_read_b128 a[164:167], v3 offset:10240
ds_read_b128 a[168:171], v3 offset:3072
v_mfma_f32_16x16x32_bf16 v[148:151], a[196:199], v[76:79], v[148:151]
v_cndmask_b32 v132, v224, v17, s[62:63]
v_cndmask_b32 v133, v224, v17, s[48:49]
v_cndmask_b32 v134, v224, v17, s[50:51]
v_cndmask_b32 v135, v224, v17, s[100:101]
v_exp_f32 v143, v143
v_mfma_f32_16x16x32_bf16 v[148:151], a[200:203], v[80:83], v[148:151]
ds_read_b128 a[172:175], v3 offset:11264
v_cvt_pk_bf16_f32 v195, v142, v143
v_mfma_f32_16x16x32_bf16 v[148:151], a[204:207], v[84:87], v[148:151]
v_exp_f32 v124, v124
v_mfma_f32_16x16x32_bf16 v[132:135], a[204:207], v[68:71], v[132:135]
ds_read_b128 a[176:179], v3 offset:4096
buffer_load_dwordx4 v16, s[32:35], s64 offen offset:2048 sc1 lds
v_mfma_f32_16x16x32_bf16 v[132:135], a[200:203], v[64:67], v[132:135]
s_branch L_po20
L_pg20:
s_branch L_pg25
L_po20:
v_exp_f32 v125, v125
v_mfma_f32_16x16x32_bf16 v[132:135], a[196:199], v[60:63], v[132:135]
ds_read_b128 a[180:183], v3 offset:12288
v_cvt_pk_bf16_f32 v186, v124, v125
v_mfma_f32_16x16x32_bf16 v[132:135], a[192:195], v[56:59], v[132:135]
v_exp_f32 v126, v126
v_smfmac_f32_16x16x64_bf16 a[136:139], a[240:243], v[200:207], v5
ds_read_b128 a[184:187], v3 offset:5120
v_smfmac_f32_16x16x64_bf16 a[140:143], a[240:243], v[208:215], v5
s_waitcnt lgkmcnt(3)
ds_read_b128 a[188:191], v3 offset:13312
v_mfma_f32_16x16x32_bf16 a[64:67], a[144:147], v[200:203], a[64:67]
v_exp_f32 v127, v127
v_mfma_f32_16x16x32_bf16 a[64:67], a[148:151], v[204:207], a[64:67]
v_exp_f32 v128, v128
v_mfma_f32_16x16x32_bf16 a[96:99], a[148:151], v[212:215], a[96:99]
v_exp_f32 v129, v129
v_mfma_f32_16x16x32_bf16 a[96:99], a[144:147], v[208:211], a[96:99]
ds_read_b128 a[192:195], v3 offset:6144
v_cvt_pk_bf16_f32 v187, v126, v127
v_mfma_f32_16x16x32_bf16 a[100:103], a[152:155], v[208:211], a[100:103]
v_exp_f32 v130, v130
v_mfma_f32_16x16x32_bf16 a[100:103], a[156:159], v[212:215], a[100:103]
ds_read_b128 a[196:199], v3 offset:14336
v_cvt_pk_bf16_f32 v188, v128, v129
v_mfma_f32_16x16x32_bf16 a[68:71], a[156:159], v[204:207], a[68:71]
v_exp_f32 v131, v131
v_mfma_f32_16x16x32_bf16 a[68:71], a[152:155], v[200:203], a[68:71]
ds_read_b128 a[200:203], v3 offset:7168
v_cvt_pk_bf16_f32 v189, v130, v131
v_mfma_f32_16x16x32_bf16 a[72:75], a[160:163], v[200:203], a[72:75]
v_exp_f32 v144, v144
v_mfma_f32_16x16x32_bf16 a[72:75], a[164:167], v[204:207], a[72:75]
buffer_load_dwordx4 v16, s[32:35], s64 offen offset:3072 sc1 lds
v_mfma_f32_16x16x32_bf16 a[104:107], a[164:167], v[212:215], a[104:107]
v_exp_f32 v145, v145
v_mfma_f32_16x16x32_bf16 a[104:107], a[160:163], v[208:211], a[104:107]
ds_read_b128 a[204:207], v3 offset:15360
v_cvt_pk_bf16_f32 v196, v144, v145
v_mfma_f32_16x16x32_bf16 a[108:111], a[168:171], v[208:211], a[108:111]
v_exp_f32 v146, v146
v_mfma_f32_16x16x32_bf16 a[108:111], a[172:175], v[212:215], a[108:111]
s_waitcnt vmcnt(9)
s_barrier
v_mfma_f32_16x16x32_bf16 a[76:79], a[172:175], v[204:207], a[76:79]
v_exp_f32 v147, v147
v_mfma_f32_16x16x32_bf16 a[76:79], a[168:171], v[200:203], a[76:79]
s_waitcnt lgkmcnt(1)
ds_read_b128 a[144:147], v2 offset:16384
v_cvt_pk_bf16_f32 v197, v146, v147
v_mfma_f32_16x16x32_bf16 a[80:83], a[176:179], v[200:203], a[80:83]
s_waitcnt vmcnt(6)
v_readfirstlane_b32 vcc_lo, v19
s_nop 0
s_cmp_lt_u32 vcc_lo, s69
s_cbranch_scc1 L_spin_8
L_spinbk_9:
v_exp_f32 v148, v148
v_mfma_f32_16x16x32_bf16 a[80:83], a[180:183], v[204:207], a[80:83]
ds_read_b128 a[148:151], v2 offset:17408
ds_read_b128 a[152:155], v2 offset:18432
v_mfma_f32_16x16x32_bf16 a[112:115], a[180:183], v[212:215], a[112:115]
v_exp_f32 v149, v149
v_mfma_f32_16x16x32_bf16 a[112:115], a[176:179], v[208:211], a[112:115]
ds_read_b128 a[156:159], v2 offset:19456
v_cvt_pk_bf16_f32 v198, v148, v149
v_mfma_f32_16x16x32_bf16 a[116:119], a[184:187], v[208:211], a[116:119]
v_exp_f32 v150, v150
v_mfma_f32_16x16x32_bf16 a[116:119], a[188:191], v[212:215], a[116:119]
v_cndmask_b32 v136, v228, v17, s[0:1]
v_cndmask_b32 v137, v228, v17, s[4:5]
v_mfma_f32_16x16x32_bf16 a[84:87], a[188:191], v[204:207], a[84:87]
v_exp_f32 v151, v151
v_mfma_f32_16x16x32_bf16 a[84:87], a[184:187], v[200:203], a[84:87]
ds_read_b128 a[160:163], v2 offset:20480
v_cvt_pk_bf16_f32 v199, v150, v151
v_mfma_f32_16x16x32_bf16 a[88:91], a[192:195], v[200:203], a[88:91]
v_exp_f32 v132, v132
v_mfma_f32_16x16x32_bf16 a[88:91], a[196:199], v[204:207], a[88:91]
ds_read_b128 a[164:167], v2 offset:21504
v_cndmask_b32 v138, v228, v17, s[6:7]
v_mfma_f32_16x16x32_bf16 a[120:123], a[196:199], v[212:215], a[120:123]
v_exp_f32 v133, v133
v_mfma_f32_16x16x32_bf16 a[120:123], a[192:195], v[208:211], a[120:123]
ds_read_b128 a[168:171], v2 offset:22528
v_cvt_pk_bf16_f32 v190, v132, v133
v_mfma_f32_16x16x32_bf16 a[124:127], a[200:203], v[208:211], a[124:127]
s_waitcnt lgkmcnt(3)
v_exp_f32 v134, v134
v_mfma_f32_16x16x32_bf16 a[124:127], a[204:207], v[212:215], a[124:127]
v_cndmask_b32 v139, v228, v17, s[8:9]
v_cndmask_b32 v140, v228, v17, s[10:11]
v_mfma_f32_16x16x32_bf16 a[92:95], a[204:207], v[204:207], a[92:95]
v_exp_f32 v135, v135
v_mfma_f32_16x16x32_bf16 a[92:95], a[200:203], v[200:203], a[92:95]
ds_read_b128 a[172:175], v2 offset:23552
v_cvt_pk_bf16_f32 v191, v134, v135
v_mfma_f32_16x16x32_bf16 v[136:139], a[144:147], v[72:75], v[136:139]
ds_read_b128 a[176:179], v2 offset:24576
v_cndmask_b32 v141, v228, v17, s[12:13]
v_mfma_f32_16x16x32_bf16 v[136:139], a[148:151], v[76:79], v[136:139]
ds_read_b128 a[180:183], v2 offset:25600
v_cndmask_b32 v142, v228, v17, s[18:19]
v_cndmask_b32 v143, v228, v17, s[22:23]
v_mfma_f32_16x16x32_bf16 v[136:139], a[152:155], v[80:83], v[136:139]
ds_read_b128 a[184:187], v2 offset:26624
v_cndmask_b32 v144, v228, v17, s[26:27]
v_mfma_f32_16x16x32_bf16 v[136:139], a[156:159], v[84:87], v[136:139]
s_waitcnt lgkmcnt(3)
ds_read_b128 a[188:191], v2 offset:27648
v_cndmask_b32 v145, v228, v17, s[56:57]
v_mfma_f32_16x16x32_bf16 v[140:143], a[172:175], v[84:87], v[140:143]
ds_read_b128 a[192:195], v2 offset:28672
ds_read_b128 a[196:199], v2 offset:29696
ds_read_b128 a[200:203], v2 offset:30720
ds_read_b128 a[204:207], v2 offset:31744
v_mfma_f32_16x16x32_bf16 v[140:143], a[168:171], v[80:83], v[140:143]
ds_read_b128 a[144:147], v3 offset:16384
v_cndmask_b32 v146, v228, v17, s[58:59]
v_cndmask_b32 v147, v228, v17, s[60:61]
v_mfma_f32_16x16x32_bf16 v[140:143], a[164:167], v[76:79], v[140:143]
ds_read_b128 a[148:151], v3 offset:24576
v_cndmask_b32 v148, v228, v17, s[62:63]
v_mfma_f32_16x16x32_bf16 v[140:143], a[160:163], v[72:75], v[140:143]
s_waitcnt lgkmcnt(8)
ds_read_b128 a[152:155], v3 offset:17408
v_cndmask_b32 v149, v228, v17, s[48:49]
v_mfma_f32_16x16x32_bf16 v[144:147], a[176:179], v[72:75], v[144:147]
ds_read_b128 a[156:159], v3 offset:25600
v_cndmask_b32 v150, v228, v17, s[50:51]
v_mfma_f32_16x16x32_bf16 v[144:147], a[180:183], v[76:79], v[144:147]
s_waitcnt lgkmcnt(8)
ds_read_b128 a[160:163], v3 offset:18432
v_cndmask_b32 v151, v228, v17, s[100:101]
v_mfma_f32_16x16x32_bf16 v[144:147], a[184:187], v[80:83], v[144:147]
v_exp_f32 v136, v136
v_mfma_f32_16x16x32_bf16 v[144:147], a[188:191], v[84:87], v[144:147]
s_waitcnt lgkmcnt(4)
v_exp_f32 v137, v137
v_mfma_f32_16x16x32_bf16 v[148:151], a[204:207], v[84:87], v[148:151]
v_exp_f32 v138, v138
v_mfma_f32_16x16x32_bf16 v[148:151], a[200:203], v[80:83], v[148:151]
s_add_u32 s65, s84, 0
v_exp_f32 v139, v139
v_mfma_f32_16x16x32_bf16 v[148:151], a[196:199], v[76:79], v[148:151]
buffer_load_dwordx4 a[208:211], v14, s[44:47], s65 offen offset:0 sc1
v_mfma_f32_16x16x32_bf16 v[148:151], a[192:195], v[72:75], v[148:151]
ds_read_b128 a[164:167], v3 offset:26624
v_cvt_pk_bf16_f32 v208, v136, v137
v_smfmac_f32_16x16x64_bf16 a[136:139], a[240:243], v[184:191], v5
ds_read_b128 a[168:171], v3 offset:19456
v_smfmac_f32_16x16x64_bf16 a[140:143], a[240:243], v[192:199], v5
ds_read_b128 a[172:175], v3 offset:27648
v_mfma_f32_16x16x32_bf16 a[64:67], a[144:147], v[184:187], a[64:67]
s_waitcnt lgkmcnt(3)
v_exp_f32 v140, v140
v_mfma_f32_16x16x32_bf16 a[64:67], a[148:151], v[188:191], a[64:67]
buffer_load_dwordx4 a[216:219], v14, s[44:47], s65 offen offset:1024 sc1
v_mfma_f32_16x16x32_bf16 a[96:99], a[148:151], v[196:199], a[96:99]
v_exp_f32 v141, v141
v_mfma_f32_16x16x32_bf16 a[96:99], a[144:147], v[192:195], a[96:99]
buffer_load_dwordx4 a[224:227], v15, s[44:47], s65 offen offset:0 sc1
v_mfma_f32_16x16x32_bf16 a[100:103], a[152:155], v[192:195], a[100:103]
v_exp_f32 v142, v142
v_mfma_f32_16x16x32_bf16 a[100:103], a[156:159], v[196:199], a[100:103]
buffer_load_dwordx4 a[232:235], v15, s[44:47], s65 offen offset:1024 sc1
v_mfma_f32_16x16x32_bf16 a[68:71], a[156:159], v[188:191], a[68:71]
s_add_u32 s65, s84, 8192
ds_read_b128 a[176:179], v3 offset:20480
v_cvt_pk_bf16_f32 v209, v138, v139
v_mfma_f32_16x16x32_bf16 a[68:71], a[152:155], v[184:187], a[68:71]
buffer_load_dwordx4 a[212:215], v14, s[44:47], s65 offen offset:0 sc1
v_mfma_f32_16x16x32_bf16 a[72:75], a[160:163], v[184:187], a[72:75]
s_waitcnt lgkmcnt(1)
ds_read_b128 a[180:183], v3 offset:28672
v_cvt_pk_bf16_f32 v210, v140, v141
v_mfma_f32_16x16x32_bf16 a[72:75], a[164:167], v[188:191], a[72:75]
v_exp_f32 v143, v143
v_mfma_f32_16x16x32_bf16 a[104:107], a[164:167], v[196:199], a[104:107]
buffer_load_dwordx4 a[220:223], v14, s[44:47], s65 offen offset:1024 sc1
v_mfma_f32_16x16x32_bf16 a[104:107], a[160:163], v[192:195], a[104:107]
v_exp_f32 v144, v144
v_mfma_f32_16x16x32_bf16 a[108:111], a[168:171], v[192:195], a[108:111]
ds_read_b128 a[184:187], v3 offset:21504
v_xor_b32 v2, 0x8000, v2
v_mfma_f32_16x16x32_bf16 a[108:111], a[172:175], v[196:199], a[108:111]
buffer_load_dwordx4 a[228:231], v15, s[44:47], s65 offen offset:0 sc1
ds_read_b128 a[188:191], v3 offset:29696
v_mfma_f32_16x16x32_bf16 a[76:79], a[172:175], v[188:191], a[76:79]
v_exp_f32 v145, v145
v_mfma_f32_16x16x32_bf16 a[76:79], a[168:171], v[184:187], a[76:79]
s_waitcnt lgkmcnt(2)
buffer_load_dwordx4 a[236:239], v15, s[44:47], s65 offen offset:1024 sc1
v_mfma_f32_16x16x32_bf16 a[80:83], a[176:179], v[184:187], a[80:83]
s_add_u32 s65, s84, 32768
ds_read_b128 a[192:195], v3 offset:22528
v_cvt_pk_bf16_f32 v211, v142, v143
v_mfma_f32_16x16x32_bf16 a[80:83], a[180:183], v[188:191], a[80:83]
buffer_load_dwordx4 v[152:155], v14, s[44:47], s65 offen offset:0 sc1
ds_read_b128 a[196:199], v3 offset:30720
v_exp_f32 v146, v146
v_mfma_f32_16x16x32_bf16 a[112:115], a[180:183], v[196:199], a[112:115]
ds_read_b128 a[200:203], v3 offset:23552
ds_read_b128 a[204:207], v3 offset:31744
v_mfma_f32_16x16x32_bf16 a[112:115], a[176:179], v[192:195], a[112:115]
s_waitcnt vmcnt(9)
s_barrier
v_xor_b32 v3, 0x8000, v3
buffer_load_dwordx4 v[160:163], v14, s[44:47], s65 offen offset:1024 sc1
s_waitcnt lgkmcnt(4)
v_mfma_f32_16x16x32_bf16 a[116:119], a[184:187], v[192:195], a[116:119]
v_exp_f32 v147, v147
v_mfma_f32_16x16x32_bf16 a[116:119], a[188:191], v[196:199], a[116:119]
buffer_load_dwordx4 v[168:171], v15, s[44:47], s65 offen offset:0 sc1
v_mfma_f32_16x16x32_bf16 a[84:87], a[188:191], v[188:191], a[84:87]
v_exp_f32 v148, v148
v_mfma_f32_16x16x32_bf16 a[84:87], a[184:187], v[184:187], a[84:87]
s_waitcnt lgkmcnt(2)
buffer_load_dwordx4 v[176:179], v15, s[44:47], s65 offen offset:1024 sc1
v_cvt_pk_bf16_f32 v212, v144, v145
v_mfma_f32_16x16x32_bf16 a[88:91], a[192:195], v[184:187], a[88:91]
s_add_u32 s65, s84, 40960
v_exp_f32 v149, v149
v_mfma_f32_16x16x32_bf16 a[88:91], a[196:199], v[188:191], a[88:91]
buffer_load_dwordx4 v[156:159], v14, s[44:47], s65 offen offset:0 sc1
v_mfma_f32_16x16x32_bf16 a[120:123], a[196:199], v[196:199], a[120:123]
ds_read_b128 a[144:147], v3 offset:0
v_cvt_pk_bf16_f32 v213, v146, v147
v_mfma_f32_16x16x32_bf16 a[120:123], a[192:195], v[192:195], a[120:123]
s_waitcnt lgkmcnt(1)
buffer_load_dwordx4 v[164:167], v14, s[44:47], s65 offen offset:1024 sc1
ds_read_b128 a[148:151], v3 offset:8192
v_exp_f32 v150, v150
v_mfma_f32_16x16x32_bf16 a[124:127], a[200:203], v[192:195], a[124:127]
ds_read_b128 a[152:155], v3 offset:1024
v_cvt_pk_bf16_f32 v214, v148, v149
v_mfma_f32_16x16x32_bf16 a[124:127], a[204:207], v[196:199], a[124:127]
buffer_load_dwordx4 v[172:175], v15, s[44:47], s65 offen offset:0 sc1
ds_read_b128 a[156:159], v3 offset:9216
v_mfma_f32_16x16x32_bf16 a[92:95], a[204:207], v[188:191], a[92:95]
v_exp_f32 v151, v151
v_mfma_f32_16x16x32_bf16 a[92:95], a[200:203], v[184:187], a[92:95]
buffer_load_dwordx4 v[180:183], v15, s[44:47], s65 offen offset:1024 sc1
ds_read_b128 a[160:163], v3 offset:2048
ds_read_b128 a[164:167], v3 offset:10240
ds_read_b128 a[168:171], v3 offset:3072
ds_read_b128 a[172:175], v3 offset:11264
v_cvt_pk_bf16_f32 v215, v150, v151
v_accvgpr_read_b32 v22, a136
v_accvgpr_read_b32 v248, a137
v_add_f32 v22, v22, v248
v_max_f32 v1, v1, v22
v_rcp_f32 v22, v22
v_accvgpr_read_b32 v232, a64
v_accvgpr_read_b32 v233, a65
v_accvgpr_read_b32 v234, a66
v_accvgpr_read_b32 v235, a67
v_accvgpr_read_b32 v236, a68
v_accvgpr_read_b32 v237, a69
v_accvgpr_read_b32 v238, a70
v_accvgpr_read_b32 v239, a71
v_mul_f32 v22, v22, v8
v_mul_f32 v232, v232, v22
v_mul_f32 v233, v233, v22
v_mul_f32 v234, v234, v22
v_mul_f32 v235, v235, v22
v_mul_f32 v236, v236, v22
v_mul_f32 v237, v237, v22
v_mul_f32 v238, v238, v22
v_mul_f32 v239, v239, v22
v_cvt_pk_bf16_f32 v232, v232, v233
v_cvt_pk_bf16_f32 v233, v234, v235
v_cvt_pk_bf16_f32 v234, v236, v237
v_cvt_pk_bf16_f32 v235, v238, v239
s_add_u32 s77, s75, 0
buffer_store_dwordx4 v[232:235], v16, s[44:47], s77 offen sc1
s_branch L_po21
L_pg21:
s_branch L_tr4
L_po21:
L_TAIL:
ds_read_b128 a[176:179], v3 offset:4096
ds_read_b128 a[180:183], v3 offset:12288
ds_read_b128 a[184:187], v3 offset:5120
ds_read_b128 a[188:191], v3 offset:13312
v_smfmac_f32_16x16x64_bf16 a[140:143], a[240:243], v[208:215], v5
s_waitcnt lgkmcnt(11)
s_add_u32 m0, s86, 32768
s_add_u32 s64, s85, 262144
ds_read_b128 a[192:195], v3 offset:6144
v_mfma_f32_16x16x32_bf16 a[96:99], a[144:147], v[208:211], a[96:99]
s_waitcnt lgkmcnt(11)
ds_read_b128 a[196:199], v3 offset:14336
ds_read_b128 a[200:203], v3 offset:7168
ds_read_b128 a[204:207], v3 offset:15360
v_mfma_f32_16x16x32_bf16 a[96:99], a[148:151], v[212:215], a[96:99]
s_waitcnt lgkmcnt(12)
buffer_load_dwordx4 v12, s[36:39], s64 offen lds
v_mfma_f32_16x16x32_bf16 a[100:103], a[156:159], v[212:215], a[100:103]
s_add_u32 m0, s86, 33792
s_add_u32 s64, s85, 270336
v_accvgpr_read_b32 v240, a72
v_accvgpr_read_b32 v241, a73
v_mfma_f32_16x16x32_bf16 a[100:103], a[152:155], v[208:211], a[100:103]
s_waitcnt lgkmcnt(11)
buffer_load_dwordx4 v13, s[36:39], s64 offen lds
v_mfma_f32_16x16x32_bf16 a[104:107], a[160:163], v[208:211], a[104:107]
s_waitcnt lgkmcnt(10)
s_add_u32 m0, s86, 34816
s_add_u32 s64, s85, 278528
v_accvgpr_read_b32 v242, a74
v_accvgpr_read_b32 v243, a75
v_mfma_f32_16x16x32_bf16 a[104:107], a[164:167], v[212:215], a[104:107]
s_waitcnt lgkmcnt(8)
buffer_load_dwordx4 v12, s[36:39], s64 offen lds
v_mfma_f32_16x16x32_bf16 a[108:111], a[172:175], v[212:215], a[108:111]
s_add_u32 m0, s86, 35840
s_add_u32 s64, s85, 286720
v_accvgpr_read_b32 v244, a76
v_accvgpr_read_b32 v245, a77
v_mfma_f32_16x16x32_bf16 a[108:111], a[168:171], v[208:211], a[108:111]
s_waitcnt lgkmcnt(7)
buffer_load_dwordx4 v13, s[36:39], s64 offen lds
v_mfma_f32_16x16x32_bf16 a[112:115], a[176:179], v[208:211], a[112:115]
s_waitcnt lgkmcnt(6)
s_add_u32 m0, s86, 36864
s_add_u32 s64, s85, 294912
v_accvgpr_read_b32 v246, a78
v_accvgpr_read_b32 v247, a79
v_mfma_f32_16x16x32_bf16 a[112:115], a[180:183], v[212:215], a[112:115]
s_waitcnt lgkmcnt(4)
buffer_load_dwordx4 v12, s[36:39], s64 offen lds
v_mfma_f32_16x16x32_bf16 a[116:119], a[188:191], v[212:215], a[116:119]
s_add_u32 m0, s86, 37888
s_add_u32 s64, s85, 303104
v_mul_f32 v240, v240, v22
v_mul_f32 v241, v241, v22
v_mfma_f32_16x16x32_bf16 a[116:119], a[184:187], v[208:211], a[116:119]
s_waitcnt lgkmcnt(3)
buffer_load_dwordx4 v13, s[36:39], s64 offen lds
v_mfma_f32_16x16x32_bf16 a[120:123], a[192:195], v[208:211], a[120:123]
s_waitcnt lgkmcnt(2)
s_add_u32 m0, s86, 38912
s_add_u32 s64, s85, 311296
v_mul_f32 v242, v242, v22
v_mul_f32 v243, v243, v22
v_mfma_f32_16x16x32_bf16 a[120:123], a[196:199], v[212:215], a[120:123]
s_waitcnt lgkmcnt(0)
buffer_load_dwordx4 v12, s[36:39], s64 offen lds
v_mfma_f32_16x16x32_bf16 a[124:127], a[204:207], v[212:215], a[124:127]
s_add_u32 m0, s86, 39936
s_add_u32 s64, s85, 319488
v_mul_f32 v244, v244, v22
v_mul_f32 v245, v245, v22
v_mfma_f32_16x16x32_bf16 a[124:127], a[200:203], v[208:211], a[124:127]
buffer_load_dwordx4 v13, s[36:39], s64 offen lds
v_mul_f32 v246, v246, v22
v_mul_f32 v247, v247, v22
v_cvt_pk_bf16_f32 v240, v240, v241
v_cvt_pk_bf16_f32 v241, v242, v243
v_cvt_pk_bf16_f32 v242, v244, v245
v_cvt_pk_bf16_f32 v243, v246, v247
s_add_u32 s77, s75, 8192
buffer_store_dwordx4 v[240:243], v16, s[44:47], s77 offen sc1
v_accvgpr_read_b32 v23, a140
v_accvgpr_read_b32 v248, a141
v_add_f32 v23, v23, v248
v_max_f32 v1, v1, v23
v_rcp_f32 v23, v23
s_mov_b32 s66, 0x5d800000
v_cmp_le_f32 vcc, s66, v1
s_lshl_b32 s67, s30, 2
s_cmp_lg_u64 vcc, 0
s_cselect_b32 s66, 1, 0
v_mov_b32 v248, s67
v_mov_b32 v249, s66
ds_write_b32 v248, v249
v_accvgpr_read_b32 v232, a80
v_accvgpr_read_b32 v233, a81
v_accvgpr_read_b32 v234, a82
v_accvgpr_read_b32 v235, a83
v_accvgpr_read_b32 v236, a84
v_accvgpr_read_b32 v237, a85
v_accvgpr_read_b32 v238, a86
v_accvgpr_read_b32 v239, a87
v_pk_mul_f32 v[232:233], v[232:233], v[22:23] op_sel_hi:[1,0]
v_pk_mul_f32 v[234:235], v[234:235], v[22:23] op_sel_hi:[1,0]
v_pk_mul_f32 v[236:237], v[236:237], v[22:23] op_sel_hi:[1,0]
v_pk_mul_f32 v[238:239], v[238:239], v[22:23] op_sel_hi:[1,0]
v_cvt_pk_bf16_f32 v232, v232, v233
v_cvt_pk_bf16_f32 v233, v234, v235
v_cvt_pk_bf16_f32 v234, v236, v237
v_cvt_pk_bf16_f32 v235, v238, v239
s_add_u32 s77, s75, 16384
buffer_store_dwordx4 v[232:235], v16, s[44:47], s77 offen sc1
v_accvgpr_read_b32 v240, a88
v_accvgpr_read_b32 v241, a89
v_accvgpr_read_b32 v242, a90
v_accvgpr_read_b32 v243, a91
v_accvgpr_read_b32 v244, a92
v_accvgpr_read_b32 v245, a93
v_accvgpr_read_b32 v246, a94
v_accvgpr_read_b32 v247, a95
v_pk_mul_f32 v[240:241], v[240:241], v[22:23] op_sel_hi:[1,0]
v_pk_mul_f32 v[242:243], v[242:243], v[22:23] op_sel_hi:[1,0]
v_pk_mul_f32 v[244:245], v[244:245], v[22:23] op_sel_hi:[1,0]
v_pk_mul_f32 v[246:247], v[246:247], v[22:23] op_sel_hi:[1,0]
v_cvt_pk_bf16_f32 v240, v240, v241
v_cvt_pk_bf16_f32 v241, v242, v243
v_cvt_pk_bf16_f32 v242, v244, v245
v_cvt_pk_bf16_f32 v243, v246, v247
s_add_u32 s77, s75, 24576
buffer_store_dwordx4 v[240:243], v16, s[44:47], s77 offen sc1
v_accvgpr_read_b32 v232, a96
v_accvgpr_read_b32 v233, a97
v_accvgpr_read_b32 v234, a98
v_accvgpr_read_b32 v235, a99
v_accvgpr_read_b32 v236, a100
v_accvgpr_read_b32 v237, a101
v_accvgpr_read_b32 v238, a102
v_accvgpr_read_b32 v239, a103
v_mul_f32 v23, v23, v10
v_pk_mul_f32 v[232:233], v[232:233], v[22:23] op_sel:[0,1]
v_pk_mul_f32 v[234:235], v[234:235], v[22:23] op_sel:[0,1]
v_pk_mul_f32 v[236:237], v[236:237], v[22:23] op_sel:[0,1]
v_pk_mul_f32 v[238:239], v[238:239], v[22:23] op_sel:[0,1]
v_cvt_pk_bf16_f32 v232, v232, v233
v_cvt_pk_bf16_f32 v233, v234, v235
v_cvt_pk_bf16_f32 v234, v236, v237
v_cvt_pk_bf16_f32 v235, v238, v239
s_add_u32 s77, s75, 4096
buffer_store_dwordx4 v[232:235], v16, s[44:47], s77 offen sc1
v_accvgpr_read_b32 v240, a104
v_accvgpr_read_b32 v241, a105
v_accvgpr_read_b32 v242, a106
v_accvgpr_read_b32 v243, a107
v_accvgpr_read_b32 v244, a108
v_accvgpr_read_b32 v245, a109
v_accvgpr_read_b32 v246, a110
v_accvgpr_read_b32 v247, a111
v_pk_mul_f32 v[240:241], v[240:241], v[22:23] op_sel:[0,1]
v_pk_mul_f32 v[242:243], v[242:243], v[22:23] op_sel:[0,1]
v_pk_mul_f32 v[244:245], v[244:245], v[22:23] op_sel:[0,1]
v_pk_mul_f32 v[246:247], v[246:247], v[22:23] op_sel:[0,1]
v_cvt_pk_bf16_f32 v240, v240, v241
v_cvt_pk_bf16_f32 v241, v242, v243
v_cvt_pk_bf16_f32 v242, v244, v245
v_cvt_pk_bf16_f32 v243, v246, v247
s_add_u32 s77, s75, 12288
buffer_store_dwordx4 v[240:243], v16, s[44:47], s77 offen sc1
v_mov_b32 v248, 0
s_waitcnt lgkmcnt(0)
s_barrier
ds_read_b128 v[248:251], v248
v_xor_b32 v188, 128, v18
v_xor_b32 v189, 160, v18
v_xor_b32 v190, 192, v18
ds_read_b64_tr_b16 a[144:145], v188 offset:32768
ds_read_b64_tr_b16 a[146:147], v188 offset:36864
ds_read_b64_tr_b16 a[148:149], v188 offset:40960
ds_read_b64_tr_b16 a[150:151], v188 offset:45056
ds_read_b64_tr_b16 a[152:153], v189 offset:32768
ds_read_b64_tr_b16 a[154:155], v189 offset:36864
ds_read_b64_tr_b16 a[156:157], v189 offset:40960
ds_read_b64_tr_b16 a[158:159], v189 offset:45056
ds_read_b64_tr_b16 a[160:161], v190 offset:32768
ds_read_b64_tr_b16 a[162:163], v190 offset:36864
ds_read_b64_tr_b16 a[164:165], v190 offset:40960
ds_read_b64_tr_b16 a[166:167], v190 offset:45056
v_xor_b32 v191, 224, v18
v_xor_b32 v184, 0, v18
v_xor_b32 v185, 32, v18
v_xor_b32 v186, 64, v18
v_xor_b32 v187, 96, v18
v_accvgpr_read_b32 v232, a112
v_accvgpr_read_b32 v233, a113
v_accvgpr_read_b32 v234, a114
v_accvgpr_read_b32 v235, a115
v_accvgpr_read_b32 v236, a116
v_accvgpr_read_b32 v237, a117
v_accvgpr_read_b32 v238, a118
v_accvgpr_read_b32 v239, a119
v_pk_mul_f32 v[232:233], v[232:233], v[22:23] op_sel:[0,1]
v_pk_mul_f32 v[234:235], v[234:235], v[22:23] op_sel:[0,1]
v_pk_mul_f32 v[236:237], v[236:237], v[22:23] op_sel:[0,1]
v_pk_mul_f32 v[238:239], v[238:239], v[22:23] op_sel:[0,1]
v_cvt_pk_bf16_f32 v232, v232, v233
v_cvt_pk_bf16_f32 v233, v234, v235
v_cvt_pk_bf16_f32 v234, v236, v237
v_cvt_pk_bf16_f32 v235, v238, v239
s_add_u32 s77, s75, 20480
buffer_store_dwordx4 v[232:235], v16, s[44:47], s77 offen sc1
v_accvgpr_read_b32 v240, a120
v_accvgpr_read_b32 v241, a121
v_accvgpr_read_b32 v242, a122
v_accvgpr_read_b32 v243, a123
v_accvgpr_read_b32 v244, a124
v_accvgpr_read_b32 v245, a125
v_accvgpr_read_b32 v246, a126
v_accvgpr_read_b32 v247, a127
v_pk_mul_f32 v[240:241], v[240:241], v[22:23] op_sel:[0,1]
v_pk_mul_f32 v[242:243], v[242:243], v[22:23] op_sel:[0,1]
v_pk_mul_f32 v[244:245], v[244:245], v[22:23] op_sel:[0,1]
v_pk_mul_f32 v[246:247], v[246:247], v[22:23] op_sel:[0,1]
v_cvt_pk_bf16_f32 v240, v240, v241
v_cvt_pk_bf16_f32 v241, v242, v243
v_cvt_pk_bf16_f32 v242, v244, v245
v_cvt_pk_bf16_f32 v243, v246, v247
s_add_u32 s77, s75, 28672
buffer_store_dwordx4 v[240:243], v16, s[44:47], s77 offen sc1
s_waitcnt lgkmcnt(12)
v_or3_b32 v248, v248, v249, v250
v_or_b32 v248, v248, v251
s_nop 0
v_readfirstlane_b32 s66, v248
s_nop 0
s_cmp_gt_u32 s66, s73
s_cbranch_scc1 L_fallback_11
s_cmp_eq_u32 s83, 0
s_cbranch_scc1 L_p5f0
s_waitcnt lgkmcnt(10)
s_waitcnt vmcnt(28)
v_mfma_f32_16x16x32_bf16 v[136:139], a[144:147], a[232:235], 0
s_waitcnt vmcnt(24)
s_waitcnt lgkmcnt(8)
s_add_u32 m0, s86, 98304
ds_read_b64_tr_b16 a[168:169], v191 offset:32768
v_xor_b32 v192, 0x10000, v184
v_mfma_f32_16x16x32_bf16 v[136:139], a[148:151], a[236:239], v[136:139]
s_add_u32 s64, s85, 524288
ds_read_b64_tr_b16 a[170:171], v191 offset:36864
v_xor_b32 v193, 0x10000, v185
v_mfma_f32_16x16x32_bf16 v[104:107], a[148:151], a[228:231], 0
buffer_load_dwordx4 v12, s[36:39], s64 offen lds
v_mfma_f32_16x16x32_bf16 v[104:107], a[144:147], a[224:227], v[104:107]
s_add_u32 m0, s86, 99328
s_add_u32 s64, s85, 532480
ds_read_b64_tr_b16 a[172:173], v191 offset:40960
v_xor_b32 v194, 0x10000, v186
v_mfma_f32_16x16x32_bf16 v[72:75], a[144:147], a[216:219], 0
buffer_load_dwordx4 v13, s[36:39], s64 offen lds
v_mfma_f32_16x16x32_bf16 v[72:75], a[148:151], a[220:223], v[72:75]
s_add_u32 m0, s86, 100352
ds_read_b64_tr_b16 a[174:175], v191 offset:45056
v_xor_b32 v195, 0x10000, v187
v_mfma_f32_16x16x32_bf16 v[40:43], a[148:151], a[212:215], 0
s_add_u32 s64, s85, 540672
ds_read_b64_tr_b16 a[176:177], v184 offset:32768
v_xor_b32 v196, 0x10000, v188
v_mfma_f32_16x16x32_bf16 v[40:43], a[144:147], a[208:211], v[40:43]
s_waitcnt lgkmcnt(5)
buffer_load_dwordx4 v12, s[36:39], s64 offen lds
v_mfma_f32_16x16x32_bf16 v[44:47], a[152:155], a[208:211], 0
s_add_u32 m0, s86, 101376
s_add_u32 s64, s85, 548864
ds_read_b64_tr_b16 a[178:179], v184 offset:36864
v_xor_b32 v197, 0x10000, v189
v_mfma_f32_16x16x32_bf16 v[44:47], a[156:159], a[212:215], v[44:47]
buffer_load_dwordx4 v13, s[36:39], s64 offen lds
v_mfma_f32_16x16x32_bf16 v[76:79], a[156:159], a[220:223], 0
s_add_u32 m0, s86, 102400
ds_read_b64_tr_b16 a[180:181], v184 offset:40960
v_xor_b32 v198, 0x10000, v190
v_mfma_f32_16x16x32_bf16 v[76:79], a[152:155], a[216:219], v[76:79]
s_add_u32 s64, s85, 557056
ds_read_b64_tr_b16 a[182:183], v184 offset:45056
v_xor_b32 v199, 0x10000, v191
v_mfma_f32_16x16x32_bf16 v[108:111], a[152:155], a[224:227], 0
buffer_load_dwordx4 v12, s[36:39], s64 offen lds
v_mfma_f32_16x16x32_bf16 v[108:111], a[156:159], a[228:231], v[108:111]
s_add_u32 m0, s86, 103424
s_add_u32 s64, s85, 565248
ds_read_b64_tr_b16 a[184:185], v185 offset:32768
v_mfma_f32_16x16x32_bf16 v[140:143], a[156:159], a[236:239], 0
s_branch L_po22
L_pg22:
s_branch L_pg30
L_po22:
buffer_load_dwordx4 v13, s[36:39], s64 offen lds
v_mfma_f32_16x16x32_bf16 v[140:143], a[152:155], a[232:235], v[140:143]
s_add_u32 m0, s86, 104448
s_add_u32 s64, s85, 573440
ds_read_b64_tr_b16 a[186:187], v185 offset:36864
v_mfma_f32_16x16x32_bf16 v[144:147], a[160:163], a[232:235], 0
s_and_b32 s68, s82, 3
s_lshl_b32 s68, s68, 11
ds_read_b64_tr_b16 a[188:189], v185 offset:40960
v_mfma_f32_16x16x32_bf16 v[144:147], a[164:167], a[236:239], v[144:147]
s_add_u32 s76, s86, s68
buffer_load_dwordx4 v12, s[36:39], s64 offen lds
v_mfma_f32_16x16x32_bf16 v[112:115], a[164:167], a[228:231], 0
s_and_b32 s71, s31, 4
s_lshl_b32 s71, s71, 5
s_add_u32 m0, s86, 105472
s_add_u32 s64, s85, 581632
ds_read_b64_tr_b16 a[190:191], v185 offset:45056
v_mfma_f32_16x16x32_bf16 v[112:115], a[160:163], a[224:227], v[112:115]
s_add_u32 s71, s71, s79
buffer_load_dwordx4 v13, s[36:39], s64 offen lds
v_mfma_f32_16x16x32_bf16 v[80:83], a[160:163], a[216:219], 0
s_add_u32 s71, s71, 4096
s_add_u32 s72, s80, 4096
ds_read_b64_tr_b16 a[192:193], v186 offset:32768
v_mfma_f32_16x16x32_bf16 v[80:83], a[164:167], a[220:223], v[80:83]
s_lshr_b32 s69, s87, 8
s_lshr_b32 s67, s82, 1
s_add_u32 s65, s84, 65536
ds_read_b64_tr_b16 a[194:195], v186 offset:36864
v_mfma_f32_16x16x32_bf16 v[48:51], a[164:167], a[212:215], 0
s_xor_b32 s69, s69, s67
buffer_load_dwordx4 a[32:35], v14, s[44:47], s65 offen offset:0 sc1
v_mfma_f32_16x16x32_bf16 v[48:51], a[160:163], a[208:211], v[48:51]
s_waitcnt lgkmcnt(4)
s_and_b32 s69, s69, 2
s_lshl_b32 s69, s69, 15
ds_read_b64_tr_b16 a[196:197], v186 offset:40960
v_mfma_f32_16x16x32_bf16 v[52:55], a[168:171], a[208:211], 0
s_add_u32 s68, s68, s69
buffer_load_dwordx4 a[40:43], v14, s[44:47], s65 offen offset:1024 sc1
v_mfma_f32_16x16x32_bf16 v[52:55], a[172:175], a[212:215], v[52:55]
ds_read_b64_tr_b16 a[198:199], v186 offset:45056
v_mfma_f32_16x16x32_bf16 v[84:87], a[172:175], a[220:223], 0
ds_read_b64_tr_b16 a[200:201], v187 offset:32768
v_mfma_f32_16x16x32_bf16 v[84:87], a[168:171], a[216:219], v[84:87]
buffer_load_dwordx4 a[48:51], v15, s[44:47], s65 offen offset:0 sc1
v_mfma_f32_16x16x32_bf16 v[116:119], a[168:171], a[224:227], 0
ds_read_b64_tr_b16 a[202:203], v187 offset:36864
v_mfma_f32_16x16x32_bf16 v[116:119], a[172:175], a[228:231], v[116:119]
buffer_load_dwordx4 a[56:59], v15, s[44:47], s65 offen offset:1024 sc1
v_mfma_f32_16x16x32_bf16 v[148:151], a[172:175], a[236:239], 0
ds_read_b64_tr_b16 a[204:205], v187 offset:40960
v_mfma_f32_16x16x32_bf16 v[148:151], a[168:171], a[232:235], v[148:151]
s_add_u32 s65, s84, 73728
ds_read_b64_tr_b16 a[206:207], v187 offset:45056
v_mfma_f32_16x16x32_bf16 v[120:123], a[176:179], a[232:235], 0
buffer_load_dwordx4 a[36:39], v14, s[44:47], s65 offen offset:0 sc1
v_mfma_f32_16x16x32_bf16 v[120:123], a[180:183], a[236:239], v[120:123]
v_mfma_f32_16x16x32_bf16 v[88:91], a[180:183], a[228:231], 0
buffer_load_dwordx4 a[44:47], v14, s[44:47], s65 offen offset:1024 sc1
v_mfma_f32_16x16x32_bf16 v[88:91], a[176:179], a[224:227], v[88:91]
v_mfma_f32_16x16x32_bf16 v[56:59], a[176:179], a[216:219], 0
v_mfma_f32_16x16x32_bf16 v[56:59], a[180:183], a[220:223], v[56:59]
buffer_load_dwordx4 a[52:55], v15, s[44:47], s65 offen offset:0 sc1
v_mfma_f32_16x16x32_bf16 v[24:27], a[180:183], a[212:215], 0
v_mfma_f32_16x16x32_bf16 v[24:27], a[176:179], a[208:211], v[24:27]
buffer_load_dwordx4 a[60:63], v15, s[44:47], s65 offen offset:1024 sc1
v_mfma_f32_16x16x32_bf16 v[28:31], a[184:187], a[208:211], 0
s_waitcnt lgkmcnt(0)
v_mfma_f32_16x16x32_bf16 v[28:31], a[188:191], a[212:215], v[28:31]
v_mfma_f32_16x16x32_bf16 v[60:63], a[188:191], a[220:223], 0
buffer_load_dword v19, off, s[52:55], s72 sc1
v_mfma_f32_16x16x32_bf16 v[60:63], a[184:187], a[216:219], v[60:63]
s_add_u32 s85, s85, 2883584
s_lshl3_add_u32 s85, s68, s85
s_waitcnt vmcnt(24) lgkmcnt(0)
s_barrier
v_mfma_f32_16x16x32_bf16 v[92:95], a[184:187], a[224:227], 0
ds_read_b64_tr_b16 a[144:145], v196 offset:0
v_mfma_f32_16x16x32_bf16 v[92:95], a[188:191], a[228:231], v[92:95]
ds_read_b64_tr_b16 a[146:147], v196 offset:4096
v_mfma_f32_16x16x32_bf16 v[124:127], a[188:191], a[236:239], 0
s_xor_b32 m0, s76, 131072
ds_read_b64_tr_b16 a[148:149], v196 offset:8192
v_mfma_f32_16x16x32_bf16 v[124:127], a[184:187], a[232:235], v[124:127]
s_xor_b32 s64, s85, 0
ds_read_b64_tr_b16 a[150:151], v196 offset:12288
v_mfma_f32_16x16x32_bf16 v[128:131], a[192:195], a[232:235], 0
buffer_load_dwordx4 v12, s[40:43], s64 offen lds
v_mfma_f32_16x16x32_bf16 v[128:131], a[196:199], a[236:239], v[128:131]
s_xor_b32 m0, s76, 132096
ds_read_b64_tr_b16 a[152:153], v197 offset:0
v_mfma_f32_16x16x32_bf16 v[96:99], a[196:199], a[228:231], 0
s_xor_b32 s64, s85, 8192
ds_read_b64_tr_b16 a[154:155], v197 offset:4096
v_mfma_f32_16x16x32_bf16 v[96:99], a[192:195], a[224:227], v[96:99]
buffer_load_dwordx4 v13, s[40:43], s64 offen lds
v_mfma_f32_16x16x32_bf16 v[64:67], a[192:195], a[216:219], 0
s_xor_b32 m0, s76, 133120
ds_read_b64_tr_b16 a[156:157], v197 offset:8192
v_mfma_f32_16x16x32_bf16 v[64:67], a[196:199], a[220:223], v[64:67]
s_xor_b32 s64, s85, 16384
ds_read_b64_tr_b16 a[158:159], v197 offset:12288
v_mfma_f32_16x16x32_bf16 v[32:35], a[196:199], a[212:215], 0
buffer_load_dwordx4 v12, s[40:43], s64 offen lds
v_mfma_f32_16x16x32_bf16 v[32:35], a[192:195], a[208:211], v[32:35]
s_xor_b32 m0, s76, 134144
ds_read_b64_tr_b16 a[160:161], v198 offset:0
v_mfma_f32_16x16x32_bf16 v[36:39], a[200:203], a[208:211], 0
s_xor_b32 s64, s85, 24576
ds_read_b64_tr_b16 a[162:163], v198 offset:4096
v_mfma_f32_16x16x32_bf16 v[36:39], a[204:207], a[212:215], v[36:39]
buffer_load_dwordx4 v13, s[40:43], s64 offen lds
v_mfma_f32_16x16x32_bf16 v[68:71], a[204:207], a[220:223], 0
s_xor_b32 m0, s76, 135168
ds_read_b64_tr_b16 a[164:165], v198 offset:8192
v_mfma_f32_16x16x32_bf16 v[68:71], a[200:203], a[216:219], v[68:71]
s_xor_b32 s64, s85, 32768
ds_read_b64_tr_b16 a[166:167], v198 offset:12288
v_mfma_f32_16x16x32_bf16 v[100:103], a[200:203], a[224:227], 0
buffer_load_dwordx4 v12, s[40:43], s64 offen lds
v_mfma_f32_16x16x32_bf16 v[100:103], a[204:207], a[228:231], v[100:103]
v_mfma_f32_16x16x32_bf16 v[132:135], a[204:207], a[236:239], 0
v_mfma_f32_16x16x32_bf16 v[132:135], a[200:203], a[232:235], v[132:135]
s_waitcnt lgkmcnt(3)
v_mfma_f32_16x16x32_bf16 v[136:139], a[144:147], v[176:179], v[136:139]
s_waitcnt vmcnt(5)
v_readfirstlane_b32 vcc_lo, v19
s_nop 0
s_cmp_lt_u32 vcc_lo, 8
s_cbranch_scc1 L_spin_2016
L_spinbk_2017:
s_sub_u32 s84, s84, 688128
s_add_u32 s84, s84, s69
v_mfma_f32_16x16x32_bf16 v[136:139], a[148:151], v[180:183], v[136:139]
s_xor_b32 m0, s76, 136192
s_xor_b32 s64, s85, 40960
ds_read_b64_tr_b16 a[168:169], v199 offset:0
v_mfma_f32_16x16x32_bf16 v[104:107], a[148:151], v[172:175], v[104:107]
buffer_load_dwordx4 v13, s[40:43], s64 offen lds
v_mfma_f32_16x16x32_bf16 v[104:107], a[144:147], v[168:171], v[104:107]
s_xor_b32 m0, s76, 137216
ds_read_b64_tr_b16 a[170:171], v199 offset:4096
v_mfma_f32_16x16x32_bf16 v[72:75], a[144:147], v[160:163], v[72:75]
s_xor_b32 s64, s85, 49152
ds_read_b64_tr_b16 a[172:173], v199 offset:8192
v_mfma_f32_16x16x32_bf16 v[72:75], a[148:151], v[164:167], v[72:75]
buffer_load_dwordx4 v12, s[40:43], s64 offen lds
v_mfma_f32_16x16x32_bf16 v[40:43], a[148:151], v[156:159], v[40:43]
ds_read_b64_tr_b16 a[174:175], v199 offset:12288
v_mfma_f32_16x16x32_bf16 v[40:43], a[144:147], v[152:155], v[40:43]
s_xor_b32 m0, s76, 138240
ds_read_b64_tr_b16 a[176:177], v192 offset:0
v_mfma_f32_16x16x32_bf16 v[44:47], a[152:155], v[152:155], v[44:47]
s_xor_b32 s64, s85, 57344
ds_read_b64_tr_b16 a[178:179], v192 offset:4096
v_mfma_f32_16x16x32_bf16 v[44:47], a[156:159], v[156:159], v[44:47]
buffer_load_dwordx4 v13, s[40:43], s64 offen lds
v_mfma_f32_16x16x32_bf16 v[76:79], a[156:159], v[164:167], v[76:79]
ds_read_b64_tr_b16 a[180:181], v192 offset:8192
v_mfma_f32_16x16x32_bf16 v[76:79], a[152:155], v[160:163], v[76:79]
s_xor_b32 s65, s84, 0
ds_read_b64_tr_b16 a[182:183], v192 offset:12288
v_mfma_f32_16x16x32_bf16 v[108:111], a[152:155], v[168:171], v[108:111]
buffer_load_dwordx4 a[208:211], v14, s[44:47], s65 offen offset:0 sc1
v_mfma_f32_16x16x32_bf16 v[108:111], a[156:159], v[172:175], v[108:111]
ds_read_b64_tr_b16 a[184:185], v193 offset:0
v_mfma_f32_16x16x32_bf16 v[140:143], a[156:159], v[180:183], v[140:143]
ds_read_b64_tr_b16 a[186:187], v193 offset:4096
v_mfma_f32_16x16x32_bf16 v[140:143], a[152:155], v[176:179], v[140:143]
s_waitcnt lgkmcnt(5)
ds_read_b64_tr_b16 a[188:189], v193 offset:8192
v_mfma_f32_16x16x32_bf16 v[144:147], a[160:163], v[176:179], v[144:147]
buffer_load_dwordx4 a[216:219], v14, s[44:47], s65 offen offset:1024 sc1
v_mfma_f32_16x16x32_bf16 v[144:147], a[164:167], v[180:183], v[144:147]
ds_read_b64_tr_b16 a[190:191], v193 offset:12288
v_mfma_f32_16x16x32_bf16 v[112:115], a[164:167], v[172:175], v[112:115]
ds_read_b64_tr_b16 a[192:193], v194 offset:0
v_mfma_f32_16x16x32_bf16 v[112:115], a[160:163], v[168:171], v[112:115]
ds_read_b64_tr_b16 a[194:195], v194 offset:4096
v_mfma_f32_16x16x32_bf16 v[80:83], a[160:163], v[160:163], v[80:83]
buffer_load_dwordx4 a[224:227], v15, s[44:47], s65 offen offset:0 sc1
v_mfma_f32_16x16x32_bf16 v[80:83], a[164:167], v[164:167], v[80:83]
ds_read_b64_tr_b16 a[196:197], v194 offset:8192
v_mfma_f32_16x16x32_bf16 v[48:51], a[164:167], v[156:159], v[48:51]
ds_read_b64_tr_b16 a[198:199], v194 offset:12288
v_mfma_f32_16x16x32_bf16 v[48:51], a[160:163], v[152:155], v[48:51]
buffer_load_dwordx4 a[232:235], v15, s[44:47], s65 offen offset:1024 sc1
v_mfma_f32_16x16x32_bf16 v[52:55], a[168:171], v[152:155], v[52:55]
v_mfma_f32_16x16x32_bf16 v[52:55], a[172:175], v[156:159], v[52:55]
v_mfma_f32_16x16x32_bf16 v[84:87], a[172:175], v[164:167], v[84:87]
s_xor_b32 s65, s84, 8192
ds_read_b64_tr_b16 a[200:201], v195 offset:0
v_mfma_f32_16x16x32_bf16 v[84:87], a[168:171], v[160:163], v[84:87]
buffer_load_dwordx4 a[212:215], v14, s[44:47], s65 offen offset:0 sc1
v_mfma_f32_16x16x32_bf16 v[116:119], a[168:171], v[168:171], v[116:119]
ds_read_b64_tr_b16 a[202:203], v195 offset:4096
v_mfma_f32_16x16x32_bf16 v[116:119], a[172:175], v[172:175], v[116:119]
ds_read_b64_tr_b16 a[204:205], v195 offset:8192
v_mfma_f32_16x16x32_bf16 v[148:151], a[172:175], v[180:183], v[148:151]
ds_read_b64_tr_b16 a[206:207], v195 offset:12288
v_mfma_f32_16x16x32_bf16 v[148:151], a[168:171], v[176:179], v[148:151]
s_waitcnt lgkmcnt(4)
s_lshl_b32 s66, s30, 30
buffer_load_dwordx4 a[220:223], v14, s[44:47], s65 offen offset:1024 sc1
v_mfma_f32_16x16x32_bf16 v[120:123], a[176:179], v[176:179], v[120:123]
v_lshl_add_u32 v1, v0, 24, s66
v_mfma_f32_16x16x32_bf16 v[120:123], a[180:183], v[180:183], v[120:123]
v_mfma_f32_16x16x32_bf16 v[88:91], a[180:183], v[172:175], v[88:91]
buffer_load_dwordx4 a[228:231], v15, s[44:47], s65 offen offset:0 sc1
v_mfma_f32_16x16x32_bf16 v[88:91], a[176:179], v[168:171], v[88:91]
v_mfma_f32_16x16x32_bf16 v[56:59], a[176:179], v[160:163], v[56:59]
v_mfma_f32_16x16x32_bf16 v[56:59], a[180:183], v[164:167], v[56:59]
v_mfma_f32_16x16x32_bf16 v[24:27], a[180:183], v[156:159], v[24:27]
buffer_load_dwordx4 a[236:239], v15, s[44:47], s65 offen offset:1024 sc1
v_mfma_f32_16x16x32_bf16 v[24:27], a[176:179], v[152:155], v[24:27]
v_mfma_f32_16x16x32_bf16 v[28:31], a[184:187], v[152:155], v[28:31]
v_mfma_f32_16x16x32_bf16 v[28:31], a[188:191], v[156:159], v[28:31]
v_mfma_f32_16x16x32_bf16 v[60:63], a[188:191], v[164:167], v[60:63]
v_mfma_f32_16x16x32_bf16 v[60:63], a[184:187], v[160:163], v[60:63]
s_waitcnt lgkmcnt(0)
s_barrier
v_mfma_f32_16x16x32_bf16 v[92:95], a[184:187], v[168:171], v[92:95]
s_mov_b64 exec, 1
buffer_atomic_add a251, v1, s[52:55], s71 offen offset:0 sc1
s_mov_b64 exec, -1
v_mfma_f32_16x16x32_bf16 v[92:95], a[188:191], v[172:175], v[92:95]
ds_read_b64_tr_b16 a[144:145], v188 offset:0
v_mfma_f32_16x16x32_bf16 v[124:127], a[188:191], v[180:183], v[124:127]
s_xor_b32 m0, s76, 32768
ds_read_b64_tr_b16 a[146:147], v188 offset:4096
v_mfma_f32_16x16x32_bf16 v[124:127], a[184:187], v[176:179], v[124:127]
s_xor_b32 s64, s85, 262144
ds_read_b64_tr_b16 a[148:149], v188 offset:8192
v_mfma_f32_16x16x32_bf16 v[128:131], a[192:195], v[176:179], v[128:131]
buffer_load_dwordx4 v12, s[40:43], s64 offen lds
v_mfma_f32_16x16x32_bf16 v[128:131], a[196:199], v[180:183], v[128:131]
s_xor_b32 m0, s76, 33792
ds_read_b64_tr_b16 a[150:151], v188 offset:12288
v_mfma_f32_16x16x32_bf16 v[96:99], a[196:199], v[172:175], v[96:99]
s_xor_b32 s64, s85, 270336
ds_read_b64_tr_b16 a[152:153], v189 offset:0
v_mfma_f32_16x16x32_bf16 v[96:99], a[192:195], v[168:171], v[96:99]
buffer_load_dwordx4 v13, s[40:43], s64 offen lds
v_mfma_f32_16x16x32_bf16 v[64:67], a[192:195], v[160:163], v[64:67]
s_xor_b32 m0, s76, 34816
ds_read_b64_tr_b16 a[154:155], v189 offset:4096
v_mfma_f32_16x16x32_bf16 v[64:67], a[196:199], v[164:167], v[64:67]
s_xor_b32 s64, s85, 278528
ds_read_b64_tr_b16 a[156:157], v189 offset:8192
v_mfma_f32_16x16x32_bf16 v[32:35], a[196:199], v[156:159], v[32:35]
buffer_load_dwordx4 v12, s[40:43], s64 offen lds
v_mfma_f32_16x16x32_bf16 v[32:35], a[192:195], v[152:155], v[32:35]
s_xor_b32 m0, s76, 35840
ds_read_b64_tr_b16 a[158:159], v189 offset:12288
v_mfma_f32_16x16x32_bf16 v[36:39], a[200:203], v[152:155], v[36:39]
s_xor_b32 s64, s85, 286720
ds_read_b64_tr_b16 a[160:161], v190 offset:0
v_mfma_f32_16x16x32_bf16 v[36:39], a[204:207], v[156:159], v[36:39]
buffer_load_dwordx4 v13, s[40:43], s64 offen lds
v_mfma_f32_16x16x32_bf16 v[68:71], a[204:207], v[164:167], v[68:71]
s_xor_b32 m0, s76, 36864
ds_read_b64_tr_b16 a[162:163], v190 offset:4096
v_mfma_f32_16x16x32_bf16 v[68:71], a[200:203], v[160:163], v[68:71]
s_xor_b32 s64, s85, 294912
ds_read_b64_tr_b16 a[164:165], v190 offset:8192
v_mfma_f32_16x16x32_bf16 v[100:103], a[200:203], v[168:171], v[100:103]
buffer_load_dwordx4 v12, s[40:43], s64 offen lds
v_mfma_f32_16x16x32_bf16 v[100:103], a[204:207], v[172:175], v[100:103]
ds_read_b64_tr_b16 a[166:167], v190 offset:12288
v_mfma_f32_16x16x32_bf16 v[132:135], a[204:207], v[180:183], v[132:135]
v_mfma_f32_16x16x32_bf16 v[132:135], a[200:203], v[176:179], v[132:135]
s_waitcnt lgkmcnt(4)
v_mfma_f32_16x16x32_bf16 v[136:139], a[144:147], a[56:59], v[136:139]
s_xor_b32 m0, s76, 37888
ds_read_b64_tr_b16 a[168:169], v191 offset:0
v_mfma_f32_16x16x32_bf16 v[136:139], a[148:151], a[60:63], v[136:139]
s_xor_b32 s64, s85, 303104
ds_read_b64_tr_b16 a[170:171], v191 offset:4096
v_mfma_f32_16x16x32_bf16 v[104:107], a[148:151], a[52:55], v[104:107]
buffer_load_dwordx4 v13, s[40:43], s64 offen lds
v_mfma_f32_16x16x32_bf16 v[104:107], a[144:147], a[48:51], v[104:107]
s_xor_b32 m0, s76, 38912
ds_read_b64_tr_b16 a[172:173], v191 offset:8192
v_mfma_f32_16x16x32_bf16 v[72:75], a[144:147], a[40:43], v[72:75]
s_xor_b32 s64, s85, 311296
ds_read_b64_tr_b16 a[174:175], v191 offset:12288
v_mfma_f32_16x16x32_bf16 v[72:75], a[148:151], a[44:47], v[72:75]
buffer_load_dwordx4 v12, s[40:43], s64 offen lds
v_mfma_f32_16x16x32_bf16 v[40:43], a[148:151], a[36:39], v[40:43]
ds_read_b64_tr_b16 a[176:177], v184 offset:0
v_mfma_f32_16x16x32_bf16 v[40:43], a[144:147], a[32:35], v[40:43]
s_xor_b32 m0, s76, 39936
ds_read_b64_tr_b16 a[178:179], v184 offset:4096
v_mfma_f32_16x16x32_bf16 v[44:47], a[152:155], a[32:35], v[44:47]
s_xor_b32 s64, s85, 319488
ds_read_b64_tr_b16 a[180:181], v184 offset:8192
v_mfma_f32_16x16x32_bf16 v[44:47], a[156:159], a[36:39], v[44:47]
buffer_load_dwordx4 v13, s[40:43], s64 offen lds
v_mfma_f32_16x16x32_bf16 v[76:79], a[156:159], a[44:47], v[76:79]
ds_read_b64_tr_b16 a[182:183], v184 offset:12288
v_mfma_f32_16x16x32_bf16 v[76:79], a[152:155], a[40:43], v[76:79]
s_xor_b32 s65, s84, 32768
ds_read_b64_tr_b16 a[184:185], v185 offset:0
v_mfma_f32_16x16x32_bf16 v[108:111], a[152:155], a[48:51], v[108:111]
buffer_load_dwordx4 v[152:155], v14, s[44:47], s65 offen offset:0 sc1
v_mfma_f32_16x16x32_bf16 v[108:111], a[156:159], a[52:55], v[108:111]
ds_read_b64_tr_b16 a[186:187], v185 offset:4096
v_mfma_f32_16x16x32_bf16 v[140:143], a[156:159], a[60:63], v[140:143]
ds_read_b64_tr_b16 a[188:189], v185 offset:8192
v_mfma_f32_16x16x32_bf16 v[140:143], a[152:155], a[56:59], v[140:143]
s_waitcnt lgkmcnt(5)
ds_read_b64_tr_b16 a[190:191], v185 offset:12288
v_mfma_f32_16x16x32_bf16 v[144:147], a[160:163], a[56:59], v[144:147]
buffer_load_dwordx4 v[160:163], v14, s[44:47], s65 offen offset:1024 sc1
v_mfma_f32_16x16x32_bf16 v[144:147], a[164:167], a[60:63], v[144:147]
v_mfma_f32_16x16x32_bf16 v[112:115], a[164:167], a[52:55], v[112:115]
ds_read_b64_tr_b16 a[192:193], v186 offset:0
v_mfma_f32_16x16x32_bf16 v[112:115], a[160:163], a[48:51], v[112:115]
ds_read_b64_tr_b16 a[194:195], v186 offset:4096
v_mfma_f32_16x16x32_bf16 v[80:83], a[160:163], a[40:43], v[80:83]
buffer_load_dwordx4 v[168:171], v15, s[44:47], s65 offen offset:0 sc1
v_mfma_f32_16x16x32_bf16 v[80:83], a[164:167], a[44:47], v[80:83]
ds_read_b64_tr_b16 a[196:197], v186 offset:8192
v_mfma_f32_16x16x32_bf16 v[48:51], a[164:167], a[36:39], v[48:51]
ds_read_b64_tr_b16 a[198:199], v186 offset:12288
v_mfma_f32_16x16x32_bf16 v[48:51], a[160:163], a[32:35], v[48:51]
buffer_load_dwordx4 v[176:179], v15, s[44:47], s65 offen offset:1024 sc1
v_mfma_f32_16x16x32_bf16 v[52:55], a[168:171], a[32:35], v[52:55]
v_mfma_f32_16x16x32_bf16 v[52:55], a[172:175], a[36:39], v[52:55]
v_mfma_f32_16x16x32_bf16 v[84:87], a[172:175], a[44:47], v[84:87]
s_xor_b32 s65, s84, 40960
ds_read_b64_tr_b16 a[200:201], v187 offset:0
v_mfma_f32_16x16x32_bf16 v[84:87], a[168:171], a[40:43], v[84:87]
buffer_load_dwordx4 v[156:159], v14, s[44:47], s65 offen offset:0 sc1
v_mfma_f32_16x16x32_bf16 v[116:119], a[168:171], a[48:51], v[116:119]
ds_read_b64_tr_b16 a[202:203], v187 offset:4096
v_mfma_f32_16x16x32_bf16 v[116:119], a[172:175], a[52:55], v[116:119]
ds_read_b64_tr_b16 a[204:205], v187 offset:8192
v_mfma_f32_16x16x32_bf16 v[148:151], a[172:175], a[60:63], v[148:151]
ds_read_b64_tr_b16 a[206:207], v187 offset:12288
v_mfma_f32_16x16x32_bf16 v[148:151], a[168:171], a[56:59], v[148:151]
buffer_load_dwordx4 v[164:167], v14, s[44:47], s65 offen offset:1024 sc1
v_mfma_f32_16x16x32_bf16 v[120:123], a[176:179], a[56:59], v[120:123]
s_waitcnt lgkmcnt(4)
v_mfma_f32_16x16x32_bf16 v[120:123], a[180:183], a[60:63], v[120:123]
v_mfma_f32_16x16x32_bf16 v[88:91], a[180:183], a[52:55], v[88:91]
buffer_load_dwordx4 v[172:175], v15, s[44:47], s65 offen offset:0 sc1
v_mfma_f32_16x16x32_bf16 v[88:91], a[176:179], a[48:51], v[88:91]
v_mfma_f32_16x16x32_bf16 v[56:59], a[176:179], a[40:43], v[56:59]
v_mfma_f32_16x16x32_bf16 v[56:59], a[180:183], a[44:47], v[56:59]
v_mfma_f32_16x16x32_bf16 v[24:27], a[180:183], a[36:39], v[24:27]
buffer_load_dwordx4 v[180:183], v15, s[44:47], s65 offen offset:1024 sc1
v_mfma_f32_16x16x32_bf16 v[24:27], a[176:179], a[32:35], v[24:27]
v_mfma_f32_16x16x32_bf16 v[28:31], a[184:187], a[32:35], v[28:31]
v_mfma_f32_16x16x32_bf16 v[28:31], a[188:191], a[36:39], v[28:31]
v_mfma_f32_16x16x32_bf16 v[60:63], a[188:191], a[44:47], v[60:63]
v_mfma_f32_16x16x32_bf16 v[60:63], a[184:187], a[40:43], v[60:63]
s_waitcnt vmcnt(25)
s_barrier
v_mfma_f32_16x16x32_bf16 v[92:95], a[184:187], a[48:51], v[92:95]
ds_read_b64_tr_b16 a[144:145], v188 offset:32768
v_mfma_f32_16x16x32_bf16 v[92:95], a[188:191], a[52:55], v[92:95]
ds_read_b64_tr_b16 a[146:147], v188 offset:36864
v_mfma_f32_16x16x32_bf16 v[124:127], a[188:191], a[60:63], v[124:127]
s_xor_b32 m0, s76, 65536
ds_read_b64_tr_b16 a[148:149], v188 offset:40960
v_mfma_f32_16x16x32_bf16 v[124:127], a[184:187], a[56:59], v[124:127]
s_xor_b32 s64, s85, 524288
ds_read_b64_tr_b16 a[150:151], v188 offset:45056
v_mfma_f32_16x16x32_bf16 v[128:131], a[192:195], a[56:59], v[128:131]
buffer_load_dwordx4 v12, s[40:43], s64 offen lds
v_mfma_f32_16x16x32_bf16 v[128:131], a[196:199], a[60:63], v[128:131]
s_xor_b32 m0, s76, 66560
ds_read_b64_tr_b16 a[152:153], v189 offset:32768
v_mfma_f32_16x16x32_bf16 v[96:99], a[196:199], a[52:55], v[96:99]
s_xor_b32 s64, s85, 532480
ds_read_b64_tr_b16 a[154:155], v189 offset:36864
v_mfma_f32_16x16x32_bf16 v[96:99], a[192:195], a[48:51], v[96:99]
buffer_load_dwordx4 v13, s[40:43], s64 offen lds
v_mfma_f32_16x16x32_bf16 v[64:67], a[192:195], a[40:43], v[64:67]
s_xor_b32 m0, s76, 67584
ds_read_b64_tr_b16 a[156:157], v189 offset:40960
v_mfma_f32_16x16x32_bf16 v[64:67], a[196:199], a[44:47], v[64:67]
s_xor_b32 s64, s85, 540672
ds_read_b64_tr_b16 a[158:159], v189 offset:45056
v_mfma_f32_16x16x32_bf16 v[32:35], a[196:199], a[36:39], v[32:35]
buffer_load_dwordx4 v12, s[40:43], s64 offen lds
v_mfma_f32_16x16x32_bf16 v[32:35], a[192:195], a[32:35], v[32:35]
s_waitcnt lgkmcnt(4)
s_xor_b32 m0, s76, 68608
ds_read_b64_tr_b16 a[160:161], v190 offset:32768
v_mfma_f32_16x16x32_bf16 v[36:39], a[200:203], a[32:35], v[36:39]
s_xor_b32 s64, s85, 548864
ds_read_b64_tr_b16 a[162:163], v190 offset:36864
v_mfma_f32_16x16x32_bf16 v[36:39], a[204:207], a[36:39], v[36:39]
buffer_load_dwordx4 v13, s[40:43], s64 offen lds
v_mfma_f32_16x16x32_bf16 v[68:71], a[204:207], a[44:47], v[68:71]
s_xor_b32 m0, s76, 69632
ds_read_b64_tr_b16 a[164:165], v190 offset:40960
v_mfma_f32_16x16x32_bf16 v[68:71], a[200:203], a[40:43], v[68:71]
s_xor_b32 s64, s85, 557056
ds_read_b64_tr_b16 a[166:167], v190 offset:45056
v_mfma_f32_16x16x32_bf16 v[100:103], a[200:203], a[48:51], v[100:103]
buffer_load_dwordx4 v12, s[40:43], s64 offen lds
v_mfma_f32_16x16x32_bf16 v[100:103], a[204:207], a[52:55], v[100:103]
s_mov_b32 s70, 3
s_mov_b32 s73, 2
v_mfma_f32_16x16x32_bf16 v[132:135], a[204:207], a[60:63], v[132:135]
v_mfma_f32_16x16x32_bf16 v[132:135], a[200:203], a[56:59], v[132:135]
s_branch L_p5join
.p2align 12
L_pg23:
s_branch L_pg31
L_p5join:
L_p5loop:
s_waitcnt lgkmcnt(10)
s_waitcnt vmcnt(19)
v_mfma_f32_16x16x32_bf16 v[136:139], a[144:147], a[232:235], v[136:139]
s_waitcnt vmcnt(15)
s_waitcnt lgkmcnt(8)
s_xor_b32 m0, s76, 70656
s_xor_b32 s64, s85, 565248
ds_read_b64_tr_b16 a[168:169], v191 offset:32768
v_mfma_f32_16x16x32_bf16 v[136:139], a[148:151], a[236:239], v[136:139]
buffer_load_dwordx4 v13, s[40:43], s64 offen lds
v_mfma_f32_16x16x32_bf16 v[104:107], a[148:151], a[228:231], v[104:107]
ds_read_b64_tr_b16 a[170:171], v191 offset:36864
v_mfma_f32_16x16x32_bf16 v[104:107], a[144:147], a[224:227], v[104:107]
s_xor_b32 m0, s76, 71680
ds_read_b64_tr_b16 a[172:173], v191 offset:40960
v_mfma_f32_16x16x32_bf16 v[72:75], a[144:147], a[216:219], v[72:75]
s_xor_b32 s64, s85, 573440
ds_read_b64_tr_b16 a[174:175], v191 offset:45056
v_mfma_f32_16x16x32_bf16 v[72:75], a[148:151], a[220:223], v[72:75]
buffer_load_dwordx4 v12, s[40:43], s64 offen lds
v_mfma_f32_16x16x32_bf16 v[40:43], a[148:151], a[212:215], v[40:43]
ds_read_b64_tr_b16 a[176:177], v184 offset:32768
v_mfma_f32_16x16x32_bf16 v[40:43], a[144:147], a[208:211], v[40:43]
s_waitcnt lgkmcnt(5)
s_xor_b32 m0, s76, 72704
ds_read_b64_tr_b16 a[178:179], v184 offset:36864
v_mfma_f32_16x16x32_bf16 v[44:47], a[152:155], a[208:211], v[44:47]
s_xor_b32 s64, s85, 581632
ds_read_b64_tr_b16 a[180:181], v184 offset:40960
v_mfma_f32_16x16x32_bf16 v[44:47], a[156:159], a[212:215], v[44:47]
buffer_load_dwordx4 v13, s[40:43], s64 offen lds
v_mfma_f32_16x16x32_bf16 v[76:79], a[156:159], a[220:223], v[76:79]
ds_read_b64_tr_b16 a[182:183], v184 offset:45056
v_mfma_f32_16x16x32_bf16 v[76:79], a[152:155], a[216:219], v[76:79]
ds_read_b64_tr_b16 a[184:185], v185 offset:32768
v_mfma_f32_16x16x32_bf16 v[108:111], a[152:155], a[224:227], v[108:111]
s_xor_b32 s65, s84, 65536
ds_read_b64_tr_b16 a[186:187], v185 offset:36864
v_mfma_f32_16x16x32_bf16 v[108:111], a[156:159], a[228:231], v[108:111]
buffer_load_dwordx4 a[0:3], v14, s[44:47], s65 offen offset:0 sc1
v_mfma_f32_16x16x32_bf16 v[140:143], a[156:159], a[236:239], v[140:143]
ds_read_b64_tr_b16 a[188:189], v185 offset:40960
v_mfma_f32_16x16x32_bf16 v[140:143], a[152:155], a[232:235], v[140:143]
ds_read_b64_tr_b16 a[190:191], v185 offset:45056
v_mfma_f32_16x16x32_bf16 v[144:147], a[160:163], a[232:235], v[144:147]
v_mfma_f32_16x16x32_bf16 v[144:147], a[164:167], a[236:239], v[144:147]
buffer_load_dwordx4 a[8:11], v14, s[44:47], s65 offen offset:1024 sc1
v_mfma_f32_16x16x32_bf16 v[112:115], a[164:167], a[228:231], v[112:115]
ds_read_b64_tr_b16 a[192:193], v186 offset:32768
v_mfma_f32_16x16x32_bf16 v[112:115], a[160:163], a[224:227], v[112:115]
ds_read_b64_tr_b16 a[194:195], v186 offset:36864
v_mfma_f32_16x16x32_bf16 v[80:83], a[160:163], a[216:219], v[80:83]
ds_read_b64_tr_b16 a[196:197], v186 offset:40960
v_mfma_f32_16x16x32_bf16 v[80:83], a[164:167], a[220:223], v[80:83]
buffer_load_dwordx4 a[16:19], v15, s[44:47], s65 offen offset:0 sc1
v_mfma_f32_16x16x32_bf16 v[48:51], a[164:167], a[212:215], v[48:51]
ds_read_b64_tr_b16 a[198:199], v186 offset:45056
v_mfma_f32_16x16x32_bf16 v[48:51], a[160:163], a[208:211], v[48:51]
s_waitcnt lgkmcnt(4)
v_mfma_f32_16x16x32_bf16 v[52:55], a[168:171], a[208:211], v[52:55]
v_mfma_f32_16x16x32_bf16 v[52:55], a[172:175], a[212:215], v[52:55]
buffer_load_dwordx4 a[24:27], v15, s[44:47], s65 offen offset:1024 sc1
v_mfma_f32_16x16x32_bf16 v[84:87], a[172:175], a[220:223], v[84:87]
ds_read_b64_tr_b16 a[200:201], v187 offset:32768
v_mfma_f32_16x16x32_bf16 v[84:87], a[168:171], a[216:219], v[84:87]
ds_read_b64_tr_b16 a[202:203], v187 offset:36864
v_mfma_f32_16x16x32_bf16 v[116:119], a[168:171], a[224:227], v[116:119]
s_xor_b32 s65, s84, 73728
ds_read_b64_tr_b16 a[204:205], v187 offset:40960
v_mfma_f32_16x16x32_bf16 v[116:119], a[172:175], a[228:231], v[116:119]
buffer_load_dwordx4 a[4:7], v14, s[44:47], s65 offen offset:0 sc1
v_mfma_f32_16x16x32_bf16 v[148:151], a[172:175], a[236:239], v[148:151]
ds_read_b64_tr_b16 a[206:207], v187 offset:45056
v_mfma_f32_16x16x32_bf16 v[148:151], a[168:171], a[232:235], v[148:151]
v_mfma_f32_16x16x32_bf16 v[120:123], a[176:179], a[232:235], v[120:123]
v_mfma_f32_16x16x32_bf16 v[120:123], a[180:183], a[236:239], v[120:123]
buffer_load_dwordx4 a[12:15], v14, s[44:47], s65 offen offset:1024 sc1
v_mfma_f32_16x16x32_bf16 v[88:91], a[180:183], a[228:231], v[88:91]
v_mfma_f32_16x16x32_bf16 v[88:91], a[176:179], a[224:227], v[88:91]
v_mfma_f32_16x16x32_bf16 v[56:59], a[176:179], a[216:219], v[56:59]
v_mfma_f32_16x16x32_bf16 v[56:59], a[180:183], a[220:223], v[56:59]
buffer_load_dwordx4 a[20:23], v15, s[44:47], s65 offen offset:0 sc1
v_mfma_f32_16x16x32_bf16 v[24:27], a[180:183], a[212:215], v[24:27]
v_mfma_f32_16x16x32_bf16 v[24:27], a[176:179], a[208:211], v[24:27]
v_mfma_f32_16x16x32_bf16 v[28:31], a[184:187], a[208:211], v[28:31]
v_mfma_f32_16x16x32_bf16 v[28:31], a[188:191], a[212:215], v[28:31]
buffer_load_dwordx4 a[28:31], v15, s[44:47], s65 offen offset:1024 sc1
v_mfma_f32_16x16x32_bf16 v[60:63], a[188:191], a[220:223], v[60:63]
v_mfma_f32_16x16x32_bf16 v[60:63], a[184:187], a[216:219], v[60:63]
s_waitcnt vmcnt(24)
s_barrier
v_mfma_f32_16x16x32_bf16 v[92:95], a[184:187], a[224:227], v[92:95]
s_xor_b32 m0, s76, 98304
ds_read_b64_tr_b16 a[144:145], v196 offset:0
v_mfma_f32_16x16x32_bf16 v[92:95], a[188:191], a[228:231], v[92:95]
s_xor_b32 s64, s85, 786432
ds_read_b64_tr_b16 a[146:147], v196 offset:4096
v_mfma_f32_16x16x32_bf16 v[124:127], a[188:191], a[236:239], v[124:127]
buffer_load_dwordx4 v12, s[40:43], s64 offen lds
v_mfma_f32_16x16x32_bf16 v[124:127], a[184:187], a[232:235], v[124:127]
s_waitcnt lgkmcnt(2)
s_xor_b32 m0, s76, 99328
ds_read_b64_tr_b16 a[148:149], v196 offset:8192
v_mfma_f32_16x16x32_bf16 v[128:131], a[192:195], a[232:235], v[128:131]
s_xor_b32 s64, s85, 794624
ds_read_b64_tr_b16 a[150:151], v196 offset:12288
v_mfma_f32_16x16x32_bf16 v[128:131], a[196:199], a[236:239], v[128:131]
buffer_load_dwordx4 v13, s[40:43], s64 offen lds
v_mfma_f32_16x16x32_bf16 v[96:99], a[196:199], a[228:231], v[96:99]
ds_read_b64_tr_b16 a[152:153], v197 offset:0
v_mfma_f32_16x16x32_bf16 v[96:99], a[192:195], a[224:227], v[96:99]
s_xor_b32 m0, s76, 100352
ds_read_b64_tr_b16 a[154:155], v197 offset:4096
v_mfma_f32_16x16x32_bf16 v[64:67], a[192:195], a[216:219], v[64:67]
s_xor_b32 s64, s85, 802816
ds_read_b64_tr_b16 a[156:157], v197 offset:8192
v_mfma_f32_16x16x32_bf16 v[64:67], a[196:199], a[220:223], v[64:67]
buffer_load_dwordx4 v12, s[40:43], s64 offen lds
v_mfma_f32_16x16x32_bf16 v[32:35], a[196:199], a[212:215], v[32:35]
ds_read_b64_tr_b16 a[158:159], v197 offset:12288
v_mfma_f32_16x16x32_bf16 v[32:35], a[192:195], a[208:211], v[32:35]
s_xor_b32 m0, s76, 101376
ds_read_b64_tr_b16 a[160:161], v198 offset:0
v_mfma_f32_16x16x32_bf16 v[36:39], a[200:203], a[208:211], v[36:39]
s_xor_b32 s64, s85, 811008
ds_read_b64_tr_b16 a[162:163], v198 offset:4096
v_mfma_f32_16x16x32_bf16 v[36:39], a[204:207], a[212:215], v[36:39]
buffer_load_dwordx4 v13, s[40:43], s64 offen lds
v_mfma_f32_16x16x32_bf16 v[68:71], a[204:207], a[220:223], v[68:71]
ds_read_b64_tr_b16 a[164:165], v198 offset:8192
v_mfma_f32_16x16x32_bf16 v[68:71], a[200:203], a[216:219], v[68:71]
s_xor_b32 m0, s76, 102400
ds_read_b64_tr_b16 a[166:167], v198 offset:12288
v_mfma_f32_16x16x32_bf16 v[100:103], a[200:203], a[224:227], v[100:103]
s_xor_b32 s64, s85, 819200
v_mfma_f32_16x16x32_bf16 v[100:103], a[204:207], a[228:231], v[100:103]
buffer_load_dwordx4 v12, s[40:43], s64 offen lds
v_mfma_f32_16x16x32_bf16 v[132:135], a[204:207], a[236:239], v[132:135]
v_mfma_f32_16x16x32_bf16 v[132:135], a[200:203], a[232:235], v[132:135]
s_waitcnt vmcnt(25)
s_waitcnt lgkmcnt(3)
s_xor_b32 m0, s76, 103424
buffer_load_dword v19, off, s[52:55], s72 offset:128 sc1
v_mfma_f32_16x16x32_bf16 v[136:139], a[144:147], v[176:179], v[136:139]
s_waitcnt vmcnt(22)
s_xor_b32 s64, s85, 827392
ds_read_b64_tr_b16 a[168:169], v199 offset:0
v_mfma_f32_16x16x32_bf16 v[136:139], a[148:151], v[180:183], v[136:139]
buffer_load_dwordx4 v13, s[40:43], s64 offen lds
v_mfma_f32_16x16x32_bf16 v[104:107], a[148:151], v[172:175], v[104:107]
ds_read_b64_tr_b16 a[170:171], v199 offset:4096
v_mfma_f32_16x16x32_bf16 v[104:107], a[144:147], v[168:171], v[104:107]
s_xor_b32 m0, s76, 104448
ds_read_b64_tr_b16 a[172:173], v199 offset:8192
v_mfma_f32_16x16x32_bf16 v[72:75], a[144:147], v[160:163], v[72:75]
s_xor_b32 s64, s85, 835584
ds_read_b64_tr_b16 a[174:175], v199 offset:12288
v_mfma_f32_16x16x32_bf16 v[72:75], a[148:151], v[164:167], v[72:75]
buffer_load_dwordx4 v12, s[40:43], s64 offen lds
v_mfma_f32_16x16x32_bf16 v[40:43], a[148:151], v[156:159], v[40:43]
ds_read_b64_tr_b16 a[176:177], v192 offset:0
v_mfma_f32_16x16x32_bf16 v[40:43], a[144:147], v[152:155], v[40:43]
s_xor_b32 m0, s76, 105472
ds_read_b64_tr_b16 a[178:179], v192 offset:4096
v_mfma_f32_16x16x32_bf16 v[44:47], a[152:155], v[152:155], v[44:47]
s_xor_b32 s64, s85, 843776
ds_read_b64_tr_b16 a[180:181], v192 offset:8192
v_mfma_f32_16x16x32_bf16 v[44:47], a[156:159], v[156:159], v[44:47]
buffer_load_dwordx4 v13, s[40:43], s64 offen lds
v_mfma_f32_16x16x32_bf16 v[76:79], a[156:159], v[164:167], v[76:79]
ds_read_b64_tr_b16 a[182:183], v192 offset:12288
v_mfma_f32_16x16x32_bf16 v[76:79], a[152:155], v[160:163], v[76:79]
ds_read_b64_tr_b16 a[184:185], v193 offset:0
v_mfma_f32_16x16x32_bf16 v[108:111], a[152:155], v[168:171], v[108:111]
s_xor_b32 s65, s84, 98304
ds_read_b64_tr_b16 a[186:187], v193 offset:4096
v_mfma_f32_16x16x32_bf16 v[108:111], a[156:159], v[172:175], v[108:111]
buffer_load_dwordx4 a[32:35], v14, s[44:47], s65 offen offset:0 sc1
v_mfma_f32_16x16x32_bf16 v[140:143], a[156:159], v[180:183], v[140:143]
ds_read_b64_tr_b16 a[188:189], v193 offset:8192
v_mfma_f32_16x16x32_bf16 v[140:143], a[152:155], v[176:179], v[140:143]
s_waitcnt lgkmcnt(5)
ds_read_b64_tr_b16 a[190:191], v193 offset:12288
v_mfma_f32_16x16x32_bf16 v[144:147], a[160:163], v[176:179], v[144:147]
s_lshl_b32 s75, s73, 20
s_add_u32 s85, s85, s75
s_lshr_b32 s74, s73, 28
v_mfma_f32_16x16x32_bf16 v[144:147], a[164:167], v[180:183], v[144:147]
s_and_b32 s74, s74, 8
buffer_load_dwordx4 a[40:43], v14, s[44:47], s65 offen offset:1024 sc1
v_mfma_f32_16x16x32_bf16 v[112:115], a[164:167], v[172:175], v[112:115]
ds_read_b64_tr_b16 a[192:193], v194 offset:0
v_mfma_f32_16x16x32_bf16 v[112:115], a[160:163], v[168:171], v[112:115]
ds_read_b64_tr_b16 a[194:195], v194 offset:4096
v_mfma_f32_16x16x32_bf16 v[80:83], a[160:163], v[160:163], v[80:83]
ds_read_b64_tr_b16 a[196:197], v194 offset:8192
v_mfma_f32_16x16x32_bf16 v[80:83], a[164:167], v[164:167], v[80:83]
buffer_load_dwordx4 a[48:51], v15, s[44:47], s65 offen offset:0 sc1
v_mfma_f32_16x16x32_bf16 v[48:51], a[164:167], v[156:159], v[48:51]
ds_read_b64_tr_b16 a[198:199], v194 offset:12288
v_mfma_f32_16x16x32_bf16 v[48:51], a[160:163], v[152:155], v[48:51]
v_mfma_f32_16x16x32_bf16 v[52:55], a[168:171], v[152:155], v[52:55]
v_mfma_f32_16x16x32_bf16 v[52:55], a[172:175], v[156:159], v[52:55]
buffer_load_dwordx4 a[56:59], v15, s[44:47], s65 offen offset:1024 sc1
v_mfma_f32_16x16x32_bf16 v[84:87], a[172:175], v[164:167], v[84:87]
ds_read_b64_tr_b16 a[200:201], v195 offset:0
v_mfma_f32_16x16x32_bf16 v[84:87], a[168:171], v[160:163], v[84:87]
ds_read_b64_tr_b16 a[202:203], v195 offset:4096
v_mfma_f32_16x16x32_bf16 v[116:119], a[168:171], v[168:171], v[116:119]
s_xor_b32 s65, s84, 106496
ds_read_b64_tr_b16 a[204:205], v195 offset:8192
v_mfma_f32_16x16x32_bf16 v[116:119], a[172:175], v[172:175], v[116:119]
buffer_load_dwordx4 a[36:39], v14, s[44:47], s65 offen offset:0 sc1
v_mfma_f32_16x16x32_bf16 v[148:151], a[172:175], v[180:183], v[148:151]
ds_read_b64_tr_b16 a[206:207], v195 offset:12288
v_mfma_f32_16x16x32_bf16 v[148:151], a[168:171], v[176:179], v[148:151]
v_mfma_f32_16x16x32_bf16 v[120:123], a[176:179], v[176:179], v[120:123]
s_waitcnt lgkmcnt(4)
v_mfma_f32_16x16x32_bf16 v[120:123], a[180:183], v[180:183], v[120:123]
buffer_load_dwordx4 a[44:47], v14, s[44:47], s65 offen offset:1024 sc1
v_mfma_f32_16x16x32_bf16 v[88:91], a[180:183], v[172:175], v[88:91]
v_mfma_f32_16x16x32_bf16 v[88:91], a[176:179], v[168:171], v[88:91]
v_mfma_f32_16x16x32_bf16 v[56:59], a[176:179], v[160:163], v[56:59]
v_mfma_f32_16x16x32_bf16 v[56:59], a[180:183], v[164:167], v[56:59]
buffer_load_dwordx4 a[52:55], v15, s[44:47], s65 offen offset:0 sc1
v_mfma_f32_16x16x32_bf16 v[24:27], a[180:183], v[156:159], v[24:27]
v_mfma_f32_16x16x32_bf16 v[24:27], a[176:179], v[152:155], v[24:27]
v_mfma_f32_16x16x32_bf16 v[28:31], a[184:187], v[152:155], v[28:31]
v_mfma_f32_16x16x32_bf16 v[28:31], a[188:191], v[156:159], v[28:31]
buffer_load_dwordx4 a[60:63], v15, s[44:47], s65 offen offset:1024 sc1
v_mfma_f32_16x16x32_bf16 v[60:63], a[188:191], v[164:167], v[60:63]
v_mfma_f32_16x16x32_bf16 v[60:63], a[184:187], v[160:163], v[60:63]
s_waitcnt vmcnt(25)
s_barrier
v_mfma_f32_16x16x32_bf16 v[92:95], a[184:187], v[168:171], v[92:95]
s_lshl_b32 s75, s73, 17
s_add_u32 s84, s84, s75
s_xor_b32 m0, s76, 131072
ds_read_b64_tr_b16 a[144:145], v196 offset:32768
v_mfma_f32_16x16x32_bf16 v[92:95], a[188:191], v[172:175], v[92:95]
s_xor_b32 s64, s85, 0
ds_read_b64_tr_b16 a[146:147], v196 offset:36864
v_mfma_f32_16x16x32_bf16 v[124:127], a[188:191], v[180:183], v[124:127]
buffer_load_dwordx4 v12, s[40:43], s64 offen lds
v_mfma_f32_16x16x32_bf16 v[124:127], a[184:187], v[176:179], v[124:127]
s_xor_b32 m0, s76, 132096
ds_read_b64_tr_b16 a[148:149], v196 offset:40960
v_mfma_f32_16x16x32_bf16 v[128:131], a[192:195], v[176:179], v[128:131]
s_xor_b32 s64, s85, 8192
ds_read_b64_tr_b16 a[150:151], v196 offset:45056
v_mfma_f32_16x16x32_bf16 v[128:131], a[196:199], v[180:183], v[128:131]
buffer_load_dwordx4 v13, s[40:43], s64 offen lds
v_mfma_f32_16x16x32_bf16 v[96:99], a[196:199], v[172:175], v[96:99]
ds_read_b64_tr_b16 a[152:153], v197 offset:32768
v_mfma_f32_16x16x32_bf16 v[96:99], a[192:195], v[168:171], v[96:99]
s_xor_b32 m0, s76, 133120
ds_read_b64_tr_b16 a[154:155], v197 offset:36864
v_mfma_f32_16x16x32_bf16 v[64:67], a[192:195], v[160:163], v[64:67]
s_xor_b32 s64, s85, 16384
ds_read_b64_tr_b16 a[156:157], v197 offset:40960
v_mfma_f32_16x16x32_bf16 v[64:67], a[196:199], v[164:167], v[64:67]
buffer_load_dwordx4 v12, s[40:43], s64 offen lds
v_mfma_f32_16x16x32_bf16 v[32:35], a[196:199], v[156:159], v[32:35]
ds_read_b64_tr_b16 a[158:159], v197 offset:45056
v_mfma_f32_16x16x32_bf16 v[32:35], a[192:195], v[152:155], v[32:35]
s_waitcnt lgkmcnt(5)
s_xor_b32 m0, s76, 134144
ds_read_b64_tr_b16 a[160:161], v198 offset:32768
v_mfma_f32_16x16x32_bf16 v[36:39], a[200:203], v[152:155], v[36:39]
s_xor_b32 s64, s85, 24576
ds_read_b64_tr_b16 a[162:163], v198 offset:36864
v_mfma_f32_16x16x32_bf16 v[36:39], a[204:207], v[156:159], v[36:39]
buffer_load_dwordx4 v13, s[40:43], s64 offen lds
v_mfma_f32_16x16x32_bf16 v[68:71], a[204:207], v[164:167], v[68:71]
ds_read_b64_tr_b16 a[164:165], v198 offset:40960
v_mfma_f32_16x16x32_bf16 v[68:71], a[200:203], v[160:163], v[68:71]
s_xor_b32 m0, s76, 135168
ds_read_b64_tr_b16 a[166:167], v198 offset:45056
v_mfma_f32_16x16x32_bf16 v[100:103], a[200:203], v[168:171], v[100:103]
s_xor_b32 s64, s85, 32768
v_mfma_f32_16x16x32_bf16 v[100:103], a[204:207], v[172:175], v[100:103]
buffer_load_dwordx4 v12, s[40:43], s64 offen lds
v_mfma_f32_16x16x32_bf16 v[132:135], a[204:207], v[180:183], v[132:135]
v_mfma_f32_16x16x32_bf16 v[132:135], a[200:203], v[176:179], v[132:135]
s_waitcnt vmcnt(26)
v_mfma_f32_16x16x32_bf16 v[136:139], a[144:147], a[24:27], v[136:139]
s_waitcnt vmcnt(16)
v_readfirstlane_b32 vcc_lo, v19
s_nop 0
s_cmp_lt_u32 vcc_lo, s74
s_cbranch_scc1 L_spin_4022
L_spinbk_4023:
s_waitcnt lgkmcnt(2)
v_mfma_f32_16x16x32_bf16 v[136:139], a[148:151], a[28:31], v[136:139]
s_xor_b32 m0, s76, 136192
ds_read_b64_tr_b16 a[168:169], v199 offset:32768
v_mfma_f32_16x16x32_bf16 v[104:107], a[148:151], a[20:23], v[104:107]
s_xor_b32 s64, s85, 40960
ds_read_b64_tr_b16 a[170:171], v199 offset:36864
v_mfma_f32_16x16x32_bf16 v[104:107], a[144:147], a[16:19], v[104:107]
buffer_load_dwordx4 v13, s[40:43], s64 offen lds
v_mfma_f32_16x16x32_bf16 v[72:75], a[144:147], a[8:11], v[72:75]
s_xor_b32 m0, s76, 137216
ds_read_b64_tr_b16 a[172:173], v199 offset:40960
v_mfma_f32_16x16x32_bf16 v[72:75], a[148:151], a[12:15], v[72:75]
s_xor_b32 s64, s85, 49152
ds_read_b64_tr_b16 a[174:175], v199 offset:45056
v_mfma_f32_16x16x32_bf16 v[40:43], a[148:151], a[4:7], v[40:43]
buffer_load_dwordx4 v12, s[40:43], s64 offen lds
v_mfma_f32_16x16x32_bf16 v[40:43], a[144:147], a[0:3], v[40:43]
ds_read_b64_tr_b16 a[176:177], v192 offset:32768
v_mfma_f32_16x16x32_bf16 v[44:47], a[152:155], a[0:3], v[44:47]
s_xor_b32 m0, s76, 138240
ds_read_b64_tr_b16 a[178:179], v192 offset:36864
v_mfma_f32_16x16x32_bf16 v[44:47], a[156:159], a[4:7], v[44:47]
s_xor_b32 s64, s85, 57344
ds_read_b64_tr_b16 a[180:181], v192 offset:40960
v_mfma_f32_16x16x32_bf16 v[76:79], a[156:159], a[12:15], v[76:79]
buffer_load_dwordx4 v13, s[40:43], s64 offen lds
v_mfma_f32_16x16x32_bf16 v[76:79], a[152:155], a[8:11], v[76:79]
ds_read_b64_tr_b16 a[182:183], v192 offset:45056
v_mfma_f32_16x16x32_bf16 v[108:111], a[152:155], a[16:19], v[108:111]
ds_read_b64_tr_b16 a[184:185], v193 offset:32768
v_mfma_f32_16x16x32_bf16 v[108:111], a[156:159], a[20:23], v[108:111]
s_xor_b32 s65, s84, 0
ds_read_b64_tr_b16 a[186:187], v193 offset:36864
v_mfma_f32_16x16x32_bf16 v[140:143], a[156:159], a[28:31], v[140:143]
buffer_load_dwordx4 a[208:211], v14, s[44:47], s65 offen offset:0 sc1
v_mfma_f32_16x16x32_bf16 v[140:143], a[152:155], a[24:27], v[140:143]
ds_read_b64_tr_b16 a[188:189], v193 offset:40960
v_mfma_f32_16x16x32_bf16 v[144:147], a[160:163], a[24:27], v[144:147]
s_waitcnt lgkmcnt(5)
ds_read_b64_tr_b16 a[190:191], v193 offset:45056
v_mfma_f32_16x16x32_bf16 v[144:147], a[164:167], a[28:31], v[144:147]
v_mfma_f32_16x16x32_bf16 v[112:115], a[164:167], a[20:23], v[112:115]
buffer_load_dwordx4 a[216:219], v14, s[44:47], s65 offen offset:1024 sc1
v_mfma_f32_16x16x32_bf16 v[112:115], a[160:163], a[16:19], v[112:115]
ds_read_b64_tr_b16 a[192:193], v194 offset:32768
v_mfma_f32_16x16x32_bf16 v[80:83], a[160:163], a[8:11], v[80:83]
ds_read_b64_tr_b16 a[194:195], v194 offset:36864
v_mfma_f32_16x16x32_bf16 v[80:83], a[164:167], a[12:15], v[80:83]
ds_read_b64_tr_b16 a[196:197], v194 offset:40960
v_mfma_f32_16x16x32_bf16 v[48:51], a[164:167], a[4:7], v[48:51]
buffer_load_dwordx4 a[224:227], v15, s[44:47], s65 offen offset:0 sc1
v_mfma_f32_16x16x32_bf16 v[48:51], a[160:163], a[0:3], v[48:51]
ds_read_b64_tr_b16 a[198:199], v194 offset:45056
v_mfma_f32_16x16x32_bf16 v[52:55], a[168:171], a[0:3], v[52:55]
v_mfma_f32_16x16x32_bf16 v[52:55], a[172:175], a[4:7], v[52:55]
buffer_load_dwordx4 a[232:235], v15, s[44:47], s65 offen offset:1024 sc1
v_mfma_f32_16x16x32_bf16 v[84:87], a[172:175], a[12:15], v[84:87]
ds_read_b64_tr_b16 a[200:201], v195 offset:32768
v_mfma_f32_16x16x32_bf16 v[84:87], a[168:171], a[8:11], v[84:87]
ds_read_b64_tr_b16 a[202:203], v195 offset:36864
v_mfma_f32_16x16x32_bf16 v[116:119], a[168:171], a[16:19], v[116:119]
s_xor_b32 s65, s84, 8192
ds_read_b64_tr_b16 a[204:205], v195 offset:40960
v_mfma_f32_16x16x32_bf16 v[116:119], a[172:175], a[20:23], v[116:119]
buffer_load_dwordx4 a[212:215], v14, s[44:47], s65 offen offset:0 sc1
v_mfma_f32_16x16x32_bf16 v[148:151], a[172:175], a[28:31], v[148:151]
ds_read_b64_tr_b16 a[206:207], v195 offset:45056
v_mfma_f32_16x16x32_bf16 v[148:151], a[168:171], a[24:27], v[148:151]
v_mfma_f32_16x16x32_bf16 v[120:123], a[176:179], a[24:27], v[120:123]
s_waitcnt lgkmcnt(4)
v_mfma_f32_16x16x32_bf16 v[120:123], a[180:183], a[28:31], v[120:123]
buffer_load_dwordx4 a[220:223], v14, s[44:47], s65 offen offset:1024 sc1
v_mfma_f32_16x16x32_bf16 v[88:91], a[180:183], a[20:23], v[88:91]
v_mfma_f32_16x16x32_bf16 v[88:91], a[176:179], a[16:19], v[88:91]
v_mfma_f32_16x16x32_bf16 v[56:59], a[176:179], a[8:11], v[56:59]
v_mfma_f32_16x16x32_bf16 v[56:59], a[180:183], a[12:15], v[56:59]
buffer_load_dwordx4 a[228:231], v15, s[44:47], s65 offen offset:0 sc1
v_mfma_f32_16x16x32_bf16 v[24:27], a[180:183], a[4:7], v[24:27]
v_mfma_f32_16x16x32_bf16 v[24:27], a[176:179], a[0:3], v[24:27]
v_mfma_f32_16x16x32_bf16 v[28:31], a[184:187], a[0:3], v[28:31]
v_mfma_f32_16x16x32_bf16 v[28:31], a[188:191], a[4:7], v[28:31]
buffer_load_dwordx4 a[236:239], v15, s[44:47], s65 offen offset:1024 sc1
v_mfma_f32_16x16x32_bf16 v[60:63], a[188:191], a[12:15], v[60:63]
v_mfma_f32_16x16x32_bf16 v[60:63], a[184:187], a[8:11], v[60:63]
s_waitcnt vmcnt(24)
s_barrier
v_mfma_f32_16x16x32_bf16 v[92:95], a[184:187], a[16:19], v[92:95]
s_xor_b32 m0, s76, 32768
ds_read_b64_tr_b16 a[144:145], v188 offset:0
v_mfma_f32_16x16x32_bf16 v[92:95], a[188:191], a[20:23], v[92:95]
s_xor_b32 s64, s85, 262144
ds_read_b64_tr_b16 a[146:147], v188 offset:4096
v_mfma_f32_16x16x32_bf16 v[124:127], a[188:191], a[28:31], v[124:127]
buffer_load_dwordx4 v12, s[40:43], s64 offen lds
v_mfma_f32_16x16x32_bf16 v[124:127], a[184:187], a[24:27], v[124:127]
s_xor_b32 m0, s76, 33792
ds_read_b64_tr_b16 a[148:149], v188 offset:8192
v_mfma_f32_16x16x32_bf16 v[128:131], a[192:195], a[24:27], v[128:131]
s_xor_b32 s64, s85, 270336
ds_read_b64_tr_b16 a[150:151], v188 offset:12288
v_mfma_f32_16x16x32_bf16 v[128:131], a[196:199], a[28:31], v[128:131]
buffer_load_dwordx4 v13, s[40:43], s64 offen lds
v_mfma_f32_16x16x32_bf16 v[96:99], a[196:199], a[20:23], v[96:99]
ds_read_b64_tr_b16 a[152:153], v189 offset:0
v_mfma_f32_16x16x32_bf16 v[96:99], a[192:195], a[16:19], v[96:99]
s_xor_b32 m0, s76, 34816
ds_read_b64_tr_b16 a[154:155], v189 offset:4096
v_mfma_f32_16x16x32_bf16 v[64:67], a[192:195], a[8:11], v[64:67]
s_xor_b32 s64, s85, 278528
ds_read_b64_tr_b16 a[156:157], v189 offset:8192
v_mfma_f32_16x16x32_bf16 v[64:67], a[196:199], a[12:15], v[64:67]
buffer_load_dwordx4 v12, s[40:43], s64 offen lds
v_mfma_f32_16x16x32_bf16 v[32:35], a[196:199], a[4:7], v[32:35]
ds_read_b64_tr_b16 a[158:159], v189 offset:12288
v_mfma_f32_16x16x32_bf16 v[32:35], a[192:195], a[0:3], v[32:35]
s_waitcnt lgkmcnt(5)
s_xor_b32 m0, s76, 35840
ds_read_b64_tr_b16 a[160:161], v190 offset:0
v_mfma_f32_16x16x32_bf16 v[36:39], a[200:203], a[0:3], v[36:39]
s_xor_b32 s64, s85, 286720
ds_read_b64_tr_b16 a[162:163], v190 offset:4096
v_mfma_f32_16x16x32_bf16 v[36:39], a[204:207], a[4:7], v[36:39]
buffer_load_dwordx4 v13, s[40:43], s64 offen lds
v_mfma_f32_16x16x32_bf16 v[68:71], a[204:207], a[12:15], v[68:71]
ds_read_b64_tr_b16 a[164:165], v190 offset:8192
v_mfma_f32_16x16x32_bf16 v[68:71], a[200:203], a[8:11], v[68:71]
s_xor_b32 m0, s76, 36864
ds_read_b64_tr_b16 a[166:167], v190 offset:12288
v_mfma_f32_16x16x32_bf16 v[100:103], a[200:203], a[16:19], v[100:103]
s_xor_b32 s64, s85, 294912
v_mfma_f32_16x16x32_bf16 v[100:103], a[204:207], a[20:23], v[100:103]
buffer_load_dwordx4 v12, s[40:43], s64 offen lds
v_mfma_f32_16x16x32_bf16 v[132:135], a[204:207], a[28:31], v[132:135]
v_mfma_f32_16x16x32_bf16 v[132:135], a[200:203], a[24:27], v[132:135]
s_waitcnt vmcnt(25)
s_xor_b32 m0, s76, 37888
v_mfma_f32_16x16x32_bf16 v[136:139], a[144:147], a[56:59], v[136:139]
s_waitcnt vmcnt(21)
s_waitcnt lgkmcnt(2)
s_xor_b32 s64, s85, 303104
ds_read_b64_tr_b16 a[168:169], v191 offset:0
v_mfma_f32_16x16x32_bf16 v[136:139], a[148:151], a[60:63], v[136:139]
buffer_load_dwordx4 v13, s[40:43], s64 offen lds
v_mfma_f32_16x16x32_bf16 v[104:107], a[148:151], a[52:55], v[104:107]
ds_read_b64_tr_b16 a[170:171], v191 offset:4096
v_mfma_f32_16x16x32_bf16 v[104:107], a[144:147], a[48:51], v[104:107]
s_xor_b32 m0, s76, 38912
ds_read_b64_tr_b16 a[172:173], v191 offset:8192
v_mfma_f32_16x16x32_bf16 v[72:75], a[144:147], a[40:43], v[72:75]
s_xor_b32 s64, s85, 311296
ds_read_b64_tr_b16 a[174:175], v191 offset:12288
v_mfma_f32_16x16x32_bf16 v[72:75], a[148:151], a[44:47], v[72:75]
buffer_load_dwordx4 v12, s[40:43], s64 offen lds
v_mfma_f32_16x16x32_bf16 v[40:43], a[148:151], a[36:39], v[40:43]
ds_read_b64_tr_b16 a[176:177], v184 offset:0
v_mfma_f32_16x16x32_bf16 v[40:43], a[144:147], a[32:35], v[40:43]
s_xor_b32 m0, s76, 39936
ds_read_b64_tr_b16 a[178:179], v184 offset:4096
v_mfma_f32_16x16x32_bf16 v[44:47], a[152:155], a[32:35], v[44:47]
s_xor_b32 s64, s85, 319488
ds_read_b64_tr_b16 a[180:181], v184 offset:8192
v_mfma_f32_16x16x32_bf16 v[44:47], a[156:159], a[36:39], v[44:47]
buffer_load_dwordx4 v13, s[40:43], s64 offen lds
v_mfma_f32_16x16x32_bf16 v[76:79], a[156:159], a[44:47], v[76:79]
ds_read_b64_tr_b16 a[182:183], v184 offset:12288
v_mfma_f32_16x16x32_bf16 v[76:79], a[152:155], a[40:43], v[76:79]
ds_read_b64_tr_b16 a[184:185], v185 offset:0
v_mfma_f32_16x16x32_bf16 v[108:111], a[152:155], a[48:51], v[108:111]
s_xor_b32 s65, s84, 32768
ds_read_b64_tr_b16 a[186:187], v185 offset:4096
v_mfma_f32_16x16x32_bf16 v[108:111], a[156:159], a[52:55], v[108:111]
buffer_load_dwordx4 v[152:155], v14, s[44:47], s65 offen offset:0 sc1
v_mfma_f32_16x16x32_bf16 v[140:143], a[156:159], a[60:63], v[140:143]
ds_read_b64_tr_b16 a[188:189], v185 offset:8192
v_mfma_f32_16x16x32_bf16 v[140:143], a[152:155], a[56:59], v[140:143]
ds_read_b64_tr_b16 a[190:191], v185 offset:12288
v_mfma_f32_16x16x32_bf16 v[144:147], a[160:163], a[56:59], v[144:147]
s_waitcnt lgkmcnt(5)
v_mfma_f32_16x16x32_bf16 v[144:147], a[164:167], a[60:63], v[144:147]
buffer_load_dwordx4 v[160:163], v14, s[44:47], s65 offen offset:1024 sc1
v_mfma_f32_16x16x32_bf16 v[112:115], a[164:167], a[52:55], v[112:115]
ds_read_b64_tr_b16 a[192:193], v186 offset:0
v_mfma_f32_16x16x32_bf16 v[112:115], a[160:163], a[48:51], v[112:115]
ds_read_b64_tr_b16 a[194:195], v186 offset:4096
v_mfma_f32_16x16x32_bf16 v[80:83], a[160:163], a[40:43], v[80:83]
ds_read_b64_tr_b16 a[196:197], v186 offset:8192
v_mfma_f32_16x16x32_bf16 v[80:83], a[164:167], a[44:47], v[80:83]
buffer_load_dwordx4 v[168:171], v15, s[44:47], s65 offen offset:0 sc1
v_mfma_f32_16x16x32_bf16 v[48:51], a[164:167], a[36:39], v[48:51]
ds_read_b64_tr_b16 a[198:199], v186 offset:12288
v_mfma_f32_16x16x32_bf16 v[48:51], a[160:163], a[32:35], v[48:51]
v_mfma_f32_16x16x32_bf16 v[52:55], a[168:171], a[32:35], v[52:55]
v_mfma_f32_16x16x32_bf16 v[52:55], a[172:175], a[36:39], v[52:55]
buffer_load_dwordx4 v[176:179], v15, s[44:47], s65 offen offset:1024 sc1
v_mfma_f32_16x16x32_bf16 v[84:87], a[172:175], a[44:47], v[84:87]
ds_read_b64_tr_b16 a[200:201], v187 offset:0
v_mfma_f32_16x16x32_bf16 v[84:87], a[168:171], a[40:43], v[84:87]
ds_read_b64_tr_b16 a[202:203], v187 offset:4096
v_mfma_f32_16x16x32_bf16 v[116:119], a[168:171], a[48:51], v[116:119]
s_xor_b32 s65, s84, 40960
ds_read_b64_tr_b16 a[204:205], v187 offset:8192
v_mfma_f32_16x16x32_bf16 v[116:119], a[172:175], a[52:55], v[116:119]
buffer_load_dwordx4 v[156:159], v14, s[44:47], s65 offen offset:0 sc1
v_mfma_f32_16x16x32_bf16 v[148:151], a[172:175], a[60:63], v[148:151]
ds_read_b64_tr_b16 a[206:207], v187 offset:12288
v_mfma_f32_16x16x32_bf16 v[148:151], a[168:171], a[56:59], v[148:151]
v_mfma_f32_16x16x32_bf16 v[120:123], a[176:179], a[56:59], v[120:123]
s_waitcnt lgkmcnt(4)
v_mfma_f32_16x16x32_bf16 v[120:123], a[180:183], a[60:63], v[120:123]
buffer_load_dwordx4 v[164:167], v14, s[44:47], s65 offen offset:1024 sc1
v_mfma_f32_16x16x32_bf16 v[88:91], a[180:183], a[52:55], v[88:91]
v_mfma_f32_16x16x32_bf16 v[88:91], a[176:179], a[48:51], v[88:91]
v_mfma_f32_16x16x32_bf16 v[56:59], a[176:179], a[40:43], v[56:59]
v_mfma_f32_16x16x32_bf16 v[56:59], a[180:183], a[44:47], v[56:59]
buffer_load_dwordx4 v[172:175], v15, s[44:47], s65 offen offset:0 sc1
v_mfma_f32_16x16x32_bf16 v[24:27], a[180:183], a[36:39], v[24:27]
v_mfma_f32_16x16x32_bf16 v[24:27], a[176:179], a[32:35], v[24:27]
v_mfma_f32_16x16x32_bf16 v[28:31], a[184:187], a[32:35], v[28:31]
v_mfma_f32_16x16x32_bf16 v[28:31], a[188:191], a[36:39], v[28:31]
buffer_load_dwordx4 v[180:183], v15, s[44:47], s65 offen offset:1024 sc1
v_mfma_f32_16x16x32_bf16 v[60:63], a[188:191], a[44:47], v[60:63]
v_mfma_f32_16x16x32_bf16 v[60:63], a[184:187], a[40:43], v[60:63]
s_waitcnt vmcnt(24)
s_barrier
v_mfma_f32_16x16x32_bf16 v[92:95], a[184:187], a[48:51], v[92:95]
s_xor_b32 m0, s76, 65536
ds_read_b64_tr_b16 a[144:145], v188 offset:32768
v_mfma_f32_16x16x32_bf16 v[92:95], a[188:191], a[52:55], v[92:95]
s_xor_b32 s64, s85, 524288
ds_read_b64_tr_b16 a[146:147], v188 offset:36864
v_mfma_f32_16x16x32_bf16 v[124:127], a[188:191], a[60:63], v[124:127]
buffer_load_dwordx4 v12, s[40:43], s64 offen lds
v_mfma_f32_16x16x32_bf16 v[124:127], a[184:187], a[56:59], v[124:127]
s_xor_b32 m0, s76, 66560
ds_read_b64_tr_b16 a[148:149], v188 offset:40960
v_mfma_f32_16x16x32_bf16 v[128:131], a[192:195], a[56:59], v[128:131]
s_xor_b32 s64, s85, 532480
ds_read_b64_tr_b16 a[150:151], v188 offset:45056
v_mfma_f32_16x16x32_bf16 v[128:131], a[196:199], a[60:63], v[128:131]
buffer_load_dwordx4 v13, s[40:43], s64 offen lds
v_mfma_f32_16x16x32_bf16 v[96:99], a[196:199], a[52:55], v[96:99]
ds_read_b64_tr_b16 a[152:153], v189 offset:32768
v_mfma_f32_16x16x32_bf16 v[96:99], a[192:195], a[48:51], v[96:99]
s_branch L_po24
L_pg24:
s_branch L_tr2
L_po24:
s_xor_b32 m0, s76, 67584
ds_read_b64_tr_b16 a[154:155], v189 offset:36864
v_mfma_f32_16x16x32_bf16 v[64:67], a[192:195], a[40:43], v[64:67]
s_xor_b32 s64, s85, 540672
ds_read_b64_tr_b16 a[156:157], v189 offset:40960
v_mfma_f32_16x16x32_bf16 v[64:67], a[196:199], a[44:47], v[64:67]
buffer_load_dwordx4 v12, s[40:43], s64 offen lds
v_mfma_f32_16x16x32_bf16 v[32:35], a[196:199], a[36:39], v[32:35]
ds_read_b64_tr_b16 a[158:159], v189 offset:45056
v_mfma_f32_16x16x32_bf16 v[32:35], a[192:195], a[32:35], v[32:35]
s_waitcnt lgkmcnt(5)
s_xor_b32 m0, s76, 68608
ds_read_b64_tr_b16 a[160:161], v190 offset:32768
v_mfma_f32_16x16x32_bf16 v[36:39], a[200:203], a[32:35], v[36:39]
s_xor_b32 s64, s85, 548864
ds_read_b64_tr_b16 a[162:163], v190 offset:36864
v_mfma_f32_16x16x32_bf16 v[36:39], a[204:207], a[36:39], v[36:39]
buffer_load_dwordx4 v13, s[40:43], s64 offen lds
v_mfma_f32_16x16x32_bf16 v[68:71], a[204:207], a[44:47], v[68:71]
ds_read_b64_tr_b16 a[164:165], v190 offset:40960
v_mfma_f32_16x16x32_bf16 v[68:71], a[200:203], a[40:43], v[68:71]
s_xor_b32 m0, s76, 69632
ds_read_b64_tr_b16 a[166:167], v190 offset:45056
v_mfma_f32_16x16x32_bf16 v[100:103], a[200:203], a[48:51], v[100:103]
s_xor_b32 s64, s85, 557056
v_mfma_f32_16x16x32_bf16 v[100:103], a[204:207], a[52:55], v[100:103]
buffer_load_dwordx4 v12, s[40:43], s64 offen lds
v_mfma_f32_16x16x32_bf16 v[132:135], a[204:207], a[60:63], v[132:135]
s_sub_u32 s73, 1, s73
s_sub_u32 s70, s70, 1
s_cmp_lg_u32 s70, 0
v_mfma_f32_16x16x32_bf16 v[132:135], a[200:203], a[56:59], v[132:135]
s_cbranch_scc1 L_p5loop
L_p5last:
s_waitcnt lgkmcnt(10)
s_waitcnt vmcnt(25)
v_mfma_f32_16x16x32_bf16 v[136:139], a[144:147], a[232:235], v[136:139]
s_waitcnt vmcnt(21)
s_waitcnt lgkmcnt(8)
s_xor_b32 m0, s76, 70656
s_xor_b32 s64, s85, 565248
ds_read_b64_tr_b16 a[168:169], v191 offset:32768
v_mfma_f32_16x16x32_bf16 v[136:139], a[148:151], a[236:239], v[136:139]
buffer_load_dwordx4 v13, s[40:43], s64 offen lds
v_mfma_f32_16x16x32_bf16 v[104:107], a[148:151], a[228:231], v[104:107]
ds_read_b64_tr_b16 a[170:171], v191 offset:36864
v_mfma_f32_16x16x32_bf16 v[104:107], a[144:147], a[224:227], v[104:107]
s_xor_b32 m0, s76, 71680
ds_read_b64_tr_b16 a[172:173], v191 offset:40960
v_mfma_f32_16x16x32_bf16 v[72:75], a[144:147], a[216:219], v[72:75]
s_xor_b32 s64, s85, 573440
ds_read_b64_tr_b16 a[174:175], v191 offset:45056
v_mfma_f32_16x16x32_bf16 v[72:75], a[148:151], a[220:223], v[72:75]
buffer_load_dwordx4 v12, s[40:43], s64 offen lds
v_mfma_f32_16x16x32_bf16 v[40:43], a[148:151], a[212:215], v[40:43]
ds_read_b64_tr_b16 a[176:177], v184 offset:32768
v_mfma_f32_16x16x32_bf16 v[40:43], a[144:147], a[208:211], v[40:43]
s_waitcnt lgkmcnt(5)
s_xor_b32 m0, s76, 72704
ds_read_b64_tr_b16 a[178:179], v184 offset:36864
v_mfma_f32_16x16x32_bf16 v[44:47], a[152:155], a[208:211], v[44:47]
s_xor_b32 s64, s85, 581632
ds_read_b64_tr_b16 a[180:181], v184 offset:40960
v_mfma_f32_16x16x32_bf16 v[44:47], a[156:159], a[212:215], v[44:47]
buffer_load_dwordx4 v13, s[40:43], s64 offen lds
v_mfma_f32_16x16x32_bf16 v[76:79], a[156:159], a[220:223], v[76:79]
ds_read_b64_tr_b16 a[182:183], v184 offset:45056
v_mfma_f32_16x16x32_bf16 v[76:79], a[152:155], a[216:219], v[76:79]
ds_read_b64_tr_b16 a[184:185], v185 offset:32768
v_mfma_f32_16x16x32_bf16 v[108:111], a[152:155], a[224:227], v[108:111]
s_xor_b32 s65, s84, 65536
ds_read_b64_tr_b16 a[186:187], v185 offset:36864
v_mfma_f32_16x16x32_bf16 v[108:111], a[156:159], a[228:231], v[108:111]
buffer_load_dwordx4 a[0:3], v14, s[44:47], s65 offen offset:0 sc1
v_mfma_f32_16x16x32_bf16 v[140:143], a[156:159], a[236:239], v[140:143]
ds_read_b64_tr_b16 a[188:189], v185 offset:40960
v_mfma_f32_16x16x32_bf16 v[140:143], a[152:155], a[232:235], v[140:143]
ds_read_b64_tr_b16 a[190:191], v185 offset:45056
v_mfma_f32_16x16x32_bf16 v[144:147], a[160:163], a[232:235], v[144:147]
v_mfma_f32_16x16x32_bf16 v[144:147], a[164:167], a[236:239], v[144:147]
buffer_load_dwordx4 a[8:11], v14, s[44:47], s65 offen offset:1024 sc1
v_mfma_f32_16x16x32_bf16 v[112:115], a[164:167], a[228:231], v[112:115]
ds_read_b64_tr_b16 a[192:193], v186 offset:32768
v_mfma_f32_16x16x32_bf16 v[112:115], a[160:163], a[224:227], v[112:115]
ds_read_b64_tr_b16 a[194:195], v186 offset:36864
v_mfma_f32_16x16x32_bf16 v[80:83], a[160:163], a[216:219], v[80:83]
ds_read_b64_tr_b16 a[196:197], v186 offset:40960
v_mfma_f32_16x16x32_bf16 v[80:83], a[164:167], a[220:223], v[80:83]
buffer_load_dwordx4 a[16:19], v15, s[44:47], s65 offen offset:0 sc1
v_mfma_f32_16x16x32_bf16 v[48:51], a[164:167], a[212:215], v[48:51]
ds_read_b64_tr_b16 a[198:199], v186 offset:45056
v_mfma_f32_16x16x32_bf16 v[48:51], a[160:163], a[208:211], v[48:51]
s_waitcnt lgkmcnt(4)
v_mfma_f32_16x16x32_bf16 v[52:55], a[168:171], a[208:211], v[52:55]
v_mfma_f32_16x16x32_bf16 v[52:55], a[172:175], a[212:215], v[52:55]
buffer_load_dwordx4 a[24:27], v15, s[44:47], s65 offen offset:1024 sc1
v_mfma_f32_16x16x32_bf16 v[84:87], a[172:175], a[220:223], v[84:87]
ds_read_b64_tr_b16 a[200:201], v187 offset:32768
v_mfma_f32_16x16x32_bf16 v[84:87], a[168:171], a[216:219], v[84:87]
ds_read_b64_tr_b16 a[202:203], v187 offset:36864
v_mfma_f32_16x16x32_bf16 v[116:119], a[168:171], a[224:227], v[116:119]
s_xor_b32 s65, s84, 73728
ds_read_b64_tr_b16 a[204:205], v187 offset:40960
v_mfma_f32_16x16x32_bf16 v[116:119], a[172:175], a[228:231], v[116:119]
buffer_load_dwordx4 a[4:7], v14, s[44:47], s65 offen offset:0 sc1
v_mfma_f32_16x16x32_bf16 v[148:151], a[172:175], a[236:239], v[148:151]
s_xor_b32 s66, s2, 1
s_lshl2_add_u32 s66, s66, s30
ds_read_b64_tr_b16 a[206:207], v187 offset:45056
v_mfma_f32_16x16x32_bf16 v[148:151], a[168:171], a[232:235], v[148:151]
s_lshl_b32 s73, s66, 12
s_add_u32 s73, s73, 67108864
s_lshl2_add_u32 s66, s2, s30
v_mfma_f32_16x16x32_bf16 v[120:123], a[176:179], a[232:235], v[120:123]
s_lshl_b32 s75, s66, 12
s_add_u32 s75, s75, 67108864
s_lshl_b32 s77, s82, 18
v_mfma_f32_16x16x32_bf16 v[120:123], a[180:183], a[236:239], v[120:123]
s_lshl_b32 s66, s30, 16
buffer_load_dwordx4 a[12:15], v14, s[44:47], s65 offen offset:1024 sc1
v_mfma_f32_16x16x32_bf16 v[88:91], a[180:183], a[228:231], v[88:91]
s_add_u32 s77, s77, s66
s_add_u32 s77, s77, s87
s_lshl_b32 s66, s83, 7
v_mfma_f32_16x16x32_bf16 v[88:91], a[176:179], a[224:227], v[88:91]
s_add_u32 s77, s77, s66
v_lshlrev_b32 v1, 24, v0
v_and_b32 v8, 7, v0
v_mfma_f32_16x16x32_bf16 v[56:59], a[176:179], a[216:219], v[56:59]
v_lshlrev_b32 v8, 11, v8
v_bfe_u32 v10, v0, 3, 1
v_mfma_f32_16x16x32_bf16 v[56:59], a[180:183], a[220:223], v[56:59]
buffer_load_dwordx4 a[20:23], v15, s[44:47], s65 offen offset:0 sc1
v_mfma_f32_16x16x32_bf16 v[24:27], a[180:183], a[212:215], v[24:27]
v_lshl_add_u32 v8, v10, 6, v8
v_bfe_u32 v10, v0, 4, 1
v_mfma_f32_16x16x32_bf16 v[24:27], a[176:179], a[208:211], v[24:27]
v_lshl_add_u32 v8, v10, 5, v8
v_lshrrev_b32 v10, 5, v0
v_mfma_f32_16x16x32_bf16 v[28:31], a[184:187], a[208:211], v[28:31]
v_lshl_add_u32 v8, v10, 4, v8
v_add_u32 v2, s86, v16
v_mfma_f32_16x16x32_bf16 v[28:31], a[188:191], a[212:215], v[28:31]
buffer_load_dwordx4 a[28:31], v15, s[44:47], s65 offen offset:1024 sc1
v_mfma_f32_16x16x32_bf16 v[60:63], a[188:191], a[220:223], v[60:63]
v_xor_b32 v3, 0x2000, v2
v_add_u32 v4, 0x20000, v2
v_mfma_f32_16x16x32_bf16 v[60:63], a[184:187], a[216:219], v[60:63]
s_waitcnt vmcnt(24)
s_barrier
v_mfma_f32_16x16x32_bf16 v[92:95], a[184:187], a[224:227], v[92:95]
s_xor_b32 m0, s76, 98304
ds_read_b64_tr_b16 a[144:145], v196 offset:0
v_add_u32 v5, 0x20000, v3
v_mfma_f32_16x16x32_bf16 v[92:95], a[188:191], a[228:231], v[92:95]
s_xor_b32 s64, s85, 786432
ds_read_b64_tr_b16 a[146:147], v196 offset:4096
v_mov_b32 v232, 0
v_mfma_f32_16x16x32_bf16 v[124:127], a[188:191], a[236:239], v[124:127]
buffer_load_dwordx4 v12, s[40:43], s64 offen lds
v_mfma_f32_16x16x32_bf16 v[124:127], a[184:187], a[232:235], v[124:127]
s_waitcnt lgkmcnt(2)
s_xor_b32 m0, s76, 99328
ds_read_b64_tr_b16 a[148:149], v196 offset:8192
v_mov_b32 v233, 0
v_mfma_f32_16x16x32_bf16 v[128:131], a[192:195], a[232:235], v[128:131]
s_xor_b32 s64, s85, 794624
ds_read_b64_tr_b16 a[150:151], v196 offset:12288
v_mov_b32 v236, 0
v_mfma_f32_16x16x32_bf16 v[128:131], a[196:199], a[236:239], v[128:131]
buffer_load_dwordx4 v13, s[40:43], s64 offen lds
v_mfma_f32_16x16x32_bf16 v[96:99], a[196:199], a[228:231], v[96:99]
ds_read_b64_tr_b16 a[152:153], v197 offset:0
v_mov_b32 v237, 0
v_mfma_f32_16x16x32_bf16 v[96:99], a[192:195], a[224:227], v[96:99]
s_xor_b32 m0, s76, 100352
ds_read_b64_tr_b16 a[154:155], v197 offset:4096
v_and_b32 v9, 1, v0
v_mfma_f32_16x16x32_bf16 v[64:67], a[192:195], a[216:219], v[64:67]
s_xor_b32 s64, s85, 802816
ds_read_b64_tr_b16 a[156:157], v197 offset:8192
v_lshlrev_b32 v9, 4, v9
v_mfma_f32_16x16x32_bf16 v[64:67], a[196:199], a[220:223], v[64:67]
buffer_load_dwordx4 v12, s[40:43], s64 offen lds
v_mfma_f32_16x16x32_bf16 v[32:35], a[196:199], a[212:215], v[32:35]
ds_read_b64_tr_b16 a[158:159], v197 offset:12288
v_mov_b32 v10, 0x3f80
v_mfma_f32_16x16x32_bf16 v[32:35], a[192:195], a[208:211], v[32:35]
s_xor_b32 m0, s76, 101376
ds_read_b64_tr_b16 a[160:161], v198 offset:0
v_lshlrev_b32 v9, v9, v10
v_mfma_f32_16x16x32_bf16 v[36:39], a[200:203], a[208:211], v[36:39]
s_xor_b32 s64, s85, 811008
ds_read_b64_tr_b16 a[162:163], v198 offset:4096
v_lshrrev_b32 v10, 4, v0
v_mfma_f32_16x16x32_bf16 v[36:39], a[204:207], a[212:215], v[36:39]
buffer_load_dwordx4 v13, s[40:43], s64 offen lds
v_mfma_f32_16x16x32_bf16 v[68:71], a[204:207], a[220:223], v[68:71]
ds_read_b64_tr_b16 a[164:165], v198 offset:8192
v_lshlrev_b32 v10, 1, v10
v_mfma_f32_16x16x32_bf16 v[68:71], a[200:203], a[216:219], v[68:71]
s_xor_b32 m0, s76, 102400
ds_read_b64_tr_b16 a[166:167], v198 offset:12288
v_bfe_u32 v11, v0, 1, 3
v_mfma_f32_16x16x32_bf16 v[100:103], a[200:203], a[224:227], v[100:103]
s_xor_b32 s64, s85, 819200
v_xor_b32 v10, v10, v11
v_subrev_u32 v11, 1, v10
v_mfma_f32_16x16x32_bf16 v[100:103], a[204:207], a[228:231], v[100:103]
buffer_load_dwordx4 v12, s[40:43], s64 offen lds
v_mfma_f32_16x16x32_bf16 v[132:135], a[204:207], a[236:239], v[132:135]
v_ashrrev_i32 v11, 31, v11
v_and_b32 v234, v11, v9
v_mfma_f32_16x16x32_bf16 v[132:135], a[200:203], a[232:235], v[132:135]
s_waitcnt vmcnt(25)
s_waitcnt lgkmcnt(3)
s_xor_b32 m0, s76, 103424
v_xor_b32 v10, 1, v10
v_subrev_u32 v11, 1, v10
v_mfma_f32_16x16x32_bf16 v[136:139], a[144:147], v[176:179], v[136:139]
s_waitcnt vmcnt(21)
s_xor_b32 s64, s85, 827392
ds_read_b64_tr_b16 a[168:169], v199 offset:0
v_ashrrev_i32 v11, 31, v11
v_mfma_f32_16x16x32_bf16 v[136:139], a[148:151], v[180:183], v[136:139]
buffer_load_dwordx4 v13, s[40:43], s64 offen lds
v_mfma_f32_16x16x32_bf16 v[104:107], a[148:151], v[172:175], v[104:107]
ds_read_b64_tr_b16 a[170:171], v199 offset:4096
v_and_b32 v235, v11, v9
v_mfma_f32_16x16x32_bf16 v[104:107], a[144:147], v[168:171], v[104:107]
s_mov_b32 s48, s24
s_mov_b32 s49, s25
s_xor_b32 m0, s76, 104448
ds_read_b64_tr_b16 a[172:173], v199 offset:8192
v_mfma_f32_16x16x32_bf16 v[72:75], a[144:147], v[160:163], v[72:75]
s_mov_b32 s50, 4194304
s_mov_b32 s51, 0x20000
s_xor_b32 s64, s85, 835584
ds_read_b64_tr_b16 a[174:175], v199 offset:12288
v_mfma_f32_16x16x32_bf16 v[72:75], a[148:151], v[164:167], v[72:75]
buffer_load_dwordx4 v12, s[40:43], s64 offen lds
v_mfma_f32_16x16x32_bf16 v[40:43], a[148:151], v[156:159], v[40:43]
s_waitcnt vmcnt(15)
s_barrier
s_xor_b32 m0, s76, 105472
s_xor_b32 s64, s85, 843776
v_mfma_f32_16x16x32_bf16 v[40:43], a[144:147], v[152:155], v[40:43]
buffer_load_dwordx4 v13, s[40:43], s64 offen lds
v_mfma_f32_16x16x32_bf16 v[44:47], a[152:155], v[152:155], v[44:47]
ds_read_b64_tr_b16 a[176:177], v196 offset:32768
v_mfma_f32_16x16x32_bf16 v[44:47], a[156:159], v[156:159], v[44:47]
s_xor_b32 s65, s84, 98304
ds_read_b64_tr_b16 a[178:179], v196 offset:36864
v_mfma_f32_16x16x32_bf16 v[76:79], a[156:159], v[164:167], v[76:79]
buffer_load_dwordx4 a[32:35], v14, s[44:47], s65 offen offset:0 sc1
v_mfma_f32_16x16x32_bf16 v[76:79], a[152:155], v[160:163], v[76:79]
ds_read_b64_tr_b16 a[180:181], v196 offset:40960
v_mfma_f32_16x16x32_bf16 v[108:111], a[152:155], v[168:171], v[108:111]
ds_read_b64_tr_b16 a[182:183], v196 offset:45056
v_mfma_f32_16x16x32_bf16 v[108:111], a[156:159], v[172:175], v[108:111]
buffer_load_dwordx4 a[40:43], v14, s[44:47], s65 offen offset:1024 sc1
v_mfma_f32_16x16x32_bf16 v[140:143], a[156:159], v[180:183], v[140:143]
ds_read_b64_tr_b16 a[184:185], v197 offset:32768
v_mfma_f32_16x16x32_bf16 v[140:143], a[152:155], v[176:179], v[140:143]
s_waitcnt lgkmcnt(5)
ds_read_b64_tr_b16 a[186:187], v197 offset:36864
v_mfma_f32_16x16x32_bf16 v[144:147], a[160:163], v[176:179], v[144:147]
buffer_load_dwordx4 a[48:51], v15, s[44:47], s65 offen offset:0 sc1
v_mfma_f32_16x16x32_bf16 v[144:147], a[164:167], v[180:183], v[144:147]
ds_read_b64_tr_b16 a[188:189], v197 offset:40960
v_mfma_f32_16x16x32_bf16 v[112:115], a[164:167], v[172:175], v[112:115]
ds_read_b64_tr_b16 a[190:191], v197 offset:45056
v_mfma_f32_16x16x32_bf16 v[112:115], a[160:163], v[168:171], v[112:115]
ds_read_b64_tr_b16 a[192:193], v198 offset:32768
v_mfma_f32_16x16x32_bf16 v[80:83], a[160:163], v[160:163], v[80:83]
buffer_load_dwordx4 a[56:59], v15, s[44:47], s65 offen offset:1024 sc1
v_mfma_f32_16x16x32_bf16 v[80:83], a[164:167], v[164:167], v[80:83]
ds_read_b64_tr_b16 a[194:195], v198 offset:36864
v_mfma_f32_16x16x32_bf16 v[48:51], a[164:167], v[156:159], v[48:51]
s_xor_b32 s65, s84, 106496
ds_read_b64_tr_b16 a[196:197], v198 offset:40960
v_mfma_f32_16x16x32_bf16 v[48:51], a[160:163], v[152:155], v[48:51]
buffer_load_dwordx4 a[36:39], v14, s[44:47], s65 offen offset:0 sc1
v_mfma_f32_16x16x32_bf16 v[52:55], a[168:171], v[152:155], v[52:55]
ds_read_b64_tr_b16 a[198:199], v198 offset:45056
v_mfma_f32_16x16x32_bf16 v[52:55], a[172:175], v[156:159], v[52:55]
v_mfma_f32_16x16x32_bf16 v[84:87], a[172:175], v[164:167], v[84:87]
buffer_load_dwordx4 a[44:47], v14, s[44:47], s65 offen offset:1024 sc1
v_mfma_f32_16x16x32_bf16 v[84:87], a[168:171], v[160:163], v[84:87]
ds_read_b64_tr_b16 a[200:201], v199 offset:32768
v_mfma_f32_16x16x32_bf16 v[116:119], a[168:171], v[168:171], v[116:119]
ds_read_b64_tr_b16 a[202:203], v199 offset:36864
v_mfma_f32_16x16x32_bf16 v[116:119], a[172:175], v[172:175], v[116:119]
buffer_load_dwordx4 a[52:55], v15, s[44:47], s65 offen offset:0 sc1
v_mfma_f32_16x16x32_bf16 v[148:151], a[172:175], v[180:183], v[148:151]
ds_read_b64_tr_b16 a[204:205], v199 offset:40960
v_mfma_f32_16x16x32_bf16 v[148:151], a[168:171], v[176:179], v[148:151]
s_waitcnt vmcnt(19)
s_waitcnt lgkmcnt(4)
ds_read_b64_tr_b16 a[206:207], v199 offset:45056
v_mfma_f32_16x16x32_bf16 v[136:139], a[176:179], a[24:27], v[136:139]
s_waitcnt vmcnt(15)
buffer_load_dwordx4 a[60:63], v15, s[44:47], s65 offen offset:1024 sc1
v_mfma_f32_16x16x32_bf16 v[136:139], a[180:183], a[28:31], v[136:139]
v_mfma_f32_16x16x32_bf16 v[104:107], a[180:183], a[20:23], v[104:107]
v_mfma_f32_16x16x32_bf16 v[104:107], a[176:179], a[16:19], v[104:107]
v_mfma_f32_16x16x32_bf16 v[72:75], a[176:179], a[8:11], v[72:75]
v_mfma_f32_16x16x32_bf16 v[72:75], a[180:183], a[12:15], v[72:75]
v_mfma_f32_16x16x32_bf16 v[40:43], a[180:183], a[4:7], v[40:43]
s_waitcnt vmcnt(8)
s_barrier
v_mfma_f32_16x16x32_bf16 v[40:43], a[176:179], a[0:3], v[40:43]
ds_read_b64_tr_b16 a[144:145], v188 offset:0
v_mfma_f32_16x16x32_bf16 v[44:47], a[184:187], a[0:3], v[44:47]
ds_read_b64_tr_b16 a[146:147], v188 offset:4096
v_mfma_f32_16x16x32_bf16 v[44:47], a[188:191], a[4:7], v[44:47]
ds_read_b64_tr_b16 a[148:149], v188 offset:8192
v_mfma_f32_16x16x32_bf16 v[76:79], a[188:191], a[12:15], v[76:79]
ds_read_b64_tr_b16 a[150:151], v188 offset:12288
v_mfma_f32_16x16x32_bf16 v[76:79], a[184:187], a[8:11], v[76:79]
ds_read_b64_tr_b16 a[152:153], v189 offset:0
v_mfma_f32_16x16x32_bf16 v[108:111], a[184:187], a[16:19], v[108:111]
ds_read_b64_tr_b16 a[154:155], v189 offset:4096
v_mfma_f32_16x16x32_bf16 v[108:111], a[188:191], a[20:23], v[108:111]
ds_read_b64_tr_b16 a[156:157], v189 offset:8192
v_mfma_f32_16x16x32_bf16 v[140:143], a[188:191], a[28:31], v[140:143]
ds_read_b64_tr_b16 a[158:159], v189 offset:12288
v_mfma_f32_16x16x32_bf16 v[140:143], a[184:187], a[24:27], v[140:143]
ds_read_b64_tr_b16 a[160:161], v190 offset:0
v_mfma_f32_16x16x32_bf16 v[144:147], a[192:195], a[24:27], v[144:147]
s_waitcnt lgkmcnt(7)
ds_read_b64_tr_b16 a[162:163], v190 offset:4096
v_mfma_f32_16x16x32_bf16 v[144:147], a[196:199], a[28:31], v[144:147]
ds_read_b64_tr_b16 a[164:165], v190 offset:8192
v_mfma_f32_16x16x32_bf16 v[112:115], a[196:199], a[20:23], v[112:115]
ds_read_b64_tr_b16 a[166:167], v190 offset:12288
v_mfma_f32_16x16x32_bf16 v[112:115], a[192:195], a[16:19], v[112:115]
ds_read_b64_tr_b16 a[168:169], v191 offset:0
v_mfma_f32_16x16x32_bf16 v[80:83], a[192:195], a[8:11], v[80:83]
ds_read_b64_tr_b16 a[170:171], v191 offset:4096
v_mfma_f32_16x16x32_bf16 v[80:83], a[196:199], a[12:15], v[80:83]
ds_read_b64_tr_b16 a[172:173], v191 offset:8192
v_mfma_f32_16x16x32_bf16 v[48:51], a[196:199], a[4:7], v[48:51]
ds_read_b64_tr_b16 a[174:175], v191 offset:12288
v_mfma_f32_16x16x32_bf16 v[48:51], a[192:195], a[0:3], v[48:51]
v_mfma_f32_16x16x32_bf16 v[52:55], a[200:203], a[0:3], v[52:55]
v_mfma_f32_16x16x32_bf16 v[52:55], a[204:207], a[4:7], v[52:55]
v_mfma_f32_16x16x32_bf16 v[84:87], a[204:207], a[12:15], v[84:87]
v_mfma_f32_16x16x32_bf16 v[84:87], a[200:203], a[8:11], v[84:87]
v_mfma_f32_16x16x32_bf16 v[116:119], a[200:203], a[16:19], v[116:119]
v_mfma_f32_16x16x32_bf16 v[116:119], a[204:207], a[20:23], v[116:119]
v_mfma_f32_16x16x32_bf16 v[148:151], a[204:207], a[28:31], v[148:151]
v_mfma_f32_16x16x32_bf16 v[148:151], a[200:203], a[24:27], v[148:151]
s_waitcnt vmcnt(5)
v_mfma_f32_16x16x32_bf16 v[104:107], a[144:147], a[48:51], v[104:107]
s_waitcnt vmcnt(1)
s_waitcnt lgkmcnt(0)
v_mfma_f32_16x16x32_bf16 v[104:107], a[148:151], a[52:55], v[104:107]
v_mfma_f32_16x16x32_bf16 v[108:111], a[156:159], a[52:55], v[108:111]
ds_read_b64_tr_b16 a[176:177], v192 offset:0
v_mfma_f32_16x16x32_bf16 v[108:111], a[152:155], a[48:51], v[108:111]
ds_read_b64_tr_b16 a[178:179], v192 offset:4096
v_mfma_f32_16x16x32_bf16 v[112:115], a[160:163], a[48:51], v[112:115]
ds_read_b64_tr_b16 a[180:181], v192 offset:8192
v_mfma_f32_16x16x32_bf16 v[112:115], a[164:167], a[52:55], v[112:115]
ds_read_b64_tr_b16 a[182:183], v192 offset:12288
v_mfma_f32_16x16x32_bf16 v[116:119], a[172:175], a[52:55], v[116:119]
v_mfma_f32_16x16x32_bf16 v[116:119], a[168:171], a[48:51], v[116:119]
v_mfma_f32_16x16x32_bf16 v[148:151], a[168:171], a[56:59], v[148:151]
s_waitcnt vmcnt(0)
v_mfma_f32_16x16x32_bf16 v[148:151], a[172:175], a[60:63], v[148:151]
ds_write_b128 v3, v[104:107] offset:0
v_mfma_f32_16x16x32_bf16 v[144:147], a[164:167], a[60:63], v[144:147]
ds_read_b64_tr_b16 a[184:185], v193 offset:0
v_mfma_f32_16x16x32_bf16 v[144:147], a[160:163], a[56:59], v[144:147]
ds_write_b128 v3, v[108:111] offset:1024
v_mfma_f32_16x16x32_bf16 v[140:143], a[152:155], a[56:59], v[140:143]
ds_read_b64_tr_b16 a[186:187], v193 offset:4096
v_mfma_f32_16x16x32_bf16 v[140:143], a[156:159], a[60:63], v[140:143]
ds_write_b128 v3, v[112:115] offset:2048
v_mfma_f32_16x16x32_bf16 v[136:139], a[148:151], a[60:63], v[136:139]
ds_read_b64_tr_b16 a[188:189], v193 offset:8192
v_mfma_f32_16x16x32_bf16 v[136:139], a[144:147], a[56:59], v[136:139]
ds_write_b128 v3, v[116:119] offset:3072
v_mfma_f32_16x16x32_bf16 v[40:43], a[144:147], a[32:35], v[40:43]
ds_read_b64_tr_b16 a[190:191], v193 offset:12288
v_mfma_f32_16x16x32_bf16 v[40:43], a[148:151], a[36:39], v[40:43]
ds_write_b128 v3, v[148:151] offset:7168
v_mfma_f32_16x16x32_bf16 v[44:47], a[156:159], a[36:39], v[44:47]
ds_read_b64_tr_b16 a[192:193], v194 offset:0
v_mfma_f32_16x16x32_bf16 v[44:47], a[152:155], a[32:35], v[44:47]
ds_write_b128 v3, v[144:147] offset:6144
v_mfma_f32_16x16x32_bf16 v[48:51], a[160:163], a[32:35], v[48:51]
ds_read_b64_tr_b16 a[194:195], v194 offset:4096
v_mfma_f32_16x16x32_bf16 v[48:51], a[164:167], a[36:39], v[48:51]
ds_write_b128 v3, v[140:143] offset:5120
v_mfma_f32_16x16x32_bf16 v[52:55], a[172:175], a[36:39], v[52:55]
ds_read_b64_tr_b16 a[196:197], v194 offset:8192
v_mfma_f32_16x16x32_bf16 v[52:55], a[168:171], a[32:35], v[52:55]
ds_write_b128 v3, v[136:139] offset:4096
v_mfma_f32_16x16x32_bf16 v[84:87], a[168:171], a[40:43], v[84:87]
ds_read_b64_tr_b16 a[198:199], v194 offset:12288
v_mfma_f32_16x16x32_bf16 v[84:87], a[172:175], a[44:47], v[84:87]
v_mfma_f32_16x16x32_bf16 v[80:83], a[164:167], a[44:47], v[80:83]
s_waitcnt lgkmcnt(0)
s_barrier
v_mfma_f32_16x16x32_bf16 v[80:83], a[160:163], a[40:43], v[80:83]
ds_read_b128 v[200:203], v2 offset:0
ds_read_b128 v[204:207], v2 offset:1024
v_mfma_f32_16x16x32_bf16 v[76:79], a[152:155], a[40:43], v[76:79]
ds_read_b128 v[208:211], v2 offset:2048
ds_read_b128 v[212:215], v2 offset:3072
v_mfma_f32_16x16x32_bf16 v[76:79], a[156:159], a[44:47], v[76:79]
ds_read_b128 v[216:219], v2 offset:4096
ds_read_b128 v[220:223], v2 offset:5120
v_mfma_f32_16x16x32_bf16 v[72:75], a[148:151], a[44:47], v[72:75]
ds_read_b128 v[224:227], v2 offset:6144
ds_read_b128 v[228:231], v2 offset:7168
v_mfma_f32_16x16x32_bf16 v[72:75], a[144:147], a[40:43], v[72:75]
ds_read_b64_tr_b16 a[200:201], v195 offset:0
v_mfma_f32_16x16x32_bf16 v[120:123], a[176:179], v[176:179], v[120:123]
ds_read_b64_tr_b16 a[202:203], v195 offset:4096
v_mfma_f32_16x16x32_bf16 v[120:123], a[180:183], v[180:183], v[120:123]
ds_read_b64_tr_b16 a[204:205], v195 offset:8192
v_mfma_f32_16x16x32_bf16 v[88:91], a[180:183], v[172:175], v[88:91]
s_waitcnt lgkmcnt(10)
ds_read_b64_tr_b16 a[206:207], v195 offset:12288
v_add_f32 v200, v200, v40
v_mfma_f32_16x16x32_bf16 v[88:91], a[176:179], v[168:171], v[88:91]
ds_read_b64_tr_b16 a[144:145], v192 offset:32768
v_add_f32 v201, v201, v41
v_mfma_f32_16x16x32_bf16 v[56:59], a[176:179], v[160:163], v[56:59]
ds_read_b64_tr_b16 a[146:147], v192 offset:36864
v_add_f32 v202, v202, v42
v_mfma_f32_16x16x32_bf16 v[56:59], a[180:183], v[164:167], v[56:59]
s_waitcnt lgkmcnt(8)
ds_read_b64_tr_b16 a[148:149], v192 offset:40960
v_add_f32 v203, v203, v43
v_add_f32 v204, v204, v44
v_add_f32 v205, v205, v45
v_add_f32 v206, v206, v46
v_add_f32 v207, v207, v47
v_cvt_pk_bf16_f32 v200, v200, v201
v_cvt_pk_bf16_f32 v201, v202, v203
v_cvt_pk_bf16_f32 v202, v204, v205
v_cvt_pk_bf16_f32 v203, v206, v207
v_mfma_f32_16x16x32_bf16 v[24:27], a[180:183], v[156:159], v[24:27]
buffer_store_dwordx4 v[200:203], v16, s[44:47], s73 offen offset:0 sc1
v_mfma_f32_16x16x32_bf16 v[24:27], a[176:179], v[152:155], v[24:27]
ds_read_b64_tr_b16 a[150:151], v192 offset:45056
v_add_f32 v208, v208, v48
v_mfma_f32_16x16x32_bf16 v[28:31], a[184:187], v[152:155], v[28:31]
v_add_f32 v209, v209, v49
v_add_f32 v210, v210, v50
v_mfma_f32_16x16x32_bf16 v[28:31], a[188:191], v[156:159], v[28:31]
v_add_f32 v211, v211, v51
v_add_f32 v212, v212, v52
v_add_f32 v213, v213, v53
v_add_f32 v214, v214, v54
v_add_f32 v215, v215, v55
v_cvt_pk_bf16_f32 v208, v208, v209
v_cvt_pk_bf16_f32 v209, v210, v211
v_cvt_pk_bf16_f32 v210, v212, v213
v_cvt_pk_bf16_f32 v211, v214, v215
v_mfma_f32_16x16x32_bf16 v[60:63], a[188:191], v[164:167], v[60:63]
buffer_store_dwordx4 v[208:211], v16, s[44:47], s73 offen offset:1024 sc1
v_mfma_f32_16x16x32_bf16 v[60:63], a[184:187], v[160:163], v[60:63]
ds_read_b64_tr_b16 a[152:153], v193 offset:32768
v_add_f32 v216, v216, v72
v_mfma_f32_16x16x32_bf16 v[92:95], a[184:187], v[168:171], v[92:95]
ds_read_b64_tr_b16 a[154:155], v193 offset:36864
v_add_f32 v217, v217, v73
v_mfma_f32_16x16x32_bf16 v[92:95], a[188:191], v[172:175], v[92:95]
ds_read_b64_tr_b16 a[156:157], v193 offset:40960
v_add_f32 v218, v218, v74
v_add_f32 v219, v219, v75
v_add_f32 v220, v220, v76
v_add_f32 v221, v221, v77
v_add_f32 v222, v222, v78
v_add_f32 v223, v223, v79
v_cvt_pk_bf16_f32 v216, v216, v217
v_cvt_pk_bf16_f32 v217, v218, v219
v_cvt_pk_bf16_f32 v218, v220, v221
v_cvt_pk_bf16_f32 v219, v222, v223
v_mfma_f32_16x16x32_bf16 v[124:127], a[188:191], v[180:183], v[124:127]
buffer_store_dwordx4 v[216:219], v16, s[44:47], s73 offen offset:2048 sc1
v_mfma_f32_16x16x32_bf16 v[124:127], a[184:187], v[176:179], v[124:127]
s_waitcnt lgkmcnt(3)
ds_read_b64_tr_b16 a[158:159], v193 offset:45056
v_add_f32 v224, v224, v80
v_mfma_f32_16x16x32_bf16 v[128:131], a[192:195], v[176:179], v[128:131]
v_add_f32 v225, v225, v81
v_add_f32 v226, v226, v82
v_mfma_f32_16x16x32_bf16 v[128:131], a[196:199], v[180:183], v[128:131]
v_add_f32 v227, v227, v83
v_add_f32 v228, v228, v84
v_add_f32 v229, v229, v85
v_add_f32 v230, v230, v86
v_add_f32 v231, v231, v87
v_cvt_pk_bf16_f32 v224, v224, v225
v_cvt_pk_bf16_f32 v225, v226, v227
v_cvt_pk_bf16_f32 v226, v228, v229
v_cvt_pk_bf16_f32 v227, v230, v231
v_mfma_f32_16x16x32_bf16 v[96:99], a[196:199], v[172:175], v[96:99]
buffer_store_dwordx4 v[224:227], v16, s[44:47], s73 offen offset:3072 sc1
v_mfma_f32_16x16x32_bf16 v[96:99], a[192:195], v[168:171], v[96:99]
ds_read_b64_tr_b16 a[160:161], v194 offset:32768
v_mfma_f32_16x16x32_bf16 v[64:67], a[192:195], v[160:163], v[64:67]
ds_read_b64_tr_b16 a[162:163], v194 offset:36864
v_mfma_f32_16x16x32_bf16 v[64:67], a[196:199], v[164:167], v[64:67]
ds_read_b64_tr_b16 a[164:165], v194 offset:40960
v_mfma_f32_16x16x32_bf16 v[32:35], a[196:199], v[156:159], v[32:35]
ds_read_b64_tr_b16 a[166:167], v194 offset:45056
v_mfma_f32_16x16x32_bf16 v[32:35], a[192:195], v[152:155], v[32:35]
v_mfma_f32_16x16x32_bf16 v[36:39], a[200:203], v[152:155], v[36:39]
v_mfma_f32_16x16x32_bf16 v[36:39], a[204:207], v[156:159], v[36:39]
v_mfma_f32_16x16x32_bf16 v[68:71], a[204:207], v[164:167], v[68:71]
ds_read_b64_tr_b16 a[168:169], v195 offset:32768
v_mfma_f32_16x16x32_bf16 v[68:71], a[200:203], v[160:163], v[68:71]
ds_read_b64_tr_b16 a[170:171], v195 offset:36864
v_mfma_f32_16x16x32_bf16 v[100:103], a[200:203], v[168:171], v[100:103]
ds_read_b64_tr_b16 a[172:173], v195 offset:40960
v_mfma_f32_16x16x32_bf16 v[100:103], a[204:207], v[172:175], v[100:103]
ds_read_b64_tr_b16 a[174:175], v195 offset:45056
v_mfma_f32_16x16x32_bf16 v[132:135], a[204:207], v[180:183], v[132:135]
v_mfma_f32_16x16x32_bf16 v[132:135], a[200:203], v[176:179], v[132:135]
v_mfma_f32_16x16x32_bf16 v[120:123], a[144:147], a[24:27], v[120:123]
v_mfma_f32_16x16x32_bf16 v[120:123], a[148:151], a[28:31], v[120:123]
v_mfma_f32_16x16x32_bf16 v[88:91], a[148:151], a[20:23], v[88:91]
ds_read_b64_tr_b16 a[176:177], v184 offset:0
v_mfma_f32_16x16x32_bf16 v[88:91], a[144:147], a[16:19], v[88:91]
ds_read_b64_tr_b16 a[178:179], v184 offset:4096
v_mfma_f32_16x16x32_bf16 v[56:59], a[144:147], a[8:11], v[56:59]
ds_read_b64_tr_b16 a[180:181], v184 offset:8192
v_mfma_f32_16x16x32_bf16 v[56:59], a[148:151], a[12:15], v[56:59]
ds_read_b64_tr_b16 a[182:183], v184 offset:12288
v_mfma_f32_16x16x32_bf16 v[24:27], a[148:151], a[4:7], v[24:27]
ds_read_b64_tr_b16 a[184:185], v185 offset:0
v_mfma_f32_16x16x32_bf16 v[24:27], a[144:147], a[0:3], v[24:27]
s_waitcnt lgkmcnt(5)
ds_read_b64_tr_b16 a[186:187], v185 offset:4096
v_mfma_f32_16x16x32_bf16 v[28:31], a[152:155], a[0:3], v[28:31]
ds_read_b64_tr_b16 a[188:189], v185 offset:8192
v_mfma_f32_16x16x32_bf16 v[28:31], a[156:159], a[4:7], v[28:31]
ds_read_b64_tr_b16 a[190:191], v185 offset:12288
v_mfma_f32_16x16x32_bf16 v[60:63], a[156:159], a[12:15], v[60:63]
ds_read_b64_tr_b16 a[192:193], v186 offset:0
v_mfma_f32_16x16x32_bf16 v[60:63], a[152:155], a[8:11], v[60:63]
ds_read_b64_tr_b16 a[194:195], v186 offset:4096
v_mfma_f32_16x16x32_bf16 v[92:95], a[152:155], a[16:19], v[92:95]
ds_read_b64_tr_b16 a[196:197], v186 offset:8192
v_mfma_f32_16x16x32_bf16 v[92:95], a[156:159], a[20:23], v[92:95]
ds_read_b64_tr_b16 a[198:199], v186 offset:12288
v_mfma_f32_16x16x32_bf16 v[124:127], a[156:159], a[28:31], v[124:127]
ds_read_b64_tr_b16 a[200:201], v187 offset:0
v_mfma_f32_16x16x32_bf16 v[124:127], a[152:155], a[24:27], v[124:127]
ds_read_b64_tr_b16 a[202:203], v187 offset:4096
v_mfma_f32_16x16x32_bf16 v[128:131], a[160:163], a[24:27], v[128:131]
ds_read_b64_tr_b16 a[204:205], v187 offset:8192
v_mfma_f32_16x16x32_bf16 v[128:131], a[164:167], a[28:31], v[128:131]
ds_read_b64_tr_b16 a[206:207], v187 offset:12288
v_mfma_f32_16x16x32_bf16 v[96:99], a[164:167], a[20:23], v[96:99]
s_branch L_po25
L_pg25:
s_branch L_tr2
L_po25:
v_mfma_f32_16x16x32_bf16 v[96:99], a[160:163], a[16:19], v[96:99]
v_mfma_f32_16x16x32_bf16 v[64:67], a[160:163], a[8:11], v[64:67]
v_mfma_f32_16x16x32_bf16 v[64:67], a[164:167], a[12:15], v[64:67]
v_mfma_f32_16x16x32_bf16 v[32:35], a[164:167], a[4:7], v[32:35]
v_mfma_f32_16x16x32_bf16 v[32:35], a[160:163], a[0:3], v[32:35]
v_mfma_f32_16x16x32_bf16 v[36:39], a[168:171], a[0:3], v[36:39]
v_mfma_f32_16x16x32_bf16 v[36:39], a[172:175], a[4:7], v[36:39]
v_mfma_f32_16x16x32_bf16 v[68:71], a[172:175], a[12:15], v[68:71]
v_mfma_f32_16x16x32_bf16 v[68:71], a[168:171], a[8:11], v[68:71]
v_mfma_f32_16x16x32_bf16 v[100:103], a[168:171], a[16:19], v[100:103]
v_mfma_f32_16x16x32_bf16 v[100:103], a[172:175], a[20:23], v[100:103]
v_mfma_f32_16x16x32_bf16 v[132:135], a[172:175], a[28:31], v[132:135]
v_mfma_f32_16x16x32_bf16 v[132:135], a[168:171], a[24:27], v[132:135]
s_waitcnt lgkmcnt(0)
v_mfma_f32_16x16x32_bf16 v[88:91], a[176:179], a[48:51], v[88:91]
v_mfma_f32_16x16x32_bf16 v[88:91], a[180:183], a[52:55], v[88:91]
v_mfma_f32_16x16x32_bf16 v[92:95], a[188:191], a[52:55], v[92:95]
buffer_load_dwordx4 v[152:155], v16, s[44:47], s75 offen offset:0 sc1
v_mfma_f32_16x16x32_bf16 v[92:95], a[184:187], a[48:51], v[92:95]
v_mfma_f32_16x16x32_bf16 v[96:99], a[192:195], a[48:51], v[96:99]
buffer_load_dwordx4 v[156:159], v16, s[44:47], s75 offen offset:1024 sc1
v_mfma_f32_16x16x32_bf16 v[96:99], a[196:199], a[52:55], v[96:99]
v_mfma_f32_16x16x32_bf16 v[100:103], a[204:207], a[52:55], v[100:103]
buffer_load_dwordx4 v[160:163], v16, s[44:47], s75 offen offset:2048 sc1
v_mfma_f32_16x16x32_bf16 v[100:103], a[200:203], a[48:51], v[100:103]
v_mfma_f32_16x16x32_bf16 v[132:135], a[200:203], a[56:59], v[132:135]
buffer_load_dwordx4 v[164:167], v16, s[44:47], s75 offen offset:3072 sc1
v_mfma_f32_16x16x32_bf16 v[132:135], a[204:207], a[60:63], v[132:135]
ds_write_b128 v5, v[88:91] offset:0
v_mfma_f32_16x16x32_bf16 v[128:131], a[196:199], a[60:63], v[128:131]
v_mfma_f32_16x16x32_bf16 v[128:131], a[192:195], a[56:59], v[128:131]
ds_write_b128 v5, v[92:95] offset:1024
v_mfma_f32_16x16x32_bf16 v[124:127], a[184:187], a[56:59], v[124:127]
v_mfma_f32_16x16x32_bf16 v[124:127], a[188:191], a[60:63], v[124:127]
ds_write_b128 v5, v[96:99] offset:2048
v_mfma_f32_16x16x32_bf16 v[120:123], a[180:183], a[60:63], v[120:123]
v_mfma_f32_16x16x32_bf16 v[120:123], a[176:179], a[56:59], v[120:123]
ds_write_b128 v5, v[100:103] offset:3072
v_mfma_f32_16x16x32_bf16 v[24:27], a[176:179], a[32:35], v[24:27]
v_mfma_f32_16x16x32_bf16 v[24:27], a[180:183], a[36:39], v[24:27]
ds_write_b128 v5, v[132:135] offset:7168
v_mfma_f32_16x16x32_bf16 v[28:31], a[188:191], a[36:39], v[28:31]
v_mfma_f32_16x16x32_bf16 v[28:31], a[184:187], a[32:35], v[28:31]
ds_write_b128 v5, v[128:131] offset:6144
v_mfma_f32_16x16x32_bf16 v[32:35], a[192:195], a[32:35], v[32:35]
v_mfma_f32_16x16x32_bf16 v[32:35], a[196:199], a[36:39], v[32:35]
ds_write_b128 v5, v[124:127] offset:5120
v_mfma_f32_16x16x32_bf16 v[36:39], a[204:207], a[36:39], v[36:39]
v_mfma_f32_16x16x32_bf16 v[36:39], a[200:203], a[32:35], v[36:39]
ds_write_b128 v5, v[120:123] offset:4096
v_mfma_f32_16x16x32_bf16 v[68:71], a[200:203], a[40:43], v[68:71]
v_mfma_f32_16x16x32_bf16 v[68:71], a[204:207], a[44:47], v[68:71]
v_mfma_f32_16x16x32_bf16 v[64:67], a[196:199], a[44:47], v[64:67]
v_mfma_f32_16x16x32_bf16 v[64:67], a[192:195], a[40:43], v[64:67]
s_waitcnt lgkmcnt(0)
s_barrier
v_mfma_f32_16x16x32_bf16 v[60:63], a[184:187], a[40:43], v[60:63]
ds_read_b128 v[200:203], v4 offset:0
ds_read_b128 v[204:207], v4 offset:1024
v_mfma_f32_16x16x32_bf16 v[60:63], a[188:191], a[44:47], v[60:63]
ds_read_b128 v[208:211], v4 offset:2048
ds_read_b128 v[212:215], v4 offset:3072
v_mfma_f32_16x16x32_bf16 v[56:59], a[180:183], a[44:47], v[56:59]
ds_read_b128 v[216:219], v4 offset:4096
ds_read_b128 v[220:223], v4 offset:5120
v_mfma_f32_16x16x32_bf16 v[56:59], a[176:179], a[40:43], v[56:59]
ds_read_b128 v[224:227], v4 offset:6144
ds_read_b128 v[228:231], v4 offset:7168
s_mov_b32 s72, 0x20000
s_waitcnt lgkmcnt(7)
v_add_f32 v24, v24, v200
v_add_f32 v25, v25, v201
v_add_f32 v26, v26, v202
v_add_f32 v27, v27, v203
s_waitcnt lgkmcnt(6)
v_add_f32 v28, v28, v204
v_add_f32 v29, v29, v205
v_add_f32 v30, v30, v206
v_add_f32 v31, v31, v207
s_waitcnt lgkmcnt(5)
v_add_f32 v32, v32, v208
v_add_f32 v33, v33, v209
v_add_f32 v34, v34, v210
v_add_f32 v35, v35, v211
s_waitcnt lgkmcnt(4)
v_add_f32 v36, v36, v212
v_add_f32 v37, v37, v213
v_add_f32 v38, v38, v214
v_add_f32 v39, v39, v215
s_waitcnt lgkmcnt(3)
v_add_f32 v56, v56, v216
v_add_f32 v57, v57, v217
v_add_f32 v58, v58, v218
v_add_f32 v59, v59, v219
s_waitcnt lgkmcnt(2)
v_add_f32 v60, v60, v220
v_add_f32 v61, v61, v221
v_add_f32 v62, v62, v222
v_add_f32 v63, v63, v223
s_waitcnt lgkmcnt(1)
v_add_f32 v64, v64, v224
v_add_f32 v65, v65, v225
v_add_f32 v66, v66, v226
v_add_f32 v67, v67, v227
s_waitcnt lgkmcnt(0)
v_add_f32 v68, v68, v228
v_add_f32 v69, v69, v229
v_add_f32 v70, v70, v230
v_add_f32 v71, v71, v231
s_waitcnt vmcnt(0)
L_xchk:
v_max3_u32 v9, v152, v153, v154
v_max3_u32 v9, v9, v155, v156
v_max3_u32 v9, v9, v157, v158
v_max3_u32 v9, v9, v159, v160
v_max3_u32 v9, v9, v161, v162
v_max3_u32 v9, v9, v163, v164
v_max3_u32 v9, v9, v165, v166
v_max_u32 v9, v9, v167
v_cmp_eq_u32 vcc, -1, v9
s_cbranch_vccnz L_xretry
L_xgo:
v_mfma_f32_16x16x32_bf16 v[24:27], v[234:237], v[152:155], v[24:27]
v_mfma_f32_16x16x32_bf16 v[28:31], v[232:235], v[152:155], v[28:31]
v_mfma_f32_16x16x32_bf16 v[32:35], v[234:237], v[156:159], v[32:35]
v_mfma_f32_16x16x32_bf16 v[36:39], v[232:235], v[156:159], v[36:39]
v_mfma_f32_16x16x32_bf16 v[56:59], v[234:237], v[160:163], v[56:59]
v_mfma_f32_16x16x32_bf16 v[60:63], v[232:235], v[160:163], v[60:63]
v_mfma_f32_16x16x32_bf16 v[64:67], v[234:237], v[164:167], v[64:67]
v_mfma_f32_16x16x32_bf16 v[68:71], v[232:235], v[164:167], v[68:71]
s_nop 1
v_cvt_pk_bf16_f32 v24, v24, v25
v_cvt_pk_bf16_f32 v25, v26, v27
v_cvt_pk_bf16_f32 v26, v28, v29
v_cvt_pk_bf16_f32 v27, v30, v31
v_cvt_pk_bf16_f32 v32, v32, v33
v_cvt_pk_bf16_f32 v33, v34, v35
v_cvt_pk_bf16_f32 v34, v36, v37
v_cvt_pk_bf16_f32 v35, v38, v39
v_permlane16_swap_b32 v24, v26
v_permlane16_swap_b32 v25, v27
v_permlane16_swap_b32 v32, v34
v_permlane16_swap_b32 v33, v35
v_mov_b32 v28, v24
v_mov_b32 v29, v25
v_mov_b32 v30, v26
v_mov_b32 v31, v27
v_mov_b32_dpp v24, v32 row_ror:8 row_mask:0xf bank_mask:0xc
v_mov_b32_dpp v25, v33 row_ror:8 row_mask:0xf bank_mask:0xc
v_mov_b32_dpp v26, v34 row_ror:8 row_mask:0xf bank_mask:0xc
v_mov_b32_dpp v27, v35 row_ror:8 row_mask:0xf bank_mask:0xc
v_mov_b32_dpp v32, v28 row_ror:8 row_mask:0xf bank_mask:0x3
v_mov_b32_dpp v33, v29 row_ror:8 row_mask:0xf bank_mask:0x3
v_mov_b32_dpp v34, v30 row_ror:8 row_mask:0xf bank_mask:0x3
v_mov_b32_dpp v35, v31 row_ror:8 row_mask:0xf bank_mask:0x3
buffer_store_dwordx4 v[24:27], v8, s[48:51], s77 offen sc1
s_add_u32 s77, s77, 16384
buffer_store_dwordx4 v[32:35], v8, s[48:51], s77 offen sc1
s_add_u32 s77, s77, 16384
v_cvt_pk_bf16_f32 v56, v56, v57
v_cvt_pk_bf16_f32 v57, v58, v59
v_cvt_pk_bf16_f32 v58, v60, v61
v_cvt_pk_bf16_f32 v59, v62, v63
v_cvt_pk_bf16_f32 v64, v64, v65
v_cvt_pk_bf16_f32 v65, v66, v67
v_cvt_pk_bf16_f32 v66, v68, v69
v_cvt_pk_bf16_f32 v67, v70, v71
v_permlane16_swap_b32 v56, v58
v_permlane16_swap_b32 v57, v59
v_permlane16_swap_b32 v64, v66
v_permlane16_swap_b32 v65, v67
v_mov_b32 v60, v56
v_mov_b32 v61, v57
v_mov_b32 v62, v58
v_mov_b32 v63, v59
v_mov_b32_dpp v56, v64 row_ror:8 row_mask:0xf bank_mask:0xc
v_mov_b32_dpp v57, v65 row_ror:8 row_mask:0xf bank_mask:0xc
v_mov_b32_dpp v58, v66 row_ror:8 row_mask:0xf bank_mask:0xc
v_mov_b32_dpp v59, v67 row_ror:8 row_mask:0xf bank_mask:0xc
v_mov_b32_dpp v64, v60 row_ror:8 row_mask:0xf bank_mask:0x3
v_mov_b32_dpp v65, v61 row_ror:8 row_mask:0xf bank_mask:0x3
v_mov_b32_dpp v66, v62 row_ror:8 row_mask:0xf bank_mask:0x3
v_mov_b32_dpp v67, v63 row_ror:8 row_mask:0xf bank_mask:0x3
buffer_store_dwordx4 v[56:59], v8, s[48:51], s77 offen sc1
s_add_u32 s77, s77, 16384
buffer_store_dwordx4 v[64:67], v8, s[48:51], s77 offen sc1
s_add_u32 s77, s77, 16384
L_end:
s_endpgm
L_xretry:
s_sub_u32 s72, s72, 1
s_cbranch_scc1 L_xgo
buffer_load_dwordx4 v[152:155], v16, s[44:47], s75 offen offset:0 sc1
buffer_load_dwordx4 v[156:159], v16, s[44:47], s75 offen offset:1024 sc1
buffer_load_dwordx4 v[160:163], v16, s[44:47], s75 offen offset:2048 sc1
buffer_load_dwordx4 v[164:167], v16, s[44:47], s75 offen offset:3072 sc1
s_waitcnt vmcnt(0)
s_branch L_xchk
L_spin_1:
s_mov_b32 vcc_hi, 0x80000
L_spinlp_3:
s_sleep 1
buffer_load_dword v1, off, s[52:55], s78 offset:0 sc1
s_waitcnt vmcnt(0)
v_readfirstlane_b32 vcc_lo, v1
s_sub_u32 vcc_hi, vcc_hi, 1
s_cbranch_scc1 L_spinbk_2
s_cmp_lt_u32 vcc_lo, s81
s_cbranch_scc1 L_spinlp_3
s_branch L_spinbk_2
L_spin_4:
s_mov_b32 vcc_hi, 0x80000
L_spinlp_6:
s_sleep 1
buffer_load_dword v1, off, s[52:55], s70 offset:0 sc1
s_waitcnt vmcnt(0)
v_readfirstlane_b32 vcc_lo, v1
s_sub_u32 vcc_hi, vcc_hi, 1
s_cbranch_scc1 L_spinbk_5
s_cmp_lt_u32 vcc_lo, s81
s_cbranch_scc1 L_spinlp_6
s_branch L_spinbk_5
L_hretry:
s_sub_u32 s72, s72, 1
s_cbranch_scc1 L_hgo
buffer_load_dwordx4 v[136:139], v16, s[44:47], s77 offen sc1
s_waitcnt vmcnt(0)
v_max3_u32 v1, v136, v137, v138
v_max_u32 v1, v1, v139
v_cmp_eq_u32 vcc, -1, v1
s_cbranch_vccnz L_hretry
s_branch L_hgo
L_spin_8:
s_mov_b32 vcc_hi, 0x80000
L_spinlp_10:
s_sleep 1
buffer_load_dword v19, off, s[52:55], s80 offset:0 sc1
s_waitcnt vmcnt(0)
v_readfirstlane_b32 vcc_lo, v19
s_sub_u32 vcc_hi, vcc_hi, 1
s_cbranch_scc1 L_spinbk_9
s_cmp_lt_u32 vcc_lo, s69
s_cbranch_scc1 L_spinlp_10
s_branch L_spinbk_9
L_spin_1012:
s_mov_b32 vcc_hi, 0x80000
L_spinlp_1014:
s_sleep 1
buffer_load_dword v19, off, s[52:55], s80 offset:0 sc1
s_waitcnt vmcnt(0)
v_readfirstlane_b32 vcc_lo, v19
s_sub_u32 vcc_hi, vcc_hi, 1
s_cbranch_scc1 L_spinbk_1013
s_cmp_lt_u32 vcc_lo, s69
s_cbranch_scc1 L_spinlp_1014
s_branch L_spinbk_1013
L_pg26:
s_branch L_tr3
L_F1:
s_waitcnt lgkmcnt(7)
v_mfma_f32_16x16x32_bf16 v[104:107], a[144:147], v[40:43], 0
s_waitcnt lgkmcnt(6)
ds_read_b128 a[176:179], v2 offset:8192
v_cndmask_b32 v88, 0, v17, s[0:1]
v_mfma_f32_16x16x32_bf16 v[104:107], a[148:151], v[44:47], v[104:107]
s_waitcnt lgkmcnt(6)
ds_read_b128 a[180:183], v2 offset:9216
v_cndmask_b32 v89, 0, v17, s[4:5]
v_mfma_f32_16x16x32_bf16 v[104:107], a[152:155], v[48:51], v[104:107]
s_waitcnt lgkmcnt(6)
buffer_load_dwordx4 v16, s[32:35], s70 offen offset:2048 sc1 lds
v_mfma_f32_16x16x32_bf16 v[104:107], a[156:159], v[52:55], v[104:107]
ds_read_b128 a[184:187], v2 offset:10240
v_cndmask_b32 v90, 0, v17, s[6:7]
v_mfma_f32_16x16x32_bf16 v[120:123], a[156:159], v[68:71], 0
ds_read_b128 a[188:191], v2 offset:11264
v_cndmask_b32 v91, 0, v17, s[8:9]
v_mfma_f32_16x16x32_bf16 v[120:123], a[152:155], v[64:67], v[120:123]
ds_read_b128 a[192:195], v2 offset:12288
v_accvgpr_write_b32 a128, 0
v_mfma_f32_16x16x32_bf16 v[120:123], a[148:151], v[60:63], v[120:123]
ds_read_b128 a[196:199], v2 offset:13312
v_accvgpr_write_b32 a129, 0
v_mfma_f32_16x16x32_bf16 v[120:123], a[144:147], v[56:59], v[120:123]
ds_read_b128 a[200:203], v2 offset:14336
v_accvgpr_write_b32 a130, 0
v_mfma_f32_16x16x32_bf16 v[136:139], a[144:147], v[72:75], 0
ds_read_b128 a[204:207], v2 offset:15360
v_accvgpr_write_b32 a131, 0
v_mfma_f32_16x16x32_bf16 v[136:139], a[148:151], v[76:79], v[136:139]
buffer_load_dwordx4 v16, s[32:35], s70 offen offset:3072 sc1 lds
v_mfma_f32_16x16x32_bf16 v[136:139], a[152:155], v[80:83], v[136:139]
v_accvgpr_write_b32 a132, 0
v_accvgpr_write_b32 a133, 0
v_mfma_f32_16x16x32_bf16 v[136:139], a[156:159], v[84:87], v[136:139]
v_accvgpr_write_b32 a134, 0
v_accvgpr_write_b32 a135, 0
v_mfma_f32_16x16x32_bf16 v[88:91], a[156:159], v[36:39], v[88:91]
v_accvgpr_write_b32 a136, 0
v_accvgpr_write_b32 a137, 0
v_mfma_f32_16x16x32_bf16 v[88:91], a[152:155], v[32:35], v[88:91]
v_accvgpr_write_b32 a138, 0
v_accvgpr_write_b32 a139, 0
v_mfma_f32_16x16x32_bf16 v[88:91], a[148:151], v[28:31], v[88:91]
v_accvgpr_write_b32 a140, 0
v_accvgpr_write_b32 a141, 0
v_mfma_f32_16x16x32_bf16 v[88:91], a[144:147], v[24:27], v[88:91]
s_waitcnt lgkmcnt(0)
s_nop 1
v_max3_f32 v21, v104, v105, v106
v_max_f32 v21, v21, v107
v_max3_f32 v22, v120, v121, v122
v_max_f32 v22, v22, v123
v_max3_f32 v23, v136, v137, v138
v_max_f32 v23, v23, v139
v_max3_f32 v20, v88, v89, v90
v_max_f32 v20, v20, v91
v_mov_b32 v248, v20
v_mov_b32 v249, v21
v_mov_b32 v250, v22
v_mov_b32 v251, v23
v_permlane16_swap_b32 v248, v20
v_permlane16_swap_b32 v249, v21
v_permlane16_swap_b32 v250, v22
v_permlane16_swap_b32 v251, v23
v_max_f32 v20, v20, v248
v_max_f32 v21, v21, v249
v_max_f32 v22, v22, v250
v_max_f32 v23, v23, v251
v_mov_b32 v248, v20
v_mov_b32 v249, v21
v_mov_b32 v250, v22
v_mov_b32 v251, v23
v_permlane32_swap_b32 v248, v20
v_permlane32_swap_b32 v249, v21
v_permlane32_swap_b32 v250, v22
v_permlane32_swap_b32 v251, v23
v_max_f32 v20, v20, v248
v_max_f32 v21, v21, v249
v_max_f32 v22, v22, v250
v_max_f32 v23, v23, v251
s_cmp_eq_u32 s73, 0
s_cselect_b64 vcc, 0, -1
v_cndmask_b32 v20, v20, v252, vcc
v_cndmask_b32 v21, v21, v253, vcc
v_cndmask_b32 v22, v22, v254, vcc
v_cndmask_b32 v23, v23, v255, vcc
v_sub_f32 v228, 0, v23
v_sub_f32 v229, 0, v23
v_sub_f32 v230, 0, v23
v_sub_f32 v231, 0, v23
v_sub_f32 v224, 0, v22
v_sub_f32 v225, 0, v22
v_sub_f32 v226, 0, v22
v_sub_f32 v227, 0, v22
v_sub_f32 v220, 0, v21
v_sub_f32 v221, 0, v21
v_sub_f32 v222, 0, v21
v_sub_f32 v223, 0, v21
v_sub_f32 v216, 0, v20
v_sub_f32 v217, 0, v20
v_sub_f32 v218, 0, v20
v_sub_f32 v219, 0, v20
v_mfma_f32_16x16x32_bf16 v[140:143], a[160:163], v[72:75], v[228:231]
s_add_u32 m0, s71, 4096
v_add_f32 v104, v104, v220
v_add_f32 v105, v105, v220
v_mfma_f32_16x16x32_bf16 v[140:143], a[164:167], v[76:79], v[140:143]
v_add_f32 v106, v106, v220
v_add_f32 v107, v107, v220
v_exp_f32 v104, v104
v_mfma_f32_16x16x32_bf16 v[140:143], a[168:171], v[80:83], v[140:143]
s_add_u32 s64, s70, 4096
v_exp_f32 v105, v105
v_mfma_f32_16x16x32_bf16 v[140:143], a[172:175], v[84:87], v[140:143]
buffer_load_dwordx4 v16, s[32:35], s64 offen offset:0 sc1 lds
v_mfma_f32_16x16x32_bf16 v[124:127], a[172:175], v[68:71], v[224:227]
v_exp_f32 v106, v106
v_mfma_f32_16x16x32_bf16 v[124:127], a[168:171], v[64:67], v[124:127]
v_exp_f32 v107, v107
v_mfma_f32_16x16x32_bf16 v[124:127], a[164:167], v[60:63], v[124:127]
v_add_f32 v120, v120, v224
v_add_f32 v121, v121, v224
v_add_f32 v122, v122, v224
v_add_f32 v123, v123, v224
v_exp_f32 v120, v120
v_mfma_f32_16x16x32_bf16 v[124:127], a[160:163], v[56:59], v[124:127]
v_exp_f32 v121, v121
v_mfma_f32_16x16x32_bf16 v[108:111], a[160:163], v[40:43], v[220:223]
v_exp_f32 v122, v122
v_mfma_f32_16x16x32_bf16 v[108:111], a[164:167], v[44:47], v[108:111]
v_cndmask_b32 v92, v216, v17, s[10:11]
v_cndmask_b32 v93, v216, v17, s[12:13]
v_cndmask_b32 v94, v216, v17, s[18:19]
v_cndmask_b32 v95, v216, v17, s[22:23]
v_mfma_f32_16x16x32_bf16 v[108:111], a[168:171], v[48:51], v[108:111]
buffer_load_dwordx4 v16, s[32:35], s64 offen offset:1024 sc1 lds
v_cvt_pk_bf16_f32 v160, v104, v105
v_mfma_f32_16x16x32_bf16 v[108:111], a[172:175], v[52:55], v[108:111]
v_exp_f32 v123, v123
v_mfma_f32_16x16x32_bf16 v[92:95], a[172:175], v[36:39], v[92:95]
v_add_f32 v136, v136, v228
v_add_f32 v137, v137, v228
v_add_f32 v138, v138, v228
v_add_f32 v139, v139, v228
v_exp_f32 v136, v136
v_mfma_f32_16x16x32_bf16 v[92:95], a[168:171], v[32:35], v[92:95]
v_cvt_pk_bf16_f32 v161, v106, v107
v_exp_f32 v137, v137
v_cndmask_b32 v96, v216, v17, s[26:27]
v_cndmask_b32 v97, v216, v17, s[56:57]
v_cndmask_b32 v98, v216, v17, s[58:59]
v_cndmask_b32 v99, v216, v17, s[60:61]
v_mfma_f32_16x16x32_bf16 v[92:95], a[164:167], v[28:31], v[92:95]
v_exp_f32 v138, v138
v_mfma_f32_16x16x32_bf16 v[92:95], a[160:163], v[24:27], v[92:95]
v_exp_f32 v139, v139
v_mfma_f32_16x16x32_bf16 v[96:99], a[176:179], v[24:27], v[96:99]
v_cvt_pk_bf16_f32 v184, v120, v121
v_add_f32 v88, v88, v216
v_mfma_f32_16x16x32_bf16 v[96:99], a[180:183], v[28:31], v[96:99]
buffer_load_dwordx4 v16, s[32:35], s64 offen offset:2048 sc1 lds
v_add_f32 v89, v89, v216
v_add_f32 v90, v90, v216
v_add_f32 v91, v91, v216
v_exp_f32 v88, v88
v_mfma_f32_16x16x32_bf16 v[96:99], a[184:187], v[32:35], v[96:99]
v_exp_f32 v89, v89
v_mfma_f32_16x16x32_bf16 v[96:99], a[188:191], v[36:39], v[96:99]
v_cvt_pk_bf16_f32 v185, v122, v123
v_cvt_pk_bf16_f32 v192, v136, v137
v_mfma_f32_16x16x32_bf16 v[112:115], a[188:191], v[52:55], v[220:223]
v_exp_f32 v90, v90
v_mfma_f32_16x16x32_bf16 v[112:115], a[184:187], v[48:51], v[112:115]
v_exp_f32 v91, v91
v_mfma_f32_16x16x32_bf16 v[112:115], a[180:183], v[44:47], v[112:115]
v_exp_f32 v140, v140
v_mfma_f32_16x16x32_bf16 v[112:115], a[176:179], v[40:43], v[112:115]
v_exp_f32 v141, v141
v_mfma_f32_16x16x32_bf16 v[128:131], a[176:179], v[56:59], v[224:227]
buffer_load_dwordx4 v16, s[32:35], s64 offen offset:3072 sc1 lds
v_cvt_pk_bf16_f32 v193, v138, v139
v_mfma_f32_16x16x32_bf16 v[128:131], a[180:183], v[60:63], v[128:131]
v_exp_f32 v142, v142
v_mfma_f32_16x16x32_bf16 v[128:131], a[184:187], v[64:67], v[128:131]
v_exp_f32 v143, v143
v_mfma_f32_16x16x32_bf16 v[128:131], a[188:191], v[68:71], v[128:131]
v_cvt_pk_bf16_f32 v152, v88, v89
v_cvt_pk_bf16_f32 v153, v90, v91
v_mfma_f32_16x16x32_bf16 v[144:147], a[188:191], v[84:87], v[228:231]
v_exp_f32 v124, v124
v_mfma_f32_16x16x32_bf16 v[144:147], a[184:187], v[80:83], v[144:147]
v_exp_f32 v125, v125
v_mfma_f32_16x16x32_bf16 v[144:147], a[180:183], v[76:79], v[144:147]
s_waitcnt vmcnt(6)
s_barrier
v_mfma_f32_16x16x32_bf16 v[144:147], a[176:179], v[72:75], v[144:147]
v_exp_f32 v126, v126
v_mfma_f32_16x16x32_bf16 v[148:151], a[192:195], v[72:75], v[228:231]
v_cvt_pk_bf16_f32 v194, v140, v141
v_cvt_pk_bf16_f32 v195, v142, v143
v_mfma_f32_16x16x32_bf16 v[148:151], a[196:199], v[76:79], v[148:151]
v_exp_f32 v127, v127
v_mfma_f32_16x16x32_bf16 v[148:151], a[200:203], v[80:83], v[148:151]
s_xor_b32 s71, s71, 16384
v_exp_f32 v108, v108
v_mfma_f32_16x16x32_bf16 v[148:151], a[204:207], v[84:87], v[148:151]
s_add_u32 s70, s70, 32768
v_exp_f32 v109, v109
v_mfma_f32_16x16x32_bf16 v[132:135], a[204:207], v[68:71], v[224:227]
s_mov_b32 m0, s71
v_exp_f32 v110, v110
v_mfma_f32_16x16x32_bf16 v[132:135], a[200:203], v[64:67], v[132:135]
buffer_load_dwordx4 v16, s[32:35], s70 offen offset:0 sc1 lds
v_mfma_f32_16x16x32_bf16 v[132:135], a[196:199], v[60:63], v[132:135]
v_cvt_pk_bf16_f32 v186, v124, v125
v_exp_f32 v111, v111
v_mfma_f32_16x16x32_bf16 v[132:135], a[192:195], v[56:59], v[132:135]
v_exp_f32 v92, v92
v_mfma_f32_16x16x32_bf16 v[116:119], a[192:195], v[40:43], v[220:223]
ds_read_b128 a[144:147], v2 offset:16384
v_cndmask_b32 v100, v216, v17, s[62:63]
v_mfma_f32_16x16x32_bf16 v[116:119], a[196:199], v[44:47], v[116:119]
ds_read_b128 a[148:151], v2 offset:17408
v_cndmask_b32 v101, v216, v17, s[48:49]
v_cndmask_b32 v102, v216, v17, s[50:51]
v_cndmask_b32 v103, v216, v17, s[100:101]
v_cvt_pk_bf16_f32 v187, v126, v127
v_exp_f32 v93, v93
v_mfma_f32_16x16x32_bf16 v[116:119], a[200:203], v[48:51], v[116:119]
v_exp_f32 v94, v94
v_mfma_f32_16x16x32_bf16 v[116:119], a[204:207], v[52:55], v[116:119]
ds_read_b128 a[152:155], v2 offset:18432
v_cvt_pk_bf16_f32 v162, v108, v109
v_mfma_f32_16x16x32_bf16 v[100:103], a[204:207], v[36:39], v[100:103]
buffer_load_dwordx4 v16, s[32:35], s70 offen offset:1024 sc1 lds
v_exp_f32 v95, v95
v_mfma_f32_16x16x32_bf16 v[100:103], a[200:203], v[32:35], v[100:103]
ds_read_b128 a[156:159], v2 offset:19456
v_exp_f32 v96, v96
v_mfma_f32_16x16x32_bf16 v[100:103], a[196:199], v[28:31], v[100:103]
v_cvt_pk_bf16_f32 v163, v110, v111
v_exp_f32 v97, v97
v_mfma_f32_16x16x32_bf16 v[100:103], a[192:195], v[24:27], v[100:103]
s_waitcnt lgkmcnt(2)
ds_read_b128 a[160:163], v2 offset:20480
ds_read_b128 a[164:167], v2 offset:21504
ds_read_b128 a[168:171], v2 offset:22528
ds_read_b128 a[172:175], v2 offset:23552
v_mfma_f32_16x16x32_bf16 v[120:123], a[144:147], v[56:59], v[224:227]
v_exp_f32 v98, v98
v_mfma_f32_16x16x32_bf16 v[120:123], a[148:151], v[60:63], v[120:123]
s_waitcnt lgkmcnt(5)
v_cvt_pk_bf16_f32 v154, v92, v93
v_exp_f32 v99, v99
v_mfma_f32_16x16x32_bf16 v[120:123], a[152:155], v[64:67], v[120:123]
s_waitcnt lgkmcnt(4)
v_exp_f32 v112, v112
v_mfma_f32_16x16x32_bf16 v[120:123], a[156:159], v[68:71], v[120:123]
v_exp_f32 v113, v113
v_mfma_f32_16x16x32_bf16 v[136:139], a[156:159], v[84:87], v[228:231]
v_cvt_pk_bf16_f32 v155, v94, v95
v_cndmask_b32 v104, v220, v17, s[0:1]
v_mfma_f32_16x16x32_bf16 v[136:139], a[152:155], v[80:83], v[136:139]
ds_read_b128 a[176:179], v2 offset:24576
buffer_load_dwordx4 v16, s[32:35], s70 offen offset:2048 sc1 lds
v_cndmask_b32 v105, v220, v17, s[4:5]
v_cndmask_b32 v106, v220, v17, s[6:7]
v_cndmask_b32 v107, v220, v17, s[8:9]
v_exp_f32 v114, v114
v_mfma_f32_16x16x32_bf16 v[136:139], a[148:151], v[76:79], v[136:139]
v_cvt_pk_bf16_f32 v156, v96, v97
v_cvt_pk_bf16_f32 v157, v98, v99
v_mfma_f32_16x16x32_bf16 v[136:139], a[144:147], v[72:75], v[136:139]
v_exp_f32 v115, v115
v_mfma_f32_16x16x32_bf16 v[104:107], a[144:147], v[40:43], v[104:107]
v_exp_f32 v128, v128
v_mfma_f32_16x16x32_bf16 v[104:107], a[148:151], v[44:47], v[104:107]
v_exp_f32 v129, v129
v_mfma_f32_16x16x32_bf16 v[104:107], a[152:155], v[48:51], v[104:107]
v_exp_f32 v130, v130
v_mfma_f32_16x16x32_bf16 v[104:107], a[156:159], v[52:55], v[104:107]
s_waitcnt lgkmcnt(0)
v_exp_f32 v131, v131
v_mfma_f32_16x16x32_bf16 v[140:143], a[172:175], v[84:87], v[228:231]
v_cvt_pk_bf16_f32 v164, v112, v113
v_cvt_pk_bf16_f32 v165, v114, v115
v_mfma_f32_16x16x32_bf16 v[140:143], a[168:171], v[80:83], v[140:143]
v_exp_f32 v144, v144
v_mfma_f32_16x16x32_bf16 v[140:143], a[164:167], v[76:79], v[140:143]
v_exp_f32 v145, v145
v_mfma_f32_16x16x32_bf16 v[140:143], a[160:163], v[72:75], v[140:143]
v_exp_f32 v146, v146
v_mfma_f32_16x16x32_bf16 v[124:127], a[160:163], v[56:59], v[224:227]
ds_read_b128 a[180:183], v2 offset:25600
v_cndmask_b32 v108, v220, v17, s[10:11]
v_mfma_f32_16x16x32_bf16 v[124:127], a[164:167], v[60:63], v[124:127]
ds_read_b128 a[184:187], v2 offset:26624
buffer_load_dwordx4 v16, s[32:35], s70 offen offset:3072 sc1 lds
v_cndmask_b32 v109, v220, v17, s[12:13]
v_cndmask_b32 v110, v220, v17, s[18:19]
v_cndmask_b32 v111, v220, v17, s[22:23]
v_cvt_pk_bf16_f32 v188, v128, v129
v_mfma_f32_16x16x32_bf16 v[124:127], a[168:171], v[64:67], v[124:127]
s_add_u32 m0, s86, 131072
v_exp_f32 v147, v147
v_mfma_f32_16x16x32_bf16 v[124:127], a[172:175], v[68:71], v[124:127]
s_add_u32 s64, s85, 0
ds_read_b128 a[188:191], v2 offset:27648
v_exp_f32 v148, v148
v_mfma_f32_16x16x32_bf16 v[108:111], a[172:175], v[52:55], v[108:111]
buffer_load_dwordx4 v12, s[36:39], s64 offen lds
v_cvt_pk_bf16_f32 v189, v130, v131
v_exp_f32 v149, v149
v_mfma_f32_16x16x32_bf16 v[108:111], a[168:171], v[48:51], v[108:111]
s_add_u32 m0, s86, 132096
ds_read_b128 a[192:195], v2 offset:28672
v_cndmask_b32 v112, v220, v17, s[26:27]
v_cndmask_b32 v113, v220, v17, s[56:57]
v_cndmask_b32 v114, v220, v17, s[58:59]
v_cndmask_b32 v115, v220, v17, s[60:61]
v_mfma_f32_16x16x32_bf16 v[108:111], a[164:167], v[44:47], v[108:111]
s_add_u32 s64, s85, 8192
v_exp_f32 v150, v150
v_mfma_f32_16x16x32_bf16 v[108:111], a[160:163], v[40:43], v[108:111]
buffer_load_dwordx4 v13, s[36:39], s64 offen lds
v_cvt_pk_bf16_f32 v196, v144, v145
v_exp_f32 v151, v151
v_mfma_f32_16x16x32_bf16 v[112:115], a[176:179], v[40:43], v[112:115]
s_waitcnt lgkmcnt(2)
s_add_u32 m0, s86, 133120
v_exp_f32 v132, v132
v_mfma_f32_16x16x32_bf16 v[112:115], a[180:183], v[44:47], v[112:115]
s_add_u32 s64, s85, 16384
v_exp_f32 v133, v133
v_mfma_f32_16x16x32_bf16 v[112:115], a[184:187], v[48:51], v[112:115]
s_waitcnt lgkmcnt(1)
buffer_load_dwordx4 v12, s[36:39], s64 offen lds
v_cvt_pk_bf16_f32 v197, v146, v147
v_mfma_f32_16x16x32_bf16 v[112:115], a[188:191], v[52:55], v[112:115]
s_add_u32 m0, s86, 134144
v_exp_f32 v134, v134
v_mfma_f32_16x16x32_bf16 v[128:131], a[188:191], v[68:71], v[224:227]
s_add_u32 s64, s85, 24576
ds_read_b128 a[196:199], v2 offset:29696
ds_read_b128 a[200:203], v2 offset:30720
ds_read_b128 a[204:207], v2 offset:31744
v_cvt_pk_bf16_f32 v198, v148, v149
v_mfma_f32_16x16x32_bf16 v[128:131], a[184:187], v[64:67], v[128:131]
buffer_load_dwordx4 v13, s[36:39], s64 offen lds
v_exp_f32 v135, v135
v_mfma_f32_16x16x32_bf16 v[128:131], a[180:183], v[60:63], v[128:131]
s_add_u32 m0, s71, 4096
v_exp_f32 v116, v116
v_mfma_f32_16x16x32_bf16 v[128:131], a[176:179], v[56:59], v[128:131]
s_add_u32 s64, s70, 4096
v_cvt_pk_bf16_f32 v199, v150, v151
v_exp_f32 v117, v117
v_mfma_f32_16x16x32_bf16 v[144:147], a[176:179], v[72:75], v[228:231]
buffer_load_dwordx4 v16, s[32:35], s64 offen offset:0 sc1 lds
v_mfma_f32_16x16x32_bf16 v[144:147], a[180:183], v[76:79], v[144:147]
v_exp_f32 v118, v118
v_mfma_f32_16x16x32_bf16 v[144:147], a[184:187], v[80:83], v[144:147]
v_cvt_pk_bf16_f32 v190, v132, v133
v_exp_f32 v119, v119
v_mfma_f32_16x16x32_bf16 v[144:147], a[188:191], v[84:87], v[144:147]
s_waitcnt lgkmcnt(0)
v_exp_f32 v100, v100
v_mfma_f32_16x16x32_bf16 v[148:151], a[204:207], v[84:87], v[228:231]
v_exp_f32 v101, v101
v_mfma_f32_16x16x32_bf16 v[148:151], a[200:203], v[80:83], v[148:151]
v_cvt_pk_bf16_f32 v191, v134, v135
v_cvt_pk_bf16_f32 v166, v116, v117
v_cvt_pk_bf16_f32 v167, v118, v119
v_mfma_f32_16x16x32_bf16 v[148:151], a[196:199], v[76:79], v[148:151]
v_exp_f32 v102, v102
v_mfma_f32_16x16x32_bf16 v[148:151], a[192:195], v[72:75], v[148:151]
v_exp_f32 v103, v103
v_mfma_f32_16x16x32_bf16 v[132:135], a[192:195], v[56:59], v[224:227]
s_lshl_b32 s66, s30, 30
ds_read_b128 a[144:147], v3 offset:16384
v_cndmask_b32 v116, v220, v17, s[62:63]
v_mfma_f32_16x16x32_bf16 v[132:135], a[196:199], v[60:63], v[132:135]
ds_read_b128 a[148:151], v3 offset:24576
v_cndmask_b32 v117, v220, v17, s[48:49]
v_cndmask_b32 v118, v220, v17, s[50:51]
v_cndmask_b32 v119, v220, v17, s[100:101]
v_exp_f32 v120, v120
v_mfma_f32_16x16x32_bf16 v[132:135], a[200:203], v[64:67], v[132:135]
v_exp_f32 v121, v121
v_mfma_f32_16x16x32_bf16 v[132:135], a[204:207], v[68:71], v[132:135]
v_exp_f32 v122, v122
v_mfma_f32_16x16x32_bf16 v[116:119], a[204:207], v[52:55], v[116:119]
ds_read_b128 a[152:155], v3 offset:17408
v_accvgpr_write_b32 a142, 0
v_mfma_f32_16x16x32_bf16 v[116:119], a[200:203], v[48:51], v[116:119]
s_branch L_po27
L_pg27:
s_branch L_tr3
L_po27:
ds_read_b128 a[156:159], v3 offset:25600
buffer_load_dwordx4 v16, s[32:35], s64 offen offset:1024 sc1 lds
v_accvgpr_write_b32 a143, 0
v_cvt_pk_bf16_f32 v158, v100, v101
v_cvt_pk_bf16_f32 v159, v102, v103
v_mfma_f32_16x16x32_bf16 v[116:119], a[196:199], v[44:47], v[116:119]
v_exp_f32 v123, v123
v_mfma_f32_16x16x32_bf16 v[116:119], a[192:195], v[40:43], v[116:119]
v_exp_f32 v136, v136
v_smfmac_f32_16x16x64_bf16 a[128:131], a[240:243], v[152:159], v5
ds_read_b128 a[160:163], v3 offset:18432
v_smfmac_f32_16x16x64_bf16 a[132:135], a[240:243], v[160:167], v5
v_exp_f32 v137, v137
v_smfmac_f32_16x16x64_bf16 a[136:139], a[240:243], v[184:191], v5
v_exp_f32 v138, v138
v_smfmac_f32_16x16x64_bf16 a[140:143], a[240:243], v[192:199], v5
s_waitcnt lgkmcnt(1)
v_cvt_pk_bf16_f32 v200, v120, v121
v_mfma_f32_16x16x32_bf16 a[0:3], a[144:147], v[152:155], 0
v_exp_f32 v139, v139
v_mfma_f32_16x16x32_bf16 a[0:3], a[148:151], v[156:159], a[0:3]
v_exp_f32 v104, v104
v_mfma_f32_16x16x32_bf16 a[32:35], a[148:151], v[164:167], 0
v_cvt_pk_bf16_f32 v201, v122, v123
v_cvt_pk_bf16_f32 v208, v136, v137
v_mfma_f32_16x16x32_bf16 a[32:35], a[144:147], v[160:163], a[32:35]
v_exp_f32 v105, v105
v_mfma_f32_16x16x32_bf16 a[64:67], a[144:147], v[184:187], 0
v_exp_f32 v106, v106
v_mfma_f32_16x16x32_bf16 a[64:67], a[148:151], v[188:191], a[64:67]
v_exp_f32 v107, v107
v_mfma_f32_16x16x32_bf16 a[96:99], a[148:151], v[196:199], 0
buffer_load_dwordx4 v16, s[32:35], s64 offen offset:2048 sc1 lds
v_mfma_f32_16x16x32_bf16 a[96:99], a[144:147], v[192:195], a[96:99]
v_exp_f32 v140, v140
v_mfma_f32_16x16x32_bf16 a[100:103], a[152:155], v[192:195], 0
ds_read_b128 a[164:167], v3 offset:26624
v_cvt_pk_bf16_f32 v209, v138, v139
v_mfma_f32_16x16x32_bf16 a[100:103], a[156:159], v[196:199], a[100:103]
v_exp_f32 v141, v141
v_mfma_f32_16x16x32_bf16 a[68:71], a[156:159], v[188:191], 0
v_exp_f32 v142, v142
v_mfma_f32_16x16x32_bf16 a[68:71], a[152:155], v[184:187], a[68:71]
v_cvt_pk_bf16_f32 v176, v104, v105
v_cvt_pk_bf16_f32 v177, v106, v107
v_mfma_f32_16x16x32_bf16 a[36:39], a[152:155], v[160:163], 0
v_exp_f32 v143, v143
v_mfma_f32_16x16x32_bf16 a[36:39], a[156:159], v[164:167], a[36:39]
v_exp_f32 v124, v124
v_mfma_f32_16x16x32_bf16 a[4:7], a[156:159], v[156:159], 0
v_exp_f32 v125, v125
v_mfma_f32_16x16x32_bf16 a[4:7], a[152:155], v[152:155], a[4:7]
s_waitcnt lgkmcnt(0)
ds_read_b128 a[168:171], v3 offset:19456
v_cvt_pk_bf16_f32 v210, v140, v141
v_mfma_f32_16x16x32_bf16 a[8:11], a[160:163], v[152:155], 0
v_exp_f32 v126, v126
v_mfma_f32_16x16x32_bf16 a[8:11], a[164:167], v[156:159], a[8:11]
ds_read_b128 a[172:175], v3 offset:27648
v_cvt_pk_bf16_f32 v211, v142, v143
v_mfma_f32_16x16x32_bf16 a[40:43], a[164:167], v[164:167], 0
v_exp_f32 v127, v127
v_mfma_f32_16x16x32_bf16 a[40:43], a[160:163], v[160:163], a[40:43]
v_exp_f32 v108, v108
v_mfma_f32_16x16x32_bf16 a[72:75], a[160:163], v[184:187], 0
buffer_load_dwordx4 v16, s[32:35], s64 offen offset:3072 sc1 lds
v_mfma_f32_16x16x32_bf16 a[72:75], a[164:167], v[188:191], a[72:75]
v_exp_f32 v109, v109
v_mfma_f32_16x16x32_bf16 a[104:107], a[164:167], v[196:199], 0
v_exp_f32 v110, v110
v_mfma_f32_16x16x32_bf16 a[104:107], a[160:163], v[192:195], a[104:107]
s_waitcnt lgkmcnt(0)
ds_read_b128 a[176:179], v3 offset:20480
v_cvt_pk_bf16_f32 v202, v124, v125
v_mfma_f32_16x16x32_bf16 a[108:111], a[168:171], v[192:195], 0
v_exp_f32 v111, v111
v_mfma_f32_16x16x32_bf16 a[108:111], a[172:175], v[196:199], a[108:111]
ds_read_b128 a[180:183], v3 offset:28672
v_cvt_pk_bf16_f32 v203, v126, v127
v_mfma_f32_16x16x32_bf16 a[76:79], a[172:175], v[188:191], 0
s_add_u32 m0, s86, 135168
v_exp_f32 v112, v112
v_mfma_f32_16x16x32_bf16 a[76:79], a[168:171], v[184:187], a[76:79]
s_add_u32 s64, s85, 32768
v_exp_f32 v113, v113
v_mfma_f32_16x16x32_bf16 a[44:47], a[168:171], v[160:163], 0
buffer_load_dwordx4 v12, s[36:39], s64 offen lds
v_mfma_f32_16x16x32_bf16 a[44:47], a[172:175], v[164:167], a[44:47]
s_add_u32 m0, s86, 136192
v_cvt_pk_bf16_f32 v178, v108, v109
v_exp_f32 v114, v114
v_mfma_f32_16x16x32_bf16 a[12:15], a[172:175], v[156:159], 0
s_add_u32 s64, s85, 40960
v_exp_f32 v115, v115
v_mfma_f32_16x16x32_bf16 a[12:15], a[168:171], v[152:155], a[12:15]
s_waitcnt lgkmcnt(0)
buffer_load_dwordx4 v13, s[36:39], s64 offen lds
v_mfma_f32_16x16x32_bf16 a[16:19], a[176:179], v[152:155], 0
s_add_u32 m0, s86, 137216
ds_read_b128 a[184:187], v3 offset:21504
ds_read_b128 a[188:191], v3 offset:29696
ds_read_b128 a[192:195], v3 offset:22528
ds_read_b128 a[196:199], v3 offset:30720
ds_read_b128 a[200:203], v3 offset:23552
ds_read_b128 a[204:207], v3 offset:31744
v_xor_b32 v2, 0x8000, v2
v_exp_f32 v128, v128
v_mfma_f32_16x16x32_bf16 a[16:19], a[180:183], v[156:159], a[16:19]
s_waitcnt vmcnt(14)
s_barrier
s_add_u32 s64, s85, 49152
v_cvt_pk_bf16_f32 v179, v110, v111
v_mfma_f32_16x16x32_bf16 a[48:51], a[180:183], v[164:167], 0
buffer_load_dwordx4 v12, s[36:39], s64 offen lds
v_exp_f32 v129, v129
v_mfma_f32_16x16x32_bf16 a[48:51], a[176:179], v[160:163], a[48:51]
s_add_u32 m0, s86, 138240
v_exp_f32 v130, v130
v_mfma_f32_16x16x32_bf16 a[80:83], a[176:179], v[184:187], 0
s_add_u32 s64, s85, 57344
v_cvt_pk_bf16_f32 v180, v112, v113
v_cvt_pk_bf16_f32 v181, v114, v115
v_mfma_f32_16x16x32_bf16 a[80:83], a[180:183], v[188:191], a[80:83]
buffer_load_dwordx4 v13, s[36:39], s64 offen lds
v_exp_f32 v131, v131
v_mfma_f32_16x16x32_bf16 a[112:115], a[180:183], v[196:199], 0
v_exp_f32 v144, v144
v_mfma_f32_16x16x32_bf16 a[112:115], a[176:179], v[192:195], a[112:115]
s_waitcnt lgkmcnt(0)
s_xor_b32 s71, s71, 49152
s_add_u32 s70, s70, 32768
s_mov_b32 m0, s71
v_exp_f32 v145, v145
v_mfma_f32_16x16x32_bf16 a[116:119], a[184:187], v[192:195], 0
buffer_load_dwordx4 v16, s[32:35], s70 offen offset:0 sc1 lds
v_mfma_f32_16x16x32_bf16 a[116:119], a[188:191], v[196:199], a[116:119]
v_exp_f32 v146, v146
v_mfma_f32_16x16x32_bf16 a[84:87], a[188:191], v[188:191], 0
v_cvt_pk_bf16_f32 v204, v128, v129
v_cvt_pk_bf16_f32 v205, v130, v131
v_mfma_f32_16x16x32_bf16 a[84:87], a[184:187], v[184:187], a[84:87]
v_exp_f32 v147, v147
v_mfma_f32_16x16x32_bf16 a[52:55], a[184:187], v[160:163], 0
v_exp_f32 v148, v148
v_mfma_f32_16x16x32_bf16 a[52:55], a[188:191], v[164:167], a[52:55]
v_exp_f32 v149, v149
v_mfma_f32_16x16x32_bf16 a[20:23], a[188:191], v[156:159], 0
ds_read_b128 a[144:147], v2 offset:0
v_lshl_add_u32 v19, v0, 24, s66
v_mfma_f32_16x16x32_bf16 a[20:23], a[184:187], v[152:155], a[20:23]
s_lshr_b32 s67, s31, 4
v_exp_f32 v150, v150
v_mfma_f32_16x16x32_bf16 a[24:27], a[192:195], v[152:155], 0
s_lshl1_add_u32 s67, s3, s67
v_cvt_pk_bf16_f32 v212, v144, v145
v_cvt_pk_bf16_f32 v213, v146, v147
v_mfma_f32_16x16x32_bf16 a[24:27], a[196:199], v[156:159], a[24:27]
s_lshl_b32 s79, s67, 8
v_exp_f32 v151, v151
v_mfma_f32_16x16x32_bf16 a[56:59], a[196:199], v[164:167], 0
s_add_u32 s79, s79, 8192
v_exp_f32 v132, v132
v_mfma_f32_16x16x32_bf16 a[56:59], a[192:195], v[160:163], a[56:59]
s_add_u32 s69, s31, 12
v_exp_f32 v133, v133
v_mfma_f32_16x16x32_bf16 a[88:91], a[192:195], v[184:187], 0
s_lshr_b32 s69, s69, 5
buffer_load_dwordx4 v16, s[32:35], s70 offen offset:1024 sc1 lds
v_mfma_f32_16x16x32_bf16 a[88:91], a[196:199], v[188:191], a[88:91]
s_lshl1_add_u32 s69, s3, s69
v_exp_f32 v134, v134
v_mfma_f32_16x16x32_bf16 a[120:123], a[196:199], v[196:199], 0
s_lshl_b32 s69, s69, 8
v_cvt_pk_bf16_f32 v214, v148, v149
v_cvt_pk_bf16_f32 v215, v150, v151
v_mfma_f32_16x16x32_bf16 a[120:123], a[192:195], v[192:195], a[120:123]
s_add_u32 s69, s69, 8192
v_exp_f32 v135, v135
v_mfma_f32_16x16x32_bf16 a[124:127], a[200:203], v[192:195], 0
s_lshl_b32 s67, s73, 16
v_exp_f32 v116, v116
v_mfma_f32_16x16x32_bf16 a[124:127], a[204:207], v[196:199], a[124:127]
s_xor_b32 s68, s80, 256
v_exp_f32 v117, v117
v_mfma_f32_16x16x32_bf16 a[92:95], a[204:207], v[188:191], 0
s_add_u32 s68, s68, s67
ds_read_b128 a[148:151], v2 offset:1024
v_cvt_pk_bf16_f32 v206, v132, v133
v_mfma_f32_16x16x32_bf16 a[92:95], a[200:203], v[184:187], a[92:95]
s_add_u32 s67, s67, s69
v_exp_f32 v118, v118
v_mfma_f32_16x16x32_bf16 a[60:63], a[200:203], v[160:163], 0
ds_read_b128 a[152:155], v2 offset:2048
v_cvt_pk_bf16_f32 v207, v134, v135
v_mfma_f32_16x16x32_bf16 a[60:63], a[204:207], v[164:167], a[60:63]
ds_read_b128 a[156:159], v2 offset:3072
v_cvt_pk_bf16_f32 v182, v116, v117
v_mfma_f32_16x16x32_bf16 a[28:31], a[204:207], v[156:159], 0
s_mov_b64 exec, 1
buffer_atomic_add a251, v19, s[52:55], s67 offen offset:0 sc1
buffer_atomic_add a251, v19, s[52:55], s68 offen offset:0 sc1
s_mov_b64 exec, -1
v_exp_f32 v119, v119
v_mfma_f32_16x16x32_bf16 a[28:31], a[200:203], v[152:155], a[28:31]
ds_read_b128 a[160:163], v2 offset:4096
ds_read_b128 a[164:167], v2 offset:5120
ds_read_b128 a[168:171], v2 offset:6144
ds_read_b128 a[172:175], v2 offset:7168
v_mul_u32_u24 v19, 52, v0
v_cvt_pk_bf16_f32 v183, v118, v119
v_xor_b32 v3, 0x8000, v3
v_accvgpr_read_b32 v20, a128
v_accvgpr_read_b32 v248, a129
v_add_f32 v20, v20, v248
v_max_f32 v1, v1, v20
v_rcp_f32 v20, v20
v_accvgpr_read_b32 v232, a0
v_accvgpr_read_b32 v233, a1
v_accvgpr_read_b32 v234, a2
v_accvgpr_read_b32 v235, a3
v_accvgpr_read_b32 v236, a4
v_accvgpr_read_b32 v237, a5
v_accvgpr_read_b32 v238, a6
v_accvgpr_read_b32 v239, a7
v_mul_f32 v20, v20, v4
v_mul_f32 v232, v232, v20
v_mul_f32 v233, v233, v20
v_mul_f32 v234, v234, v20
v_mul_f32 v235, v235, v20
v_mul_f32 v236, v236, v20
v_mul_f32 v237, v237, v20
v_mul_f32 v238, v238, v20
v_mul_f32 v239, v239, v20
v_cvt_pk_bf16_f32 v232, v232, v233
v_cvt_pk_bf16_f32 v233, v234, v235
v_cvt_pk_bf16_f32 v234, v236, v237
v_cvt_pk_bf16_f32 v235, v238, v239
s_add_u32 s77, s74, 0
buffer_store_dwordx4 v[232:235], v16, s[44:47], s77 offen sc1
v_accvgpr_read_b32 v240, a8
v_accvgpr_read_b32 v241, a9
v_accvgpr_read_b32 v242, a10
v_accvgpr_read_b32 v243, a11
v_accvgpr_read_b32 v244, a12
v_accvgpr_read_b32 v245, a13
v_accvgpr_read_b32 v246, a14
v_accvgpr_read_b32 v247, a15
v_mul_f32 v240, v240, v20
v_mul_f32 v241, v241, v20
v_mul_f32 v242, v242, v20
v_mul_f32 v243, v243, v20
v_mul_f32 v244, v244, v20
v_mul_f32 v245, v245, v20
v_mul_f32 v246, v246, v20
v_mul_f32 v247, v247, v20
v_cvt_pk_bf16_f32 v240, v240, v241
v_cvt_pk_bf16_f32 v241, v242, v243
v_cvt_pk_bf16_f32 v242, v244, v245
v_cvt_pk_bf16_f32 v243, v246, v247
s_add_u32 s77, s74, 8192
buffer_store_dwordx4 v[240:243], v16, s[44:47], s77 offen sc1
v_accvgpr_read_b32 v232, a16
v_accvgpr_read_b32 v233, a17
v_accvgpr_read_b32 v234, a18
v_accvgpr_read_b32 v235, a19
v_accvgpr_read_b32 v236, a20
v_accvgpr_read_b32 v237, a21
v_accvgpr_read_b32 v238, a22
v_accvgpr_read_b32 v239, a23
v_mul_f32 v232, v232, v20
v_mul_f32 v233, v233, v20
v_mul_f32 v234, v234, v20
v_mul_f32 v235, v235, v20
v_mul_f32 v236, v236, v20
v_mul_f32 v237, v237, v20
v_mul_f32 v238, v238, v20
v_mul_f32 v239, v239, v20
v_cvt_pk_bf16_f32 v232, v232, v233
v_cvt_pk_bf16_f32 v233, v234, v235
v_cvt_pk_bf16_f32 v234, v236, v237
v_cvt_pk_bf16_f32 v235, v238, v239
s_add_u32 s77, s74, 16384
buffer_store_dwordx4 v[232:235], v16, s[44:47], s77 offen sc1
s_branch L_T
L_pg28:
s_branch L_tr4
L_T1:
buffer_load_dword v19, off, s[52:55], s80 sc1
s_waitcnt lgkmcnt(7)
v_mfma_f32_16x16x32_bf16 v[136:139], a[144:147], v[72:75], v[228:231]
s_waitcnt lgkmcnt(6)
ds_read_b128 a[176:179], v2 offset:8192
v_cndmask_b32 v120, v224, v17, s[0:1]
v_mfma_f32_16x16x32_bf16 v[136:139], a[148:151], v[76:79], v[136:139]
s_waitcnt lgkmcnt(6)
ds_read_b128 a[180:183], v2 offset:9216
v_cndmask_b32 v121, v224, v17, s[4:5]
v_cndmask_b32 v122, v224, v17, s[6:7]
v_cndmask_b32 v123, v224, v17, s[8:9]
v_mfma_f32_16x16x32_bf16 v[136:139], a[152:155], v[80:83], v[136:139]
s_waitcnt lgkmcnt(6)
buffer_load_dwordx4 v16, s[32:35], s70 offen offset:2048 sc1 lds
v_mfma_f32_16x16x32_bf16 v[136:139], a[156:159], v[84:87], v[136:139]
ds_read_b128 a[184:187], v2 offset:10240
v_cndmask_b32 v124, v224, v17, s[10:11]
v_mfma_f32_16x16x32_bf16 v[120:123], a[156:159], v[68:71], v[120:123]
ds_read_b128 a[188:191], v2 offset:11264
v_cndmask_b32 v125, v224, v17, s[12:13]
v_mfma_f32_16x16x32_bf16 v[120:123], a[152:155], v[64:67], v[120:123]
ds_read_b128 a[192:195], v2 offset:12288
v_cndmask_b32 v126, v224, v17, s[18:19]
v_mfma_f32_16x16x32_bf16 v[120:123], a[148:151], v[60:63], v[120:123]
ds_read_b128 a[196:199], v2 offset:13312
v_cndmask_b32 v127, v224, v17, s[22:23]
v_mfma_f32_16x16x32_bf16 v[120:123], a[144:147], v[56:59], v[120:123]
s_waitcnt lgkmcnt(4)
ds_read_b128 a[200:203], v2 offset:14336
v_cndmask_b32 v128, v224, v17, s[26:27]
v_mfma_f32_16x16x32_bf16 v[140:143], a[160:163], v[72:75], v[228:231]
ds_read_b128 a[204:207], v2 offset:15360
v_cndmask_b32 v129, v224, v17, s[56:57]
v_mfma_f32_16x16x32_bf16 v[140:143], a[164:167], v[76:79], v[140:143]
ds_read_b128 a[144:147], v3 offset:0
v_cndmask_b32 v130, v224, v17, s[58:59]
v_mfma_f32_16x16x32_bf16 v[140:143], a[168:171], v[80:83], v[140:143]
v_exp_f32 v136, v136
v_mfma_f32_16x16x32_bf16 v[140:143], a[172:175], v[84:87], v[140:143]
v_exp_f32 v137, v137
v_mfma_f32_16x16x32_bf16 v[124:127], a[172:175], v[68:71], v[124:127]
ds_read_b128 a[148:151], v3 offset:8192
v_cndmask_b32 v131, v224, v17, s[60:61]
v_mfma_f32_16x16x32_bf16 v[124:127], a[168:171], v[64:67], v[124:127]
v_exp_f32 v138, v138
v_mfma_f32_16x16x32_bf16 v[124:127], a[164:167], v[60:63], v[124:127]
s_mul_i32 s69, s83, 8
buffer_load_dwordx4 v16, s[32:35], s70 offen offset:3072 sc1 lds
v_mfma_f32_16x16x32_bf16 v[124:127], a[160:163], v[56:59], v[124:127]
s_sub_u32 s69, 36, s69
v_exp_f32 v139, v139
v_mfma_f32_16x16x32_bf16 v[128:131], a[176:179], v[56:59], v[128:131]
v_exp_f32 v120, v120
v_mfma_f32_16x16x32_bf16 v[128:131], a[180:183], v[60:63], v[128:131]
s_waitcnt lgkmcnt(1)
v_exp_f32 v121, v121
v_mfma_f32_16x16x32_bf16 v[128:131], a[184:187], v[64:67], v[128:131]
v_exp_f32 v122, v122
v_mfma_f32_16x16x32_bf16 v[128:131], a[188:191], v[68:71], v[128:131]
s_add_u32 m0, s71, 4096
ds_read_b128 a[152:155], v3 offset:1024
v_cndmask_b32 v132, v224, v17, s[62:63]
v_mfma_f32_16x16x32_bf16 v[144:147], a[188:191], v[84:87], v[228:231]
s_add_u32 s64, s70, 4096
v_cvt_pk_bf16_f32 v192, v136, v137
v_cndmask_b32 v133, v224, v17, s[48:49]
v_mfma_f32_16x16x32_bf16 v[144:147], a[184:187], v[80:83], v[144:147]
buffer_load_dwordx4 v16, s[32:35], s64 offen offset:0 sc1 lds
v_mfma_f32_16x16x32_bf16 v[144:147], a[180:183], v[76:79], v[144:147]
ds_read_b128 a[156:159], v3 offset:9216
v_cndmask_b32 v134, v224, v17, s[50:51]
v_mfma_f32_16x16x32_bf16 v[144:147], a[176:179], v[72:75], v[144:147]
ds_read_b128 a[160:163], v3 offset:2048
v_cndmask_b32 v135, v224, v17, s[100:101]
v_mfma_f32_16x16x32_bf16 v[148:151], a[192:195], v[72:75], v[228:231]
v_exp_f32 v123, v123
v_mfma_f32_16x16x32_bf16 v[148:151], a[196:199], v[76:79], v[148:151]
v_cvt_pk_bf16_f32 v193, v138, v139
v_cvt_pk_bf16_f32 v184, v120, v121
v_mfma_f32_16x16x32_bf16 v[148:151], a[200:203], v[80:83], v[148:151]
v_exp_f32 v140, v140
v_mfma_f32_16x16x32_bf16 v[148:151], a[204:207], v[84:87], v[148:151]
v_exp_f32 v141, v141
v_mfma_f32_16x16x32_bf16 v[132:135], a[204:207], v[68:71], v[132:135]
v_exp_f32 v142, v142
v_mfma_f32_16x16x32_bf16 v[132:135], a[200:203], v[64:67], v[132:135]
v_exp_f32 v143, v143
v_mfma_f32_16x16x32_bf16 v[132:135], a[196:199], v[60:63], v[132:135]
buffer_load_dwordx4 v16, s[32:35], s64 offen offset:1024 sc1 lds
v_mfma_f32_16x16x32_bf16 v[132:135], a[192:195], v[56:59], v[132:135]
v_exp_f32 v124, v124
v_smfmac_f32_16x16x64_bf16 a[132:135], a[240:243], v[176:183], v5
ds_read_b128 a[164:167], v3 offset:10240
v_smfmac_f32_16x16x64_bf16 a[136:139], a[240:243], v[200:207], v5
ds_read_b128 a[168:171], v3 offset:3072
v_accvgpr_read_b32 v240, a24
v_smfmac_f32_16x16x64_bf16 a[140:143], a[240:243], v[208:215], v5
v_cvt_pk_bf16_f32 v185, v122, v123
v_mfma_f32_16x16x32_bf16 a[32:35], a[144:147], v[176:179], a[32:35]
s_waitcnt lgkmcnt(2)
v_exp_f32 v125, v125
v_mfma_f32_16x16x32_bf16 a[32:35], a[148:151], v[180:183], a[32:35]
ds_read_b128 a[172:175], v3 offset:11264
v_accvgpr_read_b32 v241, a25
v_mfma_f32_16x16x32_bf16 a[64:67], a[148:151], v[204:207], a[64:67]
ds_read_b128 a[176:179], v3 offset:4096
v_accvgpr_read_b32 v242, a26
v_mfma_f32_16x16x32_bf16 a[64:67], a[144:147], v[200:203], a[64:67]
v_cvt_pk_bf16_f32 v194, v140, v141
v_accvgpr_read_b32 v243, a27
v_mfma_f32_16x16x32_bf16 a[96:99], a[144:147], v[208:211], a[96:99]
ds_read_b128 a[180:183], v3 offset:12288
v_accvgpr_read_b32 v244, a28
v_mfma_f32_16x16x32_bf16 a[96:99], a[148:151], v[212:215], a[96:99]
ds_read_b128 a[184:187], v3 offset:5120
v_accvgpr_read_b32 v245, a29
v_mfma_f32_16x16x32_bf16 a[100:103], a[156:159], v[212:215], a[100:103]
ds_read_b128 a[188:191], v3 offset:13312
v_accvgpr_read_b32 v246, a30
v_mfma_f32_16x16x32_bf16 a[100:103], a[152:155], v[208:211], a[100:103]
ds_read_b128 a[192:195], v3 offset:6144
v_accvgpr_read_b32 v247, a31
v_mul_f32 v240, v240, v20
v_mul_f32 v241, v241, v20
v_mul_f32 v242, v242, v20
v_mul_f32 v243, v243, v20
v_mul_f32 v244, v244, v20
v_mul_f32 v245, v245, v20
v_mul_f32 v246, v246, v20
v_mul_f32 v247, v247, v20
v_cvt_pk_bf16_f32 v240, v240, v241
v_cvt_pk_bf16_f32 v241, v242, v243
v_cvt_pk_bf16_f32 v242, v244, v245
v_cvt_pk_bf16_f32 v243, v246, v247
s_add_u32 s77, s74, 24576
buffer_store_dwordx4 v[240:243], v16, s[44:47], s77 offen sc1
v_exp_f32 v126, v126
v_mfma_f32_16x16x32_bf16 a[68:71], a[152:155], v[200:203], a[68:71]
buffer_load_dwordx4 v16, s[32:35], s64 offen offset:2048 sc1 lds
v_cvt_pk_bf16_f32 v195, v142, v143
v_mfma_f32_16x16x32_bf16 a[68:71], a[156:159], v[204:207], a[68:71]
v_exp_f32 v127, v127
v_mfma_f32_16x16x32_bf16 a[36:39], a[156:159], v[180:183], a[36:39]
v_exp_f32 v128, v128
v_mfma_f32_16x16x32_bf16 a[36:39], a[152:155], v[176:179], a[36:39]
v_exp_f32 v129, v129
v_mfma_f32_16x16x32_bf16 a[40:43], a[160:163], v[176:179], a[40:43]
s_waitcnt lgkmcnt(1)
v_cvt_pk_bf16_f32 v186, v124, v125
v_cvt_pk_bf16_f32 v187, v126, v127
v_mfma_f32_16x16x32_bf16 a[40:43], a[164:167], v[180:183], a[40:43]
v_exp_f32 v130, v130
v_mfma_f32_16x16x32_bf16 a[72:75], a[164:167], v[204:207], a[72:75]
buffer_load_dwordx4 v16, s[32:35], s64 offen offset:3072 sc1 lds
v_mfma_f32_16x16x32_bf16 a[72:75], a[160:163], v[200:203], a[72:75]
v_exp_f32 v131, v131
v_mfma_f32_16x16x32_bf16 a[104:107], a[160:163], v[208:211], a[104:107]
v_exp_f32 v144, v144
v_mfma_f32_16x16x32_bf16 a[104:107], a[164:167], v[212:215], a[104:107]
v_exp_f32 v145, v145
v_mfma_f32_16x16x32_bf16 a[108:111], a[172:175], v[212:215], a[108:111]
v_exp_f32 v146, v146
v_mfma_f32_16x16x32_bf16 a[108:111], a[168:171], v[208:211], a[108:111]
ds_read_b128 a[196:199], v3 offset:14336
v_cvt_pk_bf16_f32 v188, v128, v129
v_mfma_f32_16x16x32_bf16 a[76:79], a[168:171], v[200:203], a[76:79]
ds_read_b128 a[200:203], v3 offset:7168
v_cvt_pk_bf16_f32 v189, v130, v131
v_mfma_f32_16x16x32_bf16 a[76:79], a[172:175], v[204:207], a[76:79]
ds_read_b128 a[204:207], v3 offset:15360
v_cvt_pk_bf16_f32 v196, v144, v145
v_mfma_f32_16x16x32_bf16 a[44:47], a[172:175], v[180:183], a[44:47]
v_exp_f32 v147, v147
v_mfma_f32_16x16x32_bf16 a[44:47], a[168:171], v[176:179], a[44:47]
v_exp_f32 v148, v148
v_mfma_f32_16x16x32_bf16 a[48:51], a[176:179], v[176:179], a[48:51]
v_exp_f32 v149, v149
v_mfma_f32_16x16x32_bf16 a[48:51], a[180:183], v[180:183], a[48:51]
v_exp_f32 v150, v150
v_mfma_f32_16x16x32_bf16 a[80:83], a[180:183], v[204:207], a[80:83]
s_waitcnt vmcnt(10)
s_barrier
v_mfma_f32_16x16x32_bf16 a[80:83], a[176:179], v[200:203], a[80:83]
v_exp_f32 v151, v151
v_mfma_f32_16x16x32_bf16 a[112:115], a[176:179], v[208:211], a[112:115]
v_exp_f32 v132, v132
v_mfma_f32_16x16x32_bf16 a[112:115], a[180:183], v[212:215], a[112:115]
v_exp_f32 v133, v133
v_mfma_f32_16x16x32_bf16 a[116:119], a[188:191], v[212:215], a[116:119]
ds_read_b128 a[144:147], v2 offset:16384
v_cvt_pk_bf16_f32 v197, v146, v147
v_mfma_f32_16x16x32_bf16 a[116:119], a[184:187], v[208:211], a[116:119]
v_exp_f32 v134, v134
v_mfma_f32_16x16x32_bf16 a[84:87], a[184:187], v[200:203], a[84:87]
s_waitcnt vmcnt(7)
v_readfirstlane_b32 vcc_lo, v19
s_nop 0
s_cmp_lt_u32 vcc_lo, s69
s_cbranch_scc1 L_spin_1012
L_spinbk_1013:
v_mfma_f32_16x16x32_bf16 a[84:87], a[188:191], v[204:207], a[84:87]
ds_read_b128 a[148:151], v2 offset:17408
v_cvt_pk_bf16_f32 v198, v148, v149
v_mfma_f32_16x16x32_bf16 a[52:55], a[188:191], v[180:183], a[52:55]
ds_read_b128 a[152:155], v2 offset:18432
v_cvt_pk_bf16_f32 v199, v150, v151
v_mfma_f32_16x16x32_bf16 a[52:55], a[184:187], v[176:179], a[52:55]
s_waitcnt lgkmcnt(3)
ds_read_b128 a[156:159], v2 offset:19456
v_cndmask_b32 v136, v228, v17, s[0:1]
v_mfma_f32_16x16x32_bf16 a[56:59], a[192:195], v[176:179], a[56:59]
ds_read_b128 a[160:163], v2 offset:20480
v_cndmask_b32 v137, v228, v17, s[4:5]
v_mfma_f32_16x16x32_bf16 a[56:59], a[196:199], v[180:183], a[56:59]
ds_read_b128 a[164:167], v2 offset:21504
v_cndmask_b32 v138, v228, v17, s[6:7]
v_mfma_f32_16x16x32_bf16 a[88:91], a[196:199], v[204:207], a[88:91]
ds_read_b128 a[168:171], v2 offset:22528
v_cndmask_b32 v139, v228, v17, s[8:9]
v_mfma_f32_16x16x32_bf16 a[88:91], a[192:195], v[200:203], a[88:91]
v_exp_f32 v135, v135
v_mfma_f32_16x16x32_bf16 a[120:123], a[192:195], v[208:211], a[120:123]
ds_read_b128 a[172:175], v2 offset:23552
v_cvt_pk_bf16_f32 v190, v132, v133
v_mfma_f32_16x16x32_bf16 a[120:123], a[196:199], v[212:215], a[120:123]
v_cndmask_b32 v140, v228, v17, s[10:11]
v_cvt_pk_bf16_f32 v191, v134, v135
v_mfma_f32_16x16x32_bf16 a[124:127], a[204:207], v[212:215], a[124:127]
v_cndmask_b32 v141, v228, v17, s[12:13]
v_cndmask_b32 v142, v228, v17, s[18:19]
v_mfma_f32_16x16x32_bf16 a[124:127], a[200:203], v[208:211], a[124:127]
v_cndmask_b32 v143, v228, v17, s[22:23]
v_cndmask_b32 v144, v228, v17, s[26:27]
v_mfma_f32_16x16x32_bf16 a[92:95], a[200:203], v[200:203], a[92:95]
v_cndmask_b32 v145, v228, v17, s[56:57]
v_cndmask_b32 v146, v228, v17, s[58:59]
v_mfma_f32_16x16x32_bf16 a[92:95], a[204:207], v[204:207], a[92:95]
v_cndmask_b32 v147, v228, v17, s[60:61]
v_cndmask_b32 v148, v228, v17, s[62:63]
v_mfma_f32_16x16x32_bf16 a[60:63], a[204:207], v[180:183], a[60:63]
v_cndmask_b32 v149, v228, v17, s[48:49]
v_cndmask_b32 v150, v228, v17, s[50:51]
v_mfma_f32_16x16x32_bf16 a[60:63], a[200:203], v[176:179], a[60:63]
s_waitcnt lgkmcnt(0)
v_cndmask_b32 v151, v228, v17, s[100:101]
v_accvgpr_read_b32 v21, a132
v_mfma_f32_16x16x32_bf16 v[136:139], a[144:147], v[72:75], v[136:139]
ds_read_b128 a[176:179], v2 offset:24576
v_accvgpr_read_b32 v248, a133
v_mfma_f32_16x16x32_bf16 v[136:139], a[148:151], v[76:79], v[136:139]
ds_read_b128 a[180:183], v2 offset:25600
v_add_f32 v21, v21, v248
v_mfma_f32_16x16x32_bf16 v[136:139], a[152:155], v[80:83], v[136:139]
ds_read_b128 a[184:187], v2 offset:26624
v_max_f32 v1, v1, v21
v_mfma_f32_16x16x32_bf16 v[136:139], a[156:159], v[84:87], v[136:139]
ds_read_b128 a[188:191], v2 offset:27648
ds_read_b128 a[192:195], v2 offset:28672
v_mfma_f32_16x16x32_bf16 v[140:143], a[172:175], v[84:87], v[140:143]
ds_read_b128 a[196:199], v2 offset:29696
ds_read_b128 a[200:203], v2 offset:30720
ds_read_b128 a[204:207], v2 offset:31744
v_mfma_f32_16x16x32_bf16 v[140:143], a[168:171], v[80:83], v[140:143]
v_rcp_f32 v21, v21
v_mfma_f32_16x16x32_bf16 v[140:143], a[164:167], v[76:79], v[140:143]
ds_read_b128 a[144:147], v3 offset:16384
v_accvgpr_read_b32 v232, a32
v_mfma_f32_16x16x32_bf16 v[140:143], a[160:163], v[72:75], v[140:143]
s_waitcnt lgkmcnt(7)
ds_read_b128 a[148:151], v3 offset:24576
v_accvgpr_read_b32 v233, a33
v_mfma_f32_16x16x32_bf16 v[144:147], a[176:179], v[72:75], v[144:147]
ds_read_b128 a[152:155], v3 offset:17408
v_accvgpr_read_b32 v234, a34
v_mfma_f32_16x16x32_bf16 v[144:147], a[180:183], v[76:79], v[144:147]
s_waitcnt lgkmcnt(6)
ds_read_b128 a[156:159], v3 offset:25600
v_accvgpr_read_b32 v235, a35
v_mfma_f32_16x16x32_bf16 v[144:147], a[184:187], v[80:83], v[144:147]
ds_read_b128 a[160:163], v3 offset:18432
v_accvgpr_read_b32 v236, a36
v_accvgpr_read_b32 v237, a37
v_accvgpr_read_b32 v238, a38
v_accvgpr_read_b32 v239, a39
v_mul_f32 v21, v21, v6
v_mul_f32 v232, v232, v21
v_mul_f32 v233, v233, v21
v_mul_f32 v234, v234, v21
v_mul_f32 v235, v235, v21
v_mul_f32 v236, v236, v21
v_mul_f32 v237, v237, v21
v_mul_f32 v238, v238, v21
v_mul_f32 v239, v239, v21
v_cvt_pk_bf16_f32 v232, v232, v233
v_cvt_pk_bf16_f32 v233, v234, v235
v_cvt_pk_bf16_f32 v234, v236, v237
v_cvt_pk_bf16_f32 v235, v238, v239
s_add_u32 s77, s74, 4096
buffer_store_dwordx4 v[232:235], v16, s[44:47], s77 offen sc1
v_accvgpr_read_b32 v240, a40
v_accvgpr_read_b32 v241, a41
v_accvgpr_read_b32 v242, a42
v_accvgpr_read_b32 v243, a43
v_accvgpr_read_b32 v244, a44
v_accvgpr_read_b32 v245, a45
v_accvgpr_read_b32 v246, a46
v_accvgpr_read_b32 v247, a47
v_mul_f32 v240, v240, v21
v_mul_f32 v241, v241, v21
v_mul_f32 v242, v242, v21
v_mul_f32 v243, v243, v21
v_mul_f32 v244, v244, v21
v_mul_f32 v245, v245, v21
v_mul_f32 v246, v246, v21
v_mul_f32 v247, v247, v21
v_cvt_pk_bf16_f32 v240, v240, v241
v_cvt_pk_bf16_f32 v241, v242, v243
v_cvt_pk_bf16_f32 v242, v244, v245
v_cvt_pk_bf16_f32 v243, v246, v247
s_add_u32 s77, s74, 12288
s_branch L_po29
L_pg29:
s_branch L_tr4
L_po29:
buffer_store_dwordx4 v[240:243], v16, s[44:47], s77 offen sc1
v_accvgpr_read_b32 v232, a48
v_accvgpr_read_b32 v233, a49
v_accvgpr_read_b32 v234, a50
v_accvgpr_read_b32 v235, a51
v_accvgpr_read_b32 v236, a52
v_accvgpr_read_b32 v237, a53
v_accvgpr_read_b32 v238, a54
v_accvgpr_read_b32 v239, a55
v_mul_f32 v232, v232, v21
v_mul_f32 v233, v233, v21
v_mul_f32 v234, v234, v21
v_mul_f32 v235, v235, v21
v_mul_f32 v236, v236, v21
v_mul_f32 v237, v237, v21
v_mul_f32 v238, v238, v21
v_mul_f32 v239, v239, v21
v_cvt_pk_bf16_f32 v232, v232, v233
v_cvt_pk_bf16_f32 v233, v234, v235
v_cvt_pk_bf16_f32 v234, v236, v237
v_cvt_pk_bf16_f32 v235, v238, v239
s_add_u32 s77, s74, 20480
buffer_store_dwordx4 v[232:235], v16, s[44:47], s77 offen sc1
v_accvgpr_read_b32 v240, a56
v_accvgpr_read_b32 v241, a57
v_accvgpr_read_b32 v242, a58
v_accvgpr_read_b32 v243, a59
v_accvgpr_read_b32 v244, a60
v_accvgpr_read_b32 v245, a61
v_accvgpr_read_b32 v246, a62
v_accvgpr_read_b32 v247, a63
v_mul_f32 v240, v240, v21
v_mul_f32 v241, v241, v21
v_mul_f32 v242, v242, v21
v_mul_f32 v243, v243, v21
v_mul_f32 v244, v244, v21
v_mul_f32 v245, v245, v21
v_mul_f32 v246, v246, v21
v_mul_f32 v247, v247, v21
v_cvt_pk_bf16_f32 v240, v240, v241
v_cvt_pk_bf16_f32 v241, v242, v243
v_cvt_pk_bf16_f32 v242, v244, v245
v_cvt_pk_bf16_f32 v243, v246, v247
s_add_u32 s77, s74, 28672
buffer_store_dwordx4 v[240:243], v16, s[44:47], s77 offen sc1
v_exp_f32 v136, v136
v_mfma_f32_16x16x32_bf16 v[144:147], a[188:191], v[84:87], v[144:147]
s_waitcnt lgkmcnt(5)
v_exp_f32 v137, v137
v_mfma_f32_16x16x32_bf16 v[148:151], a[204:207], v[84:87], v[148:151]
v_exp_f32 v138, v138
v_mfma_f32_16x16x32_bf16 v[148:151], a[200:203], v[80:83], v[148:151]
s_add_u32 s65, s84, 0
v_exp_f32 v139, v139
v_mfma_f32_16x16x32_bf16 v[148:151], a[196:199], v[76:79], v[148:151]
buffer_load_dwordx4 a[208:211], v14, s[44:47], s65 offen offset:0 sc1
v_mfma_f32_16x16x32_bf16 v[148:151], a[192:195], v[72:75], v[148:151]
ds_read_b128 a[164:167], v3 offset:26624
v_cvt_pk_bf16_f32 v208, v136, v137
v_smfmac_f32_16x16x64_bf16 a[136:139], a[240:243], v[184:191], v5
ds_read_b128 a[168:171], v3 offset:19456
v_smfmac_f32_16x16x64_bf16 a[140:143], a[240:243], v[192:199], v5
s_waitcnt lgkmcnt(2)
ds_read_b128 a[172:175], v3 offset:27648
v_mfma_f32_16x16x32_bf16 a[64:67], a[144:147], v[184:187], a[64:67]
v_exp_f32 v140, v140
v_mfma_f32_16x16x32_bf16 a[64:67], a[148:151], v[188:191], a[64:67]
buffer_load_dwordx4 a[216:219], v14, s[44:47], s65 offen offset:1024 sc1
v_mfma_f32_16x16x32_bf16 a[96:99], a[148:151], v[196:199], a[96:99]
v_exp_f32 v141, v141
v_mfma_f32_16x16x32_bf16 a[96:99], a[144:147], v[192:195], a[96:99]
buffer_load_dwordx4 a[224:227], v15, s[44:47], s65 offen offset:0 sc1
v_mfma_f32_16x16x32_bf16 a[100:103], a[152:155], v[192:195], a[100:103]
v_exp_f32 v142, v142
v_mfma_f32_16x16x32_bf16 a[100:103], a[156:159], v[196:199], a[100:103]
buffer_load_dwordx4 a[232:235], v15, s[44:47], s65 offen offset:1024 sc1
v_mfma_f32_16x16x32_bf16 a[68:71], a[156:159], v[188:191], a[68:71]
s_add_u32 s65, s84, 8192
ds_read_b128 a[176:179], v3 offset:20480
v_cvt_pk_bf16_f32 v209, v138, v139
v_mfma_f32_16x16x32_bf16 a[68:71], a[152:155], v[184:187], a[68:71]
buffer_load_dwordx4 a[212:215], v14, s[44:47], s65 offen offset:0 sc1
v_mfma_f32_16x16x32_bf16 a[72:75], a[160:163], v[184:187], a[72:75]
s_waitcnt lgkmcnt(1)
ds_read_b128 a[180:183], v3 offset:28672
v_cvt_pk_bf16_f32 v210, v140, v141
v_mfma_f32_16x16x32_bf16 a[72:75], a[164:167], v[188:191], a[72:75]
v_exp_f32 v143, v143
v_mfma_f32_16x16x32_bf16 a[104:107], a[164:167], v[196:199], a[104:107]
buffer_load_dwordx4 a[220:223], v14, s[44:47], s65 offen offset:1024 sc1
v_mfma_f32_16x16x32_bf16 a[104:107], a[160:163], v[192:195], a[104:107]
v_exp_f32 v144, v144
v_mfma_f32_16x16x32_bf16 a[108:111], a[168:171], v[192:195], a[108:111]
ds_read_b128 a[184:187], v3 offset:21504
v_xor_b32 v2, 0x8000, v2
v_mfma_f32_16x16x32_bf16 a[108:111], a[172:175], v[196:199], a[108:111]
buffer_load_dwordx4 a[228:231], v15, s[44:47], s65 offen offset:0 sc1
ds_read_b128 a[188:191], v3 offset:29696
v_mfma_f32_16x16x32_bf16 a[76:79], a[172:175], v[188:191], a[76:79]
v_exp_f32 v145, v145
v_mfma_f32_16x16x32_bf16 a[76:79], a[168:171], v[184:187], a[76:79]
s_waitcnt lgkmcnt(2)
buffer_load_dwordx4 a[236:239], v15, s[44:47], s65 offen offset:1024 sc1
v_mfma_f32_16x16x32_bf16 a[80:83], a[176:179], v[184:187], a[80:83]
s_add_u32 s65, s84, 32768
ds_read_b128 a[192:195], v3 offset:22528
v_cvt_pk_bf16_f32 v211, v142, v143
v_mfma_f32_16x16x32_bf16 a[80:83], a[180:183], v[188:191], a[80:83]
buffer_load_dwordx4 v[152:155], v14, s[44:47], s65 offen offset:0 sc1
ds_read_b128 a[196:199], v3 offset:30720
v_exp_f32 v146, v146
v_mfma_f32_16x16x32_bf16 a[112:115], a[180:183], v[196:199], a[112:115]
ds_read_b128 a[200:203], v3 offset:23552
ds_read_b128 a[204:207], v3 offset:31744
v_mfma_f32_16x16x32_bf16 a[112:115], a[176:179], v[192:195], a[112:115]
s_waitcnt vmcnt(13)
s_barrier
v_xor_b32 v3, 0x8000, v3
buffer_load_dwordx4 v[160:163], v14, s[44:47], s65 offen offset:1024 sc1
s_waitcnt lgkmcnt(4)
v_mfma_f32_16x16x32_bf16 a[116:119], a[184:187], v[192:195], a[116:119]
v_exp_f32 v147, v147
v_mfma_f32_16x16x32_bf16 a[116:119], a[188:191], v[196:199], a[116:119]
buffer_load_dwordx4 v[168:171], v15, s[44:47], s65 offen offset:0 sc1
v_mfma_f32_16x16x32_bf16 a[84:87], a[188:191], v[188:191], a[84:87]
v_exp_f32 v148, v148
v_mfma_f32_16x16x32_bf16 a[84:87], a[184:187], v[184:187], a[84:87]
s_waitcnt lgkmcnt(2)
buffer_load_dwordx4 v[176:179], v15, s[44:47], s65 offen offset:1024 sc1
v_cvt_pk_bf16_f32 v212, v144, v145
v_mfma_f32_16x16x32_bf16 a[88:91], a[192:195], v[184:187], a[88:91]
s_add_u32 s65, s84, 40960
v_exp_f32 v149, v149
v_mfma_f32_16x16x32_bf16 a[88:91], a[196:199], v[188:191], a[88:91]
buffer_load_dwordx4 v[156:159], v14, s[44:47], s65 offen offset:0 sc1
v_mfma_f32_16x16x32_bf16 a[120:123], a[196:199], v[196:199], a[120:123]
ds_read_b128 a[144:147], v3 offset:0
v_cvt_pk_bf16_f32 v213, v146, v147
v_mfma_f32_16x16x32_bf16 a[120:123], a[192:195], v[192:195], a[120:123]
s_waitcnt lgkmcnt(1)
buffer_load_dwordx4 v[164:167], v14, s[44:47], s65 offen offset:1024 sc1
ds_read_b128 a[148:151], v3 offset:8192
v_exp_f32 v150, v150
v_mfma_f32_16x16x32_bf16 a[124:127], a[200:203], v[192:195], a[124:127]
ds_read_b128 a[152:155], v3 offset:1024
v_cvt_pk_bf16_f32 v214, v148, v149
v_mfma_f32_16x16x32_bf16 a[124:127], a[204:207], v[196:199], a[124:127]
buffer_load_dwordx4 v[172:175], v15, s[44:47], s65 offen offset:0 sc1
ds_read_b128 a[156:159], v3 offset:9216
v_mfma_f32_16x16x32_bf16 a[92:95], a[204:207], v[188:191], a[92:95]
v_exp_f32 v151, v151
v_mfma_f32_16x16x32_bf16 a[92:95], a[200:203], v[184:187], a[92:95]
buffer_load_dwordx4 v[180:183], v15, s[44:47], s65 offen offset:1024 sc1
ds_read_b128 a[160:163], v3 offset:2048
ds_read_b128 a[164:167], v3 offset:10240
ds_read_b128 a[168:171], v3 offset:3072
ds_read_b128 a[172:175], v3 offset:11264
v_cvt_pk_bf16_f32 v215, v150, v151
v_accvgpr_read_b32 v22, a136
v_accvgpr_read_b32 v248, a137
v_add_f32 v22, v22, v248
v_max_f32 v1, v1, v22
v_rcp_f32 v22, v22
v_accvgpr_read_b32 v232, a64
v_accvgpr_read_b32 v233, a65
v_accvgpr_read_b32 v234, a66
v_accvgpr_read_b32 v235, a67
v_accvgpr_read_b32 v236, a68
v_accvgpr_read_b32 v237, a69
v_accvgpr_read_b32 v238, a70
v_accvgpr_read_b32 v239, a71
v_mul_f32 v22, v22, v8
v_mul_f32 v232, v232, v22
v_mul_f32 v233, v233, v22
v_mul_f32 v234, v234, v22
v_mul_f32 v235, v235, v22
v_mul_f32 v236, v236, v22
v_mul_f32 v237, v237, v22
v_mul_f32 v238, v238, v22
v_mul_f32 v239, v239, v22
v_cvt_pk_bf16_f32 v232, v232, v233
v_cvt_pk_bf16_f32 v233, v234, v235
v_cvt_pk_bf16_f32 v234, v236, v237
v_cvt_pk_bf16_f32 v235, v238, v239
s_add_u32 s77, s75, 0
buffer_store_dwordx4 v[232:235], v16, s[44:47], s77 offen sc1
s_branch L_TAIL
L_fallback_11:
s_waitcnt vmcnt(0) lgkmcnt(0)
s_barrier
s_mov_b32 s73, 1
s_mov_b32 s81, 0
v_and_b32 v232, 15, v0
v_lshrrev_b32 v233, 4, v0
v_lshlrev_b32 v233, 2, v233
v_sub_u32 v232, v232, v233
s_lshl_b32 s66, s30, 4
v_add_u32 v232, s66, v232
s_lshl_b32 s66, s16, 7
v_add_u32 v234, s66, v232
s_lshl_b32 s66, s3, 7
v_add_u32 v232, s66, v232
v_add_u32 v233, 64, v232
v_add_u32 v235, 64, v234
s_mov_b32 m0, s76
s_lshl_b32 s64, s30, 14
s_nop 0
buffer_load_dwordx4 v16, s[32:35], s64 offen offset:0 sc1 lds
s_nop 0
buffer_load_dwordx4 v16, s[32:35], s64 offen offset:1024 sc1 lds
s_nop 0
buffer_load_dwordx4 v16, s[32:35], s64 offen offset:2048 sc1 lds
s_nop 0
buffer_load_dwordx4 v16, s[32:35], s64 offen offset:3072 sc1 lds
s_add_u32 m0, s76, 4096
s_add_u32 s64, s64, 4096
s_nop 0
buffer_load_dwordx4 v16, s[32:35], s64 offen offset:0 sc1 lds
s_nop 0
buffer_load_dwordx4 v16, s[32:35], s64 offen offset:1024 sc1 lds
s_nop 0
buffer_load_dwordx4 v16, s[32:35], s64 offen offset:2048 sc1 lds
s_nop 0
buffer_load_dwordx4 v16, s[32:35], s64 offen offset:3072 sc1 lds
s_lshr_b32 s64, s76, 1
s_add_u32 m0, s64, 81920
s_and_b32 s71, s64, 8192
s_add_u32 s64, s64, s71
s_add_u32 s64, s64, 8192
s_nop 0
buffer_load_dwordx4 v16, s[32:35], s64 offen offset:0 sc1 lds
s_nop 0
buffer_load_dwordx4 v16, s[32:35], s64 offen offset:1024 sc1 lds
s_nop 0
buffer_load_dwordx4 v16, s[32:35], s64 offen offset:2048 sc1 lds
s_nop 0
buffer_load_dwordx4 v16, s[32:35], s64 offen offset:3072 sc1 lds
v_mov_b32 v20, 0xff800000
v_mov_b32 v21, 0xff800000
v_mov_b32 v22, 0xff800000
v_mov_b32 v23, 0xff800000
L_fbl_1015:
buffer_load_dwordx4 a[144:147], v16, s[32:35], s81 offen offset:0 sc1
buffer_load_dwordx4 a[148:151], v16, s[32:35], s81 offen offset:1024 sc1
buffer_load_dwordx4 a[152:155], v16, s[32:35], s81 offen offset:2048 sc1
buffer_load_dwordx4 a[156:159], v16, s[32:35], s81 offen offset:3072 sc1
s_add_u32 s64, s81, 4096
buffer_load_dwordx4 a[160:163], v16, s[32:35], s64 offen offset:0 sc1
buffer_load_dwordx4 a[164:167], v16, s[32:35], s64 offen offset:1024 sc1
buffer_load_dwordx4 a[168:171], v16, s[32:35], s64 offen offset:2048 sc1
buffer_load_dwordx4 a[172:175], v16, s[32:35], s64 offen offset:3072 sc1
v_subrev_u32 v88, 0, v232
v_ashrrev_i32 v88, 31, v88
v_and_b32 v88, 0xff800000, v88
v_subrev_u32 v89, 1, v232
v_ashrrev_i32 v89, 31, v89
v_and_b32 v89, 0xff800000, v89
v_subrev_u32 v90, 2, v232
v_ashrrev_i32 v90, 31, v90
v_and_b32 v90, 0xff800000, v90
v_subrev_u32 v91, 3, v232
v_ashrrev_i32 v91, 31, v91
v_and_b32 v91, 0xff800000, v91
v_subrev_u32 v92, 16, v232
v_ashrrev_i32 v92, 31, v92
v_and_b32 v92, 0xff800000, v92
v_subrev_u32 v93, 17, v232
v_ashrrev_i32 v93, 31, v93
v_and_b32 v93, 0xff800000, v93
v_subrev_u32 v94, 18, v232
v_ashrrev_i32 v94, 31, v94
v_and_b32 v94, 0xff800000, v94
v_subrev_u32 v95, 19, v232
v_ashrrev_i32 v95, 31, v95
v_and_b32 v95, 0xff800000, v95
v_subrev_u32 v232, 32, v232
v_subrev_u32 v104, 0, v233
v_ashrrev_i32 v104, 31, v104
v_and_b32 v104, 0xff800000, v104
v_subrev_u32 v105, 1, v233
v_ashrrev_i32 v105, 31, v105
v_and_b32 v105, 0xff800000, v105
v_subrev_u32 v106, 2, v233
v_ashrrev_i32 v106, 31, v106
v_and_b32 v106, 0xff800000, v106
v_subrev_u32 v107, 3, v233
v_ashrrev_i32 v107, 31, v107
v_and_b32 v107, 0xff800000, v107
v_subrev_u32 v108, 16, v233
v_ashrrev_i32 v108, 31, v108
v_and_b32 v108, 0xff800000, v108
v_subrev_u32 v109, 17, v233
v_ashrrev_i32 v109, 31, v109
v_and_b32 v109, 0xff800000, v109
v_subrev_u32 v110, 18, v233
v_ashrrev_i32 v110, 31, v110
v_and_b32 v110, 0xff800000, v110
v_subrev_u32 v111, 19, v233
v_ashrrev_i32 v111, 31, v111
v_and_b32 v111, 0xff800000, v111
v_subrev_u32 v233, 32, v233
v_subrev_u32 v120, 0, v234
v_ashrrev_i32 v120, 31, v120
v_and_b32 v120, 0xff800000, v120
v_subrev_u32 v121, 1, v234
v_ashrrev_i32 v121, 31, v121
v_and_b32 v121, 0xff800000, v121
v_subrev_u32 v122, 2, v234
v_ashrrev_i32 v122, 31, v122
v_and_b32 v122, 0xff800000, v122
v_subrev_u32 v123, 3, v234
v_ashrrev_i32 v123, 31, v123
v_and_b32 v123, 0xff800000, v123
v_subrev_u32 v124, 16, v234
v_ashrrev_i32 v124, 31, v124
v_and_b32 v124, 0xff800000, v124
v_subrev_u32 v125, 17, v234
v_ashrrev_i32 v125, 31, v125
v_and_b32 v125, 0xff800000, v125
v_subrev_u32 v126, 18, v234
v_ashrrev_i32 v126, 31, v126
v_and_b32 v126, 0xff800000, v126
v_subrev_u32 v127, 19, v234
v_ashrrev_i32 v127, 31, v127
v_and_b32 v127, 0xff800000, v127
v_subrev_u32 v234, 32, v234
v_subrev_u32 v136, 0, v235
v_ashrrev_i32 v136, 31, v136
v_and_b32 v136, 0xff800000, v136
v_subrev_u32 v137, 1, v235
v_ashrrev_i32 v137, 31, v137
v_and_b32 v137, 0xff800000, v137
v_subrev_u32 v138, 2, v235
v_ashrrev_i32 v138, 31, v138
v_and_b32 v138, 0xff800000, v138
v_subrev_u32 v139, 3, v235
v_ashrrev_i32 v139, 31, v139
v_and_b32 v139, 0xff800000, v139
v_subrev_u32 v140, 16, v235
v_ashrrev_i32 v140, 31, v140
v_and_b32 v140, 0xff800000, v140
v_subrev_u32 v141, 17, v235
v_ashrrev_i32 v141, 31, v141
v_and_b32 v141, 0xff800000, v141
v_subrev_u32 v142, 18, v235
v_ashrrev_i32 v142, 31, v142
v_and_b32 v142, 0xff800000, v142
v_subrev_u32 v143, 19, v235
v_ashrrev_i32 v143, 31, v143
v_and_b32 v143, 0xff800000, v143
v_subrev_u32 v235, 32, v235
s_waitcnt vmcnt(0)
v_mfma_f32_16x16x32_bf16 v[88:91], a[144:147], v[24:27], v[88:91]
v_mfma_f32_16x16x32_bf16 v[104:107], a[144:147], v[40:43], v[104:107]
v_mfma_f32_16x16x32_bf16 v[120:123], a[144:147], v[56:59], v[120:123]
v_mfma_f32_16x16x32_bf16 v[136:139], a[144:147], v[72:75], v[136:139]
v_mfma_f32_16x16x32_bf16 v[88:91], a[148:151], v[28:31], v[88:91]
v_mfma_f32_16x16x32_bf16 v[104:107], a[148:151], v[44:47], v[104:107]
v_mfma_f32_16x16x32_bf16 v[120:123], a[148:151], v[60:63], v[120:123]
v_mfma_f32_16x16x32_bf16 v[136:139], a[148:151], v[76:79], v[136:139]
v_mfma_f32_16x16x32_bf16 v[88:91], a[152:155], v[32:35], v[88:91]
v_mfma_f32_16x16x32_bf16 v[104:107], a[152:155], v[48:51], v[104:107]
v_mfma_f32_16x16x32_bf16 v[120:123], a[152:155], v[64:67], v[120:123]
v_mfma_f32_16x16x32_bf16 v[136:139], a[152:155], v[80:83], v[136:139]
v_mfma_f32_16x16x32_bf16 v[88:91], a[156:159], v[36:39], v[88:91]
v_mfma_f32_16x16x32_bf16 v[104:107], a[156:159], v[52:55], v[104:107]
v_mfma_f32_16x16x32_bf16 v[120:123], a[156:159], v[68:71], v[120:123]
v_mfma_f32_16x16x32_bf16 v[136:139], a[156:159], v[84:87], v[136:139]
v_mfma_f32_16x16x32_bf16 v[92:95], a[160:163], v[24:27], v[92:95]
v_mfma_f32_16x16x32_bf16 v[108:111], a[160:163], v[40:43], v[108:111]
v_mfma_f32_16x16x32_bf16 v[124:127], a[160:163], v[56:59], v[124:127]
v_mfma_f32_16x16x32_bf16 v[140:143], a[160:163], v[72:75], v[140:143]
v_mfma_f32_16x16x32_bf16 v[92:95], a[164:167], v[28:31], v[92:95]
v_mfma_f32_16x16x32_bf16 v[108:111], a[164:167], v[44:47], v[108:111]
v_mfma_f32_16x16x32_bf16 v[124:127], a[164:167], v[60:63], v[124:127]
v_mfma_f32_16x16x32_bf16 v[140:143], a[164:167], v[76:79], v[140:143]
v_mfma_f32_16x16x32_bf16 v[92:95], a[168:171], v[32:35], v[92:95]
v_mfma_f32_16x16x32_bf16 v[108:111], a[168:171], v[48:51], v[108:111]
v_mfma_f32_16x16x32_bf16 v[124:127], a[168:171], v[64:67], v[124:127]
v_mfma_f32_16x16x32_bf16 v[140:143], a[168:171], v[80:83], v[140:143]
v_mfma_f32_16x16x32_bf16 v[92:95], a[172:175], v[36:39], v[92:95]
v_mfma_f32_16x16x32_bf16 v[108:111], a[172:175], v[52:55], v[108:111]
v_mfma_f32_16x16x32_bf16 v[124:127], a[172:175], v[68:71], v[124:127]
v_mfma_f32_16x16x32_bf16 v[140:143], a[172:175], v[84:87], v[140:143]
s_nop 7
v_max3_f32 v20, v20, v88, v89
v_max3_f32 v20, v20, v90, v91
v_max3_f32 v20, v20, v92, v93
v_max3_f32 v20, v20, v94, v95
v_max3_f32 v21, v21, v104, v105
v_max3_f32 v21, v21, v106, v107
v_max3_f32 v21, v21, v108, v109
v_max3_f32 v21, v21, v110, v111
v_max3_f32 v22, v22, v120, v121
v_max3_f32 v22, v22, v122, v123
v_max3_f32 v22, v22, v124, v125
v_max3_f32 v22, v22, v126, v127
v_max3_f32 v23, v23, v136, v137
v_max3_f32 v23, v23, v138, v139
v_max3_f32 v23, v23, v140, v141
v_max3_f32 v23, v23, v142, v143
s_add_u32 s81, s81, 16384
s_cmp_lt_u32 s81, s34
s_cbranch_scc1 L_fbl_1015
v_mov_b32 v248, v20
v_mov_b32 v249, v21
v_mov_b32 v250, v22
v_mov_b32 v251, v23
v_permlane16_swap_b32 v248, v20
v_permlane16_swap_b32 v249, v21
v_permlane16_swap_b32 v250, v22
v_permlane16_swap_b32 v251, v23
v_max_f32 v20, v20, v248
v_max_f32 v21, v21, v249
v_max_f32 v22, v22, v250
v_max_f32 v23, v23, v251
v_mov_b32 v248, v20
v_mov_b32 v249, v21
v_mov_b32 v250, v22
v_mov_b32 v251, v23
v_permlane32_swap_b32 v248, v20
v_permlane32_swap_b32 v249, v21
v_permlane32_swap_b32 v250, v22
v_permlane32_swap_b32 v251, v23
v_max_f32 v20, v20, v248
v_max_f32 v21, v21, v249
v_max_f32 v22, v22, v250
v_max_f32 v23, v23, v251
v_mov_b32 v252, v20
v_mov_b32 v253, v21
v_mov_b32 v254, v22
v_mov_b32 v255, v23
s_and_b32 s70, s30, 1
s_lshr_b32 s67, s30, 1
s_lshl3_add_u32 s71, s67, s70
s_add_u32 s71, s71, 4
s_lshl_b32 s71, s71, 13
s_lshl_b32 s70, s70, 14
s_mul_i32 s67, s67, 24576
s_sub_u32 s70, s70, s67
s_add_u32 s70, s70, 65536
v_mov_b32 v2, v16
v_add_u32 v3, 0x10000, v16
v_mov_b32 v1, 0
s_mov_b32 m0, s71
s_waitcnt lgkmcnt(0)
s_barrier
ds_read_b128 a[144:147], v2 offset:0
ds_read_b128 a[148:151], v2 offset:1024
ds_read_b128 a[152:155], v2 offset:2048
ds_read_b128 a[156:159], v2 offset:3072
ds_read_b128 a[160:163], v2 offset:4096
ds_read_b128 a[164:167], v2 offset:5120
ds_read_b128 a[168:171], v2 offset:6144
ds_read_b128 a[172:175], v2 offset:7168
buffer_load_dwordx4 v16, s[32:35], s70 offen offset:0 sc1 lds
buffer_load_dwordx4 v16, s[32:35], s70 offen offset:1024 sc1 lds
s_waitcnt vmcnt(0) lgkmcnt(0)
s_branch L_attstart_7
L_spin_2016:
s_mov_b32 vcc_hi, 0x80000
L_spinlp_2018:
s_sleep 1
buffer_load_dword v19, off, s[52:55], s72 offset:0 sc1
s_waitcnt vmcnt(0)
v_readfirstlane_b32 vcc_lo, v19
s_sub_u32 vcc_hi, vcc_hi, 1
s_cbranch_scc1 L_spinbk_2017
s_cmp_lt_u32 vcc_lo, 8
s_cbranch_scc1 L_spinlp_2018
s_branch L_spinbk_2017
L_spin_3019:
s_mov_b32 vcc_hi, 0x80000
L_spinlp_3021:
s_sleep 1
buffer_load_dword v19, off, s[52:55], s72 offset:0 sc1
s_waitcnt vmcnt(0)
v_readfirstlane_b32 vcc_lo, v19
s_sub_u32 vcc_hi, vcc_hi, 1
s_cbranch_scc1 L_spinbk_3020
s_cmp_lt_u32 vcc_lo, 8
s_cbranch_scc1 L_spinlp_3021
s_branch L_spinbk_3020
.p2align 12
L_pg30:
s_branch L_tr2
L_p5f0:
s_waitcnt lgkmcnt(10)
s_waitcnt vmcnt(28)
v_mfma_f32_16x16x32_bf16 v[136:139], a[144:147], a[232:235], 0
s_waitcnt vmcnt(24)
s_waitcnt lgkmcnt(8)
s_add_u32 m0, s86, 65536
ds_read_b64_tr_b16 a[168:169], v191 offset:32768
v_xor_b32 v192, 0x10000, v184
v_mfma_f32_16x16x32_bf16 v[136:139], a[148:151], a[236:239], v[136:139]
s_add_u32 s64, s85, 524288
ds_read_b64_tr_b16 a[170:171], v191 offset:36864
v_xor_b32 v193, 0x10000, v185
v_mfma_f32_16x16x32_bf16 v[104:107], a[148:151], a[228:231], 0
buffer_load_dwordx4 v12, s[36:39], s64 offen lds
v_mfma_f32_16x16x32_bf16 v[104:107], a[144:147], a[224:227], v[104:107]
s_add_u32 m0, s86, 66560
s_add_u32 s64, s85, 532480
ds_read_b64_tr_b16 a[172:173], v191 offset:40960
v_xor_b32 v194, 0x10000, v186
v_mfma_f32_16x16x32_bf16 v[72:75], a[144:147], a[216:219], 0
buffer_load_dwordx4 v13, s[36:39], s64 offen lds
v_mfma_f32_16x16x32_bf16 v[72:75], a[148:151], a[220:223], v[72:75]
s_add_u32 m0, s86, 67584
ds_read_b64_tr_b16 a[174:175], v191 offset:45056
v_xor_b32 v195, 0x10000, v187
v_mfma_f32_16x16x32_bf16 v[40:43], a[148:151], a[212:215], 0
s_add_u32 s64, s85, 540672
ds_read_b64_tr_b16 a[176:177], v184 offset:32768
v_xor_b32 v196, 0x10000, v188
v_mfma_f32_16x16x32_bf16 v[40:43], a[144:147], a[208:211], v[40:43]
s_waitcnt lgkmcnt(5)
buffer_load_dwordx4 v12, s[36:39], s64 offen lds
v_mfma_f32_16x16x32_bf16 v[44:47], a[152:155], a[208:211], 0
s_add_u32 m0, s86, 68608
s_add_u32 s64, s85, 548864
ds_read_b64_tr_b16 a[178:179], v184 offset:36864
v_xor_b32 v197, 0x10000, v189
v_mfma_f32_16x16x32_bf16 v[44:47], a[156:159], a[212:215], v[44:47]
buffer_load_dwordx4 v13, s[36:39], s64 offen lds
v_mfma_f32_16x16x32_bf16 v[76:79], a[156:159], a[220:223], 0
s_add_u32 m0, s86, 69632
ds_read_b64_tr_b16 a[180:181], v184 offset:40960
v_xor_b32 v198, 0x10000, v190
v_mfma_f32_16x16x32_bf16 v[76:79], a[152:155], a[216:219], v[76:79]
s_add_u32 s64, s85, 557056
ds_read_b64_tr_b16 a[182:183], v184 offset:45056
v_xor_b32 v199, 0x10000, v191
v_mfma_f32_16x16x32_bf16 v[108:111], a[152:155], a[224:227], 0
buffer_load_dwordx4 v12, s[36:39], s64 offen lds
v_mfma_f32_16x16x32_bf16 v[108:111], a[156:159], a[228:231], v[108:111]
s_add_u32 m0, s86, 70656
s_add_u32 s64, s85, 565248
ds_read_b64_tr_b16 a[184:185], v185 offset:32768
v_mfma_f32_16x16x32_bf16 v[140:143], a[156:159], a[236:239], 0
buffer_load_dwordx4 v13, s[36:39], s64 offen lds
v_mfma_f32_16x16x32_bf16 v[140:143], a[152:155], a[232:235], v[140:143]
s_add_u32 m0, s86, 71680
ds_read_b64_tr_b16 a[186:187], v185 offset:36864
v_mfma_f32_16x16x32_bf16 v[144:147], a[160:163], a[232:235], 0
s_add_u32 s64, s85, 573440
ds_read_b64_tr_b16 a[188:189], v185 offset:40960
v_mfma_f32_16x16x32_bf16 v[144:147], a[164:167], a[236:239], v[144:147]
buffer_load_dwordx4 v12, s[36:39], s64 offen lds
v_mfma_f32_16x16x32_bf16 v[112:115], a[164:167], a[228:231], 0
s_and_b32 s71, s31, 4
s_lshl_b32 s71, s71, 5
s_add_u32 m0, s86, 72704
s_add_u32 s64, s85, 581632
ds_read_b64_tr_b16 a[190:191], v185 offset:45056
v_mfma_f32_16x16x32_bf16 v[112:115], a[160:163], a[224:227], v[112:115]
s_add_u32 s71, s71, s79
buffer_load_dwordx4 v13, s[36:39], s64 offen lds
v_mfma_f32_16x16x32_bf16 v[80:83], a[160:163], a[216:219], 0
s_add_u32 s71, s71, 4096
s_add_u32 s72, s80, 4096
ds_read_b64_tr_b16 a[192:193], v186 offset:32768
v_mfma_f32_16x16x32_bf16 v[80:83], a[164:167], a[220:223], v[80:83]
s_add_u32 s65, s84, 65536
ds_read_b64_tr_b16 a[194:195], v186 offset:36864
v_mfma_f32_16x16x32_bf16 v[48:51], a[164:167], a[212:215], 0
buffer_load_dwordx4 a[0:3], v14, s[44:47], s65 offen offset:0 sc1
v_mfma_f32_16x16x32_bf16 v[48:51], a[160:163], a[208:211], v[48:51]
s_waitcnt lgkmcnt(4)
ds_read_b64_tr_b16 a[196:197], v186 offset:40960
v_mfma_f32_16x16x32_bf16 v[52:55], a[168:171], a[208:211], 0
buffer_load_dwordx4 a[8:11], v14, s[44:47], s65 offen offset:1024 sc1
v_mfma_f32_16x16x32_bf16 v[52:55], a[172:175], a[212:215], v[52:55]
ds_read_b64_tr_b16 a[198:199], v186 offset:45056
v_mfma_f32_16x16x32_bf16 v[84:87], a[172:175], a[220:223], 0
ds_read_b64_tr_b16 a[200:201], v187 offset:32768
v_mfma_f32_16x16x32_bf16 v[84:87], a[168:171], a[216:219], v[84:87]
buffer_load_dwordx4 a[16:19], v15, s[44:47], s65 offen offset:0 sc1
v_mfma_f32_16x16x32_bf16 v[116:119], a[168:171], a[224:227], 0
ds_read_b64_tr_b16 a[202:203], v187 offset:36864
v_mfma_f32_16x16x32_bf16 v[116:119], a[172:175], a[228:231], v[116:119]
buffer_load_dwordx4 a[24:27], v15, s[44:47], s65 offen offset:1024 sc1
v_mfma_f32_16x16x32_bf16 v[148:151], a[172:175], a[236:239], 0
ds_read_b64_tr_b16 a[204:205], v187 offset:40960
v_mfma_f32_16x16x32_bf16 v[148:151], a[168:171], a[232:235], v[148:151]
s_add_u32 s65, s84, 73728
ds_read_b64_tr_b16 a[206:207], v187 offset:45056
v_mfma_f32_16x16x32_bf16 v[120:123], a[176:179], a[232:235], 0
buffer_load_dwordx4 a[4:7], v14, s[44:47], s65 offen offset:0 sc1
v_mfma_f32_16x16x32_bf16 v[120:123], a[180:183], a[236:239], v[120:123]
v_mfma_f32_16x16x32_bf16 v[88:91], a[180:183], a[228:231], 0
buffer_load_dwordx4 a[12:15], v14, s[44:47], s65 offen offset:1024 sc1
v_mfma_f32_16x16x32_bf16 v[88:91], a[176:179], a[224:227], v[88:91]
v_mfma_f32_16x16x32_bf16 v[56:59], a[176:179], a[216:219], 0
v_mfma_f32_16x16x32_bf16 v[56:59], a[180:183], a[220:223], v[56:59]
buffer_load_dwordx4 a[20:23], v15, s[44:47], s65 offen offset:0 sc1
v_mfma_f32_16x16x32_bf16 v[24:27], a[180:183], a[212:215], 0
v_mfma_f32_16x16x32_bf16 v[24:27], a[176:179], a[208:211], v[24:27]
buffer_load_dwordx4 a[28:31], v15, s[44:47], s65 offen offset:1024 sc1
v_mfma_f32_16x16x32_bf16 v[28:31], a[184:187], a[208:211], 0
s_waitcnt lgkmcnt(0)
v_mfma_f32_16x16x32_bf16 v[28:31], a[188:191], a[212:215], v[28:31]
v_mfma_f32_16x16x32_bf16 v[60:63], a[188:191], a[220:223], 0
v_mfma_f32_16x16x32_bf16 v[60:63], a[184:187], a[216:219], v[60:63]
s_waitcnt vmcnt(23)
s_barrier
v_mfma_f32_16x16x32_bf16 v[92:95], a[184:187], a[224:227], 0
ds_read_b64_tr_b16 a[144:145], v196 offset:0
v_mfma_f32_16x16x32_bf16 v[92:95], a[188:191], a[228:231], v[92:95]
ds_read_b64_tr_b16 a[146:147], v196 offset:4096
v_mfma_f32_16x16x32_bf16 v[124:127], a[188:191], a[236:239], 0
s_add_u32 m0, s86, 0
ds_read_b64_tr_b16 a[148:149], v196 offset:8192
v_mfma_f32_16x16x32_bf16 v[124:127], a[184:187], a[232:235], v[124:127]
s_add_u32 s64, s85, 786432
ds_read_b64_tr_b16 a[150:151], v196 offset:12288
v_mfma_f32_16x16x32_bf16 v[128:131], a[192:195], a[232:235], 0
buffer_load_dwordx4 v12, s[36:39], s64 offen lds
v_mfma_f32_16x16x32_bf16 v[128:131], a[196:199], a[236:239], v[128:131]
s_add_u32 m0, s86, 1024
ds_read_b64_tr_b16 a[152:153], v197 offset:0
v_mfma_f32_16x16x32_bf16 v[96:99], a[196:199], a[228:231], 0
s_add_u32 s64, s85, 794624
ds_read_b64_tr_b16 a[154:155], v197 offset:4096
v_mfma_f32_16x16x32_bf16 v[96:99], a[192:195], a[224:227], v[96:99]
buffer_load_dwordx4 v13, s[36:39], s64 offen lds
v_mfma_f32_16x16x32_bf16 v[64:67], a[192:195], a[216:219], 0
s_add_u32 m0, s86, 2048
ds_read_b64_tr_b16 a[156:157], v197 offset:8192
v_mfma_f32_16x16x32_bf16 v[64:67], a[196:199], a[220:223], v[64:67]
s_add_u32 s64, s85, 802816
ds_read_b64_tr_b16 a[158:159], v197 offset:12288
v_mfma_f32_16x16x32_bf16 v[32:35], a[196:199], a[212:215], 0
buffer_load_dwordx4 v12, s[36:39], s64 offen lds
v_mfma_f32_16x16x32_bf16 v[32:35], a[192:195], a[208:211], v[32:35]
s_add_u32 m0, s86, 3072
ds_read_b64_tr_b16 a[160:161], v198 offset:0
v_mfma_f32_16x16x32_bf16 v[36:39], a[200:203], a[208:211], 0
s_add_u32 s64, s85, 811008
ds_read_b64_tr_b16 a[162:163], v198 offset:4096
v_mfma_f32_16x16x32_bf16 v[36:39], a[204:207], a[212:215], v[36:39]
buffer_load_dwordx4 v13, s[36:39], s64 offen lds
v_mfma_f32_16x16x32_bf16 v[68:71], a[204:207], a[220:223], 0
s_add_u32 m0, s86, 4096
ds_read_b64_tr_b16 a[164:165], v198 offset:8192
v_mfma_f32_16x16x32_bf16 v[68:71], a[200:203], a[216:219], v[68:71]
s_add_u32 s64, s85, 819200
ds_read_b64_tr_b16 a[166:167], v198 offset:12288
v_mfma_f32_16x16x32_bf16 v[100:103], a[200:203], a[224:227], 0
buffer_load_dwordx4 v12, s[36:39], s64 offen lds
v_mfma_f32_16x16x32_bf16 v[100:103], a[204:207], a[228:231], v[100:103]
v_mfma_f32_16x16x32_bf16 v[132:135], a[204:207], a[236:239], 0
v_mfma_f32_16x16x32_bf16 v[132:135], a[200:203], a[232:235], v[132:135]
s_waitcnt lgkmcnt(3)
v_mfma_f32_16x16x32_bf16 v[136:139], a[144:147], v[176:179], v[136:139]
s_add_u32 m0, s86, 5120
ds_read_b64_tr_b16 a[168:169], v199 offset:0
v_xor_b32 v200, 0x18000, v184
v_mfma_f32_16x16x32_bf16 v[136:139], a[148:151], v[180:183], v[136:139]
s_add_u32 s64, s85, 827392
ds_read_b64_tr_b16 a[170:171], v199 offset:4096
v_xor_b32 v201, 0x18000, v185
v_mfma_f32_16x16x32_bf16 v[104:107], a[148:151], v[172:175], v[104:107]
buffer_load_dwordx4 v13, s[36:39], s64 offen lds
v_mfma_f32_16x16x32_bf16 v[104:107], a[144:147], v[168:171], v[104:107]
s_add_u32 m0, s86, 6144
ds_read_b64_tr_b16 a[172:173], v199 offset:8192
v_xor_b32 v202, 0x18000, v186
v_mfma_f32_16x16x32_bf16 v[72:75], a[144:147], v[160:163], v[72:75]
s_add_u32 s64, s85, 835584
ds_read_b64_tr_b16 a[174:175], v199 offset:12288
v_xor_b32 v203, 0x18000, v187
v_mfma_f32_16x16x32_bf16 v[72:75], a[148:151], v[164:167], v[72:75]
buffer_load_dwordx4 v12, s[36:39], s64 offen lds
v_mfma_f32_16x16x32_bf16 v[40:43], a[148:151], v[156:159], v[40:43]
ds_read_b64_tr_b16 a[176:177], v192 offset:0
v_xor_b32 v204, 0x18000, v188
v_mfma_f32_16x16x32_bf16 v[40:43], a[144:147], v[152:155], v[40:43]
s_add_u32 m0, s86, 7168
ds_read_b64_tr_b16 a[178:179], v192 offset:4096
v_xor_b32 v205, 0x18000, v189
v_mfma_f32_16x16x32_bf16 v[44:47], a[152:155], v[152:155], v[44:47]
s_add_u32 s64, s85, 843776
ds_read_b64_tr_b16 a[180:181], v192 offset:8192
v_xor_b32 v206, 0x18000, v190
v_mfma_f32_16x16x32_bf16 v[44:47], a[156:159], v[156:159], v[44:47]
buffer_load_dwordx4 v13, s[36:39], s64 offen lds
v_mfma_f32_16x16x32_bf16 v[76:79], a[156:159], v[164:167], v[76:79]
ds_read_b64_tr_b16 a[182:183], v192 offset:12288
v_xor_b32 v207, 0x18000, v191
v_mfma_f32_16x16x32_bf16 v[76:79], a[152:155], v[160:163], v[76:79]
s_add_u32 s65, s84, 98304
ds_read_b64_tr_b16 a[184:185], v193 offset:0
v_mfma_f32_16x16x32_bf16 v[108:111], a[152:155], v[168:171], v[108:111]
buffer_load_dwordx4 a[64:67], v14, s[44:47], s65 offen offset:0 sc1
v_mfma_f32_16x16x32_bf16 v[108:111], a[156:159], v[172:175], v[108:111]
ds_read_b64_tr_b16 a[186:187], v193 offset:4096
v_mfma_f32_16x16x32_bf16 v[140:143], a[156:159], v[180:183], v[140:143]
ds_read_b64_tr_b16 a[188:189], v193 offset:8192
v_mfma_f32_16x16x32_bf16 v[140:143], a[152:155], v[176:179], v[140:143]
s_waitcnt lgkmcnt(5)
ds_read_b64_tr_b16 a[190:191], v193 offset:12288
v_mfma_f32_16x16x32_bf16 v[144:147], a[160:163], v[176:179], v[144:147]
buffer_load_dwordx4 a[72:75], v14, s[44:47], s65 offen offset:1024 sc1
v_mfma_f32_16x16x32_bf16 v[144:147], a[164:167], v[180:183], v[144:147]
v_mfma_f32_16x16x32_bf16 v[112:115], a[164:167], v[172:175], v[112:115]
ds_read_b64_tr_b16 a[192:193], v194 offset:0
v_mfma_f32_16x16x32_bf16 v[112:115], a[160:163], v[168:171], v[112:115]
ds_read_b64_tr_b16 a[194:195], v194 offset:4096
v_mfma_f32_16x16x32_bf16 v[80:83], a[160:163], v[160:163], v[80:83]
buffer_load_dwordx4 a[80:83], v15, s[44:47], s65 offen offset:0 sc1
v_mfma_f32_16x16x32_bf16 v[80:83], a[164:167], v[164:167], v[80:83]
ds_read_b64_tr_b16 a[196:197], v194 offset:8192
v_mfma_f32_16x16x32_bf16 v[48:51], a[164:167], v[156:159], v[48:51]
ds_read_b64_tr_b16 a[198:199], v194 offset:12288
v_mfma_f32_16x16x32_bf16 v[48:51], a[160:163], v[152:155], v[48:51]
buffer_load_dwordx4 a[88:91], v15, s[44:47], s65 offen offset:1024 sc1
v_mfma_f32_16x16x32_bf16 v[52:55], a[168:171], v[152:155], v[52:55]
v_mfma_f32_16x16x32_bf16 v[52:55], a[172:175], v[156:159], v[52:55]
v_mfma_f32_16x16x32_bf16 v[84:87], a[172:175], v[164:167], v[84:87]
s_add_u32 s65, s84, 106496
ds_read_b64_tr_b16 a[200:201], v195 offset:0
v_mfma_f32_16x16x32_bf16 v[84:87], a[168:171], v[160:163], v[84:87]
buffer_load_dwordx4 a[68:71], v14, s[44:47], s65 offen offset:0 sc1
v_mfma_f32_16x16x32_bf16 v[116:119], a[168:171], v[168:171], v[116:119]
ds_read_b64_tr_b16 a[202:203], v195 offset:4096
v_mfma_f32_16x16x32_bf16 v[116:119], a[172:175], v[172:175], v[116:119]
ds_read_b64_tr_b16 a[204:205], v195 offset:8192
v_mfma_f32_16x16x32_bf16 v[148:151], a[172:175], v[180:183], v[148:151]
ds_read_b64_tr_b16 a[206:207], v195 offset:12288
v_mfma_f32_16x16x32_bf16 v[148:151], a[168:171], v[176:179], v[148:151]
s_lshl_b32 s66, s30, 30
buffer_load_dwordx4 a[76:79], v14, s[44:47], s65 offen offset:1024 sc1
v_mfma_f32_16x16x32_bf16 v[120:123], a[176:179], v[176:179], v[120:123]
s_waitcnt lgkmcnt(4)
v_lshl_add_u32 v1, v0, 24, s66
v_mfma_f32_16x16x32_bf16 v[120:123], a[180:183], v[180:183], v[120:123]
v_mfma_f32_16x16x32_bf16 v[88:91], a[180:183], v[172:175], v[88:91]
buffer_load_dwordx4 a[84:87], v15, s[44:47], s65 offen offset:0 sc1
v_mfma_f32_16x16x32_bf16 v[88:91], a[176:179], v[168:171], v[88:91]
v_mfma_f32_16x16x32_bf16 v[56:59], a[176:179], v[160:163], v[56:59]
v_mfma_f32_16x16x32_bf16 v[56:59], a[180:183], v[164:167], v[56:59]
v_mfma_f32_16x16x32_bf16 v[24:27], a[180:183], v[156:159], v[24:27]
buffer_load_dwordx4 a[92:95], v15, s[44:47], s65 offen offset:1024 sc1
v_mfma_f32_16x16x32_bf16 v[24:27], a[176:179], v[152:155], v[24:27]
v_mfma_f32_16x16x32_bf16 v[28:31], a[184:187], v[152:155], v[28:31]
v_mfma_f32_16x16x32_bf16 v[28:31], a[188:191], v[156:159], v[28:31]
v_mfma_f32_16x16x32_bf16 v[60:63], a[188:191], v[164:167], v[60:63]
v_mfma_f32_16x16x32_bf16 v[60:63], a[184:187], v[160:163], v[60:63]
s_waitcnt vmcnt(24)
s_barrier
v_mfma_f32_16x16x32_bf16 v[92:95], a[184:187], v[168:171], v[92:95]
s_mov_b64 exec, 1
buffer_atomic_add a251, v1, s[52:55], s71 offen offset:0 sc1
s_mov_b64 exec, -1
v_mfma_f32_16x16x32_bf16 v[92:95], a[188:191], v[172:175], v[92:95]
ds_read_b64_tr_b16 a[144:145], v196 offset:32768
v_mfma_f32_16x16x32_bf16 v[124:127], a[188:191], v[180:183], v[124:127]
s_add_u32 m0, s86, 98304
ds_read_b64_tr_b16 a[146:147], v196 offset:36864
v_mfma_f32_16x16x32_bf16 v[124:127], a[184:187], v[176:179], v[124:127]
s_add_u32 s64, s85, 1048576
ds_read_b64_tr_b16 a[148:149], v196 offset:40960
v_mfma_f32_16x16x32_bf16 v[128:131], a[192:195], v[176:179], v[128:131]
buffer_load_dwordx4 v12, s[36:39], s64 offen lds
v_mfma_f32_16x16x32_bf16 v[128:131], a[196:199], v[180:183], v[128:131]
s_add_u32 m0, s86, 99328
ds_read_b64_tr_b16 a[150:151], v196 offset:45056
v_mfma_f32_16x16x32_bf16 v[96:99], a[196:199], v[172:175], v[96:99]
s_add_u32 s64, s85, 1056768
ds_read_b64_tr_b16 a[152:153], v197 offset:32768
v_mfma_f32_16x16x32_bf16 v[96:99], a[192:195], v[168:171], v[96:99]
buffer_load_dwordx4 v13, s[36:39], s64 offen lds
v_mfma_f32_16x16x32_bf16 v[64:67], a[192:195], v[160:163], v[64:67]
s_add_u32 m0, s86, 100352
ds_read_b64_tr_b16 a[154:155], v197 offset:36864
v_mfma_f32_16x16x32_bf16 v[64:67], a[196:199], v[164:167], v[64:67]
s_add_u32 s64, s85, 1064960
ds_read_b64_tr_b16 a[156:157], v197 offset:40960
v_mfma_f32_16x16x32_bf16 v[32:35], a[196:199], v[156:159], v[32:35]
buffer_load_dwordx4 v12, s[36:39], s64 offen lds
v_mfma_f32_16x16x32_bf16 v[32:35], a[192:195], v[152:155], v[32:35]
s_waitcnt lgkmcnt(4)
s_add_u32 m0, s86, 101376
ds_read_b64_tr_b16 a[158:159], v197 offset:45056
v_mfma_f32_16x16x32_bf16 v[36:39], a[200:203], v[152:155], v[36:39]
s_add_u32 s64, s85, 1073152
ds_read_b64_tr_b16 a[160:161], v198 offset:32768
v_mfma_f32_16x16x32_bf16 v[36:39], a[204:207], v[156:159], v[36:39]
buffer_load_dwordx4 v13, s[36:39], s64 offen lds
v_mfma_f32_16x16x32_bf16 v[68:71], a[204:207], v[164:167], v[68:71]
s_add_u32 m0, s86, 102400
ds_read_b64_tr_b16 a[162:163], v198 offset:36864
v_mfma_f32_16x16x32_bf16 v[68:71], a[200:203], v[160:163], v[68:71]
s_add_u32 s64, s85, 1081344
ds_read_b64_tr_b16 a[164:165], v198 offset:40960
v_mfma_f32_16x16x32_bf16 v[100:103], a[200:203], v[168:171], v[100:103]
buffer_load_dwordx4 v12, s[36:39], s64 offen lds
v_mfma_f32_16x16x32_bf16 v[100:103], a[204:207], v[172:175], v[100:103]
ds_read_b64_tr_b16 a[166:167], v198 offset:45056
v_mfma_f32_16x16x32_bf16 v[132:135], a[204:207], v[180:183], v[132:135]
v_mfma_f32_16x16x32_bf16 v[132:135], a[200:203], v[176:179], v[132:135]
s_waitcnt vmcnt(26)
v_mfma_f32_16x16x32_bf16 v[136:139], a[144:147], a[24:27], v[136:139]
s_waitcnt vmcnt(22)
s_waitcnt lgkmcnt(3)
s_add_u32 m0, s86, 103424
ds_read_b64_tr_b16 a[168:169], v199 offset:32768
v_mfma_f32_16x16x32_bf16 v[136:139], a[148:151], a[28:31], v[136:139]
s_add_u32 s64, s85, 1089536
ds_read_b64_tr_b16 a[170:171], v199 offset:36864
v_mfma_f32_16x16x32_bf16 v[104:107], a[148:151], a[20:23], v[104:107]
buffer_load_dwordx4 v13, s[36:39], s64 offen lds
v_mfma_f32_16x16x32_bf16 v[104:107], a[144:147], a[16:19], v[104:107]
s_add_u32 m0, s86, 104448
ds_read_b64_tr_b16 a[172:173], v199 offset:40960
v_mfma_f32_16x16x32_bf16 v[72:75], a[144:147], a[8:11], v[72:75]
s_add_u32 s64, s85, 1097728
ds_read_b64_tr_b16 a[174:175], v199 offset:45056
v_mfma_f32_16x16x32_bf16 v[72:75], a[148:151], a[12:15], v[72:75]
buffer_load_dwordx4 v12, s[36:39], s64 offen lds
v_mfma_f32_16x16x32_bf16 v[40:43], a[148:151], a[4:7], v[40:43]
ds_read_b64_tr_b16 a[176:177], v192 offset:32768
v_mfma_f32_16x16x32_bf16 v[40:43], a[144:147], a[0:3], v[40:43]
s_add_u32 m0, s86, 105472
ds_read_b64_tr_b16 a[178:179], v192 offset:36864
v_mfma_f32_16x16x32_bf16 v[44:47], a[152:155], a[0:3], v[44:47]
s_add_u32 s64, s85, 1105920
ds_read_b64_tr_b16 a[180:181], v192 offset:40960
v_mfma_f32_16x16x32_bf16 v[44:47], a[156:159], a[4:7], v[44:47]
buffer_load_dwordx4 v13, s[36:39], s64 offen lds
v_mfma_f32_16x16x32_bf16 v[76:79], a[156:159], a[12:15], v[76:79]
ds_read_b64_tr_b16 a[182:183], v192 offset:45056
v_mfma_f32_16x16x32_bf16 v[76:79], a[152:155], a[8:11], v[76:79]
s_add_u32 s65, s84, 131072
ds_read_b64_tr_b16 a[184:185], v193 offset:32768
v_mfma_f32_16x16x32_bf16 v[108:111], a[152:155], a[16:19], v[108:111]
buffer_load_dwordx4 a[32:35], v14, s[44:47], s65 offen offset:0 sc1
v_mfma_f32_16x16x32_bf16 v[108:111], a[156:159], a[20:23], v[108:111]
ds_read_b64_tr_b16 a[186:187], v193 offset:36864
v_mfma_f32_16x16x32_bf16 v[140:143], a[156:159], a[28:31], v[140:143]
ds_read_b64_tr_b16 a[188:189], v193 offset:40960
v_mfma_f32_16x16x32_bf16 v[140:143], a[152:155], a[24:27], v[140:143]
s_waitcnt lgkmcnt(5)
ds_read_b64_tr_b16 a[190:191], v193 offset:45056
v_mfma_f32_16x16x32_bf16 v[144:147], a[160:163], a[24:27], v[144:147]
s_and_b32 s68, s82, 3
buffer_load_dwordx4 a[40:43], v14, s[44:47], s65 offen offset:1024 sc1
v_mfma_f32_16x16x32_bf16 v[144:147], a[164:167], a[28:31], v[144:147]
s_lshl_b32 s68, s68, 11
s_add_u32 s76, s86, s68
s_lshr_b32 s69, s87, 8
v_mfma_f32_16x16x32_bf16 v[112:115], a[164:167], a[20:23], v[112:115]
s_lshr_b32 s67, s82, 1
s_xor_b32 s69, s69, s67
ds_read_b64_tr_b16 a[192:193], v194 offset:32768
v_mfma_f32_16x16x32_bf16 v[112:115], a[160:163], a[16:19], v[112:115]
s_and_b32 s69, s69, 2
s_lshl_b32 s69, s69, 15
ds_read_b64_tr_b16 a[194:195], v194 offset:36864
v_mfma_f32_16x16x32_bf16 v[80:83], a[160:163], a[8:11], v[80:83]
s_add_u32 s68, s68, s69
buffer_load_dwordx4 a[48:51], v15, s[44:47], s65 offen offset:0 sc1
v_mfma_f32_16x16x32_bf16 v[80:83], a[164:167], a[12:15], v[80:83]
ds_read_b64_tr_b16 a[196:197], v194 offset:40960
v_mfma_f32_16x16x32_bf16 v[48:51], a[164:167], a[4:7], v[48:51]
ds_read_b64_tr_b16 a[198:199], v194 offset:45056
v_mfma_f32_16x16x32_bf16 v[48:51], a[160:163], a[0:3], v[48:51]
buffer_load_dwordx4 a[56:59], v15, s[44:47], s65 offen offset:1024 sc1
v_mfma_f32_16x16x32_bf16 v[52:55], a[168:171], a[0:3], v[52:55]
v_mfma_f32_16x16x32_bf16 v[52:55], a[172:175], a[4:7], v[52:55]
v_mfma_f32_16x16x32_bf16 v[84:87], a[172:175], a[12:15], v[84:87]
s_add_u32 s65, s84, 139264
ds_read_b64_tr_b16 a[200:201], v195 offset:32768
v_mfma_f32_16x16x32_bf16 v[84:87], a[168:171], a[8:11], v[84:87]
buffer_load_dwordx4 a[36:39], v14, s[44:47], s65 offen offset:0 sc1
v_mfma_f32_16x16x32_bf16 v[116:119], a[168:171], a[16:19], v[116:119]
ds_read_b64_tr_b16 a[202:203], v195 offset:36864
v_mfma_f32_16x16x32_bf16 v[116:119], a[172:175], a[20:23], v[116:119]
ds_read_b64_tr_b16 a[204:205], v195 offset:40960
v_mfma_f32_16x16x32_bf16 v[148:151], a[172:175], a[28:31], v[148:151]
ds_read_b64_tr_b16 a[206:207], v195 offset:45056
v_mfma_f32_16x16x32_bf16 v[148:151], a[168:171], a[24:27], v[148:151]
buffer_load_dwordx4 a[44:47], v14, s[44:47], s65 offen offset:1024 sc1
v_mfma_f32_16x16x32_bf16 v[120:123], a[176:179], a[24:27], v[120:123]
s_waitcnt lgkmcnt(4)
v_mfma_f32_16x16x32_bf16 v[120:123], a[180:183], a[28:31], v[120:123]
v_mfma_f32_16x16x32_bf16 v[88:91], a[180:183], a[20:23], v[88:91]
buffer_load_dwordx4 a[52:55], v15, s[44:47], s65 offen offset:0 sc1
v_mfma_f32_16x16x32_bf16 v[88:91], a[176:179], a[16:19], v[88:91]
v_mfma_f32_16x16x32_bf16 v[56:59], a[176:179], a[8:11], v[56:59]
v_mfma_f32_16x16x32_bf16 v[56:59], a[180:183], a[12:15], v[56:59]
v_mfma_f32_16x16x32_bf16 v[24:27], a[180:183], a[4:7], v[24:27]
buffer_load_dwordx4 a[60:63], v15, s[44:47], s65 offen offset:1024 sc1
v_mfma_f32_16x16x32_bf16 v[24:27], a[176:179], a[0:3], v[24:27]
v_mfma_f32_16x16x32_bf16 v[28:31], a[184:187], a[0:3], v[28:31]
v_mfma_f32_16x16x32_bf16 v[28:31], a[188:191], a[4:7], v[28:31]
v_mfma_f32_16x16x32_bf16 v[60:63], a[188:191], a[12:15], v[60:63]
s_lshl3_add_u32 s85, s68, s85
v_mfma_f32_16x16x32_bf16 v[60:63], a[184:187], a[8:11], v[60:63]
s_waitcnt vmcnt(25)
s_barrier
v_mfma_f32_16x16x32_bf16 v[92:95], a[184:187], a[16:19], v[92:95]
ds_read_b64_tr_b16 a[144:145], v204 offset:0
v_mfma_f32_16x16x32_bf16 v[92:95], a[188:191], a[20:23], v[92:95]
ds_read_b64_tr_b16 a[146:147], v204 offset:4096
v_mfma_f32_16x16x32_bf16 v[124:127], a[188:191], a[28:31], v[124:127]
s_xor_b32 m0, s76, 131072
ds_read_b64_tr_b16 a[148:149], v204 offset:8192
v_mfma_f32_16x16x32_bf16 v[124:127], a[184:187], a[24:27], v[124:127]
s_xor_b32 s64, s85, 0
ds_read_b64_tr_b16 a[150:151], v204 offset:12288
v_mfma_f32_16x16x32_bf16 v[128:131], a[192:195], a[24:27], v[128:131]
buffer_load_dwordx4 v12, s[40:43], s64 offen lds
v_mfma_f32_16x16x32_bf16 v[128:131], a[196:199], a[28:31], v[128:131]
s_xor_b32 m0, s76, 132096
ds_read_b64_tr_b16 a[152:153], v205 offset:0
v_mfma_f32_16x16x32_bf16 v[96:99], a[196:199], a[20:23], v[96:99]
s_xor_b32 s64, s85, 8192
ds_read_b64_tr_b16 a[154:155], v205 offset:4096
v_mfma_f32_16x16x32_bf16 v[96:99], a[192:195], a[16:19], v[96:99]
buffer_load_dwordx4 v13, s[40:43], s64 offen lds
v_mfma_f32_16x16x32_bf16 v[64:67], a[192:195], a[8:11], v[64:67]
s_xor_b32 m0, s76, 133120
ds_read_b64_tr_b16 a[156:157], v205 offset:8192
v_mfma_f32_16x16x32_bf16 v[64:67], a[196:199], a[12:15], v[64:67]
s_xor_b32 s64, s85, 16384
ds_read_b64_tr_b16 a[158:159], v205 offset:12288
v_mfma_f32_16x16x32_bf16 v[32:35], a[196:199], a[4:7], v[32:35]
buffer_load_dwordx4 v12, s[40:43], s64 offen lds
v_mfma_f32_16x16x32_bf16 v[32:35], a[192:195], a[0:3], v[32:35]
s_waitcnt lgkmcnt(4)
s_xor_b32 m0, s76, 134144
ds_read_b64_tr_b16 a[160:161], v206 offset:0
v_mfma_f32_16x16x32_bf16 v[36:39], a[200:203], a[0:3], v[36:39]
s_xor_b32 s64, s85, 24576
ds_read_b64_tr_b16 a[162:163], v206 offset:4096
v_mfma_f32_16x16x32_bf16 v[36:39], a[204:207], a[4:7], v[36:39]
buffer_load_dwordx4 v13, s[40:43], s64 offen lds
v_mfma_f32_16x16x32_bf16 v[68:71], a[204:207], a[12:15], v[68:71]
s_xor_b32 m0, s76, 135168
ds_read_b64_tr_b16 a[164:165], v206 offset:8192
v_mfma_f32_16x16x32_bf16 v[68:71], a[200:203], a[8:11], v[68:71]
s_xor_b32 s64, s85, 32768
ds_read_b64_tr_b16 a[166:167], v206 offset:12288
v_mfma_f32_16x16x32_bf16 v[100:103], a[200:203], a[16:19], v[100:103]
buffer_load_dwordx4 v12, s[40:43], s64 offen lds
v_mfma_f32_16x16x32_bf16 v[100:103], a[204:207], a[20:23], v[100:103]
v_mfma_f32_16x16x32_bf16 v[132:135], a[204:207], a[28:31], v[132:135]
v_mfma_f32_16x16x32_bf16 v[132:135], a[200:203], a[24:27], v[132:135]
s_waitcnt vmcnt(26)
v_mfma_f32_16x16x32_bf16 v[136:139], a[144:147], a[88:91], v[136:139]
s_waitcnt vmcnt(22)
s_xor_b32 m0, s76, 136192
ds_read_b64_tr_b16 a[168:169], v207 offset:0
v_mfma_f32_16x16x32_bf16 v[136:139], a[148:151], a[92:95], v[136:139]
s_xor_b32 s64, s85, 40960
ds_read_b64_tr_b16 a[170:171], v207 offset:4096
v_mfma_f32_16x16x32_bf16 v[104:107], a[148:151], a[84:87], v[104:107]
buffer_load_dwordx4 v13, s[40:43], s64 offen lds
v_mfma_f32_16x16x32_bf16 v[104:107], a[144:147], a[80:83], v[104:107]
ds_read_b64_tr_b16 a[172:173], v207 offset:8192
v_mfma_f32_16x16x32_bf16 v[72:75], a[144:147], a[72:75], v[72:75]
ds_read_b64_tr_b16 a[174:175], v207 offset:12288
v_mfma_f32_16x16x32_bf16 v[72:75], a[148:151], a[76:79], v[72:75]
ds_read_b64_tr_b16 a[176:177], v200 offset:0
v_mfma_f32_16x16x32_bf16 v[40:43], a[148:151], a[68:71], v[40:43]
ds_read_b64_tr_b16 a[178:179], v200 offset:4096
v_mfma_f32_16x16x32_bf16 v[40:43], a[144:147], a[64:67], v[40:43]
s_waitcnt lgkmcnt(6)
ds_read_b64_tr_b16 a[180:181], v200 offset:8192
v_mfma_f32_16x16x32_bf16 v[44:47], a[152:155], a[64:67], v[44:47]
s_xor_b32 m0, s76, 137216
ds_read_b64_tr_b16 a[182:183], v200 offset:12288
v_mfma_f32_16x16x32_bf16 v[44:47], a[156:159], a[68:71], v[44:47]
s_xor_b32 s64, s85, 49152
v_mfma_f32_16x16x32_bf16 v[76:79], a[156:159], a[76:79], v[76:79]
buffer_load_dwordx4 v12, s[40:43], s64 offen lds
v_mfma_f32_16x16x32_bf16 v[76:79], a[152:155], a[72:75], v[76:79]
ds_read_b64_tr_b16 a[184:185], v201 offset:0
v_mfma_f32_16x16x32_bf16 v[108:111], a[152:155], a[80:83], v[108:111]
ds_read_b64_tr_b16 a[186:187], v201 offset:4096
v_mfma_f32_16x16x32_bf16 v[108:111], a[156:159], a[84:87], v[108:111]
ds_read_b64_tr_b16 a[188:189], v201 offset:8192
v_mfma_f32_16x16x32_bf16 v[140:143], a[156:159], a[92:95], v[140:143]
ds_read_b64_tr_b16 a[190:191], v201 offset:12288
v_mfma_f32_16x16x32_bf16 v[140:143], a[152:155], a[88:91], v[140:143]
v_mfma_f32_16x16x32_bf16 v[144:147], a[160:163], a[88:91], v[144:147]
v_mfma_f32_16x16x32_bf16 v[144:147], a[164:167], a[92:95], v[144:147]
s_xor_b32 m0, s76, 138240
v_mfma_f32_16x16x32_bf16 v[112:115], a[164:167], a[84:87], v[112:115]
s_xor_b32 s64, s85, 57344
ds_read_b64_tr_b16 a[192:193], v202 offset:0
v_mfma_f32_16x16x32_bf16 v[112:115], a[160:163], a[80:83], v[112:115]
buffer_load_dwordx4 v13, s[40:43], s64 offen lds
v_mfma_f32_16x16x32_bf16 v[80:83], a[160:163], a[72:75], v[80:83]
ds_read_b64_tr_b16 a[194:195], v202 offset:4096
v_mfma_f32_16x16x32_bf16 v[80:83], a[164:167], a[76:79], v[80:83]
ds_read_b64_tr_b16 a[196:197], v202 offset:8192
v_mfma_f32_16x16x32_bf16 v[48:51], a[164:167], a[68:71], v[48:51]
ds_read_b64_tr_b16 a[198:199], v202 offset:12288
v_mfma_f32_16x16x32_bf16 v[48:51], a[160:163], a[64:67], v[48:51]
s_waitcnt lgkmcnt(4)
v_mfma_f32_16x16x32_bf16 v[52:55], a[168:171], a[64:67], v[52:55]
v_mfma_f32_16x16x32_bf16 v[52:55], a[172:175], a[68:71], v[52:55]
v_mfma_f32_16x16x32_bf16 v[84:87], a[172:175], a[76:79], v[84:87]
ds_read_b64_tr_b16 a[200:201], v203 offset:0
v_mfma_f32_16x16x32_bf16 v[84:87], a[168:171], a[72:75], v[84:87]
ds_read_b64_tr_b16 a[202:203], v203 offset:4096
v_mfma_f32_16x16x32_bf16 v[116:119], a[168:171], a[80:83], v[116:119]
ds_read_b64_tr_b16 a[204:205], v203 offset:8192
v_mfma_f32_16x16x32_bf16 v[116:119], a[172:175], a[84:87], v[116:119]
ds_read_b64_tr_b16 a[206:207], v203 offset:12288
v_mfma_f32_16x16x32_bf16 v[148:151], a[172:175], a[92:95], v[148:151]
buffer_load_dword v19, off, s[52:55], s72 sc1
v_mfma_f32_16x16x32_bf16 v[148:151], a[168:171], a[88:91], v[148:151]
v_mfma_f32_16x16x32_bf16 v[120:123], a[176:179], a[88:91], v[120:123]
v_mfma_f32_16x16x32_bf16 v[120:123], a[180:183], a[92:95], v[120:123]
v_mfma_f32_16x16x32_bf16 v[88:91], a[180:183], a[84:87], v[88:91]
v_mfma_f32_16x16x32_bf16 v[88:91], a[176:179], a[80:83], v[88:91]
s_branch L_po31
L_pg31:
s_branch L_tr2
L_po31:
v_mfma_f32_16x16x32_bf16 v[56:59], a[176:179], a[72:75], v[56:59]
v_mfma_f32_16x16x32_bf16 v[56:59], a[180:183], a[76:79], v[56:59]
v_mfma_f32_16x16x32_bf16 v[24:27], a[180:183], a[68:71], v[24:27]
v_mfma_f32_16x16x32_bf16 v[24:27], a[176:179], a[64:67], v[24:27]
v_mfma_f32_16x16x32_bf16 v[28:31], a[184:187], a[64:67], v[28:31]
v_mfma_f32_16x16x32_bf16 v[28:31], a[188:191], a[68:71], v[28:31]
v_mfma_f32_16x16x32_bf16 v[60:63], a[188:191], a[76:79], v[60:63]
v_mfma_f32_16x16x32_bf16 v[60:63], a[184:187], a[72:75], v[60:63]
s_waitcnt vmcnt(17)
s_barrier
v_mfma_f32_16x16x32_bf16 v[92:95], a[184:187], a[80:83], v[92:95]
ds_read_b64_tr_b16 a[144:145], v188 offset:0
v_mfma_f32_16x16x32_bf16 v[92:95], a[188:191], a[84:87], v[92:95]
ds_read_b64_tr_b16 a[146:147], v188 offset:4096
v_mfma_f32_16x16x32_bf16 v[124:127], a[188:191], a[92:95], v[124:127]
s_xor_b32 m0, s76, 32768
ds_read_b64_tr_b16 a[148:149], v188 offset:8192
v_mfma_f32_16x16x32_bf16 v[124:127], a[184:187], a[88:91], v[124:127]
s_waitcnt lgkmcnt(3)
s_xor_b32 s64, s85, 262144
ds_read_b64_tr_b16 a[150:151], v188 offset:12288
v_mfma_f32_16x16x32_bf16 v[128:131], a[192:195], a[88:91], v[128:131]
buffer_load_dwordx4 v12, s[40:43], s64 offen lds
v_mfma_f32_16x16x32_bf16 v[128:131], a[196:199], a[92:95], v[128:131]
s_xor_b32 m0, s76, 33792
s_xor_b32 s64, s85, 270336
ds_read_b64_tr_b16 a[152:153], v189 offset:0
v_mfma_f32_16x16x32_bf16 v[96:99], a[196:199], a[84:87], v[96:99]
buffer_load_dwordx4 v13, s[40:43], s64 offen lds
v_mfma_f32_16x16x32_bf16 v[96:99], a[192:195], a[80:83], v[96:99]
s_xor_b32 m0, s76, 34816
ds_read_b64_tr_b16 a[154:155], v189 offset:4096
v_mfma_f32_16x16x32_bf16 v[64:67], a[192:195], a[72:75], v[64:67]
s_xor_b32 s64, s85, 278528
ds_read_b64_tr_b16 a[156:157], v189 offset:8192
v_mfma_f32_16x16x32_bf16 v[64:67], a[196:199], a[76:79], v[64:67]
buffer_load_dwordx4 v12, s[40:43], s64 offen lds
v_mfma_f32_16x16x32_bf16 v[32:35], a[196:199], a[68:71], v[32:35]
s_xor_b32 m0, s76, 35840
ds_read_b64_tr_b16 a[158:159], v189 offset:12288
v_mfma_f32_16x16x32_bf16 v[32:35], a[192:195], a[64:67], v[32:35]
s_xor_b32 s64, s85, 286720
ds_read_b64_tr_b16 a[160:161], v190 offset:0
v_mfma_f32_16x16x32_bf16 v[36:39], a[200:203], a[64:67], v[36:39]
buffer_load_dwordx4 v13, s[40:43], s64 offen lds
v_mfma_f32_16x16x32_bf16 v[36:39], a[204:207], a[68:71], v[36:39]
s_xor_b32 m0, s76, 36864
s_xor_b32 s64, s85, 294912
ds_read_b64_tr_b16 a[162:163], v190 offset:4096
v_mfma_f32_16x16x32_bf16 v[68:71], a[204:207], a[76:79], v[68:71]
buffer_load_dwordx4 v12, s[40:43], s64 offen lds
v_mfma_f32_16x16x32_bf16 v[68:71], a[200:203], a[72:75], v[68:71]
s_xor_b32 m0, s76, 37888
ds_read_b64_tr_b16 a[164:165], v190 offset:8192
v_mfma_f32_16x16x32_bf16 v[100:103], a[200:203], a[80:83], v[100:103]
s_xor_b32 s64, s85, 303104
ds_read_b64_tr_b16 a[166:167], v190 offset:12288
v_mfma_f32_16x16x32_bf16 v[100:103], a[204:207], a[84:87], v[100:103]
buffer_load_dwordx4 v13, s[40:43], s64 offen lds
v_mfma_f32_16x16x32_bf16 v[132:135], a[204:207], a[92:95], v[132:135]
v_mfma_f32_16x16x32_bf16 v[132:135], a[200:203], a[88:91], v[132:135]
s_waitcnt vmcnt(19)
s_waitcnt lgkmcnt(3)
v_mfma_f32_16x16x32_bf16 v[136:139], a[144:147], a[56:59], v[136:139]
s_waitcnt vmcnt(6)
v_readfirstlane_b32 vcc_lo, v19
s_nop 0
s_cmp_lt_u32 vcc_lo, 8
s_cbranch_scc1 L_spin_3019
L_spinbk_3020:
s_sub_u32 s84, s84, 1048576
s_add_u32 s84, s84, s69
v_mfma_f32_16x16x32_bf16 v[136:139], a[148:151], a[60:63], v[136:139]
s_xor_b32 s65, s84, 0
ds_read_b64_tr_b16 a[168:169], v191 offset:0
v_mfma_f32_16x16x32_bf16 v[104:107], a[148:151], a[52:55], v[104:107]
buffer_load_dwordx4 a[208:211], v14, s[44:47], s65 offen offset:0 sc1
v_mfma_f32_16x16x32_bf16 v[104:107], a[144:147], a[48:51], v[104:107]
ds_read_b64_tr_b16 a[170:171], v191 offset:4096
v_mfma_f32_16x16x32_bf16 v[72:75], a[144:147], a[40:43], v[72:75]
buffer_load_dwordx4 a[216:219], v14, s[44:47], s65 offen offset:1024 sc1
v_mfma_f32_16x16x32_bf16 v[72:75], a[148:151], a[44:47], v[72:75]
ds_read_b64_tr_b16 a[172:173], v191 offset:8192
v_mfma_f32_16x16x32_bf16 v[40:43], a[148:151], a[36:39], v[40:43]
buffer_load_dwordx4 a[224:227], v15, s[44:47], s65 offen offset:0 sc1
v_mfma_f32_16x16x32_bf16 v[40:43], a[144:147], a[32:35], v[40:43]
ds_read_b64_tr_b16 a[174:175], v191 offset:12288
v_mfma_f32_16x16x32_bf16 v[44:47], a[152:155], a[32:35], v[44:47]
buffer_load_dwordx4 a[232:235], v15, s[44:47], s65 offen offset:1024 sc1
v_mfma_f32_16x16x32_bf16 v[44:47], a[156:159], a[36:39], v[44:47]
s_xor_b32 s65, s84, 8192
ds_read_b64_tr_b16 a[176:177], v184 offset:0
v_mfma_f32_16x16x32_bf16 v[76:79], a[156:159], a[44:47], v[76:79]
buffer_load_dwordx4 a[212:215], v14, s[44:47], s65 offen offset:0 sc1
v_mfma_f32_16x16x32_bf16 v[76:79], a[152:155], a[40:43], v[76:79]
ds_read_b64_tr_b16 a[178:179], v184 offset:4096
v_mfma_f32_16x16x32_bf16 v[108:111], a[152:155], a[48:51], v[108:111]
ds_read_b64_tr_b16 a[180:181], v184 offset:8192
v_mfma_f32_16x16x32_bf16 v[108:111], a[156:159], a[52:55], v[108:111]
buffer_load_dwordx4 a[220:223], v14, s[44:47], s65 offen offset:1024 sc1
v_mfma_f32_16x16x32_bf16 v[140:143], a[156:159], a[60:63], v[140:143]
ds_read_b64_tr_b16 a[182:183], v184 offset:12288
v_mfma_f32_16x16x32_bf16 v[140:143], a[152:155], a[56:59], v[140:143]
s_waitcnt lgkmcnt(4)
buffer_load_dwordx4 a[228:231], v15, s[44:47], s65 offen offset:0 sc1
v_mfma_f32_16x16x32_bf16 v[144:147], a[160:163], a[56:59], v[144:147]
ds_read_b64_tr_b16 a[184:185], v185 offset:0
v_mfma_f32_16x16x32_bf16 v[144:147], a[164:167], a[60:63], v[144:147]
buffer_load_dwordx4 a[236:239], v15, s[44:47], s65 offen offset:1024 sc1
v_mfma_f32_16x16x32_bf16 v[112:115], a[164:167], a[52:55], v[112:115]
s_xor_b32 m0, s76, 38912
s_xor_b32 s64, s85, 311296
ds_read_b64_tr_b16 a[186:187], v185 offset:4096
v_mfma_f32_16x16x32_bf16 v[112:115], a[160:163], a[48:51], v[112:115]
buffer_load_dwordx4 v12, s[40:43], s64 offen lds
v_mfma_f32_16x16x32_bf16 v[80:83], a[160:163], a[40:43], v[80:83]
s_xor_b32 m0, s76, 39936
ds_read_b64_tr_b16 a[188:189], v185 offset:8192
v_mfma_f32_16x16x32_bf16 v[80:83], a[164:167], a[44:47], v[80:83]
s_xor_b32 s64, s85, 319488
ds_read_b64_tr_b16 a[190:191], v185 offset:12288
v_mfma_f32_16x16x32_bf16 v[48:51], a[164:167], a[36:39], v[48:51]
buffer_load_dwordx4 v13, s[40:43], s64 offen lds
v_mfma_f32_16x16x32_bf16 v[48:51], a[160:163], a[32:35], v[48:51]
s_xor_b32 s65, s84, 32768
ds_read_b64_tr_b16 a[192:193], v186 offset:0
v_mfma_f32_16x16x32_bf16 v[52:55], a[168:171], a[32:35], v[52:55]
buffer_load_dwordx4 v[152:155], v14, s[44:47], s65 offen offset:0 sc1
v_mfma_f32_16x16x32_bf16 v[52:55], a[172:175], a[36:39], v[52:55]
ds_read_b64_tr_b16 a[194:195], v186 offset:4096
v_mfma_f32_16x16x32_bf16 v[84:87], a[172:175], a[44:47], v[84:87]
buffer_load_dwordx4 v[160:163], v14, s[44:47], s65 offen offset:1024 sc1
v_mfma_f32_16x16x32_bf16 v[84:87], a[168:171], a[40:43], v[84:87]
ds_read_b64_tr_b16 a[196:197], v186 offset:8192
v_mfma_f32_16x16x32_bf16 v[116:119], a[168:171], a[48:51], v[116:119]
buffer_load_dwordx4 v[168:171], v15, s[44:47], s65 offen offset:0 sc1
v_mfma_f32_16x16x32_bf16 v[116:119], a[172:175], a[52:55], v[116:119]
ds_read_b64_tr_b16 a[198:199], v186 offset:12288
v_mfma_f32_16x16x32_bf16 v[148:151], a[172:175], a[60:63], v[148:151]
buffer_load_dwordx4 v[176:179], v15, s[44:47], s65 offen offset:1024 sc1
v_mfma_f32_16x16x32_bf16 v[148:151], a[168:171], a[56:59], v[148:151]
s_waitcnt lgkmcnt(3)
ds_read_b64_tr_b16 a[200:201], v187 offset:0
v_mfma_f32_16x16x32_bf16 v[120:123], a[176:179], a[56:59], v[120:123]
s_xor_b32 s65, s84, 40960
ds_read_b64_tr_b16 a[202:203], v187 offset:4096
v_mfma_f32_16x16x32_bf16 v[120:123], a[180:183], a[60:63], v[120:123]
buffer_load_dwordx4 v[156:159], v14, s[44:47], s65 offen offset:0 sc1
v_mfma_f32_16x16x32_bf16 v[88:91], a[180:183], a[52:55], v[88:91]
ds_read_b64_tr_b16 a[204:205], v187 offset:8192
v_mfma_f32_16x16x32_bf16 v[88:91], a[176:179], a[48:51], v[88:91]
buffer_load_dwordx4 v[164:167], v14, s[44:47], s65 offen offset:1024 sc1
v_mfma_f32_16x16x32_bf16 v[56:59], a[176:179], a[40:43], v[56:59]
ds_read_b64_tr_b16 a[206:207], v187 offset:12288
v_mfma_f32_16x16x32_bf16 v[56:59], a[180:183], a[44:47], v[56:59]
buffer_load_dwordx4 v[172:175], v15, s[44:47], s65 offen offset:0 sc1
v_mfma_f32_16x16x32_bf16 v[24:27], a[180:183], a[36:39], v[24:27]
v_mfma_f32_16x16x32_bf16 v[24:27], a[176:179], a[32:35], v[24:27]
buffer_load_dwordx4 v[180:183], v15, s[44:47], s65 offen offset:1024 sc1
v_mfma_f32_16x16x32_bf16 v[28:31], a[184:187], a[32:35], v[28:31]
v_mfma_f32_16x16x32_bf16 v[28:31], a[188:191], a[36:39], v[28:31]
v_mfma_f32_16x16x32_bf16 v[60:63], a[188:191], a[44:47], v[60:63]
v_mfma_f32_16x16x32_bf16 v[60:63], a[184:187], a[40:43], v[60:63]
s_barrier
v_mfma_f32_16x16x32_bf16 v[92:95], a[184:187], a[48:51], v[92:95]
ds_read_b64_tr_b16 a[144:145], v188 offset:32768
v_mfma_f32_16x16x32_bf16 v[92:95], a[188:191], a[52:55], v[92:95]
ds_read_b64_tr_b16 a[146:147], v188 offset:36864
v_mfma_f32_16x16x32_bf16 v[124:127], a[188:191], a[60:63], v[124:127]
s_xor_b32 m0, s76, 65536
ds_read_b64_tr_b16 a[148:149], v188 offset:40960
v_mfma_f32_16x16x32_bf16 v[124:127], a[184:187], a[56:59], v[124:127]
s_waitcnt lgkmcnt(3)
s_xor_b32 s64, s85, 524288
ds_read_b64_tr_b16 a[150:151], v188 offset:45056
v_mfma_f32_16x16x32_bf16 v[128:131], a[192:195], a[56:59], v[128:131]
buffer_load_dwordx4 v12, s[40:43], s64 offen lds
v_mfma_f32_16x16x32_bf16 v[128:131], a[196:199], a[60:63], v[128:131]
s_xor_b32 m0, s76, 66560
ds_read_b64_tr_b16 a[152:153], v189 offset:32768
v_mfma_f32_16x16x32_bf16 v[96:99], a[196:199], a[52:55], v[96:99]
s_xor_b32 s64, s85, 532480
ds_read_b64_tr_b16 a[154:155], v189 offset:36864
v_mfma_f32_16x16x32_bf16 v[96:99], a[192:195], a[48:51], v[96:99]
buffer_load_dwordx4 v13, s[40:43], s64 offen lds
v_mfma_f32_16x16x32_bf16 v[64:67], a[192:195], a[40:43], v[64:67]
s_xor_b32 m0, s76, 67584
ds_read_b64_tr_b16 a[156:157], v189 offset:40960
v_mfma_f32_16x16x32_bf16 v[64:67], a[196:199], a[44:47], v[64:67]
s_xor_b32 s64, s85, 540672
ds_read_b64_tr_b16 a[158:159], v189 offset:45056
v_mfma_f32_16x16x32_bf16 v[32:35], a[196:199], a[36:39], v[32:35]
buffer_load_dwordx4 v12, s[40:43], s64 offen lds
v_mfma_f32_16x16x32_bf16 v[32:35], a[192:195], a[32:35], v[32:35]
s_xor_b32 m0, s76, 68608
ds_read_b64_tr_b16 a[160:161], v190 offset:32768
v_mfma_f32_16x16x32_bf16 v[36:39], a[200:203], a[32:35], v[36:39]
s_xor_b32 s64, s85, 548864
ds_read_b64_tr_b16 a[162:163], v190 offset:36864
v_mfma_f32_16x16x32_bf16 v[36:39], a[204:207], a[36:39], v[36:39]
buffer_load_dwordx4 v13, s[40:43], s64 offen lds
v_mfma_f32_16x16x32_bf16 v[68:71], a[204:207], a[44:47], v[68:71]
s_xor_b32 m0, s76, 69632
ds_read_b64_tr_b16 a[164:165], v190 offset:40960
v_mfma_f32_16x16x32_bf16 v[68:71], a[200:203], a[40:43], v[68:71]
s_xor_b32 s64, s85, 557056
ds_read_b64_tr_b16 a[166:167], v190 offset:45056
v_mfma_f32_16x16x32_bf16 v[100:103], a[200:203], a[48:51], v[100:103]
buffer_load_dwordx4 v12, s[40:43], s64 offen lds
v_mfma_f32_16x16x32_bf16 v[100:103], a[204:207], a[52:55], v[100:103]
s_mov_b32 s70, 3
s_mov_b32 s73, 2
v_mfma_f32_16x16x32_bf16 v[132:135], a[204:207], a[60:63], v[132:135]
v_mfma_f32_16x16x32_bf16 v[132:135], a[200:203], a[56:59], v[132:135]
s_branch L_p5join
L_spin_4022:
s_mov_b32 vcc_hi, 0x80000
L_spinlp_4024:
s_sleep 1
buffer_load_dword v19, off, s[52:55], s72 offset:128 sc1
s_waitcnt vmcnt(0)
v_readfirstlane_b32 vcc_lo, v19
s_sub_u32 vcc_hi, vcc_hi, 1
s_cbranch_scc1 L_spinbk_4023
s_cmp_lt_u32 vcc_lo, s74
s_cbranch_scc1 L_spinlp_4024
s_branch L_spinbk_4023
L_codeend:
.section .rodata,"a"
.p2align 6
.amdhsa_kernel gated_mix__compressed_kv_cla__sliding_local_dilated__prompt_kernel
  .amdhsa_next_free_vgpr 512
  .amdhsa_next_free_sgpr 102
  .amdhsa_accum_offset 256
  .amdhsa_group_segment_fixed_size 0
  .amdhsa_kernarg_size 104
  .amdhsa_user_sgpr_count 2
  .amdhsa_user_sgpr_kernarg_segment_ptr 1
  .amdhsa_system_sgpr_workgroup_id_x 1
.end_amdhsa_kernel
```
